```python
import torch

def _softmax(x, axis=-1):
    return torch.softmax(x, dim=axis)
def _gelu(x):
    return torch.nn.functional.gelu(x, approximate="tanh")
def _silu(x):
    return torch.nn.functional.silu(x)
def _sigmoid(x):
    return torch.sigmoid(x)
def _layernorm(x, axis=-1, eps=1e-5):
    m = x.mean(dim=axis, keepdim=True)
    v = x.var(dim=axis, keepdim=True, unbiased=False)
    return (x - m) / torch.sqrt(v + eps)
def _scatter_add(tgt, idx, src, axis=0):
    return tgt.clone().index_add_(axis, idx, src)
def _segment_sum(src, seg, n):
    out = torch.zeros((n,) + src.shape[1:], dtype=src.dtype)
    return out.index_add_(0, seg, src)
def _pad(x, pw):
    flat = tuple(v for pair in reversed(pw) for v in pair)
    return torch.nn.functional.pad(x, flat)

kernel_name = 'concat_heads__compressed_kv_cla__sliding_local_dilated__prompt'

def setup_inputs():

    _w = (lambda a: (lambda t: t.to(torch.bfloat16) if t.is_floating_point() else t)(torch.as_tensor(a)))
    def _A_setup():
        B, H, Sq, Sk, D, M = 1, 32, 2048, 2048, 128, 1024
        Dc = 4 * D
        return {
            "x": _w((lambda *s: torch.randn(*s, dtype=torch.bfloat16) * 0.2)(B, Sq, M)),
            "c_kv": _w((lambda *s: torch.randn(*s, dtype=torch.bfloat16) * 1.6)(B, Sk, Dc)),
            "w_q": _w((lambda *s: torch.randn(*s, dtype=torch.bfloat16) * 3.2)(M, H, D) * (M ** -0.5)),
            "w_uk": _w((lambda *s: torch.randn(*s, dtype=torch.bfloat16) * 3.2)(Dc, H, D) * (Dc ** -0.5)),
            "w_uv": _w((lambda *s: torch.randn(*s, dtype=torch.bfloat16) * 1.6)(Dc, H, D) * (Dc ** -0.5)),
            "w_o": _w((lambda *s: torch.randn(*s, dtype=torch.bfloat16) * 1.6)(H, D, M) * ((H * D) ** -0.5)),
        }
    _A_in = _A_setup()

    def _B_setup():
        B, S, D = 1, 2048, 1024
        return {
            "x": _w((lambda *s: torch.randn(*s, dtype=torch.bfloat16) * 0.2)(B, S, D)),
            "wqkv": _w((lambda *s: torch.randn(*s, dtype=torch.bfloat16) * 0.2)(D, 3 * D)),
            "wo": _w((lambda *s: torch.randn(*s, dtype=torch.bfloat16) * 0.05)(D, D)),
        }
    _B_in = _B_setup()

    return {
        "A_x": _A_in["x"],
        "A_c_kv": _A_in["c_kv"],
        "A_w_q": _A_in["w_q"],
        "A_w_uk": _A_in["w_uk"],
        "A_w_uv": _A_in["w_uv"],
        "A_w_o": _A_in["w_o"],
        "B_x": _B_in["x"],
        "B_wqkv": _B_in["wqkv"],
        "B_wo": _B_in["wo"],
    }

def reference(A_x, A_c_kv, A_w_q, A_w_uk, A_w_uv, A_w_o, B_x, B_wqkv, B_wo):
    def _A_ref(x, c_kv, w_q, w_uk, w_uv, w_o):
        B, Sq, M = x.shape[0], x.shape[1], x.shape[2]
        Sk = c_kv.shape[1]
        H, D = w_q.shape[1], w_q.shape[2]
        q = torch.einsum("bqm,mhd->bhqd", x, w_q)
        k = torch.einsum("bkc,chd->bhkd", c_kv, w_uk)
        v = torch.einsum("bkc,chd->bhkd", c_kv, w_uv)
        scores = torch.einsum("bhqd,bhkd->bhqk", q, k) * (D ** -0.5)
        off = Sk - Sq
        qi = torch.arange(Sq)[:, None]
        kj = torch.arange(Sk)[None, :]
        cmask = kj <= (qi + off)
        scores = torch.where(cmask[None, None], scores, -1e9)
        p = _softmax(scores, axis=-1)
        ctx = torch.einsum("bhqk,bhkd->bhqd", p, v)
        return torch.einsum("bhqd,hdm->bqm", ctx, w_o)

    def _B_ref(x, wqkv, wo):
        B, S, D = x.shape
        H = 32; Dh = D // H
        W, dil = 8, 2
        qkv = (lambda x, *d: x.permute(*d))((x @ wqkv).reshape(B, S, 3, H, Dh), 2, 0, 3, 1, 4)
        q, k, v = qkv[0], qkv[1], qkv[2]
        scale = Dh ** -0.5
        pos = torch.arange(S)
        off = torch.arange(W) * dil
        idx = pos[:, None] - off[None, :]
        mask = idx >= 0
        idx_c = torch.where(mask, idx, 0).reshape(-1)
        kg = k[:, :, idx_c, :].reshape(B, H, S, W, Dh)
        vg = v[:, :, idx_c, :].reshape(B, H, S, W, Dh)
        logits = torch.einsum("bhsd,bhswd->bhsw", q, kg) * scale
        logits = torch.where(mask[None, None, :, :], logits, -1e9)
        attn = _softmax(logits, axis=-1)
        o = torch.einsum("bhsw,bhswd->bhsd", attn, vg)
        return (lambda x, *d: x.permute(*d))(o, 0, 2, 1, 3).reshape(B, S, D) @ wo

    a = _A_ref(A_x, A_c_kv, A_w_q, A_w_uk, A_w_uv, A_w_o)
    b = _B_ref(B_x, B_wqkv, B_wo)
    return torch.concatenate([a, b], axis=-1)
```

```asm
; @launch kernel=k1_proj_kernel grid=(256,1,1) block=(256,1,1) lds=163840
; @launch kernel=k2_attn_kernel grid=(256,1,1) block=(256,1,1) lds=163840
; @launch kernel=k3_oproj_kernel grid=(256,1,1) block=(256,1,1) lds=147456
.amdgcn_target "amdgcn-amd-amdhsa--gfx950"
.text
.globl k1_proj_kernel
.p2align 8
.type k1_proj_kernel,@function
k1_proj_kernel:
  s_cmp_ge_u32 s2, 256
  s_cbranch_scc1 Lk1_end
  s_load_dwordx16 s[32:47], s[0:1], 0
  s_load_dwordx2 s[48:49], s[0:1], 64
  s_load_dwordx2 s[50:51], s[0:1], 88
  v_lshrrev_b32 v24, 6, v0
  s_nop 0
  v_readfirstlane_b32 s20, v24
  v_and_b32 v0, 63, v0
  v_lshlrev_b32 v1, 4, v0
  s_lshr_b32 s21, s20, 1
  s_and_b32 s22, s20, 1
  s_lshl_b32 s29, s20, 12
  s_and_b32 s3, s2, 1
  s_lshl_b32 s3, s3, 2
  s_bfe_u32 s6, s2, 0x20003
  s_add_u32 s3, s3, s6
  s_lshl_b32 s52, s3, 8
  s_bfe_u32 s3, s2, 0x20001
  s_lshl_b32 s3, s3, 2
  s_bfe_u32 s7, s2, 0x20005
  s_add_u32 s3, s3, s7
  s_lshl_b32 s53, s3, 8
  s_cmp_lt_u32 s2, 128
  s_cselect_b32 s5, 11, 10
  s_lshl_b32 s3, s21, 7
  s_lshl_b32 s4, s22, 5
  s_add_u32 s3, s3, s4
  v_lshrrev_b32 v24, 3, v0
  v_add_u32 v24, s3, v24
  v_and_b32 v25, 7, v0
  v_add_u32 v26, 0, v24
  v_bfe_u32 v27, v26, 1, 3
  v_xor_b32 v27, v27, v25
  v_lshlrev_b32 v26, s5, v26
  v_lshl_add_u32 v26, v27, 4, v26
  v_subrev_u32 v2, 0, v26
  v_add_u32 v26, 8, v24
  v_bfe_u32 v27, v26, 1, 3
  v_xor_b32 v27, v27, v25
  v_lshlrev_b32 v26, s5, v26
  v_lshl_add_u32 v26, v27, 4, v26
  v_subrev_u32 v3, 1024, v26
  v_add_u32 v26, 16, v24
  v_bfe_u32 v27, v26, 1, 3
  v_xor_b32 v27, v27, v25
  v_lshlrev_b32 v26, s5, v26
  v_lshl_add_u32 v26, v27, 4, v26
  v_subrev_u32 v4, 2048, v26
  v_add_u32 v26, 24, v24
  v_bfe_u32 v27, v26, 1, 3
  v_xor_b32 v27, v27, v25
  v_lshlrev_b32 v26, s5, v26
  v_lshl_add_u32 v26, v27, 4, v26
  v_subrev_u32 v5, 3072, v26
  s_lshl_b32 s3, s20, 3
  v_lshrrev_b32 v24, 5, v0
  v_add_u32 v24, s3, v24
  v_and_b32 v25, 31, v0
  v_add_u32 v26, 0, v24
  v_and_b32 v27, 3, v26
  v_lshlrev_b32 v27, 1, v27
  v_and_or_b32 v27, v26, 8, v27
  v_xor_b32 v27, v27, v25
  v_lshlrev_b32 v26, 13, v26
  v_lshl_add_u32 v26, v27, 4, v26
  v_subrev_u32 v6, 0, v26
  v_add_u32 v26, 2, v24
  v_and_b32 v27, 3, v26
  v_lshlrev_b32 v27, 1, v27
  v_and_or_b32 v27, v26, 8, v27
  v_xor_b32 v27, v27, v25
  v_lshlrev_b32 v26, 13, v26
  v_lshl_add_u32 v26, v27, 4, v26
  v_subrev_u32 v7, 1024, v26
  v_add_u32 v26, 4, v24
  v_and_b32 v27, 3, v26
  v_lshlrev_b32 v27, 1, v27
  v_and_or_b32 v27, v26, 8, v27
  v_xor_b32 v27, v27, v25
  v_lshlrev_b32 v26, 13, v26
  v_lshl_add_u32 v26, v27, 4, v26
  v_subrev_u32 v8, 2048, v26
  v_add_u32 v26, 6, v24
  v_and_b32 v27, 3, v26
  v_lshlrev_b32 v27, 1, v27
  v_and_or_b32 v27, v26, 8, v27
  v_xor_b32 v27, v27, v25
  v_lshlrev_b32 v26, 13, v26
  v_lshl_add_u32 v26, v27, 4, v26
  v_subrev_u32 v9, 3072, v26
  s_lshl_b32 s23, s52, s5
  s_lshl_b32 s31, 64, s5
  s_mov_b32 s26, s23
  s_lshl_b32 s24, s53, 1
  s_mov_b32 s28, s24
  s_add_u32 s25, s23, 1024
  s_add_u32 s27, s24, 4194304
  s_cmp_lt_u32 s2, 128
  s_cselect_b32 s25, -1, s25
  s_cselect_b32 s27, -1, s27
  s_waitcnt lgkmcnt(0)
  s_cmp_lt_u32 s2, 128
  s_cselect_b64 s[8:9], s[32:33], s[34:35]
  s_mov_b32 s10, 2097152
  s_cselect_b32 s10, 4194304, s10
  s_mov_b32 s11, 0x00020000
  s_cselect_b64 s[12:13], s[36:37], s[38:39]
  s_mov_b32 s14, 4194304
  s_cselect_b32 s14, 8388608, s14
  s_mov_b32 s15, 0x00020000
  s_mov_b64 s[64:65], s[40:41]
  s_add_u32 m0, s29, 65536
  s_nop 0
  buffer_load_dwordx4 v6, s[12:15], s24 offen offset:0 lds
  buffer_load_dwordx4 v7, s[12:15], s24 offen offset:1024 lds
  buffer_load_dwordx4 v8, s[12:15], s24 offen offset:2048 lds
  buffer_load_dwordx4 v9, s[12:15], s24 offen offset:3072 lds
  s_add_u32 s24, s24, 262144
  s_add_u32 m0, s29, 0
  s_nop 0
  buffer_load_dwordx4 v2, s[8:11], s23 offen offset:0 lds
  buffer_load_dwordx4 v3, s[8:11], s23 offen offset:1024 lds
  buffer_load_dwordx4 v4, s[8:11], s23 offen offset:2048 lds
  buffer_load_dwordx4 v5, s[8:11], s23 offen offset:3072 lds
  s_add_u32 m0, s29, 81920
  s_nop 0
  buffer_load_dwordx4 v6, s[12:15], s24 offen offset:0 lds
  buffer_load_dwordx4 v7, s[12:15], s24 offen offset:1024 lds
  buffer_load_dwordx4 v8, s[12:15], s24 offen offset:2048 lds
  buffer_load_dwordx4 v9, s[12:15], s24 offen offset:3072 lds
  s_add_u32 s24, s24, 262144
  s_cmp_eq_u32 s24, s27
  s_cselect_b32 s24, s28, s24
  s_cselect_b64 s[12:13], s[64:65], s[12:13]
  s_add_u32 m0, s29, 98304
  s_nop 0
  buffer_load_dwordx4 v6, s[12:15], s24 offen offset:0 lds
  buffer_load_dwordx4 v7, s[12:15], s24 offen offset:1024 lds
  buffer_load_dwordx4 v8, s[12:15], s24 offen offset:2048 lds
  buffer_load_dwordx4 v9, s[12:15], s24 offen offset:3072 lds
  s_add_u32 s24, s24, 262144
  s_add_u32 m0, s29, 16384
  s_add_u32 s3, s23, s31
  s_nop 0
  buffer_load_dwordx4 v2, s[8:11], s3 offen offset:0 lds
  buffer_load_dwordx4 v3, s[8:11], s3 offen offset:1024 lds
  buffer_load_dwordx4 v4, s[8:11], s3 offen offset:2048 lds
  buffer_load_dwordx4 v5, s[8:11], s3 offen offset:3072 lds
  s_add_u32 s23, s23, 128
  s_cmp_eq_u32 s23, s25
  s_cselect_b32 s23, s26, s23
  s_add_u32 m0, s29, 114688
  s_nop 0
  buffer_load_dwordx4 v6, s[12:15], s24 offen offset:0 lds
  buffer_load_dwordx4 v7, s[12:15], s24 offen offset:1024 lds
  buffer_load_dwordx4 v8, s[12:15], s24 offen offset:2048 lds
  buffer_load_dwordx4 v9, s[12:15], s24 offen offset:3072 lds
  s_add_u32 s24, s24, 262144
  s_cmp_eq_u32 s24, s27
  s_cselect_b32 s24, s28, s24
  s_cselect_b64 s[12:13], s[64:65], s[12:13]
  s_mov_b32 s63, 0x00020000
  s_cmp_eq_u32 s20, 1
  s_cbranch_scc1 Lk1_pfo
  s_cmp_eq_u32 s20, 0
  s_cbranch_scc0 Lk1_pfw
  s_bfe_u32 s4, s2, 0x20001
  s_lshl_b32 s3, s7, 2
  s_add_u32 s3, s3, s4
  s_lshl_b32 s3, s3, 4
  v_and_b32 v24, 15, v0
  v_add_u32 v24, s3, v24
  v_lshlrev_b32 v20, s5, v24
  s_mov_b64 s[60:61], s[8:9]
  s_mov_b64 s[58:59], s[8:9]
  s_mov_b32 s62, s10
  s_mov_b32 s7, s10
  s_add_u32 s54, s26, 768
  s_mov_b32 s55, 128
  s_mov_b32 s56, s25
  s_mov_b32 s57, s26
  s_branch Lk1_pfc
Lk1_pfw:
  s_lshl_b32 s3, s6, 4
  s_and_b32 s4, s2, 1
  s_lshl_b32 s4, s4, 3
  s_add_u32 s3, s3, s4
  s_lshl_b32 s4, s22, 2
  s_add_u32 s3, s3, s4
  v_bfe_u32 v24, v0, 2, 2
  v_add_u32 v24, s3, v24
  v_and_b32 v25, 3, v0
  v_lshlrev_b32 v25, 7, v25
  v_lshl_add_u32 v20, v24, 13, v25
  s_mov_b64 s[60:61], s[12:13]
  s_mov_b64 s[58:59], s[40:41]
  s_mov_b32 s62, s14
  s_mov_b32 s7, s14
  s_add_u32 s54, s28, 3670016
  s_mov_b32 s55, 524288
  s_mov_b32 s56, s27
  s_mov_b32 s57, s28
Lk1_pfc:
  s_mov_b32 s62, 0
  s_mov_b32 s7, 0
  v_lshrrev_b32 v24, 4, v0
  v_mul_lo_u32 v24, v24, s55
  v_add_u32 v24, v24, v20
  s_mul_i32 s3, s55, 4
  s_sub_u32 s3, s54, s3
  buffer_load_dword v21, v24, s[60:63], s3 offen
  s_branch Lk1_pfd
Lk1_pfo:
  v_lshlrev_b32 v20, 7, v0
  s_and_b32 s3, s2, 127
  s_lshl_b32 s54, s3, 13
  s_mov_b32 s57, s54
  s_mov_b32 s55, 1048576
  s_cmp_lt_u32 s2, 128
  s_cselect_b64 s[60:61], s[46:47], s[42:43]
  s_cselect_b64 s[58:59], s[44:45], s[48:49]
  s_mov_b32 s4, 8388608
  s_cselect_b32 s4, 6291456, s4
  s_add_u32 s56, s54, s4
  s_mov_b32 s62, s4
  s_cmp_lt_u32 s2, 128
  s_mov_b32 s7, 2097152
  s_cselect_b32 s7, 4194304, s7
  buffer_load_dword v21, v20, s[60:63], s54 offen
  s_add_u32 s54, s54, s55
  s_cmp_eq_u32 s54, s56
  s_cselect_b32 s54, s57, s54
  s_cselect_b64 s[60:61], s[58:59], s[60:61]
  s_cselect_b32 s62, s7, s62
Lk1_pfd:
  s_add_u32 m0, s29, 32768
  s_nop 0
  buffer_load_dwordx4 v2, s[8:11], s23 offen offset:0 lds
  buffer_load_dwordx4 v3, s[8:11], s23 offen offset:1024 lds
  buffer_load_dwordx4 v4, s[8:11], s23 offen offset:2048 lds
  buffer_load_dwordx4 v5, s[8:11], s23 offen offset:3072 lds
  s_lshl_b32 s4, s21, 13
  v_and_b32 v24, 15, v0
  v_lshlrev_b32 v24, 7, v24
  v_add_u32 v24, s4, v24
  v_bfe_u32 v25, v0, 1, 3
  v_lshrrev_b32 v26, 4, v0
  v_xor_b32 v25, v25, v26
  v_lshl_add_u32 v10, v25, 4, v24
  v_xor_b32 v11, 64, v10
  v_bfe_u32 v24, v0, 2, 2
  v_lshl_add_u32 v29, v26, 3, v24
  v_lshlrev_b32 v25, 9, v29
  v_and_b32 v27, 1, v0
  v_lshl_add_u32 v25, v27, 3, v25
  v_add_u32 v25, 65536, v25
  v_lshlrev_b32 v24, 1, v24
  v_and_or_b32 v24, v29, 8, v24
  v_bfe_u32 v26, v0, 1, 1
  s_lshl_b32 s4, s22, 4
  s_add_u32 s3, s4, 0
  v_add_u32 v27, s3, v26
  v_xor_b32 v27, v27, v24
  v_lshl_add_u32 v12, v27, 4, v25
  s_add_u32 s3, s4, 2
  v_add_u32 v27, s3, v26
  v_xor_b32 v27, v27, v24
  v_lshl_add_u32 v13, v27, 4, v25
  s_add_u32 s3, s4, 4
  v_add_u32 v27, s3, v26
  v_xor_b32 v27, v27, v24
  v_lshl_add_u32 v14, v27, 4, v25
  s_add_u32 s3, s4, 6
  v_add_u32 v27, s3, v26
  v_xor_b32 v27, v27, v24
  v_lshl_add_u32 v15, v27, 4, v25
  s_add_u32 s3, s4, 8
  v_add_u32 v27, s3, v26
  v_xor_b32 v27, v27, v24
  v_lshl_add_u32 v16, v27, 4, v25
  s_add_u32 s3, s4, 10
  v_add_u32 v27, s3, v26
  v_xor_b32 v27, v27, v24
  v_lshl_add_u32 v17, v27, 4, v25
  s_add_u32 s3, s4, 12
  v_add_u32 v27, s3, v26
  v_xor_b32 v27, v27, v24
  v_lshl_add_u32 v18, v27, 4, v25
  s_add_u32 s3, s4, 14
  v_add_u32 v27, s3, v26
  v_xor_b32 v27, v27, v24
  v_lshl_add_u32 v19, v27, 4, v25
  s_waitcnt vmcnt(17)
  s_barrier
  ds_read_b64_tr_b16 a[32:33], v12 offset:0
  ds_read_b64_tr_b16 a[34:35], v12 offset:2048
  ds_read_b64_tr_b16 a[40:41], v13 offset:0
  ds_read_b64_tr_b16 a[42:43], v13 offset:2048
  ds_read_b64_tr_b16 a[48:49], v14 offset:0
  ds_read_b64_tr_b16 a[50:51], v14 offset:2048
  ds_read_b64_tr_b16 a[56:57], v15 offset:0
  ds_read_b64_tr_b16 a[58:59], v15 offset:2048
  ds_read_b64_tr_b16 a[64:65], v16 offset:0
  ds_read_b64_tr_b16 a[66:67], v16 offset:2048
  ds_read_b64_tr_b16 a[72:73], v17 offset:0
  ds_read_b64_tr_b16 a[74:75], v17 offset:2048
  ds_read_b64_tr_b16 a[80:81], v18 offset:0
  ds_read_b64_tr_b16 a[82:83], v18 offset:2048
  ds_read_b64_tr_b16 a[88:89], v19 offset:0
  ds_read_b64_tr_b16 a[90:91], v19 offset:2048
  ds_read_b64_tr_b16 a[36:37], v12 offset:16384
  ds_read_b64_tr_b16 a[38:39], v12 offset:18432
  ds_read_b64_tr_b16 a[44:45], v13 offset:16384
  ds_read_b64_tr_b16 a[46:47], v13 offset:18432
  ds_read_b64_tr_b16 a[52:53], v14 offset:16384
  ds_read_b64_tr_b16 a[54:55], v14 offset:18432
  ds_read_b64_tr_b16 a[60:61], v15 offset:16384
  ds_read_b64_tr_b16 a[62:63], v15 offset:18432
  ds_read_b64_tr_b16 a[68:69], v16 offset:16384
  ds_read_b64_tr_b16 a[70:71], v16 offset:18432
  ds_read_b64_tr_b16 a[76:77], v17 offset:16384
  ds_read_b64_tr_b16 a[78:79], v17 offset:18432
  ds_read_b64_tr_b16 a[84:85], v18 offset:16384
  ds_read_b64_tr_b16 a[86:87], v18 offset:18432
  ds_read_b64_tr_b16 a[92:93], v19 offset:16384
  ds_read_b64_tr_b16 a[94:95], v19 offset:18432
  ds_read_b128 a[160:163], v10 offset:0
  ds_read_b128 a[164:167], v11 offset:0
  ds_read_b128 a[168:171], v10 offset:2048
  ds_read_b128 a[172:175], v11 offset:2048
  s_waitcnt vmcnt(13) lgkmcnt(0)
  s_barrier
  s_add_u32 m0, s29, 65536
  s_nop 0
  buffer_load_dwordx4 v6, s[12:15], s24 offen offset:0 lds
  buffer_load_dwordx4 v7, s[12:15], s24 offen offset:1024 lds
  buffer_load_dwordx4 v8, s[12:15], s24 offen offset:2048 lds
  buffer_load_dwordx4 v9, s[12:15], s24 offen offset:3072 lds
  s_add_u32 s24, s24, 262144
  s_add_u32 m0, s29, 49152
  s_add_u32 s3, s23, s31
  s_nop 0
  buffer_load_dwordx4 v2, s[8:11], s3 offen offset:0 lds
  buffer_load_dwordx4 v3, s[8:11], s3 offen offset:1024 lds
  buffer_load_dwordx4 v4, s[8:11], s3 offen offset:2048 lds
  buffer_load_dwordx4 v5, s[8:11], s3 offen offset:3072 lds
  s_cmp_lt_u32 s2, 128
  s_cbranch_scc0 Lk1_kv
  v_mfma_f32_16x16x32_bf16 v[32:35], a[32:35], a[160:163], 0
  s_add_u32 s23, s23, 128
  s_cmp_eq_u32 s23, s25
  s_cselect_b32 s23, s26, s23
  v_mfma_f32_16x16x32_bf16 v[32:35], a[36:39], a[164:167], v[32:35]
  ds_read_b128 a[176:179], v10 offset:4096
  ds_read_b128 a[180:183], v11 offset:4096
  v_mfma_f32_16x16x32_bf16 v[36:39], a[44:47], a[164:167], 0
  v_mfma_f32_16x16x32_bf16 v[36:39], a[40:43], a[160:163], v[36:39]
  ds_read_b64_tr_b16 a[96:97], v12 offset:32768
  ds_read_b64_tr_b16 a[98:99], v12 offset:34816
  v_mfma_f32_16x16x32_bf16 v[40:43], a[48:51], a[160:163], 0
  v_mfma_f32_16x16x32_bf16 v[40:43], a[52:55], a[164:167], v[40:43]
  v_mfma_f32_16x16x32_bf16 v[44:47], a[60:63], a[164:167], 0
  s_add_u32 m0, s29, 81920
  s_nop 0
  buffer_load_dwordx4 v6, s[12:15], s24 offen offset:0 lds
  v_mfma_f32_16x16x32_bf16 v[44:47], a[56:59], a[160:163], v[44:47]
  ds_read_b64_tr_b16 a[104:105], v13 offset:32768
  ds_read_b64_tr_b16 a[106:107], v13 offset:34816
  v_mfma_f32_16x16x32_bf16 v[48:51], a[64:67], a[160:163], 0
  v_mfma_f32_16x16x32_bf16 v[48:51], a[68:71], a[164:167], v[48:51]
  v_mfma_f32_16x16x32_bf16 v[52:55], a[76:79], a[164:167], 0
  v_mfma_f32_16x16x32_bf16 v[52:55], a[72:75], a[160:163], v[52:55]
  ds_read_b64_tr_b16 a[112:113], v14 offset:32768
  ds_read_b64_tr_b16 a[114:115], v14 offset:34816
  v_mfma_f32_16x16x32_bf16 v[56:59], a[80:83], a[160:163], 0
  v_mfma_f32_16x16x32_bf16 v[56:59], a[84:87], a[164:167], v[56:59]
  buffer_load_dwordx4 v7, s[12:15], s24 offen offset:1024 lds
  v_mfma_f32_16x16x32_bf16 v[60:63], a[92:95], a[164:167], 0
  v_mfma_f32_16x16x32_bf16 v[60:63], a[88:91], a[160:163], v[60:63]
  ds_read_b64_tr_b16 a[120:121], v15 offset:32768
  ds_read_b64_tr_b16 a[122:123], v15 offset:34816
  v_mfma_f32_16x16x32_bf16 v[64:67], a[32:35], a[168:171], 0
  v_mfma_f32_16x16x32_bf16 v[64:67], a[36:39], a[172:175], v[64:67]
  ds_read_b128 a[184:187], v10 offset:6144
  ds_read_b128 a[188:191], v11 offset:6144
  v_mfma_f32_16x16x32_bf16 v[68:71], a[44:47], a[172:175], 0
  v_mfma_f32_16x16x32_bf16 v[68:71], a[40:43], a[168:171], v[68:71]
  ds_read_b64_tr_b16 a[128:129], v16 offset:32768
  ds_read_b64_tr_b16 a[130:131], v16 offset:34816
  v_mfma_f32_16x16x32_bf16 v[72:75], a[48:51], a[168:171], 0
  buffer_load_dwordx4 v8, s[12:15], s24 offen offset:2048 lds
  v_mfma_f32_16x16x32_bf16 v[72:75], a[52:55], a[172:175], v[72:75]
  v_mfma_f32_16x16x32_bf16 v[76:79], a[60:63], a[172:175], 0
  v_mfma_f32_16x16x32_bf16 v[76:79], a[56:59], a[168:171], v[76:79]
  ds_read_b64_tr_b16 a[136:137], v17 offset:32768
  ds_read_b64_tr_b16 a[138:139], v17 offset:34816
  v_mfma_f32_16x16x32_bf16 v[80:83], a[64:67], a[168:171], 0
  v_mfma_f32_16x16x32_bf16 v[80:83], a[68:71], a[172:175], v[80:83]
  v_mfma_f32_16x16x32_bf16 v[84:87], a[76:79], a[172:175], 0
  buffer_load_dwordx4 v9, s[12:15], s24 offen offset:3072 lds
  v_mfma_f32_16x16x32_bf16 v[84:87], a[72:75], a[168:171], v[84:87]
  ds_read_b64_tr_b16 a[144:145], v18 offset:32768
  ds_read_b64_tr_b16 a[146:147], v18 offset:34816
  v_mfma_f32_16x16x32_bf16 v[88:91], a[80:83], a[168:171], 0
  v_mfma_f32_16x16x32_bf16 v[88:91], a[84:87], a[172:175], v[88:91]
  v_mfma_f32_16x16x32_bf16 v[92:95], a[92:95], a[172:175], 0
  v_mfma_f32_16x16x32_bf16 v[92:95], a[88:91], a[168:171], v[92:95]
  s_waitcnt lgkmcnt(15)
  ds_read_b64_tr_b16 a[152:153], v19 offset:32768
  ds_read_b64_tr_b16 a[154:155], v19 offset:34816
  v_mfma_f32_16x16x32_bf16 v[96:99], a[32:35], a[176:179], 0
  s_add_u32 s24, s24, 262144
  s_cmp_eq_u32 s24, s27
  s_cselect_b32 s24, s28, s24
  s_cselect_b64 s[12:13], s[64:65], s[12:13]
  v_mfma_f32_16x16x32_bf16 v[96:99], a[36:39], a[180:183], v[96:99]
  v_mfma_f32_16x16x32_bf16 v[100:103], a[44:47], a[180:183], 0
  v_mfma_f32_16x16x32_bf16 v[100:103], a[40:43], a[176:179], v[100:103]
  v_mfma_f32_16x16x32_bf16 v[104:107], a[48:51], a[176:179], 0
  v_mfma_f32_16x16x32_bf16 v[104:107], a[52:55], a[180:183], v[104:107]
  v_mfma_f32_16x16x32_bf16 v[108:111], a[60:63], a[180:183], 0
  v_mfma_f32_16x16x32_bf16 v[108:111], a[56:59], a[176:179], v[108:111]
  s_waitcnt vmcnt(17) lgkmcnt(0)
  s_barrier
  ds_read_b128 a[160:163], v10 offset:16384
  ds_read_b128 a[164:167], v11 offset:16384
  v_mfma_f32_16x16x32_bf16 v[112:115], a[64:67], a[176:179], 0
  s_add_u32 m0, s29, 0
  s_nop 0
  buffer_load_dwordx4 v2, s[8:11], s23 offen offset:0 lds
  v_mfma_f32_16x16x32_bf16 v[112:115], a[68:71], a[180:183], v[112:115]
  v_mfma_f32_16x16x32_bf16 v[116:119], a[76:79], a[180:183], 0
  v_mfma_f32_16x16x32_bf16 v[116:119], a[72:75], a[176:179], v[116:119]
  ds_read_b64_tr_b16 a[100:101], v12 offset:49152
  ds_read_b64_tr_b16 a[102:103], v12 offset:51200
  v_mfma_f32_16x16x32_bf16 v[120:123], a[80:83], a[176:179], 0
  v_mfma_f32_16x16x32_bf16 v[120:123], a[84:87], a[180:183], v[120:123]
  buffer_load_dwordx4 v3, s[8:11], s23 offen offset:1024 lds
  v_mfma_f32_16x16x32_bf16 v[124:127], a[92:95], a[180:183], 0
  v_mfma_f32_16x16x32_bf16 v[124:127], a[88:91], a[176:179], v[124:127]
  v_mfma_f32_16x16x32_bf16 v[128:131], a[32:35], a[184:187], 0
  v_mfma_f32_16x16x32_bf16 v[128:131], a[36:39], a[188:191], v[128:131]
  ds_read_b128 a[168:171], v10 offset:18432
  ds_read_b128 a[172:175], v11 offset:18432
  ds_read_b64_tr_b16 a[108:109], v13 offset:49152
  ds_read_b64_tr_b16 a[110:111], v13 offset:51200
  v_mfma_f32_16x16x32_bf16 v[132:135], a[44:47], a[188:191], 0
  v_mfma_f32_16x16x32_bf16 v[132:135], a[40:43], a[184:187], v[132:135]
  buffer_load_dwordx4 v4, s[8:11], s23 offen offset:2048 lds
  v_mfma_f32_16x16x32_bf16 v[136:139], a[48:51], a[184:187], 0
  v_mfma_f32_16x16x32_bf16 v[136:139], a[52:55], a[188:191], v[136:139]
  v_mfma_f32_16x16x32_bf16 v[140:143], a[60:63], a[188:191], 0
  v_mfma_f32_16x16x32_bf16 v[140:143], a[56:59], a[184:187], v[140:143]
  ds_read_b64_tr_b16 a[116:117], v14 offset:49152
  ds_read_b64_tr_b16 a[118:119], v14 offset:51200
  v_mfma_f32_16x16x32_bf16 v[144:147], a[64:67], a[184:187], 0
  v_mfma_f32_16x16x32_bf16 v[144:147], a[68:71], a[188:191], v[144:147]
  buffer_load_dwordx4 v5, s[8:11], s23 offen offset:3072 lds
  v_mfma_f32_16x16x32_bf16 v[148:151], a[76:79], a[188:191], 0
  v_mfma_f32_16x16x32_bf16 v[148:151], a[72:75], a[184:187], v[148:151]
  v_mfma_f32_16x16x32_bf16 v[152:155], a[80:83], a[184:187], 0
  v_mfma_f32_16x16x32_bf16 v[152:155], a[84:87], a[188:191], v[152:155]
  ds_read_b64_tr_b16 a[124:125], v15 offset:49152
  ds_read_b64_tr_b16 a[126:127], v15 offset:51200
  v_mfma_f32_16x16x32_bf16 v[156:159], a[92:95], a[188:191], 0
  s_add_u32 m0, s29, 98304
  s_nop 0
  buffer_load_dwordx4 v6, s[12:15], s24 offen offset:0 lds
  v_mfma_f32_16x16x32_bf16 v[156:159], a[88:91], a[184:187], v[156:159]
  s_waitcnt lgkmcnt(10)
  v_mfma_f32_16x16x32_bf16 v[160:163], a[32:35], a[160:163], 0
  v_mfma_f32_16x16x32_bf16 v[160:163], a[36:39], a[164:167], v[160:163]
  ds_read_b128 a[176:179], v10 offset:20480
  ds_read_b128 a[180:183], v11 offset:20480
  v_mfma_f32_16x16x32_bf16 v[164:167], a[44:47], a[164:167], 0
  v_mfma_f32_16x16x32_bf16 v[164:167], a[40:43], a[160:163], v[164:167]
  ds_read_b64_tr_b16 a[132:133], v16 offset:49152
  ds_read_b64_tr_b16 a[134:135], v16 offset:51200
  v_mfma_f32_16x16x32_bf16 v[168:171], a[48:51], a[160:163], 0
  v_mfma_f32_16x16x32_bf16 v[168:171], a[52:55], a[164:167], v[168:171]
  buffer_load_dwordx4 v7, s[12:15], s24 offen offset:1024 lds
  v_mfma_f32_16x16x32_bf16 v[172:175], a[60:63], a[164:167], 0
  v_mfma_f32_16x16x32_bf16 v[172:175], a[56:59], a[160:163], v[172:175]
  v_mfma_f32_16x16x32_bf16 v[176:179], a[64:67], a[160:163], 0
  v_mfma_f32_16x16x32_bf16 v[176:179], a[68:71], a[164:167], v[176:179]
  ds_read_b64_tr_b16 a[140:141], v17 offset:49152
  ds_read_b64_tr_b16 a[142:143], v17 offset:51200
  v_mfma_f32_16x16x32_bf16 v[180:183], a[76:79], a[164:167], 0
  v_mfma_f32_16x16x32_bf16 v[180:183], a[72:75], a[160:163], v[180:183]
  buffer_load_dwordx4 v8, s[12:15], s24 offen offset:2048 lds
  v_mfma_f32_16x16x32_bf16 v[184:187], a[80:83], a[160:163], 0
  v_mfma_f32_16x16x32_bf16 v[184:187], a[84:87], a[164:167], v[184:187]
  v_mfma_f32_16x16x32_bf16 v[188:191], a[92:95], a[164:167], 0
  v_mfma_f32_16x16x32_bf16 v[188:191], a[88:91], a[160:163], v[188:191]
  s_waitcnt lgkmcnt(12)
  ds_read_b64_tr_b16 a[148:149], v18 offset:49152
  ds_read_b64_tr_b16 a[150:151], v18 offset:51200
  v_mfma_f32_16x16x32_bf16 v[192:195], a[32:35], a[168:171], 0
  buffer_load_dwordx4 v9, s[12:15], s24 offen offset:3072 lds
  v_mfma_f32_16x16x32_bf16 v[192:195], a[36:39], a[172:175], v[192:195]
  ds_read_b128 a[184:187], v10 offset:22528
  ds_read_b128 a[188:191], v11 offset:22528
  v_mfma_f32_16x16x32_bf16 v[196:199], a[44:47], a[172:175], 0
  v_mfma_f32_16x16x32_bf16 v[196:199], a[40:43], a[168:171], v[196:199]
  v_mfma_f32_16x16x32_bf16 v[200:203], a[48:51], a[168:171], 0
  v_mfma_f32_16x16x32_bf16 v[200:203], a[52:55], a[172:175], v[200:203]
  ds_read_b64_tr_b16 a[156:157], v19 offset:49152
  ds_read_b64_tr_b16 a[158:159], v19 offset:51200
  v_mfma_f32_16x16x32_bf16 v[204:207], a[60:63], a[172:175], 0
  s_add_u32 s24, s24, 262144
  v_mfma_f32_16x16x32_bf16 v[204:207], a[56:59], a[168:171], v[204:207]
  v_mfma_f32_16x16x32_bf16 v[208:211], a[64:67], a[168:171], 0
  v_mfma_f32_16x16x32_bf16 v[208:211], a[68:71], a[172:175], v[208:211]
  v_mfma_f32_16x16x32_bf16 v[212:215], a[76:79], a[172:175], 0
  v_mfma_f32_16x16x32_bf16 v[212:215], a[72:75], a[168:171], v[212:215]
  buffer_load_dword v21, v20, s[60:63], s54 offen
  s_add_u32 s54, s54, s55
  v_mfma_f32_16x16x32_bf16 v[216:219], a[80:83], a[168:171], 0
  v_mfma_f32_16x16x32_bf16 v[216:219], a[84:87], a[172:175], v[216:219]
  v_mfma_f32_16x16x32_bf16 v[220:223], a[92:95], a[172:175], 0
  v_mfma_f32_16x16x32_bf16 v[220:223], a[88:91], a[168:171], v[220:223]
  s_waitcnt lgkmcnt(10)
  v_mfma_f32_16x16x32_bf16 v[224:227], a[32:35], a[176:179], 0
  s_cmp_eq_u32 s54, s56
  s_cselect_b32 s54, s57, s54
  s_cselect_b64 s[60:61], s[58:59], s[60:61]
  s_cselect_b32 s62, s7, s62
  v_mfma_f32_16x16x32_bf16 v[224:227], a[36:39], a[180:183], v[224:227]
  v_mfma_f32_16x16x32_bf16 v[228:231], a[44:47], a[180:183], 0
  v_mfma_f32_16x16x32_bf16 v[228:231], a[40:43], a[176:179], v[228:231]
  v_mfma_f32_16x16x32_bf16 v[232:235], a[48:51], a[176:179], 0
  v_mfma_f32_16x16x32_bf16 v[232:235], a[52:55], a[180:183], v[232:235]
  v_mfma_f32_16x16x32_bf16 v[236:239], a[60:63], a[180:183], 0
  v_mfma_f32_16x16x32_bf16 v[236:239], a[56:59], a[176:179], v[236:239]
  s_waitcnt vmcnt(17) lgkmcnt(0)
  s_barrier
  ds_read_b128 a[160:163], v10 offset:32768
  ds_read_b128 a[164:167], v11 offset:32768
  v_mfma_f32_16x16x32_bf16 v[240:243], a[64:67], a[176:179], 0
  s_add_u32 m0, s29, 16384
  s_add_u32 s3, s23, s31
  buffer_load_dwordx4 v2, s[8:11], s3 offen offset:0 lds
  v_mfma_f32_16x16x32_bf16 v[240:243], a[68:71], a[180:183], v[240:243]
  v_mfma_f32_16x16x32_bf16 v[244:247], a[76:79], a[180:183], 0
  v_mfma_f32_16x16x32_bf16 v[244:247], a[72:75], a[176:179], v[244:247]
  v_mfma_f32_16x16x32_bf16 v[248:251], a[80:83], a[176:179], 0
  v_mfma_f32_16x16x32_bf16 v[248:251], a[84:87], a[180:183], v[248:251]
  buffer_load_dwordx4 v3, s[8:11], s3 offen offset:1024 lds
  v_mfma_f32_16x16x32_bf16 v[252:255], a[92:95], a[180:183], 0
  v_mfma_f32_16x16x32_bf16 v[252:255], a[88:91], a[176:179], v[252:255]
  v_mfma_f32_16x16x32_bf16 a[0:3], a[32:35], a[184:187], 0
  v_mfma_f32_16x16x32_bf16 a[0:3], a[36:39], a[188:191], a[0:3]
  ds_read_b128 a[168:171], v10 offset:34816
  ds_read_b128 a[172:175], v11 offset:34816
  v_mfma_f32_16x16x32_bf16 a[4:7], a[44:47], a[188:191], 0
  v_mfma_f32_16x16x32_bf16 a[4:7], a[40:43], a[184:187], a[4:7]
  v_mfma_f32_16x16x32_bf16 a[8:11], a[48:51], a[184:187], 0
  buffer_load_dwordx4 v4, s[8:11], s3 offen offset:2048 lds
  v_mfma_f32_16x16x32_bf16 a[8:11], a[52:55], a[188:191], a[8:11]
  v_mfma_f32_16x16x32_bf16 a[12:15], a[60:63], a[188:191], 0
  v_mfma_f32_16x16x32_bf16 a[12:15], a[56:59], a[184:187], a[12:15]
  v_mfma_f32_16x16x32_bf16 a[16:19], a[64:67], a[184:187], 0
  v_mfma_f32_16x16x32_bf16 a[16:19], a[68:71], a[188:191], a[16:19]
  buffer_load_dwordx4 v5, s[8:11], s3 offen offset:3072 lds
  v_mfma_f32_16x16x32_bf16 a[20:23], a[76:79], a[188:191], 0
  v_mfma_f32_16x16x32_bf16 a[20:23], a[72:75], a[184:187], a[20:23]
  v_mfma_f32_16x16x32_bf16 a[24:27], a[80:83], a[184:187], 0
  v_mfma_f32_16x16x32_bf16 a[24:27], a[84:87], a[188:191], a[24:27]
  v_mfma_f32_16x16x32_bf16 a[28:31], a[92:95], a[188:191], 0
  v_mfma_f32_16x16x32_bf16 a[28:31], a[88:91], a[184:187], a[28:31]
  s_waitcnt lgkmcnt(2)
  v_mfma_f32_16x16x32_bf16 v[32:35], a[96:99], a[160:163], v[32:35]
  s_add_u32 s23, s23, 128
  s_cmp_eq_u32 s23, s25
  s_cselect_b32 s23, s26, s23
  v_mfma_f32_16x16x32_bf16 v[32:35], a[100:103], a[164:167], v[32:35]
  ds_read_b128 a[176:179], v10 offset:36864
  ds_read_b128 a[180:183], v11 offset:36864
  v_mfma_f32_16x16x32_bf16 v[36:39], a[108:111], a[164:167], v[36:39]
  v_mfma_f32_16x16x32_bf16 v[36:39], a[104:107], a[160:163], v[36:39]
  ds_read_b64_tr_b16 a[32:33], v12 offset:0
  ds_read_b64_tr_b16 a[34:35], v12 offset:2048
  v_mfma_f32_16x16x32_bf16 v[40:43], a[112:115], a[160:163], v[40:43]
  v_mfma_f32_16x16x32_bf16 v[40:43], a[116:119], a[164:167], v[40:43]
  v_mfma_f32_16x16x32_bf16 v[44:47], a[124:127], a[164:167], v[44:47]
  s_add_u32 m0, s29, 114688
  s_nop 0
  buffer_load_dwordx4 v6, s[12:15], s24 offen offset:0 lds
  v_mfma_f32_16x16x32_bf16 v[44:47], a[120:123], a[160:163], v[44:47]
  ds_read_b64_tr_b16 a[40:41], v13 offset:0
  ds_read_b64_tr_b16 a[42:43], v13 offset:2048
  v_mfma_f32_16x16x32_bf16 v[48:51], a[128:131], a[160:163], v[48:51]
  v_mfma_f32_16x16x32_bf16 v[48:51], a[132:135], a[164:167], v[48:51]
  v_mfma_f32_16x16x32_bf16 v[52:55], a[140:143], a[164:167], v[52:55]
  v_mfma_f32_16x16x32_bf16 v[52:55], a[136:139], a[160:163], v[52:55]
  ds_read_b64_tr_b16 a[48:49], v14 offset:0
  ds_read_b64_tr_b16 a[50:51], v14 offset:2048
  v_mfma_f32_16x16x32_bf16 v[56:59], a[144:147], a[160:163], v[56:59]
  v_mfma_f32_16x16x32_bf16 v[56:59], a[148:151], a[164:167], v[56:59]
  buffer_load_dwordx4 v7, s[12:15], s24 offen offset:1024 lds
  v_mfma_f32_16x16x32_bf16 v[60:63], a[156:159], a[164:167], v[60:63]
  v_mfma_f32_16x16x32_bf16 v[60:63], a[152:155], a[160:163], v[60:63]
  s_waitcnt lgkmcnt(8)
  ds_read_b64_tr_b16 a[56:57], v15 offset:0
  ds_read_b64_tr_b16 a[58:59], v15 offset:2048
  v_mfma_f32_16x16x32_bf16 v[64:67], a[96:99], a[168:171], v[64:67]
  v_mfma_f32_16x16x32_bf16 v[64:67], a[100:103], a[172:175], v[64:67]
  ds_read_b128 a[184:187], v10 offset:38912
  ds_read_b128 a[188:191], v11 offset:38912
  v_mfma_f32_16x16x32_bf16 v[68:71], a[108:111], a[172:175], v[68:71]
  v_mfma_f32_16x16x32_bf16 v[68:71], a[104:107], a[168:171], v[68:71]
  ds_read_b64_tr_b16 a[64:65], v16 offset:0
  ds_read_b64_tr_b16 a[66:67], v16 offset:2048
  v_mfma_f32_16x16x32_bf16 v[72:75], a[112:115], a[168:171], v[72:75]
  buffer_load_dwordx4 v8, s[12:15], s24 offen offset:2048 lds
  v_mfma_f32_16x16x32_bf16 v[72:75], a[116:119], a[172:175], v[72:75]
  v_mfma_f32_16x16x32_bf16 v[76:79], a[124:127], a[172:175], v[76:79]
  v_mfma_f32_16x16x32_bf16 v[76:79], a[120:123], a[168:171], v[76:79]
  ds_read_b64_tr_b16 a[72:73], v17 offset:0
  ds_read_b64_tr_b16 a[74:75], v17 offset:2048
  v_mfma_f32_16x16x32_bf16 v[80:83], a[128:131], a[168:171], v[80:83]
  v_mfma_f32_16x16x32_bf16 v[80:83], a[132:135], a[172:175], v[80:83]
  v_mfma_f32_16x16x32_bf16 v[84:87], a[140:143], a[172:175], v[84:87]
  buffer_load_dwordx4 v9, s[12:15], s24 offen offset:3072 lds
  v_mfma_f32_16x16x32_bf16 v[84:87], a[136:139], a[168:171], v[84:87]
  ds_read_b64_tr_b16 a[80:81], v18 offset:0
  ds_read_b64_tr_b16 a[82:83], v18 offset:2048
  v_mfma_f32_16x16x32_bf16 v[88:91], a[144:147], a[168:171], v[88:91]
  v_mfma_f32_16x16x32_bf16 v[88:91], a[148:151], a[172:175], v[88:91]
  v_mfma_f32_16x16x32_bf16 v[92:95], a[156:159], a[172:175], v[92:95]
  v_mfma_f32_16x16x32_bf16 v[92:95], a[152:155], a[168:171], v[92:95]
  s_waitcnt lgkmcnt(15)
  ds_read_b64_tr_b16 a[88:89], v19 offset:0
  ds_read_b64_tr_b16 a[90:91], v19 offset:2048
  v_mfma_f32_16x16x32_bf16 v[96:99], a[96:99], a[176:179], v[96:99]
  s_add_u32 s24, s24, 262144
  s_cmp_eq_u32 s24, s27
  s_cselect_b32 s24, s28, s24
  s_cselect_b64 s[12:13], s[64:65], s[12:13]
  v_mfma_f32_16x16x32_bf16 v[96:99], a[100:103], a[180:183], v[96:99]
  v_mfma_f32_16x16x32_bf16 v[100:103], a[108:111], a[180:183], v[100:103]
  v_mfma_f32_16x16x32_bf16 v[100:103], a[104:107], a[176:179], v[100:103]
  v_mfma_f32_16x16x32_bf16 v[104:107], a[112:115], a[176:179], v[104:107]
  v_mfma_f32_16x16x32_bf16 v[104:107], a[116:119], a[180:183], v[104:107]
  v_mfma_f32_16x16x32_bf16 v[108:111], a[124:127], a[180:183], v[108:111]
  v_mfma_f32_16x16x32_bf16 v[108:111], a[120:123], a[176:179], v[108:111]
  s_waitcnt vmcnt(17) lgkmcnt(0)
  s_barrier
  ds_read_b128 a[160:163], v10 offset:49152
  ds_read_b128 a[164:167], v11 offset:49152
  v_mfma_f32_16x16x32_bf16 v[112:115], a[128:131], a[176:179], v[112:115]
  s_add_u32 m0, s29, 32768
  s_nop 0
  buffer_load_dwordx4 v2, s[8:11], s23 offen offset:0 lds
  v_mfma_f32_16x16x32_bf16 v[112:115], a[132:135], a[180:183], v[112:115]
  v_mfma_f32_16x16x32_bf16 v[116:119], a[140:143], a[180:183], v[116:119]
  v_mfma_f32_16x16x32_bf16 v[116:119], a[136:139], a[176:179], v[116:119]
  ds_read_b64_tr_b16 a[36:37], v12 offset:16384
  ds_read_b64_tr_b16 a[38:39], v12 offset:18432
  v_mfma_f32_16x16x32_bf16 v[120:123], a[144:147], a[176:179], v[120:123]
  v_mfma_f32_16x16x32_bf16 v[120:123], a[148:151], a[180:183], v[120:123]
  buffer_load_dwordx4 v3, s[8:11], s23 offen offset:1024 lds
  v_mfma_f32_16x16x32_bf16 v[124:127], a[156:159], a[180:183], v[124:127]
  v_mfma_f32_16x16x32_bf16 v[124:127], a[152:155], a[176:179], v[124:127]
  v_mfma_f32_16x16x32_bf16 v[128:131], a[96:99], a[184:187], v[128:131]
  v_mfma_f32_16x16x32_bf16 v[128:131], a[100:103], a[188:191], v[128:131]
  ds_read_b128 a[168:171], v10 offset:51200
  ds_read_b128 a[172:175], v11 offset:51200
  ds_read_b64_tr_b16 a[44:45], v13 offset:16384
  ds_read_b64_tr_b16 a[46:47], v13 offset:18432
  v_mfma_f32_16x16x32_bf16 v[132:135], a[108:111], a[188:191], v[132:135]
  v_mfma_f32_16x16x32_bf16 v[132:135], a[104:107], a[184:187], v[132:135]
  buffer_load_dwordx4 v4, s[8:11], s23 offen offset:2048 lds
  v_mfma_f32_16x16x32_bf16 v[136:139], a[112:115], a[184:187], v[136:139]
  v_mfma_f32_16x16x32_bf16 v[136:139], a[116:119], a[188:191], v[136:139]
  v_mfma_f32_16x16x32_bf16 v[140:143], a[124:127], a[188:191], v[140:143]
  v_mfma_f32_16x16x32_bf16 v[140:143], a[120:123], a[184:187], v[140:143]
  ds_read_b64_tr_b16 a[52:53], v14 offset:16384
  ds_read_b64_tr_b16 a[54:55], v14 offset:18432
  v_mfma_f32_16x16x32_bf16 v[144:147], a[128:131], a[184:187], v[144:147]
  v_mfma_f32_16x16x32_bf16 v[144:147], a[132:135], a[188:191], v[144:147]
  buffer_load_dwordx4 v5, s[8:11], s23 offen offset:3072 lds
  v_mfma_f32_16x16x32_bf16 v[148:151], a[140:143], a[188:191], v[148:151]
  v_mfma_f32_16x16x32_bf16 v[148:151], a[136:139], a[184:187], v[148:151]
  v_mfma_f32_16x16x32_bf16 v[152:155], a[144:147], a[184:187], v[152:155]
  v_mfma_f32_16x16x32_bf16 v[152:155], a[148:151], a[188:191], v[152:155]
  ds_read_b64_tr_b16 a[60:61], v15 offset:16384
  ds_read_b64_tr_b16 a[62:63], v15 offset:18432
  v_mfma_f32_16x16x32_bf16 v[156:159], a[156:159], a[188:191], v[156:159]
  s_add_u32 m0, s29, 65536
  s_nop 0
  buffer_load_dwordx4 v6, s[12:15], s24 offen offset:0 lds
  v_mfma_f32_16x16x32_bf16 v[156:159], a[152:155], a[184:187], v[156:159]
  s_waitcnt lgkmcnt(10)
  v_mfma_f32_16x16x32_bf16 v[160:163], a[96:99], a[160:163], v[160:163]
  v_mfma_f32_16x16x32_bf16 v[160:163], a[100:103], a[164:167], v[160:163]
  ds_read_b128 a[176:179], v10 offset:53248
  ds_read_b128 a[180:183], v11 offset:53248
  v_mfma_f32_16x16x32_bf16 v[164:167], a[108:111], a[164:167], v[164:167]
  v_mfma_f32_16x16x32_bf16 v[164:167], a[104:107], a[160:163], v[164:167]
  ds_read_b64_tr_b16 a[68:69], v16 offset:16384
  ds_read_b64_tr_b16 a[70:71], v16 offset:18432
  v_mfma_f32_16x16x32_bf16 v[168:171], a[112:115], a[160:163], v[168:171]
  v_mfma_f32_16x16x32_bf16 v[168:171], a[116:119], a[164:167], v[168:171]
  buffer_load_dwordx4 v7, s[12:15], s24 offen offset:1024 lds
  v_mfma_f32_16x16x32_bf16 v[172:175], a[124:127], a[164:167], v[172:175]
  v_mfma_f32_16x16x32_bf16 v[172:175], a[120:123], a[160:163], v[172:175]
  v_mfma_f32_16x16x32_bf16 v[176:179], a[128:131], a[160:163], v[176:179]
  v_mfma_f32_16x16x32_bf16 v[176:179], a[132:135], a[164:167], v[176:179]
  ds_read_b64_tr_b16 a[76:77], v17 offset:16384
  ds_read_b64_tr_b16 a[78:79], v17 offset:18432
  v_mfma_f32_16x16x32_bf16 v[180:183], a[140:143], a[164:167], v[180:183]
  v_mfma_f32_16x16x32_bf16 v[180:183], a[136:139], a[160:163], v[180:183]
  buffer_load_dwordx4 v8, s[12:15], s24 offen offset:2048 lds
  v_mfma_f32_16x16x32_bf16 v[184:187], a[144:147], a[160:163], v[184:187]
  v_mfma_f32_16x16x32_bf16 v[184:187], a[148:151], a[164:167], v[184:187]
  v_mfma_f32_16x16x32_bf16 v[188:191], a[156:159], a[164:167], v[188:191]
  v_mfma_f32_16x16x32_bf16 v[188:191], a[152:155], a[160:163], v[188:191]
  s_waitcnt lgkmcnt(12)
  ds_read_b64_tr_b16 a[84:85], v18 offset:16384
  ds_read_b64_tr_b16 a[86:87], v18 offset:18432
  v_mfma_f32_16x16x32_bf16 v[192:195], a[96:99], a[168:171], v[192:195]
  buffer_load_dwordx4 v9, s[12:15], s24 offen offset:3072 lds
  v_mfma_f32_16x16x32_bf16 v[192:195], a[100:103], a[172:175], v[192:195]
  ds_read_b128 a[184:187], v10 offset:55296
  ds_read_b128 a[188:191], v11 offset:55296
  v_mfma_f32_16x16x32_bf16 v[196:199], a[108:111], a[172:175], v[196:199]
  v_mfma_f32_16x16x32_bf16 v[196:199], a[104:107], a[168:171], v[196:199]
  v_mfma_f32_16x16x32_bf16 v[200:203], a[112:115], a[168:171], v[200:203]
  v_mfma_f32_16x16x32_bf16 v[200:203], a[116:119], a[172:175], v[200:203]
  ds_read_b64_tr_b16 a[92:93], v19 offset:16384
  ds_read_b64_tr_b16 a[94:95], v19 offset:18432
  v_mfma_f32_16x16x32_bf16 v[204:207], a[124:127], a[172:175], v[204:207]
  s_add_u32 s24, s24, 262144
  v_mfma_f32_16x16x32_bf16 v[204:207], a[120:123], a[168:171], v[204:207]
  v_mfma_f32_16x16x32_bf16 v[208:211], a[128:131], a[168:171], v[208:211]
  v_mfma_f32_16x16x32_bf16 v[208:211], a[132:135], a[172:175], v[208:211]
  v_mfma_f32_16x16x32_bf16 v[212:215], a[140:143], a[172:175], v[212:215]
  v_mfma_f32_16x16x32_bf16 v[212:215], a[136:139], a[168:171], v[212:215]
  buffer_load_dword v21, v20, s[60:63], s54 offen
  s_add_u32 s54, s54, s55
  v_mfma_f32_16x16x32_bf16 v[216:219], a[144:147], a[168:171], v[216:219]
  v_mfma_f32_16x16x32_bf16 v[216:219], a[148:151], a[172:175], v[216:219]
  v_mfma_f32_16x16x32_bf16 v[220:223], a[156:159], a[172:175], v[220:223]
  v_mfma_f32_16x16x32_bf16 v[220:223], a[152:155], a[168:171], v[220:223]
  s_waitcnt lgkmcnt(10)
  v_mfma_f32_16x16x32_bf16 v[224:227], a[96:99], a[176:179], v[224:227]
  s_cmp_eq_u32 s54, s56
  s_cselect_b32 s54, s57, s54
  s_cselect_b64 s[60:61], s[58:59], s[60:61]
  s_cselect_b32 s62, s7, s62
  v_mfma_f32_16x16x32_bf16 v[224:227], a[100:103], a[180:183], v[224:227]
  v_mfma_f32_16x16x32_bf16 v[228:231], a[108:111], a[180:183], v[228:231]
  v_mfma_f32_16x16x32_bf16 v[228:231], a[104:107], a[176:179], v[228:231]
  v_mfma_f32_16x16x32_bf16 v[232:235], a[112:115], a[176:179], v[232:235]
  v_mfma_f32_16x16x32_bf16 v[232:235], a[116:119], a[180:183], v[232:235]
  v_mfma_f32_16x16x32_bf16 v[236:239], a[124:127], a[180:183], v[236:239]
  v_mfma_f32_16x16x32_bf16 v[236:239], a[120:123], a[176:179], v[236:239]
  s_waitcnt vmcnt(18) lgkmcnt(0)
  s_barrier
  ds_read_b128 a[160:163], v10 offset:0
  ds_read_b128 a[164:167], v11 offset:0
  v_mfma_f32_16x16x32_bf16 v[240:243], a[128:131], a[176:179], v[240:243]
  s_add_u32 m0, s29, 49152
  s_add_u32 s3, s23, s31
  buffer_load_dwordx4 v2, s[8:11], s3 offen offset:0 lds
  v_mfma_f32_16x16x32_bf16 v[240:243], a[132:135], a[180:183], v[240:243]
  v_mfma_f32_16x16x32_bf16 v[244:247], a[140:143], a[180:183], v[244:247]
  v_mfma_f32_16x16x32_bf16 v[244:247], a[136:139], a[176:179], v[244:247]
  v_mfma_f32_16x16x32_bf16 v[248:251], a[144:147], a[176:179], v[248:251]
  v_mfma_f32_16x16x32_bf16 v[248:251], a[148:151], a[180:183], v[248:251]
  buffer_load_dwordx4 v3, s[8:11], s3 offen offset:1024 lds
  v_mfma_f32_16x16x32_bf16 v[252:255], a[156:159], a[180:183], v[252:255]
  v_mfma_f32_16x16x32_bf16 v[252:255], a[152:155], a[176:179], v[252:255]
  v_mfma_f32_16x16x32_bf16 a[0:3], a[96:99], a[184:187], a[0:3]
  v_mfma_f32_16x16x32_bf16 a[0:3], a[100:103], a[188:191], a[0:3]
  ds_read_b128 a[168:171], v10 offset:2048
  ds_read_b128 a[172:175], v11 offset:2048
  v_mfma_f32_16x16x32_bf16 a[4:7], a[108:111], a[188:191], a[4:7]
  v_mfma_f32_16x16x32_bf16 a[4:7], a[104:107], a[184:187], a[4:7]
  v_mfma_f32_16x16x32_bf16 a[8:11], a[112:115], a[184:187], a[8:11]
  buffer_load_dwordx4 v4, s[8:11], s3 offen offset:2048 lds
  v_mfma_f32_16x16x32_bf16 a[8:11], a[116:119], a[188:191], a[8:11]
  v_mfma_f32_16x16x32_bf16 a[12:15], a[124:127], a[188:191], a[12:15]
  v_mfma_f32_16x16x32_bf16 a[12:15], a[120:123], a[184:187], a[12:15]
  v_mfma_f32_16x16x32_bf16 a[16:19], a[128:131], a[184:187], a[16:19]
  v_mfma_f32_16x16x32_bf16 a[16:19], a[132:135], a[188:191], a[16:19]
  buffer_load_dwordx4 v5, s[8:11], s3 offen offset:3072 lds
  v_mfma_f32_16x16x32_bf16 a[20:23], a[140:143], a[188:191], a[20:23]
  v_mfma_f32_16x16x32_bf16 a[20:23], a[136:139], a[184:187], a[20:23]
  v_mfma_f32_16x16x32_bf16 a[24:27], a[144:147], a[184:187], a[24:27]
  v_mfma_f32_16x16x32_bf16 a[24:27], a[148:151], a[188:191], a[24:27]
  v_mfma_f32_16x16x32_bf16 a[28:31], a[156:159], a[188:191], a[28:31]
  v_mfma_f32_16x16x32_bf16 a[28:31], a[152:155], a[184:187], a[28:31]
  s_waitcnt lgkmcnt(2)
  s_mov_b32 s30, 5
Lk1_ql:
  v_mfma_f32_16x16x32_bf16 v[32:35], a[32:35], a[160:163], v[32:35]
  s_add_u32 s23, s23, 128
  s_cmp_eq_u32 s23, s25
  s_cselect_b32 s23, s26, s23
  v_mfma_f32_16x16x32_bf16 v[32:35], a[36:39], a[164:167], v[32:35]
  ds_read_b128 a[176:179], v10 offset:4096
  ds_read_b128 a[180:183], v11 offset:4096
  v_mfma_f32_16x16x32_bf16 v[36:39], a[44:47], a[164:167], v[36:39]
  v_mfma_f32_16x16x32_bf16 v[36:39], a[40:43], a[160:163], v[36:39]
  ds_read_b64_tr_b16 a[96:97], v12 offset:32768
  ds_read_b64_tr_b16 a[98:99], v12 offset:34816
  v_mfma_f32_16x16x32_bf16 v[40:43], a[48:51], a[160:163], v[40:43]
  v_mfma_f32_16x16x32_bf16 v[40:43], a[52:55], a[164:167], v[40:43]
  v_mfma_f32_16x16x32_bf16 v[44:47], a[60:63], a[164:167], v[44:47]
  s_add_u32 m0, s29, 81920
  s_nop 0
  buffer_load_dwordx4 v6, s[12:15], s24 offen offset:0 lds
  v_mfma_f32_16x16x32_bf16 v[44:47], a[56:59], a[160:163], v[44:47]
  ds_read_b64_tr_b16 a[104:105], v13 offset:32768
  ds_read_b64_tr_b16 a[106:107], v13 offset:34816
  v_mfma_f32_16x16x32_bf16 v[48:51], a[64:67], a[160:163], v[48:51]
  v_mfma_f32_16x16x32_bf16 v[48:51], a[68:71], a[164:167], v[48:51]
  v_mfma_f32_16x16x32_bf16 v[52:55], a[76:79], a[164:167], v[52:55]
  v_mfma_f32_16x16x32_bf16 v[52:55], a[72:75], a[160:163], v[52:55]
  ds_read_b64_tr_b16 a[112:113], v14 offset:32768
  ds_read_b64_tr_b16 a[114:115], v14 offset:34816
  v_mfma_f32_16x16x32_bf16 v[56:59], a[80:83], a[160:163], v[56:59]
  v_mfma_f32_16x16x32_bf16 v[56:59], a[84:87], a[164:167], v[56:59]
  buffer_load_dwordx4 v7, s[12:15], s24 offen offset:1024 lds
  v_mfma_f32_16x16x32_bf16 v[60:63], a[92:95], a[164:167], v[60:63]
  v_mfma_f32_16x16x32_bf16 v[60:63], a[88:91], a[160:163], v[60:63]
  s_waitcnt lgkmcnt(8)
  ds_read_b64_tr_b16 a[120:121], v15 offset:32768
  ds_read_b64_tr_b16 a[122:123], v15 offset:34816
  v_mfma_f32_16x16x32_bf16 v[64:67], a[32:35], a[168:171], v[64:67]
  v_mfma_f32_16x16x32_bf16 v[64:67], a[36:39], a[172:175], v[64:67]
  ds_read_b128 a[184:187], v10 offset:6144
  ds_read_b128 a[188:191], v11 offset:6144
  v_mfma_f32_16x16x32_bf16 v[68:71], a[44:47], a[172:175], v[68:71]
  v_mfma_f32_16x16x32_bf16 v[68:71], a[40:43], a[168:171], v[68:71]
  ds_read_b64_tr_b16 a[128:129], v16 offset:32768
  ds_read_b64_tr_b16 a[130:131], v16 offset:34816
  v_mfma_f32_16x16x32_bf16 v[72:75], a[48:51], a[168:171], v[72:75]
  buffer_load_dwordx4 v8, s[12:15], s24 offen offset:2048 lds
  v_mfma_f32_16x16x32_bf16 v[72:75], a[52:55], a[172:175], v[72:75]
  v_mfma_f32_16x16x32_bf16 v[76:79], a[60:63], a[172:175], v[76:79]
  v_mfma_f32_16x16x32_bf16 v[76:79], a[56:59], a[168:171], v[76:79]
  ds_read_b64_tr_b16 a[136:137], v17 offset:32768
  ds_read_b64_tr_b16 a[138:139], v17 offset:34816
  v_mfma_f32_16x16x32_bf16 v[80:83], a[64:67], a[168:171], v[80:83]
  v_mfma_f32_16x16x32_bf16 v[80:83], a[68:71], a[172:175], v[80:83]
  v_mfma_f32_16x16x32_bf16 v[84:87], a[76:79], a[172:175], v[84:87]
  buffer_load_dwordx4 v9, s[12:15], s24 offen offset:3072 lds
  v_mfma_f32_16x16x32_bf16 v[84:87], a[72:75], a[168:171], v[84:87]
  ds_read_b64_tr_b16 a[144:145], v18 offset:32768
  ds_read_b64_tr_b16 a[146:147], v18 offset:34816
  v_mfma_f32_16x16x32_bf16 v[88:91], a[80:83], a[168:171], v[88:91]
  v_mfma_f32_16x16x32_bf16 v[88:91], a[84:87], a[172:175], v[88:91]
  v_mfma_f32_16x16x32_bf16 v[92:95], a[92:95], a[172:175], v[92:95]
  v_mfma_f32_16x16x32_bf16 v[92:95], a[88:91], a[168:171], v[92:95]
  s_waitcnt lgkmcnt(15)
  ds_read_b64_tr_b16 a[152:153], v19 offset:32768
  ds_read_b64_tr_b16 a[154:155], v19 offset:34816
  v_mfma_f32_16x16x32_bf16 v[96:99], a[32:35], a[176:179], v[96:99]
  s_add_u32 s24, s24, 262144
  s_cmp_eq_u32 s24, s27
  s_cselect_b32 s24, s28, s24
  s_cselect_b64 s[12:13], s[64:65], s[12:13]
  v_mfma_f32_16x16x32_bf16 v[96:99], a[36:39], a[180:183], v[96:99]
  v_mfma_f32_16x16x32_bf16 v[100:103], a[44:47], a[180:183], v[100:103]
  v_mfma_f32_16x16x32_bf16 v[100:103], a[40:43], a[176:179], v[100:103]
  v_mfma_f32_16x16x32_bf16 v[104:107], a[48:51], a[176:179], v[104:107]
  v_mfma_f32_16x16x32_bf16 v[104:107], a[52:55], a[180:183], v[104:107]
  v_mfma_f32_16x16x32_bf16 v[108:111], a[60:63], a[180:183], v[108:111]
  v_mfma_f32_16x16x32_bf16 v[108:111], a[56:59], a[176:179], v[108:111]
  s_waitcnt vmcnt(17) lgkmcnt(0)
  s_barrier
  ds_read_b128 a[160:163], v10 offset:16384
  ds_read_b128 a[164:167], v11 offset:16384
  v_mfma_f32_16x16x32_bf16 v[112:115], a[64:67], a[176:179], v[112:115]
  s_add_u32 m0, s29, 0
  s_nop 0
  buffer_load_dwordx4 v2, s[8:11], s23 offen offset:0 lds
  v_mfma_f32_16x16x32_bf16 v[112:115], a[68:71], a[180:183], v[112:115]
  v_mfma_f32_16x16x32_bf16 v[116:119], a[76:79], a[180:183], v[116:119]
  v_mfma_f32_16x16x32_bf16 v[116:119], a[72:75], a[176:179], v[116:119]
  ds_read_b64_tr_b16 a[100:101], v12 offset:49152
  ds_read_b64_tr_b16 a[102:103], v12 offset:51200
  v_mfma_f32_16x16x32_bf16 v[120:123], a[80:83], a[176:179], v[120:123]
  v_mfma_f32_16x16x32_bf16 v[120:123], a[84:87], a[180:183], v[120:123]
  buffer_load_dwordx4 v3, s[8:11], s23 offen offset:1024 lds
  v_mfma_f32_16x16x32_bf16 v[124:127], a[92:95], a[180:183], v[124:127]
  v_mfma_f32_16x16x32_bf16 v[124:127], a[88:91], a[176:179], v[124:127]
  v_mfma_f32_16x16x32_bf16 v[128:131], a[32:35], a[184:187], v[128:131]
  v_mfma_f32_16x16x32_bf16 v[128:131], a[36:39], a[188:191], v[128:131]
  ds_read_b128 a[168:171], v10 offset:18432
  ds_read_b128 a[172:175], v11 offset:18432
  ds_read_b64_tr_b16 a[108:109], v13 offset:49152
  ds_read_b64_tr_b16 a[110:111], v13 offset:51200
  v_mfma_f32_16x16x32_bf16 v[132:135], a[44:47], a[188:191], v[132:135]
  v_mfma_f32_16x16x32_bf16 v[132:135], a[40:43], a[184:187], v[132:135]
  buffer_load_dwordx4 v4, s[8:11], s23 offen offset:2048 lds
  v_mfma_f32_16x16x32_bf16 v[136:139], a[48:51], a[184:187], v[136:139]
  v_mfma_f32_16x16x32_bf16 v[136:139], a[52:55], a[188:191], v[136:139]
  v_mfma_f32_16x16x32_bf16 v[140:143], a[60:63], a[188:191], v[140:143]
  v_mfma_f32_16x16x32_bf16 v[140:143], a[56:59], a[184:187], v[140:143]
  ds_read_b64_tr_b16 a[116:117], v14 offset:49152
  ds_read_b64_tr_b16 a[118:119], v14 offset:51200
  v_mfma_f32_16x16x32_bf16 v[144:147], a[64:67], a[184:187], v[144:147]
  v_mfma_f32_16x16x32_bf16 v[144:147], a[68:71], a[188:191], v[144:147]
  buffer_load_dwordx4 v5, s[8:11], s23 offen offset:3072 lds
  v_mfma_f32_16x16x32_bf16 v[148:151], a[76:79], a[188:191], v[148:151]
  v_mfma_f32_16x16x32_bf16 v[148:151], a[72:75], a[184:187], v[148:151]
  v_mfma_f32_16x16x32_bf16 v[152:155], a[80:83], a[184:187], v[152:155]
  v_mfma_f32_16x16x32_bf16 v[152:155], a[84:87], a[188:191], v[152:155]
  ds_read_b64_tr_b16 a[124:125], v15 offset:49152
  ds_read_b64_tr_b16 a[126:127], v15 offset:51200
  v_mfma_f32_16x16x32_bf16 v[156:159], a[92:95], a[188:191], v[156:159]
  s_add_u32 m0, s29, 98304
  s_nop 0
  buffer_load_dwordx4 v6, s[12:15], s24 offen offset:0 lds
  v_mfma_f32_16x16x32_bf16 v[156:159], a[88:91], a[184:187], v[156:159]
  s_waitcnt lgkmcnt(10)
  v_mfma_f32_16x16x32_bf16 v[160:163], a[32:35], a[160:163], v[160:163]
  v_mfma_f32_16x16x32_bf16 v[160:163], a[36:39], a[164:167], v[160:163]
  ds_read_b128 a[176:179], v10 offset:20480
  ds_read_b128 a[180:183], v11 offset:20480
  v_mfma_f32_16x16x32_bf16 v[164:167], a[44:47], a[164:167], v[164:167]
  v_mfma_f32_16x16x32_bf16 v[164:167], a[40:43], a[160:163], v[164:167]
  ds_read_b64_tr_b16 a[132:133], v16 offset:49152
  ds_read_b64_tr_b16 a[134:135], v16 offset:51200
  v_mfma_f32_16x16x32_bf16 v[168:171], a[48:51], a[160:163], v[168:171]
  v_mfma_f32_16x16x32_bf16 v[168:171], a[52:55], a[164:167], v[168:171]
  buffer_load_dwordx4 v7, s[12:15], s24 offen offset:1024 lds
  v_mfma_f32_16x16x32_bf16 v[172:175], a[60:63], a[164:167], v[172:175]
  v_mfma_f32_16x16x32_bf16 v[172:175], a[56:59], a[160:163], v[172:175]
  v_mfma_f32_16x16x32_bf16 v[176:179], a[64:67], a[160:163], v[176:179]
  v_mfma_f32_16x16x32_bf16 v[176:179], a[68:71], a[164:167], v[176:179]
  ds_read_b64_tr_b16 a[140:141], v17 offset:49152
  ds_read_b64_tr_b16 a[142:143], v17 offset:51200
  v_mfma_f32_16x16x32_bf16 v[180:183], a[76:79], a[164:167], v[180:183]
  v_mfma_f32_16x16x32_bf16 v[180:183], a[72:75], a[160:163], v[180:183]
  buffer_load_dwordx4 v8, s[12:15], s24 offen offset:2048 lds
  v_mfma_f32_16x16x32_bf16 v[184:187], a[80:83], a[160:163], v[184:187]
  v_mfma_f32_16x16x32_bf16 v[184:187], a[84:87], a[164:167], v[184:187]
  v_mfma_f32_16x16x32_bf16 v[188:191], a[92:95], a[164:167], v[188:191]
  v_mfma_f32_16x16x32_bf16 v[188:191], a[88:91], a[160:163], v[188:191]
  s_waitcnt lgkmcnt(12)
  ds_read_b64_tr_b16 a[148:149], v18 offset:49152
  ds_read_b64_tr_b16 a[150:151], v18 offset:51200
  v_mfma_f32_16x16x32_bf16 v[192:195], a[32:35], a[168:171], v[192:195]
  buffer_load_dwordx4 v9, s[12:15], s24 offen offset:3072 lds
  v_mfma_f32_16x16x32_bf16 v[192:195], a[36:39], a[172:175], v[192:195]
  ds_read_b128 a[184:187], v10 offset:22528
  ds_read_b128 a[188:191], v11 offset:22528
  v_mfma_f32_16x16x32_bf16 v[196:199], a[44:47], a[172:175], v[196:199]
  v_mfma_f32_16x16x32_bf16 v[196:199], a[40:43], a[168:171], v[196:199]
  v_mfma_f32_16x16x32_bf16 v[200:203], a[48:51], a[168:171], v[200:203]
  v_mfma_f32_16x16x32_bf16 v[200:203], a[52:55], a[172:175], v[200:203]
  ds_read_b64_tr_b16 a[156:157], v19 offset:49152
  ds_read_b64_tr_b16 a[158:159], v19 offset:51200
  v_mfma_f32_16x16x32_bf16 v[204:207], a[60:63], a[172:175], v[204:207]
  s_add_u32 s24, s24, 262144
  v_mfma_f32_16x16x32_bf16 v[204:207], a[56:59], a[168:171], v[204:207]
  v_mfma_f32_16x16x32_bf16 v[208:211], a[64:67], a[168:171], v[208:211]
  v_mfma_f32_16x16x32_bf16 v[208:211], a[68:71], a[172:175], v[208:211]
  v_mfma_f32_16x16x32_bf16 v[212:215], a[76:79], a[172:175], v[212:215]
  v_mfma_f32_16x16x32_bf16 v[212:215], a[72:75], a[168:171], v[212:215]
  buffer_load_dword v21, v20, s[60:63], s54 offen
  s_add_u32 s54, s54, s55
  v_mfma_f32_16x16x32_bf16 v[216:219], a[80:83], a[168:171], v[216:219]
  v_mfma_f32_16x16x32_bf16 v[216:219], a[84:87], a[172:175], v[216:219]
  v_mfma_f32_16x16x32_bf16 v[220:223], a[92:95], a[172:175], v[220:223]
  v_mfma_f32_16x16x32_bf16 v[220:223], a[88:91], a[168:171], v[220:223]
  s_waitcnt lgkmcnt(10)
  v_mfma_f32_16x16x32_bf16 v[224:227], a[32:35], a[176:179], v[224:227]
  s_cmp_eq_u32 s54, s56
  s_cselect_b32 s54, s57, s54
  s_cselect_b64 s[60:61], s[58:59], s[60:61]
  s_cselect_b32 s62, s7, s62
  v_mfma_f32_16x16x32_bf16 v[224:227], a[36:39], a[180:183], v[224:227]
  v_mfma_f32_16x16x32_bf16 v[228:231], a[44:47], a[180:183], v[228:231]
  v_mfma_f32_16x16x32_bf16 v[228:231], a[40:43], a[176:179], v[228:231]
  v_mfma_f32_16x16x32_bf16 v[232:235], a[48:51], a[176:179], v[232:235]
  v_mfma_f32_16x16x32_bf16 v[232:235], a[52:55], a[180:183], v[232:235]
  v_mfma_f32_16x16x32_bf16 v[236:239], a[60:63], a[180:183], v[236:239]
  v_mfma_f32_16x16x32_bf16 v[236:239], a[56:59], a[176:179], v[236:239]
  s_waitcnt vmcnt(18) lgkmcnt(0)
  s_barrier
  ds_read_b128 a[160:163], v10 offset:32768
  ds_read_b128 a[164:167], v11 offset:32768
  v_mfma_f32_16x16x32_bf16 v[240:243], a[64:67], a[176:179], v[240:243]
  s_add_u32 m0, s29, 16384
  s_add_u32 s3, s23, s31
  buffer_load_dwordx4 v2, s[8:11], s3 offen offset:0 lds
  v_mfma_f32_16x16x32_bf16 v[240:243], a[68:71], a[180:183], v[240:243]
  v_mfma_f32_16x16x32_bf16 v[244:247], a[76:79], a[180:183], v[244:247]
  v_mfma_f32_16x16x32_bf16 v[244:247], a[72:75], a[176:179], v[244:247]
  v_mfma_f32_16x16x32_bf16 v[248:251], a[80:83], a[176:179], v[248:251]
  v_mfma_f32_16x16x32_bf16 v[248:251], a[84:87], a[180:183], v[248:251]
  buffer_load_dwordx4 v3, s[8:11], s3 offen offset:1024 lds
  v_mfma_f32_16x16x32_bf16 v[252:255], a[92:95], a[180:183], v[252:255]
  v_mfma_f32_16x16x32_bf16 v[252:255], a[88:91], a[176:179], v[252:255]
  v_mfma_f32_16x16x32_bf16 a[0:3], a[32:35], a[184:187], a[0:3]
  v_mfma_f32_16x16x32_bf16 a[0:3], a[36:39], a[188:191], a[0:3]
  ds_read_b128 a[168:171], v10 offset:34816
  ds_read_b128 a[172:175], v11 offset:34816
  v_mfma_f32_16x16x32_bf16 a[4:7], a[44:47], a[188:191], a[4:7]
  v_mfma_f32_16x16x32_bf16 a[4:7], a[40:43], a[184:187], a[4:7]
  v_mfma_f32_16x16x32_bf16 a[8:11], a[48:51], a[184:187], a[8:11]
  buffer_load_dwordx4 v4, s[8:11], s3 offen offset:2048 lds
  v_mfma_f32_16x16x32_bf16 a[8:11], a[52:55], a[188:191], a[8:11]
  v_mfma_f32_16x16x32_bf16 a[12:15], a[60:63], a[188:191], a[12:15]
  v_mfma_f32_16x16x32_bf16 a[12:15], a[56:59], a[184:187], a[12:15]
  v_mfma_f32_16x16x32_bf16 a[16:19], a[64:67], a[184:187], a[16:19]
  v_mfma_f32_16x16x32_bf16 a[16:19], a[68:71], a[188:191], a[16:19]
  buffer_load_dwordx4 v5, s[8:11], s3 offen offset:3072 lds
  v_mfma_f32_16x16x32_bf16 a[20:23], a[76:79], a[188:191], a[20:23]
  v_mfma_f32_16x16x32_bf16 a[20:23], a[72:75], a[184:187], a[20:23]
  v_mfma_f32_16x16x32_bf16 a[24:27], a[80:83], a[184:187], a[24:27]
  v_mfma_f32_16x16x32_bf16 a[24:27], a[84:87], a[188:191], a[24:27]
  v_mfma_f32_16x16x32_bf16 a[28:31], a[92:95], a[188:191], a[28:31]
  v_mfma_f32_16x16x32_bf16 a[28:31], a[88:91], a[184:187], a[28:31]
  s_waitcnt lgkmcnt(2)
  v_mfma_f32_16x16x32_bf16 v[32:35], a[96:99], a[160:163], v[32:35]
  s_add_u32 s23, s23, 128
  s_cmp_eq_u32 s23, s25
  s_cselect_b32 s23, s26, s23
  v_mfma_f32_16x16x32_bf16 v[32:35], a[100:103], a[164:167], v[32:35]
  ds_read_b128 a[176:179], v10 offset:36864
  ds_read_b128 a[180:183], v11 offset:36864
  v_mfma_f32_16x16x32_bf16 v[36:39], a[108:111], a[164:167], v[36:39]
  v_mfma_f32_16x16x32_bf16 v[36:39], a[104:107], a[160:163], v[36:39]
  ds_read_b64_tr_b16 a[32:33], v12 offset:0
  ds_read_b64_tr_b16 a[34:35], v12 offset:2048
  v_mfma_f32_16x16x32_bf16 v[40:43], a[112:115], a[160:163], v[40:43]
  v_mfma_f32_16x16x32_bf16 v[40:43], a[116:119], a[164:167], v[40:43]
  v_mfma_f32_16x16x32_bf16 v[44:47], a[124:127], a[164:167], v[44:47]
  s_add_u32 m0, s29, 114688
  s_nop 0
  buffer_load_dwordx4 v6, s[12:15], s24 offen offset:0 lds
  v_mfma_f32_16x16x32_bf16 v[44:47], a[120:123], a[160:163], v[44:47]
  ds_read_b64_tr_b16 a[40:41], v13 offset:0
  ds_read_b64_tr_b16 a[42:43], v13 offset:2048
  v_mfma_f32_16x16x32_bf16 v[48:51], a[128:131], a[160:163], v[48:51]
  v_mfma_f32_16x16x32_bf16 v[48:51], a[132:135], a[164:167], v[48:51]
  v_mfma_f32_16x16x32_bf16 v[52:55], a[140:143], a[164:167], v[52:55]
  v_mfma_f32_16x16x32_bf16 v[52:55], a[136:139], a[160:163], v[52:55]
  ds_read_b64_tr_b16 a[48:49], v14 offset:0
  ds_read_b64_tr_b16 a[50:51], v14 offset:2048
  v_mfma_f32_16x16x32_bf16 v[56:59], a[144:147], a[160:163], v[56:59]
  v_mfma_f32_16x16x32_bf16 v[56:59], a[148:151], a[164:167], v[56:59]
  buffer_load_dwordx4 v7, s[12:15], s24 offen offset:1024 lds
  v_mfma_f32_16x16x32_bf16 v[60:63], a[156:159], a[164:167], v[60:63]
  v_mfma_f32_16x16x32_bf16 v[60:63], a[152:155], a[160:163], v[60:63]
  s_waitcnt lgkmcnt(8)
  ds_read_b64_tr_b16 a[56:57], v15 offset:0
  ds_read_b64_tr_b16 a[58:59], v15 offset:2048
  v_mfma_f32_16x16x32_bf16 v[64:67], a[96:99], a[168:171], v[64:67]
  v_mfma_f32_16x16x32_bf16 v[64:67], a[100:103], a[172:175], v[64:67]
  ds_read_b128 a[184:187], v10 offset:38912
  ds_read_b128 a[188:191], v11 offset:38912
  v_mfma_f32_16x16x32_bf16 v[68:71], a[108:111], a[172:175], v[68:71]
  v_mfma_f32_16x16x32_bf16 v[68:71], a[104:107], a[168:171], v[68:71]
  ds_read_b64_tr_b16 a[64:65], v16 offset:0
  ds_read_b64_tr_b16 a[66:67], v16 offset:2048
  v_mfma_f32_16x16x32_bf16 v[72:75], a[112:115], a[168:171], v[72:75]
  buffer_load_dwordx4 v8, s[12:15], s24 offen offset:2048 lds
  v_mfma_f32_16x16x32_bf16 v[72:75], a[116:119], a[172:175], v[72:75]
  v_mfma_f32_16x16x32_bf16 v[76:79], a[124:127], a[172:175], v[76:79]
  v_mfma_f32_16x16x32_bf16 v[76:79], a[120:123], a[168:171], v[76:79]
  ds_read_b64_tr_b16 a[72:73], v17 offset:0
  ds_read_b64_tr_b16 a[74:75], v17 offset:2048
  v_mfma_f32_16x16x32_bf16 v[80:83], a[128:131], a[168:171], v[80:83]
  v_mfma_f32_16x16x32_bf16 v[80:83], a[132:135], a[172:175], v[80:83]
  v_mfma_f32_16x16x32_bf16 v[84:87], a[140:143], a[172:175], v[84:87]
  buffer_load_dwordx4 v9, s[12:15], s24 offen offset:3072 lds
  v_mfma_f32_16x16x32_bf16 v[84:87], a[136:139], a[168:171], v[84:87]
  ds_read_b64_tr_b16 a[80:81], v18 offset:0
  ds_read_b64_tr_b16 a[82:83], v18 offset:2048
  v_mfma_f32_16x16x32_bf16 v[88:91], a[144:147], a[168:171], v[88:91]
  v_mfma_f32_16x16x32_bf16 v[88:91], a[148:151], a[172:175], v[88:91]
  v_mfma_f32_16x16x32_bf16 v[92:95], a[156:159], a[172:175], v[92:95]
  v_mfma_f32_16x16x32_bf16 v[92:95], a[152:155], a[168:171], v[92:95]
  s_waitcnt lgkmcnt(15)
  ds_read_b64_tr_b16 a[88:89], v19 offset:0
  ds_read_b64_tr_b16 a[90:91], v19 offset:2048
  v_mfma_f32_16x16x32_bf16 v[96:99], a[96:99], a[176:179], v[96:99]
  s_add_u32 s24, s24, 262144
  s_cmp_eq_u32 s24, s27
  s_cselect_b32 s24, s28, s24
  s_cselect_b64 s[12:13], s[64:65], s[12:13]
  v_mfma_f32_16x16x32_bf16 v[96:99], a[100:103], a[180:183], v[96:99]
  v_mfma_f32_16x16x32_bf16 v[100:103], a[108:111], a[180:183], v[100:103]
  v_mfma_f32_16x16x32_bf16 v[100:103], a[104:107], a[176:179], v[100:103]
  v_mfma_f32_16x16x32_bf16 v[104:107], a[112:115], a[176:179], v[104:107]
  v_mfma_f32_16x16x32_bf16 v[104:107], a[116:119], a[180:183], v[104:107]
  v_mfma_f32_16x16x32_bf16 v[108:111], a[124:127], a[180:183], v[108:111]
  v_mfma_f32_16x16x32_bf16 v[108:111], a[120:123], a[176:179], v[108:111]
  s_waitcnt vmcnt(17) lgkmcnt(0)
  s_barrier
  ds_read_b128 a[160:163], v10 offset:49152
  ds_read_b128 a[164:167], v11 offset:49152
  v_mfma_f32_16x16x32_bf16 v[112:115], a[128:131], a[176:179], v[112:115]
  s_add_u32 m0, s29, 32768
  s_nop 0
  buffer_load_dwordx4 v2, s[8:11], s23 offen offset:0 lds
  v_mfma_f32_16x16x32_bf16 v[112:115], a[132:135], a[180:183], v[112:115]
  v_mfma_f32_16x16x32_bf16 v[116:119], a[140:143], a[180:183], v[116:119]
  v_mfma_f32_16x16x32_bf16 v[116:119], a[136:139], a[176:179], v[116:119]
  ds_read_b64_tr_b16 a[36:37], v12 offset:16384
  ds_read_b64_tr_b16 a[38:39], v12 offset:18432
  v_mfma_f32_16x16x32_bf16 v[120:123], a[144:147], a[176:179], v[120:123]
  v_mfma_f32_16x16x32_bf16 v[120:123], a[148:151], a[180:183], v[120:123]
  buffer_load_dwordx4 v3, s[8:11], s23 offen offset:1024 lds
  v_mfma_f32_16x16x32_bf16 v[124:127], a[156:159], a[180:183], v[124:127]
  v_mfma_f32_16x16x32_bf16 v[124:127], a[152:155], a[176:179], v[124:127]
  v_mfma_f32_16x16x32_bf16 v[128:131], a[96:99], a[184:187], v[128:131]
  v_mfma_f32_16x16x32_bf16 v[128:131], a[100:103], a[188:191], v[128:131]
  ds_read_b128 a[168:171], v10 offset:51200
  ds_read_b128 a[172:175], v11 offset:51200
  ds_read_b64_tr_b16 a[44:45], v13 offset:16384
  ds_read_b64_tr_b16 a[46:47], v13 offset:18432
  v_mfma_f32_16x16x32_bf16 v[132:135], a[108:111], a[188:191], v[132:135]
  v_mfma_f32_16x16x32_bf16 v[132:135], a[104:107], a[184:187], v[132:135]
  buffer_load_dwordx4 v4, s[8:11], s23 offen offset:2048 lds
  v_mfma_f32_16x16x32_bf16 v[136:139], a[112:115], a[184:187], v[136:139]
  v_mfma_f32_16x16x32_bf16 v[136:139], a[116:119], a[188:191], v[136:139]
  v_mfma_f32_16x16x32_bf16 v[140:143], a[124:127], a[188:191], v[140:143]
  v_mfma_f32_16x16x32_bf16 v[140:143], a[120:123], a[184:187], v[140:143]
  ds_read_b64_tr_b16 a[52:53], v14 offset:16384
  ds_read_b64_tr_b16 a[54:55], v14 offset:18432
  v_mfma_f32_16x16x32_bf16 v[144:147], a[128:131], a[184:187], v[144:147]
  v_mfma_f32_16x16x32_bf16 v[144:147], a[132:135], a[188:191], v[144:147]
  buffer_load_dwordx4 v5, s[8:11], s23 offen offset:3072 lds
  v_mfma_f32_16x16x32_bf16 v[148:151], a[140:143], a[188:191], v[148:151]
  v_mfma_f32_16x16x32_bf16 v[148:151], a[136:139], a[184:187], v[148:151]
  v_mfma_f32_16x16x32_bf16 v[152:155], a[144:147], a[184:187], v[152:155]
  v_mfma_f32_16x16x32_bf16 v[152:155], a[148:151], a[188:191], v[152:155]
  ds_read_b64_tr_b16 a[60:61], v15 offset:16384
  ds_read_b64_tr_b16 a[62:63], v15 offset:18432
  v_mfma_f32_16x16x32_bf16 v[156:159], a[156:159], a[188:191], v[156:159]
  s_add_u32 m0, s29, 65536
  s_nop 0
  buffer_load_dwordx4 v6, s[12:15], s24 offen offset:0 lds
  v_mfma_f32_16x16x32_bf16 v[156:159], a[152:155], a[184:187], v[156:159]
  s_waitcnt lgkmcnt(10)
  v_mfma_f32_16x16x32_bf16 v[160:163], a[96:99], a[160:163], v[160:163]
  v_mfma_f32_16x16x32_bf16 v[160:163], a[100:103], a[164:167], v[160:163]
  ds_read_b128 a[176:179], v10 offset:53248
  ds_read_b128 a[180:183], v11 offset:53248
  v_mfma_f32_16x16x32_bf16 v[164:167], a[108:111], a[164:167], v[164:167]
  v_mfma_f32_16x16x32_bf16 v[164:167], a[104:107], a[160:163], v[164:167]
  ds_read_b64_tr_b16 a[68:69], v16 offset:16384
  ds_read_b64_tr_b16 a[70:71], v16 offset:18432
  v_mfma_f32_16x16x32_bf16 v[168:171], a[112:115], a[160:163], v[168:171]
  v_mfma_f32_16x16x32_bf16 v[168:171], a[116:119], a[164:167], v[168:171]
  buffer_load_dwordx4 v7, s[12:15], s24 offen offset:1024 lds
  v_mfma_f32_16x16x32_bf16 v[172:175], a[124:127], a[164:167], v[172:175]
  v_mfma_f32_16x16x32_bf16 v[172:175], a[120:123], a[160:163], v[172:175]
  v_mfma_f32_16x16x32_bf16 v[176:179], a[128:131], a[160:163], v[176:179]
  v_mfma_f32_16x16x32_bf16 v[176:179], a[132:135], a[164:167], v[176:179]
  ds_read_b64_tr_b16 a[76:77], v17 offset:16384
  ds_read_b64_tr_b16 a[78:79], v17 offset:18432
  v_mfma_f32_16x16x32_bf16 v[180:183], a[140:143], a[164:167], v[180:183]
  v_mfma_f32_16x16x32_bf16 v[180:183], a[136:139], a[160:163], v[180:183]
  buffer_load_dwordx4 v8, s[12:15], s24 offen offset:2048 lds
  v_mfma_f32_16x16x32_bf16 v[184:187], a[144:147], a[160:163], v[184:187]
  v_mfma_f32_16x16x32_bf16 v[184:187], a[148:151], a[164:167], v[184:187]
  v_mfma_f32_16x16x32_bf16 v[188:191], a[156:159], a[164:167], v[188:191]
  v_mfma_f32_16x16x32_bf16 v[188:191], a[152:155], a[160:163], v[188:191]
  s_waitcnt lgkmcnt(12)
  ds_read_b64_tr_b16 a[84:85], v18 offset:16384
  ds_read_b64_tr_b16 a[86:87], v18 offset:18432
  v_mfma_f32_16x16x32_bf16 v[192:195], a[96:99], a[168:171], v[192:195]
  buffer_load_dwordx4 v9, s[12:15], s24 offen offset:3072 lds
  v_mfma_f32_16x16x32_bf16 v[192:195], a[100:103], a[172:175], v[192:195]
  ds_read_b128 a[184:187], v10 offset:55296
  ds_read_b128 a[188:191], v11 offset:55296
  v_mfma_f32_16x16x32_bf16 v[196:199], a[108:111], a[172:175], v[196:199]
  v_mfma_f32_16x16x32_bf16 v[196:199], a[104:107], a[168:171], v[196:199]
  v_mfma_f32_16x16x32_bf16 v[200:203], a[112:115], a[168:171], v[200:203]
  v_mfma_f32_16x16x32_bf16 v[200:203], a[116:119], a[172:175], v[200:203]
  ds_read_b64_tr_b16 a[92:93], v19 offset:16384
  ds_read_b64_tr_b16 a[94:95], v19 offset:18432
  v_mfma_f32_16x16x32_bf16 v[204:207], a[124:127], a[172:175], v[204:207]
  s_add_u32 s24, s24, 262144
  v_mfma_f32_16x16x32_bf16 v[204:207], a[120:123], a[168:171], v[204:207]
  v_mfma_f32_16x16x32_bf16 v[208:211], a[128:131], a[168:171], v[208:211]
  v_mfma_f32_16x16x32_bf16 v[208:211], a[132:135], a[172:175], v[208:211]
  v_mfma_f32_16x16x32_bf16 v[212:215], a[140:143], a[172:175], v[212:215]
  v_mfma_f32_16x16x32_bf16 v[212:215], a[136:139], a[168:171], v[212:215]
  buffer_load_dword v21, v20, s[60:63], s54 offen
  s_add_u32 s54, s54, s55
  v_mfma_f32_16x16x32_bf16 v[216:219], a[144:147], a[168:171], v[216:219]
  v_mfma_f32_16x16x32_bf16 v[216:219], a[148:151], a[172:175], v[216:219]
  v_mfma_f32_16x16x32_bf16 v[220:223], a[156:159], a[172:175], v[220:223]
  v_mfma_f32_16x16x32_bf16 v[220:223], a[152:155], a[168:171], v[220:223]
  s_waitcnt lgkmcnt(10)
  v_mfma_f32_16x16x32_bf16 v[224:227], a[96:99], a[176:179], v[224:227]
  s_cmp_eq_u32 s54, s56
  s_cselect_b32 s54, s57, s54
  s_cselect_b64 s[60:61], s[58:59], s[60:61]
  s_cselect_b32 s62, s7, s62
  v_mfma_f32_16x16x32_bf16 v[224:227], a[100:103], a[180:183], v[224:227]
  v_mfma_f32_16x16x32_bf16 v[228:231], a[108:111], a[180:183], v[228:231]
  v_mfma_f32_16x16x32_bf16 v[228:231], a[104:107], a[176:179], v[228:231]
  v_mfma_f32_16x16x32_bf16 v[232:235], a[112:115], a[176:179], v[232:235]
  v_mfma_f32_16x16x32_bf16 v[232:235], a[116:119], a[180:183], v[232:235]
  v_mfma_f32_16x16x32_bf16 v[236:239], a[124:127], a[180:183], v[236:239]
  v_mfma_f32_16x16x32_bf16 v[236:239], a[120:123], a[176:179], v[236:239]
  s_waitcnt vmcnt(18) lgkmcnt(0)
  s_barrier
  ds_read_b128 a[160:163], v10 offset:0
  ds_read_b128 a[164:167], v11 offset:0
  v_mfma_f32_16x16x32_bf16 v[240:243], a[128:131], a[176:179], v[240:243]
  s_add_u32 m0, s29, 49152
  s_add_u32 s3, s23, s31
  buffer_load_dwordx4 v2, s[8:11], s3 offen offset:0 lds
  v_mfma_f32_16x16x32_bf16 v[240:243], a[132:135], a[180:183], v[240:243]
  v_mfma_f32_16x16x32_bf16 v[244:247], a[140:143], a[180:183], v[244:247]
  v_mfma_f32_16x16x32_bf16 v[244:247], a[136:139], a[176:179], v[244:247]
  v_mfma_f32_16x16x32_bf16 v[248:251], a[144:147], a[176:179], v[248:251]
  v_mfma_f32_16x16x32_bf16 v[248:251], a[148:151], a[180:183], v[248:251]
  buffer_load_dwordx4 v3, s[8:11], s3 offen offset:1024 lds
  v_mfma_f32_16x16x32_bf16 v[252:255], a[156:159], a[180:183], v[252:255]
  v_mfma_f32_16x16x32_bf16 v[252:255], a[152:155], a[176:179], v[252:255]
  v_mfma_f32_16x16x32_bf16 a[0:3], a[96:99], a[184:187], a[0:3]
  v_mfma_f32_16x16x32_bf16 a[0:3], a[100:103], a[188:191], a[0:3]
  ds_read_b128 a[168:171], v10 offset:2048
  ds_read_b128 a[172:175], v11 offset:2048
  v_mfma_f32_16x16x32_bf16 a[4:7], a[108:111], a[188:191], a[4:7]
  v_mfma_f32_16x16x32_bf16 a[4:7], a[104:107], a[184:187], a[4:7]
  v_mfma_f32_16x16x32_bf16 a[8:11], a[112:115], a[184:187], a[8:11]
  buffer_load_dwordx4 v4, s[8:11], s3 offen offset:2048 lds
  v_mfma_f32_16x16x32_bf16 a[8:11], a[116:119], a[188:191], a[8:11]
  v_mfma_f32_16x16x32_bf16 a[12:15], a[124:127], a[188:191], a[12:15]
  v_mfma_f32_16x16x32_bf16 a[12:15], a[120:123], a[184:187], a[12:15]
  v_mfma_f32_16x16x32_bf16 a[16:19], a[128:131], a[184:187], a[16:19]
  v_mfma_f32_16x16x32_bf16 a[16:19], a[132:135], a[188:191], a[16:19]
  buffer_load_dwordx4 v5, s[8:11], s3 offen offset:3072 lds
  v_mfma_f32_16x16x32_bf16 a[20:23], a[140:143], a[188:191], a[20:23]
  v_mfma_f32_16x16x32_bf16 a[20:23], a[136:139], a[184:187], a[20:23]
  v_mfma_f32_16x16x32_bf16 a[24:27], a[144:147], a[184:187], a[24:27]
  v_mfma_f32_16x16x32_bf16 a[24:27], a[148:151], a[188:191], a[24:27]
  v_mfma_f32_16x16x32_bf16 a[28:31], a[156:159], a[188:191], a[28:31]
  v_mfma_f32_16x16x32_bf16 a[28:31], a[152:155], a[184:187], a[28:31]
  s_waitcnt lgkmcnt(2)
  s_sub_u32 s30, s30, 1
  s_cmp_lg_u32 s30, 0
  s_cbranch_scc1 Lk1_ql
  v_mfma_f32_16x16x32_bf16 v[32:35], a[32:35], a[160:163], v[32:35]
  s_add_u32 s23, s23, 128
  s_cmp_eq_u32 s23, s25
  s_cselect_b32 s23, s26, s23
  v_mfma_f32_16x16x32_bf16 v[32:35], a[36:39], a[164:167], v[32:35]
  ds_read_b128 a[176:179], v10 offset:4096
  ds_read_b128 a[180:183], v11 offset:4096
  v_mfma_f32_16x16x32_bf16 v[36:39], a[44:47], a[164:167], v[36:39]
  v_mfma_f32_16x16x32_bf16 v[36:39], a[40:43], a[160:163], v[36:39]
  ds_read_b64_tr_b16 a[96:97], v12 offset:32768
  ds_read_b64_tr_b16 a[98:99], v12 offset:34816
  v_mfma_f32_16x16x32_bf16 v[40:43], a[48:51], a[160:163], v[40:43]
  v_mfma_f32_16x16x32_bf16 v[40:43], a[52:55], a[164:167], v[40:43]
  v_mfma_f32_16x16x32_bf16 v[44:47], a[60:63], a[164:167], v[44:47]
  s_add_u32 m0, s29, 81920
  s_nop 0
  buffer_load_dwordx4 v6, s[12:15], s24 offen offset:0 lds
  v_mfma_f32_16x16x32_bf16 v[44:47], a[56:59], a[160:163], v[44:47]
  ds_read_b64_tr_b16 a[104:105], v13 offset:32768
  ds_read_b64_tr_b16 a[106:107], v13 offset:34816
  v_mfma_f32_16x16x32_bf16 v[48:51], a[64:67], a[160:163], v[48:51]
  v_mfma_f32_16x16x32_bf16 v[48:51], a[68:71], a[164:167], v[48:51]
  v_mfma_f32_16x16x32_bf16 v[52:55], a[76:79], a[164:167], v[52:55]
  v_mfma_f32_16x16x32_bf16 v[52:55], a[72:75], a[160:163], v[52:55]
  ds_read_b64_tr_b16 a[112:113], v14 offset:32768
  ds_read_b64_tr_b16 a[114:115], v14 offset:34816
  v_mfma_f32_16x16x32_bf16 v[56:59], a[80:83], a[160:163], v[56:59]
  v_mfma_f32_16x16x32_bf16 v[56:59], a[84:87], a[164:167], v[56:59]
  buffer_load_dwordx4 v7, s[12:15], s24 offen offset:1024 lds
  v_mfma_f32_16x16x32_bf16 v[60:63], a[92:95], a[164:167], v[60:63]
  v_mfma_f32_16x16x32_bf16 v[60:63], a[88:91], a[160:163], v[60:63]
  s_waitcnt lgkmcnt(8)
  ds_read_b64_tr_b16 a[120:121], v15 offset:32768
  ds_read_b64_tr_b16 a[122:123], v15 offset:34816
  v_mfma_f32_16x16x32_bf16 v[64:67], a[32:35], a[168:171], v[64:67]
  v_mfma_f32_16x16x32_bf16 v[64:67], a[36:39], a[172:175], v[64:67]
  ds_read_b128 a[184:187], v10 offset:6144
  ds_read_b128 a[188:191], v11 offset:6144
  v_mfma_f32_16x16x32_bf16 v[68:71], a[44:47], a[172:175], v[68:71]
  v_mfma_f32_16x16x32_bf16 v[68:71], a[40:43], a[168:171], v[68:71]
  ds_read_b64_tr_b16 a[128:129], v16 offset:32768
  ds_read_b64_tr_b16 a[130:131], v16 offset:34816
  v_mfma_f32_16x16x32_bf16 v[72:75], a[48:51], a[168:171], v[72:75]
  buffer_load_dwordx4 v8, s[12:15], s24 offen offset:2048 lds
  v_mfma_f32_16x16x32_bf16 v[72:75], a[52:55], a[172:175], v[72:75]
  v_mfma_f32_16x16x32_bf16 v[76:79], a[60:63], a[172:175], v[76:79]
  v_mfma_f32_16x16x32_bf16 v[76:79], a[56:59], a[168:171], v[76:79]
  ds_read_b64_tr_b16 a[136:137], v17 offset:32768
  ds_read_b64_tr_b16 a[138:139], v17 offset:34816
  v_mfma_f32_16x16x32_bf16 v[80:83], a[64:67], a[168:171], v[80:83]
  v_mfma_f32_16x16x32_bf16 v[80:83], a[68:71], a[172:175], v[80:83]
  v_mfma_f32_16x16x32_bf16 v[84:87], a[76:79], a[172:175], v[84:87]
  buffer_load_dwordx4 v9, s[12:15], s24 offen offset:3072 lds
  v_mfma_f32_16x16x32_bf16 v[84:87], a[72:75], a[168:171], v[84:87]
  ds_read_b64_tr_b16 a[144:145], v18 offset:32768
  ds_read_b64_tr_b16 a[146:147], v18 offset:34816
  v_mfma_f32_16x16x32_bf16 v[88:91], a[80:83], a[168:171], v[88:91]
  v_mfma_f32_16x16x32_bf16 v[88:91], a[84:87], a[172:175], v[88:91]
  v_mfma_f32_16x16x32_bf16 v[92:95], a[92:95], a[172:175], v[92:95]
  v_mfma_f32_16x16x32_bf16 v[92:95], a[88:91], a[168:171], v[92:95]
  s_waitcnt lgkmcnt(15)
  ds_read_b64_tr_b16 a[152:153], v19 offset:32768
  ds_read_b64_tr_b16 a[154:155], v19 offset:34816
  v_mfma_f32_16x16x32_bf16 v[96:99], a[32:35], a[176:179], v[96:99]
  s_add_u32 s24, s24, 262144
  s_cmp_eq_u32 s24, s27
  s_cselect_b32 s24, s28, s24
  s_cselect_b64 s[12:13], s[64:65], s[12:13]
  v_mfma_f32_16x16x32_bf16 v[96:99], a[36:39], a[180:183], v[96:99]
  v_mfma_f32_16x16x32_bf16 v[100:103], a[44:47], a[180:183], v[100:103]
  v_mfma_f32_16x16x32_bf16 v[100:103], a[40:43], a[176:179], v[100:103]
  v_mfma_f32_16x16x32_bf16 v[104:107], a[48:51], a[176:179], v[104:107]
  v_mfma_f32_16x16x32_bf16 v[104:107], a[52:55], a[180:183], v[104:107]
  v_mfma_f32_16x16x32_bf16 v[108:111], a[60:63], a[180:183], v[108:111]
  v_mfma_f32_16x16x32_bf16 v[108:111], a[56:59], a[176:179], v[108:111]
  s_waitcnt vmcnt(17) lgkmcnt(0)
  s_barrier
  ds_read_b128 a[160:163], v10 offset:16384
  ds_read_b128 a[164:167], v11 offset:16384
  v_mfma_f32_16x16x32_bf16 v[112:115], a[64:67], a[176:179], v[112:115]
  s_add_u32 m0, s29, 0
  s_nop 0
  buffer_load_dwordx4 v2, s[8:11], s23 offen offset:0 lds
  v_mfma_f32_16x16x32_bf16 v[112:115], a[68:71], a[180:183], v[112:115]
  v_mfma_f32_16x16x32_bf16 v[116:119], a[76:79], a[180:183], v[116:119]
  v_mfma_f32_16x16x32_bf16 v[116:119], a[72:75], a[176:179], v[116:119]
  ds_read_b64_tr_b16 a[100:101], v12 offset:49152
  ds_read_b64_tr_b16 a[102:103], v12 offset:51200
  v_mfma_f32_16x16x32_bf16 v[120:123], a[80:83], a[176:179], v[120:123]
  v_mfma_f32_16x16x32_bf16 v[120:123], a[84:87], a[180:183], v[120:123]
  v_mfma_f32_16x16x32_bf16 v[124:127], a[92:95], a[180:183], v[124:127]
  buffer_load_dwordx4 v3, s[8:11], s23 offen offset:1024 lds
  v_mfma_f32_16x16x32_bf16 v[124:127], a[88:91], a[176:179], v[124:127]
  v_mfma_f32_16x16x32_bf16 v[128:131], a[32:35], a[184:187], v[128:131]
  v_mfma_f32_16x16x32_bf16 v[128:131], a[36:39], a[188:191], v[128:131]
  ds_read_b128 a[168:171], v10 offset:18432
  ds_read_b128 a[172:175], v11 offset:18432
  ds_read_b64_tr_b16 a[108:109], v13 offset:49152
  ds_read_b64_tr_b16 a[110:111], v13 offset:51200
  v_mfma_f32_16x16x32_bf16 v[132:135], a[44:47], a[188:191], v[132:135]
  v_mfma_f32_16x16x32_bf16 v[132:135], a[40:43], a[184:187], v[132:135]
  v_mfma_f32_16x16x32_bf16 v[136:139], a[48:51], a[184:187], v[136:139]
  v_mfma_f32_16x16x32_bf16 v[136:139], a[52:55], a[188:191], v[136:139]
  buffer_load_dwordx4 v4, s[8:11], s23 offen offset:2048 lds
  v_mfma_f32_16x16x32_bf16 v[140:143], a[60:63], a[188:191], v[140:143]
  v_mfma_f32_16x16x32_bf16 v[140:143], a[56:59], a[184:187], v[140:143]
  ds_read_b64_tr_b16 a[116:117], v14 offset:49152
  ds_read_b64_tr_b16 a[118:119], v14 offset:51200
  v_mfma_f32_16x16x32_bf16 v[144:147], a[64:67], a[184:187], v[144:147]
  v_mfma_f32_16x16x32_bf16 v[144:147], a[68:71], a[188:191], v[144:147]
  v_mfma_f32_16x16x32_bf16 v[148:151], a[76:79], a[188:191], v[148:151]
  v_mfma_f32_16x16x32_bf16 v[148:151], a[72:75], a[184:187], v[148:151]
  v_mfma_f32_16x16x32_bf16 v[152:155], a[80:83], a[184:187], v[152:155]
  buffer_load_dwordx4 v5, s[8:11], s23 offen offset:3072 lds
  v_mfma_f32_16x16x32_bf16 v[152:155], a[84:87], a[188:191], v[152:155]
  ds_read_b64_tr_b16 a[124:125], v15 offset:49152
  ds_read_b64_tr_b16 a[126:127], v15 offset:51200
  v_mfma_f32_16x16x32_bf16 v[156:159], a[92:95], a[188:191], v[156:159]
  v_mfma_f32_16x16x32_bf16 v[156:159], a[88:91], a[184:187], v[156:159]
  s_waitcnt lgkmcnt(10)
  v_mfma_f32_16x16x32_bf16 v[160:163], a[32:35], a[160:163], v[160:163]
  v_mfma_f32_16x16x32_bf16 v[160:163], a[36:39], a[164:167], v[160:163]
  ds_read_b128 a[176:179], v10 offset:20480
  ds_read_b128 a[180:183], v11 offset:20480
  v_mfma_f32_16x16x32_bf16 v[164:167], a[44:47], a[164:167], v[164:167]
  v_mfma_f32_16x16x32_bf16 v[164:167], a[40:43], a[160:163], v[164:167]
  ds_read_b64_tr_b16 a[132:133], v16 offset:49152
  ds_read_b64_tr_b16 a[134:135], v16 offset:51200
  v_mfma_f32_16x16x32_bf16 v[168:171], a[48:51], a[160:163], v[168:171]
  v_mfma_f32_16x16x32_bf16 v[168:171], a[52:55], a[164:167], v[168:171]
  s_add_u32 m0, s29, 98304
  s_nop 0
  buffer_load_dwordx4 v6, s[12:15], s24 offen offset:0 lds
  v_mfma_f32_16x16x32_bf16 v[172:175], a[60:63], a[164:167], v[172:175]
  v_mfma_f32_16x16x32_bf16 v[172:175], a[56:59], a[160:163], v[172:175]
  v_mfma_f32_16x16x32_bf16 v[176:179], a[64:67], a[160:163], v[176:179]
  v_mfma_f32_16x16x32_bf16 v[176:179], a[68:71], a[164:167], v[176:179]
  ds_read_b64_tr_b16 a[140:141], v17 offset:49152
  ds_read_b64_tr_b16 a[142:143], v17 offset:51200
  v_mfma_f32_16x16x32_bf16 v[180:183], a[76:79], a[164:167], v[180:183]
  v_mfma_f32_16x16x32_bf16 v[180:183], a[72:75], a[160:163], v[180:183]
  buffer_load_dwordx4 v7, s[12:15], s24 offen offset:1024 lds
  v_mfma_f32_16x16x32_bf16 v[184:187], a[80:83], a[160:163], v[184:187]
  v_mfma_f32_16x16x32_bf16 v[184:187], a[84:87], a[164:167], v[184:187]
  v_mfma_f32_16x16x32_bf16 v[188:191], a[92:95], a[164:167], v[188:191]
  v_mfma_f32_16x16x32_bf16 v[188:191], a[88:91], a[160:163], v[188:191]
  s_waitcnt lgkmcnt(12)
  ds_read_b64_tr_b16 a[148:149], v18 offset:49152
  ds_read_b64_tr_b16 a[150:151], v18 offset:51200
  v_mfma_f32_16x16x32_bf16 v[192:195], a[32:35], a[168:171], v[192:195]
  v_mfma_f32_16x16x32_bf16 v[192:195], a[36:39], a[172:175], v[192:195]
  ds_read_b128 a[184:187], v10 offset:22528
  ds_read_b128 a[188:191], v11 offset:22528
  v_mfma_f32_16x16x32_bf16 v[196:199], a[44:47], a[172:175], v[196:199]
  v_mfma_f32_16x16x32_bf16 v[196:199], a[40:43], a[168:171], v[196:199]
  buffer_load_dwordx4 v8, s[12:15], s24 offen offset:2048 lds
  v_mfma_f32_16x16x32_bf16 v[200:203], a[48:51], a[168:171], v[200:203]
  v_mfma_f32_16x16x32_bf16 v[200:203], a[52:55], a[172:175], v[200:203]
  ds_read_b64_tr_b16 a[156:157], v19 offset:49152
  ds_read_b64_tr_b16 a[158:159], v19 offset:51200
  v_mfma_f32_16x16x32_bf16 v[204:207], a[60:63], a[172:175], v[204:207]
  v_mfma_f32_16x16x32_bf16 v[204:207], a[56:59], a[168:171], v[204:207]
  v_mfma_f32_16x16x32_bf16 v[208:211], a[64:67], a[168:171], v[208:211]
  v_mfma_f32_16x16x32_bf16 v[208:211], a[68:71], a[172:175], v[208:211]
  buffer_load_dwordx4 v9, s[12:15], s24 offen offset:3072 lds
  v_mfma_f32_16x16x32_bf16 v[212:215], a[76:79], a[172:175], v[212:215]
  v_mfma_f32_16x16x32_bf16 v[212:215], a[72:75], a[168:171], v[212:215]
  v_mfma_f32_16x16x32_bf16 v[216:219], a[80:83], a[168:171], v[216:219]
  v_mfma_f32_16x16x32_bf16 v[216:219], a[84:87], a[172:175], v[216:219]
  v_mfma_f32_16x16x32_bf16 v[220:223], a[92:95], a[172:175], v[220:223]
  s_add_u32 s24, s24, 262144
  v_mfma_f32_16x16x32_bf16 v[220:223], a[88:91], a[168:171], v[220:223]
  s_waitcnt lgkmcnt(10)
  v_mfma_f32_16x16x32_bf16 v[224:227], a[32:35], a[176:179], v[224:227]
  v_mfma_f32_16x16x32_bf16 v[224:227], a[36:39], a[180:183], v[224:227]
  v_mfma_f32_16x16x32_bf16 v[228:231], a[44:47], a[180:183], v[228:231]
  v_mfma_f32_16x16x32_bf16 v[228:231], a[40:43], a[176:179], v[228:231]
  v_mfma_f32_16x16x32_bf16 v[232:235], a[48:51], a[176:179], v[232:235]
  v_mfma_f32_16x16x32_bf16 v[232:235], a[52:55], a[180:183], v[232:235]
  v_mfma_f32_16x16x32_bf16 v[236:239], a[60:63], a[180:183], v[236:239]
  v_mfma_f32_16x16x32_bf16 v[236:239], a[56:59], a[176:179], v[236:239]
  s_waitcnt vmcnt(17) lgkmcnt(0)
  s_barrier
  ds_read_b128 a[160:163], v10 offset:32768
  ds_read_b128 a[164:167], v11 offset:32768
  v_mfma_f32_16x16x32_bf16 v[240:243], a[64:67], a[176:179], v[240:243]
  s_add_u32 m0, s29, 16384
  s_add_u32 s3, s23, s31
  buffer_load_dwordx4 v2, s[8:11], s3 offen offset:0 lds
  v_mfma_f32_16x16x32_bf16 v[240:243], a[68:71], a[180:183], v[240:243]
  v_mfma_f32_16x16x32_bf16 v[244:247], a[76:79], a[180:183], v[244:247]
  v_mfma_f32_16x16x32_bf16 v[244:247], a[72:75], a[176:179], v[244:247]
  v_mfma_f32_16x16x32_bf16 v[248:251], a[80:83], a[176:179], v[248:251]
  v_mfma_f32_16x16x32_bf16 v[248:251], a[84:87], a[180:183], v[248:251]
  buffer_load_dwordx4 v3, s[8:11], s3 offen offset:1024 lds
  v_mfma_f32_16x16x32_bf16 v[252:255], a[92:95], a[180:183], v[252:255]
  v_mfma_f32_16x16x32_bf16 v[252:255], a[88:91], a[176:179], v[252:255]
  v_mfma_f32_16x16x32_bf16 a[0:3], a[32:35], a[184:187], a[0:3]
  v_mfma_f32_16x16x32_bf16 a[0:3], a[36:39], a[188:191], a[0:3]
  ds_read_b128 a[168:171], v10 offset:34816
  ds_read_b128 a[172:175], v11 offset:34816
  v_mfma_f32_16x16x32_bf16 a[4:7], a[44:47], a[188:191], a[4:7]
  v_mfma_f32_16x16x32_bf16 a[4:7], a[40:43], a[184:187], a[4:7]
  v_mfma_f32_16x16x32_bf16 a[8:11], a[48:51], a[184:187], a[8:11]
  buffer_load_dwordx4 v4, s[8:11], s3 offen offset:2048 lds
  v_mfma_f32_16x16x32_bf16 a[8:11], a[52:55], a[188:191], a[8:11]
  v_mfma_f32_16x16x32_bf16 a[12:15], a[60:63], a[188:191], a[12:15]
  v_mfma_f32_16x16x32_bf16 a[12:15], a[56:59], a[184:187], a[12:15]
  v_mfma_f32_16x16x32_bf16 a[16:19], a[64:67], a[184:187], a[16:19]
  v_mfma_f32_16x16x32_bf16 a[16:19], a[68:71], a[188:191], a[16:19]
  buffer_load_dwordx4 v5, s[8:11], s3 offen offset:3072 lds
  v_mfma_f32_16x16x32_bf16 a[20:23], a[76:79], a[188:191], a[20:23]
  v_mfma_f32_16x16x32_bf16 a[20:23], a[72:75], a[184:187], a[20:23]
  v_mfma_f32_16x16x32_bf16 a[24:27], a[80:83], a[184:187], a[24:27]
  v_mfma_f32_16x16x32_bf16 a[24:27], a[84:87], a[188:191], a[24:27]
  v_mfma_f32_16x16x32_bf16 a[28:31], a[92:95], a[188:191], a[28:31]
  v_mfma_f32_16x16x32_bf16 a[28:31], a[88:91], a[184:187], a[28:31]
  s_waitcnt lgkmcnt(2)
  v_mfma_f32_16x16x32_bf16 v[32:35], a[96:99], a[160:163], v[32:35]
  s_add_u32 s23, s23, 128
  s_cmp_eq_u32 s23, s25
  s_cselect_b32 s23, s26, s23
  v_mfma_f32_16x16x32_bf16 v[32:35], a[100:103], a[164:167], v[32:35]
  ds_read_b128 a[176:179], v10 offset:36864
  ds_read_b128 a[180:183], v11 offset:36864
  v_mfma_f32_16x16x32_bf16 v[36:39], a[108:111], a[164:167], v[36:39]
  v_mfma_f32_16x16x32_bf16 v[36:39], a[104:107], a[160:163], v[36:39]
  ds_read_b64_tr_b16 a[32:33], v12 offset:0
  ds_read_b64_tr_b16 a[34:35], v12 offset:2048
  v_mfma_f32_16x16x32_bf16 v[40:43], a[112:115], a[160:163], v[40:43]
  v_mfma_f32_16x16x32_bf16 v[40:43], a[116:119], a[164:167], v[40:43]
  v_mfma_f32_16x16x32_bf16 v[44:47], a[124:127], a[164:167], v[44:47]
  s_add_u32 m0, s29, 114688
  s_nop 0
  buffer_load_dwordx4 v6, s[12:15], s24 offen offset:0 lds
  v_mfma_f32_16x16x32_bf16 v[44:47], a[120:123], a[160:163], v[44:47]
  ds_read_b64_tr_b16 a[40:41], v13 offset:0
  ds_read_b64_tr_b16 a[42:43], v13 offset:2048
  v_mfma_f32_16x16x32_bf16 v[48:51], a[128:131], a[160:163], v[48:51]
  v_mfma_f32_16x16x32_bf16 v[48:51], a[132:135], a[164:167], v[48:51]
  v_mfma_f32_16x16x32_bf16 v[52:55], a[140:143], a[164:167], v[52:55]
  v_mfma_f32_16x16x32_bf16 v[52:55], a[136:139], a[160:163], v[52:55]
  ds_read_b64_tr_b16 a[48:49], v14 offset:0
  ds_read_b64_tr_b16 a[50:51], v14 offset:2048
  v_mfma_f32_16x16x32_bf16 v[56:59], a[144:147], a[160:163], v[56:59]
  v_mfma_f32_16x16x32_bf16 v[56:59], a[148:151], a[164:167], v[56:59]
  buffer_load_dwordx4 v7, s[12:15], s24 offen offset:1024 lds
  v_mfma_f32_16x16x32_bf16 v[60:63], a[156:159], a[164:167], v[60:63]
  v_mfma_f32_16x16x32_bf16 v[60:63], a[152:155], a[160:163], v[60:63]
  s_waitcnt lgkmcnt(8)
  ds_read_b64_tr_b16 a[56:57], v15 offset:0
  ds_read_b64_tr_b16 a[58:59], v15 offset:2048
  v_mfma_f32_16x16x32_bf16 v[64:67], a[96:99], a[168:171], v[64:67]
  v_mfma_f32_16x16x32_bf16 v[64:67], a[100:103], a[172:175], v[64:67]
  ds_read_b128 a[184:187], v10 offset:38912
  ds_read_b128 a[188:191], v11 offset:38912
  v_mfma_f32_16x16x32_bf16 v[68:71], a[108:111], a[172:175], v[68:71]
  v_mfma_f32_16x16x32_bf16 v[68:71], a[104:107], a[168:171], v[68:71]
  ds_read_b64_tr_b16 a[64:65], v16 offset:0
  ds_read_b64_tr_b16 a[66:67], v16 offset:2048
  v_mfma_f32_16x16x32_bf16 v[72:75], a[112:115], a[168:171], v[72:75]
  buffer_load_dwordx4 v8, s[12:15], s24 offen offset:2048 lds
  v_mfma_f32_16x16x32_bf16 v[72:75], a[116:119], a[172:175], v[72:75]
  v_mfma_f32_16x16x32_bf16 v[76:79], a[124:127], a[172:175], v[76:79]
  v_mfma_f32_16x16x32_bf16 v[76:79], a[120:123], a[168:171], v[76:79]
  ds_read_b64_tr_b16 a[72:73], v17 offset:0
  ds_read_b64_tr_b16 a[74:75], v17 offset:2048
  v_mfma_f32_16x16x32_bf16 v[80:83], a[128:131], a[168:171], v[80:83]
  v_mfma_f32_16x16x32_bf16 v[80:83], a[132:135], a[172:175], v[80:83]
  v_mfma_f32_16x16x32_bf16 v[84:87], a[140:143], a[172:175], v[84:87]
  buffer_load_dwordx4 v9, s[12:15], s24 offen offset:3072 lds
  v_mfma_f32_16x16x32_bf16 v[84:87], a[136:139], a[168:171], v[84:87]
  ds_read_b64_tr_b16 a[80:81], v18 offset:0
  ds_read_b64_tr_b16 a[82:83], v18 offset:2048
  v_mfma_f32_16x16x32_bf16 v[88:91], a[144:147], a[168:171], v[88:91]
  v_mfma_f32_16x16x32_bf16 v[88:91], a[148:151], a[172:175], v[88:91]
  v_mfma_f32_16x16x32_bf16 v[92:95], a[156:159], a[172:175], v[92:95]
  v_mfma_f32_16x16x32_bf16 v[92:95], a[152:155], a[168:171], v[92:95]
  s_waitcnt lgkmcnt(15)
  ds_read_b64_tr_b16 a[88:89], v19 offset:0
  ds_read_b64_tr_b16 a[90:91], v19 offset:2048
  v_mfma_f32_16x16x32_bf16 v[96:99], a[96:99], a[176:179], v[96:99]
  s_add_u32 s24, s24, 262144
  s_cmp_eq_u32 s24, s27
  s_cselect_b32 s24, s28, s24
  s_cselect_b64 s[12:13], s[64:65], s[12:13]
  v_mfma_f32_16x16x32_bf16 v[96:99], a[100:103], a[180:183], v[96:99]
  v_mfma_f32_16x16x32_bf16 v[100:103], a[108:111], a[180:183], v[100:103]
  v_mfma_f32_16x16x32_bf16 v[100:103], a[104:107], a[176:179], v[100:103]
  v_mfma_f32_16x16x32_bf16 v[104:107], a[112:115], a[176:179], v[104:107]
  v_mfma_f32_16x16x32_bf16 v[104:107], a[116:119], a[180:183], v[104:107]
  v_mfma_f32_16x16x32_bf16 v[108:111], a[124:127], a[180:183], v[108:111]
  v_mfma_f32_16x16x32_bf16 v[108:111], a[120:123], a[176:179], v[108:111]
  s_waitcnt vmcnt(16) lgkmcnt(0)
  s_barrier
  ds_read_b128 a[160:163], v10 offset:49152
  ds_read_b128 a[164:167], v11 offset:49152
  v_mfma_f32_16x16x32_bf16 v[112:115], a[128:131], a[176:179], v[112:115]
  s_add_u32 m0, s29, 32768
  s_nop 0
  buffer_load_dwordx4 v2, s[8:11], s23 offen offset:0 lds
  v_mfma_f32_16x16x32_bf16 v[112:115], a[132:135], a[180:183], v[112:115]
  v_mfma_f32_16x16x32_bf16 v[116:119], a[140:143], a[180:183], v[116:119]
  v_mfma_f32_16x16x32_bf16 v[116:119], a[136:139], a[176:179], v[116:119]
  ds_read_b64_tr_b16 a[36:37], v12 offset:16384
  ds_read_b64_tr_b16 a[38:39], v12 offset:18432
  v_mfma_f32_16x16x32_bf16 v[120:123], a[144:147], a[176:179], v[120:123]
  v_mfma_f32_16x16x32_bf16 v[120:123], a[148:151], a[180:183], v[120:123]
  v_mfma_f32_16x16x32_bf16 v[124:127], a[156:159], a[180:183], v[124:127]
  v_mfma_f32_16x16x32_bf16 v[124:127], a[152:155], a[176:179], v[124:127]
  v_mfma_f32_16x16x32_bf16 v[128:131], a[96:99], a[184:187], v[128:131]
  v_mfma_f32_16x16x32_bf16 v[128:131], a[100:103], a[188:191], v[128:131]
  ds_read_b128 a[168:171], v10 offset:51200
  ds_read_b128 a[172:175], v11 offset:51200
  ds_read_b64_tr_b16 a[44:45], v13 offset:16384
  ds_read_b64_tr_b16 a[46:47], v13 offset:18432
  v_mfma_f32_16x16x32_bf16 v[132:135], a[108:111], a[188:191], v[132:135]
  v_mfma_f32_16x16x32_bf16 v[132:135], a[104:107], a[184:187], v[132:135]
  v_mfma_f32_16x16x32_bf16 v[136:139], a[112:115], a[184:187], v[136:139]
  v_mfma_f32_16x16x32_bf16 v[136:139], a[116:119], a[188:191], v[136:139]
  v_mfma_f32_16x16x32_bf16 v[140:143], a[124:127], a[188:191], v[140:143]
  v_mfma_f32_16x16x32_bf16 v[140:143], a[120:123], a[184:187], v[140:143]
  ds_read_b64_tr_b16 a[52:53], v14 offset:16384
  ds_read_b64_tr_b16 a[54:55], v14 offset:18432
  v_mfma_f32_16x16x32_bf16 v[144:147], a[128:131], a[184:187], v[144:147]
  buffer_load_dwordx4 v3, s[8:11], s23 offen offset:1024 lds
  v_mfma_f32_16x16x32_bf16 v[144:147], a[132:135], a[188:191], v[144:147]
  v_mfma_f32_16x16x32_bf16 v[148:151], a[140:143], a[188:191], v[148:151]
  v_mfma_f32_16x16x32_bf16 v[148:151], a[136:139], a[184:187], v[148:151]
  v_mfma_f32_16x16x32_bf16 v[152:155], a[144:147], a[184:187], v[152:155]
  v_mfma_f32_16x16x32_bf16 v[152:155], a[148:151], a[188:191], v[152:155]
  ds_read_b64_tr_b16 a[60:61], v15 offset:16384
  ds_read_b64_tr_b16 a[62:63], v15 offset:18432
  v_mfma_f32_16x16x32_bf16 v[156:159], a[156:159], a[188:191], v[156:159]
  v_mfma_f32_16x16x32_bf16 v[156:159], a[152:155], a[184:187], v[156:159]
  s_waitcnt lgkmcnt(10)
  v_mfma_f32_16x16x32_bf16 v[160:163], a[96:99], a[160:163], v[160:163]
  v_mfma_f32_16x16x32_bf16 v[160:163], a[100:103], a[164:167], v[160:163]
  ds_read_b128 a[176:179], v10 offset:53248
  ds_read_b128 a[180:183], v11 offset:53248
  v_mfma_f32_16x16x32_bf16 v[164:167], a[108:111], a[164:167], v[164:167]
  v_mfma_f32_16x16x32_bf16 v[164:167], a[104:107], a[160:163], v[164:167]
  ds_read_b64_tr_b16 a[68:69], v16 offset:16384
  ds_read_b64_tr_b16 a[70:71], v16 offset:18432
  v_mfma_f32_16x16x32_bf16 v[168:171], a[112:115], a[160:163], v[168:171]
  v_mfma_f32_16x16x32_bf16 v[168:171], a[116:119], a[164:167], v[168:171]
  v_mfma_f32_16x16x32_bf16 v[172:175], a[124:127], a[164:167], v[172:175]
  v_mfma_f32_16x16x32_bf16 v[172:175], a[120:123], a[160:163], v[172:175]
  v_mfma_f32_16x16x32_bf16 v[176:179], a[128:131], a[160:163], v[176:179]
  buffer_load_dwordx4 v4, s[8:11], s23 offen offset:2048 lds
  v_mfma_f32_16x16x32_bf16 v[176:179], a[132:135], a[164:167], v[176:179]
  ds_read_b64_tr_b16 a[76:77], v17 offset:16384
  ds_read_b64_tr_b16 a[78:79], v17 offset:18432
  v_mfma_f32_16x16x32_bf16 v[180:183], a[140:143], a[164:167], v[180:183]
  v_mfma_f32_16x16x32_bf16 v[180:183], a[136:139], a[160:163], v[180:183]
  v_mfma_f32_16x16x32_bf16 v[184:187], a[144:147], a[160:163], v[184:187]
  v_mfma_f32_16x16x32_bf16 v[184:187], a[148:151], a[164:167], v[184:187]
  v_mfma_f32_16x16x32_bf16 v[188:191], a[156:159], a[164:167], v[188:191]
  v_mfma_f32_16x16x32_bf16 v[188:191], a[152:155], a[160:163], v[188:191]
  s_waitcnt lgkmcnt(12)
  ds_read_b64_tr_b16 a[84:85], v18 offset:16384
  ds_read_b64_tr_b16 a[86:87], v18 offset:18432
  v_mfma_f32_16x16x32_bf16 v[192:195], a[96:99], a[168:171], v[192:195]
  v_mfma_f32_16x16x32_bf16 v[192:195], a[100:103], a[172:175], v[192:195]
  ds_read_b128 a[184:187], v10 offset:55296
  ds_read_b128 a[188:191], v11 offset:55296
  v_mfma_f32_16x16x32_bf16 v[196:199], a[108:111], a[172:175], v[196:199]
  v_mfma_f32_16x16x32_bf16 v[196:199], a[104:107], a[168:171], v[196:199]
  v_mfma_f32_16x16x32_bf16 v[200:203], a[112:115], a[168:171], v[200:203]
  v_mfma_f32_16x16x32_bf16 v[200:203], a[116:119], a[172:175], v[200:203]
  ds_read_b64_tr_b16 a[92:93], v19 offset:16384
  ds_read_b64_tr_b16 a[94:95], v19 offset:18432
  v_mfma_f32_16x16x32_bf16 v[204:207], a[124:127], a[172:175], v[204:207]
  v_mfma_f32_16x16x32_bf16 v[204:207], a[120:123], a[168:171], v[204:207]
  v_mfma_f32_16x16x32_bf16 v[208:211], a[128:131], a[168:171], v[208:211]
  buffer_load_dwordx4 v5, s[8:11], s23 offen offset:3072 lds
  v_mfma_f32_16x16x32_bf16 v[208:211], a[132:135], a[172:175], v[208:211]
  v_mfma_f32_16x16x32_bf16 v[212:215], a[140:143], a[172:175], v[212:215]
  v_mfma_f32_16x16x32_bf16 v[212:215], a[136:139], a[168:171], v[212:215]
  v_mfma_f32_16x16x32_bf16 v[216:219], a[144:147], a[168:171], v[216:219]
  v_mfma_f32_16x16x32_bf16 v[216:219], a[148:151], a[172:175], v[216:219]
  v_mfma_f32_16x16x32_bf16 v[220:223], a[156:159], a[172:175], v[220:223]
  v_mfma_f32_16x16x32_bf16 v[220:223], a[152:155], a[168:171], v[220:223]
  s_waitcnt lgkmcnt(10)
  v_mfma_f32_16x16x32_bf16 v[224:227], a[96:99], a[176:179], v[224:227]
  v_mfma_f32_16x16x32_bf16 v[224:227], a[100:103], a[180:183], v[224:227]
  v_mfma_f32_16x16x32_bf16 v[228:231], a[108:111], a[180:183], v[228:231]
  v_mfma_f32_16x16x32_bf16 v[228:231], a[104:107], a[176:179], v[228:231]
  v_mfma_f32_16x16x32_bf16 v[232:235], a[112:115], a[176:179], v[232:235]
  v_mfma_f32_16x16x32_bf16 v[232:235], a[116:119], a[180:183], v[232:235]
  v_mfma_f32_16x16x32_bf16 v[236:239], a[124:127], a[180:183], v[236:239]
  v_mfma_f32_16x16x32_bf16 v[236:239], a[120:123], a[176:179], v[236:239]
  s_waitcnt vmcnt(12) lgkmcnt(0)
  s_barrier
  ds_read_b128 a[160:163], v10 offset:0
  ds_read_b128 a[164:167], v11 offset:0
  v_mfma_f32_16x16x32_bf16 v[240:243], a[128:131], a[176:179], v[240:243]
  s_add_u32 m0, s29, 49152
  s_add_u32 s3, s23, s31
  buffer_load_dwordx4 v2, s[8:11], s3 offen offset:0 lds
  v_mfma_f32_16x16x32_bf16 v[240:243], a[132:135], a[180:183], v[240:243]
  v_mfma_f32_16x16x32_bf16 v[244:247], a[140:143], a[180:183], v[244:247]
  v_mfma_f32_16x16x32_bf16 v[244:247], a[136:139], a[176:179], v[244:247]
  v_mfma_f32_16x16x32_bf16 v[248:251], a[144:147], a[176:179], v[248:251]
  v_mfma_f32_16x16x32_bf16 v[248:251], a[148:151], a[180:183], v[248:251]
  v_mfma_f32_16x16x32_bf16 v[252:255], a[156:159], a[180:183], v[252:255]
  v_mfma_f32_16x16x32_bf16 v[252:255], a[152:155], a[176:179], v[252:255]
  v_mfma_f32_16x16x32_bf16 a[0:3], a[96:99], a[184:187], a[0:3]
  v_mfma_f32_16x16x32_bf16 a[0:3], a[100:103], a[188:191], a[0:3]
  ds_read_b128 a[168:171], v10 offset:2048
  ds_read_b128 a[172:175], v11 offset:2048
  v_mfma_f32_16x16x32_bf16 a[4:7], a[108:111], a[188:191], a[4:7]
  v_mfma_f32_16x16x32_bf16 a[4:7], a[104:107], a[184:187], a[4:7]
  v_mfma_f32_16x16x32_bf16 a[8:11], a[112:115], a[184:187], a[8:11]
  buffer_load_dwordx4 v3, s[8:11], s3 offen offset:1024 lds
  v_mfma_f32_16x16x32_bf16 a[8:11], a[116:119], a[188:191], a[8:11]
  v_mfma_f32_16x16x32_bf16 a[12:15], a[124:127], a[188:191], a[12:15]
  v_mfma_f32_16x16x32_bf16 a[12:15], a[120:123], a[184:187], a[12:15]
  v_mfma_f32_16x16x32_bf16 a[16:19], a[128:131], a[184:187], a[16:19]
  v_mfma_f32_16x16x32_bf16 a[16:19], a[132:135], a[188:191], a[16:19]
  v_mfma_f32_16x16x32_bf16 a[20:23], a[140:143], a[188:191], a[20:23]
  v_mfma_f32_16x16x32_bf16 a[20:23], a[136:139], a[184:187], a[20:23]
  v_mfma_f32_16x16x32_bf16 a[24:27], a[144:147], a[184:187], a[24:27]
  v_mfma_f32_16x16x32_bf16 a[24:27], a[148:151], a[188:191], a[24:27]
  v_mfma_f32_16x16x32_bf16 a[28:31], a[156:159], a[188:191], a[28:31]
  v_mfma_f32_16x16x32_bf16 a[28:31], a[152:155], a[184:187], a[28:31]
  s_waitcnt lgkmcnt(2)
  v_mfma_f32_16x16x32_bf16 v[32:35], a[32:35], a[160:163], v[32:35]
  buffer_load_dwordx4 v4, s[8:11], s3 offen offset:2048 lds
  v_mfma_f32_16x16x32_bf16 v[32:35], a[36:39], a[164:167], v[32:35]
  ds_read_b128 a[176:179], v10 offset:4096
  ds_read_b128 a[180:183], v11 offset:4096
  v_mfma_f32_16x16x32_bf16 v[36:39], a[44:47], a[164:167], v[36:39]
  v_mfma_f32_16x16x32_bf16 v[36:39], a[40:43], a[160:163], v[36:39]
  ds_read_b64_tr_b16 a[96:97], v12 offset:32768
  ds_read_b64_tr_b16 a[98:99], v12 offset:34816
  v_mfma_f32_16x16x32_bf16 v[40:43], a[48:51], a[160:163], v[40:43]
  v_mfma_f32_16x16x32_bf16 v[40:43], a[52:55], a[164:167], v[40:43]
  v_mfma_f32_16x16x32_bf16 v[44:47], a[60:63], a[164:167], v[44:47]
  v_mfma_f32_16x16x32_bf16 v[44:47], a[56:59], a[160:163], v[44:47]
  ds_read_b64_tr_b16 a[104:105], v13 offset:32768
  ds_read_b64_tr_b16 a[106:107], v13 offset:34816
  v_mfma_f32_16x16x32_bf16 v[48:51], a[64:67], a[160:163], v[48:51]
  v_mfma_f32_16x16x32_bf16 v[48:51], a[68:71], a[164:167], v[48:51]
  v_mfma_f32_16x16x32_bf16 v[52:55], a[76:79], a[164:167], v[52:55]
  v_mfma_f32_16x16x32_bf16 v[52:55], a[72:75], a[160:163], v[52:55]
  ds_read_b64_tr_b16 a[112:113], v14 offset:32768
  ds_read_b64_tr_b16 a[114:115], v14 offset:34816
  v_mfma_f32_16x16x32_bf16 v[56:59], a[80:83], a[160:163], v[56:59]
  v_mfma_f32_16x16x32_bf16 v[56:59], a[84:87], a[164:167], v[56:59]
  buffer_load_dwordx4 v5, s[8:11], s3 offen offset:3072 lds
  v_mfma_f32_16x16x32_bf16 v[60:63], a[92:95], a[164:167], v[60:63]
  v_mfma_f32_16x16x32_bf16 v[60:63], a[88:91], a[160:163], v[60:63]
  s_waitcnt lgkmcnt(8)
  ds_read_b64_tr_b16 a[120:121], v15 offset:32768
  ds_read_b64_tr_b16 a[122:123], v15 offset:34816
  v_mfma_f32_16x16x32_bf16 v[64:67], a[32:35], a[168:171], v[64:67]
  v_mfma_f32_16x16x32_bf16 v[64:67], a[36:39], a[172:175], v[64:67]
  ds_read_b128 a[184:187], v10 offset:6144
  ds_read_b128 a[188:191], v11 offset:6144
  v_mfma_f32_16x16x32_bf16 v[68:71], a[44:47], a[172:175], v[68:71]
  v_mfma_f32_16x16x32_bf16 v[68:71], a[40:43], a[168:171], v[68:71]
  ds_read_b64_tr_b16 a[128:129], v16 offset:32768
  ds_read_b64_tr_b16 a[130:131], v16 offset:34816
  v_mfma_f32_16x16x32_bf16 v[72:75], a[48:51], a[168:171], v[72:75]
  v_mfma_f32_16x16x32_bf16 v[72:75], a[52:55], a[172:175], v[72:75]
  v_mfma_f32_16x16x32_bf16 v[76:79], a[60:63], a[172:175], v[76:79]
  v_mfma_f32_16x16x32_bf16 v[76:79], a[56:59], a[168:171], v[76:79]
  ds_read_b64_tr_b16 a[136:137], v17 offset:32768
  ds_read_b64_tr_b16 a[138:139], v17 offset:34816
  v_mfma_f32_16x16x32_bf16 v[80:83], a[64:67], a[168:171], v[80:83]
  v_mfma_f32_16x16x32_bf16 v[80:83], a[68:71], a[172:175], v[80:83]
  v_mfma_f32_16x16x32_bf16 v[84:87], a[76:79], a[172:175], v[84:87]
  s_add_u32 s23, s23, 128
  s_cmp_eq_u32 s23, s25
  s_cselect_b32 s23, s26, s23
  v_mfma_f32_16x16x32_bf16 v[84:87], a[72:75], a[168:171], v[84:87]
  ds_read_b64_tr_b16 a[144:145], v18 offset:32768
  ds_read_b64_tr_b16 a[146:147], v18 offset:34816
  v_mfma_f32_16x16x32_bf16 v[88:91], a[80:83], a[168:171], v[88:91]
  v_mfma_f32_16x16x32_bf16 v[88:91], a[84:87], a[172:175], v[88:91]
  v_mfma_f32_16x16x32_bf16 v[92:95], a[92:95], a[172:175], v[92:95]
  v_mfma_f32_16x16x32_bf16 v[92:95], a[88:91], a[168:171], v[92:95]
  s_waitcnt lgkmcnt(15)
  ds_read_b64_tr_b16 a[152:153], v19 offset:32768
  ds_read_b64_tr_b16 a[154:155], v19 offset:34816
  v_mfma_f32_16x16x32_bf16 v[96:99], a[32:35], a[176:179], v[96:99]
  v_mfma_f32_16x16x32_bf16 v[96:99], a[36:39], a[180:183], v[96:99]
  v_mfma_f32_16x16x32_bf16 v[100:103], a[44:47], a[180:183], v[100:103]
  v_mfma_f32_16x16x32_bf16 v[100:103], a[40:43], a[176:179], v[100:103]
  v_mfma_f32_16x16x32_bf16 v[104:107], a[48:51], a[176:179], v[104:107]
  v_mfma_f32_16x16x32_bf16 v[104:107], a[52:55], a[180:183], v[104:107]
  v_mfma_f32_16x16x32_bf16 v[108:111], a[60:63], a[180:183], v[108:111]
  v_mfma_f32_16x16x32_bf16 v[108:111], a[56:59], a[176:179], v[108:111]
  s_waitcnt vmcnt(8) lgkmcnt(0)
  s_barrier
  ds_read_b128 a[160:163], v10 offset:16384
  ds_read_b128 a[164:167], v11 offset:16384
  v_mfma_f32_16x16x32_bf16 v[112:115], a[64:67], a[176:179], v[112:115]
  v_mfma_f32_16x16x32_bf16 v[112:115], a[68:71], a[180:183], v[112:115]
  s_and_b32 s3, s2, 1
  s_lshl_b32 s3, s3, 3
  v_mfma_f32_16x16x32_bf16 v[116:119], a[76:79], a[180:183], v[116:119]
  s_bfe_u32 s4, s2, 0x30003
  s_add_u32 s26, s3, s4
  v_mfma_f32_16x16x32_bf16 v[116:119], a[72:75], a[176:179], v[116:119]
  ds_read_b64_tr_b16 a[100:101], v12 offset:49152
  ds_read_b64_tr_b16 a[102:103], v12 offset:51200
  s_bfe_u32 s3, s2, 0x20001
  s_lshl_b32 s3, s3, 2
  v_mfma_f32_16x16x32_bf16 v[120:123], a[80:83], a[176:179], v[120:123]
  s_lshr_b32 s4, s2, 6
  s_add_u32 s27, s3, s4
  v_mfma_f32_16x16x32_bf16 v[120:123], a[84:87], a[180:183], v[120:123]
  s_lshl_b32 s23, s26, 18
  s_sub_u32 s24, s23, 32768
  v_mfma_f32_16x16x32_bf16 v[124:127], a[92:95], a[180:183], v[124:127]
  s_max_i32 s24, s24, 0
  s_lshl_b32 s25, s27, 7
  v_mfma_f32_16x16x32_bf16 v[124:127], a[88:91], a[176:179], v[124:127]
  s_mov_b64 s[8:9], s[44:45]
  s_mov_b32 s10, 4194304
  v_mfma_f32_16x16x32_bf16 v[128:131], a[32:35], a[184:187], v[128:131]
  s_mov_b64 s[12:13], s[46:47]
  s_mov_b32 s14, 6291456
  v_mfma_f32_16x16x32_bf16 v[128:131], a[36:39], a[188:191], v[128:131]
  ds_read_b128 a[168:171], v10 offset:18432
  ds_read_b128 a[172:175], v11 offset:18432
  ds_read_b64_tr_b16 a[108:109], v13 offset:49152
  ds_read_b64_tr_b16 a[110:111], v13 offset:51200
  s_lshl_b32 s28, s20, 9
  s_mul_i32 s30, s20, 6144
  v_mfma_f32_16x16x32_bf16 v[132:135], a[44:47], a[188:191], v[132:135]
  s_lshl_b32 s3, s20, 5
  v_lshrrev_b32 v24, 3, v0
  v_mfma_f32_16x16x32_bf16 v[132:135], a[40:43], a[184:187], v[132:135]
  v_and_b32 v25, 7, v0
  v_add_u32 v28, s3, v24
  v_mfma_f32_16x16x32_bf16 v[136:139], a[48:51], a[184:187], v[136:139]
  v_add_u32 v26, 0, v28
  v_bfe_u32 v27, v26, 1, 3
  v_mfma_f32_16x16x32_bf16 v[136:139], a[52:55], a[188:191], v[136:139]
  v_xor_b32 v27, v27, v25
  v_lshlrev_b32 v26, 11, v26
  v_mfma_f32_16x16x32_bf16 v[140:143], a[60:63], a[188:191], v[140:143]
  v_lshl_add_u32 v26, v27, 4, v26
  v_subrev_u32 v2, 0, v26
  v_mfma_f32_16x16x32_bf16 v[140:143], a[56:59], a[184:187], v[140:143]
  ds_read_b64_tr_b16 a[116:117], v14 offset:49152
  ds_read_b64_tr_b16 a[118:119], v14 offset:51200
  v_add_u32 v26, 8, v28
  v_bfe_u32 v27, v26, 1, 3
  v_mfma_f32_16x16x32_bf16 v[144:147], a[64:67], a[184:187], v[144:147]
  v_xor_b32 v27, v27, v25
  v_lshlrev_b32 v26, 11, v26
  v_mfma_f32_16x16x32_bf16 v[144:147], a[68:71], a[188:191], v[144:147]
  v_lshl_add_u32 v26, v27, 4, v26
  v_subrev_u32 v3, 1024, v26
  v_mfma_f32_16x16x32_bf16 v[148:151], a[76:79], a[188:191], v[148:151]
  v_add_u32 v26, 16, v28
  v_bfe_u32 v27, v26, 1, 3
  v_mfma_f32_16x16x32_bf16 v[148:151], a[72:75], a[184:187], v[148:151]
  v_xor_b32 v27, v27, v25
  v_lshlrev_b32 v26, 11, v26
  v_mfma_f32_16x16x32_bf16 v[152:155], a[80:83], a[184:187], v[152:155]
  v_lshl_add_u32 v26, v27, 4, v26
  v_subrev_u32 v4, 2048, v26
  v_mfma_f32_16x16x32_bf16 v[152:155], a[84:87], a[188:191], v[152:155]
  ds_read_b64_tr_b16 a[124:125], v15 offset:49152
  ds_read_b64_tr_b16 a[126:127], v15 offset:51200
  v_add_u32 v26, 24, v28
  v_bfe_u32 v27, v26, 1, 3
  v_mfma_f32_16x16x32_bf16 v[156:159], a[92:95], a[188:191], v[156:159]
  v_xor_b32 v27, v27, v25
  v_lshlrev_b32 v26, 11, v26
  v_mfma_f32_16x16x32_bf16 v[156:159], a[88:91], a[184:187], v[156:159]
  s_waitcnt lgkmcnt(10)
  v_lshl_add_u32 v26, v27, 4, v26
  v_subrev_u32 v5, 3072, v26
  v_mfma_f32_16x16x32_bf16 v[160:163], a[32:35], a[160:163], v[160:163]
  s_lshl_b32 s3, s20, 2
  v_add_u32 v26, s3, v24
  v_mfma_f32_16x16x32_bf16 v[160:163], a[36:39], a[164:167], v[160:163]
  ds_read_b128 a[176:179], v10 offset:20480
  ds_read_b128 a[180:183], v11 offset:20480
  v_bfe_u32 v27, v26, 1, 3
  v_xor_b32 v27, v27, v25
  v_mfma_f32_16x16x32_bf16 v[164:167], a[44:47], a[164:167], v[164:167]
  v_lshlrev_b32 v26, 11, v26
  v_lshl_add_u32 v20, v27, 4, v26
  v_mfma_f32_16x16x32_bf16 v[164:167], a[40:43], a[160:163], v[164:167]
  ds_read_b64_tr_b16 a[132:133], v16 offset:49152
  ds_read_b64_tr_b16 a[134:135], v16 offset:51200
  s_mul_i32 s3, s20, 48
  v_add_u32 v28, s3, v24
  v_mfma_f32_16x16x32_bf16 v[168:171], a[48:51], a[160:163], v[168:171]
  v_add_u32 v26, 0, v28
  v_mul_u32_u24 v27, 0xaaab, v26
  v_mfma_f32_16x16x32_bf16 v[168:171], a[52:55], a[164:167], v[168:171]
  v_lshrrev_b32 v27, 17, v27
  v_mfma_f32_16x16x32_bf16 v[172:175], a[60:63], a[164:167], v[172:175]
  v_lshrrev_b32 v29, 1, v27
  v_and_b32 v29, 4, v29
  v_mfma_f32_16x16x32_bf16 v[172:175], a[56:59], a[160:163], v[172:175]
  v_and_or_b32 v27, v27, 2, v29
  v_xor_b32 v27, v27, v25
  v_mfma_f32_16x16x32_bf16 v[176:179], a[64:67], a[160:163], v[176:179]
  v_lshlrev_b32 v26, 11, v26
  v_lshl_add_u32 v26, v27, 4, v26
  v_mfma_f32_16x16x32_bf16 v[176:179], a[68:71], a[164:167], v[176:179]
  ds_read_b64_tr_b16 a[140:141], v17 offset:49152
  ds_read_b64_tr_b16 a[142:143], v17 offset:51200
  v_subrev_u32 v6, 0, v26
  v_add_u32 v26, 8, v28
  v_mfma_f32_16x16x32_bf16 v[180:183], a[76:79], a[164:167], v[180:183]
  v_mul_u32_u24 v27, 0xaaab, v26
  v_lshrrev_b32 v27, 17, v27
  v_mfma_f32_16x16x32_bf16 v[180:183], a[72:75], a[160:163], v[180:183]
  v_lshrrev_b32 v29, 1, v27
  v_and_b32 v29, 4, v29
  v_mfma_f32_16x16x32_bf16 v[184:187], a[80:83], a[160:163], v[184:187]
  v_and_or_b32 v27, v27, 2, v29
  v_xor_b32 v27, v27, v25
  v_mfma_f32_16x16x32_bf16 v[184:187], a[84:87], a[164:167], v[184:187]
  v_lshlrev_b32 v26, 11, v26
  v_lshl_add_u32 v26, v27, 4, v26
  v_mfma_f32_16x16x32_bf16 v[188:191], a[92:95], a[164:167], v[188:191]
  v_subrev_u32 v7, 1024, v26
  v_add_u32 v26, 16, v28
  v_mfma_f32_16x16x32_bf16 v[188:191], a[88:91], a[160:163], v[188:191]
  s_waitcnt lgkmcnt(12)
  ds_read_b64_tr_b16 a[148:149], v18 offset:49152
  ds_read_b64_tr_b16 a[150:151], v18 offset:51200
  v_mul_u32_u24 v27, 0xaaab, v26
  v_lshrrev_b32 v27, 17, v27
  v_mfma_f32_16x16x32_bf16 v[192:195], a[32:35], a[168:171], v[192:195]
  v_lshrrev_b32 v29, 1, v27
  v_and_b32 v29, 4, v29
  v_mfma_f32_16x16x32_bf16 v[192:195], a[36:39], a[172:175], v[192:195]
  ds_read_b128 a[184:187], v10 offset:22528
  ds_read_b128 a[188:191], v11 offset:22528
  v_and_or_b32 v27, v27, 2, v29
  v_xor_b32 v27, v27, v25
  v_mfma_f32_16x16x32_bf16 v[196:199], a[44:47], a[172:175], v[196:199]
  v_lshlrev_b32 v26, 11, v26
  v_lshl_add_u32 v26, v27, 4, v26
  v_mfma_f32_16x16x32_bf16 v[196:199], a[40:43], a[168:171], v[196:199]
  v_subrev_u32 v8, 2048, v26
  v_add_u32 v26, 24, v28
  v_mfma_f32_16x16x32_bf16 v[200:203], a[48:51], a[168:171], v[200:203]
  v_mul_u32_u24 v27, 0xaaab, v26
  v_lshrrev_b32 v27, 17, v27
  v_mfma_f32_16x16x32_bf16 v[200:203], a[52:55], a[172:175], v[200:203]
  ds_read_b64_tr_b16 a[156:157], v19 offset:49152
  ds_read_b64_tr_b16 a[158:159], v19 offset:51200
  v_lshrrev_b32 v29, 1, v27
  v_and_b32 v29, 4, v29
  v_mfma_f32_16x16x32_bf16 v[204:207], a[60:63], a[172:175], v[204:207]
  v_and_or_b32 v27, v27, 2, v29
  v_xor_b32 v27, v27, v25
  v_mfma_f32_16x16x32_bf16 v[204:207], a[56:59], a[168:171], v[204:207]
  v_lshlrev_b32 v26, 11, v26
  v_lshl_add_u32 v26, v27, 4, v26
  v_mfma_f32_16x16x32_bf16 v[208:211], a[64:67], a[168:171], v[208:211]
  v_subrev_u32 v9, 3072, v26
  v_add_u32 v26, 32, v28
  v_mfma_f32_16x16x32_bf16 v[208:211], a[68:71], a[172:175], v[208:211]
  v_mul_u32_u24 v27, 0xaaab, v26
  v_lshrrev_b32 v27, 17, v27
  v_mfma_f32_16x16x32_bf16 v[212:215], a[76:79], a[172:175], v[212:215]
  v_lshrrev_b32 v29, 1, v27
  v_and_b32 v29, 4, v29
  v_mfma_f32_16x16x32_bf16 v[212:215], a[72:75], a[168:171], v[212:215]
  v_and_or_b32 v27, v27, 2, v29
  v_xor_b32 v27, v27, v25
  v_mfma_f32_16x16x32_bf16 v[216:219], a[80:83], a[168:171], v[216:219]
  v_lshlrev_b32 v26, 11, v26
  v_lshl_add_u32 v26, v27, 4, v26
  v_mfma_f32_16x16x32_bf16 v[216:219], a[84:87], a[172:175], v[216:219]
  v_subrev_u32 v21, 0, v26
  v_add_u32 v26, 40, v28
  v_mfma_f32_16x16x32_bf16 v[220:223], a[92:95], a[172:175], v[220:223]
  v_mul_u32_u24 v27, 0xaaab, v26
  v_lshrrev_b32 v27, 17, v27
  v_mfma_f32_16x16x32_bf16 v[220:223], a[88:91], a[168:171], v[220:223]
  s_waitcnt lgkmcnt(10)
  v_lshrrev_b32 v29, 1, v27
  v_and_b32 v29, 4, v29
  v_mfma_f32_16x16x32_bf16 v[224:227], a[32:35], a[176:179], v[224:227]
  v_and_or_b32 v27, v27, 2, v29
  v_xor_b32 v27, v27, v25
  v_mfma_f32_16x16x32_bf16 v[224:227], a[36:39], a[180:183], v[224:227]
  v_lshlrev_b32 v26, 11, v26
  v_lshl_add_u32 v26, v27, 4, v26
  v_mfma_f32_16x16x32_bf16 v[228:231], a[44:47], a[180:183], v[228:231]
  v_subrev_u32 v22, 1024, v26
  v_mfma_f32_16x16x32_bf16 v[228:231], a[40:43], a[176:179], v[228:231]
  v_mfma_f32_16x16x32_bf16 v[232:235], a[48:51], a[176:179], v[232:235]
  v_mfma_f32_16x16x32_bf16 v[232:235], a[52:55], a[180:183], v[232:235]
  v_mfma_f32_16x16x32_bf16 v[236:239], a[60:63], a[180:183], v[236:239]
  v_mfma_f32_16x16x32_bf16 v[236:239], a[56:59], a[176:179], v[236:239]
  s_waitcnt vmcnt(4) lgkmcnt(0)
  s_barrier
  ds_read_b128 a[160:163], v10 offset:32768
  ds_read_b128 a[164:167], v11 offset:32768
  v_mfma_f32_16x16x32_bf16 v[240:243], a[64:67], a[176:179], v[240:243]
  s_add_u32 m0, s28, 131072
  s_mov_b32 exec_hi, 0
  buffer_load_dwordx4 v20, s[8:11], s24 offen lds
  s_mov_b32 exec_hi, -1
  v_mfma_f32_16x16x32_bf16 v[240:243], a[68:71], a[180:183], v[240:243]
  v_mfma_f32_16x16x32_bf16 v[244:247], a[76:79], a[180:183], v[244:247]
  v_mfma_f32_16x16x32_bf16 v[244:247], a[72:75], a[176:179], v[244:247]
  s_add_u32 m0, s29, 133120
  s_nop 0
  buffer_load_dwordx4 v2, s[8:11], s23 offen offset:0 lds
  v_mfma_f32_16x16x32_bf16 v[248:251], a[80:83], a[176:179], v[248:251]
  v_mfma_f32_16x16x32_bf16 v[248:251], a[84:87], a[180:183], v[248:251]
  v_mfma_f32_16x16x32_bf16 v[252:255], a[92:95], a[180:183], v[252:255]
  v_mfma_f32_16x16x32_bf16 v[252:255], a[88:91], a[176:179], v[252:255]
  v_mfma_f32_16x16x32_bf16 a[0:3], a[32:35], a[184:187], a[0:3]
  buffer_load_dwordx4 v3, s[8:11], s23 offen offset:1024 lds
  v_mfma_f32_16x16x32_bf16 a[0:3], a[36:39], a[188:191], a[0:3]
  ds_read_b128 a[168:171], v10 offset:34816
  ds_read_b128 a[172:175], v11 offset:34816
  v_mfma_f32_16x16x32_bf16 a[4:7], a[44:47], a[188:191], a[4:7]
  v_mfma_f32_16x16x32_bf16 a[4:7], a[40:43], a[184:187], a[4:7]
  v_mfma_f32_16x16x32_bf16 a[8:11], a[48:51], a[184:187], a[8:11]
  buffer_load_dwordx4 v4, s[8:11], s23 offen offset:2048 lds
  v_mfma_f32_16x16x32_bf16 a[8:11], a[52:55], a[188:191], a[8:11]
  v_mfma_f32_16x16x32_bf16 a[12:15], a[60:63], a[188:191], a[12:15]
  v_mfma_f32_16x16x32_bf16 a[12:15], a[56:59], a[184:187], a[12:15]
  v_mfma_f32_16x16x32_bf16 a[16:19], a[64:67], a[184:187], a[16:19]
  buffer_load_dwordx4 v5, s[8:11], s23 offen offset:3072 lds
  v_mfma_f32_16x16x32_bf16 a[16:19], a[68:71], a[188:191], a[16:19]
  v_mfma_f32_16x16x32_bf16 a[20:23], a[76:79], a[188:191], a[20:23]
  v_mfma_f32_16x16x32_bf16 a[20:23], a[72:75], a[184:187], a[20:23]
  s_add_u32 s23, s23, 128
  s_add_u32 s24, s24, 128
  v_mfma_f32_16x16x32_bf16 a[24:27], a[80:83], a[184:187], a[24:27]
  v_mfma_f32_16x16x32_bf16 a[24:27], a[84:87], a[188:191], a[24:27]
  v_mfma_f32_16x16x32_bf16 a[28:31], a[92:95], a[188:191], a[28:31]
  v_mfma_f32_16x16x32_bf16 a[28:31], a[88:91], a[184:187], a[28:31]
  s_waitcnt lgkmcnt(2)
  v_mfma_f32_16x16x32_bf16 v[32:35], a[96:99], a[160:163], v[32:35]
  s_add_u32 m0, s30, 65536
  s_nop 0
  buffer_load_dwordx4 v6, s[12:15], s25 offen offset:0 lds
  v_mfma_f32_16x16x32_bf16 v[32:35], a[100:103], a[164:167], v[32:35]
  ds_read_b128 a[176:179], v10 offset:36864
  ds_read_b128 a[180:183], v11 offset:36864
  v_mfma_f32_16x16x32_bf16 v[36:39], a[108:111], a[164:167], v[36:39]
  v_mfma_f32_16x16x32_bf16 v[36:39], a[104:107], a[160:163], v[36:39]
  v_mfma_f32_16x16x32_bf16 v[40:43], a[112:115], a[160:163], v[40:43]
  v_mfma_f32_16x16x32_bf16 v[40:43], a[116:119], a[164:167], v[40:43]
  buffer_load_dwordx4 v7, s[12:15], s25 offen offset:1024 lds
  v_mfma_f32_16x16x32_bf16 v[44:47], a[124:127], a[164:167], v[44:47]
  v_mfma_f32_16x16x32_bf16 v[44:47], a[120:123], a[160:163], v[44:47]
  v_mfma_f32_16x16x32_bf16 v[48:51], a[128:131], a[160:163], v[48:51]
  v_mfma_f32_16x16x32_bf16 v[48:51], a[132:135], a[164:167], v[48:51]
  v_mfma_f32_16x16x32_bf16 v[52:55], a[140:143], a[164:167], v[52:55]
  buffer_load_dwordx4 v8, s[12:15], s25 offen offset:2048 lds
  v_mfma_f32_16x16x32_bf16 v[52:55], a[136:139], a[160:163], v[52:55]
  v_mfma_f32_16x16x32_bf16 v[56:59], a[144:147], a[160:163], v[56:59]
  v_mfma_f32_16x16x32_bf16 v[56:59], a[148:151], a[164:167], v[56:59]
  v_mfma_f32_16x16x32_bf16 v[60:63], a[156:159], a[164:167], v[60:63]
  v_mfma_f32_16x16x32_bf16 v[60:63], a[152:155], a[160:163], v[60:63]
  s_waitcnt lgkmcnt(2)
  v_mfma_f32_16x16x32_bf16 v[64:67], a[96:99], a[168:171], v[64:67]
  buffer_load_dwordx4 v9, s[12:15], s25 offen offset:3072 lds
  v_mfma_f32_16x16x32_bf16 v[64:67], a[100:103], a[172:175], v[64:67]
  ds_read_b128 a[184:187], v10 offset:38912
  ds_read_b128 a[188:191], v11 offset:38912
  v_mfma_f32_16x16x32_bf16 v[68:71], a[108:111], a[172:175], v[68:71]
  v_mfma_f32_16x16x32_bf16 v[68:71], a[104:107], a[168:171], v[68:71]
  v_mfma_f32_16x16x32_bf16 v[72:75], a[112:115], a[168:171], v[72:75]
  v_mfma_f32_16x16x32_bf16 v[72:75], a[116:119], a[172:175], v[72:75]
  s_add_u32 m0, s30, 69632
  s_nop 0
  buffer_load_dwordx4 v21, s[12:15], s25 offen offset:0 lds
  v_mfma_f32_16x16x32_bf16 v[76:79], a[124:127], a[172:175], v[76:79]
  v_mfma_f32_16x16x32_bf16 v[76:79], a[120:123], a[168:171], v[76:79]
  v_mfma_f32_16x16x32_bf16 v[80:83], a[128:131], a[168:171], v[80:83]
  v_mfma_f32_16x16x32_bf16 v[80:83], a[132:135], a[172:175], v[80:83]
  v_mfma_f32_16x16x32_bf16 v[84:87], a[140:143], a[172:175], v[84:87]
  buffer_load_dwordx4 v22, s[12:15], s25 offen offset:1024 lds
  v_mfma_f32_16x16x32_bf16 v[84:87], a[136:139], a[168:171], v[84:87]
  v_mfma_f32_16x16x32_bf16 v[88:91], a[144:147], a[168:171], v[88:91]
  v_mfma_f32_16x16x32_bf16 v[88:91], a[148:151], a[172:175], v[88:91]
  v_mfma_f32_16x16x32_bf16 v[92:95], a[156:159], a[172:175], v[92:95]
  v_mfma_f32_16x16x32_bf16 v[92:95], a[152:155], a[168:171], v[92:95]
  s_waitcnt lgkmcnt(2)
  v_mfma_f32_16x16x32_bf16 v[96:99], a[96:99], a[176:179], v[96:99]
  s_add_u32 s25, s25, 393216
  v_mfma_f32_16x16x32_bf16 v[96:99], a[100:103], a[180:183], v[96:99]
  v_mfma_f32_16x16x32_bf16 v[100:103], a[108:111], a[180:183], v[100:103]
  v_mfma_f32_16x16x32_bf16 v[100:103], a[104:107], a[176:179], v[100:103]
  v_mfma_f32_16x16x32_bf16 v[104:107], a[112:115], a[176:179], v[104:107]
  v_mfma_f32_16x16x32_bf16 v[104:107], a[116:119], a[180:183], v[104:107]
  v_mfma_f32_16x16x32_bf16 v[108:111], a[124:127], a[180:183], v[108:111]
  v_mfma_f32_16x16x32_bf16 v[108:111], a[120:123], a[176:179], v[108:111]
  s_waitcnt vmcnt(11) lgkmcnt(0)
  s_barrier
  ds_read_b128 a[160:163], v10 offset:49152
  ds_read_b128 a[164:167], v11 offset:49152
  v_mfma_f32_16x16x32_bf16 v[112:115], a[128:131], a[176:179], v[112:115]
  s_add_u32 m0, s28, 0
  s_mov_b32 exec_hi, 0
  buffer_load_dwordx4 v20, s[8:11], s24 offen lds
  s_mov_b32 exec_hi, -1
  v_mfma_f32_16x16x32_bf16 v[112:115], a[132:135], a[180:183], v[112:115]
  v_mfma_f32_16x16x32_bf16 v[116:119], a[140:143], a[180:183], v[116:119]
  v_mfma_f32_16x16x32_bf16 v[116:119], a[136:139], a[176:179], v[116:119]
  v_mfma_f32_16x16x32_bf16 v[120:123], a[144:147], a[176:179], v[120:123]
  s_add_u32 m0, s29, 2048
  s_nop 0
  buffer_load_dwordx4 v2, s[8:11], s23 offen offset:0 lds
  v_mfma_f32_16x16x32_bf16 v[120:123], a[148:151], a[180:183], v[120:123]
  v_mfma_f32_16x16x32_bf16 v[124:127], a[156:159], a[180:183], v[124:127]
  v_mfma_f32_16x16x32_bf16 v[124:127], a[152:155], a[176:179], v[124:127]
  v_mfma_f32_16x16x32_bf16 v[128:131], a[96:99], a[184:187], v[128:131]
  v_mfma_f32_16x16x32_bf16 v[128:131], a[100:103], a[188:191], v[128:131]
  ds_read_b128 a[168:171], v10 offset:51200
  ds_read_b128 a[172:175], v11 offset:51200
  v_mfma_f32_16x16x32_bf16 v[132:135], a[108:111], a[188:191], v[132:135]
  buffer_load_dwordx4 v3, s[8:11], s23 offen offset:1024 lds
  v_mfma_f32_16x16x32_bf16 v[132:135], a[104:107], a[184:187], v[132:135]
  v_mfma_f32_16x16x32_bf16 v[136:139], a[112:115], a[184:187], v[136:139]
  v_mfma_f32_16x16x32_bf16 v[136:139], a[116:119], a[188:191], v[136:139]
  v_mfma_f32_16x16x32_bf16 v[140:143], a[124:127], a[188:191], v[140:143]
  buffer_load_dwordx4 v4, s[8:11], s23 offen offset:2048 lds
  v_mfma_f32_16x16x32_bf16 v[140:143], a[120:123], a[184:187], v[140:143]
  v_mfma_f32_16x16x32_bf16 v[144:147], a[128:131], a[184:187], v[144:147]
  v_mfma_f32_16x16x32_bf16 v[144:147], a[132:135], a[188:191], v[144:147]
  v_mfma_f32_16x16x32_bf16 v[148:151], a[140:143], a[188:191], v[148:151]
  buffer_load_dwordx4 v5, s[8:11], s23 offen offset:3072 lds
  v_mfma_f32_16x16x32_bf16 v[148:151], a[136:139], a[184:187], v[148:151]
  v_mfma_f32_16x16x32_bf16 v[152:155], a[144:147], a[184:187], v[152:155]
  v_mfma_f32_16x16x32_bf16 v[152:155], a[148:151], a[188:191], v[152:155]
  v_mfma_f32_16x16x32_bf16 v[156:159], a[156:159], a[188:191], v[156:159]
  s_add_u32 s23, s23, 128
  s_add_u32 s24, s24, 128
  v_mfma_f32_16x16x32_bf16 v[156:159], a[152:155], a[184:187], v[156:159]
  s_waitcnt lgkmcnt(2)
  v_mfma_f32_16x16x32_bf16 v[160:163], a[96:99], a[160:163], v[160:163]
  v_mfma_f32_16x16x32_bf16 v[160:163], a[100:103], a[164:167], v[160:163]
  ds_read_b128 a[176:179], v10 offset:53248
  ds_read_b128 a[180:183], v11 offset:53248
  v_mfma_f32_16x16x32_bf16 v[164:167], a[108:111], a[164:167], v[164:167]
  v_mfma_f32_16x16x32_bf16 v[164:167], a[104:107], a[160:163], v[164:167]
  v_mfma_f32_16x16x32_bf16 v[168:171], a[112:115], a[160:163], v[168:171]
  s_add_u32 m0, s30, 98304
  s_nop 0
  buffer_load_dwordx4 v6, s[12:15], s25 offen offset:0 lds
  v_mfma_f32_16x16x32_bf16 v[168:171], a[116:119], a[164:167], v[168:171]
  v_mfma_f32_16x16x32_bf16 v[172:175], a[124:127], a[164:167], v[172:175]
  v_mfma_f32_16x16x32_bf16 v[172:175], a[120:123], a[160:163], v[172:175]
  v_mfma_f32_16x16x32_bf16 v[176:179], a[128:131], a[160:163], v[176:179]
  v_mfma_f32_16x16x32_bf16 v[176:179], a[132:135], a[164:167], v[176:179]
  buffer_load_dwordx4 v7, s[12:15], s25 offen offset:1024 lds
  v_mfma_f32_16x16x32_bf16 v[180:183], a[140:143], a[164:167], v[180:183]
  v_mfma_f32_16x16x32_bf16 v[180:183], a[136:139], a[160:163], v[180:183]
  v_mfma_f32_16x16x32_bf16 v[184:187], a[144:147], a[160:163], v[184:187]
  v_mfma_f32_16x16x32_bf16 v[184:187], a[148:151], a[164:167], v[184:187]
  buffer_load_dwordx4 v8, s[12:15], s25 offen offset:2048 lds
  v_mfma_f32_16x16x32_bf16 v[188:191], a[156:159], a[164:167], v[188:191]
  v_mfma_f32_16x16x32_bf16 v[188:191], a[152:155], a[160:163], v[188:191]
  s_waitcnt lgkmcnt(2)
  v_mfma_f32_16x16x32_bf16 v[192:195], a[96:99], a[168:171], v[192:195]
  v_mfma_f32_16x16x32_bf16 v[192:195], a[100:103], a[172:175], v[192:195]
  ds_read_b128 a[184:187], v10 offset:55296
  ds_read_b128 a[188:191], v11 offset:55296
  v_mfma_f32_16x16x32_bf16 v[196:199], a[108:111], a[172:175], v[196:199]
  v_mfma_f32_16x16x32_bf16 v[196:199], a[104:107], a[168:171], v[196:199]
  buffer_load_dwordx4 v9, s[12:15], s25 offen offset:3072 lds
  v_mfma_f32_16x16x32_bf16 v[200:203], a[112:115], a[168:171], v[200:203]
  v_mfma_f32_16x16x32_bf16 v[200:203], a[116:119], a[172:175], v[200:203]
  v_mfma_f32_16x16x32_bf16 v[204:207], a[124:127], a[172:175], v[204:207]
  v_mfma_f32_16x16x32_bf16 v[204:207], a[120:123], a[168:171], v[204:207]
  s_add_u32 m0, s30, 102400
  s_nop 0
  buffer_load_dwordx4 v21, s[12:15], s25 offen offset:0 lds
  v_mfma_f32_16x16x32_bf16 v[208:211], a[128:131], a[168:171], v[208:211]
  v_mfma_f32_16x16x32_bf16 v[208:211], a[132:135], a[172:175], v[208:211]
  v_mfma_f32_16x16x32_bf16 v[212:215], a[140:143], a[172:175], v[212:215]
  v_mfma_f32_16x16x32_bf16 v[212:215], a[136:139], a[168:171], v[212:215]
  buffer_load_dwordx4 v22, s[12:15], s25 offen offset:1024 lds
  v_mfma_f32_16x16x32_bf16 v[216:219], a[144:147], a[168:171], v[216:219]
  v_mfma_f32_16x16x32_bf16 v[216:219], a[148:151], a[172:175], v[216:219]
  v_mfma_f32_16x16x32_bf16 v[220:223], a[156:159], a[172:175], v[220:223]
  v_mfma_f32_16x16x32_bf16 v[220:223], a[152:155], a[168:171], v[220:223]
  s_waitcnt lgkmcnt(2)
  v_mfma_f32_16x16x32_bf16 v[224:227], a[96:99], a[176:179], v[224:227]
  s_add_u32 s25, s25, 393216
  v_mfma_f32_16x16x32_bf16 v[224:227], a[100:103], a[180:183], v[224:227]
  v_mfma_f32_16x16x32_bf16 v[228:231], a[108:111], a[180:183], v[228:231]
  v_mfma_f32_16x16x32_bf16 v[228:231], a[104:107], a[176:179], v[228:231]
  v_mfma_f32_16x16x32_bf16 v[232:235], a[112:115], a[176:179], v[232:235]
  v_mfma_f32_16x16x32_bf16 v[232:235], a[116:119], a[180:183], v[232:235]
  v_mfma_f32_16x16x32_bf16 v[236:239], a[124:127], a[180:183], v[236:239]
  v_mfma_f32_16x16x32_bf16 v[236:239], a[120:123], a[176:179], v[236:239]
  s_waitcnt vmcnt(63) lgkmcnt(0)
  s_barrier
  v_mfma_f32_16x16x32_bf16 v[240:243], a[128:131], a[176:179], v[240:243]
  s_add_u32 m0, s28, 18432
  s_mov_b32 exec_hi, 0
  buffer_load_dwordx4 v20, s[8:11], s24 offen lds
  s_mov_b32 exec_hi, -1
  v_mfma_f32_16x16x32_bf16 v[240:243], a[132:135], a[180:183], v[240:243]
  v_mfma_f32_16x16x32_bf16 v[244:247], a[140:143], a[180:183], v[244:247]
  v_mfma_f32_16x16x32_bf16 v[244:247], a[136:139], a[176:179], v[244:247]
  s_add_u32 m0, s29, 20480
  s_nop 0
  buffer_load_dwordx4 v2, s[8:11], s23 offen offset:0 lds
  v_mfma_f32_16x16x32_bf16 v[248:251], a[144:147], a[176:179], v[248:251]
  v_mfma_f32_16x16x32_bf16 v[248:251], a[148:151], a[180:183], v[248:251]
  v_mfma_f32_16x16x32_bf16 v[252:255], a[156:159], a[180:183], v[252:255]
  v_mfma_f32_16x16x32_bf16 v[252:255], a[152:155], a[176:179], v[252:255]
  v_mfma_f32_16x16x32_bf16 a[0:3], a[96:99], a[184:187], a[0:3]
  buffer_load_dwordx4 v3, s[8:11], s23 offen offset:1024 lds
  v_mfma_f32_16x16x32_bf16 a[0:3], a[100:103], a[188:191], a[0:3]
  v_mfma_f32_16x16x32_bf16 a[4:7], a[108:111], a[188:191], a[4:7]
  v_mfma_f32_16x16x32_bf16 a[4:7], a[104:107], a[184:187], a[4:7]
  v_mfma_f32_16x16x32_bf16 a[8:11], a[112:115], a[184:187], a[8:11]
  buffer_load_dwordx4 v4, s[8:11], s23 offen offset:2048 lds
  v_mfma_f32_16x16x32_bf16 a[8:11], a[116:119], a[188:191], a[8:11]
  v_mfma_f32_16x16x32_bf16 a[12:15], a[124:127], a[188:191], a[12:15]
  v_mfma_f32_16x16x32_bf16 a[12:15], a[120:123], a[184:187], a[12:15]
  buffer_load_dwordx4 v5, s[8:11], s23 offen offset:3072 lds
  v_mfma_f32_16x16x32_bf16 a[16:19], a[128:131], a[184:187], a[16:19]
  v_mfma_f32_16x16x32_bf16 a[16:19], a[132:135], a[188:191], a[16:19]
  v_mfma_f32_16x16x32_bf16 a[20:23], a[140:143], a[188:191], a[20:23]
  v_mfma_f32_16x16x32_bf16 a[20:23], a[136:139], a[184:187], a[20:23]
  s_add_u32 s23, s23, 128
  s_add_u32 s24, s24, 128
  v_mfma_f32_16x16x32_bf16 a[24:27], a[144:147], a[184:187], a[24:27]
  v_mfma_f32_16x16x32_bf16 a[24:27], a[148:151], a[188:191], a[24:27]
  v_mfma_f32_16x16x32_bf16 a[28:31], a[156:159], a[188:191], a[28:31]
  v_mfma_f32_16x16x32_bf16 a[28:31], a[152:155], a[184:187], a[28:31]
  s_mov_b32 s16, s50
  s_mov_b32 s17, s51
  s_mov_b32 s18, 16777216
  s_mov_b32 s19, 0x00020000
  s_mov_b32 s3, 0x3e0293ee
  v_mov_b32 v10, s3
  s_lshr_b32 s4, s53, 7
  s_add_u32 s4, s4, s22
  s_lshl_b32 s4, s4, 5
  s_lshr_b32 s5, s52, 6
  s_add_u32 s4, s4, s5
  s_lshl_b32 s5, s21, 1
  s_add_u32 s4, s4, s5
  s_lshl_b32 s4, s4, 14
  v_pk_mul_f32 v[32:33], v[32:33], v[10:11] op_sel_hi:[1,0]
  v_pk_mul_f32 v[34:35], v[34:35], v[10:11] op_sel_hi:[1,0]
  v_pk_mul_f32 v[36:37], v[36:37], v[10:11] op_sel_hi:[1,0]
  v_pk_mul_f32 v[38:39], v[38:39], v[10:11] op_sel_hi:[1,0]
  v_cvt_pk_bf16_f32 v24, v32, v33
  v_cvt_pk_bf16_f32 v25, v34, v35
  v_cvt_pk_bf16_f32 v26, v36, v37
  v_cvt_pk_bf16_f32 v27, v38, v39
  s_add_u32 s5, s4, 0
  buffer_store_dwordx4 v[24:27], v1, s[16:19], s5 offen offset:0
  v_pk_mul_f32 v[40:41], v[40:41], v[10:11] op_sel_hi:[1,0]
  v_pk_mul_f32 v[42:43], v[42:43], v[10:11] op_sel_hi:[1,0]
  v_pk_mul_f32 v[44:45], v[44:45], v[10:11] op_sel_hi:[1,0]
  v_pk_mul_f32 v[46:47], v[46:47], v[10:11] op_sel_hi:[1,0]
  v_cvt_pk_bf16_f32 v28, v40, v41
  v_cvt_pk_bf16_f32 v29, v42, v43
  v_cvt_pk_bf16_f32 v30, v44, v45
  v_cvt_pk_bf16_f32 v31, v46, v47
  buffer_store_dwordx4 v[28:31], v1, s[16:19], s5 offen offset:1024
  v_pk_mul_f32 v[48:49], v[48:49], v[10:11] op_sel_hi:[1,0]
  v_pk_mul_f32 v[50:51], v[50:51], v[10:11] op_sel_hi:[1,0]
  v_pk_mul_f32 v[52:53], v[52:53], v[10:11] op_sel_hi:[1,0]
  v_pk_mul_f32 v[54:55], v[54:55], v[10:11] op_sel_hi:[1,0]
  v_cvt_pk_bf16_f32 v24, v48, v49
  v_cvt_pk_bf16_f32 v25, v50, v51
  v_cvt_pk_bf16_f32 v26, v52, v53
  v_cvt_pk_bf16_f32 v27, v54, v55
  buffer_store_dwordx4 v[24:27], v1, s[16:19], s5 offen offset:2048
  v_pk_mul_f32 v[56:57], v[56:57], v[10:11] op_sel_hi:[1,0]
  v_pk_mul_f32 v[58:59], v[58:59], v[10:11] op_sel_hi:[1,0]
  v_pk_mul_f32 v[60:61], v[60:61], v[10:11] op_sel_hi:[1,0]
  v_pk_mul_f32 v[62:63], v[62:63], v[10:11] op_sel_hi:[1,0]
  v_cvt_pk_bf16_f32 v28, v56, v57
  v_cvt_pk_bf16_f32 v29, v58, v59
  v_cvt_pk_bf16_f32 v30, v60, v61
  v_cvt_pk_bf16_f32 v31, v62, v63
  buffer_store_dwordx4 v[28:31], v1, s[16:19], s5 offen offset:3072
  v_pk_mul_f32 v[64:65], v[64:65], v[10:11] op_sel_hi:[1,0]
  v_pk_mul_f32 v[66:67], v[66:67], v[10:11] op_sel_hi:[1,0]
  v_pk_mul_f32 v[68:69], v[68:69], v[10:11] op_sel_hi:[1,0]
  v_pk_mul_f32 v[70:71], v[70:71], v[10:11] op_sel_hi:[1,0]
  v_cvt_pk_bf16_f32 v24, v64, v65
  v_cvt_pk_bf16_f32 v25, v66, v67
  v_cvt_pk_bf16_f32 v26, v68, v69
  v_cvt_pk_bf16_f32 v27, v70, v71
  s_add_u32 s5, s4, 4096
  buffer_store_dwordx4 v[24:27], v1, s[16:19], s5 offen offset:0
  v_pk_mul_f32 v[72:73], v[72:73], v[10:11] op_sel_hi:[1,0]
  v_pk_mul_f32 v[74:75], v[74:75], v[10:11] op_sel_hi:[1,0]
  v_pk_mul_f32 v[76:77], v[76:77], v[10:11] op_sel_hi:[1,0]
  v_pk_mul_f32 v[78:79], v[78:79], v[10:11] op_sel_hi:[1,0]
  v_cvt_pk_bf16_f32 v28, v72, v73
  v_cvt_pk_bf16_f32 v29, v74, v75
  v_cvt_pk_bf16_f32 v30, v76, v77
  v_cvt_pk_bf16_f32 v31, v78, v79
  buffer_store_dwordx4 v[28:31], v1, s[16:19], s5 offen offset:1024
  v_pk_mul_f32 v[80:81], v[80:81], v[10:11] op_sel_hi:[1,0]
  v_pk_mul_f32 v[82:83], v[82:83], v[10:11] op_sel_hi:[1,0]
  v_pk_mul_f32 v[84:85], v[84:85], v[10:11] op_sel_hi:[1,0]
  v_pk_mul_f32 v[86:87], v[86:87], v[10:11] op_sel_hi:[1,0]
  v_cvt_pk_bf16_f32 v24, v80, v81
  v_cvt_pk_bf16_f32 v25, v82, v83
  v_cvt_pk_bf16_f32 v26, v84, v85
  v_cvt_pk_bf16_f32 v27, v86, v87
  buffer_store_dwordx4 v[24:27], v1, s[16:19], s5 offen offset:2048
  v_pk_mul_f32 v[88:89], v[88:89], v[10:11] op_sel_hi:[1,0]
  v_pk_mul_f32 v[90:91], v[90:91], v[10:11] op_sel_hi:[1,0]
  v_pk_mul_f32 v[92:93], v[92:93], v[10:11] op_sel_hi:[1,0]
  v_pk_mul_f32 v[94:95], v[94:95], v[10:11] op_sel_hi:[1,0]
  v_cvt_pk_bf16_f32 v28, v88, v89
  v_cvt_pk_bf16_f32 v29, v90, v91
  v_cvt_pk_bf16_f32 v30, v92, v93
  v_cvt_pk_bf16_f32 v31, v94, v95
  buffer_store_dwordx4 v[28:31], v1, s[16:19], s5 offen offset:3072
  v_pk_mul_f32 v[96:97], v[96:97], v[10:11] op_sel_hi:[1,0]
  v_pk_mul_f32 v[98:99], v[98:99], v[10:11] op_sel_hi:[1,0]
  v_pk_mul_f32 v[100:101], v[100:101], v[10:11] op_sel_hi:[1,0]
  v_pk_mul_f32 v[102:103], v[102:103], v[10:11] op_sel_hi:[1,0]
  v_cvt_pk_bf16_f32 v24, v96, v97
  v_cvt_pk_bf16_f32 v25, v98, v99
  v_cvt_pk_bf16_f32 v26, v100, v101
  v_cvt_pk_bf16_f32 v27, v102, v103
  s_add_u32 s5, s4, 8192
  buffer_store_dwordx4 v[24:27], v1, s[16:19], s5 offen offset:0
  v_pk_mul_f32 v[104:105], v[104:105], v[10:11] op_sel_hi:[1,0]
  v_pk_mul_f32 v[106:107], v[106:107], v[10:11] op_sel_hi:[1,0]
  v_pk_mul_f32 v[108:109], v[108:109], v[10:11] op_sel_hi:[1,0]
  v_pk_mul_f32 v[110:111], v[110:111], v[10:11] op_sel_hi:[1,0]
  v_cvt_pk_bf16_f32 v28, v104, v105
  v_cvt_pk_bf16_f32 v29, v106, v107
  v_cvt_pk_bf16_f32 v30, v108, v109
  v_cvt_pk_bf16_f32 v31, v110, v111
  buffer_store_dwordx4 v[28:31], v1, s[16:19], s5 offen offset:1024
  v_pk_mul_f32 v[112:113], v[112:113], v[10:11] op_sel_hi:[1,0]
  v_pk_mul_f32 v[114:115], v[114:115], v[10:11] op_sel_hi:[1,0]
  v_pk_mul_f32 v[116:117], v[116:117], v[10:11] op_sel_hi:[1,0]
  v_pk_mul_f32 v[118:119], v[118:119], v[10:11] op_sel_hi:[1,0]
  v_cvt_pk_bf16_f32 v24, v112, v113
  v_cvt_pk_bf16_f32 v25, v114, v115
  v_cvt_pk_bf16_f32 v26, v116, v117
  v_cvt_pk_bf16_f32 v27, v118, v119
  buffer_store_dwordx4 v[24:27], v1, s[16:19], s5 offen offset:2048
  v_pk_mul_f32 v[120:121], v[120:121], v[10:11] op_sel_hi:[1,0]
  v_pk_mul_f32 v[122:123], v[122:123], v[10:11] op_sel_hi:[1,0]
  v_pk_mul_f32 v[124:125], v[124:125], v[10:11] op_sel_hi:[1,0]
  v_pk_mul_f32 v[126:127], v[126:127], v[10:11] op_sel_hi:[1,0]
  v_cvt_pk_bf16_f32 v28, v120, v121
  v_cvt_pk_bf16_f32 v29, v122, v123
  v_cvt_pk_bf16_f32 v30, v124, v125
  v_cvt_pk_bf16_f32 v31, v126, v127
  buffer_store_dwordx4 v[28:31], v1, s[16:19], s5 offen offset:3072
  v_pk_mul_f32 v[128:129], v[128:129], v[10:11] op_sel_hi:[1,0]
  v_pk_mul_f32 v[130:131], v[130:131], v[10:11] op_sel_hi:[1,0]
  v_pk_mul_f32 v[132:133], v[132:133], v[10:11] op_sel_hi:[1,0]
  v_pk_mul_f32 v[134:135], v[134:135], v[10:11] op_sel_hi:[1,0]
  v_cvt_pk_bf16_f32 v24, v128, v129
  v_cvt_pk_bf16_f32 v25, v130, v131
  v_cvt_pk_bf16_f32 v26, v132, v133
  v_cvt_pk_bf16_f32 v27, v134, v135
  s_add_u32 s5, s4, 12288
  buffer_store_dwordx4 v[24:27], v1, s[16:19], s5 offen offset:0
  v_pk_mul_f32 v[136:137], v[136:137], v[10:11] op_sel_hi:[1,0]
  v_pk_mul_f32 v[138:139], v[138:139], v[10:11] op_sel_hi:[1,0]
  v_pk_mul_f32 v[140:141], v[140:141], v[10:11] op_sel_hi:[1,0]
  v_pk_mul_f32 v[142:143], v[142:143], v[10:11] op_sel_hi:[1,0]
  v_cvt_pk_bf16_f32 v28, v136, v137
  v_cvt_pk_bf16_f32 v29, v138, v139
  v_cvt_pk_bf16_f32 v30, v140, v141
  v_cvt_pk_bf16_f32 v31, v142, v143
  buffer_store_dwordx4 v[28:31], v1, s[16:19], s5 offen offset:1024
  v_pk_mul_f32 v[144:145], v[144:145], v[10:11] op_sel_hi:[1,0]
  v_pk_mul_f32 v[146:147], v[146:147], v[10:11] op_sel_hi:[1,0]
  v_pk_mul_f32 v[148:149], v[148:149], v[10:11] op_sel_hi:[1,0]
  v_pk_mul_f32 v[150:151], v[150:151], v[10:11] op_sel_hi:[1,0]
  v_cvt_pk_bf16_f32 v24, v144, v145
  v_cvt_pk_bf16_f32 v25, v146, v147
  v_cvt_pk_bf16_f32 v26, v148, v149
  v_cvt_pk_bf16_f32 v27, v150, v151
  buffer_store_dwordx4 v[24:27], v1, s[16:19], s5 offen offset:2048
  v_pk_mul_f32 v[152:153], v[152:153], v[10:11] op_sel_hi:[1,0]
  v_pk_mul_f32 v[154:155], v[154:155], v[10:11] op_sel_hi:[1,0]
  v_pk_mul_f32 v[156:157], v[156:157], v[10:11] op_sel_hi:[1,0]
  v_pk_mul_f32 v[158:159], v[158:159], v[10:11] op_sel_hi:[1,0]
  v_cvt_pk_bf16_f32 v28, v152, v153
  v_cvt_pk_bf16_f32 v29, v154, v155
  v_cvt_pk_bf16_f32 v30, v156, v157
  v_cvt_pk_bf16_f32 v31, v158, v159
  buffer_store_dwordx4 v[28:31], v1, s[16:19], s5 offen offset:3072
  v_pk_mul_f32 v[160:161], v[160:161], v[10:11] op_sel_hi:[1,0]
  v_pk_mul_f32 v[162:163], v[162:163], v[10:11] op_sel_hi:[1,0]
  v_pk_mul_f32 v[164:165], v[164:165], v[10:11] op_sel_hi:[1,0]
  v_pk_mul_f32 v[166:167], v[166:167], v[10:11] op_sel_hi:[1,0]
  v_cvt_pk_bf16_f32 v24, v160, v161
  v_cvt_pk_bf16_f32 v25, v162, v163
  v_cvt_pk_bf16_f32 v26, v164, v165
  v_cvt_pk_bf16_f32 v27, v166, v167
  s_add_u32 s5, s4, 16384
  buffer_store_dwordx4 v[24:27], v1, s[16:19], s5 offen offset:0
  v_pk_mul_f32 v[168:169], v[168:169], v[10:11] op_sel_hi:[1,0]
  v_pk_mul_f32 v[170:171], v[170:171], v[10:11] op_sel_hi:[1,0]
  v_pk_mul_f32 v[172:173], v[172:173], v[10:11] op_sel_hi:[1,0]
  v_pk_mul_f32 v[174:175], v[174:175], v[10:11] op_sel_hi:[1,0]
  v_cvt_pk_bf16_f32 v28, v168, v169
  v_cvt_pk_bf16_f32 v29, v170, v171
  v_cvt_pk_bf16_f32 v30, v172, v173
  v_cvt_pk_bf16_f32 v31, v174, v175
  buffer_store_dwordx4 v[28:31], v1, s[16:19], s5 offen offset:1024
  v_pk_mul_f32 v[176:177], v[176:177], v[10:11] op_sel_hi:[1,0]
  v_pk_mul_f32 v[178:179], v[178:179], v[10:11] op_sel_hi:[1,0]
  v_pk_mul_f32 v[180:181], v[180:181], v[10:11] op_sel_hi:[1,0]
  v_pk_mul_f32 v[182:183], v[182:183], v[10:11] op_sel_hi:[1,0]
  v_cvt_pk_bf16_f32 v24, v176, v177
  v_cvt_pk_bf16_f32 v25, v178, v179
  v_cvt_pk_bf16_f32 v26, v180, v181
  v_cvt_pk_bf16_f32 v27, v182, v183
  buffer_store_dwordx4 v[24:27], v1, s[16:19], s5 offen offset:2048
  v_pk_mul_f32 v[184:185], v[184:185], v[10:11] op_sel_hi:[1,0]
  v_pk_mul_f32 v[186:187], v[186:187], v[10:11] op_sel_hi:[1,0]
  v_pk_mul_f32 v[188:189], v[188:189], v[10:11] op_sel_hi:[1,0]
  v_pk_mul_f32 v[190:191], v[190:191], v[10:11] op_sel_hi:[1,0]
  v_cvt_pk_bf16_f32 v28, v184, v185
  v_cvt_pk_bf16_f32 v29, v186, v187
  v_cvt_pk_bf16_f32 v30, v188, v189
  v_cvt_pk_bf16_f32 v31, v190, v191
  buffer_store_dwordx4 v[28:31], v1, s[16:19], s5 offen offset:3072
  v_pk_mul_f32 v[192:193], v[192:193], v[10:11] op_sel_hi:[1,0]
  v_pk_mul_f32 v[194:195], v[194:195], v[10:11] op_sel_hi:[1,0]
  v_pk_mul_f32 v[196:197], v[196:197], v[10:11] op_sel_hi:[1,0]
  v_pk_mul_f32 v[198:199], v[198:199], v[10:11] op_sel_hi:[1,0]
  v_cvt_pk_bf16_f32 v24, v192, v193
  v_cvt_pk_bf16_f32 v25, v194, v195
  v_cvt_pk_bf16_f32 v26, v196, v197
  v_cvt_pk_bf16_f32 v27, v198, v199
  s_add_u32 s5, s4, 20480
  buffer_store_dwordx4 v[24:27], v1, s[16:19], s5 offen offset:0
  v_pk_mul_f32 v[200:201], v[200:201], v[10:11] op_sel_hi:[1,0]
  v_pk_mul_f32 v[202:203], v[202:203], v[10:11] op_sel_hi:[1,0]
  v_pk_mul_f32 v[204:205], v[204:205], v[10:11] op_sel_hi:[1,0]
  v_pk_mul_f32 v[206:207], v[206:207], v[10:11] op_sel_hi:[1,0]
  v_cvt_pk_bf16_f32 v28, v200, v201
  v_cvt_pk_bf16_f32 v29, v202, v203
  v_cvt_pk_bf16_f32 v30, v204, v205
  v_cvt_pk_bf16_f32 v31, v206, v207
  buffer_store_dwordx4 v[28:31], v1, s[16:19], s5 offen offset:1024
  v_pk_mul_f32 v[208:209], v[208:209], v[10:11] op_sel_hi:[1,0]
  v_pk_mul_f32 v[210:211], v[210:211], v[10:11] op_sel_hi:[1,0]
  v_pk_mul_f32 v[212:213], v[212:213], v[10:11] op_sel_hi:[1,0]
  v_pk_mul_f32 v[214:215], v[214:215], v[10:11] op_sel_hi:[1,0]
  v_cvt_pk_bf16_f32 v24, v208, v209
  v_cvt_pk_bf16_f32 v25, v210, v211
  v_cvt_pk_bf16_f32 v26, v212, v213
  v_cvt_pk_bf16_f32 v27, v214, v215
  buffer_store_dwordx4 v[24:27], v1, s[16:19], s5 offen offset:2048
  v_pk_mul_f32 v[216:217], v[216:217], v[10:11] op_sel_hi:[1,0]
  v_pk_mul_f32 v[218:219], v[218:219], v[10:11] op_sel_hi:[1,0]
  v_pk_mul_f32 v[220:221], v[220:221], v[10:11] op_sel_hi:[1,0]
  v_pk_mul_f32 v[222:223], v[222:223], v[10:11] op_sel_hi:[1,0]
  v_cvt_pk_bf16_f32 v28, v216, v217
  v_cvt_pk_bf16_f32 v29, v218, v219
  v_cvt_pk_bf16_f32 v30, v220, v221
  v_cvt_pk_bf16_f32 v31, v222, v223
  buffer_store_dwordx4 v[28:31], v1, s[16:19], s5 offen offset:3072
  v_pk_mul_f32 v[224:225], v[224:225], v[10:11] op_sel_hi:[1,0]
  v_pk_mul_f32 v[226:227], v[226:227], v[10:11] op_sel_hi:[1,0]
  v_pk_mul_f32 v[228:229], v[228:229], v[10:11] op_sel_hi:[1,0]
  v_pk_mul_f32 v[230:231], v[230:231], v[10:11] op_sel_hi:[1,0]
  v_cvt_pk_bf16_f32 v24, v224, v225
  v_cvt_pk_bf16_f32 v25, v226, v227
  v_cvt_pk_bf16_f32 v26, v228, v229
  v_cvt_pk_bf16_f32 v27, v230, v231
  s_add_u32 s5, s4, 24576
  buffer_store_dwordx4 v[24:27], v1, s[16:19], s5 offen offset:0
  v_pk_mul_f32 v[232:233], v[232:233], v[10:11] op_sel_hi:[1,0]
  v_pk_mul_f32 v[234:235], v[234:235], v[10:11] op_sel_hi:[1,0]
  v_pk_mul_f32 v[236:237], v[236:237], v[10:11] op_sel_hi:[1,0]
  v_pk_mul_f32 v[238:239], v[238:239], v[10:11] op_sel_hi:[1,0]
  v_cvt_pk_bf16_f32 v28, v232, v233
  v_cvt_pk_bf16_f32 v29, v234, v235
  v_cvt_pk_bf16_f32 v30, v236, v237
  v_cvt_pk_bf16_f32 v31, v238, v239
  buffer_store_dwordx4 v[28:31], v1, s[16:19], s5 offen offset:1024
  v_pk_mul_f32 v[240:241], v[240:241], v[10:11] op_sel_hi:[1,0]
  v_pk_mul_f32 v[242:243], v[242:243], v[10:11] op_sel_hi:[1,0]
  v_pk_mul_f32 v[244:245], v[244:245], v[10:11] op_sel_hi:[1,0]
  v_pk_mul_f32 v[246:247], v[246:247], v[10:11] op_sel_hi:[1,0]
  v_cvt_pk_bf16_f32 v24, v240, v241
  v_cvt_pk_bf16_f32 v25, v242, v243
  v_cvt_pk_bf16_f32 v26, v244, v245
  v_cvt_pk_bf16_f32 v27, v246, v247
  buffer_store_dwordx4 v[24:27], v1, s[16:19], s5 offen offset:2048
  v_pk_mul_f32 v[248:249], v[248:249], v[10:11] op_sel_hi:[1,0]
  v_pk_mul_f32 v[250:251], v[250:251], v[10:11] op_sel_hi:[1,0]
  v_pk_mul_f32 v[252:253], v[252:253], v[10:11] op_sel_hi:[1,0]
  v_pk_mul_f32 v[254:255], v[254:255], v[10:11] op_sel_hi:[1,0]
  v_cvt_pk_bf16_f32 v28, v248, v249
  v_cvt_pk_bf16_f32 v29, v250, v251
  v_cvt_pk_bf16_f32 v30, v252, v253
  v_cvt_pk_bf16_f32 v31, v254, v255
  buffer_store_dwordx4 v[28:31], v1, s[16:19], s5 offen offset:3072
  v_accvgpr_read_b32 v32, a0
  v_accvgpr_read_b32 v33, a1
  v_accvgpr_read_b32 v34, a2
  v_accvgpr_read_b32 v35, a3
  v_accvgpr_read_b32 v36, a4
  v_accvgpr_read_b32 v37, a5
  v_accvgpr_read_b32 v38, a6
  v_accvgpr_read_b32 v39, a7
  v_pk_mul_f32 v[32:33], v[32:33], v[10:11] op_sel_hi:[1,0]
  v_pk_mul_f32 v[34:35], v[34:35], v[10:11] op_sel_hi:[1,0]
  v_pk_mul_f32 v[36:37], v[36:37], v[10:11] op_sel_hi:[1,0]
  v_pk_mul_f32 v[38:39], v[38:39], v[10:11] op_sel_hi:[1,0]
  v_cvt_pk_bf16_f32 v24, v32, v33
  v_cvt_pk_bf16_f32 v25, v34, v35
  v_cvt_pk_bf16_f32 v26, v36, v37
  v_cvt_pk_bf16_f32 v27, v38, v39
  s_add_u32 s5, s4, 28672
  buffer_store_dwordx4 v[24:27], v1, s[16:19], s5 offen offset:0
  v_accvgpr_read_b32 v32, a8
  v_accvgpr_read_b32 v33, a9
  v_accvgpr_read_b32 v34, a10
  v_accvgpr_read_b32 v35, a11
  v_accvgpr_read_b32 v36, a12
  v_accvgpr_read_b32 v37, a13
  v_accvgpr_read_b32 v38, a14
  v_accvgpr_read_b32 v39, a15
  v_pk_mul_f32 v[32:33], v[32:33], v[10:11] op_sel_hi:[1,0]
  v_pk_mul_f32 v[34:35], v[34:35], v[10:11] op_sel_hi:[1,0]
  v_pk_mul_f32 v[36:37], v[36:37], v[10:11] op_sel_hi:[1,0]
  v_pk_mul_f32 v[38:39], v[38:39], v[10:11] op_sel_hi:[1,0]
  v_cvt_pk_bf16_f32 v28, v32, v33
  v_cvt_pk_bf16_f32 v29, v34, v35
  v_cvt_pk_bf16_f32 v30, v36, v37
  v_cvt_pk_bf16_f32 v31, v38, v39
  buffer_store_dwordx4 v[28:31], v1, s[16:19], s5 offen offset:1024
  v_accvgpr_read_b32 v32, a16
  v_accvgpr_read_b32 v33, a17
  v_accvgpr_read_b32 v34, a18
  v_accvgpr_read_b32 v35, a19
  v_accvgpr_read_b32 v36, a20
  v_accvgpr_read_b32 v37, a21
  v_accvgpr_read_b32 v38, a22
  v_accvgpr_read_b32 v39, a23
  v_pk_mul_f32 v[32:33], v[32:33], v[10:11] op_sel_hi:[1,0]
  v_pk_mul_f32 v[34:35], v[34:35], v[10:11] op_sel_hi:[1,0]
  v_pk_mul_f32 v[36:37], v[36:37], v[10:11] op_sel_hi:[1,0]
  v_pk_mul_f32 v[38:39], v[38:39], v[10:11] op_sel_hi:[1,0]
  v_cvt_pk_bf16_f32 v24, v32, v33
  v_cvt_pk_bf16_f32 v25, v34, v35
  v_cvt_pk_bf16_f32 v26, v36, v37
  v_cvt_pk_bf16_f32 v27, v38, v39
  buffer_store_dwordx4 v[24:27], v1, s[16:19], s5 offen offset:2048
  v_accvgpr_read_b32 v32, a24
  v_accvgpr_read_b32 v33, a25
  v_accvgpr_read_b32 v34, a26
  v_accvgpr_read_b32 v35, a27
  v_accvgpr_read_b32 v36, a28
  v_accvgpr_read_b32 v37, a29
  v_accvgpr_read_b32 v38, a30
  v_accvgpr_read_b32 v39, a31
  v_pk_mul_f32 v[32:33], v[32:33], v[10:11] op_sel_hi:[1,0]
  v_pk_mul_f32 v[34:35], v[34:35], v[10:11] op_sel_hi:[1,0]
  v_pk_mul_f32 v[36:37], v[36:37], v[10:11] op_sel_hi:[1,0]
  v_pk_mul_f32 v[38:39], v[38:39], v[10:11] op_sel_hi:[1,0]
  v_cvt_pk_bf16_f32 v28, v32, v33
  v_cvt_pk_bf16_f32 v29, v34, v35
  v_cvt_pk_bf16_f32 v30, v36, v37
  v_cvt_pk_bf16_f32 v31, v38, v39
  buffer_store_dwordx4 v[28:31], v1, s[16:19], s5 offen offset:3072
  s_branch Lk1_b
Lk1_kv:
  v_mfma_f32_16x16x32_bf16 v[32:35], a[32:35], a[160:163], 0
  s_add_u32 s23, s23, 128
  s_cmp_eq_u32 s23, s25
  s_cselect_b32 s23, s26, s23
  v_mfma_f32_16x16x32_bf16 v[32:35], a[36:39], a[164:167], v[32:35]
  ds_read_b128 a[176:179], v10 offset:4096
  ds_read_b128 a[180:183], v11 offset:4096
  v_mfma_f32_16x16x32_bf16 v[36:39], a[44:47], a[164:167], 0
  v_mfma_f32_16x16x32_bf16 v[36:39], a[40:43], a[160:163], v[36:39]
  ds_read_b64_tr_b16 a[96:97], v12 offset:32768
  ds_read_b64_tr_b16 a[98:99], v12 offset:34816
  v_mfma_f32_16x16x32_bf16 v[40:43], a[48:51], a[160:163], 0
  v_mfma_f32_16x16x32_bf16 v[40:43], a[52:55], a[164:167], v[40:43]
  v_mfma_f32_16x16x32_bf16 v[44:47], a[60:63], a[164:167], 0
  s_add_u32 m0, s29, 81920
  s_nop 0
  buffer_load_dwordx4 v6, s[12:15], s24 offen offset:0 lds
  v_mfma_f32_16x16x32_bf16 v[44:47], a[56:59], a[160:163], v[44:47]
  ds_read_b64_tr_b16 a[104:105], v13 offset:32768
  ds_read_b64_tr_b16 a[106:107], v13 offset:34816
  v_mfma_f32_16x16x32_bf16 v[48:51], a[64:67], a[160:163], 0
  v_mfma_f32_16x16x32_bf16 v[48:51], a[68:71], a[164:167], v[48:51]
  v_mfma_f32_16x16x32_bf16 v[52:55], a[76:79], a[164:167], 0
  v_mfma_f32_16x16x32_bf16 v[52:55], a[72:75], a[160:163], v[52:55]
  ds_read_b64_tr_b16 a[112:113], v14 offset:32768
  ds_read_b64_tr_b16 a[114:115], v14 offset:34816
  v_mfma_f32_16x16x32_bf16 v[56:59], a[80:83], a[160:163], 0
  v_mfma_f32_16x16x32_bf16 v[56:59], a[84:87], a[164:167], v[56:59]
  buffer_load_dwordx4 v7, s[12:15], s24 offen offset:1024 lds
  v_mfma_f32_16x16x32_bf16 v[60:63], a[92:95], a[164:167], 0
  v_mfma_f32_16x16x32_bf16 v[60:63], a[88:91], a[160:163], v[60:63]
  ds_read_b64_tr_b16 a[120:121], v15 offset:32768
  ds_read_b64_tr_b16 a[122:123], v15 offset:34816
  v_mfma_f32_16x16x32_bf16 v[64:67], a[32:35], a[168:171], 0
  v_mfma_f32_16x16x32_bf16 v[64:67], a[36:39], a[172:175], v[64:67]
  ds_read_b128 a[184:187], v10 offset:6144
  ds_read_b128 a[188:191], v11 offset:6144
  v_mfma_f32_16x16x32_bf16 v[68:71], a[44:47], a[172:175], 0
  v_mfma_f32_16x16x32_bf16 v[68:71], a[40:43], a[168:171], v[68:71]
  ds_read_b64_tr_b16 a[128:129], v16 offset:32768
  ds_read_b64_tr_b16 a[130:131], v16 offset:34816
  v_mfma_f32_16x16x32_bf16 v[72:75], a[48:51], a[168:171], 0
  buffer_load_dwordx4 v8, s[12:15], s24 offen offset:2048 lds
  v_mfma_f32_16x16x32_bf16 v[72:75], a[52:55], a[172:175], v[72:75]
  v_mfma_f32_16x16x32_bf16 v[76:79], a[60:63], a[172:175], 0
  v_mfma_f32_16x16x32_bf16 v[76:79], a[56:59], a[168:171], v[76:79]
  ds_read_b64_tr_b16 a[136:137], v17 offset:32768
  ds_read_b64_tr_b16 a[138:139], v17 offset:34816
  v_mfma_f32_16x16x32_bf16 v[80:83], a[64:67], a[168:171], 0
  v_mfma_f32_16x16x32_bf16 v[80:83], a[68:71], a[172:175], v[80:83]
  v_mfma_f32_16x16x32_bf16 v[84:87], a[76:79], a[172:175], 0
  buffer_load_dwordx4 v9, s[12:15], s24 offen offset:3072 lds
  v_mfma_f32_16x16x32_bf16 v[84:87], a[72:75], a[168:171], v[84:87]
  ds_read_b64_tr_b16 a[144:145], v18 offset:32768
  ds_read_b64_tr_b16 a[146:147], v18 offset:34816
  v_mfma_f32_16x16x32_bf16 v[88:91], a[80:83], a[168:171], 0
  v_mfma_f32_16x16x32_bf16 v[88:91], a[84:87], a[172:175], v[88:91]
  v_mfma_f32_16x16x32_bf16 v[92:95], a[92:95], a[172:175], 0
  v_mfma_f32_16x16x32_bf16 v[92:95], a[88:91], a[168:171], v[92:95]
  s_waitcnt lgkmcnt(15)
  ds_read_b64_tr_b16 a[152:153], v19 offset:32768
  ds_read_b64_tr_b16 a[154:155], v19 offset:34816
  v_mfma_f32_16x16x32_bf16 v[96:99], a[32:35], a[176:179], 0
  s_add_u32 s24, s24, 262144
  s_cmp_eq_u32 s24, s27
  s_cselect_b32 s24, s28, s24
  s_cselect_b64 s[12:13], s[64:65], s[12:13]
  v_mfma_f32_16x16x32_bf16 v[96:99], a[36:39], a[180:183], v[96:99]
  v_mfma_f32_16x16x32_bf16 v[100:103], a[44:47], a[180:183], 0
  v_mfma_f32_16x16x32_bf16 v[100:103], a[40:43], a[176:179], v[100:103]
  v_mfma_f32_16x16x32_bf16 v[104:107], a[48:51], a[176:179], 0
  v_mfma_f32_16x16x32_bf16 v[104:107], a[52:55], a[180:183], v[104:107]
  v_mfma_f32_16x16x32_bf16 v[108:111], a[60:63], a[180:183], 0
  v_mfma_f32_16x16x32_bf16 v[108:111], a[56:59], a[176:179], v[108:111]
  s_waitcnt vmcnt(17) lgkmcnt(0)
  s_barrier
  ds_read_b128 a[160:163], v10 offset:16384
  ds_read_b128 a[164:167], v11 offset:16384
  v_mfma_f32_16x16x32_bf16 v[112:115], a[64:67], a[176:179], 0
  s_add_u32 m0, s29, 0
  s_nop 0
  buffer_load_dwordx4 v2, s[8:11], s23 offen offset:0 lds
  v_mfma_f32_16x16x32_bf16 v[112:115], a[68:71], a[180:183], v[112:115]
  v_mfma_f32_16x16x32_bf16 v[116:119], a[76:79], a[180:183], 0
  v_mfma_f32_16x16x32_bf16 v[116:119], a[72:75], a[176:179], v[116:119]
  ds_read_b64_tr_b16 a[100:101], v12 offset:49152
  ds_read_b64_tr_b16 a[102:103], v12 offset:51200
  v_mfma_f32_16x16x32_bf16 v[120:123], a[80:83], a[176:179], 0
  v_mfma_f32_16x16x32_bf16 v[120:123], a[84:87], a[180:183], v[120:123]
  buffer_load_dwordx4 v3, s[8:11], s23 offen offset:1024 lds
  v_mfma_f32_16x16x32_bf16 v[124:127], a[92:95], a[180:183], 0
  v_mfma_f32_16x16x32_bf16 v[124:127], a[88:91], a[176:179], v[124:127]
  v_mfma_f32_16x16x32_bf16 v[128:131], a[32:35], a[184:187], 0
  v_mfma_f32_16x16x32_bf16 v[128:131], a[36:39], a[188:191], v[128:131]
  ds_read_b128 a[168:171], v10 offset:18432
  ds_read_b128 a[172:175], v11 offset:18432
  ds_read_b64_tr_b16 a[108:109], v13 offset:49152
  ds_read_b64_tr_b16 a[110:111], v13 offset:51200
  v_mfma_f32_16x16x32_bf16 v[132:135], a[44:47], a[188:191], 0
  v_mfma_f32_16x16x32_bf16 v[132:135], a[40:43], a[184:187], v[132:135]
  buffer_load_dwordx4 v4, s[8:11], s23 offen offset:2048 lds
  v_mfma_f32_16x16x32_bf16 v[136:139], a[48:51], a[184:187], 0
  v_mfma_f32_16x16x32_bf16 v[136:139], a[52:55], a[188:191], v[136:139]
  v_mfma_f32_16x16x32_bf16 v[140:143], a[60:63], a[188:191], 0
  v_mfma_f32_16x16x32_bf16 v[140:143], a[56:59], a[184:187], v[140:143]
  ds_read_b64_tr_b16 a[116:117], v14 offset:49152
  ds_read_b64_tr_b16 a[118:119], v14 offset:51200
  v_mfma_f32_16x16x32_bf16 v[144:147], a[64:67], a[184:187], 0
  v_mfma_f32_16x16x32_bf16 v[144:147], a[68:71], a[188:191], v[144:147]
  buffer_load_dwordx4 v5, s[8:11], s23 offen offset:3072 lds
  v_mfma_f32_16x16x32_bf16 v[148:151], a[76:79], a[188:191], 0
  v_mfma_f32_16x16x32_bf16 v[148:151], a[72:75], a[184:187], v[148:151]
  v_mfma_f32_16x16x32_bf16 v[152:155], a[80:83], a[184:187], 0
  v_mfma_f32_16x16x32_bf16 v[152:155], a[84:87], a[188:191], v[152:155]
  ds_read_b64_tr_b16 a[124:125], v15 offset:49152
  ds_read_b64_tr_b16 a[126:127], v15 offset:51200
  v_mfma_f32_16x16x32_bf16 v[156:159], a[92:95], a[188:191], 0
  s_add_u32 m0, s29, 98304
  s_nop 0
  buffer_load_dwordx4 v6, s[12:15], s24 offen offset:0 lds
  v_mfma_f32_16x16x32_bf16 v[156:159], a[88:91], a[184:187], v[156:159]
  s_waitcnt lgkmcnt(10)
  v_mfma_f32_16x16x32_bf16 v[160:163], a[32:35], a[160:163], 0
  v_mfma_f32_16x16x32_bf16 v[160:163], a[36:39], a[164:167], v[160:163]
  ds_read_b128 a[176:179], v10 offset:20480
  ds_read_b128 a[180:183], v11 offset:20480
  v_mfma_f32_16x16x32_bf16 v[164:167], a[44:47], a[164:167], 0
  v_mfma_f32_16x16x32_bf16 v[164:167], a[40:43], a[160:163], v[164:167]
  ds_read_b64_tr_b16 a[132:133], v16 offset:49152
  ds_read_b64_tr_b16 a[134:135], v16 offset:51200
  v_mfma_f32_16x16x32_bf16 v[168:171], a[48:51], a[160:163], 0
  v_mfma_f32_16x16x32_bf16 v[168:171], a[52:55], a[164:167], v[168:171]
  buffer_load_dwordx4 v7, s[12:15], s24 offen offset:1024 lds
  v_mfma_f32_16x16x32_bf16 v[172:175], a[60:63], a[164:167], 0
  v_mfma_f32_16x16x32_bf16 v[172:175], a[56:59], a[160:163], v[172:175]
  v_mfma_f32_16x16x32_bf16 v[176:179], a[64:67], a[160:163], 0
  v_mfma_f32_16x16x32_bf16 v[176:179], a[68:71], a[164:167], v[176:179]
  ds_read_b64_tr_b16 a[140:141], v17 offset:49152
  ds_read_b64_tr_b16 a[142:143], v17 offset:51200
  v_mfma_f32_16x16x32_bf16 v[180:183], a[76:79], a[164:167], 0
  v_mfma_f32_16x16x32_bf16 v[180:183], a[72:75], a[160:163], v[180:183]
  buffer_load_dwordx4 v8, s[12:15], s24 offen offset:2048 lds
  v_mfma_f32_16x16x32_bf16 v[184:187], a[80:83], a[160:163], 0
  v_mfma_f32_16x16x32_bf16 v[184:187], a[84:87], a[164:167], v[184:187]
  v_mfma_f32_16x16x32_bf16 v[188:191], a[92:95], a[164:167], 0
  v_mfma_f32_16x16x32_bf16 v[188:191], a[88:91], a[160:163], v[188:191]
  s_waitcnt lgkmcnt(12)
  ds_read_b64_tr_b16 a[148:149], v18 offset:49152
  ds_read_b64_tr_b16 a[150:151], v18 offset:51200
  v_mfma_f32_16x16x32_bf16 v[192:195], a[32:35], a[168:171], 0
  buffer_load_dwordx4 v9, s[12:15], s24 offen offset:3072 lds
  v_mfma_f32_16x16x32_bf16 v[192:195], a[36:39], a[172:175], v[192:195]
  ds_read_b128 a[184:187], v10 offset:22528
  ds_read_b128 a[188:191], v11 offset:22528
  v_mfma_f32_16x16x32_bf16 v[196:199], a[44:47], a[172:175], 0
  v_mfma_f32_16x16x32_bf16 v[196:199], a[40:43], a[168:171], v[196:199]
  v_mfma_f32_16x16x32_bf16 v[200:203], a[48:51], a[168:171], 0
  v_mfma_f32_16x16x32_bf16 v[200:203], a[52:55], a[172:175], v[200:203]
  ds_read_b64_tr_b16 a[156:157], v19 offset:49152
  ds_read_b64_tr_b16 a[158:159], v19 offset:51200
  v_mfma_f32_16x16x32_bf16 v[204:207], a[60:63], a[172:175], 0
  s_add_u32 s24, s24, 262144
  v_mfma_f32_16x16x32_bf16 v[204:207], a[56:59], a[168:171], v[204:207]
  v_mfma_f32_16x16x32_bf16 v[208:211], a[64:67], a[168:171], 0
  v_mfma_f32_16x16x32_bf16 v[208:211], a[68:71], a[172:175], v[208:211]
  v_mfma_f32_16x16x32_bf16 v[212:215], a[76:79], a[172:175], 0
  v_mfma_f32_16x16x32_bf16 v[212:215], a[72:75], a[168:171], v[212:215]
  buffer_load_dword v21, v20, s[60:63], s54 offen
  s_add_u32 s54, s54, s55
  v_mfma_f32_16x16x32_bf16 v[216:219], a[80:83], a[168:171], 0
  v_mfma_f32_16x16x32_bf16 v[216:219], a[84:87], a[172:175], v[216:219]
  v_mfma_f32_16x16x32_bf16 v[220:223], a[92:95], a[172:175], 0
  v_mfma_f32_16x16x32_bf16 v[220:223], a[88:91], a[168:171], v[220:223]
  s_waitcnt lgkmcnt(10)
  v_mfma_f32_16x16x32_bf16 v[224:227], a[32:35], a[176:179], 0
  s_cmp_eq_u32 s54, s56
  s_cselect_b32 s54, s57, s54
  s_cselect_b64 s[60:61], s[58:59], s[60:61]
  s_cselect_b32 s62, s7, s62
  v_mfma_f32_16x16x32_bf16 v[224:227], a[36:39], a[180:183], v[224:227]
  v_mfma_f32_16x16x32_bf16 v[228:231], a[44:47], a[180:183], 0
  v_mfma_f32_16x16x32_bf16 v[228:231], a[40:43], a[176:179], v[228:231]
  v_mfma_f32_16x16x32_bf16 v[232:235], a[48:51], a[176:179], 0
  v_mfma_f32_16x16x32_bf16 v[232:235], a[52:55], a[180:183], v[232:235]
  v_mfma_f32_16x16x32_bf16 v[236:239], a[60:63], a[180:183], 0
  v_mfma_f32_16x16x32_bf16 v[236:239], a[56:59], a[176:179], v[236:239]
  s_waitcnt vmcnt(17) lgkmcnt(0)
  s_barrier
  ds_read_b128 a[160:163], v10 offset:32768
  ds_read_b128 a[164:167], v11 offset:32768
  v_mfma_f32_16x16x32_bf16 v[240:243], a[64:67], a[176:179], 0
  s_add_u32 m0, s29, 16384
  s_add_u32 s3, s23, s31
  buffer_load_dwordx4 v2, s[8:11], s3 offen offset:0 lds
  v_mfma_f32_16x16x32_bf16 v[240:243], a[68:71], a[180:183], v[240:243]
  v_mfma_f32_16x16x32_bf16 v[244:247], a[76:79], a[180:183], 0
  v_mfma_f32_16x16x32_bf16 v[244:247], a[72:75], a[176:179], v[244:247]
  v_mfma_f32_16x16x32_bf16 v[248:251], a[80:83], a[176:179], 0
  v_mfma_f32_16x16x32_bf16 v[248:251], a[84:87], a[180:183], v[248:251]
  buffer_load_dwordx4 v3, s[8:11], s3 offen offset:1024 lds
  v_mfma_f32_16x16x32_bf16 v[252:255], a[92:95], a[180:183], 0
  v_mfma_f32_16x16x32_bf16 v[252:255], a[88:91], a[176:179], v[252:255]
  v_mfma_f32_16x16x32_bf16 a[0:3], a[32:35], a[184:187], 0
  v_mfma_f32_16x16x32_bf16 a[0:3], a[36:39], a[188:191], a[0:3]
  ds_read_b128 a[168:171], v10 offset:34816
  ds_read_b128 a[172:175], v11 offset:34816
  v_mfma_f32_16x16x32_bf16 a[4:7], a[44:47], a[188:191], 0
  v_mfma_f32_16x16x32_bf16 a[4:7], a[40:43], a[184:187], a[4:7]
  v_mfma_f32_16x16x32_bf16 a[8:11], a[48:51], a[184:187], 0
  buffer_load_dwordx4 v4, s[8:11], s3 offen offset:2048 lds
  v_mfma_f32_16x16x32_bf16 a[8:11], a[52:55], a[188:191], a[8:11]
  v_mfma_f32_16x16x32_bf16 a[12:15], a[60:63], a[188:191], 0
  v_mfma_f32_16x16x32_bf16 a[12:15], a[56:59], a[184:187], a[12:15]
  v_mfma_f32_16x16x32_bf16 a[16:19], a[64:67], a[184:187], 0
  v_mfma_f32_16x16x32_bf16 a[16:19], a[68:71], a[188:191], a[16:19]
  buffer_load_dwordx4 v5, s[8:11], s3 offen offset:3072 lds
  v_mfma_f32_16x16x32_bf16 a[20:23], a[76:79], a[188:191], 0
  v_mfma_f32_16x16x32_bf16 a[20:23], a[72:75], a[184:187], a[20:23]
  v_mfma_f32_16x16x32_bf16 a[24:27], a[80:83], a[184:187], 0
  v_mfma_f32_16x16x32_bf16 a[24:27], a[84:87], a[188:191], a[24:27]
  v_mfma_f32_16x16x32_bf16 a[28:31], a[92:95], a[188:191], 0
  v_mfma_f32_16x16x32_bf16 a[28:31], a[88:91], a[184:187], a[28:31]
  s_waitcnt lgkmcnt(2)
  v_mfma_f32_16x16x32_bf16 v[32:35], a[96:99], a[160:163], v[32:35]
  s_add_u32 s23, s23, 128
  s_cmp_eq_u32 s23, s25
  s_cselect_b32 s23, s26, s23
  v_mfma_f32_16x16x32_bf16 v[32:35], a[100:103], a[164:167], v[32:35]
  ds_read_b128 a[176:179], v10 offset:36864
  ds_read_b128 a[180:183], v11 offset:36864
  v_mfma_f32_16x16x32_bf16 v[36:39], a[108:111], a[164:167], v[36:39]
  v_mfma_f32_16x16x32_bf16 v[36:39], a[104:107], a[160:163], v[36:39]
  ds_read_b64_tr_b16 a[32:33], v12 offset:0
  ds_read_b64_tr_b16 a[34:35], v12 offset:2048
  v_mfma_f32_16x16x32_bf16 v[40:43], a[112:115], a[160:163], v[40:43]
  v_mfma_f32_16x16x32_bf16 v[40:43], a[116:119], a[164:167], v[40:43]
  v_mfma_f32_16x16x32_bf16 v[44:47], a[124:127], a[164:167], v[44:47]
  s_add_u32 m0, s29, 114688
  s_nop 0
  buffer_load_dwordx4 v6, s[12:15], s24 offen offset:0 lds
  v_mfma_f32_16x16x32_bf16 v[44:47], a[120:123], a[160:163], v[44:47]
  ds_read_b64_tr_b16 a[40:41], v13 offset:0
  ds_read_b64_tr_b16 a[42:43], v13 offset:2048
  v_mfma_f32_16x16x32_bf16 v[48:51], a[128:131], a[160:163], v[48:51]
  v_mfma_f32_16x16x32_bf16 v[48:51], a[132:135], a[164:167], v[48:51]
  v_mfma_f32_16x16x32_bf16 v[52:55], a[140:143], a[164:167], v[52:55]
  v_mfma_f32_16x16x32_bf16 v[52:55], a[136:139], a[160:163], v[52:55]
  ds_read_b64_tr_b16 a[48:49], v14 offset:0
  ds_read_b64_tr_b16 a[50:51], v14 offset:2048
  v_mfma_f32_16x16x32_bf16 v[56:59], a[144:147], a[160:163], v[56:59]
  v_mfma_f32_16x16x32_bf16 v[56:59], a[148:151], a[164:167], v[56:59]
  buffer_load_dwordx4 v7, s[12:15], s24 offen offset:1024 lds
  v_mfma_f32_16x16x32_bf16 v[60:63], a[156:159], a[164:167], v[60:63]
  v_mfma_f32_16x16x32_bf16 v[60:63], a[152:155], a[160:163], v[60:63]
  s_waitcnt lgkmcnt(8)
  ds_read_b64_tr_b16 a[56:57], v15 offset:0
  ds_read_b64_tr_b16 a[58:59], v15 offset:2048
  v_mfma_f32_16x16x32_bf16 v[64:67], a[96:99], a[168:171], v[64:67]
  v_mfma_f32_16x16x32_bf16 v[64:67], a[100:103], a[172:175], v[64:67]
  ds_read_b128 a[184:187], v10 offset:38912
  ds_read_b128 a[188:191], v11 offset:38912
  v_mfma_f32_16x16x32_bf16 v[68:71], a[108:111], a[172:175], v[68:71]
  v_mfma_f32_16x16x32_bf16 v[68:71], a[104:107], a[168:171], v[68:71]
  ds_read_b64_tr_b16 a[64:65], v16 offset:0
  ds_read_b64_tr_b16 a[66:67], v16 offset:2048
  v_mfma_f32_16x16x32_bf16 v[72:75], a[112:115], a[168:171], v[72:75]
  buffer_load_dwordx4 v8, s[12:15], s24 offen offset:2048 lds
  v_mfma_f32_16x16x32_bf16 v[72:75], a[116:119], a[172:175], v[72:75]
  v_mfma_f32_16x16x32_bf16 v[76:79], a[124:127], a[172:175], v[76:79]
  v_mfma_f32_16x16x32_bf16 v[76:79], a[120:123], a[168:171], v[76:79]
  ds_read_b64_tr_b16 a[72:73], v17 offset:0
  ds_read_b64_tr_b16 a[74:75], v17 offset:2048
  v_mfma_f32_16x16x32_bf16 v[80:83], a[128:131], a[168:171], v[80:83]
  v_mfma_f32_16x16x32_bf16 v[80:83], a[132:135], a[172:175], v[80:83]
  v_mfma_f32_16x16x32_bf16 v[84:87], a[140:143], a[172:175], v[84:87]
  buffer_load_dwordx4 v9, s[12:15], s24 offen offset:3072 lds
  v_mfma_f32_16x16x32_bf16 v[84:87], a[136:139], a[168:171], v[84:87]
  ds_read_b64_tr_b16 a[80:81], v18 offset:0
  ds_read_b64_tr_b16 a[82:83], v18 offset:2048
  v_mfma_f32_16x16x32_bf16 v[88:91], a[144:147], a[168:171], v[88:91]
  v_mfma_f32_16x16x32_bf16 v[88:91], a[148:151], a[172:175], v[88:91]
  v_mfma_f32_16x16x32_bf16 v[92:95], a[156:159], a[172:175], v[92:95]
  v_mfma_f32_16x16x32_bf16 v[92:95], a[152:155], a[168:171], v[92:95]
  s_waitcnt lgkmcnt(15)
  ds_read_b64_tr_b16 a[88:89], v19 offset:0
  ds_read_b64_tr_b16 a[90:91], v19 offset:2048
  v_mfma_f32_16x16x32_bf16 v[96:99], a[96:99], a[176:179], v[96:99]
  s_add_u32 s24, s24, 262144
  s_cmp_eq_u32 s24, s27
  s_cselect_b32 s24, s28, s24
  s_cselect_b64 s[12:13], s[64:65], s[12:13]
  v_mfma_f32_16x16x32_bf16 v[96:99], a[100:103], a[180:183], v[96:99]
  v_mfma_f32_16x16x32_bf16 v[100:103], a[108:111], a[180:183], v[100:103]
  v_mfma_f32_16x16x32_bf16 v[100:103], a[104:107], a[176:179], v[100:103]
  v_mfma_f32_16x16x32_bf16 v[104:107], a[112:115], a[176:179], v[104:107]
  v_mfma_f32_16x16x32_bf16 v[104:107], a[116:119], a[180:183], v[104:107]
  v_mfma_f32_16x16x32_bf16 v[108:111], a[124:127], a[180:183], v[108:111]
  v_mfma_f32_16x16x32_bf16 v[108:111], a[120:123], a[176:179], v[108:111]
  s_waitcnt vmcnt(17) lgkmcnt(0)
  s_barrier
  ds_read_b128 a[160:163], v10 offset:49152
  ds_read_b128 a[164:167], v11 offset:49152
  v_mfma_f32_16x16x32_bf16 v[112:115], a[128:131], a[176:179], v[112:115]
  s_add_u32 m0, s29, 32768
  s_nop 0
  buffer_load_dwordx4 v2, s[8:11], s23 offen offset:0 lds
  v_mfma_f32_16x16x32_bf16 v[112:115], a[132:135], a[180:183], v[112:115]
  v_mfma_f32_16x16x32_bf16 v[116:119], a[140:143], a[180:183], v[116:119]
  v_mfma_f32_16x16x32_bf16 v[116:119], a[136:139], a[176:179], v[116:119]
  ds_read_b64_tr_b16 a[36:37], v12 offset:16384
  ds_read_b64_tr_b16 a[38:39], v12 offset:18432
  v_mfma_f32_16x16x32_bf16 v[120:123], a[144:147], a[176:179], v[120:123]
  v_mfma_f32_16x16x32_bf16 v[120:123], a[148:151], a[180:183], v[120:123]
  buffer_load_dwordx4 v3, s[8:11], s23 offen offset:1024 lds
  v_mfma_f32_16x16x32_bf16 v[124:127], a[156:159], a[180:183], v[124:127]
  v_mfma_f32_16x16x32_bf16 v[124:127], a[152:155], a[176:179], v[124:127]
  v_mfma_f32_16x16x32_bf16 v[128:131], a[96:99], a[184:187], v[128:131]
  v_mfma_f32_16x16x32_bf16 v[128:131], a[100:103], a[188:191], v[128:131]
  ds_read_b128 a[168:171], v10 offset:51200
  ds_read_b128 a[172:175], v11 offset:51200
  ds_read_b64_tr_b16 a[44:45], v13 offset:16384
  ds_read_b64_tr_b16 a[46:47], v13 offset:18432
  v_mfma_f32_16x16x32_bf16 v[132:135], a[108:111], a[188:191], v[132:135]
  v_mfma_f32_16x16x32_bf16 v[132:135], a[104:107], a[184:187], v[132:135]
  buffer_load_dwordx4 v4, s[8:11], s23 offen offset:2048 lds
  v_mfma_f32_16x16x32_bf16 v[136:139], a[112:115], a[184:187], v[136:139]
  v_mfma_f32_16x16x32_bf16 v[136:139], a[116:119], a[188:191], v[136:139]
  v_mfma_f32_16x16x32_bf16 v[140:143], a[124:127], a[188:191], v[140:143]
  v_mfma_f32_16x16x32_bf16 v[140:143], a[120:123], a[184:187], v[140:143]
  ds_read_b64_tr_b16 a[52:53], v14 offset:16384
  ds_read_b64_tr_b16 a[54:55], v14 offset:18432
  v_mfma_f32_16x16x32_bf16 v[144:147], a[128:131], a[184:187], v[144:147]
  v_mfma_f32_16x16x32_bf16 v[144:147], a[132:135], a[188:191], v[144:147]
  buffer_load_dwordx4 v5, s[8:11], s23 offen offset:3072 lds
  v_mfma_f32_16x16x32_bf16 v[148:151], a[140:143], a[188:191], v[148:151]
  v_mfma_f32_16x16x32_bf16 v[148:151], a[136:139], a[184:187], v[148:151]
  v_mfma_f32_16x16x32_bf16 v[152:155], a[144:147], a[184:187], v[152:155]
  v_mfma_f32_16x16x32_bf16 v[152:155], a[148:151], a[188:191], v[152:155]
  ds_read_b64_tr_b16 a[60:61], v15 offset:16384
  ds_read_b64_tr_b16 a[62:63], v15 offset:18432
  v_mfma_f32_16x16x32_bf16 v[156:159], a[156:159], a[188:191], v[156:159]
  s_add_u32 m0, s29, 65536
  s_nop 0
  buffer_load_dwordx4 v6, s[12:15], s24 offen offset:0 lds
  v_mfma_f32_16x16x32_bf16 v[156:159], a[152:155], a[184:187], v[156:159]
  s_waitcnt lgkmcnt(10)
  v_mfma_f32_16x16x32_bf16 v[160:163], a[96:99], a[160:163], v[160:163]
  v_mfma_f32_16x16x32_bf16 v[160:163], a[100:103], a[164:167], v[160:163]
  ds_read_b128 a[176:179], v10 offset:53248
  ds_read_b128 a[180:183], v11 offset:53248
  v_mfma_f32_16x16x32_bf16 v[164:167], a[108:111], a[164:167], v[164:167]
  v_mfma_f32_16x16x32_bf16 v[164:167], a[104:107], a[160:163], v[164:167]
  ds_read_b64_tr_b16 a[68:69], v16 offset:16384
  ds_read_b64_tr_b16 a[70:71], v16 offset:18432
  v_mfma_f32_16x16x32_bf16 v[168:171], a[112:115], a[160:163], v[168:171]
  v_mfma_f32_16x16x32_bf16 v[168:171], a[116:119], a[164:167], v[168:171]
  buffer_load_dwordx4 v7, s[12:15], s24 offen offset:1024 lds
  v_mfma_f32_16x16x32_bf16 v[172:175], a[124:127], a[164:167], v[172:175]
  v_mfma_f32_16x16x32_bf16 v[172:175], a[120:123], a[160:163], v[172:175]
  v_mfma_f32_16x16x32_bf16 v[176:179], a[128:131], a[160:163], v[176:179]
  v_mfma_f32_16x16x32_bf16 v[176:179], a[132:135], a[164:167], v[176:179]
  ds_read_b64_tr_b16 a[76:77], v17 offset:16384
  ds_read_b64_tr_b16 a[78:79], v17 offset:18432
  v_mfma_f32_16x16x32_bf16 v[180:183], a[140:143], a[164:167], v[180:183]
  v_mfma_f32_16x16x32_bf16 v[180:183], a[136:139], a[160:163], v[180:183]
  buffer_load_dwordx4 v8, s[12:15], s24 offen offset:2048 lds
  v_mfma_f32_16x16x32_bf16 v[184:187], a[144:147], a[160:163], v[184:187]
  v_mfma_f32_16x16x32_bf16 v[184:187], a[148:151], a[164:167], v[184:187]
  v_mfma_f32_16x16x32_bf16 v[188:191], a[156:159], a[164:167], v[188:191]
  v_mfma_f32_16x16x32_bf16 v[188:191], a[152:155], a[160:163], v[188:191]
  s_waitcnt lgkmcnt(12)
  ds_read_b64_tr_b16 a[84:85], v18 offset:16384
  ds_read_b64_tr_b16 a[86:87], v18 offset:18432
  v_mfma_f32_16x16x32_bf16 v[192:195], a[96:99], a[168:171], v[192:195]
  buffer_load_dwordx4 v9, s[12:15], s24 offen offset:3072 lds
  v_mfma_f32_16x16x32_bf16 v[192:195], a[100:103], a[172:175], v[192:195]
  ds_read_b128 a[184:187], v10 offset:55296
  ds_read_b128 a[188:191], v11 offset:55296
  v_mfma_f32_16x16x32_bf16 v[196:199], a[108:111], a[172:175], v[196:199]
  v_mfma_f32_16x16x32_bf16 v[196:199], a[104:107], a[168:171], v[196:199]
  v_mfma_f32_16x16x32_bf16 v[200:203], a[112:115], a[168:171], v[200:203]
  v_mfma_f32_16x16x32_bf16 v[200:203], a[116:119], a[172:175], v[200:203]
  ds_read_b64_tr_b16 a[92:93], v19 offset:16384
  ds_read_b64_tr_b16 a[94:95], v19 offset:18432
  v_mfma_f32_16x16x32_bf16 v[204:207], a[124:127], a[172:175], v[204:207]
  s_add_u32 s24, s24, 262144
  v_mfma_f32_16x16x32_bf16 v[204:207], a[120:123], a[168:171], v[204:207]
  v_mfma_f32_16x16x32_bf16 v[208:211], a[128:131], a[168:171], v[208:211]
  v_mfma_f32_16x16x32_bf16 v[208:211], a[132:135], a[172:175], v[208:211]
  v_mfma_f32_16x16x32_bf16 v[212:215], a[140:143], a[172:175], v[212:215]
  v_mfma_f32_16x16x32_bf16 v[212:215], a[136:139], a[168:171], v[212:215]
  buffer_load_dword v21, v20, s[60:63], s54 offen
  s_add_u32 s54, s54, s55
  v_mfma_f32_16x16x32_bf16 v[216:219], a[144:147], a[168:171], v[216:219]
  v_mfma_f32_16x16x32_bf16 v[216:219], a[148:151], a[172:175], v[216:219]
  v_mfma_f32_16x16x32_bf16 v[220:223], a[156:159], a[172:175], v[220:223]
  v_mfma_f32_16x16x32_bf16 v[220:223], a[152:155], a[168:171], v[220:223]
  s_waitcnt lgkmcnt(10)
  v_mfma_f32_16x16x32_bf16 v[224:227], a[96:99], a[176:179], v[224:227]
  s_cmp_eq_u32 s54, s56
  s_cselect_b32 s54, s57, s54
  s_cselect_b64 s[60:61], s[58:59], s[60:61]
  s_cselect_b32 s62, s7, s62
  v_mfma_f32_16x16x32_bf16 v[224:227], a[100:103], a[180:183], v[224:227]
  v_mfma_f32_16x16x32_bf16 v[228:231], a[108:111], a[180:183], v[228:231]
  v_mfma_f32_16x16x32_bf16 v[228:231], a[104:107], a[176:179], v[228:231]
  v_mfma_f32_16x16x32_bf16 v[232:235], a[112:115], a[176:179], v[232:235]
  v_mfma_f32_16x16x32_bf16 v[232:235], a[116:119], a[180:183], v[232:235]
  v_mfma_f32_16x16x32_bf16 v[236:239], a[124:127], a[180:183], v[236:239]
  v_mfma_f32_16x16x32_bf16 v[236:239], a[120:123], a[176:179], v[236:239]
  s_waitcnt vmcnt(18) lgkmcnt(0)
  s_barrier
  ds_read_b128 a[160:163], v10 offset:0
  ds_read_b128 a[164:167], v11 offset:0
  v_mfma_f32_16x16x32_bf16 v[240:243], a[128:131], a[176:179], v[240:243]
  s_add_u32 m0, s29, 49152
  s_add_u32 s3, s23, s31
  buffer_load_dwordx4 v2, s[8:11], s3 offen offset:0 lds
  v_mfma_f32_16x16x32_bf16 v[240:243], a[132:135], a[180:183], v[240:243]
  v_mfma_f32_16x16x32_bf16 v[244:247], a[140:143], a[180:183], v[244:247]
  v_mfma_f32_16x16x32_bf16 v[244:247], a[136:139], a[176:179], v[244:247]
  v_mfma_f32_16x16x32_bf16 v[248:251], a[144:147], a[176:179], v[248:251]
  v_mfma_f32_16x16x32_bf16 v[248:251], a[148:151], a[180:183], v[248:251]
  buffer_load_dwordx4 v3, s[8:11], s3 offen offset:1024 lds
  v_mfma_f32_16x16x32_bf16 v[252:255], a[156:159], a[180:183], v[252:255]
  v_mfma_f32_16x16x32_bf16 v[252:255], a[152:155], a[176:179], v[252:255]
  v_mfma_f32_16x16x32_bf16 a[0:3], a[96:99], a[184:187], a[0:3]
  v_mfma_f32_16x16x32_bf16 a[0:3], a[100:103], a[188:191], a[0:3]
  ds_read_b128 a[168:171], v10 offset:2048
  ds_read_b128 a[172:175], v11 offset:2048
  v_mfma_f32_16x16x32_bf16 a[4:7], a[108:111], a[188:191], a[4:7]
  v_mfma_f32_16x16x32_bf16 a[4:7], a[104:107], a[184:187], a[4:7]
  v_mfma_f32_16x16x32_bf16 a[8:11], a[112:115], a[184:187], a[8:11]
  buffer_load_dwordx4 v4, s[8:11], s3 offen offset:2048 lds
  v_mfma_f32_16x16x32_bf16 a[8:11], a[116:119], a[188:191], a[8:11]
  v_mfma_f32_16x16x32_bf16 a[12:15], a[124:127], a[188:191], a[12:15]
  v_mfma_f32_16x16x32_bf16 a[12:15], a[120:123], a[184:187], a[12:15]
  v_mfma_f32_16x16x32_bf16 a[16:19], a[128:131], a[184:187], a[16:19]
  v_mfma_f32_16x16x32_bf16 a[16:19], a[132:135], a[188:191], a[16:19]
  buffer_load_dwordx4 v5, s[8:11], s3 offen offset:3072 lds
  v_mfma_f32_16x16x32_bf16 a[20:23], a[140:143], a[188:191], a[20:23]
  v_mfma_f32_16x16x32_bf16 a[20:23], a[136:139], a[184:187], a[20:23]
  v_mfma_f32_16x16x32_bf16 a[24:27], a[144:147], a[184:187], a[24:27]
  v_mfma_f32_16x16x32_bf16 a[24:27], a[148:151], a[188:191], a[24:27]
  v_mfma_f32_16x16x32_bf16 a[28:31], a[156:159], a[188:191], a[28:31]
  v_mfma_f32_16x16x32_bf16 a[28:31], a[152:155], a[184:187], a[28:31]
  s_waitcnt lgkmcnt(2)
  s_mov_b32 s30, 3
Lk1_kl:
  v_mfma_f32_16x16x32_bf16 v[32:35], a[32:35], a[160:163], v[32:35]
  s_add_u32 s23, s23, 128
  s_cmp_eq_u32 s23, s25
  s_cselect_b32 s23, s26, s23
  v_mfma_f32_16x16x32_bf16 v[32:35], a[36:39], a[164:167], v[32:35]
  ds_read_b128 a[176:179], v10 offset:4096
  ds_read_b128 a[180:183], v11 offset:4096
  v_mfma_f32_16x16x32_bf16 v[36:39], a[44:47], a[164:167], v[36:39]
  v_mfma_f32_16x16x32_bf16 v[36:39], a[40:43], a[160:163], v[36:39]
  ds_read_b64_tr_b16 a[96:97], v12 offset:32768
  ds_read_b64_tr_b16 a[98:99], v12 offset:34816
  v_mfma_f32_16x16x32_bf16 v[40:43], a[48:51], a[160:163], v[40:43]
  v_mfma_f32_16x16x32_bf16 v[40:43], a[52:55], a[164:167], v[40:43]
  v_mfma_f32_16x16x32_bf16 v[44:47], a[60:63], a[164:167], v[44:47]
  s_add_u32 m0, s29, 81920
  s_nop 0
  buffer_load_dwordx4 v6, s[12:15], s24 offen offset:0 lds
  v_mfma_f32_16x16x32_bf16 v[44:47], a[56:59], a[160:163], v[44:47]
  ds_read_b64_tr_b16 a[104:105], v13 offset:32768
  ds_read_b64_tr_b16 a[106:107], v13 offset:34816
  v_mfma_f32_16x16x32_bf16 v[48:51], a[64:67], a[160:163], v[48:51]
  v_mfma_f32_16x16x32_bf16 v[48:51], a[68:71], a[164:167], v[48:51]
  v_mfma_f32_16x16x32_bf16 v[52:55], a[76:79], a[164:167], v[52:55]
  v_mfma_f32_16x16x32_bf16 v[52:55], a[72:75], a[160:163], v[52:55]
  ds_read_b64_tr_b16 a[112:113], v14 offset:32768
  ds_read_b64_tr_b16 a[114:115], v14 offset:34816
  v_mfma_f32_16x16x32_bf16 v[56:59], a[80:83], a[160:163], v[56:59]
  v_mfma_f32_16x16x32_bf16 v[56:59], a[84:87], a[164:167], v[56:59]
  buffer_load_dwordx4 v7, s[12:15], s24 offen offset:1024 lds
  v_mfma_f32_16x16x32_bf16 v[60:63], a[92:95], a[164:167], v[60:63]
  v_mfma_f32_16x16x32_bf16 v[60:63], a[88:91], a[160:163], v[60:63]
  s_waitcnt lgkmcnt(8)
  ds_read_b64_tr_b16 a[120:121], v15 offset:32768
  ds_read_b64_tr_b16 a[122:123], v15 offset:34816
  v_mfma_f32_16x16x32_bf16 v[64:67], a[32:35], a[168:171], v[64:67]
  v_mfma_f32_16x16x32_bf16 v[64:67], a[36:39], a[172:175], v[64:67]
  ds_read_b128 a[184:187], v10 offset:6144
  ds_read_b128 a[188:191], v11 offset:6144
  v_mfma_f32_16x16x32_bf16 v[68:71], a[44:47], a[172:175], v[68:71]
  v_mfma_f32_16x16x32_bf16 v[68:71], a[40:43], a[168:171], v[68:71]
  ds_read_b64_tr_b16 a[128:129], v16 offset:32768
  ds_read_b64_tr_b16 a[130:131], v16 offset:34816
  v_mfma_f32_16x16x32_bf16 v[72:75], a[48:51], a[168:171], v[72:75]
  buffer_load_dwordx4 v8, s[12:15], s24 offen offset:2048 lds
  v_mfma_f32_16x16x32_bf16 v[72:75], a[52:55], a[172:175], v[72:75]
  v_mfma_f32_16x16x32_bf16 v[76:79], a[60:63], a[172:175], v[76:79]
  v_mfma_f32_16x16x32_bf16 v[76:79], a[56:59], a[168:171], v[76:79]
  ds_read_b64_tr_b16 a[136:137], v17 offset:32768
  ds_read_b64_tr_b16 a[138:139], v17 offset:34816
  v_mfma_f32_16x16x32_bf16 v[80:83], a[64:67], a[168:171], v[80:83]
  v_mfma_f32_16x16x32_bf16 v[80:83], a[68:71], a[172:175], v[80:83]
  v_mfma_f32_16x16x32_bf16 v[84:87], a[76:79], a[172:175], v[84:87]
  buffer_load_dwordx4 v9, s[12:15], s24 offen offset:3072 lds
  v_mfma_f32_16x16x32_bf16 v[84:87], a[72:75], a[168:171], v[84:87]
  ds_read_b64_tr_b16 a[144:145], v18 offset:32768
  ds_read_b64_tr_b16 a[146:147], v18 offset:34816
  v_mfma_f32_16x16x32_bf16 v[88:91], a[80:83], a[168:171], v[88:91]
  v_mfma_f32_16x16x32_bf16 v[88:91], a[84:87], a[172:175], v[88:91]
  v_mfma_f32_16x16x32_bf16 v[92:95], a[92:95], a[172:175], v[92:95]
  v_mfma_f32_16x16x32_bf16 v[92:95], a[88:91], a[168:171], v[92:95]
  s_waitcnt lgkmcnt(15)
  ds_read_b64_tr_b16 a[152:153], v19 offset:32768
  ds_read_b64_tr_b16 a[154:155], v19 offset:34816
  v_mfma_f32_16x16x32_bf16 v[96:99], a[32:35], a[176:179], v[96:99]
  s_add_u32 s24, s24, 262144
  s_cmp_eq_u32 s24, s27
  s_cselect_b32 s24, s28, s24
  s_cselect_b64 s[12:13], s[64:65], s[12:13]
  v_mfma_f32_16x16x32_bf16 v[96:99], a[36:39], a[180:183], v[96:99]
  v_mfma_f32_16x16x32_bf16 v[100:103], a[44:47], a[180:183], v[100:103]
  v_mfma_f32_16x16x32_bf16 v[100:103], a[40:43], a[176:179], v[100:103]
  v_mfma_f32_16x16x32_bf16 v[104:107], a[48:51], a[176:179], v[104:107]
  v_mfma_f32_16x16x32_bf16 v[104:107], a[52:55], a[180:183], v[104:107]
  v_mfma_f32_16x16x32_bf16 v[108:111], a[60:63], a[180:183], v[108:111]
  v_mfma_f32_16x16x32_bf16 v[108:111], a[56:59], a[176:179], v[108:111]
  s_waitcnt vmcnt(17) lgkmcnt(0)
  s_barrier
  ds_read_b128 a[160:163], v10 offset:16384
  ds_read_b128 a[164:167], v11 offset:16384
  v_mfma_f32_16x16x32_bf16 v[112:115], a[64:67], a[176:179], v[112:115]
  s_add_u32 m0, s29, 0
  s_nop 0
  buffer_load_dwordx4 v2, s[8:11], s23 offen offset:0 lds
  v_mfma_f32_16x16x32_bf16 v[112:115], a[68:71], a[180:183], v[112:115]
  v_mfma_f32_16x16x32_bf16 v[116:119], a[76:79], a[180:183], v[116:119]
  v_mfma_f32_16x16x32_bf16 v[116:119], a[72:75], a[176:179], v[116:119]
  ds_read_b64_tr_b16 a[100:101], v12 offset:49152
  ds_read_b64_tr_b16 a[102:103], v12 offset:51200
  v_mfma_f32_16x16x32_bf16 v[120:123], a[80:83], a[176:179], v[120:123]
  v_mfma_f32_16x16x32_bf16 v[120:123], a[84:87], a[180:183], v[120:123]
  buffer_load_dwordx4 v3, s[8:11], s23 offen offset:1024 lds
  v_mfma_f32_16x16x32_bf16 v[124:127], a[92:95], a[180:183], v[124:127]
  v_mfma_f32_16x16x32_bf16 v[124:127], a[88:91], a[176:179], v[124:127]
  v_mfma_f32_16x16x32_bf16 v[128:131], a[32:35], a[184:187], v[128:131]
  v_mfma_f32_16x16x32_bf16 v[128:131], a[36:39], a[188:191], v[128:131]
  ds_read_b128 a[168:171], v10 offset:18432
  ds_read_b128 a[172:175], v11 offset:18432
  ds_read_b64_tr_b16 a[108:109], v13 offset:49152
  ds_read_b64_tr_b16 a[110:111], v13 offset:51200
  v_mfma_f32_16x16x32_bf16 v[132:135], a[44:47], a[188:191], v[132:135]
  v_mfma_f32_16x16x32_bf16 v[132:135], a[40:43], a[184:187], v[132:135]
  buffer_load_dwordx4 v4, s[8:11], s23 offen offset:2048 lds
  v_mfma_f32_16x16x32_bf16 v[136:139], a[48:51], a[184:187], v[136:139]
  v_mfma_f32_16x16x32_bf16 v[136:139], a[52:55], a[188:191], v[136:139]
  v_mfma_f32_16x16x32_bf16 v[140:143], a[60:63], a[188:191], v[140:143]
  v_mfma_f32_16x16x32_bf16 v[140:143], a[56:59], a[184:187], v[140:143]
  ds_read_b64_tr_b16 a[116:117], v14 offset:49152
  ds_read_b64_tr_b16 a[118:119], v14 offset:51200
  v_mfma_f32_16x16x32_bf16 v[144:147], a[64:67], a[184:187], v[144:147]
  v_mfma_f32_16x16x32_bf16 v[144:147], a[68:71], a[188:191], v[144:147]
  buffer_load_dwordx4 v5, s[8:11], s23 offen offset:3072 lds
  v_mfma_f32_16x16x32_bf16 v[148:151], a[76:79], a[188:191], v[148:151]
  v_mfma_f32_16x16x32_bf16 v[148:151], a[72:75], a[184:187], v[148:151]
  v_mfma_f32_16x16x32_bf16 v[152:155], a[80:83], a[184:187], v[152:155]
  v_mfma_f32_16x16x32_bf16 v[152:155], a[84:87], a[188:191], v[152:155]
  ds_read_b64_tr_b16 a[124:125], v15 offset:49152
  ds_read_b64_tr_b16 a[126:127], v15 offset:51200
  v_mfma_f32_16x16x32_bf16 v[156:159], a[92:95], a[188:191], v[156:159]
  s_add_u32 m0, s29, 98304
  s_nop 0
  buffer_load_dwordx4 v6, s[12:15], s24 offen offset:0 lds
  v_mfma_f32_16x16x32_bf16 v[156:159], a[88:91], a[184:187], v[156:159]
  s_waitcnt lgkmcnt(10)
  v_mfma_f32_16x16x32_bf16 v[160:163], a[32:35], a[160:163], v[160:163]
  v_mfma_f32_16x16x32_bf16 v[160:163], a[36:39], a[164:167], v[160:163]
  ds_read_b128 a[176:179], v10 offset:20480
  ds_read_b128 a[180:183], v11 offset:20480
  v_mfma_f32_16x16x32_bf16 v[164:167], a[44:47], a[164:167], v[164:167]
  v_mfma_f32_16x16x32_bf16 v[164:167], a[40:43], a[160:163], v[164:167]
  ds_read_b64_tr_b16 a[132:133], v16 offset:49152
  ds_read_b64_tr_b16 a[134:135], v16 offset:51200
  v_mfma_f32_16x16x32_bf16 v[168:171], a[48:51], a[160:163], v[168:171]
  v_mfma_f32_16x16x32_bf16 v[168:171], a[52:55], a[164:167], v[168:171]
  buffer_load_dwordx4 v7, s[12:15], s24 offen offset:1024 lds
  v_mfma_f32_16x16x32_bf16 v[172:175], a[60:63], a[164:167], v[172:175]
  v_mfma_f32_16x16x32_bf16 v[172:175], a[56:59], a[160:163], v[172:175]
  v_mfma_f32_16x16x32_bf16 v[176:179], a[64:67], a[160:163], v[176:179]
  v_mfma_f32_16x16x32_bf16 v[176:179], a[68:71], a[164:167], v[176:179]
  ds_read_b64_tr_b16 a[140:141], v17 offset:49152
  ds_read_b64_tr_b16 a[142:143], v17 offset:51200
  v_mfma_f32_16x16x32_bf16 v[180:183], a[76:79], a[164:167], v[180:183]
  v_mfma_f32_16x16x32_bf16 v[180:183], a[72:75], a[160:163], v[180:183]
  buffer_load_dwordx4 v8, s[12:15], s24 offen offset:2048 lds
  v_mfma_f32_16x16x32_bf16 v[184:187], a[80:83], a[160:163], v[184:187]
  v_mfma_f32_16x16x32_bf16 v[184:187], a[84:87], a[164:167], v[184:187]
  v_mfma_f32_16x16x32_bf16 v[188:191], a[92:95], a[164:167], v[188:191]
  v_mfma_f32_16x16x32_bf16 v[188:191], a[88:91], a[160:163], v[188:191]
  s_waitcnt lgkmcnt(12)
  ds_read_b64_tr_b16 a[148:149], v18 offset:49152
  ds_read_b64_tr_b16 a[150:151], v18 offset:51200
  v_mfma_f32_16x16x32_bf16 v[192:195], a[32:35], a[168:171], v[192:195]
  buffer_load_dwordx4 v9, s[12:15], s24 offen offset:3072 lds
  v_mfma_f32_16x16x32_bf16 v[192:195], a[36:39], a[172:175], v[192:195]
  ds_read_b128 a[184:187], v10 offset:22528
  ds_read_b128 a[188:191], v11 offset:22528
  v_mfma_f32_16x16x32_bf16 v[196:199], a[44:47], a[172:175], v[196:199]
  v_mfma_f32_16x16x32_bf16 v[196:199], a[40:43], a[168:171], v[196:199]
  v_mfma_f32_16x16x32_bf16 v[200:203], a[48:51], a[168:171], v[200:203]
  v_mfma_f32_16x16x32_bf16 v[200:203], a[52:55], a[172:175], v[200:203]
  ds_read_b64_tr_b16 a[156:157], v19 offset:49152
  ds_read_b64_tr_b16 a[158:159], v19 offset:51200
  v_mfma_f32_16x16x32_bf16 v[204:207], a[60:63], a[172:175], v[204:207]
  s_add_u32 s24, s24, 262144
  v_mfma_f32_16x16x32_bf16 v[204:207], a[56:59], a[168:171], v[204:207]
  v_mfma_f32_16x16x32_bf16 v[208:211], a[64:67], a[168:171], v[208:211]
  v_mfma_f32_16x16x32_bf16 v[208:211], a[68:71], a[172:175], v[208:211]
  v_mfma_f32_16x16x32_bf16 v[212:215], a[76:79], a[172:175], v[212:215]
  v_mfma_f32_16x16x32_bf16 v[212:215], a[72:75], a[168:171], v[212:215]
  buffer_load_dword v21, v20, s[60:63], s54 offen
  s_add_u32 s54, s54, s55
  v_mfma_f32_16x16x32_bf16 v[216:219], a[80:83], a[168:171], v[216:219]
  v_mfma_f32_16x16x32_bf16 v[216:219], a[84:87], a[172:175], v[216:219]
  v_mfma_f32_16x16x32_bf16 v[220:223], a[92:95], a[172:175], v[220:223]
  v_mfma_f32_16x16x32_bf16 v[220:223], a[88:91], a[168:171], v[220:223]
  s_waitcnt lgkmcnt(10)
  v_mfma_f32_16x16x32_bf16 v[224:227], a[32:35], a[176:179], v[224:227]
  s_cmp_eq_u32 s54, s56
  s_cselect_b32 s54, s57, s54
  s_cselect_b64 s[60:61], s[58:59], s[60:61]
  s_cselect_b32 s62, s7, s62
  v_mfma_f32_16x16x32_bf16 v[224:227], a[36:39], a[180:183], v[224:227]
  v_mfma_f32_16x16x32_bf16 v[228:231], a[44:47], a[180:183], v[228:231]
  v_mfma_f32_16x16x32_bf16 v[228:231], a[40:43], a[176:179], v[228:231]
  v_mfma_f32_16x16x32_bf16 v[232:235], a[48:51], a[176:179], v[232:235]
  v_mfma_f32_16x16x32_bf16 v[232:235], a[52:55], a[180:183], v[232:235]
  v_mfma_f32_16x16x32_bf16 v[236:239], a[60:63], a[180:183], v[236:239]
  v_mfma_f32_16x16x32_bf16 v[236:239], a[56:59], a[176:179], v[236:239]
  s_waitcnt vmcnt(18) lgkmcnt(0)
  s_barrier
  ds_read_b128 a[160:163], v10 offset:32768
  ds_read_b128 a[164:167], v11 offset:32768
  v_mfma_f32_16x16x32_bf16 v[240:243], a[64:67], a[176:179], v[240:243]
  s_add_u32 m0, s29, 16384
  s_add_u32 s3, s23, s31
  buffer_load_dwordx4 v2, s[8:11], s3 offen offset:0 lds
  v_mfma_f32_16x16x32_bf16 v[240:243], a[68:71], a[180:183], v[240:243]
  v_mfma_f32_16x16x32_bf16 v[244:247], a[76:79], a[180:183], v[244:247]
  v_mfma_f32_16x16x32_bf16 v[244:247], a[72:75], a[176:179], v[244:247]
  v_mfma_f32_16x16x32_bf16 v[248:251], a[80:83], a[176:179], v[248:251]
  v_mfma_f32_16x16x32_bf16 v[248:251], a[84:87], a[180:183], v[248:251]
  buffer_load_dwordx4 v3, s[8:11], s3 offen offset:1024 lds
  v_mfma_f32_16x16x32_bf16 v[252:255], a[92:95], a[180:183], v[252:255]
  v_mfma_f32_16x16x32_bf16 v[252:255], a[88:91], a[176:179], v[252:255]
  v_mfma_f32_16x16x32_bf16 a[0:3], a[32:35], a[184:187], a[0:3]
  v_mfma_f32_16x16x32_bf16 a[0:3], a[36:39], a[188:191], a[0:3]
  ds_read_b128 a[168:171], v10 offset:34816
  ds_read_b128 a[172:175], v11 offset:34816
  v_mfma_f32_16x16x32_bf16 a[4:7], a[44:47], a[188:191], a[4:7]
  v_mfma_f32_16x16x32_bf16 a[4:7], a[40:43], a[184:187], a[4:7]
  v_mfma_f32_16x16x32_bf16 a[8:11], a[48:51], a[184:187], a[8:11]
  buffer_load_dwordx4 v4, s[8:11], s3 offen offset:2048 lds
  v_mfma_f32_16x16x32_bf16 a[8:11], a[52:55], a[188:191], a[8:11]
  v_mfma_f32_16x16x32_bf16 a[12:15], a[60:63], a[188:191], a[12:15]
  v_mfma_f32_16x16x32_bf16 a[12:15], a[56:59], a[184:187], a[12:15]
  v_mfma_f32_16x16x32_bf16 a[16:19], a[64:67], a[184:187], a[16:19]
  v_mfma_f32_16x16x32_bf16 a[16:19], a[68:71], a[188:191], a[16:19]
  buffer_load_dwordx4 v5, s[8:11], s3 offen offset:3072 lds
  v_mfma_f32_16x16x32_bf16 a[20:23], a[76:79], a[188:191], a[20:23]
  v_mfma_f32_16x16x32_bf16 a[20:23], a[72:75], a[184:187], a[20:23]
  v_mfma_f32_16x16x32_bf16 a[24:27], a[80:83], a[184:187], a[24:27]
  v_mfma_f32_16x16x32_bf16 a[24:27], a[84:87], a[188:191], a[24:27]
  v_mfma_f32_16x16x32_bf16 a[28:31], a[92:95], a[188:191], a[28:31]
  v_mfma_f32_16x16x32_bf16 a[28:31], a[88:91], a[184:187], a[28:31]
  s_waitcnt lgkmcnt(2)
  v_mfma_f32_16x16x32_bf16 v[32:35], a[96:99], a[160:163], v[32:35]
  s_add_u32 s23, s23, 128
  s_cmp_eq_u32 s23, s25
  s_cselect_b32 s23, s26, s23
  v_mfma_f32_16x16x32_bf16 v[32:35], a[100:103], a[164:167], v[32:35]
  ds_read_b128 a[176:179], v10 offset:36864
  ds_read_b128 a[180:183], v11 offset:36864
  v_mfma_f32_16x16x32_bf16 v[36:39], a[108:111], a[164:167], v[36:39]
  v_mfma_f32_16x16x32_bf16 v[36:39], a[104:107], a[160:163], v[36:39]
  ds_read_b64_tr_b16 a[32:33], v12 offset:0
  ds_read_b64_tr_b16 a[34:35], v12 offset:2048
  v_mfma_f32_16x16x32_bf16 v[40:43], a[112:115], a[160:163], v[40:43]
  v_mfma_f32_16x16x32_bf16 v[40:43], a[116:119], a[164:167], v[40:43]
  v_mfma_f32_16x16x32_bf16 v[44:47], a[124:127], a[164:167], v[44:47]
  s_add_u32 m0, s29, 114688
  s_nop 0
  buffer_load_dwordx4 v6, s[12:15], s24 offen offset:0 lds
  v_mfma_f32_16x16x32_bf16 v[44:47], a[120:123], a[160:163], v[44:47]
  ds_read_b64_tr_b16 a[40:41], v13 offset:0
  ds_read_b64_tr_b16 a[42:43], v13 offset:2048
  v_mfma_f32_16x16x32_bf16 v[48:51], a[128:131], a[160:163], v[48:51]
  v_mfma_f32_16x16x32_bf16 v[48:51], a[132:135], a[164:167], v[48:51]
  v_mfma_f32_16x16x32_bf16 v[52:55], a[140:143], a[164:167], v[52:55]
  v_mfma_f32_16x16x32_bf16 v[52:55], a[136:139], a[160:163], v[52:55]
  ds_read_b64_tr_b16 a[48:49], v14 offset:0
  ds_read_b64_tr_b16 a[50:51], v14 offset:2048
  v_mfma_f32_16x16x32_bf16 v[56:59], a[144:147], a[160:163], v[56:59]
  v_mfma_f32_16x16x32_bf16 v[56:59], a[148:151], a[164:167], v[56:59]
  buffer_load_dwordx4 v7, s[12:15], s24 offen offset:1024 lds
  v_mfma_f32_16x16x32_bf16 v[60:63], a[156:159], a[164:167], v[60:63]
  v_mfma_f32_16x16x32_bf16 v[60:63], a[152:155], a[160:163], v[60:63]
  s_waitcnt lgkmcnt(8)
  ds_read_b64_tr_b16 a[56:57], v15 offset:0
  ds_read_b64_tr_b16 a[58:59], v15 offset:2048
  v_mfma_f32_16x16x32_bf16 v[64:67], a[96:99], a[168:171], v[64:67]
  v_mfma_f32_16x16x32_bf16 v[64:67], a[100:103], a[172:175], v[64:67]
  ds_read_b128 a[184:187], v10 offset:38912
  ds_read_b128 a[188:191], v11 offset:38912
  v_mfma_f32_16x16x32_bf16 v[68:71], a[108:111], a[172:175], v[68:71]
  v_mfma_f32_16x16x32_bf16 v[68:71], a[104:107], a[168:171], v[68:71]
  ds_read_b64_tr_b16 a[64:65], v16 offset:0
  ds_read_b64_tr_b16 a[66:67], v16 offset:2048
  v_mfma_f32_16x16x32_bf16 v[72:75], a[112:115], a[168:171], v[72:75]
  buffer_load_dwordx4 v8, s[12:15], s24 offen offset:2048 lds
  v_mfma_f32_16x16x32_bf16 v[72:75], a[116:119], a[172:175], v[72:75]
  v_mfma_f32_16x16x32_bf16 v[76:79], a[124:127], a[172:175], v[76:79]
  v_mfma_f32_16x16x32_bf16 v[76:79], a[120:123], a[168:171], v[76:79]
  ds_read_b64_tr_b16 a[72:73], v17 offset:0
  ds_read_b64_tr_b16 a[74:75], v17 offset:2048
  v_mfma_f32_16x16x32_bf16 v[80:83], a[128:131], a[168:171], v[80:83]
  v_mfma_f32_16x16x32_bf16 v[80:83], a[132:135], a[172:175], v[80:83]
  v_mfma_f32_16x16x32_bf16 v[84:87], a[140:143], a[172:175], v[84:87]
  buffer_load_dwordx4 v9, s[12:15], s24 offen offset:3072 lds
  v_mfma_f32_16x16x32_bf16 v[84:87], a[136:139], a[168:171], v[84:87]
  ds_read_b64_tr_b16 a[80:81], v18 offset:0
  ds_read_b64_tr_b16 a[82:83], v18 offset:2048
  v_mfma_f32_16x16x32_bf16 v[88:91], a[144:147], a[168:171], v[88:91]
  v_mfma_f32_16x16x32_bf16 v[88:91], a[148:151], a[172:175], v[88:91]
  v_mfma_f32_16x16x32_bf16 v[92:95], a[156:159], a[172:175], v[92:95]
  v_mfma_f32_16x16x32_bf16 v[92:95], a[152:155], a[168:171], v[92:95]
  s_waitcnt lgkmcnt(15)
  ds_read_b64_tr_b16 a[88:89], v19 offset:0
  ds_read_b64_tr_b16 a[90:91], v19 offset:2048
  v_mfma_f32_16x16x32_bf16 v[96:99], a[96:99], a[176:179], v[96:99]
  s_add_u32 s24, s24, 262144
  s_cmp_eq_u32 s24, s27
  s_cselect_b32 s24, s28, s24
  s_cselect_b64 s[12:13], s[64:65], s[12:13]
  v_mfma_f32_16x16x32_bf16 v[96:99], a[100:103], a[180:183], v[96:99]
  v_mfma_f32_16x16x32_bf16 v[100:103], a[108:111], a[180:183], v[100:103]
  v_mfma_f32_16x16x32_bf16 v[100:103], a[104:107], a[176:179], v[100:103]
  v_mfma_f32_16x16x32_bf16 v[104:107], a[112:115], a[176:179], v[104:107]
  v_mfma_f32_16x16x32_bf16 v[104:107], a[116:119], a[180:183], v[104:107]
  v_mfma_f32_16x16x32_bf16 v[108:111], a[124:127], a[180:183], v[108:111]
  v_mfma_f32_16x16x32_bf16 v[108:111], a[120:123], a[176:179], v[108:111]
  s_waitcnt vmcnt(17) lgkmcnt(0)
  s_barrier
  ds_read_b128 a[160:163], v10 offset:49152
  ds_read_b128 a[164:167], v11 offset:49152
  v_mfma_f32_16x16x32_bf16 v[112:115], a[128:131], a[176:179], v[112:115]
  s_add_u32 m0, s29, 32768
  s_nop 0
  buffer_load_dwordx4 v2, s[8:11], s23 offen offset:0 lds
  v_mfma_f32_16x16x32_bf16 v[112:115], a[132:135], a[180:183], v[112:115]
  v_mfma_f32_16x16x32_bf16 v[116:119], a[140:143], a[180:183], v[116:119]
  v_mfma_f32_16x16x32_bf16 v[116:119], a[136:139], a[176:179], v[116:119]
  ds_read_b64_tr_b16 a[36:37], v12 offset:16384
  ds_read_b64_tr_b16 a[38:39], v12 offset:18432
  v_mfma_f32_16x16x32_bf16 v[120:123], a[144:147], a[176:179], v[120:123]
  v_mfma_f32_16x16x32_bf16 v[120:123], a[148:151], a[180:183], v[120:123]
  buffer_load_dwordx4 v3, s[8:11], s23 offen offset:1024 lds
  v_mfma_f32_16x16x32_bf16 v[124:127], a[156:159], a[180:183], v[124:127]
  v_mfma_f32_16x16x32_bf16 v[124:127], a[152:155], a[176:179], v[124:127]
  v_mfma_f32_16x16x32_bf16 v[128:131], a[96:99], a[184:187], v[128:131]
  v_mfma_f32_16x16x32_bf16 v[128:131], a[100:103], a[188:191], v[128:131]
  ds_read_b128 a[168:171], v10 offset:51200
  ds_read_b128 a[172:175], v11 offset:51200
  ds_read_b64_tr_b16 a[44:45], v13 offset:16384
  ds_read_b64_tr_b16 a[46:47], v13 offset:18432
  v_mfma_f32_16x16x32_bf16 v[132:135], a[108:111], a[188:191], v[132:135]
  v_mfma_f32_16x16x32_bf16 v[132:135], a[104:107], a[184:187], v[132:135]
  buffer_load_dwordx4 v4, s[8:11], s23 offen offset:2048 lds
  v_mfma_f32_16x16x32_bf16 v[136:139], a[112:115], a[184:187], v[136:139]
  v_mfma_f32_16x16x32_bf16 v[136:139], a[116:119], a[188:191], v[136:139]
  v_mfma_f32_16x16x32_bf16 v[140:143], a[124:127], a[188:191], v[140:143]
  v_mfma_f32_16x16x32_bf16 v[140:143], a[120:123], a[184:187], v[140:143]
  ds_read_b64_tr_b16 a[52:53], v14 offset:16384
  ds_read_b64_tr_b16 a[54:55], v14 offset:18432
  v_mfma_f32_16x16x32_bf16 v[144:147], a[128:131], a[184:187], v[144:147]
  v_mfma_f32_16x16x32_bf16 v[144:147], a[132:135], a[188:191], v[144:147]
  buffer_load_dwordx4 v5, s[8:11], s23 offen offset:3072 lds
  v_mfma_f32_16x16x32_bf16 v[148:151], a[140:143], a[188:191], v[148:151]
  v_mfma_f32_16x16x32_bf16 v[148:151], a[136:139], a[184:187], v[148:151]
  v_mfma_f32_16x16x32_bf16 v[152:155], a[144:147], a[184:187], v[152:155]
  v_mfma_f32_16x16x32_bf16 v[152:155], a[148:151], a[188:191], v[152:155]
  ds_read_b64_tr_b16 a[60:61], v15 offset:16384
  ds_read_b64_tr_b16 a[62:63], v15 offset:18432
  v_mfma_f32_16x16x32_bf16 v[156:159], a[156:159], a[188:191], v[156:159]
  s_add_u32 m0, s29, 65536
  s_nop 0
  buffer_load_dwordx4 v6, s[12:15], s24 offen offset:0 lds
  v_mfma_f32_16x16x32_bf16 v[156:159], a[152:155], a[184:187], v[156:159]
  s_waitcnt lgkmcnt(10)
  v_mfma_f32_16x16x32_bf16 v[160:163], a[96:99], a[160:163], v[160:163]
  v_mfma_f32_16x16x32_bf16 v[160:163], a[100:103], a[164:167], v[160:163]
  ds_read_b128 a[176:179], v10 offset:53248
  ds_read_b128 a[180:183], v11 offset:53248
  v_mfma_f32_16x16x32_bf16 v[164:167], a[108:111], a[164:167], v[164:167]
  v_mfma_f32_16x16x32_bf16 v[164:167], a[104:107], a[160:163], v[164:167]
  ds_read_b64_tr_b16 a[68:69], v16 offset:16384
  ds_read_b64_tr_b16 a[70:71], v16 offset:18432
  v_mfma_f32_16x16x32_bf16 v[168:171], a[112:115], a[160:163], v[168:171]
  v_mfma_f32_16x16x32_bf16 v[168:171], a[116:119], a[164:167], v[168:171]
  buffer_load_dwordx4 v7, s[12:15], s24 offen offset:1024 lds
  v_mfma_f32_16x16x32_bf16 v[172:175], a[124:127], a[164:167], v[172:175]
  v_mfma_f32_16x16x32_bf16 v[172:175], a[120:123], a[160:163], v[172:175]
  v_mfma_f32_16x16x32_bf16 v[176:179], a[128:131], a[160:163], v[176:179]
  v_mfma_f32_16x16x32_bf16 v[176:179], a[132:135], a[164:167], v[176:179]
  ds_read_b64_tr_b16 a[76:77], v17 offset:16384
  ds_read_b64_tr_b16 a[78:79], v17 offset:18432
  v_mfma_f32_16x16x32_bf16 v[180:183], a[140:143], a[164:167], v[180:183]
  v_mfma_f32_16x16x32_bf16 v[180:183], a[136:139], a[160:163], v[180:183]
  buffer_load_dwordx4 v8, s[12:15], s24 offen offset:2048 lds
  v_mfma_f32_16x16x32_bf16 v[184:187], a[144:147], a[160:163], v[184:187]
  v_mfma_f32_16x16x32_bf16 v[184:187], a[148:151], a[164:167], v[184:187]
  v_mfma_f32_16x16x32_bf16 v[188:191], a[156:159], a[164:167], v[188:191]
  v_mfma_f32_16x16x32_bf16 v[188:191], a[152:155], a[160:163], v[188:191]
  s_waitcnt lgkmcnt(12)
  ds_read_b64_tr_b16 a[84:85], v18 offset:16384
  ds_read_b64_tr_b16 a[86:87], v18 offset:18432
  v_mfma_f32_16x16x32_bf16 v[192:195], a[96:99], a[168:171], v[192:195]
  buffer_load_dwordx4 v9, s[12:15], s24 offen offset:3072 lds
  v_mfma_f32_16x16x32_bf16 v[192:195], a[100:103], a[172:175], v[192:195]
  ds_read_b128 a[184:187], v10 offset:55296
  ds_read_b128 a[188:191], v11 offset:55296
  v_mfma_f32_16x16x32_bf16 v[196:199], a[108:111], a[172:175], v[196:199]
  v_mfma_f32_16x16x32_bf16 v[196:199], a[104:107], a[168:171], v[196:199]
  v_mfma_f32_16x16x32_bf16 v[200:203], a[112:115], a[168:171], v[200:203]
  v_mfma_f32_16x16x32_bf16 v[200:203], a[116:119], a[172:175], v[200:203]
  ds_read_b64_tr_b16 a[92:93], v19 offset:16384
  ds_read_b64_tr_b16 a[94:95], v19 offset:18432
  v_mfma_f32_16x16x32_bf16 v[204:207], a[124:127], a[172:175], v[204:207]
  s_add_u32 s24, s24, 262144
  v_mfma_f32_16x16x32_bf16 v[204:207], a[120:123], a[168:171], v[204:207]
  v_mfma_f32_16x16x32_bf16 v[208:211], a[128:131], a[168:171], v[208:211]
  v_mfma_f32_16x16x32_bf16 v[208:211], a[132:135], a[172:175], v[208:211]
  v_mfma_f32_16x16x32_bf16 v[212:215], a[140:143], a[172:175], v[212:215]
  v_mfma_f32_16x16x32_bf16 v[212:215], a[136:139], a[168:171], v[212:215]
  buffer_load_dword v21, v20, s[60:63], s54 offen
  s_add_u32 s54, s54, s55
  v_mfma_f32_16x16x32_bf16 v[216:219], a[144:147], a[168:171], v[216:219]
  v_mfma_f32_16x16x32_bf16 v[216:219], a[148:151], a[172:175], v[216:219]
  v_mfma_f32_16x16x32_bf16 v[220:223], a[156:159], a[172:175], v[220:223]
  v_mfma_f32_16x16x32_bf16 v[220:223], a[152:155], a[168:171], v[220:223]
  s_waitcnt lgkmcnt(10)
  v_mfma_f32_16x16x32_bf16 v[224:227], a[96:99], a[176:179], v[224:227]
  s_cmp_eq_u32 s54, s56
  s_cselect_b32 s54, s57, s54
  s_cselect_b64 s[60:61], s[58:59], s[60:61]
  s_cselect_b32 s62, s7, s62
  v_mfma_f32_16x16x32_bf16 v[224:227], a[100:103], a[180:183], v[224:227]
  v_mfma_f32_16x16x32_bf16 v[228:231], a[108:111], a[180:183], v[228:231]
  v_mfma_f32_16x16x32_bf16 v[228:231], a[104:107], a[176:179], v[228:231]
  v_mfma_f32_16x16x32_bf16 v[232:235], a[112:115], a[176:179], v[232:235]
  v_mfma_f32_16x16x32_bf16 v[232:235], a[116:119], a[180:183], v[232:235]
  v_mfma_f32_16x16x32_bf16 v[236:239], a[124:127], a[180:183], v[236:239]
  v_mfma_f32_16x16x32_bf16 v[236:239], a[120:123], a[176:179], v[236:239]
  s_waitcnt vmcnt(18) lgkmcnt(0)
  s_barrier
  ds_read_b128 a[160:163], v10 offset:0
  ds_read_b128 a[164:167], v11 offset:0
  v_mfma_f32_16x16x32_bf16 v[240:243], a[128:131], a[176:179], v[240:243]
  s_add_u32 m0, s29, 49152
  s_add_u32 s3, s23, s31
  buffer_load_dwordx4 v2, s[8:11], s3 offen offset:0 lds
  v_mfma_f32_16x16x32_bf16 v[240:243], a[132:135], a[180:183], v[240:243]
  v_mfma_f32_16x16x32_bf16 v[244:247], a[140:143], a[180:183], v[244:247]
  v_mfma_f32_16x16x32_bf16 v[244:247], a[136:139], a[176:179], v[244:247]
  v_mfma_f32_16x16x32_bf16 v[248:251], a[144:147], a[176:179], v[248:251]
  v_mfma_f32_16x16x32_bf16 v[248:251], a[148:151], a[180:183], v[248:251]
  buffer_load_dwordx4 v3, s[8:11], s3 offen offset:1024 lds
  v_mfma_f32_16x16x32_bf16 v[252:255], a[156:159], a[180:183], v[252:255]
  v_mfma_f32_16x16x32_bf16 v[252:255], a[152:155], a[176:179], v[252:255]
  v_mfma_f32_16x16x32_bf16 a[0:3], a[96:99], a[184:187], a[0:3]
  v_mfma_f32_16x16x32_bf16 a[0:3], a[100:103], a[188:191], a[0:3]
  ds_read_b128 a[168:171], v10 offset:2048
  ds_read_b128 a[172:175], v11 offset:2048
  v_mfma_f32_16x16x32_bf16 a[4:7], a[108:111], a[188:191], a[4:7]
  v_mfma_f32_16x16x32_bf16 a[4:7], a[104:107], a[184:187], a[4:7]
  v_mfma_f32_16x16x32_bf16 a[8:11], a[112:115], a[184:187], a[8:11]
  buffer_load_dwordx4 v4, s[8:11], s3 offen offset:2048 lds
  v_mfma_f32_16x16x32_bf16 a[8:11], a[116:119], a[188:191], a[8:11]
  v_mfma_f32_16x16x32_bf16 a[12:15], a[124:127], a[188:191], a[12:15]
  v_mfma_f32_16x16x32_bf16 a[12:15], a[120:123], a[184:187], a[12:15]
  v_mfma_f32_16x16x32_bf16 a[16:19], a[128:131], a[184:187], a[16:19]
  v_mfma_f32_16x16x32_bf16 a[16:19], a[132:135], a[188:191], a[16:19]
  buffer_load_dwordx4 v5, s[8:11], s3 offen offset:3072 lds
  v_mfma_f32_16x16x32_bf16 a[20:23], a[140:143], a[188:191], a[20:23]
  v_mfma_f32_16x16x32_bf16 a[20:23], a[136:139], a[184:187], a[20:23]
  v_mfma_f32_16x16x32_bf16 a[24:27], a[144:147], a[184:187], a[24:27]
  v_mfma_f32_16x16x32_bf16 a[24:27], a[148:151], a[188:191], a[24:27]
  v_mfma_f32_16x16x32_bf16 a[28:31], a[156:159], a[188:191], a[28:31]
  v_mfma_f32_16x16x32_bf16 a[28:31], a[152:155], a[184:187], a[28:31]
  s_waitcnt lgkmcnt(2)
  s_sub_u32 s30, s30, 1
  s_cmp_lg_u32 s30, 0
  s_cbranch_scc1 Lk1_kl
  s_add_u32 s16, s50, 16777216
  s_addc_u32 s17, s51, 0
  s_mov_b32 s18, 33554432
  s_mov_b32 s19, 0x00020000
  s_lshr_b32 s4, s53, 7
  s_add_u32 s4, s4, s22
  s_lshl_b32 s4, s4, 5
  s_lshr_b32 s5, s52, 6
  s_add_u32 s4, s4, s5
  s_lshl_b32 s5, s21, 1
  s_add_u32 s4, s4, s5
  s_lshl_b32 s4, s4, 15
  v_cvt_pk_bf16_f32 v24, v32, v33
  v_cvt_pk_bf16_f32 v25, v34, v35
  v_cvt_pk_bf16_f32 v26, v36, v37
  v_cvt_pk_bf16_f32 v27, v38, v39
  s_add_u32 s5, s4, 0
  buffer_store_dwordx4 v[24:27], v1, s[16:19], s5 offen offset:0
  v_cvt_pk_bf16_f32 v28, v40, v41
  v_cvt_pk_bf16_f32 v29, v42, v43
  v_cvt_pk_bf16_f32 v30, v44, v45
  v_cvt_pk_bf16_f32 v31, v46, v47
  buffer_store_dwordx4 v[28:31], v1, s[16:19], s5 offen offset:1024
  v_cvt_pk_bf16_f32 v24, v48, v49
  v_cvt_pk_bf16_f32 v25, v50, v51
  v_cvt_pk_bf16_f32 v26, v52, v53
  v_cvt_pk_bf16_f32 v27, v54, v55
  buffer_store_dwordx4 v[24:27], v1, s[16:19], s5 offen offset:2048
  v_cvt_pk_bf16_f32 v28, v56, v57
  v_cvt_pk_bf16_f32 v29, v58, v59
  v_cvt_pk_bf16_f32 v30, v60, v61
  v_cvt_pk_bf16_f32 v31, v62, v63
  buffer_store_dwordx4 v[28:31], v1, s[16:19], s5 offen offset:3072
  v_cvt_pk_bf16_f32 v24, v64, v65
  v_cvt_pk_bf16_f32 v25, v66, v67
  v_cvt_pk_bf16_f32 v26, v68, v69
  v_cvt_pk_bf16_f32 v27, v70, v71
  s_add_u32 s5, s4, 4096
  buffer_store_dwordx4 v[24:27], v1, s[16:19], s5 offen offset:0
  v_cvt_pk_bf16_f32 v28, v72, v73
  v_cvt_pk_bf16_f32 v29, v74, v75
  v_cvt_pk_bf16_f32 v30, v76, v77
  v_cvt_pk_bf16_f32 v31, v78, v79
  buffer_store_dwordx4 v[28:31], v1, s[16:19], s5 offen offset:1024
  v_cvt_pk_bf16_f32 v24, v80, v81
  v_cvt_pk_bf16_f32 v25, v82, v83
  v_cvt_pk_bf16_f32 v26, v84, v85
  v_cvt_pk_bf16_f32 v27, v86, v87
  buffer_store_dwordx4 v[24:27], v1, s[16:19], s5 offen offset:2048
  v_cvt_pk_bf16_f32 v28, v88, v89
  v_cvt_pk_bf16_f32 v29, v90, v91
  v_cvt_pk_bf16_f32 v30, v92, v93
  v_cvt_pk_bf16_f32 v31, v94, v95
  buffer_store_dwordx4 v[28:31], v1, s[16:19], s5 offen offset:3072
  v_cvt_pk_bf16_f32 v24, v96, v97
  v_cvt_pk_bf16_f32 v25, v98, v99
  v_cvt_pk_bf16_f32 v26, v100, v101
  v_cvt_pk_bf16_f32 v27, v102, v103
  s_add_u32 s5, s4, 8192
  buffer_store_dwordx4 v[24:27], v1, s[16:19], s5 offen offset:0
  v_cvt_pk_bf16_f32 v28, v104, v105
  v_cvt_pk_bf16_f32 v29, v106, v107
  v_cvt_pk_bf16_f32 v30, v108, v109
  v_cvt_pk_bf16_f32 v31, v110, v111
  buffer_store_dwordx4 v[28:31], v1, s[16:19], s5 offen offset:1024
  v_cvt_pk_bf16_f32 v24, v112, v113
  v_cvt_pk_bf16_f32 v25, v114, v115
  v_cvt_pk_bf16_f32 v26, v116, v117
  v_cvt_pk_bf16_f32 v27, v118, v119
  buffer_store_dwordx4 v[24:27], v1, s[16:19], s5 offen offset:2048
  v_cvt_pk_bf16_f32 v28, v120, v121
  v_cvt_pk_bf16_f32 v29, v122, v123
  v_cvt_pk_bf16_f32 v30, v124, v125
  v_cvt_pk_bf16_f32 v31, v126, v127
  buffer_store_dwordx4 v[28:31], v1, s[16:19], s5 offen offset:3072
  v_cvt_pk_bf16_f32 v24, v128, v129
  v_cvt_pk_bf16_f32 v25, v130, v131
  v_cvt_pk_bf16_f32 v26, v132, v133
  v_cvt_pk_bf16_f32 v27, v134, v135
  s_add_u32 s5, s4, 12288
  buffer_store_dwordx4 v[24:27], v1, s[16:19], s5 offen offset:0
  v_cvt_pk_bf16_f32 v28, v136, v137
  v_cvt_pk_bf16_f32 v29, v138, v139
  v_cvt_pk_bf16_f32 v30, v140, v141
  v_cvt_pk_bf16_f32 v31, v142, v143
  buffer_store_dwordx4 v[28:31], v1, s[16:19], s5 offen offset:1024
  v_cvt_pk_bf16_f32 v24, v144, v145
  v_cvt_pk_bf16_f32 v25, v146, v147
  v_cvt_pk_bf16_f32 v26, v148, v149
  v_cvt_pk_bf16_f32 v27, v150, v151
  buffer_store_dwordx4 v[24:27], v1, s[16:19], s5 offen offset:2048
  v_cvt_pk_bf16_f32 v28, v152, v153
  v_cvt_pk_bf16_f32 v29, v154, v155
  v_cvt_pk_bf16_f32 v30, v156, v157
  v_cvt_pk_bf16_f32 v31, v158, v159
  buffer_store_dwordx4 v[28:31], v1, s[16:19], s5 offen offset:3072
  v_cvt_pk_bf16_f32 v24, v160, v161
  v_cvt_pk_bf16_f32 v25, v162, v163
  v_cvt_pk_bf16_f32 v26, v164, v165
  v_cvt_pk_bf16_f32 v27, v166, v167
  s_add_u32 s5, s4, 32768
  buffer_store_dwordx4 v[24:27], v1, s[16:19], s5 offen offset:0
  v_cvt_pk_bf16_f32 v28, v168, v169
  v_cvt_pk_bf16_f32 v29, v170, v171
  v_cvt_pk_bf16_f32 v30, v172, v173
  v_cvt_pk_bf16_f32 v31, v174, v175
  buffer_store_dwordx4 v[28:31], v1, s[16:19], s5 offen offset:1024
  v_cvt_pk_bf16_f32 v24, v176, v177
  v_cvt_pk_bf16_f32 v25, v178, v179
  v_cvt_pk_bf16_f32 v26, v180, v181
  v_cvt_pk_bf16_f32 v27, v182, v183
  buffer_store_dwordx4 v[24:27], v1, s[16:19], s5 offen offset:2048
  v_cvt_pk_bf16_f32 v28, v184, v185
  v_cvt_pk_bf16_f32 v29, v186, v187
  v_cvt_pk_bf16_f32 v30, v188, v189
  v_cvt_pk_bf16_f32 v31, v190, v191
  buffer_store_dwordx4 v[28:31], v1, s[16:19], s5 offen offset:3072
  v_cvt_pk_bf16_f32 v24, v192, v193
  v_cvt_pk_bf16_f32 v25, v194, v195
  v_cvt_pk_bf16_f32 v26, v196, v197
  v_cvt_pk_bf16_f32 v27, v198, v199
  s_add_u32 s5, s4, 36864
  buffer_store_dwordx4 v[24:27], v1, s[16:19], s5 offen offset:0
  v_cvt_pk_bf16_f32 v28, v200, v201
  v_cvt_pk_bf16_f32 v29, v202, v203
  v_cvt_pk_bf16_f32 v30, v204, v205
  v_cvt_pk_bf16_f32 v31, v206, v207
  buffer_store_dwordx4 v[28:31], v1, s[16:19], s5 offen offset:1024
  v_cvt_pk_bf16_f32 v24, v208, v209
  v_cvt_pk_bf16_f32 v25, v210, v211
  v_cvt_pk_bf16_f32 v26, v212, v213
  v_cvt_pk_bf16_f32 v27, v214, v215
  buffer_store_dwordx4 v[24:27], v1, s[16:19], s5 offen offset:2048
  v_cvt_pk_bf16_f32 v28, v216, v217
  v_cvt_pk_bf16_f32 v29, v218, v219
  v_cvt_pk_bf16_f32 v30, v220, v221
  v_cvt_pk_bf16_f32 v31, v222, v223
  buffer_store_dwordx4 v[28:31], v1, s[16:19], s5 offen offset:3072
  v_cvt_pk_bf16_f32 v24, v224, v225
  v_cvt_pk_bf16_f32 v25, v226, v227
  v_cvt_pk_bf16_f32 v26, v228, v229
  v_cvt_pk_bf16_f32 v27, v230, v231
  s_add_u32 s5, s4, 40960
  buffer_store_dwordx4 v[24:27], v1, s[16:19], s5 offen offset:0
  v_cvt_pk_bf16_f32 v28, v232, v233
  v_cvt_pk_bf16_f32 v29, v234, v235
  v_cvt_pk_bf16_f32 v30, v236, v237
  v_cvt_pk_bf16_f32 v31, v238, v239
  buffer_store_dwordx4 v[28:31], v1, s[16:19], s5 offen offset:1024
  v_cvt_pk_bf16_f32 v24, v240, v241
  v_cvt_pk_bf16_f32 v25, v242, v243
  v_cvt_pk_bf16_f32 v26, v244, v245
  v_cvt_pk_bf16_f32 v27, v246, v247
  buffer_store_dwordx4 v[24:27], v1, s[16:19], s5 offen offset:2048
  v_cvt_pk_bf16_f32 v28, v248, v249
  v_cvt_pk_bf16_f32 v29, v250, v251
  v_cvt_pk_bf16_f32 v30, v252, v253
  v_cvt_pk_bf16_f32 v31, v254, v255
  buffer_store_dwordx4 v[28:31], v1, s[16:19], s5 offen offset:3072
  v_accvgpr_read_b32 v32, a0
  v_accvgpr_read_b32 v33, a1
  v_accvgpr_read_b32 v34, a2
  v_accvgpr_read_b32 v35, a3
  v_accvgpr_read_b32 v36, a4
  v_accvgpr_read_b32 v37, a5
  v_accvgpr_read_b32 v38, a6
  v_accvgpr_read_b32 v39, a7
  v_cvt_pk_bf16_f32 v24, v32, v33
  v_cvt_pk_bf16_f32 v25, v34, v35
  v_cvt_pk_bf16_f32 v26, v36, v37
  v_cvt_pk_bf16_f32 v27, v38, v39
  s_add_u32 s5, s4, 45056
  buffer_store_dwordx4 v[24:27], v1, s[16:19], s5 offen offset:0
  v_accvgpr_read_b32 v32, a8
  v_accvgpr_read_b32 v33, a9
  v_accvgpr_read_b32 v34, a10
  v_accvgpr_read_b32 v35, a11
  v_accvgpr_read_b32 v36, a12
  v_accvgpr_read_b32 v37, a13
  v_accvgpr_read_b32 v38, a14
  v_accvgpr_read_b32 v39, a15
  v_cvt_pk_bf16_f32 v28, v32, v33
  v_cvt_pk_bf16_f32 v29, v34, v35
  v_cvt_pk_bf16_f32 v30, v36, v37
  v_cvt_pk_bf16_f32 v31, v38, v39
  buffer_store_dwordx4 v[28:31], v1, s[16:19], s5 offen offset:1024
  v_accvgpr_read_b32 v32, a16
  v_accvgpr_read_b32 v33, a17
  v_accvgpr_read_b32 v34, a18
  v_accvgpr_read_b32 v35, a19
  v_accvgpr_read_b32 v36, a20
  v_accvgpr_read_b32 v37, a21
  v_accvgpr_read_b32 v38, a22
  v_accvgpr_read_b32 v39, a23
  v_cvt_pk_bf16_f32 v24, v32, v33
  v_cvt_pk_bf16_f32 v25, v34, v35
  v_cvt_pk_bf16_f32 v26, v36, v37
  v_cvt_pk_bf16_f32 v27, v38, v39
  buffer_store_dwordx4 v[24:27], v1, s[16:19], s5 offen offset:2048
  v_accvgpr_read_b32 v32, a24
  v_accvgpr_read_b32 v33, a25
  v_accvgpr_read_b32 v34, a26
  v_accvgpr_read_b32 v35, a27
  v_accvgpr_read_b32 v36, a28
  v_accvgpr_read_b32 v37, a29
  v_accvgpr_read_b32 v38, a30
  v_accvgpr_read_b32 v39, a31
  v_cvt_pk_bf16_f32 v28, v32, v33
  v_cvt_pk_bf16_f32 v29, v34, v35
  v_cvt_pk_bf16_f32 v30, v36, v37
  v_cvt_pk_bf16_f32 v31, v38, v39
  buffer_store_dwordx4 v[28:31], v1, s[16:19], s5 offen offset:3072
  v_mfma_f32_16x16x32_bf16 v[32:35], a[160:163], a[32:35], 0
  s_add_u32 s23, s23, 128
  s_cmp_eq_u32 s23, s25
  s_cselect_b32 s23, s26, s23
  v_mfma_f32_16x16x32_bf16 v[32:35], a[164:167], a[36:39], v[32:35]
  ds_read_b128 a[176:179], v10 offset:4096
  ds_read_b128 a[180:183], v11 offset:4096
  v_mfma_f32_16x16x32_bf16 v[36:39], a[164:167], a[44:47], 0
  v_mfma_f32_16x16x32_bf16 v[36:39], a[160:163], a[40:43], v[36:39]
  ds_read_b64_tr_b16 a[96:97], v12 offset:32768
  ds_read_b64_tr_b16 a[98:99], v12 offset:34816
  v_mfma_f32_16x16x32_bf16 v[40:43], a[160:163], a[48:51], 0
  v_mfma_f32_16x16x32_bf16 v[40:43], a[164:167], a[52:55], v[40:43]
  v_mfma_f32_16x16x32_bf16 v[44:47], a[164:167], a[60:63], 0
  s_add_u32 m0, s29, 81920
  s_nop 0
  buffer_load_dwordx4 v6, s[12:15], s24 offen offset:0 lds
  v_mfma_f32_16x16x32_bf16 v[44:47], a[160:163], a[56:59], v[44:47]
  ds_read_b64_tr_b16 a[104:105], v13 offset:32768
  ds_read_b64_tr_b16 a[106:107], v13 offset:34816
  v_mfma_f32_16x16x32_bf16 v[48:51], a[160:163], a[64:67], 0
  v_mfma_f32_16x16x32_bf16 v[48:51], a[164:167], a[68:71], v[48:51]
  v_mfma_f32_16x16x32_bf16 v[52:55], a[164:167], a[76:79], 0
  v_mfma_f32_16x16x32_bf16 v[52:55], a[160:163], a[72:75], v[52:55]
  ds_read_b64_tr_b16 a[112:113], v14 offset:32768
  ds_read_b64_tr_b16 a[114:115], v14 offset:34816
  v_mfma_f32_16x16x32_bf16 v[56:59], a[160:163], a[80:83], 0
  v_mfma_f32_16x16x32_bf16 v[56:59], a[164:167], a[84:87], v[56:59]
  buffer_load_dwordx4 v7, s[12:15], s24 offen offset:1024 lds
  v_mfma_f32_16x16x32_bf16 v[60:63], a[164:167], a[92:95], 0
  v_mfma_f32_16x16x32_bf16 v[60:63], a[160:163], a[88:91], v[60:63]
  s_waitcnt lgkmcnt(8)
  ds_read_b64_tr_b16 a[120:121], v15 offset:32768
  ds_read_b64_tr_b16 a[122:123], v15 offset:34816
  v_mfma_f32_16x16x32_bf16 v[64:67], a[168:171], a[32:35], 0
  v_mfma_f32_16x16x32_bf16 v[64:67], a[172:175], a[36:39], v[64:67]
  ds_read_b128 a[184:187], v10 offset:6144
  ds_read_b128 a[188:191], v11 offset:6144
  v_mfma_f32_16x16x32_bf16 v[68:71], a[172:175], a[44:47], 0
  v_mfma_f32_16x16x32_bf16 v[68:71], a[168:171], a[40:43], v[68:71]
  ds_read_b64_tr_b16 a[128:129], v16 offset:32768
  ds_read_b64_tr_b16 a[130:131], v16 offset:34816
  v_mfma_f32_16x16x32_bf16 v[72:75], a[168:171], a[48:51], 0
  buffer_load_dwordx4 v8, s[12:15], s24 offen offset:2048 lds
  v_mfma_f32_16x16x32_bf16 v[72:75], a[172:175], a[52:55], v[72:75]
  v_mfma_f32_16x16x32_bf16 v[76:79], a[172:175], a[60:63], 0
  v_mfma_f32_16x16x32_bf16 v[76:79], a[168:171], a[56:59], v[76:79]
  ds_read_b64_tr_b16 a[136:137], v17 offset:32768
  ds_read_b64_tr_b16 a[138:139], v17 offset:34816
  v_mfma_f32_16x16x32_bf16 v[80:83], a[168:171], a[64:67], 0
  v_mfma_f32_16x16x32_bf16 v[80:83], a[172:175], a[68:71], v[80:83]
  v_mfma_f32_16x16x32_bf16 v[84:87], a[172:175], a[76:79], 0
  buffer_load_dwordx4 v9, s[12:15], s24 offen offset:3072 lds
  v_mfma_f32_16x16x32_bf16 v[84:87], a[168:171], a[72:75], v[84:87]
  ds_read_b64_tr_b16 a[144:145], v18 offset:32768
  ds_read_b64_tr_b16 a[146:147], v18 offset:34816
  v_mfma_f32_16x16x32_bf16 v[88:91], a[168:171], a[80:83], 0
  v_mfma_f32_16x16x32_bf16 v[88:91], a[172:175], a[84:87], v[88:91]
  v_mfma_f32_16x16x32_bf16 v[92:95], a[172:175], a[92:95], 0
  v_mfma_f32_16x16x32_bf16 v[92:95], a[168:171], a[88:91], v[92:95]
  s_waitcnt lgkmcnt(15)
  ds_read_b64_tr_b16 a[152:153], v19 offset:32768
  ds_read_b64_tr_b16 a[154:155], v19 offset:34816
  v_mfma_f32_16x16x32_bf16 v[96:99], a[176:179], a[32:35], 0
  s_add_u32 s24, s24, 262144
  s_cmp_eq_u32 s24, s27
  s_cselect_b32 s24, s28, s24
  s_cselect_b64 s[12:13], s[64:65], s[12:13]
  v_mfma_f32_16x16x32_bf16 v[96:99], a[180:183], a[36:39], v[96:99]
  v_mfma_f32_16x16x32_bf16 v[100:103], a[180:183], a[44:47], 0
  v_mfma_f32_16x16x32_bf16 v[100:103], a[176:179], a[40:43], v[100:103]
  v_mfma_f32_16x16x32_bf16 v[104:107], a[176:179], a[48:51], 0
  v_mfma_f32_16x16x32_bf16 v[104:107], a[180:183], a[52:55], v[104:107]
  v_mfma_f32_16x16x32_bf16 v[108:111], a[180:183], a[60:63], 0
  v_mfma_f32_16x16x32_bf16 v[108:111], a[176:179], a[56:59], v[108:111]
  s_waitcnt vmcnt(17) lgkmcnt(0)
  s_barrier
  ds_read_b128 a[160:163], v10 offset:16384
  ds_read_b128 a[164:167], v11 offset:16384
  v_mfma_f32_16x16x32_bf16 v[112:115], a[176:179], a[64:67], 0
  s_add_u32 m0, s29, 0
  s_nop 0
  buffer_load_dwordx4 v2, s[8:11], s23 offen offset:0 lds
  v_mfma_f32_16x16x32_bf16 v[112:115], a[180:183], a[68:71], v[112:115]
  v_mfma_f32_16x16x32_bf16 v[116:119], a[180:183], a[76:79], 0
  v_mfma_f32_16x16x32_bf16 v[116:119], a[176:179], a[72:75], v[116:119]
  ds_read_b64_tr_b16 a[100:101], v12 offset:49152
  ds_read_b64_tr_b16 a[102:103], v12 offset:51200
  v_mfma_f32_16x16x32_bf16 v[120:123], a[176:179], a[80:83], 0
  v_mfma_f32_16x16x32_bf16 v[120:123], a[180:183], a[84:87], v[120:123]
  buffer_load_dwordx4 v3, s[8:11], s23 offen offset:1024 lds
  v_mfma_f32_16x16x32_bf16 v[124:127], a[180:183], a[92:95], 0
  v_mfma_f32_16x16x32_bf16 v[124:127], a[176:179], a[88:91], v[124:127]
  v_mfma_f32_16x16x32_bf16 v[128:131], a[184:187], a[32:35], 0
  v_mfma_f32_16x16x32_bf16 v[128:131], a[188:191], a[36:39], v[128:131]
  ds_read_b128 a[168:171], v10 offset:18432
  ds_read_b128 a[172:175], v11 offset:18432
  ds_read_b64_tr_b16 a[108:109], v13 offset:49152
  ds_read_b64_tr_b16 a[110:111], v13 offset:51200
  v_mfma_f32_16x16x32_bf16 v[132:135], a[188:191], a[44:47], 0
  v_mfma_f32_16x16x32_bf16 v[132:135], a[184:187], a[40:43], v[132:135]
  buffer_load_dwordx4 v4, s[8:11], s23 offen offset:2048 lds
  v_mfma_f32_16x16x32_bf16 v[136:139], a[184:187], a[48:51], 0
  v_mfma_f32_16x16x32_bf16 v[136:139], a[188:191], a[52:55], v[136:139]
  v_mfma_f32_16x16x32_bf16 v[140:143], a[188:191], a[60:63], 0
  v_mfma_f32_16x16x32_bf16 v[140:143], a[184:187], a[56:59], v[140:143]
  ds_read_b64_tr_b16 a[116:117], v14 offset:49152
  ds_read_b64_tr_b16 a[118:119], v14 offset:51200
  v_mfma_f32_16x16x32_bf16 v[144:147], a[184:187], a[64:67], 0
  v_mfma_f32_16x16x32_bf16 v[144:147], a[188:191], a[68:71], v[144:147]
  buffer_load_dwordx4 v5, s[8:11], s23 offen offset:3072 lds
  v_mfma_f32_16x16x32_bf16 v[148:151], a[188:191], a[76:79], 0
  v_mfma_f32_16x16x32_bf16 v[148:151], a[184:187], a[72:75], v[148:151]
  v_mfma_f32_16x16x32_bf16 v[152:155], a[184:187], a[80:83], 0
  v_mfma_f32_16x16x32_bf16 v[152:155], a[188:191], a[84:87], v[152:155]
  ds_read_b64_tr_b16 a[124:125], v15 offset:49152
  ds_read_b64_tr_b16 a[126:127], v15 offset:51200
  v_mfma_f32_16x16x32_bf16 v[156:159], a[188:191], a[92:95], 0
  s_add_u32 m0, s29, 98304
  s_nop 0
  buffer_load_dwordx4 v6, s[12:15], s24 offen offset:0 lds
  v_mfma_f32_16x16x32_bf16 v[156:159], a[184:187], a[88:91], v[156:159]
  s_waitcnt lgkmcnt(10)
  v_mfma_f32_16x16x32_bf16 v[160:163], a[160:163], a[32:35], 0
  v_mfma_f32_16x16x32_bf16 v[160:163], a[164:167], a[36:39], v[160:163]
  ds_read_b128 a[176:179], v10 offset:20480
  ds_read_b128 a[180:183], v11 offset:20480
  v_mfma_f32_16x16x32_bf16 v[164:167], a[164:167], a[44:47], 0
  v_mfma_f32_16x16x32_bf16 v[164:167], a[160:163], a[40:43], v[164:167]
  ds_read_b64_tr_b16 a[132:133], v16 offset:49152
  ds_read_b64_tr_b16 a[134:135], v16 offset:51200
  v_mfma_f32_16x16x32_bf16 v[168:171], a[160:163], a[48:51], 0
  v_mfma_f32_16x16x32_bf16 v[168:171], a[164:167], a[52:55], v[168:171]
  buffer_load_dwordx4 v7, s[12:15], s24 offen offset:1024 lds
  v_mfma_f32_16x16x32_bf16 v[172:175], a[164:167], a[60:63], 0
  v_mfma_f32_16x16x32_bf16 v[172:175], a[160:163], a[56:59], v[172:175]
  v_mfma_f32_16x16x32_bf16 v[176:179], a[160:163], a[64:67], 0
  v_mfma_f32_16x16x32_bf16 v[176:179], a[164:167], a[68:71], v[176:179]
  ds_read_b64_tr_b16 a[140:141], v17 offset:49152
  ds_read_b64_tr_b16 a[142:143], v17 offset:51200
  v_mfma_f32_16x16x32_bf16 v[180:183], a[164:167], a[76:79], 0
  v_mfma_f32_16x16x32_bf16 v[180:183], a[160:163], a[72:75], v[180:183]
  buffer_load_dwordx4 v8, s[12:15], s24 offen offset:2048 lds
  v_mfma_f32_16x16x32_bf16 v[184:187], a[160:163], a[80:83], 0
  v_mfma_f32_16x16x32_bf16 v[184:187], a[164:167], a[84:87], v[184:187]
  v_mfma_f32_16x16x32_bf16 v[188:191], a[164:167], a[92:95], 0
  v_mfma_f32_16x16x32_bf16 v[188:191], a[160:163], a[88:91], v[188:191]
  s_waitcnt lgkmcnt(12)
  ds_read_b64_tr_b16 a[148:149], v18 offset:49152
  ds_read_b64_tr_b16 a[150:151], v18 offset:51200
  v_mfma_f32_16x16x32_bf16 v[192:195], a[168:171], a[32:35], 0
  buffer_load_dwordx4 v9, s[12:15], s24 offen offset:3072 lds
  v_mfma_f32_16x16x32_bf16 v[192:195], a[172:175], a[36:39], v[192:195]
  ds_read_b128 a[184:187], v10 offset:22528
  ds_read_b128 a[188:191], v11 offset:22528
  v_mfma_f32_16x16x32_bf16 v[196:199], a[172:175], a[44:47], 0
  v_mfma_f32_16x16x32_bf16 v[196:199], a[168:171], a[40:43], v[196:199]
  v_mfma_f32_16x16x32_bf16 v[200:203], a[168:171], a[48:51], 0
  v_mfma_f32_16x16x32_bf16 v[200:203], a[172:175], a[52:55], v[200:203]
  ds_read_b64_tr_b16 a[156:157], v19 offset:49152
  ds_read_b64_tr_b16 a[158:159], v19 offset:51200
  v_mfma_f32_16x16x32_bf16 v[204:207], a[172:175], a[60:63], 0
  s_add_u32 s24, s24, 262144
  v_mfma_f32_16x16x32_bf16 v[204:207], a[168:171], a[56:59], v[204:207]
  v_mfma_f32_16x16x32_bf16 v[208:211], a[168:171], a[64:67], 0
  v_mfma_f32_16x16x32_bf16 v[208:211], a[172:175], a[68:71], v[208:211]
  v_mfma_f32_16x16x32_bf16 v[212:215], a[172:175], a[76:79], 0
  v_mfma_f32_16x16x32_bf16 v[212:215], a[168:171], a[72:75], v[212:215]
  buffer_load_dword v21, v20, s[60:63], s54 offen
  s_add_u32 s54, s54, s55
  v_mfma_f32_16x16x32_bf16 v[216:219], a[168:171], a[80:83], 0
  v_mfma_f32_16x16x32_bf16 v[216:219], a[172:175], a[84:87], v[216:219]
  v_mfma_f32_16x16x32_bf16 v[220:223], a[172:175], a[92:95], 0
  v_mfma_f32_16x16x32_bf16 v[220:223], a[168:171], a[88:91], v[220:223]
  s_waitcnt lgkmcnt(10)
  v_mfma_f32_16x16x32_bf16 v[224:227], a[176:179], a[32:35], 0
  s_cmp_eq_u32 s54, s56
  s_cselect_b32 s54, s57, s54
  s_cselect_b64 s[60:61], s[58:59], s[60:61]
  s_cselect_b32 s62, s7, s62
  v_mfma_f32_16x16x32_bf16 v[224:227], a[180:183], a[36:39], v[224:227]
  v_mfma_f32_16x16x32_bf16 v[228:231], a[180:183], a[44:47], 0
  v_mfma_f32_16x16x32_bf16 v[228:231], a[176:179], a[40:43], v[228:231]
  v_mfma_f32_16x16x32_bf16 v[232:235], a[176:179], a[48:51], 0
  v_mfma_f32_16x16x32_bf16 v[232:235], a[180:183], a[52:55], v[232:235]
  v_mfma_f32_16x16x32_bf16 v[236:239], a[180:183], a[60:63], 0
  v_mfma_f32_16x16x32_bf16 v[236:239], a[176:179], a[56:59], v[236:239]
  s_waitcnt vmcnt(17) lgkmcnt(0)
  s_barrier
  ds_read_b128 a[160:163], v10 offset:32768
  ds_read_b128 a[164:167], v11 offset:32768
  v_mfma_f32_16x16x32_bf16 v[240:243], a[176:179], a[64:67], 0
  s_add_u32 m0, s29, 16384
  s_add_u32 s3, s23, s31
  buffer_load_dwordx4 v2, s[8:11], s3 offen offset:0 lds
  v_mfma_f32_16x16x32_bf16 v[240:243], a[180:183], a[68:71], v[240:243]
  v_mfma_f32_16x16x32_bf16 v[244:247], a[180:183], a[76:79], 0
  v_mfma_f32_16x16x32_bf16 v[244:247], a[176:179], a[72:75], v[244:247]
  v_mfma_f32_16x16x32_bf16 v[248:251], a[176:179], a[80:83], 0
  v_mfma_f32_16x16x32_bf16 v[248:251], a[180:183], a[84:87], v[248:251]
  buffer_load_dwordx4 v3, s[8:11], s3 offen offset:1024 lds
  v_mfma_f32_16x16x32_bf16 v[252:255], a[180:183], a[92:95], 0
  v_mfma_f32_16x16x32_bf16 v[252:255], a[176:179], a[88:91], v[252:255]
  v_mfma_f32_16x16x32_bf16 a[0:3], a[184:187], a[32:35], 0
  v_mfma_f32_16x16x32_bf16 a[0:3], a[188:191], a[36:39], a[0:3]
  ds_read_b128 a[168:171], v10 offset:34816
  ds_read_b128 a[172:175], v11 offset:34816
  v_mfma_f32_16x16x32_bf16 a[4:7], a[188:191], a[44:47], 0
  v_mfma_f32_16x16x32_bf16 a[4:7], a[184:187], a[40:43], a[4:7]
  v_mfma_f32_16x16x32_bf16 a[8:11], a[184:187], a[48:51], 0
  buffer_load_dwordx4 v4, s[8:11], s3 offen offset:2048 lds
  v_mfma_f32_16x16x32_bf16 a[8:11], a[188:191], a[52:55], a[8:11]
  v_mfma_f32_16x16x32_bf16 a[12:15], a[188:191], a[60:63], 0
  v_mfma_f32_16x16x32_bf16 a[12:15], a[184:187], a[56:59], a[12:15]
  v_mfma_f32_16x16x32_bf16 a[16:19], a[184:187], a[64:67], 0
  v_mfma_f32_16x16x32_bf16 a[16:19], a[188:191], a[68:71], a[16:19]
  buffer_load_dwordx4 v5, s[8:11], s3 offen offset:3072 lds
  v_mfma_f32_16x16x32_bf16 a[20:23], a[188:191], a[76:79], 0
  v_mfma_f32_16x16x32_bf16 a[20:23], a[184:187], a[72:75], a[20:23]
  v_mfma_f32_16x16x32_bf16 a[24:27], a[184:187], a[80:83], 0
  v_mfma_f32_16x16x32_bf16 a[24:27], a[188:191], a[84:87], a[24:27]
  v_mfma_f32_16x16x32_bf16 a[28:31], a[188:191], a[92:95], 0
  v_mfma_f32_16x16x32_bf16 a[28:31], a[184:187], a[88:91], a[28:31]
  s_waitcnt lgkmcnt(2)
  v_mfma_f32_16x16x32_bf16 v[32:35], a[160:163], a[96:99], v[32:35]
  s_add_u32 s23, s23, 128
  s_cmp_eq_u32 s23, s25
  s_cselect_b32 s23, s26, s23
  v_mfma_f32_16x16x32_bf16 v[32:35], a[164:167], a[100:103], v[32:35]
  ds_read_b128 a[176:179], v10 offset:36864
  ds_read_b128 a[180:183], v11 offset:36864
  v_mfma_f32_16x16x32_bf16 v[36:39], a[164:167], a[108:111], v[36:39]
  v_mfma_f32_16x16x32_bf16 v[36:39], a[160:163], a[104:107], v[36:39]
  ds_read_b64_tr_b16 a[32:33], v12 offset:0
  ds_read_b64_tr_b16 a[34:35], v12 offset:2048
  v_mfma_f32_16x16x32_bf16 v[40:43], a[160:163], a[112:115], v[40:43]
  v_mfma_f32_16x16x32_bf16 v[40:43], a[164:167], a[116:119], v[40:43]
  v_mfma_f32_16x16x32_bf16 v[44:47], a[164:167], a[124:127], v[44:47]
  s_add_u32 m0, s29, 114688
  s_nop 0
  buffer_load_dwordx4 v6, s[12:15], s24 offen offset:0 lds
  v_mfma_f32_16x16x32_bf16 v[44:47], a[160:163], a[120:123], v[44:47]
  ds_read_b64_tr_b16 a[40:41], v13 offset:0
  ds_read_b64_tr_b16 a[42:43], v13 offset:2048
  v_mfma_f32_16x16x32_bf16 v[48:51], a[160:163], a[128:131], v[48:51]
  v_mfma_f32_16x16x32_bf16 v[48:51], a[164:167], a[132:135], v[48:51]
  v_mfma_f32_16x16x32_bf16 v[52:55], a[164:167], a[140:143], v[52:55]
  v_mfma_f32_16x16x32_bf16 v[52:55], a[160:163], a[136:139], v[52:55]
  ds_read_b64_tr_b16 a[48:49], v14 offset:0
  ds_read_b64_tr_b16 a[50:51], v14 offset:2048
  v_mfma_f32_16x16x32_bf16 v[56:59], a[160:163], a[144:147], v[56:59]
  v_mfma_f32_16x16x32_bf16 v[56:59], a[164:167], a[148:151], v[56:59]
  buffer_load_dwordx4 v7, s[12:15], s24 offen offset:1024 lds
  v_mfma_f32_16x16x32_bf16 v[60:63], a[164:167], a[156:159], v[60:63]
  v_mfma_f32_16x16x32_bf16 v[60:63], a[160:163], a[152:155], v[60:63]
  s_waitcnt lgkmcnt(8)
  ds_read_b64_tr_b16 a[56:57], v15 offset:0
  ds_read_b64_tr_b16 a[58:59], v15 offset:2048
  v_mfma_f32_16x16x32_bf16 v[64:67], a[168:171], a[96:99], v[64:67]
  v_mfma_f32_16x16x32_bf16 v[64:67], a[172:175], a[100:103], v[64:67]
  ds_read_b128 a[184:187], v10 offset:38912
  ds_read_b128 a[188:191], v11 offset:38912
  v_mfma_f32_16x16x32_bf16 v[68:71], a[172:175], a[108:111], v[68:71]
  v_mfma_f32_16x16x32_bf16 v[68:71], a[168:171], a[104:107], v[68:71]
  ds_read_b64_tr_b16 a[64:65], v16 offset:0
  ds_read_b64_tr_b16 a[66:67], v16 offset:2048
  v_mfma_f32_16x16x32_bf16 v[72:75], a[168:171], a[112:115], v[72:75]
  buffer_load_dwordx4 v8, s[12:15], s24 offen offset:2048 lds
  v_mfma_f32_16x16x32_bf16 v[72:75], a[172:175], a[116:119], v[72:75]
  v_mfma_f32_16x16x32_bf16 v[76:79], a[172:175], a[124:127], v[76:79]
  v_mfma_f32_16x16x32_bf16 v[76:79], a[168:171], a[120:123], v[76:79]
  ds_read_b64_tr_b16 a[72:73], v17 offset:0
  ds_read_b64_tr_b16 a[74:75], v17 offset:2048
  v_mfma_f32_16x16x32_bf16 v[80:83], a[168:171], a[128:131], v[80:83]
  v_mfma_f32_16x16x32_bf16 v[80:83], a[172:175], a[132:135], v[80:83]
  v_mfma_f32_16x16x32_bf16 v[84:87], a[172:175], a[140:143], v[84:87]
  buffer_load_dwordx4 v9, s[12:15], s24 offen offset:3072 lds
  v_mfma_f32_16x16x32_bf16 v[84:87], a[168:171], a[136:139], v[84:87]
  ds_read_b64_tr_b16 a[80:81], v18 offset:0
  ds_read_b64_tr_b16 a[82:83], v18 offset:2048
  v_mfma_f32_16x16x32_bf16 v[88:91], a[168:171], a[144:147], v[88:91]
  v_mfma_f32_16x16x32_bf16 v[88:91], a[172:175], a[148:151], v[88:91]
  v_mfma_f32_16x16x32_bf16 v[92:95], a[172:175], a[156:159], v[92:95]
  v_mfma_f32_16x16x32_bf16 v[92:95], a[168:171], a[152:155], v[92:95]
  s_waitcnt lgkmcnt(15)
  ds_read_b64_tr_b16 a[88:89], v19 offset:0
  ds_read_b64_tr_b16 a[90:91], v19 offset:2048
  v_mfma_f32_16x16x32_bf16 v[96:99], a[176:179], a[96:99], v[96:99]
  s_add_u32 s24, s24, 262144
  s_cmp_eq_u32 s24, s27
  s_cselect_b32 s24, s28, s24
  s_cselect_b64 s[12:13], s[64:65], s[12:13]
  v_mfma_f32_16x16x32_bf16 v[96:99], a[180:183], a[100:103], v[96:99]
  v_mfma_f32_16x16x32_bf16 v[100:103], a[180:183], a[108:111], v[100:103]
  v_mfma_f32_16x16x32_bf16 v[100:103], a[176:179], a[104:107], v[100:103]
  v_mfma_f32_16x16x32_bf16 v[104:107], a[176:179], a[112:115], v[104:107]
  v_mfma_f32_16x16x32_bf16 v[104:107], a[180:183], a[116:119], v[104:107]
  v_mfma_f32_16x16x32_bf16 v[108:111], a[180:183], a[124:127], v[108:111]
  v_mfma_f32_16x16x32_bf16 v[108:111], a[176:179], a[120:123], v[108:111]
  s_waitcnt vmcnt(17) lgkmcnt(0)
  s_barrier
  ds_read_b128 a[160:163], v10 offset:49152
  ds_read_b128 a[164:167], v11 offset:49152
  v_mfma_f32_16x16x32_bf16 v[112:115], a[176:179], a[128:131], v[112:115]
  s_add_u32 m0, s29, 32768
  s_nop 0
  buffer_load_dwordx4 v2, s[8:11], s23 offen offset:0 lds
  v_mfma_f32_16x16x32_bf16 v[112:115], a[180:183], a[132:135], v[112:115]
  v_mfma_f32_16x16x32_bf16 v[116:119], a[180:183], a[140:143], v[116:119]
  v_mfma_f32_16x16x32_bf16 v[116:119], a[176:179], a[136:139], v[116:119]
  ds_read_b64_tr_b16 a[36:37], v12 offset:16384
  ds_read_b64_tr_b16 a[38:39], v12 offset:18432
  v_mfma_f32_16x16x32_bf16 v[120:123], a[176:179], a[144:147], v[120:123]
  v_mfma_f32_16x16x32_bf16 v[120:123], a[180:183], a[148:151], v[120:123]
  buffer_load_dwordx4 v3, s[8:11], s23 offen offset:1024 lds
  v_mfma_f32_16x16x32_bf16 v[124:127], a[180:183], a[156:159], v[124:127]
  v_mfma_f32_16x16x32_bf16 v[124:127], a[176:179], a[152:155], v[124:127]
  v_mfma_f32_16x16x32_bf16 v[128:131], a[184:187], a[96:99], v[128:131]
  v_mfma_f32_16x16x32_bf16 v[128:131], a[188:191], a[100:103], v[128:131]
  ds_read_b128 a[168:171], v10 offset:51200
  ds_read_b128 a[172:175], v11 offset:51200
  ds_read_b64_tr_b16 a[44:45], v13 offset:16384
  ds_read_b64_tr_b16 a[46:47], v13 offset:18432
  v_mfma_f32_16x16x32_bf16 v[132:135], a[188:191], a[108:111], v[132:135]
  v_mfma_f32_16x16x32_bf16 v[132:135], a[184:187], a[104:107], v[132:135]
  buffer_load_dwordx4 v4, s[8:11], s23 offen offset:2048 lds
  v_mfma_f32_16x16x32_bf16 v[136:139], a[184:187], a[112:115], v[136:139]
  v_mfma_f32_16x16x32_bf16 v[136:139], a[188:191], a[116:119], v[136:139]
  v_mfma_f32_16x16x32_bf16 v[140:143], a[188:191], a[124:127], v[140:143]
  v_mfma_f32_16x16x32_bf16 v[140:143], a[184:187], a[120:123], v[140:143]
  ds_read_b64_tr_b16 a[52:53], v14 offset:16384
  ds_read_b64_tr_b16 a[54:55], v14 offset:18432
  v_mfma_f32_16x16x32_bf16 v[144:147], a[184:187], a[128:131], v[144:147]
  v_mfma_f32_16x16x32_bf16 v[144:147], a[188:191], a[132:135], v[144:147]
  buffer_load_dwordx4 v5, s[8:11], s23 offen offset:3072 lds
  v_mfma_f32_16x16x32_bf16 v[148:151], a[188:191], a[140:143], v[148:151]
  v_mfma_f32_16x16x32_bf16 v[148:151], a[184:187], a[136:139], v[148:151]
  v_mfma_f32_16x16x32_bf16 v[152:155], a[184:187], a[144:147], v[152:155]
  v_mfma_f32_16x16x32_bf16 v[152:155], a[188:191], a[148:151], v[152:155]
  ds_read_b64_tr_b16 a[60:61], v15 offset:16384
  ds_read_b64_tr_b16 a[62:63], v15 offset:18432
  v_mfma_f32_16x16x32_bf16 v[156:159], a[188:191], a[156:159], v[156:159]
  s_add_u32 m0, s29, 65536
  s_nop 0
  buffer_load_dwordx4 v6, s[12:15], s24 offen offset:0 lds
  v_mfma_f32_16x16x32_bf16 v[156:159], a[184:187], a[152:155], v[156:159]
  s_waitcnt lgkmcnt(10)
  v_mfma_f32_16x16x32_bf16 v[160:163], a[160:163], a[96:99], v[160:163]
  v_mfma_f32_16x16x32_bf16 v[160:163], a[164:167], a[100:103], v[160:163]
  ds_read_b128 a[176:179], v10 offset:53248
  ds_read_b128 a[180:183], v11 offset:53248
  v_mfma_f32_16x16x32_bf16 v[164:167], a[164:167], a[108:111], v[164:167]
  v_mfma_f32_16x16x32_bf16 v[164:167], a[160:163], a[104:107], v[164:167]
  ds_read_b64_tr_b16 a[68:69], v16 offset:16384
  ds_read_b64_tr_b16 a[70:71], v16 offset:18432
  v_mfma_f32_16x16x32_bf16 v[168:171], a[160:163], a[112:115], v[168:171]
  v_mfma_f32_16x16x32_bf16 v[168:171], a[164:167], a[116:119], v[168:171]
  buffer_load_dwordx4 v7, s[12:15], s24 offen offset:1024 lds
  v_mfma_f32_16x16x32_bf16 v[172:175], a[164:167], a[124:127], v[172:175]
  v_mfma_f32_16x16x32_bf16 v[172:175], a[160:163], a[120:123], v[172:175]
  v_mfma_f32_16x16x32_bf16 v[176:179], a[160:163], a[128:131], v[176:179]
  v_mfma_f32_16x16x32_bf16 v[176:179], a[164:167], a[132:135], v[176:179]
  ds_read_b64_tr_b16 a[76:77], v17 offset:16384
  ds_read_b64_tr_b16 a[78:79], v17 offset:18432
  v_mfma_f32_16x16x32_bf16 v[180:183], a[164:167], a[140:143], v[180:183]
  v_mfma_f32_16x16x32_bf16 v[180:183], a[160:163], a[136:139], v[180:183]
  buffer_load_dwordx4 v8, s[12:15], s24 offen offset:2048 lds
  v_mfma_f32_16x16x32_bf16 v[184:187], a[160:163], a[144:147], v[184:187]
  v_mfma_f32_16x16x32_bf16 v[184:187], a[164:167], a[148:151], v[184:187]
  v_mfma_f32_16x16x32_bf16 v[188:191], a[164:167], a[156:159], v[188:191]
  v_mfma_f32_16x16x32_bf16 v[188:191], a[160:163], a[152:155], v[188:191]
  s_waitcnt lgkmcnt(12)
  ds_read_b64_tr_b16 a[84:85], v18 offset:16384
  ds_read_b64_tr_b16 a[86:87], v18 offset:18432
  v_mfma_f32_16x16x32_bf16 v[192:195], a[168:171], a[96:99], v[192:195]
  buffer_load_dwordx4 v9, s[12:15], s24 offen offset:3072 lds
  v_mfma_f32_16x16x32_bf16 v[192:195], a[172:175], a[100:103], v[192:195]
  ds_read_b128 a[184:187], v10 offset:55296
  ds_read_b128 a[188:191], v11 offset:55296
  v_mfma_f32_16x16x32_bf16 v[196:199], a[172:175], a[108:111], v[196:199]
  v_mfma_f32_16x16x32_bf16 v[196:199], a[168:171], a[104:107], v[196:199]
  v_mfma_f32_16x16x32_bf16 v[200:203], a[168:171], a[112:115], v[200:203]
  v_mfma_f32_16x16x32_bf16 v[200:203], a[172:175], a[116:119], v[200:203]
  ds_read_b64_tr_b16 a[92:93], v19 offset:16384
  ds_read_b64_tr_b16 a[94:95], v19 offset:18432
  v_mfma_f32_16x16x32_bf16 v[204:207], a[172:175], a[124:127], v[204:207]
  s_add_u32 s24, s24, 262144
  v_mfma_f32_16x16x32_bf16 v[204:207], a[168:171], a[120:123], v[204:207]
  v_mfma_f32_16x16x32_bf16 v[208:211], a[168:171], a[128:131], v[208:211]
  v_mfma_f32_16x16x32_bf16 v[208:211], a[172:175], a[132:135], v[208:211]
  v_mfma_f32_16x16x32_bf16 v[212:215], a[172:175], a[140:143], v[212:215]
  v_mfma_f32_16x16x32_bf16 v[212:215], a[168:171], a[136:139], v[212:215]
  buffer_load_dword v21, v20, s[60:63], s54 offen
  s_add_u32 s54, s54, s55
  v_mfma_f32_16x16x32_bf16 v[216:219], a[168:171], a[144:147], v[216:219]
  v_mfma_f32_16x16x32_bf16 v[216:219], a[172:175], a[148:151], v[216:219]
  v_mfma_f32_16x16x32_bf16 v[220:223], a[172:175], a[156:159], v[220:223]
  v_mfma_f32_16x16x32_bf16 v[220:223], a[168:171], a[152:155], v[220:223]
  s_waitcnt lgkmcnt(10)
  v_mfma_f32_16x16x32_bf16 v[224:227], a[176:179], a[96:99], v[224:227]
  s_cmp_eq_u32 s54, s56
  s_cselect_b32 s54, s57, s54
  s_cselect_b64 s[60:61], s[58:59], s[60:61]
  s_cselect_b32 s62, s7, s62
  v_mfma_f32_16x16x32_bf16 v[224:227], a[180:183], a[100:103], v[224:227]
  v_mfma_f32_16x16x32_bf16 v[228:231], a[180:183], a[108:111], v[228:231]
  v_mfma_f32_16x16x32_bf16 v[228:231], a[176:179], a[104:107], v[228:231]
  v_mfma_f32_16x16x32_bf16 v[232:235], a[176:179], a[112:115], v[232:235]
  v_mfma_f32_16x16x32_bf16 v[232:235], a[180:183], a[116:119], v[232:235]
  v_mfma_f32_16x16x32_bf16 v[236:239], a[180:183], a[124:127], v[236:239]
  v_mfma_f32_16x16x32_bf16 v[236:239], a[176:179], a[120:123], v[236:239]
  s_waitcnt vmcnt(18) lgkmcnt(0)
  s_barrier
  ds_read_b128 a[160:163], v10 offset:0
  ds_read_b128 a[164:167], v11 offset:0
  v_mfma_f32_16x16x32_bf16 v[240:243], a[176:179], a[128:131], v[240:243]
  s_add_u32 m0, s29, 49152
  s_add_u32 s3, s23, s31
  buffer_load_dwordx4 v2, s[8:11], s3 offen offset:0 lds
  v_mfma_f32_16x16x32_bf16 v[240:243], a[180:183], a[132:135], v[240:243]
  v_mfma_f32_16x16x32_bf16 v[244:247], a[180:183], a[140:143], v[244:247]
  v_mfma_f32_16x16x32_bf16 v[244:247], a[176:179], a[136:139], v[244:247]
  v_mfma_f32_16x16x32_bf16 v[248:251], a[176:179], a[144:147], v[248:251]
  v_mfma_f32_16x16x32_bf16 v[248:251], a[180:183], a[148:151], v[248:251]
  buffer_load_dwordx4 v3, s[8:11], s3 offen offset:1024 lds
  v_mfma_f32_16x16x32_bf16 v[252:255], a[180:183], a[156:159], v[252:255]
  v_mfma_f32_16x16x32_bf16 v[252:255], a[176:179], a[152:155], v[252:255]
  v_mfma_f32_16x16x32_bf16 a[0:3], a[184:187], a[96:99], a[0:3]
  v_mfma_f32_16x16x32_bf16 a[0:3], a[188:191], a[100:103], a[0:3]
  ds_read_b128 a[168:171], v10 offset:2048
  ds_read_b128 a[172:175], v11 offset:2048
  v_mfma_f32_16x16x32_bf16 a[4:7], a[188:191], a[108:111], a[4:7]
  v_mfma_f32_16x16x32_bf16 a[4:7], a[184:187], a[104:107], a[4:7]
  v_mfma_f32_16x16x32_bf16 a[8:11], a[184:187], a[112:115], a[8:11]
  buffer_load_dwordx4 v4, s[8:11], s3 offen offset:2048 lds
  v_mfma_f32_16x16x32_bf16 a[8:11], a[188:191], a[116:119], a[8:11]
  v_mfma_f32_16x16x32_bf16 a[12:15], a[188:191], a[124:127], a[12:15]
  v_mfma_f32_16x16x32_bf16 a[12:15], a[184:187], a[120:123], a[12:15]
  v_mfma_f32_16x16x32_bf16 a[16:19], a[184:187], a[128:131], a[16:19]
  v_mfma_f32_16x16x32_bf16 a[16:19], a[188:191], a[132:135], a[16:19]
  buffer_load_dwordx4 v5, s[8:11], s3 offen offset:3072 lds
  v_mfma_f32_16x16x32_bf16 a[20:23], a[188:191], a[140:143], a[20:23]
  v_mfma_f32_16x16x32_bf16 a[20:23], a[184:187], a[136:139], a[20:23]
  v_mfma_f32_16x16x32_bf16 a[24:27], a[184:187], a[144:147], a[24:27]
  v_mfma_f32_16x16x32_bf16 a[24:27], a[188:191], a[148:151], a[24:27]
  v_mfma_f32_16x16x32_bf16 a[28:31], a[188:191], a[156:159], a[28:31]
  v_mfma_f32_16x16x32_bf16 a[28:31], a[184:187], a[152:155], a[28:31]
  s_waitcnt lgkmcnt(2)
  v_mfma_f32_16x16x32_bf16 v[32:35], a[160:163], a[32:35], v[32:35]
  s_add_u32 s23, s23, 128
  s_cmp_eq_u32 s23, s25
  s_cselect_b32 s23, s26, s23
  v_mfma_f32_16x16x32_bf16 v[32:35], a[164:167], a[36:39], v[32:35]
  ds_read_b128 a[176:179], v10 offset:4096
  ds_read_b128 a[180:183], v11 offset:4096
  v_mfma_f32_16x16x32_bf16 v[36:39], a[164:167], a[44:47], v[36:39]
  v_mfma_f32_16x16x32_bf16 v[36:39], a[160:163], a[40:43], v[36:39]
  ds_read_b64_tr_b16 a[96:97], v12 offset:32768
  ds_read_b64_tr_b16 a[98:99], v12 offset:34816
  v_mfma_f32_16x16x32_bf16 v[40:43], a[160:163], a[48:51], v[40:43]
  v_mfma_f32_16x16x32_bf16 v[40:43], a[164:167], a[52:55], v[40:43]
  v_mfma_f32_16x16x32_bf16 v[44:47], a[164:167], a[60:63], v[44:47]
  s_add_u32 m0, s29, 81920
  s_nop 0
  buffer_load_dwordx4 v6, s[12:15], s24 offen offset:0 lds
  v_mfma_f32_16x16x32_bf16 v[44:47], a[160:163], a[56:59], v[44:47]
  ds_read_b64_tr_b16 a[104:105], v13 offset:32768
  ds_read_b64_tr_b16 a[106:107], v13 offset:34816
  v_mfma_f32_16x16x32_bf16 v[48:51], a[160:163], a[64:67], v[48:51]
  v_mfma_f32_16x16x32_bf16 v[48:51], a[164:167], a[68:71], v[48:51]
  v_mfma_f32_16x16x32_bf16 v[52:55], a[164:167], a[76:79], v[52:55]
  v_mfma_f32_16x16x32_bf16 v[52:55], a[160:163], a[72:75], v[52:55]
  ds_read_b64_tr_b16 a[112:113], v14 offset:32768
  ds_read_b64_tr_b16 a[114:115], v14 offset:34816
  v_mfma_f32_16x16x32_bf16 v[56:59], a[160:163], a[80:83], v[56:59]
  v_mfma_f32_16x16x32_bf16 v[56:59], a[164:167], a[84:87], v[56:59]
  buffer_load_dwordx4 v7, s[12:15], s24 offen offset:1024 lds
  v_mfma_f32_16x16x32_bf16 v[60:63], a[164:167], a[92:95], v[60:63]
  v_mfma_f32_16x16x32_bf16 v[60:63], a[160:163], a[88:91], v[60:63]
  s_waitcnt lgkmcnt(8)
  ds_read_b64_tr_b16 a[120:121], v15 offset:32768
  ds_read_b64_tr_b16 a[122:123], v15 offset:34816
  v_mfma_f32_16x16x32_bf16 v[64:67], a[168:171], a[32:35], v[64:67]
  v_mfma_f32_16x16x32_bf16 v[64:67], a[172:175], a[36:39], v[64:67]
  ds_read_b128 a[184:187], v10 offset:6144
  ds_read_b128 a[188:191], v11 offset:6144
  v_mfma_f32_16x16x32_bf16 v[68:71], a[172:175], a[44:47], v[68:71]
  v_mfma_f32_16x16x32_bf16 v[68:71], a[168:171], a[40:43], v[68:71]
  ds_read_b64_tr_b16 a[128:129], v16 offset:32768
  ds_read_b64_tr_b16 a[130:131], v16 offset:34816
  v_mfma_f32_16x16x32_bf16 v[72:75], a[168:171], a[48:51], v[72:75]
  buffer_load_dwordx4 v8, s[12:15], s24 offen offset:2048 lds
  v_mfma_f32_16x16x32_bf16 v[72:75], a[172:175], a[52:55], v[72:75]
  v_mfma_f32_16x16x32_bf16 v[76:79], a[172:175], a[60:63], v[76:79]
  v_mfma_f32_16x16x32_bf16 v[76:79], a[168:171], a[56:59], v[76:79]
  ds_read_b64_tr_b16 a[136:137], v17 offset:32768
  ds_read_b64_tr_b16 a[138:139], v17 offset:34816
  v_mfma_f32_16x16x32_bf16 v[80:83], a[168:171], a[64:67], v[80:83]
  v_mfma_f32_16x16x32_bf16 v[80:83], a[172:175], a[68:71], v[80:83]
  v_mfma_f32_16x16x32_bf16 v[84:87], a[172:175], a[76:79], v[84:87]
  buffer_load_dwordx4 v9, s[12:15], s24 offen offset:3072 lds
  v_mfma_f32_16x16x32_bf16 v[84:87], a[168:171], a[72:75], v[84:87]
  ds_read_b64_tr_b16 a[144:145], v18 offset:32768
  ds_read_b64_tr_b16 a[146:147], v18 offset:34816
  v_mfma_f32_16x16x32_bf16 v[88:91], a[168:171], a[80:83], v[88:91]
  v_mfma_f32_16x16x32_bf16 v[88:91], a[172:175], a[84:87], v[88:91]
  v_mfma_f32_16x16x32_bf16 v[92:95], a[172:175], a[92:95], v[92:95]
  v_mfma_f32_16x16x32_bf16 v[92:95], a[168:171], a[88:91], v[92:95]
  s_waitcnt lgkmcnt(15)
  ds_read_b64_tr_b16 a[152:153], v19 offset:32768
  ds_read_b64_tr_b16 a[154:155], v19 offset:34816
  v_mfma_f32_16x16x32_bf16 v[96:99], a[176:179], a[32:35], v[96:99]
  s_add_u32 s24, s24, 262144
  s_cmp_eq_u32 s24, s27
  s_cselect_b32 s24, s28, s24
  s_cselect_b64 s[12:13], s[64:65], s[12:13]
  v_mfma_f32_16x16x32_bf16 v[96:99], a[180:183], a[36:39], v[96:99]
  v_mfma_f32_16x16x32_bf16 v[100:103], a[180:183], a[44:47], v[100:103]
  v_mfma_f32_16x16x32_bf16 v[100:103], a[176:179], a[40:43], v[100:103]
  v_mfma_f32_16x16x32_bf16 v[104:107], a[176:179], a[48:51], v[104:107]
  v_mfma_f32_16x16x32_bf16 v[104:107], a[180:183], a[52:55], v[104:107]
  v_mfma_f32_16x16x32_bf16 v[108:111], a[180:183], a[60:63], v[108:111]
  v_mfma_f32_16x16x32_bf16 v[108:111], a[176:179], a[56:59], v[108:111]
  s_waitcnt vmcnt(17) lgkmcnt(0)
  s_barrier
  ds_read_b128 a[160:163], v10 offset:16384
  ds_read_b128 a[164:167], v11 offset:16384
  v_mfma_f32_16x16x32_bf16 v[112:115], a[176:179], a[64:67], v[112:115]
  s_add_u32 m0, s29, 0
  s_nop 0
  buffer_load_dwordx4 v2, s[8:11], s23 offen offset:0 lds
  v_mfma_f32_16x16x32_bf16 v[112:115], a[180:183], a[68:71], v[112:115]
  v_mfma_f32_16x16x32_bf16 v[116:119], a[180:183], a[76:79], v[116:119]
  v_mfma_f32_16x16x32_bf16 v[116:119], a[176:179], a[72:75], v[116:119]
  ds_read_b64_tr_b16 a[100:101], v12 offset:49152
  ds_read_b64_tr_b16 a[102:103], v12 offset:51200
  v_mfma_f32_16x16x32_bf16 v[120:123], a[176:179], a[80:83], v[120:123]
  v_mfma_f32_16x16x32_bf16 v[120:123], a[180:183], a[84:87], v[120:123]
  buffer_load_dwordx4 v3, s[8:11], s23 offen offset:1024 lds
  v_mfma_f32_16x16x32_bf16 v[124:127], a[180:183], a[92:95], v[124:127]
  v_mfma_f32_16x16x32_bf16 v[124:127], a[176:179], a[88:91], v[124:127]
  v_mfma_f32_16x16x32_bf16 v[128:131], a[184:187], a[32:35], v[128:131]
  v_mfma_f32_16x16x32_bf16 v[128:131], a[188:191], a[36:39], v[128:131]
  ds_read_b128 a[168:171], v10 offset:18432
  ds_read_b128 a[172:175], v11 offset:18432
  ds_read_b64_tr_b16 a[108:109], v13 offset:49152
  ds_read_b64_tr_b16 a[110:111], v13 offset:51200
  v_mfma_f32_16x16x32_bf16 v[132:135], a[188:191], a[44:47], v[132:135]
  v_mfma_f32_16x16x32_bf16 v[132:135], a[184:187], a[40:43], v[132:135]
  buffer_load_dwordx4 v4, s[8:11], s23 offen offset:2048 lds
  v_mfma_f32_16x16x32_bf16 v[136:139], a[184:187], a[48:51], v[136:139]
  v_mfma_f32_16x16x32_bf16 v[136:139], a[188:191], a[52:55], v[136:139]
  v_mfma_f32_16x16x32_bf16 v[140:143], a[188:191], a[60:63], v[140:143]
  v_mfma_f32_16x16x32_bf16 v[140:143], a[184:187], a[56:59], v[140:143]
  ds_read_b64_tr_b16 a[116:117], v14 offset:49152
  ds_read_b64_tr_b16 a[118:119], v14 offset:51200
  v_mfma_f32_16x16x32_bf16 v[144:147], a[184:187], a[64:67], v[144:147]
  v_mfma_f32_16x16x32_bf16 v[144:147], a[188:191], a[68:71], v[144:147]
  buffer_load_dwordx4 v5, s[8:11], s23 offen offset:3072 lds
  v_mfma_f32_16x16x32_bf16 v[148:151], a[188:191], a[76:79], v[148:151]
  v_mfma_f32_16x16x32_bf16 v[148:151], a[184:187], a[72:75], v[148:151]
  v_mfma_f32_16x16x32_bf16 v[152:155], a[184:187], a[80:83], v[152:155]
  v_mfma_f32_16x16x32_bf16 v[152:155], a[188:191], a[84:87], v[152:155]
  ds_read_b64_tr_b16 a[124:125], v15 offset:49152
  ds_read_b64_tr_b16 a[126:127], v15 offset:51200
  v_mfma_f32_16x16x32_bf16 v[156:159], a[188:191], a[92:95], v[156:159]
  s_add_u32 m0, s29, 98304
  s_nop 0
  buffer_load_dwordx4 v6, s[12:15], s24 offen offset:0 lds
  v_mfma_f32_16x16x32_bf16 v[156:159], a[184:187], a[88:91], v[156:159]
  s_waitcnt lgkmcnt(10)
  v_mfma_f32_16x16x32_bf16 v[160:163], a[160:163], a[32:35], v[160:163]
  v_mfma_f32_16x16x32_bf16 v[160:163], a[164:167], a[36:39], v[160:163]
  ds_read_b128 a[176:179], v10 offset:20480
  ds_read_b128 a[180:183], v11 offset:20480
  v_mfma_f32_16x16x32_bf16 v[164:167], a[164:167], a[44:47], v[164:167]
  v_mfma_f32_16x16x32_bf16 v[164:167], a[160:163], a[40:43], v[164:167]
  ds_read_b64_tr_b16 a[132:133], v16 offset:49152
  ds_read_b64_tr_b16 a[134:135], v16 offset:51200
  v_mfma_f32_16x16x32_bf16 v[168:171], a[160:163], a[48:51], v[168:171]
  v_mfma_f32_16x16x32_bf16 v[168:171], a[164:167], a[52:55], v[168:171]
  buffer_load_dwordx4 v7, s[12:15], s24 offen offset:1024 lds
  v_mfma_f32_16x16x32_bf16 v[172:175], a[164:167], a[60:63], v[172:175]
  v_mfma_f32_16x16x32_bf16 v[172:175], a[160:163], a[56:59], v[172:175]
  v_mfma_f32_16x16x32_bf16 v[176:179], a[160:163], a[64:67], v[176:179]
  v_mfma_f32_16x16x32_bf16 v[176:179], a[164:167], a[68:71], v[176:179]
  ds_read_b64_tr_b16 a[140:141], v17 offset:49152
  ds_read_b64_tr_b16 a[142:143], v17 offset:51200
  v_mfma_f32_16x16x32_bf16 v[180:183], a[164:167], a[76:79], v[180:183]
  v_mfma_f32_16x16x32_bf16 v[180:183], a[160:163], a[72:75], v[180:183]
  buffer_load_dwordx4 v8, s[12:15], s24 offen offset:2048 lds
  v_mfma_f32_16x16x32_bf16 v[184:187], a[160:163], a[80:83], v[184:187]
  v_mfma_f32_16x16x32_bf16 v[184:187], a[164:167], a[84:87], v[184:187]
  v_mfma_f32_16x16x32_bf16 v[188:191], a[164:167], a[92:95], v[188:191]
  v_mfma_f32_16x16x32_bf16 v[188:191], a[160:163], a[88:91], v[188:191]
  s_waitcnt lgkmcnt(12)
  ds_read_b64_tr_b16 a[148:149], v18 offset:49152
  ds_read_b64_tr_b16 a[150:151], v18 offset:51200
  v_mfma_f32_16x16x32_bf16 v[192:195], a[168:171], a[32:35], v[192:195]
  buffer_load_dwordx4 v9, s[12:15], s24 offen offset:3072 lds
  v_mfma_f32_16x16x32_bf16 v[192:195], a[172:175], a[36:39], v[192:195]
  ds_read_b128 a[184:187], v10 offset:22528
  ds_read_b128 a[188:191], v11 offset:22528
  v_mfma_f32_16x16x32_bf16 v[196:199], a[172:175], a[44:47], v[196:199]
  v_mfma_f32_16x16x32_bf16 v[196:199], a[168:171], a[40:43], v[196:199]
  v_mfma_f32_16x16x32_bf16 v[200:203], a[168:171], a[48:51], v[200:203]
  v_mfma_f32_16x16x32_bf16 v[200:203], a[172:175], a[52:55], v[200:203]
  ds_read_b64_tr_b16 a[156:157], v19 offset:49152
  ds_read_b64_tr_b16 a[158:159], v19 offset:51200
  v_mfma_f32_16x16x32_bf16 v[204:207], a[172:175], a[60:63], v[204:207]
  s_add_u32 s24, s24, 262144
  v_mfma_f32_16x16x32_bf16 v[204:207], a[168:171], a[56:59], v[204:207]
  v_mfma_f32_16x16x32_bf16 v[208:211], a[168:171], a[64:67], v[208:211]
  v_mfma_f32_16x16x32_bf16 v[208:211], a[172:175], a[68:71], v[208:211]
  v_mfma_f32_16x16x32_bf16 v[212:215], a[172:175], a[76:79], v[212:215]
  v_mfma_f32_16x16x32_bf16 v[212:215], a[168:171], a[72:75], v[212:215]
  buffer_load_dword v21, v20, s[60:63], s54 offen
  s_add_u32 s54, s54, s55
  v_mfma_f32_16x16x32_bf16 v[216:219], a[168:171], a[80:83], v[216:219]
  v_mfma_f32_16x16x32_bf16 v[216:219], a[172:175], a[84:87], v[216:219]
  v_mfma_f32_16x16x32_bf16 v[220:223], a[172:175], a[92:95], v[220:223]
  v_mfma_f32_16x16x32_bf16 v[220:223], a[168:171], a[88:91], v[220:223]
  s_waitcnt lgkmcnt(10)
  v_mfma_f32_16x16x32_bf16 v[224:227], a[176:179], a[32:35], v[224:227]
  s_cmp_eq_u32 s54, s56
  s_cselect_b32 s54, s57, s54
  s_cselect_b64 s[60:61], s[58:59], s[60:61]
  s_cselect_b32 s62, s7, s62
  v_mfma_f32_16x16x32_bf16 v[224:227], a[180:183], a[36:39], v[224:227]
  v_mfma_f32_16x16x32_bf16 v[228:231], a[180:183], a[44:47], v[228:231]
  v_mfma_f32_16x16x32_bf16 v[228:231], a[176:179], a[40:43], v[228:231]
  v_mfma_f32_16x16x32_bf16 v[232:235], a[176:179], a[48:51], v[232:235]
  v_mfma_f32_16x16x32_bf16 v[232:235], a[180:183], a[52:55], v[232:235]
  v_mfma_f32_16x16x32_bf16 v[236:239], a[180:183], a[60:63], v[236:239]
  v_mfma_f32_16x16x32_bf16 v[236:239], a[176:179], a[56:59], v[236:239]
  s_waitcnt vmcnt(18) lgkmcnt(0)
  s_barrier
  ds_read_b128 a[160:163], v10 offset:32768
  ds_read_b128 a[164:167], v11 offset:32768
  v_mfma_f32_16x16x32_bf16 v[240:243], a[176:179], a[64:67], v[240:243]
  s_add_u32 m0, s29, 16384
  s_add_u32 s3, s23, s31
  buffer_load_dwordx4 v2, s[8:11], s3 offen offset:0 lds
  v_mfma_f32_16x16x32_bf16 v[240:243], a[180:183], a[68:71], v[240:243]
  v_mfma_f32_16x16x32_bf16 v[244:247], a[180:183], a[76:79], v[244:247]
  v_mfma_f32_16x16x32_bf16 v[244:247], a[176:179], a[72:75], v[244:247]
  v_mfma_f32_16x16x32_bf16 v[248:251], a[176:179], a[80:83], v[248:251]
  v_mfma_f32_16x16x32_bf16 v[248:251], a[180:183], a[84:87], v[248:251]
  buffer_load_dwordx4 v3, s[8:11], s3 offen offset:1024 lds
  v_mfma_f32_16x16x32_bf16 v[252:255], a[180:183], a[92:95], v[252:255]
  v_mfma_f32_16x16x32_bf16 v[252:255], a[176:179], a[88:91], v[252:255]
  v_mfma_f32_16x16x32_bf16 a[0:3], a[184:187], a[32:35], a[0:3]
  v_mfma_f32_16x16x32_bf16 a[0:3], a[188:191], a[36:39], a[0:3]
  ds_read_b128 a[168:171], v10 offset:34816
  ds_read_b128 a[172:175], v11 offset:34816
  v_mfma_f32_16x16x32_bf16 a[4:7], a[188:191], a[44:47], a[4:7]
  v_mfma_f32_16x16x32_bf16 a[4:7], a[184:187], a[40:43], a[4:7]
  v_mfma_f32_16x16x32_bf16 a[8:11], a[184:187], a[48:51], a[8:11]
  buffer_load_dwordx4 v4, s[8:11], s3 offen offset:2048 lds
  v_mfma_f32_16x16x32_bf16 a[8:11], a[188:191], a[52:55], a[8:11]
  v_mfma_f32_16x16x32_bf16 a[12:15], a[188:191], a[60:63], a[12:15]
  v_mfma_f32_16x16x32_bf16 a[12:15], a[184:187], a[56:59], a[12:15]
  v_mfma_f32_16x16x32_bf16 a[16:19], a[184:187], a[64:67], a[16:19]
  v_mfma_f32_16x16x32_bf16 a[16:19], a[188:191], a[68:71], a[16:19]
  buffer_load_dwordx4 v5, s[8:11], s3 offen offset:3072 lds
  v_mfma_f32_16x16x32_bf16 a[20:23], a[188:191], a[76:79], a[20:23]
  v_mfma_f32_16x16x32_bf16 a[20:23], a[184:187], a[72:75], a[20:23]
  v_mfma_f32_16x16x32_bf16 a[24:27], a[184:187], a[80:83], a[24:27]
  v_mfma_f32_16x16x32_bf16 a[24:27], a[188:191], a[84:87], a[24:27]
  v_mfma_f32_16x16x32_bf16 a[28:31], a[188:191], a[92:95], a[28:31]
  v_mfma_f32_16x16x32_bf16 a[28:31], a[184:187], a[88:91], a[28:31]
  s_waitcnt lgkmcnt(2)
  v_mfma_f32_16x16x32_bf16 v[32:35], a[160:163], a[96:99], v[32:35]
  s_add_u32 s23, s23, 128
  s_cmp_eq_u32 s23, s25
  s_cselect_b32 s23, s26, s23
  v_mfma_f32_16x16x32_bf16 v[32:35], a[164:167], a[100:103], v[32:35]
  ds_read_b128 a[176:179], v10 offset:36864
  ds_read_b128 a[180:183], v11 offset:36864
  v_mfma_f32_16x16x32_bf16 v[36:39], a[164:167], a[108:111], v[36:39]
  v_mfma_f32_16x16x32_bf16 v[36:39], a[160:163], a[104:107], v[36:39]
  ds_read_b64_tr_b16 a[32:33], v12 offset:0
  ds_read_b64_tr_b16 a[34:35], v12 offset:2048
  v_mfma_f32_16x16x32_bf16 v[40:43], a[160:163], a[112:115], v[40:43]
  v_mfma_f32_16x16x32_bf16 v[40:43], a[164:167], a[116:119], v[40:43]
  v_mfma_f32_16x16x32_bf16 v[44:47], a[164:167], a[124:127], v[44:47]
  s_add_u32 m0, s29, 114688
  s_nop 0
  buffer_load_dwordx4 v6, s[12:15], s24 offen offset:0 lds
  v_mfma_f32_16x16x32_bf16 v[44:47], a[160:163], a[120:123], v[44:47]
  ds_read_b64_tr_b16 a[40:41], v13 offset:0
  ds_read_b64_tr_b16 a[42:43], v13 offset:2048
  v_mfma_f32_16x16x32_bf16 v[48:51], a[160:163], a[128:131], v[48:51]
  v_mfma_f32_16x16x32_bf16 v[48:51], a[164:167], a[132:135], v[48:51]
  v_mfma_f32_16x16x32_bf16 v[52:55], a[164:167], a[140:143], v[52:55]
  v_mfma_f32_16x16x32_bf16 v[52:55], a[160:163], a[136:139], v[52:55]
  ds_read_b64_tr_b16 a[48:49], v14 offset:0
  ds_read_b64_tr_b16 a[50:51], v14 offset:2048
  v_mfma_f32_16x16x32_bf16 v[56:59], a[160:163], a[144:147], v[56:59]
  v_mfma_f32_16x16x32_bf16 v[56:59], a[164:167], a[148:151], v[56:59]
  buffer_load_dwordx4 v7, s[12:15], s24 offen offset:1024 lds
  v_mfma_f32_16x16x32_bf16 v[60:63], a[164:167], a[156:159], v[60:63]
  v_mfma_f32_16x16x32_bf16 v[60:63], a[160:163], a[152:155], v[60:63]
  s_waitcnt lgkmcnt(8)
  ds_read_b64_tr_b16 a[56:57], v15 offset:0
  ds_read_b64_tr_b16 a[58:59], v15 offset:2048
  v_mfma_f32_16x16x32_bf16 v[64:67], a[168:171], a[96:99], v[64:67]
  v_mfma_f32_16x16x32_bf16 v[64:67], a[172:175], a[100:103], v[64:67]
  ds_read_b128 a[184:187], v10 offset:38912
  ds_read_b128 a[188:191], v11 offset:38912
  v_mfma_f32_16x16x32_bf16 v[68:71], a[172:175], a[108:111], v[68:71]
  v_mfma_f32_16x16x32_bf16 v[68:71], a[168:171], a[104:107], v[68:71]
  ds_read_b64_tr_b16 a[64:65], v16 offset:0
  ds_read_b64_tr_b16 a[66:67], v16 offset:2048
  v_mfma_f32_16x16x32_bf16 v[72:75], a[168:171], a[112:115], v[72:75]
  buffer_load_dwordx4 v8, s[12:15], s24 offen offset:2048 lds
  v_mfma_f32_16x16x32_bf16 v[72:75], a[172:175], a[116:119], v[72:75]
  v_mfma_f32_16x16x32_bf16 v[76:79], a[172:175], a[124:127], v[76:79]
  v_mfma_f32_16x16x32_bf16 v[76:79], a[168:171], a[120:123], v[76:79]
  ds_read_b64_tr_b16 a[72:73], v17 offset:0
  ds_read_b64_tr_b16 a[74:75], v17 offset:2048
  v_mfma_f32_16x16x32_bf16 v[80:83], a[168:171], a[128:131], v[80:83]
  v_mfma_f32_16x16x32_bf16 v[80:83], a[172:175], a[132:135], v[80:83]
  v_mfma_f32_16x16x32_bf16 v[84:87], a[172:175], a[140:143], v[84:87]
  buffer_load_dwordx4 v9, s[12:15], s24 offen offset:3072 lds
  v_mfma_f32_16x16x32_bf16 v[84:87], a[168:171], a[136:139], v[84:87]
  ds_read_b64_tr_b16 a[80:81], v18 offset:0
  ds_read_b64_tr_b16 a[82:83], v18 offset:2048
  v_mfma_f32_16x16x32_bf16 v[88:91], a[168:171], a[144:147], v[88:91]
  v_mfma_f32_16x16x32_bf16 v[88:91], a[172:175], a[148:151], v[88:91]
  v_mfma_f32_16x16x32_bf16 v[92:95], a[172:175], a[156:159], v[92:95]
  v_mfma_f32_16x16x32_bf16 v[92:95], a[168:171], a[152:155], v[92:95]
  s_waitcnt lgkmcnt(15)
  ds_read_b64_tr_b16 a[88:89], v19 offset:0
  ds_read_b64_tr_b16 a[90:91], v19 offset:2048
  v_mfma_f32_16x16x32_bf16 v[96:99], a[176:179], a[96:99], v[96:99]
  s_add_u32 s24, s24, 262144
  s_cmp_eq_u32 s24, s27
  s_cselect_b32 s24, s28, s24
  s_cselect_b64 s[12:13], s[64:65], s[12:13]
  v_mfma_f32_16x16x32_bf16 v[96:99], a[180:183], a[100:103], v[96:99]
  v_mfma_f32_16x16x32_bf16 v[100:103], a[180:183], a[108:111], v[100:103]
  v_mfma_f32_16x16x32_bf16 v[100:103], a[176:179], a[104:107], v[100:103]
  v_mfma_f32_16x16x32_bf16 v[104:107], a[176:179], a[112:115], v[104:107]
  v_mfma_f32_16x16x32_bf16 v[104:107], a[180:183], a[116:119], v[104:107]
  v_mfma_f32_16x16x32_bf16 v[108:111], a[180:183], a[124:127], v[108:111]
  v_mfma_f32_16x16x32_bf16 v[108:111], a[176:179], a[120:123], v[108:111]
  s_waitcnt vmcnt(17) lgkmcnt(0)
  s_barrier
  ds_read_b128 a[160:163], v10 offset:49152
  ds_read_b128 a[164:167], v11 offset:49152
  v_mfma_f32_16x16x32_bf16 v[112:115], a[176:179], a[128:131], v[112:115]
  s_add_u32 m0, s29, 32768
  s_nop 0
  buffer_load_dwordx4 v2, s[8:11], s23 offen offset:0 lds
  v_mfma_f32_16x16x32_bf16 v[112:115], a[180:183], a[132:135], v[112:115]
  v_mfma_f32_16x16x32_bf16 v[116:119], a[180:183], a[140:143], v[116:119]
  v_mfma_f32_16x16x32_bf16 v[116:119], a[176:179], a[136:139], v[116:119]
  ds_read_b64_tr_b16 a[36:37], v12 offset:16384
  ds_read_b64_tr_b16 a[38:39], v12 offset:18432
  v_mfma_f32_16x16x32_bf16 v[120:123], a[176:179], a[144:147], v[120:123]
  v_mfma_f32_16x16x32_bf16 v[120:123], a[180:183], a[148:151], v[120:123]
  buffer_load_dwordx4 v3, s[8:11], s23 offen offset:1024 lds
  v_mfma_f32_16x16x32_bf16 v[124:127], a[180:183], a[156:159], v[124:127]
  v_mfma_f32_16x16x32_bf16 v[124:127], a[176:179], a[152:155], v[124:127]
  v_mfma_f32_16x16x32_bf16 v[128:131], a[184:187], a[96:99], v[128:131]
  v_mfma_f32_16x16x32_bf16 v[128:131], a[188:191], a[100:103], v[128:131]
  ds_read_b128 a[168:171], v10 offset:51200
  ds_read_b128 a[172:175], v11 offset:51200
  ds_read_b64_tr_b16 a[44:45], v13 offset:16384
  ds_read_b64_tr_b16 a[46:47], v13 offset:18432
  v_mfma_f32_16x16x32_bf16 v[132:135], a[188:191], a[108:111], v[132:135]
  v_mfma_f32_16x16x32_bf16 v[132:135], a[184:187], a[104:107], v[132:135]
  buffer_load_dwordx4 v4, s[8:11], s23 offen offset:2048 lds
  v_mfma_f32_16x16x32_bf16 v[136:139], a[184:187], a[112:115], v[136:139]
  v_mfma_f32_16x16x32_bf16 v[136:139], a[188:191], a[116:119], v[136:139]
  v_mfma_f32_16x16x32_bf16 v[140:143], a[188:191], a[124:127], v[140:143]
  v_mfma_f32_16x16x32_bf16 v[140:143], a[184:187], a[120:123], v[140:143]
  ds_read_b64_tr_b16 a[52:53], v14 offset:16384
  ds_read_b64_tr_b16 a[54:55], v14 offset:18432
  v_mfma_f32_16x16x32_bf16 v[144:147], a[184:187], a[128:131], v[144:147]
  v_mfma_f32_16x16x32_bf16 v[144:147], a[188:191], a[132:135], v[144:147]
  buffer_load_dwordx4 v5, s[8:11], s23 offen offset:3072 lds
  v_mfma_f32_16x16x32_bf16 v[148:151], a[188:191], a[140:143], v[148:151]
  v_mfma_f32_16x16x32_bf16 v[148:151], a[184:187], a[136:139], v[148:151]
  v_mfma_f32_16x16x32_bf16 v[152:155], a[184:187], a[144:147], v[152:155]
  v_mfma_f32_16x16x32_bf16 v[152:155], a[188:191], a[148:151], v[152:155]
  ds_read_b64_tr_b16 a[60:61], v15 offset:16384
  ds_read_b64_tr_b16 a[62:63], v15 offset:18432
  v_mfma_f32_16x16x32_bf16 v[156:159], a[188:191], a[156:159], v[156:159]
  s_add_u32 m0, s29, 65536
  s_nop 0
  buffer_load_dwordx4 v6, s[12:15], s24 offen offset:0 lds
  v_mfma_f32_16x16x32_bf16 v[156:159], a[184:187], a[152:155], v[156:159]
  s_waitcnt lgkmcnt(10)
  v_mfma_f32_16x16x32_bf16 v[160:163], a[160:163], a[96:99], v[160:163]
  v_mfma_f32_16x16x32_bf16 v[160:163], a[164:167], a[100:103], v[160:163]
  ds_read_b128 a[176:179], v10 offset:53248
  ds_read_b128 a[180:183], v11 offset:53248
  v_mfma_f32_16x16x32_bf16 v[164:167], a[164:167], a[108:111], v[164:167]
  v_mfma_f32_16x16x32_bf16 v[164:167], a[160:163], a[104:107], v[164:167]
  ds_read_b64_tr_b16 a[68:69], v16 offset:16384
  ds_read_b64_tr_b16 a[70:71], v16 offset:18432
  v_mfma_f32_16x16x32_bf16 v[168:171], a[160:163], a[112:115], v[168:171]
  v_mfma_f32_16x16x32_bf16 v[168:171], a[164:167], a[116:119], v[168:171]
  buffer_load_dwordx4 v7, s[12:15], s24 offen offset:1024 lds
  v_mfma_f32_16x16x32_bf16 v[172:175], a[164:167], a[124:127], v[172:175]
  v_mfma_f32_16x16x32_bf16 v[172:175], a[160:163], a[120:123], v[172:175]
  v_mfma_f32_16x16x32_bf16 v[176:179], a[160:163], a[128:131], v[176:179]
  v_mfma_f32_16x16x32_bf16 v[176:179], a[164:167], a[132:135], v[176:179]
  ds_read_b64_tr_b16 a[76:77], v17 offset:16384
  ds_read_b64_tr_b16 a[78:79], v17 offset:18432
  v_mfma_f32_16x16x32_bf16 v[180:183], a[164:167], a[140:143], v[180:183]
  v_mfma_f32_16x16x32_bf16 v[180:183], a[160:163], a[136:139], v[180:183]
  buffer_load_dwordx4 v8, s[12:15], s24 offen offset:2048 lds
  v_mfma_f32_16x16x32_bf16 v[184:187], a[160:163], a[144:147], v[184:187]
  v_mfma_f32_16x16x32_bf16 v[184:187], a[164:167], a[148:151], v[184:187]
  v_mfma_f32_16x16x32_bf16 v[188:191], a[164:167], a[156:159], v[188:191]
  v_mfma_f32_16x16x32_bf16 v[188:191], a[160:163], a[152:155], v[188:191]
  s_waitcnt lgkmcnt(12)
  ds_read_b64_tr_b16 a[84:85], v18 offset:16384
  ds_read_b64_tr_b16 a[86:87], v18 offset:18432
  v_mfma_f32_16x16x32_bf16 v[192:195], a[168:171], a[96:99], v[192:195]
  buffer_load_dwordx4 v9, s[12:15], s24 offen offset:3072 lds
  v_mfma_f32_16x16x32_bf16 v[192:195], a[172:175], a[100:103], v[192:195]
  ds_read_b128 a[184:187], v10 offset:55296
  ds_read_b128 a[188:191], v11 offset:55296
  v_mfma_f32_16x16x32_bf16 v[196:199], a[172:175], a[108:111], v[196:199]
  v_mfma_f32_16x16x32_bf16 v[196:199], a[168:171], a[104:107], v[196:199]
  v_mfma_f32_16x16x32_bf16 v[200:203], a[168:171], a[112:115], v[200:203]
  v_mfma_f32_16x16x32_bf16 v[200:203], a[172:175], a[116:119], v[200:203]
  ds_read_b64_tr_b16 a[92:93], v19 offset:16384
  ds_read_b64_tr_b16 a[94:95], v19 offset:18432
  v_mfma_f32_16x16x32_bf16 v[204:207], a[172:175], a[124:127], v[204:207]
  s_add_u32 s24, s24, 262144
  v_mfma_f32_16x16x32_bf16 v[204:207], a[168:171], a[120:123], v[204:207]
  v_mfma_f32_16x16x32_bf16 v[208:211], a[168:171], a[128:131], v[208:211]
  v_mfma_f32_16x16x32_bf16 v[208:211], a[172:175], a[132:135], v[208:211]
  v_mfma_f32_16x16x32_bf16 v[212:215], a[172:175], a[140:143], v[212:215]
  v_mfma_f32_16x16x32_bf16 v[212:215], a[168:171], a[136:139], v[212:215]
  buffer_load_dword v21, v20, s[60:63], s54 offen
  s_add_u32 s54, s54, s55
  v_mfma_f32_16x16x32_bf16 v[216:219], a[168:171], a[144:147], v[216:219]
  v_mfma_f32_16x16x32_bf16 v[216:219], a[172:175], a[148:151], v[216:219]
  v_mfma_f32_16x16x32_bf16 v[220:223], a[172:175], a[156:159], v[220:223]
  v_mfma_f32_16x16x32_bf16 v[220:223], a[168:171], a[152:155], v[220:223]
  s_waitcnt lgkmcnt(10)
  v_mfma_f32_16x16x32_bf16 v[224:227], a[176:179], a[96:99], v[224:227]
  s_cmp_eq_u32 s54, s56
  s_cselect_b32 s54, s57, s54
  s_cselect_b64 s[60:61], s[58:59], s[60:61]
  s_cselect_b32 s62, s7, s62
  v_mfma_f32_16x16x32_bf16 v[224:227], a[180:183], a[100:103], v[224:227]
  v_mfma_f32_16x16x32_bf16 v[228:231], a[180:183], a[108:111], v[228:231]
  v_mfma_f32_16x16x32_bf16 v[228:231], a[176:179], a[104:107], v[228:231]
  v_mfma_f32_16x16x32_bf16 v[232:235], a[176:179], a[112:115], v[232:235]
  v_mfma_f32_16x16x32_bf16 v[232:235], a[180:183], a[116:119], v[232:235]
  v_mfma_f32_16x16x32_bf16 v[236:239], a[180:183], a[124:127], v[236:239]
  v_mfma_f32_16x16x32_bf16 v[236:239], a[176:179], a[120:123], v[236:239]
  s_waitcnt vmcnt(18) lgkmcnt(0)
  s_barrier
  ds_read_b128 a[160:163], v10 offset:0
  ds_read_b128 a[164:167], v11 offset:0
  v_mfma_f32_16x16x32_bf16 v[240:243], a[176:179], a[128:131], v[240:243]
  s_add_u32 m0, s29, 49152
  s_add_u32 s3, s23, s31
  buffer_load_dwordx4 v2, s[8:11], s3 offen offset:0 lds
  v_mfma_f32_16x16x32_bf16 v[240:243], a[180:183], a[132:135], v[240:243]
  v_mfma_f32_16x16x32_bf16 v[244:247], a[180:183], a[140:143], v[244:247]
  v_mfma_f32_16x16x32_bf16 v[244:247], a[176:179], a[136:139], v[244:247]
  v_mfma_f32_16x16x32_bf16 v[248:251], a[176:179], a[144:147], v[248:251]
  v_mfma_f32_16x16x32_bf16 v[248:251], a[180:183], a[148:151], v[248:251]
  buffer_load_dwordx4 v3, s[8:11], s3 offen offset:1024 lds
  v_mfma_f32_16x16x32_bf16 v[252:255], a[180:183], a[156:159], v[252:255]
  v_mfma_f32_16x16x32_bf16 v[252:255], a[176:179], a[152:155], v[252:255]
  v_mfma_f32_16x16x32_bf16 a[0:3], a[184:187], a[96:99], a[0:3]
  v_mfma_f32_16x16x32_bf16 a[0:3], a[188:191], a[100:103], a[0:3]
  ds_read_b128 a[168:171], v10 offset:2048
  ds_read_b128 a[172:175], v11 offset:2048
  v_mfma_f32_16x16x32_bf16 a[4:7], a[188:191], a[108:111], a[4:7]
  v_mfma_f32_16x16x32_bf16 a[4:7], a[184:187], a[104:107], a[4:7]
  v_mfma_f32_16x16x32_bf16 a[8:11], a[184:187], a[112:115], a[8:11]
  buffer_load_dwordx4 v4, s[8:11], s3 offen offset:2048 lds
  v_mfma_f32_16x16x32_bf16 a[8:11], a[188:191], a[116:119], a[8:11]
  v_mfma_f32_16x16x32_bf16 a[12:15], a[188:191], a[124:127], a[12:15]
  v_mfma_f32_16x16x32_bf16 a[12:15], a[184:187], a[120:123], a[12:15]
  v_mfma_f32_16x16x32_bf16 a[16:19], a[184:187], a[128:131], a[16:19]
  v_mfma_f32_16x16x32_bf16 a[16:19], a[188:191], a[132:135], a[16:19]
  buffer_load_dwordx4 v5, s[8:11], s3 offen offset:3072 lds
  v_mfma_f32_16x16x32_bf16 a[20:23], a[188:191], a[140:143], a[20:23]
  v_mfma_f32_16x16x32_bf16 a[20:23], a[184:187], a[136:139], a[20:23]
  v_mfma_f32_16x16x32_bf16 a[24:27], a[184:187], a[144:147], a[24:27]
  v_mfma_f32_16x16x32_bf16 a[24:27], a[188:191], a[148:151], a[24:27]
  v_mfma_f32_16x16x32_bf16 a[28:31], a[188:191], a[156:159], a[28:31]
  v_mfma_f32_16x16x32_bf16 a[28:31], a[184:187], a[152:155], a[28:31]
  s_waitcnt lgkmcnt(2)
  v_mfma_f32_16x16x32_bf16 v[32:35], a[160:163], a[32:35], v[32:35]
  s_add_u32 s23, s23, 128
  s_cmp_eq_u32 s23, s25
  s_cselect_b32 s23, s26, s23
  v_mfma_f32_16x16x32_bf16 v[32:35], a[164:167], a[36:39], v[32:35]
  ds_read_b128 a[176:179], v10 offset:4096
  ds_read_b128 a[180:183], v11 offset:4096
  v_mfma_f32_16x16x32_bf16 v[36:39], a[164:167], a[44:47], v[36:39]
  v_mfma_f32_16x16x32_bf16 v[36:39], a[160:163], a[40:43], v[36:39]
  ds_read_b64_tr_b16 a[96:97], v12 offset:32768
  ds_read_b64_tr_b16 a[98:99], v12 offset:34816
  v_mfma_f32_16x16x32_bf16 v[40:43], a[160:163], a[48:51], v[40:43]
  v_mfma_f32_16x16x32_bf16 v[40:43], a[164:167], a[52:55], v[40:43]
  v_mfma_f32_16x16x32_bf16 v[44:47], a[164:167], a[60:63], v[44:47]
  s_add_u32 m0, s29, 81920
  s_nop 0
  buffer_load_dwordx4 v6, s[12:15], s24 offen offset:0 lds
  v_mfma_f32_16x16x32_bf16 v[44:47], a[160:163], a[56:59], v[44:47]
  ds_read_b64_tr_b16 a[104:105], v13 offset:32768
  ds_read_b64_tr_b16 a[106:107], v13 offset:34816
  v_mfma_f32_16x16x32_bf16 v[48:51], a[160:163], a[64:67], v[48:51]
  v_mfma_f32_16x16x32_bf16 v[48:51], a[164:167], a[68:71], v[48:51]
  v_mfma_f32_16x16x32_bf16 v[52:55], a[164:167], a[76:79], v[52:55]
  v_mfma_f32_16x16x32_bf16 v[52:55], a[160:163], a[72:75], v[52:55]
  ds_read_b64_tr_b16 a[112:113], v14 offset:32768
  ds_read_b64_tr_b16 a[114:115], v14 offset:34816
  v_mfma_f32_16x16x32_bf16 v[56:59], a[160:163], a[80:83], v[56:59]
  v_mfma_f32_16x16x32_bf16 v[56:59], a[164:167], a[84:87], v[56:59]
  buffer_load_dwordx4 v7, s[12:15], s24 offen offset:1024 lds
  v_mfma_f32_16x16x32_bf16 v[60:63], a[164:167], a[92:95], v[60:63]
  v_mfma_f32_16x16x32_bf16 v[60:63], a[160:163], a[88:91], v[60:63]
  s_waitcnt lgkmcnt(8)
  ds_read_b64_tr_b16 a[120:121], v15 offset:32768
  ds_read_b64_tr_b16 a[122:123], v15 offset:34816
  v_mfma_f32_16x16x32_bf16 v[64:67], a[168:171], a[32:35], v[64:67]
  v_mfma_f32_16x16x32_bf16 v[64:67], a[172:175], a[36:39], v[64:67]
  ds_read_b128 a[184:187], v10 offset:6144
  ds_read_b128 a[188:191], v11 offset:6144
  v_mfma_f32_16x16x32_bf16 v[68:71], a[172:175], a[44:47], v[68:71]
  v_mfma_f32_16x16x32_bf16 v[68:71], a[168:171], a[40:43], v[68:71]
  ds_read_b64_tr_b16 a[128:129], v16 offset:32768
  ds_read_b64_tr_b16 a[130:131], v16 offset:34816
  v_mfma_f32_16x16x32_bf16 v[72:75], a[168:171], a[48:51], v[72:75]
  buffer_load_dwordx4 v8, s[12:15], s24 offen offset:2048 lds
  v_mfma_f32_16x16x32_bf16 v[72:75], a[172:175], a[52:55], v[72:75]
  v_mfma_f32_16x16x32_bf16 v[76:79], a[172:175], a[60:63], v[76:79]
  v_mfma_f32_16x16x32_bf16 v[76:79], a[168:171], a[56:59], v[76:79]
  ds_read_b64_tr_b16 a[136:137], v17 offset:32768
  ds_read_b64_tr_b16 a[138:139], v17 offset:34816
  v_mfma_f32_16x16x32_bf16 v[80:83], a[168:171], a[64:67], v[80:83]
  v_mfma_f32_16x16x32_bf16 v[80:83], a[172:175], a[68:71], v[80:83]
  v_mfma_f32_16x16x32_bf16 v[84:87], a[172:175], a[76:79], v[84:87]
  buffer_load_dwordx4 v9, s[12:15], s24 offen offset:3072 lds
  v_mfma_f32_16x16x32_bf16 v[84:87], a[168:171], a[72:75], v[84:87]
  ds_read_b64_tr_b16 a[144:145], v18 offset:32768
  ds_read_b64_tr_b16 a[146:147], v18 offset:34816
  v_mfma_f32_16x16x32_bf16 v[88:91], a[168:171], a[80:83], v[88:91]
  v_mfma_f32_16x16x32_bf16 v[88:91], a[172:175], a[84:87], v[88:91]
  v_mfma_f32_16x16x32_bf16 v[92:95], a[172:175], a[92:95], v[92:95]
  v_mfma_f32_16x16x32_bf16 v[92:95], a[168:171], a[88:91], v[92:95]
  s_waitcnt lgkmcnt(15)
  ds_read_b64_tr_b16 a[152:153], v19 offset:32768
  ds_read_b64_tr_b16 a[154:155], v19 offset:34816
  v_mfma_f32_16x16x32_bf16 v[96:99], a[176:179], a[32:35], v[96:99]
  s_add_u32 s24, s24, 262144
  s_cmp_eq_u32 s24, s27
  s_cselect_b32 s24, s28, s24
  s_cselect_b64 s[12:13], s[64:65], s[12:13]
  v_mfma_f32_16x16x32_bf16 v[96:99], a[180:183], a[36:39], v[96:99]
  v_mfma_f32_16x16x32_bf16 v[100:103], a[180:183], a[44:47], v[100:103]
  v_mfma_f32_16x16x32_bf16 v[100:103], a[176:179], a[40:43], v[100:103]
  v_mfma_f32_16x16x32_bf16 v[104:107], a[176:179], a[48:51], v[104:107]
  v_mfma_f32_16x16x32_bf16 v[104:107], a[180:183], a[52:55], v[104:107]
  v_mfma_f32_16x16x32_bf16 v[108:111], a[180:183], a[60:63], v[108:111]
  v_mfma_f32_16x16x32_bf16 v[108:111], a[176:179], a[56:59], v[108:111]
  s_waitcnt vmcnt(17) lgkmcnt(0)
  s_barrier
  ds_read_b128 a[160:163], v10 offset:16384
  ds_read_b128 a[164:167], v11 offset:16384
  v_mfma_f32_16x16x32_bf16 v[112:115], a[176:179], a[64:67], v[112:115]
  s_add_u32 m0, s29, 0
  s_nop 0
  buffer_load_dwordx4 v2, s[8:11], s23 offen offset:0 lds
  v_mfma_f32_16x16x32_bf16 v[112:115], a[180:183], a[68:71], v[112:115]
  v_mfma_f32_16x16x32_bf16 v[116:119], a[180:183], a[76:79], v[116:119]
  v_mfma_f32_16x16x32_bf16 v[116:119], a[176:179], a[72:75], v[116:119]
  ds_read_b64_tr_b16 a[100:101], v12 offset:49152
  ds_read_b64_tr_b16 a[102:103], v12 offset:51200
  v_mfma_f32_16x16x32_bf16 v[120:123], a[176:179], a[80:83], v[120:123]
  v_mfma_f32_16x16x32_bf16 v[120:123], a[180:183], a[84:87], v[120:123]
  v_mfma_f32_16x16x32_bf16 v[124:127], a[180:183], a[92:95], v[124:127]
  buffer_load_dwordx4 v3, s[8:11], s23 offen offset:1024 lds
  v_mfma_f32_16x16x32_bf16 v[124:127], a[176:179], a[88:91], v[124:127]
  v_mfma_f32_16x16x32_bf16 v[128:131], a[184:187], a[32:35], v[128:131]
  v_mfma_f32_16x16x32_bf16 v[128:131], a[188:191], a[36:39], v[128:131]
  ds_read_b128 a[168:171], v10 offset:18432
  ds_read_b128 a[172:175], v11 offset:18432
  ds_read_b64_tr_b16 a[108:109], v13 offset:49152
  ds_read_b64_tr_b16 a[110:111], v13 offset:51200
  v_mfma_f32_16x16x32_bf16 v[132:135], a[188:191], a[44:47], v[132:135]
  v_mfma_f32_16x16x32_bf16 v[132:135], a[184:187], a[40:43], v[132:135]
  v_mfma_f32_16x16x32_bf16 v[136:139], a[184:187], a[48:51], v[136:139]
  v_mfma_f32_16x16x32_bf16 v[136:139], a[188:191], a[52:55], v[136:139]
  buffer_load_dwordx4 v4, s[8:11], s23 offen offset:2048 lds
  v_mfma_f32_16x16x32_bf16 v[140:143], a[188:191], a[60:63], v[140:143]
  v_mfma_f32_16x16x32_bf16 v[140:143], a[184:187], a[56:59], v[140:143]
  ds_read_b64_tr_b16 a[116:117], v14 offset:49152
  ds_read_b64_tr_b16 a[118:119], v14 offset:51200
  v_mfma_f32_16x16x32_bf16 v[144:147], a[184:187], a[64:67], v[144:147]
  v_mfma_f32_16x16x32_bf16 v[144:147], a[188:191], a[68:71], v[144:147]
  v_mfma_f32_16x16x32_bf16 v[148:151], a[188:191], a[76:79], v[148:151]
  v_mfma_f32_16x16x32_bf16 v[148:151], a[184:187], a[72:75], v[148:151]
  v_mfma_f32_16x16x32_bf16 v[152:155], a[184:187], a[80:83], v[152:155]
  buffer_load_dwordx4 v5, s[8:11], s23 offen offset:3072 lds
  v_mfma_f32_16x16x32_bf16 v[152:155], a[188:191], a[84:87], v[152:155]
  ds_read_b64_tr_b16 a[124:125], v15 offset:49152
  ds_read_b64_tr_b16 a[126:127], v15 offset:51200
  v_mfma_f32_16x16x32_bf16 v[156:159], a[188:191], a[92:95], v[156:159]
  v_mfma_f32_16x16x32_bf16 v[156:159], a[184:187], a[88:91], v[156:159]
  s_waitcnt lgkmcnt(10)
  v_mfma_f32_16x16x32_bf16 v[160:163], a[160:163], a[32:35], v[160:163]
  v_mfma_f32_16x16x32_bf16 v[160:163], a[164:167], a[36:39], v[160:163]
  ds_read_b128 a[176:179], v10 offset:20480
  ds_read_b128 a[180:183], v11 offset:20480
  v_mfma_f32_16x16x32_bf16 v[164:167], a[164:167], a[44:47], v[164:167]
  v_mfma_f32_16x16x32_bf16 v[164:167], a[160:163], a[40:43], v[164:167]
  ds_read_b64_tr_b16 a[132:133], v16 offset:49152
  ds_read_b64_tr_b16 a[134:135], v16 offset:51200
  v_mfma_f32_16x16x32_bf16 v[168:171], a[160:163], a[48:51], v[168:171]
  v_mfma_f32_16x16x32_bf16 v[168:171], a[164:167], a[52:55], v[168:171]
  s_add_u32 m0, s29, 98304
  s_nop 0
  buffer_load_dwordx4 v6, s[12:15], s24 offen offset:0 lds
  v_mfma_f32_16x16x32_bf16 v[172:175], a[164:167], a[60:63], v[172:175]
  v_mfma_f32_16x16x32_bf16 v[172:175], a[160:163], a[56:59], v[172:175]
  v_mfma_f32_16x16x32_bf16 v[176:179], a[160:163], a[64:67], v[176:179]
  v_mfma_f32_16x16x32_bf16 v[176:179], a[164:167], a[68:71], v[176:179]
  ds_read_b64_tr_b16 a[140:141], v17 offset:49152
  ds_read_b64_tr_b16 a[142:143], v17 offset:51200
  v_mfma_f32_16x16x32_bf16 v[180:183], a[164:167], a[76:79], v[180:183]
  v_mfma_f32_16x16x32_bf16 v[180:183], a[160:163], a[72:75], v[180:183]
  buffer_load_dwordx4 v7, s[12:15], s24 offen offset:1024 lds
  v_mfma_f32_16x16x32_bf16 v[184:187], a[160:163], a[80:83], v[184:187]
  v_mfma_f32_16x16x32_bf16 v[184:187], a[164:167], a[84:87], v[184:187]
  v_mfma_f32_16x16x32_bf16 v[188:191], a[164:167], a[92:95], v[188:191]
  v_mfma_f32_16x16x32_bf16 v[188:191], a[160:163], a[88:91], v[188:191]
  s_waitcnt lgkmcnt(12)
  ds_read_b64_tr_b16 a[148:149], v18 offset:49152
  ds_read_b64_tr_b16 a[150:151], v18 offset:51200
  v_mfma_f32_16x16x32_bf16 v[192:195], a[168:171], a[32:35], v[192:195]
  v_mfma_f32_16x16x32_bf16 v[192:195], a[172:175], a[36:39], v[192:195]
  ds_read_b128 a[184:187], v10 offset:22528
  ds_read_b128 a[188:191], v11 offset:22528
  v_mfma_f32_16x16x32_bf16 v[196:199], a[172:175], a[44:47], v[196:199]
  v_mfma_f32_16x16x32_bf16 v[196:199], a[168:171], a[40:43], v[196:199]
  buffer_load_dwordx4 v8, s[12:15], s24 offen offset:2048 lds
  v_mfma_f32_16x16x32_bf16 v[200:203], a[168:171], a[48:51], v[200:203]
  v_mfma_f32_16x16x32_bf16 v[200:203], a[172:175], a[52:55], v[200:203]
  ds_read_b64_tr_b16 a[156:157], v19 offset:49152
  ds_read_b64_tr_b16 a[158:159], v19 offset:51200
  v_mfma_f32_16x16x32_bf16 v[204:207], a[172:175], a[60:63], v[204:207]
  v_mfma_f32_16x16x32_bf16 v[204:207], a[168:171], a[56:59], v[204:207]
  v_mfma_f32_16x16x32_bf16 v[208:211], a[168:171], a[64:67], v[208:211]
  v_mfma_f32_16x16x32_bf16 v[208:211], a[172:175], a[68:71], v[208:211]
  buffer_load_dwordx4 v9, s[12:15], s24 offen offset:3072 lds
  v_mfma_f32_16x16x32_bf16 v[212:215], a[172:175], a[76:79], v[212:215]
  v_mfma_f32_16x16x32_bf16 v[212:215], a[168:171], a[72:75], v[212:215]
  v_mfma_f32_16x16x32_bf16 v[216:219], a[168:171], a[80:83], v[216:219]
  v_mfma_f32_16x16x32_bf16 v[216:219], a[172:175], a[84:87], v[216:219]
  v_mfma_f32_16x16x32_bf16 v[220:223], a[172:175], a[92:95], v[220:223]
  s_add_u32 s24, s24, 262144
  v_mfma_f32_16x16x32_bf16 v[220:223], a[168:171], a[88:91], v[220:223]
  s_waitcnt lgkmcnt(10)
  v_mfma_f32_16x16x32_bf16 v[224:227], a[176:179], a[32:35], v[224:227]
  v_mfma_f32_16x16x32_bf16 v[224:227], a[180:183], a[36:39], v[224:227]
  v_mfma_f32_16x16x32_bf16 v[228:231], a[180:183], a[44:47], v[228:231]
  v_mfma_f32_16x16x32_bf16 v[228:231], a[176:179], a[40:43], v[228:231]
  v_mfma_f32_16x16x32_bf16 v[232:235], a[176:179], a[48:51], v[232:235]
  v_mfma_f32_16x16x32_bf16 v[232:235], a[180:183], a[52:55], v[232:235]
  v_mfma_f32_16x16x32_bf16 v[236:239], a[180:183], a[60:63], v[236:239]
  v_mfma_f32_16x16x32_bf16 v[236:239], a[176:179], a[56:59], v[236:239]
  s_waitcnt vmcnt(17) lgkmcnt(0)
  s_barrier
  ds_read_b128 a[160:163], v10 offset:32768
  ds_read_b128 a[164:167], v11 offset:32768
  v_mfma_f32_16x16x32_bf16 v[240:243], a[176:179], a[64:67], v[240:243]
  s_add_u32 m0, s29, 16384
  s_add_u32 s3, s23, s31
  buffer_load_dwordx4 v2, s[8:11], s3 offen offset:0 lds
  v_mfma_f32_16x16x32_bf16 v[240:243], a[180:183], a[68:71], v[240:243]
  v_mfma_f32_16x16x32_bf16 v[244:247], a[180:183], a[76:79], v[244:247]
  v_mfma_f32_16x16x32_bf16 v[244:247], a[176:179], a[72:75], v[244:247]
  v_mfma_f32_16x16x32_bf16 v[248:251], a[176:179], a[80:83], v[248:251]
  v_mfma_f32_16x16x32_bf16 v[248:251], a[180:183], a[84:87], v[248:251]
  buffer_load_dwordx4 v3, s[8:11], s3 offen offset:1024 lds
  v_mfma_f32_16x16x32_bf16 v[252:255], a[180:183], a[92:95], v[252:255]
  v_mfma_f32_16x16x32_bf16 v[252:255], a[176:179], a[88:91], v[252:255]
  v_mfma_f32_16x16x32_bf16 a[0:3], a[184:187], a[32:35], a[0:3]
  v_mfma_f32_16x16x32_bf16 a[0:3], a[188:191], a[36:39], a[0:3]
  ds_read_b128 a[168:171], v10 offset:34816
  ds_read_b128 a[172:175], v11 offset:34816
  v_mfma_f32_16x16x32_bf16 a[4:7], a[188:191], a[44:47], a[4:7]
  v_mfma_f32_16x16x32_bf16 a[4:7], a[184:187], a[40:43], a[4:7]
  v_mfma_f32_16x16x32_bf16 a[8:11], a[184:187], a[48:51], a[8:11]
  buffer_load_dwordx4 v4, s[8:11], s3 offen offset:2048 lds
  v_mfma_f32_16x16x32_bf16 a[8:11], a[188:191], a[52:55], a[8:11]
  v_mfma_f32_16x16x32_bf16 a[12:15], a[188:191], a[60:63], a[12:15]
  v_mfma_f32_16x16x32_bf16 a[12:15], a[184:187], a[56:59], a[12:15]
  v_mfma_f32_16x16x32_bf16 a[16:19], a[184:187], a[64:67], a[16:19]
  v_mfma_f32_16x16x32_bf16 a[16:19], a[188:191], a[68:71], a[16:19]
  buffer_load_dwordx4 v5, s[8:11], s3 offen offset:3072 lds
  v_mfma_f32_16x16x32_bf16 a[20:23], a[188:191], a[76:79], a[20:23]
  v_mfma_f32_16x16x32_bf16 a[20:23], a[184:187], a[72:75], a[20:23]
  v_mfma_f32_16x16x32_bf16 a[24:27], a[184:187], a[80:83], a[24:27]
  v_mfma_f32_16x16x32_bf16 a[24:27], a[188:191], a[84:87], a[24:27]
  v_mfma_f32_16x16x32_bf16 a[28:31], a[188:191], a[92:95], a[28:31]
  v_mfma_f32_16x16x32_bf16 a[28:31], a[184:187], a[88:91], a[28:31]
  s_waitcnt lgkmcnt(2)
  v_mfma_f32_16x16x32_bf16 v[32:35], a[160:163], a[96:99], v[32:35]
  s_add_u32 s23, s23, 128
  s_cmp_eq_u32 s23, s25
  s_cselect_b32 s23, s26, s23
  v_mfma_f32_16x16x32_bf16 v[32:35], a[164:167], a[100:103], v[32:35]
  ds_read_b128 a[176:179], v10 offset:36864
  ds_read_b128 a[180:183], v11 offset:36864
  v_mfma_f32_16x16x32_bf16 v[36:39], a[164:167], a[108:111], v[36:39]
  v_mfma_f32_16x16x32_bf16 v[36:39], a[160:163], a[104:107], v[36:39]
  ds_read_b64_tr_b16 a[32:33], v12 offset:0
  ds_read_b64_tr_b16 a[34:35], v12 offset:2048
  v_mfma_f32_16x16x32_bf16 v[40:43], a[160:163], a[112:115], v[40:43]
  v_mfma_f32_16x16x32_bf16 v[40:43], a[164:167], a[116:119], v[40:43]
  v_mfma_f32_16x16x32_bf16 v[44:47], a[164:167], a[124:127], v[44:47]
  s_add_u32 m0, s29, 114688
  s_nop 0
  buffer_load_dwordx4 v6, s[12:15], s24 offen offset:0 lds
  v_mfma_f32_16x16x32_bf16 v[44:47], a[160:163], a[120:123], v[44:47]
  ds_read_b64_tr_b16 a[40:41], v13 offset:0
  ds_read_b64_tr_b16 a[42:43], v13 offset:2048
  v_mfma_f32_16x16x32_bf16 v[48:51], a[160:163], a[128:131], v[48:51]
  v_mfma_f32_16x16x32_bf16 v[48:51], a[164:167], a[132:135], v[48:51]
  v_mfma_f32_16x16x32_bf16 v[52:55], a[164:167], a[140:143], v[52:55]
  v_mfma_f32_16x16x32_bf16 v[52:55], a[160:163], a[136:139], v[52:55]
  ds_read_b64_tr_b16 a[48:49], v14 offset:0
  ds_read_b64_tr_b16 a[50:51], v14 offset:2048
  v_mfma_f32_16x16x32_bf16 v[56:59], a[160:163], a[144:147], v[56:59]
  v_mfma_f32_16x16x32_bf16 v[56:59], a[164:167], a[148:151], v[56:59]
  buffer_load_dwordx4 v7, s[12:15], s24 offen offset:1024 lds
  v_mfma_f32_16x16x32_bf16 v[60:63], a[164:167], a[156:159], v[60:63]
  v_mfma_f32_16x16x32_bf16 v[60:63], a[160:163], a[152:155], v[60:63]
  s_waitcnt lgkmcnt(8)
  ds_read_b64_tr_b16 a[56:57], v15 offset:0
  ds_read_b64_tr_b16 a[58:59], v15 offset:2048
  v_mfma_f32_16x16x32_bf16 v[64:67], a[168:171], a[96:99], v[64:67]
  v_mfma_f32_16x16x32_bf16 v[64:67], a[172:175], a[100:103], v[64:67]
  ds_read_b128 a[184:187], v10 offset:38912
  ds_read_b128 a[188:191], v11 offset:38912
  v_mfma_f32_16x16x32_bf16 v[68:71], a[172:175], a[108:111], v[68:71]
  v_mfma_f32_16x16x32_bf16 v[68:71], a[168:171], a[104:107], v[68:71]
  ds_read_b64_tr_b16 a[64:65], v16 offset:0
  ds_read_b64_tr_b16 a[66:67], v16 offset:2048
  v_mfma_f32_16x16x32_bf16 v[72:75], a[168:171], a[112:115], v[72:75]
  buffer_load_dwordx4 v8, s[12:15], s24 offen offset:2048 lds
  v_mfma_f32_16x16x32_bf16 v[72:75], a[172:175], a[116:119], v[72:75]
  v_mfma_f32_16x16x32_bf16 v[76:79], a[172:175], a[124:127], v[76:79]
  v_mfma_f32_16x16x32_bf16 v[76:79], a[168:171], a[120:123], v[76:79]
  ds_read_b64_tr_b16 a[72:73], v17 offset:0
  ds_read_b64_tr_b16 a[74:75], v17 offset:2048
  v_mfma_f32_16x16x32_bf16 v[80:83], a[168:171], a[128:131], v[80:83]
  v_mfma_f32_16x16x32_bf16 v[80:83], a[172:175], a[132:135], v[80:83]
  v_mfma_f32_16x16x32_bf16 v[84:87], a[172:175], a[140:143], v[84:87]
  buffer_load_dwordx4 v9, s[12:15], s24 offen offset:3072 lds
  v_mfma_f32_16x16x32_bf16 v[84:87], a[168:171], a[136:139], v[84:87]
  ds_read_b64_tr_b16 a[80:81], v18 offset:0
  ds_read_b64_tr_b16 a[82:83], v18 offset:2048
  v_mfma_f32_16x16x32_bf16 v[88:91], a[168:171], a[144:147], v[88:91]
  v_mfma_f32_16x16x32_bf16 v[88:91], a[172:175], a[148:151], v[88:91]
  v_mfma_f32_16x16x32_bf16 v[92:95], a[172:175], a[156:159], v[92:95]
  v_mfma_f32_16x16x32_bf16 v[92:95], a[168:171], a[152:155], v[92:95]
  s_waitcnt lgkmcnt(15)
  ds_read_b64_tr_b16 a[88:89], v19 offset:0
  ds_read_b64_tr_b16 a[90:91], v19 offset:2048
  v_mfma_f32_16x16x32_bf16 v[96:99], a[176:179], a[96:99], v[96:99]
  s_add_u32 s24, s24, 262144
  s_cmp_eq_u32 s24, s27
  s_cselect_b32 s24, s28, s24
  s_cselect_b64 s[12:13], s[64:65], s[12:13]
  v_mfma_f32_16x16x32_bf16 v[96:99], a[180:183], a[100:103], v[96:99]
  v_mfma_f32_16x16x32_bf16 v[100:103], a[180:183], a[108:111], v[100:103]
  v_mfma_f32_16x16x32_bf16 v[100:103], a[176:179], a[104:107], v[100:103]
  v_mfma_f32_16x16x32_bf16 v[104:107], a[176:179], a[112:115], v[104:107]
  v_mfma_f32_16x16x32_bf16 v[104:107], a[180:183], a[116:119], v[104:107]
  v_mfma_f32_16x16x32_bf16 v[108:111], a[180:183], a[124:127], v[108:111]
  v_mfma_f32_16x16x32_bf16 v[108:111], a[176:179], a[120:123], v[108:111]
  s_waitcnt vmcnt(16) lgkmcnt(0)
  s_barrier
  ds_read_b128 a[160:163], v10 offset:49152
  ds_read_b128 a[164:167], v11 offset:49152
  v_mfma_f32_16x16x32_bf16 v[112:115], a[176:179], a[128:131], v[112:115]
  s_add_u32 m0, s29, 32768
  s_nop 0
  buffer_load_dwordx4 v2, s[8:11], s23 offen offset:0 lds
  v_mfma_f32_16x16x32_bf16 v[112:115], a[180:183], a[132:135], v[112:115]
  v_mfma_f32_16x16x32_bf16 v[116:119], a[180:183], a[140:143], v[116:119]
  v_mfma_f32_16x16x32_bf16 v[116:119], a[176:179], a[136:139], v[116:119]
  ds_read_b64_tr_b16 a[36:37], v12 offset:16384
  ds_read_b64_tr_b16 a[38:39], v12 offset:18432
  v_mfma_f32_16x16x32_bf16 v[120:123], a[176:179], a[144:147], v[120:123]
  v_mfma_f32_16x16x32_bf16 v[120:123], a[180:183], a[148:151], v[120:123]
  v_mfma_f32_16x16x32_bf16 v[124:127], a[180:183], a[156:159], v[124:127]
  v_mfma_f32_16x16x32_bf16 v[124:127], a[176:179], a[152:155], v[124:127]
  v_mfma_f32_16x16x32_bf16 v[128:131], a[184:187], a[96:99], v[128:131]
  v_mfma_f32_16x16x32_bf16 v[128:131], a[188:191], a[100:103], v[128:131]
  ds_read_b128 a[168:171], v10 offset:51200
  ds_read_b128 a[172:175], v11 offset:51200
  ds_read_b64_tr_b16 a[44:45], v13 offset:16384
  ds_read_b64_tr_b16 a[46:47], v13 offset:18432
  v_mfma_f32_16x16x32_bf16 v[132:135], a[188:191], a[108:111], v[132:135]
  v_mfma_f32_16x16x32_bf16 v[132:135], a[184:187], a[104:107], v[132:135]
  v_mfma_f32_16x16x32_bf16 v[136:139], a[184:187], a[112:115], v[136:139]
  v_mfma_f32_16x16x32_bf16 v[136:139], a[188:191], a[116:119], v[136:139]
  v_mfma_f32_16x16x32_bf16 v[140:143], a[188:191], a[124:127], v[140:143]
  v_mfma_f32_16x16x32_bf16 v[140:143], a[184:187], a[120:123], v[140:143]
  ds_read_b64_tr_b16 a[52:53], v14 offset:16384
  ds_read_b64_tr_b16 a[54:55], v14 offset:18432
  v_mfma_f32_16x16x32_bf16 v[144:147], a[184:187], a[128:131], v[144:147]
  buffer_load_dwordx4 v3, s[8:11], s23 offen offset:1024 lds
  v_mfma_f32_16x16x32_bf16 v[144:147], a[188:191], a[132:135], v[144:147]
  v_mfma_f32_16x16x32_bf16 v[148:151], a[188:191], a[140:143], v[148:151]
  v_mfma_f32_16x16x32_bf16 v[148:151], a[184:187], a[136:139], v[148:151]
  v_mfma_f32_16x16x32_bf16 v[152:155], a[184:187], a[144:147], v[152:155]
  v_mfma_f32_16x16x32_bf16 v[152:155], a[188:191], a[148:151], v[152:155]
  ds_read_b64_tr_b16 a[60:61], v15 offset:16384
  ds_read_b64_tr_b16 a[62:63], v15 offset:18432
  v_mfma_f32_16x16x32_bf16 v[156:159], a[188:191], a[156:159], v[156:159]
  v_mfma_f32_16x16x32_bf16 v[156:159], a[184:187], a[152:155], v[156:159]
  s_waitcnt lgkmcnt(10)
  v_mfma_f32_16x16x32_bf16 v[160:163], a[160:163], a[96:99], v[160:163]
  v_mfma_f32_16x16x32_bf16 v[160:163], a[164:167], a[100:103], v[160:163]
  ds_read_b128 a[176:179], v10 offset:53248
  ds_read_b128 a[180:183], v11 offset:53248
  v_mfma_f32_16x16x32_bf16 v[164:167], a[164:167], a[108:111], v[164:167]
  v_mfma_f32_16x16x32_bf16 v[164:167], a[160:163], a[104:107], v[164:167]
  ds_read_b64_tr_b16 a[68:69], v16 offset:16384
  ds_read_b64_tr_b16 a[70:71], v16 offset:18432
  v_mfma_f32_16x16x32_bf16 v[168:171], a[160:163], a[112:115], v[168:171]
  v_mfma_f32_16x16x32_bf16 v[168:171], a[164:167], a[116:119], v[168:171]
  v_mfma_f32_16x16x32_bf16 v[172:175], a[164:167], a[124:127], v[172:175]
  v_mfma_f32_16x16x32_bf16 v[172:175], a[160:163], a[120:123], v[172:175]
  v_mfma_f32_16x16x32_bf16 v[176:179], a[160:163], a[128:131], v[176:179]
  buffer_load_dwordx4 v4, s[8:11], s23 offen offset:2048 lds
  v_mfma_f32_16x16x32_bf16 v[176:179], a[164:167], a[132:135], v[176:179]
  ds_read_b64_tr_b16 a[76:77], v17 offset:16384
  ds_read_b64_tr_b16 a[78:79], v17 offset:18432
  v_mfma_f32_16x16x32_bf16 v[180:183], a[164:167], a[140:143], v[180:183]
  v_mfma_f32_16x16x32_bf16 v[180:183], a[160:163], a[136:139], v[180:183]
  v_mfma_f32_16x16x32_bf16 v[184:187], a[160:163], a[144:147], v[184:187]
  v_mfma_f32_16x16x32_bf16 v[184:187], a[164:167], a[148:151], v[184:187]
  v_mfma_f32_16x16x32_bf16 v[188:191], a[164:167], a[156:159], v[188:191]
  v_mfma_f32_16x16x32_bf16 v[188:191], a[160:163], a[152:155], v[188:191]
  s_waitcnt lgkmcnt(12)
  ds_read_b64_tr_b16 a[84:85], v18 offset:16384
  ds_read_b64_tr_b16 a[86:87], v18 offset:18432
  v_mfma_f32_16x16x32_bf16 v[192:195], a[168:171], a[96:99], v[192:195]
  v_mfma_f32_16x16x32_bf16 v[192:195], a[172:175], a[100:103], v[192:195]
  ds_read_b128 a[184:187], v10 offset:55296
  ds_read_b128 a[188:191], v11 offset:55296
  v_mfma_f32_16x16x32_bf16 v[196:199], a[172:175], a[108:111], v[196:199]
  v_mfma_f32_16x16x32_bf16 v[196:199], a[168:171], a[104:107], v[196:199]
  v_mfma_f32_16x16x32_bf16 v[200:203], a[168:171], a[112:115], v[200:203]
  v_mfma_f32_16x16x32_bf16 v[200:203], a[172:175], a[116:119], v[200:203]
  ds_read_b64_tr_b16 a[92:93], v19 offset:16384
  ds_read_b64_tr_b16 a[94:95], v19 offset:18432
  v_mfma_f32_16x16x32_bf16 v[204:207], a[172:175], a[124:127], v[204:207]
  v_mfma_f32_16x16x32_bf16 v[204:207], a[168:171], a[120:123], v[204:207]
  v_mfma_f32_16x16x32_bf16 v[208:211], a[168:171], a[128:131], v[208:211]
  buffer_load_dwordx4 v5, s[8:11], s23 offen offset:3072 lds
  v_mfma_f32_16x16x32_bf16 v[208:211], a[172:175], a[132:135], v[208:211]
  v_mfma_f32_16x16x32_bf16 v[212:215], a[172:175], a[140:143], v[212:215]
  v_mfma_f32_16x16x32_bf16 v[212:215], a[168:171], a[136:139], v[212:215]
  v_mfma_f32_16x16x32_bf16 v[216:219], a[168:171], a[144:147], v[216:219]
  v_mfma_f32_16x16x32_bf16 v[216:219], a[172:175], a[148:151], v[216:219]
  v_mfma_f32_16x16x32_bf16 v[220:223], a[172:175], a[156:159], v[220:223]
  v_mfma_f32_16x16x32_bf16 v[220:223], a[168:171], a[152:155], v[220:223]
  s_waitcnt lgkmcnt(10)
  v_mfma_f32_16x16x32_bf16 v[224:227], a[176:179], a[96:99], v[224:227]
  v_mfma_f32_16x16x32_bf16 v[224:227], a[180:183], a[100:103], v[224:227]
  v_mfma_f32_16x16x32_bf16 v[228:231], a[180:183], a[108:111], v[228:231]
  v_mfma_f32_16x16x32_bf16 v[228:231], a[176:179], a[104:107], v[228:231]
  v_mfma_f32_16x16x32_bf16 v[232:235], a[176:179], a[112:115], v[232:235]
  v_mfma_f32_16x16x32_bf16 v[232:235], a[180:183], a[116:119], v[232:235]
  v_mfma_f32_16x16x32_bf16 v[236:239], a[180:183], a[124:127], v[236:239]
  v_mfma_f32_16x16x32_bf16 v[236:239], a[176:179], a[120:123], v[236:239]
  s_waitcnt vmcnt(12) lgkmcnt(0)
  s_barrier
  ds_read_b128 a[160:163], v10 offset:0
  ds_read_b128 a[164:167], v11 offset:0
  v_mfma_f32_16x16x32_bf16 v[240:243], a[176:179], a[128:131], v[240:243]
  s_add_u32 m0, s29, 49152
  s_add_u32 s3, s23, s31
  buffer_load_dwordx4 v2, s[8:11], s3 offen offset:0 lds
  v_mfma_f32_16x16x32_bf16 v[240:243], a[180:183], a[132:135], v[240:243]
  v_mfma_f32_16x16x32_bf16 v[244:247], a[180:183], a[140:143], v[244:247]
  v_mfma_f32_16x16x32_bf16 v[244:247], a[176:179], a[136:139], v[244:247]
  v_mfma_f32_16x16x32_bf16 v[248:251], a[176:179], a[144:147], v[248:251]
  v_mfma_f32_16x16x32_bf16 v[248:251], a[180:183], a[148:151], v[248:251]
  v_mfma_f32_16x16x32_bf16 v[252:255], a[180:183], a[156:159], v[252:255]
  v_mfma_f32_16x16x32_bf16 v[252:255], a[176:179], a[152:155], v[252:255]
  v_mfma_f32_16x16x32_bf16 a[0:3], a[184:187], a[96:99], a[0:3]
  v_mfma_f32_16x16x32_bf16 a[0:3], a[188:191], a[100:103], a[0:3]
  ds_read_b128 a[168:171], v10 offset:2048
  ds_read_b128 a[172:175], v11 offset:2048
  v_mfma_f32_16x16x32_bf16 a[4:7], a[188:191], a[108:111], a[4:7]
  v_mfma_f32_16x16x32_bf16 a[4:7], a[184:187], a[104:107], a[4:7]
  v_mfma_f32_16x16x32_bf16 a[8:11], a[184:187], a[112:115], a[8:11]
  buffer_load_dwordx4 v3, s[8:11], s3 offen offset:1024 lds
  v_mfma_f32_16x16x32_bf16 a[8:11], a[188:191], a[116:119], a[8:11]
  v_mfma_f32_16x16x32_bf16 a[12:15], a[188:191], a[124:127], a[12:15]
  v_mfma_f32_16x16x32_bf16 a[12:15], a[184:187], a[120:123], a[12:15]
  v_mfma_f32_16x16x32_bf16 a[16:19], a[184:187], a[128:131], a[16:19]
  v_mfma_f32_16x16x32_bf16 a[16:19], a[188:191], a[132:135], a[16:19]
  v_mfma_f32_16x16x32_bf16 a[20:23], a[188:191], a[140:143], a[20:23]
  v_mfma_f32_16x16x32_bf16 a[20:23], a[184:187], a[136:139], a[20:23]
  v_mfma_f32_16x16x32_bf16 a[24:27], a[184:187], a[144:147], a[24:27]
  v_mfma_f32_16x16x32_bf16 a[24:27], a[188:191], a[148:151], a[24:27]
  v_mfma_f32_16x16x32_bf16 a[28:31], a[188:191], a[156:159], a[28:31]
  v_mfma_f32_16x16x32_bf16 a[28:31], a[184:187], a[152:155], a[28:31]
  s_waitcnt lgkmcnt(2)
  v_mfma_f32_16x16x32_bf16 v[32:35], a[160:163], a[32:35], v[32:35]
  buffer_load_dwordx4 v4, s[8:11], s3 offen offset:2048 lds
  v_mfma_f32_16x16x32_bf16 v[32:35], a[164:167], a[36:39], v[32:35]
  ds_read_b128 a[176:179], v10 offset:4096
  ds_read_b128 a[180:183], v11 offset:4096
  v_mfma_f32_16x16x32_bf16 v[36:39], a[164:167], a[44:47], v[36:39]
  v_mfma_f32_16x16x32_bf16 v[36:39], a[160:163], a[40:43], v[36:39]
  ds_read_b64_tr_b16 a[96:97], v12 offset:32768
  ds_read_b64_tr_b16 a[98:99], v12 offset:34816
  v_mfma_f32_16x16x32_bf16 v[40:43], a[160:163], a[48:51], v[40:43]
  v_mfma_f32_16x16x32_bf16 v[40:43], a[164:167], a[52:55], v[40:43]
  v_mfma_f32_16x16x32_bf16 v[44:47], a[164:167], a[60:63], v[44:47]
  v_mfma_f32_16x16x32_bf16 v[44:47], a[160:163], a[56:59], v[44:47]
  ds_read_b64_tr_b16 a[104:105], v13 offset:32768
  ds_read_b64_tr_b16 a[106:107], v13 offset:34816
  v_mfma_f32_16x16x32_bf16 v[48:51], a[160:163], a[64:67], v[48:51]
  v_mfma_f32_16x16x32_bf16 v[48:51], a[164:167], a[68:71], v[48:51]
  v_mfma_f32_16x16x32_bf16 v[52:55], a[164:167], a[76:79], v[52:55]
  v_mfma_f32_16x16x32_bf16 v[52:55], a[160:163], a[72:75], v[52:55]
  ds_read_b64_tr_b16 a[112:113], v14 offset:32768
  ds_read_b64_tr_b16 a[114:115], v14 offset:34816
  v_mfma_f32_16x16x32_bf16 v[56:59], a[160:163], a[80:83], v[56:59]
  v_mfma_f32_16x16x32_bf16 v[56:59], a[164:167], a[84:87], v[56:59]
  buffer_load_dwordx4 v5, s[8:11], s3 offen offset:3072 lds
  v_mfma_f32_16x16x32_bf16 v[60:63], a[164:167], a[92:95], v[60:63]
  v_mfma_f32_16x16x32_bf16 v[60:63], a[160:163], a[88:91], v[60:63]
  s_waitcnt lgkmcnt(8)
  ds_read_b64_tr_b16 a[120:121], v15 offset:32768
  ds_read_b64_tr_b16 a[122:123], v15 offset:34816
  v_mfma_f32_16x16x32_bf16 v[64:67], a[168:171], a[32:35], v[64:67]
  v_mfma_f32_16x16x32_bf16 v[64:67], a[172:175], a[36:39], v[64:67]
  ds_read_b128 a[184:187], v10 offset:6144
  ds_read_b128 a[188:191], v11 offset:6144
  v_mfma_f32_16x16x32_bf16 v[68:71], a[172:175], a[44:47], v[68:71]
  v_mfma_f32_16x16x32_bf16 v[68:71], a[168:171], a[40:43], v[68:71]
  ds_read_b64_tr_b16 a[128:129], v16 offset:32768
  ds_read_b64_tr_b16 a[130:131], v16 offset:34816
  v_mfma_f32_16x16x32_bf16 v[72:75], a[168:171], a[48:51], v[72:75]
  v_mfma_f32_16x16x32_bf16 v[72:75], a[172:175], a[52:55], v[72:75]
  v_mfma_f32_16x16x32_bf16 v[76:79], a[172:175], a[60:63], v[76:79]
  v_mfma_f32_16x16x32_bf16 v[76:79], a[168:171], a[56:59], v[76:79]
  ds_read_b64_tr_b16 a[136:137], v17 offset:32768
  ds_read_b64_tr_b16 a[138:139], v17 offset:34816
  v_mfma_f32_16x16x32_bf16 v[80:83], a[168:171], a[64:67], v[80:83]
  v_mfma_f32_16x16x32_bf16 v[80:83], a[172:175], a[68:71], v[80:83]
  v_mfma_f32_16x16x32_bf16 v[84:87], a[172:175], a[76:79], v[84:87]
  s_add_u32 s23, s23, 128
  s_cmp_eq_u32 s23, s25
  s_cselect_b32 s23, s26, s23
  v_mfma_f32_16x16x32_bf16 v[84:87], a[168:171], a[72:75], v[84:87]
  ds_read_b64_tr_b16 a[144:145], v18 offset:32768
  ds_read_b64_tr_b16 a[146:147], v18 offset:34816
  v_mfma_f32_16x16x32_bf16 v[88:91], a[168:171], a[80:83], v[88:91]
  v_mfma_f32_16x16x32_bf16 v[88:91], a[172:175], a[84:87], v[88:91]
  v_mfma_f32_16x16x32_bf16 v[92:95], a[172:175], a[92:95], v[92:95]
  v_mfma_f32_16x16x32_bf16 v[92:95], a[168:171], a[88:91], v[92:95]
  s_waitcnt lgkmcnt(15)
  ds_read_b64_tr_b16 a[152:153], v19 offset:32768
  ds_read_b64_tr_b16 a[154:155], v19 offset:34816
  v_mfma_f32_16x16x32_bf16 v[96:99], a[176:179], a[32:35], v[96:99]
  v_mfma_f32_16x16x32_bf16 v[96:99], a[180:183], a[36:39], v[96:99]
  v_mfma_f32_16x16x32_bf16 v[100:103], a[180:183], a[44:47], v[100:103]
  v_mfma_f32_16x16x32_bf16 v[100:103], a[176:179], a[40:43], v[100:103]
  v_mfma_f32_16x16x32_bf16 v[104:107], a[176:179], a[48:51], v[104:107]
  v_mfma_f32_16x16x32_bf16 v[104:107], a[180:183], a[52:55], v[104:107]
  v_mfma_f32_16x16x32_bf16 v[108:111], a[180:183], a[60:63], v[108:111]
  v_mfma_f32_16x16x32_bf16 v[108:111], a[176:179], a[56:59], v[108:111]
  s_waitcnt vmcnt(8) lgkmcnt(0)
  s_barrier
  ds_read_b128 a[160:163], v10 offset:16384
  ds_read_b128 a[164:167], v11 offset:16384
  v_mfma_f32_16x16x32_bf16 v[112:115], a[176:179], a[64:67], v[112:115]
  v_mfma_f32_16x16x32_bf16 v[112:115], a[180:183], a[68:71], v[112:115]
  s_and_b32 s3, s2, 1
  s_lshl_b32 s3, s3, 3
  v_mfma_f32_16x16x32_bf16 v[116:119], a[180:183], a[76:79], v[116:119]
  s_bfe_u32 s4, s2, 0x30003
  s_add_u32 s26, s3, s4
  v_mfma_f32_16x16x32_bf16 v[116:119], a[176:179], a[72:75], v[116:119]
  ds_read_b64_tr_b16 a[100:101], v12 offset:49152
  ds_read_b64_tr_b16 a[102:103], v12 offset:51200
  s_bfe_u32 s3, s2, 0x20001
  s_lshl_b32 s3, s3, 2
  v_mfma_f32_16x16x32_bf16 v[120:123], a[176:179], a[80:83], v[120:123]
  s_lshr_b32 s4, s2, 6
  s_add_u32 s27, s3, s4
  v_mfma_f32_16x16x32_bf16 v[120:123], a[180:183], a[84:87], v[120:123]
  s_lshl_b32 s23, s26, 18
  s_sub_u32 s24, s23, 32768
  v_mfma_f32_16x16x32_bf16 v[124:127], a[180:183], a[92:95], v[124:127]
  s_max_i32 s24, s24, 0
  s_lshl_b32 s25, s27, 7
  v_mfma_f32_16x16x32_bf16 v[124:127], a[176:179], a[88:91], v[124:127]
  s_mov_b64 s[8:9], s[44:45]
  s_mov_b32 s10, 4194304
  v_mfma_f32_16x16x32_bf16 v[128:131], a[184:187], a[32:35], v[128:131]
  s_mov_b64 s[12:13], s[46:47]
  s_mov_b32 s14, 6291456
  v_mfma_f32_16x16x32_bf16 v[128:131], a[188:191], a[36:39], v[128:131]
  ds_read_b128 a[168:171], v10 offset:18432
  ds_read_b128 a[172:175], v11 offset:18432
  ds_read_b64_tr_b16 a[108:109], v13 offset:49152
  ds_read_b64_tr_b16 a[110:111], v13 offset:51200
  s_lshl_b32 s28, s20, 9
  s_mul_i32 s30, s20, 6144
  v_mfma_f32_16x16x32_bf16 v[132:135], a[188:191], a[44:47], v[132:135]
  s_lshl_b32 s3, s20, 5
  v_lshrrev_b32 v24, 3, v0
  v_mfma_f32_16x16x32_bf16 v[132:135], a[184:187], a[40:43], v[132:135]
  v_and_b32 v25, 7, v0
  v_add_u32 v28, s3, v24
  v_mfma_f32_16x16x32_bf16 v[136:139], a[184:187], a[48:51], v[136:139]
  v_add_u32 v26, 0, v28
  v_bfe_u32 v27, v26, 1, 3
  v_mfma_f32_16x16x32_bf16 v[136:139], a[188:191], a[52:55], v[136:139]
  v_xor_b32 v27, v27, v25
  v_lshlrev_b32 v26, 11, v26
  v_mfma_f32_16x16x32_bf16 v[140:143], a[188:191], a[60:63], v[140:143]
  v_lshl_add_u32 v26, v27, 4, v26
  v_subrev_u32 v2, 0, v26
  v_mfma_f32_16x16x32_bf16 v[140:143], a[184:187], a[56:59], v[140:143]
  ds_read_b64_tr_b16 a[116:117], v14 offset:49152
  ds_read_b64_tr_b16 a[118:119], v14 offset:51200
  v_add_u32 v26, 8, v28
  v_bfe_u32 v27, v26, 1, 3
  v_mfma_f32_16x16x32_bf16 v[144:147], a[184:187], a[64:67], v[144:147]
  v_xor_b32 v27, v27, v25
  v_lshlrev_b32 v26, 11, v26
  v_mfma_f32_16x16x32_bf16 v[144:147], a[188:191], a[68:71], v[144:147]
  v_lshl_add_u32 v26, v27, 4, v26
  v_subrev_u32 v3, 1024, v26
  v_mfma_f32_16x16x32_bf16 v[148:151], a[188:191], a[76:79], v[148:151]
  v_add_u32 v26, 16, v28
  v_bfe_u32 v27, v26, 1, 3
  v_mfma_f32_16x16x32_bf16 v[148:151], a[184:187], a[72:75], v[148:151]
  v_xor_b32 v27, v27, v25
  v_lshlrev_b32 v26, 11, v26
  v_mfma_f32_16x16x32_bf16 v[152:155], a[184:187], a[80:83], v[152:155]
  v_lshl_add_u32 v26, v27, 4, v26
  v_subrev_u32 v4, 2048, v26
  v_mfma_f32_16x16x32_bf16 v[152:155], a[188:191], a[84:87], v[152:155]
  ds_read_b64_tr_b16 a[124:125], v15 offset:49152
  ds_read_b64_tr_b16 a[126:127], v15 offset:51200
  v_add_u32 v26, 24, v28
  v_bfe_u32 v27, v26, 1, 3
  v_mfma_f32_16x16x32_bf16 v[156:159], a[188:191], a[92:95], v[156:159]
  v_xor_b32 v27, v27, v25
  v_lshlrev_b32 v26, 11, v26
  v_mfma_f32_16x16x32_bf16 v[156:159], a[184:187], a[88:91], v[156:159]
  s_waitcnt lgkmcnt(10)
  v_lshl_add_u32 v26, v27, 4, v26
  v_subrev_u32 v5, 3072, v26
  v_mfma_f32_16x16x32_bf16 v[160:163], a[160:163], a[32:35], v[160:163]
  s_lshl_b32 s3, s20, 2
  v_add_u32 v26, s3, v24
  v_mfma_f32_16x16x32_bf16 v[160:163], a[164:167], a[36:39], v[160:163]
  ds_read_b128 a[176:179], v10 offset:20480
  ds_read_b128 a[180:183], v11 offset:20480
  v_bfe_u32 v27, v26, 1, 3
  v_xor_b32 v27, v27, v25
  v_mfma_f32_16x16x32_bf16 v[164:167], a[164:167], a[44:47], v[164:167]
  v_lshlrev_b32 v26, 11, v26
  v_lshl_add_u32 v20, v27, 4, v26
  v_mfma_f32_16x16x32_bf16 v[164:167], a[160:163], a[40:43], v[164:167]
  ds_read_b64_tr_b16 a[132:133], v16 offset:49152
  ds_read_b64_tr_b16 a[134:135], v16 offset:51200
  s_mul_i32 s3, s20, 48
  v_add_u32 v28, s3, v24
  v_mfma_f32_16x16x32_bf16 v[168:171], a[160:163], a[48:51], v[168:171]
  v_add_u32 v26, 0, v28
  v_mul_u32_u24 v27, 0xaaab, v26
  v_mfma_f32_16x16x32_bf16 v[168:171], a[164:167], a[52:55], v[168:171]
  v_lshrrev_b32 v27, 17, v27
  v_mfma_f32_16x16x32_bf16 v[172:175], a[164:167], a[60:63], v[172:175]
  v_lshrrev_b32 v29, 1, v27
  v_and_b32 v29, 4, v29
  v_mfma_f32_16x16x32_bf16 v[172:175], a[160:163], a[56:59], v[172:175]
  v_and_or_b32 v27, v27, 2, v29
  v_xor_b32 v27, v27, v25
  v_mfma_f32_16x16x32_bf16 v[176:179], a[160:163], a[64:67], v[176:179]
  v_lshlrev_b32 v26, 11, v26
  v_lshl_add_u32 v26, v27, 4, v26
  v_mfma_f32_16x16x32_bf16 v[176:179], a[164:167], a[68:71], v[176:179]
  ds_read_b64_tr_b16 a[140:141], v17 offset:49152
  ds_read_b64_tr_b16 a[142:143], v17 offset:51200
  v_subrev_u32 v6, 0, v26
  v_add_u32 v26, 8, v28
  v_mfma_f32_16x16x32_bf16 v[180:183], a[164:167], a[76:79], v[180:183]
  v_mul_u32_u24 v27, 0xaaab, v26
  v_lshrrev_b32 v27, 17, v27
  v_mfma_f32_16x16x32_bf16 v[180:183], a[160:163], a[72:75], v[180:183]
  v_lshrrev_b32 v29, 1, v27
  v_and_b32 v29, 4, v29
  v_mfma_f32_16x16x32_bf16 v[184:187], a[160:163], a[80:83], v[184:187]
  v_and_or_b32 v27, v27, 2, v29
  v_xor_b32 v27, v27, v25
  v_mfma_f32_16x16x32_bf16 v[184:187], a[164:167], a[84:87], v[184:187]
  v_lshlrev_b32 v26, 11, v26
  v_lshl_add_u32 v26, v27, 4, v26
  v_mfma_f32_16x16x32_bf16 v[188:191], a[164:167], a[92:95], v[188:191]
  v_subrev_u32 v7, 1024, v26
  v_add_u32 v26, 16, v28
  v_mfma_f32_16x16x32_bf16 v[188:191], a[160:163], a[88:91], v[188:191]
  s_waitcnt lgkmcnt(12)
  ds_read_b64_tr_b16 a[148:149], v18 offset:49152
  ds_read_b64_tr_b16 a[150:151], v18 offset:51200
  v_mul_u32_u24 v27, 0xaaab, v26
  v_lshrrev_b32 v27, 17, v27
  v_mfma_f32_16x16x32_bf16 v[192:195], a[168:171], a[32:35], v[192:195]
  v_lshrrev_b32 v29, 1, v27
  v_and_b32 v29, 4, v29
  v_mfma_f32_16x16x32_bf16 v[192:195], a[172:175], a[36:39], v[192:195]
  ds_read_b128 a[184:187], v10 offset:22528
  ds_read_b128 a[188:191], v11 offset:22528
  v_and_or_b32 v27, v27, 2, v29
  v_xor_b32 v27, v27, v25
  v_mfma_f32_16x16x32_bf16 v[196:199], a[172:175], a[44:47], v[196:199]
  v_lshlrev_b32 v26, 11, v26
  v_lshl_add_u32 v26, v27, 4, v26
  v_mfma_f32_16x16x32_bf16 v[196:199], a[168:171], a[40:43], v[196:199]
  v_subrev_u32 v8, 2048, v26
  v_add_u32 v26, 24, v28
  v_mfma_f32_16x16x32_bf16 v[200:203], a[168:171], a[48:51], v[200:203]
  v_mul_u32_u24 v27, 0xaaab, v26
  v_lshrrev_b32 v27, 17, v27
  v_mfma_f32_16x16x32_bf16 v[200:203], a[172:175], a[52:55], v[200:203]
  ds_read_b64_tr_b16 a[156:157], v19 offset:49152
  ds_read_b64_tr_b16 a[158:159], v19 offset:51200
  v_lshrrev_b32 v29, 1, v27
  v_and_b32 v29, 4, v29
  v_mfma_f32_16x16x32_bf16 v[204:207], a[172:175], a[60:63], v[204:207]
  v_and_or_b32 v27, v27, 2, v29
  v_xor_b32 v27, v27, v25
  v_mfma_f32_16x16x32_bf16 v[204:207], a[168:171], a[56:59], v[204:207]
  v_lshlrev_b32 v26, 11, v26
  v_lshl_add_u32 v26, v27, 4, v26
  v_mfma_f32_16x16x32_bf16 v[208:211], a[168:171], a[64:67], v[208:211]
  v_subrev_u32 v9, 3072, v26
  v_add_u32 v26, 32, v28
  v_mfma_f32_16x16x32_bf16 v[208:211], a[172:175], a[68:71], v[208:211]
  v_mul_u32_u24 v27, 0xaaab, v26
  v_lshrrev_b32 v27, 17, v27
  v_mfma_f32_16x16x32_bf16 v[212:215], a[172:175], a[76:79], v[212:215]
  v_lshrrev_b32 v29, 1, v27
  v_and_b32 v29, 4, v29
  v_mfma_f32_16x16x32_bf16 v[212:215], a[168:171], a[72:75], v[212:215]
  v_and_or_b32 v27, v27, 2, v29
  v_xor_b32 v27, v27, v25
  v_mfma_f32_16x16x32_bf16 v[216:219], a[168:171], a[80:83], v[216:219]
  v_lshlrev_b32 v26, 11, v26
  v_lshl_add_u32 v26, v27, 4, v26
  v_mfma_f32_16x16x32_bf16 v[216:219], a[172:175], a[84:87], v[216:219]
  v_subrev_u32 v21, 0, v26
  v_add_u32 v26, 40, v28
  v_mfma_f32_16x16x32_bf16 v[220:223], a[172:175], a[92:95], v[220:223]
  v_mul_u32_u24 v27, 0xaaab, v26
  v_lshrrev_b32 v27, 17, v27
  v_mfma_f32_16x16x32_bf16 v[220:223], a[168:171], a[88:91], v[220:223]
  s_waitcnt lgkmcnt(10)
  v_lshrrev_b32 v29, 1, v27
  v_and_b32 v29, 4, v29
  v_mfma_f32_16x16x32_bf16 v[224:227], a[176:179], a[32:35], v[224:227]
  v_and_or_b32 v27, v27, 2, v29
  v_xor_b32 v27, v27, v25
  v_mfma_f32_16x16x32_bf16 v[224:227], a[180:183], a[36:39], v[224:227]
  v_lshlrev_b32 v26, 11, v26
  v_lshl_add_u32 v26, v27, 4, v26
  v_mfma_f32_16x16x32_bf16 v[228:231], a[180:183], a[44:47], v[228:231]
  v_subrev_u32 v22, 1024, v26
  v_mfma_f32_16x16x32_bf16 v[228:231], a[176:179], a[40:43], v[228:231]
  v_mfma_f32_16x16x32_bf16 v[232:235], a[176:179], a[48:51], v[232:235]
  v_mfma_f32_16x16x32_bf16 v[232:235], a[180:183], a[52:55], v[232:235]
  v_mfma_f32_16x16x32_bf16 v[236:239], a[180:183], a[60:63], v[236:239]
  v_mfma_f32_16x16x32_bf16 v[236:239], a[176:179], a[56:59], v[236:239]
  s_waitcnt vmcnt(4) lgkmcnt(0)
  s_barrier
  ds_read_b128 a[160:163], v10 offset:32768
  ds_read_b128 a[164:167], v11 offset:32768
  v_mfma_f32_16x16x32_bf16 v[240:243], a[176:179], a[64:67], v[240:243]
  s_add_u32 m0, s28, 131072
  s_mov_b32 exec_hi, 0
  buffer_load_dwordx4 v20, s[8:11], s24 offen lds
  s_mov_b32 exec_hi, -1
  v_mfma_f32_16x16x32_bf16 v[240:243], a[180:183], a[68:71], v[240:243]
  v_mfma_f32_16x16x32_bf16 v[244:247], a[180:183], a[76:79], v[244:247]
  v_mfma_f32_16x16x32_bf16 v[244:247], a[176:179], a[72:75], v[244:247]
  s_add_u32 m0, s29, 133120
  s_nop 0
  buffer_load_dwordx4 v2, s[8:11], s23 offen offset:0 lds
  v_mfma_f32_16x16x32_bf16 v[248:251], a[176:179], a[80:83], v[248:251]
  v_mfma_f32_16x16x32_bf16 v[248:251], a[180:183], a[84:87], v[248:251]
  v_mfma_f32_16x16x32_bf16 v[252:255], a[180:183], a[92:95], v[252:255]
  v_mfma_f32_16x16x32_bf16 v[252:255], a[176:179], a[88:91], v[252:255]
  v_mfma_f32_16x16x32_bf16 a[0:3], a[184:187], a[32:35], a[0:3]
  buffer_load_dwordx4 v3, s[8:11], s23 offen offset:1024 lds
  v_mfma_f32_16x16x32_bf16 a[0:3], a[188:191], a[36:39], a[0:3]
  ds_read_b128 a[168:171], v10 offset:34816
  ds_read_b128 a[172:175], v11 offset:34816
  v_mfma_f32_16x16x32_bf16 a[4:7], a[188:191], a[44:47], a[4:7]
  v_mfma_f32_16x16x32_bf16 a[4:7], a[184:187], a[40:43], a[4:7]
  v_mfma_f32_16x16x32_bf16 a[8:11], a[184:187], a[48:51], a[8:11]
  buffer_load_dwordx4 v4, s[8:11], s23 offen offset:2048 lds
  v_mfma_f32_16x16x32_bf16 a[8:11], a[188:191], a[52:55], a[8:11]
  v_mfma_f32_16x16x32_bf16 a[12:15], a[188:191], a[60:63], a[12:15]
  v_mfma_f32_16x16x32_bf16 a[12:15], a[184:187], a[56:59], a[12:15]
  v_mfma_f32_16x16x32_bf16 a[16:19], a[184:187], a[64:67], a[16:19]
  buffer_load_dwordx4 v5, s[8:11], s23 offen offset:3072 lds
  v_mfma_f32_16x16x32_bf16 a[16:19], a[188:191], a[68:71], a[16:19]
  v_mfma_f32_16x16x32_bf16 a[20:23], a[188:191], a[76:79], a[20:23]
  v_mfma_f32_16x16x32_bf16 a[20:23], a[184:187], a[72:75], a[20:23]
  s_add_u32 s23, s23, 128
  s_add_u32 s24, s24, 128
  v_mfma_f32_16x16x32_bf16 a[24:27], a[184:187], a[80:83], a[24:27]
  v_mfma_f32_16x16x32_bf16 a[24:27], a[188:191], a[84:87], a[24:27]
  v_mfma_f32_16x16x32_bf16 a[28:31], a[188:191], a[92:95], a[28:31]
  v_mfma_f32_16x16x32_bf16 a[28:31], a[184:187], a[88:91], a[28:31]
  s_waitcnt lgkmcnt(2)
  v_mfma_f32_16x16x32_bf16 v[32:35], a[160:163], a[96:99], v[32:35]
  s_add_u32 m0, s30, 65536
  s_nop 0
  buffer_load_dwordx4 v6, s[12:15], s25 offen offset:0 lds
  v_mfma_f32_16x16x32_bf16 v[32:35], a[164:167], a[100:103], v[32:35]
  ds_read_b128 a[176:179], v10 offset:36864
  ds_read_b128 a[180:183], v11 offset:36864
  v_mfma_f32_16x16x32_bf16 v[36:39], a[164:167], a[108:111], v[36:39]
  v_mfma_f32_16x16x32_bf16 v[36:39], a[160:163], a[104:107], v[36:39]
  v_mfma_f32_16x16x32_bf16 v[40:43], a[160:163], a[112:115], v[40:43]
  v_mfma_f32_16x16x32_bf16 v[40:43], a[164:167], a[116:119], v[40:43]
  buffer_load_dwordx4 v7, s[12:15], s25 offen offset:1024 lds
  v_mfma_f32_16x16x32_bf16 v[44:47], a[164:167], a[124:127], v[44:47]
  v_mfma_f32_16x16x32_bf16 v[44:47], a[160:163], a[120:123], v[44:47]
  v_mfma_f32_16x16x32_bf16 v[48:51], a[160:163], a[128:131], v[48:51]
  v_mfma_f32_16x16x32_bf16 v[48:51], a[164:167], a[132:135], v[48:51]
  v_mfma_f32_16x16x32_bf16 v[52:55], a[164:167], a[140:143], v[52:55]
  buffer_load_dwordx4 v8, s[12:15], s25 offen offset:2048 lds
  v_mfma_f32_16x16x32_bf16 v[52:55], a[160:163], a[136:139], v[52:55]
  v_mfma_f32_16x16x32_bf16 v[56:59], a[160:163], a[144:147], v[56:59]
  v_mfma_f32_16x16x32_bf16 v[56:59], a[164:167], a[148:151], v[56:59]
  v_mfma_f32_16x16x32_bf16 v[60:63], a[164:167], a[156:159], v[60:63]
  v_mfma_f32_16x16x32_bf16 v[60:63], a[160:163], a[152:155], v[60:63]
  s_waitcnt lgkmcnt(2)
  v_mfma_f32_16x16x32_bf16 v[64:67], a[168:171], a[96:99], v[64:67]
  buffer_load_dwordx4 v9, s[12:15], s25 offen offset:3072 lds
  v_mfma_f32_16x16x32_bf16 v[64:67], a[172:175], a[100:103], v[64:67]
  ds_read_b128 a[184:187], v10 offset:38912
  ds_read_b128 a[188:191], v11 offset:38912
  v_mfma_f32_16x16x32_bf16 v[68:71], a[172:175], a[108:111], v[68:71]
  v_mfma_f32_16x16x32_bf16 v[68:71], a[168:171], a[104:107], v[68:71]
  v_mfma_f32_16x16x32_bf16 v[72:75], a[168:171], a[112:115], v[72:75]
  v_mfma_f32_16x16x32_bf16 v[72:75], a[172:175], a[116:119], v[72:75]
  s_add_u32 m0, s30, 69632
  s_nop 0
  buffer_load_dwordx4 v21, s[12:15], s25 offen offset:0 lds
  v_mfma_f32_16x16x32_bf16 v[76:79], a[172:175], a[124:127], v[76:79]
  v_mfma_f32_16x16x32_bf16 v[76:79], a[168:171], a[120:123], v[76:79]
  v_mfma_f32_16x16x32_bf16 v[80:83], a[168:171], a[128:131], v[80:83]
  v_mfma_f32_16x16x32_bf16 v[80:83], a[172:175], a[132:135], v[80:83]
  v_mfma_f32_16x16x32_bf16 v[84:87], a[172:175], a[140:143], v[84:87]
  buffer_load_dwordx4 v22, s[12:15], s25 offen offset:1024 lds
  v_mfma_f32_16x16x32_bf16 v[84:87], a[168:171], a[136:139], v[84:87]
  v_mfma_f32_16x16x32_bf16 v[88:91], a[168:171], a[144:147], v[88:91]
  v_mfma_f32_16x16x32_bf16 v[88:91], a[172:175], a[148:151], v[88:91]
  v_mfma_f32_16x16x32_bf16 v[92:95], a[172:175], a[156:159], v[92:95]
  v_mfma_f32_16x16x32_bf16 v[92:95], a[168:171], a[152:155], v[92:95]
  s_waitcnt lgkmcnt(2)
  v_mfma_f32_16x16x32_bf16 v[96:99], a[176:179], a[96:99], v[96:99]
  s_add_u32 s25, s25, 393216
  v_mfma_f32_16x16x32_bf16 v[96:99], a[180:183], a[100:103], v[96:99]
  v_mfma_f32_16x16x32_bf16 v[100:103], a[180:183], a[108:111], v[100:103]
  v_mfma_f32_16x16x32_bf16 v[100:103], a[176:179], a[104:107], v[100:103]
  v_mfma_f32_16x16x32_bf16 v[104:107], a[176:179], a[112:115], v[104:107]
  v_mfma_f32_16x16x32_bf16 v[104:107], a[180:183], a[116:119], v[104:107]
  v_mfma_f32_16x16x32_bf16 v[108:111], a[180:183], a[124:127], v[108:111]
  v_mfma_f32_16x16x32_bf16 v[108:111], a[176:179], a[120:123], v[108:111]
  s_waitcnt vmcnt(11) lgkmcnt(0)
  s_barrier
  ds_read_b128 a[160:163], v10 offset:49152
  ds_read_b128 a[164:167], v11 offset:49152
  v_mfma_f32_16x16x32_bf16 v[112:115], a[176:179], a[128:131], v[112:115]
  s_add_u32 m0, s28, 0
  s_mov_b32 exec_hi, 0
  buffer_load_dwordx4 v20, s[8:11], s24 offen lds
  s_mov_b32 exec_hi, -1
  v_mfma_f32_16x16x32_bf16 v[112:115], a[180:183], a[132:135], v[112:115]
  v_mfma_f32_16x16x32_bf16 v[116:119], a[180:183], a[140:143], v[116:119]
  v_mfma_f32_16x16x32_bf16 v[116:119], a[176:179], a[136:139], v[116:119]
  v_mfma_f32_16x16x32_bf16 v[120:123], a[176:179], a[144:147], v[120:123]
  s_add_u32 m0, s29, 2048
  s_nop 0
  buffer_load_dwordx4 v2, s[8:11], s23 offen offset:0 lds
  v_mfma_f32_16x16x32_bf16 v[120:123], a[180:183], a[148:151], v[120:123]
  v_mfma_f32_16x16x32_bf16 v[124:127], a[180:183], a[156:159], v[124:127]
  v_mfma_f32_16x16x32_bf16 v[124:127], a[176:179], a[152:155], v[124:127]
  v_mfma_f32_16x16x32_bf16 v[128:131], a[184:187], a[96:99], v[128:131]
  v_mfma_f32_16x16x32_bf16 v[128:131], a[188:191], a[100:103], v[128:131]
  ds_read_b128 a[168:171], v10 offset:51200
  ds_read_b128 a[172:175], v11 offset:51200
  v_mfma_f32_16x16x32_bf16 v[132:135], a[188:191], a[108:111], v[132:135]
  buffer_load_dwordx4 v3, s[8:11], s23 offen offset:1024 lds
  v_mfma_f32_16x16x32_bf16 v[132:135], a[184:187], a[104:107], v[132:135]
  v_mfma_f32_16x16x32_bf16 v[136:139], a[184:187], a[112:115], v[136:139]
  v_mfma_f32_16x16x32_bf16 v[136:139], a[188:191], a[116:119], v[136:139]
  v_mfma_f32_16x16x32_bf16 v[140:143], a[188:191], a[124:127], v[140:143]
  buffer_load_dwordx4 v4, s[8:11], s23 offen offset:2048 lds
  v_mfma_f32_16x16x32_bf16 v[140:143], a[184:187], a[120:123], v[140:143]
  v_mfma_f32_16x16x32_bf16 v[144:147], a[184:187], a[128:131], v[144:147]
  v_mfma_f32_16x16x32_bf16 v[144:147], a[188:191], a[132:135], v[144:147]
  v_mfma_f32_16x16x32_bf16 v[148:151], a[188:191], a[140:143], v[148:151]
  buffer_load_dwordx4 v5, s[8:11], s23 offen offset:3072 lds
  v_mfma_f32_16x16x32_bf16 v[148:151], a[184:187], a[136:139], v[148:151]
  v_mfma_f32_16x16x32_bf16 v[152:155], a[184:187], a[144:147], v[152:155]
  v_mfma_f32_16x16x32_bf16 v[152:155], a[188:191], a[148:151], v[152:155]
  v_mfma_f32_16x16x32_bf16 v[156:159], a[188:191], a[156:159], v[156:159]
  s_add_u32 s23, s23, 128
  s_add_u32 s24, s24, 128
  v_mfma_f32_16x16x32_bf16 v[156:159], a[184:187], a[152:155], v[156:159]
  s_waitcnt lgkmcnt(2)
  v_mfma_f32_16x16x32_bf16 v[160:163], a[160:163], a[96:99], v[160:163]
  v_mfma_f32_16x16x32_bf16 v[160:163], a[164:167], a[100:103], v[160:163]
  ds_read_b128 a[176:179], v10 offset:53248
  ds_read_b128 a[180:183], v11 offset:53248
  v_mfma_f32_16x16x32_bf16 v[164:167], a[164:167], a[108:111], v[164:167]
  v_mfma_f32_16x16x32_bf16 v[164:167], a[160:163], a[104:107], v[164:167]
  v_mfma_f32_16x16x32_bf16 v[168:171], a[160:163], a[112:115], v[168:171]
  s_add_u32 m0, s30, 98304
  s_nop 0
  buffer_load_dwordx4 v6, s[12:15], s25 offen offset:0 lds
  v_mfma_f32_16x16x32_bf16 v[168:171], a[164:167], a[116:119], v[168:171]
  v_mfma_f32_16x16x32_bf16 v[172:175], a[164:167], a[124:127], v[172:175]
  v_mfma_f32_16x16x32_bf16 v[172:175], a[160:163], a[120:123], v[172:175]
  v_mfma_f32_16x16x32_bf16 v[176:179], a[160:163], a[128:131], v[176:179]
  v_mfma_f32_16x16x32_bf16 v[176:179], a[164:167], a[132:135], v[176:179]
  buffer_load_dwordx4 v7, s[12:15], s25 offen offset:1024 lds
  v_mfma_f32_16x16x32_bf16 v[180:183], a[164:167], a[140:143], v[180:183]
  v_mfma_f32_16x16x32_bf16 v[180:183], a[160:163], a[136:139], v[180:183]
  v_mfma_f32_16x16x32_bf16 v[184:187], a[160:163], a[144:147], v[184:187]
  v_mfma_f32_16x16x32_bf16 v[184:187], a[164:167], a[148:151], v[184:187]
  buffer_load_dwordx4 v8, s[12:15], s25 offen offset:2048 lds
  v_mfma_f32_16x16x32_bf16 v[188:191], a[164:167], a[156:159], v[188:191]
  v_mfma_f32_16x16x32_bf16 v[188:191], a[160:163], a[152:155], v[188:191]
  s_waitcnt lgkmcnt(2)
  v_mfma_f32_16x16x32_bf16 v[192:195], a[168:171], a[96:99], v[192:195]
  v_mfma_f32_16x16x32_bf16 v[192:195], a[172:175], a[100:103], v[192:195]
  ds_read_b128 a[184:187], v10 offset:55296
  ds_read_b128 a[188:191], v11 offset:55296
  v_mfma_f32_16x16x32_bf16 v[196:199], a[172:175], a[108:111], v[196:199]
  v_mfma_f32_16x16x32_bf16 v[196:199], a[168:171], a[104:107], v[196:199]
  buffer_load_dwordx4 v9, s[12:15], s25 offen offset:3072 lds
  v_mfma_f32_16x16x32_bf16 v[200:203], a[168:171], a[112:115], v[200:203]
  v_mfma_f32_16x16x32_bf16 v[200:203], a[172:175], a[116:119], v[200:203]
  v_mfma_f32_16x16x32_bf16 v[204:207], a[172:175], a[124:127], v[204:207]
  v_mfma_f32_16x16x32_bf16 v[204:207], a[168:171], a[120:123], v[204:207]
  s_add_u32 m0, s30, 102400
  s_nop 0
  buffer_load_dwordx4 v21, s[12:15], s25 offen offset:0 lds
  v_mfma_f32_16x16x32_bf16 v[208:211], a[168:171], a[128:131], v[208:211]
  v_mfma_f32_16x16x32_bf16 v[208:211], a[172:175], a[132:135], v[208:211]
  v_mfma_f32_16x16x32_bf16 v[212:215], a[172:175], a[140:143], v[212:215]
  v_mfma_f32_16x16x32_bf16 v[212:215], a[168:171], a[136:139], v[212:215]
  buffer_load_dwordx4 v22, s[12:15], s25 offen offset:1024 lds
  v_mfma_f32_16x16x32_bf16 v[216:219], a[168:171], a[144:147], v[216:219]
  v_mfma_f32_16x16x32_bf16 v[216:219], a[172:175], a[148:151], v[216:219]
  v_mfma_f32_16x16x32_bf16 v[220:223], a[172:175], a[156:159], v[220:223]
  v_mfma_f32_16x16x32_bf16 v[220:223], a[168:171], a[152:155], v[220:223]
  s_waitcnt lgkmcnt(2)
  v_mfma_f32_16x16x32_bf16 v[224:227], a[176:179], a[96:99], v[224:227]
  s_add_u32 s25, s25, 393216
  v_mfma_f32_16x16x32_bf16 v[224:227], a[180:183], a[100:103], v[224:227]
  v_mfma_f32_16x16x32_bf16 v[228:231], a[180:183], a[108:111], v[228:231]
  v_mfma_f32_16x16x32_bf16 v[228:231], a[176:179], a[104:107], v[228:231]
  v_mfma_f32_16x16x32_bf16 v[232:235], a[176:179], a[112:115], v[232:235]
  v_mfma_f32_16x16x32_bf16 v[232:235], a[180:183], a[116:119], v[232:235]
  v_mfma_f32_16x16x32_bf16 v[236:239], a[180:183], a[124:127], v[236:239]
  v_mfma_f32_16x16x32_bf16 v[236:239], a[176:179], a[120:123], v[236:239]
  s_waitcnt vmcnt(63) lgkmcnt(0)
  s_barrier
  v_mfma_f32_16x16x32_bf16 v[240:243], a[176:179], a[128:131], v[240:243]
  s_add_u32 m0, s28, 18432
  s_mov_b32 exec_hi, 0
  buffer_load_dwordx4 v20, s[8:11], s24 offen lds
  s_mov_b32 exec_hi, -1
  v_mfma_f32_16x16x32_bf16 v[240:243], a[180:183], a[132:135], v[240:243]
  v_mfma_f32_16x16x32_bf16 v[244:247], a[180:183], a[140:143], v[244:247]
  v_mfma_f32_16x16x32_bf16 v[244:247], a[176:179], a[136:139], v[244:247]
  s_add_u32 m0, s29, 20480
  s_nop 0
  buffer_load_dwordx4 v2, s[8:11], s23 offen offset:0 lds
  v_mfma_f32_16x16x32_bf16 v[248:251], a[176:179], a[144:147], v[248:251]
  v_mfma_f32_16x16x32_bf16 v[248:251], a[180:183], a[148:151], v[248:251]
  v_mfma_f32_16x16x32_bf16 v[252:255], a[180:183], a[156:159], v[252:255]
  v_mfma_f32_16x16x32_bf16 v[252:255], a[176:179], a[152:155], v[252:255]
  v_mfma_f32_16x16x32_bf16 a[0:3], a[184:187], a[96:99], a[0:3]
  buffer_load_dwordx4 v3, s[8:11], s23 offen offset:1024 lds
  v_mfma_f32_16x16x32_bf16 a[0:3], a[188:191], a[100:103], a[0:3]
  v_mfma_f32_16x16x32_bf16 a[4:7], a[188:191], a[108:111], a[4:7]
  v_mfma_f32_16x16x32_bf16 a[4:7], a[184:187], a[104:107], a[4:7]
  v_mfma_f32_16x16x32_bf16 a[8:11], a[184:187], a[112:115], a[8:11]
  buffer_load_dwordx4 v4, s[8:11], s23 offen offset:2048 lds
  v_mfma_f32_16x16x32_bf16 a[8:11], a[188:191], a[116:119], a[8:11]
  v_mfma_f32_16x16x32_bf16 a[12:15], a[188:191], a[124:127], a[12:15]
  v_mfma_f32_16x16x32_bf16 a[12:15], a[184:187], a[120:123], a[12:15]
  buffer_load_dwordx4 v5, s[8:11], s23 offen offset:3072 lds
  v_mfma_f32_16x16x32_bf16 a[16:19], a[184:187], a[128:131], a[16:19]
  v_mfma_f32_16x16x32_bf16 a[16:19], a[188:191], a[132:135], a[16:19]
  v_mfma_f32_16x16x32_bf16 a[20:23], a[188:191], a[140:143], a[20:23]
  v_mfma_f32_16x16x32_bf16 a[20:23], a[184:187], a[136:139], a[20:23]
  s_add_u32 s23, s23, 128
  s_add_u32 s24, s24, 128
  v_mfma_f32_16x16x32_bf16 a[24:27], a[184:187], a[144:147], a[24:27]
  v_mfma_f32_16x16x32_bf16 a[24:27], a[188:191], a[148:151], a[24:27]
  v_mfma_f32_16x16x32_bf16 a[28:31], a[188:191], a[156:159], a[28:31]
  v_mfma_f32_16x16x32_bf16 a[28:31], a[184:187], a[152:155], a[28:31]
  s_lshr_b32 s4, s53, 7
  s_add_u32 s4, s4, s22
  s_lshl_b32 s4, s4, 5
  s_lshr_b32 s5, s52, 6
  s_add_u32 s4, s4, s5
  s_lshl_b32 s5, s21, 1
  s_add_u32 s4, s4, s5
  s_lshl_b32 s4, s4, 15
  v_cvt_pk_bf16_f32 v24, v32, v33
  v_cvt_pk_bf16_f32 v25, v34, v35
  v_cvt_pk_bf16_f32 v26, v64, v65
  v_cvt_pk_bf16_f32 v27, v66, v67
  s_add_u32 s5, s4, 16384
  buffer_store_dwordx4 v[24:27], v1, s[16:19], s5 offen offset:0
  v_cvt_pk_bf16_f32 v28, v36, v37
  v_cvt_pk_bf16_f32 v29, v38, v39
  v_cvt_pk_bf16_f32 v30, v68, v69
  v_cvt_pk_bf16_f32 v31, v70, v71
  buffer_store_dwordx4 v[28:31], v1, s[16:19], s5 offen offset:1024
  v_cvt_pk_bf16_f32 v24, v40, v41
  v_cvt_pk_bf16_f32 v25, v42, v43
  v_cvt_pk_bf16_f32 v26, v72, v73
  v_cvt_pk_bf16_f32 v27, v74, v75
  buffer_store_dwordx4 v[24:27], v1, s[16:19], s5 offen offset:2048
  v_cvt_pk_bf16_f32 v28, v44, v45
  v_cvt_pk_bf16_f32 v29, v46, v47
  v_cvt_pk_bf16_f32 v30, v76, v77
  v_cvt_pk_bf16_f32 v31, v78, v79
  buffer_store_dwordx4 v[28:31], v1, s[16:19], s5 offen offset:3072
  v_cvt_pk_bf16_f32 v24, v48, v49
  v_cvt_pk_bf16_f32 v25, v50, v51
  v_cvt_pk_bf16_f32 v26, v80, v81
  v_cvt_pk_bf16_f32 v27, v82, v83
  s_add_u32 s5, s4, 20480
  buffer_store_dwordx4 v[24:27], v1, s[16:19], s5 offen offset:0
  v_cvt_pk_bf16_f32 v28, v52, v53
  v_cvt_pk_bf16_f32 v29, v54, v55
  v_cvt_pk_bf16_f32 v30, v84, v85
  v_cvt_pk_bf16_f32 v31, v86, v87
  buffer_store_dwordx4 v[28:31], v1, s[16:19], s5 offen offset:1024
  v_cvt_pk_bf16_f32 v24, v56, v57
  v_cvt_pk_bf16_f32 v25, v58, v59
  v_cvt_pk_bf16_f32 v26, v88, v89
  v_cvt_pk_bf16_f32 v27, v90, v91
  buffer_store_dwordx4 v[24:27], v1, s[16:19], s5 offen offset:2048
  v_cvt_pk_bf16_f32 v28, v60, v61
  v_cvt_pk_bf16_f32 v29, v62, v63
  v_cvt_pk_bf16_f32 v30, v92, v93
  v_cvt_pk_bf16_f32 v31, v94, v95
  buffer_store_dwordx4 v[28:31], v1, s[16:19], s5 offen offset:3072
  v_cvt_pk_bf16_f32 v24, v96, v97
  v_cvt_pk_bf16_f32 v25, v98, v99
  v_cvt_pk_bf16_f32 v26, v128, v129
  v_cvt_pk_bf16_f32 v27, v130, v131
  s_add_u32 s5, s4, 24576
  buffer_store_dwordx4 v[24:27], v1, s[16:19], s5 offen offset:0
  v_cvt_pk_bf16_f32 v28, v100, v101
  v_cvt_pk_bf16_f32 v29, v102, v103
  v_cvt_pk_bf16_f32 v30, v132, v133
  v_cvt_pk_bf16_f32 v31, v134, v135
  buffer_store_dwordx4 v[28:31], v1, s[16:19], s5 offen offset:1024
  v_cvt_pk_bf16_f32 v24, v104, v105
  v_cvt_pk_bf16_f32 v25, v106, v107
  v_cvt_pk_bf16_f32 v26, v136, v137
  v_cvt_pk_bf16_f32 v27, v138, v139
  buffer_store_dwordx4 v[24:27], v1, s[16:19], s5 offen offset:2048
  v_cvt_pk_bf16_f32 v28, v108, v109
  v_cvt_pk_bf16_f32 v29, v110, v111
  v_cvt_pk_bf16_f32 v30, v140, v141
  v_cvt_pk_bf16_f32 v31, v142, v143
  buffer_store_dwordx4 v[28:31], v1, s[16:19], s5 offen offset:3072
  v_cvt_pk_bf16_f32 v24, v112, v113
  v_cvt_pk_bf16_f32 v25, v114, v115
  v_cvt_pk_bf16_f32 v26, v144, v145
  v_cvt_pk_bf16_f32 v27, v146, v147
  s_add_u32 s5, s4, 28672
  buffer_store_dwordx4 v[24:27], v1, s[16:19], s5 offen offset:0
  v_cvt_pk_bf16_f32 v28, v116, v117
  v_cvt_pk_bf16_f32 v29, v118, v119
  v_cvt_pk_bf16_f32 v30, v148, v149
  v_cvt_pk_bf16_f32 v31, v150, v151
  buffer_store_dwordx4 v[28:31], v1, s[16:19], s5 offen offset:1024
  v_cvt_pk_bf16_f32 v24, v120, v121
  v_cvt_pk_bf16_f32 v25, v122, v123
  v_cvt_pk_bf16_f32 v26, v152, v153
  v_cvt_pk_bf16_f32 v27, v154, v155
  buffer_store_dwordx4 v[24:27], v1, s[16:19], s5 offen offset:2048
  v_cvt_pk_bf16_f32 v28, v124, v125
  v_cvt_pk_bf16_f32 v29, v126, v127
  v_cvt_pk_bf16_f32 v30, v156, v157
  v_cvt_pk_bf16_f32 v31, v158, v159
  buffer_store_dwordx4 v[28:31], v1, s[16:19], s5 offen offset:3072
  v_cvt_pk_bf16_f32 v24, v160, v161
  v_cvt_pk_bf16_f32 v25, v162, v163
  v_cvt_pk_bf16_f32 v26, v192, v193
  v_cvt_pk_bf16_f32 v27, v194, v195
  s_add_u32 s5, s4, 49152
  buffer_store_dwordx4 v[24:27], v1, s[16:19], s5 offen offset:0
  v_cvt_pk_bf16_f32 v28, v164, v165
  v_cvt_pk_bf16_f32 v29, v166, v167
  v_cvt_pk_bf16_f32 v30, v196, v197
  v_cvt_pk_bf16_f32 v31, v198, v199
  buffer_store_dwordx4 v[28:31], v1, s[16:19], s5 offen offset:1024
  v_cvt_pk_bf16_f32 v24, v168, v169
  v_cvt_pk_bf16_f32 v25, v170, v171
  v_cvt_pk_bf16_f32 v26, v200, v201
  v_cvt_pk_bf16_f32 v27, v202, v203
  buffer_store_dwordx4 v[24:27], v1, s[16:19], s5 offen offset:2048
  v_cvt_pk_bf16_f32 v28, v172, v173
  v_cvt_pk_bf16_f32 v29, v174, v175
  v_cvt_pk_bf16_f32 v30, v204, v205
  v_cvt_pk_bf16_f32 v31, v206, v207
  buffer_store_dwordx4 v[28:31], v1, s[16:19], s5 offen offset:3072
  v_cvt_pk_bf16_f32 v24, v176, v177
  v_cvt_pk_bf16_f32 v25, v178, v179
  v_cvt_pk_bf16_f32 v26, v208, v209
  v_cvt_pk_bf16_f32 v27, v210, v211
  s_add_u32 s5, s4, 53248
  buffer_store_dwordx4 v[24:27], v1, s[16:19], s5 offen offset:0
  v_cvt_pk_bf16_f32 v28, v180, v181
  v_cvt_pk_bf16_f32 v29, v182, v183
  v_cvt_pk_bf16_f32 v30, v212, v213
  v_cvt_pk_bf16_f32 v31, v214, v215
  buffer_store_dwordx4 v[28:31], v1, s[16:19], s5 offen offset:1024
  v_cvt_pk_bf16_f32 v24, v184, v185
  v_cvt_pk_bf16_f32 v25, v186, v187
  v_cvt_pk_bf16_f32 v26, v216, v217
  v_cvt_pk_bf16_f32 v27, v218, v219
  buffer_store_dwordx4 v[24:27], v1, s[16:19], s5 offen offset:2048
  v_cvt_pk_bf16_f32 v28, v188, v189
  v_cvt_pk_bf16_f32 v29, v190, v191
  v_cvt_pk_bf16_f32 v30, v220, v221
  v_cvt_pk_bf16_f32 v31, v222, v223
  buffer_store_dwordx4 v[28:31], v1, s[16:19], s5 offen offset:3072
  v_accvgpr_read_b32 v36, a0
  v_accvgpr_read_b32 v37, a1
  v_accvgpr_read_b32 v38, a2
  v_accvgpr_read_b32 v39, a3
  v_cvt_pk_bf16_f32 v24, v224, v225
  v_cvt_pk_bf16_f32 v25, v226, v227
  v_cvt_pk_bf16_f32 v26, v36, v37
  v_cvt_pk_bf16_f32 v27, v38, v39
  s_add_u32 s5, s4, 57344
  buffer_store_dwordx4 v[24:27], v1, s[16:19], s5 offen offset:0
  v_accvgpr_read_b32 v36, a4
  v_accvgpr_read_b32 v37, a5
  v_accvgpr_read_b32 v38, a6
  v_accvgpr_read_b32 v39, a7
  v_cvt_pk_bf16_f32 v28, v228, v229
  v_cvt_pk_bf16_f32 v29, v230, v231
  v_cvt_pk_bf16_f32 v30, v36, v37
  v_cvt_pk_bf16_f32 v31, v38, v39
  buffer_store_dwordx4 v[28:31], v1, s[16:19], s5 offen offset:1024
  v_accvgpr_read_b32 v36, a8
  v_accvgpr_read_b32 v37, a9
  v_accvgpr_read_b32 v38, a10
  v_accvgpr_read_b32 v39, a11
  v_cvt_pk_bf16_f32 v24, v232, v233
  v_cvt_pk_bf16_f32 v25, v234, v235
  v_cvt_pk_bf16_f32 v26, v36, v37
  v_cvt_pk_bf16_f32 v27, v38, v39
  buffer_store_dwordx4 v[24:27], v1, s[16:19], s5 offen offset:2048
  v_accvgpr_read_b32 v36, a12
  v_accvgpr_read_b32 v37, a13
  v_accvgpr_read_b32 v38, a14
  v_accvgpr_read_b32 v39, a15
  v_cvt_pk_bf16_f32 v28, v236, v237
  v_cvt_pk_bf16_f32 v29, v238, v239
  v_cvt_pk_bf16_f32 v30, v36, v37
  v_cvt_pk_bf16_f32 v31, v38, v39
  buffer_store_dwordx4 v[28:31], v1, s[16:19], s5 offen offset:3072
  v_accvgpr_read_b32 v36, a16
  v_accvgpr_read_b32 v37, a17
  v_accvgpr_read_b32 v38, a18
  v_accvgpr_read_b32 v39, a19
  v_cvt_pk_bf16_f32 v24, v240, v241
  v_cvt_pk_bf16_f32 v25, v242, v243
  v_cvt_pk_bf16_f32 v26, v36, v37
  v_cvt_pk_bf16_f32 v27, v38, v39
  s_add_u32 s5, s4, 61440
  buffer_store_dwordx4 v[24:27], v1, s[16:19], s5 offen offset:0
  v_accvgpr_read_b32 v36, a20
  v_accvgpr_read_b32 v37, a21
  v_accvgpr_read_b32 v38, a22
  v_accvgpr_read_b32 v39, a23
  v_cvt_pk_bf16_f32 v28, v244, v245
  v_cvt_pk_bf16_f32 v29, v246, v247
  v_cvt_pk_bf16_f32 v30, v36, v37
  v_cvt_pk_bf16_f32 v31, v38, v39
  buffer_store_dwordx4 v[28:31], v1, s[16:19], s5 offen offset:1024
  v_accvgpr_read_b32 v36, a24
  v_accvgpr_read_b32 v37, a25
  v_accvgpr_read_b32 v38, a26
  v_accvgpr_read_b32 v39, a27
  v_cvt_pk_bf16_f32 v24, v248, v249
  v_cvt_pk_bf16_f32 v25, v250, v251
  v_cvt_pk_bf16_f32 v26, v36, v37
  v_cvt_pk_bf16_f32 v27, v38, v39
  buffer_store_dwordx4 v[24:27], v1, s[16:19], s5 offen offset:2048
  v_accvgpr_read_b32 v36, a28
  v_accvgpr_read_b32 v37, a29
  v_accvgpr_read_b32 v38, a30
  v_accvgpr_read_b32 v39, a31
  v_cvt_pk_bf16_f32 v28, v252, v253
  v_cvt_pk_bf16_f32 v29, v254, v255
  v_cvt_pk_bf16_f32 v30, v36, v37
  v_cvt_pk_bf16_f32 v31, v38, v39
  buffer_store_dwordx4 v[28:31], v1, s[16:19], s5 offen offset:3072
Lk1_b:
  v_and_b32 v24, 15, v0
  v_lshlrev_b32 v24, 7, v24
  v_bfe_u32 v25, v0, 1, 3
  v_lshrrev_b32 v26, 4, v0
  v_xor_b32 v25, v25, v26
  v_lshl_add_u32 v10, v25, 4, v24
  v_xor_b32 v11, 64, v10
  v_add_u32 v12, 131072, v10
  v_add_u32 v13, 131072, v11
  v_bfe_u32 v24, v0, 2, 2
  v_lshl_add_u32 v29, v26, 3, v24
  v_mul_u32_u24 v25, 384, v29
  v_and_b32 v27, 1, v0
  v_lshl_add_u32 v25, v27, 3, v25
  v_add_u32 v25, 36864, v25
  v_lshrrev_b32 v24, 1, v29
  v_and_b32 v24, 4, v24
  v_and_or_b32 v24, v29, 2, v24
  v_bfe_u32 v26, v0, 1, 1
  s_mul_i32 s4, s20, 3
  s_add_u32 s3, s4, 0
  s_and_b32 s5, s3, 3
  s_lshl_b32 s5, s5, 1
  s_lshr_b32 s3, s3, 2
  s_lshl_b32 s3, s3, 7
  v_add_u32 v27, s5, v26
  v_xor_b32 v27, v27, v24
  v_lshl_add_u32 v27, v27, 4, v25
  v_add_u32 v14, s3, v27
  v_add_u32 v17, 61440, v14
  s_add_u32 s3, s4, 1
  s_and_b32 s5, s3, 3
  s_lshl_b32 s5, s5, 1
  s_lshr_b32 s3, s3, 2
  s_lshl_b32 s3, s3, 7
  v_add_u32 v27, s5, v26
  v_xor_b32 v27, v27, v24
  v_lshl_add_u32 v27, v27, 4, v25
  v_add_u32 v15, s3, v27
  v_add_u32 v18, 61440, v15
  s_add_u32 s3, s4, 2
  s_and_b32 s5, s3, 3
  s_lshl_b32 s5, s5, 1
  s_lshr_b32 s3, s3, 2
  s_lshl_b32 s3, s3, 7
  v_add_u32 v27, s5, v26
  v_xor_b32 v27, v27, v24
  v_lshl_add_u32 v27, v27, 4, v25
  v_add_u32 v16, s3, v27
  v_add_u32 v19, 61440, v16
  s_waitcnt vmcnt(37)
  s_barrier
  ds_read_b64_tr_b16 a[140:141], v14 offset:28672
  ds_read_b64_tr_b16 a[142:143], v14 offset:30208
  ds_read_b64_tr_b16 a[148:149], v15 offset:28672
  ds_read_b64_tr_b16 a[150:151], v15 offset:30208
  ds_read_b64_tr_b16 a[156:157], v16 offset:28672
  ds_read_b64_tr_b16 a[158:159], v16 offset:30208
  ds_read_b64_tr_b16 a[144:145], v14 offset:40960
  ds_read_b64_tr_b16 a[146:147], v14 offset:42496
  ds_read_b64_tr_b16 a[152:153], v15 offset:40960
  ds_read_b64_tr_b16 a[154:155], v15 offset:42496
  ds_read_b64_tr_b16 a[160:161], v16 offset:40960
  ds_read_b64_tr_b16 a[162:163], v16 offset:42496
  ds_read_b128 a[188:191], v12 offset:0
  ds_read_b128 a[192:195], v13 offset:0
  ds_read_b128 a[196:199], v12 offset:2048
  ds_read_b128 a[200:203], v13 offset:2048
  ds_read_b128 a[204:207], v12 offset:4096
  ds_read_b128 a[208:211], v13 offset:4096
  s_waitcnt lgkmcnt(0)
  s_barrier
  v_mfma_f32_16x16x32_bf16 a[32:35], a[140:143], a[188:191], 0
  ds_read_b128 a[212:215], v12 offset:6144
  ds_read_b128 a[216:219], v13 offset:6144
  v_mfma_f32_16x16x32_bf16 a[32:35], a[144:147], a[192:195], a[32:35]
  s_add_u32 m0, s30, 36864
  s_nop 0
  buffer_load_dwordx4 v6, s[12:15], s25 offen offset:0 lds
  v_mfma_f32_16x16x32_bf16 a[36:39], a[152:155], a[192:195], 0
  ds_read_b64_tr_b16 a[164:165], v17 offset:0
  ds_read_b64_tr_b16 a[166:167], v17 offset:1536
  v_mfma_f32_16x16x32_bf16 a[36:39], a[148:151], a[188:191], a[36:39]
  buffer_load_dwordx4 v7, s[12:15], s25 offen offset:1024 lds
  v_mfma_f32_16x16x32_bf16 a[40:43], a[156:159], a[188:191], 0
  v_mfma_f32_16x16x32_bf16 a[40:43], a[160:163], a[192:195], a[40:43]
  buffer_load_dwordx4 v8, s[12:15], s25 offen offset:2048 lds
  v_mfma_f32_16x16x32_bf16 a[44:47], a[144:147], a[200:203], 0
  ds_read_b128 a[220:223], v12 offset:8192
  ds_read_b128 a[224:227], v13 offset:8192
  v_mfma_f32_16x16x32_bf16 a[44:47], a[140:143], a[196:199], a[44:47]
  v_mfma_f32_16x16x32_bf16 a[48:51], a[148:151], a[196:199], 0
  ds_read_b64_tr_b16 a[172:173], v18 offset:0
  ds_read_b64_tr_b16 a[174:175], v18 offset:1536
  v_mfma_f32_16x16x32_bf16 a[48:51], a[152:155], a[200:203], a[48:51]
  buffer_load_dwordx4 v9, s[12:15], s25 offen offset:3072 lds
  v_mfma_f32_16x16x32_bf16 a[52:55], a[160:163], a[200:203], 0
  v_mfma_f32_16x16x32_bf16 a[52:55], a[156:159], a[196:199], a[52:55]
  s_add_u32 m0, s30, 40960
  s_nop 0
  buffer_load_dwordx4 v21, s[12:15], s25 offen offset:0 lds
  v_mfma_f32_16x16x32_bf16 a[56:59], a[140:143], a[204:207], 0
  ds_read_b128 a[228:231], v12 offset:10240
  ds_read_b128 a[232:235], v13 offset:10240
  v_mfma_f32_16x16x32_bf16 a[56:59], a[144:147], a[208:211], a[56:59]
  v_mfma_f32_16x16x32_bf16 a[60:63], a[152:155], a[208:211], 0
  ds_read_b64_tr_b16 a[180:181], v19 offset:0
  ds_read_b64_tr_b16 a[182:183], v19 offset:1536
  v_mfma_f32_16x16x32_bf16 a[60:63], a[148:151], a[204:207], a[60:63]
  buffer_load_dwordx4 v22, s[12:15], s25 offen offset:1024 lds
  v_mfma_f32_16x16x32_bf16 a[64:67], a[156:159], a[204:207], 0
  v_mfma_f32_16x16x32_bf16 a[64:67], a[160:163], a[208:211], a[64:67]
  s_add_u32 s25, s25, 393216
  s_waitcnt lgkmcnt(10)
  v_mfma_f32_16x16x32_bf16 a[68:71], a[144:147], a[216:219], 0
  ds_read_b128 a[188:191], v12 offset:12288
  ds_read_b128 a[192:195], v13 offset:12288
  v_mfma_f32_16x16x32_bf16 a[68:71], a[140:143], a[212:215], a[68:71]
  v_mfma_f32_16x16x32_bf16 a[72:75], a[148:151], a[212:215], 0
  ds_read_b64_tr_b16 a[168:169], v17 offset:12288
  ds_read_b64_tr_b16 a[170:171], v17 offset:13824
  v_mfma_f32_16x16x32_bf16 a[72:75], a[152:155], a[216:219], a[72:75]
  s_add_u32 m0, s30, 65536
  s_nop 0
  buffer_load_dwordx4 v6, s[12:15], s25 offen offset:0 lds
  v_mfma_f32_16x16x32_bf16 a[76:79], a[160:163], a[216:219], 0
  v_mfma_f32_16x16x32_bf16 a[76:79], a[156:159], a[212:215], a[76:79]
  buffer_load_dwordx4 v7, s[12:15], s25 offen offset:1024 lds
  s_waitcnt lgkmcnt(10)
  v_mfma_f32_16x16x32_bf16 a[80:83], a[140:143], a[220:223], 0
  ds_read_b128 a[196:199], v12 offset:14336
  ds_read_b128 a[200:203], v13 offset:14336
  v_mfma_f32_16x16x32_bf16 a[80:83], a[144:147], a[224:227], a[80:83]
  v_mfma_f32_16x16x32_bf16 a[84:87], a[152:155], a[224:227], 0
  ds_read_b64_tr_b16 a[176:177], v18 offset:12288
  ds_read_b64_tr_b16 a[178:179], v18 offset:13824
  v_mfma_f32_16x16x32_bf16 a[84:87], a[148:151], a[220:223], a[84:87]
  buffer_load_dwordx4 v8, s[12:15], s25 offen offset:2048 lds
  v_mfma_f32_16x16x32_bf16 a[88:91], a[156:159], a[220:223], 0
  v_mfma_f32_16x16x32_bf16 a[88:91], a[160:163], a[224:227], a[88:91]
  buffer_load_dwordx4 v9, s[12:15], s25 offen offset:3072 lds
  s_waitcnt lgkmcnt(10)
  v_mfma_f32_16x16x32_bf16 a[92:95], a[144:147], a[232:235], 0
  ds_read_b128 a[204:207], v12 offset:16384
  ds_read_b128 a[208:211], v13 offset:16384
  v_mfma_f32_16x16x32_bf16 a[92:95], a[140:143], a[228:231], a[92:95]
  v_mfma_f32_16x16x32_bf16 a[96:99], a[148:151], a[228:231], 0
  ds_read_b64_tr_b16 a[184:185], v19 offset:12288
  ds_read_b64_tr_b16 a[186:187], v19 offset:13824
  v_mfma_f32_16x16x32_bf16 a[96:99], a[152:155], a[232:235], a[96:99]
  s_add_u32 m0, s30, 69632
  s_nop 0
  buffer_load_dwordx4 v21, s[12:15], s25 offen offset:0 lds
  v_mfma_f32_16x16x32_bf16 a[100:103], a[160:163], a[232:235], 0
  v_mfma_f32_16x16x32_bf16 a[100:103], a[156:159], a[228:231], a[100:103]
  buffer_load_dwordx4 v22, s[12:15], s25 offen offset:1024 lds
  s_waitcnt lgkmcnt(10)
  v_mfma_f32_16x16x32_bf16 a[104:107], a[140:143], a[188:191], 0
  v_mfma_f32_16x16x32_bf16 a[104:107], a[144:147], a[192:195], a[104:107]
  s_add_u32 s25, s25, 393216
  v_mfma_f32_16x16x32_bf16 a[108:111], a[152:155], a[192:195], 0
  v_mfma_f32_16x16x32_bf16 a[108:111], a[148:151], a[188:191], a[108:111]
  v_mfma_f32_16x16x32_bf16 a[112:115], a[156:159], a[188:191], 0
  s_waitcnt vmcnt(6) lgkmcnt(0)
  s_barrier
  ds_read_b128 a[212:215], v10 offset:0
  ds_read_b128 a[216:219], v11 offset:0
  v_mfma_f32_16x16x32_bf16 a[112:115], a[160:163], a[192:195], a[112:115]
  s_add_u32 m0, s28, 131072
  s_mov_b32 exec_hi, 0
  buffer_load_dwordx4 v20, s[8:11], s24 offen lds
  s_mov_b32 exec_hi, -1
  v_mfma_f32_16x16x32_bf16 a[116:119], a[144:147], a[200:203], 0
  ds_read_b128 a[220:223], v10 offset:2048
  ds_read_b128 a[224:227], v11 offset:2048
  v_mfma_f32_16x16x32_bf16 a[116:119], a[140:143], a[196:199], a[116:119]
  v_mfma_f32_16x16x32_bf16 a[120:123], a[148:151], a[196:199], 0
  s_add_u32 m0, s29, 133120
  s_nop 0
  buffer_load_dwordx4 v2, s[8:11], s23 offen offset:0 lds
  v_mfma_f32_16x16x32_bf16 a[120:123], a[152:155], a[200:203], a[120:123]
  v_mfma_f32_16x16x32_bf16 a[124:127], a[160:163], a[200:203], 0
  v_mfma_f32_16x16x32_bf16 a[124:127], a[156:159], a[196:199], a[124:127]
  buffer_load_dwordx4 v3, s[8:11], s23 offen offset:1024 lds
  v_mfma_f32_16x16x32_bf16 a[128:131], a[140:143], a[204:207], 0
  ds_read_b128 a[228:231], v10 offset:4096
  ds_read_b128 a[232:235], v11 offset:4096
  v_mfma_f32_16x16x32_bf16 a[128:131], a[144:147], a[208:211], a[128:131]
  v_mfma_f32_16x16x32_bf16 a[132:135], a[152:155], a[208:211], 0
  v_mfma_f32_16x16x32_bf16 a[132:135], a[148:151], a[204:207], a[132:135]
  buffer_load_dwordx4 v4, s[8:11], s23 offen offset:2048 lds
  v_mfma_f32_16x16x32_bf16 a[136:139], a[156:159], a[204:207], 0
  v_mfma_f32_16x16x32_bf16 a[136:139], a[160:163], a[208:211], a[136:139]
  s_waitcnt lgkmcnt(4)
  v_mfma_f32_16x16x32_bf16 a[32:35], a[164:167], a[212:215], a[32:35]
  ds_read_b128 a[188:191], v10 offset:6144
  ds_read_b128 a[192:195], v11 offset:6144
  v_mfma_f32_16x16x32_bf16 a[32:35], a[168:171], a[216:219], a[32:35]
  buffer_load_dwordx4 v5, s[8:11], s23 offen offset:3072 lds
  v_mfma_f32_16x16x32_bf16 a[36:39], a[176:179], a[216:219], a[36:39]
  ds_read_b64_tr_b16 a[140:141], v14 offset:0
  ds_read_b64_tr_b16 a[142:143], v14 offset:1536
  v_mfma_f32_16x16x32_bf16 a[36:39], a[172:175], a[212:215], a[36:39]
  v_mfma_f32_16x16x32_bf16 a[40:43], a[180:183], a[212:215], a[40:43]
  v_mfma_f32_16x16x32_bf16 a[40:43], a[184:187], a[216:219], a[40:43]
  s_add_u32 s23, s23, 128
  s_add_u32 s24, s24, 128
  s_waitcnt lgkmcnt(6)
  v_mfma_f32_16x16x32_bf16 a[44:47], a[168:171], a[224:227], a[44:47]
  ds_read_b128 a[196:199], v10 offset:8192
  ds_read_b128 a[200:203], v11 offset:8192
  v_mfma_f32_16x16x32_bf16 a[44:47], a[164:167], a[220:223], a[44:47]
  v_mfma_f32_16x16x32_bf16 a[48:51], a[172:175], a[220:223], a[48:51]
  ds_read_b64_tr_b16 a[148:149], v15 offset:0
  ds_read_b64_tr_b16 a[150:151], v15 offset:1536
  v_mfma_f32_16x16x32_bf16 a[48:51], a[176:179], a[224:227], a[48:51]
  v_mfma_f32_16x16x32_bf16 a[52:55], a[184:187], a[224:227], a[52:55]
  s_add_u32 m0, s30, 98304
  s_nop 0
  buffer_load_dwordx4 v6, s[12:15], s25 offen offset:0 lds
  v_mfma_f32_16x16x32_bf16 a[52:55], a[180:183], a[220:223], a[52:55]
  s_waitcnt lgkmcnt(8)
  v_mfma_f32_16x16x32_bf16 a[56:59], a[164:167], a[228:231], a[56:59]
  ds_read_b128 a[204:207], v10 offset:10240
  ds_read_b128 a[208:211], v11 offset:10240
  v_mfma_f32_16x16x32_bf16 a[56:59], a[168:171], a[232:235], a[56:59]
  v_mfma_f32_16x16x32_bf16 a[60:63], a[176:179], a[232:235], a[60:63]
  ds_read_b64_tr_b16 a[156:157], v16 offset:0
  ds_read_b64_tr_b16 a[158:159], v16 offset:1536
  v_mfma_f32_16x16x32_bf16 a[60:63], a[172:175], a[228:231], a[60:63]
  buffer_load_dwordx4 v7, s[12:15], s25 offen offset:1024 lds
  v_mfma_f32_16x16x32_bf16 a[64:67], a[180:183], a[228:231], a[64:67]
  v_mfma_f32_16x16x32_bf16 a[64:67], a[184:187], a[232:235], a[64:67]
  s_waitcnt lgkmcnt(10)
  v_mfma_f32_16x16x32_bf16 a[68:71], a[168:171], a[192:195], a[68:71]
  ds_read_b128 a[212:215], v10 offset:12288
  ds_read_b128 a[216:219], v11 offset:12288
  v_mfma_f32_16x16x32_bf16 a[68:71], a[164:167], a[188:191], a[68:71]
  buffer_load_dwordx4 v8, s[12:15], s25 offen offset:2048 lds
  v_mfma_f32_16x16x32_bf16 a[72:75], a[172:175], a[188:191], a[72:75]
  ds_read_b64_tr_b16 a[144:145], v14 offset:12288
  ds_read_b64_tr_b16 a[146:147], v14 offset:13824
  v_mfma_f32_16x16x32_bf16 a[72:75], a[176:179], a[192:195], a[72:75]
  v_mfma_f32_16x16x32_bf16 a[76:79], a[184:187], a[192:195], a[76:79]
  v_mfma_f32_16x16x32_bf16 a[76:79], a[180:183], a[188:191], a[76:79]
  buffer_load_dwordx4 v9, s[12:15], s25 offen offset:3072 lds
  s_waitcnt lgkmcnt(10)
  v_mfma_f32_16x16x32_bf16 a[80:83], a[164:167], a[196:199], a[80:83]
  ds_read_b128 a[220:223], v10 offset:14336
  ds_read_b128 a[224:227], v11 offset:14336
  v_mfma_f32_16x16x32_bf16 a[80:83], a[168:171], a[200:203], a[80:83]
  v_mfma_f32_16x16x32_bf16 a[84:87], a[176:179], a[200:203], a[84:87]
  ds_read_b64_tr_b16 a[152:153], v15 offset:12288
  ds_read_b64_tr_b16 a[154:155], v15 offset:13824
  v_mfma_f32_16x16x32_bf16 a[84:87], a[172:175], a[196:199], a[84:87]
  v_mfma_f32_16x16x32_bf16 a[88:91], a[180:183], a[196:199], a[88:91]
  s_add_u32 m0, s30, 102400
  s_nop 0
  buffer_load_dwordx4 v21, s[12:15], s25 offen offset:0 lds
  v_mfma_f32_16x16x32_bf16 a[88:91], a[184:187], a[200:203], a[88:91]
  s_waitcnt lgkmcnt(10)
  v_mfma_f32_16x16x32_bf16 a[92:95], a[168:171], a[208:211], a[92:95]
  ds_read_b128 a[228:231], v10 offset:16384
  ds_read_b128 a[232:235], v11 offset:16384
  v_mfma_f32_16x16x32_bf16 a[92:95], a[164:167], a[204:207], a[92:95]
  v_mfma_f32_16x16x32_bf16 a[96:99], a[172:175], a[204:207], a[96:99]
  ds_read_b64_tr_b16 a[160:161], v16 offset:12288
  ds_read_b64_tr_b16 a[162:163], v16 offset:13824
  v_mfma_f32_16x16x32_bf16 a[96:99], a[176:179], a[208:211], a[96:99]
  buffer_load_dwordx4 v22, s[12:15], s25 offen offset:1024 lds
  v_mfma_f32_16x16x32_bf16 a[100:103], a[184:187], a[208:211], a[100:103]
  v_mfma_f32_16x16x32_bf16 a[100:103], a[180:183], a[204:207], a[100:103]
  s_waitcnt lgkmcnt(10)
  v_mfma_f32_16x16x32_bf16 a[104:107], a[164:167], a[212:215], a[104:107]
  s_add_u32 s25, s25, 393216
  v_mfma_f32_16x16x32_bf16 a[104:107], a[168:171], a[216:219], a[104:107]
  v_mfma_f32_16x16x32_bf16 a[108:111], a[176:179], a[216:219], a[108:111]
  v_mfma_f32_16x16x32_bf16 a[108:111], a[172:175], a[212:215], a[108:111]
  v_mfma_f32_16x16x32_bf16 a[112:115], a[180:183], a[212:215], a[112:115]
  s_waitcnt vmcnt(11) lgkmcnt(0)
  s_barrier
  ds_read_b128 a[188:191], v10 offset:18432
  ds_read_b128 a[192:195], v11 offset:18432
  v_mfma_f32_16x16x32_bf16 a[112:115], a[184:187], a[216:219], a[112:115]
  s_add_u32 m0, s28, 0
  s_mov_b32 exec_hi, 0
  buffer_load_dwordx4 v20, s[8:11], s24 offen lds
  s_mov_b32 exec_hi, -1
  v_mfma_f32_16x16x32_bf16 a[116:119], a[168:171], a[224:227], a[116:119]
  ds_read_b128 a[196:199], v10 offset:20480
  ds_read_b128 a[200:203], v11 offset:20480
  v_mfma_f32_16x16x32_bf16 a[116:119], a[164:167], a[220:223], a[116:119]
  v_mfma_f32_16x16x32_bf16 a[120:123], a[172:175], a[220:223], a[120:123]
  s_add_u32 m0, s29, 2048
  s_nop 0
  buffer_load_dwordx4 v2, s[8:11], s23 offen offset:0 lds
  v_mfma_f32_16x16x32_bf16 a[120:123], a[176:179], a[224:227], a[120:123]
  v_mfma_f32_16x16x32_bf16 a[124:127], a[184:187], a[224:227], a[124:127]
  v_mfma_f32_16x16x32_bf16 a[124:127], a[180:183], a[220:223], a[124:127]
  buffer_load_dwordx4 v3, s[8:11], s23 offen offset:1024 lds
  v_mfma_f32_16x16x32_bf16 a[128:131], a[164:167], a[228:231], a[128:131]
  ds_read_b128 a[204:207], v10 offset:22528
  ds_read_b128 a[208:211], v11 offset:22528
  v_mfma_f32_16x16x32_bf16 a[128:131], a[168:171], a[232:235], a[128:131]
  v_mfma_f32_16x16x32_bf16 a[132:135], a[176:179], a[232:235], a[132:135]
  v_mfma_f32_16x16x32_bf16 a[132:135], a[172:175], a[228:231], a[132:135]
  buffer_load_dwordx4 v4, s[8:11], s23 offen offset:2048 lds
  v_mfma_f32_16x16x32_bf16 a[136:139], a[180:183], a[228:231], a[136:139]
  v_mfma_f32_16x16x32_bf16 a[136:139], a[184:187], a[232:235], a[136:139]
  s_waitcnt lgkmcnt(4)
  v_mfma_f32_16x16x32_bf16 a[32:35], a[140:143], a[188:191], a[32:35]
  ds_read_b128 a[212:215], v10 offset:24576
  ds_read_b128 a[216:219], v11 offset:24576
  v_mfma_f32_16x16x32_bf16 a[32:35], a[144:147], a[192:195], a[32:35]
  buffer_load_dwordx4 v5, s[8:11], s23 offen offset:3072 lds
  v_mfma_f32_16x16x32_bf16 a[36:39], a[152:155], a[192:195], a[36:39]
  ds_read_b64_tr_b16 a[164:165], v14 offset:28672
  ds_read_b64_tr_b16 a[166:167], v14 offset:30208
  v_mfma_f32_16x16x32_bf16 a[36:39], a[148:151], a[188:191], a[36:39]
  v_mfma_f32_16x16x32_bf16 a[40:43], a[156:159], a[188:191], a[40:43]
  v_mfma_f32_16x16x32_bf16 a[40:43], a[160:163], a[192:195], a[40:43]
  s_add_u32 s23, s23, 128
  s_add_u32 s24, s24, 128
  s_waitcnt lgkmcnt(6)
  v_mfma_f32_16x16x32_bf16 a[44:47], a[144:147], a[200:203], a[44:47]
  ds_read_b128 a[220:223], v10 offset:26624
  ds_read_b128 a[224:227], v11 offset:26624
  v_mfma_f32_16x16x32_bf16 a[44:47], a[140:143], a[196:199], a[44:47]
  v_mfma_f32_16x16x32_bf16 a[48:51], a[148:151], a[196:199], a[48:51]
  ds_read_b64_tr_b16 a[172:173], v15 offset:28672
  ds_read_b64_tr_b16 a[174:175], v15 offset:30208
  v_mfma_f32_16x16x32_bf16 a[48:51], a[152:155], a[200:203], a[48:51]
  v_mfma_f32_16x16x32_bf16 a[52:55], a[160:163], a[200:203], a[52:55]
  s_add_u32 m0, s30, 36864
  s_nop 0
  buffer_load_dwordx4 v6, s[12:15], s25 offen offset:0 lds
  v_mfma_f32_16x16x32_bf16 a[52:55], a[156:159], a[196:199], a[52:55]
  s_waitcnt lgkmcnt(8)
  v_mfma_f32_16x16x32_bf16 a[56:59], a[140:143], a[204:207], a[56:59]
  ds_read_b128 a[228:231], v10 offset:28672
  ds_read_b128 a[232:235], v11 offset:28672
  v_mfma_f32_16x16x32_bf16 a[56:59], a[144:147], a[208:211], a[56:59]
  v_mfma_f32_16x16x32_bf16 a[60:63], a[152:155], a[208:211], a[60:63]
  ds_read_b64_tr_b16 a[180:181], v16 offset:28672
  ds_read_b64_tr_b16 a[182:183], v16 offset:30208
  v_mfma_f32_16x16x32_bf16 a[60:63], a[148:151], a[204:207], a[60:63]
  buffer_load_dwordx4 v7, s[12:15], s25 offen offset:1024 lds
  v_mfma_f32_16x16x32_bf16 a[64:67], a[156:159], a[204:207], a[64:67]
  v_mfma_f32_16x16x32_bf16 a[64:67], a[160:163], a[208:211], a[64:67]
  s_waitcnt lgkmcnt(10)
  v_mfma_f32_16x16x32_bf16 a[68:71], a[144:147], a[216:219], a[68:71]
  ds_read_b128 a[188:191], v10 offset:30720
  ds_read_b128 a[192:195], v11 offset:30720
  v_mfma_f32_16x16x32_bf16 a[68:71], a[140:143], a[212:215], a[68:71]
  buffer_load_dwordx4 v8, s[12:15], s25 offen offset:2048 lds
  v_mfma_f32_16x16x32_bf16 a[72:75], a[148:151], a[212:215], a[72:75]
  ds_read_b64_tr_b16 a[168:169], v14 offset:40960
  ds_read_b64_tr_b16 a[170:171], v14 offset:42496
  v_mfma_f32_16x16x32_bf16 a[72:75], a[152:155], a[216:219], a[72:75]
  v_mfma_f32_16x16x32_bf16 a[76:79], a[160:163], a[216:219], a[76:79]
  v_mfma_f32_16x16x32_bf16 a[76:79], a[156:159], a[212:215], a[76:79]
  buffer_load_dwordx4 v9, s[12:15], s25 offen offset:3072 lds
  s_waitcnt lgkmcnt(10)
  v_mfma_f32_16x16x32_bf16 a[80:83], a[140:143], a[220:223], a[80:83]
  ds_read_b128 a[196:199], v10 offset:32768
  ds_read_b128 a[200:203], v11 offset:32768
  v_mfma_f32_16x16x32_bf16 a[80:83], a[144:147], a[224:227], a[80:83]
  v_mfma_f32_16x16x32_bf16 a[84:87], a[152:155], a[224:227], a[84:87]
  ds_read_b64_tr_b16 a[176:177], v15 offset:40960
  ds_read_b64_tr_b16 a[178:179], v15 offset:42496
  v_mfma_f32_16x16x32_bf16 a[84:87], a[148:151], a[220:223], a[84:87]
  v_mfma_f32_16x16x32_bf16 a[88:91], a[156:159], a[220:223], a[88:91]
  s_add_u32 m0, s30, 40960
  s_nop 0
  buffer_load_dwordx4 v21, s[12:15], s25 offen offset:0 lds
  v_mfma_f32_16x16x32_bf16 a[88:91], a[160:163], a[224:227], a[88:91]
  s_waitcnt lgkmcnt(10)
  v_mfma_f32_16x16x32_bf16 a[92:95], a[144:147], a[232:235], a[92:95]
  ds_read_b128 a[204:207], v10 offset:34816
  ds_read_b128 a[208:211], v11 offset:34816
  v_mfma_f32_16x16x32_bf16 a[92:95], a[140:143], a[228:231], a[92:95]
  v_mfma_f32_16x16x32_bf16 a[96:99], a[148:151], a[228:231], a[96:99]
  ds_read_b64_tr_b16 a[184:185], v16 offset:40960
  ds_read_b64_tr_b16 a[186:187], v16 offset:42496
  v_mfma_f32_16x16x32_bf16 a[96:99], a[152:155], a[232:235], a[96:99]
  buffer_load_dwordx4 v22, s[12:15], s25 offen offset:1024 lds
  v_mfma_f32_16x16x32_bf16 a[100:103], a[160:163], a[232:235], a[100:103]
  v_mfma_f32_16x16x32_bf16 a[100:103], a[156:159], a[228:231], a[100:103]
  s_waitcnt lgkmcnt(10)
  v_mfma_f32_16x16x32_bf16 a[104:107], a[140:143], a[188:191], a[104:107]
  s_add_u32 s25, s25, 393216
  v_mfma_f32_16x16x32_bf16 a[104:107], a[144:147], a[192:195], a[104:107]
  v_mfma_f32_16x16x32_bf16 a[108:111], a[152:155], a[192:195], a[108:111]
  v_mfma_f32_16x16x32_bf16 a[108:111], a[148:151], a[188:191], a[108:111]
  v_mfma_f32_16x16x32_bf16 a[112:115], a[156:159], a[188:191], a[112:115]
  s_waitcnt vmcnt(11) lgkmcnt(0)
  s_barrier
  ds_read_b128 a[212:215], v12 offset:0
  ds_read_b128 a[216:219], v13 offset:0
  v_mfma_f32_16x16x32_bf16 a[112:115], a[160:163], a[192:195], a[112:115]
  s_add_u32 m0, s28, 18432
  s_mov_b32 exec_hi, 0
  buffer_load_dwordx4 v20, s[8:11], s24 offen lds
  s_mov_b32 exec_hi, -1
  v_mfma_f32_16x16x32_bf16 a[116:119], a[144:147], a[200:203], a[116:119]
  ds_read_b128 a[220:223], v12 offset:2048
  ds_read_b128 a[224:227], v13 offset:2048
  v_mfma_f32_16x16x32_bf16 a[116:119], a[140:143], a[196:199], a[116:119]
  v_mfma_f32_16x16x32_bf16 a[120:123], a[148:151], a[196:199], a[120:123]
  s_add_u32 m0, s29, 20480
  s_nop 0
  buffer_load_dwordx4 v2, s[8:11], s23 offen offset:0 lds
  v_mfma_f32_16x16x32_bf16 a[120:123], a[152:155], a[200:203], a[120:123]
  v_mfma_f32_16x16x32_bf16 a[124:127], a[160:163], a[200:203], a[124:127]
  v_mfma_f32_16x16x32_bf16 a[124:127], a[156:159], a[196:199], a[124:127]
  buffer_load_dwordx4 v3, s[8:11], s23 offen offset:1024 lds
  v_mfma_f32_16x16x32_bf16 a[128:131], a[140:143], a[204:207], a[128:131]
  ds_read_b128 a[228:231], v12 offset:4096
  ds_read_b128 a[232:235], v13 offset:4096
  v_mfma_f32_16x16x32_bf16 a[128:131], a[144:147], a[208:211], a[128:131]
  v_mfma_f32_16x16x32_bf16 a[132:135], a[152:155], a[208:211], a[132:135]
  v_mfma_f32_16x16x32_bf16 a[132:135], a[148:151], a[204:207], a[132:135]
  buffer_load_dwordx4 v4, s[8:11], s23 offen offset:2048 lds
  v_mfma_f32_16x16x32_bf16 a[136:139], a[156:159], a[204:207], a[136:139]
  v_mfma_f32_16x16x32_bf16 a[136:139], a[160:163], a[208:211], a[136:139]
  s_waitcnt lgkmcnt(4)
  v_mfma_f32_16x16x32_bf16 a[32:35], a[164:167], a[212:215], a[32:35]
  ds_read_b128 a[188:191], v12 offset:6144
  ds_read_b128 a[192:195], v13 offset:6144
  v_mfma_f32_16x16x32_bf16 a[32:35], a[168:171], a[216:219], a[32:35]
  buffer_load_dwordx4 v5, s[8:11], s23 offen offset:3072 lds
  v_mfma_f32_16x16x32_bf16 a[36:39], a[176:179], a[216:219], a[36:39]
  ds_read_b64_tr_b16 a[140:141], v17 offset:0
  ds_read_b64_tr_b16 a[142:143], v17 offset:1536
  v_mfma_f32_16x16x32_bf16 a[36:39], a[172:175], a[212:215], a[36:39]
  v_mfma_f32_16x16x32_bf16 a[40:43], a[180:183], a[212:215], a[40:43]
  v_mfma_f32_16x16x32_bf16 a[40:43], a[184:187], a[216:219], a[40:43]
  s_add_u32 s23, s23, 128
  s_add_u32 s24, s24, 128
  s_waitcnt lgkmcnt(6)
  v_mfma_f32_16x16x32_bf16 a[44:47], a[168:171], a[224:227], a[44:47]
  ds_read_b128 a[196:199], v12 offset:8192
  ds_read_b128 a[200:203], v13 offset:8192
  v_mfma_f32_16x16x32_bf16 a[44:47], a[164:167], a[220:223], a[44:47]
  v_mfma_f32_16x16x32_bf16 a[48:51], a[172:175], a[220:223], a[48:51]
  ds_read_b64_tr_b16 a[148:149], v18 offset:0
  ds_read_b64_tr_b16 a[150:151], v18 offset:1536
  v_mfma_f32_16x16x32_bf16 a[48:51], a[176:179], a[224:227], a[48:51]
  v_mfma_f32_16x16x32_bf16 a[52:55], a[184:187], a[224:227], a[52:55]
  s_add_u32 m0, s30, 65536
  s_nop 0
  buffer_load_dwordx4 v6, s[12:15], s25 offen offset:0 lds
  v_mfma_f32_16x16x32_bf16 a[52:55], a[180:183], a[220:223], a[52:55]
  s_waitcnt lgkmcnt(8)
  v_mfma_f32_16x16x32_bf16 a[56:59], a[164:167], a[228:231], a[56:59]
  ds_read_b128 a[204:207], v12 offset:10240
  ds_read_b128 a[208:211], v13 offset:10240
  v_mfma_f32_16x16x32_bf16 a[56:59], a[168:171], a[232:235], a[56:59]
  v_mfma_f32_16x16x32_bf16 a[60:63], a[176:179], a[232:235], a[60:63]
  ds_read_b64_tr_b16 a[156:157], v19 offset:0
  ds_read_b64_tr_b16 a[158:159], v19 offset:1536
  v_mfma_f32_16x16x32_bf16 a[60:63], a[172:175], a[228:231], a[60:63]
  buffer_load_dwordx4 v7, s[12:15], s25 offen offset:1024 lds
  v_mfma_f32_16x16x32_bf16 a[64:67], a[180:183], a[228:231], a[64:67]
  v_mfma_f32_16x16x32_bf16 a[64:67], a[184:187], a[232:235], a[64:67]
  s_waitcnt lgkmcnt(10)
  v_mfma_f32_16x16x32_bf16 a[68:71], a[168:171], a[192:195], a[68:71]
  ds_read_b128 a[212:215], v12 offset:12288
  ds_read_b128 a[216:219], v13 offset:12288
  v_mfma_f32_16x16x32_bf16 a[68:71], a[164:167], a[188:191], a[68:71]
  buffer_load_dwordx4 v8, s[12:15], s25 offen offset:2048 lds
  v_mfma_f32_16x16x32_bf16 a[72:75], a[172:175], a[188:191], a[72:75]
  ds_read_b64_tr_b16 a[144:145], v17 offset:12288
  ds_read_b64_tr_b16 a[146:147], v17 offset:13824
  v_mfma_f32_16x16x32_bf16 a[72:75], a[176:179], a[192:195], a[72:75]
  v_mfma_f32_16x16x32_bf16 a[76:79], a[184:187], a[192:195], a[76:79]
  v_mfma_f32_16x16x32_bf16 a[76:79], a[180:183], a[188:191], a[76:79]
  buffer_load_dwordx4 v9, s[12:15], s25 offen offset:3072 lds
  s_waitcnt lgkmcnt(10)
  v_mfma_f32_16x16x32_bf16 a[80:83], a[164:167], a[196:199], a[80:83]
  ds_read_b128 a[220:223], v12 offset:14336
  ds_read_b128 a[224:227], v13 offset:14336
  v_mfma_f32_16x16x32_bf16 a[80:83], a[168:171], a[200:203], a[80:83]
  v_mfma_f32_16x16x32_bf16 a[84:87], a[176:179], a[200:203], a[84:87]
  ds_read_b64_tr_b16 a[152:153], v18 offset:12288
  ds_read_b64_tr_b16 a[154:155], v18 offset:13824
  v_mfma_f32_16x16x32_bf16 a[84:87], a[172:175], a[196:199], a[84:87]
  v_mfma_f32_16x16x32_bf16 a[88:91], a[180:183], a[196:199], a[88:91]
  s_add_u32 m0, s30, 69632
  s_nop 0
  buffer_load_dwordx4 v21, s[12:15], s25 offen offset:0 lds
  v_mfma_f32_16x16x32_bf16 a[88:91], a[184:187], a[200:203], a[88:91]
  s_waitcnt lgkmcnt(10)
  v_mfma_f32_16x16x32_bf16 a[92:95], a[168:171], a[208:211], a[92:95]
  ds_read_b128 a[228:231], v12 offset:16384
  ds_read_b128 a[232:235], v13 offset:16384
  v_mfma_f32_16x16x32_bf16 a[92:95], a[164:167], a[204:207], a[92:95]
  v_mfma_f32_16x16x32_bf16 a[96:99], a[172:175], a[204:207], a[96:99]
  ds_read_b64_tr_b16 a[160:161], v19 offset:12288
  ds_read_b64_tr_b16 a[162:163], v19 offset:13824
  v_mfma_f32_16x16x32_bf16 a[96:99], a[176:179], a[208:211], a[96:99]
  buffer_load_dwordx4 v22, s[12:15], s25 offen offset:1024 lds
  v_mfma_f32_16x16x32_bf16 a[100:103], a[184:187], a[208:211], a[100:103]
  v_mfma_f32_16x16x32_bf16 a[100:103], a[180:183], a[204:207], a[100:103]
  s_waitcnt lgkmcnt(10)
  v_mfma_f32_16x16x32_bf16 a[104:107], a[164:167], a[212:215], a[104:107]
  s_add_u32 s25, s25, 393216
  v_mfma_f32_16x16x32_bf16 a[104:107], a[168:171], a[216:219], a[104:107]
  v_mfma_f32_16x16x32_bf16 a[108:111], a[176:179], a[216:219], a[108:111]
  v_mfma_f32_16x16x32_bf16 a[108:111], a[172:175], a[212:215], a[108:111]
  v_mfma_f32_16x16x32_bf16 a[112:115], a[180:183], a[212:215], a[112:115]
  s_waitcnt vmcnt(11) lgkmcnt(0)
  s_barrier
  ds_read_b128 a[188:191], v10 offset:0
  ds_read_b128 a[192:195], v11 offset:0
  v_mfma_f32_16x16x32_bf16 a[112:115], a[184:187], a[216:219], a[112:115]
  s_add_u32 m0, s28, 131072
  s_mov_b32 exec_hi, 0
  buffer_load_dwordx4 v20, s[8:11], s24 offen lds
  s_mov_b32 exec_hi, -1
  v_mfma_f32_16x16x32_bf16 a[116:119], a[168:171], a[224:227], a[116:119]
  ds_read_b128 a[196:199], v10 offset:2048
  ds_read_b128 a[200:203], v11 offset:2048
  v_mfma_f32_16x16x32_bf16 a[116:119], a[164:167], a[220:223], a[116:119]
  v_mfma_f32_16x16x32_bf16 a[120:123], a[172:175], a[220:223], a[120:123]
  s_add_u32 m0, s29, 133120
  s_nop 0
  buffer_load_dwordx4 v2, s[8:11], s23 offen offset:0 lds
  v_mfma_f32_16x16x32_bf16 a[120:123], a[176:179], a[224:227], a[120:123]
  v_mfma_f32_16x16x32_bf16 a[124:127], a[184:187], a[224:227], a[124:127]
  v_mfma_f32_16x16x32_bf16 a[124:127], a[180:183], a[220:223], a[124:127]
  buffer_load_dwordx4 v3, s[8:11], s23 offen offset:1024 lds
  v_mfma_f32_16x16x32_bf16 a[128:131], a[164:167], a[228:231], a[128:131]
  ds_read_b128 a[204:207], v10 offset:4096
  ds_read_b128 a[208:211], v11 offset:4096
  v_mfma_f32_16x16x32_bf16 a[128:131], a[168:171], a[232:235], a[128:131]
  v_mfma_f32_16x16x32_bf16 a[132:135], a[176:179], a[232:235], a[132:135]
  v_mfma_f32_16x16x32_bf16 a[132:135], a[172:175], a[228:231], a[132:135]
  buffer_load_dwordx4 v4, s[8:11], s23 offen offset:2048 lds
  v_mfma_f32_16x16x32_bf16 a[136:139], a[180:183], a[228:231], a[136:139]
  v_mfma_f32_16x16x32_bf16 a[136:139], a[184:187], a[232:235], a[136:139]
  s_waitcnt lgkmcnt(4)
  v_mfma_f32_16x16x32_bf16 a[32:35], a[140:143], a[188:191], a[32:35]
  ds_read_b128 a[212:215], v10 offset:6144
  ds_read_b128 a[216:219], v11 offset:6144
  v_mfma_f32_16x16x32_bf16 a[32:35], a[144:147], a[192:195], a[32:35]
  buffer_load_dwordx4 v5, s[8:11], s23 offen offset:3072 lds
  v_mfma_f32_16x16x32_bf16 a[36:39], a[152:155], a[192:195], a[36:39]
  ds_read_b64_tr_b16 a[164:165], v14 offset:0
  ds_read_b64_tr_b16 a[166:167], v14 offset:1536
  v_mfma_f32_16x16x32_bf16 a[36:39], a[148:151], a[188:191], a[36:39]
  v_mfma_f32_16x16x32_bf16 a[40:43], a[156:159], a[188:191], a[40:43]
  v_mfma_f32_16x16x32_bf16 a[40:43], a[160:163], a[192:195], a[40:43]
  s_add_u32 s23, s23, 128
  s_add_u32 s24, s24, 128
  s_waitcnt lgkmcnt(6)
  v_mfma_f32_16x16x32_bf16 a[44:47], a[144:147], a[200:203], a[44:47]
  ds_read_b128 a[220:223], v10 offset:8192
  ds_read_b128 a[224:227], v11 offset:8192
  v_mfma_f32_16x16x32_bf16 a[44:47], a[140:143], a[196:199], a[44:47]
  v_mfma_f32_16x16x32_bf16 a[48:51], a[148:151], a[196:199], a[48:51]
  ds_read_b64_tr_b16 a[172:173], v15 offset:0
  ds_read_b64_tr_b16 a[174:175], v15 offset:1536
  v_mfma_f32_16x16x32_bf16 a[48:51], a[152:155], a[200:203], a[48:51]
  v_mfma_f32_16x16x32_bf16 a[52:55], a[160:163], a[200:203], a[52:55]
  s_add_u32 m0, s30, 98304
  s_nop 0
  buffer_load_dwordx4 v6, s[12:15], s25 offen offset:0 lds
  v_mfma_f32_16x16x32_bf16 a[52:55], a[156:159], a[196:199], a[52:55]
  s_waitcnt lgkmcnt(8)
  v_mfma_f32_16x16x32_bf16 a[56:59], a[140:143], a[204:207], a[56:59]
  ds_read_b128 a[228:231], v10 offset:10240
  ds_read_b128 a[232:235], v11 offset:10240
  v_mfma_f32_16x16x32_bf16 a[56:59], a[144:147], a[208:211], a[56:59]
  v_mfma_f32_16x16x32_bf16 a[60:63], a[152:155], a[208:211], a[60:63]
  ds_read_b64_tr_b16 a[180:181], v16 offset:0
  ds_read_b64_tr_b16 a[182:183], v16 offset:1536
  v_mfma_f32_16x16x32_bf16 a[60:63], a[148:151], a[204:207], a[60:63]
  buffer_load_dwordx4 v7, s[12:15], s25 offen offset:1024 lds
  v_mfma_f32_16x16x32_bf16 a[64:67], a[156:159], a[204:207], a[64:67]
  v_mfma_f32_16x16x32_bf16 a[64:67], a[160:163], a[208:211], a[64:67]
  s_waitcnt lgkmcnt(10)
  v_mfma_f32_16x16x32_bf16 a[68:71], a[144:147], a[216:219], a[68:71]
  ds_read_b128 a[188:191], v10 offset:12288
  ds_read_b128 a[192:195], v11 offset:12288
  v_mfma_f32_16x16x32_bf16 a[68:71], a[140:143], a[212:215], a[68:71]
  buffer_load_dwordx4 v8, s[12:15], s25 offen offset:2048 lds
  v_mfma_f32_16x16x32_bf16 a[72:75], a[148:151], a[212:215], a[72:75]
  ds_read_b64_tr_b16 a[168:169], v14 offset:12288
  ds_read_b64_tr_b16 a[170:171], v14 offset:13824
  v_mfma_f32_16x16x32_bf16 a[72:75], a[152:155], a[216:219], a[72:75]
  v_mfma_f32_16x16x32_bf16 a[76:79], a[160:163], a[216:219], a[76:79]
  v_mfma_f32_16x16x32_bf16 a[76:79], a[156:159], a[212:215], a[76:79]
  buffer_load_dwordx4 v9, s[12:15], s25 offen offset:3072 lds
  s_waitcnt lgkmcnt(10)
  v_mfma_f32_16x16x32_bf16 a[80:83], a[140:143], a[220:223], a[80:83]
  ds_read_b128 a[196:199], v10 offset:14336
  ds_read_b128 a[200:203], v11 offset:14336
  v_mfma_f32_16x16x32_bf16 a[80:83], a[144:147], a[224:227], a[80:83]
  v_mfma_f32_16x16x32_bf16 a[84:87], a[152:155], a[224:227], a[84:87]
  ds_read_b64_tr_b16 a[176:177], v15 offset:12288
  ds_read_b64_tr_b16 a[178:179], v15 offset:13824
  v_mfma_f32_16x16x32_bf16 a[84:87], a[148:151], a[220:223], a[84:87]
  v_mfma_f32_16x16x32_bf16 a[88:91], a[156:159], a[220:223], a[88:91]
  s_add_u32 m0, s30, 102400
  s_nop 0
  buffer_load_dwordx4 v21, s[12:15], s25 offen offset:0 lds
  v_mfma_f32_16x16x32_bf16 a[88:91], a[160:163], a[224:227], a[88:91]
  s_waitcnt lgkmcnt(10)
  v_mfma_f32_16x16x32_bf16 a[92:95], a[144:147], a[232:235], a[92:95]
  ds_read_b128 a[204:207], v10 offset:16384
  ds_read_b128 a[208:211], v11 offset:16384
  v_mfma_f32_16x16x32_bf16 a[92:95], a[140:143], a[228:231], a[92:95]
  v_mfma_f32_16x16x32_bf16 a[96:99], a[148:151], a[228:231], a[96:99]
  ds_read_b64_tr_b16 a[184:185], v16 offset:12288
  ds_read_b64_tr_b16 a[186:187], v16 offset:13824
  v_mfma_f32_16x16x32_bf16 a[96:99], a[152:155], a[232:235], a[96:99]
  buffer_load_dwordx4 v22, s[12:15], s25 offen offset:1024 lds
  v_mfma_f32_16x16x32_bf16 a[100:103], a[160:163], a[232:235], a[100:103]
  v_mfma_f32_16x16x32_bf16 a[100:103], a[156:159], a[228:231], a[100:103]
  s_waitcnt lgkmcnt(10)
  v_mfma_f32_16x16x32_bf16 a[104:107], a[140:143], a[188:191], a[104:107]
  s_add_u32 s25, s25, 393216
  v_mfma_f32_16x16x32_bf16 a[104:107], a[144:147], a[192:195], a[104:107]
  v_mfma_f32_16x16x32_bf16 a[108:111], a[152:155], a[192:195], a[108:111]
  v_mfma_f32_16x16x32_bf16 a[108:111], a[148:151], a[188:191], a[108:111]
  v_mfma_f32_16x16x32_bf16 a[112:115], a[156:159], a[188:191], a[112:115]
  s_waitcnt vmcnt(11) lgkmcnt(0)
  s_barrier
  ds_read_b128 a[212:215], v10 offset:18432
  ds_read_b128 a[216:219], v11 offset:18432
  v_mfma_f32_16x16x32_bf16 a[112:115], a[160:163], a[192:195], a[112:115]
  s_add_u32 m0, s28, 0
  s_mov_b32 exec_hi, 0
  buffer_load_dwordx4 v20, s[8:11], s24 offen lds
  s_mov_b32 exec_hi, -1
  v_mfma_f32_16x16x32_bf16 a[116:119], a[144:147], a[200:203], a[116:119]
  ds_read_b128 a[220:223], v10 offset:20480
  ds_read_b128 a[224:227], v11 offset:20480
  v_mfma_f32_16x16x32_bf16 a[116:119], a[140:143], a[196:199], a[116:119]
  v_mfma_f32_16x16x32_bf16 a[120:123], a[148:151], a[196:199], a[120:123]
  s_add_u32 m0, s29, 2048
  s_nop 0
  buffer_load_dwordx4 v2, s[8:11], s23 offen offset:0 lds
  v_mfma_f32_16x16x32_bf16 a[120:123], a[152:155], a[200:203], a[120:123]
  v_mfma_f32_16x16x32_bf16 a[124:127], a[160:163], a[200:203], a[124:127]
  v_mfma_f32_16x16x32_bf16 a[124:127], a[156:159], a[196:199], a[124:127]
  buffer_load_dwordx4 v3, s[8:11], s23 offen offset:1024 lds
  v_mfma_f32_16x16x32_bf16 a[128:131], a[140:143], a[204:207], a[128:131]
  ds_read_b128 a[228:231], v10 offset:22528
  ds_read_b128 a[232:235], v11 offset:22528
  v_mfma_f32_16x16x32_bf16 a[128:131], a[144:147], a[208:211], a[128:131]
  v_mfma_f32_16x16x32_bf16 a[132:135], a[152:155], a[208:211], a[132:135]
  v_mfma_f32_16x16x32_bf16 a[132:135], a[148:151], a[204:207], a[132:135]
  buffer_load_dwordx4 v4, s[8:11], s23 offen offset:2048 lds
  v_mfma_f32_16x16x32_bf16 a[136:139], a[156:159], a[204:207], a[136:139]
  v_mfma_f32_16x16x32_bf16 a[136:139], a[160:163], a[208:211], a[136:139]
  s_waitcnt lgkmcnt(4)
  v_mfma_f32_16x16x32_bf16 a[32:35], a[164:167], a[212:215], a[32:35]
  ds_read_b128 a[188:191], v10 offset:24576
  ds_read_b128 a[192:195], v11 offset:24576
  v_mfma_f32_16x16x32_bf16 a[32:35], a[168:171], a[216:219], a[32:35]
  buffer_load_dwordx4 v5, s[8:11], s23 offen offset:3072 lds
  v_mfma_f32_16x16x32_bf16 a[36:39], a[176:179], a[216:219], a[36:39]
  ds_read_b64_tr_b16 a[140:141], v14 offset:28672
  ds_read_b64_tr_b16 a[142:143], v14 offset:30208
  v_mfma_f32_16x16x32_bf16 a[36:39], a[172:175], a[212:215], a[36:39]
  v_mfma_f32_16x16x32_bf16 a[40:43], a[180:183], a[212:215], a[40:43]
  v_mfma_f32_16x16x32_bf16 a[40:43], a[184:187], a[216:219], a[40:43]
  s_add_u32 s23, s23, 128
  s_add_u32 s24, s24, 128
  s_waitcnt lgkmcnt(6)
  v_mfma_f32_16x16x32_bf16 a[44:47], a[168:171], a[224:227], a[44:47]
  ds_read_b128 a[196:199], v10 offset:26624
  ds_read_b128 a[200:203], v11 offset:26624
  v_mfma_f32_16x16x32_bf16 a[44:47], a[164:167], a[220:223], a[44:47]
  v_mfma_f32_16x16x32_bf16 a[48:51], a[172:175], a[220:223], a[48:51]
  ds_read_b64_tr_b16 a[148:149], v15 offset:28672
  ds_read_b64_tr_b16 a[150:151], v15 offset:30208
  v_mfma_f32_16x16x32_bf16 a[48:51], a[176:179], a[224:227], a[48:51]
  v_mfma_f32_16x16x32_bf16 a[52:55], a[184:187], a[224:227], a[52:55]
  s_add_u32 m0, s30, 36864
  s_nop 0
  buffer_load_dwordx4 v6, s[12:15], s25 offen offset:0 lds
  v_mfma_f32_16x16x32_bf16 a[52:55], a[180:183], a[220:223], a[52:55]
  s_waitcnt lgkmcnt(8)
  v_mfma_f32_16x16x32_bf16 a[56:59], a[164:167], a[228:231], a[56:59]
  ds_read_b128 a[204:207], v10 offset:28672
  ds_read_b128 a[208:211], v11 offset:28672
  v_mfma_f32_16x16x32_bf16 a[56:59], a[168:171], a[232:235], a[56:59]
  v_mfma_f32_16x16x32_bf16 a[60:63], a[176:179], a[232:235], a[60:63]
  ds_read_b64_tr_b16 a[156:157], v16 offset:28672
  ds_read_b64_tr_b16 a[158:159], v16 offset:30208
  v_mfma_f32_16x16x32_bf16 a[60:63], a[172:175], a[228:231], a[60:63]
  buffer_load_dwordx4 v7, s[12:15], s25 offen offset:1024 lds
  v_mfma_f32_16x16x32_bf16 a[64:67], a[180:183], a[228:231], a[64:67]
  v_mfma_f32_16x16x32_bf16 a[64:67], a[184:187], a[232:235], a[64:67]
  s_waitcnt lgkmcnt(10)
  v_mfma_f32_16x16x32_bf16 a[68:71], a[168:171], a[192:195], a[68:71]
  ds_read_b128 a[212:215], v10 offset:30720
  ds_read_b128 a[216:219], v11 offset:30720
  v_mfma_f32_16x16x32_bf16 a[68:71], a[164:167], a[188:191], a[68:71]
  buffer_load_dwordx4 v8, s[12:15], s25 offen offset:2048 lds
  v_mfma_f32_16x16x32_bf16 a[72:75], a[172:175], a[188:191], a[72:75]
  ds_read_b64_tr_b16 a[144:145], v14 offset:40960
  ds_read_b64_tr_b16 a[146:147], v14 offset:42496
  v_mfma_f32_16x16x32_bf16 a[72:75], a[176:179], a[192:195], a[72:75]
  v_mfma_f32_16x16x32_bf16 a[76:79], a[184:187], a[192:195], a[76:79]
  v_mfma_f32_16x16x32_bf16 a[76:79], a[180:183], a[188:191], a[76:79]
  buffer_load_dwordx4 v9, s[12:15], s25 offen offset:3072 lds
  s_waitcnt lgkmcnt(10)
  v_mfma_f32_16x16x32_bf16 a[80:83], a[164:167], a[196:199], a[80:83]
  ds_read_b128 a[220:223], v10 offset:32768
  ds_read_b128 a[224:227], v11 offset:32768
  v_mfma_f32_16x16x32_bf16 a[80:83], a[168:171], a[200:203], a[80:83]
  v_mfma_f32_16x16x32_bf16 a[84:87], a[176:179], a[200:203], a[84:87]
  ds_read_b64_tr_b16 a[152:153], v15 offset:40960
  ds_read_b64_tr_b16 a[154:155], v15 offset:42496
  v_mfma_f32_16x16x32_bf16 a[84:87], a[172:175], a[196:199], a[84:87]
  v_mfma_f32_16x16x32_bf16 a[88:91], a[180:183], a[196:199], a[88:91]
  s_add_u32 m0, s30, 40960
  s_nop 0
  buffer_load_dwordx4 v21, s[12:15], s25 offen offset:0 lds
  v_mfma_f32_16x16x32_bf16 a[88:91], a[184:187], a[200:203], a[88:91]
  s_waitcnt lgkmcnt(10)
  v_mfma_f32_16x16x32_bf16 a[92:95], a[168:171], a[208:211], a[92:95]
  ds_read_b128 a[228:231], v10 offset:34816
  ds_read_b128 a[232:235], v11 offset:34816
  v_mfma_f32_16x16x32_bf16 a[92:95], a[164:167], a[204:207], a[92:95]
  v_mfma_f32_16x16x32_bf16 a[96:99], a[172:175], a[204:207], a[96:99]
  ds_read_b64_tr_b16 a[160:161], v16 offset:40960
  ds_read_b64_tr_b16 a[162:163], v16 offset:42496
  v_mfma_f32_16x16x32_bf16 a[96:99], a[176:179], a[208:211], a[96:99]
  buffer_load_dwordx4 v22, s[12:15], s25 offen offset:1024 lds
  v_mfma_f32_16x16x32_bf16 a[100:103], a[184:187], a[208:211], a[100:103]
  v_mfma_f32_16x16x32_bf16 a[100:103], a[180:183], a[204:207], a[100:103]
  s_waitcnt lgkmcnt(10)
  v_mfma_f32_16x16x32_bf16 a[104:107], a[164:167], a[212:215], a[104:107]
  s_add_u32 s25, s25, 393216
  v_mfma_f32_16x16x32_bf16 a[104:107], a[168:171], a[216:219], a[104:107]
  v_mfma_f32_16x16x32_bf16 a[108:111], a[176:179], a[216:219], a[108:111]
  v_mfma_f32_16x16x32_bf16 a[108:111], a[172:175], a[212:215], a[108:111]
  v_mfma_f32_16x16x32_bf16 a[112:115], a[180:183], a[212:215], a[112:115]
  s_waitcnt vmcnt(11) lgkmcnt(0)
  s_barrier
  ds_read_b128 a[188:191], v12 offset:0
  ds_read_b128 a[192:195], v13 offset:0
  v_mfma_f32_16x16x32_bf16 a[112:115], a[184:187], a[216:219], a[112:115]
  s_add_u32 m0, s28, 18432
  s_mov_b32 exec_hi, 0
  buffer_load_dwordx4 v20, s[8:11], s24 offen lds
  s_mov_b32 exec_hi, -1
  v_mfma_f32_16x16x32_bf16 a[116:119], a[168:171], a[224:227], a[116:119]
  ds_read_b128 a[196:199], v12 offset:2048
  ds_read_b128 a[200:203], v13 offset:2048
  v_mfma_f32_16x16x32_bf16 a[116:119], a[164:167], a[220:223], a[116:119]
  v_mfma_f32_16x16x32_bf16 a[120:123], a[172:175], a[220:223], a[120:123]
  s_add_u32 m0, s29, 20480
  s_nop 0
  buffer_load_dwordx4 v2, s[8:11], s23 offen offset:0 lds
  v_mfma_f32_16x16x32_bf16 a[120:123], a[176:179], a[224:227], a[120:123]
  v_mfma_f32_16x16x32_bf16 a[124:127], a[184:187], a[224:227], a[124:127]
  v_mfma_f32_16x16x32_bf16 a[124:127], a[180:183], a[220:223], a[124:127]
  buffer_load_dwordx4 v3, s[8:11], s23 offen offset:1024 lds
  v_mfma_f32_16x16x32_bf16 a[128:131], a[164:167], a[228:231], a[128:131]
  ds_read_b128 a[204:207], v12 offset:4096
  ds_read_b128 a[208:211], v13 offset:4096
  v_mfma_f32_16x16x32_bf16 a[128:131], a[168:171], a[232:235], a[128:131]
  v_mfma_f32_16x16x32_bf16 a[132:135], a[176:179], a[232:235], a[132:135]
  v_mfma_f32_16x16x32_bf16 a[132:135], a[172:175], a[228:231], a[132:135]
  buffer_load_dwordx4 v4, s[8:11], s23 offen offset:2048 lds
  v_mfma_f32_16x16x32_bf16 a[136:139], a[180:183], a[228:231], a[136:139]
  v_mfma_f32_16x16x32_bf16 a[136:139], a[184:187], a[232:235], a[136:139]
  s_waitcnt lgkmcnt(4)
  v_mfma_f32_16x16x32_bf16 a[32:35], a[140:143], a[188:191], a[32:35]
  ds_read_b128 a[212:215], v12 offset:6144
  ds_read_b128 a[216:219], v13 offset:6144
  v_mfma_f32_16x16x32_bf16 a[32:35], a[144:147], a[192:195], a[32:35]
  buffer_load_dwordx4 v5, s[8:11], s23 offen offset:3072 lds
  v_mfma_f32_16x16x32_bf16 a[36:39], a[152:155], a[192:195], a[36:39]
  ds_read_b64_tr_b16 a[164:165], v17 offset:0
  ds_read_b64_tr_b16 a[166:167], v17 offset:1536
  v_mfma_f32_16x16x32_bf16 a[36:39], a[148:151], a[188:191], a[36:39]
  v_mfma_f32_16x16x32_bf16 a[40:43], a[156:159], a[188:191], a[40:43]
  v_mfma_f32_16x16x32_bf16 a[40:43], a[160:163], a[192:195], a[40:43]
  s_add_u32 s23, s23, 128
  s_add_u32 s24, s24, 128
  s_waitcnt lgkmcnt(6)
  v_mfma_f32_16x16x32_bf16 a[44:47], a[144:147], a[200:203], a[44:47]
  ds_read_b128 a[220:223], v12 offset:8192
  ds_read_b128 a[224:227], v13 offset:8192
  v_mfma_f32_16x16x32_bf16 a[44:47], a[140:143], a[196:199], a[44:47]
  v_mfma_f32_16x16x32_bf16 a[48:51], a[148:151], a[196:199], a[48:51]
  ds_read_b64_tr_b16 a[172:173], v18 offset:0
  ds_read_b64_tr_b16 a[174:175], v18 offset:1536
  v_mfma_f32_16x16x32_bf16 a[48:51], a[152:155], a[200:203], a[48:51]
  v_mfma_f32_16x16x32_bf16 a[52:55], a[160:163], a[200:203], a[52:55]
  s_add_u32 m0, s30, 65536
  s_nop 0
  buffer_load_dwordx4 v6, s[12:15], s25 offen offset:0 lds
  v_mfma_f32_16x16x32_bf16 a[52:55], a[156:159], a[196:199], a[52:55]
  s_waitcnt lgkmcnt(8)
  v_mfma_f32_16x16x32_bf16 a[56:59], a[140:143], a[204:207], a[56:59]
  ds_read_b128 a[228:231], v12 offset:10240
  ds_read_b128 a[232:235], v13 offset:10240
  v_mfma_f32_16x16x32_bf16 a[56:59], a[144:147], a[208:211], a[56:59]
  v_mfma_f32_16x16x32_bf16 a[60:63], a[152:155], a[208:211], a[60:63]
  ds_read_b64_tr_b16 a[180:181], v19 offset:0
  ds_read_b64_tr_b16 a[182:183], v19 offset:1536
  v_mfma_f32_16x16x32_bf16 a[60:63], a[148:151], a[204:207], a[60:63]
  buffer_load_dwordx4 v7, s[12:15], s25 offen offset:1024 lds
  v_mfma_f32_16x16x32_bf16 a[64:67], a[156:159], a[204:207], a[64:67]
  v_mfma_f32_16x16x32_bf16 a[64:67], a[160:163], a[208:211], a[64:67]
  s_waitcnt lgkmcnt(10)
  v_mfma_f32_16x16x32_bf16 a[68:71], a[144:147], a[216:219], a[68:71]
  ds_read_b128 a[188:191], v12 offset:12288
  ds_read_b128 a[192:195], v13 offset:12288
  v_mfma_f32_16x16x32_bf16 a[68:71], a[140:143], a[212:215], a[68:71]
  buffer_load_dwordx4 v8, s[12:15], s25 offen offset:2048 lds
  v_mfma_f32_16x16x32_bf16 a[72:75], a[148:151], a[212:215], a[72:75]
  ds_read_b64_tr_b16 a[168:169], v17 offset:12288
  ds_read_b64_tr_b16 a[170:171], v17 offset:13824
  v_mfma_f32_16x16x32_bf16 a[72:75], a[152:155], a[216:219], a[72:75]
  v_mfma_f32_16x16x32_bf16 a[76:79], a[160:163], a[216:219], a[76:79]
  v_mfma_f32_16x16x32_bf16 a[76:79], a[156:159], a[212:215], a[76:79]
  buffer_load_dwordx4 v9, s[12:15], s25 offen offset:3072 lds
  s_waitcnt lgkmcnt(10)
  v_mfma_f32_16x16x32_bf16 a[80:83], a[140:143], a[220:223], a[80:83]
  ds_read_b128 a[196:199], v12 offset:14336
  ds_read_b128 a[200:203], v13 offset:14336
  v_mfma_f32_16x16x32_bf16 a[80:83], a[144:147], a[224:227], a[80:83]
  v_mfma_f32_16x16x32_bf16 a[84:87], a[152:155], a[224:227], a[84:87]
  ds_read_b64_tr_b16 a[176:177], v18 offset:12288
  ds_read_b64_tr_b16 a[178:179], v18 offset:13824
  v_mfma_f32_16x16x32_bf16 a[84:87], a[148:151], a[220:223], a[84:87]
  v_mfma_f32_16x16x32_bf16 a[88:91], a[156:159], a[220:223], a[88:91]
  s_add_u32 m0, s30, 69632
  s_nop 0
  buffer_load_dwordx4 v21, s[12:15], s25 offen offset:0 lds
  v_mfma_f32_16x16x32_bf16 a[88:91], a[160:163], a[224:227], a[88:91]
  s_waitcnt lgkmcnt(10)
  v_mfma_f32_16x16x32_bf16 a[92:95], a[144:147], a[232:235], a[92:95]
  ds_read_b128 a[204:207], v12 offset:16384
  ds_read_b128 a[208:211], v13 offset:16384
  v_mfma_f32_16x16x32_bf16 a[92:95], a[140:143], a[228:231], a[92:95]
  v_mfma_f32_16x16x32_bf16 a[96:99], a[148:151], a[228:231], a[96:99]
  ds_read_b64_tr_b16 a[184:185], v19 offset:12288
  ds_read_b64_tr_b16 a[186:187], v19 offset:13824
  v_mfma_f32_16x16x32_bf16 a[96:99], a[152:155], a[232:235], a[96:99]
  buffer_load_dwordx4 v22, s[12:15], s25 offen offset:1024 lds
  v_mfma_f32_16x16x32_bf16 a[100:103], a[160:163], a[232:235], a[100:103]
  v_mfma_f32_16x16x32_bf16 a[100:103], a[156:159], a[228:231], a[100:103]
  s_waitcnt lgkmcnt(10)
  v_mfma_f32_16x16x32_bf16 a[104:107], a[140:143], a[188:191], a[104:107]
  s_add_u32 s25, s25, 393216
  v_mfma_f32_16x16x32_bf16 a[104:107], a[144:147], a[192:195], a[104:107]
  v_mfma_f32_16x16x32_bf16 a[108:111], a[152:155], a[192:195], a[108:111]
  v_mfma_f32_16x16x32_bf16 a[108:111], a[148:151], a[188:191], a[108:111]
  v_mfma_f32_16x16x32_bf16 a[112:115], a[156:159], a[188:191], a[112:115]
  s_waitcnt vmcnt(11) lgkmcnt(0)
  s_barrier
  ds_read_b128 a[212:215], v10 offset:0
  ds_read_b128 a[216:219], v11 offset:0
  v_mfma_f32_16x16x32_bf16 a[112:115], a[160:163], a[192:195], a[112:115]
  s_add_u32 m0, s28, 131072
  s_mov_b32 exec_hi, 0
  buffer_load_dwordx4 v20, s[8:11], s24 offen lds
  s_mov_b32 exec_hi, -1
  v_mfma_f32_16x16x32_bf16 a[116:119], a[144:147], a[200:203], a[116:119]
  ds_read_b128 a[220:223], v10 offset:2048
  ds_read_b128 a[224:227], v11 offset:2048
  v_mfma_f32_16x16x32_bf16 a[116:119], a[140:143], a[196:199], a[116:119]
  v_mfma_f32_16x16x32_bf16 a[120:123], a[148:151], a[196:199], a[120:123]
  s_add_u32 m0, s29, 133120
  s_nop 0
  buffer_load_dwordx4 v2, s[8:11], s23 offen offset:0 lds
  v_mfma_f32_16x16x32_bf16 a[120:123], a[152:155], a[200:203], a[120:123]
  v_mfma_f32_16x16x32_bf16 a[124:127], a[160:163], a[200:203], a[124:127]
  v_mfma_f32_16x16x32_bf16 a[124:127], a[156:159], a[196:199], a[124:127]
  buffer_load_dwordx4 v3, s[8:11], s23 offen offset:1024 lds
  v_mfma_f32_16x16x32_bf16 a[128:131], a[140:143], a[204:207], a[128:131]
  ds_read_b128 a[228:231], v10 offset:4096
  ds_read_b128 a[232:235], v11 offset:4096
  v_mfma_f32_16x16x32_bf16 a[128:131], a[144:147], a[208:211], a[128:131]
  v_mfma_f32_16x16x32_bf16 a[132:135], a[152:155], a[208:211], a[132:135]
  v_mfma_f32_16x16x32_bf16 a[132:135], a[148:151], a[204:207], a[132:135]
  buffer_load_dwordx4 v4, s[8:11], s23 offen offset:2048 lds
  v_mfma_f32_16x16x32_bf16 a[136:139], a[156:159], a[204:207], a[136:139]
  v_mfma_f32_16x16x32_bf16 a[136:139], a[160:163], a[208:211], a[136:139]
  s_waitcnt lgkmcnt(4)
  v_mfma_f32_16x16x32_bf16 a[32:35], a[164:167], a[212:215], a[32:35]
  ds_read_b128 a[188:191], v10 offset:6144
  ds_read_b128 a[192:195], v11 offset:6144
  v_mfma_f32_16x16x32_bf16 a[32:35], a[168:171], a[216:219], a[32:35]
  buffer_load_dwordx4 v5, s[8:11], s23 offen offset:3072 lds
  v_mfma_f32_16x16x32_bf16 a[36:39], a[176:179], a[216:219], a[36:39]
  ds_read_b64_tr_b16 a[140:141], v14 offset:0
  ds_read_b64_tr_b16 a[142:143], v14 offset:1536
  v_mfma_f32_16x16x32_bf16 a[36:39], a[172:175], a[212:215], a[36:39]
  v_mfma_f32_16x16x32_bf16 a[40:43], a[180:183], a[212:215], a[40:43]
  v_mfma_f32_16x16x32_bf16 a[40:43], a[184:187], a[216:219], a[40:43]
  s_add_u32 s23, s23, 128
  s_add_u32 s24, s24, 128
  s_waitcnt lgkmcnt(6)
  v_mfma_f32_16x16x32_bf16 a[44:47], a[168:171], a[224:227], a[44:47]
  ds_read_b128 a[196:199], v10 offset:8192
  ds_read_b128 a[200:203], v11 offset:8192
  v_mfma_f32_16x16x32_bf16 a[44:47], a[164:167], a[220:223], a[44:47]
  v_mfma_f32_16x16x32_bf16 a[48:51], a[172:175], a[220:223], a[48:51]
  ds_read_b64_tr_b16 a[148:149], v15 offset:0
  ds_read_b64_tr_b16 a[150:151], v15 offset:1536
  v_mfma_f32_16x16x32_bf16 a[48:51], a[176:179], a[224:227], a[48:51]
  v_mfma_f32_16x16x32_bf16 a[52:55], a[184:187], a[224:227], a[52:55]
  s_add_u32 m0, s30, 98304
  s_nop 0
  buffer_load_dwordx4 v6, s[12:15], s25 offen offset:0 lds
  v_mfma_f32_16x16x32_bf16 a[52:55], a[180:183], a[220:223], a[52:55]
  s_waitcnt lgkmcnt(8)
  v_mfma_f32_16x16x32_bf16 a[56:59], a[164:167], a[228:231], a[56:59]
  ds_read_b128 a[204:207], v10 offset:10240
  ds_read_b128 a[208:211], v11 offset:10240
  v_mfma_f32_16x16x32_bf16 a[56:59], a[168:171], a[232:235], a[56:59]
  v_mfma_f32_16x16x32_bf16 a[60:63], a[176:179], a[232:235], a[60:63]
  ds_read_b64_tr_b16 a[156:157], v16 offset:0
  ds_read_b64_tr_b16 a[158:159], v16 offset:1536
  v_mfma_f32_16x16x32_bf16 a[60:63], a[172:175], a[228:231], a[60:63]
  buffer_load_dwordx4 v7, s[12:15], s25 offen offset:1024 lds
  v_mfma_f32_16x16x32_bf16 a[64:67], a[180:183], a[228:231], a[64:67]
  v_mfma_f32_16x16x32_bf16 a[64:67], a[184:187], a[232:235], a[64:67]
  s_waitcnt lgkmcnt(10)
  v_mfma_f32_16x16x32_bf16 a[68:71], a[168:171], a[192:195], a[68:71]
  ds_read_b128 a[212:215], v10 offset:12288
  ds_read_b128 a[216:219], v11 offset:12288
  v_mfma_f32_16x16x32_bf16 a[68:71], a[164:167], a[188:191], a[68:71]
  buffer_load_dwordx4 v8, s[12:15], s25 offen offset:2048 lds
  v_mfma_f32_16x16x32_bf16 a[72:75], a[172:175], a[188:191], a[72:75]
  ds_read_b64_tr_b16 a[144:145], v14 offset:12288
  ds_read_b64_tr_b16 a[146:147], v14 offset:13824
  v_mfma_f32_16x16x32_bf16 a[72:75], a[176:179], a[192:195], a[72:75]
  v_mfma_f32_16x16x32_bf16 a[76:79], a[184:187], a[192:195], a[76:79]
  v_mfma_f32_16x16x32_bf16 a[76:79], a[180:183], a[188:191], a[76:79]
  buffer_load_dwordx4 v9, s[12:15], s25 offen offset:3072 lds
  s_waitcnt lgkmcnt(10)
  v_mfma_f32_16x16x32_bf16 a[80:83], a[164:167], a[196:199], a[80:83]
  ds_read_b128 a[220:223], v10 offset:14336
  ds_read_b128 a[224:227], v11 offset:14336
  v_mfma_f32_16x16x32_bf16 a[80:83], a[168:171], a[200:203], a[80:83]
  v_mfma_f32_16x16x32_bf16 a[84:87], a[176:179], a[200:203], a[84:87]
  ds_read_b64_tr_b16 a[152:153], v15 offset:12288
  ds_read_b64_tr_b16 a[154:155], v15 offset:13824
  v_mfma_f32_16x16x32_bf16 a[84:87], a[172:175], a[196:199], a[84:87]
  v_mfma_f32_16x16x32_bf16 a[88:91], a[180:183], a[196:199], a[88:91]
  s_add_u32 m0, s30, 102400
  s_nop 0
  buffer_load_dwordx4 v21, s[12:15], s25 offen offset:0 lds
  v_mfma_f32_16x16x32_bf16 a[88:91], a[184:187], a[200:203], a[88:91]
  s_waitcnt lgkmcnt(10)
  v_mfma_f32_16x16x32_bf16 a[92:95], a[168:171], a[208:211], a[92:95]
  ds_read_b128 a[228:231], v10 offset:16384
  ds_read_b128 a[232:235], v11 offset:16384
  v_mfma_f32_16x16x32_bf16 a[92:95], a[164:167], a[204:207], a[92:95]
  v_mfma_f32_16x16x32_bf16 a[96:99], a[172:175], a[204:207], a[96:99]
  ds_read_b64_tr_b16 a[160:161], v16 offset:12288
  ds_read_b64_tr_b16 a[162:163], v16 offset:13824
  v_mfma_f32_16x16x32_bf16 a[96:99], a[176:179], a[208:211], a[96:99]
  buffer_load_dwordx4 v22, s[12:15], s25 offen offset:1024 lds
  v_mfma_f32_16x16x32_bf16 a[100:103], a[184:187], a[208:211], a[100:103]
  v_mfma_f32_16x16x32_bf16 a[100:103], a[180:183], a[204:207], a[100:103]
  s_waitcnt lgkmcnt(10)
  v_mfma_f32_16x16x32_bf16 a[104:107], a[164:167], a[212:215], a[104:107]
  s_add_u32 s25, s25, 393216
  v_mfma_f32_16x16x32_bf16 a[104:107], a[168:171], a[216:219], a[104:107]
  v_mfma_f32_16x16x32_bf16 a[108:111], a[176:179], a[216:219], a[108:111]
  v_mfma_f32_16x16x32_bf16 a[108:111], a[172:175], a[212:215], a[108:111]
  v_mfma_f32_16x16x32_bf16 a[112:115], a[180:183], a[212:215], a[112:115]
  s_waitcnt vmcnt(11) lgkmcnt(0)
  s_barrier
  ds_read_b128 a[188:191], v10 offset:18432
  ds_read_b128 a[192:195], v11 offset:18432
  v_mfma_f32_16x16x32_bf16 a[112:115], a[184:187], a[216:219], a[112:115]
  s_add_u32 m0, s28, 0
  s_mov_b32 exec_hi, 0
  buffer_load_dwordx4 v20, s[8:11], s24 offen lds
  s_mov_b32 exec_hi, -1
  v_mfma_f32_16x16x32_bf16 a[116:119], a[168:171], a[224:227], a[116:119]
  ds_read_b128 a[196:199], v10 offset:20480
  ds_read_b128 a[200:203], v11 offset:20480
  v_mfma_f32_16x16x32_bf16 a[116:119], a[164:167], a[220:223], a[116:119]
  v_mfma_f32_16x16x32_bf16 a[120:123], a[172:175], a[220:223], a[120:123]
  s_add_u32 m0, s29, 2048
  s_nop 0
  buffer_load_dwordx4 v2, s[8:11], s23 offen offset:0 lds
  v_mfma_f32_16x16x32_bf16 a[120:123], a[176:179], a[224:227], a[120:123]
  v_mfma_f32_16x16x32_bf16 a[124:127], a[184:187], a[224:227], a[124:127]
  v_mfma_f32_16x16x32_bf16 a[124:127], a[180:183], a[220:223], a[124:127]
  buffer_load_dwordx4 v3, s[8:11], s23 offen offset:1024 lds
  v_mfma_f32_16x16x32_bf16 a[128:131], a[164:167], a[228:231], a[128:131]
  ds_read_b128 a[204:207], v10 offset:22528
  ds_read_b128 a[208:211], v11 offset:22528
  v_mfma_f32_16x16x32_bf16 a[128:131], a[168:171], a[232:235], a[128:131]
  v_mfma_f32_16x16x32_bf16 a[132:135], a[176:179], a[232:235], a[132:135]
  v_mfma_f32_16x16x32_bf16 a[132:135], a[172:175], a[228:231], a[132:135]
  buffer_load_dwordx4 v4, s[8:11], s23 offen offset:2048 lds
  v_mfma_f32_16x16x32_bf16 a[136:139], a[180:183], a[228:231], a[136:139]
  v_mfma_f32_16x16x32_bf16 a[136:139], a[184:187], a[232:235], a[136:139]
  s_waitcnt lgkmcnt(4)
  v_mfma_f32_16x16x32_bf16 a[32:35], a[140:143], a[188:191], a[32:35]
  ds_read_b128 a[212:215], v10 offset:24576
  ds_read_b128 a[216:219], v11 offset:24576
  v_mfma_f32_16x16x32_bf16 a[32:35], a[144:147], a[192:195], a[32:35]
  buffer_load_dwordx4 v5, s[8:11], s23 offen offset:3072 lds
  v_mfma_f32_16x16x32_bf16 a[36:39], a[152:155], a[192:195], a[36:39]
  ds_read_b64_tr_b16 a[164:165], v14 offset:28672
  ds_read_b64_tr_b16 a[166:167], v14 offset:30208
  v_mfma_f32_16x16x32_bf16 a[36:39], a[148:151], a[188:191], a[36:39]
  v_mfma_f32_16x16x32_bf16 a[40:43], a[156:159], a[188:191], a[40:43]
  v_mfma_f32_16x16x32_bf16 a[40:43], a[160:163], a[192:195], a[40:43]
  s_add_u32 s23, s23, 128
  s_add_u32 s24, s24, 128
  s_waitcnt lgkmcnt(6)
  v_mfma_f32_16x16x32_bf16 a[44:47], a[144:147], a[200:203], a[44:47]
  ds_read_b128 a[220:223], v10 offset:26624
  ds_read_b128 a[224:227], v11 offset:26624
  v_mfma_f32_16x16x32_bf16 a[44:47], a[140:143], a[196:199], a[44:47]
  v_mfma_f32_16x16x32_bf16 a[48:51], a[148:151], a[196:199], a[48:51]
  ds_read_b64_tr_b16 a[172:173], v15 offset:28672
  ds_read_b64_tr_b16 a[174:175], v15 offset:30208
  v_mfma_f32_16x16x32_bf16 a[48:51], a[152:155], a[200:203], a[48:51]
  v_mfma_f32_16x16x32_bf16 a[52:55], a[160:163], a[200:203], a[52:55]
  s_add_u32 m0, s30, 36864
  s_nop 0
  buffer_load_dwordx4 v6, s[12:15], s25 offen offset:0 lds
  v_mfma_f32_16x16x32_bf16 a[52:55], a[156:159], a[196:199], a[52:55]
  s_waitcnt lgkmcnt(8)
  v_mfma_f32_16x16x32_bf16 a[56:59], a[140:143], a[204:207], a[56:59]
  ds_read_b128 a[228:231], v10 offset:28672
  ds_read_b128 a[232:235], v11 offset:28672
  v_mfma_f32_16x16x32_bf16 a[56:59], a[144:147], a[208:211], a[56:59]
  v_mfma_f32_16x16x32_bf16 a[60:63], a[152:155], a[208:211], a[60:63]
  ds_read_b64_tr_b16 a[180:181], v16 offset:28672
  ds_read_b64_tr_b16 a[182:183], v16 offset:30208
  v_mfma_f32_16x16x32_bf16 a[60:63], a[148:151], a[204:207], a[60:63]
  buffer_load_dwordx4 v7, s[12:15], s25 offen offset:1024 lds
  v_mfma_f32_16x16x32_bf16 a[64:67], a[156:159], a[204:207], a[64:67]
  v_mfma_f32_16x16x32_bf16 a[64:67], a[160:163], a[208:211], a[64:67]
  s_waitcnt lgkmcnt(10)
  v_mfma_f32_16x16x32_bf16 a[68:71], a[144:147], a[216:219], a[68:71]
  ds_read_b128 a[188:191], v10 offset:30720
  ds_read_b128 a[192:195], v11 offset:30720
  v_mfma_f32_16x16x32_bf16 a[68:71], a[140:143], a[212:215], a[68:71]
  buffer_load_dwordx4 v8, s[12:15], s25 offen offset:2048 lds
  v_mfma_f32_16x16x32_bf16 a[72:75], a[148:151], a[212:215], a[72:75]
  ds_read_b64_tr_b16 a[168:169], v14 offset:40960
  ds_read_b64_tr_b16 a[170:171], v14 offset:42496
  v_mfma_f32_16x16x32_bf16 a[72:75], a[152:155], a[216:219], a[72:75]
  v_mfma_f32_16x16x32_bf16 a[76:79], a[160:163], a[216:219], a[76:79]
  v_mfma_f32_16x16x32_bf16 a[76:79], a[156:159], a[212:215], a[76:79]
  buffer_load_dwordx4 v9, s[12:15], s25 offen offset:3072 lds
  s_waitcnt lgkmcnt(10)
  v_mfma_f32_16x16x32_bf16 a[80:83], a[140:143], a[220:223], a[80:83]
  ds_read_b128 a[196:199], v10 offset:32768
  ds_read_b128 a[200:203], v11 offset:32768
  v_mfma_f32_16x16x32_bf16 a[80:83], a[144:147], a[224:227], a[80:83]
  v_mfma_f32_16x16x32_bf16 a[84:87], a[152:155], a[224:227], a[84:87]
  ds_read_b64_tr_b16 a[176:177], v15 offset:40960
  ds_read_b64_tr_b16 a[178:179], v15 offset:42496
  v_mfma_f32_16x16x32_bf16 a[84:87], a[148:151], a[220:223], a[84:87]
  v_mfma_f32_16x16x32_bf16 a[88:91], a[156:159], a[220:223], a[88:91]
  s_add_u32 m0, s30, 40960
  s_nop 0
  buffer_load_dwordx4 v21, s[12:15], s25 offen offset:0 lds
  v_mfma_f32_16x16x32_bf16 a[88:91], a[160:163], a[224:227], a[88:91]
  s_waitcnt lgkmcnt(10)
  v_mfma_f32_16x16x32_bf16 a[92:95], a[144:147], a[232:235], a[92:95]
  ds_read_b128 a[204:207], v10 offset:34816
  ds_read_b128 a[208:211], v11 offset:34816
  v_mfma_f32_16x16x32_bf16 a[92:95], a[140:143], a[228:231], a[92:95]
  v_mfma_f32_16x16x32_bf16 a[96:99], a[148:151], a[228:231], a[96:99]
  ds_read_b64_tr_b16 a[184:185], v16 offset:40960
  ds_read_b64_tr_b16 a[186:187], v16 offset:42496
  v_mfma_f32_16x16x32_bf16 a[96:99], a[152:155], a[232:235], a[96:99]
  buffer_load_dwordx4 v22, s[12:15], s25 offen offset:1024 lds
  v_mfma_f32_16x16x32_bf16 a[100:103], a[160:163], a[232:235], a[100:103]
  v_mfma_f32_16x16x32_bf16 a[100:103], a[156:159], a[228:231], a[100:103]
  s_waitcnt lgkmcnt(10)
  v_mfma_f32_16x16x32_bf16 a[104:107], a[140:143], a[188:191], a[104:107]
  s_add_u32 s25, s25, 393216
  v_mfma_f32_16x16x32_bf16 a[104:107], a[144:147], a[192:195], a[104:107]
  v_mfma_f32_16x16x32_bf16 a[108:111], a[152:155], a[192:195], a[108:111]
  v_mfma_f32_16x16x32_bf16 a[108:111], a[148:151], a[188:191], a[108:111]
  v_mfma_f32_16x16x32_bf16 a[112:115], a[156:159], a[188:191], a[112:115]
  s_waitcnt vmcnt(11) lgkmcnt(0)
  s_barrier
  ds_read_b128 a[212:215], v12 offset:0
  ds_read_b128 a[216:219], v13 offset:0
  v_mfma_f32_16x16x32_bf16 a[112:115], a[160:163], a[192:195], a[112:115]
  s_add_u32 m0, s28, 18432
  s_mov_b32 exec_hi, 0
  buffer_load_dwordx4 v20, s[8:11], s24 offen lds
  s_mov_b32 exec_hi, -1
  v_mfma_f32_16x16x32_bf16 a[116:119], a[144:147], a[200:203], a[116:119]
  ds_read_b128 a[220:223], v12 offset:2048
  ds_read_b128 a[224:227], v13 offset:2048
  v_mfma_f32_16x16x32_bf16 a[116:119], a[140:143], a[196:199], a[116:119]
  v_mfma_f32_16x16x32_bf16 a[120:123], a[148:151], a[196:199], a[120:123]
  s_add_u32 m0, s29, 20480
  s_nop 0
  buffer_load_dwordx4 v2, s[8:11], s23 offen offset:0 lds
  v_mfma_f32_16x16x32_bf16 a[120:123], a[152:155], a[200:203], a[120:123]
  v_mfma_f32_16x16x32_bf16 a[124:127], a[160:163], a[200:203], a[124:127]
  v_mfma_f32_16x16x32_bf16 a[124:127], a[156:159], a[196:199], a[124:127]
  buffer_load_dwordx4 v3, s[8:11], s23 offen offset:1024 lds
  v_mfma_f32_16x16x32_bf16 a[128:131], a[140:143], a[204:207], a[128:131]
  ds_read_b128 a[228:231], v12 offset:4096
  ds_read_b128 a[232:235], v13 offset:4096
  v_mfma_f32_16x16x32_bf16 a[128:131], a[144:147], a[208:211], a[128:131]
  v_mfma_f32_16x16x32_bf16 a[132:135], a[152:155], a[208:211], a[132:135]
  v_mfma_f32_16x16x32_bf16 a[132:135], a[148:151], a[204:207], a[132:135]
  buffer_load_dwordx4 v4, s[8:11], s23 offen offset:2048 lds
  v_mfma_f32_16x16x32_bf16 a[136:139], a[156:159], a[204:207], a[136:139]
  v_mfma_f32_16x16x32_bf16 a[136:139], a[160:163], a[208:211], a[136:139]
  s_waitcnt lgkmcnt(4)
  v_mfma_f32_16x16x32_bf16 a[32:35], a[164:167], a[212:215], a[32:35]
  ds_read_b128 a[188:191], v12 offset:6144
  ds_read_b128 a[192:195], v13 offset:6144
  v_mfma_f32_16x16x32_bf16 a[32:35], a[168:171], a[216:219], a[32:35]
  buffer_load_dwordx4 v5, s[8:11], s23 offen offset:3072 lds
  v_mfma_f32_16x16x32_bf16 a[36:39], a[176:179], a[216:219], a[36:39]
  ds_read_b64_tr_b16 a[140:141], v17 offset:0
  ds_read_b64_tr_b16 a[142:143], v17 offset:1536
  v_mfma_f32_16x16x32_bf16 a[36:39], a[172:175], a[212:215], a[36:39]
  v_mfma_f32_16x16x32_bf16 a[40:43], a[180:183], a[212:215], a[40:43]
  v_mfma_f32_16x16x32_bf16 a[40:43], a[184:187], a[216:219], a[40:43]
  s_add_u32 s23, s23, 128
  s_add_u32 s24, s24, 128
  s_waitcnt lgkmcnt(6)
  v_mfma_f32_16x16x32_bf16 a[44:47], a[168:171], a[224:227], a[44:47]
  ds_read_b128 a[196:199], v12 offset:8192
  ds_read_b128 a[200:203], v13 offset:8192
  v_mfma_f32_16x16x32_bf16 a[44:47], a[164:167], a[220:223], a[44:47]
  v_mfma_f32_16x16x32_bf16 a[48:51], a[172:175], a[220:223], a[48:51]
  ds_read_b64_tr_b16 a[148:149], v18 offset:0
  ds_read_b64_tr_b16 a[150:151], v18 offset:1536
  v_mfma_f32_16x16x32_bf16 a[48:51], a[176:179], a[224:227], a[48:51]
  v_mfma_f32_16x16x32_bf16 a[52:55], a[184:187], a[224:227], a[52:55]
  s_add_u32 m0, s30, 65536
  s_nop 0
  buffer_load_dwordx4 v6, s[12:15], s25 offen offset:0 lds
  v_mfma_f32_16x16x32_bf16 a[52:55], a[180:183], a[220:223], a[52:55]
  s_waitcnt lgkmcnt(8)
  v_mfma_f32_16x16x32_bf16 a[56:59], a[164:167], a[228:231], a[56:59]
  ds_read_b128 a[204:207], v12 offset:10240
  ds_read_b128 a[208:211], v13 offset:10240
  v_mfma_f32_16x16x32_bf16 a[56:59], a[168:171], a[232:235], a[56:59]
  v_mfma_f32_16x16x32_bf16 a[60:63], a[176:179], a[232:235], a[60:63]
  ds_read_b64_tr_b16 a[156:157], v19 offset:0
  ds_read_b64_tr_b16 a[158:159], v19 offset:1536
  v_mfma_f32_16x16x32_bf16 a[60:63], a[172:175], a[228:231], a[60:63]
  buffer_load_dwordx4 v7, s[12:15], s25 offen offset:1024 lds
  v_mfma_f32_16x16x32_bf16 a[64:67], a[180:183], a[228:231], a[64:67]
  v_mfma_f32_16x16x32_bf16 a[64:67], a[184:187], a[232:235], a[64:67]
  s_waitcnt lgkmcnt(10)
  v_mfma_f32_16x16x32_bf16 a[68:71], a[168:171], a[192:195], a[68:71]
  ds_read_b128 a[212:215], v12 offset:12288
  ds_read_b128 a[216:219], v13 offset:12288
  v_mfma_f32_16x16x32_bf16 a[68:71], a[164:167], a[188:191], a[68:71]
  buffer_load_dwordx4 v8, s[12:15], s25 offen offset:2048 lds
  v_mfma_f32_16x16x32_bf16 a[72:75], a[172:175], a[188:191], a[72:75]
  ds_read_b64_tr_b16 a[144:145], v17 offset:12288
  ds_read_b64_tr_b16 a[146:147], v17 offset:13824
  v_mfma_f32_16x16x32_bf16 a[72:75], a[176:179], a[192:195], a[72:75]
  v_mfma_f32_16x16x32_bf16 a[76:79], a[184:187], a[192:195], a[76:79]
  v_mfma_f32_16x16x32_bf16 a[76:79], a[180:183], a[188:191], a[76:79]
  buffer_load_dwordx4 v9, s[12:15], s25 offen offset:3072 lds
  s_waitcnt lgkmcnt(10)
  v_mfma_f32_16x16x32_bf16 a[80:83], a[164:167], a[196:199], a[80:83]
  ds_read_b128 a[220:223], v12 offset:14336
  ds_read_b128 a[224:227], v13 offset:14336
  v_mfma_f32_16x16x32_bf16 a[80:83], a[168:171], a[200:203], a[80:83]
  v_mfma_f32_16x16x32_bf16 a[84:87], a[176:179], a[200:203], a[84:87]
  ds_read_b64_tr_b16 a[152:153], v18 offset:12288
  ds_read_b64_tr_b16 a[154:155], v18 offset:13824
  v_mfma_f32_16x16x32_bf16 a[84:87], a[172:175], a[196:199], a[84:87]
  v_mfma_f32_16x16x32_bf16 a[88:91], a[180:183], a[196:199], a[88:91]
  s_add_u32 m0, s30, 69632
  s_nop 0
  buffer_load_dwordx4 v21, s[12:15], s25 offen offset:0 lds
  v_mfma_f32_16x16x32_bf16 a[88:91], a[184:187], a[200:203], a[88:91]
  s_waitcnt lgkmcnt(10)
  v_mfma_f32_16x16x32_bf16 a[92:95], a[168:171], a[208:211], a[92:95]
  ds_read_b128 a[228:231], v12 offset:16384
  ds_read_b128 a[232:235], v13 offset:16384
  v_mfma_f32_16x16x32_bf16 a[92:95], a[164:167], a[204:207], a[92:95]
  v_mfma_f32_16x16x32_bf16 a[96:99], a[172:175], a[204:207], a[96:99]
  ds_read_b64_tr_b16 a[160:161], v19 offset:12288
  ds_read_b64_tr_b16 a[162:163], v19 offset:13824
  v_mfma_f32_16x16x32_bf16 a[96:99], a[176:179], a[208:211], a[96:99]
  buffer_load_dwordx4 v22, s[12:15], s25 offen offset:1024 lds
  v_mfma_f32_16x16x32_bf16 a[100:103], a[184:187], a[208:211], a[100:103]
  v_mfma_f32_16x16x32_bf16 a[100:103], a[180:183], a[204:207], a[100:103]
  s_waitcnt lgkmcnt(10)
  v_mfma_f32_16x16x32_bf16 a[104:107], a[164:167], a[212:215], a[104:107]
  s_add_u32 s25, s25, 393216
  v_mfma_f32_16x16x32_bf16 a[104:107], a[168:171], a[216:219], a[104:107]
  v_mfma_f32_16x16x32_bf16 a[108:111], a[176:179], a[216:219], a[108:111]
  v_mfma_f32_16x16x32_bf16 a[108:111], a[172:175], a[212:215], a[108:111]
  v_mfma_f32_16x16x32_bf16 a[112:115], a[180:183], a[212:215], a[112:115]
  s_waitcnt vmcnt(11) lgkmcnt(0)
  s_barrier
  ds_read_b128 a[188:191], v10 offset:0
  ds_read_b128 a[192:195], v11 offset:0
  v_mfma_f32_16x16x32_bf16 a[112:115], a[184:187], a[216:219], a[112:115]
  s_add_u32 m0, s28, 131072
  s_mov_b32 exec_hi, 0
  buffer_load_dwordx4 v20, s[8:11], s24 offen lds
  s_mov_b32 exec_hi, -1
  v_mfma_f32_16x16x32_bf16 a[116:119], a[168:171], a[224:227], a[116:119]
  ds_read_b128 a[196:199], v10 offset:2048
  ds_read_b128 a[200:203], v11 offset:2048
  v_mfma_f32_16x16x32_bf16 a[116:119], a[164:167], a[220:223], a[116:119]
  v_mfma_f32_16x16x32_bf16 a[120:123], a[172:175], a[220:223], a[120:123]
  s_add_u32 m0, s29, 133120
  s_nop 0
  buffer_load_dwordx4 v2, s[8:11], s23 offen offset:0 lds
  v_mfma_f32_16x16x32_bf16 a[120:123], a[176:179], a[224:227], a[120:123]
  v_mfma_f32_16x16x32_bf16 a[124:127], a[184:187], a[224:227], a[124:127]
  v_mfma_f32_16x16x32_bf16 a[124:127], a[180:183], a[220:223], a[124:127]
  buffer_load_dwordx4 v3, s[8:11], s23 offen offset:1024 lds
  v_mfma_f32_16x16x32_bf16 a[128:131], a[164:167], a[228:231], a[128:131]
  ds_read_b128 a[204:207], v10 offset:4096
  ds_read_b128 a[208:211], v11 offset:4096
  v_mfma_f32_16x16x32_bf16 a[128:131], a[168:171], a[232:235], a[128:131]
  v_mfma_f32_16x16x32_bf16 a[132:135], a[176:179], a[232:235], a[132:135]
  v_mfma_f32_16x16x32_bf16 a[132:135], a[172:175], a[228:231], a[132:135]
  buffer_load_dwordx4 v4, s[8:11], s23 offen offset:2048 lds
  v_mfma_f32_16x16x32_bf16 a[136:139], a[180:183], a[228:231], a[136:139]
  v_mfma_f32_16x16x32_bf16 a[136:139], a[184:187], a[232:235], a[136:139]
  s_waitcnt lgkmcnt(4)
  v_mfma_f32_16x16x32_bf16 a[32:35], a[140:143], a[188:191], a[32:35]
  ds_read_b128 a[212:215], v10 offset:6144
  ds_read_b128 a[216:219], v11 offset:6144
  v_mfma_f32_16x16x32_bf16 a[32:35], a[144:147], a[192:195], a[32:35]
  buffer_load_dwordx4 v5, s[8:11], s23 offen offset:3072 lds
  v_mfma_f32_16x16x32_bf16 a[36:39], a[152:155], a[192:195], a[36:39]
  ds_read_b64_tr_b16 a[164:165], v14 offset:0
  ds_read_b64_tr_b16 a[166:167], v14 offset:1536
  v_mfma_f32_16x16x32_bf16 a[36:39], a[148:151], a[188:191], a[36:39]
  v_mfma_f32_16x16x32_bf16 a[40:43], a[156:159], a[188:191], a[40:43]
  v_mfma_f32_16x16x32_bf16 a[40:43], a[160:163], a[192:195], a[40:43]
  s_add_u32 s23, s23, 128
  s_add_u32 s24, s24, 128
  s_waitcnt lgkmcnt(6)
  v_mfma_f32_16x16x32_bf16 a[44:47], a[144:147], a[200:203], a[44:47]
  ds_read_b128 a[220:223], v10 offset:8192
  ds_read_b128 a[224:227], v11 offset:8192
  v_mfma_f32_16x16x32_bf16 a[44:47], a[140:143], a[196:199], a[44:47]
  v_mfma_f32_16x16x32_bf16 a[48:51], a[148:151], a[196:199], a[48:51]
  ds_read_b64_tr_b16 a[172:173], v15 offset:0
  ds_read_b64_tr_b16 a[174:175], v15 offset:1536
  v_mfma_f32_16x16x32_bf16 a[48:51], a[152:155], a[200:203], a[48:51]
  v_mfma_f32_16x16x32_bf16 a[52:55], a[160:163], a[200:203], a[52:55]
  s_add_u32 m0, s30, 98304
  s_nop 0
  buffer_load_dwordx4 v6, s[12:15], s25 offen offset:0 lds
  v_mfma_f32_16x16x32_bf16 a[52:55], a[156:159], a[196:199], a[52:55]
  s_waitcnt lgkmcnt(8)
  v_mfma_f32_16x16x32_bf16 a[56:59], a[140:143], a[204:207], a[56:59]
  ds_read_b128 a[228:231], v10 offset:10240
  ds_read_b128 a[232:235], v11 offset:10240
  v_mfma_f32_16x16x32_bf16 a[56:59], a[144:147], a[208:211], a[56:59]
  v_mfma_f32_16x16x32_bf16 a[60:63], a[152:155], a[208:211], a[60:63]
  ds_read_b64_tr_b16 a[180:181], v16 offset:0
  ds_read_b64_tr_b16 a[182:183], v16 offset:1536
  v_mfma_f32_16x16x32_bf16 a[60:63], a[148:151], a[204:207], a[60:63]
  buffer_load_dwordx4 v7, s[12:15], s25 offen offset:1024 lds
  v_mfma_f32_16x16x32_bf16 a[64:67], a[156:159], a[204:207], a[64:67]
  v_mfma_f32_16x16x32_bf16 a[64:67], a[160:163], a[208:211], a[64:67]
  s_waitcnt lgkmcnt(10)
  v_mfma_f32_16x16x32_bf16 a[68:71], a[144:147], a[216:219], a[68:71]
  ds_read_b128 a[188:191], v10 offset:12288
  ds_read_b128 a[192:195], v11 offset:12288
  v_mfma_f32_16x16x32_bf16 a[68:71], a[140:143], a[212:215], a[68:71]
  buffer_load_dwordx4 v8, s[12:15], s25 offen offset:2048 lds
  v_mfma_f32_16x16x32_bf16 a[72:75], a[148:151], a[212:215], a[72:75]
  ds_read_b64_tr_b16 a[168:169], v14 offset:12288
  ds_read_b64_tr_b16 a[170:171], v14 offset:13824
  v_mfma_f32_16x16x32_bf16 a[72:75], a[152:155], a[216:219], a[72:75]
  v_mfma_f32_16x16x32_bf16 a[76:79], a[160:163], a[216:219], a[76:79]
  v_mfma_f32_16x16x32_bf16 a[76:79], a[156:159], a[212:215], a[76:79]
  buffer_load_dwordx4 v9, s[12:15], s25 offen offset:3072 lds
  s_waitcnt lgkmcnt(10)
  v_mfma_f32_16x16x32_bf16 a[80:83], a[140:143], a[220:223], a[80:83]
  ds_read_b128 a[196:199], v10 offset:14336
  ds_read_b128 a[200:203], v11 offset:14336
  v_mfma_f32_16x16x32_bf16 a[80:83], a[144:147], a[224:227], a[80:83]
  v_mfma_f32_16x16x32_bf16 a[84:87], a[152:155], a[224:227], a[84:87]
  ds_read_b64_tr_b16 a[176:177], v15 offset:12288
  ds_read_b64_tr_b16 a[178:179], v15 offset:13824
  v_mfma_f32_16x16x32_bf16 a[84:87], a[148:151], a[220:223], a[84:87]
  v_mfma_f32_16x16x32_bf16 a[88:91], a[156:159], a[220:223], a[88:91]
  s_add_u32 m0, s30, 102400
  s_nop 0
  buffer_load_dwordx4 v21, s[12:15], s25 offen offset:0 lds
  v_mfma_f32_16x16x32_bf16 a[88:91], a[160:163], a[224:227], a[88:91]
  s_waitcnt lgkmcnt(10)
  v_mfma_f32_16x16x32_bf16 a[92:95], a[144:147], a[232:235], a[92:95]
  ds_read_b128 a[204:207], v10 offset:16384
  ds_read_b128 a[208:211], v11 offset:16384
  v_mfma_f32_16x16x32_bf16 a[92:95], a[140:143], a[228:231], a[92:95]
  v_mfma_f32_16x16x32_bf16 a[96:99], a[148:151], a[228:231], a[96:99]
  ds_read_b64_tr_b16 a[184:185], v16 offset:12288
  ds_read_b64_tr_b16 a[186:187], v16 offset:13824
  v_mfma_f32_16x16x32_bf16 a[96:99], a[152:155], a[232:235], a[96:99]
  buffer_load_dwordx4 v22, s[12:15], s25 offen offset:1024 lds
  v_mfma_f32_16x16x32_bf16 a[100:103], a[160:163], a[232:235], a[100:103]
  v_mfma_f32_16x16x32_bf16 a[100:103], a[156:159], a[228:231], a[100:103]
  s_waitcnt lgkmcnt(10)
  v_mfma_f32_16x16x32_bf16 a[104:107], a[140:143], a[188:191], a[104:107]
  s_add_u32 s25, s25, 393216
  v_mfma_f32_16x16x32_bf16 a[104:107], a[144:147], a[192:195], a[104:107]
  v_mfma_f32_16x16x32_bf16 a[108:111], a[152:155], a[192:195], a[108:111]
  v_mfma_f32_16x16x32_bf16 a[108:111], a[148:151], a[188:191], a[108:111]
  v_mfma_f32_16x16x32_bf16 a[112:115], a[156:159], a[188:191], a[112:115]
  s_waitcnt vmcnt(11) lgkmcnt(0)
  s_barrier
  ds_read_b128 a[212:215], v10 offset:18432
  ds_read_b128 a[216:219], v11 offset:18432
  v_mfma_f32_16x16x32_bf16 a[112:115], a[160:163], a[192:195], a[112:115]
  s_add_u32 m0, s28, 0
  s_mov_b32 exec_hi, 0
  buffer_load_dwordx4 v20, s[8:11], s24 offen lds
  s_mov_b32 exec_hi, -1
  v_mfma_f32_16x16x32_bf16 a[116:119], a[144:147], a[200:203], a[116:119]
  ds_read_b128 a[220:223], v10 offset:20480
  ds_read_b128 a[224:227], v11 offset:20480
  v_mfma_f32_16x16x32_bf16 a[116:119], a[140:143], a[196:199], a[116:119]
  v_mfma_f32_16x16x32_bf16 a[120:123], a[148:151], a[196:199], a[120:123]
  s_add_u32 m0, s29, 2048
  s_nop 0
  buffer_load_dwordx4 v2, s[8:11], s23 offen offset:0 lds
  v_mfma_f32_16x16x32_bf16 a[120:123], a[152:155], a[200:203], a[120:123]
  v_mfma_f32_16x16x32_bf16 a[124:127], a[160:163], a[200:203], a[124:127]
  v_mfma_f32_16x16x32_bf16 a[124:127], a[156:159], a[196:199], a[124:127]
  buffer_load_dwordx4 v3, s[8:11], s23 offen offset:1024 lds
  v_mfma_f32_16x16x32_bf16 a[128:131], a[140:143], a[204:207], a[128:131]
  ds_read_b128 a[228:231], v10 offset:22528
  ds_read_b128 a[232:235], v11 offset:22528
  v_mfma_f32_16x16x32_bf16 a[128:131], a[144:147], a[208:211], a[128:131]
  v_mfma_f32_16x16x32_bf16 a[132:135], a[152:155], a[208:211], a[132:135]
  v_mfma_f32_16x16x32_bf16 a[132:135], a[148:151], a[204:207], a[132:135]
  buffer_load_dwordx4 v4, s[8:11], s23 offen offset:2048 lds
  v_mfma_f32_16x16x32_bf16 a[136:139], a[156:159], a[204:207], a[136:139]
  v_mfma_f32_16x16x32_bf16 a[136:139], a[160:163], a[208:211], a[136:139]
  s_waitcnt lgkmcnt(4)
  v_mfma_f32_16x16x32_bf16 a[32:35], a[164:167], a[212:215], a[32:35]
  ds_read_b128 a[188:191], v10 offset:24576
  ds_read_b128 a[192:195], v11 offset:24576
  v_mfma_f32_16x16x32_bf16 a[32:35], a[168:171], a[216:219], a[32:35]
  buffer_load_dwordx4 v5, s[8:11], s23 offen offset:3072 lds
  v_mfma_f32_16x16x32_bf16 a[36:39], a[176:179], a[216:219], a[36:39]
  ds_read_b64_tr_b16 a[140:141], v14 offset:28672
  ds_read_b64_tr_b16 a[142:143], v14 offset:30208
  v_mfma_f32_16x16x32_bf16 a[36:39], a[172:175], a[212:215], a[36:39]
  v_mfma_f32_16x16x32_bf16 a[40:43], a[180:183], a[212:215], a[40:43]
  v_mfma_f32_16x16x32_bf16 a[40:43], a[184:187], a[216:219], a[40:43]
  s_add_u32 s23, s23, 128
  s_add_u32 s24, s24, 128
  s_waitcnt lgkmcnt(6)
  v_mfma_f32_16x16x32_bf16 a[44:47], a[168:171], a[224:227], a[44:47]
  ds_read_b128 a[196:199], v10 offset:26624
  ds_read_b128 a[200:203], v11 offset:26624
  v_mfma_f32_16x16x32_bf16 a[44:47], a[164:167], a[220:223], a[44:47]
  v_mfma_f32_16x16x32_bf16 a[48:51], a[172:175], a[220:223], a[48:51]
  ds_read_b64_tr_b16 a[148:149], v15 offset:28672
  ds_read_b64_tr_b16 a[150:151], v15 offset:30208
  v_mfma_f32_16x16x32_bf16 a[48:51], a[176:179], a[224:227], a[48:51]
  v_mfma_f32_16x16x32_bf16 a[52:55], a[184:187], a[224:227], a[52:55]
  s_add_u32 m0, s30, 36864
  s_nop 0
  buffer_load_dwordx4 v6, s[12:15], s25 offen offset:0 lds
  v_mfma_f32_16x16x32_bf16 a[52:55], a[180:183], a[220:223], a[52:55]
  s_waitcnt lgkmcnt(8)
  v_mfma_f32_16x16x32_bf16 a[56:59], a[164:167], a[228:231], a[56:59]
  ds_read_b128 a[204:207], v10 offset:28672
  ds_read_b128 a[208:211], v11 offset:28672
  v_mfma_f32_16x16x32_bf16 a[56:59], a[168:171], a[232:235], a[56:59]
  v_mfma_f32_16x16x32_bf16 a[60:63], a[176:179], a[232:235], a[60:63]
  ds_read_b64_tr_b16 a[156:157], v16 offset:28672
  ds_read_b64_tr_b16 a[158:159], v16 offset:30208
  v_mfma_f32_16x16x32_bf16 a[60:63], a[172:175], a[228:231], a[60:63]
  buffer_load_dwordx4 v7, s[12:15], s25 offen offset:1024 lds
  v_mfma_f32_16x16x32_bf16 a[64:67], a[180:183], a[228:231], a[64:67]
  v_mfma_f32_16x16x32_bf16 a[64:67], a[184:187], a[232:235], a[64:67]
  s_waitcnt lgkmcnt(10)
  v_mfma_f32_16x16x32_bf16 a[68:71], a[168:171], a[192:195], a[68:71]
  ds_read_b128 a[212:215], v10 offset:30720
  ds_read_b128 a[216:219], v11 offset:30720
  v_mfma_f32_16x16x32_bf16 a[68:71], a[164:167], a[188:191], a[68:71]
  buffer_load_dwordx4 v8, s[12:15], s25 offen offset:2048 lds
  v_mfma_f32_16x16x32_bf16 a[72:75], a[172:175], a[188:191], a[72:75]
  ds_read_b64_tr_b16 a[144:145], v14 offset:40960
  ds_read_b64_tr_b16 a[146:147], v14 offset:42496
  v_mfma_f32_16x16x32_bf16 a[72:75], a[176:179], a[192:195], a[72:75]
  v_mfma_f32_16x16x32_bf16 a[76:79], a[184:187], a[192:195], a[76:79]
  v_mfma_f32_16x16x32_bf16 a[76:79], a[180:183], a[188:191], a[76:79]
  buffer_load_dwordx4 v9, s[12:15], s25 offen offset:3072 lds
  s_waitcnt lgkmcnt(10)
  v_mfma_f32_16x16x32_bf16 a[80:83], a[164:167], a[196:199], a[80:83]
  ds_read_b128 a[220:223], v10 offset:32768
  ds_read_b128 a[224:227], v11 offset:32768
  v_mfma_f32_16x16x32_bf16 a[80:83], a[168:171], a[200:203], a[80:83]
  v_mfma_f32_16x16x32_bf16 a[84:87], a[176:179], a[200:203], a[84:87]
  ds_read_b64_tr_b16 a[152:153], v15 offset:40960
  ds_read_b64_tr_b16 a[154:155], v15 offset:42496
  v_mfma_f32_16x16x32_bf16 a[84:87], a[172:175], a[196:199], a[84:87]
  v_mfma_f32_16x16x32_bf16 a[88:91], a[180:183], a[196:199], a[88:91]
  s_add_u32 m0, s30, 40960
  s_nop 0
  buffer_load_dwordx4 v21, s[12:15], s25 offen offset:0 lds
  v_mfma_f32_16x16x32_bf16 a[88:91], a[184:187], a[200:203], a[88:91]
  s_waitcnt lgkmcnt(10)
  v_mfma_f32_16x16x32_bf16 a[92:95], a[168:171], a[208:211], a[92:95]
  ds_read_b128 a[228:231], v10 offset:34816
  ds_read_b128 a[232:235], v11 offset:34816
  v_mfma_f32_16x16x32_bf16 a[92:95], a[164:167], a[204:207], a[92:95]
  v_mfma_f32_16x16x32_bf16 a[96:99], a[172:175], a[204:207], a[96:99]
  ds_read_b64_tr_b16 a[160:161], v16 offset:40960
  ds_read_b64_tr_b16 a[162:163], v16 offset:42496
  v_mfma_f32_16x16x32_bf16 a[96:99], a[176:179], a[208:211], a[96:99]
  buffer_load_dwordx4 v22, s[12:15], s25 offen offset:1024 lds
  v_mfma_f32_16x16x32_bf16 a[100:103], a[184:187], a[208:211], a[100:103]
  v_mfma_f32_16x16x32_bf16 a[100:103], a[180:183], a[204:207], a[100:103]
  s_waitcnt lgkmcnt(10)
  v_mfma_f32_16x16x32_bf16 a[104:107], a[164:167], a[212:215], a[104:107]
  s_add_u32 s25, s25, 393216
  v_mfma_f32_16x16x32_bf16 a[104:107], a[168:171], a[216:219], a[104:107]
  v_mfma_f32_16x16x32_bf16 a[108:111], a[176:179], a[216:219], a[108:111]
  v_mfma_f32_16x16x32_bf16 a[108:111], a[172:175], a[212:215], a[108:111]
  v_mfma_f32_16x16x32_bf16 a[112:115], a[180:183], a[212:215], a[112:115]
  s_waitcnt vmcnt(11) lgkmcnt(0)
  s_barrier
  ds_read_b128 a[188:191], v12 offset:0
  ds_read_b128 a[192:195], v13 offset:0
  v_mfma_f32_16x16x32_bf16 a[112:115], a[184:187], a[216:219], a[112:115]
  s_add_u32 m0, s28, 18432
  s_mov_b32 exec_hi, 0
  buffer_load_dwordx4 v20, s[8:11], s24 offen lds
  s_mov_b32 exec_hi, -1
  v_mfma_f32_16x16x32_bf16 a[116:119], a[168:171], a[224:227], a[116:119]
  ds_read_b128 a[196:199], v12 offset:2048
  ds_read_b128 a[200:203], v13 offset:2048
  v_mfma_f32_16x16x32_bf16 a[116:119], a[164:167], a[220:223], a[116:119]
  v_mfma_f32_16x16x32_bf16 a[120:123], a[172:175], a[220:223], a[120:123]
  s_add_u32 m0, s29, 20480
  s_nop 0
  buffer_load_dwordx4 v2, s[8:11], s23 offen offset:0 lds
  v_mfma_f32_16x16x32_bf16 a[120:123], a[176:179], a[224:227], a[120:123]
  v_mfma_f32_16x16x32_bf16 a[124:127], a[184:187], a[224:227], a[124:127]
  v_mfma_f32_16x16x32_bf16 a[124:127], a[180:183], a[220:223], a[124:127]
  buffer_load_dwordx4 v3, s[8:11], s23 offen offset:1024 lds
  v_mfma_f32_16x16x32_bf16 a[128:131], a[164:167], a[228:231], a[128:131]
  ds_read_b128 a[204:207], v12 offset:4096
  ds_read_b128 a[208:211], v13 offset:4096
  v_mfma_f32_16x16x32_bf16 a[128:131], a[168:171], a[232:235], a[128:131]
  v_mfma_f32_16x16x32_bf16 a[132:135], a[176:179], a[232:235], a[132:135]
  v_mfma_f32_16x16x32_bf16 a[132:135], a[172:175], a[228:231], a[132:135]
  buffer_load_dwordx4 v4, s[8:11], s23 offen offset:2048 lds
  v_mfma_f32_16x16x32_bf16 a[136:139], a[180:183], a[228:231], a[136:139]
  v_mfma_f32_16x16x32_bf16 a[136:139], a[184:187], a[232:235], a[136:139]
  s_waitcnt lgkmcnt(4)
  v_mfma_f32_16x16x32_bf16 a[32:35], a[140:143], a[188:191], a[32:35]
  ds_read_b128 a[212:215], v12 offset:6144
  ds_read_b128 a[216:219], v13 offset:6144
  v_mfma_f32_16x16x32_bf16 a[32:35], a[144:147], a[192:195], a[32:35]
  buffer_load_dwordx4 v5, s[8:11], s23 offen offset:3072 lds
  v_mfma_f32_16x16x32_bf16 a[36:39], a[152:155], a[192:195], a[36:39]
  ds_read_b64_tr_b16 a[164:165], v17 offset:0
  ds_read_b64_tr_b16 a[166:167], v17 offset:1536
  v_mfma_f32_16x16x32_bf16 a[36:39], a[148:151], a[188:191], a[36:39]
  v_mfma_f32_16x16x32_bf16 a[40:43], a[156:159], a[188:191], a[40:43]
  v_mfma_f32_16x16x32_bf16 a[40:43], a[160:163], a[192:195], a[40:43]
  s_add_u32 s23, s23, 128
  s_add_u32 s24, s24, 128
  s_waitcnt lgkmcnt(6)
  v_mfma_f32_16x16x32_bf16 a[44:47], a[144:147], a[200:203], a[44:47]
  ds_read_b128 a[220:223], v12 offset:8192
  ds_read_b128 a[224:227], v13 offset:8192
  v_mfma_f32_16x16x32_bf16 a[44:47], a[140:143], a[196:199], a[44:47]
  v_mfma_f32_16x16x32_bf16 a[48:51], a[148:151], a[196:199], a[48:51]
  ds_read_b64_tr_b16 a[172:173], v18 offset:0
  ds_read_b64_tr_b16 a[174:175], v18 offset:1536
  v_mfma_f32_16x16x32_bf16 a[48:51], a[152:155], a[200:203], a[48:51]
  v_mfma_f32_16x16x32_bf16 a[52:55], a[160:163], a[200:203], a[52:55]
  s_add_u32 m0, s30, 65536
  s_nop 0
  buffer_load_dwordx4 v6, s[12:15], s25 offen offset:0 lds
  v_mfma_f32_16x16x32_bf16 a[52:55], a[156:159], a[196:199], a[52:55]
  s_waitcnt lgkmcnt(8)
  v_mfma_f32_16x16x32_bf16 a[56:59], a[140:143], a[204:207], a[56:59]
  ds_read_b128 a[228:231], v12 offset:10240
  ds_read_b128 a[232:235], v13 offset:10240
  v_mfma_f32_16x16x32_bf16 a[56:59], a[144:147], a[208:211], a[56:59]
  v_mfma_f32_16x16x32_bf16 a[60:63], a[152:155], a[208:211], a[60:63]
  ds_read_b64_tr_b16 a[180:181], v19 offset:0
  ds_read_b64_tr_b16 a[182:183], v19 offset:1536
  v_mfma_f32_16x16x32_bf16 a[60:63], a[148:151], a[204:207], a[60:63]
  buffer_load_dwordx4 v7, s[12:15], s25 offen offset:1024 lds
  v_mfma_f32_16x16x32_bf16 a[64:67], a[156:159], a[204:207], a[64:67]
  v_mfma_f32_16x16x32_bf16 a[64:67], a[160:163], a[208:211], a[64:67]
  s_waitcnt lgkmcnt(10)
  v_mfma_f32_16x16x32_bf16 a[68:71], a[144:147], a[216:219], a[68:71]
  ds_read_b128 a[188:191], v12 offset:12288
  ds_read_b128 a[192:195], v13 offset:12288
  v_mfma_f32_16x16x32_bf16 a[68:71], a[140:143], a[212:215], a[68:71]
  buffer_load_dwordx4 v8, s[12:15], s25 offen offset:2048 lds
  v_mfma_f32_16x16x32_bf16 a[72:75], a[148:151], a[212:215], a[72:75]
  ds_read_b64_tr_b16 a[168:169], v17 offset:12288
  ds_read_b64_tr_b16 a[170:171], v17 offset:13824
  v_mfma_f32_16x16x32_bf16 a[72:75], a[152:155], a[216:219], a[72:75]
  v_mfma_f32_16x16x32_bf16 a[76:79], a[160:163], a[216:219], a[76:79]
  v_mfma_f32_16x16x32_bf16 a[76:79], a[156:159], a[212:215], a[76:79]
  buffer_load_dwordx4 v9, s[12:15], s25 offen offset:3072 lds
  s_waitcnt lgkmcnt(10)
  v_mfma_f32_16x16x32_bf16 a[80:83], a[140:143], a[220:223], a[80:83]
  ds_read_b128 a[196:199], v12 offset:14336
  ds_read_b128 a[200:203], v13 offset:14336
  v_mfma_f32_16x16x32_bf16 a[80:83], a[144:147], a[224:227], a[80:83]
  v_mfma_f32_16x16x32_bf16 a[84:87], a[152:155], a[224:227], a[84:87]
  ds_read_b64_tr_b16 a[176:177], v18 offset:12288
  ds_read_b64_tr_b16 a[178:179], v18 offset:13824
  v_mfma_f32_16x16x32_bf16 a[84:87], a[148:151], a[220:223], a[84:87]
  v_mfma_f32_16x16x32_bf16 a[88:91], a[156:159], a[220:223], a[88:91]
  s_add_u32 m0, s30, 69632
  s_nop 0
  buffer_load_dwordx4 v21, s[12:15], s25 offen offset:0 lds
  v_mfma_f32_16x16x32_bf16 a[88:91], a[160:163], a[224:227], a[88:91]
  s_waitcnt lgkmcnt(10)
  v_mfma_f32_16x16x32_bf16 a[92:95], a[144:147], a[232:235], a[92:95]
  ds_read_b128 a[204:207], v12 offset:16384
  ds_read_b128 a[208:211], v13 offset:16384
  v_mfma_f32_16x16x32_bf16 a[92:95], a[140:143], a[228:231], a[92:95]
  v_mfma_f32_16x16x32_bf16 a[96:99], a[148:151], a[228:231], a[96:99]
  ds_read_b64_tr_b16 a[184:185], v19 offset:12288
  ds_read_b64_tr_b16 a[186:187], v19 offset:13824
  v_mfma_f32_16x16x32_bf16 a[96:99], a[152:155], a[232:235], a[96:99]
  buffer_load_dwordx4 v22, s[12:15], s25 offen offset:1024 lds
  v_mfma_f32_16x16x32_bf16 a[100:103], a[160:163], a[232:235], a[100:103]
  v_mfma_f32_16x16x32_bf16 a[100:103], a[156:159], a[228:231], a[100:103]
  s_waitcnt lgkmcnt(10)
  v_mfma_f32_16x16x32_bf16 a[104:107], a[140:143], a[188:191], a[104:107]
  s_add_u32 s25, s25, 393216
  v_mfma_f32_16x16x32_bf16 a[104:107], a[144:147], a[192:195], a[104:107]
  v_mfma_f32_16x16x32_bf16 a[108:111], a[152:155], a[192:195], a[108:111]
  v_mfma_f32_16x16x32_bf16 a[108:111], a[148:151], a[188:191], a[108:111]
  v_mfma_f32_16x16x32_bf16 a[112:115], a[156:159], a[188:191], a[112:115]
  s_waitcnt vmcnt(11) lgkmcnt(0)
  s_barrier
  ds_read_b128 a[212:215], v10 offset:0
  ds_read_b128 a[216:219], v11 offset:0
  v_mfma_f32_16x16x32_bf16 a[112:115], a[160:163], a[192:195], a[112:115]
  s_add_u32 m0, s28, 131072
  s_mov_b32 exec_hi, 0
  buffer_load_dwordx4 v20, s[8:11], s24 offen lds
  s_mov_b32 exec_hi, -1
  v_mfma_f32_16x16x32_bf16 a[116:119], a[144:147], a[200:203], a[116:119]
  ds_read_b128 a[220:223], v10 offset:2048
  ds_read_b128 a[224:227], v11 offset:2048
  v_mfma_f32_16x16x32_bf16 a[116:119], a[140:143], a[196:199], a[116:119]
  v_mfma_f32_16x16x32_bf16 a[120:123], a[148:151], a[196:199], a[120:123]
  s_add_u32 m0, s29, 133120
  s_nop 0
  buffer_load_dwordx4 v2, s[8:11], s23 offen offset:0 lds
  v_mfma_f32_16x16x32_bf16 a[120:123], a[152:155], a[200:203], a[120:123]
  v_mfma_f32_16x16x32_bf16 a[124:127], a[160:163], a[200:203], a[124:127]
  v_mfma_f32_16x16x32_bf16 a[124:127], a[156:159], a[196:199], a[124:127]
  buffer_load_dwordx4 v3, s[8:11], s23 offen offset:1024 lds
  v_mfma_f32_16x16x32_bf16 a[128:131], a[140:143], a[204:207], a[128:131]
  ds_read_b128 a[228:231], v10 offset:4096
  ds_read_b128 a[232:235], v11 offset:4096
  v_mfma_f32_16x16x32_bf16 a[128:131], a[144:147], a[208:211], a[128:131]
  v_mfma_f32_16x16x32_bf16 a[132:135], a[152:155], a[208:211], a[132:135]
  v_mfma_f32_16x16x32_bf16 a[132:135], a[148:151], a[204:207], a[132:135]
  buffer_load_dwordx4 v4, s[8:11], s23 offen offset:2048 lds
  v_mfma_f32_16x16x32_bf16 a[136:139], a[156:159], a[204:207], a[136:139]
  v_mfma_f32_16x16x32_bf16 a[136:139], a[160:163], a[208:211], a[136:139]
  s_waitcnt lgkmcnt(4)
  v_mfma_f32_16x16x32_bf16 a[32:35], a[164:167], a[212:215], a[32:35]
  ds_read_b128 a[188:191], v10 offset:6144
  ds_read_b128 a[192:195], v11 offset:6144
  v_mfma_f32_16x16x32_bf16 a[32:35], a[168:171], a[216:219], a[32:35]
  buffer_load_dwordx4 v5, s[8:11], s23 offen offset:3072 lds
  v_mfma_f32_16x16x32_bf16 a[36:39], a[176:179], a[216:219], a[36:39]
  ds_read_b64_tr_b16 a[140:141], v14 offset:0
  ds_read_b64_tr_b16 a[142:143], v14 offset:1536
  v_mfma_f32_16x16x32_bf16 a[36:39], a[172:175], a[212:215], a[36:39]
  v_mfma_f32_16x16x32_bf16 a[40:43], a[180:183], a[212:215], a[40:43]
  v_mfma_f32_16x16x32_bf16 a[40:43], a[184:187], a[216:219], a[40:43]
  s_waitcnt lgkmcnt(6)
  v_mfma_f32_16x16x32_bf16 a[44:47], a[168:171], a[224:227], a[44:47]
  ds_read_b128 a[196:199], v10 offset:8192
  ds_read_b128 a[200:203], v11 offset:8192
  v_mfma_f32_16x16x32_bf16 a[44:47], a[164:167], a[220:223], a[44:47]
  v_mfma_f32_16x16x32_bf16 a[48:51], a[172:175], a[220:223], a[48:51]
  ds_read_b64_tr_b16 a[148:149], v15 offset:0
  ds_read_b64_tr_b16 a[150:151], v15 offset:1536
  v_mfma_f32_16x16x32_bf16 a[48:51], a[176:179], a[224:227], a[48:51]
  v_mfma_f32_16x16x32_bf16 a[52:55], a[184:187], a[224:227], a[52:55]
  v_mfma_f32_16x16x32_bf16 a[52:55], a[180:183], a[220:223], a[52:55]
  s_waitcnt lgkmcnt(8)
  v_mfma_f32_16x16x32_bf16 a[56:59], a[164:167], a[228:231], a[56:59]
  ds_read_b128 a[204:207], v10 offset:10240
  ds_read_b128 a[208:211], v11 offset:10240
  v_mfma_f32_16x16x32_bf16 a[56:59], a[168:171], a[232:235], a[56:59]
  v_mfma_f32_16x16x32_bf16 a[60:63], a[176:179], a[232:235], a[60:63]
  ds_read_b64_tr_b16 a[156:157], v16 offset:0
  ds_read_b64_tr_b16 a[158:159], v16 offset:1536
  v_mfma_f32_16x16x32_bf16 a[60:63], a[172:175], a[228:231], a[60:63]
  v_mfma_f32_16x16x32_bf16 a[64:67], a[180:183], a[228:231], a[64:67]
  v_mfma_f32_16x16x32_bf16 a[64:67], a[184:187], a[232:235], a[64:67]
  s_waitcnt lgkmcnt(10)
  v_mfma_f32_16x16x32_bf16 a[68:71], a[168:171], a[192:195], a[68:71]
  ds_read_b128 a[212:215], v10 offset:12288
  ds_read_b128 a[216:219], v11 offset:12288
  v_mfma_f32_16x16x32_bf16 a[68:71], a[164:167], a[188:191], a[68:71]
  v_mfma_f32_16x16x32_bf16 a[72:75], a[172:175], a[188:191], a[72:75]
  ds_read_b64_tr_b16 a[144:145], v14 offset:12288
  ds_read_b64_tr_b16 a[146:147], v14 offset:13824
  v_mfma_f32_16x16x32_bf16 a[72:75], a[176:179], a[192:195], a[72:75]
  s_add_u32 s23, s23, 128
  s_add_u32 s24, s24, 128
  v_mfma_f32_16x16x32_bf16 a[76:79], a[184:187], a[192:195], a[76:79]
  v_mfma_f32_16x16x32_bf16 a[76:79], a[180:183], a[188:191], a[76:79]
  s_waitcnt lgkmcnt(10)
  v_mfma_f32_16x16x32_bf16 a[80:83], a[164:167], a[196:199], a[80:83]
  ds_read_b128 a[220:223], v10 offset:14336
  ds_read_b128 a[224:227], v11 offset:14336
  v_mfma_f32_16x16x32_bf16 a[80:83], a[168:171], a[200:203], a[80:83]
  v_mfma_f32_16x16x32_bf16 a[84:87], a[176:179], a[200:203], a[84:87]
  ds_read_b64_tr_b16 a[152:153], v15 offset:12288
  ds_read_b64_tr_b16 a[154:155], v15 offset:13824
  v_mfma_f32_16x16x32_bf16 a[84:87], a[172:175], a[196:199], a[84:87]
  v_mfma_f32_16x16x32_bf16 a[88:91], a[180:183], a[196:199], a[88:91]
  v_mfma_f32_16x16x32_bf16 a[88:91], a[184:187], a[200:203], a[88:91]
  s_waitcnt lgkmcnt(10)
  v_mfma_f32_16x16x32_bf16 a[92:95], a[168:171], a[208:211], a[92:95]
  ds_read_b128 a[228:231], v10 offset:16384
  ds_read_b128 a[232:235], v11 offset:16384
  v_mfma_f32_16x16x32_bf16 a[92:95], a[164:167], a[204:207], a[92:95]
  v_mfma_f32_16x16x32_bf16 a[96:99], a[172:175], a[204:207], a[96:99]
  ds_read_b64_tr_b16 a[160:161], v16 offset:12288
  ds_read_b64_tr_b16 a[162:163], v16 offset:13824
  v_mfma_f32_16x16x32_bf16 a[96:99], a[176:179], a[208:211], a[96:99]
  v_mfma_f32_16x16x32_bf16 a[100:103], a[184:187], a[208:211], a[100:103]
  v_mfma_f32_16x16x32_bf16 a[100:103], a[180:183], a[204:207], a[100:103]
  s_waitcnt lgkmcnt(10)
  v_mfma_f32_16x16x32_bf16 a[104:107], a[164:167], a[212:215], a[104:107]
  v_mfma_f32_16x16x32_bf16 a[104:107], a[168:171], a[216:219], a[104:107]
  v_mfma_f32_16x16x32_bf16 a[108:111], a[176:179], a[216:219], a[108:111]
  v_mfma_f32_16x16x32_bf16 a[108:111], a[172:175], a[212:215], a[108:111]
  v_mfma_f32_16x16x32_bf16 a[112:115], a[180:183], a[212:215], a[112:115]
  s_waitcnt vmcnt(5) lgkmcnt(0)
  s_barrier
  ds_read_b128 a[188:191], v10 offset:18432
  ds_read_b128 a[192:195], v11 offset:18432
  v_mfma_f32_16x16x32_bf16 a[112:115], a[184:187], a[216:219], a[112:115]
  v_mfma_f32_16x16x32_bf16 a[116:119], a[168:171], a[224:227], a[116:119]
  ds_read_b128 a[196:199], v10 offset:20480
  ds_read_b128 a[200:203], v11 offset:20480
  v_mfma_f32_16x16x32_bf16 a[116:119], a[164:167], a[220:223], a[116:119]
  v_mfma_f32_16x16x32_bf16 a[120:123], a[172:175], a[220:223], a[120:123]
  v_mfma_f32_16x16x32_bf16 a[120:123], a[176:179], a[224:227], a[120:123]
  v_mfma_f32_16x16x32_bf16 a[124:127], a[184:187], a[224:227], a[124:127]
  v_mfma_f32_16x16x32_bf16 a[124:127], a[180:183], a[220:223], a[124:127]
  v_mfma_f32_16x16x32_bf16 a[128:131], a[164:167], a[228:231], a[128:131]
  ds_read_b128 a[204:207], v10 offset:22528
  ds_read_b128 a[208:211], v11 offset:22528
  v_mfma_f32_16x16x32_bf16 a[128:131], a[168:171], a[232:235], a[128:131]
  v_mfma_f32_16x16x32_bf16 a[132:135], a[176:179], a[232:235], a[132:135]
  v_mfma_f32_16x16x32_bf16 a[132:135], a[172:175], a[228:231], a[132:135]
  v_mfma_f32_16x16x32_bf16 a[136:139], a[180:183], a[228:231], a[136:139]
  v_mfma_f32_16x16x32_bf16 a[136:139], a[184:187], a[232:235], a[136:139]
  s_waitcnt lgkmcnt(4)
  v_mfma_f32_16x16x32_bf16 a[32:35], a[140:143], a[188:191], a[32:35]
  ds_read_b128 a[212:215], v10 offset:24576
  ds_read_b128 a[216:219], v11 offset:24576
  v_mfma_f32_16x16x32_bf16 a[32:35], a[144:147], a[192:195], a[32:35]
  v_mfma_f32_16x16x32_bf16 a[36:39], a[152:155], a[192:195], a[36:39]
  ds_read_b64_tr_b16 a[164:165], v14 offset:28672
  ds_read_b64_tr_b16 a[166:167], v14 offset:30208
  v_mfma_f32_16x16x32_bf16 a[36:39], a[148:151], a[188:191], a[36:39]
  v_mfma_f32_16x16x32_bf16 a[40:43], a[156:159], a[188:191], a[40:43]
  v_mfma_f32_16x16x32_bf16 a[40:43], a[160:163], a[192:195], a[40:43]
  s_waitcnt lgkmcnt(6)
  v_mfma_f32_16x16x32_bf16 a[44:47], a[144:147], a[200:203], a[44:47]
  ds_read_b128 a[220:223], v10 offset:26624
  ds_read_b128 a[224:227], v11 offset:26624
  v_mfma_f32_16x16x32_bf16 a[44:47], a[140:143], a[196:199], a[44:47]
  v_mfma_f32_16x16x32_bf16 a[48:51], a[148:151], a[196:199], a[48:51]
  ds_read_b64_tr_b16 a[172:173], v15 offset:28672
  ds_read_b64_tr_b16 a[174:175], v15 offset:30208
  v_mfma_f32_16x16x32_bf16 a[48:51], a[152:155], a[200:203], a[48:51]
  v_mfma_f32_16x16x32_bf16 a[52:55], a[160:163], a[200:203], a[52:55]
  v_mfma_f32_16x16x32_bf16 a[52:55], a[156:159], a[196:199], a[52:55]
  s_waitcnt lgkmcnt(8)
  v_mfma_f32_16x16x32_bf16 a[56:59], a[140:143], a[204:207], a[56:59]
  ds_read_b128 a[228:231], v10 offset:28672
  ds_read_b128 a[232:235], v11 offset:28672
  v_mfma_f32_16x16x32_bf16 a[56:59], a[144:147], a[208:211], a[56:59]
  v_mfma_f32_16x16x32_bf16 a[60:63], a[152:155], a[208:211], a[60:63]
  ds_read_b64_tr_b16 a[180:181], v16 offset:28672
  ds_read_b64_tr_b16 a[182:183], v16 offset:30208
  v_mfma_f32_16x16x32_bf16 a[60:63], a[148:151], a[204:207], a[60:63]
  v_mfma_f32_16x16x32_bf16 a[64:67], a[156:159], a[204:207], a[64:67]
  v_mfma_f32_16x16x32_bf16 a[64:67], a[160:163], a[208:211], a[64:67]
  s_waitcnt lgkmcnt(10)
  v_mfma_f32_16x16x32_bf16 a[68:71], a[144:147], a[216:219], a[68:71]
  ds_read_b128 a[188:191], v10 offset:30720
  ds_read_b128 a[192:195], v11 offset:30720
  v_mfma_f32_16x16x32_bf16 a[68:71], a[140:143], a[212:215], a[68:71]
  v_mfma_f32_16x16x32_bf16 a[72:75], a[148:151], a[212:215], a[72:75]
  ds_read_b64_tr_b16 a[168:169], v14 offset:40960
  ds_read_b64_tr_b16 a[170:171], v14 offset:42496
  v_mfma_f32_16x16x32_bf16 a[72:75], a[152:155], a[216:219], a[72:75]
  v_mfma_f32_16x16x32_bf16 a[76:79], a[160:163], a[216:219], a[76:79]
  v_mfma_f32_16x16x32_bf16 a[76:79], a[156:159], a[212:215], a[76:79]
  s_waitcnt lgkmcnt(10)
  v_mfma_f32_16x16x32_bf16 a[80:83], a[140:143], a[220:223], a[80:83]
  ds_read_b128 a[196:199], v10 offset:32768
  ds_read_b128 a[200:203], v11 offset:32768
  v_mfma_f32_16x16x32_bf16 a[80:83], a[144:147], a[224:227], a[80:83]
  v_mfma_f32_16x16x32_bf16 a[84:87], a[152:155], a[224:227], a[84:87]
  ds_read_b64_tr_b16 a[176:177], v15 offset:40960
  ds_read_b64_tr_b16 a[178:179], v15 offset:42496
  v_mfma_f32_16x16x32_bf16 a[84:87], a[148:151], a[220:223], a[84:87]
  v_mfma_f32_16x16x32_bf16 a[88:91], a[156:159], a[220:223], a[88:91]
  v_mfma_f32_16x16x32_bf16 a[88:91], a[160:163], a[224:227], a[88:91]
  s_waitcnt lgkmcnt(10)
  v_mfma_f32_16x16x32_bf16 a[92:95], a[144:147], a[232:235], a[92:95]
  ds_read_b128 a[204:207], v10 offset:34816
  ds_read_b128 a[208:211], v11 offset:34816
  v_mfma_f32_16x16x32_bf16 a[92:95], a[140:143], a[228:231], a[92:95]
  v_mfma_f32_16x16x32_bf16 a[96:99], a[148:151], a[228:231], a[96:99]
  ds_read_b64_tr_b16 a[184:185], v16 offset:40960
  ds_read_b64_tr_b16 a[186:187], v16 offset:42496
  v_mfma_f32_16x16x32_bf16 a[96:99], a[152:155], a[232:235], a[96:99]
  v_mfma_f32_16x16x32_bf16 a[100:103], a[160:163], a[232:235], a[100:103]
  v_mfma_f32_16x16x32_bf16 a[100:103], a[156:159], a[228:231], a[100:103]
  s_waitcnt lgkmcnt(10)
  v_mfma_f32_16x16x32_bf16 a[104:107], a[140:143], a[188:191], a[104:107]
  v_mfma_f32_16x16x32_bf16 a[104:107], a[144:147], a[192:195], a[104:107]
  v_mfma_f32_16x16x32_bf16 a[108:111], a[152:155], a[192:195], a[108:111]
  v_mfma_f32_16x16x32_bf16 a[108:111], a[148:151], a[188:191], a[108:111]
  v_mfma_f32_16x16x32_bf16 a[112:115], a[156:159], a[188:191], a[112:115]
  s_waitcnt vmcnt(0) lgkmcnt(0)
  s_barrier
  ds_read_b128 a[212:215], v12 offset:0
  ds_read_b128 a[216:219], v13 offset:0
  v_mfma_f32_16x16x32_bf16 a[112:115], a[160:163], a[192:195], a[112:115]
  v_mfma_f32_16x16x32_bf16 a[116:119], a[144:147], a[200:203], a[116:119]
  ds_read_b128 a[220:223], v12 offset:2048
  ds_read_b128 a[224:227], v13 offset:2048
  v_mfma_f32_16x16x32_bf16 a[116:119], a[140:143], a[196:199], a[116:119]
  v_mfma_f32_16x16x32_bf16 a[120:123], a[148:151], a[196:199], a[120:123]
  v_mfma_f32_16x16x32_bf16 a[120:123], a[152:155], a[200:203], a[120:123]
  v_mfma_f32_16x16x32_bf16 a[124:127], a[160:163], a[200:203], a[124:127]
  v_mfma_f32_16x16x32_bf16 a[124:127], a[156:159], a[196:199], a[124:127]
  v_mfma_f32_16x16x32_bf16 a[128:131], a[140:143], a[204:207], a[128:131]
  ds_read_b128 a[228:231], v12 offset:4096
  ds_read_b128 a[232:235], v13 offset:4096
  v_mfma_f32_16x16x32_bf16 a[128:131], a[144:147], a[208:211], a[128:131]
  v_mfma_f32_16x16x32_bf16 a[132:135], a[152:155], a[208:211], a[132:135]
  v_mfma_f32_16x16x32_bf16 a[132:135], a[148:151], a[204:207], a[132:135]
  v_mfma_f32_16x16x32_bf16 a[136:139], a[156:159], a[204:207], a[136:139]
  v_mfma_f32_16x16x32_bf16 a[136:139], a[160:163], a[208:211], a[136:139]
  s_waitcnt lgkmcnt(4)
  v_and_b32 v24, 15, v0
  v_mul_u32_u24 v24, 400, v24
  v_lshrrev_b32 v25, 4, v0
  v_lshl_add_u32 v24, v25, 3, v24
  s_mul_i32 s3, s20, 96
  v_add_u32 v2, s3, v24
  v_mfma_f32_16x16x32_bf16 a[32:35], a[164:167], a[212:215], a[32:35]
  ds_read_b128 a[188:191], v12 offset:6144
  ds_read_b128 a[192:195], v13 offset:6144
  v_mfma_f32_16x16x32_bf16 a[32:35], a[168:171], a[216:219], a[32:35]
  v_mfma_f32_16x16x32_bf16 a[36:39], a[176:179], a[216:219], a[36:39]
  v_mfma_f32_16x16x32_bf16 a[36:39], a[172:175], a[212:215], a[36:39]
  v_mfma_f32_16x16x32_bf16 a[40:43], a[180:183], a[212:215], a[40:43]
  v_mfma_f32_16x16x32_bf16 a[40:43], a[184:187], a[216:219], a[40:43]
  s_waitcnt lgkmcnt(4)
  v_mfma_f32_16x16x32_bf16 a[44:47], a[168:171], a[224:227], a[44:47]
  ds_read_b128 a[196:199], v12 offset:8192
  ds_read_b128 a[200:203], v13 offset:8192
  v_mfma_f32_16x16x32_bf16 a[44:47], a[164:167], a[220:223], a[44:47]
  v_mfma_f32_16x16x32_bf16 a[48:51], a[172:175], a[220:223], a[48:51]
  v_mfma_f32_16x16x32_bf16 a[48:51], a[176:179], a[224:227], a[48:51]
  v_mfma_f32_16x16x32_bf16 a[52:55], a[184:187], a[224:227], a[52:55]
  v_mfma_f32_16x16x32_bf16 a[52:55], a[180:183], a[220:223], a[52:55]
  s_waitcnt lgkmcnt(4)
  v_mfma_f32_16x16x32_bf16 a[56:59], a[164:167], a[228:231], a[56:59]
  ds_read_b128 a[204:207], v12 offset:10240
  ds_read_b128 a[208:211], v13 offset:10240
  v_accvgpr_read_b32 v24, a32
  v_accvgpr_read_b32 v25, a33
  v_accvgpr_read_b32 v26, a34
  v_mfma_f32_16x16x32_bf16 a[56:59], a[168:171], a[232:235], a[56:59]
  v_accvgpr_read_b32 v27, a35
  v_cvt_pk_bf16_f32 v24, v24, v25
  v_cvt_pk_bf16_f32 v25, v26, v27
  ds_write_b64 v2, v[24:25] offset:0
  v_mfma_f32_16x16x32_bf16 a[60:63], a[176:179], a[232:235], a[60:63]
  v_accvgpr_read_b32 v28, a36
  v_accvgpr_read_b32 v29, a37
  v_accvgpr_read_b32 v30, a38
  v_mfma_f32_16x16x32_bf16 a[60:63], a[172:175], a[228:231], a[60:63]
  v_accvgpr_read_b32 v31, a39
  v_cvt_pk_bf16_f32 v28, v28, v29
  v_cvt_pk_bf16_f32 v29, v30, v31
  ds_write_b64 v2, v[28:29] offset:32
  v_mfma_f32_16x16x32_bf16 a[64:67], a[180:183], a[228:231], a[64:67]
  v_accvgpr_read_b32 v24, a40
  v_accvgpr_read_b32 v25, a41
  v_accvgpr_read_b32 v26, a42
  v_mfma_f32_16x16x32_bf16 a[64:67], a[184:187], a[232:235], a[64:67]
  s_waitcnt lgkmcnt(6)
  v_accvgpr_read_b32 v27, a43
  v_cvt_pk_bf16_f32 v24, v24, v25
  v_cvt_pk_bf16_f32 v25, v26, v27
  ds_write_b64 v2, v[24:25] offset:64
  v_mfma_f32_16x16x32_bf16 a[68:71], a[168:171], a[192:195], a[68:71]
  ds_read_b128 a[212:215], v12 offset:12288
  ds_read_b128 a[216:219], v13 offset:12288
  v_accvgpr_read_b32 v24, a44
  v_accvgpr_read_b32 v25, a45
  v_accvgpr_read_b32 v26, a46
  v_mfma_f32_16x16x32_bf16 a[68:71], a[164:167], a[188:191], a[68:71]
  v_accvgpr_read_b32 v27, a47
  v_cvt_pk_bf16_f32 v24, v24, v25
  v_cvt_pk_bf16_f32 v25, v26, v27
  ds_write_b64 v2, v[24:25] offset:6400
  v_mfma_f32_16x16x32_bf16 a[72:75], a[172:175], a[188:191], a[72:75]
  v_accvgpr_read_b32 v28, a48
  v_accvgpr_read_b32 v29, a49
  v_accvgpr_read_b32 v30, a50
  v_mfma_f32_16x16x32_bf16 a[72:75], a[176:179], a[192:195], a[72:75]
  v_accvgpr_read_b32 v31, a51
  v_cvt_pk_bf16_f32 v28, v28, v29
  v_cvt_pk_bf16_f32 v29, v30, v31
  ds_write_b64 v2, v[28:29] offset:6432
  v_mfma_f32_16x16x32_bf16 a[76:79], a[184:187], a[192:195], a[76:79]
  v_accvgpr_read_b32 v24, a52
  v_accvgpr_read_b32 v25, a53
  v_accvgpr_read_b32 v26, a54
  v_mfma_f32_16x16x32_bf16 a[76:79], a[180:183], a[188:191], a[76:79]
  s_waitcnt lgkmcnt(9)
  v_accvgpr_read_b32 v27, a55
  v_cvt_pk_bf16_f32 v24, v24, v25
  v_cvt_pk_bf16_f32 v25, v26, v27
  ds_write_b64 v2, v[24:25] offset:6464
  v_mfma_f32_16x16x32_bf16 a[80:83], a[164:167], a[196:199], a[80:83]
  ds_read_b128 a[220:223], v12 offset:14336
  ds_read_b128 a[224:227], v13 offset:14336
  v_accvgpr_read_b32 v24, a56
  v_accvgpr_read_b32 v25, a57
  v_accvgpr_read_b32 v26, a58
  v_mfma_f32_16x16x32_bf16 a[80:83], a[168:171], a[200:203], a[80:83]
  v_accvgpr_read_b32 v27, a59
  v_cvt_pk_bf16_f32 v24, v24, v25
  v_cvt_pk_bf16_f32 v25, v26, v27
  ds_write_b64 v2, v[24:25] offset:12800
  v_mfma_f32_16x16x32_bf16 a[84:87], a[176:179], a[200:203], a[84:87]
  v_accvgpr_read_b32 v28, a60
  v_accvgpr_read_b32 v29, a61
  v_accvgpr_read_b32 v30, a62
  v_mfma_f32_16x16x32_bf16 a[84:87], a[172:175], a[196:199], a[84:87]
  v_accvgpr_read_b32 v31, a63
  v_cvt_pk_bf16_f32 v28, v28, v29
  v_cvt_pk_bf16_f32 v29, v30, v31
  ds_write_b64 v2, v[28:29] offset:12832
  v_mfma_f32_16x16x32_bf16 a[88:91], a[180:183], a[196:199], a[88:91]
  v_accvgpr_read_b32 v24, a64
  v_accvgpr_read_b32 v25, a65
  v_accvgpr_read_b32 v26, a66
  v_mfma_f32_16x16x32_bf16 a[88:91], a[184:187], a[200:203], a[88:91]
  s_waitcnt lgkmcnt(12)
  v_accvgpr_read_b32 v27, a67
  v_cvt_pk_bf16_f32 v24, v24, v25
  v_cvt_pk_bf16_f32 v25, v26, v27
  ds_write_b64 v2, v[24:25] offset:12864
  v_mfma_f32_16x16x32_bf16 a[92:95], a[168:171], a[208:211], a[92:95]
  ds_read_b128 a[228:231], v12 offset:16384
  ds_read_b128 a[232:235], v13 offset:16384
  v_accvgpr_read_b32 v24, a68
  v_accvgpr_read_b32 v25, a69
  v_accvgpr_read_b32 v26, a70
  v_mfma_f32_16x16x32_bf16 a[92:95], a[164:167], a[204:207], a[92:95]
  v_accvgpr_read_b32 v27, a71
  v_cvt_pk_bf16_f32 v24, v24, v25
  v_cvt_pk_bf16_f32 v25, v26, v27
  ds_write_b64 v2, v[24:25] offset:19200
  v_mfma_f32_16x16x32_bf16 a[96:99], a[172:175], a[204:207], a[96:99]
  v_accvgpr_read_b32 v28, a72
  v_accvgpr_read_b32 v29, a73
  v_accvgpr_read_b32 v30, a74
  v_mfma_f32_16x16x32_bf16 a[96:99], a[176:179], a[208:211], a[96:99]
  v_accvgpr_read_b32 v31, a75
  v_cvt_pk_bf16_f32 v28, v28, v29
  v_cvt_pk_bf16_f32 v29, v30, v31
  ds_write_b64 v2, v[28:29] offset:19232
  v_mfma_f32_16x16x32_bf16 a[100:103], a[184:187], a[208:211], a[100:103]
  v_accvgpr_read_b32 v24, a76
  v_accvgpr_read_b32 v25, a77
  v_accvgpr_read_b32 v26, a78
  v_mfma_f32_16x16x32_bf16 a[100:103], a[180:183], a[204:207], a[100:103]
  s_waitcnt lgkmcnt(12)
  v_accvgpr_read_b32 v27, a79
  v_cvt_pk_bf16_f32 v24, v24, v25
  v_cvt_pk_bf16_f32 v25, v26, v27
  ds_write_b64 v2, v[24:25] offset:19264
  v_mfma_f32_16x16x32_bf16 a[104:107], a[164:167], a[212:215], a[104:107]
  v_accvgpr_read_b32 v24, a80
  v_accvgpr_read_b32 v25, a81
  v_accvgpr_read_b32 v26, a82
  v_mfma_f32_16x16x32_bf16 a[104:107], a[168:171], a[216:219], a[104:107]
  v_accvgpr_read_b32 v27, a83
  v_cvt_pk_bf16_f32 v24, v24, v25
  v_cvt_pk_bf16_f32 v25, v26, v27
  ds_write_b64 v2, v[24:25] offset:25600
  v_mfma_f32_16x16x32_bf16 a[108:111], a[176:179], a[216:219], a[108:111]
  v_accvgpr_read_b32 v28, a84
  v_accvgpr_read_b32 v29, a85
  v_accvgpr_read_b32 v30, a86
  v_mfma_f32_16x16x32_bf16 a[108:111], a[172:175], a[212:215], a[108:111]
  v_accvgpr_read_b32 v31, a87
  v_cvt_pk_bf16_f32 v28, v28, v29
  v_cvt_pk_bf16_f32 v29, v30, v31
  ds_write_b64 v2, v[28:29] offset:25632
  v_mfma_f32_16x16x32_bf16 a[112:115], a[180:183], a[212:215], a[112:115]
  v_accvgpr_read_b32 v24, a88
  v_accvgpr_read_b32 v25, a89
  v_accvgpr_read_b32 v26, a90
  v_mfma_f32_16x16x32_bf16 a[112:115], a[184:187], a[216:219], a[112:115]
  s_waitcnt lgkmcnt(10)
  v_accvgpr_read_b32 v27, a91
  v_cvt_pk_bf16_f32 v24, v24, v25
  v_cvt_pk_bf16_f32 v25, v26, v27
  ds_write_b64 v2, v[24:25] offset:25664
  v_mfma_f32_16x16x32_bf16 a[116:119], a[168:171], a[224:227], a[116:119]
  v_accvgpr_read_b32 v24, a92
  v_accvgpr_read_b32 v25, a93
  v_accvgpr_read_b32 v26, a94
  v_mfma_f32_16x16x32_bf16 a[116:119], a[164:167], a[220:223], a[116:119]
  v_accvgpr_read_b32 v27, a95
  v_cvt_pk_bf16_f32 v24, v24, v25
  v_cvt_pk_bf16_f32 v25, v26, v27
  ds_write_b64 v2, v[24:25] offset:32000
  v_mfma_f32_16x16x32_bf16 a[120:123], a[172:175], a[220:223], a[120:123]
  v_accvgpr_read_b32 v28, a96
  v_accvgpr_read_b32 v29, a97
  v_accvgpr_read_b32 v30, a98
  v_mfma_f32_16x16x32_bf16 a[120:123], a[176:179], a[224:227], a[120:123]
  v_accvgpr_read_b32 v31, a99
  v_cvt_pk_bf16_f32 v28, v28, v29
  v_cvt_pk_bf16_f32 v29, v30, v31
  ds_write_b64 v2, v[28:29] offset:32032
  v_mfma_f32_16x16x32_bf16 a[124:127], a[184:187], a[224:227], a[124:127]
  v_accvgpr_read_b32 v24, a100
  v_accvgpr_read_b32 v25, a101
  v_accvgpr_read_b32 v26, a102
  v_mfma_f32_16x16x32_bf16 a[124:127], a[180:183], a[220:223], a[124:127]
  s_waitcnt lgkmcnt(8)
  v_accvgpr_read_b32 v27, a103
  v_cvt_pk_bf16_f32 v24, v24, v25
  v_cvt_pk_bf16_f32 v25, v26, v27
  ds_write_b64 v2, v[24:25] offset:32064
  v_mfma_f32_16x16x32_bf16 a[128:131], a[164:167], a[228:231], a[128:131]
  v_accvgpr_read_b32 v24, a104
  v_accvgpr_read_b32 v25, a105
  v_accvgpr_read_b32 v26, a106
  v_mfma_f32_16x16x32_bf16 a[128:131], a[168:171], a[232:235], a[128:131]
  v_accvgpr_read_b32 v27, a107
  v_cvt_pk_bf16_f32 v24, v24, v25
  v_cvt_pk_bf16_f32 v25, v26, v27
  ds_write_b64 v2, v[24:25] offset:38400
  v_mfma_f32_16x16x32_bf16 a[132:135], a[176:179], a[232:235], a[132:135]
  v_accvgpr_read_b32 v28, a108
  v_accvgpr_read_b32 v29, a109
  v_accvgpr_read_b32 v30, a110
  v_mfma_f32_16x16x32_bf16 a[132:135], a[172:175], a[228:231], a[132:135]
  v_accvgpr_read_b32 v31, a111
  v_cvt_pk_bf16_f32 v28, v28, v29
  v_cvt_pk_bf16_f32 v29, v30, v31
  ds_write_b64 v2, v[28:29] offset:38432
  v_mfma_f32_16x16x32_bf16 a[136:139], a[180:183], a[228:231], a[136:139]
  v_accvgpr_read_b32 v24, a112
  v_accvgpr_read_b32 v25, a113
  v_accvgpr_read_b32 v26, a114
  v_mfma_f32_16x16x32_bf16 a[136:139], a[184:187], a[232:235], a[136:139]
  v_accvgpr_read_b32 v27, a115
  v_cvt_pk_bf16_f32 v24, v24, v25
  v_cvt_pk_bf16_f32 v25, v26, v27
  ds_write_b64 v2, v[24:25] offset:38464
  v_accvgpr_read_b32 v24, a116
  v_accvgpr_read_b32 v25, a117
  v_accvgpr_read_b32 v26, a118
  v_accvgpr_read_b32 v27, a119
  v_cvt_pk_bf16_f32 v24, v24, v25
  v_cvt_pk_bf16_f32 v25, v26, v27
  ds_write_b64 v2, v[24:25] offset:44800
  v_accvgpr_read_b32 v28, a120
  v_accvgpr_read_b32 v29, a121
  v_accvgpr_read_b32 v30, a122
  v_accvgpr_read_b32 v31, a123
  v_cvt_pk_bf16_f32 v28, v28, v29
  v_cvt_pk_bf16_f32 v29, v30, v31
  ds_write_b64 v2, v[28:29] offset:44832
  v_accvgpr_read_b32 v24, a124
  v_accvgpr_read_b32 v25, a125
  v_accvgpr_read_b32 v26, a126
  v_accvgpr_read_b32 v27, a127
  v_cvt_pk_bf16_f32 v24, v24, v25
  v_cvt_pk_bf16_f32 v25, v26, v27
  ds_write_b64 v2, v[24:25] offset:44864
  v_accvgpr_read_b32 v24, a128
  v_accvgpr_read_b32 v25, a129
  v_accvgpr_read_b32 v26, a130
  v_accvgpr_read_b32 v27, a131
  v_cvt_pk_bf16_f32 v24, v24, v25
  v_cvt_pk_bf16_f32 v25, v26, v27
  ds_write_b64 v2, v[24:25] offset:51200
  v_accvgpr_read_b32 v28, a132
  v_accvgpr_read_b32 v29, a133
  v_accvgpr_read_b32 v30, a134
  v_accvgpr_read_b32 v31, a135
  v_cvt_pk_bf16_f32 v28, v28, v29
  v_cvt_pk_bf16_f32 v29, v30, v31
  ds_write_b64 v2, v[28:29] offset:51232
  v_accvgpr_read_b32 v24, a136
  v_accvgpr_read_b32 v25, a137
  v_accvgpr_read_b32 v26, a138
  v_accvgpr_read_b32 v27, a139
  v_cvt_pk_bf16_f32 v24, v24, v25
  v_cvt_pk_bf16_f32 v25, v26, v27
  ds_write_b64 v2, v[24:25] offset:51264
  v_and_b32 v24, 15, v0
  v_lshrrev_b32 v25, 4, v0
  s_add_u32 s3, s21, 16
  v_lshl_add_u32 v26, v24, 1, s3
  s_lshl_b32 s4, s22, 6
  v_mul_u32_u24 v2, 400, v26
  v_lshl_add_u32 v2, v25, 4, v2
  v_add_u32 v2, s4, v2
  v_subrev_u32 v26, 32, v26
  v_max_i32 v26, 0, v26
  v_mul_u32_u24 v3, 400, v26
  v_lshl_add_u32 v3, v25, 4, v3
  v_add_u32 v3, s4, v3
  v_bfe_u32 v27, v0, 2, 2
  v_lshl_add_u32 v27, v25, 2, v27
  v_lshl_add_u32 v27, v27, 1, s3
  v_and_b32 v28, 3, v0
  v_lshlrev_b32 v28, 3, v28
  v_add_u32 v28, s4, v28
  s_movk_i32 s5, 400
  v_mad_u32_u24 v4, v27, s5, v28
  v_subrev_u32 v27, 32, v27
  v_max_i32 v27, 0, v27
  v_mad_u32_u24 v5, v27, s5, v28
  v_lshlrev_b32 v25, 2, v25
  v_sub_u32 v24, v24, v25
  v_mov_b32 v25, 0xf149f2ca
  s_cmp_eq_u32 s26, 0
  s_cselect_b32 s3, 0xf149f2ca, 0
  v_cmp_lt_i32 vcc, -9, v24
  s_nop 1
  v_cndmask_b32 v8, 0, v25, vcc
  v_subrev_u32 v26, 0, v24
  v_cmp_lt_u32 vcc, 7, v26
  s_nop 1
  v_cndmask_b32 v12, 0, v25, vcc
  v_min_f32 v16, s3, v8
  v_mov_b32 v20, 0x3f803f80
  v_cmp_lt_i32 vcc, -8, v24
  s_nop 1
  v_cndmask_b32 v9, 0, v25, vcc
  v_subrev_u32 v26, 1, v24
  v_cmp_lt_u32 vcc, 7, v26
  s_nop 1
  v_cndmask_b32 v13, 0, v25, vcc
  v_min_f32 v17, s3, v9
  v_mov_b32 v21, 0x3f803f80
  v_cmp_lt_i32 vcc, -7, v24
  s_nop 1
  v_cndmask_b32 v10, 0, v25, vcc
  v_subrev_u32 v26, 2, v24
  v_cmp_lt_u32 vcc, 7, v26
  s_nop 1
  v_cndmask_b32 v14, 0, v25, vcc
  v_min_f32 v18, s3, v10
  v_mov_b32 v22, 0x3f803f80
  v_cmp_lt_i32 vcc, -6, v24
  s_nop 1
  v_cndmask_b32 v11, 0, v25, vcc
  v_subrev_u32 v26, 3, v24
  v_cmp_lt_u32 vcc, 7, v26
  s_nop 1
  v_cndmask_b32 v15, 0, v25, vcc
  v_min_f32 v19, s3, v11
  v_mov_b32 v23, 0x3f803f80
  s_add_u32 s16, s50, 83886080
  s_addc_u32 s17, s51, 0
  s_mov_b32 s18, 4194304
  s_mov_b32 s19, 0x00020000
  s_lshl_b32 s3, s26, 1
  s_add_u32 s3, s3, s21
  s_lshl_b32 s3, s3, 17
  s_lshl_b32 s4, s27, 1
  s_add_u32 s4, s4, s22
  s_lshl_b32 s4, s4, 10
  s_add_u32 s6, s3, s4
  s_mov_b32 s7, 0x3e8293ee
  s_waitcnt lgkmcnt(0)
  s_barrier
  ds_read_b128 v[48:51], v3 offset:128
  ds_read_b128 v[32:35], v2 offset:0
  ds_read_b128 v[52:55], v2 offset:128
  ds_read_b128 v[36:39], v2 offset:12800
  ds_read_b128 v[56:59], v2 offset:12928
  ds_read_b128 v[40:43], v2 offset:25600
  ds_read_b128 v[60:63], v2 offset:25728
  ds_read_b128 v[44:47], v2 offset:38400
  ds_read_b128 v[64:67], v2 offset:38528
  ds_read_b64_tr_b16 v[68:69], v5 offset:256
  ds_read_b64_tr_b16 v[70:71], v4 offset:256
  ds_read_b64_tr_b16 v[72:73], v4 offset:13056
  ds_read_b64_tr_b16 v[74:75], v4 offset:25856
  ds_read_b64_tr_b16 v[76:77], v4 offset:38656
  ds_read_b64_tr_b16 v[78:79], v5 offset:288
  ds_read_b64_tr_b16 v[80:81], v4 offset:288
  ds_read_b64_tr_b16 v[82:83], v4 offset:13088
  ds_read_b64_tr_b16 v[84:85], v4 offset:25888
  ds_read_b64_tr_b16 v[86:87], v4 offset:38688
  s_waitcnt lgkmcnt(15)
  v_mfma_f32_16x16x32_bf16 v[88:91], v[48:51], v[32:35], v[16:19]
  v_mfma_f32_16x16x32_bf16 v[92:95], v[52:55], v[32:35], v[12:15]
  v_mfma_f32_16x16x32_bf16 v[96:99], v[52:55], v[36:39], v[8:11]
  s_waitcnt lgkmcnt(14)
  v_mfma_f32_16x16x32_bf16 v[100:103], v[56:59], v[36:39], v[12:15]
  s_waitcnt lgkmcnt(13)
  v_mfma_f32_16x16x32_bf16 v[104:107], v[56:59], v[40:43], v[8:11]
  s_waitcnt lgkmcnt(12)
  v_mfma_f32_16x16x32_bf16 v[108:111], v[60:63], v[40:43], v[12:15]
  s_waitcnt lgkmcnt(11)
  v_mfma_f32_16x16x32_bf16 v[112:115], v[60:63], v[44:47], v[8:11]
  s_waitcnt lgkmcnt(10)
  v_mfma_f32_16x16x32_bf16 v[116:119], v[64:67], v[44:47], v[12:15]
  v_max3_f32 v168, v88, v89, v90
  v_max3_f32 v168, v168, v91, v92
  v_max3_f32 v168, v168, v93, v94
  v_max_f32 v168, v168, v95
  v_max3_f32 v169, v96, v97, v98
  v_max3_f32 v169, v169, v99, v100
  v_max3_f32 v169, v169, v101, v102
  v_max_f32 v169, v169, v103
  v_max3_f32 v170, v104, v105, v106
  v_max3_f32 v170, v170, v107, v108
  v_max3_f32 v170, v170, v109, v110
  v_max_f32 v170, v170, v111
  v_max3_f32 v171, v112, v113, v114
  v_max3_f32 v171, v171, v115, v116
  v_max3_f32 v171, v171, v117, v118
  v_max_f32 v171, v171, v119
  v_mov_b32 v172, v168
  v_mov_b32 v173, v169
  v_mov_b32 v174, v170
  v_mov_b32 v175, v171
  v_permlane16_swap_b32 v168, v172
  v_permlane16_swap_b32 v169, v173
  v_permlane16_swap_b32 v170, v174
  v_permlane16_swap_b32 v171, v175
  v_max_f32 v168, v168, v172
  v_max_f32 v169, v169, v173
  v_max_f32 v170, v170, v174
  v_max_f32 v171, v171, v175
  v_mov_b32 v172, v168
  v_mov_b32 v173, v169
  v_mov_b32 v174, v170
  v_mov_b32 v175, v171
  v_permlane32_swap_b32 v168, v172
  v_permlane32_swap_b32 v169, v173
  v_permlane32_swap_b32 v170, v174
  v_permlane32_swap_b32 v171, v175
  v_max_f32 v168, v168, v172
  v_max_f32 v169, v169, v173
  v_max_f32 v170, v170, v174
  v_max_f32 v171, v171, v175
  v_mul_f32 v168, s7, v168
  v_mul_f32 v169, s7, v169
  v_mul_f32 v170, s7, v170
  v_mul_f32 v171, s7, v171
  v_fma_f32 v88, v88, s7, -v168
  v_fma_f32 v89, v89, s7, -v168
  v_fma_f32 v90, v90, s7, -v168
  v_fma_f32 v91, v91, s7, -v168
  v_fma_f32 v92, v92, s7, -v168
  v_fma_f32 v93, v93, s7, -v168
  v_fma_f32 v94, v94, s7, -v168
  v_fma_f32 v95, v95, s7, -v168
  v_exp_f32 v88, v88
  v_exp_f32 v89, v89
  v_exp_f32 v90, v90
  v_exp_f32 v91, v91
  v_exp_f32 v92, v92
  v_exp_f32 v93, v93
  v_exp_f32 v94, v94
  v_exp_f32 v95, v95
  v_fma_f32 v96, v96, s7, -v169
  v_fma_f32 v97, v97, s7, -v169
  v_fma_f32 v98, v98, s7, -v169
  v_fma_f32 v99, v99, s7, -v169
  v_fma_f32 v100, v100, s7, -v169
  v_fma_f32 v101, v101, s7, -v169
  v_fma_f32 v102, v102, s7, -v169
  v_fma_f32 v103, v103, s7, -v169
  v_exp_f32 v96, v96
  v_exp_f32 v97, v97
  v_exp_f32 v98, v98
  v_exp_f32 v99, v99
  v_exp_f32 v100, v100
  v_exp_f32 v101, v101
  v_exp_f32 v102, v102
  v_exp_f32 v103, v103
  v_fma_f32 v104, v104, s7, -v170
  v_fma_f32 v105, v105, s7, -v170
  v_fma_f32 v106, v106, s7, -v170
  v_fma_f32 v107, v107, s7, -v170
  v_fma_f32 v108, v108, s7, -v170
  v_fma_f32 v109, v109, s7, -v170
  v_fma_f32 v110, v110, s7, -v170
  v_fma_f32 v111, v111, s7, -v170
  v_exp_f32 v104, v104
  v_exp_f32 v105, v105
  v_exp_f32 v106, v106
  v_exp_f32 v107, v107
  v_exp_f32 v108, v108
  v_exp_f32 v109, v109
  v_exp_f32 v110, v110
  v_exp_f32 v111, v111
  v_fma_f32 v112, v112, s7, -v171
  v_fma_f32 v113, v113, s7, -v171
  v_fma_f32 v114, v114, s7, -v171
  v_fma_f32 v115, v115, s7, -v171
  v_fma_f32 v116, v116, s7, -v171
  v_fma_f32 v117, v117, s7, -v171
  v_fma_f32 v118, v118, s7, -v171
  v_fma_f32 v119, v119, s7, -v171
  v_exp_f32 v112, v112
  v_exp_f32 v113, v113
  v_exp_f32 v114, v114
  v_exp_f32 v115, v115
  v_exp_f32 v116, v116
  v_exp_f32 v117, v117
  v_exp_f32 v118, v118
  v_exp_f32 v119, v119
  v_cvt_pk_bf16_f32 v88, v88, v89
  v_cvt_pk_bf16_f32 v89, v90, v91
  v_cvt_pk_bf16_f32 v90, v92, v93
  v_cvt_pk_bf16_f32 v91, v94, v95
  v_cvt_pk_bf16_f32 v96, v96, v97
  v_cvt_pk_bf16_f32 v97, v98, v99
  v_cvt_pk_bf16_f32 v98, v100, v101
  v_cvt_pk_bf16_f32 v99, v102, v103
  v_cvt_pk_bf16_f32 v104, v104, v105
  v_cvt_pk_bf16_f32 v105, v106, v107
  v_cvt_pk_bf16_f32 v106, v108, v109
  v_cvt_pk_bf16_f32 v107, v110, v111
  v_cvt_pk_bf16_f32 v112, v112, v113
  v_cvt_pk_bf16_f32 v113, v114, v115
  v_cvt_pk_bf16_f32 v114, v116, v117
  v_cvt_pk_bf16_f32 v115, v118, v119
  v_mfma_f32_16x16x32_bf16 v[152:155], v[20:23], v[88:91], 0
  s_waitcnt lgkmcnt(8)
  v_mfma_f32_16x16x32_bf16 v[120:123], v[68:71], v[88:91], 0
  s_waitcnt lgkmcnt(3)
  v_mfma_f32_16x16x32_bf16 v[124:127], v[78:81], v[88:91], 0
  v_mfma_f32_16x16x32_bf16 v[156:159], v[20:23], v[96:99], 0
  v_mfma_f32_16x16x32_bf16 v[128:131], v[70:73], v[96:99], 0
  s_waitcnt lgkmcnt(2)
  v_mfma_f32_16x16x32_bf16 v[132:135], v[80:83], v[96:99], 0
  v_mfma_f32_16x16x32_bf16 v[160:163], v[20:23], v[104:107], 0
  v_mfma_f32_16x16x32_bf16 v[136:139], v[72:75], v[104:107], 0
  s_waitcnt lgkmcnt(1)
  v_mfma_f32_16x16x32_bf16 v[140:143], v[82:85], v[104:107], 0
  v_mfma_f32_16x16x32_bf16 v[164:167], v[20:23], v[112:115], 0
  v_mfma_f32_16x16x32_bf16 v[144:147], v[74:77], v[112:115], 0
  s_waitcnt lgkmcnt(0)
  v_mfma_f32_16x16x32_bf16 v[148:151], v[84:87], v[112:115], 0
  v_rcp_f32 v152, v152
  v_rcp_f32 v156, v156
  v_rcp_f32 v160, v160
  s_nop 1
  v_rcp_f32 v164, v164
  v_pk_mul_f32 v[120:121], v[120:121], v[152:153] op_sel_hi:[1,0]
  v_pk_mul_f32 v[122:123], v[122:123], v[152:153] op_sel_hi:[1,0]
  v_pk_mul_f32 v[124:125], v[124:125], v[152:153] op_sel_hi:[1,0]
  v_pk_mul_f32 v[126:127], v[126:127], v[152:153] op_sel_hi:[1,0]
  v_cvt_pk_bf16_f32 v120, v120, v121
  v_cvt_pk_bf16_f32 v121, v122, v123
  v_cvt_pk_bf16_f32 v122, v124, v125
  v_cvt_pk_bf16_f32 v123, v126, v127
  s_add_u32 s3, s6, 0
  buffer_store_dwordx4 v[120:123], v1, s[16:19], s3 offen
  v_pk_mul_f32 v[128:129], v[128:129], v[156:157] op_sel_hi:[1,0]
  v_pk_mul_f32 v[130:131], v[130:131], v[156:157] op_sel_hi:[1,0]
  v_pk_mul_f32 v[132:133], v[132:133], v[156:157] op_sel_hi:[1,0]
  v_pk_mul_f32 v[134:135], v[134:135], v[156:157] op_sel_hi:[1,0]
  v_cvt_pk_bf16_f32 v128, v128, v129
  v_cvt_pk_bf16_f32 v129, v130, v131
  v_cvt_pk_bf16_f32 v130, v132, v133
  v_cvt_pk_bf16_f32 v131, v134, v135
  s_add_u32 s3, s6, 32768
  buffer_store_dwordx4 v[128:131], v1, s[16:19], s3 offen
  v_pk_mul_f32 v[136:137], v[136:137], v[160:161] op_sel_hi:[1,0]
  v_pk_mul_f32 v[138:139], v[138:139], v[160:161] op_sel_hi:[1,0]
  v_pk_mul_f32 v[140:141], v[140:141], v[160:161] op_sel_hi:[1,0]
  v_pk_mul_f32 v[142:143], v[142:143], v[160:161] op_sel_hi:[1,0]
  v_cvt_pk_bf16_f32 v136, v136, v137
  v_cvt_pk_bf16_f32 v137, v138, v139
  v_cvt_pk_bf16_f32 v138, v140, v141
  v_cvt_pk_bf16_f32 v139, v142, v143
  s_add_u32 s3, s6, 65536
  buffer_store_dwordx4 v[136:139], v1, s[16:19], s3 offen
  v_pk_mul_f32 v[144:145], v[144:145], v[164:165] op_sel_hi:[1,0]
  v_pk_mul_f32 v[146:147], v[146:147], v[164:165] op_sel_hi:[1,0]
  v_pk_mul_f32 v[148:149], v[148:149], v[164:165] op_sel_hi:[1,0]
  v_pk_mul_f32 v[150:151], v[150:151], v[164:165] op_sel_hi:[1,0]
  v_cvt_pk_bf16_f32 v144, v144, v145
  v_cvt_pk_bf16_f32 v145, v146, v147
  v_cvt_pk_bf16_f32 v146, v148, v149
  v_cvt_pk_bf16_f32 v147, v150, v151
  s_add_u32 s3, s6, 98304
  buffer_store_dwordx4 v[144:147], v1, s[16:19], s3 offen
Lk1_end:
  s_endpgm
.globl k2_attn_kernel
.p2align 8
.type k2_attn_kernel,@function
k2_attn_kernel:
  s_cmp_ge_u32 s2, 256
  s_cbranch_scc1 Lk2_end
  s_load_dwordx2 s[4:5], s[0:1], 88
  s_and_b32 s20, s2, 7
  s_lshr_b32 s33, s2, 6
  s_lshl_b32 s33, s33, 3
  s_add_u32 s20, s20, s33
  s_bfe_u32 s21, s2, 0x30003
  v_lshrrev_b32 v8, 6, v0
  s_nop 0
  v_readfirstlane_b32 s22, v8
  v_and_b32 v9, 63, v0
  v_lshlrev_b32 v1, 4, v9
  s_and_b32 s23, s22, 1
  s_lshr_b32 s24, s22, 1
  s_lshl_b32 s33, s24, 14
  s_lshl_b32 s34, s23, 13
  s_add_u32 s29, s33, s34
  v_add_u32 v2, s33, v1
  v_add_u32 v3, 0x10000, v2
  s_lshl_b32 s28, s20, 20
  s_add_u32 s28, s28, s34
  s_lshl_b32 s33, s21, 16
  s_add_u32 s27, s28, s33
  s_add_u32 s27, s27, 65536
  s_sub_u32 s34, 491520, s33
  s_cmp_eq_u32 s24, 0
  s_cselect_b32 s34, 0, s34
  s_cselect_b32 s27, s27, 0x7fffffff
  s_add_u32 s25, s28, s34
  s_add_u32 s26, s25, 16384
  s_add_u32 s62, s27, 16384
  s_add_u32 s63, s28, 16384
  s_sub_u32 s35, 15, s21
  s_lshl_b32 s31, s21, 7
  s_cmp_eq_u32 s24, 0
  s_cselect_b32 s35, s21, s35
  s_cselect_b32 s31, s31, 960
  s_mov_b32 s60, 0
  s_waitcnt lgkmcnt(0)
  s_add_u32 s12, s4, 16777216
  s_addc_u32 s13, s5, 0
  s_mov_b32 s14, 33554432
  s_mov_b32 s15, 0x00020000
  s_mov_b32 s8, s4
  s_mov_b32 s9, s5
  s_mov_b32 s10, 16777216
  s_mov_b32 s11, 0x00020000
  s_add_u32 m0, s29, 65536
  s_add_u32 s32, s25, 4096
  buffer_load_dwordx4 v1, s[12:15], s25 offen offset:0 lds
  buffer_load_dwordx4 v1, s[12:15], s25 offen offset:1024 lds
  buffer_load_dwordx4 v1, s[12:15], s25 offen offset:2048 lds
  buffer_load_dwordx4 v1, s[12:15], s25 offen offset:3072 lds
  s_add_u32 m0, s29, 69632
  s_nop 0
  buffer_load_dwordx4 v1, s[12:15], s32 offen offset:0 lds
  buffer_load_dwordx4 v1, s[12:15], s32 offen offset:1024 lds
  buffer_load_dwordx4 v1, s[12:15], s32 offen offset:2048 lds
  buffer_load_dwordx4 v1, s[12:15], s32 offen offset:3072 lds
  s_add_u32 s25, s25, 32768
  s_cmp_eq_u32 s25, s27
  s_cselect_b32 s25, s28, s25
  s_cselect_b32 s27, -1, s27
  s_lshl_b32 s33, s20, 7
  s_lshl_b32 s34, s35, 3
  s_add_u32 s33, s33, s34
  s_lshl_b32 s34, s23, 2
  s_add_u32 s33, s33, s34
  s_lshl_b32 s33, s33, 12
  buffer_load_dwordx4 a[52:55], v1, s[8:11], s33 offen offset:0
  buffer_load_dwordx4 a[56:59], v1, s[8:11], s33 offen offset:1024
  buffer_load_dwordx4 a[60:63], v1, s[8:11], s33 offen offset:2048
  buffer_load_dwordx4 a[64:67], v1, s[8:11], s33 offen offset:3072
  s_add_u32 s33, s33, 4096
  buffer_load_dwordx4 a[68:71], v1, s[8:11], s33 offen offset:0
  buffer_load_dwordx4 a[72:75], v1, s[8:11], s33 offen offset:1024
  buffer_load_dwordx4 a[76:79], v1, s[8:11], s33 offen offset:2048
  buffer_load_dwordx4 a[80:83], v1, s[8:11], s33 offen offset:3072
  s_add_u32 s33, s33, 4096
  buffer_load_dwordx4 a[84:87], v1, s[8:11], s33 offen offset:0
  buffer_load_dwordx4 a[88:91], v1, s[8:11], s33 offen offset:1024
  buffer_load_dwordx4 a[92:95], v1, s[8:11], s33 offen offset:2048
  buffer_load_dwordx4 a[96:99], v1, s[8:11], s33 offen offset:3072
  s_add_u32 s33, s33, 4096
  buffer_load_dwordx4 a[100:103], v1, s[8:11], s33 offen offset:0
  buffer_load_dwordx4 a[104:107], v1, s[8:11], s33 offen offset:1024
  buffer_load_dwordx4 a[108:111], v1, s[8:11], s33 offen offset:2048
  buffer_load_dwordx4 a[112:115], v1, s[8:11], s33 offen offset:3072
  s_add_u32 s16, s4, 67108864
  s_addc_u32 s17, s5, 0
  s_mov_b32 s18, 16777216
  s_mov_b32 s19, 0x00020000
  v_and_b32 v8, 15, v0
  v_bfe_u32 v9, v0, 4, 2
  v_lshlrev_b32 v9, 2, v9
  v_sub_u32 v8, v8, v9
  v_mov_b32 v4, 0xf149f2ca
  v_cmp_gt_i32 vcc, 0, v8
  s_nop 1
  v_cndmask_b32 v16, 0, v4, vcc
  v_cmp_gt_i32 vcc, 1, v8
  s_nop 1
  v_cndmask_b32 v17, 0, v4, vcc
  v_cmp_gt_i32 vcc, 2, v8
  s_nop 1
  v_cndmask_b32 v18, 0, v4, vcc
  v_cmp_gt_i32 vcc, 3, v8
  s_nop 1
  v_cndmask_b32 v19, 0, v4, vcc
  v_mov_b32 v8, 0x3f803f80
  v_accvgpr_write_b32 a48, v8
  v_accvgpr_write_b32 a49, v8
  v_accvgpr_write_b32 a50, v8
  v_accvgpr_write_b32 a51, v8
  v_accvgpr_write_b32 a0, 0
  v_accvgpr_write_b32 a1, 0
  v_accvgpr_write_b32 a2, 0
  v_accvgpr_write_b32 a3, 0
  v_accvgpr_write_b32 a4, 0
  v_accvgpr_write_b32 a5, 0
  v_accvgpr_write_b32 a6, 0
  v_accvgpr_write_b32 a7, 0
  v_accvgpr_write_b32 a8, 0
  v_accvgpr_write_b32 a9, 0
  v_accvgpr_write_b32 a10, 0
  v_accvgpr_write_b32 a11, 0
  v_accvgpr_write_b32 a12, 0
  v_accvgpr_write_b32 a13, 0
  v_accvgpr_write_b32 a14, 0
  v_accvgpr_write_b32 a15, 0
  v_accvgpr_write_b32 a16, 0
  v_accvgpr_write_b32 a17, 0
  v_accvgpr_write_b32 a18, 0
  v_accvgpr_write_b32 a19, 0
  v_accvgpr_write_b32 a20, 0
  v_accvgpr_write_b32 a21, 0
  v_accvgpr_write_b32 a22, 0
  v_accvgpr_write_b32 a23, 0
  v_accvgpr_write_b32 a24, 0
  v_accvgpr_write_b32 a25, 0
  v_accvgpr_write_b32 a26, 0
  v_accvgpr_write_b32 a27, 0
  v_accvgpr_write_b32 a28, 0
  v_accvgpr_write_b32 a29, 0
  v_accvgpr_write_b32 a30, 0
  v_accvgpr_write_b32 a31, 0
  v_accvgpr_write_b32 a32, 0
  v_accvgpr_write_b32 a33, 0
  v_accvgpr_write_b32 a34, 0
  v_accvgpr_write_b32 a35, 0
  v_accvgpr_write_b32 a36, 0
  v_accvgpr_write_b32 a37, 0
  v_accvgpr_write_b32 a38, 0
  v_accvgpr_write_b32 a39, 0
  v_accvgpr_write_b32 a40, 0
  v_accvgpr_write_b32 a41, 0
  v_accvgpr_write_b32 a42, 0
  v_accvgpr_write_b32 a43, 0
  v_accvgpr_write_b32 a44, 0
  v_accvgpr_write_b32 a45, 0
  v_accvgpr_write_b32 a46, 0
  v_accvgpr_write_b32 a47, 0
  v_mov_b32 v160, 0
  v_mov_b32 v161, 0
  v_mov_b32 v162, 0
  v_mov_b32 v163, 0
  v_mov_b32 v164, 0
  v_mov_b32 v165, 0
  v_mov_b32 v166, 0
  v_mov_b32 v167, 0
  v_mov_b32 v168, 0
  v_mov_b32 v169, 0
  v_mov_b32 v170, 0
  v_mov_b32 v171, 0
  v_mov_b32 v172, 0
  v_mov_b32 v173, 0
  v_mov_b32 v174, 0
  v_mov_b32 v175, 0
  v_mov_b32 v176, 0
  v_mov_b32 v177, 0
  v_mov_b32 v178, 0
  v_mov_b32 v179, 0
  v_mov_b32 v180, 0
  v_mov_b32 v181, 0
  v_mov_b32 v182, 0
  v_mov_b32 v183, 0
  v_mov_b32 v184, 0
  v_mov_b32 v185, 0
  v_mov_b32 v186, 0
  v_mov_b32 v187, 0
  v_mov_b32 v188, 0
  v_mov_b32 v189, 0
  v_mov_b32 v190, 0
  v_mov_b32 v191, 0
  v_mov_b32 v192, 0
  v_mov_b32 v193, 0
  v_mov_b32 v194, 0
  v_mov_b32 v195, 0
  v_mov_b32 v196, 0
  v_mov_b32 v197, 0
  v_mov_b32 v198, 0
  v_mov_b32 v199, 0
  v_mov_b32 v200, 0
  v_mov_b32 v201, 0
  v_mov_b32 v202, 0
  v_mov_b32 v203, 0
  v_mov_b32 v204, 0
  v_mov_b32 v205, 0
  v_mov_b32 v206, 0
  v_mov_b32 v207, 0
  v_mov_b32 v208, 0
  v_mov_b32 v209, 0
  v_mov_b32 v210, 0
  v_mov_b32 v211, 0
  v_mov_b32 v212, 0
  v_mov_b32 v213, 0
  v_mov_b32 v214, 0
  v_mov_b32 v215, 0
  v_mov_b32 v216, 0
  v_mov_b32 v217, 0
  v_mov_b32 v218, 0
  v_mov_b32 v219, 0
  v_mov_b32 v220, 0
  v_mov_b32 v221, 0
  v_mov_b32 v222, 0
  v_mov_b32 v223, 0
  v_mov_b32 v224, 0
  v_mov_b32 v225, 0
  v_mov_b32 v226, 0
  v_mov_b32 v227, 0
  v_mov_b32 v228, 0
  v_mov_b32 v229, 0
  v_mov_b32 v230, 0
  v_mov_b32 v231, 0
  v_mov_b32 v232, 0
  v_mov_b32 v233, 0
  v_mov_b32 v234, 0
  v_mov_b32 v235, 0
  v_mov_b32 v236, 0
  v_mov_b32 v237, 0
  v_mov_b32 v238, 0
  v_mov_b32 v239, 0
  v_mov_b32 v240, 0
  v_mov_b32 v241, 0
  v_mov_b32 v242, 0
  v_mov_b32 v243, 0
  v_mov_b32 v244, 0
  v_mov_b32 v245, 0
  v_mov_b32 v246, 0
  v_mov_b32 v247, 0
  v_mov_b32 v248, 0
  v_mov_b32 v249, 0
  v_mov_b32 v250, 0
  v_mov_b32 v251, 0
  v_mov_b32 v252, 0
  v_mov_b32 v253, 0
  v_mov_b32 v254, 0
  v_mov_b32 v255, 0
  s_lshl_b32 s33, s23, 6
  s_add_i32 s33, s33, s31
  s_cmp_gt_i32 s33, 0
  s_cselect_b32 s34, 0, 0xf149f2ca
  s_cmp_lt_i32 s33, 0
  s_cselect_b32 s33, 0xf149f2ca, 0
  v_mov_b32 v20, s34
  v_mov_b32 v21, s34
  v_mov_b32 v22, s34
  v_mov_b32 v23, s34
  v_mov_b32 v28, s33
  v_mov_b32 v29, s33
  v_mov_b32 v30, s33
  v_mov_b32 v31, s33
  v_med3_f32 v24, v16, v20, v28
  v_med3_f32 v25, v17, v20, v28
  v_med3_f32 v26, v18, v20, v28
  v_med3_f32 v27, v19, v20, v28
  s_waitcnt vmcnt(0)
  s_barrier
  ds_read_b128 a[116:119], v3 offset:0
  ds_read_b128 a[120:123], v3 offset:1024
  ds_read_b128 a[124:127], v3 offset:2048
  ds_read_b128 a[128:131], v3 offset:3072
  ds_read_b128 a[132:135], v3 offset:4096
  ds_read_b128 a[136:139], v3 offset:5120
  ds_read_b128 a[140:143], v3 offset:6144
  ds_read_b128 a[144:147], v3 offset:7168
  s_add_u32 m0, s29, 0
  s_add_u32 s32, s25, 4096
  buffer_load_dwordx4 v1, s[12:15], s25 offen offset:0 lds
  buffer_load_dwordx4 v1, s[12:15], s25 offen offset:1024 lds
  buffer_load_dwordx4 v1, s[12:15], s25 offen offset:2048 lds
  buffer_load_dwordx4 v1, s[12:15], s25 offen offset:3072 lds
  s_add_u32 m0, s29, 4096
  s_nop 0
  buffer_load_dwordx4 v1, s[12:15], s32 offen offset:0 lds
  buffer_load_dwordx4 v1, s[12:15], s32 offen offset:1024 lds
  buffer_load_dwordx4 v1, s[12:15], s32 offen offset:2048 lds
  buffer_load_dwordx4 v1, s[12:15], s32 offen offset:3072 lds
  s_add_u32 s25, s25, 32768
  s_cmp_eq_u32 s25, s27
  s_cselect_b32 s25, s28, s25
  s_cselect_b32 s27, -1, s27
  s_waitcnt lgkmcnt(4)
  s_add_u32 m0, s29, 32768
  v_mfma_f32_16x16x32_bf16 v[32:35], a[116:119], a[52:55], v[24:27]
  v_mfma_f32_16x16x32_bf16 v[32:35], a[120:123], a[56:59], v[32:35]
  ds_read_b128 a[148:151], v3 offset:8192
  ds_read_b128 a[152:155], v3 offset:9216
  v_mfma_f32_16x16x32_bf16 v[32:35], a[124:127], a[60:63], v[32:35]
  v_mfma_f32_16x16x32_bf16 v[32:35], a[128:131], a[64:67], v[32:35]
  buffer_load_dwordx4 v1, s[12:15], s26 offen offset:0 lds
  s_add_u32 s32, s26, 4096
  v_mfma_f32_16x16x32_bf16 v[36:39], a[128:131], a[80:83], v[28:31]
  v_mfma_f32_16x16x32_bf16 v[36:39], a[124:127], a[76:79], v[36:39]
  v_mfma_f32_16x16x32_bf16 v[36:39], a[120:123], a[72:75], v[36:39]
  v_mfma_f32_16x16x32_bf16 v[36:39], a[116:119], a[68:71], v[36:39]
  buffer_load_dwordx4 v1, s[12:15], s26 offen offset:1024 lds
  v_mfma_f32_16x16x32_bf16 v[40:43], a[116:119], a[84:87], v[28:31]
  v_mfma_f32_16x16x32_bf16 v[40:43], a[120:123], a[88:91], v[40:43]
  ds_read_b128 a[156:159], v3 offset:10240
  ds_read_b128 a[160:163], v3 offset:11264
  v_mfma_f32_16x16x32_bf16 v[40:43], a[124:127], a[92:95], v[40:43]
  v_mfma_f32_16x16x32_bf16 v[40:43], a[128:131], a[96:99], v[40:43]
  buffer_load_dwordx4 v1, s[12:15], s26 offen offset:2048 lds
  v_mfma_f32_16x16x32_bf16 v[44:47], a[128:131], a[112:115], v[28:31]
  v_mfma_f32_16x16x32_bf16 v[44:47], a[124:127], a[108:111], v[44:47]
  v_mfma_f32_16x16x32_bf16 v[44:47], a[120:123], a[104:107], v[44:47]
  v_mfma_f32_16x16x32_bf16 v[44:47], a[116:119], a[100:103], v[44:47]
  buffer_load_dwordx4 v1, s[12:15], s26 offen offset:3072 lds
  s_add_u32 m0, s29, 36864
  s_waitcnt lgkmcnt(4)
  v_mfma_f32_16x16x32_bf16 v[48:51], a[132:135], a[52:55], v[20:23]
  v_mfma_f32_16x16x32_bf16 v[48:51], a[136:139], a[56:59], v[48:51]
  ds_read_b128 a[164:167], v3 offset:12288
  ds_read_b128 a[168:171], v3 offset:13312
  v_mfma_f32_16x16x32_bf16 v[48:51], a[140:143], a[60:63], v[48:51]
  v_mfma_f32_16x16x32_bf16 v[48:51], a[144:147], a[64:67], v[48:51]
  buffer_load_dwordx4 v1, s[12:15], s32 offen offset:0 lds
  v_mfma_f32_16x16x32_bf16 v[52:55], a[144:147], a[80:83], v[24:27]
  v_mfma_f32_16x16x32_bf16 v[52:55], a[140:143], a[76:79], v[52:55]
  v_mfma_f32_16x16x32_bf16 v[52:55], a[136:139], a[72:75], v[52:55]
  v_mfma_f32_16x16x32_bf16 v[52:55], a[132:135], a[68:71], v[52:55]
  buffer_load_dwordx4 v1, s[12:15], s32 offen offset:1024 lds
  v_mfma_f32_16x16x32_bf16 v[56:59], a[132:135], a[84:87], v[28:31]
  v_mfma_f32_16x16x32_bf16 v[56:59], a[136:139], a[88:91], v[56:59]
  ds_read_b128 a[172:175], v3 offset:14336
  ds_read_b128 a[176:179], v3 offset:15360
  v_mfma_f32_16x16x32_bf16 v[56:59], a[140:143], a[92:95], v[56:59]
  v_mfma_f32_16x16x32_bf16 v[56:59], a[144:147], a[96:99], v[56:59]
  buffer_load_dwordx4 v1, s[12:15], s32 offen offset:2048 lds
  v_mfma_f32_16x16x32_bf16 v[60:63], a[144:147], a[112:115], v[28:31]
  v_mfma_f32_16x16x32_bf16 v[60:63], a[140:143], a[108:111], v[60:63]
  v_mfma_f32_16x16x32_bf16 v[60:63], a[136:139], a[104:107], v[60:63]
  v_mfma_f32_16x16x32_bf16 v[60:63], a[132:135], a[100:103], v[60:63]
  buffer_load_dwordx4 v1, s[12:15], s32 offen offset:3072 lds
  s_waitcnt lgkmcnt(4)
  v_mfma_f32_16x16x32_bf16 v[64:67], a[148:151], a[52:55], v[20:23]
  v_mfma_f32_16x16x32_bf16 v[64:67], a[152:155], a[56:59], v[64:67]
  s_add_u32 s26, s26, 32768
  s_cmp_eq_u32 s26, s62
  s_cselect_b32 s26, s63, s26
  s_cselect_b32 s62, -1, s62
  v_mfma_f32_16x16x32_bf16 v[64:67], a[156:159], a[60:63], v[64:67]
  v_mfma_f32_16x16x32_bf16 v[64:67], a[160:163], a[64:67], v[64:67]
  v_mfma_f32_16x16x32_bf16 v[68:71], a[160:163], a[80:83], v[20:23]
  v_mfma_f32_16x16x32_bf16 v[68:71], a[156:159], a[76:79], v[68:71]
  v_mfma_f32_16x16x32_bf16 v[68:71], a[152:155], a[72:75], v[68:71]
  v_mfma_f32_16x16x32_bf16 v[68:71], a[148:151], a[68:71], v[68:71]
  v_mfma_f32_16x16x32_bf16 v[72:75], a[148:151], a[84:87], v[24:27]
  v_mfma_f32_16x16x32_bf16 v[72:75], a[152:155], a[88:91], v[72:75]
  v_mfma_f32_16x16x32_bf16 v[72:75], a[156:159], a[92:95], v[72:75]
  v_mfma_f32_16x16x32_bf16 v[72:75], a[160:163], a[96:99], v[72:75]
  v_mfma_f32_16x16x32_bf16 v[76:79], a[160:163], a[112:115], v[28:31]
  v_mfma_f32_16x16x32_bf16 v[76:79], a[156:159], a[108:111], v[76:79]
  s_waitcnt vmcnt(8) lgkmcnt(0)
  s_barrier
  ds_read_b128 a[116:119], v2 offset:0
  ds_read_b128 a[120:123], v2 offset:1024
  ds_read_b128 a[124:127], v2 offset:2048
  ds_read_b128 a[128:131], v2 offset:3072
  v_mfma_f32_16x16x32_bf16 v[76:79], a[152:155], a[104:107], v[76:79]
  v_mfma_f32_16x16x32_bf16 v[76:79], a[148:151], a[100:103], v[76:79]
  v_mfma_f32_16x16x32_bf16 v[80:83], a[164:167], a[52:55], v[20:23]
  v_mfma_f32_16x16x32_bf16 v[80:83], a[168:171], a[56:59], v[80:83]
  ds_read_b128 a[132:135], v2 offset:4096
  ds_read_b128 a[136:139], v2 offset:5120
  v_mfma_f32_16x16x32_bf16 v[80:83], a[172:175], a[60:63], v[80:83]
  v_mfma_f32_16x16x32_bf16 v[80:83], a[176:179], a[64:67], v[80:83]
  v_mfma_f32_16x16x32_bf16 v[84:87], a[176:179], a[80:83], v[20:23]
  v_mfma_f32_16x16x32_bf16 v[84:87], a[172:175], a[76:79], v[84:87]
  v_mfma_f32_16x16x32_bf16 v[84:87], a[168:171], a[72:75], v[84:87]
  v_mfma_f32_16x16x32_bf16 v[84:87], a[164:167], a[68:71], v[84:87]
  v_mfma_f32_16x16x32_bf16 v[88:91], a[164:167], a[84:87], v[20:23]
  v_mfma_f32_16x16x32_bf16 v[88:91], a[168:171], a[88:91], v[88:91]
  ds_read_b128 a[140:143], v2 offset:6144
  ds_read_b128 a[144:147], v2 offset:7168
  v_mfma_f32_16x16x32_bf16 v[88:91], a[172:175], a[92:95], v[88:91]
  v_mfma_f32_16x16x32_bf16 v[88:91], a[176:179], a[96:99], v[88:91]
  v_mfma_f32_16x16x32_bf16 v[92:95], a[176:179], a[112:115], v[24:27]
  v_mfma_f32_16x16x32_bf16 v[92:95], a[172:175], a[108:111], v[92:95]
  v_mfma_f32_16x16x32_bf16 v[92:95], a[168:171], a[104:107], v[92:95]
  v_mfma_f32_16x16x32_bf16 v[92:95], a[164:167], a[100:103], v[92:95]
  s_add_u32 m0, s29, 65536
  s_add_u32 s32, s25, 4096
  buffer_load_dwordx4 v1, s[12:15], s25 offen offset:0 lds
  buffer_load_dwordx4 v1, s[12:15], s25 offen offset:1024 lds
  buffer_load_dwordx4 v1, s[12:15], s25 offen offset:2048 lds
  buffer_load_dwordx4 v1, s[12:15], s25 offen offset:3072 lds
  s_add_u32 m0, s29, 69632
  s_nop 0
  buffer_load_dwordx4 v1, s[12:15], s32 offen offset:0 lds
  buffer_load_dwordx4 v1, s[12:15], s32 offen offset:1024 lds
  buffer_load_dwordx4 v1, s[12:15], s32 offen offset:2048 lds
  buffer_load_dwordx4 v1, s[12:15], s32 offen offset:3072 lds
  s_add_u32 s25, s25, 32768
  s_cmp_eq_u32 s25, s27
  s_cselect_b32 s25, s28, s25
  s_cselect_b32 s27, -1, s27
  v_exp_f32 v32, v32
  v_exp_f32 v33, v33
  v_exp_f32 v34, v34
  v_exp_f32 v35, v35
  v_exp_f32 v48, v48
  v_exp_f32 v49, v49
  v_exp_f32 v50, v50
  v_exp_f32 v51, v51
  v_cvt_pk_bf16_f32 v32, v32, v33
  v_cvt_pk_bf16_f32 v33, v34, v35
  v_exp_f32 v36, v36
  v_exp_f32 v37, v37
  v_exp_f32 v38, v38
  v_exp_f32 v39, v39
  v_cvt_pk_bf16_f32 v34, v48, v49
  v_cvt_pk_bf16_f32 v35, v50, v51
  v_exp_f32 v52, v52
  v_exp_f32 v53, v53
  v_exp_f32 v54, v54
  v_exp_f32 v55, v55
  v_cvt_pk_bf16_f32 v36, v36, v37
  v_cvt_pk_bf16_f32 v37, v38, v39
  v_exp_f32 v40, v40
  v_exp_f32 v41, v41
  v_exp_f32 v42, v42
  v_exp_f32 v43, v43
  v_cvt_pk_bf16_f32 v38, v52, v53
  v_cvt_pk_bf16_f32 v39, v54, v55
  v_exp_f32 v56, v56
  v_exp_f32 v57, v57
  v_exp_f32 v58, v58
  v_exp_f32 v59, v59
  v_cvt_pk_bf16_f32 v40, v40, v41
  v_cvt_pk_bf16_f32 v41, v42, v43
  v_exp_f32 v44, v44
  v_exp_f32 v45, v45
  v_exp_f32 v46, v46
  v_exp_f32 v47, v47
  v_cvt_pk_bf16_f32 v42, v56, v57
  v_cvt_pk_bf16_f32 v43, v58, v59
  v_exp_f32 v60, v60
  v_exp_f32 v61, v61
  v_exp_f32 v62, v62
  v_exp_f32 v63, v63
  v_cvt_pk_bf16_f32 v44, v44, v45
  v_cvt_pk_bf16_f32 v45, v46, v47
  v_cvt_pk_bf16_f32 v46, v60, v61
  v_cvt_pk_bf16_f32 v47, v62, v63
  s_cmp_eq_u32 s24, 1
  s_cbranch_scc1 Lk2_g1
  s_mov_b32 s30, s21
  s_cmp_eq_u32 s21, 0
  s_cbranch_scc1 Lk2_m2
Lk2_l1:
  s_waitcnt lgkmcnt(4)
  s_add_u32 m0, s29, 98304
  v_mfma_f32_16x16x32_bf16 v[96:99], a[116:119], a[52:55], 0
  v_exp_f32 v64, v64
  v_mfma_f32_16x16x32_bf16 v[96:99], a[120:123], a[56:59], v[96:99]
  ds_read_b128 a[148:151], v2 offset:8192
  ds_read_b128 a[152:155], v2 offset:9216
  v_mfma_f32_16x16x32_bf16 v[96:99], a[124:127], a[60:63], v[96:99]
  v_exp_f32 v65, v65
  v_mfma_f32_16x16x32_bf16 v[96:99], a[128:131], a[64:67], v[96:99]
  buffer_load_dwordx4 v1, s[12:15], s26 offen offset:0 lds
  s_add_u32 s32, s26, 4096
  v_mfma_f32_16x16x32_bf16 v[100:103], a[128:131], a[80:83], 0
  v_exp_f32 v66, v66
  v_mfma_f32_16x16x32_bf16 v[100:103], a[124:127], a[76:79], v[100:103]
  v_cvt_pk_bf16_f32 v64, v64, v65
  v_mfma_f32_16x16x32_bf16 v[100:103], a[120:123], a[72:75], v[100:103]
  v_exp_f32 v67, v67
  v_mfma_f32_16x16x32_bf16 v[100:103], a[116:119], a[68:71], v[100:103]
  buffer_load_dwordx4 v1, s[12:15], s26 offen offset:1024 lds
  v_mfma_f32_16x16x32_bf16 v[104:107], a[116:119], a[84:87], 0
  v_exp_f32 v80, v80
  v_mfma_f32_16x16x32_bf16 v[104:107], a[120:123], a[88:91], v[104:107]
  ds_read_b128 a[156:159], v2 offset:10240
  ds_read_b128 a[160:163], v2 offset:11264
  v_mfma_f32_16x16x32_bf16 v[104:107], a[124:127], a[92:95], v[104:107]
  v_exp_f32 v81, v81
  v_mfma_f32_16x16x32_bf16 v[104:107], a[128:131], a[96:99], v[104:107]
  buffer_load_dwordx4 v1, s[12:15], s26 offen offset:2048 lds
  v_mfma_f32_16x16x32_bf16 v[108:111], a[128:131], a[112:115], 0
  v_exp_f32 v82, v82
  v_mfma_f32_16x16x32_bf16 v[108:111], a[124:127], a[108:111], v[108:111]
  v_cvt_pk_bf16_f32 v65, v66, v67
  v_cvt_pk_bf16_f32 v66, v80, v81
  v_mfma_f32_16x16x32_bf16 v[108:111], a[120:123], a[104:107], v[108:111]
  v_exp_f32 v83, v83
  v_mfma_f32_16x16x32_bf16 v[108:111], a[116:119], a[100:103], v[108:111]
  buffer_load_dwordx4 v1, s[12:15], s26 offen offset:3072 lds
  s_add_u32 m0, s29, 102400
  s_waitcnt lgkmcnt(4)
  v_mfma_f32_16x16x32_bf16 v[112:115], a[132:135], a[52:55], 0
  v_exp_f32 v68, v68
  v_mfma_f32_16x16x32_bf16 v[112:115], a[136:139], a[56:59], v[112:115]
  ds_read_b128 a[164:167], v2 offset:12288
  ds_read_b128 a[168:171], v2 offset:13312
  v_mfma_f32_16x16x32_bf16 v[112:115], a[140:143], a[60:63], v[112:115]
  v_exp_f32 v69, v69
  v_mfma_f32_16x16x32_bf16 v[112:115], a[144:147], a[64:67], v[112:115]
  buffer_load_dwordx4 v1, s[12:15], s32 offen offset:0 lds
  v_mfma_f32_16x16x32_bf16 v[116:119], a[144:147], a[80:83], 0
  v_exp_f32 v70, v70
  v_mfma_f32_16x16x32_bf16 v[116:119], a[140:143], a[76:79], v[116:119]
  v_cvt_pk_bf16_f32 v67, v82, v83
  v_cvt_pk_bf16_f32 v68, v68, v69
  v_mfma_f32_16x16x32_bf16 v[116:119], a[136:139], a[72:75], v[116:119]
  v_exp_f32 v71, v71
  v_mfma_f32_16x16x32_bf16 v[116:119], a[132:135], a[68:71], v[116:119]
  buffer_load_dwordx4 v1, s[12:15], s32 offen offset:1024 lds
  v_mfma_f32_16x16x32_bf16 v[120:123], a[132:135], a[84:87], 0
  v_exp_f32 v84, v84
  v_mfma_f32_16x16x32_bf16 v[120:123], a[136:139], a[88:91], v[120:123]
  ds_read_b128 a[172:175], v2 offset:14336
  ds_read_b128 a[176:179], v2 offset:15360
  v_mfma_f32_16x16x32_bf16 v[120:123], a[140:143], a[92:95], v[120:123]
  v_exp_f32 v85, v85
  v_mfma_f32_16x16x32_bf16 v[120:123], a[144:147], a[96:99], v[120:123]
  buffer_load_dwordx4 v1, s[12:15], s32 offen offset:2048 lds
  v_mfma_f32_16x16x32_bf16 v[124:127], a[144:147], a[112:115], 0
  v_exp_f32 v86, v86
  v_mfma_f32_16x16x32_bf16 v[124:127], a[140:143], a[108:111], v[124:127]
  v_cvt_pk_bf16_f32 v69, v70, v71
  v_cvt_pk_bf16_f32 v70, v84, v85
  v_mfma_f32_16x16x32_bf16 v[124:127], a[136:139], a[104:107], v[124:127]
  v_exp_f32 v87, v87
  v_mfma_f32_16x16x32_bf16 v[124:127], a[132:135], a[100:103], v[124:127]
  buffer_load_dwordx4 v1, s[12:15], s32 offen offset:3072 lds
  s_waitcnt lgkmcnt(4)
  v_mfma_f32_16x16x32_bf16 v[128:131], a[148:151], a[52:55], 0
  v_exp_f32 v72, v72
  v_mfma_f32_16x16x32_bf16 v[128:131], a[152:155], a[56:59], v[128:131]
  s_add_u32 s26, s26, 32768
  s_cmp_eq_u32 s26, s62
  s_cselect_b32 s26, s63, s26
  s_cselect_b32 s62, -1, s62
  v_mfma_f32_16x16x32_bf16 v[128:131], a[156:159], a[60:63], v[128:131]
  v_exp_f32 v73, v73
  v_mfma_f32_16x16x32_bf16 v[128:131], a[160:163], a[64:67], v[128:131]
  v_cvt_pk_bf16_f32 v71, v86, v87
  v_cvt_pk_bf16_f32 v72, v72, v73
  v_mfma_f32_16x16x32_bf16 v[132:135], a[160:163], a[80:83], 0
  v_exp_f32 v74, v74
  v_mfma_f32_16x16x32_bf16 v[132:135], a[156:159], a[76:79], v[132:135]
  v_mfma_f32_16x16x32_bf16 v[132:135], a[152:155], a[72:75], v[132:135]
  v_exp_f32 v75, v75
  v_mfma_f32_16x16x32_bf16 v[132:135], a[148:151], a[68:71], v[132:135]
  v_cvt_pk_bf16_f32 v73, v74, v75
  v_mfma_f32_16x16x32_bf16 v[136:139], a[148:151], a[84:87], 0
  v_exp_f32 v88, v88
  v_mfma_f32_16x16x32_bf16 v[136:139], a[152:155], a[88:91], v[136:139]
  v_mfma_f32_16x16x32_bf16 v[136:139], a[156:159], a[92:95], v[136:139]
  v_exp_f32 v89, v89
  v_mfma_f32_16x16x32_bf16 v[136:139], a[160:163], a[96:99], v[136:139]
  v_cvt_pk_bf16_f32 v74, v88, v89
  v_mfma_f32_16x16x32_bf16 v[140:143], a[160:163], a[112:115], 0
  v_exp_f32 v90, v90
  v_mfma_f32_16x16x32_bf16 v[140:143], a[156:159], a[108:111], v[140:143]
  s_waitcnt vmcnt(16) lgkmcnt(0)
  s_barrier
  ds_read_b128 a[116:119], v2 offset:32768
  ds_read_b128 a[120:123], v2 offset:40960
  ds_read_b128 a[124:127], v2 offset:33792
  ds_read_b128 a[128:131], v2 offset:41984
  v_mfma_f32_16x16x32_bf16 v[140:143], a[152:155], a[104:107], v[140:143]
  v_exp_f32 v91, v91
  v_mfma_f32_16x16x32_bf16 v[140:143], a[148:151], a[100:103], v[140:143]
  v_cvt_pk_bf16_f32 v75, v90, v91
  v_mfma_f32_16x16x32_bf16 v[144:147], a[164:167], a[52:55], 0
  v_exp_f32 v76, v76
  v_mfma_f32_16x16x32_bf16 v[144:147], a[168:171], a[56:59], v[144:147]
  ds_read_b128 a[132:135], v2 offset:34816
  ds_read_b128 a[136:139], v2 offset:43008
  v_mfma_f32_16x16x32_bf16 v[144:147], a[172:175], a[60:63], v[144:147]
  v_exp_f32 v77, v77
  v_mfma_f32_16x16x32_bf16 v[144:147], a[176:179], a[64:67], v[144:147]
  v_cvt_pk_bf16_f32 v76, v76, v77
  v_mfma_f32_16x16x32_bf16 v[148:151], a[176:179], a[80:83], 0
  v_exp_f32 v78, v78
  v_mfma_f32_16x16x32_bf16 v[148:151], a[172:175], a[76:79], v[148:151]
  v_mfma_f32_16x16x32_bf16 v[148:151], a[168:171], a[72:75], v[148:151]
  v_exp_f32 v79, v79
  v_mfma_f32_16x16x32_bf16 v[148:151], a[164:167], a[68:71], v[148:151]
  v_cvt_pk_bf16_f32 v77, v78, v79
  v_mfma_f32_16x16x32_bf16 v[152:155], a[164:167], a[84:87], 0
  v_exp_f32 v92, v92
  v_mfma_f32_16x16x32_bf16 v[152:155], a[168:171], a[88:91], v[152:155]
  ds_read_b128 a[140:143], v2 offset:35840
  ds_read_b128 a[144:147], v2 offset:44032
  v_mfma_f32_16x16x32_bf16 v[152:155], a[172:175], a[92:95], v[152:155]
  v_exp_f32 v93, v93
  v_mfma_f32_16x16x32_bf16 v[152:155], a[176:179], a[96:99], v[152:155]
  v_cvt_pk_bf16_f32 v78, v92, v93
  v_mfma_f32_16x16x32_bf16 v[156:159], a[176:179], a[112:115], 0
  v_exp_f32 v94, v94
  v_mfma_f32_16x16x32_bf16 v[156:159], a[172:175], a[108:111], v[156:159]
  v_mfma_f32_16x16x32_bf16 v[156:159], a[168:171], a[104:107], v[156:159]
  v_exp_f32 v95, v95
  v_mfma_f32_16x16x32_bf16 v[156:159], a[164:167], a[100:103], v[156:159]
  v_cvt_pk_bf16_f32 v79, v94, v95
  s_waitcnt lgkmcnt(6)
  s_add_u32 m0, s29, 0
  v_mfma_f32_16x16x32_bf16 v[160:163], a[116:119], v[32:35], v[160:163]
  v_exp_f32 v96, v96
  v_mfma_f32_16x16x32_bf16 v[160:163], a[120:123], v[64:67], v[160:163]
  ds_read_b128 a[148:151], v2 offset:36864
  ds_read_b128 a[152:155], v2 offset:45056
  v_mfma_f32_16x16x32_bf16 v[164:167], a[120:123], v[68:71], v[164:167]
  v_exp_f32 v97, v97
  v_mfma_f32_16x16x32_bf16 v[164:167], a[116:119], v[36:39], v[164:167]
  buffer_load_dwordx4 v1, s[12:15], s25 offen offset:0 lds
  s_add_u32 s32, s25, 4096
  v_mfma_f32_16x16x32_bf16 v[168:171], a[116:119], v[40:43], v[168:171]
  v_exp_f32 v98, v98
  v_mfma_f32_16x16x32_bf16 v[168:171], a[120:123], v[72:75], v[168:171]
  v_cvt_pk_bf16_f32 v96, v96, v97
  v_mfma_f32_16x16x32_bf16 v[172:175], a[120:123], v[76:79], v[172:175]
  v_exp_f32 v99, v99
  v_mfma_f32_16x16x32_bf16 v[172:175], a[116:119], v[44:47], v[172:175]
  buffer_load_dwordx4 v1, s[12:15], s25 offen offset:1024 lds
  s_waitcnt lgkmcnt(6)
  v_mfma_f32_16x16x32_bf16 a[32:35], a[48:51], v[32:35], a[32:35]
  v_mfma_f32_16x16x32_bf16 a[32:35], a[48:51], v[64:67], a[32:35]
  v_mfma_f32_16x16x32_bf16 v[176:179], a[124:127], v[32:35], v[176:179]
  v_exp_f32 v112, v112
  v_mfma_f32_16x16x32_bf16 v[176:179], a[128:131], v[64:67], v[176:179]
  ds_read_b128 a[156:159], v2 offset:37888
  ds_read_b128 a[160:163], v2 offset:46080
  v_mfma_f32_16x16x32_bf16 v[180:183], a[128:131], v[68:71], v[180:183]
  v_exp_f32 v113, v113
  v_mfma_f32_16x16x32_bf16 v[180:183], a[124:127], v[36:39], v[180:183]
  buffer_load_dwordx4 v1, s[12:15], s25 offen offset:2048 lds
  v_mfma_f32_16x16x32_bf16 v[184:187], a[124:127], v[40:43], v[184:187]
  v_exp_f32 v114, v114
  v_mfma_f32_16x16x32_bf16 v[184:187], a[128:131], v[72:75], v[184:187]
  v_cvt_pk_bf16_f32 v97, v98, v99
  v_cvt_pk_bf16_f32 v98, v112, v113
  v_mfma_f32_16x16x32_bf16 v[188:191], a[128:131], v[76:79], v[188:191]
  v_exp_f32 v115, v115
  v_mfma_f32_16x16x32_bf16 v[188:191], a[124:127], v[44:47], v[188:191]
  buffer_load_dwordx4 v1, s[12:15], s25 offen offset:3072 lds
  s_add_u32 m0, s29, 4096
  s_waitcnt lgkmcnt(6)
  v_mfma_f32_16x16x32_bf16 a[36:39], a[48:51], v[36:39], a[36:39]
  v_mfma_f32_16x16x32_bf16 a[36:39], a[48:51], v[68:71], a[36:39]
  v_mfma_f32_16x16x32_bf16 v[192:195], a[132:135], v[32:35], v[192:195]
  v_exp_f32 v100, v100
  v_mfma_f32_16x16x32_bf16 v[192:195], a[136:139], v[64:67], v[192:195]
  ds_read_b128 a[164:167], v2 offset:38912
  ds_read_b128 a[168:171], v2 offset:47104
  v_mfma_f32_16x16x32_bf16 v[196:199], a[136:139], v[68:71], v[196:199]
  v_exp_f32 v101, v101
  v_mfma_f32_16x16x32_bf16 v[196:199], a[132:135], v[36:39], v[196:199]
  buffer_load_dwordx4 v1, s[12:15], s32 offen offset:0 lds
  v_mfma_f32_16x16x32_bf16 v[200:203], a[132:135], v[40:43], v[200:203]
  v_exp_f32 v102, v102
  v_mfma_f32_16x16x32_bf16 v[200:203], a[136:139], v[72:75], v[200:203]
  v_cvt_pk_bf16_f32 v99, v114, v115
  v_cvt_pk_bf16_f32 v100, v100, v101
  v_mfma_f32_16x16x32_bf16 v[204:207], a[136:139], v[76:79], v[204:207]
  v_exp_f32 v103, v103
  v_mfma_f32_16x16x32_bf16 v[204:207], a[132:135], v[44:47], v[204:207]
  buffer_load_dwordx4 v1, s[12:15], s32 offen offset:1024 lds
  s_waitcnt lgkmcnt(6)
  v_mfma_f32_16x16x32_bf16 a[40:43], a[48:51], v[40:43], a[40:43]
  v_mfma_f32_16x16x32_bf16 a[40:43], a[48:51], v[72:75], a[40:43]
  v_mfma_f32_16x16x32_bf16 v[208:211], a[140:143], v[32:35], v[208:211]
  v_exp_f32 v116, v116
  v_mfma_f32_16x16x32_bf16 v[208:211], a[144:147], v[64:67], v[208:211]
  ds_read_b128 a[172:175], v2 offset:39936
  ds_read_b128 a[176:179], v2 offset:48128
  v_mfma_f32_16x16x32_bf16 v[212:215], a[144:147], v[68:71], v[212:215]
  v_exp_f32 v117, v117
  v_mfma_f32_16x16x32_bf16 v[212:215], a[140:143], v[36:39], v[212:215]
  buffer_load_dwordx4 v1, s[12:15], s32 offen offset:2048 lds
  v_mfma_f32_16x16x32_bf16 v[216:219], a[140:143], v[40:43], v[216:219]
  v_exp_f32 v118, v118
  v_mfma_f32_16x16x32_bf16 v[216:219], a[144:147], v[72:75], v[216:219]
  v_cvt_pk_bf16_f32 v101, v102, v103
  v_cvt_pk_bf16_f32 v102, v116, v117
  v_mfma_f32_16x16x32_bf16 v[220:223], a[144:147], v[76:79], v[220:223]
  v_exp_f32 v119, v119
  v_mfma_f32_16x16x32_bf16 v[220:223], a[140:143], v[44:47], v[220:223]
  buffer_load_dwordx4 v1, s[12:15], s32 offen offset:3072 lds
  s_waitcnt lgkmcnt(6)
  v_mfma_f32_16x16x32_bf16 a[44:47], a[48:51], v[44:47], a[44:47]
  v_mfma_f32_16x16x32_bf16 a[44:47], a[48:51], v[76:79], a[44:47]
  v_mfma_f32_16x16x32_bf16 v[224:227], a[148:151], v[32:35], v[224:227]
  v_exp_f32 v104, v104
  v_mfma_f32_16x16x32_bf16 v[224:227], a[152:155], v[64:67], v[224:227]
  s_add_u32 s25, s25, 32768
  s_cmp_eq_u32 s25, s27
  s_cselect_b32 s25, s28, s25
  s_cselect_b32 s27, -1, s27
  v_mfma_f32_16x16x32_bf16 v[228:231], a[152:155], v[68:71], v[228:231]
  v_exp_f32 v105, v105
  v_mfma_f32_16x16x32_bf16 v[228:231], a[148:151], v[36:39], v[228:231]
  v_cvt_pk_bf16_f32 v103, v118, v119
  v_cvt_pk_bf16_f32 v104, v104, v105
  v_mfma_f32_16x16x32_bf16 v[232:235], a[148:151], v[40:43], v[232:235]
  v_exp_f32 v106, v106
  v_mfma_f32_16x16x32_bf16 v[232:235], a[152:155], v[72:75], v[232:235]
  v_mfma_f32_16x16x32_bf16 v[236:239], a[152:155], v[76:79], v[236:239]
  v_exp_f32 v107, v107
  v_mfma_f32_16x16x32_bf16 v[236:239], a[148:151], v[44:47], v[236:239]
  v_cvt_pk_bf16_f32 v105, v106, v107
  s_waitcnt lgkmcnt(4)
  v_mfma_f32_16x16x32_bf16 v[240:243], a[156:159], v[32:35], v[240:243]
  v_exp_f32 v120, v120
  v_mfma_f32_16x16x32_bf16 v[240:243], a[160:163], v[64:67], v[240:243]
  v_mfma_f32_16x16x32_bf16 v[244:247], a[160:163], v[68:71], v[244:247]
  v_exp_f32 v121, v121
  v_mfma_f32_16x16x32_bf16 v[244:247], a[156:159], v[36:39], v[244:247]
  v_cvt_pk_bf16_f32 v106, v120, v121
  v_mfma_f32_16x16x32_bf16 v[248:251], a[156:159], v[40:43], v[248:251]
  v_exp_f32 v122, v122
  v_mfma_f32_16x16x32_bf16 v[248:251], a[160:163], v[72:75], v[248:251]
  s_waitcnt vmcnt(16) lgkmcnt(0)
  s_barrier
  ds_read_b128 a[116:119], v3 offset:0
  ds_read_b128 a[120:123], v3 offset:1024
  ds_read_b128 a[124:127], v3 offset:2048
  ds_read_b128 a[128:131], v3 offset:3072
  v_mfma_f32_16x16x32_bf16 v[252:255], a[160:163], v[76:79], v[252:255]
  v_exp_f32 v123, v123
  v_mfma_f32_16x16x32_bf16 v[252:255], a[156:159], v[44:47], v[252:255]
  v_cvt_pk_bf16_f32 v107, v122, v123
  v_mfma_f32_16x16x32_bf16 a[0:3], a[164:167], v[32:35], a[0:3]
  v_exp_f32 v108, v108
  v_mfma_f32_16x16x32_bf16 a[0:3], a[168:171], v[64:67], a[0:3]
  ds_read_b128 a[132:135], v3 offset:4096
  ds_read_b128 a[136:139], v3 offset:5120
  v_mfma_f32_16x16x32_bf16 a[4:7], a[168:171], v[68:71], a[4:7]
  v_exp_f32 v109, v109
  v_mfma_f32_16x16x32_bf16 a[4:7], a[164:167], v[36:39], a[4:7]
  v_cvt_pk_bf16_f32 v108, v108, v109
  v_mfma_f32_16x16x32_bf16 a[8:11], a[164:167], v[40:43], a[8:11]
  v_exp_f32 v110, v110
  v_mfma_f32_16x16x32_bf16 a[8:11], a[168:171], v[72:75], a[8:11]
  v_mfma_f32_16x16x32_bf16 a[12:15], a[168:171], v[76:79], a[12:15]
  v_exp_f32 v111, v111
  v_mfma_f32_16x16x32_bf16 a[12:15], a[164:167], v[44:47], a[12:15]
  v_cvt_pk_bf16_f32 v109, v110, v111
  v_mfma_f32_16x16x32_bf16 a[16:19], a[172:175], v[32:35], a[16:19]
  v_exp_f32 v124, v124
  v_mfma_f32_16x16x32_bf16 a[16:19], a[176:179], v[64:67], a[16:19]
  ds_read_b128 a[140:143], v3 offset:6144
  ds_read_b128 a[144:147], v3 offset:7168
  v_mfma_f32_16x16x32_bf16 a[20:23], a[176:179], v[68:71], a[20:23]
  v_exp_f32 v125, v125
  v_mfma_f32_16x16x32_bf16 a[20:23], a[172:175], v[36:39], a[20:23]
  v_cvt_pk_bf16_f32 v110, v124, v125
  v_mfma_f32_16x16x32_bf16 a[24:27], a[172:175], v[40:43], a[24:27]
  v_exp_f32 v126, v126
  v_mfma_f32_16x16x32_bf16 a[24:27], a[176:179], v[72:75], a[24:27]
  v_mfma_f32_16x16x32_bf16 a[28:31], a[176:179], v[76:79], a[28:31]
  v_exp_f32 v127, v127
  v_mfma_f32_16x16x32_bf16 a[28:31], a[172:175], v[44:47], a[28:31]
  v_cvt_pk_bf16_f32 v111, v126, v127
  s_sub_u32 s30, s30, 1
  s_cmp_eq_u32 s30, 0
  s_cbranch_scc1 Lk2_m1
  s_waitcnt lgkmcnt(4)
  s_add_u32 m0, s29, 32768
  v_mfma_f32_16x16x32_bf16 v[32:35], a[116:119], a[52:55], 0
  v_exp_f32 v128, v128
  v_mfma_f32_16x16x32_bf16 v[32:35], a[120:123], a[56:59], v[32:35]
  ds_read_b128 a[148:151], v3 offset:8192
  ds_read_b128 a[152:155], v3 offset:9216
  v_mfma_f32_16x16x32_bf16 v[32:35], a[124:127], a[60:63], v[32:35]
  v_exp_f32 v129, v129
  v_mfma_f32_16x16x32_bf16 v[32:35], a[128:131], a[64:67], v[32:35]
  buffer_load_dwordx4 v1, s[12:15], s26 offen offset:0 lds
  s_add_u32 s32, s26, 4096
  v_mfma_f32_16x16x32_bf16 v[36:39], a[128:131], a[80:83], 0
  v_exp_f32 v130, v130
  v_mfma_f32_16x16x32_bf16 v[36:39], a[124:127], a[76:79], v[36:39]
  v_cvt_pk_bf16_f32 v128, v128, v129
  v_mfma_f32_16x16x32_bf16 v[36:39], a[120:123], a[72:75], v[36:39]
  v_exp_f32 v131, v131
  v_mfma_f32_16x16x32_bf16 v[36:39], a[116:119], a[68:71], v[36:39]
  buffer_load_dwordx4 v1, s[12:15], s26 offen offset:1024 lds
  v_mfma_f32_16x16x32_bf16 v[40:43], a[116:119], a[84:87], 0
  v_exp_f32 v144, v144
  v_mfma_f32_16x16x32_bf16 v[40:43], a[120:123], a[88:91], v[40:43]
  ds_read_b128 a[156:159], v3 offset:10240
  ds_read_b128 a[160:163], v3 offset:11264
  v_mfma_f32_16x16x32_bf16 v[40:43], a[124:127], a[92:95], v[40:43]
  v_exp_f32 v145, v145
  v_mfma_f32_16x16x32_bf16 v[40:43], a[128:131], a[96:99], v[40:43]
  buffer_load_dwordx4 v1, s[12:15], s26 offen offset:2048 lds
  v_mfma_f32_16x16x32_bf16 v[44:47], a[128:131], a[112:115], 0
  v_exp_f32 v146, v146
  v_mfma_f32_16x16x32_bf16 v[44:47], a[124:127], a[108:111], v[44:47]
  v_cvt_pk_bf16_f32 v129, v130, v131
  v_cvt_pk_bf16_f32 v130, v144, v145
  v_mfma_f32_16x16x32_bf16 v[44:47], a[120:123], a[104:107], v[44:47]
  v_exp_f32 v147, v147
  v_mfma_f32_16x16x32_bf16 v[44:47], a[116:119], a[100:103], v[44:47]
  buffer_load_dwordx4 v1, s[12:15], s26 offen offset:3072 lds
  s_add_u32 m0, s29, 36864
  s_waitcnt lgkmcnt(4)
  v_mfma_f32_16x16x32_bf16 v[48:51], a[132:135], a[52:55], 0
  v_exp_f32 v132, v132
  v_mfma_f32_16x16x32_bf16 v[48:51], a[136:139], a[56:59], v[48:51]
  ds_read_b128 a[164:167], v3 offset:12288
  ds_read_b128 a[168:171], v3 offset:13312
  v_mfma_f32_16x16x32_bf16 v[48:51], a[140:143], a[60:63], v[48:51]
  v_exp_f32 v133, v133
  v_mfma_f32_16x16x32_bf16 v[48:51], a[144:147], a[64:67], v[48:51]
  buffer_load_dwordx4 v1, s[12:15], s32 offen offset:0 lds
  v_mfma_f32_16x16x32_bf16 v[52:55], a[144:147], a[80:83], 0
  v_exp_f32 v134, v134
  v_mfma_f32_16x16x32_bf16 v[52:55], a[140:143], a[76:79], v[52:55]
  v_cvt_pk_bf16_f32 v131, v146, v147
  v_cvt_pk_bf16_f32 v132, v132, v133
  v_mfma_f32_16x16x32_bf16 v[52:55], a[136:139], a[72:75], v[52:55]
  v_exp_f32 v135, v135
  v_mfma_f32_16x16x32_bf16 v[52:55], a[132:135], a[68:71], v[52:55]
  buffer_load_dwordx4 v1, s[12:15], s32 offen offset:1024 lds
  v_mfma_f32_16x16x32_bf16 v[56:59], a[132:135], a[84:87], 0
  v_exp_f32 v148, v148
  v_mfma_f32_16x16x32_bf16 v[56:59], a[136:139], a[88:91], v[56:59]
  ds_read_b128 a[172:175], v3 offset:14336
  ds_read_b128 a[176:179], v3 offset:15360
  v_mfma_f32_16x16x32_bf16 v[56:59], a[140:143], a[92:95], v[56:59]
  v_exp_f32 v149, v149
  v_mfma_f32_16x16x32_bf16 v[56:59], a[144:147], a[96:99], v[56:59]
  buffer_load_dwordx4 v1, s[12:15], s32 offen offset:2048 lds
  v_mfma_f32_16x16x32_bf16 v[60:63], a[144:147], a[112:115], 0
  v_exp_f32 v150, v150
  v_mfma_f32_16x16x32_bf16 v[60:63], a[140:143], a[108:111], v[60:63]
  v_cvt_pk_bf16_f32 v133, v134, v135
  v_cvt_pk_bf16_f32 v134, v148, v149
  v_mfma_f32_16x16x32_bf16 v[60:63], a[136:139], a[104:107], v[60:63]
  v_exp_f32 v151, v151
  v_mfma_f32_16x16x32_bf16 v[60:63], a[132:135], a[100:103], v[60:63]
  buffer_load_dwordx4 v1, s[12:15], s32 offen offset:3072 lds
  s_waitcnt lgkmcnt(4)
  v_mfma_f32_16x16x32_bf16 v[64:67], a[148:151], a[52:55], 0
  v_exp_f32 v136, v136
  v_mfma_f32_16x16x32_bf16 v[64:67], a[152:155], a[56:59], v[64:67]
  s_add_u32 s26, s26, 32768
  s_cmp_eq_u32 s26, s62
  s_cselect_b32 s26, s63, s26
  s_cselect_b32 s62, -1, s62
  v_mfma_f32_16x16x32_bf16 v[64:67], a[156:159], a[60:63], v[64:67]
  v_exp_f32 v137, v137
  v_mfma_f32_16x16x32_bf16 v[64:67], a[160:163], a[64:67], v[64:67]
  v_cvt_pk_bf16_f32 v135, v150, v151
  v_cvt_pk_bf16_f32 v136, v136, v137
  v_mfma_f32_16x16x32_bf16 v[68:71], a[160:163], a[80:83], 0
  v_exp_f32 v138, v138
  v_mfma_f32_16x16x32_bf16 v[68:71], a[156:159], a[76:79], v[68:71]
  v_mfma_f32_16x16x32_bf16 v[68:71], a[152:155], a[72:75], v[68:71]
  v_exp_f32 v139, v139
  v_mfma_f32_16x16x32_bf16 v[68:71], a[148:151], a[68:71], v[68:71]
  v_cvt_pk_bf16_f32 v137, v138, v139
  v_mfma_f32_16x16x32_bf16 v[72:75], a[148:151], a[84:87], 0
  v_exp_f32 v152, v152
  v_mfma_f32_16x16x32_bf16 v[72:75], a[152:155], a[88:91], v[72:75]
  v_mfma_f32_16x16x32_bf16 v[72:75], a[156:159], a[92:95], v[72:75]
  v_exp_f32 v153, v153
  v_mfma_f32_16x16x32_bf16 v[72:75], a[160:163], a[96:99], v[72:75]
  v_cvt_pk_bf16_f32 v138, v152, v153
  v_mfma_f32_16x16x32_bf16 v[76:79], a[160:163], a[112:115], 0
  v_exp_f32 v154, v154
  v_mfma_f32_16x16x32_bf16 v[76:79], a[156:159], a[108:111], v[76:79]
  s_waitcnt vmcnt(16) lgkmcnt(0)
  s_barrier
  ds_read_b128 a[116:119], v3 offset:32768
  ds_read_b128 a[120:123], v3 offset:40960
  ds_read_b128 a[124:127], v3 offset:33792
  ds_read_b128 a[128:131], v3 offset:41984
  v_mfma_f32_16x16x32_bf16 v[76:79], a[152:155], a[104:107], v[76:79]
  v_exp_f32 v155, v155
  v_mfma_f32_16x16x32_bf16 v[76:79], a[148:151], a[100:103], v[76:79]
  v_cvt_pk_bf16_f32 v139, v154, v155
  v_mfma_f32_16x16x32_bf16 v[80:83], a[164:167], a[52:55], 0
  v_exp_f32 v140, v140
  v_mfma_f32_16x16x32_bf16 v[80:83], a[168:171], a[56:59], v[80:83]
  ds_read_b128 a[132:135], v3 offset:34816
  ds_read_b128 a[136:139], v3 offset:43008
  v_mfma_f32_16x16x32_bf16 v[80:83], a[172:175], a[60:63], v[80:83]
  v_exp_f32 v141, v141
  v_mfma_f32_16x16x32_bf16 v[80:83], a[176:179], a[64:67], v[80:83]
  v_cvt_pk_bf16_f32 v140, v140, v141
  v_mfma_f32_16x16x32_bf16 v[84:87], a[176:179], a[80:83], 0
  v_exp_f32 v142, v142
  v_mfma_f32_16x16x32_bf16 v[84:87], a[172:175], a[76:79], v[84:87]
  v_mfma_f32_16x16x32_bf16 v[84:87], a[168:171], a[72:75], v[84:87]
  v_exp_f32 v143, v143
  v_mfma_f32_16x16x32_bf16 v[84:87], a[164:167], a[68:71], v[84:87]
  v_cvt_pk_bf16_f32 v141, v142, v143
  v_mfma_f32_16x16x32_bf16 v[88:91], a[164:167], a[84:87], 0
  v_exp_f32 v156, v156
  v_mfma_f32_16x16x32_bf16 v[88:91], a[168:171], a[88:91], v[88:91]
  ds_read_b128 a[140:143], v3 offset:35840
  ds_read_b128 a[144:147], v3 offset:44032
  v_mfma_f32_16x16x32_bf16 v[88:91], a[172:175], a[92:95], v[88:91]
  v_exp_f32 v157, v157
  v_mfma_f32_16x16x32_bf16 v[88:91], a[176:179], a[96:99], v[88:91]
  v_cvt_pk_bf16_f32 v142, v156, v157
  v_mfma_f32_16x16x32_bf16 v[92:95], a[176:179], a[112:115], 0
  v_exp_f32 v158, v158
  v_mfma_f32_16x16x32_bf16 v[92:95], a[172:175], a[108:111], v[92:95]
  v_mfma_f32_16x16x32_bf16 v[92:95], a[168:171], a[104:107], v[92:95]
  v_exp_f32 v159, v159
  v_mfma_f32_16x16x32_bf16 v[92:95], a[164:167], a[100:103], v[92:95]
  v_cvt_pk_bf16_f32 v143, v158, v159
  s_waitcnt lgkmcnt(6)
  s_add_u32 m0, s29, 65536
  v_mfma_f32_16x16x32_bf16 v[160:163], a[116:119], v[96:99], v[160:163]
  v_exp_f32 v32, v32
  v_mfma_f32_16x16x32_bf16 v[160:163], a[120:123], v[128:131], v[160:163]
  ds_read_b128 a[148:151], v3 offset:36864
  ds_read_b128 a[152:155], v3 offset:45056
  v_mfma_f32_16x16x32_bf16 v[164:167], a[120:123], v[132:135], v[164:167]
  v_exp_f32 v33, v33
  v_mfma_f32_16x16x32_bf16 v[164:167], a[116:119], v[100:103], v[164:167]
  buffer_load_dwordx4 v1, s[12:15], s25 offen offset:0 lds
  s_add_u32 s32, s25, 4096
  v_mfma_f32_16x16x32_bf16 v[168:171], a[116:119], v[104:107], v[168:171]
  v_exp_f32 v34, v34
  v_mfma_f32_16x16x32_bf16 v[168:171], a[120:123], v[136:139], v[168:171]
  v_cvt_pk_bf16_f32 v32, v32, v33
  v_mfma_f32_16x16x32_bf16 v[172:175], a[120:123], v[140:143], v[172:175]
  v_exp_f32 v35, v35
  v_mfma_f32_16x16x32_bf16 v[172:175], a[116:119], v[108:111], v[172:175]
  buffer_load_dwordx4 v1, s[12:15], s25 offen offset:1024 lds
  s_waitcnt lgkmcnt(6)
  v_mfma_f32_16x16x32_bf16 a[32:35], a[48:51], v[96:99], a[32:35]
  v_mfma_f32_16x16x32_bf16 a[32:35], a[48:51], v[128:131], a[32:35]
  v_mfma_f32_16x16x32_bf16 v[176:179], a[124:127], v[96:99], v[176:179]
  v_exp_f32 v48, v48
  v_mfma_f32_16x16x32_bf16 v[176:179], a[128:131], v[128:131], v[176:179]
  ds_read_b128 a[156:159], v3 offset:37888
  ds_read_b128 a[160:163], v3 offset:46080
  v_mfma_f32_16x16x32_bf16 v[180:183], a[128:131], v[132:135], v[180:183]
  v_exp_f32 v49, v49
  v_mfma_f32_16x16x32_bf16 v[180:183], a[124:127], v[100:103], v[180:183]
  buffer_load_dwordx4 v1, s[12:15], s25 offen offset:2048 lds
  v_mfma_f32_16x16x32_bf16 v[184:187], a[124:127], v[104:107], v[184:187]
  v_exp_f32 v50, v50
  v_mfma_f32_16x16x32_bf16 v[184:187], a[128:131], v[136:139], v[184:187]
  v_cvt_pk_bf16_f32 v33, v34, v35
  v_cvt_pk_bf16_f32 v34, v48, v49
  v_mfma_f32_16x16x32_bf16 v[188:191], a[128:131], v[140:143], v[188:191]
  v_exp_f32 v51, v51
  v_mfma_f32_16x16x32_bf16 v[188:191], a[124:127], v[108:111], v[188:191]
  buffer_load_dwordx4 v1, s[12:15], s25 offen offset:3072 lds
  s_add_u32 m0, s29, 69632
  s_waitcnt lgkmcnt(6)
  v_mfma_f32_16x16x32_bf16 a[36:39], a[48:51], v[100:103], a[36:39]
  v_mfma_f32_16x16x32_bf16 a[36:39], a[48:51], v[132:135], a[36:39]
  v_mfma_f32_16x16x32_bf16 v[192:195], a[132:135], v[96:99], v[192:195]
  v_exp_f32 v36, v36
  v_mfma_f32_16x16x32_bf16 v[192:195], a[136:139], v[128:131], v[192:195]
  ds_read_b128 a[164:167], v3 offset:38912
  ds_read_b128 a[168:171], v3 offset:47104
  v_mfma_f32_16x16x32_bf16 v[196:199], a[136:139], v[132:135], v[196:199]
  v_exp_f32 v37, v37
  v_mfma_f32_16x16x32_bf16 v[196:199], a[132:135], v[100:103], v[196:199]
  buffer_load_dwordx4 v1, s[12:15], s32 offen offset:0 lds
  v_mfma_f32_16x16x32_bf16 v[200:203], a[132:135], v[104:107], v[200:203]
  v_exp_f32 v38, v38
  v_mfma_f32_16x16x32_bf16 v[200:203], a[136:139], v[136:139], v[200:203]
  v_cvt_pk_bf16_f32 v35, v50, v51
  v_cvt_pk_bf16_f32 v36, v36, v37
  v_mfma_f32_16x16x32_bf16 v[204:207], a[136:139], v[140:143], v[204:207]
  v_exp_f32 v39, v39
  v_mfma_f32_16x16x32_bf16 v[204:207], a[132:135], v[108:111], v[204:207]
  buffer_load_dwordx4 v1, s[12:15], s32 offen offset:1024 lds
  s_waitcnt lgkmcnt(6)
  v_mfma_f32_16x16x32_bf16 a[40:43], a[48:51], v[104:107], a[40:43]
  v_mfma_f32_16x16x32_bf16 a[40:43], a[48:51], v[136:139], a[40:43]
  v_mfma_f32_16x16x32_bf16 v[208:211], a[140:143], v[96:99], v[208:211]
  v_exp_f32 v52, v52
  v_mfma_f32_16x16x32_bf16 v[208:211], a[144:147], v[128:131], v[208:211]
  ds_read_b128 a[172:175], v3 offset:39936
  ds_read_b128 a[176:179], v3 offset:48128
  v_mfma_f32_16x16x32_bf16 v[212:215], a[144:147], v[132:135], v[212:215]
  v_exp_f32 v53, v53
  v_mfma_f32_16x16x32_bf16 v[212:215], a[140:143], v[100:103], v[212:215]
  buffer_load_dwordx4 v1, s[12:15], s32 offen offset:2048 lds
  v_mfma_f32_16x16x32_bf16 v[216:219], a[140:143], v[104:107], v[216:219]
  v_exp_f32 v54, v54
  v_mfma_f32_16x16x32_bf16 v[216:219], a[144:147], v[136:139], v[216:219]
  v_cvt_pk_bf16_f32 v37, v38, v39
  v_cvt_pk_bf16_f32 v38, v52, v53
  v_mfma_f32_16x16x32_bf16 v[220:223], a[144:147], v[140:143], v[220:223]
  v_exp_f32 v55, v55
  v_mfma_f32_16x16x32_bf16 v[220:223], a[140:143], v[108:111], v[220:223]
  buffer_load_dwordx4 v1, s[12:15], s32 offen offset:3072 lds
  s_waitcnt lgkmcnt(6)
  v_mfma_f32_16x16x32_bf16 a[44:47], a[48:51], v[108:111], a[44:47]
  v_mfma_f32_16x16x32_bf16 a[44:47], a[48:51], v[140:143], a[44:47]
  v_mfma_f32_16x16x32_bf16 v[224:227], a[148:151], v[96:99], v[224:227]
  v_exp_f32 v40, v40
  v_mfma_f32_16x16x32_bf16 v[224:227], a[152:155], v[128:131], v[224:227]
  s_add_u32 s25, s25, 32768
  s_cmp_eq_u32 s25, s27
  s_cselect_b32 s25, s28, s25
  s_cselect_b32 s27, -1, s27
  v_mfma_f32_16x16x32_bf16 v[228:231], a[152:155], v[132:135], v[228:231]
  v_exp_f32 v41, v41
  v_mfma_f32_16x16x32_bf16 v[228:231], a[148:151], v[100:103], v[228:231]
  v_cvt_pk_bf16_f32 v39, v54, v55
  v_cvt_pk_bf16_f32 v40, v40, v41
  v_mfma_f32_16x16x32_bf16 v[232:235], a[148:151], v[104:107], v[232:235]
  v_exp_f32 v42, v42
  v_mfma_f32_16x16x32_bf16 v[232:235], a[152:155], v[136:139], v[232:235]
  v_mfma_f32_16x16x32_bf16 v[236:239], a[152:155], v[140:143], v[236:239]
  v_exp_f32 v43, v43
  v_mfma_f32_16x16x32_bf16 v[236:239], a[148:151], v[108:111], v[236:239]
  v_cvt_pk_bf16_f32 v41, v42, v43
  s_waitcnt lgkmcnt(4)
  v_mfma_f32_16x16x32_bf16 v[240:243], a[156:159], v[96:99], v[240:243]
  v_exp_f32 v56, v56
  v_mfma_f32_16x16x32_bf16 v[240:243], a[160:163], v[128:131], v[240:243]
  v_mfma_f32_16x16x32_bf16 v[244:247], a[160:163], v[132:135], v[244:247]
  v_exp_f32 v57, v57
  v_mfma_f32_16x16x32_bf16 v[244:247], a[156:159], v[100:103], v[244:247]
  v_cvt_pk_bf16_f32 v42, v56, v57
  v_mfma_f32_16x16x32_bf16 v[248:251], a[156:159], v[104:107], v[248:251]
  v_exp_f32 v58, v58
  v_mfma_f32_16x16x32_bf16 v[248:251], a[160:163], v[136:139], v[248:251]
  s_waitcnt vmcnt(16) lgkmcnt(0)
  s_barrier
  ds_read_b128 a[116:119], v2 offset:0
  ds_read_b128 a[120:123], v2 offset:1024
  ds_read_b128 a[124:127], v2 offset:2048
  ds_read_b128 a[128:131], v2 offset:3072
  v_mfma_f32_16x16x32_bf16 v[252:255], a[160:163], v[140:143], v[252:255]
  v_exp_f32 v59, v59
  v_mfma_f32_16x16x32_bf16 v[252:255], a[156:159], v[108:111], v[252:255]
  v_cvt_pk_bf16_f32 v43, v58, v59
  v_mfma_f32_16x16x32_bf16 a[0:3], a[164:167], v[96:99], a[0:3]
  v_exp_f32 v44, v44
  v_mfma_f32_16x16x32_bf16 a[0:3], a[168:171], v[128:131], a[0:3]
  ds_read_b128 a[132:135], v2 offset:4096
  ds_read_b128 a[136:139], v2 offset:5120
  v_mfma_f32_16x16x32_bf16 a[4:7], a[168:171], v[132:135], a[4:7]
  v_exp_f32 v45, v45
  v_mfma_f32_16x16x32_bf16 a[4:7], a[164:167], v[100:103], a[4:7]
  v_cvt_pk_bf16_f32 v44, v44, v45
  v_mfma_f32_16x16x32_bf16 a[8:11], a[164:167], v[104:107], a[8:11]
  v_exp_f32 v46, v46
  v_mfma_f32_16x16x32_bf16 a[8:11], a[168:171], v[136:139], a[8:11]
  v_mfma_f32_16x16x32_bf16 a[12:15], a[168:171], v[140:143], a[12:15]
  v_exp_f32 v47, v47
  v_mfma_f32_16x16x32_bf16 a[12:15], a[164:167], v[108:111], a[12:15]
  v_cvt_pk_bf16_f32 v45, v46, v47
  v_mfma_f32_16x16x32_bf16 a[16:19], a[172:175], v[96:99], a[16:19]
  v_exp_f32 v60, v60
  v_mfma_f32_16x16x32_bf16 a[16:19], a[176:179], v[128:131], a[16:19]
  ds_read_b128 a[140:143], v2 offset:6144
  ds_read_b128 a[144:147], v2 offset:7168
  v_mfma_f32_16x16x32_bf16 a[20:23], a[176:179], v[132:135], a[20:23]
  v_exp_f32 v61, v61
  v_mfma_f32_16x16x32_bf16 a[20:23], a[172:175], v[100:103], a[20:23]
  v_cvt_pk_bf16_f32 v46, v60, v61
  v_mfma_f32_16x16x32_bf16 a[24:27], a[172:175], v[104:107], a[24:27]
  v_exp_f32 v62, v62
  v_mfma_f32_16x16x32_bf16 a[24:27], a[176:179], v[136:139], a[24:27]
  v_mfma_f32_16x16x32_bf16 a[28:31], a[176:179], v[140:143], a[28:31]
  v_exp_f32 v63, v63
  v_mfma_f32_16x16x32_bf16 a[28:31], a[172:175], v[108:111], a[28:31]
  v_cvt_pk_bf16_f32 v47, v62, v63
  s_branch Lk2_l1
Lk2_m1:
  s_lshl_b32 s33, s23, 6
  s_add_i32 s33, s33, 0
  s_cmp_gt_i32 s33, 0
  s_cselect_b32 s34, 0, 0xf149f2ca
  s_cmp_lt_i32 s33, 0
  s_cselect_b32 s33, 0xf149f2ca, 0
  v_mov_b32 v20, s34
  v_mov_b32 v21, s34
  v_mov_b32 v22, s34
  v_mov_b32 v23, s34
  v_mov_b32 v28, s33
  v_mov_b32 v29, s33
  v_mov_b32 v30, s33
  v_mov_b32 v31, s33
  v_med3_f32 v24, v16, v20, v28
  v_med3_f32 v25, v17, v20, v28
  v_med3_f32 v26, v18, v20, v28
  v_med3_f32 v27, v19, v20, v28
  s_waitcnt lgkmcnt(4)
  s_add_u32 m0, s29, 32768
  v_mfma_f32_16x16x32_bf16 v[32:35], a[116:119], a[52:55], v[24:27]
  v_exp_f32 v128, v128
  v_mfma_f32_16x16x32_bf16 v[32:35], a[120:123], a[56:59], v[32:35]
  ds_read_b128 a[148:151], v3 offset:8192
  ds_read_b128 a[152:155], v3 offset:9216
  v_mfma_f32_16x16x32_bf16 v[32:35], a[124:127], a[60:63], v[32:35]
  v_exp_f32 v129, v129
  v_mfma_f32_16x16x32_bf16 v[32:35], a[128:131], a[64:67], v[32:35]
  buffer_load_dwordx4 v1, s[12:15], s26 offen offset:0 lds
  s_add_u32 s32, s26, 4096
  v_mfma_f32_16x16x32_bf16 v[36:39], a[128:131], a[80:83], v[28:31]
  v_exp_f32 v130, v130
  v_mfma_f32_16x16x32_bf16 v[36:39], a[124:127], a[76:79], v[36:39]
  v_cvt_pk_bf16_f32 v128, v128, v129
  v_mfma_f32_16x16x32_bf16 v[36:39], a[120:123], a[72:75], v[36:39]
  v_exp_f32 v131, v131
  v_mfma_f32_16x16x32_bf16 v[36:39], a[116:119], a[68:71], v[36:39]
  buffer_load_dwordx4 v1, s[12:15], s26 offen offset:1024 lds
  v_mfma_f32_16x16x32_bf16 v[40:43], a[116:119], a[84:87], v[28:31]
  v_exp_f32 v144, v144
  v_mfma_f32_16x16x32_bf16 v[40:43], a[120:123], a[88:91], v[40:43]
  ds_read_b128 a[156:159], v3 offset:10240
  ds_read_b128 a[160:163], v3 offset:11264
  v_mfma_f32_16x16x32_bf16 v[40:43], a[124:127], a[92:95], v[40:43]
  v_exp_f32 v145, v145
  v_mfma_f32_16x16x32_bf16 v[40:43], a[128:131], a[96:99], v[40:43]
  buffer_load_dwordx4 v1, s[12:15], s26 offen offset:2048 lds
  v_mfma_f32_16x16x32_bf16 v[44:47], a[128:131], a[112:115], v[28:31]
  v_exp_f32 v146, v146
  v_mfma_f32_16x16x32_bf16 v[44:47], a[124:127], a[108:111], v[44:47]
  v_cvt_pk_bf16_f32 v129, v130, v131
  v_cvt_pk_bf16_f32 v130, v144, v145
  v_mfma_f32_16x16x32_bf16 v[44:47], a[120:123], a[104:107], v[44:47]
  v_exp_f32 v147, v147
  v_mfma_f32_16x16x32_bf16 v[44:47], a[116:119], a[100:103], v[44:47]
  buffer_load_dwordx4 v1, s[12:15], s26 offen offset:3072 lds
  s_add_u32 m0, s29, 36864
  s_waitcnt lgkmcnt(4)
  v_mfma_f32_16x16x32_bf16 v[48:51], a[132:135], a[52:55], v[20:23]
  v_exp_f32 v132, v132
  v_mfma_f32_16x16x32_bf16 v[48:51], a[136:139], a[56:59], v[48:51]
  ds_read_b128 a[164:167], v3 offset:12288
  ds_read_b128 a[168:171], v3 offset:13312
  v_mfma_f32_16x16x32_bf16 v[48:51], a[140:143], a[60:63], v[48:51]
  v_exp_f32 v133, v133
  v_mfma_f32_16x16x32_bf16 v[48:51], a[144:147], a[64:67], v[48:51]
  buffer_load_dwordx4 v1, s[12:15], s32 offen offset:0 lds
  v_mfma_f32_16x16x32_bf16 v[52:55], a[144:147], a[80:83], v[24:27]
  v_exp_f32 v134, v134
  v_mfma_f32_16x16x32_bf16 v[52:55], a[140:143], a[76:79], v[52:55]
  v_cvt_pk_bf16_f32 v131, v146, v147
  v_cvt_pk_bf16_f32 v132, v132, v133
  v_mfma_f32_16x16x32_bf16 v[52:55], a[136:139], a[72:75], v[52:55]
  v_exp_f32 v135, v135
  v_mfma_f32_16x16x32_bf16 v[52:55], a[132:135], a[68:71], v[52:55]
  buffer_load_dwordx4 v1, s[12:15], s32 offen offset:1024 lds
  v_mfma_f32_16x16x32_bf16 v[56:59], a[132:135], a[84:87], v[28:31]
  v_exp_f32 v148, v148
  v_mfma_f32_16x16x32_bf16 v[56:59], a[136:139], a[88:91], v[56:59]
  ds_read_b128 a[172:175], v3 offset:14336
  ds_read_b128 a[176:179], v3 offset:15360
  v_mfma_f32_16x16x32_bf16 v[56:59], a[140:143], a[92:95], v[56:59]
  v_exp_f32 v149, v149
  v_mfma_f32_16x16x32_bf16 v[56:59], a[144:147], a[96:99], v[56:59]
  buffer_load_dwordx4 v1, s[12:15], s32 offen offset:2048 lds
  v_mfma_f32_16x16x32_bf16 v[60:63], a[144:147], a[112:115], v[28:31]
  v_exp_f32 v150, v150
  v_mfma_f32_16x16x32_bf16 v[60:63], a[140:143], a[108:111], v[60:63]
  v_cvt_pk_bf16_f32 v133, v134, v135
  v_cvt_pk_bf16_f32 v134, v148, v149
  v_mfma_f32_16x16x32_bf16 v[60:63], a[136:139], a[104:107], v[60:63]
  v_exp_f32 v151, v151
  v_mfma_f32_16x16x32_bf16 v[60:63], a[132:135], a[100:103], v[60:63]
  buffer_load_dwordx4 v1, s[12:15], s32 offen offset:3072 lds
  s_waitcnt lgkmcnt(4)
  v_mfma_f32_16x16x32_bf16 v[64:67], a[148:151], a[52:55], v[20:23]
  v_exp_f32 v136, v136
  v_mfma_f32_16x16x32_bf16 v[64:67], a[152:155], a[56:59], v[64:67]
  s_add_u32 s26, s26, 32768
  s_cmp_eq_u32 s26, s62
  s_cselect_b32 s26, s63, s26
  s_cselect_b32 s62, -1, s62
  v_mfma_f32_16x16x32_bf16 v[64:67], a[156:159], a[60:63], v[64:67]
  v_exp_f32 v137, v137
  v_mfma_f32_16x16x32_bf16 v[64:67], a[160:163], a[64:67], v[64:67]
  v_cvt_pk_bf16_f32 v135, v150, v151
  v_cvt_pk_bf16_f32 v136, v136, v137
  v_mfma_f32_16x16x32_bf16 v[68:71], a[160:163], a[80:83], v[20:23]
  v_exp_f32 v138, v138
  v_mfma_f32_16x16x32_bf16 v[68:71], a[156:159], a[76:79], v[68:71]
  v_mfma_f32_16x16x32_bf16 v[68:71], a[152:155], a[72:75], v[68:71]
  v_exp_f32 v139, v139
  v_mfma_f32_16x16x32_bf16 v[68:71], a[148:151], a[68:71], v[68:71]
  v_cvt_pk_bf16_f32 v137, v138, v139
  v_mfma_f32_16x16x32_bf16 v[72:75], a[148:151], a[84:87], v[24:27]
  v_exp_f32 v152, v152
  v_mfma_f32_16x16x32_bf16 v[72:75], a[152:155], a[88:91], v[72:75]
  v_mfma_f32_16x16x32_bf16 v[72:75], a[156:159], a[92:95], v[72:75]
  v_exp_f32 v153, v153
  v_mfma_f32_16x16x32_bf16 v[72:75], a[160:163], a[96:99], v[72:75]
  v_cvt_pk_bf16_f32 v138, v152, v153
  v_mfma_f32_16x16x32_bf16 v[76:79], a[160:163], a[112:115], v[28:31]
  v_exp_f32 v154, v154
  v_mfma_f32_16x16x32_bf16 v[76:79], a[156:159], a[108:111], v[76:79]
  s_waitcnt vmcnt(16) lgkmcnt(0)
  s_barrier
  ds_read_b128 a[116:119], v3 offset:32768
  ds_read_b128 a[120:123], v3 offset:40960
  ds_read_b128 a[124:127], v3 offset:33792
  ds_read_b128 a[128:131], v3 offset:41984
  v_mfma_f32_16x16x32_bf16 v[76:79], a[152:155], a[104:107], v[76:79]
  v_exp_f32 v155, v155
  v_mfma_f32_16x16x32_bf16 v[76:79], a[148:151], a[100:103], v[76:79]
  v_cvt_pk_bf16_f32 v139, v154, v155
  v_mfma_f32_16x16x32_bf16 v[80:83], a[164:167], a[52:55], v[20:23]
  v_exp_f32 v140, v140
  v_mfma_f32_16x16x32_bf16 v[80:83], a[168:171], a[56:59], v[80:83]
  ds_read_b128 a[132:135], v3 offset:34816
  ds_read_b128 a[136:139], v3 offset:43008
  v_mfma_f32_16x16x32_bf16 v[80:83], a[172:175], a[60:63], v[80:83]
  v_exp_f32 v141, v141
  v_mfma_f32_16x16x32_bf16 v[80:83], a[176:179], a[64:67], v[80:83]
  v_cvt_pk_bf16_f32 v140, v140, v141
  v_mfma_f32_16x16x32_bf16 v[84:87], a[176:179], a[80:83], v[20:23]
  v_exp_f32 v142, v142
  v_mfma_f32_16x16x32_bf16 v[84:87], a[172:175], a[76:79], v[84:87]
  v_mfma_f32_16x16x32_bf16 v[84:87], a[168:171], a[72:75], v[84:87]
  v_exp_f32 v143, v143
  v_mfma_f32_16x16x32_bf16 v[84:87], a[164:167], a[68:71], v[84:87]
  v_cvt_pk_bf16_f32 v141, v142, v143
  v_mfma_f32_16x16x32_bf16 v[88:91], a[164:167], a[84:87], v[20:23]
  v_exp_f32 v156, v156
  v_mfma_f32_16x16x32_bf16 v[88:91], a[168:171], a[88:91], v[88:91]
  ds_read_b128 a[140:143], v3 offset:35840
  ds_read_b128 a[144:147], v3 offset:44032
  v_mfma_f32_16x16x32_bf16 v[88:91], a[172:175], a[92:95], v[88:91]
  v_exp_f32 v157, v157
  v_mfma_f32_16x16x32_bf16 v[88:91], a[176:179], a[96:99], v[88:91]
  v_cvt_pk_bf16_f32 v142, v156, v157
  v_mfma_f32_16x16x32_bf16 v[92:95], a[176:179], a[112:115], v[24:27]
  v_exp_f32 v158, v158
  v_mfma_f32_16x16x32_bf16 v[92:95], a[172:175], a[108:111], v[92:95]
  v_mfma_f32_16x16x32_bf16 v[92:95], a[168:171], a[104:107], v[92:95]
  v_exp_f32 v159, v159
  v_mfma_f32_16x16x32_bf16 v[92:95], a[164:167], a[100:103], v[92:95]
  v_cvt_pk_bf16_f32 v143, v158, v159
  s_waitcnt lgkmcnt(6)
  s_add_u32 m0, s29, 65536
  v_mfma_f32_16x16x32_bf16 v[160:163], a[116:119], v[96:99], v[160:163]
  v_exp_f32 v32, v32
  v_mfma_f32_16x16x32_bf16 v[160:163], a[120:123], v[128:131], v[160:163]
  ds_read_b128 a[148:151], v3 offset:36864
  ds_read_b128 a[152:155], v3 offset:45056
  v_mfma_f32_16x16x32_bf16 v[164:167], a[120:123], v[132:135], v[164:167]
  v_exp_f32 v33, v33
  v_mfma_f32_16x16x32_bf16 v[164:167], a[116:119], v[100:103], v[164:167]
  buffer_load_dwordx4 v1, s[12:15], s25 offen offset:0 lds
  s_add_u32 s32, s25, 4096
  v_mfma_f32_16x16x32_bf16 v[168:171], a[116:119], v[104:107], v[168:171]
  v_exp_f32 v34, v34
  v_mfma_f32_16x16x32_bf16 v[168:171], a[120:123], v[136:139], v[168:171]
  v_cvt_pk_bf16_f32 v32, v32, v33
  v_mfma_f32_16x16x32_bf16 v[172:175], a[120:123], v[140:143], v[172:175]
  v_exp_f32 v35, v35
  v_mfma_f32_16x16x32_bf16 v[172:175], a[116:119], v[108:111], v[172:175]
  buffer_load_dwordx4 v1, s[12:15], s25 offen offset:1024 lds
  s_waitcnt lgkmcnt(6)
  v_mfma_f32_16x16x32_bf16 a[32:35], a[48:51], v[96:99], a[32:35]
  v_mfma_f32_16x16x32_bf16 a[32:35], a[48:51], v[128:131], a[32:35]
  v_mfma_f32_16x16x32_bf16 v[176:179], a[124:127], v[96:99], v[176:179]
  v_exp_f32 v48, v48
  v_mfma_f32_16x16x32_bf16 v[176:179], a[128:131], v[128:131], v[176:179]
  ds_read_b128 a[156:159], v3 offset:37888
  ds_read_b128 a[160:163], v3 offset:46080
  v_mfma_f32_16x16x32_bf16 v[180:183], a[128:131], v[132:135], v[180:183]
  v_exp_f32 v49, v49
  v_mfma_f32_16x16x32_bf16 v[180:183], a[124:127], v[100:103], v[180:183]
  buffer_load_dwordx4 v1, s[12:15], s25 offen offset:2048 lds
  v_mfma_f32_16x16x32_bf16 v[184:187], a[124:127], v[104:107], v[184:187]
  v_exp_f32 v50, v50
  v_mfma_f32_16x16x32_bf16 v[184:187], a[128:131], v[136:139], v[184:187]
  v_cvt_pk_bf16_f32 v33, v34, v35
  v_cvt_pk_bf16_f32 v34, v48, v49
  v_mfma_f32_16x16x32_bf16 v[188:191], a[128:131], v[140:143], v[188:191]
  v_exp_f32 v51, v51
  v_mfma_f32_16x16x32_bf16 v[188:191], a[124:127], v[108:111], v[188:191]
  buffer_load_dwordx4 v1, s[12:15], s25 offen offset:3072 lds
  s_add_u32 m0, s29, 69632
  s_waitcnt lgkmcnt(6)
  v_mfma_f32_16x16x32_bf16 a[36:39], a[48:51], v[100:103], a[36:39]
  v_mfma_f32_16x16x32_bf16 a[36:39], a[48:51], v[132:135], a[36:39]
  v_mfma_f32_16x16x32_bf16 v[192:195], a[132:135], v[96:99], v[192:195]
  v_exp_f32 v36, v36
  v_mfma_f32_16x16x32_bf16 v[192:195], a[136:139], v[128:131], v[192:195]
  ds_read_b128 a[164:167], v3 offset:38912
  ds_read_b128 a[168:171], v3 offset:47104
  v_mfma_f32_16x16x32_bf16 v[196:199], a[136:139], v[132:135], v[196:199]
  v_exp_f32 v37, v37
  v_mfma_f32_16x16x32_bf16 v[196:199], a[132:135], v[100:103], v[196:199]
  buffer_load_dwordx4 v1, s[12:15], s32 offen offset:0 lds
  v_mfma_f32_16x16x32_bf16 v[200:203], a[132:135], v[104:107], v[200:203]
  v_exp_f32 v38, v38
  v_mfma_f32_16x16x32_bf16 v[200:203], a[136:139], v[136:139], v[200:203]
  v_cvt_pk_bf16_f32 v35, v50, v51
  v_cvt_pk_bf16_f32 v36, v36, v37
  v_mfma_f32_16x16x32_bf16 v[204:207], a[136:139], v[140:143], v[204:207]
  v_exp_f32 v39, v39
  v_mfma_f32_16x16x32_bf16 v[204:207], a[132:135], v[108:111], v[204:207]
  buffer_load_dwordx4 v1, s[12:15], s32 offen offset:1024 lds
  s_waitcnt lgkmcnt(6)
  v_mfma_f32_16x16x32_bf16 a[40:43], a[48:51], v[104:107], a[40:43]
  v_mfma_f32_16x16x32_bf16 a[40:43], a[48:51], v[136:139], a[40:43]
  v_mfma_f32_16x16x32_bf16 v[208:211], a[140:143], v[96:99], v[208:211]
  v_exp_f32 v52, v52
  v_mfma_f32_16x16x32_bf16 v[208:211], a[144:147], v[128:131], v[208:211]
  ds_read_b128 a[172:175], v3 offset:39936
  ds_read_b128 a[176:179], v3 offset:48128
  v_mfma_f32_16x16x32_bf16 v[212:215], a[144:147], v[132:135], v[212:215]
  v_exp_f32 v53, v53
  v_mfma_f32_16x16x32_bf16 v[212:215], a[140:143], v[100:103], v[212:215]
  buffer_load_dwordx4 v1, s[12:15], s32 offen offset:2048 lds
  v_mfma_f32_16x16x32_bf16 v[216:219], a[140:143], v[104:107], v[216:219]
  v_exp_f32 v54, v54
  v_mfma_f32_16x16x32_bf16 v[216:219], a[144:147], v[136:139], v[216:219]
  v_cvt_pk_bf16_f32 v37, v38, v39
  v_cvt_pk_bf16_f32 v38, v52, v53
  v_mfma_f32_16x16x32_bf16 v[220:223], a[144:147], v[140:143], v[220:223]
  v_exp_f32 v55, v55
  v_mfma_f32_16x16x32_bf16 v[220:223], a[140:143], v[108:111], v[220:223]
  buffer_load_dwordx4 v1, s[12:15], s32 offen offset:3072 lds
  s_waitcnt lgkmcnt(6)
  v_mfma_f32_16x16x32_bf16 a[44:47], a[48:51], v[108:111], a[44:47]
  v_mfma_f32_16x16x32_bf16 a[44:47], a[48:51], v[140:143], a[44:47]
  v_mfma_f32_16x16x32_bf16 v[224:227], a[148:151], v[96:99], v[224:227]
  v_exp_f32 v40, v40
  v_mfma_f32_16x16x32_bf16 v[224:227], a[152:155], v[128:131], v[224:227]
  s_add_u32 s25, s25, 32768
  s_cmp_eq_u32 s25, s27
  s_cselect_b32 s25, s28, s25
  s_cselect_b32 s27, -1, s27
  v_mfma_f32_16x16x32_bf16 v[228:231], a[152:155], v[132:135], v[228:231]
  v_exp_f32 v41, v41
  v_mfma_f32_16x16x32_bf16 v[228:231], a[148:151], v[100:103], v[228:231]
  v_cvt_pk_bf16_f32 v39, v54, v55
  v_cvt_pk_bf16_f32 v40, v40, v41
  v_mfma_f32_16x16x32_bf16 v[232:235], a[148:151], v[104:107], v[232:235]
  v_exp_f32 v42, v42
  v_mfma_f32_16x16x32_bf16 v[232:235], a[152:155], v[136:139], v[232:235]
  v_mfma_f32_16x16x32_bf16 v[236:239], a[152:155], v[140:143], v[236:239]
  v_exp_f32 v43, v43
  v_mfma_f32_16x16x32_bf16 v[236:239], a[148:151], v[108:111], v[236:239]
  v_cvt_pk_bf16_f32 v41, v42, v43
  s_waitcnt lgkmcnt(4)
  v_mfma_f32_16x16x32_bf16 v[240:243], a[156:159], v[96:99], v[240:243]
  v_exp_f32 v56, v56
  v_mfma_f32_16x16x32_bf16 v[240:243], a[160:163], v[128:131], v[240:243]
  v_mfma_f32_16x16x32_bf16 v[244:247], a[160:163], v[132:135], v[244:247]
  v_exp_f32 v57, v57
  v_mfma_f32_16x16x32_bf16 v[244:247], a[156:159], v[100:103], v[244:247]
  v_cvt_pk_bf16_f32 v42, v56, v57
  v_mfma_f32_16x16x32_bf16 v[248:251], a[156:159], v[104:107], v[248:251]
  v_exp_f32 v58, v58
  v_mfma_f32_16x16x32_bf16 v[248:251], a[160:163], v[136:139], v[248:251]
  s_waitcnt vmcnt(16) lgkmcnt(0)
  s_barrier
  ds_read_b128 a[116:119], v2 offset:0
  ds_read_b128 a[120:123], v2 offset:1024
  ds_read_b128 a[124:127], v2 offset:2048
  ds_read_b128 a[128:131], v2 offset:3072
  v_mfma_f32_16x16x32_bf16 v[252:255], a[160:163], v[140:143], v[252:255]
  v_exp_f32 v59, v59
  v_mfma_f32_16x16x32_bf16 v[252:255], a[156:159], v[108:111], v[252:255]
  v_cvt_pk_bf16_f32 v43, v58, v59
  v_mfma_f32_16x16x32_bf16 a[0:3], a[164:167], v[96:99], a[0:3]
  v_exp_f32 v44, v44
  v_mfma_f32_16x16x32_bf16 a[0:3], a[168:171], v[128:131], a[0:3]
  ds_read_b128 a[132:135], v2 offset:4096
  ds_read_b128 a[136:139], v2 offset:5120
  v_mfma_f32_16x16x32_bf16 a[4:7], a[168:171], v[132:135], a[4:7]
  v_exp_f32 v45, v45
  v_mfma_f32_16x16x32_bf16 a[4:7], a[164:167], v[100:103], a[4:7]
  v_cvt_pk_bf16_f32 v44, v44, v45
  v_mfma_f32_16x16x32_bf16 a[8:11], a[164:167], v[104:107], a[8:11]
  v_exp_f32 v46, v46
  v_mfma_f32_16x16x32_bf16 a[8:11], a[168:171], v[136:139], a[8:11]
  v_mfma_f32_16x16x32_bf16 a[12:15], a[168:171], v[140:143], a[12:15]
  v_exp_f32 v47, v47
  v_mfma_f32_16x16x32_bf16 a[12:15], a[164:167], v[108:111], a[12:15]
  v_cvt_pk_bf16_f32 v45, v46, v47
  v_mfma_f32_16x16x32_bf16 a[16:19], a[172:175], v[96:99], a[16:19]
  v_exp_f32 v60, v60
  v_mfma_f32_16x16x32_bf16 a[16:19], a[176:179], v[128:131], a[16:19]
  ds_read_b128 a[140:143], v2 offset:6144
  ds_read_b128 a[144:147], v2 offset:7168
  v_mfma_f32_16x16x32_bf16 a[20:23], a[176:179], v[132:135], a[20:23]
  v_exp_f32 v61, v61
  v_mfma_f32_16x16x32_bf16 a[20:23], a[172:175], v[100:103], a[20:23]
  v_cvt_pk_bf16_f32 v46, v60, v61
  v_mfma_f32_16x16x32_bf16 a[24:27], a[172:175], v[104:107], a[24:27]
  v_exp_f32 v62, v62
  v_mfma_f32_16x16x32_bf16 a[24:27], a[176:179], v[136:139], a[24:27]
  v_mfma_f32_16x16x32_bf16 a[28:31], a[176:179], v[140:143], a[28:31]
  v_exp_f32 v63, v63
  v_mfma_f32_16x16x32_bf16 a[28:31], a[172:175], v[108:111], a[28:31]
  v_cvt_pk_bf16_f32 v47, v62, v63
Lk2_m2:
  s_sub_u32 s35, 15, s21
  s_lshl_b32 s33, s20, 7
  s_lshl_b32 s34, s35, 3
  s_add_u32 s33, s33, s34
  s_lshl_b32 s34, s23, 2
  s_add_u32 s33, s33, s34
  s_lshl_b32 s33, s33, 12
  buffer_load_dwordx4 a[180:183], v1, s[8:11], s33 offen offset:0
  buffer_load_dwordx4 a[184:187], v1, s[8:11], s33 offen offset:1024
  buffer_load_dwordx4 a[188:191], v1, s[8:11], s33 offen offset:2048
  buffer_load_dwordx4 a[192:195], v1, s[8:11], s33 offen offset:3072
  s_add_u32 s33, s33, 4096
  buffer_load_dwordx4 a[196:199], v1, s[8:11], s33 offen offset:0
  buffer_load_dwordx4 a[200:203], v1, s[8:11], s33 offen offset:1024
  buffer_load_dwordx4 a[204:207], v1, s[8:11], s33 offen offset:2048
  buffer_load_dwordx4 a[208:211], v1, s[8:11], s33 offen offset:3072
  s_add_u32 s33, s33, 4096
  buffer_load_dwordx4 a[212:215], v1, s[8:11], s33 offen offset:0
  buffer_load_dwordx4 a[216:219], v1, s[8:11], s33 offen offset:1024
  buffer_load_dwordx4 a[220:223], v1, s[8:11], s33 offen offset:2048
  buffer_load_dwordx4 a[224:227], v1, s[8:11], s33 offen offset:3072
  s_add_u32 s33, s33, 4096
  buffer_load_dwordx4 a[228:231], v1, s[8:11], s33 offen offset:0
  buffer_load_dwordx4 a[232:235], v1, s[8:11], s33 offen offset:1024
  buffer_load_dwordx4 a[236:239], v1, s[8:11], s33 offen offset:2048
  buffer_load_dwordx4 a[240:243], v1, s[8:11], s33 offen offset:3072
  s_lshl_b32 s33, s23, 6
  s_add_i32 s33, s33, -64
  s_cmp_gt_i32 s33, 0
  s_cselect_b32 s34, 0, 0xf149f2ca
  s_cmp_lt_i32 s33, 0
  s_cselect_b32 s33, 0xf149f2ca, 0
  v_mov_b32 v20, s34
  v_mov_b32 v21, s34
  v_mov_b32 v22, s34
  v_mov_b32 v23, s34
  v_mov_b32 v28, s33
  v_mov_b32 v29, s33
  v_mov_b32 v30, s33
  v_mov_b32 v31, s33
  v_med3_f32 v24, v16, v20, v28
  v_med3_f32 v25, v17, v20, v28
  v_med3_f32 v26, v18, v20, v28
  v_med3_f32 v27, v19, v20, v28
  s_waitcnt lgkmcnt(4)
  s_add_u32 m0, s29, 98304
  v_mfma_f32_16x16x32_bf16 v[96:99], a[116:119], a[52:55], v[24:27]
  v_exp_f32 v64, v64
  v_mfma_f32_16x16x32_bf16 v[96:99], a[120:123], a[56:59], v[96:99]
  ds_read_b128 a[148:151], v2 offset:8192
  ds_read_b128 a[152:155], v2 offset:9216
  v_mfma_f32_16x16x32_bf16 v[96:99], a[124:127], a[60:63], v[96:99]
  v_exp_f32 v65, v65
  v_mfma_f32_16x16x32_bf16 v[96:99], a[128:131], a[64:67], v[96:99]
  buffer_load_dwordx4 v1, s[12:15], s26 offen offset:0 lds
  s_add_u32 s32, s26, 4096
  v_mfma_f32_16x16x32_bf16 v[100:103], a[128:131], a[80:83], v[28:31]
  v_exp_f32 v66, v66
  v_mfma_f32_16x16x32_bf16 v[100:103], a[124:127], a[76:79], v[100:103]
  v_cvt_pk_bf16_f32 v64, v64, v65
  v_mfma_f32_16x16x32_bf16 v[100:103], a[120:123], a[72:75], v[100:103]
  v_exp_f32 v67, v67
  v_mfma_f32_16x16x32_bf16 v[100:103], a[116:119], a[68:71], v[100:103]
  buffer_load_dwordx4 v1, s[12:15], s26 offen offset:1024 lds
  v_mfma_f32_16x16x32_bf16 v[104:107], a[116:119], a[84:87], v[28:31]
  v_exp_f32 v80, v80
  v_mfma_f32_16x16x32_bf16 v[104:107], a[120:123], a[88:91], v[104:107]
  ds_read_b128 a[156:159], v2 offset:10240
  ds_read_b128 a[160:163], v2 offset:11264
  v_mfma_f32_16x16x32_bf16 v[104:107], a[124:127], a[92:95], v[104:107]
  v_exp_f32 v81, v81
  v_mfma_f32_16x16x32_bf16 v[104:107], a[128:131], a[96:99], v[104:107]
  buffer_load_dwordx4 v1, s[12:15], s26 offen offset:2048 lds
  v_mfma_f32_16x16x32_bf16 v[108:111], a[128:131], a[112:115], v[28:31]
  v_exp_f32 v82, v82
  v_mfma_f32_16x16x32_bf16 v[108:111], a[124:127], a[108:111], v[108:111]
  v_cvt_pk_bf16_f32 v65, v66, v67
  v_cvt_pk_bf16_f32 v66, v80, v81
  v_mfma_f32_16x16x32_bf16 v[108:111], a[120:123], a[104:107], v[108:111]
  v_exp_f32 v83, v83
  v_mfma_f32_16x16x32_bf16 v[108:111], a[116:119], a[100:103], v[108:111]
  buffer_load_dwordx4 v1, s[12:15], s26 offen offset:3072 lds
  s_add_u32 m0, s29, 102400
  s_waitcnt lgkmcnt(4)
  v_mfma_f32_16x16x32_bf16 v[112:115], a[132:135], a[52:55], v[20:23]
  v_exp_f32 v68, v68
  v_mfma_f32_16x16x32_bf16 v[112:115], a[136:139], a[56:59], v[112:115]
  ds_read_b128 a[164:167], v2 offset:12288
  ds_read_b128 a[168:171], v2 offset:13312
  v_mfma_f32_16x16x32_bf16 v[112:115], a[140:143], a[60:63], v[112:115]
  v_exp_f32 v69, v69
  v_mfma_f32_16x16x32_bf16 v[112:115], a[144:147], a[64:67], v[112:115]
  buffer_load_dwordx4 v1, s[12:15], s32 offen offset:0 lds
  v_mfma_f32_16x16x32_bf16 v[116:119], a[144:147], a[80:83], v[24:27]
  v_exp_f32 v70, v70
  v_mfma_f32_16x16x32_bf16 v[116:119], a[140:143], a[76:79], v[116:119]
  v_cvt_pk_bf16_f32 v67, v82, v83
  v_cvt_pk_bf16_f32 v68, v68, v69
  v_mfma_f32_16x16x32_bf16 v[116:119], a[136:139], a[72:75], v[116:119]
  v_exp_f32 v71, v71
  v_mfma_f32_16x16x32_bf16 v[116:119], a[132:135], a[68:71], v[116:119]
  buffer_load_dwordx4 v1, s[12:15], s32 offen offset:1024 lds
  v_mfma_f32_16x16x32_bf16 v[120:123], a[132:135], a[84:87], v[28:31]
  v_exp_f32 v84, v84
  v_mfma_f32_16x16x32_bf16 v[120:123], a[136:139], a[88:91], v[120:123]
  ds_read_b128 a[172:175], v2 offset:14336
  ds_read_b128 a[176:179], v2 offset:15360
  v_mfma_f32_16x16x32_bf16 v[120:123], a[140:143], a[92:95], v[120:123]
  v_exp_f32 v85, v85
  v_mfma_f32_16x16x32_bf16 v[120:123], a[144:147], a[96:99], v[120:123]
  buffer_load_dwordx4 v1, s[12:15], s32 offen offset:2048 lds
  v_mfma_f32_16x16x32_bf16 v[124:127], a[144:147], a[112:115], v[28:31]
  v_exp_f32 v86, v86
  v_mfma_f32_16x16x32_bf16 v[124:127], a[140:143], a[108:111], v[124:127]
  v_cvt_pk_bf16_f32 v69, v70, v71
  v_cvt_pk_bf16_f32 v70, v84, v85
  v_mfma_f32_16x16x32_bf16 v[124:127], a[136:139], a[104:107], v[124:127]
  v_exp_f32 v87, v87
  v_mfma_f32_16x16x32_bf16 v[124:127], a[132:135], a[100:103], v[124:127]
  buffer_load_dwordx4 v1, s[12:15], s32 offen offset:3072 lds
  s_waitcnt lgkmcnt(4)
  v_mfma_f32_16x16x32_bf16 v[128:131], a[148:151], a[52:55], v[20:23]
  v_exp_f32 v72, v72
  v_mfma_f32_16x16x32_bf16 v[128:131], a[152:155], a[56:59], v[128:131]
  s_add_u32 s26, s26, 32768
  s_cmp_eq_u32 s26, s62
  s_cselect_b32 s26, s63, s26
  s_cselect_b32 s62, -1, s62
  v_mfma_f32_16x16x32_bf16 v[128:131], a[156:159], a[60:63], v[128:131]
  v_exp_f32 v73, v73
  v_mfma_f32_16x16x32_bf16 v[128:131], a[160:163], a[64:67], v[128:131]
  v_cvt_pk_bf16_f32 v71, v86, v87
  v_cvt_pk_bf16_f32 v72, v72, v73
  v_mfma_f32_16x16x32_bf16 v[132:135], a[160:163], a[80:83], v[20:23]
  v_exp_f32 v74, v74
  v_mfma_f32_16x16x32_bf16 v[132:135], a[156:159], a[76:79], v[132:135]
  v_mfma_f32_16x16x32_bf16 v[132:135], a[152:155], a[72:75], v[132:135]
  v_exp_f32 v75, v75
  v_mfma_f32_16x16x32_bf16 v[132:135], a[148:151], a[68:71], v[132:135]
  v_cvt_pk_bf16_f32 v73, v74, v75
  v_mfma_f32_16x16x32_bf16 v[136:139], a[148:151], a[84:87], v[24:27]
  v_exp_f32 v88, v88
  v_mfma_f32_16x16x32_bf16 v[136:139], a[152:155], a[88:91], v[136:139]
  v_mfma_f32_16x16x32_bf16 v[136:139], a[156:159], a[92:95], v[136:139]
  v_exp_f32 v89, v89
  v_mfma_f32_16x16x32_bf16 v[136:139], a[160:163], a[96:99], v[136:139]
  v_cvt_pk_bf16_f32 v74, v88, v89
  v_mfma_f32_16x16x32_bf16 v[140:143], a[160:163], a[112:115], v[28:31]
  v_exp_f32 v90, v90
  v_mfma_f32_16x16x32_bf16 v[140:143], a[156:159], a[108:111], v[140:143]
  s_waitcnt vmcnt(32) lgkmcnt(0)
  s_barrier
  ds_read_b128 a[116:119], v2 offset:32768
  ds_read_b128 a[120:123], v2 offset:40960
  ds_read_b128 a[124:127], v2 offset:33792
  ds_read_b128 a[128:131], v2 offset:41984
  v_mfma_f32_16x16x32_bf16 v[140:143], a[152:155], a[104:107], v[140:143]
  v_exp_f32 v91, v91
  v_mfma_f32_16x16x32_bf16 v[140:143], a[148:151], a[100:103], v[140:143]
  v_cvt_pk_bf16_f32 v75, v90, v91
  v_mfma_f32_16x16x32_bf16 v[144:147], a[164:167], a[52:55], v[20:23]
  v_exp_f32 v76, v76
  v_mfma_f32_16x16x32_bf16 v[144:147], a[168:171], a[56:59], v[144:147]
  ds_read_b128 a[132:135], v2 offset:34816
  ds_read_b128 a[136:139], v2 offset:43008
  v_mfma_f32_16x16x32_bf16 v[144:147], a[172:175], a[60:63], v[144:147]
  v_exp_f32 v77, v77
  v_mfma_f32_16x16x32_bf16 v[144:147], a[176:179], a[64:67], v[144:147]
  v_cvt_pk_bf16_f32 v76, v76, v77
  v_mfma_f32_16x16x32_bf16 v[148:151], a[176:179], a[80:83], v[20:23]
  v_exp_f32 v78, v78
  v_mfma_f32_16x16x32_bf16 v[148:151], a[172:175], a[76:79], v[148:151]
  v_mfma_f32_16x16x32_bf16 v[148:151], a[168:171], a[72:75], v[148:151]
  v_exp_f32 v79, v79
  v_mfma_f32_16x16x32_bf16 v[148:151], a[164:167], a[68:71], v[148:151]
  v_cvt_pk_bf16_f32 v77, v78, v79
  v_mfma_f32_16x16x32_bf16 v[152:155], a[164:167], a[84:87], v[20:23]
  v_exp_f32 v92, v92
  v_mfma_f32_16x16x32_bf16 v[152:155], a[168:171], a[88:91], v[152:155]
  ds_read_b128 a[140:143], v2 offset:35840
  ds_read_b128 a[144:147], v2 offset:44032
  v_mfma_f32_16x16x32_bf16 v[152:155], a[172:175], a[92:95], v[152:155]
  v_exp_f32 v93, v93
  v_mfma_f32_16x16x32_bf16 v[152:155], a[176:179], a[96:99], v[152:155]
  v_cvt_pk_bf16_f32 v78, v92, v93
  v_mfma_f32_16x16x32_bf16 v[156:159], a[176:179], a[112:115], v[24:27]
  v_exp_f32 v94, v94
  v_mfma_f32_16x16x32_bf16 v[156:159], a[172:175], a[108:111], v[156:159]
  v_mfma_f32_16x16x32_bf16 v[156:159], a[168:171], a[104:107], v[156:159]
  v_exp_f32 v95, v95
  v_mfma_f32_16x16x32_bf16 v[156:159], a[164:167], a[100:103], v[156:159]
  v_cvt_pk_bf16_f32 v79, v94, v95
  s_waitcnt lgkmcnt(6)
  s_add_u32 m0, s29, 0
  v_mfma_f32_16x16x32_bf16 v[160:163], a[116:119], v[32:35], v[160:163]
  v_exp_f32 v96, v96
  v_mfma_f32_16x16x32_bf16 v[160:163], a[120:123], v[64:67], v[160:163]
  ds_read_b128 a[148:151], v2 offset:36864
  ds_read_b128 a[152:155], v2 offset:45056
  v_mfma_f32_16x16x32_bf16 v[164:167], a[120:123], v[68:71], v[164:167]
  v_exp_f32 v97, v97
  v_mfma_f32_16x16x32_bf16 v[164:167], a[116:119], v[36:39], v[164:167]
  buffer_load_dwordx4 v1, s[12:15], s25 offen offset:0 lds
  s_add_u32 s32, s25, 4096
  v_mfma_f32_16x16x32_bf16 v[168:171], a[116:119], v[40:43], v[168:171]
  v_exp_f32 v98, v98
  v_mfma_f32_16x16x32_bf16 v[168:171], a[120:123], v[72:75], v[168:171]
  v_cvt_pk_bf16_f32 v96, v96, v97
  v_mfma_f32_16x16x32_bf16 v[172:175], a[120:123], v[76:79], v[172:175]
  v_exp_f32 v99, v99
  v_mfma_f32_16x16x32_bf16 v[172:175], a[116:119], v[44:47], v[172:175]
  buffer_load_dwordx4 v1, s[12:15], s25 offen offset:1024 lds
  s_waitcnt lgkmcnt(6)
  v_mfma_f32_16x16x32_bf16 a[32:35], a[48:51], v[32:35], a[32:35]
  v_mfma_f32_16x16x32_bf16 a[32:35], a[48:51], v[64:67], a[32:35]
  v_mfma_f32_16x16x32_bf16 v[176:179], a[124:127], v[32:35], v[176:179]
  v_exp_f32 v112, v112
  v_mfma_f32_16x16x32_bf16 v[176:179], a[128:131], v[64:67], v[176:179]
  ds_read_b128 a[156:159], v2 offset:37888
  ds_read_b128 a[160:163], v2 offset:46080
  v_mfma_f32_16x16x32_bf16 v[180:183], a[128:131], v[68:71], v[180:183]
  v_exp_f32 v113, v113
  v_mfma_f32_16x16x32_bf16 v[180:183], a[124:127], v[36:39], v[180:183]
  buffer_load_dwordx4 v1, s[12:15], s25 offen offset:2048 lds
  v_mfma_f32_16x16x32_bf16 v[184:187], a[124:127], v[40:43], v[184:187]
  v_exp_f32 v114, v114
  v_mfma_f32_16x16x32_bf16 v[184:187], a[128:131], v[72:75], v[184:187]
  v_cvt_pk_bf16_f32 v97, v98, v99
  v_cvt_pk_bf16_f32 v98, v112, v113
  v_mfma_f32_16x16x32_bf16 v[188:191], a[128:131], v[76:79], v[188:191]
  v_exp_f32 v115, v115
  v_mfma_f32_16x16x32_bf16 v[188:191], a[124:127], v[44:47], v[188:191]
  buffer_load_dwordx4 v1, s[12:15], s25 offen offset:3072 lds
  s_add_u32 m0, s29, 4096
  s_waitcnt lgkmcnt(6)
  v_mfma_f32_16x16x32_bf16 a[36:39], a[48:51], v[36:39], a[36:39]
  v_mfma_f32_16x16x32_bf16 a[36:39], a[48:51], v[68:71], a[36:39]
  v_mfma_f32_16x16x32_bf16 v[192:195], a[132:135], v[32:35], v[192:195]
  v_exp_f32 v100, v100
  v_mfma_f32_16x16x32_bf16 v[192:195], a[136:139], v[64:67], v[192:195]
  ds_read_b128 a[164:167], v2 offset:38912
  ds_read_b128 a[168:171], v2 offset:47104
  v_mfma_f32_16x16x32_bf16 v[196:199], a[136:139], v[68:71], v[196:199]
  v_exp_f32 v101, v101
  v_mfma_f32_16x16x32_bf16 v[196:199], a[132:135], v[36:39], v[196:199]
  buffer_load_dwordx4 v1, s[12:15], s32 offen offset:0 lds
  v_mfma_f32_16x16x32_bf16 v[200:203], a[132:135], v[40:43], v[200:203]
  v_exp_f32 v102, v102
  v_mfma_f32_16x16x32_bf16 v[200:203], a[136:139], v[72:75], v[200:203]
  v_cvt_pk_bf16_f32 v99, v114, v115
  v_cvt_pk_bf16_f32 v100, v100, v101
  v_mfma_f32_16x16x32_bf16 v[204:207], a[136:139], v[76:79], v[204:207]
  v_exp_f32 v103, v103
  v_mfma_f32_16x16x32_bf16 v[204:207], a[132:135], v[44:47], v[204:207]
  buffer_load_dwordx4 v1, s[12:15], s32 offen offset:1024 lds
  s_waitcnt lgkmcnt(6)
  v_mfma_f32_16x16x32_bf16 a[40:43], a[48:51], v[40:43], a[40:43]
  v_mfma_f32_16x16x32_bf16 a[40:43], a[48:51], v[72:75], a[40:43]
  v_mfma_f32_16x16x32_bf16 v[208:211], a[140:143], v[32:35], v[208:211]
  v_exp_f32 v116, v116
  v_mfma_f32_16x16x32_bf16 v[208:211], a[144:147], v[64:67], v[208:211]
  ds_read_b128 a[172:175], v2 offset:39936
  ds_read_b128 a[176:179], v2 offset:48128
  v_mfma_f32_16x16x32_bf16 v[212:215], a[144:147], v[68:71], v[212:215]
  v_exp_f32 v117, v117
  v_mfma_f32_16x16x32_bf16 v[212:215], a[140:143], v[36:39], v[212:215]
  buffer_load_dwordx4 v1, s[12:15], s32 offen offset:2048 lds
  v_mfma_f32_16x16x32_bf16 v[216:219], a[140:143], v[40:43], v[216:219]
  v_exp_f32 v118, v118
  v_mfma_f32_16x16x32_bf16 v[216:219], a[144:147], v[72:75], v[216:219]
  v_cvt_pk_bf16_f32 v101, v102, v103
  v_cvt_pk_bf16_f32 v102, v116, v117
  v_mfma_f32_16x16x32_bf16 v[220:223], a[144:147], v[76:79], v[220:223]
  v_exp_f32 v119, v119
  v_mfma_f32_16x16x32_bf16 v[220:223], a[140:143], v[44:47], v[220:223]
  buffer_load_dwordx4 v1, s[12:15], s32 offen offset:3072 lds
  s_waitcnt lgkmcnt(6)
  v_mfma_f32_16x16x32_bf16 a[44:47], a[48:51], v[44:47], a[44:47]
  v_mfma_f32_16x16x32_bf16 a[44:47], a[48:51], v[76:79], a[44:47]
  v_mfma_f32_16x16x32_bf16 v[224:227], a[148:151], v[32:35], v[224:227]
  v_exp_f32 v104, v104
  v_mfma_f32_16x16x32_bf16 v[224:227], a[152:155], v[64:67], v[224:227]
  s_add_u32 s25, s25, 32768
  s_cmp_eq_u32 s25, s27
  s_cselect_b32 s25, s28, s25
  s_cselect_b32 s27, -1, s27
  v_mfma_f32_16x16x32_bf16 v[228:231], a[152:155], v[68:71], v[228:231]
  v_exp_f32 v105, v105
  v_mfma_f32_16x16x32_bf16 v[228:231], a[148:151], v[36:39], v[228:231]
  v_cvt_pk_bf16_f32 v103, v118, v119
  v_cvt_pk_bf16_f32 v104, v104, v105
  v_mfma_f32_16x16x32_bf16 v[232:235], a[148:151], v[40:43], v[232:235]
  v_exp_f32 v106, v106
  v_mfma_f32_16x16x32_bf16 v[232:235], a[152:155], v[72:75], v[232:235]
  v_mfma_f32_16x16x32_bf16 v[236:239], a[152:155], v[76:79], v[236:239]
  v_exp_f32 v107, v107
  v_mfma_f32_16x16x32_bf16 v[236:239], a[148:151], v[44:47], v[236:239]
  v_cvt_pk_bf16_f32 v105, v106, v107
  s_waitcnt lgkmcnt(4)
  v_mfma_f32_16x16x32_bf16 v[240:243], a[156:159], v[32:35], v[240:243]
  v_exp_f32 v120, v120
  v_mfma_f32_16x16x32_bf16 v[240:243], a[160:163], v[64:67], v[240:243]
  v_mfma_f32_16x16x32_bf16 v[244:247], a[160:163], v[68:71], v[244:247]
  v_exp_f32 v121, v121
  v_mfma_f32_16x16x32_bf16 v[244:247], a[156:159], v[36:39], v[244:247]
  v_cvt_pk_bf16_f32 v106, v120, v121
  v_mfma_f32_16x16x32_bf16 v[248:251], a[156:159], v[40:43], v[248:251]
  v_exp_f32 v122, v122
  v_mfma_f32_16x16x32_bf16 v[248:251], a[160:163], v[72:75], v[248:251]
  s_waitcnt vmcnt(32) lgkmcnt(0)
  s_barrier
  ds_read_b128 a[116:119], v3 offset:0
  ds_read_b128 a[120:123], v3 offset:1024
  ds_read_b128 a[124:127], v3 offset:2048
  ds_read_b128 a[128:131], v3 offset:3072
  v_mfma_f32_16x16x32_bf16 v[252:255], a[160:163], v[76:79], v[252:255]
  v_exp_f32 v123, v123
  v_mfma_f32_16x16x32_bf16 v[252:255], a[156:159], v[44:47], v[252:255]
  v_cvt_pk_bf16_f32 v107, v122, v123
  v_mfma_f32_16x16x32_bf16 a[0:3], a[164:167], v[32:35], a[0:3]
  v_exp_f32 v108, v108
  v_mfma_f32_16x16x32_bf16 a[0:3], a[168:171], v[64:67], a[0:3]
  ds_read_b128 a[132:135], v3 offset:4096
  ds_read_b128 a[136:139], v3 offset:5120
  v_mfma_f32_16x16x32_bf16 a[4:7], a[168:171], v[68:71], a[4:7]
  v_exp_f32 v109, v109
  v_mfma_f32_16x16x32_bf16 a[4:7], a[164:167], v[36:39], a[4:7]
  v_cvt_pk_bf16_f32 v108, v108, v109
  v_mfma_f32_16x16x32_bf16 a[8:11], a[164:167], v[40:43], a[8:11]
  v_exp_f32 v110, v110
  v_mfma_f32_16x16x32_bf16 a[8:11], a[168:171], v[72:75], a[8:11]
  v_mfma_f32_16x16x32_bf16 a[12:15], a[168:171], v[76:79], a[12:15]
  v_exp_f32 v111, v111
  v_mfma_f32_16x16x32_bf16 a[12:15], a[164:167], v[44:47], a[12:15]
  v_cvt_pk_bf16_f32 v109, v110, v111
  v_mfma_f32_16x16x32_bf16 a[16:19], a[172:175], v[32:35], a[16:19]
  v_exp_f32 v124, v124
  v_mfma_f32_16x16x32_bf16 a[16:19], a[176:179], v[64:67], a[16:19]
  ds_read_b128 a[140:143], v3 offset:6144
  ds_read_b128 a[144:147], v3 offset:7168
  v_mfma_f32_16x16x32_bf16 a[20:23], a[176:179], v[68:71], a[20:23]
  v_exp_f32 v125, v125
  v_mfma_f32_16x16x32_bf16 a[20:23], a[172:175], v[36:39], a[20:23]
  v_cvt_pk_bf16_f32 v110, v124, v125
  v_mfma_f32_16x16x32_bf16 a[24:27], a[172:175], v[40:43], a[24:27]
  v_exp_f32 v126, v126
  v_mfma_f32_16x16x32_bf16 a[24:27], a[176:179], v[72:75], a[24:27]
  v_mfma_f32_16x16x32_bf16 a[28:31], a[176:179], v[76:79], a[28:31]
  v_exp_f32 v127, v127
  v_mfma_f32_16x16x32_bf16 a[28:31], a[172:175], v[44:47], a[28:31]
  v_cvt_pk_bf16_f32 v111, v126, v127
  s_waitcnt vmcnt(16)
  s_waitcnt lgkmcnt(4)
  s_add_u32 m0, s29, 32768
  v_mfma_f32_16x16x32_bf16 v[32:35], a[116:119], a[180:183], 0
  v_exp_f32 v128, v128
  v_mfma_f32_16x16x32_bf16 v[32:35], a[120:123], a[184:187], v[32:35]
  ds_read_b128 a[148:151], v3 offset:8192
  ds_read_b128 a[152:155], v3 offset:9216
  v_mfma_f32_16x16x32_bf16 v[32:35], a[124:127], a[188:191], v[32:35]
  v_exp_f32 v129, v129
  v_mfma_f32_16x16x32_bf16 v[32:35], a[128:131], a[192:195], v[32:35]
  buffer_load_dwordx4 v1, s[12:15], s26 offen offset:0 lds
  s_add_u32 s32, s26, 4096
  v_mfma_f32_16x16x32_bf16 v[36:39], a[128:131], a[208:211], 0
  v_exp_f32 v130, v130
  v_mfma_f32_16x16x32_bf16 v[36:39], a[124:127], a[204:207], v[36:39]
  v_cvt_pk_bf16_f32 v128, v128, v129
  v_mfma_f32_16x16x32_bf16 v[36:39], a[120:123], a[200:203], v[36:39]
  v_exp_f32 v131, v131
  v_mfma_f32_16x16x32_bf16 v[36:39], a[116:119], a[196:199], v[36:39]
  buffer_load_dwordx4 v1, s[12:15], s26 offen offset:1024 lds
  v_mfma_f32_16x16x32_bf16 v[40:43], a[116:119], a[212:215], 0
  v_exp_f32 v144, v144
  v_mfma_f32_16x16x32_bf16 v[40:43], a[120:123], a[216:219], v[40:43]
  ds_read_b128 a[156:159], v3 offset:10240
  ds_read_b128 a[160:163], v3 offset:11264
  v_mfma_f32_16x16x32_bf16 v[40:43], a[124:127], a[220:223], v[40:43]
  v_exp_f32 v145, v145
  v_mfma_f32_16x16x32_bf16 v[40:43], a[128:131], a[224:227], v[40:43]
  buffer_load_dwordx4 v1, s[12:15], s26 offen offset:2048 lds
  v_mfma_f32_16x16x32_bf16 v[44:47], a[128:131], a[240:243], 0
  v_exp_f32 v146, v146
  v_mfma_f32_16x16x32_bf16 v[44:47], a[124:127], a[236:239], v[44:47]
  v_cvt_pk_bf16_f32 v129, v130, v131
  v_cvt_pk_bf16_f32 v130, v144, v145
  v_mfma_f32_16x16x32_bf16 v[44:47], a[120:123], a[232:235], v[44:47]
  v_exp_f32 v147, v147
  v_mfma_f32_16x16x32_bf16 v[44:47], a[116:119], a[228:231], v[44:47]
  buffer_load_dwordx4 v1, s[12:15], s26 offen offset:3072 lds
  s_add_u32 m0, s29, 36864
  s_waitcnt lgkmcnt(4)
  v_mfma_f32_16x16x32_bf16 v[48:51], a[132:135], a[180:183], 0
  v_exp_f32 v132, v132
  v_mfma_f32_16x16x32_bf16 v[48:51], a[136:139], a[184:187], v[48:51]
  ds_read_b128 a[164:167], v3 offset:12288
  ds_read_b128 a[168:171], v3 offset:13312
  v_mfma_f32_16x16x32_bf16 v[48:51], a[140:143], a[188:191], v[48:51]
  v_exp_f32 v133, v133
  v_mfma_f32_16x16x32_bf16 v[48:51], a[144:147], a[192:195], v[48:51]
  buffer_load_dwordx4 v1, s[12:15], s32 offen offset:0 lds
  v_mfma_f32_16x16x32_bf16 v[52:55], a[144:147], a[208:211], 0
  v_exp_f32 v134, v134
  v_mfma_f32_16x16x32_bf16 v[52:55], a[140:143], a[204:207], v[52:55]
  v_cvt_pk_bf16_f32 v131, v146, v147
  v_cvt_pk_bf16_f32 v132, v132, v133
  v_mfma_f32_16x16x32_bf16 v[52:55], a[136:139], a[200:203], v[52:55]
  v_exp_f32 v135, v135
  v_mfma_f32_16x16x32_bf16 v[52:55], a[132:135], a[196:199], v[52:55]
  buffer_load_dwordx4 v1, s[12:15], s32 offen offset:1024 lds
  v_mfma_f32_16x16x32_bf16 v[56:59], a[132:135], a[212:215], 0
  v_exp_f32 v148, v148
  v_mfma_f32_16x16x32_bf16 v[56:59], a[136:139], a[216:219], v[56:59]
  ds_read_b128 a[172:175], v3 offset:14336
  ds_read_b128 a[176:179], v3 offset:15360
  v_mfma_f32_16x16x32_bf16 v[56:59], a[140:143], a[220:223], v[56:59]
  v_exp_f32 v149, v149
  v_mfma_f32_16x16x32_bf16 v[56:59], a[144:147], a[224:227], v[56:59]
  buffer_load_dwordx4 v1, s[12:15], s32 offen offset:2048 lds
  v_mfma_f32_16x16x32_bf16 v[60:63], a[144:147], a[240:243], 0
  v_exp_f32 v150, v150
  v_mfma_f32_16x16x32_bf16 v[60:63], a[140:143], a[236:239], v[60:63]
  v_cvt_pk_bf16_f32 v133, v134, v135
  v_cvt_pk_bf16_f32 v134, v148, v149
  v_mfma_f32_16x16x32_bf16 v[60:63], a[136:139], a[232:235], v[60:63]
  v_exp_f32 v151, v151
  v_mfma_f32_16x16x32_bf16 v[60:63], a[132:135], a[228:231], v[60:63]
  buffer_load_dwordx4 v1, s[12:15], s32 offen offset:3072 lds
  s_waitcnt lgkmcnt(4)
  v_mfma_f32_16x16x32_bf16 v[64:67], a[148:151], a[180:183], 0
  v_exp_f32 v136, v136
  v_mfma_f32_16x16x32_bf16 v[64:67], a[152:155], a[184:187], v[64:67]
  s_add_u32 s26, s26, 32768
  s_cmp_eq_u32 s26, s62
  s_cselect_b32 s26, s63, s26
  s_cselect_b32 s62, -1, s62
  v_mfma_f32_16x16x32_bf16 v[64:67], a[156:159], a[188:191], v[64:67]
  v_exp_f32 v137, v137
  v_mfma_f32_16x16x32_bf16 v[64:67], a[160:163], a[192:195], v[64:67]
  v_cvt_pk_bf16_f32 v135, v150, v151
  v_cvt_pk_bf16_f32 v136, v136, v137
  v_mfma_f32_16x16x32_bf16 v[68:71], a[160:163], a[208:211], 0
  v_exp_f32 v138, v138
  v_mfma_f32_16x16x32_bf16 v[68:71], a[156:159], a[204:207], v[68:71]
  v_mfma_f32_16x16x32_bf16 v[68:71], a[152:155], a[200:203], v[68:71]
  v_exp_f32 v139, v139
  v_mfma_f32_16x16x32_bf16 v[68:71], a[148:151], a[196:199], v[68:71]
  v_cvt_pk_bf16_f32 v137, v138, v139
  v_mfma_f32_16x16x32_bf16 v[72:75], a[148:151], a[212:215], 0
  v_exp_f32 v152, v152
  v_mfma_f32_16x16x32_bf16 v[72:75], a[152:155], a[216:219], v[72:75]
  v_mfma_f32_16x16x32_bf16 v[72:75], a[156:159], a[220:223], v[72:75]
  v_exp_f32 v153, v153
  v_mfma_f32_16x16x32_bf16 v[72:75], a[160:163], a[224:227], v[72:75]
  v_cvt_pk_bf16_f32 v138, v152, v153
  v_mfma_f32_16x16x32_bf16 v[76:79], a[160:163], a[240:243], 0
  v_exp_f32 v154, v154
  v_mfma_f32_16x16x32_bf16 v[76:79], a[156:159], a[236:239], v[76:79]
  s_waitcnt vmcnt(16) lgkmcnt(0)
  s_barrier
  ds_read_b128 a[116:119], v3 offset:32768
  ds_read_b128 a[120:123], v3 offset:40960
  ds_read_b128 a[124:127], v3 offset:33792
  ds_read_b128 a[128:131], v3 offset:41984
  v_mfma_f32_16x16x32_bf16 v[76:79], a[152:155], a[232:235], v[76:79]
  v_exp_f32 v155, v155
  v_mfma_f32_16x16x32_bf16 v[76:79], a[148:151], a[228:231], v[76:79]
  v_cvt_pk_bf16_f32 v139, v154, v155
  v_mfma_f32_16x16x32_bf16 v[80:83], a[164:167], a[180:183], 0
  v_exp_f32 v140, v140
  v_mfma_f32_16x16x32_bf16 v[80:83], a[168:171], a[184:187], v[80:83]
  ds_read_b128 a[132:135], v3 offset:34816
  ds_read_b128 a[136:139], v3 offset:43008
  v_mfma_f32_16x16x32_bf16 v[80:83], a[172:175], a[188:191], v[80:83]
  v_exp_f32 v141, v141
  v_mfma_f32_16x16x32_bf16 v[80:83], a[176:179], a[192:195], v[80:83]
  v_cvt_pk_bf16_f32 v140, v140, v141
  v_mfma_f32_16x16x32_bf16 v[84:87], a[176:179], a[208:211], 0
  v_exp_f32 v142, v142
  v_mfma_f32_16x16x32_bf16 v[84:87], a[172:175], a[204:207], v[84:87]
  v_mfma_f32_16x16x32_bf16 v[84:87], a[168:171], a[200:203], v[84:87]
  v_exp_f32 v143, v143
  v_mfma_f32_16x16x32_bf16 v[84:87], a[164:167], a[196:199], v[84:87]
  v_cvt_pk_bf16_f32 v141, v142, v143
  v_mfma_f32_16x16x32_bf16 v[88:91], a[164:167], a[212:215], 0
  v_exp_f32 v156, v156
  v_mfma_f32_16x16x32_bf16 v[88:91], a[168:171], a[216:219], v[88:91]
  ds_read_b128 a[140:143], v3 offset:35840
  ds_read_b128 a[144:147], v3 offset:44032
  v_mfma_f32_16x16x32_bf16 v[88:91], a[172:175], a[220:223], v[88:91]
  v_exp_f32 v157, v157
  v_mfma_f32_16x16x32_bf16 v[88:91], a[176:179], a[224:227], v[88:91]
  v_cvt_pk_bf16_f32 v142, v156, v157
  v_mfma_f32_16x16x32_bf16 v[92:95], a[176:179], a[240:243], 0
  v_exp_f32 v158, v158
  v_mfma_f32_16x16x32_bf16 v[92:95], a[172:175], a[236:239], v[92:95]
  v_mfma_f32_16x16x32_bf16 v[92:95], a[168:171], a[232:235], v[92:95]
  v_exp_f32 v159, v159
  v_mfma_f32_16x16x32_bf16 v[92:95], a[164:167], a[228:231], v[92:95]
  v_cvt_pk_bf16_f32 v143, v158, v159
  s_waitcnt lgkmcnt(6)
  s_add_u32 m0, s29, 65536
  v_mfma_f32_16x16x32_bf16 v[160:163], a[116:119], v[96:99], v[160:163]
  v_exp_f32 v32, v32
  v_mfma_f32_16x16x32_bf16 v[160:163], a[120:123], v[128:131], v[160:163]
  ds_read_b128 a[148:151], v3 offset:36864
  ds_read_b128 a[152:155], v3 offset:45056
  v_mfma_f32_16x16x32_bf16 v[164:167], a[120:123], v[132:135], v[164:167]
  v_exp_f32 v33, v33
  v_mfma_f32_16x16x32_bf16 v[164:167], a[116:119], v[100:103], v[164:167]
  buffer_load_dwordx4 v1, s[12:15], s25 offen offset:0 lds
  s_add_u32 s32, s25, 4096
  v_mfma_f32_16x16x32_bf16 v[168:171], a[116:119], v[104:107], v[168:171]
  v_exp_f32 v34, v34
  v_mfma_f32_16x16x32_bf16 v[168:171], a[120:123], v[136:139], v[168:171]
  v_cvt_pk_bf16_f32 v32, v32, v33
  v_mfma_f32_16x16x32_bf16 v[172:175], a[120:123], v[140:143], v[172:175]
  v_exp_f32 v35, v35
  v_mfma_f32_16x16x32_bf16 v[172:175], a[116:119], v[108:111], v[172:175]
  buffer_load_dwordx4 v1, s[12:15], s25 offen offset:1024 lds
  s_waitcnt lgkmcnt(6)
  v_mfma_f32_16x16x32_bf16 a[32:35], a[48:51], v[96:99], a[32:35]
  v_mfma_f32_16x16x32_bf16 a[32:35], a[48:51], v[128:131], a[32:35]
  v_mfma_f32_16x16x32_bf16 v[176:179], a[124:127], v[96:99], v[176:179]
  v_exp_f32 v48, v48
  v_mfma_f32_16x16x32_bf16 v[176:179], a[128:131], v[128:131], v[176:179]
  ds_read_b128 a[156:159], v3 offset:37888
  ds_read_b128 a[160:163], v3 offset:46080
  v_mfma_f32_16x16x32_bf16 v[180:183], a[128:131], v[132:135], v[180:183]
  v_exp_f32 v49, v49
  v_mfma_f32_16x16x32_bf16 v[180:183], a[124:127], v[100:103], v[180:183]
  buffer_load_dwordx4 v1, s[12:15], s25 offen offset:2048 lds
  v_mfma_f32_16x16x32_bf16 v[184:187], a[124:127], v[104:107], v[184:187]
  v_exp_f32 v50, v50
  v_mfma_f32_16x16x32_bf16 v[184:187], a[128:131], v[136:139], v[184:187]
  v_cvt_pk_bf16_f32 v33, v34, v35
  v_cvt_pk_bf16_f32 v34, v48, v49
  v_mfma_f32_16x16x32_bf16 v[188:191], a[128:131], v[140:143], v[188:191]
  v_exp_f32 v51, v51
  v_mfma_f32_16x16x32_bf16 v[188:191], a[124:127], v[108:111], v[188:191]
  buffer_load_dwordx4 v1, s[12:15], s25 offen offset:3072 lds
  s_add_u32 m0, s29, 69632
  s_waitcnt lgkmcnt(6)
  v_mfma_f32_16x16x32_bf16 a[36:39], a[48:51], v[100:103], a[36:39]
  v_mfma_f32_16x16x32_bf16 a[36:39], a[48:51], v[132:135], a[36:39]
  v_mfma_f32_16x16x32_bf16 v[192:195], a[132:135], v[96:99], v[192:195]
  v_exp_f32 v36, v36
  v_mfma_f32_16x16x32_bf16 v[192:195], a[136:139], v[128:131], v[192:195]
  ds_read_b128 a[164:167], v3 offset:38912
  ds_read_b128 a[168:171], v3 offset:47104
  v_mfma_f32_16x16x32_bf16 v[196:199], a[136:139], v[132:135], v[196:199]
  v_exp_f32 v37, v37
  v_mfma_f32_16x16x32_bf16 v[196:199], a[132:135], v[100:103], v[196:199]
  buffer_load_dwordx4 v1, s[12:15], s32 offen offset:0 lds
  v_mfma_f32_16x16x32_bf16 v[200:203], a[132:135], v[104:107], v[200:203]
  v_exp_f32 v38, v38
  v_mfma_f32_16x16x32_bf16 v[200:203], a[136:139], v[136:139], v[200:203]
  v_cvt_pk_bf16_f32 v35, v50, v51
  v_cvt_pk_bf16_f32 v36, v36, v37
  v_mfma_f32_16x16x32_bf16 v[204:207], a[136:139], v[140:143], v[204:207]
  v_exp_f32 v39, v39
  v_mfma_f32_16x16x32_bf16 v[204:207], a[132:135], v[108:111], v[204:207]
  buffer_load_dwordx4 v1, s[12:15], s32 offen offset:1024 lds
  s_waitcnt lgkmcnt(6)
  v_mfma_f32_16x16x32_bf16 a[40:43], a[48:51], v[104:107], a[40:43]
  v_mfma_f32_16x16x32_bf16 a[40:43], a[48:51], v[136:139], a[40:43]
  v_mfma_f32_16x16x32_bf16 v[208:211], a[140:143], v[96:99], v[208:211]
  v_exp_f32 v52, v52
  v_mfma_f32_16x16x32_bf16 v[208:211], a[144:147], v[128:131], v[208:211]
  ds_read_b128 a[172:175], v3 offset:39936
  ds_read_b128 a[176:179], v3 offset:48128
  v_mfma_f32_16x16x32_bf16 v[212:215], a[144:147], v[132:135], v[212:215]
  v_exp_f32 v53, v53
  v_mfma_f32_16x16x32_bf16 v[212:215], a[140:143], v[100:103], v[212:215]
  buffer_load_dwordx4 v1, s[12:15], s32 offen offset:2048 lds
  v_mfma_f32_16x16x32_bf16 v[216:219], a[140:143], v[104:107], v[216:219]
  v_exp_f32 v54, v54
  v_mfma_f32_16x16x32_bf16 v[216:219], a[144:147], v[136:139], v[216:219]
  v_cvt_pk_bf16_f32 v37, v38, v39
  v_cvt_pk_bf16_f32 v38, v52, v53
  v_mfma_f32_16x16x32_bf16 v[220:223], a[144:147], v[140:143], v[220:223]
  v_exp_f32 v55, v55
  v_mfma_f32_16x16x32_bf16 v[220:223], a[140:143], v[108:111], v[220:223]
  buffer_load_dwordx4 v1, s[12:15], s32 offen offset:3072 lds
  s_waitcnt lgkmcnt(6)
  v_mfma_f32_16x16x32_bf16 a[44:47], a[48:51], v[108:111], a[44:47]
  v_mfma_f32_16x16x32_bf16 a[44:47], a[48:51], v[140:143], a[44:47]
  v_mfma_f32_16x16x32_bf16 v[224:227], a[148:151], v[96:99], v[224:227]
  v_exp_f32 v40, v40
  v_mfma_f32_16x16x32_bf16 v[224:227], a[152:155], v[128:131], v[224:227]
  s_add_u32 s25, s25, 32768
  s_cmp_eq_u32 s25, s27
  s_cselect_b32 s25, s28, s25
  s_cselect_b32 s27, -1, s27
  v_mfma_f32_16x16x32_bf16 v[228:231], a[152:155], v[132:135], v[228:231]
  v_exp_f32 v41, v41
  v_mfma_f32_16x16x32_bf16 v[228:231], a[148:151], v[100:103], v[228:231]
  v_cvt_pk_bf16_f32 v39, v54, v55
  v_cvt_pk_bf16_f32 v40, v40, v41
  v_mfma_f32_16x16x32_bf16 v[232:235], a[148:151], v[104:107], v[232:235]
  v_exp_f32 v42, v42
  v_mfma_f32_16x16x32_bf16 v[232:235], a[152:155], v[136:139], v[232:235]
  v_mfma_f32_16x16x32_bf16 v[236:239], a[152:155], v[140:143], v[236:239]
  v_exp_f32 v43, v43
  v_mfma_f32_16x16x32_bf16 v[236:239], a[148:151], v[108:111], v[236:239]
  v_cvt_pk_bf16_f32 v41, v42, v43
  s_waitcnt lgkmcnt(4)
  v_mfma_f32_16x16x32_bf16 v[240:243], a[156:159], v[96:99], v[240:243]
  v_exp_f32 v56, v56
  v_mfma_f32_16x16x32_bf16 v[240:243], a[160:163], v[128:131], v[240:243]
  v_mfma_f32_16x16x32_bf16 v[244:247], a[160:163], v[132:135], v[244:247]
  v_exp_f32 v57, v57
  v_mfma_f32_16x16x32_bf16 v[244:247], a[156:159], v[100:103], v[244:247]
  v_cvt_pk_bf16_f32 v42, v56, v57
  v_mfma_f32_16x16x32_bf16 v[248:251], a[156:159], v[104:107], v[248:251]
  v_exp_f32 v58, v58
  v_mfma_f32_16x16x32_bf16 v[248:251], a[160:163], v[136:139], v[248:251]
  s_waitcnt vmcnt(16) lgkmcnt(0)
  s_barrier
  ds_read_b128 a[116:119], v2 offset:0
  ds_read_b128 a[120:123], v2 offset:1024
  ds_read_b128 a[124:127], v2 offset:2048
  ds_read_b128 a[128:131], v2 offset:3072
  v_mfma_f32_16x16x32_bf16 v[252:255], a[160:163], v[140:143], v[252:255]
  v_exp_f32 v59, v59
  v_mfma_f32_16x16x32_bf16 v[252:255], a[156:159], v[108:111], v[252:255]
  v_cvt_pk_bf16_f32 v43, v58, v59
  v_mfma_f32_16x16x32_bf16 a[0:3], a[164:167], v[96:99], a[0:3]
  v_exp_f32 v44, v44
  v_mfma_f32_16x16x32_bf16 a[0:3], a[168:171], v[128:131], a[0:3]
  ds_read_b128 a[132:135], v2 offset:4096
  ds_read_b128 a[136:139], v2 offset:5120
  v_mfma_f32_16x16x32_bf16 a[4:7], a[168:171], v[132:135], a[4:7]
  v_exp_f32 v45, v45
  v_mfma_f32_16x16x32_bf16 a[4:7], a[164:167], v[100:103], a[4:7]
  v_cvt_pk_bf16_f32 v44, v44, v45
  v_mfma_f32_16x16x32_bf16 a[8:11], a[164:167], v[104:107], a[8:11]
  v_exp_f32 v46, v46
  v_mfma_f32_16x16x32_bf16 a[8:11], a[168:171], v[136:139], a[8:11]
  v_mfma_f32_16x16x32_bf16 a[12:15], a[168:171], v[140:143], a[12:15]
  v_exp_f32 v47, v47
  v_mfma_f32_16x16x32_bf16 a[12:15], a[164:167], v[108:111], a[12:15]
  v_cvt_pk_bf16_f32 v45, v46, v47
  v_mfma_f32_16x16x32_bf16 a[16:19], a[172:175], v[96:99], a[16:19]
  v_exp_f32 v60, v60
  v_mfma_f32_16x16x32_bf16 a[16:19], a[176:179], v[128:131], a[16:19]
  ds_read_b128 a[140:143], v2 offset:6144
  ds_read_b128 a[144:147], v2 offset:7168
  v_mfma_f32_16x16x32_bf16 a[20:23], a[176:179], v[132:135], a[20:23]
  v_exp_f32 v61, v61
  v_mfma_f32_16x16x32_bf16 a[20:23], a[172:175], v[100:103], a[20:23]
  v_cvt_pk_bf16_f32 v46, v60, v61
  v_mfma_f32_16x16x32_bf16 a[24:27], a[172:175], v[104:107], a[24:27]
  v_exp_f32 v62, v62
  v_mfma_f32_16x16x32_bf16 a[24:27], a[176:179], v[136:139], a[24:27]
  v_mfma_f32_16x16x32_bf16 a[28:31], a[176:179], v[140:143], a[28:31]
  v_exp_f32 v63, v63
  v_mfma_f32_16x16x32_bf16 a[28:31], a[172:175], v[108:111], a[28:31]
  v_cvt_pk_bf16_f32 v47, v62, v63
  v_accvgpr_read_b32 v20, a32
  v_accvgpr_read_b32 v21, a36
  v_accvgpr_read_b32 v22, a40
  v_accvgpr_read_b32 v23, a44
  v_rcp_f32 v8, v20
  v_rcp_f32 v9, v21
  v_rcp_f32 v10, v22
  v_rcp_f32 v11, v23
  v_subrev_u32 v20, 0x21800000, v20
  v_subrev_u32 v21, 0x21800000, v21
  v_subrev_u32 v22, 0x21800000, v22
  v_subrev_u32 v23, 0x21800000, v23
  v_max_u32 v12, v20, v21
  v_max3_u32 v12, v12, v22, v23
  s_mov_b32 s64, 0x207
  v_pk_mul_f32 v[160:161], v[160:161], v[8:9] op_sel:[0,0] op_sel_hi:[1,0]
  v_pk_mul_f32 v[162:163], v[162:163], v[8:9] op_sel:[0,0] op_sel_hi:[1,0]
  v_pk_mul_f32 v[176:177], v[176:177], v[8:9] op_sel:[0,0] op_sel_hi:[1,0]
  v_pk_mul_f32 v[178:179], v[178:179], v[8:9] op_sel:[0,0] op_sel_hi:[1,0]
  v_cvt_pk_bf16_f32 v160, v160, v161
  v_cvt_pk_bf16_f32 v161, v162, v163
  v_cvt_pk_bf16_f32 v162, v176, v177
  v_cvt_pk_bf16_f32 v163, v178, v179
  s_nop 1
  v_mfma_f32_16x16x32_bf16 v[24:27], a[48:51], v[160:163], 0
  v_pk_mul_f32 v[164:165], v[164:165], v[8:9] op_sel:[0,1] op_sel_hi:[1,1]
  v_pk_mul_f32 v[166:167], v[166:167], v[8:9] op_sel:[0,1] op_sel_hi:[1,1]
  v_pk_mul_f32 v[180:181], v[180:181], v[8:9] op_sel:[0,1] op_sel_hi:[1,1]
  v_pk_mul_f32 v[182:183], v[182:183], v[8:9] op_sel:[0,1] op_sel_hi:[1,1]
  v_cvt_pk_bf16_f32 v164, v164, v165
  v_cvt_pk_bf16_f32 v165, v166, v167
  v_cvt_pk_bf16_f32 v166, v180, v181
  v_cvt_pk_bf16_f32 v167, v182, v183
  s_nop 1
  v_mfma_f32_16x16x32_bf16 v[24:27], a[48:51], v[164:167], v[24:27]
  v_pk_mul_f32 v[168:169], v[168:169], v[10:11] op_sel:[0,0] op_sel_hi:[1,0]
  v_pk_mul_f32 v[170:171], v[170:171], v[10:11] op_sel:[0,0] op_sel_hi:[1,0]
  v_pk_mul_f32 v[184:185], v[184:185], v[10:11] op_sel:[0,0] op_sel_hi:[1,0]
  v_pk_mul_f32 v[186:187], v[186:187], v[10:11] op_sel:[0,0] op_sel_hi:[1,0]
  v_cvt_pk_bf16_f32 v168, v168, v169
  v_cvt_pk_bf16_f32 v169, v170, v171
  v_cvt_pk_bf16_f32 v170, v184, v185
  v_cvt_pk_bf16_f32 v171, v186, v187
  s_nop 1
  v_mfma_f32_16x16x32_bf16 v[24:27], a[48:51], v[168:171], v[24:27]
  v_pk_mul_f32 v[172:173], v[172:173], v[10:11] op_sel:[0,1] op_sel_hi:[1,1]
  v_pk_mul_f32 v[174:175], v[174:175], v[10:11] op_sel:[0,1] op_sel_hi:[1,1]
  v_pk_mul_f32 v[188:189], v[188:189], v[10:11] op_sel:[0,1] op_sel_hi:[1,1]
  v_pk_mul_f32 v[190:191], v[190:191], v[10:11] op_sel:[0,1] op_sel_hi:[1,1]
  v_cvt_pk_bf16_f32 v172, v172, v173
  v_cvt_pk_bf16_f32 v173, v174, v175
  v_cvt_pk_bf16_f32 v174, v188, v189
  v_cvt_pk_bf16_f32 v175, v190, v191
  s_nop 1
  v_mfma_f32_16x16x32_bf16 v[24:27], a[48:51], v[172:175], v[24:27]
  v_pk_mul_f32 v[192:193], v[192:193], v[8:9] op_sel:[0,0] op_sel_hi:[1,0]
  v_pk_mul_f32 v[194:195], v[194:195], v[8:9] op_sel:[0,0] op_sel_hi:[1,0]
  v_pk_mul_f32 v[208:209], v[208:209], v[8:9] op_sel:[0,0] op_sel_hi:[1,0]
  v_pk_mul_f32 v[210:211], v[210:211], v[8:9] op_sel:[0,0] op_sel_hi:[1,0]
  v_cvt_pk_bf16_f32 v192, v192, v193
  v_cvt_pk_bf16_f32 v193, v194, v195
  v_cvt_pk_bf16_f32 v194, v208, v209
  v_cvt_pk_bf16_f32 v195, v210, v211
  s_nop 1
  v_mfma_f32_16x16x32_bf16 v[24:27], a[48:51], v[192:195], v[24:27]
  v_pk_mul_f32 v[196:197], v[196:197], v[8:9] op_sel:[0,1] op_sel_hi:[1,1]
  v_pk_mul_f32 v[198:199], v[198:199], v[8:9] op_sel:[0,1] op_sel_hi:[1,1]
  v_pk_mul_f32 v[212:213], v[212:213], v[8:9] op_sel:[0,1] op_sel_hi:[1,1]
  v_pk_mul_f32 v[214:215], v[214:215], v[8:9] op_sel:[0,1] op_sel_hi:[1,1]
  v_cvt_pk_bf16_f32 v196, v196, v197
  v_cvt_pk_bf16_f32 v197, v198, v199
  v_cvt_pk_bf16_f32 v198, v212, v213
  v_cvt_pk_bf16_f32 v199, v214, v215
  s_nop 1
  v_mfma_f32_16x16x32_bf16 v[24:27], a[48:51], v[196:199], v[24:27]
  v_pk_mul_f32 v[200:201], v[200:201], v[10:11] op_sel:[0,0] op_sel_hi:[1,0]
  v_pk_mul_f32 v[202:203], v[202:203], v[10:11] op_sel:[0,0] op_sel_hi:[1,0]
  v_pk_mul_f32 v[216:217], v[216:217], v[10:11] op_sel:[0,0] op_sel_hi:[1,0]
  v_pk_mul_f32 v[218:219], v[218:219], v[10:11] op_sel:[0,0] op_sel_hi:[1,0]
  v_cvt_pk_bf16_f32 v200, v200, v201
  v_cvt_pk_bf16_f32 v201, v202, v203
  v_cvt_pk_bf16_f32 v202, v216, v217
  v_cvt_pk_bf16_f32 v203, v218, v219
  s_nop 1
  v_mfma_f32_16x16x32_bf16 v[24:27], a[48:51], v[200:203], v[24:27]
  v_pk_mul_f32 v[204:205], v[204:205], v[10:11] op_sel:[0,1] op_sel_hi:[1,1]
  v_pk_mul_f32 v[206:207], v[206:207], v[10:11] op_sel:[0,1] op_sel_hi:[1,1]
  v_pk_mul_f32 v[220:221], v[220:221], v[10:11] op_sel:[0,1] op_sel_hi:[1,1]
  v_pk_mul_f32 v[222:223], v[222:223], v[10:11] op_sel:[0,1] op_sel_hi:[1,1]
  v_cvt_pk_bf16_f32 v204, v204, v205
  v_cvt_pk_bf16_f32 v205, v206, v207
  v_cvt_pk_bf16_f32 v206, v220, v221
  v_cvt_pk_bf16_f32 v207, v222, v223
  s_nop 1
  v_mfma_f32_16x16x32_bf16 v[24:27], a[48:51], v[204:207], v[24:27]
  v_pk_mul_f32 v[224:225], v[224:225], v[8:9] op_sel:[0,0] op_sel_hi:[1,0]
  v_pk_mul_f32 v[226:227], v[226:227], v[8:9] op_sel:[0,0] op_sel_hi:[1,0]
  v_pk_mul_f32 v[240:241], v[240:241], v[8:9] op_sel:[0,0] op_sel_hi:[1,0]
  v_pk_mul_f32 v[242:243], v[242:243], v[8:9] op_sel:[0,0] op_sel_hi:[1,0]
  v_cvt_pk_bf16_f32 v224, v224, v225
  v_cvt_pk_bf16_f32 v225, v226, v227
  v_cvt_pk_bf16_f32 v226, v240, v241
  v_cvt_pk_bf16_f32 v227, v242, v243
  s_nop 1
  v_mfma_f32_16x16x32_bf16 v[24:27], a[48:51], v[224:227], v[24:27]
  v_pk_mul_f32 v[228:229], v[228:229], v[8:9] op_sel:[0,1] op_sel_hi:[1,1]
  v_pk_mul_f32 v[230:231], v[230:231], v[8:9] op_sel:[0,1] op_sel_hi:[1,1]
  v_pk_mul_f32 v[244:245], v[244:245], v[8:9] op_sel:[0,1] op_sel_hi:[1,1]
  v_pk_mul_f32 v[246:247], v[246:247], v[8:9] op_sel:[0,1] op_sel_hi:[1,1]
  v_cvt_pk_bf16_f32 v228, v228, v229
  v_cvt_pk_bf16_f32 v229, v230, v231
  v_cvt_pk_bf16_f32 v230, v244, v245
  v_cvt_pk_bf16_f32 v231, v246, v247
  s_nop 1
  v_mfma_f32_16x16x32_bf16 v[24:27], a[48:51], v[228:231], v[24:27]
  v_pk_mul_f32 v[232:233], v[232:233], v[10:11] op_sel:[0,0] op_sel_hi:[1,0]
  v_pk_mul_f32 v[234:235], v[234:235], v[10:11] op_sel:[0,0] op_sel_hi:[1,0]
  v_pk_mul_f32 v[248:249], v[248:249], v[10:11] op_sel:[0,0] op_sel_hi:[1,0]
  v_pk_mul_f32 v[250:251], v[250:251], v[10:11] op_sel:[0,0] op_sel_hi:[1,0]
  v_cvt_pk_bf16_f32 v232, v232, v233
  v_cvt_pk_bf16_f32 v233, v234, v235
  v_cvt_pk_bf16_f32 v234, v248, v249
  v_cvt_pk_bf16_f32 v235, v250, v251
  s_nop 1
  v_mfma_f32_16x16x32_bf16 v[24:27], a[48:51], v[232:235], v[24:27]
  v_pk_mul_f32 v[236:237], v[236:237], v[10:11] op_sel:[0,1] op_sel_hi:[1,1]
  v_pk_mul_f32 v[238:239], v[238:239], v[10:11] op_sel:[0,1] op_sel_hi:[1,1]
  v_pk_mul_f32 v[252:253], v[252:253], v[10:11] op_sel:[0,1] op_sel_hi:[1,1]
  v_pk_mul_f32 v[254:255], v[254:255], v[10:11] op_sel:[0,1] op_sel_hi:[1,1]
  v_cvt_pk_bf16_f32 v236, v236, v237
  v_cvt_pk_bf16_f32 v237, v238, v239
  v_cvt_pk_bf16_f32 v238, v252, v253
  v_cvt_pk_bf16_f32 v239, v254, v255
  v_accvgpr_read_b32 v176, a0
  v_accvgpr_read_b32 v177, a1
  v_accvgpr_read_b32 v178, a2
  v_accvgpr_read_b32 v179, a3
  v_accvgpr_read_b32 v180, a16
  v_accvgpr_read_b32 v181, a17
  v_accvgpr_read_b32 v182, a18
  v_accvgpr_read_b32 v183, a19
  v_mfma_f32_16x16x32_bf16 v[24:27], a[48:51], v[236:239], v[24:27]
  v_pk_mul_f32 v[176:177], v[176:177], v[8:9] op_sel:[0,0] op_sel_hi:[1,0]
  v_pk_mul_f32 v[178:179], v[178:179], v[8:9] op_sel:[0,0] op_sel_hi:[1,0]
  v_pk_mul_f32 v[180:181], v[180:181], v[8:9] op_sel:[0,0] op_sel_hi:[1,0]
  v_pk_mul_f32 v[182:183], v[182:183], v[8:9] op_sel:[0,0] op_sel_hi:[1,0]
  v_cvt_pk_bf16_f32 v176, v176, v177
  v_cvt_pk_bf16_f32 v177, v178, v179
  v_cvt_pk_bf16_f32 v178, v180, v181
  v_cvt_pk_bf16_f32 v179, v182, v183
  v_accvgpr_read_b32 v184, a4
  v_accvgpr_read_b32 v185, a5
  v_accvgpr_read_b32 v186, a6
  v_accvgpr_read_b32 v187, a7
  v_accvgpr_read_b32 v188, a20
  v_accvgpr_read_b32 v189, a21
  v_accvgpr_read_b32 v190, a22
  v_accvgpr_read_b32 v191, a23
  v_mfma_f32_16x16x32_bf16 v[24:27], a[48:51], v[176:179], v[24:27]
  v_pk_mul_f32 v[184:185], v[184:185], v[8:9] op_sel:[0,1] op_sel_hi:[1,1]
  v_pk_mul_f32 v[186:187], v[186:187], v[8:9] op_sel:[0,1] op_sel_hi:[1,1]
  v_pk_mul_f32 v[188:189], v[188:189], v[8:9] op_sel:[0,1] op_sel_hi:[1,1]
  v_pk_mul_f32 v[190:191], v[190:191], v[8:9] op_sel:[0,1] op_sel_hi:[1,1]
  v_cvt_pk_bf16_f32 v184, v184, v185
  v_cvt_pk_bf16_f32 v185, v186, v187
  v_cvt_pk_bf16_f32 v186, v188, v189
  v_cvt_pk_bf16_f32 v187, v190, v191
  v_accvgpr_read_b32 v208, a8
  v_accvgpr_read_b32 v209, a9
  v_accvgpr_read_b32 v210, a10
  v_accvgpr_read_b32 v211, a11
  v_accvgpr_read_b32 v212, a24
  v_accvgpr_read_b32 v213, a25
  v_accvgpr_read_b32 v214, a26
  v_accvgpr_read_b32 v215, a27
  v_mfma_f32_16x16x32_bf16 v[24:27], a[48:51], v[184:187], v[24:27]
  v_pk_mul_f32 v[208:209], v[208:209], v[10:11] op_sel:[0,0] op_sel_hi:[1,0]
  v_pk_mul_f32 v[210:211], v[210:211], v[10:11] op_sel:[0,0] op_sel_hi:[1,0]
  v_pk_mul_f32 v[212:213], v[212:213], v[10:11] op_sel:[0,0] op_sel_hi:[1,0]
  v_pk_mul_f32 v[214:215], v[214:215], v[10:11] op_sel:[0,0] op_sel_hi:[1,0]
  v_cvt_pk_bf16_f32 v208, v208, v209
  v_cvt_pk_bf16_f32 v209, v210, v211
  v_cvt_pk_bf16_f32 v210, v212, v213
  v_cvt_pk_bf16_f32 v211, v214, v215
  v_accvgpr_read_b32 v216, a12
  v_accvgpr_read_b32 v217, a13
  v_accvgpr_read_b32 v218, a14
  v_accvgpr_read_b32 v219, a15
  v_accvgpr_read_b32 v220, a28
  v_accvgpr_read_b32 v221, a29
  v_accvgpr_read_b32 v222, a30
  v_accvgpr_read_b32 v223, a31
  v_mfma_f32_16x16x32_bf16 v[24:27], a[48:51], v[208:211], v[24:27]
  v_pk_mul_f32 v[216:217], v[216:217], v[10:11] op_sel:[0,1] op_sel_hi:[1,1]
  v_pk_mul_f32 v[218:219], v[218:219], v[10:11] op_sel:[0,1] op_sel_hi:[1,1]
  v_pk_mul_f32 v[220:221], v[220:221], v[10:11] op_sel:[0,1] op_sel_hi:[1,1]
  v_pk_mul_f32 v[222:223], v[222:223], v[10:11] op_sel:[0,1] op_sel_hi:[1,1]
  v_cvt_pk_bf16_f32 v216, v216, v217
  v_cvt_pk_bf16_f32 v217, v218, v219
  v_cvt_pk_bf16_f32 v218, v220, v221
  v_cvt_pk_bf16_f32 v219, v222, v223
  s_nop 1
  v_mfma_f32_16x16x32_bf16 v[24:27], a[48:51], v[216:219], v[24:27]
  v_cmp_lt_u32 vcc, 0x3c000000, v12
  s_nop 6
  v_cmp_class_f32 s[40:41], v24, s64
  s_nop 0
  s_or_b64 vcc, vcc, s[40:41]
  s_cbranch_vccnz Lbad_1
  s_lshl_b32 s33, s21, 3
  s_lshl_b32 s34, s23, 2
  s_add_u32 s33, s33, s34
  s_lshl_b32 s33, s33, 17
  s_lshl_b32 s34, s20, 12
  s_add_u32 s36, s33, s34
  s_add_u32 s37, s36, 131072
  s_add_u32 s38, s36, 262144
  s_add_u32 s39, s36, 393216
  buffer_store_dwordx4 v[160:163], v1, s[16:19], s36 offen offset:0
  buffer_store_dwordx4 v[164:167], v1, s[16:19], s37 offen offset:0
  buffer_store_dwordx4 v[168:171], v1, s[16:19], s38 offen offset:0
  buffer_store_dwordx4 v[172:175], v1, s[16:19], s39 offen offset:0
  buffer_store_dwordx4 v[192:195], v1, s[16:19], s36 offen offset:1024
  buffer_store_dwordx4 v[196:199], v1, s[16:19], s37 offen offset:1024
  buffer_store_dwordx4 v[200:203], v1, s[16:19], s38 offen offset:1024
  buffer_store_dwordx4 v[204:207], v1, s[16:19], s39 offen offset:1024
  buffer_store_dwordx4 v[224:227], v1, s[16:19], s36 offen offset:2048
  buffer_store_dwordx4 v[228:231], v1, s[16:19], s37 offen offset:2048
  buffer_store_dwordx4 v[232:235], v1, s[16:19], s38 offen offset:2048
  buffer_store_dwordx4 v[236:239], v1, s[16:19], s39 offen offset:2048
  buffer_store_dwordx4 v[176:179], v1, s[16:19], s36 offen offset:3072
  buffer_store_dwordx4 v[184:187], v1, s[16:19], s37 offen offset:3072
  buffer_store_dwordx4 v[208:211], v1, s[16:19], s38 offen offset:3072
  buffer_store_dwordx4 v[216:219], v1, s[16:19], s39 offen offset:3072
  s_branch Lfd_2
Lbad_1:
  s_or_b32 s60, s60, 1
Lfd_2:
  s_sub_u32 s30, 7, s21
  s_cmp_lg_u32 s30, 0
  s_cbranch_scc1 Lk2_b0
  s_waitcnt vmcnt(8)
  s_waitcnt lgkmcnt(0)
  s_barrier
  ds_read_b128 a[116:119], v2 offset:32768
  ds_read_b128 a[120:123], v2 offset:40960
  ds_read_b128 a[124:127], v2 offset:33792
  ds_read_b128 a[128:131], v2 offset:41984
  ds_read_b128 a[132:135], v2 offset:34816
  ds_read_b128 a[136:139], v2 offset:43008
  ds_read_b128 a[140:143], v2 offset:35840
  ds_read_b128 a[144:147], v2 offset:44032
  v_exp_f32 v64, v64
  v_exp_f32 v65, v65
  v_exp_f32 v66, v66
  v_exp_f32 v67, v67
  v_exp_f32 v80, v80
  v_exp_f32 v81, v81
  v_exp_f32 v82, v82
  v_exp_f32 v83, v83
  v_cvt_pk_bf16_f32 v64, v64, v65
  v_cvt_pk_bf16_f32 v65, v66, v67
  v_exp_f32 v68, v68
  v_exp_f32 v69, v69
  v_exp_f32 v70, v70
  v_exp_f32 v71, v71
  v_cvt_pk_bf16_f32 v66, v80, v81
  v_cvt_pk_bf16_f32 v67, v82, v83
  v_exp_f32 v84, v84
  v_exp_f32 v85, v85
  v_exp_f32 v86, v86
  v_exp_f32 v87, v87
  v_cvt_pk_bf16_f32 v68, v68, v69
  v_cvt_pk_bf16_f32 v69, v70, v71
  v_exp_f32 v72, v72
  v_exp_f32 v73, v73
  v_exp_f32 v74, v74
  v_exp_f32 v75, v75
  v_cvt_pk_bf16_f32 v70, v84, v85
  v_cvt_pk_bf16_f32 v71, v86, v87
  v_exp_f32 v88, v88
  v_exp_f32 v89, v89
  v_exp_f32 v90, v90
  v_exp_f32 v91, v91
  v_cvt_pk_bf16_f32 v72, v72, v73
  v_cvt_pk_bf16_f32 v73, v74, v75
  v_exp_f32 v76, v76
  v_exp_f32 v77, v77
  v_exp_f32 v78, v78
  v_exp_f32 v79, v79
  v_cvt_pk_bf16_f32 v74, v88, v89
  v_cvt_pk_bf16_f32 v75, v90, v91
  v_exp_f32 v92, v92
  v_exp_f32 v93, v93
  v_exp_f32 v94, v94
  v_exp_f32 v95, v95
  v_cvt_pk_bf16_f32 v76, v76, v77
  v_cvt_pk_bf16_f32 v77, v78, v79
  v_cvt_pk_bf16_f32 v78, v92, v93
  v_cvt_pk_bf16_f32 v79, v94, v95
  s_waitcnt lgkmcnt(6)
  v_mfma_f32_16x16x32_bf16 v[160:163], a[116:119], v[32:35], 0
  v_mfma_f32_16x16x32_bf16 v[160:163], a[120:123], v[64:67], v[160:163]
  ds_read_b128 a[148:151], v2 offset:36864
  ds_read_b128 a[152:155], v2 offset:45056
  v_mfma_f32_16x16x32_bf16 v[164:167], a[120:123], v[68:71], 0
  v_mfma_f32_16x16x32_bf16 v[164:167], a[116:119], v[36:39], v[164:167]
  v_mfma_f32_16x16x32_bf16 v[168:171], a[116:119], v[40:43], 0
  v_mfma_f32_16x16x32_bf16 v[168:171], a[120:123], v[72:75], v[168:171]
  v_mfma_f32_16x16x32_bf16 v[172:175], a[120:123], v[76:79], 0
  v_mfma_f32_16x16x32_bf16 v[172:175], a[116:119], v[44:47], v[172:175]
  s_waitcnt lgkmcnt(6)
  v_mfma_f32_16x16x32_bf16 a[32:35], a[48:51], v[32:35], 0
  v_mfma_f32_16x16x32_bf16 a[32:35], a[48:51], v[64:67], a[32:35]
  v_mfma_f32_16x16x32_bf16 v[176:179], a[124:127], v[32:35], 0
  v_mfma_f32_16x16x32_bf16 v[176:179], a[128:131], v[64:67], v[176:179]
  ds_read_b128 a[156:159], v2 offset:37888
  ds_read_b128 a[160:163], v2 offset:46080
  v_mfma_f32_16x16x32_bf16 v[180:183], a[128:131], v[68:71], 0
  v_mfma_f32_16x16x32_bf16 v[180:183], a[124:127], v[36:39], v[180:183]
  v_mfma_f32_16x16x32_bf16 v[184:187], a[124:127], v[40:43], 0
  v_mfma_f32_16x16x32_bf16 v[184:187], a[128:131], v[72:75], v[184:187]
  v_mfma_f32_16x16x32_bf16 v[188:191], a[128:131], v[76:79], 0
  v_mfma_f32_16x16x32_bf16 v[188:191], a[124:127], v[44:47], v[188:191]
  s_waitcnt lgkmcnt(6)
  v_mfma_f32_16x16x32_bf16 a[36:39], a[48:51], v[36:39], 0
  v_mfma_f32_16x16x32_bf16 a[36:39], a[48:51], v[68:71], a[36:39]
  v_mfma_f32_16x16x32_bf16 v[192:195], a[132:135], v[32:35], 0
  v_mfma_f32_16x16x32_bf16 v[192:195], a[136:139], v[64:67], v[192:195]
  ds_read_b128 a[164:167], v2 offset:38912
  ds_read_b128 a[168:171], v2 offset:47104
  v_mfma_f32_16x16x32_bf16 v[196:199], a[136:139], v[68:71], 0
  v_mfma_f32_16x16x32_bf16 v[196:199], a[132:135], v[36:39], v[196:199]
  v_mfma_f32_16x16x32_bf16 v[200:203], a[132:135], v[40:43], 0
  v_mfma_f32_16x16x32_bf16 v[200:203], a[136:139], v[72:75], v[200:203]
  v_mfma_f32_16x16x32_bf16 v[204:207], a[136:139], v[76:79], 0
  v_mfma_f32_16x16x32_bf16 v[204:207], a[132:135], v[44:47], v[204:207]
  s_waitcnt lgkmcnt(6)
  v_mfma_f32_16x16x32_bf16 a[40:43], a[48:51], v[40:43], 0
  v_mfma_f32_16x16x32_bf16 a[40:43], a[48:51], v[72:75], a[40:43]
  v_mfma_f32_16x16x32_bf16 v[208:211], a[140:143], v[32:35], 0
  v_mfma_f32_16x16x32_bf16 v[208:211], a[144:147], v[64:67], v[208:211]
  ds_read_b128 a[172:175], v2 offset:39936
  ds_read_b128 a[176:179], v2 offset:48128
  v_mfma_f32_16x16x32_bf16 v[212:215], a[144:147], v[68:71], 0
  v_mfma_f32_16x16x32_bf16 v[212:215], a[140:143], v[36:39], v[212:215]
  v_mfma_f32_16x16x32_bf16 v[216:219], a[140:143], v[40:43], 0
  v_mfma_f32_16x16x32_bf16 v[216:219], a[144:147], v[72:75], v[216:219]
  v_mfma_f32_16x16x32_bf16 v[220:223], a[144:147], v[76:79], 0
  v_mfma_f32_16x16x32_bf16 v[220:223], a[140:143], v[44:47], v[220:223]
  s_waitcnt lgkmcnt(6)
  v_mfma_f32_16x16x32_bf16 a[44:47], a[48:51], v[44:47], 0
  v_mfma_f32_16x16x32_bf16 a[44:47], a[48:51], v[76:79], a[44:47]
  v_mfma_f32_16x16x32_bf16 v[224:227], a[148:151], v[32:35], 0
  v_mfma_f32_16x16x32_bf16 v[224:227], a[152:155], v[64:67], v[224:227]
  v_mfma_f32_16x16x32_bf16 v[228:231], a[152:155], v[68:71], 0
  v_mfma_f32_16x16x32_bf16 v[228:231], a[148:151], v[36:39], v[228:231]
  v_mfma_f32_16x16x32_bf16 v[232:235], a[148:151], v[40:43], 0
  v_mfma_f32_16x16x32_bf16 v[232:235], a[152:155], v[72:75], v[232:235]
  v_mfma_f32_16x16x32_bf16 v[236:239], a[152:155], v[76:79], 0
  v_mfma_f32_16x16x32_bf16 v[236:239], a[148:151], v[44:47], v[236:239]
  s_waitcnt lgkmcnt(4)
  v_mfma_f32_16x16x32_bf16 v[240:243], a[156:159], v[32:35], 0
  v_mfma_f32_16x16x32_bf16 v[240:243], a[160:163], v[64:67], v[240:243]
  v_mfma_f32_16x16x32_bf16 v[244:247], a[160:163], v[68:71], 0
  v_mfma_f32_16x16x32_bf16 v[244:247], a[156:159], v[36:39], v[244:247]
  v_mfma_f32_16x16x32_bf16 v[248:251], a[156:159], v[40:43], 0
  v_mfma_f32_16x16x32_bf16 v[248:251], a[160:163], v[72:75], v[248:251]
  s_waitcnt vmcnt(63) lgkmcnt(0)
  s_barrier
  v_mfma_f32_16x16x32_bf16 v[252:255], a[160:163], v[76:79], 0
  v_mfma_f32_16x16x32_bf16 v[252:255], a[156:159], v[44:47], v[252:255]
  v_mfma_f32_16x16x32_bf16 a[0:3], a[164:167], v[32:35], 0
  v_mfma_f32_16x16x32_bf16 a[0:3], a[168:171], v[64:67], a[0:3]
  v_mfma_f32_16x16x32_bf16 a[4:7], a[168:171], v[68:71], 0
  v_mfma_f32_16x16x32_bf16 a[4:7], a[164:167], v[36:39], a[4:7]
  v_mfma_f32_16x16x32_bf16 a[8:11], a[164:167], v[40:43], 0
  v_mfma_f32_16x16x32_bf16 a[8:11], a[168:171], v[72:75], a[8:11]
  v_mfma_f32_16x16x32_bf16 a[12:15], a[168:171], v[76:79], 0
  v_mfma_f32_16x16x32_bf16 a[12:15], a[164:167], v[44:47], a[12:15]
  v_mfma_f32_16x16x32_bf16 a[16:19], a[172:175], v[32:35], 0
  v_mfma_f32_16x16x32_bf16 a[16:19], a[176:179], v[64:67], a[16:19]
  v_mfma_f32_16x16x32_bf16 a[20:23], a[176:179], v[68:71], 0
  v_mfma_f32_16x16x32_bf16 a[20:23], a[172:175], v[36:39], a[20:23]
  v_mfma_f32_16x16x32_bf16 a[24:27], a[172:175], v[40:43], 0
  v_mfma_f32_16x16x32_bf16 a[24:27], a[176:179], v[72:75], a[24:27]
  v_mfma_f32_16x16x32_bf16 a[28:31], a[176:179], v[76:79], 0
  v_mfma_f32_16x16x32_bf16 a[28:31], a[172:175], v[44:47], a[28:31]
  s_branch Lk2_merge
Lk2_b0:
  s_waitcnt lgkmcnt(4)
  s_add_u32 m0, s29, 98304
  v_mfma_f32_16x16x32_bf16 v[96:99], a[116:119], a[180:183], 0
  v_exp_f32 v64, v64
  v_mfma_f32_16x16x32_bf16 v[96:99], a[120:123], a[184:187], v[96:99]
  ds_read_b128 a[148:151], v2 offset:8192
  ds_read_b128 a[152:155], v2 offset:9216
  v_mfma_f32_16x16x32_bf16 v[96:99], a[124:127], a[188:191], v[96:99]
  v_exp_f32 v65, v65
  v_mfma_f32_16x16x32_bf16 v[96:99], a[128:131], a[192:195], v[96:99]
  buffer_load_dwordx4 v1, s[12:15], s26 offen offset:0 lds
  s_add_u32 s32, s26, 4096
  v_mfma_f32_16x16x32_bf16 v[100:103], a[128:131], a[208:211], 0
  v_exp_f32 v66, v66
  v_mfma_f32_16x16x32_bf16 v[100:103], a[124:127], a[204:207], v[100:103]
  v_cvt_pk_bf16_f32 v64, v64, v65
  v_mfma_f32_16x16x32_bf16 v[100:103], a[120:123], a[200:203], v[100:103]
  v_exp_f32 v67, v67
  v_mfma_f32_16x16x32_bf16 v[100:103], a[116:119], a[196:199], v[100:103]
  buffer_load_dwordx4 v1, s[12:15], s26 offen offset:1024 lds
  v_mfma_f32_16x16x32_bf16 v[104:107], a[116:119], a[212:215], 0
  v_exp_f32 v80, v80
  v_mfma_f32_16x16x32_bf16 v[104:107], a[120:123], a[216:219], v[104:107]
  ds_read_b128 a[156:159], v2 offset:10240
  ds_read_b128 a[160:163], v2 offset:11264
  v_mfma_f32_16x16x32_bf16 v[104:107], a[124:127], a[220:223], v[104:107]
  v_exp_f32 v81, v81
  v_mfma_f32_16x16x32_bf16 v[104:107], a[128:131], a[224:227], v[104:107]
  buffer_load_dwordx4 v1, s[12:15], s26 offen offset:2048 lds
  v_mfma_f32_16x16x32_bf16 v[108:111], a[128:131], a[240:243], 0
  v_exp_f32 v82, v82
  v_mfma_f32_16x16x32_bf16 v[108:111], a[124:127], a[236:239], v[108:111]
  v_cvt_pk_bf16_f32 v65, v66, v67
  v_cvt_pk_bf16_f32 v66, v80, v81
  v_mfma_f32_16x16x32_bf16 v[108:111], a[120:123], a[232:235], v[108:111]
  v_exp_f32 v83, v83
  v_mfma_f32_16x16x32_bf16 v[108:111], a[116:119], a[228:231], v[108:111]
  buffer_load_dwordx4 v1, s[12:15], s26 offen offset:3072 lds
  s_add_u32 m0, s29, 102400
  s_waitcnt lgkmcnt(4)
  v_mfma_f32_16x16x32_bf16 v[112:115], a[132:135], a[180:183], 0
  v_exp_f32 v68, v68
  v_mfma_f32_16x16x32_bf16 v[112:115], a[136:139], a[184:187], v[112:115]
  ds_read_b128 a[164:167], v2 offset:12288
  ds_read_b128 a[168:171], v2 offset:13312
  v_mfma_f32_16x16x32_bf16 v[112:115], a[140:143], a[188:191], v[112:115]
  v_exp_f32 v69, v69
  v_mfma_f32_16x16x32_bf16 v[112:115], a[144:147], a[192:195], v[112:115]
  buffer_load_dwordx4 v1, s[12:15], s32 offen offset:0 lds
  v_mfma_f32_16x16x32_bf16 v[116:119], a[144:147], a[208:211], 0
  v_exp_f32 v70, v70
  v_mfma_f32_16x16x32_bf16 v[116:119], a[140:143], a[204:207], v[116:119]
  v_cvt_pk_bf16_f32 v67, v82, v83
  v_cvt_pk_bf16_f32 v68, v68, v69
  v_mfma_f32_16x16x32_bf16 v[116:119], a[136:139], a[200:203], v[116:119]
  v_exp_f32 v71, v71
  v_mfma_f32_16x16x32_bf16 v[116:119], a[132:135], a[196:199], v[116:119]
  buffer_load_dwordx4 v1, s[12:15], s32 offen offset:1024 lds
  v_mfma_f32_16x16x32_bf16 v[120:123], a[132:135], a[212:215], 0
  v_exp_f32 v84, v84
  v_mfma_f32_16x16x32_bf16 v[120:123], a[136:139], a[216:219], v[120:123]
  ds_read_b128 a[172:175], v2 offset:14336
  ds_read_b128 a[176:179], v2 offset:15360
  v_mfma_f32_16x16x32_bf16 v[120:123], a[140:143], a[220:223], v[120:123]
  v_exp_f32 v85, v85
  v_mfma_f32_16x16x32_bf16 v[120:123], a[144:147], a[224:227], v[120:123]
  buffer_load_dwordx4 v1, s[12:15], s32 offen offset:2048 lds
  v_mfma_f32_16x16x32_bf16 v[124:127], a[144:147], a[240:243], 0
  v_exp_f32 v86, v86
  v_mfma_f32_16x16x32_bf16 v[124:127], a[140:143], a[236:239], v[124:127]
  v_cvt_pk_bf16_f32 v69, v70, v71
  v_cvt_pk_bf16_f32 v70, v84, v85
  v_mfma_f32_16x16x32_bf16 v[124:127], a[136:139], a[232:235], v[124:127]
  v_exp_f32 v87, v87
  v_mfma_f32_16x16x32_bf16 v[124:127], a[132:135], a[228:231], v[124:127]
  buffer_load_dwordx4 v1, s[12:15], s32 offen offset:3072 lds
  s_waitcnt lgkmcnt(4)
  v_mfma_f32_16x16x32_bf16 v[128:131], a[148:151], a[180:183], 0
  v_exp_f32 v72, v72
  v_mfma_f32_16x16x32_bf16 v[128:131], a[152:155], a[184:187], v[128:131]
  s_add_u32 s26, s26, 32768
  s_cmp_eq_u32 s26, s62
  s_cselect_b32 s26, s63, s26
  s_cselect_b32 s62, -1, s62
  v_mfma_f32_16x16x32_bf16 v[128:131], a[156:159], a[188:191], v[128:131]
  v_exp_f32 v73, v73
  v_mfma_f32_16x16x32_bf16 v[128:131], a[160:163], a[192:195], v[128:131]
  v_cvt_pk_bf16_f32 v71, v86, v87
  v_cvt_pk_bf16_f32 v72, v72, v73
  v_mfma_f32_16x16x32_bf16 v[132:135], a[160:163], a[208:211], 0
  v_exp_f32 v74, v74
  v_mfma_f32_16x16x32_bf16 v[132:135], a[156:159], a[204:207], v[132:135]
  v_mfma_f32_16x16x32_bf16 v[132:135], a[152:155], a[200:203], v[132:135]
  v_exp_f32 v75, v75
  v_mfma_f32_16x16x32_bf16 v[132:135], a[148:151], a[196:199], v[132:135]
  v_cvt_pk_bf16_f32 v73, v74, v75
  v_mfma_f32_16x16x32_bf16 v[136:139], a[148:151], a[212:215], 0
  v_exp_f32 v88, v88
  v_mfma_f32_16x16x32_bf16 v[136:139], a[152:155], a[216:219], v[136:139]
  v_mfma_f32_16x16x32_bf16 v[136:139], a[156:159], a[220:223], v[136:139]
  v_exp_f32 v89, v89
  v_mfma_f32_16x16x32_bf16 v[136:139], a[160:163], a[224:227], v[136:139]
  v_cvt_pk_bf16_f32 v74, v88, v89
  v_mfma_f32_16x16x32_bf16 v[140:143], a[160:163], a[240:243], 0
  v_exp_f32 v90, v90
  v_mfma_f32_16x16x32_bf16 v[140:143], a[156:159], a[236:239], v[140:143]
  s_waitcnt vmcnt(16) lgkmcnt(0)
  s_barrier
  ds_read_b128 a[116:119], v2 offset:32768
  ds_read_b128 a[120:123], v2 offset:40960
  ds_read_b128 a[124:127], v2 offset:33792
  ds_read_b128 a[128:131], v2 offset:41984
  v_mfma_f32_16x16x32_bf16 v[140:143], a[152:155], a[232:235], v[140:143]
  v_exp_f32 v91, v91
  v_mfma_f32_16x16x32_bf16 v[140:143], a[148:151], a[228:231], v[140:143]
  v_cvt_pk_bf16_f32 v75, v90, v91
  v_mfma_f32_16x16x32_bf16 v[144:147], a[164:167], a[180:183], 0
  v_exp_f32 v76, v76
  v_mfma_f32_16x16x32_bf16 v[144:147], a[168:171], a[184:187], v[144:147]
  ds_read_b128 a[132:135], v2 offset:34816
  ds_read_b128 a[136:139], v2 offset:43008
  v_mfma_f32_16x16x32_bf16 v[144:147], a[172:175], a[188:191], v[144:147]
  v_exp_f32 v77, v77
  v_mfma_f32_16x16x32_bf16 v[144:147], a[176:179], a[192:195], v[144:147]
  v_cvt_pk_bf16_f32 v76, v76, v77
  v_mfma_f32_16x16x32_bf16 v[148:151], a[176:179], a[208:211], 0
  v_exp_f32 v78, v78
  v_mfma_f32_16x16x32_bf16 v[148:151], a[172:175], a[204:207], v[148:151]
  v_mfma_f32_16x16x32_bf16 v[148:151], a[168:171], a[200:203], v[148:151]
  v_exp_f32 v79, v79
  v_mfma_f32_16x16x32_bf16 v[148:151], a[164:167], a[196:199], v[148:151]
  v_cvt_pk_bf16_f32 v77, v78, v79
  v_mfma_f32_16x16x32_bf16 v[152:155], a[164:167], a[212:215], 0
  v_exp_f32 v92, v92
  v_mfma_f32_16x16x32_bf16 v[152:155], a[168:171], a[216:219], v[152:155]
  ds_read_b128 a[140:143], v2 offset:35840
  ds_read_b128 a[144:147], v2 offset:44032
  v_mfma_f32_16x16x32_bf16 v[152:155], a[172:175], a[220:223], v[152:155]
  v_exp_f32 v93, v93
  v_mfma_f32_16x16x32_bf16 v[152:155], a[176:179], a[224:227], v[152:155]
  v_cvt_pk_bf16_f32 v78, v92, v93
  v_mfma_f32_16x16x32_bf16 v[156:159], a[176:179], a[240:243], 0
  v_exp_f32 v94, v94
  v_mfma_f32_16x16x32_bf16 v[156:159], a[172:175], a[236:239], v[156:159]
  v_mfma_f32_16x16x32_bf16 v[156:159], a[168:171], a[232:235], v[156:159]
  v_exp_f32 v95, v95
  v_mfma_f32_16x16x32_bf16 v[156:159], a[164:167], a[228:231], v[156:159]
  v_cvt_pk_bf16_f32 v79, v94, v95
  s_waitcnt lgkmcnt(6)
  s_add_u32 m0, s29, 0
  v_mfma_f32_16x16x32_bf16 v[160:163], a[116:119], v[32:35], 0
  v_exp_f32 v96, v96
  v_mfma_f32_16x16x32_bf16 v[160:163], a[120:123], v[64:67], v[160:163]
  ds_read_b128 a[148:151], v2 offset:36864
  ds_read_b128 a[152:155], v2 offset:45056
  v_mfma_f32_16x16x32_bf16 v[164:167], a[120:123], v[68:71], 0
  v_exp_f32 v97, v97
  v_mfma_f32_16x16x32_bf16 v[164:167], a[116:119], v[36:39], v[164:167]
  buffer_load_dwordx4 v1, s[12:15], s25 offen offset:0 lds
  s_add_u32 s32, s25, 4096
  v_mfma_f32_16x16x32_bf16 v[168:171], a[116:119], v[40:43], 0
  v_exp_f32 v98, v98
  v_mfma_f32_16x16x32_bf16 v[168:171], a[120:123], v[72:75], v[168:171]
  v_cvt_pk_bf16_f32 v96, v96, v97
  v_mfma_f32_16x16x32_bf16 v[172:175], a[120:123], v[76:79], 0
  v_exp_f32 v99, v99
  v_mfma_f32_16x16x32_bf16 v[172:175], a[116:119], v[44:47], v[172:175]
  buffer_load_dwordx4 v1, s[12:15], s25 offen offset:1024 lds
  s_waitcnt lgkmcnt(6)
  v_mfma_f32_16x16x32_bf16 a[32:35], a[48:51], v[32:35], 0
  v_mfma_f32_16x16x32_bf16 a[32:35], a[48:51], v[64:67], a[32:35]
  v_mfma_f32_16x16x32_bf16 v[176:179], a[124:127], v[32:35], 0
  v_exp_f32 v112, v112
  v_mfma_f32_16x16x32_bf16 v[176:179], a[128:131], v[64:67], v[176:179]
  ds_read_b128 a[156:159], v2 offset:37888
  ds_read_b128 a[160:163], v2 offset:46080
  v_mfma_f32_16x16x32_bf16 v[180:183], a[128:131], v[68:71], 0
  v_exp_f32 v113, v113
  v_mfma_f32_16x16x32_bf16 v[180:183], a[124:127], v[36:39], v[180:183]
  buffer_load_dwordx4 v1, s[12:15], s25 offen offset:2048 lds
  v_mfma_f32_16x16x32_bf16 v[184:187], a[124:127], v[40:43], 0
  v_exp_f32 v114, v114
  v_mfma_f32_16x16x32_bf16 v[184:187], a[128:131], v[72:75], v[184:187]
  v_cvt_pk_bf16_f32 v97, v98, v99
  v_cvt_pk_bf16_f32 v98, v112, v113
  v_mfma_f32_16x16x32_bf16 v[188:191], a[128:131], v[76:79], 0
  v_exp_f32 v115, v115
  v_mfma_f32_16x16x32_bf16 v[188:191], a[124:127], v[44:47], v[188:191]
  buffer_load_dwordx4 v1, s[12:15], s25 offen offset:3072 lds
  s_add_u32 m0, s29, 4096
  s_waitcnt lgkmcnt(6)
  v_mfma_f32_16x16x32_bf16 a[36:39], a[48:51], v[36:39], 0
  v_mfma_f32_16x16x32_bf16 a[36:39], a[48:51], v[68:71], a[36:39]
  v_mfma_f32_16x16x32_bf16 v[192:195], a[132:135], v[32:35], 0
  v_exp_f32 v100, v100
  v_mfma_f32_16x16x32_bf16 v[192:195], a[136:139], v[64:67], v[192:195]
  ds_read_b128 a[164:167], v2 offset:38912
  ds_read_b128 a[168:171], v2 offset:47104
  v_mfma_f32_16x16x32_bf16 v[196:199], a[136:139], v[68:71], 0
  v_exp_f32 v101, v101
  v_mfma_f32_16x16x32_bf16 v[196:199], a[132:135], v[36:39], v[196:199]
  buffer_load_dwordx4 v1, s[12:15], s32 offen offset:0 lds
  v_mfma_f32_16x16x32_bf16 v[200:203], a[132:135], v[40:43], 0
  v_exp_f32 v102, v102
  v_mfma_f32_16x16x32_bf16 v[200:203], a[136:139], v[72:75], v[200:203]
  v_cvt_pk_bf16_f32 v99, v114, v115
  v_cvt_pk_bf16_f32 v100, v100, v101
  v_mfma_f32_16x16x32_bf16 v[204:207], a[136:139], v[76:79], 0
  v_exp_f32 v103, v103
  v_mfma_f32_16x16x32_bf16 v[204:207], a[132:135], v[44:47], v[204:207]
  buffer_load_dwordx4 v1, s[12:15], s32 offen offset:1024 lds
  s_waitcnt lgkmcnt(6)
  v_mfma_f32_16x16x32_bf16 a[40:43], a[48:51], v[40:43], 0
  v_mfma_f32_16x16x32_bf16 a[40:43], a[48:51], v[72:75], a[40:43]
  v_mfma_f32_16x16x32_bf16 v[208:211], a[140:143], v[32:35], 0
  v_exp_f32 v116, v116
  v_mfma_f32_16x16x32_bf16 v[208:211], a[144:147], v[64:67], v[208:211]
  ds_read_b128 a[172:175], v2 offset:39936
  ds_read_b128 a[176:179], v2 offset:48128
  v_mfma_f32_16x16x32_bf16 v[212:215], a[144:147], v[68:71], 0
  v_exp_f32 v117, v117
  v_mfma_f32_16x16x32_bf16 v[212:215], a[140:143], v[36:39], v[212:215]
  buffer_load_dwordx4 v1, s[12:15], s32 offen offset:2048 lds
  v_mfma_f32_16x16x32_bf16 v[216:219], a[140:143], v[40:43], 0
  v_exp_f32 v118, v118
  v_mfma_f32_16x16x32_bf16 v[216:219], a[144:147], v[72:75], v[216:219]
  v_cvt_pk_bf16_f32 v101, v102, v103
  v_cvt_pk_bf16_f32 v102, v116, v117
  v_mfma_f32_16x16x32_bf16 v[220:223], a[144:147], v[76:79], 0
  v_exp_f32 v119, v119
  v_mfma_f32_16x16x32_bf16 v[220:223], a[140:143], v[44:47], v[220:223]
  buffer_load_dwordx4 v1, s[12:15], s32 offen offset:3072 lds
  s_waitcnt lgkmcnt(6)
  v_mfma_f32_16x16x32_bf16 a[44:47], a[48:51], v[44:47], 0
  v_mfma_f32_16x16x32_bf16 a[44:47], a[48:51], v[76:79], a[44:47]
  v_mfma_f32_16x16x32_bf16 v[224:227], a[148:151], v[32:35], 0
  v_exp_f32 v104, v104
  v_mfma_f32_16x16x32_bf16 v[224:227], a[152:155], v[64:67], v[224:227]
  s_add_u32 s25, s25, 32768
  s_cmp_eq_u32 s25, s27
  s_cselect_b32 s25, s28, s25
  s_cselect_b32 s27, -1, s27
  v_mfma_f32_16x16x32_bf16 v[228:231], a[152:155], v[68:71], 0
  v_exp_f32 v105, v105
  v_mfma_f32_16x16x32_bf16 v[228:231], a[148:151], v[36:39], v[228:231]
  v_cvt_pk_bf16_f32 v103, v118, v119
  v_cvt_pk_bf16_f32 v104, v104, v105
  v_mfma_f32_16x16x32_bf16 v[232:235], a[148:151], v[40:43], 0
  v_exp_f32 v106, v106
  v_mfma_f32_16x16x32_bf16 v[232:235], a[152:155], v[72:75], v[232:235]
  v_mfma_f32_16x16x32_bf16 v[236:239], a[152:155], v[76:79], 0
  v_exp_f32 v107, v107
  v_mfma_f32_16x16x32_bf16 v[236:239], a[148:151], v[44:47], v[236:239]
  v_cvt_pk_bf16_f32 v105, v106, v107
  s_waitcnt lgkmcnt(4)
  v_mfma_f32_16x16x32_bf16 v[240:243], a[156:159], v[32:35], 0
  v_exp_f32 v120, v120
  v_mfma_f32_16x16x32_bf16 v[240:243], a[160:163], v[64:67], v[240:243]
  v_mfma_f32_16x16x32_bf16 v[244:247], a[160:163], v[68:71], 0
  v_exp_f32 v121, v121
  v_mfma_f32_16x16x32_bf16 v[244:247], a[156:159], v[36:39], v[244:247]
  v_cvt_pk_bf16_f32 v106, v120, v121
  v_mfma_f32_16x16x32_bf16 v[248:251], a[156:159], v[40:43], 0
  v_exp_f32 v122, v122
  v_mfma_f32_16x16x32_bf16 v[248:251], a[160:163], v[72:75], v[248:251]
  s_waitcnt vmcnt(16) lgkmcnt(0)
  s_barrier
  ds_read_b128 a[116:119], v3 offset:0
  ds_read_b128 a[120:123], v3 offset:1024
  ds_read_b128 a[124:127], v3 offset:2048
  ds_read_b128 a[128:131], v3 offset:3072
  v_mfma_f32_16x16x32_bf16 v[252:255], a[160:163], v[76:79], 0
  v_exp_f32 v123, v123
  v_mfma_f32_16x16x32_bf16 v[252:255], a[156:159], v[44:47], v[252:255]
  v_cvt_pk_bf16_f32 v107, v122, v123
  v_mfma_f32_16x16x32_bf16 a[0:3], a[164:167], v[32:35], 0
  v_exp_f32 v108, v108
  v_mfma_f32_16x16x32_bf16 a[0:3], a[168:171], v[64:67], a[0:3]
  ds_read_b128 a[132:135], v3 offset:4096
  ds_read_b128 a[136:139], v3 offset:5120
  v_mfma_f32_16x16x32_bf16 a[4:7], a[168:171], v[68:71], 0
  v_exp_f32 v109, v109
  v_mfma_f32_16x16x32_bf16 a[4:7], a[164:167], v[36:39], a[4:7]
  v_cvt_pk_bf16_f32 v108, v108, v109
  v_mfma_f32_16x16x32_bf16 a[8:11], a[164:167], v[40:43], 0
  v_exp_f32 v110, v110
  v_mfma_f32_16x16x32_bf16 a[8:11], a[168:171], v[72:75], a[8:11]
  v_mfma_f32_16x16x32_bf16 a[12:15], a[168:171], v[76:79], 0
  v_exp_f32 v111, v111
  v_mfma_f32_16x16x32_bf16 a[12:15], a[164:167], v[44:47], a[12:15]
  v_cvt_pk_bf16_f32 v109, v110, v111
  v_mfma_f32_16x16x32_bf16 a[16:19], a[172:175], v[32:35], 0
  v_exp_f32 v124, v124
  v_mfma_f32_16x16x32_bf16 a[16:19], a[176:179], v[64:67], a[16:19]
  ds_read_b128 a[140:143], v3 offset:6144
  ds_read_b128 a[144:147], v3 offset:7168
  v_mfma_f32_16x16x32_bf16 a[20:23], a[176:179], v[68:71], 0
  v_exp_f32 v125, v125
  v_mfma_f32_16x16x32_bf16 a[20:23], a[172:175], v[36:39], a[20:23]
  v_cvt_pk_bf16_f32 v110, v124, v125
  v_mfma_f32_16x16x32_bf16 a[24:27], a[172:175], v[40:43], 0
  v_exp_f32 v126, v126
  v_mfma_f32_16x16x32_bf16 a[24:27], a[176:179], v[72:75], a[24:27]
  v_mfma_f32_16x16x32_bf16 a[28:31], a[176:179], v[76:79], 0
  v_exp_f32 v127, v127
  v_mfma_f32_16x16x32_bf16 a[28:31], a[172:175], v[44:47], a[28:31]
  v_cvt_pk_bf16_f32 v111, v126, v127
  s_branch Lk2_l2b
Lk2_l2:
  s_waitcnt lgkmcnt(4)
  s_add_u32 m0, s29, 98304
  v_mfma_f32_16x16x32_bf16 v[96:99], a[116:119], a[180:183], 0
  v_exp_f32 v64, v64
  v_mfma_f32_16x16x32_bf16 v[96:99], a[120:123], a[184:187], v[96:99]
  ds_read_b128 a[148:151], v2 offset:8192
  ds_read_b128 a[152:155], v2 offset:9216
  v_mfma_f32_16x16x32_bf16 v[96:99], a[124:127], a[188:191], v[96:99]
  v_exp_f32 v65, v65
  v_mfma_f32_16x16x32_bf16 v[96:99], a[128:131], a[192:195], v[96:99]
  buffer_load_dwordx4 v1, s[12:15], s26 offen offset:0 lds
  s_add_u32 s32, s26, 4096
  v_mfma_f32_16x16x32_bf16 v[100:103], a[128:131], a[208:211], 0
  v_exp_f32 v66, v66
  v_mfma_f32_16x16x32_bf16 v[100:103], a[124:127], a[204:207], v[100:103]
  v_cvt_pk_bf16_f32 v64, v64, v65
  v_mfma_f32_16x16x32_bf16 v[100:103], a[120:123], a[200:203], v[100:103]
  v_exp_f32 v67, v67
  v_mfma_f32_16x16x32_bf16 v[100:103], a[116:119], a[196:199], v[100:103]
  buffer_load_dwordx4 v1, s[12:15], s26 offen offset:1024 lds
  v_mfma_f32_16x16x32_bf16 v[104:107], a[116:119], a[212:215], 0
  v_exp_f32 v80, v80
  v_mfma_f32_16x16x32_bf16 v[104:107], a[120:123], a[216:219], v[104:107]
  ds_read_b128 a[156:159], v2 offset:10240
  ds_read_b128 a[160:163], v2 offset:11264
  v_mfma_f32_16x16x32_bf16 v[104:107], a[124:127], a[220:223], v[104:107]
  v_exp_f32 v81, v81
  v_mfma_f32_16x16x32_bf16 v[104:107], a[128:131], a[224:227], v[104:107]
  buffer_load_dwordx4 v1, s[12:15], s26 offen offset:2048 lds
  v_mfma_f32_16x16x32_bf16 v[108:111], a[128:131], a[240:243], 0
  v_exp_f32 v82, v82
  v_mfma_f32_16x16x32_bf16 v[108:111], a[124:127], a[236:239], v[108:111]
  v_cvt_pk_bf16_f32 v65, v66, v67
  v_cvt_pk_bf16_f32 v66, v80, v81
  v_mfma_f32_16x16x32_bf16 v[108:111], a[120:123], a[232:235], v[108:111]
  v_exp_f32 v83, v83
  v_mfma_f32_16x16x32_bf16 v[108:111], a[116:119], a[228:231], v[108:111]
  buffer_load_dwordx4 v1, s[12:15], s26 offen offset:3072 lds
  s_add_u32 m0, s29, 102400
  s_waitcnt lgkmcnt(4)
  v_mfma_f32_16x16x32_bf16 v[112:115], a[132:135], a[180:183], 0
  v_exp_f32 v68, v68
  v_mfma_f32_16x16x32_bf16 v[112:115], a[136:139], a[184:187], v[112:115]
  ds_read_b128 a[164:167], v2 offset:12288
  ds_read_b128 a[168:171], v2 offset:13312
  v_mfma_f32_16x16x32_bf16 v[112:115], a[140:143], a[188:191], v[112:115]
  v_exp_f32 v69, v69
  v_mfma_f32_16x16x32_bf16 v[112:115], a[144:147], a[192:195], v[112:115]
  buffer_load_dwordx4 v1, s[12:15], s32 offen offset:0 lds
  v_mfma_f32_16x16x32_bf16 v[116:119], a[144:147], a[208:211], 0
  v_exp_f32 v70, v70
  v_mfma_f32_16x16x32_bf16 v[116:119], a[140:143], a[204:207], v[116:119]
  v_cvt_pk_bf16_f32 v67, v82, v83
  v_cvt_pk_bf16_f32 v68, v68, v69
  v_mfma_f32_16x16x32_bf16 v[116:119], a[136:139], a[200:203], v[116:119]
  v_exp_f32 v71, v71
  v_mfma_f32_16x16x32_bf16 v[116:119], a[132:135], a[196:199], v[116:119]
  buffer_load_dwordx4 v1, s[12:15], s32 offen offset:1024 lds
  v_mfma_f32_16x16x32_bf16 v[120:123], a[132:135], a[212:215], 0
  v_exp_f32 v84, v84
  v_mfma_f32_16x16x32_bf16 v[120:123], a[136:139], a[216:219], v[120:123]
  ds_read_b128 a[172:175], v2 offset:14336
  ds_read_b128 a[176:179], v2 offset:15360
  v_mfma_f32_16x16x32_bf16 v[120:123], a[140:143], a[220:223], v[120:123]
  v_exp_f32 v85, v85
  v_mfma_f32_16x16x32_bf16 v[120:123], a[144:147], a[224:227], v[120:123]
  buffer_load_dwordx4 v1, s[12:15], s32 offen offset:2048 lds
  v_mfma_f32_16x16x32_bf16 v[124:127], a[144:147], a[240:243], 0
  v_exp_f32 v86, v86
  v_mfma_f32_16x16x32_bf16 v[124:127], a[140:143], a[236:239], v[124:127]
  v_cvt_pk_bf16_f32 v69, v70, v71
  v_cvt_pk_bf16_f32 v70, v84, v85
  v_mfma_f32_16x16x32_bf16 v[124:127], a[136:139], a[232:235], v[124:127]
  v_exp_f32 v87, v87
  v_mfma_f32_16x16x32_bf16 v[124:127], a[132:135], a[228:231], v[124:127]
  buffer_load_dwordx4 v1, s[12:15], s32 offen offset:3072 lds
  s_waitcnt lgkmcnt(4)
  v_mfma_f32_16x16x32_bf16 v[128:131], a[148:151], a[180:183], 0
  v_exp_f32 v72, v72
  v_mfma_f32_16x16x32_bf16 v[128:131], a[152:155], a[184:187], v[128:131]
  s_add_u32 s26, s26, 32768
  s_cmp_eq_u32 s26, s62
  s_cselect_b32 s26, s63, s26
  s_cselect_b32 s62, -1, s62
  v_mfma_f32_16x16x32_bf16 v[128:131], a[156:159], a[188:191], v[128:131]
  v_exp_f32 v73, v73
  v_mfma_f32_16x16x32_bf16 v[128:131], a[160:163], a[192:195], v[128:131]
  v_cvt_pk_bf16_f32 v71, v86, v87
  v_cvt_pk_bf16_f32 v72, v72, v73
  v_mfma_f32_16x16x32_bf16 v[132:135], a[160:163], a[208:211], 0
  v_exp_f32 v74, v74
  v_mfma_f32_16x16x32_bf16 v[132:135], a[156:159], a[204:207], v[132:135]
  v_mfma_f32_16x16x32_bf16 v[132:135], a[152:155], a[200:203], v[132:135]
  v_exp_f32 v75, v75
  v_mfma_f32_16x16x32_bf16 v[132:135], a[148:151], a[196:199], v[132:135]
  v_cvt_pk_bf16_f32 v73, v74, v75
  v_mfma_f32_16x16x32_bf16 v[136:139], a[148:151], a[212:215], 0
  v_exp_f32 v88, v88
  v_mfma_f32_16x16x32_bf16 v[136:139], a[152:155], a[216:219], v[136:139]
  v_mfma_f32_16x16x32_bf16 v[136:139], a[156:159], a[220:223], v[136:139]
  v_exp_f32 v89, v89
  v_mfma_f32_16x16x32_bf16 v[136:139], a[160:163], a[224:227], v[136:139]
  v_cvt_pk_bf16_f32 v74, v88, v89
  v_mfma_f32_16x16x32_bf16 v[140:143], a[160:163], a[240:243], 0
  v_exp_f32 v90, v90
  v_mfma_f32_16x16x32_bf16 v[140:143], a[156:159], a[236:239], v[140:143]
  s_waitcnt vmcnt(16) lgkmcnt(0)
  s_barrier
  ds_read_b128 a[116:119], v2 offset:32768
  ds_read_b128 a[120:123], v2 offset:40960
  ds_read_b128 a[124:127], v2 offset:33792
  ds_read_b128 a[128:131], v2 offset:41984
  v_mfma_f32_16x16x32_bf16 v[140:143], a[152:155], a[232:235], v[140:143]
  v_exp_f32 v91, v91
  v_mfma_f32_16x16x32_bf16 v[140:143], a[148:151], a[228:231], v[140:143]
  v_cvt_pk_bf16_f32 v75, v90, v91
  v_mfma_f32_16x16x32_bf16 v[144:147], a[164:167], a[180:183], 0
  v_exp_f32 v76, v76
  v_mfma_f32_16x16x32_bf16 v[144:147], a[168:171], a[184:187], v[144:147]
  ds_read_b128 a[132:135], v2 offset:34816
  ds_read_b128 a[136:139], v2 offset:43008
  v_mfma_f32_16x16x32_bf16 v[144:147], a[172:175], a[188:191], v[144:147]
  v_exp_f32 v77, v77
  v_mfma_f32_16x16x32_bf16 v[144:147], a[176:179], a[192:195], v[144:147]
  v_cvt_pk_bf16_f32 v76, v76, v77
  v_mfma_f32_16x16x32_bf16 v[148:151], a[176:179], a[208:211], 0
  v_exp_f32 v78, v78
  v_mfma_f32_16x16x32_bf16 v[148:151], a[172:175], a[204:207], v[148:151]
  v_mfma_f32_16x16x32_bf16 v[148:151], a[168:171], a[200:203], v[148:151]
  v_exp_f32 v79, v79
  v_mfma_f32_16x16x32_bf16 v[148:151], a[164:167], a[196:199], v[148:151]
  v_cvt_pk_bf16_f32 v77, v78, v79
  v_mfma_f32_16x16x32_bf16 v[152:155], a[164:167], a[212:215], 0
  v_exp_f32 v92, v92
  v_mfma_f32_16x16x32_bf16 v[152:155], a[168:171], a[216:219], v[152:155]
  ds_read_b128 a[140:143], v2 offset:35840
  ds_read_b128 a[144:147], v2 offset:44032
  v_mfma_f32_16x16x32_bf16 v[152:155], a[172:175], a[220:223], v[152:155]
  v_exp_f32 v93, v93
  v_mfma_f32_16x16x32_bf16 v[152:155], a[176:179], a[224:227], v[152:155]
  v_cvt_pk_bf16_f32 v78, v92, v93
  v_mfma_f32_16x16x32_bf16 v[156:159], a[176:179], a[240:243], 0
  v_exp_f32 v94, v94
  v_mfma_f32_16x16x32_bf16 v[156:159], a[172:175], a[236:239], v[156:159]
  v_mfma_f32_16x16x32_bf16 v[156:159], a[168:171], a[232:235], v[156:159]
  v_exp_f32 v95, v95
  v_mfma_f32_16x16x32_bf16 v[156:159], a[164:167], a[228:231], v[156:159]
  v_cvt_pk_bf16_f32 v79, v94, v95
  s_waitcnt lgkmcnt(6)
  s_add_u32 m0, s29, 0
  v_mfma_f32_16x16x32_bf16 v[160:163], a[116:119], v[32:35], v[160:163]
  v_exp_f32 v96, v96
  v_mfma_f32_16x16x32_bf16 v[160:163], a[120:123], v[64:67], v[160:163]
  ds_read_b128 a[148:151], v2 offset:36864
  ds_read_b128 a[152:155], v2 offset:45056
  v_mfma_f32_16x16x32_bf16 v[164:167], a[120:123], v[68:71], v[164:167]
  v_exp_f32 v97, v97
  v_mfma_f32_16x16x32_bf16 v[164:167], a[116:119], v[36:39], v[164:167]
  buffer_load_dwordx4 v1, s[12:15], s25 offen offset:0 lds
  s_add_u32 s32, s25, 4096
  v_mfma_f32_16x16x32_bf16 v[168:171], a[116:119], v[40:43], v[168:171]
  v_exp_f32 v98, v98
  v_mfma_f32_16x16x32_bf16 v[168:171], a[120:123], v[72:75], v[168:171]
  v_cvt_pk_bf16_f32 v96, v96, v97
  v_mfma_f32_16x16x32_bf16 v[172:175], a[120:123], v[76:79], v[172:175]
  v_exp_f32 v99, v99
  v_mfma_f32_16x16x32_bf16 v[172:175], a[116:119], v[44:47], v[172:175]
  buffer_load_dwordx4 v1, s[12:15], s25 offen offset:1024 lds
  s_waitcnt lgkmcnt(6)
  v_mfma_f32_16x16x32_bf16 a[32:35], a[48:51], v[32:35], a[32:35]
  v_mfma_f32_16x16x32_bf16 a[32:35], a[48:51], v[64:67], a[32:35]
  v_mfma_f32_16x16x32_bf16 v[176:179], a[124:127], v[32:35], v[176:179]
  v_exp_f32 v112, v112
  v_mfma_f32_16x16x32_bf16 v[176:179], a[128:131], v[64:67], v[176:179]
  ds_read_b128 a[156:159], v2 offset:37888
  ds_read_b128 a[160:163], v2 offset:46080
  v_mfma_f32_16x16x32_bf16 v[180:183], a[128:131], v[68:71], v[180:183]
  v_exp_f32 v113, v113
  v_mfma_f32_16x16x32_bf16 v[180:183], a[124:127], v[36:39], v[180:183]
  buffer_load_dwordx4 v1, s[12:15], s25 offen offset:2048 lds
  v_mfma_f32_16x16x32_bf16 v[184:187], a[124:127], v[40:43], v[184:187]
  v_exp_f32 v114, v114
  v_mfma_f32_16x16x32_bf16 v[184:187], a[128:131], v[72:75], v[184:187]
  v_cvt_pk_bf16_f32 v97, v98, v99
  v_cvt_pk_bf16_f32 v98, v112, v113
  v_mfma_f32_16x16x32_bf16 v[188:191], a[128:131], v[76:79], v[188:191]
  v_exp_f32 v115, v115
  v_mfma_f32_16x16x32_bf16 v[188:191], a[124:127], v[44:47], v[188:191]
  buffer_load_dwordx4 v1, s[12:15], s25 offen offset:3072 lds
  s_add_u32 m0, s29, 4096
  s_waitcnt lgkmcnt(6)
  v_mfma_f32_16x16x32_bf16 a[36:39], a[48:51], v[36:39], a[36:39]
  v_mfma_f32_16x16x32_bf16 a[36:39], a[48:51], v[68:71], a[36:39]
  v_mfma_f32_16x16x32_bf16 v[192:195], a[132:135], v[32:35], v[192:195]
  v_exp_f32 v100, v100
  v_mfma_f32_16x16x32_bf16 v[192:195], a[136:139], v[64:67], v[192:195]
  ds_read_b128 a[164:167], v2 offset:38912
  ds_read_b128 a[168:171], v2 offset:47104
  v_mfma_f32_16x16x32_bf16 v[196:199], a[136:139], v[68:71], v[196:199]
  v_exp_f32 v101, v101
  v_mfma_f32_16x16x32_bf16 v[196:199], a[132:135], v[36:39], v[196:199]
  buffer_load_dwordx4 v1, s[12:15], s32 offen offset:0 lds
  v_mfma_f32_16x16x32_bf16 v[200:203], a[132:135], v[40:43], v[200:203]
  v_exp_f32 v102, v102
  v_mfma_f32_16x16x32_bf16 v[200:203], a[136:139], v[72:75], v[200:203]
  v_cvt_pk_bf16_f32 v99, v114, v115
  v_cvt_pk_bf16_f32 v100, v100, v101
  v_mfma_f32_16x16x32_bf16 v[204:207], a[136:139], v[76:79], v[204:207]
  v_exp_f32 v103, v103
  v_mfma_f32_16x16x32_bf16 v[204:207], a[132:135], v[44:47], v[204:207]
  buffer_load_dwordx4 v1, s[12:15], s32 offen offset:1024 lds
  s_waitcnt lgkmcnt(6)
  v_mfma_f32_16x16x32_bf16 a[40:43], a[48:51], v[40:43], a[40:43]
  v_mfma_f32_16x16x32_bf16 a[40:43], a[48:51], v[72:75], a[40:43]
  v_mfma_f32_16x16x32_bf16 v[208:211], a[140:143], v[32:35], v[208:211]
  v_exp_f32 v116, v116
  v_mfma_f32_16x16x32_bf16 v[208:211], a[144:147], v[64:67], v[208:211]
  ds_read_b128 a[172:175], v2 offset:39936
  ds_read_b128 a[176:179], v2 offset:48128
  v_mfma_f32_16x16x32_bf16 v[212:215], a[144:147], v[68:71], v[212:215]
  v_exp_f32 v117, v117
  v_mfma_f32_16x16x32_bf16 v[212:215], a[140:143], v[36:39], v[212:215]
  buffer_load_dwordx4 v1, s[12:15], s32 offen offset:2048 lds
  v_mfma_f32_16x16x32_bf16 v[216:219], a[140:143], v[40:43], v[216:219]
  v_exp_f32 v118, v118
  v_mfma_f32_16x16x32_bf16 v[216:219], a[144:147], v[72:75], v[216:219]
  v_cvt_pk_bf16_f32 v101, v102, v103
  v_cvt_pk_bf16_f32 v102, v116, v117
  v_mfma_f32_16x16x32_bf16 v[220:223], a[144:147], v[76:79], v[220:223]
  v_exp_f32 v119, v119
  v_mfma_f32_16x16x32_bf16 v[220:223], a[140:143], v[44:47], v[220:223]
  buffer_load_dwordx4 v1, s[12:15], s32 offen offset:3072 lds
  s_waitcnt lgkmcnt(6)
  v_mfma_f32_16x16x32_bf16 a[44:47], a[48:51], v[44:47], a[44:47]
  v_mfma_f32_16x16x32_bf16 a[44:47], a[48:51], v[76:79], a[44:47]
  v_mfma_f32_16x16x32_bf16 v[224:227], a[148:151], v[32:35], v[224:227]
  v_exp_f32 v104, v104
  v_mfma_f32_16x16x32_bf16 v[224:227], a[152:155], v[64:67], v[224:227]
  s_add_u32 s25, s25, 32768
  s_cmp_eq_u32 s25, s27
  s_cselect_b32 s25, s28, s25
  s_cselect_b32 s27, -1, s27
  v_mfma_f32_16x16x32_bf16 v[228:231], a[152:155], v[68:71], v[228:231]
  v_exp_f32 v105, v105
  v_mfma_f32_16x16x32_bf16 v[228:231], a[148:151], v[36:39], v[228:231]
  v_cvt_pk_bf16_f32 v103, v118, v119
  v_cvt_pk_bf16_f32 v104, v104, v105
  v_mfma_f32_16x16x32_bf16 v[232:235], a[148:151], v[40:43], v[232:235]
  v_exp_f32 v106, v106
  v_mfma_f32_16x16x32_bf16 v[232:235], a[152:155], v[72:75], v[232:235]
  v_mfma_f32_16x16x32_bf16 v[236:239], a[152:155], v[76:79], v[236:239]
  v_exp_f32 v107, v107
  v_mfma_f32_16x16x32_bf16 v[236:239], a[148:151], v[44:47], v[236:239]
  v_cvt_pk_bf16_f32 v105, v106, v107
  s_waitcnt lgkmcnt(4)
  v_mfma_f32_16x16x32_bf16 v[240:243], a[156:159], v[32:35], v[240:243]
  v_exp_f32 v120, v120
  v_mfma_f32_16x16x32_bf16 v[240:243], a[160:163], v[64:67], v[240:243]
  v_mfma_f32_16x16x32_bf16 v[244:247], a[160:163], v[68:71], v[244:247]
  v_exp_f32 v121, v121
  v_mfma_f32_16x16x32_bf16 v[244:247], a[156:159], v[36:39], v[244:247]
  v_cvt_pk_bf16_f32 v106, v120, v121
  v_mfma_f32_16x16x32_bf16 v[248:251], a[156:159], v[40:43], v[248:251]
  v_exp_f32 v122, v122
  v_mfma_f32_16x16x32_bf16 v[248:251], a[160:163], v[72:75], v[248:251]
  s_waitcnt vmcnt(16) lgkmcnt(0)
  s_barrier
  ds_read_b128 a[116:119], v3 offset:0
  ds_read_b128 a[120:123], v3 offset:1024
  ds_read_b128 a[124:127], v3 offset:2048
  ds_read_b128 a[128:131], v3 offset:3072
  v_mfma_f32_16x16x32_bf16 v[252:255], a[160:163], v[76:79], v[252:255]
  v_exp_f32 v123, v123
  v_mfma_f32_16x16x32_bf16 v[252:255], a[156:159], v[44:47], v[252:255]
  v_cvt_pk_bf16_f32 v107, v122, v123
  v_mfma_f32_16x16x32_bf16 a[0:3], a[164:167], v[32:35], a[0:3]
  v_exp_f32 v108, v108
  v_mfma_f32_16x16x32_bf16 a[0:3], a[168:171], v[64:67], a[0:3]
  ds_read_b128 a[132:135], v3 offset:4096
  ds_read_b128 a[136:139], v3 offset:5120
  v_mfma_f32_16x16x32_bf16 a[4:7], a[168:171], v[68:71], a[4:7]
  v_exp_f32 v109, v109
  v_mfma_f32_16x16x32_bf16 a[4:7], a[164:167], v[36:39], a[4:7]
  v_cvt_pk_bf16_f32 v108, v108, v109
  v_mfma_f32_16x16x32_bf16 a[8:11], a[164:167], v[40:43], a[8:11]
  v_exp_f32 v110, v110
  v_mfma_f32_16x16x32_bf16 a[8:11], a[168:171], v[72:75], a[8:11]
  v_mfma_f32_16x16x32_bf16 a[12:15], a[168:171], v[76:79], a[12:15]
  v_exp_f32 v111, v111
  v_mfma_f32_16x16x32_bf16 a[12:15], a[164:167], v[44:47], a[12:15]
  v_cvt_pk_bf16_f32 v109, v110, v111
  v_mfma_f32_16x16x32_bf16 a[16:19], a[172:175], v[32:35], a[16:19]
  v_exp_f32 v124, v124
  v_mfma_f32_16x16x32_bf16 a[16:19], a[176:179], v[64:67], a[16:19]
  ds_read_b128 a[140:143], v3 offset:6144
  ds_read_b128 a[144:147], v3 offset:7168
  v_mfma_f32_16x16x32_bf16 a[20:23], a[176:179], v[68:71], a[20:23]
  v_exp_f32 v125, v125
  v_mfma_f32_16x16x32_bf16 a[20:23], a[172:175], v[36:39], a[20:23]
  v_cvt_pk_bf16_f32 v110, v124, v125
  v_mfma_f32_16x16x32_bf16 a[24:27], a[172:175], v[40:43], a[24:27]
  v_exp_f32 v126, v126
  v_mfma_f32_16x16x32_bf16 a[24:27], a[176:179], v[72:75], a[24:27]
  v_mfma_f32_16x16x32_bf16 a[28:31], a[176:179], v[76:79], a[28:31]
  v_exp_f32 v127, v127
  v_mfma_f32_16x16x32_bf16 a[28:31], a[172:175], v[44:47], a[28:31]
  v_cvt_pk_bf16_f32 v111, v126, v127
Lk2_l2b:
  s_waitcnt lgkmcnt(4)
  s_add_u32 m0, s29, 32768
  v_mfma_f32_16x16x32_bf16 v[32:35], a[116:119], a[180:183], 0
  v_exp_f32 v128, v128
  v_mfma_f32_16x16x32_bf16 v[32:35], a[120:123], a[184:187], v[32:35]
  ds_read_b128 a[148:151], v3 offset:8192
  ds_read_b128 a[152:155], v3 offset:9216
  v_mfma_f32_16x16x32_bf16 v[32:35], a[124:127], a[188:191], v[32:35]
  v_exp_f32 v129, v129
  v_mfma_f32_16x16x32_bf16 v[32:35], a[128:131], a[192:195], v[32:35]
  buffer_load_dwordx4 v1, s[12:15], s26 offen offset:0 lds
  s_add_u32 s32, s26, 4096
  v_mfma_f32_16x16x32_bf16 v[36:39], a[128:131], a[208:211], 0
  v_exp_f32 v130, v130
  v_mfma_f32_16x16x32_bf16 v[36:39], a[124:127], a[204:207], v[36:39]
  v_cvt_pk_bf16_f32 v128, v128, v129
  v_mfma_f32_16x16x32_bf16 v[36:39], a[120:123], a[200:203], v[36:39]
  v_exp_f32 v131, v131
  v_mfma_f32_16x16x32_bf16 v[36:39], a[116:119], a[196:199], v[36:39]
  buffer_load_dwordx4 v1, s[12:15], s26 offen offset:1024 lds
  v_mfma_f32_16x16x32_bf16 v[40:43], a[116:119], a[212:215], 0
  v_exp_f32 v144, v144
  v_mfma_f32_16x16x32_bf16 v[40:43], a[120:123], a[216:219], v[40:43]
  ds_read_b128 a[156:159], v3 offset:10240
  ds_read_b128 a[160:163], v3 offset:11264
  v_mfma_f32_16x16x32_bf16 v[40:43], a[124:127], a[220:223], v[40:43]
  v_exp_f32 v145, v145
  v_mfma_f32_16x16x32_bf16 v[40:43], a[128:131], a[224:227], v[40:43]
  buffer_load_dwordx4 v1, s[12:15], s26 offen offset:2048 lds
  v_mfma_f32_16x16x32_bf16 v[44:47], a[128:131], a[240:243], 0
  v_exp_f32 v146, v146
  v_mfma_f32_16x16x32_bf16 v[44:47], a[124:127], a[236:239], v[44:47]
  v_cvt_pk_bf16_f32 v129, v130, v131
  v_cvt_pk_bf16_f32 v130, v144, v145
  v_mfma_f32_16x16x32_bf16 v[44:47], a[120:123], a[232:235], v[44:47]
  v_exp_f32 v147, v147
  v_mfma_f32_16x16x32_bf16 v[44:47], a[116:119], a[228:231], v[44:47]
  buffer_load_dwordx4 v1, s[12:15], s26 offen offset:3072 lds
  s_add_u32 m0, s29, 36864
  s_waitcnt lgkmcnt(4)
  v_mfma_f32_16x16x32_bf16 v[48:51], a[132:135], a[180:183], 0
  v_exp_f32 v132, v132
  v_mfma_f32_16x16x32_bf16 v[48:51], a[136:139], a[184:187], v[48:51]
  ds_read_b128 a[164:167], v3 offset:12288
  ds_read_b128 a[168:171], v3 offset:13312
  v_mfma_f32_16x16x32_bf16 v[48:51], a[140:143], a[188:191], v[48:51]
  v_exp_f32 v133, v133
  v_mfma_f32_16x16x32_bf16 v[48:51], a[144:147], a[192:195], v[48:51]
  buffer_load_dwordx4 v1, s[12:15], s32 offen offset:0 lds
  v_mfma_f32_16x16x32_bf16 v[52:55], a[144:147], a[208:211], 0
  v_exp_f32 v134, v134
  v_mfma_f32_16x16x32_bf16 v[52:55], a[140:143], a[204:207], v[52:55]
  v_cvt_pk_bf16_f32 v131, v146, v147
  v_cvt_pk_bf16_f32 v132, v132, v133
  v_mfma_f32_16x16x32_bf16 v[52:55], a[136:139], a[200:203], v[52:55]
  v_exp_f32 v135, v135
  v_mfma_f32_16x16x32_bf16 v[52:55], a[132:135], a[196:199], v[52:55]
  buffer_load_dwordx4 v1, s[12:15], s32 offen offset:1024 lds
  v_mfma_f32_16x16x32_bf16 v[56:59], a[132:135], a[212:215], 0
  v_exp_f32 v148, v148
  v_mfma_f32_16x16x32_bf16 v[56:59], a[136:139], a[216:219], v[56:59]
  ds_read_b128 a[172:175], v3 offset:14336
  ds_read_b128 a[176:179], v3 offset:15360
  v_mfma_f32_16x16x32_bf16 v[56:59], a[140:143], a[220:223], v[56:59]
  v_exp_f32 v149, v149
  v_mfma_f32_16x16x32_bf16 v[56:59], a[144:147], a[224:227], v[56:59]
  buffer_load_dwordx4 v1, s[12:15], s32 offen offset:2048 lds
  v_mfma_f32_16x16x32_bf16 v[60:63], a[144:147], a[240:243], 0
  v_exp_f32 v150, v150
  v_mfma_f32_16x16x32_bf16 v[60:63], a[140:143], a[236:239], v[60:63]
  v_cvt_pk_bf16_f32 v133, v134, v135
  v_cvt_pk_bf16_f32 v134, v148, v149
  v_mfma_f32_16x16x32_bf16 v[60:63], a[136:139], a[232:235], v[60:63]
  v_exp_f32 v151, v151
  v_mfma_f32_16x16x32_bf16 v[60:63], a[132:135], a[228:231], v[60:63]
  buffer_load_dwordx4 v1, s[12:15], s32 offen offset:3072 lds
  s_waitcnt lgkmcnt(4)
  v_mfma_f32_16x16x32_bf16 v[64:67], a[148:151], a[180:183], 0
  v_exp_f32 v136, v136
  v_mfma_f32_16x16x32_bf16 v[64:67], a[152:155], a[184:187], v[64:67]
  s_add_u32 s26, s26, 32768
  s_cmp_eq_u32 s26, s62
  s_cselect_b32 s26, s63, s26
  s_cselect_b32 s62, -1, s62
  v_mfma_f32_16x16x32_bf16 v[64:67], a[156:159], a[188:191], v[64:67]
  v_exp_f32 v137, v137
  v_mfma_f32_16x16x32_bf16 v[64:67], a[160:163], a[192:195], v[64:67]
  v_cvt_pk_bf16_f32 v135, v150, v151
  v_cvt_pk_bf16_f32 v136, v136, v137
  v_mfma_f32_16x16x32_bf16 v[68:71], a[160:163], a[208:211], 0
  v_exp_f32 v138, v138
  v_mfma_f32_16x16x32_bf16 v[68:71], a[156:159], a[204:207], v[68:71]
  v_mfma_f32_16x16x32_bf16 v[68:71], a[152:155], a[200:203], v[68:71]
  v_exp_f32 v139, v139
  v_mfma_f32_16x16x32_bf16 v[68:71], a[148:151], a[196:199], v[68:71]
  v_cvt_pk_bf16_f32 v137, v138, v139
  v_mfma_f32_16x16x32_bf16 v[72:75], a[148:151], a[212:215], 0
  v_exp_f32 v152, v152
  v_mfma_f32_16x16x32_bf16 v[72:75], a[152:155], a[216:219], v[72:75]
  v_mfma_f32_16x16x32_bf16 v[72:75], a[156:159], a[220:223], v[72:75]
  v_exp_f32 v153, v153
  v_mfma_f32_16x16x32_bf16 v[72:75], a[160:163], a[224:227], v[72:75]
  v_cvt_pk_bf16_f32 v138, v152, v153
  v_mfma_f32_16x16x32_bf16 v[76:79], a[160:163], a[240:243], 0
  v_exp_f32 v154, v154
  v_mfma_f32_16x16x32_bf16 v[76:79], a[156:159], a[236:239], v[76:79]
  s_waitcnt vmcnt(16) lgkmcnt(0)
  s_barrier
  ds_read_b128 a[116:119], v3 offset:32768
  ds_read_b128 a[120:123], v3 offset:40960
  ds_read_b128 a[124:127], v3 offset:33792
  ds_read_b128 a[128:131], v3 offset:41984
  v_mfma_f32_16x16x32_bf16 v[76:79], a[152:155], a[232:235], v[76:79]
  v_exp_f32 v155, v155
  v_mfma_f32_16x16x32_bf16 v[76:79], a[148:151], a[228:231], v[76:79]
  v_cvt_pk_bf16_f32 v139, v154, v155
  v_mfma_f32_16x16x32_bf16 v[80:83], a[164:167], a[180:183], 0
  v_exp_f32 v140, v140
  v_mfma_f32_16x16x32_bf16 v[80:83], a[168:171], a[184:187], v[80:83]
  ds_read_b128 a[132:135], v3 offset:34816
  ds_read_b128 a[136:139], v3 offset:43008
  v_mfma_f32_16x16x32_bf16 v[80:83], a[172:175], a[188:191], v[80:83]
  v_exp_f32 v141, v141
  v_mfma_f32_16x16x32_bf16 v[80:83], a[176:179], a[192:195], v[80:83]
  v_cvt_pk_bf16_f32 v140, v140, v141
  v_mfma_f32_16x16x32_bf16 v[84:87], a[176:179], a[208:211], 0
  v_exp_f32 v142, v142
  v_mfma_f32_16x16x32_bf16 v[84:87], a[172:175], a[204:207], v[84:87]
  v_mfma_f32_16x16x32_bf16 v[84:87], a[168:171], a[200:203], v[84:87]
  v_exp_f32 v143, v143
  v_mfma_f32_16x16x32_bf16 v[84:87], a[164:167], a[196:199], v[84:87]
  v_cvt_pk_bf16_f32 v141, v142, v143
  v_mfma_f32_16x16x32_bf16 v[88:91], a[164:167], a[212:215], 0
  v_exp_f32 v156, v156
  v_mfma_f32_16x16x32_bf16 v[88:91], a[168:171], a[216:219], v[88:91]
  ds_read_b128 a[140:143], v3 offset:35840
  ds_read_b128 a[144:147], v3 offset:44032
  v_mfma_f32_16x16x32_bf16 v[88:91], a[172:175], a[220:223], v[88:91]
  v_exp_f32 v157, v157
  v_mfma_f32_16x16x32_bf16 v[88:91], a[176:179], a[224:227], v[88:91]
  v_cvt_pk_bf16_f32 v142, v156, v157
  v_mfma_f32_16x16x32_bf16 v[92:95], a[176:179], a[240:243], 0
  v_exp_f32 v158, v158
  v_mfma_f32_16x16x32_bf16 v[92:95], a[172:175], a[236:239], v[92:95]
  v_mfma_f32_16x16x32_bf16 v[92:95], a[168:171], a[232:235], v[92:95]
  v_exp_f32 v159, v159
  v_mfma_f32_16x16x32_bf16 v[92:95], a[164:167], a[228:231], v[92:95]
  v_cvt_pk_bf16_f32 v143, v158, v159
  s_waitcnt lgkmcnt(6)
  s_add_u32 m0, s29, 65536
  v_mfma_f32_16x16x32_bf16 v[160:163], a[116:119], v[96:99], v[160:163]
  v_exp_f32 v32, v32
  v_mfma_f32_16x16x32_bf16 v[160:163], a[120:123], v[128:131], v[160:163]
  ds_read_b128 a[148:151], v3 offset:36864
  ds_read_b128 a[152:155], v3 offset:45056
  v_mfma_f32_16x16x32_bf16 v[164:167], a[120:123], v[132:135], v[164:167]
  v_exp_f32 v33, v33
  v_mfma_f32_16x16x32_bf16 v[164:167], a[116:119], v[100:103], v[164:167]
  buffer_load_dwordx4 v1, s[12:15], s25 offen offset:0 lds
  s_add_u32 s32, s25, 4096
  v_mfma_f32_16x16x32_bf16 v[168:171], a[116:119], v[104:107], v[168:171]
  v_exp_f32 v34, v34
  v_mfma_f32_16x16x32_bf16 v[168:171], a[120:123], v[136:139], v[168:171]
  v_cvt_pk_bf16_f32 v32, v32, v33
  v_mfma_f32_16x16x32_bf16 v[172:175], a[120:123], v[140:143], v[172:175]
  v_exp_f32 v35, v35
  v_mfma_f32_16x16x32_bf16 v[172:175], a[116:119], v[108:111], v[172:175]
  buffer_load_dwordx4 v1, s[12:15], s25 offen offset:1024 lds
  s_waitcnt lgkmcnt(6)
  v_mfma_f32_16x16x32_bf16 a[32:35], a[48:51], v[96:99], a[32:35]
  v_mfma_f32_16x16x32_bf16 a[32:35], a[48:51], v[128:131], a[32:35]
  v_mfma_f32_16x16x32_bf16 v[176:179], a[124:127], v[96:99], v[176:179]
  v_exp_f32 v48, v48
  v_mfma_f32_16x16x32_bf16 v[176:179], a[128:131], v[128:131], v[176:179]
  ds_read_b128 a[156:159], v3 offset:37888
  ds_read_b128 a[160:163], v3 offset:46080
  v_mfma_f32_16x16x32_bf16 v[180:183], a[128:131], v[132:135], v[180:183]
  v_exp_f32 v49, v49
  v_mfma_f32_16x16x32_bf16 v[180:183], a[124:127], v[100:103], v[180:183]
  buffer_load_dwordx4 v1, s[12:15], s25 offen offset:2048 lds
  v_mfma_f32_16x16x32_bf16 v[184:187], a[124:127], v[104:107], v[184:187]
  v_exp_f32 v50, v50
  v_mfma_f32_16x16x32_bf16 v[184:187], a[128:131], v[136:139], v[184:187]
  v_cvt_pk_bf16_f32 v33, v34, v35
  v_cvt_pk_bf16_f32 v34, v48, v49
  v_mfma_f32_16x16x32_bf16 v[188:191], a[128:131], v[140:143], v[188:191]
  v_exp_f32 v51, v51
  v_mfma_f32_16x16x32_bf16 v[188:191], a[124:127], v[108:111], v[188:191]
  buffer_load_dwordx4 v1, s[12:15], s25 offen offset:3072 lds
  s_add_u32 m0, s29, 69632
  s_waitcnt lgkmcnt(6)
  v_mfma_f32_16x16x32_bf16 a[36:39], a[48:51], v[100:103], a[36:39]
  v_mfma_f32_16x16x32_bf16 a[36:39], a[48:51], v[132:135], a[36:39]
  v_mfma_f32_16x16x32_bf16 v[192:195], a[132:135], v[96:99], v[192:195]
  v_exp_f32 v36, v36
  v_mfma_f32_16x16x32_bf16 v[192:195], a[136:139], v[128:131], v[192:195]
  ds_read_b128 a[164:167], v3 offset:38912
  ds_read_b128 a[168:171], v3 offset:47104
  v_mfma_f32_16x16x32_bf16 v[196:199], a[136:139], v[132:135], v[196:199]
  v_exp_f32 v37, v37
  v_mfma_f32_16x16x32_bf16 v[196:199], a[132:135], v[100:103], v[196:199]
  buffer_load_dwordx4 v1, s[12:15], s32 offen offset:0 lds
  v_mfma_f32_16x16x32_bf16 v[200:203], a[132:135], v[104:107], v[200:203]
  v_exp_f32 v38, v38
  v_mfma_f32_16x16x32_bf16 v[200:203], a[136:139], v[136:139], v[200:203]
  v_cvt_pk_bf16_f32 v35, v50, v51
  v_cvt_pk_bf16_f32 v36, v36, v37
  v_mfma_f32_16x16x32_bf16 v[204:207], a[136:139], v[140:143], v[204:207]
  v_exp_f32 v39, v39
  v_mfma_f32_16x16x32_bf16 v[204:207], a[132:135], v[108:111], v[204:207]
  buffer_load_dwordx4 v1, s[12:15], s32 offen offset:1024 lds
  s_waitcnt lgkmcnt(6)
  v_mfma_f32_16x16x32_bf16 a[40:43], a[48:51], v[104:107], a[40:43]
  v_mfma_f32_16x16x32_bf16 a[40:43], a[48:51], v[136:139], a[40:43]
  v_mfma_f32_16x16x32_bf16 v[208:211], a[140:143], v[96:99], v[208:211]
  v_exp_f32 v52, v52
  v_mfma_f32_16x16x32_bf16 v[208:211], a[144:147], v[128:131], v[208:211]
  ds_read_b128 a[172:175], v3 offset:39936
  ds_read_b128 a[176:179], v3 offset:48128
  v_mfma_f32_16x16x32_bf16 v[212:215], a[144:147], v[132:135], v[212:215]
  v_exp_f32 v53, v53
  v_mfma_f32_16x16x32_bf16 v[212:215], a[140:143], v[100:103], v[212:215]
  buffer_load_dwordx4 v1, s[12:15], s32 offen offset:2048 lds
  v_mfma_f32_16x16x32_bf16 v[216:219], a[140:143], v[104:107], v[216:219]
  v_exp_f32 v54, v54
  v_mfma_f32_16x16x32_bf16 v[216:219], a[144:147], v[136:139], v[216:219]
  v_cvt_pk_bf16_f32 v37, v38, v39
  v_cvt_pk_bf16_f32 v38, v52, v53
  v_mfma_f32_16x16x32_bf16 v[220:223], a[144:147], v[140:143], v[220:223]
  v_exp_f32 v55, v55
  v_mfma_f32_16x16x32_bf16 v[220:223], a[140:143], v[108:111], v[220:223]
  buffer_load_dwordx4 v1, s[12:15], s32 offen offset:3072 lds
  s_waitcnt lgkmcnt(6)
  v_mfma_f32_16x16x32_bf16 a[44:47], a[48:51], v[108:111], a[44:47]
  v_mfma_f32_16x16x32_bf16 a[44:47], a[48:51], v[140:143], a[44:47]
  v_mfma_f32_16x16x32_bf16 v[224:227], a[148:151], v[96:99], v[224:227]
  v_exp_f32 v40, v40
  v_mfma_f32_16x16x32_bf16 v[224:227], a[152:155], v[128:131], v[224:227]
  s_add_u32 s25, s25, 32768
  s_cmp_eq_u32 s25, s27
  s_cselect_b32 s25, s28, s25
  s_cselect_b32 s27, -1, s27
  v_mfma_f32_16x16x32_bf16 v[228:231], a[152:155], v[132:135], v[228:231]
  v_exp_f32 v41, v41
  v_mfma_f32_16x16x32_bf16 v[228:231], a[148:151], v[100:103], v[228:231]
  v_cvt_pk_bf16_f32 v39, v54, v55
  v_cvt_pk_bf16_f32 v40, v40, v41
  v_mfma_f32_16x16x32_bf16 v[232:235], a[148:151], v[104:107], v[232:235]
  v_exp_f32 v42, v42
  v_mfma_f32_16x16x32_bf16 v[232:235], a[152:155], v[136:139], v[232:235]
  v_mfma_f32_16x16x32_bf16 v[236:239], a[152:155], v[140:143], v[236:239]
  v_exp_f32 v43, v43
  v_mfma_f32_16x16x32_bf16 v[236:239], a[148:151], v[108:111], v[236:239]
  v_cvt_pk_bf16_f32 v41, v42, v43
  s_waitcnt lgkmcnt(4)
  v_mfma_f32_16x16x32_bf16 v[240:243], a[156:159], v[96:99], v[240:243]
  v_exp_f32 v56, v56
  v_mfma_f32_16x16x32_bf16 v[240:243], a[160:163], v[128:131], v[240:243]
  v_mfma_f32_16x16x32_bf16 v[244:247], a[160:163], v[132:135], v[244:247]
  v_exp_f32 v57, v57
  v_mfma_f32_16x16x32_bf16 v[244:247], a[156:159], v[100:103], v[244:247]
  v_cvt_pk_bf16_f32 v42, v56, v57
  v_mfma_f32_16x16x32_bf16 v[248:251], a[156:159], v[104:107], v[248:251]
  v_exp_f32 v58, v58
  v_mfma_f32_16x16x32_bf16 v[248:251], a[160:163], v[136:139], v[248:251]
  s_waitcnt vmcnt(16) lgkmcnt(0)
  s_barrier
  ds_read_b128 a[116:119], v2 offset:0
  ds_read_b128 a[120:123], v2 offset:1024
  ds_read_b128 a[124:127], v2 offset:2048
  ds_read_b128 a[128:131], v2 offset:3072
  v_mfma_f32_16x16x32_bf16 v[252:255], a[160:163], v[140:143], v[252:255]
  v_exp_f32 v59, v59
  v_mfma_f32_16x16x32_bf16 v[252:255], a[156:159], v[108:111], v[252:255]
  v_cvt_pk_bf16_f32 v43, v58, v59
  v_mfma_f32_16x16x32_bf16 a[0:3], a[164:167], v[96:99], a[0:3]
  v_exp_f32 v44, v44
  v_mfma_f32_16x16x32_bf16 a[0:3], a[168:171], v[128:131], a[0:3]
  ds_read_b128 a[132:135], v2 offset:4096
  ds_read_b128 a[136:139], v2 offset:5120
  v_mfma_f32_16x16x32_bf16 a[4:7], a[168:171], v[132:135], a[4:7]
  v_exp_f32 v45, v45
  v_mfma_f32_16x16x32_bf16 a[4:7], a[164:167], v[100:103], a[4:7]
  v_cvt_pk_bf16_f32 v44, v44, v45
  v_mfma_f32_16x16x32_bf16 a[8:11], a[164:167], v[104:107], a[8:11]
  v_exp_f32 v46, v46
  v_mfma_f32_16x16x32_bf16 a[8:11], a[168:171], v[136:139], a[8:11]
  v_mfma_f32_16x16x32_bf16 a[12:15], a[168:171], v[140:143], a[12:15]
  v_exp_f32 v47, v47
  v_mfma_f32_16x16x32_bf16 a[12:15], a[164:167], v[108:111], a[12:15]
  v_cvt_pk_bf16_f32 v45, v46, v47
  v_mfma_f32_16x16x32_bf16 a[16:19], a[172:175], v[96:99], a[16:19]
  v_exp_f32 v60, v60
  v_mfma_f32_16x16x32_bf16 a[16:19], a[176:179], v[128:131], a[16:19]
  ds_read_b128 a[140:143], v2 offset:6144
  ds_read_b128 a[144:147], v2 offset:7168
  v_mfma_f32_16x16x32_bf16 a[20:23], a[176:179], v[132:135], a[20:23]
  v_exp_f32 v61, v61
  v_mfma_f32_16x16x32_bf16 a[20:23], a[172:175], v[100:103], a[20:23]
  v_cvt_pk_bf16_f32 v46, v60, v61
  v_mfma_f32_16x16x32_bf16 a[24:27], a[172:175], v[104:107], a[24:27]
  v_exp_f32 v62, v62
  v_mfma_f32_16x16x32_bf16 a[24:27], a[176:179], v[136:139], a[24:27]
  v_mfma_f32_16x16x32_bf16 a[28:31], a[176:179], v[140:143], a[28:31]
  v_exp_f32 v63, v63
  v_mfma_f32_16x16x32_bf16 a[28:31], a[172:175], v[108:111], a[28:31]
  v_cvt_pk_bf16_f32 v47, v62, v63
  s_sub_u32 s30, s30, 1
  s_cmp_lg_u32 s30, 0
  s_cbranch_scc1 Lk2_l2
  s_branch Lk2_fin
Lk2_g1:
  s_mov_b32 s30, 7
Lk2_l3:
  s_waitcnt lgkmcnt(4)
  s_add_u32 m0, s29, 98304
  v_mfma_f32_16x16x32_bf16 v[96:99], a[116:119], a[52:55], 0
  v_exp_f32 v64, v64
  v_mfma_f32_16x16x32_bf16 v[96:99], a[120:123], a[56:59], v[96:99]
  ds_read_b128 a[148:151], v2 offset:8192
  ds_read_b128 a[152:155], v2 offset:9216
  v_mfma_f32_16x16x32_bf16 v[96:99], a[124:127], a[60:63], v[96:99]
  v_exp_f32 v65, v65
  v_mfma_f32_16x16x32_bf16 v[96:99], a[128:131], a[64:67], v[96:99]
  buffer_load_dwordx4 v1, s[12:15], s26 offen offset:0 lds
  s_add_u32 s32, s26, 4096
  v_mfma_f32_16x16x32_bf16 v[100:103], a[128:131], a[80:83], 0
  v_exp_f32 v66, v66
  v_mfma_f32_16x16x32_bf16 v[100:103], a[124:127], a[76:79], v[100:103]
  v_cvt_pk_bf16_f32 v64, v64, v65
  v_mfma_f32_16x16x32_bf16 v[100:103], a[120:123], a[72:75], v[100:103]
  v_exp_f32 v67, v67
  v_mfma_f32_16x16x32_bf16 v[100:103], a[116:119], a[68:71], v[100:103]
  buffer_load_dwordx4 v1, s[12:15], s26 offen offset:1024 lds
  v_mfma_f32_16x16x32_bf16 v[104:107], a[116:119], a[84:87], 0
  v_exp_f32 v80, v80
  v_mfma_f32_16x16x32_bf16 v[104:107], a[120:123], a[88:91], v[104:107]
  ds_read_b128 a[156:159], v2 offset:10240
  ds_read_b128 a[160:163], v2 offset:11264
  v_mfma_f32_16x16x32_bf16 v[104:107], a[124:127], a[92:95], v[104:107]
  v_exp_f32 v81, v81
  v_mfma_f32_16x16x32_bf16 v[104:107], a[128:131], a[96:99], v[104:107]
  buffer_load_dwordx4 v1, s[12:15], s26 offen offset:2048 lds
  v_mfma_f32_16x16x32_bf16 v[108:111], a[128:131], a[112:115], 0
  v_exp_f32 v82, v82
  v_mfma_f32_16x16x32_bf16 v[108:111], a[124:127], a[108:111], v[108:111]
  v_cvt_pk_bf16_f32 v65, v66, v67
  v_cvt_pk_bf16_f32 v66, v80, v81
  v_mfma_f32_16x16x32_bf16 v[108:111], a[120:123], a[104:107], v[108:111]
  v_exp_f32 v83, v83
  v_mfma_f32_16x16x32_bf16 v[108:111], a[116:119], a[100:103], v[108:111]
  buffer_load_dwordx4 v1, s[12:15], s26 offen offset:3072 lds
  s_add_u32 m0, s29, 102400
  s_waitcnt lgkmcnt(4)
  v_mfma_f32_16x16x32_bf16 v[112:115], a[132:135], a[52:55], 0
  v_exp_f32 v68, v68
  v_mfma_f32_16x16x32_bf16 v[112:115], a[136:139], a[56:59], v[112:115]
  ds_read_b128 a[164:167], v2 offset:12288
  ds_read_b128 a[168:171], v2 offset:13312
  v_mfma_f32_16x16x32_bf16 v[112:115], a[140:143], a[60:63], v[112:115]
  v_exp_f32 v69, v69
  v_mfma_f32_16x16x32_bf16 v[112:115], a[144:147], a[64:67], v[112:115]
  buffer_load_dwordx4 v1, s[12:15], s32 offen offset:0 lds
  v_mfma_f32_16x16x32_bf16 v[116:119], a[144:147], a[80:83], 0
  v_exp_f32 v70, v70
  v_mfma_f32_16x16x32_bf16 v[116:119], a[140:143], a[76:79], v[116:119]
  v_cvt_pk_bf16_f32 v67, v82, v83
  v_cvt_pk_bf16_f32 v68, v68, v69
  v_mfma_f32_16x16x32_bf16 v[116:119], a[136:139], a[72:75], v[116:119]
  v_exp_f32 v71, v71
  v_mfma_f32_16x16x32_bf16 v[116:119], a[132:135], a[68:71], v[116:119]
  buffer_load_dwordx4 v1, s[12:15], s32 offen offset:1024 lds
  v_mfma_f32_16x16x32_bf16 v[120:123], a[132:135], a[84:87], 0
  v_exp_f32 v84, v84
  v_mfma_f32_16x16x32_bf16 v[120:123], a[136:139], a[88:91], v[120:123]
  ds_read_b128 a[172:175], v2 offset:14336
  ds_read_b128 a[176:179], v2 offset:15360
  v_mfma_f32_16x16x32_bf16 v[120:123], a[140:143], a[92:95], v[120:123]
  v_exp_f32 v85, v85
  v_mfma_f32_16x16x32_bf16 v[120:123], a[144:147], a[96:99], v[120:123]
  buffer_load_dwordx4 v1, s[12:15], s32 offen offset:2048 lds
  v_mfma_f32_16x16x32_bf16 v[124:127], a[144:147], a[112:115], 0
  v_exp_f32 v86, v86
  v_mfma_f32_16x16x32_bf16 v[124:127], a[140:143], a[108:111], v[124:127]
  v_cvt_pk_bf16_f32 v69, v70, v71
  v_cvt_pk_bf16_f32 v70, v84, v85
  v_mfma_f32_16x16x32_bf16 v[124:127], a[136:139], a[104:107], v[124:127]
  v_exp_f32 v87, v87
  v_mfma_f32_16x16x32_bf16 v[124:127], a[132:135], a[100:103], v[124:127]
  buffer_load_dwordx4 v1, s[12:15], s32 offen offset:3072 lds
  s_waitcnt lgkmcnt(4)
  v_mfma_f32_16x16x32_bf16 v[128:131], a[148:151], a[52:55], 0
  v_exp_f32 v72, v72
  v_mfma_f32_16x16x32_bf16 v[128:131], a[152:155], a[56:59], v[128:131]
  s_add_u32 s26, s26, 32768
  s_cmp_eq_u32 s26, s62
  s_cselect_b32 s26, s63, s26
  s_cselect_b32 s62, -1, s62
  v_mfma_f32_16x16x32_bf16 v[128:131], a[156:159], a[60:63], v[128:131]
  v_exp_f32 v73, v73
  v_mfma_f32_16x16x32_bf16 v[128:131], a[160:163], a[64:67], v[128:131]
  v_cvt_pk_bf16_f32 v71, v86, v87
  v_cvt_pk_bf16_f32 v72, v72, v73
  v_mfma_f32_16x16x32_bf16 v[132:135], a[160:163], a[80:83], 0
  v_exp_f32 v74, v74
  v_mfma_f32_16x16x32_bf16 v[132:135], a[156:159], a[76:79], v[132:135]
  v_mfma_f32_16x16x32_bf16 v[132:135], a[152:155], a[72:75], v[132:135]
  v_exp_f32 v75, v75
  v_mfma_f32_16x16x32_bf16 v[132:135], a[148:151], a[68:71], v[132:135]
  v_cvt_pk_bf16_f32 v73, v74, v75
  v_mfma_f32_16x16x32_bf16 v[136:139], a[148:151], a[84:87], 0
  v_exp_f32 v88, v88
  v_mfma_f32_16x16x32_bf16 v[136:139], a[152:155], a[88:91], v[136:139]
  v_mfma_f32_16x16x32_bf16 v[136:139], a[156:159], a[92:95], v[136:139]
  v_exp_f32 v89, v89
  v_mfma_f32_16x16x32_bf16 v[136:139], a[160:163], a[96:99], v[136:139]
  v_cvt_pk_bf16_f32 v74, v88, v89
  v_mfma_f32_16x16x32_bf16 v[140:143], a[160:163], a[112:115], 0
  v_exp_f32 v90, v90
  v_mfma_f32_16x16x32_bf16 v[140:143], a[156:159], a[108:111], v[140:143]
  s_waitcnt vmcnt(16) lgkmcnt(0)
  s_barrier
  ds_read_b128 a[116:119], v2 offset:32768
  ds_read_b128 a[120:123], v2 offset:40960
  ds_read_b128 a[124:127], v2 offset:33792
  ds_read_b128 a[128:131], v2 offset:41984
  v_mfma_f32_16x16x32_bf16 v[140:143], a[152:155], a[104:107], v[140:143]
  v_exp_f32 v91, v91
  v_mfma_f32_16x16x32_bf16 v[140:143], a[148:151], a[100:103], v[140:143]
  v_cvt_pk_bf16_f32 v75, v90, v91
  v_mfma_f32_16x16x32_bf16 v[144:147], a[164:167], a[52:55], 0
  v_exp_f32 v76, v76
  v_mfma_f32_16x16x32_bf16 v[144:147], a[168:171], a[56:59], v[144:147]
  ds_read_b128 a[132:135], v2 offset:34816
  ds_read_b128 a[136:139], v2 offset:43008
  v_mfma_f32_16x16x32_bf16 v[144:147], a[172:175], a[60:63], v[144:147]
  v_exp_f32 v77, v77
  v_mfma_f32_16x16x32_bf16 v[144:147], a[176:179], a[64:67], v[144:147]
  v_cvt_pk_bf16_f32 v76, v76, v77
  v_mfma_f32_16x16x32_bf16 v[148:151], a[176:179], a[80:83], 0
  v_exp_f32 v78, v78
  v_mfma_f32_16x16x32_bf16 v[148:151], a[172:175], a[76:79], v[148:151]
  v_mfma_f32_16x16x32_bf16 v[148:151], a[168:171], a[72:75], v[148:151]
  v_exp_f32 v79, v79
  v_mfma_f32_16x16x32_bf16 v[148:151], a[164:167], a[68:71], v[148:151]
  v_cvt_pk_bf16_f32 v77, v78, v79
  v_mfma_f32_16x16x32_bf16 v[152:155], a[164:167], a[84:87], 0
  v_exp_f32 v92, v92
  v_mfma_f32_16x16x32_bf16 v[152:155], a[168:171], a[88:91], v[152:155]
  ds_read_b128 a[140:143], v2 offset:35840
  ds_read_b128 a[144:147], v2 offset:44032
  v_mfma_f32_16x16x32_bf16 v[152:155], a[172:175], a[92:95], v[152:155]
  v_exp_f32 v93, v93
  v_mfma_f32_16x16x32_bf16 v[152:155], a[176:179], a[96:99], v[152:155]
  v_cvt_pk_bf16_f32 v78, v92, v93
  v_mfma_f32_16x16x32_bf16 v[156:159], a[176:179], a[112:115], 0
  v_exp_f32 v94, v94
  v_mfma_f32_16x16x32_bf16 v[156:159], a[172:175], a[108:111], v[156:159]
  v_mfma_f32_16x16x32_bf16 v[156:159], a[168:171], a[104:107], v[156:159]
  v_exp_f32 v95, v95
  v_mfma_f32_16x16x32_bf16 v[156:159], a[164:167], a[100:103], v[156:159]
  v_cvt_pk_bf16_f32 v79, v94, v95
  s_waitcnt lgkmcnt(6)
  s_add_u32 m0, s29, 0
  v_mfma_f32_16x16x32_bf16 v[160:163], a[116:119], v[32:35], v[160:163]
  v_exp_f32 v96, v96
  v_mfma_f32_16x16x32_bf16 v[160:163], a[120:123], v[64:67], v[160:163]
  ds_read_b128 a[148:151], v2 offset:36864
  ds_read_b128 a[152:155], v2 offset:45056
  v_mfma_f32_16x16x32_bf16 v[164:167], a[120:123], v[68:71], v[164:167]
  v_exp_f32 v97, v97
  v_mfma_f32_16x16x32_bf16 v[164:167], a[116:119], v[36:39], v[164:167]
  buffer_load_dwordx4 v1, s[12:15], s25 offen offset:0 lds
  s_add_u32 s32, s25, 4096
  v_mfma_f32_16x16x32_bf16 v[168:171], a[116:119], v[40:43], v[168:171]
  v_exp_f32 v98, v98
  v_mfma_f32_16x16x32_bf16 v[168:171], a[120:123], v[72:75], v[168:171]
  v_cvt_pk_bf16_f32 v96, v96, v97
  v_mfma_f32_16x16x32_bf16 v[172:175], a[120:123], v[76:79], v[172:175]
  v_exp_f32 v99, v99
  v_mfma_f32_16x16x32_bf16 v[172:175], a[116:119], v[44:47], v[172:175]
  buffer_load_dwordx4 v1, s[12:15], s25 offen offset:1024 lds
  s_waitcnt lgkmcnt(6)
  v_mfma_f32_16x16x32_bf16 a[32:35], a[48:51], v[32:35], a[32:35]
  v_mfma_f32_16x16x32_bf16 a[32:35], a[48:51], v[64:67], a[32:35]
  v_mfma_f32_16x16x32_bf16 v[176:179], a[124:127], v[32:35], v[176:179]
  v_exp_f32 v112, v112
  v_mfma_f32_16x16x32_bf16 v[176:179], a[128:131], v[64:67], v[176:179]
  ds_read_b128 a[156:159], v2 offset:37888
  ds_read_b128 a[160:163], v2 offset:46080
  v_mfma_f32_16x16x32_bf16 v[180:183], a[128:131], v[68:71], v[180:183]
  v_exp_f32 v113, v113
  v_mfma_f32_16x16x32_bf16 v[180:183], a[124:127], v[36:39], v[180:183]
  buffer_load_dwordx4 v1, s[12:15], s25 offen offset:2048 lds
  v_mfma_f32_16x16x32_bf16 v[184:187], a[124:127], v[40:43], v[184:187]
  v_exp_f32 v114, v114
  v_mfma_f32_16x16x32_bf16 v[184:187], a[128:131], v[72:75], v[184:187]
  v_cvt_pk_bf16_f32 v97, v98, v99
  v_cvt_pk_bf16_f32 v98, v112, v113
  v_mfma_f32_16x16x32_bf16 v[188:191], a[128:131], v[76:79], v[188:191]
  v_exp_f32 v115, v115
  v_mfma_f32_16x16x32_bf16 v[188:191], a[124:127], v[44:47], v[188:191]
  buffer_load_dwordx4 v1, s[12:15], s25 offen offset:3072 lds
  s_add_u32 m0, s29, 4096
  s_waitcnt lgkmcnt(6)
  v_mfma_f32_16x16x32_bf16 a[36:39], a[48:51], v[36:39], a[36:39]
  v_mfma_f32_16x16x32_bf16 a[36:39], a[48:51], v[68:71], a[36:39]
  v_mfma_f32_16x16x32_bf16 v[192:195], a[132:135], v[32:35], v[192:195]
  v_exp_f32 v100, v100
  v_mfma_f32_16x16x32_bf16 v[192:195], a[136:139], v[64:67], v[192:195]
  ds_read_b128 a[164:167], v2 offset:38912
  ds_read_b128 a[168:171], v2 offset:47104
  v_mfma_f32_16x16x32_bf16 v[196:199], a[136:139], v[68:71], v[196:199]
  v_exp_f32 v101, v101
  v_mfma_f32_16x16x32_bf16 v[196:199], a[132:135], v[36:39], v[196:199]
  buffer_load_dwordx4 v1, s[12:15], s32 offen offset:0 lds
  v_mfma_f32_16x16x32_bf16 v[200:203], a[132:135], v[40:43], v[200:203]
  v_exp_f32 v102, v102
  v_mfma_f32_16x16x32_bf16 v[200:203], a[136:139], v[72:75], v[200:203]
  v_cvt_pk_bf16_f32 v99, v114, v115
  v_cvt_pk_bf16_f32 v100, v100, v101
  v_mfma_f32_16x16x32_bf16 v[204:207], a[136:139], v[76:79], v[204:207]
  v_exp_f32 v103, v103
  v_mfma_f32_16x16x32_bf16 v[204:207], a[132:135], v[44:47], v[204:207]
  buffer_load_dwordx4 v1, s[12:15], s32 offen offset:1024 lds
  s_waitcnt lgkmcnt(6)
  v_mfma_f32_16x16x32_bf16 a[40:43], a[48:51], v[40:43], a[40:43]
  v_mfma_f32_16x16x32_bf16 a[40:43], a[48:51], v[72:75], a[40:43]
  v_mfma_f32_16x16x32_bf16 v[208:211], a[140:143], v[32:35], v[208:211]
  v_exp_f32 v116, v116
  v_mfma_f32_16x16x32_bf16 v[208:211], a[144:147], v[64:67], v[208:211]
  ds_read_b128 a[172:175], v2 offset:39936
  ds_read_b128 a[176:179], v2 offset:48128
  v_mfma_f32_16x16x32_bf16 v[212:215], a[144:147], v[68:71], v[212:215]
  v_exp_f32 v117, v117
  v_mfma_f32_16x16x32_bf16 v[212:215], a[140:143], v[36:39], v[212:215]
  buffer_load_dwordx4 v1, s[12:15], s32 offen offset:2048 lds
  v_mfma_f32_16x16x32_bf16 v[216:219], a[140:143], v[40:43], v[216:219]
  v_exp_f32 v118, v118
  v_mfma_f32_16x16x32_bf16 v[216:219], a[144:147], v[72:75], v[216:219]
  v_cvt_pk_bf16_f32 v101, v102, v103
  v_cvt_pk_bf16_f32 v102, v116, v117
  v_mfma_f32_16x16x32_bf16 v[220:223], a[144:147], v[76:79], v[220:223]
  v_exp_f32 v119, v119
  v_mfma_f32_16x16x32_bf16 v[220:223], a[140:143], v[44:47], v[220:223]
  buffer_load_dwordx4 v1, s[12:15], s32 offen offset:3072 lds
  s_waitcnt lgkmcnt(6)
  v_mfma_f32_16x16x32_bf16 a[44:47], a[48:51], v[44:47], a[44:47]
  v_mfma_f32_16x16x32_bf16 a[44:47], a[48:51], v[76:79], a[44:47]
  v_mfma_f32_16x16x32_bf16 v[224:227], a[148:151], v[32:35], v[224:227]
  v_exp_f32 v104, v104
  v_mfma_f32_16x16x32_bf16 v[224:227], a[152:155], v[64:67], v[224:227]
  s_add_u32 s25, s25, 32768
  s_cmp_eq_u32 s25, s27
  s_cselect_b32 s25, s28, s25
  s_cselect_b32 s27, -1, s27
  v_mfma_f32_16x16x32_bf16 v[228:231], a[152:155], v[68:71], v[228:231]
  v_exp_f32 v105, v105
  v_mfma_f32_16x16x32_bf16 v[228:231], a[148:151], v[36:39], v[228:231]
  v_cvt_pk_bf16_f32 v103, v118, v119
  v_cvt_pk_bf16_f32 v104, v104, v105
  v_mfma_f32_16x16x32_bf16 v[232:235], a[148:151], v[40:43], v[232:235]
  v_exp_f32 v106, v106
  v_mfma_f32_16x16x32_bf16 v[232:235], a[152:155], v[72:75], v[232:235]
  v_mfma_f32_16x16x32_bf16 v[236:239], a[152:155], v[76:79], v[236:239]
  v_exp_f32 v107, v107
  v_mfma_f32_16x16x32_bf16 v[236:239], a[148:151], v[44:47], v[236:239]
  v_cvt_pk_bf16_f32 v105, v106, v107
  s_waitcnt lgkmcnt(4)
  v_mfma_f32_16x16x32_bf16 v[240:243], a[156:159], v[32:35], v[240:243]
  v_exp_f32 v120, v120
  v_mfma_f32_16x16x32_bf16 v[240:243], a[160:163], v[64:67], v[240:243]
  v_mfma_f32_16x16x32_bf16 v[244:247], a[160:163], v[68:71], v[244:247]
  v_exp_f32 v121, v121
  v_mfma_f32_16x16x32_bf16 v[244:247], a[156:159], v[36:39], v[244:247]
  v_cvt_pk_bf16_f32 v106, v120, v121
  v_mfma_f32_16x16x32_bf16 v[248:251], a[156:159], v[40:43], v[248:251]
  v_exp_f32 v122, v122
  v_mfma_f32_16x16x32_bf16 v[248:251], a[160:163], v[72:75], v[248:251]
  s_waitcnt vmcnt(16) lgkmcnt(0)
  s_barrier
  ds_read_b128 a[116:119], v3 offset:0
  ds_read_b128 a[120:123], v3 offset:1024
  ds_read_b128 a[124:127], v3 offset:2048
  ds_read_b128 a[128:131], v3 offset:3072
  v_mfma_f32_16x16x32_bf16 v[252:255], a[160:163], v[76:79], v[252:255]
  v_exp_f32 v123, v123
  v_mfma_f32_16x16x32_bf16 v[252:255], a[156:159], v[44:47], v[252:255]
  v_cvt_pk_bf16_f32 v107, v122, v123
  v_mfma_f32_16x16x32_bf16 a[0:3], a[164:167], v[32:35], a[0:3]
  v_exp_f32 v108, v108
  v_mfma_f32_16x16x32_bf16 a[0:3], a[168:171], v[64:67], a[0:3]
  ds_read_b128 a[132:135], v3 offset:4096
  ds_read_b128 a[136:139], v3 offset:5120
  v_mfma_f32_16x16x32_bf16 a[4:7], a[168:171], v[68:71], a[4:7]
  v_exp_f32 v109, v109
  v_mfma_f32_16x16x32_bf16 a[4:7], a[164:167], v[36:39], a[4:7]
  v_cvt_pk_bf16_f32 v108, v108, v109
  v_mfma_f32_16x16x32_bf16 a[8:11], a[164:167], v[40:43], a[8:11]
  v_exp_f32 v110, v110
  v_mfma_f32_16x16x32_bf16 a[8:11], a[168:171], v[72:75], a[8:11]
  v_mfma_f32_16x16x32_bf16 a[12:15], a[168:171], v[76:79], a[12:15]
  v_exp_f32 v111, v111
  v_mfma_f32_16x16x32_bf16 a[12:15], a[164:167], v[44:47], a[12:15]
  v_cvt_pk_bf16_f32 v109, v110, v111
  v_mfma_f32_16x16x32_bf16 a[16:19], a[172:175], v[32:35], a[16:19]
  v_exp_f32 v124, v124
  v_mfma_f32_16x16x32_bf16 a[16:19], a[176:179], v[64:67], a[16:19]
  ds_read_b128 a[140:143], v3 offset:6144
  ds_read_b128 a[144:147], v3 offset:7168
  v_mfma_f32_16x16x32_bf16 a[20:23], a[176:179], v[68:71], a[20:23]
  v_exp_f32 v125, v125
  v_mfma_f32_16x16x32_bf16 a[20:23], a[172:175], v[36:39], a[20:23]
  v_cvt_pk_bf16_f32 v110, v124, v125
  v_mfma_f32_16x16x32_bf16 a[24:27], a[172:175], v[40:43], a[24:27]
  v_exp_f32 v126, v126
  v_mfma_f32_16x16x32_bf16 a[24:27], a[176:179], v[72:75], a[24:27]
  v_mfma_f32_16x16x32_bf16 a[28:31], a[176:179], v[76:79], a[28:31]
  v_exp_f32 v127, v127
  v_mfma_f32_16x16x32_bf16 a[28:31], a[172:175], v[44:47], a[28:31]
  v_cvt_pk_bf16_f32 v111, v126, v127
  s_waitcnt lgkmcnt(4)
  s_add_u32 m0, s29, 32768
  v_mfma_f32_16x16x32_bf16 v[32:35], a[116:119], a[52:55], 0
  v_exp_f32 v128, v128
  v_mfma_f32_16x16x32_bf16 v[32:35], a[120:123], a[56:59], v[32:35]
  ds_read_b128 a[148:151], v3 offset:8192
  ds_read_b128 a[152:155], v3 offset:9216
  v_mfma_f32_16x16x32_bf16 v[32:35], a[124:127], a[60:63], v[32:35]
  v_exp_f32 v129, v129
  v_mfma_f32_16x16x32_bf16 v[32:35], a[128:131], a[64:67], v[32:35]
  buffer_load_dwordx4 v1, s[12:15], s26 offen offset:0 lds
  s_add_u32 s32, s26, 4096
  v_mfma_f32_16x16x32_bf16 v[36:39], a[128:131], a[80:83], 0
  v_exp_f32 v130, v130
  v_mfma_f32_16x16x32_bf16 v[36:39], a[124:127], a[76:79], v[36:39]
  v_cvt_pk_bf16_f32 v128, v128, v129
  v_mfma_f32_16x16x32_bf16 v[36:39], a[120:123], a[72:75], v[36:39]
  v_exp_f32 v131, v131
  v_mfma_f32_16x16x32_bf16 v[36:39], a[116:119], a[68:71], v[36:39]
  buffer_load_dwordx4 v1, s[12:15], s26 offen offset:1024 lds
  v_mfma_f32_16x16x32_bf16 v[40:43], a[116:119], a[84:87], 0
  v_exp_f32 v144, v144
  v_mfma_f32_16x16x32_bf16 v[40:43], a[120:123], a[88:91], v[40:43]
  ds_read_b128 a[156:159], v3 offset:10240
  ds_read_b128 a[160:163], v3 offset:11264
  v_mfma_f32_16x16x32_bf16 v[40:43], a[124:127], a[92:95], v[40:43]
  v_exp_f32 v145, v145
  v_mfma_f32_16x16x32_bf16 v[40:43], a[128:131], a[96:99], v[40:43]
  buffer_load_dwordx4 v1, s[12:15], s26 offen offset:2048 lds
  v_mfma_f32_16x16x32_bf16 v[44:47], a[128:131], a[112:115], 0
  v_exp_f32 v146, v146
  v_mfma_f32_16x16x32_bf16 v[44:47], a[124:127], a[108:111], v[44:47]
  v_cvt_pk_bf16_f32 v129, v130, v131
  v_cvt_pk_bf16_f32 v130, v144, v145
  v_mfma_f32_16x16x32_bf16 v[44:47], a[120:123], a[104:107], v[44:47]
  v_exp_f32 v147, v147
  v_mfma_f32_16x16x32_bf16 v[44:47], a[116:119], a[100:103], v[44:47]
  buffer_load_dwordx4 v1, s[12:15], s26 offen offset:3072 lds
  s_add_u32 m0, s29, 36864
  s_waitcnt lgkmcnt(4)
  v_mfma_f32_16x16x32_bf16 v[48:51], a[132:135], a[52:55], 0
  v_exp_f32 v132, v132
  v_mfma_f32_16x16x32_bf16 v[48:51], a[136:139], a[56:59], v[48:51]
  ds_read_b128 a[164:167], v3 offset:12288
  ds_read_b128 a[168:171], v3 offset:13312
  v_mfma_f32_16x16x32_bf16 v[48:51], a[140:143], a[60:63], v[48:51]
  v_exp_f32 v133, v133
  v_mfma_f32_16x16x32_bf16 v[48:51], a[144:147], a[64:67], v[48:51]
  buffer_load_dwordx4 v1, s[12:15], s32 offen offset:0 lds
  v_mfma_f32_16x16x32_bf16 v[52:55], a[144:147], a[80:83], 0
  v_exp_f32 v134, v134
  v_mfma_f32_16x16x32_bf16 v[52:55], a[140:143], a[76:79], v[52:55]
  v_cvt_pk_bf16_f32 v131, v146, v147
  v_cvt_pk_bf16_f32 v132, v132, v133
  v_mfma_f32_16x16x32_bf16 v[52:55], a[136:139], a[72:75], v[52:55]
  v_exp_f32 v135, v135
  v_mfma_f32_16x16x32_bf16 v[52:55], a[132:135], a[68:71], v[52:55]
  buffer_load_dwordx4 v1, s[12:15], s32 offen offset:1024 lds
  v_mfma_f32_16x16x32_bf16 v[56:59], a[132:135], a[84:87], 0
  v_exp_f32 v148, v148
  v_mfma_f32_16x16x32_bf16 v[56:59], a[136:139], a[88:91], v[56:59]
  ds_read_b128 a[172:175], v3 offset:14336
  ds_read_b128 a[176:179], v3 offset:15360
  v_mfma_f32_16x16x32_bf16 v[56:59], a[140:143], a[92:95], v[56:59]
  v_exp_f32 v149, v149
  v_mfma_f32_16x16x32_bf16 v[56:59], a[144:147], a[96:99], v[56:59]
  buffer_load_dwordx4 v1, s[12:15], s32 offen offset:2048 lds
  v_mfma_f32_16x16x32_bf16 v[60:63], a[144:147], a[112:115], 0
  v_exp_f32 v150, v150
  v_mfma_f32_16x16x32_bf16 v[60:63], a[140:143], a[108:111], v[60:63]
  v_cvt_pk_bf16_f32 v133, v134, v135
  v_cvt_pk_bf16_f32 v134, v148, v149
  v_mfma_f32_16x16x32_bf16 v[60:63], a[136:139], a[104:107], v[60:63]
  v_exp_f32 v151, v151
  v_mfma_f32_16x16x32_bf16 v[60:63], a[132:135], a[100:103], v[60:63]
  buffer_load_dwordx4 v1, s[12:15], s32 offen offset:3072 lds
  s_waitcnt lgkmcnt(4)
  v_mfma_f32_16x16x32_bf16 v[64:67], a[148:151], a[52:55], 0
  v_exp_f32 v136, v136
  v_mfma_f32_16x16x32_bf16 v[64:67], a[152:155], a[56:59], v[64:67]
  s_add_u32 s26, s26, 32768
  s_cmp_eq_u32 s26, s62
  s_cselect_b32 s26, s63, s26
  s_cselect_b32 s62, -1, s62
  v_mfma_f32_16x16x32_bf16 v[64:67], a[156:159], a[60:63], v[64:67]
  v_exp_f32 v137, v137
  v_mfma_f32_16x16x32_bf16 v[64:67], a[160:163], a[64:67], v[64:67]
  v_cvt_pk_bf16_f32 v135, v150, v151
  v_cvt_pk_bf16_f32 v136, v136, v137
  v_mfma_f32_16x16x32_bf16 v[68:71], a[160:163], a[80:83], 0
  v_exp_f32 v138, v138
  v_mfma_f32_16x16x32_bf16 v[68:71], a[156:159], a[76:79], v[68:71]
  v_mfma_f32_16x16x32_bf16 v[68:71], a[152:155], a[72:75], v[68:71]
  v_exp_f32 v139, v139
  v_mfma_f32_16x16x32_bf16 v[68:71], a[148:151], a[68:71], v[68:71]
  v_cvt_pk_bf16_f32 v137, v138, v139
  v_mfma_f32_16x16x32_bf16 v[72:75], a[148:151], a[84:87], 0
  v_exp_f32 v152, v152
  v_mfma_f32_16x16x32_bf16 v[72:75], a[152:155], a[88:91], v[72:75]
  v_mfma_f32_16x16x32_bf16 v[72:75], a[156:159], a[92:95], v[72:75]
  v_exp_f32 v153, v153
  v_mfma_f32_16x16x32_bf16 v[72:75], a[160:163], a[96:99], v[72:75]
  v_cvt_pk_bf16_f32 v138, v152, v153
  v_mfma_f32_16x16x32_bf16 v[76:79], a[160:163], a[112:115], 0
  v_exp_f32 v154, v154
  v_mfma_f32_16x16x32_bf16 v[76:79], a[156:159], a[108:111], v[76:79]
  s_waitcnt vmcnt(16) lgkmcnt(0)
  s_barrier
  ds_read_b128 a[116:119], v3 offset:32768
  ds_read_b128 a[120:123], v3 offset:40960
  ds_read_b128 a[124:127], v3 offset:33792
  ds_read_b128 a[128:131], v3 offset:41984
  v_mfma_f32_16x16x32_bf16 v[76:79], a[152:155], a[104:107], v[76:79]
  v_exp_f32 v155, v155
  v_mfma_f32_16x16x32_bf16 v[76:79], a[148:151], a[100:103], v[76:79]
  v_cvt_pk_bf16_f32 v139, v154, v155
  v_mfma_f32_16x16x32_bf16 v[80:83], a[164:167], a[52:55], 0
  v_exp_f32 v140, v140
  v_mfma_f32_16x16x32_bf16 v[80:83], a[168:171], a[56:59], v[80:83]
  ds_read_b128 a[132:135], v3 offset:34816
  ds_read_b128 a[136:139], v3 offset:43008
  v_mfma_f32_16x16x32_bf16 v[80:83], a[172:175], a[60:63], v[80:83]
  v_exp_f32 v141, v141
  v_mfma_f32_16x16x32_bf16 v[80:83], a[176:179], a[64:67], v[80:83]
  v_cvt_pk_bf16_f32 v140, v140, v141
  v_mfma_f32_16x16x32_bf16 v[84:87], a[176:179], a[80:83], 0
  v_exp_f32 v142, v142
  v_mfma_f32_16x16x32_bf16 v[84:87], a[172:175], a[76:79], v[84:87]
  v_mfma_f32_16x16x32_bf16 v[84:87], a[168:171], a[72:75], v[84:87]
  v_exp_f32 v143, v143
  v_mfma_f32_16x16x32_bf16 v[84:87], a[164:167], a[68:71], v[84:87]
  v_cvt_pk_bf16_f32 v141, v142, v143
  v_mfma_f32_16x16x32_bf16 v[88:91], a[164:167], a[84:87], 0
  v_exp_f32 v156, v156
  v_mfma_f32_16x16x32_bf16 v[88:91], a[168:171], a[88:91], v[88:91]
  ds_read_b128 a[140:143], v3 offset:35840
  ds_read_b128 a[144:147], v3 offset:44032
  v_mfma_f32_16x16x32_bf16 v[88:91], a[172:175], a[92:95], v[88:91]
  v_exp_f32 v157, v157
  v_mfma_f32_16x16x32_bf16 v[88:91], a[176:179], a[96:99], v[88:91]
  v_cvt_pk_bf16_f32 v142, v156, v157
  v_mfma_f32_16x16x32_bf16 v[92:95], a[176:179], a[112:115], 0
  v_exp_f32 v158, v158
  v_mfma_f32_16x16x32_bf16 v[92:95], a[172:175], a[108:111], v[92:95]
  v_mfma_f32_16x16x32_bf16 v[92:95], a[168:171], a[104:107], v[92:95]
  v_exp_f32 v159, v159
  v_mfma_f32_16x16x32_bf16 v[92:95], a[164:167], a[100:103], v[92:95]
  v_cvt_pk_bf16_f32 v143, v158, v159
  s_waitcnt lgkmcnt(6)
  s_add_u32 m0, s29, 65536
  v_mfma_f32_16x16x32_bf16 v[160:163], a[116:119], v[96:99], v[160:163]
  v_exp_f32 v32, v32
  v_mfma_f32_16x16x32_bf16 v[160:163], a[120:123], v[128:131], v[160:163]
  ds_read_b128 a[148:151], v3 offset:36864
  ds_read_b128 a[152:155], v3 offset:45056
  v_mfma_f32_16x16x32_bf16 v[164:167], a[120:123], v[132:135], v[164:167]
  v_exp_f32 v33, v33
  v_mfma_f32_16x16x32_bf16 v[164:167], a[116:119], v[100:103], v[164:167]
  buffer_load_dwordx4 v1, s[12:15], s25 offen offset:0 lds
  s_add_u32 s32, s25, 4096
  v_mfma_f32_16x16x32_bf16 v[168:171], a[116:119], v[104:107], v[168:171]
  v_exp_f32 v34, v34
  v_mfma_f32_16x16x32_bf16 v[168:171], a[120:123], v[136:139], v[168:171]
  v_cvt_pk_bf16_f32 v32, v32, v33
  v_mfma_f32_16x16x32_bf16 v[172:175], a[120:123], v[140:143], v[172:175]
  v_exp_f32 v35, v35
  v_mfma_f32_16x16x32_bf16 v[172:175], a[116:119], v[108:111], v[172:175]
  buffer_load_dwordx4 v1, s[12:15], s25 offen offset:1024 lds
  s_waitcnt lgkmcnt(6)
  v_mfma_f32_16x16x32_bf16 a[32:35], a[48:51], v[96:99], a[32:35]
  v_mfma_f32_16x16x32_bf16 a[32:35], a[48:51], v[128:131], a[32:35]
  v_mfma_f32_16x16x32_bf16 v[176:179], a[124:127], v[96:99], v[176:179]
  v_exp_f32 v48, v48
  v_mfma_f32_16x16x32_bf16 v[176:179], a[128:131], v[128:131], v[176:179]
  ds_read_b128 a[156:159], v3 offset:37888
  ds_read_b128 a[160:163], v3 offset:46080
  v_mfma_f32_16x16x32_bf16 v[180:183], a[128:131], v[132:135], v[180:183]
  v_exp_f32 v49, v49
  v_mfma_f32_16x16x32_bf16 v[180:183], a[124:127], v[100:103], v[180:183]
  buffer_load_dwordx4 v1, s[12:15], s25 offen offset:2048 lds
  v_mfma_f32_16x16x32_bf16 v[184:187], a[124:127], v[104:107], v[184:187]
  v_exp_f32 v50, v50
  v_mfma_f32_16x16x32_bf16 v[184:187], a[128:131], v[136:139], v[184:187]
  v_cvt_pk_bf16_f32 v33, v34, v35
  v_cvt_pk_bf16_f32 v34, v48, v49
  v_mfma_f32_16x16x32_bf16 v[188:191], a[128:131], v[140:143], v[188:191]
  v_exp_f32 v51, v51
  v_mfma_f32_16x16x32_bf16 v[188:191], a[124:127], v[108:111], v[188:191]
  buffer_load_dwordx4 v1, s[12:15], s25 offen offset:3072 lds
  s_add_u32 m0, s29, 69632
  s_waitcnt lgkmcnt(6)
  v_mfma_f32_16x16x32_bf16 a[36:39], a[48:51], v[100:103], a[36:39]
  v_mfma_f32_16x16x32_bf16 a[36:39], a[48:51], v[132:135], a[36:39]
  v_mfma_f32_16x16x32_bf16 v[192:195], a[132:135], v[96:99], v[192:195]
  v_exp_f32 v36, v36
  v_mfma_f32_16x16x32_bf16 v[192:195], a[136:139], v[128:131], v[192:195]
  ds_read_b128 a[164:167], v3 offset:38912
  ds_read_b128 a[168:171], v3 offset:47104
  v_mfma_f32_16x16x32_bf16 v[196:199], a[136:139], v[132:135], v[196:199]
  v_exp_f32 v37, v37
  v_mfma_f32_16x16x32_bf16 v[196:199], a[132:135], v[100:103], v[196:199]
  buffer_load_dwordx4 v1, s[12:15], s32 offen offset:0 lds
  v_mfma_f32_16x16x32_bf16 v[200:203], a[132:135], v[104:107], v[200:203]
  v_exp_f32 v38, v38
  v_mfma_f32_16x16x32_bf16 v[200:203], a[136:139], v[136:139], v[200:203]
  v_cvt_pk_bf16_f32 v35, v50, v51
  v_cvt_pk_bf16_f32 v36, v36, v37
  v_mfma_f32_16x16x32_bf16 v[204:207], a[136:139], v[140:143], v[204:207]
  v_exp_f32 v39, v39
  v_mfma_f32_16x16x32_bf16 v[204:207], a[132:135], v[108:111], v[204:207]
  buffer_load_dwordx4 v1, s[12:15], s32 offen offset:1024 lds
  s_waitcnt lgkmcnt(6)
  v_mfma_f32_16x16x32_bf16 a[40:43], a[48:51], v[104:107], a[40:43]
  v_mfma_f32_16x16x32_bf16 a[40:43], a[48:51], v[136:139], a[40:43]
  v_mfma_f32_16x16x32_bf16 v[208:211], a[140:143], v[96:99], v[208:211]
  v_exp_f32 v52, v52
  v_mfma_f32_16x16x32_bf16 v[208:211], a[144:147], v[128:131], v[208:211]
  ds_read_b128 a[172:175], v3 offset:39936
  ds_read_b128 a[176:179], v3 offset:48128
  v_mfma_f32_16x16x32_bf16 v[212:215], a[144:147], v[132:135], v[212:215]
  v_exp_f32 v53, v53
  v_mfma_f32_16x16x32_bf16 v[212:215], a[140:143], v[100:103], v[212:215]
  buffer_load_dwordx4 v1, s[12:15], s32 offen offset:2048 lds
  v_mfma_f32_16x16x32_bf16 v[216:219], a[140:143], v[104:107], v[216:219]
  v_exp_f32 v54, v54
  v_mfma_f32_16x16x32_bf16 v[216:219], a[144:147], v[136:139], v[216:219]
  v_cvt_pk_bf16_f32 v37, v38, v39
  v_cvt_pk_bf16_f32 v38, v52, v53
  v_mfma_f32_16x16x32_bf16 v[220:223], a[144:147], v[140:143], v[220:223]
  v_exp_f32 v55, v55
  v_mfma_f32_16x16x32_bf16 v[220:223], a[140:143], v[108:111], v[220:223]
  buffer_load_dwordx4 v1, s[12:15], s32 offen offset:3072 lds
  s_waitcnt lgkmcnt(6)
  v_mfma_f32_16x16x32_bf16 a[44:47], a[48:51], v[108:111], a[44:47]
  v_mfma_f32_16x16x32_bf16 a[44:47], a[48:51], v[140:143], a[44:47]
  v_mfma_f32_16x16x32_bf16 v[224:227], a[148:151], v[96:99], v[224:227]
  v_exp_f32 v40, v40
  v_mfma_f32_16x16x32_bf16 v[224:227], a[152:155], v[128:131], v[224:227]
  s_add_u32 s25, s25, 32768
  s_cmp_eq_u32 s25, s27
  s_cselect_b32 s25, s28, s25
  s_cselect_b32 s27, -1, s27
  v_mfma_f32_16x16x32_bf16 v[228:231], a[152:155], v[132:135], v[228:231]
  v_exp_f32 v41, v41
  v_mfma_f32_16x16x32_bf16 v[228:231], a[148:151], v[100:103], v[228:231]
  v_cvt_pk_bf16_f32 v39, v54, v55
  v_cvt_pk_bf16_f32 v40, v40, v41
  v_mfma_f32_16x16x32_bf16 v[232:235], a[148:151], v[104:107], v[232:235]
  v_exp_f32 v42, v42
  v_mfma_f32_16x16x32_bf16 v[232:235], a[152:155], v[136:139], v[232:235]
  v_mfma_f32_16x16x32_bf16 v[236:239], a[152:155], v[140:143], v[236:239]
  v_exp_f32 v43, v43
  v_mfma_f32_16x16x32_bf16 v[236:239], a[148:151], v[108:111], v[236:239]
  v_cvt_pk_bf16_f32 v41, v42, v43
  s_waitcnt lgkmcnt(4)
  v_mfma_f32_16x16x32_bf16 v[240:243], a[156:159], v[96:99], v[240:243]
  v_exp_f32 v56, v56
  v_mfma_f32_16x16x32_bf16 v[240:243], a[160:163], v[128:131], v[240:243]
  v_mfma_f32_16x16x32_bf16 v[244:247], a[160:163], v[132:135], v[244:247]
  v_exp_f32 v57, v57
  v_mfma_f32_16x16x32_bf16 v[244:247], a[156:159], v[100:103], v[244:247]
  v_cvt_pk_bf16_f32 v42, v56, v57
  v_mfma_f32_16x16x32_bf16 v[248:251], a[156:159], v[104:107], v[248:251]
  v_exp_f32 v58, v58
  v_mfma_f32_16x16x32_bf16 v[248:251], a[160:163], v[136:139], v[248:251]
  s_waitcnt vmcnt(16) lgkmcnt(0)
  s_barrier
  ds_read_b128 a[116:119], v2 offset:0
  ds_read_b128 a[120:123], v2 offset:1024
  ds_read_b128 a[124:127], v2 offset:2048
  ds_read_b128 a[128:131], v2 offset:3072
  v_mfma_f32_16x16x32_bf16 v[252:255], a[160:163], v[140:143], v[252:255]
  v_exp_f32 v59, v59
  v_mfma_f32_16x16x32_bf16 v[252:255], a[156:159], v[108:111], v[252:255]
  v_cvt_pk_bf16_f32 v43, v58, v59
  v_mfma_f32_16x16x32_bf16 a[0:3], a[164:167], v[96:99], a[0:3]
  v_exp_f32 v44, v44
  v_mfma_f32_16x16x32_bf16 a[0:3], a[168:171], v[128:131], a[0:3]
  ds_read_b128 a[132:135], v2 offset:4096
  ds_read_b128 a[136:139], v2 offset:5120
  v_mfma_f32_16x16x32_bf16 a[4:7], a[168:171], v[132:135], a[4:7]
  v_exp_f32 v45, v45
  v_mfma_f32_16x16x32_bf16 a[4:7], a[164:167], v[100:103], a[4:7]
  v_cvt_pk_bf16_f32 v44, v44, v45
  v_mfma_f32_16x16x32_bf16 a[8:11], a[164:167], v[104:107], a[8:11]
  v_exp_f32 v46, v46
  v_mfma_f32_16x16x32_bf16 a[8:11], a[168:171], v[136:139], a[8:11]
  v_mfma_f32_16x16x32_bf16 a[12:15], a[168:171], v[140:143], a[12:15]
  v_exp_f32 v47, v47
  v_mfma_f32_16x16x32_bf16 a[12:15], a[164:167], v[108:111], a[12:15]
  v_cvt_pk_bf16_f32 v45, v46, v47
  v_mfma_f32_16x16x32_bf16 a[16:19], a[172:175], v[96:99], a[16:19]
  v_exp_f32 v60, v60
  v_mfma_f32_16x16x32_bf16 a[16:19], a[176:179], v[128:131], a[16:19]
  ds_read_b128 a[140:143], v2 offset:6144
  ds_read_b128 a[144:147], v2 offset:7168
  v_mfma_f32_16x16x32_bf16 a[20:23], a[176:179], v[132:135], a[20:23]
  v_exp_f32 v61, v61
  v_mfma_f32_16x16x32_bf16 a[20:23], a[172:175], v[100:103], a[20:23]
  v_cvt_pk_bf16_f32 v46, v60, v61
  v_mfma_f32_16x16x32_bf16 a[24:27], a[172:175], v[104:107], a[24:27]
  v_exp_f32 v62, v62
  v_mfma_f32_16x16x32_bf16 a[24:27], a[176:179], v[136:139], a[24:27]
  v_mfma_f32_16x16x32_bf16 a[28:31], a[176:179], v[140:143], a[28:31]
  v_exp_f32 v63, v63
  v_mfma_f32_16x16x32_bf16 a[28:31], a[172:175], v[108:111], a[28:31]
  v_cvt_pk_bf16_f32 v47, v62, v63
  s_sub_u32 s30, s30, 1
  s_cmp_lg_u32 s30, 0
  s_cbranch_scc1 Lk2_l3
  s_lshl_b32 s33, s23, 6
  s_add_i32 s33, s33, 0
  s_cmp_gt_i32 s33, 0
  s_cselect_b32 s34, 0, 0xf149f2ca
  s_cmp_lt_i32 s33, 0
  s_cselect_b32 s33, 0xf149f2ca, 0
  v_mov_b32 v20, s34
  v_mov_b32 v21, s34
  v_mov_b32 v22, s34
  v_mov_b32 v23, s34
  v_mov_b32 v28, s33
  v_mov_b32 v29, s33
  v_mov_b32 v30, s33
  v_mov_b32 v31, s33
  v_med3_f32 v24, v16, v20, v28
  v_med3_f32 v25, v17, v20, v28
  v_med3_f32 v26, v18, v20, v28
  v_med3_f32 v27, v19, v20, v28
  s_waitcnt lgkmcnt(4)
  s_add_u32 m0, s29, 98304
  v_mfma_f32_16x16x32_bf16 v[96:99], a[116:119], a[52:55], v[24:27]
  v_exp_f32 v64, v64
  v_mfma_f32_16x16x32_bf16 v[96:99], a[120:123], a[56:59], v[96:99]
  ds_read_b128 a[148:151], v2 offset:8192
  ds_read_b128 a[152:155], v2 offset:9216
  v_mfma_f32_16x16x32_bf16 v[96:99], a[124:127], a[60:63], v[96:99]
  v_exp_f32 v65, v65
  v_mfma_f32_16x16x32_bf16 v[96:99], a[128:131], a[64:67], v[96:99]
  buffer_load_dwordx4 v1, s[12:15], s26 offen offset:0 lds
  s_add_u32 s32, s26, 4096
  v_mfma_f32_16x16x32_bf16 v[100:103], a[128:131], a[80:83], v[28:31]
  v_exp_f32 v66, v66
  v_mfma_f32_16x16x32_bf16 v[100:103], a[124:127], a[76:79], v[100:103]
  v_cvt_pk_bf16_f32 v64, v64, v65
  v_mfma_f32_16x16x32_bf16 v[100:103], a[120:123], a[72:75], v[100:103]
  v_exp_f32 v67, v67
  v_mfma_f32_16x16x32_bf16 v[100:103], a[116:119], a[68:71], v[100:103]
  buffer_load_dwordx4 v1, s[12:15], s26 offen offset:1024 lds
  v_mfma_f32_16x16x32_bf16 v[104:107], a[116:119], a[84:87], v[28:31]
  v_exp_f32 v80, v80
  v_mfma_f32_16x16x32_bf16 v[104:107], a[120:123], a[88:91], v[104:107]
  ds_read_b128 a[156:159], v2 offset:10240
  ds_read_b128 a[160:163], v2 offset:11264
  v_mfma_f32_16x16x32_bf16 v[104:107], a[124:127], a[92:95], v[104:107]
  v_exp_f32 v81, v81
  v_mfma_f32_16x16x32_bf16 v[104:107], a[128:131], a[96:99], v[104:107]
  buffer_load_dwordx4 v1, s[12:15], s26 offen offset:2048 lds
  v_mfma_f32_16x16x32_bf16 v[108:111], a[128:131], a[112:115], v[28:31]
  v_exp_f32 v82, v82
  v_mfma_f32_16x16x32_bf16 v[108:111], a[124:127], a[108:111], v[108:111]
  v_cvt_pk_bf16_f32 v65, v66, v67
  v_cvt_pk_bf16_f32 v66, v80, v81
  v_mfma_f32_16x16x32_bf16 v[108:111], a[120:123], a[104:107], v[108:111]
  v_exp_f32 v83, v83
  v_mfma_f32_16x16x32_bf16 v[108:111], a[116:119], a[100:103], v[108:111]
  buffer_load_dwordx4 v1, s[12:15], s26 offen offset:3072 lds
  s_add_u32 m0, s29, 102400
  s_waitcnt lgkmcnt(4)
  v_mfma_f32_16x16x32_bf16 v[112:115], a[132:135], a[52:55], v[20:23]
  v_exp_f32 v68, v68
  v_mfma_f32_16x16x32_bf16 v[112:115], a[136:139], a[56:59], v[112:115]
  ds_read_b128 a[164:167], v2 offset:12288
  ds_read_b128 a[168:171], v2 offset:13312
  v_mfma_f32_16x16x32_bf16 v[112:115], a[140:143], a[60:63], v[112:115]
  v_exp_f32 v69, v69
  v_mfma_f32_16x16x32_bf16 v[112:115], a[144:147], a[64:67], v[112:115]
  buffer_load_dwordx4 v1, s[12:15], s32 offen offset:0 lds
  v_mfma_f32_16x16x32_bf16 v[116:119], a[144:147], a[80:83], v[24:27]
  v_exp_f32 v70, v70
  v_mfma_f32_16x16x32_bf16 v[116:119], a[140:143], a[76:79], v[116:119]
  v_cvt_pk_bf16_f32 v67, v82, v83
  v_cvt_pk_bf16_f32 v68, v68, v69
  v_mfma_f32_16x16x32_bf16 v[116:119], a[136:139], a[72:75], v[116:119]
  v_exp_f32 v71, v71
  v_mfma_f32_16x16x32_bf16 v[116:119], a[132:135], a[68:71], v[116:119]
  buffer_load_dwordx4 v1, s[12:15], s32 offen offset:1024 lds
  v_mfma_f32_16x16x32_bf16 v[120:123], a[132:135], a[84:87], v[28:31]
  v_exp_f32 v84, v84
  v_mfma_f32_16x16x32_bf16 v[120:123], a[136:139], a[88:91], v[120:123]
  ds_read_b128 a[172:175], v2 offset:14336
  ds_read_b128 a[176:179], v2 offset:15360
  v_mfma_f32_16x16x32_bf16 v[120:123], a[140:143], a[92:95], v[120:123]
  v_exp_f32 v85, v85
  v_mfma_f32_16x16x32_bf16 v[120:123], a[144:147], a[96:99], v[120:123]
  buffer_load_dwordx4 v1, s[12:15], s32 offen offset:2048 lds
  v_mfma_f32_16x16x32_bf16 v[124:127], a[144:147], a[112:115], v[28:31]
  v_exp_f32 v86, v86
  v_mfma_f32_16x16x32_bf16 v[124:127], a[140:143], a[108:111], v[124:127]
  v_cvt_pk_bf16_f32 v69, v70, v71
  v_cvt_pk_bf16_f32 v70, v84, v85
  v_mfma_f32_16x16x32_bf16 v[124:127], a[136:139], a[104:107], v[124:127]
  v_exp_f32 v87, v87
  v_mfma_f32_16x16x32_bf16 v[124:127], a[132:135], a[100:103], v[124:127]
  buffer_load_dwordx4 v1, s[12:15], s32 offen offset:3072 lds
  s_waitcnt lgkmcnt(4)
  v_mfma_f32_16x16x32_bf16 v[128:131], a[148:151], a[52:55], v[20:23]
  v_exp_f32 v72, v72
  v_mfma_f32_16x16x32_bf16 v[128:131], a[152:155], a[56:59], v[128:131]
  s_add_u32 s26, s26, 32768
  s_cmp_eq_u32 s26, s62
  s_cselect_b32 s26, s63, s26
  s_cselect_b32 s62, -1, s62
  v_mfma_f32_16x16x32_bf16 v[128:131], a[156:159], a[60:63], v[128:131]
  v_exp_f32 v73, v73
  v_mfma_f32_16x16x32_bf16 v[128:131], a[160:163], a[64:67], v[128:131]
  v_cvt_pk_bf16_f32 v71, v86, v87
  v_cvt_pk_bf16_f32 v72, v72, v73
  v_mfma_f32_16x16x32_bf16 v[132:135], a[160:163], a[80:83], v[20:23]
  v_exp_f32 v74, v74
  v_mfma_f32_16x16x32_bf16 v[132:135], a[156:159], a[76:79], v[132:135]
  v_mfma_f32_16x16x32_bf16 v[132:135], a[152:155], a[72:75], v[132:135]
  v_exp_f32 v75, v75
  v_mfma_f32_16x16x32_bf16 v[132:135], a[148:151], a[68:71], v[132:135]
  v_cvt_pk_bf16_f32 v73, v74, v75
  v_mfma_f32_16x16x32_bf16 v[136:139], a[148:151], a[84:87], v[24:27]
  v_exp_f32 v88, v88
  v_mfma_f32_16x16x32_bf16 v[136:139], a[152:155], a[88:91], v[136:139]
  v_mfma_f32_16x16x32_bf16 v[136:139], a[156:159], a[92:95], v[136:139]
  v_exp_f32 v89, v89
  v_mfma_f32_16x16x32_bf16 v[136:139], a[160:163], a[96:99], v[136:139]
  v_cvt_pk_bf16_f32 v74, v88, v89
  v_mfma_f32_16x16x32_bf16 v[140:143], a[160:163], a[112:115], v[28:31]
  v_exp_f32 v90, v90
  v_mfma_f32_16x16x32_bf16 v[140:143], a[156:159], a[108:111], v[140:143]
  s_waitcnt vmcnt(16) lgkmcnt(0)
  s_barrier
  ds_read_b128 a[116:119], v2 offset:32768
  ds_read_b128 a[120:123], v2 offset:40960
  ds_read_b128 a[124:127], v2 offset:33792
  ds_read_b128 a[128:131], v2 offset:41984
  v_mfma_f32_16x16x32_bf16 v[140:143], a[152:155], a[104:107], v[140:143]
  v_exp_f32 v91, v91
  v_mfma_f32_16x16x32_bf16 v[140:143], a[148:151], a[100:103], v[140:143]
  v_cvt_pk_bf16_f32 v75, v90, v91
  v_mfma_f32_16x16x32_bf16 v[144:147], a[164:167], a[52:55], v[20:23]
  v_exp_f32 v76, v76
  v_mfma_f32_16x16x32_bf16 v[144:147], a[168:171], a[56:59], v[144:147]
  ds_read_b128 a[132:135], v2 offset:34816
  ds_read_b128 a[136:139], v2 offset:43008
  v_mfma_f32_16x16x32_bf16 v[144:147], a[172:175], a[60:63], v[144:147]
  v_exp_f32 v77, v77
  v_mfma_f32_16x16x32_bf16 v[144:147], a[176:179], a[64:67], v[144:147]
  v_cvt_pk_bf16_f32 v76, v76, v77
  v_mfma_f32_16x16x32_bf16 v[148:151], a[176:179], a[80:83], v[20:23]
  v_exp_f32 v78, v78
  v_mfma_f32_16x16x32_bf16 v[148:151], a[172:175], a[76:79], v[148:151]
  v_mfma_f32_16x16x32_bf16 v[148:151], a[168:171], a[72:75], v[148:151]
  v_exp_f32 v79, v79
  v_mfma_f32_16x16x32_bf16 v[148:151], a[164:167], a[68:71], v[148:151]
  v_cvt_pk_bf16_f32 v77, v78, v79
  v_mfma_f32_16x16x32_bf16 v[152:155], a[164:167], a[84:87], v[20:23]
  v_exp_f32 v92, v92
  v_mfma_f32_16x16x32_bf16 v[152:155], a[168:171], a[88:91], v[152:155]
  ds_read_b128 a[140:143], v2 offset:35840
  ds_read_b128 a[144:147], v2 offset:44032
  v_mfma_f32_16x16x32_bf16 v[152:155], a[172:175], a[92:95], v[152:155]
  v_exp_f32 v93, v93
  v_mfma_f32_16x16x32_bf16 v[152:155], a[176:179], a[96:99], v[152:155]
  v_cvt_pk_bf16_f32 v78, v92, v93
  v_mfma_f32_16x16x32_bf16 v[156:159], a[176:179], a[112:115], v[24:27]
  v_exp_f32 v94, v94
  v_mfma_f32_16x16x32_bf16 v[156:159], a[172:175], a[108:111], v[156:159]
  v_mfma_f32_16x16x32_bf16 v[156:159], a[168:171], a[104:107], v[156:159]
  v_exp_f32 v95, v95
  v_mfma_f32_16x16x32_bf16 v[156:159], a[164:167], a[100:103], v[156:159]
  v_cvt_pk_bf16_f32 v79, v94, v95
  s_waitcnt lgkmcnt(6)
  s_add_u32 m0, s29, 0
  v_mfma_f32_16x16x32_bf16 v[160:163], a[116:119], v[32:35], v[160:163]
  v_exp_f32 v96, v96
  v_mfma_f32_16x16x32_bf16 v[160:163], a[120:123], v[64:67], v[160:163]
  ds_read_b128 a[148:151], v2 offset:36864
  ds_read_b128 a[152:155], v2 offset:45056
  v_mfma_f32_16x16x32_bf16 v[164:167], a[120:123], v[68:71], v[164:167]
  v_exp_f32 v97, v97
  v_mfma_f32_16x16x32_bf16 v[164:167], a[116:119], v[36:39], v[164:167]
  buffer_load_dwordx4 v1, s[12:15], s25 offen offset:0 lds
  s_add_u32 s32, s25, 4096
  v_mfma_f32_16x16x32_bf16 v[168:171], a[116:119], v[40:43], v[168:171]
  v_exp_f32 v98, v98
  v_mfma_f32_16x16x32_bf16 v[168:171], a[120:123], v[72:75], v[168:171]
  v_cvt_pk_bf16_f32 v96, v96, v97
  v_mfma_f32_16x16x32_bf16 v[172:175], a[120:123], v[76:79], v[172:175]
  v_exp_f32 v99, v99
  v_mfma_f32_16x16x32_bf16 v[172:175], a[116:119], v[44:47], v[172:175]
  buffer_load_dwordx4 v1, s[12:15], s25 offen offset:1024 lds
  s_waitcnt lgkmcnt(6)
  v_mfma_f32_16x16x32_bf16 a[32:35], a[48:51], v[32:35], a[32:35]
  v_mfma_f32_16x16x32_bf16 a[32:35], a[48:51], v[64:67], a[32:35]
  v_mfma_f32_16x16x32_bf16 v[176:179], a[124:127], v[32:35], v[176:179]
  v_exp_f32 v112, v112
  v_mfma_f32_16x16x32_bf16 v[176:179], a[128:131], v[64:67], v[176:179]
  ds_read_b128 a[156:159], v2 offset:37888
  ds_read_b128 a[160:163], v2 offset:46080
  v_mfma_f32_16x16x32_bf16 v[180:183], a[128:131], v[68:71], v[180:183]
  v_exp_f32 v113, v113
  v_mfma_f32_16x16x32_bf16 v[180:183], a[124:127], v[36:39], v[180:183]
  buffer_load_dwordx4 v1, s[12:15], s25 offen offset:2048 lds
  v_mfma_f32_16x16x32_bf16 v[184:187], a[124:127], v[40:43], v[184:187]
  v_exp_f32 v114, v114
  v_mfma_f32_16x16x32_bf16 v[184:187], a[128:131], v[72:75], v[184:187]
  v_cvt_pk_bf16_f32 v97, v98, v99
  v_cvt_pk_bf16_f32 v98, v112, v113
  v_mfma_f32_16x16x32_bf16 v[188:191], a[128:131], v[76:79], v[188:191]
  v_exp_f32 v115, v115
  v_mfma_f32_16x16x32_bf16 v[188:191], a[124:127], v[44:47], v[188:191]
  buffer_load_dwordx4 v1, s[12:15], s25 offen offset:3072 lds
  s_add_u32 m0, s29, 4096
  s_waitcnt lgkmcnt(6)
  v_mfma_f32_16x16x32_bf16 a[36:39], a[48:51], v[36:39], a[36:39]
  v_mfma_f32_16x16x32_bf16 a[36:39], a[48:51], v[68:71], a[36:39]
  v_mfma_f32_16x16x32_bf16 v[192:195], a[132:135], v[32:35], v[192:195]
  v_exp_f32 v100, v100
  v_mfma_f32_16x16x32_bf16 v[192:195], a[136:139], v[64:67], v[192:195]
  ds_read_b128 a[164:167], v2 offset:38912
  ds_read_b128 a[168:171], v2 offset:47104
  v_mfma_f32_16x16x32_bf16 v[196:199], a[136:139], v[68:71], v[196:199]
  v_exp_f32 v101, v101
  v_mfma_f32_16x16x32_bf16 v[196:199], a[132:135], v[36:39], v[196:199]
  buffer_load_dwordx4 v1, s[12:15], s32 offen offset:0 lds
  v_mfma_f32_16x16x32_bf16 v[200:203], a[132:135], v[40:43], v[200:203]
  v_exp_f32 v102, v102
  v_mfma_f32_16x16x32_bf16 v[200:203], a[136:139], v[72:75], v[200:203]
  v_cvt_pk_bf16_f32 v99, v114, v115
  v_cvt_pk_bf16_f32 v100, v100, v101
  v_mfma_f32_16x16x32_bf16 v[204:207], a[136:139], v[76:79], v[204:207]
  v_exp_f32 v103, v103
  v_mfma_f32_16x16x32_bf16 v[204:207], a[132:135], v[44:47], v[204:207]
  buffer_load_dwordx4 v1, s[12:15], s32 offen offset:1024 lds
  s_waitcnt lgkmcnt(6)
  v_mfma_f32_16x16x32_bf16 a[40:43], a[48:51], v[40:43], a[40:43]
  v_mfma_f32_16x16x32_bf16 a[40:43], a[48:51], v[72:75], a[40:43]
  v_mfma_f32_16x16x32_bf16 v[208:211], a[140:143], v[32:35], v[208:211]
  v_exp_f32 v116, v116
  v_mfma_f32_16x16x32_bf16 v[208:211], a[144:147], v[64:67], v[208:211]
  ds_read_b128 a[172:175], v2 offset:39936
  ds_read_b128 a[176:179], v2 offset:48128
  v_mfma_f32_16x16x32_bf16 v[212:215], a[144:147], v[68:71], v[212:215]
  v_exp_f32 v117, v117
  v_mfma_f32_16x16x32_bf16 v[212:215], a[140:143], v[36:39], v[212:215]
  buffer_load_dwordx4 v1, s[12:15], s32 offen offset:2048 lds
  v_mfma_f32_16x16x32_bf16 v[216:219], a[140:143], v[40:43], v[216:219]
  v_exp_f32 v118, v118
  v_mfma_f32_16x16x32_bf16 v[216:219], a[144:147], v[72:75], v[216:219]
  v_cvt_pk_bf16_f32 v101, v102, v103
  v_cvt_pk_bf16_f32 v102, v116, v117
  v_mfma_f32_16x16x32_bf16 v[220:223], a[144:147], v[76:79], v[220:223]
  v_exp_f32 v119, v119
  v_mfma_f32_16x16x32_bf16 v[220:223], a[140:143], v[44:47], v[220:223]
  buffer_load_dwordx4 v1, s[12:15], s32 offen offset:3072 lds
  s_waitcnt lgkmcnt(6)
  v_mfma_f32_16x16x32_bf16 a[44:47], a[48:51], v[44:47], a[44:47]
  v_mfma_f32_16x16x32_bf16 a[44:47], a[48:51], v[76:79], a[44:47]
  v_mfma_f32_16x16x32_bf16 v[224:227], a[148:151], v[32:35], v[224:227]
  v_exp_f32 v104, v104
  v_mfma_f32_16x16x32_bf16 v[224:227], a[152:155], v[64:67], v[224:227]
  s_add_u32 s25, s25, 32768
  s_cmp_eq_u32 s25, s27
  s_cselect_b32 s25, s28, s25
  s_cselect_b32 s27, -1, s27
  v_mfma_f32_16x16x32_bf16 v[228:231], a[152:155], v[68:71], v[228:231]
  v_exp_f32 v105, v105
  v_mfma_f32_16x16x32_bf16 v[228:231], a[148:151], v[36:39], v[228:231]
  v_cvt_pk_bf16_f32 v103, v118, v119
  v_cvt_pk_bf16_f32 v104, v104, v105
  v_mfma_f32_16x16x32_bf16 v[232:235], a[148:151], v[40:43], v[232:235]
  v_exp_f32 v106, v106
  v_mfma_f32_16x16x32_bf16 v[232:235], a[152:155], v[72:75], v[232:235]
  v_mfma_f32_16x16x32_bf16 v[236:239], a[152:155], v[76:79], v[236:239]
  v_exp_f32 v107, v107
  v_mfma_f32_16x16x32_bf16 v[236:239], a[148:151], v[44:47], v[236:239]
  v_cvt_pk_bf16_f32 v105, v106, v107
  s_waitcnt lgkmcnt(4)
  v_mfma_f32_16x16x32_bf16 v[240:243], a[156:159], v[32:35], v[240:243]
  v_exp_f32 v120, v120
  v_mfma_f32_16x16x32_bf16 v[240:243], a[160:163], v[64:67], v[240:243]
  v_mfma_f32_16x16x32_bf16 v[244:247], a[160:163], v[68:71], v[244:247]
  v_exp_f32 v121, v121
  v_mfma_f32_16x16x32_bf16 v[244:247], a[156:159], v[36:39], v[244:247]
  v_cvt_pk_bf16_f32 v106, v120, v121
  v_mfma_f32_16x16x32_bf16 v[248:251], a[156:159], v[40:43], v[248:251]
  v_exp_f32 v122, v122
  v_mfma_f32_16x16x32_bf16 v[248:251], a[160:163], v[72:75], v[248:251]
  s_waitcnt vmcnt(16) lgkmcnt(0)
  s_barrier
  ds_read_b128 a[116:119], v3 offset:0
  ds_read_b128 a[120:123], v3 offset:1024
  ds_read_b128 a[124:127], v3 offset:2048
  ds_read_b128 a[128:131], v3 offset:3072
  v_mfma_f32_16x16x32_bf16 v[252:255], a[160:163], v[76:79], v[252:255]
  v_exp_f32 v123, v123
  v_mfma_f32_16x16x32_bf16 v[252:255], a[156:159], v[44:47], v[252:255]
  v_cvt_pk_bf16_f32 v107, v122, v123
  v_mfma_f32_16x16x32_bf16 a[0:3], a[164:167], v[32:35], a[0:3]
  v_exp_f32 v108, v108
  v_mfma_f32_16x16x32_bf16 a[0:3], a[168:171], v[64:67], a[0:3]
  ds_read_b128 a[132:135], v3 offset:4096
  ds_read_b128 a[136:139], v3 offset:5120
  v_mfma_f32_16x16x32_bf16 a[4:7], a[168:171], v[68:71], a[4:7]
  v_exp_f32 v109, v109
  v_mfma_f32_16x16x32_bf16 a[4:7], a[164:167], v[36:39], a[4:7]
  v_cvt_pk_bf16_f32 v108, v108, v109
  v_mfma_f32_16x16x32_bf16 a[8:11], a[164:167], v[40:43], a[8:11]
  v_exp_f32 v110, v110
  v_mfma_f32_16x16x32_bf16 a[8:11], a[168:171], v[72:75], a[8:11]
  v_mfma_f32_16x16x32_bf16 a[12:15], a[168:171], v[76:79], a[12:15]
  v_exp_f32 v111, v111
  v_mfma_f32_16x16x32_bf16 a[12:15], a[164:167], v[44:47], a[12:15]
  v_cvt_pk_bf16_f32 v109, v110, v111
  v_mfma_f32_16x16x32_bf16 a[16:19], a[172:175], v[32:35], a[16:19]
  v_exp_f32 v124, v124
  v_mfma_f32_16x16x32_bf16 a[16:19], a[176:179], v[64:67], a[16:19]
  ds_read_b128 a[140:143], v3 offset:6144
  ds_read_b128 a[144:147], v3 offset:7168
  v_mfma_f32_16x16x32_bf16 a[20:23], a[176:179], v[68:71], a[20:23]
  v_exp_f32 v125, v125
  v_mfma_f32_16x16x32_bf16 a[20:23], a[172:175], v[36:39], a[20:23]
  v_cvt_pk_bf16_f32 v110, v124, v125
  v_mfma_f32_16x16x32_bf16 a[24:27], a[172:175], v[40:43], a[24:27]
  v_exp_f32 v126, v126
  v_mfma_f32_16x16x32_bf16 a[24:27], a[176:179], v[72:75], a[24:27]
  v_mfma_f32_16x16x32_bf16 a[28:31], a[176:179], v[76:79], a[28:31]
  v_exp_f32 v127, v127
  v_mfma_f32_16x16x32_bf16 a[28:31], a[172:175], v[44:47], a[28:31]
  v_cvt_pk_bf16_f32 v111, v126, v127
  s_lshl_b32 s33, s23, 6
  s_add_i32 s33, s33, -64
  s_cmp_gt_i32 s33, 0
  s_cselect_b32 s34, 0, 0xf149f2ca
  s_cmp_lt_i32 s33, 0
  s_cselect_b32 s33, 0xf149f2ca, 0
  v_mov_b32 v20, s34
  v_mov_b32 v21, s34
  v_mov_b32 v22, s34
  v_mov_b32 v23, s34
  v_mov_b32 v28, s33
  v_mov_b32 v29, s33
  v_mov_b32 v30, s33
  v_mov_b32 v31, s33
  v_med3_f32 v24, v16, v20, v28
  v_med3_f32 v25, v17, v20, v28
  v_med3_f32 v26, v18, v20, v28
  v_med3_f32 v27, v19, v20, v28
  s_waitcnt lgkmcnt(4)
  s_add_u32 m0, s29, 32768
  v_mfma_f32_16x16x32_bf16 v[32:35], a[116:119], a[52:55], v[24:27]
  v_exp_f32 v128, v128
  v_mfma_f32_16x16x32_bf16 v[32:35], a[120:123], a[56:59], v[32:35]
  ds_read_b128 a[148:151], v3 offset:8192
  ds_read_b128 a[152:155], v3 offset:9216
  v_mfma_f32_16x16x32_bf16 v[32:35], a[124:127], a[60:63], v[32:35]
  v_exp_f32 v129, v129
  v_mfma_f32_16x16x32_bf16 v[32:35], a[128:131], a[64:67], v[32:35]
  buffer_load_dwordx4 v1, s[12:15], s26 offen offset:0 lds
  s_add_u32 s32, s26, 4096
  v_mfma_f32_16x16x32_bf16 v[36:39], a[128:131], a[80:83], v[28:31]
  v_exp_f32 v130, v130
  v_mfma_f32_16x16x32_bf16 v[36:39], a[124:127], a[76:79], v[36:39]
  v_cvt_pk_bf16_f32 v128, v128, v129
  v_mfma_f32_16x16x32_bf16 v[36:39], a[120:123], a[72:75], v[36:39]
  v_exp_f32 v131, v131
  v_mfma_f32_16x16x32_bf16 v[36:39], a[116:119], a[68:71], v[36:39]
  buffer_load_dwordx4 v1, s[12:15], s26 offen offset:1024 lds
  v_mfma_f32_16x16x32_bf16 v[40:43], a[116:119], a[84:87], v[28:31]
  v_exp_f32 v144, v144
  v_mfma_f32_16x16x32_bf16 v[40:43], a[120:123], a[88:91], v[40:43]
  ds_read_b128 a[156:159], v3 offset:10240
  ds_read_b128 a[160:163], v3 offset:11264
  v_mfma_f32_16x16x32_bf16 v[40:43], a[124:127], a[92:95], v[40:43]
  v_exp_f32 v145, v145
  v_mfma_f32_16x16x32_bf16 v[40:43], a[128:131], a[96:99], v[40:43]
  buffer_load_dwordx4 v1, s[12:15], s26 offen offset:2048 lds
  v_mfma_f32_16x16x32_bf16 v[44:47], a[128:131], a[112:115], v[28:31]
  v_exp_f32 v146, v146
  v_mfma_f32_16x16x32_bf16 v[44:47], a[124:127], a[108:111], v[44:47]
  v_cvt_pk_bf16_f32 v129, v130, v131
  v_cvt_pk_bf16_f32 v130, v144, v145
  v_mfma_f32_16x16x32_bf16 v[44:47], a[120:123], a[104:107], v[44:47]
  v_exp_f32 v147, v147
  v_mfma_f32_16x16x32_bf16 v[44:47], a[116:119], a[100:103], v[44:47]
  buffer_load_dwordx4 v1, s[12:15], s26 offen offset:3072 lds
  s_add_u32 m0, s29, 36864
  s_waitcnt lgkmcnt(4)
  v_mfma_f32_16x16x32_bf16 v[48:51], a[132:135], a[52:55], v[20:23]
  v_exp_f32 v132, v132
  v_mfma_f32_16x16x32_bf16 v[48:51], a[136:139], a[56:59], v[48:51]
  ds_read_b128 a[164:167], v3 offset:12288
  ds_read_b128 a[168:171], v3 offset:13312
  v_mfma_f32_16x16x32_bf16 v[48:51], a[140:143], a[60:63], v[48:51]
  v_exp_f32 v133, v133
  v_mfma_f32_16x16x32_bf16 v[48:51], a[144:147], a[64:67], v[48:51]
  buffer_load_dwordx4 v1, s[12:15], s32 offen offset:0 lds
  v_mfma_f32_16x16x32_bf16 v[52:55], a[144:147], a[80:83], v[24:27]
  v_exp_f32 v134, v134
  v_mfma_f32_16x16x32_bf16 v[52:55], a[140:143], a[76:79], v[52:55]
  v_cvt_pk_bf16_f32 v131, v146, v147
  v_cvt_pk_bf16_f32 v132, v132, v133
  v_mfma_f32_16x16x32_bf16 v[52:55], a[136:139], a[72:75], v[52:55]
  v_exp_f32 v135, v135
  v_mfma_f32_16x16x32_bf16 v[52:55], a[132:135], a[68:71], v[52:55]
  buffer_load_dwordx4 v1, s[12:15], s32 offen offset:1024 lds
  v_mfma_f32_16x16x32_bf16 v[56:59], a[132:135], a[84:87], v[28:31]
  v_exp_f32 v148, v148
  v_mfma_f32_16x16x32_bf16 v[56:59], a[136:139], a[88:91], v[56:59]
  ds_read_b128 a[172:175], v3 offset:14336
  ds_read_b128 a[176:179], v3 offset:15360
  v_mfma_f32_16x16x32_bf16 v[56:59], a[140:143], a[92:95], v[56:59]
  v_exp_f32 v149, v149
  v_mfma_f32_16x16x32_bf16 v[56:59], a[144:147], a[96:99], v[56:59]
  buffer_load_dwordx4 v1, s[12:15], s32 offen offset:2048 lds
  v_mfma_f32_16x16x32_bf16 v[60:63], a[144:147], a[112:115], v[28:31]
  v_exp_f32 v150, v150
  v_mfma_f32_16x16x32_bf16 v[60:63], a[140:143], a[108:111], v[60:63]
  v_cvt_pk_bf16_f32 v133, v134, v135
  v_cvt_pk_bf16_f32 v134, v148, v149
  v_mfma_f32_16x16x32_bf16 v[60:63], a[136:139], a[104:107], v[60:63]
  v_exp_f32 v151, v151
  v_mfma_f32_16x16x32_bf16 v[60:63], a[132:135], a[100:103], v[60:63]
  buffer_load_dwordx4 v1, s[12:15], s32 offen offset:3072 lds
  s_waitcnt lgkmcnt(4)
  v_mfma_f32_16x16x32_bf16 v[64:67], a[148:151], a[52:55], v[20:23]
  v_exp_f32 v136, v136
  v_mfma_f32_16x16x32_bf16 v[64:67], a[152:155], a[56:59], v[64:67]
  s_add_u32 s26, s26, 32768
  s_cmp_eq_u32 s26, s62
  s_cselect_b32 s26, s63, s26
  s_cselect_b32 s62, -1, s62
  v_mfma_f32_16x16x32_bf16 v[64:67], a[156:159], a[60:63], v[64:67]
  v_exp_f32 v137, v137
  v_mfma_f32_16x16x32_bf16 v[64:67], a[160:163], a[64:67], v[64:67]
  v_cvt_pk_bf16_f32 v135, v150, v151
  v_cvt_pk_bf16_f32 v136, v136, v137
  v_mfma_f32_16x16x32_bf16 v[68:71], a[160:163], a[80:83], v[20:23]
  v_exp_f32 v138, v138
  v_mfma_f32_16x16x32_bf16 v[68:71], a[156:159], a[76:79], v[68:71]
  v_mfma_f32_16x16x32_bf16 v[68:71], a[152:155], a[72:75], v[68:71]
  v_exp_f32 v139, v139
  v_mfma_f32_16x16x32_bf16 v[68:71], a[148:151], a[68:71], v[68:71]
  v_cvt_pk_bf16_f32 v137, v138, v139
  v_mfma_f32_16x16x32_bf16 v[72:75], a[148:151], a[84:87], v[24:27]
  v_exp_f32 v152, v152
  v_mfma_f32_16x16x32_bf16 v[72:75], a[152:155], a[88:91], v[72:75]
  v_mfma_f32_16x16x32_bf16 v[72:75], a[156:159], a[92:95], v[72:75]
  v_exp_f32 v153, v153
  v_mfma_f32_16x16x32_bf16 v[72:75], a[160:163], a[96:99], v[72:75]
  v_cvt_pk_bf16_f32 v138, v152, v153
  v_mfma_f32_16x16x32_bf16 v[76:79], a[160:163], a[112:115], v[28:31]
  v_exp_f32 v154, v154
  v_mfma_f32_16x16x32_bf16 v[76:79], a[156:159], a[108:111], v[76:79]
  s_waitcnt vmcnt(16) lgkmcnt(0)
  s_barrier
  ds_read_b128 a[116:119], v3 offset:32768
  ds_read_b128 a[120:123], v3 offset:40960
  ds_read_b128 a[124:127], v3 offset:33792
  ds_read_b128 a[128:131], v3 offset:41984
  v_mfma_f32_16x16x32_bf16 v[76:79], a[152:155], a[104:107], v[76:79]
  v_exp_f32 v155, v155
  v_mfma_f32_16x16x32_bf16 v[76:79], a[148:151], a[100:103], v[76:79]
  v_cvt_pk_bf16_f32 v139, v154, v155
  v_mfma_f32_16x16x32_bf16 v[80:83], a[164:167], a[52:55], v[20:23]
  v_exp_f32 v140, v140
  v_mfma_f32_16x16x32_bf16 v[80:83], a[168:171], a[56:59], v[80:83]
  ds_read_b128 a[132:135], v3 offset:34816
  ds_read_b128 a[136:139], v3 offset:43008
  v_mfma_f32_16x16x32_bf16 v[80:83], a[172:175], a[60:63], v[80:83]
  v_exp_f32 v141, v141
  v_mfma_f32_16x16x32_bf16 v[80:83], a[176:179], a[64:67], v[80:83]
  v_cvt_pk_bf16_f32 v140, v140, v141
  v_mfma_f32_16x16x32_bf16 v[84:87], a[176:179], a[80:83], v[20:23]
  v_exp_f32 v142, v142
  v_mfma_f32_16x16x32_bf16 v[84:87], a[172:175], a[76:79], v[84:87]
  v_mfma_f32_16x16x32_bf16 v[84:87], a[168:171], a[72:75], v[84:87]
  v_exp_f32 v143, v143
  v_mfma_f32_16x16x32_bf16 v[84:87], a[164:167], a[68:71], v[84:87]
  v_cvt_pk_bf16_f32 v141, v142, v143
  v_mfma_f32_16x16x32_bf16 v[88:91], a[164:167], a[84:87], v[20:23]
  v_exp_f32 v156, v156
  v_mfma_f32_16x16x32_bf16 v[88:91], a[168:171], a[88:91], v[88:91]
  ds_read_b128 a[140:143], v3 offset:35840
  ds_read_b128 a[144:147], v3 offset:44032
  v_mfma_f32_16x16x32_bf16 v[88:91], a[172:175], a[92:95], v[88:91]
  v_exp_f32 v157, v157
  v_mfma_f32_16x16x32_bf16 v[88:91], a[176:179], a[96:99], v[88:91]
  v_cvt_pk_bf16_f32 v142, v156, v157
  v_mfma_f32_16x16x32_bf16 v[92:95], a[176:179], a[112:115], v[24:27]
  v_exp_f32 v158, v158
  v_mfma_f32_16x16x32_bf16 v[92:95], a[172:175], a[108:111], v[92:95]
  v_mfma_f32_16x16x32_bf16 v[92:95], a[168:171], a[104:107], v[92:95]
  v_exp_f32 v159, v159
  v_mfma_f32_16x16x32_bf16 v[92:95], a[164:167], a[100:103], v[92:95]
  v_cvt_pk_bf16_f32 v143, v158, v159
  s_waitcnt lgkmcnt(6)
  s_add_u32 m0, s29, 65536
  v_mfma_f32_16x16x32_bf16 v[160:163], a[116:119], v[96:99], v[160:163]
  v_exp_f32 v32, v32
  v_mfma_f32_16x16x32_bf16 v[160:163], a[120:123], v[128:131], v[160:163]
  ds_read_b128 a[148:151], v3 offset:36864
  ds_read_b128 a[152:155], v3 offset:45056
  v_mfma_f32_16x16x32_bf16 v[164:167], a[120:123], v[132:135], v[164:167]
  v_exp_f32 v33, v33
  v_mfma_f32_16x16x32_bf16 v[164:167], a[116:119], v[100:103], v[164:167]
  buffer_load_dwordx4 v1, s[12:15], s25 offen offset:0 lds
  s_add_u32 s32, s25, 4096
  v_mfma_f32_16x16x32_bf16 v[168:171], a[116:119], v[104:107], v[168:171]
  v_exp_f32 v34, v34
  v_mfma_f32_16x16x32_bf16 v[168:171], a[120:123], v[136:139], v[168:171]
  v_cvt_pk_bf16_f32 v32, v32, v33
  v_mfma_f32_16x16x32_bf16 v[172:175], a[120:123], v[140:143], v[172:175]
  v_exp_f32 v35, v35
  v_mfma_f32_16x16x32_bf16 v[172:175], a[116:119], v[108:111], v[172:175]
  buffer_load_dwordx4 v1, s[12:15], s25 offen offset:1024 lds
  s_waitcnt lgkmcnt(6)
  v_mfma_f32_16x16x32_bf16 a[32:35], a[48:51], v[96:99], a[32:35]
  v_mfma_f32_16x16x32_bf16 a[32:35], a[48:51], v[128:131], a[32:35]
  v_mfma_f32_16x16x32_bf16 v[176:179], a[124:127], v[96:99], v[176:179]
  v_exp_f32 v48, v48
  v_mfma_f32_16x16x32_bf16 v[176:179], a[128:131], v[128:131], v[176:179]
  ds_read_b128 a[156:159], v3 offset:37888
  ds_read_b128 a[160:163], v3 offset:46080
  v_mfma_f32_16x16x32_bf16 v[180:183], a[128:131], v[132:135], v[180:183]
  v_exp_f32 v49, v49
  v_mfma_f32_16x16x32_bf16 v[180:183], a[124:127], v[100:103], v[180:183]
  buffer_load_dwordx4 v1, s[12:15], s25 offen offset:2048 lds
  v_mfma_f32_16x16x32_bf16 v[184:187], a[124:127], v[104:107], v[184:187]
  v_exp_f32 v50, v50
  v_mfma_f32_16x16x32_bf16 v[184:187], a[128:131], v[136:139], v[184:187]
  v_cvt_pk_bf16_f32 v33, v34, v35
  v_cvt_pk_bf16_f32 v34, v48, v49
  v_mfma_f32_16x16x32_bf16 v[188:191], a[128:131], v[140:143], v[188:191]
  v_exp_f32 v51, v51
  v_mfma_f32_16x16x32_bf16 v[188:191], a[124:127], v[108:111], v[188:191]
  buffer_load_dwordx4 v1, s[12:15], s25 offen offset:3072 lds
  s_add_u32 m0, s29, 69632
  s_waitcnt lgkmcnt(6)
  v_mfma_f32_16x16x32_bf16 a[36:39], a[48:51], v[100:103], a[36:39]
  v_mfma_f32_16x16x32_bf16 a[36:39], a[48:51], v[132:135], a[36:39]
  v_mfma_f32_16x16x32_bf16 v[192:195], a[132:135], v[96:99], v[192:195]
  v_exp_f32 v36, v36
  v_mfma_f32_16x16x32_bf16 v[192:195], a[136:139], v[128:131], v[192:195]
  ds_read_b128 a[164:167], v3 offset:38912
  ds_read_b128 a[168:171], v3 offset:47104
  v_mfma_f32_16x16x32_bf16 v[196:199], a[136:139], v[132:135], v[196:199]
  v_exp_f32 v37, v37
  v_mfma_f32_16x16x32_bf16 v[196:199], a[132:135], v[100:103], v[196:199]
  buffer_load_dwordx4 v1, s[12:15], s32 offen offset:0 lds
  v_mfma_f32_16x16x32_bf16 v[200:203], a[132:135], v[104:107], v[200:203]
  v_exp_f32 v38, v38
  v_mfma_f32_16x16x32_bf16 v[200:203], a[136:139], v[136:139], v[200:203]
  v_cvt_pk_bf16_f32 v35, v50, v51
  v_cvt_pk_bf16_f32 v36, v36, v37
  v_mfma_f32_16x16x32_bf16 v[204:207], a[136:139], v[140:143], v[204:207]
  v_exp_f32 v39, v39
  v_mfma_f32_16x16x32_bf16 v[204:207], a[132:135], v[108:111], v[204:207]
  buffer_load_dwordx4 v1, s[12:15], s32 offen offset:1024 lds
  s_waitcnt lgkmcnt(6)
  v_mfma_f32_16x16x32_bf16 a[40:43], a[48:51], v[104:107], a[40:43]
  v_mfma_f32_16x16x32_bf16 a[40:43], a[48:51], v[136:139], a[40:43]
  v_mfma_f32_16x16x32_bf16 v[208:211], a[140:143], v[96:99], v[208:211]
  v_exp_f32 v52, v52
  v_mfma_f32_16x16x32_bf16 v[208:211], a[144:147], v[128:131], v[208:211]
  ds_read_b128 a[172:175], v3 offset:39936
  ds_read_b128 a[176:179], v3 offset:48128
  v_mfma_f32_16x16x32_bf16 v[212:215], a[144:147], v[132:135], v[212:215]
  v_exp_f32 v53, v53
  v_mfma_f32_16x16x32_bf16 v[212:215], a[140:143], v[100:103], v[212:215]
  buffer_load_dwordx4 v1, s[12:15], s32 offen offset:2048 lds
  v_mfma_f32_16x16x32_bf16 v[216:219], a[140:143], v[104:107], v[216:219]
  v_exp_f32 v54, v54
  v_mfma_f32_16x16x32_bf16 v[216:219], a[144:147], v[136:139], v[216:219]
  v_cvt_pk_bf16_f32 v37, v38, v39
  v_cvt_pk_bf16_f32 v38, v52, v53
  v_mfma_f32_16x16x32_bf16 v[220:223], a[144:147], v[140:143], v[220:223]
  v_exp_f32 v55, v55
  v_mfma_f32_16x16x32_bf16 v[220:223], a[140:143], v[108:111], v[220:223]
  buffer_load_dwordx4 v1, s[12:15], s32 offen offset:3072 lds
  s_waitcnt lgkmcnt(6)
  v_mfma_f32_16x16x32_bf16 a[44:47], a[48:51], v[108:111], a[44:47]
  v_mfma_f32_16x16x32_bf16 a[44:47], a[48:51], v[140:143], a[44:47]
  v_mfma_f32_16x16x32_bf16 v[224:227], a[148:151], v[96:99], v[224:227]
  v_exp_f32 v40, v40
  v_mfma_f32_16x16x32_bf16 v[224:227], a[152:155], v[128:131], v[224:227]
  s_add_u32 s25, s25, 32768
  s_cmp_eq_u32 s25, s27
  s_cselect_b32 s25, s28, s25
  s_cselect_b32 s27, -1, s27
  v_mfma_f32_16x16x32_bf16 v[228:231], a[152:155], v[132:135], v[228:231]
  v_exp_f32 v41, v41
  v_mfma_f32_16x16x32_bf16 v[228:231], a[148:151], v[100:103], v[228:231]
  v_cvt_pk_bf16_f32 v39, v54, v55
  v_cvt_pk_bf16_f32 v40, v40, v41
  v_mfma_f32_16x16x32_bf16 v[232:235], a[148:151], v[104:107], v[232:235]
  v_exp_f32 v42, v42
  v_mfma_f32_16x16x32_bf16 v[232:235], a[152:155], v[136:139], v[232:235]
  v_mfma_f32_16x16x32_bf16 v[236:239], a[152:155], v[140:143], v[236:239]
  v_exp_f32 v43, v43
  v_mfma_f32_16x16x32_bf16 v[236:239], a[148:151], v[108:111], v[236:239]
  v_cvt_pk_bf16_f32 v41, v42, v43
  s_waitcnt lgkmcnt(4)
  v_mfma_f32_16x16x32_bf16 v[240:243], a[156:159], v[96:99], v[240:243]
  v_exp_f32 v56, v56
  v_mfma_f32_16x16x32_bf16 v[240:243], a[160:163], v[128:131], v[240:243]
  v_mfma_f32_16x16x32_bf16 v[244:247], a[160:163], v[132:135], v[244:247]
  v_exp_f32 v57, v57
  v_mfma_f32_16x16x32_bf16 v[244:247], a[156:159], v[100:103], v[244:247]
  v_cvt_pk_bf16_f32 v42, v56, v57
  v_mfma_f32_16x16x32_bf16 v[248:251], a[156:159], v[104:107], v[248:251]
  v_exp_f32 v58, v58
  v_mfma_f32_16x16x32_bf16 v[248:251], a[160:163], v[136:139], v[248:251]
  s_waitcnt vmcnt(16) lgkmcnt(0)
  s_barrier
  ds_read_b128 a[116:119], v2 offset:0
  ds_read_b128 a[120:123], v2 offset:1024
  ds_read_b128 a[124:127], v2 offset:2048
  ds_read_b128 a[128:131], v2 offset:3072
  v_mfma_f32_16x16x32_bf16 v[252:255], a[160:163], v[140:143], v[252:255]
  v_exp_f32 v59, v59
  v_mfma_f32_16x16x32_bf16 v[252:255], a[156:159], v[108:111], v[252:255]
  v_cvt_pk_bf16_f32 v43, v58, v59
  v_mfma_f32_16x16x32_bf16 a[0:3], a[164:167], v[96:99], a[0:3]
  v_exp_f32 v44, v44
  v_mfma_f32_16x16x32_bf16 a[0:3], a[168:171], v[128:131], a[0:3]
  ds_read_b128 a[132:135], v2 offset:4096
  ds_read_b128 a[136:139], v2 offset:5120
  v_mfma_f32_16x16x32_bf16 a[4:7], a[168:171], v[132:135], a[4:7]
  v_exp_f32 v45, v45
  v_mfma_f32_16x16x32_bf16 a[4:7], a[164:167], v[100:103], a[4:7]
  v_cvt_pk_bf16_f32 v44, v44, v45
  v_mfma_f32_16x16x32_bf16 a[8:11], a[164:167], v[104:107], a[8:11]
  v_exp_f32 v46, v46
  v_mfma_f32_16x16x32_bf16 a[8:11], a[168:171], v[136:139], a[8:11]
  v_mfma_f32_16x16x32_bf16 a[12:15], a[168:171], v[140:143], a[12:15]
  v_exp_f32 v47, v47
  v_mfma_f32_16x16x32_bf16 a[12:15], a[164:167], v[108:111], a[12:15]
  v_cvt_pk_bf16_f32 v45, v46, v47
  v_mfma_f32_16x16x32_bf16 a[16:19], a[172:175], v[96:99], a[16:19]
  v_exp_f32 v60, v60
  v_mfma_f32_16x16x32_bf16 a[16:19], a[176:179], v[128:131], a[16:19]
  ds_read_b128 a[140:143], v2 offset:6144
  ds_read_b128 a[144:147], v2 offset:7168
  v_mfma_f32_16x16x32_bf16 a[20:23], a[176:179], v[132:135], a[20:23]
  v_exp_f32 v61, v61
  v_mfma_f32_16x16x32_bf16 a[20:23], a[172:175], v[100:103], a[20:23]
  v_cvt_pk_bf16_f32 v46, v60, v61
  v_mfma_f32_16x16x32_bf16 a[24:27], a[172:175], v[104:107], a[24:27]
  v_exp_f32 v62, v62
  v_mfma_f32_16x16x32_bf16 a[24:27], a[176:179], v[136:139], a[24:27]
  v_mfma_f32_16x16x32_bf16 a[28:31], a[176:179], v[140:143], a[28:31]
  v_exp_f32 v63, v63
  v_mfma_f32_16x16x32_bf16 a[28:31], a[172:175], v[108:111], a[28:31]
  v_cvt_pk_bf16_f32 v47, v62, v63
  s_waitcnt lgkmcnt(0)
Lk2_fin:
  s_waitcnt vmcnt(8)
  s_barrier
  ds_read_b128 a[116:119], v2 offset:32768
  ds_read_b128 a[120:123], v2 offset:40960
  ds_read_b128 a[124:127], v2 offset:33792
  ds_read_b128 a[128:131], v2 offset:41984
  ds_read_b128 a[132:135], v2 offset:34816
  ds_read_b128 a[136:139], v2 offset:43008
  ds_read_b128 a[140:143], v2 offset:35840
  ds_read_b128 a[144:147], v2 offset:44032
  v_exp_f32 v64, v64
  v_exp_f32 v65, v65
  v_exp_f32 v66, v66
  v_exp_f32 v67, v67
  v_exp_f32 v80, v80
  v_exp_f32 v81, v81
  v_exp_f32 v82, v82
  v_exp_f32 v83, v83
  v_cvt_pk_bf16_f32 v64, v64, v65
  v_cvt_pk_bf16_f32 v65, v66, v67
  v_exp_f32 v68, v68
  v_exp_f32 v69, v69
  v_exp_f32 v70, v70
  v_exp_f32 v71, v71
  v_cvt_pk_bf16_f32 v66, v80, v81
  v_cvt_pk_bf16_f32 v67, v82, v83
  v_exp_f32 v84, v84
  v_exp_f32 v85, v85
  v_exp_f32 v86, v86
  v_exp_f32 v87, v87
  v_cvt_pk_bf16_f32 v68, v68, v69
  v_cvt_pk_bf16_f32 v69, v70, v71
  v_exp_f32 v72, v72
  v_exp_f32 v73, v73
  v_exp_f32 v74, v74
  v_exp_f32 v75, v75
  v_cvt_pk_bf16_f32 v70, v84, v85
  v_cvt_pk_bf16_f32 v71, v86, v87
  v_exp_f32 v88, v88
  v_exp_f32 v89, v89
  v_exp_f32 v90, v90
  v_exp_f32 v91, v91
  v_cvt_pk_bf16_f32 v72, v72, v73
  v_cvt_pk_bf16_f32 v73, v74, v75
  v_exp_f32 v76, v76
  v_exp_f32 v77, v77
  v_exp_f32 v78, v78
  v_exp_f32 v79, v79
  v_cvt_pk_bf16_f32 v74, v88, v89
  v_cvt_pk_bf16_f32 v75, v90, v91
  v_exp_f32 v92, v92
  v_exp_f32 v93, v93
  v_exp_f32 v94, v94
  v_exp_f32 v95, v95
  v_cvt_pk_bf16_f32 v76, v76, v77
  v_cvt_pk_bf16_f32 v77, v78, v79
  v_cvt_pk_bf16_f32 v78, v92, v93
  v_cvt_pk_bf16_f32 v79, v94, v95
  s_waitcnt lgkmcnt(6)
  v_mfma_f32_16x16x32_bf16 v[160:163], a[116:119], v[32:35], v[160:163]
  v_mfma_f32_16x16x32_bf16 v[160:163], a[120:123], v[64:67], v[160:163]
  ds_read_b128 a[148:151], v2 offset:36864
  ds_read_b128 a[152:155], v2 offset:45056
  v_mfma_f32_16x16x32_bf16 v[164:167], a[120:123], v[68:71], v[164:167]
  v_mfma_f32_16x16x32_bf16 v[164:167], a[116:119], v[36:39], v[164:167]
  v_mfma_f32_16x16x32_bf16 v[168:171], a[116:119], v[40:43], v[168:171]
  v_mfma_f32_16x16x32_bf16 v[168:171], a[120:123], v[72:75], v[168:171]
  v_mfma_f32_16x16x32_bf16 v[172:175], a[120:123], v[76:79], v[172:175]
  v_mfma_f32_16x16x32_bf16 v[172:175], a[116:119], v[44:47], v[172:175]
  s_waitcnt lgkmcnt(6)
  v_mfma_f32_16x16x32_bf16 a[32:35], a[48:51], v[32:35], a[32:35]
  v_mfma_f32_16x16x32_bf16 a[32:35], a[48:51], v[64:67], a[32:35]
  v_mfma_f32_16x16x32_bf16 v[176:179], a[124:127], v[32:35], v[176:179]
  v_mfma_f32_16x16x32_bf16 v[176:179], a[128:131], v[64:67], v[176:179]
  ds_read_b128 a[156:159], v2 offset:37888
  ds_read_b128 a[160:163], v2 offset:46080
  v_mfma_f32_16x16x32_bf16 v[180:183], a[128:131], v[68:71], v[180:183]
  v_mfma_f32_16x16x32_bf16 v[180:183], a[124:127], v[36:39], v[180:183]
  v_mfma_f32_16x16x32_bf16 v[184:187], a[124:127], v[40:43], v[184:187]
  v_mfma_f32_16x16x32_bf16 v[184:187], a[128:131], v[72:75], v[184:187]
  v_mfma_f32_16x16x32_bf16 v[188:191], a[128:131], v[76:79], v[188:191]
  v_mfma_f32_16x16x32_bf16 v[188:191], a[124:127], v[44:47], v[188:191]
  s_waitcnt lgkmcnt(6)
  v_mfma_f32_16x16x32_bf16 a[36:39], a[48:51], v[36:39], a[36:39]
  v_mfma_f32_16x16x32_bf16 a[36:39], a[48:51], v[68:71], a[36:39]
  v_mfma_f32_16x16x32_bf16 v[192:195], a[132:135], v[32:35], v[192:195]
  v_mfma_f32_16x16x32_bf16 v[192:195], a[136:139], v[64:67], v[192:195]
  ds_read_b128 a[164:167], v2 offset:38912
  ds_read_b128 a[168:171], v2 offset:47104
  v_mfma_f32_16x16x32_bf16 v[196:199], a[136:139], v[68:71], v[196:199]
  v_mfma_f32_16x16x32_bf16 v[196:199], a[132:135], v[36:39], v[196:199]
  v_mfma_f32_16x16x32_bf16 v[200:203], a[132:135], v[40:43], v[200:203]
  v_mfma_f32_16x16x32_bf16 v[200:203], a[136:139], v[72:75], v[200:203]
  v_mfma_f32_16x16x32_bf16 v[204:207], a[136:139], v[76:79], v[204:207]
  v_mfma_f32_16x16x32_bf16 v[204:207], a[132:135], v[44:47], v[204:207]
  s_waitcnt lgkmcnt(6)
  v_mfma_f32_16x16x32_bf16 a[40:43], a[48:51], v[40:43], a[40:43]
  v_mfma_f32_16x16x32_bf16 a[40:43], a[48:51], v[72:75], a[40:43]
  v_mfma_f32_16x16x32_bf16 v[208:211], a[140:143], v[32:35], v[208:211]
  v_mfma_f32_16x16x32_bf16 v[208:211], a[144:147], v[64:67], v[208:211]
  ds_read_b128 a[172:175], v2 offset:39936
  ds_read_b128 a[176:179], v2 offset:48128
  v_mfma_f32_16x16x32_bf16 v[212:215], a[144:147], v[68:71], v[212:215]
  v_mfma_f32_16x16x32_bf16 v[212:215], a[140:143], v[36:39], v[212:215]
  v_mfma_f32_16x16x32_bf16 v[216:219], a[140:143], v[40:43], v[216:219]
  v_mfma_f32_16x16x32_bf16 v[216:219], a[144:147], v[72:75], v[216:219]
  v_mfma_f32_16x16x32_bf16 v[220:223], a[144:147], v[76:79], v[220:223]
  v_mfma_f32_16x16x32_bf16 v[220:223], a[140:143], v[44:47], v[220:223]
  s_waitcnt lgkmcnt(6)
  v_mfma_f32_16x16x32_bf16 a[44:47], a[48:51], v[44:47], a[44:47]
  v_mfma_f32_16x16x32_bf16 a[44:47], a[48:51], v[76:79], a[44:47]
  v_mfma_f32_16x16x32_bf16 v[224:227], a[148:151], v[32:35], v[224:227]
  v_mfma_f32_16x16x32_bf16 v[224:227], a[152:155], v[64:67], v[224:227]
  v_mfma_f32_16x16x32_bf16 v[228:231], a[152:155], v[68:71], v[228:231]
  v_mfma_f32_16x16x32_bf16 v[228:231], a[148:151], v[36:39], v[228:231]
  v_mfma_f32_16x16x32_bf16 v[232:235], a[148:151], v[40:43], v[232:235]
  v_mfma_f32_16x16x32_bf16 v[232:235], a[152:155], v[72:75], v[232:235]
  v_mfma_f32_16x16x32_bf16 v[236:239], a[152:155], v[76:79], v[236:239]
  v_mfma_f32_16x16x32_bf16 v[236:239], a[148:151], v[44:47], v[236:239]
  s_waitcnt lgkmcnt(4)
  v_mfma_f32_16x16x32_bf16 v[240:243], a[156:159], v[32:35], v[240:243]
  v_mfma_f32_16x16x32_bf16 v[240:243], a[160:163], v[64:67], v[240:243]
  v_mfma_f32_16x16x32_bf16 v[244:247], a[160:163], v[68:71], v[244:247]
  v_mfma_f32_16x16x32_bf16 v[244:247], a[156:159], v[36:39], v[244:247]
  v_mfma_f32_16x16x32_bf16 v[248:251], a[156:159], v[40:43], v[248:251]
  v_mfma_f32_16x16x32_bf16 v[248:251], a[160:163], v[72:75], v[248:251]
  s_waitcnt vmcnt(63) lgkmcnt(0)
  s_barrier
  v_mfma_f32_16x16x32_bf16 v[252:255], a[160:163], v[76:79], v[252:255]
  v_mfma_f32_16x16x32_bf16 v[252:255], a[156:159], v[44:47], v[252:255]
  v_mfma_f32_16x16x32_bf16 a[0:3], a[164:167], v[32:35], a[0:3]
  v_mfma_f32_16x16x32_bf16 a[0:3], a[168:171], v[64:67], a[0:3]
  v_mfma_f32_16x16x32_bf16 a[4:7], a[168:171], v[68:71], a[4:7]
  v_mfma_f32_16x16x32_bf16 a[4:7], a[164:167], v[36:39], a[4:7]
  v_mfma_f32_16x16x32_bf16 a[8:11], a[164:167], v[40:43], a[8:11]
  v_mfma_f32_16x16x32_bf16 a[8:11], a[168:171], v[72:75], a[8:11]
  v_mfma_f32_16x16x32_bf16 a[12:15], a[168:171], v[76:79], a[12:15]
  v_mfma_f32_16x16x32_bf16 a[12:15], a[164:167], v[44:47], a[12:15]
  v_mfma_f32_16x16x32_bf16 a[16:19], a[172:175], v[32:35], a[16:19]
  v_mfma_f32_16x16x32_bf16 a[16:19], a[176:179], v[64:67], a[16:19]
  v_mfma_f32_16x16x32_bf16 a[20:23], a[176:179], v[68:71], a[20:23]
  v_mfma_f32_16x16x32_bf16 a[20:23], a[172:175], v[36:39], a[20:23]
  v_mfma_f32_16x16x32_bf16 a[24:27], a[172:175], v[40:43], a[24:27]
  v_mfma_f32_16x16x32_bf16 a[24:27], a[176:179], v[72:75], a[24:27]
  v_mfma_f32_16x16x32_bf16 a[28:31], a[176:179], v[76:79], a[28:31]
  v_mfma_f32_16x16x32_bf16 a[28:31], a[172:175], v[44:47], a[28:31]
Lk2_merge:
  s_lshl_b32 s33, s23, 14
  s_add_u32 s34, s33, 131072
  s_add_u32 s33, s33, 32768
  s_cmp_eq_u32 s24, 0
  s_cselect_b32 s35, s34, s33
  s_cselect_b32 s36, s33, s34
  v_add_u32 v2, s35, v1
  v_add_u32 v3, s36, v1
  s_lshl_b32 s33, s22, 10
  s_xor_b32 s34, s33, 2048
  v_add_u32 v14, s33, v1
  v_add_u32 v15, s34, v1
  v_accvgpr_read_b32 v20, a32
  v_accvgpr_read_b32 v21, a36
  v_accvgpr_read_b32 v22, a40
  v_accvgpr_read_b32 v23, a44
  ds_write_b128 v14, v[20:23]
  s_cmp_eq_u32 s24, 1
  s_waitcnt lgkmcnt(0)
  s_cbranch_scc1 Lk2_mg1
  ds_write_b128 v2, v[224:227] offset:0
  ds_write_b128 v2, v[228:231] offset:1024
  ds_write_b128 v2, v[232:235] offset:2048
  ds_write_b128 v2, v[236:239] offset:3072
  ds_write_b128 v2, v[240:243] offset:4096
  ds_write_b128 v2, v[244:247] offset:5120
  ds_write_b128 v2, v[248:251] offset:6144
  ds_write_b128 v2, v[252:255] offset:7168
  ds_write_b128 v2, a[0:3] offset:8192
  ds_write_b128 v2, a[4:7] offset:9216
  ds_write_b128 v2, a[8:11] offset:10240
  ds_write_b128 v2, a[12:15] offset:11264
  ds_write_b128 v2, a[16:19] offset:12288
  ds_write_b128 v2, a[20:23] offset:13312
  ds_write_b128 v2, a[24:27] offset:14336
  ds_write_b128 v2, a[28:31] offset:15360
  s_waitcnt lgkmcnt(0)
  s_barrier
  ds_read_b128 v[28:31], v15
  ds_read_b128 v[32:35], v3 offset:0
  ds_read_b128 v[36:39], v3 offset:1024
  ds_read_b128 v[40:43], v3 offset:2048
  ds_read_b128 v[44:47], v3 offset:3072
  ds_read_b128 v[48:51], v3 offset:4096
  ds_read_b128 v[52:55], v3 offset:5120
  ds_read_b128 v[56:59], v3 offset:6144
  ds_read_b128 v[60:63], v3 offset:7168
  ds_read_b128 v[64:67], v3 offset:8192
  ds_read_b128 v[68:71], v3 offset:9216
  ds_read_b128 v[72:75], v3 offset:10240
  ds_read_b128 v[76:79], v3 offset:11264
  ds_read_b128 v[80:83], v3 offset:12288
  ds_read_b128 v[84:87], v3 offset:13312
  ds_read_b128 v[88:91], v3 offset:14336
  ds_read_b128 v[92:95], v3 offset:15360
  s_waitcnt lgkmcnt(15)
  v_add_f32 v20, v20, v28
  v_add_f32 v21, v21, v29
  v_add_f32 v22, v22, v30
  v_add_f32 v23, v23, v31
  s_sub_u32 s35, 15, s21
  v_rcp_f32 v8, v20
  v_rcp_f32 v9, v21
  v_rcp_f32 v10, v22
  v_rcp_f32 v11, v23
  v_subrev_u32 v20, 0x21800000, v20
  v_subrev_u32 v21, 0x21800000, v21
  v_subrev_u32 v22, 0x21800000, v22
  v_subrev_u32 v23, 0x21800000, v23
  v_max_u32 v12, v20, v21
  v_max3_u32 v12, v12, v22, v23
  s_mov_b32 s64, 0x207
  v_pk_add_f32 v[160:161], v[160:161], v[32:33]
  v_pk_add_f32 v[162:163], v[162:163], v[34:35]
  s_waitcnt lgkmcnt(11)
  v_pk_add_f32 v[176:177], v[176:177], v[48:49]
  v_pk_add_f32 v[178:179], v[178:179], v[50:51]
  v_pk_mul_f32 v[160:161], v[160:161], v[8:9] op_sel:[0,0] op_sel_hi:[1,0]
  v_pk_mul_f32 v[162:163], v[162:163], v[8:9] op_sel:[0,0] op_sel_hi:[1,0]
  v_pk_mul_f32 v[176:177], v[176:177], v[8:9] op_sel:[0,0] op_sel_hi:[1,0]
  v_pk_mul_f32 v[178:179], v[178:179], v[8:9] op_sel:[0,0] op_sel_hi:[1,0]
  v_cvt_pk_bf16_f32 v160, v160, v161
  v_cvt_pk_bf16_f32 v161, v162, v163
  v_cvt_pk_bf16_f32 v162, v176, v177
  v_cvt_pk_bf16_f32 v163, v178, v179
  v_pk_add_f32 v[164:165], v[164:165], v[36:37]
  v_pk_add_f32 v[166:167], v[166:167], v[38:39]
  s_waitcnt lgkmcnt(10)
  v_pk_add_f32 v[180:181], v[180:181], v[52:53]
  v_pk_add_f32 v[182:183], v[182:183], v[54:55]
  v_mfma_f32_16x16x32_bf16 v[24:27], a[48:51], v[160:163], 0
  v_pk_mul_f32 v[164:165], v[164:165], v[8:9] op_sel:[0,1] op_sel_hi:[1,1]
  v_pk_mul_f32 v[166:167], v[166:167], v[8:9] op_sel:[0,1] op_sel_hi:[1,1]
  v_pk_mul_f32 v[180:181], v[180:181], v[8:9] op_sel:[0,1] op_sel_hi:[1,1]
  v_pk_mul_f32 v[182:183], v[182:183], v[8:9] op_sel:[0,1] op_sel_hi:[1,1]
  v_cvt_pk_bf16_f32 v164, v164, v165
  v_cvt_pk_bf16_f32 v165, v166, v167
  v_cvt_pk_bf16_f32 v166, v180, v181
  v_cvt_pk_bf16_f32 v167, v182, v183
  v_pk_add_f32 v[168:169], v[168:169], v[40:41]
  v_pk_add_f32 v[170:171], v[170:171], v[42:43]
  s_waitcnt lgkmcnt(9)
  v_pk_add_f32 v[184:185], v[184:185], v[56:57]
  v_pk_add_f32 v[186:187], v[186:187], v[58:59]
  v_mfma_f32_16x16x32_bf16 v[24:27], a[48:51], v[164:167], v[24:27]
  v_pk_mul_f32 v[168:169], v[168:169], v[10:11] op_sel:[0,0] op_sel_hi:[1,0]
  v_pk_mul_f32 v[170:171], v[170:171], v[10:11] op_sel:[0,0] op_sel_hi:[1,0]
  v_pk_mul_f32 v[184:185], v[184:185], v[10:11] op_sel:[0,0] op_sel_hi:[1,0]
  v_pk_mul_f32 v[186:187], v[186:187], v[10:11] op_sel:[0,0] op_sel_hi:[1,0]
  v_cvt_pk_bf16_f32 v168, v168, v169
  v_cvt_pk_bf16_f32 v169, v170, v171
  v_cvt_pk_bf16_f32 v170, v184, v185
  v_cvt_pk_bf16_f32 v171, v186, v187
  v_pk_add_f32 v[172:173], v[172:173], v[44:45]
  v_pk_add_f32 v[174:175], v[174:175], v[46:47]
  s_waitcnt lgkmcnt(8)
  v_pk_add_f32 v[188:189], v[188:189], v[60:61]
  v_pk_add_f32 v[190:191], v[190:191], v[62:63]
  v_mfma_f32_16x16x32_bf16 v[24:27], a[48:51], v[168:171], v[24:27]
  v_pk_mul_f32 v[172:173], v[172:173], v[10:11] op_sel:[0,1] op_sel_hi:[1,1]
  v_pk_mul_f32 v[174:175], v[174:175], v[10:11] op_sel:[0,1] op_sel_hi:[1,1]
  v_pk_mul_f32 v[188:189], v[188:189], v[10:11] op_sel:[0,1] op_sel_hi:[1,1]
  v_pk_mul_f32 v[190:191], v[190:191], v[10:11] op_sel:[0,1] op_sel_hi:[1,1]
  v_cvt_pk_bf16_f32 v172, v172, v173
  v_cvt_pk_bf16_f32 v173, v174, v175
  v_cvt_pk_bf16_f32 v174, v188, v189
  v_cvt_pk_bf16_f32 v175, v190, v191
  s_waitcnt lgkmcnt(7)
  v_pk_add_f32 v[192:193], v[192:193], v[64:65]
  v_pk_add_f32 v[194:195], v[194:195], v[66:67]
  s_waitcnt lgkmcnt(3)
  v_pk_add_f32 v[208:209], v[208:209], v[80:81]
  v_pk_add_f32 v[210:211], v[210:211], v[82:83]
  v_mfma_f32_16x16x32_bf16 v[24:27], a[48:51], v[172:175], v[24:27]
  v_pk_mul_f32 v[192:193], v[192:193], v[8:9] op_sel:[0,0] op_sel_hi:[1,0]
  v_pk_mul_f32 v[194:195], v[194:195], v[8:9] op_sel:[0,0] op_sel_hi:[1,0]
  v_pk_mul_f32 v[208:209], v[208:209], v[8:9] op_sel:[0,0] op_sel_hi:[1,0]
  v_pk_mul_f32 v[210:211], v[210:211], v[8:9] op_sel:[0,0] op_sel_hi:[1,0]
  v_cvt_pk_bf16_f32 v192, v192, v193
  v_cvt_pk_bf16_f32 v193, v194, v195
  v_cvt_pk_bf16_f32 v194, v208, v209
  v_cvt_pk_bf16_f32 v195, v210, v211
  v_pk_add_f32 v[196:197], v[196:197], v[68:69]
  v_pk_add_f32 v[198:199], v[198:199], v[70:71]
  s_waitcnt lgkmcnt(2)
  v_pk_add_f32 v[212:213], v[212:213], v[84:85]
  v_pk_add_f32 v[214:215], v[214:215], v[86:87]
  v_mfma_f32_16x16x32_bf16 v[24:27], a[48:51], v[192:195], v[24:27]
  v_pk_mul_f32 v[196:197], v[196:197], v[8:9] op_sel:[0,1] op_sel_hi:[1,1]
  v_pk_mul_f32 v[198:199], v[198:199], v[8:9] op_sel:[0,1] op_sel_hi:[1,1]
  v_pk_mul_f32 v[212:213], v[212:213], v[8:9] op_sel:[0,1] op_sel_hi:[1,1]
  v_pk_mul_f32 v[214:215], v[214:215], v[8:9] op_sel:[0,1] op_sel_hi:[1,1]
  v_cvt_pk_bf16_f32 v196, v196, v197
  v_cvt_pk_bf16_f32 v197, v198, v199
  v_cvt_pk_bf16_f32 v198, v212, v213
  v_cvt_pk_bf16_f32 v199, v214, v215
  v_pk_add_f32 v[200:201], v[200:201], v[72:73]
  v_pk_add_f32 v[202:203], v[202:203], v[74:75]
  s_waitcnt lgkmcnt(1)
  v_pk_add_f32 v[216:217], v[216:217], v[88:89]
  v_pk_add_f32 v[218:219], v[218:219], v[90:91]
  v_mfma_f32_16x16x32_bf16 v[24:27], a[48:51], v[196:199], v[24:27]
  v_pk_mul_f32 v[200:201], v[200:201], v[10:11] op_sel:[0,0] op_sel_hi:[1,0]
  v_pk_mul_f32 v[202:203], v[202:203], v[10:11] op_sel:[0,0] op_sel_hi:[1,0]
  v_pk_mul_f32 v[216:217], v[216:217], v[10:11] op_sel:[0,0] op_sel_hi:[1,0]
  v_pk_mul_f32 v[218:219], v[218:219], v[10:11] op_sel:[0,0] op_sel_hi:[1,0]
  v_cvt_pk_bf16_f32 v200, v200, v201
  v_cvt_pk_bf16_f32 v201, v202, v203
  v_cvt_pk_bf16_f32 v202, v216, v217
  v_cvt_pk_bf16_f32 v203, v218, v219
  v_pk_add_f32 v[204:205], v[204:205], v[76:77]
  v_pk_add_f32 v[206:207], v[206:207], v[78:79]
  s_waitcnt lgkmcnt(0)
  v_pk_add_f32 v[220:221], v[220:221], v[92:93]
  v_pk_add_f32 v[222:223], v[222:223], v[94:95]
  v_mfma_f32_16x16x32_bf16 v[24:27], a[48:51], v[200:203], v[24:27]
  v_pk_mul_f32 v[204:205], v[204:205], v[10:11] op_sel:[0,1] op_sel_hi:[1,1]
  v_pk_mul_f32 v[206:207], v[206:207], v[10:11] op_sel:[0,1] op_sel_hi:[1,1]
  v_pk_mul_f32 v[220:221], v[220:221], v[10:11] op_sel:[0,1] op_sel_hi:[1,1]
  v_pk_mul_f32 v[222:223], v[222:223], v[10:11] op_sel:[0,1] op_sel_hi:[1,1]
  v_cvt_pk_bf16_f32 v204, v204, v205
  v_cvt_pk_bf16_f32 v205, v206, v207
  v_cvt_pk_bf16_f32 v206, v220, v221
  v_cvt_pk_bf16_f32 v207, v222, v223
  s_nop 1
  v_mfma_f32_16x16x32_bf16 v[24:27], a[48:51], v[204:207], v[24:27]
  v_cmp_lt_u32 vcc, 0x3c000000, v12
  s_nop 6
  v_cmp_class_f32 s[40:41], v24, s64
  s_nop 0
  s_or_b64 vcc, vcc, s[40:41]
  s_cbranch_vccnz Lbad_3
  s_lshl_b32 s33, s35, 3
  s_lshl_b32 s34, s23, 2
  s_add_u32 s33, s33, s34
  s_lshl_b32 s33, s33, 17
  s_lshl_b32 s34, s20, 12
  s_add_u32 s36, s33, s34
  s_add_u32 s37, s36, 131072
  s_add_u32 s38, s36, 262144
  s_add_u32 s39, s36, 393216
  buffer_store_dwordx4 v[160:163], v1, s[16:19], s36 offen offset:0
  buffer_store_dwordx4 v[164:167], v1, s[16:19], s37 offen offset:0
  buffer_store_dwordx4 v[168:171], v1, s[16:19], s38 offen offset:0
  buffer_store_dwordx4 v[172:175], v1, s[16:19], s39 offen offset:0
  buffer_store_dwordx4 v[192:195], v1, s[16:19], s36 offen offset:1024
  buffer_store_dwordx4 v[196:199], v1, s[16:19], s37 offen offset:1024
  buffer_store_dwordx4 v[200:203], v1, s[16:19], s38 offen offset:1024
  buffer_store_dwordx4 v[204:207], v1, s[16:19], s39 offen offset:1024
  s_branch Lfd_4
Lbad_3:
  s_or_b32 s60, s60, 2
Lfd_4:
  s_branch Lk2_chk
Lk2_mg1:
  ds_write_b128 v2, v[160:163] offset:0
  ds_write_b128 v2, v[164:167] offset:1024
  ds_write_b128 v2, v[168:171] offset:2048
  ds_write_b128 v2, v[172:175] offset:3072
  ds_write_b128 v2, v[176:179] offset:4096
  ds_write_b128 v2, v[180:183] offset:5120
  ds_write_b128 v2, v[184:187] offset:6144
  ds_write_b128 v2, v[188:191] offset:7168
  ds_write_b128 v2, v[192:195] offset:8192
  ds_write_b128 v2, v[196:199] offset:9216
  ds_write_b128 v2, v[200:203] offset:10240
  ds_write_b128 v2, v[204:207] offset:11264
  ds_write_b128 v2, v[208:211] offset:12288
  ds_write_b128 v2, v[212:215] offset:13312
  ds_write_b128 v2, v[216:219] offset:14336
  ds_write_b128 v2, v[220:223] offset:15360
  s_waitcnt lgkmcnt(0)
  s_barrier
  ds_read_b128 v[28:31], v15
  ds_read_b128 v[32:35], v3 offset:0
  ds_read_b128 v[36:39], v3 offset:1024
  ds_read_b128 v[40:43], v3 offset:2048
  ds_read_b128 v[44:47], v3 offset:3072
  ds_read_b128 v[48:51], v3 offset:4096
  ds_read_b128 v[52:55], v3 offset:5120
  ds_read_b128 v[56:59], v3 offset:6144
  ds_read_b128 v[60:63], v3 offset:7168
  ds_read_b128 v[64:67], v3 offset:8192
  ds_read_b128 v[68:71], v3 offset:9216
  ds_read_b128 v[72:75], v3 offset:10240
  ds_read_b128 v[76:79], v3 offset:11264
  ds_read_b128 v[80:83], v3 offset:12288
  ds_read_b128 v[84:87], v3 offset:13312
  ds_read_b128 v[88:91], v3 offset:14336
  ds_read_b128 v[92:95], v3 offset:15360
  s_waitcnt lgkmcnt(15)
  v_add_f32 v20, v20, v28
  v_add_f32 v21, v21, v29
  v_add_f32 v22, v22, v30
  v_add_f32 v23, v23, v31
  s_sub_u32 s35, 15, s21
  v_rcp_f32 v8, v20
  v_rcp_f32 v9, v21
  v_rcp_f32 v10, v22
  v_rcp_f32 v11, v23
  v_subrev_u32 v20, 0x21800000, v20
  v_subrev_u32 v21, 0x21800000, v21
  v_subrev_u32 v22, 0x21800000, v22
  v_subrev_u32 v23, 0x21800000, v23
  v_max_u32 v12, v20, v21
  v_max3_u32 v12, v12, v22, v23
  s_mov_b32 s64, 0x207
  v_pk_add_f32 v[224:225], v[224:225], v[32:33]
  v_pk_add_f32 v[226:227], v[226:227], v[34:35]
  s_waitcnt lgkmcnt(11)
  v_pk_add_f32 v[240:241], v[240:241], v[48:49]
  v_pk_add_f32 v[242:243], v[242:243], v[50:51]
  v_pk_mul_f32 v[224:225], v[224:225], v[8:9] op_sel:[0,0] op_sel_hi:[1,0]
  v_pk_mul_f32 v[226:227], v[226:227], v[8:9] op_sel:[0,0] op_sel_hi:[1,0]
  v_pk_mul_f32 v[240:241], v[240:241], v[8:9] op_sel:[0,0] op_sel_hi:[1,0]
  v_pk_mul_f32 v[242:243], v[242:243], v[8:9] op_sel:[0,0] op_sel_hi:[1,0]
  v_cvt_pk_bf16_f32 v224, v224, v225
  v_cvt_pk_bf16_f32 v225, v226, v227
  v_cvt_pk_bf16_f32 v226, v240, v241
  v_cvt_pk_bf16_f32 v227, v242, v243
  v_pk_add_f32 v[228:229], v[228:229], v[36:37]
  v_pk_add_f32 v[230:231], v[230:231], v[38:39]
  s_waitcnt lgkmcnt(10)
  v_pk_add_f32 v[244:245], v[244:245], v[52:53]
  v_pk_add_f32 v[246:247], v[246:247], v[54:55]
  v_mfma_f32_16x16x32_bf16 v[24:27], a[48:51], v[224:227], 0
  v_pk_mul_f32 v[228:229], v[228:229], v[8:9] op_sel:[0,1] op_sel_hi:[1,1]
  v_pk_mul_f32 v[230:231], v[230:231], v[8:9] op_sel:[0,1] op_sel_hi:[1,1]
  v_pk_mul_f32 v[244:245], v[244:245], v[8:9] op_sel:[0,1] op_sel_hi:[1,1]
  v_pk_mul_f32 v[246:247], v[246:247], v[8:9] op_sel:[0,1] op_sel_hi:[1,1]
  v_cvt_pk_bf16_f32 v228, v228, v229
  v_cvt_pk_bf16_f32 v229, v230, v231
  v_cvt_pk_bf16_f32 v230, v244, v245
  v_cvt_pk_bf16_f32 v231, v246, v247
  v_pk_add_f32 v[232:233], v[232:233], v[40:41]
  v_pk_add_f32 v[234:235], v[234:235], v[42:43]
  s_waitcnt lgkmcnt(9)
  v_pk_add_f32 v[248:249], v[248:249], v[56:57]
  v_pk_add_f32 v[250:251], v[250:251], v[58:59]
  v_mfma_f32_16x16x32_bf16 v[24:27], a[48:51], v[228:231], v[24:27]
  v_pk_mul_f32 v[232:233], v[232:233], v[10:11] op_sel:[0,0] op_sel_hi:[1,0]
  v_pk_mul_f32 v[234:235], v[234:235], v[10:11] op_sel:[0,0] op_sel_hi:[1,0]
  v_pk_mul_f32 v[248:249], v[248:249], v[10:11] op_sel:[0,0] op_sel_hi:[1,0]
  v_pk_mul_f32 v[250:251], v[250:251], v[10:11] op_sel:[0,0] op_sel_hi:[1,0]
  v_cvt_pk_bf16_f32 v232, v232, v233
  v_cvt_pk_bf16_f32 v233, v234, v235
  v_cvt_pk_bf16_f32 v234, v248, v249
  v_cvt_pk_bf16_f32 v235, v250, v251
  v_pk_add_f32 v[236:237], v[236:237], v[44:45]
  v_pk_add_f32 v[238:239], v[238:239], v[46:47]
  s_waitcnt lgkmcnt(8)
  v_pk_add_f32 v[252:253], v[252:253], v[60:61]
  v_pk_add_f32 v[254:255], v[254:255], v[62:63]
  v_mfma_f32_16x16x32_bf16 v[24:27], a[48:51], v[232:235], v[24:27]
  v_pk_mul_f32 v[236:237], v[236:237], v[10:11] op_sel:[0,1] op_sel_hi:[1,1]
  v_pk_mul_f32 v[238:239], v[238:239], v[10:11] op_sel:[0,1] op_sel_hi:[1,1]
  v_pk_mul_f32 v[252:253], v[252:253], v[10:11] op_sel:[0,1] op_sel_hi:[1,1]
  v_pk_mul_f32 v[254:255], v[254:255], v[10:11] op_sel:[0,1] op_sel_hi:[1,1]
  v_cvt_pk_bf16_f32 v236, v236, v237
  v_cvt_pk_bf16_f32 v237, v238, v239
  v_cvt_pk_bf16_f32 v238, v252, v253
  v_cvt_pk_bf16_f32 v239, v254, v255
  v_accvgpr_read_b32 v32, a0
  v_accvgpr_read_b32 v33, a1
  v_accvgpr_read_b32 v34, a2
  v_accvgpr_read_b32 v35, a3
  s_waitcnt lgkmcnt(7)
  v_pk_add_f32 v[32:33], v[32:33], v[64:65]
  v_pk_add_f32 v[34:35], v[34:35], v[66:67]
  v_accvgpr_read_b32 v48, a16
  v_accvgpr_read_b32 v49, a17
  v_accvgpr_read_b32 v50, a18
  v_accvgpr_read_b32 v51, a19
  s_waitcnt lgkmcnt(3)
  v_pk_add_f32 v[48:49], v[48:49], v[80:81]
  v_pk_add_f32 v[50:51], v[50:51], v[82:83]
  v_mfma_f32_16x16x32_bf16 v[24:27], a[48:51], v[236:239], v[24:27]
  v_pk_mul_f32 v[32:33], v[32:33], v[8:9] op_sel:[0,0] op_sel_hi:[1,0]
  v_pk_mul_f32 v[34:35], v[34:35], v[8:9] op_sel:[0,0] op_sel_hi:[1,0]
  v_pk_mul_f32 v[48:49], v[48:49], v[8:9] op_sel:[0,0] op_sel_hi:[1,0]
  v_pk_mul_f32 v[50:51], v[50:51], v[8:9] op_sel:[0,0] op_sel_hi:[1,0]
  v_cvt_pk_bf16_f32 v32, v32, v33
  v_cvt_pk_bf16_f32 v33, v34, v35
  v_cvt_pk_bf16_f32 v34, v48, v49
  v_cvt_pk_bf16_f32 v35, v50, v51
  v_accvgpr_read_b32 v240, a4
  v_accvgpr_read_b32 v241, a5
  v_accvgpr_read_b32 v242, a6
  v_accvgpr_read_b32 v243, a7
  v_pk_add_f32 v[240:241], v[240:241], v[68:69]
  v_pk_add_f32 v[242:243], v[242:243], v[70:71]
  v_accvgpr_read_b32 v36, a20
  v_accvgpr_read_b32 v37, a21
  v_accvgpr_read_b32 v38, a22
  v_accvgpr_read_b32 v39, a23
  s_waitcnt lgkmcnt(2)
  v_pk_add_f32 v[36:37], v[36:37], v[84:85]
  v_pk_add_f32 v[38:39], v[38:39], v[86:87]
  v_mfma_f32_16x16x32_bf16 v[24:27], a[48:51], v[32:35], v[24:27]
  v_pk_mul_f32 v[240:241], v[240:241], v[8:9] op_sel:[0,1] op_sel_hi:[1,1]
  v_pk_mul_f32 v[242:243], v[242:243], v[8:9] op_sel:[0,1] op_sel_hi:[1,1]
  v_pk_mul_f32 v[36:37], v[36:37], v[8:9] op_sel:[0,1] op_sel_hi:[1,1]
  v_pk_mul_f32 v[38:39], v[38:39], v[8:9] op_sel:[0,1] op_sel_hi:[1,1]
  v_cvt_pk_bf16_f32 v240, v240, v241
  v_cvt_pk_bf16_f32 v241, v242, v243
  v_cvt_pk_bf16_f32 v242, v36, v37
  v_cvt_pk_bf16_f32 v243, v38, v39
  v_accvgpr_read_b32 v52, a8
  v_accvgpr_read_b32 v53, a9
  v_accvgpr_read_b32 v54, a10
  v_accvgpr_read_b32 v55, a11
  v_pk_add_f32 v[52:53], v[52:53], v[72:73]
  v_pk_add_f32 v[54:55], v[54:55], v[74:75]
  v_accvgpr_read_b32 v244, a24
  v_accvgpr_read_b32 v245, a25
  v_accvgpr_read_b32 v246, a26
  v_accvgpr_read_b32 v247, a27
  s_waitcnt lgkmcnt(1)
  v_pk_add_f32 v[244:245], v[244:245], v[88:89]
  v_pk_add_f32 v[246:247], v[246:247], v[90:91]
  v_mfma_f32_16x16x32_bf16 v[24:27], a[48:51], v[240:243], v[24:27]
  v_pk_mul_f32 v[52:53], v[52:53], v[10:11] op_sel:[0,0] op_sel_hi:[1,0]
  v_pk_mul_f32 v[54:55], v[54:55], v[10:11] op_sel:[0,0] op_sel_hi:[1,0]
  v_pk_mul_f32 v[244:245], v[244:245], v[10:11] op_sel:[0,0] op_sel_hi:[1,0]
  v_pk_mul_f32 v[246:247], v[246:247], v[10:11] op_sel:[0,0] op_sel_hi:[1,0]
  v_cvt_pk_bf16_f32 v52, v52, v53
  v_cvt_pk_bf16_f32 v53, v54, v55
  v_cvt_pk_bf16_f32 v54, v244, v245
  v_cvt_pk_bf16_f32 v55, v246, v247
  v_accvgpr_read_b32 v40, a12
  v_accvgpr_read_b32 v41, a13
  v_accvgpr_read_b32 v42, a14
  v_accvgpr_read_b32 v43, a15
  v_pk_add_f32 v[40:41], v[40:41], v[76:77]
  v_pk_add_f32 v[42:43], v[42:43], v[78:79]
  v_accvgpr_read_b32 v56, a28
  v_accvgpr_read_b32 v57, a29
  v_accvgpr_read_b32 v58, a30
  v_accvgpr_read_b32 v59, a31
  s_waitcnt lgkmcnt(0)
  v_pk_add_f32 v[56:57], v[56:57], v[92:93]
  v_pk_add_f32 v[58:59], v[58:59], v[94:95]
  v_mfma_f32_16x16x32_bf16 v[24:27], a[48:51], v[52:55], v[24:27]
  v_pk_mul_f32 v[40:41], v[40:41], v[10:11] op_sel:[0,1] op_sel_hi:[1,1]
  v_pk_mul_f32 v[42:43], v[42:43], v[10:11] op_sel:[0,1] op_sel_hi:[1,1]
  v_pk_mul_f32 v[56:57], v[56:57], v[10:11] op_sel:[0,1] op_sel_hi:[1,1]
  v_pk_mul_f32 v[58:59], v[58:59], v[10:11] op_sel:[0,1] op_sel_hi:[1,1]
  v_cvt_pk_bf16_f32 v40, v40, v41
  v_cvt_pk_bf16_f32 v41, v42, v43
  v_cvt_pk_bf16_f32 v42, v56, v57
  v_cvt_pk_bf16_f32 v43, v58, v59
  s_nop 1
  v_mfma_f32_16x16x32_bf16 v[24:27], a[48:51], v[40:43], v[24:27]
  v_cmp_lt_u32 vcc, 0x3c000000, v12
  s_nop 6
  v_cmp_class_f32 s[40:41], v24, s64
  s_nop 0
  s_or_b64 vcc, vcc, s[40:41]
  s_cbranch_vccnz Lbad_5
  s_lshl_b32 s33, s35, 3
  s_lshl_b32 s34, s23, 2
  s_add_u32 s33, s33, s34
  s_lshl_b32 s33, s33, 17
  s_lshl_b32 s34, s20, 12
  s_add_u32 s36, s33, s34
  s_add_u32 s37, s36, 131072
  s_add_u32 s38, s36, 262144
  s_add_u32 s39, s36, 393216
  buffer_store_dwordx4 v[224:227], v1, s[16:19], s36 offen offset:2048
  buffer_store_dwordx4 v[228:231], v1, s[16:19], s37 offen offset:2048
  buffer_store_dwordx4 v[232:235], v1, s[16:19], s38 offen offset:2048
  buffer_store_dwordx4 v[236:239], v1, s[16:19], s39 offen offset:2048
  buffer_store_dwordx4 v[32:35], v1, s[16:19], s36 offen offset:3072
  buffer_store_dwordx4 v[240:243], v1, s[16:19], s37 offen offset:3072
  buffer_store_dwordx4 v[52:55], v1, s[16:19], s38 offen offset:3072
  buffer_store_dwordx4 v[40:43], v1, s[16:19], s39 offen offset:3072
  s_branch Lfd_6
Lbad_5:
  s_or_b32 s60, s60, 2
Lfd_6:
Lk2_chk:
  s_cmp_eq_u32 s60, 0
  s_cbranch_scc1 Lk2_done
  s_sub_u32 s56, 15, s21
  s_lshl_b32 s33, s24, 1
  s_lshl_b32 s61, 3, s33
  s_and_b32 s34, s60, 2
  s_bitcmp1_b32 s60, 0
  s_cselect_b32 s56, s21, s56
  s_cselect_b32 s61, 15, s61
  s_cselect_b32 s60, s34, 0
  s_waitcnt vmcnt(0)
  s_lshl_b32 s33, s20, 7
  s_lshl_b32 s34, s56, 3
  s_add_u32 s33, s33, s34
  s_lshl_b32 s34, s23, 2
  s_add_u32 s33, s33, s34
  s_lshl_b32 s33, s33, 12
  buffer_load_dwordx4 a[52:55], v1, s[8:11], s33 offen offset:0
  buffer_load_dwordx4 a[56:59], v1, s[8:11], s33 offen offset:1024
  buffer_load_dwordx4 a[60:63], v1, s[8:11], s33 offen offset:2048
  buffer_load_dwordx4 a[64:67], v1, s[8:11], s33 offen offset:3072
  s_add_u32 s33, s33, 4096
  buffer_load_dwordx4 a[68:71], v1, s[8:11], s33 offen offset:0
  buffer_load_dwordx4 a[72:75], v1, s[8:11], s33 offen offset:1024
  buffer_load_dwordx4 a[76:79], v1, s[8:11], s33 offen offset:2048
  buffer_load_dwordx4 a[80:83], v1, s[8:11], s33 offen offset:3072
  s_add_u32 s33, s33, 4096
  buffer_load_dwordx4 a[84:87], v1, s[8:11], s33 offen offset:0
  buffer_load_dwordx4 a[88:91], v1, s[8:11], s33 offen offset:1024
  buffer_load_dwordx4 a[92:95], v1, s[8:11], s33 offen offset:2048
  buffer_load_dwordx4 a[96:99], v1, s[8:11], s33 offen offset:3072
  s_add_u32 s33, s33, 4096
  buffer_load_dwordx4 a[100:103], v1, s[8:11], s33 offen offset:0
  buffer_load_dwordx4 a[104:107], v1, s[8:11], s33 offen offset:1024
  buffer_load_dwordx4 a[108:111], v1, s[8:11], s33 offen offset:2048
  buffer_load_dwordx4 a[112:115], v1, s[8:11], s33 offen offset:3072
  v_accvgpr_write_b32 a0, 0
  v_accvgpr_write_b32 a1, 0
  v_accvgpr_write_b32 a2, 0
  v_accvgpr_write_b32 a3, 0
  v_accvgpr_write_b32 a4, 0
  v_accvgpr_write_b32 a5, 0
  v_accvgpr_write_b32 a6, 0
  v_accvgpr_write_b32 a7, 0
  v_accvgpr_write_b32 a8, 0
  v_accvgpr_write_b32 a9, 0
  v_accvgpr_write_b32 a10, 0
  v_accvgpr_write_b32 a11, 0
  v_accvgpr_write_b32 a12, 0
  v_accvgpr_write_b32 a13, 0
  v_accvgpr_write_b32 a14, 0
  v_accvgpr_write_b32 a15, 0
  v_accvgpr_write_b32 a16, 0
  v_accvgpr_write_b32 a17, 0
  v_accvgpr_write_b32 a18, 0
  v_accvgpr_write_b32 a19, 0
  v_accvgpr_write_b32 a20, 0
  v_accvgpr_write_b32 a21, 0
  v_accvgpr_write_b32 a22, 0
  v_accvgpr_write_b32 a23, 0
  v_accvgpr_write_b32 a24, 0
  v_accvgpr_write_b32 a25, 0
  v_accvgpr_write_b32 a26, 0
  v_accvgpr_write_b32 a27, 0
  v_accvgpr_write_b32 a28, 0
  v_accvgpr_write_b32 a29, 0
  v_accvgpr_write_b32 a30, 0
  v_accvgpr_write_b32 a31, 0
  v_accvgpr_write_b32 a32, 0
  v_accvgpr_write_b32 a33, 0
  v_accvgpr_write_b32 a34, 0
  v_accvgpr_write_b32 a35, 0
  v_accvgpr_write_b32 a36, 0
  v_accvgpr_write_b32 a37, 0
  v_accvgpr_write_b32 a38, 0
  v_accvgpr_write_b32 a39, 0
  v_accvgpr_write_b32 a40, 0
  v_accvgpr_write_b32 a41, 0
  v_accvgpr_write_b32 a42, 0
  v_accvgpr_write_b32 a43, 0
  v_accvgpr_write_b32 a44, 0
  v_accvgpr_write_b32 a45, 0
  v_accvgpr_write_b32 a46, 0
  v_accvgpr_write_b32 a47, 0
  v_mov_b32 v160, 0
  v_mov_b32 v161, 0
  v_mov_b32 v162, 0
  v_mov_b32 v163, 0
  v_mov_b32 v164, 0
  v_mov_b32 v165, 0
  v_mov_b32 v166, 0
  v_mov_b32 v167, 0
  v_mov_b32 v168, 0
  v_mov_b32 v169, 0
  v_mov_b32 v170, 0
  v_mov_b32 v171, 0
  v_mov_b32 v172, 0
  v_mov_b32 v173, 0
  v_mov_b32 v174, 0
  v_mov_b32 v175, 0
  v_mov_b32 v176, 0
  v_mov_b32 v177, 0
  v_mov_b32 v178, 0
  v_mov_b32 v179, 0
  v_mov_b32 v180, 0
  v_mov_b32 v181, 0
  v_mov_b32 v182, 0
  v_mov_b32 v183, 0
  v_mov_b32 v184, 0
  v_mov_b32 v185, 0
  v_mov_b32 v186, 0
  v_mov_b32 v187, 0
  v_mov_b32 v188, 0
  v_mov_b32 v189, 0
  v_mov_b32 v190, 0
  v_mov_b32 v191, 0
  v_mov_b32 v192, 0
  v_mov_b32 v193, 0
  v_mov_b32 v194, 0
  v_mov_b32 v195, 0
  v_mov_b32 v196, 0
  v_mov_b32 v197, 0
  v_mov_b32 v198, 0
  v_mov_b32 v199, 0
  v_mov_b32 v200, 0
  v_mov_b32 v201, 0
  v_mov_b32 v202, 0
  v_mov_b32 v203, 0
  v_mov_b32 v204, 0
  v_mov_b32 v205, 0
  v_mov_b32 v206, 0
  v_mov_b32 v207, 0
  v_mov_b32 v208, 0
  v_mov_b32 v209, 0
  v_mov_b32 v210, 0
  v_mov_b32 v211, 0
  v_mov_b32 v212, 0
  v_mov_b32 v213, 0
  v_mov_b32 v214, 0
  v_mov_b32 v215, 0
  v_mov_b32 v216, 0
  v_mov_b32 v217, 0
  v_mov_b32 v218, 0
  v_mov_b32 v219, 0
  v_mov_b32 v220, 0
  v_mov_b32 v221, 0
  v_mov_b32 v222, 0
  v_mov_b32 v223, 0
  v_mov_b32 v224, 0
  v_mov_b32 v225, 0
  v_mov_b32 v226, 0
  v_mov_b32 v227, 0
  v_mov_b32 v228, 0
  v_mov_b32 v229, 0
  v_mov_b32 v230, 0
  v_mov_b32 v231, 0
  v_mov_b32 v232, 0
  v_mov_b32 v233, 0
  v_mov_b32 v234, 0
  v_mov_b32 v235, 0
  v_mov_b32 v236, 0
  v_mov_b32 v237, 0
  v_mov_b32 v238, 0
  v_mov_b32 v239, 0
  v_mov_b32 v240, 0
  v_mov_b32 v241, 0
  v_mov_b32 v242, 0
  v_mov_b32 v243, 0
  v_mov_b32 v244, 0
  v_mov_b32 v245, 0
  v_mov_b32 v246, 0
  v_mov_b32 v247, 0
  v_mov_b32 v248, 0
  v_mov_b32 v249, 0
  v_mov_b32 v250, 0
  v_mov_b32 v251, 0
  v_mov_b32 v252, 0
  v_mov_b32 v253, 0
  v_mov_b32 v254, 0
  v_mov_b32 v255, 0
  v_mov_b32 v8, v4
  v_mov_b32 v9, v4
  v_mov_b32 v10, v4
  v_mov_b32 v11, v4
  s_lshl_b32 s57, s20, 20
  s_lshl_b32 s58, s56, 7
  s_lshl_b32 s59, s56, 1
  s_add_u32 s59, s59, 2
Lslow_7:
  s_add_u32 s35, s57, 0
  buffer_load_dwordx4 v[96:99], v1, s[12:15], s35 offen offset:0
  buffer_load_dwordx4 v[100:103], v1, s[12:15], s35 offen offset:1024
  buffer_load_dwordx4 v[104:107], v1, s[12:15], s35 offen offset:2048
  buffer_load_dwordx4 v[108:111], v1, s[12:15], s35 offen offset:3072
  s_add_u32 s35, s57, 4096
  buffer_load_dwordx4 v[112:115], v1, s[12:15], s35 offen offset:0
  buffer_load_dwordx4 v[116:119], v1, s[12:15], s35 offen offset:1024
  buffer_load_dwordx4 v[120:123], v1, s[12:15], s35 offen offset:2048
  buffer_load_dwordx4 v[124:127], v1, s[12:15], s35 offen offset:3072
  s_add_u32 s35, s57, 8192
  buffer_load_dwordx4 v[128:131], v1, s[12:15], s35 offen offset:0
  buffer_load_dwordx4 v[132:135], v1, s[12:15], s35 offen offset:1024
  buffer_load_dwordx4 v[136:139], v1, s[12:15], s35 offen offset:2048
  buffer_load_dwordx4 v[140:143], v1, s[12:15], s35 offen offset:3072
  s_add_u32 s35, s57, 12288
  buffer_load_dwordx4 v[144:147], v1, s[12:15], s35 offen offset:0
  buffer_load_dwordx4 v[148:151], v1, s[12:15], s35 offen offset:1024
  buffer_load_dwordx4 v[152:155], v1, s[12:15], s35 offen offset:2048
  buffer_load_dwordx4 v[156:159], v1, s[12:15], s35 offen offset:3072
  s_lshl_b32 s33, s23, 6
  s_add_i32 s33, s33, s58
  s_cmp_gt_i32 s33, 0
  s_cselect_b32 s34, 0, 0xf149f2ca
  s_cmp_lt_i32 s33, 0
  s_cselect_b32 s33, 0xf149f2ca, 0
  v_mov_b32 v20, s34
  v_mov_b32 v21, s34
  v_mov_b32 v22, s34
  v_mov_b32 v23, s34
  v_mov_b32 v28, s33
  v_mov_b32 v29, s33
  v_mov_b32 v30, s33
  v_mov_b32 v31, s33
  v_med3_f32 v24, v16, v20, v28
  v_med3_f32 v25, v17, v20, v28
  v_med3_f32 v26, v18, v20, v28
  v_med3_f32 v27, v19, v20, v28
  s_waitcnt vmcnt(0)
  s_nop 0
  v_mfma_f32_16x16x32_bf16 v[32:35], v[96:99], a[52:55], v[24:27]
  v_mfma_f32_16x16x32_bf16 v[32:35], v[100:103], a[56:59], v[32:35]
  v_mfma_f32_16x16x32_bf16 v[32:35], v[104:107], a[60:63], v[32:35]
  v_mfma_f32_16x16x32_bf16 v[32:35], v[108:111], a[64:67], v[32:35]
  v_mfma_f32_16x16x32_bf16 v[36:39], v[96:99], a[68:71], v[28:31]
  v_mfma_f32_16x16x32_bf16 v[36:39], v[100:103], a[72:75], v[36:39]
  v_mfma_f32_16x16x32_bf16 v[36:39], v[104:107], a[76:79], v[36:39]
  v_mfma_f32_16x16x32_bf16 v[36:39], v[108:111], a[80:83], v[36:39]
  v_mfma_f32_16x16x32_bf16 v[40:43], v[96:99], a[84:87], v[28:31]
  v_mfma_f32_16x16x32_bf16 v[40:43], v[100:103], a[88:91], v[40:43]
  v_mfma_f32_16x16x32_bf16 v[40:43], v[104:107], a[92:95], v[40:43]
  v_mfma_f32_16x16x32_bf16 v[40:43], v[108:111], a[96:99], v[40:43]
  v_mfma_f32_16x16x32_bf16 v[44:47], v[96:99], a[100:103], v[28:31]
  v_mfma_f32_16x16x32_bf16 v[44:47], v[100:103], a[104:107], v[44:47]
  v_mfma_f32_16x16x32_bf16 v[44:47], v[104:107], a[108:111], v[44:47]
  v_mfma_f32_16x16x32_bf16 v[44:47], v[108:111], a[112:115], v[44:47]
  v_mfma_f32_16x16x32_bf16 v[48:51], v[112:115], a[52:55], v[20:23]
  v_mfma_f32_16x16x32_bf16 v[48:51], v[116:119], a[56:59], v[48:51]
  v_mfma_f32_16x16x32_bf16 v[48:51], v[120:123], a[60:63], v[48:51]
  v_mfma_f32_16x16x32_bf16 v[48:51], v[124:127], a[64:67], v[48:51]
  v_mfma_f32_16x16x32_bf16 v[52:55], v[112:115], a[68:71], v[24:27]
  v_mfma_f32_16x16x32_bf16 v[52:55], v[116:119], a[72:75], v[52:55]
  v_mfma_f32_16x16x32_bf16 v[52:55], v[120:123], a[76:79], v[52:55]
  v_mfma_f32_16x16x32_bf16 v[52:55], v[124:127], a[80:83], v[52:55]
  v_mfma_f32_16x16x32_bf16 v[56:59], v[112:115], a[84:87], v[28:31]
  v_mfma_f32_16x16x32_bf16 v[56:59], v[116:119], a[88:91], v[56:59]
  v_mfma_f32_16x16x32_bf16 v[56:59], v[120:123], a[92:95], v[56:59]
  v_mfma_f32_16x16x32_bf16 v[56:59], v[124:127], a[96:99], v[56:59]
  v_mfma_f32_16x16x32_bf16 v[60:63], v[112:115], a[100:103], v[28:31]
  v_mfma_f32_16x16x32_bf16 v[60:63], v[116:119], a[104:107], v[60:63]
  v_mfma_f32_16x16x32_bf16 v[60:63], v[120:123], a[108:111], v[60:63]
  v_mfma_f32_16x16x32_bf16 v[60:63], v[124:127], a[112:115], v[60:63]
  v_mfma_f32_16x16x32_bf16 v[64:67], v[128:131], a[52:55], v[20:23]
  v_mfma_f32_16x16x32_bf16 v[64:67], v[132:135], a[56:59], v[64:67]
  v_mfma_f32_16x16x32_bf16 v[64:67], v[136:139], a[60:63], v[64:67]
  v_mfma_f32_16x16x32_bf16 v[64:67], v[140:143], a[64:67], v[64:67]
  v_mfma_f32_16x16x32_bf16 v[68:71], v[128:131], a[68:71], v[20:23]
  v_mfma_f32_16x16x32_bf16 v[68:71], v[132:135], a[72:75], v[68:71]
  v_mfma_f32_16x16x32_bf16 v[68:71], v[136:139], a[76:79], v[68:71]
  v_mfma_f32_16x16x32_bf16 v[68:71], v[140:143], a[80:83], v[68:71]
  v_mfma_f32_16x16x32_bf16 v[72:75], v[128:131], a[84:87], v[24:27]
  v_mfma_f32_16x16x32_bf16 v[72:75], v[132:135], a[88:91], v[72:75]
  v_mfma_f32_16x16x32_bf16 v[72:75], v[136:139], a[92:95], v[72:75]
  v_mfma_f32_16x16x32_bf16 v[72:75], v[140:143], a[96:99], v[72:75]
  v_mfma_f32_16x16x32_bf16 v[76:79], v[128:131], a[100:103], v[28:31]
  v_mfma_f32_16x16x32_bf16 v[76:79], v[132:135], a[104:107], v[76:79]
  v_mfma_f32_16x16x32_bf16 v[76:79], v[136:139], a[108:111], v[76:79]
  v_mfma_f32_16x16x32_bf16 v[76:79], v[140:143], a[112:115], v[76:79]
  v_mfma_f32_16x16x32_bf16 v[80:83], v[144:147], a[52:55], v[20:23]
  v_mfma_f32_16x16x32_bf16 v[80:83], v[148:151], a[56:59], v[80:83]
  v_mfma_f32_16x16x32_bf16 v[80:83], v[152:155], a[60:63], v[80:83]
  v_mfma_f32_16x16x32_bf16 v[80:83], v[156:159], a[64:67], v[80:83]
  v_mfma_f32_16x16x32_bf16 v[84:87], v[144:147], a[68:71], v[20:23]
  v_mfma_f32_16x16x32_bf16 v[84:87], v[148:151], a[72:75], v[84:87]
  v_mfma_f32_16x16x32_bf16 v[84:87], v[152:155], a[76:79], v[84:87]
  v_mfma_f32_16x16x32_bf16 v[84:87], v[156:159], a[80:83], v[84:87]
  v_mfma_f32_16x16x32_bf16 v[88:91], v[144:147], a[84:87], v[20:23]
  v_mfma_f32_16x16x32_bf16 v[88:91], v[148:151], a[88:91], v[88:91]
  v_mfma_f32_16x16x32_bf16 v[88:91], v[152:155], a[92:95], v[88:91]
  v_mfma_f32_16x16x32_bf16 v[88:91], v[156:159], a[96:99], v[88:91]
  v_mfma_f32_16x16x32_bf16 v[92:95], v[144:147], a[100:103], v[24:27]
  v_mfma_f32_16x16x32_bf16 v[92:95], v[148:151], a[104:107], v[92:95]
  v_mfma_f32_16x16x32_bf16 v[92:95], v[152:155], a[108:111], v[92:95]
  v_mfma_f32_16x16x32_bf16 v[92:95], v[156:159], a[112:115], v[92:95]
  s_nop 7
  s_add_u32 s35, s57, 16384
  buffer_load_dwordx4 v[96:99], v1, s[12:15], s35 offen offset:0
  buffer_load_dwordx4 v[100:103], v1, s[12:15], s35 offen offset:1024
  buffer_load_dwordx4 v[104:107], v1, s[12:15], s35 offen offset:2048
  buffer_load_dwordx4 v[108:111], v1, s[12:15], s35 offen offset:3072
  s_add_u32 s35, s57, 20480
  buffer_load_dwordx4 v[112:115], v1, s[12:15], s35 offen offset:0
  buffer_load_dwordx4 v[116:119], v1, s[12:15], s35 offen offset:1024
  buffer_load_dwordx4 v[120:123], v1, s[12:15], s35 offen offset:2048
  buffer_load_dwordx4 v[124:127], v1, s[12:15], s35 offen offset:3072
  s_add_u32 s35, s57, 24576
  buffer_load_dwordx4 v[128:131], v1, s[12:15], s35 offen offset:0
  buffer_load_dwordx4 v[132:135], v1, s[12:15], s35 offen offset:1024
  buffer_load_dwordx4 v[136:139], v1, s[12:15], s35 offen offset:2048
  buffer_load_dwordx4 v[140:143], v1, s[12:15], s35 offen offset:3072
  s_add_u32 s35, s57, 28672
  buffer_load_dwordx4 v[144:147], v1, s[12:15], s35 offen offset:0
  buffer_load_dwordx4 v[148:151], v1, s[12:15], s35 offen offset:1024
  buffer_load_dwordx4 v[152:155], v1, s[12:15], s35 offen offset:2048
  buffer_load_dwordx4 v[156:159], v1, s[12:15], s35 offen offset:3072
  v_max3_f32 v13, v32, v33, v8
  v_max3_f32 v13, v13, v34, v35
  v_max3_f32 v13, v13, v48, v49
  v_max3_f32 v13, v13, v50, v51
  v_max3_f32 v13, v13, v64, v65
  v_max3_f32 v13, v13, v66, v67
  v_max3_f32 v13, v13, v80, v81
  v_max3_f32 v13, v13, v82, v83
  v_mov_b32 v14, v13
  s_nop 1
  v_permlane16_swap_b32 v13, v14
  v_max_f32 v13, v13, v14
  v_mov_b32 v14, v13
  s_nop 1
  v_permlane32_swap_b32 v13, v14
  v_max_f32 v13, v13, v14
  v_sub_f32 v12, v8, v13
  v_exp_f32 v12, v12
  v_mov_b32 v8, v13
  v_sub_f32 v32, v32, v13
  v_sub_f32 v33, v33, v13
  v_sub_f32 v34, v34, v13
  v_sub_f32 v35, v35, v13
  v_sub_f32 v48, v48, v13
  v_sub_f32 v49, v49, v13
  v_sub_f32 v50, v50, v13
  v_sub_f32 v51, v51, v13
  v_sub_f32 v64, v64, v13
  v_sub_f32 v65, v65, v13
  v_sub_f32 v66, v66, v13
  v_sub_f32 v67, v67, v13
  v_sub_f32 v80, v80, v13
  v_sub_f32 v81, v81, v13
  v_sub_f32 v82, v82, v13
  v_sub_f32 v83, v83, v13
  v_mul_f32 v160, v160, v12
  v_mul_f32 v161, v161, v12
  v_mul_f32 v162, v162, v12
  v_mul_f32 v163, v163, v12
  v_mul_f32 v176, v176, v12
  v_mul_f32 v177, v177, v12
  v_mul_f32 v178, v178, v12
  v_mul_f32 v179, v179, v12
  v_mul_f32 v192, v192, v12
  v_mul_f32 v193, v193, v12
  v_mul_f32 v194, v194, v12
  v_mul_f32 v195, v195, v12
  v_mul_f32 v208, v208, v12
  v_mul_f32 v209, v209, v12
  v_mul_f32 v210, v210, v12
  v_mul_f32 v211, v211, v12
  v_mul_f32 v224, v224, v12
  v_mul_f32 v225, v225, v12
  v_mul_f32 v226, v226, v12
  v_mul_f32 v227, v227, v12
  v_mul_f32 v240, v240, v12
  v_mul_f32 v241, v241, v12
  v_mul_f32 v242, v242, v12
  v_mul_f32 v243, v243, v12
  v_accvgpr_read_b32 v14, a0
  v_mul_f32 v14, v14, v12
  v_accvgpr_write_b32 a0, v14
  v_accvgpr_read_b32 v14, a1
  v_mul_f32 v14, v14, v12
  v_accvgpr_write_b32 a1, v14
  v_accvgpr_read_b32 v14, a2
  v_mul_f32 v14, v14, v12
  v_accvgpr_write_b32 a2, v14
  v_accvgpr_read_b32 v14, a3
  v_mul_f32 v14, v14, v12
  v_accvgpr_write_b32 a3, v14
  v_accvgpr_read_b32 v14, a16
  v_mul_f32 v14, v14, v12
  v_accvgpr_write_b32 a16, v14
  v_accvgpr_read_b32 v14, a17
  v_mul_f32 v14, v14, v12
  v_accvgpr_write_b32 a17, v14
  v_accvgpr_read_b32 v14, a18
  v_mul_f32 v14, v14, v12
  v_accvgpr_write_b32 a18, v14
  v_accvgpr_read_b32 v14, a19
  v_mul_f32 v14, v14, v12
  v_accvgpr_write_b32 a19, v14
  v_accvgpr_read_b32 v14, a32
  v_mul_f32 v14, v14, v12
  v_accvgpr_write_b32 a32, v14
  v_accvgpr_read_b32 v14, a33
  v_mul_f32 v14, v14, v12
  v_accvgpr_write_b32 a33, v14
  v_accvgpr_read_b32 v14, a34
  v_mul_f32 v14, v14, v12
  v_accvgpr_write_b32 a34, v14
  v_accvgpr_read_b32 v14, a35
  v_mul_f32 v14, v14, v12
  v_accvgpr_write_b32 a35, v14
  v_max3_f32 v13, v36, v37, v9
  v_max3_f32 v13, v13, v38, v39
  v_max3_f32 v13, v13, v52, v53
  v_max3_f32 v13, v13, v54, v55
  v_max3_f32 v13, v13, v68, v69
  v_max3_f32 v13, v13, v70, v71
  v_max3_f32 v13, v13, v84, v85
  v_max3_f32 v13, v13, v86, v87
  v_mov_b32 v14, v13
  s_nop 1
  v_permlane16_swap_b32 v13, v14
  v_max_f32 v13, v13, v14
  v_mov_b32 v14, v13
  s_nop 1
  v_permlane32_swap_b32 v13, v14
  v_max_f32 v13, v13, v14
  v_sub_f32 v12, v9, v13
  v_exp_f32 v12, v12
  v_mov_b32 v9, v13
  v_sub_f32 v36, v36, v13
  v_sub_f32 v37, v37, v13
  v_sub_f32 v38, v38, v13
  v_sub_f32 v39, v39, v13
  v_sub_f32 v52, v52, v13
  v_sub_f32 v53, v53, v13
  v_sub_f32 v54, v54, v13
  v_sub_f32 v55, v55, v13
  v_sub_f32 v68, v68, v13
  v_sub_f32 v69, v69, v13
  v_sub_f32 v70, v70, v13
  v_sub_f32 v71, v71, v13
  v_sub_f32 v84, v84, v13
  v_sub_f32 v85, v85, v13
  v_sub_f32 v86, v86, v13
  v_sub_f32 v87, v87, v13
  v_mul_f32 v164, v164, v12
  v_mul_f32 v165, v165, v12
  v_mul_f32 v166, v166, v12
  v_mul_f32 v167, v167, v12
  v_mul_f32 v180, v180, v12
  v_mul_f32 v181, v181, v12
  v_mul_f32 v182, v182, v12
  v_mul_f32 v183, v183, v12
  v_mul_f32 v196, v196, v12
  v_mul_f32 v197, v197, v12
  v_mul_f32 v198, v198, v12
  v_mul_f32 v199, v199, v12
  v_mul_f32 v212, v212, v12
  v_mul_f32 v213, v213, v12
  v_mul_f32 v214, v214, v12
  v_mul_f32 v215, v215, v12
  v_mul_f32 v228, v228, v12
  v_mul_f32 v229, v229, v12
  v_mul_f32 v230, v230, v12
  v_mul_f32 v231, v231, v12
  v_mul_f32 v244, v244, v12
  v_mul_f32 v245, v245, v12
  v_mul_f32 v246, v246, v12
  v_mul_f32 v247, v247, v12
  v_accvgpr_read_b32 v14, a4
  v_mul_f32 v14, v14, v12
  v_accvgpr_write_b32 a4, v14
  v_accvgpr_read_b32 v14, a5
  v_mul_f32 v14, v14, v12
  v_accvgpr_write_b32 a5, v14
  v_accvgpr_read_b32 v14, a6
  v_mul_f32 v14, v14, v12
  v_accvgpr_write_b32 a6, v14
  v_accvgpr_read_b32 v14, a7
  v_mul_f32 v14, v14, v12
  v_accvgpr_write_b32 a7, v14
  v_accvgpr_read_b32 v14, a20
  v_mul_f32 v14, v14, v12
  v_accvgpr_write_b32 a20, v14
  v_accvgpr_read_b32 v14, a21
  v_mul_f32 v14, v14, v12
  v_accvgpr_write_b32 a21, v14
  v_accvgpr_read_b32 v14, a22
  v_mul_f32 v14, v14, v12
  v_accvgpr_write_b32 a22, v14
  v_accvgpr_read_b32 v14, a23
  v_mul_f32 v14, v14, v12
  v_accvgpr_write_b32 a23, v14
  v_accvgpr_read_b32 v14, a36
  v_mul_f32 v14, v14, v12
  v_accvgpr_write_b32 a36, v14
  v_accvgpr_read_b32 v14, a37
  v_mul_f32 v14, v14, v12
  v_accvgpr_write_b32 a37, v14
  v_accvgpr_read_b32 v14, a38
  v_mul_f32 v14, v14, v12
  v_accvgpr_write_b32 a38, v14
  v_accvgpr_read_b32 v14, a39
  v_mul_f32 v14, v14, v12
  v_accvgpr_write_b32 a39, v14
  v_max3_f32 v13, v40, v41, v10
  v_max3_f32 v13, v13, v42, v43
  v_max3_f32 v13, v13, v56, v57
  v_max3_f32 v13, v13, v58, v59
  v_max3_f32 v13, v13, v72, v73
  v_max3_f32 v13, v13, v74, v75
  v_max3_f32 v13, v13, v88, v89
  v_max3_f32 v13, v13, v90, v91
  v_mov_b32 v14, v13
  s_nop 1
  v_permlane16_swap_b32 v13, v14
  v_max_f32 v13, v13, v14
  v_mov_b32 v14, v13
  s_nop 1
  v_permlane32_swap_b32 v13, v14
  v_max_f32 v13, v13, v14
  v_sub_f32 v12, v10, v13
  v_exp_f32 v12, v12
  v_mov_b32 v10, v13
  v_sub_f32 v40, v40, v13
  v_sub_f32 v41, v41, v13
  v_sub_f32 v42, v42, v13
  v_sub_f32 v43, v43, v13
  v_sub_f32 v56, v56, v13
  v_sub_f32 v57, v57, v13
  v_sub_f32 v58, v58, v13
  v_sub_f32 v59, v59, v13
  v_sub_f32 v72, v72, v13
  v_sub_f32 v73, v73, v13
  v_sub_f32 v74, v74, v13
  v_sub_f32 v75, v75, v13
  v_sub_f32 v88, v88, v13
  v_sub_f32 v89, v89, v13
  v_sub_f32 v90, v90, v13
  v_sub_f32 v91, v91, v13
  v_mul_f32 v168, v168, v12
  v_mul_f32 v169, v169, v12
  v_mul_f32 v170, v170, v12
  v_mul_f32 v171, v171, v12
  v_mul_f32 v184, v184, v12
  v_mul_f32 v185, v185, v12
  v_mul_f32 v186, v186, v12
  v_mul_f32 v187, v187, v12
  v_mul_f32 v200, v200, v12
  v_mul_f32 v201, v201, v12
  v_mul_f32 v202, v202, v12
  v_mul_f32 v203, v203, v12
  v_mul_f32 v216, v216, v12
  v_mul_f32 v217, v217, v12
  v_mul_f32 v218, v218, v12
  v_mul_f32 v219, v219, v12
  v_mul_f32 v232, v232, v12
  v_mul_f32 v233, v233, v12
  v_mul_f32 v234, v234, v12
  v_mul_f32 v235, v235, v12
  v_mul_f32 v248, v248, v12
  v_mul_f32 v249, v249, v12
  v_mul_f32 v250, v250, v12
  v_mul_f32 v251, v251, v12
  v_accvgpr_read_b32 v14, a8
  v_mul_f32 v14, v14, v12
  v_accvgpr_write_b32 a8, v14
  v_accvgpr_read_b32 v14, a9
  v_mul_f32 v14, v14, v12
  v_accvgpr_write_b32 a9, v14
  v_accvgpr_read_b32 v14, a10
  v_mul_f32 v14, v14, v12
  v_accvgpr_write_b32 a10, v14
  v_accvgpr_read_b32 v14, a11
  v_mul_f32 v14, v14, v12
  v_accvgpr_write_b32 a11, v14
  v_accvgpr_read_b32 v14, a24
  v_mul_f32 v14, v14, v12
  v_accvgpr_write_b32 a24, v14
  v_accvgpr_read_b32 v14, a25
  v_mul_f32 v14, v14, v12
  v_accvgpr_write_b32 a25, v14
  v_accvgpr_read_b32 v14, a26
  v_mul_f32 v14, v14, v12
  v_accvgpr_write_b32 a26, v14
  v_accvgpr_read_b32 v14, a27
  v_mul_f32 v14, v14, v12
  v_accvgpr_write_b32 a27, v14
  v_accvgpr_read_b32 v14, a40
  v_mul_f32 v14, v14, v12
  v_accvgpr_write_b32 a40, v14
  v_accvgpr_read_b32 v14, a41
  v_mul_f32 v14, v14, v12
  v_accvgpr_write_b32 a41, v14
  v_accvgpr_read_b32 v14, a42
  v_mul_f32 v14, v14, v12
  v_accvgpr_write_b32 a42, v14
  v_accvgpr_read_b32 v14, a43
  v_mul_f32 v14, v14, v12
  v_accvgpr_write_b32 a43, v14
  v_max3_f32 v13, v44, v45, v11
  v_max3_f32 v13, v13, v46, v47
  v_max3_f32 v13, v13, v60, v61
  v_max3_f32 v13, v13, v62, v63
  v_max3_f32 v13, v13, v76, v77
  v_max3_f32 v13, v13, v78, v79
  v_max3_f32 v13, v13, v92, v93
  v_max3_f32 v13, v13, v94, v95
  v_mov_b32 v14, v13
  s_nop 1
  v_permlane16_swap_b32 v13, v14
  v_max_f32 v13, v13, v14
  v_mov_b32 v14, v13
  s_nop 1
  v_permlane32_swap_b32 v13, v14
  v_max_f32 v13, v13, v14
  v_sub_f32 v12, v11, v13
  v_exp_f32 v12, v12
  v_mov_b32 v11, v13
  v_sub_f32 v44, v44, v13
  v_sub_f32 v45, v45, v13
  v_sub_f32 v46, v46, v13
  v_sub_f32 v47, v47, v13
  v_sub_f32 v60, v60, v13
  v_sub_f32 v61, v61, v13
  v_sub_f32 v62, v62, v13
  v_sub_f32 v63, v63, v13
  v_sub_f32 v76, v76, v13
  v_sub_f32 v77, v77, v13
  v_sub_f32 v78, v78, v13
  v_sub_f32 v79, v79, v13
  v_sub_f32 v92, v92, v13
  v_sub_f32 v93, v93, v13
  v_sub_f32 v94, v94, v13
  v_sub_f32 v95, v95, v13
  v_mul_f32 v172, v172, v12
  v_mul_f32 v173, v173, v12
  v_mul_f32 v174, v174, v12
  v_mul_f32 v175, v175, v12
  v_mul_f32 v188, v188, v12
  v_mul_f32 v189, v189, v12
  v_mul_f32 v190, v190, v12
  v_mul_f32 v191, v191, v12
  v_mul_f32 v204, v204, v12
  v_mul_f32 v205, v205, v12
  v_mul_f32 v206, v206, v12
  v_mul_f32 v207, v207, v12
  v_mul_f32 v220, v220, v12
  v_mul_f32 v221, v221, v12
  v_mul_f32 v222, v222, v12
  v_mul_f32 v223, v223, v12
  v_mul_f32 v236, v236, v12
  v_mul_f32 v237, v237, v12
  v_mul_f32 v238, v238, v12
  v_mul_f32 v239, v239, v12
  v_mul_f32 v252, v252, v12
  v_mul_f32 v253, v253, v12
  v_mul_f32 v254, v254, v12
  v_mul_f32 v255, v255, v12
  v_accvgpr_read_b32 v14, a12
  v_mul_f32 v14, v14, v12
  v_accvgpr_write_b32 a12, v14
  v_accvgpr_read_b32 v14, a13
  v_mul_f32 v14, v14, v12
  v_accvgpr_write_b32 a13, v14
  v_accvgpr_read_b32 v14, a14
  v_mul_f32 v14, v14, v12
  v_accvgpr_write_b32 a14, v14
  v_accvgpr_read_b32 v14, a15
  v_mul_f32 v14, v14, v12
  v_accvgpr_write_b32 a15, v14
  v_accvgpr_read_b32 v14, a28
  v_mul_f32 v14, v14, v12
  v_accvgpr_write_b32 a28, v14
  v_accvgpr_read_b32 v14, a29
  v_mul_f32 v14, v14, v12
  v_accvgpr_write_b32 a29, v14
  v_accvgpr_read_b32 v14, a30
  v_mul_f32 v14, v14, v12
  v_accvgpr_write_b32 a30, v14
  v_accvgpr_read_b32 v14, a31
  v_mul_f32 v14, v14, v12
  v_accvgpr_write_b32 a31, v14
  v_accvgpr_read_b32 v14, a44
  v_mul_f32 v14, v14, v12
  v_accvgpr_write_b32 a44, v14
  v_accvgpr_read_b32 v14, a45
  v_mul_f32 v14, v14, v12
  v_accvgpr_write_b32 a45, v14
  v_accvgpr_read_b32 v14, a46
  v_mul_f32 v14, v14, v12
  v_accvgpr_write_b32 a46, v14
  v_accvgpr_read_b32 v14, a47
  v_mul_f32 v14, v14, v12
  v_accvgpr_write_b32 a47, v14
  v_exp_f32 v32, v32
  v_exp_f32 v33, v33
  v_exp_f32 v34, v34
  v_exp_f32 v35, v35
  v_exp_f32 v48, v48
  v_exp_f32 v49, v49
  v_exp_f32 v50, v50
  v_exp_f32 v51, v51
  v_cvt_pk_bf16_f32 v32, v32, v33
  v_cvt_pk_bf16_f32 v33, v34, v35
  v_exp_f32 v36, v36
  v_exp_f32 v37, v37
  v_exp_f32 v38, v38
  v_exp_f32 v39, v39
  v_cvt_pk_bf16_f32 v34, v48, v49
  v_cvt_pk_bf16_f32 v35, v50, v51
  v_exp_f32 v52, v52
  v_exp_f32 v53, v53
  v_exp_f32 v54, v54
  v_exp_f32 v55, v55
  v_cvt_pk_bf16_f32 v36, v36, v37
  v_cvt_pk_bf16_f32 v37, v38, v39
  v_exp_f32 v40, v40
  v_exp_f32 v41, v41
  v_exp_f32 v42, v42
  v_exp_f32 v43, v43
  v_cvt_pk_bf16_f32 v38, v52, v53
  v_cvt_pk_bf16_f32 v39, v54, v55
  v_exp_f32 v56, v56
  v_exp_f32 v57, v57
  v_exp_f32 v58, v58
  v_exp_f32 v59, v59
  v_cvt_pk_bf16_f32 v40, v40, v41
  v_cvt_pk_bf16_f32 v41, v42, v43
  v_exp_f32 v44, v44
  v_exp_f32 v45, v45
  v_exp_f32 v46, v46
  v_exp_f32 v47, v47
  v_cvt_pk_bf16_f32 v42, v56, v57
  v_cvt_pk_bf16_f32 v43, v58, v59
  v_exp_f32 v60, v60
  v_exp_f32 v61, v61
  v_exp_f32 v62, v62
  v_exp_f32 v63, v63
  v_cvt_pk_bf16_f32 v44, v44, v45
  v_cvt_pk_bf16_f32 v45, v46, v47
  v_cvt_pk_bf16_f32 v46, v60, v61
  v_cvt_pk_bf16_f32 v47, v62, v63
  v_exp_f32 v64, v64
  v_exp_f32 v65, v65
  v_exp_f32 v66, v66
  v_exp_f32 v67, v67
  v_exp_f32 v80, v80
  v_exp_f32 v81, v81
  v_exp_f32 v82, v82
  v_exp_f32 v83, v83
  v_cvt_pk_bf16_f32 v64, v64, v65
  v_cvt_pk_bf16_f32 v65, v66, v67
  v_exp_f32 v68, v68
  v_exp_f32 v69, v69
  v_exp_f32 v70, v70
  v_exp_f32 v71, v71
  v_cvt_pk_bf16_f32 v66, v80, v81
  v_cvt_pk_bf16_f32 v67, v82, v83
  v_exp_f32 v84, v84
  v_exp_f32 v85, v85
  v_exp_f32 v86, v86
  v_exp_f32 v87, v87
  v_cvt_pk_bf16_f32 v68, v68, v69
  v_cvt_pk_bf16_f32 v69, v70, v71
  v_exp_f32 v72, v72
  v_exp_f32 v73, v73
  v_exp_f32 v74, v74
  v_exp_f32 v75, v75
  v_cvt_pk_bf16_f32 v70, v84, v85
  v_cvt_pk_bf16_f32 v71, v86, v87
  v_exp_f32 v88, v88
  v_exp_f32 v89, v89
  v_exp_f32 v90, v90
  v_exp_f32 v91, v91
  v_cvt_pk_bf16_f32 v72, v72, v73
  v_cvt_pk_bf16_f32 v73, v74, v75
  v_exp_f32 v76, v76
  v_exp_f32 v77, v77
  v_exp_f32 v78, v78
  v_exp_f32 v79, v79
  v_cvt_pk_bf16_f32 v74, v88, v89
  v_cvt_pk_bf16_f32 v75, v90, v91
  v_exp_f32 v92, v92
  v_exp_f32 v93, v93
  v_exp_f32 v94, v94
  v_exp_f32 v95, v95
  v_cvt_pk_bf16_f32 v76, v76, v77
  v_cvt_pk_bf16_f32 v77, v78, v79
  v_cvt_pk_bf16_f32 v78, v92, v93
  v_cvt_pk_bf16_f32 v79, v94, v95
  s_waitcnt vmcnt(0)
  v_mfma_f32_16x16x32_bf16 a[32:35], a[48:51], v[32:35], a[32:35]
  v_mfma_f32_16x16x32_bf16 a[36:39], a[48:51], v[36:39], a[36:39]
  v_mfma_f32_16x16x32_bf16 a[40:43], a[48:51], v[40:43], a[40:43]
  v_mfma_f32_16x16x32_bf16 a[44:47], a[48:51], v[44:47], a[44:47]
  v_mfma_f32_16x16x32_bf16 v[160:163], v[96:99], v[32:35], v[160:163]
  v_mfma_f32_16x16x32_bf16 v[164:167], v[96:99], v[36:39], v[164:167]
  v_mfma_f32_16x16x32_bf16 v[168:171], v[96:99], v[40:43], v[168:171]
  v_mfma_f32_16x16x32_bf16 v[172:175], v[96:99], v[44:47], v[172:175]
  v_mfma_f32_16x16x32_bf16 v[176:179], v[100:103], v[32:35], v[176:179]
  v_mfma_f32_16x16x32_bf16 v[180:183], v[100:103], v[36:39], v[180:183]
  v_mfma_f32_16x16x32_bf16 v[184:187], v[100:103], v[40:43], v[184:187]
  v_mfma_f32_16x16x32_bf16 v[188:191], v[100:103], v[44:47], v[188:191]
  v_mfma_f32_16x16x32_bf16 v[192:195], v[104:107], v[32:35], v[192:195]
  v_mfma_f32_16x16x32_bf16 v[196:199], v[104:107], v[36:39], v[196:199]
  v_mfma_f32_16x16x32_bf16 v[200:203], v[104:107], v[40:43], v[200:203]
  v_mfma_f32_16x16x32_bf16 v[204:207], v[104:107], v[44:47], v[204:207]
  v_mfma_f32_16x16x32_bf16 v[208:211], v[108:111], v[32:35], v[208:211]
  v_mfma_f32_16x16x32_bf16 v[212:215], v[108:111], v[36:39], v[212:215]
  v_mfma_f32_16x16x32_bf16 v[216:219], v[108:111], v[40:43], v[216:219]
  v_mfma_f32_16x16x32_bf16 v[220:223], v[108:111], v[44:47], v[220:223]
  v_mfma_f32_16x16x32_bf16 v[224:227], v[112:115], v[32:35], v[224:227]
  v_mfma_f32_16x16x32_bf16 v[228:231], v[112:115], v[36:39], v[228:231]
  v_mfma_f32_16x16x32_bf16 v[232:235], v[112:115], v[40:43], v[232:235]
  v_mfma_f32_16x16x32_bf16 v[236:239], v[112:115], v[44:47], v[236:239]
  v_mfma_f32_16x16x32_bf16 v[240:243], v[116:119], v[32:35], v[240:243]
  v_mfma_f32_16x16x32_bf16 v[244:247], v[116:119], v[36:39], v[244:247]
  v_mfma_f32_16x16x32_bf16 v[248:251], v[116:119], v[40:43], v[248:251]
  v_mfma_f32_16x16x32_bf16 v[252:255], v[116:119], v[44:47], v[252:255]
  v_mfma_f32_16x16x32_bf16 a[0:3], v[120:123], v[32:35], a[0:3]
  v_mfma_f32_16x16x32_bf16 a[4:7], v[120:123], v[36:39], a[4:7]
  v_mfma_f32_16x16x32_bf16 a[8:11], v[120:123], v[40:43], a[8:11]
  v_mfma_f32_16x16x32_bf16 a[12:15], v[120:123], v[44:47], a[12:15]
  v_mfma_f32_16x16x32_bf16 a[16:19], v[124:127], v[32:35], a[16:19]
  v_mfma_f32_16x16x32_bf16 a[20:23], v[124:127], v[36:39], a[20:23]
  v_mfma_f32_16x16x32_bf16 a[24:27], v[124:127], v[40:43], a[24:27]
  v_mfma_f32_16x16x32_bf16 a[28:31], v[124:127], v[44:47], a[28:31]
  v_mfma_f32_16x16x32_bf16 a[32:35], a[48:51], v[64:67], a[32:35]
  v_mfma_f32_16x16x32_bf16 a[36:39], a[48:51], v[68:71], a[36:39]
  v_mfma_f32_16x16x32_bf16 a[40:43], a[48:51], v[72:75], a[40:43]
  v_mfma_f32_16x16x32_bf16 a[44:47], a[48:51], v[76:79], a[44:47]
  v_mfma_f32_16x16x32_bf16 v[160:163], v[128:131], v[64:67], v[160:163]
  v_mfma_f32_16x16x32_bf16 v[164:167], v[128:131], v[68:71], v[164:167]
  v_mfma_f32_16x16x32_bf16 v[168:171], v[128:131], v[72:75], v[168:171]
  v_mfma_f32_16x16x32_bf16 v[172:175], v[128:131], v[76:79], v[172:175]
  v_mfma_f32_16x16x32_bf16 v[176:179], v[132:135], v[64:67], v[176:179]
  v_mfma_f32_16x16x32_bf16 v[180:183], v[132:135], v[68:71], v[180:183]
  v_mfma_f32_16x16x32_bf16 v[184:187], v[132:135], v[72:75], v[184:187]
  v_mfma_f32_16x16x32_bf16 v[188:191], v[132:135], v[76:79], v[188:191]
  v_mfma_f32_16x16x32_bf16 v[192:195], v[136:139], v[64:67], v[192:195]
  v_mfma_f32_16x16x32_bf16 v[196:199], v[136:139], v[68:71], v[196:199]
  v_mfma_f32_16x16x32_bf16 v[200:203], v[136:139], v[72:75], v[200:203]
  v_mfma_f32_16x16x32_bf16 v[204:207], v[136:139], v[76:79], v[204:207]
  v_mfma_f32_16x16x32_bf16 v[208:211], v[140:143], v[64:67], v[208:211]
  v_mfma_f32_16x16x32_bf16 v[212:215], v[140:143], v[68:71], v[212:215]
  v_mfma_f32_16x16x32_bf16 v[216:219], v[140:143], v[72:75], v[216:219]
  v_mfma_f32_16x16x32_bf16 v[220:223], v[140:143], v[76:79], v[220:223]
  v_mfma_f32_16x16x32_bf16 v[224:227], v[144:147], v[64:67], v[224:227]
  v_mfma_f32_16x16x32_bf16 v[228:231], v[144:147], v[68:71], v[228:231]
  v_mfma_f32_16x16x32_bf16 v[232:235], v[144:147], v[72:75], v[232:235]
  v_mfma_f32_16x16x32_bf16 v[236:239], v[144:147], v[76:79], v[236:239]
  v_mfma_f32_16x16x32_bf16 v[240:243], v[148:151], v[64:67], v[240:243]
  v_mfma_f32_16x16x32_bf16 v[244:247], v[148:151], v[68:71], v[244:247]
  v_mfma_f32_16x16x32_bf16 v[248:251], v[148:151], v[72:75], v[248:251]
  v_mfma_f32_16x16x32_bf16 v[252:255], v[148:151], v[76:79], v[252:255]
  v_mfma_f32_16x16x32_bf16 a[0:3], v[152:155], v[64:67], a[0:3]
  v_mfma_f32_16x16x32_bf16 a[4:7], v[152:155], v[68:71], a[4:7]
  v_mfma_f32_16x16x32_bf16 a[8:11], v[152:155], v[72:75], a[8:11]
  v_mfma_f32_16x16x32_bf16 a[12:15], v[152:155], v[76:79], a[12:15]
  v_mfma_f32_16x16x32_bf16 a[16:19], v[156:159], v[64:67], a[16:19]
  v_mfma_f32_16x16x32_bf16 a[20:23], v[156:159], v[68:71], a[20:23]
  v_mfma_f32_16x16x32_bf16 a[24:27], v[156:159], v[72:75], a[24:27]
  v_mfma_f32_16x16x32_bf16 a[28:31], v[156:159], v[76:79], a[28:31]
  s_nop 7
  s_add_u32 s57, s57, 32768
  s_sub_u32 s58, s58, 64
  s_sub_u32 s59, s59, 1
  s_cmp_lg_u32 s59, 0
  s_cbranch_scc1 Lslow_7
  v_accvgpr_read_b32 v20, a32
  v_accvgpr_read_b32 v21, a36
  v_accvgpr_read_b32 v22, a40
  v_accvgpr_read_b32 v23, a44
  v_rcp_f32 v8, v20
  v_rcp_f32 v9, v21
  v_rcp_f32 v10, v22
  v_rcp_f32 v11, v23
  v_pk_mul_f32 v[160:161], v[160:161], v[8:9] op_sel:[0,0] op_sel_hi:[1,0]
  v_pk_mul_f32 v[162:163], v[162:163], v[8:9] op_sel:[0,0] op_sel_hi:[1,0]
  v_pk_mul_f32 v[176:177], v[176:177], v[8:9] op_sel:[0,0] op_sel_hi:[1,0]
  v_pk_mul_f32 v[178:179], v[178:179], v[8:9] op_sel:[0,0] op_sel_hi:[1,0]
  v_cvt_pk_bf16_f32 v160, v160, v161
  v_cvt_pk_bf16_f32 v161, v162, v163
  v_cvt_pk_bf16_f32 v162, v176, v177
  v_cvt_pk_bf16_f32 v163, v178, v179
  v_pk_mul_f32 v[164:165], v[164:165], v[8:9] op_sel:[0,1] op_sel_hi:[1,1]
  v_pk_mul_f32 v[166:167], v[166:167], v[8:9] op_sel:[0,1] op_sel_hi:[1,1]
  v_pk_mul_f32 v[180:181], v[180:181], v[8:9] op_sel:[0,1] op_sel_hi:[1,1]
  v_pk_mul_f32 v[182:183], v[182:183], v[8:9] op_sel:[0,1] op_sel_hi:[1,1]
  v_cvt_pk_bf16_f32 v164, v164, v165
  v_cvt_pk_bf16_f32 v165, v166, v167
  v_cvt_pk_bf16_f32 v166, v180, v181
  v_cvt_pk_bf16_f32 v167, v182, v183
  v_pk_mul_f32 v[168:169], v[168:169], v[10:11] op_sel:[0,0] op_sel_hi:[1,0]
  v_pk_mul_f32 v[170:171], v[170:171], v[10:11] op_sel:[0,0] op_sel_hi:[1,0]
  v_pk_mul_f32 v[184:185], v[184:185], v[10:11] op_sel:[0,0] op_sel_hi:[1,0]
  v_pk_mul_f32 v[186:187], v[186:187], v[10:11] op_sel:[0,0] op_sel_hi:[1,0]
  v_cvt_pk_bf16_f32 v168, v168, v169
  v_cvt_pk_bf16_f32 v169, v170, v171
  v_cvt_pk_bf16_f32 v170, v184, v185
  v_cvt_pk_bf16_f32 v171, v186, v187
  v_pk_mul_f32 v[172:173], v[172:173], v[10:11] op_sel:[0,1] op_sel_hi:[1,1]
  v_pk_mul_f32 v[174:175], v[174:175], v[10:11] op_sel:[0,1] op_sel_hi:[1,1]
  v_pk_mul_f32 v[188:189], v[188:189], v[10:11] op_sel:[0,1] op_sel_hi:[1,1]
  v_pk_mul_f32 v[190:191], v[190:191], v[10:11] op_sel:[0,1] op_sel_hi:[1,1]
  v_cvt_pk_bf16_f32 v172, v172, v173
  v_cvt_pk_bf16_f32 v173, v174, v175
  v_cvt_pk_bf16_f32 v174, v188, v189
  v_cvt_pk_bf16_f32 v175, v190, v191
  v_pk_mul_f32 v[192:193], v[192:193], v[8:9] op_sel:[0,0] op_sel_hi:[1,0]
  v_pk_mul_f32 v[194:195], v[194:195], v[8:9] op_sel:[0,0] op_sel_hi:[1,0]
  v_pk_mul_f32 v[208:209], v[208:209], v[8:9] op_sel:[0,0] op_sel_hi:[1,0]
  v_pk_mul_f32 v[210:211], v[210:211], v[8:9] op_sel:[0,0] op_sel_hi:[1,0]
  v_cvt_pk_bf16_f32 v192, v192, v193
  v_cvt_pk_bf16_f32 v193, v194, v195
  v_cvt_pk_bf16_f32 v194, v208, v209
  v_cvt_pk_bf16_f32 v195, v210, v211
  v_pk_mul_f32 v[196:197], v[196:197], v[8:9] op_sel:[0,1] op_sel_hi:[1,1]
  v_pk_mul_f32 v[198:199], v[198:199], v[8:9] op_sel:[0,1] op_sel_hi:[1,1]
  v_pk_mul_f32 v[212:213], v[212:213], v[8:9] op_sel:[0,1] op_sel_hi:[1,1]
  v_pk_mul_f32 v[214:215], v[214:215], v[8:9] op_sel:[0,1] op_sel_hi:[1,1]
  v_cvt_pk_bf16_f32 v196, v196, v197
  v_cvt_pk_bf16_f32 v197, v198, v199
  v_cvt_pk_bf16_f32 v198, v212, v213
  v_cvt_pk_bf16_f32 v199, v214, v215
  v_pk_mul_f32 v[200:201], v[200:201], v[10:11] op_sel:[0,0] op_sel_hi:[1,0]
  v_pk_mul_f32 v[202:203], v[202:203], v[10:11] op_sel:[0,0] op_sel_hi:[1,0]
  v_pk_mul_f32 v[216:217], v[216:217], v[10:11] op_sel:[0,0] op_sel_hi:[1,0]
  v_pk_mul_f32 v[218:219], v[218:219], v[10:11] op_sel:[0,0] op_sel_hi:[1,0]
  v_cvt_pk_bf16_f32 v200, v200, v201
  v_cvt_pk_bf16_f32 v201, v202, v203
  v_cvt_pk_bf16_f32 v202, v216, v217
  v_cvt_pk_bf16_f32 v203, v218, v219
  v_pk_mul_f32 v[204:205], v[204:205], v[10:11] op_sel:[0,1] op_sel_hi:[1,1]
  v_pk_mul_f32 v[206:207], v[206:207], v[10:11] op_sel:[0,1] op_sel_hi:[1,1]
  v_pk_mul_f32 v[220:221], v[220:221], v[10:11] op_sel:[0,1] op_sel_hi:[1,1]
  v_pk_mul_f32 v[222:223], v[222:223], v[10:11] op_sel:[0,1] op_sel_hi:[1,1]
  v_cvt_pk_bf16_f32 v204, v204, v205
  v_cvt_pk_bf16_f32 v205, v206, v207
  v_cvt_pk_bf16_f32 v206, v220, v221
  v_cvt_pk_bf16_f32 v207, v222, v223
  v_pk_mul_f32 v[224:225], v[224:225], v[8:9] op_sel:[0,0] op_sel_hi:[1,0]
  v_pk_mul_f32 v[226:227], v[226:227], v[8:9] op_sel:[0,0] op_sel_hi:[1,0]
  v_pk_mul_f32 v[240:241], v[240:241], v[8:9] op_sel:[0,0] op_sel_hi:[1,0]
  v_pk_mul_f32 v[242:243], v[242:243], v[8:9] op_sel:[0,0] op_sel_hi:[1,0]
  v_cvt_pk_bf16_f32 v224, v224, v225
  v_cvt_pk_bf16_f32 v225, v226, v227
  v_cvt_pk_bf16_f32 v226, v240, v241
  v_cvt_pk_bf16_f32 v227, v242, v243
  v_pk_mul_f32 v[228:229], v[228:229], v[8:9] op_sel:[0,1] op_sel_hi:[1,1]
  v_pk_mul_f32 v[230:231], v[230:231], v[8:9] op_sel:[0,1] op_sel_hi:[1,1]
  v_pk_mul_f32 v[244:245], v[244:245], v[8:9] op_sel:[0,1] op_sel_hi:[1,1]
  v_pk_mul_f32 v[246:247], v[246:247], v[8:9] op_sel:[0,1] op_sel_hi:[1,1]
  v_cvt_pk_bf16_f32 v228, v228, v229
  v_cvt_pk_bf16_f32 v229, v230, v231
  v_cvt_pk_bf16_f32 v230, v244, v245
  v_cvt_pk_bf16_f32 v231, v246, v247
  v_pk_mul_f32 v[232:233], v[232:233], v[10:11] op_sel:[0,0] op_sel_hi:[1,0]
  v_pk_mul_f32 v[234:235], v[234:235], v[10:11] op_sel:[0,0] op_sel_hi:[1,0]
  v_pk_mul_f32 v[248:249], v[248:249], v[10:11] op_sel:[0,0] op_sel_hi:[1,0]
  v_pk_mul_f32 v[250:251], v[250:251], v[10:11] op_sel:[0,0] op_sel_hi:[1,0]
  v_cvt_pk_bf16_f32 v232, v232, v233
  v_cvt_pk_bf16_f32 v233, v234, v235
  v_cvt_pk_bf16_f32 v234, v248, v249
  v_cvt_pk_bf16_f32 v235, v250, v251
  v_pk_mul_f32 v[236:237], v[236:237], v[10:11] op_sel:[0,1] op_sel_hi:[1,1]
  v_pk_mul_f32 v[238:239], v[238:239], v[10:11] op_sel:[0,1] op_sel_hi:[1,1]
  v_pk_mul_f32 v[252:253], v[252:253], v[10:11] op_sel:[0,1] op_sel_hi:[1,1]
  v_pk_mul_f32 v[254:255], v[254:255], v[10:11] op_sel:[0,1] op_sel_hi:[1,1]
  v_cvt_pk_bf16_f32 v236, v236, v237
  v_cvt_pk_bf16_f32 v237, v238, v239
  v_cvt_pk_bf16_f32 v238, v252, v253
  v_cvt_pk_bf16_f32 v239, v254, v255
  v_accvgpr_read_b32 v176, a0
  v_accvgpr_read_b32 v177, a1
  v_accvgpr_read_b32 v178, a2
  v_accvgpr_read_b32 v179, a3
  v_accvgpr_read_b32 v180, a16
  v_accvgpr_read_b32 v181, a17
  v_accvgpr_read_b32 v182, a18
  v_accvgpr_read_b32 v183, a19
  v_pk_mul_f32 v[176:177], v[176:177], v[8:9] op_sel:[0,0] op_sel_hi:[1,0]
  v_pk_mul_f32 v[178:179], v[178:179], v[8:9] op_sel:[0,0] op_sel_hi:[1,0]
  v_pk_mul_f32 v[180:181], v[180:181], v[8:9] op_sel:[0,0] op_sel_hi:[1,0]
  v_pk_mul_f32 v[182:183], v[182:183], v[8:9] op_sel:[0,0] op_sel_hi:[1,0]
  v_cvt_pk_bf16_f32 v176, v176, v177
  v_cvt_pk_bf16_f32 v177, v178, v179
  v_cvt_pk_bf16_f32 v178, v180, v181
  v_cvt_pk_bf16_f32 v179, v182, v183
  v_accvgpr_read_b32 v184, a4
  v_accvgpr_read_b32 v185, a5
  v_accvgpr_read_b32 v186, a6
  v_accvgpr_read_b32 v187, a7
  v_accvgpr_read_b32 v188, a20
  v_accvgpr_read_b32 v189, a21
  v_accvgpr_read_b32 v190, a22
  v_accvgpr_read_b32 v191, a23
  v_pk_mul_f32 v[184:185], v[184:185], v[8:9] op_sel:[0,1] op_sel_hi:[1,1]
  v_pk_mul_f32 v[186:187], v[186:187], v[8:9] op_sel:[0,1] op_sel_hi:[1,1]
  v_pk_mul_f32 v[188:189], v[188:189], v[8:9] op_sel:[0,1] op_sel_hi:[1,1]
  v_pk_mul_f32 v[190:191], v[190:191], v[8:9] op_sel:[0,1] op_sel_hi:[1,1]
  v_cvt_pk_bf16_f32 v184, v184, v185
  v_cvt_pk_bf16_f32 v185, v186, v187
  v_cvt_pk_bf16_f32 v186, v188, v189
  v_cvt_pk_bf16_f32 v187, v190, v191
  v_accvgpr_read_b32 v208, a8
  v_accvgpr_read_b32 v209, a9
  v_accvgpr_read_b32 v210, a10
  v_accvgpr_read_b32 v211, a11
  v_accvgpr_read_b32 v212, a24
  v_accvgpr_read_b32 v213, a25
  v_accvgpr_read_b32 v214, a26
  v_accvgpr_read_b32 v215, a27
  v_pk_mul_f32 v[208:209], v[208:209], v[10:11] op_sel:[0,0] op_sel_hi:[1,0]
  v_pk_mul_f32 v[210:211], v[210:211], v[10:11] op_sel:[0,0] op_sel_hi:[1,0]
  v_pk_mul_f32 v[212:213], v[212:213], v[10:11] op_sel:[0,0] op_sel_hi:[1,0]
  v_pk_mul_f32 v[214:215], v[214:215], v[10:11] op_sel:[0,0] op_sel_hi:[1,0]
  v_cvt_pk_bf16_f32 v208, v208, v209
  v_cvt_pk_bf16_f32 v209, v210, v211
  v_cvt_pk_bf16_f32 v210, v212, v213
  v_cvt_pk_bf16_f32 v211, v214, v215
  v_accvgpr_read_b32 v216, a12
  v_accvgpr_read_b32 v217, a13
  v_accvgpr_read_b32 v218, a14
  v_accvgpr_read_b32 v219, a15
  v_accvgpr_read_b32 v220, a28
  v_accvgpr_read_b32 v221, a29
  v_accvgpr_read_b32 v222, a30
  v_accvgpr_read_b32 v223, a31
  v_pk_mul_f32 v[216:217], v[216:217], v[10:11] op_sel:[0,1] op_sel_hi:[1,1]
  v_pk_mul_f32 v[218:219], v[218:219], v[10:11] op_sel:[0,1] op_sel_hi:[1,1]
  v_pk_mul_f32 v[220:221], v[220:221], v[10:11] op_sel:[0,1] op_sel_hi:[1,1]
  v_pk_mul_f32 v[222:223], v[222:223], v[10:11] op_sel:[0,1] op_sel_hi:[1,1]
  v_cvt_pk_bf16_f32 v216, v216, v217
  v_cvt_pk_bf16_f32 v217, v218, v219
  v_cvt_pk_bf16_f32 v218, v220, v221
  v_cvt_pk_bf16_f32 v219, v222, v223
  s_lshl_b32 s33, s56, 3
  s_lshl_b32 s34, s23, 2
  s_add_u32 s33, s33, s34
  s_lshl_b32 s33, s33, 17
  s_lshl_b32 s34, s20, 12
  s_add_u32 s36, s33, s34
  s_add_u32 s37, s36, 131072
  s_add_u32 s38, s36, 262144
  s_add_u32 s39, s36, 393216
  s_bitcmp1_b32 s61, 0
  s_cbranch_scc0 Lss_10
  buffer_store_dwordx4 v[160:163], v1, s[16:19], s36 offen offset:0
  buffer_store_dwordx4 v[164:167], v1, s[16:19], s37 offen offset:0
  buffer_store_dwordx4 v[168:171], v1, s[16:19], s38 offen offset:0
  buffer_store_dwordx4 v[172:175], v1, s[16:19], s39 offen offset:0
Lss_10:
  s_bitcmp1_b32 s61, 1
  s_cbranch_scc0 Lss_11
  buffer_store_dwordx4 v[192:195], v1, s[16:19], s36 offen offset:1024
  buffer_store_dwordx4 v[196:199], v1, s[16:19], s37 offen offset:1024
  buffer_store_dwordx4 v[200:203], v1, s[16:19], s38 offen offset:1024
  buffer_store_dwordx4 v[204:207], v1, s[16:19], s39 offen offset:1024
Lss_11:
  s_bitcmp1_b32 s61, 2
  s_cbranch_scc0 Lss_12
  buffer_store_dwordx4 v[224:227], v1, s[16:19], s36 offen offset:2048
  buffer_store_dwordx4 v[228:231], v1, s[16:19], s37 offen offset:2048
  buffer_store_dwordx4 v[232:235], v1, s[16:19], s38 offen offset:2048
  buffer_store_dwordx4 v[236:239], v1, s[16:19], s39 offen offset:2048
Lss_12:
  s_bitcmp1_b32 s61, 3
  s_cbranch_scc0 Lss_13
  buffer_store_dwordx4 v[176:179], v1, s[16:19], s36 offen offset:3072
  buffer_store_dwordx4 v[184:187], v1, s[16:19], s37 offen offset:3072
  buffer_store_dwordx4 v[208:211], v1, s[16:19], s38 offen offset:3072
  buffer_store_dwordx4 v[216:219], v1, s[16:19], s39 offen offset:3072
Lss_13:
  s_branch Lk2_chk
Lk2_done:
Lk2_end:
  s_endpgm
.globl k3_oproj_kernel
.p2align 8
.type k3_oproj_kernel,@function
k3_oproj_kernel:
  s_cmp_ge_u32 s2, 256
  s_cbranch_scc1 Lk3_end
  s_load_dwordx2 s[4:5], s[0:1], 40
  s_load_dwordx4 s[32:35], s[0:1], 64
  s_load_dwordx2 s[6:7], s[0:1], 88
  v_lshrrev_b32 v12, 6, v0
  s_nop 0
  v_readfirstlane_b32 s20, v12
  v_and_b32 v0, 63, v0
  v_lshlrev_b32 v1, 4, v0
  s_lshr_b32 s21, s20, 1
  s_and_b32 s22, s20, 1
  s_and_b32 s3, s2, 3
  s_lshl_b32 s3, s3, 2
  s_bfe_u32 s36, s2, 0x20003
  s_add_u32 s36, s3, s36
  s_lshl_b32 s29, s36, 7
  s_bfe_u32 s3, s2, 0x10002
  s_lshl_b32 s3, s3, 3
  s_lshr_b32 s37, s2, 5
  s_add_u32 s3, s3, s37
  s_lshl_b32 s30, s3, 6
  s_lshl_b32 s41, s20, 12
  s_lshl_b32 s42, s20, 11
  s_add_u32 s42, s42, 16384
  s_lshl_b32 s3, s36, 3
  s_lshl_b32 s38, s20, 1
  s_add_u32 s3, s3, s38
  s_lshl_b32 s23, s3, 17
  s_add_u32 s24, s23, 129024
  s_lshl_b32 s49, s3, 15
  s_add_u32 s50, s49, 30720
  s_lshl_b32 s25, s30, 1
  s_mov_b32 s51, s25
  s_mov_b32 s43, 4194304
  s_mov_b32 s48, 2097152
  s_mov_b32 s26, 0
  s_mov_b32 s27, 0
  s_mov_b32 s31, 64
  s_lshl_b32 s3, s20, 4
  v_lshrrev_b32 v12, 3, v0
  v_and_b32 v13, 6, v12
  v_and_b32 v14, 7, v0
  v_xor_b32 v13, v13, v14
  v_add_u32 v12, s3, v12
  v_lshlrev_b32 v12, 11, v12
  v_lshl_add_u32 v2, v13, 4, v12
  v_add_u32 v3, 15360, v2
  s_waitcnt lgkmcnt(0)
  s_add_u32 s8, s6, 67108864
  s_addc_u32 s9, s7, 0
  s_mov_b32 s10, 16777216
  s_mov_b32 s11, 0x00020000
  s_mov_b32 s12, s4
  s_mov_b32 s13, s5
  s_mov_b32 s14, 8388608
  s_mov_b32 s15, 0x00020000
  s_add_u32 s44, s6, 83886080
  s_addc_u32 s45, s7, 0
  s_mov_b64 s[46:47], s[32:33]
  s_add_u32 m0, s26, s41
  s_nop 0
  buffer_load_dwordx4 v1, s[8:11], s23 offen lds
  buffer_load_dwordx4 v1, s[8:11], s23 offen offset:1024 lds
  buffer_load_dwordx4 v1, s[8:11], s24 offen offset:2048 lds
  buffer_load_dwordx4 v1, s[8:11], s24 offen offset:3072 lds
  s_add_u32 m0, s26, s42
  s_nop 0
  buffer_load_dwordx4 v2, s[12:15], s25 offen lds
  buffer_load_dwordx4 v3, s[12:15], s25 offen offset:1024 lds
  s_add_u32 s23, s23, 2048
  s_add_u32 s24, s24, 2048
  s_add_u32 s25, s25, 131072
  s_add_u32 s26, s26, 24576
  s_cmp_eq_u32 s26, 147456
  s_cselect_b32 s26, 0, s26
  s_sub_u32 s31, s31, 1
  s_cmp_eq_u32 s31, 0
  s_cselect_b64 s[8:9], s[44:45], s[8:9]
  s_cselect_b32 s10, s43, s10
  s_cselect_b64 s[12:13], s[46:47], s[12:13]
  s_cselect_b32 s14, s48, s14
  s_cselect_b32 s23, s49, s23
  s_cselect_b32 s24, s50, s24
  s_cselect_b32 s25, s51, s25
  s_add_u32 m0, s26, s41
  s_nop 0
  buffer_load_dwordx4 v1, s[8:11], s23 offen lds
  buffer_load_dwordx4 v1, s[8:11], s23 offen offset:1024 lds
  buffer_load_dwordx4 v1, s[8:11], s24 offen offset:2048 lds
  buffer_load_dwordx4 v1, s[8:11], s24 offen offset:3072 lds
  s_add_u32 m0, s26, s42
  s_nop 0
  buffer_load_dwordx4 v2, s[12:15], s25 offen lds
  buffer_load_dwordx4 v3, s[12:15], s25 offen offset:1024 lds
  s_add_u32 s23, s23, 2048
  s_add_u32 s24, s24, 2048
  s_add_u32 s25, s25, 131072
  s_add_u32 s26, s26, 24576
  s_cmp_eq_u32 s26, 147456
  s_cselect_b32 s26, 0, s26
  s_sub_u32 s31, s31, 1
  s_cmp_eq_u32 s31, 0
  s_cselect_b64 s[8:9], s[44:45], s[8:9]
  s_cselect_b32 s10, s43, s10
  s_cselect_b64 s[12:13], s[46:47], s[12:13]
  s_cselect_b32 s14, s48, s14
  s_cselect_b32 s23, s49, s23
  s_cselect_b32 s24, s50, s24
  s_cselect_b32 s25, s51, s25
  s_add_u32 m0, s26, s41
  s_nop 0
  buffer_load_dwordx4 v1, s[8:11], s23 offen lds
  buffer_load_dwordx4 v1, s[8:11], s23 offen offset:1024 lds
  buffer_load_dwordx4 v1, s[8:11], s24 offen offset:2048 lds
  buffer_load_dwordx4 v1, s[8:11], s24 offen offset:3072 lds
  s_add_u32 m0, s26, s42
  s_nop 0
  buffer_load_dwordx4 v2, s[12:15], s25 offen lds
  buffer_load_dwordx4 v3, s[12:15], s25 offen offset:1024 lds
  s_add_u32 s23, s23, 2048
  s_add_u32 s24, s24, 2048
  s_add_u32 s25, s25, 131072
  s_add_u32 s26, s26, 24576
  s_cmp_eq_u32 s26, 147456
  s_cselect_b32 s26, 0, s26
  s_sub_u32 s31, s31, 1
  s_cmp_eq_u32 s31, 0
  s_cselect_b64 s[8:9], s[44:45], s[8:9]
  s_cselect_b32 s10, s43, s10
  s_cselect_b64 s[12:13], s[46:47], s[12:13]
  s_cselect_b32 s14, s48, s14
  s_cselect_b32 s23, s49, s23
  s_cselect_b32 s24, s50, s24
  s_cselect_b32 s25, s51, s25
  s_add_u32 m0, s26, s41
  s_nop 0
  buffer_load_dwordx4 v1, s[8:11], s23 offen lds
  buffer_load_dwordx4 v1, s[8:11], s23 offen offset:1024 lds
  buffer_load_dwordx4 v1, s[8:11], s24 offen offset:2048 lds
  buffer_load_dwordx4 v1, s[8:11], s24 offen offset:3072 lds
  s_add_u32 m0, s26, s42
  s_nop 0
  buffer_load_dwordx4 v2, s[12:15], s25 offen lds
  buffer_load_dwordx4 v3, s[12:15], s25 offen offset:1024 lds
  s_add_u32 s23, s23, 2048
  s_add_u32 s24, s24, 2048
  s_add_u32 s25, s25, 131072
  s_add_u32 s26, s26, 24576
  s_cmp_eq_u32 s26, 147456
  s_cselect_b32 s26, 0, s26
  s_sub_u32 s31, s31, 1
  s_cmp_eq_u32 s31, 0
  s_cselect_b64 s[8:9], s[44:45], s[8:9]
  s_cselect_b32 s10, s43, s10
  s_cselect_b64 s[12:13], s[46:47], s[12:13]
  s_cselect_b32 s14, s48, s14
  s_cselect_b32 s23, s49, s23
  s_cselect_b32 s24, s50, s24
  s_cselect_b32 s25, s51, s25
  s_add_u32 m0, s26, s41
  s_nop 0
  buffer_load_dwordx4 v1, s[8:11], s23 offen lds
  buffer_load_dwordx4 v1, s[8:11], s23 offen offset:1024 lds
  buffer_load_dwordx4 v1, s[8:11], s24 offen offset:2048 lds
  buffer_load_dwordx4 v1, s[8:11], s24 offen offset:3072 lds
  s_add_u32 m0, s26, s42
  s_nop 0
  buffer_load_dwordx4 v2, s[12:15], s25 offen lds
  buffer_load_dwordx4 v3, s[12:15], s25 offen offset:1024 lds
  s_add_u32 s23, s23, 2048
  s_add_u32 s24, s24, 2048
  s_add_u32 s25, s25, 131072
  s_add_u32 s26, s26, 24576
  s_cmp_eq_u32 s26, 147456
  s_cselect_b32 s26, 0, s26
  s_sub_u32 s31, s31, 1
  s_cmp_eq_u32 s31, 0
  s_cselect_b64 s[8:9], s[44:45], s[8:9]
  s_cselect_b32 s10, s43, s10
  s_cselect_b64 s[12:13], s[46:47], s[12:13]
  s_cselect_b32 s14, s48, s14
  s_cselect_b32 s23, s49, s23
  s_cselect_b32 s24, s50, s24
  s_cselect_b32 s25, s51, s25
  s_add_u32 m0, s26, s41
  s_nop 0
  buffer_load_dwordx4 v1, s[8:11], s23 offen lds
  buffer_load_dwordx4 v1, s[8:11], s23 offen offset:1024 lds
  buffer_load_dwordx4 v1, s[8:11], s24 offen offset:2048 lds
  buffer_load_dwordx4 v1, s[8:11], s24 offen offset:3072 lds
  s_add_u32 m0, s26, s42
  s_nop 0
  buffer_load_dwordx4 v2, s[12:15], s25 offen lds
  buffer_load_dwordx4 v3, s[12:15], s25 offen offset:1024 lds
  s_add_u32 s23, s23, 2048
  s_add_u32 s24, s24, 2048
  s_add_u32 s25, s25, 131072
  s_add_u32 s26, s26, 24576
  s_cmp_eq_u32 s26, 147456
  s_cselect_b32 s26, 0, s26
  s_sub_u32 s31, s31, 1
  s_cmp_eq_u32 s31, 0
  s_cselect_b64 s[8:9], s[44:45], s[8:9]
  s_cselect_b32 s10, s43, s10
  s_cselect_b64 s[12:13], s[46:47], s[12:13]
  s_cselect_b32 s14, s48, s14
  s_cselect_b32 s23, s49, s23
  s_cselect_b32 s24, s50, s24
  s_cselect_b32 s25, s51, s25
  s_mov_b32 s16, s34
  s_mov_b32 s17, s35
  s_mov_b32 s18, 8388608
  s_mov_b32 s19, 0x00020000
  s_lshl_b32 s3, s21, 13
  v_add_u32 v4, s3, v1
  v_lshrrev_b32 v12, 2, v0
  v_lshlrev_b32 v13, 7, v12
  v_and_b32 v14, 1, v0
  v_lshl_add_u32 v13, v14, 3, v13
  v_add_u32 v13, 16384, v13
  v_and_b32 v12, 6, v12
  v_bfe_u32 v14, v0, 1, 1
  s_lshl_b32 s3, s22, 2
  v_add_u32 v15, s3, v14
  v_xor_b32 v15, v15, v12
  v_lshl_add_u32 v5, v15, 4, v13
  v_add_u32 v15, s3, v14
  v_add_u32 v15, 2, v15
  v_xor_b32 v15, v15, v12
  v_lshl_add_u32 v6, v15, 4, v13
  v_mov_b32 v8, v4
  v_mov_b32 v9, v5
  v_mov_b32 v10, v6
  s_waitcnt vmcnt(30)
  s_barrier
  ds_read_b128 v[64:67], v8 offset:0
  ds_read_b128 v[68:71], v8 offset:1024
  ds_read_b64_tr_b16 v[128:129], v9 offset:0
  ds_read_b64_tr_b16 v[130:131], v9 offset:2048
  ds_read_b64_tr_b16 v[136:137], v10 offset:0
  ds_read_b64_tr_b16 v[138:139], v10 offset:2048
  ds_read_b64_tr_b16 v[132:133], v9 offset:4096
  ds_read_b64_tr_b16 v[134:135], v9 offset:6144
  ds_read_b64_tr_b16 v[140:141], v10 offset:4096
  ds_read_b64_tr_b16 v[142:143], v10 offset:6144
  ds_read_b128 v[72:75], v8 offset:2048
  ds_read_b128 v[76:79], v8 offset:3072
  ds_read_b128 v[80:83], v8 offset:4096
  ds_read_b128 v[84:87], v8 offset:5120
  ds_read_b128 v[88:91], v8 offset:6144
  ds_read_b128 v[92:95], v8 offset:7168
  s_add_u32 s27, s27, 24576
  s_cmp_eq_u32 s27, 147456
  s_cselect_b32 s27, 0, s27
  v_add_u32 v8, s27, v4
  v_add_u32 v9, s27, v5
  v_add_u32 v10, s27, v6
  s_waitcnt vmcnt(24) lgkmcnt(0)
  s_barrier
  v_mfma_f32_16x16x32_bf16 v[32:35], v[128:131], v[64:67], 0
  s_add_u32 m0, s26, s41
  s_nop 0
  buffer_load_dwordx4 v1, s[8:11], s23 offen lds
  ds_read_b128 v[96:99], v8 offset:0
  ds_read_b128 v[100:103], v8 offset:1024
  v_mfma_f32_16x16x32_bf16 v[32:35], v[132:135], v[68:71], v[32:35]
  buffer_load_dwordx4 v1, s[8:11], s23 offen offset:1024 lds
  ds_read_b64_tr_b16 v[144:145], v9 offset:0
  ds_read_b64_tr_b16 v[146:147], v9 offset:2048
  v_mfma_f32_16x16x32_bf16 v[36:39], v[140:143], v[68:71], 0
  buffer_load_dwordx4 v1, s[8:11], s24 offen offset:2048 lds
  ds_read_b64_tr_b16 v[152:153], v10 offset:0
  ds_read_b64_tr_b16 v[154:155], v10 offset:2048
  v_mfma_f32_16x16x32_bf16 v[36:39], v[136:139], v[64:67], v[36:39]
  buffer_load_dwordx4 v1, s[8:11], s24 offen offset:3072 lds
  ds_read_b64_tr_b16 v[148:149], v9 offset:4096
  ds_read_b64_tr_b16 v[150:151], v9 offset:6144
  v_mfma_f32_16x16x32_bf16 v[40:43], v[128:131], v[72:75], 0
  s_add_u32 m0, s26, s42
  s_nop 0
  buffer_load_dwordx4 v2, s[12:15], s25 offen lds
  ds_read_b64_tr_b16 v[156:157], v10 offset:4096
  ds_read_b64_tr_b16 v[158:159], v10 offset:6144
  v_mfma_f32_16x16x32_bf16 v[40:43], v[132:135], v[76:79], v[40:43]
  buffer_load_dwordx4 v3, s[12:15], s25 offen offset:1024 lds
  ds_read_b128 v[104:107], v8 offset:2048
  ds_read_b128 v[108:111], v8 offset:3072
  v_mfma_f32_16x16x32_bf16 v[44:47], v[140:143], v[76:79], 0
  ds_read_b128 v[112:115], v8 offset:4096
  ds_read_b128 v[116:119], v8 offset:5120
  v_mfma_f32_16x16x32_bf16 v[44:47], v[136:139], v[72:75], v[44:47]
  ds_read_b128 v[120:123], v8 offset:6144
  ds_read_b128 v[124:127], v8 offset:7168
  v_mfma_f32_16x16x32_bf16 v[48:51], v[128:131], v[80:83], 0
  s_add_u32 s23, s23, 2048
  s_add_u32 s24, s24, 2048
  s_add_u32 s25, s25, 131072
  v_mfma_f32_16x16x32_bf16 v[48:51], v[132:135], v[84:87], v[48:51]
  s_add_u32 s26, s26, 24576
  s_cmp_eq_u32 s26, 147456
  s_cselect_b32 s26, 0, s26
  v_mfma_f32_16x16x32_bf16 v[52:55], v[140:143], v[84:87], 0
  s_sub_u32 s31, s31, 1
  s_cmp_eq_u32 s31, 0
  v_mfma_f32_16x16x32_bf16 v[52:55], v[136:139], v[80:83], v[52:55]
  s_cselect_b64 s[8:9], s[44:45], s[8:9]
  s_cselect_b32 s10, s43, s10
  s_cselect_b64 s[12:13], s[46:47], s[12:13]
  v_mfma_f32_16x16x32_bf16 v[56:59], v[128:131], v[88:91], 0
  s_cselect_b32 s14, s48, s14
  s_cselect_b32 s23, s49, s23
  s_cselect_b32 s24, s50, s24
  v_mfma_f32_16x16x32_bf16 v[56:59], v[132:135], v[92:95], v[56:59]
  s_cselect_b32 s25, s51, s25
  s_add_u32 s27, s27, 24576
  v_mfma_f32_16x16x32_bf16 v[60:63], v[140:143], v[92:95], 0
  s_cmp_eq_u32 s27, 147456
  s_cselect_b32 s27, 0, s27
  v_add_u32 v8, s27, v4
  v_mfma_f32_16x16x32_bf16 v[60:63], v[136:139], v[88:91], v[60:63]
  v_add_u32 v9, s27, v5
  v_add_u32 v10, s27, v6
  s_waitcnt vmcnt(24) lgkmcnt(0)
  s_barrier
  v_mfma_f32_16x16x32_bf16 v[32:35], v[144:147], v[96:99], v[32:35]
  s_add_u32 m0, s26, s41
  s_nop 0
  buffer_load_dwordx4 v1, s[8:11], s23 offen lds
  ds_read_b128 v[64:67], v8 offset:0
  ds_read_b128 v[68:71], v8 offset:1024
  v_mfma_f32_16x16x32_bf16 v[32:35], v[148:151], v[100:103], v[32:35]
  buffer_load_dwordx4 v1, s[8:11], s23 offen offset:1024 lds
  ds_read_b64_tr_b16 v[128:129], v9 offset:0
  ds_read_b64_tr_b16 v[130:131], v9 offset:2048
  v_mfma_f32_16x16x32_bf16 v[36:39], v[156:159], v[100:103], v[36:39]
  buffer_load_dwordx4 v1, s[8:11], s24 offen offset:2048 lds
  ds_read_b64_tr_b16 v[136:137], v10 offset:0
  ds_read_b64_tr_b16 v[138:139], v10 offset:2048
  v_mfma_f32_16x16x32_bf16 v[36:39], v[152:155], v[96:99], v[36:39]
  buffer_load_dwordx4 v1, s[8:11], s24 offen offset:3072 lds
  ds_read_b64_tr_b16 v[132:133], v9 offset:4096
  ds_read_b64_tr_b16 v[134:135], v9 offset:6144
  v_mfma_f32_16x16x32_bf16 v[40:43], v[144:147], v[104:107], v[40:43]
  s_add_u32 m0, s26, s42
  s_nop 0
  buffer_load_dwordx4 v2, s[12:15], s25 offen lds
  ds_read_b64_tr_b16 v[140:141], v10 offset:4096
  ds_read_b64_tr_b16 v[142:143], v10 offset:6144
  v_mfma_f32_16x16x32_bf16 v[40:43], v[148:151], v[108:111], v[40:43]
  buffer_load_dwordx4 v3, s[12:15], s25 offen offset:1024 lds
  ds_read_b128 v[72:75], v8 offset:2048
  ds_read_b128 v[76:79], v8 offset:3072
  v_mfma_f32_16x16x32_bf16 v[44:47], v[156:159], v[108:111], v[44:47]
  ds_read_b128 v[80:83], v8 offset:4096
  ds_read_b128 v[84:87], v8 offset:5120
  v_mfma_f32_16x16x32_bf16 v[44:47], v[152:155], v[104:107], v[44:47]
  ds_read_b128 v[88:91], v8 offset:6144
  ds_read_b128 v[92:95], v8 offset:7168
  v_mfma_f32_16x16x32_bf16 v[48:51], v[144:147], v[112:115], v[48:51]
  s_add_u32 s23, s23, 2048
  s_add_u32 s24, s24, 2048
  s_add_u32 s25, s25, 131072
  v_mfma_f32_16x16x32_bf16 v[48:51], v[148:151], v[116:119], v[48:51]
  s_add_u32 s26, s26, 24576
  s_cmp_eq_u32 s26, 147456
  s_cselect_b32 s26, 0, s26
  v_mfma_f32_16x16x32_bf16 v[52:55], v[156:159], v[116:119], v[52:55]
  s_sub_u32 s31, s31, 1
  s_cmp_eq_u32 s31, 0
  v_mfma_f32_16x16x32_bf16 v[52:55], v[152:155], v[112:115], v[52:55]
  s_cselect_b64 s[8:9], s[44:45], s[8:9]
  s_cselect_b32 s10, s43, s10
  s_cselect_b64 s[12:13], s[46:47], s[12:13]
  v_mfma_f32_16x16x32_bf16 v[56:59], v[144:147], v[120:123], v[56:59]
  s_cselect_b32 s14, s48, s14
  s_cselect_b32 s23, s49, s23
  s_cselect_b32 s24, s50, s24
  v_mfma_f32_16x16x32_bf16 v[56:59], v[148:151], v[124:127], v[56:59]
  s_cselect_b32 s25, s51, s25
  s_add_u32 s27, s27, 24576
  v_mfma_f32_16x16x32_bf16 v[60:63], v[156:159], v[124:127], v[60:63]
  s_cmp_eq_u32 s27, 147456
  s_cselect_b32 s27, 0, s27
  v_add_u32 v8, s27, v4
  v_mfma_f32_16x16x32_bf16 v[60:63], v[152:155], v[120:123], v[60:63]
  v_add_u32 v9, s27, v5
  v_add_u32 v10, s27, v6
  s_mov_b32 s28, 31
  s_waitcnt lgkmcnt(0)
Lk3_la:
  s_waitcnt vmcnt(24) lgkmcnt(0)
  s_barrier
  v_mfma_f32_16x16x32_bf16 v[32:35], v[128:131], v[64:67], v[32:35]
  s_add_u32 m0, s26, s41
  s_nop 0
  buffer_load_dwordx4 v1, s[8:11], s23 offen lds
  ds_read_b128 v[96:99], v8 offset:0
  ds_read_b128 v[100:103], v8 offset:1024
  v_mfma_f32_16x16x32_bf16 v[32:35], v[132:135], v[68:71], v[32:35]
  buffer_load_dwordx4 v1, s[8:11], s23 offen offset:1024 lds
  ds_read_b64_tr_b16 v[144:145], v9 offset:0
  ds_read_b64_tr_b16 v[146:147], v9 offset:2048
  v_mfma_f32_16x16x32_bf16 v[36:39], v[140:143], v[68:71], v[36:39]
  buffer_load_dwordx4 v1, s[8:11], s24 offen offset:2048 lds
  ds_read_b64_tr_b16 v[152:153], v10 offset:0
  ds_read_b64_tr_b16 v[154:155], v10 offset:2048
  v_mfma_f32_16x16x32_bf16 v[36:39], v[136:139], v[64:67], v[36:39]
  buffer_load_dwordx4 v1, s[8:11], s24 offen offset:3072 lds
  ds_read_b64_tr_b16 v[148:149], v9 offset:4096
  ds_read_b64_tr_b16 v[150:151], v9 offset:6144
  v_mfma_f32_16x16x32_bf16 v[40:43], v[128:131], v[72:75], v[40:43]
  s_add_u32 m0, s26, s42
  s_nop 0
  buffer_load_dwordx4 v2, s[12:15], s25 offen lds
  ds_read_b64_tr_b16 v[156:157], v10 offset:4096
  ds_read_b64_tr_b16 v[158:159], v10 offset:6144
  v_mfma_f32_16x16x32_bf16 v[40:43], v[132:135], v[76:79], v[40:43]
  buffer_load_dwordx4 v3, s[12:15], s25 offen offset:1024 lds
  ds_read_b128 v[104:107], v8 offset:2048
  ds_read_b128 v[108:111], v8 offset:3072
  v_mfma_f32_16x16x32_bf16 v[44:47], v[140:143], v[76:79], v[44:47]
  ds_read_b128 v[112:115], v8 offset:4096
  ds_read_b128 v[116:119], v8 offset:5120
  v_mfma_f32_16x16x32_bf16 v[44:47], v[136:139], v[72:75], v[44:47]
  ds_read_b128 v[120:123], v8 offset:6144
  ds_read_b128 v[124:127], v8 offset:7168
  v_mfma_f32_16x16x32_bf16 v[48:51], v[128:131], v[80:83], v[48:51]
  s_add_u32 s23, s23, 2048
  s_add_u32 s24, s24, 2048
  s_add_u32 s25, s25, 131072
  v_mfma_f32_16x16x32_bf16 v[48:51], v[132:135], v[84:87], v[48:51]
  s_add_u32 s26, s26, 24576
  s_cmp_eq_u32 s26, 147456
  s_cselect_b32 s26, 0, s26
  v_mfma_f32_16x16x32_bf16 v[52:55], v[140:143], v[84:87], v[52:55]
  s_sub_u32 s31, s31, 1
  s_cmp_eq_u32 s31, 0
  v_mfma_f32_16x16x32_bf16 v[52:55], v[136:139], v[80:83], v[52:55]
  s_cselect_b64 s[8:9], s[44:45], s[8:9]
  s_cselect_b32 s10, s43, s10
  s_cselect_b64 s[12:13], s[46:47], s[12:13]
  v_mfma_f32_16x16x32_bf16 v[56:59], v[128:131], v[88:91], v[56:59]
  s_cselect_b32 s14, s48, s14
  s_cselect_b32 s23, s49, s23
  s_cselect_b32 s24, s50, s24
  v_mfma_f32_16x16x32_bf16 v[56:59], v[132:135], v[92:95], v[56:59]
  s_cselect_b32 s25, s51, s25
  s_add_u32 s27, s27, 24576
  v_mfma_f32_16x16x32_bf16 v[60:63], v[140:143], v[92:95], v[60:63]
  s_cmp_eq_u32 s27, 147456
  s_cselect_b32 s27, 0, s27
  v_add_u32 v8, s27, v4
  v_mfma_f32_16x16x32_bf16 v[60:63], v[136:139], v[88:91], v[60:63]
  v_add_u32 v9, s27, v5
  v_add_u32 v10, s27, v6
  s_waitcnt vmcnt(24) lgkmcnt(0)
  s_barrier
  v_mfma_f32_16x16x32_bf16 v[32:35], v[144:147], v[96:99], v[32:35]
  s_add_u32 m0, s26, s41
  s_nop 0
  buffer_load_dwordx4 v1, s[8:11], s23 offen lds
  ds_read_b128 v[64:67], v8 offset:0
  ds_read_b128 v[68:71], v8 offset:1024
  v_mfma_f32_16x16x32_bf16 v[32:35], v[148:151], v[100:103], v[32:35]
  buffer_load_dwordx4 v1, s[8:11], s23 offen offset:1024 lds
  ds_read_b64_tr_b16 v[128:129], v9 offset:0
  ds_read_b64_tr_b16 v[130:131], v9 offset:2048
  v_mfma_f32_16x16x32_bf16 v[36:39], v[156:159], v[100:103], v[36:39]
  buffer_load_dwordx4 v1, s[8:11], s24 offen offset:2048 lds
  ds_read_b64_tr_b16 v[136:137], v10 offset:0
  ds_read_b64_tr_b16 v[138:139], v10 offset:2048
  v_mfma_f32_16x16x32_bf16 v[36:39], v[152:155], v[96:99], v[36:39]
  buffer_load_dwordx4 v1, s[8:11], s24 offen offset:3072 lds
  ds_read_b64_tr_b16 v[132:133], v9 offset:4096
  ds_read_b64_tr_b16 v[134:135], v9 offset:6144
  v_mfma_f32_16x16x32_bf16 v[40:43], v[144:147], v[104:107], v[40:43]
  s_add_u32 m0, s26, s42
  s_nop 0
  buffer_load_dwordx4 v2, s[12:15], s25 offen lds
  ds_read_b64_tr_b16 v[140:141], v10 offset:4096
  ds_read_b64_tr_b16 v[142:143], v10 offset:6144
  v_mfma_f32_16x16x32_bf16 v[40:43], v[148:151], v[108:111], v[40:43]
  buffer_load_dwordx4 v3, s[12:15], s25 offen offset:1024 lds
  ds_read_b128 v[72:75], v8 offset:2048
  ds_read_b128 v[76:79], v8 offset:3072
  v_mfma_f32_16x16x32_bf16 v[44:47], v[156:159], v[108:111], v[44:47]
  ds_read_b128 v[80:83], v8 offset:4096
  ds_read_b128 v[84:87], v8 offset:5120
  v_mfma_f32_16x16x32_bf16 v[44:47], v[152:155], v[104:107], v[44:47]
  ds_read_b128 v[88:91], v8 offset:6144
  ds_read_b128 v[92:95], v8 offset:7168
  v_mfma_f32_16x16x32_bf16 v[48:51], v[144:147], v[112:115], v[48:51]
  s_add_u32 s23, s23, 2048
  s_add_u32 s24, s24, 2048
  s_add_u32 s25, s25, 131072
  v_mfma_f32_16x16x32_bf16 v[48:51], v[148:151], v[116:119], v[48:51]
  s_add_u32 s26, s26, 24576
  s_cmp_eq_u32 s26, 147456
  s_cselect_b32 s26, 0, s26
  v_mfma_f32_16x16x32_bf16 v[52:55], v[156:159], v[116:119], v[52:55]
  s_sub_u32 s31, s31, 1
  s_cmp_eq_u32 s31, 0
  v_mfma_f32_16x16x32_bf16 v[52:55], v[152:155], v[112:115], v[52:55]
  s_cselect_b64 s[8:9], s[44:45], s[8:9]
  s_cselect_b32 s10, s43, s10
  s_cselect_b64 s[12:13], s[46:47], s[12:13]
  v_mfma_f32_16x16x32_bf16 v[56:59], v[144:147], v[120:123], v[56:59]
  s_cselect_b32 s14, s48, s14
  s_cselect_b32 s23, s49, s23
  s_cselect_b32 s24, s50, s24
  v_mfma_f32_16x16x32_bf16 v[56:59], v[148:151], v[124:127], v[56:59]
  s_cselect_b32 s25, s51, s25
  s_add_u32 s27, s27, 24576
  v_mfma_f32_16x16x32_bf16 v[60:63], v[156:159], v[124:127], v[60:63]
  s_cmp_eq_u32 s27, 147456
  s_cselect_b32 s27, 0, s27
  v_add_u32 v8, s27, v4
  v_mfma_f32_16x16x32_bf16 v[60:63], v[152:155], v[120:123], v[60:63]
  v_add_u32 v9, s27, v5
  v_add_u32 v10, s27, v6
  s_sub_u32 s28, s28, 1
  s_cmp_lg_u32 s28, 0
  s_cbranch_scc1 Lk3_la
  v_bfe_u32 v12, v0, 4, 1
  v_lshrrev_b32 v13, 5, v0
  v_lshl_or_b32 v12, v12, 1, v13
  v_and_b32 v13, 15, v0
  v_lshlrev_b32 v13, 12, v13
  v_lshl_add_u32 v12, v12, 4, v13
  s_lshl_b32 s3, s21, 6
  s_add_u32 s3, s3, s29
  s_lshl_b32 s3, s3, 12
  s_lshl_b32 s4, s22, 5
  s_add_u32 s4, s4, s30
  s_lshl_b32 s4, s4, 1
  s_add_u32 s3, s3, s4
  v_cvt_pk_bf16_f32 v16, v32, v33
  v_cvt_pk_bf16_f32 v17, v34, v35
  v_cvt_pk_bf16_f32 v18, v36, v37
  v_cvt_pk_bf16_f32 v19, v38, v39
  s_nop 0
  v_permlane16_swap_b32 v16, v18
  v_permlane16_swap_b32 v17, v19
  buffer_store_dwordx4 v[16:19], v12, s[16:19], s3 offen
  s_add_u32 s3, s3, 65536
  v_cvt_pk_bf16_f32 v20, v40, v41
  v_cvt_pk_bf16_f32 v21, v42, v43
  v_cvt_pk_bf16_f32 v22, v44, v45
  v_cvt_pk_bf16_f32 v23, v46, v47
  s_nop 0
  v_permlane16_swap_b32 v20, v22
  v_permlane16_swap_b32 v21, v23
  buffer_store_dwordx4 v[20:23], v12, s[16:19], s3 offen
  s_add_u32 s3, s3, 65536
  v_cvt_pk_bf16_f32 v16, v48, v49
  v_cvt_pk_bf16_f32 v17, v50, v51
  v_cvt_pk_bf16_f32 v18, v52, v53
  v_cvt_pk_bf16_f32 v19, v54, v55
  s_nop 0
  v_permlane16_swap_b32 v16, v18
  v_permlane16_swap_b32 v17, v19
  buffer_store_dwordx4 v[16:19], v12, s[16:19], s3 offen
  s_add_u32 s3, s3, 65536
  v_cvt_pk_bf16_f32 v20, v56, v57
  v_cvt_pk_bf16_f32 v21, v58, v59
  v_cvt_pk_bf16_f32 v22, v60, v61
  v_cvt_pk_bf16_f32 v23, v62, v63
  s_nop 0
  v_permlane16_swap_b32 v20, v22
  v_permlane16_swap_b32 v21, v23
  buffer_store_dwordx4 v[20:23], v12, s[16:19], s3 offen
  s_waitcnt vmcnt(24) lgkmcnt(0)
  s_barrier
  v_mfma_f32_16x16x32_bf16 v[32:35], v[128:131], v[64:67], 0
  s_add_u32 m0, s26, s41
  s_nop 0
  buffer_load_dwordx4 v1, s[8:11], s23 offen lds
  ds_read_b128 v[96:99], v8 offset:0
  ds_read_b128 v[100:103], v8 offset:1024
  v_mfma_f32_16x16x32_bf16 v[32:35], v[132:135], v[68:71], v[32:35]
  buffer_load_dwordx4 v1, s[8:11], s23 offen offset:1024 lds
  ds_read_b64_tr_b16 v[144:145], v9 offset:0
  ds_read_b64_tr_b16 v[146:147], v9 offset:2048
  v_mfma_f32_16x16x32_bf16 v[36:39], v[140:143], v[68:71], 0
  buffer_load_dwordx4 v1, s[8:11], s24 offen offset:2048 lds
  ds_read_b64_tr_b16 v[152:153], v10 offset:0
  ds_read_b64_tr_b16 v[154:155], v10 offset:2048
  v_mfma_f32_16x16x32_bf16 v[36:39], v[136:139], v[64:67], v[36:39]
  buffer_load_dwordx4 v1, s[8:11], s24 offen offset:3072 lds
  ds_read_b64_tr_b16 v[148:149], v9 offset:4096
  ds_read_b64_tr_b16 v[150:151], v9 offset:6144
  v_mfma_f32_16x16x32_bf16 v[40:43], v[128:131], v[72:75], 0
  s_add_u32 m0, s26, s42
  s_nop 0
  buffer_load_dwordx4 v2, s[12:15], s25 offen lds
  ds_read_b64_tr_b16 v[156:157], v10 offset:4096
  ds_read_b64_tr_b16 v[158:159], v10 offset:6144
  v_mfma_f32_16x16x32_bf16 v[40:43], v[132:135], v[76:79], v[40:43]
  buffer_load_dwordx4 v3, s[12:15], s25 offen offset:1024 lds
  ds_read_b128 v[104:107], v8 offset:2048
  ds_read_b128 v[108:111], v8 offset:3072
  v_mfma_f32_16x16x32_bf16 v[44:47], v[140:143], v[76:79], 0
  ds_read_b128 v[112:115], v8 offset:4096
  ds_read_b128 v[116:119], v8 offset:5120
  v_mfma_f32_16x16x32_bf16 v[44:47], v[136:139], v[72:75], v[44:47]
  ds_read_b128 v[120:123], v8 offset:6144
  ds_read_b128 v[124:127], v8 offset:7168
  v_mfma_f32_16x16x32_bf16 v[48:51], v[128:131], v[80:83], 0
  s_add_u32 s23, s23, 2048
  s_add_u32 s24, s24, 2048
  s_add_u32 s25, s25, 131072
  v_mfma_f32_16x16x32_bf16 v[48:51], v[132:135], v[84:87], v[48:51]
  s_add_u32 s26, s26, 24576
  s_cmp_eq_u32 s26, 147456
  s_cselect_b32 s26, 0, s26
  v_mfma_f32_16x16x32_bf16 v[52:55], v[140:143], v[84:87], 0
  s_sub_u32 s31, s31, 1
  s_cmp_eq_u32 s31, 0
  v_mfma_f32_16x16x32_bf16 v[52:55], v[136:139], v[80:83], v[52:55]
  s_cselect_b64 s[8:9], s[44:45], s[8:9]
  s_cselect_b32 s10, s43, s10
  s_cselect_b64 s[12:13], s[46:47], s[12:13]
  v_mfma_f32_16x16x32_bf16 v[56:59], v[128:131], v[88:91], 0
  s_cselect_b32 s14, s48, s14
  s_cselect_b32 s23, s49, s23
  s_cselect_b32 s24, s50, s24
  v_mfma_f32_16x16x32_bf16 v[56:59], v[132:135], v[92:95], v[56:59]
  s_cselect_b32 s25, s51, s25
  s_add_u32 s27, s27, 24576
  v_mfma_f32_16x16x32_bf16 v[60:63], v[140:143], v[92:95], 0
  s_cmp_eq_u32 s27, 147456
  s_cselect_b32 s27, 0, s27
  v_add_u32 v8, s27, v4
  v_mfma_f32_16x16x32_bf16 v[60:63], v[136:139], v[88:91], v[60:63]
  v_add_u32 v9, s27, v5
  v_add_u32 v10, s27, v6
  s_waitcnt vmcnt(24) lgkmcnt(0)
  s_barrier
  v_mfma_f32_16x16x32_bf16 v[32:35], v[144:147], v[96:99], v[32:35]
  s_add_u32 m0, s26, s41
  s_nop 0
  buffer_load_dwordx4 v1, s[8:11], s23 offen lds
  ds_read_b128 v[64:67], v8 offset:0
  ds_read_b128 v[68:71], v8 offset:1024
  v_mfma_f32_16x16x32_bf16 v[32:35], v[148:151], v[100:103], v[32:35]
  buffer_load_dwordx4 v1, s[8:11], s23 offen offset:1024 lds
  ds_read_b64_tr_b16 v[128:129], v9 offset:0
  ds_read_b64_tr_b16 v[130:131], v9 offset:2048
  v_mfma_f32_16x16x32_bf16 v[36:39], v[156:159], v[100:103], v[36:39]
  buffer_load_dwordx4 v1, s[8:11], s24 offen offset:2048 lds
  ds_read_b64_tr_b16 v[136:137], v10 offset:0
  ds_read_b64_tr_b16 v[138:139], v10 offset:2048
  v_mfma_f32_16x16x32_bf16 v[36:39], v[152:155], v[96:99], v[36:39]
  buffer_load_dwordx4 v1, s[8:11], s24 offen offset:3072 lds
  ds_read_b64_tr_b16 v[132:133], v9 offset:4096
  ds_read_b64_tr_b16 v[134:135], v9 offset:6144
  v_mfma_f32_16x16x32_bf16 v[40:43], v[144:147], v[104:107], v[40:43]
  s_add_u32 m0, s26, s42
  s_nop 0
  buffer_load_dwordx4 v2, s[12:15], s25 offen lds
  ds_read_b64_tr_b16 v[140:141], v10 offset:4096
  ds_read_b64_tr_b16 v[142:143], v10 offset:6144
  v_mfma_f32_16x16x32_bf16 v[40:43], v[148:151], v[108:111], v[40:43]
  buffer_load_dwordx4 v3, s[12:15], s25 offen offset:1024 lds
  ds_read_b128 v[72:75], v8 offset:2048
  ds_read_b128 v[76:79], v8 offset:3072
  v_mfma_f32_16x16x32_bf16 v[44:47], v[156:159], v[108:111], v[44:47]
  ds_read_b128 v[80:83], v8 offset:4096
  ds_read_b128 v[84:87], v8 offset:5120
  v_mfma_f32_16x16x32_bf16 v[44:47], v[152:155], v[104:107], v[44:47]
  ds_read_b128 v[88:91], v8 offset:6144
  ds_read_b128 v[92:95], v8 offset:7168
  v_mfma_f32_16x16x32_bf16 v[48:51], v[144:147], v[112:115], v[48:51]
  s_add_u32 s23, s23, 2048
  s_add_u32 s24, s24, 2048
  s_add_u32 s25, s25, 131072
  v_mfma_f32_16x16x32_bf16 v[48:51], v[148:151], v[116:119], v[48:51]
  s_add_u32 s26, s26, 24576
  s_cmp_eq_u32 s26, 147456
  s_cselect_b32 s26, 0, s26
  v_mfma_f32_16x16x32_bf16 v[52:55], v[156:159], v[116:119], v[52:55]
  s_sub_u32 s31, s31, 1
  s_cmp_eq_u32 s31, 0
  v_mfma_f32_16x16x32_bf16 v[52:55], v[152:155], v[112:115], v[52:55]
  s_cselect_b64 s[8:9], s[44:45], s[8:9]
  s_cselect_b32 s10, s43, s10
  s_cselect_b64 s[12:13], s[46:47], s[12:13]
  v_mfma_f32_16x16x32_bf16 v[56:59], v[144:147], v[120:123], v[56:59]
  s_cselect_b32 s14, s48, s14
  s_cselect_b32 s23, s49, s23
  s_cselect_b32 s24, s50, s24
  v_mfma_f32_16x16x32_bf16 v[56:59], v[148:151], v[124:127], v[56:59]
  s_cselect_b32 s25, s51, s25
  s_add_u32 s27, s27, 24576
  v_mfma_f32_16x16x32_bf16 v[60:63], v[156:159], v[124:127], v[60:63]
  s_cmp_eq_u32 s27, 147456
  s_cselect_b32 s27, 0, s27
  v_add_u32 v8, s27, v4
  v_mfma_f32_16x16x32_bf16 v[60:63], v[152:155], v[120:123], v[60:63]
  v_add_u32 v9, s27, v5
  v_add_u32 v10, s27, v6
  s_mov_b32 s28, 4
  s_waitcnt lgkmcnt(0)
Lk3_lb:
  s_waitcnt vmcnt(24) lgkmcnt(0)
  s_barrier
  v_mfma_f32_16x16x32_bf16 v[32:35], v[128:131], v[64:67], v[32:35]
  s_add_u32 m0, s26, s41
  s_nop 0
  buffer_load_dwordx4 v1, s[8:11], s23 offen lds
  ds_read_b128 v[96:99], v8 offset:0
  ds_read_b128 v[100:103], v8 offset:1024
  v_mfma_f32_16x16x32_bf16 v[32:35], v[132:135], v[68:71], v[32:35]
  buffer_load_dwordx4 v1, s[8:11], s23 offen offset:1024 lds
  ds_read_b64_tr_b16 v[144:145], v9 offset:0
  ds_read_b64_tr_b16 v[146:147], v9 offset:2048
  v_mfma_f32_16x16x32_bf16 v[36:39], v[140:143], v[68:71], v[36:39]
  buffer_load_dwordx4 v1, s[8:11], s24 offen offset:2048 lds
  ds_read_b64_tr_b16 v[152:153], v10 offset:0
  ds_read_b64_tr_b16 v[154:155], v10 offset:2048
  v_mfma_f32_16x16x32_bf16 v[36:39], v[136:139], v[64:67], v[36:39]
  buffer_load_dwordx4 v1, s[8:11], s24 offen offset:3072 lds
  ds_read_b64_tr_b16 v[148:149], v9 offset:4096
  ds_read_b64_tr_b16 v[150:151], v9 offset:6144
  v_mfma_f32_16x16x32_bf16 v[40:43], v[128:131], v[72:75], v[40:43]
  s_add_u32 m0, s26, s42
  s_nop 0
  buffer_load_dwordx4 v2, s[12:15], s25 offen lds
  ds_read_b64_tr_b16 v[156:157], v10 offset:4096
  ds_read_b64_tr_b16 v[158:159], v10 offset:6144
  v_mfma_f32_16x16x32_bf16 v[40:43], v[132:135], v[76:79], v[40:43]
  buffer_load_dwordx4 v3, s[12:15], s25 offen offset:1024 lds
  ds_read_b128 v[104:107], v8 offset:2048
  ds_read_b128 v[108:111], v8 offset:3072
  v_mfma_f32_16x16x32_bf16 v[44:47], v[140:143], v[76:79], v[44:47]
  ds_read_b128 v[112:115], v8 offset:4096
  ds_read_b128 v[116:119], v8 offset:5120
  v_mfma_f32_16x16x32_bf16 v[44:47], v[136:139], v[72:75], v[44:47]
  ds_read_b128 v[120:123], v8 offset:6144
  ds_read_b128 v[124:127], v8 offset:7168
  v_mfma_f32_16x16x32_bf16 v[48:51], v[128:131], v[80:83], v[48:51]
  s_add_u32 s23, s23, 2048
  s_add_u32 s24, s24, 2048
  s_add_u32 s25, s25, 131072
  v_mfma_f32_16x16x32_bf16 v[48:51], v[132:135], v[84:87], v[48:51]
  s_add_u32 s26, s26, 24576
  s_cmp_eq_u32 s26, 147456
  s_cselect_b32 s26, 0, s26
  v_mfma_f32_16x16x32_bf16 v[52:55], v[140:143], v[84:87], v[52:55]
  s_sub_u32 s31, s31, 1
  s_cmp_eq_u32 s31, 0
  v_mfma_f32_16x16x32_bf16 v[52:55], v[136:139], v[80:83], v[52:55]
  s_cselect_b64 s[8:9], s[44:45], s[8:9]
  s_cselect_b32 s10, s43, s10
  s_cselect_b64 s[12:13], s[46:47], s[12:13]
  v_mfma_f32_16x16x32_bf16 v[56:59], v[128:131], v[88:91], v[56:59]
  s_cselect_b32 s14, s48, s14
  s_cselect_b32 s23, s49, s23
  s_cselect_b32 s24, s50, s24
  v_mfma_f32_16x16x32_bf16 v[56:59], v[132:135], v[92:95], v[56:59]
  s_cselect_b32 s25, s51, s25
  s_add_u32 s27, s27, 24576
  v_mfma_f32_16x16x32_bf16 v[60:63], v[140:143], v[92:95], v[60:63]
  s_cmp_eq_u32 s27, 147456
  s_cselect_b32 s27, 0, s27
  v_add_u32 v8, s27, v4
  v_mfma_f32_16x16x32_bf16 v[60:63], v[136:139], v[88:91], v[60:63]
  v_add_u32 v9, s27, v5
  v_add_u32 v10, s27, v6
  s_waitcnt vmcnt(24) lgkmcnt(0)
  s_barrier
  v_mfma_f32_16x16x32_bf16 v[32:35], v[144:147], v[96:99], v[32:35]
  s_add_u32 m0, s26, s41
  s_nop 0
  buffer_load_dwordx4 v1, s[8:11], s23 offen lds
  ds_read_b128 v[64:67], v8 offset:0
  ds_read_b128 v[68:71], v8 offset:1024
  v_mfma_f32_16x16x32_bf16 v[32:35], v[148:151], v[100:103], v[32:35]
  buffer_load_dwordx4 v1, s[8:11], s23 offen offset:1024 lds
  ds_read_b64_tr_b16 v[128:129], v9 offset:0
  ds_read_b64_tr_b16 v[130:131], v9 offset:2048
  v_mfma_f32_16x16x32_bf16 v[36:39], v[156:159], v[100:103], v[36:39]
  buffer_load_dwordx4 v1, s[8:11], s24 offen offset:2048 lds
  ds_read_b64_tr_b16 v[136:137], v10 offset:0
  ds_read_b64_tr_b16 v[138:139], v10 offset:2048
  v_mfma_f32_16x16x32_bf16 v[36:39], v[152:155], v[96:99], v[36:39]
  buffer_load_dwordx4 v1, s[8:11], s24 offen offset:3072 lds
  ds_read_b64_tr_b16 v[132:133], v9 offset:4096
  ds_read_b64_tr_b16 v[134:135], v9 offset:6144
  v_mfma_f32_16x16x32_bf16 v[40:43], v[144:147], v[104:107], v[40:43]
  s_add_u32 m0, s26, s42
  s_nop 0
  buffer_load_dwordx4 v2, s[12:15], s25 offen lds
  ds_read_b64_tr_b16 v[140:141], v10 offset:4096
  ds_read_b64_tr_b16 v[142:143], v10 offset:6144
  v_mfma_f32_16x16x32_bf16 v[40:43], v[148:151], v[108:111], v[40:43]
  buffer_load_dwordx4 v3, s[12:15], s25 offen offset:1024 lds
  ds_read_b128 v[72:75], v8 offset:2048
  ds_read_b128 v[76:79], v8 offset:3072
  v_mfma_f32_16x16x32_bf16 v[44:47], v[156:159], v[108:111], v[44:47]
  ds_read_b128 v[80:83], v8 offset:4096
  ds_read_b128 v[84:87], v8 offset:5120
  v_mfma_f32_16x16x32_bf16 v[44:47], v[152:155], v[104:107], v[44:47]
  ds_read_b128 v[88:91], v8 offset:6144
  ds_read_b128 v[92:95], v8 offset:7168
  v_mfma_f32_16x16x32_bf16 v[48:51], v[144:147], v[112:115], v[48:51]
  s_add_u32 s23, s23, 2048
  s_add_u32 s24, s24, 2048
  s_add_u32 s25, s25, 131072
  v_mfma_f32_16x16x32_bf16 v[48:51], v[148:151], v[116:119], v[48:51]
  s_add_u32 s26, s26, 24576
  s_cmp_eq_u32 s26, 147456
  s_cselect_b32 s26, 0, s26
  v_mfma_f32_16x16x32_bf16 v[52:55], v[156:159], v[116:119], v[52:55]
  s_sub_u32 s31, s31, 1
  s_cmp_eq_u32 s31, 0
  v_mfma_f32_16x16x32_bf16 v[52:55], v[152:155], v[112:115], v[52:55]
  s_cselect_b64 s[8:9], s[44:45], s[8:9]
  s_cselect_b32 s10, s43, s10
  s_cselect_b64 s[12:13], s[46:47], s[12:13]
  v_mfma_f32_16x16x32_bf16 v[56:59], v[144:147], v[120:123], v[56:59]
  s_cselect_b32 s14, s48, s14
  s_cselect_b32 s23, s49, s23
  s_cselect_b32 s24, s50, s24
  v_mfma_f32_16x16x32_bf16 v[56:59], v[148:151], v[124:127], v[56:59]
  s_cselect_b32 s25, s51, s25
  s_add_u32 s27, s27, 24576
  v_mfma_f32_16x16x32_bf16 v[60:63], v[156:159], v[124:127], v[60:63]
  s_cmp_eq_u32 s27, 147456
  s_cselect_b32 s27, 0, s27
  v_add_u32 v8, s27, v4
  v_mfma_f32_16x16x32_bf16 v[60:63], v[152:155], v[120:123], v[60:63]
  v_add_u32 v9, s27, v5
  v_add_u32 v10, s27, v6
  s_sub_u32 s28, s28, 1
  s_cmp_lg_u32 s28, 0
  s_cbranch_scc1 Lk3_lb
  s_waitcnt vmcnt(24) lgkmcnt(0)
  s_barrier
  v_mfma_f32_16x16x32_bf16 v[32:35], v[128:131], v[64:67], v[32:35]
  ds_read_b128 v[96:99], v8 offset:0
  ds_read_b128 v[100:103], v8 offset:1024
  v_mfma_f32_16x16x32_bf16 v[32:35], v[132:135], v[68:71], v[32:35]
  ds_read_b64_tr_b16 v[144:145], v9 offset:0
  ds_read_b64_tr_b16 v[146:147], v9 offset:2048
  v_mfma_f32_16x16x32_bf16 v[36:39], v[140:143], v[68:71], v[36:39]
  ds_read_b64_tr_b16 v[152:153], v10 offset:0
  ds_read_b64_tr_b16 v[154:155], v10 offset:2048
  v_mfma_f32_16x16x32_bf16 v[36:39], v[136:139], v[64:67], v[36:39]
  ds_read_b64_tr_b16 v[148:149], v9 offset:4096
  ds_read_b64_tr_b16 v[150:151], v9 offset:6144
  v_mfma_f32_16x16x32_bf16 v[40:43], v[128:131], v[72:75], v[40:43]
  ds_read_b64_tr_b16 v[156:157], v10 offset:4096
  ds_read_b64_tr_b16 v[158:159], v10 offset:6144
  v_mfma_f32_16x16x32_bf16 v[40:43], v[132:135], v[76:79], v[40:43]
  ds_read_b128 v[104:107], v8 offset:2048
  ds_read_b128 v[108:111], v8 offset:3072
  v_mfma_f32_16x16x32_bf16 v[44:47], v[140:143], v[76:79], v[44:47]
  ds_read_b128 v[112:115], v8 offset:4096
  ds_read_b128 v[116:119], v8 offset:5120
  v_mfma_f32_16x16x32_bf16 v[44:47], v[136:139], v[72:75], v[44:47]
  ds_read_b128 v[120:123], v8 offset:6144
  ds_read_b128 v[124:127], v8 offset:7168
  v_mfma_f32_16x16x32_bf16 v[48:51], v[128:131], v[80:83], v[48:51]
  s_add_u32 s27, s27, 24576
  v_mfma_f32_16x16x32_bf16 v[48:51], v[132:135], v[84:87], v[48:51]
  s_cmp_eq_u32 s27, 147456
  v_mfma_f32_16x16x32_bf16 v[52:55], v[140:143], v[84:87], v[52:55]
  s_cselect_b32 s27, 0, s27
  v_mfma_f32_16x16x32_bf16 v[52:55], v[136:139], v[80:83], v[52:55]
  v_mfma_f32_16x16x32_bf16 v[56:59], v[128:131], v[88:91], v[56:59]
  v_add_u32 v8, s27, v4
  v_mfma_f32_16x16x32_bf16 v[56:59], v[132:135], v[92:95], v[56:59]
  v_add_u32 v9, s27, v5
  v_mfma_f32_16x16x32_bf16 v[60:63], v[140:143], v[92:95], v[60:63]
  v_add_u32 v10, s27, v6
  v_mfma_f32_16x16x32_bf16 v[60:63], v[136:139], v[88:91], v[60:63]
  s_waitcnt vmcnt(18) lgkmcnt(0)
  s_barrier
  v_mfma_f32_16x16x32_bf16 v[32:35], v[144:147], v[96:99], v[32:35]
  ds_read_b128 v[64:67], v8 offset:0
  ds_read_b128 v[68:71], v8 offset:1024
  v_mfma_f32_16x16x32_bf16 v[32:35], v[148:151], v[100:103], v[32:35]
  ds_read_b64_tr_b16 v[128:129], v9 offset:0
  ds_read_b64_tr_b16 v[130:131], v9 offset:2048
  v_mfma_f32_16x16x32_bf16 v[36:39], v[156:159], v[100:103], v[36:39]
  ds_read_b64_tr_b16 v[136:137], v10 offset:0
  ds_read_b64_tr_b16 v[138:139], v10 offset:2048
  v_mfma_f32_16x16x32_bf16 v[36:39], v[152:155], v[96:99], v[36:39]
  ds_read_b64_tr_b16 v[132:133], v9 offset:4096
  ds_read_b64_tr_b16 v[134:135], v9 offset:6144
  v_mfma_f32_16x16x32_bf16 v[40:43], v[144:147], v[104:107], v[40:43]
  ds_read_b64_tr_b16 v[140:141], v10 offset:4096
  ds_read_b64_tr_b16 v[142:143], v10 offset:6144
  v_mfma_f32_16x16x32_bf16 v[40:43], v[148:151], v[108:111], v[40:43]
  ds_read_b128 v[72:75], v8 offset:2048
  ds_read_b128 v[76:79], v8 offset:3072
  v_mfma_f32_16x16x32_bf16 v[44:47], v[156:159], v[108:111], v[44:47]
  ds_read_b128 v[80:83], v8 offset:4096
  ds_read_b128 v[84:87], v8 offset:5120
  v_mfma_f32_16x16x32_bf16 v[44:47], v[152:155], v[104:107], v[44:47]
  ds_read_b128 v[88:91], v8 offset:6144
  ds_read_b128 v[92:95], v8 offset:7168
  v_mfma_f32_16x16x32_bf16 v[48:51], v[144:147], v[112:115], v[48:51]
  s_add_u32 s27, s27, 24576
  v_mfma_f32_16x16x32_bf16 v[48:51], v[148:151], v[116:119], v[48:51]
  s_cmp_eq_u32 s27, 147456
  v_mfma_f32_16x16x32_bf16 v[52:55], v[156:159], v[116:119], v[52:55]
  s_cselect_b32 s27, 0, s27
  v_mfma_f32_16x16x32_bf16 v[52:55], v[152:155], v[112:115], v[52:55]
  v_mfma_f32_16x16x32_bf16 v[56:59], v[144:147], v[120:123], v[56:59]
  v_add_u32 v8, s27, v4
  v_mfma_f32_16x16x32_bf16 v[56:59], v[148:151], v[124:127], v[56:59]
  v_add_u32 v9, s27, v5
  v_mfma_f32_16x16x32_bf16 v[60:63], v[156:159], v[124:127], v[60:63]
  v_add_u32 v10, s27, v6
  v_mfma_f32_16x16x32_bf16 v[60:63], v[152:155], v[120:123], v[60:63]
  s_waitcnt vmcnt(12) lgkmcnt(0)
  s_barrier
  v_mfma_f32_16x16x32_bf16 v[32:35], v[128:131], v[64:67], v[32:35]
  ds_read_b128 v[96:99], v8 offset:0
  ds_read_b128 v[100:103], v8 offset:1024
  v_mfma_f32_16x16x32_bf16 v[32:35], v[132:135], v[68:71], v[32:35]
  ds_read_b64_tr_b16 v[144:145], v9 offset:0
  ds_read_b64_tr_b16 v[146:147], v9 offset:2048
  v_mfma_f32_16x16x32_bf16 v[36:39], v[140:143], v[68:71], v[36:39]
  ds_read_b64_tr_b16 v[152:153], v10 offset:0
  ds_read_b64_tr_b16 v[154:155], v10 offset:2048
  v_mfma_f32_16x16x32_bf16 v[36:39], v[136:139], v[64:67], v[36:39]
  ds_read_b64_tr_b16 v[148:149], v9 offset:4096
  ds_read_b64_tr_b16 v[150:151], v9 offset:6144
  v_mfma_f32_16x16x32_bf16 v[40:43], v[128:131], v[72:75], v[40:43]
  ds_read_b64_tr_b16 v[156:157], v10 offset:4096
  ds_read_b64_tr_b16 v[158:159], v10 offset:6144
  v_mfma_f32_16x16x32_bf16 v[40:43], v[132:135], v[76:79], v[40:43]
  ds_read_b128 v[104:107], v8 offset:2048
  ds_read_b128 v[108:111], v8 offset:3072
  v_mfma_f32_16x16x32_bf16 v[44:47], v[140:143], v[76:79], v[44:47]
  ds_read_b128 v[112:115], v8 offset:4096
  ds_read_b128 v[116:119], v8 offset:5120
  v_mfma_f32_16x16x32_bf16 v[44:47], v[136:139], v[72:75], v[44:47]
  ds_read_b128 v[120:123], v8 offset:6144
  ds_read_b128 v[124:127], v8 offset:7168
  v_mfma_f32_16x16x32_bf16 v[48:51], v[128:131], v[80:83], v[48:51]
  s_add_u32 s27, s27, 24576
  v_mfma_f32_16x16x32_bf16 v[48:51], v[132:135], v[84:87], v[48:51]
  s_cmp_eq_u32 s27, 147456
  v_mfma_f32_16x16x32_bf16 v[52:55], v[140:143], v[84:87], v[52:55]
  s_cselect_b32 s27, 0, s27
  v_mfma_f32_16x16x32_bf16 v[52:55], v[136:139], v[80:83], v[52:55]
  v_mfma_f32_16x16x32_bf16 v[56:59], v[128:131], v[88:91], v[56:59]
  v_add_u32 v8, s27, v4
  v_mfma_f32_16x16x32_bf16 v[56:59], v[132:135], v[92:95], v[56:59]
  v_add_u32 v9, s27, v5
  v_mfma_f32_16x16x32_bf16 v[60:63], v[140:143], v[92:95], v[60:63]
  v_add_u32 v10, s27, v6
  v_mfma_f32_16x16x32_bf16 v[60:63], v[136:139], v[88:91], v[60:63]
  s_waitcnt vmcnt(6) lgkmcnt(0)
  s_barrier
  v_mfma_f32_16x16x32_bf16 v[32:35], v[144:147], v[96:99], v[32:35]
  ds_read_b128 v[64:67], v8 offset:0
  ds_read_b128 v[68:71], v8 offset:1024
  v_mfma_f32_16x16x32_bf16 v[32:35], v[148:151], v[100:103], v[32:35]
  ds_read_b64_tr_b16 v[128:129], v9 offset:0
  ds_read_b64_tr_b16 v[130:131], v9 offset:2048
  v_mfma_f32_16x16x32_bf16 v[36:39], v[156:159], v[100:103], v[36:39]
  ds_read_b64_tr_b16 v[136:137], v10 offset:0
  ds_read_b64_tr_b16 v[138:139], v10 offset:2048
  v_mfma_f32_16x16x32_bf16 v[36:39], v[152:155], v[96:99], v[36:39]
  ds_read_b64_tr_b16 v[132:133], v9 offset:4096
  ds_read_b64_tr_b16 v[134:135], v9 offset:6144
  v_mfma_f32_16x16x32_bf16 v[40:43], v[144:147], v[104:107], v[40:43]
  ds_read_b64_tr_b16 v[140:141], v10 offset:4096
  ds_read_b64_tr_b16 v[142:143], v10 offset:6144
  v_mfma_f32_16x16x32_bf16 v[40:43], v[148:151], v[108:111], v[40:43]
  ds_read_b128 v[72:75], v8 offset:2048
  ds_read_b128 v[76:79], v8 offset:3072
  v_mfma_f32_16x16x32_bf16 v[44:47], v[156:159], v[108:111], v[44:47]
  ds_read_b128 v[80:83], v8 offset:4096
  ds_read_b128 v[84:87], v8 offset:5120
  v_mfma_f32_16x16x32_bf16 v[44:47], v[152:155], v[104:107], v[44:47]
  ds_read_b128 v[88:91], v8 offset:6144
  ds_read_b128 v[92:95], v8 offset:7168
  v_mfma_f32_16x16x32_bf16 v[48:51], v[144:147], v[112:115], v[48:51]
  s_add_u32 s27, s27, 24576
  v_mfma_f32_16x16x32_bf16 v[48:51], v[148:151], v[116:119], v[48:51]
  s_cmp_eq_u32 s27, 147456
  v_mfma_f32_16x16x32_bf16 v[52:55], v[156:159], v[116:119], v[52:55]
  s_cselect_b32 s27, 0, s27
  v_mfma_f32_16x16x32_bf16 v[52:55], v[152:155], v[112:115], v[52:55]
  v_mfma_f32_16x16x32_bf16 v[56:59], v[144:147], v[120:123], v[56:59]
  v_add_u32 v8, s27, v4
  v_mfma_f32_16x16x32_bf16 v[56:59], v[148:151], v[124:127], v[56:59]
  v_add_u32 v9, s27, v5
  v_mfma_f32_16x16x32_bf16 v[60:63], v[156:159], v[124:127], v[60:63]
  v_add_u32 v10, s27, v6
  v_mfma_f32_16x16x32_bf16 v[60:63], v[152:155], v[120:123], v[60:63]
  s_waitcnt vmcnt(0) lgkmcnt(0)
  s_barrier
  v_mfma_f32_16x16x32_bf16 v[32:35], v[128:131], v[64:67], v[32:35]
  ds_read_b128 v[96:99], v8 offset:0
  ds_read_b128 v[100:103], v8 offset:1024
  v_mfma_f32_16x16x32_bf16 v[32:35], v[132:135], v[68:71], v[32:35]
  ds_read_b64_tr_b16 v[144:145], v9 offset:0
  ds_read_b64_tr_b16 v[146:147], v9 offset:2048
  v_mfma_f32_16x16x32_bf16 v[36:39], v[140:143], v[68:71], v[36:39]
  ds_read_b64_tr_b16 v[152:153], v10 offset:0
  ds_read_b64_tr_b16 v[154:155], v10 offset:2048
  v_mfma_f32_16x16x32_bf16 v[36:39], v[136:139], v[64:67], v[36:39]
  ds_read_b64_tr_b16 v[148:149], v9 offset:4096
  ds_read_b64_tr_b16 v[150:151], v9 offset:6144
  v_mfma_f32_16x16x32_bf16 v[40:43], v[128:131], v[72:75], v[40:43]
  ds_read_b64_tr_b16 v[156:157], v10 offset:4096
  ds_read_b64_tr_b16 v[158:159], v10 offset:6144
  v_mfma_f32_16x16x32_bf16 v[40:43], v[132:135], v[76:79], v[40:43]
  ds_read_b128 v[104:107], v8 offset:2048
  ds_read_b128 v[108:111], v8 offset:3072
  v_mfma_f32_16x16x32_bf16 v[44:47], v[140:143], v[76:79], v[44:47]
  ds_read_b128 v[112:115], v8 offset:4096
  ds_read_b128 v[116:119], v8 offset:5120
  v_mfma_f32_16x16x32_bf16 v[44:47], v[136:139], v[72:75], v[44:47]
  ds_read_b128 v[120:123], v8 offset:6144
  ds_read_b128 v[124:127], v8 offset:7168
  v_mfma_f32_16x16x32_bf16 v[48:51], v[128:131], v[80:83], v[48:51]
  s_add_u32 s27, s27, 24576
  v_mfma_f32_16x16x32_bf16 v[48:51], v[132:135], v[84:87], v[48:51]
  s_cmp_eq_u32 s27, 147456
  v_mfma_f32_16x16x32_bf16 v[52:55], v[140:143], v[84:87], v[52:55]
  s_cselect_b32 s27, 0, s27
  v_mfma_f32_16x16x32_bf16 v[52:55], v[136:139], v[80:83], v[52:55]
  v_mfma_f32_16x16x32_bf16 v[56:59], v[128:131], v[88:91], v[56:59]
  v_add_u32 v8, s27, v4
  v_mfma_f32_16x16x32_bf16 v[56:59], v[132:135], v[92:95], v[56:59]
  v_add_u32 v9, s27, v5
  v_mfma_f32_16x16x32_bf16 v[60:63], v[140:143], v[92:95], v[60:63]
  v_add_u32 v10, s27, v6
  v_mfma_f32_16x16x32_bf16 v[60:63], v[136:139], v[88:91], v[60:63]
  s_waitcnt lgkmcnt(0)
  v_mfma_f32_16x16x32_bf16 v[32:35], v[144:147], v[96:99], v[32:35]
  v_mfma_f32_16x16x32_bf16 v[32:35], v[148:151], v[100:103], v[32:35]
  v_mfma_f32_16x16x32_bf16 v[36:39], v[156:159], v[100:103], v[36:39]
  v_mfma_f32_16x16x32_bf16 v[36:39], v[152:155], v[96:99], v[36:39]
  v_mfma_f32_16x16x32_bf16 v[40:43], v[144:147], v[104:107], v[40:43]
  v_mfma_f32_16x16x32_bf16 v[40:43], v[148:151], v[108:111], v[40:43]
  v_mfma_f32_16x16x32_bf16 v[44:47], v[156:159], v[108:111], v[44:47]
  v_mfma_f32_16x16x32_bf16 v[44:47], v[152:155], v[104:107], v[44:47]
  v_mfma_f32_16x16x32_bf16 v[48:51], v[144:147], v[112:115], v[48:51]
  v_mfma_f32_16x16x32_bf16 v[48:51], v[148:151], v[116:119], v[48:51]
  v_mfma_f32_16x16x32_bf16 v[52:55], v[156:159], v[116:119], v[52:55]
  v_mfma_f32_16x16x32_bf16 v[52:55], v[152:155], v[112:115], v[52:55]
  v_mfma_f32_16x16x32_bf16 v[56:59], v[144:147], v[120:123], v[56:59]
  v_mfma_f32_16x16x32_bf16 v[56:59], v[148:151], v[124:127], v[56:59]
  v_mfma_f32_16x16x32_bf16 v[60:63], v[156:159], v[124:127], v[60:63]
  v_mfma_f32_16x16x32_bf16 v[60:63], v[152:155], v[120:123], v[60:63]
  v_bfe_u32 v12, v0, 4, 1
  v_lshrrev_b32 v13, 5, v0
  v_lshl_or_b32 v12, v12, 1, v13
  v_and_b32 v13, 15, v0
  v_lshlrev_b32 v13, 13, v13
  v_lshl_add_u32 v12, v12, 4, v13
  s_lshl_b32 s3, s21, 0
  s_add_u32 s3, s3, s29
  s_lshl_b32 s3, s3, 12
  s_lshl_b32 s4, s22, 5
  s_add_u32 s4, s4, s30
  s_lshl_b32 s4, s4, 1
  s_add_u32 s3, s3, s4
  s_add_u32 s3, s3, 2048
  v_cvt_pk_bf16_f32 v16, v32, v33
  v_cvt_pk_bf16_f32 v17, v34, v35
  v_cvt_pk_bf16_f32 v18, v36, v37
  v_cvt_pk_bf16_f32 v19, v38, v39
  s_nop 0
  v_permlane16_swap_b32 v16, v18
  v_permlane16_swap_b32 v17, v19
  buffer_store_dwordx4 v[16:19], v12, s[16:19], s3 offen
  s_add_u32 s3, s3, 131072
  v_cvt_pk_bf16_f32 v20, v40, v41
  v_cvt_pk_bf16_f32 v21, v42, v43
  v_cvt_pk_bf16_f32 v22, v44, v45
  v_cvt_pk_bf16_f32 v23, v46, v47
  s_nop 0
  v_permlane16_swap_b32 v20, v22
  v_permlane16_swap_b32 v21, v23
  buffer_store_dwordx4 v[20:23], v12, s[16:19], s3 offen
  s_add_u32 s3, s3, 131072
  v_cvt_pk_bf16_f32 v16, v48, v49
  v_cvt_pk_bf16_f32 v17, v50, v51
  v_cvt_pk_bf16_f32 v18, v52, v53
  v_cvt_pk_bf16_f32 v19, v54, v55
  s_nop 0
  v_permlane16_swap_b32 v16, v18
  v_permlane16_swap_b32 v17, v19
  buffer_store_dwordx4 v[16:19], v12, s[16:19], s3 offen
  s_add_u32 s3, s3, 131072
  v_cvt_pk_bf16_f32 v20, v56, v57
  v_cvt_pk_bf16_f32 v21, v58, v59
  v_cvt_pk_bf16_f32 v22, v60, v61
  v_cvt_pk_bf16_f32 v23, v62, v63
  s_nop 0
  v_permlane16_swap_b32 v20, v22
  v_permlane16_swap_b32 v21, v23
  buffer_store_dwordx4 v[20:23], v12, s[16:19], s3 offen
Lk3_end:
  s_endpgm
.section .rodata,"a"
.p2align 6
.amdhsa_kernel k1_proj_kernel
  .amdhsa_next_free_vgpr 512
  .amdhsa_next_free_sgpr 102
  .amdhsa_accum_offset 256
  .amdhsa_group_segment_fixed_size 0
  .amdhsa_kernarg_size 96
  .amdhsa_user_sgpr_count 2
  .amdhsa_user_sgpr_kernarg_segment_ptr 1
  .amdhsa_system_sgpr_workgroup_id_x 1
.end_amdhsa_kernel
.p2align 6
.amdhsa_kernel k2_attn_kernel
  .amdhsa_next_free_vgpr 500
  .amdhsa_next_free_sgpr 102
  .amdhsa_accum_offset 256
  .amdhsa_group_segment_fixed_size 0
  .amdhsa_kernarg_size 96
  .amdhsa_user_sgpr_count 2
  .amdhsa_user_sgpr_kernarg_segment_ptr 1
  .amdhsa_system_sgpr_workgroup_id_x 1
.end_amdhsa_kernel
.p2align 6
.amdhsa_kernel k3_oproj_kernel
  .amdhsa_next_free_vgpr 160
  .amdhsa_next_free_sgpr 102
  .amdhsa_accum_offset 160
  .amdhsa_group_segment_fixed_size 0
  .amdhsa_kernarg_size 96
  .amdhsa_user_sgpr_count 2
  .amdhsa_user_sgpr_kernarg_segment_ptr 1
  .amdhsa_system_sgpr_workgroup_id_x 1
.end_amdhsa_kernel
```

```asm
; @launch kernel=k1_proj_kernel grid=(256,1,1) block=(256,1,1) lds=163840
; @launch kernel=k2_attn_kernel grid=(256,1,1) block=(256,1,1) lds=163840
; @launch kernel=k3_oproj_kernel grid=(256,1,1) block=(256,1,1) lds=131072
.amdgcn_target "amdgcn-amd-amdhsa--gfx950"
.text
.globl k1_proj_kernel
.p2align 8
.type k1_proj_kernel,@function
k1_proj_kernel:
  s_cmp_ge_u32 s2, 256
  s_cbranch_scc1 Lk1_end
  s_load_dwordx16 s[32:47], s[0:1], 0
  s_load_dwordx2 s[48:49], s[0:1], 64
  s_load_dwordx2 s[50:51], s[0:1], 88
  v_lshrrev_b32 v24, 6, v0
  s_nop 0
  v_readfirstlane_b32 s20, v24
  v_and_b32 v0, 63, v0
  v_lshlrev_b32 v1, 4, v0
  s_lshr_b32 s21, s20, 1
  s_and_b32 s22, s20, 1
  s_lshl_b32 s29, s20, 12
  s_and_b32 s3, s2, 1
  s_lshl_b32 s3, s3, 2
  s_bfe_u32 s6, s2, 0x20003
  s_add_u32 s3, s3, s6
  s_lshl_b32 s52, s3, 8
  s_bfe_u32 s3, s2, 0x20001
  s_lshl_b32 s3, s3, 2
  s_bfe_u32 s7, s2, 0x20005
  s_add_u32 s3, s3, s7
  s_lshl_b32 s53, s3, 8
  s_cmp_lt_u32 s2, 128
  s_cselect_b32 s5, 11, 10
  s_lshl_b32 s3, s21, 7
  s_lshl_b32 s4, s22, 5
  s_add_u32 s3, s3, s4
  v_lshrrev_b32 v24, 3, v0
  v_add_u32 v24, s3, v24
  v_and_b32 v25, 7, v0
  v_add_u32 v26, 0, v24
  v_bfe_u32 v27, v26, 1, 3
  v_xor_b32 v27, v27, v25
  v_lshlrev_b32 v26, s5, v26
  v_lshl_add_u32 v26, v27, 4, v26
  v_subrev_u32 v2, 0, v26
  v_add_u32 v26, 8, v24
  v_bfe_u32 v27, v26, 1, 3
  v_xor_b32 v27, v27, v25
  v_lshlrev_b32 v26, s5, v26
  v_lshl_add_u32 v26, v27, 4, v26
  v_subrev_u32 v3, 1024, v26
  v_add_u32 v26, 16, v24
  v_bfe_u32 v27, v26, 1, 3
  v_xor_b32 v27, v27, v25
  v_lshlrev_b32 v26, s5, v26
  v_lshl_add_u32 v26, v27, 4, v26
  v_subrev_u32 v4, 2048, v26
  v_add_u32 v26, 24, v24
  v_bfe_u32 v27, v26, 1, 3
  v_xor_b32 v27, v27, v25
  v_lshlrev_b32 v26, s5, v26
  v_lshl_add_u32 v26, v27, 4, v26
  v_subrev_u32 v5, 3072, v26
  s_lshl_b32 s3, s20, 3
  v_lshrrev_b32 v24, 5, v0
  v_add_u32 v24, s3, v24
  v_and_b32 v25, 31, v0
  v_add_u32 v26, 0, v24
  v_and_b32 v27, 3, v26
  v_lshlrev_b32 v27, 1, v27
  v_and_or_b32 v27, v26, 8, v27
  v_xor_b32 v27, v27, v25
  v_lshlrev_b32 v26, 13, v26
  v_lshl_add_u32 v26, v27, 4, v26
  v_subrev_u32 v6, 0, v26
  v_add_u32 v26, 2, v24
  v_and_b32 v27, 3, v26
  v_lshlrev_b32 v27, 1, v27
  v_and_or_b32 v27, v26, 8, v27
  v_xor_b32 v27, v27, v25
  v_lshlrev_b32 v26, 13, v26
  v_lshl_add_u32 v26, v27, 4, v26
  v_subrev_u32 v7, 1024, v26
  v_add_u32 v26, 4, v24
  v_and_b32 v27, 3, v26
  v_lshlrev_b32 v27, 1, v27
  v_and_or_b32 v27, v26, 8, v27
  v_xor_b32 v27, v27, v25
  v_lshlrev_b32 v26, 13, v26
  v_lshl_add_u32 v26, v27, 4, v26
  v_subrev_u32 v8, 2048, v26
  v_add_u32 v26, 6, v24
  v_and_b32 v27, 3, v26
  v_lshlrev_b32 v27, 1, v27
  v_and_or_b32 v27, v26, 8, v27
  v_xor_b32 v27, v27, v25
  v_lshlrev_b32 v26, 13, v26
  v_lshl_add_u32 v26, v27, 4, v26
  v_subrev_u32 v9, 3072, v26
  s_lshl_b32 s23, s52, s5
  s_lshl_b32 s31, 64, s5
  s_mov_b32 s26, s23
  s_lshl_b32 s24, s53, 1
  s_mov_b32 s28, s24
  s_lshl_b32 s3, 1, s5
  s_add_u32 s25, s23, s3
  s_lshl_b32 s3, s3, 12
  s_add_u32 s27, s24, s3
  s_bfe_u32 s3, s2, 0x20001
  s_and_b32 s4, s2, 1
  s_lshl_b32 s4, s4, 1
  s_add_u32 s3, s3, s4
  s_and_b32 s3, s3, 3
  s_sub_u32 s4, s5, 2
  s_lshl_b32 s3, s3, s4
  s_add_u32 s23, s23, s3
  s_lshl_b32 s3, s3, 12
  s_add_u32 s24, s24, s3
  s_mov_b32 s95, s6
  s_cmp_lt_u32 s2, 128
  s_cselect_b32 s6, -1, 8
  s_waitcnt lgkmcnt(0)
  s_cmp_lt_u32 s2, 128
  s_cselect_b64 s[8:9], s[32:33], s[34:35]
  s_mov_b32 s10, 2097152
  s_cselect_b32 s10, 4194304, s10
  s_mov_b32 s11, 0x00020000
  s_cselect_b64 s[12:13], s[36:37], s[38:39]
  s_mov_b32 s14, 4194304
  s_cselect_b32 s14, 8388608, s14
  s_mov_b32 s15, 0x00020000
  s_mov_b64 s[64:65], s[40:41]
  s_add_u32 m0, s29, 65536
  s_nop 0
  buffer_load_dwordx4 v6, s[12:15], s24 offen offset:0 lds
  buffer_load_dwordx4 v7, s[12:15], s24 offen offset:1024 lds
  buffer_load_dwordx4 v8, s[12:15], s24 offen offset:2048 lds
  buffer_load_dwordx4 v9, s[12:15], s24 offen offset:3072 lds
  s_add_u32 s24, s24, 262144
  s_add_u32 m0, s29, 0
  s_nop 0
  buffer_load_dwordx4 v2, s[8:11], s23 offen offset:0 lds
  buffer_load_dwordx4 v3, s[8:11], s23 offen offset:1024 lds
  buffer_load_dwordx4 v4, s[8:11], s23 offen offset:2048 lds
  buffer_load_dwordx4 v5, s[8:11], s23 offen offset:3072 lds
  s_add_u32 m0, s29, 81920
  s_nop 0
  buffer_load_dwordx4 v6, s[12:15], s24 offen offset:0 lds
  buffer_load_dwordx4 v7, s[12:15], s24 offen offset:1024 lds
  buffer_load_dwordx4 v8, s[12:15], s24 offen offset:2048 lds
  buffer_load_dwordx4 v9, s[12:15], s24 offen offset:3072 lds
  s_add_u32 s24, s24, 262144
  s_cmp_eq_u32 s24, s27
  s_cselect_b32 s24, s28, s24
  s_sub_u32 s6, s6, 1
  s_cmp_eq_u32 s6, 0
  s_cselect_b64 s[12:13], s[64:65], s[12:13]
  s_add_u32 m0, s29, 98304
  s_nop 0
  buffer_load_dwordx4 v6, s[12:15], s24 offen offset:0 lds
  buffer_load_dwordx4 v7, s[12:15], s24 offen offset:1024 lds
  buffer_load_dwordx4 v8, s[12:15], s24 offen offset:2048 lds
  buffer_load_dwordx4 v9, s[12:15], s24 offen offset:3072 lds
  s_add_u32 s24, s24, 262144
  s_add_u32 m0, s29, 16384
  s_add_u32 s3, s23, s31
  s_nop 0
  buffer_load_dwordx4 v2, s[8:11], s3 offen offset:0 lds
  buffer_load_dwordx4 v3, s[8:11], s3 offen offset:1024 lds
  buffer_load_dwordx4 v4, s[8:11], s3 offen offset:2048 lds
  buffer_load_dwordx4 v5, s[8:11], s3 offen offset:3072 lds
  s_add_u32 s23, s23, 128
  s_cmp_eq_u32 s23, s25
  s_cselect_b32 s23, s26, s23
  s_add_u32 m0, s29, 114688
  s_nop 0
  buffer_load_dwordx4 v6, s[12:15], s24 offen offset:0 lds
  buffer_load_dwordx4 v7, s[12:15], s24 offen offset:1024 lds
  buffer_load_dwordx4 v8, s[12:15], s24 offen offset:2048 lds
  buffer_load_dwordx4 v9, s[12:15], s24 offen offset:3072 lds
  s_add_u32 s24, s24, 262144
  s_cmp_eq_u32 s24, s27
  s_cselect_b32 s24, s28, s24
  s_sub_u32 s6, s6, 1
  s_cmp_eq_u32 s6, 0
  s_cselect_b64 s[12:13], s[64:65], s[12:13]
  s_add_u32 s16, s50, 109051904
  s_addc_u32 s17, s51, 0
  s_mov_b32 s18, 1024
  s_mov_b32 s19, 0x00020000
  s_lshl_b32 s3, s2, 2
  v_mov_b32 v24, 0
  buffer_store_dword v24, v24, s[16:19], s3 offen
  s_mov_b32 s63, 0x00020000
  s_cmp_eq_u32 s20, 1
  s_cbranch_scc1 Lk1_pfo
  s_cmp_eq_u32 s20, 0
  s_cbranch_scc0 Lk1_pfw
  s_bfe_u32 s4, s2, 0x20001
  s_lshl_b32 s3, s7, 2
  s_add_u32 s3, s3, s4
  s_lshl_b32 s3, s3, 4
  v_and_b32 v24, 15, v0
  v_add_u32 v24, s3, v24
  v_lshlrev_b32 v20, s5, v24
  s_mov_b64 s[60:61], s[8:9]
  s_mov_b64 s[58:59], s[8:9]
  s_mov_b32 s62, s10
  s_mov_b32 s7, s10
  s_add_u32 s54, s26, 768
  s_mov_b32 s55, 128
  s_mov_b32 s56, s25
  s_mov_b32 s57, s26
  s_branch Lk1_pfc
Lk1_pfw:
  s_lshl_b32 s3, s95, 4
  s_and_b32 s4, s2, 1
  s_lshl_b32 s4, s4, 3
  s_add_u32 s3, s3, s4
  s_lshl_b32 s4, s22, 2
  s_add_u32 s3, s3, s4
  v_bfe_u32 v24, v0, 2, 2
  v_add_u32 v24, s3, v24
  v_and_b32 v25, 3, v0
  v_lshlrev_b32 v25, 7, v25
  v_lshl_add_u32 v20, v24, 13, v25
  s_mov_b64 s[60:61], s[12:13]
  s_mov_b64 s[58:59], s[40:41]
  s_mov_b32 s62, s14
  s_mov_b32 s7, s14
  s_add_u32 s54, s28, 3670016
  s_mov_b32 s55, 524288
  s_mov_b32 s56, s27
  s_mov_b32 s57, s28
Lk1_pfc:
  s_mov_b32 s62, 0
  s_mov_b32 s7, 0
  v_lshrrev_b32 v24, 4, v0
  v_mul_lo_u32 v24, v24, s55
  v_add_u32 v24, v24, v20
  s_mul_i32 s3, s55, 4
  s_sub_u32 s3, s54, s3
  buffer_load_dword v21, v24, s[60:63], s3 offen
  s_branch Lk1_pfd
Lk1_pfo:
  v_lshlrev_b32 v20, 7, v0
  s_and_b32 s3, s2, 127
  s_lshl_b32 s54, s3, 13
  s_mov_b32 s57, s54
  s_mov_b32 s55, 1048576
  s_cmp_lt_u32 s2, 128
  s_cselect_b64 s[60:61], s[46:47], s[42:43]
  s_cselect_b64 s[58:59], s[44:45], s[48:49]
  s_mov_b32 s4, 8388608
  s_cselect_b32 s4, 6291456, s4
  s_add_u32 s56, s54, s4
  s_mov_b32 s62, s4
  s_cmp_lt_u32 s2, 128
  s_mov_b32 s7, 2097152
  s_cselect_b32 s7, 4194304, s7
  s_cselect_b32 s62, s62, 0
  s_cselect_b32 s7, s7, 0
  buffer_load_dword v21, v20, s[60:63], s54 offen
  s_add_u32 s54, s54, s55
  s_cmp_eq_u32 s54, s56
  s_cselect_b32 s54, s57, s54
  s_cselect_b64 s[60:61], s[58:59], s[60:61]
  s_cselect_b32 s62, s7, s62
Lk1_pfd:
  s_add_u32 m0, s29, 32768
  s_nop 0
  buffer_load_dwordx4 v2, s[8:11], s23 offen offset:0 lds
  buffer_load_dwordx4 v3, s[8:11], s23 offen offset:1024 lds
  buffer_load_dwordx4 v4, s[8:11], s23 offen offset:2048 lds
  buffer_load_dwordx4 v5, s[8:11], s23 offen offset:3072 lds
  s_lshl_b32 s4, s21, 13
  v_and_b32 v24, 15, v0
  v_lshlrev_b32 v24, 7, v24
  v_add_u32 v24, s4, v24
  v_bfe_u32 v25, v0, 1, 3
  v_lshrrev_b32 v26, 4, v0
  v_xor_b32 v25, v25, v26
  v_lshl_add_u32 v10, v25, 4, v24
  v_xor_b32 v11, 64, v10
  v_bfe_u32 v24, v0, 2, 2
  v_lshl_add_u32 v29, v26, 3, v24
  v_lshlrev_b32 v25, 9, v29
  v_and_b32 v27, 1, v0
  v_lshl_add_u32 v25, v27, 3, v25
  v_add_u32 v25, 65536, v25
  v_lshlrev_b32 v24, 1, v24
  v_and_or_b32 v24, v29, 8, v24
  v_bfe_u32 v26, v0, 1, 1
  s_lshl_b32 s4, s22, 4
  s_add_u32 s3, s4, 0
  v_add_u32 v27, s3, v26
  v_xor_b32 v27, v27, v24
  v_lshl_add_u32 v12, v27, 4, v25
  s_add_u32 s3, s4, 2
  v_add_u32 v27, s3, v26
  v_xor_b32 v27, v27, v24
  v_lshl_add_u32 v13, v27, 4, v25
  s_add_u32 s3, s4, 4
  v_add_u32 v27, s3, v26
  v_xor_b32 v27, v27, v24
  v_lshl_add_u32 v14, v27, 4, v25
  s_add_u32 s3, s4, 6
  v_add_u32 v27, s3, v26
  v_xor_b32 v27, v27, v24
  v_lshl_add_u32 v15, v27, 4, v25
  s_add_u32 s3, s4, 8
  v_add_u32 v27, s3, v26
  v_xor_b32 v27, v27, v24
  v_lshl_add_u32 v16, v27, 4, v25
  s_add_u32 s3, s4, 10
  v_add_u32 v27, s3, v26
  v_xor_b32 v27, v27, v24
  v_lshl_add_u32 v17, v27, 4, v25
  s_add_u32 s3, s4, 12
  v_add_u32 v27, s3, v26
  v_xor_b32 v27, v27, v24
  v_lshl_add_u32 v18, v27, 4, v25
  s_add_u32 s3, s4, 14
  v_add_u32 v27, s3, v26
  v_xor_b32 v27, v27, v24
  v_lshl_add_u32 v19, v27, 4, v25
  s_waitcnt vmcnt(18)
  s_barrier
  ds_read_b64_tr_b16 a[32:33], v12 offset:0
  ds_read_b64_tr_b16 a[34:35], v12 offset:2048
  ds_read_b64_tr_b16 a[40:41], v13 offset:0
  ds_read_b64_tr_b16 a[42:43], v13 offset:2048
  ds_read_b64_tr_b16 a[48:49], v14 offset:0
  ds_read_b64_tr_b16 a[50:51], v14 offset:2048
  ds_read_b64_tr_b16 a[56:57], v15 offset:0
  ds_read_b64_tr_b16 a[58:59], v15 offset:2048
  ds_read_b64_tr_b16 a[64:65], v16 offset:0
  ds_read_b64_tr_b16 a[66:67], v16 offset:2048
  ds_read_b64_tr_b16 a[72:73], v17 offset:0
  ds_read_b64_tr_b16 a[74:75], v17 offset:2048
  ds_read_b64_tr_b16 a[80:81], v18 offset:0
  ds_read_b64_tr_b16 a[82:83], v18 offset:2048
  ds_read_b64_tr_b16 a[88:89], v19 offset:0
  ds_read_b64_tr_b16 a[90:91], v19 offset:2048
  ds_read_b64_tr_b16 a[36:37], v12 offset:16384
  ds_read_b64_tr_b16 a[38:39], v12 offset:18432
  ds_read_b64_tr_b16 a[44:45], v13 offset:16384
  ds_read_b64_tr_b16 a[46:47], v13 offset:18432
  ds_read_b64_tr_b16 a[52:53], v14 offset:16384
  ds_read_b64_tr_b16 a[54:55], v14 offset:18432
  ds_read_b64_tr_b16 a[60:61], v15 offset:16384
  ds_read_b64_tr_b16 a[62:63], v15 offset:18432
  ds_read_b64_tr_b16 a[68:69], v16 offset:16384
  ds_read_b64_tr_b16 a[70:71], v16 offset:18432
  ds_read_b64_tr_b16 a[76:77], v17 offset:16384
  ds_read_b64_tr_b16 a[78:79], v17 offset:18432
  ds_read_b64_tr_b16 a[84:85], v18 offset:16384
  ds_read_b64_tr_b16 a[86:87], v18 offset:18432
  ds_read_b64_tr_b16 a[92:93], v19 offset:16384
  ds_read_b64_tr_b16 a[94:95], v19 offset:18432
  ds_read_b128 a[160:163], v10 offset:0
  ds_read_b128 a[164:167], v11 offset:0
  ds_read_b128 a[168:171], v10 offset:2048
  ds_read_b128 a[172:175], v11 offset:2048
  s_waitcnt vmcnt(14) lgkmcnt(0)
  s_barrier
  s_add_u32 m0, s29, 65536
  s_nop 0
  buffer_load_dwordx4 v6, s[12:15], s24 offen offset:0 lds
  buffer_load_dwordx4 v7, s[12:15], s24 offen offset:1024 lds
  buffer_load_dwordx4 v8, s[12:15], s24 offen offset:2048 lds
  buffer_load_dwordx4 v9, s[12:15], s24 offen offset:3072 lds
  s_add_u32 s24, s24, 262144
  s_add_u32 m0, s29, 49152
  s_add_u32 s3, s23, s31
  s_nop 0
  buffer_load_dwordx4 v2, s[8:11], s3 offen offset:0 lds
  buffer_load_dwordx4 v3, s[8:11], s3 offen offset:1024 lds
  buffer_load_dwordx4 v4, s[8:11], s3 offen offset:2048 lds
  buffer_load_dwordx4 v5, s[8:11], s3 offen offset:3072 lds
  s_cmp_lt_u32 s2, 128
  s_cbranch_scc0 Lk1_kv
  v_mfma_f32_16x16x32_bf16 v[32:35], a[32:35], a[160:163], 0
  s_add_u32 s23, s23, 128
  s_cmp_eq_u32 s23, s25
  s_cselect_b32 s23, s26, s23
  v_mfma_f32_16x16x32_bf16 v[32:35], a[36:39], a[164:167], v[32:35]
  ds_read_b128 a[176:179], v10 offset:4096
  ds_read_b128 a[180:183], v11 offset:4096
  v_mfma_f32_16x16x32_bf16 v[36:39], a[44:47], a[164:167], 0
  v_mfma_f32_16x16x32_bf16 v[36:39], a[40:43], a[160:163], v[36:39]
  ds_read_b64_tr_b16 a[96:97], v12 offset:32768
  ds_read_b64_tr_b16 a[98:99], v12 offset:34816
  v_mfma_f32_16x16x32_bf16 v[40:43], a[48:51], a[160:163], 0
  v_mfma_f32_16x16x32_bf16 v[40:43], a[52:55], a[164:167], v[40:43]
  v_mfma_f32_16x16x32_bf16 v[44:47], a[60:63], a[164:167], 0
  s_add_u32 m0, s29, 81920
  s_nop 0
  buffer_load_dwordx4 v6, s[12:15], s24 offen offset:0 lds
  v_mfma_f32_16x16x32_bf16 v[44:47], a[56:59], a[160:163], v[44:47]
  ds_read_b64_tr_b16 a[104:105], v13 offset:32768
  ds_read_b64_tr_b16 a[106:107], v13 offset:34816
  v_mfma_f32_16x16x32_bf16 v[48:51], a[64:67], a[160:163], 0
  v_mfma_f32_16x16x32_bf16 v[48:51], a[68:71], a[164:167], v[48:51]
  v_mfma_f32_16x16x32_bf16 v[52:55], a[76:79], a[164:167], 0
  v_mfma_f32_16x16x32_bf16 v[52:55], a[72:75], a[160:163], v[52:55]
  ds_read_b64_tr_b16 a[112:113], v14 offset:32768
  ds_read_b64_tr_b16 a[114:115], v14 offset:34816
  v_mfma_f32_16x16x32_bf16 v[56:59], a[80:83], a[160:163], 0
  v_mfma_f32_16x16x32_bf16 v[56:59], a[84:87], a[164:167], v[56:59]
  buffer_load_dwordx4 v7, s[12:15], s24 offen offset:1024 lds
  v_mfma_f32_16x16x32_bf16 v[60:63], a[92:95], a[164:167], 0
  v_mfma_f32_16x16x32_bf16 v[60:63], a[88:91], a[160:163], v[60:63]
  ds_read_b64_tr_b16 a[120:121], v15 offset:32768
  ds_read_b64_tr_b16 a[122:123], v15 offset:34816
  v_mfma_f32_16x16x32_bf16 v[64:67], a[32:35], a[168:171], 0
  v_mfma_f32_16x16x32_bf16 v[64:67], a[36:39], a[172:175], v[64:67]
  ds_read_b128 a[184:187], v10 offset:6144
  ds_read_b128 a[188:191], v11 offset:6144
  v_mfma_f32_16x16x32_bf16 v[68:71], a[44:47], a[172:175], 0
  v_mfma_f32_16x16x32_bf16 v[68:71], a[40:43], a[168:171], v[68:71]
  ds_read_b64_tr_b16 a[128:129], v16 offset:32768
  ds_read_b64_tr_b16 a[130:131], v16 offset:34816
  v_mfma_f32_16x16x32_bf16 v[72:75], a[48:51], a[168:171], 0
  buffer_load_dwordx4 v8, s[12:15], s24 offen offset:2048 lds
  v_mfma_f32_16x16x32_bf16 v[72:75], a[52:55], a[172:175], v[72:75]
  v_mfma_f32_16x16x32_bf16 v[76:79], a[60:63], a[172:175], 0
  v_mfma_f32_16x16x32_bf16 v[76:79], a[56:59], a[168:171], v[76:79]
  ds_read_b64_tr_b16 a[136:137], v17 offset:32768
  ds_read_b64_tr_b16 a[138:139], v17 offset:34816
  v_mfma_f32_16x16x32_bf16 v[80:83], a[64:67], a[168:171], 0
  v_mfma_f32_16x16x32_bf16 v[80:83], a[68:71], a[172:175], v[80:83]
  v_mfma_f32_16x16x32_bf16 v[84:87], a[76:79], a[172:175], 0
  buffer_load_dwordx4 v9, s[12:15], s24 offen offset:3072 lds
  v_mfma_f32_16x16x32_bf16 v[84:87], a[72:75], a[168:171], v[84:87]
  ds_read_b64_tr_b16 a[144:145], v18 offset:32768
  ds_read_b64_tr_b16 a[146:147], v18 offset:34816
  v_mfma_f32_16x16x32_bf16 v[88:91], a[80:83], a[168:171], 0
  v_mfma_f32_16x16x32_bf16 v[88:91], a[84:87], a[172:175], v[88:91]
  v_mfma_f32_16x16x32_bf16 v[92:95], a[92:95], a[172:175], 0
  v_mfma_f32_16x16x32_bf16 v[92:95], a[88:91], a[168:171], v[92:95]
  s_waitcnt lgkmcnt(15)
  ds_read_b64_tr_b16 a[152:153], v19 offset:32768
  ds_read_b64_tr_b16 a[154:155], v19 offset:34816
  v_mfma_f32_16x16x32_bf16 v[96:99], a[32:35], a[176:179], 0
  s_add_u32 s24, s24, 262144
  s_cmp_eq_u32 s24, s27
  s_cselect_b32 s24, s28, s24
  s_sub_u32 s6, s6, 1
  s_cmp_eq_u32 s6, 0
  s_cselect_b64 s[12:13], s[64:65], s[12:13]
  v_mfma_f32_16x16x32_bf16 v[96:99], a[36:39], a[180:183], v[96:99]
  v_mfma_f32_16x16x32_bf16 v[100:103], a[44:47], a[180:183], 0
  v_mfma_f32_16x16x32_bf16 v[100:103], a[40:43], a[176:179], v[100:103]
  v_mfma_f32_16x16x32_bf16 v[104:107], a[48:51], a[176:179], 0
  v_mfma_f32_16x16x32_bf16 v[104:107], a[52:55], a[180:183], v[104:107]
  v_mfma_f32_16x16x32_bf16 v[108:111], a[60:63], a[180:183], 0
  v_mfma_f32_16x16x32_bf16 v[108:111], a[56:59], a[176:179], v[108:111]
  s_waitcnt vmcnt(17) lgkmcnt(0)
  s_barrier
  ds_read_b128 a[160:163], v10 offset:16384
  ds_read_b128 a[164:167], v11 offset:16384
  v_mfma_f32_16x16x32_bf16 v[112:115], a[64:67], a[176:179], 0
  s_add_u32 m0, s29, 0
  s_nop 0
  buffer_load_dwordx4 v2, s[8:11], s23 offen offset:0 lds
  v_mfma_f32_16x16x32_bf16 v[112:115], a[68:71], a[180:183], v[112:115]
  v_mfma_f32_16x16x32_bf16 v[116:119], a[76:79], a[180:183], 0
  v_mfma_f32_16x16x32_bf16 v[116:119], a[72:75], a[176:179], v[116:119]
  ds_read_b64_tr_b16 a[100:101], v12 offset:49152
  ds_read_b64_tr_b16 a[102:103], v12 offset:51200
  v_mfma_f32_16x16x32_bf16 v[120:123], a[80:83], a[176:179], 0
  v_mfma_f32_16x16x32_bf16 v[120:123], a[84:87], a[180:183], v[120:123]
  buffer_load_dwordx4 v3, s[8:11], s23 offen offset:1024 lds
  v_mfma_f32_16x16x32_bf16 v[124:127], a[92:95], a[180:183], 0
  v_mfma_f32_16x16x32_bf16 v[124:127], a[88:91], a[176:179], v[124:127]
  v_mfma_f32_16x16x32_bf16 v[128:131], a[32:35], a[184:187], 0
  v_mfma_f32_16x16x32_bf16 v[128:131], a[36:39], a[188:191], v[128:131]
  ds_read_b128 a[168:171], v10 offset:18432
  ds_read_b128 a[172:175], v11 offset:18432
  ds_read_b64_tr_b16 a[108:109], v13 offset:49152
  ds_read_b64_tr_b16 a[110:111], v13 offset:51200
  v_mfma_f32_16x16x32_bf16 v[132:135], a[44:47], a[188:191], 0
  v_mfma_f32_16x16x32_bf16 v[132:135], a[40:43], a[184:187], v[132:135]
  buffer_load_dwordx4 v4, s[8:11], s23 offen offset:2048 lds
  v_mfma_f32_16x16x32_bf16 v[136:139], a[48:51], a[184:187], 0
  v_mfma_f32_16x16x32_bf16 v[136:139], a[52:55], a[188:191], v[136:139]
  v_mfma_f32_16x16x32_bf16 v[140:143], a[60:63], a[188:191], 0
  v_mfma_f32_16x16x32_bf16 v[140:143], a[56:59], a[184:187], v[140:143]
  ds_read_b64_tr_b16 a[116:117], v14 offset:49152
  ds_read_b64_tr_b16 a[118:119], v14 offset:51200
  v_mfma_f32_16x16x32_bf16 v[144:147], a[64:67], a[184:187], 0
  v_mfma_f32_16x16x32_bf16 v[144:147], a[68:71], a[188:191], v[144:147]
  buffer_load_dwordx4 v5, s[8:11], s23 offen offset:3072 lds
  v_mfma_f32_16x16x32_bf16 v[148:151], a[76:79], a[188:191], 0
  v_mfma_f32_16x16x32_bf16 v[148:151], a[72:75], a[184:187], v[148:151]
  v_mfma_f32_16x16x32_bf16 v[152:155], a[80:83], a[184:187], 0
  v_mfma_f32_16x16x32_bf16 v[152:155], a[84:87], a[188:191], v[152:155]
  ds_read_b64_tr_b16 a[124:125], v15 offset:49152
  ds_read_b64_tr_b16 a[126:127], v15 offset:51200
  v_mfma_f32_16x16x32_bf16 v[156:159], a[92:95], a[188:191], 0
  s_add_u32 m0, s29, 98304
  s_nop 0
  buffer_load_dwordx4 v6, s[12:15], s24 offen offset:0 lds
  v_mfma_f32_16x16x32_bf16 v[156:159], a[88:91], a[184:187], v[156:159]
  s_waitcnt lgkmcnt(10)
  v_mfma_f32_16x16x32_bf16 v[160:163], a[32:35], a[160:163], 0
  v_mfma_f32_16x16x32_bf16 v[160:163], a[36:39], a[164:167], v[160:163]
  ds_read_b128 a[176:179], v10 offset:20480
  ds_read_b128 a[180:183], v11 offset:20480
  v_mfma_f32_16x16x32_bf16 v[164:167], a[44:47], a[164:167], 0
  v_mfma_f32_16x16x32_bf16 v[164:167], a[40:43], a[160:163], v[164:167]
  ds_read_b64_tr_b16 a[132:133], v16 offset:49152
  ds_read_b64_tr_b16 a[134:135], v16 offset:51200
  v_mfma_f32_16x16x32_bf16 v[168:171], a[48:51], a[160:163], 0
  v_mfma_f32_16x16x32_bf16 v[168:171], a[52:55], a[164:167], v[168:171]
  buffer_load_dwordx4 v7, s[12:15], s24 offen offset:1024 lds
  v_mfma_f32_16x16x32_bf16 v[172:175], a[60:63], a[164:167], 0
  v_mfma_f32_16x16x32_bf16 v[172:175], a[56:59], a[160:163], v[172:175]
  v_mfma_f32_16x16x32_bf16 v[176:179], a[64:67], a[160:163], 0
  v_mfma_f32_16x16x32_bf16 v[176:179], a[68:71], a[164:167], v[176:179]
  ds_read_b64_tr_b16 a[140:141], v17 offset:49152
  ds_read_b64_tr_b16 a[142:143], v17 offset:51200
  v_mfma_f32_16x16x32_bf16 v[180:183], a[76:79], a[164:167], 0
  v_mfma_f32_16x16x32_bf16 v[180:183], a[72:75], a[160:163], v[180:183]
  buffer_load_dwordx4 v8, s[12:15], s24 offen offset:2048 lds
  v_mfma_f32_16x16x32_bf16 v[184:187], a[80:83], a[160:163], 0
  v_mfma_f32_16x16x32_bf16 v[184:187], a[84:87], a[164:167], v[184:187]
  v_mfma_f32_16x16x32_bf16 v[188:191], a[92:95], a[164:167], 0
  v_mfma_f32_16x16x32_bf16 v[188:191], a[88:91], a[160:163], v[188:191]
  s_waitcnt lgkmcnt(12)
  ds_read_b64_tr_b16 a[148:149], v18 offset:49152
  ds_read_b64_tr_b16 a[150:151], v18 offset:51200
  v_mfma_f32_16x16x32_bf16 v[192:195], a[32:35], a[168:171], 0
  buffer_load_dwordx4 v9, s[12:15], s24 offen offset:3072 lds
  v_mfma_f32_16x16x32_bf16 v[192:195], a[36:39], a[172:175], v[192:195]
  ds_read_b128 a[184:187], v10 offset:22528
  ds_read_b128 a[188:191], v11 offset:22528
  v_mfma_f32_16x16x32_bf16 v[196:199], a[44:47], a[172:175], 0
  v_mfma_f32_16x16x32_bf16 v[196:199], a[40:43], a[168:171], v[196:199]
  v_mfma_f32_16x16x32_bf16 v[200:203], a[48:51], a[168:171], 0
  v_mfma_f32_16x16x32_bf16 v[200:203], a[52:55], a[172:175], v[200:203]
  ds_read_b64_tr_b16 a[156:157], v19 offset:49152
  ds_read_b64_tr_b16 a[158:159], v19 offset:51200
  v_mfma_f32_16x16x32_bf16 v[204:207], a[60:63], a[172:175], 0
  s_add_u32 s24, s24, 262144
  v_mfma_f32_16x16x32_bf16 v[204:207], a[56:59], a[168:171], v[204:207]
  v_mfma_f32_16x16x32_bf16 v[208:211], a[64:67], a[168:171], 0
  v_mfma_f32_16x16x32_bf16 v[208:211], a[68:71], a[172:175], v[208:211]
  v_mfma_f32_16x16x32_bf16 v[212:215], a[76:79], a[172:175], 0
  v_mfma_f32_16x16x32_bf16 v[212:215], a[72:75], a[168:171], v[212:215]
  buffer_load_dword v21, v20, s[60:63], s54 offen
  s_add_u32 s54, s54, s55
  v_mfma_f32_16x16x32_bf16 v[216:219], a[80:83], a[168:171], 0
  v_mfma_f32_16x16x32_bf16 v[216:219], a[84:87], a[172:175], v[216:219]
  v_mfma_f32_16x16x32_bf16 v[220:223], a[92:95], a[172:175], 0
  v_mfma_f32_16x16x32_bf16 v[220:223], a[88:91], a[168:171], v[220:223]
  s_waitcnt lgkmcnt(10)
  v_mfma_f32_16x16x32_bf16 v[224:227], a[32:35], a[176:179], 0
  s_cmp_eq_u32 s54, s56
  s_cselect_b32 s54, s57, s54
  s_cselect_b64 s[60:61], s[58:59], s[60:61]
  s_cselect_b32 s62, s7, s62
  v_mfma_f32_16x16x32_bf16 v[224:227], a[36:39], a[180:183], v[224:227]
  v_mfma_f32_16x16x32_bf16 v[228:231], a[44:47], a[180:183], 0
  v_mfma_f32_16x16x32_bf16 v[228:231], a[40:43], a[176:179], v[228:231]
  v_mfma_f32_16x16x32_bf16 v[232:235], a[48:51], a[176:179], 0
  v_mfma_f32_16x16x32_bf16 v[232:235], a[52:55], a[180:183], v[232:235]
  v_mfma_f32_16x16x32_bf16 v[236:239], a[60:63], a[180:183], 0
  v_mfma_f32_16x16x32_bf16 v[236:239], a[56:59], a[176:179], v[236:239]
  s_waitcnt vmcnt(17) lgkmcnt(0)
  s_barrier
  ds_read_b128 a[160:163], v10 offset:32768
  ds_read_b128 a[164:167], v11 offset:32768
  v_mfma_f32_16x16x32_bf16 v[240:243], a[64:67], a[176:179], 0
  s_add_u32 m0, s29, 16384
  s_add_u32 s3, s23, s31
  buffer_load_dwordx4 v2, s[8:11], s3 offen offset:0 lds
  v_mfma_f32_16x16x32_bf16 v[240:243], a[68:71], a[180:183], v[240:243]
  v_mfma_f32_16x16x32_bf16 v[244:247], a[76:79], a[180:183], 0
  v_mfma_f32_16x16x32_bf16 v[244:247], a[72:75], a[176:179], v[244:247]
  v_mfma_f32_16x16x32_bf16 v[248:251], a[80:83], a[176:179], 0
  v_mfma_f32_16x16x32_bf16 v[248:251], a[84:87], a[180:183], v[248:251]
  buffer_load_dwordx4 v3, s[8:11], s3 offen offset:1024 lds
  v_mfma_f32_16x16x32_bf16 v[252:255], a[92:95], a[180:183], 0
  v_mfma_f32_16x16x32_bf16 v[252:255], a[88:91], a[176:179], v[252:255]
  v_mfma_f32_16x16x32_bf16 a[0:3], a[32:35], a[184:187], 0
  v_mfma_f32_16x16x32_bf16 a[0:3], a[36:39], a[188:191], a[0:3]
  ds_read_b128 a[168:171], v10 offset:34816
  ds_read_b128 a[172:175], v11 offset:34816
  v_mfma_f32_16x16x32_bf16 a[4:7], a[44:47], a[188:191], 0
  v_mfma_f32_16x16x32_bf16 a[4:7], a[40:43], a[184:187], a[4:7]
  v_mfma_f32_16x16x32_bf16 a[8:11], a[48:51], a[184:187], 0
  buffer_load_dwordx4 v4, s[8:11], s3 offen offset:2048 lds
  v_mfma_f32_16x16x32_bf16 a[8:11], a[52:55], a[188:191], a[8:11]
  v_mfma_f32_16x16x32_bf16 a[12:15], a[60:63], a[188:191], 0
  v_mfma_f32_16x16x32_bf16 a[12:15], a[56:59], a[184:187], a[12:15]
  v_mfma_f32_16x16x32_bf16 a[16:19], a[64:67], a[184:187], 0
  v_mfma_f32_16x16x32_bf16 a[16:19], a[68:71], a[188:191], a[16:19]
  buffer_load_dwordx4 v5, s[8:11], s3 offen offset:3072 lds
  v_mfma_f32_16x16x32_bf16 a[20:23], a[76:79], a[188:191], 0
  v_mfma_f32_16x16x32_bf16 a[20:23], a[72:75], a[184:187], a[20:23]
  v_mfma_f32_16x16x32_bf16 a[24:27], a[80:83], a[184:187], 0
  v_mfma_f32_16x16x32_bf16 a[24:27], a[84:87], a[188:191], a[24:27]
  v_mfma_f32_16x16x32_bf16 a[28:31], a[92:95], a[188:191], 0
  v_mfma_f32_16x16x32_bf16 a[28:31], a[88:91], a[184:187], a[28:31]
  s_waitcnt lgkmcnt(2)
  v_mfma_f32_16x16x32_bf16 v[32:35], a[96:99], a[160:163], v[32:35]
  s_add_u32 s23, s23, 128
  s_cmp_eq_u32 s23, s25
  s_cselect_b32 s23, s26, s23
  v_mfma_f32_16x16x32_bf16 v[32:35], a[100:103], a[164:167], v[32:35]
  ds_read_b128 a[176:179], v10 offset:36864
  ds_read_b128 a[180:183], v11 offset:36864
  v_mfma_f32_16x16x32_bf16 v[36:39], a[108:111], a[164:167], v[36:39]
  v_mfma_f32_16x16x32_bf16 v[36:39], a[104:107], a[160:163], v[36:39]
  ds_read_b64_tr_b16 a[32:33], v12 offset:0
  ds_read_b64_tr_b16 a[34:35], v12 offset:2048
  v_mfma_f32_16x16x32_bf16 v[40:43], a[112:115], a[160:163], v[40:43]
  v_mfma_f32_16x16x32_bf16 v[40:43], a[116:119], a[164:167], v[40:43]
  v_mfma_f32_16x16x32_bf16 v[44:47], a[124:127], a[164:167], v[44:47]
  s_add_u32 m0, s29, 114688
  s_nop 0
  buffer_load_dwordx4 v6, s[12:15], s24 offen offset:0 lds
  v_mfma_f32_16x16x32_bf16 v[44:47], a[120:123], a[160:163], v[44:47]
  ds_read_b64_tr_b16 a[40:41], v13 offset:0
  ds_read_b64_tr_b16 a[42:43], v13 offset:2048
  v_mfma_f32_16x16x32_bf16 v[48:51], a[128:131], a[160:163], v[48:51]
  v_mfma_f32_16x16x32_bf16 v[48:51], a[132:135], a[164:167], v[48:51]
  v_mfma_f32_16x16x32_bf16 v[52:55], a[140:143], a[164:167], v[52:55]
  v_mfma_f32_16x16x32_bf16 v[52:55], a[136:139], a[160:163], v[52:55]
  ds_read_b64_tr_b16 a[48:49], v14 offset:0
  ds_read_b64_tr_b16 a[50:51], v14 offset:2048
  v_mfma_f32_16x16x32_bf16 v[56:59], a[144:147], a[160:163], v[56:59]
  v_mfma_f32_16x16x32_bf16 v[56:59], a[148:151], a[164:167], v[56:59]
  buffer_load_dwordx4 v7, s[12:15], s24 offen offset:1024 lds
  v_mfma_f32_16x16x32_bf16 v[60:63], a[156:159], a[164:167], v[60:63]
  v_mfma_f32_16x16x32_bf16 v[60:63], a[152:155], a[160:163], v[60:63]
  s_waitcnt lgkmcnt(8)
  ds_read_b64_tr_b16 a[56:57], v15 offset:0
  ds_read_b64_tr_b16 a[58:59], v15 offset:2048
  v_mfma_f32_16x16x32_bf16 v[64:67], a[96:99], a[168:171], v[64:67]
  v_mfma_f32_16x16x32_bf16 v[64:67], a[100:103], a[172:175], v[64:67]
  ds_read_b128 a[184:187], v10 offset:38912
  ds_read_b128 a[188:191], v11 offset:38912
  v_mfma_f32_16x16x32_bf16 v[68:71], a[108:111], a[172:175], v[68:71]
  v_mfma_f32_16x16x32_bf16 v[68:71], a[104:107], a[168:171], v[68:71]
  ds_read_b64_tr_b16 a[64:65], v16 offset:0
  ds_read_b64_tr_b16 a[66:67], v16 offset:2048
  v_mfma_f32_16x16x32_bf16 v[72:75], a[112:115], a[168:171], v[72:75]
  buffer_load_dwordx4 v8, s[12:15], s24 offen offset:2048 lds
  v_mfma_f32_16x16x32_bf16 v[72:75], a[116:119], a[172:175], v[72:75]
  v_mfma_f32_16x16x32_bf16 v[76:79], a[124:127], a[172:175], v[76:79]
  v_mfma_f32_16x16x32_bf16 v[76:79], a[120:123], a[168:171], v[76:79]
  ds_read_b64_tr_b16 a[72:73], v17 offset:0
  ds_read_b64_tr_b16 a[74:75], v17 offset:2048
  v_mfma_f32_16x16x32_bf16 v[80:83], a[128:131], a[168:171], v[80:83]
  v_mfma_f32_16x16x32_bf16 v[80:83], a[132:135], a[172:175], v[80:83]
  v_mfma_f32_16x16x32_bf16 v[84:87], a[140:143], a[172:175], v[84:87]
  buffer_load_dwordx4 v9, s[12:15], s24 offen offset:3072 lds
  v_mfma_f32_16x16x32_bf16 v[84:87], a[136:139], a[168:171], v[84:87]
  ds_read_b64_tr_b16 a[80:81], v18 offset:0
  ds_read_b64_tr_b16 a[82:83], v18 offset:2048
  v_mfma_f32_16x16x32_bf16 v[88:91], a[144:147], a[168:171], v[88:91]
  v_mfma_f32_16x16x32_bf16 v[88:91], a[148:151], a[172:175], v[88:91]
  v_mfma_f32_16x16x32_bf16 v[92:95], a[156:159], a[172:175], v[92:95]
  v_mfma_f32_16x16x32_bf16 v[92:95], a[152:155], a[168:171], v[92:95]
  s_waitcnt lgkmcnt(15)
  ds_read_b64_tr_b16 a[88:89], v19 offset:0
  ds_read_b64_tr_b16 a[90:91], v19 offset:2048
  v_mfma_f32_16x16x32_bf16 v[96:99], a[96:99], a[176:179], v[96:99]
  s_add_u32 s24, s24, 262144
  s_cmp_eq_u32 s24, s27
  s_cselect_b32 s24, s28, s24
  s_sub_u32 s6, s6, 1
  s_cmp_eq_u32 s6, 0
  s_cselect_b64 s[12:13], s[64:65], s[12:13]
  v_mfma_f32_16x16x32_bf16 v[96:99], a[100:103], a[180:183], v[96:99]
  v_mfma_f32_16x16x32_bf16 v[100:103], a[108:111], a[180:183], v[100:103]
  v_mfma_f32_16x16x32_bf16 v[100:103], a[104:107], a[176:179], v[100:103]
  v_mfma_f32_16x16x32_bf16 v[104:107], a[112:115], a[176:179], v[104:107]
  v_mfma_f32_16x16x32_bf16 v[104:107], a[116:119], a[180:183], v[104:107]
  v_mfma_f32_16x16x32_bf16 v[108:111], a[124:127], a[180:183], v[108:111]
  v_mfma_f32_16x16x32_bf16 v[108:111], a[120:123], a[176:179], v[108:111]
  s_waitcnt vmcnt(17) lgkmcnt(0)
  s_barrier
  ds_read_b128 a[160:163], v10 offset:49152
  ds_read_b128 a[164:167], v11 offset:49152
  v_mfma_f32_16x16x32_bf16 v[112:115], a[128:131], a[176:179], v[112:115]
  s_add_u32 m0, s29, 32768
  s_nop 0
  buffer_load_dwordx4 v2, s[8:11], s23 offen offset:0 lds
  v_mfma_f32_16x16x32_bf16 v[112:115], a[132:135], a[180:183], v[112:115]
  v_mfma_f32_16x16x32_bf16 v[116:119], a[140:143], a[180:183], v[116:119]
  v_mfma_f32_16x16x32_bf16 v[116:119], a[136:139], a[176:179], v[116:119]
  ds_read_b64_tr_b16 a[36:37], v12 offset:16384
  ds_read_b64_tr_b16 a[38:39], v12 offset:18432
  v_mfma_f32_16x16x32_bf16 v[120:123], a[144:147], a[176:179], v[120:123]
  v_mfma_f32_16x16x32_bf16 v[120:123], a[148:151], a[180:183], v[120:123]
  buffer_load_dwordx4 v3, s[8:11], s23 offen offset:1024 lds
  v_mfma_f32_16x16x32_bf16 v[124:127], a[156:159], a[180:183], v[124:127]
  v_mfma_f32_16x16x32_bf16 v[124:127], a[152:155], a[176:179], v[124:127]
  v_mfma_f32_16x16x32_bf16 v[128:131], a[96:99], a[184:187], v[128:131]
  v_mfma_f32_16x16x32_bf16 v[128:131], a[100:103], a[188:191], v[128:131]
  ds_read_b128 a[168:171], v10 offset:51200
  ds_read_b128 a[172:175], v11 offset:51200
  ds_read_b64_tr_b16 a[44:45], v13 offset:16384
  ds_read_b64_tr_b16 a[46:47], v13 offset:18432
  v_mfma_f32_16x16x32_bf16 v[132:135], a[108:111], a[188:191], v[132:135]
  v_mfma_f32_16x16x32_bf16 v[132:135], a[104:107], a[184:187], v[132:135]
  buffer_load_dwordx4 v4, s[8:11], s23 offen offset:2048 lds
  v_mfma_f32_16x16x32_bf16 v[136:139], a[112:115], a[184:187], v[136:139]
  v_mfma_f32_16x16x32_bf16 v[136:139], a[116:119], a[188:191], v[136:139]
  v_mfma_f32_16x16x32_bf16 v[140:143], a[124:127], a[188:191], v[140:143]
  v_mfma_f32_16x16x32_bf16 v[140:143], a[120:123], a[184:187], v[140:143]
  ds_read_b64_tr_b16 a[52:53], v14 offset:16384
  ds_read_b64_tr_b16 a[54:55], v14 offset:18432
  v_mfma_f32_16x16x32_bf16 v[144:147], a[128:131], a[184:187], v[144:147]
  v_mfma_f32_16x16x32_bf16 v[144:147], a[132:135], a[188:191], v[144:147]
  buffer_load_dwordx4 v5, s[8:11], s23 offen offset:3072 lds
  v_mfma_f32_16x16x32_bf16 v[148:151], a[140:143], a[188:191], v[148:151]
  v_mfma_f32_16x16x32_bf16 v[148:151], a[136:139], a[184:187], v[148:151]
  v_mfma_f32_16x16x32_bf16 v[152:155], a[144:147], a[184:187], v[152:155]
  v_mfma_f32_16x16x32_bf16 v[152:155], a[148:151], a[188:191], v[152:155]
  ds_read_b64_tr_b16 a[60:61], v15 offset:16384
  ds_read_b64_tr_b16 a[62:63], v15 offset:18432
  v_mfma_f32_16x16x32_bf16 v[156:159], a[156:159], a[188:191], v[156:159]
  s_add_u32 m0, s29, 65536
  s_nop 0
  buffer_load_dwordx4 v6, s[12:15], s24 offen offset:0 lds
  v_mfma_f32_16x16x32_bf16 v[156:159], a[152:155], a[184:187], v[156:159]
  s_waitcnt lgkmcnt(10)
  v_mfma_f32_16x16x32_bf16 v[160:163], a[96:99], a[160:163], v[160:163]
  v_mfma_f32_16x16x32_bf16 v[160:163], a[100:103], a[164:167], v[160:163]
  ds_read_b128 a[176:179], v10 offset:53248
  ds_read_b128 a[180:183], v11 offset:53248
  v_mfma_f32_16x16x32_bf16 v[164:167], a[108:111], a[164:167], v[164:167]
  v_mfma_f32_16x16x32_bf16 v[164:167], a[104:107], a[160:163], v[164:167]
  ds_read_b64_tr_b16 a[68:69], v16 offset:16384
  ds_read_b64_tr_b16 a[70:71], v16 offset:18432
  v_mfma_f32_16x16x32_bf16 v[168:171], a[112:115], a[160:163], v[168:171]
  v_mfma_f32_16x16x32_bf16 v[168:171], a[116:119], a[164:167], v[168:171]
  buffer_load_dwordx4 v7, s[12:15], s24 offen offset:1024 lds
  v_mfma_f32_16x16x32_bf16 v[172:175], a[124:127], a[164:167], v[172:175]
  v_mfma_f32_16x16x32_bf16 v[172:175], a[120:123], a[160:163], v[172:175]
  v_mfma_f32_16x16x32_bf16 v[176:179], a[128:131], a[160:163], v[176:179]
  v_mfma_f32_16x16x32_bf16 v[176:179], a[132:135], a[164:167], v[176:179]
  ds_read_b64_tr_b16 a[76:77], v17 offset:16384
  ds_read_b64_tr_b16 a[78:79], v17 offset:18432
  v_mfma_f32_16x16x32_bf16 v[180:183], a[140:143], a[164:167], v[180:183]
  v_mfma_f32_16x16x32_bf16 v[180:183], a[136:139], a[160:163], v[180:183]
  buffer_load_dwordx4 v8, s[12:15], s24 offen offset:2048 lds
  v_mfma_f32_16x16x32_bf16 v[184:187], a[144:147], a[160:163], v[184:187]
  v_mfma_f32_16x16x32_bf16 v[184:187], a[148:151], a[164:167], v[184:187]
  v_mfma_f32_16x16x32_bf16 v[188:191], a[156:159], a[164:167], v[188:191]
  v_mfma_f32_16x16x32_bf16 v[188:191], a[152:155], a[160:163], v[188:191]
  s_waitcnt lgkmcnt(12)
  ds_read_b64_tr_b16 a[84:85], v18 offset:16384
  ds_read_b64_tr_b16 a[86:87], v18 offset:18432
  v_mfma_f32_16x16x32_bf16 v[192:195], a[96:99], a[168:171], v[192:195]
  buffer_load_dwordx4 v9, s[12:15], s24 offen offset:3072 lds
  v_mfma_f32_16x16x32_bf16 v[192:195], a[100:103], a[172:175], v[192:195]
  ds_read_b128 a[184:187], v10 offset:55296
  ds_read_b128 a[188:191], v11 offset:55296
  v_mfma_f32_16x16x32_bf16 v[196:199], a[108:111], a[172:175], v[196:199]
  v_mfma_f32_16x16x32_bf16 v[196:199], a[104:107], a[168:171], v[196:199]
  v_mfma_f32_16x16x32_bf16 v[200:203], a[112:115], a[168:171], v[200:203]
  v_mfma_f32_16x16x32_bf16 v[200:203], a[116:119], a[172:175], v[200:203]
  ds_read_b64_tr_b16 a[92:93], v19 offset:16384
  ds_read_b64_tr_b16 a[94:95], v19 offset:18432
  v_mfma_f32_16x16x32_bf16 v[204:207], a[124:127], a[172:175], v[204:207]
  s_add_u32 s24, s24, 262144
  v_mfma_f32_16x16x32_bf16 v[204:207], a[120:123], a[168:171], v[204:207]
  v_mfma_f32_16x16x32_bf16 v[208:211], a[128:131], a[168:171], v[208:211]
  v_mfma_f32_16x16x32_bf16 v[208:211], a[132:135], a[172:175], v[208:211]
  v_mfma_f32_16x16x32_bf16 v[212:215], a[140:143], a[172:175], v[212:215]
  v_mfma_f32_16x16x32_bf16 v[212:215], a[136:139], a[168:171], v[212:215]
  buffer_load_dword v21, v20, s[60:63], s54 offen
  s_add_u32 s54, s54, s55
  v_mfma_f32_16x16x32_bf16 v[216:219], a[144:147], a[168:171], v[216:219]
  v_mfma_f32_16x16x32_bf16 v[216:219], a[148:151], a[172:175], v[216:219]
  v_mfma_f32_16x16x32_bf16 v[220:223], a[156:159], a[172:175], v[220:223]
  v_mfma_f32_16x16x32_bf16 v[220:223], a[152:155], a[168:171], v[220:223]
  s_waitcnt lgkmcnt(10)
  v_mfma_f32_16x16x32_bf16 v[224:227], a[96:99], a[176:179], v[224:227]
  s_cmp_eq_u32 s54, s56
  s_cselect_b32 s54, s57, s54
  s_cselect_b64 s[60:61], s[58:59], s[60:61]
  s_cselect_b32 s62, s7, s62
  v_mfma_f32_16x16x32_bf16 v[224:227], a[100:103], a[180:183], v[224:227]
  v_mfma_f32_16x16x32_bf16 v[228:231], a[108:111], a[180:183], v[228:231]
  v_mfma_f32_16x16x32_bf16 v[228:231], a[104:107], a[176:179], v[228:231]
  v_mfma_f32_16x16x32_bf16 v[232:235], a[112:115], a[176:179], v[232:235]
  v_mfma_f32_16x16x32_bf16 v[232:235], a[116:119], a[180:183], v[232:235]
  v_mfma_f32_16x16x32_bf16 v[236:239], a[124:127], a[180:183], v[236:239]
  v_mfma_f32_16x16x32_bf16 v[236:239], a[120:123], a[176:179], v[236:239]
  s_waitcnt vmcnt(18) lgkmcnt(0)
  s_barrier
  ds_read_b128 a[160:163], v10 offset:0
  ds_read_b128 a[164:167], v11 offset:0
  v_mfma_f32_16x16x32_bf16 v[240:243], a[128:131], a[176:179], v[240:243]
  s_add_u32 m0, s29, 49152
  s_add_u32 s3, s23, s31
  buffer_load_dwordx4 v2, s[8:11], s3 offen offset:0 lds
  v_mfma_f32_16x16x32_bf16 v[240:243], a[132:135], a[180:183], v[240:243]
  v_mfma_f32_16x16x32_bf16 v[244:247], a[140:143], a[180:183], v[244:247]
  v_mfma_f32_16x16x32_bf16 v[244:247], a[136:139], a[176:179], v[244:247]
  v_mfma_f32_16x16x32_bf16 v[248:251], a[144:147], a[176:179], v[248:251]
  v_mfma_f32_16x16x32_bf16 v[248:251], a[148:151], a[180:183], v[248:251]
  buffer_load_dwordx4 v3, s[8:11], s3 offen offset:1024 lds
  v_mfma_f32_16x16x32_bf16 v[252:255], a[156:159], a[180:183], v[252:255]
  v_mfma_f32_16x16x32_bf16 v[252:255], a[152:155], a[176:179], v[252:255]
  v_mfma_f32_16x16x32_bf16 a[0:3], a[96:99], a[184:187], a[0:3]
  v_mfma_f32_16x16x32_bf16 a[0:3], a[100:103], a[188:191], a[0:3]
  ds_read_b128 a[168:171], v10 offset:2048
  ds_read_b128 a[172:175], v11 offset:2048
  v_mfma_f32_16x16x32_bf16 a[4:7], a[108:111], a[188:191], a[4:7]
  v_mfma_f32_16x16x32_bf16 a[4:7], a[104:107], a[184:187], a[4:7]
  v_mfma_f32_16x16x32_bf16 a[8:11], a[112:115], a[184:187], a[8:11]
  buffer_load_dwordx4 v4, s[8:11], s3 offen offset:2048 lds
  v_mfma_f32_16x16x32_bf16 a[8:11], a[116:119], a[188:191], a[8:11]
  v_mfma_f32_16x16x32_bf16 a[12:15], a[124:127], a[188:191], a[12:15]
  v_mfma_f32_16x16x32_bf16 a[12:15], a[120:123], a[184:187], a[12:15]
  v_mfma_f32_16x16x32_bf16 a[16:19], a[128:131], a[184:187], a[16:19]
  v_mfma_f32_16x16x32_bf16 a[16:19], a[132:135], a[188:191], a[16:19]
  buffer_load_dwordx4 v5, s[8:11], s3 offen offset:3072 lds
  v_mfma_f32_16x16x32_bf16 a[20:23], a[140:143], a[188:191], a[20:23]
  v_mfma_f32_16x16x32_bf16 a[20:23], a[136:139], a[184:187], a[20:23]
  v_mfma_f32_16x16x32_bf16 a[24:27], a[144:147], a[184:187], a[24:27]
  v_mfma_f32_16x16x32_bf16 a[24:27], a[148:151], a[188:191], a[24:27]
  v_mfma_f32_16x16x32_bf16 a[28:31], a[156:159], a[188:191], a[28:31]
  v_mfma_f32_16x16x32_bf16 a[28:31], a[152:155], a[184:187], a[28:31]
  s_waitcnt lgkmcnt(2)
  s_mov_b32 s30, 5
Lk1_ql:
  v_mfma_f32_16x16x32_bf16 v[32:35], a[32:35], a[160:163], v[32:35]
  s_add_u32 s23, s23, 128
  s_cmp_eq_u32 s23, s25
  s_cselect_b32 s23, s26, s23
  v_mfma_f32_16x16x32_bf16 v[32:35], a[36:39], a[164:167], v[32:35]
  ds_read_b128 a[176:179], v10 offset:4096
  ds_read_b128 a[180:183], v11 offset:4096
  v_mfma_f32_16x16x32_bf16 v[36:39], a[44:47], a[164:167], v[36:39]
  v_mfma_f32_16x16x32_bf16 v[36:39], a[40:43], a[160:163], v[36:39]
  ds_read_b64_tr_b16 a[96:97], v12 offset:32768
  ds_read_b64_tr_b16 a[98:99], v12 offset:34816
  v_mfma_f32_16x16x32_bf16 v[40:43], a[48:51], a[160:163], v[40:43]
  v_mfma_f32_16x16x32_bf16 v[40:43], a[52:55], a[164:167], v[40:43]
  v_mfma_f32_16x16x32_bf16 v[44:47], a[60:63], a[164:167], v[44:47]
  s_add_u32 m0, s29, 81920
  s_nop 0
  buffer_load_dwordx4 v6, s[12:15], s24 offen offset:0 lds
  v_mfma_f32_16x16x32_bf16 v[44:47], a[56:59], a[160:163], v[44:47]
  ds_read_b64_tr_b16 a[104:105], v13 offset:32768
  ds_read_b64_tr_b16 a[106:107], v13 offset:34816
  v_mfma_f32_16x16x32_bf16 v[48:51], a[64:67], a[160:163], v[48:51]
  v_mfma_f32_16x16x32_bf16 v[48:51], a[68:71], a[164:167], v[48:51]
  v_mfma_f32_16x16x32_bf16 v[52:55], a[76:79], a[164:167], v[52:55]
  v_mfma_f32_16x16x32_bf16 v[52:55], a[72:75], a[160:163], v[52:55]
  ds_read_b64_tr_b16 a[112:113], v14 offset:32768
  ds_read_b64_tr_b16 a[114:115], v14 offset:34816
  v_mfma_f32_16x16x32_bf16 v[56:59], a[80:83], a[160:163], v[56:59]
  v_mfma_f32_16x16x32_bf16 v[56:59], a[84:87], a[164:167], v[56:59]
  buffer_load_dwordx4 v7, s[12:15], s24 offen offset:1024 lds
  v_mfma_f32_16x16x32_bf16 v[60:63], a[92:95], a[164:167], v[60:63]
  v_mfma_f32_16x16x32_bf16 v[60:63], a[88:91], a[160:163], v[60:63]
  s_waitcnt lgkmcnt(8)
  ds_read_b64_tr_b16 a[120:121], v15 offset:32768
  ds_read_b64_tr_b16 a[122:123], v15 offset:34816
  v_mfma_f32_16x16x32_bf16 v[64:67], a[32:35], a[168:171], v[64:67]
  v_mfma_f32_16x16x32_bf16 v[64:67], a[36:39], a[172:175], v[64:67]
  ds_read_b128 a[184:187], v10 offset:6144
  ds_read_b128 a[188:191], v11 offset:6144
  v_mfma_f32_16x16x32_bf16 v[68:71], a[44:47], a[172:175], v[68:71]
  v_mfma_f32_16x16x32_bf16 v[68:71], a[40:43], a[168:171], v[68:71]
  ds_read_b64_tr_b16 a[128:129], v16 offset:32768
  ds_read_b64_tr_b16 a[130:131], v16 offset:34816
  v_mfma_f32_16x16x32_bf16 v[72:75], a[48:51], a[168:171], v[72:75]
  buffer_load_dwordx4 v8, s[12:15], s24 offen offset:2048 lds
  v_mfma_f32_16x16x32_bf16 v[72:75], a[52:55], a[172:175], v[72:75]
  v_mfma_f32_16x16x32_bf16 v[76:79], a[60:63], a[172:175], v[76:79]
  v_mfma_f32_16x16x32_bf16 v[76:79], a[56:59], a[168:171], v[76:79]
  ds_read_b64_tr_b16 a[136:137], v17 offset:32768
  ds_read_b64_tr_b16 a[138:139], v17 offset:34816
  v_mfma_f32_16x16x32_bf16 v[80:83], a[64:67], a[168:171], v[80:83]
  v_mfma_f32_16x16x32_bf16 v[80:83], a[68:71], a[172:175], v[80:83]
  v_mfma_f32_16x16x32_bf16 v[84:87], a[76:79], a[172:175], v[84:87]
  buffer_load_dwordx4 v9, s[12:15], s24 offen offset:3072 lds
  v_mfma_f32_16x16x32_bf16 v[84:87], a[72:75], a[168:171], v[84:87]
  ds_read_b64_tr_b16 a[144:145], v18 offset:32768
  ds_read_b64_tr_b16 a[146:147], v18 offset:34816
  v_mfma_f32_16x16x32_bf16 v[88:91], a[80:83], a[168:171], v[88:91]
  v_mfma_f32_16x16x32_bf16 v[88:91], a[84:87], a[172:175], v[88:91]
  v_mfma_f32_16x16x32_bf16 v[92:95], a[92:95], a[172:175], v[92:95]
  v_mfma_f32_16x16x32_bf16 v[92:95], a[88:91], a[168:171], v[92:95]
  s_waitcnt lgkmcnt(15)
  ds_read_b64_tr_b16 a[152:153], v19 offset:32768
  ds_read_b64_tr_b16 a[154:155], v19 offset:34816
  v_mfma_f32_16x16x32_bf16 v[96:99], a[32:35], a[176:179], v[96:99]
  s_add_u32 s24, s24, 262144
  s_cmp_eq_u32 s24, s27
  s_cselect_b32 s24, s28, s24
  s_sub_u32 s6, s6, 1
  s_cmp_eq_u32 s6, 0
  s_cselect_b64 s[12:13], s[64:65], s[12:13]
  v_mfma_f32_16x16x32_bf16 v[96:99], a[36:39], a[180:183], v[96:99]
  v_mfma_f32_16x16x32_bf16 v[100:103], a[44:47], a[180:183], v[100:103]
  v_mfma_f32_16x16x32_bf16 v[100:103], a[40:43], a[176:179], v[100:103]
  v_mfma_f32_16x16x32_bf16 v[104:107], a[48:51], a[176:179], v[104:107]
  v_mfma_f32_16x16x32_bf16 v[104:107], a[52:55], a[180:183], v[104:107]
  v_mfma_f32_16x16x32_bf16 v[108:111], a[60:63], a[180:183], v[108:111]
  v_mfma_f32_16x16x32_bf16 v[108:111], a[56:59], a[176:179], v[108:111]
  s_waitcnt vmcnt(17) lgkmcnt(0)
  s_barrier
  ds_read_b128 a[160:163], v10 offset:16384
  ds_read_b128 a[164:167], v11 offset:16384
  v_mfma_f32_16x16x32_bf16 v[112:115], a[64:67], a[176:179], v[112:115]
  s_add_u32 m0, s29, 0
  s_nop 0
  buffer_load_dwordx4 v2, s[8:11], s23 offen offset:0 lds
  v_mfma_f32_16x16x32_bf16 v[112:115], a[68:71], a[180:183], v[112:115]
  v_mfma_f32_16x16x32_bf16 v[116:119], a[76:79], a[180:183], v[116:119]
  v_mfma_f32_16x16x32_bf16 v[116:119], a[72:75], a[176:179], v[116:119]
  ds_read_b64_tr_b16 a[100:101], v12 offset:49152
  ds_read_b64_tr_b16 a[102:103], v12 offset:51200
  v_mfma_f32_16x16x32_bf16 v[120:123], a[80:83], a[176:179], v[120:123]
  v_mfma_f32_16x16x32_bf16 v[120:123], a[84:87], a[180:183], v[120:123]
  buffer_load_dwordx4 v3, s[8:11], s23 offen offset:1024 lds
  v_mfma_f32_16x16x32_bf16 v[124:127], a[92:95], a[180:183], v[124:127]
  v_mfma_f32_16x16x32_bf16 v[124:127], a[88:91], a[176:179], v[124:127]
  v_mfma_f32_16x16x32_bf16 v[128:131], a[32:35], a[184:187], v[128:131]
  v_mfma_f32_16x16x32_bf16 v[128:131], a[36:39], a[188:191], v[128:131]
  ds_read_b128 a[168:171], v10 offset:18432
  ds_read_b128 a[172:175], v11 offset:18432
  ds_read_b64_tr_b16 a[108:109], v13 offset:49152
  ds_read_b64_tr_b16 a[110:111], v13 offset:51200
  v_mfma_f32_16x16x32_bf16 v[132:135], a[44:47], a[188:191], v[132:135]
  v_mfma_f32_16x16x32_bf16 v[132:135], a[40:43], a[184:187], v[132:135]
  buffer_load_dwordx4 v4, s[8:11], s23 offen offset:2048 lds
  v_mfma_f32_16x16x32_bf16 v[136:139], a[48:51], a[184:187], v[136:139]
  v_mfma_f32_16x16x32_bf16 v[136:139], a[52:55], a[188:191], v[136:139]
  v_mfma_f32_16x16x32_bf16 v[140:143], a[60:63], a[188:191], v[140:143]
  v_mfma_f32_16x16x32_bf16 v[140:143], a[56:59], a[184:187], v[140:143]
  ds_read_b64_tr_b16 a[116:117], v14 offset:49152
  ds_read_b64_tr_b16 a[118:119], v14 offset:51200
  v_mfma_f32_16x16x32_bf16 v[144:147], a[64:67], a[184:187], v[144:147]
  v_mfma_f32_16x16x32_bf16 v[144:147], a[68:71], a[188:191], v[144:147]
  buffer_load_dwordx4 v5, s[8:11], s23 offen offset:3072 lds
  v_mfma_f32_16x16x32_bf16 v[148:151], a[76:79], a[188:191], v[148:151]
  v_mfma_f32_16x16x32_bf16 v[148:151], a[72:75], a[184:187], v[148:151]
  v_mfma_f32_16x16x32_bf16 v[152:155], a[80:83], a[184:187], v[152:155]
  v_mfma_f32_16x16x32_bf16 v[152:155], a[84:87], a[188:191], v[152:155]
  ds_read_b64_tr_b16 a[124:125], v15 offset:49152
  ds_read_b64_tr_b16 a[126:127], v15 offset:51200
  v_mfma_f32_16x16x32_bf16 v[156:159], a[92:95], a[188:191], v[156:159]
  s_add_u32 m0, s29, 98304
  s_nop 0
  buffer_load_dwordx4 v6, s[12:15], s24 offen offset:0 lds
  v_mfma_f32_16x16x32_bf16 v[156:159], a[88:91], a[184:187], v[156:159]
  s_waitcnt lgkmcnt(10)
  v_mfma_f32_16x16x32_bf16 v[160:163], a[32:35], a[160:163], v[160:163]
  v_mfma_f32_16x16x32_bf16 v[160:163], a[36:39], a[164:167], v[160:163]
  ds_read_b128 a[176:179], v10 offset:20480
  ds_read_b128 a[180:183], v11 offset:20480
  v_mfma_f32_16x16x32_bf16 v[164:167], a[44:47], a[164:167], v[164:167]
  v_mfma_f32_16x16x32_bf16 v[164:167], a[40:43], a[160:163], v[164:167]
  ds_read_b64_tr_b16 a[132:133], v16 offset:49152
  ds_read_b64_tr_b16 a[134:135], v16 offset:51200
  v_mfma_f32_16x16x32_bf16 v[168:171], a[48:51], a[160:163], v[168:171]
  v_mfma_f32_16x16x32_bf16 v[168:171], a[52:55], a[164:167], v[168:171]
  buffer_load_dwordx4 v7, s[12:15], s24 offen offset:1024 lds
  v_mfma_f32_16x16x32_bf16 v[172:175], a[60:63], a[164:167], v[172:175]
  v_mfma_f32_16x16x32_bf16 v[172:175], a[56:59], a[160:163], v[172:175]
  v_mfma_f32_16x16x32_bf16 v[176:179], a[64:67], a[160:163], v[176:179]
  v_mfma_f32_16x16x32_bf16 v[176:179], a[68:71], a[164:167], v[176:179]
  ds_read_b64_tr_b16 a[140:141], v17 offset:49152
  ds_read_b64_tr_b16 a[142:143], v17 offset:51200
  v_mfma_f32_16x16x32_bf16 v[180:183], a[76:79], a[164:167], v[180:183]
  v_mfma_f32_16x16x32_bf16 v[180:183], a[72:75], a[160:163], v[180:183]
  buffer_load_dwordx4 v8, s[12:15], s24 offen offset:2048 lds
  v_mfma_f32_16x16x32_bf16 v[184:187], a[80:83], a[160:163], v[184:187]
  v_mfma_f32_16x16x32_bf16 v[184:187], a[84:87], a[164:167], v[184:187]
  v_mfma_f32_16x16x32_bf16 v[188:191], a[92:95], a[164:167], v[188:191]
  v_mfma_f32_16x16x32_bf16 v[188:191], a[88:91], a[160:163], v[188:191]
  s_waitcnt lgkmcnt(12)
  ds_read_b64_tr_b16 a[148:149], v18 offset:49152
  ds_read_b64_tr_b16 a[150:151], v18 offset:51200
  v_mfma_f32_16x16x32_bf16 v[192:195], a[32:35], a[168:171], v[192:195]
  buffer_load_dwordx4 v9, s[12:15], s24 offen offset:3072 lds
  v_mfma_f32_16x16x32_bf16 v[192:195], a[36:39], a[172:175], v[192:195]
  ds_read_b128 a[184:187], v10 offset:22528
  ds_read_b128 a[188:191], v11 offset:22528
  v_mfma_f32_16x16x32_bf16 v[196:199], a[44:47], a[172:175], v[196:199]
  v_mfma_f32_16x16x32_bf16 v[196:199], a[40:43], a[168:171], v[196:199]
  v_mfma_f32_16x16x32_bf16 v[200:203], a[48:51], a[168:171], v[200:203]
  v_mfma_f32_16x16x32_bf16 v[200:203], a[52:55], a[172:175], v[200:203]
  ds_read_b64_tr_b16 a[156:157], v19 offset:49152
  ds_read_b64_tr_b16 a[158:159], v19 offset:51200
  v_mfma_f32_16x16x32_bf16 v[204:207], a[60:63], a[172:175], v[204:207]
  s_add_u32 s24, s24, 262144
  v_mfma_f32_16x16x32_bf16 v[204:207], a[56:59], a[168:171], v[204:207]
  v_mfma_f32_16x16x32_bf16 v[208:211], a[64:67], a[168:171], v[208:211]
  v_mfma_f32_16x16x32_bf16 v[208:211], a[68:71], a[172:175], v[208:211]
  v_mfma_f32_16x16x32_bf16 v[212:215], a[76:79], a[172:175], v[212:215]
  v_mfma_f32_16x16x32_bf16 v[212:215], a[72:75], a[168:171], v[212:215]
  buffer_load_dword v21, v20, s[60:63], s54 offen
  s_add_u32 s54, s54, s55
  v_mfma_f32_16x16x32_bf16 v[216:219], a[80:83], a[168:171], v[216:219]
  v_mfma_f32_16x16x32_bf16 v[216:219], a[84:87], a[172:175], v[216:219]
  v_mfma_f32_16x16x32_bf16 v[220:223], a[92:95], a[172:175], v[220:223]
  v_mfma_f32_16x16x32_bf16 v[220:223], a[88:91], a[168:171], v[220:223]
  s_waitcnt lgkmcnt(10)
  v_mfma_f32_16x16x32_bf16 v[224:227], a[32:35], a[176:179], v[224:227]
  s_cmp_eq_u32 s54, s56
  s_cselect_b32 s54, s57, s54
  s_cselect_b64 s[60:61], s[58:59], s[60:61]
  s_cselect_b32 s62, s7, s62
  v_mfma_f32_16x16x32_bf16 v[224:227], a[36:39], a[180:183], v[224:227]
  v_mfma_f32_16x16x32_bf16 v[228:231], a[44:47], a[180:183], v[228:231]
  v_mfma_f32_16x16x32_bf16 v[228:231], a[40:43], a[176:179], v[228:231]
  v_mfma_f32_16x16x32_bf16 v[232:235], a[48:51], a[176:179], v[232:235]
  v_mfma_f32_16x16x32_bf16 v[232:235], a[52:55], a[180:183], v[232:235]
  v_mfma_f32_16x16x32_bf16 v[236:239], a[60:63], a[180:183], v[236:239]
  v_mfma_f32_16x16x32_bf16 v[236:239], a[56:59], a[176:179], v[236:239]
  s_waitcnt vmcnt(18) lgkmcnt(0)
  s_barrier
  ds_read_b128 a[160:163], v10 offset:32768
  ds_read_b128 a[164:167], v11 offset:32768
  v_mfma_f32_16x16x32_bf16 v[240:243], a[64:67], a[176:179], v[240:243]
  s_add_u32 m0, s29, 16384
  s_add_u32 s3, s23, s31
  buffer_load_dwordx4 v2, s[8:11], s3 offen offset:0 lds
  v_mfma_f32_16x16x32_bf16 v[240:243], a[68:71], a[180:183], v[240:243]
  v_mfma_f32_16x16x32_bf16 v[244:247], a[76:79], a[180:183], v[244:247]
  v_mfma_f32_16x16x32_bf16 v[244:247], a[72:75], a[176:179], v[244:247]
  v_mfma_f32_16x16x32_bf16 v[248:251], a[80:83], a[176:179], v[248:251]
  v_mfma_f32_16x16x32_bf16 v[248:251], a[84:87], a[180:183], v[248:251]
  buffer_load_dwordx4 v3, s[8:11], s3 offen offset:1024 lds
  v_mfma_f32_16x16x32_bf16 v[252:255], a[92:95], a[180:183], v[252:255]
  v_mfma_f32_16x16x32_bf16 v[252:255], a[88:91], a[176:179], v[252:255]
  v_mfma_f32_16x16x32_bf16 a[0:3], a[32:35], a[184:187], a[0:3]
  v_mfma_f32_16x16x32_bf16 a[0:3], a[36:39], a[188:191], a[0:3]
  ds_read_b128 a[168:171], v10 offset:34816
  ds_read_b128 a[172:175], v11 offset:34816
  v_mfma_f32_16x16x32_bf16 a[4:7], a[44:47], a[188:191], a[4:7]
  v_mfma_f32_16x16x32_bf16 a[4:7], a[40:43], a[184:187], a[4:7]
  v_mfma_f32_16x16x32_bf16 a[8:11], a[48:51], a[184:187], a[8:11]
  buffer_load_dwordx4 v4, s[8:11], s3 offen offset:2048 lds
  v_mfma_f32_16x16x32_bf16 a[8:11], a[52:55], a[188:191], a[8:11]
  v_mfma_f32_16x16x32_bf16 a[12:15], a[60:63], a[188:191], a[12:15]
  v_mfma_f32_16x16x32_bf16 a[12:15], a[56:59], a[184:187], a[12:15]
  v_mfma_f32_16x16x32_bf16 a[16:19], a[64:67], a[184:187], a[16:19]
  v_mfma_f32_16x16x32_bf16 a[16:19], a[68:71], a[188:191], a[16:19]
  buffer_load_dwordx4 v5, s[8:11], s3 offen offset:3072 lds
  v_mfma_f32_16x16x32_bf16 a[20:23], a[76:79], a[188:191], a[20:23]
  v_mfma_f32_16x16x32_bf16 a[20:23], a[72:75], a[184:187], a[20:23]
  v_mfma_f32_16x16x32_bf16 a[24:27], a[80:83], a[184:187], a[24:27]
  v_mfma_f32_16x16x32_bf16 a[24:27], a[84:87], a[188:191], a[24:27]
  v_mfma_f32_16x16x32_bf16 a[28:31], a[92:95], a[188:191], a[28:31]
  v_mfma_f32_16x16x32_bf16 a[28:31], a[88:91], a[184:187], a[28:31]
  s_waitcnt lgkmcnt(2)
  v_mfma_f32_16x16x32_bf16 v[32:35], a[96:99], a[160:163], v[32:35]
  s_add_u32 s23, s23, 128
  s_cmp_eq_u32 s23, s25
  s_cselect_b32 s23, s26, s23
  v_mfma_f32_16x16x32_bf16 v[32:35], a[100:103], a[164:167], v[32:35]
  ds_read_b128 a[176:179], v10 offset:36864
  ds_read_b128 a[180:183], v11 offset:36864
  v_mfma_f32_16x16x32_bf16 v[36:39], a[108:111], a[164:167], v[36:39]
  v_mfma_f32_16x16x32_bf16 v[36:39], a[104:107], a[160:163], v[36:39]
  ds_read_b64_tr_b16 a[32:33], v12 offset:0
  ds_read_b64_tr_b16 a[34:35], v12 offset:2048
  v_mfma_f32_16x16x32_bf16 v[40:43], a[112:115], a[160:163], v[40:43]
  v_mfma_f32_16x16x32_bf16 v[40:43], a[116:119], a[164:167], v[40:43]
  v_mfma_f32_16x16x32_bf16 v[44:47], a[124:127], a[164:167], v[44:47]
  s_add_u32 m0, s29, 114688
  s_nop 0
  buffer_load_dwordx4 v6, s[12:15], s24 offen offset:0 lds
  v_mfma_f32_16x16x32_bf16 v[44:47], a[120:123], a[160:163], v[44:47]
  ds_read_b64_tr_b16 a[40:41], v13 offset:0
  ds_read_b64_tr_b16 a[42:43], v13 offset:2048
  v_mfma_f32_16x16x32_bf16 v[48:51], a[128:131], a[160:163], v[48:51]
  v_mfma_f32_16x16x32_bf16 v[48:51], a[132:135], a[164:167], v[48:51]
  v_mfma_f32_16x16x32_bf16 v[52:55], a[140:143], a[164:167], v[52:55]
  v_mfma_f32_16x16x32_bf16 v[52:55], a[136:139], a[160:163], v[52:55]
  ds_read_b64_tr_b16 a[48:49], v14 offset:0
  ds_read_b64_tr_b16 a[50:51], v14 offset:2048
  v_mfma_f32_16x16x32_bf16 v[56:59], a[144:147], a[160:163], v[56:59]
  v_mfma_f32_16x16x32_bf16 v[56:59], a[148:151], a[164:167], v[56:59]
  buffer_load_dwordx4 v7, s[12:15], s24 offen offset:1024 lds
  v_mfma_f32_16x16x32_bf16 v[60:63], a[156:159], a[164:167], v[60:63]
  v_mfma_f32_16x16x32_bf16 v[60:63], a[152:155], a[160:163], v[60:63]
  s_waitcnt lgkmcnt(8)
  ds_read_b64_tr_b16 a[56:57], v15 offset:0
  ds_read_b64_tr_b16 a[58:59], v15 offset:2048
  v_mfma_f32_16x16x32_bf16 v[64:67], a[96:99], a[168:171], v[64:67]
  v_mfma_f32_16x16x32_bf16 v[64:67], a[100:103], a[172:175], v[64:67]
  ds_read_b128 a[184:187], v10 offset:38912
  ds_read_b128 a[188:191], v11 offset:38912
  v_mfma_f32_16x16x32_bf16 v[68:71], a[108:111], a[172:175], v[68:71]
  v_mfma_f32_16x16x32_bf16 v[68:71], a[104:107], a[168:171], v[68:71]
  ds_read_b64_tr_b16 a[64:65], v16 offset:0
  ds_read_b64_tr_b16 a[66:67], v16 offset:2048
  v_mfma_f32_16x16x32_bf16 v[72:75], a[112:115], a[168:171], v[72:75]
  buffer_load_dwordx4 v8, s[12:15], s24 offen offset:2048 lds
  v_mfma_f32_16x16x32_bf16 v[72:75], a[116:119], a[172:175], v[72:75]
  v_mfma_f32_16x16x32_bf16 v[76:79], a[124:127], a[172:175], v[76:79]
  v_mfma_f32_16x16x32_bf16 v[76:79], a[120:123], a[168:171], v[76:79]
  ds_read_b64_tr_b16 a[72:73], v17 offset:0
  ds_read_b64_tr_b16 a[74:75], v17 offset:2048
  v_mfma_f32_16x16x32_bf16 v[80:83], a[128:131], a[168:171], v[80:83]
  v_mfma_f32_16x16x32_bf16 v[80:83], a[132:135], a[172:175], v[80:83]
  v_mfma_f32_16x16x32_bf16 v[84:87], a[140:143], a[172:175], v[84:87]
  buffer_load_dwordx4 v9, s[12:15], s24 offen offset:3072 lds
  v_mfma_f32_16x16x32_bf16 v[84:87], a[136:139], a[168:171], v[84:87]
  ds_read_b64_tr_b16 a[80:81], v18 offset:0
  ds_read_b64_tr_b16 a[82:83], v18 offset:2048
  v_mfma_f32_16x16x32_bf16 v[88:91], a[144:147], a[168:171], v[88:91]
  v_mfma_f32_16x16x32_bf16 v[88:91], a[148:151], a[172:175], v[88:91]
  v_mfma_f32_16x16x32_bf16 v[92:95], a[156:159], a[172:175], v[92:95]
  v_mfma_f32_16x16x32_bf16 v[92:95], a[152:155], a[168:171], v[92:95]
  s_waitcnt lgkmcnt(15)
  ds_read_b64_tr_b16 a[88:89], v19 offset:0
  ds_read_b64_tr_b16 a[90:91], v19 offset:2048
  v_mfma_f32_16x16x32_bf16 v[96:99], a[96:99], a[176:179], v[96:99]
  s_add_u32 s24, s24, 262144
  s_cmp_eq_u32 s24, s27
  s_cselect_b32 s24, s28, s24
  s_sub_u32 s6, s6, 1
  s_cmp_eq_u32 s6, 0
  s_cselect_b64 s[12:13], s[64:65], s[12:13]
  v_mfma_f32_16x16x32_bf16 v[96:99], a[100:103], a[180:183], v[96:99]
  v_mfma_f32_16x16x32_bf16 v[100:103], a[108:111], a[180:183], v[100:103]
  v_mfma_f32_16x16x32_bf16 v[100:103], a[104:107], a[176:179], v[100:103]
  v_mfma_f32_16x16x32_bf16 v[104:107], a[112:115], a[176:179], v[104:107]
  v_mfma_f32_16x16x32_bf16 v[104:107], a[116:119], a[180:183], v[104:107]
  v_mfma_f32_16x16x32_bf16 v[108:111], a[124:127], a[180:183], v[108:111]
  v_mfma_f32_16x16x32_bf16 v[108:111], a[120:123], a[176:179], v[108:111]
  s_waitcnt vmcnt(17) lgkmcnt(0)
  s_barrier
  ds_read_b128 a[160:163], v10 offset:49152
  ds_read_b128 a[164:167], v11 offset:49152
  v_mfma_f32_16x16x32_bf16 v[112:115], a[128:131], a[176:179], v[112:115]
  s_add_u32 m0, s29, 32768
  s_nop 0
  buffer_load_dwordx4 v2, s[8:11], s23 offen offset:0 lds
  v_mfma_f32_16x16x32_bf16 v[112:115], a[132:135], a[180:183], v[112:115]
  v_mfma_f32_16x16x32_bf16 v[116:119], a[140:143], a[180:183], v[116:119]
  v_mfma_f32_16x16x32_bf16 v[116:119], a[136:139], a[176:179], v[116:119]
  ds_read_b64_tr_b16 a[36:37], v12 offset:16384
  ds_read_b64_tr_b16 a[38:39], v12 offset:18432
  v_mfma_f32_16x16x32_bf16 v[120:123], a[144:147], a[176:179], v[120:123]
  v_mfma_f32_16x16x32_bf16 v[120:123], a[148:151], a[180:183], v[120:123]
  buffer_load_dwordx4 v3, s[8:11], s23 offen offset:1024 lds
  v_mfma_f32_16x16x32_bf16 v[124:127], a[156:159], a[180:183], v[124:127]
  v_mfma_f32_16x16x32_bf16 v[124:127], a[152:155], a[176:179], v[124:127]
  v_mfma_f32_16x16x32_bf16 v[128:131], a[96:99], a[184:187], v[128:131]
  v_mfma_f32_16x16x32_bf16 v[128:131], a[100:103], a[188:191], v[128:131]
  ds_read_b128 a[168:171], v10 offset:51200
  ds_read_b128 a[172:175], v11 offset:51200
  ds_read_b64_tr_b16 a[44:45], v13 offset:16384
  ds_read_b64_tr_b16 a[46:47], v13 offset:18432
  v_mfma_f32_16x16x32_bf16 v[132:135], a[108:111], a[188:191], v[132:135]
  v_mfma_f32_16x16x32_bf16 v[132:135], a[104:107], a[184:187], v[132:135]
  buffer_load_dwordx4 v4, s[8:11], s23 offen offset:2048 lds
  v_mfma_f32_16x16x32_bf16 v[136:139], a[112:115], a[184:187], v[136:139]
  v_mfma_f32_16x16x32_bf16 v[136:139], a[116:119], a[188:191], v[136:139]
  v_mfma_f32_16x16x32_bf16 v[140:143], a[124:127], a[188:191], v[140:143]
  v_mfma_f32_16x16x32_bf16 v[140:143], a[120:123], a[184:187], v[140:143]
  ds_read_b64_tr_b16 a[52:53], v14 offset:16384
  ds_read_b64_tr_b16 a[54:55], v14 offset:18432
  v_mfma_f32_16x16x32_bf16 v[144:147], a[128:131], a[184:187], v[144:147]
  v_mfma_f32_16x16x32_bf16 v[144:147], a[132:135], a[188:191], v[144:147]
  buffer_load_dwordx4 v5, s[8:11], s23 offen offset:3072 lds
  v_mfma_f32_16x16x32_bf16 v[148:151], a[140:143], a[188:191], v[148:151]
  v_mfma_f32_16x16x32_bf16 v[148:151], a[136:139], a[184:187], v[148:151]
  v_mfma_f32_16x16x32_bf16 v[152:155], a[144:147], a[184:187], v[152:155]
  v_mfma_f32_16x16x32_bf16 v[152:155], a[148:151], a[188:191], v[152:155]
  ds_read_b64_tr_b16 a[60:61], v15 offset:16384
  ds_read_b64_tr_b16 a[62:63], v15 offset:18432
  v_mfma_f32_16x16x32_bf16 v[156:159], a[156:159], a[188:191], v[156:159]
  s_add_u32 m0, s29, 65536
  s_nop 0
  buffer_load_dwordx4 v6, s[12:15], s24 offen offset:0 lds
  v_mfma_f32_16x16x32_bf16 v[156:159], a[152:155], a[184:187], v[156:159]
  s_waitcnt lgkmcnt(10)
  v_mfma_f32_16x16x32_bf16 v[160:163], a[96:99], a[160:163], v[160:163]
  v_mfma_f32_16x16x32_bf16 v[160:163], a[100:103], a[164:167], v[160:163]
  ds_read_b128 a[176:179], v10 offset:53248
  ds_read_b128 a[180:183], v11 offset:53248
  v_mfma_f32_16x16x32_bf16 v[164:167], a[108:111], a[164:167], v[164:167]
  v_mfma_f32_16x16x32_bf16 v[164:167], a[104:107], a[160:163], v[164:167]
  ds_read_b64_tr_b16 a[68:69], v16 offset:16384
  ds_read_b64_tr_b16 a[70:71], v16 offset:18432
  v_mfma_f32_16x16x32_bf16 v[168:171], a[112:115], a[160:163], v[168:171]
  v_mfma_f32_16x16x32_bf16 v[168:171], a[116:119], a[164:167], v[168:171]
  buffer_load_dwordx4 v7, s[12:15], s24 offen offset:1024 lds
  v_mfma_f32_16x16x32_bf16 v[172:175], a[124:127], a[164:167], v[172:175]
  v_mfma_f32_16x16x32_bf16 v[172:175], a[120:123], a[160:163], v[172:175]
  v_mfma_f32_16x16x32_bf16 v[176:179], a[128:131], a[160:163], v[176:179]
  v_mfma_f32_16x16x32_bf16 v[176:179], a[132:135], a[164:167], v[176:179]
  ds_read_b64_tr_b16 a[76:77], v17 offset:16384
  ds_read_b64_tr_b16 a[78:79], v17 offset:18432
  v_mfma_f32_16x16x32_bf16 v[180:183], a[140:143], a[164:167], v[180:183]
  v_mfma_f32_16x16x32_bf16 v[180:183], a[136:139], a[160:163], v[180:183]
  buffer_load_dwordx4 v8, s[12:15], s24 offen offset:2048 lds
  v_mfma_f32_16x16x32_bf16 v[184:187], a[144:147], a[160:163], v[184:187]
  v_mfma_f32_16x16x32_bf16 v[184:187], a[148:151], a[164:167], v[184:187]
  v_mfma_f32_16x16x32_bf16 v[188:191], a[156:159], a[164:167], v[188:191]
  v_mfma_f32_16x16x32_bf16 v[188:191], a[152:155], a[160:163], v[188:191]
  s_waitcnt lgkmcnt(12)
  ds_read_b64_tr_b16 a[84:85], v18 offset:16384
  ds_read_b64_tr_b16 a[86:87], v18 offset:18432
  v_mfma_f32_16x16x32_bf16 v[192:195], a[96:99], a[168:171], v[192:195]
  buffer_load_dwordx4 v9, s[12:15], s24 offen offset:3072 lds
  v_mfma_f32_16x16x32_bf16 v[192:195], a[100:103], a[172:175], v[192:195]
  ds_read_b128 a[184:187], v10 offset:55296
  ds_read_b128 a[188:191], v11 offset:55296
  v_mfma_f32_16x16x32_bf16 v[196:199], a[108:111], a[172:175], v[196:199]
  v_mfma_f32_16x16x32_bf16 v[196:199], a[104:107], a[168:171], v[196:199]
  v_mfma_f32_16x16x32_bf16 v[200:203], a[112:115], a[168:171], v[200:203]
  v_mfma_f32_16x16x32_bf16 v[200:203], a[116:119], a[172:175], v[200:203]
  ds_read_b64_tr_b16 a[92:93], v19 offset:16384
  ds_read_b64_tr_b16 a[94:95], v19 offset:18432
  v_mfma_f32_16x16x32_bf16 v[204:207], a[124:127], a[172:175], v[204:207]
  s_add_u32 s24, s24, 262144
  v_mfma_f32_16x16x32_bf16 v[204:207], a[120:123], a[168:171], v[204:207]
  v_mfma_f32_16x16x32_bf16 v[208:211], a[128:131], a[168:171], v[208:211]
  v_mfma_f32_16x16x32_bf16 v[208:211], a[132:135], a[172:175], v[208:211]
  v_mfma_f32_16x16x32_bf16 v[212:215], a[140:143], a[172:175], v[212:215]
  v_mfma_f32_16x16x32_bf16 v[212:215], a[136:139], a[168:171], v[212:215]
  buffer_load_dword v21, v20, s[60:63], s54 offen
  s_add_u32 s54, s54, s55
  v_mfma_f32_16x16x32_bf16 v[216:219], a[144:147], a[168:171], v[216:219]
  v_mfma_f32_16x16x32_bf16 v[216:219], a[148:151], a[172:175], v[216:219]
  v_mfma_f32_16x16x32_bf16 v[220:223], a[156:159], a[172:175], v[220:223]
  v_mfma_f32_16x16x32_bf16 v[220:223], a[152:155], a[168:171], v[220:223]
  s_waitcnt lgkmcnt(10)
  v_mfma_f32_16x16x32_bf16 v[224:227], a[96:99], a[176:179], v[224:227]
  s_cmp_eq_u32 s54, s56
  s_cselect_b32 s54, s57, s54
  s_cselect_b64 s[60:61], s[58:59], s[60:61]
  s_cselect_b32 s62, s7, s62
  v_mfma_f32_16x16x32_bf16 v[224:227], a[100:103], a[180:183], v[224:227]
  v_mfma_f32_16x16x32_bf16 v[228:231], a[108:111], a[180:183], v[228:231]
  v_mfma_f32_16x16x32_bf16 v[228:231], a[104:107], a[176:179], v[228:231]
  v_mfma_f32_16x16x32_bf16 v[232:235], a[112:115], a[176:179], v[232:235]
  v_mfma_f32_16x16x32_bf16 v[232:235], a[116:119], a[180:183], v[232:235]
  v_mfma_f32_16x16x32_bf16 v[236:239], a[124:127], a[180:183], v[236:239]
  v_mfma_f32_16x16x32_bf16 v[236:239], a[120:123], a[176:179], v[236:239]
  s_waitcnt vmcnt(18) lgkmcnt(0)
  s_barrier
  ds_read_b128 a[160:163], v10 offset:0
  ds_read_b128 a[164:167], v11 offset:0
  v_mfma_f32_16x16x32_bf16 v[240:243], a[128:131], a[176:179], v[240:243]
  s_add_u32 m0, s29, 49152
  s_add_u32 s3, s23, s31
  buffer_load_dwordx4 v2, s[8:11], s3 offen offset:0 lds
  v_mfma_f32_16x16x32_bf16 v[240:243], a[132:135], a[180:183], v[240:243]
  v_mfma_f32_16x16x32_bf16 v[244:247], a[140:143], a[180:183], v[244:247]
  v_mfma_f32_16x16x32_bf16 v[244:247], a[136:139], a[176:179], v[244:247]
  v_mfma_f32_16x16x32_bf16 v[248:251], a[144:147], a[176:179], v[248:251]
  v_mfma_f32_16x16x32_bf16 v[248:251], a[148:151], a[180:183], v[248:251]
  buffer_load_dwordx4 v3, s[8:11], s3 offen offset:1024 lds
  v_mfma_f32_16x16x32_bf16 v[252:255], a[156:159], a[180:183], v[252:255]
  v_mfma_f32_16x16x32_bf16 v[252:255], a[152:155], a[176:179], v[252:255]
  v_mfma_f32_16x16x32_bf16 a[0:3], a[96:99], a[184:187], a[0:3]
  v_mfma_f32_16x16x32_bf16 a[0:3], a[100:103], a[188:191], a[0:3]
  ds_read_b128 a[168:171], v10 offset:2048
  ds_read_b128 a[172:175], v11 offset:2048
  v_mfma_f32_16x16x32_bf16 a[4:7], a[108:111], a[188:191], a[4:7]
  v_mfma_f32_16x16x32_bf16 a[4:7], a[104:107], a[184:187], a[4:7]
  v_mfma_f32_16x16x32_bf16 a[8:11], a[112:115], a[184:187], a[8:11]
  buffer_load_dwordx4 v4, s[8:11], s3 offen offset:2048 lds
  v_mfma_f32_16x16x32_bf16 a[8:11], a[116:119], a[188:191], a[8:11]
  v_mfma_f32_16x16x32_bf16 a[12:15], a[124:127], a[188:191], a[12:15]
  v_mfma_f32_16x16x32_bf16 a[12:15], a[120:123], a[184:187], a[12:15]
  v_mfma_f32_16x16x32_bf16 a[16:19], a[128:131], a[184:187], a[16:19]
  v_mfma_f32_16x16x32_bf16 a[16:19], a[132:135], a[188:191], a[16:19]
  buffer_load_dwordx4 v5, s[8:11], s3 offen offset:3072 lds
  v_mfma_f32_16x16x32_bf16 a[20:23], a[140:143], a[188:191], a[20:23]
  v_mfma_f32_16x16x32_bf16 a[20:23], a[136:139], a[184:187], a[20:23]
  v_mfma_f32_16x16x32_bf16 a[24:27], a[144:147], a[184:187], a[24:27]
  v_mfma_f32_16x16x32_bf16 a[24:27], a[148:151], a[188:191], a[24:27]
  v_mfma_f32_16x16x32_bf16 a[28:31], a[156:159], a[188:191], a[28:31]
  v_mfma_f32_16x16x32_bf16 a[28:31], a[152:155], a[184:187], a[28:31]
  s_waitcnt lgkmcnt(2)
  s_sub_u32 s30, s30, 1
  s_cmp_lg_u32 s30, 0
  s_cbranch_scc1 Lk1_ql
  v_mfma_f32_16x16x32_bf16 v[32:35], a[32:35], a[160:163], v[32:35]
  s_add_u32 s23, s23, 128
  s_cmp_eq_u32 s23, s25
  s_cselect_b32 s23, s26, s23
  v_mfma_f32_16x16x32_bf16 v[32:35], a[36:39], a[164:167], v[32:35]
  ds_read_b128 a[176:179], v10 offset:4096
  ds_read_b128 a[180:183], v11 offset:4096
  v_mfma_f32_16x16x32_bf16 v[36:39], a[44:47], a[164:167], v[36:39]
  v_mfma_f32_16x16x32_bf16 v[36:39], a[40:43], a[160:163], v[36:39]
  ds_read_b64_tr_b16 a[96:97], v12 offset:32768
  ds_read_b64_tr_b16 a[98:99], v12 offset:34816
  v_mfma_f32_16x16x32_bf16 v[40:43], a[48:51], a[160:163], v[40:43]
  v_mfma_f32_16x16x32_bf16 v[40:43], a[52:55], a[164:167], v[40:43]
  v_mfma_f32_16x16x32_bf16 v[44:47], a[60:63], a[164:167], v[44:47]
  s_add_u32 m0, s29, 81920
  s_nop 0
  buffer_load_dwordx4 v6, s[12:15], s24 offen offset:0 lds
  v_mfma_f32_16x16x32_bf16 v[44:47], a[56:59], a[160:163], v[44:47]
  ds_read_b64_tr_b16 a[104:105], v13 offset:32768
  ds_read_b64_tr_b16 a[106:107], v13 offset:34816
  v_mfma_f32_16x16x32_bf16 v[48:51], a[64:67], a[160:163], v[48:51]
  v_mfma_f32_16x16x32_bf16 v[48:51], a[68:71], a[164:167], v[48:51]
  v_mfma_f32_16x16x32_bf16 v[52:55], a[76:79], a[164:167], v[52:55]
  v_mfma_f32_16x16x32_bf16 v[52:55], a[72:75], a[160:163], v[52:55]
  ds_read_b64_tr_b16 a[112:113], v14 offset:32768
  ds_read_b64_tr_b16 a[114:115], v14 offset:34816
  v_mfma_f32_16x16x32_bf16 v[56:59], a[80:83], a[160:163], v[56:59]
  v_mfma_f32_16x16x32_bf16 v[56:59], a[84:87], a[164:167], v[56:59]
  buffer_load_dwordx4 v7, s[12:15], s24 offen offset:1024 lds
  v_mfma_f32_16x16x32_bf16 v[60:63], a[92:95], a[164:167], v[60:63]
  v_mfma_f32_16x16x32_bf16 v[60:63], a[88:91], a[160:163], v[60:63]
  s_waitcnt lgkmcnt(8)
  ds_read_b64_tr_b16 a[120:121], v15 offset:32768
  ds_read_b64_tr_b16 a[122:123], v15 offset:34816
  v_mfma_f32_16x16x32_bf16 v[64:67], a[32:35], a[168:171], v[64:67]
  v_mfma_f32_16x16x32_bf16 v[64:67], a[36:39], a[172:175], v[64:67]
  ds_read_b128 a[184:187], v10 offset:6144
  ds_read_b128 a[188:191], v11 offset:6144
  v_mfma_f32_16x16x32_bf16 v[68:71], a[44:47], a[172:175], v[68:71]
  v_mfma_f32_16x16x32_bf16 v[68:71], a[40:43], a[168:171], v[68:71]
  ds_read_b64_tr_b16 a[128:129], v16 offset:32768
  ds_read_b64_tr_b16 a[130:131], v16 offset:34816
  v_mfma_f32_16x16x32_bf16 v[72:75], a[48:51], a[168:171], v[72:75]
  buffer_load_dwordx4 v8, s[12:15], s24 offen offset:2048 lds
  v_mfma_f32_16x16x32_bf16 v[72:75], a[52:55], a[172:175], v[72:75]
  v_mfma_f32_16x16x32_bf16 v[76:79], a[60:63], a[172:175], v[76:79]
  v_mfma_f32_16x16x32_bf16 v[76:79], a[56:59], a[168:171], v[76:79]
  ds_read_b64_tr_b16 a[136:137], v17 offset:32768
  ds_read_b64_tr_b16 a[138:139], v17 offset:34816
  v_mfma_f32_16x16x32_bf16 v[80:83], a[64:67], a[168:171], v[80:83]
  v_mfma_f32_16x16x32_bf16 v[80:83], a[68:71], a[172:175], v[80:83]
  v_mfma_f32_16x16x32_bf16 v[84:87], a[76:79], a[172:175], v[84:87]
  buffer_load_dwordx4 v9, s[12:15], s24 offen offset:3072 lds
  v_mfma_f32_16x16x32_bf16 v[84:87], a[72:75], a[168:171], v[84:87]
  ds_read_b64_tr_b16 a[144:145], v18 offset:32768
  ds_read_b64_tr_b16 a[146:147], v18 offset:34816
  v_mfma_f32_16x16x32_bf16 v[88:91], a[80:83], a[168:171], v[88:91]
  v_mfma_f32_16x16x32_bf16 v[88:91], a[84:87], a[172:175], v[88:91]
  v_mfma_f32_16x16x32_bf16 v[92:95], a[92:95], a[172:175], v[92:95]
  v_mfma_f32_16x16x32_bf16 v[92:95], a[88:91], a[168:171], v[92:95]
  s_waitcnt lgkmcnt(15)
  ds_read_b64_tr_b16 a[152:153], v19 offset:32768
  ds_read_b64_tr_b16 a[154:155], v19 offset:34816
  v_mfma_f32_16x16x32_bf16 v[96:99], a[32:35], a[176:179], v[96:99]
  s_add_u32 s24, s24, 262144
  s_cmp_eq_u32 s24, s27
  s_cselect_b32 s24, s28, s24
  s_sub_u32 s6, s6, 1
  s_cmp_eq_u32 s6, 0
  s_cselect_b64 s[12:13], s[64:65], s[12:13]
  v_mfma_f32_16x16x32_bf16 v[96:99], a[36:39], a[180:183], v[96:99]
  v_mfma_f32_16x16x32_bf16 v[100:103], a[44:47], a[180:183], v[100:103]
  v_mfma_f32_16x16x32_bf16 v[100:103], a[40:43], a[176:179], v[100:103]
  v_mfma_f32_16x16x32_bf16 v[104:107], a[48:51], a[176:179], v[104:107]
  v_mfma_f32_16x16x32_bf16 v[104:107], a[52:55], a[180:183], v[104:107]
  v_mfma_f32_16x16x32_bf16 v[108:111], a[60:63], a[180:183], v[108:111]
  v_mfma_f32_16x16x32_bf16 v[108:111], a[56:59], a[176:179], v[108:111]
  s_waitcnt vmcnt(17) lgkmcnt(0)
  s_barrier
  ds_read_b128 a[160:163], v10 offset:16384
  ds_read_b128 a[164:167], v11 offset:16384
  v_mfma_f32_16x16x32_bf16 v[112:115], a[64:67], a[176:179], v[112:115]
  s_add_u32 m0, s29, 0
  s_nop 0
  buffer_load_dwordx4 v2, s[8:11], s23 offen offset:0 lds
  v_mfma_f32_16x16x32_bf16 v[112:115], a[68:71], a[180:183], v[112:115]
  v_mfma_f32_16x16x32_bf16 v[116:119], a[76:79], a[180:183], v[116:119]
  v_mfma_f32_16x16x32_bf16 v[116:119], a[72:75], a[176:179], v[116:119]
  ds_read_b64_tr_b16 a[100:101], v12 offset:49152
  ds_read_b64_tr_b16 a[102:103], v12 offset:51200
  v_mfma_f32_16x16x32_bf16 v[120:123], a[80:83], a[176:179], v[120:123]
  v_mfma_f32_16x16x32_bf16 v[120:123], a[84:87], a[180:183], v[120:123]
  v_mfma_f32_16x16x32_bf16 v[124:127], a[92:95], a[180:183], v[124:127]
  buffer_load_dwordx4 v3, s[8:11], s23 offen offset:1024 lds
  v_mfma_f32_16x16x32_bf16 v[124:127], a[88:91], a[176:179], v[124:127]
  v_mfma_f32_16x16x32_bf16 v[128:131], a[32:35], a[184:187], v[128:131]
  v_mfma_f32_16x16x32_bf16 v[128:131], a[36:39], a[188:191], v[128:131]
  ds_read_b128 a[168:171], v10 offset:18432
  ds_read_b128 a[172:175], v11 offset:18432
  ds_read_b64_tr_b16 a[108:109], v13 offset:49152
  ds_read_b64_tr_b16 a[110:111], v13 offset:51200
  v_mfma_f32_16x16x32_bf16 v[132:135], a[44:47], a[188:191], v[132:135]
  v_mfma_f32_16x16x32_bf16 v[132:135], a[40:43], a[184:187], v[132:135]
  v_mfma_f32_16x16x32_bf16 v[136:139], a[48:51], a[184:187], v[136:139]
  v_mfma_f32_16x16x32_bf16 v[136:139], a[52:55], a[188:191], v[136:139]
  buffer_load_dwordx4 v4, s[8:11], s23 offen offset:2048 lds
  v_mfma_f32_16x16x32_bf16 v[140:143], a[60:63], a[188:191], v[140:143]
  v_mfma_f32_16x16x32_bf16 v[140:143], a[56:59], a[184:187], v[140:143]
  ds_read_b64_tr_b16 a[116:117], v14 offset:49152
  ds_read_b64_tr_b16 a[118:119], v14 offset:51200
  v_mfma_f32_16x16x32_bf16 v[144:147], a[64:67], a[184:187], v[144:147]
  v_mfma_f32_16x16x32_bf16 v[144:147], a[68:71], a[188:191], v[144:147]
  v_mfma_f32_16x16x32_bf16 v[148:151], a[76:79], a[188:191], v[148:151]
  v_mfma_f32_16x16x32_bf16 v[148:151], a[72:75], a[184:187], v[148:151]
  v_mfma_f32_16x16x32_bf16 v[152:155], a[80:83], a[184:187], v[152:155]
  buffer_load_dwordx4 v5, s[8:11], s23 offen offset:3072 lds
  v_mfma_f32_16x16x32_bf16 v[152:155], a[84:87], a[188:191], v[152:155]
  ds_read_b64_tr_b16 a[124:125], v15 offset:49152
  ds_read_b64_tr_b16 a[126:127], v15 offset:51200
  v_mfma_f32_16x16x32_bf16 v[156:159], a[92:95], a[188:191], v[156:159]
  v_mfma_f32_16x16x32_bf16 v[156:159], a[88:91], a[184:187], v[156:159]
  s_waitcnt lgkmcnt(10)
  v_mfma_f32_16x16x32_bf16 v[160:163], a[32:35], a[160:163], v[160:163]
  v_mfma_f32_16x16x32_bf16 v[160:163], a[36:39], a[164:167], v[160:163]
  ds_read_b128 a[176:179], v10 offset:20480
  ds_read_b128 a[180:183], v11 offset:20480
  v_mfma_f32_16x16x32_bf16 v[164:167], a[44:47], a[164:167], v[164:167]
  v_mfma_f32_16x16x32_bf16 v[164:167], a[40:43], a[160:163], v[164:167]
  ds_read_b64_tr_b16 a[132:133], v16 offset:49152
  ds_read_b64_tr_b16 a[134:135], v16 offset:51200
  v_mfma_f32_16x16x32_bf16 v[168:171], a[48:51], a[160:163], v[168:171]
  v_mfma_f32_16x16x32_bf16 v[168:171], a[52:55], a[164:167], v[168:171]
  s_add_u32 m0, s29, 98304
  s_nop 0
  buffer_load_dwordx4 v6, s[12:15], s24 offen offset:0 lds
  v_mfma_f32_16x16x32_bf16 v[172:175], a[60:63], a[164:167], v[172:175]
  v_mfma_f32_16x16x32_bf16 v[172:175], a[56:59], a[160:163], v[172:175]
  v_mfma_f32_16x16x32_bf16 v[176:179], a[64:67], a[160:163], v[176:179]
  v_mfma_f32_16x16x32_bf16 v[176:179], a[68:71], a[164:167], v[176:179]
  ds_read_b64_tr_b16 a[140:141], v17 offset:49152
  ds_read_b64_tr_b16 a[142:143], v17 offset:51200
  v_mfma_f32_16x16x32_bf16 v[180:183], a[76:79], a[164:167], v[180:183]
  v_mfma_f32_16x16x32_bf16 v[180:183], a[72:75], a[160:163], v[180:183]
  buffer_load_dwordx4 v7, s[12:15], s24 offen offset:1024 lds
  v_mfma_f32_16x16x32_bf16 v[184:187], a[80:83], a[160:163], v[184:187]
  v_mfma_f32_16x16x32_bf16 v[184:187], a[84:87], a[164:167], v[184:187]
  v_mfma_f32_16x16x32_bf16 v[188:191], a[92:95], a[164:167], v[188:191]
  v_mfma_f32_16x16x32_bf16 v[188:191], a[88:91], a[160:163], v[188:191]
  s_waitcnt lgkmcnt(12)
  ds_read_b64_tr_b16 a[148:149], v18 offset:49152
  ds_read_b64_tr_b16 a[150:151], v18 offset:51200
  v_mfma_f32_16x16x32_bf16 v[192:195], a[32:35], a[168:171], v[192:195]
  v_mfma_f32_16x16x32_bf16 v[192:195], a[36:39], a[172:175], v[192:195]
  ds_read_b128 a[184:187], v10 offset:22528
  ds_read_b128 a[188:191], v11 offset:22528
  v_mfma_f32_16x16x32_bf16 v[196:199], a[44:47], a[172:175], v[196:199]
  v_mfma_f32_16x16x32_bf16 v[196:199], a[40:43], a[168:171], v[196:199]
  buffer_load_dwordx4 v8, s[12:15], s24 offen offset:2048 lds
  v_mfma_f32_16x16x32_bf16 v[200:203], a[48:51], a[168:171], v[200:203]
  v_mfma_f32_16x16x32_bf16 v[200:203], a[52:55], a[172:175], v[200:203]
  ds_read_b64_tr_b16 a[156:157], v19 offset:49152
  ds_read_b64_tr_b16 a[158:159], v19 offset:51200
  v_mfma_f32_16x16x32_bf16 v[204:207], a[60:63], a[172:175], v[204:207]
  v_mfma_f32_16x16x32_bf16 v[204:207], a[56:59], a[168:171], v[204:207]
  v_mfma_f32_16x16x32_bf16 v[208:211], a[64:67], a[168:171], v[208:211]
  v_mfma_f32_16x16x32_bf16 v[208:211], a[68:71], a[172:175], v[208:211]
  buffer_load_dwordx4 v9, s[12:15], s24 offen offset:3072 lds
  v_mfma_f32_16x16x32_bf16 v[212:215], a[76:79], a[172:175], v[212:215]
  v_mfma_f32_16x16x32_bf16 v[212:215], a[72:75], a[168:171], v[212:215]
  v_mfma_f32_16x16x32_bf16 v[216:219], a[80:83], a[168:171], v[216:219]
  v_mfma_f32_16x16x32_bf16 v[216:219], a[84:87], a[172:175], v[216:219]
  v_mfma_f32_16x16x32_bf16 v[220:223], a[92:95], a[172:175], v[220:223]
  s_add_u32 s24, s24, 262144
  v_mfma_f32_16x16x32_bf16 v[220:223], a[88:91], a[168:171], v[220:223]
  s_waitcnt lgkmcnt(10)
  v_mfma_f32_16x16x32_bf16 v[224:227], a[32:35], a[176:179], v[224:227]
  v_mfma_f32_16x16x32_bf16 v[224:227], a[36:39], a[180:183], v[224:227]
  v_mfma_f32_16x16x32_bf16 v[228:231], a[44:47], a[180:183], v[228:231]
  v_mfma_f32_16x16x32_bf16 v[228:231], a[40:43], a[176:179], v[228:231]
  v_mfma_f32_16x16x32_bf16 v[232:235], a[48:51], a[176:179], v[232:235]
  v_mfma_f32_16x16x32_bf16 v[232:235], a[52:55], a[180:183], v[232:235]
  v_mfma_f32_16x16x32_bf16 v[236:239], a[60:63], a[180:183], v[236:239]
  v_mfma_f32_16x16x32_bf16 v[236:239], a[56:59], a[176:179], v[236:239]
  s_waitcnt vmcnt(17) lgkmcnt(0)
  s_barrier
  ds_read_b128 a[160:163], v10 offset:32768
  ds_read_b128 a[164:167], v11 offset:32768
  v_mfma_f32_16x16x32_bf16 v[240:243], a[64:67], a[176:179], v[240:243]
  s_add_u32 m0, s29, 16384
  s_add_u32 s3, s23, s31
  buffer_load_dwordx4 v2, s[8:11], s3 offen offset:0 lds
  v_mfma_f32_16x16x32_bf16 v[240:243], a[68:71], a[180:183], v[240:243]
  v_mfma_f32_16x16x32_bf16 v[244:247], a[76:79], a[180:183], v[244:247]
  v_mfma_f32_16x16x32_bf16 v[244:247], a[72:75], a[176:179], v[244:247]
  v_mfma_f32_16x16x32_bf16 v[248:251], a[80:83], a[176:179], v[248:251]
  v_mfma_f32_16x16x32_bf16 v[248:251], a[84:87], a[180:183], v[248:251]
  buffer_load_dwordx4 v3, s[8:11], s3 offen offset:1024 lds
  v_mfma_f32_16x16x32_bf16 v[252:255], a[92:95], a[180:183], v[252:255]
  v_mfma_f32_16x16x32_bf16 v[252:255], a[88:91], a[176:179], v[252:255]
  v_mfma_f32_16x16x32_bf16 a[0:3], a[32:35], a[184:187], a[0:3]
  v_mfma_f32_16x16x32_bf16 a[0:3], a[36:39], a[188:191], a[0:3]
  ds_read_b128 a[168:171], v10 offset:34816
  ds_read_b128 a[172:175], v11 offset:34816
  v_mfma_f32_16x16x32_bf16 a[4:7], a[44:47], a[188:191], a[4:7]
  v_mfma_f32_16x16x32_bf16 a[4:7], a[40:43], a[184:187], a[4:7]
  v_mfma_f32_16x16x32_bf16 a[8:11], a[48:51], a[184:187], a[8:11]
  buffer_load_dwordx4 v4, s[8:11], s3 offen offset:2048 lds
  v_mfma_f32_16x16x32_bf16 a[8:11], a[52:55], a[188:191], a[8:11]
  v_mfma_f32_16x16x32_bf16 a[12:15], a[60:63], a[188:191], a[12:15]
  v_mfma_f32_16x16x32_bf16 a[12:15], a[56:59], a[184:187], a[12:15]
  v_mfma_f32_16x16x32_bf16 a[16:19], a[64:67], a[184:187], a[16:19]
  v_mfma_f32_16x16x32_bf16 a[16:19], a[68:71], a[188:191], a[16:19]
  buffer_load_dwordx4 v5, s[8:11], s3 offen offset:3072 lds
  v_mfma_f32_16x16x32_bf16 a[20:23], a[76:79], a[188:191], a[20:23]
  v_mfma_f32_16x16x32_bf16 a[20:23], a[72:75], a[184:187], a[20:23]
  v_mfma_f32_16x16x32_bf16 a[24:27], a[80:83], a[184:187], a[24:27]
  v_mfma_f32_16x16x32_bf16 a[24:27], a[84:87], a[188:191], a[24:27]
  v_mfma_f32_16x16x32_bf16 a[28:31], a[92:95], a[188:191], a[28:31]
  v_mfma_f32_16x16x32_bf16 a[28:31], a[88:91], a[184:187], a[28:31]
  s_waitcnt lgkmcnt(2)
  v_mfma_f32_16x16x32_bf16 v[32:35], a[96:99], a[160:163], v[32:35]
  s_add_u32 s23, s23, 128
  s_cmp_eq_u32 s23, s25
  s_cselect_b32 s23, s26, s23
  v_mfma_f32_16x16x32_bf16 v[32:35], a[100:103], a[164:167], v[32:35]
  ds_read_b128 a[176:179], v10 offset:36864
  ds_read_b128 a[180:183], v11 offset:36864
  v_mfma_f32_16x16x32_bf16 v[36:39], a[108:111], a[164:167], v[36:39]
  v_mfma_f32_16x16x32_bf16 v[36:39], a[104:107], a[160:163], v[36:39]
  ds_read_b64_tr_b16 a[32:33], v12 offset:0
  ds_read_b64_tr_b16 a[34:35], v12 offset:2048
  v_mfma_f32_16x16x32_bf16 v[40:43], a[112:115], a[160:163], v[40:43]
  v_mfma_f32_16x16x32_bf16 v[40:43], a[116:119], a[164:167], v[40:43]
  v_mfma_f32_16x16x32_bf16 v[44:47], a[124:127], a[164:167], v[44:47]
  s_add_u32 m0, s29, 114688
  s_nop 0
  buffer_load_dwordx4 v6, s[12:15], s24 offen offset:0 lds
  v_mfma_f32_16x16x32_bf16 v[44:47], a[120:123], a[160:163], v[44:47]
  ds_read_b64_tr_b16 a[40:41], v13 offset:0
  ds_read_b64_tr_b16 a[42:43], v13 offset:2048
  v_mfma_f32_16x16x32_bf16 v[48:51], a[128:131], a[160:163], v[48:51]
  v_mfma_f32_16x16x32_bf16 v[48:51], a[132:135], a[164:167], v[48:51]
  v_mfma_f32_16x16x32_bf16 v[52:55], a[140:143], a[164:167], v[52:55]
  v_mfma_f32_16x16x32_bf16 v[52:55], a[136:139], a[160:163], v[52:55]
  ds_read_b64_tr_b16 a[48:49], v14 offset:0
  ds_read_b64_tr_b16 a[50:51], v14 offset:2048
  v_mfma_f32_16x16x32_bf16 v[56:59], a[144:147], a[160:163], v[56:59]
  v_mfma_f32_16x16x32_bf16 v[56:59], a[148:151], a[164:167], v[56:59]
  buffer_load_dwordx4 v7, s[12:15], s24 offen offset:1024 lds
  v_mfma_f32_16x16x32_bf16 v[60:63], a[156:159], a[164:167], v[60:63]
  v_mfma_f32_16x16x32_bf16 v[60:63], a[152:155], a[160:163], v[60:63]
  s_waitcnt lgkmcnt(8)
  ds_read_b64_tr_b16 a[56:57], v15 offset:0
  ds_read_b64_tr_b16 a[58:59], v15 offset:2048
  v_mfma_f32_16x16x32_bf16 v[64:67], a[96:99], a[168:171], v[64:67]
  v_mfma_f32_16x16x32_bf16 v[64:67], a[100:103], a[172:175], v[64:67]
  ds_read_b128 a[184:187], v10 offset:38912
  ds_read_b128 a[188:191], v11 offset:38912
  v_mfma_f32_16x16x32_bf16 v[68:71], a[108:111], a[172:175], v[68:71]
  v_mfma_f32_16x16x32_bf16 v[68:71], a[104:107], a[168:171], v[68:71]
  ds_read_b64_tr_b16 a[64:65], v16 offset:0
  ds_read_b64_tr_b16 a[66:67], v16 offset:2048
  v_mfma_f32_16x16x32_bf16 v[72:75], a[112:115], a[168:171], v[72:75]
  buffer_load_dwordx4 v8, s[12:15], s24 offen offset:2048 lds
  v_mfma_f32_16x16x32_bf16 v[72:75], a[116:119], a[172:175], v[72:75]
  v_mfma_f32_16x16x32_bf16 v[76:79], a[124:127], a[172:175], v[76:79]
  v_mfma_f32_16x16x32_bf16 v[76:79], a[120:123], a[168:171], v[76:79]
  ds_read_b64_tr_b16 a[72:73], v17 offset:0
  ds_read_b64_tr_b16 a[74:75], v17 offset:2048
  v_mfma_f32_16x16x32_bf16 v[80:83], a[128:131], a[168:171], v[80:83]
  v_mfma_f32_16x16x32_bf16 v[80:83], a[132:135], a[172:175], v[80:83]
  v_mfma_f32_16x16x32_bf16 v[84:87], a[140:143], a[172:175], v[84:87]
  buffer_load_dwordx4 v9, s[12:15], s24 offen offset:3072 lds
  v_mfma_f32_16x16x32_bf16 v[84:87], a[136:139], a[168:171], v[84:87]
  ds_read_b64_tr_b16 a[80:81], v18 offset:0
  ds_read_b64_tr_b16 a[82:83], v18 offset:2048
  v_mfma_f32_16x16x32_bf16 v[88:91], a[144:147], a[168:171], v[88:91]
  v_mfma_f32_16x16x32_bf16 v[88:91], a[148:151], a[172:175], v[88:91]
  v_mfma_f32_16x16x32_bf16 v[92:95], a[156:159], a[172:175], v[92:95]
  v_mfma_f32_16x16x32_bf16 v[92:95], a[152:155], a[168:171], v[92:95]
  s_waitcnt lgkmcnt(15)
  ds_read_b64_tr_b16 a[88:89], v19 offset:0
  ds_read_b64_tr_b16 a[90:91], v19 offset:2048
  v_mfma_f32_16x16x32_bf16 v[96:99], a[96:99], a[176:179], v[96:99]
  s_add_u32 s24, s24, 262144
  s_cmp_eq_u32 s24, s27
  s_cselect_b32 s24, s28, s24
  s_sub_u32 s6, s6, 1
  s_cmp_eq_u32 s6, 0
  s_cselect_b64 s[12:13], s[64:65], s[12:13]
  v_mfma_f32_16x16x32_bf16 v[96:99], a[100:103], a[180:183], v[96:99]
  v_mfma_f32_16x16x32_bf16 v[100:103], a[108:111], a[180:183], v[100:103]
  v_mfma_f32_16x16x32_bf16 v[100:103], a[104:107], a[176:179], v[100:103]
  v_mfma_f32_16x16x32_bf16 v[104:107], a[112:115], a[176:179], v[104:107]
  v_mfma_f32_16x16x32_bf16 v[104:107], a[116:119], a[180:183], v[104:107]
  v_mfma_f32_16x16x32_bf16 v[108:111], a[124:127], a[180:183], v[108:111]
  v_mfma_f32_16x16x32_bf16 v[108:111], a[120:123], a[176:179], v[108:111]
  s_waitcnt vmcnt(16) lgkmcnt(0)
  s_barrier
  ds_read_b128 a[160:163], v10 offset:49152
  ds_read_b128 a[164:167], v11 offset:49152
  v_mfma_f32_16x16x32_bf16 v[112:115], a[128:131], a[176:179], v[112:115]
  s_add_u32 m0, s29, 32768
  s_nop 0
  buffer_load_dwordx4 v2, s[8:11], s23 offen offset:0 lds
  v_mfma_f32_16x16x32_bf16 v[112:115], a[132:135], a[180:183], v[112:115]
  v_mfma_f32_16x16x32_bf16 v[116:119], a[140:143], a[180:183], v[116:119]
  v_mfma_f32_16x16x32_bf16 v[116:119], a[136:139], a[176:179], v[116:119]
  ds_read_b64_tr_b16 a[36:37], v12 offset:16384
  ds_read_b64_tr_b16 a[38:39], v12 offset:18432
  v_mfma_f32_16x16x32_bf16 v[120:123], a[144:147], a[176:179], v[120:123]
  v_mfma_f32_16x16x32_bf16 v[120:123], a[148:151], a[180:183], v[120:123]
  v_mfma_f32_16x16x32_bf16 v[124:127], a[156:159], a[180:183], v[124:127]
  v_mfma_f32_16x16x32_bf16 v[124:127], a[152:155], a[176:179], v[124:127]
  v_mfma_f32_16x16x32_bf16 v[128:131], a[96:99], a[184:187], v[128:131]
  v_mfma_f32_16x16x32_bf16 v[128:131], a[100:103], a[188:191], v[128:131]
  ds_read_b128 a[168:171], v10 offset:51200
  ds_read_b128 a[172:175], v11 offset:51200
  ds_read_b64_tr_b16 a[44:45], v13 offset:16384
  ds_read_b64_tr_b16 a[46:47], v13 offset:18432
  v_mfma_f32_16x16x32_bf16 v[132:135], a[108:111], a[188:191], v[132:135]
  v_mfma_f32_16x16x32_bf16 v[132:135], a[104:107], a[184:187], v[132:135]
  v_mfma_f32_16x16x32_bf16 v[136:139], a[112:115], a[184:187], v[136:139]
  v_mfma_f32_16x16x32_bf16 v[136:139], a[116:119], a[188:191], v[136:139]
  v_mfma_f32_16x16x32_bf16 v[140:143], a[124:127], a[188:191], v[140:143]
  v_mfma_f32_16x16x32_bf16 v[140:143], a[120:123], a[184:187], v[140:143]
  ds_read_b64_tr_b16 a[52:53], v14 offset:16384
  ds_read_b64_tr_b16 a[54:55], v14 offset:18432
  v_mfma_f32_16x16x32_bf16 v[144:147], a[128:131], a[184:187], v[144:147]
  buffer_load_dwordx4 v3, s[8:11], s23 offen offset:1024 lds
  v_mfma_f32_16x16x32_bf16 v[144:147], a[132:135], a[188:191], v[144:147]
  v_mfma_f32_16x16x32_bf16 v[148:151], a[140:143], a[188:191], v[148:151]
  v_mfma_f32_16x16x32_bf16 v[148:151], a[136:139], a[184:187], v[148:151]
  v_mfma_f32_16x16x32_bf16 v[152:155], a[144:147], a[184:187], v[152:155]
  v_mfma_f32_16x16x32_bf16 v[152:155], a[148:151], a[188:191], v[152:155]
  ds_read_b64_tr_b16 a[60:61], v15 offset:16384
  ds_read_b64_tr_b16 a[62:63], v15 offset:18432
  v_mfma_f32_16x16x32_bf16 v[156:159], a[156:159], a[188:191], v[156:159]
  v_mfma_f32_16x16x32_bf16 v[156:159], a[152:155], a[184:187], v[156:159]
  s_waitcnt lgkmcnt(10)
  v_mfma_f32_16x16x32_bf16 v[160:163], a[96:99], a[160:163], v[160:163]
  v_mfma_f32_16x16x32_bf16 v[160:163], a[100:103], a[164:167], v[160:163]
  ds_read_b128 a[176:179], v10 offset:53248
  ds_read_b128 a[180:183], v11 offset:53248
  v_mfma_f32_16x16x32_bf16 v[164:167], a[108:111], a[164:167], v[164:167]
  v_mfma_f32_16x16x32_bf16 v[164:167], a[104:107], a[160:163], v[164:167]
  ds_read_b64_tr_b16 a[68:69], v16 offset:16384
  ds_read_b64_tr_b16 a[70:71], v16 offset:18432
  v_mfma_f32_16x16x32_bf16 v[168:171], a[112:115], a[160:163], v[168:171]
  v_mfma_f32_16x16x32_bf16 v[168:171], a[116:119], a[164:167], v[168:171]
  v_mfma_f32_16x16x32_bf16 v[172:175], a[124:127], a[164:167], v[172:175]
  v_mfma_f32_16x16x32_bf16 v[172:175], a[120:123], a[160:163], v[172:175]
  v_mfma_f32_16x16x32_bf16 v[176:179], a[128:131], a[160:163], v[176:179]
  buffer_load_dwordx4 v4, s[8:11], s23 offen offset:2048 lds
  v_mfma_f32_16x16x32_bf16 v[176:179], a[132:135], a[164:167], v[176:179]
  ds_read_b64_tr_b16 a[76:77], v17 offset:16384
  ds_read_b64_tr_b16 a[78:79], v17 offset:18432
  v_mfma_f32_16x16x32_bf16 v[180:183], a[140:143], a[164:167], v[180:183]
  v_mfma_f32_16x16x32_bf16 v[180:183], a[136:139], a[160:163], v[180:183]
  v_mfma_f32_16x16x32_bf16 v[184:187], a[144:147], a[160:163], v[184:187]
  v_mfma_f32_16x16x32_bf16 v[184:187], a[148:151], a[164:167], v[184:187]
  v_mfma_f32_16x16x32_bf16 v[188:191], a[156:159], a[164:167], v[188:191]
  v_mfma_f32_16x16x32_bf16 v[188:191], a[152:155], a[160:163], v[188:191]
  s_waitcnt lgkmcnt(12)
  ds_read_b64_tr_b16 a[84:85], v18 offset:16384
  ds_read_b64_tr_b16 a[86:87], v18 offset:18432
  v_mfma_f32_16x16x32_bf16 v[192:195], a[96:99], a[168:171], v[192:195]
  v_mfma_f32_16x16x32_bf16 v[192:195], a[100:103], a[172:175], v[192:195]
  ds_read_b128 a[184:187], v10 offset:55296
  ds_read_b128 a[188:191], v11 offset:55296
  v_mfma_f32_16x16x32_bf16 v[196:199], a[108:111], a[172:175], v[196:199]
  v_mfma_f32_16x16x32_bf16 v[196:199], a[104:107], a[168:171], v[196:199]
  v_mfma_f32_16x16x32_bf16 v[200:203], a[112:115], a[168:171], v[200:203]
  v_mfma_f32_16x16x32_bf16 v[200:203], a[116:119], a[172:175], v[200:203]
  ds_read_b64_tr_b16 a[92:93], v19 offset:16384
  ds_read_b64_tr_b16 a[94:95], v19 offset:18432
  v_mfma_f32_16x16x32_bf16 v[204:207], a[124:127], a[172:175], v[204:207]
  v_mfma_f32_16x16x32_bf16 v[204:207], a[120:123], a[168:171], v[204:207]
  v_mfma_f32_16x16x32_bf16 v[208:211], a[128:131], a[168:171], v[208:211]
  buffer_load_dwordx4 v5, s[8:11], s23 offen offset:3072 lds
  v_mfma_f32_16x16x32_bf16 v[208:211], a[132:135], a[172:175], v[208:211]
  v_mfma_f32_16x16x32_bf16 v[212:215], a[140:143], a[172:175], v[212:215]
  v_mfma_f32_16x16x32_bf16 v[212:215], a[136:139], a[168:171], v[212:215]
  v_mfma_f32_16x16x32_bf16 v[216:219], a[144:147], a[168:171], v[216:219]
  v_mfma_f32_16x16x32_bf16 v[216:219], a[148:151], a[172:175], v[216:219]
  v_mfma_f32_16x16x32_bf16 v[220:223], a[156:159], a[172:175], v[220:223]
  v_mfma_f32_16x16x32_bf16 v[220:223], a[152:155], a[168:171], v[220:223]
  s_waitcnt lgkmcnt(10)
  v_mfma_f32_16x16x32_bf16 v[224:227], a[96:99], a[176:179], v[224:227]
  v_mfma_f32_16x16x32_bf16 v[224:227], a[100:103], a[180:183], v[224:227]
  v_mfma_f32_16x16x32_bf16 v[228:231], a[108:111], a[180:183], v[228:231]
  v_mfma_f32_16x16x32_bf16 v[228:231], a[104:107], a[176:179], v[228:231]
  v_mfma_f32_16x16x32_bf16 v[232:235], a[112:115], a[176:179], v[232:235]
  v_mfma_f32_16x16x32_bf16 v[232:235], a[116:119], a[180:183], v[232:235]
  v_mfma_f32_16x16x32_bf16 v[236:239], a[124:127], a[180:183], v[236:239]
  v_mfma_f32_16x16x32_bf16 v[236:239], a[120:123], a[176:179], v[236:239]
  s_waitcnt vmcnt(12) lgkmcnt(0)
  s_barrier
  ds_read_b128 a[160:163], v10 offset:0
  ds_read_b128 a[164:167], v11 offset:0
  v_mfma_f32_16x16x32_bf16 v[240:243], a[128:131], a[176:179], v[240:243]
  s_add_u32 m0, s29, 49152
  s_add_u32 s3, s23, s31
  buffer_load_dwordx4 v2, s[8:11], s3 offen offset:0 lds
  v_mfma_f32_16x16x32_bf16 v[240:243], a[132:135], a[180:183], v[240:243]
  v_mfma_f32_16x16x32_bf16 v[244:247], a[140:143], a[180:183], v[244:247]
  v_mfma_f32_16x16x32_bf16 v[244:247], a[136:139], a[176:179], v[244:247]
  v_mfma_f32_16x16x32_bf16 v[248:251], a[144:147], a[176:179], v[248:251]
  v_mfma_f32_16x16x32_bf16 v[248:251], a[148:151], a[180:183], v[248:251]
  v_mfma_f32_16x16x32_bf16 v[252:255], a[156:159], a[180:183], v[252:255]
  v_mfma_f32_16x16x32_bf16 v[252:255], a[152:155], a[176:179], v[252:255]
  v_mfma_f32_16x16x32_bf16 a[0:3], a[96:99], a[184:187], a[0:3]
  v_mfma_f32_16x16x32_bf16 a[0:3], a[100:103], a[188:191], a[0:3]
  ds_read_b128 a[168:171], v10 offset:2048
  ds_read_b128 a[172:175], v11 offset:2048
  v_mfma_f32_16x16x32_bf16 a[4:7], a[108:111], a[188:191], a[4:7]
  v_mfma_f32_16x16x32_bf16 a[4:7], a[104:107], a[184:187], a[4:7]
  v_mfma_f32_16x16x32_bf16 a[8:11], a[112:115], a[184:187], a[8:11]
  buffer_load_dwordx4 v3, s[8:11], s3 offen offset:1024 lds
  v_mfma_f32_16x16x32_bf16 a[8:11], a[116:119], a[188:191], a[8:11]
  v_mfma_f32_16x16x32_bf16 a[12:15], a[124:127], a[188:191], a[12:15]
  v_mfma_f32_16x16x32_bf16 a[12:15], a[120:123], a[184:187], a[12:15]
  v_mfma_f32_16x16x32_bf16 a[16:19], a[128:131], a[184:187], a[16:19]
  v_mfma_f32_16x16x32_bf16 a[16:19], a[132:135], a[188:191], a[16:19]
  v_mfma_f32_16x16x32_bf16 a[20:23], a[140:143], a[188:191], a[20:23]
  v_mfma_f32_16x16x32_bf16 a[20:23], a[136:139], a[184:187], a[20:23]
  v_mfma_f32_16x16x32_bf16 a[24:27], a[144:147], a[184:187], a[24:27]
  v_mfma_f32_16x16x32_bf16 a[24:27], a[148:151], a[188:191], a[24:27]
  v_mfma_f32_16x16x32_bf16 a[28:31], a[156:159], a[188:191], a[28:31]
  v_mfma_f32_16x16x32_bf16 a[28:31], a[152:155], a[184:187], a[28:31]
  s_waitcnt lgkmcnt(2)
  v_mfma_f32_16x16x32_bf16 v[32:35], a[32:35], a[160:163], v[32:35]
  buffer_load_dwordx4 v4, s[8:11], s3 offen offset:2048 lds
  v_mfma_f32_16x16x32_bf16 v[32:35], a[36:39], a[164:167], v[32:35]
  ds_read_b128 a[176:179], v10 offset:4096
  ds_read_b128 a[180:183], v11 offset:4096
  v_mfma_f32_16x16x32_bf16 v[36:39], a[44:47], a[164:167], v[36:39]
  v_mfma_f32_16x16x32_bf16 v[36:39], a[40:43], a[160:163], v[36:39]
  ds_read_b64_tr_b16 a[96:97], v12 offset:32768
  ds_read_b64_tr_b16 a[98:99], v12 offset:34816
  v_mfma_f32_16x16x32_bf16 v[40:43], a[48:51], a[160:163], v[40:43]
  v_mfma_f32_16x16x32_bf16 v[40:43], a[52:55], a[164:167], v[40:43]
  v_mfma_f32_16x16x32_bf16 v[44:47], a[60:63], a[164:167], v[44:47]
  v_mfma_f32_16x16x32_bf16 v[44:47], a[56:59], a[160:163], v[44:47]
  ds_read_b64_tr_b16 a[104:105], v13 offset:32768
  ds_read_b64_tr_b16 a[106:107], v13 offset:34816
  v_mfma_f32_16x16x32_bf16 v[48:51], a[64:67], a[160:163], v[48:51]
  v_mfma_f32_16x16x32_bf16 v[48:51], a[68:71], a[164:167], v[48:51]
  v_mfma_f32_16x16x32_bf16 v[52:55], a[76:79], a[164:167], v[52:55]
  v_mfma_f32_16x16x32_bf16 v[52:55], a[72:75], a[160:163], v[52:55]
  ds_read_b64_tr_b16 a[112:113], v14 offset:32768
  ds_read_b64_tr_b16 a[114:115], v14 offset:34816
  v_mfma_f32_16x16x32_bf16 v[56:59], a[80:83], a[160:163], v[56:59]
  v_mfma_f32_16x16x32_bf16 v[56:59], a[84:87], a[164:167], v[56:59]
  buffer_load_dwordx4 v5, s[8:11], s3 offen offset:3072 lds
  v_mfma_f32_16x16x32_bf16 v[60:63], a[92:95], a[164:167], v[60:63]
  v_mfma_f32_16x16x32_bf16 v[60:63], a[88:91], a[160:163], v[60:63]
  s_waitcnt lgkmcnt(8)
  ds_read_b64_tr_b16 a[120:121], v15 offset:32768
  ds_read_b64_tr_b16 a[122:123], v15 offset:34816
  v_mfma_f32_16x16x32_bf16 v[64:67], a[32:35], a[168:171], v[64:67]
  v_mfma_f32_16x16x32_bf16 v[64:67], a[36:39], a[172:175], v[64:67]
  ds_read_b128 a[184:187], v10 offset:6144
  ds_read_b128 a[188:191], v11 offset:6144
  v_mfma_f32_16x16x32_bf16 v[68:71], a[44:47], a[172:175], v[68:71]
  v_mfma_f32_16x16x32_bf16 v[68:71], a[40:43], a[168:171], v[68:71]
  ds_read_b64_tr_b16 a[128:129], v16 offset:32768
  ds_read_b64_tr_b16 a[130:131], v16 offset:34816
  v_mfma_f32_16x16x32_bf16 v[72:75], a[48:51], a[168:171], v[72:75]
  v_mfma_f32_16x16x32_bf16 v[72:75], a[52:55], a[172:175], v[72:75]
  v_mfma_f32_16x16x32_bf16 v[76:79], a[60:63], a[172:175], v[76:79]
  v_mfma_f32_16x16x32_bf16 v[76:79], a[56:59], a[168:171], v[76:79]
  ds_read_b64_tr_b16 a[136:137], v17 offset:32768
  ds_read_b64_tr_b16 a[138:139], v17 offset:34816
  v_mfma_f32_16x16x32_bf16 v[80:83], a[64:67], a[168:171], v[80:83]
  v_mfma_f32_16x16x32_bf16 v[80:83], a[68:71], a[172:175], v[80:83]
  v_mfma_f32_16x16x32_bf16 v[84:87], a[76:79], a[172:175], v[84:87]
  s_add_u32 s23, s23, 128
  s_cmp_eq_u32 s23, s25
  s_cselect_b32 s23, s26, s23
  v_mfma_f32_16x16x32_bf16 v[84:87], a[72:75], a[168:171], v[84:87]
  ds_read_b64_tr_b16 a[144:145], v18 offset:32768
  ds_read_b64_tr_b16 a[146:147], v18 offset:34816
  v_mfma_f32_16x16x32_bf16 v[88:91], a[80:83], a[168:171], v[88:91]
  v_mfma_f32_16x16x32_bf16 v[88:91], a[84:87], a[172:175], v[88:91]
  v_mfma_f32_16x16x32_bf16 v[92:95], a[92:95], a[172:175], v[92:95]
  v_mfma_f32_16x16x32_bf16 v[92:95], a[88:91], a[168:171], v[92:95]
  s_waitcnt lgkmcnt(15)
  ds_read_b64_tr_b16 a[152:153], v19 offset:32768
  ds_read_b64_tr_b16 a[154:155], v19 offset:34816
  v_mfma_f32_16x16x32_bf16 v[96:99], a[32:35], a[176:179], v[96:99]
  v_mfma_f32_16x16x32_bf16 v[96:99], a[36:39], a[180:183], v[96:99]
  v_mfma_f32_16x16x32_bf16 v[100:103], a[44:47], a[180:183], v[100:103]
  v_mfma_f32_16x16x32_bf16 v[100:103], a[40:43], a[176:179], v[100:103]
  v_mfma_f32_16x16x32_bf16 v[104:107], a[48:51], a[176:179], v[104:107]
  v_mfma_f32_16x16x32_bf16 v[104:107], a[52:55], a[180:183], v[104:107]
  v_mfma_f32_16x16x32_bf16 v[108:111], a[60:63], a[180:183], v[108:111]
  v_mfma_f32_16x16x32_bf16 v[108:111], a[56:59], a[176:179], v[108:111]
  s_waitcnt vmcnt(8) lgkmcnt(0)
  s_barrier
  ds_read_b128 a[160:163], v10 offset:16384
  ds_read_b128 a[164:167], v11 offset:16384
  v_mfma_f32_16x16x32_bf16 v[112:115], a[64:67], a[176:179], v[112:115]
  v_mfma_f32_16x16x32_bf16 v[112:115], a[68:71], a[180:183], v[112:115]
  s_and_b32 s3, s2, 1
  s_lshl_b32 s3, s3, 3
  s_bfe_u32 s4, s2, 0x30003
  v_mfma_f32_16x16x32_bf16 v[116:119], a[76:79], a[180:183], v[116:119]
  s_add_u32 s26, s3, s4
  s_bfe_u32 s3, s2, 0x20001
  v_mfma_f32_16x16x32_bf16 v[116:119], a[72:75], a[176:179], v[116:119]
  ds_read_b64_tr_b16 a[100:101], v12 offset:49152
  ds_read_b64_tr_b16 a[102:103], v12 offset:51200
  s_lshl_b32 s3, s3, 2
  s_lshr_b32 s4, s2, 6
  s_add_u32 s27, s3, s4
  v_mfma_f32_16x16x32_bf16 v[120:123], a[80:83], a[176:179], v[120:123]
  s_lshl_b32 s23, s26, 18
  s_sub_u32 s24, s23, 32768
  v_mfma_f32_16x16x32_bf16 v[120:123], a[84:87], a[180:183], v[120:123]
  s_max_i32 s24, s24, 0
  s_lshl_b32 s25, s27, 7
  s_xor_b32 s3, s26, s27
  v_mfma_f32_16x16x32_bf16 v[124:127], a[92:95], a[180:183], v[124:127]
  s_and_b32 s3, s3, 0
  s_lshl_b32 s3, s3, 3
  v_mfma_f32_16x16x32_bf16 v[124:127], a[88:91], a[176:179], v[124:127]
  s_sub_u32 s31, 16, s3
  s_mov_b32 s54, s31
  s_movk_i32 s57, 128
  v_mfma_f32_16x16x32_bf16 v[128:131], a[32:35], a[184:187], v[128:131]
  s_mov_b32 s55, 4289069056
  s_mov_b32 s56, 393216
  v_mfma_f32_16x16x32_bf16 v[128:131], a[36:39], a[188:191], v[128:131]
  ds_read_b128 a[168:171], v10 offset:18432
  ds_read_b128 a[172:175], v11 offset:18432
  ds_read_b64_tr_b16 a[108:109], v13 offset:49152
  ds_read_b64_tr_b16 a[110:111], v13 offset:51200
  s_lshl_b32 s4, s3, 7
  s_add_u32 s23, s23, s4
  s_add_u32 s24, s24, s4
  v_mfma_f32_16x16x32_bf16 v[132:135], a[44:47], a[188:191], v[132:135]
  s_mul_i32 s4, s3, 393216
  s_add_u32 s25, s25, s4
  v_mfma_f32_16x16x32_bf16 v[132:135], a[40:43], a[184:187], v[132:135]
  s_mov_b64 s[8:9], s[44:45]
  s_mov_b32 s10, 4194304
  v_mfma_f32_16x16x32_bf16 v[136:139], a[48:51], a[184:187], v[136:139]
  s_mov_b64 s[12:13], s[46:47]
  s_mov_b32 s14, 6291456
  s_lshl_b32 s28, s20, 9
  v_mfma_f32_16x16x32_bf16 v[136:139], a[52:55], a[188:191], v[136:139]
  s_mul_i32 s30, s20, 6144
  s_lshl_b32 s3, s20, 5
  v_mfma_f32_16x16x32_bf16 v[140:143], a[60:63], a[188:191], v[140:143]
  v_lshrrev_b32 v24, 3, v0
  v_and_b32 v25, 7, v0
  v_add_u32 v28, s3, v24
  v_mfma_f32_16x16x32_bf16 v[140:143], a[56:59], a[184:187], v[140:143]
  ds_read_b64_tr_b16 a[116:117], v14 offset:49152
  ds_read_b64_tr_b16 a[118:119], v14 offset:51200
  v_add_u32 v26, 0, v28
  v_bfe_u32 v27, v26, 1, 3
  v_mfma_f32_16x16x32_bf16 v[144:147], a[64:67], a[184:187], v[144:147]
  v_xor_b32 v27, v27, v25
  v_lshlrev_b32 v26, 11, v26
  v_lshl_add_u32 v26, v27, 4, v26
  v_mfma_f32_16x16x32_bf16 v[144:147], a[68:71], a[188:191], v[144:147]
  v_subrev_u32 v2, 0, v26
  v_add_u32 v26, 8, v28
  v_mfma_f32_16x16x32_bf16 v[148:151], a[76:79], a[188:191], v[148:151]
  v_bfe_u32 v27, v26, 1, 3
  v_xor_b32 v27, v27, v25
  v_lshlrev_b32 v26, 11, v26
  v_mfma_f32_16x16x32_bf16 v[148:151], a[72:75], a[184:187], v[148:151]
  v_lshl_add_u32 v26, v27, 4, v26
  v_subrev_u32 v3, 1024, v26
  v_mfma_f32_16x16x32_bf16 v[152:155], a[80:83], a[184:187], v[152:155]
  v_add_u32 v26, 16, v28
  v_bfe_u32 v27, v26, 1, 3
  v_mfma_f32_16x16x32_bf16 v[152:155], a[84:87], a[188:191], v[152:155]
  ds_read_b64_tr_b16 a[124:125], v15 offset:49152
  ds_read_b64_tr_b16 a[126:127], v15 offset:51200
  v_xor_b32 v27, v27, v25
  v_lshlrev_b32 v26, 11, v26
  v_lshl_add_u32 v26, v27, 4, v26
  v_mfma_f32_16x16x32_bf16 v[156:159], a[92:95], a[188:191], v[156:159]
  v_subrev_u32 v4, 2048, v26
  v_add_u32 v26, 24, v28
  v_mfma_f32_16x16x32_bf16 v[156:159], a[88:91], a[184:187], v[156:159]
  s_waitcnt lgkmcnt(10)
  v_bfe_u32 v27, v26, 1, 3
  v_xor_b32 v27, v27, v25
  v_lshlrev_b32 v26, 11, v26
  v_mfma_f32_16x16x32_bf16 v[160:163], a[32:35], a[160:163], v[160:163]
  v_lshl_add_u32 v26, v27, 4, v26
  v_subrev_u32 v5, 3072, v26
  v_mfma_f32_16x16x32_bf16 v[160:163], a[36:39], a[164:167], v[160:163]
  ds_read_b128 a[176:179], v10 offset:20480
  ds_read_b128 a[180:183], v11 offset:20480
  s_lshl_b32 s3, s20, 2
  v_add_u32 v26, s3, v24
  v_bfe_u32 v27, v26, 1, 3
  v_mfma_f32_16x16x32_bf16 v[164:167], a[44:47], a[164:167], v[164:167]
  v_xor_b32 v27, v27, v25
  v_lshlrev_b32 v26, 11, v26
  v_mfma_f32_16x16x32_bf16 v[164:167], a[40:43], a[160:163], v[164:167]
  ds_read_b64_tr_b16 a[132:133], v16 offset:49152
  ds_read_b64_tr_b16 a[134:135], v16 offset:51200
  v_lshl_add_u32 v20, v27, 4, v26
  s_mul_i32 s3, s20, 48
  v_add_u32 v28, s3, v24
  v_mfma_f32_16x16x32_bf16 v[168:171], a[48:51], a[160:163], v[168:171]
  v_add_u32 v26, 0, v28
  v_mul_u32_u24 v27, 0xaaab, v26
  v_mfma_f32_16x16x32_bf16 v[168:171], a[52:55], a[164:167], v[168:171]
  v_lshrrev_b32 v27, 17, v27
  v_lshrrev_b32 v29, 1, v27
  v_mfma_f32_16x16x32_bf16 v[172:175], a[60:63], a[164:167], v[172:175]
  v_and_b32 v29, 4, v29
  v_and_or_b32 v27, v27, 2, v29
  v_xor_b32 v27, v27, v25
  v_mfma_f32_16x16x32_bf16 v[172:175], a[56:59], a[160:163], v[172:175]
  v_lshlrev_b32 v26, 11, v26
  v_lshl_add_u32 v26, v27, 4, v26
  v_mfma_f32_16x16x32_bf16 v[176:179], a[64:67], a[160:163], v[176:179]
  v_subrev_u32 v6, 0, v26
  v_add_u32 v26, 8, v28
  v_mul_u32_u24 v27, 0xaaab, v26
  v_mfma_f32_16x16x32_bf16 v[176:179], a[68:71], a[164:167], v[176:179]
  ds_read_b64_tr_b16 a[140:141], v17 offset:49152
  ds_read_b64_tr_b16 a[142:143], v17 offset:51200
  v_lshrrev_b32 v27, 17, v27
  v_lshrrev_b32 v29, 1, v27
  v_mfma_f32_16x16x32_bf16 v[180:183], a[76:79], a[164:167], v[180:183]
  v_and_b32 v29, 4, v29
  v_and_or_b32 v27, v27, 2, v29
  v_xor_b32 v27, v27, v25
  v_mfma_f32_16x16x32_bf16 v[180:183], a[72:75], a[160:163], v[180:183]
  v_lshlrev_b32 v26, 11, v26
  v_lshl_add_u32 v26, v27, 4, v26
  v_mfma_f32_16x16x32_bf16 v[184:187], a[80:83], a[160:163], v[184:187]
  v_subrev_u32 v7, 1024, v26
  v_add_u32 v26, 16, v28
  v_mul_u32_u24 v27, 0xaaab, v26
  v_mfma_f32_16x16x32_bf16 v[184:187], a[84:87], a[164:167], v[184:187]
  v_lshrrev_b32 v27, 17, v27
  v_lshrrev_b32 v29, 1, v27
  v_mfma_f32_16x16x32_bf16 v[188:191], a[92:95], a[164:167], v[188:191]
  v_and_b32 v29, 4, v29
  v_and_or_b32 v27, v27, 2, v29
  v_xor_b32 v27, v27, v25
  v_mfma_f32_16x16x32_bf16 v[188:191], a[88:91], a[160:163], v[188:191]
  s_waitcnt lgkmcnt(12)
  ds_read_b64_tr_b16 a[148:149], v18 offset:49152
  ds_read_b64_tr_b16 a[150:151], v18 offset:51200
  v_lshlrev_b32 v26, 11, v26
  v_lshl_add_u32 v26, v27, 4, v26
  v_mfma_f32_16x16x32_bf16 v[192:195], a[32:35], a[168:171], v[192:195]
  v_subrev_u32 v8, 2048, v26
  v_add_u32 v26, 24, v28
  v_mfma_f32_16x16x32_bf16 v[192:195], a[36:39], a[172:175], v[192:195]
  ds_read_b128 a[184:187], v10 offset:22528
  ds_read_b128 a[188:191], v11 offset:22528
  v_mul_u32_u24 v27, 0xaaab, v26
  v_lshrrev_b32 v27, 17, v27
  v_lshrrev_b32 v29, 1, v27
  v_mfma_f32_16x16x32_bf16 v[196:199], a[44:47], a[172:175], v[196:199]
  v_and_b32 v29, 4, v29
  v_and_or_b32 v27, v27, 2, v29
  v_mfma_f32_16x16x32_bf16 v[196:199], a[40:43], a[168:171], v[196:199]
  v_xor_b32 v27, v27, v25
  v_lshlrev_b32 v26, 11, v26
  v_lshl_add_u32 v26, v27, 4, v26
  v_mfma_f32_16x16x32_bf16 v[200:203], a[48:51], a[168:171], v[200:203]
  v_subrev_u32 v9, 3072, v26
  v_add_u32 v26, 32, v28
  v_mfma_f32_16x16x32_bf16 v[200:203], a[52:55], a[172:175], v[200:203]
  ds_read_b64_tr_b16 a[156:157], v19 offset:49152
  ds_read_b64_tr_b16 a[158:159], v19 offset:51200
  v_mul_u32_u24 v27, 0xaaab, v26
  v_lshrrev_b32 v27, 17, v27
  v_lshrrev_b32 v29, 1, v27
  v_mfma_f32_16x16x32_bf16 v[204:207], a[60:63], a[172:175], v[204:207]
  v_and_b32 v29, 4, v29
  v_and_or_b32 v27, v27, 2, v29
  v_mfma_f32_16x16x32_bf16 v[204:207], a[56:59], a[168:171], v[204:207]
  v_xor_b32 v27, v27, v25
  v_lshlrev_b32 v26, 11, v26
  v_lshl_add_u32 v26, v27, 4, v26
  v_mfma_f32_16x16x32_bf16 v[208:211], a[64:67], a[168:171], v[208:211]
  v_subrev_u32 v21, 0, v26
  v_add_u32 v26, 40, v28
  v_mfma_f32_16x16x32_bf16 v[208:211], a[68:71], a[172:175], v[208:211]
  v_mul_u32_u24 v27, 0xaaab, v26
  v_lshrrev_b32 v27, 17, v27
  v_mfma_f32_16x16x32_bf16 v[212:215], a[76:79], a[172:175], v[212:215]
  v_lshrrev_b32 v29, 1, v27
  v_and_b32 v29, 4, v29
  v_and_or_b32 v27, v27, 2, v29
  v_mfma_f32_16x16x32_bf16 v[212:215], a[72:75], a[168:171], v[212:215]
  v_xor_b32 v27, v27, v25
  v_lshlrev_b32 v26, 11, v26
  v_mfma_f32_16x16x32_bf16 v[216:219], a[80:83], a[168:171], v[216:219]
  v_lshl_add_u32 v26, v27, 4, v26
  v_subrev_u32 v22, 1024, v26
  s_lshr_b32 s3, s53, 7
  v_mfma_f32_16x16x32_bf16 v[216:219], a[84:87], a[172:175], v[216:219]
  s_add_u32 s3, s3, s22
  s_lshl_b32 s3, s3, 5
  v_mfma_f32_16x16x32_bf16 v[220:223], a[92:95], a[172:175], v[220:223]
  s_lshr_b32 s19, s52, 6
  s_add_u32 s3, s3, s19
  s_lshl_b32 s19, s21, 1
  v_mfma_f32_16x16x32_bf16 v[220:223], a[88:91], a[168:171], v[220:223]
  s_waitcnt lgkmcnt(10)
  s_add_u32 s3, s3, s19
  s_lshl_b32 s92, s3, 14
  v_mfma_f32_16x16x32_bf16 v[224:227], a[32:35], a[176:179], v[224:227]
  s_add_u32 s93, s92, 16384
  s_add_u32 s16, s50, 0
  s_addc_u32 s17, s51, 0
  v_mfma_f32_16x16x32_bf16 v[224:227], a[36:39], a[180:183], v[224:227]
  s_mov_b32 s18, 16777216
  s_mov_b32 s19, 0x00020000
  v_mfma_f32_16x16x32_bf16 v[228:231], a[44:47], a[180:183], v[228:231]
  s_mov_b32 s4, 0x3e0293ee
  s_mov_b32 s5, 0x3e0293ee
  v_mfma_f32_16x16x32_bf16 v[228:231], a[40:43], a[176:179], v[228:231]
  v_mfma_f32_16x16x32_bf16 v[232:235], a[48:51], a[176:179], v[232:235]
  v_mfma_f32_16x16x32_bf16 v[232:235], a[52:55], a[180:183], v[232:235]
  v_mfma_f32_16x16x32_bf16 v[236:239], a[60:63], a[180:183], v[236:239]
  v_mfma_f32_16x16x32_bf16 v[236:239], a[56:59], a[176:179], v[236:239]
  s_waitcnt vmcnt(4) lgkmcnt(0)
  s_barrier
  ds_read_b128 a[160:163], v10 offset:32768
  ds_read_b128 a[164:167], v11 offset:32768
  v_mfma_f32_16x16x32_bf16 v[240:243], a[64:67], a[176:179], v[240:243]
  s_add_u32 m0, s28, 131072
  s_mov_b32 exec_hi, 0
  buffer_load_dwordx4 v20, s[8:11], s24 offen lds
  s_mov_b32 exec_hi, -1
  v_mfma_f32_16x16x32_bf16 v[240:243], a[68:71], a[180:183], v[240:243]
  v_mfma_f32_16x16x32_bf16 v[244:247], a[76:79], a[180:183], v[244:247]
  v_mfma_f32_16x16x32_bf16 v[244:247], a[72:75], a[176:179], v[244:247]
  s_add_u32 m0, s29, 133120
  s_nop 0
  buffer_load_dwordx4 v2, s[8:11], s23 offen offset:0 lds
  v_mfma_f32_16x16x32_bf16 v[248:251], a[80:83], a[176:179], v[248:251]
  v_mfma_f32_16x16x32_bf16 v[248:251], a[84:87], a[180:183], v[248:251]
  v_mfma_f32_16x16x32_bf16 v[252:255], a[92:95], a[180:183], v[252:255]
  v_mfma_f32_16x16x32_bf16 v[252:255], a[88:91], a[176:179], v[252:255]
  v_mfma_f32_16x16x32_bf16 a[0:3], a[32:35], a[184:187], a[0:3]
  buffer_load_dwordx4 v3, s[8:11], s23 offen offset:1024 lds
  v_mfma_f32_16x16x32_bf16 a[0:3], a[36:39], a[188:191], a[0:3]
  ds_read_b128 a[168:171], v10 offset:34816
  ds_read_b128 a[172:175], v11 offset:34816
  v_mfma_f32_16x16x32_bf16 a[4:7], a[44:47], a[188:191], a[4:7]
  v_mfma_f32_16x16x32_bf16 a[4:7], a[40:43], a[184:187], a[4:7]
  v_mfma_f32_16x16x32_bf16 a[8:11], a[48:51], a[184:187], a[8:11]
  buffer_load_dwordx4 v4, s[8:11], s23 offen offset:2048 lds
  v_mfma_f32_16x16x32_bf16 a[8:11], a[52:55], a[188:191], a[8:11]
  v_mfma_f32_16x16x32_bf16 a[12:15], a[60:63], a[188:191], a[12:15]
  v_mfma_f32_16x16x32_bf16 a[12:15], a[56:59], a[184:187], a[12:15]
  v_mfma_f32_16x16x32_bf16 a[16:19], a[64:67], a[184:187], a[16:19]
  buffer_load_dwordx4 v5, s[8:11], s23 offen offset:3072 lds
  v_mfma_f32_16x16x32_bf16 a[16:19], a[68:71], a[188:191], a[16:19]
  v_mfma_f32_16x16x32_bf16 a[20:23], a[76:79], a[188:191], a[20:23]
  v_mfma_f32_16x16x32_bf16 a[20:23], a[72:75], a[184:187], a[20:23]
  s_sub_u32 s31, s31, 1
  s_cmp_eq_u32 s31, 0
  s_cselect_b32 s58, -1920, s57
  s_add_u32 s23, s23, s58
  s_add_u32 s24, s24, s58
  v_mfma_f32_16x16x32_bf16 a[24:27], a[80:83], a[184:187], a[24:27]
  v_mfma_f32_16x16x32_bf16 a[24:27], a[84:87], a[188:191], a[24:27]
  v_mfma_f32_16x16x32_bf16 a[28:31], a[92:95], a[188:191], a[28:31]
  v_mfma_f32_16x16x32_bf16 a[28:31], a[88:91], a[184:187], a[28:31]
  s_waitcnt lgkmcnt(2)
  v_mfma_f32_16x16x32_bf16 v[32:35], a[96:99], a[160:163], v[32:35]
  s_add_u32 m0, s30, 65536
  s_nop 0
  buffer_load_dwordx4 v6, s[12:15], s25 offen offset:0 lds
  v_mfma_f32_16x16x32_bf16 v[32:35], a[100:103], a[164:167], v[32:35]
  ds_read_b128 a[176:179], v10 offset:36864
  ds_read_b128 a[180:183], v11 offset:36864
  v_mfma_f32_16x16x32_bf16 v[36:39], a[108:111], a[164:167], v[36:39]
  v_mfma_f32_16x16x32_bf16 v[36:39], a[104:107], a[160:163], v[36:39]
  v_mfma_f32_16x16x32_bf16 v[40:43], a[112:115], a[160:163], v[40:43]
  v_mfma_f32_16x16x32_bf16 v[40:43], a[116:119], a[164:167], v[40:43]
  buffer_load_dwordx4 v7, s[12:15], s25 offen offset:1024 lds
  v_mfma_f32_16x16x32_bf16 v[44:47], a[124:127], a[164:167], v[44:47]
  v_mfma_f32_16x16x32_bf16 v[44:47], a[120:123], a[160:163], v[44:47]
  v_mfma_f32_16x16x32_bf16 v[48:51], a[128:131], a[160:163], v[48:51]
  v_mfma_f32_16x16x32_bf16 v[48:51], a[132:135], a[164:167], v[48:51]
  v_mfma_f32_16x16x32_bf16 v[52:55], a[140:143], a[164:167], v[52:55]
  buffer_load_dwordx4 v8, s[12:15], s25 offen offset:2048 lds
  v_mfma_f32_16x16x32_bf16 v[52:55], a[136:139], a[160:163], v[52:55]
  v_mfma_f32_16x16x32_bf16 v[56:59], a[144:147], a[160:163], v[56:59]
  v_mfma_f32_16x16x32_bf16 v[56:59], a[148:151], a[164:167], v[56:59]
  v_mfma_f32_16x16x32_bf16 v[60:63], a[156:159], a[164:167], v[60:63]
  v_mfma_f32_16x16x32_bf16 v[60:63], a[152:155], a[160:163], v[60:63]
  s_waitcnt lgkmcnt(2)
  v_mfma_f32_16x16x32_bf16 v[64:67], a[96:99], a[168:171], v[64:67]
  buffer_load_dwordx4 v9, s[12:15], s25 offen offset:3072 lds
  v_mfma_f32_16x16x32_bf16 v[64:67], a[100:103], a[172:175], v[64:67]
  ds_read_b128 a[184:187], v10 offset:38912
  ds_read_b128 a[188:191], v11 offset:38912
  v_mfma_f32_16x16x32_bf16 v[68:71], a[108:111], a[172:175], v[68:71]
  v_mfma_f32_16x16x32_bf16 v[68:71], a[104:107], a[168:171], v[68:71]
  v_pk_mul_f32 v[32:33], v[32:33], s[4:5]
  v_pk_mul_f32 v[34:35], v[34:35], s[4:5]
  v_pk_mul_f32 v[36:37], v[36:37], s[4:5]
  v_mfma_f32_16x16x32_bf16 v[72:75], a[112:115], a[168:171], v[72:75]
  v_pk_mul_f32 v[38:39], v[38:39], s[4:5]
  v_cvt_pk_bf16_f32 v32, v32, v33
  v_mfma_f32_16x16x32_bf16 v[72:75], a[116:119], a[172:175], v[72:75]
  s_add_u32 m0, s30, 69632
  s_nop 0
  buffer_load_dwordx4 v21, s[12:15], s25 offen offset:0 lds
  v_cvt_pk_bf16_f32 v33, v34, v35
  v_cvt_pk_bf16_f32 v34, v36, v37
  v_mfma_f32_16x16x32_bf16 v[76:79], a[124:127], a[172:175], v[76:79]
  v_cvt_pk_bf16_f32 v35, v38, v39
  v_pk_mul_f32 v[40:41], v[40:41], s[4:5]
  v_pk_mul_f32 v[42:43], v[42:43], s[4:5]
  v_mfma_f32_16x16x32_bf16 v[76:79], a[120:123], a[168:171], v[76:79]
  v_pk_mul_f32 v[44:45], v[44:45], s[4:5]
  v_pk_mul_f32 v[46:47], v[46:47], s[4:5]
  v_mfma_f32_16x16x32_bf16 v[80:83], a[128:131], a[168:171], v[80:83]
  v_cvt_pk_bf16_f32 v40, v40, v41
  v_cvt_pk_bf16_f32 v41, v42, v43
  v_mfma_f32_16x16x32_bf16 v[80:83], a[132:135], a[172:175], v[80:83]
  v_cvt_pk_bf16_f32 v42, v44, v45
  v_cvt_pk_bf16_f32 v43, v46, v47
  v_mfma_f32_16x16x32_bf16 v[84:87], a[140:143], a[172:175], v[84:87]
  buffer_load_dwordx4 v22, s[12:15], s25 offen offset:1024 lds
  v_pk_mul_f32 v[48:49], v[48:49], s[4:5]
  v_pk_mul_f32 v[50:51], v[50:51], s[4:5]
  v_pk_mul_f32 v[52:53], v[52:53], s[4:5]
  v_mfma_f32_16x16x32_bf16 v[84:87], a[136:139], a[168:171], v[84:87]
  v_pk_mul_f32 v[54:55], v[54:55], s[4:5]
  v_cvt_pk_bf16_f32 v48, v48, v49
  v_mfma_f32_16x16x32_bf16 v[88:91], a[144:147], a[168:171], v[88:91]
  v_cvt_pk_bf16_f32 v49, v50, v51
  v_cvt_pk_bf16_f32 v50, v52, v53
  v_mfma_f32_16x16x32_bf16 v[88:91], a[148:151], a[172:175], v[88:91]
  v_cvt_pk_bf16_f32 v51, v54, v55
  v_pk_mul_f32 v[56:57], v[56:57], s[4:5]
  v_pk_mul_f32 v[58:59], v[58:59], s[4:5]
  v_mfma_f32_16x16x32_bf16 v[92:95], a[156:159], a[172:175], v[92:95]
  v_pk_mul_f32 v[60:61], v[60:61], s[4:5]
  v_pk_mul_f32 v[62:63], v[62:63], s[4:5]
  v_mfma_f32_16x16x32_bf16 v[92:95], a[152:155], a[168:171], v[92:95]
  s_waitcnt lgkmcnt(2)
  v_cvt_pk_bf16_f32 v56, v56, v57
  v_cvt_pk_bf16_f32 v57, v58, v59
  v_mfma_f32_16x16x32_bf16 v[96:99], a[96:99], a[176:179], v[96:99]
  s_sub_u32 s54, s54, 1
  s_cmp_eq_u32 s54, 0
  s_cselect_b32 s58, s55, s56
  s_add_u32 s25, s25, s58
  v_cvt_pk_bf16_f32 v58, v60, v61
  v_cvt_pk_bf16_f32 v59, v62, v63
  v_mfma_f32_16x16x32_bf16 v[96:99], a[100:103], a[180:183], v[96:99]
  v_mfma_f32_16x16x32_bf16 v[100:103], a[108:111], a[180:183], v[100:103]
  v_mfma_f32_16x16x32_bf16 v[100:103], a[104:107], a[176:179], v[100:103]
  v_pk_mul_f32 v[64:65], v[64:65], s[4:5]
  v_pk_mul_f32 v[66:67], v[66:67], s[4:5]
  v_pk_mul_f32 v[68:69], v[68:69], s[4:5]
  v_mfma_f32_16x16x32_bf16 v[104:107], a[112:115], a[176:179], v[104:107]
  v_pk_mul_f32 v[70:71], v[70:71], s[4:5]
  v_cvt_pk_bf16_f32 v64, v64, v65
  v_mfma_f32_16x16x32_bf16 v[104:107], a[116:119], a[180:183], v[104:107]
  v_cvt_pk_bf16_f32 v65, v66, v67
  v_cvt_pk_bf16_f32 v66, v68, v69
  v_mfma_f32_16x16x32_bf16 v[108:111], a[124:127], a[180:183], v[108:111]
  v_cvt_pk_bf16_f32 v67, v70, v71
  v_pk_mul_f32 v[72:73], v[72:73], s[4:5]
  v_pk_mul_f32 v[74:75], v[74:75], s[4:5]
  v_mfma_f32_16x16x32_bf16 v[108:111], a[120:123], a[176:179], v[108:111]
  s_waitcnt vmcnt(11) lgkmcnt(0)
  s_barrier
  ds_read_b128 a[160:163], v10 offset:49152
  ds_read_b128 a[164:167], v11 offset:49152
  v_pk_mul_f32 v[76:77], v[76:77], s[4:5]
  v_pk_mul_f32 v[78:79], v[78:79], s[4:5]
  v_mfma_f32_16x16x32_bf16 v[112:115], a[128:131], a[176:179], v[112:115]
  s_add_u32 m0, s28, 0
  s_mov_b32 exec_hi, 0
  buffer_load_dwordx4 v20, s[8:11], s24 offen lds
  s_mov_b32 exec_hi, -1
  v_cvt_pk_bf16_f32 v72, v72, v73
  v_cvt_pk_bf16_f32 v73, v74, v75
  v_mfma_f32_16x16x32_bf16 v[112:115], a[132:135], a[180:183], v[112:115]
  v_cvt_pk_bf16_f32 v74, v76, v77
  v_cvt_pk_bf16_f32 v75, v78, v79
  v_mfma_f32_16x16x32_bf16 v[116:119], a[140:143], a[180:183], v[116:119]
  v_pk_mul_f32 v[80:81], v[80:81], s[4:5]
  v_pk_mul_f32 v[82:83], v[82:83], s[4:5]
  v_pk_mul_f32 v[84:85], v[84:85], s[4:5]
  v_mfma_f32_16x16x32_bf16 v[116:119], a[136:139], a[176:179], v[116:119]
  v_pk_mul_f32 v[86:87], v[86:87], s[4:5]
  v_cvt_pk_bf16_f32 v80, v80, v81
  v_mfma_f32_16x16x32_bf16 v[120:123], a[144:147], a[176:179], v[120:123]
  s_add_u32 m0, s29, 2048
  s_nop 0
  buffer_load_dwordx4 v2, s[8:11], s23 offen offset:0 lds
  v_cvt_pk_bf16_f32 v81, v82, v83
  v_cvt_pk_bf16_f32 v82, v84, v85
  v_mfma_f32_16x16x32_bf16 v[120:123], a[148:151], a[180:183], v[120:123]
  v_cvt_pk_bf16_f32 v83, v86, v87
  v_pk_mul_f32 v[88:89], v[88:89], s[4:5]
  v_pk_mul_f32 v[90:91], v[90:91], s[4:5]
  v_mfma_f32_16x16x32_bf16 v[124:127], a[156:159], a[180:183], v[124:127]
  v_pk_mul_f32 v[92:93], v[92:93], s[4:5]
  v_pk_mul_f32 v[94:95], v[94:95], s[4:5]
  v_mfma_f32_16x16x32_bf16 v[124:127], a[152:155], a[176:179], v[124:127]
  v_cvt_pk_bf16_f32 v88, v88, v89
  v_cvt_pk_bf16_f32 v89, v90, v91
  v_mfma_f32_16x16x32_bf16 v[128:131], a[96:99], a[184:187], v[128:131]
  v_cvt_pk_bf16_f32 v90, v92, v93
  v_cvt_pk_bf16_f32 v91, v94, v95
  v_mfma_f32_16x16x32_bf16 v[128:131], a[100:103], a[188:191], v[128:131]
  ds_read_b128 a[168:171], v10 offset:51200
  ds_read_b128 a[172:175], v11 offset:51200
  v_mfma_f32_16x16x32_bf16 v[132:135], a[108:111], a[188:191], v[132:135]
  buffer_load_dwordx4 v3, s[8:11], s23 offen offset:1024 lds
  v_mfma_f32_16x16x32_bf16 v[132:135], a[104:107], a[184:187], v[132:135]
  v_pk_mul_f32 v[96:97], v[96:97], s[4:5]
  v_pk_mul_f32 v[98:99], v[98:99], s[4:5]
  v_pk_mul_f32 v[100:101], v[100:101], s[4:5]
  v_mfma_f32_16x16x32_bf16 v[136:139], a[112:115], a[184:187], v[136:139]
  v_pk_mul_f32 v[102:103], v[102:103], s[4:5]
  v_cvt_pk_bf16_f32 v96, v96, v97
  v_mfma_f32_16x16x32_bf16 v[136:139], a[116:119], a[188:191], v[136:139]
  v_cvt_pk_bf16_f32 v97, v98, v99
  v_cvt_pk_bf16_f32 v98, v100, v101
  v_mfma_f32_16x16x32_bf16 v[140:143], a[124:127], a[188:191], v[140:143]
  buffer_load_dwordx4 v4, s[8:11], s23 offen offset:2048 lds
  v_cvt_pk_bf16_f32 v99, v102, v103
  v_pk_mul_f32 v[104:105], v[104:105], s[4:5]
  v_pk_mul_f32 v[106:107], v[106:107], s[4:5]
  v_mfma_f32_16x16x32_bf16 v[140:143], a[120:123], a[184:187], v[140:143]
  v_pk_mul_f32 v[108:109], v[108:109], s[4:5]
  v_pk_mul_f32 v[110:111], v[110:111], s[4:5]
  v_mfma_f32_16x16x32_bf16 v[144:147], a[128:131], a[184:187], v[144:147]
  v_cvt_pk_bf16_f32 v104, v104, v105
  v_cvt_pk_bf16_f32 v105, v106, v107
  v_mfma_f32_16x16x32_bf16 v[144:147], a[132:135], a[188:191], v[144:147]
  v_cvt_pk_bf16_f32 v106, v108, v109
  v_cvt_pk_bf16_f32 v107, v110, v111
  v_mfma_f32_16x16x32_bf16 v[148:151], a[140:143], a[188:191], v[148:151]
  buffer_load_dwordx4 v5, s[8:11], s23 offen offset:3072 lds
  v_pk_mul_f32 v[112:113], v[112:113], s[4:5]
  v_pk_mul_f32 v[114:115], v[114:115], s[4:5]
  v_pk_mul_f32 v[116:117], v[116:117], s[4:5]
  v_mfma_f32_16x16x32_bf16 v[148:151], a[136:139], a[184:187], v[148:151]
  v_pk_mul_f32 v[118:119], v[118:119], s[4:5]
  v_cvt_pk_bf16_f32 v112, v112, v113
  v_mfma_f32_16x16x32_bf16 v[152:155], a[144:147], a[184:187], v[152:155]
  v_cvt_pk_bf16_f32 v113, v114, v115
  v_cvt_pk_bf16_f32 v114, v116, v117
  v_mfma_f32_16x16x32_bf16 v[152:155], a[148:151], a[188:191], v[152:155]
  v_cvt_pk_bf16_f32 v115, v118, v119
  v_pk_mul_f32 v[120:121], v[120:121], s[4:5]
  v_pk_mul_f32 v[122:123], v[122:123], s[4:5]
  v_mfma_f32_16x16x32_bf16 v[156:159], a[156:159], a[188:191], v[156:159]
  s_sub_u32 s31, s31, 1
  s_cmp_eq_u32 s31, 0
  s_cselect_b32 s58, -1920, s57
  s_add_u32 s23, s23, s58
  s_add_u32 s24, s24, s58
  v_pk_mul_f32 v[124:125], v[124:125], s[4:5]
  v_pk_mul_f32 v[126:127], v[126:127], s[4:5]
  v_mfma_f32_16x16x32_bf16 v[156:159], a[152:155], a[184:187], v[156:159]
  s_waitcnt lgkmcnt(2)
  v_cvt_pk_bf16_f32 v120, v120, v121
  v_cvt_pk_bf16_f32 v121, v122, v123
  v_mfma_f32_16x16x32_bf16 v[160:163], a[96:99], a[160:163], v[160:163]
  v_cvt_pk_bf16_f32 v122, v124, v125
  v_cvt_pk_bf16_f32 v123, v126, v127
  v_mfma_f32_16x16x32_bf16 v[160:163], a[100:103], a[164:167], v[160:163]
  ds_read_b128 a[176:179], v10 offset:53248
  ds_read_b128 a[180:183], v11 offset:53248
  v_mfma_f32_16x16x32_bf16 v[164:167], a[108:111], a[164:167], v[164:167]
  v_mfma_f32_16x16x32_bf16 v[164:167], a[104:107], a[160:163], v[164:167]
  v_pk_mul_f32 v[128:129], v[128:129], s[4:5]
  v_pk_mul_f32 v[130:131], v[130:131], s[4:5]
  v_pk_mul_f32 v[132:133], v[132:133], s[4:5]
  v_mfma_f32_16x16x32_bf16 v[168:171], a[112:115], a[160:163], v[168:171]
  s_add_u32 m0, s30, 98304
  s_nop 0
  buffer_load_dwordx4 v6, s[12:15], s25 offen offset:0 lds
  v_pk_mul_f32 v[134:135], v[134:135], s[4:5]
  v_cvt_pk_bf16_f32 v128, v128, v129
  v_mfma_f32_16x16x32_bf16 v[168:171], a[116:119], a[164:167], v[168:171]
  v_cvt_pk_bf16_f32 v129, v130, v131
  v_cvt_pk_bf16_f32 v130, v132, v133
  v_mfma_f32_16x16x32_bf16 v[172:175], a[124:127], a[164:167], v[172:175]
  v_cvt_pk_bf16_f32 v131, v134, v135
  v_pk_mul_f32 v[136:137], v[136:137], s[4:5]
  v_pk_mul_f32 v[138:139], v[138:139], s[4:5]
  v_mfma_f32_16x16x32_bf16 v[172:175], a[120:123], a[160:163], v[172:175]
  v_pk_mul_f32 v[140:141], v[140:141], s[4:5]
  v_pk_mul_f32 v[142:143], v[142:143], s[4:5]
  v_mfma_f32_16x16x32_bf16 v[176:179], a[128:131], a[160:163], v[176:179]
  v_cvt_pk_bf16_f32 v136, v136, v137
  v_cvt_pk_bf16_f32 v137, v138, v139
  v_mfma_f32_16x16x32_bf16 v[176:179], a[132:135], a[164:167], v[176:179]
  buffer_load_dwordx4 v7, s[12:15], s25 offen offset:1024 lds
  v_cvt_pk_bf16_f32 v138, v140, v141
  v_cvt_pk_bf16_f32 v139, v142, v143
  v_mfma_f32_16x16x32_bf16 v[180:183], a[140:143], a[164:167], v[180:183]
  v_pk_mul_f32 v[144:145], v[144:145], s[4:5]
  v_pk_mul_f32 v[146:147], v[146:147], s[4:5]
  v_pk_mul_f32 v[148:149], v[148:149], s[4:5]
  v_mfma_f32_16x16x32_bf16 v[180:183], a[136:139], a[160:163], v[180:183]
  v_pk_mul_f32 v[150:151], v[150:151], s[4:5]
  v_cvt_pk_bf16_f32 v144, v144, v145
  v_mfma_f32_16x16x32_bf16 v[184:187], a[144:147], a[160:163], v[184:187]
  v_cvt_pk_bf16_f32 v145, v146, v147
  v_cvt_pk_bf16_f32 v146, v148, v149
  v_mfma_f32_16x16x32_bf16 v[184:187], a[148:151], a[164:167], v[184:187]
  buffer_load_dwordx4 v8, s[12:15], s25 offen offset:2048 lds
  v_cvt_pk_bf16_f32 v147, v150, v151
  v_pk_mul_f32 v[152:153], v[152:153], s[4:5]
  v_pk_mul_f32 v[154:155], v[154:155], s[4:5]
  v_mfma_f32_16x16x32_bf16 v[188:191], a[156:159], a[164:167], v[188:191]
  v_pk_mul_f32 v[156:157], v[156:157], s[4:5]
  v_pk_mul_f32 v[158:159], v[158:159], s[4:5]
  v_mfma_f32_16x16x32_bf16 v[188:191], a[152:155], a[160:163], v[188:191]
  s_waitcnt lgkmcnt(2)
  v_cvt_pk_bf16_f32 v152, v152, v153
  v_cvt_pk_bf16_f32 v153, v154, v155
  v_mfma_f32_16x16x32_bf16 v[192:195], a[96:99], a[168:171], v[192:195]
  v_cvt_pk_bf16_f32 v154, v156, v157
  v_cvt_pk_bf16_f32 v155, v158, v159
  v_mfma_f32_16x16x32_bf16 v[192:195], a[100:103], a[172:175], v[192:195]
  ds_read_b128 a[184:187], v10 offset:55296
  ds_read_b128 a[188:191], v11 offset:55296
  v_mfma_f32_16x16x32_bf16 v[196:199], a[108:111], a[172:175], v[196:199]
  v_mfma_f32_16x16x32_bf16 v[196:199], a[104:107], a[168:171], v[196:199]
  buffer_load_dwordx4 v9, s[12:15], s25 offen offset:3072 lds
  v_pk_mul_f32 v[160:161], v[160:161], s[4:5]
  v_pk_mul_f32 v[162:163], v[162:163], s[4:5]
  v_pk_mul_f32 v[164:165], v[164:165], s[4:5]
  v_mfma_f32_16x16x32_bf16 v[200:203], a[112:115], a[168:171], v[200:203]
  v_pk_mul_f32 v[166:167], v[166:167], s[4:5]
  v_cvt_pk_bf16_f32 v160, v160, v161
  v_mfma_f32_16x16x32_bf16 v[200:203], a[116:119], a[172:175], v[200:203]
  v_cvt_pk_bf16_f32 v161, v162, v163
  v_cvt_pk_bf16_f32 v162, v164, v165
  v_mfma_f32_16x16x32_bf16 v[204:207], a[124:127], a[172:175], v[204:207]
  v_cvt_pk_bf16_f32 v163, v166, v167
  v_pk_mul_f32 v[168:169], v[168:169], s[4:5]
  v_pk_mul_f32 v[170:171], v[170:171], s[4:5]
  v_mfma_f32_16x16x32_bf16 v[204:207], a[120:123], a[168:171], v[204:207]
  s_add_u32 m0, s30, 102400
  s_nop 0
  buffer_load_dwordx4 v21, s[12:15], s25 offen offset:0 lds
  v_pk_mul_f32 v[172:173], v[172:173], s[4:5]
  v_pk_mul_f32 v[174:175], v[174:175], s[4:5]
  v_mfma_f32_16x16x32_bf16 v[208:211], a[128:131], a[168:171], v[208:211]
  v_cvt_pk_bf16_f32 v168, v168, v169
  v_cvt_pk_bf16_f32 v169, v170, v171
  v_mfma_f32_16x16x32_bf16 v[208:211], a[132:135], a[172:175], v[208:211]
  v_cvt_pk_bf16_f32 v170, v172, v173
  v_cvt_pk_bf16_f32 v171, v174, v175
  v_mfma_f32_16x16x32_bf16 v[212:215], a[140:143], a[172:175], v[212:215]
  v_pk_mul_f32 v[176:177], v[176:177], s[4:5]
  v_pk_mul_f32 v[178:179], v[178:179], s[4:5]
  v_pk_mul_f32 v[180:181], v[180:181], s[4:5]
  v_mfma_f32_16x16x32_bf16 v[212:215], a[136:139], a[168:171], v[212:215]
  buffer_load_dwordx4 v22, s[12:15], s25 offen offset:1024 lds
  v_pk_mul_f32 v[182:183], v[182:183], s[4:5]
  v_cvt_pk_bf16_f32 v176, v176, v177
  v_mfma_f32_16x16x32_bf16 v[216:219], a[144:147], a[168:171], v[216:219]
  v_cvt_pk_bf16_f32 v177, v178, v179
  v_cvt_pk_bf16_f32 v178, v180, v181
  v_mfma_f32_16x16x32_bf16 v[216:219], a[148:151], a[172:175], v[216:219]
  v_cvt_pk_bf16_f32 v179, v182, v183
  v_pk_mul_f32 v[184:185], v[184:185], s[4:5]
  v_pk_mul_f32 v[186:187], v[186:187], s[4:5]
  v_mfma_f32_16x16x32_bf16 v[220:223], a[156:159], a[172:175], v[220:223]
  v_pk_mul_f32 v[188:189], v[188:189], s[4:5]
  v_pk_mul_f32 v[190:191], v[190:191], s[4:5]
  v_mfma_f32_16x16x32_bf16 v[220:223], a[152:155], a[168:171], v[220:223]
  s_waitcnt lgkmcnt(2)
  v_cvt_pk_bf16_f32 v184, v184, v185
  v_cvt_pk_bf16_f32 v185, v186, v187
  v_mfma_f32_16x16x32_bf16 v[224:227], a[96:99], a[176:179], v[224:227]
  s_sub_u32 s54, s54, 1
  s_cmp_eq_u32 s54, 0
  s_cselect_b32 s58, s55, s56
  s_add_u32 s25, s25, s58
  v_cvt_pk_bf16_f32 v186, v188, v189
  v_cvt_pk_bf16_f32 v187, v190, v191
  v_mfma_f32_16x16x32_bf16 v[224:227], a[100:103], a[180:183], v[224:227]
  v_mfma_f32_16x16x32_bf16 v[228:231], a[108:111], a[180:183], v[228:231]
  v_mfma_f32_16x16x32_bf16 v[228:231], a[104:107], a[176:179], v[228:231]
  v_pk_mul_f32 v[192:193], v[192:193], s[4:5]
  v_pk_mul_f32 v[194:195], v[194:195], s[4:5]
  v_pk_mul_f32 v[196:197], v[196:197], s[4:5]
  v_mfma_f32_16x16x32_bf16 v[232:235], a[112:115], a[176:179], v[232:235]
  v_pk_mul_f32 v[198:199], v[198:199], s[4:5]
  v_cvt_pk_bf16_f32 v192, v192, v193
  v_mfma_f32_16x16x32_bf16 v[232:235], a[116:119], a[180:183], v[232:235]
  v_cvt_pk_bf16_f32 v193, v194, v195
  v_cvt_pk_bf16_f32 v194, v196, v197
  v_mfma_f32_16x16x32_bf16 v[236:239], a[124:127], a[180:183], v[236:239]
  v_cvt_pk_bf16_f32 v195, v198, v199
  v_pk_mul_f32 v[200:201], v[200:201], s[4:5]
  v_pk_mul_f32 v[202:203], v[202:203], s[4:5]
  v_mfma_f32_16x16x32_bf16 v[236:239], a[120:123], a[176:179], v[236:239]
  s_waitcnt vmcnt(63) lgkmcnt(0)
  s_barrier
  v_pk_mul_f32 v[204:205], v[204:205], s[4:5]
  v_pk_mul_f32 v[206:207], v[206:207], s[4:5]
  v_mfma_f32_16x16x32_bf16 v[240:243], a[128:131], a[176:179], v[240:243]
  s_add_u32 m0, s28, 18432
  s_mov_b32 exec_hi, 0
  buffer_load_dwordx4 v20, s[8:11], s24 offen lds
  s_mov_b32 exec_hi, -1
  v_cvt_pk_bf16_f32 v200, v200, v201
  v_cvt_pk_bf16_f32 v201, v202, v203
  v_mfma_f32_16x16x32_bf16 v[240:243], a[132:135], a[180:183], v[240:243]
  v_cvt_pk_bf16_f32 v202, v204, v205
  v_cvt_pk_bf16_f32 v203, v206, v207
  v_mfma_f32_16x16x32_bf16 v[244:247], a[140:143], a[180:183], v[244:247]
  v_pk_mul_f32 v[208:209], v[208:209], s[4:5]
  v_pk_mul_f32 v[210:211], v[210:211], s[4:5]
  v_pk_mul_f32 v[212:213], v[212:213], s[4:5]
  v_mfma_f32_16x16x32_bf16 v[244:247], a[136:139], a[176:179], v[244:247]
  s_add_u32 m0, s29, 20480
  s_nop 0
  buffer_load_dwordx4 v2, s[8:11], s23 offen offset:0 lds
  v_pk_mul_f32 v[214:215], v[214:215], s[4:5]
  v_cvt_pk_bf16_f32 v208, v208, v209
  v_mfma_f32_16x16x32_bf16 v[248:251], a[144:147], a[176:179], v[248:251]
  v_cvt_pk_bf16_f32 v209, v210, v211
  v_cvt_pk_bf16_f32 v210, v212, v213
  v_mfma_f32_16x16x32_bf16 v[248:251], a[148:151], a[180:183], v[248:251]
  v_cvt_pk_bf16_f32 v211, v214, v215
  v_pk_mul_f32 v[216:217], v[216:217], s[4:5]
  v_pk_mul_f32 v[218:219], v[218:219], s[4:5]
  v_mfma_f32_16x16x32_bf16 v[252:255], a[156:159], a[180:183], v[252:255]
  v_pk_mul_f32 v[220:221], v[220:221], s[4:5]
  v_pk_mul_f32 v[222:223], v[222:223], s[4:5]
  v_mfma_f32_16x16x32_bf16 v[252:255], a[152:155], a[176:179], v[252:255]
  v_cvt_pk_bf16_f32 v216, v216, v217
  v_cvt_pk_bf16_f32 v217, v218, v219
  v_mfma_f32_16x16x32_bf16 a[0:3], a[96:99], a[184:187], a[0:3]
  buffer_load_dwordx4 v3, s[8:11], s23 offen offset:1024 lds
  v_cvt_pk_bf16_f32 v218, v220, v221
  v_cvt_pk_bf16_f32 v219, v222, v223
  v_mfma_f32_16x16x32_bf16 a[0:3], a[100:103], a[188:191], a[0:3]
  v_mfma_f32_16x16x32_bf16 a[4:7], a[108:111], a[188:191], a[4:7]
  v_mfma_f32_16x16x32_bf16 a[4:7], a[104:107], a[184:187], a[4:7]
  v_pk_mul_f32 v[224:225], v[224:225], s[4:5]
  v_pk_mul_f32 v[226:227], v[226:227], s[4:5]
  v_pk_mul_f32 v[228:229], v[228:229], s[4:5]
  v_mfma_f32_16x16x32_bf16 a[8:11], a[112:115], a[184:187], a[8:11]
  buffer_load_dwordx4 v4, s[8:11], s23 offen offset:2048 lds
  v_pk_mul_f32 v[230:231], v[230:231], s[4:5]
  v_cvt_pk_bf16_f32 v224, v224, v225
  v_mfma_f32_16x16x32_bf16 a[8:11], a[116:119], a[188:191], a[8:11]
  v_cvt_pk_bf16_f32 v225, v226, v227
  v_cvt_pk_bf16_f32 v226, v228, v229
  v_mfma_f32_16x16x32_bf16 a[12:15], a[124:127], a[188:191], a[12:15]
  v_cvt_pk_bf16_f32 v227, v230, v231
  v_pk_mul_f32 v[232:233], v[232:233], s[4:5]
  v_pk_mul_f32 v[234:235], v[234:235], s[4:5]
  v_mfma_f32_16x16x32_bf16 a[12:15], a[120:123], a[184:187], a[12:15]
  buffer_load_dwordx4 v5, s[8:11], s23 offen offset:3072 lds
  v_pk_mul_f32 v[236:237], v[236:237], s[4:5]
  v_pk_mul_f32 v[238:239], v[238:239], s[4:5]
  v_mfma_f32_16x16x32_bf16 a[16:19], a[128:131], a[184:187], a[16:19]
  v_cvt_pk_bf16_f32 v232, v232, v233
  v_cvt_pk_bf16_f32 v233, v234, v235
  v_mfma_f32_16x16x32_bf16 a[16:19], a[132:135], a[188:191], a[16:19]
  v_cvt_pk_bf16_f32 v234, v236, v237
  v_cvt_pk_bf16_f32 v235, v238, v239
  v_mfma_f32_16x16x32_bf16 a[20:23], a[140:143], a[188:191], a[20:23]
  v_pk_mul_f32 v[240:241], v[240:241], s[4:5]
  v_pk_mul_f32 v[242:243], v[242:243], s[4:5]
  v_pk_mul_f32 v[244:245], v[244:245], s[4:5]
  v_mfma_f32_16x16x32_bf16 a[20:23], a[136:139], a[184:187], a[20:23]
  s_sub_u32 s31, s31, 1
  s_cmp_eq_u32 s31, 0
  s_cselect_b32 s58, -1920, s57
  s_add_u32 s23, s23, s58
  s_add_u32 s24, s24, s58
  v_pk_mul_f32 v[246:247], v[246:247], s[4:5]
  v_cvt_pk_bf16_f32 v240, v240, v241
  v_mfma_f32_16x16x32_bf16 a[24:27], a[144:147], a[184:187], a[24:27]
  v_cvt_pk_bf16_f32 v241, v242, v243
  v_cvt_pk_bf16_f32 v242, v244, v245
  v_mfma_f32_16x16x32_bf16 a[24:27], a[148:151], a[188:191], a[24:27]
  v_cvt_pk_bf16_f32 v243, v246, v247
  v_pk_mul_f32 v[248:249], v[248:249], s[4:5]
  v_pk_mul_f32 v[250:251], v[250:251], s[4:5]
  v_mfma_f32_16x16x32_bf16 a[28:31], a[156:159], a[188:191], a[28:31]
  v_pk_mul_f32 v[252:253], v[252:253], s[4:5]
  v_pk_mul_f32 v[254:255], v[254:255], s[4:5]
  v_mfma_f32_16x16x32_bf16 a[28:31], a[152:155], a[184:187], a[28:31]
  v_cvt_pk_bf16_f32 v248, v248, v249
  v_cvt_pk_bf16_f32 v249, v250, v251
  v_cvt_pk_bf16_f32 v250, v252, v253
  v_cvt_pk_bf16_f32 v251, v254, v255
  v_accvgpr_read_b32 v24, a0
  v_accvgpr_read_b32 v25, a1
  v_accvgpr_read_b32 v26, a2
  v_accvgpr_read_b32 v27, a3
  v_accvgpr_read_b32 v28, a4
  v_accvgpr_read_b32 v29, a5
  v_accvgpr_read_b32 v30, a6
  v_accvgpr_read_b32 v31, a7
  v_pk_mul_f32 v[24:25], v[24:25], s[4:5]
  v_pk_mul_f32 v[26:27], v[26:27], s[4:5]
  v_pk_mul_f32 v[28:29], v[28:29], s[4:5]
  v_pk_mul_f32 v[30:31], v[30:31], s[4:5]
  v_cvt_pk_bf16_f32 v36, v24, v25
  v_cvt_pk_bf16_f32 v37, v26, v27
  v_cvt_pk_bf16_f32 v38, v28, v29
  v_cvt_pk_bf16_f32 v39, v30, v31
  v_accvgpr_read_b32 v24, a8
  v_accvgpr_read_b32 v25, a9
  v_accvgpr_read_b32 v26, a10
  v_accvgpr_read_b32 v27, a11
  v_accvgpr_read_b32 v28, a12
  v_accvgpr_read_b32 v29, a13
  v_accvgpr_read_b32 v30, a14
  v_accvgpr_read_b32 v31, a15
  v_pk_mul_f32 v[24:25], v[24:25], s[4:5]
  v_pk_mul_f32 v[26:27], v[26:27], s[4:5]
  v_pk_mul_f32 v[28:29], v[28:29], s[4:5]
  v_pk_mul_f32 v[30:31], v[30:31], s[4:5]
  v_cvt_pk_bf16_f32 v44, v24, v25
  v_cvt_pk_bf16_f32 v45, v26, v27
  v_cvt_pk_bf16_f32 v46, v28, v29
  v_cvt_pk_bf16_f32 v47, v30, v31
  v_accvgpr_read_b32 v24, a16
  v_accvgpr_read_b32 v25, a17
  v_accvgpr_read_b32 v26, a18
  v_accvgpr_read_b32 v27, a19
  v_accvgpr_read_b32 v28, a20
  v_accvgpr_read_b32 v29, a21
  v_accvgpr_read_b32 v30, a22
  v_accvgpr_read_b32 v31, a23
  v_pk_mul_f32 v[24:25], v[24:25], s[4:5]
  v_pk_mul_f32 v[26:27], v[26:27], s[4:5]
  v_pk_mul_f32 v[28:29], v[28:29], s[4:5]
  v_pk_mul_f32 v[30:31], v[30:31], s[4:5]
  v_cvt_pk_bf16_f32 v52, v24, v25
  v_cvt_pk_bf16_f32 v53, v26, v27
  v_cvt_pk_bf16_f32 v54, v28, v29
  v_cvt_pk_bf16_f32 v55, v30, v31
  v_accvgpr_read_b32 v24, a24
  v_accvgpr_read_b32 v25, a25
  v_accvgpr_read_b32 v26, a26
  v_accvgpr_read_b32 v27, a27
  v_accvgpr_read_b32 v28, a28
  v_accvgpr_read_b32 v29, a29
  v_accvgpr_read_b32 v30, a30
  v_accvgpr_read_b32 v31, a31
  v_pk_mul_f32 v[24:25], v[24:25], s[4:5]
  v_pk_mul_f32 v[26:27], v[26:27], s[4:5]
  v_pk_mul_f32 v[28:29], v[28:29], s[4:5]
  v_pk_mul_f32 v[30:31], v[30:31], s[4:5]
  v_cvt_pk_bf16_f32 v60, v24, v25
  v_cvt_pk_bf16_f32 v61, v26, v27
  v_cvt_pk_bf16_f32 v62, v28, v29
  v_cvt_pk_bf16_f32 v63, v30, v31
  s_branch Lk1_b
Lk1_kv:
  v_mfma_f32_16x16x32_bf16 v[32:35], a[32:35], a[160:163], 0
  s_add_u32 s23, s23, 128
  s_cmp_eq_u32 s23, s25
  s_cselect_b32 s23, s26, s23
  v_mfma_f32_16x16x32_bf16 v[32:35], a[36:39], a[164:167], v[32:35]
  ds_read_b128 a[176:179], v10 offset:4096
  ds_read_b128 a[180:183], v11 offset:4096
  v_mfma_f32_16x16x32_bf16 v[36:39], a[44:47], a[164:167], 0
  v_mfma_f32_16x16x32_bf16 v[36:39], a[40:43], a[160:163], v[36:39]
  ds_read_b64_tr_b16 a[96:97], v12 offset:32768
  ds_read_b64_tr_b16 a[98:99], v12 offset:34816
  v_mfma_f32_16x16x32_bf16 v[40:43], a[48:51], a[160:163], 0
  v_mfma_f32_16x16x32_bf16 v[40:43], a[52:55], a[164:167], v[40:43]
  v_mfma_f32_16x16x32_bf16 v[44:47], a[60:63], a[164:167], 0
  s_add_u32 m0, s29, 81920
  s_nop 0
  buffer_load_dwordx4 v6, s[12:15], s24 offen offset:0 lds
  v_mfma_f32_16x16x32_bf16 v[44:47], a[56:59], a[160:163], v[44:47]
  ds_read_b64_tr_b16 a[104:105], v13 offset:32768
  ds_read_b64_tr_b16 a[106:107], v13 offset:34816
  v_mfma_f32_16x16x32_bf16 v[48:51], a[64:67], a[160:163], 0
  v_mfma_f32_16x16x32_bf16 v[48:51], a[68:71], a[164:167], v[48:51]
  v_mfma_f32_16x16x32_bf16 v[52:55], a[76:79], a[164:167], 0
  v_mfma_f32_16x16x32_bf16 v[52:55], a[72:75], a[160:163], v[52:55]
  ds_read_b64_tr_b16 a[112:113], v14 offset:32768
  ds_read_b64_tr_b16 a[114:115], v14 offset:34816
  v_mfma_f32_16x16x32_bf16 v[56:59], a[80:83], a[160:163], 0
  v_mfma_f32_16x16x32_bf16 v[56:59], a[84:87], a[164:167], v[56:59]
  buffer_load_dwordx4 v7, s[12:15], s24 offen offset:1024 lds
  v_mfma_f32_16x16x32_bf16 v[60:63], a[92:95], a[164:167], 0
  v_mfma_f32_16x16x32_bf16 v[60:63], a[88:91], a[160:163], v[60:63]
  ds_read_b64_tr_b16 a[120:121], v15 offset:32768
  ds_read_b64_tr_b16 a[122:123], v15 offset:34816
  v_mfma_f32_16x16x32_bf16 v[64:67], a[32:35], a[168:171], 0
  v_mfma_f32_16x16x32_bf16 v[64:67], a[36:39], a[172:175], v[64:67]
  ds_read_b128 a[184:187], v10 offset:6144
  ds_read_b128 a[188:191], v11 offset:6144
  v_mfma_f32_16x16x32_bf16 v[68:71], a[44:47], a[172:175], 0
  v_mfma_f32_16x16x32_bf16 v[68:71], a[40:43], a[168:171], v[68:71]
  ds_read_b64_tr_b16 a[128:129], v16 offset:32768
  ds_read_b64_tr_b16 a[130:131], v16 offset:34816
  v_mfma_f32_16x16x32_bf16 v[72:75], a[48:51], a[168:171], 0
  buffer_load_dwordx4 v8, s[12:15], s24 offen offset:2048 lds
  v_mfma_f32_16x16x32_bf16 v[72:75], a[52:55], a[172:175], v[72:75]
  v_mfma_f32_16x16x32_bf16 v[76:79], a[60:63], a[172:175], 0
  v_mfma_f32_16x16x32_bf16 v[76:79], a[56:59], a[168:171], v[76:79]
  ds_read_b64_tr_b16 a[136:137], v17 offset:32768
  ds_read_b64_tr_b16 a[138:139], v17 offset:34816
  v_mfma_f32_16x16x32_bf16 v[80:83], a[64:67], a[168:171], 0
  v_mfma_f32_16x16x32_bf16 v[80:83], a[68:71], a[172:175], v[80:83]
  v_mfma_f32_16x16x32_bf16 v[84:87], a[76:79], a[172:175], 0
  buffer_load_dwordx4 v9, s[12:15], s24 offen offset:3072 lds
  v_mfma_f32_16x16x32_bf16 v[84:87], a[72:75], a[168:171], v[84:87]
  ds_read_b64_tr_b16 a[144:145], v18 offset:32768
  ds_read_b64_tr_b16 a[146:147], v18 offset:34816
  v_mfma_f32_16x16x32_bf16 v[88:91], a[80:83], a[168:171], 0
  v_mfma_f32_16x16x32_bf16 v[88:91], a[84:87], a[172:175], v[88:91]
  v_mfma_f32_16x16x32_bf16 v[92:95], a[92:95], a[172:175], 0
  v_mfma_f32_16x16x32_bf16 v[92:95], a[88:91], a[168:171], v[92:95]
  s_waitcnt lgkmcnt(15)
  ds_read_b64_tr_b16 a[152:153], v19 offset:32768
  ds_read_b64_tr_b16 a[154:155], v19 offset:34816
  v_mfma_f32_16x16x32_bf16 v[96:99], a[32:35], a[176:179], 0
  s_add_u32 s24, s24, 262144
  s_cmp_eq_u32 s24, s27
  s_cselect_b32 s24, s28, s24
  s_sub_u32 s6, s6, 1
  s_cmp_eq_u32 s6, 0
  s_cselect_b64 s[12:13], s[64:65], s[12:13]
  v_mfma_f32_16x16x32_bf16 v[96:99], a[36:39], a[180:183], v[96:99]
  v_mfma_f32_16x16x32_bf16 v[100:103], a[44:47], a[180:183], 0
  v_mfma_f32_16x16x32_bf16 v[100:103], a[40:43], a[176:179], v[100:103]
  v_mfma_f32_16x16x32_bf16 v[104:107], a[48:51], a[176:179], 0
  v_mfma_f32_16x16x32_bf16 v[104:107], a[52:55], a[180:183], v[104:107]
  v_mfma_f32_16x16x32_bf16 v[108:111], a[60:63], a[180:183], 0
  v_mfma_f32_16x16x32_bf16 v[108:111], a[56:59], a[176:179], v[108:111]
  s_waitcnt vmcnt(17) lgkmcnt(0)
  s_barrier
  ds_read_b128 a[160:163], v10 offset:16384
  ds_read_b128 a[164:167], v11 offset:16384
  v_mfma_f32_16x16x32_bf16 v[112:115], a[64:67], a[176:179], 0
  s_add_u32 m0, s29, 0
  s_nop 0
  buffer_load_dwordx4 v2, s[8:11], s23 offen offset:0 lds
  v_mfma_f32_16x16x32_bf16 v[112:115], a[68:71], a[180:183], v[112:115]
  v_mfma_f32_16x16x32_bf16 v[116:119], a[76:79], a[180:183], 0
  v_mfma_f32_16x16x32_bf16 v[116:119], a[72:75], a[176:179], v[116:119]
  ds_read_b64_tr_b16 a[100:101], v12 offset:49152
  ds_read_b64_tr_b16 a[102:103], v12 offset:51200
  v_mfma_f32_16x16x32_bf16 v[120:123], a[80:83], a[176:179], 0
  v_mfma_f32_16x16x32_bf16 v[120:123], a[84:87], a[180:183], v[120:123]
  buffer_load_dwordx4 v3, s[8:11], s23 offen offset:1024 lds
  v_mfma_f32_16x16x32_bf16 v[124:127], a[92:95], a[180:183], 0
  v_mfma_f32_16x16x32_bf16 v[124:127], a[88:91], a[176:179], v[124:127]
  v_mfma_f32_16x16x32_bf16 v[128:131], a[32:35], a[184:187], 0
  v_mfma_f32_16x16x32_bf16 v[128:131], a[36:39], a[188:191], v[128:131]
  ds_read_b128 a[168:171], v10 offset:18432
  ds_read_b128 a[172:175], v11 offset:18432
  ds_read_b64_tr_b16 a[108:109], v13 offset:49152
  ds_read_b64_tr_b16 a[110:111], v13 offset:51200
  v_mfma_f32_16x16x32_bf16 v[132:135], a[44:47], a[188:191], 0
  v_mfma_f32_16x16x32_bf16 v[132:135], a[40:43], a[184:187], v[132:135]
  buffer_load_dwordx4 v4, s[8:11], s23 offen offset:2048 lds
  v_mfma_f32_16x16x32_bf16 v[136:139], a[48:51], a[184:187], 0
  v_mfma_f32_16x16x32_bf16 v[136:139], a[52:55], a[188:191], v[136:139]
  v_mfma_f32_16x16x32_bf16 v[140:143], a[60:63], a[188:191], 0
  v_mfma_f32_16x16x32_bf16 v[140:143], a[56:59], a[184:187], v[140:143]
  ds_read_b64_tr_b16 a[116:117], v14 offset:49152
  ds_read_b64_tr_b16 a[118:119], v14 offset:51200
  v_mfma_f32_16x16x32_bf16 v[144:147], a[64:67], a[184:187], 0
  v_mfma_f32_16x16x32_bf16 v[144:147], a[68:71], a[188:191], v[144:147]
  buffer_load_dwordx4 v5, s[8:11], s23 offen offset:3072 lds
  v_mfma_f32_16x16x32_bf16 v[148:151], a[76:79], a[188:191], 0
  v_mfma_f32_16x16x32_bf16 v[148:151], a[72:75], a[184:187], v[148:151]
  v_mfma_f32_16x16x32_bf16 v[152:155], a[80:83], a[184:187], 0
  v_mfma_f32_16x16x32_bf16 v[152:155], a[84:87], a[188:191], v[152:155]
  ds_read_b64_tr_b16 a[124:125], v15 offset:49152
  ds_read_b64_tr_b16 a[126:127], v15 offset:51200
  v_mfma_f32_16x16x32_bf16 v[156:159], a[92:95], a[188:191], 0
  s_add_u32 m0, s29, 98304
  s_nop 0
  buffer_load_dwordx4 v6, s[12:15], s24 offen offset:0 lds
  v_mfma_f32_16x16x32_bf16 v[156:159], a[88:91], a[184:187], v[156:159]
  s_waitcnt lgkmcnt(10)
  v_mfma_f32_16x16x32_bf16 v[160:163], a[32:35], a[160:163], 0
  v_mfma_f32_16x16x32_bf16 v[160:163], a[36:39], a[164:167], v[160:163]
  ds_read_b128 a[176:179], v10 offset:20480
  ds_read_b128 a[180:183], v11 offset:20480
  v_mfma_f32_16x16x32_bf16 v[164:167], a[44:47], a[164:167], 0
  v_mfma_f32_16x16x32_bf16 v[164:167], a[40:43], a[160:163], v[164:167]
  ds_read_b64_tr_b16 a[132:133], v16 offset:49152
  ds_read_b64_tr_b16 a[134:135], v16 offset:51200
  v_mfma_f32_16x16x32_bf16 v[168:171], a[48:51], a[160:163], 0
  v_mfma_f32_16x16x32_bf16 v[168:171], a[52:55], a[164:167], v[168:171]
  buffer_load_dwordx4 v7, s[12:15], s24 offen offset:1024 lds
  v_mfma_f32_16x16x32_bf16 v[172:175], a[60:63], a[164:167], 0
  v_mfma_f32_16x16x32_bf16 v[172:175], a[56:59], a[160:163], v[172:175]
  v_mfma_f32_16x16x32_bf16 v[176:179], a[64:67], a[160:163], 0
  v_mfma_f32_16x16x32_bf16 v[176:179], a[68:71], a[164:167], v[176:179]
  ds_read_b64_tr_b16 a[140:141], v17 offset:49152
  ds_read_b64_tr_b16 a[142:143], v17 offset:51200
  v_mfma_f32_16x16x32_bf16 v[180:183], a[76:79], a[164:167], 0
  v_mfma_f32_16x16x32_bf16 v[180:183], a[72:75], a[160:163], v[180:183]
  buffer_load_dwordx4 v8, s[12:15], s24 offen offset:2048 lds
  v_mfma_f32_16x16x32_bf16 v[184:187], a[80:83], a[160:163], 0
  v_mfma_f32_16x16x32_bf16 v[184:187], a[84:87], a[164:167], v[184:187]
  v_mfma_f32_16x16x32_bf16 v[188:191], a[92:95], a[164:167], 0
  v_mfma_f32_16x16x32_bf16 v[188:191], a[88:91], a[160:163], v[188:191]
  s_waitcnt lgkmcnt(12)
  ds_read_b64_tr_b16 a[148:149], v18 offset:49152
  ds_read_b64_tr_b16 a[150:151], v18 offset:51200
  v_mfma_f32_16x16x32_bf16 v[192:195], a[32:35], a[168:171], 0
  buffer_load_dwordx4 v9, s[12:15], s24 offen offset:3072 lds
  v_mfma_f32_16x16x32_bf16 v[192:195], a[36:39], a[172:175], v[192:195]
  ds_read_b128 a[184:187], v10 offset:22528
  ds_read_b128 a[188:191], v11 offset:22528
  v_mfma_f32_16x16x32_bf16 v[196:199], a[44:47], a[172:175], 0
  v_mfma_f32_16x16x32_bf16 v[196:199], a[40:43], a[168:171], v[196:199]
  v_mfma_f32_16x16x32_bf16 v[200:203], a[48:51], a[168:171], 0
  v_mfma_f32_16x16x32_bf16 v[200:203], a[52:55], a[172:175], v[200:203]
  ds_read_b64_tr_b16 a[156:157], v19 offset:49152
  ds_read_b64_tr_b16 a[158:159], v19 offset:51200
  v_mfma_f32_16x16x32_bf16 v[204:207], a[60:63], a[172:175], 0
  s_add_u32 s24, s24, 262144
  v_mfma_f32_16x16x32_bf16 v[204:207], a[56:59], a[168:171], v[204:207]
  v_mfma_f32_16x16x32_bf16 v[208:211], a[64:67], a[168:171], 0
  v_mfma_f32_16x16x32_bf16 v[208:211], a[68:71], a[172:175], v[208:211]
  v_mfma_f32_16x16x32_bf16 v[212:215], a[76:79], a[172:175], 0
  v_mfma_f32_16x16x32_bf16 v[212:215], a[72:75], a[168:171], v[212:215]
  buffer_load_dword v21, v20, s[60:63], s54 offen
  s_add_u32 s54, s54, s55
  v_mfma_f32_16x16x32_bf16 v[216:219], a[80:83], a[168:171], 0
  v_mfma_f32_16x16x32_bf16 v[216:219], a[84:87], a[172:175], v[216:219]
  v_mfma_f32_16x16x32_bf16 v[220:223], a[92:95], a[172:175], 0
  v_mfma_f32_16x16x32_bf16 v[220:223], a[88:91], a[168:171], v[220:223]
  s_waitcnt lgkmcnt(10)
  v_mfma_f32_16x16x32_bf16 v[224:227], a[32:35], a[176:179], 0
  s_cmp_eq_u32 s54, s56
  s_cselect_b32 s54, s57, s54
  s_cselect_b64 s[60:61], s[58:59], s[60:61]
  s_cselect_b32 s62, s7, s62
  v_mfma_f32_16x16x32_bf16 v[224:227], a[36:39], a[180:183], v[224:227]
  v_mfma_f32_16x16x32_bf16 v[228:231], a[44:47], a[180:183], 0
  v_mfma_f32_16x16x32_bf16 v[228:231], a[40:43], a[176:179], v[228:231]
  v_mfma_f32_16x16x32_bf16 v[232:235], a[48:51], a[176:179], 0
  v_mfma_f32_16x16x32_bf16 v[232:235], a[52:55], a[180:183], v[232:235]
  v_mfma_f32_16x16x32_bf16 v[236:239], a[60:63], a[180:183], 0
  v_mfma_f32_16x16x32_bf16 v[236:239], a[56:59], a[176:179], v[236:239]
  s_waitcnt vmcnt(17) lgkmcnt(0)
  s_barrier
  ds_read_b128 a[160:163], v10 offset:32768
  ds_read_b128 a[164:167], v11 offset:32768
  v_mfma_f32_16x16x32_bf16 v[240:243], a[64:67], a[176:179], 0
  s_add_u32 m0, s29, 16384
  s_add_u32 s3, s23, s31
  buffer_load_dwordx4 v2, s[8:11], s3 offen offset:0 lds
  v_mfma_f32_16x16x32_bf16 v[240:243], a[68:71], a[180:183], v[240:243]
  v_mfma_f32_16x16x32_bf16 v[244:247], a[76:79], a[180:183], 0
  v_mfma_f32_16x16x32_bf16 v[244:247], a[72:75], a[176:179], v[244:247]
  v_mfma_f32_16x16x32_bf16 v[248:251], a[80:83], a[176:179], 0
  v_mfma_f32_16x16x32_bf16 v[248:251], a[84:87], a[180:183], v[248:251]
  buffer_load_dwordx4 v3, s[8:11], s3 offen offset:1024 lds
  v_mfma_f32_16x16x32_bf16 v[252:255], a[92:95], a[180:183], 0
  v_mfma_f32_16x16x32_bf16 v[252:255], a[88:91], a[176:179], v[252:255]
  v_mfma_f32_16x16x32_bf16 a[0:3], a[32:35], a[184:187], 0
  v_mfma_f32_16x16x32_bf16 a[0:3], a[36:39], a[188:191], a[0:3]
  ds_read_b128 a[168:171], v10 offset:34816
  ds_read_b128 a[172:175], v11 offset:34816
  v_mfma_f32_16x16x32_bf16 a[4:7], a[44:47], a[188:191], 0
  v_mfma_f32_16x16x32_bf16 a[4:7], a[40:43], a[184:187], a[4:7]
  v_mfma_f32_16x16x32_bf16 a[8:11], a[48:51], a[184:187], 0
  buffer_load_dwordx4 v4, s[8:11], s3 offen offset:2048 lds
  v_mfma_f32_16x16x32_bf16 a[8:11], a[52:55], a[188:191], a[8:11]
  v_mfma_f32_16x16x32_bf16 a[12:15], a[60:63], a[188:191], 0
  v_mfma_f32_16x16x32_bf16 a[12:15], a[56:59], a[184:187], a[12:15]
  v_mfma_f32_16x16x32_bf16 a[16:19], a[64:67], a[184:187], 0
  v_mfma_f32_16x16x32_bf16 a[16:19], a[68:71], a[188:191], a[16:19]
  buffer_load_dwordx4 v5, s[8:11], s3 offen offset:3072 lds
  v_mfma_f32_16x16x32_bf16 a[20:23], a[76:79], a[188:191], 0
  v_mfma_f32_16x16x32_bf16 a[20:23], a[72:75], a[184:187], a[20:23]
  v_mfma_f32_16x16x32_bf16 a[24:27], a[80:83], a[184:187], 0
  v_mfma_f32_16x16x32_bf16 a[24:27], a[84:87], a[188:191], a[24:27]
  v_mfma_f32_16x16x32_bf16 a[28:31], a[92:95], a[188:191], 0
  v_mfma_f32_16x16x32_bf16 a[28:31], a[88:91], a[184:187], a[28:31]
  s_waitcnt lgkmcnt(2)
  v_mfma_f32_16x16x32_bf16 v[32:35], a[96:99], a[160:163], v[32:35]
  s_add_u32 s23, s23, 128
  s_cmp_eq_u32 s23, s25
  s_cselect_b32 s23, s26, s23
  v_mfma_f32_16x16x32_bf16 v[32:35], a[100:103], a[164:167], v[32:35]
  ds_read_b128 a[176:179], v10 offset:36864
  ds_read_b128 a[180:183], v11 offset:36864
  v_mfma_f32_16x16x32_bf16 v[36:39], a[108:111], a[164:167], v[36:39]
  v_mfma_f32_16x16x32_bf16 v[36:39], a[104:107], a[160:163], v[36:39]
  ds_read_b64_tr_b16 a[32:33], v12 offset:0
  ds_read_b64_tr_b16 a[34:35], v12 offset:2048
  v_mfma_f32_16x16x32_bf16 v[40:43], a[112:115], a[160:163], v[40:43]
  v_mfma_f32_16x16x32_bf16 v[40:43], a[116:119], a[164:167], v[40:43]
  v_mfma_f32_16x16x32_bf16 v[44:47], a[124:127], a[164:167], v[44:47]
  s_add_u32 m0, s29, 114688
  s_nop 0
  buffer_load_dwordx4 v6, s[12:15], s24 offen offset:0 lds
  v_mfma_f32_16x16x32_bf16 v[44:47], a[120:123], a[160:163], v[44:47]
  ds_read_b64_tr_b16 a[40:41], v13 offset:0
  ds_read_b64_tr_b16 a[42:43], v13 offset:2048
  v_mfma_f32_16x16x32_bf16 v[48:51], a[128:131], a[160:163], v[48:51]
  v_mfma_f32_16x16x32_bf16 v[48:51], a[132:135], a[164:167], v[48:51]
  v_mfma_f32_16x16x32_bf16 v[52:55], a[140:143], a[164:167], v[52:55]
  v_mfma_f32_16x16x32_bf16 v[52:55], a[136:139], a[160:163], v[52:55]
  ds_read_b64_tr_b16 a[48:49], v14 offset:0
  ds_read_b64_tr_b16 a[50:51], v14 offset:2048
  v_mfma_f32_16x16x32_bf16 v[56:59], a[144:147], a[160:163], v[56:59]
  v_mfma_f32_16x16x32_bf16 v[56:59], a[148:151], a[164:167], v[56:59]
  buffer_load_dwordx4 v7, s[12:15], s24 offen offset:1024 lds
  v_mfma_f32_16x16x32_bf16 v[60:63], a[156:159], a[164:167], v[60:63]
  v_mfma_f32_16x16x32_bf16 v[60:63], a[152:155], a[160:163], v[60:63]
  s_waitcnt lgkmcnt(8)
  ds_read_b64_tr_b16 a[56:57], v15 offset:0
  ds_read_b64_tr_b16 a[58:59], v15 offset:2048
  v_mfma_f32_16x16x32_bf16 v[64:67], a[96:99], a[168:171], v[64:67]
  v_mfma_f32_16x16x32_bf16 v[64:67], a[100:103], a[172:175], v[64:67]
  ds_read_b128 a[184:187], v10 offset:38912
  ds_read_b128 a[188:191], v11 offset:38912
  v_mfma_f32_16x16x32_bf16 v[68:71], a[108:111], a[172:175], v[68:71]
  v_mfma_f32_16x16x32_bf16 v[68:71], a[104:107], a[168:171], v[68:71]
  ds_read_b64_tr_b16 a[64:65], v16 offset:0
  ds_read_b64_tr_b16 a[66:67], v16 offset:2048
  v_mfma_f32_16x16x32_bf16 v[72:75], a[112:115], a[168:171], v[72:75]
  buffer_load_dwordx4 v8, s[12:15], s24 offen offset:2048 lds
  v_mfma_f32_16x16x32_bf16 v[72:75], a[116:119], a[172:175], v[72:75]
  v_mfma_f32_16x16x32_bf16 v[76:79], a[124:127], a[172:175], v[76:79]
  v_mfma_f32_16x16x32_bf16 v[76:79], a[120:123], a[168:171], v[76:79]
  ds_read_b64_tr_b16 a[72:73], v17 offset:0
  ds_read_b64_tr_b16 a[74:75], v17 offset:2048
  v_mfma_f32_16x16x32_bf16 v[80:83], a[128:131], a[168:171], v[80:83]
  v_mfma_f32_16x16x32_bf16 v[80:83], a[132:135], a[172:175], v[80:83]
  v_mfma_f32_16x16x32_bf16 v[84:87], a[140:143], a[172:175], v[84:87]
  buffer_load_dwordx4 v9, s[12:15], s24 offen offset:3072 lds
  v_mfma_f32_16x16x32_bf16 v[84:87], a[136:139], a[168:171], v[84:87]
  ds_read_b64_tr_b16 a[80:81], v18 offset:0
  ds_read_b64_tr_b16 a[82:83], v18 offset:2048
  v_mfma_f32_16x16x32_bf16 v[88:91], a[144:147], a[168:171], v[88:91]
  v_mfma_f32_16x16x32_bf16 v[88:91], a[148:151], a[172:175], v[88:91]
  v_mfma_f32_16x16x32_bf16 v[92:95], a[156:159], a[172:175], v[92:95]
  v_mfma_f32_16x16x32_bf16 v[92:95], a[152:155], a[168:171], v[92:95]
  s_waitcnt lgkmcnt(15)
  ds_read_b64_tr_b16 a[88:89], v19 offset:0
  ds_read_b64_tr_b16 a[90:91], v19 offset:2048
  v_mfma_f32_16x16x32_bf16 v[96:99], a[96:99], a[176:179], v[96:99]
  s_add_u32 s24, s24, 262144
  s_cmp_eq_u32 s24, s27
  s_cselect_b32 s24, s28, s24
  s_sub_u32 s6, s6, 1
  s_cmp_eq_u32 s6, 0
  s_cselect_b64 s[12:13], s[64:65], s[12:13]
  v_mfma_f32_16x16x32_bf16 v[96:99], a[100:103], a[180:183], v[96:99]
  v_mfma_f32_16x16x32_bf16 v[100:103], a[108:111], a[180:183], v[100:103]
  v_mfma_f32_16x16x32_bf16 v[100:103], a[104:107], a[176:179], v[100:103]
  v_mfma_f32_16x16x32_bf16 v[104:107], a[112:115], a[176:179], v[104:107]
  v_mfma_f32_16x16x32_bf16 v[104:107], a[116:119], a[180:183], v[104:107]
  v_mfma_f32_16x16x32_bf16 v[108:111], a[124:127], a[180:183], v[108:111]
  v_mfma_f32_16x16x32_bf16 v[108:111], a[120:123], a[176:179], v[108:111]
  s_waitcnt vmcnt(17) lgkmcnt(0)
  s_barrier
  ds_read_b128 a[160:163], v10 offset:49152
  ds_read_b128 a[164:167], v11 offset:49152
  v_mfma_f32_16x16x32_bf16 v[112:115], a[128:131], a[176:179], v[112:115]
  s_add_u32 m0, s29, 32768
  s_nop 0
  buffer_load_dwordx4 v2, s[8:11], s23 offen offset:0 lds
  v_mfma_f32_16x16x32_bf16 v[112:115], a[132:135], a[180:183], v[112:115]
  v_mfma_f32_16x16x32_bf16 v[116:119], a[140:143], a[180:183], v[116:119]
  v_mfma_f32_16x16x32_bf16 v[116:119], a[136:139], a[176:179], v[116:119]
  ds_read_b64_tr_b16 a[36:37], v12 offset:16384
  ds_read_b64_tr_b16 a[38:39], v12 offset:18432
  v_mfma_f32_16x16x32_bf16 v[120:123], a[144:147], a[176:179], v[120:123]
  v_mfma_f32_16x16x32_bf16 v[120:123], a[148:151], a[180:183], v[120:123]
  buffer_load_dwordx4 v3, s[8:11], s23 offen offset:1024 lds
  v_mfma_f32_16x16x32_bf16 v[124:127], a[156:159], a[180:183], v[124:127]
  v_mfma_f32_16x16x32_bf16 v[124:127], a[152:155], a[176:179], v[124:127]
  v_mfma_f32_16x16x32_bf16 v[128:131], a[96:99], a[184:187], v[128:131]
  v_mfma_f32_16x16x32_bf16 v[128:131], a[100:103], a[188:191], v[128:131]
  ds_read_b128 a[168:171], v10 offset:51200
  ds_read_b128 a[172:175], v11 offset:51200
  ds_read_b64_tr_b16 a[44:45], v13 offset:16384
  ds_read_b64_tr_b16 a[46:47], v13 offset:18432
  v_mfma_f32_16x16x32_bf16 v[132:135], a[108:111], a[188:191], v[132:135]
  v_mfma_f32_16x16x32_bf16 v[132:135], a[104:107], a[184:187], v[132:135]
  buffer_load_dwordx4 v4, s[8:11], s23 offen offset:2048 lds
  v_mfma_f32_16x16x32_bf16 v[136:139], a[112:115], a[184:187], v[136:139]
  v_mfma_f32_16x16x32_bf16 v[136:139], a[116:119], a[188:191], v[136:139]
  v_mfma_f32_16x16x32_bf16 v[140:143], a[124:127], a[188:191], v[140:143]
  v_mfma_f32_16x16x32_bf16 v[140:143], a[120:123], a[184:187], v[140:143]
  ds_read_b64_tr_b16 a[52:53], v14 offset:16384
  ds_read_b64_tr_b16 a[54:55], v14 offset:18432
  v_mfma_f32_16x16x32_bf16 v[144:147], a[128:131], a[184:187], v[144:147]
  v_mfma_f32_16x16x32_bf16 v[144:147], a[132:135], a[188:191], v[144:147]
  buffer_load_dwordx4 v5, s[8:11], s23 offen offset:3072 lds
  v_mfma_f32_16x16x32_bf16 v[148:151], a[140:143], a[188:191], v[148:151]
  v_mfma_f32_16x16x32_bf16 v[148:151], a[136:139], a[184:187], v[148:151]
  v_mfma_f32_16x16x32_bf16 v[152:155], a[144:147], a[184:187], v[152:155]
  v_mfma_f32_16x16x32_bf16 v[152:155], a[148:151], a[188:191], v[152:155]
  ds_read_b64_tr_b16 a[60:61], v15 offset:16384
  ds_read_b64_tr_b16 a[62:63], v15 offset:18432
  v_mfma_f32_16x16x32_bf16 v[156:159], a[156:159], a[188:191], v[156:159]
  s_add_u32 m0, s29, 65536
  s_nop 0
  buffer_load_dwordx4 v6, s[12:15], s24 offen offset:0 lds
  v_mfma_f32_16x16x32_bf16 v[156:159], a[152:155], a[184:187], v[156:159]
  s_waitcnt lgkmcnt(10)
  v_mfma_f32_16x16x32_bf16 v[160:163], a[96:99], a[160:163], v[160:163]
  v_mfma_f32_16x16x32_bf16 v[160:163], a[100:103], a[164:167], v[160:163]
  ds_read_b128 a[176:179], v10 offset:53248
  ds_read_b128 a[180:183], v11 offset:53248
  v_mfma_f32_16x16x32_bf16 v[164:167], a[108:111], a[164:167], v[164:167]
  v_mfma_f32_16x16x32_bf16 v[164:167], a[104:107], a[160:163], v[164:167]
  ds_read_b64_tr_b16 a[68:69], v16 offset:16384
  ds_read_b64_tr_b16 a[70:71], v16 offset:18432
  v_mfma_f32_16x16x32_bf16 v[168:171], a[112:115], a[160:163], v[168:171]
  v_mfma_f32_16x16x32_bf16 v[168:171], a[116:119], a[164:167], v[168:171]
  buffer_load_dwordx4 v7, s[12:15], s24 offen offset:1024 lds
  v_mfma_f32_16x16x32_bf16 v[172:175], a[124:127], a[164:167], v[172:175]
  v_mfma_f32_16x16x32_bf16 v[172:175], a[120:123], a[160:163], v[172:175]
  v_mfma_f32_16x16x32_bf16 v[176:179], a[128:131], a[160:163], v[176:179]
  v_mfma_f32_16x16x32_bf16 v[176:179], a[132:135], a[164:167], v[176:179]
  ds_read_b64_tr_b16 a[76:77], v17 offset:16384
  ds_read_b64_tr_b16 a[78:79], v17 offset:18432
  v_mfma_f32_16x16x32_bf16 v[180:183], a[140:143], a[164:167], v[180:183]
  v_mfma_f32_16x16x32_bf16 v[180:183], a[136:139], a[160:163], v[180:183]
  buffer_load_dwordx4 v8, s[12:15], s24 offen offset:2048 lds
  v_mfma_f32_16x16x32_bf16 v[184:187], a[144:147], a[160:163], v[184:187]
  v_mfma_f32_16x16x32_bf16 v[184:187], a[148:151], a[164:167], v[184:187]
  v_mfma_f32_16x16x32_bf16 v[188:191], a[156:159], a[164:167], v[188:191]
  v_mfma_f32_16x16x32_bf16 v[188:191], a[152:155], a[160:163], v[188:191]
  s_waitcnt lgkmcnt(12)
  ds_read_b64_tr_b16 a[84:85], v18 offset:16384
  ds_read_b64_tr_b16 a[86:87], v18 offset:18432
  v_mfma_f32_16x16x32_bf16 v[192:195], a[96:99], a[168:171], v[192:195]
  buffer_load_dwordx4 v9, s[12:15], s24 offen offset:3072 lds
  v_mfma_f32_16x16x32_bf16 v[192:195], a[100:103], a[172:175], v[192:195]
  ds_read_b128 a[184:187], v10 offset:55296
  ds_read_b128 a[188:191], v11 offset:55296
  v_mfma_f32_16x16x32_bf16 v[196:199], a[108:111], a[172:175], v[196:199]
  v_mfma_f32_16x16x32_bf16 v[196:199], a[104:107], a[168:171], v[196:199]
  v_mfma_f32_16x16x32_bf16 v[200:203], a[112:115], a[168:171], v[200:203]
  v_mfma_f32_16x16x32_bf16 v[200:203], a[116:119], a[172:175], v[200:203]
  ds_read_b64_tr_b16 a[92:93], v19 offset:16384
  ds_read_b64_tr_b16 a[94:95], v19 offset:18432
  v_mfma_f32_16x16x32_bf16 v[204:207], a[124:127], a[172:175], v[204:207]
  s_add_u32 s24, s24, 262144
  v_mfma_f32_16x16x32_bf16 v[204:207], a[120:123], a[168:171], v[204:207]
  v_mfma_f32_16x16x32_bf16 v[208:211], a[128:131], a[168:171], v[208:211]
  v_mfma_f32_16x16x32_bf16 v[208:211], a[132:135], a[172:175], v[208:211]
  v_mfma_f32_16x16x32_bf16 v[212:215], a[140:143], a[172:175], v[212:215]
  v_mfma_f32_16x16x32_bf16 v[212:215], a[136:139], a[168:171], v[212:215]
  buffer_load_dword v21, v20, s[60:63], s54 offen
  s_add_u32 s54, s54, s55
  v_mfma_f32_16x16x32_bf16 v[216:219], a[144:147], a[168:171], v[216:219]
  v_mfma_f32_16x16x32_bf16 v[216:219], a[148:151], a[172:175], v[216:219]
  v_mfma_f32_16x16x32_bf16 v[220:223], a[156:159], a[172:175], v[220:223]
  v_mfma_f32_16x16x32_bf16 v[220:223], a[152:155], a[168:171], v[220:223]
  s_waitcnt lgkmcnt(10)
  v_mfma_f32_16x16x32_bf16 v[224:227], a[96:99], a[176:179], v[224:227]
  s_cmp_eq_u32 s54, s56
  s_cselect_b32 s54, s57, s54
  s_cselect_b64 s[60:61], s[58:59], s[60:61]
  s_cselect_b32 s62, s7, s62
  v_mfma_f32_16x16x32_bf16 v[224:227], a[100:103], a[180:183], v[224:227]
  v_mfma_f32_16x16x32_bf16 v[228:231], a[108:111], a[180:183], v[228:231]
  v_mfma_f32_16x16x32_bf16 v[228:231], a[104:107], a[176:179], v[228:231]
  v_mfma_f32_16x16x32_bf16 v[232:235], a[112:115], a[176:179], v[232:235]
  v_mfma_f32_16x16x32_bf16 v[232:235], a[116:119], a[180:183], v[232:235]
  v_mfma_f32_16x16x32_bf16 v[236:239], a[124:127], a[180:183], v[236:239]
  v_mfma_f32_16x16x32_bf16 v[236:239], a[120:123], a[176:179], v[236:239]
  s_waitcnt vmcnt(18) lgkmcnt(0)
  s_barrier
  ds_read_b128 a[160:163], v10 offset:0
  ds_read_b128 a[164:167], v11 offset:0
  v_mfma_f32_16x16x32_bf16 v[240:243], a[128:131], a[176:179], v[240:243]
  s_add_u32 m0, s29, 49152
  s_add_u32 s3, s23, s31
  buffer_load_dwordx4 v2, s[8:11], s3 offen offset:0 lds
  v_mfma_f32_16x16x32_bf16 v[240:243], a[132:135], a[180:183], v[240:243]
  v_mfma_f32_16x16x32_bf16 v[244:247], a[140:143], a[180:183], v[244:247]
  v_mfma_f32_16x16x32_bf16 v[244:247], a[136:139], a[176:179], v[244:247]
  v_mfma_f32_16x16x32_bf16 v[248:251], a[144:147], a[176:179], v[248:251]
  v_mfma_f32_16x16x32_bf16 v[248:251], a[148:151], a[180:183], v[248:251]
  buffer_load_dwordx4 v3, s[8:11], s3 offen offset:1024 lds
  v_mfma_f32_16x16x32_bf16 v[252:255], a[156:159], a[180:183], v[252:255]
  v_mfma_f32_16x16x32_bf16 v[252:255], a[152:155], a[176:179], v[252:255]
  v_mfma_f32_16x16x32_bf16 a[0:3], a[96:99], a[184:187], a[0:3]
  v_mfma_f32_16x16x32_bf16 a[0:3], a[100:103], a[188:191], a[0:3]
  ds_read_b128 a[168:171], v10 offset:2048
  ds_read_b128 a[172:175], v11 offset:2048
  v_mfma_f32_16x16x32_bf16 a[4:7], a[108:111], a[188:191], a[4:7]
  v_mfma_f32_16x16x32_bf16 a[4:7], a[104:107], a[184:187], a[4:7]
  v_mfma_f32_16x16x32_bf16 a[8:11], a[112:115], a[184:187], a[8:11]
  buffer_load_dwordx4 v4, s[8:11], s3 offen offset:2048 lds
  v_mfma_f32_16x16x32_bf16 a[8:11], a[116:119], a[188:191], a[8:11]
  v_mfma_f32_16x16x32_bf16 a[12:15], a[124:127], a[188:191], a[12:15]
  v_mfma_f32_16x16x32_bf16 a[12:15], a[120:123], a[184:187], a[12:15]
  v_mfma_f32_16x16x32_bf16 a[16:19], a[128:131], a[184:187], a[16:19]
  v_mfma_f32_16x16x32_bf16 a[16:19], a[132:135], a[188:191], a[16:19]
  buffer_load_dwordx4 v5, s[8:11], s3 offen offset:3072 lds
  v_mfma_f32_16x16x32_bf16 a[20:23], a[140:143], a[188:191], a[20:23]
  v_mfma_f32_16x16x32_bf16 a[20:23], a[136:139], a[184:187], a[20:23]
  v_mfma_f32_16x16x32_bf16 a[24:27], a[144:147], a[184:187], a[24:27]
  v_mfma_f32_16x16x32_bf16 a[24:27], a[148:151], a[188:191], a[24:27]
  v_mfma_f32_16x16x32_bf16 a[28:31], a[156:159], a[188:191], a[28:31]
  v_mfma_f32_16x16x32_bf16 a[28:31], a[152:155], a[184:187], a[28:31]
  s_waitcnt lgkmcnt(2)
  s_mov_b32 s30, 2
Lk1_kl:
  v_mfma_f32_16x16x32_bf16 v[32:35], a[32:35], a[160:163], v[32:35]
  s_add_u32 s23, s23, 128
  s_cmp_eq_u32 s23, s25
  s_cselect_b32 s23, s26, s23
  v_mfma_f32_16x16x32_bf16 v[32:35], a[36:39], a[164:167], v[32:35]
  ds_read_b128 a[176:179], v10 offset:4096
  ds_read_b128 a[180:183], v11 offset:4096
  v_mfma_f32_16x16x32_bf16 v[36:39], a[44:47], a[164:167], v[36:39]
  v_mfma_f32_16x16x32_bf16 v[36:39], a[40:43], a[160:163], v[36:39]
  ds_read_b64_tr_b16 a[96:97], v12 offset:32768
  ds_read_b64_tr_b16 a[98:99], v12 offset:34816
  v_mfma_f32_16x16x32_bf16 v[40:43], a[48:51], a[160:163], v[40:43]
  v_mfma_f32_16x16x32_bf16 v[40:43], a[52:55], a[164:167], v[40:43]
  v_mfma_f32_16x16x32_bf16 v[44:47], a[60:63], a[164:167], v[44:47]
  s_add_u32 m0, s29, 81920
  s_nop 0
  buffer_load_dwordx4 v6, s[12:15], s24 offen offset:0 lds
  v_mfma_f32_16x16x32_bf16 v[44:47], a[56:59], a[160:163], v[44:47]
  ds_read_b64_tr_b16 a[104:105], v13 offset:32768
  ds_read_b64_tr_b16 a[106:107], v13 offset:34816
  v_mfma_f32_16x16x32_bf16 v[48:51], a[64:67], a[160:163], v[48:51]
  v_mfma_f32_16x16x32_bf16 v[48:51], a[68:71], a[164:167], v[48:51]
  v_mfma_f32_16x16x32_bf16 v[52:55], a[76:79], a[164:167], v[52:55]
  v_mfma_f32_16x16x32_bf16 v[52:55], a[72:75], a[160:163], v[52:55]
  ds_read_b64_tr_b16 a[112:113], v14 offset:32768
  ds_read_b64_tr_b16 a[114:115], v14 offset:34816
  v_mfma_f32_16x16x32_bf16 v[56:59], a[80:83], a[160:163], v[56:59]
  v_mfma_f32_16x16x32_bf16 v[56:59], a[84:87], a[164:167], v[56:59]
  buffer_load_dwordx4 v7, s[12:15], s24 offen offset:1024 lds
  v_mfma_f32_16x16x32_bf16 v[60:63], a[92:95], a[164:167], v[60:63]
  v_mfma_f32_16x16x32_bf16 v[60:63], a[88:91], a[160:163], v[60:63]
  s_waitcnt lgkmcnt(8)
  ds_read_b64_tr_b16 a[120:121], v15 offset:32768
  ds_read_b64_tr_b16 a[122:123], v15 offset:34816
  v_mfma_f32_16x16x32_bf16 v[64:67], a[32:35], a[168:171], v[64:67]
  v_mfma_f32_16x16x32_bf16 v[64:67], a[36:39], a[172:175], v[64:67]
  ds_read_b128 a[184:187], v10 offset:6144
  ds_read_b128 a[188:191], v11 offset:6144
  v_mfma_f32_16x16x32_bf16 v[68:71], a[44:47], a[172:175], v[68:71]
  v_mfma_f32_16x16x32_bf16 v[68:71], a[40:43], a[168:171], v[68:71]
  ds_read_b64_tr_b16 a[128:129], v16 offset:32768
  ds_read_b64_tr_b16 a[130:131], v16 offset:34816
  v_mfma_f32_16x16x32_bf16 v[72:75], a[48:51], a[168:171], v[72:75]
  buffer_load_dwordx4 v8, s[12:15], s24 offen offset:2048 lds
  v_mfma_f32_16x16x32_bf16 v[72:75], a[52:55], a[172:175], v[72:75]
  v_mfma_f32_16x16x32_bf16 v[76:79], a[60:63], a[172:175], v[76:79]
  v_mfma_f32_16x16x32_bf16 v[76:79], a[56:59], a[168:171], v[76:79]
  ds_read_b64_tr_b16 a[136:137], v17 offset:32768
  ds_read_b64_tr_b16 a[138:139], v17 offset:34816
  v_mfma_f32_16x16x32_bf16 v[80:83], a[64:67], a[168:171], v[80:83]
  v_mfma_f32_16x16x32_bf16 v[80:83], a[68:71], a[172:175], v[80:83]
  v_mfma_f32_16x16x32_bf16 v[84:87], a[76:79], a[172:175], v[84:87]
  buffer_load_dwordx4 v9, s[12:15], s24 offen offset:3072 lds
  v_mfma_f32_16x16x32_bf16 v[84:87], a[72:75], a[168:171], v[84:87]
  ds_read_b64_tr_b16 a[144:145], v18 offset:32768
  ds_read_b64_tr_b16 a[146:147], v18 offset:34816
  v_mfma_f32_16x16x32_bf16 v[88:91], a[80:83], a[168:171], v[88:91]
  v_mfma_f32_16x16x32_bf16 v[88:91], a[84:87], a[172:175], v[88:91]
  v_mfma_f32_16x16x32_bf16 v[92:95], a[92:95], a[172:175], v[92:95]
  v_mfma_f32_16x16x32_bf16 v[92:95], a[88:91], a[168:171], v[92:95]
  s_waitcnt lgkmcnt(15)
  ds_read_b64_tr_b16 a[152:153], v19 offset:32768
  ds_read_b64_tr_b16 a[154:155], v19 offset:34816
  v_mfma_f32_16x16x32_bf16 v[96:99], a[32:35], a[176:179], v[96:99]
  s_add_u32 s24, s24, 262144
  s_cmp_eq_u32 s24, s27
  s_cselect_b32 s24, s28, s24
  s_sub_u32 s6, s6, 1
  s_cmp_eq_u32 s6, 0
  s_cselect_b64 s[12:13], s[64:65], s[12:13]
  v_mfma_f32_16x16x32_bf16 v[96:99], a[36:39], a[180:183], v[96:99]
  v_mfma_f32_16x16x32_bf16 v[100:103], a[44:47], a[180:183], v[100:103]
  v_mfma_f32_16x16x32_bf16 v[100:103], a[40:43], a[176:179], v[100:103]
  v_mfma_f32_16x16x32_bf16 v[104:107], a[48:51], a[176:179], v[104:107]
  v_mfma_f32_16x16x32_bf16 v[104:107], a[52:55], a[180:183], v[104:107]
  v_mfma_f32_16x16x32_bf16 v[108:111], a[60:63], a[180:183], v[108:111]
  v_mfma_f32_16x16x32_bf16 v[108:111], a[56:59], a[176:179], v[108:111]
  s_waitcnt vmcnt(17) lgkmcnt(0)
  s_barrier
  ds_read_b128 a[160:163], v10 offset:16384
  ds_read_b128 a[164:167], v11 offset:16384
  v_mfma_f32_16x16x32_bf16 v[112:115], a[64:67], a[176:179], v[112:115]
  s_add_u32 m0, s29, 0
  s_nop 0
  buffer_load_dwordx4 v2, s[8:11], s23 offen offset:0 lds
  v_mfma_f32_16x16x32_bf16 v[112:115], a[68:71], a[180:183], v[112:115]
  v_mfma_f32_16x16x32_bf16 v[116:119], a[76:79], a[180:183], v[116:119]
  v_mfma_f32_16x16x32_bf16 v[116:119], a[72:75], a[176:179], v[116:119]
  ds_read_b64_tr_b16 a[100:101], v12 offset:49152
  ds_read_b64_tr_b16 a[102:103], v12 offset:51200
  v_mfma_f32_16x16x32_bf16 v[120:123], a[80:83], a[176:179], v[120:123]
  v_mfma_f32_16x16x32_bf16 v[120:123], a[84:87], a[180:183], v[120:123]
  buffer_load_dwordx4 v3, s[8:11], s23 offen offset:1024 lds
  v_mfma_f32_16x16x32_bf16 v[124:127], a[92:95], a[180:183], v[124:127]
  v_mfma_f32_16x16x32_bf16 v[124:127], a[88:91], a[176:179], v[124:127]
  v_mfma_f32_16x16x32_bf16 v[128:131], a[32:35], a[184:187], v[128:131]
  v_mfma_f32_16x16x32_bf16 v[128:131], a[36:39], a[188:191], v[128:131]
  ds_read_b128 a[168:171], v10 offset:18432
  ds_read_b128 a[172:175], v11 offset:18432
  ds_read_b64_tr_b16 a[108:109], v13 offset:49152
  ds_read_b64_tr_b16 a[110:111], v13 offset:51200
  v_mfma_f32_16x16x32_bf16 v[132:135], a[44:47], a[188:191], v[132:135]
  v_mfma_f32_16x16x32_bf16 v[132:135], a[40:43], a[184:187], v[132:135]
  buffer_load_dwordx4 v4, s[8:11], s23 offen offset:2048 lds
  v_mfma_f32_16x16x32_bf16 v[136:139], a[48:51], a[184:187], v[136:139]
  v_mfma_f32_16x16x32_bf16 v[136:139], a[52:55], a[188:191], v[136:139]
  v_mfma_f32_16x16x32_bf16 v[140:143], a[60:63], a[188:191], v[140:143]
  v_mfma_f32_16x16x32_bf16 v[140:143], a[56:59], a[184:187], v[140:143]
  ds_read_b64_tr_b16 a[116:117], v14 offset:49152
  ds_read_b64_tr_b16 a[118:119], v14 offset:51200
  v_mfma_f32_16x16x32_bf16 v[144:147], a[64:67], a[184:187], v[144:147]
  v_mfma_f32_16x16x32_bf16 v[144:147], a[68:71], a[188:191], v[144:147]
  buffer_load_dwordx4 v5, s[8:11], s23 offen offset:3072 lds
  v_mfma_f32_16x16x32_bf16 v[148:151], a[76:79], a[188:191], v[148:151]
  v_mfma_f32_16x16x32_bf16 v[148:151], a[72:75], a[184:187], v[148:151]
  v_mfma_f32_16x16x32_bf16 v[152:155], a[80:83], a[184:187], v[152:155]
  v_mfma_f32_16x16x32_bf16 v[152:155], a[84:87], a[188:191], v[152:155]
  ds_read_b64_tr_b16 a[124:125], v15 offset:49152
  ds_read_b64_tr_b16 a[126:127], v15 offset:51200
  v_mfma_f32_16x16x32_bf16 v[156:159], a[92:95], a[188:191], v[156:159]
  s_add_u32 m0, s29, 98304
  s_nop 0
  buffer_load_dwordx4 v6, s[12:15], s24 offen offset:0 lds
  v_mfma_f32_16x16x32_bf16 v[156:159], a[88:91], a[184:187], v[156:159]
  s_waitcnt lgkmcnt(10)
  v_mfma_f32_16x16x32_bf16 v[160:163], a[32:35], a[160:163], v[160:163]
  v_mfma_f32_16x16x32_bf16 v[160:163], a[36:39], a[164:167], v[160:163]
  ds_read_b128 a[176:179], v10 offset:20480
  ds_read_b128 a[180:183], v11 offset:20480
  v_mfma_f32_16x16x32_bf16 v[164:167], a[44:47], a[164:167], v[164:167]
  v_mfma_f32_16x16x32_bf16 v[164:167], a[40:43], a[160:163], v[164:167]
  ds_read_b64_tr_b16 a[132:133], v16 offset:49152
  ds_read_b64_tr_b16 a[134:135], v16 offset:51200
  v_mfma_f32_16x16x32_bf16 v[168:171], a[48:51], a[160:163], v[168:171]
  v_mfma_f32_16x16x32_bf16 v[168:171], a[52:55], a[164:167], v[168:171]
  buffer_load_dwordx4 v7, s[12:15], s24 offen offset:1024 lds
  v_mfma_f32_16x16x32_bf16 v[172:175], a[60:63], a[164:167], v[172:175]
  v_mfma_f32_16x16x32_bf16 v[172:175], a[56:59], a[160:163], v[172:175]
  v_mfma_f32_16x16x32_bf16 v[176:179], a[64:67], a[160:163], v[176:179]
  v_mfma_f32_16x16x32_bf16 v[176:179], a[68:71], a[164:167], v[176:179]
  ds_read_b64_tr_b16 a[140:141], v17 offset:49152
  ds_read_b64_tr_b16 a[142:143], v17 offset:51200
  v_mfma_f32_16x16x32_bf16 v[180:183], a[76:79], a[164:167], v[180:183]
  v_mfma_f32_16x16x32_bf16 v[180:183], a[72:75], a[160:163], v[180:183]
  buffer_load_dwordx4 v8, s[12:15], s24 offen offset:2048 lds
  v_mfma_f32_16x16x32_bf16 v[184:187], a[80:83], a[160:163], v[184:187]
  v_mfma_f32_16x16x32_bf16 v[184:187], a[84:87], a[164:167], v[184:187]
  v_mfma_f32_16x16x32_bf16 v[188:191], a[92:95], a[164:167], v[188:191]
  v_mfma_f32_16x16x32_bf16 v[188:191], a[88:91], a[160:163], v[188:191]
  s_waitcnt lgkmcnt(12)
  ds_read_b64_tr_b16 a[148:149], v18 offset:49152
  ds_read_b64_tr_b16 a[150:151], v18 offset:51200
  v_mfma_f32_16x16x32_bf16 v[192:195], a[32:35], a[168:171], v[192:195]
  buffer_load_dwordx4 v9, s[12:15], s24 offen offset:3072 lds
  v_mfma_f32_16x16x32_bf16 v[192:195], a[36:39], a[172:175], v[192:195]
  ds_read_b128 a[184:187], v10 offset:22528
  ds_read_b128 a[188:191], v11 offset:22528
  v_mfma_f32_16x16x32_bf16 v[196:199], a[44:47], a[172:175], v[196:199]
  v_mfma_f32_16x16x32_bf16 v[196:199], a[40:43], a[168:171], v[196:199]
  v_mfma_f32_16x16x32_bf16 v[200:203], a[48:51], a[168:171], v[200:203]
  v_mfma_f32_16x16x32_bf16 v[200:203], a[52:55], a[172:175], v[200:203]
  ds_read_b64_tr_b16 a[156:157], v19 offset:49152
  ds_read_b64_tr_b16 a[158:159], v19 offset:51200
  v_mfma_f32_16x16x32_bf16 v[204:207], a[60:63], a[172:175], v[204:207]
  s_add_u32 s24, s24, 262144
  v_mfma_f32_16x16x32_bf16 v[204:207], a[56:59], a[168:171], v[204:207]
  v_mfma_f32_16x16x32_bf16 v[208:211], a[64:67], a[168:171], v[208:211]
  v_mfma_f32_16x16x32_bf16 v[208:211], a[68:71], a[172:175], v[208:211]
  v_mfma_f32_16x16x32_bf16 v[212:215], a[76:79], a[172:175], v[212:215]
  v_mfma_f32_16x16x32_bf16 v[212:215], a[72:75], a[168:171], v[212:215]
  buffer_load_dword v21, v20, s[60:63], s54 offen
  s_add_u32 s54, s54, s55
  v_mfma_f32_16x16x32_bf16 v[216:219], a[80:83], a[168:171], v[216:219]
  v_mfma_f32_16x16x32_bf16 v[216:219], a[84:87], a[172:175], v[216:219]
  v_mfma_f32_16x16x32_bf16 v[220:223], a[92:95], a[172:175], v[220:223]
  v_mfma_f32_16x16x32_bf16 v[220:223], a[88:91], a[168:171], v[220:223]
  s_waitcnt lgkmcnt(10)
  v_mfma_f32_16x16x32_bf16 v[224:227], a[32:35], a[176:179], v[224:227]
  s_cmp_eq_u32 s54, s56
  s_cselect_b32 s54, s57, s54
  s_cselect_b64 s[60:61], s[58:59], s[60:61]
  s_cselect_b32 s62, s7, s62
  v_mfma_f32_16x16x32_bf16 v[224:227], a[36:39], a[180:183], v[224:227]
  v_mfma_f32_16x16x32_bf16 v[228:231], a[44:47], a[180:183], v[228:231]
  v_mfma_f32_16x16x32_bf16 v[228:231], a[40:43], a[176:179], v[228:231]
  v_mfma_f32_16x16x32_bf16 v[232:235], a[48:51], a[176:179], v[232:235]
  v_mfma_f32_16x16x32_bf16 v[232:235], a[52:55], a[180:183], v[232:235]
  v_mfma_f32_16x16x32_bf16 v[236:239], a[60:63], a[180:183], v[236:239]
  v_mfma_f32_16x16x32_bf16 v[236:239], a[56:59], a[176:179], v[236:239]
  s_waitcnt vmcnt(18) lgkmcnt(0)
  s_barrier
  ds_read_b128 a[160:163], v10 offset:32768
  ds_read_b128 a[164:167], v11 offset:32768
  v_mfma_f32_16x16x32_bf16 v[240:243], a[64:67], a[176:179], v[240:243]
  s_add_u32 m0, s29, 16384
  s_add_u32 s3, s23, s31
  buffer_load_dwordx4 v2, s[8:11], s3 offen offset:0 lds
  v_mfma_f32_16x16x32_bf16 v[240:243], a[68:71], a[180:183], v[240:243]
  v_mfma_f32_16x16x32_bf16 v[244:247], a[76:79], a[180:183], v[244:247]
  v_mfma_f32_16x16x32_bf16 v[244:247], a[72:75], a[176:179], v[244:247]
  v_mfma_f32_16x16x32_bf16 v[248:251], a[80:83], a[176:179], v[248:251]
  v_mfma_f32_16x16x32_bf16 v[248:251], a[84:87], a[180:183], v[248:251]
  buffer_load_dwordx4 v3, s[8:11], s3 offen offset:1024 lds
  v_mfma_f32_16x16x32_bf16 v[252:255], a[92:95], a[180:183], v[252:255]
  v_mfma_f32_16x16x32_bf16 v[252:255], a[88:91], a[176:179], v[252:255]
  v_mfma_f32_16x16x32_bf16 a[0:3], a[32:35], a[184:187], a[0:3]
  v_mfma_f32_16x16x32_bf16 a[0:3], a[36:39], a[188:191], a[0:3]
  ds_read_b128 a[168:171], v10 offset:34816
  ds_read_b128 a[172:175], v11 offset:34816
  v_mfma_f32_16x16x32_bf16 a[4:7], a[44:47], a[188:191], a[4:7]
  v_mfma_f32_16x16x32_bf16 a[4:7], a[40:43], a[184:187], a[4:7]
  v_mfma_f32_16x16x32_bf16 a[8:11], a[48:51], a[184:187], a[8:11]
  buffer_load_dwordx4 v4, s[8:11], s3 offen offset:2048 lds
  v_mfma_f32_16x16x32_bf16 a[8:11], a[52:55], a[188:191], a[8:11]
  v_mfma_f32_16x16x32_bf16 a[12:15], a[60:63], a[188:191], a[12:15]
  v_mfma_f32_16x16x32_bf16 a[12:15], a[56:59], a[184:187], a[12:15]
  v_mfma_f32_16x16x32_bf16 a[16:19], a[64:67], a[184:187], a[16:19]
  v_mfma_f32_16x16x32_bf16 a[16:19], a[68:71], a[188:191], a[16:19]
  buffer_load_dwordx4 v5, s[8:11], s3 offen offset:3072 lds
  v_mfma_f32_16x16x32_bf16 a[20:23], a[76:79], a[188:191], a[20:23]
  v_mfma_f32_16x16x32_bf16 a[20:23], a[72:75], a[184:187], a[20:23]
  v_mfma_f32_16x16x32_bf16 a[24:27], a[80:83], a[184:187], a[24:27]
  v_mfma_f32_16x16x32_bf16 a[24:27], a[84:87], a[188:191], a[24:27]
  v_mfma_f32_16x16x32_bf16 a[28:31], a[92:95], a[188:191], a[28:31]
  v_mfma_f32_16x16x32_bf16 a[28:31], a[88:91], a[184:187], a[28:31]
  s_waitcnt lgkmcnt(2)
  v_mfma_f32_16x16x32_bf16 v[32:35], a[96:99], a[160:163], v[32:35]
  s_add_u32 s23, s23, 128
  s_cmp_eq_u32 s23, s25
  s_cselect_b32 s23, s26, s23
  v_mfma_f32_16x16x32_bf16 v[32:35], a[100:103], a[164:167], v[32:35]
  ds_read_b128 a[176:179], v10 offset:36864
  ds_read_b128 a[180:183], v11 offset:36864
  v_mfma_f32_16x16x32_bf16 v[36:39], a[108:111], a[164:167], v[36:39]
  v_mfma_f32_16x16x32_bf16 v[36:39], a[104:107], a[160:163], v[36:39]
  ds_read_b64_tr_b16 a[32:33], v12 offset:0
  ds_read_b64_tr_b16 a[34:35], v12 offset:2048
  v_mfma_f32_16x16x32_bf16 v[40:43], a[112:115], a[160:163], v[40:43]
  v_mfma_f32_16x16x32_bf16 v[40:43], a[116:119], a[164:167], v[40:43]
  v_mfma_f32_16x16x32_bf16 v[44:47], a[124:127], a[164:167], v[44:47]
  s_add_u32 m0, s29, 114688
  s_nop 0
  buffer_load_dwordx4 v6, s[12:15], s24 offen offset:0 lds
  v_mfma_f32_16x16x32_bf16 v[44:47], a[120:123], a[160:163], v[44:47]
  ds_read_b64_tr_b16 a[40:41], v13 offset:0
  ds_read_b64_tr_b16 a[42:43], v13 offset:2048
  v_mfma_f32_16x16x32_bf16 v[48:51], a[128:131], a[160:163], v[48:51]
  v_mfma_f32_16x16x32_bf16 v[48:51], a[132:135], a[164:167], v[48:51]
  v_mfma_f32_16x16x32_bf16 v[52:55], a[140:143], a[164:167], v[52:55]
  v_mfma_f32_16x16x32_bf16 v[52:55], a[136:139], a[160:163], v[52:55]
  ds_read_b64_tr_b16 a[48:49], v14 offset:0
  ds_read_b64_tr_b16 a[50:51], v14 offset:2048
  v_mfma_f32_16x16x32_bf16 v[56:59], a[144:147], a[160:163], v[56:59]
  v_mfma_f32_16x16x32_bf16 v[56:59], a[148:151], a[164:167], v[56:59]
  buffer_load_dwordx4 v7, s[12:15], s24 offen offset:1024 lds
  v_mfma_f32_16x16x32_bf16 v[60:63], a[156:159], a[164:167], v[60:63]
  v_mfma_f32_16x16x32_bf16 v[60:63], a[152:155], a[160:163], v[60:63]
  s_waitcnt lgkmcnt(8)
  ds_read_b64_tr_b16 a[56:57], v15 offset:0
  ds_read_b64_tr_b16 a[58:59], v15 offset:2048
  v_mfma_f32_16x16x32_bf16 v[64:67], a[96:99], a[168:171], v[64:67]
  v_mfma_f32_16x16x32_bf16 v[64:67], a[100:103], a[172:175], v[64:67]
  ds_read_b128 a[184:187], v10 offset:38912
  ds_read_b128 a[188:191], v11 offset:38912
  v_mfma_f32_16x16x32_bf16 v[68:71], a[108:111], a[172:175], v[68:71]
  v_mfma_f32_16x16x32_bf16 v[68:71], a[104:107], a[168:171], v[68:71]
  ds_read_b64_tr_b16 a[64:65], v16 offset:0
  ds_read_b64_tr_b16 a[66:67], v16 offset:2048
  v_mfma_f32_16x16x32_bf16 v[72:75], a[112:115], a[168:171], v[72:75]
  buffer_load_dwordx4 v8, s[12:15], s24 offen offset:2048 lds
  v_mfma_f32_16x16x32_bf16 v[72:75], a[116:119], a[172:175], v[72:75]
  v_mfma_f32_16x16x32_bf16 v[76:79], a[124:127], a[172:175], v[76:79]
  v_mfma_f32_16x16x32_bf16 v[76:79], a[120:123], a[168:171], v[76:79]
  ds_read_b64_tr_b16 a[72:73], v17 offset:0
  ds_read_b64_tr_b16 a[74:75], v17 offset:2048
  v_mfma_f32_16x16x32_bf16 v[80:83], a[128:131], a[168:171], v[80:83]
  v_mfma_f32_16x16x32_bf16 v[80:83], a[132:135], a[172:175], v[80:83]
  v_mfma_f32_16x16x32_bf16 v[84:87], a[140:143], a[172:175], v[84:87]
  buffer_load_dwordx4 v9, s[12:15], s24 offen offset:3072 lds
  v_mfma_f32_16x16x32_bf16 v[84:87], a[136:139], a[168:171], v[84:87]
  ds_read_b64_tr_b16 a[80:81], v18 offset:0
  ds_read_b64_tr_b16 a[82:83], v18 offset:2048
  v_mfma_f32_16x16x32_bf16 v[88:91], a[144:147], a[168:171], v[88:91]
  v_mfma_f32_16x16x32_bf16 v[88:91], a[148:151], a[172:175], v[88:91]
  v_mfma_f32_16x16x32_bf16 v[92:95], a[156:159], a[172:175], v[92:95]
  v_mfma_f32_16x16x32_bf16 v[92:95], a[152:155], a[168:171], v[92:95]
  s_waitcnt lgkmcnt(15)
  ds_read_b64_tr_b16 a[88:89], v19 offset:0
  ds_read_b64_tr_b16 a[90:91], v19 offset:2048
  v_mfma_f32_16x16x32_bf16 v[96:99], a[96:99], a[176:179], v[96:99]
  s_add_u32 s24, s24, 262144
  s_cmp_eq_u32 s24, s27
  s_cselect_b32 s24, s28, s24
  s_sub_u32 s6, s6, 1
  s_cmp_eq_u32 s6, 0
  s_cselect_b64 s[12:13], s[64:65], s[12:13]
  v_mfma_f32_16x16x32_bf16 v[96:99], a[100:103], a[180:183], v[96:99]
  v_mfma_f32_16x16x32_bf16 v[100:103], a[108:111], a[180:183], v[100:103]
  v_mfma_f32_16x16x32_bf16 v[100:103], a[104:107], a[176:179], v[100:103]
  v_mfma_f32_16x16x32_bf16 v[104:107], a[112:115], a[176:179], v[104:107]
  v_mfma_f32_16x16x32_bf16 v[104:107], a[116:119], a[180:183], v[104:107]
  v_mfma_f32_16x16x32_bf16 v[108:111], a[124:127], a[180:183], v[108:111]
  v_mfma_f32_16x16x32_bf16 v[108:111], a[120:123], a[176:179], v[108:111]
  s_waitcnt vmcnt(17) lgkmcnt(0)
  s_barrier
  ds_read_b128 a[160:163], v10 offset:49152
  ds_read_b128 a[164:167], v11 offset:49152
  v_mfma_f32_16x16x32_bf16 v[112:115], a[128:131], a[176:179], v[112:115]
  s_add_u32 m0, s29, 32768
  s_nop 0
  buffer_load_dwordx4 v2, s[8:11], s23 offen offset:0 lds
  v_mfma_f32_16x16x32_bf16 v[112:115], a[132:135], a[180:183], v[112:115]
  v_mfma_f32_16x16x32_bf16 v[116:119], a[140:143], a[180:183], v[116:119]
  v_mfma_f32_16x16x32_bf16 v[116:119], a[136:139], a[176:179], v[116:119]
  ds_read_b64_tr_b16 a[36:37], v12 offset:16384
  ds_read_b64_tr_b16 a[38:39], v12 offset:18432
  v_mfma_f32_16x16x32_bf16 v[120:123], a[144:147], a[176:179], v[120:123]
  v_mfma_f32_16x16x32_bf16 v[120:123], a[148:151], a[180:183], v[120:123]
  buffer_load_dwordx4 v3, s[8:11], s23 offen offset:1024 lds
  v_mfma_f32_16x16x32_bf16 v[124:127], a[156:159], a[180:183], v[124:127]
  v_mfma_f32_16x16x32_bf16 v[124:127], a[152:155], a[176:179], v[124:127]
  v_mfma_f32_16x16x32_bf16 v[128:131], a[96:99], a[184:187], v[128:131]
  v_mfma_f32_16x16x32_bf16 v[128:131], a[100:103], a[188:191], v[128:131]
  ds_read_b128 a[168:171], v10 offset:51200
  ds_read_b128 a[172:175], v11 offset:51200
  ds_read_b64_tr_b16 a[44:45], v13 offset:16384
  ds_read_b64_tr_b16 a[46:47], v13 offset:18432
  v_mfma_f32_16x16x32_bf16 v[132:135], a[108:111], a[188:191], v[132:135]
  v_mfma_f32_16x16x32_bf16 v[132:135], a[104:107], a[184:187], v[132:135]
  buffer_load_dwordx4 v4, s[8:11], s23 offen offset:2048 lds
  v_mfma_f32_16x16x32_bf16 v[136:139], a[112:115], a[184:187], v[136:139]
  v_mfma_f32_16x16x32_bf16 v[136:139], a[116:119], a[188:191], v[136:139]
  v_mfma_f32_16x16x32_bf16 v[140:143], a[124:127], a[188:191], v[140:143]
  v_mfma_f32_16x16x32_bf16 v[140:143], a[120:123], a[184:187], v[140:143]
  ds_read_b64_tr_b16 a[52:53], v14 offset:16384
  ds_read_b64_tr_b16 a[54:55], v14 offset:18432
  v_mfma_f32_16x16x32_bf16 v[144:147], a[128:131], a[184:187], v[144:147]
  v_mfma_f32_16x16x32_bf16 v[144:147], a[132:135], a[188:191], v[144:147]
  buffer_load_dwordx4 v5, s[8:11], s23 offen offset:3072 lds
  v_mfma_f32_16x16x32_bf16 v[148:151], a[140:143], a[188:191], v[148:151]
  v_mfma_f32_16x16x32_bf16 v[148:151], a[136:139], a[184:187], v[148:151]
  v_mfma_f32_16x16x32_bf16 v[152:155], a[144:147], a[184:187], v[152:155]
  v_mfma_f32_16x16x32_bf16 v[152:155], a[148:151], a[188:191], v[152:155]
  ds_read_b64_tr_b16 a[60:61], v15 offset:16384
  ds_read_b64_tr_b16 a[62:63], v15 offset:18432
  v_mfma_f32_16x16x32_bf16 v[156:159], a[156:159], a[188:191], v[156:159]
  s_add_u32 m0, s29, 65536
  s_nop 0
  buffer_load_dwordx4 v6, s[12:15], s24 offen offset:0 lds
  v_mfma_f32_16x16x32_bf16 v[156:159], a[152:155], a[184:187], v[156:159]
  s_waitcnt lgkmcnt(10)
  v_mfma_f32_16x16x32_bf16 v[160:163], a[96:99], a[160:163], v[160:163]
  v_mfma_f32_16x16x32_bf16 v[160:163], a[100:103], a[164:167], v[160:163]
  ds_read_b128 a[176:179], v10 offset:53248
  ds_read_b128 a[180:183], v11 offset:53248
  v_mfma_f32_16x16x32_bf16 v[164:167], a[108:111], a[164:167], v[164:167]
  v_mfma_f32_16x16x32_bf16 v[164:167], a[104:107], a[160:163], v[164:167]
  ds_read_b64_tr_b16 a[68:69], v16 offset:16384
  ds_read_b64_tr_b16 a[70:71], v16 offset:18432
  v_mfma_f32_16x16x32_bf16 v[168:171], a[112:115], a[160:163], v[168:171]
  v_mfma_f32_16x16x32_bf16 v[168:171], a[116:119], a[164:167], v[168:171]
  buffer_load_dwordx4 v7, s[12:15], s24 offen offset:1024 lds
  v_mfma_f32_16x16x32_bf16 v[172:175], a[124:127], a[164:167], v[172:175]
  v_mfma_f32_16x16x32_bf16 v[172:175], a[120:123], a[160:163], v[172:175]
  v_mfma_f32_16x16x32_bf16 v[176:179], a[128:131], a[160:163], v[176:179]
  v_mfma_f32_16x16x32_bf16 v[176:179], a[132:135], a[164:167], v[176:179]
  ds_read_b64_tr_b16 a[76:77], v17 offset:16384
  ds_read_b64_tr_b16 a[78:79], v17 offset:18432
  v_mfma_f32_16x16x32_bf16 v[180:183], a[140:143], a[164:167], v[180:183]
  v_mfma_f32_16x16x32_bf16 v[180:183], a[136:139], a[160:163], v[180:183]
  buffer_load_dwordx4 v8, s[12:15], s24 offen offset:2048 lds
  v_mfma_f32_16x16x32_bf16 v[184:187], a[144:147], a[160:163], v[184:187]
  v_mfma_f32_16x16x32_bf16 v[184:187], a[148:151], a[164:167], v[184:187]
  v_mfma_f32_16x16x32_bf16 v[188:191], a[156:159], a[164:167], v[188:191]
  v_mfma_f32_16x16x32_bf16 v[188:191], a[152:155], a[160:163], v[188:191]
  s_waitcnt lgkmcnt(12)
  ds_read_b64_tr_b16 a[84:85], v18 offset:16384
  ds_read_b64_tr_b16 a[86:87], v18 offset:18432
  v_mfma_f32_16x16x32_bf16 v[192:195], a[96:99], a[168:171], v[192:195]
  buffer_load_dwordx4 v9, s[12:15], s24 offen offset:3072 lds
  v_mfma_f32_16x16x32_bf16 v[192:195], a[100:103], a[172:175], v[192:195]
  ds_read_b128 a[184:187], v10 offset:55296
  ds_read_b128 a[188:191], v11 offset:55296
  v_mfma_f32_16x16x32_bf16 v[196:199], a[108:111], a[172:175], v[196:199]
  v_mfma_f32_16x16x32_bf16 v[196:199], a[104:107], a[168:171], v[196:199]
  v_mfma_f32_16x16x32_bf16 v[200:203], a[112:115], a[168:171], v[200:203]
  v_mfma_f32_16x16x32_bf16 v[200:203], a[116:119], a[172:175], v[200:203]
  ds_read_b64_tr_b16 a[92:93], v19 offset:16384
  ds_read_b64_tr_b16 a[94:95], v19 offset:18432
  v_mfma_f32_16x16x32_bf16 v[204:207], a[124:127], a[172:175], v[204:207]
  s_add_u32 s24, s24, 262144
  v_mfma_f32_16x16x32_bf16 v[204:207], a[120:123], a[168:171], v[204:207]
  v_mfma_f32_16x16x32_bf16 v[208:211], a[128:131], a[168:171], v[208:211]
  v_mfma_f32_16x16x32_bf16 v[208:211], a[132:135], a[172:175], v[208:211]
  v_mfma_f32_16x16x32_bf16 v[212:215], a[140:143], a[172:175], v[212:215]
  v_mfma_f32_16x16x32_bf16 v[212:215], a[136:139], a[168:171], v[212:215]
  buffer_load_dword v21, v20, s[60:63], s54 offen
  s_add_u32 s54, s54, s55
  v_mfma_f32_16x16x32_bf16 v[216:219], a[144:147], a[168:171], v[216:219]
  v_mfma_f32_16x16x32_bf16 v[216:219], a[148:151], a[172:175], v[216:219]
  v_mfma_f32_16x16x32_bf16 v[220:223], a[156:159], a[172:175], v[220:223]
  v_mfma_f32_16x16x32_bf16 v[220:223], a[152:155], a[168:171], v[220:223]
  s_waitcnt lgkmcnt(10)
  v_mfma_f32_16x16x32_bf16 v[224:227], a[96:99], a[176:179], v[224:227]
  s_cmp_eq_u32 s54, s56
  s_cselect_b32 s54, s57, s54
  s_cselect_b64 s[60:61], s[58:59], s[60:61]
  s_cselect_b32 s62, s7, s62
  v_mfma_f32_16x16x32_bf16 v[224:227], a[100:103], a[180:183], v[224:227]
  v_mfma_f32_16x16x32_bf16 v[228:231], a[108:111], a[180:183], v[228:231]
  v_mfma_f32_16x16x32_bf16 v[228:231], a[104:107], a[176:179], v[228:231]
  v_mfma_f32_16x16x32_bf16 v[232:235], a[112:115], a[176:179], v[232:235]
  v_mfma_f32_16x16x32_bf16 v[232:235], a[116:119], a[180:183], v[232:235]
  v_mfma_f32_16x16x32_bf16 v[236:239], a[124:127], a[180:183], v[236:239]
  v_mfma_f32_16x16x32_bf16 v[236:239], a[120:123], a[176:179], v[236:239]
  s_waitcnt vmcnt(18) lgkmcnt(0)
  s_barrier
  ds_read_b128 a[160:163], v10 offset:0
  ds_read_b128 a[164:167], v11 offset:0
  v_mfma_f32_16x16x32_bf16 v[240:243], a[128:131], a[176:179], v[240:243]
  s_add_u32 m0, s29, 49152
  s_add_u32 s3, s23, s31
  buffer_load_dwordx4 v2, s[8:11], s3 offen offset:0 lds
  v_mfma_f32_16x16x32_bf16 v[240:243], a[132:135], a[180:183], v[240:243]
  v_mfma_f32_16x16x32_bf16 v[244:247], a[140:143], a[180:183], v[244:247]
  v_mfma_f32_16x16x32_bf16 v[244:247], a[136:139], a[176:179], v[244:247]
  v_mfma_f32_16x16x32_bf16 v[248:251], a[144:147], a[176:179], v[248:251]
  v_mfma_f32_16x16x32_bf16 v[248:251], a[148:151], a[180:183], v[248:251]
  buffer_load_dwordx4 v3, s[8:11], s3 offen offset:1024 lds
  v_mfma_f32_16x16x32_bf16 v[252:255], a[156:159], a[180:183], v[252:255]
  v_mfma_f32_16x16x32_bf16 v[252:255], a[152:155], a[176:179], v[252:255]
  v_mfma_f32_16x16x32_bf16 a[0:3], a[96:99], a[184:187], a[0:3]
  v_mfma_f32_16x16x32_bf16 a[0:3], a[100:103], a[188:191], a[0:3]
  ds_read_b128 a[168:171], v10 offset:2048
  ds_read_b128 a[172:175], v11 offset:2048
  v_mfma_f32_16x16x32_bf16 a[4:7], a[108:111], a[188:191], a[4:7]
  v_mfma_f32_16x16x32_bf16 a[4:7], a[104:107], a[184:187], a[4:7]
  v_mfma_f32_16x16x32_bf16 a[8:11], a[112:115], a[184:187], a[8:11]
  buffer_load_dwordx4 v4, s[8:11], s3 offen offset:2048 lds
  v_mfma_f32_16x16x32_bf16 a[8:11], a[116:119], a[188:191], a[8:11]
  v_mfma_f32_16x16x32_bf16 a[12:15], a[124:127], a[188:191], a[12:15]
  v_mfma_f32_16x16x32_bf16 a[12:15], a[120:123], a[184:187], a[12:15]
  v_mfma_f32_16x16x32_bf16 a[16:19], a[128:131], a[184:187], a[16:19]
  v_mfma_f32_16x16x32_bf16 a[16:19], a[132:135], a[188:191], a[16:19]
  buffer_load_dwordx4 v5, s[8:11], s3 offen offset:3072 lds
  v_mfma_f32_16x16x32_bf16 a[20:23], a[140:143], a[188:191], a[20:23]
  v_mfma_f32_16x16x32_bf16 a[20:23], a[136:139], a[184:187], a[20:23]
  v_mfma_f32_16x16x32_bf16 a[24:27], a[144:147], a[184:187], a[24:27]
  v_mfma_f32_16x16x32_bf16 a[24:27], a[148:151], a[188:191], a[24:27]
  v_mfma_f32_16x16x32_bf16 a[28:31], a[156:159], a[188:191], a[28:31]
  v_mfma_f32_16x16x32_bf16 a[28:31], a[152:155], a[184:187], a[28:31]
  s_waitcnt lgkmcnt(2)
  s_sub_u32 s30, s30, 1
  s_cmp_lg_u32 s30, 0
  s_cbranch_scc1 Lk1_kl
  v_mfma_f32_16x16x32_bf16 v[32:35], a[32:35], a[160:163], v[32:35]
  s_add_u32 s23, s23, 128
  s_cmp_eq_u32 s23, s25
  s_cselect_b32 s23, s26, s23
  v_mfma_f32_16x16x32_bf16 v[32:35], a[36:39], a[164:167], v[32:35]
  ds_read_b128 a[176:179], v10 offset:4096
  ds_read_b128 a[180:183], v11 offset:4096
  v_mfma_f32_16x16x32_bf16 v[36:39], a[44:47], a[164:167], v[36:39]
  v_mfma_f32_16x16x32_bf16 v[36:39], a[40:43], a[160:163], v[36:39]
  ds_read_b64_tr_b16 a[96:97], v12 offset:32768
  ds_read_b64_tr_b16 a[98:99], v12 offset:34816
  v_mfma_f32_16x16x32_bf16 v[40:43], a[48:51], a[160:163], v[40:43]
  v_mfma_f32_16x16x32_bf16 v[40:43], a[52:55], a[164:167], v[40:43]
  v_mfma_f32_16x16x32_bf16 v[44:47], a[60:63], a[164:167], v[44:47]
  s_add_u32 m0, s29, 81920
  s_nop 0
  buffer_load_dwordx4 v6, s[12:15], s24 offen offset:0 lds
  v_mfma_f32_16x16x32_bf16 v[44:47], a[56:59], a[160:163], v[44:47]
  ds_read_b64_tr_b16 a[104:105], v13 offset:32768
  ds_read_b64_tr_b16 a[106:107], v13 offset:34816
  v_mfma_f32_16x16x32_bf16 v[48:51], a[64:67], a[160:163], v[48:51]
  v_mfma_f32_16x16x32_bf16 v[48:51], a[68:71], a[164:167], v[48:51]
  v_mfma_f32_16x16x32_bf16 v[52:55], a[76:79], a[164:167], v[52:55]
  v_mfma_f32_16x16x32_bf16 v[52:55], a[72:75], a[160:163], v[52:55]
  ds_read_b64_tr_b16 a[112:113], v14 offset:32768
  ds_read_b64_tr_b16 a[114:115], v14 offset:34816
  v_mfma_f32_16x16x32_bf16 v[56:59], a[80:83], a[160:163], v[56:59]
  v_mfma_f32_16x16x32_bf16 v[56:59], a[84:87], a[164:167], v[56:59]
  buffer_load_dwordx4 v7, s[12:15], s24 offen offset:1024 lds
  v_mfma_f32_16x16x32_bf16 v[60:63], a[92:95], a[164:167], v[60:63]
  v_mfma_f32_16x16x32_bf16 v[60:63], a[88:91], a[160:163], v[60:63]
  s_waitcnt lgkmcnt(8)
  ds_read_b64_tr_b16 a[120:121], v15 offset:32768
  ds_read_b64_tr_b16 a[122:123], v15 offset:34816
  v_mfma_f32_16x16x32_bf16 v[64:67], a[32:35], a[168:171], v[64:67]
  v_mfma_f32_16x16x32_bf16 v[64:67], a[36:39], a[172:175], v[64:67]
  ds_read_b128 a[184:187], v10 offset:6144
  ds_read_b128 a[188:191], v11 offset:6144
  v_mfma_f32_16x16x32_bf16 v[68:71], a[44:47], a[172:175], v[68:71]
  v_mfma_f32_16x16x32_bf16 v[68:71], a[40:43], a[168:171], v[68:71]
  ds_read_b64_tr_b16 a[128:129], v16 offset:32768
  ds_read_b64_tr_b16 a[130:131], v16 offset:34816
  v_mfma_f32_16x16x32_bf16 v[72:75], a[48:51], a[168:171], v[72:75]
  buffer_load_dwordx4 v8, s[12:15], s24 offen offset:2048 lds
  v_mfma_f32_16x16x32_bf16 v[72:75], a[52:55], a[172:175], v[72:75]
  v_mfma_f32_16x16x32_bf16 v[76:79], a[60:63], a[172:175], v[76:79]
  v_mfma_f32_16x16x32_bf16 v[76:79], a[56:59], a[168:171], v[76:79]
  ds_read_b64_tr_b16 a[136:137], v17 offset:32768
  ds_read_b64_tr_b16 a[138:139], v17 offset:34816
  v_mfma_f32_16x16x32_bf16 v[80:83], a[64:67], a[168:171], v[80:83]
  v_mfma_f32_16x16x32_bf16 v[80:83], a[68:71], a[172:175], v[80:83]
  v_mfma_f32_16x16x32_bf16 v[84:87], a[76:79], a[172:175], v[84:87]
  buffer_load_dwordx4 v9, s[12:15], s24 offen offset:3072 lds
  v_mfma_f32_16x16x32_bf16 v[84:87], a[72:75], a[168:171], v[84:87]
  ds_read_b64_tr_b16 a[144:145], v18 offset:32768
  ds_read_b64_tr_b16 a[146:147], v18 offset:34816
  v_mfma_f32_16x16x32_bf16 v[88:91], a[80:83], a[168:171], v[88:91]
  v_mfma_f32_16x16x32_bf16 v[88:91], a[84:87], a[172:175], v[88:91]
  v_mfma_f32_16x16x32_bf16 v[92:95], a[92:95], a[172:175], v[92:95]
  v_mfma_f32_16x16x32_bf16 v[92:95], a[88:91], a[168:171], v[92:95]
  s_waitcnt lgkmcnt(15)
  ds_read_b64_tr_b16 a[152:153], v19 offset:32768
  ds_read_b64_tr_b16 a[154:155], v19 offset:34816
  v_mfma_f32_16x16x32_bf16 v[96:99], a[32:35], a[176:179], v[96:99]
  s_add_u32 s24, s24, 262144
  s_cmp_eq_u32 s24, s27
  s_cselect_b32 s24, s28, s24
  s_sub_u32 s6, s6, 1
  s_cmp_eq_u32 s6, 0
  s_cselect_b64 s[12:13], s[64:65], s[12:13]
  v_mfma_f32_16x16x32_bf16 v[96:99], a[36:39], a[180:183], v[96:99]
  v_mfma_f32_16x16x32_bf16 v[100:103], a[44:47], a[180:183], v[100:103]
  v_mfma_f32_16x16x32_bf16 v[100:103], a[40:43], a[176:179], v[100:103]
  v_mfma_f32_16x16x32_bf16 v[104:107], a[48:51], a[176:179], v[104:107]
  v_mfma_f32_16x16x32_bf16 v[104:107], a[52:55], a[180:183], v[104:107]
  v_mfma_f32_16x16x32_bf16 v[108:111], a[60:63], a[180:183], v[108:111]
  v_mfma_f32_16x16x32_bf16 v[108:111], a[56:59], a[176:179], v[108:111]
  s_waitcnt vmcnt(17) lgkmcnt(0)
  s_barrier
  ds_read_b128 a[160:163], v10 offset:16384
  ds_read_b128 a[164:167], v11 offset:16384
  v_mfma_f32_16x16x32_bf16 v[112:115], a[64:67], a[176:179], v[112:115]
  s_add_u32 m0, s29, 0
  s_nop 0
  buffer_load_dwordx4 v2, s[8:11], s23 offen offset:0 lds
  v_mfma_f32_16x16x32_bf16 v[112:115], a[68:71], a[180:183], v[112:115]
  v_mfma_f32_16x16x32_bf16 v[116:119], a[76:79], a[180:183], v[116:119]
  v_mfma_f32_16x16x32_bf16 v[116:119], a[72:75], a[176:179], v[116:119]
  ds_read_b64_tr_b16 a[100:101], v12 offset:49152
  ds_read_b64_tr_b16 a[102:103], v12 offset:51200
  v_mfma_f32_16x16x32_bf16 v[120:123], a[80:83], a[176:179], v[120:123]
  v_mfma_f32_16x16x32_bf16 v[120:123], a[84:87], a[180:183], v[120:123]
  buffer_load_dwordx4 v3, s[8:11], s23 offen offset:1024 lds
  v_mfma_f32_16x16x32_bf16 v[124:127], a[92:95], a[180:183], v[124:127]
  v_mfma_f32_16x16x32_bf16 v[124:127], a[88:91], a[176:179], v[124:127]
  v_mfma_f32_16x16x32_bf16 v[128:131], a[32:35], a[184:187], v[128:131]
  v_mfma_f32_16x16x32_bf16 v[128:131], a[36:39], a[188:191], v[128:131]
  ds_read_b128 a[168:171], v10 offset:18432
  ds_read_b128 a[172:175], v11 offset:18432
  ds_read_b64_tr_b16 a[108:109], v13 offset:49152
  ds_read_b64_tr_b16 a[110:111], v13 offset:51200
  v_mfma_f32_16x16x32_bf16 v[132:135], a[44:47], a[188:191], v[132:135]
  v_mfma_f32_16x16x32_bf16 v[132:135], a[40:43], a[184:187], v[132:135]
  buffer_load_dwordx4 v4, s[8:11], s23 offen offset:2048 lds
  v_mfma_f32_16x16x32_bf16 v[136:139], a[48:51], a[184:187], v[136:139]
  v_mfma_f32_16x16x32_bf16 v[136:139], a[52:55], a[188:191], v[136:139]
  v_mfma_f32_16x16x32_bf16 v[140:143], a[60:63], a[188:191], v[140:143]
  v_mfma_f32_16x16x32_bf16 v[140:143], a[56:59], a[184:187], v[140:143]
  ds_read_b64_tr_b16 a[116:117], v14 offset:49152
  ds_read_b64_tr_b16 a[118:119], v14 offset:51200
  v_mfma_f32_16x16x32_bf16 v[144:147], a[64:67], a[184:187], v[144:147]
  v_mfma_f32_16x16x32_bf16 v[144:147], a[68:71], a[188:191], v[144:147]
  buffer_load_dwordx4 v5, s[8:11], s23 offen offset:3072 lds
  v_mfma_f32_16x16x32_bf16 v[148:151], a[76:79], a[188:191], v[148:151]
  v_mfma_f32_16x16x32_bf16 v[148:151], a[72:75], a[184:187], v[148:151]
  v_mfma_f32_16x16x32_bf16 v[152:155], a[80:83], a[184:187], v[152:155]
  s_lshr_b32 s3, s53, 7
  s_add_u32 s3, s3, s22
  v_mfma_f32_16x16x32_bf16 v[152:155], a[84:87], a[188:191], v[152:155]
  ds_read_b64_tr_b16 a[124:125], v15 offset:49152
  ds_read_b64_tr_b16 a[126:127], v15 offset:51200
  s_lshl_b32 s3, s3, 5
  s_lshr_b32 s19, s52, 6
  v_mfma_f32_16x16x32_bf16 v[156:159], a[92:95], a[188:191], v[156:159]
  s_add_u32 m0, s29, 98304
  s_nop 0
  buffer_load_dwordx4 v6, s[12:15], s24 offen offset:0 lds
  s_add_u32 s3, s3, s19
  s_lshl_b32 s19, s21, 1
  v_mfma_f32_16x16x32_bf16 v[156:159], a[88:91], a[184:187], v[156:159]
  s_waitcnt lgkmcnt(10)
  s_add_u32 s3, s3, s19
  s_lshl_b32 s92, s3, 15
  v_mfma_f32_16x16x32_bf16 v[160:163], a[32:35], a[160:163], v[160:163]
  s_add_u32 s93, s92, 32768
  s_add_u32 s16, s50, 16777216
  v_mfma_f32_16x16x32_bf16 v[160:163], a[36:39], a[164:167], v[160:163]
  ds_read_b128 a[176:179], v10 offset:20480
  ds_read_b128 a[180:183], v11 offset:20480
  s_addc_u32 s17, s51, 0
  s_mov_b32 s18, 33554432
  v_mfma_f32_16x16x32_bf16 v[164:167], a[44:47], a[164:167], v[164:167]
  s_mov_b32 s19, 0x00020000
  v_mfma_f32_16x16x32_bf16 v[164:167], a[40:43], a[160:163], v[164:167]
  ds_read_b64_tr_b16 a[132:133], v16 offset:49152
  ds_read_b64_tr_b16 a[134:135], v16 offset:51200
  v_mfma_f32_16x16x32_bf16 v[168:171], a[48:51], a[160:163], v[168:171]
  v_mfma_f32_16x16x32_bf16 v[168:171], a[52:55], a[164:167], v[168:171]
  buffer_load_dwordx4 v7, s[12:15], s24 offen offset:1024 lds
  v_mfma_f32_16x16x32_bf16 v[172:175], a[60:63], a[164:167], v[172:175]
  v_mfma_f32_16x16x32_bf16 v[172:175], a[56:59], a[160:163], v[172:175]
  v_mfma_f32_16x16x32_bf16 v[176:179], a[64:67], a[160:163], v[176:179]
  v_mfma_f32_16x16x32_bf16 v[176:179], a[68:71], a[164:167], v[176:179]
  ds_read_b64_tr_b16 a[140:141], v17 offset:49152
  ds_read_b64_tr_b16 a[142:143], v17 offset:51200
  v_mfma_f32_16x16x32_bf16 v[180:183], a[76:79], a[164:167], v[180:183]
  v_mfma_f32_16x16x32_bf16 v[180:183], a[72:75], a[160:163], v[180:183]
  buffer_load_dwordx4 v8, s[12:15], s24 offen offset:2048 lds
  v_mfma_f32_16x16x32_bf16 v[184:187], a[80:83], a[160:163], v[184:187]
  v_mfma_f32_16x16x32_bf16 v[184:187], a[84:87], a[164:167], v[184:187]
  v_mfma_f32_16x16x32_bf16 v[188:191], a[92:95], a[164:167], v[188:191]
  v_mfma_f32_16x16x32_bf16 v[188:191], a[88:91], a[160:163], v[188:191]
  s_waitcnt lgkmcnt(12)
  ds_read_b64_tr_b16 a[148:149], v18 offset:49152
  ds_read_b64_tr_b16 a[150:151], v18 offset:51200
  v_mfma_f32_16x16x32_bf16 v[192:195], a[32:35], a[168:171], v[192:195]
  buffer_load_dwordx4 v9, s[12:15], s24 offen offset:3072 lds
  v_mfma_f32_16x16x32_bf16 v[192:195], a[36:39], a[172:175], v[192:195]
  ds_read_b128 a[184:187], v10 offset:22528
  ds_read_b128 a[188:191], v11 offset:22528
  v_mfma_f32_16x16x32_bf16 v[196:199], a[44:47], a[172:175], v[196:199]
  v_mfma_f32_16x16x32_bf16 v[196:199], a[40:43], a[168:171], v[196:199]
  v_mfma_f32_16x16x32_bf16 v[200:203], a[48:51], a[168:171], v[200:203]
  v_mfma_f32_16x16x32_bf16 v[200:203], a[52:55], a[172:175], v[200:203]
  ds_read_b64_tr_b16 a[156:157], v19 offset:49152
  ds_read_b64_tr_b16 a[158:159], v19 offset:51200
  v_mfma_f32_16x16x32_bf16 v[204:207], a[60:63], a[172:175], v[204:207]
  s_add_u32 s24, s24, 262144
  v_mfma_f32_16x16x32_bf16 v[204:207], a[56:59], a[168:171], v[204:207]
  v_mfma_f32_16x16x32_bf16 v[208:211], a[64:67], a[168:171], v[208:211]
  v_mfma_f32_16x16x32_bf16 v[208:211], a[68:71], a[172:175], v[208:211]
  v_mfma_f32_16x16x32_bf16 v[212:215], a[76:79], a[172:175], v[212:215]
  v_mfma_f32_16x16x32_bf16 v[212:215], a[72:75], a[168:171], v[212:215]
  buffer_load_dword v21, v20, s[60:63], s54 offen
  s_add_u32 s54, s54, s55
  v_mfma_f32_16x16x32_bf16 v[216:219], a[80:83], a[168:171], v[216:219]
  v_mfma_f32_16x16x32_bf16 v[216:219], a[84:87], a[172:175], v[216:219]
  v_mfma_f32_16x16x32_bf16 v[220:223], a[92:95], a[172:175], v[220:223]
  v_mfma_f32_16x16x32_bf16 v[220:223], a[88:91], a[168:171], v[220:223]
  s_waitcnt lgkmcnt(10)
  v_mfma_f32_16x16x32_bf16 v[224:227], a[32:35], a[176:179], v[224:227]
  s_cmp_eq_u32 s54, s56
  s_cselect_b32 s54, s57, s54
  s_cselect_b64 s[60:61], s[58:59], s[60:61]
  s_cselect_b32 s62, s7, s62
  v_mfma_f32_16x16x32_bf16 v[224:227], a[36:39], a[180:183], v[224:227]
  v_mfma_f32_16x16x32_bf16 v[228:231], a[44:47], a[180:183], v[228:231]
  v_mfma_f32_16x16x32_bf16 v[228:231], a[40:43], a[176:179], v[228:231]
  v_mfma_f32_16x16x32_bf16 v[232:235], a[48:51], a[176:179], v[232:235]
  v_mfma_f32_16x16x32_bf16 v[232:235], a[52:55], a[180:183], v[232:235]
  v_mfma_f32_16x16x32_bf16 v[236:239], a[60:63], a[180:183], v[236:239]
  v_mfma_f32_16x16x32_bf16 v[236:239], a[56:59], a[176:179], v[236:239]
  s_waitcnt vmcnt(18) lgkmcnt(0)
  s_barrier
  ds_read_b128 a[160:163], v10 offset:32768
  ds_read_b128 a[164:167], v11 offset:32768
  v_mfma_f32_16x16x32_bf16 v[240:243], a[64:67], a[176:179], v[240:243]
  s_add_u32 m0, s29, 16384
  s_add_u32 s3, s23, s31
  buffer_load_dwordx4 v2, s[8:11], s3 offen offset:0 lds
  v_mfma_f32_16x16x32_bf16 v[240:243], a[68:71], a[180:183], v[240:243]
  v_mfma_f32_16x16x32_bf16 v[244:247], a[76:79], a[180:183], v[244:247]
  v_mfma_f32_16x16x32_bf16 v[244:247], a[72:75], a[176:179], v[244:247]
  v_mfma_f32_16x16x32_bf16 v[248:251], a[80:83], a[176:179], v[248:251]
  v_mfma_f32_16x16x32_bf16 v[248:251], a[84:87], a[180:183], v[248:251]
  buffer_load_dwordx4 v3, s[8:11], s3 offen offset:1024 lds
  v_mfma_f32_16x16x32_bf16 v[252:255], a[92:95], a[180:183], v[252:255]
  v_mfma_f32_16x16x32_bf16 v[252:255], a[88:91], a[176:179], v[252:255]
  v_mfma_f32_16x16x32_bf16 a[0:3], a[32:35], a[184:187], a[0:3]
  v_mfma_f32_16x16x32_bf16 a[0:3], a[36:39], a[188:191], a[0:3]
  ds_read_b128 a[168:171], v10 offset:34816
  ds_read_b128 a[172:175], v11 offset:34816
  v_mfma_f32_16x16x32_bf16 a[4:7], a[44:47], a[188:191], a[4:7]
  v_mfma_f32_16x16x32_bf16 a[4:7], a[40:43], a[184:187], a[4:7]
  v_mfma_f32_16x16x32_bf16 a[8:11], a[48:51], a[184:187], a[8:11]
  buffer_load_dwordx4 v4, s[8:11], s3 offen offset:2048 lds
  v_mfma_f32_16x16x32_bf16 a[8:11], a[52:55], a[188:191], a[8:11]
  v_mfma_f32_16x16x32_bf16 a[12:15], a[60:63], a[188:191], a[12:15]
  v_mfma_f32_16x16x32_bf16 a[12:15], a[56:59], a[184:187], a[12:15]
  v_mfma_f32_16x16x32_bf16 a[16:19], a[64:67], a[184:187], a[16:19]
  v_mfma_f32_16x16x32_bf16 a[16:19], a[68:71], a[188:191], a[16:19]
  buffer_load_dwordx4 v5, s[8:11], s3 offen offset:3072 lds
  v_mfma_f32_16x16x32_bf16 a[20:23], a[76:79], a[188:191], a[20:23]
  v_mfma_f32_16x16x32_bf16 a[20:23], a[72:75], a[184:187], a[20:23]
  v_mfma_f32_16x16x32_bf16 a[24:27], a[80:83], a[184:187], a[24:27]
  v_mfma_f32_16x16x32_bf16 a[24:27], a[84:87], a[188:191], a[24:27]
  v_mfma_f32_16x16x32_bf16 a[28:31], a[92:95], a[188:191], a[28:31]
  v_mfma_f32_16x16x32_bf16 a[28:31], a[88:91], a[184:187], a[28:31]
  s_waitcnt lgkmcnt(2)
  v_mfma_f32_16x16x32_bf16 v[32:35], a[96:99], a[160:163], v[32:35]
  s_add_u32 s23, s23, 128
  s_cmp_eq_u32 s23, s25
  s_cselect_b32 s23, s26, s23
  v_mfma_f32_16x16x32_bf16 v[32:35], a[100:103], a[164:167], v[32:35]
  ds_read_b128 a[176:179], v10 offset:36864
  ds_read_b128 a[180:183], v11 offset:36864
  v_mfma_f32_16x16x32_bf16 v[36:39], a[108:111], a[164:167], v[36:39]
  v_mfma_f32_16x16x32_bf16 v[36:39], a[104:107], a[160:163], v[36:39]
  ds_read_b64_tr_b16 a[32:33], v12 offset:0
  ds_read_b64_tr_b16 a[34:35], v12 offset:2048
  v_mfma_f32_16x16x32_bf16 v[40:43], a[112:115], a[160:163], v[40:43]
  v_mfma_f32_16x16x32_bf16 v[40:43], a[116:119], a[164:167], v[40:43]
  v_mfma_f32_16x16x32_bf16 v[44:47], a[124:127], a[164:167], v[44:47]
  s_add_u32 m0, s29, 114688
  s_nop 0
  buffer_load_dwordx4 v6, s[12:15], s24 offen offset:0 lds
  v_mfma_f32_16x16x32_bf16 v[44:47], a[120:123], a[160:163], v[44:47]
  ds_read_b64_tr_b16 a[40:41], v13 offset:0
  ds_read_b64_tr_b16 a[42:43], v13 offset:2048
  v_mfma_f32_16x16x32_bf16 v[48:51], a[128:131], a[160:163], v[48:51]
  v_mfma_f32_16x16x32_bf16 v[48:51], a[132:135], a[164:167], v[48:51]
  v_mfma_f32_16x16x32_bf16 v[52:55], a[140:143], a[164:167], v[52:55]
  v_mfma_f32_16x16x32_bf16 v[52:55], a[136:139], a[160:163], v[52:55]
  ds_read_b64_tr_b16 a[48:49], v14 offset:0
  ds_read_b64_tr_b16 a[50:51], v14 offset:2048
  v_mfma_f32_16x16x32_bf16 v[56:59], a[144:147], a[160:163], v[56:59]
  buffer_load_dwordx4 v7, s[12:15], s24 offen offset:1024 lds
  v_mfma_f32_16x16x32_bf16 v[56:59], a[148:151], a[164:167], v[56:59]
  v_mfma_f32_16x16x32_bf16 v[60:63], a[156:159], a[164:167], v[60:63]
  v_mfma_f32_16x16x32_bf16 v[60:63], a[152:155], a[160:163], v[60:63]
  s_waitcnt lgkmcnt(8)
  ds_read_b64_tr_b16 a[56:57], v15 offset:0
  ds_read_b64_tr_b16 a[58:59], v15 offset:2048
  v_mfma_f32_16x16x32_bf16 v[64:67], a[96:99], a[168:171], v[64:67]
  v_mfma_f32_16x16x32_bf16 v[64:67], a[100:103], a[172:175], v[64:67]
  ds_read_b128 a[184:187], v10 offset:38912
  ds_read_b128 a[188:191], v11 offset:38912
  v_mfma_f32_16x16x32_bf16 v[68:71], a[108:111], a[172:175], v[68:71]
  v_mfma_f32_16x16x32_bf16 v[68:71], a[104:107], a[168:171], v[68:71]
  ds_read_b64_tr_b16 a[64:65], v16 offset:0
  ds_read_b64_tr_b16 a[66:67], v16 offset:2048
  v_cvt_pk_bf16_f32 v32, v32, v33
  v_cvt_pk_bf16_f32 v33, v34, v35
  v_mfma_f32_16x16x32_bf16 v[72:75], a[112:115], a[168:171], v[72:75]
  buffer_load_dwordx4 v8, s[12:15], s24 offen offset:2048 lds
  v_cvt_pk_bf16_f32 v34, v36, v37
  v_cvt_pk_bf16_f32 v35, v38, v39
  v_mfma_f32_16x16x32_bf16 v[72:75], a[116:119], a[172:175], v[72:75]
  v_cvt_pk_bf16_f32 v40, v40, v41
  v_cvt_pk_bf16_f32 v41, v42, v43
  v_mfma_f32_16x16x32_bf16 v[76:79], a[124:127], a[172:175], v[76:79]
  v_cvt_pk_bf16_f32 v42, v44, v45
  v_cvt_pk_bf16_f32 v43, v46, v47
  v_mfma_f32_16x16x32_bf16 v[76:79], a[120:123], a[168:171], v[76:79]
  ds_read_b64_tr_b16 a[72:73], v17 offset:0
  ds_read_b64_tr_b16 a[74:75], v17 offset:2048
  v_cvt_pk_bf16_f32 v48, v48, v49
  v_cvt_pk_bf16_f32 v49, v50, v51
  v_mfma_f32_16x16x32_bf16 v[80:83], a[128:131], a[168:171], v[80:83]
  v_cvt_pk_bf16_f32 v50, v52, v53
  v_cvt_pk_bf16_f32 v51, v54, v55
  v_mfma_f32_16x16x32_bf16 v[80:83], a[132:135], a[172:175], v[80:83]
  buffer_load_dwordx4 v9, s[12:15], s24 offen offset:3072 lds
  v_cvt_pk_bf16_f32 v56, v56, v57
  v_cvt_pk_bf16_f32 v57, v58, v59
  v_mfma_f32_16x16x32_bf16 v[84:87], a[140:143], a[172:175], v[84:87]
  v_cvt_pk_bf16_f32 v58, v60, v61
  v_cvt_pk_bf16_f32 v59, v62, v63
  v_mfma_f32_16x16x32_bf16 v[84:87], a[136:139], a[168:171], v[84:87]
  ds_read_b64_tr_b16 a[80:81], v18 offset:0
  ds_read_b64_tr_b16 a[82:83], v18 offset:2048
  v_mfma_f32_16x16x32_bf16 v[88:91], a[144:147], a[168:171], v[88:91]
  v_mfma_f32_16x16x32_bf16 v[88:91], a[148:151], a[172:175], v[88:91]
  v_mfma_f32_16x16x32_bf16 v[92:95], a[156:159], a[172:175], v[92:95]
  s_add_u32 s94, s92, 0
  buffer_store_dwordx4 v[32:35], v1, s[16:19], s94 offen offset:0
  v_mfma_f32_16x16x32_bf16 v[92:95], a[152:155], a[168:171], v[92:95]
  s_waitcnt lgkmcnt(15)
  ds_read_b64_tr_b16 a[88:89], v19 offset:0
  ds_read_b64_tr_b16 a[90:91], v19 offset:2048
  v_mfma_f32_16x16x32_bf16 v[96:99], a[96:99], a[176:179], v[96:99]
  s_add_u32 s24, s24, 262144
  s_cmp_eq_u32 s24, s27
  s_cselect_b32 s24, s28, s24
  s_sub_u32 s6, s6, 1
  s_cmp_eq_u32 s6, 0
  s_cselect_b64 s[12:13], s[64:65], s[12:13]
  v_mfma_f32_16x16x32_bf16 v[96:99], a[100:103], a[180:183], v[96:99]
  v_mfma_f32_16x16x32_bf16 v[100:103], a[108:111], a[180:183], v[100:103]
  v_mfma_f32_16x16x32_bf16 v[100:103], a[104:107], a[176:179], v[100:103]
  v_cvt_pk_bf16_f32 v64, v64, v65
  v_cvt_pk_bf16_f32 v65, v66, v67
  v_mfma_f32_16x16x32_bf16 v[104:107], a[112:115], a[176:179], v[104:107]
  v_cvt_pk_bf16_f32 v66, v68, v69
  v_cvt_pk_bf16_f32 v67, v70, v71
  v_mfma_f32_16x16x32_bf16 v[104:107], a[116:119], a[180:183], v[104:107]
  s_add_u32 s94, s92, 0
  buffer_store_dwordx4 v[40:43], v1, s[16:19], s94 offen offset:1024
  v_cvt_pk_bf16_f32 v72, v72, v73
  v_cvt_pk_bf16_f32 v73, v74, v75
  v_mfma_f32_16x16x32_bf16 v[108:111], a[124:127], a[180:183], v[108:111]
  v_cvt_pk_bf16_f32 v74, v76, v77
  v_cvt_pk_bf16_f32 v75, v78, v79
  v_mfma_f32_16x16x32_bf16 v[108:111], a[120:123], a[176:179], v[108:111]
  s_waitcnt vmcnt(19) lgkmcnt(0)
  s_barrier
  ds_read_b128 a[160:163], v10 offset:49152
  ds_read_b128 a[164:167], v11 offset:49152
  v_cvt_pk_bf16_f32 v80, v80, v81
  v_cvt_pk_bf16_f32 v81, v82, v83
  v_mfma_f32_16x16x32_bf16 v[112:115], a[128:131], a[176:179], v[112:115]
  s_add_u32 m0, s29, 32768
  s_nop 0
  buffer_load_dwordx4 v2, s[8:11], s23 offen offset:0 lds
  v_cvt_pk_bf16_f32 v82, v84, v85
  v_cvt_pk_bf16_f32 v83, v86, v87
  v_mfma_f32_16x16x32_bf16 v[112:115], a[132:135], a[180:183], v[112:115]
  v_cvt_pk_bf16_f32 v88, v88, v89
  v_cvt_pk_bf16_f32 v89, v90, v91
  v_mfma_f32_16x16x32_bf16 v[116:119], a[140:143], a[180:183], v[116:119]
  v_cvt_pk_bf16_f32 v90, v92, v93
  v_cvt_pk_bf16_f32 v91, v94, v95
  v_mfma_f32_16x16x32_bf16 v[116:119], a[136:139], a[176:179], v[116:119]
  ds_read_b64_tr_b16 a[36:37], v12 offset:16384
  ds_read_b64_tr_b16 a[38:39], v12 offset:18432
  v_mfma_f32_16x16x32_bf16 v[120:123], a[144:147], a[176:179], v[120:123]
  s_add_u32 s94, s92, 0
  buffer_store_dwordx4 v[48:51], v1, s[16:19], s94 offen offset:2048
  v_mfma_f32_16x16x32_bf16 v[120:123], a[148:151], a[180:183], v[120:123]
  buffer_load_dwordx4 v3, s[8:11], s23 offen offset:1024 lds
  v_mfma_f32_16x16x32_bf16 v[124:127], a[156:159], a[180:183], v[124:127]
  v_mfma_f32_16x16x32_bf16 v[124:127], a[152:155], a[176:179], v[124:127]
  v_mfma_f32_16x16x32_bf16 v[128:131], a[96:99], a[184:187], v[128:131]
  v_mfma_f32_16x16x32_bf16 v[128:131], a[100:103], a[188:191], v[128:131]
  ds_read_b128 a[168:171], v10 offset:51200
  ds_read_b128 a[172:175], v11 offset:51200
  ds_read_b64_tr_b16 a[44:45], v13 offset:16384
  ds_read_b64_tr_b16 a[46:47], v13 offset:18432
  v_mfma_f32_16x16x32_bf16 v[132:135], a[108:111], a[188:191], v[132:135]
  v_mfma_f32_16x16x32_bf16 v[132:135], a[104:107], a[184:187], v[132:135]
  s_add_u32 s94, s92, 0
  buffer_store_dwordx4 v[56:59], v1, s[16:19], s94 offen offset:3072
  v_cvt_pk_bf16_f32 v96, v96, v97
  v_cvt_pk_bf16_f32 v97, v98, v99
  v_mfma_f32_16x16x32_bf16 v[136:139], a[112:115], a[184:187], v[136:139]
  buffer_load_dwordx4 v4, s[8:11], s23 offen offset:2048 lds
  v_cvt_pk_bf16_f32 v98, v100, v101
  v_cvt_pk_bf16_f32 v99, v102, v103
  v_mfma_f32_16x16x32_bf16 v[136:139], a[116:119], a[188:191], v[136:139]
  v_cvt_pk_bf16_f32 v104, v104, v105
  v_cvt_pk_bf16_f32 v105, v106, v107
  v_mfma_f32_16x16x32_bf16 v[140:143], a[124:127], a[188:191], v[140:143]
  v_cvt_pk_bf16_f32 v106, v108, v109
  v_cvt_pk_bf16_f32 v107, v110, v111
  v_mfma_f32_16x16x32_bf16 v[140:143], a[120:123], a[184:187], v[140:143]
  ds_read_b64_tr_b16 a[52:53], v14 offset:16384
  ds_read_b64_tr_b16 a[54:55], v14 offset:18432
  v_cvt_pk_bf16_f32 v112, v112, v113
  v_cvt_pk_bf16_f32 v113, v114, v115
  v_mfma_f32_16x16x32_bf16 v[144:147], a[128:131], a[184:187], v[144:147]
  buffer_load_dwordx4 v5, s[8:11], s23 offen offset:3072 lds
  v_cvt_pk_bf16_f32 v114, v116, v117
  v_cvt_pk_bf16_f32 v115, v118, v119
  v_mfma_f32_16x16x32_bf16 v[144:147], a[132:135], a[188:191], v[144:147]
  v_cvt_pk_bf16_f32 v120, v120, v121
  v_cvt_pk_bf16_f32 v121, v122, v123
  v_mfma_f32_16x16x32_bf16 v[148:151], a[140:143], a[188:191], v[148:151]
  s_add_u32 s94, s92, 4096
  buffer_store_dwordx4 v[64:67], v1, s[16:19], s94 offen offset:0
  v_cvt_pk_bf16_f32 v122, v124, v125
  v_cvt_pk_bf16_f32 v123, v126, v127
  v_mfma_f32_16x16x32_bf16 v[148:151], a[136:139], a[184:187], v[148:151]
  v_mfma_f32_16x16x32_bf16 v[152:155], a[144:147], a[184:187], v[152:155]
  v_mfma_f32_16x16x32_bf16 v[152:155], a[148:151], a[188:191], v[152:155]
  ds_read_b64_tr_b16 a[60:61], v15 offset:16384
  ds_read_b64_tr_b16 a[62:63], v15 offset:18432
  v_mfma_f32_16x16x32_bf16 v[156:159], a[156:159], a[188:191], v[156:159]
  s_add_u32 m0, s29, 65536
  s_nop 0
  buffer_load_dwordx4 v6, s[12:15], s24 offen offset:0 lds
  v_mfma_f32_16x16x32_bf16 v[156:159], a[152:155], a[184:187], v[156:159]
  s_waitcnt lgkmcnt(10)
  v_mfma_f32_16x16x32_bf16 v[160:163], a[96:99], a[160:163], v[160:163]
  v_mfma_f32_16x16x32_bf16 v[160:163], a[100:103], a[164:167], v[160:163]
  ds_read_b128 a[176:179], v10 offset:53248
  ds_read_b128 a[180:183], v11 offset:53248
  v_mfma_f32_16x16x32_bf16 v[164:167], a[108:111], a[164:167], v[164:167]
  s_add_u32 s94, s92, 4096
  buffer_store_dwordx4 v[72:75], v1, s[16:19], s94 offen offset:1024
  v_mfma_f32_16x16x32_bf16 v[164:167], a[104:107], a[160:163], v[164:167]
  ds_read_b64_tr_b16 a[68:69], v16 offset:16384
  ds_read_b64_tr_b16 a[70:71], v16 offset:18432
  v_cvt_pk_bf16_f32 v128, v128, v129
  v_cvt_pk_bf16_f32 v129, v130, v131
  v_mfma_f32_16x16x32_bf16 v[168:171], a[112:115], a[160:163], v[168:171]
  v_cvt_pk_bf16_f32 v130, v132, v133
  v_cvt_pk_bf16_f32 v131, v134, v135
  v_mfma_f32_16x16x32_bf16 v[168:171], a[116:119], a[164:167], v[168:171]
  buffer_load_dwordx4 v7, s[12:15], s24 offen offset:1024 lds
  v_cvt_pk_bf16_f32 v136, v136, v137
  v_cvt_pk_bf16_f32 v137, v138, v139
  v_mfma_f32_16x16x32_bf16 v[172:175], a[124:127], a[164:167], v[172:175]
  v_cvt_pk_bf16_f32 v138, v140, v141
  v_cvt_pk_bf16_f32 v139, v142, v143
  v_mfma_f32_16x16x32_bf16 v[172:175], a[120:123], a[160:163], v[172:175]
  v_cvt_pk_bf16_f32 v144, v144, v145
  v_cvt_pk_bf16_f32 v145, v146, v147
  v_mfma_f32_16x16x32_bf16 v[176:179], a[128:131], a[160:163], v[176:179]
  s_add_u32 s94, s92, 4096
  buffer_store_dwordx4 v[80:83], v1, s[16:19], s94 offen offset:2048
  v_cvt_pk_bf16_f32 v146, v148, v149
  v_cvt_pk_bf16_f32 v147, v150, v151
  v_mfma_f32_16x16x32_bf16 v[176:179], a[132:135], a[164:167], v[176:179]
  ds_read_b64_tr_b16 a[76:77], v17 offset:16384
  ds_read_b64_tr_b16 a[78:79], v17 offset:18432
  v_cvt_pk_bf16_f32 v152, v152, v153
  v_cvt_pk_bf16_f32 v153, v154, v155
  v_mfma_f32_16x16x32_bf16 v[180:183], a[140:143], a[164:167], v[180:183]
  v_cvt_pk_bf16_f32 v154, v156, v157
  v_cvt_pk_bf16_f32 v155, v158, v159
  v_mfma_f32_16x16x32_bf16 v[180:183], a[136:139], a[160:163], v[180:183]
  buffer_load_dwordx4 v8, s[12:15], s24 offen offset:2048 lds
  v_mfma_f32_16x16x32_bf16 v[184:187], a[144:147], a[160:163], v[184:187]
  v_mfma_f32_16x16x32_bf16 v[184:187], a[148:151], a[164:167], v[184:187]
  v_mfma_f32_16x16x32_bf16 v[188:191], a[156:159], a[164:167], v[188:191]
  buffer_load_dwordx4 v9, s[12:15], s24 offen offset:3072 lds
  v_mfma_f32_16x16x32_bf16 v[188:191], a[152:155], a[160:163], v[188:191]
  s_waitcnt lgkmcnt(12)
  ds_read_b64_tr_b16 a[84:85], v18 offset:16384
  ds_read_b64_tr_b16 a[86:87], v18 offset:18432
  v_mfma_f32_16x16x32_bf16 v[192:195], a[96:99], a[168:171], v[192:195]
  s_add_u32 s94, s92, 4096
  buffer_store_dwordx4 v[88:91], v1, s[16:19], s94 offen offset:3072
  v_mfma_f32_16x16x32_bf16 v[192:195], a[100:103], a[172:175], v[192:195]
  ds_read_b128 a[184:187], v10 offset:55296
  ds_read_b128 a[188:191], v11 offset:55296
  v_mfma_f32_16x16x32_bf16 v[196:199], a[108:111], a[172:175], v[196:199]
  v_mfma_f32_16x16x32_bf16 v[196:199], a[104:107], a[168:171], v[196:199]
  v_cvt_pk_bf16_f32 v160, v160, v161
  v_cvt_pk_bf16_f32 v161, v162, v163
  v_mfma_f32_16x16x32_bf16 v[200:203], a[112:115], a[168:171], v[200:203]
  v_cvt_pk_bf16_f32 v162, v164, v165
  v_cvt_pk_bf16_f32 v163, v166, v167
  v_mfma_f32_16x16x32_bf16 v[200:203], a[116:119], a[172:175], v[200:203]
  ds_read_b64_tr_b16 a[92:93], v19 offset:16384
  ds_read_b64_tr_b16 a[94:95], v19 offset:18432
  v_cvt_pk_bf16_f32 v168, v168, v169
  v_cvt_pk_bf16_f32 v169, v170, v171
  v_mfma_f32_16x16x32_bf16 v[204:207], a[124:127], a[172:175], v[204:207]
  s_add_u32 s94, s92, 8192
  buffer_store_dwordx4 v[96:99], v1, s[16:19], s94 offen offset:0
  v_cvt_pk_bf16_f32 v170, v172, v173
  v_cvt_pk_bf16_f32 v171, v174, v175
  v_mfma_f32_16x16x32_bf16 v[204:207], a[120:123], a[168:171], v[204:207]
  s_add_u32 s24, s24, 262144
  v_cvt_pk_bf16_f32 v176, v176, v177
  v_cvt_pk_bf16_f32 v177, v178, v179
  v_mfma_f32_16x16x32_bf16 v[208:211], a[128:131], a[168:171], v[208:211]
  v_cvt_pk_bf16_f32 v178, v180, v181
  v_cvt_pk_bf16_f32 v179, v182, v183
  v_mfma_f32_16x16x32_bf16 v[208:211], a[132:135], a[172:175], v[208:211]
  v_cvt_pk_bf16_f32 v184, v184, v185
  v_cvt_pk_bf16_f32 v185, v186, v187
  v_mfma_f32_16x16x32_bf16 v[212:215], a[140:143], a[172:175], v[212:215]
  buffer_load_dword v21, v20, s[60:63], s54 offen
  s_add_u32 s54, s54, s55
  v_cvt_pk_bf16_f32 v186, v188, v189
  v_cvt_pk_bf16_f32 v187, v190, v191
  v_mfma_f32_16x16x32_bf16 v[212:215], a[136:139], a[168:171], v[212:215]
  v_mfma_f32_16x16x32_bf16 v[216:219], a[144:147], a[168:171], v[216:219]
  v_mfma_f32_16x16x32_bf16 v[216:219], a[148:151], a[172:175], v[216:219]
  s_add_u32 s94, s92, 8192
  buffer_store_dwordx4 v[104:107], v1, s[16:19], s94 offen offset:1024
  v_mfma_f32_16x16x32_bf16 v[220:223], a[156:159], a[172:175], v[220:223]
  v_mfma_f32_16x16x32_bf16 v[220:223], a[152:155], a[168:171], v[220:223]
  s_waitcnt lgkmcnt(10)
  v_mfma_f32_16x16x32_bf16 v[224:227], a[96:99], a[176:179], v[224:227]
  s_cmp_eq_u32 s54, s56
  s_cselect_b32 s54, s57, s54
  s_cselect_b64 s[60:61], s[58:59], s[60:61]
  s_cselect_b32 s62, s7, s62
  v_mfma_f32_16x16x32_bf16 v[224:227], a[100:103], a[180:183], v[224:227]
  v_mfma_f32_16x16x32_bf16 v[228:231], a[108:111], a[180:183], v[228:231]
  v_mfma_f32_16x16x32_bf16 v[228:231], a[104:107], a[176:179], v[228:231]
  v_cvt_pk_bf16_f32 v192, v192, v193
  v_cvt_pk_bf16_f32 v193, v194, v195
  v_mfma_f32_16x16x32_bf16 v[232:235], a[112:115], a[176:179], v[232:235]
  s_add_u32 s94, s92, 8192
  buffer_store_dwordx4 v[112:115], v1, s[16:19], s94 offen offset:2048
  v_cvt_pk_bf16_f32 v194, v196, v197
  v_cvt_pk_bf16_f32 v195, v198, v199
  v_mfma_f32_16x16x32_bf16 v[232:235], a[116:119], a[180:183], v[232:235]
  v_cvt_pk_bf16_f32 v200, v200, v201
  v_cvt_pk_bf16_f32 v201, v202, v203
  v_mfma_f32_16x16x32_bf16 v[236:239], a[124:127], a[180:183], v[236:239]
  v_cvt_pk_bf16_f32 v202, v204, v205
  v_cvt_pk_bf16_f32 v203, v206, v207
  v_mfma_f32_16x16x32_bf16 v[236:239], a[120:123], a[176:179], v[236:239]
  s_waitcnt vmcnt(29) lgkmcnt(0)
  s_barrier
  ds_read_b128 a[160:163], v10 offset:0
  ds_read_b128 a[164:167], v11 offset:0
  v_cvt_pk_bf16_f32 v208, v208, v209
  v_cvt_pk_bf16_f32 v209, v210, v211
  v_mfma_f32_16x16x32_bf16 v[240:243], a[128:131], a[176:179], v[240:243]
  s_add_u32 m0, s29, 49152
  s_add_u32 s3, s23, s31
  buffer_load_dwordx4 v2, s[8:11], s3 offen offset:0 lds
  v_cvt_pk_bf16_f32 v210, v212, v213
  v_cvt_pk_bf16_f32 v211, v214, v215
  v_mfma_f32_16x16x32_bf16 v[240:243], a[132:135], a[180:183], v[240:243]
  v_cvt_pk_bf16_f32 v216, v216, v217
  v_cvt_pk_bf16_f32 v217, v218, v219
  v_mfma_f32_16x16x32_bf16 v[244:247], a[140:143], a[180:183], v[244:247]
  v_cvt_pk_bf16_f32 v218, v220, v221
  v_cvt_pk_bf16_f32 v219, v222, v223
  v_mfma_f32_16x16x32_bf16 v[244:247], a[136:139], a[176:179], v[244:247]
  s_add_u32 s94, s92, 8192
  buffer_store_dwordx4 v[120:123], v1, s[16:19], s94 offen offset:3072
  v_mfma_f32_16x16x32_bf16 v[248:251], a[144:147], a[176:179], v[248:251]
  v_mfma_f32_16x16x32_bf16 v[248:251], a[148:151], a[180:183], v[248:251]
  buffer_load_dwordx4 v3, s[8:11], s3 offen offset:1024 lds
  v_mfma_f32_16x16x32_bf16 v[252:255], a[156:159], a[180:183], v[252:255]
  v_mfma_f32_16x16x32_bf16 v[252:255], a[152:155], a[176:179], v[252:255]
  v_mfma_f32_16x16x32_bf16 a[0:3], a[96:99], a[184:187], a[0:3]
  v_mfma_f32_16x16x32_bf16 a[0:3], a[100:103], a[188:191], a[0:3]
  ds_read_b128 a[168:171], v10 offset:2048
  ds_read_b128 a[172:175], v11 offset:2048
  v_mfma_f32_16x16x32_bf16 a[4:7], a[108:111], a[188:191], a[4:7]
  s_add_u32 s94, s92, 12288
  buffer_store_dwordx4 v[128:131], v1, s[16:19], s94 offen offset:0
  v_mfma_f32_16x16x32_bf16 a[4:7], a[104:107], a[184:187], a[4:7]
  v_cvt_pk_bf16_f32 v224, v224, v225
  v_cvt_pk_bf16_f32 v225, v226, v227
  v_mfma_f32_16x16x32_bf16 a[8:11], a[112:115], a[184:187], a[8:11]
  v_cvt_pk_bf16_f32 v226, v228, v229
  v_cvt_pk_bf16_f32 v227, v230, v231
  v_mfma_f32_16x16x32_bf16 a[8:11], a[116:119], a[188:191], a[8:11]
  buffer_load_dwordx4 v4, s[8:11], s3 offen offset:2048 lds
  v_cvt_pk_bf16_f32 v232, v232, v233
  v_cvt_pk_bf16_f32 v233, v234, v235
  v_mfma_f32_16x16x32_bf16 a[12:15], a[124:127], a[188:191], a[12:15]
  v_cvt_pk_bf16_f32 v234, v236, v237
  v_cvt_pk_bf16_f32 v235, v238, v239
  v_mfma_f32_16x16x32_bf16 a[12:15], a[120:123], a[184:187], a[12:15]
  v_cvt_pk_bf16_f32 v240, v240, v241
  v_cvt_pk_bf16_f32 v241, v242, v243
  v_mfma_f32_16x16x32_bf16 a[16:19], a[128:131], a[184:187], a[16:19]
  v_cvt_pk_bf16_f32 v242, v244, v245
  v_cvt_pk_bf16_f32 v243, v246, v247
  v_mfma_f32_16x16x32_bf16 a[16:19], a[132:135], a[188:191], a[16:19]
  s_add_u32 s94, s92, 12288
  buffer_store_dwordx4 v[136:139], v1, s[16:19], s94 offen offset:1024
  v_cvt_pk_bf16_f32 v248, v248, v249
  v_cvt_pk_bf16_f32 v249, v250, v251
  v_mfma_f32_16x16x32_bf16 a[20:23], a[140:143], a[188:191], a[20:23]
  buffer_load_dwordx4 v5, s[8:11], s3 offen offset:3072 lds
  v_cvt_pk_bf16_f32 v250, v252, v253
  v_cvt_pk_bf16_f32 v251, v254, v255
  v_mfma_f32_16x16x32_bf16 a[20:23], a[136:139], a[184:187], a[20:23]
  v_mfma_f32_16x16x32_bf16 a[24:27], a[144:147], a[184:187], a[24:27]
  v_mfma_f32_16x16x32_bf16 a[24:27], a[148:151], a[188:191], a[24:27]
  v_mfma_f32_16x16x32_bf16 a[28:31], a[156:159], a[188:191], a[28:31]
  v_mfma_f32_16x16x32_bf16 a[28:31], a[152:155], a[184:187], a[28:31]
  s_waitcnt lgkmcnt(2)
  v_mfma_f32_16x16x32_bf16 v[32:35], a[160:163], a[32:35], 0
  s_add_u32 s94, s92, 12288
  buffer_store_dwordx4 v[144:147], v1, s[16:19], s94 offen offset:2048
  v_mfma_f32_16x16x32_bf16 v[32:35], a[164:167], a[36:39], v[32:35]
  ds_read_b128 a[176:179], v10 offset:4096
  ds_read_b128 a[180:183], v11 offset:4096
  v_mfma_f32_16x16x32_bf16 v[36:39], a[164:167], a[44:47], 0
  s_add_u32 s23, s23, 128
  s_cmp_eq_u32 s23, s25
  s_cselect_b32 s23, s26, s23
  v_mfma_f32_16x16x32_bf16 v[36:39], a[160:163], a[40:43], v[36:39]
  ds_read_b64_tr_b16 a[96:97], v12 offset:32768
  ds_read_b64_tr_b16 a[98:99], v12 offset:34816
  v_mfma_f32_16x16x32_bf16 v[40:43], a[160:163], a[48:51], 0
  v_mfma_f32_16x16x32_bf16 v[40:43], a[164:167], a[52:55], v[40:43]
  v_mfma_f32_16x16x32_bf16 v[44:47], a[164:167], a[60:63], 0
  s_add_u32 m0, s29, 81920
  s_nop 0
  buffer_load_dwordx4 v6, s[12:15], s24 offen offset:0 lds
  v_accvgpr_read_b32 v24, a0
  v_accvgpr_read_b32 v25, a1
  v_mfma_f32_16x16x32_bf16 v[44:47], a[160:163], a[56:59], v[44:47]
  ds_read_b64_tr_b16 a[104:105], v13 offset:32768
  ds_read_b64_tr_b16 a[106:107], v13 offset:34816
  v_accvgpr_read_b32 v26, a2
  v_accvgpr_read_b32 v27, a3
  v_mfma_f32_16x16x32_bf16 v[48:51], a[160:163], a[64:67], 0
  s_add_u32 s94, s92, 12288
  buffer_store_dwordx4 v[152:155], v1, s[16:19], s94 offen offset:3072
  v_accvgpr_read_b32 v28, a4
  v_accvgpr_read_b32 v29, a5
  v_mfma_f32_16x16x32_bf16 v[48:51], a[164:167], a[68:71], v[48:51]
  v_accvgpr_read_b32 v30, a6
  v_accvgpr_read_b32 v31, a7
  v_mfma_f32_16x16x32_bf16 v[52:55], a[164:167], a[76:79], 0
  v_cvt_pk_bf16_f32 v24, v24, v25
  v_cvt_pk_bf16_f32 v25, v26, v27
  v_mfma_f32_16x16x32_bf16 v[52:55], a[160:163], a[72:75], v[52:55]
  ds_read_b64_tr_b16 a[112:113], v14 offset:32768
  ds_read_b64_tr_b16 a[114:115], v14 offset:34816
  v_cvt_pk_bf16_f32 v26, v28, v29
  v_cvt_pk_bf16_f32 v27, v30, v31
  v_mfma_f32_16x16x32_bf16 v[56:59], a[160:163], a[80:83], 0
  buffer_load_dwordx4 v7, s[12:15], s24 offen offset:1024 lds
  v_mfma_f32_16x16x32_bf16 v[56:59], a[164:167], a[84:87], v[56:59]
  v_mfma_f32_16x16x32_bf16 v[60:63], a[164:167], a[92:95], 0
  s_add_u32 s94, s93, 0
  buffer_store_dwordx4 v[160:163], v1, s[16:19], s94 offen offset:0
  v_mfma_f32_16x16x32_bf16 v[60:63], a[160:163], a[88:91], v[60:63]
  s_waitcnt lgkmcnt(8)
  ds_read_b64_tr_b16 a[120:121], v15 offset:32768
  ds_read_b64_tr_b16 a[122:123], v15 offset:34816
  v_mfma_f32_16x16x32_bf16 v[64:67], a[168:171], a[32:35], 0
  s_add_u32 s94, s93, 12288
  buffer_store_dwordx4 v[24:27], v1, s[16:19], s94 offen offset:0
  v_mfma_f32_16x16x32_bf16 v[64:67], a[172:175], a[36:39], v[64:67]
  ds_read_b128 a[184:187], v10 offset:6144
  ds_read_b128 a[188:191], v11 offset:6144
  v_mfma_f32_16x16x32_bf16 v[68:71], a[172:175], a[44:47], 0
  v_mfma_f32_16x16x32_bf16 v[68:71], a[168:171], a[40:43], v[68:71]
  ds_read_b64_tr_b16 a[128:129], v16 offset:32768
  ds_read_b64_tr_b16 a[130:131], v16 offset:34816
  v_mfma_f32_16x16x32_bf16 v[72:75], a[168:171], a[48:51], 0
  v_mfma_f32_16x16x32_bf16 v[72:75], a[172:175], a[52:55], v[72:75]
  s_add_u32 s94, s93, 0
  buffer_store_dwordx4 v[168:171], v1, s[16:19], s94 offen offset:1024
  v_mfma_f32_16x16x32_bf16 v[76:79], a[172:175], a[60:63], 0
  buffer_load_dwordx4 v8, s[12:15], s24 offen offset:2048 lds
  v_mfma_f32_16x16x32_bf16 v[76:79], a[168:171], a[56:59], v[76:79]
  ds_read_b64_tr_b16 a[136:137], v17 offset:32768
  ds_read_b64_tr_b16 a[138:139], v17 offset:34816
  v_mfma_f32_16x16x32_bf16 v[80:83], a[168:171], a[64:67], 0
  v_mfma_f32_16x16x32_bf16 v[80:83], a[172:175], a[68:71], v[80:83]
  v_mfma_f32_16x16x32_bf16 v[84:87], a[172:175], a[76:79], 0
  buffer_load_dwordx4 v9, s[12:15], s24 offen offset:3072 lds
  v_mfma_f32_16x16x32_bf16 v[84:87], a[168:171], a[72:75], v[84:87]
  ds_read_b64_tr_b16 a[144:145], v18 offset:32768
  ds_read_b64_tr_b16 a[146:147], v18 offset:34816
  v_mfma_f32_16x16x32_bf16 v[88:91], a[168:171], a[80:83], 0
  s_add_u32 s94, s93, 0
  buffer_store_dwordx4 v[176:179], v1, s[16:19], s94 offen offset:2048
  v_mfma_f32_16x16x32_bf16 v[88:91], a[172:175], a[84:87], v[88:91]
  v_mfma_f32_16x16x32_bf16 v[92:95], a[172:175], a[92:95], 0
  v_mfma_f32_16x16x32_bf16 v[92:95], a[168:171], a[88:91], v[92:95]
  s_waitcnt lgkmcnt(15)
  ds_read_b64_tr_b16 a[152:153], v19 offset:32768
  ds_read_b64_tr_b16 a[154:155], v19 offset:34816
  v_mfma_f32_16x16x32_bf16 v[96:99], a[176:179], a[32:35], 0
  s_add_u32 s24, s24, 262144
  s_cmp_eq_u32 s24, s27
  s_cselect_b32 s24, s28, s24
  s_sub_u32 s6, s6, 1
  s_cmp_eq_u32 s6, 0
  s_cselect_b64 s[12:13], s[64:65], s[12:13]
  v_accvgpr_read_b32 v24, a8
  v_accvgpr_read_b32 v25, a9
  v_mfma_f32_16x16x32_bf16 v[96:99], a[180:183], a[36:39], v[96:99]
  v_accvgpr_read_b32 v26, a10
  v_accvgpr_read_b32 v27, a11
  v_mfma_f32_16x16x32_bf16 v[100:103], a[180:183], a[44:47], 0
  v_accvgpr_read_b32 v28, a12
  v_accvgpr_read_b32 v29, a13
  v_mfma_f32_16x16x32_bf16 v[100:103], a[176:179], a[40:43], v[100:103]
  s_add_u32 s94, s93, 0
  buffer_store_dwordx4 v[184:187], v1, s[16:19], s94 offen offset:3072
  v_accvgpr_read_b32 v30, a14
  v_accvgpr_read_b32 v31, a15
  v_mfma_f32_16x16x32_bf16 v[104:107], a[176:179], a[48:51], 0
  v_cvt_pk_bf16_f32 v24, v24, v25
  v_cvt_pk_bf16_f32 v25, v26, v27
  v_mfma_f32_16x16x32_bf16 v[104:107], a[180:183], a[52:55], v[104:107]
  v_cvt_pk_bf16_f32 v26, v28, v29
  v_cvt_pk_bf16_f32 v27, v30, v31
  v_mfma_f32_16x16x32_bf16 v[108:111], a[180:183], a[60:63], 0
  v_mfma_f32_16x16x32_bf16 v[108:111], a[176:179], a[56:59], v[108:111]
  s_waitcnt vmcnt(38) lgkmcnt(0)
  s_barrier
  ds_read_b128 a[160:163], v10 offset:16384
  ds_read_b128 a[164:167], v11 offset:16384
  v_mfma_f32_16x16x32_bf16 v[112:115], a[176:179], a[64:67], 0
  s_add_u32 m0, s29, 0
  s_nop 0
  buffer_load_dwordx4 v2, s[8:11], s23 offen offset:0 lds
  v_mfma_f32_16x16x32_bf16 v[112:115], a[180:183], a[68:71], v[112:115]
  s_add_u32 s94, s93, 12288
  buffer_store_dwordx4 v[24:27], v1, s[16:19], s94 offen offset:1024
  v_mfma_f32_16x16x32_bf16 v[116:119], a[180:183], a[76:79], 0
  s_add_u32 s94, s93, 4096
  buffer_store_dwordx4 v[192:195], v1, s[16:19], s94 offen offset:0
  v_mfma_f32_16x16x32_bf16 v[116:119], a[176:179], a[72:75], v[116:119]
  ds_read_b64_tr_b16 a[100:101], v12 offset:49152
  ds_read_b64_tr_b16 a[102:103], v12 offset:51200
  v_mfma_f32_16x16x32_bf16 v[120:123], a[176:179], a[80:83], 0
  v_mfma_f32_16x16x32_bf16 v[120:123], a[180:183], a[84:87], v[120:123]
  v_mfma_f32_16x16x32_bf16 v[124:127], a[180:183], a[92:95], 0
  buffer_load_dwordx4 v3, s[8:11], s23 offen offset:1024 lds
  v_mfma_f32_16x16x32_bf16 v[124:127], a[176:179], a[88:91], v[124:127]
  v_mfma_f32_16x16x32_bf16 v[128:131], a[184:187], a[32:35], 0
  v_mfma_f32_16x16x32_bf16 v[128:131], a[188:191], a[36:39], v[128:131]
  ds_read_b128 a[168:171], v10 offset:18432
  ds_read_b128 a[172:175], v11 offset:18432
  ds_read_b64_tr_b16 a[108:109], v13 offset:49152
  ds_read_b64_tr_b16 a[110:111], v13 offset:51200
  v_mfma_f32_16x16x32_bf16 v[132:135], a[188:191], a[44:47], 0
  s_add_u32 s94, s93, 4096
  buffer_store_dwordx4 v[200:203], v1, s[16:19], s94 offen offset:1024
  v_mfma_f32_16x16x32_bf16 v[132:135], a[184:187], a[40:43], v[132:135]
  v_mfma_f32_16x16x32_bf16 v[136:139], a[184:187], a[48:51], 0
  buffer_load_dwordx4 v4, s[8:11], s23 offen offset:2048 lds
  v_mfma_f32_16x16x32_bf16 v[136:139], a[188:191], a[52:55], v[136:139]
  v_mfma_f32_16x16x32_bf16 v[140:143], a[188:191], a[60:63], 0
  v_mfma_f32_16x16x32_bf16 v[140:143], a[184:187], a[56:59], v[140:143]
  ds_read_b64_tr_b16 a[116:117], v14 offset:49152
  ds_read_b64_tr_b16 a[118:119], v14 offset:51200
  v_mfma_f32_16x16x32_bf16 v[144:147], a[184:187], a[64:67], 0
  s_add_u32 s94, s93, 4096
  buffer_store_dwordx4 v[208:211], v1, s[16:19], s94 offen offset:2048
  v_mfma_f32_16x16x32_bf16 v[144:147], a[188:191], a[68:71], v[144:147]
  v_mfma_f32_16x16x32_bf16 v[148:151], a[188:191], a[76:79], 0
  buffer_load_dwordx4 v5, s[8:11], s23 offen offset:3072 lds
  v_accvgpr_read_b32 v24, a16
  v_accvgpr_read_b32 v25, a17
  v_mfma_f32_16x16x32_bf16 v[148:151], a[184:187], a[72:75], v[148:151]
  v_accvgpr_read_b32 v26, a18
  v_accvgpr_read_b32 v27, a19
  v_mfma_f32_16x16x32_bf16 v[152:155], a[184:187], a[80:83], 0
  v_accvgpr_read_b32 v28, a20
  v_accvgpr_read_b32 v29, a21
  v_mfma_f32_16x16x32_bf16 v[152:155], a[188:191], a[84:87], v[152:155]
  ds_read_b64_tr_b16 a[124:125], v15 offset:49152
  ds_read_b64_tr_b16 a[126:127], v15 offset:51200
  v_accvgpr_read_b32 v30, a22
  v_accvgpr_read_b32 v31, a23
  v_mfma_f32_16x16x32_bf16 v[156:159], a[188:191], a[92:95], 0
  s_add_u32 m0, s29, 98304
  s_nop 0
  buffer_load_dwordx4 v6, s[12:15], s24 offen offset:0 lds
  v_cvt_pk_bf16_f32 v24, v24, v25
  v_cvt_pk_bf16_f32 v25, v26, v27
  v_mfma_f32_16x16x32_bf16 v[156:159], a[184:187], a[88:91], v[156:159]
  s_add_u32 s94, s93, 4096
  buffer_store_dwordx4 v[216:219], v1, s[16:19], s94 offen offset:3072
  s_waitcnt lgkmcnt(10)
  v_cvt_pk_bf16_f32 v26, v28, v29
  v_cvt_pk_bf16_f32 v27, v30, v31
  v_mfma_f32_16x16x32_bf16 v[160:163], a[160:163], a[32:35], 0
  v_mfma_f32_16x16x32_bf16 v[160:163], a[164:167], a[36:39], v[160:163]
  ds_read_b128 a[176:179], v10 offset:20480
  ds_read_b128 a[180:183], v11 offset:20480
  v_mfma_f32_16x16x32_bf16 v[164:167], a[164:167], a[44:47], 0
  v_mfma_f32_16x16x32_bf16 v[164:167], a[160:163], a[40:43], v[164:167]
  ds_read_b64_tr_b16 a[132:133], v16 offset:49152
  ds_read_b64_tr_b16 a[134:135], v16 offset:51200
  v_mfma_f32_16x16x32_bf16 v[168:171], a[160:163], a[48:51], 0
  s_add_u32 s94, s93, 12288
  buffer_store_dwordx4 v[24:27], v1, s[16:19], s94 offen offset:2048
  v_mfma_f32_16x16x32_bf16 v[168:171], a[164:167], a[52:55], v[168:171]
  v_mfma_f32_16x16x32_bf16 v[172:175], a[164:167], a[60:63], 0
  s_add_u32 s94, s93, 8192
  buffer_store_dwordx4 v[224:227], v1, s[16:19], s94 offen offset:0
  v_mfma_f32_16x16x32_bf16 v[172:175], a[160:163], a[56:59], v[172:175]
  buffer_load_dwordx4 v7, s[12:15], s24 offen offset:1024 lds
  v_mfma_f32_16x16x32_bf16 v[176:179], a[160:163], a[64:67], 0
  v_mfma_f32_16x16x32_bf16 v[176:179], a[164:167], a[68:71], v[176:179]
  ds_read_b64_tr_b16 a[140:141], v17 offset:49152
  ds_read_b64_tr_b16 a[142:143], v17 offset:51200
  v_mfma_f32_16x16x32_bf16 v[180:183], a[164:167], a[76:79], 0
  v_mfma_f32_16x16x32_bf16 v[180:183], a[160:163], a[72:75], v[180:183]
  buffer_load_dwordx4 v8, s[12:15], s24 offen offset:2048 lds
  v_mfma_f32_16x16x32_bf16 v[184:187], a[160:163], a[80:83], 0
  v_mfma_f32_16x16x32_bf16 v[184:187], a[164:167], a[84:87], v[184:187]
  s_add_u32 s94, s93, 8192
  buffer_store_dwordx4 v[232:235], v1, s[16:19], s94 offen offset:1024
  v_mfma_f32_16x16x32_bf16 v[188:191], a[164:167], a[92:95], 0
  v_mfma_f32_16x16x32_bf16 v[188:191], a[160:163], a[88:91], v[188:191]
  s_waitcnt lgkmcnt(12)
  ds_read_b64_tr_b16 a[148:149], v18 offset:49152
  ds_read_b64_tr_b16 a[150:151], v18 offset:51200
  v_mfma_f32_16x16x32_bf16 v[192:195], a[168:171], a[32:35], 0
  v_mfma_f32_16x16x32_bf16 v[192:195], a[172:175], a[36:39], v[192:195]
  ds_read_b128 a[184:187], v10 offset:22528
  ds_read_b128 a[188:191], v11 offset:22528
  v_mfma_f32_16x16x32_bf16 v[196:199], a[172:175], a[44:47], 0
  buffer_load_dwordx4 v9, s[12:15], s24 offen offset:3072 lds
  v_mfma_f32_16x16x32_bf16 v[196:199], a[168:171], a[40:43], v[196:199]
  v_mfma_f32_16x16x32_bf16 v[200:203], a[168:171], a[48:51], 0
  s_add_u32 s94, s93, 8192
  buffer_store_dwordx4 v[240:243], v1, s[16:19], s94 offen offset:2048
  v_accvgpr_read_b32 v24, a24
  v_accvgpr_read_b32 v25, a25
  v_mfma_f32_16x16x32_bf16 v[200:203], a[172:175], a[52:55], v[200:203]
  ds_read_b64_tr_b16 a[156:157], v19 offset:49152
  ds_read_b64_tr_b16 a[158:159], v19 offset:51200
  v_accvgpr_read_b32 v26, a26
  v_accvgpr_read_b32 v27, a27
  v_mfma_f32_16x16x32_bf16 v[204:207], a[172:175], a[60:63], 0
  v_accvgpr_read_b32 v28, a28
  v_accvgpr_read_b32 v29, a29
  v_mfma_f32_16x16x32_bf16 v[204:207], a[168:171], a[56:59], v[204:207]
  s_add_u32 s24, s24, 262144
  v_accvgpr_read_b32 v30, a30
  v_accvgpr_read_b32 v31, a31
  v_mfma_f32_16x16x32_bf16 v[208:211], a[168:171], a[64:67], 0
  v_cvt_pk_bf16_f32 v24, v24, v25
  v_cvt_pk_bf16_f32 v25, v26, v27
  v_mfma_f32_16x16x32_bf16 v[208:211], a[172:175], a[68:71], v[208:211]
  v_cvt_pk_bf16_f32 v26, v28, v29
  v_cvt_pk_bf16_f32 v27, v30, v31
  v_mfma_f32_16x16x32_bf16 v[212:215], a[172:175], a[76:79], 0
  v_mfma_f32_16x16x32_bf16 v[212:215], a[168:171], a[72:75], v[212:215]
  s_add_u32 s94, s93, 8192
  buffer_store_dwordx4 v[248:251], v1, s[16:19], s94 offen offset:3072
  v_mfma_f32_16x16x32_bf16 v[216:219], a[168:171], a[80:83], 0
  buffer_load_dword v21, v20, s[60:63], s54 offen
  s_add_u32 s54, s54, s55
  v_mfma_f32_16x16x32_bf16 v[216:219], a[172:175], a[84:87], v[216:219]
  s_add_u32 s94, s93, 12288
  buffer_store_dwordx4 v[24:27], v1, s[16:19], s94 offen offset:3072
  v_mfma_f32_16x16x32_bf16 v[220:223], a[172:175], a[92:95], 0
  v_mfma_f32_16x16x32_bf16 v[220:223], a[168:171], a[88:91], v[220:223]
  s_waitcnt lgkmcnt(10)
  v_mfma_f32_16x16x32_bf16 v[224:227], a[176:179], a[32:35], 0
  v_mfma_f32_16x16x32_bf16 v[224:227], a[180:183], a[36:39], v[224:227]
  s_cmp_eq_u32 s54, s56
  s_cselect_b32 s54, s57, s54
  s_cselect_b64 s[60:61], s[58:59], s[60:61]
  s_cselect_b32 s62, s7, s62
  v_mfma_f32_16x16x32_bf16 v[228:231], a[180:183], a[44:47], 0
  v_mfma_f32_16x16x32_bf16 v[228:231], a[176:179], a[40:43], v[228:231]
  v_mfma_f32_16x16x32_bf16 v[232:235], a[176:179], a[48:51], 0
  v_mfma_f32_16x16x32_bf16 v[232:235], a[180:183], a[52:55], v[232:235]
  v_mfma_f32_16x16x32_bf16 v[236:239], a[180:183], a[60:63], 0
  v_mfma_f32_16x16x32_bf16 v[236:239], a[176:179], a[56:59], v[236:239]
  s_waitcnt vmcnt(43) lgkmcnt(0)
  s_barrier
  ds_read_b128 a[160:163], v10 offset:32768
  ds_read_b128 a[164:167], v11 offset:32768
  v_mfma_f32_16x16x32_bf16 v[240:243], a[176:179], a[64:67], 0
  s_add_u32 m0, s29, 16384
  s_add_u32 s3, s23, s31
  buffer_load_dwordx4 v2, s[8:11], s3 offen offset:0 lds
  v_mfma_f32_16x16x32_bf16 v[240:243], a[180:183], a[68:71], v[240:243]
  v_mfma_f32_16x16x32_bf16 v[244:247], a[180:183], a[76:79], 0
  v_mfma_f32_16x16x32_bf16 v[244:247], a[176:179], a[72:75], v[244:247]
  v_mfma_f32_16x16x32_bf16 v[248:251], a[176:179], a[80:83], 0
  v_mfma_f32_16x16x32_bf16 v[248:251], a[180:183], a[84:87], v[248:251]
  buffer_load_dwordx4 v3, s[8:11], s3 offen offset:1024 lds
  v_mfma_f32_16x16x32_bf16 v[252:255], a[180:183], a[92:95], 0
  v_mfma_f32_16x16x32_bf16 v[252:255], a[176:179], a[88:91], v[252:255]
  v_mfma_f32_16x16x32_bf16 a[0:3], a[184:187], a[32:35], 0
  v_mfma_f32_16x16x32_bf16 a[0:3], a[188:191], a[36:39], a[0:3]
  ds_read_b128 a[168:171], v10 offset:34816
  ds_read_b128 a[172:175], v11 offset:34816
  v_mfma_f32_16x16x32_bf16 a[4:7], a[188:191], a[44:47], 0
  v_mfma_f32_16x16x32_bf16 a[4:7], a[184:187], a[40:43], a[4:7]
  v_mfma_f32_16x16x32_bf16 a[8:11], a[184:187], a[48:51], 0
  buffer_load_dwordx4 v4, s[8:11], s3 offen offset:2048 lds
  v_mfma_f32_16x16x32_bf16 a[8:11], a[188:191], a[52:55], a[8:11]
  v_mfma_f32_16x16x32_bf16 a[12:15], a[188:191], a[60:63], 0
  v_mfma_f32_16x16x32_bf16 a[12:15], a[184:187], a[56:59], a[12:15]
  v_mfma_f32_16x16x32_bf16 a[16:19], a[184:187], a[64:67], 0
  v_mfma_f32_16x16x32_bf16 a[16:19], a[188:191], a[68:71], a[16:19]
  buffer_load_dwordx4 v5, s[8:11], s3 offen offset:3072 lds
  v_mfma_f32_16x16x32_bf16 a[20:23], a[188:191], a[76:79], 0
  v_mfma_f32_16x16x32_bf16 a[20:23], a[184:187], a[72:75], a[20:23]
  v_mfma_f32_16x16x32_bf16 a[24:27], a[184:187], a[80:83], 0
  v_mfma_f32_16x16x32_bf16 a[24:27], a[188:191], a[84:87], a[24:27]
  v_mfma_f32_16x16x32_bf16 a[28:31], a[188:191], a[92:95], 0
  v_mfma_f32_16x16x32_bf16 a[28:31], a[184:187], a[88:91], a[28:31]
  s_waitcnt lgkmcnt(2)
  v_mfma_f32_16x16x32_bf16 v[32:35], a[160:163], a[96:99], v[32:35]
  s_add_u32 s23, s23, 128
  s_cmp_eq_u32 s23, s25
  s_cselect_b32 s23, s26, s23
  v_mfma_f32_16x16x32_bf16 v[32:35], a[164:167], a[100:103], v[32:35]
  ds_read_b128 a[176:179], v10 offset:36864
  ds_read_b128 a[180:183], v11 offset:36864
  v_mfma_f32_16x16x32_bf16 v[36:39], a[164:167], a[108:111], v[36:39]
  v_mfma_f32_16x16x32_bf16 v[36:39], a[160:163], a[104:107], v[36:39]
  ds_read_b64_tr_b16 a[32:33], v12 offset:0
  ds_read_b64_tr_b16 a[34:35], v12 offset:2048
  v_mfma_f32_16x16x32_bf16 v[40:43], a[160:163], a[112:115], v[40:43]
  v_mfma_f32_16x16x32_bf16 v[40:43], a[164:167], a[116:119], v[40:43]
  v_mfma_f32_16x16x32_bf16 v[44:47], a[164:167], a[124:127], v[44:47]
  s_add_u32 m0, s29, 114688
  s_nop 0
  buffer_load_dwordx4 v6, s[12:15], s24 offen offset:0 lds
  v_mfma_f32_16x16x32_bf16 v[44:47], a[160:163], a[120:123], v[44:47]
  ds_read_b64_tr_b16 a[40:41], v13 offset:0
  ds_read_b64_tr_b16 a[42:43], v13 offset:2048
  v_mfma_f32_16x16x32_bf16 v[48:51], a[160:163], a[128:131], v[48:51]
  v_mfma_f32_16x16x32_bf16 v[48:51], a[164:167], a[132:135], v[48:51]
  v_mfma_f32_16x16x32_bf16 v[52:55], a[164:167], a[140:143], v[52:55]
  v_mfma_f32_16x16x32_bf16 v[52:55], a[160:163], a[136:139], v[52:55]
  ds_read_b64_tr_b16 a[48:49], v14 offset:0
  ds_read_b64_tr_b16 a[50:51], v14 offset:2048
  v_mfma_f32_16x16x32_bf16 v[56:59], a[160:163], a[144:147], v[56:59]
  v_mfma_f32_16x16x32_bf16 v[56:59], a[164:167], a[148:151], v[56:59]
  buffer_load_dwordx4 v7, s[12:15], s24 offen offset:1024 lds
  v_mfma_f32_16x16x32_bf16 v[60:63], a[164:167], a[156:159], v[60:63]
  v_mfma_f32_16x16x32_bf16 v[60:63], a[160:163], a[152:155], v[60:63]
  s_waitcnt lgkmcnt(8)
  ds_read_b64_tr_b16 a[56:57], v15 offset:0
  ds_read_b64_tr_b16 a[58:59], v15 offset:2048
  v_mfma_f32_16x16x32_bf16 v[64:67], a[168:171], a[96:99], v[64:67]
  v_mfma_f32_16x16x32_bf16 v[64:67], a[172:175], a[100:103], v[64:67]
  ds_read_b128 a[184:187], v10 offset:38912
  ds_read_b128 a[188:191], v11 offset:38912
  v_mfma_f32_16x16x32_bf16 v[68:71], a[172:175], a[108:111], v[68:71]
  v_mfma_f32_16x16x32_bf16 v[68:71], a[168:171], a[104:107], v[68:71]
  ds_read_b64_tr_b16 a[64:65], v16 offset:0
  ds_read_b64_tr_b16 a[66:67], v16 offset:2048
  v_mfma_f32_16x16x32_bf16 v[72:75], a[168:171], a[112:115], v[72:75]
  buffer_load_dwordx4 v8, s[12:15], s24 offen offset:2048 lds
  v_mfma_f32_16x16x32_bf16 v[72:75], a[172:175], a[116:119], v[72:75]
  v_mfma_f32_16x16x32_bf16 v[76:79], a[172:175], a[124:127], v[76:79]
  v_mfma_f32_16x16x32_bf16 v[76:79], a[168:171], a[120:123], v[76:79]
  ds_read_b64_tr_b16 a[72:73], v17 offset:0
  ds_read_b64_tr_b16 a[74:75], v17 offset:2048
  v_mfma_f32_16x16x32_bf16 v[80:83], a[168:171], a[128:131], v[80:83]
  v_mfma_f32_16x16x32_bf16 v[80:83], a[172:175], a[132:135], v[80:83]
  v_mfma_f32_16x16x32_bf16 v[84:87], a[172:175], a[140:143], v[84:87]
  buffer_load_dwordx4 v9, s[12:15], s24 offen offset:3072 lds
  v_mfma_f32_16x16x32_bf16 v[84:87], a[168:171], a[136:139], v[84:87]
  ds_read_b64_tr_b16 a[80:81], v18 offset:0
  ds_read_b64_tr_b16 a[82:83], v18 offset:2048
  v_mfma_f32_16x16x32_bf16 v[88:91], a[168:171], a[144:147], v[88:91]
  v_mfma_f32_16x16x32_bf16 v[88:91], a[172:175], a[148:151], v[88:91]
  v_mfma_f32_16x16x32_bf16 v[92:95], a[172:175], a[156:159], v[92:95]
  v_mfma_f32_16x16x32_bf16 v[92:95], a[168:171], a[152:155], v[92:95]
  s_waitcnt lgkmcnt(15)
  ds_read_b64_tr_b16 a[88:89], v19 offset:0
  ds_read_b64_tr_b16 a[90:91], v19 offset:2048
  v_mfma_f32_16x16x32_bf16 v[96:99], a[176:179], a[96:99], v[96:99]
  s_add_u32 s24, s24, 262144
  s_cmp_eq_u32 s24, s27
  s_cselect_b32 s24, s28, s24
  s_sub_u32 s6, s6, 1
  s_cmp_eq_u32 s6, 0
  s_cselect_b64 s[12:13], s[64:65], s[12:13]
  v_mfma_f32_16x16x32_bf16 v[96:99], a[180:183], a[100:103], v[96:99]
  v_mfma_f32_16x16x32_bf16 v[100:103], a[180:183], a[108:111], v[100:103]
  v_mfma_f32_16x16x32_bf16 v[100:103], a[176:179], a[104:107], v[100:103]
  v_mfma_f32_16x16x32_bf16 v[104:107], a[176:179], a[112:115], v[104:107]
  v_mfma_f32_16x16x32_bf16 v[104:107], a[180:183], a[116:119], v[104:107]
  v_mfma_f32_16x16x32_bf16 v[108:111], a[180:183], a[124:127], v[108:111]
  v_mfma_f32_16x16x32_bf16 v[108:111], a[176:179], a[120:123], v[108:111]
  s_waitcnt vmcnt(30) lgkmcnt(0)
  s_barrier
  ds_read_b128 a[160:163], v10 offset:49152
  ds_read_b128 a[164:167], v11 offset:49152
  v_mfma_f32_16x16x32_bf16 v[112:115], a[176:179], a[128:131], v[112:115]
  s_add_u32 m0, s29, 32768
  s_nop 0
  buffer_load_dwordx4 v2, s[8:11], s23 offen offset:0 lds
  v_mfma_f32_16x16x32_bf16 v[112:115], a[180:183], a[132:135], v[112:115]
  v_mfma_f32_16x16x32_bf16 v[116:119], a[180:183], a[140:143], v[116:119]
  v_mfma_f32_16x16x32_bf16 v[116:119], a[176:179], a[136:139], v[116:119]
  ds_read_b64_tr_b16 a[36:37], v12 offset:16384
  ds_read_b64_tr_b16 a[38:39], v12 offset:18432
  v_mfma_f32_16x16x32_bf16 v[120:123], a[176:179], a[144:147], v[120:123]
  v_mfma_f32_16x16x32_bf16 v[120:123], a[180:183], a[148:151], v[120:123]
  buffer_load_dwordx4 v3, s[8:11], s23 offen offset:1024 lds
  v_mfma_f32_16x16x32_bf16 v[124:127], a[180:183], a[156:159], v[124:127]
  v_mfma_f32_16x16x32_bf16 v[124:127], a[176:179], a[152:155], v[124:127]
  v_mfma_f32_16x16x32_bf16 v[128:131], a[184:187], a[96:99], v[128:131]
  v_mfma_f32_16x16x32_bf16 v[128:131], a[188:191], a[100:103], v[128:131]
  ds_read_b128 a[168:171], v10 offset:51200
  ds_read_b128 a[172:175], v11 offset:51200
  ds_read_b64_tr_b16 a[44:45], v13 offset:16384
  ds_read_b64_tr_b16 a[46:47], v13 offset:18432
  v_mfma_f32_16x16x32_bf16 v[132:135], a[188:191], a[108:111], v[132:135]
  v_mfma_f32_16x16x32_bf16 v[132:135], a[184:187], a[104:107], v[132:135]
  buffer_load_dwordx4 v4, s[8:11], s23 offen offset:2048 lds
  v_mfma_f32_16x16x32_bf16 v[136:139], a[184:187], a[112:115], v[136:139]
  v_mfma_f32_16x16x32_bf16 v[136:139], a[188:191], a[116:119], v[136:139]
  v_mfma_f32_16x16x32_bf16 v[140:143], a[188:191], a[124:127], v[140:143]
  v_mfma_f32_16x16x32_bf16 v[140:143], a[184:187], a[120:123], v[140:143]
  ds_read_b64_tr_b16 a[52:53], v14 offset:16384
  ds_read_b64_tr_b16 a[54:55], v14 offset:18432
  v_mfma_f32_16x16x32_bf16 v[144:147], a[184:187], a[128:131], v[144:147]
  v_mfma_f32_16x16x32_bf16 v[144:147], a[188:191], a[132:135], v[144:147]
  buffer_load_dwordx4 v5, s[8:11], s23 offen offset:3072 lds
  v_mfma_f32_16x16x32_bf16 v[148:151], a[188:191], a[140:143], v[148:151]
  v_mfma_f32_16x16x32_bf16 v[148:151], a[184:187], a[136:139], v[148:151]
  v_mfma_f32_16x16x32_bf16 v[152:155], a[184:187], a[144:147], v[152:155]
  v_mfma_f32_16x16x32_bf16 v[152:155], a[188:191], a[148:151], v[152:155]
  ds_read_b64_tr_b16 a[60:61], v15 offset:16384
  ds_read_b64_tr_b16 a[62:63], v15 offset:18432
  v_mfma_f32_16x16x32_bf16 v[156:159], a[188:191], a[156:159], v[156:159]
  s_add_u32 m0, s29, 65536
  s_nop 0
  buffer_load_dwordx4 v6, s[12:15], s24 offen offset:0 lds
  v_mfma_f32_16x16x32_bf16 v[156:159], a[184:187], a[152:155], v[156:159]
  s_waitcnt lgkmcnt(10)
  v_mfma_f32_16x16x32_bf16 v[160:163], a[160:163], a[96:99], v[160:163]
  v_mfma_f32_16x16x32_bf16 v[160:163], a[164:167], a[100:103], v[160:163]
  ds_read_b128 a[176:179], v10 offset:53248
  ds_read_b128 a[180:183], v11 offset:53248
  v_mfma_f32_16x16x32_bf16 v[164:167], a[164:167], a[108:111], v[164:167]
  v_mfma_f32_16x16x32_bf16 v[164:167], a[160:163], a[104:107], v[164:167]
  ds_read_b64_tr_b16 a[68:69], v16 offset:16384
  ds_read_b64_tr_b16 a[70:71], v16 offset:18432
  v_mfma_f32_16x16x32_bf16 v[168:171], a[160:163], a[112:115], v[168:171]
  v_mfma_f32_16x16x32_bf16 v[168:171], a[164:167], a[116:119], v[168:171]
  buffer_load_dwordx4 v7, s[12:15], s24 offen offset:1024 lds
  v_mfma_f32_16x16x32_bf16 v[172:175], a[164:167], a[124:127], v[172:175]
  v_mfma_f32_16x16x32_bf16 v[172:175], a[160:163], a[120:123], v[172:175]
  v_mfma_f32_16x16x32_bf16 v[176:179], a[160:163], a[128:131], v[176:179]
  v_mfma_f32_16x16x32_bf16 v[176:179], a[164:167], a[132:135], v[176:179]
  ds_read_b64_tr_b16 a[76:77], v17 offset:16384
  ds_read_b64_tr_b16 a[78:79], v17 offset:18432
  v_mfma_f32_16x16x32_bf16 v[180:183], a[164:167], a[140:143], v[180:183]
  v_mfma_f32_16x16x32_bf16 v[180:183], a[160:163], a[136:139], v[180:183]
  buffer_load_dwordx4 v8, s[12:15], s24 offen offset:2048 lds
  v_mfma_f32_16x16x32_bf16 v[184:187], a[160:163], a[144:147], v[184:187]
  v_mfma_f32_16x16x32_bf16 v[184:187], a[164:167], a[148:151], v[184:187]
  v_mfma_f32_16x16x32_bf16 v[188:191], a[164:167], a[156:159], v[188:191]
  v_mfma_f32_16x16x32_bf16 v[188:191], a[160:163], a[152:155], v[188:191]
  s_waitcnt lgkmcnt(12)
  ds_read_b64_tr_b16 a[84:85], v18 offset:16384
  ds_read_b64_tr_b16 a[86:87], v18 offset:18432
  v_mfma_f32_16x16x32_bf16 v[192:195], a[168:171], a[96:99], v[192:195]
  buffer_load_dwordx4 v9, s[12:15], s24 offen offset:3072 lds
  v_mfma_f32_16x16x32_bf16 v[192:195], a[172:175], a[100:103], v[192:195]
  ds_read_b128 a[184:187], v10 offset:55296
  ds_read_b128 a[188:191], v11 offset:55296
  v_mfma_f32_16x16x32_bf16 v[196:199], a[172:175], a[108:111], v[196:199]
  v_mfma_f32_16x16x32_bf16 v[196:199], a[168:171], a[104:107], v[196:199]
  v_mfma_f32_16x16x32_bf16 v[200:203], a[168:171], a[112:115], v[200:203]
  v_mfma_f32_16x16x32_bf16 v[200:203], a[172:175], a[116:119], v[200:203]
  ds_read_b64_tr_b16 a[92:93], v19 offset:16384
  ds_read_b64_tr_b16 a[94:95], v19 offset:18432
  v_mfma_f32_16x16x32_bf16 v[204:207], a[172:175], a[124:127], v[204:207]
  s_add_u32 s24, s24, 262144
  v_mfma_f32_16x16x32_bf16 v[204:207], a[168:171], a[120:123], v[204:207]
  v_mfma_f32_16x16x32_bf16 v[208:211], a[168:171], a[128:131], v[208:211]
  v_mfma_f32_16x16x32_bf16 v[208:211], a[172:175], a[132:135], v[208:211]
  v_mfma_f32_16x16x32_bf16 v[212:215], a[172:175], a[140:143], v[212:215]
  v_mfma_f32_16x16x32_bf16 v[212:215], a[168:171], a[136:139], v[212:215]
  buffer_load_dword v21, v20, s[60:63], s54 offen
  s_add_u32 s54, s54, s55
  v_mfma_f32_16x16x32_bf16 v[216:219], a[168:171], a[144:147], v[216:219]
  v_mfma_f32_16x16x32_bf16 v[216:219], a[172:175], a[148:151], v[216:219]
  v_mfma_f32_16x16x32_bf16 v[220:223], a[172:175], a[156:159], v[220:223]
  v_mfma_f32_16x16x32_bf16 v[220:223], a[168:171], a[152:155], v[220:223]
  s_waitcnt lgkmcnt(10)
  v_mfma_f32_16x16x32_bf16 v[224:227], a[176:179], a[96:99], v[224:227]
  s_cmp_eq_u32 s54, s56
  s_cselect_b32 s54, s57, s54
  s_cselect_b64 s[60:61], s[58:59], s[60:61]
  s_cselect_b32 s62, s7, s62
  v_mfma_f32_16x16x32_bf16 v[224:227], a[180:183], a[100:103], v[224:227]
  v_mfma_f32_16x16x32_bf16 v[228:231], a[180:183], a[108:111], v[228:231]
  v_mfma_f32_16x16x32_bf16 v[228:231], a[176:179], a[104:107], v[228:231]
  v_mfma_f32_16x16x32_bf16 v[232:235], a[176:179], a[112:115], v[232:235]
  v_mfma_f32_16x16x32_bf16 v[232:235], a[180:183], a[116:119], v[232:235]
  v_mfma_f32_16x16x32_bf16 v[236:239], a[180:183], a[124:127], v[236:239]
  v_mfma_f32_16x16x32_bf16 v[236:239], a[176:179], a[120:123], v[236:239]
  s_waitcnt vmcnt(21) lgkmcnt(0)
  s_barrier
  ds_read_b128 a[160:163], v10 offset:0
  ds_read_b128 a[164:167], v11 offset:0
  v_mfma_f32_16x16x32_bf16 v[240:243], a[176:179], a[128:131], v[240:243]
  s_add_u32 m0, s29, 49152
  s_add_u32 s3, s23, s31
  buffer_load_dwordx4 v2, s[8:11], s3 offen offset:0 lds
  v_mfma_f32_16x16x32_bf16 v[240:243], a[180:183], a[132:135], v[240:243]
  v_mfma_f32_16x16x32_bf16 v[244:247], a[180:183], a[140:143], v[244:247]
  v_mfma_f32_16x16x32_bf16 v[244:247], a[176:179], a[136:139], v[244:247]
  v_mfma_f32_16x16x32_bf16 v[248:251], a[176:179], a[144:147], v[248:251]
  v_mfma_f32_16x16x32_bf16 v[248:251], a[180:183], a[148:151], v[248:251]
  buffer_load_dwordx4 v3, s[8:11], s3 offen offset:1024 lds
  v_mfma_f32_16x16x32_bf16 v[252:255], a[180:183], a[156:159], v[252:255]
  v_mfma_f32_16x16x32_bf16 v[252:255], a[176:179], a[152:155], v[252:255]
  v_mfma_f32_16x16x32_bf16 a[0:3], a[184:187], a[96:99], a[0:3]
  v_mfma_f32_16x16x32_bf16 a[0:3], a[188:191], a[100:103], a[0:3]
  ds_read_b128 a[168:171], v10 offset:2048
  ds_read_b128 a[172:175], v11 offset:2048
  v_mfma_f32_16x16x32_bf16 a[4:7], a[188:191], a[108:111], a[4:7]
  v_mfma_f32_16x16x32_bf16 a[4:7], a[184:187], a[104:107], a[4:7]
  v_mfma_f32_16x16x32_bf16 a[8:11], a[184:187], a[112:115], a[8:11]
  buffer_load_dwordx4 v4, s[8:11], s3 offen offset:2048 lds
  v_mfma_f32_16x16x32_bf16 a[8:11], a[188:191], a[116:119], a[8:11]
  v_mfma_f32_16x16x32_bf16 a[12:15], a[188:191], a[124:127], a[12:15]
  v_mfma_f32_16x16x32_bf16 a[12:15], a[184:187], a[120:123], a[12:15]
  v_mfma_f32_16x16x32_bf16 a[16:19], a[184:187], a[128:131], a[16:19]
  v_mfma_f32_16x16x32_bf16 a[16:19], a[188:191], a[132:135], a[16:19]
  buffer_load_dwordx4 v5, s[8:11], s3 offen offset:3072 lds
  v_mfma_f32_16x16x32_bf16 a[20:23], a[188:191], a[140:143], a[20:23]
  v_mfma_f32_16x16x32_bf16 a[20:23], a[184:187], a[136:139], a[20:23]
  v_mfma_f32_16x16x32_bf16 a[24:27], a[184:187], a[144:147], a[24:27]
  v_mfma_f32_16x16x32_bf16 a[24:27], a[188:191], a[148:151], a[24:27]
  v_mfma_f32_16x16x32_bf16 a[28:31], a[188:191], a[156:159], a[28:31]
  v_mfma_f32_16x16x32_bf16 a[28:31], a[184:187], a[152:155], a[28:31]
  s_waitcnt lgkmcnt(2)
  v_mfma_f32_16x16x32_bf16 v[32:35], a[160:163], a[32:35], v[32:35]
  s_add_u32 s23, s23, 128
  s_cmp_eq_u32 s23, s25
  s_cselect_b32 s23, s26, s23
  v_mfma_f32_16x16x32_bf16 v[32:35], a[164:167], a[36:39], v[32:35]
  ds_read_b128 a[176:179], v10 offset:4096
  ds_read_b128 a[180:183], v11 offset:4096
  v_mfma_f32_16x16x32_bf16 v[36:39], a[164:167], a[44:47], v[36:39]
  v_mfma_f32_16x16x32_bf16 v[36:39], a[160:163], a[40:43], v[36:39]
  ds_read_b64_tr_b16 a[96:97], v12 offset:32768
  ds_read_b64_tr_b16 a[98:99], v12 offset:34816
  v_mfma_f32_16x16x32_bf16 v[40:43], a[160:163], a[48:51], v[40:43]
  v_mfma_f32_16x16x32_bf16 v[40:43], a[164:167], a[52:55], v[40:43]
  v_mfma_f32_16x16x32_bf16 v[44:47], a[164:167], a[60:63], v[44:47]
  s_add_u32 m0, s29, 81920
  s_nop 0
  buffer_load_dwordx4 v6, s[12:15], s24 offen offset:0 lds
  v_mfma_f32_16x16x32_bf16 v[44:47], a[160:163], a[56:59], v[44:47]
  ds_read_b64_tr_b16 a[104:105], v13 offset:32768
  ds_read_b64_tr_b16 a[106:107], v13 offset:34816
  v_mfma_f32_16x16x32_bf16 v[48:51], a[160:163], a[64:67], v[48:51]
  v_mfma_f32_16x16x32_bf16 v[48:51], a[164:167], a[68:71], v[48:51]
  v_mfma_f32_16x16x32_bf16 v[52:55], a[164:167], a[76:79], v[52:55]
  v_mfma_f32_16x16x32_bf16 v[52:55], a[160:163], a[72:75], v[52:55]
  ds_read_b64_tr_b16 a[112:113], v14 offset:32768
  ds_read_b64_tr_b16 a[114:115], v14 offset:34816
  v_mfma_f32_16x16x32_bf16 v[56:59], a[160:163], a[80:83], v[56:59]
  v_mfma_f32_16x16x32_bf16 v[56:59], a[164:167], a[84:87], v[56:59]
  buffer_load_dwordx4 v7, s[12:15], s24 offen offset:1024 lds
  v_mfma_f32_16x16x32_bf16 v[60:63], a[164:167], a[92:95], v[60:63]
  v_mfma_f32_16x16x32_bf16 v[60:63], a[160:163], a[88:91], v[60:63]
  s_waitcnt lgkmcnt(8)
  ds_read_b64_tr_b16 a[120:121], v15 offset:32768
  ds_read_b64_tr_b16 a[122:123], v15 offset:34816
  v_mfma_f32_16x16x32_bf16 v[64:67], a[168:171], a[32:35], v[64:67]
  v_mfma_f32_16x16x32_bf16 v[64:67], a[172:175], a[36:39], v[64:67]
  ds_read_b128 a[184:187], v10 offset:6144
  ds_read_b128 a[188:191], v11 offset:6144
  v_mfma_f32_16x16x32_bf16 v[68:71], a[172:175], a[44:47], v[68:71]
  v_mfma_f32_16x16x32_bf16 v[68:71], a[168:171], a[40:43], v[68:71]
  ds_read_b64_tr_b16 a[128:129], v16 offset:32768
  ds_read_b64_tr_b16 a[130:131], v16 offset:34816
  v_mfma_f32_16x16x32_bf16 v[72:75], a[168:171], a[48:51], v[72:75]
  buffer_load_dwordx4 v8, s[12:15], s24 offen offset:2048 lds
  v_mfma_f32_16x16x32_bf16 v[72:75], a[172:175], a[52:55], v[72:75]
  v_mfma_f32_16x16x32_bf16 v[76:79], a[172:175], a[60:63], v[76:79]
  v_mfma_f32_16x16x32_bf16 v[76:79], a[168:171], a[56:59], v[76:79]
  ds_read_b64_tr_b16 a[136:137], v17 offset:32768
  ds_read_b64_tr_b16 a[138:139], v17 offset:34816
  v_mfma_f32_16x16x32_bf16 v[80:83], a[168:171], a[64:67], v[80:83]
  v_mfma_f32_16x16x32_bf16 v[80:83], a[172:175], a[68:71], v[80:83]
  v_mfma_f32_16x16x32_bf16 v[84:87], a[172:175], a[76:79], v[84:87]
  buffer_load_dwordx4 v9, s[12:15], s24 offen offset:3072 lds
  v_mfma_f32_16x16x32_bf16 v[84:87], a[168:171], a[72:75], v[84:87]
  ds_read_b64_tr_b16 a[144:145], v18 offset:32768
  ds_read_b64_tr_b16 a[146:147], v18 offset:34816
  v_mfma_f32_16x16x32_bf16 v[88:91], a[168:171], a[80:83], v[88:91]
  v_mfma_f32_16x16x32_bf16 v[88:91], a[172:175], a[84:87], v[88:91]
  v_mfma_f32_16x16x32_bf16 v[92:95], a[172:175], a[92:95], v[92:95]
  v_mfma_f32_16x16x32_bf16 v[92:95], a[168:171], a[88:91], v[92:95]
  s_waitcnt lgkmcnt(15)
  ds_read_b64_tr_b16 a[152:153], v19 offset:32768
  ds_read_b64_tr_b16 a[154:155], v19 offset:34816
  v_mfma_f32_16x16x32_bf16 v[96:99], a[176:179], a[32:35], v[96:99]
  s_add_u32 s24, s24, 262144
  s_cmp_eq_u32 s24, s27
  s_cselect_b32 s24, s28, s24
  s_sub_u32 s6, s6, 1
  s_cmp_eq_u32 s6, 0
  s_cselect_b64 s[12:13], s[64:65], s[12:13]
  v_mfma_f32_16x16x32_bf16 v[96:99], a[180:183], a[36:39], v[96:99]
  v_mfma_f32_16x16x32_bf16 v[100:103], a[180:183], a[44:47], v[100:103]
  v_mfma_f32_16x16x32_bf16 v[100:103], a[176:179], a[40:43], v[100:103]
  v_mfma_f32_16x16x32_bf16 v[104:107], a[176:179], a[48:51], v[104:107]
  v_mfma_f32_16x16x32_bf16 v[104:107], a[180:183], a[52:55], v[104:107]
  v_mfma_f32_16x16x32_bf16 v[108:111], a[180:183], a[60:63], v[108:111]
  v_mfma_f32_16x16x32_bf16 v[108:111], a[176:179], a[56:59], v[108:111]
  s_waitcnt vmcnt(17) lgkmcnt(0)
  s_barrier
  ds_read_b128 a[160:163], v10 offset:16384
  ds_read_b128 a[164:167], v11 offset:16384
  v_mfma_f32_16x16x32_bf16 v[112:115], a[176:179], a[64:67], v[112:115]
  s_add_u32 m0, s29, 0
  s_nop 0
  buffer_load_dwordx4 v2, s[8:11], s23 offen offset:0 lds
  v_mfma_f32_16x16x32_bf16 v[112:115], a[180:183], a[68:71], v[112:115]
  v_mfma_f32_16x16x32_bf16 v[116:119], a[180:183], a[76:79], v[116:119]
  v_mfma_f32_16x16x32_bf16 v[116:119], a[176:179], a[72:75], v[116:119]
  ds_read_b64_tr_b16 a[100:101], v12 offset:49152
  ds_read_b64_tr_b16 a[102:103], v12 offset:51200
  v_mfma_f32_16x16x32_bf16 v[120:123], a[176:179], a[80:83], v[120:123]
  v_mfma_f32_16x16x32_bf16 v[120:123], a[180:183], a[84:87], v[120:123]
  buffer_load_dwordx4 v3, s[8:11], s23 offen offset:1024 lds
  v_mfma_f32_16x16x32_bf16 v[124:127], a[180:183], a[92:95], v[124:127]
  v_mfma_f32_16x16x32_bf16 v[124:127], a[176:179], a[88:91], v[124:127]
  v_mfma_f32_16x16x32_bf16 v[128:131], a[184:187], a[32:35], v[128:131]
  v_mfma_f32_16x16x32_bf16 v[128:131], a[188:191], a[36:39], v[128:131]
  ds_read_b128 a[168:171], v10 offset:18432
  ds_read_b128 a[172:175], v11 offset:18432
  ds_read_b64_tr_b16 a[108:109], v13 offset:49152
  ds_read_b64_tr_b16 a[110:111], v13 offset:51200
  v_mfma_f32_16x16x32_bf16 v[132:135], a[188:191], a[44:47], v[132:135]
  v_mfma_f32_16x16x32_bf16 v[132:135], a[184:187], a[40:43], v[132:135]
  buffer_load_dwordx4 v4, s[8:11], s23 offen offset:2048 lds
  v_mfma_f32_16x16x32_bf16 v[136:139], a[184:187], a[48:51], v[136:139]
  v_mfma_f32_16x16x32_bf16 v[136:139], a[188:191], a[52:55], v[136:139]
  v_mfma_f32_16x16x32_bf16 v[140:143], a[188:191], a[60:63], v[140:143]
  v_mfma_f32_16x16x32_bf16 v[140:143], a[184:187], a[56:59], v[140:143]
  ds_read_b64_tr_b16 a[116:117], v14 offset:49152
  ds_read_b64_tr_b16 a[118:119], v14 offset:51200
  v_mfma_f32_16x16x32_bf16 v[144:147], a[184:187], a[64:67], v[144:147]
  v_mfma_f32_16x16x32_bf16 v[144:147], a[188:191], a[68:71], v[144:147]
  buffer_load_dwordx4 v5, s[8:11], s23 offen offset:3072 lds
  v_mfma_f32_16x16x32_bf16 v[148:151], a[188:191], a[76:79], v[148:151]
  v_mfma_f32_16x16x32_bf16 v[148:151], a[184:187], a[72:75], v[148:151]
  v_mfma_f32_16x16x32_bf16 v[152:155], a[184:187], a[80:83], v[152:155]
  v_mfma_f32_16x16x32_bf16 v[152:155], a[188:191], a[84:87], v[152:155]
  ds_read_b64_tr_b16 a[124:125], v15 offset:49152
  ds_read_b64_tr_b16 a[126:127], v15 offset:51200
  v_mfma_f32_16x16x32_bf16 v[156:159], a[188:191], a[92:95], v[156:159]
  s_add_u32 m0, s29, 98304
  s_nop 0
  buffer_load_dwordx4 v6, s[12:15], s24 offen offset:0 lds
  v_mfma_f32_16x16x32_bf16 v[156:159], a[184:187], a[88:91], v[156:159]
  s_waitcnt lgkmcnt(10)
  v_mfma_f32_16x16x32_bf16 v[160:163], a[160:163], a[32:35], v[160:163]
  v_mfma_f32_16x16x32_bf16 v[160:163], a[164:167], a[36:39], v[160:163]
  ds_read_b128 a[176:179], v10 offset:20480
  ds_read_b128 a[180:183], v11 offset:20480
  v_mfma_f32_16x16x32_bf16 v[164:167], a[164:167], a[44:47], v[164:167]
  v_mfma_f32_16x16x32_bf16 v[164:167], a[160:163], a[40:43], v[164:167]
  ds_read_b64_tr_b16 a[132:133], v16 offset:49152
  ds_read_b64_tr_b16 a[134:135], v16 offset:51200
  v_mfma_f32_16x16x32_bf16 v[168:171], a[160:163], a[48:51], v[168:171]
  v_mfma_f32_16x16x32_bf16 v[168:171], a[164:167], a[52:55], v[168:171]
  buffer_load_dwordx4 v7, s[12:15], s24 offen offset:1024 lds
  v_mfma_f32_16x16x32_bf16 v[172:175], a[164:167], a[60:63], v[172:175]
  v_mfma_f32_16x16x32_bf16 v[172:175], a[160:163], a[56:59], v[172:175]
  v_mfma_f32_16x16x32_bf16 v[176:179], a[160:163], a[64:67], v[176:179]
  v_mfma_f32_16x16x32_bf16 v[176:179], a[164:167], a[68:71], v[176:179]
  ds_read_b64_tr_b16 a[140:141], v17 offset:49152
  ds_read_b64_tr_b16 a[142:143], v17 offset:51200
  v_mfma_f32_16x16x32_bf16 v[180:183], a[164:167], a[76:79], v[180:183]
  v_mfma_f32_16x16x32_bf16 v[180:183], a[160:163], a[72:75], v[180:183]
  buffer_load_dwordx4 v8, s[12:15], s24 offen offset:2048 lds
  v_mfma_f32_16x16x32_bf16 v[184:187], a[160:163], a[80:83], v[184:187]
  v_mfma_f32_16x16x32_bf16 v[184:187], a[164:167], a[84:87], v[184:187]
  v_mfma_f32_16x16x32_bf16 v[188:191], a[164:167], a[92:95], v[188:191]
  v_mfma_f32_16x16x32_bf16 v[188:191], a[160:163], a[88:91], v[188:191]
  s_waitcnt lgkmcnt(12)
  ds_read_b64_tr_b16 a[148:149], v18 offset:49152
  ds_read_b64_tr_b16 a[150:151], v18 offset:51200
  v_mfma_f32_16x16x32_bf16 v[192:195], a[168:171], a[32:35], v[192:195]
  buffer_load_dwordx4 v9, s[12:15], s24 offen offset:3072 lds
  v_mfma_f32_16x16x32_bf16 v[192:195], a[172:175], a[36:39], v[192:195]
  ds_read_b128 a[184:187], v10 offset:22528
  ds_read_b128 a[188:191], v11 offset:22528
  v_mfma_f32_16x16x32_bf16 v[196:199], a[172:175], a[44:47], v[196:199]
  v_mfma_f32_16x16x32_bf16 v[196:199], a[168:171], a[40:43], v[196:199]
  v_mfma_f32_16x16x32_bf16 v[200:203], a[168:171], a[48:51], v[200:203]
  v_mfma_f32_16x16x32_bf16 v[200:203], a[172:175], a[52:55], v[200:203]
  ds_read_b64_tr_b16 a[156:157], v19 offset:49152
  ds_read_b64_tr_b16 a[158:159], v19 offset:51200
  v_mfma_f32_16x16x32_bf16 v[204:207], a[172:175], a[60:63], v[204:207]
  s_add_u32 s24, s24, 262144
  v_mfma_f32_16x16x32_bf16 v[204:207], a[168:171], a[56:59], v[204:207]
  v_mfma_f32_16x16x32_bf16 v[208:211], a[168:171], a[64:67], v[208:211]
  v_mfma_f32_16x16x32_bf16 v[208:211], a[172:175], a[68:71], v[208:211]
  v_mfma_f32_16x16x32_bf16 v[212:215], a[172:175], a[76:79], v[212:215]
  v_mfma_f32_16x16x32_bf16 v[212:215], a[168:171], a[72:75], v[212:215]
  buffer_load_dword v21, v20, s[60:63], s54 offen
  s_add_u32 s54, s54, s55
  v_mfma_f32_16x16x32_bf16 v[216:219], a[168:171], a[80:83], v[216:219]
  v_mfma_f32_16x16x32_bf16 v[216:219], a[172:175], a[84:87], v[216:219]
  v_mfma_f32_16x16x32_bf16 v[220:223], a[172:175], a[92:95], v[220:223]
  v_mfma_f32_16x16x32_bf16 v[220:223], a[168:171], a[88:91], v[220:223]
  s_waitcnt lgkmcnt(10)
  v_mfma_f32_16x16x32_bf16 v[224:227], a[176:179], a[32:35], v[224:227]
  s_cmp_eq_u32 s54, s56
  s_cselect_b32 s54, s57, s54
  s_cselect_b64 s[60:61], s[58:59], s[60:61]
  s_cselect_b32 s62, s7, s62
  v_mfma_f32_16x16x32_bf16 v[224:227], a[180:183], a[36:39], v[224:227]
  v_mfma_f32_16x16x32_bf16 v[228:231], a[180:183], a[44:47], v[228:231]
  v_mfma_f32_16x16x32_bf16 v[228:231], a[176:179], a[40:43], v[228:231]
  v_mfma_f32_16x16x32_bf16 v[232:235], a[176:179], a[48:51], v[232:235]
  v_mfma_f32_16x16x32_bf16 v[232:235], a[180:183], a[52:55], v[232:235]
  v_mfma_f32_16x16x32_bf16 v[236:239], a[180:183], a[60:63], v[236:239]
  v_mfma_f32_16x16x32_bf16 v[236:239], a[176:179], a[56:59], v[236:239]
  s_waitcnt vmcnt(18) lgkmcnt(0)
  s_barrier
  ds_read_b128 a[160:163], v10 offset:32768
  ds_read_b128 a[164:167], v11 offset:32768
  v_mfma_f32_16x16x32_bf16 v[240:243], a[176:179], a[64:67], v[240:243]
  s_add_u32 m0, s29, 16384
  s_add_u32 s3, s23, s31
  buffer_load_dwordx4 v2, s[8:11], s3 offen offset:0 lds
  v_mfma_f32_16x16x32_bf16 v[240:243], a[180:183], a[68:71], v[240:243]
  v_mfma_f32_16x16x32_bf16 v[244:247], a[180:183], a[76:79], v[244:247]
  v_mfma_f32_16x16x32_bf16 v[244:247], a[176:179], a[72:75], v[244:247]
  v_mfma_f32_16x16x32_bf16 v[248:251], a[176:179], a[80:83], v[248:251]
  v_mfma_f32_16x16x32_bf16 v[248:251], a[180:183], a[84:87], v[248:251]
  buffer_load_dwordx4 v3, s[8:11], s3 offen offset:1024 lds
  v_mfma_f32_16x16x32_bf16 v[252:255], a[180:183], a[92:95], v[252:255]
  v_mfma_f32_16x16x32_bf16 v[252:255], a[176:179], a[88:91], v[252:255]
  v_mfma_f32_16x16x32_bf16 a[0:3], a[184:187], a[32:35], a[0:3]
  v_mfma_f32_16x16x32_bf16 a[0:3], a[188:191], a[36:39], a[0:3]
  ds_read_b128 a[168:171], v10 offset:34816
  ds_read_b128 a[172:175], v11 offset:34816
  v_mfma_f32_16x16x32_bf16 a[4:7], a[188:191], a[44:47], a[4:7]
  v_mfma_f32_16x16x32_bf16 a[4:7], a[184:187], a[40:43], a[4:7]
  v_mfma_f32_16x16x32_bf16 a[8:11], a[184:187], a[48:51], a[8:11]
  buffer_load_dwordx4 v4, s[8:11], s3 offen offset:2048 lds
  v_mfma_f32_16x16x32_bf16 a[8:11], a[188:191], a[52:55], a[8:11]
  v_mfma_f32_16x16x32_bf16 a[12:15], a[188:191], a[60:63], a[12:15]
  v_mfma_f32_16x16x32_bf16 a[12:15], a[184:187], a[56:59], a[12:15]
  v_mfma_f32_16x16x32_bf16 a[16:19], a[184:187], a[64:67], a[16:19]
  v_mfma_f32_16x16x32_bf16 a[16:19], a[188:191], a[68:71], a[16:19]
  buffer_load_dwordx4 v5, s[8:11], s3 offen offset:3072 lds
  v_mfma_f32_16x16x32_bf16 a[20:23], a[188:191], a[76:79], a[20:23]
  v_mfma_f32_16x16x32_bf16 a[20:23], a[184:187], a[72:75], a[20:23]
  v_mfma_f32_16x16x32_bf16 a[24:27], a[184:187], a[80:83], a[24:27]
  v_mfma_f32_16x16x32_bf16 a[24:27], a[188:191], a[84:87], a[24:27]
  v_mfma_f32_16x16x32_bf16 a[28:31], a[188:191], a[92:95], a[28:31]
  v_mfma_f32_16x16x32_bf16 a[28:31], a[184:187], a[88:91], a[28:31]
  s_waitcnt lgkmcnt(2)
  v_mfma_f32_16x16x32_bf16 v[32:35], a[160:163], a[96:99], v[32:35]
  s_add_u32 s23, s23, 128
  s_cmp_eq_u32 s23, s25
  s_cselect_b32 s23, s26, s23
  v_mfma_f32_16x16x32_bf16 v[32:35], a[164:167], a[100:103], v[32:35]
  ds_read_b128 a[176:179], v10 offset:36864
  ds_read_b128 a[180:183], v11 offset:36864
  v_mfma_f32_16x16x32_bf16 v[36:39], a[164:167], a[108:111], v[36:39]
  v_mfma_f32_16x16x32_bf16 v[36:39], a[160:163], a[104:107], v[36:39]
  ds_read_b64_tr_b16 a[32:33], v12 offset:0
  ds_read_b64_tr_b16 a[34:35], v12 offset:2048
  v_mfma_f32_16x16x32_bf16 v[40:43], a[160:163], a[112:115], v[40:43]
  v_mfma_f32_16x16x32_bf16 v[40:43], a[164:167], a[116:119], v[40:43]
  v_mfma_f32_16x16x32_bf16 v[44:47], a[164:167], a[124:127], v[44:47]
  s_add_u32 m0, s29, 114688
  s_nop 0
  buffer_load_dwordx4 v6, s[12:15], s24 offen offset:0 lds
  v_mfma_f32_16x16x32_bf16 v[44:47], a[160:163], a[120:123], v[44:47]
  ds_read_b64_tr_b16 a[40:41], v13 offset:0
  ds_read_b64_tr_b16 a[42:43], v13 offset:2048
  v_mfma_f32_16x16x32_bf16 v[48:51], a[160:163], a[128:131], v[48:51]
  v_mfma_f32_16x16x32_bf16 v[48:51], a[164:167], a[132:135], v[48:51]
  v_mfma_f32_16x16x32_bf16 v[52:55], a[164:167], a[140:143], v[52:55]
  v_mfma_f32_16x16x32_bf16 v[52:55], a[160:163], a[136:139], v[52:55]
  ds_read_b64_tr_b16 a[48:49], v14 offset:0
  ds_read_b64_tr_b16 a[50:51], v14 offset:2048
  v_mfma_f32_16x16x32_bf16 v[56:59], a[160:163], a[144:147], v[56:59]
  v_mfma_f32_16x16x32_bf16 v[56:59], a[164:167], a[148:151], v[56:59]
  buffer_load_dwordx4 v7, s[12:15], s24 offen offset:1024 lds
  v_mfma_f32_16x16x32_bf16 v[60:63], a[164:167], a[156:159], v[60:63]
  v_mfma_f32_16x16x32_bf16 v[60:63], a[160:163], a[152:155], v[60:63]
  s_waitcnt lgkmcnt(8)
  ds_read_b64_tr_b16 a[56:57], v15 offset:0
  ds_read_b64_tr_b16 a[58:59], v15 offset:2048
  v_mfma_f32_16x16x32_bf16 v[64:67], a[168:171], a[96:99], v[64:67]
  v_mfma_f32_16x16x32_bf16 v[64:67], a[172:175], a[100:103], v[64:67]
  ds_read_b128 a[184:187], v10 offset:38912
  ds_read_b128 a[188:191], v11 offset:38912
  v_mfma_f32_16x16x32_bf16 v[68:71], a[172:175], a[108:111], v[68:71]
  v_mfma_f32_16x16x32_bf16 v[68:71], a[168:171], a[104:107], v[68:71]
  ds_read_b64_tr_b16 a[64:65], v16 offset:0
  ds_read_b64_tr_b16 a[66:67], v16 offset:2048
  v_mfma_f32_16x16x32_bf16 v[72:75], a[168:171], a[112:115], v[72:75]
  buffer_load_dwordx4 v8, s[12:15], s24 offen offset:2048 lds
  v_mfma_f32_16x16x32_bf16 v[72:75], a[172:175], a[116:119], v[72:75]
  v_mfma_f32_16x16x32_bf16 v[76:79], a[172:175], a[124:127], v[76:79]
  v_mfma_f32_16x16x32_bf16 v[76:79], a[168:171], a[120:123], v[76:79]
  ds_read_b64_tr_b16 a[72:73], v17 offset:0
  ds_read_b64_tr_b16 a[74:75], v17 offset:2048
  v_mfma_f32_16x16x32_bf16 v[80:83], a[168:171], a[128:131], v[80:83]
  v_mfma_f32_16x16x32_bf16 v[80:83], a[172:175], a[132:135], v[80:83]
  v_mfma_f32_16x16x32_bf16 v[84:87], a[172:175], a[140:143], v[84:87]
  buffer_load_dwordx4 v9, s[12:15], s24 offen offset:3072 lds
  v_mfma_f32_16x16x32_bf16 v[84:87], a[168:171], a[136:139], v[84:87]
  ds_read_b64_tr_b16 a[80:81], v18 offset:0
  ds_read_b64_tr_b16 a[82:83], v18 offset:2048
  v_mfma_f32_16x16x32_bf16 v[88:91], a[168:171], a[144:147], v[88:91]
  v_mfma_f32_16x16x32_bf16 v[88:91], a[172:175], a[148:151], v[88:91]
  v_mfma_f32_16x16x32_bf16 v[92:95], a[172:175], a[156:159], v[92:95]
  v_mfma_f32_16x16x32_bf16 v[92:95], a[168:171], a[152:155], v[92:95]
  s_waitcnt lgkmcnt(15)
  ds_read_b64_tr_b16 a[88:89], v19 offset:0
  ds_read_b64_tr_b16 a[90:91], v19 offset:2048
  v_mfma_f32_16x16x32_bf16 v[96:99], a[176:179], a[96:99], v[96:99]
  s_add_u32 s24, s24, 262144
  s_cmp_eq_u32 s24, s27
  s_cselect_b32 s24, s28, s24
  s_sub_u32 s6, s6, 1
  s_cmp_eq_u32 s6, 0
  s_cselect_b64 s[12:13], s[64:65], s[12:13]
  v_mfma_f32_16x16x32_bf16 v[96:99], a[180:183], a[100:103], v[96:99]
  v_mfma_f32_16x16x32_bf16 v[100:103], a[180:183], a[108:111], v[100:103]
  v_mfma_f32_16x16x32_bf16 v[100:103], a[176:179], a[104:107], v[100:103]
  v_mfma_f32_16x16x32_bf16 v[104:107], a[176:179], a[112:115], v[104:107]
  v_mfma_f32_16x16x32_bf16 v[104:107], a[180:183], a[116:119], v[104:107]
  v_mfma_f32_16x16x32_bf16 v[108:111], a[180:183], a[124:127], v[108:111]
  v_mfma_f32_16x16x32_bf16 v[108:111], a[176:179], a[120:123], v[108:111]
  s_waitcnt vmcnt(17) lgkmcnt(0)
  s_barrier
  ds_read_b128 a[160:163], v10 offset:49152
  ds_read_b128 a[164:167], v11 offset:49152
  v_mfma_f32_16x16x32_bf16 v[112:115], a[176:179], a[128:131], v[112:115]
  s_add_u32 m0, s29, 32768
  s_nop 0
  buffer_load_dwordx4 v2, s[8:11], s23 offen offset:0 lds
  v_mfma_f32_16x16x32_bf16 v[112:115], a[180:183], a[132:135], v[112:115]
  v_mfma_f32_16x16x32_bf16 v[116:119], a[180:183], a[140:143], v[116:119]
  v_mfma_f32_16x16x32_bf16 v[116:119], a[176:179], a[136:139], v[116:119]
  ds_read_b64_tr_b16 a[36:37], v12 offset:16384
  ds_read_b64_tr_b16 a[38:39], v12 offset:18432
  v_mfma_f32_16x16x32_bf16 v[120:123], a[176:179], a[144:147], v[120:123]
  v_mfma_f32_16x16x32_bf16 v[120:123], a[180:183], a[148:151], v[120:123]
  buffer_load_dwordx4 v3, s[8:11], s23 offen offset:1024 lds
  v_mfma_f32_16x16x32_bf16 v[124:127], a[180:183], a[156:159], v[124:127]
  v_mfma_f32_16x16x32_bf16 v[124:127], a[176:179], a[152:155], v[124:127]
  v_mfma_f32_16x16x32_bf16 v[128:131], a[184:187], a[96:99], v[128:131]
  v_mfma_f32_16x16x32_bf16 v[128:131], a[188:191], a[100:103], v[128:131]
  ds_read_b128 a[168:171], v10 offset:51200
  ds_read_b128 a[172:175], v11 offset:51200
  ds_read_b64_tr_b16 a[44:45], v13 offset:16384
  ds_read_b64_tr_b16 a[46:47], v13 offset:18432
  v_mfma_f32_16x16x32_bf16 v[132:135], a[188:191], a[108:111], v[132:135]
  v_mfma_f32_16x16x32_bf16 v[132:135], a[184:187], a[104:107], v[132:135]
  buffer_load_dwordx4 v4, s[8:11], s23 offen offset:2048 lds
  v_mfma_f32_16x16x32_bf16 v[136:139], a[184:187], a[112:115], v[136:139]
  v_mfma_f32_16x16x32_bf16 v[136:139], a[188:191], a[116:119], v[136:139]
  v_mfma_f32_16x16x32_bf16 v[140:143], a[188:191], a[124:127], v[140:143]
  v_mfma_f32_16x16x32_bf16 v[140:143], a[184:187], a[120:123], v[140:143]
  ds_read_b64_tr_b16 a[52:53], v14 offset:16384
  ds_read_b64_tr_b16 a[54:55], v14 offset:18432
  v_mfma_f32_16x16x32_bf16 v[144:147], a[184:187], a[128:131], v[144:147]
  v_mfma_f32_16x16x32_bf16 v[144:147], a[188:191], a[132:135], v[144:147]
  buffer_load_dwordx4 v5, s[8:11], s23 offen offset:3072 lds
  v_mfma_f32_16x16x32_bf16 v[148:151], a[188:191], a[140:143], v[148:151]
  v_mfma_f32_16x16x32_bf16 v[148:151], a[184:187], a[136:139], v[148:151]
  v_mfma_f32_16x16x32_bf16 v[152:155], a[184:187], a[144:147], v[152:155]
  v_mfma_f32_16x16x32_bf16 v[152:155], a[188:191], a[148:151], v[152:155]
  ds_read_b64_tr_b16 a[60:61], v15 offset:16384
  ds_read_b64_tr_b16 a[62:63], v15 offset:18432
  v_mfma_f32_16x16x32_bf16 v[156:159], a[188:191], a[156:159], v[156:159]
  s_add_u32 m0, s29, 65536
  s_nop 0
  buffer_load_dwordx4 v6, s[12:15], s24 offen offset:0 lds
  v_mfma_f32_16x16x32_bf16 v[156:159], a[184:187], a[152:155], v[156:159]
  s_waitcnt lgkmcnt(10)
  v_mfma_f32_16x16x32_bf16 v[160:163], a[160:163], a[96:99], v[160:163]
  v_mfma_f32_16x16x32_bf16 v[160:163], a[164:167], a[100:103], v[160:163]
  ds_read_b128 a[176:179], v10 offset:53248
  ds_read_b128 a[180:183], v11 offset:53248
  v_mfma_f32_16x16x32_bf16 v[164:167], a[164:167], a[108:111], v[164:167]
  v_mfma_f32_16x16x32_bf16 v[164:167], a[160:163], a[104:107], v[164:167]
  ds_read_b64_tr_b16 a[68:69], v16 offset:16384
  ds_read_b64_tr_b16 a[70:71], v16 offset:18432
  v_mfma_f32_16x16x32_bf16 v[168:171], a[160:163], a[112:115], v[168:171]
  v_mfma_f32_16x16x32_bf16 v[168:171], a[164:167], a[116:119], v[168:171]
  buffer_load_dwordx4 v7, s[12:15], s24 offen offset:1024 lds
  v_mfma_f32_16x16x32_bf16 v[172:175], a[164:167], a[124:127], v[172:175]
  v_mfma_f32_16x16x32_bf16 v[172:175], a[160:163], a[120:123], v[172:175]
  v_mfma_f32_16x16x32_bf16 v[176:179], a[160:163], a[128:131], v[176:179]
  v_mfma_f32_16x16x32_bf16 v[176:179], a[164:167], a[132:135], v[176:179]
  ds_read_b64_tr_b16 a[76:77], v17 offset:16384
  ds_read_b64_tr_b16 a[78:79], v17 offset:18432
  v_mfma_f32_16x16x32_bf16 v[180:183], a[164:167], a[140:143], v[180:183]
  v_mfma_f32_16x16x32_bf16 v[180:183], a[160:163], a[136:139], v[180:183]
  buffer_load_dwordx4 v8, s[12:15], s24 offen offset:2048 lds
  v_mfma_f32_16x16x32_bf16 v[184:187], a[160:163], a[144:147], v[184:187]
  v_mfma_f32_16x16x32_bf16 v[184:187], a[164:167], a[148:151], v[184:187]
  v_mfma_f32_16x16x32_bf16 v[188:191], a[164:167], a[156:159], v[188:191]
  v_mfma_f32_16x16x32_bf16 v[188:191], a[160:163], a[152:155], v[188:191]
  s_waitcnt lgkmcnt(12)
  ds_read_b64_tr_b16 a[84:85], v18 offset:16384
  ds_read_b64_tr_b16 a[86:87], v18 offset:18432
  v_mfma_f32_16x16x32_bf16 v[192:195], a[168:171], a[96:99], v[192:195]
  buffer_load_dwordx4 v9, s[12:15], s24 offen offset:3072 lds
  v_mfma_f32_16x16x32_bf16 v[192:195], a[172:175], a[100:103], v[192:195]
  ds_read_b128 a[184:187], v10 offset:55296
  ds_read_b128 a[188:191], v11 offset:55296
  v_mfma_f32_16x16x32_bf16 v[196:199], a[172:175], a[108:111], v[196:199]
  v_mfma_f32_16x16x32_bf16 v[196:199], a[168:171], a[104:107], v[196:199]
  v_mfma_f32_16x16x32_bf16 v[200:203], a[168:171], a[112:115], v[200:203]
  v_mfma_f32_16x16x32_bf16 v[200:203], a[172:175], a[116:119], v[200:203]
  ds_read_b64_tr_b16 a[92:93], v19 offset:16384
  ds_read_b64_tr_b16 a[94:95], v19 offset:18432
  v_mfma_f32_16x16x32_bf16 v[204:207], a[172:175], a[124:127], v[204:207]
  s_add_u32 s24, s24, 262144
  v_mfma_f32_16x16x32_bf16 v[204:207], a[168:171], a[120:123], v[204:207]
  v_mfma_f32_16x16x32_bf16 v[208:211], a[168:171], a[128:131], v[208:211]
  v_mfma_f32_16x16x32_bf16 v[208:211], a[172:175], a[132:135], v[208:211]
  v_mfma_f32_16x16x32_bf16 v[212:215], a[172:175], a[140:143], v[212:215]
  v_mfma_f32_16x16x32_bf16 v[212:215], a[168:171], a[136:139], v[212:215]
  buffer_load_dword v21, v20, s[60:63], s54 offen
  s_add_u32 s54, s54, s55
  v_mfma_f32_16x16x32_bf16 v[216:219], a[168:171], a[144:147], v[216:219]
  v_mfma_f32_16x16x32_bf16 v[216:219], a[172:175], a[148:151], v[216:219]
  v_mfma_f32_16x16x32_bf16 v[220:223], a[172:175], a[156:159], v[220:223]
  v_mfma_f32_16x16x32_bf16 v[220:223], a[168:171], a[152:155], v[220:223]
  s_waitcnt lgkmcnt(10)
  v_mfma_f32_16x16x32_bf16 v[224:227], a[176:179], a[96:99], v[224:227]
  s_cmp_eq_u32 s54, s56
  s_cselect_b32 s54, s57, s54
  s_cselect_b64 s[60:61], s[58:59], s[60:61]
  s_cselect_b32 s62, s7, s62
  v_mfma_f32_16x16x32_bf16 v[224:227], a[180:183], a[100:103], v[224:227]
  v_mfma_f32_16x16x32_bf16 v[228:231], a[180:183], a[108:111], v[228:231]
  v_mfma_f32_16x16x32_bf16 v[228:231], a[176:179], a[104:107], v[228:231]
  v_mfma_f32_16x16x32_bf16 v[232:235], a[176:179], a[112:115], v[232:235]
  v_mfma_f32_16x16x32_bf16 v[232:235], a[180:183], a[116:119], v[232:235]
  v_mfma_f32_16x16x32_bf16 v[236:239], a[180:183], a[124:127], v[236:239]
  v_mfma_f32_16x16x32_bf16 v[236:239], a[176:179], a[120:123], v[236:239]
  s_waitcnt vmcnt(18) lgkmcnt(0)
  s_barrier
  ds_read_b128 a[160:163], v10 offset:0
  ds_read_b128 a[164:167], v11 offset:0
  v_mfma_f32_16x16x32_bf16 v[240:243], a[176:179], a[128:131], v[240:243]
  s_add_u32 m0, s29, 49152
  s_add_u32 s3, s23, s31
  buffer_load_dwordx4 v2, s[8:11], s3 offen offset:0 lds
  v_mfma_f32_16x16x32_bf16 v[240:243], a[180:183], a[132:135], v[240:243]
  v_mfma_f32_16x16x32_bf16 v[244:247], a[180:183], a[140:143], v[244:247]
  v_mfma_f32_16x16x32_bf16 v[244:247], a[176:179], a[136:139], v[244:247]
  v_mfma_f32_16x16x32_bf16 v[248:251], a[176:179], a[144:147], v[248:251]
  v_mfma_f32_16x16x32_bf16 v[248:251], a[180:183], a[148:151], v[248:251]
  buffer_load_dwordx4 v3, s[8:11], s3 offen offset:1024 lds
  v_mfma_f32_16x16x32_bf16 v[252:255], a[180:183], a[156:159], v[252:255]
  v_mfma_f32_16x16x32_bf16 v[252:255], a[176:179], a[152:155], v[252:255]
  v_mfma_f32_16x16x32_bf16 a[0:3], a[184:187], a[96:99], a[0:3]
  v_mfma_f32_16x16x32_bf16 a[0:3], a[188:191], a[100:103], a[0:3]
  ds_read_b128 a[168:171], v10 offset:2048
  ds_read_b128 a[172:175], v11 offset:2048
  v_mfma_f32_16x16x32_bf16 a[4:7], a[188:191], a[108:111], a[4:7]
  v_mfma_f32_16x16x32_bf16 a[4:7], a[184:187], a[104:107], a[4:7]
  v_mfma_f32_16x16x32_bf16 a[8:11], a[184:187], a[112:115], a[8:11]
  buffer_load_dwordx4 v4, s[8:11], s3 offen offset:2048 lds
  v_mfma_f32_16x16x32_bf16 a[8:11], a[188:191], a[116:119], a[8:11]
  v_mfma_f32_16x16x32_bf16 a[12:15], a[188:191], a[124:127], a[12:15]
  v_mfma_f32_16x16x32_bf16 a[12:15], a[184:187], a[120:123], a[12:15]
  v_mfma_f32_16x16x32_bf16 a[16:19], a[184:187], a[128:131], a[16:19]
  v_mfma_f32_16x16x32_bf16 a[16:19], a[188:191], a[132:135], a[16:19]
  buffer_load_dwordx4 v5, s[8:11], s3 offen offset:3072 lds
  v_mfma_f32_16x16x32_bf16 a[20:23], a[188:191], a[140:143], a[20:23]
  v_mfma_f32_16x16x32_bf16 a[20:23], a[184:187], a[136:139], a[20:23]
  v_mfma_f32_16x16x32_bf16 a[24:27], a[184:187], a[144:147], a[24:27]
  v_mfma_f32_16x16x32_bf16 a[24:27], a[188:191], a[148:151], a[24:27]
  v_mfma_f32_16x16x32_bf16 a[28:31], a[188:191], a[156:159], a[28:31]
  v_mfma_f32_16x16x32_bf16 a[28:31], a[184:187], a[152:155], a[28:31]
  s_waitcnt lgkmcnt(2)
  v_mfma_f32_16x16x32_bf16 v[32:35], a[160:163], a[32:35], v[32:35]
  s_add_u32 s23, s23, 128
  s_cmp_eq_u32 s23, s25
  s_cselect_b32 s23, s26, s23
  v_mfma_f32_16x16x32_bf16 v[32:35], a[164:167], a[36:39], v[32:35]
  ds_read_b128 a[176:179], v10 offset:4096
  ds_read_b128 a[180:183], v11 offset:4096
  v_mfma_f32_16x16x32_bf16 v[36:39], a[164:167], a[44:47], v[36:39]
  v_mfma_f32_16x16x32_bf16 v[36:39], a[160:163], a[40:43], v[36:39]
  ds_read_b64_tr_b16 a[96:97], v12 offset:32768
  ds_read_b64_tr_b16 a[98:99], v12 offset:34816
  v_mfma_f32_16x16x32_bf16 v[40:43], a[160:163], a[48:51], v[40:43]
  v_mfma_f32_16x16x32_bf16 v[40:43], a[164:167], a[52:55], v[40:43]
  v_mfma_f32_16x16x32_bf16 v[44:47], a[164:167], a[60:63], v[44:47]
  s_add_u32 m0, s29, 81920
  s_nop 0
  buffer_load_dwordx4 v6, s[12:15], s24 offen offset:0 lds
  v_mfma_f32_16x16x32_bf16 v[44:47], a[160:163], a[56:59], v[44:47]
  ds_read_b64_tr_b16 a[104:105], v13 offset:32768
  ds_read_b64_tr_b16 a[106:107], v13 offset:34816
  v_mfma_f32_16x16x32_bf16 v[48:51], a[160:163], a[64:67], v[48:51]
  v_mfma_f32_16x16x32_bf16 v[48:51], a[164:167], a[68:71], v[48:51]
  v_mfma_f32_16x16x32_bf16 v[52:55], a[164:167], a[76:79], v[52:55]
  v_mfma_f32_16x16x32_bf16 v[52:55], a[160:163], a[72:75], v[52:55]
  ds_read_b64_tr_b16 a[112:113], v14 offset:32768
  ds_read_b64_tr_b16 a[114:115], v14 offset:34816
  v_mfma_f32_16x16x32_bf16 v[56:59], a[160:163], a[80:83], v[56:59]
  v_mfma_f32_16x16x32_bf16 v[56:59], a[164:167], a[84:87], v[56:59]
  buffer_load_dwordx4 v7, s[12:15], s24 offen offset:1024 lds
  v_mfma_f32_16x16x32_bf16 v[60:63], a[164:167], a[92:95], v[60:63]
  v_mfma_f32_16x16x32_bf16 v[60:63], a[160:163], a[88:91], v[60:63]
  s_waitcnt lgkmcnt(8)
  ds_read_b64_tr_b16 a[120:121], v15 offset:32768
  ds_read_b64_tr_b16 a[122:123], v15 offset:34816
  v_mfma_f32_16x16x32_bf16 v[64:67], a[168:171], a[32:35], v[64:67]
  v_mfma_f32_16x16x32_bf16 v[64:67], a[172:175], a[36:39], v[64:67]
  ds_read_b128 a[184:187], v10 offset:6144
  ds_read_b128 a[188:191], v11 offset:6144
  v_mfma_f32_16x16x32_bf16 v[68:71], a[172:175], a[44:47], v[68:71]
  v_mfma_f32_16x16x32_bf16 v[68:71], a[168:171], a[40:43], v[68:71]
  ds_read_b64_tr_b16 a[128:129], v16 offset:32768
  ds_read_b64_tr_b16 a[130:131], v16 offset:34816
  v_mfma_f32_16x16x32_bf16 v[72:75], a[168:171], a[48:51], v[72:75]
  buffer_load_dwordx4 v8, s[12:15], s24 offen offset:2048 lds
  v_mfma_f32_16x16x32_bf16 v[72:75], a[172:175], a[52:55], v[72:75]
  v_mfma_f32_16x16x32_bf16 v[76:79], a[172:175], a[60:63], v[76:79]
  v_mfma_f32_16x16x32_bf16 v[76:79], a[168:171], a[56:59], v[76:79]
  ds_read_b64_tr_b16 a[136:137], v17 offset:32768
  ds_read_b64_tr_b16 a[138:139], v17 offset:34816
  v_mfma_f32_16x16x32_bf16 v[80:83], a[168:171], a[64:67], v[80:83]
  v_mfma_f32_16x16x32_bf16 v[80:83], a[172:175], a[68:71], v[80:83]
  v_mfma_f32_16x16x32_bf16 v[84:87], a[172:175], a[76:79], v[84:87]
  buffer_load_dwordx4 v9, s[12:15], s24 offen offset:3072 lds
  v_mfma_f32_16x16x32_bf16 v[84:87], a[168:171], a[72:75], v[84:87]
  ds_read_b64_tr_b16 a[144:145], v18 offset:32768
  ds_read_b64_tr_b16 a[146:147], v18 offset:34816
  v_mfma_f32_16x16x32_bf16 v[88:91], a[168:171], a[80:83], v[88:91]
  v_mfma_f32_16x16x32_bf16 v[88:91], a[172:175], a[84:87], v[88:91]
  v_mfma_f32_16x16x32_bf16 v[92:95], a[172:175], a[92:95], v[92:95]
  v_mfma_f32_16x16x32_bf16 v[92:95], a[168:171], a[88:91], v[92:95]
  s_waitcnt lgkmcnt(15)
  ds_read_b64_tr_b16 a[152:153], v19 offset:32768
  ds_read_b64_tr_b16 a[154:155], v19 offset:34816
  v_mfma_f32_16x16x32_bf16 v[96:99], a[176:179], a[32:35], v[96:99]
  s_add_u32 s24, s24, 262144
  s_cmp_eq_u32 s24, s27
  s_cselect_b32 s24, s28, s24
  s_sub_u32 s6, s6, 1
  s_cmp_eq_u32 s6, 0
  s_cselect_b64 s[12:13], s[64:65], s[12:13]
  v_mfma_f32_16x16x32_bf16 v[96:99], a[180:183], a[36:39], v[96:99]
  v_mfma_f32_16x16x32_bf16 v[100:103], a[180:183], a[44:47], v[100:103]
  v_mfma_f32_16x16x32_bf16 v[100:103], a[176:179], a[40:43], v[100:103]
  v_mfma_f32_16x16x32_bf16 v[104:107], a[176:179], a[48:51], v[104:107]
  v_mfma_f32_16x16x32_bf16 v[104:107], a[180:183], a[52:55], v[104:107]
  v_mfma_f32_16x16x32_bf16 v[108:111], a[180:183], a[60:63], v[108:111]
  v_mfma_f32_16x16x32_bf16 v[108:111], a[176:179], a[56:59], v[108:111]
  s_waitcnt vmcnt(17) lgkmcnt(0)
  s_barrier
  ds_read_b128 a[160:163], v10 offset:16384
  ds_read_b128 a[164:167], v11 offset:16384
  v_mfma_f32_16x16x32_bf16 v[112:115], a[176:179], a[64:67], v[112:115]
  s_add_u32 m0, s29, 0
  s_nop 0
  buffer_load_dwordx4 v2, s[8:11], s23 offen offset:0 lds
  v_mfma_f32_16x16x32_bf16 v[112:115], a[180:183], a[68:71], v[112:115]
  v_mfma_f32_16x16x32_bf16 v[116:119], a[180:183], a[76:79], v[116:119]
  v_mfma_f32_16x16x32_bf16 v[116:119], a[176:179], a[72:75], v[116:119]
  ds_read_b64_tr_b16 a[100:101], v12 offset:49152
  ds_read_b64_tr_b16 a[102:103], v12 offset:51200
  v_mfma_f32_16x16x32_bf16 v[120:123], a[176:179], a[80:83], v[120:123]
  v_mfma_f32_16x16x32_bf16 v[120:123], a[180:183], a[84:87], v[120:123]
  v_mfma_f32_16x16x32_bf16 v[124:127], a[180:183], a[92:95], v[124:127]
  buffer_load_dwordx4 v3, s[8:11], s23 offen offset:1024 lds
  v_mfma_f32_16x16x32_bf16 v[124:127], a[176:179], a[88:91], v[124:127]
  v_mfma_f32_16x16x32_bf16 v[128:131], a[184:187], a[32:35], v[128:131]
  v_mfma_f32_16x16x32_bf16 v[128:131], a[188:191], a[36:39], v[128:131]
  ds_read_b128 a[168:171], v10 offset:18432
  ds_read_b128 a[172:175], v11 offset:18432
  ds_read_b64_tr_b16 a[108:109], v13 offset:49152
  ds_read_b64_tr_b16 a[110:111], v13 offset:51200
  v_mfma_f32_16x16x32_bf16 v[132:135], a[188:191], a[44:47], v[132:135]
  v_mfma_f32_16x16x32_bf16 v[132:135], a[184:187], a[40:43], v[132:135]
  v_mfma_f32_16x16x32_bf16 v[136:139], a[184:187], a[48:51], v[136:139]
  v_mfma_f32_16x16x32_bf16 v[136:139], a[188:191], a[52:55], v[136:139]
  buffer_load_dwordx4 v4, s[8:11], s23 offen offset:2048 lds
  v_mfma_f32_16x16x32_bf16 v[140:143], a[188:191], a[60:63], v[140:143]
  v_mfma_f32_16x16x32_bf16 v[140:143], a[184:187], a[56:59], v[140:143]
  ds_read_b64_tr_b16 a[116:117], v14 offset:49152
  ds_read_b64_tr_b16 a[118:119], v14 offset:51200
  v_mfma_f32_16x16x32_bf16 v[144:147], a[184:187], a[64:67], v[144:147]
  v_mfma_f32_16x16x32_bf16 v[144:147], a[188:191], a[68:71], v[144:147]
  v_mfma_f32_16x16x32_bf16 v[148:151], a[188:191], a[76:79], v[148:151]
  v_mfma_f32_16x16x32_bf16 v[148:151], a[184:187], a[72:75], v[148:151]
  v_mfma_f32_16x16x32_bf16 v[152:155], a[184:187], a[80:83], v[152:155]
  buffer_load_dwordx4 v5, s[8:11], s23 offen offset:3072 lds
  v_mfma_f32_16x16x32_bf16 v[152:155], a[188:191], a[84:87], v[152:155]
  ds_read_b64_tr_b16 a[124:125], v15 offset:49152
  ds_read_b64_tr_b16 a[126:127], v15 offset:51200
  v_mfma_f32_16x16x32_bf16 v[156:159], a[188:191], a[92:95], v[156:159]
  v_mfma_f32_16x16x32_bf16 v[156:159], a[184:187], a[88:91], v[156:159]
  s_waitcnt lgkmcnt(10)
  v_mfma_f32_16x16x32_bf16 v[160:163], a[160:163], a[32:35], v[160:163]
  v_mfma_f32_16x16x32_bf16 v[160:163], a[164:167], a[36:39], v[160:163]
  ds_read_b128 a[176:179], v10 offset:20480
  ds_read_b128 a[180:183], v11 offset:20480
  v_mfma_f32_16x16x32_bf16 v[164:167], a[164:167], a[44:47], v[164:167]
  v_mfma_f32_16x16x32_bf16 v[164:167], a[160:163], a[40:43], v[164:167]
  ds_read_b64_tr_b16 a[132:133], v16 offset:49152
  ds_read_b64_tr_b16 a[134:135], v16 offset:51200
  v_mfma_f32_16x16x32_bf16 v[168:171], a[160:163], a[48:51], v[168:171]
  v_mfma_f32_16x16x32_bf16 v[168:171], a[164:167], a[52:55], v[168:171]
  s_add_u32 m0, s29, 98304
  s_nop 0
  buffer_load_dwordx4 v6, s[12:15], s24 offen offset:0 lds
  v_mfma_f32_16x16x32_bf16 v[172:175], a[164:167], a[60:63], v[172:175]
  v_mfma_f32_16x16x32_bf16 v[172:175], a[160:163], a[56:59], v[172:175]
  v_mfma_f32_16x16x32_bf16 v[176:179], a[160:163], a[64:67], v[176:179]
  v_mfma_f32_16x16x32_bf16 v[176:179], a[164:167], a[68:71], v[176:179]
  ds_read_b64_tr_b16 a[140:141], v17 offset:49152
  ds_read_b64_tr_b16 a[142:143], v17 offset:51200
  v_mfma_f32_16x16x32_bf16 v[180:183], a[164:167], a[76:79], v[180:183]
  v_mfma_f32_16x16x32_bf16 v[180:183], a[160:163], a[72:75], v[180:183]
  buffer_load_dwordx4 v7, s[12:15], s24 offen offset:1024 lds
  v_mfma_f32_16x16x32_bf16 v[184:187], a[160:163], a[80:83], v[184:187]
  v_mfma_f32_16x16x32_bf16 v[184:187], a[164:167], a[84:87], v[184:187]
  v_mfma_f32_16x16x32_bf16 v[188:191], a[164:167], a[92:95], v[188:191]
  v_mfma_f32_16x16x32_bf16 v[188:191], a[160:163], a[88:91], v[188:191]
  s_waitcnt lgkmcnt(12)
  ds_read_b64_tr_b16 a[148:149], v18 offset:49152
  ds_read_b64_tr_b16 a[150:151], v18 offset:51200
  v_mfma_f32_16x16x32_bf16 v[192:195], a[168:171], a[32:35], v[192:195]
  v_mfma_f32_16x16x32_bf16 v[192:195], a[172:175], a[36:39], v[192:195]
  ds_read_b128 a[184:187], v10 offset:22528
  ds_read_b128 a[188:191], v11 offset:22528
  v_mfma_f32_16x16x32_bf16 v[196:199], a[172:175], a[44:47], v[196:199]
  v_mfma_f32_16x16x32_bf16 v[196:199], a[168:171], a[40:43], v[196:199]
  buffer_load_dwordx4 v8, s[12:15], s24 offen offset:2048 lds
  v_mfma_f32_16x16x32_bf16 v[200:203], a[168:171], a[48:51], v[200:203]
  v_mfma_f32_16x16x32_bf16 v[200:203], a[172:175], a[52:55], v[200:203]
  ds_read_b64_tr_b16 a[156:157], v19 offset:49152
  ds_read_b64_tr_b16 a[158:159], v19 offset:51200
  v_mfma_f32_16x16x32_bf16 v[204:207], a[172:175], a[60:63], v[204:207]
  v_mfma_f32_16x16x32_bf16 v[204:207], a[168:171], a[56:59], v[204:207]
  v_mfma_f32_16x16x32_bf16 v[208:211], a[168:171], a[64:67], v[208:211]
  v_mfma_f32_16x16x32_bf16 v[208:211], a[172:175], a[68:71], v[208:211]
  buffer_load_dwordx4 v9, s[12:15], s24 offen offset:3072 lds
  v_mfma_f32_16x16x32_bf16 v[212:215], a[172:175], a[76:79], v[212:215]
  v_mfma_f32_16x16x32_bf16 v[212:215], a[168:171], a[72:75], v[212:215]
  v_mfma_f32_16x16x32_bf16 v[216:219], a[168:171], a[80:83], v[216:219]
  v_mfma_f32_16x16x32_bf16 v[216:219], a[172:175], a[84:87], v[216:219]
  v_mfma_f32_16x16x32_bf16 v[220:223], a[172:175], a[92:95], v[220:223]
  s_add_u32 s24, s24, 262144
  v_mfma_f32_16x16x32_bf16 v[220:223], a[168:171], a[88:91], v[220:223]
  s_waitcnt lgkmcnt(10)
  v_mfma_f32_16x16x32_bf16 v[224:227], a[176:179], a[32:35], v[224:227]
  v_mfma_f32_16x16x32_bf16 v[224:227], a[180:183], a[36:39], v[224:227]
  v_mfma_f32_16x16x32_bf16 v[228:231], a[180:183], a[44:47], v[228:231]
  v_mfma_f32_16x16x32_bf16 v[228:231], a[176:179], a[40:43], v[228:231]
  v_mfma_f32_16x16x32_bf16 v[232:235], a[176:179], a[48:51], v[232:235]
  v_mfma_f32_16x16x32_bf16 v[232:235], a[180:183], a[52:55], v[232:235]
  v_mfma_f32_16x16x32_bf16 v[236:239], a[180:183], a[60:63], v[236:239]
  v_mfma_f32_16x16x32_bf16 v[236:239], a[176:179], a[56:59], v[236:239]
  s_waitcnt vmcnt(17) lgkmcnt(0)
  s_barrier
  ds_read_b128 a[160:163], v10 offset:32768
  ds_read_b128 a[164:167], v11 offset:32768
  v_mfma_f32_16x16x32_bf16 v[240:243], a[176:179], a[64:67], v[240:243]
  s_add_u32 m0, s29, 16384
  s_add_u32 s3, s23, s31
  buffer_load_dwordx4 v2, s[8:11], s3 offen offset:0 lds
  v_mfma_f32_16x16x32_bf16 v[240:243], a[180:183], a[68:71], v[240:243]
  v_mfma_f32_16x16x32_bf16 v[244:247], a[180:183], a[76:79], v[244:247]
  v_mfma_f32_16x16x32_bf16 v[244:247], a[176:179], a[72:75], v[244:247]
  v_mfma_f32_16x16x32_bf16 v[248:251], a[176:179], a[80:83], v[248:251]
  v_mfma_f32_16x16x32_bf16 v[248:251], a[180:183], a[84:87], v[248:251]
  buffer_load_dwordx4 v3, s[8:11], s3 offen offset:1024 lds
  v_mfma_f32_16x16x32_bf16 v[252:255], a[180:183], a[92:95], v[252:255]
  v_mfma_f32_16x16x32_bf16 v[252:255], a[176:179], a[88:91], v[252:255]
  v_mfma_f32_16x16x32_bf16 a[0:3], a[184:187], a[32:35], a[0:3]
  v_mfma_f32_16x16x32_bf16 a[0:3], a[188:191], a[36:39], a[0:3]
  ds_read_b128 a[168:171], v10 offset:34816
  ds_read_b128 a[172:175], v11 offset:34816
  v_mfma_f32_16x16x32_bf16 a[4:7], a[188:191], a[44:47], a[4:7]
  v_mfma_f32_16x16x32_bf16 a[4:7], a[184:187], a[40:43], a[4:7]
  v_mfma_f32_16x16x32_bf16 a[8:11], a[184:187], a[48:51], a[8:11]
  buffer_load_dwordx4 v4, s[8:11], s3 offen offset:2048 lds
  v_mfma_f32_16x16x32_bf16 a[8:11], a[188:191], a[52:55], a[8:11]
  v_mfma_f32_16x16x32_bf16 a[12:15], a[188:191], a[60:63], a[12:15]
  v_mfma_f32_16x16x32_bf16 a[12:15], a[184:187], a[56:59], a[12:15]
  v_mfma_f32_16x16x32_bf16 a[16:19], a[184:187], a[64:67], a[16:19]
  v_mfma_f32_16x16x32_bf16 a[16:19], a[188:191], a[68:71], a[16:19]
  buffer_load_dwordx4 v5, s[8:11], s3 offen offset:3072 lds
  v_mfma_f32_16x16x32_bf16 a[20:23], a[188:191], a[76:79], a[20:23]
  v_mfma_f32_16x16x32_bf16 a[20:23], a[184:187], a[72:75], a[20:23]
  v_mfma_f32_16x16x32_bf16 a[24:27], a[184:187], a[80:83], a[24:27]
  v_mfma_f32_16x16x32_bf16 a[24:27], a[188:191], a[84:87], a[24:27]
  v_mfma_f32_16x16x32_bf16 a[28:31], a[188:191], a[92:95], a[28:31]
  v_mfma_f32_16x16x32_bf16 a[28:31], a[184:187], a[88:91], a[28:31]
  s_waitcnt lgkmcnt(2)
  v_mfma_f32_16x16x32_bf16 v[32:35], a[160:163], a[96:99], v[32:35]
  s_add_u32 s23, s23, 128
  s_cmp_eq_u32 s23, s25
  s_cselect_b32 s23, s26, s23
  v_mfma_f32_16x16x32_bf16 v[32:35], a[164:167], a[100:103], v[32:35]
  ds_read_b128 a[176:179], v10 offset:36864
  ds_read_b128 a[180:183], v11 offset:36864
  v_mfma_f32_16x16x32_bf16 v[36:39], a[164:167], a[108:111], v[36:39]
  v_mfma_f32_16x16x32_bf16 v[36:39], a[160:163], a[104:107], v[36:39]
  ds_read_b64_tr_b16 a[32:33], v12 offset:0
  ds_read_b64_tr_b16 a[34:35], v12 offset:2048
  v_mfma_f32_16x16x32_bf16 v[40:43], a[160:163], a[112:115], v[40:43]
  v_mfma_f32_16x16x32_bf16 v[40:43], a[164:167], a[116:119], v[40:43]
  v_mfma_f32_16x16x32_bf16 v[44:47], a[164:167], a[124:127], v[44:47]
  s_add_u32 m0, s29, 114688
  s_nop 0
  buffer_load_dwordx4 v6, s[12:15], s24 offen offset:0 lds
  v_mfma_f32_16x16x32_bf16 v[44:47], a[160:163], a[120:123], v[44:47]
  ds_read_b64_tr_b16 a[40:41], v13 offset:0
  ds_read_b64_tr_b16 a[42:43], v13 offset:2048
  v_mfma_f32_16x16x32_bf16 v[48:51], a[160:163], a[128:131], v[48:51]
  v_mfma_f32_16x16x32_bf16 v[48:51], a[164:167], a[132:135], v[48:51]
  v_mfma_f32_16x16x32_bf16 v[52:55], a[164:167], a[140:143], v[52:55]
  v_mfma_f32_16x16x32_bf16 v[52:55], a[160:163], a[136:139], v[52:55]
  ds_read_b64_tr_b16 a[48:49], v14 offset:0
  ds_read_b64_tr_b16 a[50:51], v14 offset:2048
  v_mfma_f32_16x16x32_bf16 v[56:59], a[160:163], a[144:147], v[56:59]
  v_mfma_f32_16x16x32_bf16 v[56:59], a[164:167], a[148:151], v[56:59]
  buffer_load_dwordx4 v7, s[12:15], s24 offen offset:1024 lds
  v_mfma_f32_16x16x32_bf16 v[60:63], a[164:167], a[156:159], v[60:63]
  v_mfma_f32_16x16x32_bf16 v[60:63], a[160:163], a[152:155], v[60:63]
  s_waitcnt lgkmcnt(8)
  ds_read_b64_tr_b16 a[56:57], v15 offset:0
  ds_read_b64_tr_b16 a[58:59], v15 offset:2048
  v_mfma_f32_16x16x32_bf16 v[64:67], a[168:171], a[96:99], v[64:67]
  v_mfma_f32_16x16x32_bf16 v[64:67], a[172:175], a[100:103], v[64:67]
  ds_read_b128 a[184:187], v10 offset:38912
  ds_read_b128 a[188:191], v11 offset:38912
  v_mfma_f32_16x16x32_bf16 v[68:71], a[172:175], a[108:111], v[68:71]
  v_mfma_f32_16x16x32_bf16 v[68:71], a[168:171], a[104:107], v[68:71]
  ds_read_b64_tr_b16 a[64:65], v16 offset:0
  ds_read_b64_tr_b16 a[66:67], v16 offset:2048
  v_mfma_f32_16x16x32_bf16 v[72:75], a[168:171], a[112:115], v[72:75]
  buffer_load_dwordx4 v8, s[12:15], s24 offen offset:2048 lds
  v_mfma_f32_16x16x32_bf16 v[72:75], a[172:175], a[116:119], v[72:75]
  v_mfma_f32_16x16x32_bf16 v[76:79], a[172:175], a[124:127], v[76:79]
  v_mfma_f32_16x16x32_bf16 v[76:79], a[168:171], a[120:123], v[76:79]
  ds_read_b64_tr_b16 a[72:73], v17 offset:0
  ds_read_b64_tr_b16 a[74:75], v17 offset:2048
  v_mfma_f32_16x16x32_bf16 v[80:83], a[168:171], a[128:131], v[80:83]
  v_mfma_f32_16x16x32_bf16 v[80:83], a[172:175], a[132:135], v[80:83]
  v_mfma_f32_16x16x32_bf16 v[84:87], a[172:175], a[140:143], v[84:87]
  buffer_load_dwordx4 v9, s[12:15], s24 offen offset:3072 lds
  v_mfma_f32_16x16x32_bf16 v[84:87], a[168:171], a[136:139], v[84:87]
  ds_read_b64_tr_b16 a[80:81], v18 offset:0
  ds_read_b64_tr_b16 a[82:83], v18 offset:2048
  v_mfma_f32_16x16x32_bf16 v[88:91], a[168:171], a[144:147], v[88:91]
  v_mfma_f32_16x16x32_bf16 v[88:91], a[172:175], a[148:151], v[88:91]
  v_mfma_f32_16x16x32_bf16 v[92:95], a[172:175], a[156:159], v[92:95]
  v_mfma_f32_16x16x32_bf16 v[92:95], a[168:171], a[152:155], v[92:95]
  s_waitcnt lgkmcnt(15)
  ds_read_b64_tr_b16 a[88:89], v19 offset:0
  ds_read_b64_tr_b16 a[90:91], v19 offset:2048
  v_mfma_f32_16x16x32_bf16 v[96:99], a[176:179], a[96:99], v[96:99]
  s_add_u32 s24, s24, 262144
  s_cmp_eq_u32 s24, s27
  s_cselect_b32 s24, s28, s24
  s_sub_u32 s6, s6, 1
  s_cmp_eq_u32 s6, 0
  s_cselect_b64 s[12:13], s[64:65], s[12:13]
  v_mfma_f32_16x16x32_bf16 v[96:99], a[180:183], a[100:103], v[96:99]
  v_mfma_f32_16x16x32_bf16 v[100:103], a[180:183], a[108:111], v[100:103]
  v_mfma_f32_16x16x32_bf16 v[100:103], a[176:179], a[104:107], v[100:103]
  v_mfma_f32_16x16x32_bf16 v[104:107], a[176:179], a[112:115], v[104:107]
  v_mfma_f32_16x16x32_bf16 v[104:107], a[180:183], a[116:119], v[104:107]
  v_mfma_f32_16x16x32_bf16 v[108:111], a[180:183], a[124:127], v[108:111]
  v_mfma_f32_16x16x32_bf16 v[108:111], a[176:179], a[120:123], v[108:111]
  s_waitcnt vmcnt(16) lgkmcnt(0)
  s_barrier
  ds_read_b128 a[160:163], v10 offset:49152
  ds_read_b128 a[164:167], v11 offset:49152
  v_mfma_f32_16x16x32_bf16 v[112:115], a[176:179], a[128:131], v[112:115]
  s_add_u32 m0, s29, 32768
  s_nop 0
  buffer_load_dwordx4 v2, s[8:11], s23 offen offset:0 lds
  v_mfma_f32_16x16x32_bf16 v[112:115], a[180:183], a[132:135], v[112:115]
  v_mfma_f32_16x16x32_bf16 v[116:119], a[180:183], a[140:143], v[116:119]
  v_mfma_f32_16x16x32_bf16 v[116:119], a[176:179], a[136:139], v[116:119]
  ds_read_b64_tr_b16 a[36:37], v12 offset:16384
  ds_read_b64_tr_b16 a[38:39], v12 offset:18432
  v_mfma_f32_16x16x32_bf16 v[120:123], a[176:179], a[144:147], v[120:123]
  v_mfma_f32_16x16x32_bf16 v[120:123], a[180:183], a[148:151], v[120:123]
  v_mfma_f32_16x16x32_bf16 v[124:127], a[180:183], a[156:159], v[124:127]
  v_mfma_f32_16x16x32_bf16 v[124:127], a[176:179], a[152:155], v[124:127]
  v_mfma_f32_16x16x32_bf16 v[128:131], a[184:187], a[96:99], v[128:131]
  v_mfma_f32_16x16x32_bf16 v[128:131], a[188:191], a[100:103], v[128:131]
  ds_read_b128 a[168:171], v10 offset:51200
  ds_read_b128 a[172:175], v11 offset:51200
  ds_read_b64_tr_b16 a[44:45], v13 offset:16384
  ds_read_b64_tr_b16 a[46:47], v13 offset:18432
  v_mfma_f32_16x16x32_bf16 v[132:135], a[188:191], a[108:111], v[132:135]
  v_mfma_f32_16x16x32_bf16 v[132:135], a[184:187], a[104:107], v[132:135]
  v_mfma_f32_16x16x32_bf16 v[136:139], a[184:187], a[112:115], v[136:139]
  v_mfma_f32_16x16x32_bf16 v[136:139], a[188:191], a[116:119], v[136:139]
  v_mfma_f32_16x16x32_bf16 v[140:143], a[188:191], a[124:127], v[140:143]
  v_mfma_f32_16x16x32_bf16 v[140:143], a[184:187], a[120:123], v[140:143]
  ds_read_b64_tr_b16 a[52:53], v14 offset:16384
  ds_read_b64_tr_b16 a[54:55], v14 offset:18432
  v_mfma_f32_16x16x32_bf16 v[144:147], a[184:187], a[128:131], v[144:147]
  buffer_load_dwordx4 v3, s[8:11], s23 offen offset:1024 lds
  v_mfma_f32_16x16x32_bf16 v[144:147], a[188:191], a[132:135], v[144:147]
  v_mfma_f32_16x16x32_bf16 v[148:151], a[188:191], a[140:143], v[148:151]
  v_mfma_f32_16x16x32_bf16 v[148:151], a[184:187], a[136:139], v[148:151]
  v_mfma_f32_16x16x32_bf16 v[152:155], a[184:187], a[144:147], v[152:155]
  v_mfma_f32_16x16x32_bf16 v[152:155], a[188:191], a[148:151], v[152:155]
  ds_read_b64_tr_b16 a[60:61], v15 offset:16384
  ds_read_b64_tr_b16 a[62:63], v15 offset:18432
  v_mfma_f32_16x16x32_bf16 v[156:159], a[188:191], a[156:159], v[156:159]
  v_mfma_f32_16x16x32_bf16 v[156:159], a[184:187], a[152:155], v[156:159]
  s_waitcnt lgkmcnt(10)
  v_mfma_f32_16x16x32_bf16 v[160:163], a[160:163], a[96:99], v[160:163]
  v_mfma_f32_16x16x32_bf16 v[160:163], a[164:167], a[100:103], v[160:163]
  ds_read_b128 a[176:179], v10 offset:53248
  ds_read_b128 a[180:183], v11 offset:53248
  v_mfma_f32_16x16x32_bf16 v[164:167], a[164:167], a[108:111], v[164:167]
  v_mfma_f32_16x16x32_bf16 v[164:167], a[160:163], a[104:107], v[164:167]
  ds_read_b64_tr_b16 a[68:69], v16 offset:16384
  ds_read_b64_tr_b16 a[70:71], v16 offset:18432
  v_mfma_f32_16x16x32_bf16 v[168:171], a[160:163], a[112:115], v[168:171]
  v_mfma_f32_16x16x32_bf16 v[168:171], a[164:167], a[116:119], v[168:171]
  v_mfma_f32_16x16x32_bf16 v[172:175], a[164:167], a[124:127], v[172:175]
  v_mfma_f32_16x16x32_bf16 v[172:175], a[160:163], a[120:123], v[172:175]
  v_mfma_f32_16x16x32_bf16 v[176:179], a[160:163], a[128:131], v[176:179]
  buffer_load_dwordx4 v4, s[8:11], s23 offen offset:2048 lds
  v_mfma_f32_16x16x32_bf16 v[176:179], a[164:167], a[132:135], v[176:179]
  ds_read_b64_tr_b16 a[76:77], v17 offset:16384
  ds_read_b64_tr_b16 a[78:79], v17 offset:18432
  v_mfma_f32_16x16x32_bf16 v[180:183], a[164:167], a[140:143], v[180:183]
  v_mfma_f32_16x16x32_bf16 v[180:183], a[160:163], a[136:139], v[180:183]
  v_mfma_f32_16x16x32_bf16 v[184:187], a[160:163], a[144:147], v[184:187]
  v_mfma_f32_16x16x32_bf16 v[184:187], a[164:167], a[148:151], v[184:187]
  v_mfma_f32_16x16x32_bf16 v[188:191], a[164:167], a[156:159], v[188:191]
  v_mfma_f32_16x16x32_bf16 v[188:191], a[160:163], a[152:155], v[188:191]
  s_waitcnt lgkmcnt(12)
  ds_read_b64_tr_b16 a[84:85], v18 offset:16384
  ds_read_b64_tr_b16 a[86:87], v18 offset:18432
  v_mfma_f32_16x16x32_bf16 v[192:195], a[168:171], a[96:99], v[192:195]
  v_mfma_f32_16x16x32_bf16 v[192:195], a[172:175], a[100:103], v[192:195]
  ds_read_b128 a[184:187], v10 offset:55296
  ds_read_b128 a[188:191], v11 offset:55296
  v_mfma_f32_16x16x32_bf16 v[196:199], a[172:175], a[108:111], v[196:199]
  v_mfma_f32_16x16x32_bf16 v[196:199], a[168:171], a[104:107], v[196:199]
  v_mfma_f32_16x16x32_bf16 v[200:203], a[168:171], a[112:115], v[200:203]
  v_mfma_f32_16x16x32_bf16 v[200:203], a[172:175], a[116:119], v[200:203]
  ds_read_b64_tr_b16 a[92:93], v19 offset:16384
  ds_read_b64_tr_b16 a[94:95], v19 offset:18432
  v_mfma_f32_16x16x32_bf16 v[204:207], a[172:175], a[124:127], v[204:207]
  v_mfma_f32_16x16x32_bf16 v[204:207], a[168:171], a[120:123], v[204:207]
  v_mfma_f32_16x16x32_bf16 v[208:211], a[168:171], a[128:131], v[208:211]
  buffer_load_dwordx4 v5, s[8:11], s23 offen offset:3072 lds
  v_mfma_f32_16x16x32_bf16 v[208:211], a[172:175], a[132:135], v[208:211]
  v_mfma_f32_16x16x32_bf16 v[212:215], a[172:175], a[140:143], v[212:215]
  v_mfma_f32_16x16x32_bf16 v[212:215], a[168:171], a[136:139], v[212:215]
  v_mfma_f32_16x16x32_bf16 v[216:219], a[168:171], a[144:147], v[216:219]
  v_mfma_f32_16x16x32_bf16 v[216:219], a[172:175], a[148:151], v[216:219]
  v_mfma_f32_16x16x32_bf16 v[220:223], a[172:175], a[156:159], v[220:223]
  v_mfma_f32_16x16x32_bf16 v[220:223], a[168:171], a[152:155], v[220:223]
  s_waitcnt lgkmcnt(10)
  v_mfma_f32_16x16x32_bf16 v[224:227], a[176:179], a[96:99], v[224:227]
  v_mfma_f32_16x16x32_bf16 v[224:227], a[180:183], a[100:103], v[224:227]
  v_mfma_f32_16x16x32_bf16 v[228:231], a[180:183], a[108:111], v[228:231]
  v_mfma_f32_16x16x32_bf16 v[228:231], a[176:179], a[104:107], v[228:231]
  v_mfma_f32_16x16x32_bf16 v[232:235], a[176:179], a[112:115], v[232:235]
  v_mfma_f32_16x16x32_bf16 v[232:235], a[180:183], a[116:119], v[232:235]
  v_mfma_f32_16x16x32_bf16 v[236:239], a[180:183], a[124:127], v[236:239]
  v_mfma_f32_16x16x32_bf16 v[236:239], a[176:179], a[120:123], v[236:239]
  s_waitcnt vmcnt(12) lgkmcnt(0)
  s_barrier
  ds_read_b128 a[160:163], v10 offset:0
  ds_read_b128 a[164:167], v11 offset:0
  v_mfma_f32_16x16x32_bf16 v[240:243], a[176:179], a[128:131], v[240:243]
  s_add_u32 m0, s29, 49152
  s_add_u32 s3, s23, s31
  buffer_load_dwordx4 v2, s[8:11], s3 offen offset:0 lds
  v_mfma_f32_16x16x32_bf16 v[240:243], a[180:183], a[132:135], v[240:243]
  v_mfma_f32_16x16x32_bf16 v[244:247], a[180:183], a[140:143], v[244:247]
  v_mfma_f32_16x16x32_bf16 v[244:247], a[176:179], a[136:139], v[244:247]
  v_mfma_f32_16x16x32_bf16 v[248:251], a[176:179], a[144:147], v[248:251]
  v_mfma_f32_16x16x32_bf16 v[248:251], a[180:183], a[148:151], v[248:251]
  v_mfma_f32_16x16x32_bf16 v[252:255], a[180:183], a[156:159], v[252:255]
  v_mfma_f32_16x16x32_bf16 v[252:255], a[176:179], a[152:155], v[252:255]
  v_mfma_f32_16x16x32_bf16 a[0:3], a[184:187], a[96:99], a[0:3]
  v_mfma_f32_16x16x32_bf16 a[0:3], a[188:191], a[100:103], a[0:3]
  ds_read_b128 a[168:171], v10 offset:2048
  ds_read_b128 a[172:175], v11 offset:2048
  v_mfma_f32_16x16x32_bf16 a[4:7], a[188:191], a[108:111], a[4:7]
  v_mfma_f32_16x16x32_bf16 a[4:7], a[184:187], a[104:107], a[4:7]
  v_mfma_f32_16x16x32_bf16 a[8:11], a[184:187], a[112:115], a[8:11]
  buffer_load_dwordx4 v3, s[8:11], s3 offen offset:1024 lds
  v_mfma_f32_16x16x32_bf16 a[8:11], a[188:191], a[116:119], a[8:11]
  v_mfma_f32_16x16x32_bf16 a[12:15], a[188:191], a[124:127], a[12:15]
  v_mfma_f32_16x16x32_bf16 a[12:15], a[184:187], a[120:123], a[12:15]
  v_mfma_f32_16x16x32_bf16 a[16:19], a[184:187], a[128:131], a[16:19]
  v_mfma_f32_16x16x32_bf16 a[16:19], a[188:191], a[132:135], a[16:19]
  v_mfma_f32_16x16x32_bf16 a[20:23], a[188:191], a[140:143], a[20:23]
  v_mfma_f32_16x16x32_bf16 a[20:23], a[184:187], a[136:139], a[20:23]
  v_mfma_f32_16x16x32_bf16 a[24:27], a[184:187], a[144:147], a[24:27]
  v_mfma_f32_16x16x32_bf16 a[24:27], a[188:191], a[148:151], a[24:27]
  v_mfma_f32_16x16x32_bf16 a[28:31], a[188:191], a[156:159], a[28:31]
  v_mfma_f32_16x16x32_bf16 a[28:31], a[184:187], a[152:155], a[28:31]
  s_waitcnt lgkmcnt(2)
  v_mfma_f32_16x16x32_bf16 v[32:35], a[160:163], a[32:35], v[32:35]
  buffer_load_dwordx4 v4, s[8:11], s3 offen offset:2048 lds
  v_mfma_f32_16x16x32_bf16 v[32:35], a[164:167], a[36:39], v[32:35]
  ds_read_b128 a[176:179], v10 offset:4096
  ds_read_b128 a[180:183], v11 offset:4096
  v_mfma_f32_16x16x32_bf16 v[36:39], a[164:167], a[44:47], v[36:39]
  v_mfma_f32_16x16x32_bf16 v[36:39], a[160:163], a[40:43], v[36:39]
  ds_read_b64_tr_b16 a[96:97], v12 offset:32768
  ds_read_b64_tr_b16 a[98:99], v12 offset:34816
  v_mfma_f32_16x16x32_bf16 v[40:43], a[160:163], a[48:51], v[40:43]
  v_mfma_f32_16x16x32_bf16 v[40:43], a[164:167], a[52:55], v[40:43]
  v_mfma_f32_16x16x32_bf16 v[44:47], a[164:167], a[60:63], v[44:47]
  v_mfma_f32_16x16x32_bf16 v[44:47], a[160:163], a[56:59], v[44:47]
  ds_read_b64_tr_b16 a[104:105], v13 offset:32768
  ds_read_b64_tr_b16 a[106:107], v13 offset:34816
  v_mfma_f32_16x16x32_bf16 v[48:51], a[160:163], a[64:67], v[48:51]
  v_mfma_f32_16x16x32_bf16 v[48:51], a[164:167], a[68:71], v[48:51]
  v_mfma_f32_16x16x32_bf16 v[52:55], a[164:167], a[76:79], v[52:55]
  v_mfma_f32_16x16x32_bf16 v[52:55], a[160:163], a[72:75], v[52:55]
  ds_read_b64_tr_b16 a[112:113], v14 offset:32768
  ds_read_b64_tr_b16 a[114:115], v14 offset:34816
  v_mfma_f32_16x16x32_bf16 v[56:59], a[160:163], a[80:83], v[56:59]
  v_mfma_f32_16x16x32_bf16 v[56:59], a[164:167], a[84:87], v[56:59]
  buffer_load_dwordx4 v5, s[8:11], s3 offen offset:3072 lds
  v_mfma_f32_16x16x32_bf16 v[60:63], a[164:167], a[92:95], v[60:63]
  v_mfma_f32_16x16x32_bf16 v[60:63], a[160:163], a[88:91], v[60:63]
  s_waitcnt lgkmcnt(8)
  ds_read_b64_tr_b16 a[120:121], v15 offset:32768
  ds_read_b64_tr_b16 a[122:123], v15 offset:34816
  v_mfma_f32_16x16x32_bf16 v[64:67], a[168:171], a[32:35], v[64:67]
  v_mfma_f32_16x16x32_bf16 v[64:67], a[172:175], a[36:39], v[64:67]
  ds_read_b128 a[184:187], v10 offset:6144
  ds_read_b128 a[188:191], v11 offset:6144
  v_mfma_f32_16x16x32_bf16 v[68:71], a[172:175], a[44:47], v[68:71]
  v_mfma_f32_16x16x32_bf16 v[68:71], a[168:171], a[40:43], v[68:71]
  ds_read_b64_tr_b16 a[128:129], v16 offset:32768
  ds_read_b64_tr_b16 a[130:131], v16 offset:34816
  v_mfma_f32_16x16x32_bf16 v[72:75], a[168:171], a[48:51], v[72:75]
  v_mfma_f32_16x16x32_bf16 v[72:75], a[172:175], a[52:55], v[72:75]
  v_mfma_f32_16x16x32_bf16 v[76:79], a[172:175], a[60:63], v[76:79]
  v_mfma_f32_16x16x32_bf16 v[76:79], a[168:171], a[56:59], v[76:79]
  ds_read_b64_tr_b16 a[136:137], v17 offset:32768
  ds_read_b64_tr_b16 a[138:139], v17 offset:34816
  v_mfma_f32_16x16x32_bf16 v[80:83], a[168:171], a[64:67], v[80:83]
  v_mfma_f32_16x16x32_bf16 v[80:83], a[172:175], a[68:71], v[80:83]
  v_mfma_f32_16x16x32_bf16 v[84:87], a[172:175], a[76:79], v[84:87]
  s_add_u32 s23, s23, 128
  s_cmp_eq_u32 s23, s25
  s_cselect_b32 s23, s26, s23
  v_mfma_f32_16x16x32_bf16 v[84:87], a[168:171], a[72:75], v[84:87]
  ds_read_b64_tr_b16 a[144:145], v18 offset:32768
  ds_read_b64_tr_b16 a[146:147], v18 offset:34816
  v_mfma_f32_16x16x32_bf16 v[88:91], a[168:171], a[80:83], v[88:91]
  v_mfma_f32_16x16x32_bf16 v[88:91], a[172:175], a[84:87], v[88:91]
  v_mfma_f32_16x16x32_bf16 v[92:95], a[172:175], a[92:95], v[92:95]
  v_mfma_f32_16x16x32_bf16 v[92:95], a[168:171], a[88:91], v[92:95]
  s_waitcnt lgkmcnt(15)
  ds_read_b64_tr_b16 a[152:153], v19 offset:32768
  ds_read_b64_tr_b16 a[154:155], v19 offset:34816
  v_mfma_f32_16x16x32_bf16 v[96:99], a[176:179], a[32:35], v[96:99]
  v_mfma_f32_16x16x32_bf16 v[96:99], a[180:183], a[36:39], v[96:99]
  v_mfma_f32_16x16x32_bf16 v[100:103], a[180:183], a[44:47], v[100:103]
  v_mfma_f32_16x16x32_bf16 v[100:103], a[176:179], a[40:43], v[100:103]
  v_mfma_f32_16x16x32_bf16 v[104:107], a[176:179], a[48:51], v[104:107]
  v_mfma_f32_16x16x32_bf16 v[104:107], a[180:183], a[52:55], v[104:107]
  v_mfma_f32_16x16x32_bf16 v[108:111], a[180:183], a[60:63], v[108:111]
  v_mfma_f32_16x16x32_bf16 v[108:111], a[176:179], a[56:59], v[108:111]
  s_waitcnt vmcnt(8) lgkmcnt(0)
  s_barrier
  ds_read_b128 a[160:163], v10 offset:16384
  ds_read_b128 a[164:167], v11 offset:16384
  v_mfma_f32_16x16x32_bf16 v[112:115], a[176:179], a[64:67], v[112:115]
  v_mfma_f32_16x16x32_bf16 v[112:115], a[180:183], a[68:71], v[112:115]
  s_and_b32 s3, s2, 1
  s_lshl_b32 s3, s3, 3
  s_bfe_u32 s4, s2, 0x30003
  v_mfma_f32_16x16x32_bf16 v[116:119], a[180:183], a[76:79], v[116:119]
  s_add_u32 s26, s3, s4
  s_bfe_u32 s3, s2, 0x20001
  v_mfma_f32_16x16x32_bf16 v[116:119], a[176:179], a[72:75], v[116:119]
  ds_read_b64_tr_b16 a[100:101], v12 offset:49152
  ds_read_b64_tr_b16 a[102:103], v12 offset:51200
  s_lshl_b32 s3, s3, 2
  s_lshr_b32 s4, s2, 6
  s_add_u32 s27, s3, s4
  v_mfma_f32_16x16x32_bf16 v[120:123], a[176:179], a[80:83], v[120:123]
  s_lshl_b32 s23, s26, 18
  s_sub_u32 s24, s23, 32768
  v_mfma_f32_16x16x32_bf16 v[120:123], a[180:183], a[84:87], v[120:123]
  s_max_i32 s24, s24, 0
  s_lshl_b32 s25, s27, 7
  s_xor_b32 s3, s26, s27
  v_mfma_f32_16x16x32_bf16 v[124:127], a[180:183], a[92:95], v[124:127]
  s_and_b32 s3, s3, 0
  s_lshl_b32 s3, s3, 3
  v_mfma_f32_16x16x32_bf16 v[124:127], a[176:179], a[88:91], v[124:127]
  s_sub_u32 s31, 16, s3
  s_mov_b32 s54, s31
  s_movk_i32 s57, 128
  v_mfma_f32_16x16x32_bf16 v[128:131], a[184:187], a[32:35], v[128:131]
  s_mov_b32 s55, 4289069056
  s_mov_b32 s56, 393216
  v_mfma_f32_16x16x32_bf16 v[128:131], a[188:191], a[36:39], v[128:131]
  ds_read_b128 a[168:171], v10 offset:18432
  ds_read_b128 a[172:175], v11 offset:18432
  ds_read_b64_tr_b16 a[108:109], v13 offset:49152
  ds_read_b64_tr_b16 a[110:111], v13 offset:51200
  s_lshl_b32 s4, s3, 7
  s_add_u32 s23, s23, s4
  v_mfma_f32_16x16x32_bf16 v[132:135], a[188:191], a[44:47], v[132:135]
  s_add_u32 s24, s24, s4
  s_mul_i32 s4, s3, 393216
  s_add_u32 s25, s25, s4
  v_mfma_f32_16x16x32_bf16 v[132:135], a[184:187], a[40:43], v[132:135]
  s_mov_b64 s[8:9], s[44:45]
  s_mov_b32 s10, 4194304
  v_mfma_f32_16x16x32_bf16 v[136:139], a[184:187], a[48:51], v[136:139]
  s_mov_b64 s[12:13], s[46:47]
  s_mov_b32 s14, 6291456
  s_lshl_b32 s28, s20, 9
  v_mfma_f32_16x16x32_bf16 v[136:139], a[188:191], a[52:55], v[136:139]
  s_mul_i32 s30, s20, 6144
  s_lshl_b32 s3, s20, 5
  v_mfma_f32_16x16x32_bf16 v[140:143], a[188:191], a[60:63], v[140:143]
  v_lshrrev_b32 v24, 3, v0
  v_and_b32 v25, 7, v0
  v_add_u32 v28, s3, v24
  v_mfma_f32_16x16x32_bf16 v[140:143], a[184:187], a[56:59], v[140:143]
  ds_read_b64_tr_b16 a[116:117], v14 offset:49152
  ds_read_b64_tr_b16 a[118:119], v14 offset:51200
  v_add_u32 v26, 0, v28
  v_bfe_u32 v27, v26, 1, 3
  v_mfma_f32_16x16x32_bf16 v[144:147], a[184:187], a[64:67], v[144:147]
  v_xor_b32 v27, v27, v25
  v_lshlrev_b32 v26, 11, v26
  v_mfma_f32_16x16x32_bf16 v[144:147], a[188:191], a[68:71], v[144:147]
  v_lshl_add_u32 v26, v27, 4, v26
  v_subrev_u32 v2, 0, v26
  v_add_u32 v26, 8, v28
  v_mfma_f32_16x16x32_bf16 v[148:151], a[188:191], a[76:79], v[148:151]
  v_bfe_u32 v27, v26, 1, 3
  v_xor_b32 v27, v27, v25
  v_mfma_f32_16x16x32_bf16 v[148:151], a[184:187], a[72:75], v[148:151]
  v_lshlrev_b32 v26, 11, v26
  v_lshl_add_u32 v26, v27, 4, v26
  v_subrev_u32 v3, 1024, v26
  v_mfma_f32_16x16x32_bf16 v[152:155], a[184:187], a[80:83], v[152:155]
  v_add_u32 v26, 16, v28
  v_bfe_u32 v27, v26, 1, 3
  v_mfma_f32_16x16x32_bf16 v[152:155], a[188:191], a[84:87], v[152:155]
  ds_read_b64_tr_b16 a[124:125], v15 offset:49152
  ds_read_b64_tr_b16 a[126:127], v15 offset:51200
  v_xor_b32 v27, v27, v25
  v_lshlrev_b32 v26, 11, v26
  v_lshl_add_u32 v26, v27, 4, v26
  v_mfma_f32_16x16x32_bf16 v[156:159], a[188:191], a[92:95], v[156:159]
  v_subrev_u32 v4, 2048, v26
  v_add_u32 v26, 24, v28
  v_mfma_f32_16x16x32_bf16 v[156:159], a[184:187], a[88:91], v[156:159]
  s_waitcnt lgkmcnt(10)
  v_bfe_u32 v27, v26, 1, 3
  v_xor_b32 v27, v27, v25
  v_mfma_f32_16x16x32_bf16 v[160:163], a[160:163], a[32:35], v[160:163]
  v_lshlrev_b32 v26, 11, v26
  v_lshl_add_u32 v26, v27, 4, v26
  v_subrev_u32 v5, 3072, v26
  v_mfma_f32_16x16x32_bf16 v[160:163], a[164:167], a[36:39], v[160:163]
  ds_read_b128 a[176:179], v10 offset:20480
  ds_read_b128 a[180:183], v11 offset:20480
  s_lshl_b32 s3, s20, 2
  v_add_u32 v26, s3, v24
  v_mfma_f32_16x16x32_bf16 v[164:167], a[164:167], a[44:47], v[164:167]
  v_bfe_u32 v27, v26, 1, 3
  v_xor_b32 v27, v27, v25
  v_lshlrev_b32 v26, 11, v26
  v_mfma_f32_16x16x32_bf16 v[164:167], a[160:163], a[40:43], v[164:167]
  ds_read_b64_tr_b16 a[132:133], v16 offset:49152
  ds_read_b64_tr_b16 a[134:135], v16 offset:51200
  v_lshl_add_u32 v20, v27, 4, v26
  s_mul_i32 s3, s20, 48
  v_mfma_f32_16x16x32_bf16 v[168:171], a[160:163], a[48:51], v[168:171]
  v_add_u32 v28, s3, v24
  v_add_u32 v26, 0, v28
  v_mul_u32_u24 v27, 0xaaab, v26
  v_mfma_f32_16x16x32_bf16 v[168:171], a[164:167], a[52:55], v[168:171]
  v_lshrrev_b32 v27, 17, v27
  v_lshrrev_b32 v29, 1, v27
  v_mfma_f32_16x16x32_bf16 v[172:175], a[164:167], a[60:63], v[172:175]
  v_and_b32 v29, 4, v29
  v_and_or_b32 v27, v27, 2, v29
  v_mfma_f32_16x16x32_bf16 v[172:175], a[160:163], a[56:59], v[172:175]
  v_xor_b32 v27, v27, v25
  v_lshlrev_b32 v26, 11, v26
  v_lshl_add_u32 v26, v27, 4, v26
  v_mfma_f32_16x16x32_bf16 v[176:179], a[160:163], a[64:67], v[176:179]
  v_subrev_u32 v6, 0, v26
  v_add_u32 v26, 8, v28
  v_mfma_f32_16x16x32_bf16 v[176:179], a[164:167], a[68:71], v[176:179]
  ds_read_b64_tr_b16 a[140:141], v17 offset:49152
  ds_read_b64_tr_b16 a[142:143], v17 offset:51200
  v_mul_u32_u24 v27, 0xaaab, v26
  v_lshrrev_b32 v27, 17, v27
  v_lshrrev_b32 v29, 1, v27
  v_mfma_f32_16x16x32_bf16 v[180:183], a[164:167], a[76:79], v[180:183]
  v_and_b32 v29, 4, v29
  v_and_or_b32 v27, v27, 2, v29
  v_mfma_f32_16x16x32_bf16 v[180:183], a[160:163], a[72:75], v[180:183]
  v_xor_b32 v27, v27, v25
  v_lshlrev_b32 v26, 11, v26
  v_lshl_add_u32 v26, v27, 4, v26
  v_mfma_f32_16x16x32_bf16 v[184:187], a[160:163], a[80:83], v[184:187]
  v_subrev_u32 v7, 1024, v26
  v_add_u32 v26, 16, v28
  v_mfma_f32_16x16x32_bf16 v[184:187], a[164:167], a[84:87], v[184:187]
  v_mul_u32_u24 v27, 0xaaab, v26
  v_lshrrev_b32 v27, 17, v27
  v_mfma_f32_16x16x32_bf16 v[188:191], a[164:167], a[92:95], v[188:191]
  v_lshrrev_b32 v29, 1, v27
  v_and_b32 v29, 4, v29
  v_and_or_b32 v27, v27, 2, v29
  v_mfma_f32_16x16x32_bf16 v[188:191], a[160:163], a[88:91], v[188:191]
  s_waitcnt lgkmcnt(12)
  ds_read_b64_tr_b16 a[148:149], v18 offset:49152
  ds_read_b64_tr_b16 a[150:151], v18 offset:51200
  v_xor_b32 v27, v27, v25
  v_lshlrev_b32 v26, 11, v26
  v_mfma_f32_16x16x32_bf16 v[192:195], a[168:171], a[32:35], v[192:195]
  v_lshl_add_u32 v26, v27, 4, v26
  v_subrev_u32 v8, 2048, v26
  v_add_u32 v26, 24, v28
  v_mfma_f32_16x16x32_bf16 v[192:195], a[172:175], a[36:39], v[192:195]
  ds_read_b128 a[184:187], v10 offset:22528
  ds_read_b128 a[188:191], v11 offset:22528
  v_mul_u32_u24 v27, 0xaaab, v26
  v_lshrrev_b32 v27, 17, v27
  v_mfma_f32_16x16x32_bf16 v[196:199], a[172:175], a[44:47], v[196:199]
  v_lshrrev_b32 v29, 1, v27
  v_and_b32 v29, 4, v29
  v_and_or_b32 v27, v27, 2, v29
  v_mfma_f32_16x16x32_bf16 v[196:199], a[168:171], a[40:43], v[196:199]
  v_xor_b32 v27, v27, v25
  v_lshlrev_b32 v26, 11, v26
  v_mfma_f32_16x16x32_bf16 v[200:203], a[168:171], a[48:51], v[200:203]
  v_lshl_add_u32 v26, v27, 4, v26
  v_subrev_u32 v9, 3072, v26
  v_mfma_f32_16x16x32_bf16 v[200:203], a[172:175], a[52:55], v[200:203]
  ds_read_b64_tr_b16 a[156:157], v19 offset:49152
  ds_read_b64_tr_b16 a[158:159], v19 offset:51200
  v_add_u32 v26, 32, v28
  v_mul_u32_u24 v27, 0xaaab, v26
  v_lshrrev_b32 v27, 17, v27
  v_mfma_f32_16x16x32_bf16 v[204:207], a[172:175], a[60:63], v[204:207]
  v_lshrrev_b32 v29, 1, v27
  v_and_b32 v29, 4, v29
  v_mfma_f32_16x16x32_bf16 v[204:207], a[168:171], a[56:59], v[204:207]
  v_and_or_b32 v27, v27, 2, v29
  v_xor_b32 v27, v27, v25
  v_lshlrev_b32 v26, 11, v26
  v_mfma_f32_16x16x32_bf16 v[208:211], a[168:171], a[64:67], v[208:211]
  v_lshl_add_u32 v26, v27, 4, v26
  v_subrev_u32 v21, 0, v26
  v_mfma_f32_16x16x32_bf16 v[208:211], a[172:175], a[68:71], v[208:211]
  v_add_u32 v26, 40, v28
  v_mul_u32_u24 v27, 0xaaab, v26
  v_lshrrev_b32 v27, 17, v27
  v_mfma_f32_16x16x32_bf16 v[212:215], a[172:175], a[76:79], v[212:215]
  v_lshrrev_b32 v29, 1, v27
  v_and_b32 v29, 4, v29
  v_mfma_f32_16x16x32_bf16 v[212:215], a[168:171], a[72:75], v[212:215]
  v_and_or_b32 v27, v27, 2, v29
  v_xor_b32 v27, v27, v25
  v_mfma_f32_16x16x32_bf16 v[216:219], a[168:171], a[80:83], v[216:219]
  v_lshlrev_b32 v26, 11, v26
  v_lshl_add_u32 v26, v27, 4, v26
  v_subrev_u32 v22, 1024, v26
  v_mfma_f32_16x16x32_bf16 v[216:219], a[172:175], a[84:87], v[216:219]
  s_lshr_b32 s3, s53, 7
  s_add_u32 s3, s3, s22
  v_mfma_f32_16x16x32_bf16 v[220:223], a[172:175], a[92:95], v[220:223]
  s_lshl_b32 s3, s3, 5
  s_lshr_b32 s19, s52, 6
  s_add_u32 s3, s3, s19
  v_mfma_f32_16x16x32_bf16 v[220:223], a[168:171], a[88:91], v[220:223]
  s_waitcnt lgkmcnt(10)
  s_lshl_b32 s19, s21, 1
  s_add_u32 s3, s3, s19
  v_mfma_f32_16x16x32_bf16 v[224:227], a[176:179], a[32:35], v[224:227]
  s_lshl_b32 s92, s3, 15
  s_add_u32 s92, s92, 16384
  s_add_u32 s93, s92, 32768
  v_mfma_f32_16x16x32_bf16 v[224:227], a[180:183], a[36:39], v[224:227]
  s_add_u32 s16, s50, 16777216
  s_addc_u32 s17, s51, 0
  v_mfma_f32_16x16x32_bf16 v[228:231], a[180:183], a[44:47], v[228:231]
  s_mov_b32 s18, 33554432
  s_mov_b32 s19, 0x00020000
  v_mfma_f32_16x16x32_bf16 v[228:231], a[176:179], a[40:43], v[228:231]
  v_mfma_f32_16x16x32_bf16 v[232:235], a[176:179], a[48:51], v[232:235]
  v_mfma_f32_16x16x32_bf16 v[232:235], a[180:183], a[52:55], v[232:235]
  v_mfma_f32_16x16x32_bf16 v[236:239], a[180:183], a[60:63], v[236:239]
  v_mfma_f32_16x16x32_bf16 v[236:239], a[176:179], a[56:59], v[236:239]
  s_waitcnt vmcnt(4) lgkmcnt(0)
  s_barrier
  ds_read_b128 a[160:163], v10 offset:32768
  ds_read_b128 a[164:167], v11 offset:32768
  v_mfma_f32_16x16x32_bf16 v[240:243], a[176:179], a[64:67], v[240:243]
  s_add_u32 m0, s28, 131072
  s_mov_b32 exec_hi, 0
  buffer_load_dwordx4 v20, s[8:11], s24 offen lds
  s_mov_b32 exec_hi, -1
  v_mfma_f32_16x16x32_bf16 v[240:243], a[180:183], a[68:71], v[240:243]
  v_mfma_f32_16x16x32_bf16 v[244:247], a[180:183], a[76:79], v[244:247]
  v_mfma_f32_16x16x32_bf16 v[244:247], a[176:179], a[72:75], v[244:247]
  s_add_u32 m0, s29, 133120
  s_nop 0
  buffer_load_dwordx4 v2, s[8:11], s23 offen offset:0 lds
  v_mfma_f32_16x16x32_bf16 v[248:251], a[176:179], a[80:83], v[248:251]
  v_mfma_f32_16x16x32_bf16 v[248:251], a[180:183], a[84:87], v[248:251]
  v_mfma_f32_16x16x32_bf16 v[252:255], a[180:183], a[92:95], v[252:255]
  v_mfma_f32_16x16x32_bf16 v[252:255], a[176:179], a[88:91], v[252:255]
  v_mfma_f32_16x16x32_bf16 a[0:3], a[184:187], a[32:35], a[0:3]
  buffer_load_dwordx4 v3, s[8:11], s23 offen offset:1024 lds
  v_mfma_f32_16x16x32_bf16 a[0:3], a[188:191], a[36:39], a[0:3]
  ds_read_b128 a[168:171], v10 offset:34816
  ds_read_b128 a[172:175], v11 offset:34816
  v_mfma_f32_16x16x32_bf16 a[4:7], a[188:191], a[44:47], a[4:7]
  v_mfma_f32_16x16x32_bf16 a[4:7], a[184:187], a[40:43], a[4:7]
  v_mfma_f32_16x16x32_bf16 a[8:11], a[184:187], a[48:51], a[8:11]
  buffer_load_dwordx4 v4, s[8:11], s23 offen offset:2048 lds
  v_mfma_f32_16x16x32_bf16 a[8:11], a[188:191], a[52:55], a[8:11]
  v_mfma_f32_16x16x32_bf16 a[12:15], a[188:191], a[60:63], a[12:15]
  v_mfma_f32_16x16x32_bf16 a[12:15], a[184:187], a[56:59], a[12:15]
  v_mfma_f32_16x16x32_bf16 a[16:19], a[184:187], a[64:67], a[16:19]
  buffer_load_dwordx4 v5, s[8:11], s23 offen offset:3072 lds
  v_mfma_f32_16x16x32_bf16 a[16:19], a[188:191], a[68:71], a[16:19]
  v_mfma_f32_16x16x32_bf16 a[20:23], a[188:191], a[76:79], a[20:23]
  v_mfma_f32_16x16x32_bf16 a[20:23], a[184:187], a[72:75], a[20:23]
  s_sub_u32 s31, s31, 1
  s_cmp_eq_u32 s31, 0
  s_cselect_b32 s58, -1920, s57
  s_add_u32 s23, s23, s58
  s_add_u32 s24, s24, s58
  v_mfma_f32_16x16x32_bf16 a[24:27], a[184:187], a[80:83], a[24:27]
  v_mfma_f32_16x16x32_bf16 a[24:27], a[188:191], a[84:87], a[24:27]
  v_mfma_f32_16x16x32_bf16 a[28:31], a[188:191], a[92:95], a[28:31]
  v_mfma_f32_16x16x32_bf16 a[28:31], a[184:187], a[88:91], a[28:31]
  s_waitcnt lgkmcnt(2)
  v_mfma_f32_16x16x32_bf16 v[32:35], a[160:163], a[96:99], v[32:35]
  s_add_u32 m0, s30, 65536
  s_nop 0
  buffer_load_dwordx4 v6, s[12:15], s25 offen offset:0 lds
  v_mfma_f32_16x16x32_bf16 v[32:35], a[164:167], a[100:103], v[32:35]
  ds_read_b128 a[176:179], v10 offset:36864
  ds_read_b128 a[180:183], v11 offset:36864
  v_mfma_f32_16x16x32_bf16 v[36:39], a[164:167], a[108:111], v[36:39]
  v_mfma_f32_16x16x32_bf16 v[36:39], a[160:163], a[104:107], v[36:39]
  v_mfma_f32_16x16x32_bf16 v[40:43], a[160:163], a[112:115], v[40:43]
  v_mfma_f32_16x16x32_bf16 v[40:43], a[164:167], a[116:119], v[40:43]
  buffer_load_dwordx4 v7, s[12:15], s25 offen offset:1024 lds
  v_mfma_f32_16x16x32_bf16 v[44:47], a[164:167], a[124:127], v[44:47]
  v_mfma_f32_16x16x32_bf16 v[44:47], a[160:163], a[120:123], v[44:47]
  v_mfma_f32_16x16x32_bf16 v[48:51], a[160:163], a[128:131], v[48:51]
  v_mfma_f32_16x16x32_bf16 v[48:51], a[164:167], a[132:135], v[48:51]
  v_mfma_f32_16x16x32_bf16 v[52:55], a[164:167], a[140:143], v[52:55]
  buffer_load_dwordx4 v8, s[12:15], s25 offen offset:2048 lds
  v_mfma_f32_16x16x32_bf16 v[52:55], a[160:163], a[136:139], v[52:55]
  v_mfma_f32_16x16x32_bf16 v[56:59], a[160:163], a[144:147], v[56:59]
  v_mfma_f32_16x16x32_bf16 v[56:59], a[164:167], a[148:151], v[56:59]
  v_mfma_f32_16x16x32_bf16 v[60:63], a[164:167], a[156:159], v[60:63]
  v_mfma_f32_16x16x32_bf16 v[60:63], a[160:163], a[152:155], v[60:63]
  s_waitcnt lgkmcnt(2)
  v_mfma_f32_16x16x32_bf16 v[64:67], a[168:171], a[96:99], v[64:67]
  buffer_load_dwordx4 v9, s[12:15], s25 offen offset:3072 lds
  v_mfma_f32_16x16x32_bf16 v[64:67], a[172:175], a[100:103], v[64:67]
  ds_read_b128 a[184:187], v10 offset:38912
  ds_read_b128 a[188:191], v11 offset:38912
  v_mfma_f32_16x16x32_bf16 v[68:71], a[172:175], a[108:111], v[68:71]
  v_mfma_f32_16x16x32_bf16 v[68:71], a[168:171], a[104:107], v[68:71]
  v_mfma_f32_16x16x32_bf16 v[72:75], a[168:171], a[112:115], v[72:75]
  v_mfma_f32_16x16x32_bf16 v[72:75], a[172:175], a[116:119], v[72:75]
  s_add_u32 m0, s30, 69632
  s_nop 0
  buffer_load_dwordx4 v21, s[12:15], s25 offen offset:0 lds
  v_mfma_f32_16x16x32_bf16 v[76:79], a[172:175], a[124:127], v[76:79]
  v_mfma_f32_16x16x32_bf16 v[76:79], a[168:171], a[120:123], v[76:79]
  v_mfma_f32_16x16x32_bf16 v[80:83], a[168:171], a[128:131], v[80:83]
  v_mfma_f32_16x16x32_bf16 v[80:83], a[172:175], a[132:135], v[80:83]
  v_mfma_f32_16x16x32_bf16 v[84:87], a[172:175], a[140:143], v[84:87]
  buffer_load_dwordx4 v22, s[12:15], s25 offen offset:1024 lds
  v_mfma_f32_16x16x32_bf16 v[84:87], a[168:171], a[136:139], v[84:87]
  v_mfma_f32_16x16x32_bf16 v[88:91], a[168:171], a[144:147], v[88:91]
  v_mfma_f32_16x16x32_bf16 v[88:91], a[172:175], a[148:151], v[88:91]
  v_mfma_f32_16x16x32_bf16 v[92:95], a[172:175], a[156:159], v[92:95]
  v_mfma_f32_16x16x32_bf16 v[92:95], a[168:171], a[152:155], v[92:95]
  s_waitcnt lgkmcnt(2)
  v_mfma_f32_16x16x32_bf16 v[96:99], a[176:179], a[96:99], v[96:99]
  s_sub_u32 s54, s54, 1
  s_cmp_eq_u32 s54, 0
  s_cselect_b32 s58, s55, s56
  s_add_u32 s25, s25, s58
  v_mfma_f32_16x16x32_bf16 v[96:99], a[180:183], a[100:103], v[96:99]
  v_mfma_f32_16x16x32_bf16 v[100:103], a[180:183], a[108:111], v[100:103]
  v_mfma_f32_16x16x32_bf16 v[100:103], a[176:179], a[104:107], v[100:103]
  v_cvt_pk_bf16_f32 v32, v32, v33
  v_cvt_pk_bf16_f32 v33, v34, v35
  v_mfma_f32_16x16x32_bf16 v[104:107], a[176:179], a[112:115], v[104:107]
  v_cvt_pk_bf16_f32 v34, v64, v65
  v_cvt_pk_bf16_f32 v35, v66, v67
  v_mfma_f32_16x16x32_bf16 v[104:107], a[180:183], a[116:119], v[104:107]
  v_cvt_pk_bf16_f32 v64, v48, v49
  v_mfma_f32_16x16x32_bf16 v[108:111], a[180:183], a[124:127], v[108:111]
  v_cvt_pk_bf16_f32 v65, v50, v51
  v_cvt_pk_bf16_f32 v66, v80, v81
  v_mfma_f32_16x16x32_bf16 v[108:111], a[176:179], a[120:123], v[108:111]
  s_waitcnt vmcnt(11) lgkmcnt(0)
  s_barrier
  ds_read_b128 a[160:163], v10 offset:49152
  ds_read_b128 a[164:167], v11 offset:49152
  v_cvt_pk_bf16_f32 v67, v82, v83
  v_mfma_f32_16x16x32_bf16 v[112:115], a[176:179], a[128:131], v[112:115]
  s_add_u32 m0, s28, 0
  s_mov_b32 exec_hi, 0
  buffer_load_dwordx4 v20, s[8:11], s24 offen lds
  s_mov_b32 exec_hi, -1
  v_cvt_pk_bf16_f32 v48, v40, v41
  v_cvt_pk_bf16_f32 v49, v42, v43
  v_mfma_f32_16x16x32_bf16 v[112:115], a[180:183], a[132:135], v[112:115]
  v_cvt_pk_bf16_f32 v50, v72, v73
  v_cvt_pk_bf16_f32 v51, v74, v75
  v_mfma_f32_16x16x32_bf16 v[116:119], a[180:183], a[140:143], v[116:119]
  v_cvt_pk_bf16_f32 v80, v56, v57
  v_mfma_f32_16x16x32_bf16 v[116:119], a[176:179], a[136:139], v[116:119]
  v_cvt_pk_bf16_f32 v81, v58, v59
  v_cvt_pk_bf16_f32 v82, v88, v89
  v_mfma_f32_16x16x32_bf16 v[120:123], a[176:179], a[144:147], v[120:123]
  s_add_u32 m0, s29, 2048
  s_nop 0
  buffer_load_dwordx4 v2, s[8:11], s23 offen offset:0 lds
  v_cvt_pk_bf16_f32 v83, v90, v91
  v_mfma_f32_16x16x32_bf16 v[120:123], a[180:183], a[148:151], v[120:123]
  v_cvt_pk_bf16_f32 v40, v36, v37
  v_cvt_pk_bf16_f32 v41, v38, v39
  v_mfma_f32_16x16x32_bf16 v[124:127], a[180:183], a[156:159], v[124:127]
  v_cvt_pk_bf16_f32 v42, v68, v69
  v_cvt_pk_bf16_f32 v43, v70, v71
  v_mfma_f32_16x16x32_bf16 v[124:127], a[176:179], a[152:155], v[124:127]
  v_cvt_pk_bf16_f32 v72, v52, v53
  v_mfma_f32_16x16x32_bf16 v[128:131], a[184:187], a[96:99], v[128:131]
  v_cvt_pk_bf16_f32 v73, v54, v55
  v_cvt_pk_bf16_f32 v74, v84, v85
  v_mfma_f32_16x16x32_bf16 v[128:131], a[188:191], a[100:103], v[128:131]
  ds_read_b128 a[168:171], v10 offset:51200
  ds_read_b128 a[172:175], v11 offset:51200
  v_cvt_pk_bf16_f32 v75, v86, v87
  v_mfma_f32_16x16x32_bf16 v[132:135], a[188:191], a[108:111], v[132:135]
  buffer_load_dwordx4 v3, s[8:11], s23 offen offset:1024 lds
  v_cvt_pk_bf16_f32 v56, v44, v45
  v_cvt_pk_bf16_f32 v57, v46, v47
  v_mfma_f32_16x16x32_bf16 v[132:135], a[184:187], a[104:107], v[132:135]
  v_cvt_pk_bf16_f32 v58, v76, v77
  v_cvt_pk_bf16_f32 v59, v78, v79
  v_mfma_f32_16x16x32_bf16 v[136:139], a[184:187], a[112:115], v[136:139]
  v_cvt_pk_bf16_f32 v88, v60, v61
  v_mfma_f32_16x16x32_bf16 v[136:139], a[188:191], a[116:119], v[136:139]
  v_cvt_pk_bf16_f32 v89, v62, v63
  v_cvt_pk_bf16_f32 v90, v92, v93
  v_mfma_f32_16x16x32_bf16 v[140:143], a[188:191], a[124:127], v[140:143]
  buffer_load_dwordx4 v4, s[8:11], s23 offen offset:2048 lds
  v_cvt_pk_bf16_f32 v91, v94, v95
  v_mfma_f32_16x16x32_bf16 v[140:143], a[184:187], a[120:123], v[140:143]
  v_mfma_f32_16x16x32_bf16 v[144:147], a[184:187], a[128:131], v[144:147]
  v_mfma_f32_16x16x32_bf16 v[144:147], a[188:191], a[132:135], v[144:147]
  v_mfma_f32_16x16x32_bf16 v[148:151], a[188:191], a[140:143], v[148:151]
  buffer_load_dwordx4 v5, s[8:11], s23 offen offset:3072 lds
  v_mfma_f32_16x16x32_bf16 v[148:151], a[184:187], a[136:139], v[148:151]
  v_mfma_f32_16x16x32_bf16 v[152:155], a[184:187], a[144:147], v[152:155]
  v_mfma_f32_16x16x32_bf16 v[152:155], a[188:191], a[148:151], v[152:155]
  v_mfma_f32_16x16x32_bf16 v[156:159], a[188:191], a[156:159], v[156:159]
  s_sub_u32 s31, s31, 1
  s_cmp_eq_u32 s31, 0
  s_cselect_b32 s58, -1920, s57
  s_add_u32 s23, s23, s58
  s_add_u32 s24, s24, s58
  v_mfma_f32_16x16x32_bf16 v[156:159], a[184:187], a[152:155], v[156:159]
  s_waitcnt lgkmcnt(2)
  v_mfma_f32_16x16x32_bf16 v[160:163], a[160:163], a[96:99], v[160:163]
  v_mfma_f32_16x16x32_bf16 v[160:163], a[164:167], a[100:103], v[160:163]
  ds_read_b128 a[176:179], v10 offset:53248
  ds_read_b128 a[180:183], v11 offset:53248
  v_mfma_f32_16x16x32_bf16 v[164:167], a[164:167], a[108:111], v[164:167]
  v_mfma_f32_16x16x32_bf16 v[164:167], a[160:163], a[104:107], v[164:167]
  v_cvt_pk_bf16_f32 v96, v96, v97
  v_cvt_pk_bf16_f32 v97, v98, v99
  v_mfma_f32_16x16x32_bf16 v[168:171], a[160:163], a[112:115], v[168:171]
  s_add_u32 m0, s30, 98304
  s_nop 0
  buffer_load_dwordx4 v6, s[12:15], s25 offen offset:0 lds
  v_cvt_pk_bf16_f32 v98, v128, v129
  v_cvt_pk_bf16_f32 v99, v130, v131
  v_mfma_f32_16x16x32_bf16 v[168:171], a[164:167], a[116:119], v[168:171]
  v_cvt_pk_bf16_f32 v128, v112, v113
  v_mfma_f32_16x16x32_bf16 v[172:175], a[164:167], a[124:127], v[172:175]
  v_cvt_pk_bf16_f32 v129, v114, v115
  v_cvt_pk_bf16_f32 v130, v144, v145
  v_mfma_f32_16x16x32_bf16 v[172:175], a[160:163], a[120:123], v[172:175]
  v_cvt_pk_bf16_f32 v131, v146, v147
  v_mfma_f32_16x16x32_bf16 v[176:179], a[160:163], a[128:131], v[176:179]
  v_cvt_pk_bf16_f32 v112, v104, v105
  v_cvt_pk_bf16_f32 v113, v106, v107
  v_mfma_f32_16x16x32_bf16 v[176:179], a[164:167], a[132:135], v[176:179]
  buffer_load_dwordx4 v7, s[12:15], s25 offen offset:1024 lds
  v_cvt_pk_bf16_f32 v114, v136, v137
  v_cvt_pk_bf16_f32 v115, v138, v139
  v_mfma_f32_16x16x32_bf16 v[180:183], a[164:167], a[140:143], v[180:183]
  v_cvt_pk_bf16_f32 v144, v120, v121
  v_mfma_f32_16x16x32_bf16 v[180:183], a[160:163], a[136:139], v[180:183]
  v_cvt_pk_bf16_f32 v145, v122, v123
  v_cvt_pk_bf16_f32 v146, v152, v153
  v_mfma_f32_16x16x32_bf16 v[184:187], a[160:163], a[144:147], v[184:187]
  v_cvt_pk_bf16_f32 v147, v154, v155
  v_mfma_f32_16x16x32_bf16 v[184:187], a[164:167], a[148:151], v[184:187]
  buffer_load_dwordx4 v8, s[12:15], s25 offen offset:2048 lds
  v_cvt_pk_bf16_f32 v104, v100, v101
  v_cvt_pk_bf16_f32 v105, v102, v103
  v_mfma_f32_16x16x32_bf16 v[188:191], a[164:167], a[156:159], v[188:191]
  v_cvt_pk_bf16_f32 v106, v132, v133
  v_cvt_pk_bf16_f32 v107, v134, v135
  v_mfma_f32_16x16x32_bf16 v[188:191], a[160:163], a[152:155], v[188:191]
  s_waitcnt lgkmcnt(2)
  v_cvt_pk_bf16_f32 v136, v116, v117
  v_mfma_f32_16x16x32_bf16 v[192:195], a[168:171], a[96:99], v[192:195]
  v_cvt_pk_bf16_f32 v137, v118, v119
  v_cvt_pk_bf16_f32 v138, v148, v149
  v_mfma_f32_16x16x32_bf16 v[192:195], a[172:175], a[100:103], v[192:195]
  ds_read_b128 a[184:187], v10 offset:55296
  ds_read_b128 a[188:191], v11 offset:55296
  v_cvt_pk_bf16_f32 v139, v150, v151
  v_mfma_f32_16x16x32_bf16 v[196:199], a[172:175], a[108:111], v[196:199]
  v_cvt_pk_bf16_f32 v120, v108, v109
  v_cvt_pk_bf16_f32 v121, v110, v111
  v_mfma_f32_16x16x32_bf16 v[196:199], a[168:171], a[104:107], v[196:199]
  buffer_load_dwordx4 v9, s[12:15], s25 offen offset:3072 lds
  v_cvt_pk_bf16_f32 v122, v140, v141
  v_cvt_pk_bf16_f32 v123, v142, v143
  v_mfma_f32_16x16x32_bf16 v[200:203], a[168:171], a[112:115], v[200:203]
  v_cvt_pk_bf16_f32 v152, v124, v125
  v_mfma_f32_16x16x32_bf16 v[200:203], a[172:175], a[116:119], v[200:203]
  v_cvt_pk_bf16_f32 v153, v126, v127
  v_cvt_pk_bf16_f32 v154, v156, v157
  v_mfma_f32_16x16x32_bf16 v[204:207], a[172:175], a[124:127], v[204:207]
  v_cvt_pk_bf16_f32 v155, v158, v159
  v_mfma_f32_16x16x32_bf16 v[204:207], a[168:171], a[120:123], v[204:207]
  s_add_u32 m0, s30, 102400
  s_nop 0
  buffer_load_dwordx4 v21, s[12:15], s25 offen offset:0 lds
  v_mfma_f32_16x16x32_bf16 v[208:211], a[168:171], a[128:131], v[208:211]
  v_mfma_f32_16x16x32_bf16 v[208:211], a[172:175], a[132:135], v[208:211]
  v_mfma_f32_16x16x32_bf16 v[212:215], a[172:175], a[140:143], v[212:215]
  v_mfma_f32_16x16x32_bf16 v[212:215], a[168:171], a[136:139], v[212:215]
  buffer_load_dwordx4 v22, s[12:15], s25 offen offset:1024 lds
  v_mfma_f32_16x16x32_bf16 v[216:219], a[168:171], a[144:147], v[216:219]
  v_mfma_f32_16x16x32_bf16 v[216:219], a[172:175], a[148:151], v[216:219]
  v_mfma_f32_16x16x32_bf16 v[220:223], a[172:175], a[156:159], v[220:223]
  v_mfma_f32_16x16x32_bf16 v[220:223], a[168:171], a[152:155], v[220:223]
  s_waitcnt lgkmcnt(2)
  v_mfma_f32_16x16x32_bf16 v[224:227], a[176:179], a[96:99], v[224:227]
  s_sub_u32 s54, s54, 1
  s_cmp_eq_u32 s54, 0
  s_cselect_b32 s58, s55, s56
  s_add_u32 s25, s25, s58
  v_mfma_f32_16x16x32_bf16 v[224:227], a[180:183], a[100:103], v[224:227]
  v_mfma_f32_16x16x32_bf16 v[228:231], a[180:183], a[108:111], v[228:231]
  v_mfma_f32_16x16x32_bf16 v[228:231], a[176:179], a[104:107], v[228:231]
  v_cvt_pk_bf16_f32 v160, v160, v161
  v_cvt_pk_bf16_f32 v161, v162, v163
  v_mfma_f32_16x16x32_bf16 v[232:235], a[176:179], a[112:115], v[232:235]
  v_cvt_pk_bf16_f32 v162, v192, v193
  v_cvt_pk_bf16_f32 v163, v194, v195
  v_mfma_f32_16x16x32_bf16 v[232:235], a[180:183], a[116:119], v[232:235]
  v_cvt_pk_bf16_f32 v192, v176, v177
  v_mfma_f32_16x16x32_bf16 v[236:239], a[180:183], a[124:127], v[236:239]
  v_cvt_pk_bf16_f32 v193, v178, v179
  v_cvt_pk_bf16_f32 v194, v208, v209
  v_mfma_f32_16x16x32_bf16 v[236:239], a[176:179], a[120:123], v[236:239]
  s_waitcnt vmcnt(63) lgkmcnt(0)
  s_barrier
  v_cvt_pk_bf16_f32 v195, v210, v211
  v_mfma_f32_16x16x32_bf16 v[240:243], a[176:179], a[128:131], v[240:243]
  s_add_u32 m0, s28, 18432
  s_mov_b32 exec_hi, 0
  buffer_load_dwordx4 v20, s[8:11], s24 offen lds
  s_mov_b32 exec_hi, -1
  v_cvt_pk_bf16_f32 v176, v168, v169
  v_cvt_pk_bf16_f32 v177, v170, v171
  v_mfma_f32_16x16x32_bf16 v[240:243], a[180:183], a[132:135], v[240:243]
  v_cvt_pk_bf16_f32 v178, v200, v201
  v_cvt_pk_bf16_f32 v179, v202, v203
  v_mfma_f32_16x16x32_bf16 v[244:247], a[180:183], a[140:143], v[244:247]
  v_cvt_pk_bf16_f32 v208, v184, v185
  v_mfma_f32_16x16x32_bf16 v[244:247], a[176:179], a[136:139], v[244:247]
  s_add_u32 m0, s29, 20480
  s_nop 0
  buffer_load_dwordx4 v2, s[8:11], s23 offen offset:0 lds
  v_cvt_pk_bf16_f32 v209, v186, v187
  v_cvt_pk_bf16_f32 v210, v216, v217
  v_mfma_f32_16x16x32_bf16 v[248:251], a[176:179], a[144:147], v[248:251]
  v_cvt_pk_bf16_f32 v211, v218, v219
  v_mfma_f32_16x16x32_bf16 v[248:251], a[180:183], a[148:151], v[248:251]
  v_cvt_pk_bf16_f32 v168, v164, v165
  v_cvt_pk_bf16_f32 v169, v166, v167
  v_mfma_f32_16x16x32_bf16 v[252:255], a[180:183], a[156:159], v[252:255]
  v_cvt_pk_bf16_f32 v170, v196, v197
  v_cvt_pk_bf16_f32 v171, v198, v199
  v_mfma_f32_16x16x32_bf16 v[252:255], a[176:179], a[152:155], v[252:255]
  v_cvt_pk_bf16_f32 v200, v180, v181
  v_mfma_f32_16x16x32_bf16 a[0:3], a[184:187], a[96:99], a[0:3]
  buffer_load_dwordx4 v3, s[8:11], s23 offen offset:1024 lds
  v_cvt_pk_bf16_f32 v201, v182, v183
  v_cvt_pk_bf16_f32 v202, v212, v213
  v_mfma_f32_16x16x32_bf16 a[0:3], a[188:191], a[100:103], a[0:3]
  v_cvt_pk_bf16_f32 v203, v214, v215
  v_mfma_f32_16x16x32_bf16 a[4:7], a[188:191], a[108:111], a[4:7]
  v_cvt_pk_bf16_f32 v184, v172, v173
  v_cvt_pk_bf16_f32 v185, v174, v175
  v_mfma_f32_16x16x32_bf16 a[4:7], a[184:187], a[104:107], a[4:7]
  v_cvt_pk_bf16_f32 v186, v204, v205
  v_cvt_pk_bf16_f32 v187, v206, v207
  v_mfma_f32_16x16x32_bf16 a[8:11], a[184:187], a[112:115], a[8:11]
  buffer_load_dwordx4 v4, s[8:11], s23 offen offset:2048 lds
  v_cvt_pk_bf16_f32 v216, v188, v189
  v_mfma_f32_16x16x32_bf16 a[8:11], a[188:191], a[116:119], a[8:11]
  v_cvt_pk_bf16_f32 v217, v190, v191
  v_cvt_pk_bf16_f32 v218, v220, v221
  v_mfma_f32_16x16x32_bf16 a[12:15], a[188:191], a[124:127], a[12:15]
  v_cvt_pk_bf16_f32 v219, v222, v223
  v_mfma_f32_16x16x32_bf16 a[12:15], a[184:187], a[120:123], a[12:15]
  buffer_load_dwordx4 v5, s[8:11], s23 offen offset:3072 lds
  v_mfma_f32_16x16x32_bf16 a[16:19], a[184:187], a[128:131], a[16:19]
  v_mfma_f32_16x16x32_bf16 a[16:19], a[188:191], a[132:135], a[16:19]
  v_mfma_f32_16x16x32_bf16 a[20:23], a[188:191], a[140:143], a[20:23]
  v_mfma_f32_16x16x32_bf16 a[20:23], a[184:187], a[136:139], a[20:23]
  s_sub_u32 s31, s31, 1
  s_cmp_eq_u32 s31, 0
  s_cselect_b32 s58, -1920, s57
  s_add_u32 s23, s23, s58
  s_add_u32 s24, s24, s58
  v_mfma_f32_16x16x32_bf16 a[24:27], a[184:187], a[144:147], a[24:27]
  v_mfma_f32_16x16x32_bf16 a[24:27], a[188:191], a[148:151], a[24:27]
  v_mfma_f32_16x16x32_bf16 a[28:31], a[188:191], a[156:159], a[28:31]
  v_mfma_f32_16x16x32_bf16 a[28:31], a[184:187], a[152:155], a[28:31]
  v_accvgpr_read_b32 v24, a0
  v_accvgpr_read_b32 v25, a1
  v_accvgpr_read_b32 v26, a2
  v_accvgpr_read_b32 v27, a3
  v_cvt_pk_bf16_f32 v224, v224, v225
  v_cvt_pk_bf16_f32 v225, v226, v227
  v_cvt_pk_bf16_f32 v226, v24, v25
  v_cvt_pk_bf16_f32 v227, v26, v27
  v_accvgpr_read_b32 v24, a16
  v_accvgpr_read_b32 v25, a17
  v_accvgpr_read_b32 v26, a18
  v_accvgpr_read_b32 v27, a19
  v_cvt_pk_bf16_f32 v36, v240, v241
  v_cvt_pk_bf16_f32 v37, v242, v243
  v_cvt_pk_bf16_f32 v38, v24, v25
  v_cvt_pk_bf16_f32 v39, v26, v27
  v_accvgpr_read_b32 v24, a24
  v_accvgpr_read_b32 v25, a25
  v_accvgpr_read_b32 v26, a26
  v_accvgpr_read_b32 v27, a27
  v_cvt_pk_bf16_f32 v52, v248, v249
  v_cvt_pk_bf16_f32 v53, v250, v251
  v_cvt_pk_bf16_f32 v54, v24, v25
  v_cvt_pk_bf16_f32 v55, v26, v27
  v_accvgpr_read_b32 v24, a8
  v_accvgpr_read_b32 v25, a9
  v_accvgpr_read_b32 v26, a10
  v_accvgpr_read_b32 v27, a11
  v_cvt_pk_bf16_f32 v240, v232, v233
  v_cvt_pk_bf16_f32 v241, v234, v235
  v_cvt_pk_bf16_f32 v242, v24, v25
  v_cvt_pk_bf16_f32 v243, v26, v27
  v_accvgpr_read_b32 v28, a4
  v_accvgpr_read_b32 v29, a5
  v_accvgpr_read_b32 v30, a6
  v_accvgpr_read_b32 v31, a7
  v_cvt_pk_bf16_f32 v232, v228, v229
  v_cvt_pk_bf16_f32 v233, v230, v231
  v_cvt_pk_bf16_f32 v234, v28, v29
  v_cvt_pk_bf16_f32 v235, v30, v31
  v_accvgpr_read_b32 v28, a12
  v_accvgpr_read_b32 v29, a13
  v_accvgpr_read_b32 v30, a14
  v_accvgpr_read_b32 v31, a15
  v_cvt_pk_bf16_f32 v248, v236, v237
  v_cvt_pk_bf16_f32 v249, v238, v239
  v_cvt_pk_bf16_f32 v250, v28, v29
  v_cvt_pk_bf16_f32 v251, v30, v31
  v_accvgpr_read_b32 v28, a20
  v_accvgpr_read_b32 v29, a21
  v_accvgpr_read_b32 v30, a22
  v_accvgpr_read_b32 v31, a23
  v_cvt_pk_bf16_f32 v44, v244, v245
  v_cvt_pk_bf16_f32 v45, v246, v247
  v_cvt_pk_bf16_f32 v46, v28, v29
  v_cvt_pk_bf16_f32 v47, v30, v31
  v_accvgpr_read_b32 v28, a28
  v_accvgpr_read_b32 v29, a29
  v_accvgpr_read_b32 v30, a30
  v_accvgpr_read_b32 v31, a31
  v_cvt_pk_bf16_f32 v60, v252, v253
  v_cvt_pk_bf16_f32 v61, v254, v255
  v_cvt_pk_bf16_f32 v62, v28, v29
  v_cvt_pk_bf16_f32 v63, v30, v31
Lk1_b:
  v_and_b32 v24, 15, v0
  v_lshlrev_b32 v24, 7, v24
  v_bfe_u32 v25, v0, 1, 3
  v_lshrrev_b32 v26, 4, v0
  v_xor_b32 v25, v25, v26
  v_lshl_add_u32 v10, v25, 4, v24
  v_xor_b32 v11, 64, v10
  v_add_u32 v12, 131072, v10
  v_add_u32 v13, 131072, v11
  v_bfe_u32 v24, v0, 2, 2
  v_lshl_add_u32 v29, v26, 3, v24
  v_mul_u32_u24 v25, 384, v29
  v_and_b32 v27, 1, v0
  v_lshl_add_u32 v25, v27, 3, v25
  v_add_u32 v25, 36864, v25
  v_lshrrev_b32 v24, 1, v29
  v_and_b32 v24, 4, v24
  v_and_or_b32 v24, v29, 2, v24
  v_bfe_u32 v26, v0, 1, 1
  s_mul_i32 s4, s20, 3
  s_add_u32 s3, s4, 0
  s_and_b32 s5, s3, 3
  s_lshl_b32 s5, s5, 1
  s_lshr_b32 s3, s3, 2
  s_lshl_b32 s3, s3, 7
  v_add_u32 v27, s5, v26
  v_xor_b32 v27, v27, v24
  v_lshl_add_u32 v27, v27, 4, v25
  v_add_u32 v14, s3, v27
  v_add_u32 v17, 61440, v14
  s_add_u32 s3, s4, 1
  s_and_b32 s5, s3, 3
  s_lshl_b32 s5, s5, 1
  s_lshr_b32 s3, s3, 2
  s_lshl_b32 s3, s3, 7
  v_add_u32 v27, s5, v26
  v_xor_b32 v27, v27, v24
  v_lshl_add_u32 v27, v27, 4, v25
  v_add_u32 v15, s3, v27
  v_add_u32 v18, 61440, v15
  s_add_u32 s3, s4, 2
  s_and_b32 s5, s3, 3
  s_lshl_b32 s5, s5, 1
  s_lshr_b32 s3, s3, 2
  s_lshl_b32 s3, s3, 7
  v_add_u32 v27, s5, v26
  v_xor_b32 v27, v27, v24
  v_lshl_add_u32 v27, v27, 4, v25
  v_add_u32 v16, s3, v27
  v_add_u32 v19, 61440, v16
  s_waitcnt vmcnt(5)
  s_barrier
  ds_read_b64_tr_b16 a[140:141], v14 offset:28672
  ds_read_b64_tr_b16 a[142:143], v14 offset:30208
  ds_read_b64_tr_b16 a[148:149], v15 offset:28672
  ds_read_b64_tr_b16 a[150:151], v15 offset:30208
  ds_read_b64_tr_b16 a[156:157], v16 offset:28672
  ds_read_b64_tr_b16 a[158:159], v16 offset:30208
  ds_read_b64_tr_b16 a[144:145], v14 offset:40960
  ds_read_b64_tr_b16 a[146:147], v14 offset:42496
  ds_read_b64_tr_b16 a[152:153], v15 offset:40960
  ds_read_b64_tr_b16 a[154:155], v15 offset:42496
  ds_read_b64_tr_b16 a[160:161], v16 offset:40960
  ds_read_b64_tr_b16 a[162:163], v16 offset:42496
  ds_read_b128 a[188:191], v12 offset:0
  ds_read_b128 a[192:195], v13 offset:0
  ds_read_b128 a[196:199], v12 offset:2048
  ds_read_b128 a[200:203], v13 offset:2048
  ds_read_b128 a[204:207], v12 offset:4096
  ds_read_b128 a[208:211], v13 offset:4096
  s_waitcnt lgkmcnt(0)
  s_barrier
  v_mfma_f32_16x16x32_bf16 a[32:35], a[140:143], a[188:191], 0
  ds_read_b128 a[212:215], v12 offset:6144
  ds_read_b128 a[216:219], v13 offset:6144
  v_mfma_f32_16x16x32_bf16 a[32:35], a[144:147], a[192:195], a[32:35]
  s_add_u32 m0, s30, 36864
  s_nop 0
  buffer_load_dwordx4 v6, s[12:15], s25 offen offset:0 lds
  v_mfma_f32_16x16x32_bf16 a[36:39], a[152:155], a[192:195], 0
  ds_read_b64_tr_b16 a[164:165], v17 offset:0
  ds_read_b64_tr_b16 a[166:167], v17 offset:1536
  v_mfma_f32_16x16x32_bf16 a[36:39], a[148:151], a[188:191], a[36:39]
  buffer_load_dwordx4 v7, s[12:15], s25 offen offset:1024 lds
  v_mfma_f32_16x16x32_bf16 a[40:43], a[156:159], a[188:191], 0
  v_mfma_f32_16x16x32_bf16 a[40:43], a[160:163], a[192:195], a[40:43]
  buffer_load_dwordx4 v8, s[12:15], s25 offen offset:2048 lds
  v_mfma_f32_16x16x32_bf16 a[44:47], a[144:147], a[200:203], 0
  ds_read_b128 a[220:223], v12 offset:8192
  ds_read_b128 a[224:227], v13 offset:8192
  v_mfma_f32_16x16x32_bf16 a[44:47], a[140:143], a[196:199], a[44:47]
  v_mfma_f32_16x16x32_bf16 a[48:51], a[148:151], a[196:199], 0
  ds_read_b64_tr_b16 a[172:173], v18 offset:0
  ds_read_b64_tr_b16 a[174:175], v18 offset:1536
  v_mfma_f32_16x16x32_bf16 a[48:51], a[152:155], a[200:203], a[48:51]
  buffer_load_dwordx4 v9, s[12:15], s25 offen offset:3072 lds
  v_mfma_f32_16x16x32_bf16 a[52:55], a[160:163], a[200:203], 0
  v_mfma_f32_16x16x32_bf16 a[52:55], a[156:159], a[196:199], a[52:55]
  s_add_u32 m0, s30, 40960
  s_nop 0
  buffer_load_dwordx4 v21, s[12:15], s25 offen offset:0 lds
  v_mfma_f32_16x16x32_bf16 a[56:59], a[140:143], a[204:207], 0
  ds_read_b128 a[228:231], v12 offset:10240
  ds_read_b128 a[232:235], v13 offset:10240
  v_mfma_f32_16x16x32_bf16 a[56:59], a[144:147], a[208:211], a[56:59]
  v_mfma_f32_16x16x32_bf16 a[60:63], a[152:155], a[208:211], 0
  ds_read_b64_tr_b16 a[180:181], v19 offset:0
  ds_read_b64_tr_b16 a[182:183], v19 offset:1536
  v_mfma_f32_16x16x32_bf16 a[60:63], a[148:151], a[204:207], a[60:63]
  buffer_load_dwordx4 v22, s[12:15], s25 offen offset:1024 lds
  v_mfma_f32_16x16x32_bf16 a[64:67], a[156:159], a[204:207], 0
  v_mfma_f32_16x16x32_bf16 a[64:67], a[160:163], a[208:211], a[64:67]
  s_sub_u32 s54, s54, 1
  s_cmp_eq_u32 s54, 0
  s_cselect_b32 s58, s55, s56
  s_add_u32 s25, s25, s58
  s_waitcnt lgkmcnt(10)
  v_mfma_f32_16x16x32_bf16 a[68:71], a[144:147], a[216:219], 0
  ds_read_b128 a[188:191], v12 offset:12288
  ds_read_b128 a[192:195], v13 offset:12288
  v_mfma_f32_16x16x32_bf16 a[68:71], a[140:143], a[212:215], a[68:71]
  v_mfma_f32_16x16x32_bf16 a[72:75], a[148:151], a[212:215], 0
  ds_read_b64_tr_b16 a[168:169], v17 offset:12288
  ds_read_b64_tr_b16 a[170:171], v17 offset:13824
  v_mfma_f32_16x16x32_bf16 a[72:75], a[152:155], a[216:219], a[72:75]
  s_add_u32 m0, s30, 65536
  s_nop 0
  buffer_load_dwordx4 v6, s[12:15], s25 offen offset:0 lds
  v_mfma_f32_16x16x32_bf16 a[76:79], a[160:163], a[216:219], 0
  v_mfma_f32_16x16x32_bf16 a[76:79], a[156:159], a[212:215], a[76:79]
  buffer_load_dwordx4 v7, s[12:15], s25 offen offset:1024 lds
  s_waitcnt lgkmcnt(10)
  v_mfma_f32_16x16x32_bf16 a[80:83], a[140:143], a[220:223], 0
  ds_read_b128 a[196:199], v12 offset:14336
  ds_read_b128 a[200:203], v13 offset:14336
  v_mfma_f32_16x16x32_bf16 a[80:83], a[144:147], a[224:227], a[80:83]
  v_mfma_f32_16x16x32_bf16 a[84:87], a[152:155], a[224:227], 0
  ds_read_b64_tr_b16 a[176:177], v18 offset:12288
  ds_read_b64_tr_b16 a[178:179], v18 offset:13824
  v_mfma_f32_16x16x32_bf16 a[84:87], a[148:151], a[220:223], a[84:87]
  buffer_load_dwordx4 v8, s[12:15], s25 offen offset:2048 lds
  v_mfma_f32_16x16x32_bf16 a[88:91], a[156:159], a[220:223], 0
  v_mfma_f32_16x16x32_bf16 a[88:91], a[160:163], a[224:227], a[88:91]
  buffer_load_dwordx4 v9, s[12:15], s25 offen offset:3072 lds
  s_waitcnt lgkmcnt(10)
  v_mfma_f32_16x16x32_bf16 a[92:95], a[144:147], a[232:235], 0
  ds_read_b128 a[204:207], v12 offset:16384
  ds_read_b128 a[208:211], v13 offset:16384
  v_mfma_f32_16x16x32_bf16 a[92:95], a[140:143], a[228:231], a[92:95]
  v_mfma_f32_16x16x32_bf16 a[96:99], a[148:151], a[228:231], 0
  ds_read_b64_tr_b16 a[184:185], v19 offset:12288
  ds_read_b64_tr_b16 a[186:187], v19 offset:13824
  v_mfma_f32_16x16x32_bf16 a[96:99], a[152:155], a[232:235], a[96:99]
  s_add_u32 m0, s30, 69632
  s_nop 0
  buffer_load_dwordx4 v21, s[12:15], s25 offen offset:0 lds
  v_mfma_f32_16x16x32_bf16 a[100:103], a[160:163], a[232:235], 0
  v_mfma_f32_16x16x32_bf16 a[100:103], a[156:159], a[228:231], a[100:103]
  buffer_load_dwordx4 v22, s[12:15], s25 offen offset:1024 lds
  s_waitcnt lgkmcnt(10)
  v_mfma_f32_16x16x32_bf16 a[104:107], a[140:143], a[188:191], 0
  v_mfma_f32_16x16x32_bf16 a[104:107], a[144:147], a[192:195], a[104:107]
  s_sub_u32 s54, s54, 1
  s_cmp_eq_u32 s54, 0
  s_cselect_b32 s58, s55, s56
  s_add_u32 s25, s25, s58
  v_mfma_f32_16x16x32_bf16 a[108:111], a[152:155], a[192:195], 0
  v_mfma_f32_16x16x32_bf16 a[108:111], a[148:151], a[188:191], a[108:111]
  v_mfma_f32_16x16x32_bf16 a[112:115], a[156:159], a[188:191], 0
  s_waitcnt vmcnt(6) lgkmcnt(0)
  s_barrier
  ds_read_b128 a[212:215], v10 offset:0
  ds_read_b128 a[216:219], v11 offset:0
  v_mfma_f32_16x16x32_bf16 a[112:115], a[160:163], a[192:195], a[112:115]
  s_add_u32 s94, s92, 0
  buffer_store_dwordx4 v[32:35], v1, s[16:19], s94 offen offset:0
  v_mfma_f32_16x16x32_bf16 a[116:119], a[144:147], a[200:203], 0
  ds_read_b128 a[220:223], v10 offset:2048
  ds_read_b128 a[224:227], v11 offset:2048
  v_mfma_f32_16x16x32_bf16 a[116:119], a[140:143], a[196:199], a[116:119]
  v_mfma_f32_16x16x32_bf16 a[120:123], a[148:151], a[196:199], 0
  s_add_u32 s94, s92, 0
  buffer_store_dwordx4 v[40:43], v1, s[16:19], s94 offen offset:1024
  v_mfma_f32_16x16x32_bf16 a[120:123], a[152:155], a[200:203], a[120:123]
  v_mfma_f32_16x16x32_bf16 a[124:127], a[160:163], a[200:203], 0
  v_mfma_f32_16x16x32_bf16 a[124:127], a[156:159], a[196:199], a[124:127]
  s_add_u32 m0, s28, 131072
  s_mov_b32 exec_hi, 0
  buffer_load_dwordx4 v20, s[8:11], s24 offen lds
  s_mov_b32 exec_hi, -1
  v_mfma_f32_16x16x32_bf16 a[128:131], a[140:143], a[204:207], 0
  ds_read_b128 a[228:231], v10 offset:4096
  ds_read_b128 a[232:235], v11 offset:4096
  v_mfma_f32_16x16x32_bf16 a[128:131], a[144:147], a[208:211], a[128:131]
  v_mfma_f32_16x16x32_bf16 a[132:135], a[152:155], a[208:211], 0
  v_mfma_f32_16x16x32_bf16 a[132:135], a[148:151], a[204:207], a[132:135]
  s_add_u32 m0, s29, 133120
  s_nop 0
  buffer_load_dwordx4 v2, s[8:11], s23 offen offset:0 lds
  v_mfma_f32_16x16x32_bf16 a[136:139], a[156:159], a[204:207], 0
  v_mfma_f32_16x16x32_bf16 a[136:139], a[160:163], a[208:211], a[136:139]
  s_waitcnt lgkmcnt(4)
  v_mfma_f32_16x16x32_bf16 a[32:35], a[164:167], a[212:215], a[32:35]
  ds_read_b128 a[188:191], v10 offset:6144
  ds_read_b128 a[192:195], v11 offset:6144
  v_mfma_f32_16x16x32_bf16 a[32:35], a[168:171], a[216:219], a[32:35]
  buffer_load_dwordx4 v3, s[8:11], s23 offen offset:1024 lds
  v_mfma_f32_16x16x32_bf16 a[36:39], a[176:179], a[216:219], a[36:39]
  ds_read_b64_tr_b16 a[140:141], v14 offset:0
  ds_read_b64_tr_b16 a[142:143], v14 offset:1536
  v_mfma_f32_16x16x32_bf16 a[36:39], a[172:175], a[212:215], a[36:39]
  v_mfma_f32_16x16x32_bf16 a[40:43], a[180:183], a[212:215], a[40:43]
  buffer_load_dwordx4 v4, s[8:11], s23 offen offset:2048 lds
  v_mfma_f32_16x16x32_bf16 a[40:43], a[184:187], a[216:219], a[40:43]
  s_waitcnt lgkmcnt(6)
  v_mfma_f32_16x16x32_bf16 a[44:47], a[168:171], a[224:227], a[44:47]
  ds_read_b128 a[196:199], v10 offset:8192
  ds_read_b128 a[200:203], v11 offset:8192
  v_mfma_f32_16x16x32_bf16 a[44:47], a[164:167], a[220:223], a[44:47]
  buffer_load_dwordx4 v5, s[8:11], s23 offen offset:3072 lds
  v_mfma_f32_16x16x32_bf16 a[48:51], a[172:175], a[220:223], a[48:51]
  ds_read_b64_tr_b16 a[148:149], v15 offset:0
  ds_read_b64_tr_b16 a[150:151], v15 offset:1536
  v_mfma_f32_16x16x32_bf16 a[48:51], a[176:179], a[224:227], a[48:51]
  v_mfma_f32_16x16x32_bf16 a[52:55], a[184:187], a[224:227], a[52:55]
  v_mfma_f32_16x16x32_bf16 a[52:55], a[180:183], a[220:223], a[52:55]
  s_sub_u32 s31, s31, 1
  s_cmp_eq_u32 s31, 0
  s_cselect_b32 s58, -1920, s57
  s_add_u32 s23, s23, s58
  s_add_u32 s24, s24, s58
  s_waitcnt lgkmcnt(8)
  v_mfma_f32_16x16x32_bf16 a[56:59], a[164:167], a[228:231], a[56:59]
  ds_read_b128 a[204:207], v10 offset:10240
  ds_read_b128 a[208:211], v11 offset:10240
  v_mfma_f32_16x16x32_bf16 a[56:59], a[168:171], a[232:235], a[56:59]
  v_mfma_f32_16x16x32_bf16 a[60:63], a[176:179], a[232:235], a[60:63]
  ds_read_b64_tr_b16 a[156:157], v16 offset:0
  ds_read_b64_tr_b16 a[158:159], v16 offset:1536
  v_mfma_f32_16x16x32_bf16 a[60:63], a[172:175], a[228:231], a[60:63]
  s_add_u32 m0, s30, 98304
  s_nop 0
  buffer_load_dwordx4 v6, s[12:15], s25 offen offset:0 lds
  v_mfma_f32_16x16x32_bf16 a[64:67], a[180:183], a[228:231], a[64:67]
  v_mfma_f32_16x16x32_bf16 a[64:67], a[184:187], a[232:235], a[64:67]
  s_waitcnt lgkmcnt(10)
  v_mfma_f32_16x16x32_bf16 a[68:71], a[168:171], a[192:195], a[68:71]
  ds_read_b128 a[212:215], v10 offset:12288
  ds_read_b128 a[216:219], v11 offset:12288
  v_mfma_f32_16x16x32_bf16 a[68:71], a[164:167], a[188:191], a[68:71]
  buffer_load_dwordx4 v7, s[12:15], s25 offen offset:1024 lds
  v_mfma_f32_16x16x32_bf16 a[72:75], a[172:175], a[188:191], a[72:75]
  ds_read_b64_tr_b16 a[144:145], v14 offset:12288
  ds_read_b64_tr_b16 a[146:147], v14 offset:13824
  v_mfma_f32_16x16x32_bf16 a[72:75], a[176:179], a[192:195], a[72:75]
  v_mfma_f32_16x16x32_bf16 a[76:79], a[184:187], a[192:195], a[76:79]
  buffer_load_dwordx4 v8, s[12:15], s25 offen offset:2048 lds
  v_mfma_f32_16x16x32_bf16 a[76:79], a[180:183], a[188:191], a[76:79]
  s_waitcnt lgkmcnt(10)
  v_mfma_f32_16x16x32_bf16 a[80:83], a[164:167], a[196:199], a[80:83]
  ds_read_b128 a[220:223], v10 offset:14336
  ds_read_b128 a[224:227], v11 offset:14336
  v_mfma_f32_16x16x32_bf16 a[80:83], a[168:171], a[200:203], a[80:83]
  v_mfma_f32_16x16x32_bf16 a[84:87], a[176:179], a[200:203], a[84:87]
  ds_read_b64_tr_b16 a[152:153], v15 offset:12288
  ds_read_b64_tr_b16 a[154:155], v15 offset:13824
  v_mfma_f32_16x16x32_bf16 a[84:87], a[172:175], a[196:199], a[84:87]
  buffer_load_dwordx4 v9, s[12:15], s25 offen offset:3072 lds
  v_mfma_f32_16x16x32_bf16 a[88:91], a[180:183], a[196:199], a[88:91]
  v_mfma_f32_16x16x32_bf16 a[88:91], a[184:187], a[200:203], a[88:91]
  s_add_u32 m0, s30, 102400
  s_nop 0
  buffer_load_dwordx4 v21, s[12:15], s25 offen offset:0 lds
  s_waitcnt lgkmcnt(10)
  v_mfma_f32_16x16x32_bf16 a[92:95], a[168:171], a[208:211], a[92:95]
  ds_read_b128 a[228:231], v10 offset:16384
  ds_read_b128 a[232:235], v11 offset:16384
  v_mfma_f32_16x16x32_bf16 a[92:95], a[164:167], a[204:207], a[92:95]
  v_mfma_f32_16x16x32_bf16 a[96:99], a[172:175], a[204:207], a[96:99]
  ds_read_b64_tr_b16 a[160:161], v16 offset:12288
  ds_read_b64_tr_b16 a[162:163], v16 offset:13824
  v_mfma_f32_16x16x32_bf16 a[96:99], a[176:179], a[208:211], a[96:99]
  v_mfma_f32_16x16x32_bf16 a[100:103], a[184:187], a[208:211], a[100:103]
  buffer_load_dwordx4 v22, s[12:15], s25 offen offset:1024 lds
  v_mfma_f32_16x16x32_bf16 a[100:103], a[180:183], a[204:207], a[100:103]
  s_waitcnt lgkmcnt(10)
  v_mfma_f32_16x16x32_bf16 a[104:107], a[164:167], a[212:215], a[104:107]
  s_sub_u32 s54, s54, 1
  s_cmp_eq_u32 s54, 0
  s_cselect_b32 s58, s55, s56
  s_add_u32 s25, s25, s58
  v_mfma_f32_16x16x32_bf16 a[104:107], a[168:171], a[216:219], a[104:107]
  v_mfma_f32_16x16x32_bf16 a[108:111], a[176:179], a[216:219], a[108:111]
  v_mfma_f32_16x16x32_bf16 a[108:111], a[172:175], a[212:215], a[108:111]
  v_mfma_f32_16x16x32_bf16 a[112:115], a[180:183], a[212:215], a[112:115]
  s_waitcnt vmcnt(13) lgkmcnt(0)
  s_barrier
  ds_read_b128 a[188:191], v10 offset:18432
  ds_read_b128 a[192:195], v11 offset:18432
  v_mfma_f32_16x16x32_bf16 a[112:115], a[184:187], a[216:219], a[112:115]
  s_add_u32 s94, s92, 0
  buffer_store_dwordx4 v[48:51], v1, s[16:19], s94 offen offset:2048
  v_mfma_f32_16x16x32_bf16 a[116:119], a[168:171], a[224:227], a[116:119]
  ds_read_b128 a[196:199], v10 offset:20480
  ds_read_b128 a[200:203], v11 offset:20480
  v_mfma_f32_16x16x32_bf16 a[116:119], a[164:167], a[220:223], a[116:119]
  v_mfma_f32_16x16x32_bf16 a[120:123], a[172:175], a[220:223], a[120:123]
  s_add_u32 s94, s92, 0
  buffer_store_dwordx4 v[56:59], v1, s[16:19], s94 offen offset:3072
  v_mfma_f32_16x16x32_bf16 a[120:123], a[176:179], a[224:227], a[120:123]
  v_mfma_f32_16x16x32_bf16 a[124:127], a[184:187], a[224:227], a[124:127]
  v_mfma_f32_16x16x32_bf16 a[124:127], a[180:183], a[220:223], a[124:127]
  s_add_u32 m0, s28, 0
  s_mov_b32 exec_hi, 0
  buffer_load_dwordx4 v20, s[8:11], s24 offen lds
  s_mov_b32 exec_hi, -1
  v_mfma_f32_16x16x32_bf16 a[128:131], a[164:167], a[228:231], a[128:131]
  ds_read_b128 a[204:207], v10 offset:22528
  ds_read_b128 a[208:211], v11 offset:22528
  v_mfma_f32_16x16x32_bf16 a[128:131], a[168:171], a[232:235], a[128:131]
  v_mfma_f32_16x16x32_bf16 a[132:135], a[176:179], a[232:235], a[132:135]
  v_mfma_f32_16x16x32_bf16 a[132:135], a[172:175], a[228:231], a[132:135]
  s_add_u32 m0, s29, 2048
  s_nop 0
  buffer_load_dwordx4 v2, s[8:11], s23 offen offset:0 lds
  v_mfma_f32_16x16x32_bf16 a[136:139], a[180:183], a[228:231], a[136:139]
  v_mfma_f32_16x16x32_bf16 a[136:139], a[184:187], a[232:235], a[136:139]
  s_waitcnt lgkmcnt(4)
  v_mfma_f32_16x16x32_bf16 a[32:35], a[140:143], a[188:191], a[32:35]
  ds_read_b128 a[212:215], v10 offset:24576
  ds_read_b128 a[216:219], v11 offset:24576
  v_mfma_f32_16x16x32_bf16 a[32:35], a[144:147], a[192:195], a[32:35]
  buffer_load_dwordx4 v3, s[8:11], s23 offen offset:1024 lds
  v_mfma_f32_16x16x32_bf16 a[36:39], a[152:155], a[192:195], a[36:39]
  ds_read_b64_tr_b16 a[164:165], v14 offset:28672
  ds_read_b64_tr_b16 a[166:167], v14 offset:30208
  v_mfma_f32_16x16x32_bf16 a[36:39], a[148:151], a[188:191], a[36:39]
  v_mfma_f32_16x16x32_bf16 a[40:43], a[156:159], a[188:191], a[40:43]
  buffer_load_dwordx4 v4, s[8:11], s23 offen offset:2048 lds
  v_mfma_f32_16x16x32_bf16 a[40:43], a[160:163], a[192:195], a[40:43]
  s_waitcnt lgkmcnt(6)
  v_mfma_f32_16x16x32_bf16 a[44:47], a[144:147], a[200:203], a[44:47]
  ds_read_b128 a[220:223], v10 offset:26624
  ds_read_b128 a[224:227], v11 offset:26624
  v_mfma_f32_16x16x32_bf16 a[44:47], a[140:143], a[196:199], a[44:47]
  buffer_load_dwordx4 v5, s[8:11], s23 offen offset:3072 lds
  v_mfma_f32_16x16x32_bf16 a[48:51], a[148:151], a[196:199], a[48:51]
  ds_read_b64_tr_b16 a[172:173], v15 offset:28672
  ds_read_b64_tr_b16 a[174:175], v15 offset:30208
  v_mfma_f32_16x16x32_bf16 a[48:51], a[152:155], a[200:203], a[48:51]
  v_mfma_f32_16x16x32_bf16 a[52:55], a[160:163], a[200:203], a[52:55]
  v_mfma_f32_16x16x32_bf16 a[52:55], a[156:159], a[196:199], a[52:55]
  s_sub_u32 s31, s31, 1
  s_cmp_eq_u32 s31, 0
  s_cselect_b32 s58, -1920, s57
  s_add_u32 s23, s23, s58
  s_add_u32 s24, s24, s58
  s_waitcnt lgkmcnt(8)
  v_mfma_f32_16x16x32_bf16 a[56:59], a[140:143], a[204:207], a[56:59]
  ds_read_b128 a[228:231], v10 offset:28672
  ds_read_b128 a[232:235], v11 offset:28672
  v_mfma_f32_16x16x32_bf16 a[56:59], a[144:147], a[208:211], a[56:59]
  v_mfma_f32_16x16x32_bf16 a[60:63], a[152:155], a[208:211], a[60:63]
  ds_read_b64_tr_b16 a[180:181], v16 offset:28672
  ds_read_b64_tr_b16 a[182:183], v16 offset:30208
  v_mfma_f32_16x16x32_bf16 a[60:63], a[148:151], a[204:207], a[60:63]
  s_add_u32 m0, s30, 36864
  s_nop 0
  buffer_load_dwordx4 v6, s[12:15], s25 offen offset:0 lds
  v_mfma_f32_16x16x32_bf16 a[64:67], a[156:159], a[204:207], a[64:67]
  v_mfma_f32_16x16x32_bf16 a[64:67], a[160:163], a[208:211], a[64:67]
  s_waitcnt lgkmcnt(10)
  v_mfma_f32_16x16x32_bf16 a[68:71], a[144:147], a[216:219], a[68:71]
  ds_read_b128 a[188:191], v10 offset:30720
  ds_read_b128 a[192:195], v11 offset:30720
  v_mfma_f32_16x16x32_bf16 a[68:71], a[140:143], a[212:215], a[68:71]
  buffer_load_dwordx4 v7, s[12:15], s25 offen offset:1024 lds
  v_mfma_f32_16x16x32_bf16 a[72:75], a[148:151], a[212:215], a[72:75]
  ds_read_b64_tr_b16 a[168:169], v14 offset:40960
  ds_read_b64_tr_b16 a[170:171], v14 offset:42496
  v_mfma_f32_16x16x32_bf16 a[72:75], a[152:155], a[216:219], a[72:75]
  v_mfma_f32_16x16x32_bf16 a[76:79], a[160:163], a[216:219], a[76:79]
  buffer_load_dwordx4 v8, s[12:15], s25 offen offset:2048 lds
  v_mfma_f32_16x16x32_bf16 a[76:79], a[156:159], a[212:215], a[76:79]
  s_waitcnt lgkmcnt(10)
  v_mfma_f32_16x16x32_bf16 a[80:83], a[140:143], a[220:223], a[80:83]
  ds_read_b128 a[196:199], v10 offset:32768
  ds_read_b128 a[200:203], v11 offset:32768
  v_mfma_f32_16x16x32_bf16 a[80:83], a[144:147], a[224:227], a[80:83]
  v_mfma_f32_16x16x32_bf16 a[84:87], a[152:155], a[224:227], a[84:87]
  ds_read_b64_tr_b16 a[176:177], v15 offset:40960
  ds_read_b64_tr_b16 a[178:179], v15 offset:42496
  v_mfma_f32_16x16x32_bf16 a[84:87], a[148:151], a[220:223], a[84:87]
  buffer_load_dwordx4 v9, s[12:15], s25 offen offset:3072 lds
  v_mfma_f32_16x16x32_bf16 a[88:91], a[156:159], a[220:223], a[88:91]
  v_mfma_f32_16x16x32_bf16 a[88:91], a[160:163], a[224:227], a[88:91]
  s_add_u32 m0, s30, 40960
  s_nop 0
  buffer_load_dwordx4 v21, s[12:15], s25 offen offset:0 lds
  s_waitcnt lgkmcnt(10)
  v_mfma_f32_16x16x32_bf16 a[92:95], a[144:147], a[232:235], a[92:95]
  ds_read_b128 a[204:207], v10 offset:34816
  ds_read_b128 a[208:211], v11 offset:34816
  v_mfma_f32_16x16x32_bf16 a[92:95], a[140:143], a[228:231], a[92:95]
  v_mfma_f32_16x16x32_bf16 a[96:99], a[148:151], a[228:231], a[96:99]
  ds_read_b64_tr_b16 a[184:185], v16 offset:40960
  ds_read_b64_tr_b16 a[186:187], v16 offset:42496
  v_mfma_f32_16x16x32_bf16 a[96:99], a[152:155], a[232:235], a[96:99]
  v_mfma_f32_16x16x32_bf16 a[100:103], a[160:163], a[232:235], a[100:103]
  buffer_load_dwordx4 v22, s[12:15], s25 offen offset:1024 lds
  v_mfma_f32_16x16x32_bf16 a[100:103], a[156:159], a[228:231], a[100:103]
  s_waitcnt lgkmcnt(10)
  v_mfma_f32_16x16x32_bf16 a[104:107], a[140:143], a[188:191], a[104:107]
  s_sub_u32 s54, s54, 1
  s_cmp_eq_u32 s54, 0
  s_cselect_b32 s58, s55, s56
  s_add_u32 s25, s25, s58
  v_mfma_f32_16x16x32_bf16 a[104:107], a[144:147], a[192:195], a[104:107]
  v_mfma_f32_16x16x32_bf16 a[108:111], a[152:155], a[192:195], a[108:111]
  v_mfma_f32_16x16x32_bf16 a[108:111], a[148:151], a[188:191], a[108:111]
  v_mfma_f32_16x16x32_bf16 a[112:115], a[156:159], a[188:191], a[112:115]
  s_waitcnt vmcnt(13) lgkmcnt(0)
  s_barrier
  ds_read_b128 a[212:215], v12 offset:0
  ds_read_b128 a[216:219], v13 offset:0
  v_mfma_f32_16x16x32_bf16 a[112:115], a[160:163], a[192:195], a[112:115]
  s_add_u32 s94, s92, 4096
  buffer_store_dwordx4 v[64:67], v1, s[16:19], s94 offen offset:0
  v_mfma_f32_16x16x32_bf16 a[116:119], a[144:147], a[200:203], a[116:119]
  ds_read_b128 a[220:223], v12 offset:2048
  ds_read_b128 a[224:227], v13 offset:2048
  v_mfma_f32_16x16x32_bf16 a[116:119], a[140:143], a[196:199], a[116:119]
  v_mfma_f32_16x16x32_bf16 a[120:123], a[148:151], a[196:199], a[120:123]
  s_add_u32 s94, s92, 4096
  buffer_store_dwordx4 v[72:75], v1, s[16:19], s94 offen offset:1024
  v_mfma_f32_16x16x32_bf16 a[120:123], a[152:155], a[200:203], a[120:123]
  v_mfma_f32_16x16x32_bf16 a[124:127], a[160:163], a[200:203], a[124:127]
  v_mfma_f32_16x16x32_bf16 a[124:127], a[156:159], a[196:199], a[124:127]
  s_add_u32 m0, s28, 18432
  s_mov_b32 exec_hi, 0
  buffer_load_dwordx4 v20, s[8:11], s24 offen lds
  s_mov_b32 exec_hi, -1
  v_mfma_f32_16x16x32_bf16 a[128:131], a[140:143], a[204:207], a[128:131]
  ds_read_b128 a[228:231], v12 offset:4096
  ds_read_b128 a[232:235], v13 offset:4096
  v_mfma_f32_16x16x32_bf16 a[128:131], a[144:147], a[208:211], a[128:131]
  v_mfma_f32_16x16x32_bf16 a[132:135], a[152:155], a[208:211], a[132:135]
  v_mfma_f32_16x16x32_bf16 a[132:135], a[148:151], a[204:207], a[132:135]
  s_add_u32 m0, s29, 20480
  s_nop 0
  buffer_load_dwordx4 v2, s[8:11], s23 offen offset:0 lds
  v_mfma_f32_16x16x32_bf16 a[136:139], a[156:159], a[204:207], a[136:139]
  v_mfma_f32_16x16x32_bf16 a[136:139], a[160:163], a[208:211], a[136:139]
  s_waitcnt lgkmcnt(4)
  v_mfma_f32_16x16x32_bf16 a[32:35], a[164:167], a[212:215], a[32:35]
  ds_read_b128 a[188:191], v12 offset:6144
  ds_read_b128 a[192:195], v13 offset:6144
  v_mfma_f32_16x16x32_bf16 a[32:35], a[168:171], a[216:219], a[32:35]
  buffer_load_dwordx4 v3, s[8:11], s23 offen offset:1024 lds
  v_mfma_f32_16x16x32_bf16 a[36:39], a[176:179], a[216:219], a[36:39]
  ds_read_b64_tr_b16 a[140:141], v17 offset:0
  ds_read_b64_tr_b16 a[142:143], v17 offset:1536
  v_mfma_f32_16x16x32_bf16 a[36:39], a[172:175], a[212:215], a[36:39]
  v_mfma_f32_16x16x32_bf16 a[40:43], a[180:183], a[212:215], a[40:43]
  buffer_load_dwordx4 v4, s[8:11], s23 offen offset:2048 lds
  v_mfma_f32_16x16x32_bf16 a[40:43], a[184:187], a[216:219], a[40:43]
  s_waitcnt lgkmcnt(6)
  v_mfma_f32_16x16x32_bf16 a[44:47], a[168:171], a[224:227], a[44:47]
  ds_read_b128 a[196:199], v12 offset:8192
  ds_read_b128 a[200:203], v13 offset:8192
  v_mfma_f32_16x16x32_bf16 a[44:47], a[164:167], a[220:223], a[44:47]
  buffer_load_dwordx4 v5, s[8:11], s23 offen offset:3072 lds
  v_mfma_f32_16x16x32_bf16 a[48:51], a[172:175], a[220:223], a[48:51]
  ds_read_b64_tr_b16 a[148:149], v18 offset:0
  ds_read_b64_tr_b16 a[150:151], v18 offset:1536
  v_mfma_f32_16x16x32_bf16 a[48:51], a[176:179], a[224:227], a[48:51]
  v_mfma_f32_16x16x32_bf16 a[52:55], a[184:187], a[224:227], a[52:55]
  v_mfma_f32_16x16x32_bf16 a[52:55], a[180:183], a[220:223], a[52:55]
  s_sub_u32 s31, s31, 1
  s_cmp_eq_u32 s31, 0
  s_cselect_b32 s58, -1920, s57
  s_add_u32 s23, s23, s58
  s_add_u32 s24, s24, s58
  s_waitcnt lgkmcnt(8)
  v_mfma_f32_16x16x32_bf16 a[56:59], a[164:167], a[228:231], a[56:59]
  ds_read_b128 a[204:207], v12 offset:10240
  ds_read_b128 a[208:211], v13 offset:10240
  v_mfma_f32_16x16x32_bf16 a[56:59], a[168:171], a[232:235], a[56:59]
  v_mfma_f32_16x16x32_bf16 a[60:63], a[176:179], a[232:235], a[60:63]
  ds_read_b64_tr_b16 a[156:157], v19 offset:0
  ds_read_b64_tr_b16 a[158:159], v19 offset:1536
  v_mfma_f32_16x16x32_bf16 a[60:63], a[172:175], a[228:231], a[60:63]
  s_add_u32 m0, s30, 65536
  s_nop 0
  buffer_load_dwordx4 v6, s[12:15], s25 offen offset:0 lds
  v_mfma_f32_16x16x32_bf16 a[64:67], a[180:183], a[228:231], a[64:67]
  v_mfma_f32_16x16x32_bf16 a[64:67], a[184:187], a[232:235], a[64:67]
  s_waitcnt lgkmcnt(10)
  v_mfma_f32_16x16x32_bf16 a[68:71], a[168:171], a[192:195], a[68:71]
  ds_read_b128 a[212:215], v12 offset:12288
  ds_read_b128 a[216:219], v13 offset:12288
  v_mfma_f32_16x16x32_bf16 a[68:71], a[164:167], a[188:191], a[68:71]
  buffer_load_dwordx4 v7, s[12:15], s25 offen offset:1024 lds
  v_mfma_f32_16x16x32_bf16 a[72:75], a[172:175], a[188:191], a[72:75]
  ds_read_b64_tr_b16 a[144:145], v17 offset:12288
  ds_read_b64_tr_b16 a[146:147], v17 offset:13824
  v_mfma_f32_16x16x32_bf16 a[72:75], a[176:179], a[192:195], a[72:75]
  v_mfma_f32_16x16x32_bf16 a[76:79], a[184:187], a[192:195], a[76:79]
  buffer_load_dwordx4 v8, s[12:15], s25 offen offset:2048 lds
  v_mfma_f32_16x16x32_bf16 a[76:79], a[180:183], a[188:191], a[76:79]
  s_waitcnt lgkmcnt(10)
  v_mfma_f32_16x16x32_bf16 a[80:83], a[164:167], a[196:199], a[80:83]
  ds_read_b128 a[220:223], v12 offset:14336
  ds_read_b128 a[224:227], v13 offset:14336
  v_mfma_f32_16x16x32_bf16 a[80:83], a[168:171], a[200:203], a[80:83]
  v_mfma_f32_16x16x32_bf16 a[84:87], a[176:179], a[200:203], a[84:87]
  ds_read_b64_tr_b16 a[152:153], v18 offset:12288
  ds_read_b64_tr_b16 a[154:155], v18 offset:13824
  v_mfma_f32_16x16x32_bf16 a[84:87], a[172:175], a[196:199], a[84:87]
  buffer_load_dwordx4 v9, s[12:15], s25 offen offset:3072 lds
  v_mfma_f32_16x16x32_bf16 a[88:91], a[180:183], a[196:199], a[88:91]
  v_mfma_f32_16x16x32_bf16 a[88:91], a[184:187], a[200:203], a[88:91]
  s_add_u32 m0, s30, 69632
  s_nop 0
  buffer_load_dwordx4 v21, s[12:15], s25 offen offset:0 lds
  s_waitcnt lgkmcnt(10)
  v_mfma_f32_16x16x32_bf16 a[92:95], a[168:171], a[208:211], a[92:95]
  ds_read_b128 a[228:231], v12 offset:16384
  ds_read_b128 a[232:235], v13 offset:16384
  v_mfma_f32_16x16x32_bf16 a[92:95], a[164:167], a[204:207], a[92:95]
  v_mfma_f32_16x16x32_bf16 a[96:99], a[172:175], a[204:207], a[96:99]
  ds_read_b64_tr_b16 a[160:161], v19 offset:12288
  ds_read_b64_tr_b16 a[162:163], v19 offset:13824
  v_mfma_f32_16x16x32_bf16 a[96:99], a[176:179], a[208:211], a[96:99]
  v_mfma_f32_16x16x32_bf16 a[100:103], a[184:187], a[208:211], a[100:103]
  buffer_load_dwordx4 v22, s[12:15], s25 offen offset:1024 lds
  v_mfma_f32_16x16x32_bf16 a[100:103], a[180:183], a[204:207], a[100:103]
  s_waitcnt lgkmcnt(10)
  v_mfma_f32_16x16x32_bf16 a[104:107], a[164:167], a[212:215], a[104:107]
  s_sub_u32 s54, s54, 1
  s_cmp_eq_u32 s54, 0
  s_cselect_b32 s58, s55, s56
  s_add_u32 s25, s25, s58
  v_mfma_f32_16x16x32_bf16 a[104:107], a[168:171], a[216:219], a[104:107]
  v_mfma_f32_16x16x32_bf16 a[108:111], a[176:179], a[216:219], a[108:111]
  v_mfma_f32_16x16x32_bf16 a[108:111], a[172:175], a[212:215], a[108:111]
  v_mfma_f32_16x16x32_bf16 a[112:115], a[180:183], a[212:215], a[112:115]
  s_waitcnt vmcnt(13) lgkmcnt(0)
  s_barrier
  ds_read_b128 a[188:191], v10 offset:0
  ds_read_b128 a[192:195], v11 offset:0
  v_mfma_f32_16x16x32_bf16 a[112:115], a[184:187], a[216:219], a[112:115]
  s_add_u32 s94, s92, 4096
  buffer_store_dwordx4 v[80:83], v1, s[16:19], s94 offen offset:2048
  v_mfma_f32_16x16x32_bf16 a[116:119], a[168:171], a[224:227], a[116:119]
  ds_read_b128 a[196:199], v10 offset:2048
  ds_read_b128 a[200:203], v11 offset:2048
  v_mfma_f32_16x16x32_bf16 a[116:119], a[164:167], a[220:223], a[116:119]
  v_mfma_f32_16x16x32_bf16 a[120:123], a[172:175], a[220:223], a[120:123]
  s_add_u32 s94, s92, 4096
  buffer_store_dwordx4 v[88:91], v1, s[16:19], s94 offen offset:3072
  v_mfma_f32_16x16x32_bf16 a[120:123], a[176:179], a[224:227], a[120:123]
  v_mfma_f32_16x16x32_bf16 a[124:127], a[184:187], a[224:227], a[124:127]
  v_mfma_f32_16x16x32_bf16 a[124:127], a[180:183], a[220:223], a[124:127]
  s_add_u32 m0, s28, 131072
  s_mov_b32 exec_hi, 0
  buffer_load_dwordx4 v20, s[8:11], s24 offen lds
  s_mov_b32 exec_hi, -1
  v_mfma_f32_16x16x32_bf16 a[128:131], a[164:167], a[228:231], a[128:131]
  ds_read_b128 a[204:207], v10 offset:4096
  ds_read_b128 a[208:211], v11 offset:4096
  v_mfma_f32_16x16x32_bf16 a[128:131], a[168:171], a[232:235], a[128:131]
  v_mfma_f32_16x16x32_bf16 a[132:135], a[176:179], a[232:235], a[132:135]
  v_mfma_f32_16x16x32_bf16 a[132:135], a[172:175], a[228:231], a[132:135]
  s_add_u32 m0, s29, 133120
  s_nop 0
  buffer_load_dwordx4 v2, s[8:11], s23 offen offset:0 lds
  v_mfma_f32_16x16x32_bf16 a[136:139], a[180:183], a[228:231], a[136:139]
  v_mfma_f32_16x16x32_bf16 a[136:139], a[184:187], a[232:235], a[136:139]
  s_waitcnt lgkmcnt(4)
  v_mfma_f32_16x16x32_bf16 a[32:35], a[140:143], a[188:191], a[32:35]
  ds_read_b128 a[212:215], v10 offset:6144
  ds_read_b128 a[216:219], v11 offset:6144
  v_mfma_f32_16x16x32_bf16 a[32:35], a[144:147], a[192:195], a[32:35]
  buffer_load_dwordx4 v3, s[8:11], s23 offen offset:1024 lds
  v_mfma_f32_16x16x32_bf16 a[36:39], a[152:155], a[192:195], a[36:39]
  ds_read_b64_tr_b16 a[164:165], v14 offset:0
  ds_read_b64_tr_b16 a[166:167], v14 offset:1536
  v_mfma_f32_16x16x32_bf16 a[36:39], a[148:151], a[188:191], a[36:39]
  v_mfma_f32_16x16x32_bf16 a[40:43], a[156:159], a[188:191], a[40:43]
  buffer_load_dwordx4 v4, s[8:11], s23 offen offset:2048 lds
  v_mfma_f32_16x16x32_bf16 a[40:43], a[160:163], a[192:195], a[40:43]
  s_waitcnt lgkmcnt(6)
  v_mfma_f32_16x16x32_bf16 a[44:47], a[144:147], a[200:203], a[44:47]
  ds_read_b128 a[220:223], v10 offset:8192
  ds_read_b128 a[224:227], v11 offset:8192
  v_mfma_f32_16x16x32_bf16 a[44:47], a[140:143], a[196:199], a[44:47]
  buffer_load_dwordx4 v5, s[8:11], s23 offen offset:3072 lds
  v_mfma_f32_16x16x32_bf16 a[48:51], a[148:151], a[196:199], a[48:51]
  ds_read_b64_tr_b16 a[172:173], v15 offset:0
  ds_read_b64_tr_b16 a[174:175], v15 offset:1536
  v_mfma_f32_16x16x32_bf16 a[48:51], a[152:155], a[200:203], a[48:51]
  v_mfma_f32_16x16x32_bf16 a[52:55], a[160:163], a[200:203], a[52:55]
  v_mfma_f32_16x16x32_bf16 a[52:55], a[156:159], a[196:199], a[52:55]
  s_sub_u32 s31, s31, 1
  s_cmp_eq_u32 s31, 0
  s_cselect_b32 s58, -1920, s57
  s_add_u32 s23, s23, s58
  s_add_u32 s24, s24, s58
  s_waitcnt lgkmcnt(8)
  v_mfma_f32_16x16x32_bf16 a[56:59], a[140:143], a[204:207], a[56:59]
  ds_read_b128 a[228:231], v10 offset:10240
  ds_read_b128 a[232:235], v11 offset:10240
  v_mfma_f32_16x16x32_bf16 a[56:59], a[144:147], a[208:211], a[56:59]
  v_mfma_f32_16x16x32_bf16 a[60:63], a[152:155], a[208:211], a[60:63]
  ds_read_b64_tr_b16 a[180:181], v16 offset:0
  ds_read_b64_tr_b16 a[182:183], v16 offset:1536
  v_mfma_f32_16x16x32_bf16 a[60:63], a[148:151], a[204:207], a[60:63]
  s_add_u32 m0, s30, 98304
  s_nop 0
  buffer_load_dwordx4 v6, s[12:15], s25 offen offset:0 lds
  v_mfma_f32_16x16x32_bf16 a[64:67], a[156:159], a[204:207], a[64:67]
  v_mfma_f32_16x16x32_bf16 a[64:67], a[160:163], a[208:211], a[64:67]
  s_waitcnt lgkmcnt(10)
  v_mfma_f32_16x16x32_bf16 a[68:71], a[144:147], a[216:219], a[68:71]
  ds_read_b128 a[188:191], v10 offset:12288
  ds_read_b128 a[192:195], v11 offset:12288
  v_mfma_f32_16x16x32_bf16 a[68:71], a[140:143], a[212:215], a[68:71]
  buffer_load_dwordx4 v7, s[12:15], s25 offen offset:1024 lds
  v_mfma_f32_16x16x32_bf16 a[72:75], a[148:151], a[212:215], a[72:75]
  ds_read_b64_tr_b16 a[168:169], v14 offset:12288
  ds_read_b64_tr_b16 a[170:171], v14 offset:13824
  v_mfma_f32_16x16x32_bf16 a[72:75], a[152:155], a[216:219], a[72:75]
  v_mfma_f32_16x16x32_bf16 a[76:79], a[160:163], a[216:219], a[76:79]
  buffer_load_dwordx4 v8, s[12:15], s25 offen offset:2048 lds
  v_mfma_f32_16x16x32_bf16 a[76:79], a[156:159], a[212:215], a[76:79]
  s_waitcnt lgkmcnt(10)
  v_mfma_f32_16x16x32_bf16 a[80:83], a[140:143], a[220:223], a[80:83]
  ds_read_b128 a[196:199], v10 offset:14336
  ds_read_b128 a[200:203], v11 offset:14336
  v_mfma_f32_16x16x32_bf16 a[80:83], a[144:147], a[224:227], a[80:83]
  v_mfma_f32_16x16x32_bf16 a[84:87], a[152:155], a[224:227], a[84:87]
  ds_read_b64_tr_b16 a[176:177], v15 offset:12288
  ds_read_b64_tr_b16 a[178:179], v15 offset:13824
  v_mfma_f32_16x16x32_bf16 a[84:87], a[148:151], a[220:223], a[84:87]
  buffer_load_dwordx4 v9, s[12:15], s25 offen offset:3072 lds
  v_mfma_f32_16x16x32_bf16 a[88:91], a[156:159], a[220:223], a[88:91]
  v_mfma_f32_16x16x32_bf16 a[88:91], a[160:163], a[224:227], a[88:91]
  s_add_u32 m0, s30, 102400
  s_nop 0
  buffer_load_dwordx4 v21, s[12:15], s25 offen offset:0 lds
  s_waitcnt lgkmcnt(10)
  v_mfma_f32_16x16x32_bf16 a[92:95], a[144:147], a[232:235], a[92:95]
  ds_read_b128 a[204:207], v10 offset:16384
  ds_read_b128 a[208:211], v11 offset:16384
  v_mfma_f32_16x16x32_bf16 a[92:95], a[140:143], a[228:231], a[92:95]
  v_mfma_f32_16x16x32_bf16 a[96:99], a[148:151], a[228:231], a[96:99]
  ds_read_b64_tr_b16 a[184:185], v16 offset:12288
  ds_read_b64_tr_b16 a[186:187], v16 offset:13824
  v_mfma_f32_16x16x32_bf16 a[96:99], a[152:155], a[232:235], a[96:99]
  v_mfma_f32_16x16x32_bf16 a[100:103], a[160:163], a[232:235], a[100:103]
  buffer_load_dwordx4 v22, s[12:15], s25 offen offset:1024 lds
  v_mfma_f32_16x16x32_bf16 a[100:103], a[156:159], a[228:231], a[100:103]
  s_waitcnt lgkmcnt(10)
  v_mfma_f32_16x16x32_bf16 a[104:107], a[140:143], a[188:191], a[104:107]
  s_sub_u32 s54, s54, 1
  s_cmp_eq_u32 s54, 0
  s_cselect_b32 s58, s55, s56
  s_add_u32 s25, s25, s58
  v_mfma_f32_16x16x32_bf16 a[104:107], a[144:147], a[192:195], a[104:107]
  v_mfma_f32_16x16x32_bf16 a[108:111], a[152:155], a[192:195], a[108:111]
  v_mfma_f32_16x16x32_bf16 a[108:111], a[148:151], a[188:191], a[108:111]
  v_mfma_f32_16x16x32_bf16 a[112:115], a[156:159], a[188:191], a[112:115]
  s_waitcnt vmcnt(13) lgkmcnt(0)
  s_barrier
  ds_read_b128 a[212:215], v10 offset:18432
  ds_read_b128 a[216:219], v11 offset:18432
  v_mfma_f32_16x16x32_bf16 a[112:115], a[160:163], a[192:195], a[112:115]
  s_add_u32 s94, s92, 8192
  buffer_store_dwordx4 v[96:99], v1, s[16:19], s94 offen offset:0
  v_mfma_f32_16x16x32_bf16 a[116:119], a[144:147], a[200:203], a[116:119]
  ds_read_b128 a[220:223], v10 offset:20480
  ds_read_b128 a[224:227], v11 offset:20480
  v_mfma_f32_16x16x32_bf16 a[116:119], a[140:143], a[196:199], a[116:119]
  v_mfma_f32_16x16x32_bf16 a[120:123], a[148:151], a[196:199], a[120:123]
  s_add_u32 s94, s92, 8192
  buffer_store_dwordx4 v[104:107], v1, s[16:19], s94 offen offset:1024
  v_mfma_f32_16x16x32_bf16 a[120:123], a[152:155], a[200:203], a[120:123]
  v_mfma_f32_16x16x32_bf16 a[124:127], a[160:163], a[200:203], a[124:127]
  v_mfma_f32_16x16x32_bf16 a[124:127], a[156:159], a[196:199], a[124:127]
  s_add_u32 m0, s28, 0
  s_mov_b32 exec_hi, 0
  buffer_load_dwordx4 v20, s[8:11], s24 offen lds
  s_mov_b32 exec_hi, -1
  v_mfma_f32_16x16x32_bf16 a[128:131], a[140:143], a[204:207], a[128:131]
  ds_read_b128 a[228:231], v10 offset:22528
  ds_read_b128 a[232:235], v11 offset:22528
  v_mfma_f32_16x16x32_bf16 a[128:131], a[144:147], a[208:211], a[128:131]
  v_mfma_f32_16x16x32_bf16 a[132:135], a[152:155], a[208:211], a[132:135]
  v_mfma_f32_16x16x32_bf16 a[132:135], a[148:151], a[204:207], a[132:135]
  s_add_u32 m0, s29, 2048
  s_nop 0
  buffer_load_dwordx4 v2, s[8:11], s23 offen offset:0 lds
  v_mfma_f32_16x16x32_bf16 a[136:139], a[156:159], a[204:207], a[136:139]
  v_mfma_f32_16x16x32_bf16 a[136:139], a[160:163], a[208:211], a[136:139]
  s_waitcnt lgkmcnt(4)
  v_mfma_f32_16x16x32_bf16 a[32:35], a[164:167], a[212:215], a[32:35]
  ds_read_b128 a[188:191], v10 offset:24576
  ds_read_b128 a[192:195], v11 offset:24576
  v_mfma_f32_16x16x32_bf16 a[32:35], a[168:171], a[216:219], a[32:35]
  buffer_load_dwordx4 v3, s[8:11], s23 offen offset:1024 lds
  v_mfma_f32_16x16x32_bf16 a[36:39], a[176:179], a[216:219], a[36:39]
  ds_read_b64_tr_b16 a[140:141], v14 offset:28672
  ds_read_b64_tr_b16 a[142:143], v14 offset:30208
  v_mfma_f32_16x16x32_bf16 a[36:39], a[172:175], a[212:215], a[36:39]
  v_mfma_f32_16x16x32_bf16 a[40:43], a[180:183], a[212:215], a[40:43]
  buffer_load_dwordx4 v4, s[8:11], s23 offen offset:2048 lds
  v_mfma_f32_16x16x32_bf16 a[40:43], a[184:187], a[216:219], a[40:43]
  s_waitcnt lgkmcnt(6)
  v_mfma_f32_16x16x32_bf16 a[44:47], a[168:171], a[224:227], a[44:47]
  ds_read_b128 a[196:199], v10 offset:26624
  ds_read_b128 a[200:203], v11 offset:26624
  v_mfma_f32_16x16x32_bf16 a[44:47], a[164:167], a[220:223], a[44:47]
  buffer_load_dwordx4 v5, s[8:11], s23 offen offset:3072 lds
  v_mfma_f32_16x16x32_bf16 a[48:51], a[172:175], a[220:223], a[48:51]
  ds_read_b64_tr_b16 a[148:149], v15 offset:28672
  ds_read_b64_tr_b16 a[150:151], v15 offset:30208
  v_mfma_f32_16x16x32_bf16 a[48:51], a[176:179], a[224:227], a[48:51]
  v_mfma_f32_16x16x32_bf16 a[52:55], a[184:187], a[224:227], a[52:55]
  v_mfma_f32_16x16x32_bf16 a[52:55], a[180:183], a[220:223], a[52:55]
  s_sub_u32 s31, s31, 1
  s_cmp_eq_u32 s31, 0
  s_cselect_b32 s58, -1920, s57
  s_add_u32 s23, s23, s58
  s_add_u32 s24, s24, s58
  s_waitcnt lgkmcnt(8)
  v_mfma_f32_16x16x32_bf16 a[56:59], a[164:167], a[228:231], a[56:59]
  ds_read_b128 a[204:207], v10 offset:28672
  ds_read_b128 a[208:211], v11 offset:28672
  v_mfma_f32_16x16x32_bf16 a[56:59], a[168:171], a[232:235], a[56:59]
  v_mfma_f32_16x16x32_bf16 a[60:63], a[176:179], a[232:235], a[60:63]
  ds_read_b64_tr_b16 a[156:157], v16 offset:28672
  ds_read_b64_tr_b16 a[158:159], v16 offset:30208
  v_mfma_f32_16x16x32_bf16 a[60:63], a[172:175], a[228:231], a[60:63]
  s_add_u32 m0, s30, 36864
  s_nop 0
  buffer_load_dwordx4 v6, s[12:15], s25 offen offset:0 lds
  v_mfma_f32_16x16x32_bf16 a[64:67], a[180:183], a[228:231], a[64:67]
  v_mfma_f32_16x16x32_bf16 a[64:67], a[184:187], a[232:235], a[64:67]
  s_waitcnt lgkmcnt(10)
  v_mfma_f32_16x16x32_bf16 a[68:71], a[168:171], a[192:195], a[68:71]
  ds_read_b128 a[212:215], v10 offset:30720
  ds_read_b128 a[216:219], v11 offset:30720
  v_mfma_f32_16x16x32_bf16 a[68:71], a[164:167], a[188:191], a[68:71]
  buffer_load_dwordx4 v7, s[12:15], s25 offen offset:1024 lds
  v_mfma_f32_16x16x32_bf16 a[72:75], a[172:175], a[188:191], a[72:75]
  ds_read_b64_tr_b16 a[144:145], v14 offset:40960
  ds_read_b64_tr_b16 a[146:147], v14 offset:42496
  v_mfma_f32_16x16x32_bf16 a[72:75], a[176:179], a[192:195], a[72:75]
  v_mfma_f32_16x16x32_bf16 a[76:79], a[184:187], a[192:195], a[76:79]
  buffer_load_dwordx4 v8, s[12:15], s25 offen offset:2048 lds
  v_mfma_f32_16x16x32_bf16 a[76:79], a[180:183], a[188:191], a[76:79]
  s_waitcnt lgkmcnt(10)
  v_mfma_f32_16x16x32_bf16 a[80:83], a[164:167], a[196:199], a[80:83]
  ds_read_b128 a[220:223], v10 offset:32768
  ds_read_b128 a[224:227], v11 offset:32768
  v_mfma_f32_16x16x32_bf16 a[80:83], a[168:171], a[200:203], a[80:83]
  v_mfma_f32_16x16x32_bf16 a[84:87], a[176:179], a[200:203], a[84:87]
  ds_read_b64_tr_b16 a[152:153], v15 offset:40960
  ds_read_b64_tr_b16 a[154:155], v15 offset:42496
  v_mfma_f32_16x16x32_bf16 a[84:87], a[172:175], a[196:199], a[84:87]
  buffer_load_dwordx4 v9, s[12:15], s25 offen offset:3072 lds
  v_mfma_f32_16x16x32_bf16 a[88:91], a[180:183], a[196:199], a[88:91]
  v_mfma_f32_16x16x32_bf16 a[88:91], a[184:187], a[200:203], a[88:91]
  s_add_u32 m0, s30, 40960
  s_nop 0
  buffer_load_dwordx4 v21, s[12:15], s25 offen offset:0 lds
  s_waitcnt lgkmcnt(10)
  v_mfma_f32_16x16x32_bf16 a[92:95], a[168:171], a[208:211], a[92:95]
  ds_read_b128 a[228:231], v10 offset:34816
  ds_read_b128 a[232:235], v11 offset:34816
  v_mfma_f32_16x16x32_bf16 a[92:95], a[164:167], a[204:207], a[92:95]
  v_mfma_f32_16x16x32_bf16 a[96:99], a[172:175], a[204:207], a[96:99]
  ds_read_b64_tr_b16 a[160:161], v16 offset:40960
  ds_read_b64_tr_b16 a[162:163], v16 offset:42496
  v_mfma_f32_16x16x32_bf16 a[96:99], a[176:179], a[208:211], a[96:99]
  v_mfma_f32_16x16x32_bf16 a[100:103], a[184:187], a[208:211], a[100:103]
  buffer_load_dwordx4 v22, s[12:15], s25 offen offset:1024 lds
  v_mfma_f32_16x16x32_bf16 a[100:103], a[180:183], a[204:207], a[100:103]
  s_waitcnt lgkmcnt(10)
  v_mfma_f32_16x16x32_bf16 a[104:107], a[164:167], a[212:215], a[104:107]
  s_sub_u32 s54, s54, 1
  s_cmp_eq_u32 s54, 0
  s_cselect_b32 s58, s55, s56
  s_add_u32 s25, s25, s58
  v_mfma_f32_16x16x32_bf16 a[104:107], a[168:171], a[216:219], a[104:107]
  v_mfma_f32_16x16x32_bf16 a[108:111], a[176:179], a[216:219], a[108:111]
  v_mfma_f32_16x16x32_bf16 a[108:111], a[172:175], a[212:215], a[108:111]
  v_mfma_f32_16x16x32_bf16 a[112:115], a[180:183], a[212:215], a[112:115]
  s_waitcnt vmcnt(13) lgkmcnt(0)
  s_barrier
  ds_read_b128 a[188:191], v12 offset:0
  ds_read_b128 a[192:195], v13 offset:0
  v_mfma_f32_16x16x32_bf16 a[112:115], a[184:187], a[216:219], a[112:115]
  s_add_u32 s94, s92, 8192
  buffer_store_dwordx4 v[112:115], v1, s[16:19], s94 offen offset:2048
  v_mfma_f32_16x16x32_bf16 a[116:119], a[168:171], a[224:227], a[116:119]
  ds_read_b128 a[196:199], v12 offset:2048
  ds_read_b128 a[200:203], v13 offset:2048
  v_mfma_f32_16x16x32_bf16 a[116:119], a[164:167], a[220:223], a[116:119]
  v_mfma_f32_16x16x32_bf16 a[120:123], a[172:175], a[220:223], a[120:123]
  s_add_u32 s94, s92, 8192
  buffer_store_dwordx4 v[120:123], v1, s[16:19], s94 offen offset:3072
  v_mfma_f32_16x16x32_bf16 a[120:123], a[176:179], a[224:227], a[120:123]
  v_mfma_f32_16x16x32_bf16 a[124:127], a[184:187], a[224:227], a[124:127]
  v_mfma_f32_16x16x32_bf16 a[124:127], a[180:183], a[220:223], a[124:127]
  s_add_u32 m0, s28, 18432
  s_mov_b32 exec_hi, 0
  buffer_load_dwordx4 v20, s[8:11], s24 offen lds
  s_mov_b32 exec_hi, -1
  v_mfma_f32_16x16x32_bf16 a[128:131], a[164:167], a[228:231], a[128:131]
  ds_read_b128 a[204:207], v12 offset:4096
  ds_read_b128 a[208:211], v13 offset:4096
  v_mfma_f32_16x16x32_bf16 a[128:131], a[168:171], a[232:235], a[128:131]
  v_mfma_f32_16x16x32_bf16 a[132:135], a[176:179], a[232:235], a[132:135]
  v_mfma_f32_16x16x32_bf16 a[132:135], a[172:175], a[228:231], a[132:135]
  s_add_u32 m0, s29, 20480
  s_nop 0
  buffer_load_dwordx4 v2, s[8:11], s23 offen offset:0 lds
  v_mfma_f32_16x16x32_bf16 a[136:139], a[180:183], a[228:231], a[136:139]
  v_mfma_f32_16x16x32_bf16 a[136:139], a[184:187], a[232:235], a[136:139]
  s_waitcnt lgkmcnt(4)
  v_mfma_f32_16x16x32_bf16 a[32:35], a[140:143], a[188:191], a[32:35]
  ds_read_b128 a[212:215], v12 offset:6144
  ds_read_b128 a[216:219], v13 offset:6144
  v_mfma_f32_16x16x32_bf16 a[32:35], a[144:147], a[192:195], a[32:35]
  buffer_load_dwordx4 v3, s[8:11], s23 offen offset:1024 lds
  v_mfma_f32_16x16x32_bf16 a[36:39], a[152:155], a[192:195], a[36:39]
  ds_read_b64_tr_b16 a[164:165], v17 offset:0
  ds_read_b64_tr_b16 a[166:167], v17 offset:1536
  v_mfma_f32_16x16x32_bf16 a[36:39], a[148:151], a[188:191], a[36:39]
  v_mfma_f32_16x16x32_bf16 a[40:43], a[156:159], a[188:191], a[40:43]
  buffer_load_dwordx4 v4, s[8:11], s23 offen offset:2048 lds
  v_mfma_f32_16x16x32_bf16 a[40:43], a[160:163], a[192:195], a[40:43]
  s_waitcnt lgkmcnt(6)
  v_mfma_f32_16x16x32_bf16 a[44:47], a[144:147], a[200:203], a[44:47]
  ds_read_b128 a[220:223], v12 offset:8192
  ds_read_b128 a[224:227], v13 offset:8192
  v_mfma_f32_16x16x32_bf16 a[44:47], a[140:143], a[196:199], a[44:47]
  buffer_load_dwordx4 v5, s[8:11], s23 offen offset:3072 lds
  v_mfma_f32_16x16x32_bf16 a[48:51], a[148:151], a[196:199], a[48:51]
  ds_read_b64_tr_b16 a[172:173], v18 offset:0
  ds_read_b64_tr_b16 a[174:175], v18 offset:1536
  v_mfma_f32_16x16x32_bf16 a[48:51], a[152:155], a[200:203], a[48:51]
  v_mfma_f32_16x16x32_bf16 a[52:55], a[160:163], a[200:203], a[52:55]
  v_mfma_f32_16x16x32_bf16 a[52:55], a[156:159], a[196:199], a[52:55]
  s_sub_u32 s31, s31, 1
  s_cmp_eq_u32 s31, 0
  s_cselect_b32 s58, -1920, s57
  s_add_u32 s23, s23, s58
  s_add_u32 s24, s24, s58
  s_waitcnt lgkmcnt(8)
  v_mfma_f32_16x16x32_bf16 a[56:59], a[140:143], a[204:207], a[56:59]
  ds_read_b128 a[228:231], v12 offset:10240
  ds_read_b128 a[232:235], v13 offset:10240
  v_mfma_f32_16x16x32_bf16 a[56:59], a[144:147], a[208:211], a[56:59]
  v_mfma_f32_16x16x32_bf16 a[60:63], a[152:155], a[208:211], a[60:63]
  ds_read_b64_tr_b16 a[180:181], v19 offset:0
  ds_read_b64_tr_b16 a[182:183], v19 offset:1536
  v_mfma_f32_16x16x32_bf16 a[60:63], a[148:151], a[204:207], a[60:63]
  s_add_u32 m0, s30, 65536
  s_nop 0
  buffer_load_dwordx4 v6, s[12:15], s25 offen offset:0 lds
  v_mfma_f32_16x16x32_bf16 a[64:67], a[156:159], a[204:207], a[64:67]
  v_mfma_f32_16x16x32_bf16 a[64:67], a[160:163], a[208:211], a[64:67]
  s_waitcnt lgkmcnt(10)
  v_mfma_f32_16x16x32_bf16 a[68:71], a[144:147], a[216:219], a[68:71]
  ds_read_b128 a[188:191], v12 offset:12288
  ds_read_b128 a[192:195], v13 offset:12288
  v_mfma_f32_16x16x32_bf16 a[68:71], a[140:143], a[212:215], a[68:71]
  buffer_load_dwordx4 v7, s[12:15], s25 offen offset:1024 lds
  v_mfma_f32_16x16x32_bf16 a[72:75], a[148:151], a[212:215], a[72:75]
  ds_read_b64_tr_b16 a[168:169], v17 offset:12288
  ds_read_b64_tr_b16 a[170:171], v17 offset:13824
  v_mfma_f32_16x16x32_bf16 a[72:75], a[152:155], a[216:219], a[72:75]
  v_mfma_f32_16x16x32_bf16 a[76:79], a[160:163], a[216:219], a[76:79]
  buffer_load_dwordx4 v8, s[12:15], s25 offen offset:2048 lds
  v_mfma_f32_16x16x32_bf16 a[76:79], a[156:159], a[212:215], a[76:79]
  s_waitcnt lgkmcnt(10)
  v_mfma_f32_16x16x32_bf16 a[80:83], a[140:143], a[220:223], a[80:83]
  ds_read_b128 a[196:199], v12 offset:14336
  ds_read_b128 a[200:203], v13 offset:14336
  v_mfma_f32_16x16x32_bf16 a[80:83], a[144:147], a[224:227], a[80:83]
  v_mfma_f32_16x16x32_bf16 a[84:87], a[152:155], a[224:227], a[84:87]
  ds_read_b64_tr_b16 a[176:177], v18 offset:12288
  ds_read_b64_tr_b16 a[178:179], v18 offset:13824
  v_mfma_f32_16x16x32_bf16 a[84:87], a[148:151], a[220:223], a[84:87]
  buffer_load_dwordx4 v9, s[12:15], s25 offen offset:3072 lds
  v_mfma_f32_16x16x32_bf16 a[88:91], a[156:159], a[220:223], a[88:91]
  v_mfma_f32_16x16x32_bf16 a[88:91], a[160:163], a[224:227], a[88:91]
  s_add_u32 m0, s30, 69632
  s_nop 0
  buffer_load_dwordx4 v21, s[12:15], s25 offen offset:0 lds
  s_waitcnt lgkmcnt(10)
  v_mfma_f32_16x16x32_bf16 a[92:95], a[144:147], a[232:235], a[92:95]
  ds_read_b128 a[204:207], v12 offset:16384
  ds_read_b128 a[208:211], v13 offset:16384
  v_mfma_f32_16x16x32_bf16 a[92:95], a[140:143], a[228:231], a[92:95]
  v_mfma_f32_16x16x32_bf16 a[96:99], a[148:151], a[228:231], a[96:99]
  ds_read_b64_tr_b16 a[184:185], v19 offset:12288
  ds_read_b64_tr_b16 a[186:187], v19 offset:13824
  v_mfma_f32_16x16x32_bf16 a[96:99], a[152:155], a[232:235], a[96:99]
  v_mfma_f32_16x16x32_bf16 a[100:103], a[160:163], a[232:235], a[100:103]
  buffer_load_dwordx4 v22, s[12:15], s25 offen offset:1024 lds
  v_mfma_f32_16x16x32_bf16 a[100:103], a[156:159], a[228:231], a[100:103]
  s_waitcnt lgkmcnt(10)
  v_mfma_f32_16x16x32_bf16 a[104:107], a[140:143], a[188:191], a[104:107]
  s_sub_u32 s54, s54, 1
  s_cmp_eq_u32 s54, 0
  s_cselect_b32 s58, s55, s56
  s_add_u32 s25, s25, s58
  v_mfma_f32_16x16x32_bf16 a[104:107], a[144:147], a[192:195], a[104:107]
  v_mfma_f32_16x16x32_bf16 a[108:111], a[152:155], a[192:195], a[108:111]
  v_mfma_f32_16x16x32_bf16 a[108:111], a[148:151], a[188:191], a[108:111]
  v_mfma_f32_16x16x32_bf16 a[112:115], a[156:159], a[188:191], a[112:115]
  s_waitcnt vmcnt(13) lgkmcnt(0)
  s_barrier
  ds_read_b128 a[212:215], v10 offset:0
  ds_read_b128 a[216:219], v11 offset:0
  v_mfma_f32_16x16x32_bf16 a[112:115], a[160:163], a[192:195], a[112:115]
  s_add_u32 s94, s92, 12288
  buffer_store_dwordx4 v[128:131], v1, s[16:19], s94 offen offset:0
  v_mfma_f32_16x16x32_bf16 a[116:119], a[144:147], a[200:203], a[116:119]
  ds_read_b128 a[220:223], v10 offset:2048
  ds_read_b128 a[224:227], v11 offset:2048
  v_mfma_f32_16x16x32_bf16 a[116:119], a[140:143], a[196:199], a[116:119]
  v_mfma_f32_16x16x32_bf16 a[120:123], a[148:151], a[196:199], a[120:123]
  s_add_u32 s94, s92, 12288
  buffer_store_dwordx4 v[136:139], v1, s[16:19], s94 offen offset:1024
  v_mfma_f32_16x16x32_bf16 a[120:123], a[152:155], a[200:203], a[120:123]
  v_mfma_f32_16x16x32_bf16 a[124:127], a[160:163], a[200:203], a[124:127]
  v_mfma_f32_16x16x32_bf16 a[124:127], a[156:159], a[196:199], a[124:127]
  s_add_u32 m0, s28, 131072
  s_mov_b32 exec_hi, 0
  buffer_load_dwordx4 v20, s[8:11], s24 offen lds
  s_mov_b32 exec_hi, -1
  v_mfma_f32_16x16x32_bf16 a[128:131], a[140:143], a[204:207], a[128:131]
  ds_read_b128 a[228:231], v10 offset:4096
  ds_read_b128 a[232:235], v11 offset:4096
  v_mfma_f32_16x16x32_bf16 a[128:131], a[144:147], a[208:211], a[128:131]
  v_mfma_f32_16x16x32_bf16 a[132:135], a[152:155], a[208:211], a[132:135]
  v_mfma_f32_16x16x32_bf16 a[132:135], a[148:151], a[204:207], a[132:135]
  s_add_u32 m0, s29, 133120
  s_nop 0
  buffer_load_dwordx4 v2, s[8:11], s23 offen offset:0 lds
  v_mfma_f32_16x16x32_bf16 a[136:139], a[156:159], a[204:207], a[136:139]
  v_mfma_f32_16x16x32_bf16 a[136:139], a[160:163], a[208:211], a[136:139]
  s_waitcnt lgkmcnt(4)
  v_mfma_f32_16x16x32_bf16 a[32:35], a[164:167], a[212:215], a[32:35]
  ds_read_b128 a[188:191], v10 offset:6144
  ds_read_b128 a[192:195], v11 offset:6144
  v_mfma_f32_16x16x32_bf16 a[32:35], a[168:171], a[216:219], a[32:35]
  buffer_load_dwordx4 v3, s[8:11], s23 offen offset:1024 lds
  v_mfma_f32_16x16x32_bf16 a[36:39], a[176:179], a[216:219], a[36:39]
  ds_read_b64_tr_b16 a[140:141], v14 offset:0
  ds_read_b64_tr_b16 a[142:143], v14 offset:1536
  v_mfma_f32_16x16x32_bf16 a[36:39], a[172:175], a[212:215], a[36:39]
  v_mfma_f32_16x16x32_bf16 a[40:43], a[180:183], a[212:215], a[40:43]
  buffer_load_dwordx4 v4, s[8:11], s23 offen offset:2048 lds
  v_mfma_f32_16x16x32_bf16 a[40:43], a[184:187], a[216:219], a[40:43]
  s_waitcnt lgkmcnt(6)
  v_mfma_f32_16x16x32_bf16 a[44:47], a[168:171], a[224:227], a[44:47]
  ds_read_b128 a[196:199], v10 offset:8192
  ds_read_b128 a[200:203], v11 offset:8192
  v_mfma_f32_16x16x32_bf16 a[44:47], a[164:167], a[220:223], a[44:47]
  buffer_load_dwordx4 v5, s[8:11], s23 offen offset:3072 lds
  v_mfma_f32_16x16x32_bf16 a[48:51], a[172:175], a[220:223], a[48:51]
  ds_read_b64_tr_b16 a[148:149], v15 offset:0
  ds_read_b64_tr_b16 a[150:151], v15 offset:1536
  v_mfma_f32_16x16x32_bf16 a[48:51], a[176:179], a[224:227], a[48:51]
  v_mfma_f32_16x16x32_bf16 a[52:55], a[184:187], a[224:227], a[52:55]
  v_mfma_f32_16x16x32_bf16 a[52:55], a[180:183], a[220:223], a[52:55]
  s_sub_u32 s31, s31, 1
  s_cmp_eq_u32 s31, 0
  s_cselect_b32 s58, -1920, s57
  s_add_u32 s23, s23, s58
  s_add_u32 s24, s24, s58
  s_waitcnt lgkmcnt(8)
  v_mfma_f32_16x16x32_bf16 a[56:59], a[164:167], a[228:231], a[56:59]
  ds_read_b128 a[204:207], v10 offset:10240
  ds_read_b128 a[208:211], v11 offset:10240
  v_mfma_f32_16x16x32_bf16 a[56:59], a[168:171], a[232:235], a[56:59]
  v_mfma_f32_16x16x32_bf16 a[60:63], a[176:179], a[232:235], a[60:63]
  ds_read_b64_tr_b16 a[156:157], v16 offset:0
  ds_read_b64_tr_b16 a[158:159], v16 offset:1536
  v_mfma_f32_16x16x32_bf16 a[60:63], a[172:175], a[228:231], a[60:63]
  s_add_u32 m0, s30, 98304
  s_nop 0
  buffer_load_dwordx4 v6, s[12:15], s25 offen offset:0 lds
  v_mfma_f32_16x16x32_bf16 a[64:67], a[180:183], a[228:231], a[64:67]
  v_mfma_f32_16x16x32_bf16 a[64:67], a[184:187], a[232:235], a[64:67]
  s_waitcnt lgkmcnt(10)
  v_mfma_f32_16x16x32_bf16 a[68:71], a[168:171], a[192:195], a[68:71]
  ds_read_b128 a[212:215], v10 offset:12288
  ds_read_b128 a[216:219], v11 offset:12288
  v_mfma_f32_16x16x32_bf16 a[68:71], a[164:167], a[188:191], a[68:71]
  buffer_load_dwordx4 v7, s[12:15], s25 offen offset:1024 lds
  v_mfma_f32_16x16x32_bf16 a[72:75], a[172:175], a[188:191], a[72:75]
  ds_read_b64_tr_b16 a[144:145], v14 offset:12288
  ds_read_b64_tr_b16 a[146:147], v14 offset:13824
  v_mfma_f32_16x16x32_bf16 a[72:75], a[176:179], a[192:195], a[72:75]
  v_mfma_f32_16x16x32_bf16 a[76:79], a[184:187], a[192:195], a[76:79]
  buffer_load_dwordx4 v8, s[12:15], s25 offen offset:2048 lds
  v_mfma_f32_16x16x32_bf16 a[76:79], a[180:183], a[188:191], a[76:79]
  s_waitcnt lgkmcnt(10)
  v_mfma_f32_16x16x32_bf16 a[80:83], a[164:167], a[196:199], a[80:83]
  ds_read_b128 a[220:223], v10 offset:14336
  ds_read_b128 a[224:227], v11 offset:14336
  v_mfma_f32_16x16x32_bf16 a[80:83], a[168:171], a[200:203], a[80:83]
  v_mfma_f32_16x16x32_bf16 a[84:87], a[176:179], a[200:203], a[84:87]
  ds_read_b64_tr_b16 a[152:153], v15 offset:12288
  ds_read_b64_tr_b16 a[154:155], v15 offset:13824
  v_mfma_f32_16x16x32_bf16 a[84:87], a[172:175], a[196:199], a[84:87]
  buffer_load_dwordx4 v9, s[12:15], s25 offen offset:3072 lds
  v_mfma_f32_16x16x32_bf16 a[88:91], a[180:183], a[196:199], a[88:91]
  v_mfma_f32_16x16x32_bf16 a[88:91], a[184:187], a[200:203], a[88:91]
  s_add_u32 m0, s30, 102400
  s_nop 0
  buffer_load_dwordx4 v21, s[12:15], s25 offen offset:0 lds
  s_waitcnt lgkmcnt(10)
  v_mfma_f32_16x16x32_bf16 a[92:95], a[168:171], a[208:211], a[92:95]
  ds_read_b128 a[228:231], v10 offset:16384
  ds_read_b128 a[232:235], v11 offset:16384
  v_mfma_f32_16x16x32_bf16 a[92:95], a[164:167], a[204:207], a[92:95]
  v_mfma_f32_16x16x32_bf16 a[96:99], a[172:175], a[204:207], a[96:99]
  ds_read_b64_tr_b16 a[160:161], v16 offset:12288
  ds_read_b64_tr_b16 a[162:163], v16 offset:13824
  v_mfma_f32_16x16x32_bf16 a[96:99], a[176:179], a[208:211], a[96:99]
  v_mfma_f32_16x16x32_bf16 a[100:103], a[184:187], a[208:211], a[100:103]
  buffer_load_dwordx4 v22, s[12:15], s25 offen offset:1024 lds
  v_mfma_f32_16x16x32_bf16 a[100:103], a[180:183], a[204:207], a[100:103]
  s_waitcnt lgkmcnt(10)
  v_mfma_f32_16x16x32_bf16 a[104:107], a[164:167], a[212:215], a[104:107]
  s_sub_u32 s54, s54, 1
  s_cmp_eq_u32 s54, 0
  s_cselect_b32 s58, s55, s56
  s_add_u32 s25, s25, s58
  v_mfma_f32_16x16x32_bf16 a[104:107], a[168:171], a[216:219], a[104:107]
  v_mfma_f32_16x16x32_bf16 a[108:111], a[176:179], a[216:219], a[108:111]
  v_mfma_f32_16x16x32_bf16 a[108:111], a[172:175], a[212:215], a[108:111]
  v_mfma_f32_16x16x32_bf16 a[112:115], a[180:183], a[212:215], a[112:115]
  s_waitcnt vmcnt(13) lgkmcnt(0)
  s_barrier
  ds_read_b128 a[188:191], v10 offset:18432
  ds_read_b128 a[192:195], v11 offset:18432
  v_mfma_f32_16x16x32_bf16 a[112:115], a[184:187], a[216:219], a[112:115]
  s_add_u32 s94, s92, 12288
  buffer_store_dwordx4 v[144:147], v1, s[16:19], s94 offen offset:2048
  v_mfma_f32_16x16x32_bf16 a[116:119], a[168:171], a[224:227], a[116:119]
  ds_read_b128 a[196:199], v10 offset:20480
  ds_read_b128 a[200:203], v11 offset:20480
  v_mfma_f32_16x16x32_bf16 a[116:119], a[164:167], a[220:223], a[116:119]
  v_mfma_f32_16x16x32_bf16 a[120:123], a[172:175], a[220:223], a[120:123]
  s_add_u32 s94, s92, 12288
  buffer_store_dwordx4 v[152:155], v1, s[16:19], s94 offen offset:3072
  v_mfma_f32_16x16x32_bf16 a[120:123], a[176:179], a[224:227], a[120:123]
  v_mfma_f32_16x16x32_bf16 a[124:127], a[184:187], a[224:227], a[124:127]
  v_mfma_f32_16x16x32_bf16 a[124:127], a[180:183], a[220:223], a[124:127]
  s_add_u32 m0, s28, 0
  s_mov_b32 exec_hi, 0
  buffer_load_dwordx4 v20, s[8:11], s24 offen lds
  s_mov_b32 exec_hi, -1
  v_mfma_f32_16x16x32_bf16 a[128:131], a[164:167], a[228:231], a[128:131]
  ds_read_b128 a[204:207], v10 offset:22528
  ds_read_b128 a[208:211], v11 offset:22528
  v_mfma_f32_16x16x32_bf16 a[128:131], a[168:171], a[232:235], a[128:131]
  v_mfma_f32_16x16x32_bf16 a[132:135], a[176:179], a[232:235], a[132:135]
  v_mfma_f32_16x16x32_bf16 a[132:135], a[172:175], a[228:231], a[132:135]
  s_add_u32 m0, s29, 2048
  s_nop 0
  buffer_load_dwordx4 v2, s[8:11], s23 offen offset:0 lds
  v_mfma_f32_16x16x32_bf16 a[136:139], a[180:183], a[228:231], a[136:139]
  v_mfma_f32_16x16x32_bf16 a[136:139], a[184:187], a[232:235], a[136:139]
  s_waitcnt lgkmcnt(4)
  v_mfma_f32_16x16x32_bf16 a[32:35], a[140:143], a[188:191], a[32:35]
  ds_read_b128 a[212:215], v10 offset:24576
  ds_read_b128 a[216:219], v11 offset:24576
  v_mfma_f32_16x16x32_bf16 a[32:35], a[144:147], a[192:195], a[32:35]
  buffer_load_dwordx4 v3, s[8:11], s23 offen offset:1024 lds
  v_mfma_f32_16x16x32_bf16 a[36:39], a[152:155], a[192:195], a[36:39]
  ds_read_b64_tr_b16 a[164:165], v14 offset:28672
  ds_read_b64_tr_b16 a[166:167], v14 offset:30208
  v_mfma_f32_16x16x32_bf16 a[36:39], a[148:151], a[188:191], a[36:39]
  v_mfma_f32_16x16x32_bf16 a[40:43], a[156:159], a[188:191], a[40:43]
  buffer_load_dwordx4 v4, s[8:11], s23 offen offset:2048 lds
  v_mfma_f32_16x16x32_bf16 a[40:43], a[160:163], a[192:195], a[40:43]
  s_waitcnt lgkmcnt(6)
  v_mfma_f32_16x16x32_bf16 a[44:47], a[144:147], a[200:203], a[44:47]
  ds_read_b128 a[220:223], v10 offset:26624
  ds_read_b128 a[224:227], v11 offset:26624
  v_mfma_f32_16x16x32_bf16 a[44:47], a[140:143], a[196:199], a[44:47]
  buffer_load_dwordx4 v5, s[8:11], s23 offen offset:3072 lds
  v_mfma_f32_16x16x32_bf16 a[48:51], a[148:151], a[196:199], a[48:51]
  ds_read_b64_tr_b16 a[172:173], v15 offset:28672
  ds_read_b64_tr_b16 a[174:175], v15 offset:30208
  v_mfma_f32_16x16x32_bf16 a[48:51], a[152:155], a[200:203], a[48:51]
  v_mfma_f32_16x16x32_bf16 a[52:55], a[160:163], a[200:203], a[52:55]
  v_mfma_f32_16x16x32_bf16 a[52:55], a[156:159], a[196:199], a[52:55]
  s_sub_u32 s31, s31, 1
  s_cmp_eq_u32 s31, 0
  s_cselect_b32 s58, -1920, s57
  s_add_u32 s23, s23, s58
  s_add_u32 s24, s24, s58
  s_waitcnt lgkmcnt(8)
  v_mfma_f32_16x16x32_bf16 a[56:59], a[140:143], a[204:207], a[56:59]
  ds_read_b128 a[228:231], v10 offset:28672
  ds_read_b128 a[232:235], v11 offset:28672
  v_mfma_f32_16x16x32_bf16 a[56:59], a[144:147], a[208:211], a[56:59]
  v_mfma_f32_16x16x32_bf16 a[60:63], a[152:155], a[208:211], a[60:63]
  ds_read_b64_tr_b16 a[180:181], v16 offset:28672
  ds_read_b64_tr_b16 a[182:183], v16 offset:30208
  v_mfma_f32_16x16x32_bf16 a[60:63], a[148:151], a[204:207], a[60:63]
  s_add_u32 m0, s30, 36864
  s_nop 0
  buffer_load_dwordx4 v6, s[12:15], s25 offen offset:0 lds
  v_mfma_f32_16x16x32_bf16 a[64:67], a[156:159], a[204:207], a[64:67]
  v_mfma_f32_16x16x32_bf16 a[64:67], a[160:163], a[208:211], a[64:67]
  s_waitcnt lgkmcnt(10)
  v_mfma_f32_16x16x32_bf16 a[68:71], a[144:147], a[216:219], a[68:71]
  ds_read_b128 a[188:191], v10 offset:30720
  ds_read_b128 a[192:195], v11 offset:30720
  v_mfma_f32_16x16x32_bf16 a[68:71], a[140:143], a[212:215], a[68:71]
  buffer_load_dwordx4 v7, s[12:15], s25 offen offset:1024 lds
  v_mfma_f32_16x16x32_bf16 a[72:75], a[148:151], a[212:215], a[72:75]
  ds_read_b64_tr_b16 a[168:169], v14 offset:40960
  ds_read_b64_tr_b16 a[170:171], v14 offset:42496
  v_mfma_f32_16x16x32_bf16 a[72:75], a[152:155], a[216:219], a[72:75]
  v_mfma_f32_16x16x32_bf16 a[76:79], a[160:163], a[216:219], a[76:79]
  buffer_load_dwordx4 v8, s[12:15], s25 offen offset:2048 lds
  v_mfma_f32_16x16x32_bf16 a[76:79], a[156:159], a[212:215], a[76:79]
  s_waitcnt lgkmcnt(10)
  v_mfma_f32_16x16x32_bf16 a[80:83], a[140:143], a[220:223], a[80:83]
  ds_read_b128 a[196:199], v10 offset:32768
  ds_read_b128 a[200:203], v11 offset:32768
  v_mfma_f32_16x16x32_bf16 a[80:83], a[144:147], a[224:227], a[80:83]
  v_mfma_f32_16x16x32_bf16 a[84:87], a[152:155], a[224:227], a[84:87]
  ds_read_b64_tr_b16 a[176:177], v15 offset:40960
  ds_read_b64_tr_b16 a[178:179], v15 offset:42496
  v_mfma_f32_16x16x32_bf16 a[84:87], a[148:151], a[220:223], a[84:87]
  buffer_load_dwordx4 v9, s[12:15], s25 offen offset:3072 lds
  v_mfma_f32_16x16x32_bf16 a[88:91], a[156:159], a[220:223], a[88:91]
  v_mfma_f32_16x16x32_bf16 a[88:91], a[160:163], a[224:227], a[88:91]
  s_add_u32 m0, s30, 40960
  s_nop 0
  buffer_load_dwordx4 v21, s[12:15], s25 offen offset:0 lds
  s_waitcnt lgkmcnt(10)
  v_mfma_f32_16x16x32_bf16 a[92:95], a[144:147], a[232:235], a[92:95]
  ds_read_b128 a[204:207], v10 offset:34816
  ds_read_b128 a[208:211], v11 offset:34816
  v_mfma_f32_16x16x32_bf16 a[92:95], a[140:143], a[228:231], a[92:95]
  v_mfma_f32_16x16x32_bf16 a[96:99], a[148:151], a[228:231], a[96:99]
  ds_read_b64_tr_b16 a[184:185], v16 offset:40960
  ds_read_b64_tr_b16 a[186:187], v16 offset:42496
  v_mfma_f32_16x16x32_bf16 a[96:99], a[152:155], a[232:235], a[96:99]
  v_mfma_f32_16x16x32_bf16 a[100:103], a[160:163], a[232:235], a[100:103]
  buffer_load_dwordx4 v22, s[12:15], s25 offen offset:1024 lds
  v_mfma_f32_16x16x32_bf16 a[100:103], a[156:159], a[228:231], a[100:103]
  s_waitcnt lgkmcnt(10)
  v_mfma_f32_16x16x32_bf16 a[104:107], a[140:143], a[188:191], a[104:107]
  s_sub_u32 s54, s54, 1
  s_cmp_eq_u32 s54, 0
  s_cselect_b32 s58, s55, s56
  s_add_u32 s25, s25, s58
  v_mfma_f32_16x16x32_bf16 a[104:107], a[144:147], a[192:195], a[104:107]
  v_mfma_f32_16x16x32_bf16 a[108:111], a[152:155], a[192:195], a[108:111]
  v_mfma_f32_16x16x32_bf16 a[108:111], a[148:151], a[188:191], a[108:111]
  v_mfma_f32_16x16x32_bf16 a[112:115], a[156:159], a[188:191], a[112:115]
  s_waitcnt vmcnt(13) lgkmcnt(0)
  s_barrier
  ds_read_b128 a[212:215], v12 offset:0
  ds_read_b128 a[216:219], v13 offset:0
  v_mfma_f32_16x16x32_bf16 a[112:115], a[160:163], a[192:195], a[112:115]
  s_add_u32 s94, s93, 0
  buffer_store_dwordx4 v[160:163], v1, s[16:19], s94 offen offset:0
  v_mfma_f32_16x16x32_bf16 a[116:119], a[144:147], a[200:203], a[116:119]
  ds_read_b128 a[220:223], v12 offset:2048
  ds_read_b128 a[224:227], v13 offset:2048
  v_mfma_f32_16x16x32_bf16 a[116:119], a[140:143], a[196:199], a[116:119]
  v_mfma_f32_16x16x32_bf16 a[120:123], a[148:151], a[196:199], a[120:123]
  s_add_u32 s94, s93, 0
  buffer_store_dwordx4 v[168:171], v1, s[16:19], s94 offen offset:1024
  v_mfma_f32_16x16x32_bf16 a[120:123], a[152:155], a[200:203], a[120:123]
  v_mfma_f32_16x16x32_bf16 a[124:127], a[160:163], a[200:203], a[124:127]
  v_mfma_f32_16x16x32_bf16 a[124:127], a[156:159], a[196:199], a[124:127]
  s_add_u32 m0, s28, 18432
  s_mov_b32 exec_hi, 0
  buffer_load_dwordx4 v20, s[8:11], s24 offen lds
  s_mov_b32 exec_hi, -1
  v_mfma_f32_16x16x32_bf16 a[128:131], a[140:143], a[204:207], a[128:131]
  ds_read_b128 a[228:231], v12 offset:4096
  ds_read_b128 a[232:235], v13 offset:4096
  v_mfma_f32_16x16x32_bf16 a[128:131], a[144:147], a[208:211], a[128:131]
  v_mfma_f32_16x16x32_bf16 a[132:135], a[152:155], a[208:211], a[132:135]
  v_mfma_f32_16x16x32_bf16 a[132:135], a[148:151], a[204:207], a[132:135]
  s_add_u32 m0, s29, 20480
  s_nop 0
  buffer_load_dwordx4 v2, s[8:11], s23 offen offset:0 lds
  v_mfma_f32_16x16x32_bf16 a[136:139], a[156:159], a[204:207], a[136:139]
  v_mfma_f32_16x16x32_bf16 a[136:139], a[160:163], a[208:211], a[136:139]
  s_waitcnt lgkmcnt(4)
  v_mfma_f32_16x16x32_bf16 a[32:35], a[164:167], a[212:215], a[32:35]
  ds_read_b128 a[188:191], v12 offset:6144
  ds_read_b128 a[192:195], v13 offset:6144
  v_mfma_f32_16x16x32_bf16 a[32:35], a[168:171], a[216:219], a[32:35]
  buffer_load_dwordx4 v3, s[8:11], s23 offen offset:1024 lds
  v_mfma_f32_16x16x32_bf16 a[36:39], a[176:179], a[216:219], a[36:39]
  ds_read_b64_tr_b16 a[140:141], v17 offset:0
  ds_read_b64_tr_b16 a[142:143], v17 offset:1536
  v_mfma_f32_16x16x32_bf16 a[36:39], a[172:175], a[212:215], a[36:39]
  v_mfma_f32_16x16x32_bf16 a[40:43], a[180:183], a[212:215], a[40:43]
  buffer_load_dwordx4 v4, s[8:11], s23 offen offset:2048 lds
  v_mfma_f32_16x16x32_bf16 a[40:43], a[184:187], a[216:219], a[40:43]
  s_waitcnt lgkmcnt(6)
  v_mfma_f32_16x16x32_bf16 a[44:47], a[168:171], a[224:227], a[44:47]
  ds_read_b128 a[196:199], v12 offset:8192
  ds_read_b128 a[200:203], v13 offset:8192
  v_mfma_f32_16x16x32_bf16 a[44:47], a[164:167], a[220:223], a[44:47]
  buffer_load_dwordx4 v5, s[8:11], s23 offen offset:3072 lds
  v_mfma_f32_16x16x32_bf16 a[48:51], a[172:175], a[220:223], a[48:51]
  ds_read_b64_tr_b16 a[148:149], v18 offset:0
  ds_read_b64_tr_b16 a[150:151], v18 offset:1536
  v_mfma_f32_16x16x32_bf16 a[48:51], a[176:179], a[224:227], a[48:51]
  v_mfma_f32_16x16x32_bf16 a[52:55], a[184:187], a[224:227], a[52:55]
  v_mfma_f32_16x16x32_bf16 a[52:55], a[180:183], a[220:223], a[52:55]
  s_sub_u32 s31, s31, 1
  s_cmp_eq_u32 s31, 0
  s_cselect_b32 s58, -1920, s57
  s_add_u32 s23, s23, s58
  s_add_u32 s24, s24, s58
  s_waitcnt lgkmcnt(8)
  v_mfma_f32_16x16x32_bf16 a[56:59], a[164:167], a[228:231], a[56:59]
  ds_read_b128 a[204:207], v12 offset:10240
  ds_read_b128 a[208:211], v13 offset:10240
  v_mfma_f32_16x16x32_bf16 a[56:59], a[168:171], a[232:235], a[56:59]
  v_mfma_f32_16x16x32_bf16 a[60:63], a[176:179], a[232:235], a[60:63]
  ds_read_b64_tr_b16 a[156:157], v19 offset:0
  ds_read_b64_tr_b16 a[158:159], v19 offset:1536
  v_mfma_f32_16x16x32_bf16 a[60:63], a[172:175], a[228:231], a[60:63]
  s_add_u32 m0, s30, 65536
  s_nop 0
  buffer_load_dwordx4 v6, s[12:15], s25 offen offset:0 lds
  v_mfma_f32_16x16x32_bf16 a[64:67], a[180:183], a[228:231], a[64:67]
  v_mfma_f32_16x16x32_bf16 a[64:67], a[184:187], a[232:235], a[64:67]
  s_waitcnt lgkmcnt(10)
  v_mfma_f32_16x16x32_bf16 a[68:71], a[168:171], a[192:195], a[68:71]
  ds_read_b128 a[212:215], v12 offset:12288
  ds_read_b128 a[216:219], v13 offset:12288
  v_mfma_f32_16x16x32_bf16 a[68:71], a[164:167], a[188:191], a[68:71]
  buffer_load_dwordx4 v7, s[12:15], s25 offen offset:1024 lds
  v_mfma_f32_16x16x32_bf16 a[72:75], a[172:175], a[188:191], a[72:75]
  ds_read_b64_tr_b16 a[144:145], v17 offset:12288
  ds_read_b64_tr_b16 a[146:147], v17 offset:13824
  v_mfma_f32_16x16x32_bf16 a[72:75], a[176:179], a[192:195], a[72:75]
  v_mfma_f32_16x16x32_bf16 a[76:79], a[184:187], a[192:195], a[76:79]
  buffer_load_dwordx4 v8, s[12:15], s25 offen offset:2048 lds
  v_mfma_f32_16x16x32_bf16 a[76:79], a[180:183], a[188:191], a[76:79]
  s_waitcnt lgkmcnt(10)
  v_mfma_f32_16x16x32_bf16 a[80:83], a[164:167], a[196:199], a[80:83]
  ds_read_b128 a[220:223], v12 offset:14336
  ds_read_b128 a[224:227], v13 offset:14336
  v_mfma_f32_16x16x32_bf16 a[80:83], a[168:171], a[200:203], a[80:83]
  v_mfma_f32_16x16x32_bf16 a[84:87], a[176:179], a[200:203], a[84:87]
  ds_read_b64_tr_b16 a[152:153], v18 offset:12288
  ds_read_b64_tr_b16 a[154:155], v18 offset:13824
  v_mfma_f32_16x16x32_bf16 a[84:87], a[172:175], a[196:199], a[84:87]
  buffer_load_dwordx4 v9, s[12:15], s25 offen offset:3072 lds
  v_mfma_f32_16x16x32_bf16 a[88:91], a[180:183], a[196:199], a[88:91]
  v_mfma_f32_16x16x32_bf16 a[88:91], a[184:187], a[200:203], a[88:91]
  s_add_u32 m0, s30, 69632
  s_nop 0
  buffer_load_dwordx4 v21, s[12:15], s25 offen offset:0 lds
  s_waitcnt lgkmcnt(10)
  v_mfma_f32_16x16x32_bf16 a[92:95], a[168:171], a[208:211], a[92:95]
  ds_read_b128 a[228:231], v12 offset:16384
  ds_read_b128 a[232:235], v13 offset:16384
  v_mfma_f32_16x16x32_bf16 a[92:95], a[164:167], a[204:207], a[92:95]
  v_mfma_f32_16x16x32_bf16 a[96:99], a[172:175], a[204:207], a[96:99]
  ds_read_b64_tr_b16 a[160:161], v19 offset:12288
  ds_read_b64_tr_b16 a[162:163], v19 offset:13824
  v_mfma_f32_16x16x32_bf16 a[96:99], a[176:179], a[208:211], a[96:99]
  v_mfma_f32_16x16x32_bf16 a[100:103], a[184:187], a[208:211], a[100:103]
  buffer_load_dwordx4 v22, s[12:15], s25 offen offset:1024 lds
  v_mfma_f32_16x16x32_bf16 a[100:103], a[180:183], a[204:207], a[100:103]
  s_waitcnt lgkmcnt(10)
  v_mfma_f32_16x16x32_bf16 a[104:107], a[164:167], a[212:215], a[104:107]
  s_sub_u32 s54, s54, 1
  s_cmp_eq_u32 s54, 0
  s_cselect_b32 s58, s55, s56
  s_add_u32 s25, s25, s58
  v_mfma_f32_16x16x32_bf16 a[104:107], a[168:171], a[216:219], a[104:107]
  v_mfma_f32_16x16x32_bf16 a[108:111], a[176:179], a[216:219], a[108:111]
  v_mfma_f32_16x16x32_bf16 a[108:111], a[172:175], a[212:215], a[108:111]
  v_mfma_f32_16x16x32_bf16 a[112:115], a[180:183], a[212:215], a[112:115]
  s_waitcnt vmcnt(13) lgkmcnt(0)
  s_barrier
  ds_read_b128 a[188:191], v10 offset:0
  ds_read_b128 a[192:195], v11 offset:0
  v_mfma_f32_16x16x32_bf16 a[112:115], a[184:187], a[216:219], a[112:115]
  s_add_u32 s94, s93, 0
  buffer_store_dwordx4 v[176:179], v1, s[16:19], s94 offen offset:2048
  v_mfma_f32_16x16x32_bf16 a[116:119], a[168:171], a[224:227], a[116:119]
  ds_read_b128 a[196:199], v10 offset:2048
  ds_read_b128 a[200:203], v11 offset:2048
  v_mfma_f32_16x16x32_bf16 a[116:119], a[164:167], a[220:223], a[116:119]
  v_mfma_f32_16x16x32_bf16 a[120:123], a[172:175], a[220:223], a[120:123]
  s_add_u32 s94, s93, 0
  buffer_store_dwordx4 v[184:187], v1, s[16:19], s94 offen offset:3072
  v_mfma_f32_16x16x32_bf16 a[120:123], a[176:179], a[224:227], a[120:123]
  v_mfma_f32_16x16x32_bf16 a[124:127], a[184:187], a[224:227], a[124:127]
  v_mfma_f32_16x16x32_bf16 a[124:127], a[180:183], a[220:223], a[124:127]
  s_add_u32 m0, s28, 131072
  s_mov_b32 exec_hi, 0
  buffer_load_dwordx4 v20, s[8:11], s24 offen lds
  s_mov_b32 exec_hi, -1
  v_mfma_f32_16x16x32_bf16 a[128:131], a[164:167], a[228:231], a[128:131]
  ds_read_b128 a[204:207], v10 offset:4096
  ds_read_b128 a[208:211], v11 offset:4096
  v_mfma_f32_16x16x32_bf16 a[128:131], a[168:171], a[232:235], a[128:131]
  v_mfma_f32_16x16x32_bf16 a[132:135], a[176:179], a[232:235], a[132:135]
  v_mfma_f32_16x16x32_bf16 a[132:135], a[172:175], a[228:231], a[132:135]
  s_add_u32 m0, s29, 133120
  s_nop 0
  buffer_load_dwordx4 v2, s[8:11], s23 offen offset:0 lds
  v_mfma_f32_16x16x32_bf16 a[136:139], a[180:183], a[228:231], a[136:139]
  v_mfma_f32_16x16x32_bf16 a[136:139], a[184:187], a[232:235], a[136:139]
  s_waitcnt lgkmcnt(4)
  v_mfma_f32_16x16x32_bf16 a[32:35], a[140:143], a[188:191], a[32:35]
  ds_read_b128 a[212:215], v10 offset:6144
  ds_read_b128 a[216:219], v11 offset:6144
  v_mfma_f32_16x16x32_bf16 a[32:35], a[144:147], a[192:195], a[32:35]
  buffer_load_dwordx4 v3, s[8:11], s23 offen offset:1024 lds
  v_mfma_f32_16x16x32_bf16 a[36:39], a[152:155], a[192:195], a[36:39]
  ds_read_b64_tr_b16 a[164:165], v14 offset:0
  ds_read_b64_tr_b16 a[166:167], v14 offset:1536
  v_mfma_f32_16x16x32_bf16 a[36:39], a[148:151], a[188:191], a[36:39]
  v_mfma_f32_16x16x32_bf16 a[40:43], a[156:159], a[188:191], a[40:43]
  buffer_load_dwordx4 v4, s[8:11], s23 offen offset:2048 lds
  v_mfma_f32_16x16x32_bf16 a[40:43], a[160:163], a[192:195], a[40:43]
  s_waitcnt lgkmcnt(6)
  v_mfma_f32_16x16x32_bf16 a[44:47], a[144:147], a[200:203], a[44:47]
  ds_read_b128 a[220:223], v10 offset:8192
  ds_read_b128 a[224:227], v11 offset:8192
  v_mfma_f32_16x16x32_bf16 a[44:47], a[140:143], a[196:199], a[44:47]
  buffer_load_dwordx4 v5, s[8:11], s23 offen offset:3072 lds
  v_mfma_f32_16x16x32_bf16 a[48:51], a[148:151], a[196:199], a[48:51]
  ds_read_b64_tr_b16 a[172:173], v15 offset:0
  ds_read_b64_tr_b16 a[174:175], v15 offset:1536
  v_mfma_f32_16x16x32_bf16 a[48:51], a[152:155], a[200:203], a[48:51]
  v_mfma_f32_16x16x32_bf16 a[52:55], a[160:163], a[200:203], a[52:55]
  v_mfma_f32_16x16x32_bf16 a[52:55], a[156:159], a[196:199], a[52:55]
  s_sub_u32 s31, s31, 1
  s_cmp_eq_u32 s31, 0
  s_cselect_b32 s58, -1920, s57
  s_add_u32 s23, s23, s58
  s_add_u32 s24, s24, s58
  s_waitcnt lgkmcnt(8)
  v_mfma_f32_16x16x32_bf16 a[56:59], a[140:143], a[204:207], a[56:59]
  ds_read_b128 a[228:231], v10 offset:10240
  ds_read_b128 a[232:235], v11 offset:10240
  v_mfma_f32_16x16x32_bf16 a[56:59], a[144:147], a[208:211], a[56:59]
  v_mfma_f32_16x16x32_bf16 a[60:63], a[152:155], a[208:211], a[60:63]
  ds_read_b64_tr_b16 a[180:181], v16 offset:0
  ds_read_b64_tr_b16 a[182:183], v16 offset:1536
  v_mfma_f32_16x16x32_bf16 a[60:63], a[148:151], a[204:207], a[60:63]
  s_add_u32 m0, s30, 98304
  s_nop 0
  buffer_load_dwordx4 v6, s[12:15], s25 offen offset:0 lds
  v_mfma_f32_16x16x32_bf16 a[64:67], a[156:159], a[204:207], a[64:67]
  v_mfma_f32_16x16x32_bf16 a[64:67], a[160:163], a[208:211], a[64:67]
  s_waitcnt lgkmcnt(10)
  v_mfma_f32_16x16x32_bf16 a[68:71], a[144:147], a[216:219], a[68:71]
  ds_read_b128 a[188:191], v10 offset:12288
  ds_read_b128 a[192:195], v11 offset:12288
  v_mfma_f32_16x16x32_bf16 a[68:71], a[140:143], a[212:215], a[68:71]
  buffer_load_dwordx4 v7, s[12:15], s25 offen offset:1024 lds
  v_mfma_f32_16x16x32_bf16 a[72:75], a[148:151], a[212:215], a[72:75]
  ds_read_b64_tr_b16 a[168:169], v14 offset:12288
  ds_read_b64_tr_b16 a[170:171], v14 offset:13824
  v_mfma_f32_16x16x32_bf16 a[72:75], a[152:155], a[216:219], a[72:75]
  v_mfma_f32_16x16x32_bf16 a[76:79], a[160:163], a[216:219], a[76:79]
  buffer_load_dwordx4 v8, s[12:15], s25 offen offset:2048 lds
  v_mfma_f32_16x16x32_bf16 a[76:79], a[156:159], a[212:215], a[76:79]
  s_waitcnt lgkmcnt(10)
  v_mfma_f32_16x16x32_bf16 a[80:83], a[140:143], a[220:223], a[80:83]
  ds_read_b128 a[196:199], v10 offset:14336
  ds_read_b128 a[200:203], v11 offset:14336
  v_mfma_f32_16x16x32_bf16 a[80:83], a[144:147], a[224:227], a[80:83]
  v_mfma_f32_16x16x32_bf16 a[84:87], a[152:155], a[224:227], a[84:87]
  ds_read_b64_tr_b16 a[176:177], v15 offset:12288
  ds_read_b64_tr_b16 a[178:179], v15 offset:13824
  v_mfma_f32_16x16x32_bf16 a[84:87], a[148:151], a[220:223], a[84:87]
  buffer_load_dwordx4 v9, s[12:15], s25 offen offset:3072 lds
  v_mfma_f32_16x16x32_bf16 a[88:91], a[156:159], a[220:223], a[88:91]
  v_mfma_f32_16x16x32_bf16 a[88:91], a[160:163], a[224:227], a[88:91]
  s_add_u32 m0, s30, 102400
  s_nop 0
  buffer_load_dwordx4 v21, s[12:15], s25 offen offset:0 lds
  s_waitcnt lgkmcnt(10)
  v_mfma_f32_16x16x32_bf16 a[92:95], a[144:147], a[232:235], a[92:95]
  ds_read_b128 a[204:207], v10 offset:16384
  ds_read_b128 a[208:211], v11 offset:16384
  v_mfma_f32_16x16x32_bf16 a[92:95], a[140:143], a[228:231], a[92:95]
  v_mfma_f32_16x16x32_bf16 a[96:99], a[148:151], a[228:231], a[96:99]
  ds_read_b64_tr_b16 a[184:185], v16 offset:12288
  ds_read_b64_tr_b16 a[186:187], v16 offset:13824
  v_mfma_f32_16x16x32_bf16 a[96:99], a[152:155], a[232:235], a[96:99]
  v_mfma_f32_16x16x32_bf16 a[100:103], a[160:163], a[232:235], a[100:103]
  buffer_load_dwordx4 v22, s[12:15], s25 offen offset:1024 lds
  v_mfma_f32_16x16x32_bf16 a[100:103], a[156:159], a[228:231], a[100:103]
  s_waitcnt lgkmcnt(10)
  v_mfma_f32_16x16x32_bf16 a[104:107], a[140:143], a[188:191], a[104:107]
  s_sub_u32 s54, s54, 1
  s_cmp_eq_u32 s54, 0
  s_cselect_b32 s58, s55, s56
  s_add_u32 s25, s25, s58
  v_mfma_f32_16x16x32_bf16 a[104:107], a[144:147], a[192:195], a[104:107]
  v_mfma_f32_16x16x32_bf16 a[108:111], a[152:155], a[192:195], a[108:111]
  v_mfma_f32_16x16x32_bf16 a[108:111], a[148:151], a[188:191], a[108:111]
  v_mfma_f32_16x16x32_bf16 a[112:115], a[156:159], a[188:191], a[112:115]
  s_waitcnt vmcnt(13) lgkmcnt(0)
  s_barrier
  ds_read_b128 a[212:215], v10 offset:18432
  ds_read_b128 a[216:219], v11 offset:18432
  v_mfma_f32_16x16x32_bf16 a[112:115], a[160:163], a[192:195], a[112:115]
  s_add_u32 s94, s93, 4096
  buffer_store_dwordx4 v[192:195], v1, s[16:19], s94 offen offset:0
  v_mfma_f32_16x16x32_bf16 a[116:119], a[144:147], a[200:203], a[116:119]
  ds_read_b128 a[220:223], v10 offset:20480
  ds_read_b128 a[224:227], v11 offset:20480
  v_mfma_f32_16x16x32_bf16 a[116:119], a[140:143], a[196:199], a[116:119]
  v_mfma_f32_16x16x32_bf16 a[120:123], a[148:151], a[196:199], a[120:123]
  s_add_u32 s94, s93, 4096
  buffer_store_dwordx4 v[200:203], v1, s[16:19], s94 offen offset:1024
  v_mfma_f32_16x16x32_bf16 a[120:123], a[152:155], a[200:203], a[120:123]
  v_mfma_f32_16x16x32_bf16 a[124:127], a[160:163], a[200:203], a[124:127]
  v_mfma_f32_16x16x32_bf16 a[124:127], a[156:159], a[196:199], a[124:127]
  s_add_u32 m0, s28, 0
  s_mov_b32 exec_hi, 0
  buffer_load_dwordx4 v20, s[8:11], s24 offen lds
  s_mov_b32 exec_hi, -1
  v_mfma_f32_16x16x32_bf16 a[128:131], a[140:143], a[204:207], a[128:131]
  ds_read_b128 a[228:231], v10 offset:22528
  ds_read_b128 a[232:235], v11 offset:22528
  v_mfma_f32_16x16x32_bf16 a[128:131], a[144:147], a[208:211], a[128:131]
  v_mfma_f32_16x16x32_bf16 a[132:135], a[152:155], a[208:211], a[132:135]
  v_mfma_f32_16x16x32_bf16 a[132:135], a[148:151], a[204:207], a[132:135]
  s_add_u32 m0, s29, 2048
  s_nop 0
  buffer_load_dwordx4 v2, s[8:11], s23 offen offset:0 lds
  v_mfma_f32_16x16x32_bf16 a[136:139], a[156:159], a[204:207], a[136:139]
  v_mfma_f32_16x16x32_bf16 a[136:139], a[160:163], a[208:211], a[136:139]
  s_waitcnt lgkmcnt(4)
  v_mfma_f32_16x16x32_bf16 a[32:35], a[164:167], a[212:215], a[32:35]
  ds_read_b128 a[188:191], v10 offset:24576
  ds_read_b128 a[192:195], v11 offset:24576
  v_mfma_f32_16x16x32_bf16 a[32:35], a[168:171], a[216:219], a[32:35]
  buffer_load_dwordx4 v3, s[8:11], s23 offen offset:1024 lds
  v_mfma_f32_16x16x32_bf16 a[36:39], a[176:179], a[216:219], a[36:39]
  ds_read_b64_tr_b16 a[140:141], v14 offset:28672
  ds_read_b64_tr_b16 a[142:143], v14 offset:30208
  v_mfma_f32_16x16x32_bf16 a[36:39], a[172:175], a[212:215], a[36:39]
  v_mfma_f32_16x16x32_bf16 a[40:43], a[180:183], a[212:215], a[40:43]
  buffer_load_dwordx4 v4, s[8:11], s23 offen offset:2048 lds
  v_mfma_f32_16x16x32_bf16 a[40:43], a[184:187], a[216:219], a[40:43]
  s_waitcnt lgkmcnt(6)
  v_mfma_f32_16x16x32_bf16 a[44:47], a[168:171], a[224:227], a[44:47]
  ds_read_b128 a[196:199], v10 offset:26624
  ds_read_b128 a[200:203], v11 offset:26624
  v_mfma_f32_16x16x32_bf16 a[44:47], a[164:167], a[220:223], a[44:47]
  buffer_load_dwordx4 v5, s[8:11], s23 offen offset:3072 lds
  v_mfma_f32_16x16x32_bf16 a[48:51], a[172:175], a[220:223], a[48:51]
  ds_read_b64_tr_b16 a[148:149], v15 offset:28672
  ds_read_b64_tr_b16 a[150:151], v15 offset:30208
  v_mfma_f32_16x16x32_bf16 a[48:51], a[176:179], a[224:227], a[48:51]
  v_mfma_f32_16x16x32_bf16 a[52:55], a[184:187], a[224:227], a[52:55]
  v_mfma_f32_16x16x32_bf16 a[52:55], a[180:183], a[220:223], a[52:55]
  s_sub_u32 s31, s31, 1
  s_cmp_eq_u32 s31, 0
  s_cselect_b32 s58, -1920, s57
  s_add_u32 s23, s23, s58
  s_add_u32 s24, s24, s58
  s_waitcnt lgkmcnt(8)
  v_mfma_f32_16x16x32_bf16 a[56:59], a[164:167], a[228:231], a[56:59]
  ds_read_b128 a[204:207], v10 offset:28672
  ds_read_b128 a[208:211], v11 offset:28672
  v_mfma_f32_16x16x32_bf16 a[56:59], a[168:171], a[232:235], a[56:59]
  v_mfma_f32_16x16x32_bf16 a[60:63], a[176:179], a[232:235], a[60:63]
  ds_read_b64_tr_b16 a[156:157], v16 offset:28672
  ds_read_b64_tr_b16 a[158:159], v16 offset:30208
  v_mfma_f32_16x16x32_bf16 a[60:63], a[172:175], a[228:231], a[60:63]
  s_add_u32 m0, s30, 36864
  s_nop 0
  buffer_load_dwordx4 v6, s[12:15], s25 offen offset:0 lds
  v_mfma_f32_16x16x32_bf16 a[64:67], a[180:183], a[228:231], a[64:67]
  v_mfma_f32_16x16x32_bf16 a[64:67], a[184:187], a[232:235], a[64:67]
  s_waitcnt lgkmcnt(10)
  v_mfma_f32_16x16x32_bf16 a[68:71], a[168:171], a[192:195], a[68:71]
  ds_read_b128 a[212:215], v10 offset:30720
  ds_read_b128 a[216:219], v11 offset:30720
  v_mfma_f32_16x16x32_bf16 a[68:71], a[164:167], a[188:191], a[68:71]
  buffer_load_dwordx4 v7, s[12:15], s25 offen offset:1024 lds
  v_mfma_f32_16x16x32_bf16 a[72:75], a[172:175], a[188:191], a[72:75]
  ds_read_b64_tr_b16 a[144:145], v14 offset:40960
  ds_read_b64_tr_b16 a[146:147], v14 offset:42496
  v_mfma_f32_16x16x32_bf16 a[72:75], a[176:179], a[192:195], a[72:75]
  v_mfma_f32_16x16x32_bf16 a[76:79], a[184:187], a[192:195], a[76:79]
  buffer_load_dwordx4 v8, s[12:15], s25 offen offset:2048 lds
  v_mfma_f32_16x16x32_bf16 a[76:79], a[180:183], a[188:191], a[76:79]
  s_waitcnt lgkmcnt(10)
  v_mfma_f32_16x16x32_bf16 a[80:83], a[164:167], a[196:199], a[80:83]
  ds_read_b128 a[220:223], v10 offset:32768
  ds_read_b128 a[224:227], v11 offset:32768
  v_mfma_f32_16x16x32_bf16 a[80:83], a[168:171], a[200:203], a[80:83]
  v_mfma_f32_16x16x32_bf16 a[84:87], a[176:179], a[200:203], a[84:87]
  ds_read_b64_tr_b16 a[152:153], v15 offset:40960
  ds_read_b64_tr_b16 a[154:155], v15 offset:42496
  v_mfma_f32_16x16x32_bf16 a[84:87], a[172:175], a[196:199], a[84:87]
  buffer_load_dwordx4 v9, s[12:15], s25 offen offset:3072 lds
  v_mfma_f32_16x16x32_bf16 a[88:91], a[180:183], a[196:199], a[88:91]
  v_mfma_f32_16x16x32_bf16 a[88:91], a[184:187], a[200:203], a[88:91]
  s_add_u32 m0, s30, 40960
  s_nop 0
  buffer_load_dwordx4 v21, s[12:15], s25 offen offset:0 lds
  s_waitcnt lgkmcnt(10)
  v_mfma_f32_16x16x32_bf16 a[92:95], a[168:171], a[208:211], a[92:95]
  ds_read_b128 a[228:231], v10 offset:34816
  ds_read_b128 a[232:235], v11 offset:34816
  v_mfma_f32_16x16x32_bf16 a[92:95], a[164:167], a[204:207], a[92:95]
  v_mfma_f32_16x16x32_bf16 a[96:99], a[172:175], a[204:207], a[96:99]
  ds_read_b64_tr_b16 a[160:161], v16 offset:40960
  ds_read_b64_tr_b16 a[162:163], v16 offset:42496
  v_mfma_f32_16x16x32_bf16 a[96:99], a[176:179], a[208:211], a[96:99]
  v_mfma_f32_16x16x32_bf16 a[100:103], a[184:187], a[208:211], a[100:103]
  buffer_load_dwordx4 v22, s[12:15], s25 offen offset:1024 lds
  v_mfma_f32_16x16x32_bf16 a[100:103], a[180:183], a[204:207], a[100:103]
  s_waitcnt lgkmcnt(10)
  v_mfma_f32_16x16x32_bf16 a[104:107], a[164:167], a[212:215], a[104:107]
  s_sub_u32 s54, s54, 1
  s_cmp_eq_u32 s54, 0
  s_cselect_b32 s58, s55, s56
  s_add_u32 s25, s25, s58
  v_mfma_f32_16x16x32_bf16 a[104:107], a[168:171], a[216:219], a[104:107]
  v_mfma_f32_16x16x32_bf16 a[108:111], a[176:179], a[216:219], a[108:111]
  v_mfma_f32_16x16x32_bf16 a[108:111], a[172:175], a[212:215], a[108:111]
  v_mfma_f32_16x16x32_bf16 a[112:115], a[180:183], a[212:215], a[112:115]
  s_waitcnt vmcnt(13) lgkmcnt(0)
  s_barrier
  ds_read_b128 a[188:191], v12 offset:0
  ds_read_b128 a[192:195], v13 offset:0
  v_mfma_f32_16x16x32_bf16 a[112:115], a[184:187], a[216:219], a[112:115]
  s_add_u32 s94, s93, 4096
  buffer_store_dwordx4 v[208:211], v1, s[16:19], s94 offen offset:2048
  v_mfma_f32_16x16x32_bf16 a[116:119], a[168:171], a[224:227], a[116:119]
  ds_read_b128 a[196:199], v12 offset:2048
  ds_read_b128 a[200:203], v13 offset:2048
  v_mfma_f32_16x16x32_bf16 a[116:119], a[164:167], a[220:223], a[116:119]
  v_mfma_f32_16x16x32_bf16 a[120:123], a[172:175], a[220:223], a[120:123]
  s_add_u32 s94, s93, 4096
  buffer_store_dwordx4 v[216:219], v1, s[16:19], s94 offen offset:3072
  v_mfma_f32_16x16x32_bf16 a[120:123], a[176:179], a[224:227], a[120:123]
  v_mfma_f32_16x16x32_bf16 a[124:127], a[184:187], a[224:227], a[124:127]
  v_mfma_f32_16x16x32_bf16 a[124:127], a[180:183], a[220:223], a[124:127]
  s_add_u32 m0, s28, 18432
  s_mov_b32 exec_hi, 0
  buffer_load_dwordx4 v20, s[8:11], s24 offen lds
  s_mov_b32 exec_hi, -1
  v_mfma_f32_16x16x32_bf16 a[128:131], a[164:167], a[228:231], a[128:131]
  ds_read_b128 a[204:207], v12 offset:4096
  ds_read_b128 a[208:211], v13 offset:4096
  v_mfma_f32_16x16x32_bf16 a[128:131], a[168:171], a[232:235], a[128:131]
  v_mfma_f32_16x16x32_bf16 a[132:135], a[176:179], a[232:235], a[132:135]
  v_mfma_f32_16x16x32_bf16 a[132:135], a[172:175], a[228:231], a[132:135]
  s_add_u32 m0, s29, 20480
  s_nop 0
  buffer_load_dwordx4 v2, s[8:11], s23 offen offset:0 lds
  v_mfma_f32_16x16x32_bf16 a[136:139], a[180:183], a[228:231], a[136:139]
  v_mfma_f32_16x16x32_bf16 a[136:139], a[184:187], a[232:235], a[136:139]
  s_waitcnt lgkmcnt(4)
  v_mfma_f32_16x16x32_bf16 a[32:35], a[140:143], a[188:191], a[32:35]
  ds_read_b128 a[212:215], v12 offset:6144
  ds_read_b128 a[216:219], v13 offset:6144
  v_mfma_f32_16x16x32_bf16 a[32:35], a[144:147], a[192:195], a[32:35]
  buffer_load_dwordx4 v3, s[8:11], s23 offen offset:1024 lds
  v_mfma_f32_16x16x32_bf16 a[36:39], a[152:155], a[192:195], a[36:39]
  ds_read_b64_tr_b16 a[164:165], v17 offset:0
  ds_read_b64_tr_b16 a[166:167], v17 offset:1536
  v_mfma_f32_16x16x32_bf16 a[36:39], a[148:151], a[188:191], a[36:39]
  v_mfma_f32_16x16x32_bf16 a[40:43], a[156:159], a[188:191], a[40:43]
  buffer_load_dwordx4 v4, s[8:11], s23 offen offset:2048 lds
  v_mfma_f32_16x16x32_bf16 a[40:43], a[160:163], a[192:195], a[40:43]
  s_waitcnt lgkmcnt(6)
  v_mfma_f32_16x16x32_bf16 a[44:47], a[144:147], a[200:203], a[44:47]
  ds_read_b128 a[220:223], v12 offset:8192
  ds_read_b128 a[224:227], v13 offset:8192
  v_mfma_f32_16x16x32_bf16 a[44:47], a[140:143], a[196:199], a[44:47]
  buffer_load_dwordx4 v5, s[8:11], s23 offen offset:3072 lds
  v_mfma_f32_16x16x32_bf16 a[48:51], a[148:151], a[196:199], a[48:51]
  ds_read_b64_tr_b16 a[172:173], v18 offset:0
  ds_read_b64_tr_b16 a[174:175], v18 offset:1536
  v_mfma_f32_16x16x32_bf16 a[48:51], a[152:155], a[200:203], a[48:51]
  v_mfma_f32_16x16x32_bf16 a[52:55], a[160:163], a[200:203], a[52:55]
  v_mfma_f32_16x16x32_bf16 a[52:55], a[156:159], a[196:199], a[52:55]
  s_sub_u32 s31, s31, 1
  s_cmp_eq_u32 s31, 0
  s_cselect_b32 s58, -1920, s57
  s_add_u32 s23, s23, s58
  s_add_u32 s24, s24, s58
  s_waitcnt lgkmcnt(8)
  v_mfma_f32_16x16x32_bf16 a[56:59], a[140:143], a[204:207], a[56:59]
  ds_read_b128 a[228:231], v12 offset:10240
  ds_read_b128 a[232:235], v13 offset:10240
  v_mfma_f32_16x16x32_bf16 a[56:59], a[144:147], a[208:211], a[56:59]
  v_mfma_f32_16x16x32_bf16 a[60:63], a[152:155], a[208:211], a[60:63]
  ds_read_b64_tr_b16 a[180:181], v19 offset:0
  ds_read_b64_tr_b16 a[182:183], v19 offset:1536
  v_mfma_f32_16x16x32_bf16 a[60:63], a[148:151], a[204:207], a[60:63]
  s_add_u32 m0, s30, 65536
  s_nop 0
  buffer_load_dwordx4 v6, s[12:15], s25 offen offset:0 lds
  v_mfma_f32_16x16x32_bf16 a[64:67], a[156:159], a[204:207], a[64:67]
  v_mfma_f32_16x16x32_bf16 a[64:67], a[160:163], a[208:211], a[64:67]
  s_waitcnt lgkmcnt(10)
  v_mfma_f32_16x16x32_bf16 a[68:71], a[144:147], a[216:219], a[68:71]
  ds_read_b128 a[188:191], v12 offset:12288
  ds_read_b128 a[192:195], v13 offset:12288
  v_mfma_f32_16x16x32_bf16 a[68:71], a[140:143], a[212:215], a[68:71]
  buffer_load_dwordx4 v7, s[12:15], s25 offen offset:1024 lds
  v_mfma_f32_16x16x32_bf16 a[72:75], a[148:151], a[212:215], a[72:75]
  ds_read_b64_tr_b16 a[168:169], v17 offset:12288
  ds_read_b64_tr_b16 a[170:171], v17 offset:13824
  v_mfma_f32_16x16x32_bf16 a[72:75], a[152:155], a[216:219], a[72:75]
  v_mfma_f32_16x16x32_bf16 a[76:79], a[160:163], a[216:219], a[76:79]
  buffer_load_dwordx4 v8, s[12:15], s25 offen offset:2048 lds
  v_mfma_f32_16x16x32_bf16 a[76:79], a[156:159], a[212:215], a[76:79]
  s_waitcnt lgkmcnt(10)
  v_mfma_f32_16x16x32_bf16 a[80:83], a[140:143], a[220:223], a[80:83]
  ds_read_b128 a[196:199], v12 offset:14336
  ds_read_b128 a[200:203], v13 offset:14336
  v_mfma_f32_16x16x32_bf16 a[80:83], a[144:147], a[224:227], a[80:83]
  v_mfma_f32_16x16x32_bf16 a[84:87], a[152:155], a[224:227], a[84:87]
  ds_read_b64_tr_b16 a[176:177], v18 offset:12288
  ds_read_b64_tr_b16 a[178:179], v18 offset:13824
  v_mfma_f32_16x16x32_bf16 a[84:87], a[148:151], a[220:223], a[84:87]
  buffer_load_dwordx4 v9, s[12:15], s25 offen offset:3072 lds
  v_mfma_f32_16x16x32_bf16 a[88:91], a[156:159], a[220:223], a[88:91]
  v_mfma_f32_16x16x32_bf16 a[88:91], a[160:163], a[224:227], a[88:91]
  s_add_u32 m0, s30, 69632
  s_nop 0
  buffer_load_dwordx4 v21, s[12:15], s25 offen offset:0 lds
  s_waitcnt lgkmcnt(10)
  v_mfma_f32_16x16x32_bf16 a[92:95], a[144:147], a[232:235], a[92:95]
  ds_read_b128 a[204:207], v12 offset:16384
  ds_read_b128 a[208:211], v13 offset:16384
  v_mfma_f32_16x16x32_bf16 a[92:95], a[140:143], a[228:231], a[92:95]
  v_mfma_f32_16x16x32_bf16 a[96:99], a[148:151], a[228:231], a[96:99]
  ds_read_b64_tr_b16 a[184:185], v19 offset:12288
  ds_read_b64_tr_b16 a[186:187], v19 offset:13824
  v_mfma_f32_16x16x32_bf16 a[96:99], a[152:155], a[232:235], a[96:99]
  v_mfma_f32_16x16x32_bf16 a[100:103], a[160:163], a[232:235], a[100:103]
  buffer_load_dwordx4 v22, s[12:15], s25 offen offset:1024 lds
  v_mfma_f32_16x16x32_bf16 a[100:103], a[156:159], a[228:231], a[100:103]
  s_waitcnt lgkmcnt(10)
  v_mfma_f32_16x16x32_bf16 a[104:107], a[140:143], a[188:191], a[104:107]
  s_sub_u32 s54, s54, 1
  s_cmp_eq_u32 s54, 0
  s_cselect_b32 s58, s55, s56
  s_add_u32 s25, s25, s58
  v_mfma_f32_16x16x32_bf16 a[104:107], a[144:147], a[192:195], a[104:107]
  v_mfma_f32_16x16x32_bf16 a[108:111], a[152:155], a[192:195], a[108:111]
  v_mfma_f32_16x16x32_bf16 a[108:111], a[148:151], a[188:191], a[108:111]
  v_mfma_f32_16x16x32_bf16 a[112:115], a[156:159], a[188:191], a[112:115]
  s_waitcnt vmcnt(13) lgkmcnt(0)
  s_barrier
  ds_read_b128 a[212:215], v10 offset:0
  ds_read_b128 a[216:219], v11 offset:0
  v_mfma_f32_16x16x32_bf16 a[112:115], a[160:163], a[192:195], a[112:115]
  s_add_u32 s94, s93, 8192
  buffer_store_dwordx4 v[224:227], v1, s[16:19], s94 offen offset:0
  v_mfma_f32_16x16x32_bf16 a[116:119], a[144:147], a[200:203], a[116:119]
  ds_read_b128 a[220:223], v10 offset:2048
  ds_read_b128 a[224:227], v11 offset:2048
  v_mfma_f32_16x16x32_bf16 a[116:119], a[140:143], a[196:199], a[116:119]
  v_mfma_f32_16x16x32_bf16 a[120:123], a[148:151], a[196:199], a[120:123]
  s_add_u32 s94, s93, 8192
  buffer_store_dwordx4 v[232:235], v1, s[16:19], s94 offen offset:1024
  v_mfma_f32_16x16x32_bf16 a[120:123], a[152:155], a[200:203], a[120:123]
  v_mfma_f32_16x16x32_bf16 a[124:127], a[160:163], a[200:203], a[124:127]
  v_mfma_f32_16x16x32_bf16 a[124:127], a[156:159], a[196:199], a[124:127]
  s_add_u32 m0, s28, 131072
  s_mov_b32 exec_hi, 0
  buffer_load_dwordx4 v20, s[8:11], s24 offen lds
  s_mov_b32 exec_hi, -1
  v_mfma_f32_16x16x32_bf16 a[128:131], a[140:143], a[204:207], a[128:131]
  ds_read_b128 a[228:231], v10 offset:4096
  ds_read_b128 a[232:235], v11 offset:4096
  v_mfma_f32_16x16x32_bf16 a[128:131], a[144:147], a[208:211], a[128:131]
  v_mfma_f32_16x16x32_bf16 a[132:135], a[152:155], a[208:211], a[132:135]
  v_mfma_f32_16x16x32_bf16 a[132:135], a[148:151], a[204:207], a[132:135]
  s_add_u32 m0, s29, 133120
  s_nop 0
  buffer_load_dwordx4 v2, s[8:11], s23 offen offset:0 lds
  v_mfma_f32_16x16x32_bf16 a[136:139], a[156:159], a[204:207], a[136:139]
  v_mfma_f32_16x16x32_bf16 a[136:139], a[160:163], a[208:211], a[136:139]
  s_waitcnt lgkmcnt(4)
  v_mfma_f32_16x16x32_bf16 a[32:35], a[164:167], a[212:215], a[32:35]
  ds_read_b128 a[188:191], v10 offset:6144
  ds_read_b128 a[192:195], v11 offset:6144
  v_mfma_f32_16x16x32_bf16 a[32:35], a[168:171], a[216:219], a[32:35]
  buffer_load_dwordx4 v3, s[8:11], s23 offen offset:1024 lds
  v_mfma_f32_16x16x32_bf16 a[36:39], a[176:179], a[216:219], a[36:39]
  ds_read_b64_tr_b16 a[140:141], v14 offset:0
  ds_read_b64_tr_b16 a[142:143], v14 offset:1536
  v_mfma_f32_16x16x32_bf16 a[36:39], a[172:175], a[212:215], a[36:39]
  v_mfma_f32_16x16x32_bf16 a[40:43], a[180:183], a[212:215], a[40:43]
  v_mfma_f32_16x16x32_bf16 a[40:43], a[184:187], a[216:219], a[40:43]
  s_waitcnt lgkmcnt(6)
  v_mfma_f32_16x16x32_bf16 a[44:47], a[168:171], a[224:227], a[44:47]
  ds_read_b128 a[196:199], v10 offset:8192
  ds_read_b128 a[200:203], v11 offset:8192
  v_mfma_f32_16x16x32_bf16 a[44:47], a[164:167], a[220:223], a[44:47]
  v_mfma_f32_16x16x32_bf16 a[48:51], a[172:175], a[220:223], a[48:51]
  ds_read_b64_tr_b16 a[148:149], v15 offset:0
  ds_read_b64_tr_b16 a[150:151], v15 offset:1536
  v_mfma_f32_16x16x32_bf16 a[48:51], a[176:179], a[224:227], a[48:51]
  v_mfma_f32_16x16x32_bf16 a[52:55], a[184:187], a[224:227], a[52:55]
  buffer_load_dwordx4 v4, s[8:11], s23 offen offset:2048 lds
  v_mfma_f32_16x16x32_bf16 a[52:55], a[180:183], a[220:223], a[52:55]
  s_waitcnt lgkmcnt(8)
  v_mfma_f32_16x16x32_bf16 a[56:59], a[164:167], a[228:231], a[56:59]
  ds_read_b128 a[204:207], v10 offset:10240
  ds_read_b128 a[208:211], v11 offset:10240
  v_mfma_f32_16x16x32_bf16 a[56:59], a[168:171], a[232:235], a[56:59]
  v_mfma_f32_16x16x32_bf16 a[60:63], a[176:179], a[232:235], a[60:63]
  ds_read_b64_tr_b16 a[156:157], v16 offset:0
  ds_read_b64_tr_b16 a[158:159], v16 offset:1536
  v_mfma_f32_16x16x32_bf16 a[60:63], a[172:175], a[228:231], a[60:63]
  v_mfma_f32_16x16x32_bf16 a[64:67], a[180:183], a[228:231], a[64:67]
  v_mfma_f32_16x16x32_bf16 a[64:67], a[184:187], a[232:235], a[64:67]
  s_waitcnt lgkmcnt(10)
  v_mfma_f32_16x16x32_bf16 a[68:71], a[168:171], a[192:195], a[68:71]
  ds_read_b128 a[212:215], v10 offset:12288
  ds_read_b128 a[216:219], v11 offset:12288
  v_mfma_f32_16x16x32_bf16 a[68:71], a[164:167], a[188:191], a[68:71]
  v_mfma_f32_16x16x32_bf16 a[72:75], a[172:175], a[188:191], a[72:75]
  ds_read_b64_tr_b16 a[144:145], v14 offset:12288
  ds_read_b64_tr_b16 a[146:147], v14 offset:13824
  v_mfma_f32_16x16x32_bf16 a[72:75], a[176:179], a[192:195], a[72:75]
  buffer_load_dwordx4 v5, s[8:11], s23 offen offset:3072 lds
  v_mfma_f32_16x16x32_bf16 a[76:79], a[184:187], a[192:195], a[76:79]
  v_mfma_f32_16x16x32_bf16 a[76:79], a[180:183], a[188:191], a[76:79]
  s_waitcnt lgkmcnt(10)
  v_mfma_f32_16x16x32_bf16 a[80:83], a[164:167], a[196:199], a[80:83]
  ds_read_b128 a[220:223], v10 offset:14336
  ds_read_b128 a[224:227], v11 offset:14336
  v_mfma_f32_16x16x32_bf16 a[80:83], a[168:171], a[200:203], a[80:83]
  v_mfma_f32_16x16x32_bf16 a[84:87], a[176:179], a[200:203], a[84:87]
  ds_read_b64_tr_b16 a[152:153], v15 offset:12288
  ds_read_b64_tr_b16 a[154:155], v15 offset:13824
  v_mfma_f32_16x16x32_bf16 a[84:87], a[172:175], a[196:199], a[84:87]
  v_mfma_f32_16x16x32_bf16 a[88:91], a[180:183], a[196:199], a[88:91]
  v_mfma_f32_16x16x32_bf16 a[88:91], a[184:187], a[200:203], a[88:91]
  s_waitcnt lgkmcnt(10)
  v_mfma_f32_16x16x32_bf16 a[92:95], a[168:171], a[208:211], a[92:95]
  ds_read_b128 a[228:231], v10 offset:16384
  ds_read_b128 a[232:235], v11 offset:16384
  v_mfma_f32_16x16x32_bf16 a[92:95], a[164:167], a[204:207], a[92:95]
  s_sub_u32 s31, s31, 1
  s_cmp_eq_u32 s31, 0
  s_cselect_b32 s58, -1920, s57
  s_add_u32 s23, s23, s58
  s_add_u32 s24, s24, s58
  v_mfma_f32_16x16x32_bf16 a[96:99], a[172:175], a[204:207], a[96:99]
  ds_read_b64_tr_b16 a[160:161], v16 offset:12288
  ds_read_b64_tr_b16 a[162:163], v16 offset:13824
  v_mfma_f32_16x16x32_bf16 a[96:99], a[176:179], a[208:211], a[96:99]
  v_mfma_f32_16x16x32_bf16 a[100:103], a[184:187], a[208:211], a[100:103]
  v_mfma_f32_16x16x32_bf16 a[100:103], a[180:183], a[204:207], a[100:103]
  s_waitcnt lgkmcnt(10)
  v_mfma_f32_16x16x32_bf16 a[104:107], a[164:167], a[212:215], a[104:107]
  v_mfma_f32_16x16x32_bf16 a[104:107], a[168:171], a[216:219], a[104:107]
  v_mfma_f32_16x16x32_bf16 a[108:111], a[176:179], a[216:219], a[108:111]
  v_mfma_f32_16x16x32_bf16 a[108:111], a[172:175], a[212:215], a[108:111]
  v_mfma_f32_16x16x32_bf16 a[112:115], a[180:183], a[212:215], a[112:115]
  s_waitcnt vmcnt(7) lgkmcnt(0)
  s_barrier
  ds_read_b128 a[188:191], v10 offset:18432
  ds_read_b128 a[192:195], v11 offset:18432
  v_mfma_f32_16x16x32_bf16 a[112:115], a[184:187], a[216:219], a[112:115]
  s_add_u32 s94, s93, 8192
  buffer_store_dwordx4 v[240:243], v1, s[16:19], s94 offen offset:2048
  v_mfma_f32_16x16x32_bf16 a[116:119], a[168:171], a[224:227], a[116:119]
  ds_read_b128 a[196:199], v10 offset:20480
  ds_read_b128 a[200:203], v11 offset:20480
  v_mfma_f32_16x16x32_bf16 a[116:119], a[164:167], a[220:223], a[116:119]
  v_mfma_f32_16x16x32_bf16 a[120:123], a[172:175], a[220:223], a[120:123]
  v_mfma_f32_16x16x32_bf16 a[120:123], a[176:179], a[224:227], a[120:123]
  v_mfma_f32_16x16x32_bf16 a[124:127], a[184:187], a[224:227], a[124:127]
  v_mfma_f32_16x16x32_bf16 a[124:127], a[180:183], a[220:223], a[124:127]
  s_add_u32 s94, s93, 8192
  buffer_store_dwordx4 v[248:251], v1, s[16:19], s94 offen offset:3072
  v_mfma_f32_16x16x32_bf16 a[128:131], a[164:167], a[228:231], a[128:131]
  ds_read_b128 a[204:207], v10 offset:22528
  ds_read_b128 a[208:211], v11 offset:22528
  v_mfma_f32_16x16x32_bf16 a[128:131], a[168:171], a[232:235], a[128:131]
  v_mfma_f32_16x16x32_bf16 a[132:135], a[176:179], a[232:235], a[132:135]
  v_mfma_f32_16x16x32_bf16 a[132:135], a[172:175], a[228:231], a[132:135]
  v_mfma_f32_16x16x32_bf16 a[136:139], a[180:183], a[228:231], a[136:139]
  v_mfma_f32_16x16x32_bf16 a[136:139], a[184:187], a[232:235], a[136:139]
  s_waitcnt lgkmcnt(4)
  v_mfma_f32_16x16x32_bf16 a[32:35], a[140:143], a[188:191], a[32:35]
  ds_read_b128 a[212:215], v10 offset:24576
  ds_read_b128 a[216:219], v11 offset:24576
  v_mfma_f32_16x16x32_bf16 a[32:35], a[144:147], a[192:195], a[32:35]
  v_mfma_f32_16x16x32_bf16 a[36:39], a[152:155], a[192:195], a[36:39]
  ds_read_b64_tr_b16 a[164:165], v14 offset:28672
  ds_read_b64_tr_b16 a[166:167], v14 offset:30208
  v_mfma_f32_16x16x32_bf16 a[36:39], a[148:151], a[188:191], a[36:39]
  v_mfma_f32_16x16x32_bf16 a[40:43], a[156:159], a[188:191], a[40:43]
  v_mfma_f32_16x16x32_bf16 a[40:43], a[160:163], a[192:195], a[40:43]
  s_waitcnt lgkmcnt(6)
  v_mfma_f32_16x16x32_bf16 a[44:47], a[144:147], a[200:203], a[44:47]
  ds_read_b128 a[220:223], v10 offset:26624
  ds_read_b128 a[224:227], v11 offset:26624
  v_mfma_f32_16x16x32_bf16 a[44:47], a[140:143], a[196:199], a[44:47]
  v_mfma_f32_16x16x32_bf16 a[48:51], a[148:151], a[196:199], a[48:51]
  ds_read_b64_tr_b16 a[172:173], v15 offset:28672
  ds_read_b64_tr_b16 a[174:175], v15 offset:30208
  v_mfma_f32_16x16x32_bf16 a[48:51], a[152:155], a[200:203], a[48:51]
  v_mfma_f32_16x16x32_bf16 a[52:55], a[160:163], a[200:203], a[52:55]
  v_mfma_f32_16x16x32_bf16 a[52:55], a[156:159], a[196:199], a[52:55]
  s_waitcnt lgkmcnt(8)
  v_mfma_f32_16x16x32_bf16 a[56:59], a[140:143], a[204:207], a[56:59]
  ds_read_b128 a[228:231], v10 offset:28672
  ds_read_b128 a[232:235], v11 offset:28672
  v_mfma_f32_16x16x32_bf16 a[56:59], a[144:147], a[208:211], a[56:59]
  v_mfma_f32_16x16x32_bf16 a[60:63], a[152:155], a[208:211], a[60:63]
  ds_read_b64_tr_b16 a[180:181], v16 offset:28672
  ds_read_b64_tr_b16 a[182:183], v16 offset:30208
  v_mfma_f32_16x16x32_bf16 a[60:63], a[148:151], a[204:207], a[60:63]
  v_mfma_f32_16x16x32_bf16 a[64:67], a[156:159], a[204:207], a[64:67]
  v_mfma_f32_16x16x32_bf16 a[64:67], a[160:163], a[208:211], a[64:67]
  s_waitcnt lgkmcnt(10)
  v_mfma_f32_16x16x32_bf16 a[68:71], a[144:147], a[216:219], a[68:71]
  ds_read_b128 a[188:191], v10 offset:30720
  ds_read_b128 a[192:195], v11 offset:30720
  v_mfma_f32_16x16x32_bf16 a[68:71], a[140:143], a[212:215], a[68:71]
  v_mfma_f32_16x16x32_bf16 a[72:75], a[148:151], a[212:215], a[72:75]
  ds_read_b64_tr_b16 a[168:169], v14 offset:40960
  ds_read_b64_tr_b16 a[170:171], v14 offset:42496
  v_mfma_f32_16x16x32_bf16 a[72:75], a[152:155], a[216:219], a[72:75]
  v_mfma_f32_16x16x32_bf16 a[76:79], a[160:163], a[216:219], a[76:79]
  v_mfma_f32_16x16x32_bf16 a[76:79], a[156:159], a[212:215], a[76:79]
  s_waitcnt lgkmcnt(10)
  v_mfma_f32_16x16x32_bf16 a[80:83], a[140:143], a[220:223], a[80:83]
  ds_read_b128 a[196:199], v10 offset:32768
  ds_read_b128 a[200:203], v11 offset:32768
  v_mfma_f32_16x16x32_bf16 a[80:83], a[144:147], a[224:227], a[80:83]
  v_mfma_f32_16x16x32_bf16 a[84:87], a[152:155], a[224:227], a[84:87]
  ds_read_b64_tr_b16 a[176:177], v15 offset:40960
  ds_read_b64_tr_b16 a[178:179], v15 offset:42496
  v_mfma_f32_16x16x32_bf16 a[84:87], a[148:151], a[220:223], a[84:87]
  v_mfma_f32_16x16x32_bf16 a[88:91], a[156:159], a[220:223], a[88:91]
  v_mfma_f32_16x16x32_bf16 a[88:91], a[160:163], a[224:227], a[88:91]
  s_waitcnt lgkmcnt(10)
  v_mfma_f32_16x16x32_bf16 a[92:95], a[144:147], a[232:235], a[92:95]
  ds_read_b128 a[204:207], v10 offset:34816
  ds_read_b128 a[208:211], v11 offset:34816
  v_mfma_f32_16x16x32_bf16 a[92:95], a[140:143], a[228:231], a[92:95]
  v_mfma_f32_16x16x32_bf16 a[96:99], a[148:151], a[228:231], a[96:99]
  ds_read_b64_tr_b16 a[184:185], v16 offset:40960
  ds_read_b64_tr_b16 a[186:187], v16 offset:42496
  v_mfma_f32_16x16x32_bf16 a[96:99], a[152:155], a[232:235], a[96:99]
  v_mfma_f32_16x16x32_bf16 a[100:103], a[160:163], a[232:235], a[100:103]
  v_mfma_f32_16x16x32_bf16 a[100:103], a[156:159], a[228:231], a[100:103]
  s_waitcnt lgkmcnt(10)
  v_mfma_f32_16x16x32_bf16 a[104:107], a[140:143], a[188:191], a[104:107]
  v_mfma_f32_16x16x32_bf16 a[104:107], a[144:147], a[192:195], a[104:107]
  v_mfma_f32_16x16x32_bf16 a[108:111], a[152:155], a[192:195], a[108:111]
  v_mfma_f32_16x16x32_bf16 a[108:111], a[148:151], a[188:191], a[108:111]
  v_mfma_f32_16x16x32_bf16 a[112:115], a[156:159], a[188:191], a[112:115]
  s_waitcnt vmcnt(2) lgkmcnt(0)
  s_barrier
  ds_read_b128 a[212:215], v12 offset:0
  ds_read_b128 a[216:219], v13 offset:0
  v_mfma_f32_16x16x32_bf16 a[112:115], a[160:163], a[192:195], a[112:115]
  s_add_u32 s94, s93, 12288
  buffer_store_dwordx4 v[36:39], v1, s[16:19], s94 offen offset:0
  v_mfma_f32_16x16x32_bf16 a[116:119], a[144:147], a[200:203], a[116:119]
  ds_read_b128 a[220:223], v12 offset:2048
  ds_read_b128 a[224:227], v13 offset:2048
  v_mfma_f32_16x16x32_bf16 a[116:119], a[140:143], a[196:199], a[116:119]
  v_mfma_f32_16x16x32_bf16 a[120:123], a[148:151], a[196:199], a[120:123]
  v_mfma_f32_16x16x32_bf16 a[120:123], a[152:155], a[200:203], a[120:123]
  v_mfma_f32_16x16x32_bf16 a[124:127], a[160:163], a[200:203], a[124:127]
  v_mfma_f32_16x16x32_bf16 a[124:127], a[156:159], a[196:199], a[124:127]
  s_add_u32 s94, s93, 12288
  buffer_store_dwordx4 v[44:47], v1, s[16:19], s94 offen offset:1024
  v_mfma_f32_16x16x32_bf16 a[128:131], a[140:143], a[204:207], a[128:131]
  ds_read_b128 a[228:231], v12 offset:4096
  ds_read_b128 a[232:235], v13 offset:4096
  v_mfma_f32_16x16x32_bf16 a[128:131], a[144:147], a[208:211], a[128:131]
  v_mfma_f32_16x16x32_bf16 a[132:135], a[152:155], a[208:211], a[132:135]
  v_mfma_f32_16x16x32_bf16 a[132:135], a[148:151], a[204:207], a[132:135]
  v_mfma_f32_16x16x32_bf16 a[136:139], a[156:159], a[204:207], a[136:139]
  v_mfma_f32_16x16x32_bf16 a[136:139], a[160:163], a[208:211], a[136:139]
  s_waitcnt lgkmcnt(4)
  v_and_b32 v24, 15, v0
  v_mul_u32_u24 v24, 400, v24
  v_lshrrev_b32 v25, 4, v0
  v_lshl_add_u32 v24, v25, 3, v24
  s_mul_i32 s3, s20, 96
  v_add_u32 v2, s3, v24
  v_mfma_f32_16x16x32_bf16 a[32:35], a[164:167], a[212:215], a[32:35]
  ds_read_b128 a[188:191], v12 offset:6144
  ds_read_b128 a[192:195], v13 offset:6144
  v_mfma_f32_16x16x32_bf16 a[32:35], a[168:171], a[216:219], a[32:35]
  v_mfma_f32_16x16x32_bf16 a[36:39], a[176:179], a[216:219], a[36:39]
  v_mfma_f32_16x16x32_bf16 a[36:39], a[172:175], a[212:215], a[36:39]
  v_mfma_f32_16x16x32_bf16 a[40:43], a[180:183], a[212:215], a[40:43]
  v_mfma_f32_16x16x32_bf16 a[40:43], a[184:187], a[216:219], a[40:43]
  s_waitcnt lgkmcnt(4)
  v_mfma_f32_16x16x32_bf16 a[44:47], a[168:171], a[224:227], a[44:47]
  ds_read_b128 a[196:199], v12 offset:8192
  ds_read_b128 a[200:203], v13 offset:8192
  v_mfma_f32_16x16x32_bf16 a[44:47], a[164:167], a[220:223], a[44:47]
  v_mfma_f32_16x16x32_bf16 a[48:51], a[172:175], a[220:223], a[48:51]
  v_mfma_f32_16x16x32_bf16 a[48:51], a[176:179], a[224:227], a[48:51]
  v_mfma_f32_16x16x32_bf16 a[52:55], a[184:187], a[224:227], a[52:55]
  v_mfma_f32_16x16x32_bf16 a[52:55], a[180:183], a[220:223], a[52:55]
  s_waitcnt lgkmcnt(4)
  v_mfma_f32_16x16x32_bf16 a[56:59], a[164:167], a[228:231], a[56:59]
  ds_read_b128 a[204:207], v12 offset:10240
  ds_read_b128 a[208:211], v13 offset:10240
  v_accvgpr_read_b32 v24, a32
  v_accvgpr_read_b32 v25, a33
  v_accvgpr_read_b32 v26, a34
  v_mfma_f32_16x16x32_bf16 a[56:59], a[168:171], a[232:235], a[56:59]
  v_accvgpr_read_b32 v27, a35
  v_cvt_pk_bf16_f32 v24, v24, v25
  v_cvt_pk_bf16_f32 v25, v26, v27
  ds_write_b64 v2, v[24:25] offset:0
  v_mfma_f32_16x16x32_bf16 a[60:63], a[176:179], a[232:235], a[60:63]
  v_accvgpr_read_b32 v28, a36
  v_accvgpr_read_b32 v29, a37
  v_accvgpr_read_b32 v30, a38
  v_mfma_f32_16x16x32_bf16 a[60:63], a[172:175], a[228:231], a[60:63]
  v_accvgpr_read_b32 v31, a39
  v_cvt_pk_bf16_f32 v28, v28, v29
  v_cvt_pk_bf16_f32 v29, v30, v31
  ds_write_b64 v2, v[28:29] offset:32
  v_mfma_f32_16x16x32_bf16 a[64:67], a[180:183], a[228:231], a[64:67]
  v_accvgpr_read_b32 v24, a40
  v_accvgpr_read_b32 v25, a41
  v_accvgpr_read_b32 v26, a42
  v_mfma_f32_16x16x32_bf16 a[64:67], a[184:187], a[232:235], a[64:67]
  s_waitcnt lgkmcnt(6)
  v_accvgpr_read_b32 v27, a43
  v_cvt_pk_bf16_f32 v24, v24, v25
  v_cvt_pk_bf16_f32 v25, v26, v27
  ds_write_b64 v2, v[24:25] offset:64
  v_mfma_f32_16x16x32_bf16 a[68:71], a[168:171], a[192:195], a[68:71]
  ds_read_b128 a[212:215], v12 offset:12288
  ds_read_b128 a[216:219], v13 offset:12288
  v_accvgpr_read_b32 v24, a44
  v_accvgpr_read_b32 v25, a45
  v_accvgpr_read_b32 v26, a46
  v_mfma_f32_16x16x32_bf16 a[68:71], a[164:167], a[188:191], a[68:71]
  v_accvgpr_read_b32 v27, a47
  v_cvt_pk_bf16_f32 v24, v24, v25
  v_cvt_pk_bf16_f32 v25, v26, v27
  ds_write_b64 v2, v[24:25] offset:6400
  v_mfma_f32_16x16x32_bf16 a[72:75], a[172:175], a[188:191], a[72:75]
  v_accvgpr_read_b32 v28, a48
  v_accvgpr_read_b32 v29, a49
  v_accvgpr_read_b32 v30, a50
  v_mfma_f32_16x16x32_bf16 a[72:75], a[176:179], a[192:195], a[72:75]
  v_accvgpr_read_b32 v31, a51
  v_cvt_pk_bf16_f32 v28, v28, v29
  v_cvt_pk_bf16_f32 v29, v30, v31
  ds_write_b64 v2, v[28:29] offset:6432
  v_mfma_f32_16x16x32_bf16 a[76:79], a[184:187], a[192:195], a[76:79]
  v_accvgpr_read_b32 v24, a52
  v_accvgpr_read_b32 v25, a53
  v_accvgpr_read_b32 v26, a54
  v_mfma_f32_16x16x32_bf16 a[76:79], a[180:183], a[188:191], a[76:79]
  s_waitcnt lgkmcnt(9)
  v_accvgpr_read_b32 v27, a55
  v_cvt_pk_bf16_f32 v24, v24, v25
  v_cvt_pk_bf16_f32 v25, v26, v27
  ds_write_b64 v2, v[24:25] offset:6464
  v_mfma_f32_16x16x32_bf16 a[80:83], a[164:167], a[196:199], a[80:83]
  ds_read_b128 a[220:223], v12 offset:14336
  ds_read_b128 a[224:227], v13 offset:14336
  v_accvgpr_read_b32 v24, a56
  v_accvgpr_read_b32 v25, a57
  v_accvgpr_read_b32 v26, a58
  v_mfma_f32_16x16x32_bf16 a[80:83], a[168:171], a[200:203], a[80:83]
  v_accvgpr_read_b32 v27, a59
  v_cvt_pk_bf16_f32 v24, v24, v25
  v_cvt_pk_bf16_f32 v25, v26, v27
  ds_write_b64 v2, v[24:25] offset:12800
  v_mfma_f32_16x16x32_bf16 a[84:87], a[176:179], a[200:203], a[84:87]
  v_accvgpr_read_b32 v28, a60
  v_accvgpr_read_b32 v29, a61
  v_accvgpr_read_b32 v30, a62
  v_mfma_f32_16x16x32_bf16 a[84:87], a[172:175], a[196:199], a[84:87]
  v_accvgpr_read_b32 v31, a63
  v_cvt_pk_bf16_f32 v28, v28, v29
  v_cvt_pk_bf16_f32 v29, v30, v31
  ds_write_b64 v2, v[28:29] offset:12832
  v_mfma_f32_16x16x32_bf16 a[88:91], a[180:183], a[196:199], a[88:91]
  v_accvgpr_read_b32 v24, a64
  v_accvgpr_read_b32 v25, a65
  v_accvgpr_read_b32 v26, a66
  v_mfma_f32_16x16x32_bf16 a[88:91], a[184:187], a[200:203], a[88:91]
  s_waitcnt lgkmcnt(12)
  v_accvgpr_read_b32 v27, a67
  v_cvt_pk_bf16_f32 v24, v24, v25
  v_cvt_pk_bf16_f32 v25, v26, v27
  ds_write_b64 v2, v[24:25] offset:12864
  v_mfma_f32_16x16x32_bf16 a[92:95], a[168:171], a[208:211], a[92:95]
  ds_read_b128 a[228:231], v12 offset:16384
  ds_read_b128 a[232:235], v13 offset:16384
  v_accvgpr_read_b32 v24, a68
  v_accvgpr_read_b32 v25, a69
  v_accvgpr_read_b32 v26, a70
  v_mfma_f32_16x16x32_bf16 a[92:95], a[164:167], a[204:207], a[92:95]
  v_accvgpr_read_b32 v27, a71
  v_cvt_pk_bf16_f32 v24, v24, v25
  v_cvt_pk_bf16_f32 v25, v26, v27
  ds_write_b64 v2, v[24:25] offset:19200
  v_mfma_f32_16x16x32_bf16 a[96:99], a[172:175], a[204:207], a[96:99]
  v_accvgpr_read_b32 v28, a72
  v_accvgpr_read_b32 v29, a73
  v_accvgpr_read_b32 v30, a74
  v_mfma_f32_16x16x32_bf16 a[96:99], a[176:179], a[208:211], a[96:99]
  v_accvgpr_read_b32 v31, a75
  v_cvt_pk_bf16_f32 v28, v28, v29
  v_cvt_pk_bf16_f32 v29, v30, v31
  ds_write_b64 v2, v[28:29] offset:19232
  v_mfma_f32_16x16x32_bf16 a[100:103], a[184:187], a[208:211], a[100:103]
  v_accvgpr_read_b32 v24, a76
  v_accvgpr_read_b32 v25, a77
  v_accvgpr_read_b32 v26, a78
  v_mfma_f32_16x16x32_bf16 a[100:103], a[180:183], a[204:207], a[100:103]
  s_waitcnt lgkmcnt(12)
  v_accvgpr_read_b32 v27, a79
  v_cvt_pk_bf16_f32 v24, v24, v25
  v_cvt_pk_bf16_f32 v25, v26, v27
  ds_write_b64 v2, v[24:25] offset:19264
  v_mfma_f32_16x16x32_bf16 a[104:107], a[164:167], a[212:215], a[104:107]
  v_accvgpr_read_b32 v24, a80
  v_accvgpr_read_b32 v25, a81
  v_accvgpr_read_b32 v26, a82
  v_mfma_f32_16x16x32_bf16 a[104:107], a[168:171], a[216:219], a[104:107]
  v_accvgpr_read_b32 v27, a83
  v_cvt_pk_bf16_f32 v24, v24, v25
  v_cvt_pk_bf16_f32 v25, v26, v27
  ds_write_b64 v2, v[24:25] offset:25600
  v_mfma_f32_16x16x32_bf16 a[108:111], a[176:179], a[216:219], a[108:111]
  v_accvgpr_read_b32 v28, a84
  v_accvgpr_read_b32 v29, a85
  v_accvgpr_read_b32 v30, a86
  v_mfma_f32_16x16x32_bf16 a[108:111], a[172:175], a[212:215], a[108:111]
  v_accvgpr_read_b32 v31, a87
  v_cvt_pk_bf16_f32 v28, v28, v29
  v_cvt_pk_bf16_f32 v29, v30, v31
  ds_write_b64 v2, v[28:29] offset:25632
  v_mfma_f32_16x16x32_bf16 a[112:115], a[180:183], a[212:215], a[112:115]
  v_accvgpr_read_b32 v24, a88
  v_accvgpr_read_b32 v25, a89
  v_accvgpr_read_b32 v26, a90
  v_mfma_f32_16x16x32_bf16 a[112:115], a[184:187], a[216:219], a[112:115]
  s_add_u32 s94, s93, 12288
  buffer_store_dwordx4 v[52:55], v1, s[16:19], s94 offen offset:2048
  s_waitcnt lgkmcnt(10)
  v_accvgpr_read_b32 v27, a91
  v_cvt_pk_bf16_f32 v24, v24, v25
  v_cvt_pk_bf16_f32 v25, v26, v27
  ds_write_b64 v2, v[24:25] offset:25664
  v_mfma_f32_16x16x32_bf16 a[116:119], a[168:171], a[224:227], a[116:119]
  v_accvgpr_read_b32 v24, a92
  v_accvgpr_read_b32 v25, a93
  v_accvgpr_read_b32 v26, a94
  v_mfma_f32_16x16x32_bf16 a[116:119], a[164:167], a[220:223], a[116:119]
  v_accvgpr_read_b32 v27, a95
  v_cvt_pk_bf16_f32 v24, v24, v25
  v_cvt_pk_bf16_f32 v25, v26, v27
  ds_write_b64 v2, v[24:25] offset:32000
  v_mfma_f32_16x16x32_bf16 a[120:123], a[172:175], a[220:223], a[120:123]
  v_accvgpr_read_b32 v28, a96
  v_accvgpr_read_b32 v29, a97
  v_accvgpr_read_b32 v30, a98
  v_mfma_f32_16x16x32_bf16 a[120:123], a[176:179], a[224:227], a[120:123]
  v_accvgpr_read_b32 v31, a99
  v_cvt_pk_bf16_f32 v28, v28, v29
  v_cvt_pk_bf16_f32 v29, v30, v31
  ds_write_b64 v2, v[28:29] offset:32032
  v_mfma_f32_16x16x32_bf16 a[124:127], a[184:187], a[224:227], a[124:127]
  v_accvgpr_read_b32 v24, a100
  v_accvgpr_read_b32 v25, a101
  v_accvgpr_read_b32 v26, a102
  v_mfma_f32_16x16x32_bf16 a[124:127], a[180:183], a[220:223], a[124:127]
  s_add_u32 s94, s93, 12288
  buffer_store_dwordx4 v[60:63], v1, s[16:19], s94 offen offset:3072
  s_waitcnt lgkmcnt(8)
  v_accvgpr_read_b32 v27, a103
  v_cvt_pk_bf16_f32 v24, v24, v25
  v_cvt_pk_bf16_f32 v25, v26, v27
  ds_write_b64 v2, v[24:25] offset:32064
  v_mfma_f32_16x16x32_bf16 a[128:131], a[164:167], a[228:231], a[128:131]
  v_accvgpr_read_b32 v24, a104
  v_accvgpr_read_b32 v25, a105
  v_accvgpr_read_b32 v26, a106
  v_mfma_f32_16x16x32_bf16 a[128:131], a[168:171], a[232:235], a[128:131]
  v_accvgpr_read_b32 v27, a107
  v_cvt_pk_bf16_f32 v24, v24, v25
  v_cvt_pk_bf16_f32 v25, v26, v27
  ds_write_b64 v2, v[24:25] offset:38400
  v_mfma_f32_16x16x32_bf16 a[132:135], a[176:179], a[232:235], a[132:135]
  v_accvgpr_read_b32 v28, a108
  v_accvgpr_read_b32 v29, a109
  v_accvgpr_read_b32 v30, a110
  v_mfma_f32_16x16x32_bf16 a[132:135], a[172:175], a[228:231], a[132:135]
  v_accvgpr_read_b32 v31, a111
  v_cvt_pk_bf16_f32 v28, v28, v29
  v_cvt_pk_bf16_f32 v29, v30, v31
  ds_write_b64 v2, v[28:29] offset:38432
  v_mfma_f32_16x16x32_bf16 a[136:139], a[180:183], a[228:231], a[136:139]
  v_accvgpr_read_b32 v24, a112
  v_accvgpr_read_b32 v25, a113
  v_accvgpr_read_b32 v26, a114
  v_mfma_f32_16x16x32_bf16 a[136:139], a[184:187], a[232:235], a[136:139]
  v_accvgpr_read_b32 v27, a115
  v_cvt_pk_bf16_f32 v24, v24, v25
  v_cvt_pk_bf16_f32 v25, v26, v27
  ds_write_b64 v2, v[24:25] offset:38464
  v_accvgpr_read_b32 v24, a116
  v_accvgpr_read_b32 v25, a117
  v_accvgpr_read_b32 v26, a118
  v_accvgpr_read_b32 v27, a119
  v_cvt_pk_bf16_f32 v24, v24, v25
  v_cvt_pk_bf16_f32 v25, v26, v27
  ds_write_b64 v2, v[24:25] offset:44800
  v_accvgpr_read_b32 v28, a120
  v_accvgpr_read_b32 v29, a121
  v_accvgpr_read_b32 v30, a122
  v_accvgpr_read_b32 v31, a123
  v_cvt_pk_bf16_f32 v28, v28, v29
  v_cvt_pk_bf16_f32 v29, v30, v31
  ds_write_b64 v2, v[28:29] offset:44832
  v_accvgpr_read_b32 v24, a124
  v_accvgpr_read_b32 v25, a125
  v_accvgpr_read_b32 v26, a126
  v_accvgpr_read_b32 v27, a127
  v_cvt_pk_bf16_f32 v24, v24, v25
  v_cvt_pk_bf16_f32 v25, v26, v27
  ds_write_b64 v2, v[24:25] offset:44864
  v_accvgpr_read_b32 v24, a128
  v_accvgpr_read_b32 v25, a129
  v_accvgpr_read_b32 v26, a130
  v_accvgpr_read_b32 v27, a131
  v_cvt_pk_bf16_f32 v24, v24, v25
  v_cvt_pk_bf16_f32 v25, v26, v27
  ds_write_b64 v2, v[24:25] offset:51200
  v_accvgpr_read_b32 v28, a132
  v_accvgpr_read_b32 v29, a133
  v_accvgpr_read_b32 v30, a134
  v_accvgpr_read_b32 v31, a135
  v_cvt_pk_bf16_f32 v28, v28, v29
  v_cvt_pk_bf16_f32 v29, v30, v31
  ds_write_b64 v2, v[28:29] offset:51232
  v_accvgpr_read_b32 v24, a136
  v_accvgpr_read_b32 v25, a137
  v_accvgpr_read_b32 v26, a138
  v_accvgpr_read_b32 v27, a139
  v_cvt_pk_bf16_f32 v24, v24, v25
  v_cvt_pk_bf16_f32 v25, v26, v27
  ds_write_b64 v2, v[24:25] offset:51264
  v_and_b32 v24, 15, v0
  v_lshrrev_b32 v25, 4, v0
  s_add_u32 s3, s21, 16
  v_lshl_add_u32 v26, v24, 1, s3
  s_lshl_b32 s4, s22, 6
  v_mul_u32_u24 v2, 400, v26
  v_lshl_add_u32 v2, v25, 4, v2
  v_add_u32 v2, s4, v2
  v_subrev_u32 v26, 32, v26
  v_max_i32 v26, 0, v26
  v_mul_u32_u24 v3, 400, v26
  v_lshl_add_u32 v3, v25, 4, v3
  v_add_u32 v3, s4, v3
  v_bfe_u32 v27, v0, 2, 2
  v_lshl_add_u32 v27, v25, 2, v27
  v_lshl_add_u32 v27, v27, 1, s3
  v_and_b32 v28, 3, v0
  v_lshlrev_b32 v28, 3, v28
  v_add_u32 v28, s4, v28
  s_movk_i32 s5, 400
  v_mad_u32_u24 v4, v27, s5, v28
  v_subrev_u32 v27, 32, v27
  v_max_i32 v27, 0, v27
  v_mad_u32_u24 v5, v27, s5, v28
  v_lshlrev_b32 v25, 2, v25
  v_sub_u32 v24, v24, v25
  v_mov_b32 v25, 0xf149f2ca
  s_cmp_eq_u32 s26, 0
  s_cselect_b32 s3, 0xf149f2ca, 0
  v_cmp_lt_i32 vcc, -9, v24
  s_nop 1
  v_cndmask_b32 v8, 0, v25, vcc
  v_subrev_u32 v26, 0, v24
  v_cmp_lt_u32 vcc, 7, v26
  s_nop 1
  v_cndmask_b32 v12, 0, v25, vcc
  v_min_f32 v16, s3, v8
  v_mov_b32 v20, 0x3f803f80
  v_cmp_lt_i32 vcc, -8, v24
  s_nop 1
  v_cndmask_b32 v9, 0, v25, vcc
  v_subrev_u32 v26, 1, v24
  v_cmp_lt_u32 vcc, 7, v26
  s_nop 1
  v_cndmask_b32 v13, 0, v25, vcc
  v_min_f32 v17, s3, v9
  v_mov_b32 v21, 0x3f803f80
  v_cmp_lt_i32 vcc, -7, v24
  s_nop 1
  v_cndmask_b32 v10, 0, v25, vcc
  v_subrev_u32 v26, 2, v24
  v_cmp_lt_u32 vcc, 7, v26
  s_nop 1
  v_cndmask_b32 v14, 0, v25, vcc
  v_min_f32 v18, s3, v10
  v_mov_b32 v22, 0x3f803f80
  v_cmp_lt_i32 vcc, -6, v24
  s_nop 1
  v_cndmask_b32 v11, 0, v25, vcc
  v_subrev_u32 v26, 3, v24
  v_cmp_lt_u32 vcc, 7, v26
  s_nop 1
  v_cndmask_b32 v15, 0, v25, vcc
  v_min_f32 v19, s3, v11
  v_mov_b32 v23, 0x3f803f80
  s_add_u32 s16, s50, 83886080
  s_addc_u32 s17, s51, 0
  s_mov_b32 s18, 4194304
  s_mov_b32 s19, 0x00020000
  s_lshl_b32 s3, s26, 18
  s_lshl_b32 s4, s27, 14
  s_add_u32 s3, s3, s4
  s_lshl_b32 s4, s21, 13
  s_add_u32 s3, s3, s4
  s_lshl_b32 s4, s22, 10
  s_add_u32 s6, s3, s4
  s_mov_b32 s7, 0x3e8293ee
  s_waitcnt lgkmcnt(0)
  s_barrier
  ds_read_b128 v[48:51], v3 offset:128
  ds_read_b128 v[32:35], v2 offset:0
  ds_read_b128 v[52:55], v2 offset:128
  ds_read_b128 v[36:39], v2 offset:12800
  ds_read_b128 v[56:59], v2 offset:12928
  ds_read_b128 v[40:43], v2 offset:25600
  ds_read_b128 v[60:63], v2 offset:25728
  ds_read_b128 v[44:47], v2 offset:38400
  ds_read_b128 v[64:67], v2 offset:38528
  ds_read_b64_tr_b16 v[68:69], v5 offset:256
  ds_read_b64_tr_b16 v[70:71], v4 offset:256
  ds_read_b64_tr_b16 v[72:73], v4 offset:13056
  ds_read_b64_tr_b16 v[74:75], v4 offset:25856
  ds_read_b64_tr_b16 v[76:77], v4 offset:38656
  ds_read_b64_tr_b16 v[78:79], v5 offset:288
  ds_read_b64_tr_b16 v[80:81], v4 offset:288
  ds_read_b64_tr_b16 v[82:83], v4 offset:13088
  ds_read_b64_tr_b16 v[84:85], v4 offset:25888
  ds_read_b64_tr_b16 v[86:87], v4 offset:38688
  s_waitcnt lgkmcnt(15)
  v_mfma_f32_16x16x32_bf16 v[88:91], v[48:51], v[32:35], v[16:19]
  v_mfma_f32_16x16x32_bf16 v[92:95], v[52:55], v[32:35], v[12:15]
  v_mfma_f32_16x16x32_bf16 v[96:99], v[52:55], v[36:39], v[8:11]
  s_waitcnt lgkmcnt(14)
  v_mfma_f32_16x16x32_bf16 v[100:103], v[56:59], v[36:39], v[12:15]
  s_waitcnt lgkmcnt(13)
  v_mfma_f32_16x16x32_bf16 v[104:107], v[56:59], v[40:43], v[8:11]
  s_waitcnt lgkmcnt(12)
  v_mfma_f32_16x16x32_bf16 v[108:111], v[60:63], v[40:43], v[12:15]
  s_waitcnt lgkmcnt(11)
  v_mfma_f32_16x16x32_bf16 v[112:115], v[60:63], v[44:47], v[8:11]
  s_waitcnt lgkmcnt(10)
  v_mfma_f32_16x16x32_bf16 v[116:119], v[64:67], v[44:47], v[12:15]
  v_max3_f32 v168, v88, v89, v90
  v_max3_f32 v168, v168, v91, v92
  v_max3_f32 v168, v168, v93, v94
  v_max_f32 v168, v168, v95
  v_max3_f32 v169, v96, v97, v98
  v_max3_f32 v169, v169, v99, v100
  v_max3_f32 v169, v169, v101, v102
  v_max_f32 v169, v169, v103
  v_max3_f32 v170, v104, v105, v106
  v_max3_f32 v170, v170, v107, v108
  v_max3_f32 v170, v170, v109, v110
  v_max_f32 v170, v170, v111
  v_max3_f32 v171, v112, v113, v114
  v_max3_f32 v171, v171, v115, v116
  v_max3_f32 v171, v171, v117, v118
  v_max_f32 v171, v171, v119
  v_mov_b32 v172, v168
  v_mov_b32 v173, v169
  v_mov_b32 v174, v170
  v_mov_b32 v175, v171
  v_permlane16_swap_b32 v168, v172
  v_permlane16_swap_b32 v169, v173
  v_permlane16_swap_b32 v170, v174
  v_permlane16_swap_b32 v171, v175
  v_max_f32 v168, v168, v172
  v_max_f32 v169, v169, v173
  v_max_f32 v170, v170, v174
  v_max_f32 v171, v171, v175
  v_mov_b32 v172, v168
  v_mov_b32 v173, v169
  v_mov_b32 v174, v170
  v_mov_b32 v175, v171
  v_permlane32_swap_b32 v168, v172
  v_permlane32_swap_b32 v169, v173
  v_permlane32_swap_b32 v170, v174
  v_permlane32_swap_b32 v171, v175
  v_max_f32 v168, v168, v172
  v_max_f32 v169, v169, v173
  v_max_f32 v170, v170, v174
  v_max_f32 v171, v171, v175
  v_mul_f32 v168, s7, v168
  v_mul_f32 v169, s7, v169
  v_mul_f32 v170, s7, v170
  v_mul_f32 v171, s7, v171
  v_fma_f32 v88, v88, s7, -v168
  v_fma_f32 v89, v89, s7, -v168
  v_fma_f32 v90, v90, s7, -v168
  v_fma_f32 v91, v91, s7, -v168
  v_fma_f32 v92, v92, s7, -v168
  v_fma_f32 v93, v93, s7, -v168
  v_fma_f32 v94, v94, s7, -v168
  v_fma_f32 v95, v95, s7, -v168
  v_exp_f32 v88, v88
  v_exp_f32 v89, v89
  v_exp_f32 v90, v90
  v_exp_f32 v91, v91
  v_exp_f32 v92, v92
  v_exp_f32 v93, v93
  v_exp_f32 v94, v94
  v_exp_f32 v95, v95
  v_fma_f32 v96, v96, s7, -v169
  v_fma_f32 v97, v97, s7, -v169
  v_fma_f32 v98, v98, s7, -v169
  v_fma_f32 v99, v99, s7, -v169
  v_fma_f32 v100, v100, s7, -v169
  v_fma_f32 v101, v101, s7, -v169
  v_fma_f32 v102, v102, s7, -v169
  v_fma_f32 v103, v103, s7, -v169
  v_exp_f32 v96, v96
  v_exp_f32 v97, v97
  v_exp_f32 v98, v98
  v_exp_f32 v99, v99
  v_exp_f32 v100, v100
  v_exp_f32 v101, v101
  v_exp_f32 v102, v102
  v_exp_f32 v103, v103
  v_fma_f32 v104, v104, s7, -v170
  v_fma_f32 v105, v105, s7, -v170
  v_fma_f32 v106, v106, s7, -v170
  v_fma_f32 v107, v107, s7, -v170
  v_fma_f32 v108, v108, s7, -v170
  v_fma_f32 v109, v109, s7, -v170
  v_fma_f32 v110, v110, s7, -v170
  v_fma_f32 v111, v111, s7, -v170
  v_exp_f32 v104, v104
  v_exp_f32 v105, v105
  v_exp_f32 v106, v106
  v_exp_f32 v107, v107
  v_exp_f32 v108, v108
  v_exp_f32 v109, v109
  v_exp_f32 v110, v110
  v_exp_f32 v111, v111
  v_fma_f32 v112, v112, s7, -v171
  v_fma_f32 v113, v113, s7, -v171
  v_fma_f32 v114, v114, s7, -v171
  v_fma_f32 v115, v115, s7, -v171
  v_fma_f32 v116, v116, s7, -v171
  v_fma_f32 v117, v117, s7, -v171
  v_fma_f32 v118, v118, s7, -v171
  v_fma_f32 v119, v119, s7, -v171
  v_exp_f32 v112, v112
  v_exp_f32 v113, v113
  v_exp_f32 v114, v114
  v_exp_f32 v115, v115
  v_exp_f32 v116, v116
  v_exp_f32 v117, v117
  v_exp_f32 v118, v118
  v_exp_f32 v119, v119
  v_cvt_pk_bf16_f32 v88, v88, v89
  v_cvt_pk_bf16_f32 v89, v90, v91
  v_cvt_pk_bf16_f32 v90, v92, v93
  v_cvt_pk_bf16_f32 v91, v94, v95
  v_cvt_pk_bf16_f32 v96, v96, v97
  v_cvt_pk_bf16_f32 v97, v98, v99
  v_cvt_pk_bf16_f32 v98, v100, v101
  v_cvt_pk_bf16_f32 v99, v102, v103
  v_cvt_pk_bf16_f32 v104, v104, v105
  v_cvt_pk_bf16_f32 v105, v106, v107
  v_cvt_pk_bf16_f32 v106, v108, v109
  v_cvt_pk_bf16_f32 v107, v110, v111
  v_cvt_pk_bf16_f32 v112, v112, v113
  v_cvt_pk_bf16_f32 v113, v114, v115
  v_cvt_pk_bf16_f32 v114, v116, v117
  v_cvt_pk_bf16_f32 v115, v118, v119
  v_mfma_f32_16x16x32_bf16 v[152:155], v[20:23], v[88:91], 0
  s_waitcnt lgkmcnt(8)
  v_mfma_f32_16x16x32_bf16 v[120:123], v[68:71], v[88:91], 0
  s_waitcnt lgkmcnt(3)
  v_mfma_f32_16x16x32_bf16 v[124:127], v[78:81], v[88:91], 0
  v_mfma_f32_16x16x32_bf16 v[156:159], v[20:23], v[96:99], 0
  v_mfma_f32_16x16x32_bf16 v[128:131], v[70:73], v[96:99], 0
  s_waitcnt lgkmcnt(2)
  v_mfma_f32_16x16x32_bf16 v[132:135], v[80:83], v[96:99], 0
  v_mfma_f32_16x16x32_bf16 v[160:163], v[20:23], v[104:107], 0
  v_mfma_f32_16x16x32_bf16 v[136:139], v[72:75], v[104:107], 0
  s_waitcnt lgkmcnt(1)
  v_mfma_f32_16x16x32_bf16 v[140:143], v[82:85], v[104:107], 0
  v_mfma_f32_16x16x32_bf16 v[164:167], v[20:23], v[112:115], 0
  v_mfma_f32_16x16x32_bf16 v[144:147], v[74:77], v[112:115], 0
  s_waitcnt lgkmcnt(0)
  v_mfma_f32_16x16x32_bf16 v[148:151], v[84:87], v[112:115], 0
  v_rcp_f32 v152, v152
  v_rcp_f32 v156, v156
  v_rcp_f32 v160, v160
  s_nop 1
  v_rcp_f32 v164, v164
  v_pk_mul_f32 v[120:121], v[120:121], v[152:153] op_sel_hi:[1,0]
  v_pk_mul_f32 v[122:123], v[122:123], v[152:153] op_sel_hi:[1,0]
  v_pk_mul_f32 v[124:125], v[124:125], v[152:153] op_sel_hi:[1,0]
  v_pk_mul_f32 v[126:127], v[126:127], v[152:153] op_sel_hi:[1,0]
  v_cvt_pk_bf16_f32 v120, v120, v121
  v_cvt_pk_bf16_f32 v121, v122, v123
  v_cvt_pk_bf16_f32 v122, v124, v125
  v_cvt_pk_bf16_f32 v123, v126, v127
  s_add_u32 s3, s6, 0
  buffer_store_dwordx4 v[120:123], v1, s[16:19], s3 offen
  v_pk_mul_f32 v[128:129], v[128:129], v[156:157] op_sel_hi:[1,0]
  v_pk_mul_f32 v[130:131], v[130:131], v[156:157] op_sel_hi:[1,0]
  v_pk_mul_f32 v[132:133], v[132:133], v[156:157] op_sel_hi:[1,0]
  v_pk_mul_f32 v[134:135], v[134:135], v[156:157] op_sel_hi:[1,0]
  v_cvt_pk_bf16_f32 v128, v128, v129
  v_cvt_pk_bf16_f32 v129, v130, v131
  v_cvt_pk_bf16_f32 v130, v132, v133
  v_cvt_pk_bf16_f32 v131, v134, v135
  s_add_u32 s3, s6, 2048
  buffer_store_dwordx4 v[128:131], v1, s[16:19], s3 offen
  v_pk_mul_f32 v[136:137], v[136:137], v[160:161] op_sel_hi:[1,0]
  v_pk_mul_f32 v[138:139], v[138:139], v[160:161] op_sel_hi:[1,0]
  v_pk_mul_f32 v[140:141], v[140:141], v[160:161] op_sel_hi:[1,0]
  v_pk_mul_f32 v[142:143], v[142:143], v[160:161] op_sel_hi:[1,0]
  v_cvt_pk_bf16_f32 v136, v136, v137
  v_cvt_pk_bf16_f32 v137, v138, v139
  v_cvt_pk_bf16_f32 v138, v140, v141
  v_cvt_pk_bf16_f32 v139, v142, v143
  s_add_u32 s3, s6, 4096
  buffer_store_dwordx4 v[136:139], v1, s[16:19], s3 offen
  v_pk_mul_f32 v[144:145], v[144:145], v[164:165] op_sel_hi:[1,0]
  v_pk_mul_f32 v[146:147], v[146:147], v[164:165] op_sel_hi:[1,0]
  v_pk_mul_f32 v[148:149], v[148:149], v[164:165] op_sel_hi:[1,0]
  v_pk_mul_f32 v[150:151], v[150:151], v[164:165] op_sel_hi:[1,0]
  v_cvt_pk_bf16_f32 v144, v144, v145
  v_cvt_pk_bf16_f32 v145, v146, v147
  v_cvt_pk_bf16_f32 v146, v148, v149
  v_cvt_pk_bf16_f32 v147, v150, v151
  s_add_u32 s3, s6, 6144
  buffer_store_dwordx4 v[144:147], v1, s[16:19], s3 offen
Lk1_end:
  s_endpgm
.globl k2_attn_kernel
.p2align 8
.type k2_attn_kernel,@function
k2_attn_kernel:
  s_cmp_ge_u32 s2, 256
  s_cbranch_scc1 Lk2_end
  s_load_dwordx2 s[4:5], s[0:1], 88
  s_load_dwordx2 s[44:45], s[0:1], 40
  s_load_dwordx2 s[48:49], s[0:1], 64
  s_and_b32 s20, s2, 7
  s_lshr_b32 s33, s2, 6
  s_lshl_b32 s33, s33, 3
  s_add_u32 s20, s20, s33
  s_bfe_u32 s21, s2, 0x30003
  v_lshrrev_b32 v8, 6, v0
  s_nop 0
  v_readfirstlane_b32 s22, v8
  v_and_b32 v9, 63, v0
  v_lshlrev_b32 v1, 4, v9
  s_and_b32 s23, s22, 1
  s_lshr_b32 s24, s22, 1
  s_lshl_b32 s33, s24, 14
  s_lshl_b32 s34, s23, 13
  s_add_u32 s29, s33, s34
  v_add_u32 v2, s33, v1
  v_add_u32 v3, 0x10000, v2
  s_lshl_b32 s28, s20, 20
  s_add_u32 s28, s28, s34
  s_lshl_b32 s33, s21, 16
  s_add_u32 s27, s28, s33
  s_add_u32 s27, s27, 65536
  s_sub_u32 s34, 491520, s33
  s_cmp_eq_u32 s24, 0
  s_cselect_b32 s34, 0, s34
  s_cselect_b32 s27, s27, 0x7fffffff
  s_add_u32 s25, s28, s34
  s_add_u32 s26, s25, 16384
  s_add_u32 s62, s27, 16384
  s_add_u32 s63, s28, 16384
  s_sub_u32 s35, 15, s21
  s_lshl_b32 s31, s21, 7
  s_cmp_eq_u32 s24, 0
  s_cselect_b32 s35, s21, s35
  s_cselect_b32 s31, s31, 960
  s_mov_b32 s60, 0
  s_waitcnt lgkmcnt(0)
  s_add_u32 s12, s4, 16777216
  s_addc_u32 s13, s5, 0
  s_mov_b32 s14, 33554432
  s_mov_b32 s15, 0x00020000
  s_mov_b32 s8, s4
  s_mov_b32 s9, s5
  s_mov_b32 s10, 16777216
  s_mov_b32 s11, 0x00020000
  s_add_u32 m0, s29, 65536
  s_add_u32 s32, s25, 4096
  buffer_load_dwordx4 v1, s[12:15], s25 offen offset:0 lds
  buffer_load_dwordx4 v1, s[12:15], s25 offen offset:1024 lds
  buffer_load_dwordx4 v1, s[12:15], s25 offen offset:2048 lds
  buffer_load_dwordx4 v1, s[12:15], s25 offen offset:3072 lds
  s_add_u32 m0, s29, 69632
  s_nop 0
  buffer_load_dwordx4 v1, s[12:15], s32 offen offset:0 lds
  buffer_load_dwordx4 v1, s[12:15], s32 offen offset:1024 lds
  buffer_load_dwordx4 v1, s[12:15], s32 offen offset:2048 lds
  buffer_load_dwordx4 v1, s[12:15], s32 offen offset:3072 lds
  s_add_u32 s25, s25, 32768
  s_cmp_eq_u32 s25, s27
  s_cselect_b32 s25, s28, s25
  s_cselect_b32 s27, -1, s27
  s_lshl_b32 s33, s20, 7
  s_lshl_b32 s34, s35, 3
  s_add_u32 s33, s33, s34
  s_lshl_b32 s34, s23, 2
  s_add_u32 s33, s33, s34
  s_lshl_b32 s33, s33, 12
  buffer_load_dwordx4 a[52:55], v1, s[8:11], s33 offen offset:0
  buffer_load_dwordx4 a[56:59], v1, s[8:11], s33 offen offset:1024
  buffer_load_dwordx4 a[60:63], v1, s[8:11], s33 offen offset:2048
  buffer_load_dwordx4 a[64:67], v1, s[8:11], s33 offen offset:3072
  s_add_u32 s33, s33, 4096
  buffer_load_dwordx4 a[68:71], v1, s[8:11], s33 offen offset:0
  buffer_load_dwordx4 a[72:75], v1, s[8:11], s33 offen offset:1024
  buffer_load_dwordx4 a[76:79], v1, s[8:11], s33 offen offset:2048
  buffer_load_dwordx4 a[80:83], v1, s[8:11], s33 offen offset:3072
  s_add_u32 s33, s33, 4096
  buffer_load_dwordx4 a[84:87], v1, s[8:11], s33 offen offset:0
  buffer_load_dwordx4 a[88:91], v1, s[8:11], s33 offen offset:1024
  buffer_load_dwordx4 a[92:95], v1, s[8:11], s33 offen offset:2048
  buffer_load_dwordx4 a[96:99], v1, s[8:11], s33 offen offset:3072
  s_add_u32 s33, s33, 4096
  buffer_load_dwordx4 a[100:103], v1, s[8:11], s33 offen offset:0
  buffer_load_dwordx4 a[104:107], v1, s[8:11], s33 offen offset:1024
  buffer_load_dwordx4 a[108:111], v1, s[8:11], s33 offen offset:2048
  buffer_load_dwordx4 a[112:115], v1, s[8:11], s33 offen offset:3072
  s_add_u32 s16, s4, 67108864
  s_addc_u32 s17, s5, 0
  s_mov_b32 s18, 16777216
  s_mov_b32 s19, 0x00020000
  s_mov_b32 s46, 8388608
  s_mov_b32 s47, 0x00020000
  s_mov_b32 s50, 2097152
  s_mov_b32 s51, 0x00020000
  v_and_b32 v8, 15, v0
  v_bfe_u32 v9, v0, 4, 2
  v_lshlrev_b32 v9, 2, v9
  v_sub_u32 v8, v8, v9
  v_mov_b32 v4, 0xf149f2ca
  v_cmp_gt_i32 vcc, 0, v8
  s_nop 1
  v_cndmask_b32 v16, 0, v4, vcc
  v_cmp_gt_i32 vcc, 1, v8
  s_nop 1
  v_cndmask_b32 v17, 0, v4, vcc
  v_cmp_gt_i32 vcc, 2, v8
  s_nop 1
  v_cndmask_b32 v18, 0, v4, vcc
  v_cmp_gt_i32 vcc, 3, v8
  s_nop 1
  v_cndmask_b32 v19, 0, v4, vcc
  v_mov_b32 v8, 0x3f803f80
  v_accvgpr_write_b32 a48, v8
  v_accvgpr_write_b32 a49, v8
  v_accvgpr_write_b32 a50, v8
  v_accvgpr_write_b32 a51, v8
  v_accvgpr_write_b32 a0, 0
  v_accvgpr_write_b32 a1, 0
  v_accvgpr_write_b32 a2, 0
  v_accvgpr_write_b32 a3, 0
  v_accvgpr_write_b32 a4, 0
  v_accvgpr_write_b32 a5, 0
  v_accvgpr_write_b32 a6, 0
  v_accvgpr_write_b32 a7, 0
  v_accvgpr_write_b32 a8, 0
  v_accvgpr_write_b32 a9, 0
  v_accvgpr_write_b32 a10, 0
  v_accvgpr_write_b32 a11, 0
  v_accvgpr_write_b32 a12, 0
  v_accvgpr_write_b32 a13, 0
  v_accvgpr_write_b32 a14, 0
  v_accvgpr_write_b32 a15, 0
  v_accvgpr_write_b32 a16, 0
  v_accvgpr_write_b32 a17, 0
  v_accvgpr_write_b32 a18, 0
  v_accvgpr_write_b32 a19, 0
  v_accvgpr_write_b32 a20, 0
  v_accvgpr_write_b32 a21, 0
  v_accvgpr_write_b32 a22, 0
  v_accvgpr_write_b32 a23, 0
  v_accvgpr_write_b32 a24, 0
  v_accvgpr_write_b32 a25, 0
  v_accvgpr_write_b32 a26, 0
  v_accvgpr_write_b32 a27, 0
  v_accvgpr_write_b32 a28, 0
  v_accvgpr_write_b32 a29, 0
  v_accvgpr_write_b32 a30, 0
  v_accvgpr_write_b32 a31, 0
  v_accvgpr_write_b32 a32, 0
  v_accvgpr_write_b32 a33, 0
  v_accvgpr_write_b32 a34, 0
  v_accvgpr_write_b32 a35, 0
  v_accvgpr_write_b32 a36, 0
  v_accvgpr_write_b32 a37, 0
  v_accvgpr_write_b32 a38, 0
  v_accvgpr_write_b32 a39, 0
  v_accvgpr_write_b32 a40, 0
  v_accvgpr_write_b32 a41, 0
  v_accvgpr_write_b32 a42, 0
  v_accvgpr_write_b32 a43, 0
  v_accvgpr_write_b32 a44, 0
  v_accvgpr_write_b32 a45, 0
  v_accvgpr_write_b32 a46, 0
  v_accvgpr_write_b32 a47, 0
  v_mov_b32 v160, 0
  v_mov_b32 v161, 0
  v_mov_b32 v162, 0
  v_mov_b32 v163, 0
  v_mov_b32 v164, 0
  v_mov_b32 v165, 0
  v_mov_b32 v166, 0
  v_mov_b32 v167, 0
  v_mov_b32 v168, 0
  v_mov_b32 v169, 0
  v_mov_b32 v170, 0
  v_mov_b32 v171, 0
  v_mov_b32 v172, 0
  v_mov_b32 v173, 0
  v_mov_b32 v174, 0
  v_mov_b32 v175, 0
  v_mov_b32 v176, 0
  v_mov_b32 v177, 0
  v_mov_b32 v178, 0
  v_mov_b32 v179, 0
  v_mov_b32 v180, 0
  v_mov_b32 v181, 0
  v_mov_b32 v182, 0
  v_mov_b32 v183, 0
  v_mov_b32 v184, 0
  v_mov_b32 v185, 0
  v_mov_b32 v186, 0
  v_mov_b32 v187, 0
  v_mov_b32 v188, 0
  v_mov_b32 v189, 0
  v_mov_b32 v190, 0
  v_mov_b32 v191, 0
  v_mov_b32 v192, 0
  v_mov_b32 v193, 0
  v_mov_b32 v194, 0
  v_mov_b32 v195, 0
  v_mov_b32 v196, 0
  v_mov_b32 v197, 0
  v_mov_b32 v198, 0
  v_mov_b32 v199, 0
  v_mov_b32 v200, 0
  v_mov_b32 v201, 0
  v_mov_b32 v202, 0
  v_mov_b32 v203, 0
  v_mov_b32 v204, 0
  v_mov_b32 v205, 0
  v_mov_b32 v206, 0
  v_mov_b32 v207, 0
  v_mov_b32 v208, 0
  v_mov_b32 v209, 0
  v_mov_b32 v210, 0
  v_mov_b32 v211, 0
  v_mov_b32 v212, 0
  v_mov_b32 v213, 0
  v_mov_b32 v214, 0
  v_mov_b32 v215, 0
  v_mov_b32 v216, 0
  v_mov_b32 v217, 0
  v_mov_b32 v218, 0
  v_mov_b32 v219, 0
  v_mov_b32 v220, 0
  v_mov_b32 v221, 0
  v_mov_b32 v222, 0
  v_mov_b32 v223, 0
  v_mov_b32 v224, 0
  v_mov_b32 v225, 0
  v_mov_b32 v226, 0
  v_mov_b32 v227, 0
  v_mov_b32 v228, 0
  v_mov_b32 v229, 0
  v_mov_b32 v230, 0
  v_mov_b32 v231, 0
  v_mov_b32 v232, 0
  v_mov_b32 v233, 0
  v_mov_b32 v234, 0
  v_mov_b32 v235, 0
  v_mov_b32 v236, 0
  v_mov_b32 v237, 0
  v_mov_b32 v238, 0
  v_mov_b32 v239, 0
  v_mov_b32 v240, 0
  v_mov_b32 v241, 0
  v_mov_b32 v242, 0
  v_mov_b32 v243, 0
  v_mov_b32 v244, 0
  v_mov_b32 v245, 0
  v_mov_b32 v246, 0
  v_mov_b32 v247, 0
  v_mov_b32 v248, 0
  v_mov_b32 v249, 0
  v_mov_b32 v250, 0
  v_mov_b32 v251, 0
  v_mov_b32 v252, 0
  v_mov_b32 v253, 0
  v_mov_b32 v254, 0
  v_mov_b32 v255, 0
  s_lshl_b32 s33, s23, 6
  s_add_i32 s33, s33, s31
  s_cmp_gt_i32 s33, 0
  s_cselect_b32 s34, 0, 0xf149f2ca
  s_cmp_lt_i32 s33, 0
  s_cselect_b32 s33, 0xf149f2ca, 0
  v_mov_b32 v20, s34
  v_mov_b32 v21, s34
  v_mov_b32 v22, s34
  v_mov_b32 v23, s34
  v_mov_b32 v28, s33
  v_mov_b32 v29, s33
  v_mov_b32 v30, s33
  v_mov_b32 v31, s33
  v_med3_f32 v24, v16, v20, v28
  v_med3_f32 v25, v17, v20, v28
  v_med3_f32 v26, v18, v20, v28
  v_med3_f32 v27, v19, v20, v28
  s_waitcnt vmcnt(0)
  s_barrier
  ds_read_b128 a[116:119], v3 offset:0
  ds_read_b128 a[120:123], v3 offset:1024
  ds_read_b128 a[124:127], v3 offset:2048
  ds_read_b128 a[128:131], v3 offset:3072
  ds_read_b128 a[132:135], v3 offset:4096
  ds_read_b128 a[136:139], v3 offset:5120
  ds_read_b128 a[140:143], v3 offset:6144
  ds_read_b128 a[144:147], v3 offset:7168
  s_add_u32 m0, s29, 0
  s_add_u32 s32, s25, 4096
  buffer_load_dwordx4 v1, s[12:15], s25 offen offset:0 lds
  buffer_load_dwordx4 v1, s[12:15], s25 offen offset:1024 lds
  buffer_load_dwordx4 v1, s[12:15], s25 offen offset:2048 lds
  buffer_load_dwordx4 v1, s[12:15], s25 offen offset:3072 lds
  s_add_u32 m0, s29, 4096
  s_nop 0
  buffer_load_dwordx4 v1, s[12:15], s32 offen offset:0 lds
  buffer_load_dwordx4 v1, s[12:15], s32 offen offset:1024 lds
  buffer_load_dwordx4 v1, s[12:15], s32 offen offset:2048 lds
  buffer_load_dwordx4 v1, s[12:15], s32 offen offset:3072 lds
  s_add_u32 s25, s25, 32768
  s_cmp_eq_u32 s25, s27
  s_cselect_b32 s25, s28, s25
  s_cselect_b32 s27, -1, s27
  s_waitcnt lgkmcnt(4)
  s_add_u32 m0, s29, 32768
  v_mfma_f32_16x16x32_bf16 v[32:35], a[116:119], a[52:55], v[24:27]
  v_mfma_f32_16x16x32_bf16 v[32:35], a[120:123], a[56:59], v[32:35]
  ds_read_b128 a[148:151], v3 offset:8192
  ds_read_b128 a[152:155], v3 offset:9216
  v_mfma_f32_16x16x32_bf16 v[32:35], a[124:127], a[60:63], v[32:35]
  v_mfma_f32_16x16x32_bf16 v[32:35], a[128:131], a[64:67], v[32:35]
  buffer_load_dwordx4 v1, s[12:15], s26 offen offset:0 lds
  s_add_u32 s32, s26, 4096
  v_mfma_f32_16x16x32_bf16 v[36:39], a[128:131], a[80:83], v[28:31]
  v_mfma_f32_16x16x32_bf16 v[36:39], a[124:127], a[76:79], v[36:39]
  v_mfma_f32_16x16x32_bf16 v[36:39], a[120:123], a[72:75], v[36:39]
  v_mfma_f32_16x16x32_bf16 v[36:39], a[116:119], a[68:71], v[36:39]
  buffer_load_dwordx4 v1, s[12:15], s26 offen offset:1024 lds
  v_mfma_f32_16x16x32_bf16 v[40:43], a[116:119], a[84:87], v[28:31]
  v_mfma_f32_16x16x32_bf16 v[40:43], a[120:123], a[88:91], v[40:43]
  ds_read_b128 a[156:159], v3 offset:10240
  ds_read_b128 a[160:163], v3 offset:11264
  v_mfma_f32_16x16x32_bf16 v[40:43], a[124:127], a[92:95], v[40:43]
  v_mfma_f32_16x16x32_bf16 v[40:43], a[128:131], a[96:99], v[40:43]
  buffer_load_dwordx4 v1, s[12:15], s26 offen offset:2048 lds
  v_mfma_f32_16x16x32_bf16 v[44:47], a[128:131], a[112:115], v[28:31]
  v_mfma_f32_16x16x32_bf16 v[44:47], a[124:127], a[108:111], v[44:47]
  v_mfma_f32_16x16x32_bf16 v[44:47], a[120:123], a[104:107], v[44:47]
  v_mfma_f32_16x16x32_bf16 v[44:47], a[116:119], a[100:103], v[44:47]
  buffer_load_dwordx4 v1, s[12:15], s26 offen offset:3072 lds
  s_add_u32 m0, s29, 36864
  s_waitcnt lgkmcnt(4)
  v_mfma_f32_16x16x32_bf16 v[48:51], a[132:135], a[52:55], v[20:23]
  v_mfma_f32_16x16x32_bf16 v[48:51], a[136:139], a[56:59], v[48:51]
  ds_read_b128 a[164:167], v3 offset:12288
  ds_read_b128 a[168:171], v3 offset:13312
  v_mfma_f32_16x16x32_bf16 v[48:51], a[140:143], a[60:63], v[48:51]
  v_mfma_f32_16x16x32_bf16 v[48:51], a[144:147], a[64:67], v[48:51]
  buffer_load_dwordx4 v1, s[12:15], s32 offen offset:0 lds
  v_mfma_f32_16x16x32_bf16 v[52:55], a[144:147], a[80:83], v[24:27]
  v_mfma_f32_16x16x32_bf16 v[52:55], a[140:143], a[76:79], v[52:55]
  v_mfma_f32_16x16x32_bf16 v[52:55], a[136:139], a[72:75], v[52:55]
  v_mfma_f32_16x16x32_bf16 v[52:55], a[132:135], a[68:71], v[52:55]
  buffer_load_dwordx4 v1, s[12:15], s32 offen offset:1024 lds
  v_mfma_f32_16x16x32_bf16 v[56:59], a[132:135], a[84:87], v[28:31]
  v_mfma_f32_16x16x32_bf16 v[56:59], a[136:139], a[88:91], v[56:59]
  ds_read_b128 a[172:175], v3 offset:14336
  ds_read_b128 a[176:179], v3 offset:15360
  v_mfma_f32_16x16x32_bf16 v[56:59], a[140:143], a[92:95], v[56:59]
  v_mfma_f32_16x16x32_bf16 v[56:59], a[144:147], a[96:99], v[56:59]
  buffer_load_dwordx4 v1, s[12:15], s32 offen offset:2048 lds
  v_mfma_f32_16x16x32_bf16 v[60:63], a[144:147], a[112:115], v[28:31]
  v_mfma_f32_16x16x32_bf16 v[60:63], a[140:143], a[108:111], v[60:63]
  v_mfma_f32_16x16x32_bf16 v[60:63], a[136:139], a[104:107], v[60:63]
  v_mfma_f32_16x16x32_bf16 v[60:63], a[132:135], a[100:103], v[60:63]
  buffer_load_dwordx4 v1, s[12:15], s32 offen offset:3072 lds
  s_waitcnt lgkmcnt(4)
  v_mfma_f32_16x16x32_bf16 v[64:67], a[148:151], a[52:55], v[20:23]
  v_mfma_f32_16x16x32_bf16 v[64:67], a[152:155], a[56:59], v[64:67]
  s_add_u32 s26, s26, 32768
  s_cmp_eq_u32 s26, s62
  s_cselect_b32 s26, s63, s26
  s_cselect_b32 s62, -1, s62
  v_mfma_f32_16x16x32_bf16 v[64:67], a[156:159], a[60:63], v[64:67]
  v_mfma_f32_16x16x32_bf16 v[64:67], a[160:163], a[64:67], v[64:67]
  v_mfma_f32_16x16x32_bf16 v[68:71], a[160:163], a[80:83], v[20:23]
  v_mfma_f32_16x16x32_bf16 v[68:71], a[156:159], a[76:79], v[68:71]
  v_mfma_f32_16x16x32_bf16 v[68:71], a[152:155], a[72:75], v[68:71]
  v_mfma_f32_16x16x32_bf16 v[68:71], a[148:151], a[68:71], v[68:71]
  v_mfma_f32_16x16x32_bf16 v[72:75], a[148:151], a[84:87], v[24:27]
  v_mfma_f32_16x16x32_bf16 v[72:75], a[152:155], a[88:91], v[72:75]
  v_mfma_f32_16x16x32_bf16 v[72:75], a[156:159], a[92:95], v[72:75]
  v_mfma_f32_16x16x32_bf16 v[72:75], a[160:163], a[96:99], v[72:75]
  v_mfma_f32_16x16x32_bf16 v[76:79], a[160:163], a[112:115], v[28:31]
  v_mfma_f32_16x16x32_bf16 v[76:79], a[156:159], a[108:111], v[76:79]
  s_waitcnt vmcnt(8) lgkmcnt(0)
  s_barrier
  ds_read_b128 a[116:119], v2 offset:0
  ds_read_b128 a[120:123], v2 offset:1024
  ds_read_b128 a[124:127], v2 offset:2048
  ds_read_b128 a[128:131], v2 offset:3072
  v_mfma_f32_16x16x32_bf16 v[76:79], a[152:155], a[104:107], v[76:79]
  v_mfma_f32_16x16x32_bf16 v[76:79], a[148:151], a[100:103], v[76:79]
  v_mfma_f32_16x16x32_bf16 v[80:83], a[164:167], a[52:55], v[20:23]
  v_mfma_f32_16x16x32_bf16 v[80:83], a[168:171], a[56:59], v[80:83]
  ds_read_b128 a[132:135], v2 offset:4096
  ds_read_b128 a[136:139], v2 offset:5120
  v_mfma_f32_16x16x32_bf16 v[80:83], a[172:175], a[60:63], v[80:83]
  v_mfma_f32_16x16x32_bf16 v[80:83], a[176:179], a[64:67], v[80:83]
  v_mfma_f32_16x16x32_bf16 v[84:87], a[176:179], a[80:83], v[20:23]
  v_mfma_f32_16x16x32_bf16 v[84:87], a[172:175], a[76:79], v[84:87]
  v_mfma_f32_16x16x32_bf16 v[84:87], a[168:171], a[72:75], v[84:87]
  v_mfma_f32_16x16x32_bf16 v[84:87], a[164:167], a[68:71], v[84:87]
  v_mfma_f32_16x16x32_bf16 v[88:91], a[164:167], a[84:87], v[20:23]
  v_mfma_f32_16x16x32_bf16 v[88:91], a[168:171], a[88:91], v[88:91]
  ds_read_b128 a[140:143], v2 offset:6144
  ds_read_b128 a[144:147], v2 offset:7168
  v_mfma_f32_16x16x32_bf16 v[88:91], a[172:175], a[92:95], v[88:91]
  v_mfma_f32_16x16x32_bf16 v[88:91], a[176:179], a[96:99], v[88:91]
  v_mfma_f32_16x16x32_bf16 v[92:95], a[176:179], a[112:115], v[24:27]
  v_mfma_f32_16x16x32_bf16 v[92:95], a[172:175], a[108:111], v[92:95]
  v_mfma_f32_16x16x32_bf16 v[92:95], a[168:171], a[104:107], v[92:95]
  v_mfma_f32_16x16x32_bf16 v[92:95], a[164:167], a[100:103], v[92:95]
  s_add_u32 m0, s29, 65536
  s_add_u32 s32, s25, 4096
  buffer_load_dwordx4 v1, s[12:15], s25 offen offset:0 lds
  buffer_load_dwordx4 v1, s[12:15], s25 offen offset:1024 lds
  buffer_load_dwordx4 v1, s[12:15], s25 offen offset:2048 lds
  buffer_load_dwordx4 v1, s[12:15], s25 offen offset:3072 lds
  s_add_u32 m0, s29, 69632
  s_nop 0
  buffer_load_dwordx4 v1, s[12:15], s32 offen offset:0 lds
  buffer_load_dwordx4 v1, s[12:15], s32 offen offset:1024 lds
  buffer_load_dwordx4 v1, s[12:15], s32 offen offset:2048 lds
  buffer_load_dwordx4 v1, s[12:15], s32 offen offset:3072 lds
  s_add_u32 s25, s25, 32768
  s_cmp_eq_u32 s25, s27
  s_cselect_b32 s25, s28, s25
  s_cselect_b32 s27, -1, s27
  v_exp_f32 v32, v32
  v_exp_f32 v33, v33
  v_exp_f32 v34, v34
  v_exp_f32 v35, v35
  v_exp_f32 v48, v48
  v_exp_f32 v49, v49
  v_exp_f32 v50, v50
  v_exp_f32 v51, v51
  v_cvt_pk_bf16_f32 v32, v32, v33
  v_cvt_pk_bf16_f32 v33, v34, v35
  v_exp_f32 v36, v36
  v_exp_f32 v37, v37
  v_exp_f32 v38, v38
  v_exp_f32 v39, v39
  v_cvt_pk_bf16_f32 v34, v48, v49
  v_cvt_pk_bf16_f32 v35, v50, v51
  v_exp_f32 v52, v52
  v_exp_f32 v53, v53
  v_exp_f32 v54, v54
  v_exp_f32 v55, v55
  v_cvt_pk_bf16_f32 v36, v36, v37
  v_cvt_pk_bf16_f32 v37, v38, v39
  v_exp_f32 v40, v40
  v_exp_f32 v41, v41
  v_exp_f32 v42, v42
  v_exp_f32 v43, v43
  v_cvt_pk_bf16_f32 v38, v52, v53
  v_cvt_pk_bf16_f32 v39, v54, v55
  v_exp_f32 v56, v56
  v_exp_f32 v57, v57
  v_exp_f32 v58, v58
  v_exp_f32 v59, v59
  v_cvt_pk_bf16_f32 v40, v40, v41
  v_cvt_pk_bf16_f32 v41, v42, v43
  v_exp_f32 v44, v44
  v_exp_f32 v45, v45
  v_exp_f32 v46, v46
  v_exp_f32 v47, v47
  v_cvt_pk_bf16_f32 v42, v56, v57
  v_cvt_pk_bf16_f32 v43, v58, v59
  v_exp_f32 v60, v60
  v_exp_f32 v61, v61
  v_exp_f32 v62, v62
  v_exp_f32 v63, v63
  v_cvt_pk_bf16_f32 v44, v44, v45
  v_cvt_pk_bf16_f32 v45, v46, v47
  v_cvt_pk_bf16_f32 v46, v60, v61
  v_cvt_pk_bf16_f32 v47, v62, v63
  s_cmp_eq_u32 s24, 1
  s_cbranch_scc1 Lk2_g1
  s_mov_b32 s30, s21
  s_cmp_eq_u32 s21, 0
  s_cbranch_scc1 Lk2_m2
Lk2_l1:
  s_waitcnt lgkmcnt(4)
  s_add_u32 m0, s29, 98304
  v_mfma_f32_16x16x32_bf16 v[96:99], a[116:119], a[52:55], 0
  v_exp_f32 v64, v64
  v_mfma_f32_16x16x32_bf16 v[96:99], a[120:123], a[56:59], v[96:99]
  ds_read_b128 a[148:151], v2 offset:8192
  ds_read_b128 a[152:155], v2 offset:9216
  v_mfma_f32_16x16x32_bf16 v[96:99], a[124:127], a[60:63], v[96:99]
  v_exp_f32 v65, v65
  v_mfma_f32_16x16x32_bf16 v[96:99], a[128:131], a[64:67], v[96:99]
  buffer_load_dwordx4 v1, s[12:15], s26 offen offset:0 lds
  s_add_u32 s32, s26, 4096
  v_mfma_f32_16x16x32_bf16 v[100:103], a[128:131], a[80:83], 0
  v_exp_f32 v66, v66
  v_mfma_f32_16x16x32_bf16 v[100:103], a[124:127], a[76:79], v[100:103]
  v_cvt_pk_bf16_f32 v64, v64, v65
  v_mfma_f32_16x16x32_bf16 v[100:103], a[120:123], a[72:75], v[100:103]
  v_exp_f32 v67, v67
  v_mfma_f32_16x16x32_bf16 v[100:103], a[116:119], a[68:71], v[100:103]
  buffer_load_dwordx4 v1, s[12:15], s26 offen offset:1024 lds
  v_mfma_f32_16x16x32_bf16 v[104:107], a[116:119], a[84:87], 0
  v_exp_f32 v80, v80
  v_mfma_f32_16x16x32_bf16 v[104:107], a[120:123], a[88:91], v[104:107]
  ds_read_b128 a[156:159], v2 offset:10240
  ds_read_b128 a[160:163], v2 offset:11264
  v_mfma_f32_16x16x32_bf16 v[104:107], a[124:127], a[92:95], v[104:107]
  v_exp_f32 v81, v81
  v_mfma_f32_16x16x32_bf16 v[104:107], a[128:131], a[96:99], v[104:107]
  buffer_load_dwordx4 v1, s[12:15], s26 offen offset:2048 lds
  v_mfma_f32_16x16x32_bf16 v[108:111], a[128:131], a[112:115], 0
  v_exp_f32 v82, v82
  v_mfma_f32_16x16x32_bf16 v[108:111], a[124:127], a[108:111], v[108:111]
  v_cvt_pk_bf16_f32 v65, v66, v67
  v_cvt_pk_bf16_f32 v66, v80, v81
  v_mfma_f32_16x16x32_bf16 v[108:111], a[120:123], a[104:107], v[108:111]
  v_exp_f32 v83, v83
  v_mfma_f32_16x16x32_bf16 v[108:111], a[116:119], a[100:103], v[108:111]
  buffer_load_dwordx4 v1, s[12:15], s26 offen offset:3072 lds
  s_add_u32 m0, s29, 102400
  s_waitcnt lgkmcnt(4)
  v_mfma_f32_16x16x32_bf16 v[112:115], a[132:135], a[52:55], 0
  v_exp_f32 v68, v68
  v_mfma_f32_16x16x32_bf16 v[112:115], a[136:139], a[56:59], v[112:115]
  ds_read_b128 a[164:167], v2 offset:12288
  ds_read_b128 a[168:171], v2 offset:13312
  v_mfma_f32_16x16x32_bf16 v[112:115], a[140:143], a[60:63], v[112:115]
  v_exp_f32 v69, v69
  v_mfma_f32_16x16x32_bf16 v[112:115], a[144:147], a[64:67], v[112:115]
  buffer_load_dwordx4 v1, s[12:15], s32 offen offset:0 lds
  v_mfma_f32_16x16x32_bf16 v[116:119], a[144:147], a[80:83], 0
  v_exp_f32 v70, v70
  v_mfma_f32_16x16x32_bf16 v[116:119], a[140:143], a[76:79], v[116:119]
  v_cvt_pk_bf16_f32 v67, v82, v83
  v_cvt_pk_bf16_f32 v68, v68, v69
  v_mfma_f32_16x16x32_bf16 v[116:119], a[136:139], a[72:75], v[116:119]
  v_exp_f32 v71, v71
  v_mfma_f32_16x16x32_bf16 v[116:119], a[132:135], a[68:71], v[116:119]
  buffer_load_dwordx4 v1, s[12:15], s32 offen offset:1024 lds
  v_mfma_f32_16x16x32_bf16 v[120:123], a[132:135], a[84:87], 0
  v_exp_f32 v84, v84
  v_mfma_f32_16x16x32_bf16 v[120:123], a[136:139], a[88:91], v[120:123]
  ds_read_b128 a[172:175], v2 offset:14336
  ds_read_b128 a[176:179], v2 offset:15360
  v_mfma_f32_16x16x32_bf16 v[120:123], a[140:143], a[92:95], v[120:123]
  v_exp_f32 v85, v85
  v_mfma_f32_16x16x32_bf16 v[120:123], a[144:147], a[96:99], v[120:123]
  buffer_load_dwordx4 v1, s[12:15], s32 offen offset:2048 lds
  v_mfma_f32_16x16x32_bf16 v[124:127], a[144:147], a[112:115], 0
  v_exp_f32 v86, v86
  v_mfma_f32_16x16x32_bf16 v[124:127], a[140:143], a[108:111], v[124:127]
  v_cvt_pk_bf16_f32 v69, v70, v71
  v_cvt_pk_bf16_f32 v70, v84, v85
  v_mfma_f32_16x16x32_bf16 v[124:127], a[136:139], a[104:107], v[124:127]
  v_exp_f32 v87, v87
  v_mfma_f32_16x16x32_bf16 v[124:127], a[132:135], a[100:103], v[124:127]
  buffer_load_dwordx4 v1, s[12:15], s32 offen offset:3072 lds
  s_waitcnt lgkmcnt(4)
  v_mfma_f32_16x16x32_bf16 v[128:131], a[148:151], a[52:55], 0
  v_exp_f32 v72, v72
  v_mfma_f32_16x16x32_bf16 v[128:131], a[152:155], a[56:59], v[128:131]
  s_add_u32 s26, s26, 32768
  s_cmp_eq_u32 s26, s62
  s_cselect_b32 s26, s63, s26
  s_cselect_b32 s62, -1, s62
  v_mfma_f32_16x16x32_bf16 v[128:131], a[156:159], a[60:63], v[128:131]
  v_exp_f32 v73, v73
  v_mfma_f32_16x16x32_bf16 v[128:131], a[160:163], a[64:67], v[128:131]
  v_cvt_pk_bf16_f32 v71, v86, v87
  v_cvt_pk_bf16_f32 v72, v72, v73
  v_mfma_f32_16x16x32_bf16 v[132:135], a[160:163], a[80:83], 0
  v_exp_f32 v74, v74
  v_mfma_f32_16x16x32_bf16 v[132:135], a[156:159], a[76:79], v[132:135]
  v_mfma_f32_16x16x32_bf16 v[132:135], a[152:155], a[72:75], v[132:135]
  v_exp_f32 v75, v75
  v_mfma_f32_16x16x32_bf16 v[132:135], a[148:151], a[68:71], v[132:135]
  v_cvt_pk_bf16_f32 v73, v74, v75
  v_mfma_f32_16x16x32_bf16 v[136:139], a[148:151], a[84:87], 0
  v_exp_f32 v88, v88
  v_mfma_f32_16x16x32_bf16 v[136:139], a[152:155], a[88:91], v[136:139]
  v_mfma_f32_16x16x32_bf16 v[136:139], a[156:159], a[92:95], v[136:139]
  v_exp_f32 v89, v89
  v_mfma_f32_16x16x32_bf16 v[136:139], a[160:163], a[96:99], v[136:139]
  v_cvt_pk_bf16_f32 v74, v88, v89
  v_mfma_f32_16x16x32_bf16 v[140:143], a[160:163], a[112:115], 0
  v_exp_f32 v90, v90
  v_mfma_f32_16x16x32_bf16 v[140:143], a[156:159], a[108:111], v[140:143]
  s_waitcnt vmcnt(16) lgkmcnt(0)
  s_barrier
  ds_read_b128 a[116:119], v2 offset:32768
  ds_read_b128 a[120:123], v2 offset:40960
  ds_read_b128 a[124:127], v2 offset:33792
  ds_read_b128 a[128:131], v2 offset:41984
  v_mfma_f32_16x16x32_bf16 v[140:143], a[152:155], a[104:107], v[140:143]
  v_exp_f32 v91, v91
  v_mfma_f32_16x16x32_bf16 v[140:143], a[148:151], a[100:103], v[140:143]
  v_cvt_pk_bf16_f32 v75, v90, v91
  v_mfma_f32_16x16x32_bf16 v[144:147], a[164:167], a[52:55], 0
  v_exp_f32 v76, v76
  v_mfma_f32_16x16x32_bf16 v[144:147], a[168:171], a[56:59], v[144:147]
  ds_read_b128 a[132:135], v2 offset:34816
  ds_read_b128 a[136:139], v2 offset:43008
  v_mfma_f32_16x16x32_bf16 v[144:147], a[172:175], a[60:63], v[144:147]
  v_exp_f32 v77, v77
  v_mfma_f32_16x16x32_bf16 v[144:147], a[176:179], a[64:67], v[144:147]
  v_cvt_pk_bf16_f32 v76, v76, v77
  v_mfma_f32_16x16x32_bf16 v[148:151], a[176:179], a[80:83], 0
  v_exp_f32 v78, v78
  v_mfma_f32_16x16x32_bf16 v[148:151], a[172:175], a[76:79], v[148:151]
  v_mfma_f32_16x16x32_bf16 v[148:151], a[168:171], a[72:75], v[148:151]
  v_exp_f32 v79, v79
  v_mfma_f32_16x16x32_bf16 v[148:151], a[164:167], a[68:71], v[148:151]
  v_cvt_pk_bf16_f32 v77, v78, v79
  v_mfma_f32_16x16x32_bf16 v[152:155], a[164:167], a[84:87], 0
  v_exp_f32 v92, v92
  v_mfma_f32_16x16x32_bf16 v[152:155], a[168:171], a[88:91], v[152:155]
  ds_read_b128 a[140:143], v2 offset:35840
  ds_read_b128 a[144:147], v2 offset:44032
  v_mfma_f32_16x16x32_bf16 v[152:155], a[172:175], a[92:95], v[152:155]
  v_exp_f32 v93, v93
  v_mfma_f32_16x16x32_bf16 v[152:155], a[176:179], a[96:99], v[152:155]
  v_cvt_pk_bf16_f32 v78, v92, v93
  v_mfma_f32_16x16x32_bf16 v[156:159], a[176:179], a[112:115], 0
  v_exp_f32 v94, v94
  v_mfma_f32_16x16x32_bf16 v[156:159], a[172:175], a[108:111], v[156:159]
  v_mfma_f32_16x16x32_bf16 v[156:159], a[168:171], a[104:107], v[156:159]
  v_exp_f32 v95, v95
  v_mfma_f32_16x16x32_bf16 v[156:159], a[164:167], a[100:103], v[156:159]
  v_cvt_pk_bf16_f32 v79, v94, v95
  s_waitcnt lgkmcnt(6)
  s_add_u32 m0, s29, 0
  v_mfma_f32_16x16x32_bf16 v[160:163], a[116:119], v[32:35], v[160:163]
  v_exp_f32 v96, v96
  v_mfma_f32_16x16x32_bf16 v[160:163], a[120:123], v[64:67], v[160:163]
  ds_read_b128 a[148:151], v2 offset:36864
  ds_read_b128 a[152:155], v2 offset:45056
  v_mfma_f32_16x16x32_bf16 v[164:167], a[120:123], v[68:71], v[164:167]
  v_exp_f32 v97, v97
  v_mfma_f32_16x16x32_bf16 v[164:167], a[116:119], v[36:39], v[164:167]
  buffer_load_dwordx4 v1, s[12:15], s25 offen offset:0 lds
  s_add_u32 s32, s25, 4096
  v_mfma_f32_16x16x32_bf16 v[168:171], a[116:119], v[40:43], v[168:171]
  v_exp_f32 v98, v98
  v_mfma_f32_16x16x32_bf16 v[168:171], a[120:123], v[72:75], v[168:171]
  v_cvt_pk_bf16_f32 v96, v96, v97
  v_mfma_f32_16x16x32_bf16 v[172:175], a[120:123], v[76:79], v[172:175]
  v_exp_f32 v99, v99
  v_mfma_f32_16x16x32_bf16 v[172:175], a[116:119], v[44:47], v[172:175]
  buffer_load_dwordx4 v1, s[12:15], s25 offen offset:1024 lds
  s_waitcnt lgkmcnt(6)
  v_mfma_f32_16x16x32_bf16 a[32:35], a[48:51], v[32:35], a[32:35]
  v_mfma_f32_16x16x32_bf16 a[32:35], a[48:51], v[64:67], a[32:35]
  v_mfma_f32_16x16x32_bf16 v[176:179], a[124:127], v[32:35], v[176:179]
  v_exp_f32 v112, v112
  v_mfma_f32_16x16x32_bf16 v[176:179], a[128:131], v[64:67], v[176:179]
  ds_read_b128 a[156:159], v2 offset:37888
  ds_read_b128 a[160:163], v2 offset:46080
  v_mfma_f32_16x16x32_bf16 v[180:183], a[128:131], v[68:71], v[180:183]
  v_exp_f32 v113, v113
  v_mfma_f32_16x16x32_bf16 v[180:183], a[124:127], v[36:39], v[180:183]
  buffer_load_dwordx4 v1, s[12:15], s25 offen offset:2048 lds
  v_mfma_f32_16x16x32_bf16 v[184:187], a[124:127], v[40:43], v[184:187]
  v_exp_f32 v114, v114
  v_mfma_f32_16x16x32_bf16 v[184:187], a[128:131], v[72:75], v[184:187]
  v_cvt_pk_bf16_f32 v97, v98, v99
  v_cvt_pk_bf16_f32 v98, v112, v113
  v_mfma_f32_16x16x32_bf16 v[188:191], a[128:131], v[76:79], v[188:191]
  v_exp_f32 v115, v115
  v_mfma_f32_16x16x32_bf16 v[188:191], a[124:127], v[44:47], v[188:191]
  buffer_load_dwordx4 v1, s[12:15], s25 offen offset:3072 lds
  s_add_u32 m0, s29, 4096
  s_waitcnt lgkmcnt(6)
  v_mfma_f32_16x16x32_bf16 a[36:39], a[48:51], v[36:39], a[36:39]
  v_mfma_f32_16x16x32_bf16 a[36:39], a[48:51], v[68:71], a[36:39]
  v_mfma_f32_16x16x32_bf16 v[192:195], a[132:135], v[32:35], v[192:195]
  v_exp_f32 v100, v100
  v_mfma_f32_16x16x32_bf16 v[192:195], a[136:139], v[64:67], v[192:195]
  ds_read_b128 a[164:167], v2 offset:38912
  ds_read_b128 a[168:171], v2 offset:47104
  v_mfma_f32_16x16x32_bf16 v[196:199], a[136:139], v[68:71], v[196:199]
  v_exp_f32 v101, v101
  v_mfma_f32_16x16x32_bf16 v[196:199], a[132:135], v[36:39], v[196:199]
  buffer_load_dwordx4 v1, s[12:15], s32 offen offset:0 lds
  v_mfma_f32_16x16x32_bf16 v[200:203], a[132:135], v[40:43], v[200:203]
  v_exp_f32 v102, v102
  v_mfma_f32_16x16x32_bf16 v[200:203], a[136:139], v[72:75], v[200:203]
  v_cvt_pk_bf16_f32 v99, v114, v115
  v_cvt_pk_bf16_f32 v100, v100, v101
  v_mfma_f32_16x16x32_bf16 v[204:207], a[136:139], v[76:79], v[204:207]
  v_exp_f32 v103, v103
  v_mfma_f32_16x16x32_bf16 v[204:207], a[132:135], v[44:47], v[204:207]
  buffer_load_dwordx4 v1, s[12:15], s32 offen offset:1024 lds
  s_waitcnt lgkmcnt(6)
  v_mfma_f32_16x16x32_bf16 a[40:43], a[48:51], v[40:43], a[40:43]
  v_mfma_f32_16x16x32_bf16 a[40:43], a[48:51], v[72:75], a[40:43]
  v_mfma_f32_16x16x32_bf16 v[208:211], a[140:143], v[32:35], v[208:211]
  v_exp_f32 v116, v116
  v_mfma_f32_16x16x32_bf16 v[208:211], a[144:147], v[64:67], v[208:211]
  ds_read_b128 a[172:175], v2 offset:39936
  ds_read_b128 a[176:179], v2 offset:48128
  v_mfma_f32_16x16x32_bf16 v[212:215], a[144:147], v[68:71], v[212:215]
  v_exp_f32 v117, v117
  v_mfma_f32_16x16x32_bf16 v[212:215], a[140:143], v[36:39], v[212:215]
  buffer_load_dwordx4 v1, s[12:15], s32 offen offset:2048 lds
  v_mfma_f32_16x16x32_bf16 v[216:219], a[140:143], v[40:43], v[216:219]
  v_exp_f32 v118, v118
  v_mfma_f32_16x16x32_bf16 v[216:219], a[144:147], v[72:75], v[216:219]
  v_cvt_pk_bf16_f32 v101, v102, v103
  v_cvt_pk_bf16_f32 v102, v116, v117
  v_mfma_f32_16x16x32_bf16 v[220:223], a[144:147], v[76:79], v[220:223]
  v_exp_f32 v119, v119
  v_mfma_f32_16x16x32_bf16 v[220:223], a[140:143], v[44:47], v[220:223]
  buffer_load_dwordx4 v1, s[12:15], s32 offen offset:3072 lds
  s_waitcnt lgkmcnt(6)
  v_mfma_f32_16x16x32_bf16 a[44:47], a[48:51], v[44:47], a[44:47]
  v_mfma_f32_16x16x32_bf16 a[44:47], a[48:51], v[76:79], a[44:47]
  v_mfma_f32_16x16x32_bf16 v[224:227], a[148:151], v[32:35], v[224:227]
  v_exp_f32 v104, v104
  v_mfma_f32_16x16x32_bf16 v[224:227], a[152:155], v[64:67], v[224:227]
  s_add_u32 s25, s25, 32768
  s_cmp_eq_u32 s25, s27
  s_cselect_b32 s25, s28, s25
  s_cselect_b32 s27, -1, s27
  v_mfma_f32_16x16x32_bf16 v[228:231], a[152:155], v[68:71], v[228:231]
  v_exp_f32 v105, v105
  v_mfma_f32_16x16x32_bf16 v[228:231], a[148:151], v[36:39], v[228:231]
  v_cvt_pk_bf16_f32 v103, v118, v119
  v_cvt_pk_bf16_f32 v104, v104, v105
  v_mfma_f32_16x16x32_bf16 v[232:235], a[148:151], v[40:43], v[232:235]
  v_exp_f32 v106, v106
  v_mfma_f32_16x16x32_bf16 v[232:235], a[152:155], v[72:75], v[232:235]
  v_mfma_f32_16x16x32_bf16 v[236:239], a[152:155], v[76:79], v[236:239]
  v_exp_f32 v107, v107
  v_mfma_f32_16x16x32_bf16 v[236:239], a[148:151], v[44:47], v[236:239]
  v_cvt_pk_bf16_f32 v105, v106, v107
  s_waitcnt lgkmcnt(4)
  v_mfma_f32_16x16x32_bf16 v[240:243], a[156:159], v[32:35], v[240:243]
  v_exp_f32 v120, v120
  v_mfma_f32_16x16x32_bf16 v[240:243], a[160:163], v[64:67], v[240:243]
  v_mfma_f32_16x16x32_bf16 v[244:247], a[160:163], v[68:71], v[244:247]
  v_exp_f32 v121, v121
  v_mfma_f32_16x16x32_bf16 v[244:247], a[156:159], v[36:39], v[244:247]
  v_cvt_pk_bf16_f32 v106, v120, v121
  v_mfma_f32_16x16x32_bf16 v[248:251], a[156:159], v[40:43], v[248:251]
  v_exp_f32 v122, v122
  v_mfma_f32_16x16x32_bf16 v[248:251], a[160:163], v[72:75], v[248:251]
  s_waitcnt vmcnt(16) lgkmcnt(0)
  s_barrier
  ds_read_b128 a[116:119], v3 offset:0
  ds_read_b128 a[120:123], v3 offset:1024
  ds_read_b128 a[124:127], v3 offset:2048
  ds_read_b128 a[128:131], v3 offset:3072
  v_mfma_f32_16x16x32_bf16 v[252:255], a[160:163], v[76:79], v[252:255]
  v_exp_f32 v123, v123
  v_mfma_f32_16x16x32_bf16 v[252:255], a[156:159], v[44:47], v[252:255]
  v_cvt_pk_bf16_f32 v107, v122, v123
  v_mfma_f32_16x16x32_bf16 a[0:3], a[164:167], v[32:35], a[0:3]
  v_exp_f32 v108, v108
  v_mfma_f32_16x16x32_bf16 a[0:3], a[168:171], v[64:67], a[0:3]
  ds_read_b128 a[132:135], v3 offset:4096
  ds_read_b128 a[136:139], v3 offset:5120
  v_mfma_f32_16x16x32_bf16 a[4:7], a[168:171], v[68:71], a[4:7]
  v_exp_f32 v109, v109
  v_mfma_f32_16x16x32_bf16 a[4:7], a[164:167], v[36:39], a[4:7]
  v_cvt_pk_bf16_f32 v108, v108, v109
  v_mfma_f32_16x16x32_bf16 a[8:11], a[164:167], v[40:43], a[8:11]
  v_exp_f32 v110, v110
  v_mfma_f32_16x16x32_bf16 a[8:11], a[168:171], v[72:75], a[8:11]
  v_mfma_f32_16x16x32_bf16 a[12:15], a[168:171], v[76:79], a[12:15]
  v_exp_f32 v111, v111
  v_mfma_f32_16x16x32_bf16 a[12:15], a[164:167], v[44:47], a[12:15]
  v_cvt_pk_bf16_f32 v109, v110, v111
  v_mfma_f32_16x16x32_bf16 a[16:19], a[172:175], v[32:35], a[16:19]
  v_exp_f32 v124, v124
  v_mfma_f32_16x16x32_bf16 a[16:19], a[176:179], v[64:67], a[16:19]
  ds_read_b128 a[140:143], v3 offset:6144
  ds_read_b128 a[144:147], v3 offset:7168
  v_mfma_f32_16x16x32_bf16 a[20:23], a[176:179], v[68:71], a[20:23]
  v_exp_f32 v125, v125
  v_mfma_f32_16x16x32_bf16 a[20:23], a[172:175], v[36:39], a[20:23]
  v_cvt_pk_bf16_f32 v110, v124, v125
  v_mfma_f32_16x16x32_bf16 a[24:27], a[172:175], v[40:43], a[24:27]
  v_exp_f32 v126, v126
  v_mfma_f32_16x16x32_bf16 a[24:27], a[176:179], v[72:75], a[24:27]
  v_mfma_f32_16x16x32_bf16 a[28:31], a[176:179], v[76:79], a[28:31]
  v_exp_f32 v127, v127
  v_mfma_f32_16x16x32_bf16 a[28:31], a[172:175], v[44:47], a[28:31]
  v_cvt_pk_bf16_f32 v111, v126, v127
  s_sub_u32 s30, s30, 1
  s_cmp_eq_u32 s30, 0
  s_cbranch_scc1 Lk2_m1
  s_waitcnt lgkmcnt(4)
  s_add_u32 m0, s29, 32768
  v_mfma_f32_16x16x32_bf16 v[32:35], a[116:119], a[52:55], 0
  v_exp_f32 v128, v128
  v_mfma_f32_16x16x32_bf16 v[32:35], a[120:123], a[56:59], v[32:35]
  ds_read_b128 a[148:151], v3 offset:8192
  ds_read_b128 a[152:155], v3 offset:9216
  v_mfma_f32_16x16x32_bf16 v[32:35], a[124:127], a[60:63], v[32:35]
  v_exp_f32 v129, v129
  v_mfma_f32_16x16x32_bf16 v[32:35], a[128:131], a[64:67], v[32:35]
  buffer_load_dwordx4 v1, s[12:15], s26 offen offset:0 lds
  s_add_u32 s32, s26, 4096
  v_mfma_f32_16x16x32_bf16 v[36:39], a[128:131], a[80:83], 0
  v_exp_f32 v130, v130
  v_mfma_f32_16x16x32_bf16 v[36:39], a[124:127], a[76:79], v[36:39]
  v_cvt_pk_bf16_f32 v128, v128, v129
  v_mfma_f32_16x16x32_bf16 v[36:39], a[120:123], a[72:75], v[36:39]
  v_exp_f32 v131, v131
  v_mfma_f32_16x16x32_bf16 v[36:39], a[116:119], a[68:71], v[36:39]
  buffer_load_dwordx4 v1, s[12:15], s26 offen offset:1024 lds
  v_mfma_f32_16x16x32_bf16 v[40:43], a[116:119], a[84:87], 0
  v_exp_f32 v144, v144
  v_mfma_f32_16x16x32_bf16 v[40:43], a[120:123], a[88:91], v[40:43]
  ds_read_b128 a[156:159], v3 offset:10240
  ds_read_b128 a[160:163], v3 offset:11264
  v_mfma_f32_16x16x32_bf16 v[40:43], a[124:127], a[92:95], v[40:43]
  v_exp_f32 v145, v145
  v_mfma_f32_16x16x32_bf16 v[40:43], a[128:131], a[96:99], v[40:43]
  buffer_load_dwordx4 v1, s[12:15], s26 offen offset:2048 lds
  v_mfma_f32_16x16x32_bf16 v[44:47], a[128:131], a[112:115], 0
  v_exp_f32 v146, v146
  v_mfma_f32_16x16x32_bf16 v[44:47], a[124:127], a[108:111], v[44:47]
  v_cvt_pk_bf16_f32 v129, v130, v131
  v_cvt_pk_bf16_f32 v130, v144, v145
  v_mfma_f32_16x16x32_bf16 v[44:47], a[120:123], a[104:107], v[44:47]
  v_exp_f32 v147, v147
  v_mfma_f32_16x16x32_bf16 v[44:47], a[116:119], a[100:103], v[44:47]
  buffer_load_dwordx4 v1, s[12:15], s26 offen offset:3072 lds
  s_add_u32 m0, s29, 36864
  s_waitcnt lgkmcnt(4)
  v_mfma_f32_16x16x32_bf16 v[48:51], a[132:135], a[52:55], 0
  v_exp_f32 v132, v132
  v_mfma_f32_16x16x32_bf16 v[48:51], a[136:139], a[56:59], v[48:51]
  ds_read_b128 a[164:167], v3 offset:12288
  ds_read_b128 a[168:171], v3 offset:13312
  v_mfma_f32_16x16x32_bf16 v[48:51], a[140:143], a[60:63], v[48:51]
  v_exp_f32 v133, v133
  v_mfma_f32_16x16x32_bf16 v[48:51], a[144:147], a[64:67], v[48:51]
  buffer_load_dwordx4 v1, s[12:15], s32 offen offset:0 lds
  v_mfma_f32_16x16x32_bf16 v[52:55], a[144:147], a[80:83], 0
  v_exp_f32 v134, v134
  v_mfma_f32_16x16x32_bf16 v[52:55], a[140:143], a[76:79], v[52:55]
  v_cvt_pk_bf16_f32 v131, v146, v147
  v_cvt_pk_bf16_f32 v132, v132, v133
  v_mfma_f32_16x16x32_bf16 v[52:55], a[136:139], a[72:75], v[52:55]
  v_exp_f32 v135, v135
  v_mfma_f32_16x16x32_bf16 v[52:55], a[132:135], a[68:71], v[52:55]
  buffer_load_dwordx4 v1, s[12:15], s32 offen offset:1024 lds
  v_mfma_f32_16x16x32_bf16 v[56:59], a[132:135], a[84:87], 0
  v_exp_f32 v148, v148
  v_mfma_f32_16x16x32_bf16 v[56:59], a[136:139], a[88:91], v[56:59]
  ds_read_b128 a[172:175], v3 offset:14336
  ds_read_b128 a[176:179], v3 offset:15360
  v_mfma_f32_16x16x32_bf16 v[56:59], a[140:143], a[92:95], v[56:59]
  v_exp_f32 v149, v149
  v_mfma_f32_16x16x32_bf16 v[56:59], a[144:147], a[96:99], v[56:59]
  buffer_load_dwordx4 v1, s[12:15], s32 offen offset:2048 lds
  v_mfma_f32_16x16x32_bf16 v[60:63], a[144:147], a[112:115], 0
  v_exp_f32 v150, v150
  v_mfma_f32_16x16x32_bf16 v[60:63], a[140:143], a[108:111], v[60:63]
  v_cvt_pk_bf16_f32 v133, v134, v135
  v_cvt_pk_bf16_f32 v134, v148, v149
  v_mfma_f32_16x16x32_bf16 v[60:63], a[136:139], a[104:107], v[60:63]
  v_exp_f32 v151, v151
  v_mfma_f32_16x16x32_bf16 v[60:63], a[132:135], a[100:103], v[60:63]
  buffer_load_dwordx4 v1, s[12:15], s32 offen offset:3072 lds
  s_waitcnt lgkmcnt(4)
  v_mfma_f32_16x16x32_bf16 v[64:67], a[148:151], a[52:55], 0
  v_exp_f32 v136, v136
  v_mfma_f32_16x16x32_bf16 v[64:67], a[152:155], a[56:59], v[64:67]
  s_add_u32 s26, s26, 32768
  s_cmp_eq_u32 s26, s62
  s_cselect_b32 s26, s63, s26
  s_cselect_b32 s62, -1, s62
  v_mfma_f32_16x16x32_bf16 v[64:67], a[156:159], a[60:63], v[64:67]
  v_exp_f32 v137, v137
  v_mfma_f32_16x16x32_bf16 v[64:67], a[160:163], a[64:67], v[64:67]
  v_cvt_pk_bf16_f32 v135, v150, v151
  v_cvt_pk_bf16_f32 v136, v136, v137
  v_mfma_f32_16x16x32_bf16 v[68:71], a[160:163], a[80:83], 0
  v_exp_f32 v138, v138
  v_mfma_f32_16x16x32_bf16 v[68:71], a[156:159], a[76:79], v[68:71]
  v_mfma_f32_16x16x32_bf16 v[68:71], a[152:155], a[72:75], v[68:71]
  v_exp_f32 v139, v139
  v_mfma_f32_16x16x32_bf16 v[68:71], a[148:151], a[68:71], v[68:71]
  v_cvt_pk_bf16_f32 v137, v138, v139
  v_mfma_f32_16x16x32_bf16 v[72:75], a[148:151], a[84:87], 0
  v_exp_f32 v152, v152
  v_mfma_f32_16x16x32_bf16 v[72:75], a[152:155], a[88:91], v[72:75]
  v_mfma_f32_16x16x32_bf16 v[72:75], a[156:159], a[92:95], v[72:75]
  v_exp_f32 v153, v153
  v_mfma_f32_16x16x32_bf16 v[72:75], a[160:163], a[96:99], v[72:75]
  v_cvt_pk_bf16_f32 v138, v152, v153
  v_mfma_f32_16x16x32_bf16 v[76:79], a[160:163], a[112:115], 0
  v_exp_f32 v154, v154
  v_mfma_f32_16x16x32_bf16 v[76:79], a[156:159], a[108:111], v[76:79]
  s_waitcnt vmcnt(16) lgkmcnt(0)
  s_barrier
  ds_read_b128 a[116:119], v3 offset:32768
  ds_read_b128 a[120:123], v3 offset:40960
  ds_read_b128 a[124:127], v3 offset:33792
  ds_read_b128 a[128:131], v3 offset:41984
  v_mfma_f32_16x16x32_bf16 v[76:79], a[152:155], a[104:107], v[76:79]
  v_exp_f32 v155, v155
  v_mfma_f32_16x16x32_bf16 v[76:79], a[148:151], a[100:103], v[76:79]
  v_cvt_pk_bf16_f32 v139, v154, v155
  v_mfma_f32_16x16x32_bf16 v[80:83], a[164:167], a[52:55], 0
  v_exp_f32 v140, v140
  v_mfma_f32_16x16x32_bf16 v[80:83], a[168:171], a[56:59], v[80:83]
  ds_read_b128 a[132:135], v3 offset:34816
  ds_read_b128 a[136:139], v3 offset:43008
  v_mfma_f32_16x16x32_bf16 v[80:83], a[172:175], a[60:63], v[80:83]
  v_exp_f32 v141, v141
  v_mfma_f32_16x16x32_bf16 v[80:83], a[176:179], a[64:67], v[80:83]
  v_cvt_pk_bf16_f32 v140, v140, v141
  v_mfma_f32_16x16x32_bf16 v[84:87], a[176:179], a[80:83], 0
  v_exp_f32 v142, v142
  v_mfma_f32_16x16x32_bf16 v[84:87], a[172:175], a[76:79], v[84:87]
  v_mfma_f32_16x16x32_bf16 v[84:87], a[168:171], a[72:75], v[84:87]
  v_exp_f32 v143, v143
  v_mfma_f32_16x16x32_bf16 v[84:87], a[164:167], a[68:71], v[84:87]
  v_cvt_pk_bf16_f32 v141, v142, v143
  v_mfma_f32_16x16x32_bf16 v[88:91], a[164:167], a[84:87], 0
  v_exp_f32 v156, v156
  v_mfma_f32_16x16x32_bf16 v[88:91], a[168:171], a[88:91], v[88:91]
  ds_read_b128 a[140:143], v3 offset:35840
  ds_read_b128 a[144:147], v3 offset:44032
  v_mfma_f32_16x16x32_bf16 v[88:91], a[172:175], a[92:95], v[88:91]
  v_exp_f32 v157, v157
  v_mfma_f32_16x16x32_bf16 v[88:91], a[176:179], a[96:99], v[88:91]
  v_cvt_pk_bf16_f32 v142, v156, v157
  v_mfma_f32_16x16x32_bf16 v[92:95], a[176:179], a[112:115], 0
  v_exp_f32 v158, v158
  v_mfma_f32_16x16x32_bf16 v[92:95], a[172:175], a[108:111], v[92:95]
  v_mfma_f32_16x16x32_bf16 v[92:95], a[168:171], a[104:107], v[92:95]
  v_exp_f32 v159, v159
  v_mfma_f32_16x16x32_bf16 v[92:95], a[164:167], a[100:103], v[92:95]
  v_cvt_pk_bf16_f32 v143, v158, v159
  s_waitcnt lgkmcnt(6)
  s_add_u32 m0, s29, 65536
  v_mfma_f32_16x16x32_bf16 v[160:163], a[116:119], v[96:99], v[160:163]
  v_exp_f32 v32, v32
  v_mfma_f32_16x16x32_bf16 v[160:163], a[120:123], v[128:131], v[160:163]
  ds_read_b128 a[148:151], v3 offset:36864
  ds_read_b128 a[152:155], v3 offset:45056
  v_mfma_f32_16x16x32_bf16 v[164:167], a[120:123], v[132:135], v[164:167]
  v_exp_f32 v33, v33
  v_mfma_f32_16x16x32_bf16 v[164:167], a[116:119], v[100:103], v[164:167]
  buffer_load_dwordx4 v1, s[12:15], s25 offen offset:0 lds
  s_add_u32 s32, s25, 4096
  v_mfma_f32_16x16x32_bf16 v[168:171], a[116:119], v[104:107], v[168:171]
  v_exp_f32 v34, v34
  v_mfma_f32_16x16x32_bf16 v[168:171], a[120:123], v[136:139], v[168:171]
  v_cvt_pk_bf16_f32 v32, v32, v33
  v_mfma_f32_16x16x32_bf16 v[172:175], a[120:123], v[140:143], v[172:175]
  v_exp_f32 v35, v35
  v_mfma_f32_16x16x32_bf16 v[172:175], a[116:119], v[108:111], v[172:175]
  buffer_load_dwordx4 v1, s[12:15], s25 offen offset:1024 lds
  s_waitcnt lgkmcnt(6)
  v_mfma_f32_16x16x32_bf16 a[32:35], a[48:51], v[96:99], a[32:35]
  v_mfma_f32_16x16x32_bf16 a[32:35], a[48:51], v[128:131], a[32:35]
  v_mfma_f32_16x16x32_bf16 v[176:179], a[124:127], v[96:99], v[176:179]
  v_exp_f32 v48, v48
  v_mfma_f32_16x16x32_bf16 v[176:179], a[128:131], v[128:131], v[176:179]
  ds_read_b128 a[156:159], v3 offset:37888
  ds_read_b128 a[160:163], v3 offset:46080
  v_mfma_f32_16x16x32_bf16 v[180:183], a[128:131], v[132:135], v[180:183]
  v_exp_f32 v49, v49
  v_mfma_f32_16x16x32_bf16 v[180:183], a[124:127], v[100:103], v[180:183]
  buffer_load_dwordx4 v1, s[12:15], s25 offen offset:2048 lds
  v_mfma_f32_16x16x32_bf16 v[184:187], a[124:127], v[104:107], v[184:187]
  v_exp_f32 v50, v50
  v_mfma_f32_16x16x32_bf16 v[184:187], a[128:131], v[136:139], v[184:187]
  v_cvt_pk_bf16_f32 v33, v34, v35
  v_cvt_pk_bf16_f32 v34, v48, v49
  v_mfma_f32_16x16x32_bf16 v[188:191], a[128:131], v[140:143], v[188:191]
  v_exp_f32 v51, v51
  v_mfma_f32_16x16x32_bf16 v[188:191], a[124:127], v[108:111], v[188:191]
  buffer_load_dwordx4 v1, s[12:15], s25 offen offset:3072 lds
  s_add_u32 m0, s29, 69632
  s_waitcnt lgkmcnt(6)
  v_mfma_f32_16x16x32_bf16 a[36:39], a[48:51], v[100:103], a[36:39]
  v_mfma_f32_16x16x32_bf16 a[36:39], a[48:51], v[132:135], a[36:39]
  v_mfma_f32_16x16x32_bf16 v[192:195], a[132:135], v[96:99], v[192:195]
  v_exp_f32 v36, v36
  v_mfma_f32_16x16x32_bf16 v[192:195], a[136:139], v[128:131], v[192:195]
  ds_read_b128 a[164:167], v3 offset:38912
  ds_read_b128 a[168:171], v3 offset:47104
  v_mfma_f32_16x16x32_bf16 v[196:199], a[136:139], v[132:135], v[196:199]
  v_exp_f32 v37, v37
  v_mfma_f32_16x16x32_bf16 v[196:199], a[132:135], v[100:103], v[196:199]
  buffer_load_dwordx4 v1, s[12:15], s32 offen offset:0 lds
  v_mfma_f32_16x16x32_bf16 v[200:203], a[132:135], v[104:107], v[200:203]
  v_exp_f32 v38, v38
  v_mfma_f32_16x16x32_bf16 v[200:203], a[136:139], v[136:139], v[200:203]
  v_cvt_pk_bf16_f32 v35, v50, v51
  v_cvt_pk_bf16_f32 v36, v36, v37
  v_mfma_f32_16x16x32_bf16 v[204:207], a[136:139], v[140:143], v[204:207]
  v_exp_f32 v39, v39
  v_mfma_f32_16x16x32_bf16 v[204:207], a[132:135], v[108:111], v[204:207]
  buffer_load_dwordx4 v1, s[12:15], s32 offen offset:1024 lds
  s_waitcnt lgkmcnt(6)
  v_mfma_f32_16x16x32_bf16 a[40:43], a[48:51], v[104:107], a[40:43]
  v_mfma_f32_16x16x32_bf16 a[40:43], a[48:51], v[136:139], a[40:43]
  v_mfma_f32_16x16x32_bf16 v[208:211], a[140:143], v[96:99], v[208:211]
  v_exp_f32 v52, v52
  v_mfma_f32_16x16x32_bf16 v[208:211], a[144:147], v[128:131], v[208:211]
  ds_read_b128 a[172:175], v3 offset:39936
  ds_read_b128 a[176:179], v3 offset:48128
  v_mfma_f32_16x16x32_bf16 v[212:215], a[144:147], v[132:135], v[212:215]
  v_exp_f32 v53, v53
  v_mfma_f32_16x16x32_bf16 v[212:215], a[140:143], v[100:103], v[212:215]
  buffer_load_dwordx4 v1, s[12:15], s32 offen offset:2048 lds
  v_mfma_f32_16x16x32_bf16 v[216:219], a[140:143], v[104:107], v[216:219]
  v_exp_f32 v54, v54
  v_mfma_f32_16x16x32_bf16 v[216:219], a[144:147], v[136:139], v[216:219]
  v_cvt_pk_bf16_f32 v37, v38, v39
  v_cvt_pk_bf16_f32 v38, v52, v53
  v_mfma_f32_16x16x32_bf16 v[220:223], a[144:147], v[140:143], v[220:223]
  v_exp_f32 v55, v55
  v_mfma_f32_16x16x32_bf16 v[220:223], a[140:143], v[108:111], v[220:223]
  buffer_load_dwordx4 v1, s[12:15], s32 offen offset:3072 lds
  s_waitcnt lgkmcnt(6)
  v_mfma_f32_16x16x32_bf16 a[44:47], a[48:51], v[108:111], a[44:47]
  v_mfma_f32_16x16x32_bf16 a[44:47], a[48:51], v[140:143], a[44:47]
  v_mfma_f32_16x16x32_bf16 v[224:227], a[148:151], v[96:99], v[224:227]
  v_exp_f32 v40, v40
  v_mfma_f32_16x16x32_bf16 v[224:227], a[152:155], v[128:131], v[224:227]
  s_add_u32 s25, s25, 32768
  s_cmp_eq_u32 s25, s27
  s_cselect_b32 s25, s28, s25
  s_cselect_b32 s27, -1, s27
  v_mfma_f32_16x16x32_bf16 v[228:231], a[152:155], v[132:135], v[228:231]
  v_exp_f32 v41, v41
  v_mfma_f32_16x16x32_bf16 v[228:231], a[148:151], v[100:103], v[228:231]
  v_cvt_pk_bf16_f32 v39, v54, v55
  v_cvt_pk_bf16_f32 v40, v40, v41
  v_mfma_f32_16x16x32_bf16 v[232:235], a[148:151], v[104:107], v[232:235]
  v_exp_f32 v42, v42
  v_mfma_f32_16x16x32_bf16 v[232:235], a[152:155], v[136:139], v[232:235]
  v_mfma_f32_16x16x32_bf16 v[236:239], a[152:155], v[140:143], v[236:239]
  v_exp_f32 v43, v43
  v_mfma_f32_16x16x32_bf16 v[236:239], a[148:151], v[108:111], v[236:239]
  v_cvt_pk_bf16_f32 v41, v42, v43
  s_waitcnt lgkmcnt(4)
  v_mfma_f32_16x16x32_bf16 v[240:243], a[156:159], v[96:99], v[240:243]
  v_exp_f32 v56, v56
  v_mfma_f32_16x16x32_bf16 v[240:243], a[160:163], v[128:131], v[240:243]
  v_mfma_f32_16x16x32_bf16 v[244:247], a[160:163], v[132:135], v[244:247]
  v_exp_f32 v57, v57
  v_mfma_f32_16x16x32_bf16 v[244:247], a[156:159], v[100:103], v[244:247]
  v_cvt_pk_bf16_f32 v42, v56, v57
  v_mfma_f32_16x16x32_bf16 v[248:251], a[156:159], v[104:107], v[248:251]
  v_exp_f32 v58, v58
  v_mfma_f32_16x16x32_bf16 v[248:251], a[160:163], v[136:139], v[248:251]
  s_waitcnt vmcnt(16) lgkmcnt(0)
  s_barrier
  ds_read_b128 a[116:119], v2 offset:0
  ds_read_b128 a[120:123], v2 offset:1024
  ds_read_b128 a[124:127], v2 offset:2048
  ds_read_b128 a[128:131], v2 offset:3072
  v_mfma_f32_16x16x32_bf16 v[252:255], a[160:163], v[140:143], v[252:255]
  v_exp_f32 v59, v59
  v_mfma_f32_16x16x32_bf16 v[252:255], a[156:159], v[108:111], v[252:255]
  v_cvt_pk_bf16_f32 v43, v58, v59
  v_mfma_f32_16x16x32_bf16 a[0:3], a[164:167], v[96:99], a[0:3]
  v_exp_f32 v44, v44
  v_mfma_f32_16x16x32_bf16 a[0:3], a[168:171], v[128:131], a[0:3]
  ds_read_b128 a[132:135], v2 offset:4096
  ds_read_b128 a[136:139], v2 offset:5120
  v_mfma_f32_16x16x32_bf16 a[4:7], a[168:171], v[132:135], a[4:7]
  v_exp_f32 v45, v45
  v_mfma_f32_16x16x32_bf16 a[4:7], a[164:167], v[100:103], a[4:7]
  v_cvt_pk_bf16_f32 v44, v44, v45
  v_mfma_f32_16x16x32_bf16 a[8:11], a[164:167], v[104:107], a[8:11]
  v_exp_f32 v46, v46
  v_mfma_f32_16x16x32_bf16 a[8:11], a[168:171], v[136:139], a[8:11]
  v_mfma_f32_16x16x32_bf16 a[12:15], a[168:171], v[140:143], a[12:15]
  v_exp_f32 v47, v47
  v_mfma_f32_16x16x32_bf16 a[12:15], a[164:167], v[108:111], a[12:15]
  v_cvt_pk_bf16_f32 v45, v46, v47
  v_mfma_f32_16x16x32_bf16 a[16:19], a[172:175], v[96:99], a[16:19]
  v_exp_f32 v60, v60
  v_mfma_f32_16x16x32_bf16 a[16:19], a[176:179], v[128:131], a[16:19]
  ds_read_b128 a[140:143], v2 offset:6144
  ds_read_b128 a[144:147], v2 offset:7168
  v_mfma_f32_16x16x32_bf16 a[20:23], a[176:179], v[132:135], a[20:23]
  v_exp_f32 v61, v61
  v_mfma_f32_16x16x32_bf16 a[20:23], a[172:175], v[100:103], a[20:23]
  v_cvt_pk_bf16_f32 v46, v60, v61
  v_mfma_f32_16x16x32_bf16 a[24:27], a[172:175], v[104:107], a[24:27]
  v_exp_f32 v62, v62
  v_mfma_f32_16x16x32_bf16 a[24:27], a[176:179], v[136:139], a[24:27]
  v_mfma_f32_16x16x32_bf16 a[28:31], a[176:179], v[140:143], a[28:31]
  v_exp_f32 v63, v63
  v_mfma_f32_16x16x32_bf16 a[28:31], a[172:175], v[108:111], a[28:31]
  v_cvt_pk_bf16_f32 v47, v62, v63
  s_branch Lk2_l1
Lk2_m1:
  s_lshl_b32 s33, s23, 6
  s_add_i32 s33, s33, 0
  s_cmp_gt_i32 s33, 0
  s_cselect_b32 s34, 0, 0xf149f2ca
  s_cmp_lt_i32 s33, 0
  s_cselect_b32 s33, 0xf149f2ca, 0
  v_mov_b32 v20, s34
  v_mov_b32 v21, s34
  v_mov_b32 v22, s34
  v_mov_b32 v23, s34
  v_mov_b32 v28, s33
  v_mov_b32 v29, s33
  v_mov_b32 v30, s33
  v_mov_b32 v31, s33
  v_med3_f32 v24, v16, v20, v28
  v_med3_f32 v25, v17, v20, v28
  v_med3_f32 v26, v18, v20, v28
  v_med3_f32 v27, v19, v20, v28
  s_waitcnt lgkmcnt(4)
  s_add_u32 m0, s29, 32768
  v_mfma_f32_16x16x32_bf16 v[32:35], a[116:119], a[52:55], v[24:27]
  v_exp_f32 v128, v128
  v_mfma_f32_16x16x32_bf16 v[32:35], a[120:123], a[56:59], v[32:35]
  ds_read_b128 a[148:151], v3 offset:8192
  ds_read_b128 a[152:155], v3 offset:9216
  v_mfma_f32_16x16x32_bf16 v[32:35], a[124:127], a[60:63], v[32:35]
  v_exp_f32 v129, v129
  v_mfma_f32_16x16x32_bf16 v[32:35], a[128:131], a[64:67], v[32:35]
  buffer_load_dwordx4 v1, s[12:15], s26 offen offset:0 lds
  s_add_u32 s32, s26, 4096
  v_mfma_f32_16x16x32_bf16 v[36:39], a[128:131], a[80:83], v[28:31]
  v_exp_f32 v130, v130
  v_mfma_f32_16x16x32_bf16 v[36:39], a[124:127], a[76:79], v[36:39]
  v_cvt_pk_bf16_f32 v128, v128, v129
  v_mfma_f32_16x16x32_bf16 v[36:39], a[120:123], a[72:75], v[36:39]
  v_exp_f32 v131, v131
  v_mfma_f32_16x16x32_bf16 v[36:39], a[116:119], a[68:71], v[36:39]
  buffer_load_dwordx4 v1, s[12:15], s26 offen offset:1024 lds
  v_mfma_f32_16x16x32_bf16 v[40:43], a[116:119], a[84:87], v[28:31]
  v_exp_f32 v144, v144
  v_mfma_f32_16x16x32_bf16 v[40:43], a[120:123], a[88:91], v[40:43]
  ds_read_b128 a[156:159], v3 offset:10240
  ds_read_b128 a[160:163], v3 offset:11264
  v_mfma_f32_16x16x32_bf16 v[40:43], a[124:127], a[92:95], v[40:43]
  v_exp_f32 v145, v145
  v_mfma_f32_16x16x32_bf16 v[40:43], a[128:131], a[96:99], v[40:43]
  buffer_load_dwordx4 v1, s[12:15], s26 offen offset:2048 lds
  v_mfma_f32_16x16x32_bf16 v[44:47], a[128:131], a[112:115], v[28:31]
  v_exp_f32 v146, v146
  v_mfma_f32_16x16x32_bf16 v[44:47], a[124:127], a[108:111], v[44:47]
  v_cvt_pk_bf16_f32 v129, v130, v131
  v_cvt_pk_bf16_f32 v130, v144, v145
  v_mfma_f32_16x16x32_bf16 v[44:47], a[120:123], a[104:107], v[44:47]
  v_exp_f32 v147, v147
  v_mfma_f32_16x16x32_bf16 v[44:47], a[116:119], a[100:103], v[44:47]
  buffer_load_dwordx4 v1, s[12:15], s26 offen offset:3072 lds
  s_add_u32 m0, s29, 36864
  s_waitcnt lgkmcnt(4)
  v_mfma_f32_16x16x32_bf16 v[48:51], a[132:135], a[52:55], v[20:23]
  v_exp_f32 v132, v132
  v_mfma_f32_16x16x32_bf16 v[48:51], a[136:139], a[56:59], v[48:51]
  ds_read_b128 a[164:167], v3 offset:12288
  ds_read_b128 a[168:171], v3 offset:13312
  v_mfma_f32_16x16x32_bf16 v[48:51], a[140:143], a[60:63], v[48:51]
  v_exp_f32 v133, v133
  v_mfma_f32_16x16x32_bf16 v[48:51], a[144:147], a[64:67], v[48:51]
  buffer_load_dwordx4 v1, s[12:15], s32 offen offset:0 lds
  v_mfma_f32_16x16x32_bf16 v[52:55], a[144:147], a[80:83], v[24:27]
  v_exp_f32 v134, v134
  v_mfma_f32_16x16x32_bf16 v[52:55], a[140:143], a[76:79], v[52:55]
  v_cvt_pk_bf16_f32 v131, v146, v147
  v_cvt_pk_bf16_f32 v132, v132, v133
  v_mfma_f32_16x16x32_bf16 v[52:55], a[136:139], a[72:75], v[52:55]
  v_exp_f32 v135, v135
  v_mfma_f32_16x16x32_bf16 v[52:55], a[132:135], a[68:71], v[52:55]
  buffer_load_dwordx4 v1, s[12:15], s32 offen offset:1024 lds
  v_mfma_f32_16x16x32_bf16 v[56:59], a[132:135], a[84:87], v[28:31]
  v_exp_f32 v148, v148
  v_mfma_f32_16x16x32_bf16 v[56:59], a[136:139], a[88:91], v[56:59]
  ds_read_b128 a[172:175], v3 offset:14336
  ds_read_b128 a[176:179], v3 offset:15360
  v_mfma_f32_16x16x32_bf16 v[56:59], a[140:143], a[92:95], v[56:59]
  v_exp_f32 v149, v149
  v_mfma_f32_16x16x32_bf16 v[56:59], a[144:147], a[96:99], v[56:59]
  buffer_load_dwordx4 v1, s[12:15], s32 offen offset:2048 lds
  v_mfma_f32_16x16x32_bf16 v[60:63], a[144:147], a[112:115], v[28:31]
  v_exp_f32 v150, v150
  v_mfma_f32_16x16x32_bf16 v[60:63], a[140:143], a[108:111], v[60:63]
  v_cvt_pk_bf16_f32 v133, v134, v135
  v_cvt_pk_bf16_f32 v134, v148, v149
  v_mfma_f32_16x16x32_bf16 v[60:63], a[136:139], a[104:107], v[60:63]
  v_exp_f32 v151, v151
  v_mfma_f32_16x16x32_bf16 v[60:63], a[132:135], a[100:103], v[60:63]
  buffer_load_dwordx4 v1, s[12:15], s32 offen offset:3072 lds
  s_waitcnt lgkmcnt(4)
  v_mfma_f32_16x16x32_bf16 v[64:67], a[148:151], a[52:55], v[20:23]
  v_exp_f32 v136, v136
  v_mfma_f32_16x16x32_bf16 v[64:67], a[152:155], a[56:59], v[64:67]
  s_add_u32 s26, s26, 32768
  s_cmp_eq_u32 s26, s62
  s_cselect_b32 s26, s63, s26
  s_cselect_b32 s62, -1, s62
  v_mfma_f32_16x16x32_bf16 v[64:67], a[156:159], a[60:63], v[64:67]
  v_exp_f32 v137, v137
  v_mfma_f32_16x16x32_bf16 v[64:67], a[160:163], a[64:67], v[64:67]
  v_cvt_pk_bf16_f32 v135, v150, v151
  v_cvt_pk_bf16_f32 v136, v136, v137
  v_mfma_f32_16x16x32_bf16 v[68:71], a[160:163], a[80:83], v[20:23]
  v_exp_f32 v138, v138
  v_mfma_f32_16x16x32_bf16 v[68:71], a[156:159], a[76:79], v[68:71]
  v_mfma_f32_16x16x32_bf16 v[68:71], a[152:155], a[72:75], v[68:71]
  v_exp_f32 v139, v139
  v_mfma_f32_16x16x32_bf16 v[68:71], a[148:151], a[68:71], v[68:71]
  v_cvt_pk_bf16_f32 v137, v138, v139
  v_mfma_f32_16x16x32_bf16 v[72:75], a[148:151], a[84:87], v[24:27]
  v_exp_f32 v152, v152
  v_mfma_f32_16x16x32_bf16 v[72:75], a[152:155], a[88:91], v[72:75]
  v_mfma_f32_16x16x32_bf16 v[72:75], a[156:159], a[92:95], v[72:75]
  v_exp_f32 v153, v153
  v_mfma_f32_16x16x32_bf16 v[72:75], a[160:163], a[96:99], v[72:75]
  v_cvt_pk_bf16_f32 v138, v152, v153
  v_mfma_f32_16x16x32_bf16 v[76:79], a[160:163], a[112:115], v[28:31]
  v_exp_f32 v154, v154
  v_mfma_f32_16x16x32_bf16 v[76:79], a[156:159], a[108:111], v[76:79]
  s_waitcnt vmcnt(16) lgkmcnt(0)
  s_barrier
  ds_read_b128 a[116:119], v3 offset:32768
  ds_read_b128 a[120:123], v3 offset:40960
  ds_read_b128 a[124:127], v3 offset:33792
  ds_read_b128 a[128:131], v3 offset:41984
  v_mfma_f32_16x16x32_bf16 v[76:79], a[152:155], a[104:107], v[76:79]
  v_exp_f32 v155, v155
  v_mfma_f32_16x16x32_bf16 v[76:79], a[148:151], a[100:103], v[76:79]
  v_cvt_pk_bf16_f32 v139, v154, v155
  v_mfma_f32_16x16x32_bf16 v[80:83], a[164:167], a[52:55], v[20:23]
  v_exp_f32 v140, v140
  v_mfma_f32_16x16x32_bf16 v[80:83], a[168:171], a[56:59], v[80:83]
  ds_read_b128 a[132:135], v3 offset:34816
  ds_read_b128 a[136:139], v3 offset:43008
  v_mfma_f32_16x16x32_bf16 v[80:83], a[172:175], a[60:63], v[80:83]
  v_exp_f32 v141, v141
  v_mfma_f32_16x16x32_bf16 v[80:83], a[176:179], a[64:67], v[80:83]
  v_cvt_pk_bf16_f32 v140, v140, v141
  v_mfma_f32_16x16x32_bf16 v[84:87], a[176:179], a[80:83], v[20:23]
  v_exp_f32 v142, v142
  v_mfma_f32_16x16x32_bf16 v[84:87], a[172:175], a[76:79], v[84:87]
  v_mfma_f32_16x16x32_bf16 v[84:87], a[168:171], a[72:75], v[84:87]
  v_exp_f32 v143, v143
  v_mfma_f32_16x16x32_bf16 v[84:87], a[164:167], a[68:71], v[84:87]
  v_cvt_pk_bf16_f32 v141, v142, v143
  v_mfma_f32_16x16x32_bf16 v[88:91], a[164:167], a[84:87], v[20:23]
  v_exp_f32 v156, v156
  v_mfma_f32_16x16x32_bf16 v[88:91], a[168:171], a[88:91], v[88:91]
  ds_read_b128 a[140:143], v3 offset:35840
  ds_read_b128 a[144:147], v3 offset:44032
  v_mfma_f32_16x16x32_bf16 v[88:91], a[172:175], a[92:95], v[88:91]
  v_exp_f32 v157, v157
  v_mfma_f32_16x16x32_bf16 v[88:91], a[176:179], a[96:99], v[88:91]
  v_cvt_pk_bf16_f32 v142, v156, v157
  v_mfma_f32_16x16x32_bf16 v[92:95], a[176:179], a[112:115], v[24:27]
  v_exp_f32 v158, v158
  v_mfma_f32_16x16x32_bf16 v[92:95], a[172:175], a[108:111], v[92:95]
  v_mfma_f32_16x16x32_bf16 v[92:95], a[168:171], a[104:107], v[92:95]
  v_exp_f32 v159, v159
  v_mfma_f32_16x16x32_bf16 v[92:95], a[164:167], a[100:103], v[92:95]
  v_cvt_pk_bf16_f32 v143, v158, v159
  s_waitcnt lgkmcnt(6)
  s_add_u32 m0, s29, 65536
  v_mfma_f32_16x16x32_bf16 v[160:163], a[116:119], v[96:99], v[160:163]
  v_exp_f32 v32, v32
  v_mfma_f32_16x16x32_bf16 v[160:163], a[120:123], v[128:131], v[160:163]
  ds_read_b128 a[148:151], v3 offset:36864
  ds_read_b128 a[152:155], v3 offset:45056
  v_mfma_f32_16x16x32_bf16 v[164:167], a[120:123], v[132:135], v[164:167]
  v_exp_f32 v33, v33
  v_mfma_f32_16x16x32_bf16 v[164:167], a[116:119], v[100:103], v[164:167]
  buffer_load_dwordx4 v1, s[12:15], s25 offen offset:0 lds
  s_add_u32 s32, s25, 4096
  v_mfma_f32_16x16x32_bf16 v[168:171], a[116:119], v[104:107], v[168:171]
  v_exp_f32 v34, v34
  v_mfma_f32_16x16x32_bf16 v[168:171], a[120:123], v[136:139], v[168:171]
  v_cvt_pk_bf16_f32 v32, v32, v33
  v_mfma_f32_16x16x32_bf16 v[172:175], a[120:123], v[140:143], v[172:175]
  v_exp_f32 v35, v35
  v_mfma_f32_16x16x32_bf16 v[172:175], a[116:119], v[108:111], v[172:175]
  buffer_load_dwordx4 v1, s[12:15], s25 offen offset:1024 lds
  s_waitcnt lgkmcnt(6)
  v_mfma_f32_16x16x32_bf16 a[32:35], a[48:51], v[96:99], a[32:35]
  v_mfma_f32_16x16x32_bf16 a[32:35], a[48:51], v[128:131], a[32:35]
  v_mfma_f32_16x16x32_bf16 v[176:179], a[124:127], v[96:99], v[176:179]
  v_exp_f32 v48, v48
  v_mfma_f32_16x16x32_bf16 v[176:179], a[128:131], v[128:131], v[176:179]
  ds_read_b128 a[156:159], v3 offset:37888
  ds_read_b128 a[160:163], v3 offset:46080
  v_mfma_f32_16x16x32_bf16 v[180:183], a[128:131], v[132:135], v[180:183]
  v_exp_f32 v49, v49
  v_mfma_f32_16x16x32_bf16 v[180:183], a[124:127], v[100:103], v[180:183]
  buffer_load_dwordx4 v1, s[12:15], s25 offen offset:2048 lds
  v_mfma_f32_16x16x32_bf16 v[184:187], a[124:127], v[104:107], v[184:187]
  v_exp_f32 v50, v50
  v_mfma_f32_16x16x32_bf16 v[184:187], a[128:131], v[136:139], v[184:187]
  v_cvt_pk_bf16_f32 v33, v34, v35
  v_cvt_pk_bf16_f32 v34, v48, v49
  v_mfma_f32_16x16x32_bf16 v[188:191], a[128:131], v[140:143], v[188:191]
  v_exp_f32 v51, v51
  v_mfma_f32_16x16x32_bf16 v[188:191], a[124:127], v[108:111], v[188:191]
  buffer_load_dwordx4 v1, s[12:15], s25 offen offset:3072 lds
  s_add_u32 m0, s29, 69632
  s_waitcnt lgkmcnt(6)
  v_mfma_f32_16x16x32_bf16 a[36:39], a[48:51], v[100:103], a[36:39]
  v_mfma_f32_16x16x32_bf16 a[36:39], a[48:51], v[132:135], a[36:39]
  v_mfma_f32_16x16x32_bf16 v[192:195], a[132:135], v[96:99], v[192:195]
  v_exp_f32 v36, v36
  v_mfma_f32_16x16x32_bf16 v[192:195], a[136:139], v[128:131], v[192:195]
  ds_read_b128 a[164:167], v3 offset:38912
  ds_read_b128 a[168:171], v3 offset:47104
  v_mfma_f32_16x16x32_bf16 v[196:199], a[136:139], v[132:135], v[196:199]
  v_exp_f32 v37, v37
  v_mfma_f32_16x16x32_bf16 v[196:199], a[132:135], v[100:103], v[196:199]
  buffer_load_dwordx4 v1, s[12:15], s32 offen offset:0 lds
  v_mfma_f32_16x16x32_bf16 v[200:203], a[132:135], v[104:107], v[200:203]
  v_exp_f32 v38, v38
  v_mfma_f32_16x16x32_bf16 v[200:203], a[136:139], v[136:139], v[200:203]
  v_cvt_pk_bf16_f32 v35, v50, v51
  v_cvt_pk_bf16_f32 v36, v36, v37
  v_mfma_f32_16x16x32_bf16 v[204:207], a[136:139], v[140:143], v[204:207]
  v_exp_f32 v39, v39
  v_mfma_f32_16x16x32_bf16 v[204:207], a[132:135], v[108:111], v[204:207]
  buffer_load_dwordx4 v1, s[12:15], s32 offen offset:1024 lds
  s_waitcnt lgkmcnt(6)
  v_mfma_f32_16x16x32_bf16 a[40:43], a[48:51], v[104:107], a[40:43]
  v_mfma_f32_16x16x32_bf16 a[40:43], a[48:51], v[136:139], a[40:43]
  v_mfma_f32_16x16x32_bf16 v[208:211], a[140:143], v[96:99], v[208:211]
  v_exp_f32 v52, v52
  v_mfma_f32_16x16x32_bf16 v[208:211], a[144:147], v[128:131], v[208:211]
  ds_read_b128 a[172:175], v3 offset:39936
  ds_read_b128 a[176:179], v3 offset:48128
  v_mfma_f32_16x16x32_bf16 v[212:215], a[144:147], v[132:135], v[212:215]
  v_exp_f32 v53, v53
  v_mfma_f32_16x16x32_bf16 v[212:215], a[140:143], v[100:103], v[212:215]
  buffer_load_dwordx4 v1, s[12:15], s32 offen offset:2048 lds
  v_mfma_f32_16x16x32_bf16 v[216:219], a[140:143], v[104:107], v[216:219]
  v_exp_f32 v54, v54
  v_mfma_f32_16x16x32_bf16 v[216:219], a[144:147], v[136:139], v[216:219]
  v_cvt_pk_bf16_f32 v37, v38, v39
  v_cvt_pk_bf16_f32 v38, v52, v53
  v_mfma_f32_16x16x32_bf16 v[220:223], a[144:147], v[140:143], v[220:223]
  v_exp_f32 v55, v55
  v_mfma_f32_16x16x32_bf16 v[220:223], a[140:143], v[108:111], v[220:223]
  buffer_load_dwordx4 v1, s[12:15], s32 offen offset:3072 lds
  s_waitcnt lgkmcnt(6)
  v_mfma_f32_16x16x32_bf16 a[44:47], a[48:51], v[108:111], a[44:47]
  v_mfma_f32_16x16x32_bf16 a[44:47], a[48:51], v[140:143], a[44:47]
  v_mfma_f32_16x16x32_bf16 v[224:227], a[148:151], v[96:99], v[224:227]
  v_exp_f32 v40, v40
  v_mfma_f32_16x16x32_bf16 v[224:227], a[152:155], v[128:131], v[224:227]
  s_add_u32 s25, s25, 32768
  s_cmp_eq_u32 s25, s27
  s_cselect_b32 s25, s28, s25
  s_cselect_b32 s27, -1, s27
  v_mfma_f32_16x16x32_bf16 v[228:231], a[152:155], v[132:135], v[228:231]
  v_exp_f32 v41, v41
  v_mfma_f32_16x16x32_bf16 v[228:231], a[148:151], v[100:103], v[228:231]
  v_cvt_pk_bf16_f32 v39, v54, v55
  v_cvt_pk_bf16_f32 v40, v40, v41
  v_mfma_f32_16x16x32_bf16 v[232:235], a[148:151], v[104:107], v[232:235]
  v_exp_f32 v42, v42
  v_mfma_f32_16x16x32_bf16 v[232:235], a[152:155], v[136:139], v[232:235]
  v_mfma_f32_16x16x32_bf16 v[236:239], a[152:155], v[140:143], v[236:239]
  v_exp_f32 v43, v43
  v_mfma_f32_16x16x32_bf16 v[236:239], a[148:151], v[108:111], v[236:239]
  v_cvt_pk_bf16_f32 v41, v42, v43
  s_waitcnt lgkmcnt(4)
  v_mfma_f32_16x16x32_bf16 v[240:243], a[156:159], v[96:99], v[240:243]
  v_exp_f32 v56, v56
  v_mfma_f32_16x16x32_bf16 v[240:243], a[160:163], v[128:131], v[240:243]
  v_mfma_f32_16x16x32_bf16 v[244:247], a[160:163], v[132:135], v[244:247]
  v_exp_f32 v57, v57
  v_mfma_f32_16x16x32_bf16 v[244:247], a[156:159], v[100:103], v[244:247]
  v_cvt_pk_bf16_f32 v42, v56, v57
  v_mfma_f32_16x16x32_bf16 v[248:251], a[156:159], v[104:107], v[248:251]
  v_exp_f32 v58, v58
  v_mfma_f32_16x16x32_bf16 v[248:251], a[160:163], v[136:139], v[248:251]
  s_waitcnt vmcnt(16) lgkmcnt(0)
  s_barrier
  ds_read_b128 a[116:119], v2 offset:0
  ds_read_b128 a[120:123], v2 offset:1024
  ds_read_b128 a[124:127], v2 offset:2048
  ds_read_b128 a[128:131], v2 offset:3072
  v_mfma_f32_16x16x32_bf16 v[252:255], a[160:163], v[140:143], v[252:255]
  v_exp_f32 v59, v59
  v_mfma_f32_16x16x32_bf16 v[252:255], a[156:159], v[108:111], v[252:255]
  v_cvt_pk_bf16_f32 v43, v58, v59
  v_mfma_f32_16x16x32_bf16 a[0:3], a[164:167], v[96:99], a[0:3]
  v_exp_f32 v44, v44
  v_mfma_f32_16x16x32_bf16 a[0:3], a[168:171], v[128:131], a[0:3]
  ds_read_b128 a[132:135], v2 offset:4096
  ds_read_b128 a[136:139], v2 offset:5120
  v_mfma_f32_16x16x32_bf16 a[4:7], a[168:171], v[132:135], a[4:7]
  v_exp_f32 v45, v45
  v_mfma_f32_16x16x32_bf16 a[4:7], a[164:167], v[100:103], a[4:7]
  v_cvt_pk_bf16_f32 v44, v44, v45
  v_mfma_f32_16x16x32_bf16 a[8:11], a[164:167], v[104:107], a[8:11]
  v_exp_f32 v46, v46
  v_mfma_f32_16x16x32_bf16 a[8:11], a[168:171], v[136:139], a[8:11]
  v_mfma_f32_16x16x32_bf16 a[12:15], a[168:171], v[140:143], a[12:15]
  v_exp_f32 v47, v47
  v_mfma_f32_16x16x32_bf16 a[12:15], a[164:167], v[108:111], a[12:15]
  v_cvt_pk_bf16_f32 v45, v46, v47
  v_mfma_f32_16x16x32_bf16 a[16:19], a[172:175], v[96:99], a[16:19]
  v_exp_f32 v60, v60
  v_mfma_f32_16x16x32_bf16 a[16:19], a[176:179], v[128:131], a[16:19]
  ds_read_b128 a[140:143], v2 offset:6144
  ds_read_b128 a[144:147], v2 offset:7168
  v_mfma_f32_16x16x32_bf16 a[20:23], a[176:179], v[132:135], a[20:23]
  v_exp_f32 v61, v61
  v_mfma_f32_16x16x32_bf16 a[20:23], a[172:175], v[100:103], a[20:23]
  v_cvt_pk_bf16_f32 v46, v60, v61
  v_mfma_f32_16x16x32_bf16 a[24:27], a[172:175], v[104:107], a[24:27]
  v_exp_f32 v62, v62
  v_mfma_f32_16x16x32_bf16 a[24:27], a[176:179], v[136:139], a[24:27]
  v_mfma_f32_16x16x32_bf16 a[28:31], a[176:179], v[140:143], a[28:31]
  v_exp_f32 v63, v63
  v_mfma_f32_16x16x32_bf16 a[28:31], a[172:175], v[108:111], a[28:31]
  v_cvt_pk_bf16_f32 v47, v62, v63
Lk2_m2:
  s_sub_u32 s35, 15, s21
  s_lshl_b32 s33, s20, 7
  s_lshl_b32 s34, s35, 3
  s_add_u32 s33, s33, s34
  s_lshl_b32 s34, s23, 2
  s_add_u32 s33, s33, s34
  s_lshl_b32 s33, s33, 12
  buffer_load_dwordx4 a[180:183], v1, s[8:11], s33 offen offset:0
  buffer_load_dwordx4 a[184:187], v1, s[8:11], s33 offen offset:1024
  buffer_load_dwordx4 a[188:191], v1, s[8:11], s33 offen offset:2048
  buffer_load_dwordx4 a[192:195], v1, s[8:11], s33 offen offset:3072
  s_add_u32 s33, s33, 4096
  buffer_load_dwordx4 a[196:199], v1, s[8:11], s33 offen offset:0
  buffer_load_dwordx4 a[200:203], v1, s[8:11], s33 offen offset:1024
  buffer_load_dwordx4 a[204:207], v1, s[8:11], s33 offen offset:2048
  buffer_load_dwordx4 a[208:211], v1, s[8:11], s33 offen offset:3072
  s_add_u32 s33, s33, 4096
  buffer_load_dwordx4 a[212:215], v1, s[8:11], s33 offen offset:0
  buffer_load_dwordx4 a[216:219], v1, s[8:11], s33 offen offset:1024
  buffer_load_dwordx4 a[220:223], v1, s[8:11], s33 offen offset:2048
  buffer_load_dwordx4 a[224:227], v1, s[8:11], s33 offen offset:3072
  s_add_u32 s33, s33, 4096
  buffer_load_dwordx4 a[228:231], v1, s[8:11], s33 offen offset:0
  buffer_load_dwordx4 a[232:235], v1, s[8:11], s33 offen offset:1024
  buffer_load_dwordx4 a[236:239], v1, s[8:11], s33 offen offset:2048
  buffer_load_dwordx4 a[240:243], v1, s[8:11], s33 offen offset:3072
  s_lshl_b32 s33, s23, 6
  s_add_i32 s33, s33, -64
  s_cmp_gt_i32 s33, 0
  s_cselect_b32 s34, 0, 0xf149f2ca
  s_cmp_lt_i32 s33, 0
  s_cselect_b32 s33, 0xf149f2ca, 0
  v_mov_b32 v20, s34
  v_mov_b32 v21, s34
  v_mov_b32 v22, s34
  v_mov_b32 v23, s34
  v_mov_b32 v28, s33
  v_mov_b32 v29, s33
  v_mov_b32 v30, s33
  v_mov_b32 v31, s33
  v_med3_f32 v24, v16, v20, v28
  v_med3_f32 v25, v17, v20, v28
  v_med3_f32 v26, v18, v20, v28
  v_med3_f32 v27, v19, v20, v28
  s_waitcnt lgkmcnt(4)
  s_add_u32 m0, s29, 98304
  v_mfma_f32_16x16x32_bf16 v[96:99], a[116:119], a[52:55], v[24:27]
  v_exp_f32 v64, v64
  v_mfma_f32_16x16x32_bf16 v[96:99], a[120:123], a[56:59], v[96:99]
  ds_read_b128 a[148:151], v2 offset:8192
  ds_read_b128 a[152:155], v2 offset:9216
  v_mfma_f32_16x16x32_bf16 v[96:99], a[124:127], a[60:63], v[96:99]
  v_exp_f32 v65, v65
  v_mfma_f32_16x16x32_bf16 v[96:99], a[128:131], a[64:67], v[96:99]
  buffer_load_dwordx4 v1, s[12:15], s26 offen offset:0 lds
  s_add_u32 s32, s26, 4096
  v_mfma_f32_16x16x32_bf16 v[100:103], a[128:131], a[80:83], v[28:31]
  v_exp_f32 v66, v66
  v_mfma_f32_16x16x32_bf16 v[100:103], a[124:127], a[76:79], v[100:103]
  v_cvt_pk_bf16_f32 v64, v64, v65
  v_mfma_f32_16x16x32_bf16 v[100:103], a[120:123], a[72:75], v[100:103]
  v_exp_f32 v67, v67
  v_mfma_f32_16x16x32_bf16 v[100:103], a[116:119], a[68:71], v[100:103]
  buffer_load_dwordx4 v1, s[12:15], s26 offen offset:1024 lds
  v_mfma_f32_16x16x32_bf16 v[104:107], a[116:119], a[84:87], v[28:31]
  v_exp_f32 v80, v80
  v_mfma_f32_16x16x32_bf16 v[104:107], a[120:123], a[88:91], v[104:107]
  ds_read_b128 a[156:159], v2 offset:10240
  ds_read_b128 a[160:163], v2 offset:11264
  v_mfma_f32_16x16x32_bf16 v[104:107], a[124:127], a[92:95], v[104:107]
  v_exp_f32 v81, v81
  v_mfma_f32_16x16x32_bf16 v[104:107], a[128:131], a[96:99], v[104:107]
  buffer_load_dwordx4 v1, s[12:15], s26 offen offset:2048 lds
  v_mfma_f32_16x16x32_bf16 v[108:111], a[128:131], a[112:115], v[28:31]
  v_exp_f32 v82, v82
  v_mfma_f32_16x16x32_bf16 v[108:111], a[124:127], a[108:111], v[108:111]
  v_cvt_pk_bf16_f32 v65, v66, v67
  v_cvt_pk_bf16_f32 v66, v80, v81
  v_mfma_f32_16x16x32_bf16 v[108:111], a[120:123], a[104:107], v[108:111]
  v_exp_f32 v83, v83
  v_mfma_f32_16x16x32_bf16 v[108:111], a[116:119], a[100:103], v[108:111]
  buffer_load_dwordx4 v1, s[12:15], s26 offen offset:3072 lds
  s_add_u32 m0, s29, 102400
  s_waitcnt lgkmcnt(4)
  v_mfma_f32_16x16x32_bf16 v[112:115], a[132:135], a[52:55], v[20:23]
  v_exp_f32 v68, v68
  v_mfma_f32_16x16x32_bf16 v[112:115], a[136:139], a[56:59], v[112:115]
  ds_read_b128 a[164:167], v2 offset:12288
  ds_read_b128 a[168:171], v2 offset:13312
  v_mfma_f32_16x16x32_bf16 v[112:115], a[140:143], a[60:63], v[112:115]
  v_exp_f32 v69, v69
  v_mfma_f32_16x16x32_bf16 v[112:115], a[144:147], a[64:67], v[112:115]
  buffer_load_dwordx4 v1, s[12:15], s32 offen offset:0 lds
  v_mfma_f32_16x16x32_bf16 v[116:119], a[144:147], a[80:83], v[24:27]
  v_exp_f32 v70, v70
  v_mfma_f32_16x16x32_bf16 v[116:119], a[140:143], a[76:79], v[116:119]
  v_cvt_pk_bf16_f32 v67, v82, v83
  v_cvt_pk_bf16_f32 v68, v68, v69
  v_mfma_f32_16x16x32_bf16 v[116:119], a[136:139], a[72:75], v[116:119]
  v_exp_f32 v71, v71
  v_mfma_f32_16x16x32_bf16 v[116:119], a[132:135], a[68:71], v[116:119]
  buffer_load_dwordx4 v1, s[12:15], s32 offen offset:1024 lds
  v_mfma_f32_16x16x32_bf16 v[120:123], a[132:135], a[84:87], v[28:31]
  v_exp_f32 v84, v84
  v_mfma_f32_16x16x32_bf16 v[120:123], a[136:139], a[88:91], v[120:123]
  ds_read_b128 a[172:175], v2 offset:14336
  ds_read_b128 a[176:179], v2 offset:15360
  v_mfma_f32_16x16x32_bf16 v[120:123], a[140:143], a[92:95], v[120:123]
  v_exp_f32 v85, v85
  v_mfma_f32_16x16x32_bf16 v[120:123], a[144:147], a[96:99], v[120:123]
  buffer_load_dwordx4 v1, s[12:15], s32 offen offset:2048 lds
  v_mfma_f32_16x16x32_bf16 v[124:127], a[144:147], a[112:115], v[28:31]
  v_exp_f32 v86, v86
  v_mfma_f32_16x16x32_bf16 v[124:127], a[140:143], a[108:111], v[124:127]
  v_cvt_pk_bf16_f32 v69, v70, v71
  v_cvt_pk_bf16_f32 v70, v84, v85
  v_mfma_f32_16x16x32_bf16 v[124:127], a[136:139], a[104:107], v[124:127]
  v_exp_f32 v87, v87
  v_mfma_f32_16x16x32_bf16 v[124:127], a[132:135], a[100:103], v[124:127]
  buffer_load_dwordx4 v1, s[12:15], s32 offen offset:3072 lds
  s_waitcnt lgkmcnt(4)
  v_mfma_f32_16x16x32_bf16 v[128:131], a[148:151], a[52:55], v[20:23]
  v_exp_f32 v72, v72
  v_mfma_f32_16x16x32_bf16 v[128:131], a[152:155], a[56:59], v[128:131]
  s_add_u32 s26, s26, 32768
  s_cmp_eq_u32 s26, s62
  s_cselect_b32 s26, s63, s26
  s_cselect_b32 s62, -1, s62
  v_mfma_f32_16x16x32_bf16 v[128:131], a[156:159], a[60:63], v[128:131]
  v_exp_f32 v73, v73
  v_mfma_f32_16x16x32_bf16 v[128:131], a[160:163], a[64:67], v[128:131]
  v_cvt_pk_bf16_f32 v71, v86, v87
  v_cvt_pk_bf16_f32 v72, v72, v73
  v_mfma_f32_16x16x32_bf16 v[132:135], a[160:163], a[80:83], v[20:23]
  v_exp_f32 v74, v74
  v_mfma_f32_16x16x32_bf16 v[132:135], a[156:159], a[76:79], v[132:135]
  v_mfma_f32_16x16x32_bf16 v[132:135], a[152:155], a[72:75], v[132:135]
  v_exp_f32 v75, v75
  v_mfma_f32_16x16x32_bf16 v[132:135], a[148:151], a[68:71], v[132:135]
  v_cvt_pk_bf16_f32 v73, v74, v75
  v_mfma_f32_16x16x32_bf16 v[136:139], a[148:151], a[84:87], v[24:27]
  v_exp_f32 v88, v88
  v_mfma_f32_16x16x32_bf16 v[136:139], a[152:155], a[88:91], v[136:139]
  v_mfma_f32_16x16x32_bf16 v[136:139], a[156:159], a[92:95], v[136:139]
  v_exp_f32 v89, v89
  v_mfma_f32_16x16x32_bf16 v[136:139], a[160:163], a[96:99], v[136:139]
  v_cvt_pk_bf16_f32 v74, v88, v89
  v_mfma_f32_16x16x32_bf16 v[140:143], a[160:163], a[112:115], v[28:31]
  v_exp_f32 v90, v90
  v_mfma_f32_16x16x32_bf16 v[140:143], a[156:159], a[108:111], v[140:143]
  s_waitcnt vmcnt(32) lgkmcnt(0)
  s_barrier
  ds_read_b128 a[116:119], v2 offset:32768
  ds_read_b128 a[120:123], v2 offset:40960
  ds_read_b128 a[124:127], v2 offset:33792
  ds_read_b128 a[128:131], v2 offset:41984
  v_mfma_f32_16x16x32_bf16 v[140:143], a[152:155], a[104:107], v[140:143]
  v_exp_f32 v91, v91
  v_mfma_f32_16x16x32_bf16 v[140:143], a[148:151], a[100:103], v[140:143]
  v_cvt_pk_bf16_f32 v75, v90, v91
  v_mfma_f32_16x16x32_bf16 v[144:147], a[164:167], a[52:55], v[20:23]
  v_exp_f32 v76, v76
  v_mfma_f32_16x16x32_bf16 v[144:147], a[168:171], a[56:59], v[144:147]
  ds_read_b128 a[132:135], v2 offset:34816
  ds_read_b128 a[136:139], v2 offset:43008
  v_mfma_f32_16x16x32_bf16 v[144:147], a[172:175], a[60:63], v[144:147]
  v_exp_f32 v77, v77
  v_mfma_f32_16x16x32_bf16 v[144:147], a[176:179], a[64:67], v[144:147]
  v_cvt_pk_bf16_f32 v76, v76, v77
  v_mfma_f32_16x16x32_bf16 v[148:151], a[176:179], a[80:83], v[20:23]
  v_exp_f32 v78, v78
  v_mfma_f32_16x16x32_bf16 v[148:151], a[172:175], a[76:79], v[148:151]
  v_mfma_f32_16x16x32_bf16 v[148:151], a[168:171], a[72:75], v[148:151]
  v_exp_f32 v79, v79
  v_mfma_f32_16x16x32_bf16 v[148:151], a[164:167], a[68:71], v[148:151]
  v_cvt_pk_bf16_f32 v77, v78, v79
  v_mfma_f32_16x16x32_bf16 v[152:155], a[164:167], a[84:87], v[20:23]
  v_exp_f32 v92, v92
  v_mfma_f32_16x16x32_bf16 v[152:155], a[168:171], a[88:91], v[152:155]
  ds_read_b128 a[140:143], v2 offset:35840
  ds_read_b128 a[144:147], v2 offset:44032
  v_mfma_f32_16x16x32_bf16 v[152:155], a[172:175], a[92:95], v[152:155]
  v_exp_f32 v93, v93
  v_mfma_f32_16x16x32_bf16 v[152:155], a[176:179], a[96:99], v[152:155]
  v_cvt_pk_bf16_f32 v78, v92, v93
  v_mfma_f32_16x16x32_bf16 v[156:159], a[176:179], a[112:115], v[24:27]
  v_exp_f32 v94, v94
  v_mfma_f32_16x16x32_bf16 v[156:159], a[172:175], a[108:111], v[156:159]
  v_mfma_f32_16x16x32_bf16 v[156:159], a[168:171], a[104:107], v[156:159]
  v_exp_f32 v95, v95
  v_mfma_f32_16x16x32_bf16 v[156:159], a[164:167], a[100:103], v[156:159]
  v_cvt_pk_bf16_f32 v79, v94, v95
  s_waitcnt lgkmcnt(6)
  s_add_u32 m0, s29, 0
  v_mfma_f32_16x16x32_bf16 v[160:163], a[116:119], v[32:35], v[160:163]
  v_exp_f32 v96, v96
  v_mfma_f32_16x16x32_bf16 v[160:163], a[120:123], v[64:67], v[160:163]
  ds_read_b128 a[148:151], v2 offset:36864
  ds_read_b128 a[152:155], v2 offset:45056
  v_mfma_f32_16x16x32_bf16 v[164:167], a[120:123], v[68:71], v[164:167]
  v_exp_f32 v97, v97
  v_mfma_f32_16x16x32_bf16 v[164:167], a[116:119], v[36:39], v[164:167]
  buffer_load_dwordx4 v1, s[12:15], s25 offen offset:0 lds
  s_add_u32 s32, s25, 4096
  v_mfma_f32_16x16x32_bf16 v[168:171], a[116:119], v[40:43], v[168:171]
  v_exp_f32 v98, v98
  v_mfma_f32_16x16x32_bf16 v[168:171], a[120:123], v[72:75], v[168:171]
  v_cvt_pk_bf16_f32 v96, v96, v97
  v_mfma_f32_16x16x32_bf16 v[172:175], a[120:123], v[76:79], v[172:175]
  v_exp_f32 v99, v99
  v_mfma_f32_16x16x32_bf16 v[172:175], a[116:119], v[44:47], v[172:175]
  buffer_load_dwordx4 v1, s[12:15], s25 offen offset:1024 lds
  s_waitcnt lgkmcnt(6)
  v_mfma_f32_16x16x32_bf16 a[32:35], a[48:51], v[32:35], a[32:35]
  v_mfma_f32_16x16x32_bf16 a[32:35], a[48:51], v[64:67], a[32:35]
  v_mfma_f32_16x16x32_bf16 v[176:179], a[124:127], v[32:35], v[176:179]
  v_exp_f32 v112, v112
  v_mfma_f32_16x16x32_bf16 v[176:179], a[128:131], v[64:67], v[176:179]
  ds_read_b128 a[156:159], v2 offset:37888
  ds_read_b128 a[160:163], v2 offset:46080
  v_mfma_f32_16x16x32_bf16 v[180:183], a[128:131], v[68:71], v[180:183]
  v_exp_f32 v113, v113
  v_mfma_f32_16x16x32_bf16 v[180:183], a[124:127], v[36:39], v[180:183]
  buffer_load_dwordx4 v1, s[12:15], s25 offen offset:2048 lds
  v_mfma_f32_16x16x32_bf16 v[184:187], a[124:127], v[40:43], v[184:187]
  v_exp_f32 v114, v114
  v_mfma_f32_16x16x32_bf16 v[184:187], a[128:131], v[72:75], v[184:187]
  v_cvt_pk_bf16_f32 v97, v98, v99
  v_cvt_pk_bf16_f32 v98, v112, v113
  v_mfma_f32_16x16x32_bf16 v[188:191], a[128:131], v[76:79], v[188:191]
  v_exp_f32 v115, v115
  v_mfma_f32_16x16x32_bf16 v[188:191], a[124:127], v[44:47], v[188:191]
  buffer_load_dwordx4 v1, s[12:15], s25 offen offset:3072 lds
  s_add_u32 m0, s29, 4096
  s_waitcnt lgkmcnt(6)
  v_mfma_f32_16x16x32_bf16 a[36:39], a[48:51], v[36:39], a[36:39]
  v_mfma_f32_16x16x32_bf16 a[36:39], a[48:51], v[68:71], a[36:39]
  v_mfma_f32_16x16x32_bf16 v[192:195], a[132:135], v[32:35], v[192:195]
  v_exp_f32 v100, v100
  v_mfma_f32_16x16x32_bf16 v[192:195], a[136:139], v[64:67], v[192:195]
  ds_read_b128 a[164:167], v2 offset:38912
  ds_read_b128 a[168:171], v2 offset:47104
  v_mfma_f32_16x16x32_bf16 v[196:199], a[136:139], v[68:71], v[196:199]
  v_exp_f32 v101, v101
  v_mfma_f32_16x16x32_bf16 v[196:199], a[132:135], v[36:39], v[196:199]
  buffer_load_dwordx4 v1, s[12:15], s32 offen offset:0 lds
  v_mfma_f32_16x16x32_bf16 v[200:203], a[132:135], v[40:43], v[200:203]
  v_exp_f32 v102, v102
  v_mfma_f32_16x16x32_bf16 v[200:203], a[136:139], v[72:75], v[200:203]
  v_cvt_pk_bf16_f32 v99, v114, v115
  v_cvt_pk_bf16_f32 v100, v100, v101
  v_mfma_f32_16x16x32_bf16 v[204:207], a[136:139], v[76:79], v[204:207]
  v_exp_f32 v103, v103
  v_mfma_f32_16x16x32_bf16 v[204:207], a[132:135], v[44:47], v[204:207]
  buffer_load_dwordx4 v1, s[12:15], s32 offen offset:1024 lds
  s_waitcnt lgkmcnt(6)
  v_mfma_f32_16x16x32_bf16 a[40:43], a[48:51], v[40:43], a[40:43]
  v_mfma_f32_16x16x32_bf16 a[40:43], a[48:51], v[72:75], a[40:43]
  v_mfma_f32_16x16x32_bf16 v[208:211], a[140:143], v[32:35], v[208:211]
  v_exp_f32 v116, v116
  v_mfma_f32_16x16x32_bf16 v[208:211], a[144:147], v[64:67], v[208:211]
  ds_read_b128 a[172:175], v2 offset:39936
  ds_read_b128 a[176:179], v2 offset:48128
  v_mfma_f32_16x16x32_bf16 v[212:215], a[144:147], v[68:71], v[212:215]
  v_exp_f32 v117, v117
  v_mfma_f32_16x16x32_bf16 v[212:215], a[140:143], v[36:39], v[212:215]
  buffer_load_dwordx4 v1, s[12:15], s32 offen offset:2048 lds
  v_mfma_f32_16x16x32_bf16 v[216:219], a[140:143], v[40:43], v[216:219]
  v_exp_f32 v118, v118
  v_mfma_f32_16x16x32_bf16 v[216:219], a[144:147], v[72:75], v[216:219]
  v_cvt_pk_bf16_f32 v101, v102, v103
  v_cvt_pk_bf16_f32 v102, v116, v117
  v_mfma_f32_16x16x32_bf16 v[220:223], a[144:147], v[76:79], v[220:223]
  v_exp_f32 v119, v119
  v_mfma_f32_16x16x32_bf16 v[220:223], a[140:143], v[44:47], v[220:223]
  buffer_load_dwordx4 v1, s[12:15], s32 offen offset:3072 lds
  s_waitcnt lgkmcnt(6)
  v_mfma_f32_16x16x32_bf16 a[44:47], a[48:51], v[44:47], a[44:47]
  v_mfma_f32_16x16x32_bf16 a[44:47], a[48:51], v[76:79], a[44:47]
  v_mfma_f32_16x16x32_bf16 v[224:227], a[148:151], v[32:35], v[224:227]
  v_exp_f32 v104, v104
  v_mfma_f32_16x16x32_bf16 v[224:227], a[152:155], v[64:67], v[224:227]
  s_add_u32 s25, s25, 32768
  s_cmp_eq_u32 s25, s27
  s_cselect_b32 s25, s28, s25
  s_cselect_b32 s27, -1, s27
  v_mfma_f32_16x16x32_bf16 v[228:231], a[152:155], v[68:71], v[228:231]
  v_exp_f32 v105, v105
  v_mfma_f32_16x16x32_bf16 v[228:231], a[148:151], v[36:39], v[228:231]
  v_cvt_pk_bf16_f32 v103, v118, v119
  v_cvt_pk_bf16_f32 v104, v104, v105
  v_mfma_f32_16x16x32_bf16 v[232:235], a[148:151], v[40:43], v[232:235]
  v_exp_f32 v106, v106
  v_mfma_f32_16x16x32_bf16 v[232:235], a[152:155], v[72:75], v[232:235]
  v_mfma_f32_16x16x32_bf16 v[236:239], a[152:155], v[76:79], v[236:239]
  v_exp_f32 v107, v107
  v_mfma_f32_16x16x32_bf16 v[236:239], a[148:151], v[44:47], v[236:239]
  v_cvt_pk_bf16_f32 v105, v106, v107
  s_waitcnt lgkmcnt(4)
  v_mfma_f32_16x16x32_bf16 v[240:243], a[156:159], v[32:35], v[240:243]
  v_exp_f32 v120, v120
  v_mfma_f32_16x16x32_bf16 v[240:243], a[160:163], v[64:67], v[240:243]
  v_mfma_f32_16x16x32_bf16 v[244:247], a[160:163], v[68:71], v[244:247]
  v_exp_f32 v121, v121
  v_mfma_f32_16x16x32_bf16 v[244:247], a[156:159], v[36:39], v[244:247]
  v_cvt_pk_bf16_f32 v106, v120, v121
  v_mfma_f32_16x16x32_bf16 v[248:251], a[156:159], v[40:43], v[248:251]
  v_exp_f32 v122, v122
  v_mfma_f32_16x16x32_bf16 v[248:251], a[160:163], v[72:75], v[248:251]
  s_waitcnt vmcnt(32) lgkmcnt(0)
  s_barrier
  ds_read_b128 a[116:119], v3 offset:0
  ds_read_b128 a[120:123], v3 offset:1024
  ds_read_b128 a[124:127], v3 offset:2048
  ds_read_b128 a[128:131], v3 offset:3072
  v_mfma_f32_16x16x32_bf16 v[252:255], a[160:163], v[76:79], v[252:255]
  v_exp_f32 v123, v123
  v_mfma_f32_16x16x32_bf16 v[252:255], a[156:159], v[44:47], v[252:255]
  v_cvt_pk_bf16_f32 v107, v122, v123
  v_mfma_f32_16x16x32_bf16 a[0:3], a[164:167], v[32:35], a[0:3]
  v_exp_f32 v108, v108
  v_mfma_f32_16x16x32_bf16 a[0:3], a[168:171], v[64:67], a[0:3]
  ds_read_b128 a[132:135], v3 offset:4096
  ds_read_b128 a[136:139], v3 offset:5120
  v_mfma_f32_16x16x32_bf16 a[4:7], a[168:171], v[68:71], a[4:7]
  v_exp_f32 v109, v109
  v_mfma_f32_16x16x32_bf16 a[4:7], a[164:167], v[36:39], a[4:7]
  v_cvt_pk_bf16_f32 v108, v108, v109
  v_mfma_f32_16x16x32_bf16 a[8:11], a[164:167], v[40:43], a[8:11]
  v_exp_f32 v110, v110
  v_mfma_f32_16x16x32_bf16 a[8:11], a[168:171], v[72:75], a[8:11]
  v_mfma_f32_16x16x32_bf16 a[12:15], a[168:171], v[76:79], a[12:15]
  v_exp_f32 v111, v111
  v_mfma_f32_16x16x32_bf16 a[12:15], a[164:167], v[44:47], a[12:15]
  v_cvt_pk_bf16_f32 v109, v110, v111
  v_mfma_f32_16x16x32_bf16 a[16:19], a[172:175], v[32:35], a[16:19]
  v_exp_f32 v124, v124
  v_mfma_f32_16x16x32_bf16 a[16:19], a[176:179], v[64:67], a[16:19]
  ds_read_b128 a[140:143], v3 offset:6144
  ds_read_b128 a[144:147], v3 offset:7168
  v_mfma_f32_16x16x32_bf16 a[20:23], a[176:179], v[68:71], a[20:23]
  v_exp_f32 v125, v125
  v_mfma_f32_16x16x32_bf16 a[20:23], a[172:175], v[36:39], a[20:23]
  v_cvt_pk_bf16_f32 v110, v124, v125
  v_mfma_f32_16x16x32_bf16 a[24:27], a[172:175], v[40:43], a[24:27]
  v_exp_f32 v126, v126
  v_mfma_f32_16x16x32_bf16 a[24:27], a[176:179], v[72:75], a[24:27]
  v_mfma_f32_16x16x32_bf16 a[28:31], a[176:179], v[76:79], a[28:31]
  v_exp_f32 v127, v127
  v_mfma_f32_16x16x32_bf16 a[28:31], a[172:175], v[44:47], a[28:31]
  v_cvt_pk_bf16_f32 v111, v126, v127
  s_waitcnt vmcnt(16)
  s_waitcnt lgkmcnt(4)
  s_add_u32 m0, s29, 32768
  v_mfma_f32_16x16x32_bf16 v[32:35], a[116:119], a[180:183], 0
  v_exp_f32 v128, v128
  v_mfma_f32_16x16x32_bf16 v[32:35], a[120:123], a[184:187], v[32:35]
  ds_read_b128 a[148:151], v3 offset:8192
  ds_read_b128 a[152:155], v3 offset:9216
  v_mfma_f32_16x16x32_bf16 v[32:35], a[124:127], a[188:191], v[32:35]
  v_exp_f32 v129, v129
  v_mfma_f32_16x16x32_bf16 v[32:35], a[128:131], a[192:195], v[32:35]
  buffer_load_dwordx4 v1, s[12:15], s26 offen offset:0 lds
  s_add_u32 s32, s26, 4096
  v_mfma_f32_16x16x32_bf16 v[36:39], a[128:131], a[208:211], 0
  v_exp_f32 v130, v130
  v_mfma_f32_16x16x32_bf16 v[36:39], a[124:127], a[204:207], v[36:39]
  v_cvt_pk_bf16_f32 v128, v128, v129
  v_mfma_f32_16x16x32_bf16 v[36:39], a[120:123], a[200:203], v[36:39]
  v_exp_f32 v131, v131
  v_mfma_f32_16x16x32_bf16 v[36:39], a[116:119], a[196:199], v[36:39]
  buffer_load_dwordx4 v1, s[12:15], s26 offen offset:1024 lds
  v_mfma_f32_16x16x32_bf16 v[40:43], a[116:119], a[212:215], 0
  v_exp_f32 v144, v144
  v_mfma_f32_16x16x32_bf16 v[40:43], a[120:123], a[216:219], v[40:43]
  ds_read_b128 a[156:159], v3 offset:10240
  ds_read_b128 a[160:163], v3 offset:11264
  v_mfma_f32_16x16x32_bf16 v[40:43], a[124:127], a[220:223], v[40:43]
  v_exp_f32 v145, v145
  v_mfma_f32_16x16x32_bf16 v[40:43], a[128:131], a[224:227], v[40:43]
  buffer_load_dwordx4 v1, s[12:15], s26 offen offset:2048 lds
  v_mfma_f32_16x16x32_bf16 v[44:47], a[128:131], a[240:243], 0
  v_exp_f32 v146, v146
  v_mfma_f32_16x16x32_bf16 v[44:47], a[124:127], a[236:239], v[44:47]
  v_cvt_pk_bf16_f32 v129, v130, v131
  v_cvt_pk_bf16_f32 v130, v144, v145
  v_mfma_f32_16x16x32_bf16 v[44:47], a[120:123], a[232:235], v[44:47]
  v_exp_f32 v147, v147
  v_mfma_f32_16x16x32_bf16 v[44:47], a[116:119], a[228:231], v[44:47]
  buffer_load_dwordx4 v1, s[12:15], s26 offen offset:3072 lds
  s_add_u32 m0, s29, 36864
  s_waitcnt lgkmcnt(4)
  v_mfma_f32_16x16x32_bf16 v[48:51], a[132:135], a[180:183], 0
  v_exp_f32 v132, v132
  v_mfma_f32_16x16x32_bf16 v[48:51], a[136:139], a[184:187], v[48:51]
  ds_read_b128 a[164:167], v3 offset:12288
  ds_read_b128 a[168:171], v3 offset:13312
  v_mfma_f32_16x16x32_bf16 v[48:51], a[140:143], a[188:191], v[48:51]
  v_exp_f32 v133, v133
  v_mfma_f32_16x16x32_bf16 v[48:51], a[144:147], a[192:195], v[48:51]
  buffer_load_dwordx4 v1, s[12:15], s32 offen offset:0 lds
  v_mfma_f32_16x16x32_bf16 v[52:55], a[144:147], a[208:211], 0
  v_exp_f32 v134, v134
  v_mfma_f32_16x16x32_bf16 v[52:55], a[140:143], a[204:207], v[52:55]
  v_cvt_pk_bf16_f32 v131, v146, v147
  v_cvt_pk_bf16_f32 v132, v132, v133
  v_mfma_f32_16x16x32_bf16 v[52:55], a[136:139], a[200:203], v[52:55]
  v_exp_f32 v135, v135
  v_mfma_f32_16x16x32_bf16 v[52:55], a[132:135], a[196:199], v[52:55]
  buffer_load_dwordx4 v1, s[12:15], s32 offen offset:1024 lds
  v_mfma_f32_16x16x32_bf16 v[56:59], a[132:135], a[212:215], 0
  v_exp_f32 v148, v148
  v_mfma_f32_16x16x32_bf16 v[56:59], a[136:139], a[216:219], v[56:59]
  ds_read_b128 a[172:175], v3 offset:14336
  ds_read_b128 a[176:179], v3 offset:15360
  v_mfma_f32_16x16x32_bf16 v[56:59], a[140:143], a[220:223], v[56:59]
  v_exp_f32 v149, v149
  v_mfma_f32_16x16x32_bf16 v[56:59], a[144:147], a[224:227], v[56:59]
  buffer_load_dwordx4 v1, s[12:15], s32 offen offset:2048 lds
  v_mfma_f32_16x16x32_bf16 v[60:63], a[144:147], a[240:243], 0
  v_exp_f32 v150, v150
  v_mfma_f32_16x16x32_bf16 v[60:63], a[140:143], a[236:239], v[60:63]
  v_cvt_pk_bf16_f32 v133, v134, v135
  v_cvt_pk_bf16_f32 v134, v148, v149
  v_mfma_f32_16x16x32_bf16 v[60:63], a[136:139], a[232:235], v[60:63]
  v_exp_f32 v151, v151
  v_mfma_f32_16x16x32_bf16 v[60:63], a[132:135], a[228:231], v[60:63]
  buffer_load_dwordx4 v1, s[12:15], s32 offen offset:3072 lds
  s_waitcnt lgkmcnt(4)
  v_mfma_f32_16x16x32_bf16 v[64:67], a[148:151], a[180:183], 0
  v_exp_f32 v136, v136
  v_mfma_f32_16x16x32_bf16 v[64:67], a[152:155], a[184:187], v[64:67]
  s_add_u32 s26, s26, 32768
  s_cmp_eq_u32 s26, s62
  s_cselect_b32 s26, s63, s26
  s_cselect_b32 s62, -1, s62
  v_mfma_f32_16x16x32_bf16 v[64:67], a[156:159], a[188:191], v[64:67]
  v_exp_f32 v137, v137
  v_mfma_f32_16x16x32_bf16 v[64:67], a[160:163], a[192:195], v[64:67]
  v_cvt_pk_bf16_f32 v135, v150, v151
  v_cvt_pk_bf16_f32 v136, v136, v137
  v_mfma_f32_16x16x32_bf16 v[68:71], a[160:163], a[208:211], 0
  v_exp_f32 v138, v138
  v_mfma_f32_16x16x32_bf16 v[68:71], a[156:159], a[204:207], v[68:71]
  v_mfma_f32_16x16x32_bf16 v[68:71], a[152:155], a[200:203], v[68:71]
  v_exp_f32 v139, v139
  v_mfma_f32_16x16x32_bf16 v[68:71], a[148:151], a[196:199], v[68:71]
  v_cvt_pk_bf16_f32 v137, v138, v139
  v_mfma_f32_16x16x32_bf16 v[72:75], a[148:151], a[212:215], 0
  v_exp_f32 v152, v152
  v_mfma_f32_16x16x32_bf16 v[72:75], a[152:155], a[216:219], v[72:75]
  v_mfma_f32_16x16x32_bf16 v[72:75], a[156:159], a[220:223], v[72:75]
  v_exp_f32 v153, v153
  v_mfma_f32_16x16x32_bf16 v[72:75], a[160:163], a[224:227], v[72:75]
  v_cvt_pk_bf16_f32 v138, v152, v153
  v_mfma_f32_16x16x32_bf16 v[76:79], a[160:163], a[240:243], 0
  v_exp_f32 v154, v154
  v_mfma_f32_16x16x32_bf16 v[76:79], a[156:159], a[236:239], v[76:79]
  s_waitcnt vmcnt(16) lgkmcnt(0)
  s_barrier
  ds_read_b128 a[116:119], v3 offset:32768
  ds_read_b128 a[120:123], v3 offset:40960
  ds_read_b128 a[124:127], v3 offset:33792
  ds_read_b128 a[128:131], v3 offset:41984
  v_mfma_f32_16x16x32_bf16 v[76:79], a[152:155], a[232:235], v[76:79]
  v_exp_f32 v155, v155
  v_mfma_f32_16x16x32_bf16 v[76:79], a[148:151], a[228:231], v[76:79]
  v_cvt_pk_bf16_f32 v139, v154, v155
  v_mfma_f32_16x16x32_bf16 v[80:83], a[164:167], a[180:183], 0
  v_exp_f32 v140, v140
  v_mfma_f32_16x16x32_bf16 v[80:83], a[168:171], a[184:187], v[80:83]
  ds_read_b128 a[132:135], v3 offset:34816
  ds_read_b128 a[136:139], v3 offset:43008
  v_mfma_f32_16x16x32_bf16 v[80:83], a[172:175], a[188:191], v[80:83]
  v_exp_f32 v141, v141
  v_mfma_f32_16x16x32_bf16 v[80:83], a[176:179], a[192:195], v[80:83]
  v_cvt_pk_bf16_f32 v140, v140, v141
  v_mfma_f32_16x16x32_bf16 v[84:87], a[176:179], a[208:211], 0
  v_exp_f32 v142, v142
  v_mfma_f32_16x16x32_bf16 v[84:87], a[172:175], a[204:207], v[84:87]
  v_mfma_f32_16x16x32_bf16 v[84:87], a[168:171], a[200:203], v[84:87]
  v_exp_f32 v143, v143
  v_mfma_f32_16x16x32_bf16 v[84:87], a[164:167], a[196:199], v[84:87]
  v_cvt_pk_bf16_f32 v141, v142, v143
  v_mfma_f32_16x16x32_bf16 v[88:91], a[164:167], a[212:215], 0
  v_exp_f32 v156, v156
  v_mfma_f32_16x16x32_bf16 v[88:91], a[168:171], a[216:219], v[88:91]
  ds_read_b128 a[140:143], v3 offset:35840
  ds_read_b128 a[144:147], v3 offset:44032
  v_mfma_f32_16x16x32_bf16 v[88:91], a[172:175], a[220:223], v[88:91]
  v_exp_f32 v157, v157
  v_mfma_f32_16x16x32_bf16 v[88:91], a[176:179], a[224:227], v[88:91]
  v_cvt_pk_bf16_f32 v142, v156, v157
  v_mfma_f32_16x16x32_bf16 v[92:95], a[176:179], a[240:243], 0
  v_exp_f32 v158, v158
  v_mfma_f32_16x16x32_bf16 v[92:95], a[172:175], a[236:239], v[92:95]
  v_mfma_f32_16x16x32_bf16 v[92:95], a[168:171], a[232:235], v[92:95]
  v_exp_f32 v159, v159
  v_mfma_f32_16x16x32_bf16 v[92:95], a[164:167], a[228:231], v[92:95]
  v_cvt_pk_bf16_f32 v143, v158, v159
  s_waitcnt lgkmcnt(6)
  s_add_u32 m0, s29, 65536
  v_mfma_f32_16x16x32_bf16 v[160:163], a[116:119], v[96:99], v[160:163]
  v_exp_f32 v32, v32
  v_mfma_f32_16x16x32_bf16 v[160:163], a[120:123], v[128:131], v[160:163]
  ds_read_b128 a[148:151], v3 offset:36864
  ds_read_b128 a[152:155], v3 offset:45056
  v_mfma_f32_16x16x32_bf16 v[164:167], a[120:123], v[132:135], v[164:167]
  v_exp_f32 v33, v33
  v_mfma_f32_16x16x32_bf16 v[164:167], a[116:119], v[100:103], v[164:167]
  buffer_load_dwordx4 v1, s[12:15], s25 offen offset:0 lds
  s_add_u32 s32, s25, 4096
  v_mfma_f32_16x16x32_bf16 v[168:171], a[116:119], v[104:107], v[168:171]
  v_exp_f32 v34, v34
  v_mfma_f32_16x16x32_bf16 v[168:171], a[120:123], v[136:139], v[168:171]
  v_cvt_pk_bf16_f32 v32, v32, v33
  v_mfma_f32_16x16x32_bf16 v[172:175], a[120:123], v[140:143], v[172:175]
  v_exp_f32 v35, v35
  v_mfma_f32_16x16x32_bf16 v[172:175], a[116:119], v[108:111], v[172:175]
  buffer_load_dwordx4 v1, s[12:15], s25 offen offset:1024 lds
  s_waitcnt lgkmcnt(6)
  v_mfma_f32_16x16x32_bf16 a[32:35], a[48:51], v[96:99], a[32:35]
  v_mfma_f32_16x16x32_bf16 a[32:35], a[48:51], v[128:131], a[32:35]
  v_mfma_f32_16x16x32_bf16 v[176:179], a[124:127], v[96:99], v[176:179]
  v_exp_f32 v48, v48
  v_mfma_f32_16x16x32_bf16 v[176:179], a[128:131], v[128:131], v[176:179]
  ds_read_b128 a[156:159], v3 offset:37888
  ds_read_b128 a[160:163], v3 offset:46080
  v_mfma_f32_16x16x32_bf16 v[180:183], a[128:131], v[132:135], v[180:183]
  v_exp_f32 v49, v49
  v_mfma_f32_16x16x32_bf16 v[180:183], a[124:127], v[100:103], v[180:183]
  buffer_load_dwordx4 v1, s[12:15], s25 offen offset:2048 lds
  v_mfma_f32_16x16x32_bf16 v[184:187], a[124:127], v[104:107], v[184:187]
  v_exp_f32 v50, v50
  v_mfma_f32_16x16x32_bf16 v[184:187], a[128:131], v[136:139], v[184:187]
  v_cvt_pk_bf16_f32 v33, v34, v35
  v_cvt_pk_bf16_f32 v34, v48, v49
  v_mfma_f32_16x16x32_bf16 v[188:191], a[128:131], v[140:143], v[188:191]
  v_exp_f32 v51, v51
  v_mfma_f32_16x16x32_bf16 v[188:191], a[124:127], v[108:111], v[188:191]
  buffer_load_dwordx4 v1, s[12:15], s25 offen offset:3072 lds
  s_add_u32 m0, s29, 69632
  s_waitcnt lgkmcnt(6)
  v_mfma_f32_16x16x32_bf16 a[36:39], a[48:51], v[100:103], a[36:39]
  v_mfma_f32_16x16x32_bf16 a[36:39], a[48:51], v[132:135], a[36:39]
  v_mfma_f32_16x16x32_bf16 v[192:195], a[132:135], v[96:99], v[192:195]
  v_exp_f32 v36, v36
  v_mfma_f32_16x16x32_bf16 v[192:195], a[136:139], v[128:131], v[192:195]
  ds_read_b128 a[164:167], v3 offset:38912
  ds_read_b128 a[168:171], v3 offset:47104
  v_mfma_f32_16x16x32_bf16 v[196:199], a[136:139], v[132:135], v[196:199]
  v_exp_f32 v37, v37
  v_mfma_f32_16x16x32_bf16 v[196:199], a[132:135], v[100:103], v[196:199]
  buffer_load_dwordx4 v1, s[12:15], s32 offen offset:0 lds
  v_mfma_f32_16x16x32_bf16 v[200:203], a[132:135], v[104:107], v[200:203]
  v_exp_f32 v38, v38
  v_mfma_f32_16x16x32_bf16 v[200:203], a[136:139], v[136:139], v[200:203]
  v_cvt_pk_bf16_f32 v35, v50, v51
  v_cvt_pk_bf16_f32 v36, v36, v37
  v_mfma_f32_16x16x32_bf16 v[204:207], a[136:139], v[140:143], v[204:207]
  v_exp_f32 v39, v39
  v_mfma_f32_16x16x32_bf16 v[204:207], a[132:135], v[108:111], v[204:207]
  buffer_load_dwordx4 v1, s[12:15], s32 offen offset:1024 lds
  s_waitcnt lgkmcnt(6)
  v_mfma_f32_16x16x32_bf16 a[40:43], a[48:51], v[104:107], a[40:43]
  v_mfma_f32_16x16x32_bf16 a[40:43], a[48:51], v[136:139], a[40:43]
  v_mfma_f32_16x16x32_bf16 v[208:211], a[140:143], v[96:99], v[208:211]
  v_exp_f32 v52, v52
  v_mfma_f32_16x16x32_bf16 v[208:211], a[144:147], v[128:131], v[208:211]
  ds_read_b128 a[172:175], v3 offset:39936
  ds_read_b128 a[176:179], v3 offset:48128
  v_mfma_f32_16x16x32_bf16 v[212:215], a[144:147], v[132:135], v[212:215]
  v_exp_f32 v53, v53
  v_mfma_f32_16x16x32_bf16 v[212:215], a[140:143], v[100:103], v[212:215]
  buffer_load_dwordx4 v1, s[12:15], s32 offen offset:2048 lds
  v_mfma_f32_16x16x32_bf16 v[216:219], a[140:143], v[104:107], v[216:219]
  v_exp_f32 v54, v54
  v_mfma_f32_16x16x32_bf16 v[216:219], a[144:147], v[136:139], v[216:219]
  v_cvt_pk_bf16_f32 v37, v38, v39
  v_cvt_pk_bf16_f32 v38, v52, v53
  v_mfma_f32_16x16x32_bf16 v[220:223], a[144:147], v[140:143], v[220:223]
  v_exp_f32 v55, v55
  v_mfma_f32_16x16x32_bf16 v[220:223], a[140:143], v[108:111], v[220:223]
  buffer_load_dwordx4 v1, s[12:15], s32 offen offset:3072 lds
  s_waitcnt lgkmcnt(6)
  v_mfma_f32_16x16x32_bf16 a[44:47], a[48:51], v[108:111], a[44:47]
  v_mfma_f32_16x16x32_bf16 a[44:47], a[48:51], v[140:143], a[44:47]
  v_mfma_f32_16x16x32_bf16 v[224:227], a[148:151], v[96:99], v[224:227]
  v_exp_f32 v40, v40
  v_mfma_f32_16x16x32_bf16 v[224:227], a[152:155], v[128:131], v[224:227]
  s_add_u32 s25, s25, 32768
  s_cmp_eq_u32 s25, s27
  s_cselect_b32 s25, s28, s25
  s_cselect_b32 s27, -1, s27
  v_mfma_f32_16x16x32_bf16 v[228:231], a[152:155], v[132:135], v[228:231]
  v_exp_f32 v41, v41
  v_mfma_f32_16x16x32_bf16 v[228:231], a[148:151], v[100:103], v[228:231]
  v_cvt_pk_bf16_f32 v39, v54, v55
  v_cvt_pk_bf16_f32 v40, v40, v41
  v_mfma_f32_16x16x32_bf16 v[232:235], a[148:151], v[104:107], v[232:235]
  v_exp_f32 v42, v42
  v_mfma_f32_16x16x32_bf16 v[232:235], a[152:155], v[136:139], v[232:235]
  v_mfma_f32_16x16x32_bf16 v[236:239], a[152:155], v[140:143], v[236:239]
  v_exp_f32 v43, v43
  v_mfma_f32_16x16x32_bf16 v[236:239], a[148:151], v[108:111], v[236:239]
  v_cvt_pk_bf16_f32 v41, v42, v43
  s_waitcnt lgkmcnt(4)
  v_mfma_f32_16x16x32_bf16 v[240:243], a[156:159], v[96:99], v[240:243]
  v_exp_f32 v56, v56
  v_mfma_f32_16x16x32_bf16 v[240:243], a[160:163], v[128:131], v[240:243]
  v_mfma_f32_16x16x32_bf16 v[244:247], a[160:163], v[132:135], v[244:247]
  v_exp_f32 v57, v57
  v_mfma_f32_16x16x32_bf16 v[244:247], a[156:159], v[100:103], v[244:247]
  v_cvt_pk_bf16_f32 v42, v56, v57
  v_mfma_f32_16x16x32_bf16 v[248:251], a[156:159], v[104:107], v[248:251]
  v_exp_f32 v58, v58
  v_mfma_f32_16x16x32_bf16 v[248:251], a[160:163], v[136:139], v[248:251]
  s_waitcnt vmcnt(16) lgkmcnt(0)
  s_barrier
  ds_read_b128 a[116:119], v2 offset:0
  ds_read_b128 a[120:123], v2 offset:1024
  ds_read_b128 a[124:127], v2 offset:2048
  ds_read_b128 a[128:131], v2 offset:3072
  v_mfma_f32_16x16x32_bf16 v[252:255], a[160:163], v[140:143], v[252:255]
  v_exp_f32 v59, v59
  v_mfma_f32_16x16x32_bf16 v[252:255], a[156:159], v[108:111], v[252:255]
  v_cvt_pk_bf16_f32 v43, v58, v59
  v_mfma_f32_16x16x32_bf16 a[0:3], a[164:167], v[96:99], a[0:3]
  v_exp_f32 v44, v44
  v_mfma_f32_16x16x32_bf16 a[0:3], a[168:171], v[128:131], a[0:3]
  ds_read_b128 a[132:135], v2 offset:4096
  ds_read_b128 a[136:139], v2 offset:5120
  v_mfma_f32_16x16x32_bf16 a[4:7], a[168:171], v[132:135], a[4:7]
  v_exp_f32 v45, v45
  v_mfma_f32_16x16x32_bf16 a[4:7], a[164:167], v[100:103], a[4:7]
  v_cvt_pk_bf16_f32 v44, v44, v45
  v_mfma_f32_16x16x32_bf16 a[8:11], a[164:167], v[104:107], a[8:11]
  v_exp_f32 v46, v46
  v_mfma_f32_16x16x32_bf16 a[8:11], a[168:171], v[136:139], a[8:11]
  v_mfma_f32_16x16x32_bf16 a[12:15], a[168:171], v[140:143], a[12:15]
  v_exp_f32 v47, v47
  v_mfma_f32_16x16x32_bf16 a[12:15], a[164:167], v[108:111], a[12:15]
  v_cvt_pk_bf16_f32 v45, v46, v47
  v_mfma_f32_16x16x32_bf16 a[16:19], a[172:175], v[96:99], a[16:19]
  v_exp_f32 v60, v60
  v_mfma_f32_16x16x32_bf16 a[16:19], a[176:179], v[128:131], a[16:19]
  ds_read_b128 a[140:143], v2 offset:6144
  ds_read_b128 a[144:147], v2 offset:7168
  v_mfma_f32_16x16x32_bf16 a[20:23], a[176:179], v[132:135], a[20:23]
  v_exp_f32 v61, v61
  v_mfma_f32_16x16x32_bf16 a[20:23], a[172:175], v[100:103], a[20:23]
  v_cvt_pk_bf16_f32 v46, v60, v61
  v_mfma_f32_16x16x32_bf16 a[24:27], a[172:175], v[104:107], a[24:27]
  v_exp_f32 v62, v62
  v_mfma_f32_16x16x32_bf16 a[24:27], a[176:179], v[136:139], a[24:27]
  v_mfma_f32_16x16x32_bf16 a[28:31], a[176:179], v[140:143], a[28:31]
  v_exp_f32 v63, v63
  v_mfma_f32_16x16x32_bf16 a[28:31], a[172:175], v[108:111], a[28:31]
  v_cvt_pk_bf16_f32 v47, v62, v63
  v_accvgpr_read_b32 v20, a32
  v_accvgpr_read_b32 v21, a36
  v_accvgpr_read_b32 v22, a40
  v_accvgpr_read_b32 v23, a44
  v_rcp_f32 v8, v20
  v_rcp_f32 v9, v21
  v_rcp_f32 v10, v22
  v_rcp_f32 v11, v23
  v_subrev_u32 v20, 0x21800000, v20
  v_subrev_u32 v21, 0x21800000, v21
  v_subrev_u32 v22, 0x21800000, v22
  v_subrev_u32 v23, 0x21800000, v23
  v_max_u32 v12, v20, v21
  v_max3_u32 v12, v12, v22, v23
  s_mov_b32 s64, 0x207
  v_pk_mul_f32 v[160:161], v[160:161], v[8:9] op_sel:[0,0] op_sel_hi:[1,0]
  v_pk_mul_f32 v[162:163], v[162:163], v[8:9] op_sel:[0,0] op_sel_hi:[1,0]
  v_pk_mul_f32 v[176:177], v[176:177], v[8:9] op_sel:[0,0] op_sel_hi:[1,0]
  v_pk_mul_f32 v[178:179], v[178:179], v[8:9] op_sel:[0,0] op_sel_hi:[1,0]
  v_cvt_pk_bf16_f32 v160, v160, v161
  v_cvt_pk_bf16_f32 v161, v162, v163
  v_cvt_pk_bf16_f32 v162, v176, v177
  v_cvt_pk_bf16_f32 v163, v178, v179
  s_nop 1
  v_mfma_f32_16x16x32_bf16 v[24:27], a[48:51], v[160:163], 0
  v_pk_mul_f32 v[164:165], v[164:165], v[8:9] op_sel:[0,1] op_sel_hi:[1,1]
  v_pk_mul_f32 v[166:167], v[166:167], v[8:9] op_sel:[0,1] op_sel_hi:[1,1]
  v_pk_mul_f32 v[180:181], v[180:181], v[8:9] op_sel:[0,1] op_sel_hi:[1,1]
  v_pk_mul_f32 v[182:183], v[182:183], v[8:9] op_sel:[0,1] op_sel_hi:[1,1]
  v_cvt_pk_bf16_f32 v164, v164, v165
  v_cvt_pk_bf16_f32 v165, v166, v167
  v_cvt_pk_bf16_f32 v166, v180, v181
  v_cvt_pk_bf16_f32 v167, v182, v183
  s_nop 1
  v_mfma_f32_16x16x32_bf16 v[24:27], a[48:51], v[164:167], v[24:27]
  v_pk_mul_f32 v[168:169], v[168:169], v[10:11] op_sel:[0,0] op_sel_hi:[1,0]
  v_pk_mul_f32 v[170:171], v[170:171], v[10:11] op_sel:[0,0] op_sel_hi:[1,0]
  v_pk_mul_f32 v[184:185], v[184:185], v[10:11] op_sel:[0,0] op_sel_hi:[1,0]
  v_pk_mul_f32 v[186:187], v[186:187], v[10:11] op_sel:[0,0] op_sel_hi:[1,0]
  v_cvt_pk_bf16_f32 v168, v168, v169
  v_cvt_pk_bf16_f32 v169, v170, v171
  v_cvt_pk_bf16_f32 v170, v184, v185
  v_cvt_pk_bf16_f32 v171, v186, v187
  s_nop 1
  v_mfma_f32_16x16x32_bf16 v[24:27], a[48:51], v[168:171], v[24:27]
  v_pk_mul_f32 v[172:173], v[172:173], v[10:11] op_sel:[0,1] op_sel_hi:[1,1]
  v_pk_mul_f32 v[174:175], v[174:175], v[10:11] op_sel:[0,1] op_sel_hi:[1,1]
  v_pk_mul_f32 v[188:189], v[188:189], v[10:11] op_sel:[0,1] op_sel_hi:[1,1]
  v_pk_mul_f32 v[190:191], v[190:191], v[10:11] op_sel:[0,1] op_sel_hi:[1,1]
  v_cvt_pk_bf16_f32 v172, v172, v173
  v_cvt_pk_bf16_f32 v173, v174, v175
  v_cvt_pk_bf16_f32 v174, v188, v189
  v_cvt_pk_bf16_f32 v175, v190, v191
  s_nop 1
  v_mfma_f32_16x16x32_bf16 v[24:27], a[48:51], v[172:175], v[24:27]
  v_pk_mul_f32 v[192:193], v[192:193], v[8:9] op_sel:[0,0] op_sel_hi:[1,0]
  v_pk_mul_f32 v[194:195], v[194:195], v[8:9] op_sel:[0,0] op_sel_hi:[1,0]
  v_pk_mul_f32 v[208:209], v[208:209], v[8:9] op_sel:[0,0] op_sel_hi:[1,0]
  v_pk_mul_f32 v[210:211], v[210:211], v[8:9] op_sel:[0,0] op_sel_hi:[1,0]
  v_cvt_pk_bf16_f32 v192, v192, v193
  v_cvt_pk_bf16_f32 v193, v194, v195
  v_cvt_pk_bf16_f32 v194, v208, v209
  v_cvt_pk_bf16_f32 v195, v210, v211
  s_nop 1
  v_mfma_f32_16x16x32_bf16 v[24:27], a[48:51], v[192:195], v[24:27]
  v_pk_mul_f32 v[196:197], v[196:197], v[8:9] op_sel:[0,1] op_sel_hi:[1,1]
  v_pk_mul_f32 v[198:199], v[198:199], v[8:9] op_sel:[0,1] op_sel_hi:[1,1]
  v_pk_mul_f32 v[212:213], v[212:213], v[8:9] op_sel:[0,1] op_sel_hi:[1,1]
  v_pk_mul_f32 v[214:215], v[214:215], v[8:9] op_sel:[0,1] op_sel_hi:[1,1]
  v_cvt_pk_bf16_f32 v196, v196, v197
  v_cvt_pk_bf16_f32 v197, v198, v199
  v_cvt_pk_bf16_f32 v198, v212, v213
  v_cvt_pk_bf16_f32 v199, v214, v215
  s_nop 1
  v_mfma_f32_16x16x32_bf16 v[24:27], a[48:51], v[196:199], v[24:27]
  v_pk_mul_f32 v[200:201], v[200:201], v[10:11] op_sel:[0,0] op_sel_hi:[1,0]
  v_pk_mul_f32 v[202:203], v[202:203], v[10:11] op_sel:[0,0] op_sel_hi:[1,0]
  v_pk_mul_f32 v[216:217], v[216:217], v[10:11] op_sel:[0,0] op_sel_hi:[1,0]
  v_pk_mul_f32 v[218:219], v[218:219], v[10:11] op_sel:[0,0] op_sel_hi:[1,0]
  v_cvt_pk_bf16_f32 v200, v200, v201
  v_cvt_pk_bf16_f32 v201, v202, v203
  v_cvt_pk_bf16_f32 v202, v216, v217
  v_cvt_pk_bf16_f32 v203, v218, v219
  s_nop 1
  v_mfma_f32_16x16x32_bf16 v[24:27], a[48:51], v[200:203], v[24:27]
  v_pk_mul_f32 v[204:205], v[204:205], v[10:11] op_sel:[0,1] op_sel_hi:[1,1]
  v_pk_mul_f32 v[206:207], v[206:207], v[10:11] op_sel:[0,1] op_sel_hi:[1,1]
  v_pk_mul_f32 v[220:221], v[220:221], v[10:11] op_sel:[0,1] op_sel_hi:[1,1]
  v_pk_mul_f32 v[222:223], v[222:223], v[10:11] op_sel:[0,1] op_sel_hi:[1,1]
  v_cvt_pk_bf16_f32 v204, v204, v205
  v_cvt_pk_bf16_f32 v205, v206, v207
  v_cvt_pk_bf16_f32 v206, v220, v221
  v_cvt_pk_bf16_f32 v207, v222, v223
  s_nop 1
  v_mfma_f32_16x16x32_bf16 v[24:27], a[48:51], v[204:207], v[24:27]
  v_pk_mul_f32 v[224:225], v[224:225], v[8:9] op_sel:[0,0] op_sel_hi:[1,0]
  v_pk_mul_f32 v[226:227], v[226:227], v[8:9] op_sel:[0,0] op_sel_hi:[1,0]
  v_pk_mul_f32 v[240:241], v[240:241], v[8:9] op_sel:[0,0] op_sel_hi:[1,0]
  v_pk_mul_f32 v[242:243], v[242:243], v[8:9] op_sel:[0,0] op_sel_hi:[1,0]
  v_cvt_pk_bf16_f32 v224, v224, v225
  v_cvt_pk_bf16_f32 v225, v226, v227
  v_cvt_pk_bf16_f32 v226, v240, v241
  v_cvt_pk_bf16_f32 v227, v242, v243
  s_nop 1
  v_mfma_f32_16x16x32_bf16 v[24:27], a[48:51], v[224:227], v[24:27]
  v_pk_mul_f32 v[228:229], v[228:229], v[8:9] op_sel:[0,1] op_sel_hi:[1,1]
  v_pk_mul_f32 v[230:231], v[230:231], v[8:9] op_sel:[0,1] op_sel_hi:[1,1]
  v_pk_mul_f32 v[244:245], v[244:245], v[8:9] op_sel:[0,1] op_sel_hi:[1,1]
  v_pk_mul_f32 v[246:247], v[246:247], v[8:9] op_sel:[0,1] op_sel_hi:[1,1]
  v_cvt_pk_bf16_f32 v228, v228, v229
  v_cvt_pk_bf16_f32 v229, v230, v231
  v_cvt_pk_bf16_f32 v230, v244, v245
  v_cvt_pk_bf16_f32 v231, v246, v247
  s_nop 1
  v_mfma_f32_16x16x32_bf16 v[24:27], a[48:51], v[228:231], v[24:27]
  v_pk_mul_f32 v[232:233], v[232:233], v[10:11] op_sel:[0,0] op_sel_hi:[1,0]
  v_pk_mul_f32 v[234:235], v[234:235], v[10:11] op_sel:[0,0] op_sel_hi:[1,0]
  v_pk_mul_f32 v[248:249], v[248:249], v[10:11] op_sel:[0,0] op_sel_hi:[1,0]
  v_pk_mul_f32 v[250:251], v[250:251], v[10:11] op_sel:[0,0] op_sel_hi:[1,0]
  v_cvt_pk_bf16_f32 v232, v232, v233
  v_cvt_pk_bf16_f32 v233, v234, v235
  v_cvt_pk_bf16_f32 v234, v248, v249
  v_cvt_pk_bf16_f32 v235, v250, v251
  s_nop 1
  v_mfma_f32_16x16x32_bf16 v[24:27], a[48:51], v[232:235], v[24:27]
  v_pk_mul_f32 v[236:237], v[236:237], v[10:11] op_sel:[0,1] op_sel_hi:[1,1]
  v_pk_mul_f32 v[238:239], v[238:239], v[10:11] op_sel:[0,1] op_sel_hi:[1,1]
  v_pk_mul_f32 v[252:253], v[252:253], v[10:11] op_sel:[0,1] op_sel_hi:[1,1]
  v_pk_mul_f32 v[254:255], v[254:255], v[10:11] op_sel:[0,1] op_sel_hi:[1,1]
  v_cvt_pk_bf16_f32 v236, v236, v237
  v_cvt_pk_bf16_f32 v237, v238, v239
  v_cvt_pk_bf16_f32 v238, v252, v253
  v_cvt_pk_bf16_f32 v239, v254, v255
  v_accvgpr_read_b32 v176, a0
  v_accvgpr_read_b32 v177, a1
  v_accvgpr_read_b32 v178, a2
  v_accvgpr_read_b32 v179, a3
  v_accvgpr_read_b32 v180, a16
  v_accvgpr_read_b32 v181, a17
  v_accvgpr_read_b32 v182, a18
  v_accvgpr_read_b32 v183, a19
  v_mfma_f32_16x16x32_bf16 v[24:27], a[48:51], v[236:239], v[24:27]
  v_pk_mul_f32 v[176:177], v[176:177], v[8:9] op_sel:[0,0] op_sel_hi:[1,0]
  v_pk_mul_f32 v[178:179], v[178:179], v[8:9] op_sel:[0,0] op_sel_hi:[1,0]
  v_pk_mul_f32 v[180:181], v[180:181], v[8:9] op_sel:[0,0] op_sel_hi:[1,0]
  v_pk_mul_f32 v[182:183], v[182:183], v[8:9] op_sel:[0,0] op_sel_hi:[1,0]
  v_cvt_pk_bf16_f32 v176, v176, v177
  v_cvt_pk_bf16_f32 v177, v178, v179
  v_cvt_pk_bf16_f32 v178, v180, v181
  v_cvt_pk_bf16_f32 v179, v182, v183
  v_accvgpr_read_b32 v184, a4
  v_accvgpr_read_b32 v185, a5
  v_accvgpr_read_b32 v186, a6
  v_accvgpr_read_b32 v187, a7
  v_accvgpr_read_b32 v188, a20
  v_accvgpr_read_b32 v189, a21
  v_accvgpr_read_b32 v190, a22
  v_accvgpr_read_b32 v191, a23
  v_mfma_f32_16x16x32_bf16 v[24:27], a[48:51], v[176:179], v[24:27]
  v_pk_mul_f32 v[184:185], v[184:185], v[8:9] op_sel:[0,1] op_sel_hi:[1,1]
  v_pk_mul_f32 v[186:187], v[186:187], v[8:9] op_sel:[0,1] op_sel_hi:[1,1]
  v_pk_mul_f32 v[188:189], v[188:189], v[8:9] op_sel:[0,1] op_sel_hi:[1,1]
  v_pk_mul_f32 v[190:191], v[190:191], v[8:9] op_sel:[0,1] op_sel_hi:[1,1]
  v_cvt_pk_bf16_f32 v184, v184, v185
  v_cvt_pk_bf16_f32 v185, v186, v187
  v_cvt_pk_bf16_f32 v186, v188, v189
  v_cvt_pk_bf16_f32 v187, v190, v191
  v_accvgpr_read_b32 v208, a8
  v_accvgpr_read_b32 v209, a9
  v_accvgpr_read_b32 v210, a10
  v_accvgpr_read_b32 v211, a11
  v_accvgpr_read_b32 v212, a24
  v_accvgpr_read_b32 v213, a25
  v_accvgpr_read_b32 v214, a26
  v_accvgpr_read_b32 v215, a27
  v_mfma_f32_16x16x32_bf16 v[24:27], a[48:51], v[184:187], v[24:27]
  v_pk_mul_f32 v[208:209], v[208:209], v[10:11] op_sel:[0,0] op_sel_hi:[1,0]
  v_pk_mul_f32 v[210:211], v[210:211], v[10:11] op_sel:[0,0] op_sel_hi:[1,0]
  v_pk_mul_f32 v[212:213], v[212:213], v[10:11] op_sel:[0,0] op_sel_hi:[1,0]
  v_pk_mul_f32 v[214:215], v[214:215], v[10:11] op_sel:[0,0] op_sel_hi:[1,0]
  v_cvt_pk_bf16_f32 v208, v208, v209
  v_cvt_pk_bf16_f32 v209, v210, v211
  v_cvt_pk_bf16_f32 v210, v212, v213
  v_cvt_pk_bf16_f32 v211, v214, v215
  v_accvgpr_read_b32 v216, a12
  v_accvgpr_read_b32 v217, a13
  v_accvgpr_read_b32 v218, a14
  v_accvgpr_read_b32 v219, a15
  v_accvgpr_read_b32 v220, a28
  v_accvgpr_read_b32 v221, a29
  v_accvgpr_read_b32 v222, a30
  v_accvgpr_read_b32 v223, a31
  v_mfma_f32_16x16x32_bf16 v[24:27], a[48:51], v[208:211], v[24:27]
  v_pk_mul_f32 v[216:217], v[216:217], v[10:11] op_sel:[0,1] op_sel_hi:[1,1]
  v_pk_mul_f32 v[218:219], v[218:219], v[10:11] op_sel:[0,1] op_sel_hi:[1,1]
  v_pk_mul_f32 v[220:221], v[220:221], v[10:11] op_sel:[0,1] op_sel_hi:[1,1]
  v_pk_mul_f32 v[222:223], v[222:223], v[10:11] op_sel:[0,1] op_sel_hi:[1,1]
  v_cvt_pk_bf16_f32 v216, v216, v217
  v_cvt_pk_bf16_f32 v217, v218, v219
  v_cvt_pk_bf16_f32 v218, v220, v221
  v_cvt_pk_bf16_f32 v219, v222, v223
  s_nop 1
  v_mfma_f32_16x16x32_bf16 v[24:27], a[48:51], v[216:219], v[24:27]
  v_cmp_lt_u32 vcc, 0x3c000000, v12
  s_nop 6
  v_cmp_class_f32 s[40:41], v24, s64
  s_nop 0
  s_or_b64 vcc, vcc, s[40:41]
  s_cbranch_vccnz Lbad_1
  s_lshl_b32 s33, s21, 20
  s_lshl_b32 s34, s20, 15
  s_add_u32 s33, s33, s34
  s_lshl_b32 s34, s23, 13
  s_add_u32 s36, s33, s34
  s_add_u32 s37, s36, 4096
  s_add_u32 s38, s36, 16384
  s_add_u32 s39, s36, 20480
  buffer_store_dwordx4 v[160:163], v1, s[16:19], s36 offen offset:0
  buffer_store_dwordx4 v[164:167], v1, s[16:19], s36 offen offset:2048
  buffer_store_dwordx4 v[168:171], v1, s[16:19], s37 offen offset:0
  buffer_store_dwordx4 v[172:175], v1, s[16:19], s37 offen offset:2048
  buffer_store_dwordx4 v[192:195], v1, s[16:19], s36 offen offset:1024
  buffer_store_dwordx4 v[196:199], v1, s[16:19], s36 offen offset:3072
  buffer_store_dwordx4 v[200:203], v1, s[16:19], s37 offen offset:1024
  buffer_store_dwordx4 v[204:207], v1, s[16:19], s37 offen offset:3072
  buffer_store_dwordx4 v[224:227], v1, s[16:19], s38 offen offset:0
  buffer_store_dwordx4 v[228:231], v1, s[16:19], s38 offen offset:2048
  buffer_store_dwordx4 v[232:235], v1, s[16:19], s39 offen offset:0
  buffer_store_dwordx4 v[236:239], v1, s[16:19], s39 offen offset:2048
  buffer_store_dwordx4 v[176:179], v1, s[16:19], s38 offen offset:1024
  buffer_store_dwordx4 v[184:187], v1, s[16:19], s38 offen offset:3072
  buffer_store_dwordx4 v[208:211], v1, s[16:19], s39 offen offset:1024
  buffer_store_dwordx4 v[216:219], v1, s[16:19], s39 offen offset:3072
  s_branch Lfd_2
Lbad_1:
  s_or_b32 s60, s60, 1
Lfd_2:
  s_sub_u32 s30, 7, s21
  s_cmp_lg_u32 s30, 0
  s_cbranch_scc1 Lk2_b0
  s_waitcnt vmcnt(8)
  s_waitcnt lgkmcnt(0)
  s_barrier
  s_lshl_b32 s33, s2, 2
  s_add_u32 s33, s33, s22
  s_lshl_b32 s34, s33, 11
  s_lshl_b32 s33, s33, 13
  v_lshlrev_b32 v8, 3, v1
  v_lshlrev_b32 v9, 1, v1
  buffer_load_dword v5, v8, s[44:47], s33 offen
  buffer_load_dword v6, v9, s[48:51], s34 offen
  ds_read_b128 a[116:119], v2 offset:32768
  ds_read_b128 a[120:123], v2 offset:40960
  ds_read_b128 a[124:127], v2 offset:33792
  ds_read_b128 a[128:131], v2 offset:41984
  ds_read_b128 a[132:135], v2 offset:34816
  ds_read_b128 a[136:139], v2 offset:43008
  ds_read_b128 a[140:143], v2 offset:35840
  ds_read_b128 a[144:147], v2 offset:44032
  v_exp_f32 v64, v64
  v_exp_f32 v65, v65
  v_exp_f32 v66, v66
  v_exp_f32 v67, v67
  v_exp_f32 v80, v80
  v_exp_f32 v81, v81
  v_exp_f32 v82, v82
  v_exp_f32 v83, v83
  v_cvt_pk_bf16_f32 v64, v64, v65
  v_cvt_pk_bf16_f32 v65, v66, v67
  v_exp_f32 v68, v68
  v_exp_f32 v69, v69
  v_exp_f32 v70, v70
  v_exp_f32 v71, v71
  v_cvt_pk_bf16_f32 v66, v80, v81
  v_cvt_pk_bf16_f32 v67, v82, v83
  v_exp_f32 v84, v84
  v_exp_f32 v85, v85
  v_exp_f32 v86, v86
  v_exp_f32 v87, v87
  v_cvt_pk_bf16_f32 v68, v68, v69
  v_cvt_pk_bf16_f32 v69, v70, v71
  v_exp_f32 v72, v72
  v_exp_f32 v73, v73
  v_exp_f32 v74, v74
  v_exp_f32 v75, v75
  v_cvt_pk_bf16_f32 v70, v84, v85
  v_cvt_pk_bf16_f32 v71, v86, v87
  v_exp_f32 v88, v88
  v_exp_f32 v89, v89
  v_exp_f32 v90, v90
  v_exp_f32 v91, v91
  v_cvt_pk_bf16_f32 v72, v72, v73
  v_cvt_pk_bf16_f32 v73, v74, v75
  v_exp_f32 v76, v76
  v_exp_f32 v77, v77
  v_exp_f32 v78, v78
  v_exp_f32 v79, v79
  v_cvt_pk_bf16_f32 v74, v88, v89
  v_cvt_pk_bf16_f32 v75, v90, v91
  v_exp_f32 v92, v92
  v_exp_f32 v93, v93
  v_exp_f32 v94, v94
  v_exp_f32 v95, v95
  v_cvt_pk_bf16_f32 v76, v76, v77
  v_cvt_pk_bf16_f32 v77, v78, v79
  v_cvt_pk_bf16_f32 v78, v92, v93
  v_cvt_pk_bf16_f32 v79, v94, v95
  s_waitcnt lgkmcnt(6)
  v_mfma_f32_16x16x32_bf16 v[160:163], a[116:119], v[32:35], 0
  v_mfma_f32_16x16x32_bf16 v[160:163], a[120:123], v[64:67], v[160:163]
  ds_read_b128 a[148:151], v2 offset:36864
  ds_read_b128 a[152:155], v2 offset:45056
  v_mfma_f32_16x16x32_bf16 v[164:167], a[120:123], v[68:71], 0
  v_mfma_f32_16x16x32_bf16 v[164:167], a[116:119], v[36:39], v[164:167]
  v_mfma_f32_16x16x32_bf16 v[168:171], a[116:119], v[40:43], 0
  v_mfma_f32_16x16x32_bf16 v[168:171], a[120:123], v[72:75], v[168:171]
  v_mfma_f32_16x16x32_bf16 v[172:175], a[120:123], v[76:79], 0
  v_mfma_f32_16x16x32_bf16 v[172:175], a[116:119], v[44:47], v[172:175]
  s_waitcnt lgkmcnt(6)
  v_mfma_f32_16x16x32_bf16 a[32:35], a[48:51], v[32:35], 0
  v_mfma_f32_16x16x32_bf16 a[32:35], a[48:51], v[64:67], a[32:35]
  v_mfma_f32_16x16x32_bf16 v[176:179], a[124:127], v[32:35], 0
  v_mfma_f32_16x16x32_bf16 v[176:179], a[128:131], v[64:67], v[176:179]
  ds_read_b128 a[156:159], v2 offset:37888
  ds_read_b128 a[160:163], v2 offset:46080
  v_mfma_f32_16x16x32_bf16 v[180:183], a[128:131], v[68:71], 0
  v_mfma_f32_16x16x32_bf16 v[180:183], a[124:127], v[36:39], v[180:183]
  v_mfma_f32_16x16x32_bf16 v[184:187], a[124:127], v[40:43], 0
  v_mfma_f32_16x16x32_bf16 v[184:187], a[128:131], v[72:75], v[184:187]
  v_mfma_f32_16x16x32_bf16 v[188:191], a[128:131], v[76:79], 0
  v_mfma_f32_16x16x32_bf16 v[188:191], a[124:127], v[44:47], v[188:191]
  s_waitcnt lgkmcnt(6)
  v_mfma_f32_16x16x32_bf16 a[36:39], a[48:51], v[36:39], 0
  v_mfma_f32_16x16x32_bf16 a[36:39], a[48:51], v[68:71], a[36:39]
  v_mfma_f32_16x16x32_bf16 v[192:195], a[132:135], v[32:35], 0
  v_mfma_f32_16x16x32_bf16 v[192:195], a[136:139], v[64:67], v[192:195]
  ds_read_b128 a[164:167], v2 offset:38912
  ds_read_b128 a[168:171], v2 offset:47104
  v_mfma_f32_16x16x32_bf16 v[196:199], a[136:139], v[68:71], 0
  v_mfma_f32_16x16x32_bf16 v[196:199], a[132:135], v[36:39], v[196:199]
  v_mfma_f32_16x16x32_bf16 v[200:203], a[132:135], v[40:43], 0
  v_mfma_f32_16x16x32_bf16 v[200:203], a[136:139], v[72:75], v[200:203]
  v_mfma_f32_16x16x32_bf16 v[204:207], a[136:139], v[76:79], 0
  v_mfma_f32_16x16x32_bf16 v[204:207], a[132:135], v[44:47], v[204:207]
  s_waitcnt lgkmcnt(6)
  v_mfma_f32_16x16x32_bf16 a[40:43], a[48:51], v[40:43], 0
  v_mfma_f32_16x16x32_bf16 a[40:43], a[48:51], v[72:75], a[40:43]
  v_mfma_f32_16x16x32_bf16 v[208:211], a[140:143], v[32:35], 0
  v_mfma_f32_16x16x32_bf16 v[208:211], a[144:147], v[64:67], v[208:211]
  ds_read_b128 a[172:175], v2 offset:39936
  ds_read_b128 a[176:179], v2 offset:48128
  v_mfma_f32_16x16x32_bf16 v[212:215], a[144:147], v[68:71], 0
  v_mfma_f32_16x16x32_bf16 v[212:215], a[140:143], v[36:39], v[212:215]
  v_mfma_f32_16x16x32_bf16 v[216:219], a[140:143], v[40:43], 0
  v_mfma_f32_16x16x32_bf16 v[216:219], a[144:147], v[72:75], v[216:219]
  v_mfma_f32_16x16x32_bf16 v[220:223], a[144:147], v[76:79], 0
  v_mfma_f32_16x16x32_bf16 v[220:223], a[140:143], v[44:47], v[220:223]
  s_waitcnt lgkmcnt(6)
  v_mfma_f32_16x16x32_bf16 a[44:47], a[48:51], v[44:47], 0
  v_mfma_f32_16x16x32_bf16 a[44:47], a[48:51], v[76:79], a[44:47]
  v_mfma_f32_16x16x32_bf16 v[224:227], a[148:151], v[32:35], 0
  v_mfma_f32_16x16x32_bf16 v[224:227], a[152:155], v[64:67], v[224:227]
  v_mfma_f32_16x16x32_bf16 v[228:231], a[152:155], v[68:71], 0
  v_mfma_f32_16x16x32_bf16 v[228:231], a[148:151], v[36:39], v[228:231]
  v_mfma_f32_16x16x32_bf16 v[232:235], a[148:151], v[40:43], 0
  v_mfma_f32_16x16x32_bf16 v[232:235], a[152:155], v[72:75], v[232:235]
  v_mfma_f32_16x16x32_bf16 v[236:239], a[152:155], v[76:79], 0
  v_mfma_f32_16x16x32_bf16 v[236:239], a[148:151], v[44:47], v[236:239]
  s_waitcnt lgkmcnt(4)
  v_mfma_f32_16x16x32_bf16 v[240:243], a[156:159], v[32:35], 0
  v_mfma_f32_16x16x32_bf16 v[240:243], a[160:163], v[64:67], v[240:243]
  v_mfma_f32_16x16x32_bf16 v[244:247], a[160:163], v[68:71], 0
  v_mfma_f32_16x16x32_bf16 v[244:247], a[156:159], v[36:39], v[244:247]
  v_mfma_f32_16x16x32_bf16 v[248:251], a[156:159], v[40:43], 0
  v_mfma_f32_16x16x32_bf16 v[248:251], a[160:163], v[72:75], v[248:251]
  s_waitcnt vmcnt(63) lgkmcnt(0)
  s_barrier
  v_mfma_f32_16x16x32_bf16 v[252:255], a[160:163], v[76:79], 0
  v_mfma_f32_16x16x32_bf16 v[252:255], a[156:159], v[44:47], v[252:255]
  v_mfma_f32_16x16x32_bf16 a[0:3], a[164:167], v[32:35], 0
  v_mfma_f32_16x16x32_bf16 a[0:3], a[168:171], v[64:67], a[0:3]
  v_mfma_f32_16x16x32_bf16 a[4:7], a[168:171], v[68:71], 0
  v_mfma_f32_16x16x32_bf16 a[4:7], a[164:167], v[36:39], a[4:7]
  v_mfma_f32_16x16x32_bf16 a[8:11], a[164:167], v[40:43], 0
  v_mfma_f32_16x16x32_bf16 a[8:11], a[168:171], v[72:75], a[8:11]
  v_mfma_f32_16x16x32_bf16 a[12:15], a[168:171], v[76:79], 0
  v_mfma_f32_16x16x32_bf16 a[12:15], a[164:167], v[44:47], a[12:15]
  v_mfma_f32_16x16x32_bf16 a[16:19], a[172:175], v[32:35], 0
  v_mfma_f32_16x16x32_bf16 a[16:19], a[176:179], v[64:67], a[16:19]
  v_mfma_f32_16x16x32_bf16 a[20:23], a[176:179], v[68:71], 0
  v_mfma_f32_16x16x32_bf16 a[20:23], a[172:175], v[36:39], a[20:23]
  v_mfma_f32_16x16x32_bf16 a[24:27], a[172:175], v[40:43], 0
  v_mfma_f32_16x16x32_bf16 a[24:27], a[176:179], v[72:75], a[24:27]
  v_mfma_f32_16x16x32_bf16 a[28:31], a[176:179], v[76:79], 0
  v_mfma_f32_16x16x32_bf16 a[28:31], a[172:175], v[44:47], a[28:31]
  s_branch Lk2_merge
Lk2_b0:
  s_waitcnt lgkmcnt(4)
  s_add_u32 m0, s29, 98304
  v_mfma_f32_16x16x32_bf16 v[96:99], a[116:119], a[180:183], 0
  v_exp_f32 v64, v64
  v_mfma_f32_16x16x32_bf16 v[96:99], a[120:123], a[184:187], v[96:99]
  ds_read_b128 a[148:151], v2 offset:8192
  ds_read_b128 a[152:155], v2 offset:9216
  v_mfma_f32_16x16x32_bf16 v[96:99], a[124:127], a[188:191], v[96:99]
  v_exp_f32 v65, v65
  v_mfma_f32_16x16x32_bf16 v[96:99], a[128:131], a[192:195], v[96:99]
  buffer_load_dwordx4 v1, s[12:15], s26 offen offset:0 lds
  s_add_u32 s32, s26, 4096
  v_mfma_f32_16x16x32_bf16 v[100:103], a[128:131], a[208:211], 0
  v_exp_f32 v66, v66
  v_mfma_f32_16x16x32_bf16 v[100:103], a[124:127], a[204:207], v[100:103]
  v_cvt_pk_bf16_f32 v64, v64, v65
  v_mfma_f32_16x16x32_bf16 v[100:103], a[120:123], a[200:203], v[100:103]
  v_exp_f32 v67, v67
  v_mfma_f32_16x16x32_bf16 v[100:103], a[116:119], a[196:199], v[100:103]
  buffer_load_dwordx4 v1, s[12:15], s26 offen offset:1024 lds
  v_mfma_f32_16x16x32_bf16 v[104:107], a[116:119], a[212:215], 0
  v_exp_f32 v80, v80
  v_mfma_f32_16x16x32_bf16 v[104:107], a[120:123], a[216:219], v[104:107]
  ds_read_b128 a[156:159], v2 offset:10240
  ds_read_b128 a[160:163], v2 offset:11264
  v_mfma_f32_16x16x32_bf16 v[104:107], a[124:127], a[220:223], v[104:107]
  v_exp_f32 v81, v81
  v_mfma_f32_16x16x32_bf16 v[104:107], a[128:131], a[224:227], v[104:107]
  buffer_load_dwordx4 v1, s[12:15], s26 offen offset:2048 lds
  v_mfma_f32_16x16x32_bf16 v[108:111], a[128:131], a[240:243], 0
  v_exp_f32 v82, v82
  v_mfma_f32_16x16x32_bf16 v[108:111], a[124:127], a[236:239], v[108:111]
  v_cvt_pk_bf16_f32 v65, v66, v67
  v_cvt_pk_bf16_f32 v66, v80, v81
  v_mfma_f32_16x16x32_bf16 v[108:111], a[120:123], a[232:235], v[108:111]
  v_exp_f32 v83, v83
  v_mfma_f32_16x16x32_bf16 v[108:111], a[116:119], a[228:231], v[108:111]
  buffer_load_dwordx4 v1, s[12:15], s26 offen offset:3072 lds
  s_add_u32 m0, s29, 102400
  s_waitcnt lgkmcnt(4)
  v_mfma_f32_16x16x32_bf16 v[112:115], a[132:135], a[180:183], 0
  v_exp_f32 v68, v68
  v_mfma_f32_16x16x32_bf16 v[112:115], a[136:139], a[184:187], v[112:115]
  ds_read_b128 a[164:167], v2 offset:12288
  ds_read_b128 a[168:171], v2 offset:13312
  v_mfma_f32_16x16x32_bf16 v[112:115], a[140:143], a[188:191], v[112:115]
  v_exp_f32 v69, v69
  v_mfma_f32_16x16x32_bf16 v[112:115], a[144:147], a[192:195], v[112:115]
  buffer_load_dwordx4 v1, s[12:15], s32 offen offset:0 lds
  v_mfma_f32_16x16x32_bf16 v[116:119], a[144:147], a[208:211], 0
  v_exp_f32 v70, v70
  v_mfma_f32_16x16x32_bf16 v[116:119], a[140:143], a[204:207], v[116:119]
  v_cvt_pk_bf16_f32 v67, v82, v83
  v_cvt_pk_bf16_f32 v68, v68, v69
  v_mfma_f32_16x16x32_bf16 v[116:119], a[136:139], a[200:203], v[116:119]
  v_exp_f32 v71, v71
  v_mfma_f32_16x16x32_bf16 v[116:119], a[132:135], a[196:199], v[116:119]
  buffer_load_dwordx4 v1, s[12:15], s32 offen offset:1024 lds
  v_mfma_f32_16x16x32_bf16 v[120:123], a[132:135], a[212:215], 0
  v_exp_f32 v84, v84
  v_mfma_f32_16x16x32_bf16 v[120:123], a[136:139], a[216:219], v[120:123]
  ds_read_b128 a[172:175], v2 offset:14336
  ds_read_b128 a[176:179], v2 offset:15360
  v_mfma_f32_16x16x32_bf16 v[120:123], a[140:143], a[220:223], v[120:123]
  v_exp_f32 v85, v85
  v_mfma_f32_16x16x32_bf16 v[120:123], a[144:147], a[224:227], v[120:123]
  buffer_load_dwordx4 v1, s[12:15], s32 offen offset:2048 lds
  v_mfma_f32_16x16x32_bf16 v[124:127], a[144:147], a[240:243], 0
  v_exp_f32 v86, v86
  v_mfma_f32_16x16x32_bf16 v[124:127], a[140:143], a[236:239], v[124:127]
  v_cvt_pk_bf16_f32 v69, v70, v71
  v_cvt_pk_bf16_f32 v70, v84, v85
  v_mfma_f32_16x16x32_bf16 v[124:127], a[136:139], a[232:235], v[124:127]
  v_exp_f32 v87, v87
  v_mfma_f32_16x16x32_bf16 v[124:127], a[132:135], a[228:231], v[124:127]
  buffer_load_dwordx4 v1, s[12:15], s32 offen offset:3072 lds
  s_waitcnt lgkmcnt(4)
  v_mfma_f32_16x16x32_bf16 v[128:131], a[148:151], a[180:183], 0
  v_exp_f32 v72, v72
  v_mfma_f32_16x16x32_bf16 v[128:131], a[152:155], a[184:187], v[128:131]
  s_add_u32 s26, s26, 32768
  s_cmp_eq_u32 s26, s62
  s_cselect_b32 s26, s63, s26
  s_cselect_b32 s62, -1, s62
  v_mfma_f32_16x16x32_bf16 v[128:131], a[156:159], a[188:191], v[128:131]
  v_exp_f32 v73, v73
  v_mfma_f32_16x16x32_bf16 v[128:131], a[160:163], a[192:195], v[128:131]
  v_cvt_pk_bf16_f32 v71, v86, v87
  v_cvt_pk_bf16_f32 v72, v72, v73
  v_mfma_f32_16x16x32_bf16 v[132:135], a[160:163], a[208:211], 0
  v_exp_f32 v74, v74
  v_mfma_f32_16x16x32_bf16 v[132:135], a[156:159], a[204:207], v[132:135]
  v_mfma_f32_16x16x32_bf16 v[132:135], a[152:155], a[200:203], v[132:135]
  v_exp_f32 v75, v75
  v_mfma_f32_16x16x32_bf16 v[132:135], a[148:151], a[196:199], v[132:135]
  v_cvt_pk_bf16_f32 v73, v74, v75
  v_mfma_f32_16x16x32_bf16 v[136:139], a[148:151], a[212:215], 0
  v_exp_f32 v88, v88
  v_mfma_f32_16x16x32_bf16 v[136:139], a[152:155], a[216:219], v[136:139]
  v_mfma_f32_16x16x32_bf16 v[136:139], a[156:159], a[220:223], v[136:139]
  v_exp_f32 v89, v89
  v_mfma_f32_16x16x32_bf16 v[136:139], a[160:163], a[224:227], v[136:139]
  v_cvt_pk_bf16_f32 v74, v88, v89
  v_mfma_f32_16x16x32_bf16 v[140:143], a[160:163], a[240:243], 0
  v_exp_f32 v90, v90
  v_mfma_f32_16x16x32_bf16 v[140:143], a[156:159], a[236:239], v[140:143]
  s_waitcnt vmcnt(16) lgkmcnt(0)
  s_barrier
  ds_read_b128 a[116:119], v2 offset:32768
  ds_read_b128 a[120:123], v2 offset:40960
  ds_read_b128 a[124:127], v2 offset:33792
  ds_read_b128 a[128:131], v2 offset:41984
  v_mfma_f32_16x16x32_bf16 v[140:143], a[152:155], a[232:235], v[140:143]
  v_exp_f32 v91, v91
  v_mfma_f32_16x16x32_bf16 v[140:143], a[148:151], a[228:231], v[140:143]
  v_cvt_pk_bf16_f32 v75, v90, v91
  v_mfma_f32_16x16x32_bf16 v[144:147], a[164:167], a[180:183], 0
  v_exp_f32 v76, v76
  v_mfma_f32_16x16x32_bf16 v[144:147], a[168:171], a[184:187], v[144:147]
  ds_read_b128 a[132:135], v2 offset:34816
  ds_read_b128 a[136:139], v2 offset:43008
  v_mfma_f32_16x16x32_bf16 v[144:147], a[172:175], a[188:191], v[144:147]
  v_exp_f32 v77, v77
  v_mfma_f32_16x16x32_bf16 v[144:147], a[176:179], a[192:195], v[144:147]
  v_cvt_pk_bf16_f32 v76, v76, v77
  v_mfma_f32_16x16x32_bf16 v[148:151], a[176:179], a[208:211], 0
  v_exp_f32 v78, v78
  v_mfma_f32_16x16x32_bf16 v[148:151], a[172:175], a[204:207], v[148:151]
  v_mfma_f32_16x16x32_bf16 v[148:151], a[168:171], a[200:203], v[148:151]
  v_exp_f32 v79, v79
  v_mfma_f32_16x16x32_bf16 v[148:151], a[164:167], a[196:199], v[148:151]
  v_cvt_pk_bf16_f32 v77, v78, v79
  v_mfma_f32_16x16x32_bf16 v[152:155], a[164:167], a[212:215], 0
  v_exp_f32 v92, v92
  v_mfma_f32_16x16x32_bf16 v[152:155], a[168:171], a[216:219], v[152:155]
  ds_read_b128 a[140:143], v2 offset:35840
  ds_read_b128 a[144:147], v2 offset:44032
  v_mfma_f32_16x16x32_bf16 v[152:155], a[172:175], a[220:223], v[152:155]
  v_exp_f32 v93, v93
  v_mfma_f32_16x16x32_bf16 v[152:155], a[176:179], a[224:227], v[152:155]
  v_cvt_pk_bf16_f32 v78, v92, v93
  v_mfma_f32_16x16x32_bf16 v[156:159], a[176:179], a[240:243], 0
  v_exp_f32 v94, v94
  v_mfma_f32_16x16x32_bf16 v[156:159], a[172:175], a[236:239], v[156:159]
  v_mfma_f32_16x16x32_bf16 v[156:159], a[168:171], a[232:235], v[156:159]
  v_exp_f32 v95, v95
  v_mfma_f32_16x16x32_bf16 v[156:159], a[164:167], a[228:231], v[156:159]
  v_cvt_pk_bf16_f32 v79, v94, v95
  s_waitcnt lgkmcnt(6)
  s_add_u32 m0, s29, 0
  v_mfma_f32_16x16x32_bf16 v[160:163], a[116:119], v[32:35], 0
  v_exp_f32 v96, v96
  v_mfma_f32_16x16x32_bf16 v[160:163], a[120:123], v[64:67], v[160:163]
  ds_read_b128 a[148:151], v2 offset:36864
  ds_read_b128 a[152:155], v2 offset:45056
  v_mfma_f32_16x16x32_bf16 v[164:167], a[120:123], v[68:71], 0
  v_exp_f32 v97, v97
  v_mfma_f32_16x16x32_bf16 v[164:167], a[116:119], v[36:39], v[164:167]
  buffer_load_dwordx4 v1, s[12:15], s25 offen offset:0 lds
  s_add_u32 s32, s25, 4096
  v_mfma_f32_16x16x32_bf16 v[168:171], a[116:119], v[40:43], 0
  v_exp_f32 v98, v98
  v_mfma_f32_16x16x32_bf16 v[168:171], a[120:123], v[72:75], v[168:171]
  v_cvt_pk_bf16_f32 v96, v96, v97
  v_mfma_f32_16x16x32_bf16 v[172:175], a[120:123], v[76:79], 0
  v_exp_f32 v99, v99
  v_mfma_f32_16x16x32_bf16 v[172:175], a[116:119], v[44:47], v[172:175]
  buffer_load_dwordx4 v1, s[12:15], s25 offen offset:1024 lds
  s_waitcnt lgkmcnt(6)
  v_mfma_f32_16x16x32_bf16 a[32:35], a[48:51], v[32:35], 0
  v_mfma_f32_16x16x32_bf16 a[32:35], a[48:51], v[64:67], a[32:35]
  v_mfma_f32_16x16x32_bf16 v[176:179], a[124:127], v[32:35], 0
  v_exp_f32 v112, v112
  v_mfma_f32_16x16x32_bf16 v[176:179], a[128:131], v[64:67], v[176:179]
  ds_read_b128 a[156:159], v2 offset:37888
  ds_read_b128 a[160:163], v2 offset:46080
  v_mfma_f32_16x16x32_bf16 v[180:183], a[128:131], v[68:71], 0
  v_exp_f32 v113, v113
  v_mfma_f32_16x16x32_bf16 v[180:183], a[124:127], v[36:39], v[180:183]
  buffer_load_dwordx4 v1, s[12:15], s25 offen offset:2048 lds
  v_mfma_f32_16x16x32_bf16 v[184:187], a[124:127], v[40:43], 0
  v_exp_f32 v114, v114
  v_mfma_f32_16x16x32_bf16 v[184:187], a[128:131], v[72:75], v[184:187]
  v_cvt_pk_bf16_f32 v97, v98, v99
  v_cvt_pk_bf16_f32 v98, v112, v113
  v_mfma_f32_16x16x32_bf16 v[188:191], a[128:131], v[76:79], 0
  v_exp_f32 v115, v115
  v_mfma_f32_16x16x32_bf16 v[188:191], a[124:127], v[44:47], v[188:191]
  buffer_load_dwordx4 v1, s[12:15], s25 offen offset:3072 lds
  s_add_u32 m0, s29, 4096
  s_waitcnt lgkmcnt(6)
  v_mfma_f32_16x16x32_bf16 a[36:39], a[48:51], v[36:39], 0
  v_mfma_f32_16x16x32_bf16 a[36:39], a[48:51], v[68:71], a[36:39]
  v_mfma_f32_16x16x32_bf16 v[192:195], a[132:135], v[32:35], 0
  v_exp_f32 v100, v100
  v_mfma_f32_16x16x32_bf16 v[192:195], a[136:139], v[64:67], v[192:195]
  ds_read_b128 a[164:167], v2 offset:38912
  ds_read_b128 a[168:171], v2 offset:47104
  v_mfma_f32_16x16x32_bf16 v[196:199], a[136:139], v[68:71], 0
  v_exp_f32 v101, v101
  v_mfma_f32_16x16x32_bf16 v[196:199], a[132:135], v[36:39], v[196:199]
  buffer_load_dwordx4 v1, s[12:15], s32 offen offset:0 lds
  v_mfma_f32_16x16x32_bf16 v[200:203], a[132:135], v[40:43], 0
  v_exp_f32 v102, v102
  v_mfma_f32_16x16x32_bf16 v[200:203], a[136:139], v[72:75], v[200:203]
  v_cvt_pk_bf16_f32 v99, v114, v115
  v_cvt_pk_bf16_f32 v100, v100, v101
  v_mfma_f32_16x16x32_bf16 v[204:207], a[136:139], v[76:79], 0
  v_exp_f32 v103, v103
  v_mfma_f32_16x16x32_bf16 v[204:207], a[132:135], v[44:47], v[204:207]
  buffer_load_dwordx4 v1, s[12:15], s32 offen offset:1024 lds
  s_waitcnt lgkmcnt(6)
  v_mfma_f32_16x16x32_bf16 a[40:43], a[48:51], v[40:43], 0
  v_mfma_f32_16x16x32_bf16 a[40:43], a[48:51], v[72:75], a[40:43]
  v_mfma_f32_16x16x32_bf16 v[208:211], a[140:143], v[32:35], 0
  v_exp_f32 v116, v116
  v_mfma_f32_16x16x32_bf16 v[208:211], a[144:147], v[64:67], v[208:211]
  ds_read_b128 a[172:175], v2 offset:39936
  ds_read_b128 a[176:179], v2 offset:48128
  v_mfma_f32_16x16x32_bf16 v[212:215], a[144:147], v[68:71], 0
  v_exp_f32 v117, v117
  v_mfma_f32_16x16x32_bf16 v[212:215], a[140:143], v[36:39], v[212:215]
  buffer_load_dwordx4 v1, s[12:15], s32 offen offset:2048 lds
  v_mfma_f32_16x16x32_bf16 v[216:219], a[140:143], v[40:43], 0
  v_exp_f32 v118, v118
  v_mfma_f32_16x16x32_bf16 v[216:219], a[144:147], v[72:75], v[216:219]
  v_cvt_pk_bf16_f32 v101, v102, v103
  v_cvt_pk_bf16_f32 v102, v116, v117
  v_mfma_f32_16x16x32_bf16 v[220:223], a[144:147], v[76:79], 0
  v_exp_f32 v119, v119
  v_mfma_f32_16x16x32_bf16 v[220:223], a[140:143], v[44:47], v[220:223]
  buffer_load_dwordx4 v1, s[12:15], s32 offen offset:3072 lds
  s_waitcnt lgkmcnt(6)
  v_mfma_f32_16x16x32_bf16 a[44:47], a[48:51], v[44:47], 0
  v_mfma_f32_16x16x32_bf16 a[44:47], a[48:51], v[76:79], a[44:47]
  v_mfma_f32_16x16x32_bf16 v[224:227], a[148:151], v[32:35], 0
  v_exp_f32 v104, v104
  v_mfma_f32_16x16x32_bf16 v[224:227], a[152:155], v[64:67], v[224:227]
  s_add_u32 s25, s25, 32768
  s_cmp_eq_u32 s25, s27
  s_cselect_b32 s25, s28, s25
  s_cselect_b32 s27, -1, s27
  v_mfma_f32_16x16x32_bf16 v[228:231], a[152:155], v[68:71], 0
  v_exp_f32 v105, v105
  v_mfma_f32_16x16x32_bf16 v[228:231], a[148:151], v[36:39], v[228:231]
  v_cvt_pk_bf16_f32 v103, v118, v119
  v_cvt_pk_bf16_f32 v104, v104, v105
  v_mfma_f32_16x16x32_bf16 v[232:235], a[148:151], v[40:43], 0
  v_exp_f32 v106, v106
  v_mfma_f32_16x16x32_bf16 v[232:235], a[152:155], v[72:75], v[232:235]
  v_mfma_f32_16x16x32_bf16 v[236:239], a[152:155], v[76:79], 0
  v_exp_f32 v107, v107
  v_mfma_f32_16x16x32_bf16 v[236:239], a[148:151], v[44:47], v[236:239]
  v_cvt_pk_bf16_f32 v105, v106, v107
  s_waitcnt lgkmcnt(4)
  v_mfma_f32_16x16x32_bf16 v[240:243], a[156:159], v[32:35], 0
  v_exp_f32 v120, v120
  v_mfma_f32_16x16x32_bf16 v[240:243], a[160:163], v[64:67], v[240:243]
  v_mfma_f32_16x16x32_bf16 v[244:247], a[160:163], v[68:71], 0
  v_exp_f32 v121, v121
  v_mfma_f32_16x16x32_bf16 v[244:247], a[156:159], v[36:39], v[244:247]
  v_cvt_pk_bf16_f32 v106, v120, v121
  v_mfma_f32_16x16x32_bf16 v[248:251], a[156:159], v[40:43], 0
  v_exp_f32 v122, v122
  v_mfma_f32_16x16x32_bf16 v[248:251], a[160:163], v[72:75], v[248:251]
  s_waitcnt vmcnt(16) lgkmcnt(0)
  s_barrier
  ds_read_b128 a[116:119], v3 offset:0
  ds_read_b128 a[120:123], v3 offset:1024
  ds_read_b128 a[124:127], v3 offset:2048
  ds_read_b128 a[128:131], v3 offset:3072
  v_mfma_f32_16x16x32_bf16 v[252:255], a[160:163], v[76:79], 0
  v_exp_f32 v123, v123
  v_mfma_f32_16x16x32_bf16 v[252:255], a[156:159], v[44:47], v[252:255]
  v_cvt_pk_bf16_f32 v107, v122, v123
  v_mfma_f32_16x16x32_bf16 a[0:3], a[164:167], v[32:35], 0
  v_exp_f32 v108, v108
  v_mfma_f32_16x16x32_bf16 a[0:3], a[168:171], v[64:67], a[0:3]
  ds_read_b128 a[132:135], v3 offset:4096
  ds_read_b128 a[136:139], v3 offset:5120
  v_mfma_f32_16x16x32_bf16 a[4:7], a[168:171], v[68:71], 0
  v_exp_f32 v109, v109
  v_mfma_f32_16x16x32_bf16 a[4:7], a[164:167], v[36:39], a[4:7]
  v_cvt_pk_bf16_f32 v108, v108, v109
  v_mfma_f32_16x16x32_bf16 a[8:11], a[164:167], v[40:43], 0
  v_exp_f32 v110, v110
  v_mfma_f32_16x16x32_bf16 a[8:11], a[168:171], v[72:75], a[8:11]
  v_mfma_f32_16x16x32_bf16 a[12:15], a[168:171], v[76:79], 0
  v_exp_f32 v111, v111
  v_mfma_f32_16x16x32_bf16 a[12:15], a[164:167], v[44:47], a[12:15]
  v_cvt_pk_bf16_f32 v109, v110, v111
  v_mfma_f32_16x16x32_bf16 a[16:19], a[172:175], v[32:35], 0
  v_exp_f32 v124, v124
  v_mfma_f32_16x16x32_bf16 a[16:19], a[176:179], v[64:67], a[16:19]
  ds_read_b128 a[140:143], v3 offset:6144
  ds_read_b128 a[144:147], v3 offset:7168
  v_mfma_f32_16x16x32_bf16 a[20:23], a[176:179], v[68:71], 0
  v_exp_f32 v125, v125
  v_mfma_f32_16x16x32_bf16 a[20:23], a[172:175], v[36:39], a[20:23]
  v_cvt_pk_bf16_f32 v110, v124, v125
  v_mfma_f32_16x16x32_bf16 a[24:27], a[172:175], v[40:43], 0
  v_exp_f32 v126, v126
  v_mfma_f32_16x16x32_bf16 a[24:27], a[176:179], v[72:75], a[24:27]
  v_mfma_f32_16x16x32_bf16 a[28:31], a[176:179], v[76:79], 0
  v_exp_f32 v127, v127
  v_mfma_f32_16x16x32_bf16 a[28:31], a[172:175], v[44:47], a[28:31]
  v_cvt_pk_bf16_f32 v111, v126, v127
  s_branch Lk2_l2b
Lk2_l2:
  s_waitcnt lgkmcnt(4)
  s_add_u32 m0, s29, 98304
  v_mfma_f32_16x16x32_bf16 v[96:99], a[116:119], a[180:183], 0
  v_exp_f32 v64, v64
  v_mfma_f32_16x16x32_bf16 v[96:99], a[120:123], a[184:187], v[96:99]
  ds_read_b128 a[148:151], v2 offset:8192
  ds_read_b128 a[152:155], v2 offset:9216
  v_mfma_f32_16x16x32_bf16 v[96:99], a[124:127], a[188:191], v[96:99]
  v_exp_f32 v65, v65
  v_mfma_f32_16x16x32_bf16 v[96:99], a[128:131], a[192:195], v[96:99]
  buffer_load_dwordx4 v1, s[12:15], s26 offen offset:0 lds
  s_add_u32 s32, s26, 4096
  v_mfma_f32_16x16x32_bf16 v[100:103], a[128:131], a[208:211], 0
  v_exp_f32 v66, v66
  v_mfma_f32_16x16x32_bf16 v[100:103], a[124:127], a[204:207], v[100:103]
  v_cvt_pk_bf16_f32 v64, v64, v65
  v_mfma_f32_16x16x32_bf16 v[100:103], a[120:123], a[200:203], v[100:103]
  v_exp_f32 v67, v67
  v_mfma_f32_16x16x32_bf16 v[100:103], a[116:119], a[196:199], v[100:103]
  buffer_load_dwordx4 v1, s[12:15], s26 offen offset:1024 lds
  v_mfma_f32_16x16x32_bf16 v[104:107], a[116:119], a[212:215], 0
  v_exp_f32 v80, v80
  v_mfma_f32_16x16x32_bf16 v[104:107], a[120:123], a[216:219], v[104:107]
  ds_read_b128 a[156:159], v2 offset:10240
  ds_read_b128 a[160:163], v2 offset:11264
  v_mfma_f32_16x16x32_bf16 v[104:107], a[124:127], a[220:223], v[104:107]
  v_exp_f32 v81, v81
  v_mfma_f32_16x16x32_bf16 v[104:107], a[128:131], a[224:227], v[104:107]
  buffer_load_dwordx4 v1, s[12:15], s26 offen offset:2048 lds
  v_mfma_f32_16x16x32_bf16 v[108:111], a[128:131], a[240:243], 0
  v_exp_f32 v82, v82
  v_mfma_f32_16x16x32_bf16 v[108:111], a[124:127], a[236:239], v[108:111]
  v_cvt_pk_bf16_f32 v65, v66, v67
  v_cvt_pk_bf16_f32 v66, v80, v81
  v_mfma_f32_16x16x32_bf16 v[108:111], a[120:123], a[232:235], v[108:111]
  v_exp_f32 v83, v83
  v_mfma_f32_16x16x32_bf16 v[108:111], a[116:119], a[228:231], v[108:111]
  buffer_load_dwordx4 v1, s[12:15], s26 offen offset:3072 lds
  s_add_u32 m0, s29, 102400
  s_waitcnt lgkmcnt(4)
  v_mfma_f32_16x16x32_bf16 v[112:115], a[132:135], a[180:183], 0
  v_exp_f32 v68, v68
  v_mfma_f32_16x16x32_bf16 v[112:115], a[136:139], a[184:187], v[112:115]
  ds_read_b128 a[164:167], v2 offset:12288
  ds_read_b128 a[168:171], v2 offset:13312
  v_mfma_f32_16x16x32_bf16 v[112:115], a[140:143], a[188:191], v[112:115]
  v_exp_f32 v69, v69
  v_mfma_f32_16x16x32_bf16 v[112:115], a[144:147], a[192:195], v[112:115]
  buffer_load_dwordx4 v1, s[12:15], s32 offen offset:0 lds
  v_mfma_f32_16x16x32_bf16 v[116:119], a[144:147], a[208:211], 0
  v_exp_f32 v70, v70
  v_mfma_f32_16x16x32_bf16 v[116:119], a[140:143], a[204:207], v[116:119]
  v_cvt_pk_bf16_f32 v67, v82, v83
  v_cvt_pk_bf16_f32 v68, v68, v69
  v_mfma_f32_16x16x32_bf16 v[116:119], a[136:139], a[200:203], v[116:119]
  v_exp_f32 v71, v71
  v_mfma_f32_16x16x32_bf16 v[116:119], a[132:135], a[196:199], v[116:119]
  buffer_load_dwordx4 v1, s[12:15], s32 offen offset:1024 lds
  v_mfma_f32_16x16x32_bf16 v[120:123], a[132:135], a[212:215], 0
  v_exp_f32 v84, v84
  v_mfma_f32_16x16x32_bf16 v[120:123], a[136:139], a[216:219], v[120:123]
  ds_read_b128 a[172:175], v2 offset:14336
  ds_read_b128 a[176:179], v2 offset:15360
  v_mfma_f32_16x16x32_bf16 v[120:123], a[140:143], a[220:223], v[120:123]
  v_exp_f32 v85, v85
  v_mfma_f32_16x16x32_bf16 v[120:123], a[144:147], a[224:227], v[120:123]
  buffer_load_dwordx4 v1, s[12:15], s32 offen offset:2048 lds
  v_mfma_f32_16x16x32_bf16 v[124:127], a[144:147], a[240:243], 0
  v_exp_f32 v86, v86
  v_mfma_f32_16x16x32_bf16 v[124:127], a[140:143], a[236:239], v[124:127]
  v_cvt_pk_bf16_f32 v69, v70, v71
  v_cvt_pk_bf16_f32 v70, v84, v85
  v_mfma_f32_16x16x32_bf16 v[124:127], a[136:139], a[232:235], v[124:127]
  v_exp_f32 v87, v87
  v_mfma_f32_16x16x32_bf16 v[124:127], a[132:135], a[228:231], v[124:127]
  buffer_load_dwordx4 v1, s[12:15], s32 offen offset:3072 lds
  s_waitcnt lgkmcnt(4)
  v_mfma_f32_16x16x32_bf16 v[128:131], a[148:151], a[180:183], 0
  v_exp_f32 v72, v72
  v_mfma_f32_16x16x32_bf16 v[128:131], a[152:155], a[184:187], v[128:131]
  s_add_u32 s26, s26, 32768
  s_cmp_eq_u32 s26, s62
  s_cselect_b32 s26, s63, s26
  s_cselect_b32 s62, -1, s62
  v_mfma_f32_16x16x32_bf16 v[128:131], a[156:159], a[188:191], v[128:131]
  v_exp_f32 v73, v73
  v_mfma_f32_16x16x32_bf16 v[128:131], a[160:163], a[192:195], v[128:131]
  v_cvt_pk_bf16_f32 v71, v86, v87
  v_cvt_pk_bf16_f32 v72, v72, v73
  v_mfma_f32_16x16x32_bf16 v[132:135], a[160:163], a[208:211], 0
  v_exp_f32 v74, v74
  v_mfma_f32_16x16x32_bf16 v[132:135], a[156:159], a[204:207], v[132:135]
  v_mfma_f32_16x16x32_bf16 v[132:135], a[152:155], a[200:203], v[132:135]
  v_exp_f32 v75, v75
  v_mfma_f32_16x16x32_bf16 v[132:135], a[148:151], a[196:199], v[132:135]
  v_cvt_pk_bf16_f32 v73, v74, v75
  v_mfma_f32_16x16x32_bf16 v[136:139], a[148:151], a[212:215], 0
  v_exp_f32 v88, v88
  v_mfma_f32_16x16x32_bf16 v[136:139], a[152:155], a[216:219], v[136:139]
  v_mfma_f32_16x16x32_bf16 v[136:139], a[156:159], a[220:223], v[136:139]
  v_exp_f32 v89, v89
  v_mfma_f32_16x16x32_bf16 v[136:139], a[160:163], a[224:227], v[136:139]
  v_cvt_pk_bf16_f32 v74, v88, v89
  v_mfma_f32_16x16x32_bf16 v[140:143], a[160:163], a[240:243], 0
  v_exp_f32 v90, v90
  v_mfma_f32_16x16x32_bf16 v[140:143], a[156:159], a[236:239], v[140:143]
  s_waitcnt vmcnt(16) lgkmcnt(0)
  s_barrier
  ds_read_b128 a[116:119], v2 offset:32768
  ds_read_b128 a[120:123], v2 offset:40960
  ds_read_b128 a[124:127], v2 offset:33792
  ds_read_b128 a[128:131], v2 offset:41984
  v_mfma_f32_16x16x32_bf16 v[140:143], a[152:155], a[232:235], v[140:143]
  v_exp_f32 v91, v91
  v_mfma_f32_16x16x32_bf16 v[140:143], a[148:151], a[228:231], v[140:143]
  v_cvt_pk_bf16_f32 v75, v90, v91
  v_mfma_f32_16x16x32_bf16 v[144:147], a[164:167], a[180:183], 0
  v_exp_f32 v76, v76
  v_mfma_f32_16x16x32_bf16 v[144:147], a[168:171], a[184:187], v[144:147]
  ds_read_b128 a[132:135], v2 offset:34816
  ds_read_b128 a[136:139], v2 offset:43008
  v_mfma_f32_16x16x32_bf16 v[144:147], a[172:175], a[188:191], v[144:147]
  v_exp_f32 v77, v77
  v_mfma_f32_16x16x32_bf16 v[144:147], a[176:179], a[192:195], v[144:147]
  v_cvt_pk_bf16_f32 v76, v76, v77
  v_mfma_f32_16x16x32_bf16 v[148:151], a[176:179], a[208:211], 0
  v_exp_f32 v78, v78
  v_mfma_f32_16x16x32_bf16 v[148:151], a[172:175], a[204:207], v[148:151]
  v_mfma_f32_16x16x32_bf16 v[148:151], a[168:171], a[200:203], v[148:151]
  v_exp_f32 v79, v79
  v_mfma_f32_16x16x32_bf16 v[148:151], a[164:167], a[196:199], v[148:151]
  v_cvt_pk_bf16_f32 v77, v78, v79
  v_mfma_f32_16x16x32_bf16 v[152:155], a[164:167], a[212:215], 0
  v_exp_f32 v92, v92
  v_mfma_f32_16x16x32_bf16 v[152:155], a[168:171], a[216:219], v[152:155]
  ds_read_b128 a[140:143], v2 offset:35840
  ds_read_b128 a[144:147], v2 offset:44032
  v_mfma_f32_16x16x32_bf16 v[152:155], a[172:175], a[220:223], v[152:155]
  v_exp_f32 v93, v93
  v_mfma_f32_16x16x32_bf16 v[152:155], a[176:179], a[224:227], v[152:155]
  v_cvt_pk_bf16_f32 v78, v92, v93
  v_mfma_f32_16x16x32_bf16 v[156:159], a[176:179], a[240:243], 0
  v_exp_f32 v94, v94
  v_mfma_f32_16x16x32_bf16 v[156:159], a[172:175], a[236:239], v[156:159]
  v_mfma_f32_16x16x32_bf16 v[156:159], a[168:171], a[232:235], v[156:159]
  v_exp_f32 v95, v95
  v_mfma_f32_16x16x32_bf16 v[156:159], a[164:167], a[228:231], v[156:159]
  v_cvt_pk_bf16_f32 v79, v94, v95
  s_waitcnt lgkmcnt(6)
  s_add_u32 m0, s29, 0
  v_mfma_f32_16x16x32_bf16 v[160:163], a[116:119], v[32:35], v[160:163]
  v_exp_f32 v96, v96
  v_mfma_f32_16x16x32_bf16 v[160:163], a[120:123], v[64:67], v[160:163]
  ds_read_b128 a[148:151], v2 offset:36864
  ds_read_b128 a[152:155], v2 offset:45056
  v_mfma_f32_16x16x32_bf16 v[164:167], a[120:123], v[68:71], v[164:167]
  v_exp_f32 v97, v97
  v_mfma_f32_16x16x32_bf16 v[164:167], a[116:119], v[36:39], v[164:167]
  buffer_load_dwordx4 v1, s[12:15], s25 offen offset:0 lds
  s_add_u32 s32, s25, 4096
  v_mfma_f32_16x16x32_bf16 v[168:171], a[116:119], v[40:43], v[168:171]
  v_exp_f32 v98, v98
  v_mfma_f32_16x16x32_bf16 v[168:171], a[120:123], v[72:75], v[168:171]
  v_cvt_pk_bf16_f32 v96, v96, v97
  v_mfma_f32_16x16x32_bf16 v[172:175], a[120:123], v[76:79], v[172:175]
  v_exp_f32 v99, v99
  v_mfma_f32_16x16x32_bf16 v[172:175], a[116:119], v[44:47], v[172:175]
  buffer_load_dwordx4 v1, s[12:15], s25 offen offset:1024 lds
  s_waitcnt lgkmcnt(6)
  v_mfma_f32_16x16x32_bf16 a[32:35], a[48:51], v[32:35], a[32:35]
  v_mfma_f32_16x16x32_bf16 a[32:35], a[48:51], v[64:67], a[32:35]
  v_mfma_f32_16x16x32_bf16 v[176:179], a[124:127], v[32:35], v[176:179]
  v_exp_f32 v112, v112
  v_mfma_f32_16x16x32_bf16 v[176:179], a[128:131], v[64:67], v[176:179]
  ds_read_b128 a[156:159], v2 offset:37888
  ds_read_b128 a[160:163], v2 offset:46080
  v_mfma_f32_16x16x32_bf16 v[180:183], a[128:131], v[68:71], v[180:183]
  v_exp_f32 v113, v113
  v_mfma_f32_16x16x32_bf16 v[180:183], a[124:127], v[36:39], v[180:183]
  buffer_load_dwordx4 v1, s[12:15], s25 offen offset:2048 lds
  v_mfma_f32_16x16x32_bf16 v[184:187], a[124:127], v[40:43], v[184:187]
  v_exp_f32 v114, v114
  v_mfma_f32_16x16x32_bf16 v[184:187], a[128:131], v[72:75], v[184:187]
  v_cvt_pk_bf16_f32 v97, v98, v99
  v_cvt_pk_bf16_f32 v98, v112, v113
  v_mfma_f32_16x16x32_bf16 v[188:191], a[128:131], v[76:79], v[188:191]
  v_exp_f32 v115, v115
  v_mfma_f32_16x16x32_bf16 v[188:191], a[124:127], v[44:47], v[188:191]
  buffer_load_dwordx4 v1, s[12:15], s25 offen offset:3072 lds
  s_add_u32 m0, s29, 4096
  s_waitcnt lgkmcnt(6)
  v_mfma_f32_16x16x32_bf16 a[36:39], a[48:51], v[36:39], a[36:39]
  v_mfma_f32_16x16x32_bf16 a[36:39], a[48:51], v[68:71], a[36:39]
  v_mfma_f32_16x16x32_bf16 v[192:195], a[132:135], v[32:35], v[192:195]
  v_exp_f32 v100, v100
  v_mfma_f32_16x16x32_bf16 v[192:195], a[136:139], v[64:67], v[192:195]
  ds_read_b128 a[164:167], v2 offset:38912
  ds_read_b128 a[168:171], v2 offset:47104
  v_mfma_f32_16x16x32_bf16 v[196:199], a[136:139], v[68:71], v[196:199]
  v_exp_f32 v101, v101
  v_mfma_f32_16x16x32_bf16 v[196:199], a[132:135], v[36:39], v[196:199]
  buffer_load_dwordx4 v1, s[12:15], s32 offen offset:0 lds
  v_mfma_f32_16x16x32_bf16 v[200:203], a[132:135], v[40:43], v[200:203]
  v_exp_f32 v102, v102
  v_mfma_f32_16x16x32_bf16 v[200:203], a[136:139], v[72:75], v[200:203]
  v_cvt_pk_bf16_f32 v99, v114, v115
  v_cvt_pk_bf16_f32 v100, v100, v101
  v_mfma_f32_16x16x32_bf16 v[204:207], a[136:139], v[76:79], v[204:207]
  v_exp_f32 v103, v103
  v_mfma_f32_16x16x32_bf16 v[204:207], a[132:135], v[44:47], v[204:207]
  buffer_load_dwordx4 v1, s[12:15], s32 offen offset:1024 lds
  s_waitcnt lgkmcnt(6)
  v_mfma_f32_16x16x32_bf16 a[40:43], a[48:51], v[40:43], a[40:43]
  v_mfma_f32_16x16x32_bf16 a[40:43], a[48:51], v[72:75], a[40:43]
  v_mfma_f32_16x16x32_bf16 v[208:211], a[140:143], v[32:35], v[208:211]
  v_exp_f32 v116, v116
  v_mfma_f32_16x16x32_bf16 v[208:211], a[144:147], v[64:67], v[208:211]
  ds_read_b128 a[172:175], v2 offset:39936
  ds_read_b128 a[176:179], v2 offset:48128
  v_mfma_f32_16x16x32_bf16 v[212:215], a[144:147], v[68:71], v[212:215]
  v_exp_f32 v117, v117
  v_mfma_f32_16x16x32_bf16 v[212:215], a[140:143], v[36:39], v[212:215]
  buffer_load_dwordx4 v1, s[12:15], s32 offen offset:2048 lds
  v_mfma_f32_16x16x32_bf16 v[216:219], a[140:143], v[40:43], v[216:219]
  v_exp_f32 v118, v118
  v_mfma_f32_16x16x32_bf16 v[216:219], a[144:147], v[72:75], v[216:219]
  v_cvt_pk_bf16_f32 v101, v102, v103
  v_cvt_pk_bf16_f32 v102, v116, v117
  v_mfma_f32_16x16x32_bf16 v[220:223], a[144:147], v[76:79], v[220:223]
  v_exp_f32 v119, v119
  v_mfma_f32_16x16x32_bf16 v[220:223], a[140:143], v[44:47], v[220:223]
  buffer_load_dwordx4 v1, s[12:15], s32 offen offset:3072 lds
  s_waitcnt lgkmcnt(6)
  v_mfma_f32_16x16x32_bf16 a[44:47], a[48:51], v[44:47], a[44:47]
  v_mfma_f32_16x16x32_bf16 a[44:47], a[48:51], v[76:79], a[44:47]
  v_mfma_f32_16x16x32_bf16 v[224:227], a[148:151], v[32:35], v[224:227]
  v_exp_f32 v104, v104
  v_mfma_f32_16x16x32_bf16 v[224:227], a[152:155], v[64:67], v[224:227]
  s_add_u32 s25, s25, 32768
  s_cmp_eq_u32 s25, s27
  s_cselect_b32 s25, s28, s25
  s_cselect_b32 s27, -1, s27
  v_mfma_f32_16x16x32_bf16 v[228:231], a[152:155], v[68:71], v[228:231]
  v_exp_f32 v105, v105
  v_mfma_f32_16x16x32_bf16 v[228:231], a[148:151], v[36:39], v[228:231]
  v_cvt_pk_bf16_f32 v103, v118, v119
  v_cvt_pk_bf16_f32 v104, v104, v105
  v_mfma_f32_16x16x32_bf16 v[232:235], a[148:151], v[40:43], v[232:235]
  v_exp_f32 v106, v106
  v_mfma_f32_16x16x32_bf16 v[232:235], a[152:155], v[72:75], v[232:235]
  v_mfma_f32_16x16x32_bf16 v[236:239], a[152:155], v[76:79], v[236:239]
  v_exp_f32 v107, v107
  v_mfma_f32_16x16x32_bf16 v[236:239], a[148:151], v[44:47], v[236:239]
  v_cvt_pk_bf16_f32 v105, v106, v107
  s_waitcnt lgkmcnt(4)
  v_mfma_f32_16x16x32_bf16 v[240:243], a[156:159], v[32:35], v[240:243]
  v_exp_f32 v120, v120
  v_mfma_f32_16x16x32_bf16 v[240:243], a[160:163], v[64:67], v[240:243]
  v_mfma_f32_16x16x32_bf16 v[244:247], a[160:163], v[68:71], v[244:247]
  v_exp_f32 v121, v121
  v_mfma_f32_16x16x32_bf16 v[244:247], a[156:159], v[36:39], v[244:247]
  v_cvt_pk_bf16_f32 v106, v120, v121
  v_mfma_f32_16x16x32_bf16 v[248:251], a[156:159], v[40:43], v[248:251]
  v_exp_f32 v122, v122
  v_mfma_f32_16x16x32_bf16 v[248:251], a[160:163], v[72:75], v[248:251]
  s_waitcnt vmcnt(16) lgkmcnt(0)
  s_barrier
  ds_read_b128 a[116:119], v3 offset:0
  ds_read_b128 a[120:123], v3 offset:1024
  ds_read_b128 a[124:127], v3 offset:2048
  ds_read_b128 a[128:131], v3 offset:3072
  v_mfma_f32_16x16x32_bf16 v[252:255], a[160:163], v[76:79], v[252:255]
  v_exp_f32 v123, v123
  v_mfma_f32_16x16x32_bf16 v[252:255], a[156:159], v[44:47], v[252:255]
  v_cvt_pk_bf16_f32 v107, v122, v123
  v_mfma_f32_16x16x32_bf16 a[0:3], a[164:167], v[32:35], a[0:3]
  v_exp_f32 v108, v108
  v_mfma_f32_16x16x32_bf16 a[0:3], a[168:171], v[64:67], a[0:3]
  ds_read_b128 a[132:135], v3 offset:4096
  ds_read_b128 a[136:139], v3 offset:5120
  v_mfma_f32_16x16x32_bf16 a[4:7], a[168:171], v[68:71], a[4:7]
  v_exp_f32 v109, v109
  v_mfma_f32_16x16x32_bf16 a[4:7], a[164:167], v[36:39], a[4:7]
  v_cvt_pk_bf16_f32 v108, v108, v109
  v_mfma_f32_16x16x32_bf16 a[8:11], a[164:167], v[40:43], a[8:11]
  v_exp_f32 v110, v110
  v_mfma_f32_16x16x32_bf16 a[8:11], a[168:171], v[72:75], a[8:11]
  v_mfma_f32_16x16x32_bf16 a[12:15], a[168:171], v[76:79], a[12:15]
  v_exp_f32 v111, v111
  v_mfma_f32_16x16x32_bf16 a[12:15], a[164:167], v[44:47], a[12:15]
  v_cvt_pk_bf16_f32 v109, v110, v111
  v_mfma_f32_16x16x32_bf16 a[16:19], a[172:175], v[32:35], a[16:19]
  v_exp_f32 v124, v124
  v_mfma_f32_16x16x32_bf16 a[16:19], a[176:179], v[64:67], a[16:19]
  ds_read_b128 a[140:143], v3 offset:6144
  ds_read_b128 a[144:147], v3 offset:7168
  v_mfma_f32_16x16x32_bf16 a[20:23], a[176:179], v[68:71], a[20:23]
  v_exp_f32 v125, v125
  v_mfma_f32_16x16x32_bf16 a[20:23], a[172:175], v[36:39], a[20:23]
  v_cvt_pk_bf16_f32 v110, v124, v125
  v_mfma_f32_16x16x32_bf16 a[24:27], a[172:175], v[40:43], a[24:27]
  v_exp_f32 v126, v126
  v_mfma_f32_16x16x32_bf16 a[24:27], a[176:179], v[72:75], a[24:27]
  v_mfma_f32_16x16x32_bf16 a[28:31], a[176:179], v[76:79], a[28:31]
  v_exp_f32 v127, v127
  v_mfma_f32_16x16x32_bf16 a[28:31], a[172:175], v[44:47], a[28:31]
  v_cvt_pk_bf16_f32 v111, v126, v127
Lk2_l2b:
  s_waitcnt lgkmcnt(4)
  s_add_u32 m0, s29, 32768
  v_mfma_f32_16x16x32_bf16 v[32:35], a[116:119], a[180:183], 0
  v_exp_f32 v128, v128
  v_mfma_f32_16x16x32_bf16 v[32:35], a[120:123], a[184:187], v[32:35]
  ds_read_b128 a[148:151], v3 offset:8192
  ds_read_b128 a[152:155], v3 offset:9216
  v_mfma_f32_16x16x32_bf16 v[32:35], a[124:127], a[188:191], v[32:35]
  v_exp_f32 v129, v129
  v_mfma_f32_16x16x32_bf16 v[32:35], a[128:131], a[192:195], v[32:35]
  buffer_load_dwordx4 v1, s[12:15], s26 offen offset:0 lds
  s_add_u32 s32, s26, 4096
  v_mfma_f32_16x16x32_bf16 v[36:39], a[128:131], a[208:211], 0
  v_exp_f32 v130, v130
  v_mfma_f32_16x16x32_bf16 v[36:39], a[124:127], a[204:207], v[36:39]
  v_cvt_pk_bf16_f32 v128, v128, v129
  v_mfma_f32_16x16x32_bf16 v[36:39], a[120:123], a[200:203], v[36:39]
  v_exp_f32 v131, v131
  v_mfma_f32_16x16x32_bf16 v[36:39], a[116:119], a[196:199], v[36:39]
  buffer_load_dwordx4 v1, s[12:15], s26 offen offset:1024 lds
  v_mfma_f32_16x16x32_bf16 v[40:43], a[116:119], a[212:215], 0
  v_exp_f32 v144, v144
  v_mfma_f32_16x16x32_bf16 v[40:43], a[120:123], a[216:219], v[40:43]
  ds_read_b128 a[156:159], v3 offset:10240
  ds_read_b128 a[160:163], v3 offset:11264
  v_mfma_f32_16x16x32_bf16 v[40:43], a[124:127], a[220:223], v[40:43]
  v_exp_f32 v145, v145
  v_mfma_f32_16x16x32_bf16 v[40:43], a[128:131], a[224:227], v[40:43]
  buffer_load_dwordx4 v1, s[12:15], s26 offen offset:2048 lds
  v_mfma_f32_16x16x32_bf16 v[44:47], a[128:131], a[240:243], 0
  v_exp_f32 v146, v146
  v_mfma_f32_16x16x32_bf16 v[44:47], a[124:127], a[236:239], v[44:47]
  v_cvt_pk_bf16_f32 v129, v130, v131
  v_cvt_pk_bf16_f32 v130, v144, v145
  v_mfma_f32_16x16x32_bf16 v[44:47], a[120:123], a[232:235], v[44:47]
  v_exp_f32 v147, v147
  v_mfma_f32_16x16x32_bf16 v[44:47], a[116:119], a[228:231], v[44:47]
  buffer_load_dwordx4 v1, s[12:15], s26 offen offset:3072 lds
  s_add_u32 m0, s29, 36864
  s_waitcnt lgkmcnt(4)
  v_mfma_f32_16x16x32_bf16 v[48:51], a[132:135], a[180:183], 0
  v_exp_f32 v132, v132
  v_mfma_f32_16x16x32_bf16 v[48:51], a[136:139], a[184:187], v[48:51]
  ds_read_b128 a[164:167], v3 offset:12288
  ds_read_b128 a[168:171], v3 offset:13312
  v_mfma_f32_16x16x32_bf16 v[48:51], a[140:143], a[188:191], v[48:51]
  v_exp_f32 v133, v133
  v_mfma_f32_16x16x32_bf16 v[48:51], a[144:147], a[192:195], v[48:51]
  buffer_load_dwordx4 v1, s[12:15], s32 offen offset:0 lds
  v_mfma_f32_16x16x32_bf16 v[52:55], a[144:147], a[208:211], 0
  v_exp_f32 v134, v134
  v_mfma_f32_16x16x32_bf16 v[52:55], a[140:143], a[204:207], v[52:55]
  v_cvt_pk_bf16_f32 v131, v146, v147
  v_cvt_pk_bf16_f32 v132, v132, v133
  v_mfma_f32_16x16x32_bf16 v[52:55], a[136:139], a[200:203], v[52:55]
  v_exp_f32 v135, v135
  v_mfma_f32_16x16x32_bf16 v[52:55], a[132:135], a[196:199], v[52:55]
  buffer_load_dwordx4 v1, s[12:15], s32 offen offset:1024 lds
  v_mfma_f32_16x16x32_bf16 v[56:59], a[132:135], a[212:215], 0
  v_exp_f32 v148, v148
  v_mfma_f32_16x16x32_bf16 v[56:59], a[136:139], a[216:219], v[56:59]
  ds_read_b128 a[172:175], v3 offset:14336
  ds_read_b128 a[176:179], v3 offset:15360
  v_mfma_f32_16x16x32_bf16 v[56:59], a[140:143], a[220:223], v[56:59]
  v_exp_f32 v149, v149
  v_mfma_f32_16x16x32_bf16 v[56:59], a[144:147], a[224:227], v[56:59]
  buffer_load_dwordx4 v1, s[12:15], s32 offen offset:2048 lds
  v_mfma_f32_16x16x32_bf16 v[60:63], a[144:147], a[240:243], 0
  v_exp_f32 v150, v150
  v_mfma_f32_16x16x32_bf16 v[60:63], a[140:143], a[236:239], v[60:63]
  v_cvt_pk_bf16_f32 v133, v134, v135
  v_cvt_pk_bf16_f32 v134, v148, v149
  v_mfma_f32_16x16x32_bf16 v[60:63], a[136:139], a[232:235], v[60:63]
  v_exp_f32 v151, v151
  v_mfma_f32_16x16x32_bf16 v[60:63], a[132:135], a[228:231], v[60:63]
  buffer_load_dwordx4 v1, s[12:15], s32 offen offset:3072 lds
  s_waitcnt lgkmcnt(4)
  v_mfma_f32_16x16x32_bf16 v[64:67], a[148:151], a[180:183], 0
  v_exp_f32 v136, v136
  v_mfma_f32_16x16x32_bf16 v[64:67], a[152:155], a[184:187], v[64:67]
  s_add_u32 s26, s26, 32768
  s_cmp_eq_u32 s26, s62
  s_cselect_b32 s26, s63, s26
  s_cselect_b32 s62, -1, s62
  v_mfma_f32_16x16x32_bf16 v[64:67], a[156:159], a[188:191], v[64:67]
  v_exp_f32 v137, v137
  v_mfma_f32_16x16x32_bf16 v[64:67], a[160:163], a[192:195], v[64:67]
  v_cvt_pk_bf16_f32 v135, v150, v151
  v_cvt_pk_bf16_f32 v136, v136, v137
  v_mfma_f32_16x16x32_bf16 v[68:71], a[160:163], a[208:211], 0
  v_exp_f32 v138, v138
  v_mfma_f32_16x16x32_bf16 v[68:71], a[156:159], a[204:207], v[68:71]
  v_mfma_f32_16x16x32_bf16 v[68:71], a[152:155], a[200:203], v[68:71]
  v_exp_f32 v139, v139
  v_mfma_f32_16x16x32_bf16 v[68:71], a[148:151], a[196:199], v[68:71]
  v_cvt_pk_bf16_f32 v137, v138, v139
  v_mfma_f32_16x16x32_bf16 v[72:75], a[148:151], a[212:215], 0
  v_exp_f32 v152, v152
  v_mfma_f32_16x16x32_bf16 v[72:75], a[152:155], a[216:219], v[72:75]
  v_mfma_f32_16x16x32_bf16 v[72:75], a[156:159], a[220:223], v[72:75]
  v_exp_f32 v153, v153
  v_mfma_f32_16x16x32_bf16 v[72:75], a[160:163], a[224:227], v[72:75]
  v_cvt_pk_bf16_f32 v138, v152, v153
  v_mfma_f32_16x16x32_bf16 v[76:79], a[160:163], a[240:243], 0
  v_exp_f32 v154, v154
  v_mfma_f32_16x16x32_bf16 v[76:79], a[156:159], a[236:239], v[76:79]
  s_waitcnt vmcnt(16) lgkmcnt(0)
  s_barrier
  ds_read_b128 a[116:119], v3 offset:32768
  ds_read_b128 a[120:123], v3 offset:40960
  ds_read_b128 a[124:127], v3 offset:33792
  ds_read_b128 a[128:131], v3 offset:41984
  v_mfma_f32_16x16x32_bf16 v[76:79], a[152:155], a[232:235], v[76:79]
  v_exp_f32 v155, v155
  v_mfma_f32_16x16x32_bf16 v[76:79], a[148:151], a[228:231], v[76:79]
  v_cvt_pk_bf16_f32 v139, v154, v155
  v_mfma_f32_16x16x32_bf16 v[80:83], a[164:167], a[180:183], 0
  v_exp_f32 v140, v140
  v_mfma_f32_16x16x32_bf16 v[80:83], a[168:171], a[184:187], v[80:83]
  ds_read_b128 a[132:135], v3 offset:34816
  ds_read_b128 a[136:139], v3 offset:43008
  v_mfma_f32_16x16x32_bf16 v[80:83], a[172:175], a[188:191], v[80:83]
  v_exp_f32 v141, v141
  v_mfma_f32_16x16x32_bf16 v[80:83], a[176:179], a[192:195], v[80:83]
  v_cvt_pk_bf16_f32 v140, v140, v141
  v_mfma_f32_16x16x32_bf16 v[84:87], a[176:179], a[208:211], 0
  v_exp_f32 v142, v142
  v_mfma_f32_16x16x32_bf16 v[84:87], a[172:175], a[204:207], v[84:87]
  v_mfma_f32_16x16x32_bf16 v[84:87], a[168:171], a[200:203], v[84:87]
  v_exp_f32 v143, v143
  v_mfma_f32_16x16x32_bf16 v[84:87], a[164:167], a[196:199], v[84:87]
  v_cvt_pk_bf16_f32 v141, v142, v143
  v_mfma_f32_16x16x32_bf16 v[88:91], a[164:167], a[212:215], 0
  v_exp_f32 v156, v156
  v_mfma_f32_16x16x32_bf16 v[88:91], a[168:171], a[216:219], v[88:91]
  ds_read_b128 a[140:143], v3 offset:35840
  ds_read_b128 a[144:147], v3 offset:44032
  v_mfma_f32_16x16x32_bf16 v[88:91], a[172:175], a[220:223], v[88:91]
  v_exp_f32 v157, v157
  v_mfma_f32_16x16x32_bf16 v[88:91], a[176:179], a[224:227], v[88:91]
  v_cvt_pk_bf16_f32 v142, v156, v157
  v_mfma_f32_16x16x32_bf16 v[92:95], a[176:179], a[240:243], 0
  v_exp_f32 v158, v158
  v_mfma_f32_16x16x32_bf16 v[92:95], a[172:175], a[236:239], v[92:95]
  v_mfma_f32_16x16x32_bf16 v[92:95], a[168:171], a[232:235], v[92:95]
  v_exp_f32 v159, v159
  v_mfma_f32_16x16x32_bf16 v[92:95], a[164:167], a[228:231], v[92:95]
  v_cvt_pk_bf16_f32 v143, v158, v159
  s_waitcnt lgkmcnt(6)
  s_add_u32 m0, s29, 65536
  v_mfma_f32_16x16x32_bf16 v[160:163], a[116:119], v[96:99], v[160:163]
  v_exp_f32 v32, v32
  v_mfma_f32_16x16x32_bf16 v[160:163], a[120:123], v[128:131], v[160:163]
  ds_read_b128 a[148:151], v3 offset:36864
  ds_read_b128 a[152:155], v3 offset:45056
  v_mfma_f32_16x16x32_bf16 v[164:167], a[120:123], v[132:135], v[164:167]
  v_exp_f32 v33, v33
  v_mfma_f32_16x16x32_bf16 v[164:167], a[116:119], v[100:103], v[164:167]
  buffer_load_dwordx4 v1, s[12:15], s25 offen offset:0 lds
  s_add_u32 s32, s25, 4096
  v_mfma_f32_16x16x32_bf16 v[168:171], a[116:119], v[104:107], v[168:171]
  v_exp_f32 v34, v34
  v_mfma_f32_16x16x32_bf16 v[168:171], a[120:123], v[136:139], v[168:171]
  v_cvt_pk_bf16_f32 v32, v32, v33
  v_mfma_f32_16x16x32_bf16 v[172:175], a[120:123], v[140:143], v[172:175]
  v_exp_f32 v35, v35
  v_mfma_f32_16x16x32_bf16 v[172:175], a[116:119], v[108:111], v[172:175]
  buffer_load_dwordx4 v1, s[12:15], s25 offen offset:1024 lds
  s_waitcnt lgkmcnt(6)
  v_mfma_f32_16x16x32_bf16 a[32:35], a[48:51], v[96:99], a[32:35]
  v_mfma_f32_16x16x32_bf16 a[32:35], a[48:51], v[128:131], a[32:35]
  v_mfma_f32_16x16x32_bf16 v[176:179], a[124:127], v[96:99], v[176:179]
  v_exp_f32 v48, v48
  v_mfma_f32_16x16x32_bf16 v[176:179], a[128:131], v[128:131], v[176:179]
  ds_read_b128 a[156:159], v3 offset:37888
  ds_read_b128 a[160:163], v3 offset:46080
  v_mfma_f32_16x16x32_bf16 v[180:183], a[128:131], v[132:135], v[180:183]
  v_exp_f32 v49, v49
  v_mfma_f32_16x16x32_bf16 v[180:183], a[124:127], v[100:103], v[180:183]
  buffer_load_dwordx4 v1, s[12:15], s25 offen offset:2048 lds
  v_mfma_f32_16x16x32_bf16 v[184:187], a[124:127], v[104:107], v[184:187]
  v_exp_f32 v50, v50
  v_mfma_f32_16x16x32_bf16 v[184:187], a[128:131], v[136:139], v[184:187]
  v_cvt_pk_bf16_f32 v33, v34, v35
  v_cvt_pk_bf16_f32 v34, v48, v49
  v_mfma_f32_16x16x32_bf16 v[188:191], a[128:131], v[140:143], v[188:191]
  v_exp_f32 v51, v51
  v_mfma_f32_16x16x32_bf16 v[188:191], a[124:127], v[108:111], v[188:191]
  buffer_load_dwordx4 v1, s[12:15], s25 offen offset:3072 lds
  s_add_u32 m0, s29, 69632
  s_waitcnt lgkmcnt(6)
  v_mfma_f32_16x16x32_bf16 a[36:39], a[48:51], v[100:103], a[36:39]
  v_mfma_f32_16x16x32_bf16 a[36:39], a[48:51], v[132:135], a[36:39]
  v_mfma_f32_16x16x32_bf16 v[192:195], a[132:135], v[96:99], v[192:195]
  v_exp_f32 v36, v36
  v_mfma_f32_16x16x32_bf16 v[192:195], a[136:139], v[128:131], v[192:195]
  ds_read_b128 a[164:167], v3 offset:38912
  ds_read_b128 a[168:171], v3 offset:47104
  v_mfma_f32_16x16x32_bf16 v[196:199], a[136:139], v[132:135], v[196:199]
  v_exp_f32 v37, v37
  v_mfma_f32_16x16x32_bf16 v[196:199], a[132:135], v[100:103], v[196:199]
  buffer_load_dwordx4 v1, s[12:15], s32 offen offset:0 lds
  v_mfma_f32_16x16x32_bf16 v[200:203], a[132:135], v[104:107], v[200:203]
  v_exp_f32 v38, v38
  v_mfma_f32_16x16x32_bf16 v[200:203], a[136:139], v[136:139], v[200:203]
  v_cvt_pk_bf16_f32 v35, v50, v51
  v_cvt_pk_bf16_f32 v36, v36, v37
  v_mfma_f32_16x16x32_bf16 v[204:207], a[136:139], v[140:143], v[204:207]
  v_exp_f32 v39, v39
  v_mfma_f32_16x16x32_bf16 v[204:207], a[132:135], v[108:111], v[204:207]
  buffer_load_dwordx4 v1, s[12:15], s32 offen offset:1024 lds
  s_waitcnt lgkmcnt(6)
  v_mfma_f32_16x16x32_bf16 a[40:43], a[48:51], v[104:107], a[40:43]
  v_mfma_f32_16x16x32_bf16 a[40:43], a[48:51], v[136:139], a[40:43]
  v_mfma_f32_16x16x32_bf16 v[208:211], a[140:143], v[96:99], v[208:211]
  v_exp_f32 v52, v52
  v_mfma_f32_16x16x32_bf16 v[208:211], a[144:147], v[128:131], v[208:211]
  ds_read_b128 a[172:175], v3 offset:39936
  ds_read_b128 a[176:179], v3 offset:48128
  v_mfma_f32_16x16x32_bf16 v[212:215], a[144:147], v[132:135], v[212:215]
  v_exp_f32 v53, v53
  v_mfma_f32_16x16x32_bf16 v[212:215], a[140:143], v[100:103], v[212:215]
  buffer_load_dwordx4 v1, s[12:15], s32 offen offset:2048 lds
  v_mfma_f32_16x16x32_bf16 v[216:219], a[140:143], v[104:107], v[216:219]
  v_exp_f32 v54, v54
  v_mfma_f32_16x16x32_bf16 v[216:219], a[144:147], v[136:139], v[216:219]
  v_cvt_pk_bf16_f32 v37, v38, v39
  v_cvt_pk_bf16_f32 v38, v52, v53
  v_mfma_f32_16x16x32_bf16 v[220:223], a[144:147], v[140:143], v[220:223]
  v_exp_f32 v55, v55
  v_mfma_f32_16x16x32_bf16 v[220:223], a[140:143], v[108:111], v[220:223]
  buffer_load_dwordx4 v1, s[12:15], s32 offen offset:3072 lds
  s_waitcnt lgkmcnt(6)
  v_mfma_f32_16x16x32_bf16 a[44:47], a[48:51], v[108:111], a[44:47]
  v_mfma_f32_16x16x32_bf16 a[44:47], a[48:51], v[140:143], a[44:47]
  v_mfma_f32_16x16x32_bf16 v[224:227], a[148:151], v[96:99], v[224:227]
  v_exp_f32 v40, v40
  v_mfma_f32_16x16x32_bf16 v[224:227], a[152:155], v[128:131], v[224:227]
  s_add_u32 s25, s25, 32768
  s_cmp_eq_u32 s25, s27
  s_cselect_b32 s25, s28, s25
  s_cselect_b32 s27, -1, s27
  v_mfma_f32_16x16x32_bf16 v[228:231], a[152:155], v[132:135], v[228:231]
  v_exp_f32 v41, v41
  v_mfma_f32_16x16x32_bf16 v[228:231], a[148:151], v[100:103], v[228:231]
  v_cvt_pk_bf16_f32 v39, v54, v55
  v_cvt_pk_bf16_f32 v40, v40, v41
  v_mfma_f32_16x16x32_bf16 v[232:235], a[148:151], v[104:107], v[232:235]
  v_exp_f32 v42, v42
  v_mfma_f32_16x16x32_bf16 v[232:235], a[152:155], v[136:139], v[232:235]
  v_mfma_f32_16x16x32_bf16 v[236:239], a[152:155], v[140:143], v[236:239]
  v_exp_f32 v43, v43
  v_mfma_f32_16x16x32_bf16 v[236:239], a[148:151], v[108:111], v[236:239]
  v_cvt_pk_bf16_f32 v41, v42, v43
  s_waitcnt lgkmcnt(4)
  v_mfma_f32_16x16x32_bf16 v[240:243], a[156:159], v[96:99], v[240:243]
  v_exp_f32 v56, v56
  v_mfma_f32_16x16x32_bf16 v[240:243], a[160:163], v[128:131], v[240:243]
  v_mfma_f32_16x16x32_bf16 v[244:247], a[160:163], v[132:135], v[244:247]
  v_exp_f32 v57, v57
  v_mfma_f32_16x16x32_bf16 v[244:247], a[156:159], v[100:103], v[244:247]
  v_cvt_pk_bf16_f32 v42, v56, v57
  v_mfma_f32_16x16x32_bf16 v[248:251], a[156:159], v[104:107], v[248:251]
  v_exp_f32 v58, v58
  v_mfma_f32_16x16x32_bf16 v[248:251], a[160:163], v[136:139], v[248:251]
  s_waitcnt vmcnt(16) lgkmcnt(0)
  s_barrier
  ds_read_b128 a[116:119], v2 offset:0
  ds_read_b128 a[120:123], v2 offset:1024
  ds_read_b128 a[124:127], v2 offset:2048
  ds_read_b128 a[128:131], v2 offset:3072
  v_mfma_f32_16x16x32_bf16 v[252:255], a[160:163], v[140:143], v[252:255]
  v_exp_f32 v59, v59
  v_mfma_f32_16x16x32_bf16 v[252:255], a[156:159], v[108:111], v[252:255]
  v_cvt_pk_bf16_f32 v43, v58, v59
  v_mfma_f32_16x16x32_bf16 a[0:3], a[164:167], v[96:99], a[0:3]
  v_exp_f32 v44, v44
  v_mfma_f32_16x16x32_bf16 a[0:3], a[168:171], v[128:131], a[0:3]
  ds_read_b128 a[132:135], v2 offset:4096
  ds_read_b128 a[136:139], v2 offset:5120
  v_mfma_f32_16x16x32_bf16 a[4:7], a[168:171], v[132:135], a[4:7]
  v_exp_f32 v45, v45
  v_mfma_f32_16x16x32_bf16 a[4:7], a[164:167], v[100:103], a[4:7]
  v_cvt_pk_bf16_f32 v44, v44, v45
  v_mfma_f32_16x16x32_bf16 a[8:11], a[164:167], v[104:107], a[8:11]
  v_exp_f32 v46, v46
  v_mfma_f32_16x16x32_bf16 a[8:11], a[168:171], v[136:139], a[8:11]
  v_mfma_f32_16x16x32_bf16 a[12:15], a[168:171], v[140:143], a[12:15]
  v_exp_f32 v47, v47
  v_mfma_f32_16x16x32_bf16 a[12:15], a[164:167], v[108:111], a[12:15]
  v_cvt_pk_bf16_f32 v45, v46, v47
  v_mfma_f32_16x16x32_bf16 a[16:19], a[172:175], v[96:99], a[16:19]
  v_exp_f32 v60, v60
  v_mfma_f32_16x16x32_bf16 a[16:19], a[176:179], v[128:131], a[16:19]
  ds_read_b128 a[140:143], v2 offset:6144
  ds_read_b128 a[144:147], v2 offset:7168
  v_mfma_f32_16x16x32_bf16 a[20:23], a[176:179], v[132:135], a[20:23]
  v_exp_f32 v61, v61
  v_mfma_f32_16x16x32_bf16 a[20:23], a[172:175], v[100:103], a[20:23]
  v_cvt_pk_bf16_f32 v46, v60, v61
  v_mfma_f32_16x16x32_bf16 a[24:27], a[172:175], v[104:107], a[24:27]
  v_exp_f32 v62, v62
  v_mfma_f32_16x16x32_bf16 a[24:27], a[176:179], v[136:139], a[24:27]
  v_mfma_f32_16x16x32_bf16 a[28:31], a[176:179], v[140:143], a[28:31]
  v_exp_f32 v63, v63
  v_mfma_f32_16x16x32_bf16 a[28:31], a[172:175], v[108:111], a[28:31]
  v_cvt_pk_bf16_f32 v47, v62, v63
  s_sub_u32 s30, s30, 1
  s_cmp_lg_u32 s30, 0
  s_cbranch_scc1 Lk2_l2
  s_branch Lk2_fin
Lk2_g1:
  s_mov_b32 s30, 7
Lk2_l3:
  s_waitcnt lgkmcnt(4)
  s_add_u32 m0, s29, 98304
  v_mfma_f32_16x16x32_bf16 v[96:99], a[116:119], a[52:55], 0
  v_exp_f32 v64, v64
  v_mfma_f32_16x16x32_bf16 v[96:99], a[120:123], a[56:59], v[96:99]
  ds_read_b128 a[148:151], v2 offset:8192
  ds_read_b128 a[152:155], v2 offset:9216
  v_mfma_f32_16x16x32_bf16 v[96:99], a[124:127], a[60:63], v[96:99]
  v_exp_f32 v65, v65
  v_mfma_f32_16x16x32_bf16 v[96:99], a[128:131], a[64:67], v[96:99]
  buffer_load_dwordx4 v1, s[12:15], s26 offen offset:0 lds
  s_add_u32 s32, s26, 4096
  v_mfma_f32_16x16x32_bf16 v[100:103], a[128:131], a[80:83], 0
  v_exp_f32 v66, v66
  v_mfma_f32_16x16x32_bf16 v[100:103], a[124:127], a[76:79], v[100:103]
  v_cvt_pk_bf16_f32 v64, v64, v65
  v_mfma_f32_16x16x32_bf16 v[100:103], a[120:123], a[72:75], v[100:103]
  v_exp_f32 v67, v67
  v_mfma_f32_16x16x32_bf16 v[100:103], a[116:119], a[68:71], v[100:103]
  buffer_load_dwordx4 v1, s[12:15], s26 offen offset:1024 lds
  v_mfma_f32_16x16x32_bf16 v[104:107], a[116:119], a[84:87], 0
  v_exp_f32 v80, v80
  v_mfma_f32_16x16x32_bf16 v[104:107], a[120:123], a[88:91], v[104:107]
  ds_read_b128 a[156:159], v2 offset:10240
  ds_read_b128 a[160:163], v2 offset:11264
  v_mfma_f32_16x16x32_bf16 v[104:107], a[124:127], a[92:95], v[104:107]
  v_exp_f32 v81, v81
  v_mfma_f32_16x16x32_bf16 v[104:107], a[128:131], a[96:99], v[104:107]
  buffer_load_dwordx4 v1, s[12:15], s26 offen offset:2048 lds
  v_mfma_f32_16x16x32_bf16 v[108:111], a[128:131], a[112:115], 0
  v_exp_f32 v82, v82
  v_mfma_f32_16x16x32_bf16 v[108:111], a[124:127], a[108:111], v[108:111]
  v_cvt_pk_bf16_f32 v65, v66, v67
  v_cvt_pk_bf16_f32 v66, v80, v81
  v_mfma_f32_16x16x32_bf16 v[108:111], a[120:123], a[104:107], v[108:111]
  v_exp_f32 v83, v83
  v_mfma_f32_16x16x32_bf16 v[108:111], a[116:119], a[100:103], v[108:111]
  buffer_load_dwordx4 v1, s[12:15], s26 offen offset:3072 lds
  s_add_u32 m0, s29, 102400
  s_waitcnt lgkmcnt(4)
  v_mfma_f32_16x16x32_bf16 v[112:115], a[132:135], a[52:55], 0
  v_exp_f32 v68, v68
  v_mfma_f32_16x16x32_bf16 v[112:115], a[136:139], a[56:59], v[112:115]
  ds_read_b128 a[164:167], v2 offset:12288
  ds_read_b128 a[168:171], v2 offset:13312
  v_mfma_f32_16x16x32_bf16 v[112:115], a[140:143], a[60:63], v[112:115]
  v_exp_f32 v69, v69
  v_mfma_f32_16x16x32_bf16 v[112:115], a[144:147], a[64:67], v[112:115]
  buffer_load_dwordx4 v1, s[12:15], s32 offen offset:0 lds
  v_mfma_f32_16x16x32_bf16 v[116:119], a[144:147], a[80:83], 0
  v_exp_f32 v70, v70
  v_mfma_f32_16x16x32_bf16 v[116:119], a[140:143], a[76:79], v[116:119]
  v_cvt_pk_bf16_f32 v67, v82, v83
  v_cvt_pk_bf16_f32 v68, v68, v69
  v_mfma_f32_16x16x32_bf16 v[116:119], a[136:139], a[72:75], v[116:119]
  v_exp_f32 v71, v71
  v_mfma_f32_16x16x32_bf16 v[116:119], a[132:135], a[68:71], v[116:119]
  buffer_load_dwordx4 v1, s[12:15], s32 offen offset:1024 lds
  v_mfma_f32_16x16x32_bf16 v[120:123], a[132:135], a[84:87], 0
  v_exp_f32 v84, v84
  v_mfma_f32_16x16x32_bf16 v[120:123], a[136:139], a[88:91], v[120:123]
  ds_read_b128 a[172:175], v2 offset:14336
  ds_read_b128 a[176:179], v2 offset:15360
  v_mfma_f32_16x16x32_bf16 v[120:123], a[140:143], a[92:95], v[120:123]
  v_exp_f32 v85, v85
  v_mfma_f32_16x16x32_bf16 v[120:123], a[144:147], a[96:99], v[120:123]
  buffer_load_dwordx4 v1, s[12:15], s32 offen offset:2048 lds
  v_mfma_f32_16x16x32_bf16 v[124:127], a[144:147], a[112:115], 0
  v_exp_f32 v86, v86
  v_mfma_f32_16x16x32_bf16 v[124:127], a[140:143], a[108:111], v[124:127]
  v_cvt_pk_bf16_f32 v69, v70, v71
  v_cvt_pk_bf16_f32 v70, v84, v85
  v_mfma_f32_16x16x32_bf16 v[124:127], a[136:139], a[104:107], v[124:127]
  v_exp_f32 v87, v87
  v_mfma_f32_16x16x32_bf16 v[124:127], a[132:135], a[100:103], v[124:127]
  buffer_load_dwordx4 v1, s[12:15], s32 offen offset:3072 lds
  s_waitcnt lgkmcnt(4)
  v_mfma_f32_16x16x32_bf16 v[128:131], a[148:151], a[52:55], 0
  v_exp_f32 v72, v72
  v_mfma_f32_16x16x32_bf16 v[128:131], a[152:155], a[56:59], v[128:131]
  s_add_u32 s26, s26, 32768
  s_cmp_eq_u32 s26, s62
  s_cselect_b32 s26, s63, s26
  s_cselect_b32 s62, -1, s62
  v_mfma_f32_16x16x32_bf16 v[128:131], a[156:159], a[60:63], v[128:131]
  v_exp_f32 v73, v73
  v_mfma_f32_16x16x32_bf16 v[128:131], a[160:163], a[64:67], v[128:131]
  v_cvt_pk_bf16_f32 v71, v86, v87
  v_cvt_pk_bf16_f32 v72, v72, v73
  v_mfma_f32_16x16x32_bf16 v[132:135], a[160:163], a[80:83], 0
  v_exp_f32 v74, v74
  v_mfma_f32_16x16x32_bf16 v[132:135], a[156:159], a[76:79], v[132:135]
  v_mfma_f32_16x16x32_bf16 v[132:135], a[152:155], a[72:75], v[132:135]
  v_exp_f32 v75, v75
  v_mfma_f32_16x16x32_bf16 v[132:135], a[148:151], a[68:71], v[132:135]
  v_cvt_pk_bf16_f32 v73, v74, v75
  v_mfma_f32_16x16x32_bf16 v[136:139], a[148:151], a[84:87], 0
  v_exp_f32 v88, v88
  v_mfma_f32_16x16x32_bf16 v[136:139], a[152:155], a[88:91], v[136:139]
  v_mfma_f32_16x16x32_bf16 v[136:139], a[156:159], a[92:95], v[136:139]
  v_exp_f32 v89, v89
  v_mfma_f32_16x16x32_bf16 v[136:139], a[160:163], a[96:99], v[136:139]
  v_cvt_pk_bf16_f32 v74, v88, v89
  v_mfma_f32_16x16x32_bf16 v[140:143], a[160:163], a[112:115], 0
  v_exp_f32 v90, v90
  v_mfma_f32_16x16x32_bf16 v[140:143], a[156:159], a[108:111], v[140:143]
  s_waitcnt vmcnt(16) lgkmcnt(0)
  s_barrier
  ds_read_b128 a[116:119], v2 offset:32768
  ds_read_b128 a[120:123], v2 offset:40960
  ds_read_b128 a[124:127], v2 offset:33792
  ds_read_b128 a[128:131], v2 offset:41984
  v_mfma_f32_16x16x32_bf16 v[140:143], a[152:155], a[104:107], v[140:143]
  v_exp_f32 v91, v91
  v_mfma_f32_16x16x32_bf16 v[140:143], a[148:151], a[100:103], v[140:143]
  v_cvt_pk_bf16_f32 v75, v90, v91
  v_mfma_f32_16x16x32_bf16 v[144:147], a[164:167], a[52:55], 0
  v_exp_f32 v76, v76
  v_mfma_f32_16x16x32_bf16 v[144:147], a[168:171], a[56:59], v[144:147]
  ds_read_b128 a[132:135], v2 offset:34816
  ds_read_b128 a[136:139], v2 offset:43008
  v_mfma_f32_16x16x32_bf16 v[144:147], a[172:175], a[60:63], v[144:147]
  v_exp_f32 v77, v77
  v_mfma_f32_16x16x32_bf16 v[144:147], a[176:179], a[64:67], v[144:147]
  v_cvt_pk_bf16_f32 v76, v76, v77
  v_mfma_f32_16x16x32_bf16 v[148:151], a[176:179], a[80:83], 0
  v_exp_f32 v78, v78
  v_mfma_f32_16x16x32_bf16 v[148:151], a[172:175], a[76:79], v[148:151]
  v_mfma_f32_16x16x32_bf16 v[148:151], a[168:171], a[72:75], v[148:151]
  v_exp_f32 v79, v79
  v_mfma_f32_16x16x32_bf16 v[148:151], a[164:167], a[68:71], v[148:151]
  v_cvt_pk_bf16_f32 v77, v78, v79
  v_mfma_f32_16x16x32_bf16 v[152:155], a[164:167], a[84:87], 0
  v_exp_f32 v92, v92
  v_mfma_f32_16x16x32_bf16 v[152:155], a[168:171], a[88:91], v[152:155]
  ds_read_b128 a[140:143], v2 offset:35840
  ds_read_b128 a[144:147], v2 offset:44032
  v_mfma_f32_16x16x32_bf16 v[152:155], a[172:175], a[92:95], v[152:155]
  v_exp_f32 v93, v93
  v_mfma_f32_16x16x32_bf16 v[152:155], a[176:179], a[96:99], v[152:155]
  v_cvt_pk_bf16_f32 v78, v92, v93
  v_mfma_f32_16x16x32_bf16 v[156:159], a[176:179], a[112:115], 0
  v_exp_f32 v94, v94
  v_mfma_f32_16x16x32_bf16 v[156:159], a[172:175], a[108:111], v[156:159]
  v_mfma_f32_16x16x32_bf16 v[156:159], a[168:171], a[104:107], v[156:159]
  v_exp_f32 v95, v95
  v_mfma_f32_16x16x32_bf16 v[156:159], a[164:167], a[100:103], v[156:159]
  v_cvt_pk_bf16_f32 v79, v94, v95
  s_waitcnt lgkmcnt(6)
  s_add_u32 m0, s29, 0
  v_mfma_f32_16x16x32_bf16 v[160:163], a[116:119], v[32:35], v[160:163]
  v_exp_f32 v96, v96
  v_mfma_f32_16x16x32_bf16 v[160:163], a[120:123], v[64:67], v[160:163]
  ds_read_b128 a[148:151], v2 offset:36864
  ds_read_b128 a[152:155], v2 offset:45056
  v_mfma_f32_16x16x32_bf16 v[164:167], a[120:123], v[68:71], v[164:167]
  v_exp_f32 v97, v97
  v_mfma_f32_16x16x32_bf16 v[164:167], a[116:119], v[36:39], v[164:167]
  buffer_load_dwordx4 v1, s[12:15], s25 offen offset:0 lds
  s_add_u32 s32, s25, 4096
  v_mfma_f32_16x16x32_bf16 v[168:171], a[116:119], v[40:43], v[168:171]
  v_exp_f32 v98, v98
  v_mfma_f32_16x16x32_bf16 v[168:171], a[120:123], v[72:75], v[168:171]
  v_cvt_pk_bf16_f32 v96, v96, v97
  v_mfma_f32_16x16x32_bf16 v[172:175], a[120:123], v[76:79], v[172:175]
  v_exp_f32 v99, v99
  v_mfma_f32_16x16x32_bf16 v[172:175], a[116:119], v[44:47], v[172:175]
  buffer_load_dwordx4 v1, s[12:15], s25 offen offset:1024 lds
  s_waitcnt lgkmcnt(6)
  v_mfma_f32_16x16x32_bf16 a[32:35], a[48:51], v[32:35], a[32:35]
  v_mfma_f32_16x16x32_bf16 a[32:35], a[48:51], v[64:67], a[32:35]
  v_mfma_f32_16x16x32_bf16 v[176:179], a[124:127], v[32:35], v[176:179]
  v_exp_f32 v112, v112
  v_mfma_f32_16x16x32_bf16 v[176:179], a[128:131], v[64:67], v[176:179]
  ds_read_b128 a[156:159], v2 offset:37888
  ds_read_b128 a[160:163], v2 offset:46080
  v_mfma_f32_16x16x32_bf16 v[180:183], a[128:131], v[68:71], v[180:183]
  v_exp_f32 v113, v113
  v_mfma_f32_16x16x32_bf16 v[180:183], a[124:127], v[36:39], v[180:183]
  buffer_load_dwordx4 v1, s[12:15], s25 offen offset:2048 lds
  v_mfma_f32_16x16x32_bf16 v[184:187], a[124:127], v[40:43], v[184:187]
  v_exp_f32 v114, v114
  v_mfma_f32_16x16x32_bf16 v[184:187], a[128:131], v[72:75], v[184:187]
  v_cvt_pk_bf16_f32 v97, v98, v99
  v_cvt_pk_bf16_f32 v98, v112, v113
  v_mfma_f32_16x16x32_bf16 v[188:191], a[128:131], v[76:79], v[188:191]
  v_exp_f32 v115, v115
  v_mfma_f32_16x16x32_bf16 v[188:191], a[124:127], v[44:47], v[188:191]
  buffer_load_dwordx4 v1, s[12:15], s25 offen offset:3072 lds
  s_add_u32 m0, s29, 4096
  s_waitcnt lgkmcnt(6)
  v_mfma_f32_16x16x32_bf16 a[36:39], a[48:51], v[36:39], a[36:39]
  v_mfma_f32_16x16x32_bf16 a[36:39], a[48:51], v[68:71], a[36:39]
  v_mfma_f32_16x16x32_bf16 v[192:195], a[132:135], v[32:35], v[192:195]
  v_exp_f32 v100, v100
  v_mfma_f32_16x16x32_bf16 v[192:195], a[136:139], v[64:67], v[192:195]
  ds_read_b128 a[164:167], v2 offset:38912
  ds_read_b128 a[168:171], v2 offset:47104
  v_mfma_f32_16x16x32_bf16 v[196:199], a[136:139], v[68:71], v[196:199]
  v_exp_f32 v101, v101
  v_mfma_f32_16x16x32_bf16 v[196:199], a[132:135], v[36:39], v[196:199]
  buffer_load_dwordx4 v1, s[12:15], s32 offen offset:0 lds
  v_mfma_f32_16x16x32_bf16 v[200:203], a[132:135], v[40:43], v[200:203]
  v_exp_f32 v102, v102
  v_mfma_f32_16x16x32_bf16 v[200:203], a[136:139], v[72:75], v[200:203]
  v_cvt_pk_bf16_f32 v99, v114, v115
  v_cvt_pk_bf16_f32 v100, v100, v101
  v_mfma_f32_16x16x32_bf16 v[204:207], a[136:139], v[76:79], v[204:207]
  v_exp_f32 v103, v103
  v_mfma_f32_16x16x32_bf16 v[204:207], a[132:135], v[44:47], v[204:207]
  buffer_load_dwordx4 v1, s[12:15], s32 offen offset:1024 lds
  s_waitcnt lgkmcnt(6)
  v_mfma_f32_16x16x32_bf16 a[40:43], a[48:51], v[40:43], a[40:43]
  v_mfma_f32_16x16x32_bf16 a[40:43], a[48:51], v[72:75], a[40:43]
  v_mfma_f32_16x16x32_bf16 v[208:211], a[140:143], v[32:35], v[208:211]
  v_exp_f32 v116, v116
  v_mfma_f32_16x16x32_bf16 v[208:211], a[144:147], v[64:67], v[208:211]
  ds_read_b128 a[172:175], v2 offset:39936
  ds_read_b128 a[176:179], v2 offset:48128
  v_mfma_f32_16x16x32_bf16 v[212:215], a[144:147], v[68:71], v[212:215]
  v_exp_f32 v117, v117
  v_mfma_f32_16x16x32_bf16 v[212:215], a[140:143], v[36:39], v[212:215]
  buffer_load_dwordx4 v1, s[12:15], s32 offen offset:2048 lds
  v_mfma_f32_16x16x32_bf16 v[216:219], a[140:143], v[40:43], v[216:219]
  v_exp_f32 v118, v118
  v_mfma_f32_16x16x32_bf16 v[216:219], a[144:147], v[72:75], v[216:219]
  v_cvt_pk_bf16_f32 v101, v102, v103
  v_cvt_pk_bf16_f32 v102, v116, v117
  v_mfma_f32_16x16x32_bf16 v[220:223], a[144:147], v[76:79], v[220:223]
  v_exp_f32 v119, v119
  v_mfma_f32_16x16x32_bf16 v[220:223], a[140:143], v[44:47], v[220:223]
  buffer_load_dwordx4 v1, s[12:15], s32 offen offset:3072 lds
  s_waitcnt lgkmcnt(6)
  v_mfma_f32_16x16x32_bf16 a[44:47], a[48:51], v[44:47], a[44:47]
  v_mfma_f32_16x16x32_bf16 a[44:47], a[48:51], v[76:79], a[44:47]
  v_mfma_f32_16x16x32_bf16 v[224:227], a[148:151], v[32:35], v[224:227]
  v_exp_f32 v104, v104
  v_mfma_f32_16x16x32_bf16 v[224:227], a[152:155], v[64:67], v[224:227]
  s_add_u32 s25, s25, 32768
  s_cmp_eq_u32 s25, s27
  s_cselect_b32 s25, s28, s25
  s_cselect_b32 s27, -1, s27
  v_mfma_f32_16x16x32_bf16 v[228:231], a[152:155], v[68:71], v[228:231]
  v_exp_f32 v105, v105
  v_mfma_f32_16x16x32_bf16 v[228:231], a[148:151], v[36:39], v[228:231]
  v_cvt_pk_bf16_f32 v103, v118, v119
  v_cvt_pk_bf16_f32 v104, v104, v105
  v_mfma_f32_16x16x32_bf16 v[232:235], a[148:151], v[40:43], v[232:235]
  v_exp_f32 v106, v106
  v_mfma_f32_16x16x32_bf16 v[232:235], a[152:155], v[72:75], v[232:235]
  v_mfma_f32_16x16x32_bf16 v[236:239], a[152:155], v[76:79], v[236:239]
  v_exp_f32 v107, v107
  v_mfma_f32_16x16x32_bf16 v[236:239], a[148:151], v[44:47], v[236:239]
  v_cvt_pk_bf16_f32 v105, v106, v107
  s_waitcnt lgkmcnt(4)
  v_mfma_f32_16x16x32_bf16 v[240:243], a[156:159], v[32:35], v[240:243]
  v_exp_f32 v120, v120
  v_mfma_f32_16x16x32_bf16 v[240:243], a[160:163], v[64:67], v[240:243]
  v_mfma_f32_16x16x32_bf16 v[244:247], a[160:163], v[68:71], v[244:247]
  v_exp_f32 v121, v121
  v_mfma_f32_16x16x32_bf16 v[244:247], a[156:159], v[36:39], v[244:247]
  v_cvt_pk_bf16_f32 v106, v120, v121
  v_mfma_f32_16x16x32_bf16 v[248:251], a[156:159], v[40:43], v[248:251]
  v_exp_f32 v122, v122
  v_mfma_f32_16x16x32_bf16 v[248:251], a[160:163], v[72:75], v[248:251]
  s_waitcnt vmcnt(16) lgkmcnt(0)
  s_barrier
  ds_read_b128 a[116:119], v3 offset:0
  ds_read_b128 a[120:123], v3 offset:1024
  ds_read_b128 a[124:127], v3 offset:2048
  ds_read_b128 a[128:131], v3 offset:3072
  v_mfma_f32_16x16x32_bf16 v[252:255], a[160:163], v[76:79], v[252:255]
  v_exp_f32 v123, v123
  v_mfma_f32_16x16x32_bf16 v[252:255], a[156:159], v[44:47], v[252:255]
  v_cvt_pk_bf16_f32 v107, v122, v123
  v_mfma_f32_16x16x32_bf16 a[0:3], a[164:167], v[32:35], a[0:3]
  v_exp_f32 v108, v108
  v_mfma_f32_16x16x32_bf16 a[0:3], a[168:171], v[64:67], a[0:3]
  ds_read_b128 a[132:135], v3 offset:4096
  ds_read_b128 a[136:139], v3 offset:5120
  v_mfma_f32_16x16x32_bf16 a[4:7], a[168:171], v[68:71], a[4:7]
  v_exp_f32 v109, v109
  v_mfma_f32_16x16x32_bf16 a[4:7], a[164:167], v[36:39], a[4:7]
  v_cvt_pk_bf16_f32 v108, v108, v109
  v_mfma_f32_16x16x32_bf16 a[8:11], a[164:167], v[40:43], a[8:11]
  v_exp_f32 v110, v110
  v_mfma_f32_16x16x32_bf16 a[8:11], a[168:171], v[72:75], a[8:11]
  v_mfma_f32_16x16x32_bf16 a[12:15], a[168:171], v[76:79], a[12:15]
  v_exp_f32 v111, v111
  v_mfma_f32_16x16x32_bf16 a[12:15], a[164:167], v[44:47], a[12:15]
  v_cvt_pk_bf16_f32 v109, v110, v111
  v_mfma_f32_16x16x32_bf16 a[16:19], a[172:175], v[32:35], a[16:19]
  v_exp_f32 v124, v124
  v_mfma_f32_16x16x32_bf16 a[16:19], a[176:179], v[64:67], a[16:19]
  ds_read_b128 a[140:143], v3 offset:6144
  ds_read_b128 a[144:147], v3 offset:7168
  v_mfma_f32_16x16x32_bf16 a[20:23], a[176:179], v[68:71], a[20:23]
  v_exp_f32 v125, v125
  v_mfma_f32_16x16x32_bf16 a[20:23], a[172:175], v[36:39], a[20:23]
  v_cvt_pk_bf16_f32 v110, v124, v125
  v_mfma_f32_16x16x32_bf16 a[24:27], a[172:175], v[40:43], a[24:27]
  v_exp_f32 v126, v126
  v_mfma_f32_16x16x32_bf16 a[24:27], a[176:179], v[72:75], a[24:27]
  v_mfma_f32_16x16x32_bf16 a[28:31], a[176:179], v[76:79], a[28:31]
  v_exp_f32 v127, v127
  v_mfma_f32_16x16x32_bf16 a[28:31], a[172:175], v[44:47], a[28:31]
  v_cvt_pk_bf16_f32 v111, v126, v127
  s_waitcnt lgkmcnt(4)
  s_add_u32 m0, s29, 32768
  v_mfma_f32_16x16x32_bf16 v[32:35], a[116:119], a[52:55], 0
  v_exp_f32 v128, v128
  v_mfma_f32_16x16x32_bf16 v[32:35], a[120:123], a[56:59], v[32:35]
  ds_read_b128 a[148:151], v3 offset:8192
  ds_read_b128 a[152:155], v3 offset:9216
  v_mfma_f32_16x16x32_bf16 v[32:35], a[124:127], a[60:63], v[32:35]
  v_exp_f32 v129, v129
  v_mfma_f32_16x16x32_bf16 v[32:35], a[128:131], a[64:67], v[32:35]
  buffer_load_dwordx4 v1, s[12:15], s26 offen offset:0 lds
  s_add_u32 s32, s26, 4096
  v_mfma_f32_16x16x32_bf16 v[36:39], a[128:131], a[80:83], 0
  v_exp_f32 v130, v130
  v_mfma_f32_16x16x32_bf16 v[36:39], a[124:127], a[76:79], v[36:39]
  v_cvt_pk_bf16_f32 v128, v128, v129
  v_mfma_f32_16x16x32_bf16 v[36:39], a[120:123], a[72:75], v[36:39]
  v_exp_f32 v131, v131
  v_mfma_f32_16x16x32_bf16 v[36:39], a[116:119], a[68:71], v[36:39]
  buffer_load_dwordx4 v1, s[12:15], s26 offen offset:1024 lds
  v_mfma_f32_16x16x32_bf16 v[40:43], a[116:119], a[84:87], 0
  v_exp_f32 v144, v144
  v_mfma_f32_16x16x32_bf16 v[40:43], a[120:123], a[88:91], v[40:43]
  ds_read_b128 a[156:159], v3 offset:10240
  ds_read_b128 a[160:163], v3 offset:11264
  v_mfma_f32_16x16x32_bf16 v[40:43], a[124:127], a[92:95], v[40:43]
  v_exp_f32 v145, v145
  v_mfma_f32_16x16x32_bf16 v[40:43], a[128:131], a[96:99], v[40:43]
  buffer_load_dwordx4 v1, s[12:15], s26 offen offset:2048 lds
  v_mfma_f32_16x16x32_bf16 v[44:47], a[128:131], a[112:115], 0
  v_exp_f32 v146, v146
  v_mfma_f32_16x16x32_bf16 v[44:47], a[124:127], a[108:111], v[44:47]
  v_cvt_pk_bf16_f32 v129, v130, v131
  v_cvt_pk_bf16_f32 v130, v144, v145
  v_mfma_f32_16x16x32_bf16 v[44:47], a[120:123], a[104:107], v[44:47]
  v_exp_f32 v147, v147
  v_mfma_f32_16x16x32_bf16 v[44:47], a[116:119], a[100:103], v[44:47]
  buffer_load_dwordx4 v1, s[12:15], s26 offen offset:3072 lds
  s_add_u32 m0, s29, 36864
  s_waitcnt lgkmcnt(4)
  v_mfma_f32_16x16x32_bf16 v[48:51], a[132:135], a[52:55], 0
  v_exp_f32 v132, v132
  v_mfma_f32_16x16x32_bf16 v[48:51], a[136:139], a[56:59], v[48:51]
  ds_read_b128 a[164:167], v3 offset:12288
  ds_read_b128 a[168:171], v3 offset:13312
  v_mfma_f32_16x16x32_bf16 v[48:51], a[140:143], a[60:63], v[48:51]
  v_exp_f32 v133, v133
  v_mfma_f32_16x16x32_bf16 v[48:51], a[144:147], a[64:67], v[48:51]
  buffer_load_dwordx4 v1, s[12:15], s32 offen offset:0 lds
  v_mfma_f32_16x16x32_bf16 v[52:55], a[144:147], a[80:83], 0
  v_exp_f32 v134, v134
  v_mfma_f32_16x16x32_bf16 v[52:55], a[140:143], a[76:79], v[52:55]
  v_cvt_pk_bf16_f32 v131, v146, v147
  v_cvt_pk_bf16_f32 v132, v132, v133
  v_mfma_f32_16x16x32_bf16 v[52:55], a[136:139], a[72:75], v[52:55]
  v_exp_f32 v135, v135
  v_mfma_f32_16x16x32_bf16 v[52:55], a[132:135], a[68:71], v[52:55]
  buffer_load_dwordx4 v1, s[12:15], s32 offen offset:1024 lds
  v_mfma_f32_16x16x32_bf16 v[56:59], a[132:135], a[84:87], 0
  v_exp_f32 v148, v148
  v_mfma_f32_16x16x32_bf16 v[56:59], a[136:139], a[88:91], v[56:59]
  ds_read_b128 a[172:175], v3 offset:14336
  ds_read_b128 a[176:179], v3 offset:15360
  v_mfma_f32_16x16x32_bf16 v[56:59], a[140:143], a[92:95], v[56:59]
  v_exp_f32 v149, v149
  v_mfma_f32_16x16x32_bf16 v[56:59], a[144:147], a[96:99], v[56:59]
  buffer_load_dwordx4 v1, s[12:15], s32 offen offset:2048 lds
  v_mfma_f32_16x16x32_bf16 v[60:63], a[144:147], a[112:115], 0
  v_exp_f32 v150, v150
  v_mfma_f32_16x16x32_bf16 v[60:63], a[140:143], a[108:111], v[60:63]
  v_cvt_pk_bf16_f32 v133, v134, v135
  v_cvt_pk_bf16_f32 v134, v148, v149
  v_mfma_f32_16x16x32_bf16 v[60:63], a[136:139], a[104:107], v[60:63]
  v_exp_f32 v151, v151
  v_mfma_f32_16x16x32_bf16 v[60:63], a[132:135], a[100:103], v[60:63]
  buffer_load_dwordx4 v1, s[12:15], s32 offen offset:3072 lds
  s_waitcnt lgkmcnt(4)
  v_mfma_f32_16x16x32_bf16 v[64:67], a[148:151], a[52:55], 0
  v_exp_f32 v136, v136
  v_mfma_f32_16x16x32_bf16 v[64:67], a[152:155], a[56:59], v[64:67]
  s_add_u32 s26, s26, 32768
  s_cmp_eq_u32 s26, s62
  s_cselect_b32 s26, s63, s26
  s_cselect_b32 s62, -1, s62
  v_mfma_f32_16x16x32_bf16 v[64:67], a[156:159], a[60:63], v[64:67]
  v_exp_f32 v137, v137
  v_mfma_f32_16x16x32_bf16 v[64:67], a[160:163], a[64:67], v[64:67]
  v_cvt_pk_bf16_f32 v135, v150, v151
  v_cvt_pk_bf16_f32 v136, v136, v137
  v_mfma_f32_16x16x32_bf16 v[68:71], a[160:163], a[80:83], 0
  v_exp_f32 v138, v138
  v_mfma_f32_16x16x32_bf16 v[68:71], a[156:159], a[76:79], v[68:71]
  v_mfma_f32_16x16x32_bf16 v[68:71], a[152:155], a[72:75], v[68:71]
  v_exp_f32 v139, v139
  v_mfma_f32_16x16x32_bf16 v[68:71], a[148:151], a[68:71], v[68:71]
  v_cvt_pk_bf16_f32 v137, v138, v139
  v_mfma_f32_16x16x32_bf16 v[72:75], a[148:151], a[84:87], 0
  v_exp_f32 v152, v152
  v_mfma_f32_16x16x32_bf16 v[72:75], a[152:155], a[88:91], v[72:75]
  v_mfma_f32_16x16x32_bf16 v[72:75], a[156:159], a[92:95], v[72:75]
  v_exp_f32 v153, v153
  v_mfma_f32_16x16x32_bf16 v[72:75], a[160:163], a[96:99], v[72:75]
  v_cvt_pk_bf16_f32 v138, v152, v153
  v_mfma_f32_16x16x32_bf16 v[76:79], a[160:163], a[112:115], 0
  v_exp_f32 v154, v154
  v_mfma_f32_16x16x32_bf16 v[76:79], a[156:159], a[108:111], v[76:79]
  s_waitcnt vmcnt(16) lgkmcnt(0)
  s_barrier
  ds_read_b128 a[116:119], v3 offset:32768
  ds_read_b128 a[120:123], v3 offset:40960
  ds_read_b128 a[124:127], v3 offset:33792
  ds_read_b128 a[128:131], v3 offset:41984
  v_mfma_f32_16x16x32_bf16 v[76:79], a[152:155], a[104:107], v[76:79]
  v_exp_f32 v155, v155
  v_mfma_f32_16x16x32_bf16 v[76:79], a[148:151], a[100:103], v[76:79]
  v_cvt_pk_bf16_f32 v139, v154, v155
  v_mfma_f32_16x16x32_bf16 v[80:83], a[164:167], a[52:55], 0
  v_exp_f32 v140, v140
  v_mfma_f32_16x16x32_bf16 v[80:83], a[168:171], a[56:59], v[80:83]
  ds_read_b128 a[132:135], v3 offset:34816
  ds_read_b128 a[136:139], v3 offset:43008
  v_mfma_f32_16x16x32_bf16 v[80:83], a[172:175], a[60:63], v[80:83]
  v_exp_f32 v141, v141
  v_mfma_f32_16x16x32_bf16 v[80:83], a[176:179], a[64:67], v[80:83]
  v_cvt_pk_bf16_f32 v140, v140, v141
  v_mfma_f32_16x16x32_bf16 v[84:87], a[176:179], a[80:83], 0
  v_exp_f32 v142, v142
  v_mfma_f32_16x16x32_bf16 v[84:87], a[172:175], a[76:79], v[84:87]
  v_mfma_f32_16x16x32_bf16 v[84:87], a[168:171], a[72:75], v[84:87]
  v_exp_f32 v143, v143
  v_mfma_f32_16x16x32_bf16 v[84:87], a[164:167], a[68:71], v[84:87]
  v_cvt_pk_bf16_f32 v141, v142, v143
  v_mfma_f32_16x16x32_bf16 v[88:91], a[164:167], a[84:87], 0
  v_exp_f32 v156, v156
  v_mfma_f32_16x16x32_bf16 v[88:91], a[168:171], a[88:91], v[88:91]
  ds_read_b128 a[140:143], v3 offset:35840
  ds_read_b128 a[144:147], v3 offset:44032
  v_mfma_f32_16x16x32_bf16 v[88:91], a[172:175], a[92:95], v[88:91]
  v_exp_f32 v157, v157
  v_mfma_f32_16x16x32_bf16 v[88:91], a[176:179], a[96:99], v[88:91]
  v_cvt_pk_bf16_f32 v142, v156, v157
  v_mfma_f32_16x16x32_bf16 v[92:95], a[176:179], a[112:115], 0
  v_exp_f32 v158, v158
  v_mfma_f32_16x16x32_bf16 v[92:95], a[172:175], a[108:111], v[92:95]
  v_mfma_f32_16x16x32_bf16 v[92:95], a[168:171], a[104:107], v[92:95]
  v_exp_f32 v159, v159
  v_mfma_f32_16x16x32_bf16 v[92:95], a[164:167], a[100:103], v[92:95]
  v_cvt_pk_bf16_f32 v143, v158, v159
  s_waitcnt lgkmcnt(6)
  s_add_u32 m0, s29, 65536
  v_mfma_f32_16x16x32_bf16 v[160:163], a[116:119], v[96:99], v[160:163]
  v_exp_f32 v32, v32
  v_mfma_f32_16x16x32_bf16 v[160:163], a[120:123], v[128:131], v[160:163]
  ds_read_b128 a[148:151], v3 offset:36864
  ds_read_b128 a[152:155], v3 offset:45056
  v_mfma_f32_16x16x32_bf16 v[164:167], a[120:123], v[132:135], v[164:167]
  v_exp_f32 v33, v33
  v_mfma_f32_16x16x32_bf16 v[164:167], a[116:119], v[100:103], v[164:167]
  buffer_load_dwordx4 v1, s[12:15], s25 offen offset:0 lds
  s_add_u32 s32, s25, 4096
  v_mfma_f32_16x16x32_bf16 v[168:171], a[116:119], v[104:107], v[168:171]
  v_exp_f32 v34, v34
  v_mfma_f32_16x16x32_bf16 v[168:171], a[120:123], v[136:139], v[168:171]
  v_cvt_pk_bf16_f32 v32, v32, v33
  v_mfma_f32_16x16x32_bf16 v[172:175], a[120:123], v[140:143], v[172:175]
  v_exp_f32 v35, v35
  v_mfma_f32_16x16x32_bf16 v[172:175], a[116:119], v[108:111], v[172:175]
  buffer_load_dwordx4 v1, s[12:15], s25 offen offset:1024 lds
  s_waitcnt lgkmcnt(6)
  v_mfma_f32_16x16x32_bf16 a[32:35], a[48:51], v[96:99], a[32:35]
  v_mfma_f32_16x16x32_bf16 a[32:35], a[48:51], v[128:131], a[32:35]
  v_mfma_f32_16x16x32_bf16 v[176:179], a[124:127], v[96:99], v[176:179]
  v_exp_f32 v48, v48
  v_mfma_f32_16x16x32_bf16 v[176:179], a[128:131], v[128:131], v[176:179]
  ds_read_b128 a[156:159], v3 offset:37888
  ds_read_b128 a[160:163], v3 offset:46080
  v_mfma_f32_16x16x32_bf16 v[180:183], a[128:131], v[132:135], v[180:183]
  v_exp_f32 v49, v49
  v_mfma_f32_16x16x32_bf16 v[180:183], a[124:127], v[100:103], v[180:183]
  buffer_load_dwordx4 v1, s[12:15], s25 offen offset:2048 lds
  v_mfma_f32_16x16x32_bf16 v[184:187], a[124:127], v[104:107], v[184:187]
  v_exp_f32 v50, v50
  v_mfma_f32_16x16x32_bf16 v[184:187], a[128:131], v[136:139], v[184:187]
  v_cvt_pk_bf16_f32 v33, v34, v35
  v_cvt_pk_bf16_f32 v34, v48, v49
  v_mfma_f32_16x16x32_bf16 v[188:191], a[128:131], v[140:143], v[188:191]
  v_exp_f32 v51, v51
  v_mfma_f32_16x16x32_bf16 v[188:191], a[124:127], v[108:111], v[188:191]
  buffer_load_dwordx4 v1, s[12:15], s25 offen offset:3072 lds
  s_add_u32 m0, s29, 69632
  s_waitcnt lgkmcnt(6)
  v_mfma_f32_16x16x32_bf16 a[36:39], a[48:51], v[100:103], a[36:39]
  v_mfma_f32_16x16x32_bf16 a[36:39], a[48:51], v[132:135], a[36:39]
  v_mfma_f32_16x16x32_bf16 v[192:195], a[132:135], v[96:99], v[192:195]
  v_exp_f32 v36, v36
  v_mfma_f32_16x16x32_bf16 v[192:195], a[136:139], v[128:131], v[192:195]
  ds_read_b128 a[164:167], v3 offset:38912
  ds_read_b128 a[168:171], v3 offset:47104
  v_mfma_f32_16x16x32_bf16 v[196:199], a[136:139], v[132:135], v[196:199]
  v_exp_f32 v37, v37
  v_mfma_f32_16x16x32_bf16 v[196:199], a[132:135], v[100:103], v[196:199]
  buffer_load_dwordx4 v1, s[12:15], s32 offen offset:0 lds
  v_mfma_f32_16x16x32_bf16 v[200:203], a[132:135], v[104:107], v[200:203]
  v_exp_f32 v38, v38
  v_mfma_f32_16x16x32_bf16 v[200:203], a[136:139], v[136:139], v[200:203]
  v_cvt_pk_bf16_f32 v35, v50, v51
  v_cvt_pk_bf16_f32 v36, v36, v37
  v_mfma_f32_16x16x32_bf16 v[204:207], a[136:139], v[140:143], v[204:207]
  v_exp_f32 v39, v39
  v_mfma_f32_16x16x32_bf16 v[204:207], a[132:135], v[108:111], v[204:207]
  buffer_load_dwordx4 v1, s[12:15], s32 offen offset:1024 lds
  s_waitcnt lgkmcnt(6)
  v_mfma_f32_16x16x32_bf16 a[40:43], a[48:51], v[104:107], a[40:43]
  v_mfma_f32_16x16x32_bf16 a[40:43], a[48:51], v[136:139], a[40:43]
  v_mfma_f32_16x16x32_bf16 v[208:211], a[140:143], v[96:99], v[208:211]
  v_exp_f32 v52, v52
  v_mfma_f32_16x16x32_bf16 v[208:211], a[144:147], v[128:131], v[208:211]
  ds_read_b128 a[172:175], v3 offset:39936
  ds_read_b128 a[176:179], v3 offset:48128
  v_mfma_f32_16x16x32_bf16 v[212:215], a[144:147], v[132:135], v[212:215]
  v_exp_f32 v53, v53
  v_mfma_f32_16x16x32_bf16 v[212:215], a[140:143], v[100:103], v[212:215]
  buffer_load_dwordx4 v1, s[12:15], s32 offen offset:2048 lds
  v_mfma_f32_16x16x32_bf16 v[216:219], a[140:143], v[104:107], v[216:219]
  v_exp_f32 v54, v54
  v_mfma_f32_16x16x32_bf16 v[216:219], a[144:147], v[136:139], v[216:219]
  v_cvt_pk_bf16_f32 v37, v38, v39
  v_cvt_pk_bf16_f32 v38, v52, v53
  v_mfma_f32_16x16x32_bf16 v[220:223], a[144:147], v[140:143], v[220:223]
  v_exp_f32 v55, v55
  v_mfma_f32_16x16x32_bf16 v[220:223], a[140:143], v[108:111], v[220:223]
  buffer_load_dwordx4 v1, s[12:15], s32 offen offset:3072 lds
  s_waitcnt lgkmcnt(6)
  v_mfma_f32_16x16x32_bf16 a[44:47], a[48:51], v[108:111], a[44:47]
  v_mfma_f32_16x16x32_bf16 a[44:47], a[48:51], v[140:143], a[44:47]
  v_mfma_f32_16x16x32_bf16 v[224:227], a[148:151], v[96:99], v[224:227]
  v_exp_f32 v40, v40
  v_mfma_f32_16x16x32_bf16 v[224:227], a[152:155], v[128:131], v[224:227]
  s_add_u32 s25, s25, 32768
  s_cmp_eq_u32 s25, s27
  s_cselect_b32 s25, s28, s25
  s_cselect_b32 s27, -1, s27
  v_mfma_f32_16x16x32_bf16 v[228:231], a[152:155], v[132:135], v[228:231]
  v_exp_f32 v41, v41
  v_mfma_f32_16x16x32_bf16 v[228:231], a[148:151], v[100:103], v[228:231]
  v_cvt_pk_bf16_f32 v39, v54, v55
  v_cvt_pk_bf16_f32 v40, v40, v41
  v_mfma_f32_16x16x32_bf16 v[232:235], a[148:151], v[104:107], v[232:235]
  v_exp_f32 v42, v42
  v_mfma_f32_16x16x32_bf16 v[232:235], a[152:155], v[136:139], v[232:235]
  v_mfma_f32_16x16x32_bf16 v[236:239], a[152:155], v[140:143], v[236:239]
  v_exp_f32 v43, v43
  v_mfma_f32_16x16x32_bf16 v[236:239], a[148:151], v[108:111], v[236:239]
  v_cvt_pk_bf16_f32 v41, v42, v43
  s_waitcnt lgkmcnt(4)
  v_mfma_f32_16x16x32_bf16 v[240:243], a[156:159], v[96:99], v[240:243]
  v_exp_f32 v56, v56
  v_mfma_f32_16x16x32_bf16 v[240:243], a[160:163], v[128:131], v[240:243]
  v_mfma_f32_16x16x32_bf16 v[244:247], a[160:163], v[132:135], v[244:247]
  v_exp_f32 v57, v57
  v_mfma_f32_16x16x32_bf16 v[244:247], a[156:159], v[100:103], v[244:247]
  v_cvt_pk_bf16_f32 v42, v56, v57
  v_mfma_f32_16x16x32_bf16 v[248:251], a[156:159], v[104:107], v[248:251]
  v_exp_f32 v58, v58
  v_mfma_f32_16x16x32_bf16 v[248:251], a[160:163], v[136:139], v[248:251]
  s_waitcnt vmcnt(16) lgkmcnt(0)
  s_barrier
  ds_read_b128 a[116:119], v2 offset:0
  ds_read_b128 a[120:123], v2 offset:1024
  ds_read_b128 a[124:127], v2 offset:2048
  ds_read_b128 a[128:131], v2 offset:3072
  v_mfma_f32_16x16x32_bf16 v[252:255], a[160:163], v[140:143], v[252:255]
  v_exp_f32 v59, v59
  v_mfma_f32_16x16x32_bf16 v[252:255], a[156:159], v[108:111], v[252:255]
  v_cvt_pk_bf16_f32 v43, v58, v59
  v_mfma_f32_16x16x32_bf16 a[0:3], a[164:167], v[96:99], a[0:3]
  v_exp_f32 v44, v44
  v_mfma_f32_16x16x32_bf16 a[0:3], a[168:171], v[128:131], a[0:3]
  ds_read_b128 a[132:135], v2 offset:4096
  ds_read_b128 a[136:139], v2 offset:5120
  v_mfma_f32_16x16x32_bf16 a[4:7], a[168:171], v[132:135], a[4:7]
  v_exp_f32 v45, v45
  v_mfma_f32_16x16x32_bf16 a[4:7], a[164:167], v[100:103], a[4:7]
  v_cvt_pk_bf16_f32 v44, v44, v45
  v_mfma_f32_16x16x32_bf16 a[8:11], a[164:167], v[104:107], a[8:11]
  v_exp_f32 v46, v46
  v_mfma_f32_16x16x32_bf16 a[8:11], a[168:171], v[136:139], a[8:11]
  v_mfma_f32_16x16x32_bf16 a[12:15], a[168:171], v[140:143], a[12:15]
  v_exp_f32 v47, v47
  v_mfma_f32_16x16x32_bf16 a[12:15], a[164:167], v[108:111], a[12:15]
  v_cvt_pk_bf16_f32 v45, v46, v47
  v_mfma_f32_16x16x32_bf16 a[16:19], a[172:175], v[96:99], a[16:19]
  v_exp_f32 v60, v60
  v_mfma_f32_16x16x32_bf16 a[16:19], a[176:179], v[128:131], a[16:19]
  ds_read_b128 a[140:143], v2 offset:6144
  ds_read_b128 a[144:147], v2 offset:7168
  v_mfma_f32_16x16x32_bf16 a[20:23], a[176:179], v[132:135], a[20:23]
  v_exp_f32 v61, v61
  v_mfma_f32_16x16x32_bf16 a[20:23], a[172:175], v[100:103], a[20:23]
  v_cvt_pk_bf16_f32 v46, v60, v61
  v_mfma_f32_16x16x32_bf16 a[24:27], a[172:175], v[104:107], a[24:27]
  v_exp_f32 v62, v62
  v_mfma_f32_16x16x32_bf16 a[24:27], a[176:179], v[136:139], a[24:27]
  v_mfma_f32_16x16x32_bf16 a[28:31], a[176:179], v[140:143], a[28:31]
  v_exp_f32 v63, v63
  v_mfma_f32_16x16x32_bf16 a[28:31], a[172:175], v[108:111], a[28:31]
  v_cvt_pk_bf16_f32 v47, v62, v63
  s_sub_u32 s30, s30, 1
  s_cmp_lg_u32 s30, 0
  s_cbranch_scc1 Lk2_l3
  s_lshl_b32 s33, s23, 6
  s_add_i32 s33, s33, 0
  s_cmp_gt_i32 s33, 0
  s_cselect_b32 s34, 0, 0xf149f2ca
  s_cmp_lt_i32 s33, 0
  s_cselect_b32 s33, 0xf149f2ca, 0
  v_mov_b32 v20, s34
  v_mov_b32 v21, s34
  v_mov_b32 v22, s34
  v_mov_b32 v23, s34
  v_mov_b32 v28, s33
  v_mov_b32 v29, s33
  v_mov_b32 v30, s33
  v_mov_b32 v31, s33
  v_med3_f32 v24, v16, v20, v28
  v_med3_f32 v25, v17, v20, v28
  v_med3_f32 v26, v18, v20, v28
  v_med3_f32 v27, v19, v20, v28
  s_waitcnt lgkmcnt(4)
  s_add_u32 m0, s29, 98304
  v_mfma_f32_16x16x32_bf16 v[96:99], a[116:119], a[52:55], v[24:27]
  v_exp_f32 v64, v64
  v_mfma_f32_16x16x32_bf16 v[96:99], a[120:123], a[56:59], v[96:99]
  ds_read_b128 a[148:151], v2 offset:8192
  ds_read_b128 a[152:155], v2 offset:9216
  v_mfma_f32_16x16x32_bf16 v[96:99], a[124:127], a[60:63], v[96:99]
  v_exp_f32 v65, v65
  v_mfma_f32_16x16x32_bf16 v[96:99], a[128:131], a[64:67], v[96:99]
  buffer_load_dwordx4 v1, s[12:15], s26 offen offset:0 lds
  s_add_u32 s32, s26, 4096
  v_mfma_f32_16x16x32_bf16 v[100:103], a[128:131], a[80:83], v[28:31]
  v_exp_f32 v66, v66
  v_mfma_f32_16x16x32_bf16 v[100:103], a[124:127], a[76:79], v[100:103]
  v_cvt_pk_bf16_f32 v64, v64, v65
  v_mfma_f32_16x16x32_bf16 v[100:103], a[120:123], a[72:75], v[100:103]
  v_exp_f32 v67, v67
  v_mfma_f32_16x16x32_bf16 v[100:103], a[116:119], a[68:71], v[100:103]
  buffer_load_dwordx4 v1, s[12:15], s26 offen offset:1024 lds
  v_mfma_f32_16x16x32_bf16 v[104:107], a[116:119], a[84:87], v[28:31]
  v_exp_f32 v80, v80
  v_mfma_f32_16x16x32_bf16 v[104:107], a[120:123], a[88:91], v[104:107]
  ds_read_b128 a[156:159], v2 offset:10240
  ds_read_b128 a[160:163], v2 offset:11264
  v_mfma_f32_16x16x32_bf16 v[104:107], a[124:127], a[92:95], v[104:107]
  v_exp_f32 v81, v81
  v_mfma_f32_16x16x32_bf16 v[104:107], a[128:131], a[96:99], v[104:107]
  buffer_load_dwordx4 v1, s[12:15], s26 offen offset:2048 lds
  v_mfma_f32_16x16x32_bf16 v[108:111], a[128:131], a[112:115], v[28:31]
  v_exp_f32 v82, v82
  v_mfma_f32_16x16x32_bf16 v[108:111], a[124:127], a[108:111], v[108:111]
  v_cvt_pk_bf16_f32 v65, v66, v67
  v_cvt_pk_bf16_f32 v66, v80, v81
  v_mfma_f32_16x16x32_bf16 v[108:111], a[120:123], a[104:107], v[108:111]
  v_exp_f32 v83, v83
  v_mfma_f32_16x16x32_bf16 v[108:111], a[116:119], a[100:103], v[108:111]
  buffer_load_dwordx4 v1, s[12:15], s26 offen offset:3072 lds
  s_add_u32 m0, s29, 102400
  s_waitcnt lgkmcnt(4)
  v_mfma_f32_16x16x32_bf16 v[112:115], a[132:135], a[52:55], v[20:23]
  v_exp_f32 v68, v68
  v_mfma_f32_16x16x32_bf16 v[112:115], a[136:139], a[56:59], v[112:115]
  ds_read_b128 a[164:167], v2 offset:12288
  ds_read_b128 a[168:171], v2 offset:13312
  v_mfma_f32_16x16x32_bf16 v[112:115], a[140:143], a[60:63], v[112:115]
  v_exp_f32 v69, v69
  v_mfma_f32_16x16x32_bf16 v[112:115], a[144:147], a[64:67], v[112:115]
  buffer_load_dwordx4 v1, s[12:15], s32 offen offset:0 lds
  v_mfma_f32_16x16x32_bf16 v[116:119], a[144:147], a[80:83], v[24:27]
  v_exp_f32 v70, v70
  v_mfma_f32_16x16x32_bf16 v[116:119], a[140:143], a[76:79], v[116:119]
  v_cvt_pk_bf16_f32 v67, v82, v83
  v_cvt_pk_bf16_f32 v68, v68, v69
  v_mfma_f32_16x16x32_bf16 v[116:119], a[136:139], a[72:75], v[116:119]
  v_exp_f32 v71, v71
  v_mfma_f32_16x16x32_bf16 v[116:119], a[132:135], a[68:71], v[116:119]
  buffer_load_dwordx4 v1, s[12:15], s32 offen offset:1024 lds
  v_mfma_f32_16x16x32_bf16 v[120:123], a[132:135], a[84:87], v[28:31]
  v_exp_f32 v84, v84
  v_mfma_f32_16x16x32_bf16 v[120:123], a[136:139], a[88:91], v[120:123]
  ds_read_b128 a[172:175], v2 offset:14336
  ds_read_b128 a[176:179], v2 offset:15360
  v_mfma_f32_16x16x32_bf16 v[120:123], a[140:143], a[92:95], v[120:123]
  v_exp_f32 v85, v85
  v_mfma_f32_16x16x32_bf16 v[120:123], a[144:147], a[96:99], v[120:123]
  buffer_load_dwordx4 v1, s[12:15], s32 offen offset:2048 lds
  v_mfma_f32_16x16x32_bf16 v[124:127], a[144:147], a[112:115], v[28:31]
  v_exp_f32 v86, v86
  v_mfma_f32_16x16x32_bf16 v[124:127], a[140:143], a[108:111], v[124:127]
  v_cvt_pk_bf16_f32 v69, v70, v71
  v_cvt_pk_bf16_f32 v70, v84, v85
  v_mfma_f32_16x16x32_bf16 v[124:127], a[136:139], a[104:107], v[124:127]
  v_exp_f32 v87, v87
  v_mfma_f32_16x16x32_bf16 v[124:127], a[132:135], a[100:103], v[124:127]
  buffer_load_dwordx4 v1, s[12:15], s32 offen offset:3072 lds
  s_waitcnt lgkmcnt(4)
  v_mfma_f32_16x16x32_bf16 v[128:131], a[148:151], a[52:55], v[20:23]
  v_exp_f32 v72, v72
  v_mfma_f32_16x16x32_bf16 v[128:131], a[152:155], a[56:59], v[128:131]
  s_add_u32 s26, s26, 32768
  s_cmp_eq_u32 s26, s62
  s_cselect_b32 s26, s63, s26
  s_cselect_b32 s62, -1, s62
  v_mfma_f32_16x16x32_bf16 v[128:131], a[156:159], a[60:63], v[128:131]
  v_exp_f32 v73, v73
  v_mfma_f32_16x16x32_bf16 v[128:131], a[160:163], a[64:67], v[128:131]
  v_cvt_pk_bf16_f32 v71, v86, v87
  v_cvt_pk_bf16_f32 v72, v72, v73
  v_mfma_f32_16x16x32_bf16 v[132:135], a[160:163], a[80:83], v[20:23]
  v_exp_f32 v74, v74
  v_mfma_f32_16x16x32_bf16 v[132:135], a[156:159], a[76:79], v[132:135]
  v_mfma_f32_16x16x32_bf16 v[132:135], a[152:155], a[72:75], v[132:135]
  v_exp_f32 v75, v75
  v_mfma_f32_16x16x32_bf16 v[132:135], a[148:151], a[68:71], v[132:135]
  v_cvt_pk_bf16_f32 v73, v74, v75
  v_mfma_f32_16x16x32_bf16 v[136:139], a[148:151], a[84:87], v[24:27]
  v_exp_f32 v88, v88
  v_mfma_f32_16x16x32_bf16 v[136:139], a[152:155], a[88:91], v[136:139]
  v_mfma_f32_16x16x32_bf16 v[136:139], a[156:159], a[92:95], v[136:139]
  v_exp_f32 v89, v89
  v_mfma_f32_16x16x32_bf16 v[136:139], a[160:163], a[96:99], v[136:139]
  v_cvt_pk_bf16_f32 v74, v88, v89
  v_mfma_f32_16x16x32_bf16 v[140:143], a[160:163], a[112:115], v[28:31]
  v_exp_f32 v90, v90
  v_mfma_f32_16x16x32_bf16 v[140:143], a[156:159], a[108:111], v[140:143]
  s_waitcnt vmcnt(16) lgkmcnt(0)
  s_barrier
  ds_read_b128 a[116:119], v2 offset:32768
  ds_read_b128 a[120:123], v2 offset:40960
  ds_read_b128 a[124:127], v2 offset:33792
  ds_read_b128 a[128:131], v2 offset:41984
  v_mfma_f32_16x16x32_bf16 v[140:143], a[152:155], a[104:107], v[140:143]
  v_exp_f32 v91, v91
  v_mfma_f32_16x16x32_bf16 v[140:143], a[148:151], a[100:103], v[140:143]
  v_cvt_pk_bf16_f32 v75, v90, v91
  v_mfma_f32_16x16x32_bf16 v[144:147], a[164:167], a[52:55], v[20:23]
  v_exp_f32 v76, v76
  v_mfma_f32_16x16x32_bf16 v[144:147], a[168:171], a[56:59], v[144:147]
  ds_read_b128 a[132:135], v2 offset:34816
  ds_read_b128 a[136:139], v2 offset:43008
  v_mfma_f32_16x16x32_bf16 v[144:147], a[172:175], a[60:63], v[144:147]
  v_exp_f32 v77, v77
  v_mfma_f32_16x16x32_bf16 v[144:147], a[176:179], a[64:67], v[144:147]
  v_cvt_pk_bf16_f32 v76, v76, v77
  v_mfma_f32_16x16x32_bf16 v[148:151], a[176:179], a[80:83], v[20:23]
  v_exp_f32 v78, v78
  v_mfma_f32_16x16x32_bf16 v[148:151], a[172:175], a[76:79], v[148:151]
  v_mfma_f32_16x16x32_bf16 v[148:151], a[168:171], a[72:75], v[148:151]
  v_exp_f32 v79, v79
  v_mfma_f32_16x16x32_bf16 v[148:151], a[164:167], a[68:71], v[148:151]
  v_cvt_pk_bf16_f32 v77, v78, v79
  v_mfma_f32_16x16x32_bf16 v[152:155], a[164:167], a[84:87], v[20:23]
  v_exp_f32 v92, v92
  v_mfma_f32_16x16x32_bf16 v[152:155], a[168:171], a[88:91], v[152:155]
  ds_read_b128 a[140:143], v2 offset:35840
  ds_read_b128 a[144:147], v2 offset:44032
  v_mfma_f32_16x16x32_bf16 v[152:155], a[172:175], a[92:95], v[152:155]
  v_exp_f32 v93, v93
  v_mfma_f32_16x16x32_bf16 v[152:155], a[176:179], a[96:99], v[152:155]
  v_cvt_pk_bf16_f32 v78, v92, v93
  v_mfma_f32_16x16x32_bf16 v[156:159], a[176:179], a[112:115], v[24:27]
  v_exp_f32 v94, v94
  v_mfma_f32_16x16x32_bf16 v[156:159], a[172:175], a[108:111], v[156:159]
  v_mfma_f32_16x16x32_bf16 v[156:159], a[168:171], a[104:107], v[156:159]
  v_exp_f32 v95, v95
  v_mfma_f32_16x16x32_bf16 v[156:159], a[164:167], a[100:103], v[156:159]
  v_cvt_pk_bf16_f32 v79, v94, v95
  s_waitcnt lgkmcnt(6)
  s_add_u32 m0, s29, 0
  v_mfma_f32_16x16x32_bf16 v[160:163], a[116:119], v[32:35], v[160:163]
  v_exp_f32 v96, v96
  v_mfma_f32_16x16x32_bf16 v[160:163], a[120:123], v[64:67], v[160:163]
  ds_read_b128 a[148:151], v2 offset:36864
  ds_read_b128 a[152:155], v2 offset:45056
  v_mfma_f32_16x16x32_bf16 v[164:167], a[120:123], v[68:71], v[164:167]
  v_exp_f32 v97, v97
  v_mfma_f32_16x16x32_bf16 v[164:167], a[116:119], v[36:39], v[164:167]
  buffer_load_dwordx4 v1, s[12:15], s25 offen offset:0 lds
  s_add_u32 s32, s25, 4096
  v_mfma_f32_16x16x32_bf16 v[168:171], a[116:119], v[40:43], v[168:171]
  v_exp_f32 v98, v98
  v_mfma_f32_16x16x32_bf16 v[168:171], a[120:123], v[72:75], v[168:171]
  v_cvt_pk_bf16_f32 v96, v96, v97
  v_mfma_f32_16x16x32_bf16 v[172:175], a[120:123], v[76:79], v[172:175]
  v_exp_f32 v99, v99
  v_mfma_f32_16x16x32_bf16 v[172:175], a[116:119], v[44:47], v[172:175]
  buffer_load_dwordx4 v1, s[12:15], s25 offen offset:1024 lds
  s_waitcnt lgkmcnt(6)
  v_mfma_f32_16x16x32_bf16 a[32:35], a[48:51], v[32:35], a[32:35]
  v_mfma_f32_16x16x32_bf16 a[32:35], a[48:51], v[64:67], a[32:35]
  v_mfma_f32_16x16x32_bf16 v[176:179], a[124:127], v[32:35], v[176:179]
  v_exp_f32 v112, v112
  v_mfma_f32_16x16x32_bf16 v[176:179], a[128:131], v[64:67], v[176:179]
  ds_read_b128 a[156:159], v2 offset:37888
  ds_read_b128 a[160:163], v2 offset:46080
  v_mfma_f32_16x16x32_bf16 v[180:183], a[128:131], v[68:71], v[180:183]
  v_exp_f32 v113, v113
  v_mfma_f32_16x16x32_bf16 v[180:183], a[124:127], v[36:39], v[180:183]
  buffer_load_dwordx4 v1, s[12:15], s25 offen offset:2048 lds
  v_mfma_f32_16x16x32_bf16 v[184:187], a[124:127], v[40:43], v[184:187]
  v_exp_f32 v114, v114
  v_mfma_f32_16x16x32_bf16 v[184:187], a[128:131], v[72:75], v[184:187]
  v_cvt_pk_bf16_f32 v97, v98, v99
  v_cvt_pk_bf16_f32 v98, v112, v113
  v_mfma_f32_16x16x32_bf16 v[188:191], a[128:131], v[76:79], v[188:191]
  v_exp_f32 v115, v115
  v_mfma_f32_16x16x32_bf16 v[188:191], a[124:127], v[44:47], v[188:191]
  buffer_load_dwordx4 v1, s[12:15], s25 offen offset:3072 lds
  s_add_u32 m0, s29, 4096
  s_waitcnt lgkmcnt(6)
  v_mfma_f32_16x16x32_bf16 a[36:39], a[48:51], v[36:39], a[36:39]
  v_mfma_f32_16x16x32_bf16 a[36:39], a[48:51], v[68:71], a[36:39]
  v_mfma_f32_16x16x32_bf16 v[192:195], a[132:135], v[32:35], v[192:195]
  v_exp_f32 v100, v100
  v_mfma_f32_16x16x32_bf16 v[192:195], a[136:139], v[64:67], v[192:195]
  ds_read_b128 a[164:167], v2 offset:38912
  ds_read_b128 a[168:171], v2 offset:47104
  v_mfma_f32_16x16x32_bf16 v[196:199], a[136:139], v[68:71], v[196:199]
  v_exp_f32 v101, v101
  v_mfma_f32_16x16x32_bf16 v[196:199], a[132:135], v[36:39], v[196:199]
  buffer_load_dwordx4 v1, s[12:15], s32 offen offset:0 lds
  v_mfma_f32_16x16x32_bf16 v[200:203], a[132:135], v[40:43], v[200:203]
  v_exp_f32 v102, v102
  v_mfma_f32_16x16x32_bf16 v[200:203], a[136:139], v[72:75], v[200:203]
  v_cvt_pk_bf16_f32 v99, v114, v115
  v_cvt_pk_bf16_f32 v100, v100, v101
  v_mfma_f32_16x16x32_bf16 v[204:207], a[136:139], v[76:79], v[204:207]
  v_exp_f32 v103, v103
  v_mfma_f32_16x16x32_bf16 v[204:207], a[132:135], v[44:47], v[204:207]
  buffer_load_dwordx4 v1, s[12:15], s32 offen offset:1024 lds
  s_waitcnt lgkmcnt(6)
  v_mfma_f32_16x16x32_bf16 a[40:43], a[48:51], v[40:43], a[40:43]
  v_mfma_f32_16x16x32_bf16 a[40:43], a[48:51], v[72:75], a[40:43]
  v_mfma_f32_16x16x32_bf16 v[208:211], a[140:143], v[32:35], v[208:211]
  v_exp_f32 v116, v116
  v_mfma_f32_16x16x32_bf16 v[208:211], a[144:147], v[64:67], v[208:211]
  ds_read_b128 a[172:175], v2 offset:39936
  ds_read_b128 a[176:179], v2 offset:48128
  v_mfma_f32_16x16x32_bf16 v[212:215], a[144:147], v[68:71], v[212:215]
  v_exp_f32 v117, v117
  v_mfma_f32_16x16x32_bf16 v[212:215], a[140:143], v[36:39], v[212:215]
  buffer_load_dwordx4 v1, s[12:15], s32 offen offset:2048 lds
  v_mfma_f32_16x16x32_bf16 v[216:219], a[140:143], v[40:43], v[216:219]
  v_exp_f32 v118, v118
  v_mfma_f32_16x16x32_bf16 v[216:219], a[144:147], v[72:75], v[216:219]
  v_cvt_pk_bf16_f32 v101, v102, v103
  v_cvt_pk_bf16_f32 v102, v116, v117
  v_mfma_f32_16x16x32_bf16 v[220:223], a[144:147], v[76:79], v[220:223]
  v_exp_f32 v119, v119
  v_mfma_f32_16x16x32_bf16 v[220:223], a[140:143], v[44:47], v[220:223]
  buffer_load_dwordx4 v1, s[12:15], s32 offen offset:3072 lds
  s_waitcnt lgkmcnt(6)
  v_mfma_f32_16x16x32_bf16 a[44:47], a[48:51], v[44:47], a[44:47]
  v_mfma_f32_16x16x32_bf16 a[44:47], a[48:51], v[76:79], a[44:47]
  v_mfma_f32_16x16x32_bf16 v[224:227], a[148:151], v[32:35], v[224:227]
  v_exp_f32 v104, v104
  v_mfma_f32_16x16x32_bf16 v[224:227], a[152:155], v[64:67], v[224:227]
  s_add_u32 s25, s25, 32768
  s_cmp_eq_u32 s25, s27
  s_cselect_b32 s25, s28, s25
  s_cselect_b32 s27, -1, s27
  v_mfma_f32_16x16x32_bf16 v[228:231], a[152:155], v[68:71], v[228:231]
  v_exp_f32 v105, v105
  v_mfma_f32_16x16x32_bf16 v[228:231], a[148:151], v[36:39], v[228:231]
  v_cvt_pk_bf16_f32 v103, v118, v119
  v_cvt_pk_bf16_f32 v104, v104, v105
  v_mfma_f32_16x16x32_bf16 v[232:235], a[148:151], v[40:43], v[232:235]
  v_exp_f32 v106, v106
  v_mfma_f32_16x16x32_bf16 v[232:235], a[152:155], v[72:75], v[232:235]
  v_mfma_f32_16x16x32_bf16 v[236:239], a[152:155], v[76:79], v[236:239]
  v_exp_f32 v107, v107
  v_mfma_f32_16x16x32_bf16 v[236:239], a[148:151], v[44:47], v[236:239]
  v_cvt_pk_bf16_f32 v105, v106, v107
  s_waitcnt lgkmcnt(4)
  v_mfma_f32_16x16x32_bf16 v[240:243], a[156:159], v[32:35], v[240:243]
  v_exp_f32 v120, v120
  v_mfma_f32_16x16x32_bf16 v[240:243], a[160:163], v[64:67], v[240:243]
  v_mfma_f32_16x16x32_bf16 v[244:247], a[160:163], v[68:71], v[244:247]
  v_exp_f32 v121, v121
  v_mfma_f32_16x16x32_bf16 v[244:247], a[156:159], v[36:39], v[244:247]
  v_cvt_pk_bf16_f32 v106, v120, v121
  v_mfma_f32_16x16x32_bf16 v[248:251], a[156:159], v[40:43], v[248:251]
  v_exp_f32 v122, v122
  v_mfma_f32_16x16x32_bf16 v[248:251], a[160:163], v[72:75], v[248:251]
  s_waitcnt vmcnt(16) lgkmcnt(0)
  s_barrier
  ds_read_b128 a[116:119], v3 offset:0
  ds_read_b128 a[120:123], v3 offset:1024
  ds_read_b128 a[124:127], v3 offset:2048
  ds_read_b128 a[128:131], v3 offset:3072
  v_mfma_f32_16x16x32_bf16 v[252:255], a[160:163], v[76:79], v[252:255]
  v_exp_f32 v123, v123
  v_mfma_f32_16x16x32_bf16 v[252:255], a[156:159], v[44:47], v[252:255]
  v_cvt_pk_bf16_f32 v107, v122, v123
  v_mfma_f32_16x16x32_bf16 a[0:3], a[164:167], v[32:35], a[0:3]
  v_exp_f32 v108, v108
  v_mfma_f32_16x16x32_bf16 a[0:3], a[168:171], v[64:67], a[0:3]
  ds_read_b128 a[132:135], v3 offset:4096
  ds_read_b128 a[136:139], v3 offset:5120
  v_mfma_f32_16x16x32_bf16 a[4:7], a[168:171], v[68:71], a[4:7]
  v_exp_f32 v109, v109
  v_mfma_f32_16x16x32_bf16 a[4:7], a[164:167], v[36:39], a[4:7]
  v_cvt_pk_bf16_f32 v108, v108, v109
  v_mfma_f32_16x16x32_bf16 a[8:11], a[164:167], v[40:43], a[8:11]
  v_exp_f32 v110, v110
  v_mfma_f32_16x16x32_bf16 a[8:11], a[168:171], v[72:75], a[8:11]
  v_mfma_f32_16x16x32_bf16 a[12:15], a[168:171], v[76:79], a[12:15]
  v_exp_f32 v111, v111
  v_mfma_f32_16x16x32_bf16 a[12:15], a[164:167], v[44:47], a[12:15]
  v_cvt_pk_bf16_f32 v109, v110, v111
  v_mfma_f32_16x16x32_bf16 a[16:19], a[172:175], v[32:35], a[16:19]
  v_exp_f32 v124, v124
  v_mfma_f32_16x16x32_bf16 a[16:19], a[176:179], v[64:67], a[16:19]
  ds_read_b128 a[140:143], v3 offset:6144
  ds_read_b128 a[144:147], v3 offset:7168
  v_mfma_f32_16x16x32_bf16 a[20:23], a[176:179], v[68:71], a[20:23]
  v_exp_f32 v125, v125
  v_mfma_f32_16x16x32_bf16 a[20:23], a[172:175], v[36:39], a[20:23]
  v_cvt_pk_bf16_f32 v110, v124, v125
  v_mfma_f32_16x16x32_bf16 a[24:27], a[172:175], v[40:43], a[24:27]
  v_exp_f32 v126, v126
  v_mfma_f32_16x16x32_bf16 a[24:27], a[176:179], v[72:75], a[24:27]
  v_mfma_f32_16x16x32_bf16 a[28:31], a[176:179], v[76:79], a[28:31]
  v_exp_f32 v127, v127
  v_mfma_f32_16x16x32_bf16 a[28:31], a[172:175], v[44:47], a[28:31]
  v_cvt_pk_bf16_f32 v111, v126, v127
  s_lshl_b32 s33, s23, 6
  s_add_i32 s33, s33, -64
  s_cmp_gt_i32 s33, 0
  s_cselect_b32 s34, 0, 0xf149f2ca
  s_cmp_lt_i32 s33, 0
  s_cselect_b32 s33, 0xf149f2ca, 0
  v_mov_b32 v20, s34
  v_mov_b32 v21, s34
  v_mov_b32 v22, s34
  v_mov_b32 v23, s34
  v_mov_b32 v28, s33
  v_mov_b32 v29, s33
  v_mov_b32 v30, s33
  v_mov_b32 v31, s33
  v_med3_f32 v24, v16, v20, v28
  v_med3_f32 v25, v17, v20, v28
  v_med3_f32 v26, v18, v20, v28
  v_med3_f32 v27, v19, v20, v28
  s_waitcnt lgkmcnt(4)
  s_add_u32 m0, s29, 32768
  v_mfma_f32_16x16x32_bf16 v[32:35], a[116:119], a[52:55], v[24:27]
  v_exp_f32 v128, v128
  v_mfma_f32_16x16x32_bf16 v[32:35], a[120:123], a[56:59], v[32:35]
  ds_read_b128 a[148:151], v3 offset:8192
  ds_read_b128 a[152:155], v3 offset:9216
  v_mfma_f32_16x16x32_bf16 v[32:35], a[124:127], a[60:63], v[32:35]
  v_exp_f32 v129, v129
  v_mfma_f32_16x16x32_bf16 v[32:35], a[128:131], a[64:67], v[32:35]
  buffer_load_dwordx4 v1, s[12:15], s26 offen offset:0 lds
  s_add_u32 s32, s26, 4096
  v_mfma_f32_16x16x32_bf16 v[36:39], a[128:131], a[80:83], v[28:31]
  v_exp_f32 v130, v130
  v_mfma_f32_16x16x32_bf16 v[36:39], a[124:127], a[76:79], v[36:39]
  v_cvt_pk_bf16_f32 v128, v128, v129
  v_mfma_f32_16x16x32_bf16 v[36:39], a[120:123], a[72:75], v[36:39]
  v_exp_f32 v131, v131
  v_mfma_f32_16x16x32_bf16 v[36:39], a[116:119], a[68:71], v[36:39]
  buffer_load_dwordx4 v1, s[12:15], s26 offen offset:1024 lds
  v_mfma_f32_16x16x32_bf16 v[40:43], a[116:119], a[84:87], v[28:31]
  v_exp_f32 v144, v144
  v_mfma_f32_16x16x32_bf16 v[40:43], a[120:123], a[88:91], v[40:43]
  ds_read_b128 a[156:159], v3 offset:10240
  ds_read_b128 a[160:163], v3 offset:11264
  v_mfma_f32_16x16x32_bf16 v[40:43], a[124:127], a[92:95], v[40:43]
  v_exp_f32 v145, v145
  v_mfma_f32_16x16x32_bf16 v[40:43], a[128:131], a[96:99], v[40:43]
  buffer_load_dwordx4 v1, s[12:15], s26 offen offset:2048 lds
  v_mfma_f32_16x16x32_bf16 v[44:47], a[128:131], a[112:115], v[28:31]
  v_exp_f32 v146, v146
  v_mfma_f32_16x16x32_bf16 v[44:47], a[124:127], a[108:111], v[44:47]
  v_cvt_pk_bf16_f32 v129, v130, v131
  v_cvt_pk_bf16_f32 v130, v144, v145
  v_mfma_f32_16x16x32_bf16 v[44:47], a[120:123], a[104:107], v[44:47]
  v_exp_f32 v147, v147
  v_mfma_f32_16x16x32_bf16 v[44:47], a[116:119], a[100:103], v[44:47]
  buffer_load_dwordx4 v1, s[12:15], s26 offen offset:3072 lds
  s_add_u32 m0, s29, 36864
  s_waitcnt lgkmcnt(4)
  v_mfma_f32_16x16x32_bf16 v[48:51], a[132:135], a[52:55], v[20:23]
  v_exp_f32 v132, v132
  v_mfma_f32_16x16x32_bf16 v[48:51], a[136:139], a[56:59], v[48:51]
  ds_read_b128 a[164:167], v3 offset:12288
  ds_read_b128 a[168:171], v3 offset:13312
  v_mfma_f32_16x16x32_bf16 v[48:51], a[140:143], a[60:63], v[48:51]
  v_exp_f32 v133, v133
  v_mfma_f32_16x16x32_bf16 v[48:51], a[144:147], a[64:67], v[48:51]
  buffer_load_dwordx4 v1, s[12:15], s32 offen offset:0 lds
  v_mfma_f32_16x16x32_bf16 v[52:55], a[144:147], a[80:83], v[24:27]
  v_exp_f32 v134, v134
  v_mfma_f32_16x16x32_bf16 v[52:55], a[140:143], a[76:79], v[52:55]
  v_cvt_pk_bf16_f32 v131, v146, v147
  v_cvt_pk_bf16_f32 v132, v132, v133
  v_mfma_f32_16x16x32_bf16 v[52:55], a[136:139], a[72:75], v[52:55]
  v_exp_f32 v135, v135
  v_mfma_f32_16x16x32_bf16 v[52:55], a[132:135], a[68:71], v[52:55]
  buffer_load_dwordx4 v1, s[12:15], s32 offen offset:1024 lds
  v_mfma_f32_16x16x32_bf16 v[56:59], a[132:135], a[84:87], v[28:31]
  v_exp_f32 v148, v148
  v_mfma_f32_16x16x32_bf16 v[56:59], a[136:139], a[88:91], v[56:59]
  ds_read_b128 a[172:175], v3 offset:14336
  ds_read_b128 a[176:179], v3 offset:15360
  v_mfma_f32_16x16x32_bf16 v[56:59], a[140:143], a[92:95], v[56:59]
  v_exp_f32 v149, v149
  v_mfma_f32_16x16x32_bf16 v[56:59], a[144:147], a[96:99], v[56:59]
  buffer_load_dwordx4 v1, s[12:15], s32 offen offset:2048 lds
  v_mfma_f32_16x16x32_bf16 v[60:63], a[144:147], a[112:115], v[28:31]
  v_exp_f32 v150, v150
  v_mfma_f32_16x16x32_bf16 v[60:63], a[140:143], a[108:111], v[60:63]
  v_cvt_pk_bf16_f32 v133, v134, v135
  v_cvt_pk_bf16_f32 v134, v148, v149
  v_mfma_f32_16x16x32_bf16 v[60:63], a[136:139], a[104:107], v[60:63]
  v_exp_f32 v151, v151
  v_mfma_f32_16x16x32_bf16 v[60:63], a[132:135], a[100:103], v[60:63]
  buffer_load_dwordx4 v1, s[12:15], s32 offen offset:3072 lds
  s_waitcnt lgkmcnt(4)
  v_mfma_f32_16x16x32_bf16 v[64:67], a[148:151], a[52:55], v[20:23]
  v_exp_f32 v136, v136
  v_mfma_f32_16x16x32_bf16 v[64:67], a[152:155], a[56:59], v[64:67]
  s_add_u32 s26, s26, 32768
  s_cmp_eq_u32 s26, s62
  s_cselect_b32 s26, s63, s26
  s_cselect_b32 s62, -1, s62
  v_mfma_f32_16x16x32_bf16 v[64:67], a[156:159], a[60:63], v[64:67]
  v_exp_f32 v137, v137
  v_mfma_f32_16x16x32_bf16 v[64:67], a[160:163], a[64:67], v[64:67]
  v_cvt_pk_bf16_f32 v135, v150, v151
  v_cvt_pk_bf16_f32 v136, v136, v137
  v_mfma_f32_16x16x32_bf16 v[68:71], a[160:163], a[80:83], v[20:23]
  v_exp_f32 v138, v138
  v_mfma_f32_16x16x32_bf16 v[68:71], a[156:159], a[76:79], v[68:71]
  v_mfma_f32_16x16x32_bf16 v[68:71], a[152:155], a[72:75], v[68:71]
  v_exp_f32 v139, v139
  v_mfma_f32_16x16x32_bf16 v[68:71], a[148:151], a[68:71], v[68:71]
  v_cvt_pk_bf16_f32 v137, v138, v139
  v_mfma_f32_16x16x32_bf16 v[72:75], a[148:151], a[84:87], v[24:27]
  v_exp_f32 v152, v152
  v_mfma_f32_16x16x32_bf16 v[72:75], a[152:155], a[88:91], v[72:75]
  v_mfma_f32_16x16x32_bf16 v[72:75], a[156:159], a[92:95], v[72:75]
  v_exp_f32 v153, v153
  v_mfma_f32_16x16x32_bf16 v[72:75], a[160:163], a[96:99], v[72:75]
  v_cvt_pk_bf16_f32 v138, v152, v153
  v_mfma_f32_16x16x32_bf16 v[76:79], a[160:163], a[112:115], v[28:31]
  v_exp_f32 v154, v154
  v_mfma_f32_16x16x32_bf16 v[76:79], a[156:159], a[108:111], v[76:79]
  s_waitcnt vmcnt(16) lgkmcnt(0)
  s_barrier
  ds_read_b128 a[116:119], v3 offset:32768
  ds_read_b128 a[120:123], v3 offset:40960
  ds_read_b128 a[124:127], v3 offset:33792
  ds_read_b128 a[128:131], v3 offset:41984
  v_mfma_f32_16x16x32_bf16 v[76:79], a[152:155], a[104:107], v[76:79]
  v_exp_f32 v155, v155
  v_mfma_f32_16x16x32_bf16 v[76:79], a[148:151], a[100:103], v[76:79]
  v_cvt_pk_bf16_f32 v139, v154, v155
  v_mfma_f32_16x16x32_bf16 v[80:83], a[164:167], a[52:55], v[20:23]
  v_exp_f32 v140, v140
  v_mfma_f32_16x16x32_bf16 v[80:83], a[168:171], a[56:59], v[80:83]
  ds_read_b128 a[132:135], v3 offset:34816
  ds_read_b128 a[136:139], v3 offset:43008
  v_mfma_f32_16x16x32_bf16 v[80:83], a[172:175], a[60:63], v[80:83]
  v_exp_f32 v141, v141
  v_mfma_f32_16x16x32_bf16 v[80:83], a[176:179], a[64:67], v[80:83]
  v_cvt_pk_bf16_f32 v140, v140, v141
  v_mfma_f32_16x16x32_bf16 v[84:87], a[176:179], a[80:83], v[20:23]
  v_exp_f32 v142, v142
  v_mfma_f32_16x16x32_bf16 v[84:87], a[172:175], a[76:79], v[84:87]
  v_mfma_f32_16x16x32_bf16 v[84:87], a[168:171], a[72:75], v[84:87]
  v_exp_f32 v143, v143
  v_mfma_f32_16x16x32_bf16 v[84:87], a[164:167], a[68:71], v[84:87]
  v_cvt_pk_bf16_f32 v141, v142, v143
  v_mfma_f32_16x16x32_bf16 v[88:91], a[164:167], a[84:87], v[20:23]
  v_exp_f32 v156, v156
  v_mfma_f32_16x16x32_bf16 v[88:91], a[168:171], a[88:91], v[88:91]
  ds_read_b128 a[140:143], v3 offset:35840
  ds_read_b128 a[144:147], v3 offset:44032
  v_mfma_f32_16x16x32_bf16 v[88:91], a[172:175], a[92:95], v[88:91]
  v_exp_f32 v157, v157
  v_mfma_f32_16x16x32_bf16 v[88:91], a[176:179], a[96:99], v[88:91]
  v_cvt_pk_bf16_f32 v142, v156, v157
  v_mfma_f32_16x16x32_bf16 v[92:95], a[176:179], a[112:115], v[24:27]
  v_exp_f32 v158, v158
  v_mfma_f32_16x16x32_bf16 v[92:95], a[172:175], a[108:111], v[92:95]
  v_mfma_f32_16x16x32_bf16 v[92:95], a[168:171], a[104:107], v[92:95]
  v_exp_f32 v159, v159
  v_mfma_f32_16x16x32_bf16 v[92:95], a[164:167], a[100:103], v[92:95]
  v_cvt_pk_bf16_f32 v143, v158, v159
  s_waitcnt lgkmcnt(6)
  s_add_u32 m0, s29, 65536
  v_mfma_f32_16x16x32_bf16 v[160:163], a[116:119], v[96:99], v[160:163]
  v_exp_f32 v32, v32
  v_mfma_f32_16x16x32_bf16 v[160:163], a[120:123], v[128:131], v[160:163]
  ds_read_b128 a[148:151], v3 offset:36864
  ds_read_b128 a[152:155], v3 offset:45056
  v_mfma_f32_16x16x32_bf16 v[164:167], a[120:123], v[132:135], v[164:167]
  v_exp_f32 v33, v33
  v_mfma_f32_16x16x32_bf16 v[164:167], a[116:119], v[100:103], v[164:167]
  buffer_load_dwordx4 v1, s[12:15], s25 offen offset:0 lds
  s_add_u32 s32, s25, 4096
  v_mfma_f32_16x16x32_bf16 v[168:171], a[116:119], v[104:107], v[168:171]
  v_exp_f32 v34, v34
  v_mfma_f32_16x16x32_bf16 v[168:171], a[120:123], v[136:139], v[168:171]
  v_cvt_pk_bf16_f32 v32, v32, v33
  v_mfma_f32_16x16x32_bf16 v[172:175], a[120:123], v[140:143], v[172:175]
  v_exp_f32 v35, v35
  v_mfma_f32_16x16x32_bf16 v[172:175], a[116:119], v[108:111], v[172:175]
  buffer_load_dwordx4 v1, s[12:15], s25 offen offset:1024 lds
  s_waitcnt lgkmcnt(6)
  v_mfma_f32_16x16x32_bf16 a[32:35], a[48:51], v[96:99], a[32:35]
  v_mfma_f32_16x16x32_bf16 a[32:35], a[48:51], v[128:131], a[32:35]
  v_mfma_f32_16x16x32_bf16 v[176:179], a[124:127], v[96:99], v[176:179]
  v_exp_f32 v48, v48
  v_mfma_f32_16x16x32_bf16 v[176:179], a[128:131], v[128:131], v[176:179]
  ds_read_b128 a[156:159], v3 offset:37888
  ds_read_b128 a[160:163], v3 offset:46080
  v_mfma_f32_16x16x32_bf16 v[180:183], a[128:131], v[132:135], v[180:183]
  v_exp_f32 v49, v49
  v_mfma_f32_16x16x32_bf16 v[180:183], a[124:127], v[100:103], v[180:183]
  buffer_load_dwordx4 v1, s[12:15], s25 offen offset:2048 lds
  v_mfma_f32_16x16x32_bf16 v[184:187], a[124:127], v[104:107], v[184:187]
  v_exp_f32 v50, v50
  v_mfma_f32_16x16x32_bf16 v[184:187], a[128:131], v[136:139], v[184:187]
  v_cvt_pk_bf16_f32 v33, v34, v35
  v_cvt_pk_bf16_f32 v34, v48, v49
  v_mfma_f32_16x16x32_bf16 v[188:191], a[128:131], v[140:143], v[188:191]
  v_exp_f32 v51, v51
  v_mfma_f32_16x16x32_bf16 v[188:191], a[124:127], v[108:111], v[188:191]
  buffer_load_dwordx4 v1, s[12:15], s25 offen offset:3072 lds
  s_add_u32 m0, s29, 69632
  s_waitcnt lgkmcnt(6)
  v_mfma_f32_16x16x32_bf16 a[36:39], a[48:51], v[100:103], a[36:39]
  v_mfma_f32_16x16x32_bf16 a[36:39], a[48:51], v[132:135], a[36:39]
  v_mfma_f32_16x16x32_bf16 v[192:195], a[132:135], v[96:99], v[192:195]
  v_exp_f32 v36, v36
  v_mfma_f32_16x16x32_bf16 v[192:195], a[136:139], v[128:131], v[192:195]
  ds_read_b128 a[164:167], v3 offset:38912
  ds_read_b128 a[168:171], v3 offset:47104
  v_mfma_f32_16x16x32_bf16 v[196:199], a[136:139], v[132:135], v[196:199]
  v_exp_f32 v37, v37
  v_mfma_f32_16x16x32_bf16 v[196:199], a[132:135], v[100:103], v[196:199]
  buffer_load_dwordx4 v1, s[12:15], s32 offen offset:0 lds
  v_mfma_f32_16x16x32_bf16 v[200:203], a[132:135], v[104:107], v[200:203]
  v_exp_f32 v38, v38
  v_mfma_f32_16x16x32_bf16 v[200:203], a[136:139], v[136:139], v[200:203]
  v_cvt_pk_bf16_f32 v35, v50, v51
  v_cvt_pk_bf16_f32 v36, v36, v37
  v_mfma_f32_16x16x32_bf16 v[204:207], a[136:139], v[140:143], v[204:207]
  v_exp_f32 v39, v39
  v_mfma_f32_16x16x32_bf16 v[204:207], a[132:135], v[108:111], v[204:207]
  buffer_load_dwordx4 v1, s[12:15], s32 offen offset:1024 lds
  s_waitcnt lgkmcnt(6)
  v_mfma_f32_16x16x32_bf16 a[40:43], a[48:51], v[104:107], a[40:43]
  v_mfma_f32_16x16x32_bf16 a[40:43], a[48:51], v[136:139], a[40:43]
  v_mfma_f32_16x16x32_bf16 v[208:211], a[140:143], v[96:99], v[208:211]
  v_exp_f32 v52, v52
  v_mfma_f32_16x16x32_bf16 v[208:211], a[144:147], v[128:131], v[208:211]
  ds_read_b128 a[172:175], v3 offset:39936
  ds_read_b128 a[176:179], v3 offset:48128
  v_mfma_f32_16x16x32_bf16 v[212:215], a[144:147], v[132:135], v[212:215]
  v_exp_f32 v53, v53
  v_mfma_f32_16x16x32_bf16 v[212:215], a[140:143], v[100:103], v[212:215]
  buffer_load_dwordx4 v1, s[12:15], s32 offen offset:2048 lds
  v_mfma_f32_16x16x32_bf16 v[216:219], a[140:143], v[104:107], v[216:219]
  v_exp_f32 v54, v54
  v_mfma_f32_16x16x32_bf16 v[216:219], a[144:147], v[136:139], v[216:219]
  v_cvt_pk_bf16_f32 v37, v38, v39
  v_cvt_pk_bf16_f32 v38, v52, v53
  v_mfma_f32_16x16x32_bf16 v[220:223], a[144:147], v[140:143], v[220:223]
  v_exp_f32 v55, v55
  v_mfma_f32_16x16x32_bf16 v[220:223], a[140:143], v[108:111], v[220:223]
  buffer_load_dwordx4 v1, s[12:15], s32 offen offset:3072 lds
  s_waitcnt lgkmcnt(6)
  v_mfma_f32_16x16x32_bf16 a[44:47], a[48:51], v[108:111], a[44:47]
  v_mfma_f32_16x16x32_bf16 a[44:47], a[48:51], v[140:143], a[44:47]
  v_mfma_f32_16x16x32_bf16 v[224:227], a[148:151], v[96:99], v[224:227]
  v_exp_f32 v40, v40
  v_mfma_f32_16x16x32_bf16 v[224:227], a[152:155], v[128:131], v[224:227]
  s_add_u32 s25, s25, 32768
  s_cmp_eq_u32 s25, s27
  s_cselect_b32 s25, s28, s25
  s_cselect_b32 s27, -1, s27
  v_mfma_f32_16x16x32_bf16 v[228:231], a[152:155], v[132:135], v[228:231]
  v_exp_f32 v41, v41
  v_mfma_f32_16x16x32_bf16 v[228:231], a[148:151], v[100:103], v[228:231]
  v_cvt_pk_bf16_f32 v39, v54, v55
  v_cvt_pk_bf16_f32 v40, v40, v41
  v_mfma_f32_16x16x32_bf16 v[232:235], a[148:151], v[104:107], v[232:235]
  v_exp_f32 v42, v42
  v_mfma_f32_16x16x32_bf16 v[232:235], a[152:155], v[136:139], v[232:235]
  v_mfma_f32_16x16x32_bf16 v[236:239], a[152:155], v[140:143], v[236:239]
  v_exp_f32 v43, v43
  v_mfma_f32_16x16x32_bf16 v[236:239], a[148:151], v[108:111], v[236:239]
  v_cvt_pk_bf16_f32 v41, v42, v43
  s_waitcnt lgkmcnt(4)
  v_mfma_f32_16x16x32_bf16 v[240:243], a[156:159], v[96:99], v[240:243]
  v_exp_f32 v56, v56
  v_mfma_f32_16x16x32_bf16 v[240:243], a[160:163], v[128:131], v[240:243]
  v_mfma_f32_16x16x32_bf16 v[244:247], a[160:163], v[132:135], v[244:247]
  v_exp_f32 v57, v57
  v_mfma_f32_16x16x32_bf16 v[244:247], a[156:159], v[100:103], v[244:247]
  v_cvt_pk_bf16_f32 v42, v56, v57
  v_mfma_f32_16x16x32_bf16 v[248:251], a[156:159], v[104:107], v[248:251]
  v_exp_f32 v58, v58
  v_mfma_f32_16x16x32_bf16 v[248:251], a[160:163], v[136:139], v[248:251]
  s_waitcnt vmcnt(16) lgkmcnt(0)
  s_barrier
  ds_read_b128 a[116:119], v2 offset:0
  ds_read_b128 a[120:123], v2 offset:1024
  ds_read_b128 a[124:127], v2 offset:2048
  ds_read_b128 a[128:131], v2 offset:3072
  v_mfma_f32_16x16x32_bf16 v[252:255], a[160:163], v[140:143], v[252:255]
  v_exp_f32 v59, v59
  v_mfma_f32_16x16x32_bf16 v[252:255], a[156:159], v[108:111], v[252:255]
  v_cvt_pk_bf16_f32 v43, v58, v59
  v_mfma_f32_16x16x32_bf16 a[0:3], a[164:167], v[96:99], a[0:3]
  v_exp_f32 v44, v44
  v_mfma_f32_16x16x32_bf16 a[0:3], a[168:171], v[128:131], a[0:3]
  ds_read_b128 a[132:135], v2 offset:4096
  ds_read_b128 a[136:139], v2 offset:5120
  v_mfma_f32_16x16x32_bf16 a[4:7], a[168:171], v[132:135], a[4:7]
  v_exp_f32 v45, v45
  v_mfma_f32_16x16x32_bf16 a[4:7], a[164:167], v[100:103], a[4:7]
  v_cvt_pk_bf16_f32 v44, v44, v45
  v_mfma_f32_16x16x32_bf16 a[8:11], a[164:167], v[104:107], a[8:11]
  v_exp_f32 v46, v46
  v_mfma_f32_16x16x32_bf16 a[8:11], a[168:171], v[136:139], a[8:11]
  v_mfma_f32_16x16x32_bf16 a[12:15], a[168:171], v[140:143], a[12:15]
  v_exp_f32 v47, v47
  v_mfma_f32_16x16x32_bf16 a[12:15], a[164:167], v[108:111], a[12:15]
  v_cvt_pk_bf16_f32 v45, v46, v47
  v_mfma_f32_16x16x32_bf16 a[16:19], a[172:175], v[96:99], a[16:19]
  v_exp_f32 v60, v60
  v_mfma_f32_16x16x32_bf16 a[16:19], a[176:179], v[128:131], a[16:19]
  ds_read_b128 a[140:143], v2 offset:6144
  ds_read_b128 a[144:147], v2 offset:7168
  v_mfma_f32_16x16x32_bf16 a[20:23], a[176:179], v[132:135], a[20:23]
  v_exp_f32 v61, v61
  v_mfma_f32_16x16x32_bf16 a[20:23], a[172:175], v[100:103], a[20:23]
  v_cvt_pk_bf16_f32 v46, v60, v61
  v_mfma_f32_16x16x32_bf16 a[24:27], a[172:175], v[104:107], a[24:27]
  v_exp_f32 v62, v62
  v_mfma_f32_16x16x32_bf16 a[24:27], a[176:179], v[136:139], a[24:27]
  v_mfma_f32_16x16x32_bf16 a[28:31], a[176:179], v[140:143], a[28:31]
  v_exp_f32 v63, v63
  v_mfma_f32_16x16x32_bf16 a[28:31], a[172:175], v[108:111], a[28:31]
  v_cvt_pk_bf16_f32 v47, v62, v63
  s_waitcnt lgkmcnt(0)
Lk2_fin:
  s_waitcnt vmcnt(8)
  s_barrier
  s_lshl_b32 s33, s2, 2
  s_add_u32 s33, s33, s22
  s_lshl_b32 s34, s33, 11
  s_lshl_b32 s33, s33, 13
  v_lshlrev_b32 v8, 3, v1
  v_lshlrev_b32 v9, 1, v1
  buffer_load_dword v5, v8, s[44:47], s33 offen
  buffer_load_dword v6, v9, s[48:51], s34 offen
  ds_read_b128 a[116:119], v2 offset:32768
  ds_read_b128 a[120:123], v2 offset:40960
  ds_read_b128 a[124:127], v2 offset:33792
  ds_read_b128 a[128:131], v2 offset:41984
  ds_read_b128 a[132:135], v2 offset:34816
  ds_read_b128 a[136:139], v2 offset:43008
  ds_read_b128 a[140:143], v2 offset:35840
  ds_read_b128 a[144:147], v2 offset:44032
  v_exp_f32 v64, v64
  v_exp_f32 v65, v65
  v_exp_f32 v66, v66
  v_exp_f32 v67, v67
  v_exp_f32 v80, v80
  v_exp_f32 v81, v81
  v_exp_f32 v82, v82
  v_exp_f32 v83, v83
  v_cvt_pk_bf16_f32 v64, v64, v65
  v_cvt_pk_bf16_f32 v65, v66, v67
  v_exp_f32 v68, v68
  v_exp_f32 v69, v69
  v_exp_f32 v70, v70
  v_exp_f32 v71, v71
  v_cvt_pk_bf16_f32 v66, v80, v81
  v_cvt_pk_bf16_f32 v67, v82, v83
  v_exp_f32 v84, v84
  v_exp_f32 v85, v85
  v_exp_f32 v86, v86
  v_exp_f32 v87, v87
  v_cvt_pk_bf16_f32 v68, v68, v69
  v_cvt_pk_bf16_f32 v69, v70, v71
  v_exp_f32 v72, v72
  v_exp_f32 v73, v73
  v_exp_f32 v74, v74
  v_exp_f32 v75, v75
  v_cvt_pk_bf16_f32 v70, v84, v85
  v_cvt_pk_bf16_f32 v71, v86, v87
  v_exp_f32 v88, v88
  v_exp_f32 v89, v89
  v_exp_f32 v90, v90
  v_exp_f32 v91, v91
  v_cvt_pk_bf16_f32 v72, v72, v73
  v_cvt_pk_bf16_f32 v73, v74, v75
  v_exp_f32 v76, v76
  v_exp_f32 v77, v77
  v_exp_f32 v78, v78
  v_exp_f32 v79, v79
  v_cvt_pk_bf16_f32 v74, v88, v89
  v_cvt_pk_bf16_f32 v75, v90, v91
  v_exp_f32 v92, v92
  v_exp_f32 v93, v93
  v_exp_f32 v94, v94
  v_exp_f32 v95, v95
  v_cvt_pk_bf16_f32 v76, v76, v77
  v_cvt_pk_bf16_f32 v77, v78, v79
  v_cvt_pk_bf16_f32 v78, v92, v93
  v_cvt_pk_bf16_f32 v79, v94, v95
  s_waitcnt lgkmcnt(6)
  v_mfma_f32_16x16x32_bf16 v[160:163], a[116:119], v[32:35], v[160:163]
  v_mfma_f32_16x16x32_bf16 v[160:163], a[120:123], v[64:67], v[160:163]
  ds_read_b128 a[148:151], v2 offset:36864
  ds_read_b128 a[152:155], v2 offset:45056
  v_mfma_f32_16x16x32_bf16 v[164:167], a[120:123], v[68:71], v[164:167]
  v_mfma_f32_16x16x32_bf16 v[164:167], a[116:119], v[36:39], v[164:167]
  v_mfma_f32_16x16x32_bf16 v[168:171], a[116:119], v[40:43], v[168:171]
  v_mfma_f32_16x16x32_bf16 v[168:171], a[120:123], v[72:75], v[168:171]
  v_mfma_f32_16x16x32_bf16 v[172:175], a[120:123], v[76:79], v[172:175]
  v_mfma_f32_16x16x32_bf16 v[172:175], a[116:119], v[44:47], v[172:175]
  s_waitcnt lgkmcnt(6)
  v_mfma_f32_16x16x32_bf16 a[32:35], a[48:51], v[32:35], a[32:35]
  v_mfma_f32_16x16x32_bf16 a[32:35], a[48:51], v[64:67], a[32:35]
  v_mfma_f32_16x16x32_bf16 v[176:179], a[124:127], v[32:35], v[176:179]
  v_mfma_f32_16x16x32_bf16 v[176:179], a[128:131], v[64:67], v[176:179]
  ds_read_b128 a[156:159], v2 offset:37888
  ds_read_b128 a[160:163], v2 offset:46080
  v_mfma_f32_16x16x32_bf16 v[180:183], a[128:131], v[68:71], v[180:183]
  v_mfma_f32_16x16x32_bf16 v[180:183], a[124:127], v[36:39], v[180:183]
  v_mfma_f32_16x16x32_bf16 v[184:187], a[124:127], v[40:43], v[184:187]
  v_mfma_f32_16x16x32_bf16 v[184:187], a[128:131], v[72:75], v[184:187]
  v_mfma_f32_16x16x32_bf16 v[188:191], a[128:131], v[76:79], v[188:191]
  v_mfma_f32_16x16x32_bf16 v[188:191], a[124:127], v[44:47], v[188:191]
  s_waitcnt lgkmcnt(6)
  v_mfma_f32_16x16x32_bf16 a[36:39], a[48:51], v[36:39], a[36:39]
  v_mfma_f32_16x16x32_bf16 a[36:39], a[48:51], v[68:71], a[36:39]
  v_mfma_f32_16x16x32_bf16 v[192:195], a[132:135], v[32:35], v[192:195]
  v_mfma_f32_16x16x32_bf16 v[192:195], a[136:139], v[64:67], v[192:195]
  ds_read_b128 a[164:167], v2 offset:38912
  ds_read_b128 a[168:171], v2 offset:47104
  v_mfma_f32_16x16x32_bf16 v[196:199], a[136:139], v[68:71], v[196:199]
  v_mfma_f32_16x16x32_bf16 v[196:199], a[132:135], v[36:39], v[196:199]
  v_mfma_f32_16x16x32_bf16 v[200:203], a[132:135], v[40:43], v[200:203]
  v_mfma_f32_16x16x32_bf16 v[200:203], a[136:139], v[72:75], v[200:203]
  v_mfma_f32_16x16x32_bf16 v[204:207], a[136:139], v[76:79], v[204:207]
  v_mfma_f32_16x16x32_bf16 v[204:207], a[132:135], v[44:47], v[204:207]
  s_waitcnt lgkmcnt(6)
  v_mfma_f32_16x16x32_bf16 a[40:43], a[48:51], v[40:43], a[40:43]
  v_mfma_f32_16x16x32_bf16 a[40:43], a[48:51], v[72:75], a[40:43]
  v_mfma_f32_16x16x32_bf16 v[208:211], a[140:143], v[32:35], v[208:211]
  v_mfma_f32_16x16x32_bf16 v[208:211], a[144:147], v[64:67], v[208:211]
  ds_read_b128 a[172:175], v2 offset:39936
  ds_read_b128 a[176:179], v2 offset:48128
  v_mfma_f32_16x16x32_bf16 v[212:215], a[144:147], v[68:71], v[212:215]
  v_mfma_f32_16x16x32_bf16 v[212:215], a[140:143], v[36:39], v[212:215]
  v_mfma_f32_16x16x32_bf16 v[216:219], a[140:143], v[40:43], v[216:219]
  v_mfma_f32_16x16x32_bf16 v[216:219], a[144:147], v[72:75], v[216:219]
  v_mfma_f32_16x16x32_bf16 v[220:223], a[144:147], v[76:79], v[220:223]
  v_mfma_f32_16x16x32_bf16 v[220:223], a[140:143], v[44:47], v[220:223]
  s_waitcnt lgkmcnt(6)
  v_mfma_f32_16x16x32_bf16 a[44:47], a[48:51], v[44:47], a[44:47]
  v_mfma_f32_16x16x32_bf16 a[44:47], a[48:51], v[76:79], a[44:47]
  v_mfma_f32_16x16x32_bf16 v[224:227], a[148:151], v[32:35], v[224:227]
  v_mfma_f32_16x16x32_bf16 v[224:227], a[152:155], v[64:67], v[224:227]
  v_mfma_f32_16x16x32_bf16 v[228:231], a[152:155], v[68:71], v[228:231]
  v_mfma_f32_16x16x32_bf16 v[228:231], a[148:151], v[36:39], v[228:231]
  v_mfma_f32_16x16x32_bf16 v[232:235], a[148:151], v[40:43], v[232:235]
  v_mfma_f32_16x16x32_bf16 v[232:235], a[152:155], v[72:75], v[232:235]
  v_mfma_f32_16x16x32_bf16 v[236:239], a[152:155], v[76:79], v[236:239]
  v_mfma_f32_16x16x32_bf16 v[236:239], a[148:151], v[44:47], v[236:239]
  s_waitcnt lgkmcnt(4)
  v_mfma_f32_16x16x32_bf16 v[240:243], a[156:159], v[32:35], v[240:243]
  v_mfma_f32_16x16x32_bf16 v[240:243], a[160:163], v[64:67], v[240:243]
  v_mfma_f32_16x16x32_bf16 v[244:247], a[160:163], v[68:71], v[244:247]
  v_mfma_f32_16x16x32_bf16 v[244:247], a[156:159], v[36:39], v[244:247]
  v_mfma_f32_16x16x32_bf16 v[248:251], a[156:159], v[40:43], v[248:251]
  v_mfma_f32_16x16x32_bf16 v[248:251], a[160:163], v[72:75], v[248:251]
  s_waitcnt vmcnt(63) lgkmcnt(0)
  s_barrier
  v_mfma_f32_16x16x32_bf16 v[252:255], a[160:163], v[76:79], v[252:255]
  v_mfma_f32_16x16x32_bf16 v[252:255], a[156:159], v[44:47], v[252:255]
  v_mfma_f32_16x16x32_bf16 a[0:3], a[164:167], v[32:35], a[0:3]
  v_mfma_f32_16x16x32_bf16 a[0:3], a[168:171], v[64:67], a[0:3]
  v_mfma_f32_16x16x32_bf16 a[4:7], a[168:171], v[68:71], a[4:7]
  v_mfma_f32_16x16x32_bf16 a[4:7], a[164:167], v[36:39], a[4:7]
  v_mfma_f32_16x16x32_bf16 a[8:11], a[164:167], v[40:43], a[8:11]
  v_mfma_f32_16x16x32_bf16 a[8:11], a[168:171], v[72:75], a[8:11]
  v_mfma_f32_16x16x32_bf16 a[12:15], a[168:171], v[76:79], a[12:15]
  v_mfma_f32_16x16x32_bf16 a[12:15], a[164:167], v[44:47], a[12:15]
  v_mfma_f32_16x16x32_bf16 a[16:19], a[172:175], v[32:35], a[16:19]
  v_mfma_f32_16x16x32_bf16 a[16:19], a[176:179], v[64:67], a[16:19]
  v_mfma_f32_16x16x32_bf16 a[20:23], a[176:179], v[68:71], a[20:23]
  v_mfma_f32_16x16x32_bf16 a[20:23], a[172:175], v[36:39], a[20:23]
  v_mfma_f32_16x16x32_bf16 a[24:27], a[172:175], v[40:43], a[24:27]
  v_mfma_f32_16x16x32_bf16 a[24:27], a[176:179], v[72:75], a[24:27]
  v_mfma_f32_16x16x32_bf16 a[28:31], a[176:179], v[76:79], a[28:31]
  v_mfma_f32_16x16x32_bf16 a[28:31], a[172:175], v[44:47], a[28:31]
Lk2_merge:
  s_lshl_b32 s33, s23, 14
  s_add_u32 s34, s33, 131072
  s_add_u32 s33, s33, 32768
  s_cmp_eq_u32 s24, 0
  s_cselect_b32 s35, s34, s33
  s_cselect_b32 s36, s33, s34
  v_add_u32 v2, s35, v1
  v_add_u32 v3, s36, v1
  s_lshl_b32 s33, s22, 10
  s_xor_b32 s34, s33, 2048
  v_add_u32 v14, s33, v1
  v_add_u32 v15, s34, v1
  v_accvgpr_read_b32 v20, a32
  v_accvgpr_read_b32 v21, a36
  v_accvgpr_read_b32 v22, a40
  v_accvgpr_read_b32 v23, a44
  ds_write_b128 v14, v[20:23]
  s_cmp_eq_u32 s24, 1
  s_waitcnt lgkmcnt(0)
  s_cbranch_scc1 Lk2_mg1
  ds_write_b128 v2, v[224:227] offset:0
  ds_write_b128 v2, v[228:231] offset:1024
  ds_write_b128 v2, v[232:235] offset:2048
  ds_write_b128 v2, v[236:239] offset:3072
  ds_write_b128 v2, v[240:243] offset:4096
  ds_write_b128 v2, v[244:247] offset:5120
  ds_write_b128 v2, v[248:251] offset:6144
  ds_write_b128 v2, v[252:255] offset:7168
  ds_write_b128 v2, a[0:3] offset:8192
  ds_write_b128 v2, a[4:7] offset:9216
  ds_write_b128 v2, a[8:11] offset:10240
  ds_write_b128 v2, a[12:15] offset:11264
  ds_write_b128 v2, a[16:19] offset:12288
  ds_write_b128 v2, a[20:23] offset:13312
  ds_write_b128 v2, a[24:27] offset:14336
  ds_write_b128 v2, a[28:31] offset:15360
  s_waitcnt lgkmcnt(0)
  s_barrier
  ds_read_b128 v[28:31], v15
  ds_read_b128 v[32:35], v3 offset:0
  ds_read_b128 v[36:39], v3 offset:1024
  ds_read_b128 v[40:43], v3 offset:2048
  ds_read_b128 v[44:47], v3 offset:3072
  ds_read_b128 v[48:51], v3 offset:4096
  ds_read_b128 v[52:55], v3 offset:5120
  ds_read_b128 v[56:59], v3 offset:6144
  ds_read_b128 v[60:63], v3 offset:7168
  ds_read_b128 v[64:67], v3 offset:8192
  ds_read_b128 v[68:71], v3 offset:9216
  ds_read_b128 v[72:75], v3 offset:10240
  ds_read_b128 v[76:79], v3 offset:11264
  ds_read_b128 v[80:83], v3 offset:12288
  ds_read_b128 v[84:87], v3 offset:13312
  ds_read_b128 v[88:91], v3 offset:14336
  ds_read_b128 v[92:95], v3 offset:15360
  s_waitcnt lgkmcnt(15)
  v_add_f32 v20, v20, v28
  v_add_f32 v21, v21, v29
  v_add_f32 v22, v22, v30
  v_add_f32 v23, v23, v31
  s_sub_u32 s35, 15, s21
  v_rcp_f32 v8, v20
  v_rcp_f32 v9, v21
  v_rcp_f32 v10, v22
  v_rcp_f32 v11, v23
  v_subrev_u32 v20, 0x21800000, v20
  v_subrev_u32 v21, 0x21800000, v21
  v_subrev_u32 v22, 0x21800000, v22
  v_subrev_u32 v23, 0x21800000, v23
  v_max_u32 v12, v20, v21
  v_max3_u32 v12, v12, v22, v23
  s_mov_b32 s64, 0x207
  v_pk_add_f32 v[160:161], v[160:161], v[32:33]
  v_pk_add_f32 v[162:163], v[162:163], v[34:35]
  s_waitcnt lgkmcnt(11)
  v_pk_add_f32 v[176:177], v[176:177], v[48:49]
  v_pk_add_f32 v[178:179], v[178:179], v[50:51]
  v_pk_mul_f32 v[160:161], v[160:161], v[8:9] op_sel:[0,0] op_sel_hi:[1,0]
  v_pk_mul_f32 v[162:163], v[162:163], v[8:9] op_sel:[0,0] op_sel_hi:[1,0]
  v_pk_mul_f32 v[176:177], v[176:177], v[8:9] op_sel:[0,0] op_sel_hi:[1,0]
  v_pk_mul_f32 v[178:179], v[178:179], v[8:9] op_sel:[0,0] op_sel_hi:[1,0]
  v_cvt_pk_bf16_f32 v160, v160, v161
  v_cvt_pk_bf16_f32 v161, v162, v163
  v_cvt_pk_bf16_f32 v162, v176, v177
  v_cvt_pk_bf16_f32 v163, v178, v179
  v_pk_add_f32 v[164:165], v[164:165], v[36:37]
  v_pk_add_f32 v[166:167], v[166:167], v[38:39]
  s_waitcnt lgkmcnt(10)
  v_pk_add_f32 v[180:181], v[180:181], v[52:53]
  v_pk_add_f32 v[182:183], v[182:183], v[54:55]
  v_mfma_f32_16x16x32_bf16 v[24:27], a[48:51], v[160:163], 0
  v_pk_mul_f32 v[164:165], v[164:165], v[8:9] op_sel:[0,1] op_sel_hi:[1,1]
  v_pk_mul_f32 v[166:167], v[166:167], v[8:9] op_sel:[0,1] op_sel_hi:[1,1]
  v_pk_mul_f32 v[180:181], v[180:181], v[8:9] op_sel:[0,1] op_sel_hi:[1,1]
  v_pk_mul_f32 v[182:183], v[182:183], v[8:9] op_sel:[0,1] op_sel_hi:[1,1]
  v_cvt_pk_bf16_f32 v164, v164, v165
  v_cvt_pk_bf16_f32 v165, v166, v167
  v_cvt_pk_bf16_f32 v166, v180, v181
  v_cvt_pk_bf16_f32 v167, v182, v183
  v_pk_add_f32 v[168:169], v[168:169], v[40:41]
  v_pk_add_f32 v[170:171], v[170:171], v[42:43]
  s_waitcnt lgkmcnt(9)
  v_pk_add_f32 v[184:185], v[184:185], v[56:57]
  v_pk_add_f32 v[186:187], v[186:187], v[58:59]
  v_mfma_f32_16x16x32_bf16 v[24:27], a[48:51], v[164:167], v[24:27]
  v_pk_mul_f32 v[168:169], v[168:169], v[10:11] op_sel:[0,0] op_sel_hi:[1,0]
  v_pk_mul_f32 v[170:171], v[170:171], v[10:11] op_sel:[0,0] op_sel_hi:[1,0]
  v_pk_mul_f32 v[184:185], v[184:185], v[10:11] op_sel:[0,0] op_sel_hi:[1,0]
  v_pk_mul_f32 v[186:187], v[186:187], v[10:11] op_sel:[0,0] op_sel_hi:[1,0]
  v_cvt_pk_bf16_f32 v168, v168, v169
  v_cvt_pk_bf16_f32 v169, v170, v171
  v_cvt_pk_bf16_f32 v170, v184, v185
  v_cvt_pk_bf16_f32 v171, v186, v187
  v_pk_add_f32 v[172:173], v[172:173], v[44:45]
  v_pk_add_f32 v[174:175], v[174:175], v[46:47]
  s_waitcnt lgkmcnt(8)
  v_pk_add_f32 v[188:189], v[188:189], v[60:61]
  v_pk_add_f32 v[190:191], v[190:191], v[62:63]
  v_mfma_f32_16x16x32_bf16 v[24:27], a[48:51], v[168:171], v[24:27]
  v_pk_mul_f32 v[172:173], v[172:173], v[10:11] op_sel:[0,1] op_sel_hi:[1,1]
  v_pk_mul_f32 v[174:175], v[174:175], v[10:11] op_sel:[0,1] op_sel_hi:[1,1]
  v_pk_mul_f32 v[188:189], v[188:189], v[10:11] op_sel:[0,1] op_sel_hi:[1,1]
  v_pk_mul_f32 v[190:191], v[190:191], v[10:11] op_sel:[0,1] op_sel_hi:[1,1]
  v_cvt_pk_bf16_f32 v172, v172, v173
  v_cvt_pk_bf16_f32 v173, v174, v175
  v_cvt_pk_bf16_f32 v174, v188, v189
  v_cvt_pk_bf16_f32 v175, v190, v191
  s_waitcnt lgkmcnt(7)
  v_pk_add_f32 v[192:193], v[192:193], v[64:65]
  v_pk_add_f32 v[194:195], v[194:195], v[66:67]
  s_waitcnt lgkmcnt(3)
  v_pk_add_f32 v[208:209], v[208:209], v[80:81]
  v_pk_add_f32 v[210:211], v[210:211], v[82:83]
  v_mfma_f32_16x16x32_bf16 v[24:27], a[48:51], v[172:175], v[24:27]
  v_pk_mul_f32 v[192:193], v[192:193], v[8:9] op_sel:[0,0] op_sel_hi:[1,0]
  v_pk_mul_f32 v[194:195], v[194:195], v[8:9] op_sel:[0,0] op_sel_hi:[1,0]
  v_pk_mul_f32 v[208:209], v[208:209], v[8:9] op_sel:[0,0] op_sel_hi:[1,0]
  v_pk_mul_f32 v[210:211], v[210:211], v[8:9] op_sel:[0,0] op_sel_hi:[1,0]
  v_cvt_pk_bf16_f32 v192, v192, v193
  v_cvt_pk_bf16_f32 v193, v194, v195
  v_cvt_pk_bf16_f32 v194, v208, v209
  v_cvt_pk_bf16_f32 v195, v210, v211
  v_pk_add_f32 v[196:197], v[196:197], v[68:69]
  v_pk_add_f32 v[198:199], v[198:199], v[70:71]
  s_waitcnt lgkmcnt(2)
  v_pk_add_f32 v[212:213], v[212:213], v[84:85]
  v_pk_add_f32 v[214:215], v[214:215], v[86:87]
  v_mfma_f32_16x16x32_bf16 v[24:27], a[48:51], v[192:195], v[24:27]
  v_pk_mul_f32 v[196:197], v[196:197], v[8:9] op_sel:[0,1] op_sel_hi:[1,1]
  v_pk_mul_f32 v[198:199], v[198:199], v[8:9] op_sel:[0,1] op_sel_hi:[1,1]
  v_pk_mul_f32 v[212:213], v[212:213], v[8:9] op_sel:[0,1] op_sel_hi:[1,1]
  v_pk_mul_f32 v[214:215], v[214:215], v[8:9] op_sel:[0,1] op_sel_hi:[1,1]
  v_cvt_pk_bf16_f32 v196, v196, v197
  v_cvt_pk_bf16_f32 v197, v198, v199
  v_cvt_pk_bf16_f32 v198, v212, v213
  v_cvt_pk_bf16_f32 v199, v214, v215
  v_pk_add_f32 v[200:201], v[200:201], v[72:73]
  v_pk_add_f32 v[202:203], v[202:203], v[74:75]
  s_waitcnt lgkmcnt(1)
  v_pk_add_f32 v[216:217], v[216:217], v[88:89]
  v_pk_add_f32 v[218:219], v[218:219], v[90:91]
  v_mfma_f32_16x16x32_bf16 v[24:27], a[48:51], v[196:199], v[24:27]
  v_pk_mul_f32 v[200:201], v[200:201], v[10:11] op_sel:[0,0] op_sel_hi:[1,0]
  v_pk_mul_f32 v[202:203], v[202:203], v[10:11] op_sel:[0,0] op_sel_hi:[1,0]
  v_pk_mul_f32 v[216:217], v[216:217], v[10:11] op_sel:[0,0] op_sel_hi:[1,0]
  v_pk_mul_f32 v[218:219], v[218:219], v[10:11] op_sel:[0,0] op_sel_hi:[1,0]
  v_cvt_pk_bf16_f32 v200, v200, v201
  v_cvt_pk_bf16_f32 v201, v202, v203
  v_cvt_pk_bf16_f32 v202, v216, v217
  v_cvt_pk_bf16_f32 v203, v218, v219
  v_pk_add_f32 v[204:205], v[204:205], v[76:77]
  v_pk_add_f32 v[206:207], v[206:207], v[78:79]
  s_waitcnt lgkmcnt(0)
  v_pk_add_f32 v[220:221], v[220:221], v[92:93]
  v_pk_add_f32 v[222:223], v[222:223], v[94:95]
  v_mfma_f32_16x16x32_bf16 v[24:27], a[48:51], v[200:203], v[24:27]
  v_pk_mul_f32 v[204:205], v[204:205], v[10:11] op_sel:[0,1] op_sel_hi:[1,1]
  v_pk_mul_f32 v[206:207], v[206:207], v[10:11] op_sel:[0,1] op_sel_hi:[1,1]
  v_pk_mul_f32 v[220:221], v[220:221], v[10:11] op_sel:[0,1] op_sel_hi:[1,1]
  v_pk_mul_f32 v[222:223], v[222:223], v[10:11] op_sel:[0,1] op_sel_hi:[1,1]
  v_cvt_pk_bf16_f32 v204, v204, v205
  v_cvt_pk_bf16_f32 v205, v206, v207
  v_cvt_pk_bf16_f32 v206, v220, v221
  v_cvt_pk_bf16_f32 v207, v222, v223
  s_nop 1
  v_mfma_f32_16x16x32_bf16 v[24:27], a[48:51], v[204:207], v[24:27]
  v_cmp_lt_u32 vcc, 0x3c000000, v12
  s_nop 6
  v_cmp_class_f32 s[40:41], v24, s64
  s_nop 0
  s_or_b64 vcc, vcc, s[40:41]
  s_cbranch_vccnz Lbad_3
  s_lshl_b32 s33, s35, 20
  s_lshl_b32 s34, s20, 15
  s_add_u32 s33, s33, s34
  s_lshl_b32 s34, s23, 13
  s_add_u32 s36, s33, s34
  s_add_u32 s37, s36, 4096
  s_add_u32 s38, s36, 16384
  s_add_u32 s39, s36, 20480
  buffer_store_dwordx4 v[160:163], v1, s[16:19], s36 offen offset:0
  buffer_store_dwordx4 v[164:167], v1, s[16:19], s36 offen offset:2048
  buffer_store_dwordx4 v[168:171], v1, s[16:19], s37 offen offset:0
  buffer_store_dwordx4 v[172:175], v1, s[16:19], s37 offen offset:2048
  buffer_store_dwordx4 v[192:195], v1, s[16:19], s36 offen offset:1024
  buffer_store_dwordx4 v[196:199], v1, s[16:19], s36 offen offset:3072
  buffer_store_dwordx4 v[200:203], v1, s[16:19], s37 offen offset:1024
  buffer_store_dwordx4 v[204:207], v1, s[16:19], s37 offen offset:3072
  s_branch Lfd_4
Lbad_3:
  s_or_b32 s60, s60, 2
Lfd_4:
  s_branch Lk2_chk
Lk2_mg1:
  ds_write_b128 v2, v[160:163] offset:0
  ds_write_b128 v2, v[164:167] offset:1024
  ds_write_b128 v2, v[168:171] offset:2048
  ds_write_b128 v2, v[172:175] offset:3072
  ds_write_b128 v2, v[176:179] offset:4096
  ds_write_b128 v2, v[180:183] offset:5120
  ds_write_b128 v2, v[184:187] offset:6144
  ds_write_b128 v2, v[188:191] offset:7168
  ds_write_b128 v2, v[192:195] offset:8192
  ds_write_b128 v2, v[196:199] offset:9216
  ds_write_b128 v2, v[200:203] offset:10240
  ds_write_b128 v2, v[204:207] offset:11264
  ds_write_b128 v2, v[208:211] offset:12288
  ds_write_b128 v2, v[212:215] offset:13312
  ds_write_b128 v2, v[216:219] offset:14336
  ds_write_b128 v2, v[220:223] offset:15360
  s_waitcnt lgkmcnt(0)
  s_barrier
  ds_read_b128 v[28:31], v15
  ds_read_b128 v[32:35], v3 offset:0
  ds_read_b128 v[36:39], v3 offset:1024
  ds_read_b128 v[40:43], v3 offset:2048
  ds_read_b128 v[44:47], v3 offset:3072
  ds_read_b128 v[48:51], v3 offset:4096
  ds_read_b128 v[52:55], v3 offset:5120
  ds_read_b128 v[56:59], v3 offset:6144
  ds_read_b128 v[60:63], v3 offset:7168
  ds_read_b128 v[64:67], v3 offset:8192
  ds_read_b128 v[68:71], v3 offset:9216
  ds_read_b128 v[72:75], v3 offset:10240
  ds_read_b128 v[76:79], v3 offset:11264
  ds_read_b128 v[80:83], v3 offset:12288
  ds_read_b128 v[84:87], v3 offset:13312
  ds_read_b128 v[88:91], v3 offset:14336
  ds_read_b128 v[92:95], v3 offset:15360
  s_waitcnt lgkmcnt(15)
  v_add_f32 v20, v20, v28
  v_add_f32 v21, v21, v29
  v_add_f32 v22, v22, v30
  v_add_f32 v23, v23, v31
  s_sub_u32 s35, 15, s21
  v_rcp_f32 v8, v20
  v_rcp_f32 v9, v21
  v_rcp_f32 v10, v22
  v_rcp_f32 v11, v23
  v_subrev_u32 v20, 0x21800000, v20
  v_subrev_u32 v21, 0x21800000, v21
  v_subrev_u32 v22, 0x21800000, v22
  v_subrev_u32 v23, 0x21800000, v23
  v_max_u32 v12, v20, v21
  v_max3_u32 v12, v12, v22, v23
  s_mov_b32 s64, 0x207
  v_pk_add_f32 v[224:225], v[224:225], v[32:33]
  v_pk_add_f32 v[226:227], v[226:227], v[34:35]
  s_waitcnt lgkmcnt(11)
  v_pk_add_f32 v[240:241], v[240:241], v[48:49]
  v_pk_add_f32 v[242:243], v[242:243], v[50:51]
  v_pk_mul_f32 v[224:225], v[224:225], v[8:9] op_sel:[0,0] op_sel_hi:[1,0]
  v_pk_mul_f32 v[226:227], v[226:227], v[8:9] op_sel:[0,0] op_sel_hi:[1,0]
  v_pk_mul_f32 v[240:241], v[240:241], v[8:9] op_sel:[0,0] op_sel_hi:[1,0]
  v_pk_mul_f32 v[242:243], v[242:243], v[8:9] op_sel:[0,0] op_sel_hi:[1,0]
  v_cvt_pk_bf16_f32 v224, v224, v225
  v_cvt_pk_bf16_f32 v225, v226, v227
  v_cvt_pk_bf16_f32 v226, v240, v241
  v_cvt_pk_bf16_f32 v227, v242, v243
  v_pk_add_f32 v[228:229], v[228:229], v[36:37]
  v_pk_add_f32 v[230:231], v[230:231], v[38:39]
  s_waitcnt lgkmcnt(10)
  v_pk_add_f32 v[244:245], v[244:245], v[52:53]
  v_pk_add_f32 v[246:247], v[246:247], v[54:55]
  v_mfma_f32_16x16x32_bf16 v[24:27], a[48:51], v[224:227], 0
  v_pk_mul_f32 v[228:229], v[228:229], v[8:9] op_sel:[0,1] op_sel_hi:[1,1]
  v_pk_mul_f32 v[230:231], v[230:231], v[8:9] op_sel:[0,1] op_sel_hi:[1,1]
  v_pk_mul_f32 v[244:245], v[244:245], v[8:9] op_sel:[0,1] op_sel_hi:[1,1]
  v_pk_mul_f32 v[246:247], v[246:247], v[8:9] op_sel:[0,1] op_sel_hi:[1,1]
  v_cvt_pk_bf16_f32 v228, v228, v229
  v_cvt_pk_bf16_f32 v229, v230, v231
  v_cvt_pk_bf16_f32 v230, v244, v245
  v_cvt_pk_bf16_f32 v231, v246, v247
  v_pk_add_f32 v[232:233], v[232:233], v[40:41]
  v_pk_add_f32 v[234:235], v[234:235], v[42:43]
  s_waitcnt lgkmcnt(9)
  v_pk_add_f32 v[248:249], v[248:249], v[56:57]
  v_pk_add_f32 v[250:251], v[250:251], v[58:59]
  v_mfma_f32_16x16x32_bf16 v[24:27], a[48:51], v[228:231], v[24:27]
  v_pk_mul_f32 v[232:233], v[232:233], v[10:11] op_sel:[0,0] op_sel_hi:[1,0]
  v_pk_mul_f32 v[234:235], v[234:235], v[10:11] op_sel:[0,0] op_sel_hi:[1,0]
  v_pk_mul_f32 v[248:249], v[248:249], v[10:11] op_sel:[0,0] op_sel_hi:[1,0]
  v_pk_mul_f32 v[250:251], v[250:251], v[10:11] op_sel:[0,0] op_sel_hi:[1,0]
  v_cvt_pk_bf16_f32 v232, v232, v233
  v_cvt_pk_bf16_f32 v233, v234, v235
  v_cvt_pk_bf16_f32 v234, v248, v249
  v_cvt_pk_bf16_f32 v235, v250, v251
  v_pk_add_f32 v[236:237], v[236:237], v[44:45]
  v_pk_add_f32 v[238:239], v[238:239], v[46:47]
  s_waitcnt lgkmcnt(8)
  v_pk_add_f32 v[252:253], v[252:253], v[60:61]
  v_pk_add_f32 v[254:255], v[254:255], v[62:63]
  v_mfma_f32_16x16x32_bf16 v[24:27], a[48:51], v[232:235], v[24:27]
  v_pk_mul_f32 v[236:237], v[236:237], v[10:11] op_sel:[0,1] op_sel_hi:[1,1]
  v_pk_mul_f32 v[238:239], v[238:239], v[10:11] op_sel:[0,1] op_sel_hi:[1,1]
  v_pk_mul_f32 v[252:253], v[252:253], v[10:11] op_sel:[0,1] op_sel_hi:[1,1]
  v_pk_mul_f32 v[254:255], v[254:255], v[10:11] op_sel:[0,1] op_sel_hi:[1,1]
  v_cvt_pk_bf16_f32 v236, v236, v237
  v_cvt_pk_bf16_f32 v237, v238, v239
  v_cvt_pk_bf16_f32 v238, v252, v253
  v_cvt_pk_bf16_f32 v239, v254, v255
  v_accvgpr_read_b32 v32, a0
  v_accvgpr_read_b32 v33, a1
  v_accvgpr_read_b32 v34, a2
  v_accvgpr_read_b32 v35, a3
  s_waitcnt lgkmcnt(7)
  v_pk_add_f32 v[32:33], v[32:33], v[64:65]
  v_pk_add_f32 v[34:35], v[34:35], v[66:67]
  v_accvgpr_read_b32 v48, a16
  v_accvgpr_read_b32 v49, a17
  v_accvgpr_read_b32 v50, a18
  v_accvgpr_read_b32 v51, a19
  s_waitcnt lgkmcnt(3)
  v_pk_add_f32 v[48:49], v[48:49], v[80:81]
  v_pk_add_f32 v[50:51], v[50:51], v[82:83]
  v_mfma_f32_16x16x32_bf16 v[24:27], a[48:51], v[236:239], v[24:27]
  v_pk_mul_f32 v[32:33], v[32:33], v[8:9] op_sel:[0,0] op_sel_hi:[1,0]
  v_pk_mul_f32 v[34:35], v[34:35], v[8:9] op_sel:[0,0] op_sel_hi:[1,0]
  v_pk_mul_f32 v[48:49], v[48:49], v[8:9] op_sel:[0,0] op_sel_hi:[1,0]
  v_pk_mul_f32 v[50:51], v[50:51], v[8:9] op_sel:[0,0] op_sel_hi:[1,0]
  v_cvt_pk_bf16_f32 v32, v32, v33
  v_cvt_pk_bf16_f32 v33, v34, v35
  v_cvt_pk_bf16_f32 v34, v48, v49
  v_cvt_pk_bf16_f32 v35, v50, v51
  v_accvgpr_read_b32 v240, a4
  v_accvgpr_read_b32 v241, a5
  v_accvgpr_read_b32 v242, a6
  v_accvgpr_read_b32 v243, a7
  v_pk_add_f32 v[240:241], v[240:241], v[68:69]
  v_pk_add_f32 v[242:243], v[242:243], v[70:71]
  v_accvgpr_read_b32 v36, a20
  v_accvgpr_read_b32 v37, a21
  v_accvgpr_read_b32 v38, a22
  v_accvgpr_read_b32 v39, a23
  s_waitcnt lgkmcnt(2)
  v_pk_add_f32 v[36:37], v[36:37], v[84:85]
  v_pk_add_f32 v[38:39], v[38:39], v[86:87]
  v_mfma_f32_16x16x32_bf16 v[24:27], a[48:51], v[32:35], v[24:27]
  v_pk_mul_f32 v[240:241], v[240:241], v[8:9] op_sel:[0,1] op_sel_hi:[1,1]
  v_pk_mul_f32 v[242:243], v[242:243], v[8:9] op_sel:[0,1] op_sel_hi:[1,1]
  v_pk_mul_f32 v[36:37], v[36:37], v[8:9] op_sel:[0,1] op_sel_hi:[1,1]
  v_pk_mul_f32 v[38:39], v[38:39], v[8:9] op_sel:[0,1] op_sel_hi:[1,1]
  v_cvt_pk_bf16_f32 v240, v240, v241
  v_cvt_pk_bf16_f32 v241, v242, v243
  v_cvt_pk_bf16_f32 v242, v36, v37
  v_cvt_pk_bf16_f32 v243, v38, v39
  v_accvgpr_read_b32 v52, a8
  v_accvgpr_read_b32 v53, a9
  v_accvgpr_read_b32 v54, a10
  v_accvgpr_read_b32 v55, a11
  v_pk_add_f32 v[52:53], v[52:53], v[72:73]
  v_pk_add_f32 v[54:55], v[54:55], v[74:75]
  v_accvgpr_read_b32 v244, a24
  v_accvgpr_read_b32 v245, a25
  v_accvgpr_read_b32 v246, a26
  v_accvgpr_read_b32 v247, a27
  s_waitcnt lgkmcnt(1)
  v_pk_add_f32 v[244:245], v[244:245], v[88:89]
  v_pk_add_f32 v[246:247], v[246:247], v[90:91]
  v_mfma_f32_16x16x32_bf16 v[24:27], a[48:51], v[240:243], v[24:27]
  v_pk_mul_f32 v[52:53], v[52:53], v[10:11] op_sel:[0,0] op_sel_hi:[1,0]
  v_pk_mul_f32 v[54:55], v[54:55], v[10:11] op_sel:[0,0] op_sel_hi:[1,0]
  v_pk_mul_f32 v[244:245], v[244:245], v[10:11] op_sel:[0,0] op_sel_hi:[1,0]
  v_pk_mul_f32 v[246:247], v[246:247], v[10:11] op_sel:[0,0] op_sel_hi:[1,0]
  v_cvt_pk_bf16_f32 v52, v52, v53
  v_cvt_pk_bf16_f32 v53, v54, v55
  v_cvt_pk_bf16_f32 v54, v244, v245
  v_cvt_pk_bf16_f32 v55, v246, v247
  v_accvgpr_read_b32 v40, a12
  v_accvgpr_read_b32 v41, a13
  v_accvgpr_read_b32 v42, a14
  v_accvgpr_read_b32 v43, a15
  v_pk_add_f32 v[40:41], v[40:41], v[76:77]
  v_pk_add_f32 v[42:43], v[42:43], v[78:79]
  v_accvgpr_read_b32 v56, a28
  v_accvgpr_read_b32 v57, a29
  v_accvgpr_read_b32 v58, a30
  v_accvgpr_read_b32 v59, a31
  s_waitcnt lgkmcnt(0)
  v_pk_add_f32 v[56:57], v[56:57], v[92:93]
  v_pk_add_f32 v[58:59], v[58:59], v[94:95]
  v_mfma_f32_16x16x32_bf16 v[24:27], a[48:51], v[52:55], v[24:27]
  v_pk_mul_f32 v[40:41], v[40:41], v[10:11] op_sel:[0,1] op_sel_hi:[1,1]
  v_pk_mul_f32 v[42:43], v[42:43], v[10:11] op_sel:[0,1] op_sel_hi:[1,1]
  v_pk_mul_f32 v[56:57], v[56:57], v[10:11] op_sel:[0,1] op_sel_hi:[1,1]
  v_pk_mul_f32 v[58:59], v[58:59], v[10:11] op_sel:[0,1] op_sel_hi:[1,1]
  v_cvt_pk_bf16_f32 v40, v40, v41
  v_cvt_pk_bf16_f32 v41, v42, v43
  v_cvt_pk_bf16_f32 v42, v56, v57
  v_cvt_pk_bf16_f32 v43, v58, v59
  s_nop 1
  v_mfma_f32_16x16x32_bf16 v[24:27], a[48:51], v[40:43], v[24:27]
  v_cmp_lt_u32 vcc, 0x3c000000, v12
  s_nop 6
  v_cmp_class_f32 s[40:41], v24, s64
  s_nop 0
  s_or_b64 vcc, vcc, s[40:41]
  s_cbranch_vccnz Lbad_5
  s_lshl_b32 s33, s35, 20
  s_lshl_b32 s34, s20, 15
  s_add_u32 s33, s33, s34
  s_lshl_b32 s34, s23, 13
  s_add_u32 s36, s33, s34
  s_add_u32 s37, s36, 4096
  s_add_u32 s38, s36, 16384
  s_add_u32 s39, s36, 20480
  buffer_store_dwordx4 v[224:227], v1, s[16:19], s38 offen offset:0
  buffer_store_dwordx4 v[228:231], v1, s[16:19], s38 offen offset:2048
  buffer_store_dwordx4 v[232:235], v1, s[16:19], s39 offen offset:0
  buffer_store_dwordx4 v[236:239], v1, s[16:19], s39 offen offset:2048
  buffer_store_dwordx4 v[32:35], v1, s[16:19], s38 offen offset:1024
  buffer_store_dwordx4 v[240:243], v1, s[16:19], s38 offen offset:3072
  buffer_store_dwordx4 v[52:55], v1, s[16:19], s39 offen offset:1024
  buffer_store_dwordx4 v[40:43], v1, s[16:19], s39 offen offset:3072
  s_branch Lfd_6
Lbad_5:
  s_or_b32 s60, s60, 2
Lfd_6:
Lk2_chk:
  s_cmp_eq_u32 s60, 0
  s_cbranch_scc1 Lk2_done
  s_sub_u32 s56, 15, s21
  s_lshl_b32 s33, s24, 1
  s_lshl_b32 s61, 3, s33
  s_and_b32 s34, s60, 2
  s_bitcmp1_b32 s60, 0
  s_cselect_b32 s56, s21, s56
  s_cselect_b32 s61, 15, s61
  s_cselect_b32 s60, s34, 0
  s_waitcnt vmcnt(0)
  s_lshl_b32 s33, s20, 7
  s_lshl_b32 s34, s56, 3
  s_add_u32 s33, s33, s34
  s_lshl_b32 s34, s23, 2
  s_add_u32 s33, s33, s34
  s_lshl_b32 s33, s33, 12
  buffer_load_dwordx4 a[52:55], v1, s[8:11], s33 offen offset:0
  buffer_load_dwordx4 a[56:59], v1, s[8:11], s33 offen offset:1024
  buffer_load_dwordx4 a[60:63], v1, s[8:11], s33 offen offset:2048
  buffer_load_dwordx4 a[64:67], v1, s[8:11], s33 offen offset:3072
  s_add_u32 s33, s33, 4096
  buffer_load_dwordx4 a[68:71], v1, s[8:11], s33 offen offset:0
  buffer_load_dwordx4 a[72:75], v1, s[8:11], s33 offen offset:1024
  buffer_load_dwordx4 a[76:79], v1, s[8:11], s33 offen offset:2048
  buffer_load_dwordx4 a[80:83], v1, s[8:11], s33 offen offset:3072
  s_add_u32 s33, s33, 4096
  buffer_load_dwordx4 a[84:87], v1, s[8:11], s33 offen offset:0
  buffer_load_dwordx4 a[88:91], v1, s[8:11], s33 offen offset:1024
  buffer_load_dwordx4 a[92:95], v1, s[8:11], s33 offen offset:2048
  buffer_load_dwordx4 a[96:99], v1, s[8:11], s33 offen offset:3072
  s_add_u32 s33, s33, 4096
  buffer_load_dwordx4 a[100:103], v1, s[8:11], s33 offen offset:0
  buffer_load_dwordx4 a[104:107], v1, s[8:11], s33 offen offset:1024
  buffer_load_dwordx4 a[108:111], v1, s[8:11], s33 offen offset:2048
  buffer_load_dwordx4 a[112:115], v1, s[8:11], s33 offen offset:3072
  v_accvgpr_write_b32 a0, 0
  v_accvgpr_write_b32 a1, 0
  v_accvgpr_write_b32 a2, 0
  v_accvgpr_write_b32 a3, 0
  v_accvgpr_write_b32 a4, 0
  v_accvgpr_write_b32 a5, 0
  v_accvgpr_write_b32 a6, 0
  v_accvgpr_write_b32 a7, 0
  v_accvgpr_write_b32 a8, 0
  v_accvgpr_write_b32 a9, 0
  v_accvgpr_write_b32 a10, 0
  v_accvgpr_write_b32 a11, 0
  v_accvgpr_write_b32 a12, 0
  v_accvgpr_write_b32 a13, 0
  v_accvgpr_write_b32 a14, 0
  v_accvgpr_write_b32 a15, 0
  v_accvgpr_write_b32 a16, 0
  v_accvgpr_write_b32 a17, 0
  v_accvgpr_write_b32 a18, 0
  v_accvgpr_write_b32 a19, 0
  v_accvgpr_write_b32 a20, 0
  v_accvgpr_write_b32 a21, 0
  v_accvgpr_write_b32 a22, 0
  v_accvgpr_write_b32 a23, 0
  v_accvgpr_write_b32 a24, 0
  v_accvgpr_write_b32 a25, 0
  v_accvgpr_write_b32 a26, 0
  v_accvgpr_write_b32 a27, 0
  v_accvgpr_write_b32 a28, 0
  v_accvgpr_write_b32 a29, 0
  v_accvgpr_write_b32 a30, 0
  v_accvgpr_write_b32 a31, 0
  v_accvgpr_write_b32 a32, 0
  v_accvgpr_write_b32 a33, 0
  v_accvgpr_write_b32 a34, 0
  v_accvgpr_write_b32 a35, 0
  v_accvgpr_write_b32 a36, 0
  v_accvgpr_write_b32 a37, 0
  v_accvgpr_write_b32 a38, 0
  v_accvgpr_write_b32 a39, 0
  v_accvgpr_write_b32 a40, 0
  v_accvgpr_write_b32 a41, 0
  v_accvgpr_write_b32 a42, 0
  v_accvgpr_write_b32 a43, 0
  v_accvgpr_write_b32 a44, 0
  v_accvgpr_write_b32 a45, 0
  v_accvgpr_write_b32 a46, 0
  v_accvgpr_write_b32 a47, 0
  v_mov_b32 v160, 0
  v_mov_b32 v161, 0
  v_mov_b32 v162, 0
  v_mov_b32 v163, 0
  v_mov_b32 v164, 0
  v_mov_b32 v165, 0
  v_mov_b32 v166, 0
  v_mov_b32 v167, 0
  v_mov_b32 v168, 0
  v_mov_b32 v169, 0
  v_mov_b32 v170, 0
  v_mov_b32 v171, 0
  v_mov_b32 v172, 0
  v_mov_b32 v173, 0
  v_mov_b32 v174, 0
  v_mov_b32 v175, 0
  v_mov_b32 v176, 0
  v_mov_b32 v177, 0
  v_mov_b32 v178, 0
  v_mov_b32 v179, 0
  v_mov_b32 v180, 0
  v_mov_b32 v181, 0
  v_mov_b32 v182, 0
  v_mov_b32 v183, 0
  v_mov_b32 v184, 0
  v_mov_b32 v185, 0
  v_mov_b32 v186, 0
  v_mov_b32 v187, 0
  v_mov_b32 v188, 0
  v_mov_b32 v189, 0
  v_mov_b32 v190, 0
  v_mov_b32 v191, 0
  v_mov_b32 v192, 0
  v_mov_b32 v193, 0
  v_mov_b32 v194, 0
  v_mov_b32 v195, 0
  v_mov_b32 v196, 0
  v_mov_b32 v197, 0
  v_mov_b32 v198, 0
  v_mov_b32 v199, 0
  v_mov_b32 v200, 0
  v_mov_b32 v201, 0
  v_mov_b32 v202, 0
  v_mov_b32 v203, 0
  v_mov_b32 v204, 0
  v_mov_b32 v205, 0
  v_mov_b32 v206, 0
  v_mov_b32 v207, 0
  v_mov_b32 v208, 0
  v_mov_b32 v209, 0
  v_mov_b32 v210, 0
  v_mov_b32 v211, 0
  v_mov_b32 v212, 0
  v_mov_b32 v213, 0
  v_mov_b32 v214, 0
  v_mov_b32 v215, 0
  v_mov_b32 v216, 0
  v_mov_b32 v217, 0
  v_mov_b32 v218, 0
  v_mov_b32 v219, 0
  v_mov_b32 v220, 0
  v_mov_b32 v221, 0
  v_mov_b32 v222, 0
  v_mov_b32 v223, 0
  v_mov_b32 v224, 0
  v_mov_b32 v225, 0
  v_mov_b32 v226, 0
  v_mov_b32 v227, 0
  v_mov_b32 v228, 0
  v_mov_b32 v229, 0
  v_mov_b32 v230, 0
  v_mov_b32 v231, 0
  v_mov_b32 v232, 0
  v_mov_b32 v233, 0
  v_mov_b32 v234, 0
  v_mov_b32 v235, 0
  v_mov_b32 v236, 0
  v_mov_b32 v237, 0
  v_mov_b32 v238, 0
  v_mov_b32 v239, 0
  v_mov_b32 v240, 0
  v_mov_b32 v241, 0
  v_mov_b32 v242, 0
  v_mov_b32 v243, 0
  v_mov_b32 v244, 0
  v_mov_b32 v245, 0
  v_mov_b32 v246, 0
  v_mov_b32 v247, 0
  v_mov_b32 v248, 0
  v_mov_b32 v249, 0
  v_mov_b32 v250, 0
  v_mov_b32 v251, 0
  v_mov_b32 v252, 0
  v_mov_b32 v253, 0
  v_mov_b32 v254, 0
  v_mov_b32 v255, 0
  v_mov_b32 v8, v4
  v_mov_b32 v9, v4
  v_mov_b32 v10, v4
  v_mov_b32 v11, v4
  s_lshl_b32 s57, s20, 20
  s_lshl_b32 s58, s56, 7
  s_lshl_b32 s59, s56, 1
  s_add_u32 s59, s59, 2
Lslow_7:
  s_add_u32 s35, s57, 0
  buffer_load_dwordx4 v[96:99], v1, s[12:15], s35 offen offset:0
  buffer_load_dwordx4 v[100:103], v1, s[12:15], s35 offen offset:1024
  buffer_load_dwordx4 v[104:107], v1, s[12:15], s35 offen offset:2048
  buffer_load_dwordx4 v[108:111], v1, s[12:15], s35 offen offset:3072
  s_add_u32 s35, s57, 4096
  buffer_load_dwordx4 v[112:115], v1, s[12:15], s35 offen offset:0
  buffer_load_dwordx4 v[116:119], v1, s[12:15], s35 offen offset:1024
  buffer_load_dwordx4 v[120:123], v1, s[12:15], s35 offen offset:2048
  buffer_load_dwordx4 v[124:127], v1, s[12:15], s35 offen offset:3072
  s_add_u32 s35, s57, 8192
  buffer_load_dwordx4 v[128:131], v1, s[12:15], s35 offen offset:0
  buffer_load_dwordx4 v[132:135], v1, s[12:15], s35 offen offset:1024
  buffer_load_dwordx4 v[136:139], v1, s[12:15], s35 offen offset:2048
  buffer_load_dwordx4 v[140:143], v1, s[12:15], s35 offen offset:3072
  s_add_u32 s35, s57, 12288
  buffer_load_dwordx4 v[144:147], v1, s[12:15], s35 offen offset:0
  buffer_load_dwordx4 v[148:151], v1, s[12:15], s35 offen offset:1024
  buffer_load_dwordx4 v[152:155], v1, s[12:15], s35 offen offset:2048
  buffer_load_dwordx4 v[156:159], v1, s[12:15], s35 offen offset:3072
  s_lshl_b32 s33, s23, 6
  s_add_i32 s33, s33, s58
  s_cmp_gt_i32 s33, 0
  s_cselect_b32 s34, 0, 0xf149f2ca
  s_cmp_lt_i32 s33, 0
  s_cselect_b32 s33, 0xf149f2ca, 0
  v_mov_b32 v20, s34
  v_mov_b32 v21, s34
  v_mov_b32 v22, s34
  v_mov_b32 v23, s34
  v_mov_b32 v28, s33
  v_mov_b32 v29, s33
  v_mov_b32 v30, s33
  v_mov_b32 v31, s33
  v_med3_f32 v24, v16, v20, v28
  v_med3_f32 v25, v17, v20, v28
  v_med3_f32 v26, v18, v20, v28
  v_med3_f32 v27, v19, v20, v28
  s_waitcnt vmcnt(0)
  s_nop 0
  v_mfma_f32_16x16x32_bf16 v[32:35], v[96:99], a[52:55], v[24:27]
  v_mfma_f32_16x16x32_bf16 v[32:35], v[100:103], a[56:59], v[32:35]
  v_mfma_f32_16x16x32_bf16 v[32:35], v[104:107], a[60:63], v[32:35]
  v_mfma_f32_16x16x32_bf16 v[32:35], v[108:111], a[64:67], v[32:35]
  v_mfma_f32_16x16x32_bf16 v[36:39], v[96:99], a[68:71], v[28:31]
  v_mfma_f32_16x16x32_bf16 v[36:39], v[100:103], a[72:75], v[36:39]
  v_mfma_f32_16x16x32_bf16 v[36:39], v[104:107], a[76:79], v[36:39]
  v_mfma_f32_16x16x32_bf16 v[36:39], v[108:111], a[80:83], v[36:39]
  v_mfma_f32_16x16x32_bf16 v[40:43], v[96:99], a[84:87], v[28:31]
  v_mfma_f32_16x16x32_bf16 v[40:43], v[100:103], a[88:91], v[40:43]
  v_mfma_f32_16x16x32_bf16 v[40:43], v[104:107], a[92:95], v[40:43]
  v_mfma_f32_16x16x32_bf16 v[40:43], v[108:111], a[96:99], v[40:43]
  v_mfma_f32_16x16x32_bf16 v[44:47], v[96:99], a[100:103], v[28:31]
  v_mfma_f32_16x16x32_bf16 v[44:47], v[100:103], a[104:107], v[44:47]
  v_mfma_f32_16x16x32_bf16 v[44:47], v[104:107], a[108:111], v[44:47]
  v_mfma_f32_16x16x32_bf16 v[44:47], v[108:111], a[112:115], v[44:47]
  v_mfma_f32_16x16x32_bf16 v[48:51], v[112:115], a[52:55], v[20:23]
  v_mfma_f32_16x16x32_bf16 v[48:51], v[116:119], a[56:59], v[48:51]
  v_mfma_f32_16x16x32_bf16 v[48:51], v[120:123], a[60:63], v[48:51]
  v_mfma_f32_16x16x32_bf16 v[48:51], v[124:127], a[64:67], v[48:51]
  v_mfma_f32_16x16x32_bf16 v[52:55], v[112:115], a[68:71], v[24:27]
  v_mfma_f32_16x16x32_bf16 v[52:55], v[116:119], a[72:75], v[52:55]
  v_mfma_f32_16x16x32_bf16 v[52:55], v[120:123], a[76:79], v[52:55]
  v_mfma_f32_16x16x32_bf16 v[52:55], v[124:127], a[80:83], v[52:55]
  v_mfma_f32_16x16x32_bf16 v[56:59], v[112:115], a[84:87], v[28:31]
  v_mfma_f32_16x16x32_bf16 v[56:59], v[116:119], a[88:91], v[56:59]
  v_mfma_f32_16x16x32_bf16 v[56:59], v[120:123], a[92:95], v[56:59]
  v_mfma_f32_16x16x32_bf16 v[56:59], v[124:127], a[96:99], v[56:59]
  v_mfma_f32_16x16x32_bf16 v[60:63], v[112:115], a[100:103], v[28:31]
  v_mfma_f32_16x16x32_bf16 v[60:63], v[116:119], a[104:107], v[60:63]
  v_mfma_f32_16x16x32_bf16 v[60:63], v[120:123], a[108:111], v[60:63]
  v_mfma_f32_16x16x32_bf16 v[60:63], v[124:127], a[112:115], v[60:63]
  v_mfma_f32_16x16x32_bf16 v[64:67], v[128:131], a[52:55], v[20:23]
  v_mfma_f32_16x16x32_bf16 v[64:67], v[132:135], a[56:59], v[64:67]
  v_mfma_f32_16x16x32_bf16 v[64:67], v[136:139], a[60:63], v[64:67]
  v_mfma_f32_16x16x32_bf16 v[64:67], v[140:143], a[64:67], v[64:67]
  v_mfma_f32_16x16x32_bf16 v[68:71], v[128:131], a[68:71], v[20:23]
  v_mfma_f32_16x16x32_bf16 v[68:71], v[132:135], a[72:75], v[68:71]
  v_mfma_f32_16x16x32_bf16 v[68:71], v[136:139], a[76:79], v[68:71]
  v_mfma_f32_16x16x32_bf16 v[68:71], v[140:143], a[80:83], v[68:71]
  v_mfma_f32_16x16x32_bf16 v[72:75], v[128:131], a[84:87], v[24:27]
  v_mfma_f32_16x16x32_bf16 v[72:75], v[132:135], a[88:91], v[72:75]
  v_mfma_f32_16x16x32_bf16 v[72:75], v[136:139], a[92:95], v[72:75]
  v_mfma_f32_16x16x32_bf16 v[72:75], v[140:143], a[96:99], v[72:75]
  v_mfma_f32_16x16x32_bf16 v[76:79], v[128:131], a[100:103], v[28:31]
  v_mfma_f32_16x16x32_bf16 v[76:79], v[132:135], a[104:107], v[76:79]
  v_mfma_f32_16x16x32_bf16 v[76:79], v[136:139], a[108:111], v[76:79]
  v_mfma_f32_16x16x32_bf16 v[76:79], v[140:143], a[112:115], v[76:79]
  v_mfma_f32_16x16x32_bf16 v[80:83], v[144:147], a[52:55], v[20:23]
  v_mfma_f32_16x16x32_bf16 v[80:83], v[148:151], a[56:59], v[80:83]
  v_mfma_f32_16x16x32_bf16 v[80:83], v[152:155], a[60:63], v[80:83]
  v_mfma_f32_16x16x32_bf16 v[80:83], v[156:159], a[64:67], v[80:83]
  v_mfma_f32_16x16x32_bf16 v[84:87], v[144:147], a[68:71], v[20:23]
  v_mfma_f32_16x16x32_bf16 v[84:87], v[148:151], a[72:75], v[84:87]
  v_mfma_f32_16x16x32_bf16 v[84:87], v[152:155], a[76:79], v[84:87]
  v_mfma_f32_16x16x32_bf16 v[84:87], v[156:159], a[80:83], v[84:87]
  v_mfma_f32_16x16x32_bf16 v[88:91], v[144:147], a[84:87], v[20:23]
  v_mfma_f32_16x16x32_bf16 v[88:91], v[148:151], a[88:91], v[88:91]
  v_mfma_f32_16x16x32_bf16 v[88:91], v[152:155], a[92:95], v[88:91]
  v_mfma_f32_16x16x32_bf16 v[88:91], v[156:159], a[96:99], v[88:91]
  v_mfma_f32_16x16x32_bf16 v[92:95], v[144:147], a[100:103], v[24:27]
  v_mfma_f32_16x16x32_bf16 v[92:95], v[148:151], a[104:107], v[92:95]
  v_mfma_f32_16x16x32_bf16 v[92:95], v[152:155], a[108:111], v[92:95]
  v_mfma_f32_16x16x32_bf16 v[92:95], v[156:159], a[112:115], v[92:95]
  s_nop 7
  s_add_u32 s35, s57, 16384
  buffer_load_dwordx4 v[96:99], v1, s[12:15], s35 offen offset:0
  buffer_load_dwordx4 v[100:103], v1, s[12:15], s35 offen offset:1024
  buffer_load_dwordx4 v[104:107], v1, s[12:15], s35 offen offset:2048
  buffer_load_dwordx4 v[108:111], v1, s[12:15], s35 offen offset:3072
  s_add_u32 s35, s57, 20480
  buffer_load_dwordx4 v[112:115], v1, s[12:15], s35 offen offset:0
  buffer_load_dwordx4 v[116:119], v1, s[12:15], s35 offen offset:1024
  buffer_load_dwordx4 v[120:123], v1, s[12:15], s35 offen offset:2048
  buffer_load_dwordx4 v[124:127], v1, s[12:15], s35 offen offset:3072
  s_add_u32 s35, s57, 24576
  buffer_load_dwordx4 v[128:131], v1, s[12:15], s35 offen offset:0
  buffer_load_dwordx4 v[132:135], v1, s[12:15], s35 offen offset:1024
  buffer_load_dwordx4 v[136:139], v1, s[12:15], s35 offen offset:2048
  buffer_load_dwordx4 v[140:143], v1, s[12:15], s35 offen offset:3072
  s_add_u32 s35, s57, 28672
  buffer_load_dwordx4 v[144:147], v1, s[12:15], s35 offen offset:0
  buffer_load_dwordx4 v[148:151], v1, s[12:15], s35 offen offset:1024
  buffer_load_dwordx4 v[152:155], v1, s[12:15], s35 offen offset:2048
  buffer_load_dwordx4 v[156:159], v1, s[12:15], s35 offen offset:3072
  v_max3_f32 v13, v32, v33, v8
  v_max3_f32 v13, v13, v34, v35
  v_max3_f32 v13, v13, v48, v49
  v_max3_f32 v13, v13, v50, v51
  v_max3_f32 v13, v13, v64, v65
  v_max3_f32 v13, v13, v66, v67
  v_max3_f32 v13, v13, v80, v81
  v_max3_f32 v13, v13, v82, v83
  v_mov_b32 v14, v13
  s_nop 1
  v_permlane16_swap_b32 v13, v14
  v_max_f32 v13, v13, v14
  v_mov_b32 v14, v13
  s_nop 1
  v_permlane32_swap_b32 v13, v14
  v_max_f32 v13, v13, v14
  v_sub_f32 v12, v8, v13
  v_exp_f32 v12, v12
  v_mov_b32 v8, v13
  v_sub_f32 v32, v32, v13
  v_sub_f32 v33, v33, v13
  v_sub_f32 v34, v34, v13
  v_sub_f32 v35, v35, v13
  v_sub_f32 v48, v48, v13
  v_sub_f32 v49, v49, v13
  v_sub_f32 v50, v50, v13
  v_sub_f32 v51, v51, v13
  v_sub_f32 v64, v64, v13
  v_sub_f32 v65, v65, v13
  v_sub_f32 v66, v66, v13
  v_sub_f32 v67, v67, v13
  v_sub_f32 v80, v80, v13
  v_sub_f32 v81, v81, v13
  v_sub_f32 v82, v82, v13
  v_sub_f32 v83, v83, v13
  v_mul_f32 v160, v160, v12
  v_mul_f32 v161, v161, v12
  v_mul_f32 v162, v162, v12
  v_mul_f32 v163, v163, v12
  v_mul_f32 v176, v176, v12
  v_mul_f32 v177, v177, v12
  v_mul_f32 v178, v178, v12
  v_mul_f32 v179, v179, v12
  v_mul_f32 v192, v192, v12
  v_mul_f32 v193, v193, v12
  v_mul_f32 v194, v194, v12
  v_mul_f32 v195, v195, v12
  v_mul_f32 v208, v208, v12
  v_mul_f32 v209, v209, v12
  v_mul_f32 v210, v210, v12
  v_mul_f32 v211, v211, v12
  v_mul_f32 v224, v224, v12
  v_mul_f32 v225, v225, v12
  v_mul_f32 v226, v226, v12
  v_mul_f32 v227, v227, v12
  v_mul_f32 v240, v240, v12
  v_mul_f32 v241, v241, v12
  v_mul_f32 v242, v242, v12
  v_mul_f32 v243, v243, v12
  v_accvgpr_read_b32 v14, a0
  v_mul_f32 v14, v14, v12
  v_accvgpr_write_b32 a0, v14
  v_accvgpr_read_b32 v14, a1
  v_mul_f32 v14, v14, v12
  v_accvgpr_write_b32 a1, v14
  v_accvgpr_read_b32 v14, a2
  v_mul_f32 v14, v14, v12
  v_accvgpr_write_b32 a2, v14
  v_accvgpr_read_b32 v14, a3
  v_mul_f32 v14, v14, v12
  v_accvgpr_write_b32 a3, v14
  v_accvgpr_read_b32 v14, a16
  v_mul_f32 v14, v14, v12
  v_accvgpr_write_b32 a16, v14
  v_accvgpr_read_b32 v14, a17
  v_mul_f32 v14, v14, v12
  v_accvgpr_write_b32 a17, v14
  v_accvgpr_read_b32 v14, a18
  v_mul_f32 v14, v14, v12
  v_accvgpr_write_b32 a18, v14
  v_accvgpr_read_b32 v14, a19
  v_mul_f32 v14, v14, v12
  v_accvgpr_write_b32 a19, v14
  v_accvgpr_read_b32 v14, a32
  v_mul_f32 v14, v14, v12
  v_accvgpr_write_b32 a32, v14
  v_accvgpr_read_b32 v14, a33
  v_mul_f32 v14, v14, v12
  v_accvgpr_write_b32 a33, v14
  v_accvgpr_read_b32 v14, a34
  v_mul_f32 v14, v14, v12
  v_accvgpr_write_b32 a34, v14
  v_accvgpr_read_b32 v14, a35
  v_mul_f32 v14, v14, v12
  v_accvgpr_write_b32 a35, v14
  v_max3_f32 v13, v36, v37, v9
  v_max3_f32 v13, v13, v38, v39
  v_max3_f32 v13, v13, v52, v53
  v_max3_f32 v13, v13, v54, v55
  v_max3_f32 v13, v13, v68, v69
  v_max3_f32 v13, v13, v70, v71
  v_max3_f32 v13, v13, v84, v85
  v_max3_f32 v13, v13, v86, v87
  v_mov_b32 v14, v13
  s_nop 1
  v_permlane16_swap_b32 v13, v14
  v_max_f32 v13, v13, v14
  v_mov_b32 v14, v13
  s_nop 1
  v_permlane32_swap_b32 v13, v14
  v_max_f32 v13, v13, v14
  v_sub_f32 v12, v9, v13
  v_exp_f32 v12, v12
  v_mov_b32 v9, v13
  v_sub_f32 v36, v36, v13
  v_sub_f32 v37, v37, v13
  v_sub_f32 v38, v38, v13
  v_sub_f32 v39, v39, v13
  v_sub_f32 v52, v52, v13
  v_sub_f32 v53, v53, v13
  v_sub_f32 v54, v54, v13
  v_sub_f32 v55, v55, v13
  v_sub_f32 v68, v68, v13
  v_sub_f32 v69, v69, v13
  v_sub_f32 v70, v70, v13
  v_sub_f32 v71, v71, v13
  v_sub_f32 v84, v84, v13
  v_sub_f32 v85, v85, v13
  v_sub_f32 v86, v86, v13
  v_sub_f32 v87, v87, v13
  v_mul_f32 v164, v164, v12
  v_mul_f32 v165, v165, v12
  v_mul_f32 v166, v166, v12
  v_mul_f32 v167, v167, v12
  v_mul_f32 v180, v180, v12
  v_mul_f32 v181, v181, v12
  v_mul_f32 v182, v182, v12
  v_mul_f32 v183, v183, v12
  v_mul_f32 v196, v196, v12
  v_mul_f32 v197, v197, v12
  v_mul_f32 v198, v198, v12
  v_mul_f32 v199, v199, v12
  v_mul_f32 v212, v212, v12
  v_mul_f32 v213, v213, v12
  v_mul_f32 v214, v214, v12
  v_mul_f32 v215, v215, v12
  v_mul_f32 v228, v228, v12
  v_mul_f32 v229, v229, v12
  v_mul_f32 v230, v230, v12
  v_mul_f32 v231, v231, v12
  v_mul_f32 v244, v244, v12
  v_mul_f32 v245, v245, v12
  v_mul_f32 v246, v246, v12
  v_mul_f32 v247, v247, v12
  v_accvgpr_read_b32 v14, a4
  v_mul_f32 v14, v14, v12
  v_accvgpr_write_b32 a4, v14
  v_accvgpr_read_b32 v14, a5
  v_mul_f32 v14, v14, v12
  v_accvgpr_write_b32 a5, v14
  v_accvgpr_read_b32 v14, a6
  v_mul_f32 v14, v14, v12
  v_accvgpr_write_b32 a6, v14
  v_accvgpr_read_b32 v14, a7
  v_mul_f32 v14, v14, v12
  v_accvgpr_write_b32 a7, v14
  v_accvgpr_read_b32 v14, a20
  v_mul_f32 v14, v14, v12
  v_accvgpr_write_b32 a20, v14
  v_accvgpr_read_b32 v14, a21
  v_mul_f32 v14, v14, v12
  v_accvgpr_write_b32 a21, v14
  v_accvgpr_read_b32 v14, a22
  v_mul_f32 v14, v14, v12
  v_accvgpr_write_b32 a22, v14
  v_accvgpr_read_b32 v14, a23
  v_mul_f32 v14, v14, v12
  v_accvgpr_write_b32 a23, v14
  v_accvgpr_read_b32 v14, a36
  v_mul_f32 v14, v14, v12
  v_accvgpr_write_b32 a36, v14
  v_accvgpr_read_b32 v14, a37
  v_mul_f32 v14, v14, v12
  v_accvgpr_write_b32 a37, v14
  v_accvgpr_read_b32 v14, a38
  v_mul_f32 v14, v14, v12
  v_accvgpr_write_b32 a38, v14
  v_accvgpr_read_b32 v14, a39
  v_mul_f32 v14, v14, v12
  v_accvgpr_write_b32 a39, v14
  v_max3_f32 v13, v40, v41, v10
  v_max3_f32 v13, v13, v42, v43
  v_max3_f32 v13, v13, v56, v57
  v_max3_f32 v13, v13, v58, v59
  v_max3_f32 v13, v13, v72, v73
  v_max3_f32 v13, v13, v74, v75
  v_max3_f32 v13, v13, v88, v89
  v_max3_f32 v13, v13, v90, v91
  v_mov_b32 v14, v13
  s_nop 1
  v_permlane16_swap_b32 v13, v14
  v_max_f32 v13, v13, v14
  v_mov_b32 v14, v13
  s_nop 1
  v_permlane32_swap_b32 v13, v14
  v_max_f32 v13, v13, v14
  v_sub_f32 v12, v10, v13
  v_exp_f32 v12, v12
  v_mov_b32 v10, v13
  v_sub_f32 v40, v40, v13
  v_sub_f32 v41, v41, v13
  v_sub_f32 v42, v42, v13
  v_sub_f32 v43, v43, v13
  v_sub_f32 v56, v56, v13
  v_sub_f32 v57, v57, v13
  v_sub_f32 v58, v58, v13
  v_sub_f32 v59, v59, v13
  v_sub_f32 v72, v72, v13
  v_sub_f32 v73, v73, v13
  v_sub_f32 v74, v74, v13
  v_sub_f32 v75, v75, v13
  v_sub_f32 v88, v88, v13
  v_sub_f32 v89, v89, v13
  v_sub_f32 v90, v90, v13
  v_sub_f32 v91, v91, v13
  v_mul_f32 v168, v168, v12
  v_mul_f32 v169, v169, v12
  v_mul_f32 v170, v170, v12
  v_mul_f32 v171, v171, v12
  v_mul_f32 v184, v184, v12
  v_mul_f32 v185, v185, v12
  v_mul_f32 v186, v186, v12
  v_mul_f32 v187, v187, v12
  v_mul_f32 v200, v200, v12
  v_mul_f32 v201, v201, v12
  v_mul_f32 v202, v202, v12
  v_mul_f32 v203, v203, v12
  v_mul_f32 v216, v216, v12
  v_mul_f32 v217, v217, v12
  v_mul_f32 v218, v218, v12
  v_mul_f32 v219, v219, v12
  v_mul_f32 v232, v232, v12
  v_mul_f32 v233, v233, v12
  v_mul_f32 v234, v234, v12
  v_mul_f32 v235, v235, v12
  v_mul_f32 v248, v248, v12
  v_mul_f32 v249, v249, v12
  v_mul_f32 v250, v250, v12
  v_mul_f32 v251, v251, v12
  v_accvgpr_read_b32 v14, a8
  v_mul_f32 v14, v14, v12
  v_accvgpr_write_b32 a8, v14
  v_accvgpr_read_b32 v14, a9
  v_mul_f32 v14, v14, v12
  v_accvgpr_write_b32 a9, v14
  v_accvgpr_read_b32 v14, a10
  v_mul_f32 v14, v14, v12
  v_accvgpr_write_b32 a10, v14
  v_accvgpr_read_b32 v14, a11
  v_mul_f32 v14, v14, v12
  v_accvgpr_write_b32 a11, v14
  v_accvgpr_read_b32 v14, a24
  v_mul_f32 v14, v14, v12
  v_accvgpr_write_b32 a24, v14
  v_accvgpr_read_b32 v14, a25
  v_mul_f32 v14, v14, v12
  v_accvgpr_write_b32 a25, v14
  v_accvgpr_read_b32 v14, a26
  v_mul_f32 v14, v14, v12
  v_accvgpr_write_b32 a26, v14
  v_accvgpr_read_b32 v14, a27
  v_mul_f32 v14, v14, v12
  v_accvgpr_write_b32 a27, v14
  v_accvgpr_read_b32 v14, a40
  v_mul_f32 v14, v14, v12
  v_accvgpr_write_b32 a40, v14
  v_accvgpr_read_b32 v14, a41
  v_mul_f32 v14, v14, v12
  v_accvgpr_write_b32 a41, v14
  v_accvgpr_read_b32 v14, a42
  v_mul_f32 v14, v14, v12
  v_accvgpr_write_b32 a42, v14
  v_accvgpr_read_b32 v14, a43
  v_mul_f32 v14, v14, v12
  v_accvgpr_write_b32 a43, v14
  v_max3_f32 v13, v44, v45, v11
  v_max3_f32 v13, v13, v46, v47
  v_max3_f32 v13, v13, v60, v61
  v_max3_f32 v13, v13, v62, v63
  v_max3_f32 v13, v13, v76, v77
  v_max3_f32 v13, v13, v78, v79
  v_max3_f32 v13, v13, v92, v93
  v_max3_f32 v13, v13, v94, v95
  v_mov_b32 v14, v13
  s_nop 1
  v_permlane16_swap_b32 v13, v14
  v_max_f32 v13, v13, v14
  v_mov_b32 v14, v13
  s_nop 1
  v_permlane32_swap_b32 v13, v14
  v_max_f32 v13, v13, v14
  v_sub_f32 v12, v11, v13
  v_exp_f32 v12, v12
  v_mov_b32 v11, v13
  v_sub_f32 v44, v44, v13
  v_sub_f32 v45, v45, v13
  v_sub_f32 v46, v46, v13
  v_sub_f32 v47, v47, v13
  v_sub_f32 v60, v60, v13
  v_sub_f32 v61, v61, v13
  v_sub_f32 v62, v62, v13
  v_sub_f32 v63, v63, v13
  v_sub_f32 v76, v76, v13
  v_sub_f32 v77, v77, v13
  v_sub_f32 v78, v78, v13
  v_sub_f32 v79, v79, v13
  v_sub_f32 v92, v92, v13
  v_sub_f32 v93, v93, v13
  v_sub_f32 v94, v94, v13
  v_sub_f32 v95, v95, v13
  v_mul_f32 v172, v172, v12
  v_mul_f32 v173, v173, v12
  v_mul_f32 v174, v174, v12
  v_mul_f32 v175, v175, v12
  v_mul_f32 v188, v188, v12
  v_mul_f32 v189, v189, v12
  v_mul_f32 v190, v190, v12
  v_mul_f32 v191, v191, v12
  v_mul_f32 v204, v204, v12
  v_mul_f32 v205, v205, v12
  v_mul_f32 v206, v206, v12
  v_mul_f32 v207, v207, v12
  v_mul_f32 v220, v220, v12
  v_mul_f32 v221, v221, v12
  v_mul_f32 v222, v222, v12
  v_mul_f32 v223, v223, v12
  v_mul_f32 v236, v236, v12
  v_mul_f32 v237, v237, v12
  v_mul_f32 v238, v238, v12
  v_mul_f32 v239, v239, v12
  v_mul_f32 v252, v252, v12
  v_mul_f32 v253, v253, v12
  v_mul_f32 v254, v254, v12
  v_mul_f32 v255, v255, v12
  v_accvgpr_read_b32 v14, a12
  v_mul_f32 v14, v14, v12
  v_accvgpr_write_b32 a12, v14
  v_accvgpr_read_b32 v14, a13
  v_mul_f32 v14, v14, v12
  v_accvgpr_write_b32 a13, v14
  v_accvgpr_read_b32 v14, a14
  v_mul_f32 v14, v14, v12
  v_accvgpr_write_b32 a14, v14
  v_accvgpr_read_b32 v14, a15
  v_mul_f32 v14, v14, v12
  v_accvgpr_write_b32 a15, v14
  v_accvgpr_read_b32 v14, a28
  v_mul_f32 v14, v14, v12
  v_accvgpr_write_b32 a28, v14
  v_accvgpr_read_b32 v14, a29
  v_mul_f32 v14, v14, v12
  v_accvgpr_write_b32 a29, v14
  v_accvgpr_read_b32 v14, a30
  v_mul_f32 v14, v14, v12
  v_accvgpr_write_b32 a30, v14
  v_accvgpr_read_b32 v14, a31
  v_mul_f32 v14, v14, v12
  v_accvgpr_write_b32 a31, v14
  v_accvgpr_read_b32 v14, a44
  v_mul_f32 v14, v14, v12
  v_accvgpr_write_b32 a44, v14
  v_accvgpr_read_b32 v14, a45
  v_mul_f32 v14, v14, v12
  v_accvgpr_write_b32 a45, v14
  v_accvgpr_read_b32 v14, a46
  v_mul_f32 v14, v14, v12
  v_accvgpr_write_b32 a46, v14
  v_accvgpr_read_b32 v14, a47
  v_mul_f32 v14, v14, v12
  v_accvgpr_write_b32 a47, v14
  v_exp_f32 v32, v32
  v_exp_f32 v33, v33
  v_exp_f32 v34, v34
  v_exp_f32 v35, v35
  v_exp_f32 v48, v48
  v_exp_f32 v49, v49
  v_exp_f32 v50, v50
  v_exp_f32 v51, v51
  v_cvt_pk_bf16_f32 v32, v32, v33
  v_cvt_pk_bf16_f32 v33, v34, v35
  v_exp_f32 v36, v36
  v_exp_f32 v37, v37
  v_exp_f32 v38, v38
  v_exp_f32 v39, v39
  v_cvt_pk_bf16_f32 v34, v48, v49
  v_cvt_pk_bf16_f32 v35, v50, v51
  v_exp_f32 v52, v52
  v_exp_f32 v53, v53
  v_exp_f32 v54, v54
  v_exp_f32 v55, v55
  v_cvt_pk_bf16_f32 v36, v36, v37
  v_cvt_pk_bf16_f32 v37, v38, v39
  v_exp_f32 v40, v40
  v_exp_f32 v41, v41
  v_exp_f32 v42, v42
  v_exp_f32 v43, v43
  v_cvt_pk_bf16_f32 v38, v52, v53
  v_cvt_pk_bf16_f32 v39, v54, v55
  v_exp_f32 v56, v56
  v_exp_f32 v57, v57
  v_exp_f32 v58, v58
  v_exp_f32 v59, v59
  v_cvt_pk_bf16_f32 v40, v40, v41
  v_cvt_pk_bf16_f32 v41, v42, v43
  v_exp_f32 v44, v44
  v_exp_f32 v45, v45
  v_exp_f32 v46, v46
  v_exp_f32 v47, v47
  v_cvt_pk_bf16_f32 v42, v56, v57
  v_cvt_pk_bf16_f32 v43, v58, v59
  v_exp_f32 v60, v60
  v_exp_f32 v61, v61
  v_exp_f32 v62, v62
  v_exp_f32 v63, v63
  v_cvt_pk_bf16_f32 v44, v44, v45
  v_cvt_pk_bf16_f32 v45, v46, v47
  v_cvt_pk_bf16_f32 v46, v60, v61
  v_cvt_pk_bf16_f32 v47, v62, v63
  v_exp_f32 v64, v64
  v_exp_f32 v65, v65
  v_exp_f32 v66, v66
  v_exp_f32 v67, v67
  v_exp_f32 v80, v80
  v_exp_f32 v81, v81
  v_exp_f32 v82, v82
  v_exp_f32 v83, v83
  v_cvt_pk_bf16_f32 v64, v64, v65
  v_cvt_pk_bf16_f32 v65, v66, v67
  v_exp_f32 v68, v68
  v_exp_f32 v69, v69
  v_exp_f32 v70, v70
  v_exp_f32 v71, v71
  v_cvt_pk_bf16_f32 v66, v80, v81
  v_cvt_pk_bf16_f32 v67, v82, v83
  v_exp_f32 v84, v84
  v_exp_f32 v85, v85
  v_exp_f32 v86, v86
  v_exp_f32 v87, v87
  v_cvt_pk_bf16_f32 v68, v68, v69
  v_cvt_pk_bf16_f32 v69, v70, v71
  v_exp_f32 v72, v72
  v_exp_f32 v73, v73
  v_exp_f32 v74, v74
  v_exp_f32 v75, v75
  v_cvt_pk_bf16_f32 v70, v84, v85
  v_cvt_pk_bf16_f32 v71, v86, v87
  v_exp_f32 v88, v88
  v_exp_f32 v89, v89
  v_exp_f32 v90, v90
  v_exp_f32 v91, v91
  v_cvt_pk_bf16_f32 v72, v72, v73
  v_cvt_pk_bf16_f32 v73, v74, v75
  v_exp_f32 v76, v76
  v_exp_f32 v77, v77
  v_exp_f32 v78, v78
  v_exp_f32 v79, v79
  v_cvt_pk_bf16_f32 v74, v88, v89
  v_cvt_pk_bf16_f32 v75, v90, v91
  v_exp_f32 v92, v92
  v_exp_f32 v93, v93
  v_exp_f32 v94, v94
  v_exp_f32 v95, v95
  v_cvt_pk_bf16_f32 v76, v76, v77
  v_cvt_pk_bf16_f32 v77, v78, v79
  v_cvt_pk_bf16_f32 v78, v92, v93
  v_cvt_pk_bf16_f32 v79, v94, v95
  s_waitcnt vmcnt(0)
  v_mfma_f32_16x16x32_bf16 a[32:35], a[48:51], v[32:35], a[32:35]
  v_mfma_f32_16x16x32_bf16 a[36:39], a[48:51], v[36:39], a[36:39]
  v_mfma_f32_16x16x32_bf16 a[40:43], a[48:51], v[40:43], a[40:43]
  v_mfma_f32_16x16x32_bf16 a[44:47], a[48:51], v[44:47], a[44:47]
  v_mfma_f32_16x16x32_bf16 v[160:163], v[96:99], v[32:35], v[160:163]
  v_mfma_f32_16x16x32_bf16 v[164:167], v[96:99], v[36:39], v[164:167]
  v_mfma_f32_16x16x32_bf16 v[168:171], v[96:99], v[40:43], v[168:171]
  v_mfma_f32_16x16x32_bf16 v[172:175], v[96:99], v[44:47], v[172:175]
  v_mfma_f32_16x16x32_bf16 v[176:179], v[100:103], v[32:35], v[176:179]
  v_mfma_f32_16x16x32_bf16 v[180:183], v[100:103], v[36:39], v[180:183]
  v_mfma_f32_16x16x32_bf16 v[184:187], v[100:103], v[40:43], v[184:187]
  v_mfma_f32_16x16x32_bf16 v[188:191], v[100:103], v[44:47], v[188:191]
  v_mfma_f32_16x16x32_bf16 v[192:195], v[104:107], v[32:35], v[192:195]
  v_mfma_f32_16x16x32_bf16 v[196:199], v[104:107], v[36:39], v[196:199]
  v_mfma_f32_16x16x32_bf16 v[200:203], v[104:107], v[40:43], v[200:203]
  v_mfma_f32_16x16x32_bf16 v[204:207], v[104:107], v[44:47], v[204:207]
  v_mfma_f32_16x16x32_bf16 v[208:211], v[108:111], v[32:35], v[208:211]
  v_mfma_f32_16x16x32_bf16 v[212:215], v[108:111], v[36:39], v[212:215]
  v_mfma_f32_16x16x32_bf16 v[216:219], v[108:111], v[40:43], v[216:219]
  v_mfma_f32_16x16x32_bf16 v[220:223], v[108:111], v[44:47], v[220:223]
  v_mfma_f32_16x16x32_bf16 v[224:227], v[112:115], v[32:35], v[224:227]
  v_mfma_f32_16x16x32_bf16 v[228:231], v[112:115], v[36:39], v[228:231]
  v_mfma_f32_16x16x32_bf16 v[232:235], v[112:115], v[40:43], v[232:235]
  v_mfma_f32_16x16x32_bf16 v[236:239], v[112:115], v[44:47], v[236:239]
  v_mfma_f32_16x16x32_bf16 v[240:243], v[116:119], v[32:35], v[240:243]
  v_mfma_f32_16x16x32_bf16 v[244:247], v[116:119], v[36:39], v[244:247]
  v_mfma_f32_16x16x32_bf16 v[248:251], v[116:119], v[40:43], v[248:251]
  v_mfma_f32_16x16x32_bf16 v[252:255], v[116:119], v[44:47], v[252:255]
  v_mfma_f32_16x16x32_bf16 a[0:3], v[120:123], v[32:35], a[0:3]
  v_mfma_f32_16x16x32_bf16 a[4:7], v[120:123], v[36:39], a[4:7]
  v_mfma_f32_16x16x32_bf16 a[8:11], v[120:123], v[40:43], a[8:11]
  v_mfma_f32_16x16x32_bf16 a[12:15], v[120:123], v[44:47], a[12:15]
  v_mfma_f32_16x16x32_bf16 a[16:19], v[124:127], v[32:35], a[16:19]
  v_mfma_f32_16x16x32_bf16 a[20:23], v[124:127], v[36:39], a[20:23]
  v_mfma_f32_16x16x32_bf16 a[24:27], v[124:127], v[40:43], a[24:27]
  v_mfma_f32_16x16x32_bf16 a[28:31], v[124:127], v[44:47], a[28:31]
  v_mfma_f32_16x16x32_bf16 a[32:35], a[48:51], v[64:67], a[32:35]
  v_mfma_f32_16x16x32_bf16 a[36:39], a[48:51], v[68:71], a[36:39]
  v_mfma_f32_16x16x32_bf16 a[40:43], a[48:51], v[72:75], a[40:43]
  v_mfma_f32_16x16x32_bf16 a[44:47], a[48:51], v[76:79], a[44:47]
  v_mfma_f32_16x16x32_bf16 v[160:163], v[128:131], v[64:67], v[160:163]
  v_mfma_f32_16x16x32_bf16 v[164:167], v[128:131], v[68:71], v[164:167]
  v_mfma_f32_16x16x32_bf16 v[168:171], v[128:131], v[72:75], v[168:171]
  v_mfma_f32_16x16x32_bf16 v[172:175], v[128:131], v[76:79], v[172:175]
  v_mfma_f32_16x16x32_bf16 v[176:179], v[132:135], v[64:67], v[176:179]
  v_mfma_f32_16x16x32_bf16 v[180:183], v[132:135], v[68:71], v[180:183]
  v_mfma_f32_16x16x32_bf16 v[184:187], v[132:135], v[72:75], v[184:187]
  v_mfma_f32_16x16x32_bf16 v[188:191], v[132:135], v[76:79], v[188:191]
  v_mfma_f32_16x16x32_bf16 v[192:195], v[136:139], v[64:67], v[192:195]
  v_mfma_f32_16x16x32_bf16 v[196:199], v[136:139], v[68:71], v[196:199]
  v_mfma_f32_16x16x32_bf16 v[200:203], v[136:139], v[72:75], v[200:203]
  v_mfma_f32_16x16x32_bf16 v[204:207], v[136:139], v[76:79], v[204:207]
  v_mfma_f32_16x16x32_bf16 v[208:211], v[140:143], v[64:67], v[208:211]
  v_mfma_f32_16x16x32_bf16 v[212:215], v[140:143], v[68:71], v[212:215]
  v_mfma_f32_16x16x32_bf16 v[216:219], v[140:143], v[72:75], v[216:219]
  v_mfma_f32_16x16x32_bf16 v[220:223], v[140:143], v[76:79], v[220:223]
  v_mfma_f32_16x16x32_bf16 v[224:227], v[144:147], v[64:67], v[224:227]
  v_mfma_f32_16x16x32_bf16 v[228:231], v[144:147], v[68:71], v[228:231]
  v_mfma_f32_16x16x32_bf16 v[232:235], v[144:147], v[72:75], v[232:235]
  v_mfma_f32_16x16x32_bf16 v[236:239], v[144:147], v[76:79], v[236:239]
  v_mfma_f32_16x16x32_bf16 v[240:243], v[148:151], v[64:67], v[240:243]
  v_mfma_f32_16x16x32_bf16 v[244:247], v[148:151], v[68:71], v[244:247]
  v_mfma_f32_16x16x32_bf16 v[248:251], v[148:151], v[72:75], v[248:251]
  v_mfma_f32_16x16x32_bf16 v[252:255], v[148:151], v[76:79], v[252:255]
  v_mfma_f32_16x16x32_bf16 a[0:3], v[152:155], v[64:67], a[0:3]
  v_mfma_f32_16x16x32_bf16 a[4:7], v[152:155], v[68:71], a[4:7]
  v_mfma_f32_16x16x32_bf16 a[8:11], v[152:155], v[72:75], a[8:11]
  v_mfma_f32_16x16x32_bf16 a[12:15], v[152:155], v[76:79], a[12:15]
  v_mfma_f32_16x16x32_bf16 a[16:19], v[156:159], v[64:67], a[16:19]
  v_mfma_f32_16x16x32_bf16 a[20:23], v[156:159], v[68:71], a[20:23]
  v_mfma_f32_16x16x32_bf16 a[24:27], v[156:159], v[72:75], a[24:27]
  v_mfma_f32_16x16x32_bf16 a[28:31], v[156:159], v[76:79], a[28:31]
  s_nop 7
  s_add_u32 s57, s57, 32768
  s_sub_u32 s58, s58, 64
  s_sub_u32 s59, s59, 1
  s_cmp_lg_u32 s59, 0
  s_cbranch_scc1 Lslow_7
  v_accvgpr_read_b32 v20, a32
  v_accvgpr_read_b32 v21, a36
  v_accvgpr_read_b32 v22, a40
  v_accvgpr_read_b32 v23, a44
  v_rcp_f32 v8, v20
  v_rcp_f32 v9, v21
  v_rcp_f32 v10, v22
  v_rcp_f32 v11, v23
  v_pk_mul_f32 v[160:161], v[160:161], v[8:9] op_sel:[0,0] op_sel_hi:[1,0]
  v_pk_mul_f32 v[162:163], v[162:163], v[8:9] op_sel:[0,0] op_sel_hi:[1,0]
  v_pk_mul_f32 v[176:177], v[176:177], v[8:9] op_sel:[0,0] op_sel_hi:[1,0]
  v_pk_mul_f32 v[178:179], v[178:179], v[8:9] op_sel:[0,0] op_sel_hi:[1,0]
  v_cvt_pk_bf16_f32 v160, v160, v161
  v_cvt_pk_bf16_f32 v161, v162, v163
  v_cvt_pk_bf16_f32 v162, v176, v177
  v_cvt_pk_bf16_f32 v163, v178, v179
  v_pk_mul_f32 v[164:165], v[164:165], v[8:9] op_sel:[0,1] op_sel_hi:[1,1]
  v_pk_mul_f32 v[166:167], v[166:167], v[8:9] op_sel:[0,1] op_sel_hi:[1,1]
  v_pk_mul_f32 v[180:181], v[180:181], v[8:9] op_sel:[0,1] op_sel_hi:[1,1]
  v_pk_mul_f32 v[182:183], v[182:183], v[8:9] op_sel:[0,1] op_sel_hi:[1,1]
  v_cvt_pk_bf16_f32 v164, v164, v165
  v_cvt_pk_bf16_f32 v165, v166, v167
  v_cvt_pk_bf16_f32 v166, v180, v181
  v_cvt_pk_bf16_f32 v167, v182, v183
  v_pk_mul_f32 v[168:169], v[168:169], v[10:11] op_sel:[0,0] op_sel_hi:[1,0]
  v_pk_mul_f32 v[170:171], v[170:171], v[10:11] op_sel:[0,0] op_sel_hi:[1,0]
  v_pk_mul_f32 v[184:185], v[184:185], v[10:11] op_sel:[0,0] op_sel_hi:[1,0]
  v_pk_mul_f32 v[186:187], v[186:187], v[10:11] op_sel:[0,0] op_sel_hi:[1,0]
  v_cvt_pk_bf16_f32 v168, v168, v169
  v_cvt_pk_bf16_f32 v169, v170, v171
  v_cvt_pk_bf16_f32 v170, v184, v185
  v_cvt_pk_bf16_f32 v171, v186, v187
  v_pk_mul_f32 v[172:173], v[172:173], v[10:11] op_sel:[0,1] op_sel_hi:[1,1]
  v_pk_mul_f32 v[174:175], v[174:175], v[10:11] op_sel:[0,1] op_sel_hi:[1,1]
  v_pk_mul_f32 v[188:189], v[188:189], v[10:11] op_sel:[0,1] op_sel_hi:[1,1]
  v_pk_mul_f32 v[190:191], v[190:191], v[10:11] op_sel:[0,1] op_sel_hi:[1,1]
  v_cvt_pk_bf16_f32 v172, v172, v173
  v_cvt_pk_bf16_f32 v173, v174, v175
  v_cvt_pk_bf16_f32 v174, v188, v189
  v_cvt_pk_bf16_f32 v175, v190, v191
  v_pk_mul_f32 v[192:193], v[192:193], v[8:9] op_sel:[0,0] op_sel_hi:[1,0]
  v_pk_mul_f32 v[194:195], v[194:195], v[8:9] op_sel:[0,0] op_sel_hi:[1,0]
  v_pk_mul_f32 v[208:209], v[208:209], v[8:9] op_sel:[0,0] op_sel_hi:[1,0]
  v_pk_mul_f32 v[210:211], v[210:211], v[8:9] op_sel:[0,0] op_sel_hi:[1,0]
  v_cvt_pk_bf16_f32 v192, v192, v193
  v_cvt_pk_bf16_f32 v193, v194, v195
  v_cvt_pk_bf16_f32 v194, v208, v209
  v_cvt_pk_bf16_f32 v195, v210, v211
  v_pk_mul_f32 v[196:197], v[196:197], v[8:9] op_sel:[0,1] op_sel_hi:[1,1]
  v_pk_mul_f32 v[198:199], v[198:199], v[8:9] op_sel:[0,1] op_sel_hi:[1,1]
  v_pk_mul_f32 v[212:213], v[212:213], v[8:9] op_sel:[0,1] op_sel_hi:[1,1]
  v_pk_mul_f32 v[214:215], v[214:215], v[8:9] op_sel:[0,1] op_sel_hi:[1,1]
  v_cvt_pk_bf16_f32 v196, v196, v197
  v_cvt_pk_bf16_f32 v197, v198, v199
  v_cvt_pk_bf16_f32 v198, v212, v213
  v_cvt_pk_bf16_f32 v199, v214, v215
  v_pk_mul_f32 v[200:201], v[200:201], v[10:11] op_sel:[0,0] op_sel_hi:[1,0]
  v_pk_mul_f32 v[202:203], v[202:203], v[10:11] op_sel:[0,0] op_sel_hi:[1,0]
  v_pk_mul_f32 v[216:217], v[216:217], v[10:11] op_sel:[0,0] op_sel_hi:[1,0]
  v_pk_mul_f32 v[218:219], v[218:219], v[10:11] op_sel:[0,0] op_sel_hi:[1,0]
  v_cvt_pk_bf16_f32 v200, v200, v201
  v_cvt_pk_bf16_f32 v201, v202, v203
  v_cvt_pk_bf16_f32 v202, v216, v217
  v_cvt_pk_bf16_f32 v203, v218, v219
  v_pk_mul_f32 v[204:205], v[204:205], v[10:11] op_sel:[0,1] op_sel_hi:[1,1]
  v_pk_mul_f32 v[206:207], v[206:207], v[10:11] op_sel:[0,1] op_sel_hi:[1,1]
  v_pk_mul_f32 v[220:221], v[220:221], v[10:11] op_sel:[0,1] op_sel_hi:[1,1]
  v_pk_mul_f32 v[222:223], v[222:223], v[10:11] op_sel:[0,1] op_sel_hi:[1,1]
  v_cvt_pk_bf16_f32 v204, v204, v205
  v_cvt_pk_bf16_f32 v205, v206, v207
  v_cvt_pk_bf16_f32 v206, v220, v221
  v_cvt_pk_bf16_f32 v207, v222, v223
  v_pk_mul_f32 v[224:225], v[224:225], v[8:9] op_sel:[0,0] op_sel_hi:[1,0]
  v_pk_mul_f32 v[226:227], v[226:227], v[8:9] op_sel:[0,0] op_sel_hi:[1,0]
  v_pk_mul_f32 v[240:241], v[240:241], v[8:9] op_sel:[0,0] op_sel_hi:[1,0]
  v_pk_mul_f32 v[242:243], v[242:243], v[8:9] op_sel:[0,0] op_sel_hi:[1,0]
  v_cvt_pk_bf16_f32 v224, v224, v225
  v_cvt_pk_bf16_f32 v225, v226, v227
  v_cvt_pk_bf16_f32 v226, v240, v241
  v_cvt_pk_bf16_f32 v227, v242, v243
  v_pk_mul_f32 v[228:229], v[228:229], v[8:9] op_sel:[0,1] op_sel_hi:[1,1]
  v_pk_mul_f32 v[230:231], v[230:231], v[8:9] op_sel:[0,1] op_sel_hi:[1,1]
  v_pk_mul_f32 v[244:245], v[244:245], v[8:9] op_sel:[0,1] op_sel_hi:[1,1]
  v_pk_mul_f32 v[246:247], v[246:247], v[8:9] op_sel:[0,1] op_sel_hi:[1,1]
  v_cvt_pk_bf16_f32 v228, v228, v229
  v_cvt_pk_bf16_f32 v229, v230, v231
  v_cvt_pk_bf16_f32 v230, v244, v245
  v_cvt_pk_bf16_f32 v231, v246, v247
  v_pk_mul_f32 v[232:233], v[232:233], v[10:11] op_sel:[0,0] op_sel_hi:[1,0]
  v_pk_mul_f32 v[234:235], v[234:235], v[10:11] op_sel:[0,0] op_sel_hi:[1,0]
  v_pk_mul_f32 v[248:249], v[248:249], v[10:11] op_sel:[0,0] op_sel_hi:[1,0]
  v_pk_mul_f32 v[250:251], v[250:251], v[10:11] op_sel:[0,0] op_sel_hi:[1,0]
  v_cvt_pk_bf16_f32 v232, v232, v233
  v_cvt_pk_bf16_f32 v233, v234, v235
  v_cvt_pk_bf16_f32 v234, v248, v249
  v_cvt_pk_bf16_f32 v235, v250, v251
  v_pk_mul_f32 v[236:237], v[236:237], v[10:11] op_sel:[0,1] op_sel_hi:[1,1]
  v_pk_mul_f32 v[238:239], v[238:239], v[10:11] op_sel:[0,1] op_sel_hi:[1,1]
  v_pk_mul_f32 v[252:253], v[252:253], v[10:11] op_sel:[0,1] op_sel_hi:[1,1]
  v_pk_mul_f32 v[254:255], v[254:255], v[10:11] op_sel:[0,1] op_sel_hi:[1,1]
  v_cvt_pk_bf16_f32 v236, v236, v237
  v_cvt_pk_bf16_f32 v237, v238, v239
  v_cvt_pk_bf16_f32 v238, v252, v253
  v_cvt_pk_bf16_f32 v239, v254, v255
  v_accvgpr_read_b32 v176, a0
  v_accvgpr_read_b32 v177, a1
  v_accvgpr_read_b32 v178, a2
  v_accvgpr_read_b32 v179, a3
  v_accvgpr_read_b32 v180, a16
  v_accvgpr_read_b32 v181, a17
  v_accvgpr_read_b32 v182, a18
  v_accvgpr_read_b32 v183, a19
  v_pk_mul_f32 v[176:177], v[176:177], v[8:9] op_sel:[0,0] op_sel_hi:[1,0]
  v_pk_mul_f32 v[178:179], v[178:179], v[8:9] op_sel:[0,0] op_sel_hi:[1,0]
  v_pk_mul_f32 v[180:181], v[180:181], v[8:9] op_sel:[0,0] op_sel_hi:[1,0]
  v_pk_mul_f32 v[182:183], v[182:183], v[8:9] op_sel:[0,0] op_sel_hi:[1,0]
  v_cvt_pk_bf16_f32 v176, v176, v177
  v_cvt_pk_bf16_f32 v177, v178, v179
  v_cvt_pk_bf16_f32 v178, v180, v181
  v_cvt_pk_bf16_f32 v179, v182, v183
  v_accvgpr_read_b32 v184, a4
  v_accvgpr_read_b32 v185, a5
  v_accvgpr_read_b32 v186, a6
  v_accvgpr_read_b32 v187, a7
  v_accvgpr_read_b32 v188, a20
  v_accvgpr_read_b32 v189, a21
  v_accvgpr_read_b32 v190, a22
  v_accvgpr_read_b32 v191, a23
  v_pk_mul_f32 v[184:185], v[184:185], v[8:9] op_sel:[0,1] op_sel_hi:[1,1]
  v_pk_mul_f32 v[186:187], v[186:187], v[8:9] op_sel:[0,1] op_sel_hi:[1,1]
  v_pk_mul_f32 v[188:189], v[188:189], v[8:9] op_sel:[0,1] op_sel_hi:[1,1]
  v_pk_mul_f32 v[190:191], v[190:191], v[8:9] op_sel:[0,1] op_sel_hi:[1,1]
  v_cvt_pk_bf16_f32 v184, v184, v185
  v_cvt_pk_bf16_f32 v185, v186, v187
  v_cvt_pk_bf16_f32 v186, v188, v189
  v_cvt_pk_bf16_f32 v187, v190, v191
  v_accvgpr_read_b32 v208, a8
  v_accvgpr_read_b32 v209, a9
  v_accvgpr_read_b32 v210, a10
  v_accvgpr_read_b32 v211, a11
  v_accvgpr_read_b32 v212, a24
  v_accvgpr_read_b32 v213, a25
  v_accvgpr_read_b32 v214, a26
  v_accvgpr_read_b32 v215, a27
  v_pk_mul_f32 v[208:209], v[208:209], v[10:11] op_sel:[0,0] op_sel_hi:[1,0]
  v_pk_mul_f32 v[210:211], v[210:211], v[10:11] op_sel:[0,0] op_sel_hi:[1,0]
  v_pk_mul_f32 v[212:213], v[212:213], v[10:11] op_sel:[0,0] op_sel_hi:[1,0]
  v_pk_mul_f32 v[214:215], v[214:215], v[10:11] op_sel:[0,0] op_sel_hi:[1,0]
  v_cvt_pk_bf16_f32 v208, v208, v209
  v_cvt_pk_bf16_f32 v209, v210, v211
  v_cvt_pk_bf16_f32 v210, v212, v213
  v_cvt_pk_bf16_f32 v211, v214, v215
  v_accvgpr_read_b32 v216, a12
  v_accvgpr_read_b32 v217, a13
  v_accvgpr_read_b32 v218, a14
  v_accvgpr_read_b32 v219, a15
  v_accvgpr_read_b32 v220, a28
  v_accvgpr_read_b32 v221, a29
  v_accvgpr_read_b32 v222, a30
  v_accvgpr_read_b32 v223, a31
  v_pk_mul_f32 v[216:217], v[216:217], v[10:11] op_sel:[0,1] op_sel_hi:[1,1]
  v_pk_mul_f32 v[218:219], v[218:219], v[10:11] op_sel:[0,1] op_sel_hi:[1,1]
  v_pk_mul_f32 v[220:221], v[220:221], v[10:11] op_sel:[0,1] op_sel_hi:[1,1]
  v_pk_mul_f32 v[222:223], v[222:223], v[10:11] op_sel:[0,1] op_sel_hi:[1,1]
  v_cvt_pk_bf16_f32 v216, v216, v217
  v_cvt_pk_bf16_f32 v217, v218, v219
  v_cvt_pk_bf16_f32 v218, v220, v221
  v_cvt_pk_bf16_f32 v219, v222, v223
  s_lshl_b32 s33, s56, 20
  s_lshl_b32 s34, s20, 15
  s_add_u32 s33, s33, s34
  s_lshl_b32 s34, s23, 13
  s_add_u32 s36, s33, s34
  s_add_u32 s37, s36, 4096
  s_add_u32 s38, s36, 16384
  s_add_u32 s39, s36, 20480
  s_bitcmp1_b32 s61, 0
  s_cbranch_scc0 Lss_10
  buffer_store_dwordx4 v[160:163], v1, s[16:19], s36 offen offset:0
  buffer_store_dwordx4 v[164:167], v1, s[16:19], s36 offen offset:2048
  buffer_store_dwordx4 v[168:171], v1, s[16:19], s37 offen offset:0
  buffer_store_dwordx4 v[172:175], v1, s[16:19], s37 offen offset:2048
Lss_10:
  s_bitcmp1_b32 s61, 1
  s_cbranch_scc0 Lss_11
  buffer_store_dwordx4 v[192:195], v1, s[16:19], s36 offen offset:1024
  buffer_store_dwordx4 v[196:199], v1, s[16:19], s36 offen offset:3072
  buffer_store_dwordx4 v[200:203], v1, s[16:19], s37 offen offset:1024
  buffer_store_dwordx4 v[204:207], v1, s[16:19], s37 offen offset:3072
Lss_11:
  s_bitcmp1_b32 s61, 2
  s_cbranch_scc0 Lss_12
  buffer_store_dwordx4 v[224:227], v1, s[16:19], s38 offen offset:0
  buffer_store_dwordx4 v[228:231], v1, s[16:19], s38 offen offset:2048
  buffer_store_dwordx4 v[232:235], v1, s[16:19], s39 offen offset:0
  buffer_store_dwordx4 v[236:239], v1, s[16:19], s39 offen offset:2048
Lss_12:
  s_bitcmp1_b32 s61, 3
  s_cbranch_scc0 Lss_13
  buffer_store_dwordx4 v[176:179], v1, s[16:19], s38 offen offset:1024
  buffer_store_dwordx4 v[184:187], v1, s[16:19], s38 offen offset:3072
  buffer_store_dwordx4 v[208:211], v1, s[16:19], s39 offen offset:1024
  buffer_store_dwordx4 v[216:219], v1, s[16:19], s39 offen offset:3072
Lss_13:
  s_branch Lk2_chk
Lk2_done:
Lk2_end:
  s_endpgm
.globl k3_oproj_kernel
.p2align 8
.type k3_oproj_kernel,@function
k3_oproj_kernel:
  s_cmp_ge_u32 s2, 256
  s_cbranch_scc1 Lk3_end
  s_load_dwordx2 s[4:5], s[0:1], 40
  s_load_dwordx4 s[32:35], s[0:1], 64
  s_load_dwordx2 s[6:7], s[0:1], 88
  v_lshrrev_b32 v224, 6, v0
  s_nop 0
  v_readfirstlane_b32 s20, v224
  v_and_b32 v0, 63, v0
  v_lshlrev_b32 v1, 4, v0
  s_and_b32 s40, s2, 1
  s_bfe_u32 s3, s2, 0x10001
  s_lshl_b32 s3, s3, 3
  s_bfe_u32 s36, s2, 0x30003
  s_add_u32 s36, s3, s36
  s_lshl_b32 s29, s36, 7
  s_bfe_u32 s3, s2, 0x10002
  s_lshl_b32 s3, s3, 2
  s_lshr_b32 s37, s2, 6
  s_add_u32 s3, s3, s37
  s_lshl_b32 s25, s3, 8
  s_lshl_b32 s30, s3, 7
  s_lshl_b32 s3, s40, 6
  s_add_u32 s30, s30, s3
  s_lshl_b32 s41, s20, 12
  s_lshl_b32 s42, s20, 11
  s_lshl_b32 s23, s36, 20
  s_add_u32 s23, s23, s41
  s_lshr_b32 s3, s2, 1
  s_lshr_b32 s38, s2, 2
  s_xor_b32 s3, s3, s38
  s_and_b32 s3, s3, 1
  s_lshl_b32 s3, s3, 4
  s_sub_u32 s39, 32, s3
  s_lshl_b32 s38, s40, 5
  s_add_u32 s3, s3, s38
  s_lshl_b32 s3, s3, 14
  s_add_u32 s23, s23, s3
  s_lshl_b32 s3, s3, 3
  s_add_u32 s25, s25, s3
  s_mov_b32 s64, 4294459392
  s_mov_b32 s65, 16384
  s_lshl_b32 s3, s20, 4
  v_lshrrev_b32 v224, 4, v0
  v_and_b32 v226, 15, v0
  v_add_u32 v225, 0, v224
  v_lshlrev_b32 v225, 1, v225
  v_xor_b32 v225, v225, v226
  v_add_u32 v227, s3, v224
  v_lshlrev_b32 v227, 11, v227
  v_lshl_add_u32 v227, v225, 4, v227
  v_add_u32 v2, 0, v227
  v_add_u32 v225, 4, v224
  v_lshlrev_b32 v225, 1, v225
  v_xor_b32 v225, v225, v226
  v_add_u32 v227, s3, v224
  v_lshlrev_b32 v227, 11, v227
  v_lshl_add_u32 v227, v225, 4, v227
  v_add_u32 v3, 7168, v227
  v_add_u32 v225, 0, v224
  v_lshlrev_b32 v225, 1, v225
  v_xor_b32 v225, v225, v226
  v_add_u32 v227, s3, v224
  v_lshlrev_b32 v227, 11, v227
  v_lshl_add_u32 v227, v225, 4, v227
  v_add_u32 v4, 14336, v227
  v_add_u32 v225, 4, v224
  v_lshlrev_b32 v225, 1, v225
  v_xor_b32 v225, v225, v226
  v_add_u32 v227, s3, v224
  v_lshlrev_b32 v227, 11, v227
  v_lshl_add_u32 v227, v225, 4, v227
  v_add_u32 v5, 21504, v227
  s_waitcnt lgkmcnt(0)
  s_add_u32 s8, s6, 67108864
  s_addc_u32 s9, s7, 0
  s_mov_b32 s10, 16777216
  s_mov_b32 s11, 0x00020000
  s_mov_b32 s12, s4
  s_mov_b32 s13, s5
  s_mov_b32 s14, 8388608
  s_mov_b32 s15, 0x00020000
  s_add_u32 m0, s41, 0
  s_nop 0
  buffer_load_dwordx4 v2, s[12:15], s25 offen offset:0 lds
  buffer_load_dwordx4 v3, s[12:15], s25 offen offset:1024 lds
  buffer_load_dwordx4 v4, s[12:15], s25 offen offset:2048 lds
  buffer_load_dwordx4 v5, s[12:15], s25 offen offset:3072 lds
  buffer_load_dwordx4 a[0:3], v1, s[8:11], s23 offen offset:0
  buffer_load_dwordx4 a[4:7], v1, s[8:11], s23 offen offset:1024
  buffer_load_dwordx4 a[8:11], v1, s[8:11], s23 offen offset:2048
  buffer_load_dwordx4 a[12:15], v1, s[8:11], s23 offen offset:3072
  s_sub_u32 s39, s39, 1
  s_cmp_eq_u32 s39, 0
  s_cselect_b32 s3, s64, s65
  s_add_u32 s23, s23, s3
  s_lshl_b32 s3, s3, 3
  s_add_u32 s25, s25, s3
  s_add_u32 m0, s41, 16384
  s_nop 0
  buffer_load_dwordx4 v2, s[12:15], s25 offen offset:0 lds
  buffer_load_dwordx4 v3, s[12:15], s25 offen offset:1024 lds
  buffer_load_dwordx4 v4, s[12:15], s25 offen offset:2048 lds
  buffer_load_dwordx4 v5, s[12:15], s25 offen offset:3072 lds
  buffer_load_dwordx4 a[16:19], v1, s[8:11], s23 offen offset:0
  buffer_load_dwordx4 a[20:23], v1, s[8:11], s23 offen offset:1024
  buffer_load_dwordx4 a[24:27], v1, s[8:11], s23 offen offset:2048
  buffer_load_dwordx4 a[28:31], v1, s[8:11], s23 offen offset:3072
  s_sub_u32 s39, s39, 1
  s_cmp_eq_u32 s39, 0
  s_cselect_b32 s3, s64, s65
  s_add_u32 s23, s23, s3
  s_lshl_b32 s3, s3, 3
  s_add_u32 s25, s25, s3
  v_lshrrev_b32 v224, 2, v0
  v_lshlrev_b32 v225, 8, v224
  v_and_b32 v226, 1, v0
  v_lshl_add_u32 v225, v226, 3, v225
  v_and_b32 v228, 7, v224
  v_lshlrev_b32 v228, 1, v228
  s_lshl_b32 s38, s40, 3
  v_xor_b32 v228, s38, v228
  v_bfe_u32 v229, v0, 1, 1
  v_add_u32 v227, 0, v229
  v_xor_b32 v227, v227, v228
  v_lshl_add_u32 v8, v227, 4, v225
  v_add_u32 v16, 0x10000, v8
  v_add_u32 v227, 2, v229
  v_xor_b32 v227, v227, v228
  v_lshl_add_u32 v9, v227, 4, v225
  v_add_u32 v17, 0x10000, v9
  v_add_u32 v227, 4, v229
  v_xor_b32 v227, v227, v228
  v_lshl_add_u32 v10, v227, 4, v225
  v_add_u32 v18, 0x10000, v10
  v_add_u32 v227, 6, v229
  v_xor_b32 v227, v227, v228
  v_lshl_add_u32 v11, v227, 4, v225
  v_add_u32 v19, 0x10000, v11
  v_add_u32 v227, 8, v229
  v_xor_b32 v227, v227, v228
  v_lshl_add_u32 v12, v227, 4, v225
  v_add_u32 v20, 0x10000, v12
  v_add_u32 v227, 10, v229
  v_xor_b32 v227, v227, v228
  v_lshl_add_u32 v13, v227, 4, v225
  v_add_u32 v21, 0x10000, v13
  v_add_u32 v227, 12, v229
  v_xor_b32 v227, v227, v228
  v_lshl_add_u32 v14, v227, 4, v225
  v_add_u32 v22, 0x10000, v14
  v_add_u32 v227, 14, v229
  v_xor_b32 v227, v227, v228
  v_lshl_add_u32 v15, v227, 4, v225
  v_add_u32 v23, 0x10000, v15
  s_add_u32 m0, s41, 32768
  s_nop 0
  buffer_load_dwordx4 v2, s[12:15], s25 offen offset:0 lds
  buffer_load_dwordx4 v3, s[12:15], s25 offen offset:1024 lds
  buffer_load_dwordx4 v4, s[12:15], s25 offen offset:2048 lds
  buffer_load_dwordx4 v5, s[12:15], s25 offen offset:3072 lds
  buffer_load_dwordx4 a[32:35], v1, s[8:11], s23 offen offset:0
  buffer_load_dwordx4 a[36:39], v1, s[8:11], s23 offen offset:1024
  buffer_load_dwordx4 a[40:43], v1, s[8:11], s23 offen offset:2048
  buffer_load_dwordx4 a[44:47], v1, s[8:11], s23 offen offset:3072
  s_sub_u32 s39, s39, 1
  s_cmp_eq_u32 s39, 0
  s_cselect_b32 s3, s64, s65
  s_add_u32 s23, s23, s3
  s_lshl_b32 s3, s3, 3
  s_add_u32 s25, s25, s3
  s_and_b32 s38, s2, 3
  s_lshl_b32 s38, s38, 2
  s_bfe_u32 s36, s2, 0x20003
  s_add_u32 s36, s38, s36
  s_lshl_b32 s21, s36, 7
  s_lshl_b32 s49, s36, 18
  s_add_u32 s49, s49, s41
  s_bfe_u32 s38, s2, 0x10002
  s_lshl_b32 s38, s38, 3
  s_lshr_b32 s37, s2, 5
  s_add_u32 s38, s38, s37
  s_lshl_b32 s22, s38, 6
  s_lshl_b32 s51, s38, 7
  s_add_u32 s44, s6, 83886080
  s_addc_u32 s45, s7, 0
  s_mov_b64 s[46:47], s[32:33]
  s_mov_b32 s16, s34
  s_mov_b32 s17, s35
  s_mov_b32 s18, 8388608
  s_mov_b32 s19, 0x00020000
  s_add_u32 s52, s6, 100663296
  s_addc_u32 s53, s7, 0
  s_mov_b32 s54, 8392704
  s_mov_b32 s55, 0x00020000
  s_lshl_b32 s56, s2, 15
  s_lshl_b32 s38, s20, 13
  s_add_u32 s56, s56, s38
  s_xor_b32 s57, s56, 32768
  s_lshl_b32 s58, s2, 2
  s_add_u32 s58, s58, 8388608
  s_xor_b32 s59, s58, 4
  s_mov_b32 s61, 0
  s_lshl_b32 s38, s20, 4
  v_lshrrev_b32 v230, 3, v0
  v_and_b32 v231, 6, v230
  v_and_b32 v232, 7, v0
  v_xor_b32 v231, v231, v232
  v_add_u32 v230, s38, v230
  v_lshlrev_b32 v230, 11, v230
  v_lshl_add_u32 v6, v231, 4, v230
  v_add_u32 v7, 15360, v6
  v_lshlrev_b32 v225, 7, v224
  v_lshl_add_u32 v225, v226, 3, v225
  v_and_b32 v228, 6, v224
  v_add_u32 v227, 0, v229
  v_xor_b32 v227, v227, v228
  v_lshl_add_u32 v24, v227, 4, v225
  v_add_u32 v28, 0x10000, v24
  v_add_u32 v227, 2, v229
  v_xor_b32 v227, v227, v228
  v_lshl_add_u32 v25, v227, 4, v225
  v_add_u32 v29, 0x10000, v25
  v_add_u32 v227, 4, v229
  v_xor_b32 v227, v227, v228
  v_lshl_add_u32 v26, v227, 4, v225
  v_add_u32 v30, 0x10000, v26
  v_add_u32 v227, 6, v229
  v_xor_b32 v227, v227, v228
  v_lshl_add_u32 v27, v227, 4, v225
  v_add_u32 v31, 0x10000, v27
  s_add_u32 m0, s41, 49152
  s_nop 0
  buffer_load_dwordx4 v2, s[12:15], s25 offen offset:0 lds
  buffer_load_dwordx4 v3, s[12:15], s25 offen offset:1024 lds
  buffer_load_dwordx4 v4, s[12:15], s25 offen offset:2048 lds
  buffer_load_dwordx4 v5, s[12:15], s25 offen offset:3072 lds
  buffer_load_dwordx4 a[48:51], v1, s[8:11], s23 offen offset:0
  buffer_load_dwordx4 a[52:55], v1, s[8:11], s23 offen offset:1024
  buffer_load_dwordx4 a[56:59], v1, s[8:11], s23 offen offset:2048
  buffer_load_dwordx4 a[60:63], v1, s[8:11], s23 offen offset:3072
  s_sub_u32 s39, s39, 1
  s_cmp_eq_u32 s39, 0
  s_cselect_b32 s3, s64, s65
  s_add_u32 s23, s23, s3
  s_lshl_b32 s3, s3, 3
  s_add_u32 s25, s25, s3
  s_add_u32 m0, s41, 65536
  s_nop 0
  buffer_load_dwordx4 v2, s[12:15], s25 offen offset:0 lds
  buffer_load_dwordx4 v3, s[12:15], s25 offen offset:1024 lds
  buffer_load_dwordx4 v4, s[12:15], s25 offen offset:2048 lds
  buffer_load_dwordx4 v5, s[12:15], s25 offen offset:3072 lds
  buffer_load_dwordx4 a[64:67], v1, s[8:11], s23 offen offset:0
  buffer_load_dwordx4 a[68:71], v1, s[8:11], s23 offen offset:1024
  buffer_load_dwordx4 a[72:75], v1, s[8:11], s23 offen offset:2048
  buffer_load_dwordx4 a[76:79], v1, s[8:11], s23 offen offset:3072
  s_sub_u32 s39, s39, 1
  s_cmp_eq_u32 s39, 0
  s_cselect_b32 s3, s64, s65
  s_add_u32 s23, s23, s3
  s_lshl_b32 s3, s3, 3
  s_add_u32 s25, s25, s3
  s_waitcnt vmcnt(32)
  s_barrier
  ds_read_b64_tr_b16 v[96:97], v8 offset:0
  ds_read_b64_tr_b16 v[98:99], v8 offset:4096
  ds_read_b64_tr_b16 v[100:101], v8 offset:8192
  ds_read_b64_tr_b16 v[102:103], v8 offset:12288
  ds_read_b64_tr_b16 v[104:105], v9 offset:0
  ds_read_b64_tr_b16 v[106:107], v9 offset:4096
  ds_read_b64_tr_b16 v[108:109], v9 offset:8192
  ds_read_b64_tr_b16 v[110:111], v9 offset:12288
  ds_read_b64_tr_b16 v[112:113], v10 offset:0
  ds_read_b64_tr_b16 v[114:115], v10 offset:4096
  ds_read_b64_tr_b16 v[116:117], v10 offset:8192
  ds_read_b64_tr_b16 v[118:119], v10 offset:12288
  ds_read_b64_tr_b16 v[120:121], v11 offset:0
  ds_read_b64_tr_b16 v[122:123], v11 offset:4096
  ds_read_b64_tr_b16 v[124:125], v11 offset:8192
  ds_read_b64_tr_b16 v[126:127], v11 offset:12288
  ds_read_b64_tr_b16 v[128:129], v12 offset:0
  ds_read_b64_tr_b16 v[130:131], v12 offset:4096
  ds_read_b64_tr_b16 v[132:133], v12 offset:8192
  ds_read_b64_tr_b16 v[134:135], v12 offset:12288
  ds_read_b64_tr_b16 v[136:137], v13 offset:0
  ds_read_b64_tr_b16 v[138:139], v13 offset:4096
  ds_read_b64_tr_b16 v[140:141], v13 offset:8192
  ds_read_b64_tr_b16 v[142:143], v13 offset:12288
  ds_read_b64_tr_b16 v[144:145], v14 offset:0
  ds_read_b64_tr_b16 v[146:147], v14 offset:4096
  ds_read_b64_tr_b16 v[148:149], v14 offset:8192
  ds_read_b64_tr_b16 v[150:151], v14 offset:12288
  ds_read_b64_tr_b16 v[152:153], v15 offset:0
  ds_read_b64_tr_b16 v[154:155], v15 offset:4096
  ds_read_b64_tr_b16 v[156:157], v15 offset:8192
  ds_read_b64_tr_b16 v[158:159], v15 offset:12288
  s_waitcnt vmcnt(24) lgkmcnt(0)
  s_barrier
  v_mfma_f32_16x16x32_bf16 v[32:35], v[96:99], a[0:3], 0
  s_add_u32 m0, s41, 81920
  s_nop 0
  buffer_load_dwordx4 v2, s[12:15], s25 offen offset:0 lds
  v_mfma_f32_16x16x32_bf16 v[32:35], v[100:103], a[4:7], v[32:35]
  ds_read_b64_tr_b16 v[160:161], v8 offset:16384
  ds_read_b64_tr_b16 v[162:163], v8 offset:20480
  v_mfma_f32_16x16x32_bf16 v[36:39], v[108:111], a[4:7], 0
  buffer_load_dwordx4 v3, s[12:15], s25 offen offset:1024 lds
  v_mfma_f32_16x16x32_bf16 v[36:39], v[104:107], a[0:3], v[36:39]
  ds_read_b64_tr_b16 v[164:165], v8 offset:24576
  ds_read_b64_tr_b16 v[166:167], v8 offset:28672
  v_mfma_f32_16x16x32_bf16 v[40:43], v[112:115], a[0:3], 0
  buffer_load_dwordx4 v4, s[12:15], s25 offen offset:2048 lds
  v_mfma_f32_16x16x32_bf16 v[40:43], v[116:119], a[4:7], v[40:43]
  ds_read_b64_tr_b16 v[168:169], v9 offset:16384
  ds_read_b64_tr_b16 v[170:171], v9 offset:20480
  v_mfma_f32_16x16x32_bf16 v[44:47], v[124:127], a[4:7], 0
  buffer_load_dwordx4 v5, s[12:15], s25 offen offset:3072 lds
  v_mfma_f32_16x16x32_bf16 v[44:47], v[120:123], a[0:3], v[44:47]
  v_mfma_f32_16x16x32_bf16 v[48:51], v[128:131], a[0:3], 0
  ds_read_b64_tr_b16 v[172:173], v9 offset:24576
  ds_read_b64_tr_b16 v[174:175], v9 offset:28672
  v_mfma_f32_16x16x32_bf16 v[48:51], v[132:135], a[4:7], v[48:51]
  buffer_load_dwordx4 a[80:83], v1, s[8:11], s23 offen offset:0
  v_mfma_f32_16x16x32_bf16 v[52:55], v[140:143], a[4:7], 0
  ds_read_b64_tr_b16 v[176:177], v10 offset:16384
  ds_read_b64_tr_b16 v[178:179], v10 offset:20480
  v_mfma_f32_16x16x32_bf16 v[52:55], v[136:139], a[0:3], v[52:55]
  buffer_load_dwordx4 a[84:87], v1, s[8:11], s23 offen offset:1024
  v_mfma_f32_16x16x32_bf16 v[56:59], v[144:147], a[0:3], 0
  ds_read_b64_tr_b16 v[180:181], v10 offset:24576
  ds_read_b64_tr_b16 v[182:183], v10 offset:28672
  v_mfma_f32_16x16x32_bf16 v[56:59], v[148:151], a[4:7], v[56:59]
  buffer_load_dwordx4 a[88:91], v1, s[8:11], s23 offen offset:2048
  v_mfma_f32_16x16x32_bf16 v[60:63], v[156:159], a[4:7], 0
  v_mfma_f32_16x16x32_bf16 v[60:63], v[152:155], a[0:3], v[60:63]
  ds_read_b64_tr_b16 v[184:185], v11 offset:16384
  ds_read_b64_tr_b16 v[186:187], v11 offset:20480
  v_mfma_f32_16x16x32_bf16 v[64:67], v[96:99], a[8:11], 0
  buffer_load_dwordx4 a[92:95], v1, s[8:11], s23 offen offset:3072
  v_mfma_f32_16x16x32_bf16 v[64:67], v[100:103], a[12:15], v[64:67]
  ds_read_b64_tr_b16 v[188:189], v11 offset:24576
  ds_read_b64_tr_b16 v[190:191], v11 offset:28672
  v_mfma_f32_16x16x32_bf16 v[68:71], v[108:111], a[12:15], 0
  s_sub_u32 s39, s39, 1
  s_cmp_eq_u32 s39, 0
  s_cselect_b32 s3, s64, s65
  v_mfma_f32_16x16x32_bf16 v[68:71], v[104:107], a[8:11], v[68:71]
  ds_read_b64_tr_b16 v[192:193], v12 offset:16384
  ds_read_b64_tr_b16 v[194:195], v12 offset:20480
  v_mfma_f32_16x16x32_bf16 v[72:75], v[112:115], a[8:11], 0
  s_add_u32 s23, s23, s3
  s_lshl_b32 s3, s3, 3
  s_add_u32 s25, s25, s3
  v_mfma_f32_16x16x32_bf16 v[72:75], v[116:119], a[12:15], v[72:75]
  ds_read_b64_tr_b16 v[196:197], v12 offset:24576
  ds_read_b64_tr_b16 v[198:199], v12 offset:28672
  v_mfma_f32_16x16x32_bf16 v[76:79], v[124:127], a[12:15], 0
  v_mfma_f32_16x16x32_bf16 v[76:79], v[120:123], a[8:11], v[76:79]
  ds_read_b64_tr_b16 v[200:201], v13 offset:16384
  ds_read_b64_tr_b16 v[202:203], v13 offset:20480
  v_mfma_f32_16x16x32_bf16 v[80:83], v[128:131], a[8:11], 0
  ds_read_b64_tr_b16 v[204:205], v13 offset:24576
  ds_read_b64_tr_b16 v[206:207], v13 offset:28672
  v_mfma_f32_16x16x32_bf16 v[80:83], v[132:135], a[12:15], v[80:83]
  ds_read_b64_tr_b16 v[208:209], v14 offset:16384
  ds_read_b64_tr_b16 v[210:211], v14 offset:20480
  v_mfma_f32_16x16x32_bf16 v[84:87], v[140:143], a[12:15], 0
  ds_read_b64_tr_b16 v[212:213], v14 offset:24576
  ds_read_b64_tr_b16 v[214:215], v14 offset:28672
  v_mfma_f32_16x16x32_bf16 v[84:87], v[136:139], a[8:11], v[84:87]
  ds_read_b64_tr_b16 v[216:217], v15 offset:16384
  ds_read_b64_tr_b16 v[218:219], v15 offset:20480
  v_mfma_f32_16x16x32_bf16 v[88:91], v[144:147], a[8:11], 0
  ds_read_b64_tr_b16 v[220:221], v15 offset:24576
  ds_read_b64_tr_b16 v[222:223], v15 offset:28672
  v_mfma_f32_16x16x32_bf16 v[88:91], v[148:151], a[12:15], v[88:91]
  v_mfma_f32_16x16x32_bf16 v[92:95], v[156:159], a[12:15], 0
  v_mfma_f32_16x16x32_bf16 v[92:95], v[152:155], a[8:11], v[92:95]
  s_waitcnt vmcnt(24) lgkmcnt(0)
  s_barrier
  v_mfma_f32_16x16x32_bf16 v[32:35], v[160:163], a[16:19], v[32:35]
  s_add_u32 m0, s41, 98304
  s_nop 0
  buffer_load_dwordx4 v2, s[12:15], s25 offen offset:0 lds
  v_mfma_f32_16x16x32_bf16 v[32:35], v[164:167], a[20:23], v[32:35]
  ds_read_b64_tr_b16 v[96:97], v8 offset:32768
  ds_read_b64_tr_b16 v[98:99], v8 offset:36864
  v_mfma_f32_16x16x32_bf16 v[36:39], v[172:175], a[20:23], v[36:39]
  buffer_load_dwordx4 v3, s[12:15], s25 offen offset:1024 lds
  v_mfma_f32_16x16x32_bf16 v[36:39], v[168:171], a[16:19], v[36:39]
  ds_read_b64_tr_b16 v[100:101], v8 offset:40960
  ds_read_b64_tr_b16 v[102:103], v8 offset:45056
  v_mfma_f32_16x16x32_bf16 v[40:43], v[176:179], a[16:19], v[40:43]
  buffer_load_dwordx4 v4, s[12:15], s25 offen offset:2048 lds
  v_mfma_f32_16x16x32_bf16 v[40:43], v[180:183], a[20:23], v[40:43]
  ds_read_b64_tr_b16 v[104:105], v9 offset:32768
  ds_read_b64_tr_b16 v[106:107], v9 offset:36864
  v_mfma_f32_16x16x32_bf16 v[44:47], v[188:191], a[20:23], v[44:47]
  buffer_load_dwordx4 v5, s[12:15], s25 offen offset:3072 lds
  v_mfma_f32_16x16x32_bf16 v[44:47], v[184:187], a[16:19], v[44:47]
  v_mfma_f32_16x16x32_bf16 v[48:51], v[192:195], a[16:19], v[48:51]
  ds_read_b64_tr_b16 v[108:109], v9 offset:40960
  ds_read_b64_tr_b16 v[110:111], v9 offset:45056
  v_mfma_f32_16x16x32_bf16 v[48:51], v[196:199], a[20:23], v[48:51]
  buffer_load_dwordx4 a[96:99], v1, s[8:11], s23 offen offset:0
  v_mfma_f32_16x16x32_bf16 v[52:55], v[204:207], a[20:23], v[52:55]
  ds_read_b64_tr_b16 v[112:113], v10 offset:32768
  ds_read_b64_tr_b16 v[114:115], v10 offset:36864
  v_mfma_f32_16x16x32_bf16 v[52:55], v[200:203], a[16:19], v[52:55]
  buffer_load_dwordx4 a[100:103], v1, s[8:11], s23 offen offset:1024
  v_mfma_f32_16x16x32_bf16 v[56:59], v[208:211], a[16:19], v[56:59]
  ds_read_b64_tr_b16 v[116:117], v10 offset:40960
  ds_read_b64_tr_b16 v[118:119], v10 offset:45056
  v_mfma_f32_16x16x32_bf16 v[56:59], v[212:215], a[20:23], v[56:59]
  buffer_load_dwordx4 a[104:107], v1, s[8:11], s23 offen offset:2048
  v_mfma_f32_16x16x32_bf16 v[60:63], v[220:223], a[20:23], v[60:63]
  v_mfma_f32_16x16x32_bf16 v[60:63], v[216:219], a[16:19], v[60:63]
  ds_read_b64_tr_b16 v[120:121], v11 offset:32768
  ds_read_b64_tr_b16 v[122:123], v11 offset:36864
  v_mfma_f32_16x16x32_bf16 v[64:67], v[160:163], a[24:27], v[64:67]
  buffer_load_dwordx4 a[108:111], v1, s[8:11], s23 offen offset:3072
  v_mfma_f32_16x16x32_bf16 v[64:67], v[164:167], a[28:31], v[64:67]
  ds_read_b64_tr_b16 v[124:125], v11 offset:40960
  ds_read_b64_tr_b16 v[126:127], v11 offset:45056
  v_mfma_f32_16x16x32_bf16 v[68:71], v[172:175], a[28:31], v[68:71]
  s_sub_u32 s39, s39, 1
  s_cmp_eq_u32 s39, 0
  s_cselect_b32 s3, s64, s65
  v_mfma_f32_16x16x32_bf16 v[68:71], v[168:171], a[24:27], v[68:71]
  ds_read_b64_tr_b16 v[128:129], v12 offset:32768
  ds_read_b64_tr_b16 v[130:131], v12 offset:36864
  v_mfma_f32_16x16x32_bf16 v[72:75], v[176:179], a[24:27], v[72:75]
  s_add_u32 s23, s23, s3
  s_lshl_b32 s3, s3, 3
  s_add_u32 s25, s25, s3
  v_mfma_f32_16x16x32_bf16 v[72:75], v[180:183], a[28:31], v[72:75]
  ds_read_b64_tr_b16 v[132:133], v12 offset:40960
  ds_read_b64_tr_b16 v[134:135], v12 offset:45056
  v_mfma_f32_16x16x32_bf16 v[76:79], v[188:191], a[28:31], v[76:79]
  v_mfma_f32_16x16x32_bf16 v[76:79], v[184:187], a[24:27], v[76:79]
  ds_read_b64_tr_b16 v[136:137], v13 offset:32768
  ds_read_b64_tr_b16 v[138:139], v13 offset:36864
  v_mfma_f32_16x16x32_bf16 v[80:83], v[192:195], a[24:27], v[80:83]
  ds_read_b64_tr_b16 v[140:141], v13 offset:40960
  ds_read_b64_tr_b16 v[142:143], v13 offset:45056
  v_mfma_f32_16x16x32_bf16 v[80:83], v[196:199], a[28:31], v[80:83]
  ds_read_b64_tr_b16 v[144:145], v14 offset:32768
  ds_read_b64_tr_b16 v[146:147], v14 offset:36864
  v_mfma_f32_16x16x32_bf16 v[84:87], v[204:207], a[28:31], v[84:87]
  ds_read_b64_tr_b16 v[148:149], v14 offset:40960
  ds_read_b64_tr_b16 v[150:151], v14 offset:45056
  v_mfma_f32_16x16x32_bf16 v[84:87], v[200:203], a[24:27], v[84:87]
  ds_read_b64_tr_b16 v[152:153], v15 offset:32768
  ds_read_b64_tr_b16 v[154:155], v15 offset:36864
  v_mfma_f32_16x16x32_bf16 v[88:91], v[208:211], a[24:27], v[88:91]
  ds_read_b64_tr_b16 v[156:157], v15 offset:40960
  ds_read_b64_tr_b16 v[158:159], v15 offset:45056
  v_mfma_f32_16x16x32_bf16 v[88:91], v[212:215], a[28:31], v[88:91]
  v_mfma_f32_16x16x32_bf16 v[92:95], v[220:223], a[28:31], v[92:95]
  v_mfma_f32_16x16x32_bf16 v[92:95], v[216:219], a[24:27], v[92:95]
  s_waitcnt vmcnt(24) lgkmcnt(0)
  s_barrier
  v_mfma_f32_16x16x32_bf16 v[32:35], v[96:99], a[32:35], v[32:35]
  s_add_u32 m0, s41, 114688
  s_nop 0
  buffer_load_dwordx4 v2, s[12:15], s25 offen offset:0 lds
  v_mfma_f32_16x16x32_bf16 v[32:35], v[100:103], a[36:39], v[32:35]
  ds_read_b64_tr_b16 v[160:161], v8 offset:49152
  ds_read_b64_tr_b16 v[162:163], v8 offset:53248
  v_mfma_f32_16x16x32_bf16 v[36:39], v[108:111], a[36:39], v[36:39]
  buffer_load_dwordx4 v3, s[12:15], s25 offen offset:1024 lds
  v_mfma_f32_16x16x32_bf16 v[36:39], v[104:107], a[32:35], v[36:39]
  ds_read_b64_tr_b16 v[164:165], v8 offset:57344
  ds_read_b64_tr_b16 v[166:167], v8 offset:61440
  v_mfma_f32_16x16x32_bf16 v[40:43], v[112:115], a[32:35], v[40:43]
  buffer_load_dwordx4 v4, s[12:15], s25 offen offset:2048 lds
  v_mfma_f32_16x16x32_bf16 v[40:43], v[116:119], a[36:39], v[40:43]
  ds_read_b64_tr_b16 v[168:169], v9 offset:49152
  ds_read_b64_tr_b16 v[170:171], v9 offset:53248
  v_mfma_f32_16x16x32_bf16 v[44:47], v[124:127], a[36:39], v[44:47]
  buffer_load_dwordx4 v5, s[12:15], s25 offen offset:3072 lds
  v_mfma_f32_16x16x32_bf16 v[44:47], v[120:123], a[32:35], v[44:47]
  v_mfma_f32_16x16x32_bf16 v[48:51], v[128:131], a[32:35], v[48:51]
  ds_read_b64_tr_b16 v[172:173], v9 offset:57344
  ds_read_b64_tr_b16 v[174:175], v9 offset:61440
  v_mfma_f32_16x16x32_bf16 v[48:51], v[132:135], a[36:39], v[48:51]
  buffer_load_dwordx4 a[112:115], v1, s[8:11], s23 offen offset:0
  v_mfma_f32_16x16x32_bf16 v[52:55], v[140:143], a[36:39], v[52:55]
  ds_read_b64_tr_b16 v[176:177], v10 offset:49152
  ds_read_b64_tr_b16 v[178:179], v10 offset:53248
  v_mfma_f32_16x16x32_bf16 v[52:55], v[136:139], a[32:35], v[52:55]
  buffer_load_dwordx4 a[116:119], v1, s[8:11], s23 offen offset:1024
  v_mfma_f32_16x16x32_bf16 v[56:59], v[144:147], a[32:35], v[56:59]
  ds_read_b64_tr_b16 v[180:181], v10 offset:57344
  ds_read_b64_tr_b16 v[182:183], v10 offset:61440
  v_mfma_f32_16x16x32_bf16 v[56:59], v[148:151], a[36:39], v[56:59]
  buffer_load_dwordx4 a[120:123], v1, s[8:11], s23 offen offset:2048
  v_mfma_f32_16x16x32_bf16 v[60:63], v[156:159], a[36:39], v[60:63]
  v_mfma_f32_16x16x32_bf16 v[60:63], v[152:155], a[32:35], v[60:63]
  ds_read_b64_tr_b16 v[184:185], v11 offset:49152
  ds_read_b64_tr_b16 v[186:187], v11 offset:53248
  v_mfma_f32_16x16x32_bf16 v[64:67], v[96:99], a[40:43], v[64:67]
  buffer_load_dwordx4 a[124:127], v1, s[8:11], s23 offen offset:3072
  v_mfma_f32_16x16x32_bf16 v[64:67], v[100:103], a[44:47], v[64:67]
  ds_read_b64_tr_b16 v[188:189], v11 offset:57344
  ds_read_b64_tr_b16 v[190:191], v11 offset:61440
  v_mfma_f32_16x16x32_bf16 v[68:71], v[108:111], a[44:47], v[68:71]
  s_sub_u32 s39, s39, 1
  s_cmp_eq_u32 s39, 0
  s_cselect_b32 s3, s64, s65
  v_mfma_f32_16x16x32_bf16 v[68:71], v[104:107], a[40:43], v[68:71]
  ds_read_b64_tr_b16 v[192:193], v12 offset:49152
  ds_read_b64_tr_b16 v[194:195], v12 offset:53248
  v_mfma_f32_16x16x32_bf16 v[72:75], v[112:115], a[40:43], v[72:75]
  s_add_u32 s23, s23, s3
  s_lshl_b32 s3, s3, 3
  s_add_u32 s25, s25, s3
  v_mfma_f32_16x16x32_bf16 v[72:75], v[116:119], a[44:47], v[72:75]
  ds_read_b64_tr_b16 v[196:197], v12 offset:57344
  ds_read_b64_tr_b16 v[198:199], v12 offset:61440
  v_mfma_f32_16x16x32_bf16 v[76:79], v[124:127], a[44:47], v[76:79]
  v_mfma_f32_16x16x32_bf16 v[76:79], v[120:123], a[40:43], v[76:79]
  ds_read_b64_tr_b16 v[200:201], v13 offset:49152
  ds_read_b64_tr_b16 v[202:203], v13 offset:53248
  v_mfma_f32_16x16x32_bf16 v[80:83], v[128:131], a[40:43], v[80:83]
  ds_read_b64_tr_b16 v[204:205], v13 offset:57344
  ds_read_b64_tr_b16 v[206:207], v13 offset:61440
  v_mfma_f32_16x16x32_bf16 v[80:83], v[132:135], a[44:47], v[80:83]
  ds_read_b64_tr_b16 v[208:209], v14 offset:49152
  ds_read_b64_tr_b16 v[210:211], v14 offset:53248
  v_mfma_f32_16x16x32_bf16 v[84:87], v[140:143], a[44:47], v[84:87]
  ds_read_b64_tr_b16 v[212:213], v14 offset:57344
  ds_read_b64_tr_b16 v[214:215], v14 offset:61440
  v_mfma_f32_16x16x32_bf16 v[84:87], v[136:139], a[40:43], v[84:87]
  ds_read_b64_tr_b16 v[216:217], v15 offset:49152
  ds_read_b64_tr_b16 v[218:219], v15 offset:53248
  v_mfma_f32_16x16x32_bf16 v[88:91], v[144:147], a[40:43], v[88:91]
  ds_read_b64_tr_b16 v[220:221], v15 offset:57344
  ds_read_b64_tr_b16 v[222:223], v15 offset:61440
  v_mfma_f32_16x16x32_bf16 v[88:91], v[148:151], a[44:47], v[88:91]
  v_mfma_f32_16x16x32_bf16 v[92:95], v[156:159], a[44:47], v[92:95]
  v_mfma_f32_16x16x32_bf16 v[92:95], v[152:155], a[40:43], v[92:95]
  s_waitcnt vmcnt(24) lgkmcnt(0)
  s_barrier
  v_mfma_f32_16x16x32_bf16 v[32:35], v[160:163], a[48:51], v[32:35]
  s_add_u32 m0, s41, 0
  s_nop 0
  buffer_load_dwordx4 v2, s[12:15], s25 offen offset:0 lds
  v_mfma_f32_16x16x32_bf16 v[32:35], v[164:167], a[52:55], v[32:35]
  ds_read_b64_tr_b16 v[96:97], v16 offset:0
  ds_read_b64_tr_b16 v[98:99], v16 offset:4096
  v_mfma_f32_16x16x32_bf16 v[36:39], v[172:175], a[52:55], v[36:39]
  buffer_load_dwordx4 v3, s[12:15], s25 offen offset:1024 lds
  v_mfma_f32_16x16x32_bf16 v[36:39], v[168:171], a[48:51], v[36:39]
  ds_read_b64_tr_b16 v[100:101], v16 offset:8192
  ds_read_b64_tr_b16 v[102:103], v16 offset:12288
  v_mfma_f32_16x16x32_bf16 v[40:43], v[176:179], a[48:51], v[40:43]
  buffer_load_dwordx4 v4, s[12:15], s25 offen offset:2048 lds
  v_mfma_f32_16x16x32_bf16 v[40:43], v[180:183], a[52:55], v[40:43]
  ds_read_b64_tr_b16 v[104:105], v17 offset:0
  ds_read_b64_tr_b16 v[106:107], v17 offset:4096
  v_mfma_f32_16x16x32_bf16 v[44:47], v[188:191], a[52:55], v[44:47]
  buffer_load_dwordx4 v5, s[12:15], s25 offen offset:3072 lds
  v_mfma_f32_16x16x32_bf16 v[44:47], v[184:187], a[48:51], v[44:47]
  v_mfma_f32_16x16x32_bf16 v[48:51], v[192:195], a[48:51], v[48:51]
  ds_read_b64_tr_b16 v[108:109], v17 offset:8192
  ds_read_b64_tr_b16 v[110:111], v17 offset:12288
  v_mfma_f32_16x16x32_bf16 v[48:51], v[196:199], a[52:55], v[48:51]
  buffer_load_dwordx4 a[0:3], v1, s[8:11], s23 offen offset:0
  v_mfma_f32_16x16x32_bf16 v[52:55], v[204:207], a[52:55], v[52:55]
  ds_read_b64_tr_b16 v[112:113], v18 offset:0
  ds_read_b64_tr_b16 v[114:115], v18 offset:4096
  v_mfma_f32_16x16x32_bf16 v[52:55], v[200:203], a[48:51], v[52:55]
  buffer_load_dwordx4 a[4:7], v1, s[8:11], s23 offen offset:1024
  v_mfma_f32_16x16x32_bf16 v[56:59], v[208:211], a[48:51], v[56:59]
  ds_read_b64_tr_b16 v[116:117], v18 offset:8192
  ds_read_b64_tr_b16 v[118:119], v18 offset:12288
  v_mfma_f32_16x16x32_bf16 v[56:59], v[212:215], a[52:55], v[56:59]
  buffer_load_dwordx4 a[8:11], v1, s[8:11], s23 offen offset:2048
  v_mfma_f32_16x16x32_bf16 v[60:63], v[220:223], a[52:55], v[60:63]
  v_mfma_f32_16x16x32_bf16 v[60:63], v[216:219], a[48:51], v[60:63]
  ds_read_b64_tr_b16 v[120:121], v19 offset:0
  ds_read_b64_tr_b16 v[122:123], v19 offset:4096
  v_mfma_f32_16x16x32_bf16 v[64:67], v[160:163], a[56:59], v[64:67]
  buffer_load_dwordx4 a[12:15], v1, s[8:11], s23 offen offset:3072
  v_mfma_f32_16x16x32_bf16 v[64:67], v[164:167], a[60:63], v[64:67]
  ds_read_b64_tr_b16 v[124:125], v19 offset:8192
  ds_read_b64_tr_b16 v[126:127], v19 offset:12288
  v_mfma_f32_16x16x32_bf16 v[68:71], v[172:175], a[60:63], v[68:71]
  s_sub_u32 s39, s39, 1
  s_cmp_eq_u32 s39, 0
  s_cselect_b32 s3, s64, s65
  v_mfma_f32_16x16x32_bf16 v[68:71], v[168:171], a[56:59], v[68:71]
  ds_read_b64_tr_b16 v[128:129], v20 offset:0
  ds_read_b64_tr_b16 v[130:131], v20 offset:4096
  v_mfma_f32_16x16x32_bf16 v[72:75], v[176:179], a[56:59], v[72:75]
  s_add_u32 s23, s23, s3
  s_lshl_b32 s3, s3, 3
  s_add_u32 s25, s25, s3
  v_mfma_f32_16x16x32_bf16 v[72:75], v[180:183], a[60:63], v[72:75]
  ds_read_b64_tr_b16 v[132:133], v20 offset:8192
  ds_read_b64_tr_b16 v[134:135], v20 offset:12288
  v_mfma_f32_16x16x32_bf16 v[76:79], v[188:191], a[60:63], v[76:79]
  v_mfma_f32_16x16x32_bf16 v[76:79], v[184:187], a[56:59], v[76:79]
  ds_read_b64_tr_b16 v[136:137], v21 offset:0
  ds_read_b64_tr_b16 v[138:139], v21 offset:4096
  v_mfma_f32_16x16x32_bf16 v[80:83], v[192:195], a[56:59], v[80:83]
  ds_read_b64_tr_b16 v[140:141], v21 offset:8192
  ds_read_b64_tr_b16 v[142:143], v21 offset:12288
  v_mfma_f32_16x16x32_bf16 v[80:83], v[196:199], a[60:63], v[80:83]
  ds_read_b64_tr_b16 v[144:145], v22 offset:0
  ds_read_b64_tr_b16 v[146:147], v22 offset:4096
  v_mfma_f32_16x16x32_bf16 v[84:87], v[204:207], a[60:63], v[84:87]
  ds_read_b64_tr_b16 v[148:149], v22 offset:8192
  ds_read_b64_tr_b16 v[150:151], v22 offset:12288
  v_mfma_f32_16x16x32_bf16 v[84:87], v[200:203], a[56:59], v[84:87]
  ds_read_b64_tr_b16 v[152:153], v23 offset:0
  ds_read_b64_tr_b16 v[154:155], v23 offset:4096
  v_mfma_f32_16x16x32_bf16 v[88:91], v[208:211], a[56:59], v[88:91]
  ds_read_b64_tr_b16 v[156:157], v23 offset:8192
  ds_read_b64_tr_b16 v[158:159], v23 offset:12288
  v_mfma_f32_16x16x32_bf16 v[88:91], v[212:215], a[60:63], v[88:91]
  v_mfma_f32_16x16x32_bf16 v[92:95], v[220:223], a[60:63], v[92:95]
  v_mfma_f32_16x16x32_bf16 v[92:95], v[216:219], a[56:59], v[92:95]
  s_waitcnt vmcnt(24) lgkmcnt(0)
  s_barrier
  v_mfma_f32_16x16x32_bf16 v[32:35], v[96:99], a[64:67], v[32:35]
  s_add_u32 m0, s41, 16384
  s_nop 0
  buffer_load_dwordx4 v2, s[12:15], s25 offen offset:0 lds
  v_mfma_f32_16x16x32_bf16 v[32:35], v[100:103], a[68:71], v[32:35]
  ds_read_b64_tr_b16 v[160:161], v16 offset:16384
  ds_read_b64_tr_b16 v[162:163], v16 offset:20480
  v_mfma_f32_16x16x32_bf16 v[36:39], v[108:111], a[68:71], v[36:39]
  buffer_load_dwordx4 v3, s[12:15], s25 offen offset:1024 lds
  v_mfma_f32_16x16x32_bf16 v[36:39], v[104:107], a[64:67], v[36:39]
  ds_read_b64_tr_b16 v[164:165], v16 offset:24576
  ds_read_b64_tr_b16 v[166:167], v16 offset:28672
  v_mfma_f32_16x16x32_bf16 v[40:43], v[112:115], a[64:67], v[40:43]
  buffer_load_dwordx4 v4, s[12:15], s25 offen offset:2048 lds
  v_mfma_f32_16x16x32_bf16 v[40:43], v[116:119], a[68:71], v[40:43]
  ds_read_b64_tr_b16 v[168:169], v17 offset:16384
  ds_read_b64_tr_b16 v[170:171], v17 offset:20480
  v_mfma_f32_16x16x32_bf16 v[44:47], v[124:127], a[68:71], v[44:47]
  buffer_load_dwordx4 v5, s[12:15], s25 offen offset:3072 lds
  v_mfma_f32_16x16x32_bf16 v[44:47], v[120:123], a[64:67], v[44:47]
  v_mfma_f32_16x16x32_bf16 v[48:51], v[128:131], a[64:67], v[48:51]
  ds_read_b64_tr_b16 v[172:173], v17 offset:24576
  ds_read_b64_tr_b16 v[174:175], v17 offset:28672
  v_mfma_f32_16x16x32_bf16 v[48:51], v[132:135], a[68:71], v[48:51]
  buffer_load_dwordx4 a[16:19], v1, s[8:11], s23 offen offset:0
  v_mfma_f32_16x16x32_bf16 v[52:55], v[140:143], a[68:71], v[52:55]
  ds_read_b64_tr_b16 v[176:177], v18 offset:16384
  ds_read_b64_tr_b16 v[178:179], v18 offset:20480
  v_mfma_f32_16x16x32_bf16 v[52:55], v[136:139], a[64:67], v[52:55]
  buffer_load_dwordx4 a[20:23], v1, s[8:11], s23 offen offset:1024
  v_mfma_f32_16x16x32_bf16 v[56:59], v[144:147], a[64:67], v[56:59]
  ds_read_b64_tr_b16 v[180:181], v18 offset:24576
  ds_read_b64_tr_b16 v[182:183], v18 offset:28672
  v_mfma_f32_16x16x32_bf16 v[56:59], v[148:151], a[68:71], v[56:59]
  buffer_load_dwordx4 a[24:27], v1, s[8:11], s23 offen offset:2048
  v_mfma_f32_16x16x32_bf16 v[60:63], v[156:159], a[68:71], v[60:63]
  v_mfma_f32_16x16x32_bf16 v[60:63], v[152:155], a[64:67], v[60:63]
  ds_read_b64_tr_b16 v[184:185], v19 offset:16384
  ds_read_b64_tr_b16 v[186:187], v19 offset:20480
  v_mfma_f32_16x16x32_bf16 v[64:67], v[96:99], a[72:75], v[64:67]
  buffer_load_dwordx4 a[28:31], v1, s[8:11], s23 offen offset:3072
  v_mfma_f32_16x16x32_bf16 v[64:67], v[100:103], a[76:79], v[64:67]
  ds_read_b64_tr_b16 v[188:189], v19 offset:24576
  ds_read_b64_tr_b16 v[190:191], v19 offset:28672
  v_mfma_f32_16x16x32_bf16 v[68:71], v[108:111], a[76:79], v[68:71]
  s_sub_u32 s39, s39, 1
  s_cmp_eq_u32 s39, 0
  s_cselect_b32 s3, s64, s65
  v_mfma_f32_16x16x32_bf16 v[68:71], v[104:107], a[72:75], v[68:71]
  ds_read_b64_tr_b16 v[192:193], v20 offset:16384
  ds_read_b64_tr_b16 v[194:195], v20 offset:20480
  v_mfma_f32_16x16x32_bf16 v[72:75], v[112:115], a[72:75], v[72:75]
  s_add_u32 s23, s23, s3
  s_lshl_b32 s3, s3, 3
  s_add_u32 s25, s25, s3
  v_mfma_f32_16x16x32_bf16 v[72:75], v[116:119], a[76:79], v[72:75]
  ds_read_b64_tr_b16 v[196:197], v20 offset:24576
  ds_read_b64_tr_b16 v[198:199], v20 offset:28672
  v_mfma_f32_16x16x32_bf16 v[76:79], v[124:127], a[76:79], v[76:79]
  v_mfma_f32_16x16x32_bf16 v[76:79], v[120:123], a[72:75], v[76:79]
  ds_read_b64_tr_b16 v[200:201], v21 offset:16384
  ds_read_b64_tr_b16 v[202:203], v21 offset:20480
  v_mfma_f32_16x16x32_bf16 v[80:83], v[128:131], a[72:75], v[80:83]
  ds_read_b64_tr_b16 v[204:205], v21 offset:24576
  ds_read_b64_tr_b16 v[206:207], v21 offset:28672
  v_mfma_f32_16x16x32_bf16 v[80:83], v[132:135], a[76:79], v[80:83]
  ds_read_b64_tr_b16 v[208:209], v22 offset:16384
  ds_read_b64_tr_b16 v[210:211], v22 offset:20480
  v_mfma_f32_16x16x32_bf16 v[84:87], v[140:143], a[76:79], v[84:87]
  ds_read_b64_tr_b16 v[212:213], v22 offset:24576
  ds_read_b64_tr_b16 v[214:215], v22 offset:28672
  v_mfma_f32_16x16x32_bf16 v[84:87], v[136:139], a[72:75], v[84:87]
  ds_read_b64_tr_b16 v[216:217], v23 offset:16384
  ds_read_b64_tr_b16 v[218:219], v23 offset:20480
  v_mfma_f32_16x16x32_bf16 v[88:91], v[144:147], a[72:75], v[88:91]
  ds_read_b64_tr_b16 v[220:221], v23 offset:24576
  ds_read_b64_tr_b16 v[222:223], v23 offset:28672
  v_mfma_f32_16x16x32_bf16 v[88:91], v[148:151], a[76:79], v[88:91]
  v_mfma_f32_16x16x32_bf16 v[92:95], v[156:159], a[76:79], v[92:95]
  v_mfma_f32_16x16x32_bf16 v[92:95], v[152:155], a[72:75], v[92:95]
  s_waitcnt vmcnt(24) lgkmcnt(0)
  s_barrier
  v_mfma_f32_16x16x32_bf16 v[32:35], v[160:163], a[80:83], v[32:35]
  s_add_u32 m0, s41, 32768
  s_nop 0
  buffer_load_dwordx4 v2, s[12:15], s25 offen offset:0 lds
  v_mfma_f32_16x16x32_bf16 v[32:35], v[164:167], a[84:87], v[32:35]
  ds_read_b64_tr_b16 v[96:97], v16 offset:32768
  ds_read_b64_tr_b16 v[98:99], v16 offset:36864
  v_mfma_f32_16x16x32_bf16 v[36:39], v[172:175], a[84:87], v[36:39]
  buffer_load_dwordx4 v3, s[12:15], s25 offen offset:1024 lds
  v_mfma_f32_16x16x32_bf16 v[36:39], v[168:171], a[80:83], v[36:39]
  ds_read_b64_tr_b16 v[100:101], v16 offset:40960
  ds_read_b64_tr_b16 v[102:103], v16 offset:45056
  v_mfma_f32_16x16x32_bf16 v[40:43], v[176:179], a[80:83], v[40:43]
  buffer_load_dwordx4 v4, s[12:15], s25 offen offset:2048 lds
  v_mfma_f32_16x16x32_bf16 v[40:43], v[180:183], a[84:87], v[40:43]
  ds_read_b64_tr_b16 v[104:105], v17 offset:32768
  ds_read_b64_tr_b16 v[106:107], v17 offset:36864
  v_mfma_f32_16x16x32_bf16 v[44:47], v[188:191], a[84:87], v[44:47]
  buffer_load_dwordx4 v5, s[12:15], s25 offen offset:3072 lds
  v_mfma_f32_16x16x32_bf16 v[44:47], v[184:187], a[80:83], v[44:47]
  v_mfma_f32_16x16x32_bf16 v[48:51], v[192:195], a[80:83], v[48:51]
  ds_read_b64_tr_b16 v[108:109], v17 offset:40960
  ds_read_b64_tr_b16 v[110:111], v17 offset:45056
  v_mfma_f32_16x16x32_bf16 v[48:51], v[196:199], a[84:87], v[48:51]
  buffer_load_dwordx4 a[32:35], v1, s[8:11], s23 offen offset:0
  v_mfma_f32_16x16x32_bf16 v[52:55], v[204:207], a[84:87], v[52:55]
  ds_read_b64_tr_b16 v[112:113], v18 offset:32768
  ds_read_b64_tr_b16 v[114:115], v18 offset:36864
  v_mfma_f32_16x16x32_bf16 v[52:55], v[200:203], a[80:83], v[52:55]
  buffer_load_dwordx4 a[36:39], v1, s[8:11], s23 offen offset:1024
  v_mfma_f32_16x16x32_bf16 v[56:59], v[208:211], a[80:83], v[56:59]
  ds_read_b64_tr_b16 v[116:117], v18 offset:40960
  ds_read_b64_tr_b16 v[118:119], v18 offset:45056
  v_mfma_f32_16x16x32_bf16 v[56:59], v[212:215], a[84:87], v[56:59]
  buffer_load_dwordx4 a[40:43], v1, s[8:11], s23 offen offset:2048
  v_mfma_f32_16x16x32_bf16 v[60:63], v[220:223], a[84:87], v[60:63]
  v_mfma_f32_16x16x32_bf16 v[60:63], v[216:219], a[80:83], v[60:63]
  ds_read_b64_tr_b16 v[120:121], v19 offset:32768
  ds_read_b64_tr_b16 v[122:123], v19 offset:36864
  v_mfma_f32_16x16x32_bf16 v[64:67], v[160:163], a[88:91], v[64:67]
  buffer_load_dwordx4 a[44:47], v1, s[8:11], s23 offen offset:3072
  v_mfma_f32_16x16x32_bf16 v[64:67], v[164:167], a[92:95], v[64:67]
  ds_read_b64_tr_b16 v[124:125], v19 offset:40960
  ds_read_b64_tr_b16 v[126:127], v19 offset:45056
  v_mfma_f32_16x16x32_bf16 v[68:71], v[172:175], a[92:95], v[68:71]
  s_sub_u32 s39, s39, 1
  s_cmp_eq_u32 s39, 0
  s_cselect_b32 s3, s64, s65
  v_mfma_f32_16x16x32_bf16 v[68:71], v[168:171], a[88:91], v[68:71]
  ds_read_b64_tr_b16 v[128:129], v20 offset:32768
  ds_read_b64_tr_b16 v[130:131], v20 offset:36864
  v_mfma_f32_16x16x32_bf16 v[72:75], v[176:179], a[88:91], v[72:75]
  s_add_u32 s23, s23, s3
  s_lshl_b32 s3, s3, 3
  s_add_u32 s25, s25, s3
  v_mfma_f32_16x16x32_bf16 v[72:75], v[180:183], a[92:95], v[72:75]
  ds_read_b64_tr_b16 v[132:133], v20 offset:40960
  ds_read_b64_tr_b16 v[134:135], v20 offset:45056
  v_mfma_f32_16x16x32_bf16 v[76:79], v[188:191], a[92:95], v[76:79]
  v_mfma_f32_16x16x32_bf16 v[76:79], v[184:187], a[88:91], v[76:79]
  ds_read_b64_tr_b16 v[136:137], v21 offset:32768
  ds_read_b64_tr_b16 v[138:139], v21 offset:36864
  v_mfma_f32_16x16x32_bf16 v[80:83], v[192:195], a[88:91], v[80:83]
  ds_read_b64_tr_b16 v[140:141], v21 offset:40960
  ds_read_b64_tr_b16 v[142:143], v21 offset:45056
  v_mfma_f32_16x16x32_bf16 v[80:83], v[196:199], a[92:95], v[80:83]
  ds_read_b64_tr_b16 v[144:145], v22 offset:32768
  ds_read_b64_tr_b16 v[146:147], v22 offset:36864
  v_mfma_f32_16x16x32_bf16 v[84:87], v[204:207], a[92:95], v[84:87]
  ds_read_b64_tr_b16 v[148:149], v22 offset:40960
  ds_read_b64_tr_b16 v[150:151], v22 offset:45056
  v_mfma_f32_16x16x32_bf16 v[84:87], v[200:203], a[88:91], v[84:87]
  ds_read_b64_tr_b16 v[152:153], v23 offset:32768
  ds_read_b64_tr_b16 v[154:155], v23 offset:36864
  v_mfma_f32_16x16x32_bf16 v[88:91], v[208:211], a[88:91], v[88:91]
  ds_read_b64_tr_b16 v[156:157], v23 offset:40960
  ds_read_b64_tr_b16 v[158:159], v23 offset:45056
  v_mfma_f32_16x16x32_bf16 v[88:91], v[212:215], a[92:95], v[88:91]
  v_mfma_f32_16x16x32_bf16 v[92:95], v[220:223], a[92:95], v[92:95]
  v_mfma_f32_16x16x32_bf16 v[92:95], v[216:219], a[88:91], v[92:95]
  s_waitcnt vmcnt(24) lgkmcnt(0)
  s_barrier
  v_mfma_f32_16x16x32_bf16 v[32:35], v[96:99], a[96:99], v[32:35]
  s_add_u32 m0, s41, 49152
  s_nop 0
  buffer_load_dwordx4 v2, s[12:15], s25 offen offset:0 lds
  v_mfma_f32_16x16x32_bf16 v[32:35], v[100:103], a[100:103], v[32:35]
  ds_read_b64_tr_b16 v[160:161], v16 offset:49152
  ds_read_b64_tr_b16 v[162:163], v16 offset:53248
  v_mfma_f32_16x16x32_bf16 v[36:39], v[108:111], a[100:103], v[36:39]
  buffer_load_dwordx4 v3, s[12:15], s25 offen offset:1024 lds
  v_mfma_f32_16x16x32_bf16 v[36:39], v[104:107], a[96:99], v[36:39]
  ds_read_b64_tr_b16 v[164:165], v16 offset:57344
  ds_read_b64_tr_b16 v[166:167], v16 offset:61440
  v_mfma_f32_16x16x32_bf16 v[40:43], v[112:115], a[96:99], v[40:43]
  buffer_load_dwordx4 v4, s[12:15], s25 offen offset:2048 lds
  v_mfma_f32_16x16x32_bf16 v[40:43], v[116:119], a[100:103], v[40:43]
  ds_read_b64_tr_b16 v[168:169], v17 offset:49152
  ds_read_b64_tr_b16 v[170:171], v17 offset:53248
  v_mfma_f32_16x16x32_bf16 v[44:47], v[124:127], a[100:103], v[44:47]
  buffer_load_dwordx4 v5, s[12:15], s25 offen offset:3072 lds
  v_mfma_f32_16x16x32_bf16 v[44:47], v[120:123], a[96:99], v[44:47]
  v_mfma_f32_16x16x32_bf16 v[48:51], v[128:131], a[96:99], v[48:51]
  ds_read_b64_tr_b16 v[172:173], v17 offset:57344
  ds_read_b64_tr_b16 v[174:175], v17 offset:61440
  v_mfma_f32_16x16x32_bf16 v[48:51], v[132:135], a[100:103], v[48:51]
  buffer_load_dwordx4 a[48:51], v1, s[8:11], s23 offen offset:0
  v_mfma_f32_16x16x32_bf16 v[52:55], v[140:143], a[100:103], v[52:55]
  ds_read_b64_tr_b16 v[176:177], v18 offset:49152
  ds_read_b64_tr_b16 v[178:179], v18 offset:53248
  v_mfma_f32_16x16x32_bf16 v[52:55], v[136:139], a[96:99], v[52:55]
  buffer_load_dwordx4 a[52:55], v1, s[8:11], s23 offen offset:1024
  v_mfma_f32_16x16x32_bf16 v[56:59], v[144:147], a[96:99], v[56:59]
  ds_read_b64_tr_b16 v[180:181], v18 offset:57344
  ds_read_b64_tr_b16 v[182:183], v18 offset:61440
  v_mfma_f32_16x16x32_bf16 v[56:59], v[148:151], a[100:103], v[56:59]
  buffer_load_dwordx4 a[56:59], v1, s[8:11], s23 offen offset:2048
  v_mfma_f32_16x16x32_bf16 v[60:63], v[156:159], a[100:103], v[60:63]
  v_mfma_f32_16x16x32_bf16 v[60:63], v[152:155], a[96:99], v[60:63]
  ds_read_b64_tr_b16 v[184:185], v19 offset:49152
  ds_read_b64_tr_b16 v[186:187], v19 offset:53248
  v_mfma_f32_16x16x32_bf16 v[64:67], v[96:99], a[104:107], v[64:67]
  buffer_load_dwordx4 a[60:63], v1, s[8:11], s23 offen offset:3072
  v_mfma_f32_16x16x32_bf16 v[64:67], v[100:103], a[108:111], v[64:67]
  ds_read_b64_tr_b16 v[188:189], v19 offset:57344
  ds_read_b64_tr_b16 v[190:191], v19 offset:61440
  v_mfma_f32_16x16x32_bf16 v[68:71], v[108:111], a[108:111], v[68:71]
  s_sub_u32 s39, s39, 1
  s_cmp_eq_u32 s39, 0
  s_cselect_b32 s3, s64, s65
  v_mfma_f32_16x16x32_bf16 v[68:71], v[104:107], a[104:107], v[68:71]
  ds_read_b64_tr_b16 v[192:193], v20 offset:49152
  ds_read_b64_tr_b16 v[194:195], v20 offset:53248
  v_mfma_f32_16x16x32_bf16 v[72:75], v[112:115], a[104:107], v[72:75]
  s_add_u32 s23, s23, s3
  s_lshl_b32 s3, s3, 3
  s_add_u32 s25, s25, s3
  v_mfma_f32_16x16x32_bf16 v[72:75], v[116:119], a[108:111], v[72:75]
  ds_read_b64_tr_b16 v[196:197], v20 offset:57344
  ds_read_b64_tr_b16 v[198:199], v20 offset:61440
  v_mfma_f32_16x16x32_bf16 v[76:79], v[124:127], a[108:111], v[76:79]
  v_mfma_f32_16x16x32_bf16 v[76:79], v[120:123], a[104:107], v[76:79]
  ds_read_b64_tr_b16 v[200:201], v21 offset:49152
  ds_read_b64_tr_b16 v[202:203], v21 offset:53248
  v_mfma_f32_16x16x32_bf16 v[80:83], v[128:131], a[104:107], v[80:83]
  ds_read_b64_tr_b16 v[204:205], v21 offset:57344
  ds_read_b64_tr_b16 v[206:207], v21 offset:61440
  v_mfma_f32_16x16x32_bf16 v[80:83], v[132:135], a[108:111], v[80:83]
  ds_read_b64_tr_b16 v[208:209], v22 offset:49152
  ds_read_b64_tr_b16 v[210:211], v22 offset:53248
  v_mfma_f32_16x16x32_bf16 v[84:87], v[140:143], a[108:111], v[84:87]
  ds_read_b64_tr_b16 v[212:213], v22 offset:57344
  ds_read_b64_tr_b16 v[214:215], v22 offset:61440
  v_mfma_f32_16x16x32_bf16 v[84:87], v[136:139], a[104:107], v[84:87]
  ds_read_b64_tr_b16 v[216:217], v23 offset:49152
  ds_read_b64_tr_b16 v[218:219], v23 offset:53248
  v_mfma_f32_16x16x32_bf16 v[88:91], v[144:147], a[104:107], v[88:91]
  ds_read_b64_tr_b16 v[220:221], v23 offset:57344
  ds_read_b64_tr_b16 v[222:223], v23 offset:61440
  v_mfma_f32_16x16x32_bf16 v[88:91], v[148:151], a[108:111], v[88:91]
  v_mfma_f32_16x16x32_bf16 v[92:95], v[156:159], a[108:111], v[92:95]
  v_mfma_f32_16x16x32_bf16 v[92:95], v[152:155], a[104:107], v[92:95]
  s_waitcnt vmcnt(24) lgkmcnt(0)
  s_barrier
  v_mfma_f32_16x16x32_bf16 v[32:35], v[160:163], a[112:115], v[32:35]
  s_add_u32 m0, s41, 65536
  s_nop 0
  buffer_load_dwordx4 v2, s[12:15], s25 offen offset:0 lds
  v_mfma_f32_16x16x32_bf16 v[32:35], v[164:167], a[116:119], v[32:35]
  ds_read_b64_tr_b16 v[96:97], v8 offset:0
  ds_read_b64_tr_b16 v[98:99], v8 offset:4096
  v_mfma_f32_16x16x32_bf16 v[36:39], v[172:175], a[116:119], v[36:39]
  buffer_load_dwordx4 v3, s[12:15], s25 offen offset:1024 lds
  v_mfma_f32_16x16x32_bf16 v[36:39], v[168:171], a[112:115], v[36:39]
  ds_read_b64_tr_b16 v[100:101], v8 offset:8192
  ds_read_b64_tr_b16 v[102:103], v8 offset:12288
  v_mfma_f32_16x16x32_bf16 v[40:43], v[176:179], a[112:115], v[40:43]
  buffer_load_dwordx4 v4, s[12:15], s25 offen offset:2048 lds
  v_mfma_f32_16x16x32_bf16 v[40:43], v[180:183], a[116:119], v[40:43]
  ds_read_b64_tr_b16 v[104:105], v9 offset:0
  ds_read_b64_tr_b16 v[106:107], v9 offset:4096
  v_mfma_f32_16x16x32_bf16 v[44:47], v[188:191], a[116:119], v[44:47]
  buffer_load_dwordx4 v5, s[12:15], s25 offen offset:3072 lds
  v_mfma_f32_16x16x32_bf16 v[44:47], v[184:187], a[112:115], v[44:47]
  v_mfma_f32_16x16x32_bf16 v[48:51], v[192:195], a[112:115], v[48:51]
  ds_read_b64_tr_b16 v[108:109], v9 offset:8192
  ds_read_b64_tr_b16 v[110:111], v9 offset:12288
  v_mfma_f32_16x16x32_bf16 v[48:51], v[196:199], a[116:119], v[48:51]
  buffer_load_dwordx4 a[64:67], v1, s[8:11], s23 offen offset:0
  v_mfma_f32_16x16x32_bf16 v[52:55], v[204:207], a[116:119], v[52:55]
  ds_read_b64_tr_b16 v[112:113], v10 offset:0
  ds_read_b64_tr_b16 v[114:115], v10 offset:4096
  v_mfma_f32_16x16x32_bf16 v[52:55], v[200:203], a[112:115], v[52:55]
  buffer_load_dwordx4 a[68:71], v1, s[8:11], s23 offen offset:1024
  v_mfma_f32_16x16x32_bf16 v[56:59], v[208:211], a[112:115], v[56:59]
  ds_read_b64_tr_b16 v[116:117], v10 offset:8192
  ds_read_b64_tr_b16 v[118:119], v10 offset:12288
  v_mfma_f32_16x16x32_bf16 v[56:59], v[212:215], a[116:119], v[56:59]
  buffer_load_dwordx4 a[72:75], v1, s[8:11], s23 offen offset:2048
  v_mfma_f32_16x16x32_bf16 v[60:63], v[220:223], a[116:119], v[60:63]
  v_mfma_f32_16x16x32_bf16 v[60:63], v[216:219], a[112:115], v[60:63]
  ds_read_b64_tr_b16 v[120:121], v11 offset:0
  ds_read_b64_tr_b16 v[122:123], v11 offset:4096
  v_mfma_f32_16x16x32_bf16 v[64:67], v[160:163], a[120:123], v[64:67]
  buffer_load_dwordx4 a[76:79], v1, s[8:11], s23 offen offset:3072
  v_mfma_f32_16x16x32_bf16 v[64:67], v[164:167], a[124:127], v[64:67]
  ds_read_b64_tr_b16 v[124:125], v11 offset:8192
  ds_read_b64_tr_b16 v[126:127], v11 offset:12288
  v_mfma_f32_16x16x32_bf16 v[68:71], v[172:175], a[124:127], v[68:71]
  s_sub_u32 s39, s39, 1
  s_cmp_eq_u32 s39, 0
  s_cselect_b32 s3, s64, s65
  v_mfma_f32_16x16x32_bf16 v[68:71], v[168:171], a[120:123], v[68:71]
  ds_read_b64_tr_b16 v[128:129], v12 offset:0
  ds_read_b64_tr_b16 v[130:131], v12 offset:4096
  v_mfma_f32_16x16x32_bf16 v[72:75], v[176:179], a[120:123], v[72:75]
  s_add_u32 s23, s23, s3
  s_lshl_b32 s3, s3, 3
  s_add_u32 s25, s25, s3
  v_mfma_f32_16x16x32_bf16 v[72:75], v[180:183], a[124:127], v[72:75]
  ds_read_b64_tr_b16 v[132:133], v12 offset:8192
  ds_read_b64_tr_b16 v[134:135], v12 offset:12288
  v_mfma_f32_16x16x32_bf16 v[76:79], v[188:191], a[124:127], v[76:79]
  v_mfma_f32_16x16x32_bf16 v[76:79], v[184:187], a[120:123], v[76:79]
  ds_read_b64_tr_b16 v[136:137], v13 offset:0
  ds_read_b64_tr_b16 v[138:139], v13 offset:4096
  v_mfma_f32_16x16x32_bf16 v[80:83], v[192:195], a[120:123], v[80:83]
  ds_read_b64_tr_b16 v[140:141], v13 offset:8192
  ds_read_b64_tr_b16 v[142:143], v13 offset:12288
  v_mfma_f32_16x16x32_bf16 v[80:83], v[196:199], a[124:127], v[80:83]
  ds_read_b64_tr_b16 v[144:145], v14 offset:0
  ds_read_b64_tr_b16 v[146:147], v14 offset:4096
  v_mfma_f32_16x16x32_bf16 v[84:87], v[204:207], a[124:127], v[84:87]
  ds_read_b64_tr_b16 v[148:149], v14 offset:8192
  ds_read_b64_tr_b16 v[150:151], v14 offset:12288
  v_mfma_f32_16x16x32_bf16 v[84:87], v[200:203], a[120:123], v[84:87]
  ds_read_b64_tr_b16 v[152:153], v15 offset:0
  ds_read_b64_tr_b16 v[154:155], v15 offset:4096
  v_mfma_f32_16x16x32_bf16 v[88:91], v[208:211], a[120:123], v[88:91]
  ds_read_b64_tr_b16 v[156:157], v15 offset:8192
  ds_read_b64_tr_b16 v[158:159], v15 offset:12288
  v_mfma_f32_16x16x32_bf16 v[88:91], v[212:215], a[124:127], v[88:91]
  v_mfma_f32_16x16x32_bf16 v[92:95], v[220:223], a[124:127], v[92:95]
  v_mfma_f32_16x16x32_bf16 v[92:95], v[216:219], a[120:123], v[92:95]
  s_mov_b32 s28, 2
Lk3_la:
  s_waitcnt vmcnt(24) lgkmcnt(0)
  s_barrier
  v_mfma_f32_16x16x32_bf16 v[32:35], v[96:99], a[0:3], v[32:35]
  s_add_u32 m0, s41, 81920
  s_nop 0
  buffer_load_dwordx4 v2, s[12:15], s25 offen offset:0 lds
  v_mfma_f32_16x16x32_bf16 v[32:35], v[100:103], a[4:7], v[32:35]
  ds_read_b64_tr_b16 v[160:161], v8 offset:16384
  ds_read_b64_tr_b16 v[162:163], v8 offset:20480
  v_mfma_f32_16x16x32_bf16 v[36:39], v[108:111], a[4:7], v[36:39]
  buffer_load_dwordx4 v3, s[12:15], s25 offen offset:1024 lds
  v_mfma_f32_16x16x32_bf16 v[36:39], v[104:107], a[0:3], v[36:39]
  ds_read_b64_tr_b16 v[164:165], v8 offset:24576
  ds_read_b64_tr_b16 v[166:167], v8 offset:28672
  v_mfma_f32_16x16x32_bf16 v[40:43], v[112:115], a[0:3], v[40:43]
  buffer_load_dwordx4 v4, s[12:15], s25 offen offset:2048 lds
  v_mfma_f32_16x16x32_bf16 v[40:43], v[116:119], a[4:7], v[40:43]
  ds_read_b64_tr_b16 v[168:169], v9 offset:16384
  ds_read_b64_tr_b16 v[170:171], v9 offset:20480
  v_mfma_f32_16x16x32_bf16 v[44:47], v[124:127], a[4:7], v[44:47]
  buffer_load_dwordx4 v5, s[12:15], s25 offen offset:3072 lds
  v_mfma_f32_16x16x32_bf16 v[44:47], v[120:123], a[0:3], v[44:47]
  v_mfma_f32_16x16x32_bf16 v[48:51], v[128:131], a[0:3], v[48:51]
  ds_read_b64_tr_b16 v[172:173], v9 offset:24576
  ds_read_b64_tr_b16 v[174:175], v9 offset:28672
  v_mfma_f32_16x16x32_bf16 v[48:51], v[132:135], a[4:7], v[48:51]
  buffer_load_dwordx4 a[80:83], v1, s[8:11], s23 offen offset:0
  v_mfma_f32_16x16x32_bf16 v[52:55], v[140:143], a[4:7], v[52:55]
  ds_read_b64_tr_b16 v[176:177], v10 offset:16384
  ds_read_b64_tr_b16 v[178:179], v10 offset:20480
  v_mfma_f32_16x16x32_bf16 v[52:55], v[136:139], a[0:3], v[52:55]
  buffer_load_dwordx4 a[84:87], v1, s[8:11], s23 offen offset:1024
  v_mfma_f32_16x16x32_bf16 v[56:59], v[144:147], a[0:3], v[56:59]
  ds_read_b64_tr_b16 v[180:181], v10 offset:24576
  ds_read_b64_tr_b16 v[182:183], v10 offset:28672
  v_mfma_f32_16x16x32_bf16 v[56:59], v[148:151], a[4:7], v[56:59]
  buffer_load_dwordx4 a[88:91], v1, s[8:11], s23 offen offset:2048
  v_mfma_f32_16x16x32_bf16 v[60:63], v[156:159], a[4:7], v[60:63]
  v_mfma_f32_16x16x32_bf16 v[60:63], v[152:155], a[0:3], v[60:63]
  ds_read_b64_tr_b16 v[184:185], v11 offset:16384
  ds_read_b64_tr_b16 v[186:187], v11 offset:20480
  v_mfma_f32_16x16x32_bf16 v[64:67], v[96:99], a[8:11], v[64:67]
  buffer_load_dwordx4 a[92:95], v1, s[8:11], s23 offen offset:3072
  v_mfma_f32_16x16x32_bf16 v[64:67], v[100:103], a[12:15], v[64:67]
  ds_read_b64_tr_b16 v[188:189], v11 offset:24576
  ds_read_b64_tr_b16 v[190:191], v11 offset:28672
  v_mfma_f32_16x16x32_bf16 v[68:71], v[108:111], a[12:15], v[68:71]
  s_sub_u32 s39, s39, 1
  s_cmp_eq_u32 s39, 0
  s_cselect_b32 s3, s64, s65
  v_mfma_f32_16x16x32_bf16 v[68:71], v[104:107], a[8:11], v[68:71]
  ds_read_b64_tr_b16 v[192:193], v12 offset:16384
  ds_read_b64_tr_b16 v[194:195], v12 offset:20480
  v_mfma_f32_16x16x32_bf16 v[72:75], v[112:115], a[8:11], v[72:75]
  s_add_u32 s23, s23, s3
  s_lshl_b32 s3, s3, 3
  s_add_u32 s25, s25, s3
  v_mfma_f32_16x16x32_bf16 v[72:75], v[116:119], a[12:15], v[72:75]
  ds_read_b64_tr_b16 v[196:197], v12 offset:24576
  ds_read_b64_tr_b16 v[198:199], v12 offset:28672
  v_mfma_f32_16x16x32_bf16 v[76:79], v[124:127], a[12:15], v[76:79]
  v_mfma_f32_16x16x32_bf16 v[76:79], v[120:123], a[8:11], v[76:79]
  ds_read_b64_tr_b16 v[200:201], v13 offset:16384
  ds_read_b64_tr_b16 v[202:203], v13 offset:20480
  v_mfma_f32_16x16x32_bf16 v[80:83], v[128:131], a[8:11], v[80:83]
  ds_read_b64_tr_b16 v[204:205], v13 offset:24576
  ds_read_b64_tr_b16 v[206:207], v13 offset:28672
  v_mfma_f32_16x16x32_bf16 v[80:83], v[132:135], a[12:15], v[80:83]
  ds_read_b64_tr_b16 v[208:209], v14 offset:16384
  ds_read_b64_tr_b16 v[210:211], v14 offset:20480
  v_mfma_f32_16x16x32_bf16 v[84:87], v[140:143], a[12:15], v[84:87]
  ds_read_b64_tr_b16 v[212:213], v14 offset:24576
  ds_read_b64_tr_b16 v[214:215], v14 offset:28672
  v_mfma_f32_16x16x32_bf16 v[84:87], v[136:139], a[8:11], v[84:87]
  ds_read_b64_tr_b16 v[216:217], v15 offset:16384
  ds_read_b64_tr_b16 v[218:219], v15 offset:20480
  v_mfma_f32_16x16x32_bf16 v[88:91], v[144:147], a[8:11], v[88:91]
  ds_read_b64_tr_b16 v[220:221], v15 offset:24576
  ds_read_b64_tr_b16 v[222:223], v15 offset:28672
  v_mfma_f32_16x16x32_bf16 v[88:91], v[148:151], a[12:15], v[88:91]
  v_mfma_f32_16x16x32_bf16 v[92:95], v[156:159], a[12:15], v[92:95]
  v_mfma_f32_16x16x32_bf16 v[92:95], v[152:155], a[8:11], v[92:95]
  s_waitcnt vmcnt(24) lgkmcnt(0)
  s_barrier
  v_mfma_f32_16x16x32_bf16 v[32:35], v[160:163], a[16:19], v[32:35]
  s_add_u32 m0, s41, 98304
  s_nop 0
  buffer_load_dwordx4 v2, s[12:15], s25 offen offset:0 lds
  v_mfma_f32_16x16x32_bf16 v[32:35], v[164:167], a[20:23], v[32:35]
  ds_read_b64_tr_b16 v[96:97], v8 offset:32768
  ds_read_b64_tr_b16 v[98:99], v8 offset:36864
  v_mfma_f32_16x16x32_bf16 v[36:39], v[172:175], a[20:23], v[36:39]
  buffer_load_dwordx4 v3, s[12:15], s25 offen offset:1024 lds
  v_mfma_f32_16x16x32_bf16 v[36:39], v[168:171], a[16:19], v[36:39]
  ds_read_b64_tr_b16 v[100:101], v8 offset:40960
  ds_read_b64_tr_b16 v[102:103], v8 offset:45056
  v_mfma_f32_16x16x32_bf16 v[40:43], v[176:179], a[16:19], v[40:43]
  buffer_load_dwordx4 v4, s[12:15], s25 offen offset:2048 lds
  v_mfma_f32_16x16x32_bf16 v[40:43], v[180:183], a[20:23], v[40:43]
  ds_read_b64_tr_b16 v[104:105], v9 offset:32768
  ds_read_b64_tr_b16 v[106:107], v9 offset:36864
  v_mfma_f32_16x16x32_bf16 v[44:47], v[188:191], a[20:23], v[44:47]
  buffer_load_dwordx4 v5, s[12:15], s25 offen offset:3072 lds
  v_mfma_f32_16x16x32_bf16 v[44:47], v[184:187], a[16:19], v[44:47]
  v_mfma_f32_16x16x32_bf16 v[48:51], v[192:195], a[16:19], v[48:51]
  ds_read_b64_tr_b16 v[108:109], v9 offset:40960
  ds_read_b64_tr_b16 v[110:111], v9 offset:45056
  v_mfma_f32_16x16x32_bf16 v[48:51], v[196:199], a[20:23], v[48:51]
  buffer_load_dwordx4 a[96:99], v1, s[8:11], s23 offen offset:0
  v_mfma_f32_16x16x32_bf16 v[52:55], v[204:207], a[20:23], v[52:55]
  ds_read_b64_tr_b16 v[112:113], v10 offset:32768
  ds_read_b64_tr_b16 v[114:115], v10 offset:36864
  v_mfma_f32_16x16x32_bf16 v[52:55], v[200:203], a[16:19], v[52:55]
  buffer_load_dwordx4 a[100:103], v1, s[8:11], s23 offen offset:1024
  v_mfma_f32_16x16x32_bf16 v[56:59], v[208:211], a[16:19], v[56:59]
  ds_read_b64_tr_b16 v[116:117], v10 offset:40960
  ds_read_b64_tr_b16 v[118:119], v10 offset:45056
  v_mfma_f32_16x16x32_bf16 v[56:59], v[212:215], a[20:23], v[56:59]
  buffer_load_dwordx4 a[104:107], v1, s[8:11], s23 offen offset:2048
  v_mfma_f32_16x16x32_bf16 v[60:63], v[220:223], a[20:23], v[60:63]
  v_mfma_f32_16x16x32_bf16 v[60:63], v[216:219], a[16:19], v[60:63]
  ds_read_b64_tr_b16 v[120:121], v11 offset:32768
  ds_read_b64_tr_b16 v[122:123], v11 offset:36864
  v_mfma_f32_16x16x32_bf16 v[64:67], v[160:163], a[24:27], v[64:67]
  buffer_load_dwordx4 a[108:111], v1, s[8:11], s23 offen offset:3072
  v_mfma_f32_16x16x32_bf16 v[64:67], v[164:167], a[28:31], v[64:67]
  ds_read_b64_tr_b16 v[124:125], v11 offset:40960
  ds_read_b64_tr_b16 v[126:127], v11 offset:45056
  v_mfma_f32_16x16x32_bf16 v[68:71], v[172:175], a[28:31], v[68:71]
  s_sub_u32 s39, s39, 1
  s_cmp_eq_u32 s39, 0
  s_cselect_b32 s3, s64, s65
  v_mfma_f32_16x16x32_bf16 v[68:71], v[168:171], a[24:27], v[68:71]
  ds_read_b64_tr_b16 v[128:129], v12 offset:32768
  ds_read_b64_tr_b16 v[130:131], v12 offset:36864
  v_mfma_f32_16x16x32_bf16 v[72:75], v[176:179], a[24:27], v[72:75]
  s_add_u32 s23, s23, s3
  s_lshl_b32 s3, s3, 3
  s_add_u32 s25, s25, s3
  v_mfma_f32_16x16x32_bf16 v[72:75], v[180:183], a[28:31], v[72:75]
  ds_read_b64_tr_b16 v[132:133], v12 offset:40960
  ds_read_b64_tr_b16 v[134:135], v12 offset:45056
  v_mfma_f32_16x16x32_bf16 v[76:79], v[188:191], a[28:31], v[76:79]
  v_mfma_f32_16x16x32_bf16 v[76:79], v[184:187], a[24:27], v[76:79]
  ds_read_b64_tr_b16 v[136:137], v13 offset:32768
  ds_read_b64_tr_b16 v[138:139], v13 offset:36864
  v_mfma_f32_16x16x32_bf16 v[80:83], v[192:195], a[24:27], v[80:83]
  ds_read_b64_tr_b16 v[140:141], v13 offset:40960
  ds_read_b64_tr_b16 v[142:143], v13 offset:45056
  v_mfma_f32_16x16x32_bf16 v[80:83], v[196:199], a[28:31], v[80:83]
  ds_read_b64_tr_b16 v[144:145], v14 offset:32768
  ds_read_b64_tr_b16 v[146:147], v14 offset:36864
  v_mfma_f32_16x16x32_bf16 v[84:87], v[204:207], a[28:31], v[84:87]
  ds_read_b64_tr_b16 v[148:149], v14 offset:40960
  ds_read_b64_tr_b16 v[150:151], v14 offset:45056
  v_mfma_f32_16x16x32_bf16 v[84:87], v[200:203], a[24:27], v[84:87]
  ds_read_b64_tr_b16 v[152:153], v15 offset:32768
  ds_read_b64_tr_b16 v[154:155], v15 offset:36864
  v_mfma_f32_16x16x32_bf16 v[88:91], v[208:211], a[24:27], v[88:91]
  ds_read_b64_tr_b16 v[156:157], v15 offset:40960
  ds_read_b64_tr_b16 v[158:159], v15 offset:45056
  v_mfma_f32_16x16x32_bf16 v[88:91], v[212:215], a[28:31], v[88:91]
  v_mfma_f32_16x16x32_bf16 v[92:95], v[220:223], a[28:31], v[92:95]
  v_mfma_f32_16x16x32_bf16 v[92:95], v[216:219], a[24:27], v[92:95]
  s_waitcnt vmcnt(24) lgkmcnt(0)
  s_barrier
  v_mfma_f32_16x16x32_bf16 v[32:35], v[96:99], a[32:35], v[32:35]
  s_add_u32 m0, s41, 114688
  s_nop 0
  buffer_load_dwordx4 v2, s[12:15], s25 offen offset:0 lds
  v_mfma_f32_16x16x32_bf16 v[32:35], v[100:103], a[36:39], v[32:35]
  ds_read_b64_tr_b16 v[160:161], v8 offset:49152
  ds_read_b64_tr_b16 v[162:163], v8 offset:53248
  v_mfma_f32_16x16x32_bf16 v[36:39], v[108:111], a[36:39], v[36:39]
  buffer_load_dwordx4 v3, s[12:15], s25 offen offset:1024 lds
  v_mfma_f32_16x16x32_bf16 v[36:39], v[104:107], a[32:35], v[36:39]
  ds_read_b64_tr_b16 v[164:165], v8 offset:57344
  ds_read_b64_tr_b16 v[166:167], v8 offset:61440
  v_mfma_f32_16x16x32_bf16 v[40:43], v[112:115], a[32:35], v[40:43]
  buffer_load_dwordx4 v4, s[12:15], s25 offen offset:2048 lds
  v_mfma_f32_16x16x32_bf16 v[40:43], v[116:119], a[36:39], v[40:43]
  ds_read_b64_tr_b16 v[168:169], v9 offset:49152
  ds_read_b64_tr_b16 v[170:171], v9 offset:53248
  v_mfma_f32_16x16x32_bf16 v[44:47], v[124:127], a[36:39], v[44:47]
  buffer_load_dwordx4 v5, s[12:15], s25 offen offset:3072 lds
  v_mfma_f32_16x16x32_bf16 v[44:47], v[120:123], a[32:35], v[44:47]
  v_mfma_f32_16x16x32_bf16 v[48:51], v[128:131], a[32:35], v[48:51]
  ds_read_b64_tr_b16 v[172:173], v9 offset:57344
  ds_read_b64_tr_b16 v[174:175], v9 offset:61440
  v_mfma_f32_16x16x32_bf16 v[48:51], v[132:135], a[36:39], v[48:51]
  buffer_load_dwordx4 a[112:115], v1, s[8:11], s23 offen offset:0
  v_mfma_f32_16x16x32_bf16 v[52:55], v[140:143], a[36:39], v[52:55]
  ds_read_b64_tr_b16 v[176:177], v10 offset:49152
  ds_read_b64_tr_b16 v[178:179], v10 offset:53248
  v_mfma_f32_16x16x32_bf16 v[52:55], v[136:139], a[32:35], v[52:55]
  buffer_load_dwordx4 a[116:119], v1, s[8:11], s23 offen offset:1024
  v_mfma_f32_16x16x32_bf16 v[56:59], v[144:147], a[32:35], v[56:59]
  ds_read_b64_tr_b16 v[180:181], v10 offset:57344
  ds_read_b64_tr_b16 v[182:183], v10 offset:61440
  v_mfma_f32_16x16x32_bf16 v[56:59], v[148:151], a[36:39], v[56:59]
  buffer_load_dwordx4 a[120:123], v1, s[8:11], s23 offen offset:2048
  v_mfma_f32_16x16x32_bf16 v[60:63], v[156:159], a[36:39], v[60:63]
  v_mfma_f32_16x16x32_bf16 v[60:63], v[152:155], a[32:35], v[60:63]
  ds_read_b64_tr_b16 v[184:185], v11 offset:49152
  ds_read_b64_tr_b16 v[186:187], v11 offset:53248
  v_mfma_f32_16x16x32_bf16 v[64:67], v[96:99], a[40:43], v[64:67]
  buffer_load_dwordx4 a[124:127], v1, s[8:11], s23 offen offset:3072
  v_mfma_f32_16x16x32_bf16 v[64:67], v[100:103], a[44:47], v[64:67]
  ds_read_b64_tr_b16 v[188:189], v11 offset:57344
  ds_read_b64_tr_b16 v[190:191], v11 offset:61440
  v_mfma_f32_16x16x32_bf16 v[68:71], v[108:111], a[44:47], v[68:71]
  s_sub_u32 s39, s39, 1
  s_cmp_eq_u32 s39, 0
  s_cselect_b32 s3, s64, s65
  v_mfma_f32_16x16x32_bf16 v[68:71], v[104:107], a[40:43], v[68:71]
  ds_read_b64_tr_b16 v[192:193], v12 offset:49152
  ds_read_b64_tr_b16 v[194:195], v12 offset:53248
  v_mfma_f32_16x16x32_bf16 v[72:75], v[112:115], a[40:43], v[72:75]
  s_add_u32 s23, s23, s3
  s_lshl_b32 s3, s3, 3
  s_add_u32 s25, s25, s3
  v_mfma_f32_16x16x32_bf16 v[72:75], v[116:119], a[44:47], v[72:75]
  ds_read_b64_tr_b16 v[196:197], v12 offset:57344
  ds_read_b64_tr_b16 v[198:199], v12 offset:61440
  v_mfma_f32_16x16x32_bf16 v[76:79], v[124:127], a[44:47], v[76:79]
  v_mfma_f32_16x16x32_bf16 v[76:79], v[120:123], a[40:43], v[76:79]
  ds_read_b64_tr_b16 v[200:201], v13 offset:49152
  ds_read_b64_tr_b16 v[202:203], v13 offset:53248
  v_mfma_f32_16x16x32_bf16 v[80:83], v[128:131], a[40:43], v[80:83]
  ds_read_b64_tr_b16 v[204:205], v13 offset:57344
  ds_read_b64_tr_b16 v[206:207], v13 offset:61440
  v_mfma_f32_16x16x32_bf16 v[80:83], v[132:135], a[44:47], v[80:83]
  ds_read_b64_tr_b16 v[208:209], v14 offset:49152
  ds_read_b64_tr_b16 v[210:211], v14 offset:53248
  v_mfma_f32_16x16x32_bf16 v[84:87], v[140:143], a[44:47], v[84:87]
  ds_read_b64_tr_b16 v[212:213], v14 offset:57344
  ds_read_b64_tr_b16 v[214:215], v14 offset:61440
  v_mfma_f32_16x16x32_bf16 v[84:87], v[136:139], a[40:43], v[84:87]
  ds_read_b64_tr_b16 v[216:217], v15 offset:49152
  ds_read_b64_tr_b16 v[218:219], v15 offset:53248
  v_mfma_f32_16x16x32_bf16 v[88:91], v[144:147], a[40:43], v[88:91]
  ds_read_b64_tr_b16 v[220:221], v15 offset:57344
  ds_read_b64_tr_b16 v[222:223], v15 offset:61440
  v_mfma_f32_16x16x32_bf16 v[88:91], v[148:151], a[44:47], v[88:91]
  v_mfma_f32_16x16x32_bf16 v[92:95], v[156:159], a[44:47], v[92:95]
  v_mfma_f32_16x16x32_bf16 v[92:95], v[152:155], a[40:43], v[92:95]
  s_waitcnt vmcnt(24) lgkmcnt(0)
  s_barrier
  v_mfma_f32_16x16x32_bf16 v[32:35], v[160:163], a[48:51], v[32:35]
  s_add_u32 m0, s41, 0
  s_nop 0
  buffer_load_dwordx4 v2, s[12:15], s25 offen offset:0 lds
  v_mfma_f32_16x16x32_bf16 v[32:35], v[164:167], a[52:55], v[32:35]
  ds_read_b64_tr_b16 v[96:97], v16 offset:0
  ds_read_b64_tr_b16 v[98:99], v16 offset:4096
  v_mfma_f32_16x16x32_bf16 v[36:39], v[172:175], a[52:55], v[36:39]
  buffer_load_dwordx4 v3, s[12:15], s25 offen offset:1024 lds
  v_mfma_f32_16x16x32_bf16 v[36:39], v[168:171], a[48:51], v[36:39]
  ds_read_b64_tr_b16 v[100:101], v16 offset:8192
  ds_read_b64_tr_b16 v[102:103], v16 offset:12288
  v_mfma_f32_16x16x32_bf16 v[40:43], v[176:179], a[48:51], v[40:43]
  buffer_load_dwordx4 v4, s[12:15], s25 offen offset:2048 lds
  v_mfma_f32_16x16x32_bf16 v[40:43], v[180:183], a[52:55], v[40:43]
  ds_read_b64_tr_b16 v[104:105], v17 offset:0
  ds_read_b64_tr_b16 v[106:107], v17 offset:4096
  v_mfma_f32_16x16x32_bf16 v[44:47], v[188:191], a[52:55], v[44:47]
  buffer_load_dwordx4 v5, s[12:15], s25 offen offset:3072 lds
  v_mfma_f32_16x16x32_bf16 v[44:47], v[184:187], a[48:51], v[44:47]
  v_mfma_f32_16x16x32_bf16 v[48:51], v[192:195], a[48:51], v[48:51]
  ds_read_b64_tr_b16 v[108:109], v17 offset:8192
  ds_read_b64_tr_b16 v[110:111], v17 offset:12288
  v_mfma_f32_16x16x32_bf16 v[48:51], v[196:199], a[52:55], v[48:51]
  buffer_load_dwordx4 a[0:3], v1, s[8:11], s23 offen offset:0
  v_mfma_f32_16x16x32_bf16 v[52:55], v[204:207], a[52:55], v[52:55]
  ds_read_b64_tr_b16 v[112:113], v18 offset:0
  ds_read_b64_tr_b16 v[114:115], v18 offset:4096
  v_mfma_f32_16x16x32_bf16 v[52:55], v[200:203], a[48:51], v[52:55]
  buffer_load_dwordx4 a[4:7], v1, s[8:11], s23 offen offset:1024
  v_mfma_f32_16x16x32_bf16 v[56:59], v[208:211], a[48:51], v[56:59]
  ds_read_b64_tr_b16 v[116:117], v18 offset:8192
  ds_read_b64_tr_b16 v[118:119], v18 offset:12288
  v_mfma_f32_16x16x32_bf16 v[56:59], v[212:215], a[52:55], v[56:59]
  buffer_load_dwordx4 a[8:11], v1, s[8:11], s23 offen offset:2048
  v_mfma_f32_16x16x32_bf16 v[60:63], v[220:223], a[52:55], v[60:63]
  v_mfma_f32_16x16x32_bf16 v[60:63], v[216:219], a[48:51], v[60:63]
  ds_read_b64_tr_b16 v[120:121], v19 offset:0
  ds_read_b64_tr_b16 v[122:123], v19 offset:4096
  v_mfma_f32_16x16x32_bf16 v[64:67], v[160:163], a[56:59], v[64:67]
  buffer_load_dwordx4 a[12:15], v1, s[8:11], s23 offen offset:3072
  v_mfma_f32_16x16x32_bf16 v[64:67], v[164:167], a[60:63], v[64:67]
  ds_read_b64_tr_b16 v[124:125], v19 offset:8192
  ds_read_b64_tr_b16 v[126:127], v19 offset:12288
  v_mfma_f32_16x16x32_bf16 v[68:71], v[172:175], a[60:63], v[68:71]
  s_sub_u32 s39, s39, 1
  s_cmp_eq_u32 s39, 0
  s_cselect_b32 s3, s64, s65
  v_mfma_f32_16x16x32_bf16 v[68:71], v[168:171], a[56:59], v[68:71]
  ds_read_b64_tr_b16 v[128:129], v20 offset:0
  ds_read_b64_tr_b16 v[130:131], v20 offset:4096
  v_mfma_f32_16x16x32_bf16 v[72:75], v[176:179], a[56:59], v[72:75]
  s_add_u32 s23, s23, s3
  s_lshl_b32 s3, s3, 3
  s_add_u32 s25, s25, s3
  v_mfma_f32_16x16x32_bf16 v[72:75], v[180:183], a[60:63], v[72:75]
  ds_read_b64_tr_b16 v[132:133], v20 offset:8192
  ds_read_b64_tr_b16 v[134:135], v20 offset:12288
  v_mfma_f32_16x16x32_bf16 v[76:79], v[188:191], a[60:63], v[76:79]
  v_mfma_f32_16x16x32_bf16 v[76:79], v[184:187], a[56:59], v[76:79]
  ds_read_b64_tr_b16 v[136:137], v21 offset:0
  ds_read_b64_tr_b16 v[138:139], v21 offset:4096
  v_mfma_f32_16x16x32_bf16 v[80:83], v[192:195], a[56:59], v[80:83]
  ds_read_b64_tr_b16 v[140:141], v21 offset:8192
  ds_read_b64_tr_b16 v[142:143], v21 offset:12288
  v_mfma_f32_16x16x32_bf16 v[80:83], v[196:199], a[60:63], v[80:83]
  ds_read_b64_tr_b16 v[144:145], v22 offset:0
  ds_read_b64_tr_b16 v[146:147], v22 offset:4096
  v_mfma_f32_16x16x32_bf16 v[84:87], v[204:207], a[60:63], v[84:87]
  ds_read_b64_tr_b16 v[148:149], v22 offset:8192
  ds_read_b64_tr_b16 v[150:151], v22 offset:12288
  v_mfma_f32_16x16x32_bf16 v[84:87], v[200:203], a[56:59], v[84:87]
  ds_read_b64_tr_b16 v[152:153], v23 offset:0
  ds_read_b64_tr_b16 v[154:155], v23 offset:4096
  v_mfma_f32_16x16x32_bf16 v[88:91], v[208:211], a[56:59], v[88:91]
  ds_read_b64_tr_b16 v[156:157], v23 offset:8192
  ds_read_b64_tr_b16 v[158:159], v23 offset:12288
  v_mfma_f32_16x16x32_bf16 v[88:91], v[212:215], a[60:63], v[88:91]
  v_mfma_f32_16x16x32_bf16 v[92:95], v[220:223], a[60:63], v[92:95]
  v_mfma_f32_16x16x32_bf16 v[92:95], v[216:219], a[56:59], v[92:95]
  s_waitcnt vmcnt(24) lgkmcnt(0)
  s_barrier
  v_mfma_f32_16x16x32_bf16 v[32:35], v[96:99], a[64:67], v[32:35]
  s_add_u32 m0, s41, 16384
  s_nop 0
  buffer_load_dwordx4 v2, s[12:15], s25 offen offset:0 lds
  v_mfma_f32_16x16x32_bf16 v[32:35], v[100:103], a[68:71], v[32:35]
  ds_read_b64_tr_b16 v[160:161], v16 offset:16384
  ds_read_b64_tr_b16 v[162:163], v16 offset:20480
  v_mfma_f32_16x16x32_bf16 v[36:39], v[108:111], a[68:71], v[36:39]
  buffer_load_dwordx4 v3, s[12:15], s25 offen offset:1024 lds
  v_mfma_f32_16x16x32_bf16 v[36:39], v[104:107], a[64:67], v[36:39]
  ds_read_b64_tr_b16 v[164:165], v16 offset:24576
  ds_read_b64_tr_b16 v[166:167], v16 offset:28672
  v_mfma_f32_16x16x32_bf16 v[40:43], v[112:115], a[64:67], v[40:43]
  buffer_load_dwordx4 v4, s[12:15], s25 offen offset:2048 lds
  v_mfma_f32_16x16x32_bf16 v[40:43], v[116:119], a[68:71], v[40:43]
  ds_read_b64_tr_b16 v[168:169], v17 offset:16384
  ds_read_b64_tr_b16 v[170:171], v17 offset:20480
  v_mfma_f32_16x16x32_bf16 v[44:47], v[124:127], a[68:71], v[44:47]
  buffer_load_dwordx4 v5, s[12:15], s25 offen offset:3072 lds
  v_mfma_f32_16x16x32_bf16 v[44:47], v[120:123], a[64:67], v[44:47]
  v_mfma_f32_16x16x32_bf16 v[48:51], v[128:131], a[64:67], v[48:51]
  ds_read_b64_tr_b16 v[172:173], v17 offset:24576
  ds_read_b64_tr_b16 v[174:175], v17 offset:28672
  v_mfma_f32_16x16x32_bf16 v[48:51], v[132:135], a[68:71], v[48:51]
  buffer_load_dwordx4 a[16:19], v1, s[8:11], s23 offen offset:0
  v_mfma_f32_16x16x32_bf16 v[52:55], v[140:143], a[68:71], v[52:55]
  ds_read_b64_tr_b16 v[176:177], v18 offset:16384
  ds_read_b64_tr_b16 v[178:179], v18 offset:20480
  v_mfma_f32_16x16x32_bf16 v[52:55], v[136:139], a[64:67], v[52:55]
  buffer_load_dwordx4 a[20:23], v1, s[8:11], s23 offen offset:1024
  v_mfma_f32_16x16x32_bf16 v[56:59], v[144:147], a[64:67], v[56:59]
  ds_read_b64_tr_b16 v[180:181], v18 offset:24576
  ds_read_b64_tr_b16 v[182:183], v18 offset:28672
  v_mfma_f32_16x16x32_bf16 v[56:59], v[148:151], a[68:71], v[56:59]
  buffer_load_dwordx4 a[24:27], v1, s[8:11], s23 offen offset:2048
  v_mfma_f32_16x16x32_bf16 v[60:63], v[156:159], a[68:71], v[60:63]
  v_mfma_f32_16x16x32_bf16 v[60:63], v[152:155], a[64:67], v[60:63]
  ds_read_b64_tr_b16 v[184:185], v19 offset:16384
  ds_read_b64_tr_b16 v[186:187], v19 offset:20480
  v_mfma_f32_16x16x32_bf16 v[64:67], v[96:99], a[72:75], v[64:67]
  buffer_load_dwordx4 a[28:31], v1, s[8:11], s23 offen offset:3072
  v_mfma_f32_16x16x32_bf16 v[64:67], v[100:103], a[76:79], v[64:67]
  ds_read_b64_tr_b16 v[188:189], v19 offset:24576
  ds_read_b64_tr_b16 v[190:191], v19 offset:28672
  v_mfma_f32_16x16x32_bf16 v[68:71], v[108:111], a[76:79], v[68:71]
  s_sub_u32 s39, s39, 1
  s_cmp_eq_u32 s39, 0
  s_cselect_b32 s3, s64, s65
  v_mfma_f32_16x16x32_bf16 v[68:71], v[104:107], a[72:75], v[68:71]
  ds_read_b64_tr_b16 v[192:193], v20 offset:16384
  ds_read_b64_tr_b16 v[194:195], v20 offset:20480
  v_mfma_f32_16x16x32_bf16 v[72:75], v[112:115], a[72:75], v[72:75]
  s_add_u32 s23, s23, s3
  s_lshl_b32 s3, s3, 3
  s_add_u32 s25, s25, s3
  v_mfma_f32_16x16x32_bf16 v[72:75], v[116:119], a[76:79], v[72:75]
  ds_read_b64_tr_b16 v[196:197], v20 offset:24576
  ds_read_b64_tr_b16 v[198:199], v20 offset:28672
  v_mfma_f32_16x16x32_bf16 v[76:79], v[124:127], a[76:79], v[76:79]
  v_mfma_f32_16x16x32_bf16 v[76:79], v[120:123], a[72:75], v[76:79]
  ds_read_b64_tr_b16 v[200:201], v21 offset:16384
  ds_read_b64_tr_b16 v[202:203], v21 offset:20480
  v_mfma_f32_16x16x32_bf16 v[80:83], v[128:131], a[72:75], v[80:83]
  ds_read_b64_tr_b16 v[204:205], v21 offset:24576
  ds_read_b64_tr_b16 v[206:207], v21 offset:28672
  v_mfma_f32_16x16x32_bf16 v[80:83], v[132:135], a[76:79], v[80:83]
  ds_read_b64_tr_b16 v[208:209], v22 offset:16384
  ds_read_b64_tr_b16 v[210:211], v22 offset:20480
  v_mfma_f32_16x16x32_bf16 v[84:87], v[140:143], a[76:79], v[84:87]
  ds_read_b64_tr_b16 v[212:213], v22 offset:24576
  ds_read_b64_tr_b16 v[214:215], v22 offset:28672
  v_mfma_f32_16x16x32_bf16 v[84:87], v[136:139], a[72:75], v[84:87]
  ds_read_b64_tr_b16 v[216:217], v23 offset:16384
  ds_read_b64_tr_b16 v[218:219], v23 offset:20480
  v_mfma_f32_16x16x32_bf16 v[88:91], v[144:147], a[72:75], v[88:91]
  ds_read_b64_tr_b16 v[220:221], v23 offset:24576
  ds_read_b64_tr_b16 v[222:223], v23 offset:28672
  v_mfma_f32_16x16x32_bf16 v[88:91], v[148:151], a[76:79], v[88:91]
  v_mfma_f32_16x16x32_bf16 v[92:95], v[156:159], a[76:79], v[92:95]
  v_mfma_f32_16x16x32_bf16 v[92:95], v[152:155], a[72:75], v[92:95]
  s_waitcnt vmcnt(24) lgkmcnt(0)
  s_barrier
  v_mfma_f32_16x16x32_bf16 v[32:35], v[160:163], a[80:83], v[32:35]
  s_add_u32 m0, s41, 32768
  s_nop 0
  buffer_load_dwordx4 v2, s[12:15], s25 offen offset:0 lds
  v_mfma_f32_16x16x32_bf16 v[32:35], v[164:167], a[84:87], v[32:35]
  ds_read_b64_tr_b16 v[96:97], v16 offset:32768
  ds_read_b64_tr_b16 v[98:99], v16 offset:36864
  v_mfma_f32_16x16x32_bf16 v[36:39], v[172:175], a[84:87], v[36:39]
  buffer_load_dwordx4 v3, s[12:15], s25 offen offset:1024 lds
  v_mfma_f32_16x16x32_bf16 v[36:39], v[168:171], a[80:83], v[36:39]
  ds_read_b64_tr_b16 v[100:101], v16 offset:40960
  ds_read_b64_tr_b16 v[102:103], v16 offset:45056
  v_mfma_f32_16x16x32_bf16 v[40:43], v[176:179], a[80:83], v[40:43]
  buffer_load_dwordx4 v4, s[12:15], s25 offen offset:2048 lds
  v_mfma_f32_16x16x32_bf16 v[40:43], v[180:183], a[84:87], v[40:43]
  ds_read_b64_tr_b16 v[104:105], v17 offset:32768
  ds_read_b64_tr_b16 v[106:107], v17 offset:36864
  v_mfma_f32_16x16x32_bf16 v[44:47], v[188:191], a[84:87], v[44:47]
  buffer_load_dwordx4 v5, s[12:15], s25 offen offset:3072 lds
  v_mfma_f32_16x16x32_bf16 v[44:47], v[184:187], a[80:83], v[44:47]
  v_mfma_f32_16x16x32_bf16 v[48:51], v[192:195], a[80:83], v[48:51]
  ds_read_b64_tr_b16 v[108:109], v17 offset:40960
  ds_read_b64_tr_b16 v[110:111], v17 offset:45056
  v_mfma_f32_16x16x32_bf16 v[48:51], v[196:199], a[84:87], v[48:51]
  buffer_load_dwordx4 a[32:35], v1, s[8:11], s23 offen offset:0
  v_mfma_f32_16x16x32_bf16 v[52:55], v[204:207], a[84:87], v[52:55]
  ds_read_b64_tr_b16 v[112:113], v18 offset:32768
  ds_read_b64_tr_b16 v[114:115], v18 offset:36864
  v_mfma_f32_16x16x32_bf16 v[52:55], v[200:203], a[80:83], v[52:55]
  buffer_load_dwordx4 a[36:39], v1, s[8:11], s23 offen offset:1024
  v_mfma_f32_16x16x32_bf16 v[56:59], v[208:211], a[80:83], v[56:59]
  ds_read_b64_tr_b16 v[116:117], v18 offset:40960
  ds_read_b64_tr_b16 v[118:119], v18 offset:45056
  v_mfma_f32_16x16x32_bf16 v[56:59], v[212:215], a[84:87], v[56:59]
  buffer_load_dwordx4 a[40:43], v1, s[8:11], s23 offen offset:2048
  v_mfma_f32_16x16x32_bf16 v[60:63], v[220:223], a[84:87], v[60:63]
  v_mfma_f32_16x16x32_bf16 v[60:63], v[216:219], a[80:83], v[60:63]
  ds_read_b64_tr_b16 v[120:121], v19 offset:32768
  ds_read_b64_tr_b16 v[122:123], v19 offset:36864
  v_mfma_f32_16x16x32_bf16 v[64:67], v[160:163], a[88:91], v[64:67]
  buffer_load_dwordx4 a[44:47], v1, s[8:11], s23 offen offset:3072
  v_mfma_f32_16x16x32_bf16 v[64:67], v[164:167], a[92:95], v[64:67]
  ds_read_b64_tr_b16 v[124:125], v19 offset:40960
  ds_read_b64_tr_b16 v[126:127], v19 offset:45056
  v_mfma_f32_16x16x32_bf16 v[68:71], v[172:175], a[92:95], v[68:71]
  s_sub_u32 s39, s39, 1
  s_cmp_eq_u32 s39, 0
  s_cselect_b32 s3, s64, s65
  v_mfma_f32_16x16x32_bf16 v[68:71], v[168:171], a[88:91], v[68:71]
  ds_read_b64_tr_b16 v[128:129], v20 offset:32768
  ds_read_b64_tr_b16 v[130:131], v20 offset:36864
  v_mfma_f32_16x16x32_bf16 v[72:75], v[176:179], a[88:91], v[72:75]
  s_add_u32 s23, s23, s3
  s_lshl_b32 s3, s3, 3
  s_add_u32 s25, s25, s3
  v_mfma_f32_16x16x32_bf16 v[72:75], v[180:183], a[92:95], v[72:75]
  ds_read_b64_tr_b16 v[132:133], v20 offset:40960
  ds_read_b64_tr_b16 v[134:135], v20 offset:45056
  v_mfma_f32_16x16x32_bf16 v[76:79], v[188:191], a[92:95], v[76:79]
  v_mfma_f32_16x16x32_bf16 v[76:79], v[184:187], a[88:91], v[76:79]
  ds_read_b64_tr_b16 v[136:137], v21 offset:32768
  ds_read_b64_tr_b16 v[138:139], v21 offset:36864
  v_mfma_f32_16x16x32_bf16 v[80:83], v[192:195], a[88:91], v[80:83]
  ds_read_b64_tr_b16 v[140:141], v21 offset:40960
  ds_read_b64_tr_b16 v[142:143], v21 offset:45056
  v_mfma_f32_16x16x32_bf16 v[80:83], v[196:199], a[92:95], v[80:83]
  ds_read_b64_tr_b16 v[144:145], v22 offset:32768
  ds_read_b64_tr_b16 v[146:147], v22 offset:36864
  v_mfma_f32_16x16x32_bf16 v[84:87], v[204:207], a[92:95], v[84:87]
  ds_read_b64_tr_b16 v[148:149], v22 offset:40960
  ds_read_b64_tr_b16 v[150:151], v22 offset:45056
  v_mfma_f32_16x16x32_bf16 v[84:87], v[200:203], a[88:91], v[84:87]
  ds_read_b64_tr_b16 v[152:153], v23 offset:32768
  ds_read_b64_tr_b16 v[154:155], v23 offset:36864
  v_mfma_f32_16x16x32_bf16 v[88:91], v[208:211], a[88:91], v[88:91]
  ds_read_b64_tr_b16 v[156:157], v23 offset:40960
  ds_read_b64_tr_b16 v[158:159], v23 offset:45056
  v_mfma_f32_16x16x32_bf16 v[88:91], v[212:215], a[92:95], v[88:91]
  v_mfma_f32_16x16x32_bf16 v[92:95], v[220:223], a[92:95], v[92:95]
  v_mfma_f32_16x16x32_bf16 v[92:95], v[216:219], a[88:91], v[92:95]
  s_waitcnt vmcnt(24) lgkmcnt(0)
  s_barrier
  v_mfma_f32_16x16x32_bf16 v[32:35], v[96:99], a[96:99], v[32:35]
  s_add_u32 m0, s41, 49152
  s_nop 0
  buffer_load_dwordx4 v2, s[12:15], s25 offen offset:0 lds
  v_mfma_f32_16x16x32_bf16 v[32:35], v[100:103], a[100:103], v[32:35]
  ds_read_b64_tr_b16 v[160:161], v16 offset:49152
  ds_read_b64_tr_b16 v[162:163], v16 offset:53248
  v_mfma_f32_16x16x32_bf16 v[36:39], v[108:111], a[100:103], v[36:39]
  buffer_load_dwordx4 v3, s[12:15], s25 offen offset:1024 lds
  v_mfma_f32_16x16x32_bf16 v[36:39], v[104:107], a[96:99], v[36:39]
  ds_read_b64_tr_b16 v[164:165], v16 offset:57344
  ds_read_b64_tr_b16 v[166:167], v16 offset:61440
  v_mfma_f32_16x16x32_bf16 v[40:43], v[112:115], a[96:99], v[40:43]
  buffer_load_dwordx4 v4, s[12:15], s25 offen offset:2048 lds
  v_mfma_f32_16x16x32_bf16 v[40:43], v[116:119], a[100:103], v[40:43]
  ds_read_b64_tr_b16 v[168:169], v17 offset:49152
  ds_read_b64_tr_b16 v[170:171], v17 offset:53248
  v_mfma_f32_16x16x32_bf16 v[44:47], v[124:127], a[100:103], v[44:47]
  buffer_load_dwordx4 v5, s[12:15], s25 offen offset:3072 lds
  v_mfma_f32_16x16x32_bf16 v[44:47], v[120:123], a[96:99], v[44:47]
  v_mfma_f32_16x16x32_bf16 v[48:51], v[128:131], a[96:99], v[48:51]
  ds_read_b64_tr_b16 v[172:173], v17 offset:57344
  ds_read_b64_tr_b16 v[174:175], v17 offset:61440
  v_mfma_f32_16x16x32_bf16 v[48:51], v[132:135], a[100:103], v[48:51]
  buffer_load_dwordx4 a[48:51], v1, s[8:11], s23 offen offset:0
  v_mfma_f32_16x16x32_bf16 v[52:55], v[140:143], a[100:103], v[52:55]
  ds_read_b64_tr_b16 v[176:177], v18 offset:49152
  ds_read_b64_tr_b16 v[178:179], v18 offset:53248
  v_mfma_f32_16x16x32_bf16 v[52:55], v[136:139], a[96:99], v[52:55]
  buffer_load_dwordx4 a[52:55], v1, s[8:11], s23 offen offset:1024
  v_mfma_f32_16x16x32_bf16 v[56:59], v[144:147], a[96:99], v[56:59]
  ds_read_b64_tr_b16 v[180:181], v18 offset:57344
  ds_read_b64_tr_b16 v[182:183], v18 offset:61440
  v_mfma_f32_16x16x32_bf16 v[56:59], v[148:151], a[100:103], v[56:59]
  buffer_load_dwordx4 a[56:59], v1, s[8:11], s23 offen offset:2048
  v_mfma_f32_16x16x32_bf16 v[60:63], v[156:159], a[100:103], v[60:63]
  v_mfma_f32_16x16x32_bf16 v[60:63], v[152:155], a[96:99], v[60:63]
  ds_read_b64_tr_b16 v[184:185], v19 offset:49152
  ds_read_b64_tr_b16 v[186:187], v19 offset:53248
  v_mfma_f32_16x16x32_bf16 v[64:67], v[96:99], a[104:107], v[64:67]
  buffer_load_dwordx4 a[60:63], v1, s[8:11], s23 offen offset:3072
  v_mfma_f32_16x16x32_bf16 v[64:67], v[100:103], a[108:111], v[64:67]
  ds_read_b64_tr_b16 v[188:189], v19 offset:57344
  ds_read_b64_tr_b16 v[190:191], v19 offset:61440
  v_mfma_f32_16x16x32_bf16 v[68:71], v[108:111], a[108:111], v[68:71]
  s_sub_u32 s39, s39, 1
  s_cmp_eq_u32 s39, 0
  s_cselect_b32 s3, s64, s65
  v_mfma_f32_16x16x32_bf16 v[68:71], v[104:107], a[104:107], v[68:71]
  ds_read_b64_tr_b16 v[192:193], v20 offset:49152
  ds_read_b64_tr_b16 v[194:195], v20 offset:53248
  v_mfma_f32_16x16x32_bf16 v[72:75], v[112:115], a[104:107], v[72:75]
  s_add_u32 s23, s23, s3
  s_lshl_b32 s3, s3, 3
  s_add_u32 s25, s25, s3
  v_mfma_f32_16x16x32_bf16 v[72:75], v[116:119], a[108:111], v[72:75]
  ds_read_b64_tr_b16 v[196:197], v20 offset:57344
  ds_read_b64_tr_b16 v[198:199], v20 offset:61440
  v_mfma_f32_16x16x32_bf16 v[76:79], v[124:127], a[108:111], v[76:79]
  v_mfma_f32_16x16x32_bf16 v[76:79], v[120:123], a[104:107], v[76:79]
  ds_read_b64_tr_b16 v[200:201], v21 offset:49152
  ds_read_b64_tr_b16 v[202:203], v21 offset:53248
  v_mfma_f32_16x16x32_bf16 v[80:83], v[128:131], a[104:107], v[80:83]
  ds_read_b64_tr_b16 v[204:205], v21 offset:57344
  ds_read_b64_tr_b16 v[206:207], v21 offset:61440
  v_mfma_f32_16x16x32_bf16 v[80:83], v[132:135], a[108:111], v[80:83]
  ds_read_b64_tr_b16 v[208:209], v22 offset:49152
  ds_read_b64_tr_b16 v[210:211], v22 offset:53248
  v_mfma_f32_16x16x32_bf16 v[84:87], v[140:143], a[108:111], v[84:87]
  ds_read_b64_tr_b16 v[212:213], v22 offset:57344
  ds_read_b64_tr_b16 v[214:215], v22 offset:61440
  v_mfma_f32_16x16x32_bf16 v[84:87], v[136:139], a[104:107], v[84:87]
  ds_read_b64_tr_b16 v[216:217], v23 offset:49152
  ds_read_b64_tr_b16 v[218:219], v23 offset:53248
  v_mfma_f32_16x16x32_bf16 v[88:91], v[144:147], a[104:107], v[88:91]
  ds_read_b64_tr_b16 v[220:221], v23 offset:57344
  ds_read_b64_tr_b16 v[222:223], v23 offset:61440
  v_mfma_f32_16x16x32_bf16 v[88:91], v[148:151], a[108:111], v[88:91]
  v_mfma_f32_16x16x32_bf16 v[92:95], v[156:159], a[108:111], v[92:95]
  v_mfma_f32_16x16x32_bf16 v[92:95], v[152:155], a[104:107], v[92:95]
  s_waitcnt vmcnt(24) lgkmcnt(0)
  s_barrier
  v_mfma_f32_16x16x32_bf16 v[32:35], v[160:163], a[112:115], v[32:35]
  s_add_u32 m0, s41, 65536
  s_nop 0
  buffer_load_dwordx4 v2, s[12:15], s25 offen offset:0 lds
  v_mfma_f32_16x16x32_bf16 v[32:35], v[164:167], a[116:119], v[32:35]
  ds_read_b64_tr_b16 v[96:97], v8 offset:0
  ds_read_b64_tr_b16 v[98:99], v8 offset:4096
  v_mfma_f32_16x16x32_bf16 v[36:39], v[172:175], a[116:119], v[36:39]
  buffer_load_dwordx4 v3, s[12:15], s25 offen offset:1024 lds
  v_mfma_f32_16x16x32_bf16 v[36:39], v[168:171], a[112:115], v[36:39]
  ds_read_b64_tr_b16 v[100:101], v8 offset:8192
  ds_read_b64_tr_b16 v[102:103], v8 offset:12288
  v_mfma_f32_16x16x32_bf16 v[40:43], v[176:179], a[112:115], v[40:43]
  buffer_load_dwordx4 v4, s[12:15], s25 offen offset:2048 lds
  v_mfma_f32_16x16x32_bf16 v[40:43], v[180:183], a[116:119], v[40:43]
  ds_read_b64_tr_b16 v[104:105], v9 offset:0
  ds_read_b64_tr_b16 v[106:107], v9 offset:4096
  v_mfma_f32_16x16x32_bf16 v[44:47], v[188:191], a[116:119], v[44:47]
  buffer_load_dwordx4 v5, s[12:15], s25 offen offset:3072 lds
  v_mfma_f32_16x16x32_bf16 v[44:47], v[184:187], a[112:115], v[44:47]
  v_mfma_f32_16x16x32_bf16 v[48:51], v[192:195], a[112:115], v[48:51]
  ds_read_b64_tr_b16 v[108:109], v9 offset:8192
  ds_read_b64_tr_b16 v[110:111], v9 offset:12288
  v_mfma_f32_16x16x32_bf16 v[48:51], v[196:199], a[116:119], v[48:51]
  buffer_load_dwordx4 a[64:67], v1, s[8:11], s23 offen offset:0
  v_mfma_f32_16x16x32_bf16 v[52:55], v[204:207], a[116:119], v[52:55]
  ds_read_b64_tr_b16 v[112:113], v10 offset:0
  ds_read_b64_tr_b16 v[114:115], v10 offset:4096
  v_mfma_f32_16x16x32_bf16 v[52:55], v[200:203], a[112:115], v[52:55]
  buffer_load_dwordx4 a[68:71], v1, s[8:11], s23 offen offset:1024
  v_mfma_f32_16x16x32_bf16 v[56:59], v[208:211], a[112:115], v[56:59]
  ds_read_b64_tr_b16 v[116:117], v10 offset:8192
  ds_read_b64_tr_b16 v[118:119], v10 offset:12288
  v_mfma_f32_16x16x32_bf16 v[56:59], v[212:215], a[116:119], v[56:59]
  buffer_load_dwordx4 a[72:75], v1, s[8:11], s23 offen offset:2048
  v_mfma_f32_16x16x32_bf16 v[60:63], v[220:223], a[116:119], v[60:63]
  v_mfma_f32_16x16x32_bf16 v[60:63], v[216:219], a[112:115], v[60:63]
  ds_read_b64_tr_b16 v[120:121], v11 offset:0
  ds_read_b64_tr_b16 v[122:123], v11 offset:4096
  v_mfma_f32_16x16x32_bf16 v[64:67], v[160:163], a[120:123], v[64:67]
  buffer_load_dwordx4 a[76:79], v1, s[8:11], s23 offen offset:3072
  v_mfma_f32_16x16x32_bf16 v[64:67], v[164:167], a[124:127], v[64:67]
  ds_read_b64_tr_b16 v[124:125], v11 offset:8192
  ds_read_b64_tr_b16 v[126:127], v11 offset:12288
  v_mfma_f32_16x16x32_bf16 v[68:71], v[172:175], a[124:127], v[68:71]
  s_sub_u32 s39, s39, 1
  s_cmp_eq_u32 s39, 0
  s_cselect_b32 s3, s64, s65
  v_mfma_f32_16x16x32_bf16 v[68:71], v[168:171], a[120:123], v[68:71]
  ds_read_b64_tr_b16 v[128:129], v12 offset:0
  ds_read_b64_tr_b16 v[130:131], v12 offset:4096
  v_mfma_f32_16x16x32_bf16 v[72:75], v[176:179], a[120:123], v[72:75]
  s_add_u32 s23, s23, s3
  s_lshl_b32 s3, s3, 3
  s_add_u32 s25, s25, s3
  v_mfma_f32_16x16x32_bf16 v[72:75], v[180:183], a[124:127], v[72:75]
  ds_read_b64_tr_b16 v[132:133], v12 offset:8192
  ds_read_b64_tr_b16 v[134:135], v12 offset:12288
  v_mfma_f32_16x16x32_bf16 v[76:79], v[188:191], a[124:127], v[76:79]
  v_mfma_f32_16x16x32_bf16 v[76:79], v[184:187], a[120:123], v[76:79]
  ds_read_b64_tr_b16 v[136:137], v13 offset:0
  ds_read_b64_tr_b16 v[138:139], v13 offset:4096
  v_mfma_f32_16x16x32_bf16 v[80:83], v[192:195], a[120:123], v[80:83]
  ds_read_b64_tr_b16 v[140:141], v13 offset:8192
  ds_read_b64_tr_b16 v[142:143], v13 offset:12288
  v_mfma_f32_16x16x32_bf16 v[80:83], v[196:199], a[124:127], v[80:83]
  ds_read_b64_tr_b16 v[144:145], v14 offset:0
  ds_read_b64_tr_b16 v[146:147], v14 offset:4096
  v_mfma_f32_16x16x32_bf16 v[84:87], v[204:207], a[124:127], v[84:87]
  ds_read_b64_tr_b16 v[148:149], v14 offset:8192
  ds_read_b64_tr_b16 v[150:151], v14 offset:12288
  v_mfma_f32_16x16x32_bf16 v[84:87], v[200:203], a[120:123], v[84:87]
  ds_read_b64_tr_b16 v[152:153], v15 offset:0
  ds_read_b64_tr_b16 v[154:155], v15 offset:4096
  v_mfma_f32_16x16x32_bf16 v[88:91], v[208:211], a[120:123], v[88:91]
  ds_read_b64_tr_b16 v[156:157], v15 offset:8192
  ds_read_b64_tr_b16 v[158:159], v15 offset:12288
  v_mfma_f32_16x16x32_bf16 v[88:91], v[212:215], a[124:127], v[88:91]
  v_mfma_f32_16x16x32_bf16 v[92:95], v[220:223], a[124:127], v[92:95]
  v_mfma_f32_16x16x32_bf16 v[92:95], v[216:219], a[120:123], v[92:95]
  s_sub_u32 s28, s28, 1
  s_cmp_lg_u32 s28, 0
  s_cbranch_scc1 Lk3_la
  s_waitcnt vmcnt(24) lgkmcnt(0)
  s_barrier
  v_mfma_f32_16x16x32_bf16 v[32:35], v[96:99], a[0:3], v[32:35]
  s_add_u32 m0, s41, 81920
  s_nop 0
  buffer_load_dwordx4 v2, s[12:15], s25 offen offset:0 lds
  v_mfma_f32_16x16x32_bf16 v[32:35], v[100:103], a[4:7], v[32:35]
  ds_read_b64_tr_b16 v[160:161], v8 offset:16384
  ds_read_b64_tr_b16 v[162:163], v8 offset:20480
  v_mfma_f32_16x16x32_bf16 v[36:39], v[108:111], a[4:7], v[36:39]
  buffer_load_dwordx4 v3, s[12:15], s25 offen offset:1024 lds
  v_mfma_f32_16x16x32_bf16 v[36:39], v[104:107], a[0:3], v[36:39]
  ds_read_b64_tr_b16 v[164:165], v8 offset:24576
  ds_read_b64_tr_b16 v[166:167], v8 offset:28672
  v_mfma_f32_16x16x32_bf16 v[40:43], v[112:115], a[0:3], v[40:43]
  buffer_load_dwordx4 v4, s[12:15], s25 offen offset:2048 lds
  v_mfma_f32_16x16x32_bf16 v[40:43], v[116:119], a[4:7], v[40:43]
  ds_read_b64_tr_b16 v[168:169], v9 offset:16384
  ds_read_b64_tr_b16 v[170:171], v9 offset:20480
  v_mfma_f32_16x16x32_bf16 v[44:47], v[124:127], a[4:7], v[44:47]
  buffer_load_dwordx4 v5, s[12:15], s25 offen offset:3072 lds
  v_mfma_f32_16x16x32_bf16 v[44:47], v[120:123], a[0:3], v[44:47]
  v_mfma_f32_16x16x32_bf16 v[48:51], v[128:131], a[0:3], v[48:51]
  ds_read_b64_tr_b16 v[172:173], v9 offset:24576
  ds_read_b64_tr_b16 v[174:175], v9 offset:28672
  v_mfma_f32_16x16x32_bf16 v[48:51], v[132:135], a[4:7], v[48:51]
  buffer_load_dwordx4 a[80:83], v1, s[8:11], s23 offen offset:0
  v_mfma_f32_16x16x32_bf16 v[52:55], v[140:143], a[4:7], v[52:55]
  ds_read_b64_tr_b16 v[176:177], v10 offset:16384
  ds_read_b64_tr_b16 v[178:179], v10 offset:20480
  v_mfma_f32_16x16x32_bf16 v[52:55], v[136:139], a[0:3], v[52:55]
  buffer_load_dwordx4 a[84:87], v1, s[8:11], s23 offen offset:1024
  v_mfma_f32_16x16x32_bf16 v[56:59], v[144:147], a[0:3], v[56:59]
  ds_read_b64_tr_b16 v[180:181], v10 offset:24576
  ds_read_b64_tr_b16 v[182:183], v10 offset:28672
  v_mfma_f32_16x16x32_bf16 v[56:59], v[148:151], a[4:7], v[56:59]
  buffer_load_dwordx4 a[88:91], v1, s[8:11], s23 offen offset:2048
  v_mfma_f32_16x16x32_bf16 v[60:63], v[156:159], a[4:7], v[60:63]
  v_mfma_f32_16x16x32_bf16 v[60:63], v[152:155], a[0:3], v[60:63]
  ds_read_b64_tr_b16 v[184:185], v11 offset:16384
  ds_read_b64_tr_b16 v[186:187], v11 offset:20480
  v_mfma_f32_16x16x32_bf16 v[64:67], v[96:99], a[8:11], v[64:67]
  buffer_load_dwordx4 a[92:95], v1, s[8:11], s23 offen offset:3072
  v_mfma_f32_16x16x32_bf16 v[64:67], v[100:103], a[12:15], v[64:67]
  ds_read_b64_tr_b16 v[188:189], v11 offset:24576
  ds_read_b64_tr_b16 v[190:191], v11 offset:28672
  v_mfma_f32_16x16x32_bf16 v[68:71], v[108:111], a[12:15], v[68:71]
  s_sub_u32 s39, s39, 1
  s_cmp_eq_u32 s39, 0
  s_cselect_b32 s3, s64, s65
  v_mfma_f32_16x16x32_bf16 v[68:71], v[104:107], a[8:11], v[68:71]
  ds_read_b64_tr_b16 v[192:193], v12 offset:16384
  ds_read_b64_tr_b16 v[194:195], v12 offset:20480
  v_mfma_f32_16x16x32_bf16 v[72:75], v[112:115], a[8:11], v[72:75]
  s_add_u32 s23, s23, s3
  s_lshl_b32 s3, s3, 3
  s_add_u32 s25, s25, s3
  v_mfma_f32_16x16x32_bf16 v[72:75], v[116:119], a[12:15], v[72:75]
  ds_read_b64_tr_b16 v[196:197], v12 offset:24576
  ds_read_b64_tr_b16 v[198:199], v12 offset:28672
  v_mfma_f32_16x16x32_bf16 v[76:79], v[124:127], a[12:15], v[76:79]
  v_mfma_f32_16x16x32_bf16 v[76:79], v[120:123], a[8:11], v[76:79]
  ds_read_b64_tr_b16 v[200:201], v13 offset:16384
  ds_read_b64_tr_b16 v[202:203], v13 offset:20480
  v_mfma_f32_16x16x32_bf16 v[80:83], v[128:131], a[8:11], v[80:83]
  ds_read_b64_tr_b16 v[204:205], v13 offset:24576
  ds_read_b64_tr_b16 v[206:207], v13 offset:28672
  v_mfma_f32_16x16x32_bf16 v[80:83], v[132:135], a[12:15], v[80:83]
  ds_read_b64_tr_b16 v[208:209], v14 offset:16384
  ds_read_b64_tr_b16 v[210:211], v14 offset:20480
  v_mfma_f32_16x16x32_bf16 v[84:87], v[140:143], a[12:15], v[84:87]
  ds_read_b64_tr_b16 v[212:213], v14 offset:24576
  ds_read_b64_tr_b16 v[214:215], v14 offset:28672
  v_mfma_f32_16x16x32_bf16 v[84:87], v[136:139], a[8:11], v[84:87]
  ds_read_b64_tr_b16 v[216:217], v15 offset:16384
  ds_read_b64_tr_b16 v[218:219], v15 offset:20480
  v_mfma_f32_16x16x32_bf16 v[88:91], v[144:147], a[8:11], v[88:91]
  ds_read_b64_tr_b16 v[220:221], v15 offset:24576
  ds_read_b64_tr_b16 v[222:223], v15 offset:28672
  v_mfma_f32_16x16x32_bf16 v[88:91], v[148:151], a[12:15], v[88:91]
  v_mfma_f32_16x16x32_bf16 v[92:95], v[156:159], a[12:15], v[92:95]
  v_mfma_f32_16x16x32_bf16 v[92:95], v[152:155], a[8:11], v[92:95]
  s_waitcnt vmcnt(24) lgkmcnt(0)
  s_barrier
  v_mfma_f32_16x16x32_bf16 v[32:35], v[160:163], a[16:19], v[32:35]
  s_add_u32 m0, s41, 98304
  s_nop 0
  buffer_load_dwordx4 v2, s[12:15], s25 offen offset:0 lds
  v_mfma_f32_16x16x32_bf16 v[32:35], v[164:167], a[20:23], v[32:35]
  ds_read_b64_tr_b16 v[96:97], v8 offset:32768
  ds_read_b64_tr_b16 v[98:99], v8 offset:36864
  v_mfma_f32_16x16x32_bf16 v[36:39], v[172:175], a[20:23], v[36:39]
  buffer_load_dwordx4 v3, s[12:15], s25 offen offset:1024 lds
  v_mfma_f32_16x16x32_bf16 v[36:39], v[168:171], a[16:19], v[36:39]
  ds_read_b64_tr_b16 v[100:101], v8 offset:40960
  ds_read_b64_tr_b16 v[102:103], v8 offset:45056
  v_mfma_f32_16x16x32_bf16 v[40:43], v[176:179], a[16:19], v[40:43]
  buffer_load_dwordx4 v4, s[12:15], s25 offen offset:2048 lds
  v_mfma_f32_16x16x32_bf16 v[40:43], v[180:183], a[20:23], v[40:43]
  ds_read_b64_tr_b16 v[104:105], v9 offset:32768
  ds_read_b64_tr_b16 v[106:107], v9 offset:36864
  v_mfma_f32_16x16x32_bf16 v[44:47], v[188:191], a[20:23], v[44:47]
  buffer_load_dwordx4 v5, s[12:15], s25 offen offset:3072 lds
  v_mfma_f32_16x16x32_bf16 v[44:47], v[184:187], a[16:19], v[44:47]
  v_mfma_f32_16x16x32_bf16 v[48:51], v[192:195], a[16:19], v[48:51]
  ds_read_b64_tr_b16 v[108:109], v9 offset:40960
  ds_read_b64_tr_b16 v[110:111], v9 offset:45056
  v_mfma_f32_16x16x32_bf16 v[48:51], v[196:199], a[20:23], v[48:51]
  buffer_load_dwordx4 a[96:99], v1, s[8:11], s23 offen offset:0
  v_mfma_f32_16x16x32_bf16 v[52:55], v[204:207], a[20:23], v[52:55]
  ds_read_b64_tr_b16 v[112:113], v10 offset:32768
  ds_read_b64_tr_b16 v[114:115], v10 offset:36864
  v_mfma_f32_16x16x32_bf16 v[52:55], v[200:203], a[16:19], v[52:55]
  buffer_load_dwordx4 a[100:103], v1, s[8:11], s23 offen offset:1024
  v_mfma_f32_16x16x32_bf16 v[56:59], v[208:211], a[16:19], v[56:59]
  ds_read_b64_tr_b16 v[116:117], v10 offset:40960
  ds_read_b64_tr_b16 v[118:119], v10 offset:45056
  v_mfma_f32_16x16x32_bf16 v[56:59], v[212:215], a[20:23], v[56:59]
  buffer_load_dwordx4 a[104:107], v1, s[8:11], s23 offen offset:2048
  v_mfma_f32_16x16x32_bf16 v[60:63], v[220:223], a[20:23], v[60:63]
  v_mfma_f32_16x16x32_bf16 v[60:63], v[216:219], a[16:19], v[60:63]
  ds_read_b64_tr_b16 v[120:121], v11 offset:32768
  ds_read_b64_tr_b16 v[122:123], v11 offset:36864
  v_mfma_f32_16x16x32_bf16 v[64:67], v[160:163], a[24:27], v[64:67]
  buffer_load_dwordx4 a[108:111], v1, s[8:11], s23 offen offset:3072
  v_mfma_f32_16x16x32_bf16 v[64:67], v[164:167], a[28:31], v[64:67]
  ds_read_b64_tr_b16 v[124:125], v11 offset:40960
  ds_read_b64_tr_b16 v[126:127], v11 offset:45056
  v_mfma_f32_16x16x32_bf16 v[68:71], v[172:175], a[28:31], v[68:71]
  s_sub_u32 s39, s39, 1
  s_cmp_eq_u32 s39, 0
  s_cselect_b32 s3, s64, s65
  v_mfma_f32_16x16x32_bf16 v[68:71], v[168:171], a[24:27], v[68:71]
  ds_read_b64_tr_b16 v[128:129], v12 offset:32768
  ds_read_b64_tr_b16 v[130:131], v12 offset:36864
  v_mfma_f32_16x16x32_bf16 v[72:75], v[176:179], a[24:27], v[72:75]
  s_add_u32 s23, s23, s3
  s_lshl_b32 s3, s3, 3
  s_add_u32 s25, s25, s3
  v_mfma_f32_16x16x32_bf16 v[72:75], v[180:183], a[28:31], v[72:75]
  ds_read_b64_tr_b16 v[132:133], v12 offset:40960
  ds_read_b64_tr_b16 v[134:135], v12 offset:45056
  v_mfma_f32_16x16x32_bf16 v[76:79], v[188:191], a[28:31], v[76:79]
  v_mfma_f32_16x16x32_bf16 v[76:79], v[184:187], a[24:27], v[76:79]
  ds_read_b64_tr_b16 v[136:137], v13 offset:32768
  ds_read_b64_tr_b16 v[138:139], v13 offset:36864
  v_mfma_f32_16x16x32_bf16 v[80:83], v[192:195], a[24:27], v[80:83]
  ds_read_b64_tr_b16 v[140:141], v13 offset:40960
  ds_read_b64_tr_b16 v[142:143], v13 offset:45056
  v_mfma_f32_16x16x32_bf16 v[80:83], v[196:199], a[28:31], v[80:83]
  ds_read_b64_tr_b16 v[144:145], v14 offset:32768
  ds_read_b64_tr_b16 v[146:147], v14 offset:36864
  v_mfma_f32_16x16x32_bf16 v[84:87], v[204:207], a[28:31], v[84:87]
  ds_read_b64_tr_b16 v[148:149], v14 offset:40960
  ds_read_b64_tr_b16 v[150:151], v14 offset:45056
  v_mfma_f32_16x16x32_bf16 v[84:87], v[200:203], a[24:27], v[84:87]
  ds_read_b64_tr_b16 v[152:153], v15 offset:32768
  ds_read_b64_tr_b16 v[154:155], v15 offset:36864
  v_mfma_f32_16x16x32_bf16 v[88:91], v[208:211], a[24:27], v[88:91]
  ds_read_b64_tr_b16 v[156:157], v15 offset:40960
  ds_read_b64_tr_b16 v[158:159], v15 offset:45056
  v_mfma_f32_16x16x32_bf16 v[88:91], v[212:215], a[28:31], v[88:91]
  v_mfma_f32_16x16x32_bf16 v[92:95], v[220:223], a[28:31], v[92:95]
  v_mfma_f32_16x16x32_bf16 v[92:95], v[216:219], a[24:27], v[92:95]
  s_waitcnt vmcnt(24) lgkmcnt(0)
  s_barrier
  v_mfma_f32_16x16x32_bf16 v[32:35], v[96:99], a[32:35], v[32:35]
  s_add_u32 m0, s41, 114688
  s_nop 0
  buffer_load_dwordx4 v2, s[12:15], s25 offen offset:0 lds
  v_mfma_f32_16x16x32_bf16 v[32:35], v[100:103], a[36:39], v[32:35]
  ds_read_b64_tr_b16 v[160:161], v8 offset:49152
  ds_read_b64_tr_b16 v[162:163], v8 offset:53248
  v_mfma_f32_16x16x32_bf16 v[36:39], v[108:111], a[36:39], v[36:39]
  buffer_load_dwordx4 v3, s[12:15], s25 offen offset:1024 lds
  v_mfma_f32_16x16x32_bf16 v[36:39], v[104:107], a[32:35], v[36:39]
  ds_read_b64_tr_b16 v[164:165], v8 offset:57344
  ds_read_b64_tr_b16 v[166:167], v8 offset:61440
  v_mfma_f32_16x16x32_bf16 v[40:43], v[112:115], a[32:35], v[40:43]
  buffer_load_dwordx4 v4, s[12:15], s25 offen offset:2048 lds
  v_mfma_f32_16x16x32_bf16 v[40:43], v[116:119], a[36:39], v[40:43]
  ds_read_b64_tr_b16 v[168:169], v9 offset:49152
  ds_read_b64_tr_b16 v[170:171], v9 offset:53248
  v_mfma_f32_16x16x32_bf16 v[44:47], v[124:127], a[36:39], v[44:47]
  buffer_load_dwordx4 v5, s[12:15], s25 offen offset:3072 lds
  v_mfma_f32_16x16x32_bf16 v[44:47], v[120:123], a[32:35], v[44:47]
  v_mfma_f32_16x16x32_bf16 v[48:51], v[128:131], a[32:35], v[48:51]
  ds_read_b64_tr_b16 v[172:173], v9 offset:57344
  ds_read_b64_tr_b16 v[174:175], v9 offset:61440
  v_mfma_f32_16x16x32_bf16 v[48:51], v[132:135], a[36:39], v[48:51]
  buffer_load_dwordx4 a[112:115], v1, s[8:11], s23 offen offset:0
  v_mfma_f32_16x16x32_bf16 v[52:55], v[140:143], a[36:39], v[52:55]
  ds_read_b64_tr_b16 v[176:177], v10 offset:49152
  ds_read_b64_tr_b16 v[178:179], v10 offset:53248
  v_mfma_f32_16x16x32_bf16 v[52:55], v[136:139], a[32:35], v[52:55]
  buffer_load_dwordx4 a[116:119], v1, s[8:11], s23 offen offset:1024
  v_mfma_f32_16x16x32_bf16 v[56:59], v[144:147], a[32:35], v[56:59]
  ds_read_b64_tr_b16 v[180:181], v10 offset:57344
  ds_read_b64_tr_b16 v[182:183], v10 offset:61440
  v_mfma_f32_16x16x32_bf16 v[56:59], v[148:151], a[36:39], v[56:59]
  buffer_load_dwordx4 a[120:123], v1, s[8:11], s23 offen offset:2048
  v_mfma_f32_16x16x32_bf16 v[60:63], v[156:159], a[36:39], v[60:63]
  v_mfma_f32_16x16x32_bf16 v[60:63], v[152:155], a[32:35], v[60:63]
  ds_read_b64_tr_b16 v[184:185], v11 offset:49152
  ds_read_b64_tr_b16 v[186:187], v11 offset:53248
  v_mfma_f32_16x16x32_bf16 v[64:67], v[96:99], a[40:43], v[64:67]
  buffer_load_dwordx4 a[124:127], v1, s[8:11], s23 offen offset:3072
  v_mfma_f32_16x16x32_bf16 v[64:67], v[100:103], a[44:47], v[64:67]
  ds_read_b64_tr_b16 v[188:189], v11 offset:57344
  ds_read_b64_tr_b16 v[190:191], v11 offset:61440
  v_mfma_f32_16x16x32_bf16 v[68:71], v[108:111], a[44:47], v[68:71]
  s_sub_u32 s39, s39, 1
  s_cmp_eq_u32 s39, 0
  s_cselect_b32 s3, s64, s65
  v_mfma_f32_16x16x32_bf16 v[68:71], v[104:107], a[40:43], v[68:71]
  ds_read_b64_tr_b16 v[192:193], v12 offset:49152
  ds_read_b64_tr_b16 v[194:195], v12 offset:53248
  v_mfma_f32_16x16x32_bf16 v[72:75], v[112:115], a[40:43], v[72:75]
  s_add_u32 s23, s23, s3
  s_lshl_b32 s3, s3, 3
  s_add_u32 s25, s25, s3
  v_mfma_f32_16x16x32_bf16 v[72:75], v[116:119], a[44:47], v[72:75]
  ds_read_b64_tr_b16 v[196:197], v12 offset:57344
  ds_read_b64_tr_b16 v[198:199], v12 offset:61440
  v_mfma_f32_16x16x32_bf16 v[76:79], v[124:127], a[44:47], v[76:79]
  v_mfma_f32_16x16x32_bf16 v[76:79], v[120:123], a[40:43], v[76:79]
  ds_read_b64_tr_b16 v[200:201], v13 offset:49152
  ds_read_b64_tr_b16 v[202:203], v13 offset:53248
  v_mfma_f32_16x16x32_bf16 v[80:83], v[128:131], a[40:43], v[80:83]
  ds_read_b64_tr_b16 v[204:205], v13 offset:57344
  ds_read_b64_tr_b16 v[206:207], v13 offset:61440
  v_mfma_f32_16x16x32_bf16 v[80:83], v[132:135], a[44:47], v[80:83]
  ds_read_b64_tr_b16 v[208:209], v14 offset:49152
  ds_read_b64_tr_b16 v[210:211], v14 offset:53248
  v_mfma_f32_16x16x32_bf16 v[84:87], v[140:143], a[44:47], v[84:87]
  ds_read_b64_tr_b16 v[212:213], v14 offset:57344
  ds_read_b64_tr_b16 v[214:215], v14 offset:61440
  v_mfma_f32_16x16x32_bf16 v[84:87], v[136:139], a[40:43], v[84:87]
  ds_read_b64_tr_b16 v[216:217], v15 offset:49152
  ds_read_b64_tr_b16 v[218:219], v15 offset:53248
  v_mfma_f32_16x16x32_bf16 v[88:91], v[144:147], a[40:43], v[88:91]
  ds_read_b64_tr_b16 v[220:221], v15 offset:57344
  ds_read_b64_tr_b16 v[222:223], v15 offset:61440
  v_mfma_f32_16x16x32_bf16 v[88:91], v[148:151], a[44:47], v[88:91]
  v_mfma_f32_16x16x32_bf16 v[92:95], v[156:159], a[44:47], v[92:95]
  v_mfma_f32_16x16x32_bf16 v[92:95], v[152:155], a[40:43], v[92:95]
  s_waitcnt vmcnt(24) lgkmcnt(0)
  s_barrier
  v_mfma_f32_16x16x32_bf16 v[32:35], v[160:163], a[48:51], v[32:35]
  s_mov_b64 s[8:9], s[44:45]
  s_mov_b32 s10, 4194304
  s_mov_b64 s[12:13], s[46:47]
  s_mov_b32 s14, 2097152
  s_mov_b32 s23, s49
  s_mov_b32 s25, s51
  s_add_u32 m0, s42, 0
  s_nop 0
  buffer_load_dwordx4 v6, s[12:15], s25 offen offset:0 lds
  v_mfma_f32_16x16x32_bf16 v[32:35], v[164:167], a[52:55], v[32:35]
  ds_read_b64_tr_b16 v[96:97], v16 offset:0
  ds_read_b64_tr_b16 v[98:99], v16 offset:4096
  v_mfma_f32_16x16x32_bf16 v[36:39], v[172:175], a[52:55], v[36:39]
  buffer_load_dwordx4 v7, s[12:15], s25 offen offset:1024 lds
  v_mfma_f32_16x16x32_bf16 v[36:39], v[168:171], a[48:51], v[36:39]
  ds_read_b64_tr_b16 v[100:101], v16 offset:8192
  ds_read_b64_tr_b16 v[102:103], v16 offset:12288
  v_mfma_f32_16x16x32_bf16 v[40:43], v[176:179], a[48:51], v[40:43]
  v_mfma_f32_16x16x32_bf16 v[40:43], v[180:183], a[52:55], v[40:43]
  buffer_load_dwordx4 a[0:3], v1, s[8:11], s23 offen offset:0
  v_mfma_f32_16x16x32_bf16 v[44:47], v[188:191], a[52:55], v[44:47]
  ds_read_b64_tr_b16 v[104:105], v17 offset:0
  ds_read_b64_tr_b16 v[106:107], v17 offset:4096
  v_mfma_f32_16x16x32_bf16 v[44:47], v[184:187], a[48:51], v[44:47]
  buffer_load_dwordx4 a[4:7], v1, s[8:11], s23 offen offset:1024
  v_mfma_f32_16x16x32_bf16 v[48:51], v[192:195], a[48:51], v[48:51]
  v_mfma_f32_16x16x32_bf16 v[48:51], v[196:199], a[52:55], v[48:51]
  ds_read_b64_tr_b16 v[108:109], v17 offset:8192
  ds_read_b64_tr_b16 v[110:111], v17 offset:12288
  v_mfma_f32_16x16x32_bf16 v[52:55], v[204:207], a[52:55], v[52:55]
  buffer_load_dwordx4 a[8:11], v1, s[8:11], s23 offen offset:2048
  v_mfma_f32_16x16x32_bf16 v[52:55], v[200:203], a[48:51], v[52:55]
  ds_read_b64_tr_b16 v[112:113], v18 offset:0
  ds_read_b64_tr_b16 v[114:115], v18 offset:4096
  v_mfma_f32_16x16x32_bf16 v[56:59], v[208:211], a[48:51], v[56:59]
  v_mfma_f32_16x16x32_bf16 v[56:59], v[212:215], a[52:55], v[56:59]
  buffer_load_dwordx4 a[12:15], v1, s[8:11], s23 offen offset:3072
  v_mfma_f32_16x16x32_bf16 v[60:63], v[220:223], a[52:55], v[60:63]
  ds_read_b64_tr_b16 v[116:117], v18 offset:8192
  ds_read_b64_tr_b16 v[118:119], v18 offset:12288
  v_mfma_f32_16x16x32_bf16 v[60:63], v[216:219], a[48:51], v[60:63]
  s_add_u32 s23, s23, 16384
  s_add_u32 s25, s25, 131072
  v_mfma_f32_16x16x32_bf16 v[64:67], v[160:163], a[56:59], v[64:67]
  ds_read_b64_tr_b16 v[120:121], v19 offset:0
  ds_read_b64_tr_b16 v[122:123], v19 offset:4096
  v_mfma_f32_16x16x32_bf16 v[64:67], v[164:167], a[60:63], v[64:67]
  v_mfma_f32_16x16x32_bf16 v[68:71], v[172:175], a[60:63], v[68:71]
  ds_read_b64_tr_b16 v[124:125], v19 offset:8192
  ds_read_b64_tr_b16 v[126:127], v19 offset:12288
  v_mfma_f32_16x16x32_bf16 v[68:71], v[168:171], a[56:59], v[68:71]
  ds_read_b64_tr_b16 v[128:129], v20 offset:0
  ds_read_b64_tr_b16 v[130:131], v20 offset:4096
  v_mfma_f32_16x16x32_bf16 v[72:75], v[176:179], a[56:59], v[72:75]
  ds_read_b64_tr_b16 v[132:133], v20 offset:8192
  ds_read_b64_tr_b16 v[134:135], v20 offset:12288
  v_mfma_f32_16x16x32_bf16 v[72:75], v[180:183], a[60:63], v[72:75]
  v_mfma_f32_16x16x32_bf16 v[76:79], v[188:191], a[60:63], v[76:79]
  ds_read_b64_tr_b16 v[136:137], v21 offset:0
  ds_read_b64_tr_b16 v[138:139], v21 offset:4096
  v_mfma_f32_16x16x32_bf16 v[76:79], v[184:187], a[56:59], v[76:79]
  ds_read_b64_tr_b16 v[140:141], v21 offset:8192
  ds_read_b64_tr_b16 v[142:143], v21 offset:12288
  v_mfma_f32_16x16x32_bf16 v[80:83], v[192:195], a[56:59], v[80:83]
  ds_read_b64_tr_b16 v[144:145], v22 offset:0
  ds_read_b64_tr_b16 v[146:147], v22 offset:4096
  v_mfma_f32_16x16x32_bf16 v[80:83], v[196:199], a[60:63], v[80:83]
  v_mfma_f32_16x16x32_bf16 v[84:87], v[204:207], a[60:63], v[84:87]
  ds_read_b64_tr_b16 v[148:149], v22 offset:8192
  ds_read_b64_tr_b16 v[150:151], v22 offset:12288
  v_mfma_f32_16x16x32_bf16 v[84:87], v[200:203], a[56:59], v[84:87]
  ds_read_b64_tr_b16 v[152:153], v23 offset:0
  ds_read_b64_tr_b16 v[154:155], v23 offset:4096
  v_mfma_f32_16x16x32_bf16 v[88:91], v[208:211], a[56:59], v[88:91]
  ds_read_b64_tr_b16 v[156:157], v23 offset:8192
  ds_read_b64_tr_b16 v[158:159], v23 offset:12288
  v_mfma_f32_16x16x32_bf16 v[88:91], v[212:215], a[60:63], v[88:91]
  v_mfma_f32_16x16x32_bf16 v[92:95], v[220:223], a[60:63], v[92:95]
  v_mfma_f32_16x16x32_bf16 v[92:95], v[216:219], a[56:59], v[92:95]
  s_waitcnt vmcnt(22) lgkmcnt(0)
  s_barrier
  v_mfma_f32_16x16x32_bf16 v[32:35], v[96:99], a[64:67], v[32:35]
  s_add_u32 m0, s42, 16384
  s_nop 0
  buffer_load_dwordx4 v6, s[12:15], s25 offen offset:0 lds
  v_mfma_f32_16x16x32_bf16 v[32:35], v[100:103], a[68:71], v[32:35]
  ds_read_b64_tr_b16 v[160:161], v16 offset:16384
  ds_read_b64_tr_b16 v[162:163], v16 offset:20480
  v_mfma_f32_16x16x32_bf16 v[36:39], v[108:111], a[68:71], v[36:39]
  buffer_load_dwordx4 v7, s[12:15], s25 offen offset:1024 lds
  v_mfma_f32_16x16x32_bf16 v[36:39], v[104:107], a[64:67], v[36:39]
  ds_read_b64_tr_b16 v[164:165], v16 offset:24576
  ds_read_b64_tr_b16 v[166:167], v16 offset:28672
  v_mfma_f32_16x16x32_bf16 v[40:43], v[112:115], a[64:67], v[40:43]
  v_mfma_f32_16x16x32_bf16 v[40:43], v[116:119], a[68:71], v[40:43]
  buffer_load_dwordx4 a[16:19], v1, s[8:11], s23 offen offset:0
  v_mfma_f32_16x16x32_bf16 v[44:47], v[124:127], a[68:71], v[44:47]
  ds_read_b64_tr_b16 v[168:169], v17 offset:16384
  ds_read_b64_tr_b16 v[170:171], v17 offset:20480
  v_mfma_f32_16x16x32_bf16 v[44:47], v[120:123], a[64:67], v[44:47]
  buffer_load_dwordx4 a[20:23], v1, s[8:11], s23 offen offset:1024
  v_mfma_f32_16x16x32_bf16 v[48:51], v[128:131], a[64:67], v[48:51]
  v_mfma_f32_16x16x32_bf16 v[48:51], v[132:135], a[68:71], v[48:51]
  ds_read_b64_tr_b16 v[172:173], v17 offset:24576
  ds_read_b64_tr_b16 v[174:175], v17 offset:28672
  v_mfma_f32_16x16x32_bf16 v[52:55], v[140:143], a[68:71], v[52:55]
  buffer_load_dwordx4 a[24:27], v1, s[8:11], s23 offen offset:2048
  v_mfma_f32_16x16x32_bf16 v[52:55], v[136:139], a[64:67], v[52:55]
  ds_read_b64_tr_b16 v[176:177], v18 offset:16384
  ds_read_b64_tr_b16 v[178:179], v18 offset:20480
  v_mfma_f32_16x16x32_bf16 v[56:59], v[144:147], a[64:67], v[56:59]
  v_mfma_f32_16x16x32_bf16 v[56:59], v[148:151], a[68:71], v[56:59]
  buffer_load_dwordx4 a[28:31], v1, s[8:11], s23 offen offset:3072
  v_mfma_f32_16x16x32_bf16 v[60:63], v[156:159], a[68:71], v[60:63]
  ds_read_b64_tr_b16 v[180:181], v18 offset:24576
  ds_read_b64_tr_b16 v[182:183], v18 offset:28672
  v_mfma_f32_16x16x32_bf16 v[60:63], v[152:155], a[64:67], v[60:63]
  s_add_u32 s23, s23, 16384
  s_add_u32 s25, s25, 131072
  v_mfma_f32_16x16x32_bf16 v[64:67], v[96:99], a[72:75], v[64:67]
  ds_read_b64_tr_b16 v[184:185], v19 offset:16384
  ds_read_b64_tr_b16 v[186:187], v19 offset:20480
  v_mfma_f32_16x16x32_bf16 v[64:67], v[100:103], a[76:79], v[64:67]
  v_mfma_f32_16x16x32_bf16 v[68:71], v[108:111], a[76:79], v[68:71]
  ds_read_b64_tr_b16 v[188:189], v19 offset:24576
  ds_read_b64_tr_b16 v[190:191], v19 offset:28672
  v_mfma_f32_16x16x32_bf16 v[68:71], v[104:107], a[72:75], v[68:71]
  ds_read_b64_tr_b16 v[192:193], v20 offset:16384
  ds_read_b64_tr_b16 v[194:195], v20 offset:20480
  v_mfma_f32_16x16x32_bf16 v[72:75], v[112:115], a[72:75], v[72:75]
  ds_read_b64_tr_b16 v[196:197], v20 offset:24576
  ds_read_b64_tr_b16 v[198:199], v20 offset:28672
  v_mfma_f32_16x16x32_bf16 v[72:75], v[116:119], a[76:79], v[72:75]
  v_mfma_f32_16x16x32_bf16 v[76:79], v[124:127], a[76:79], v[76:79]
  ds_read_b64_tr_b16 v[200:201], v21 offset:16384
  ds_read_b64_tr_b16 v[202:203], v21 offset:20480
  v_mfma_f32_16x16x32_bf16 v[76:79], v[120:123], a[72:75], v[76:79]
  ds_read_b64_tr_b16 v[204:205], v21 offset:24576
  ds_read_b64_tr_b16 v[206:207], v21 offset:28672
  v_mfma_f32_16x16x32_bf16 v[80:83], v[128:131], a[72:75], v[80:83]
  ds_read_b64_tr_b16 v[208:209], v22 offset:16384
  ds_read_b64_tr_b16 v[210:211], v22 offset:20480
  v_mfma_f32_16x16x32_bf16 v[80:83], v[132:135], a[76:79], v[80:83]
  v_mfma_f32_16x16x32_bf16 v[84:87], v[140:143], a[76:79], v[84:87]
  ds_read_b64_tr_b16 v[212:213], v22 offset:24576
  ds_read_b64_tr_b16 v[214:215], v22 offset:28672
  v_mfma_f32_16x16x32_bf16 v[84:87], v[136:139], a[72:75], v[84:87]
  ds_read_b64_tr_b16 v[216:217], v23 offset:16384
  ds_read_b64_tr_b16 v[218:219], v23 offset:20480
  v_mfma_f32_16x16x32_bf16 v[88:91], v[144:147], a[72:75], v[88:91]
  ds_read_b64_tr_b16 v[220:221], v23 offset:24576
  ds_read_b64_tr_b16 v[222:223], v23 offset:28672
  v_mfma_f32_16x16x32_bf16 v[88:91], v[148:151], a[76:79], v[88:91]
  v_mfma_f32_16x16x32_bf16 v[92:95], v[156:159], a[76:79], v[92:95]
  v_mfma_f32_16x16x32_bf16 v[92:95], v[152:155], a[72:75], v[92:95]
  s_waitcnt vmcnt(20) lgkmcnt(0)
  s_barrier
  v_mfma_f32_16x16x32_bf16 v[32:35], v[160:163], a[80:83], v[32:35]
  s_add_u32 m0, s42, 32768
  s_nop 0
  buffer_load_dwordx4 v6, s[12:15], s25 offen offset:0 lds
  v_mfma_f32_16x16x32_bf16 v[32:35], v[164:167], a[84:87], v[32:35]
  ds_read_b64_tr_b16 v[96:97], v16 offset:32768
  ds_read_b64_tr_b16 v[98:99], v16 offset:36864
  v_mfma_f32_16x16x32_bf16 v[36:39], v[172:175], a[84:87], v[36:39]
  buffer_load_dwordx4 v7, s[12:15], s25 offen offset:1024 lds
  v_mfma_f32_16x16x32_bf16 v[36:39], v[168:171], a[80:83], v[36:39]
  ds_read_b64_tr_b16 v[100:101], v16 offset:40960
  ds_read_b64_tr_b16 v[102:103], v16 offset:45056
  v_mfma_f32_16x16x32_bf16 v[40:43], v[176:179], a[80:83], v[40:43]
  v_mfma_f32_16x16x32_bf16 v[40:43], v[180:183], a[84:87], v[40:43]
  buffer_load_dwordx4 a[32:35], v1, s[8:11], s23 offen offset:0
  v_mfma_f32_16x16x32_bf16 v[44:47], v[188:191], a[84:87], v[44:47]
  ds_read_b64_tr_b16 v[104:105], v17 offset:32768
  ds_read_b64_tr_b16 v[106:107], v17 offset:36864
  v_mfma_f32_16x16x32_bf16 v[44:47], v[184:187], a[80:83], v[44:47]
  buffer_load_dwordx4 a[36:39], v1, s[8:11], s23 offen offset:1024
  v_mfma_f32_16x16x32_bf16 v[48:51], v[192:195], a[80:83], v[48:51]
  v_mfma_f32_16x16x32_bf16 v[48:51], v[196:199], a[84:87], v[48:51]
  ds_read_b64_tr_b16 v[108:109], v17 offset:40960
  ds_read_b64_tr_b16 v[110:111], v17 offset:45056
  v_mfma_f32_16x16x32_bf16 v[52:55], v[204:207], a[84:87], v[52:55]
  buffer_load_dwordx4 a[40:43], v1, s[8:11], s23 offen offset:2048
  v_mfma_f32_16x16x32_bf16 v[52:55], v[200:203], a[80:83], v[52:55]
  ds_read_b64_tr_b16 v[112:113], v18 offset:32768
  ds_read_b64_tr_b16 v[114:115], v18 offset:36864
  v_mfma_f32_16x16x32_bf16 v[56:59], v[208:211], a[80:83], v[56:59]
  v_mfma_f32_16x16x32_bf16 v[56:59], v[212:215], a[84:87], v[56:59]
  buffer_load_dwordx4 a[44:47], v1, s[8:11], s23 offen offset:3072
  v_mfma_f32_16x16x32_bf16 v[60:63], v[220:223], a[84:87], v[60:63]
  ds_read_b64_tr_b16 v[116:117], v18 offset:40960
  ds_read_b64_tr_b16 v[118:119], v18 offset:45056
  v_mfma_f32_16x16x32_bf16 v[60:63], v[216:219], a[80:83], v[60:63]
  s_add_u32 s23, s23, 16384
  s_add_u32 s25, s25, 131072
  v_mfma_f32_16x16x32_bf16 v[64:67], v[160:163], a[88:91], v[64:67]
  ds_read_b64_tr_b16 v[120:121], v19 offset:32768
  ds_read_b64_tr_b16 v[122:123], v19 offset:36864
  v_mfma_f32_16x16x32_bf16 v[64:67], v[164:167], a[92:95], v[64:67]
  v_mfma_f32_16x16x32_bf16 v[68:71], v[172:175], a[92:95], v[68:71]
  ds_read_b64_tr_b16 v[124:125], v19 offset:40960
  ds_read_b64_tr_b16 v[126:127], v19 offset:45056
  v_mfma_f32_16x16x32_bf16 v[68:71], v[168:171], a[88:91], v[68:71]
  ds_read_b64_tr_b16 v[128:129], v20 offset:32768
  ds_read_b64_tr_b16 v[130:131], v20 offset:36864
  v_mfma_f32_16x16x32_bf16 v[72:75], v[176:179], a[88:91], v[72:75]
  ds_read_b64_tr_b16 v[132:133], v20 offset:40960
  ds_read_b64_tr_b16 v[134:135], v20 offset:45056
  v_mfma_f32_16x16x32_bf16 v[72:75], v[180:183], a[92:95], v[72:75]
  v_mfma_f32_16x16x32_bf16 v[76:79], v[188:191], a[92:95], v[76:79]
  ds_read_b64_tr_b16 v[136:137], v21 offset:32768
  ds_read_b64_tr_b16 v[138:139], v21 offset:36864
  v_mfma_f32_16x16x32_bf16 v[76:79], v[184:187], a[88:91], v[76:79]
  ds_read_b64_tr_b16 v[140:141], v21 offset:40960
  ds_read_b64_tr_b16 v[142:143], v21 offset:45056
  v_mfma_f32_16x16x32_bf16 v[80:83], v[192:195], a[88:91], v[80:83]
  ds_read_b64_tr_b16 v[144:145], v22 offset:32768
  ds_read_b64_tr_b16 v[146:147], v22 offset:36864
  v_mfma_f32_16x16x32_bf16 v[80:83], v[196:199], a[92:95], v[80:83]
  v_mfma_f32_16x16x32_bf16 v[84:87], v[204:207], a[92:95], v[84:87]
  ds_read_b64_tr_b16 v[148:149], v22 offset:40960
  ds_read_b64_tr_b16 v[150:151], v22 offset:45056
  v_mfma_f32_16x16x32_bf16 v[84:87], v[200:203], a[88:91], v[84:87]
  ds_read_b64_tr_b16 v[152:153], v23 offset:32768
  ds_read_b64_tr_b16 v[154:155], v23 offset:36864
  v_mfma_f32_16x16x32_bf16 v[88:91], v[208:211], a[88:91], v[88:91]
  ds_read_b64_tr_b16 v[156:157], v23 offset:40960
  ds_read_b64_tr_b16 v[158:159], v23 offset:45056
  v_mfma_f32_16x16x32_bf16 v[88:91], v[212:215], a[92:95], v[88:91]
  v_mfma_f32_16x16x32_bf16 v[92:95], v[220:223], a[92:95], v[92:95]
  v_mfma_f32_16x16x32_bf16 v[92:95], v[216:219], a[88:91], v[92:95]
  s_waitcnt vmcnt(18) lgkmcnt(0)
  s_barrier
  v_mfma_f32_16x16x32_bf16 v[32:35], v[96:99], a[96:99], v[32:35]
  s_add_u32 m0, s42, 49152
  s_nop 0
  buffer_load_dwordx4 v6, s[12:15], s25 offen offset:0 lds
  v_mfma_f32_16x16x32_bf16 v[32:35], v[100:103], a[100:103], v[32:35]
  ds_read_b64_tr_b16 v[160:161], v16 offset:49152
  ds_read_b64_tr_b16 v[162:163], v16 offset:53248
  v_mfma_f32_16x16x32_bf16 v[36:39], v[108:111], a[100:103], v[36:39]
  buffer_load_dwordx4 v7, s[12:15], s25 offen offset:1024 lds
  v_mfma_f32_16x16x32_bf16 v[36:39], v[104:107], a[96:99], v[36:39]
  ds_read_b64_tr_b16 v[164:165], v16 offset:57344
  ds_read_b64_tr_b16 v[166:167], v16 offset:61440
  v_mfma_f32_16x16x32_bf16 v[40:43], v[112:115], a[96:99], v[40:43]
  v_mfma_f32_16x16x32_bf16 v[40:43], v[116:119], a[100:103], v[40:43]
  buffer_load_dwordx4 a[48:51], v1, s[8:11], s23 offen offset:0
  v_mfma_f32_16x16x32_bf16 v[44:47], v[124:127], a[100:103], v[44:47]
  ds_read_b64_tr_b16 v[168:169], v17 offset:49152
  ds_read_b64_tr_b16 v[170:171], v17 offset:53248
  v_mfma_f32_16x16x32_bf16 v[44:47], v[120:123], a[96:99], v[44:47]
  buffer_load_dwordx4 a[52:55], v1, s[8:11], s23 offen offset:1024
  v_mfma_f32_16x16x32_bf16 v[48:51], v[128:131], a[96:99], v[48:51]
  v_mfma_f32_16x16x32_bf16 v[48:51], v[132:135], a[100:103], v[48:51]
  ds_read_b64_tr_b16 v[172:173], v17 offset:57344
  ds_read_b64_tr_b16 v[174:175], v17 offset:61440
  v_mfma_f32_16x16x32_bf16 v[52:55], v[140:143], a[100:103], v[52:55]
  buffer_load_dwordx4 a[56:59], v1, s[8:11], s23 offen offset:2048
  v_mfma_f32_16x16x32_bf16 v[52:55], v[136:139], a[96:99], v[52:55]
  ds_read_b64_tr_b16 v[176:177], v18 offset:49152
  ds_read_b64_tr_b16 v[178:179], v18 offset:53248
  v_mfma_f32_16x16x32_bf16 v[56:59], v[144:147], a[96:99], v[56:59]
  v_mfma_f32_16x16x32_bf16 v[56:59], v[148:151], a[100:103], v[56:59]
  buffer_load_dwordx4 a[60:63], v1, s[8:11], s23 offen offset:3072
  v_mfma_f32_16x16x32_bf16 v[60:63], v[156:159], a[100:103], v[60:63]
  ds_read_b64_tr_b16 v[180:181], v18 offset:57344
  ds_read_b64_tr_b16 v[182:183], v18 offset:61440
  v_mfma_f32_16x16x32_bf16 v[60:63], v[152:155], a[96:99], v[60:63]
  s_add_u32 s23, s23, 16384
  s_add_u32 s25, s25, 131072
  v_mfma_f32_16x16x32_bf16 v[64:67], v[96:99], a[104:107], v[64:67]
  ds_read_b64_tr_b16 v[184:185], v19 offset:49152
  ds_read_b64_tr_b16 v[186:187], v19 offset:53248
  v_mfma_f32_16x16x32_bf16 v[64:67], v[100:103], a[108:111], v[64:67]
  v_mfma_f32_16x16x32_bf16 v[68:71], v[108:111], a[108:111], v[68:71]
  ds_read_b64_tr_b16 v[188:189], v19 offset:57344
  ds_read_b64_tr_b16 v[190:191], v19 offset:61440
  v_mfma_f32_16x16x32_bf16 v[68:71], v[104:107], a[104:107], v[68:71]
  ds_read_b64_tr_b16 v[192:193], v20 offset:49152
  ds_read_b64_tr_b16 v[194:195], v20 offset:53248
  v_mfma_f32_16x16x32_bf16 v[72:75], v[112:115], a[104:107], v[72:75]
  ds_read_b64_tr_b16 v[196:197], v20 offset:57344
  ds_read_b64_tr_b16 v[198:199], v20 offset:61440
  v_mfma_f32_16x16x32_bf16 v[72:75], v[116:119], a[108:111], v[72:75]
  v_mfma_f32_16x16x32_bf16 v[76:79], v[124:127], a[108:111], v[76:79]
  ds_read_b64_tr_b16 v[200:201], v21 offset:49152
  ds_read_b64_tr_b16 v[202:203], v21 offset:53248
  v_mfma_f32_16x16x32_bf16 v[76:79], v[120:123], a[104:107], v[76:79]
  ds_read_b64_tr_b16 v[204:205], v21 offset:57344
  ds_read_b64_tr_b16 v[206:207], v21 offset:61440
  v_mfma_f32_16x16x32_bf16 v[80:83], v[128:131], a[104:107], v[80:83]
  ds_read_b64_tr_b16 v[208:209], v22 offset:49152
  ds_read_b64_tr_b16 v[210:211], v22 offset:53248
  v_mfma_f32_16x16x32_bf16 v[80:83], v[132:135], a[108:111], v[80:83]
  v_mfma_f32_16x16x32_bf16 v[84:87], v[140:143], a[108:111], v[84:87]
  ds_read_b64_tr_b16 v[212:213], v22 offset:57344
  ds_read_b64_tr_b16 v[214:215], v22 offset:61440
  v_mfma_f32_16x16x32_bf16 v[84:87], v[136:139], a[104:107], v[84:87]
  ds_read_b64_tr_b16 v[216:217], v23 offset:49152
  ds_read_b64_tr_b16 v[218:219], v23 offset:53248
  v_mfma_f32_16x16x32_bf16 v[88:91], v[144:147], a[104:107], v[88:91]
  ds_read_b64_tr_b16 v[220:221], v23 offset:57344
  ds_read_b64_tr_b16 v[222:223], v23 offset:61440
  v_mfma_f32_16x16x32_bf16 v[88:91], v[148:151], a[108:111], v[88:91]
  v_mfma_f32_16x16x32_bf16 v[92:95], v[156:159], a[108:111], v[92:95]
  v_mfma_f32_16x16x32_bf16 v[92:95], v[152:155], a[104:107], v[92:95]
  s_waitcnt vmcnt(18) lgkmcnt(0)
  s_barrier
  v_mfma_f32_16x16x32_bf16 v[32:35], v[160:163], a[112:115], v[32:35]
  s_add_u32 m0, s42, 65536
  s_nop 0
  buffer_load_dwordx4 v6, s[12:15], s25 offen offset:0 lds
  v_mfma_f32_16x16x32_bf16 v[32:35], v[164:167], a[116:119], v[32:35]
  v_mfma_f32_16x16x32_bf16 v[36:39], v[172:175], a[116:119], v[36:39]
  ds_read_b64_tr_b16 v[96:97], v24 offset:0
  ds_read_b64_tr_b16 v[98:99], v24 offset:2048
  v_mfma_f32_16x16x32_bf16 v[36:39], v[168:171], a[112:115], v[36:39]
  v_mfma_f32_16x16x32_bf16 v[40:43], v[176:179], a[112:115], v[40:43]
  buffer_load_dwordx4 v7, s[12:15], s25 offen offset:1024 lds
  v_mfma_f32_16x16x32_bf16 v[40:43], v[180:183], a[116:119], v[40:43]
  v_mfma_f32_16x16x32_bf16 v[44:47], v[188:191], a[116:119], v[44:47]
  ds_read_b64_tr_b16 v[100:101], v24 offset:4096
  ds_read_b64_tr_b16 v[102:103], v24 offset:6144
  v_mfma_f32_16x16x32_bf16 v[44:47], v[184:187], a[112:115], v[44:47]
  v_mfma_f32_16x16x32_bf16 v[48:51], v[192:195], a[112:115], v[48:51]
  buffer_load_dwordx4 a[64:67], v1, s[8:11], s23 offen offset:0
  v_mfma_f32_16x16x32_bf16 v[48:51], v[196:199], a[116:119], v[48:51]
  v_mfma_f32_16x16x32_bf16 v[52:55], v[204:207], a[116:119], v[52:55]
  ds_read_b64_tr_b16 v[104:105], v25 offset:0
  ds_read_b64_tr_b16 v[106:107], v25 offset:2048
  v_mfma_f32_16x16x32_bf16 v[52:55], v[200:203], a[112:115], v[52:55]
  v_mfma_f32_16x16x32_bf16 v[56:59], v[208:211], a[112:115], v[56:59]
  buffer_load_dwordx4 a[68:71], v1, s[8:11], s23 offen offset:1024
  v_mfma_f32_16x16x32_bf16 v[56:59], v[212:215], a[116:119], v[56:59]
  v_mfma_f32_16x16x32_bf16 v[60:63], v[220:223], a[116:119], v[60:63]
  ds_read_b64_tr_b16 v[108:109], v25 offset:4096
  ds_read_b64_tr_b16 v[110:111], v25 offset:6144
  v_mfma_f32_16x16x32_bf16 v[60:63], v[216:219], a[112:115], v[60:63]
  v_mfma_f32_16x16x32_bf16 v[64:67], v[160:163], a[120:123], v[64:67]
  buffer_load_dwordx4 a[72:75], v1, s[8:11], s23 offen offset:2048
  v_mfma_f32_16x16x32_bf16 v[64:67], v[164:167], a[124:127], v[64:67]
  v_mfma_f32_16x16x32_bf16 v[68:71], v[172:175], a[124:127], v[68:71]
  ds_read_b64_tr_b16 v[112:113], v26 offset:0
  ds_read_b64_tr_b16 v[114:115], v26 offset:2048
  v_mfma_f32_16x16x32_bf16 v[68:71], v[168:171], a[120:123], v[68:71]
  v_mfma_f32_16x16x32_bf16 v[72:75], v[176:179], a[120:123], v[72:75]
  buffer_load_dwordx4 a[76:79], v1, s[8:11], s23 offen offset:3072
  v_mfma_f32_16x16x32_bf16 v[72:75], v[180:183], a[124:127], v[72:75]
  v_mfma_f32_16x16x32_bf16 v[76:79], v[188:191], a[124:127], v[76:79]
  ds_read_b64_tr_b16 v[116:117], v26 offset:4096
  ds_read_b64_tr_b16 v[118:119], v26 offset:6144
  v_mfma_f32_16x16x32_bf16 v[76:79], v[184:187], a[120:123], v[76:79]
  v_mfma_f32_16x16x32_bf16 v[80:83], v[192:195], a[120:123], v[80:83]
  s_add_u32 s23, s23, 16384
  s_add_u32 s25, s25, 131072
  v_mfma_f32_16x16x32_bf16 v[80:83], v[196:199], a[124:127], v[80:83]
  v_mfma_f32_16x16x32_bf16 v[84:87], v[204:207], a[124:127], v[84:87]
  ds_read_b64_tr_b16 v[120:121], v27 offset:0
  ds_read_b64_tr_b16 v[122:123], v27 offset:2048
  v_mfma_f32_16x16x32_bf16 v[84:87], v[200:203], a[120:123], v[84:87]
  v_mfma_f32_16x16x32_bf16 v[88:91], v[208:211], a[120:123], v[88:91]
  ds_read_b64_tr_b16 v[124:125], v27 offset:4096
  ds_read_b64_tr_b16 v[126:127], v27 offset:6144
  v_mfma_f32_16x16x32_bf16 v[88:91], v[212:215], a[124:127], v[88:91]
  v_mfma_f32_16x16x32_bf16 v[92:95], v[220:223], a[124:127], v[92:95]
  v_mfma_f32_16x16x32_bf16 v[92:95], v[216:219], a[120:123], v[92:95]
  s_waitcnt vmcnt(18) lgkmcnt(0)
  s_barrier
  v_mfma_f32_16x16x32_bf16 v[160:163], v[96:99], a[0:3], 0
  s_add_u32 m0, s42, 81920
  s_nop 0
  buffer_load_dwordx4 v6, s[12:15], s25 offen offset:0 lds
  ds_read_b64_tr_b16 v[128:129], v24 offset:16384
  ds_read_b64_tr_b16 v[130:131], v24 offset:18432
  v_mfma_f32_16x16x32_bf16 v[160:163], v[100:103], a[4:7], v[160:163]
  buffer_load_dwordx4 v7, s[12:15], s25 offen offset:1024 lds
  v_mfma_f32_16x16x32_bf16 v[164:167], v[108:111], a[4:7], 0
  ds_read_b64_tr_b16 v[132:133], v24 offset:20480
  ds_read_b64_tr_b16 v[134:135], v24 offset:22528
  buffer_load_dwordx4 a[80:83], v1, s[8:11], s23 offen offset:0
  v_mfma_f32_16x16x32_bf16 v[164:167], v[104:107], a[0:3], v[164:167]
  ds_read_b64_tr_b16 v[136:137], v25 offset:16384
  ds_read_b64_tr_b16 v[138:139], v25 offset:18432
  v_mfma_f32_16x16x32_bf16 v[168:171], v[112:115], a[0:3], 0
  buffer_load_dwordx4 a[84:87], v1, s[8:11], s23 offen offset:1024
  v_mfma_f32_16x16x32_bf16 v[168:171], v[116:119], a[4:7], v[168:171]
  ds_read_b64_tr_b16 v[140:141], v25 offset:20480
  ds_read_b64_tr_b16 v[142:143], v25 offset:22528
  buffer_load_dwordx4 a[88:91], v1, s[8:11], s23 offen offset:2048
  v_mfma_f32_16x16x32_bf16 v[172:175], v[124:127], a[4:7], 0
  ds_read_b64_tr_b16 v[144:145], v26 offset:16384
  ds_read_b64_tr_b16 v[146:147], v26 offset:18432
  v_mfma_f32_16x16x32_bf16 v[172:175], v[120:123], a[0:3], v[172:175]
  buffer_load_dwordx4 a[92:95], v1, s[8:11], s23 offen offset:3072
  v_mfma_f32_16x16x32_bf16 v[176:179], v[96:99], a[8:11], 0
  ds_read_b64_tr_b16 v[148:149], v26 offset:20480
  ds_read_b64_tr_b16 v[150:151], v26 offset:22528
  s_add_u32 s23, s23, 16384
  s_add_u32 s25, s25, 131072
  v_mfma_f32_16x16x32_bf16 v[176:179], v[100:103], a[12:15], v[176:179]
  ds_read_b64_tr_b16 v[152:153], v27 offset:16384
  ds_read_b64_tr_b16 v[154:155], v27 offset:18432
  v_mfma_f32_16x16x32_bf16 v[180:183], v[108:111], a[12:15], 0
  s_add_u32 s60, s56, 0
  buffer_store_dwordx4 v[48:51], v1, s[52:55], s60 offen offset:0 sc1
  v_mfma_f32_16x16x32_bf16 v[180:183], v[104:107], a[8:11], v[180:183]
  ds_read_b64_tr_b16 v[156:157], v27 offset:20480
  ds_read_b64_tr_b16 v[158:159], v27 offset:22528
  buffer_store_dwordx4 v[52:55], v1, s[52:55], s60 offen offset:1024 sc1
  v_mfma_f32_16x16x32_bf16 v[184:187], v[112:115], a[8:11], 0
  buffer_store_dwordx4 v[56:59], v1, s[52:55], s60 offen offset:2048 sc1
  v_mfma_f32_16x16x32_bf16 v[184:187], v[116:119], a[12:15], v[184:187]
  buffer_store_dwordx4 v[60:63], v1, s[52:55], s60 offen offset:3072 sc1
  v_mfma_f32_16x16x32_bf16 v[188:191], v[124:127], a[12:15], 0
  v_mfma_f32_16x16x32_bf16 v[188:191], v[120:123], a[8:11], v[188:191]
  s_waitcnt vmcnt(22) lgkmcnt(0)
  s_barrier
  v_mfma_f32_16x16x32_bf16 v[160:163], v[128:131], a[16:19], v[160:163]
  s_add_u32 m0, s42, 98304
  s_nop 0
  buffer_load_dwordx4 v6, s[12:15], s25 offen offset:0 lds
  ds_read_b64_tr_b16 v[96:97], v24 offset:32768
  ds_read_b64_tr_b16 v[98:99], v24 offset:34816
  v_mfma_f32_16x16x32_bf16 v[160:163], v[132:135], a[20:23], v[160:163]
  buffer_load_dwordx4 v7, s[12:15], s25 offen offset:1024 lds
  v_mfma_f32_16x16x32_bf16 v[164:167], v[140:143], a[20:23], v[164:167]
  ds_read_b64_tr_b16 v[100:101], v24 offset:36864
  ds_read_b64_tr_b16 v[102:103], v24 offset:38912
  buffer_load_dwordx4 a[96:99], v1, s[8:11], s23 offen offset:0
  v_mfma_f32_16x16x32_bf16 v[164:167], v[136:139], a[16:19], v[164:167]
  ds_read_b64_tr_b16 v[104:105], v25 offset:32768
  ds_read_b64_tr_b16 v[106:107], v25 offset:34816
  v_mfma_f32_16x16x32_bf16 v[168:171], v[144:147], a[16:19], v[168:171]
  buffer_load_dwordx4 a[100:103], v1, s[8:11], s23 offen offset:1024
  v_mfma_f32_16x16x32_bf16 v[168:171], v[148:151], a[20:23], v[168:171]
  ds_read_b64_tr_b16 v[108:109], v25 offset:36864
  ds_read_b64_tr_b16 v[110:111], v25 offset:38912
  buffer_load_dwordx4 a[104:107], v1, s[8:11], s23 offen offset:2048
  v_mfma_f32_16x16x32_bf16 v[172:175], v[156:159], a[20:23], v[172:175]
  ds_read_b64_tr_b16 v[112:113], v26 offset:32768
  ds_read_b64_tr_b16 v[114:115], v26 offset:34816
  v_mfma_f32_16x16x32_bf16 v[172:175], v[152:155], a[16:19], v[172:175]
  buffer_load_dwordx4 a[108:111], v1, s[8:11], s23 offen offset:3072
  v_mfma_f32_16x16x32_bf16 v[176:179], v[128:131], a[24:27], v[176:179]
  ds_read_b64_tr_b16 v[116:117], v26 offset:36864
  ds_read_b64_tr_b16 v[118:119], v26 offset:38912
  s_add_u32 s23, s23, 16384
  s_add_u32 s25, s25, 131072
  v_mfma_f32_16x16x32_bf16 v[176:179], v[132:135], a[28:31], v[176:179]
  ds_read_b64_tr_b16 v[120:121], v27 offset:32768
  ds_read_b64_tr_b16 v[122:123], v27 offset:34816
  v_mfma_f32_16x16x32_bf16 v[180:183], v[140:143], a[28:31], v[180:183]
  s_add_u32 s60, s56, 4096
  buffer_store_dwordx4 v[80:83], v1, s[52:55], s60 offen offset:0 sc1
  v_mfma_f32_16x16x32_bf16 v[180:183], v[136:139], a[24:27], v[180:183]
  ds_read_b64_tr_b16 v[124:125], v27 offset:36864
  ds_read_b64_tr_b16 v[126:127], v27 offset:38912
  buffer_store_dwordx4 v[84:87], v1, s[52:55], s60 offen offset:1024 sc1
  v_mfma_f32_16x16x32_bf16 v[184:187], v[144:147], a[24:27], v[184:187]
  buffer_store_dwordx4 v[88:91], v1, s[52:55], s60 offen offset:2048 sc1
  v_mfma_f32_16x16x32_bf16 v[184:187], v[148:151], a[28:31], v[184:187]
  buffer_store_dwordx4 v[92:95], v1, s[52:55], s60 offen offset:3072 sc1
  v_mfma_f32_16x16x32_bf16 v[188:191], v[156:159], a[28:31], v[188:191]
  v_mfma_f32_16x16x32_bf16 v[188:191], v[152:155], a[24:27], v[188:191]
  s_waitcnt vmcnt(26) lgkmcnt(0)
  s_barrier
  v_mfma_f32_16x16x32_bf16 v[160:163], v[96:99], a[32:35], v[160:163]
  s_add_u32 m0, s42, 114688
  s_nop 0
  buffer_load_dwordx4 v6, s[12:15], s25 offen offset:0 lds
  ds_read_b64_tr_b16 v[128:129], v24 offset:49152
  ds_read_b64_tr_b16 v[130:131], v24 offset:51200
  v_mfma_f32_16x16x32_bf16 v[160:163], v[100:103], a[36:39], v[160:163]
  buffer_load_dwordx4 v7, s[12:15], s25 offen offset:1024 lds
  v_mfma_f32_16x16x32_bf16 v[164:167], v[108:111], a[36:39], v[164:167]
  ds_read_b64_tr_b16 v[132:133], v24 offset:53248
  ds_read_b64_tr_b16 v[134:135], v24 offset:55296
  v_mfma_f32_16x16x32_bf16 v[164:167], v[104:107], a[32:35], v[164:167]
  buffer_load_dwordx4 a[112:115], v1, s[8:11], s23 offen offset:0
  v_mfma_f32_16x16x32_bf16 v[168:171], v[112:115], a[32:35], v[168:171]
  ds_read_b64_tr_b16 v[136:137], v25 offset:49152
  ds_read_b64_tr_b16 v[138:139], v25 offset:51200
  v_mfma_f32_16x16x32_bf16 v[168:171], v[116:119], a[36:39], v[168:171]
  buffer_load_dwordx4 a[116:119], v1, s[8:11], s23 offen offset:1024
  v_mfma_f32_16x16x32_bf16 v[172:175], v[124:127], a[36:39], v[172:175]
  ds_read_b64_tr_b16 v[140:141], v25 offset:53248
  ds_read_b64_tr_b16 v[142:143], v25 offset:55296
  v_mfma_f32_16x16x32_bf16 v[172:175], v[120:123], a[32:35], v[172:175]
  buffer_load_dwordx4 a[120:123], v1, s[8:11], s23 offen offset:2048
  v_mfma_f32_16x16x32_bf16 v[176:179], v[96:99], a[40:43], v[176:179]
  ds_read_b64_tr_b16 v[144:145], v26 offset:49152
  ds_read_b64_tr_b16 v[146:147], v26 offset:51200
  v_mfma_f32_16x16x32_bf16 v[176:179], v[100:103], a[44:47], v[176:179]
  buffer_load_dwordx4 a[124:127], v1, s[8:11], s23 offen offset:3072
  v_mfma_f32_16x16x32_bf16 v[180:183], v[108:111], a[44:47], v[180:183]
  ds_read_b64_tr_b16 v[148:149], v26 offset:53248
  ds_read_b64_tr_b16 v[150:151], v26 offset:55296
  v_mfma_f32_16x16x32_bf16 v[180:183], v[104:107], a[40:43], v[180:183]
  s_add_u32 s23, s23, 16384
  s_add_u32 s25, s25, 131072
  v_mfma_f32_16x16x32_bf16 v[184:187], v[112:115], a[40:43], v[184:187]
  ds_read_b64_tr_b16 v[152:153], v27 offset:49152
  ds_read_b64_tr_b16 v[154:155], v27 offset:51200
  v_mfma_f32_16x16x32_bf16 v[184:187], v[116:119], a[44:47], v[184:187]
  ds_read_b64_tr_b16 v[156:157], v27 offset:53248
  ds_read_b64_tr_b16 v[158:159], v27 offset:55296
  v_mfma_f32_16x16x32_bf16 v[188:191], v[124:127], a[44:47], v[188:191]
  v_mfma_f32_16x16x32_bf16 v[188:191], v[120:123], a[40:43], v[188:191]
  s_waitcnt vmcnt(26) lgkmcnt(0)
  s_barrier
  v_mfma_f32_16x16x32_bf16 v[160:163], v[128:131], a[48:51], v[160:163]
  s_add_u32 m0, s42, 0
  s_nop 0
  buffer_load_dwordx4 v6, s[12:15], s25 offen offset:0 lds
  ds_read_b64_tr_b16 v[96:97], v28 offset:0
  ds_read_b64_tr_b16 v[98:99], v28 offset:2048
  v_mfma_f32_16x16x32_bf16 v[160:163], v[132:135], a[52:55], v[160:163]
  buffer_load_dwordx4 v7, s[12:15], s25 offen offset:1024 lds
  v_mfma_f32_16x16x32_bf16 v[164:167], v[140:143], a[52:55], v[164:167]
  ds_read_b64_tr_b16 v[100:101], v28 offset:4096
  ds_read_b64_tr_b16 v[102:103], v28 offset:6144
  v_mfma_f32_16x16x32_bf16 v[164:167], v[136:139], a[48:51], v[164:167]
  buffer_load_dwordx4 a[0:3], v1, s[8:11], s23 offen offset:0
  v_mfma_f32_16x16x32_bf16 v[168:171], v[144:147], a[48:51], v[168:171]
  ds_read_b64_tr_b16 v[104:105], v29 offset:0
  ds_read_b64_tr_b16 v[106:107], v29 offset:2048
  v_mfma_f32_16x16x32_bf16 v[168:171], v[148:151], a[52:55], v[168:171]
  buffer_load_dwordx4 a[4:7], v1, s[8:11], s23 offen offset:1024
  v_mfma_f32_16x16x32_bf16 v[172:175], v[156:159], a[52:55], v[172:175]
  ds_read_b64_tr_b16 v[108:109], v29 offset:4096
  ds_read_b64_tr_b16 v[110:111], v29 offset:6144
  v_mfma_f32_16x16x32_bf16 v[172:175], v[152:155], a[48:51], v[172:175]
  buffer_load_dwordx4 a[8:11], v1, s[8:11], s23 offen offset:2048
  v_mfma_f32_16x16x32_bf16 v[176:179], v[128:131], a[56:59], v[176:179]
  ds_read_b64_tr_b16 v[112:113], v30 offset:0
  ds_read_b64_tr_b16 v[114:115], v30 offset:2048
  v_mfma_f32_16x16x32_bf16 v[176:179], v[132:135], a[60:63], v[176:179]
  buffer_load_dwordx4 a[12:15], v1, s[8:11], s23 offen offset:3072
  v_mfma_f32_16x16x32_bf16 v[180:183], v[140:143], a[60:63], v[180:183]
  ds_read_b64_tr_b16 v[116:117], v30 offset:4096
  ds_read_b64_tr_b16 v[118:119], v30 offset:6144
  v_mfma_f32_16x16x32_bf16 v[180:183], v[136:139], a[56:59], v[180:183]
  s_add_u32 s23, s23, 16384
  s_add_u32 s25, s25, 131072
  v_mfma_f32_16x16x32_bf16 v[184:187], v[144:147], a[56:59], v[184:187]
  ds_read_b64_tr_b16 v[120:121], v31 offset:0
  ds_read_b64_tr_b16 v[122:123], v31 offset:2048
  v_mfma_f32_16x16x32_bf16 v[184:187], v[148:151], a[60:63], v[184:187]
  ds_read_b64_tr_b16 v[124:125], v31 offset:4096
  ds_read_b64_tr_b16 v[126:127], v31 offset:6144
  v_mfma_f32_16x16x32_bf16 v[188:191], v[156:159], a[60:63], v[188:191]
  v_mfma_f32_16x16x32_bf16 v[188:191], v[152:155], a[56:59], v[188:191]
  s_waitcnt vmcnt(12) lgkmcnt(0)
  s_barrier
  s_cmp_lg_u32 s20, 0
  s_cbranch_scc1 Lk3f_14
  v_mov_b32 v9, 1
  v_mov_b32 v10, 0
  s_mov_b64 exec, 1
  buffer_store_dword v9, v10, s[52:55], s58 offen sc1
  s_mov_b64 exec, -1
Lk3f_14:
  v_mfma_f32_16x16x32_bf16 v[160:163], v[96:99], a[64:67], v[160:163]
  s_add_u32 m0, s42, 16384
  s_nop 0
  buffer_load_dwordx4 v6, s[12:15], s25 offen offset:0 lds
  ds_read_b64_tr_b16 v[128:129], v28 offset:16384
  ds_read_b64_tr_b16 v[130:131], v28 offset:18432
  v_mfma_f32_16x16x32_bf16 v[160:163], v[100:103], a[68:71], v[160:163]
  buffer_load_dwordx4 v7, s[12:15], s25 offen offset:1024 lds
  v_mfma_f32_16x16x32_bf16 v[164:167], v[108:111], a[68:71], v[164:167]
  ds_read_b64_tr_b16 v[132:133], v28 offset:20480
  ds_read_b64_tr_b16 v[134:135], v28 offset:22528
  v_mfma_f32_16x16x32_bf16 v[164:167], v[104:107], a[64:67], v[164:167]
  buffer_load_dwordx4 a[16:19], v1, s[8:11], s23 offen offset:0
  v_mfma_f32_16x16x32_bf16 v[168:171], v[112:115], a[64:67], v[168:171]
  ds_read_b64_tr_b16 v[136:137], v29 offset:16384
  ds_read_b64_tr_b16 v[138:139], v29 offset:18432
  v_mfma_f32_16x16x32_bf16 v[168:171], v[116:119], a[68:71], v[168:171]
  buffer_load_dwordx4 a[20:23], v1, s[8:11], s23 offen offset:1024
  v_mfma_f32_16x16x32_bf16 v[172:175], v[124:127], a[68:71], v[172:175]
  ds_read_b64_tr_b16 v[140:141], v29 offset:20480
  ds_read_b64_tr_b16 v[142:143], v29 offset:22528
  v_mfma_f32_16x16x32_bf16 v[172:175], v[120:123], a[64:67], v[172:175]
  buffer_load_dwordx4 a[24:27], v1, s[8:11], s23 offen offset:2048
  v_mfma_f32_16x16x32_bf16 v[176:179], v[96:99], a[72:75], v[176:179]
  ds_read_b64_tr_b16 v[144:145], v30 offset:16384
  ds_read_b64_tr_b16 v[146:147], v30 offset:18432
  v_mfma_f32_16x16x32_bf16 v[176:179], v[100:103], a[76:79], v[176:179]
  buffer_load_dwordx4 a[28:31], v1, s[8:11], s23 offen offset:3072
  v_mfma_f32_16x16x32_bf16 v[180:183], v[108:111], a[76:79], v[180:183]
  ds_read_b64_tr_b16 v[148:149], v30 offset:20480
  ds_read_b64_tr_b16 v[150:151], v30 offset:22528
  v_mfma_f32_16x16x32_bf16 v[180:183], v[104:107], a[72:75], v[180:183]
  s_add_u32 s23, s23, 16384
  s_add_u32 s25, s25, 131072
  v_mfma_f32_16x16x32_bf16 v[184:187], v[112:115], a[72:75], v[184:187]
  ds_read_b64_tr_b16 v[152:153], v31 offset:16384
  ds_read_b64_tr_b16 v[154:155], v31 offset:18432
  v_mfma_f32_16x16x32_bf16 v[184:187], v[116:119], a[76:79], v[184:187]
  ds_read_b64_tr_b16 v[156:157], v31 offset:20480
  ds_read_b64_tr_b16 v[158:159], v31 offset:22528
  v_mfma_f32_16x16x32_bf16 v[188:191], v[124:127], a[76:79], v[188:191]
  v_mfma_f32_16x16x32_bf16 v[188:191], v[120:123], a[72:75], v[188:191]
  s_waitcnt vmcnt(22) lgkmcnt(0)
  s_barrier
  v_mfma_f32_16x16x32_bf16 v[160:163], v[128:131], a[80:83], v[160:163]
  s_add_u32 m0, s42, 32768
  s_nop 0
  buffer_load_dwordx4 v6, s[12:15], s25 offen offset:0 lds
  ds_read_b64_tr_b16 v[96:97], v28 offset:32768
  ds_read_b64_tr_b16 v[98:99], v28 offset:34816
  v_mfma_f32_16x16x32_bf16 v[160:163], v[132:135], a[84:87], v[160:163]
  buffer_load_dwordx4 v7, s[12:15], s25 offen offset:1024 lds
  v_mfma_f32_16x16x32_bf16 v[164:167], v[140:143], a[84:87], v[164:167]
  ds_read_b64_tr_b16 v[100:101], v28 offset:36864
  ds_read_b64_tr_b16 v[102:103], v28 offset:38912
  v_mfma_f32_16x16x32_bf16 v[164:167], v[136:139], a[80:83], v[164:167]
  buffer_load_dwordx4 a[32:35], v1, s[8:11], s23 offen offset:0
  v_mfma_f32_16x16x32_bf16 v[168:171], v[144:147], a[80:83], v[168:171]
  ds_read_b64_tr_b16 v[104:105], v29 offset:32768
  ds_read_b64_tr_b16 v[106:107], v29 offset:34816
  v_mfma_f32_16x16x32_bf16 v[168:171], v[148:151], a[84:87], v[168:171]
  buffer_load_dwordx4 a[36:39], v1, s[8:11], s23 offen offset:1024
  v_mfma_f32_16x16x32_bf16 v[172:175], v[156:159], a[84:87], v[172:175]
  ds_read_b64_tr_b16 v[108:109], v29 offset:36864
  ds_read_b64_tr_b16 v[110:111], v29 offset:38912
  v_mfma_f32_16x16x32_bf16 v[172:175], v[152:155], a[80:83], v[172:175]
  buffer_load_dwordx4 a[40:43], v1, s[8:11], s23 offen offset:2048
  v_mfma_f32_16x16x32_bf16 v[176:179], v[128:131], a[88:91], v[176:179]
  ds_read_b64_tr_b16 v[112:113], v30 offset:32768
  ds_read_b64_tr_b16 v[114:115], v30 offset:34816
  v_mfma_f32_16x16x32_bf16 v[176:179], v[132:135], a[92:95], v[176:179]
  buffer_load_dwordx4 a[44:47], v1, s[8:11], s23 offen offset:3072
  v_mfma_f32_16x16x32_bf16 v[180:183], v[140:143], a[92:95], v[180:183]
  ds_read_b64_tr_b16 v[116:117], v30 offset:36864
  ds_read_b64_tr_b16 v[118:119], v30 offset:38912
  v_mfma_f32_16x16x32_bf16 v[180:183], v[136:139], a[88:91], v[180:183]
  s_add_u32 s23, s23, 16384
  s_add_u32 s25, s25, 131072
  v_mfma_f32_16x16x32_bf16 v[184:187], v[144:147], a[88:91], v[184:187]
  ds_read_b64_tr_b16 v[120:121], v31 offset:32768
  ds_read_b64_tr_b16 v[122:123], v31 offset:34816
  v_mfma_f32_16x16x32_bf16 v[184:187], v[148:151], a[92:95], v[184:187]
  ds_read_b64_tr_b16 v[124:125], v31 offset:36864
  ds_read_b64_tr_b16 v[126:127], v31 offset:38912
  v_mfma_f32_16x16x32_bf16 v[188:191], v[156:159], a[92:95], v[188:191]
  v_mfma_f32_16x16x32_bf16 v[188:191], v[152:155], a[88:91], v[188:191]
  s_waitcnt vmcnt(18) lgkmcnt(0)
  s_barrier
  v_mfma_f32_16x16x32_bf16 v[160:163], v[96:99], a[96:99], v[160:163]
  s_add_u32 m0, s42, 49152
  s_nop 0
  buffer_load_dwordx4 v6, s[12:15], s25 offen offset:0 lds
  ds_read_b64_tr_b16 v[128:129], v28 offset:49152
  ds_read_b64_tr_b16 v[130:131], v28 offset:51200
  v_mfma_f32_16x16x32_bf16 v[160:163], v[100:103], a[100:103], v[160:163]
  buffer_load_dwordx4 v7, s[12:15], s25 offen offset:1024 lds
  v_mfma_f32_16x16x32_bf16 v[164:167], v[108:111], a[100:103], v[164:167]
  ds_read_b64_tr_b16 v[132:133], v28 offset:53248
  ds_read_b64_tr_b16 v[134:135], v28 offset:55296
  v_mfma_f32_16x16x32_bf16 v[164:167], v[104:107], a[96:99], v[164:167]
  buffer_load_dwordx4 a[48:51], v1, s[8:11], s23 offen offset:0
  v_mfma_f32_16x16x32_bf16 v[168:171], v[112:115], a[96:99], v[168:171]
  ds_read_b64_tr_b16 v[136:137], v29 offset:49152
  ds_read_b64_tr_b16 v[138:139], v29 offset:51200
  v_mfma_f32_16x16x32_bf16 v[168:171], v[116:119], a[100:103], v[168:171]
  buffer_load_dwordx4 a[52:55], v1, s[8:11], s23 offen offset:1024
  v_mfma_f32_16x16x32_bf16 v[172:175], v[124:127], a[100:103], v[172:175]
  ds_read_b64_tr_b16 v[140:141], v29 offset:53248
  ds_read_b64_tr_b16 v[142:143], v29 offset:55296
  v_mfma_f32_16x16x32_bf16 v[172:175], v[120:123], a[96:99], v[172:175]
  buffer_load_dwordx4 a[56:59], v1, s[8:11], s23 offen offset:2048
  v_mfma_f32_16x16x32_bf16 v[176:179], v[96:99], a[104:107], v[176:179]
  ds_read_b64_tr_b16 v[144:145], v30 offset:49152
  ds_read_b64_tr_b16 v[146:147], v30 offset:51200
  v_mfma_f32_16x16x32_bf16 v[176:179], v[100:103], a[108:111], v[176:179]
  buffer_load_dwordx4 a[60:63], v1, s[8:11], s23 offen offset:3072
  v_mfma_f32_16x16x32_bf16 v[180:183], v[108:111], a[108:111], v[180:183]
  ds_read_b64_tr_b16 v[148:149], v30 offset:53248
  ds_read_b64_tr_b16 v[150:151], v30 offset:55296
  v_mfma_f32_16x16x32_bf16 v[180:183], v[104:107], a[104:107], v[180:183]
  s_add_u32 s23, s23, 16384
  s_add_u32 s25, s25, 131072
  v_mfma_f32_16x16x32_bf16 v[184:187], v[112:115], a[104:107], v[184:187]
  ds_read_b64_tr_b16 v[152:153], v31 offset:49152
  ds_read_b64_tr_b16 v[154:155], v31 offset:51200
  v_mfma_f32_16x16x32_bf16 v[184:187], v[116:119], a[108:111], v[184:187]
  ds_read_b64_tr_b16 v[156:157], v31 offset:53248
  ds_read_b64_tr_b16 v[158:159], v31 offset:55296
  v_mfma_f32_16x16x32_bf16 v[188:191], v[124:127], a[108:111], v[188:191]
  v_mfma_f32_16x16x32_bf16 v[188:191], v[120:123], a[104:107], v[188:191]
  s_waitcnt vmcnt(18) lgkmcnt(0)
  s_barrier
  v_mfma_f32_16x16x32_bf16 v[160:163], v[128:131], a[112:115], v[160:163]
  s_add_u32 m0, s42, 65536
  s_nop 0
  buffer_load_dwordx4 v6, s[12:15], s25 offen offset:0 lds
  ds_read_b64_tr_b16 v[96:97], v24 offset:0
  ds_read_b64_tr_b16 v[98:99], v24 offset:2048
  v_mfma_f32_16x16x32_bf16 v[160:163], v[132:135], a[116:119], v[160:163]
  buffer_load_dwordx4 v7, s[12:15], s25 offen offset:1024 lds
  v_mfma_f32_16x16x32_bf16 v[164:167], v[140:143], a[116:119], v[164:167]
  ds_read_b64_tr_b16 v[100:101], v24 offset:4096
  ds_read_b64_tr_b16 v[102:103], v24 offset:6144
  v_mfma_f32_16x16x32_bf16 v[164:167], v[136:139], a[112:115], v[164:167]
  buffer_load_dwordx4 a[64:67], v1, s[8:11], s23 offen offset:0
  v_mfma_f32_16x16x32_bf16 v[168:171], v[144:147], a[112:115], v[168:171]
  ds_read_b64_tr_b16 v[104:105], v25 offset:0
  ds_read_b64_tr_b16 v[106:107], v25 offset:2048
  v_mfma_f32_16x16x32_bf16 v[168:171], v[148:151], a[116:119], v[168:171]
  buffer_load_dwordx4 a[68:71], v1, s[8:11], s23 offen offset:1024
  v_mfma_f32_16x16x32_bf16 v[172:175], v[156:159], a[116:119], v[172:175]
  ds_read_b64_tr_b16 v[108:109], v25 offset:4096
  ds_read_b64_tr_b16 v[110:111], v25 offset:6144
  v_mfma_f32_16x16x32_bf16 v[172:175], v[152:155], a[112:115], v[172:175]
  buffer_load_dwordx4 a[72:75], v1, s[8:11], s23 offen offset:2048
  v_mfma_f32_16x16x32_bf16 v[176:179], v[128:131], a[120:123], v[176:179]
  ds_read_b64_tr_b16 v[112:113], v26 offset:0
  ds_read_b64_tr_b16 v[114:115], v26 offset:2048
  v_mfma_f32_16x16x32_bf16 v[176:179], v[132:135], a[124:127], v[176:179]
  buffer_load_dwordx4 a[76:79], v1, s[8:11], s23 offen offset:3072
  v_mfma_f32_16x16x32_bf16 v[180:183], v[140:143], a[124:127], v[180:183]
  ds_read_b64_tr_b16 v[116:117], v26 offset:4096
  ds_read_b64_tr_b16 v[118:119], v26 offset:6144
  v_mfma_f32_16x16x32_bf16 v[180:183], v[136:139], a[120:123], v[180:183]
  s_add_u32 s23, s23, 16384
  s_add_u32 s25, s25, 131072
  v_mfma_f32_16x16x32_bf16 v[184:187], v[144:147], a[120:123], v[184:187]
  ds_read_b64_tr_b16 v[120:121], v27 offset:0
  ds_read_b64_tr_b16 v[122:123], v27 offset:2048
  v_mfma_f32_16x16x32_bf16 v[184:187], v[148:151], a[124:127], v[184:187]
  ds_read_b64_tr_b16 v[124:125], v27 offset:4096
  ds_read_b64_tr_b16 v[126:127], v27 offset:6144
  v_mfma_f32_16x16x32_bf16 v[188:191], v[156:159], a[124:127], v[188:191]
  v_mfma_f32_16x16x32_bf16 v[188:191], v[152:155], a[120:123], v[188:191]
  s_waitcnt vmcnt(18) lgkmcnt(0)
  s_barrier
  v_mfma_f32_16x16x32_bf16 v[160:163], v[96:99], a[0:3], v[160:163]
  s_add_u32 m0, s42, 81920
  s_nop 0
  buffer_load_dwordx4 v6, s[12:15], s25 offen offset:0 lds
  ds_read_b64_tr_b16 v[128:129], v24 offset:16384
  ds_read_b64_tr_b16 v[130:131], v24 offset:18432
  v_mfma_f32_16x16x32_bf16 v[160:163], v[100:103], a[4:7], v[160:163]
  buffer_load_dwordx4 v7, s[12:15], s25 offen offset:1024 lds
  v_mfma_f32_16x16x32_bf16 v[164:167], v[108:111], a[4:7], v[164:167]
  ds_read_b64_tr_b16 v[132:133], v24 offset:20480
  ds_read_b64_tr_b16 v[134:135], v24 offset:22528
  v_mfma_f32_16x16x32_bf16 v[164:167], v[104:107], a[0:3], v[164:167]
  buffer_load_dwordx4 a[80:83], v1, s[8:11], s23 offen offset:0
  v_mfma_f32_16x16x32_bf16 v[168:171], v[112:115], a[0:3], v[168:171]
  ds_read_b64_tr_b16 v[136:137], v25 offset:16384
  ds_read_b64_tr_b16 v[138:139], v25 offset:18432
  v_mfma_f32_16x16x32_bf16 v[168:171], v[116:119], a[4:7], v[168:171]
  buffer_load_dwordx4 a[84:87], v1, s[8:11], s23 offen offset:1024
  v_mfma_f32_16x16x32_bf16 v[172:175], v[124:127], a[4:7], v[172:175]
  ds_read_b64_tr_b16 v[140:141], v25 offset:20480
  ds_read_b64_tr_b16 v[142:143], v25 offset:22528
  v_mfma_f32_16x16x32_bf16 v[172:175], v[120:123], a[0:3], v[172:175]
  buffer_load_dwordx4 a[88:91], v1, s[8:11], s23 offen offset:2048
  v_mfma_f32_16x16x32_bf16 v[176:179], v[96:99], a[8:11], v[176:179]
  ds_read_b64_tr_b16 v[144:145], v26 offset:16384
  ds_read_b64_tr_b16 v[146:147], v26 offset:18432
  v_mfma_f32_16x16x32_bf16 v[176:179], v[100:103], a[12:15], v[176:179]
  buffer_load_dwordx4 a[92:95], v1, s[8:11], s23 offen offset:3072
  v_mfma_f32_16x16x32_bf16 v[180:183], v[108:111], a[12:15], v[180:183]
  ds_read_b64_tr_b16 v[148:149], v26 offset:20480
  ds_read_b64_tr_b16 v[150:151], v26 offset:22528
  v_mfma_f32_16x16x32_bf16 v[180:183], v[104:107], a[8:11], v[180:183]
  s_add_u32 s23, s23, 16384
  s_add_u32 s25, s25, 131072
  v_mfma_f32_16x16x32_bf16 v[184:187], v[112:115], a[8:11], v[184:187]
  ds_read_b64_tr_b16 v[152:153], v27 offset:16384
  ds_read_b64_tr_b16 v[154:155], v27 offset:18432
  v_mfma_f32_16x16x32_bf16 v[184:187], v[116:119], a[12:15], v[184:187]
  ds_read_b64_tr_b16 v[156:157], v27 offset:20480
  ds_read_b64_tr_b16 v[158:159], v27 offset:22528
  v_mfma_f32_16x16x32_bf16 v[188:191], v[124:127], a[12:15], v[188:191]
  v_mfma_f32_16x16x32_bf16 v[188:191], v[120:123], a[8:11], v[188:191]
  s_waitcnt vmcnt(18) lgkmcnt(0)
  s_barrier
  v_mfma_f32_16x16x32_bf16 v[160:163], v[128:131], a[16:19], v[160:163]
  s_add_u32 m0, s42, 98304
  s_nop 0
  buffer_load_dwordx4 v6, s[12:15], s25 offen offset:0 lds
  ds_read_b64_tr_b16 v[96:97], v24 offset:32768
  ds_read_b64_tr_b16 v[98:99], v24 offset:34816
  v_mfma_f32_16x16x32_bf16 v[160:163], v[132:135], a[20:23], v[160:163]
  buffer_load_dwordx4 v7, s[12:15], s25 offen offset:1024 lds
  v_mfma_f32_16x16x32_bf16 v[164:167], v[140:143], a[20:23], v[164:167]
  ds_read_b64_tr_b16 v[100:101], v24 offset:36864
  ds_read_b64_tr_b16 v[102:103], v24 offset:38912
  v_mfma_f32_16x16x32_bf16 v[164:167], v[136:139], a[16:19], v[164:167]
  buffer_load_dwordx4 a[96:99], v1, s[8:11], s23 offen offset:0
  v_mfma_f32_16x16x32_bf16 v[168:171], v[144:147], a[16:19], v[168:171]
  ds_read_b64_tr_b16 v[104:105], v25 offset:32768
  ds_read_b64_tr_b16 v[106:107], v25 offset:34816
  v_mfma_f32_16x16x32_bf16 v[168:171], v[148:151], a[20:23], v[168:171]
  buffer_load_dwordx4 a[100:103], v1, s[8:11], s23 offen offset:1024
  v_mfma_f32_16x16x32_bf16 v[172:175], v[156:159], a[20:23], v[172:175]
  ds_read_b64_tr_b16 v[108:109], v25 offset:36864
  ds_read_b64_tr_b16 v[110:111], v25 offset:38912
  v_mfma_f32_16x16x32_bf16 v[172:175], v[152:155], a[16:19], v[172:175]
  buffer_load_dwordx4 a[104:107], v1, s[8:11], s23 offen offset:2048
  ds_read_b64_tr_b16 v[112:113], v26 offset:32768
  ds_read_b64_tr_b16 v[114:115], v26 offset:34816
  v_mfma_f32_16x16x32_bf16 v[176:179], v[128:131], a[24:27], v[176:179]
  buffer_load_dwordx4 a[108:111], v1, s[8:11], s23 offen offset:3072
  v_mfma_f32_16x16x32_bf16 v[176:179], v[132:135], a[28:31], v[176:179]
  ds_read_b64_tr_b16 v[116:117], v26 offset:36864
  ds_read_b64_tr_b16 v[118:119], v26 offset:38912
  v_mfma_f32_16x16x32_bf16 v[180:183], v[140:143], a[28:31], v[180:183]
  s_add_u32 s23, s23, 16384
  s_add_u32 s25, s25, 131072
  v_mfma_f32_16x16x32_bf16 v[180:183], v[136:139], a[24:27], v[180:183]
  ds_read_b64_tr_b16 v[120:121], v27 offset:32768
  ds_read_b64_tr_b16 v[122:123], v27 offset:34816
  v_mfma_f32_16x16x32_bf16 v[184:187], v[144:147], a[24:27], v[184:187]
  v_mov_b32 v11, 0
  buffer_load_dword v8, v11, s[52:55], s59 offen sc1
  v_mfma_f32_16x16x32_bf16 v[184:187], v[148:151], a[28:31], v[184:187]
  ds_read_b64_tr_b16 v[124:125], v27 offset:36864
  ds_read_b64_tr_b16 v[126:127], v27 offset:38912
  v_mfma_f32_16x16x32_bf16 v[188:191], v[156:159], a[28:31], v[188:191]
  v_mfma_f32_16x16x32_bf16 v[188:191], v[152:155], a[24:27], v[188:191]
  s_waitcnt vmcnt(19) lgkmcnt(0)
  s_barrier
  v_mfma_f32_16x16x32_bf16 v[160:163], v[96:99], a[32:35], v[160:163]
  s_add_u32 m0, s42, 114688
  s_nop 0
  buffer_load_dwordx4 v6, s[12:15], s25 offen offset:0 lds
  ds_read_b64_tr_b16 v[128:129], v24 offset:49152
  ds_read_b64_tr_b16 v[130:131], v24 offset:51200
  v_mfma_f32_16x16x32_bf16 v[160:163], v[100:103], a[36:39], v[160:163]
  buffer_load_dwordx4 v7, s[12:15], s25 offen offset:1024 lds
  v_mfma_f32_16x16x32_bf16 v[164:167], v[108:111], a[36:39], v[164:167]
  ds_read_b64_tr_b16 v[132:133], v24 offset:53248
  ds_read_b64_tr_b16 v[134:135], v24 offset:55296
  v_mfma_f32_16x16x32_bf16 v[164:167], v[104:107], a[32:35], v[164:167]
  buffer_load_dwordx4 a[112:115], v1, s[8:11], s23 offen offset:0
  v_mfma_f32_16x16x32_bf16 v[168:171], v[112:115], a[32:35], v[168:171]
  ds_read_b64_tr_b16 v[136:137], v25 offset:49152
  ds_read_b64_tr_b16 v[138:139], v25 offset:51200
  v_mfma_f32_16x16x32_bf16 v[168:171], v[116:119], a[36:39], v[168:171]
  buffer_load_dwordx4 a[116:119], v1, s[8:11], s23 offen offset:1024
  v_mfma_f32_16x16x32_bf16 v[172:175], v[124:127], a[36:39], v[172:175]
  ds_read_b64_tr_b16 v[140:141], v25 offset:53248
  ds_read_b64_tr_b16 v[142:143], v25 offset:55296
  v_mfma_f32_16x16x32_bf16 v[172:175], v[120:123], a[32:35], v[172:175]
  buffer_load_dwordx4 a[120:123], v1, s[8:11], s23 offen offset:2048
  v_mfma_f32_16x16x32_bf16 v[176:179], v[96:99], a[40:43], v[176:179]
  ds_read_b64_tr_b16 v[144:145], v26 offset:49152
  ds_read_b64_tr_b16 v[146:147], v26 offset:51200
  v_mfma_f32_16x16x32_bf16 v[176:179], v[100:103], a[44:47], v[176:179]
  buffer_load_dwordx4 a[124:127], v1, s[8:11], s23 offen offset:3072
  v_mfma_f32_16x16x32_bf16 v[180:183], v[108:111], a[44:47], v[180:183]
  ds_read_b64_tr_b16 v[148:149], v26 offset:53248
  ds_read_b64_tr_b16 v[150:151], v26 offset:55296
  v_mfma_f32_16x16x32_bf16 v[180:183], v[104:107], a[40:43], v[180:183]
  s_add_u32 s23, s23, 16384
  s_add_u32 s25, s25, 131072
  v_mfma_f32_16x16x32_bf16 v[184:187], v[112:115], a[40:43], v[184:187]
  ds_read_b64_tr_b16 v[152:153], v27 offset:49152
  ds_read_b64_tr_b16 v[154:155], v27 offset:51200
  v_mfma_f32_16x16x32_bf16 v[184:187], v[116:119], a[44:47], v[184:187]
  ds_read_b64_tr_b16 v[156:157], v27 offset:53248
  ds_read_b64_tr_b16 v[158:159], v27 offset:55296
  v_mfma_f32_16x16x32_bf16 v[188:191], v[124:127], a[44:47], v[188:191]
  v_mfma_f32_16x16x32_bf16 v[188:191], v[120:123], a[40:43], v[188:191]
  s_waitcnt vmcnt(19) lgkmcnt(0)
  s_barrier
  s_waitcnt vmcnt(6)
  v_readfirstlane_b32 s3, v8
  s_nop 0
  s_cmp_eq_u32 s3, 1
  s_cbranch_scc0 Lk3_spin
Lk3_got:
  v_mfma_f32_16x16x32_bf16 v[160:163], v[128:131], a[48:51], v[160:163]
  s_add_u32 s60, s57, 0
  buffer_load_dwordx4 v[224:227], v1, s[52:55], s60 offen offset:0 sc1
  v_mfma_f32_16x16x32_bf16 v[160:163], v[132:135], a[52:55], v[160:163]
  ds_read_b64_tr_b16 v[96:97], v28 offset:0
  ds_read_b64_tr_b16 v[98:99], v28 offset:2048
  v_mfma_f32_16x16x32_bf16 v[164:167], v[140:143], a[52:55], v[164:167]
  buffer_load_dwordx4 v[228:231], v1, s[52:55], s60 offen offset:1024 sc1
  v_mfma_f32_16x16x32_bf16 v[164:167], v[136:139], a[48:51], v[164:167]
  ds_read_b64_tr_b16 v[100:101], v28 offset:4096
  ds_read_b64_tr_b16 v[102:103], v28 offset:6144
  v_mfma_f32_16x16x32_bf16 v[168:171], v[144:147], a[48:51], v[168:171]
  buffer_load_dwordx4 v[232:235], v1, s[52:55], s60 offen offset:2048 sc1
  v_mfma_f32_16x16x32_bf16 v[168:171], v[148:151], a[52:55], v[168:171]
  ds_read_b64_tr_b16 v[104:105], v29 offset:0
  ds_read_b64_tr_b16 v[106:107], v29 offset:2048
  v_mfma_f32_16x16x32_bf16 v[172:175], v[156:159], a[52:55], v[172:175]
  v_mfma_f32_16x16x32_bf16 v[172:175], v[152:155], a[48:51], v[172:175]
  buffer_load_dwordx4 v[236:239], v1, s[52:55], s60 offen offset:3072 sc1
  v_mfma_f32_16x16x32_bf16 v[176:179], v[128:131], a[56:59], v[176:179]
  ds_read_b64_tr_b16 v[108:109], v29 offset:4096
  ds_read_b64_tr_b16 v[110:111], v29 offset:6144
  v_mfma_f32_16x16x32_bf16 v[176:179], v[132:135], a[60:63], v[176:179]
  ds_read_b64_tr_b16 v[112:113], v30 offset:0
  ds_read_b64_tr_b16 v[114:115], v30 offset:2048
  v_mfma_f32_16x16x32_bf16 v[180:183], v[140:143], a[60:63], v[180:183]
  ds_read_b64_tr_b16 v[116:117], v30 offset:4096
  ds_read_b64_tr_b16 v[118:119], v30 offset:6144
  v_mfma_f32_16x16x32_bf16 v[180:183], v[136:139], a[56:59], v[180:183]
  ds_read_b64_tr_b16 v[120:121], v31 offset:0
  ds_read_b64_tr_b16 v[122:123], v31 offset:2048
  v_mfma_f32_16x16x32_bf16 v[184:187], v[144:147], a[56:59], v[184:187]
  ds_read_b64_tr_b16 v[124:125], v31 offset:4096
  ds_read_b64_tr_b16 v[126:127], v31 offset:6144
  v_mfma_f32_16x16x32_bf16 v[184:187], v[148:151], a[60:63], v[184:187]
  v_mfma_f32_16x16x32_bf16 v[188:191], v[156:159], a[60:63], v[188:191]
  v_mfma_f32_16x16x32_bf16 v[188:191], v[152:155], a[56:59], v[188:191]
  s_waitcnt vmcnt(17) lgkmcnt(0)
  s_barrier
  v_mfma_f32_16x16x32_bf16 v[160:163], v[96:99], a[64:67], v[160:163]
  s_add_u32 s60, s57, 4096
  buffer_load_dwordx4 v[240:243], v1, s[52:55], s60 offen offset:0 sc1
  v_mfma_f32_16x16x32_bf16 v[160:163], v[100:103], a[68:71], v[160:163]
  ds_read_b64_tr_b16 v[128:129], v28 offset:16384
  ds_read_b64_tr_b16 v[130:131], v28 offset:18432
  v_mfma_f32_16x16x32_bf16 v[164:167], v[108:111], a[68:71], v[164:167]
  buffer_load_dwordx4 v[244:247], v1, s[52:55], s60 offen offset:1024 sc1
  v_mfma_f32_16x16x32_bf16 v[164:167], v[104:107], a[64:67], v[164:167]
  ds_read_b64_tr_b16 v[132:133], v28 offset:20480
  ds_read_b64_tr_b16 v[134:135], v28 offset:22528
  v_mfma_f32_16x16x32_bf16 v[168:171], v[112:115], a[64:67], v[168:171]
  buffer_load_dwordx4 v[248:251], v1, s[52:55], s60 offen offset:2048 sc1
  v_mfma_f32_16x16x32_bf16 v[168:171], v[116:119], a[68:71], v[168:171]
  ds_read_b64_tr_b16 v[136:137], v29 offset:16384
  ds_read_b64_tr_b16 v[138:139], v29 offset:18432
  v_mfma_f32_16x16x32_bf16 v[172:175], v[124:127], a[68:71], v[172:175]
  v_mfma_f32_16x16x32_bf16 v[172:175], v[120:123], a[64:67], v[172:175]
  buffer_load_dwordx4 v[252:255], v1, s[52:55], s60 offen offset:3072 sc1
  v_mfma_f32_16x16x32_bf16 v[176:179], v[96:99], a[72:75], v[176:179]
  ds_read_b64_tr_b16 v[140:141], v29 offset:20480
  ds_read_b64_tr_b16 v[142:143], v29 offset:22528
  v_mfma_f32_16x16x32_bf16 v[176:179], v[100:103], a[76:79], v[176:179]
  ds_read_b64_tr_b16 v[144:145], v30 offset:16384
  ds_read_b64_tr_b16 v[146:147], v30 offset:18432
  v_mfma_f32_16x16x32_bf16 v[180:183], v[108:111], a[76:79], v[180:183]
  ds_read_b64_tr_b16 v[148:149], v30 offset:20480
  ds_read_b64_tr_b16 v[150:151], v30 offset:22528
  v_mfma_f32_16x16x32_bf16 v[180:183], v[104:107], a[72:75], v[180:183]
  ds_read_b64_tr_b16 v[152:153], v31 offset:16384
  ds_read_b64_tr_b16 v[154:155], v31 offset:18432
  v_mfma_f32_16x16x32_bf16 v[184:187], v[112:115], a[72:75], v[184:187]
  ds_read_b64_tr_b16 v[156:157], v31 offset:20480
  ds_read_b64_tr_b16 v[158:159], v31 offset:22528
  v_mfma_f32_16x16x32_bf16 v[184:187], v[116:119], a[76:79], v[184:187]
  v_mfma_f32_16x16x32_bf16 v[188:191], v[124:127], a[76:79], v[188:191]
  v_mfma_f32_16x16x32_bf16 v[188:191], v[120:123], a[72:75], v[188:191]
  s_waitcnt vmcnt(15) lgkmcnt(0)
  s_barrier
  v_mfma_f32_16x16x32_bf16 v[160:163], v[128:131], a[80:83], v[160:163]
  ds_read_b64_tr_b16 v[96:97], v28 offset:32768
  ds_read_b64_tr_b16 v[98:99], v28 offset:34816
  v_mfma_f32_16x16x32_bf16 v[160:163], v[132:135], a[84:87], v[160:163]
  ds_read_b64_tr_b16 v[100:101], v28 offset:36864
  ds_read_b64_tr_b16 v[102:103], v28 offset:38912
  v_mfma_f32_16x16x32_bf16 v[164:167], v[140:143], a[84:87], v[164:167]
  v_mfma_f32_16x16x32_bf16 v[164:167], v[136:139], a[80:83], v[164:167]
  ds_read_b64_tr_b16 v[104:105], v29 offset:32768
  ds_read_b64_tr_b16 v[106:107], v29 offset:34816
  v_mfma_f32_16x16x32_bf16 v[168:171], v[144:147], a[80:83], v[168:171]
  v_mfma_f32_16x16x32_bf16 v[168:171], v[148:151], a[84:87], v[168:171]
  ds_read_b64_tr_b16 v[108:109], v29 offset:36864
  ds_read_b64_tr_b16 v[110:111], v29 offset:38912
  v_mfma_f32_16x16x32_bf16 v[172:175], v[156:159], a[84:87], v[172:175]
  v_mfma_f32_16x16x32_bf16 v[172:175], v[152:155], a[80:83], v[172:175]
  ds_read_b64_tr_b16 v[112:113], v30 offset:32768
  ds_read_b64_tr_b16 v[114:115], v30 offset:34816
  v_mfma_f32_16x16x32_bf16 v[176:179], v[128:131], a[88:91], v[176:179]
  ds_read_b64_tr_b16 v[116:117], v30 offset:36864
  ds_read_b64_tr_b16 v[118:119], v30 offset:38912
  v_mfma_f32_16x16x32_bf16 v[176:179], v[132:135], a[92:95], v[176:179]
  v_mfma_f32_16x16x32_bf16 v[180:183], v[140:143], a[92:95], v[180:183]
  ds_read_b64_tr_b16 v[120:121], v31 offset:32768
  ds_read_b64_tr_b16 v[122:123], v31 offset:34816
  v_mfma_f32_16x16x32_bf16 v[180:183], v[136:139], a[88:91], v[180:183]
  v_mfma_f32_16x16x32_bf16 v[184:187], v[144:147], a[88:91], v[184:187]
  ds_read_b64_tr_b16 v[124:125], v31 offset:36864
  ds_read_b64_tr_b16 v[126:127], v31 offset:38912
  v_mfma_f32_16x16x32_bf16 v[184:187], v[148:151], a[92:95], v[184:187]
  v_mfma_f32_16x16x32_bf16 v[188:191], v[156:159], a[92:95], v[188:191]
  v_mfma_f32_16x16x32_bf16 v[188:191], v[152:155], a[88:91], v[188:191]
  s_waitcnt vmcnt(8) lgkmcnt(0)
  s_barrier
  v_mfma_f32_16x16x32_bf16 v[160:163], v[96:99], a[96:99], v[160:163]
  ds_read_b64_tr_b16 v[128:129], v28 offset:49152
  ds_read_b64_tr_b16 v[130:131], v28 offset:51200
  v_mfma_f32_16x16x32_bf16 v[160:163], v[100:103], a[100:103], v[160:163]
  ds_read_b64_tr_b16 v[132:133], v28 offset:53248
  ds_read_b64_tr_b16 v[134:135], v28 offset:55296
  v_mfma_f32_16x16x32_bf16 v[164:167], v[108:111], a[100:103], v[164:167]
  v_mfma_f32_16x16x32_bf16 v[164:167], v[104:107], a[96:99], v[164:167]
  ds_read_b64_tr_b16 v[136:137], v29 offset:49152
  ds_read_b64_tr_b16 v[138:139], v29 offset:51200
  v_mfma_f32_16x16x32_bf16 v[168:171], v[112:115], a[96:99], v[168:171]
  v_mfma_f32_16x16x32_bf16 v[168:171], v[116:119], a[100:103], v[168:171]
  ds_read_b64_tr_b16 v[140:141], v29 offset:53248
  ds_read_b64_tr_b16 v[142:143], v29 offset:55296
  v_mfma_f32_16x16x32_bf16 v[172:175], v[124:127], a[100:103], v[172:175]
  v_mfma_f32_16x16x32_bf16 v[172:175], v[120:123], a[96:99], v[172:175]
  ds_read_b64_tr_b16 v[144:145], v30 offset:49152
  ds_read_b64_tr_b16 v[146:147], v30 offset:51200
  v_mfma_f32_16x16x32_bf16 v[176:179], v[96:99], a[104:107], v[176:179]
  ds_read_b64_tr_b16 v[148:149], v30 offset:53248
  ds_read_b64_tr_b16 v[150:151], v30 offset:55296
  v_mfma_f32_16x16x32_bf16 v[176:179], v[100:103], a[108:111], v[176:179]
  v_mfma_f32_16x16x32_bf16 v[180:183], v[108:111], a[108:111], v[180:183]
  ds_read_b64_tr_b16 v[152:153], v31 offset:49152
  ds_read_b64_tr_b16 v[154:155], v31 offset:51200
  v_mfma_f32_16x16x32_bf16 v[180:183], v[104:107], a[104:107], v[180:183]
  v_mfma_f32_16x16x32_bf16 v[184:187], v[112:115], a[104:107], v[184:187]
  ds_read_b64_tr_b16 v[156:157], v31 offset:53248
  ds_read_b64_tr_b16 v[158:159], v31 offset:55296
  v_mfma_f32_16x16x32_bf16 v[184:187], v[116:119], a[108:111], v[184:187]
  v_mfma_f32_16x16x32_bf16 v[188:191], v[124:127], a[108:111], v[188:191]
  v_mfma_f32_16x16x32_bf16 v[188:191], v[120:123], a[104:107], v[188:191]
  s_waitcnt lgkmcnt(0)
  v_mfma_f32_16x16x32_bf16 v[160:163], v[128:131], a[112:115], v[160:163]
  v_mfma_f32_16x16x32_bf16 v[160:163], v[132:135], a[116:119], v[160:163]
  v_mfma_f32_16x16x32_bf16 v[164:167], v[140:143], a[116:119], v[164:167]
  v_mfma_f32_16x16x32_bf16 v[164:167], v[136:139], a[112:115], v[164:167]
  v_mfma_f32_16x16x32_bf16 v[168:171], v[144:147], a[112:115], v[168:171]
  v_mfma_f32_16x16x32_bf16 v[168:171], v[148:151], a[116:119], v[168:171]
  v_mfma_f32_16x16x32_bf16 v[172:175], v[156:159], a[116:119], v[172:175]
  v_mfma_f32_16x16x32_bf16 v[172:175], v[152:155], a[112:115], v[172:175]
  v_mfma_f32_16x16x32_bf16 v[176:179], v[128:131], a[120:123], v[176:179]
  v_mfma_f32_16x16x32_bf16 v[176:179], v[132:135], a[124:127], v[176:179]
  v_mfma_f32_16x16x32_bf16 v[180:183], v[140:143], a[124:127], v[180:183]
  v_mfma_f32_16x16x32_bf16 v[180:183], v[136:139], a[120:123], v[180:183]
  v_mfma_f32_16x16x32_bf16 v[184:187], v[144:147], a[120:123], v[184:187]
  v_mfma_f32_16x16x32_bf16 v[184:187], v[148:151], a[124:127], v[184:187]
  v_mfma_f32_16x16x32_bf16 v[188:191], v[156:159], a[124:127], v[188:191]
  v_mfma_f32_16x16x32_bf16 v[188:191], v[152:155], a[120:123], v[188:191]
  v_bfe_u32 v96, v0, 4, 1
  v_lshrrev_b32 v97, 5, v0
  v_lshl_or_b32 v96, v96, 1, v97
  v_and_b32 v97, 15, v0
  v_lshlrev_b32 v97, 13, v97
  v_lshl_add_u32 v96, v96, 4, v97
  s_and_b32 s3, s20, 1
  s_lshl_b32 s3, s3, 6
  s_lshr_b32 s4, s20, 1
  s_add_u32 s3, s3, s4
  s_add_u32 s3, s3, s21
  s_lshl_b32 s3, s3, 12
  s_lshl_b32 s4, s22, 1
  s_add_u32 s3, s3, s4
  s_add_u32 s3, s3, 2048
  v_cvt_pk_bf16_f32 v100, v160, v161
  v_cvt_pk_bf16_f32 v101, v162, v163
  v_cvt_pk_bf16_f32 v102, v164, v165
  v_cvt_pk_bf16_f32 v103, v166, v167
  s_nop 0
  v_permlane16_swap_b32 v100, v102
  v_permlane16_swap_b32 v101, v103
  buffer_store_dwordx4 v[100:103], v96, s[16:19], s3 offen offset:0
  v_cvt_pk_bf16_f32 v104, v168, v169
  v_cvt_pk_bf16_f32 v105, v170, v171
  v_cvt_pk_bf16_f32 v106, v172, v173
  v_cvt_pk_bf16_f32 v107, v174, v175
  s_nop 0
  v_permlane16_swap_b32 v104, v106
  v_permlane16_swap_b32 v105, v107
  buffer_store_dwordx4 v[104:107], v96, s[16:19], s3 offen offset:64
  s_add_u32 s3, s3, 131072
  v_cvt_pk_bf16_f32 v100, v176, v177
  v_cvt_pk_bf16_f32 v101, v178, v179
  v_cvt_pk_bf16_f32 v102, v180, v181
  v_cvt_pk_bf16_f32 v103, v182, v183
  s_nop 0
  v_permlane16_swap_b32 v100, v102
  v_permlane16_swap_b32 v101, v103
  buffer_store_dwordx4 v[100:103], v96, s[16:19], s3 offen offset:0
  v_cvt_pk_bf16_f32 v104, v184, v185
  v_cvt_pk_bf16_f32 v105, v186, v187
  v_cvt_pk_bf16_f32 v106, v188, v189
  v_cvt_pk_bf16_f32 v107, v190, v191
  s_nop 0
  v_permlane16_swap_b32 v104, v106
  v_permlane16_swap_b32 v105, v107
  buffer_store_dwordx4 v[104:107], v96, s[16:19], s3 offen offset:64
  v_bfe_u32 v112, v0, 4, 1
  v_lshrrev_b32 v113, 5, v0
  v_lshl_or_b32 v112, v112, 1, v113
  v_and_b32 v113, 15, v0
  v_lshlrev_b32 v113, 12, v113
  v_lshl_add_u32 v112, v112, 4, v113
  s_lshl_b32 s3, s20, 5
  s_add_u32 s3, s3, s29
  s_lshl_b32 s3, s3, 12
  s_lshl_b32 s4, s30, 1
  s_add_u32 s3, s3, s4
  s_waitcnt vmcnt(4)
  v_pk_add_f32 v[32:33], v[32:33], v[224:225]
  v_pk_add_f32 v[34:35], v[34:35], v[226:227]
  v_pk_add_f32 v[36:37], v[36:37], v[228:229]
  v_pk_add_f32 v[38:39], v[38:39], v[230:231]
  v_cvt_pk_bf16_f32 v116, v32, v33
  v_cvt_pk_bf16_f32 v117, v34, v35
  v_cvt_pk_bf16_f32 v118, v36, v37
  v_cvt_pk_bf16_f32 v119, v38, v39
  s_nop 0
  v_permlane16_swap_b32 v116, v118
  v_permlane16_swap_b32 v117, v119
  buffer_store_dwordx4 v[116:119], v112, s[16:19], s3 offen offset:0
  v_pk_add_f32 v[40:41], v[40:41], v[232:233]
  v_pk_add_f32 v[42:43], v[42:43], v[234:235]
  v_pk_add_f32 v[44:45], v[44:45], v[236:237]
  v_pk_add_f32 v[46:47], v[46:47], v[238:239]
  v_cvt_pk_bf16_f32 v120, v40, v41
  v_cvt_pk_bf16_f32 v121, v42, v43
  v_cvt_pk_bf16_f32 v122, v44, v45
  v_cvt_pk_bf16_f32 v123, v46, v47
  s_nop 0
  v_permlane16_swap_b32 v120, v122
  v_permlane16_swap_b32 v121, v123
  buffer_store_dwordx4 v[120:123], v112, s[16:19], s3 offen offset:64
  s_add_u32 s3, s3, 65536
  v_pk_add_f32 v[64:65], v[64:65], v[240:241]
  v_pk_add_f32 v[66:67], v[66:67], v[242:243]
  v_pk_add_f32 v[68:69], v[68:69], v[244:245]
  v_pk_add_f32 v[70:71], v[70:71], v[246:247]
  v_cvt_pk_bf16_f32 v116, v64, v65
  v_cvt_pk_bf16_f32 v117, v66, v67
  v_cvt_pk_bf16_f32 v118, v68, v69
  v_cvt_pk_bf16_f32 v119, v70, v71
  s_nop 0
  v_permlane16_swap_b32 v116, v118
  v_permlane16_swap_b32 v117, v119
  buffer_store_dwordx4 v[116:119], v112, s[16:19], s3 offen offset:0
  v_pk_add_f32 v[72:73], v[72:73], v[248:249]
  v_pk_add_f32 v[74:75], v[74:75], v[250:251]
  v_pk_add_f32 v[76:77], v[76:77], v[252:253]
  v_pk_add_f32 v[78:79], v[78:79], v[254:255]
  v_cvt_pk_bf16_f32 v120, v72, v73
  v_cvt_pk_bf16_f32 v121, v74, v75
  v_cvt_pk_bf16_f32 v122, v76, v77
  v_cvt_pk_bf16_f32 v123, v78, v79
  s_nop 0
  v_permlane16_swap_b32 v120, v122
  v_permlane16_swap_b32 v121, v123
  buffer_store_dwordx4 v[120:123], v112, s[16:19], s3 offen offset:64
Lk3_end:
  s_endpgm
Lk3_spin:
  s_add_u32 s61, s61, 1
  s_cmp_gt_u32 s61, 0x400000
  s_cbranch_scc1 Lk3_got
  s_sleep 4
  buffer_load_dword v8, v11, s[52:55], s59 offen sc1
  s_waitcnt vmcnt(0)
  v_readfirstlane_b32 s3, v8
  s_nop 0
  s_cmp_eq_u32 s3, 1
  s_cbranch_scc0 Lk3_spin
  s_branch Lk3_got
.section .rodata,"a"
.p2align 6
.amdhsa_kernel k1_proj_kernel
  .amdhsa_next_free_vgpr 512
  .amdhsa_next_free_sgpr 102
  .amdhsa_accum_offset 256
  .amdhsa_group_segment_fixed_size 0
  .amdhsa_kernarg_size 96
  .amdhsa_user_sgpr_count 2
  .amdhsa_user_sgpr_kernarg_segment_ptr 1
  .amdhsa_system_sgpr_workgroup_id_x 1
.end_amdhsa_kernel
.p2align 6
.amdhsa_kernel k2_attn_kernel
  .amdhsa_next_free_vgpr 500
  .amdhsa_next_free_sgpr 102
  .amdhsa_accum_offset 256
  .amdhsa_group_segment_fixed_size 0
  .amdhsa_kernarg_size 96
  .amdhsa_user_sgpr_count 2
  .amdhsa_user_sgpr_kernarg_segment_ptr 1
  .amdhsa_system_sgpr_workgroup_id_x 1
.end_amdhsa_kernel
.p2align 6
.amdhsa_kernel k3_oproj_kernel
  .amdhsa_next_free_vgpr 384
  .amdhsa_next_free_sgpr 102
  .amdhsa_accum_offset 256
  .amdhsa_group_segment_fixed_size 0
  .amdhsa_kernarg_size 96
  .amdhsa_user_sgpr_count 2
  .amdhsa_user_sgpr_kernarg_segment_ptr 1
  .amdhsa_system_sgpr_workgroup_id_x 1
.end_amdhsa_kernel
```

```asm
; @launch grid=(256,1,1) block=(256,1,1) lds=163840
.amdgcn_target "amdgcn-amd-amdhsa--gfx950"
.text
.macro M d, a, b, c
v_mfma_f32_16x16x32_bf16 \d, \a, \b, \c
.endm
.globl concat_heads__compressed_kv_cla__sliding_local_dilated__prompt_kernel
.p2align 8
.type concat_heads__compressed_kv_cla__sliding_local_dilated__prompt_kernel,@function
concat_heads__compressed_kv_cla__sliding_local_dilated__prompt_kernel:
s_cmp_lt_u32 s2, 256
s_cbranch_scc1 Lk1_go
s_endpgm
Lk1_go:
s_load_dwordx16 s[32:47], s[0:1], 0
s_load_dwordx2 s[48:49], s[0:1], 64
s_load_dwordx2 s[50:51], s[0:1], 88
s_load_dwordx2 s[90:91], s[0:1], 80
v_lshrrev_b32 v24, 6, v0
s_nop 0
v_readfirstlane_b32 s20, v24
v_and_b32 v0, 63, v0
v_lshlrev_b32 v1, 4, v0
s_mov_b32 s101, s20
s_lshr_b32 s21, s20, 1
s_and_b32 s22, s20, 1
s_lshl_b32 s29, s20, 12
s_and_b32 s3, s2, 1
s_lshl_b32 s3, s3, 2
s_bfe_u32 s6, s2, 0x20003
s_add_u32 s3, s3, s6
s_lshl_b32 s52, s3, 8
s_bfe_u32 s3, s2, 0x20001
s_lshl_b32 s3, s3, 2
s_bfe_u32 s7, s2, 0x20005
s_add_u32 s3, s3, s7
s_lshl_b32 s53, s3, 8
s_cmp_lt_u32 s2, 128
s_cselect_b32 s5, 11, 10
s_lshl_b32 s3, s21, 7
s_lshl_b32 s4, s22, 5
s_add_u32 s3, s3, s4
v_lshrrev_b32 v24, 3, v0
v_add_u32 v24, s3, v24
v_and_b32 v25, 7, v0
v_add_u32 v26, 0, v24
v_bfe_u32 v27, v26, 1, 3
v_xor_b32 v27, v27, v25
v_lshlrev_b32 v26, s5, v26
v_lshl_add_u32 v26, v27, 4, v26
v_subrev_u32 v2, 0, v26
v_add_u32 v26, 8, v24
v_bfe_u32 v27, v26, 1, 3
v_xor_b32 v27, v27, v25
v_lshlrev_b32 v26, s5, v26
v_lshl_add_u32 v26, v27, 4, v26
v_subrev_u32 v3, 1024, v26
v_add_u32 v26, 16, v24
v_bfe_u32 v27, v26, 1, 3
v_xor_b32 v27, v27, v25
v_lshlrev_b32 v26, s5, v26
v_lshl_add_u32 v26, v27, 4, v26
v_subrev_u32 v4, 2048, v26
v_add_u32 v26, 24, v24
v_bfe_u32 v27, v26, 1, 3
v_xor_b32 v27, v27, v25
v_lshlrev_b32 v26, s5, v26
v_lshl_add_u32 v26, v27, 4, v26
v_subrev_u32 v5, 3072, v26
s_lshl_b32 s3, s20, 3
v_lshrrev_b32 v24, 5, v0
v_add_u32 v24, s3, v24
v_and_b32 v25, 31, v0
v_add_u32 v26, 0, v24
v_and_b32 v27, 3, v26
v_lshlrev_b32 v27, 1, v27
v_and_or_b32 v27, v26, 8, v27
v_xor_b32 v27, v27, v25
v_lshlrev_b32 v26, 13, v26
v_lshl_add_u32 v26, v27, 4, v26
v_subrev_u32 v6, 0, v26
v_add_u32 v26, 2, v24
v_and_b32 v27, 3, v26
v_lshlrev_b32 v27, 1, v27
v_and_or_b32 v27, v26, 8, v27
v_xor_b32 v27, v27, v25
v_lshlrev_b32 v26, 13, v26
v_lshl_add_u32 v26, v27, 4, v26
v_subrev_u32 v7, 1024, v26
v_add_u32 v26, 4, v24
v_and_b32 v27, 3, v26
v_lshlrev_b32 v27, 1, v27
v_and_or_b32 v27, v26, 8, v27
v_xor_b32 v27, v27, v25
v_lshlrev_b32 v26, 13, v26
v_lshl_add_u32 v26, v27, 4, v26
v_subrev_u32 v8, 2048, v26
v_add_u32 v26, 6, v24
v_and_b32 v27, 3, v26
v_lshlrev_b32 v27, 1, v27
v_and_or_b32 v27, v26, 8, v27
v_xor_b32 v27, v27, v25
v_lshlrev_b32 v26, 13, v26
v_lshl_add_u32 v26, v27, 4, v26
v_subrev_u32 v9, 3072, v26
s_lshl_b32 s23, s52, s5
s_lshl_b32 s31, 64, s5
s_mov_b32 s26, s23
s_lshl_b32 s24, s53, 1
s_mov_b32 s28, s24
s_lshl_b32 s3, 1, s5
s_add_u32 s25, s23, s3
s_lshl_b32 s3, s3, 12
s_add_u32 s27, s24, s3
s_bfe_u32 s3, s2, 0x20001
s_and_b32 s4, s2, 1
s_lshl_b32 s4, s4, 1
s_add_u32 s3, s3, s4
s_and_b32 s3, s3, 3
s_sub_u32 s4, s5, 2
s_lshl_b32 s3, s3, s4
s_add_u32 s23, s23, s3
s_lshl_b32 s3, s3, 12
s_add_u32 s24, s24, s3
s_mov_b32 s95, s6
s_cmp_lt_u32 s2, 128
s_cselect_b32 s6, -1, 8
s_waitcnt lgkmcnt(0)
s_cmp_lt_u32 s2, 128
s_cselect_b64 s[8:9], s[32:33], s[34:35]
s_mov_b32 s10, 2097152
s_cselect_b32 s10, 4194304, s10
s_mov_b32 s11, 0x00020000
s_cselect_b64 s[12:13], s[36:37], s[38:39]
s_mov_b32 s14, 4194304
s_cselect_b32 s14, 8388608, s14
s_mov_b32 s15, 0x00020000
s_mov_b64 s[64:65], s[40:41]
s_add_u32 m0, s29, 65536
s_nop 0
buffer_load_dwordx4 v6, s[12:15], s24 offen offset:0 lds
buffer_load_dwordx4 v7, s[12:15], s24 offen offset:1024 lds
buffer_load_dwordx4 v8, s[12:15], s24 offen offset:2048 lds
buffer_load_dwordx4 v9, s[12:15], s24 offen offset:3072 lds
s_add_u32 s24, s24, 262144
s_add_u32 m0, s29, 0
s_nop 0
buffer_load_dwordx4 v2, s[8:11], s23 offen offset:0 lds
buffer_load_dwordx4 v3, s[8:11], s23 offen offset:1024 lds
buffer_load_dwordx4 v4, s[8:11], s23 offen offset:2048 lds
buffer_load_dwordx4 v5, s[8:11], s23 offen offset:3072 lds
s_add_u32 m0, s29, 81920
s_nop 0
buffer_load_dwordx4 v6, s[12:15], s24 offen offset:0 lds
buffer_load_dwordx4 v7, s[12:15], s24 offen offset:1024 lds
buffer_load_dwordx4 v8, s[12:15], s24 offen offset:2048 lds
buffer_load_dwordx4 v9, s[12:15], s24 offen offset:3072 lds
s_add_u32 s24, s24, 262144
s_cmp_eq_u32 s24, s27
s_cselect_b32 s24, s28, s24
s_sub_u32 s6, s6, 1
s_cmp_eq_u32 s6, 0
s_cselect_b64 s[12:13], s[64:65], s[12:13]
s_add_u32 m0, s29, 98304
s_nop 0
buffer_load_dwordx4 v6, s[12:15], s24 offen offset:0 lds
buffer_load_dwordx4 v7, s[12:15], s24 offen offset:1024 lds
buffer_load_dwordx4 v8, s[12:15], s24 offen offset:2048 lds
buffer_load_dwordx4 v9, s[12:15], s24 offen offset:3072 lds
s_add_u32 s24, s24, 262144
s_add_u32 m0, s29, 16384
s_add_u32 s3, s23, s31
s_nop 0
buffer_load_dwordx4 v2, s[8:11], s3 offen offset:0 lds
buffer_load_dwordx4 v3, s[8:11], s3 offen offset:1024 lds
buffer_load_dwordx4 v4, s[8:11], s3 offen offset:2048 lds
buffer_load_dwordx4 v5, s[8:11], s3 offen offset:3072 lds
s_add_u32 s23, s23, 128
s_cmp_eq_u32 s23, s25
s_cselect_b32 s23, s26, s23
s_add_u32 m0, s29, 114688
s_nop 0
buffer_load_dwordx4 v6, s[12:15], s24 offen offset:0 lds
buffer_load_dwordx4 v7, s[12:15], s24 offen offset:1024 lds
buffer_load_dwordx4 v8, s[12:15], s24 offen offset:2048 lds
buffer_load_dwordx4 v9, s[12:15], s24 offen offset:3072 lds
s_add_u32 s24, s24, 262144
s_cmp_eq_u32 s24, s27
s_cselect_b32 s24, s28, s24
s_sub_u32 s6, s6, 1
s_cmp_eq_u32 s6, 0
s_cselect_b64 s[12:13], s[64:65], s[12:13]
s_add_u32 s16, s50, 109051904
s_addc_u32 s17, s51, 0
s_mov_b32 s18, 16384
s_mov_b32 s19, 0x00020000
v_mov_b32 v24, 0
v_mov_b32 v25, 0
v_mov_b32 v26, 0
v_mov_b32 v27, 0
s_lshl_b32 s3, s2, 2
buffer_store_dword v24, v24, s[16:19], s3 offen sc1
s_and_b32 s3, s2, 7
s_lshr_b32 s4, s2, 6
s_lshl_b32 s4, s4, 3
s_add_u32 s3, s3, s4
s_lshl_b32 s3, s3, 4
s_add_u32 s3, s3, 4096
s_bfe_u32 s4, s2, 0x30003
s_lshl_b32 s4, s4, 9
s_add_u32 s92, s3, s4
s_sub_u32 s4, 7680, s4
s_add_u32 s93, s3, s4
buffer_store_dwordx4 v[24:27], v24, s[16:19], s92 offen sc1
buffer_store_dwordx4 v[24:27], v24, s[16:19], s93 offen sc1
s_and_b32 s3, s2, 1
s_lshl_b32 s3, s3, 3
s_bfe_u32 s4, s2, 0x30003
s_add_u32 s92, s3, s4
s_bfe_u32 s3, s2, 0x20001
s_lshl_b32 s3, s3, 2
s_lshr_b32 s4, s2, 6
s_add_u32 s93, s3, s4
s_lshl_b32 s92, s92, 8
s_lshl_b32 s93, s93, 4
s_add_u32 s92, s92, s93
s_add_u32 s92, s92, 12288
buffer_store_dwordx4 v[24:27], v24, s[16:19], s92 offen sc1
s_mov_b32 s63, 0x00020000
s_cmp_eq_u32 s20, 1
s_cbranch_scc1 Lk1_pfo
s_cmp_eq_u32 s20, 0
s_cbranch_scc0 Lk1_pfw
s_bfe_u32 s4, s2, 0x20001
s_lshl_b32 s3, s7, 2
s_add_u32 s3, s3, s4
s_lshl_b32 s3, s3, 4
v_and_b32 v24, 15, v0
v_add_u32 v24, s3, v24
v_lshlrev_b32 v20, s5, v24
s_mov_b64 s[60:61], s[8:9]
s_mov_b64 s[58:59], s[8:9]
s_mov_b32 s62, s10
s_mov_b32 s7, s10
s_add_u32 s54, s26, 768
s_mov_b32 s55, 128
s_mov_b32 s56, s25
s_mov_b32 s57, s26
s_branch Lk1_pfc
Lk1_pfw:
s_lshl_b32 s3, s95, 4
s_and_b32 s4, s2, 1
s_lshl_b32 s4, s4, 3
s_add_u32 s3, s3, s4
s_lshl_b32 s4, s22, 2
s_add_u32 s3, s3, s4
v_bfe_u32 v24, v0, 2, 2
v_add_u32 v24, s3, v24
v_and_b32 v25, 3, v0
v_lshlrev_b32 v25, 7, v25
v_lshl_add_u32 v20, v24, 13, v25
s_mov_b64 s[60:61], s[12:13]
s_mov_b64 s[58:59], s[40:41]
s_mov_b32 s62, s14
s_mov_b32 s7, s14
s_add_u32 s54, s28, 3670016
s_mov_b32 s55, 524288
s_mov_b32 s56, s27
s_mov_b32 s57, s28
Lk1_pfc:
s_mov_b32 s62, 0
s_mov_b32 s7, 0
v_lshrrev_b32 v24, 4, v0
v_mul_lo_u32 v24, v24, s55
v_add_u32 v24, v24, v20
s_mul_i32 s3, s55, 4
s_sub_u32 s3, s54, s3
buffer_load_dword v21, v24, s[60:63], s3 offen
s_branch Lk1_pfd
Lk1_pfo:
v_lshlrev_b32 v20, 7, v0
s_and_b32 s3, s2, 127
s_lshl_b32 s54, s3, 13
s_mov_b32 s57, s54
s_mov_b32 s55, 1048576
s_cmp_lt_u32 s2, 128
s_cselect_b64 s[60:61], s[46:47], s[42:43]
s_cselect_b64 s[58:59], s[44:45], s[48:49]
s_mov_b32 s4, 8388608
s_cselect_b32 s4, 6291456, s4
s_add_u32 s56, s54, s4
s_mov_b32 s62, s4
s_cmp_lt_u32 s2, 128
s_mov_b32 s7, 2097152
s_cselect_b32 s7, 4194304, s7
s_cselect_b32 s62, s62, 0
s_cselect_b32 s7, s7, 0
buffer_load_dword v21, v20, s[60:63], s54 offen
s_add_u32 s54, s54, s55
s_cmp_eq_u32 s54, s56
s_cselect_b32 s54, s57, s54
s_cselect_b64 s[60:61], s[58:59], s[60:61]
s_cselect_b32 s62, s7, s62
Lk1_pfd:
s_add_u32 m0, s29, 32768
s_nop 0
buffer_load_dwordx4 v2, s[8:11], s23 offen offset:0 lds
buffer_load_dwordx4 v3, s[8:11], s23 offen offset:1024 lds
buffer_load_dwordx4 v4, s[8:11], s23 offen offset:2048 lds
buffer_load_dwordx4 v5, s[8:11], s23 offen offset:3072 lds
s_lshl_b32 s4, s21, 13
v_and_b32 v24, 15, v0
v_lshlrev_b32 v24, 7, v24
v_add_u32 v24, s4, v24
v_bfe_u32 v25, v0, 1, 3
v_lshrrev_b32 v26, 4, v0
v_xor_b32 v25, v25, v26
v_lshl_add_u32 v10, v25, 4, v24
v_xor_b32 v11, 64, v10
v_bfe_u32 v24, v0, 2, 2
v_lshl_add_u32 v29, v26, 3, v24
v_lshlrev_b32 v25, 9, v29
v_and_b32 v27, 1, v0
v_lshl_add_u32 v25, v27, 3, v25
v_add_u32 v25, 65536, v25
v_lshlrev_b32 v24, 1, v24
v_and_or_b32 v24, v29, 8, v24
v_bfe_u32 v26, v0, 1, 1
s_lshl_b32 s4, s22, 4
s_add_u32 s3, s4, 0
v_add_u32 v27, s3, v26
v_xor_b32 v27, v27, v24
v_lshl_add_u32 v12, v27, 4, v25
s_add_u32 s3, s4, 2
v_add_u32 v27, s3, v26
v_xor_b32 v27, v27, v24
v_lshl_add_u32 v13, v27, 4, v25
s_add_u32 s3, s4, 4
v_add_u32 v27, s3, v26
v_xor_b32 v27, v27, v24
v_lshl_add_u32 v14, v27, 4, v25
s_add_u32 s3, s4, 6
v_add_u32 v27, s3, v26
v_xor_b32 v27, v27, v24
v_lshl_add_u32 v15, v27, 4, v25
s_add_u32 s3, s4, 8
v_add_u32 v27, s3, v26
v_xor_b32 v27, v27, v24
v_lshl_add_u32 v16, v27, 4, v25
s_add_u32 s3, s4, 10
v_add_u32 v27, s3, v26
v_xor_b32 v27, v27, v24
v_lshl_add_u32 v17, v27, 4, v25
s_add_u32 s3, s4, 12
v_add_u32 v27, s3, v26
v_xor_b32 v27, v27, v24
v_lshl_add_u32 v18, v27, 4, v25
s_add_u32 s3, s4, 14
v_add_u32 v27, s3, v26
v_xor_b32 v27, v27, v24
v_lshl_add_u32 v19, v27, 4, v25
s_waitcnt vmcnt(21)
s_barrier
ds_read_b64_tr_b16 a[32:33], v12 offset:0
ds_read_b64_tr_b16 a[34:35], v12 offset:2048
ds_read_b64_tr_b16 a[40:41], v13 offset:0
ds_read_b64_tr_b16 a[42:43], v13 offset:2048
ds_read_b64_tr_b16 a[48:49], v14 offset:0
ds_read_b64_tr_b16 a[50:51], v14 offset:2048
ds_read_b64_tr_b16 a[56:57], v15 offset:0
ds_read_b64_tr_b16 a[58:59], v15 offset:2048
ds_read_b64_tr_b16 a[64:65], v16 offset:0
ds_read_b64_tr_b16 a[66:67], v16 offset:2048
ds_read_b64_tr_b16 a[72:73], v17 offset:0
ds_read_b64_tr_b16 a[74:75], v17 offset:2048
ds_read_b64_tr_b16 a[80:81], v18 offset:0
ds_read_b64_tr_b16 a[82:83], v18 offset:2048
ds_read_b64_tr_b16 a[88:89], v19 offset:0
ds_read_b64_tr_b16 a[90:91], v19 offset:2048
ds_read_b64_tr_b16 a[36:37], v12 offset:16384
ds_read_b64_tr_b16 a[38:39], v12 offset:18432
ds_read_b64_tr_b16 a[44:45], v13 offset:16384
ds_read_b64_tr_b16 a[46:47], v13 offset:18432
ds_read_b64_tr_b16 a[52:53], v14 offset:16384
ds_read_b64_tr_b16 a[54:55], v14 offset:18432
ds_read_b64_tr_b16 a[60:61], v15 offset:16384
ds_read_b64_tr_b16 a[62:63], v15 offset:18432
ds_read_b64_tr_b16 a[68:69], v16 offset:16384
ds_read_b64_tr_b16 a[70:71], v16 offset:18432
ds_read_b64_tr_b16 a[76:77], v17 offset:16384
ds_read_b64_tr_b16 a[78:79], v17 offset:18432
ds_read_b64_tr_b16 a[84:85], v18 offset:16384
ds_read_b64_tr_b16 a[86:87], v18 offset:18432
ds_read_b64_tr_b16 a[92:93], v19 offset:16384
ds_read_b64_tr_b16 a[94:95], v19 offset:18432
ds_read_b128 a[160:163], v10 offset:0
ds_read_b128 a[164:167], v11 offset:0
ds_read_b128 a[168:171], v10 offset:2048
ds_read_b128 a[172:175], v11 offset:2048
s_waitcnt vmcnt(17) lgkmcnt(0)
s_barrier
s_add_u32 m0, s29, 65536
s_nop 0
buffer_load_dwordx4 v6, s[12:15], s24 offen offset:0 lds
buffer_load_dwordx4 v7, s[12:15], s24 offen offset:1024 lds
buffer_load_dwordx4 v8, s[12:15], s24 offen offset:2048 lds
buffer_load_dwordx4 v9, s[12:15], s24 offen offset:3072 lds
s_add_u32 s24, s24, 262144
s_add_u32 m0, s29, 49152
s_add_u32 s3, s23, s31
s_nop 0
buffer_load_dwordx4 v2, s[8:11], s3 offen offset:0 lds
buffer_load_dwordx4 v3, s[8:11], s3 offen offset:1024 lds
buffer_load_dwordx4 v4, s[8:11], s3 offen offset:2048 lds
buffer_load_dwordx4 v5, s[8:11], s3 offen offset:3072 lds
s_cmp_lt_u32 s2, 128
s_cbranch_scc0 Lk1_kv
M v[32:35], a[32:35], a[160:163], 0
s_add_u32 s23, s23, 128
s_cmp_eq_u32 s23, s25
s_cselect_b32 s23, s26, s23
M v[32:35], a[36:39], a[164:167], v[32:35]
ds_read_b128 a[176:179], v10 offset:4096
ds_read_b128 a[180:183], v11 offset:4096
M v[36:39], a[44:47], a[164:167], 0
M v[36:39], a[40:43], a[160:163], v[36:39]
ds_read_b64_tr_b16 a[96:97], v12 offset:32768
ds_read_b64_tr_b16 a[98:99], v12 offset:34816
M v[40:43], a[48:51], a[160:163], 0
M v[40:43], a[52:55], a[164:167], v[40:43]
M v[44:47], a[60:63], a[164:167], 0
s_add_u32 m0, s29, 81920
s_nop 0
buffer_load_dwordx4 v6, s[12:15], s24 offen offset:0 lds
M v[44:47], a[56:59], a[160:163], v[44:47]
ds_read_b64_tr_b16 a[104:105], v13 offset:32768
ds_read_b64_tr_b16 a[106:107], v13 offset:34816
M v[48:51], a[64:67], a[160:163], 0
M v[48:51], a[68:71], a[164:167], v[48:51]
M v[52:55], a[76:79], a[164:167], 0
M v[52:55], a[72:75], a[160:163], v[52:55]
ds_read_b64_tr_b16 a[112:113], v14 offset:32768
ds_read_b64_tr_b16 a[114:115], v14 offset:34816
M v[56:59], a[80:83], a[160:163], 0
M v[56:59], a[84:87], a[164:167], v[56:59]
buffer_load_dwordx4 v7, s[12:15], s24 offen offset:1024 lds
M v[60:63], a[92:95], a[164:167], 0
M v[60:63], a[88:91], a[160:163], v[60:63]
ds_read_b64_tr_b16 a[120:121], v15 offset:32768
ds_read_b64_tr_b16 a[122:123], v15 offset:34816
M v[64:67], a[32:35], a[168:171], 0
M v[64:67], a[36:39], a[172:175], v[64:67]
ds_read_b128 a[184:187], v10 offset:6144
ds_read_b128 a[188:191], v11 offset:6144
M v[68:71], a[44:47], a[172:175], 0
M v[68:71], a[40:43], a[168:171], v[68:71]
ds_read_b64_tr_b16 a[128:129], v16 offset:32768
ds_read_b64_tr_b16 a[130:131], v16 offset:34816
M v[72:75], a[48:51], a[168:171], 0
buffer_load_dwordx4 v8, s[12:15], s24 offen offset:2048 lds
M v[72:75], a[52:55], a[172:175], v[72:75]
M v[76:79], a[60:63], a[172:175], 0
M v[76:79], a[56:59], a[168:171], v[76:79]
ds_read_b64_tr_b16 a[136:137], v17 offset:32768
ds_read_b64_tr_b16 a[138:139], v17 offset:34816
M v[80:83], a[64:67], a[168:171], 0
M v[80:83], a[68:71], a[172:175], v[80:83]
M v[84:87], a[76:79], a[172:175], 0
buffer_load_dwordx4 v9, s[12:15], s24 offen offset:3072 lds
M v[84:87], a[72:75], a[168:171], v[84:87]
ds_read_b64_tr_b16 a[144:145], v18 offset:32768
ds_read_b64_tr_b16 a[146:147], v18 offset:34816
M v[88:91], a[80:83], a[168:171], 0
M v[88:91], a[84:87], a[172:175], v[88:91]
M v[92:95], a[92:95], a[172:175], 0
M v[92:95], a[88:91], a[168:171], v[92:95]
s_waitcnt lgkmcnt(15)
ds_read_b64_tr_b16 a[152:153], v19 offset:32768
ds_read_b64_tr_b16 a[154:155], v19 offset:34816
M v[96:99], a[32:35], a[176:179], 0
s_add_u32 s24, s24, 262144
s_cmp_eq_u32 s24, s27
s_cselect_b32 s24, s28, s24
s_sub_u32 s6, s6, 1
s_cmp_eq_u32 s6, 0
s_cselect_b64 s[12:13], s[64:65], s[12:13]
M v[96:99], a[36:39], a[180:183], v[96:99]
M v[100:103], a[44:47], a[180:183], 0
M v[100:103], a[40:43], a[176:179], v[100:103]
M v[104:107], a[48:51], a[176:179], 0
M v[104:107], a[52:55], a[180:183], v[104:107]
M v[108:111], a[60:63], a[180:183], 0
M v[108:111], a[56:59], a[176:179], v[108:111]
s_waitcnt vmcnt(17) lgkmcnt(0)
s_barrier
ds_read_b128 a[160:163], v10 offset:16384
ds_read_b128 a[164:167], v11 offset:16384
M v[112:115], a[64:67], a[176:179], 0
s_add_u32 m0, s29, 0
s_nop 0
buffer_load_dwordx4 v2, s[8:11], s23 offen offset:0 lds
M v[112:115], a[68:71], a[180:183], v[112:115]
M v[116:119], a[76:79], a[180:183], 0
M v[116:119], a[72:75], a[176:179], v[116:119]
ds_read_b64_tr_b16 a[100:101], v12 offset:49152
ds_read_b64_tr_b16 a[102:103], v12 offset:51200
M v[120:123], a[80:83], a[176:179], 0
M v[120:123], a[84:87], a[180:183], v[120:123]
buffer_load_dwordx4 v3, s[8:11], s23 offen offset:1024 lds
M v[124:127], a[92:95], a[180:183], 0
M v[124:127], a[88:91], a[176:179], v[124:127]
M v[128:131], a[32:35], a[184:187], 0
M v[128:131], a[36:39], a[188:191], v[128:131]
ds_read_b128 a[168:171], v10 offset:18432
ds_read_b128 a[172:175], v11 offset:18432
ds_read_b64_tr_b16 a[108:109], v13 offset:49152
ds_read_b64_tr_b16 a[110:111], v13 offset:51200
M v[132:135], a[44:47], a[188:191], 0
M v[132:135], a[40:43], a[184:187], v[132:135]
buffer_load_dwordx4 v4, s[8:11], s23 offen offset:2048 lds
M v[136:139], a[48:51], a[184:187], 0
M v[136:139], a[52:55], a[188:191], v[136:139]
M v[140:143], a[60:63], a[188:191], 0
M v[140:143], a[56:59], a[184:187], v[140:143]
ds_read_b64_tr_b16 a[116:117], v14 offset:49152
ds_read_b64_tr_b16 a[118:119], v14 offset:51200
M v[144:147], a[64:67], a[184:187], 0
M v[144:147], a[68:71], a[188:191], v[144:147]
buffer_load_dwordx4 v5, s[8:11], s23 offen offset:3072 lds
M v[148:151], a[76:79], a[188:191], 0
M v[148:151], a[72:75], a[184:187], v[148:151]
M v[152:155], a[80:83], a[184:187], 0
M v[152:155], a[84:87], a[188:191], v[152:155]
ds_read_b64_tr_b16 a[124:125], v15 offset:49152
ds_read_b64_tr_b16 a[126:127], v15 offset:51200
M v[156:159], a[92:95], a[188:191], 0
s_add_u32 m0, s29, 98304
s_nop 0
buffer_load_dwordx4 v6, s[12:15], s24 offen offset:0 lds
M v[156:159], a[88:91], a[184:187], v[156:159]
s_waitcnt lgkmcnt(10)
M v[160:163], a[32:35], a[160:163], 0
M v[160:163], a[36:39], a[164:167], v[160:163]
ds_read_b128 a[176:179], v10 offset:20480
ds_read_b128 a[180:183], v11 offset:20480
M v[164:167], a[44:47], a[164:167], 0
M v[164:167], a[40:43], a[160:163], v[164:167]
ds_read_b64_tr_b16 a[132:133], v16 offset:49152
ds_read_b64_tr_b16 a[134:135], v16 offset:51200
M v[168:171], a[48:51], a[160:163], 0
M v[168:171], a[52:55], a[164:167], v[168:171]
buffer_load_dwordx4 v7, s[12:15], s24 offen offset:1024 lds
M v[172:175], a[60:63], a[164:167], 0
M v[172:175], a[56:59], a[160:163], v[172:175]
M v[176:179], a[64:67], a[160:163], 0
M v[176:179], a[68:71], a[164:167], v[176:179]
ds_read_b64_tr_b16 a[140:141], v17 offset:49152
ds_read_b64_tr_b16 a[142:143], v17 offset:51200
M v[180:183], a[76:79], a[164:167], 0
M v[180:183], a[72:75], a[160:163], v[180:183]
buffer_load_dwordx4 v8, s[12:15], s24 offen offset:2048 lds
M v[184:187], a[80:83], a[160:163], 0
M v[184:187], a[84:87], a[164:167], v[184:187]
M v[188:191], a[92:95], a[164:167], 0
M v[188:191], a[88:91], a[160:163], v[188:191]
s_waitcnt lgkmcnt(12)
ds_read_b64_tr_b16 a[148:149], v18 offset:49152
ds_read_b64_tr_b16 a[150:151], v18 offset:51200
M v[192:195], a[32:35], a[168:171], 0
buffer_load_dwordx4 v9, s[12:15], s24 offen offset:3072 lds
M v[192:195], a[36:39], a[172:175], v[192:195]
ds_read_b128 a[184:187], v10 offset:22528
ds_read_b128 a[188:191], v11 offset:22528
M v[196:199], a[44:47], a[172:175], 0
M v[196:199], a[40:43], a[168:171], v[196:199]
M v[200:203], a[48:51], a[168:171], 0
M v[200:203], a[52:55], a[172:175], v[200:203]
ds_read_b64_tr_b16 a[156:157], v19 offset:49152
ds_read_b64_tr_b16 a[158:159], v19 offset:51200
M v[204:207], a[60:63], a[172:175], 0
s_add_u32 s24, s24, 262144
M v[204:207], a[56:59], a[168:171], v[204:207]
M v[208:211], a[64:67], a[168:171], 0
M v[208:211], a[68:71], a[172:175], v[208:211]
M v[212:215], a[76:79], a[172:175], 0
M v[212:215], a[72:75], a[168:171], v[212:215]
buffer_load_dword v21, v20, s[60:63], s54 offen
s_add_u32 s54, s54, s55
M v[216:219], a[80:83], a[168:171], 0
M v[216:219], a[84:87], a[172:175], v[216:219]
M v[220:223], a[92:95], a[172:175], 0
M v[220:223], a[88:91], a[168:171], v[220:223]
s_waitcnt lgkmcnt(10)
M v[224:227], a[32:35], a[176:179], 0
s_cmp_eq_u32 s54, s56
s_cselect_b32 s54, s57, s54
s_cselect_b64 s[60:61], s[58:59], s[60:61]
s_cselect_b32 s62, s7, s62
M v[224:227], a[36:39], a[180:183], v[224:227]
M v[228:231], a[44:47], a[180:183], 0
M v[228:231], a[40:43], a[176:179], v[228:231]
M v[232:235], a[48:51], a[176:179], 0
M v[232:235], a[52:55], a[180:183], v[232:235]
M v[236:239], a[60:63], a[180:183], 0
M v[236:239], a[56:59], a[176:179], v[236:239]
s_waitcnt vmcnt(17) lgkmcnt(0)
s_barrier
ds_read_b128 a[160:163], v10 offset:32768
ds_read_b128 a[164:167], v11 offset:32768
M v[240:243], a[64:67], a[176:179], 0
s_add_u32 m0, s29, 16384
s_add_u32 s3, s23, s31
buffer_load_dwordx4 v2, s[8:11], s3 offen offset:0 lds
M v[240:243], a[68:71], a[180:183], v[240:243]
M v[244:247], a[76:79], a[180:183], 0
M v[244:247], a[72:75], a[176:179], v[244:247]
M v[248:251], a[80:83], a[176:179], 0
M v[248:251], a[84:87], a[180:183], v[248:251]
buffer_load_dwordx4 v3, s[8:11], s3 offen offset:1024 lds
M v[252:255], a[92:95], a[180:183], 0
M v[252:255], a[88:91], a[176:179], v[252:255]
M a[0:3], a[32:35], a[184:187], 0
M a[0:3], a[36:39], a[188:191], a[0:3]
ds_read_b128 a[168:171], v10 offset:34816
ds_read_b128 a[172:175], v11 offset:34816
M a[4:7], a[44:47], a[188:191], 0
M a[4:7], a[40:43], a[184:187], a[4:7]
M a[8:11], a[48:51], a[184:187], 0
buffer_load_dwordx4 v4, s[8:11], s3 offen offset:2048 lds
M a[8:11], a[52:55], a[188:191], a[8:11]
M a[12:15], a[60:63], a[188:191], 0
M a[12:15], a[56:59], a[184:187], a[12:15]
M a[16:19], a[64:67], a[184:187], 0
M a[16:19], a[68:71], a[188:191], a[16:19]
buffer_load_dwordx4 v5, s[8:11], s3 offen offset:3072 lds
M a[20:23], a[76:79], a[188:191], 0
M a[20:23], a[72:75], a[184:187], a[20:23]
M a[24:27], a[80:83], a[184:187], 0
M a[24:27], a[84:87], a[188:191], a[24:27]
M a[28:31], a[92:95], a[188:191], 0
M a[28:31], a[88:91], a[184:187], a[28:31]
s_waitcnt lgkmcnt(2)
M v[32:35], a[96:99], a[160:163], v[32:35]
s_add_u32 s23, s23, 128
s_cmp_eq_u32 s23, s25
s_cselect_b32 s23, s26, s23
M v[32:35], a[100:103], a[164:167], v[32:35]
ds_read_b128 a[176:179], v10 offset:36864
ds_read_b128 a[180:183], v11 offset:36864
M v[36:39], a[108:111], a[164:167], v[36:39]
M v[36:39], a[104:107], a[160:163], v[36:39]
ds_read_b64_tr_b16 a[32:33], v12 offset:0
ds_read_b64_tr_b16 a[34:35], v12 offset:2048
M v[40:43], a[112:115], a[160:163], v[40:43]
M v[40:43], a[116:119], a[164:167], v[40:43]
M v[44:47], a[124:127], a[164:167], v[44:47]
s_add_u32 m0, s29, 114688
s_nop 0
buffer_load_dwordx4 v6, s[12:15], s24 offen offset:0 lds
M v[44:47], a[120:123], a[160:163], v[44:47]
ds_read_b64_tr_b16 a[40:41], v13 offset:0
ds_read_b64_tr_b16 a[42:43], v13 offset:2048
M v[48:51], a[128:131], a[160:163], v[48:51]
M v[48:51], a[132:135], a[164:167], v[48:51]
M v[52:55], a[140:143], a[164:167], v[52:55]
M v[52:55], a[136:139], a[160:163], v[52:55]
ds_read_b64_tr_b16 a[48:49], v14 offset:0
ds_read_b64_tr_b16 a[50:51], v14 offset:2048
M v[56:59], a[144:147], a[160:163], v[56:59]
M v[56:59], a[148:151], a[164:167], v[56:59]
buffer_load_dwordx4 v7, s[12:15], s24 offen offset:1024 lds
M v[60:63], a[156:159], a[164:167], v[60:63]
M v[60:63], a[152:155], a[160:163], v[60:63]
s_waitcnt lgkmcnt(8)
ds_read_b64_tr_b16 a[56:57], v15 offset:0
ds_read_b64_tr_b16 a[58:59], v15 offset:2048
M v[64:67], a[96:99], a[168:171], v[64:67]
M v[64:67], a[100:103], a[172:175], v[64:67]
ds_read_b128 a[184:187], v10 offset:38912
ds_read_b128 a[188:191], v11 offset:38912
M v[68:71], a[108:111], a[172:175], v[68:71]
M v[68:71], a[104:107], a[168:171], v[68:71]
ds_read_b64_tr_b16 a[64:65], v16 offset:0
ds_read_b64_tr_b16 a[66:67], v16 offset:2048
M v[72:75], a[112:115], a[168:171], v[72:75]
buffer_load_dwordx4 v8, s[12:15], s24 offen offset:2048 lds
M v[72:75], a[116:119], a[172:175], v[72:75]
M v[76:79], a[124:127], a[172:175], v[76:79]
M v[76:79], a[120:123], a[168:171], v[76:79]
ds_read_b64_tr_b16 a[72:73], v17 offset:0
ds_read_b64_tr_b16 a[74:75], v17 offset:2048
M v[80:83], a[128:131], a[168:171], v[80:83]
M v[80:83], a[132:135], a[172:175], v[80:83]
M v[84:87], a[140:143], a[172:175], v[84:87]
buffer_load_dwordx4 v9, s[12:15], s24 offen offset:3072 lds
M v[84:87], a[136:139], a[168:171], v[84:87]
ds_read_b64_tr_b16 a[80:81], v18 offset:0
ds_read_b64_tr_b16 a[82:83], v18 offset:2048
M v[88:91], a[144:147], a[168:171], v[88:91]
M v[88:91], a[148:151], a[172:175], v[88:91]
M v[92:95], a[156:159], a[172:175], v[92:95]
M v[92:95], a[152:155], a[168:171], v[92:95]
s_waitcnt lgkmcnt(15)
ds_read_b64_tr_b16 a[88:89], v19 offset:0
ds_read_b64_tr_b16 a[90:91], v19 offset:2048
M v[96:99], a[96:99], a[176:179], v[96:99]
s_add_u32 s24, s24, 262144
s_cmp_eq_u32 s24, s27
s_cselect_b32 s24, s28, s24
s_sub_u32 s6, s6, 1
s_cmp_eq_u32 s6, 0
s_cselect_b64 s[12:13], s[64:65], s[12:13]
M v[96:99], a[100:103], a[180:183], v[96:99]
M v[100:103], a[108:111], a[180:183], v[100:103]
M v[100:103], a[104:107], a[176:179], v[100:103]
M v[104:107], a[112:115], a[176:179], v[104:107]
M v[104:107], a[116:119], a[180:183], v[104:107]
M v[108:111], a[124:127], a[180:183], v[108:111]
M v[108:111], a[120:123], a[176:179], v[108:111]
s_waitcnt vmcnt(17) lgkmcnt(0)
s_barrier
ds_read_b128 a[160:163], v10 offset:49152
ds_read_b128 a[164:167], v11 offset:49152
M v[112:115], a[128:131], a[176:179], v[112:115]
s_add_u32 m0, s29, 32768
s_nop 0
buffer_load_dwordx4 v2, s[8:11], s23 offen offset:0 lds
M v[112:115], a[132:135], a[180:183], v[112:115]
M v[116:119], a[140:143], a[180:183], v[116:119]
M v[116:119], a[136:139], a[176:179], v[116:119]
ds_read_b64_tr_b16 a[36:37], v12 offset:16384
ds_read_b64_tr_b16 a[38:39], v12 offset:18432
M v[120:123], a[144:147], a[176:179], v[120:123]
M v[120:123], a[148:151], a[180:183], v[120:123]
buffer_load_dwordx4 v3, s[8:11], s23 offen offset:1024 lds
M v[124:127], a[156:159], a[180:183], v[124:127]
M v[124:127], a[152:155], a[176:179], v[124:127]
M v[128:131], a[96:99], a[184:187], v[128:131]
M v[128:131], a[100:103], a[188:191], v[128:131]
ds_read_b128 a[168:171], v10 offset:51200
ds_read_b128 a[172:175], v11 offset:51200
ds_read_b64_tr_b16 a[44:45], v13 offset:16384
ds_read_b64_tr_b16 a[46:47], v13 offset:18432
M v[132:135], a[108:111], a[188:191], v[132:135]
M v[132:135], a[104:107], a[184:187], v[132:135]
buffer_load_dwordx4 v4, s[8:11], s23 offen offset:2048 lds
M v[136:139], a[112:115], a[184:187], v[136:139]
M v[136:139], a[116:119], a[188:191], v[136:139]
M v[140:143], a[124:127], a[188:191], v[140:143]
M v[140:143], a[120:123], a[184:187], v[140:143]
ds_read_b64_tr_b16 a[52:53], v14 offset:16384
ds_read_b64_tr_b16 a[54:55], v14 offset:18432
M v[144:147], a[128:131], a[184:187], v[144:147]
M v[144:147], a[132:135], a[188:191], v[144:147]
buffer_load_dwordx4 v5, s[8:11], s23 offen offset:3072 lds
M v[148:151], a[140:143], a[188:191], v[148:151]
M v[148:151], a[136:139], a[184:187], v[148:151]
M v[152:155], a[144:147], a[184:187], v[152:155]
M v[152:155], a[148:151], a[188:191], v[152:155]
ds_read_b64_tr_b16 a[60:61], v15 offset:16384
ds_read_b64_tr_b16 a[62:63], v15 offset:18432
M v[156:159], a[156:159], a[188:191], v[156:159]
s_add_u32 m0, s29, 65536
s_nop 0
buffer_load_dwordx4 v6, s[12:15], s24 offen offset:0 lds
M v[156:159], a[152:155], a[184:187], v[156:159]
s_waitcnt lgkmcnt(10)
M v[160:163], a[96:99], a[160:163], v[160:163]
M v[160:163], a[100:103], a[164:167], v[160:163]
ds_read_b128 a[176:179], v10 offset:53248
ds_read_b128 a[180:183], v11 offset:53248
M v[164:167], a[108:111], a[164:167], v[164:167]
M v[164:167], a[104:107], a[160:163], v[164:167]
ds_read_b64_tr_b16 a[68:69], v16 offset:16384
ds_read_b64_tr_b16 a[70:71], v16 offset:18432
M v[168:171], a[112:115], a[160:163], v[168:171]
M v[168:171], a[116:119], a[164:167], v[168:171]
buffer_load_dwordx4 v7, s[12:15], s24 offen offset:1024 lds
M v[172:175], a[124:127], a[164:167], v[172:175]
M v[172:175], a[120:123], a[160:163], v[172:175]
M v[176:179], a[128:131], a[160:163], v[176:179]
M v[176:179], a[132:135], a[164:167], v[176:179]
ds_read_b64_tr_b16 a[76:77], v17 offset:16384
ds_read_b64_tr_b16 a[78:79], v17 offset:18432
M v[180:183], a[140:143], a[164:167], v[180:183]
M v[180:183], a[136:139], a[160:163], v[180:183]
buffer_load_dwordx4 v8, s[12:15], s24 offen offset:2048 lds
M v[184:187], a[144:147], a[160:163], v[184:187]
M v[184:187], a[148:151], a[164:167], v[184:187]
M v[188:191], a[156:159], a[164:167], v[188:191]
M v[188:191], a[152:155], a[160:163], v[188:191]
s_waitcnt lgkmcnt(12)
ds_read_b64_tr_b16 a[84:85], v18 offset:16384
ds_read_b64_tr_b16 a[86:87], v18 offset:18432
M v[192:195], a[96:99], a[168:171], v[192:195]
buffer_load_dwordx4 v9, s[12:15], s24 offen offset:3072 lds
M v[192:195], a[100:103], a[172:175], v[192:195]
ds_read_b128 a[184:187], v10 offset:55296
ds_read_b128 a[188:191], v11 offset:55296
M v[196:199], a[108:111], a[172:175], v[196:199]
M v[196:199], a[104:107], a[168:171], v[196:199]
M v[200:203], a[112:115], a[168:171], v[200:203]
M v[200:203], a[116:119], a[172:175], v[200:203]
ds_read_b64_tr_b16 a[92:93], v19 offset:16384
ds_read_b64_tr_b16 a[94:95], v19 offset:18432
M v[204:207], a[124:127], a[172:175], v[204:207]
s_add_u32 s24, s24, 262144
M v[204:207], a[120:123], a[168:171], v[204:207]
M v[208:211], a[128:131], a[168:171], v[208:211]
M v[208:211], a[132:135], a[172:175], v[208:211]
M v[212:215], a[140:143], a[172:175], v[212:215]
M v[212:215], a[136:139], a[168:171], v[212:215]
buffer_load_dword v21, v20, s[60:63], s54 offen
s_add_u32 s54, s54, s55
M v[216:219], a[144:147], a[168:171], v[216:219]
M v[216:219], a[148:151], a[172:175], v[216:219]
M v[220:223], a[156:159], a[172:175], v[220:223]
M v[220:223], a[152:155], a[168:171], v[220:223]
s_waitcnt lgkmcnt(10)
M v[224:227], a[96:99], a[176:179], v[224:227]
s_cmp_eq_u32 s54, s56
s_cselect_b32 s54, s57, s54
s_cselect_b64 s[60:61], s[58:59], s[60:61]
s_cselect_b32 s62, s7, s62
M v[224:227], a[100:103], a[180:183], v[224:227]
M v[228:231], a[108:111], a[180:183], v[228:231]
M v[228:231], a[104:107], a[176:179], v[228:231]
M v[232:235], a[112:115], a[176:179], v[232:235]
M v[232:235], a[116:119], a[180:183], v[232:235]
M v[236:239], a[124:127], a[180:183], v[236:239]
M v[236:239], a[120:123], a[176:179], v[236:239]
s_waitcnt vmcnt(18) lgkmcnt(0)
s_barrier
ds_read_b128 a[160:163], v10 offset:0
ds_read_b128 a[164:167], v11 offset:0
M v[240:243], a[128:131], a[176:179], v[240:243]
s_add_u32 m0, s29, 49152
s_add_u32 s3, s23, s31
buffer_load_dwordx4 v2, s[8:11], s3 offen offset:0 lds
M v[240:243], a[132:135], a[180:183], v[240:243]
M v[244:247], a[140:143], a[180:183], v[244:247]
M v[244:247], a[136:139], a[176:179], v[244:247]
M v[248:251], a[144:147], a[176:179], v[248:251]
M v[248:251], a[148:151], a[180:183], v[248:251]
buffer_load_dwordx4 v3, s[8:11], s3 offen offset:1024 lds
M v[252:255], a[156:159], a[180:183], v[252:255]
M v[252:255], a[152:155], a[176:179], v[252:255]
M a[0:3], a[96:99], a[184:187], a[0:3]
M a[0:3], a[100:103], a[188:191], a[0:3]
ds_read_b128 a[168:171], v10 offset:2048
ds_read_b128 a[172:175], v11 offset:2048
M a[4:7], a[108:111], a[188:191], a[4:7]
M a[4:7], a[104:107], a[184:187], a[4:7]
M a[8:11], a[112:115], a[184:187], a[8:11]
buffer_load_dwordx4 v4, s[8:11], s3 offen offset:2048 lds
M a[8:11], a[116:119], a[188:191], a[8:11]
M a[12:15], a[124:127], a[188:191], a[12:15]
M a[12:15], a[120:123], a[184:187], a[12:15]
M a[16:19], a[128:131], a[184:187], a[16:19]
M a[16:19], a[132:135], a[188:191], a[16:19]
buffer_load_dwordx4 v5, s[8:11], s3 offen offset:3072 lds
M a[20:23], a[140:143], a[188:191], a[20:23]
M a[20:23], a[136:139], a[184:187], a[20:23]
M a[24:27], a[144:147], a[184:187], a[24:27]
M a[24:27], a[148:151], a[188:191], a[24:27]
M a[28:31], a[156:159], a[188:191], a[28:31]
M a[28:31], a[152:155], a[184:187], a[28:31]
s_waitcnt lgkmcnt(2)
s_mov_b32 s30, 5
Lk1_ql:
M v[32:35], a[32:35], a[160:163], v[32:35]
s_add_u32 s23, s23, 128
s_cmp_eq_u32 s23, s25
s_cselect_b32 s23, s26, s23
M v[32:35], a[36:39], a[164:167], v[32:35]
ds_read_b128 a[176:179], v10 offset:4096
ds_read_b128 a[180:183], v11 offset:4096
M v[36:39], a[44:47], a[164:167], v[36:39]
M v[36:39], a[40:43], a[160:163], v[36:39]
ds_read_b64_tr_b16 a[96:97], v12 offset:32768
ds_read_b64_tr_b16 a[98:99], v12 offset:34816
M v[40:43], a[48:51], a[160:163], v[40:43]
M v[40:43], a[52:55], a[164:167], v[40:43]
M v[44:47], a[60:63], a[164:167], v[44:47]
s_add_u32 m0, s29, 81920
s_nop 0
buffer_load_dwordx4 v6, s[12:15], s24 offen offset:0 lds
M v[44:47], a[56:59], a[160:163], v[44:47]
ds_read_b64_tr_b16 a[104:105], v13 offset:32768
ds_read_b64_tr_b16 a[106:107], v13 offset:34816
M v[48:51], a[64:67], a[160:163], v[48:51]
M v[48:51], a[68:71], a[164:167], v[48:51]
M v[52:55], a[76:79], a[164:167], v[52:55]
M v[52:55], a[72:75], a[160:163], v[52:55]
ds_read_b64_tr_b16 a[112:113], v14 offset:32768
ds_read_b64_tr_b16 a[114:115], v14 offset:34816
M v[56:59], a[80:83], a[160:163], v[56:59]
M v[56:59], a[84:87], a[164:167], v[56:59]
buffer_load_dwordx4 v7, s[12:15], s24 offen offset:1024 lds
M v[60:63], a[92:95], a[164:167], v[60:63]
M v[60:63], a[88:91], a[160:163], v[60:63]
s_waitcnt lgkmcnt(8)
ds_read_b64_tr_b16 a[120:121], v15 offset:32768
ds_read_b64_tr_b16 a[122:123], v15 offset:34816
M v[64:67], a[32:35], a[168:171], v[64:67]
M v[64:67], a[36:39], a[172:175], v[64:67]
ds_read_b128 a[184:187], v10 offset:6144
ds_read_b128 a[188:191], v11 offset:6144
M v[68:71], a[44:47], a[172:175], v[68:71]
M v[68:71], a[40:43], a[168:171], v[68:71]
ds_read_b64_tr_b16 a[128:129], v16 offset:32768
ds_read_b64_tr_b16 a[130:131], v16 offset:34816
M v[72:75], a[48:51], a[168:171], v[72:75]
buffer_load_dwordx4 v8, s[12:15], s24 offen offset:2048 lds
M v[72:75], a[52:55], a[172:175], v[72:75]
M v[76:79], a[60:63], a[172:175], v[76:79]
M v[76:79], a[56:59], a[168:171], v[76:79]
ds_read_b64_tr_b16 a[136:137], v17 offset:32768
ds_read_b64_tr_b16 a[138:139], v17 offset:34816
M v[80:83], a[64:67], a[168:171], v[80:83]
M v[80:83], a[68:71], a[172:175], v[80:83]
M v[84:87], a[76:79], a[172:175], v[84:87]
buffer_load_dwordx4 v9, s[12:15], s24 offen offset:3072 lds
M v[84:87], a[72:75], a[168:171], v[84:87]
ds_read_b64_tr_b16 a[144:145], v18 offset:32768
ds_read_b64_tr_b16 a[146:147], v18 offset:34816
M v[88:91], a[80:83], a[168:171], v[88:91]
M v[88:91], a[84:87], a[172:175], v[88:91]
M v[92:95], a[92:95], a[172:175], v[92:95]
M v[92:95], a[88:91], a[168:171], v[92:95]
s_waitcnt lgkmcnt(15)
ds_read_b64_tr_b16 a[152:153], v19 offset:32768
ds_read_b64_tr_b16 a[154:155], v19 offset:34816
M v[96:99], a[32:35], a[176:179], v[96:99]
s_add_u32 s24, s24, 262144
s_cmp_eq_u32 s24, s27
s_cselect_b32 s24, s28, s24
s_sub_u32 s6, s6, 1
s_cmp_eq_u32 s6, 0
s_cselect_b64 s[12:13], s[64:65], s[12:13]
M v[96:99], a[36:39], a[180:183], v[96:99]
M v[100:103], a[44:47], a[180:183], v[100:103]
M v[100:103], a[40:43], a[176:179], v[100:103]
M v[104:107], a[48:51], a[176:179], v[104:107]
M v[104:107], a[52:55], a[180:183], v[104:107]
M v[108:111], a[60:63], a[180:183], v[108:111]
M v[108:111], a[56:59], a[176:179], v[108:111]
s_waitcnt vmcnt(17) lgkmcnt(0)
s_barrier
ds_read_b128 a[160:163], v10 offset:16384
ds_read_b128 a[164:167], v11 offset:16384
M v[112:115], a[64:67], a[176:179], v[112:115]
s_add_u32 m0, s29, 0
s_nop 0
buffer_load_dwordx4 v2, s[8:11], s23 offen offset:0 lds
M v[112:115], a[68:71], a[180:183], v[112:115]
M v[116:119], a[76:79], a[180:183], v[116:119]
M v[116:119], a[72:75], a[176:179], v[116:119]
ds_read_b64_tr_b16 a[100:101], v12 offset:49152
ds_read_b64_tr_b16 a[102:103], v12 offset:51200
M v[120:123], a[80:83], a[176:179], v[120:123]
M v[120:123], a[84:87], a[180:183], v[120:123]
buffer_load_dwordx4 v3, s[8:11], s23 offen offset:1024 lds
M v[124:127], a[92:95], a[180:183], v[124:127]
M v[124:127], a[88:91], a[176:179], v[124:127]
M v[128:131], a[32:35], a[184:187], v[128:131]
M v[128:131], a[36:39], a[188:191], v[128:131]
ds_read_b128 a[168:171], v10 offset:18432
ds_read_b128 a[172:175], v11 offset:18432
ds_read_b64_tr_b16 a[108:109], v13 offset:49152
ds_read_b64_tr_b16 a[110:111], v13 offset:51200
M v[132:135], a[44:47], a[188:191], v[132:135]
M v[132:135], a[40:43], a[184:187], v[132:135]
buffer_load_dwordx4 v4, s[8:11], s23 offen offset:2048 lds
M v[136:139], a[48:51], a[184:187], v[136:139]
M v[136:139], a[52:55], a[188:191], v[136:139]
M v[140:143], a[60:63], a[188:191], v[140:143]
M v[140:143], a[56:59], a[184:187], v[140:143]
ds_read_b64_tr_b16 a[116:117], v14 offset:49152
ds_read_b64_tr_b16 a[118:119], v14 offset:51200
M v[144:147], a[64:67], a[184:187], v[144:147]
M v[144:147], a[68:71], a[188:191], v[144:147]
buffer_load_dwordx4 v5, s[8:11], s23 offen offset:3072 lds
M v[148:151], a[76:79], a[188:191], v[148:151]
M v[148:151], a[72:75], a[184:187], v[148:151]
M v[152:155], a[80:83], a[184:187], v[152:155]
M v[152:155], a[84:87], a[188:191], v[152:155]
ds_read_b64_tr_b16 a[124:125], v15 offset:49152
ds_read_b64_tr_b16 a[126:127], v15 offset:51200
M v[156:159], a[92:95], a[188:191], v[156:159]
s_add_u32 m0, s29, 98304
s_nop 0
buffer_load_dwordx4 v6, s[12:15], s24 offen offset:0 lds
M v[156:159], a[88:91], a[184:187], v[156:159]
s_waitcnt lgkmcnt(10)
M v[160:163], a[32:35], a[160:163], v[160:163]
M v[160:163], a[36:39], a[164:167], v[160:163]
ds_read_b128 a[176:179], v10 offset:20480
ds_read_b128 a[180:183], v11 offset:20480
M v[164:167], a[44:47], a[164:167], v[164:167]
M v[164:167], a[40:43], a[160:163], v[164:167]
ds_read_b64_tr_b16 a[132:133], v16 offset:49152
ds_read_b64_tr_b16 a[134:135], v16 offset:51200
M v[168:171], a[48:51], a[160:163], v[168:171]
M v[168:171], a[52:55], a[164:167], v[168:171]
buffer_load_dwordx4 v7, s[12:15], s24 offen offset:1024 lds
M v[172:175], a[60:63], a[164:167], v[172:175]
M v[172:175], a[56:59], a[160:163], v[172:175]
M v[176:179], a[64:67], a[160:163], v[176:179]
M v[176:179], a[68:71], a[164:167], v[176:179]
ds_read_b64_tr_b16 a[140:141], v17 offset:49152
ds_read_b64_tr_b16 a[142:143], v17 offset:51200
M v[180:183], a[76:79], a[164:167], v[180:183]
M v[180:183], a[72:75], a[160:163], v[180:183]
buffer_load_dwordx4 v8, s[12:15], s24 offen offset:2048 lds
M v[184:187], a[80:83], a[160:163], v[184:187]
M v[184:187], a[84:87], a[164:167], v[184:187]
M v[188:191], a[92:95], a[164:167], v[188:191]
M v[188:191], a[88:91], a[160:163], v[188:191]
s_waitcnt lgkmcnt(12)
ds_read_b64_tr_b16 a[148:149], v18 offset:49152
ds_read_b64_tr_b16 a[150:151], v18 offset:51200
M v[192:195], a[32:35], a[168:171], v[192:195]
buffer_load_dwordx4 v9, s[12:15], s24 offen offset:3072 lds
M v[192:195], a[36:39], a[172:175], v[192:195]
ds_read_b128 a[184:187], v10 offset:22528
ds_read_b128 a[188:191], v11 offset:22528
M v[196:199], a[44:47], a[172:175], v[196:199]
M v[196:199], a[40:43], a[168:171], v[196:199]
M v[200:203], a[48:51], a[168:171], v[200:203]
M v[200:203], a[52:55], a[172:175], v[200:203]
ds_read_b64_tr_b16 a[156:157], v19 offset:49152
ds_read_b64_tr_b16 a[158:159], v19 offset:51200
M v[204:207], a[60:63], a[172:175], v[204:207]
s_add_u32 s24, s24, 262144
M v[204:207], a[56:59], a[168:171], v[204:207]
M v[208:211], a[64:67], a[168:171], v[208:211]
M v[208:211], a[68:71], a[172:175], v[208:211]
M v[212:215], a[76:79], a[172:175], v[212:215]
M v[212:215], a[72:75], a[168:171], v[212:215]
buffer_load_dword v21, v20, s[60:63], s54 offen
s_add_u32 s54, s54, s55
M v[216:219], a[80:83], a[168:171], v[216:219]
M v[216:219], a[84:87], a[172:175], v[216:219]
M v[220:223], a[92:95], a[172:175], v[220:223]
M v[220:223], a[88:91], a[168:171], v[220:223]
s_waitcnt lgkmcnt(10)
M v[224:227], a[32:35], a[176:179], v[224:227]
s_cmp_eq_u32 s54, s56
s_cselect_b32 s54, s57, s54
s_cselect_b64 s[60:61], s[58:59], s[60:61]
s_cselect_b32 s62, s7, s62
M v[224:227], a[36:39], a[180:183], v[224:227]
M v[228:231], a[44:47], a[180:183], v[228:231]
M v[228:231], a[40:43], a[176:179], v[228:231]
M v[232:235], a[48:51], a[176:179], v[232:235]
M v[232:235], a[52:55], a[180:183], v[232:235]
M v[236:239], a[60:63], a[180:183], v[236:239]
M v[236:239], a[56:59], a[176:179], v[236:239]
s_waitcnt vmcnt(18) lgkmcnt(0)
s_barrier
ds_read_b128 a[160:163], v10 offset:32768
ds_read_b128 a[164:167], v11 offset:32768
M v[240:243], a[64:67], a[176:179], v[240:243]
s_add_u32 m0, s29, 16384
s_add_u32 s3, s23, s31
buffer_load_dwordx4 v2, s[8:11], s3 offen offset:0 lds
M v[240:243], a[68:71], a[180:183], v[240:243]
M v[244:247], a[76:79], a[180:183], v[244:247]
M v[244:247], a[72:75], a[176:179], v[244:247]
M v[248:251], a[80:83], a[176:179], v[248:251]
M v[248:251], a[84:87], a[180:183], v[248:251]
buffer_load_dwordx4 v3, s[8:11], s3 offen offset:1024 lds
M v[252:255], a[92:95], a[180:183], v[252:255]
M v[252:255], a[88:91], a[176:179], v[252:255]
M a[0:3], a[32:35], a[184:187], a[0:3]
M a[0:3], a[36:39], a[188:191], a[0:3]
ds_read_b128 a[168:171], v10 offset:34816
ds_read_b128 a[172:175], v11 offset:34816
M a[4:7], a[44:47], a[188:191], a[4:7]
M a[4:7], a[40:43], a[184:187], a[4:7]
M a[8:11], a[48:51], a[184:187], a[8:11]
buffer_load_dwordx4 v4, s[8:11], s3 offen offset:2048 lds
M a[8:11], a[52:55], a[188:191], a[8:11]
M a[12:15], a[60:63], a[188:191], a[12:15]
M a[12:15], a[56:59], a[184:187], a[12:15]
M a[16:19], a[64:67], a[184:187], a[16:19]
M a[16:19], a[68:71], a[188:191], a[16:19]
buffer_load_dwordx4 v5, s[8:11], s3 offen offset:3072 lds
M a[20:23], a[76:79], a[188:191], a[20:23]
M a[20:23], a[72:75], a[184:187], a[20:23]
M a[24:27], a[80:83], a[184:187], a[24:27]
M a[24:27], a[84:87], a[188:191], a[24:27]
M a[28:31], a[92:95], a[188:191], a[28:31]
M a[28:31], a[88:91], a[184:187], a[28:31]
s_waitcnt lgkmcnt(2)
M v[32:35], a[96:99], a[160:163], v[32:35]
s_add_u32 s23, s23, 128
s_cmp_eq_u32 s23, s25
s_cselect_b32 s23, s26, s23
M v[32:35], a[100:103], a[164:167], v[32:35]
ds_read_b128 a[176:179], v10 offset:36864
ds_read_b128 a[180:183], v11 offset:36864
M v[36:39], a[108:111], a[164:167], v[36:39]
M v[36:39], a[104:107], a[160:163], v[36:39]
ds_read_b64_tr_b16 a[32:33], v12 offset:0
ds_read_b64_tr_b16 a[34:35], v12 offset:2048
M v[40:43], a[112:115], a[160:163], v[40:43]
M v[40:43], a[116:119], a[164:167], v[40:43]
M v[44:47], a[124:127], a[164:167], v[44:47]
s_add_u32 m0, s29, 114688
s_nop 0
buffer_load_dwordx4 v6, s[12:15], s24 offen offset:0 lds
M v[44:47], a[120:123], a[160:163], v[44:47]
ds_read_b64_tr_b16 a[40:41], v13 offset:0
ds_read_b64_tr_b16 a[42:43], v13 offset:2048
M v[48:51], a[128:131], a[160:163], v[48:51]
M v[48:51], a[132:135], a[164:167], v[48:51]
M v[52:55], a[140:143], a[164:167], v[52:55]
M v[52:55], a[136:139], a[160:163], v[52:55]
ds_read_b64_tr_b16 a[48:49], v14 offset:0
ds_read_b64_tr_b16 a[50:51], v14 offset:2048
M v[56:59], a[144:147], a[160:163], v[56:59]
M v[56:59], a[148:151], a[164:167], v[56:59]
buffer_load_dwordx4 v7, s[12:15], s24 offen offset:1024 lds
M v[60:63], a[156:159], a[164:167], v[60:63]
M v[60:63], a[152:155], a[160:163], v[60:63]
s_waitcnt lgkmcnt(8)
ds_read_b64_tr_b16 a[56:57], v15 offset:0
ds_read_b64_tr_b16 a[58:59], v15 offset:2048
M v[64:67], a[96:99], a[168:171], v[64:67]
M v[64:67], a[100:103], a[172:175], v[64:67]
ds_read_b128 a[184:187], v10 offset:38912
ds_read_b128 a[188:191], v11 offset:38912
M v[68:71], a[108:111], a[172:175], v[68:71]
M v[68:71], a[104:107], a[168:171], v[68:71]
ds_read_b64_tr_b16 a[64:65], v16 offset:0
ds_read_b64_tr_b16 a[66:67], v16 offset:2048
M v[72:75], a[112:115], a[168:171], v[72:75]
buffer_load_dwordx4 v8, s[12:15], s24 offen offset:2048 lds
M v[72:75], a[116:119], a[172:175], v[72:75]
M v[76:79], a[124:127], a[172:175], v[76:79]
M v[76:79], a[120:123], a[168:171], v[76:79]
ds_read_b64_tr_b16 a[72:73], v17 offset:0
ds_read_b64_tr_b16 a[74:75], v17 offset:2048
M v[80:83], a[128:131], a[168:171], v[80:83]
M v[80:83], a[132:135], a[172:175], v[80:83]
M v[84:87], a[140:143], a[172:175], v[84:87]
buffer_load_dwordx4 v9, s[12:15], s24 offen offset:3072 lds
M v[84:87], a[136:139], a[168:171], v[84:87]
ds_read_b64_tr_b16 a[80:81], v18 offset:0
ds_read_b64_tr_b16 a[82:83], v18 offset:2048
M v[88:91], a[144:147], a[168:171], v[88:91]
M v[88:91], a[148:151], a[172:175], v[88:91]
M v[92:95], a[156:159], a[172:175], v[92:95]
M v[92:95], a[152:155], a[168:171], v[92:95]
s_waitcnt lgkmcnt(15)
ds_read_b64_tr_b16 a[88:89], v19 offset:0
ds_read_b64_tr_b16 a[90:91], v19 offset:2048
M v[96:99], a[96:99], a[176:179], v[96:99]
s_add_u32 s24, s24, 262144
s_cmp_eq_u32 s24, s27
s_cselect_b32 s24, s28, s24
s_sub_u32 s6, s6, 1
s_cmp_eq_u32 s6, 0
s_cselect_b64 s[12:13], s[64:65], s[12:13]
M v[96:99], a[100:103], a[180:183], v[96:99]
M v[100:103], a[108:111], a[180:183], v[100:103]
M v[100:103], a[104:107], a[176:179], v[100:103]
M v[104:107], a[112:115], a[176:179], v[104:107]
M v[104:107], a[116:119], a[180:183], v[104:107]
M v[108:111], a[124:127], a[180:183], v[108:111]
M v[108:111], a[120:123], a[176:179], v[108:111]
s_waitcnt vmcnt(17) lgkmcnt(0)
s_barrier
ds_read_b128 a[160:163], v10 offset:49152
ds_read_b128 a[164:167], v11 offset:49152
M v[112:115], a[128:131], a[176:179], v[112:115]
s_add_u32 m0, s29, 32768
s_nop 0
buffer_load_dwordx4 v2, s[8:11], s23 offen offset:0 lds
M v[112:115], a[132:135], a[180:183], v[112:115]
M v[116:119], a[140:143], a[180:183], v[116:119]
M v[116:119], a[136:139], a[176:179], v[116:119]
ds_read_b64_tr_b16 a[36:37], v12 offset:16384
ds_read_b64_tr_b16 a[38:39], v12 offset:18432
M v[120:123], a[144:147], a[176:179], v[120:123]
M v[120:123], a[148:151], a[180:183], v[120:123]
buffer_load_dwordx4 v3, s[8:11], s23 offen offset:1024 lds
M v[124:127], a[156:159], a[180:183], v[124:127]
M v[124:127], a[152:155], a[176:179], v[124:127]
M v[128:131], a[96:99], a[184:187], v[128:131]
M v[128:131], a[100:103], a[188:191], v[128:131]
ds_read_b128 a[168:171], v10 offset:51200
ds_read_b128 a[172:175], v11 offset:51200
ds_read_b64_tr_b16 a[44:45], v13 offset:16384
ds_read_b64_tr_b16 a[46:47], v13 offset:18432
M v[132:135], a[108:111], a[188:191], v[132:135]
M v[132:135], a[104:107], a[184:187], v[132:135]
buffer_load_dwordx4 v4, s[8:11], s23 offen offset:2048 lds
M v[136:139], a[112:115], a[184:187], v[136:139]
M v[136:139], a[116:119], a[188:191], v[136:139]
M v[140:143], a[124:127], a[188:191], v[140:143]
M v[140:143], a[120:123], a[184:187], v[140:143]
ds_read_b64_tr_b16 a[52:53], v14 offset:16384
ds_read_b64_tr_b16 a[54:55], v14 offset:18432
M v[144:147], a[128:131], a[184:187], v[144:147]
M v[144:147], a[132:135], a[188:191], v[144:147]
buffer_load_dwordx4 v5, s[8:11], s23 offen offset:3072 lds
M v[148:151], a[140:143], a[188:191], v[148:151]
M v[148:151], a[136:139], a[184:187], v[148:151]
M v[152:155], a[144:147], a[184:187], v[152:155]
M v[152:155], a[148:151], a[188:191], v[152:155]
ds_read_b64_tr_b16 a[60:61], v15 offset:16384
ds_read_b64_tr_b16 a[62:63], v15 offset:18432
M v[156:159], a[156:159], a[188:191], v[156:159]
s_add_u32 m0, s29, 65536
s_nop 0
buffer_load_dwordx4 v6, s[12:15], s24 offen offset:0 lds
M v[156:159], a[152:155], a[184:187], v[156:159]
s_waitcnt lgkmcnt(10)
M v[160:163], a[96:99], a[160:163], v[160:163]
M v[160:163], a[100:103], a[164:167], v[160:163]
ds_read_b128 a[176:179], v10 offset:53248
ds_read_b128 a[180:183], v11 offset:53248
M v[164:167], a[108:111], a[164:167], v[164:167]
M v[164:167], a[104:107], a[160:163], v[164:167]
ds_read_b64_tr_b16 a[68:69], v16 offset:16384
ds_read_b64_tr_b16 a[70:71], v16 offset:18432
M v[168:171], a[112:115], a[160:163], v[168:171]
M v[168:171], a[116:119], a[164:167], v[168:171]
buffer_load_dwordx4 v7, s[12:15], s24 offen offset:1024 lds
M v[172:175], a[124:127], a[164:167], v[172:175]
M v[172:175], a[120:123], a[160:163], v[172:175]
M v[176:179], a[128:131], a[160:163], v[176:179]
M v[176:179], a[132:135], a[164:167], v[176:179]
ds_read_b64_tr_b16 a[76:77], v17 offset:16384
ds_read_b64_tr_b16 a[78:79], v17 offset:18432
M v[180:183], a[140:143], a[164:167], v[180:183]
M v[180:183], a[136:139], a[160:163], v[180:183]
buffer_load_dwordx4 v8, s[12:15], s24 offen offset:2048 lds
M v[184:187], a[144:147], a[160:163], v[184:187]
M v[184:187], a[148:151], a[164:167], v[184:187]
M v[188:191], a[156:159], a[164:167], v[188:191]
M v[188:191], a[152:155], a[160:163], v[188:191]
s_waitcnt lgkmcnt(12)
ds_read_b64_tr_b16 a[84:85], v18 offset:16384
ds_read_b64_tr_b16 a[86:87], v18 offset:18432
M v[192:195], a[96:99], a[168:171], v[192:195]
buffer_load_dwordx4 v9, s[12:15], s24 offen offset:3072 lds
M v[192:195], a[100:103], a[172:175], v[192:195]
ds_read_b128 a[184:187], v10 offset:55296
ds_read_b128 a[188:191], v11 offset:55296
M v[196:199], a[108:111], a[172:175], v[196:199]
M v[196:199], a[104:107], a[168:171], v[196:199]
M v[200:203], a[112:115], a[168:171], v[200:203]
M v[200:203], a[116:119], a[172:175], v[200:203]
ds_read_b64_tr_b16 a[92:93], v19 offset:16384
ds_read_b64_tr_b16 a[94:95], v19 offset:18432
M v[204:207], a[124:127], a[172:175], v[204:207]
s_add_u32 s24, s24, 262144
M v[204:207], a[120:123], a[168:171], v[204:207]
M v[208:211], a[128:131], a[168:171], v[208:211]
M v[208:211], a[132:135], a[172:175], v[208:211]
M v[212:215], a[140:143], a[172:175], v[212:215]
M v[212:215], a[136:139], a[168:171], v[212:215]
buffer_load_dword v21, v20, s[60:63], s54 offen
s_add_u32 s54, s54, s55
M v[216:219], a[144:147], a[168:171], v[216:219]
M v[216:219], a[148:151], a[172:175], v[216:219]
M v[220:223], a[156:159], a[172:175], v[220:223]
M v[220:223], a[152:155], a[168:171], v[220:223]
s_waitcnt lgkmcnt(10)
M v[224:227], a[96:99], a[176:179], v[224:227]
s_cmp_eq_u32 s54, s56
s_cselect_b32 s54, s57, s54
s_cselect_b64 s[60:61], s[58:59], s[60:61]
s_cselect_b32 s62, s7, s62
M v[224:227], a[100:103], a[180:183], v[224:227]
M v[228:231], a[108:111], a[180:183], v[228:231]
M v[228:231], a[104:107], a[176:179], v[228:231]
M v[232:235], a[112:115], a[176:179], v[232:235]
M v[232:235], a[116:119], a[180:183], v[232:235]
M v[236:239], a[124:127], a[180:183], v[236:239]
M v[236:239], a[120:123], a[176:179], v[236:239]
s_waitcnt vmcnt(18) lgkmcnt(0)
s_barrier
ds_read_b128 a[160:163], v10 offset:0
ds_read_b128 a[164:167], v11 offset:0
M v[240:243], a[128:131], a[176:179], v[240:243]
s_add_u32 m0, s29, 49152
s_add_u32 s3, s23, s31
buffer_load_dwordx4 v2, s[8:11], s3 offen offset:0 lds
M v[240:243], a[132:135], a[180:183], v[240:243]
M v[244:247], a[140:143], a[180:183], v[244:247]
M v[244:247], a[136:139], a[176:179], v[244:247]
M v[248:251], a[144:147], a[176:179], v[248:251]
M v[248:251], a[148:151], a[180:183], v[248:251]
buffer_load_dwordx4 v3, s[8:11], s3 offen offset:1024 lds
M v[252:255], a[156:159], a[180:183], v[252:255]
M v[252:255], a[152:155], a[176:179], v[252:255]
M a[0:3], a[96:99], a[184:187], a[0:3]
M a[0:3], a[100:103], a[188:191], a[0:3]
ds_read_b128 a[168:171], v10 offset:2048
ds_read_b128 a[172:175], v11 offset:2048
M a[4:7], a[108:111], a[188:191], a[4:7]
M a[4:7], a[104:107], a[184:187], a[4:7]
M a[8:11], a[112:115], a[184:187], a[8:11]
buffer_load_dwordx4 v4, s[8:11], s3 offen offset:2048 lds
M a[8:11], a[116:119], a[188:191], a[8:11]
M a[12:15], a[124:127], a[188:191], a[12:15]
M a[12:15], a[120:123], a[184:187], a[12:15]
M a[16:19], a[128:131], a[184:187], a[16:19]
M a[16:19], a[132:135], a[188:191], a[16:19]
buffer_load_dwordx4 v5, s[8:11], s3 offen offset:3072 lds
M a[20:23], a[140:143], a[188:191], a[20:23]
M a[20:23], a[136:139], a[184:187], a[20:23]
M a[24:27], a[144:147], a[184:187], a[24:27]
M a[24:27], a[148:151], a[188:191], a[24:27]
M a[28:31], a[156:159], a[188:191], a[28:31]
M a[28:31], a[152:155], a[184:187], a[28:31]
s_waitcnt lgkmcnt(2)
s_sub_u32 s30, s30, 1
s_cmp_lg_u32 s30, 0
s_cbranch_scc1 Lk1_ql
M v[32:35], a[32:35], a[160:163], v[32:35]
s_add_u32 s23, s23, 128
s_cmp_eq_u32 s23, s25
s_cselect_b32 s23, s26, s23
M v[32:35], a[36:39], a[164:167], v[32:35]
ds_read_b128 a[176:179], v10 offset:4096
ds_read_b128 a[180:183], v11 offset:4096
M v[36:39], a[44:47], a[164:167], v[36:39]
M v[36:39], a[40:43], a[160:163], v[36:39]
ds_read_b64_tr_b16 a[96:97], v12 offset:32768
ds_read_b64_tr_b16 a[98:99], v12 offset:34816
M v[40:43], a[48:51], a[160:163], v[40:43]
M v[40:43], a[52:55], a[164:167], v[40:43]
M v[44:47], a[60:63], a[164:167], v[44:47]
s_add_u32 m0, s29, 81920
s_nop 0
buffer_load_dwordx4 v6, s[12:15], s24 offen offset:0 lds
M v[44:47], a[56:59], a[160:163], v[44:47]
ds_read_b64_tr_b16 a[104:105], v13 offset:32768
ds_read_b64_tr_b16 a[106:107], v13 offset:34816
M v[48:51], a[64:67], a[160:163], v[48:51]
M v[48:51], a[68:71], a[164:167], v[48:51]
M v[52:55], a[76:79], a[164:167], v[52:55]
M v[52:55], a[72:75], a[160:163], v[52:55]
ds_read_b64_tr_b16 a[112:113], v14 offset:32768
ds_read_b64_tr_b16 a[114:115], v14 offset:34816
M v[56:59], a[80:83], a[160:163], v[56:59]
M v[56:59], a[84:87], a[164:167], v[56:59]
buffer_load_dwordx4 v7, s[12:15], s24 offen offset:1024 lds
M v[60:63], a[92:95], a[164:167], v[60:63]
M v[60:63], a[88:91], a[160:163], v[60:63]
s_waitcnt lgkmcnt(8)
ds_read_b64_tr_b16 a[120:121], v15 offset:32768
ds_read_b64_tr_b16 a[122:123], v15 offset:34816
M v[64:67], a[32:35], a[168:171], v[64:67]
M v[64:67], a[36:39], a[172:175], v[64:67]
ds_read_b128 a[184:187], v10 offset:6144
ds_read_b128 a[188:191], v11 offset:6144
M v[68:71], a[44:47], a[172:175], v[68:71]
M v[68:71], a[40:43], a[168:171], v[68:71]
ds_read_b64_tr_b16 a[128:129], v16 offset:32768
ds_read_b64_tr_b16 a[130:131], v16 offset:34816
M v[72:75], a[48:51], a[168:171], v[72:75]
buffer_load_dwordx4 v8, s[12:15], s24 offen offset:2048 lds
M v[72:75], a[52:55], a[172:175], v[72:75]
M v[76:79], a[60:63], a[172:175], v[76:79]
M v[76:79], a[56:59], a[168:171], v[76:79]
ds_read_b64_tr_b16 a[136:137], v17 offset:32768
ds_read_b64_tr_b16 a[138:139], v17 offset:34816
M v[80:83], a[64:67], a[168:171], v[80:83]
M v[80:83], a[68:71], a[172:175], v[80:83]
M v[84:87], a[76:79], a[172:175], v[84:87]
buffer_load_dwordx4 v9, s[12:15], s24 offen offset:3072 lds
M v[84:87], a[72:75], a[168:171], v[84:87]
ds_read_b64_tr_b16 a[144:145], v18 offset:32768
ds_read_b64_tr_b16 a[146:147], v18 offset:34816
M v[88:91], a[80:83], a[168:171], v[88:91]
M v[88:91], a[84:87], a[172:175], v[88:91]
M v[92:95], a[92:95], a[172:175], v[92:95]
M v[92:95], a[88:91], a[168:171], v[92:95]
s_waitcnt lgkmcnt(15)
ds_read_b64_tr_b16 a[152:153], v19 offset:32768
ds_read_b64_tr_b16 a[154:155], v19 offset:34816
M v[96:99], a[32:35], a[176:179], v[96:99]
s_add_u32 s24, s24, 262144
s_cmp_eq_u32 s24, s27
s_cselect_b32 s24, s28, s24
s_sub_u32 s6, s6, 1
s_cmp_eq_u32 s6, 0
s_cselect_b64 s[12:13], s[64:65], s[12:13]
M v[96:99], a[36:39], a[180:183], v[96:99]
M v[100:103], a[44:47], a[180:183], v[100:103]
M v[100:103], a[40:43], a[176:179], v[100:103]
M v[104:107], a[48:51], a[176:179], v[104:107]
M v[104:107], a[52:55], a[180:183], v[104:107]
M v[108:111], a[60:63], a[180:183], v[108:111]
M v[108:111], a[56:59], a[176:179], v[108:111]
s_waitcnt vmcnt(17) lgkmcnt(0)
s_barrier
ds_read_b128 a[160:163], v10 offset:16384
ds_read_b128 a[164:167], v11 offset:16384
M v[112:115], a[64:67], a[176:179], v[112:115]
s_add_u32 m0, s29, 0
s_nop 0
buffer_load_dwordx4 v2, s[8:11], s23 offen offset:0 lds
M v[112:115], a[68:71], a[180:183], v[112:115]
M v[116:119], a[76:79], a[180:183], v[116:119]
M v[116:119], a[72:75], a[176:179], v[116:119]
ds_read_b64_tr_b16 a[100:101], v12 offset:49152
ds_read_b64_tr_b16 a[102:103], v12 offset:51200
M v[120:123], a[80:83], a[176:179], v[120:123]
M v[120:123], a[84:87], a[180:183], v[120:123]
M v[124:127], a[92:95], a[180:183], v[124:127]
buffer_load_dwordx4 v3, s[8:11], s23 offen offset:1024 lds
M v[124:127], a[88:91], a[176:179], v[124:127]
M v[128:131], a[32:35], a[184:187], v[128:131]
M v[128:131], a[36:39], a[188:191], v[128:131]
ds_read_b128 a[168:171], v10 offset:18432
ds_read_b128 a[172:175], v11 offset:18432
ds_read_b64_tr_b16 a[108:109], v13 offset:49152
ds_read_b64_tr_b16 a[110:111], v13 offset:51200
M v[132:135], a[44:47], a[188:191], v[132:135]
M v[132:135], a[40:43], a[184:187], v[132:135]
M v[136:139], a[48:51], a[184:187], v[136:139]
M v[136:139], a[52:55], a[188:191], v[136:139]
buffer_load_dwordx4 v4, s[8:11], s23 offen offset:2048 lds
M v[140:143], a[60:63], a[188:191], v[140:143]
M v[140:143], a[56:59], a[184:187], v[140:143]
ds_read_b64_tr_b16 a[116:117], v14 offset:49152
ds_read_b64_tr_b16 a[118:119], v14 offset:51200
M v[144:147], a[64:67], a[184:187], v[144:147]
M v[144:147], a[68:71], a[188:191], v[144:147]
M v[148:151], a[76:79], a[188:191], v[148:151]
M v[148:151], a[72:75], a[184:187], v[148:151]
M v[152:155], a[80:83], a[184:187], v[152:155]
buffer_load_dwordx4 v5, s[8:11], s23 offen offset:3072 lds
M v[152:155], a[84:87], a[188:191], v[152:155]
ds_read_b64_tr_b16 a[124:125], v15 offset:49152
ds_read_b64_tr_b16 a[126:127], v15 offset:51200
M v[156:159], a[92:95], a[188:191], v[156:159]
M v[156:159], a[88:91], a[184:187], v[156:159]
s_waitcnt lgkmcnt(10)
M v[160:163], a[32:35], a[160:163], v[160:163]
M v[160:163], a[36:39], a[164:167], v[160:163]
ds_read_b128 a[176:179], v10 offset:20480
ds_read_b128 a[180:183], v11 offset:20480
M v[164:167], a[44:47], a[164:167], v[164:167]
M v[164:167], a[40:43], a[160:163], v[164:167]
ds_read_b64_tr_b16 a[132:133], v16 offset:49152
ds_read_b64_tr_b16 a[134:135], v16 offset:51200
M v[168:171], a[48:51], a[160:163], v[168:171]
M v[168:171], a[52:55], a[164:167], v[168:171]
s_add_u32 m0, s29, 98304
s_nop 0
buffer_load_dwordx4 v6, s[12:15], s24 offen offset:0 lds
M v[172:175], a[60:63], a[164:167], v[172:175]
M v[172:175], a[56:59], a[160:163], v[172:175]
M v[176:179], a[64:67], a[160:163], v[176:179]
M v[176:179], a[68:71], a[164:167], v[176:179]
ds_read_b64_tr_b16 a[140:141], v17 offset:49152
ds_read_b64_tr_b16 a[142:143], v17 offset:51200
M v[180:183], a[76:79], a[164:167], v[180:183]
M v[180:183], a[72:75], a[160:163], v[180:183]
buffer_load_dwordx4 v7, s[12:15], s24 offen offset:1024 lds
M v[184:187], a[80:83], a[160:163], v[184:187]
M v[184:187], a[84:87], a[164:167], v[184:187]
M v[188:191], a[92:95], a[164:167], v[188:191]
M v[188:191], a[88:91], a[160:163], v[188:191]
s_waitcnt lgkmcnt(12)
ds_read_b64_tr_b16 a[148:149], v18 offset:49152
ds_read_b64_tr_b16 a[150:151], v18 offset:51200
M v[192:195], a[32:35], a[168:171], v[192:195]
M v[192:195], a[36:39], a[172:175], v[192:195]
ds_read_b128 a[184:187], v10 offset:22528
ds_read_b128 a[188:191], v11 offset:22528
M v[196:199], a[44:47], a[172:175], v[196:199]
M v[196:199], a[40:43], a[168:171], v[196:199]
buffer_load_dwordx4 v8, s[12:15], s24 offen offset:2048 lds
M v[200:203], a[48:51], a[168:171], v[200:203]
M v[200:203], a[52:55], a[172:175], v[200:203]
ds_read_b64_tr_b16 a[156:157], v19 offset:49152
ds_read_b64_tr_b16 a[158:159], v19 offset:51200
M v[204:207], a[60:63], a[172:175], v[204:207]
M v[204:207], a[56:59], a[168:171], v[204:207]
M v[208:211], a[64:67], a[168:171], v[208:211]
M v[208:211], a[68:71], a[172:175], v[208:211]
buffer_load_dwordx4 v9, s[12:15], s24 offen offset:3072 lds
M v[212:215], a[76:79], a[172:175], v[212:215]
M v[212:215], a[72:75], a[168:171], v[212:215]
M v[216:219], a[80:83], a[168:171], v[216:219]
M v[216:219], a[84:87], a[172:175], v[216:219]
M v[220:223], a[92:95], a[172:175], v[220:223]
s_add_u32 s24, s24, 262144
M v[220:223], a[88:91], a[168:171], v[220:223]
s_waitcnt lgkmcnt(10)
M v[224:227], a[32:35], a[176:179], v[224:227]
M v[224:227], a[36:39], a[180:183], v[224:227]
M v[228:231], a[44:47], a[180:183], v[228:231]
M v[228:231], a[40:43], a[176:179], v[228:231]
M v[232:235], a[48:51], a[176:179], v[232:235]
M v[232:235], a[52:55], a[180:183], v[232:235]
M v[236:239], a[60:63], a[180:183], v[236:239]
M v[236:239], a[56:59], a[176:179], v[236:239]
s_waitcnt vmcnt(17) lgkmcnt(0)
s_barrier
ds_read_b128 a[160:163], v10 offset:32768
ds_read_b128 a[164:167], v11 offset:32768
M v[240:243], a[64:67], a[176:179], v[240:243]
s_add_u32 m0, s29, 16384
s_add_u32 s3, s23, s31
buffer_load_dwordx4 v2, s[8:11], s3 offen offset:0 lds
M v[240:243], a[68:71], a[180:183], v[240:243]
M v[244:247], a[76:79], a[180:183], v[244:247]
M v[244:247], a[72:75], a[176:179], v[244:247]
M v[248:251], a[80:83], a[176:179], v[248:251]
M v[248:251], a[84:87], a[180:183], v[248:251]
buffer_load_dwordx4 v3, s[8:11], s3 offen offset:1024 lds
M v[252:255], a[92:95], a[180:183], v[252:255]
M v[252:255], a[88:91], a[176:179], v[252:255]
M a[0:3], a[32:35], a[184:187], a[0:3]
M a[0:3], a[36:39], a[188:191], a[0:3]
ds_read_b128 a[168:171], v10 offset:34816
ds_read_b128 a[172:175], v11 offset:34816
M a[4:7], a[44:47], a[188:191], a[4:7]
M a[4:7], a[40:43], a[184:187], a[4:7]
M a[8:11], a[48:51], a[184:187], a[8:11]
buffer_load_dwordx4 v4, s[8:11], s3 offen offset:2048 lds
M a[8:11], a[52:55], a[188:191], a[8:11]
M a[12:15], a[60:63], a[188:191], a[12:15]
M a[12:15], a[56:59], a[184:187], a[12:15]
M a[16:19], a[64:67], a[184:187], a[16:19]
M a[16:19], a[68:71], a[188:191], a[16:19]
buffer_load_dwordx4 v5, s[8:11], s3 offen offset:3072 lds
M a[20:23], a[76:79], a[188:191], a[20:23]
M a[20:23], a[72:75], a[184:187], a[20:23]
M a[24:27], a[80:83], a[184:187], a[24:27]
M a[24:27], a[84:87], a[188:191], a[24:27]
M a[28:31], a[92:95], a[188:191], a[28:31]
M a[28:31], a[88:91], a[184:187], a[28:31]
s_waitcnt lgkmcnt(2)
M v[32:35], a[96:99], a[160:163], v[32:35]
s_add_u32 s23, s23, 128
s_cmp_eq_u32 s23, s25
s_cselect_b32 s23, s26, s23
M v[32:35], a[100:103], a[164:167], v[32:35]
ds_read_b128 a[176:179], v10 offset:36864
ds_read_b128 a[180:183], v11 offset:36864
M v[36:39], a[108:111], a[164:167], v[36:39]
M v[36:39], a[104:107], a[160:163], v[36:39]
ds_read_b64_tr_b16 a[32:33], v12 offset:0
ds_read_b64_tr_b16 a[34:35], v12 offset:2048
M v[40:43], a[112:115], a[160:163], v[40:43]
M v[40:43], a[116:119], a[164:167], v[40:43]
M v[44:47], a[124:127], a[164:167], v[44:47]
s_add_u32 m0, s29, 114688
s_nop 0
buffer_load_dwordx4 v6, s[12:15], s24 offen offset:0 lds
M v[44:47], a[120:123], a[160:163], v[44:47]
ds_read_b64_tr_b16 a[40:41], v13 offset:0
ds_read_b64_tr_b16 a[42:43], v13 offset:2048
M v[48:51], a[128:131], a[160:163], v[48:51]
M v[48:51], a[132:135], a[164:167], v[48:51]
M v[52:55], a[140:143], a[164:167], v[52:55]
M v[52:55], a[136:139], a[160:163], v[52:55]
ds_read_b64_tr_b16 a[48:49], v14 offset:0
ds_read_b64_tr_b16 a[50:51], v14 offset:2048
M v[56:59], a[144:147], a[160:163], v[56:59]
M v[56:59], a[148:151], a[164:167], v[56:59]
buffer_load_dwordx4 v7, s[12:15], s24 offen offset:1024 lds
M v[60:63], a[156:159], a[164:167], v[60:63]
M v[60:63], a[152:155], a[160:163], v[60:63]
s_waitcnt lgkmcnt(8)
ds_read_b64_tr_b16 a[56:57], v15 offset:0
ds_read_b64_tr_b16 a[58:59], v15 offset:2048
M v[64:67], a[96:99], a[168:171], v[64:67]
M v[64:67], a[100:103], a[172:175], v[64:67]
ds_read_b128 a[184:187], v10 offset:38912
ds_read_b128 a[188:191], v11 offset:38912
M v[68:71], a[108:111], a[172:175], v[68:71]
M v[68:71], a[104:107], a[168:171], v[68:71]
ds_read_b64_tr_b16 a[64:65], v16 offset:0
ds_read_b64_tr_b16 a[66:67], v16 offset:2048
M v[72:75], a[112:115], a[168:171], v[72:75]
buffer_load_dwordx4 v8, s[12:15], s24 offen offset:2048 lds
M v[72:75], a[116:119], a[172:175], v[72:75]
M v[76:79], a[124:127], a[172:175], v[76:79]
M v[76:79], a[120:123], a[168:171], v[76:79]
ds_read_b64_tr_b16 a[72:73], v17 offset:0
ds_read_b64_tr_b16 a[74:75], v17 offset:2048
M v[80:83], a[128:131], a[168:171], v[80:83]
M v[80:83], a[132:135], a[172:175], v[80:83]
M v[84:87], a[140:143], a[172:175], v[84:87]
buffer_load_dwordx4 v9, s[12:15], s24 offen offset:3072 lds
M v[84:87], a[136:139], a[168:171], v[84:87]
ds_read_b64_tr_b16 a[80:81], v18 offset:0
ds_read_b64_tr_b16 a[82:83], v18 offset:2048
M v[88:91], a[144:147], a[168:171], v[88:91]
M v[88:91], a[148:151], a[172:175], v[88:91]
M v[92:95], a[156:159], a[172:175], v[92:95]
M v[92:95], a[152:155], a[168:171], v[92:95]
s_waitcnt lgkmcnt(15)
ds_read_b64_tr_b16 a[88:89], v19 offset:0
ds_read_b64_tr_b16 a[90:91], v19 offset:2048
M v[96:99], a[96:99], a[176:179], v[96:99]
s_add_u32 s24, s24, 262144
s_cmp_eq_u32 s24, s27
s_cselect_b32 s24, s28, s24
s_sub_u32 s6, s6, 1
s_cmp_eq_u32 s6, 0
s_cselect_b64 s[12:13], s[64:65], s[12:13]
M v[96:99], a[100:103], a[180:183], v[96:99]
M v[100:103], a[108:111], a[180:183], v[100:103]
M v[100:103], a[104:107], a[176:179], v[100:103]
M v[104:107], a[112:115], a[176:179], v[104:107]
M v[104:107], a[116:119], a[180:183], v[104:107]
M v[108:111], a[124:127], a[180:183], v[108:111]
M v[108:111], a[120:123], a[176:179], v[108:111]
s_waitcnt vmcnt(16) lgkmcnt(0)
s_barrier
ds_read_b128 a[160:163], v10 offset:49152
ds_read_b128 a[164:167], v11 offset:49152
M v[112:115], a[128:131], a[176:179], v[112:115]
s_add_u32 m0, s29, 32768
s_nop 0
buffer_load_dwordx4 v2, s[8:11], s23 offen offset:0 lds
M v[112:115], a[132:135], a[180:183], v[112:115]
M v[116:119], a[140:143], a[180:183], v[116:119]
M v[116:119], a[136:139], a[176:179], v[116:119]
ds_read_b64_tr_b16 a[36:37], v12 offset:16384
ds_read_b64_tr_b16 a[38:39], v12 offset:18432
M v[120:123], a[144:147], a[176:179], v[120:123]
M v[120:123], a[148:151], a[180:183], v[120:123]
M v[124:127], a[156:159], a[180:183], v[124:127]
M v[124:127], a[152:155], a[176:179], v[124:127]
M v[128:131], a[96:99], a[184:187], v[128:131]
M v[128:131], a[100:103], a[188:191], v[128:131]
ds_read_b128 a[168:171], v10 offset:51200
ds_read_b128 a[172:175], v11 offset:51200
ds_read_b64_tr_b16 a[44:45], v13 offset:16384
ds_read_b64_tr_b16 a[46:47], v13 offset:18432
M v[132:135], a[108:111], a[188:191], v[132:135]
M v[132:135], a[104:107], a[184:187], v[132:135]
M v[136:139], a[112:115], a[184:187], v[136:139]
M v[136:139], a[116:119], a[188:191], v[136:139]
M v[140:143], a[124:127], a[188:191], v[140:143]
M v[140:143], a[120:123], a[184:187], v[140:143]
ds_read_b64_tr_b16 a[52:53], v14 offset:16384
ds_read_b64_tr_b16 a[54:55], v14 offset:18432
M v[144:147], a[128:131], a[184:187], v[144:147]
buffer_load_dwordx4 v3, s[8:11], s23 offen offset:1024 lds
M v[144:147], a[132:135], a[188:191], v[144:147]
M v[148:151], a[140:143], a[188:191], v[148:151]
M v[148:151], a[136:139], a[184:187], v[148:151]
M v[152:155], a[144:147], a[184:187], v[152:155]
M v[152:155], a[148:151], a[188:191], v[152:155]
ds_read_b64_tr_b16 a[60:61], v15 offset:16384
ds_read_b64_tr_b16 a[62:63], v15 offset:18432
M v[156:159], a[156:159], a[188:191], v[156:159]
M v[156:159], a[152:155], a[184:187], v[156:159]
s_waitcnt lgkmcnt(10)
M v[160:163], a[96:99], a[160:163], v[160:163]
M v[160:163], a[100:103], a[164:167], v[160:163]
ds_read_b128 a[176:179], v10 offset:53248
ds_read_b128 a[180:183], v11 offset:53248
M v[164:167], a[108:111], a[164:167], v[164:167]
M v[164:167], a[104:107], a[160:163], v[164:167]
ds_read_b64_tr_b16 a[68:69], v16 offset:16384
ds_read_b64_tr_b16 a[70:71], v16 offset:18432
M v[168:171], a[112:115], a[160:163], v[168:171]
M v[168:171], a[116:119], a[164:167], v[168:171]
M v[172:175], a[124:127], a[164:167], v[172:175]
M v[172:175], a[120:123], a[160:163], v[172:175]
M v[176:179], a[128:131], a[160:163], v[176:179]
buffer_load_dwordx4 v4, s[8:11], s23 offen offset:2048 lds
M v[176:179], a[132:135], a[164:167], v[176:179]
ds_read_b64_tr_b16 a[76:77], v17 offset:16384
ds_read_b64_tr_b16 a[78:79], v17 offset:18432
M v[180:183], a[140:143], a[164:167], v[180:183]
M v[180:183], a[136:139], a[160:163], v[180:183]
M v[184:187], a[144:147], a[160:163], v[184:187]
M v[184:187], a[148:151], a[164:167], v[184:187]
M v[188:191], a[156:159], a[164:167], v[188:191]
M v[188:191], a[152:155], a[160:163], v[188:191]
s_waitcnt lgkmcnt(12)
ds_read_b64_tr_b16 a[84:85], v18 offset:16384
ds_read_b64_tr_b16 a[86:87], v18 offset:18432
M v[192:195], a[96:99], a[168:171], v[192:195]
M v[192:195], a[100:103], a[172:175], v[192:195]
ds_read_b128 a[184:187], v10 offset:55296
ds_read_b128 a[188:191], v11 offset:55296
M v[196:199], a[108:111], a[172:175], v[196:199]
M v[196:199], a[104:107], a[168:171], v[196:199]
M v[200:203], a[112:115], a[168:171], v[200:203]
M v[200:203], a[116:119], a[172:175], v[200:203]
ds_read_b64_tr_b16 a[92:93], v19 offset:16384
ds_read_b64_tr_b16 a[94:95], v19 offset:18432
M v[204:207], a[124:127], a[172:175], v[204:207]
M v[204:207], a[120:123], a[168:171], v[204:207]
M v[208:211], a[128:131], a[168:171], v[208:211]
buffer_load_dwordx4 v5, s[8:11], s23 offen offset:3072 lds
M v[208:211], a[132:135], a[172:175], v[208:211]
M v[212:215], a[140:143], a[172:175], v[212:215]
M v[212:215], a[136:139], a[168:171], v[212:215]
M v[216:219], a[144:147], a[168:171], v[216:219]
M v[216:219], a[148:151], a[172:175], v[216:219]
M v[220:223], a[156:159], a[172:175], v[220:223]
M v[220:223], a[152:155], a[168:171], v[220:223]
s_waitcnt lgkmcnt(10)
M v[224:227], a[96:99], a[176:179], v[224:227]
M v[224:227], a[100:103], a[180:183], v[224:227]
M v[228:231], a[108:111], a[180:183], v[228:231]
M v[228:231], a[104:107], a[176:179], v[228:231]
M v[232:235], a[112:115], a[176:179], v[232:235]
M v[232:235], a[116:119], a[180:183], v[232:235]
M v[236:239], a[124:127], a[180:183], v[236:239]
M v[236:239], a[120:123], a[176:179], v[236:239]
s_waitcnt vmcnt(12) lgkmcnt(0)
s_barrier
ds_read_b128 a[160:163], v10 offset:0
ds_read_b128 a[164:167], v11 offset:0
M v[240:243], a[128:131], a[176:179], v[240:243]
s_add_u32 m0, s29, 49152
s_add_u32 s3, s23, s31
buffer_load_dwordx4 v2, s[8:11], s3 offen offset:0 lds
M v[240:243], a[132:135], a[180:183], v[240:243]
M v[244:247], a[140:143], a[180:183], v[244:247]
M v[244:247], a[136:139], a[176:179], v[244:247]
M v[248:251], a[144:147], a[176:179], v[248:251]
M v[248:251], a[148:151], a[180:183], v[248:251]
M v[252:255], a[156:159], a[180:183], v[252:255]
M v[252:255], a[152:155], a[176:179], v[252:255]
M a[0:3], a[96:99], a[184:187], a[0:3]
M a[0:3], a[100:103], a[188:191], a[0:3]
ds_read_b128 a[168:171], v10 offset:2048
ds_read_b128 a[172:175], v11 offset:2048
M a[4:7], a[108:111], a[188:191], a[4:7]
M a[4:7], a[104:107], a[184:187], a[4:7]
M a[8:11], a[112:115], a[184:187], a[8:11]
buffer_load_dwordx4 v3, s[8:11], s3 offen offset:1024 lds
M a[8:11], a[116:119], a[188:191], a[8:11]
M a[12:15], a[124:127], a[188:191], a[12:15]
M a[12:15], a[120:123], a[184:187], a[12:15]
M a[16:19], a[128:131], a[184:187], a[16:19]
M a[16:19], a[132:135], a[188:191], a[16:19]
M a[20:23], a[140:143], a[188:191], a[20:23]
M a[20:23], a[136:139], a[184:187], a[20:23]
M a[24:27], a[144:147], a[184:187], a[24:27]
M a[24:27], a[148:151], a[188:191], a[24:27]
M a[28:31], a[156:159], a[188:191], a[28:31]
M a[28:31], a[152:155], a[184:187], a[28:31]
s_waitcnt lgkmcnt(2)
M v[32:35], a[32:35], a[160:163], v[32:35]
buffer_load_dwordx4 v4, s[8:11], s3 offen offset:2048 lds
M v[32:35], a[36:39], a[164:167], v[32:35]
ds_read_b128 a[176:179], v10 offset:4096
ds_read_b128 a[180:183], v11 offset:4096
M v[36:39], a[44:47], a[164:167], v[36:39]
M v[36:39], a[40:43], a[160:163], v[36:39]
ds_read_b64_tr_b16 a[96:97], v12 offset:32768
ds_read_b64_tr_b16 a[98:99], v12 offset:34816
M v[40:43], a[48:51], a[160:163], v[40:43]
M v[40:43], a[52:55], a[164:167], v[40:43]
M v[44:47], a[60:63], a[164:167], v[44:47]
M v[44:47], a[56:59], a[160:163], v[44:47]
ds_read_b64_tr_b16 a[104:105], v13 offset:32768
ds_read_b64_tr_b16 a[106:107], v13 offset:34816
M v[48:51], a[64:67], a[160:163], v[48:51]
M v[48:51], a[68:71], a[164:167], v[48:51]
M v[52:55], a[76:79], a[164:167], v[52:55]
M v[52:55], a[72:75], a[160:163], v[52:55]
ds_read_b64_tr_b16 a[112:113], v14 offset:32768
ds_read_b64_tr_b16 a[114:115], v14 offset:34816
M v[56:59], a[80:83], a[160:163], v[56:59]
M v[56:59], a[84:87], a[164:167], v[56:59]
buffer_load_dwordx4 v5, s[8:11], s3 offen offset:3072 lds
M v[60:63], a[92:95], a[164:167], v[60:63]
M v[60:63], a[88:91], a[160:163], v[60:63]
s_waitcnt lgkmcnt(8)
ds_read_b64_tr_b16 a[120:121], v15 offset:32768
ds_read_b64_tr_b16 a[122:123], v15 offset:34816
M v[64:67], a[32:35], a[168:171], v[64:67]
M v[64:67], a[36:39], a[172:175], v[64:67]
ds_read_b128 a[184:187], v10 offset:6144
ds_read_b128 a[188:191], v11 offset:6144
M v[68:71], a[44:47], a[172:175], v[68:71]
M v[68:71], a[40:43], a[168:171], v[68:71]
ds_read_b64_tr_b16 a[128:129], v16 offset:32768
ds_read_b64_tr_b16 a[130:131], v16 offset:34816
M v[72:75], a[48:51], a[168:171], v[72:75]
M v[72:75], a[52:55], a[172:175], v[72:75]
M v[76:79], a[60:63], a[172:175], v[76:79]
M v[76:79], a[56:59], a[168:171], v[76:79]
ds_read_b64_tr_b16 a[136:137], v17 offset:32768
ds_read_b64_tr_b16 a[138:139], v17 offset:34816
M v[80:83], a[64:67], a[168:171], v[80:83]
M v[80:83], a[68:71], a[172:175], v[80:83]
M v[84:87], a[76:79], a[172:175], v[84:87]
s_add_u32 s23, s23, 128
s_cmp_eq_u32 s23, s25
s_cselect_b32 s23, s26, s23
M v[84:87], a[72:75], a[168:171], v[84:87]
ds_read_b64_tr_b16 a[144:145], v18 offset:32768
ds_read_b64_tr_b16 a[146:147], v18 offset:34816
M v[88:91], a[80:83], a[168:171], v[88:91]
M v[88:91], a[84:87], a[172:175], v[88:91]
M v[92:95], a[92:95], a[172:175], v[92:95]
M v[92:95], a[88:91], a[168:171], v[92:95]
s_waitcnt lgkmcnt(15)
ds_read_b64_tr_b16 a[152:153], v19 offset:32768
ds_read_b64_tr_b16 a[154:155], v19 offset:34816
M v[96:99], a[32:35], a[176:179], v[96:99]
M v[96:99], a[36:39], a[180:183], v[96:99]
M v[100:103], a[44:47], a[180:183], v[100:103]
M v[100:103], a[40:43], a[176:179], v[100:103]
M v[104:107], a[48:51], a[176:179], v[104:107]
M v[104:107], a[52:55], a[180:183], v[104:107]
M v[108:111], a[60:63], a[180:183], v[108:111]
M v[108:111], a[56:59], a[176:179], v[108:111]
s_waitcnt vmcnt(8) lgkmcnt(0)
s_barrier
ds_read_b128 a[160:163], v10 offset:16384
ds_read_b128 a[164:167], v11 offset:16384
M v[112:115], a[64:67], a[176:179], v[112:115]
M v[112:115], a[68:71], a[180:183], v[112:115]
s_and_b32 s3, s2, 1
s_lshl_b32 s3, s3, 3
s_bfe_u32 s4, s2, 0x30003
M v[116:119], a[76:79], a[180:183], v[116:119]
s_add_u32 s26, s3, s4
s_bfe_u32 s3, s2, 0x20001
M v[116:119], a[72:75], a[176:179], v[116:119]
ds_read_b64_tr_b16 a[100:101], v12 offset:49152
ds_read_b64_tr_b16 a[102:103], v12 offset:51200
s_lshl_b32 s3, s3, 2
s_lshr_b32 s4, s2, 6
s_add_u32 s27, s3, s4
M v[120:123], a[80:83], a[176:179], v[120:123]
s_lshl_b32 s23, s26, 18
s_sub_u32 s24, s23, 32768
M v[120:123], a[84:87], a[180:183], v[120:123]
s_max_i32 s24, s24, 0
s_lshl_b32 s25, s27, 7
s_xor_b32 s3, s26, s27
M v[124:127], a[92:95], a[180:183], v[124:127]
s_and_b32 s3, s3, 0
s_lshl_b32 s3, s3, 3
M v[124:127], a[88:91], a[176:179], v[124:127]
s_sub_u32 s31, 16, s3
s_mov_b32 s54, s31
s_movk_i32 s57, 128
M v[128:131], a[32:35], a[184:187], v[128:131]
s_mov_b32 s55, 4289069056
s_mov_b32 s56, 393216
M v[128:131], a[36:39], a[188:191], v[128:131]
ds_read_b128 a[168:171], v10 offset:18432
ds_read_b128 a[172:175], v11 offset:18432
ds_read_b64_tr_b16 a[108:109], v13 offset:49152
ds_read_b64_tr_b16 a[110:111], v13 offset:51200
s_lshl_b32 s4, s3, 7
s_add_u32 s23, s23, s4
s_add_u32 s24, s24, s4
M v[132:135], a[44:47], a[188:191], v[132:135]
s_mul_i32 s4, s3, 393216
s_add_u32 s25, s25, s4
M v[132:135], a[40:43], a[184:187], v[132:135]
s_mov_b64 s[8:9], s[44:45]
s_mov_b32 s10, 4194304
s_mov_b64 s[12:13], s[46:47]
M v[136:139], a[48:51], a[184:187], v[136:139]
s_mov_b32 s14, 6291456
s_mov_b64 s[60:61], s[90:91]
M v[136:139], a[52:55], a[188:191], v[136:139]
s_mov_b32 s62, 256
s_mov_b32 s63, 0x00020000
s_lshl_b32 s28, s20, 9
M v[140:143], a[60:63], a[188:191], v[140:143]
s_mul_i32 s30, s20, 6144
s_lshl_b32 s3, s20, 5
M v[140:143], a[56:59], a[184:187], v[140:143]
ds_read_b64_tr_b16 a[116:117], v14 offset:49152
ds_read_b64_tr_b16 a[118:119], v14 offset:51200
v_lshrrev_b32 v24, 3, v0
v_and_b32 v25, 7, v0
v_add_u32 v28, s3, v24
M v[144:147], a[64:67], a[184:187], v[144:147]
v_add_u32 v26, 0, v28
v_bfe_u32 v27, v26, 1, 3
M v[144:147], a[68:71], a[188:191], v[144:147]
v_xor_b32 v27, v27, v25
v_lshlrev_b32 v26, 11, v26
v_lshl_add_u32 v26, v27, 4, v26
M v[148:151], a[76:79], a[188:191], v[148:151]
v_subrev_u32 v2, 0, v26
v_add_u32 v26, 8, v28
M v[148:151], a[72:75], a[184:187], v[148:151]
v_bfe_u32 v27, v26, 1, 3
v_xor_b32 v27, v27, v25
v_lshlrev_b32 v26, 11, v26
M v[152:155], a[80:83], a[184:187], v[152:155]
v_lshl_add_u32 v26, v27, 4, v26
v_subrev_u32 v3, 1024, v26
M v[152:155], a[84:87], a[188:191], v[152:155]
ds_read_b64_tr_b16 a[124:125], v15 offset:49152
ds_read_b64_tr_b16 a[126:127], v15 offset:51200
v_add_u32 v26, 16, v28
v_bfe_u32 v27, v26, 1, 3
v_xor_b32 v27, v27, v25
M v[156:159], a[92:95], a[188:191], v[156:159]
v_lshlrev_b32 v26, 11, v26
v_lshl_add_u32 v26, v27, 4, v26
M v[156:159], a[88:91], a[184:187], v[156:159]
s_waitcnt lgkmcnt(10)
v_subrev_u32 v4, 2048, v26
v_add_u32 v26, 24, v28
v_bfe_u32 v27, v26, 1, 3
M v[160:163], a[32:35], a[160:163], v[160:163]
v_xor_b32 v27, v27, v25
v_lshlrev_b32 v26, 11, v26
M v[160:163], a[36:39], a[164:167], v[160:163]
ds_read_b128 a[176:179], v10 offset:20480
ds_read_b128 a[180:183], v11 offset:20480
v_lshl_add_u32 v26, v27, 4, v26
v_subrev_u32 v5, 3072, v26
s_lshl_b32 s3, s20, 2
M v[164:167], a[44:47], a[164:167], v[164:167]
v_add_u32 v26, s3, v24
v_bfe_u32 v27, v26, 1, 3
M v[164:167], a[40:43], a[160:163], v[164:167]
ds_read_b64_tr_b16 a[132:133], v16 offset:49152
ds_read_b64_tr_b16 a[134:135], v16 offset:51200
v_xor_b32 v27, v27, v25
v_lshlrev_b32 v26, 11, v26
v_lshl_add_u32 v20, v27, 4, v26
M v[168:171], a[48:51], a[160:163], v[168:171]
s_mul_i32 s3, s20, 48
v_add_u32 v28, s3, v24
M v[168:171], a[52:55], a[164:167], v[168:171]
v_add_u32 v26, 0, v28
v_mul_u32_u24 v27, 0xaaab, v26
v_lshrrev_b32 v27, 17, v27
M v[172:175], a[60:63], a[164:167], v[172:175]
v_lshrrev_b32 v29, 1, v27
v_and_b32 v29, 4, v29
M v[172:175], a[56:59], a[160:163], v[172:175]
v_and_or_b32 v27, v27, 2, v29
v_xor_b32 v27, v27, v25
v_lshlrev_b32 v26, 11, v26
M v[176:179], a[64:67], a[160:163], v[176:179]
v_lshl_add_u32 v26, v27, 4, v26
v_subrev_u32 v6, 0, v26
M v[176:179], a[68:71], a[164:167], v[176:179]
ds_read_b64_tr_b16 a[140:141], v17 offset:49152
ds_read_b64_tr_b16 a[142:143], v17 offset:51200
v_add_u32 v26, 8, v28
v_mul_u32_u24 v27, 0xaaab, v26
v_lshrrev_b32 v27, 17, v27
M v[180:183], a[76:79], a[164:167], v[180:183]
v_lshrrev_b32 v29, 1, v27
v_and_b32 v29, 4, v29
M v[180:183], a[72:75], a[160:163], v[180:183]
v_and_or_b32 v27, v27, 2, v29
v_xor_b32 v27, v27, v25
v_lshlrev_b32 v26, 11, v26
M v[184:187], a[80:83], a[160:163], v[184:187]
v_lshl_add_u32 v26, v27, 4, v26
v_subrev_u32 v7, 1024, v26
M v[184:187], a[84:87], a[164:167], v[184:187]
v_add_u32 v26, 16, v28
v_mul_u32_u24 v27, 0xaaab, v26
v_lshrrev_b32 v27, 17, v27
M v[188:191], a[92:95], a[164:167], v[188:191]
v_lshrrev_b32 v29, 1, v27
v_and_b32 v29, 4, v29
M v[188:191], a[88:91], a[160:163], v[188:191]
s_waitcnt lgkmcnt(12)
ds_read_b64_tr_b16 a[148:149], v18 offset:49152
ds_read_b64_tr_b16 a[150:151], v18 offset:51200
v_and_or_b32 v27, v27, 2, v29
v_xor_b32 v27, v27, v25
v_lshlrev_b32 v26, 11, v26
M v[192:195], a[32:35], a[168:171], v[192:195]
v_lshl_add_u32 v26, v27, 4, v26
v_subrev_u32 v8, 2048, v26
M v[192:195], a[36:39], a[172:175], v[192:195]
ds_read_b128 a[184:187], v10 offset:22528
ds_read_b128 a[188:191], v11 offset:22528
v_add_u32 v26, 24, v28
v_mul_u32_u24 v27, 0xaaab, v26
v_lshrrev_b32 v27, 17, v27
M v[196:199], a[44:47], a[172:175], v[196:199]
v_lshrrev_b32 v29, 1, v27
v_and_b32 v29, 4, v29
M v[196:199], a[40:43], a[168:171], v[196:199]
v_and_or_b32 v27, v27, 2, v29
v_xor_b32 v27, v27, v25
v_lshlrev_b32 v26, 11, v26
M v[200:203], a[48:51], a[168:171], v[200:203]
v_lshl_add_u32 v26, v27, 4, v26
v_subrev_u32 v9, 3072, v26
M v[200:203], a[52:55], a[172:175], v[200:203]
ds_read_b64_tr_b16 a[156:157], v19 offset:49152
ds_read_b64_tr_b16 a[158:159], v19 offset:51200
v_add_u32 v26, 32, v28
v_mul_u32_u24 v27, 0xaaab, v26
v_lshrrev_b32 v27, 17, v27
M v[204:207], a[60:63], a[172:175], v[204:207]
v_lshrrev_b32 v29, 1, v27
v_and_b32 v29, 4, v29
M v[204:207], a[56:59], a[168:171], v[204:207]
v_and_or_b32 v27, v27, 2, v29
v_xor_b32 v27, v27, v25
v_lshlrev_b32 v26, 11, v26
M v[208:211], a[64:67], a[168:171], v[208:211]
v_lshl_add_u32 v26, v27, 4, v26
v_subrev_u32 v21, 0, v26
M v[208:211], a[68:71], a[172:175], v[208:211]
v_add_u32 v26, 40, v28
v_mul_u32_u24 v27, 0xaaab, v26
v_lshrrev_b32 v27, 17, v27
M v[212:215], a[76:79], a[172:175], v[212:215]
v_lshrrev_b32 v29, 1, v27
v_and_b32 v29, 4, v29
M v[212:215], a[72:75], a[168:171], v[212:215]
v_and_or_b32 v27, v27, 2, v29
v_xor_b32 v27, v27, v25
v_lshlrev_b32 v26, 11, v26
M v[216:219], a[80:83], a[168:171], v[216:219]
v_lshl_add_u32 v26, v27, 4, v26
v_subrev_u32 v22, 1024, v26
M v[216:219], a[84:87], a[172:175], v[216:219]
s_lshr_b32 s3, s53, 7
s_add_u32 s3, s3, s22
s_lshl_b32 s3, s3, 5
M v[220:223], a[92:95], a[172:175], v[220:223]
s_lshr_b32 s19, s52, 6
s_add_u32 s3, s3, s19
M v[220:223], a[88:91], a[168:171], v[220:223]
s_waitcnt lgkmcnt(10)
s_lshl_b32 s19, s21, 1
s_add_u32 s3, s3, s19
s_lshl_b32 s92, s3, 14
M v[224:227], a[32:35], a[176:179], v[224:227]
s_add_u32 s93, s92, 16384
s_add_u32 s16, s50, 0
M v[224:227], a[36:39], a[180:183], v[224:227]
s_addc_u32 s17, s51, 0
s_mov_b32 s18, 16777216
s_mov_b32 s19, 0x00020000
M v[228:231], a[44:47], a[180:183], v[228:231]
s_mov_b32 s4, 0x3e0293ee
s_mov_b32 s5, 0x3e0293ee
M v[228:231], a[40:43], a[176:179], v[228:231]
M v[232:235], a[48:51], a[176:179], v[232:235]
M v[232:235], a[52:55], a[180:183], v[232:235]
M v[236:239], a[60:63], a[180:183], v[236:239]
M v[236:239], a[56:59], a[176:179], v[236:239]
s_waitcnt vmcnt(4) lgkmcnt(0)
s_barrier
ds_read_b128 a[160:163], v10 offset:32768
ds_read_b128 a[164:167], v11 offset:32768
M v[240:243], a[64:67], a[176:179], v[240:243]
s_add_u32 m0, s28, 131072
s_mov_b32 exec_hi, 0
buffer_load_dwordx4 v20, s[8:11], s24 offen lds
s_mov_b32 exec_hi, -1
M v[240:243], a[68:71], a[180:183], v[240:243]
M v[244:247], a[76:79], a[180:183], v[244:247]
M v[244:247], a[72:75], a[176:179], v[244:247]
s_add_u32 m0, s29, 133120
s_nop 0
buffer_load_dwordx4 v2, s[8:11], s23 offen offset:0 lds
M v[248:251], a[80:83], a[176:179], v[248:251]
M v[248:251], a[84:87], a[180:183], v[248:251]
M v[252:255], a[92:95], a[180:183], v[252:255]
M v[252:255], a[88:91], a[176:179], v[252:255]
M a[0:3], a[32:35], a[184:187], a[0:3]
buffer_load_dwordx4 v3, s[8:11], s23 offen offset:1024 lds
M a[0:3], a[36:39], a[188:191], a[0:3]
ds_read_b128 a[168:171], v10 offset:34816
ds_read_b128 a[172:175], v11 offset:34816
M a[4:7], a[44:47], a[188:191], a[4:7]
M a[4:7], a[40:43], a[184:187], a[4:7]
M a[8:11], a[48:51], a[184:187], a[8:11]
buffer_load_dwordx4 v4, s[8:11], s23 offen offset:2048 lds
M a[8:11], a[52:55], a[188:191], a[8:11]
M a[12:15], a[60:63], a[188:191], a[12:15]
M a[12:15], a[56:59], a[184:187], a[12:15]
M a[16:19], a[64:67], a[184:187], a[16:19]
buffer_load_dwordx4 v5, s[8:11], s23 offen offset:3072 lds
M a[16:19], a[68:71], a[188:191], a[16:19]
M a[20:23], a[76:79], a[188:191], a[20:23]
M a[20:23], a[72:75], a[184:187], a[20:23]
s_sub_u32 s31, s31, 1
s_cmp_eq_u32 s31, 0
s_cselect_b32 s58, -1920, s57
s_add_u32 s23, s23, s58
s_add_u32 s24, s24, s58
M a[24:27], a[80:83], a[184:187], a[24:27]
M a[24:27], a[84:87], a[188:191], a[24:27]
M a[28:31], a[92:95], a[188:191], a[28:31]
M a[28:31], a[88:91], a[184:187], a[28:31]
s_waitcnt lgkmcnt(2)
M v[32:35], a[96:99], a[160:163], v[32:35]
s_add_u32 m0, s30, 65536
s_nop 0
buffer_load_dwordx4 v6, s[12:15], s25 offen offset:0 lds
M v[32:35], a[100:103], a[164:167], v[32:35]
ds_read_b128 a[176:179], v10 offset:36864
ds_read_b128 a[180:183], v11 offset:36864
M v[36:39], a[108:111], a[164:167], v[36:39]
M v[36:39], a[104:107], a[160:163], v[36:39]
M v[40:43], a[112:115], a[160:163], v[40:43]
M v[40:43], a[116:119], a[164:167], v[40:43]
buffer_load_dwordx4 v7, s[12:15], s25 offen offset:1024 lds
M v[44:47], a[124:127], a[164:167], v[44:47]
M v[44:47], a[120:123], a[160:163], v[44:47]
M v[48:51], a[128:131], a[160:163], v[48:51]
M v[48:51], a[132:135], a[164:167], v[48:51]
M v[52:55], a[140:143], a[164:167], v[52:55]
buffer_load_dwordx4 v8, s[12:15], s25 offen offset:2048 lds
M v[52:55], a[136:139], a[160:163], v[52:55]
M v[56:59], a[144:147], a[160:163], v[56:59]
M v[56:59], a[148:151], a[164:167], v[56:59]
M v[60:63], a[156:159], a[164:167], v[60:63]
M v[60:63], a[152:155], a[160:163], v[60:63]
s_waitcnt lgkmcnt(2)
M v[64:67], a[96:99], a[168:171], v[64:67]
buffer_load_dwordx4 v9, s[12:15], s25 offen offset:3072 lds
M v[64:67], a[100:103], a[172:175], v[64:67]
ds_read_b128 a[184:187], v10 offset:38912
ds_read_b128 a[188:191], v11 offset:38912
M v[68:71], a[108:111], a[172:175], v[68:71]
M v[68:71], a[104:107], a[168:171], v[68:71]
v_pk_mul_f32 v[32:33], v[32:33], s[4:5]
v_pk_mul_f32 v[34:35], v[34:35], s[4:5]
v_pk_mul_f32 v[36:37], v[36:37], s[4:5]
M v[72:75], a[112:115], a[168:171], v[72:75]
v_pk_mul_f32 v[38:39], v[38:39], s[4:5]
v_cvt_pk_bf16_f32 v32, v32, v33
M v[72:75], a[116:119], a[172:175], v[72:75]
s_add_u32 m0, s30, 69632
s_nop 0
buffer_load_dwordx4 v21, s[12:15], s25 offen offset:0 lds
v_cvt_pk_bf16_f32 v33, v34, v35
v_cvt_pk_bf16_f32 v34, v36, v37
M v[76:79], a[124:127], a[172:175], v[76:79]
v_cvt_pk_bf16_f32 v35, v38, v39
v_pk_mul_f32 v[40:41], v[40:41], s[4:5]
v_pk_mul_f32 v[42:43], v[42:43], s[4:5]
M v[76:79], a[120:123], a[168:171], v[76:79]
v_pk_mul_f32 v[44:45], v[44:45], s[4:5]
v_pk_mul_f32 v[46:47], v[46:47], s[4:5]
M v[80:83], a[128:131], a[168:171], v[80:83]
v_cvt_pk_bf16_f32 v40, v40, v41
v_cvt_pk_bf16_f32 v41, v42, v43
M v[80:83], a[132:135], a[172:175], v[80:83]
v_cvt_pk_bf16_f32 v42, v44, v45
v_cvt_pk_bf16_f32 v43, v46, v47
M v[84:87], a[140:143], a[172:175], v[84:87]
buffer_load_dwordx4 v22, s[12:15], s25 offen offset:1024 lds
v_pk_mul_f32 v[48:49], v[48:49], s[4:5]
v_pk_mul_f32 v[50:51], v[50:51], s[4:5]
v_pk_mul_f32 v[52:53], v[52:53], s[4:5]
M v[84:87], a[136:139], a[168:171], v[84:87]
v_pk_mul_f32 v[54:55], v[54:55], s[4:5]
v_cvt_pk_bf16_f32 v48, v48, v49
M v[88:91], a[144:147], a[168:171], v[88:91]
v_cvt_pk_bf16_f32 v49, v50, v51
v_cvt_pk_bf16_f32 v50, v52, v53
M v[88:91], a[148:151], a[172:175], v[88:91]
v_cvt_pk_bf16_f32 v51, v54, v55
v_pk_mul_f32 v[56:57], v[56:57], s[4:5]
v_pk_mul_f32 v[58:59], v[58:59], s[4:5]
M v[92:95], a[156:159], a[172:175], v[92:95]
v_pk_mul_f32 v[60:61], v[60:61], s[4:5]
v_pk_mul_f32 v[62:63], v[62:63], s[4:5]
M v[92:95], a[152:155], a[168:171], v[92:95]
s_waitcnt lgkmcnt(2)
v_cvt_pk_bf16_f32 v56, v56, v57
v_cvt_pk_bf16_f32 v57, v58, v59
M v[96:99], a[96:99], a[176:179], v[96:99]
s_sub_u32 s54, s54, 1
s_cmp_eq_u32 s54, 0
s_cselect_b32 s58, s55, s56
s_add_u32 s25, s25, s58
v_cvt_pk_bf16_f32 v58, v60, v61
v_cvt_pk_bf16_f32 v59, v62, v63
M v[96:99], a[100:103], a[180:183], v[96:99]
M v[100:103], a[108:111], a[180:183], v[100:103]
M v[100:103], a[104:107], a[176:179], v[100:103]
v_pk_mul_f32 v[64:65], v[64:65], s[4:5]
v_pk_mul_f32 v[66:67], v[66:67], s[4:5]
v_pk_mul_f32 v[68:69], v[68:69], s[4:5]
M v[104:107], a[112:115], a[176:179], v[104:107]
v_pk_mul_f32 v[70:71], v[70:71], s[4:5]
v_cvt_pk_bf16_f32 v64, v64, v65
M v[104:107], a[116:119], a[180:183], v[104:107]
v_cvt_pk_bf16_f32 v65, v66, v67
v_cvt_pk_bf16_f32 v66, v68, v69
M v[108:111], a[124:127], a[180:183], v[108:111]
v_cvt_pk_bf16_f32 v67, v70, v71
v_pk_mul_f32 v[72:73], v[72:73], s[4:5]
v_pk_mul_f32 v[74:75], v[74:75], s[4:5]
M v[108:111], a[120:123], a[176:179], v[108:111]
s_waitcnt vmcnt(11) lgkmcnt(0)
s_barrier
ds_read_b128 a[160:163], v10 offset:49152
ds_read_b128 a[164:167], v11 offset:49152
v_pk_mul_f32 v[76:77], v[76:77], s[4:5]
v_pk_mul_f32 v[78:79], v[78:79], s[4:5]
M v[112:115], a[128:131], a[176:179], v[112:115]
s_add_u32 m0, s28, 0
s_mov_b32 exec_hi, 0
buffer_load_dwordx4 v20, s[8:11], s24 offen lds
s_mov_b32 exec_hi, -1
v_cvt_pk_bf16_f32 v72, v72, v73
v_cvt_pk_bf16_f32 v73, v74, v75
M v[112:115], a[132:135], a[180:183], v[112:115]
v_cvt_pk_bf16_f32 v74, v76, v77
v_cvt_pk_bf16_f32 v75, v78, v79
M v[116:119], a[140:143], a[180:183], v[116:119]
v_pk_mul_f32 v[80:81], v[80:81], s[4:5]
v_pk_mul_f32 v[82:83], v[82:83], s[4:5]
v_pk_mul_f32 v[84:85], v[84:85], s[4:5]
M v[116:119], a[136:139], a[176:179], v[116:119]
v_pk_mul_f32 v[86:87], v[86:87], s[4:5]
v_cvt_pk_bf16_f32 v80, v80, v81
M v[120:123], a[144:147], a[176:179], v[120:123]
s_add_u32 m0, s29, 2048
s_nop 0
buffer_load_dwordx4 v2, s[8:11], s23 offen offset:0 lds
v_cvt_pk_bf16_f32 v81, v82, v83
v_cvt_pk_bf16_f32 v82, v84, v85
M v[120:123], a[148:151], a[180:183], v[120:123]
v_cvt_pk_bf16_f32 v83, v86, v87
v_pk_mul_f32 v[88:89], v[88:89], s[4:5]
v_pk_mul_f32 v[90:91], v[90:91], s[4:5]
M v[124:127], a[156:159], a[180:183], v[124:127]
v_pk_mul_f32 v[92:93], v[92:93], s[4:5]
v_pk_mul_f32 v[94:95], v[94:95], s[4:5]
M v[124:127], a[152:155], a[176:179], v[124:127]
v_cvt_pk_bf16_f32 v88, v88, v89
v_cvt_pk_bf16_f32 v89, v90, v91
M v[128:131], a[96:99], a[184:187], v[128:131]
v_cvt_pk_bf16_f32 v90, v92, v93
v_cvt_pk_bf16_f32 v91, v94, v95
M v[128:131], a[100:103], a[188:191], v[128:131]
ds_read_b128 a[168:171], v10 offset:51200
ds_read_b128 a[172:175], v11 offset:51200
M v[132:135], a[108:111], a[188:191], v[132:135]
buffer_load_dwordx4 v3, s[8:11], s23 offen offset:1024 lds
M v[132:135], a[104:107], a[184:187], v[132:135]
v_pk_mul_f32 v[96:97], v[96:97], s[4:5]
v_pk_mul_f32 v[98:99], v[98:99], s[4:5]
v_pk_mul_f32 v[100:101], v[100:101], s[4:5]
M v[136:139], a[112:115], a[184:187], v[136:139]
v_pk_mul_f32 v[102:103], v[102:103], s[4:5]
v_cvt_pk_bf16_f32 v96, v96, v97
M v[136:139], a[116:119], a[188:191], v[136:139]
v_cvt_pk_bf16_f32 v97, v98, v99
v_cvt_pk_bf16_f32 v98, v100, v101
M v[140:143], a[124:127], a[188:191], v[140:143]
buffer_load_dwordx4 v4, s[8:11], s23 offen offset:2048 lds
v_cvt_pk_bf16_f32 v99, v102, v103
v_pk_mul_f32 v[104:105], v[104:105], s[4:5]
v_pk_mul_f32 v[106:107], v[106:107], s[4:5]
M v[140:143], a[120:123], a[184:187], v[140:143]
v_pk_mul_f32 v[108:109], v[108:109], s[4:5]
v_pk_mul_f32 v[110:111], v[110:111], s[4:5]
M v[144:147], a[128:131], a[184:187], v[144:147]
v_cvt_pk_bf16_f32 v104, v104, v105
v_cvt_pk_bf16_f32 v105, v106, v107
M v[144:147], a[132:135], a[188:191], v[144:147]
v_cvt_pk_bf16_f32 v106, v108, v109
v_cvt_pk_bf16_f32 v107, v110, v111
M v[148:151], a[140:143], a[188:191], v[148:151]
buffer_load_dwordx4 v5, s[8:11], s23 offen offset:3072 lds
v_pk_mul_f32 v[112:113], v[112:113], s[4:5]
v_pk_mul_f32 v[114:115], v[114:115], s[4:5]
v_pk_mul_f32 v[116:117], v[116:117], s[4:5]
M v[148:151], a[136:139], a[184:187], v[148:151]
v_pk_mul_f32 v[118:119], v[118:119], s[4:5]
v_cvt_pk_bf16_f32 v112, v112, v113
M v[152:155], a[144:147], a[184:187], v[152:155]
v_cvt_pk_bf16_f32 v113, v114, v115
v_cvt_pk_bf16_f32 v114, v116, v117
M v[152:155], a[148:151], a[188:191], v[152:155]
v_cvt_pk_bf16_f32 v115, v118, v119
v_pk_mul_f32 v[120:121], v[120:121], s[4:5]
v_pk_mul_f32 v[122:123], v[122:123], s[4:5]
M v[156:159], a[156:159], a[188:191], v[156:159]
s_sub_u32 s31, s31, 1
s_cmp_eq_u32 s31, 0
s_cselect_b32 s58, -1920, s57
s_add_u32 s23, s23, s58
s_add_u32 s24, s24, s58
v_pk_mul_f32 v[124:125], v[124:125], s[4:5]
v_pk_mul_f32 v[126:127], v[126:127], s[4:5]
M v[156:159], a[152:155], a[184:187], v[156:159]
s_waitcnt lgkmcnt(2)
v_cvt_pk_bf16_f32 v120, v120, v121
v_cvt_pk_bf16_f32 v121, v122, v123
M v[160:163], a[96:99], a[160:163], v[160:163]
v_cvt_pk_bf16_f32 v122, v124, v125
v_cvt_pk_bf16_f32 v123, v126, v127
M v[160:163], a[100:103], a[164:167], v[160:163]
ds_read_b128 a[176:179], v10 offset:53248
ds_read_b128 a[180:183], v11 offset:53248
M v[164:167], a[108:111], a[164:167], v[164:167]
M v[164:167], a[104:107], a[160:163], v[164:167]
v_pk_mul_f32 v[128:129], v[128:129], s[4:5]
v_pk_mul_f32 v[130:131], v[130:131], s[4:5]
v_pk_mul_f32 v[132:133], v[132:133], s[4:5]
M v[168:171], a[112:115], a[160:163], v[168:171]
s_add_u32 m0, s30, 98304
s_nop 0
buffer_load_dwordx4 v6, s[12:15], s25 offen offset:0 lds
v_pk_mul_f32 v[134:135], v[134:135], s[4:5]
v_cvt_pk_bf16_f32 v128, v128, v129
M v[168:171], a[116:119], a[164:167], v[168:171]
v_cvt_pk_bf16_f32 v129, v130, v131
v_cvt_pk_bf16_f32 v130, v132, v133
M v[172:175], a[124:127], a[164:167], v[172:175]
v_cvt_pk_bf16_f32 v131, v134, v135
v_pk_mul_f32 v[136:137], v[136:137], s[4:5]
v_pk_mul_f32 v[138:139], v[138:139], s[4:5]
M v[172:175], a[120:123], a[160:163], v[172:175]
v_pk_mul_f32 v[140:141], v[140:141], s[4:5]
v_pk_mul_f32 v[142:143], v[142:143], s[4:5]
M v[176:179], a[128:131], a[160:163], v[176:179]
v_cvt_pk_bf16_f32 v136, v136, v137
v_cvt_pk_bf16_f32 v137, v138, v139
M v[176:179], a[132:135], a[164:167], v[176:179]
buffer_load_dwordx4 v7, s[12:15], s25 offen offset:1024 lds
v_cvt_pk_bf16_f32 v138, v140, v141
v_cvt_pk_bf16_f32 v139, v142, v143
M v[180:183], a[140:143], a[164:167], v[180:183]
v_pk_mul_f32 v[144:145], v[144:145], s[4:5]
v_pk_mul_f32 v[146:147], v[146:147], s[4:5]
v_pk_mul_f32 v[148:149], v[148:149], s[4:5]
M v[180:183], a[136:139], a[160:163], v[180:183]
v_pk_mul_f32 v[150:151], v[150:151], s[4:5]
v_cvt_pk_bf16_f32 v144, v144, v145
M v[184:187], a[144:147], a[160:163], v[184:187]
v_cvt_pk_bf16_f32 v145, v146, v147
v_cvt_pk_bf16_f32 v146, v148, v149
M v[184:187], a[148:151], a[164:167], v[184:187]
buffer_load_dwordx4 v8, s[12:15], s25 offen offset:2048 lds
v_cvt_pk_bf16_f32 v147, v150, v151
v_pk_mul_f32 v[152:153], v[152:153], s[4:5]
v_pk_mul_f32 v[154:155], v[154:155], s[4:5]
M v[188:191], a[156:159], a[164:167], v[188:191]
v_pk_mul_f32 v[156:157], v[156:157], s[4:5]
v_pk_mul_f32 v[158:159], v[158:159], s[4:5]
M v[188:191], a[152:155], a[160:163], v[188:191]
s_waitcnt lgkmcnt(2)
v_cvt_pk_bf16_f32 v152, v152, v153
v_cvt_pk_bf16_f32 v153, v154, v155
M v[192:195], a[96:99], a[168:171], v[192:195]
v_cvt_pk_bf16_f32 v154, v156, v157
v_cvt_pk_bf16_f32 v155, v158, v159
M v[192:195], a[100:103], a[172:175], v[192:195]
ds_read_b128 a[184:187], v10 offset:55296
ds_read_b128 a[188:191], v11 offset:55296
M v[196:199], a[108:111], a[172:175], v[196:199]
M v[196:199], a[104:107], a[168:171], v[196:199]
buffer_load_dwordx4 v9, s[12:15], s25 offen offset:3072 lds
v_pk_mul_f32 v[160:161], v[160:161], s[4:5]
v_pk_mul_f32 v[162:163], v[162:163], s[4:5]
v_pk_mul_f32 v[164:165], v[164:165], s[4:5]
M v[200:203], a[112:115], a[168:171], v[200:203]
v_pk_mul_f32 v[166:167], v[166:167], s[4:5]
v_cvt_pk_bf16_f32 v160, v160, v161
M v[200:203], a[116:119], a[172:175], v[200:203]
v_cvt_pk_bf16_f32 v161, v162, v163
v_cvt_pk_bf16_f32 v162, v164, v165
M v[204:207], a[124:127], a[172:175], v[204:207]
v_cvt_pk_bf16_f32 v163, v166, v167
v_pk_mul_f32 v[168:169], v[168:169], s[4:5]
v_pk_mul_f32 v[170:171], v[170:171], s[4:5]
M v[204:207], a[120:123], a[168:171], v[204:207]
s_add_u32 m0, s30, 102400
s_nop 0
buffer_load_dwordx4 v21, s[12:15], s25 offen offset:0 lds
v_pk_mul_f32 v[172:173], v[172:173], s[4:5]
v_pk_mul_f32 v[174:175], v[174:175], s[4:5]
M v[208:211], a[128:131], a[168:171], v[208:211]
v_cvt_pk_bf16_f32 v168, v168, v169
v_cvt_pk_bf16_f32 v169, v170, v171
M v[208:211], a[132:135], a[172:175], v[208:211]
v_cvt_pk_bf16_f32 v170, v172, v173
v_cvt_pk_bf16_f32 v171, v174, v175
M v[212:215], a[140:143], a[172:175], v[212:215]
v_pk_mul_f32 v[176:177], v[176:177], s[4:5]
v_pk_mul_f32 v[178:179], v[178:179], s[4:5]
v_pk_mul_f32 v[180:181], v[180:181], s[4:5]
M v[212:215], a[136:139], a[168:171], v[212:215]
buffer_load_dwordx4 v22, s[12:15], s25 offen offset:1024 lds
v_pk_mul_f32 v[182:183], v[182:183], s[4:5]
v_cvt_pk_bf16_f32 v176, v176, v177
M v[216:219], a[144:147], a[168:171], v[216:219]
v_cvt_pk_bf16_f32 v177, v178, v179
v_cvt_pk_bf16_f32 v178, v180, v181
M v[216:219], a[148:151], a[172:175], v[216:219]
v_cvt_pk_bf16_f32 v179, v182, v183
v_pk_mul_f32 v[184:185], v[184:185], s[4:5]
v_pk_mul_f32 v[186:187], v[186:187], s[4:5]
M v[220:223], a[156:159], a[172:175], v[220:223]
v_pk_mul_f32 v[188:189], v[188:189], s[4:5]
v_pk_mul_f32 v[190:191], v[190:191], s[4:5]
M v[220:223], a[152:155], a[168:171], v[220:223]
s_waitcnt lgkmcnt(2)
v_cvt_pk_bf16_f32 v184, v184, v185
v_cvt_pk_bf16_f32 v185, v186, v187
M v[224:227], a[96:99], a[176:179], v[224:227]
s_sub_u32 s54, s54, 1
s_cmp_eq_u32 s54, 0
s_cselect_b32 s58, s55, s56
s_add_u32 s25, s25, s58
v_cvt_pk_bf16_f32 v186, v188, v189
v_cvt_pk_bf16_f32 v187, v190, v191
M v[224:227], a[100:103], a[180:183], v[224:227]
M v[228:231], a[108:111], a[180:183], v[228:231]
M v[228:231], a[104:107], a[176:179], v[228:231]
v_pk_mul_f32 v[192:193], v[192:193], s[4:5]
v_pk_mul_f32 v[194:195], v[194:195], s[4:5]
v_pk_mul_f32 v[196:197], v[196:197], s[4:5]
M v[232:235], a[112:115], a[176:179], v[232:235]
v_pk_mul_f32 v[198:199], v[198:199], s[4:5]
v_cvt_pk_bf16_f32 v192, v192, v193
M v[232:235], a[116:119], a[180:183], v[232:235]
v_cvt_pk_bf16_f32 v193, v194, v195
v_cvt_pk_bf16_f32 v194, v196, v197
M v[236:239], a[124:127], a[180:183], v[236:239]
v_cvt_pk_bf16_f32 v195, v198, v199
v_pk_mul_f32 v[200:201], v[200:201], s[4:5]
v_pk_mul_f32 v[202:203], v[202:203], s[4:5]
M v[236:239], a[120:123], a[176:179], v[236:239]
s_waitcnt vmcnt(63) lgkmcnt(0)
s_barrier
v_pk_mul_f32 v[204:205], v[204:205], s[4:5]
v_pk_mul_f32 v[206:207], v[206:207], s[4:5]
M v[240:243], a[128:131], a[176:179], v[240:243]
s_add_u32 m0, s28, 18432
s_mov_b32 exec_hi, 0
buffer_load_dwordx4 v20, s[8:11], s24 offen lds
s_mov_b32 exec_hi, -1
v_cvt_pk_bf16_f32 v200, v200, v201
v_cvt_pk_bf16_f32 v201, v202, v203
M v[240:243], a[132:135], a[180:183], v[240:243]
v_cvt_pk_bf16_f32 v202, v204, v205
v_cvt_pk_bf16_f32 v203, v206, v207
M v[244:247], a[140:143], a[180:183], v[244:247]
v_pk_mul_f32 v[208:209], v[208:209], s[4:5]
v_pk_mul_f32 v[210:211], v[210:211], s[4:5]
v_pk_mul_f32 v[212:213], v[212:213], s[4:5]
M v[244:247], a[136:139], a[176:179], v[244:247]
s_add_u32 m0, s29, 20480
s_nop 0
buffer_load_dwordx4 v2, s[8:11], s23 offen offset:0 lds
v_pk_mul_f32 v[214:215], v[214:215], s[4:5]
v_cvt_pk_bf16_f32 v208, v208, v209
M v[248:251], a[144:147], a[176:179], v[248:251]
v_cvt_pk_bf16_f32 v209, v210, v211
v_cvt_pk_bf16_f32 v210, v212, v213
M v[248:251], a[148:151], a[180:183], v[248:251]
v_cvt_pk_bf16_f32 v211, v214, v215
v_pk_mul_f32 v[216:217], v[216:217], s[4:5]
v_pk_mul_f32 v[218:219], v[218:219], s[4:5]
M v[252:255], a[156:159], a[180:183], v[252:255]
v_pk_mul_f32 v[220:221], v[220:221], s[4:5]
v_pk_mul_f32 v[222:223], v[222:223], s[4:5]
M v[252:255], a[152:155], a[176:179], v[252:255]
v_cvt_pk_bf16_f32 v216, v216, v217
v_cvt_pk_bf16_f32 v217, v218, v219
M a[0:3], a[96:99], a[184:187], a[0:3]
buffer_load_dwordx4 v3, s[8:11], s23 offen offset:1024 lds
v_cvt_pk_bf16_f32 v218, v220, v221
v_cvt_pk_bf16_f32 v219, v222, v223
M a[0:3], a[100:103], a[188:191], a[0:3]
M a[4:7], a[108:111], a[188:191], a[4:7]
M a[4:7], a[104:107], a[184:187], a[4:7]
v_pk_mul_f32 v[224:225], v[224:225], s[4:5]
v_pk_mul_f32 v[226:227], v[226:227], s[4:5]
v_pk_mul_f32 v[228:229], v[228:229], s[4:5]
M a[8:11], a[112:115], a[184:187], a[8:11]
buffer_load_dwordx4 v4, s[8:11], s23 offen offset:2048 lds
v_pk_mul_f32 v[230:231], v[230:231], s[4:5]
v_cvt_pk_bf16_f32 v224, v224, v225
M a[8:11], a[116:119], a[188:191], a[8:11]
v_cvt_pk_bf16_f32 v225, v226, v227
v_cvt_pk_bf16_f32 v226, v228, v229
M a[12:15], a[124:127], a[188:191], a[12:15]
v_cvt_pk_bf16_f32 v227, v230, v231
v_pk_mul_f32 v[232:233], v[232:233], s[4:5]
v_pk_mul_f32 v[234:235], v[234:235], s[4:5]
M a[12:15], a[120:123], a[184:187], a[12:15]
buffer_load_dwordx4 v5, s[8:11], s23 offen offset:3072 lds
v_pk_mul_f32 v[236:237], v[236:237], s[4:5]
v_pk_mul_f32 v[238:239], v[238:239], s[4:5]
M a[16:19], a[128:131], a[184:187], a[16:19]
v_cvt_pk_bf16_f32 v232, v232, v233
v_cvt_pk_bf16_f32 v233, v234, v235
M a[16:19], a[132:135], a[188:191], a[16:19]
v_cvt_pk_bf16_f32 v234, v236, v237
v_cvt_pk_bf16_f32 v235, v238, v239
M a[20:23], a[140:143], a[188:191], a[20:23]
v_pk_mul_f32 v[240:241], v[240:241], s[4:5]
v_pk_mul_f32 v[242:243], v[242:243], s[4:5]
v_pk_mul_f32 v[244:245], v[244:245], s[4:5]
M a[20:23], a[136:139], a[184:187], a[20:23]
s_sub_u32 s31, s31, 1
s_cmp_eq_u32 s31, 0
s_cselect_b32 s58, -1920, s57
s_add_u32 s23, s23, s58
s_add_u32 s24, s24, s58
v_pk_mul_f32 v[246:247], v[246:247], s[4:5]
v_cvt_pk_bf16_f32 v240, v240, v241
M a[24:27], a[144:147], a[184:187], a[24:27]
v_cvt_pk_bf16_f32 v241, v242, v243
v_cvt_pk_bf16_f32 v242, v244, v245
M a[24:27], a[148:151], a[188:191], a[24:27]
v_cvt_pk_bf16_f32 v243, v246, v247
v_pk_mul_f32 v[248:249], v[248:249], s[4:5]
v_pk_mul_f32 v[250:251], v[250:251], s[4:5]
M a[28:31], a[156:159], a[188:191], a[28:31]
v_pk_mul_f32 v[252:253], v[252:253], s[4:5]
v_pk_mul_f32 v[254:255], v[254:255], s[4:5]
M a[28:31], a[152:155], a[184:187], a[28:31]
v_cvt_pk_bf16_f32 v248, v248, v249
v_cvt_pk_bf16_f32 v249, v250, v251
v_cvt_pk_bf16_f32 v250, v252, v253
v_cvt_pk_bf16_f32 v251, v254, v255
v_accvgpr_read_b32 v24, a0
v_accvgpr_read_b32 v25, a1
v_accvgpr_read_b32 v26, a2
v_accvgpr_read_b32 v27, a3
v_accvgpr_read_b32 v28, a4
v_accvgpr_read_b32 v29, a5
v_accvgpr_read_b32 v30, a6
v_accvgpr_read_b32 v31, a7
v_pk_mul_f32 v[24:25], v[24:25], s[4:5]
v_pk_mul_f32 v[26:27], v[26:27], s[4:5]
v_pk_mul_f32 v[28:29], v[28:29], s[4:5]
v_pk_mul_f32 v[30:31], v[30:31], s[4:5]
v_cvt_pk_bf16_f32 v36, v24, v25
v_cvt_pk_bf16_f32 v37, v26, v27
v_cvt_pk_bf16_f32 v38, v28, v29
v_cvt_pk_bf16_f32 v39, v30, v31
v_accvgpr_read_b32 v24, a8
v_accvgpr_read_b32 v25, a9
v_accvgpr_read_b32 v26, a10
v_accvgpr_read_b32 v27, a11
v_accvgpr_read_b32 v28, a12
v_accvgpr_read_b32 v29, a13
v_accvgpr_read_b32 v30, a14
v_accvgpr_read_b32 v31, a15
v_pk_mul_f32 v[24:25], v[24:25], s[4:5]
v_pk_mul_f32 v[26:27], v[26:27], s[4:5]
v_pk_mul_f32 v[28:29], v[28:29], s[4:5]
v_pk_mul_f32 v[30:31], v[30:31], s[4:5]
v_cvt_pk_bf16_f32 v44, v24, v25
v_cvt_pk_bf16_f32 v45, v26, v27
v_cvt_pk_bf16_f32 v46, v28, v29
v_cvt_pk_bf16_f32 v47, v30, v31
v_accvgpr_read_b32 v24, a16
v_accvgpr_read_b32 v25, a17
v_accvgpr_read_b32 v26, a18
v_accvgpr_read_b32 v27, a19
v_accvgpr_read_b32 v28, a20
v_accvgpr_read_b32 v29, a21
v_accvgpr_read_b32 v30, a22
v_accvgpr_read_b32 v31, a23
v_pk_mul_f32 v[24:25], v[24:25], s[4:5]
v_pk_mul_f32 v[26:27], v[26:27], s[4:5]
v_pk_mul_f32 v[28:29], v[28:29], s[4:5]
v_pk_mul_f32 v[30:31], v[30:31], s[4:5]
v_cvt_pk_bf16_f32 v52, v24, v25
v_cvt_pk_bf16_f32 v53, v26, v27
v_cvt_pk_bf16_f32 v54, v28, v29
v_cvt_pk_bf16_f32 v55, v30, v31
v_accvgpr_read_b32 v24, a24
v_accvgpr_read_b32 v25, a25
v_accvgpr_read_b32 v26, a26
v_accvgpr_read_b32 v27, a27
v_accvgpr_read_b32 v28, a28
v_accvgpr_read_b32 v29, a29
v_accvgpr_read_b32 v30, a30
v_accvgpr_read_b32 v31, a31
v_pk_mul_f32 v[24:25], v[24:25], s[4:5]
v_pk_mul_f32 v[26:27], v[26:27], s[4:5]
v_pk_mul_f32 v[28:29], v[28:29], s[4:5]
v_pk_mul_f32 v[30:31], v[30:31], s[4:5]
v_cvt_pk_bf16_f32 v60, v24, v25
v_cvt_pk_bf16_f32 v61, v26, v27
v_cvt_pk_bf16_f32 v62, v28, v29
v_cvt_pk_bf16_f32 v63, v30, v31
s_branch Lk1_b
Lk1_spin:
s_add_u32 s59, s59, 1
s_cmp_gt_u32 s59, 1048576
s_cbranch_scc1 Lk1_got
s_sleep 2
buffer_load_dword v6, v7, s[60:63], 0 offen sc1
s_waitcnt vmcnt(0)
v_cmp_gt_u32 vcc, 0x80, v6
s_nop 0
s_cbranch_vccnz Lk1_spin
s_branch Lk1_got
Lk1_kv:
M v[32:35], a[32:35], a[160:163], 0
s_add_u32 s23, s23, 128
s_cmp_eq_u32 s23, s25
s_cselect_b32 s23, s26, s23
M v[32:35], a[36:39], a[164:167], v[32:35]
ds_read_b128 a[176:179], v10 offset:4096
ds_read_b128 a[180:183], v11 offset:4096
M v[36:39], a[44:47], a[164:167], 0
M v[36:39], a[40:43], a[160:163], v[36:39]
ds_read_b64_tr_b16 a[96:97], v12 offset:32768
ds_read_b64_tr_b16 a[98:99], v12 offset:34816
M v[40:43], a[48:51], a[160:163], 0
M v[40:43], a[52:55], a[164:167], v[40:43]
M v[44:47], a[60:63], a[164:167], 0
s_add_u32 m0, s29, 81920
s_nop 0
buffer_load_dwordx4 v6, s[12:15], s24 offen offset:0 lds
M v[44:47], a[56:59], a[160:163], v[44:47]
ds_read_b64_tr_b16 a[104:105], v13 offset:32768
ds_read_b64_tr_b16 a[106:107], v13 offset:34816
M v[48:51], a[64:67], a[160:163], 0
M v[48:51], a[68:71], a[164:167], v[48:51]
M v[52:55], a[76:79], a[164:167], 0
M v[52:55], a[72:75], a[160:163], v[52:55]
ds_read_b64_tr_b16 a[112:113], v14 offset:32768
ds_read_b64_tr_b16 a[114:115], v14 offset:34816
M v[56:59], a[80:83], a[160:163], 0
M v[56:59], a[84:87], a[164:167], v[56:59]
buffer_load_dwordx4 v7, s[12:15], s24 offen offset:1024 lds
M v[60:63], a[92:95], a[164:167], 0
M v[60:63], a[88:91], a[160:163], v[60:63]
ds_read_b64_tr_b16 a[120:121], v15 offset:32768
ds_read_b64_tr_b16 a[122:123], v15 offset:34816
M v[64:67], a[32:35], a[168:171], 0
M v[64:67], a[36:39], a[172:175], v[64:67]
ds_read_b128 a[184:187], v10 offset:6144
ds_read_b128 a[188:191], v11 offset:6144
M v[68:71], a[44:47], a[172:175], 0
M v[68:71], a[40:43], a[168:171], v[68:71]
ds_read_b64_tr_b16 a[128:129], v16 offset:32768
ds_read_b64_tr_b16 a[130:131], v16 offset:34816
M v[72:75], a[48:51], a[168:171], 0
buffer_load_dwordx4 v8, s[12:15], s24 offen offset:2048 lds
M v[72:75], a[52:55], a[172:175], v[72:75]
M v[76:79], a[60:63], a[172:175], 0
M v[76:79], a[56:59], a[168:171], v[76:79]
ds_read_b64_tr_b16 a[136:137], v17 offset:32768
ds_read_b64_tr_b16 a[138:139], v17 offset:34816
M v[80:83], a[64:67], a[168:171], 0
M v[80:83], a[68:71], a[172:175], v[80:83]
M v[84:87], a[76:79], a[172:175], 0
buffer_load_dwordx4 v9, s[12:15], s24 offen offset:3072 lds
M v[84:87], a[72:75], a[168:171], v[84:87]
ds_read_b64_tr_b16 a[144:145], v18 offset:32768
ds_read_b64_tr_b16 a[146:147], v18 offset:34816
M v[88:91], a[80:83], a[168:171], 0
M v[88:91], a[84:87], a[172:175], v[88:91]
M v[92:95], a[92:95], a[172:175], 0
M v[92:95], a[88:91], a[168:171], v[92:95]
s_waitcnt lgkmcnt(15)
ds_read_b64_tr_b16 a[152:153], v19 offset:32768
ds_read_b64_tr_b16 a[154:155], v19 offset:34816
M v[96:99], a[32:35], a[176:179], 0
s_add_u32 s24, s24, 262144
s_cmp_eq_u32 s24, s27
s_cselect_b32 s24, s28, s24
s_sub_u32 s6, s6, 1
s_cmp_eq_u32 s6, 0
s_cselect_b64 s[12:13], s[64:65], s[12:13]
M v[96:99], a[36:39], a[180:183], v[96:99]
M v[100:103], a[44:47], a[180:183], 0
M v[100:103], a[40:43], a[176:179], v[100:103]
M v[104:107], a[48:51], a[176:179], 0
M v[104:107], a[52:55], a[180:183], v[104:107]
M v[108:111], a[60:63], a[180:183], 0
M v[108:111], a[56:59], a[176:179], v[108:111]
s_waitcnt vmcnt(17) lgkmcnt(0)
s_barrier
ds_read_b128 a[160:163], v10 offset:16384
ds_read_b128 a[164:167], v11 offset:16384
M v[112:115], a[64:67], a[176:179], 0
s_add_u32 m0, s29, 0
s_nop 0
buffer_load_dwordx4 v2, s[8:11], s23 offen offset:0 lds
M v[112:115], a[68:71], a[180:183], v[112:115]
M v[116:119], a[76:79], a[180:183], 0
M v[116:119], a[72:75], a[176:179], v[116:119]
ds_read_b64_tr_b16 a[100:101], v12 offset:49152
ds_read_b64_tr_b16 a[102:103], v12 offset:51200
M v[120:123], a[80:83], a[176:179], 0
M v[120:123], a[84:87], a[180:183], v[120:123]
buffer_load_dwordx4 v3, s[8:11], s23 offen offset:1024 lds
M v[124:127], a[92:95], a[180:183], 0
M v[124:127], a[88:91], a[176:179], v[124:127]
M v[128:131], a[32:35], a[184:187], 0
M v[128:131], a[36:39], a[188:191], v[128:131]
ds_read_b128 a[168:171], v10 offset:18432
ds_read_b128 a[172:175], v11 offset:18432
ds_read_b64_tr_b16 a[108:109], v13 offset:49152
ds_read_b64_tr_b16 a[110:111], v13 offset:51200
M v[132:135], a[44:47], a[188:191], 0
M v[132:135], a[40:43], a[184:187], v[132:135]
buffer_load_dwordx4 v4, s[8:11], s23 offen offset:2048 lds
M v[136:139], a[48:51], a[184:187], 0
M v[136:139], a[52:55], a[188:191], v[136:139]
M v[140:143], a[60:63], a[188:191], 0
M v[140:143], a[56:59], a[184:187], v[140:143]
ds_read_b64_tr_b16 a[116:117], v14 offset:49152
ds_read_b64_tr_b16 a[118:119], v14 offset:51200
M v[144:147], a[64:67], a[184:187], 0
M v[144:147], a[68:71], a[188:191], v[144:147]
buffer_load_dwordx4 v5, s[8:11], s23 offen offset:3072 lds
M v[148:151], a[76:79], a[188:191], 0
M v[148:151], a[72:75], a[184:187], v[148:151]
M v[152:155], a[80:83], a[184:187], 0
M v[152:155], a[84:87], a[188:191], v[152:155]
ds_read_b64_tr_b16 a[124:125], v15 offset:49152
ds_read_b64_tr_b16 a[126:127], v15 offset:51200
M v[156:159], a[92:95], a[188:191], 0
s_add_u32 m0, s29, 98304
s_nop 0
buffer_load_dwordx4 v6, s[12:15], s24 offen offset:0 lds
M v[156:159], a[88:91], a[184:187], v[156:159]
s_waitcnt lgkmcnt(10)
M v[160:163], a[32:35], a[160:163], 0
M v[160:163], a[36:39], a[164:167], v[160:163]
ds_read_b128 a[176:179], v10 offset:20480
ds_read_b128 a[180:183], v11 offset:20480
M v[164:167], a[44:47], a[164:167], 0
M v[164:167], a[40:43], a[160:163], v[164:167]
ds_read_b64_tr_b16 a[132:133], v16 offset:49152
ds_read_b64_tr_b16 a[134:135], v16 offset:51200
M v[168:171], a[48:51], a[160:163], 0
M v[168:171], a[52:55], a[164:167], v[168:171]
buffer_load_dwordx4 v7, s[12:15], s24 offen offset:1024 lds
M v[172:175], a[60:63], a[164:167], 0
M v[172:175], a[56:59], a[160:163], v[172:175]
M v[176:179], a[64:67], a[160:163], 0
M v[176:179], a[68:71], a[164:167], v[176:179]
ds_read_b64_tr_b16 a[140:141], v17 offset:49152
ds_read_b64_tr_b16 a[142:143], v17 offset:51200
M v[180:183], a[76:79], a[164:167], 0
M v[180:183], a[72:75], a[160:163], v[180:183]
buffer_load_dwordx4 v8, s[12:15], s24 offen offset:2048 lds
M v[184:187], a[80:83], a[160:163], 0
M v[184:187], a[84:87], a[164:167], v[184:187]
M v[188:191], a[92:95], a[164:167], 0
M v[188:191], a[88:91], a[160:163], v[188:191]
s_waitcnt lgkmcnt(12)
ds_read_b64_tr_b16 a[148:149], v18 offset:49152
ds_read_b64_tr_b16 a[150:151], v18 offset:51200
M v[192:195], a[32:35], a[168:171], 0
buffer_load_dwordx4 v9, s[12:15], s24 offen offset:3072 lds
M v[192:195], a[36:39], a[172:175], v[192:195]
ds_read_b128 a[184:187], v10 offset:22528
ds_read_b128 a[188:191], v11 offset:22528
M v[196:199], a[44:47], a[172:175], 0
M v[196:199], a[40:43], a[168:171], v[196:199]
M v[200:203], a[48:51], a[168:171], 0
M v[200:203], a[52:55], a[172:175], v[200:203]
ds_read_b64_tr_b16 a[156:157], v19 offset:49152
ds_read_b64_tr_b16 a[158:159], v19 offset:51200
M v[204:207], a[60:63], a[172:175], 0
s_add_u32 s24, s24, 262144
M v[204:207], a[56:59], a[168:171], v[204:207]
M v[208:211], a[64:67], a[168:171], 0
M v[208:211], a[68:71], a[172:175], v[208:211]
M v[212:215], a[76:79], a[172:175], 0
M v[212:215], a[72:75], a[168:171], v[212:215]
buffer_load_dword v21, v20, s[60:63], s54 offen
s_add_u32 s54, s54, s55
M v[216:219], a[80:83], a[168:171], 0
M v[216:219], a[84:87], a[172:175], v[216:219]
M v[220:223], a[92:95], a[172:175], 0
M v[220:223], a[88:91], a[168:171], v[220:223]
s_waitcnt lgkmcnt(10)
M v[224:227], a[32:35], a[176:179], 0
s_cmp_eq_u32 s54, s56
s_cselect_b32 s54, s57, s54
s_cselect_b64 s[60:61], s[58:59], s[60:61]
s_cselect_b32 s62, s7, s62
M v[224:227], a[36:39], a[180:183], v[224:227]
M v[228:231], a[44:47], a[180:183], 0
M v[228:231], a[40:43], a[176:179], v[228:231]
M v[232:235], a[48:51], a[176:179], 0
M v[232:235], a[52:55], a[180:183], v[232:235]
M v[236:239], a[60:63], a[180:183], 0
M v[236:239], a[56:59], a[176:179], v[236:239]
s_waitcnt vmcnt(17) lgkmcnt(0)
s_barrier
ds_read_b128 a[160:163], v10 offset:32768
ds_read_b128 a[164:167], v11 offset:32768
M v[240:243], a[64:67], a[176:179], 0
s_add_u32 m0, s29, 16384
s_add_u32 s3, s23, s31
buffer_load_dwordx4 v2, s[8:11], s3 offen offset:0 lds
M v[240:243], a[68:71], a[180:183], v[240:243]
M v[244:247], a[76:79], a[180:183], 0
M v[244:247], a[72:75], a[176:179], v[244:247]
M v[248:251], a[80:83], a[176:179], 0
M v[248:251], a[84:87], a[180:183], v[248:251]
buffer_load_dwordx4 v3, s[8:11], s3 offen offset:1024 lds
M v[252:255], a[92:95], a[180:183], 0
M v[252:255], a[88:91], a[176:179], v[252:255]
M a[0:3], a[32:35], a[184:187], 0
M a[0:3], a[36:39], a[188:191], a[0:3]
ds_read_b128 a[168:171], v10 offset:34816
ds_read_b128 a[172:175], v11 offset:34816
M a[4:7], a[44:47], a[188:191], 0
M a[4:7], a[40:43], a[184:187], a[4:7]
M a[8:11], a[48:51], a[184:187], 0
buffer_load_dwordx4 v4, s[8:11], s3 offen offset:2048 lds
M a[8:11], a[52:55], a[188:191], a[8:11]
M a[12:15], a[60:63], a[188:191], 0
M a[12:15], a[56:59], a[184:187], a[12:15]
M a[16:19], a[64:67], a[184:187], 0
M a[16:19], a[68:71], a[188:191], a[16:19]
buffer_load_dwordx4 v5, s[8:11], s3 offen offset:3072 lds
M a[20:23], a[76:79], a[188:191], 0
M a[20:23], a[72:75], a[184:187], a[20:23]
M a[24:27], a[80:83], a[184:187], 0
M a[24:27], a[84:87], a[188:191], a[24:27]
M a[28:31], a[92:95], a[188:191], 0
M a[28:31], a[88:91], a[184:187], a[28:31]
s_waitcnt lgkmcnt(2)
M v[32:35], a[96:99], a[160:163], v[32:35]
s_add_u32 s23, s23, 128
s_cmp_eq_u32 s23, s25
s_cselect_b32 s23, s26, s23
M v[32:35], a[100:103], a[164:167], v[32:35]
ds_read_b128 a[176:179], v10 offset:36864
ds_read_b128 a[180:183], v11 offset:36864
M v[36:39], a[108:111], a[164:167], v[36:39]
M v[36:39], a[104:107], a[160:163], v[36:39]
ds_read_b64_tr_b16 a[32:33], v12 offset:0
ds_read_b64_tr_b16 a[34:35], v12 offset:2048
M v[40:43], a[112:115], a[160:163], v[40:43]
M v[40:43], a[116:119], a[164:167], v[40:43]
M v[44:47], a[124:127], a[164:167], v[44:47]
s_add_u32 m0, s29, 114688
s_nop 0
buffer_load_dwordx4 v6, s[12:15], s24 offen offset:0 lds
M v[44:47], a[120:123], a[160:163], v[44:47]
ds_read_b64_tr_b16 a[40:41], v13 offset:0
ds_read_b64_tr_b16 a[42:43], v13 offset:2048
M v[48:51], a[128:131], a[160:163], v[48:51]
M v[48:51], a[132:135], a[164:167], v[48:51]
M v[52:55], a[140:143], a[164:167], v[52:55]
M v[52:55], a[136:139], a[160:163], v[52:55]
ds_read_b64_tr_b16 a[48:49], v14 offset:0
ds_read_b64_tr_b16 a[50:51], v14 offset:2048
M v[56:59], a[144:147], a[160:163], v[56:59]
M v[56:59], a[148:151], a[164:167], v[56:59]
buffer_load_dwordx4 v7, s[12:15], s24 offen offset:1024 lds
M v[60:63], a[156:159], a[164:167], v[60:63]
M v[60:63], a[152:155], a[160:163], v[60:63]
s_waitcnt lgkmcnt(8)
ds_read_b64_tr_b16 a[56:57], v15 offset:0
ds_read_b64_tr_b16 a[58:59], v15 offset:2048
M v[64:67], a[96:99], a[168:171], v[64:67]
M v[64:67], a[100:103], a[172:175], v[64:67]
ds_read_b128 a[184:187], v10 offset:38912
ds_read_b128 a[188:191], v11 offset:38912
M v[68:71], a[108:111], a[172:175], v[68:71]
M v[68:71], a[104:107], a[168:171], v[68:71]
ds_read_b64_tr_b16 a[64:65], v16 offset:0
ds_read_b64_tr_b16 a[66:67], v16 offset:2048
M v[72:75], a[112:115], a[168:171], v[72:75]
buffer_load_dwordx4 v8, s[12:15], s24 offen offset:2048 lds
M v[72:75], a[116:119], a[172:175], v[72:75]
M v[76:79], a[124:127], a[172:175], v[76:79]
M v[76:79], a[120:123], a[168:171], v[76:79]
ds_read_b64_tr_b16 a[72:73], v17 offset:0
ds_read_b64_tr_b16 a[74:75], v17 offset:2048
M v[80:83], a[128:131], a[168:171], v[80:83]
M v[80:83], a[132:135], a[172:175], v[80:83]
M v[84:87], a[140:143], a[172:175], v[84:87]
buffer_load_dwordx4 v9, s[12:15], s24 offen offset:3072 lds
M v[84:87], a[136:139], a[168:171], v[84:87]
ds_read_b64_tr_b16 a[80:81], v18 offset:0
ds_read_b64_tr_b16 a[82:83], v18 offset:2048
M v[88:91], a[144:147], a[168:171], v[88:91]
M v[88:91], a[148:151], a[172:175], v[88:91]
M v[92:95], a[156:159], a[172:175], v[92:95]
M v[92:95], a[152:155], a[168:171], v[92:95]
s_waitcnt lgkmcnt(15)
ds_read_b64_tr_b16 a[88:89], v19 offset:0
ds_read_b64_tr_b16 a[90:91], v19 offset:2048
M v[96:99], a[96:99], a[176:179], v[96:99]
s_add_u32 s24, s24, 262144
s_cmp_eq_u32 s24, s27
s_cselect_b32 s24, s28, s24
s_sub_u32 s6, s6, 1
s_cmp_eq_u32 s6, 0
s_cselect_b64 s[12:13], s[64:65], s[12:13]
M v[96:99], a[100:103], a[180:183], v[96:99]
M v[100:103], a[108:111], a[180:183], v[100:103]
M v[100:103], a[104:107], a[176:179], v[100:103]
M v[104:107], a[112:115], a[176:179], v[104:107]
M v[104:107], a[116:119], a[180:183], v[104:107]
M v[108:111], a[124:127], a[180:183], v[108:111]
M v[108:111], a[120:123], a[176:179], v[108:111]
s_waitcnt vmcnt(17) lgkmcnt(0)
s_barrier
ds_read_b128 a[160:163], v10 offset:49152
ds_read_b128 a[164:167], v11 offset:49152
M v[112:115], a[128:131], a[176:179], v[112:115]
s_add_u32 m0, s29, 32768
s_nop 0
buffer_load_dwordx4 v2, s[8:11], s23 offen offset:0 lds
M v[112:115], a[132:135], a[180:183], v[112:115]
M v[116:119], a[140:143], a[180:183], v[116:119]
M v[116:119], a[136:139], a[176:179], v[116:119]
ds_read_b64_tr_b16 a[36:37], v12 offset:16384
ds_read_b64_tr_b16 a[38:39], v12 offset:18432
M v[120:123], a[144:147], a[176:179], v[120:123]
M v[120:123], a[148:151], a[180:183], v[120:123]
buffer_load_dwordx4 v3, s[8:11], s23 offen offset:1024 lds
M v[124:127], a[156:159], a[180:183], v[124:127]
M v[124:127], a[152:155], a[176:179], v[124:127]
M v[128:131], a[96:99], a[184:187], v[128:131]
M v[128:131], a[100:103], a[188:191], v[128:131]
ds_read_b128 a[168:171], v10 offset:51200
ds_read_b128 a[172:175], v11 offset:51200
ds_read_b64_tr_b16 a[44:45], v13 offset:16384
ds_read_b64_tr_b16 a[46:47], v13 offset:18432
M v[132:135], a[108:111], a[188:191], v[132:135]
M v[132:135], a[104:107], a[184:187], v[132:135]
buffer_load_dwordx4 v4, s[8:11], s23 offen offset:2048 lds
M v[136:139], a[112:115], a[184:187], v[136:139]
M v[136:139], a[116:119], a[188:191], v[136:139]
M v[140:143], a[124:127], a[188:191], v[140:143]
M v[140:143], a[120:123], a[184:187], v[140:143]
ds_read_b64_tr_b16 a[52:53], v14 offset:16384
ds_read_b64_tr_b16 a[54:55], v14 offset:18432
M v[144:147], a[128:131], a[184:187], v[144:147]
M v[144:147], a[132:135], a[188:191], v[144:147]
buffer_load_dwordx4 v5, s[8:11], s23 offen offset:3072 lds
M v[148:151], a[140:143], a[188:191], v[148:151]
M v[148:151], a[136:139], a[184:187], v[148:151]
M v[152:155], a[144:147], a[184:187], v[152:155]
M v[152:155], a[148:151], a[188:191], v[152:155]
ds_read_b64_tr_b16 a[60:61], v15 offset:16384
ds_read_b64_tr_b16 a[62:63], v15 offset:18432
M v[156:159], a[156:159], a[188:191], v[156:159]
s_add_u32 m0, s29, 65536
s_nop 0
buffer_load_dwordx4 v6, s[12:15], s24 offen offset:0 lds
M v[156:159], a[152:155], a[184:187], v[156:159]
s_waitcnt lgkmcnt(10)
M v[160:163], a[96:99], a[160:163], v[160:163]
M v[160:163], a[100:103], a[164:167], v[160:163]
ds_read_b128 a[176:179], v10 offset:53248
ds_read_b128 a[180:183], v11 offset:53248
M v[164:167], a[108:111], a[164:167], v[164:167]
M v[164:167], a[104:107], a[160:163], v[164:167]
ds_read_b64_tr_b16 a[68:69], v16 offset:16384
ds_read_b64_tr_b16 a[70:71], v16 offset:18432
M v[168:171], a[112:115], a[160:163], v[168:171]
M v[168:171], a[116:119], a[164:167], v[168:171]
buffer_load_dwordx4 v7, s[12:15], s24 offen offset:1024 lds
M v[172:175], a[124:127], a[164:167], v[172:175]
M v[172:175], a[120:123], a[160:163], v[172:175]
M v[176:179], a[128:131], a[160:163], v[176:179]
M v[176:179], a[132:135], a[164:167], v[176:179]
ds_read_b64_tr_b16 a[76:77], v17 offset:16384
ds_read_b64_tr_b16 a[78:79], v17 offset:18432
M v[180:183], a[140:143], a[164:167], v[180:183]
M v[180:183], a[136:139], a[160:163], v[180:183]
buffer_load_dwordx4 v8, s[12:15], s24 offen offset:2048 lds
M v[184:187], a[144:147], a[160:163], v[184:187]
M v[184:187], a[148:151], a[164:167], v[184:187]
M v[188:191], a[156:159], a[164:167], v[188:191]
M v[188:191], a[152:155], a[160:163], v[188:191]
s_waitcnt lgkmcnt(12)
ds_read_b64_tr_b16 a[84:85], v18 offset:16384
ds_read_b64_tr_b16 a[86:87], v18 offset:18432
M v[192:195], a[96:99], a[168:171], v[192:195]
buffer_load_dwordx4 v9, s[12:15], s24 offen offset:3072 lds
M v[192:195], a[100:103], a[172:175], v[192:195]
ds_read_b128 a[184:187], v10 offset:55296
ds_read_b128 a[188:191], v11 offset:55296
M v[196:199], a[108:111], a[172:175], v[196:199]
M v[196:199], a[104:107], a[168:171], v[196:199]
M v[200:203], a[112:115], a[168:171], v[200:203]
M v[200:203], a[116:119], a[172:175], v[200:203]
ds_read_b64_tr_b16 a[92:93], v19 offset:16384
ds_read_b64_tr_b16 a[94:95], v19 offset:18432
M v[204:207], a[124:127], a[172:175], v[204:207]
s_add_u32 s24, s24, 262144
M v[204:207], a[120:123], a[168:171], v[204:207]
M v[208:211], a[128:131], a[168:171], v[208:211]
M v[208:211], a[132:135], a[172:175], v[208:211]
M v[212:215], a[140:143], a[172:175], v[212:215]
M v[212:215], a[136:139], a[168:171], v[212:215]
buffer_load_dword v21, v20, s[60:63], s54 offen
s_add_u32 s54, s54, s55
M v[216:219], a[144:147], a[168:171], v[216:219]
M v[216:219], a[148:151], a[172:175], v[216:219]
M v[220:223], a[156:159], a[172:175], v[220:223]
M v[220:223], a[152:155], a[168:171], v[220:223]
s_waitcnt lgkmcnt(10)
M v[224:227], a[96:99], a[176:179], v[224:227]
s_cmp_eq_u32 s54, s56
s_cselect_b32 s54, s57, s54
s_cselect_b64 s[60:61], s[58:59], s[60:61]
s_cselect_b32 s62, s7, s62
M v[224:227], a[100:103], a[180:183], v[224:227]
M v[228:231], a[108:111], a[180:183], v[228:231]
M v[228:231], a[104:107], a[176:179], v[228:231]
M v[232:235], a[112:115], a[176:179], v[232:235]
M v[232:235], a[116:119], a[180:183], v[232:235]
M v[236:239], a[124:127], a[180:183], v[236:239]
M v[236:239], a[120:123], a[176:179], v[236:239]
s_waitcnt vmcnt(18) lgkmcnt(0)
s_barrier
ds_read_b128 a[160:163], v10 offset:0
ds_read_b128 a[164:167], v11 offset:0
M v[240:243], a[128:131], a[176:179], v[240:243]
s_add_u32 m0, s29, 49152
s_add_u32 s3, s23, s31
buffer_load_dwordx4 v2, s[8:11], s3 offen offset:0 lds
M v[240:243], a[132:135], a[180:183], v[240:243]
M v[244:247], a[140:143], a[180:183], v[244:247]
M v[244:247], a[136:139], a[176:179], v[244:247]
M v[248:251], a[144:147], a[176:179], v[248:251]
M v[248:251], a[148:151], a[180:183], v[248:251]
buffer_load_dwordx4 v3, s[8:11], s3 offen offset:1024 lds
M v[252:255], a[156:159], a[180:183], v[252:255]
M v[252:255], a[152:155], a[176:179], v[252:255]
M a[0:3], a[96:99], a[184:187], a[0:3]
M a[0:3], a[100:103], a[188:191], a[0:3]
ds_read_b128 a[168:171], v10 offset:2048
ds_read_b128 a[172:175], v11 offset:2048
M a[4:7], a[108:111], a[188:191], a[4:7]
M a[4:7], a[104:107], a[184:187], a[4:7]
M a[8:11], a[112:115], a[184:187], a[8:11]
buffer_load_dwordx4 v4, s[8:11], s3 offen offset:2048 lds
M a[8:11], a[116:119], a[188:191], a[8:11]
M a[12:15], a[124:127], a[188:191], a[12:15]
M a[12:15], a[120:123], a[184:187], a[12:15]
M a[16:19], a[128:131], a[184:187], a[16:19]
M a[16:19], a[132:135], a[188:191], a[16:19]
buffer_load_dwordx4 v5, s[8:11], s3 offen offset:3072 lds
M a[20:23], a[140:143], a[188:191], a[20:23]
M a[20:23], a[136:139], a[184:187], a[20:23]
M a[24:27], a[144:147], a[184:187], a[24:27]
M a[24:27], a[148:151], a[188:191], a[24:27]
M a[28:31], a[156:159], a[188:191], a[28:31]
M a[28:31], a[152:155], a[184:187], a[28:31]
s_waitcnt lgkmcnt(2)
s_mov_b32 s30, 2
Lk1_kl:
M v[32:35], a[32:35], a[160:163], v[32:35]
s_add_u32 s23, s23, 128
s_cmp_eq_u32 s23, s25
s_cselect_b32 s23, s26, s23
M v[32:35], a[36:39], a[164:167], v[32:35]
ds_read_b128 a[176:179], v10 offset:4096
ds_read_b128 a[180:183], v11 offset:4096
M v[36:39], a[44:47], a[164:167], v[36:39]
M v[36:39], a[40:43], a[160:163], v[36:39]
ds_read_b64_tr_b16 a[96:97], v12 offset:32768
ds_read_b64_tr_b16 a[98:99], v12 offset:34816
M v[40:43], a[48:51], a[160:163], v[40:43]
M v[40:43], a[52:55], a[164:167], v[40:43]
M v[44:47], a[60:63], a[164:167], v[44:47]
s_add_u32 m0, s29, 81920
s_nop 0
buffer_load_dwordx4 v6, s[12:15], s24 offen offset:0 lds
M v[44:47], a[56:59], a[160:163], v[44:47]
ds_read_b64_tr_b16 a[104:105], v13 offset:32768
ds_read_b64_tr_b16 a[106:107], v13 offset:34816
M v[48:51], a[64:67], a[160:163], v[48:51]
M v[48:51], a[68:71], a[164:167], v[48:51]
M v[52:55], a[76:79], a[164:167], v[52:55]
M v[52:55], a[72:75], a[160:163], v[52:55]
ds_read_b64_tr_b16 a[112:113], v14 offset:32768
ds_read_b64_tr_b16 a[114:115], v14 offset:34816
M v[56:59], a[80:83], a[160:163], v[56:59]
M v[56:59], a[84:87], a[164:167], v[56:59]
buffer_load_dwordx4 v7, s[12:15], s24 offen offset:1024 lds
M v[60:63], a[92:95], a[164:167], v[60:63]
M v[60:63], a[88:91], a[160:163], v[60:63]
s_waitcnt lgkmcnt(8)
ds_read_b64_tr_b16 a[120:121], v15 offset:32768
ds_read_b64_tr_b16 a[122:123], v15 offset:34816
M v[64:67], a[32:35], a[168:171], v[64:67]
M v[64:67], a[36:39], a[172:175], v[64:67]
ds_read_b128 a[184:187], v10 offset:6144
ds_read_b128 a[188:191], v11 offset:6144
M v[68:71], a[44:47], a[172:175], v[68:71]
M v[68:71], a[40:43], a[168:171], v[68:71]
ds_read_b64_tr_b16 a[128:129], v16 offset:32768
ds_read_b64_tr_b16 a[130:131], v16 offset:34816
M v[72:75], a[48:51], a[168:171], v[72:75]
buffer_load_dwordx4 v8, s[12:15], s24 offen offset:2048 lds
M v[72:75], a[52:55], a[172:175], v[72:75]
M v[76:79], a[60:63], a[172:175], v[76:79]
M v[76:79], a[56:59], a[168:171], v[76:79]
ds_read_b64_tr_b16 a[136:137], v17 offset:32768
ds_read_b64_tr_b16 a[138:139], v17 offset:34816
M v[80:83], a[64:67], a[168:171], v[80:83]
M v[80:83], a[68:71], a[172:175], v[80:83]
M v[84:87], a[76:79], a[172:175], v[84:87]
buffer_load_dwordx4 v9, s[12:15], s24 offen offset:3072 lds
M v[84:87], a[72:75], a[168:171], v[84:87]
ds_read_b64_tr_b16 a[144:145], v18 offset:32768
ds_read_b64_tr_b16 a[146:147], v18 offset:34816
M v[88:91], a[80:83], a[168:171], v[88:91]
M v[88:91], a[84:87], a[172:175], v[88:91]
M v[92:95], a[92:95], a[172:175], v[92:95]
M v[92:95], a[88:91], a[168:171], v[92:95]
s_waitcnt lgkmcnt(15)
ds_read_b64_tr_b16 a[152:153], v19 offset:32768
ds_read_b64_tr_b16 a[154:155], v19 offset:34816
M v[96:99], a[32:35], a[176:179], v[96:99]
s_add_u32 s24, s24, 262144
s_cmp_eq_u32 s24, s27
s_cselect_b32 s24, s28, s24
s_sub_u32 s6, s6, 1
s_cmp_eq_u32 s6, 0
s_cselect_b64 s[12:13], s[64:65], s[12:13]
M v[96:99], a[36:39], a[180:183], v[96:99]
M v[100:103], a[44:47], a[180:183], v[100:103]
M v[100:103], a[40:43], a[176:179], v[100:103]
M v[104:107], a[48:51], a[176:179], v[104:107]
M v[104:107], a[52:55], a[180:183], v[104:107]
M v[108:111], a[60:63], a[180:183], v[108:111]
M v[108:111], a[56:59], a[176:179], v[108:111]
s_waitcnt vmcnt(17) lgkmcnt(0)
s_barrier
ds_read_b128 a[160:163], v10 offset:16384
ds_read_b128 a[164:167], v11 offset:16384
M v[112:115], a[64:67], a[176:179], v[112:115]
s_add_u32 m0, s29, 0
s_nop 0
buffer_load_dwordx4 v2, s[8:11], s23 offen offset:0 lds
M v[112:115], a[68:71], a[180:183], v[112:115]
M v[116:119], a[76:79], a[180:183], v[116:119]
M v[116:119], a[72:75], a[176:179], v[116:119]
ds_read_b64_tr_b16 a[100:101], v12 offset:49152
ds_read_b64_tr_b16 a[102:103], v12 offset:51200
M v[120:123], a[80:83], a[176:179], v[120:123]
M v[120:123], a[84:87], a[180:183], v[120:123]
buffer_load_dwordx4 v3, s[8:11], s23 offen offset:1024 lds
M v[124:127], a[92:95], a[180:183], v[124:127]
M v[124:127], a[88:91], a[176:179], v[124:127]
M v[128:131], a[32:35], a[184:187], v[128:131]
M v[128:131], a[36:39], a[188:191], v[128:131]
ds_read_b128 a[168:171], v10 offset:18432
ds_read_b128 a[172:175], v11 offset:18432
ds_read_b64_tr_b16 a[108:109], v13 offset:49152
ds_read_b64_tr_b16 a[110:111], v13 offset:51200
M v[132:135], a[44:47], a[188:191], v[132:135]
M v[132:135], a[40:43], a[184:187], v[132:135]
buffer_load_dwordx4 v4, s[8:11], s23 offen offset:2048 lds
M v[136:139], a[48:51], a[184:187], v[136:139]
M v[136:139], a[52:55], a[188:191], v[136:139]
M v[140:143], a[60:63], a[188:191], v[140:143]
M v[140:143], a[56:59], a[184:187], v[140:143]
ds_read_b64_tr_b16 a[116:117], v14 offset:49152
ds_read_b64_tr_b16 a[118:119], v14 offset:51200
M v[144:147], a[64:67], a[184:187], v[144:147]
M v[144:147], a[68:71], a[188:191], v[144:147]
buffer_load_dwordx4 v5, s[8:11], s23 offen offset:3072 lds
M v[148:151], a[76:79], a[188:191], v[148:151]
M v[148:151], a[72:75], a[184:187], v[148:151]
M v[152:155], a[80:83], a[184:187], v[152:155]
M v[152:155], a[84:87], a[188:191], v[152:155]
ds_read_b64_tr_b16 a[124:125], v15 offset:49152
ds_read_b64_tr_b16 a[126:127], v15 offset:51200
M v[156:159], a[92:95], a[188:191], v[156:159]
s_add_u32 m0, s29, 98304
s_nop 0
buffer_load_dwordx4 v6, s[12:15], s24 offen offset:0 lds
M v[156:159], a[88:91], a[184:187], v[156:159]
s_waitcnt lgkmcnt(10)
M v[160:163], a[32:35], a[160:163], v[160:163]
M v[160:163], a[36:39], a[164:167], v[160:163]
ds_read_b128 a[176:179], v10 offset:20480
ds_read_b128 a[180:183], v11 offset:20480
M v[164:167], a[44:47], a[164:167], v[164:167]
M v[164:167], a[40:43], a[160:163], v[164:167]
ds_read_b64_tr_b16 a[132:133], v16 offset:49152
ds_read_b64_tr_b16 a[134:135], v16 offset:51200
M v[168:171], a[48:51], a[160:163], v[168:171]
M v[168:171], a[52:55], a[164:167], v[168:171]
buffer_load_dwordx4 v7, s[12:15], s24 offen offset:1024 lds
M v[172:175], a[60:63], a[164:167], v[172:175]
M v[172:175], a[56:59], a[160:163], v[172:175]
M v[176:179], a[64:67], a[160:163], v[176:179]
M v[176:179], a[68:71], a[164:167], v[176:179]
ds_read_b64_tr_b16 a[140:141], v17 offset:49152
ds_read_b64_tr_b16 a[142:143], v17 offset:51200
M v[180:183], a[76:79], a[164:167], v[180:183]
M v[180:183], a[72:75], a[160:163], v[180:183]
buffer_load_dwordx4 v8, s[12:15], s24 offen offset:2048 lds
M v[184:187], a[80:83], a[160:163], v[184:187]
M v[184:187], a[84:87], a[164:167], v[184:187]
M v[188:191], a[92:95], a[164:167], v[188:191]
M v[188:191], a[88:91], a[160:163], v[188:191]
s_waitcnt lgkmcnt(12)
ds_read_b64_tr_b16 a[148:149], v18 offset:49152
ds_read_b64_tr_b16 a[150:151], v18 offset:51200
M v[192:195], a[32:35], a[168:171], v[192:195]
buffer_load_dwordx4 v9, s[12:15], s24 offen offset:3072 lds
M v[192:195], a[36:39], a[172:175], v[192:195]
ds_read_b128 a[184:187], v10 offset:22528
ds_read_b128 a[188:191], v11 offset:22528
M v[196:199], a[44:47], a[172:175], v[196:199]
M v[196:199], a[40:43], a[168:171], v[196:199]
M v[200:203], a[48:51], a[168:171], v[200:203]
M v[200:203], a[52:55], a[172:175], v[200:203]
ds_read_b64_tr_b16 a[156:157], v19 offset:49152
ds_read_b64_tr_b16 a[158:159], v19 offset:51200
M v[204:207], a[60:63], a[172:175], v[204:207]
s_add_u32 s24, s24, 262144
M v[204:207], a[56:59], a[168:171], v[204:207]
M v[208:211], a[64:67], a[168:171], v[208:211]
M v[208:211], a[68:71], a[172:175], v[208:211]
M v[212:215], a[76:79], a[172:175], v[212:215]
M v[212:215], a[72:75], a[168:171], v[212:215]
buffer_load_dword v21, v20, s[60:63], s54 offen
s_add_u32 s54, s54, s55
M v[216:219], a[80:83], a[168:171], v[216:219]
M v[216:219], a[84:87], a[172:175], v[216:219]
M v[220:223], a[92:95], a[172:175], v[220:223]
M v[220:223], a[88:91], a[168:171], v[220:223]
s_waitcnt lgkmcnt(10)
M v[224:227], a[32:35], a[176:179], v[224:227]
s_cmp_eq_u32 s54, s56
s_cselect_b32 s54, s57, s54
s_cselect_b64 s[60:61], s[58:59], s[60:61]
s_cselect_b32 s62, s7, s62
M v[224:227], a[36:39], a[180:183], v[224:227]
M v[228:231], a[44:47], a[180:183], v[228:231]
M v[228:231], a[40:43], a[176:179], v[228:231]
M v[232:235], a[48:51], a[176:179], v[232:235]
M v[232:235], a[52:55], a[180:183], v[232:235]
M v[236:239], a[60:63], a[180:183], v[236:239]
M v[236:239], a[56:59], a[176:179], v[236:239]
s_waitcnt vmcnt(18) lgkmcnt(0)
s_barrier
ds_read_b128 a[160:163], v10 offset:32768
ds_read_b128 a[164:167], v11 offset:32768
M v[240:243], a[64:67], a[176:179], v[240:243]
s_add_u32 m0, s29, 16384
s_add_u32 s3, s23, s31
buffer_load_dwordx4 v2, s[8:11], s3 offen offset:0 lds
M v[240:243], a[68:71], a[180:183], v[240:243]
M v[244:247], a[76:79], a[180:183], v[244:247]
M v[244:247], a[72:75], a[176:179], v[244:247]
M v[248:251], a[80:83], a[176:179], v[248:251]
M v[248:251], a[84:87], a[180:183], v[248:251]
buffer_load_dwordx4 v3, s[8:11], s3 offen offset:1024 lds
M v[252:255], a[92:95], a[180:183], v[252:255]
M v[252:255], a[88:91], a[176:179], v[252:255]
M a[0:3], a[32:35], a[184:187], a[0:3]
M a[0:3], a[36:39], a[188:191], a[0:3]
ds_read_b128 a[168:171], v10 offset:34816
ds_read_b128 a[172:175], v11 offset:34816
M a[4:7], a[44:47], a[188:191], a[4:7]
M a[4:7], a[40:43], a[184:187], a[4:7]
M a[8:11], a[48:51], a[184:187], a[8:11]
buffer_load_dwordx4 v4, s[8:11], s3 offen offset:2048 lds
M a[8:11], a[52:55], a[188:191], a[8:11]
M a[12:15], a[60:63], a[188:191], a[12:15]
M a[12:15], a[56:59], a[184:187], a[12:15]
M a[16:19], a[64:67], a[184:187], a[16:19]
M a[16:19], a[68:71], a[188:191], a[16:19]
buffer_load_dwordx4 v5, s[8:11], s3 offen offset:3072 lds
M a[20:23], a[76:79], a[188:191], a[20:23]
M a[20:23], a[72:75], a[184:187], a[20:23]
M a[24:27], a[80:83], a[184:187], a[24:27]
M a[24:27], a[84:87], a[188:191], a[24:27]
M a[28:31], a[92:95], a[188:191], a[28:31]
M a[28:31], a[88:91], a[184:187], a[28:31]
s_waitcnt lgkmcnt(2)
M v[32:35], a[96:99], a[160:163], v[32:35]
s_add_u32 s23, s23, 128
s_cmp_eq_u32 s23, s25
s_cselect_b32 s23, s26, s23
M v[32:35], a[100:103], a[164:167], v[32:35]
ds_read_b128 a[176:179], v10 offset:36864
ds_read_b128 a[180:183], v11 offset:36864
M v[36:39], a[108:111], a[164:167], v[36:39]
M v[36:39], a[104:107], a[160:163], v[36:39]
ds_read_b64_tr_b16 a[32:33], v12 offset:0
ds_read_b64_tr_b16 a[34:35], v12 offset:2048
M v[40:43], a[112:115], a[160:163], v[40:43]
M v[40:43], a[116:119], a[164:167], v[40:43]
M v[44:47], a[124:127], a[164:167], v[44:47]
s_add_u32 m0, s29, 114688
s_nop 0
buffer_load_dwordx4 v6, s[12:15], s24 offen offset:0 lds
M v[44:47], a[120:123], a[160:163], v[44:47]
ds_read_b64_tr_b16 a[40:41], v13 offset:0
ds_read_b64_tr_b16 a[42:43], v13 offset:2048
M v[48:51], a[128:131], a[160:163], v[48:51]
M v[48:51], a[132:135], a[164:167], v[48:51]
M v[52:55], a[140:143], a[164:167], v[52:55]
M v[52:55], a[136:139], a[160:163], v[52:55]
ds_read_b64_tr_b16 a[48:49], v14 offset:0
ds_read_b64_tr_b16 a[50:51], v14 offset:2048
M v[56:59], a[144:147], a[160:163], v[56:59]
M v[56:59], a[148:151], a[164:167], v[56:59]
buffer_load_dwordx4 v7, s[12:15], s24 offen offset:1024 lds
M v[60:63], a[156:159], a[164:167], v[60:63]
M v[60:63], a[152:155], a[160:163], v[60:63]
s_waitcnt lgkmcnt(8)
ds_read_b64_tr_b16 a[56:57], v15 offset:0
ds_read_b64_tr_b16 a[58:59], v15 offset:2048
M v[64:67], a[96:99], a[168:171], v[64:67]
M v[64:67], a[100:103], a[172:175], v[64:67]
ds_read_b128 a[184:187], v10 offset:38912
ds_read_b128 a[188:191], v11 offset:38912
M v[68:71], a[108:111], a[172:175], v[68:71]
M v[68:71], a[104:107], a[168:171], v[68:71]
ds_read_b64_tr_b16 a[64:65], v16 offset:0
ds_read_b64_tr_b16 a[66:67], v16 offset:2048
M v[72:75], a[112:115], a[168:171], v[72:75]
buffer_load_dwordx4 v8, s[12:15], s24 offen offset:2048 lds
M v[72:75], a[116:119], a[172:175], v[72:75]
M v[76:79], a[124:127], a[172:175], v[76:79]
M v[76:79], a[120:123], a[168:171], v[76:79]
ds_read_b64_tr_b16 a[72:73], v17 offset:0
ds_read_b64_tr_b16 a[74:75], v17 offset:2048
M v[80:83], a[128:131], a[168:171], v[80:83]
M v[80:83], a[132:135], a[172:175], v[80:83]
M v[84:87], a[140:143], a[172:175], v[84:87]
buffer_load_dwordx4 v9, s[12:15], s24 offen offset:3072 lds
M v[84:87], a[136:139], a[168:171], v[84:87]
ds_read_b64_tr_b16 a[80:81], v18 offset:0
ds_read_b64_tr_b16 a[82:83], v18 offset:2048
M v[88:91], a[144:147], a[168:171], v[88:91]
M v[88:91], a[148:151], a[172:175], v[88:91]
M v[92:95], a[156:159], a[172:175], v[92:95]
M v[92:95], a[152:155], a[168:171], v[92:95]
s_waitcnt lgkmcnt(15)
ds_read_b64_tr_b16 a[88:89], v19 offset:0
ds_read_b64_tr_b16 a[90:91], v19 offset:2048
M v[96:99], a[96:99], a[176:179], v[96:99]
s_add_u32 s24, s24, 262144
s_cmp_eq_u32 s24, s27
s_cselect_b32 s24, s28, s24
s_sub_u32 s6, s6, 1
s_cmp_eq_u32 s6, 0
s_cselect_b64 s[12:13], s[64:65], s[12:13]
M v[96:99], a[100:103], a[180:183], v[96:99]
M v[100:103], a[108:111], a[180:183], v[100:103]
M v[100:103], a[104:107], a[176:179], v[100:103]
M v[104:107], a[112:115], a[176:179], v[104:107]
M v[104:107], a[116:119], a[180:183], v[104:107]
M v[108:111], a[124:127], a[180:183], v[108:111]
M v[108:111], a[120:123], a[176:179], v[108:111]
s_waitcnt vmcnt(17) lgkmcnt(0)
s_barrier
ds_read_b128 a[160:163], v10 offset:49152
ds_read_b128 a[164:167], v11 offset:49152
M v[112:115], a[128:131], a[176:179], v[112:115]
s_add_u32 m0, s29, 32768
s_nop 0
buffer_load_dwordx4 v2, s[8:11], s23 offen offset:0 lds
M v[112:115], a[132:135], a[180:183], v[112:115]
M v[116:119], a[140:143], a[180:183], v[116:119]
M v[116:119], a[136:139], a[176:179], v[116:119]
ds_read_b64_tr_b16 a[36:37], v12 offset:16384
ds_read_b64_tr_b16 a[38:39], v12 offset:18432
M v[120:123], a[144:147], a[176:179], v[120:123]
M v[120:123], a[148:151], a[180:183], v[120:123]
buffer_load_dwordx4 v3, s[8:11], s23 offen offset:1024 lds
M v[124:127], a[156:159], a[180:183], v[124:127]
M v[124:127], a[152:155], a[176:179], v[124:127]
M v[128:131], a[96:99], a[184:187], v[128:131]
M v[128:131], a[100:103], a[188:191], v[128:131]
ds_read_b128 a[168:171], v10 offset:51200
ds_read_b128 a[172:175], v11 offset:51200
ds_read_b64_tr_b16 a[44:45], v13 offset:16384
ds_read_b64_tr_b16 a[46:47], v13 offset:18432
M v[132:135], a[108:111], a[188:191], v[132:135]
M v[132:135], a[104:107], a[184:187], v[132:135]
buffer_load_dwordx4 v4, s[8:11], s23 offen offset:2048 lds
M v[136:139], a[112:115], a[184:187], v[136:139]
M v[136:139], a[116:119], a[188:191], v[136:139]
M v[140:143], a[124:127], a[188:191], v[140:143]
M v[140:143], a[120:123], a[184:187], v[140:143]
ds_read_b64_tr_b16 a[52:53], v14 offset:16384
ds_read_b64_tr_b16 a[54:55], v14 offset:18432
M v[144:147], a[128:131], a[184:187], v[144:147]
M v[144:147], a[132:135], a[188:191], v[144:147]
buffer_load_dwordx4 v5, s[8:11], s23 offen offset:3072 lds
M v[148:151], a[140:143], a[188:191], v[148:151]
M v[148:151], a[136:139], a[184:187], v[148:151]
M v[152:155], a[144:147], a[184:187], v[152:155]
M v[152:155], a[148:151], a[188:191], v[152:155]
ds_read_b64_tr_b16 a[60:61], v15 offset:16384
ds_read_b64_tr_b16 a[62:63], v15 offset:18432
M v[156:159], a[156:159], a[188:191], v[156:159]
s_add_u32 m0, s29, 65536
s_nop 0
buffer_load_dwordx4 v6, s[12:15], s24 offen offset:0 lds
M v[156:159], a[152:155], a[184:187], v[156:159]
s_waitcnt lgkmcnt(10)
M v[160:163], a[96:99], a[160:163], v[160:163]
M v[160:163], a[100:103], a[164:167], v[160:163]
ds_read_b128 a[176:179], v10 offset:53248
ds_read_b128 a[180:183], v11 offset:53248
M v[164:167], a[108:111], a[164:167], v[164:167]
M v[164:167], a[104:107], a[160:163], v[164:167]
ds_read_b64_tr_b16 a[68:69], v16 offset:16384
ds_read_b64_tr_b16 a[70:71], v16 offset:18432
M v[168:171], a[112:115], a[160:163], v[168:171]
M v[168:171], a[116:119], a[164:167], v[168:171]
buffer_load_dwordx4 v7, s[12:15], s24 offen offset:1024 lds
M v[172:175], a[124:127], a[164:167], v[172:175]
M v[172:175], a[120:123], a[160:163], v[172:175]
M v[176:179], a[128:131], a[160:163], v[176:179]
M v[176:179], a[132:135], a[164:167], v[176:179]
ds_read_b64_tr_b16 a[76:77], v17 offset:16384
ds_read_b64_tr_b16 a[78:79], v17 offset:18432
M v[180:183], a[140:143], a[164:167], v[180:183]
M v[180:183], a[136:139], a[160:163], v[180:183]
buffer_load_dwordx4 v8, s[12:15], s24 offen offset:2048 lds
M v[184:187], a[144:147], a[160:163], v[184:187]
M v[184:187], a[148:151], a[164:167], v[184:187]
M v[188:191], a[156:159], a[164:167], v[188:191]
M v[188:191], a[152:155], a[160:163], v[188:191]
s_waitcnt lgkmcnt(12)
ds_read_b64_tr_b16 a[84:85], v18 offset:16384
ds_read_b64_tr_b16 a[86:87], v18 offset:18432
M v[192:195], a[96:99], a[168:171], v[192:195]
buffer_load_dwordx4 v9, s[12:15], s24 offen offset:3072 lds
M v[192:195], a[100:103], a[172:175], v[192:195]
ds_read_b128 a[184:187], v10 offset:55296
ds_read_b128 a[188:191], v11 offset:55296
M v[196:199], a[108:111], a[172:175], v[196:199]
M v[196:199], a[104:107], a[168:171], v[196:199]
M v[200:203], a[112:115], a[168:171], v[200:203]
M v[200:203], a[116:119], a[172:175], v[200:203]
ds_read_b64_tr_b16 a[92:93], v19 offset:16384
ds_read_b64_tr_b16 a[94:95], v19 offset:18432
M v[204:207], a[124:127], a[172:175], v[204:207]
s_add_u32 s24, s24, 262144
M v[204:207], a[120:123], a[168:171], v[204:207]
M v[208:211], a[128:131], a[168:171], v[208:211]
M v[208:211], a[132:135], a[172:175], v[208:211]
M v[212:215], a[140:143], a[172:175], v[212:215]
M v[212:215], a[136:139], a[168:171], v[212:215]
buffer_load_dword v21, v20, s[60:63], s54 offen
s_add_u32 s54, s54, s55
M v[216:219], a[144:147], a[168:171], v[216:219]
M v[216:219], a[148:151], a[172:175], v[216:219]
M v[220:223], a[156:159], a[172:175], v[220:223]
M v[220:223], a[152:155], a[168:171], v[220:223]
s_waitcnt lgkmcnt(10)
M v[224:227], a[96:99], a[176:179], v[224:227]
s_cmp_eq_u32 s54, s56
s_cselect_b32 s54, s57, s54
s_cselect_b64 s[60:61], s[58:59], s[60:61]
s_cselect_b32 s62, s7, s62
M v[224:227], a[100:103], a[180:183], v[224:227]
M v[228:231], a[108:111], a[180:183], v[228:231]
M v[228:231], a[104:107], a[176:179], v[228:231]
M v[232:235], a[112:115], a[176:179], v[232:235]
M v[232:235], a[116:119], a[180:183], v[232:235]
M v[236:239], a[124:127], a[180:183], v[236:239]
M v[236:239], a[120:123], a[176:179], v[236:239]
s_waitcnt vmcnt(18) lgkmcnt(0)
s_barrier
ds_read_b128 a[160:163], v10 offset:0
ds_read_b128 a[164:167], v11 offset:0
M v[240:243], a[128:131], a[176:179], v[240:243]
s_add_u32 m0, s29, 49152
s_add_u32 s3, s23, s31
buffer_load_dwordx4 v2, s[8:11], s3 offen offset:0 lds
M v[240:243], a[132:135], a[180:183], v[240:243]
M v[244:247], a[140:143], a[180:183], v[244:247]
M v[244:247], a[136:139], a[176:179], v[244:247]
M v[248:251], a[144:147], a[176:179], v[248:251]
M v[248:251], a[148:151], a[180:183], v[248:251]
buffer_load_dwordx4 v3, s[8:11], s3 offen offset:1024 lds
M v[252:255], a[156:159], a[180:183], v[252:255]
M v[252:255], a[152:155], a[176:179], v[252:255]
M a[0:3], a[96:99], a[184:187], a[0:3]
M a[0:3], a[100:103], a[188:191], a[0:3]
ds_read_b128 a[168:171], v10 offset:2048
ds_read_b128 a[172:175], v11 offset:2048
M a[4:7], a[108:111], a[188:191], a[4:7]
M a[4:7], a[104:107], a[184:187], a[4:7]
M a[8:11], a[112:115], a[184:187], a[8:11]
buffer_load_dwordx4 v4, s[8:11], s3 offen offset:2048 lds
M a[8:11], a[116:119], a[188:191], a[8:11]
M a[12:15], a[124:127], a[188:191], a[12:15]
M a[12:15], a[120:123], a[184:187], a[12:15]
M a[16:19], a[128:131], a[184:187], a[16:19]
M a[16:19], a[132:135], a[188:191], a[16:19]
buffer_load_dwordx4 v5, s[8:11], s3 offen offset:3072 lds
M a[20:23], a[140:143], a[188:191], a[20:23]
M a[20:23], a[136:139], a[184:187], a[20:23]
M a[24:27], a[144:147], a[184:187], a[24:27]
M a[24:27], a[148:151], a[188:191], a[24:27]
M a[28:31], a[156:159], a[188:191], a[28:31]
M a[28:31], a[152:155], a[184:187], a[28:31]
s_waitcnt lgkmcnt(2)
s_sub_u32 s30, s30, 1
s_cmp_lg_u32 s30, 0
s_cbranch_scc1 Lk1_kl
M v[32:35], a[32:35], a[160:163], v[32:35]
s_add_u32 s23, s23, 128
s_cmp_eq_u32 s23, s25
s_cselect_b32 s23, s26, s23
M v[32:35], a[36:39], a[164:167], v[32:35]
ds_read_b128 a[176:179], v10 offset:4096
ds_read_b128 a[180:183], v11 offset:4096
M v[36:39], a[44:47], a[164:167], v[36:39]
M v[36:39], a[40:43], a[160:163], v[36:39]
ds_read_b64_tr_b16 a[96:97], v12 offset:32768
ds_read_b64_tr_b16 a[98:99], v12 offset:34816
M v[40:43], a[48:51], a[160:163], v[40:43]
M v[40:43], a[52:55], a[164:167], v[40:43]
M v[44:47], a[60:63], a[164:167], v[44:47]
s_add_u32 m0, s29, 81920
s_nop 0
buffer_load_dwordx4 v6, s[12:15], s24 offen offset:0 lds
M v[44:47], a[56:59], a[160:163], v[44:47]
ds_read_b64_tr_b16 a[104:105], v13 offset:32768
ds_read_b64_tr_b16 a[106:107], v13 offset:34816
M v[48:51], a[64:67], a[160:163], v[48:51]
M v[48:51], a[68:71], a[164:167], v[48:51]
M v[52:55], a[76:79], a[164:167], v[52:55]
M v[52:55], a[72:75], a[160:163], v[52:55]
ds_read_b64_tr_b16 a[112:113], v14 offset:32768
ds_read_b64_tr_b16 a[114:115], v14 offset:34816
M v[56:59], a[80:83], a[160:163], v[56:59]
M v[56:59], a[84:87], a[164:167], v[56:59]
buffer_load_dwordx4 v7, s[12:15], s24 offen offset:1024 lds
M v[60:63], a[92:95], a[164:167], v[60:63]
M v[60:63], a[88:91], a[160:163], v[60:63]
s_waitcnt lgkmcnt(8)
ds_read_b64_tr_b16 a[120:121], v15 offset:32768
ds_read_b64_tr_b16 a[122:123], v15 offset:34816
M v[64:67], a[32:35], a[168:171], v[64:67]
M v[64:67], a[36:39], a[172:175], v[64:67]
ds_read_b128 a[184:187], v10 offset:6144
ds_read_b128 a[188:191], v11 offset:6144
M v[68:71], a[44:47], a[172:175], v[68:71]
M v[68:71], a[40:43], a[168:171], v[68:71]
ds_read_b64_tr_b16 a[128:129], v16 offset:32768
ds_read_b64_tr_b16 a[130:131], v16 offset:34816
M v[72:75], a[48:51], a[168:171], v[72:75]
buffer_load_dwordx4 v8, s[12:15], s24 offen offset:2048 lds
M v[72:75], a[52:55], a[172:175], v[72:75]
M v[76:79], a[60:63], a[172:175], v[76:79]
M v[76:79], a[56:59], a[168:171], v[76:79]
ds_read_b64_tr_b16 a[136:137], v17 offset:32768
ds_read_b64_tr_b16 a[138:139], v17 offset:34816
M v[80:83], a[64:67], a[168:171], v[80:83]
M v[80:83], a[68:71], a[172:175], v[80:83]
M v[84:87], a[76:79], a[172:175], v[84:87]
buffer_load_dwordx4 v9, s[12:15], s24 offen offset:3072 lds
M v[84:87], a[72:75], a[168:171], v[84:87]
ds_read_b64_tr_b16 a[144:145], v18 offset:32768
ds_read_b64_tr_b16 a[146:147], v18 offset:34816
M v[88:91], a[80:83], a[168:171], v[88:91]
M v[88:91], a[84:87], a[172:175], v[88:91]
M v[92:95], a[92:95], a[172:175], v[92:95]
M v[92:95], a[88:91], a[168:171], v[92:95]
s_waitcnt lgkmcnt(15)
ds_read_b64_tr_b16 a[152:153], v19 offset:32768
ds_read_b64_tr_b16 a[154:155], v19 offset:34816
M v[96:99], a[32:35], a[176:179], v[96:99]
s_add_u32 s24, s24, 262144
s_cmp_eq_u32 s24, s27
s_cselect_b32 s24, s28, s24
s_sub_u32 s6, s6, 1
s_cmp_eq_u32 s6, 0
s_cselect_b64 s[12:13], s[64:65], s[12:13]
M v[96:99], a[36:39], a[180:183], v[96:99]
M v[100:103], a[44:47], a[180:183], v[100:103]
M v[100:103], a[40:43], a[176:179], v[100:103]
M v[104:107], a[48:51], a[176:179], v[104:107]
M v[104:107], a[52:55], a[180:183], v[104:107]
M v[108:111], a[60:63], a[180:183], v[108:111]
M v[108:111], a[56:59], a[176:179], v[108:111]
s_waitcnt vmcnt(17) lgkmcnt(0)
s_barrier
ds_read_b128 a[160:163], v10 offset:16384
ds_read_b128 a[164:167], v11 offset:16384
M v[112:115], a[64:67], a[176:179], v[112:115]
s_add_u32 m0, s29, 0
s_nop 0
buffer_load_dwordx4 v2, s[8:11], s23 offen offset:0 lds
M v[112:115], a[68:71], a[180:183], v[112:115]
M v[116:119], a[76:79], a[180:183], v[116:119]
M v[116:119], a[72:75], a[176:179], v[116:119]
ds_read_b64_tr_b16 a[100:101], v12 offset:49152
ds_read_b64_tr_b16 a[102:103], v12 offset:51200
M v[120:123], a[80:83], a[176:179], v[120:123]
M v[120:123], a[84:87], a[180:183], v[120:123]
buffer_load_dwordx4 v3, s[8:11], s23 offen offset:1024 lds
M v[124:127], a[92:95], a[180:183], v[124:127]
M v[124:127], a[88:91], a[176:179], v[124:127]
M v[128:131], a[32:35], a[184:187], v[128:131]
M v[128:131], a[36:39], a[188:191], v[128:131]
ds_read_b128 a[168:171], v10 offset:18432
ds_read_b128 a[172:175], v11 offset:18432
ds_read_b64_tr_b16 a[108:109], v13 offset:49152
ds_read_b64_tr_b16 a[110:111], v13 offset:51200
M v[132:135], a[44:47], a[188:191], v[132:135]
M v[132:135], a[40:43], a[184:187], v[132:135]
buffer_load_dwordx4 v4, s[8:11], s23 offen offset:2048 lds
M v[136:139], a[48:51], a[184:187], v[136:139]
M v[136:139], a[52:55], a[188:191], v[136:139]
M v[140:143], a[60:63], a[188:191], v[140:143]
M v[140:143], a[56:59], a[184:187], v[140:143]
ds_read_b64_tr_b16 a[116:117], v14 offset:49152
ds_read_b64_tr_b16 a[118:119], v14 offset:51200
M v[144:147], a[64:67], a[184:187], v[144:147]
M v[144:147], a[68:71], a[188:191], v[144:147]
buffer_load_dwordx4 v5, s[8:11], s23 offen offset:3072 lds
M v[148:151], a[76:79], a[188:191], v[148:151]
M v[148:151], a[72:75], a[184:187], v[148:151]
M v[152:155], a[80:83], a[184:187], v[152:155]
s_lshr_b32 s3, s53, 7
s_add_u32 s3, s3, s22
M v[152:155], a[84:87], a[188:191], v[152:155]
ds_read_b64_tr_b16 a[124:125], v15 offset:49152
ds_read_b64_tr_b16 a[126:127], v15 offset:51200
s_lshl_b32 s3, s3, 5
s_lshr_b32 s19, s52, 6
M v[156:159], a[92:95], a[188:191], v[156:159]
s_add_u32 m0, s29, 98304
s_nop 0
buffer_load_dwordx4 v6, s[12:15], s24 offen offset:0 lds
s_add_u32 s3, s3, s19
s_lshl_b32 s19, s21, 1
M v[156:159], a[88:91], a[184:187], v[156:159]
s_waitcnt lgkmcnt(10)
s_add_u32 s3, s3, s19
s_lshl_b32 s92, s3, 15
M v[160:163], a[32:35], a[160:163], v[160:163]
s_add_u32 s93, s92, 32768
s_add_u32 s16, s50, 16777216
M v[160:163], a[36:39], a[164:167], v[160:163]
ds_read_b128 a[176:179], v10 offset:20480
ds_read_b128 a[180:183], v11 offset:20480
s_addc_u32 s17, s51, 0
s_mov_b32 s18, 33554432
M v[164:167], a[44:47], a[164:167], v[164:167]
s_mov_b32 s19, 0x00020000
M v[164:167], a[40:43], a[160:163], v[164:167]
ds_read_b64_tr_b16 a[132:133], v16 offset:49152
ds_read_b64_tr_b16 a[134:135], v16 offset:51200
M v[168:171], a[48:51], a[160:163], v[168:171]
M v[168:171], a[52:55], a[164:167], v[168:171]
buffer_load_dwordx4 v7, s[12:15], s24 offen offset:1024 lds
M v[172:175], a[60:63], a[164:167], v[172:175]
M v[172:175], a[56:59], a[160:163], v[172:175]
M v[176:179], a[64:67], a[160:163], v[176:179]
M v[176:179], a[68:71], a[164:167], v[176:179]
ds_read_b64_tr_b16 a[140:141], v17 offset:49152
ds_read_b64_tr_b16 a[142:143], v17 offset:51200
M v[180:183], a[76:79], a[164:167], v[180:183]
M v[180:183], a[72:75], a[160:163], v[180:183]
buffer_load_dwordx4 v8, s[12:15], s24 offen offset:2048 lds
M v[184:187], a[80:83], a[160:163], v[184:187]
M v[184:187], a[84:87], a[164:167], v[184:187]
M v[188:191], a[92:95], a[164:167], v[188:191]
M v[188:191], a[88:91], a[160:163], v[188:191]
s_waitcnt lgkmcnt(12)
ds_read_b64_tr_b16 a[148:149], v18 offset:49152
ds_read_b64_tr_b16 a[150:151], v18 offset:51200
M v[192:195], a[32:35], a[168:171], v[192:195]
buffer_load_dwordx4 v9, s[12:15], s24 offen offset:3072 lds
M v[192:195], a[36:39], a[172:175], v[192:195]
ds_read_b128 a[184:187], v10 offset:22528
ds_read_b128 a[188:191], v11 offset:22528
M v[196:199], a[44:47], a[172:175], v[196:199]
M v[196:199], a[40:43], a[168:171], v[196:199]
M v[200:203], a[48:51], a[168:171], v[200:203]
M v[200:203], a[52:55], a[172:175], v[200:203]
ds_read_b64_tr_b16 a[156:157], v19 offset:49152
ds_read_b64_tr_b16 a[158:159], v19 offset:51200
M v[204:207], a[60:63], a[172:175], v[204:207]
s_add_u32 s24, s24, 262144
M v[204:207], a[56:59], a[168:171], v[204:207]
M v[208:211], a[64:67], a[168:171], v[208:211]
M v[208:211], a[68:71], a[172:175], v[208:211]
M v[212:215], a[76:79], a[172:175], v[212:215]
M v[212:215], a[72:75], a[168:171], v[212:215]
buffer_load_dword v21, v20, s[60:63], s54 offen
s_add_u32 s54, s54, s55
M v[216:219], a[80:83], a[168:171], v[216:219]
M v[216:219], a[84:87], a[172:175], v[216:219]
M v[220:223], a[92:95], a[172:175], v[220:223]
M v[220:223], a[88:91], a[168:171], v[220:223]
s_waitcnt lgkmcnt(10)
M v[224:227], a[32:35], a[176:179], v[224:227]
s_cmp_eq_u32 s54, s56
s_cselect_b32 s54, s57, s54
s_cselect_b64 s[60:61], s[58:59], s[60:61]
s_cselect_b32 s62, s7, s62
M v[224:227], a[36:39], a[180:183], v[224:227]
M v[228:231], a[44:47], a[180:183], v[228:231]
M v[228:231], a[40:43], a[176:179], v[228:231]
M v[232:235], a[48:51], a[176:179], v[232:235]
M v[232:235], a[52:55], a[180:183], v[232:235]
M v[236:239], a[60:63], a[180:183], v[236:239]
M v[236:239], a[56:59], a[176:179], v[236:239]
s_waitcnt vmcnt(18) lgkmcnt(0)
s_barrier
ds_read_b128 a[160:163], v10 offset:32768
ds_read_b128 a[164:167], v11 offset:32768
M v[240:243], a[64:67], a[176:179], v[240:243]
s_add_u32 m0, s29, 16384
s_add_u32 s3, s23, s31
buffer_load_dwordx4 v2, s[8:11], s3 offen offset:0 lds
M v[240:243], a[68:71], a[180:183], v[240:243]
M v[244:247], a[76:79], a[180:183], v[244:247]
M v[244:247], a[72:75], a[176:179], v[244:247]
M v[248:251], a[80:83], a[176:179], v[248:251]
M v[248:251], a[84:87], a[180:183], v[248:251]
buffer_load_dwordx4 v3, s[8:11], s3 offen offset:1024 lds
M v[252:255], a[92:95], a[180:183], v[252:255]
M v[252:255], a[88:91], a[176:179], v[252:255]
M a[0:3], a[32:35], a[184:187], a[0:3]
M a[0:3], a[36:39], a[188:191], a[0:3]
ds_read_b128 a[168:171], v10 offset:34816
ds_read_b128 a[172:175], v11 offset:34816
M a[4:7], a[44:47], a[188:191], a[4:7]
M a[4:7], a[40:43], a[184:187], a[4:7]
M a[8:11], a[48:51], a[184:187], a[8:11]
buffer_load_dwordx4 v4, s[8:11], s3 offen offset:2048 lds
M a[8:11], a[52:55], a[188:191], a[8:11]
M a[12:15], a[60:63], a[188:191], a[12:15]
M a[12:15], a[56:59], a[184:187], a[12:15]
M a[16:19], a[64:67], a[184:187], a[16:19]
M a[16:19], a[68:71], a[188:191], a[16:19]
buffer_load_dwordx4 v5, s[8:11], s3 offen offset:3072 lds
M a[20:23], a[76:79], a[188:191], a[20:23]
M a[20:23], a[72:75], a[184:187], a[20:23]
M a[24:27], a[80:83], a[184:187], a[24:27]
M a[24:27], a[84:87], a[188:191], a[24:27]
M a[28:31], a[92:95], a[188:191], a[28:31]
M a[28:31], a[88:91], a[184:187], a[28:31]
s_waitcnt lgkmcnt(2)
M v[32:35], a[96:99], a[160:163], v[32:35]
s_add_u32 s23, s23, 128
s_cmp_eq_u32 s23, s25
s_cselect_b32 s23, s26, s23
M v[32:35], a[100:103], a[164:167], v[32:35]
ds_read_b128 a[176:179], v10 offset:36864
ds_read_b128 a[180:183], v11 offset:36864
M v[36:39], a[108:111], a[164:167], v[36:39]
M v[36:39], a[104:107], a[160:163], v[36:39]
ds_read_b64_tr_b16 a[32:33], v12 offset:0
ds_read_b64_tr_b16 a[34:35], v12 offset:2048
M v[40:43], a[112:115], a[160:163], v[40:43]
M v[40:43], a[116:119], a[164:167], v[40:43]
M v[44:47], a[124:127], a[164:167], v[44:47]
s_add_u32 m0, s29, 114688
s_nop 0
buffer_load_dwordx4 v6, s[12:15], s24 offen offset:0 lds
M v[44:47], a[120:123], a[160:163], v[44:47]
ds_read_b64_tr_b16 a[40:41], v13 offset:0
ds_read_b64_tr_b16 a[42:43], v13 offset:2048
M v[48:51], a[128:131], a[160:163], v[48:51]
M v[48:51], a[132:135], a[164:167], v[48:51]
M v[52:55], a[140:143], a[164:167], v[52:55]
M v[52:55], a[136:139], a[160:163], v[52:55]
ds_read_b64_tr_b16 a[48:49], v14 offset:0
ds_read_b64_tr_b16 a[50:51], v14 offset:2048
M v[56:59], a[144:147], a[160:163], v[56:59]
buffer_load_dwordx4 v7, s[12:15], s24 offen offset:1024 lds
M v[56:59], a[148:151], a[164:167], v[56:59]
M v[60:63], a[156:159], a[164:167], v[60:63]
M v[60:63], a[152:155], a[160:163], v[60:63]
s_waitcnt lgkmcnt(8)
ds_read_b64_tr_b16 a[56:57], v15 offset:0
ds_read_b64_tr_b16 a[58:59], v15 offset:2048
M v[64:67], a[96:99], a[168:171], v[64:67]
M v[64:67], a[100:103], a[172:175], v[64:67]
ds_read_b128 a[184:187], v10 offset:38912
ds_read_b128 a[188:191], v11 offset:38912
M v[68:71], a[108:111], a[172:175], v[68:71]
M v[68:71], a[104:107], a[168:171], v[68:71]
ds_read_b64_tr_b16 a[64:65], v16 offset:0
ds_read_b64_tr_b16 a[66:67], v16 offset:2048
v_cvt_pk_bf16_f32 v32, v32, v33
v_cvt_pk_bf16_f32 v33, v34, v35
M v[72:75], a[112:115], a[168:171], v[72:75]
buffer_load_dwordx4 v8, s[12:15], s24 offen offset:2048 lds
v_cvt_pk_bf16_f32 v34, v36, v37
v_cvt_pk_bf16_f32 v35, v38, v39
M v[72:75], a[116:119], a[172:175], v[72:75]
v_cvt_pk_bf16_f32 v40, v40, v41
v_cvt_pk_bf16_f32 v41, v42, v43
M v[76:79], a[124:127], a[172:175], v[76:79]
v_cvt_pk_bf16_f32 v42, v44, v45
v_cvt_pk_bf16_f32 v43, v46, v47
M v[76:79], a[120:123], a[168:171], v[76:79]
ds_read_b64_tr_b16 a[72:73], v17 offset:0
ds_read_b64_tr_b16 a[74:75], v17 offset:2048
v_cvt_pk_bf16_f32 v48, v48, v49
v_cvt_pk_bf16_f32 v49, v50, v51
M v[80:83], a[128:131], a[168:171], v[80:83]
v_cvt_pk_bf16_f32 v50, v52, v53
v_cvt_pk_bf16_f32 v51, v54, v55
M v[80:83], a[132:135], a[172:175], v[80:83]
buffer_load_dwordx4 v9, s[12:15], s24 offen offset:3072 lds
v_cvt_pk_bf16_f32 v56, v56, v57
v_cvt_pk_bf16_f32 v57, v58, v59
M v[84:87], a[140:143], a[172:175], v[84:87]
v_cvt_pk_bf16_f32 v58, v60, v61
v_cvt_pk_bf16_f32 v59, v62, v63
M v[84:87], a[136:139], a[168:171], v[84:87]
ds_read_b64_tr_b16 a[80:81], v18 offset:0
ds_read_b64_tr_b16 a[82:83], v18 offset:2048
M v[88:91], a[144:147], a[168:171], v[88:91]
M v[88:91], a[148:151], a[172:175], v[88:91]
M v[92:95], a[156:159], a[172:175], v[92:95]
s_add_u32 s94, s92, 0
buffer_store_dwordx4 v[32:35], v1, s[16:19], s94 offen offset:0 sc1
M v[92:95], a[152:155], a[168:171], v[92:95]
s_waitcnt lgkmcnt(15)
ds_read_b64_tr_b16 a[88:89], v19 offset:0
ds_read_b64_tr_b16 a[90:91], v19 offset:2048
M v[96:99], a[96:99], a[176:179], v[96:99]
s_add_u32 s24, s24, 262144
s_cmp_eq_u32 s24, s27
s_cselect_b32 s24, s28, s24
s_sub_u32 s6, s6, 1
s_cmp_eq_u32 s6, 0
s_cselect_b64 s[12:13], s[64:65], s[12:13]
M v[96:99], a[100:103], a[180:183], v[96:99]
M v[100:103], a[108:111], a[180:183], v[100:103]
M v[100:103], a[104:107], a[176:179], v[100:103]
v_cvt_pk_bf16_f32 v64, v64, v65
v_cvt_pk_bf16_f32 v65, v66, v67
M v[104:107], a[112:115], a[176:179], v[104:107]
v_cvt_pk_bf16_f32 v66, v68, v69
v_cvt_pk_bf16_f32 v67, v70, v71
M v[104:107], a[116:119], a[180:183], v[104:107]
s_add_u32 s94, s92, 0
buffer_store_dwordx4 v[40:43], v1, s[16:19], s94 offen offset:1024 sc1
v_cvt_pk_bf16_f32 v72, v72, v73
v_cvt_pk_bf16_f32 v73, v74, v75
M v[108:111], a[124:127], a[180:183], v[108:111]
v_cvt_pk_bf16_f32 v74, v76, v77
v_cvt_pk_bf16_f32 v75, v78, v79
M v[108:111], a[120:123], a[176:179], v[108:111]
s_waitcnt vmcnt(19) lgkmcnt(0)
s_barrier
ds_read_b128 a[160:163], v10 offset:49152
ds_read_b128 a[164:167], v11 offset:49152
v_cvt_pk_bf16_f32 v80, v80, v81
v_cvt_pk_bf16_f32 v81, v82, v83
M v[112:115], a[128:131], a[176:179], v[112:115]
s_add_u32 m0, s29, 32768
s_nop 0
buffer_load_dwordx4 v2, s[8:11], s23 offen offset:0 lds
v_cvt_pk_bf16_f32 v82, v84, v85
v_cvt_pk_bf16_f32 v83, v86, v87
M v[112:115], a[132:135], a[180:183], v[112:115]
v_cvt_pk_bf16_f32 v88, v88, v89
v_cvt_pk_bf16_f32 v89, v90, v91
M v[116:119], a[140:143], a[180:183], v[116:119]
v_cvt_pk_bf16_f32 v90, v92, v93
v_cvt_pk_bf16_f32 v91, v94, v95
M v[116:119], a[136:139], a[176:179], v[116:119]
ds_read_b64_tr_b16 a[36:37], v12 offset:16384
ds_read_b64_tr_b16 a[38:39], v12 offset:18432
M v[120:123], a[144:147], a[176:179], v[120:123]
s_add_u32 s94, s92, 0
buffer_store_dwordx4 v[48:51], v1, s[16:19], s94 offen offset:2048 sc1
M v[120:123], a[148:151], a[180:183], v[120:123]
buffer_load_dwordx4 v3, s[8:11], s23 offen offset:1024 lds
M v[124:127], a[156:159], a[180:183], v[124:127]
M v[124:127], a[152:155], a[176:179], v[124:127]
M v[128:131], a[96:99], a[184:187], v[128:131]
M v[128:131], a[100:103], a[188:191], v[128:131]
ds_read_b128 a[168:171], v10 offset:51200
ds_read_b128 a[172:175], v11 offset:51200
ds_read_b64_tr_b16 a[44:45], v13 offset:16384
ds_read_b64_tr_b16 a[46:47], v13 offset:18432
M v[132:135], a[108:111], a[188:191], v[132:135]
M v[132:135], a[104:107], a[184:187], v[132:135]
s_add_u32 s94, s92, 0
buffer_store_dwordx4 v[56:59], v1, s[16:19], s94 offen offset:3072 sc1
v_cvt_pk_bf16_f32 v96, v96, v97
v_cvt_pk_bf16_f32 v97, v98, v99
M v[136:139], a[112:115], a[184:187], v[136:139]
buffer_load_dwordx4 v4, s[8:11], s23 offen offset:2048 lds
v_cvt_pk_bf16_f32 v98, v100, v101
v_cvt_pk_bf16_f32 v99, v102, v103
M v[136:139], a[116:119], a[188:191], v[136:139]
v_cvt_pk_bf16_f32 v104, v104, v105
v_cvt_pk_bf16_f32 v105, v106, v107
M v[140:143], a[124:127], a[188:191], v[140:143]
v_cvt_pk_bf16_f32 v106, v108, v109
v_cvt_pk_bf16_f32 v107, v110, v111
M v[140:143], a[120:123], a[184:187], v[140:143]
ds_read_b64_tr_b16 a[52:53], v14 offset:16384
ds_read_b64_tr_b16 a[54:55], v14 offset:18432
v_cvt_pk_bf16_f32 v112, v112, v113
v_cvt_pk_bf16_f32 v113, v114, v115
M v[144:147], a[128:131], a[184:187], v[144:147]
buffer_load_dwordx4 v5, s[8:11], s23 offen offset:3072 lds
v_cvt_pk_bf16_f32 v114, v116, v117
v_cvt_pk_bf16_f32 v115, v118, v119
M v[144:147], a[132:135], a[188:191], v[144:147]
v_cvt_pk_bf16_f32 v120, v120, v121
v_cvt_pk_bf16_f32 v121, v122, v123
M v[148:151], a[140:143], a[188:191], v[148:151]
s_add_u32 s94, s92, 4096
buffer_store_dwordx4 v[64:67], v1, s[16:19], s94 offen offset:0 sc1
v_cvt_pk_bf16_f32 v122, v124, v125
v_cvt_pk_bf16_f32 v123, v126, v127
M v[148:151], a[136:139], a[184:187], v[148:151]
M v[152:155], a[144:147], a[184:187], v[152:155]
M v[152:155], a[148:151], a[188:191], v[152:155]
ds_read_b64_tr_b16 a[60:61], v15 offset:16384
ds_read_b64_tr_b16 a[62:63], v15 offset:18432
M v[156:159], a[156:159], a[188:191], v[156:159]
s_add_u32 m0, s29, 65536
s_nop 0
buffer_load_dwordx4 v6, s[12:15], s24 offen offset:0 lds
M v[156:159], a[152:155], a[184:187], v[156:159]
s_waitcnt lgkmcnt(10)
M v[160:163], a[96:99], a[160:163], v[160:163]
M v[160:163], a[100:103], a[164:167], v[160:163]
ds_read_b128 a[176:179], v10 offset:53248
ds_read_b128 a[180:183], v11 offset:53248
M v[164:167], a[108:111], a[164:167], v[164:167]
s_add_u32 s94, s92, 4096
buffer_store_dwordx4 v[72:75], v1, s[16:19], s94 offen offset:1024 sc1
M v[164:167], a[104:107], a[160:163], v[164:167]
ds_read_b64_tr_b16 a[68:69], v16 offset:16384
ds_read_b64_tr_b16 a[70:71], v16 offset:18432
v_cvt_pk_bf16_f32 v128, v128, v129
v_cvt_pk_bf16_f32 v129, v130, v131
M v[168:171], a[112:115], a[160:163], v[168:171]
v_cvt_pk_bf16_f32 v130, v132, v133
v_cvt_pk_bf16_f32 v131, v134, v135
M v[168:171], a[116:119], a[164:167], v[168:171]
buffer_load_dwordx4 v7, s[12:15], s24 offen offset:1024 lds
v_cvt_pk_bf16_f32 v136, v136, v137
v_cvt_pk_bf16_f32 v137, v138, v139
M v[172:175], a[124:127], a[164:167], v[172:175]
v_cvt_pk_bf16_f32 v138, v140, v141
v_cvt_pk_bf16_f32 v139, v142, v143
M v[172:175], a[120:123], a[160:163], v[172:175]
v_cvt_pk_bf16_f32 v144, v144, v145
v_cvt_pk_bf16_f32 v145, v146, v147
M v[176:179], a[128:131], a[160:163], v[176:179]
s_add_u32 s94, s92, 4096
buffer_store_dwordx4 v[80:83], v1, s[16:19], s94 offen offset:2048 sc1
v_cvt_pk_bf16_f32 v146, v148, v149
v_cvt_pk_bf16_f32 v147, v150, v151
M v[176:179], a[132:135], a[164:167], v[176:179]
ds_read_b64_tr_b16 a[76:77], v17 offset:16384
ds_read_b64_tr_b16 a[78:79], v17 offset:18432
v_cvt_pk_bf16_f32 v152, v152, v153
v_cvt_pk_bf16_f32 v153, v154, v155
M v[180:183], a[140:143], a[164:167], v[180:183]
v_cvt_pk_bf16_f32 v154, v156, v157
v_cvt_pk_bf16_f32 v155, v158, v159
M v[180:183], a[136:139], a[160:163], v[180:183]
buffer_load_dwordx4 v8, s[12:15], s24 offen offset:2048 lds
M v[184:187], a[144:147], a[160:163], v[184:187]
M v[184:187], a[148:151], a[164:167], v[184:187]
M v[188:191], a[156:159], a[164:167], v[188:191]
buffer_load_dwordx4 v9, s[12:15], s24 offen offset:3072 lds
M v[188:191], a[152:155], a[160:163], v[188:191]
s_waitcnt lgkmcnt(12)
ds_read_b64_tr_b16 a[84:85], v18 offset:16384
ds_read_b64_tr_b16 a[86:87], v18 offset:18432
M v[192:195], a[96:99], a[168:171], v[192:195]
s_add_u32 s94, s92, 4096
buffer_store_dwordx4 v[88:91], v1, s[16:19], s94 offen offset:3072 sc1
M v[192:195], a[100:103], a[172:175], v[192:195]
ds_read_b128 a[184:187], v10 offset:55296
ds_read_b128 a[188:191], v11 offset:55296
M v[196:199], a[108:111], a[172:175], v[196:199]
M v[196:199], a[104:107], a[168:171], v[196:199]
v_cvt_pk_bf16_f32 v160, v160, v161
v_cvt_pk_bf16_f32 v161, v162, v163
M v[200:203], a[112:115], a[168:171], v[200:203]
v_cvt_pk_bf16_f32 v162, v164, v165
v_cvt_pk_bf16_f32 v163, v166, v167
M v[200:203], a[116:119], a[172:175], v[200:203]
ds_read_b64_tr_b16 a[92:93], v19 offset:16384
ds_read_b64_tr_b16 a[94:95], v19 offset:18432
v_cvt_pk_bf16_f32 v168, v168, v169
v_cvt_pk_bf16_f32 v169, v170, v171
M v[204:207], a[124:127], a[172:175], v[204:207]
s_add_u32 s94, s92, 8192
buffer_store_dwordx4 v[96:99], v1, s[16:19], s94 offen offset:0 sc1
v_cvt_pk_bf16_f32 v170, v172, v173
v_cvt_pk_bf16_f32 v171, v174, v175
M v[204:207], a[120:123], a[168:171], v[204:207]
s_add_u32 s24, s24, 262144
v_cvt_pk_bf16_f32 v176, v176, v177
v_cvt_pk_bf16_f32 v177, v178, v179
M v[208:211], a[128:131], a[168:171], v[208:211]
v_cvt_pk_bf16_f32 v178, v180, v181
v_cvt_pk_bf16_f32 v179, v182, v183
M v[208:211], a[132:135], a[172:175], v[208:211]
v_cvt_pk_bf16_f32 v184, v184, v185
v_cvt_pk_bf16_f32 v185, v186, v187
M v[212:215], a[140:143], a[172:175], v[212:215]
buffer_load_dword v21, v20, s[60:63], s54 offen
s_add_u32 s54, s54, s55
v_cvt_pk_bf16_f32 v186, v188, v189
v_cvt_pk_bf16_f32 v187, v190, v191
M v[212:215], a[136:139], a[168:171], v[212:215]
M v[216:219], a[144:147], a[168:171], v[216:219]
M v[216:219], a[148:151], a[172:175], v[216:219]
s_add_u32 s94, s92, 8192
buffer_store_dwordx4 v[104:107], v1, s[16:19], s94 offen offset:1024 sc1
M v[220:223], a[156:159], a[172:175], v[220:223]
M v[220:223], a[152:155], a[168:171], v[220:223]
s_waitcnt lgkmcnt(10)
M v[224:227], a[96:99], a[176:179], v[224:227]
s_cmp_eq_u32 s54, s56
s_cselect_b32 s54, s57, s54
s_cselect_b64 s[60:61], s[58:59], s[60:61]
s_cselect_b32 s62, s7, s62
M v[224:227], a[100:103], a[180:183], v[224:227]
M v[228:231], a[108:111], a[180:183], v[228:231]
M v[228:231], a[104:107], a[176:179], v[228:231]
v_cvt_pk_bf16_f32 v192, v192, v193
v_cvt_pk_bf16_f32 v193, v194, v195
M v[232:235], a[112:115], a[176:179], v[232:235]
s_add_u32 s94, s92, 8192
buffer_store_dwordx4 v[112:115], v1, s[16:19], s94 offen offset:2048 sc1
v_cvt_pk_bf16_f32 v194, v196, v197
v_cvt_pk_bf16_f32 v195, v198, v199
M v[232:235], a[116:119], a[180:183], v[232:235]
v_cvt_pk_bf16_f32 v200, v200, v201
v_cvt_pk_bf16_f32 v201, v202, v203
M v[236:239], a[124:127], a[180:183], v[236:239]
v_cvt_pk_bf16_f32 v202, v204, v205
v_cvt_pk_bf16_f32 v203, v206, v207
M v[236:239], a[120:123], a[176:179], v[236:239]
s_waitcnt vmcnt(29) lgkmcnt(0)
s_barrier
ds_read_b128 a[160:163], v10 offset:0
ds_read_b128 a[164:167], v11 offset:0
v_cvt_pk_bf16_f32 v208, v208, v209
v_cvt_pk_bf16_f32 v209, v210, v211
M v[240:243], a[128:131], a[176:179], v[240:243]
s_add_u32 m0, s29, 49152
s_add_u32 s3, s23, s31
buffer_load_dwordx4 v2, s[8:11], s3 offen offset:0 lds
v_cvt_pk_bf16_f32 v210, v212, v213
v_cvt_pk_bf16_f32 v211, v214, v215
M v[240:243], a[132:135], a[180:183], v[240:243]
v_cvt_pk_bf16_f32 v216, v216, v217
v_cvt_pk_bf16_f32 v217, v218, v219
M v[244:247], a[140:143], a[180:183], v[244:247]
v_cvt_pk_bf16_f32 v218, v220, v221
v_cvt_pk_bf16_f32 v219, v222, v223
M v[244:247], a[136:139], a[176:179], v[244:247]
s_add_u32 s94, s92, 8192
buffer_store_dwordx4 v[120:123], v1, s[16:19], s94 offen offset:3072 sc1
M v[248:251], a[144:147], a[176:179], v[248:251]
M v[248:251], a[148:151], a[180:183], v[248:251]
buffer_load_dwordx4 v3, s[8:11], s3 offen offset:1024 lds
M v[252:255], a[156:159], a[180:183], v[252:255]
M v[252:255], a[152:155], a[176:179], v[252:255]
M a[0:3], a[96:99], a[184:187], a[0:3]
M a[0:3], a[100:103], a[188:191], a[0:3]
ds_read_b128 a[168:171], v10 offset:2048
ds_read_b128 a[172:175], v11 offset:2048
M a[4:7], a[108:111], a[188:191], a[4:7]
s_add_u32 s94, s92, 12288
buffer_store_dwordx4 v[128:131], v1, s[16:19], s94 offen offset:0 sc1
M a[4:7], a[104:107], a[184:187], a[4:7]
v_cvt_pk_bf16_f32 v224, v224, v225
v_cvt_pk_bf16_f32 v225, v226, v227
M a[8:11], a[112:115], a[184:187], a[8:11]
v_cvt_pk_bf16_f32 v226, v228, v229
v_cvt_pk_bf16_f32 v227, v230, v231
M a[8:11], a[116:119], a[188:191], a[8:11]
buffer_load_dwordx4 v4, s[8:11], s3 offen offset:2048 lds
v_cvt_pk_bf16_f32 v232, v232, v233
v_cvt_pk_bf16_f32 v233, v234, v235
M a[12:15], a[124:127], a[188:191], a[12:15]
v_cvt_pk_bf16_f32 v234, v236, v237
v_cvt_pk_bf16_f32 v235, v238, v239
M a[12:15], a[120:123], a[184:187], a[12:15]
v_cvt_pk_bf16_f32 v240, v240, v241
v_cvt_pk_bf16_f32 v241, v242, v243
M a[16:19], a[128:131], a[184:187], a[16:19]
v_cvt_pk_bf16_f32 v242, v244, v245
v_cvt_pk_bf16_f32 v243, v246, v247
M a[16:19], a[132:135], a[188:191], a[16:19]
s_add_u32 s94, s92, 12288
buffer_store_dwordx4 v[136:139], v1, s[16:19], s94 offen offset:1024 sc1
v_cvt_pk_bf16_f32 v248, v248, v249
v_cvt_pk_bf16_f32 v249, v250, v251
M a[20:23], a[140:143], a[188:191], a[20:23]
buffer_load_dwordx4 v5, s[8:11], s3 offen offset:3072 lds
v_cvt_pk_bf16_f32 v250, v252, v253
v_cvt_pk_bf16_f32 v251, v254, v255
M a[20:23], a[136:139], a[184:187], a[20:23]
M a[24:27], a[144:147], a[184:187], a[24:27]
M a[24:27], a[148:151], a[188:191], a[24:27]
M a[28:31], a[156:159], a[188:191], a[28:31]
M a[28:31], a[152:155], a[184:187], a[28:31]
s_waitcnt lgkmcnt(2)
M v[32:35], a[160:163], a[32:35], 0
s_add_u32 s94, s92, 12288
buffer_store_dwordx4 v[144:147], v1, s[16:19], s94 offen offset:2048 sc1
M v[32:35], a[164:167], a[36:39], v[32:35]
ds_read_b128 a[176:179], v10 offset:4096
ds_read_b128 a[180:183], v11 offset:4096
M v[36:39], a[164:167], a[44:47], 0
s_add_u32 s23, s23, 128
s_cmp_eq_u32 s23, s25
s_cselect_b32 s23, s26, s23
M v[36:39], a[160:163], a[40:43], v[36:39]
ds_read_b64_tr_b16 a[96:97], v12 offset:32768
ds_read_b64_tr_b16 a[98:99], v12 offset:34816
M v[40:43], a[160:163], a[48:51], 0
M v[40:43], a[164:167], a[52:55], v[40:43]
M v[44:47], a[164:167], a[60:63], 0
s_add_u32 m0, s29, 81920
s_nop 0
buffer_load_dwordx4 v6, s[12:15], s24 offen offset:0 lds
v_accvgpr_read_b32 v24, a0
v_accvgpr_read_b32 v25, a1
M v[44:47], a[160:163], a[56:59], v[44:47]
ds_read_b64_tr_b16 a[104:105], v13 offset:32768
ds_read_b64_tr_b16 a[106:107], v13 offset:34816
v_accvgpr_read_b32 v26, a2
v_accvgpr_read_b32 v27, a3
M v[48:51], a[160:163], a[64:67], 0
s_add_u32 s94, s92, 12288
buffer_store_dwordx4 v[152:155], v1, s[16:19], s94 offen offset:3072 sc1
v_accvgpr_read_b32 v28, a4
v_accvgpr_read_b32 v29, a5
M v[48:51], a[164:167], a[68:71], v[48:51]
v_accvgpr_read_b32 v30, a6
v_accvgpr_read_b32 v31, a7
M v[52:55], a[164:167], a[76:79], 0
v_cvt_pk_bf16_f32 v24, v24, v25
v_cvt_pk_bf16_f32 v25, v26, v27
M v[52:55], a[160:163], a[72:75], v[52:55]
ds_read_b64_tr_b16 a[112:113], v14 offset:32768
ds_read_b64_tr_b16 a[114:115], v14 offset:34816
v_cvt_pk_bf16_f32 v26, v28, v29
v_cvt_pk_bf16_f32 v27, v30, v31
M v[56:59], a[160:163], a[80:83], 0
buffer_load_dwordx4 v7, s[12:15], s24 offen offset:1024 lds
M v[56:59], a[164:167], a[84:87], v[56:59]
M v[60:63], a[164:167], a[92:95], 0
s_add_u32 s94, s93, 0
buffer_store_dwordx4 v[160:163], v1, s[16:19], s94 offen offset:0 sc1
M v[60:63], a[160:163], a[88:91], v[60:63]
s_waitcnt lgkmcnt(8)
ds_read_b64_tr_b16 a[120:121], v15 offset:32768
ds_read_b64_tr_b16 a[122:123], v15 offset:34816
M v[64:67], a[168:171], a[32:35], 0
s_add_u32 s94, s93, 12288
buffer_store_dwordx4 v[24:27], v1, s[16:19], s94 offen offset:0 sc1
M v[64:67], a[172:175], a[36:39], v[64:67]
ds_read_b128 a[184:187], v10 offset:6144
ds_read_b128 a[188:191], v11 offset:6144
M v[68:71], a[172:175], a[44:47], 0
M v[68:71], a[168:171], a[40:43], v[68:71]
ds_read_b64_tr_b16 a[128:129], v16 offset:32768
ds_read_b64_tr_b16 a[130:131], v16 offset:34816
M v[72:75], a[168:171], a[48:51], 0
M v[72:75], a[172:175], a[52:55], v[72:75]
s_add_u32 s94, s93, 0
buffer_store_dwordx4 v[168:171], v1, s[16:19], s94 offen offset:1024 sc1
M v[76:79], a[172:175], a[60:63], 0
buffer_load_dwordx4 v8, s[12:15], s24 offen offset:2048 lds
M v[76:79], a[168:171], a[56:59], v[76:79]
ds_read_b64_tr_b16 a[136:137], v17 offset:32768
ds_read_b64_tr_b16 a[138:139], v17 offset:34816
M v[80:83], a[168:171], a[64:67], 0
M v[80:83], a[172:175], a[68:71], v[80:83]
M v[84:87], a[172:175], a[76:79], 0
buffer_load_dwordx4 v9, s[12:15], s24 offen offset:3072 lds
M v[84:87], a[168:171], a[72:75], v[84:87]
ds_read_b64_tr_b16 a[144:145], v18 offset:32768
ds_read_b64_tr_b16 a[146:147], v18 offset:34816
M v[88:91], a[168:171], a[80:83], 0
s_add_u32 s94, s93, 0
buffer_store_dwordx4 v[176:179], v1, s[16:19], s94 offen offset:2048 sc1
M v[88:91], a[172:175], a[84:87], v[88:91]
M v[92:95], a[172:175], a[92:95], 0
M v[92:95], a[168:171], a[88:91], v[92:95]
s_waitcnt lgkmcnt(15)
ds_read_b64_tr_b16 a[152:153], v19 offset:32768
ds_read_b64_tr_b16 a[154:155], v19 offset:34816
M v[96:99], a[176:179], a[32:35], 0
s_add_u32 s24, s24, 262144
s_cmp_eq_u32 s24, s27
s_cselect_b32 s24, s28, s24
s_sub_u32 s6, s6, 1
s_cmp_eq_u32 s6, 0
s_cselect_b64 s[12:13], s[64:65], s[12:13]
v_accvgpr_read_b32 v24, a8
v_accvgpr_read_b32 v25, a9
M v[96:99], a[180:183], a[36:39], v[96:99]
v_accvgpr_read_b32 v26, a10
v_accvgpr_read_b32 v27, a11
M v[100:103], a[180:183], a[44:47], 0
v_accvgpr_read_b32 v28, a12
v_accvgpr_read_b32 v29, a13
M v[100:103], a[176:179], a[40:43], v[100:103]
s_add_u32 s94, s93, 0
buffer_store_dwordx4 v[184:187], v1, s[16:19], s94 offen offset:3072 sc1
v_accvgpr_read_b32 v30, a14
v_accvgpr_read_b32 v31, a15
M v[104:107], a[176:179], a[48:51], 0
v_cvt_pk_bf16_f32 v24, v24, v25
v_cvt_pk_bf16_f32 v25, v26, v27
M v[104:107], a[180:183], a[52:55], v[104:107]
v_cvt_pk_bf16_f32 v26, v28, v29
v_cvt_pk_bf16_f32 v27, v30, v31
M v[108:111], a[180:183], a[60:63], 0
M v[108:111], a[176:179], a[56:59], v[108:111]
s_waitcnt vmcnt(38) lgkmcnt(0)
s_barrier
ds_read_b128 a[160:163], v10 offset:16384
ds_read_b128 a[164:167], v11 offset:16384
M v[112:115], a[176:179], a[64:67], 0
s_add_u32 m0, s29, 0
s_nop 0
buffer_load_dwordx4 v2, s[8:11], s23 offen offset:0 lds
M v[112:115], a[180:183], a[68:71], v[112:115]
s_add_u32 s94, s93, 12288
buffer_store_dwordx4 v[24:27], v1, s[16:19], s94 offen offset:1024 sc1
M v[116:119], a[180:183], a[76:79], 0
s_add_u32 s94, s93, 4096
buffer_store_dwordx4 v[192:195], v1, s[16:19], s94 offen offset:0 sc1
M v[116:119], a[176:179], a[72:75], v[116:119]
ds_read_b64_tr_b16 a[100:101], v12 offset:49152
ds_read_b64_tr_b16 a[102:103], v12 offset:51200
M v[120:123], a[176:179], a[80:83], 0
M v[120:123], a[180:183], a[84:87], v[120:123]
M v[124:127], a[180:183], a[92:95], 0
buffer_load_dwordx4 v3, s[8:11], s23 offen offset:1024 lds
M v[124:127], a[176:179], a[88:91], v[124:127]
M v[128:131], a[184:187], a[32:35], 0
M v[128:131], a[188:191], a[36:39], v[128:131]
ds_read_b128 a[168:171], v10 offset:18432
ds_read_b128 a[172:175], v11 offset:18432
ds_read_b64_tr_b16 a[108:109], v13 offset:49152
ds_read_b64_tr_b16 a[110:111], v13 offset:51200
M v[132:135], a[188:191], a[44:47], 0
s_add_u32 s94, s93, 4096
buffer_store_dwordx4 v[200:203], v1, s[16:19], s94 offen offset:1024 sc1
M v[132:135], a[184:187], a[40:43], v[132:135]
M v[136:139], a[184:187], a[48:51], 0
buffer_load_dwordx4 v4, s[8:11], s23 offen offset:2048 lds
M v[136:139], a[188:191], a[52:55], v[136:139]
M v[140:143], a[188:191], a[60:63], 0
M v[140:143], a[184:187], a[56:59], v[140:143]
ds_read_b64_tr_b16 a[116:117], v14 offset:49152
ds_read_b64_tr_b16 a[118:119], v14 offset:51200
M v[144:147], a[184:187], a[64:67], 0
s_add_u32 s94, s93, 4096
buffer_store_dwordx4 v[208:211], v1, s[16:19], s94 offen offset:2048 sc1
M v[144:147], a[188:191], a[68:71], v[144:147]
M v[148:151], a[188:191], a[76:79], 0
buffer_load_dwordx4 v5, s[8:11], s23 offen offset:3072 lds
v_accvgpr_read_b32 v24, a16
v_accvgpr_read_b32 v25, a17
M v[148:151], a[184:187], a[72:75], v[148:151]
v_accvgpr_read_b32 v26, a18
v_accvgpr_read_b32 v27, a19
M v[152:155], a[184:187], a[80:83], 0
v_accvgpr_read_b32 v28, a20
v_accvgpr_read_b32 v29, a21
M v[152:155], a[188:191], a[84:87], v[152:155]
ds_read_b64_tr_b16 a[124:125], v15 offset:49152
ds_read_b64_tr_b16 a[126:127], v15 offset:51200
v_accvgpr_read_b32 v30, a22
v_accvgpr_read_b32 v31, a23
M v[156:159], a[188:191], a[92:95], 0
s_add_u32 m0, s29, 98304
s_nop 0
buffer_load_dwordx4 v6, s[12:15], s24 offen offset:0 lds
v_cvt_pk_bf16_f32 v24, v24, v25
v_cvt_pk_bf16_f32 v25, v26, v27
M v[156:159], a[184:187], a[88:91], v[156:159]
s_add_u32 s94, s93, 4096
buffer_store_dwordx4 v[216:219], v1, s[16:19], s94 offen offset:3072 sc1
s_waitcnt lgkmcnt(10)
v_cvt_pk_bf16_f32 v26, v28, v29
v_cvt_pk_bf16_f32 v27, v30, v31
M v[160:163], a[160:163], a[32:35], 0
M v[160:163], a[164:167], a[36:39], v[160:163]
ds_read_b128 a[176:179], v10 offset:20480
ds_read_b128 a[180:183], v11 offset:20480
M v[164:167], a[164:167], a[44:47], 0
M v[164:167], a[160:163], a[40:43], v[164:167]
ds_read_b64_tr_b16 a[132:133], v16 offset:49152
ds_read_b64_tr_b16 a[134:135], v16 offset:51200
M v[168:171], a[160:163], a[48:51], 0
s_add_u32 s94, s93, 12288
buffer_store_dwordx4 v[24:27], v1, s[16:19], s94 offen offset:2048 sc1
M v[168:171], a[164:167], a[52:55], v[168:171]
M v[172:175], a[164:167], a[60:63], 0
s_add_u32 s94, s93, 8192
buffer_store_dwordx4 v[224:227], v1, s[16:19], s94 offen offset:0 sc1
M v[172:175], a[160:163], a[56:59], v[172:175]
buffer_load_dwordx4 v7, s[12:15], s24 offen offset:1024 lds
M v[176:179], a[160:163], a[64:67], 0
M v[176:179], a[164:167], a[68:71], v[176:179]
ds_read_b64_tr_b16 a[140:141], v17 offset:49152
ds_read_b64_tr_b16 a[142:143], v17 offset:51200
M v[180:183], a[164:167], a[76:79], 0
M v[180:183], a[160:163], a[72:75], v[180:183]
buffer_load_dwordx4 v8, s[12:15], s24 offen offset:2048 lds
M v[184:187], a[160:163], a[80:83], 0
M v[184:187], a[164:167], a[84:87], v[184:187]
s_add_u32 s94, s93, 8192
buffer_store_dwordx4 v[232:235], v1, s[16:19], s94 offen offset:1024 sc1
M v[188:191], a[164:167], a[92:95], 0
M v[188:191], a[160:163], a[88:91], v[188:191]
s_waitcnt lgkmcnt(12)
ds_read_b64_tr_b16 a[148:149], v18 offset:49152
ds_read_b64_tr_b16 a[150:151], v18 offset:51200
M v[192:195], a[168:171], a[32:35], 0
M v[192:195], a[172:175], a[36:39], v[192:195]
ds_read_b128 a[184:187], v10 offset:22528
ds_read_b128 a[188:191], v11 offset:22528
M v[196:199], a[172:175], a[44:47], 0
buffer_load_dwordx4 v9, s[12:15], s24 offen offset:3072 lds
M v[196:199], a[168:171], a[40:43], v[196:199]
M v[200:203], a[168:171], a[48:51], 0
s_add_u32 s94, s93, 8192
buffer_store_dwordx4 v[240:243], v1, s[16:19], s94 offen offset:2048 sc1
v_accvgpr_read_b32 v24, a24
v_accvgpr_read_b32 v25, a25
M v[200:203], a[172:175], a[52:55], v[200:203]
ds_read_b64_tr_b16 a[156:157], v19 offset:49152
ds_read_b64_tr_b16 a[158:159], v19 offset:51200
v_accvgpr_read_b32 v26, a26
v_accvgpr_read_b32 v27, a27
M v[204:207], a[172:175], a[60:63], 0
v_accvgpr_read_b32 v28, a28
v_accvgpr_read_b32 v29, a29
M v[204:207], a[168:171], a[56:59], v[204:207]
s_add_u32 s24, s24, 262144
v_accvgpr_read_b32 v30, a30
v_accvgpr_read_b32 v31, a31
M v[208:211], a[168:171], a[64:67], 0
v_cvt_pk_bf16_f32 v24, v24, v25
v_cvt_pk_bf16_f32 v25, v26, v27
M v[208:211], a[172:175], a[68:71], v[208:211]
v_cvt_pk_bf16_f32 v26, v28, v29
v_cvt_pk_bf16_f32 v27, v30, v31
M v[212:215], a[172:175], a[76:79], 0
M v[212:215], a[168:171], a[72:75], v[212:215]
s_add_u32 s94, s93, 8192
buffer_store_dwordx4 v[248:251], v1, s[16:19], s94 offen offset:3072 sc1
M v[216:219], a[168:171], a[80:83], 0
buffer_load_dword v21, v20, s[60:63], s54 offen
s_add_u32 s54, s54, s55
M v[216:219], a[172:175], a[84:87], v[216:219]
s_add_u32 s94, s93, 12288
buffer_store_dwordx4 v[24:27], v1, s[16:19], s94 offen offset:3072 sc1
M v[220:223], a[172:175], a[92:95], 0
M v[220:223], a[168:171], a[88:91], v[220:223]
s_waitcnt lgkmcnt(10)
M v[224:227], a[176:179], a[32:35], 0
M v[224:227], a[180:183], a[36:39], v[224:227]
s_cmp_eq_u32 s54, s56
s_cselect_b32 s54, s57, s54
s_cselect_b64 s[60:61], s[58:59], s[60:61]
s_cselect_b32 s62, s7, s62
M v[228:231], a[180:183], a[44:47], 0
M v[228:231], a[176:179], a[40:43], v[228:231]
M v[232:235], a[176:179], a[48:51], 0
M v[232:235], a[180:183], a[52:55], v[232:235]
M v[236:239], a[180:183], a[60:63], 0
M v[236:239], a[176:179], a[56:59], v[236:239]
s_waitcnt vmcnt(43) lgkmcnt(0)
s_barrier
ds_read_b128 a[160:163], v10 offset:32768
ds_read_b128 a[164:167], v11 offset:32768
M v[240:243], a[176:179], a[64:67], 0
s_add_u32 m0, s29, 16384
s_add_u32 s3, s23, s31
buffer_load_dwordx4 v2, s[8:11], s3 offen offset:0 lds
M v[240:243], a[180:183], a[68:71], v[240:243]
M v[244:247], a[180:183], a[76:79], 0
M v[244:247], a[176:179], a[72:75], v[244:247]
M v[248:251], a[176:179], a[80:83], 0
M v[248:251], a[180:183], a[84:87], v[248:251]
buffer_load_dwordx4 v3, s[8:11], s3 offen offset:1024 lds
M v[252:255], a[180:183], a[92:95], 0
M v[252:255], a[176:179], a[88:91], v[252:255]
M a[0:3], a[184:187], a[32:35], 0
M a[0:3], a[188:191], a[36:39], a[0:3]
ds_read_b128 a[168:171], v10 offset:34816
ds_read_b128 a[172:175], v11 offset:34816
M a[4:7], a[188:191], a[44:47], 0
M a[4:7], a[184:187], a[40:43], a[4:7]
M a[8:11], a[184:187], a[48:51], 0
buffer_load_dwordx4 v4, s[8:11], s3 offen offset:2048 lds
M a[8:11], a[188:191], a[52:55], a[8:11]
M a[12:15], a[188:191], a[60:63], 0
M a[12:15], a[184:187], a[56:59], a[12:15]
M a[16:19], a[184:187], a[64:67], 0
M a[16:19], a[188:191], a[68:71], a[16:19]
buffer_load_dwordx4 v5, s[8:11], s3 offen offset:3072 lds
M a[20:23], a[188:191], a[76:79], 0
M a[20:23], a[184:187], a[72:75], a[20:23]
M a[24:27], a[184:187], a[80:83], 0
M a[24:27], a[188:191], a[84:87], a[24:27]
M a[28:31], a[188:191], a[92:95], 0
M a[28:31], a[184:187], a[88:91], a[28:31]
s_waitcnt lgkmcnt(2)
M v[32:35], a[160:163], a[96:99], v[32:35]
s_add_u32 s23, s23, 128
s_cmp_eq_u32 s23, s25
s_cselect_b32 s23, s26, s23
M v[32:35], a[164:167], a[100:103], v[32:35]
ds_read_b128 a[176:179], v10 offset:36864
ds_read_b128 a[180:183], v11 offset:36864
M v[36:39], a[164:167], a[108:111], v[36:39]
M v[36:39], a[160:163], a[104:107], v[36:39]
ds_read_b64_tr_b16 a[32:33], v12 offset:0
ds_read_b64_tr_b16 a[34:35], v12 offset:2048
M v[40:43], a[160:163], a[112:115], v[40:43]
M v[40:43], a[164:167], a[116:119], v[40:43]
M v[44:47], a[164:167], a[124:127], v[44:47]
s_add_u32 m0, s29, 114688
s_nop 0
buffer_load_dwordx4 v6, s[12:15], s24 offen offset:0 lds
M v[44:47], a[160:163], a[120:123], v[44:47]
ds_read_b64_tr_b16 a[40:41], v13 offset:0
ds_read_b64_tr_b16 a[42:43], v13 offset:2048
M v[48:51], a[160:163], a[128:131], v[48:51]
M v[48:51], a[164:167], a[132:135], v[48:51]
M v[52:55], a[164:167], a[140:143], v[52:55]
M v[52:55], a[160:163], a[136:139], v[52:55]
ds_read_b64_tr_b16 a[48:49], v14 offset:0
ds_read_b64_tr_b16 a[50:51], v14 offset:2048
M v[56:59], a[160:163], a[144:147], v[56:59]
M v[56:59], a[164:167], a[148:151], v[56:59]
buffer_load_dwordx4 v7, s[12:15], s24 offen offset:1024 lds
M v[60:63], a[164:167], a[156:159], v[60:63]
M v[60:63], a[160:163], a[152:155], v[60:63]
s_waitcnt lgkmcnt(8)
ds_read_b64_tr_b16 a[56:57], v15 offset:0
ds_read_b64_tr_b16 a[58:59], v15 offset:2048
M v[64:67], a[168:171], a[96:99], v[64:67]
M v[64:67], a[172:175], a[100:103], v[64:67]
ds_read_b128 a[184:187], v10 offset:38912
ds_read_b128 a[188:191], v11 offset:38912
M v[68:71], a[172:175], a[108:111], v[68:71]
M v[68:71], a[168:171], a[104:107], v[68:71]
ds_read_b64_tr_b16 a[64:65], v16 offset:0
ds_read_b64_tr_b16 a[66:67], v16 offset:2048
M v[72:75], a[168:171], a[112:115], v[72:75]
buffer_load_dwordx4 v8, s[12:15], s24 offen offset:2048 lds
M v[72:75], a[172:175], a[116:119], v[72:75]
M v[76:79], a[172:175], a[124:127], v[76:79]
M v[76:79], a[168:171], a[120:123], v[76:79]
ds_read_b64_tr_b16 a[72:73], v17 offset:0
ds_read_b64_tr_b16 a[74:75], v17 offset:2048
M v[80:83], a[168:171], a[128:131], v[80:83]
M v[80:83], a[172:175], a[132:135], v[80:83]
M v[84:87], a[172:175], a[140:143], v[84:87]
buffer_load_dwordx4 v9, s[12:15], s24 offen offset:3072 lds
M v[84:87], a[168:171], a[136:139], v[84:87]
ds_read_b64_tr_b16 a[80:81], v18 offset:0
ds_read_b64_tr_b16 a[82:83], v18 offset:2048
M v[88:91], a[168:171], a[144:147], v[88:91]
M v[88:91], a[172:175], a[148:151], v[88:91]
M v[92:95], a[172:175], a[156:159], v[92:95]
M v[92:95], a[168:171], a[152:155], v[92:95]
s_waitcnt lgkmcnt(15)
ds_read_b64_tr_b16 a[88:89], v19 offset:0
ds_read_b64_tr_b16 a[90:91], v19 offset:2048
M v[96:99], a[176:179], a[96:99], v[96:99]
s_add_u32 s24, s24, 262144
s_cmp_eq_u32 s24, s27
s_cselect_b32 s24, s28, s24
s_sub_u32 s6, s6, 1
s_cmp_eq_u32 s6, 0
s_cselect_b64 s[12:13], s[64:65], s[12:13]
M v[96:99], a[180:183], a[100:103], v[96:99]
M v[100:103], a[180:183], a[108:111], v[100:103]
M v[100:103], a[176:179], a[104:107], v[100:103]
M v[104:107], a[176:179], a[112:115], v[104:107]
M v[104:107], a[180:183], a[116:119], v[104:107]
M v[108:111], a[180:183], a[124:127], v[108:111]
M v[108:111], a[176:179], a[120:123], v[108:111]
s_waitcnt vmcnt(30) lgkmcnt(0)
s_barrier
ds_read_b128 a[160:163], v10 offset:49152
ds_read_b128 a[164:167], v11 offset:49152
M v[112:115], a[176:179], a[128:131], v[112:115]
s_add_u32 m0, s29, 32768
s_nop 0
buffer_load_dwordx4 v2, s[8:11], s23 offen offset:0 lds
M v[112:115], a[180:183], a[132:135], v[112:115]
M v[116:119], a[180:183], a[140:143], v[116:119]
M v[116:119], a[176:179], a[136:139], v[116:119]
ds_read_b64_tr_b16 a[36:37], v12 offset:16384
ds_read_b64_tr_b16 a[38:39], v12 offset:18432
M v[120:123], a[176:179], a[144:147], v[120:123]
M v[120:123], a[180:183], a[148:151], v[120:123]
buffer_load_dwordx4 v3, s[8:11], s23 offen offset:1024 lds
M v[124:127], a[180:183], a[156:159], v[124:127]
M v[124:127], a[176:179], a[152:155], v[124:127]
M v[128:131], a[184:187], a[96:99], v[128:131]
M v[128:131], a[188:191], a[100:103], v[128:131]
ds_read_b128 a[168:171], v10 offset:51200
ds_read_b128 a[172:175], v11 offset:51200
ds_read_b64_tr_b16 a[44:45], v13 offset:16384
ds_read_b64_tr_b16 a[46:47], v13 offset:18432
M v[132:135], a[188:191], a[108:111], v[132:135]
M v[132:135], a[184:187], a[104:107], v[132:135]
buffer_load_dwordx4 v4, s[8:11], s23 offen offset:2048 lds
M v[136:139], a[184:187], a[112:115], v[136:139]
M v[136:139], a[188:191], a[116:119], v[136:139]
M v[140:143], a[188:191], a[124:127], v[140:143]
M v[140:143], a[184:187], a[120:123], v[140:143]
ds_read_b64_tr_b16 a[52:53], v14 offset:16384
ds_read_b64_tr_b16 a[54:55], v14 offset:18432
M v[144:147], a[184:187], a[128:131], v[144:147]
M v[144:147], a[188:191], a[132:135], v[144:147]
buffer_load_dwordx4 v5, s[8:11], s23 offen offset:3072 lds
M v[148:151], a[188:191], a[140:143], v[148:151]
M v[148:151], a[184:187], a[136:139], v[148:151]
M v[152:155], a[184:187], a[144:147], v[152:155]
M v[152:155], a[188:191], a[148:151], v[152:155]
ds_read_b64_tr_b16 a[60:61], v15 offset:16384
ds_read_b64_tr_b16 a[62:63], v15 offset:18432
M v[156:159], a[188:191], a[156:159], v[156:159]
s_add_u32 m0, s29, 65536
s_nop 0
buffer_load_dwordx4 v6, s[12:15], s24 offen offset:0 lds
M v[156:159], a[184:187], a[152:155], v[156:159]
s_waitcnt lgkmcnt(10)
M v[160:163], a[160:163], a[96:99], v[160:163]
M v[160:163], a[164:167], a[100:103], v[160:163]
ds_read_b128 a[176:179], v10 offset:53248
ds_read_b128 a[180:183], v11 offset:53248
M v[164:167], a[164:167], a[108:111], v[164:167]
M v[164:167], a[160:163], a[104:107], v[164:167]
ds_read_b64_tr_b16 a[68:69], v16 offset:16384
ds_read_b64_tr_b16 a[70:71], v16 offset:18432
M v[168:171], a[160:163], a[112:115], v[168:171]
M v[168:171], a[164:167], a[116:119], v[168:171]
buffer_load_dwordx4 v7, s[12:15], s24 offen offset:1024 lds
M v[172:175], a[164:167], a[124:127], v[172:175]
M v[172:175], a[160:163], a[120:123], v[172:175]
M v[176:179], a[160:163], a[128:131], v[176:179]
M v[176:179], a[164:167], a[132:135], v[176:179]
ds_read_b64_tr_b16 a[76:77], v17 offset:16384
ds_read_b64_tr_b16 a[78:79], v17 offset:18432
M v[180:183], a[164:167], a[140:143], v[180:183]
M v[180:183], a[160:163], a[136:139], v[180:183]
buffer_load_dwordx4 v8, s[12:15], s24 offen offset:2048 lds
M v[184:187], a[160:163], a[144:147], v[184:187]
M v[184:187], a[164:167], a[148:151], v[184:187]
M v[188:191], a[164:167], a[156:159], v[188:191]
M v[188:191], a[160:163], a[152:155], v[188:191]
s_waitcnt lgkmcnt(12)
ds_read_b64_tr_b16 a[84:85], v18 offset:16384
ds_read_b64_tr_b16 a[86:87], v18 offset:18432
M v[192:195], a[168:171], a[96:99], v[192:195]
buffer_load_dwordx4 v9, s[12:15], s24 offen offset:3072 lds
M v[192:195], a[172:175], a[100:103], v[192:195]
ds_read_b128 a[184:187], v10 offset:55296
ds_read_b128 a[188:191], v11 offset:55296
M v[196:199], a[172:175], a[108:111], v[196:199]
M v[196:199], a[168:171], a[104:107], v[196:199]
M v[200:203], a[168:171], a[112:115], v[200:203]
M v[200:203], a[172:175], a[116:119], v[200:203]
ds_read_b64_tr_b16 a[92:93], v19 offset:16384
ds_read_b64_tr_b16 a[94:95], v19 offset:18432
M v[204:207], a[172:175], a[124:127], v[204:207]
s_add_u32 s24, s24, 262144
M v[204:207], a[168:171], a[120:123], v[204:207]
M v[208:211], a[168:171], a[128:131], v[208:211]
M v[208:211], a[172:175], a[132:135], v[208:211]
M v[212:215], a[172:175], a[140:143], v[212:215]
M v[212:215], a[168:171], a[136:139], v[212:215]
buffer_load_dword v21, v20, s[60:63], s54 offen
s_add_u32 s54, s54, s55
M v[216:219], a[168:171], a[144:147], v[216:219]
M v[216:219], a[172:175], a[148:151], v[216:219]
M v[220:223], a[172:175], a[156:159], v[220:223]
M v[220:223], a[168:171], a[152:155], v[220:223]
s_waitcnt lgkmcnt(10)
M v[224:227], a[176:179], a[96:99], v[224:227]
s_cmp_eq_u32 s54, s56
s_cselect_b32 s54, s57, s54
s_cselect_b64 s[60:61], s[58:59], s[60:61]
s_cselect_b32 s62, s7, s62
M v[224:227], a[180:183], a[100:103], v[224:227]
M v[228:231], a[180:183], a[108:111], v[228:231]
M v[228:231], a[176:179], a[104:107], v[228:231]
M v[232:235], a[176:179], a[112:115], v[232:235]
M v[232:235], a[180:183], a[116:119], v[232:235]
M v[236:239], a[180:183], a[124:127], v[236:239]
M v[236:239], a[176:179], a[120:123], v[236:239]
s_waitcnt vmcnt(21) lgkmcnt(0)
s_barrier
ds_read_b128 a[160:163], v10 offset:0
ds_read_b128 a[164:167], v11 offset:0
M v[240:243], a[176:179], a[128:131], v[240:243]
s_add_u32 m0, s29, 49152
s_add_u32 s3, s23, s31
buffer_load_dwordx4 v2, s[8:11], s3 offen offset:0 lds
M v[240:243], a[180:183], a[132:135], v[240:243]
M v[244:247], a[180:183], a[140:143], v[244:247]
M v[244:247], a[176:179], a[136:139], v[244:247]
M v[248:251], a[176:179], a[144:147], v[248:251]
M v[248:251], a[180:183], a[148:151], v[248:251]
buffer_load_dwordx4 v3, s[8:11], s3 offen offset:1024 lds
M v[252:255], a[180:183], a[156:159], v[252:255]
M v[252:255], a[176:179], a[152:155], v[252:255]
M a[0:3], a[184:187], a[96:99], a[0:3]
M a[0:3], a[188:191], a[100:103], a[0:3]
ds_read_b128 a[168:171], v10 offset:2048
ds_read_b128 a[172:175], v11 offset:2048
M a[4:7], a[188:191], a[108:111], a[4:7]
M a[4:7], a[184:187], a[104:107], a[4:7]
M a[8:11], a[184:187], a[112:115], a[8:11]
buffer_load_dwordx4 v4, s[8:11], s3 offen offset:2048 lds
M a[8:11], a[188:191], a[116:119], a[8:11]
M a[12:15], a[188:191], a[124:127], a[12:15]
M a[12:15], a[184:187], a[120:123], a[12:15]
M a[16:19], a[184:187], a[128:131], a[16:19]
M a[16:19], a[188:191], a[132:135], a[16:19]
buffer_load_dwordx4 v5, s[8:11], s3 offen offset:3072 lds
M a[20:23], a[188:191], a[140:143], a[20:23]
M a[20:23], a[184:187], a[136:139], a[20:23]
M a[24:27], a[184:187], a[144:147], a[24:27]
M a[24:27], a[188:191], a[148:151], a[24:27]
M a[28:31], a[188:191], a[156:159], a[28:31]
M a[28:31], a[184:187], a[152:155], a[28:31]
s_waitcnt lgkmcnt(2)
M v[32:35], a[160:163], a[32:35], v[32:35]
s_add_u32 s23, s23, 128
s_cmp_eq_u32 s23, s25
s_cselect_b32 s23, s26, s23
M v[32:35], a[164:167], a[36:39], v[32:35]
ds_read_b128 a[176:179], v10 offset:4096
ds_read_b128 a[180:183], v11 offset:4096
M v[36:39], a[164:167], a[44:47], v[36:39]
M v[36:39], a[160:163], a[40:43], v[36:39]
ds_read_b64_tr_b16 a[96:97], v12 offset:32768
ds_read_b64_tr_b16 a[98:99], v12 offset:34816
M v[40:43], a[160:163], a[48:51], v[40:43]
M v[40:43], a[164:167], a[52:55], v[40:43]
M v[44:47], a[164:167], a[60:63], v[44:47]
s_add_u32 m0, s29, 81920
s_nop 0
buffer_load_dwordx4 v6, s[12:15], s24 offen offset:0 lds
M v[44:47], a[160:163], a[56:59], v[44:47]
ds_read_b64_tr_b16 a[104:105], v13 offset:32768
ds_read_b64_tr_b16 a[106:107], v13 offset:34816
M v[48:51], a[160:163], a[64:67], v[48:51]
M v[48:51], a[164:167], a[68:71], v[48:51]
M v[52:55], a[164:167], a[76:79], v[52:55]
M v[52:55], a[160:163], a[72:75], v[52:55]
ds_read_b64_tr_b16 a[112:113], v14 offset:32768
ds_read_b64_tr_b16 a[114:115], v14 offset:34816
M v[56:59], a[160:163], a[80:83], v[56:59]
M v[56:59], a[164:167], a[84:87], v[56:59]
buffer_load_dwordx4 v7, s[12:15], s24 offen offset:1024 lds
M v[60:63], a[164:167], a[92:95], v[60:63]
M v[60:63], a[160:163], a[88:91], v[60:63]
s_waitcnt lgkmcnt(8)
ds_read_b64_tr_b16 a[120:121], v15 offset:32768
ds_read_b64_tr_b16 a[122:123], v15 offset:34816
M v[64:67], a[168:171], a[32:35], v[64:67]
M v[64:67], a[172:175], a[36:39], v[64:67]
ds_read_b128 a[184:187], v10 offset:6144
ds_read_b128 a[188:191], v11 offset:6144
M v[68:71], a[172:175], a[44:47], v[68:71]
M v[68:71], a[168:171], a[40:43], v[68:71]
ds_read_b64_tr_b16 a[128:129], v16 offset:32768
ds_read_b64_tr_b16 a[130:131], v16 offset:34816
M v[72:75], a[168:171], a[48:51], v[72:75]
buffer_load_dwordx4 v8, s[12:15], s24 offen offset:2048 lds
M v[72:75], a[172:175], a[52:55], v[72:75]
M v[76:79], a[172:175], a[60:63], v[76:79]
M v[76:79], a[168:171], a[56:59], v[76:79]
ds_read_b64_tr_b16 a[136:137], v17 offset:32768
ds_read_b64_tr_b16 a[138:139], v17 offset:34816
M v[80:83], a[168:171], a[64:67], v[80:83]
M v[80:83], a[172:175], a[68:71], v[80:83]
M v[84:87], a[172:175], a[76:79], v[84:87]
buffer_load_dwordx4 v9, s[12:15], s24 offen offset:3072 lds
M v[84:87], a[168:171], a[72:75], v[84:87]
ds_read_b64_tr_b16 a[144:145], v18 offset:32768
ds_read_b64_tr_b16 a[146:147], v18 offset:34816
M v[88:91], a[168:171], a[80:83], v[88:91]
M v[88:91], a[172:175], a[84:87], v[88:91]
M v[92:95], a[172:175], a[92:95], v[92:95]
M v[92:95], a[168:171], a[88:91], v[92:95]
s_waitcnt lgkmcnt(15)
ds_read_b64_tr_b16 a[152:153], v19 offset:32768
ds_read_b64_tr_b16 a[154:155], v19 offset:34816
M v[96:99], a[176:179], a[32:35], v[96:99]
s_add_u32 s24, s24, 262144
s_cmp_eq_u32 s24, s27
s_cselect_b32 s24, s28, s24
s_sub_u32 s6, s6, 1
s_cmp_eq_u32 s6, 0
s_cselect_b64 s[12:13], s[64:65], s[12:13]
M v[96:99], a[180:183], a[36:39], v[96:99]
M v[100:103], a[180:183], a[44:47], v[100:103]
M v[100:103], a[176:179], a[40:43], v[100:103]
M v[104:107], a[176:179], a[48:51], v[104:107]
M v[104:107], a[180:183], a[52:55], v[104:107]
M v[108:111], a[180:183], a[60:63], v[108:111]
M v[108:111], a[176:179], a[56:59], v[108:111]
s_waitcnt vmcnt(17) lgkmcnt(0)
s_barrier
ds_read_b128 a[160:163], v10 offset:16384
ds_read_b128 a[164:167], v11 offset:16384
M v[112:115], a[176:179], a[64:67], v[112:115]
s_add_u32 m0, s29, 0
s_nop 0
buffer_load_dwordx4 v2, s[8:11], s23 offen offset:0 lds
M v[112:115], a[180:183], a[68:71], v[112:115]
M v[116:119], a[180:183], a[76:79], v[116:119]
M v[116:119], a[176:179], a[72:75], v[116:119]
ds_read_b64_tr_b16 a[100:101], v12 offset:49152
ds_read_b64_tr_b16 a[102:103], v12 offset:51200
M v[120:123], a[176:179], a[80:83], v[120:123]
M v[120:123], a[180:183], a[84:87], v[120:123]
buffer_load_dwordx4 v3, s[8:11], s23 offen offset:1024 lds
M v[124:127], a[180:183], a[92:95], v[124:127]
M v[124:127], a[176:179], a[88:91], v[124:127]
M v[128:131], a[184:187], a[32:35], v[128:131]
M v[128:131], a[188:191], a[36:39], v[128:131]
ds_read_b128 a[168:171], v10 offset:18432
ds_read_b128 a[172:175], v11 offset:18432
ds_read_b64_tr_b16 a[108:109], v13 offset:49152
ds_read_b64_tr_b16 a[110:111], v13 offset:51200
M v[132:135], a[188:191], a[44:47], v[132:135]
M v[132:135], a[184:187], a[40:43], v[132:135]
buffer_load_dwordx4 v4, s[8:11], s23 offen offset:2048 lds
M v[136:139], a[184:187], a[48:51], v[136:139]
M v[136:139], a[188:191], a[52:55], v[136:139]
M v[140:143], a[188:191], a[60:63], v[140:143]
M v[140:143], a[184:187], a[56:59], v[140:143]
ds_read_b64_tr_b16 a[116:117], v14 offset:49152
ds_read_b64_tr_b16 a[118:119], v14 offset:51200
M v[144:147], a[184:187], a[64:67], v[144:147]
M v[144:147], a[188:191], a[68:71], v[144:147]
buffer_load_dwordx4 v5, s[8:11], s23 offen offset:3072 lds
M v[148:151], a[188:191], a[76:79], v[148:151]
M v[148:151], a[184:187], a[72:75], v[148:151]
M v[152:155], a[184:187], a[80:83], v[152:155]
M v[152:155], a[188:191], a[84:87], v[152:155]
ds_read_b64_tr_b16 a[124:125], v15 offset:49152
ds_read_b64_tr_b16 a[126:127], v15 offset:51200
M v[156:159], a[188:191], a[92:95], v[156:159]
s_add_u32 m0, s29, 98304
s_nop 0
buffer_load_dwordx4 v6, s[12:15], s24 offen offset:0 lds
M v[156:159], a[184:187], a[88:91], v[156:159]
s_waitcnt lgkmcnt(10)
M v[160:163], a[160:163], a[32:35], v[160:163]
M v[160:163], a[164:167], a[36:39], v[160:163]
ds_read_b128 a[176:179], v10 offset:20480
ds_read_b128 a[180:183], v11 offset:20480
M v[164:167], a[164:167], a[44:47], v[164:167]
M v[164:167], a[160:163], a[40:43], v[164:167]
ds_read_b64_tr_b16 a[132:133], v16 offset:49152
ds_read_b64_tr_b16 a[134:135], v16 offset:51200
M v[168:171], a[160:163], a[48:51], v[168:171]
M v[168:171], a[164:167], a[52:55], v[168:171]
buffer_load_dwordx4 v7, s[12:15], s24 offen offset:1024 lds
M v[172:175], a[164:167], a[60:63], v[172:175]
M v[172:175], a[160:163], a[56:59], v[172:175]
M v[176:179], a[160:163], a[64:67], v[176:179]
M v[176:179], a[164:167], a[68:71], v[176:179]
ds_read_b64_tr_b16 a[140:141], v17 offset:49152
ds_read_b64_tr_b16 a[142:143], v17 offset:51200
M v[180:183], a[164:167], a[76:79], v[180:183]
M v[180:183], a[160:163], a[72:75], v[180:183]
buffer_load_dwordx4 v8, s[12:15], s24 offen offset:2048 lds
M v[184:187], a[160:163], a[80:83], v[184:187]
M v[184:187], a[164:167], a[84:87], v[184:187]
M v[188:191], a[164:167], a[92:95], v[188:191]
M v[188:191], a[160:163], a[88:91], v[188:191]
s_waitcnt lgkmcnt(12)
ds_read_b64_tr_b16 a[148:149], v18 offset:49152
ds_read_b64_tr_b16 a[150:151], v18 offset:51200
M v[192:195], a[168:171], a[32:35], v[192:195]
buffer_load_dwordx4 v9, s[12:15], s24 offen offset:3072 lds
M v[192:195], a[172:175], a[36:39], v[192:195]
ds_read_b128 a[184:187], v10 offset:22528
ds_read_b128 a[188:191], v11 offset:22528
M v[196:199], a[172:175], a[44:47], v[196:199]
M v[196:199], a[168:171], a[40:43], v[196:199]
M v[200:203], a[168:171], a[48:51], v[200:203]
M v[200:203], a[172:175], a[52:55], v[200:203]
ds_read_b64_tr_b16 a[156:157], v19 offset:49152
ds_read_b64_tr_b16 a[158:159], v19 offset:51200
M v[204:207], a[172:175], a[60:63], v[204:207]
s_add_u32 s24, s24, 262144
M v[204:207], a[168:171], a[56:59], v[204:207]
M v[208:211], a[168:171], a[64:67], v[208:211]
M v[208:211], a[172:175], a[68:71], v[208:211]
M v[212:215], a[172:175], a[76:79], v[212:215]
M v[212:215], a[168:171], a[72:75], v[212:215]
buffer_load_dword v21, v20, s[60:63], s54 offen
s_add_u32 s54, s54, s55
M v[216:219], a[168:171], a[80:83], v[216:219]
M v[216:219], a[172:175], a[84:87], v[216:219]
M v[220:223], a[172:175], a[92:95], v[220:223]
M v[220:223], a[168:171], a[88:91], v[220:223]
s_waitcnt lgkmcnt(10)
M v[224:227], a[176:179], a[32:35], v[224:227]
s_cmp_eq_u32 s54, s56
s_cselect_b32 s54, s57, s54
s_cselect_b64 s[60:61], s[58:59], s[60:61]
s_cselect_b32 s62, s7, s62
M v[224:227], a[180:183], a[36:39], v[224:227]
M v[228:231], a[180:183], a[44:47], v[228:231]
M v[228:231], a[176:179], a[40:43], v[228:231]
M v[232:235], a[176:179], a[48:51], v[232:235]
M v[232:235], a[180:183], a[52:55], v[232:235]
M v[236:239], a[180:183], a[60:63], v[236:239]
M v[236:239], a[176:179], a[56:59], v[236:239]
s_waitcnt vmcnt(18) lgkmcnt(0)
s_barrier
ds_read_b128 a[160:163], v10 offset:32768
ds_read_b128 a[164:167], v11 offset:32768
M v[240:243], a[176:179], a[64:67], v[240:243]
s_add_u32 m0, s29, 16384
s_add_u32 s3, s23, s31
buffer_load_dwordx4 v2, s[8:11], s3 offen offset:0 lds
M v[240:243], a[180:183], a[68:71], v[240:243]
M v[244:247], a[180:183], a[76:79], v[244:247]
M v[244:247], a[176:179], a[72:75], v[244:247]
M v[248:251], a[176:179], a[80:83], v[248:251]
M v[248:251], a[180:183], a[84:87], v[248:251]
buffer_load_dwordx4 v3, s[8:11], s3 offen offset:1024 lds
M v[252:255], a[180:183], a[92:95], v[252:255]
M v[252:255], a[176:179], a[88:91], v[252:255]
M a[0:3], a[184:187], a[32:35], a[0:3]
M a[0:3], a[188:191], a[36:39], a[0:3]
ds_read_b128 a[168:171], v10 offset:34816
ds_read_b128 a[172:175], v11 offset:34816
M a[4:7], a[188:191], a[44:47], a[4:7]
M a[4:7], a[184:187], a[40:43], a[4:7]
M a[8:11], a[184:187], a[48:51], a[8:11]
buffer_load_dwordx4 v4, s[8:11], s3 offen offset:2048 lds
M a[8:11], a[188:191], a[52:55], a[8:11]
M a[12:15], a[188:191], a[60:63], a[12:15]
M a[12:15], a[184:187], a[56:59], a[12:15]
M a[16:19], a[184:187], a[64:67], a[16:19]
M a[16:19], a[188:191], a[68:71], a[16:19]
buffer_load_dwordx4 v5, s[8:11], s3 offen offset:3072 lds
M a[20:23], a[188:191], a[76:79], a[20:23]
M a[20:23], a[184:187], a[72:75], a[20:23]
M a[24:27], a[184:187], a[80:83], a[24:27]
M a[24:27], a[188:191], a[84:87], a[24:27]
M a[28:31], a[188:191], a[92:95], a[28:31]
M a[28:31], a[184:187], a[88:91], a[28:31]
s_waitcnt lgkmcnt(2)
M v[32:35], a[160:163], a[96:99], v[32:35]
s_add_u32 s23, s23, 128
s_cmp_eq_u32 s23, s25
s_cselect_b32 s23, s26, s23
M v[32:35], a[164:167], a[100:103], v[32:35]
ds_read_b128 a[176:179], v10 offset:36864
ds_read_b128 a[180:183], v11 offset:36864
M v[36:39], a[164:167], a[108:111], v[36:39]
M v[36:39], a[160:163], a[104:107], v[36:39]
ds_read_b64_tr_b16 a[32:33], v12 offset:0
ds_read_b64_tr_b16 a[34:35], v12 offset:2048
M v[40:43], a[160:163], a[112:115], v[40:43]
M v[40:43], a[164:167], a[116:119], v[40:43]
M v[44:47], a[164:167], a[124:127], v[44:47]
s_add_u32 m0, s29, 114688
s_nop 0
buffer_load_dwordx4 v6, s[12:15], s24 offen offset:0 lds
M v[44:47], a[160:163], a[120:123], v[44:47]
ds_read_b64_tr_b16 a[40:41], v13 offset:0
ds_read_b64_tr_b16 a[42:43], v13 offset:2048
M v[48:51], a[160:163], a[128:131], v[48:51]
M v[48:51], a[164:167], a[132:135], v[48:51]
M v[52:55], a[164:167], a[140:143], v[52:55]
M v[52:55], a[160:163], a[136:139], v[52:55]
ds_read_b64_tr_b16 a[48:49], v14 offset:0
ds_read_b64_tr_b16 a[50:51], v14 offset:2048
M v[56:59], a[160:163], a[144:147], v[56:59]
M v[56:59], a[164:167], a[148:151], v[56:59]
buffer_load_dwordx4 v7, s[12:15], s24 offen offset:1024 lds
M v[60:63], a[164:167], a[156:159], v[60:63]
M v[60:63], a[160:163], a[152:155], v[60:63]
s_waitcnt lgkmcnt(8)
ds_read_b64_tr_b16 a[56:57], v15 offset:0
ds_read_b64_tr_b16 a[58:59], v15 offset:2048
M v[64:67], a[168:171], a[96:99], v[64:67]
M v[64:67], a[172:175], a[100:103], v[64:67]
ds_read_b128 a[184:187], v10 offset:38912
ds_read_b128 a[188:191], v11 offset:38912
M v[68:71], a[172:175], a[108:111], v[68:71]
M v[68:71], a[168:171], a[104:107], v[68:71]
ds_read_b64_tr_b16 a[64:65], v16 offset:0
ds_read_b64_tr_b16 a[66:67], v16 offset:2048
M v[72:75], a[168:171], a[112:115], v[72:75]
buffer_load_dwordx4 v8, s[12:15], s24 offen offset:2048 lds
M v[72:75], a[172:175], a[116:119], v[72:75]
M v[76:79], a[172:175], a[124:127], v[76:79]
M v[76:79], a[168:171], a[120:123], v[76:79]
ds_read_b64_tr_b16 a[72:73], v17 offset:0
ds_read_b64_tr_b16 a[74:75], v17 offset:2048
M v[80:83], a[168:171], a[128:131], v[80:83]
M v[80:83], a[172:175], a[132:135], v[80:83]
M v[84:87], a[172:175], a[140:143], v[84:87]
buffer_load_dwordx4 v9, s[12:15], s24 offen offset:3072 lds
M v[84:87], a[168:171], a[136:139], v[84:87]
ds_read_b64_tr_b16 a[80:81], v18 offset:0
ds_read_b64_tr_b16 a[82:83], v18 offset:2048
M v[88:91], a[168:171], a[144:147], v[88:91]
M v[88:91], a[172:175], a[148:151], v[88:91]
M v[92:95], a[172:175], a[156:159], v[92:95]
M v[92:95], a[168:171], a[152:155], v[92:95]
s_waitcnt lgkmcnt(15)
ds_read_b64_tr_b16 a[88:89], v19 offset:0
ds_read_b64_tr_b16 a[90:91], v19 offset:2048
M v[96:99], a[176:179], a[96:99], v[96:99]
s_add_u32 s24, s24, 262144
s_cmp_eq_u32 s24, s27
s_cselect_b32 s24, s28, s24
s_sub_u32 s6, s6, 1
s_cmp_eq_u32 s6, 0
s_cselect_b64 s[12:13], s[64:65], s[12:13]
M v[96:99], a[180:183], a[100:103], v[96:99]
M v[100:103], a[180:183], a[108:111], v[100:103]
M v[100:103], a[176:179], a[104:107], v[100:103]
M v[104:107], a[176:179], a[112:115], v[104:107]
M v[104:107], a[180:183], a[116:119], v[104:107]
M v[108:111], a[180:183], a[124:127], v[108:111]
M v[108:111], a[176:179], a[120:123], v[108:111]
s_waitcnt vmcnt(17) lgkmcnt(0)
s_barrier
ds_read_b128 a[160:163], v10 offset:49152
ds_read_b128 a[164:167], v11 offset:49152
M v[112:115], a[176:179], a[128:131], v[112:115]
s_add_u32 m0, s29, 32768
s_nop 0
buffer_load_dwordx4 v2, s[8:11], s23 offen offset:0 lds
M v[112:115], a[180:183], a[132:135], v[112:115]
M v[116:119], a[180:183], a[140:143], v[116:119]
M v[116:119], a[176:179], a[136:139], v[116:119]
ds_read_b64_tr_b16 a[36:37], v12 offset:16384
ds_read_b64_tr_b16 a[38:39], v12 offset:18432
M v[120:123], a[176:179], a[144:147], v[120:123]
M v[120:123], a[180:183], a[148:151], v[120:123]
buffer_load_dwordx4 v3, s[8:11], s23 offen offset:1024 lds
M v[124:127], a[180:183], a[156:159], v[124:127]
M v[124:127], a[176:179], a[152:155], v[124:127]
M v[128:131], a[184:187], a[96:99], v[128:131]
M v[128:131], a[188:191], a[100:103], v[128:131]
ds_read_b128 a[168:171], v10 offset:51200
ds_read_b128 a[172:175], v11 offset:51200
ds_read_b64_tr_b16 a[44:45], v13 offset:16384
ds_read_b64_tr_b16 a[46:47], v13 offset:18432
M v[132:135], a[188:191], a[108:111], v[132:135]
M v[132:135], a[184:187], a[104:107], v[132:135]
buffer_load_dwordx4 v4, s[8:11], s23 offen offset:2048 lds
M v[136:139], a[184:187], a[112:115], v[136:139]
M v[136:139], a[188:191], a[116:119], v[136:139]
M v[140:143], a[188:191], a[124:127], v[140:143]
M v[140:143], a[184:187], a[120:123], v[140:143]
ds_read_b64_tr_b16 a[52:53], v14 offset:16384
ds_read_b64_tr_b16 a[54:55], v14 offset:18432
M v[144:147], a[184:187], a[128:131], v[144:147]
M v[144:147], a[188:191], a[132:135], v[144:147]
buffer_load_dwordx4 v5, s[8:11], s23 offen offset:3072 lds
M v[148:151], a[188:191], a[140:143], v[148:151]
M v[148:151], a[184:187], a[136:139], v[148:151]
M v[152:155], a[184:187], a[144:147], v[152:155]
M v[152:155], a[188:191], a[148:151], v[152:155]
ds_read_b64_tr_b16 a[60:61], v15 offset:16384
ds_read_b64_tr_b16 a[62:63], v15 offset:18432
M v[156:159], a[188:191], a[156:159], v[156:159]
s_add_u32 m0, s29, 65536
s_nop 0
buffer_load_dwordx4 v6, s[12:15], s24 offen offset:0 lds
M v[156:159], a[184:187], a[152:155], v[156:159]
s_waitcnt lgkmcnt(10)
M v[160:163], a[160:163], a[96:99], v[160:163]
M v[160:163], a[164:167], a[100:103], v[160:163]
ds_read_b128 a[176:179], v10 offset:53248
ds_read_b128 a[180:183], v11 offset:53248
M v[164:167], a[164:167], a[108:111], v[164:167]
M v[164:167], a[160:163], a[104:107], v[164:167]
ds_read_b64_tr_b16 a[68:69], v16 offset:16384
ds_read_b64_tr_b16 a[70:71], v16 offset:18432
M v[168:171], a[160:163], a[112:115], v[168:171]
M v[168:171], a[164:167], a[116:119], v[168:171]
buffer_load_dwordx4 v7, s[12:15], s24 offen offset:1024 lds
M v[172:175], a[164:167], a[124:127], v[172:175]
M v[172:175], a[160:163], a[120:123], v[172:175]
M v[176:179], a[160:163], a[128:131], v[176:179]
M v[176:179], a[164:167], a[132:135], v[176:179]
ds_read_b64_tr_b16 a[76:77], v17 offset:16384
ds_read_b64_tr_b16 a[78:79], v17 offset:18432
M v[180:183], a[164:167], a[140:143], v[180:183]
M v[180:183], a[160:163], a[136:139], v[180:183]
buffer_load_dwordx4 v8, s[12:15], s24 offen offset:2048 lds
M v[184:187], a[160:163], a[144:147], v[184:187]
M v[184:187], a[164:167], a[148:151], v[184:187]
M v[188:191], a[164:167], a[156:159], v[188:191]
M v[188:191], a[160:163], a[152:155], v[188:191]
s_waitcnt lgkmcnt(12)
ds_read_b64_tr_b16 a[84:85], v18 offset:16384
ds_read_b64_tr_b16 a[86:87], v18 offset:18432
M v[192:195], a[168:171], a[96:99], v[192:195]
buffer_load_dwordx4 v9, s[12:15], s24 offen offset:3072 lds
M v[192:195], a[172:175], a[100:103], v[192:195]
ds_read_b128 a[184:187], v10 offset:55296
ds_read_b128 a[188:191], v11 offset:55296
M v[196:199], a[172:175], a[108:111], v[196:199]
M v[196:199], a[168:171], a[104:107], v[196:199]
M v[200:203], a[168:171], a[112:115], v[200:203]
M v[200:203], a[172:175], a[116:119], v[200:203]
ds_read_b64_tr_b16 a[92:93], v19 offset:16384
ds_read_b64_tr_b16 a[94:95], v19 offset:18432
M v[204:207], a[172:175], a[124:127], v[204:207]
s_add_u32 s24, s24, 262144
M v[204:207], a[168:171], a[120:123], v[204:207]
M v[208:211], a[168:171], a[128:131], v[208:211]
M v[208:211], a[172:175], a[132:135], v[208:211]
M v[212:215], a[172:175], a[140:143], v[212:215]
M v[212:215], a[168:171], a[136:139], v[212:215]
buffer_load_dword v21, v20, s[60:63], s54 offen
s_add_u32 s54, s54, s55
M v[216:219], a[168:171], a[144:147], v[216:219]
M v[216:219], a[172:175], a[148:151], v[216:219]
M v[220:223], a[172:175], a[156:159], v[220:223]
M v[220:223], a[168:171], a[152:155], v[220:223]
s_waitcnt lgkmcnt(10)
M v[224:227], a[176:179], a[96:99], v[224:227]
s_cmp_eq_u32 s54, s56
s_cselect_b32 s54, s57, s54
s_cselect_b64 s[60:61], s[58:59], s[60:61]
s_cselect_b32 s62, s7, s62
M v[224:227], a[180:183], a[100:103], v[224:227]
M v[228:231], a[180:183], a[108:111], v[228:231]
M v[228:231], a[176:179], a[104:107], v[228:231]
M v[232:235], a[176:179], a[112:115], v[232:235]
M v[232:235], a[180:183], a[116:119], v[232:235]
M v[236:239], a[180:183], a[124:127], v[236:239]
M v[236:239], a[176:179], a[120:123], v[236:239]
s_waitcnt vmcnt(18) lgkmcnt(0)
s_barrier
ds_read_b128 a[160:163], v10 offset:0
ds_read_b128 a[164:167], v11 offset:0
M v[240:243], a[176:179], a[128:131], v[240:243]
s_add_u32 m0, s29, 49152
s_add_u32 s3, s23, s31
buffer_load_dwordx4 v2, s[8:11], s3 offen offset:0 lds
M v[240:243], a[180:183], a[132:135], v[240:243]
M v[244:247], a[180:183], a[140:143], v[244:247]
M v[244:247], a[176:179], a[136:139], v[244:247]
M v[248:251], a[176:179], a[144:147], v[248:251]
M v[248:251], a[180:183], a[148:151], v[248:251]
buffer_load_dwordx4 v3, s[8:11], s3 offen offset:1024 lds
M v[252:255], a[180:183], a[156:159], v[252:255]
M v[252:255], a[176:179], a[152:155], v[252:255]
M a[0:3], a[184:187], a[96:99], a[0:3]
M a[0:3], a[188:191], a[100:103], a[0:3]
ds_read_b128 a[168:171], v10 offset:2048
ds_read_b128 a[172:175], v11 offset:2048
M a[4:7], a[188:191], a[108:111], a[4:7]
M a[4:7], a[184:187], a[104:107], a[4:7]
M a[8:11], a[184:187], a[112:115], a[8:11]
buffer_load_dwordx4 v4, s[8:11], s3 offen offset:2048 lds
M a[8:11], a[188:191], a[116:119], a[8:11]
M a[12:15], a[188:191], a[124:127], a[12:15]
M a[12:15], a[184:187], a[120:123], a[12:15]
M a[16:19], a[184:187], a[128:131], a[16:19]
M a[16:19], a[188:191], a[132:135], a[16:19]
buffer_load_dwordx4 v5, s[8:11], s3 offen offset:3072 lds
M a[20:23], a[188:191], a[140:143], a[20:23]
M a[20:23], a[184:187], a[136:139], a[20:23]
M a[24:27], a[184:187], a[144:147], a[24:27]
M a[24:27], a[188:191], a[148:151], a[24:27]
M a[28:31], a[188:191], a[156:159], a[28:31]
M a[28:31], a[184:187], a[152:155], a[28:31]
s_waitcnt lgkmcnt(2)
M v[32:35], a[160:163], a[32:35], v[32:35]
s_add_u32 s23, s23, 128
s_cmp_eq_u32 s23, s25
s_cselect_b32 s23, s26, s23
M v[32:35], a[164:167], a[36:39], v[32:35]
ds_read_b128 a[176:179], v10 offset:4096
ds_read_b128 a[180:183], v11 offset:4096
M v[36:39], a[164:167], a[44:47], v[36:39]
M v[36:39], a[160:163], a[40:43], v[36:39]
ds_read_b64_tr_b16 a[96:97], v12 offset:32768
ds_read_b64_tr_b16 a[98:99], v12 offset:34816
M v[40:43], a[160:163], a[48:51], v[40:43]
M v[40:43], a[164:167], a[52:55], v[40:43]
M v[44:47], a[164:167], a[60:63], v[44:47]
s_add_u32 m0, s29, 81920
s_nop 0
buffer_load_dwordx4 v6, s[12:15], s24 offen offset:0 lds
M v[44:47], a[160:163], a[56:59], v[44:47]
ds_read_b64_tr_b16 a[104:105], v13 offset:32768
ds_read_b64_tr_b16 a[106:107], v13 offset:34816
M v[48:51], a[160:163], a[64:67], v[48:51]
M v[48:51], a[164:167], a[68:71], v[48:51]
M v[52:55], a[164:167], a[76:79], v[52:55]
M v[52:55], a[160:163], a[72:75], v[52:55]
ds_read_b64_tr_b16 a[112:113], v14 offset:32768
ds_read_b64_tr_b16 a[114:115], v14 offset:34816
M v[56:59], a[160:163], a[80:83], v[56:59]
M v[56:59], a[164:167], a[84:87], v[56:59]
buffer_load_dwordx4 v7, s[12:15], s24 offen offset:1024 lds
M v[60:63], a[164:167], a[92:95], v[60:63]
M v[60:63], a[160:163], a[88:91], v[60:63]
s_waitcnt lgkmcnt(8)
ds_read_b64_tr_b16 a[120:121], v15 offset:32768
ds_read_b64_tr_b16 a[122:123], v15 offset:34816
M v[64:67], a[168:171], a[32:35], v[64:67]
M v[64:67], a[172:175], a[36:39], v[64:67]
ds_read_b128 a[184:187], v10 offset:6144
ds_read_b128 a[188:191], v11 offset:6144
M v[68:71], a[172:175], a[44:47], v[68:71]
M v[68:71], a[168:171], a[40:43], v[68:71]
ds_read_b64_tr_b16 a[128:129], v16 offset:32768
ds_read_b64_tr_b16 a[130:131], v16 offset:34816
M v[72:75], a[168:171], a[48:51], v[72:75]
buffer_load_dwordx4 v8, s[12:15], s24 offen offset:2048 lds
M v[72:75], a[172:175], a[52:55], v[72:75]
M v[76:79], a[172:175], a[60:63], v[76:79]
M v[76:79], a[168:171], a[56:59], v[76:79]
ds_read_b64_tr_b16 a[136:137], v17 offset:32768
ds_read_b64_tr_b16 a[138:139], v17 offset:34816
M v[80:83], a[168:171], a[64:67], v[80:83]
M v[80:83], a[172:175], a[68:71], v[80:83]
M v[84:87], a[172:175], a[76:79], v[84:87]
buffer_load_dwordx4 v9, s[12:15], s24 offen offset:3072 lds
M v[84:87], a[168:171], a[72:75], v[84:87]
ds_read_b64_tr_b16 a[144:145], v18 offset:32768
ds_read_b64_tr_b16 a[146:147], v18 offset:34816
M v[88:91], a[168:171], a[80:83], v[88:91]
M v[88:91], a[172:175], a[84:87], v[88:91]
M v[92:95], a[172:175], a[92:95], v[92:95]
M v[92:95], a[168:171], a[88:91], v[92:95]
s_waitcnt lgkmcnt(15)
ds_read_b64_tr_b16 a[152:153], v19 offset:32768
ds_read_b64_tr_b16 a[154:155], v19 offset:34816
M v[96:99], a[176:179], a[32:35], v[96:99]
s_add_u32 s24, s24, 262144
s_cmp_eq_u32 s24, s27
s_cselect_b32 s24, s28, s24
s_sub_u32 s6, s6, 1
s_cmp_eq_u32 s6, 0
s_cselect_b64 s[12:13], s[64:65], s[12:13]
M v[96:99], a[180:183], a[36:39], v[96:99]
M v[100:103], a[180:183], a[44:47], v[100:103]
M v[100:103], a[176:179], a[40:43], v[100:103]
M v[104:107], a[176:179], a[48:51], v[104:107]
M v[104:107], a[180:183], a[52:55], v[104:107]
M v[108:111], a[180:183], a[60:63], v[108:111]
M v[108:111], a[176:179], a[56:59], v[108:111]
s_waitcnt vmcnt(17) lgkmcnt(0)
s_barrier
ds_read_b128 a[160:163], v10 offset:16384
ds_read_b128 a[164:167], v11 offset:16384
M v[112:115], a[176:179], a[64:67], v[112:115]
s_add_u32 m0, s29, 0
s_nop 0
buffer_load_dwordx4 v2, s[8:11], s23 offen offset:0 lds
M v[112:115], a[180:183], a[68:71], v[112:115]
M v[116:119], a[180:183], a[76:79], v[116:119]
M v[116:119], a[176:179], a[72:75], v[116:119]
ds_read_b64_tr_b16 a[100:101], v12 offset:49152
ds_read_b64_tr_b16 a[102:103], v12 offset:51200
M v[120:123], a[176:179], a[80:83], v[120:123]
M v[120:123], a[180:183], a[84:87], v[120:123]
M v[124:127], a[180:183], a[92:95], v[124:127]
buffer_load_dwordx4 v3, s[8:11], s23 offen offset:1024 lds
M v[124:127], a[176:179], a[88:91], v[124:127]
M v[128:131], a[184:187], a[32:35], v[128:131]
M v[128:131], a[188:191], a[36:39], v[128:131]
ds_read_b128 a[168:171], v10 offset:18432
ds_read_b128 a[172:175], v11 offset:18432
ds_read_b64_tr_b16 a[108:109], v13 offset:49152
ds_read_b64_tr_b16 a[110:111], v13 offset:51200
M v[132:135], a[188:191], a[44:47], v[132:135]
M v[132:135], a[184:187], a[40:43], v[132:135]
M v[136:139], a[184:187], a[48:51], v[136:139]
M v[136:139], a[188:191], a[52:55], v[136:139]
buffer_load_dwordx4 v4, s[8:11], s23 offen offset:2048 lds
M v[140:143], a[188:191], a[60:63], v[140:143]
M v[140:143], a[184:187], a[56:59], v[140:143]
ds_read_b64_tr_b16 a[116:117], v14 offset:49152
ds_read_b64_tr_b16 a[118:119], v14 offset:51200
M v[144:147], a[184:187], a[64:67], v[144:147]
M v[144:147], a[188:191], a[68:71], v[144:147]
M v[148:151], a[188:191], a[76:79], v[148:151]
M v[148:151], a[184:187], a[72:75], v[148:151]
M v[152:155], a[184:187], a[80:83], v[152:155]
buffer_load_dwordx4 v5, s[8:11], s23 offen offset:3072 lds
M v[152:155], a[188:191], a[84:87], v[152:155]
ds_read_b64_tr_b16 a[124:125], v15 offset:49152
ds_read_b64_tr_b16 a[126:127], v15 offset:51200
M v[156:159], a[188:191], a[92:95], v[156:159]
M v[156:159], a[184:187], a[88:91], v[156:159]
s_waitcnt lgkmcnt(10)
M v[160:163], a[160:163], a[32:35], v[160:163]
M v[160:163], a[164:167], a[36:39], v[160:163]
ds_read_b128 a[176:179], v10 offset:20480
ds_read_b128 a[180:183], v11 offset:20480
M v[164:167], a[164:167], a[44:47], v[164:167]
M v[164:167], a[160:163], a[40:43], v[164:167]
ds_read_b64_tr_b16 a[132:133], v16 offset:49152
ds_read_b64_tr_b16 a[134:135], v16 offset:51200
M v[168:171], a[160:163], a[48:51], v[168:171]
M v[168:171], a[164:167], a[52:55], v[168:171]
s_add_u32 m0, s29, 98304
s_nop 0
buffer_load_dwordx4 v6, s[12:15], s24 offen offset:0 lds
M v[172:175], a[164:167], a[60:63], v[172:175]
M v[172:175], a[160:163], a[56:59], v[172:175]
M v[176:179], a[160:163], a[64:67], v[176:179]
M v[176:179], a[164:167], a[68:71], v[176:179]
ds_read_b64_tr_b16 a[140:141], v17 offset:49152
ds_read_b64_tr_b16 a[142:143], v17 offset:51200
M v[180:183], a[164:167], a[76:79], v[180:183]
M v[180:183], a[160:163], a[72:75], v[180:183]
buffer_load_dwordx4 v7, s[12:15], s24 offen offset:1024 lds
M v[184:187], a[160:163], a[80:83], v[184:187]
M v[184:187], a[164:167], a[84:87], v[184:187]
M v[188:191], a[164:167], a[92:95], v[188:191]
M v[188:191], a[160:163], a[88:91], v[188:191]
s_waitcnt lgkmcnt(12)
ds_read_b64_tr_b16 a[148:149], v18 offset:49152
ds_read_b64_tr_b16 a[150:151], v18 offset:51200
M v[192:195], a[168:171], a[32:35], v[192:195]
M v[192:195], a[172:175], a[36:39], v[192:195]
ds_read_b128 a[184:187], v10 offset:22528
ds_read_b128 a[188:191], v11 offset:22528
M v[196:199], a[172:175], a[44:47], v[196:199]
M v[196:199], a[168:171], a[40:43], v[196:199]
buffer_load_dwordx4 v8, s[12:15], s24 offen offset:2048 lds
M v[200:203], a[168:171], a[48:51], v[200:203]
M v[200:203], a[172:175], a[52:55], v[200:203]
ds_read_b64_tr_b16 a[156:157], v19 offset:49152
ds_read_b64_tr_b16 a[158:159], v19 offset:51200
M v[204:207], a[172:175], a[60:63], v[204:207]
M v[204:207], a[168:171], a[56:59], v[204:207]
M v[208:211], a[168:171], a[64:67], v[208:211]
M v[208:211], a[172:175], a[68:71], v[208:211]
buffer_load_dwordx4 v9, s[12:15], s24 offen offset:3072 lds
M v[212:215], a[172:175], a[76:79], v[212:215]
M v[212:215], a[168:171], a[72:75], v[212:215]
M v[216:219], a[168:171], a[80:83], v[216:219]
M v[216:219], a[172:175], a[84:87], v[216:219]
M v[220:223], a[172:175], a[92:95], v[220:223]
s_add_u32 s24, s24, 262144
M v[220:223], a[168:171], a[88:91], v[220:223]
s_waitcnt lgkmcnt(10)
M v[224:227], a[176:179], a[32:35], v[224:227]
M v[224:227], a[180:183], a[36:39], v[224:227]
M v[228:231], a[180:183], a[44:47], v[228:231]
M v[228:231], a[176:179], a[40:43], v[228:231]
M v[232:235], a[176:179], a[48:51], v[232:235]
M v[232:235], a[180:183], a[52:55], v[232:235]
M v[236:239], a[180:183], a[60:63], v[236:239]
M v[236:239], a[176:179], a[56:59], v[236:239]
s_waitcnt vmcnt(17) lgkmcnt(0)
s_barrier
ds_read_b128 a[160:163], v10 offset:32768
ds_read_b128 a[164:167], v11 offset:32768
M v[240:243], a[176:179], a[64:67], v[240:243]
s_add_u32 m0, s29, 16384
s_add_u32 s3, s23, s31
buffer_load_dwordx4 v2, s[8:11], s3 offen offset:0 lds
M v[240:243], a[180:183], a[68:71], v[240:243]
M v[244:247], a[180:183], a[76:79], v[244:247]
M v[244:247], a[176:179], a[72:75], v[244:247]
M v[248:251], a[176:179], a[80:83], v[248:251]
M v[248:251], a[180:183], a[84:87], v[248:251]
buffer_load_dwordx4 v3, s[8:11], s3 offen offset:1024 lds
M v[252:255], a[180:183], a[92:95], v[252:255]
M v[252:255], a[176:179], a[88:91], v[252:255]
M a[0:3], a[184:187], a[32:35], a[0:3]
M a[0:3], a[188:191], a[36:39], a[0:3]
ds_read_b128 a[168:171], v10 offset:34816
ds_read_b128 a[172:175], v11 offset:34816
M a[4:7], a[188:191], a[44:47], a[4:7]
M a[4:7], a[184:187], a[40:43], a[4:7]
M a[8:11], a[184:187], a[48:51], a[8:11]
buffer_load_dwordx4 v4, s[8:11], s3 offen offset:2048 lds
M a[8:11], a[188:191], a[52:55], a[8:11]
M a[12:15], a[188:191], a[60:63], a[12:15]
M a[12:15], a[184:187], a[56:59], a[12:15]
M a[16:19], a[184:187], a[64:67], a[16:19]
M a[16:19], a[188:191], a[68:71], a[16:19]
buffer_load_dwordx4 v5, s[8:11], s3 offen offset:3072 lds
M a[20:23], a[188:191], a[76:79], a[20:23]
M a[20:23], a[184:187], a[72:75], a[20:23]
M a[24:27], a[184:187], a[80:83], a[24:27]
M a[24:27], a[188:191], a[84:87], a[24:27]
M a[28:31], a[188:191], a[92:95], a[28:31]
M a[28:31], a[184:187], a[88:91], a[28:31]
s_waitcnt lgkmcnt(2)
M v[32:35], a[160:163], a[96:99], v[32:35]
s_add_u32 s23, s23, 128
s_cmp_eq_u32 s23, s25
s_cselect_b32 s23, s26, s23
M v[32:35], a[164:167], a[100:103], v[32:35]
ds_read_b128 a[176:179], v10 offset:36864
ds_read_b128 a[180:183], v11 offset:36864
M v[36:39], a[164:167], a[108:111], v[36:39]
M v[36:39], a[160:163], a[104:107], v[36:39]
ds_read_b64_tr_b16 a[32:33], v12 offset:0
ds_read_b64_tr_b16 a[34:35], v12 offset:2048
M v[40:43], a[160:163], a[112:115], v[40:43]
M v[40:43], a[164:167], a[116:119], v[40:43]
M v[44:47], a[164:167], a[124:127], v[44:47]
s_add_u32 m0, s29, 114688
s_nop 0
buffer_load_dwordx4 v6, s[12:15], s24 offen offset:0 lds
M v[44:47], a[160:163], a[120:123], v[44:47]
ds_read_b64_tr_b16 a[40:41], v13 offset:0
ds_read_b64_tr_b16 a[42:43], v13 offset:2048
M v[48:51], a[160:163], a[128:131], v[48:51]
M v[48:51], a[164:167], a[132:135], v[48:51]
M v[52:55], a[164:167], a[140:143], v[52:55]
M v[52:55], a[160:163], a[136:139], v[52:55]
ds_read_b64_tr_b16 a[48:49], v14 offset:0
ds_read_b64_tr_b16 a[50:51], v14 offset:2048
M v[56:59], a[160:163], a[144:147], v[56:59]
M v[56:59], a[164:167], a[148:151], v[56:59]
buffer_load_dwordx4 v7, s[12:15], s24 offen offset:1024 lds
M v[60:63], a[164:167], a[156:159], v[60:63]
M v[60:63], a[160:163], a[152:155], v[60:63]
s_waitcnt lgkmcnt(8)
ds_read_b64_tr_b16 a[56:57], v15 offset:0
ds_read_b64_tr_b16 a[58:59], v15 offset:2048
M v[64:67], a[168:171], a[96:99], v[64:67]
M v[64:67], a[172:175], a[100:103], v[64:67]
ds_read_b128 a[184:187], v10 offset:38912
ds_read_b128 a[188:191], v11 offset:38912
M v[68:71], a[172:175], a[108:111], v[68:71]
M v[68:71], a[168:171], a[104:107], v[68:71]
ds_read_b64_tr_b16 a[64:65], v16 offset:0
ds_read_b64_tr_b16 a[66:67], v16 offset:2048
M v[72:75], a[168:171], a[112:115], v[72:75]
buffer_load_dwordx4 v8, s[12:15], s24 offen offset:2048 lds
M v[72:75], a[172:175], a[116:119], v[72:75]
M v[76:79], a[172:175], a[124:127], v[76:79]
M v[76:79], a[168:171], a[120:123], v[76:79]
ds_read_b64_tr_b16 a[72:73], v17 offset:0
ds_read_b64_tr_b16 a[74:75], v17 offset:2048
M v[80:83], a[168:171], a[128:131], v[80:83]
M v[80:83], a[172:175], a[132:135], v[80:83]
M v[84:87], a[172:175], a[140:143], v[84:87]
buffer_load_dwordx4 v9, s[12:15], s24 offen offset:3072 lds
M v[84:87], a[168:171], a[136:139], v[84:87]
ds_read_b64_tr_b16 a[80:81], v18 offset:0
ds_read_b64_tr_b16 a[82:83], v18 offset:2048
M v[88:91], a[168:171], a[144:147], v[88:91]
M v[88:91], a[172:175], a[148:151], v[88:91]
M v[92:95], a[172:175], a[156:159], v[92:95]
M v[92:95], a[168:171], a[152:155], v[92:95]
s_waitcnt lgkmcnt(15)
ds_read_b64_tr_b16 a[88:89], v19 offset:0
ds_read_b64_tr_b16 a[90:91], v19 offset:2048
M v[96:99], a[176:179], a[96:99], v[96:99]
s_add_u32 s24, s24, 262144
s_cmp_eq_u32 s24, s27
s_cselect_b32 s24, s28, s24
s_sub_u32 s6, s6, 1
s_cmp_eq_u32 s6, 0
s_cselect_b64 s[12:13], s[64:65], s[12:13]
M v[96:99], a[180:183], a[100:103], v[96:99]
M v[100:103], a[180:183], a[108:111], v[100:103]
M v[100:103], a[176:179], a[104:107], v[100:103]
M v[104:107], a[176:179], a[112:115], v[104:107]
M v[104:107], a[180:183], a[116:119], v[104:107]
M v[108:111], a[180:183], a[124:127], v[108:111]
M v[108:111], a[176:179], a[120:123], v[108:111]
s_waitcnt vmcnt(16) lgkmcnt(0)
s_barrier
ds_read_b128 a[160:163], v10 offset:49152
ds_read_b128 a[164:167], v11 offset:49152
M v[112:115], a[176:179], a[128:131], v[112:115]
s_add_u32 m0, s29, 32768
s_nop 0
buffer_load_dwordx4 v2, s[8:11], s23 offen offset:0 lds
M v[112:115], a[180:183], a[132:135], v[112:115]
M v[116:119], a[180:183], a[140:143], v[116:119]
M v[116:119], a[176:179], a[136:139], v[116:119]
ds_read_b64_tr_b16 a[36:37], v12 offset:16384
ds_read_b64_tr_b16 a[38:39], v12 offset:18432
M v[120:123], a[176:179], a[144:147], v[120:123]
M v[120:123], a[180:183], a[148:151], v[120:123]
M v[124:127], a[180:183], a[156:159], v[124:127]
M v[124:127], a[176:179], a[152:155], v[124:127]
M v[128:131], a[184:187], a[96:99], v[128:131]
M v[128:131], a[188:191], a[100:103], v[128:131]
ds_read_b128 a[168:171], v10 offset:51200
ds_read_b128 a[172:175], v11 offset:51200
ds_read_b64_tr_b16 a[44:45], v13 offset:16384
ds_read_b64_tr_b16 a[46:47], v13 offset:18432
M v[132:135], a[188:191], a[108:111], v[132:135]
M v[132:135], a[184:187], a[104:107], v[132:135]
M v[136:139], a[184:187], a[112:115], v[136:139]
M v[136:139], a[188:191], a[116:119], v[136:139]
M v[140:143], a[188:191], a[124:127], v[140:143]
M v[140:143], a[184:187], a[120:123], v[140:143]
ds_read_b64_tr_b16 a[52:53], v14 offset:16384
ds_read_b64_tr_b16 a[54:55], v14 offset:18432
M v[144:147], a[184:187], a[128:131], v[144:147]
buffer_load_dwordx4 v3, s[8:11], s23 offen offset:1024 lds
M v[144:147], a[188:191], a[132:135], v[144:147]
M v[148:151], a[188:191], a[140:143], v[148:151]
M v[148:151], a[184:187], a[136:139], v[148:151]
M v[152:155], a[184:187], a[144:147], v[152:155]
M v[152:155], a[188:191], a[148:151], v[152:155]
ds_read_b64_tr_b16 a[60:61], v15 offset:16384
ds_read_b64_tr_b16 a[62:63], v15 offset:18432
M v[156:159], a[188:191], a[156:159], v[156:159]
M v[156:159], a[184:187], a[152:155], v[156:159]
s_waitcnt lgkmcnt(10)
M v[160:163], a[160:163], a[96:99], v[160:163]
M v[160:163], a[164:167], a[100:103], v[160:163]
ds_read_b128 a[176:179], v10 offset:53248
ds_read_b128 a[180:183], v11 offset:53248
M v[164:167], a[164:167], a[108:111], v[164:167]
M v[164:167], a[160:163], a[104:107], v[164:167]
ds_read_b64_tr_b16 a[68:69], v16 offset:16384
ds_read_b64_tr_b16 a[70:71], v16 offset:18432
M v[168:171], a[160:163], a[112:115], v[168:171]
M v[168:171], a[164:167], a[116:119], v[168:171]
M v[172:175], a[164:167], a[124:127], v[172:175]
M v[172:175], a[160:163], a[120:123], v[172:175]
M v[176:179], a[160:163], a[128:131], v[176:179]
buffer_load_dwordx4 v4, s[8:11], s23 offen offset:2048 lds
M v[176:179], a[164:167], a[132:135], v[176:179]
ds_read_b64_tr_b16 a[76:77], v17 offset:16384
ds_read_b64_tr_b16 a[78:79], v17 offset:18432
M v[180:183], a[164:167], a[140:143], v[180:183]
M v[180:183], a[160:163], a[136:139], v[180:183]
M v[184:187], a[160:163], a[144:147], v[184:187]
M v[184:187], a[164:167], a[148:151], v[184:187]
M v[188:191], a[164:167], a[156:159], v[188:191]
M v[188:191], a[160:163], a[152:155], v[188:191]
s_waitcnt lgkmcnt(12)
ds_read_b64_tr_b16 a[84:85], v18 offset:16384
ds_read_b64_tr_b16 a[86:87], v18 offset:18432
M v[192:195], a[168:171], a[96:99], v[192:195]
M v[192:195], a[172:175], a[100:103], v[192:195]
ds_read_b128 a[184:187], v10 offset:55296
ds_read_b128 a[188:191], v11 offset:55296
M v[196:199], a[172:175], a[108:111], v[196:199]
M v[196:199], a[168:171], a[104:107], v[196:199]
M v[200:203], a[168:171], a[112:115], v[200:203]
M v[200:203], a[172:175], a[116:119], v[200:203]
ds_read_b64_tr_b16 a[92:93], v19 offset:16384
ds_read_b64_tr_b16 a[94:95], v19 offset:18432
M v[204:207], a[172:175], a[124:127], v[204:207]
M v[204:207], a[168:171], a[120:123], v[204:207]
M v[208:211], a[168:171], a[128:131], v[208:211]
buffer_load_dwordx4 v5, s[8:11], s23 offen offset:3072 lds
M v[208:211], a[172:175], a[132:135], v[208:211]
M v[212:215], a[172:175], a[140:143], v[212:215]
M v[212:215], a[168:171], a[136:139], v[212:215]
M v[216:219], a[168:171], a[144:147], v[216:219]
M v[216:219], a[172:175], a[148:151], v[216:219]
M v[220:223], a[172:175], a[156:159], v[220:223]
M v[220:223], a[168:171], a[152:155], v[220:223]
s_waitcnt lgkmcnt(10)
M v[224:227], a[176:179], a[96:99], v[224:227]
M v[224:227], a[180:183], a[100:103], v[224:227]
M v[228:231], a[180:183], a[108:111], v[228:231]
M v[228:231], a[176:179], a[104:107], v[228:231]
M v[232:235], a[176:179], a[112:115], v[232:235]
M v[232:235], a[180:183], a[116:119], v[232:235]
M v[236:239], a[180:183], a[124:127], v[236:239]
M v[236:239], a[176:179], a[120:123], v[236:239]
s_waitcnt vmcnt(12) lgkmcnt(0)
s_barrier
ds_read_b128 a[160:163], v10 offset:0
ds_read_b128 a[164:167], v11 offset:0
M v[240:243], a[176:179], a[128:131], v[240:243]
s_add_u32 m0, s29, 49152
s_add_u32 s3, s23, s31
buffer_load_dwordx4 v2, s[8:11], s3 offen offset:0 lds
M v[240:243], a[180:183], a[132:135], v[240:243]
M v[244:247], a[180:183], a[140:143], v[244:247]
M v[244:247], a[176:179], a[136:139], v[244:247]
M v[248:251], a[176:179], a[144:147], v[248:251]
M v[248:251], a[180:183], a[148:151], v[248:251]
M v[252:255], a[180:183], a[156:159], v[252:255]
M v[252:255], a[176:179], a[152:155], v[252:255]
M a[0:3], a[184:187], a[96:99], a[0:3]
M a[0:3], a[188:191], a[100:103], a[0:3]
ds_read_b128 a[168:171], v10 offset:2048
ds_read_b128 a[172:175], v11 offset:2048
M a[4:7], a[188:191], a[108:111], a[4:7]
M a[4:7], a[184:187], a[104:107], a[4:7]
M a[8:11], a[184:187], a[112:115], a[8:11]
buffer_load_dwordx4 v3, s[8:11], s3 offen offset:1024 lds
M a[8:11], a[188:191], a[116:119], a[8:11]
M a[12:15], a[188:191], a[124:127], a[12:15]
M a[12:15], a[184:187], a[120:123], a[12:15]
M a[16:19], a[184:187], a[128:131], a[16:19]
M a[16:19], a[188:191], a[132:135], a[16:19]
M a[20:23], a[188:191], a[140:143], a[20:23]
M a[20:23], a[184:187], a[136:139], a[20:23]
M a[24:27], a[184:187], a[144:147], a[24:27]
M a[24:27], a[188:191], a[148:151], a[24:27]
M a[28:31], a[188:191], a[156:159], a[28:31]
M a[28:31], a[184:187], a[152:155], a[28:31]
s_waitcnt lgkmcnt(2)
M v[32:35], a[160:163], a[32:35], v[32:35]
buffer_load_dwordx4 v4, s[8:11], s3 offen offset:2048 lds
M v[32:35], a[164:167], a[36:39], v[32:35]
ds_read_b128 a[176:179], v10 offset:4096
ds_read_b128 a[180:183], v11 offset:4096
M v[36:39], a[164:167], a[44:47], v[36:39]
M v[36:39], a[160:163], a[40:43], v[36:39]
ds_read_b64_tr_b16 a[96:97], v12 offset:32768
ds_read_b64_tr_b16 a[98:99], v12 offset:34816
M v[40:43], a[160:163], a[48:51], v[40:43]
M v[40:43], a[164:167], a[52:55], v[40:43]
M v[44:47], a[164:167], a[60:63], v[44:47]
M v[44:47], a[160:163], a[56:59], v[44:47]
ds_read_b64_tr_b16 a[104:105], v13 offset:32768
ds_read_b64_tr_b16 a[106:107], v13 offset:34816
M v[48:51], a[160:163], a[64:67], v[48:51]
M v[48:51], a[164:167], a[68:71], v[48:51]
M v[52:55], a[164:167], a[76:79], v[52:55]
M v[52:55], a[160:163], a[72:75], v[52:55]
ds_read_b64_tr_b16 a[112:113], v14 offset:32768
ds_read_b64_tr_b16 a[114:115], v14 offset:34816
M v[56:59], a[160:163], a[80:83], v[56:59]
M v[56:59], a[164:167], a[84:87], v[56:59]
buffer_load_dwordx4 v5, s[8:11], s3 offen offset:3072 lds
M v[60:63], a[164:167], a[92:95], v[60:63]
M v[60:63], a[160:163], a[88:91], v[60:63]
s_waitcnt lgkmcnt(8)
ds_read_b64_tr_b16 a[120:121], v15 offset:32768
ds_read_b64_tr_b16 a[122:123], v15 offset:34816
M v[64:67], a[168:171], a[32:35], v[64:67]
M v[64:67], a[172:175], a[36:39], v[64:67]
ds_read_b128 a[184:187], v10 offset:6144
ds_read_b128 a[188:191], v11 offset:6144
M v[68:71], a[172:175], a[44:47], v[68:71]
M v[68:71], a[168:171], a[40:43], v[68:71]
ds_read_b64_tr_b16 a[128:129], v16 offset:32768
ds_read_b64_tr_b16 a[130:131], v16 offset:34816
M v[72:75], a[168:171], a[48:51], v[72:75]
M v[72:75], a[172:175], a[52:55], v[72:75]
M v[76:79], a[172:175], a[60:63], v[76:79]
M v[76:79], a[168:171], a[56:59], v[76:79]
ds_read_b64_tr_b16 a[136:137], v17 offset:32768
ds_read_b64_tr_b16 a[138:139], v17 offset:34816
M v[80:83], a[168:171], a[64:67], v[80:83]
M v[80:83], a[172:175], a[68:71], v[80:83]
M v[84:87], a[172:175], a[76:79], v[84:87]
s_add_u32 s23, s23, 128
s_cmp_eq_u32 s23, s25
s_cselect_b32 s23, s26, s23
M v[84:87], a[168:171], a[72:75], v[84:87]
ds_read_b64_tr_b16 a[144:145], v18 offset:32768
ds_read_b64_tr_b16 a[146:147], v18 offset:34816
M v[88:91], a[168:171], a[80:83], v[88:91]
M v[88:91], a[172:175], a[84:87], v[88:91]
M v[92:95], a[172:175], a[92:95], v[92:95]
M v[92:95], a[168:171], a[88:91], v[92:95]
s_waitcnt lgkmcnt(15)
ds_read_b64_tr_b16 a[152:153], v19 offset:32768
ds_read_b64_tr_b16 a[154:155], v19 offset:34816
M v[96:99], a[176:179], a[32:35], v[96:99]
M v[96:99], a[180:183], a[36:39], v[96:99]
M v[100:103], a[180:183], a[44:47], v[100:103]
M v[100:103], a[176:179], a[40:43], v[100:103]
M v[104:107], a[176:179], a[48:51], v[104:107]
M v[104:107], a[180:183], a[52:55], v[104:107]
M v[108:111], a[180:183], a[60:63], v[108:111]
M v[108:111], a[176:179], a[56:59], v[108:111]
s_waitcnt vmcnt(8) lgkmcnt(0)
s_barrier
ds_read_b128 a[160:163], v10 offset:16384
ds_read_b128 a[164:167], v11 offset:16384
M v[112:115], a[176:179], a[64:67], v[112:115]
M v[112:115], a[180:183], a[68:71], v[112:115]
s_and_b32 s3, s2, 1
s_lshl_b32 s3, s3, 3
s_bfe_u32 s4, s2, 0x30003
M v[116:119], a[180:183], a[76:79], v[116:119]
s_add_u32 s26, s3, s4
s_bfe_u32 s3, s2, 0x20001
M v[116:119], a[176:179], a[72:75], v[116:119]
ds_read_b64_tr_b16 a[100:101], v12 offset:49152
ds_read_b64_tr_b16 a[102:103], v12 offset:51200
s_lshl_b32 s3, s3, 2
s_lshr_b32 s4, s2, 6
s_add_u32 s27, s3, s4
M v[120:123], a[176:179], a[80:83], v[120:123]
s_lshl_b32 s23, s26, 18
s_sub_u32 s24, s23, 32768
M v[120:123], a[180:183], a[84:87], v[120:123]
s_max_i32 s24, s24, 0
s_lshl_b32 s25, s27, 7
s_xor_b32 s3, s26, s27
M v[124:127], a[180:183], a[92:95], v[124:127]
s_and_b32 s3, s3, 0
s_lshl_b32 s3, s3, 3
M v[124:127], a[176:179], a[88:91], v[124:127]
s_sub_u32 s31, 16, s3
s_mov_b32 s54, s31
s_movk_i32 s57, 128
M v[128:131], a[184:187], a[32:35], v[128:131]
s_mov_b32 s55, 4289069056
s_mov_b32 s56, 393216
M v[128:131], a[188:191], a[36:39], v[128:131]
ds_read_b128 a[168:171], v10 offset:18432
ds_read_b128 a[172:175], v11 offset:18432
ds_read_b64_tr_b16 a[108:109], v13 offset:49152
ds_read_b64_tr_b16 a[110:111], v13 offset:51200
s_lshl_b32 s4, s3, 7
s_add_u32 s23, s23, s4
s_add_u32 s24, s24, s4
M v[132:135], a[188:191], a[44:47], v[132:135]
s_mul_i32 s4, s3, 393216
s_add_u32 s25, s25, s4
M v[132:135], a[184:187], a[40:43], v[132:135]
s_mov_b64 s[8:9], s[44:45]
s_mov_b32 s10, 4194304
s_mov_b64 s[12:13], s[46:47]
M v[136:139], a[184:187], a[48:51], v[136:139]
s_mov_b32 s14, 6291456
s_mov_b64 s[60:61], s[90:91]
M v[136:139], a[188:191], a[52:55], v[136:139]
s_mov_b32 s62, 256
s_mov_b32 s63, 0x00020000
s_lshl_b32 s28, s20, 9
M v[140:143], a[188:191], a[60:63], v[140:143]
s_mul_i32 s30, s20, 6144
s_lshl_b32 s3, s20, 5
M v[140:143], a[184:187], a[56:59], v[140:143]
ds_read_b64_tr_b16 a[116:117], v14 offset:49152
ds_read_b64_tr_b16 a[118:119], v14 offset:51200
v_lshrrev_b32 v24, 3, v0
v_and_b32 v25, 7, v0
v_add_u32 v28, s3, v24
M v[144:147], a[184:187], a[64:67], v[144:147]
v_add_u32 v26, 0, v28
v_bfe_u32 v27, v26, 1, 3
M v[144:147], a[188:191], a[68:71], v[144:147]
v_xor_b32 v27, v27, v25
v_lshlrev_b32 v26, 11, v26
v_lshl_add_u32 v26, v27, 4, v26
M v[148:151], a[188:191], a[76:79], v[148:151]
v_subrev_u32 v2, 0, v26
v_add_u32 v26, 8, v28
M v[148:151], a[184:187], a[72:75], v[148:151]
v_bfe_u32 v27, v26, 1, 3
v_xor_b32 v27, v27, v25
v_lshlrev_b32 v26, 11, v26
M v[152:155], a[184:187], a[80:83], v[152:155]
v_lshl_add_u32 v26, v27, 4, v26
v_subrev_u32 v3, 1024, v26
M v[152:155], a[188:191], a[84:87], v[152:155]
ds_read_b64_tr_b16 a[124:125], v15 offset:49152
ds_read_b64_tr_b16 a[126:127], v15 offset:51200
v_add_u32 v26, 16, v28
v_bfe_u32 v27, v26, 1, 3
v_xor_b32 v27, v27, v25
M v[156:159], a[188:191], a[92:95], v[156:159]
v_lshlrev_b32 v26, 11, v26
v_lshl_add_u32 v26, v27, 4, v26
M v[156:159], a[184:187], a[88:91], v[156:159]
s_waitcnt lgkmcnt(10)
v_subrev_u32 v4, 2048, v26
v_add_u32 v26, 24, v28
v_bfe_u32 v27, v26, 1, 3
M v[160:163], a[160:163], a[32:35], v[160:163]
v_xor_b32 v27, v27, v25
v_lshlrev_b32 v26, 11, v26
M v[160:163], a[164:167], a[36:39], v[160:163]
ds_read_b128 a[176:179], v10 offset:20480
ds_read_b128 a[180:183], v11 offset:20480
v_lshl_add_u32 v26, v27, 4, v26
v_subrev_u32 v5, 3072, v26
s_lshl_b32 s3, s20, 2
M v[164:167], a[164:167], a[44:47], v[164:167]
v_add_u32 v26, s3, v24
v_bfe_u32 v27, v26, 1, 3
M v[164:167], a[160:163], a[40:43], v[164:167]
ds_read_b64_tr_b16 a[132:133], v16 offset:49152
ds_read_b64_tr_b16 a[134:135], v16 offset:51200
v_xor_b32 v27, v27, v25
v_lshlrev_b32 v26, 11, v26
v_lshl_add_u32 v20, v27, 4, v26
M v[168:171], a[160:163], a[48:51], v[168:171]
s_mul_i32 s3, s20, 48
v_add_u32 v28, s3, v24
M v[168:171], a[164:167], a[52:55], v[168:171]
v_add_u32 v26, 0, v28
v_mul_u32_u24 v27, 0xaaab, v26
M v[172:175], a[164:167], a[60:63], v[172:175]
v_lshrrev_b32 v27, 17, v27
v_lshrrev_b32 v29, 1, v27
v_and_b32 v29, 4, v29
M v[172:175], a[160:163], a[56:59], v[172:175]
v_and_or_b32 v27, v27, 2, v29
v_xor_b32 v27, v27, v25
M v[176:179], a[160:163], a[64:67], v[176:179]
v_lshlrev_b32 v26, 11, v26
v_lshl_add_u32 v26, v27, 4, v26
v_subrev_u32 v6, 0, v26
M v[176:179], a[164:167], a[68:71], v[176:179]
ds_read_b64_tr_b16 a[140:141], v17 offset:49152
ds_read_b64_tr_b16 a[142:143], v17 offset:51200
v_add_u32 v26, 8, v28
v_mul_u32_u24 v27, 0xaaab, v26
M v[180:183], a[164:167], a[76:79], v[180:183]
v_lshrrev_b32 v27, 17, v27
v_lshrrev_b32 v29, 1, v27
v_and_b32 v29, 4, v29
M v[180:183], a[160:163], a[72:75], v[180:183]
v_and_or_b32 v27, v27, 2, v29
v_xor_b32 v27, v27, v25
M v[184:187], a[160:163], a[80:83], v[184:187]
v_lshlrev_b32 v26, 11, v26
v_lshl_add_u32 v26, v27, 4, v26
v_subrev_u32 v7, 1024, v26
M v[184:187], a[164:167], a[84:87], v[184:187]
v_add_u32 v26, 16, v28
v_mul_u32_u24 v27, 0xaaab, v26
M v[188:191], a[164:167], a[92:95], v[188:191]
v_lshrrev_b32 v27, 17, v27
v_lshrrev_b32 v29, 1, v27
v_and_b32 v29, 4, v29
M v[188:191], a[160:163], a[88:91], v[188:191]
s_waitcnt lgkmcnt(12)
ds_read_b64_tr_b16 a[148:149], v18 offset:49152
ds_read_b64_tr_b16 a[150:151], v18 offset:51200
v_and_or_b32 v27, v27, 2, v29
v_xor_b32 v27, v27, v25
M v[192:195], a[168:171], a[32:35], v[192:195]
v_lshlrev_b32 v26, 11, v26
v_lshl_add_u32 v26, v27, 4, v26
v_subrev_u32 v8, 2048, v26
M v[192:195], a[172:175], a[36:39], v[192:195]
ds_read_b128 a[184:187], v10 offset:22528
ds_read_b128 a[188:191], v11 offset:22528
v_add_u32 v26, 24, v28
v_mul_u32_u24 v27, 0xaaab, v26
M v[196:199], a[172:175], a[44:47], v[196:199]
v_lshrrev_b32 v27, 17, v27
v_lshrrev_b32 v29, 1, v27
v_and_b32 v29, 4, v29
M v[196:199], a[168:171], a[40:43], v[196:199]
v_and_or_b32 v27, v27, 2, v29
v_xor_b32 v27, v27, v25
M v[200:203], a[168:171], a[48:51], v[200:203]
v_lshlrev_b32 v26, 11, v26
v_lshl_add_u32 v26, v27, 4, v26
v_subrev_u32 v9, 3072, v26
M v[200:203], a[172:175], a[52:55], v[200:203]
ds_read_b64_tr_b16 a[156:157], v19 offset:49152
ds_read_b64_tr_b16 a[158:159], v19 offset:51200
v_add_u32 v26, 32, v28
v_mul_u32_u24 v27, 0xaaab, v26
M v[204:207], a[172:175], a[60:63], v[204:207]
v_lshrrev_b32 v27, 17, v27
v_lshrrev_b32 v29, 1, v27
v_and_b32 v29, 4, v29
M v[204:207], a[168:171], a[56:59], v[204:207]
v_and_or_b32 v27, v27, 2, v29
v_xor_b32 v27, v27, v25
M v[208:211], a[168:171], a[64:67], v[208:211]
v_lshlrev_b32 v26, 11, v26
v_lshl_add_u32 v26, v27, 4, v26
v_subrev_u32 v21, 0, v26
M v[208:211], a[172:175], a[68:71], v[208:211]
v_add_u32 v26, 40, v28
v_mul_u32_u24 v27, 0xaaab, v26
M v[212:215], a[172:175], a[76:79], v[212:215]
v_lshrrev_b32 v27, 17, v27
v_lshrrev_b32 v29, 1, v27
v_and_b32 v29, 4, v29
M v[212:215], a[168:171], a[72:75], v[212:215]
v_and_or_b32 v27, v27, 2, v29
v_xor_b32 v27, v27, v25
M v[216:219], a[168:171], a[80:83], v[216:219]
v_lshlrev_b32 v26, 11, v26
v_lshl_add_u32 v26, v27, 4, v26
v_subrev_u32 v22, 1024, v26
M v[216:219], a[172:175], a[84:87], v[216:219]
s_lshr_b32 s3, s53, 7
s_add_u32 s3, s3, s22
M v[220:223], a[172:175], a[92:95], v[220:223]
s_lshl_b32 s3, s3, 5
s_lshr_b32 s19, s52, 6
s_add_u32 s3, s3, s19
M v[220:223], a[168:171], a[88:91], v[220:223]
s_waitcnt lgkmcnt(10)
s_lshl_b32 s19, s21, 1
s_add_u32 s3, s3, s19
M v[224:227], a[176:179], a[32:35], v[224:227]
s_lshl_b32 s92, s3, 15
s_add_u32 s92, s92, 16384
s_add_u32 s93, s92, 32768
M v[224:227], a[180:183], a[36:39], v[224:227]
s_add_u32 s16, s50, 16777216
s_addc_u32 s17, s51, 0
M v[228:231], a[180:183], a[44:47], v[228:231]
s_mov_b32 s18, 33554432
s_mov_b32 s19, 0x00020000
M v[228:231], a[176:179], a[40:43], v[228:231]
M v[232:235], a[176:179], a[48:51], v[232:235]
M v[232:235], a[180:183], a[52:55], v[232:235]
M v[236:239], a[180:183], a[60:63], v[236:239]
M v[236:239], a[176:179], a[56:59], v[236:239]
s_waitcnt vmcnt(4) lgkmcnt(0)
s_barrier
ds_read_b128 a[160:163], v10 offset:32768
ds_read_b128 a[164:167], v11 offset:32768
M v[240:243], a[176:179], a[64:67], v[240:243]
s_add_u32 m0, s28, 131072
s_mov_b32 exec_hi, 0
buffer_load_dwordx4 v20, s[8:11], s24 offen lds
s_mov_b32 exec_hi, -1
M v[240:243], a[180:183], a[68:71], v[240:243]
M v[244:247], a[180:183], a[76:79], v[244:247]
M v[244:247], a[176:179], a[72:75], v[244:247]
s_add_u32 m0, s29, 133120
s_nop 0
buffer_load_dwordx4 v2, s[8:11], s23 offen offset:0 lds
M v[248:251], a[176:179], a[80:83], v[248:251]
M v[248:251], a[180:183], a[84:87], v[248:251]
M v[252:255], a[180:183], a[92:95], v[252:255]
M v[252:255], a[176:179], a[88:91], v[252:255]
M a[0:3], a[184:187], a[32:35], a[0:3]
buffer_load_dwordx4 v3, s[8:11], s23 offen offset:1024 lds
M a[0:3], a[188:191], a[36:39], a[0:3]
ds_read_b128 a[168:171], v10 offset:34816
ds_read_b128 a[172:175], v11 offset:34816
M a[4:7], a[188:191], a[44:47], a[4:7]
M a[4:7], a[184:187], a[40:43], a[4:7]
M a[8:11], a[184:187], a[48:51], a[8:11]
buffer_load_dwordx4 v4, s[8:11], s23 offen offset:2048 lds
M a[8:11], a[188:191], a[52:55], a[8:11]
M a[12:15], a[188:191], a[60:63], a[12:15]
M a[12:15], a[184:187], a[56:59], a[12:15]
M a[16:19], a[184:187], a[64:67], a[16:19]
buffer_load_dwordx4 v5, s[8:11], s23 offen offset:3072 lds
M a[16:19], a[188:191], a[68:71], a[16:19]
M a[20:23], a[188:191], a[76:79], a[20:23]
M a[20:23], a[184:187], a[72:75], a[20:23]
s_sub_u32 s31, s31, 1
s_cmp_eq_u32 s31, 0
s_cselect_b32 s58, -1920, s57
s_add_u32 s23, s23, s58
s_add_u32 s24, s24, s58
M a[24:27], a[184:187], a[80:83], a[24:27]
M a[24:27], a[188:191], a[84:87], a[24:27]
M a[28:31], a[188:191], a[92:95], a[28:31]
M a[28:31], a[184:187], a[88:91], a[28:31]
s_waitcnt lgkmcnt(2)
M v[32:35], a[160:163], a[96:99], v[32:35]
s_add_u32 m0, s30, 65536
s_nop 0
buffer_load_dwordx4 v6, s[12:15], s25 offen offset:0 lds
M v[32:35], a[164:167], a[100:103], v[32:35]
ds_read_b128 a[176:179], v10 offset:36864
ds_read_b128 a[180:183], v11 offset:36864
M v[36:39], a[164:167], a[108:111], v[36:39]
M v[36:39], a[160:163], a[104:107], v[36:39]
M v[40:43], a[160:163], a[112:115], v[40:43]
M v[40:43], a[164:167], a[116:119], v[40:43]
buffer_load_dwordx4 v7, s[12:15], s25 offen offset:1024 lds
M v[44:47], a[164:167], a[124:127], v[44:47]
M v[44:47], a[160:163], a[120:123], v[44:47]
M v[48:51], a[160:163], a[128:131], v[48:51]
M v[48:51], a[164:167], a[132:135], v[48:51]
M v[52:55], a[164:167], a[140:143], v[52:55]
buffer_load_dwordx4 v8, s[12:15], s25 offen offset:2048 lds
M v[52:55], a[160:163], a[136:139], v[52:55]
M v[56:59], a[160:163], a[144:147], v[56:59]
M v[56:59], a[164:167], a[148:151], v[56:59]
M v[60:63], a[164:167], a[156:159], v[60:63]
M v[60:63], a[160:163], a[152:155], v[60:63]
s_waitcnt lgkmcnt(2)
M v[64:67], a[168:171], a[96:99], v[64:67]
buffer_load_dwordx4 v9, s[12:15], s25 offen offset:3072 lds
M v[64:67], a[172:175], a[100:103], v[64:67]
ds_read_b128 a[184:187], v10 offset:38912
ds_read_b128 a[188:191], v11 offset:38912
M v[68:71], a[172:175], a[108:111], v[68:71]
M v[68:71], a[168:171], a[104:107], v[68:71]
M v[72:75], a[168:171], a[112:115], v[72:75]
M v[72:75], a[172:175], a[116:119], v[72:75]
s_add_u32 m0, s30, 69632
s_nop 0
buffer_load_dwordx4 v21, s[12:15], s25 offen offset:0 lds
M v[76:79], a[172:175], a[124:127], v[76:79]
M v[76:79], a[168:171], a[120:123], v[76:79]
M v[80:83], a[168:171], a[128:131], v[80:83]
M v[80:83], a[172:175], a[132:135], v[80:83]
M v[84:87], a[172:175], a[140:143], v[84:87]
buffer_load_dwordx4 v22, s[12:15], s25 offen offset:1024 lds
M v[84:87], a[168:171], a[136:139], v[84:87]
M v[88:91], a[168:171], a[144:147], v[88:91]
M v[88:91], a[172:175], a[148:151], v[88:91]
M v[92:95], a[172:175], a[156:159], v[92:95]
M v[92:95], a[168:171], a[152:155], v[92:95]
s_waitcnt lgkmcnt(2)
M v[96:99], a[176:179], a[96:99], v[96:99]
s_sub_u32 s54, s54, 1
s_cmp_eq_u32 s54, 0
s_cselect_b32 s58, s55, s56
s_add_u32 s25, s25, s58
M v[96:99], a[180:183], a[100:103], v[96:99]
M v[100:103], a[180:183], a[108:111], v[100:103]
M v[100:103], a[176:179], a[104:107], v[100:103]
v_cvt_pk_bf16_f32 v32, v32, v33
v_cvt_pk_bf16_f32 v33, v34, v35
M v[104:107], a[176:179], a[112:115], v[104:107]
v_cvt_pk_bf16_f32 v34, v64, v65
v_cvt_pk_bf16_f32 v35, v66, v67
M v[104:107], a[180:183], a[116:119], v[104:107]
v_cvt_pk_bf16_f32 v64, v48, v49
M v[108:111], a[180:183], a[124:127], v[108:111]
v_cvt_pk_bf16_f32 v65, v50, v51
v_cvt_pk_bf16_f32 v66, v80, v81
M v[108:111], a[176:179], a[120:123], v[108:111]
s_waitcnt vmcnt(11) lgkmcnt(0)
s_barrier
ds_read_b128 a[160:163], v10 offset:49152
ds_read_b128 a[164:167], v11 offset:49152
v_cvt_pk_bf16_f32 v67, v82, v83
M v[112:115], a[176:179], a[128:131], v[112:115]
s_add_u32 m0, s28, 0
s_mov_b32 exec_hi, 0
buffer_load_dwordx4 v20, s[8:11], s24 offen lds
s_mov_b32 exec_hi, -1
v_cvt_pk_bf16_f32 v48, v40, v41
v_cvt_pk_bf16_f32 v49, v42, v43
M v[112:115], a[180:183], a[132:135], v[112:115]
v_cvt_pk_bf16_f32 v50, v72, v73
v_cvt_pk_bf16_f32 v51, v74, v75
M v[116:119], a[180:183], a[140:143], v[116:119]
v_cvt_pk_bf16_f32 v80, v56, v57
M v[116:119], a[176:179], a[136:139], v[116:119]
v_cvt_pk_bf16_f32 v81, v58, v59
v_cvt_pk_bf16_f32 v82, v88, v89
M v[120:123], a[176:179], a[144:147], v[120:123]
s_add_u32 m0, s29, 2048
s_nop 0
buffer_load_dwordx4 v2, s[8:11], s23 offen offset:0 lds
v_cvt_pk_bf16_f32 v83, v90, v91
M v[120:123], a[180:183], a[148:151], v[120:123]
v_cvt_pk_bf16_f32 v40, v36, v37
v_cvt_pk_bf16_f32 v41, v38, v39
M v[124:127], a[180:183], a[156:159], v[124:127]
v_cvt_pk_bf16_f32 v42, v68, v69
v_cvt_pk_bf16_f32 v43, v70, v71
M v[124:127], a[176:179], a[152:155], v[124:127]
v_cvt_pk_bf16_f32 v72, v52, v53
M v[128:131], a[184:187], a[96:99], v[128:131]
v_cvt_pk_bf16_f32 v73, v54, v55
v_cvt_pk_bf16_f32 v74, v84, v85
M v[128:131], a[188:191], a[100:103], v[128:131]
ds_read_b128 a[168:171], v10 offset:51200
ds_read_b128 a[172:175], v11 offset:51200
v_cvt_pk_bf16_f32 v75, v86, v87
M v[132:135], a[188:191], a[108:111], v[132:135]
buffer_load_dwordx4 v3, s[8:11], s23 offen offset:1024 lds
v_cvt_pk_bf16_f32 v56, v44, v45
v_cvt_pk_bf16_f32 v57, v46, v47
M v[132:135], a[184:187], a[104:107], v[132:135]
v_cvt_pk_bf16_f32 v58, v76, v77
v_cvt_pk_bf16_f32 v59, v78, v79
M v[136:139], a[184:187], a[112:115], v[136:139]
v_cvt_pk_bf16_f32 v88, v60, v61
M v[136:139], a[188:191], a[116:119], v[136:139]
v_cvt_pk_bf16_f32 v89, v62, v63
v_cvt_pk_bf16_f32 v90, v92, v93
M v[140:143], a[188:191], a[124:127], v[140:143]
buffer_load_dwordx4 v4, s[8:11], s23 offen offset:2048 lds
v_cvt_pk_bf16_f32 v91, v94, v95
M v[140:143], a[184:187], a[120:123], v[140:143]
M v[144:147], a[184:187], a[128:131], v[144:147]
M v[144:147], a[188:191], a[132:135], v[144:147]
M v[148:151], a[188:191], a[140:143], v[148:151]
buffer_load_dwordx4 v5, s[8:11], s23 offen offset:3072 lds
M v[148:151], a[184:187], a[136:139], v[148:151]
M v[152:155], a[184:187], a[144:147], v[152:155]
M v[152:155], a[188:191], a[148:151], v[152:155]
M v[156:159], a[188:191], a[156:159], v[156:159]
s_sub_u32 s31, s31, 1
s_cmp_eq_u32 s31, 0
s_cselect_b32 s58, -1920, s57
s_add_u32 s23, s23, s58
s_add_u32 s24, s24, s58
M v[156:159], a[184:187], a[152:155], v[156:159]
s_waitcnt lgkmcnt(2)
M v[160:163], a[160:163], a[96:99], v[160:163]
M v[160:163], a[164:167], a[100:103], v[160:163]
ds_read_b128 a[176:179], v10 offset:53248
ds_read_b128 a[180:183], v11 offset:53248
M v[164:167], a[164:167], a[108:111], v[164:167]
M v[164:167], a[160:163], a[104:107], v[164:167]
v_cvt_pk_bf16_f32 v96, v96, v97
v_cvt_pk_bf16_f32 v97, v98, v99
M v[168:171], a[160:163], a[112:115], v[168:171]
s_add_u32 m0, s30, 98304
s_nop 0
buffer_load_dwordx4 v6, s[12:15], s25 offen offset:0 lds
v_cvt_pk_bf16_f32 v98, v128, v129
v_cvt_pk_bf16_f32 v99, v130, v131
M v[168:171], a[164:167], a[116:119], v[168:171]
v_cvt_pk_bf16_f32 v128, v112, v113
M v[172:175], a[164:167], a[124:127], v[172:175]
v_cvt_pk_bf16_f32 v129, v114, v115
v_cvt_pk_bf16_f32 v130, v144, v145
M v[172:175], a[160:163], a[120:123], v[172:175]
v_cvt_pk_bf16_f32 v131, v146, v147
M v[176:179], a[160:163], a[128:131], v[176:179]
v_cvt_pk_bf16_f32 v112, v104, v105
v_cvt_pk_bf16_f32 v113, v106, v107
M v[176:179], a[164:167], a[132:135], v[176:179]
buffer_load_dwordx4 v7, s[12:15], s25 offen offset:1024 lds
v_cvt_pk_bf16_f32 v114, v136, v137
v_cvt_pk_bf16_f32 v115, v138, v139
M v[180:183], a[164:167], a[140:143], v[180:183]
v_cvt_pk_bf16_f32 v144, v120, v121
M v[180:183], a[160:163], a[136:139], v[180:183]
v_cvt_pk_bf16_f32 v145, v122, v123
v_cvt_pk_bf16_f32 v146, v152, v153
M v[184:187], a[160:163], a[144:147], v[184:187]
v_cvt_pk_bf16_f32 v147, v154, v155
M v[184:187], a[164:167], a[148:151], v[184:187]
buffer_load_dwordx4 v8, s[12:15], s25 offen offset:2048 lds
v_cvt_pk_bf16_f32 v104, v100, v101
v_cvt_pk_bf16_f32 v105, v102, v103
M v[188:191], a[164:167], a[156:159], v[188:191]
v_cvt_pk_bf16_f32 v106, v132, v133
v_cvt_pk_bf16_f32 v107, v134, v135
M v[188:191], a[160:163], a[152:155], v[188:191]
s_waitcnt lgkmcnt(2)
v_cvt_pk_bf16_f32 v136, v116, v117
M v[192:195], a[168:171], a[96:99], v[192:195]
v_cvt_pk_bf16_f32 v137, v118, v119
v_cvt_pk_bf16_f32 v138, v148, v149
M v[192:195], a[172:175], a[100:103], v[192:195]
ds_read_b128 a[184:187], v10 offset:55296
ds_read_b128 a[188:191], v11 offset:55296
v_cvt_pk_bf16_f32 v139, v150, v151
M v[196:199], a[172:175], a[108:111], v[196:199]
v_cvt_pk_bf16_f32 v120, v108, v109
v_cvt_pk_bf16_f32 v121, v110, v111
M v[196:199], a[168:171], a[104:107], v[196:199]
buffer_load_dwordx4 v9, s[12:15], s25 offen offset:3072 lds
v_cvt_pk_bf16_f32 v122, v140, v141
v_cvt_pk_bf16_f32 v123, v142, v143
M v[200:203], a[168:171], a[112:115], v[200:203]
v_cvt_pk_bf16_f32 v152, v124, v125
M v[200:203], a[172:175], a[116:119], v[200:203]
v_cvt_pk_bf16_f32 v153, v126, v127
v_cvt_pk_bf16_f32 v154, v156, v157
M v[204:207], a[172:175], a[124:127], v[204:207]
v_cvt_pk_bf16_f32 v155, v158, v159
M v[204:207], a[168:171], a[120:123], v[204:207]
s_add_u32 m0, s30, 102400
s_nop 0
buffer_load_dwordx4 v21, s[12:15], s25 offen offset:0 lds
M v[208:211], a[168:171], a[128:131], v[208:211]
M v[208:211], a[172:175], a[132:135], v[208:211]
M v[212:215], a[172:175], a[140:143], v[212:215]
M v[212:215], a[168:171], a[136:139], v[212:215]
buffer_load_dwordx4 v22, s[12:15], s25 offen offset:1024 lds
M v[216:219], a[168:171], a[144:147], v[216:219]
M v[216:219], a[172:175], a[148:151], v[216:219]
M v[220:223], a[172:175], a[156:159], v[220:223]
M v[220:223], a[168:171], a[152:155], v[220:223]
s_waitcnt lgkmcnt(2)
M v[224:227], a[176:179], a[96:99], v[224:227]
s_sub_u32 s54, s54, 1
s_cmp_eq_u32 s54, 0
s_cselect_b32 s58, s55, s56
s_add_u32 s25, s25, s58
M v[224:227], a[180:183], a[100:103], v[224:227]
M v[228:231], a[180:183], a[108:111], v[228:231]
M v[228:231], a[176:179], a[104:107], v[228:231]
v_cvt_pk_bf16_f32 v160, v160, v161
v_cvt_pk_bf16_f32 v161, v162, v163
M v[232:235], a[176:179], a[112:115], v[232:235]
v_cvt_pk_bf16_f32 v162, v192, v193
v_cvt_pk_bf16_f32 v163, v194, v195
M v[232:235], a[180:183], a[116:119], v[232:235]
v_cvt_pk_bf16_f32 v192, v176, v177
M v[236:239], a[180:183], a[124:127], v[236:239]
v_cvt_pk_bf16_f32 v193, v178, v179
v_cvt_pk_bf16_f32 v194, v208, v209
M v[236:239], a[176:179], a[120:123], v[236:239]
s_waitcnt vmcnt(63) lgkmcnt(0)
s_barrier
v_cvt_pk_bf16_f32 v195, v210, v211
M v[240:243], a[176:179], a[128:131], v[240:243]
s_add_u32 m0, s28, 18432
s_mov_b32 exec_hi, 0
buffer_load_dwordx4 v20, s[8:11], s24 offen lds
s_mov_b32 exec_hi, -1
v_cvt_pk_bf16_f32 v176, v168, v169
v_cvt_pk_bf16_f32 v177, v170, v171
M v[240:243], a[180:183], a[132:135], v[240:243]
v_cvt_pk_bf16_f32 v178, v200, v201
v_cvt_pk_bf16_f32 v179, v202, v203
M v[244:247], a[180:183], a[140:143], v[244:247]
v_cvt_pk_bf16_f32 v208, v184, v185
M v[244:247], a[176:179], a[136:139], v[244:247]
s_add_u32 m0, s29, 20480
s_nop 0
buffer_load_dwordx4 v2, s[8:11], s23 offen offset:0 lds
v_cvt_pk_bf16_f32 v209, v186, v187
v_cvt_pk_bf16_f32 v210, v216, v217
M v[248:251], a[176:179], a[144:147], v[248:251]
v_cvt_pk_bf16_f32 v211, v218, v219
M v[248:251], a[180:183], a[148:151], v[248:251]
v_cvt_pk_bf16_f32 v168, v164, v165
v_cvt_pk_bf16_f32 v169, v166, v167
M v[252:255], a[180:183], a[156:159], v[252:255]
v_cvt_pk_bf16_f32 v170, v196, v197
v_cvt_pk_bf16_f32 v171, v198, v199
M v[252:255], a[176:179], a[152:155], v[252:255]
v_cvt_pk_bf16_f32 v200, v180, v181
M a[0:3], a[184:187], a[96:99], a[0:3]
buffer_load_dwordx4 v3, s[8:11], s23 offen offset:1024 lds
v_cvt_pk_bf16_f32 v201, v182, v183
v_cvt_pk_bf16_f32 v202, v212, v213
M a[0:3], a[188:191], a[100:103], a[0:3]
v_cvt_pk_bf16_f32 v203, v214, v215
M a[4:7], a[188:191], a[108:111], a[4:7]
v_cvt_pk_bf16_f32 v184, v172, v173
v_cvt_pk_bf16_f32 v185, v174, v175
M a[4:7], a[184:187], a[104:107], a[4:7]
v_cvt_pk_bf16_f32 v186, v204, v205
v_cvt_pk_bf16_f32 v187, v206, v207
M a[8:11], a[184:187], a[112:115], a[8:11]
buffer_load_dwordx4 v4, s[8:11], s23 offen offset:2048 lds
v_cvt_pk_bf16_f32 v216, v188, v189
M a[8:11], a[188:191], a[116:119], a[8:11]
v_cvt_pk_bf16_f32 v217, v190, v191
v_cvt_pk_bf16_f32 v218, v220, v221
M a[12:15], a[188:191], a[124:127], a[12:15]
v_cvt_pk_bf16_f32 v219, v222, v223
M a[12:15], a[184:187], a[120:123], a[12:15]
buffer_load_dwordx4 v5, s[8:11], s23 offen offset:3072 lds
M a[16:19], a[184:187], a[128:131], a[16:19]
M a[16:19], a[188:191], a[132:135], a[16:19]
M a[20:23], a[188:191], a[140:143], a[20:23]
M a[20:23], a[184:187], a[136:139], a[20:23]
s_sub_u32 s31, s31, 1
s_cmp_eq_u32 s31, 0
s_cselect_b32 s58, -1920, s57
s_add_u32 s23, s23, s58
s_add_u32 s24, s24, s58
M a[24:27], a[184:187], a[144:147], a[24:27]
M a[24:27], a[188:191], a[148:151], a[24:27]
M a[28:31], a[188:191], a[156:159], a[28:31]
M a[28:31], a[184:187], a[152:155], a[28:31]
v_accvgpr_read_b32 v24, a0
v_accvgpr_read_b32 v25, a1
v_accvgpr_read_b32 v26, a2
v_accvgpr_read_b32 v27, a3
v_cvt_pk_bf16_f32 v224, v224, v225
v_cvt_pk_bf16_f32 v225, v226, v227
v_cvt_pk_bf16_f32 v226, v24, v25
v_cvt_pk_bf16_f32 v227, v26, v27
v_accvgpr_read_b32 v24, a16
v_accvgpr_read_b32 v25, a17
v_accvgpr_read_b32 v26, a18
v_accvgpr_read_b32 v27, a19
v_cvt_pk_bf16_f32 v36, v240, v241
v_cvt_pk_bf16_f32 v37, v242, v243
v_cvt_pk_bf16_f32 v38, v24, v25
v_cvt_pk_bf16_f32 v39, v26, v27
v_accvgpr_read_b32 v24, a24
v_accvgpr_read_b32 v25, a25
v_accvgpr_read_b32 v26, a26
v_accvgpr_read_b32 v27, a27
v_cvt_pk_bf16_f32 v52, v248, v249
v_cvt_pk_bf16_f32 v53, v250, v251
v_cvt_pk_bf16_f32 v54, v24, v25
v_cvt_pk_bf16_f32 v55, v26, v27
v_accvgpr_read_b32 v24, a8
v_accvgpr_read_b32 v25, a9
v_accvgpr_read_b32 v26, a10
v_accvgpr_read_b32 v27, a11
v_cvt_pk_bf16_f32 v240, v232, v233
v_cvt_pk_bf16_f32 v241, v234, v235
v_cvt_pk_bf16_f32 v242, v24, v25
v_cvt_pk_bf16_f32 v243, v26, v27
v_accvgpr_read_b32 v28, a4
v_accvgpr_read_b32 v29, a5
v_accvgpr_read_b32 v30, a6
v_accvgpr_read_b32 v31, a7
v_cvt_pk_bf16_f32 v232, v228, v229
v_cvt_pk_bf16_f32 v233, v230, v231
v_cvt_pk_bf16_f32 v234, v28, v29
v_cvt_pk_bf16_f32 v235, v30, v31
v_accvgpr_read_b32 v28, a12
v_accvgpr_read_b32 v29, a13
v_accvgpr_read_b32 v30, a14
v_accvgpr_read_b32 v31, a15
v_cvt_pk_bf16_f32 v248, v236, v237
v_cvt_pk_bf16_f32 v249, v238, v239
v_cvt_pk_bf16_f32 v250, v28, v29
v_cvt_pk_bf16_f32 v251, v30, v31
v_accvgpr_read_b32 v28, a20
v_accvgpr_read_b32 v29, a21
v_accvgpr_read_b32 v30, a22
v_accvgpr_read_b32 v31, a23
v_cvt_pk_bf16_f32 v44, v244, v245
v_cvt_pk_bf16_f32 v45, v246, v247
v_cvt_pk_bf16_f32 v46, v28, v29
v_cvt_pk_bf16_f32 v47, v30, v31
v_accvgpr_read_b32 v28, a28
v_accvgpr_read_b32 v29, a29
v_accvgpr_read_b32 v30, a30
v_accvgpr_read_b32 v31, a31
v_cvt_pk_bf16_f32 v60, v252, v253
v_cvt_pk_bf16_f32 v61, v254, v255
v_cvt_pk_bf16_f32 v62, v28, v29
v_cvt_pk_bf16_f32 v63, v30, v31
Lk1_b:
v_and_b32 v24, 15, v0
v_lshlrev_b32 v24, 7, v24
v_bfe_u32 v25, v0, 1, 3
v_lshrrev_b32 v26, 4, v0
v_xor_b32 v25, v25, v26
v_lshl_add_u32 v10, v25, 4, v24
v_xor_b32 v11, 64, v10
v_add_u32 v12, 131072, v10
v_add_u32 v13, 131072, v11
v_bfe_u32 v24, v0, 2, 2
v_lshl_add_u32 v29, v26, 3, v24
v_mul_u32_u24 v25, 384, v29
v_and_b32 v27, 1, v0
v_lshl_add_u32 v25, v27, 3, v25
v_add_u32 v25, 36864, v25
v_lshrrev_b32 v24, 1, v29
v_and_b32 v24, 4, v24
v_and_or_b32 v24, v29, 2, v24
v_bfe_u32 v26, v0, 1, 1
s_mul_i32 s4, s20, 3
s_add_u32 s3, s4, 0
s_and_b32 s5, s3, 3
s_lshl_b32 s5, s5, 1
s_lshr_b32 s3, s3, 2
s_lshl_b32 s3, s3, 7
v_add_u32 v27, s5, v26
v_xor_b32 v27, v27, v24
v_lshl_add_u32 v27, v27, 4, v25
v_add_u32 v14, s3, v27
v_add_u32 v17, 61440, v14
s_add_u32 s3, s4, 1
s_and_b32 s5, s3, 3
s_lshl_b32 s5, s5, 1
s_lshr_b32 s3, s3, 2
s_lshl_b32 s3, s3, 7
v_add_u32 v27, s5, v26
v_xor_b32 v27, v27, v24
v_lshl_add_u32 v27, v27, 4, v25
v_add_u32 v15, s3, v27
v_add_u32 v18, 61440, v15
s_add_u32 s3, s4, 2
s_and_b32 s5, s3, 3
s_lshl_b32 s5, s5, 1
s_lshr_b32 s3, s3, 2
s_lshl_b32 s3, s3, 7
v_add_u32 v27, s5, v26
v_xor_b32 v27, v27, v24
v_lshl_add_u32 v27, v27, 4, v25
v_add_u32 v16, s3, v27
v_add_u32 v19, 61440, v16
s_waitcnt vmcnt(5)
s_barrier
ds_read_b64_tr_b16 a[140:141], v14 offset:28672
ds_read_b64_tr_b16 a[142:143], v14 offset:30208
ds_read_b64_tr_b16 a[148:149], v15 offset:28672
ds_read_b64_tr_b16 a[150:151], v15 offset:30208
ds_read_b64_tr_b16 a[156:157], v16 offset:28672
ds_read_b64_tr_b16 a[158:159], v16 offset:30208
ds_read_b64_tr_b16 a[144:145], v14 offset:40960
ds_read_b64_tr_b16 a[146:147], v14 offset:42496
ds_read_b64_tr_b16 a[152:153], v15 offset:40960
ds_read_b64_tr_b16 a[154:155], v15 offset:42496
ds_read_b64_tr_b16 a[160:161], v16 offset:40960
ds_read_b64_tr_b16 a[162:163], v16 offset:42496
ds_read_b128 a[188:191], v12 offset:0
ds_read_b128 a[192:195], v13 offset:0
ds_read_b128 a[196:199], v12 offset:2048
ds_read_b128 a[200:203], v13 offset:2048
ds_read_b128 a[204:207], v12 offset:4096
ds_read_b128 a[208:211], v13 offset:4096
s_waitcnt lgkmcnt(0)
s_barrier
M a[32:35], a[140:143], a[188:191], 0
ds_read_b128 a[212:215], v12 offset:6144
ds_read_b128 a[216:219], v13 offset:6144
M a[32:35], a[144:147], a[192:195], a[32:35]
s_add_u32 m0, s30, 36864
s_nop 0
buffer_load_dwordx4 v6, s[12:15], s25 offen offset:0 lds
M a[36:39], a[152:155], a[192:195], 0
ds_read_b64_tr_b16 a[164:165], v17 offset:0
ds_read_b64_tr_b16 a[166:167], v17 offset:1536
M a[36:39], a[148:151], a[188:191], a[36:39]
buffer_load_dwordx4 v7, s[12:15], s25 offen offset:1024 lds
M a[40:43], a[156:159], a[188:191], 0
M a[40:43], a[160:163], a[192:195], a[40:43]
buffer_load_dwordx4 v8, s[12:15], s25 offen offset:2048 lds
M a[44:47], a[144:147], a[200:203], 0
ds_read_b128 a[220:223], v12 offset:8192
ds_read_b128 a[224:227], v13 offset:8192
M a[44:47], a[140:143], a[196:199], a[44:47]
M a[48:51], a[148:151], a[196:199], 0
ds_read_b64_tr_b16 a[172:173], v18 offset:0
ds_read_b64_tr_b16 a[174:175], v18 offset:1536
M a[48:51], a[152:155], a[200:203], a[48:51]
buffer_load_dwordx4 v9, s[12:15], s25 offen offset:3072 lds
M a[52:55], a[160:163], a[200:203], 0
M a[52:55], a[156:159], a[196:199], a[52:55]
s_add_u32 m0, s30, 40960
s_nop 0
buffer_load_dwordx4 v21, s[12:15], s25 offen offset:0 lds
M a[56:59], a[140:143], a[204:207], 0
ds_read_b128 a[228:231], v12 offset:10240
ds_read_b128 a[232:235], v13 offset:10240
M a[56:59], a[144:147], a[208:211], a[56:59]
M a[60:63], a[152:155], a[208:211], 0
ds_read_b64_tr_b16 a[180:181], v19 offset:0
ds_read_b64_tr_b16 a[182:183], v19 offset:1536
M a[60:63], a[148:151], a[204:207], a[60:63]
buffer_load_dwordx4 v22, s[12:15], s25 offen offset:1024 lds
M a[64:67], a[156:159], a[204:207], 0
M a[64:67], a[160:163], a[208:211], a[64:67]
s_sub_u32 s54, s54, 1
s_cmp_eq_u32 s54, 0
s_cselect_b32 s58, s55, s56
s_add_u32 s25, s25, s58
s_waitcnt lgkmcnt(10)
M a[68:71], a[144:147], a[216:219], 0
ds_read_b128 a[188:191], v12 offset:12288
ds_read_b128 a[192:195], v13 offset:12288
M a[68:71], a[140:143], a[212:215], a[68:71]
M a[72:75], a[148:151], a[212:215], 0
ds_read_b64_tr_b16 a[168:169], v17 offset:12288
ds_read_b64_tr_b16 a[170:171], v17 offset:13824
M a[72:75], a[152:155], a[216:219], a[72:75]
s_add_u32 m0, s30, 65536
s_nop 0
buffer_load_dwordx4 v6, s[12:15], s25 offen offset:0 lds
M a[76:79], a[160:163], a[216:219], 0
M a[76:79], a[156:159], a[212:215], a[76:79]
buffer_load_dwordx4 v7, s[12:15], s25 offen offset:1024 lds
s_waitcnt lgkmcnt(10)
M a[80:83], a[140:143], a[220:223], 0
ds_read_b128 a[196:199], v12 offset:14336
ds_read_b128 a[200:203], v13 offset:14336
M a[80:83], a[144:147], a[224:227], a[80:83]
M a[84:87], a[152:155], a[224:227], 0
ds_read_b64_tr_b16 a[176:177], v18 offset:12288
ds_read_b64_tr_b16 a[178:179], v18 offset:13824
M a[84:87], a[148:151], a[220:223], a[84:87]
buffer_load_dwordx4 v8, s[12:15], s25 offen offset:2048 lds
M a[88:91], a[156:159], a[220:223], 0
M a[88:91], a[160:163], a[224:227], a[88:91]
buffer_load_dwordx4 v9, s[12:15], s25 offen offset:3072 lds
s_waitcnt lgkmcnt(10)
M a[92:95], a[144:147], a[232:235], 0
ds_read_b128 a[204:207], v12 offset:16384
ds_read_b128 a[208:211], v13 offset:16384
M a[92:95], a[140:143], a[228:231], a[92:95]
M a[96:99], a[148:151], a[228:231], 0
ds_read_b64_tr_b16 a[184:185], v19 offset:12288
ds_read_b64_tr_b16 a[186:187], v19 offset:13824
M a[96:99], a[152:155], a[232:235], a[96:99]
s_add_u32 m0, s30, 69632
s_nop 0
buffer_load_dwordx4 v21, s[12:15], s25 offen offset:0 lds
M a[100:103], a[160:163], a[232:235], 0
M a[100:103], a[156:159], a[228:231], a[100:103]
buffer_load_dwordx4 v22, s[12:15], s25 offen offset:1024 lds
s_waitcnt lgkmcnt(10)
M a[104:107], a[140:143], a[188:191], 0
M a[104:107], a[144:147], a[192:195], a[104:107]
s_sub_u32 s54, s54, 1
s_cmp_eq_u32 s54, 0
s_cselect_b32 s58, s55, s56
s_add_u32 s25, s25, s58
M a[108:111], a[152:155], a[192:195], 0
M a[108:111], a[148:151], a[188:191], a[108:111]
M a[112:115], a[156:159], a[188:191], 0
s_waitcnt vmcnt(6) lgkmcnt(0)
s_barrier
ds_read_b128 a[212:215], v10 offset:0
ds_read_b128 a[216:219], v11 offset:0
M a[112:115], a[160:163], a[192:195], a[112:115]
s_add_u32 s94, s92, 0
buffer_store_dwordx4 v[32:35], v1, s[16:19], s94 offen offset:0 sc1
M a[116:119], a[144:147], a[200:203], 0
ds_read_b128 a[220:223], v10 offset:2048
ds_read_b128 a[224:227], v11 offset:2048
M a[116:119], a[140:143], a[196:199], a[116:119]
M a[120:123], a[148:151], a[196:199], 0
s_add_u32 s94, s92, 0
buffer_store_dwordx4 v[40:43], v1, s[16:19], s94 offen offset:1024 sc1
M a[120:123], a[152:155], a[200:203], a[120:123]
M a[124:127], a[160:163], a[200:203], 0
M a[124:127], a[156:159], a[196:199], a[124:127]
s_add_u32 s94, s92, 0
buffer_store_dwordx4 v[48:51], v1, s[16:19], s94 offen offset:2048 sc1
M a[128:131], a[140:143], a[204:207], 0
ds_read_b128 a[228:231], v10 offset:4096
ds_read_b128 a[232:235], v11 offset:4096
M a[128:131], a[144:147], a[208:211], a[128:131]
M a[132:135], a[152:155], a[208:211], 0
M a[132:135], a[148:151], a[204:207], a[132:135]
s_add_u32 s94, s92, 0
buffer_store_dwordx4 v[56:59], v1, s[16:19], s94 offen offset:3072 sc1
M a[136:139], a[156:159], a[204:207], 0
M a[136:139], a[160:163], a[208:211], a[136:139]
s_waitcnt lgkmcnt(4)
M a[32:35], a[164:167], a[212:215], a[32:35]
ds_read_b128 a[188:191], v10 offset:6144
ds_read_b128 a[192:195], v11 offset:6144
M a[32:35], a[168:171], a[216:219], a[32:35]
s_add_u32 m0, s28, 131072
s_mov_b32 exec_hi, 0
buffer_load_dwordx4 v20, s[8:11], s24 offen lds
s_mov_b32 exec_hi, -1
M a[36:39], a[176:179], a[216:219], a[36:39]
ds_read_b64_tr_b16 a[140:141], v14 offset:0
ds_read_b64_tr_b16 a[142:143], v14 offset:1536
M a[36:39], a[172:175], a[212:215], a[36:39]
M a[40:43], a[180:183], a[212:215], a[40:43]
s_add_u32 m0, s29, 133120
s_nop 0
buffer_load_dwordx4 v2, s[8:11], s23 offen offset:0 lds
M a[40:43], a[184:187], a[216:219], a[40:43]
s_waitcnt lgkmcnt(6)
M a[44:47], a[168:171], a[224:227], a[44:47]
ds_read_b128 a[196:199], v10 offset:8192
ds_read_b128 a[200:203], v11 offset:8192
M a[44:47], a[164:167], a[220:223], a[44:47]
buffer_load_dwordx4 v3, s[8:11], s23 offen offset:1024 lds
M a[48:51], a[172:175], a[220:223], a[48:51]
ds_read_b64_tr_b16 a[148:149], v15 offset:0
ds_read_b64_tr_b16 a[150:151], v15 offset:1536
M a[48:51], a[176:179], a[224:227], a[48:51]
M a[52:55], a[184:187], a[224:227], a[52:55]
buffer_load_dwordx4 v4, s[8:11], s23 offen offset:2048 lds
M a[52:55], a[180:183], a[220:223], a[52:55]
s_waitcnt lgkmcnt(8)
M a[56:59], a[164:167], a[228:231], a[56:59]
ds_read_b128 a[204:207], v10 offset:10240
ds_read_b128 a[208:211], v11 offset:10240
M a[56:59], a[168:171], a[232:235], a[56:59]
buffer_load_dwordx4 v5, s[8:11], s23 offen offset:3072 lds
M a[60:63], a[176:179], a[232:235], a[60:63]
ds_read_b64_tr_b16 a[156:157], v16 offset:0
ds_read_b64_tr_b16 a[158:159], v16 offset:1536
M a[60:63], a[172:175], a[228:231], a[60:63]
M a[64:67], a[180:183], a[228:231], a[64:67]
s_sub_u32 s31, s31, 1
s_cmp_eq_u32 s31, 0
s_cselect_b32 s58, -1920, s57
s_add_u32 s23, s23, s58
s_add_u32 s24, s24, s58
M a[64:67], a[184:187], a[232:235], a[64:67]
s_waitcnt lgkmcnt(10)
M a[68:71], a[168:171], a[192:195], a[68:71]
ds_read_b128 a[212:215], v10 offset:12288
ds_read_b128 a[216:219], v11 offset:12288
M a[68:71], a[164:167], a[188:191], a[68:71]
s_add_u32 m0, s30, 98304
s_nop 0
buffer_load_dwordx4 v6, s[12:15], s25 offen offset:0 lds
M a[72:75], a[172:175], a[188:191], a[72:75]
ds_read_b64_tr_b16 a[144:145], v14 offset:12288
ds_read_b64_tr_b16 a[146:147], v14 offset:13824
M a[72:75], a[176:179], a[192:195], a[72:75]
M a[76:79], a[184:187], a[192:195], a[76:79]
buffer_load_dwordx4 v7, s[12:15], s25 offen offset:1024 lds
M a[76:79], a[180:183], a[188:191], a[76:79]
s_waitcnt lgkmcnt(10)
M a[80:83], a[164:167], a[196:199], a[80:83]
ds_read_b128 a[220:223], v10 offset:14336
ds_read_b128 a[224:227], v11 offset:14336
M a[80:83], a[168:171], a[200:203], a[80:83]
buffer_load_dwordx4 v8, s[12:15], s25 offen offset:2048 lds
M a[84:87], a[176:179], a[200:203], a[84:87]
ds_read_b64_tr_b16 a[152:153], v15 offset:12288
ds_read_b64_tr_b16 a[154:155], v15 offset:13824
M a[84:87], a[172:175], a[196:199], a[84:87]
M a[88:91], a[180:183], a[196:199], a[88:91]
buffer_load_dwordx4 v9, s[12:15], s25 offen offset:3072 lds
M a[88:91], a[184:187], a[200:203], a[88:91]
s_waitcnt lgkmcnt(10)
M a[92:95], a[168:171], a[208:211], a[92:95]
ds_read_b128 a[228:231], v10 offset:16384
ds_read_b128 a[232:235], v11 offset:16384
M a[92:95], a[164:167], a[204:207], a[92:95]
s_add_u32 m0, s30, 102400
s_nop 0
buffer_load_dwordx4 v21, s[12:15], s25 offen offset:0 lds
M a[96:99], a[172:175], a[204:207], a[96:99]
ds_read_b64_tr_b16 a[160:161], v16 offset:12288
ds_read_b64_tr_b16 a[162:163], v16 offset:13824
M a[96:99], a[176:179], a[208:211], a[96:99]
M a[100:103], a[184:187], a[208:211], a[100:103]
buffer_load_dwordx4 v22, s[12:15], s25 offen offset:1024 lds
M a[100:103], a[180:183], a[204:207], a[100:103]
s_waitcnt lgkmcnt(10)
M a[104:107], a[164:167], a[212:215], a[104:107]
s_sub_u32 s54, s54, 1
s_cmp_eq_u32 s54, 0
s_cselect_b32 s58, s55, s56
s_add_u32 s25, s25, s58
M a[104:107], a[168:171], a[216:219], a[104:107]
M a[108:111], a[176:179], a[216:219], a[108:111]
M a[108:111], a[172:175], a[212:215], a[108:111]
M a[112:115], a[180:183], a[212:215], a[112:115]
s_waitcnt vmcnt(15) lgkmcnt(0)
s_barrier
ds_read_b128 a[188:191], v10 offset:18432
ds_read_b128 a[192:195], v11 offset:18432
M a[112:115], a[184:187], a[216:219], a[112:115]
s_add_u32 s94, s92, 4096
buffer_store_dwordx4 v[64:67], v1, s[16:19], s94 offen offset:0 sc1
M a[116:119], a[168:171], a[224:227], a[116:119]
ds_read_b128 a[196:199], v10 offset:20480
ds_read_b128 a[200:203], v11 offset:20480
M a[116:119], a[164:167], a[220:223], a[116:119]
M a[120:123], a[172:175], a[220:223], a[120:123]
s_add_u32 s94, s92, 4096
buffer_store_dwordx4 v[72:75], v1, s[16:19], s94 offen offset:1024 sc1
M a[120:123], a[176:179], a[224:227], a[120:123]
M a[124:127], a[184:187], a[224:227], a[124:127]
M a[124:127], a[180:183], a[220:223], a[124:127]
s_add_u32 s94, s92, 4096
buffer_store_dwordx4 v[80:83], v1, s[16:19], s94 offen offset:2048 sc1
M a[128:131], a[164:167], a[228:231], a[128:131]
ds_read_b128 a[204:207], v10 offset:22528
ds_read_b128 a[208:211], v11 offset:22528
M a[128:131], a[168:171], a[232:235], a[128:131]
M a[132:135], a[176:179], a[232:235], a[132:135]
M a[132:135], a[172:175], a[228:231], a[132:135]
s_add_u32 s94, s92, 4096
buffer_store_dwordx4 v[88:91], v1, s[16:19], s94 offen offset:3072 sc1
M a[136:139], a[180:183], a[228:231], a[136:139]
M a[136:139], a[184:187], a[232:235], a[136:139]
s_waitcnt lgkmcnt(4)
M a[32:35], a[140:143], a[188:191], a[32:35]
ds_read_b128 a[212:215], v10 offset:24576
ds_read_b128 a[216:219], v11 offset:24576
M a[32:35], a[144:147], a[192:195], a[32:35]
s_add_u32 m0, s28, 0
s_mov_b32 exec_hi, 0
buffer_load_dwordx4 v20, s[8:11], s24 offen lds
s_mov_b32 exec_hi, -1
M a[36:39], a[152:155], a[192:195], a[36:39]
ds_read_b64_tr_b16 a[164:165], v14 offset:28672
ds_read_b64_tr_b16 a[166:167], v14 offset:30208
M a[36:39], a[148:151], a[188:191], a[36:39]
M a[40:43], a[156:159], a[188:191], a[40:43]
s_add_u32 m0, s29, 2048
s_nop 0
buffer_load_dwordx4 v2, s[8:11], s23 offen offset:0 lds
M a[40:43], a[160:163], a[192:195], a[40:43]
s_waitcnt lgkmcnt(6)
M a[44:47], a[144:147], a[200:203], a[44:47]
ds_read_b128 a[220:223], v10 offset:26624
ds_read_b128 a[224:227], v11 offset:26624
M a[44:47], a[140:143], a[196:199], a[44:47]
buffer_load_dwordx4 v3, s[8:11], s23 offen offset:1024 lds
M a[48:51], a[148:151], a[196:199], a[48:51]
ds_read_b64_tr_b16 a[172:173], v15 offset:28672
ds_read_b64_tr_b16 a[174:175], v15 offset:30208
M a[48:51], a[152:155], a[200:203], a[48:51]
M a[52:55], a[160:163], a[200:203], a[52:55]
buffer_load_dwordx4 v4, s[8:11], s23 offen offset:2048 lds
M a[52:55], a[156:159], a[196:199], a[52:55]
s_waitcnt lgkmcnt(8)
M a[56:59], a[140:143], a[204:207], a[56:59]
ds_read_b128 a[228:231], v10 offset:28672
ds_read_b128 a[232:235], v11 offset:28672
M a[56:59], a[144:147], a[208:211], a[56:59]
buffer_load_dwordx4 v5, s[8:11], s23 offen offset:3072 lds
M a[60:63], a[152:155], a[208:211], a[60:63]
ds_read_b64_tr_b16 a[180:181], v16 offset:28672
ds_read_b64_tr_b16 a[182:183], v16 offset:30208
M a[60:63], a[148:151], a[204:207], a[60:63]
M a[64:67], a[156:159], a[204:207], a[64:67]
s_sub_u32 s31, s31, 1
s_cmp_eq_u32 s31, 0
s_cselect_b32 s58, -1920, s57
s_add_u32 s23, s23, s58
s_add_u32 s24, s24, s58
M a[64:67], a[160:163], a[208:211], a[64:67]
s_waitcnt lgkmcnt(10)
M a[68:71], a[144:147], a[216:219], a[68:71]
ds_read_b128 a[188:191], v10 offset:30720
ds_read_b128 a[192:195], v11 offset:30720
M a[68:71], a[140:143], a[212:215], a[68:71]
s_add_u32 m0, s30, 36864
s_nop 0
buffer_load_dwordx4 v6, s[12:15], s25 offen offset:0 lds
M a[72:75], a[148:151], a[212:215], a[72:75]
ds_read_b64_tr_b16 a[168:169], v14 offset:40960
ds_read_b64_tr_b16 a[170:171], v14 offset:42496
M a[72:75], a[152:155], a[216:219], a[72:75]
M a[76:79], a[160:163], a[216:219], a[76:79]
buffer_load_dwordx4 v7, s[12:15], s25 offen offset:1024 lds
M a[76:79], a[156:159], a[212:215], a[76:79]
s_waitcnt lgkmcnt(10)
M a[80:83], a[140:143], a[220:223], a[80:83]
ds_read_b128 a[196:199], v10 offset:32768
ds_read_b128 a[200:203], v11 offset:32768
M a[80:83], a[144:147], a[224:227], a[80:83]
buffer_load_dwordx4 v8, s[12:15], s25 offen offset:2048 lds
M a[84:87], a[152:155], a[224:227], a[84:87]
ds_read_b64_tr_b16 a[176:177], v15 offset:40960
ds_read_b64_tr_b16 a[178:179], v15 offset:42496
M a[84:87], a[148:151], a[220:223], a[84:87]
M a[88:91], a[156:159], a[220:223], a[88:91]
buffer_load_dwordx4 v9, s[12:15], s25 offen offset:3072 lds
M a[88:91], a[160:163], a[224:227], a[88:91]
s_waitcnt lgkmcnt(10)
M a[92:95], a[144:147], a[232:235], a[92:95]
ds_read_b128 a[204:207], v10 offset:34816
ds_read_b128 a[208:211], v11 offset:34816
M a[92:95], a[140:143], a[228:231], a[92:95]
s_add_u32 m0, s30, 40960
s_nop 0
buffer_load_dwordx4 v21, s[12:15], s25 offen offset:0 lds
M a[96:99], a[148:151], a[228:231], a[96:99]
ds_read_b64_tr_b16 a[184:185], v16 offset:40960
ds_read_b64_tr_b16 a[186:187], v16 offset:42496
M a[96:99], a[152:155], a[232:235], a[96:99]
M a[100:103], a[160:163], a[232:235], a[100:103]
buffer_load_dwordx4 v22, s[12:15], s25 offen offset:1024 lds
M a[100:103], a[156:159], a[228:231], a[100:103]
s_waitcnt lgkmcnt(10)
M a[104:107], a[140:143], a[188:191], a[104:107]
s_sub_u32 s54, s54, 1
s_cmp_eq_u32 s54, 0
s_cselect_b32 s58, s55, s56
s_add_u32 s25, s25, s58
M a[104:107], a[144:147], a[192:195], a[104:107]
M a[108:111], a[152:155], a[192:195], a[108:111]
M a[108:111], a[148:151], a[188:191], a[108:111]
M a[112:115], a[156:159], a[188:191], a[112:115]
s_waitcnt vmcnt(15) lgkmcnt(0)
s_barrier
ds_read_b128 a[212:215], v12 offset:0
ds_read_b128 a[216:219], v13 offset:0
M a[112:115], a[160:163], a[192:195], a[112:115]
s_add_u32 s94, s92, 8192
buffer_store_dwordx4 v[96:99], v1, s[16:19], s94 offen offset:0 sc1
M a[116:119], a[144:147], a[200:203], a[116:119]
ds_read_b128 a[220:223], v12 offset:2048
ds_read_b128 a[224:227], v13 offset:2048
M a[116:119], a[140:143], a[196:199], a[116:119]
M a[120:123], a[148:151], a[196:199], a[120:123]
s_add_u32 s94, s92, 8192
buffer_store_dwordx4 v[104:107], v1, s[16:19], s94 offen offset:1024 sc1
M a[120:123], a[152:155], a[200:203], a[120:123]
M a[124:127], a[160:163], a[200:203], a[124:127]
M a[124:127], a[156:159], a[196:199], a[124:127]
s_add_u32 s94, s92, 8192
buffer_store_dwordx4 v[112:115], v1, s[16:19], s94 offen offset:2048 sc1
M a[128:131], a[140:143], a[204:207], a[128:131]
ds_read_b128 a[228:231], v12 offset:4096
ds_read_b128 a[232:235], v13 offset:4096
M a[128:131], a[144:147], a[208:211], a[128:131]
M a[132:135], a[152:155], a[208:211], a[132:135]
M a[132:135], a[148:151], a[204:207], a[132:135]
s_add_u32 s94, s92, 8192
buffer_store_dwordx4 v[120:123], v1, s[16:19], s94 offen offset:3072 sc1
M a[136:139], a[156:159], a[204:207], a[136:139]
M a[136:139], a[160:163], a[208:211], a[136:139]
s_waitcnt lgkmcnt(4)
M a[32:35], a[164:167], a[212:215], a[32:35]
ds_read_b128 a[188:191], v12 offset:6144
ds_read_b128 a[192:195], v13 offset:6144
M a[32:35], a[168:171], a[216:219], a[32:35]
s_add_u32 m0, s28, 18432
s_mov_b32 exec_hi, 0
buffer_load_dwordx4 v20, s[8:11], s24 offen lds
s_mov_b32 exec_hi, -1
M a[36:39], a[176:179], a[216:219], a[36:39]
ds_read_b64_tr_b16 a[140:141], v17 offset:0
ds_read_b64_tr_b16 a[142:143], v17 offset:1536
M a[36:39], a[172:175], a[212:215], a[36:39]
M a[40:43], a[180:183], a[212:215], a[40:43]
s_add_u32 m0, s29, 20480
s_nop 0
buffer_load_dwordx4 v2, s[8:11], s23 offen offset:0 lds
M a[40:43], a[184:187], a[216:219], a[40:43]
s_waitcnt lgkmcnt(6)
M a[44:47], a[168:171], a[224:227], a[44:47]
ds_read_b128 a[196:199], v12 offset:8192
ds_read_b128 a[200:203], v13 offset:8192
M a[44:47], a[164:167], a[220:223], a[44:47]
buffer_load_dwordx4 v3, s[8:11], s23 offen offset:1024 lds
M a[48:51], a[172:175], a[220:223], a[48:51]
ds_read_b64_tr_b16 a[148:149], v18 offset:0
ds_read_b64_tr_b16 a[150:151], v18 offset:1536
M a[48:51], a[176:179], a[224:227], a[48:51]
M a[52:55], a[184:187], a[224:227], a[52:55]
buffer_load_dwordx4 v4, s[8:11], s23 offen offset:2048 lds
M a[52:55], a[180:183], a[220:223], a[52:55]
s_waitcnt lgkmcnt(8)
M a[56:59], a[164:167], a[228:231], a[56:59]
ds_read_b128 a[204:207], v12 offset:10240
ds_read_b128 a[208:211], v13 offset:10240
M a[56:59], a[168:171], a[232:235], a[56:59]
buffer_load_dwordx4 v5, s[8:11], s23 offen offset:3072 lds
M a[60:63], a[176:179], a[232:235], a[60:63]
ds_read_b64_tr_b16 a[156:157], v19 offset:0
ds_read_b64_tr_b16 a[158:159], v19 offset:1536
M a[60:63], a[172:175], a[228:231], a[60:63]
M a[64:67], a[180:183], a[228:231], a[64:67]
s_sub_u32 s31, s31, 1
s_cmp_eq_u32 s31, 0
s_cselect_b32 s58, -1920, s57
s_add_u32 s23, s23, s58
s_add_u32 s24, s24, s58
M a[64:67], a[184:187], a[232:235], a[64:67]
s_waitcnt lgkmcnt(10)
M a[68:71], a[168:171], a[192:195], a[68:71]
ds_read_b128 a[212:215], v12 offset:12288
ds_read_b128 a[216:219], v13 offset:12288
M a[68:71], a[164:167], a[188:191], a[68:71]
s_add_u32 m0, s30, 65536
s_nop 0
buffer_load_dwordx4 v6, s[12:15], s25 offen offset:0 lds
M a[72:75], a[172:175], a[188:191], a[72:75]
ds_read_b64_tr_b16 a[144:145], v17 offset:12288
ds_read_b64_tr_b16 a[146:147], v17 offset:13824
M a[72:75], a[176:179], a[192:195], a[72:75]
M a[76:79], a[184:187], a[192:195], a[76:79]
buffer_load_dwordx4 v7, s[12:15], s25 offen offset:1024 lds
M a[76:79], a[180:183], a[188:191], a[76:79]
s_waitcnt lgkmcnt(10)
M a[80:83], a[164:167], a[196:199], a[80:83]
ds_read_b128 a[220:223], v12 offset:14336
ds_read_b128 a[224:227], v13 offset:14336
M a[80:83], a[168:171], a[200:203], a[80:83]
buffer_load_dwordx4 v8, s[12:15], s25 offen offset:2048 lds
M a[84:87], a[176:179], a[200:203], a[84:87]
ds_read_b64_tr_b16 a[152:153], v18 offset:12288
ds_read_b64_tr_b16 a[154:155], v18 offset:13824
M a[84:87], a[172:175], a[196:199], a[84:87]
M a[88:91], a[180:183], a[196:199], a[88:91]
buffer_load_dwordx4 v9, s[12:15], s25 offen offset:3072 lds
M a[88:91], a[184:187], a[200:203], a[88:91]
s_waitcnt lgkmcnt(10)
M a[92:95], a[168:171], a[208:211], a[92:95]
ds_read_b128 a[228:231], v12 offset:16384
ds_read_b128 a[232:235], v13 offset:16384
M a[92:95], a[164:167], a[204:207], a[92:95]
s_add_u32 m0, s30, 69632
s_nop 0
buffer_load_dwordx4 v21, s[12:15], s25 offen offset:0 lds
M a[96:99], a[172:175], a[204:207], a[96:99]
ds_read_b64_tr_b16 a[160:161], v19 offset:12288
ds_read_b64_tr_b16 a[162:163], v19 offset:13824
M a[96:99], a[176:179], a[208:211], a[96:99]
M a[100:103], a[184:187], a[208:211], a[100:103]
buffer_load_dwordx4 v22, s[12:15], s25 offen offset:1024 lds
M a[100:103], a[180:183], a[204:207], a[100:103]
s_waitcnt lgkmcnt(10)
M a[104:107], a[164:167], a[212:215], a[104:107]
s_sub_u32 s54, s54, 1
s_cmp_eq_u32 s54, 0
s_cselect_b32 s58, s55, s56
s_add_u32 s25, s25, s58
M a[104:107], a[168:171], a[216:219], a[104:107]
M a[108:111], a[176:179], a[216:219], a[108:111]
M a[108:111], a[172:175], a[212:215], a[108:111]
M a[112:115], a[180:183], a[212:215], a[112:115]
s_waitcnt vmcnt(15) lgkmcnt(0)
s_barrier
ds_read_b128 a[188:191], v10 offset:0
ds_read_b128 a[192:195], v11 offset:0
M a[112:115], a[184:187], a[216:219], a[112:115]
s_add_u32 s94, s92, 12288
buffer_store_dwordx4 v[128:131], v1, s[16:19], s94 offen offset:0 sc1
M a[116:119], a[168:171], a[224:227], a[116:119]
ds_read_b128 a[196:199], v10 offset:2048
ds_read_b128 a[200:203], v11 offset:2048
M a[116:119], a[164:167], a[220:223], a[116:119]
M a[120:123], a[172:175], a[220:223], a[120:123]
s_add_u32 s94, s92, 12288
buffer_store_dwordx4 v[136:139], v1, s[16:19], s94 offen offset:1024 sc1
M a[120:123], a[176:179], a[224:227], a[120:123]
M a[124:127], a[184:187], a[224:227], a[124:127]
M a[124:127], a[180:183], a[220:223], a[124:127]
s_add_u32 s94, s92, 12288
buffer_store_dwordx4 v[144:147], v1, s[16:19], s94 offen offset:2048 sc1
M a[128:131], a[164:167], a[228:231], a[128:131]
ds_read_b128 a[204:207], v10 offset:4096
ds_read_b128 a[208:211], v11 offset:4096
M a[128:131], a[168:171], a[232:235], a[128:131]
M a[132:135], a[176:179], a[232:235], a[132:135]
M a[132:135], a[172:175], a[228:231], a[132:135]
s_add_u32 s94, s92, 12288
buffer_store_dwordx4 v[152:155], v1, s[16:19], s94 offen offset:3072 sc1
M a[136:139], a[180:183], a[228:231], a[136:139]
M a[136:139], a[184:187], a[232:235], a[136:139]
s_waitcnt lgkmcnt(4)
M a[32:35], a[140:143], a[188:191], a[32:35]
ds_read_b128 a[212:215], v10 offset:6144
ds_read_b128 a[216:219], v11 offset:6144
M a[32:35], a[144:147], a[192:195], a[32:35]
s_add_u32 m0, s28, 131072
s_mov_b32 exec_hi, 0
buffer_load_dwordx4 v20, s[8:11], s24 offen lds
s_mov_b32 exec_hi, -1
M a[36:39], a[152:155], a[192:195], a[36:39]
ds_read_b64_tr_b16 a[164:165], v14 offset:0
ds_read_b64_tr_b16 a[166:167], v14 offset:1536
M a[36:39], a[148:151], a[188:191], a[36:39]
M a[40:43], a[156:159], a[188:191], a[40:43]
s_add_u32 m0, s29, 133120
s_nop 0
buffer_load_dwordx4 v2, s[8:11], s23 offen offset:0 lds
M a[40:43], a[160:163], a[192:195], a[40:43]
s_waitcnt lgkmcnt(6)
M a[44:47], a[144:147], a[200:203], a[44:47]
ds_read_b128 a[220:223], v10 offset:8192
ds_read_b128 a[224:227], v11 offset:8192
M a[44:47], a[140:143], a[196:199], a[44:47]
buffer_load_dwordx4 v3, s[8:11], s23 offen offset:1024 lds
M a[48:51], a[148:151], a[196:199], a[48:51]
ds_read_b64_tr_b16 a[172:173], v15 offset:0
ds_read_b64_tr_b16 a[174:175], v15 offset:1536
M a[48:51], a[152:155], a[200:203], a[48:51]
M a[52:55], a[160:163], a[200:203], a[52:55]
buffer_load_dwordx4 v4, s[8:11], s23 offen offset:2048 lds
M a[52:55], a[156:159], a[196:199], a[52:55]
s_waitcnt lgkmcnt(8)
M a[56:59], a[140:143], a[204:207], a[56:59]
ds_read_b128 a[228:231], v10 offset:10240
ds_read_b128 a[232:235], v11 offset:10240
M a[56:59], a[144:147], a[208:211], a[56:59]
buffer_load_dwordx4 v5, s[8:11], s23 offen offset:3072 lds
M a[60:63], a[152:155], a[208:211], a[60:63]
ds_read_b64_tr_b16 a[180:181], v16 offset:0
ds_read_b64_tr_b16 a[182:183], v16 offset:1536
M a[60:63], a[148:151], a[204:207], a[60:63]
M a[64:67], a[156:159], a[204:207], a[64:67]
s_sub_u32 s31, s31, 1
s_cmp_eq_u32 s31, 0
s_cselect_b32 s58, -1920, s57
s_add_u32 s23, s23, s58
s_add_u32 s24, s24, s58
M a[64:67], a[160:163], a[208:211], a[64:67]
s_waitcnt lgkmcnt(10)
M a[68:71], a[144:147], a[216:219], a[68:71]
ds_read_b128 a[188:191], v10 offset:12288
ds_read_b128 a[192:195], v11 offset:12288
M a[68:71], a[140:143], a[212:215], a[68:71]
s_add_u32 m0, s30, 98304
s_nop 0
buffer_load_dwordx4 v6, s[12:15], s25 offen offset:0 lds
M a[72:75], a[148:151], a[212:215], a[72:75]
ds_read_b64_tr_b16 a[168:169], v14 offset:12288
ds_read_b64_tr_b16 a[170:171], v14 offset:13824
M a[72:75], a[152:155], a[216:219], a[72:75]
M a[76:79], a[160:163], a[216:219], a[76:79]
buffer_load_dwordx4 v7, s[12:15], s25 offen offset:1024 lds
M a[76:79], a[156:159], a[212:215], a[76:79]
s_waitcnt lgkmcnt(10)
M a[80:83], a[140:143], a[220:223], a[80:83]
ds_read_b128 a[196:199], v10 offset:14336
ds_read_b128 a[200:203], v11 offset:14336
M a[80:83], a[144:147], a[224:227], a[80:83]
buffer_load_dwordx4 v8, s[12:15], s25 offen offset:2048 lds
M a[84:87], a[152:155], a[224:227], a[84:87]
ds_read_b64_tr_b16 a[176:177], v15 offset:12288
ds_read_b64_tr_b16 a[178:179], v15 offset:13824
M a[84:87], a[148:151], a[220:223], a[84:87]
M a[88:91], a[156:159], a[220:223], a[88:91]
buffer_load_dwordx4 v9, s[12:15], s25 offen offset:3072 lds
M a[88:91], a[160:163], a[224:227], a[88:91]
s_waitcnt lgkmcnt(10)
M a[92:95], a[144:147], a[232:235], a[92:95]
ds_read_b128 a[204:207], v10 offset:16384
ds_read_b128 a[208:211], v11 offset:16384
M a[92:95], a[140:143], a[228:231], a[92:95]
s_add_u32 m0, s30, 102400
s_nop 0
buffer_load_dwordx4 v21, s[12:15], s25 offen offset:0 lds
M a[96:99], a[148:151], a[228:231], a[96:99]
ds_read_b64_tr_b16 a[184:185], v16 offset:12288
ds_read_b64_tr_b16 a[186:187], v16 offset:13824
M a[96:99], a[152:155], a[232:235], a[96:99]
M a[100:103], a[160:163], a[232:235], a[100:103]
buffer_load_dwordx4 v22, s[12:15], s25 offen offset:1024 lds
M a[100:103], a[156:159], a[228:231], a[100:103]
s_waitcnt lgkmcnt(10)
M a[104:107], a[140:143], a[188:191], a[104:107]
s_sub_u32 s54, s54, 1
s_cmp_eq_u32 s54, 0
s_cselect_b32 s58, s55, s56
s_add_u32 s25, s25, s58
M a[104:107], a[144:147], a[192:195], a[104:107]
M a[108:111], a[152:155], a[192:195], a[108:111]
M a[108:111], a[148:151], a[188:191], a[108:111]
M a[112:115], a[156:159], a[188:191], a[112:115]
s_waitcnt vmcnt(15) lgkmcnt(0)
s_barrier
ds_read_b128 a[212:215], v10 offset:18432
ds_read_b128 a[216:219], v11 offset:18432
M a[112:115], a[160:163], a[192:195], a[112:115]
s_add_u32 s94, s93, 0
buffer_store_dwordx4 v[160:163], v1, s[16:19], s94 offen offset:0 sc1
M a[116:119], a[144:147], a[200:203], a[116:119]
ds_read_b128 a[220:223], v10 offset:20480
ds_read_b128 a[224:227], v11 offset:20480
M a[116:119], a[140:143], a[196:199], a[116:119]
M a[120:123], a[148:151], a[196:199], a[120:123]
s_add_u32 s94, s93, 0
buffer_store_dwordx4 v[168:171], v1, s[16:19], s94 offen offset:1024 sc1
M a[120:123], a[152:155], a[200:203], a[120:123]
M a[124:127], a[160:163], a[200:203], a[124:127]
M a[124:127], a[156:159], a[196:199], a[124:127]
s_add_u32 s94, s93, 0
buffer_store_dwordx4 v[176:179], v1, s[16:19], s94 offen offset:2048 sc1
M a[128:131], a[140:143], a[204:207], a[128:131]
ds_read_b128 a[228:231], v10 offset:22528
ds_read_b128 a[232:235], v11 offset:22528
M a[128:131], a[144:147], a[208:211], a[128:131]
M a[132:135], a[152:155], a[208:211], a[132:135]
M a[132:135], a[148:151], a[204:207], a[132:135]
s_add_u32 s94, s93, 0
buffer_store_dwordx4 v[184:187], v1, s[16:19], s94 offen offset:3072 sc1
M a[136:139], a[156:159], a[204:207], a[136:139]
M a[136:139], a[160:163], a[208:211], a[136:139]
s_waitcnt lgkmcnt(4)
M a[32:35], a[164:167], a[212:215], a[32:35]
ds_read_b128 a[188:191], v10 offset:24576
ds_read_b128 a[192:195], v11 offset:24576
M a[32:35], a[168:171], a[216:219], a[32:35]
s_add_u32 m0, s28, 0
s_mov_b32 exec_hi, 0
buffer_load_dwordx4 v20, s[8:11], s24 offen lds
s_mov_b32 exec_hi, -1
M a[36:39], a[176:179], a[216:219], a[36:39]
ds_read_b64_tr_b16 a[140:141], v14 offset:28672
ds_read_b64_tr_b16 a[142:143], v14 offset:30208
M a[36:39], a[172:175], a[212:215], a[36:39]
M a[40:43], a[180:183], a[212:215], a[40:43]
s_add_u32 m0, s29, 2048
s_nop 0
buffer_load_dwordx4 v2, s[8:11], s23 offen offset:0 lds
M a[40:43], a[184:187], a[216:219], a[40:43]
s_waitcnt lgkmcnt(6)
M a[44:47], a[168:171], a[224:227], a[44:47]
ds_read_b128 a[196:199], v10 offset:26624
ds_read_b128 a[200:203], v11 offset:26624
M a[44:47], a[164:167], a[220:223], a[44:47]
buffer_load_dwordx4 v3, s[8:11], s23 offen offset:1024 lds
M a[48:51], a[172:175], a[220:223], a[48:51]
ds_read_b64_tr_b16 a[148:149], v15 offset:28672
ds_read_b64_tr_b16 a[150:151], v15 offset:30208
M a[48:51], a[176:179], a[224:227], a[48:51]
M a[52:55], a[184:187], a[224:227], a[52:55]
buffer_load_dwordx4 v4, s[8:11], s23 offen offset:2048 lds
M a[52:55], a[180:183], a[220:223], a[52:55]
s_waitcnt lgkmcnt(8)
M a[56:59], a[164:167], a[228:231], a[56:59]
ds_read_b128 a[204:207], v10 offset:28672
ds_read_b128 a[208:211], v11 offset:28672
M a[56:59], a[168:171], a[232:235], a[56:59]
buffer_load_dwordx4 v5, s[8:11], s23 offen offset:3072 lds
M a[60:63], a[176:179], a[232:235], a[60:63]
ds_read_b64_tr_b16 a[156:157], v16 offset:28672
ds_read_b64_tr_b16 a[158:159], v16 offset:30208
M a[60:63], a[172:175], a[228:231], a[60:63]
M a[64:67], a[180:183], a[228:231], a[64:67]
s_sub_u32 s31, s31, 1
s_cmp_eq_u32 s31, 0
s_cselect_b32 s58, -1920, s57
s_add_u32 s23, s23, s58
s_add_u32 s24, s24, s58
M a[64:67], a[184:187], a[232:235], a[64:67]
s_waitcnt lgkmcnt(10)
M a[68:71], a[168:171], a[192:195], a[68:71]
ds_read_b128 a[212:215], v10 offset:30720
ds_read_b128 a[216:219], v11 offset:30720
M a[68:71], a[164:167], a[188:191], a[68:71]
s_add_u32 m0, s30, 36864
s_nop 0
buffer_load_dwordx4 v6, s[12:15], s25 offen offset:0 lds
M a[72:75], a[172:175], a[188:191], a[72:75]
ds_read_b64_tr_b16 a[144:145], v14 offset:40960
ds_read_b64_tr_b16 a[146:147], v14 offset:42496
M a[72:75], a[176:179], a[192:195], a[72:75]
M a[76:79], a[184:187], a[192:195], a[76:79]
buffer_load_dwordx4 v7, s[12:15], s25 offen offset:1024 lds
M a[76:79], a[180:183], a[188:191], a[76:79]
s_waitcnt lgkmcnt(10)
M a[80:83], a[164:167], a[196:199], a[80:83]
ds_read_b128 a[220:223], v10 offset:32768
ds_read_b128 a[224:227], v11 offset:32768
M a[80:83], a[168:171], a[200:203], a[80:83]
buffer_load_dwordx4 v8, s[12:15], s25 offen offset:2048 lds
M a[84:87], a[176:179], a[200:203], a[84:87]
ds_read_b64_tr_b16 a[152:153], v15 offset:40960
ds_read_b64_tr_b16 a[154:155], v15 offset:42496
M a[84:87], a[172:175], a[196:199], a[84:87]
M a[88:91], a[180:183], a[196:199], a[88:91]
buffer_load_dwordx4 v9, s[12:15], s25 offen offset:3072 lds
M a[88:91], a[184:187], a[200:203], a[88:91]
s_waitcnt lgkmcnt(10)
M a[92:95], a[168:171], a[208:211], a[92:95]
ds_read_b128 a[228:231], v10 offset:34816
ds_read_b128 a[232:235], v11 offset:34816
M a[92:95], a[164:167], a[204:207], a[92:95]
s_add_u32 m0, s30, 40960
s_nop 0
buffer_load_dwordx4 v21, s[12:15], s25 offen offset:0 lds
M a[96:99], a[172:175], a[204:207], a[96:99]
ds_read_b64_tr_b16 a[160:161], v16 offset:40960
ds_read_b64_tr_b16 a[162:163], v16 offset:42496
M a[96:99], a[176:179], a[208:211], a[96:99]
M a[100:103], a[184:187], a[208:211], a[100:103]
buffer_load_dwordx4 v22, s[12:15], s25 offen offset:1024 lds
M a[100:103], a[180:183], a[204:207], a[100:103]
s_waitcnt lgkmcnt(10)
M a[104:107], a[164:167], a[212:215], a[104:107]
s_sub_u32 s54, s54, 1
s_cmp_eq_u32 s54, 0
s_cselect_b32 s58, s55, s56
s_add_u32 s25, s25, s58
M a[104:107], a[168:171], a[216:219], a[104:107]
M a[108:111], a[176:179], a[216:219], a[108:111]
M a[108:111], a[172:175], a[212:215], a[108:111]
M a[112:115], a[180:183], a[212:215], a[112:115]
s_waitcnt vmcnt(15) lgkmcnt(0)
s_barrier
ds_read_b128 a[188:191], v12 offset:0
ds_read_b128 a[192:195], v13 offset:0
M a[112:115], a[184:187], a[216:219], a[112:115]
s_add_u32 s94, s93, 4096
buffer_store_dwordx4 v[192:195], v1, s[16:19], s94 offen offset:0 sc1
M a[116:119], a[168:171], a[224:227], a[116:119]
ds_read_b128 a[196:199], v12 offset:2048
ds_read_b128 a[200:203], v13 offset:2048
M a[116:119], a[164:167], a[220:223], a[116:119]
M a[120:123], a[172:175], a[220:223], a[120:123]
s_add_u32 s94, s93, 4096
buffer_store_dwordx4 v[200:203], v1, s[16:19], s94 offen offset:1024 sc1
M a[120:123], a[176:179], a[224:227], a[120:123]
M a[124:127], a[184:187], a[224:227], a[124:127]
M a[124:127], a[180:183], a[220:223], a[124:127]
s_add_u32 s94, s93, 4096
buffer_store_dwordx4 v[208:211], v1, s[16:19], s94 offen offset:2048 sc1
M a[128:131], a[164:167], a[228:231], a[128:131]
ds_read_b128 a[204:207], v12 offset:4096
ds_read_b128 a[208:211], v13 offset:4096
M a[128:131], a[168:171], a[232:235], a[128:131]
M a[132:135], a[176:179], a[232:235], a[132:135]
M a[132:135], a[172:175], a[228:231], a[132:135]
s_add_u32 s94, s93, 4096
buffer_store_dwordx4 v[216:219], v1, s[16:19], s94 offen offset:3072 sc1
M a[136:139], a[180:183], a[228:231], a[136:139]
M a[136:139], a[184:187], a[232:235], a[136:139]
s_waitcnt lgkmcnt(4)
M a[32:35], a[140:143], a[188:191], a[32:35]
ds_read_b128 a[212:215], v12 offset:6144
ds_read_b128 a[216:219], v13 offset:6144
M a[32:35], a[144:147], a[192:195], a[32:35]
s_add_u32 m0, s28, 18432
s_mov_b32 exec_hi, 0
buffer_load_dwordx4 v20, s[8:11], s24 offen lds
s_mov_b32 exec_hi, -1
M a[36:39], a[152:155], a[192:195], a[36:39]
ds_read_b64_tr_b16 a[164:165], v17 offset:0
ds_read_b64_tr_b16 a[166:167], v17 offset:1536
M a[36:39], a[148:151], a[188:191], a[36:39]
M a[40:43], a[156:159], a[188:191], a[40:43]
s_add_u32 m0, s29, 20480
s_nop 0
buffer_load_dwordx4 v2, s[8:11], s23 offen offset:0 lds
M a[40:43], a[160:163], a[192:195], a[40:43]
s_waitcnt lgkmcnt(6)
M a[44:47], a[144:147], a[200:203], a[44:47]
ds_read_b128 a[220:223], v12 offset:8192
ds_read_b128 a[224:227], v13 offset:8192
M a[44:47], a[140:143], a[196:199], a[44:47]
buffer_load_dwordx4 v3, s[8:11], s23 offen offset:1024 lds
M a[48:51], a[148:151], a[196:199], a[48:51]
ds_read_b64_tr_b16 a[172:173], v18 offset:0
ds_read_b64_tr_b16 a[174:175], v18 offset:1536
M a[48:51], a[152:155], a[200:203], a[48:51]
M a[52:55], a[160:163], a[200:203], a[52:55]
buffer_load_dwordx4 v4, s[8:11], s23 offen offset:2048 lds
M a[52:55], a[156:159], a[196:199], a[52:55]
s_waitcnt lgkmcnt(8)
M a[56:59], a[140:143], a[204:207], a[56:59]
ds_read_b128 a[228:231], v12 offset:10240
ds_read_b128 a[232:235], v13 offset:10240
M a[56:59], a[144:147], a[208:211], a[56:59]
buffer_load_dwordx4 v5, s[8:11], s23 offen offset:3072 lds
M a[60:63], a[152:155], a[208:211], a[60:63]
ds_read_b64_tr_b16 a[180:181], v19 offset:0
ds_read_b64_tr_b16 a[182:183], v19 offset:1536
M a[60:63], a[148:151], a[204:207], a[60:63]
M a[64:67], a[156:159], a[204:207], a[64:67]
s_sub_u32 s31, s31, 1
s_cmp_eq_u32 s31, 0
s_cselect_b32 s58, -1920, s57
s_add_u32 s23, s23, s58
s_add_u32 s24, s24, s58
M a[64:67], a[160:163], a[208:211], a[64:67]
s_waitcnt lgkmcnt(10)
M a[68:71], a[144:147], a[216:219], a[68:71]
ds_read_b128 a[188:191], v12 offset:12288
ds_read_b128 a[192:195], v13 offset:12288
M a[68:71], a[140:143], a[212:215], a[68:71]
s_add_u32 m0, s30, 65536
s_nop 0
buffer_load_dwordx4 v6, s[12:15], s25 offen offset:0 lds
M a[72:75], a[148:151], a[212:215], a[72:75]
ds_read_b64_tr_b16 a[168:169], v17 offset:12288
ds_read_b64_tr_b16 a[170:171], v17 offset:13824
M a[72:75], a[152:155], a[216:219], a[72:75]
M a[76:79], a[160:163], a[216:219], a[76:79]
buffer_load_dwordx4 v7, s[12:15], s25 offen offset:1024 lds
M a[76:79], a[156:159], a[212:215], a[76:79]
s_waitcnt lgkmcnt(10)
M a[80:83], a[140:143], a[220:223], a[80:83]
ds_read_b128 a[196:199], v12 offset:14336
ds_read_b128 a[200:203], v13 offset:14336
M a[80:83], a[144:147], a[224:227], a[80:83]
buffer_load_dwordx4 v8, s[12:15], s25 offen offset:2048 lds
M a[84:87], a[152:155], a[224:227], a[84:87]
ds_read_b64_tr_b16 a[176:177], v18 offset:12288
ds_read_b64_tr_b16 a[178:179], v18 offset:13824
M a[84:87], a[148:151], a[220:223], a[84:87]
M a[88:91], a[156:159], a[220:223], a[88:91]
buffer_load_dwordx4 v9, s[12:15], s25 offen offset:3072 lds
M a[88:91], a[160:163], a[224:227], a[88:91]
s_waitcnt lgkmcnt(10)
M a[92:95], a[144:147], a[232:235], a[92:95]
ds_read_b128 a[204:207], v12 offset:16384
ds_read_b128 a[208:211], v13 offset:16384
M a[92:95], a[140:143], a[228:231], a[92:95]
s_add_u32 m0, s30, 69632
s_nop 0
buffer_load_dwordx4 v21, s[12:15], s25 offen offset:0 lds
M a[96:99], a[148:151], a[228:231], a[96:99]
ds_read_b64_tr_b16 a[184:185], v19 offset:12288
ds_read_b64_tr_b16 a[186:187], v19 offset:13824
M a[96:99], a[152:155], a[232:235], a[96:99]
M a[100:103], a[160:163], a[232:235], a[100:103]
buffer_load_dwordx4 v22, s[12:15], s25 offen offset:1024 lds
M a[100:103], a[156:159], a[228:231], a[100:103]
s_waitcnt lgkmcnt(10)
M a[104:107], a[140:143], a[188:191], a[104:107]
s_sub_u32 s54, s54, 1
s_cmp_eq_u32 s54, 0
s_cselect_b32 s58, s55, s56
s_add_u32 s25, s25, s58
M a[104:107], a[144:147], a[192:195], a[104:107]
M a[108:111], a[152:155], a[192:195], a[108:111]
M a[108:111], a[148:151], a[188:191], a[108:111]
M a[112:115], a[156:159], a[188:191], a[112:115]
s_waitcnt vmcnt(15) lgkmcnt(0)
s_barrier
ds_read_b128 a[212:215], v10 offset:0
ds_read_b128 a[216:219], v11 offset:0
M a[112:115], a[160:163], a[192:195], a[112:115]
s_add_u32 s94, s93, 8192
buffer_store_dwordx4 v[224:227], v1, s[16:19], s94 offen offset:0 sc1
M a[116:119], a[144:147], a[200:203], a[116:119]
ds_read_b128 a[220:223], v10 offset:2048
ds_read_b128 a[224:227], v11 offset:2048
M a[116:119], a[140:143], a[196:199], a[116:119]
M a[120:123], a[148:151], a[196:199], a[120:123]
s_add_u32 s94, s93, 8192
buffer_store_dwordx4 v[232:235], v1, s[16:19], s94 offen offset:1024 sc1
M a[120:123], a[152:155], a[200:203], a[120:123]
M a[124:127], a[160:163], a[200:203], a[124:127]
M a[124:127], a[156:159], a[196:199], a[124:127]
s_add_u32 s94, s93, 8192
buffer_store_dwordx4 v[240:243], v1, s[16:19], s94 offen offset:2048 sc1
M a[128:131], a[140:143], a[204:207], a[128:131]
ds_read_b128 a[228:231], v10 offset:4096
ds_read_b128 a[232:235], v11 offset:4096
M a[128:131], a[144:147], a[208:211], a[128:131]
M a[132:135], a[152:155], a[208:211], a[132:135]
M a[132:135], a[148:151], a[204:207], a[132:135]
s_add_u32 s94, s93, 8192
buffer_store_dwordx4 v[248:251], v1, s[16:19], s94 offen offset:3072 sc1
M a[136:139], a[156:159], a[204:207], a[136:139]
M a[136:139], a[160:163], a[208:211], a[136:139]
s_waitcnt lgkmcnt(4)
M a[32:35], a[164:167], a[212:215], a[32:35]
ds_read_b128 a[188:191], v10 offset:6144
ds_read_b128 a[192:195], v11 offset:6144
M a[32:35], a[168:171], a[216:219], a[32:35]
s_add_u32 m0, s28, 131072
s_mov_b32 exec_hi, 0
buffer_load_dwordx4 v20, s[8:11], s24 offen lds
s_mov_b32 exec_hi, -1
M a[36:39], a[176:179], a[216:219], a[36:39]
ds_read_b64_tr_b16 a[140:141], v14 offset:0
ds_read_b64_tr_b16 a[142:143], v14 offset:1536
M a[36:39], a[172:175], a[212:215], a[36:39]
M a[40:43], a[180:183], a[212:215], a[40:43]
s_add_u32 m0, s29, 133120
s_nop 0
buffer_load_dwordx4 v2, s[8:11], s23 offen offset:0 lds
M a[40:43], a[184:187], a[216:219], a[40:43]
s_waitcnt lgkmcnt(6)
M a[44:47], a[168:171], a[224:227], a[44:47]
ds_read_b128 a[196:199], v10 offset:8192
ds_read_b128 a[200:203], v11 offset:8192
M a[44:47], a[164:167], a[220:223], a[44:47]
buffer_load_dwordx4 v3, s[8:11], s23 offen offset:1024 lds
M a[48:51], a[172:175], a[220:223], a[48:51]
ds_read_b64_tr_b16 a[148:149], v15 offset:0
ds_read_b64_tr_b16 a[150:151], v15 offset:1536
M a[48:51], a[176:179], a[224:227], a[48:51]
M a[52:55], a[184:187], a[224:227], a[52:55]
buffer_load_dwordx4 v4, s[8:11], s23 offen offset:2048 lds
M a[52:55], a[180:183], a[220:223], a[52:55]
s_waitcnt lgkmcnt(8)
M a[56:59], a[164:167], a[228:231], a[56:59]
ds_read_b128 a[204:207], v10 offset:10240
ds_read_b128 a[208:211], v11 offset:10240
M a[56:59], a[168:171], a[232:235], a[56:59]
buffer_load_dwordx4 v5, s[8:11], s23 offen offset:3072 lds
M a[60:63], a[176:179], a[232:235], a[60:63]
ds_read_b64_tr_b16 a[156:157], v16 offset:0
ds_read_b64_tr_b16 a[158:159], v16 offset:1536
M a[60:63], a[172:175], a[228:231], a[60:63]
M a[64:67], a[180:183], a[228:231], a[64:67]
s_sub_u32 s31, s31, 1
s_cmp_eq_u32 s31, 0
s_cselect_b32 s58, -1920, s57
s_add_u32 s23, s23, s58
s_add_u32 s24, s24, s58
M a[64:67], a[184:187], a[232:235], a[64:67]
s_waitcnt lgkmcnt(10)
M a[68:71], a[168:171], a[192:195], a[68:71]
ds_read_b128 a[212:215], v10 offset:12288
ds_read_b128 a[216:219], v11 offset:12288
M a[68:71], a[164:167], a[188:191], a[68:71]
s_add_u32 m0, s30, 98304
s_nop 0
buffer_load_dwordx4 v6, s[12:15], s25 offen offset:0 lds
M a[72:75], a[172:175], a[188:191], a[72:75]
ds_read_b64_tr_b16 a[144:145], v14 offset:12288
ds_read_b64_tr_b16 a[146:147], v14 offset:13824
M a[72:75], a[176:179], a[192:195], a[72:75]
M a[76:79], a[184:187], a[192:195], a[76:79]
buffer_load_dwordx4 v7, s[12:15], s25 offen offset:1024 lds
M a[76:79], a[180:183], a[188:191], a[76:79]
s_waitcnt lgkmcnt(10)
M a[80:83], a[164:167], a[196:199], a[80:83]
ds_read_b128 a[220:223], v10 offset:14336
ds_read_b128 a[224:227], v11 offset:14336
M a[80:83], a[168:171], a[200:203], a[80:83]
buffer_load_dwordx4 v8, s[12:15], s25 offen offset:2048 lds
M a[84:87], a[176:179], a[200:203], a[84:87]
ds_read_b64_tr_b16 a[152:153], v15 offset:12288
ds_read_b64_tr_b16 a[154:155], v15 offset:13824
M a[84:87], a[172:175], a[196:199], a[84:87]
M a[88:91], a[180:183], a[196:199], a[88:91]
buffer_load_dwordx4 v9, s[12:15], s25 offen offset:3072 lds
M a[88:91], a[184:187], a[200:203], a[88:91]
s_waitcnt lgkmcnt(10)
M a[92:95], a[168:171], a[208:211], a[92:95]
ds_read_b128 a[228:231], v10 offset:16384
ds_read_b128 a[232:235], v11 offset:16384
M a[92:95], a[164:167], a[204:207], a[92:95]
s_add_u32 m0, s30, 102400
s_nop 0
buffer_load_dwordx4 v21, s[12:15], s25 offen offset:0 lds
M a[96:99], a[172:175], a[204:207], a[96:99]
ds_read_b64_tr_b16 a[160:161], v16 offset:12288
ds_read_b64_tr_b16 a[162:163], v16 offset:13824
M a[96:99], a[176:179], a[208:211], a[96:99]
M a[100:103], a[184:187], a[208:211], a[100:103]
buffer_load_dwordx4 v22, s[12:15], s25 offen offset:1024 lds
M a[100:103], a[180:183], a[204:207], a[100:103]
s_waitcnt lgkmcnt(10)
M a[104:107], a[164:167], a[212:215], a[104:107]
s_sub_u32 s54, s54, 1
s_cmp_eq_u32 s54, 0
s_cselect_b32 s58, s55, s56
s_add_u32 s25, s25, s58
M a[104:107], a[168:171], a[216:219], a[104:107]
M a[108:111], a[176:179], a[216:219], a[108:111]
M a[108:111], a[172:175], a[212:215], a[108:111]
M a[112:115], a[180:183], a[212:215], a[112:115]
s_waitcnt vmcnt(15) lgkmcnt(0)
s_barrier
ds_read_b128 a[188:191], v10 offset:18432
ds_read_b128 a[192:195], v11 offset:18432
M a[112:115], a[184:187], a[216:219], a[112:115]
s_add_u32 s94, s93, 12288
buffer_store_dwordx4 v[36:39], v1, s[16:19], s94 offen offset:0 sc1
M a[116:119], a[168:171], a[224:227], a[116:119]
ds_read_b128 a[196:199], v10 offset:20480
ds_read_b128 a[200:203], v11 offset:20480
M a[116:119], a[164:167], a[220:223], a[116:119]
M a[120:123], a[172:175], a[220:223], a[120:123]
s_add_u32 s94, s93, 12288
buffer_store_dwordx4 v[44:47], v1, s[16:19], s94 offen offset:1024 sc1
M a[120:123], a[176:179], a[224:227], a[120:123]
M a[124:127], a[184:187], a[224:227], a[124:127]
M a[124:127], a[180:183], a[220:223], a[124:127]
s_add_u32 s94, s93, 12288
buffer_store_dwordx4 v[52:55], v1, s[16:19], s94 offen offset:2048 sc1
M a[128:131], a[164:167], a[228:231], a[128:131]
ds_read_b128 a[204:207], v10 offset:22528
ds_read_b128 a[208:211], v11 offset:22528
M a[128:131], a[168:171], a[232:235], a[128:131]
M a[132:135], a[176:179], a[232:235], a[132:135]
M a[132:135], a[172:175], a[228:231], a[132:135]
s_add_u32 s94, s93, 12288
buffer_store_dwordx4 v[60:63], v1, s[16:19], s94 offen offset:3072 sc1
M a[136:139], a[180:183], a[228:231], a[136:139]
M a[136:139], a[184:187], a[232:235], a[136:139]
s_waitcnt lgkmcnt(4)
M a[32:35], a[140:143], a[188:191], a[32:35]
ds_read_b128 a[212:215], v10 offset:24576
ds_read_b128 a[216:219], v11 offset:24576
M a[32:35], a[144:147], a[192:195], a[32:35]
s_add_u32 m0, s28, 0
s_mov_b32 exec_hi, 0
buffer_load_dwordx4 v20, s[8:11], s24 offen lds
s_mov_b32 exec_hi, -1
M a[36:39], a[152:155], a[192:195], a[36:39]
ds_read_b64_tr_b16 a[164:165], v14 offset:28672
ds_read_b64_tr_b16 a[166:167], v14 offset:30208
M a[36:39], a[148:151], a[188:191], a[36:39]
M a[40:43], a[156:159], a[188:191], a[40:43]
s_add_u32 m0, s29, 2048
s_nop 0
buffer_load_dwordx4 v2, s[8:11], s23 offen offset:0 lds
M a[40:43], a[160:163], a[192:195], a[40:43]
s_waitcnt lgkmcnt(6)
M a[44:47], a[144:147], a[200:203], a[44:47]
ds_read_b128 a[220:223], v10 offset:26624
ds_read_b128 a[224:227], v11 offset:26624
M a[44:47], a[140:143], a[196:199], a[44:47]
buffer_load_dwordx4 v3, s[8:11], s23 offen offset:1024 lds
M a[48:51], a[148:151], a[196:199], a[48:51]
ds_read_b64_tr_b16 a[172:173], v15 offset:28672
ds_read_b64_tr_b16 a[174:175], v15 offset:30208
M a[48:51], a[152:155], a[200:203], a[48:51]
M a[52:55], a[160:163], a[200:203], a[52:55]
buffer_load_dwordx4 v4, s[8:11], s23 offen offset:2048 lds
M a[52:55], a[156:159], a[196:199], a[52:55]
s_waitcnt lgkmcnt(8)
M a[56:59], a[140:143], a[204:207], a[56:59]
ds_read_b128 a[228:231], v10 offset:28672
ds_read_b128 a[232:235], v11 offset:28672
M a[56:59], a[144:147], a[208:211], a[56:59]
buffer_load_dwordx4 v5, s[8:11], s23 offen offset:3072 lds
M a[60:63], a[152:155], a[208:211], a[60:63]
ds_read_b64_tr_b16 a[180:181], v16 offset:28672
ds_read_b64_tr_b16 a[182:183], v16 offset:30208
M a[60:63], a[148:151], a[204:207], a[60:63]
M a[64:67], a[156:159], a[204:207], a[64:67]
s_sub_u32 s31, s31, 1
s_cmp_eq_u32 s31, 0
s_cselect_b32 s58, -1920, s57
s_add_u32 s23, s23, s58
s_add_u32 s24, s24, s58
M a[64:67], a[160:163], a[208:211], a[64:67]
s_waitcnt lgkmcnt(10)
M a[68:71], a[144:147], a[216:219], a[68:71]
ds_read_b128 a[188:191], v10 offset:30720
ds_read_b128 a[192:195], v11 offset:30720
M a[68:71], a[140:143], a[212:215], a[68:71]
s_add_u32 m0, s30, 36864
s_nop 0
buffer_load_dwordx4 v6, s[12:15], s25 offen offset:0 lds
M a[72:75], a[148:151], a[212:215], a[72:75]
ds_read_b64_tr_b16 a[168:169], v14 offset:40960
ds_read_b64_tr_b16 a[170:171], v14 offset:42496
M a[72:75], a[152:155], a[216:219], a[72:75]
M a[76:79], a[160:163], a[216:219], a[76:79]
buffer_load_dwordx4 v7, s[12:15], s25 offen offset:1024 lds
M a[76:79], a[156:159], a[212:215], a[76:79]
s_waitcnt lgkmcnt(10)
M a[80:83], a[140:143], a[220:223], a[80:83]
ds_read_b128 a[196:199], v10 offset:32768
ds_read_b128 a[200:203], v11 offset:32768
M a[80:83], a[144:147], a[224:227], a[80:83]
buffer_load_dwordx4 v8, s[12:15], s25 offen offset:2048 lds
M a[84:87], a[152:155], a[224:227], a[84:87]
ds_read_b64_tr_b16 a[176:177], v15 offset:40960
ds_read_b64_tr_b16 a[178:179], v15 offset:42496
M a[84:87], a[148:151], a[220:223], a[84:87]
M a[88:91], a[156:159], a[220:223], a[88:91]
buffer_load_dwordx4 v9, s[12:15], s25 offen offset:3072 lds
M a[88:91], a[160:163], a[224:227], a[88:91]
s_waitcnt lgkmcnt(10)
M a[92:95], a[144:147], a[232:235], a[92:95]
ds_read_b128 a[204:207], v10 offset:34816
ds_read_b128 a[208:211], v11 offset:34816
M a[92:95], a[140:143], a[228:231], a[92:95]
s_add_u32 m0, s30, 40960
s_nop 0
buffer_load_dwordx4 v21, s[12:15], s25 offen offset:0 lds
M a[96:99], a[148:151], a[228:231], a[96:99]
ds_read_b64_tr_b16 a[184:185], v16 offset:40960
ds_read_b64_tr_b16 a[186:187], v16 offset:42496
M a[96:99], a[152:155], a[232:235], a[96:99]
M a[100:103], a[160:163], a[232:235], a[100:103]
buffer_load_dwordx4 v22, s[12:15], s25 offen offset:1024 lds
M a[100:103], a[156:159], a[228:231], a[100:103]
s_waitcnt lgkmcnt(10)
M a[104:107], a[140:143], a[188:191], a[104:107]
s_sub_u32 s54, s54, 1
s_cmp_eq_u32 s54, 0
s_cselect_b32 s58, s55, s56
s_add_u32 s25, s25, s58
M a[104:107], a[144:147], a[192:195], a[104:107]
M a[108:111], a[152:155], a[192:195], a[108:111]
M a[108:111], a[148:151], a[188:191], a[108:111]
M a[112:115], a[156:159], a[188:191], a[112:115]
s_waitcnt vmcnt(15) lgkmcnt(0)
s_barrier
ds_read_b128 a[212:215], v12 offset:0
ds_read_b128 a[216:219], v13 offset:0
M a[112:115], a[160:163], a[192:195], a[112:115]
s_add_u32 m0, s28, 18432
s_mov_b32 exec_hi, 0
buffer_load_dwordx4 v20, s[8:11], s24 offen lds
s_mov_b32 exec_hi, -1
M a[116:119], a[144:147], a[200:203], a[116:119]
ds_read_b128 a[220:223], v12 offset:2048
ds_read_b128 a[224:227], v13 offset:2048
M a[116:119], a[140:143], a[196:199], a[116:119]
M a[120:123], a[148:151], a[196:199], a[120:123]
s_add_u32 m0, s29, 20480
s_nop 0
buffer_load_dwordx4 v2, s[8:11], s23 offen offset:0 lds
M a[120:123], a[152:155], a[200:203], a[120:123]
M a[124:127], a[160:163], a[200:203], a[124:127]
M a[124:127], a[156:159], a[196:199], a[124:127]
buffer_load_dwordx4 v3, s[8:11], s23 offen offset:1024 lds
M a[128:131], a[140:143], a[204:207], a[128:131]
ds_read_b128 a[228:231], v12 offset:4096
ds_read_b128 a[232:235], v13 offset:4096
M a[128:131], a[144:147], a[208:211], a[128:131]
M a[132:135], a[152:155], a[208:211], a[132:135]
M a[132:135], a[148:151], a[204:207], a[132:135]
buffer_load_dwordx4 v4, s[8:11], s23 offen offset:2048 lds
M a[136:139], a[156:159], a[204:207], a[136:139]
M a[136:139], a[160:163], a[208:211], a[136:139]
s_waitcnt lgkmcnt(4)
M a[32:35], a[164:167], a[212:215], a[32:35]
ds_read_b128 a[188:191], v12 offset:6144
ds_read_b128 a[192:195], v13 offset:6144
M a[32:35], a[168:171], a[216:219], a[32:35]
buffer_load_dwordx4 v5, s[8:11], s23 offen offset:3072 lds
M a[36:39], a[176:179], a[216:219], a[36:39]
ds_read_b64_tr_b16 a[140:141], v17 offset:0
ds_read_b64_tr_b16 a[142:143], v17 offset:1536
M a[36:39], a[172:175], a[212:215], a[36:39]
M a[40:43], a[180:183], a[212:215], a[40:43]
M a[40:43], a[184:187], a[216:219], a[40:43]
s_sub_u32 s31, s31, 1
s_cmp_eq_u32 s31, 0
s_cselect_b32 s58, -1920, s57
s_add_u32 s23, s23, s58
s_add_u32 s24, s24, s58
s_waitcnt lgkmcnt(6)
M a[44:47], a[168:171], a[224:227], a[44:47]
ds_read_b128 a[196:199], v12 offset:8192
ds_read_b128 a[200:203], v13 offset:8192
M a[44:47], a[164:167], a[220:223], a[44:47]
M a[48:51], a[172:175], a[220:223], a[48:51]
ds_read_b64_tr_b16 a[148:149], v18 offset:0
ds_read_b64_tr_b16 a[150:151], v18 offset:1536
M a[48:51], a[176:179], a[224:227], a[48:51]
M a[52:55], a[184:187], a[224:227], a[52:55]
s_add_u32 m0, s30, 65536
s_nop 0
buffer_load_dwordx4 v6, s[12:15], s25 offen offset:0 lds
M a[52:55], a[180:183], a[220:223], a[52:55]
s_waitcnt lgkmcnt(8)
M a[56:59], a[164:167], a[228:231], a[56:59]
ds_read_b128 a[204:207], v12 offset:10240
ds_read_b128 a[208:211], v13 offset:10240
M a[56:59], a[168:171], a[232:235], a[56:59]
M a[60:63], a[176:179], a[232:235], a[60:63]
ds_read_b64_tr_b16 a[156:157], v19 offset:0
ds_read_b64_tr_b16 a[158:159], v19 offset:1536
M a[60:63], a[172:175], a[228:231], a[60:63]
buffer_load_dwordx4 v7, s[12:15], s25 offen offset:1024 lds
M a[64:67], a[180:183], a[228:231], a[64:67]
M a[64:67], a[184:187], a[232:235], a[64:67]
s_waitcnt lgkmcnt(10)
M a[68:71], a[168:171], a[192:195], a[68:71]
ds_read_b128 a[212:215], v12 offset:12288
ds_read_b128 a[216:219], v13 offset:12288
M a[68:71], a[164:167], a[188:191], a[68:71]
buffer_load_dwordx4 v8, s[12:15], s25 offen offset:2048 lds
M a[72:75], a[172:175], a[188:191], a[72:75]
ds_read_b64_tr_b16 a[144:145], v17 offset:12288
ds_read_b64_tr_b16 a[146:147], v17 offset:13824
M a[72:75], a[176:179], a[192:195], a[72:75]
M a[76:79], a[184:187], a[192:195], a[76:79]
M a[76:79], a[180:183], a[188:191], a[76:79]
buffer_load_dwordx4 v9, s[12:15], s25 offen offset:3072 lds
s_waitcnt lgkmcnt(10)
M a[80:83], a[164:167], a[196:199], a[80:83]
ds_read_b128 a[220:223], v12 offset:14336
ds_read_b128 a[224:227], v13 offset:14336
M a[80:83], a[168:171], a[200:203], a[80:83]
M a[84:87], a[176:179], a[200:203], a[84:87]
ds_read_b64_tr_b16 a[152:153], v18 offset:12288
ds_read_b64_tr_b16 a[154:155], v18 offset:13824
M a[84:87], a[172:175], a[196:199], a[84:87]
M a[88:91], a[180:183], a[196:199], a[88:91]
s_add_u32 m0, s30, 69632
s_nop 0
buffer_load_dwordx4 v21, s[12:15], s25 offen offset:0 lds
M a[88:91], a[184:187], a[200:203], a[88:91]
s_waitcnt lgkmcnt(10)
M a[92:95], a[168:171], a[208:211], a[92:95]
ds_read_b128 a[228:231], v12 offset:16384
ds_read_b128 a[232:235], v13 offset:16384
M a[92:95], a[164:167], a[204:207], a[92:95]
M a[96:99], a[172:175], a[204:207], a[96:99]
ds_read_b64_tr_b16 a[160:161], v19 offset:12288
ds_read_b64_tr_b16 a[162:163], v19 offset:13824
M a[96:99], a[176:179], a[208:211], a[96:99]
buffer_load_dwordx4 v22, s[12:15], s25 offen offset:1024 lds
M a[100:103], a[184:187], a[208:211], a[100:103]
M a[100:103], a[180:183], a[204:207], a[100:103]
s_waitcnt lgkmcnt(10)
M a[104:107], a[164:167], a[212:215], a[104:107]
s_sub_u32 s54, s54, 1
s_cmp_eq_u32 s54, 0
s_cselect_b32 s58, s55, s56
s_add_u32 s25, s25, s58
M a[104:107], a[168:171], a[216:219], a[104:107]
M a[108:111], a[176:179], a[216:219], a[108:111]
M a[108:111], a[172:175], a[212:215], a[108:111]
M a[112:115], a[180:183], a[212:215], a[112:115]
s_waitcnt vmcnt(11) lgkmcnt(0)
s_barrier
ds_read_b128 a[188:191], v10 offset:0
ds_read_b128 a[192:195], v11 offset:0
M a[112:115], a[184:187], a[216:219], a[112:115]
s_add_u32 m0, s28, 131072
s_mov_b32 exec_hi, 0
buffer_load_dwordx4 v20, s[8:11], s24 offen lds
s_mov_b32 exec_hi, -1
M a[116:119], a[168:171], a[224:227], a[116:119]
ds_read_b128 a[196:199], v10 offset:2048
ds_read_b128 a[200:203], v11 offset:2048
M a[116:119], a[164:167], a[220:223], a[116:119]
M a[120:123], a[172:175], a[220:223], a[120:123]
s_add_u32 m0, s29, 133120
s_nop 0
buffer_load_dwordx4 v2, s[8:11], s23 offen offset:0 lds
M a[120:123], a[176:179], a[224:227], a[120:123]
M a[124:127], a[184:187], a[224:227], a[124:127]
M a[124:127], a[180:183], a[220:223], a[124:127]
buffer_load_dwordx4 v3, s[8:11], s23 offen offset:1024 lds
M a[128:131], a[164:167], a[228:231], a[128:131]
ds_read_b128 a[204:207], v10 offset:4096
ds_read_b128 a[208:211], v11 offset:4096
M a[128:131], a[168:171], a[232:235], a[128:131]
M a[132:135], a[176:179], a[232:235], a[132:135]
M a[132:135], a[172:175], a[228:231], a[132:135]
buffer_load_dwordx4 v4, s[8:11], s23 offen offset:2048 lds
M a[136:139], a[180:183], a[228:231], a[136:139]
M a[136:139], a[184:187], a[232:235], a[136:139]
s_waitcnt lgkmcnt(4)
M a[32:35], a[140:143], a[188:191], a[32:35]
ds_read_b128 a[212:215], v10 offset:6144
ds_read_b128 a[216:219], v11 offset:6144
M a[32:35], a[144:147], a[192:195], a[32:35]
buffer_load_dwordx4 v5, s[8:11], s23 offen offset:3072 lds
M a[36:39], a[152:155], a[192:195], a[36:39]
ds_read_b64_tr_b16 a[164:165], v14 offset:0
ds_read_b64_tr_b16 a[166:167], v14 offset:1536
M a[36:39], a[148:151], a[188:191], a[36:39]
M a[40:43], a[156:159], a[188:191], a[40:43]
M a[40:43], a[160:163], a[192:195], a[40:43]
s_sub_u32 s31, s31, 1
s_cmp_eq_u32 s31, 0
s_cselect_b32 s58, -1920, s57
s_add_u32 s23, s23, s58
s_add_u32 s24, s24, s58
s_waitcnt lgkmcnt(6)
M a[44:47], a[144:147], a[200:203], a[44:47]
ds_read_b128 a[220:223], v10 offset:8192
ds_read_b128 a[224:227], v11 offset:8192
M a[44:47], a[140:143], a[196:199], a[44:47]
M a[48:51], a[148:151], a[196:199], a[48:51]
ds_read_b64_tr_b16 a[172:173], v15 offset:0
ds_read_b64_tr_b16 a[174:175], v15 offset:1536
M a[48:51], a[152:155], a[200:203], a[48:51]
M a[52:55], a[160:163], a[200:203], a[52:55]
s_add_u32 m0, s30, 98304
s_nop 0
buffer_load_dwordx4 v6, s[12:15], s25 offen offset:0 lds
M a[52:55], a[156:159], a[196:199], a[52:55]
s_waitcnt lgkmcnt(8)
M a[56:59], a[140:143], a[204:207], a[56:59]
ds_read_b128 a[228:231], v10 offset:10240
ds_read_b128 a[232:235], v11 offset:10240
M a[56:59], a[144:147], a[208:211], a[56:59]
M a[60:63], a[152:155], a[208:211], a[60:63]
ds_read_b64_tr_b16 a[180:181], v16 offset:0
ds_read_b64_tr_b16 a[182:183], v16 offset:1536
M a[60:63], a[148:151], a[204:207], a[60:63]
buffer_load_dwordx4 v7, s[12:15], s25 offen offset:1024 lds
M a[64:67], a[156:159], a[204:207], a[64:67]
M a[64:67], a[160:163], a[208:211], a[64:67]
s_waitcnt lgkmcnt(10)
M a[68:71], a[144:147], a[216:219], a[68:71]
ds_read_b128 a[188:191], v10 offset:12288
ds_read_b128 a[192:195], v11 offset:12288
M a[68:71], a[140:143], a[212:215], a[68:71]
buffer_load_dwordx4 v8, s[12:15], s25 offen offset:2048 lds
M a[72:75], a[148:151], a[212:215], a[72:75]
ds_read_b64_tr_b16 a[168:169], v14 offset:12288
ds_read_b64_tr_b16 a[170:171], v14 offset:13824
M a[72:75], a[152:155], a[216:219], a[72:75]
M a[76:79], a[160:163], a[216:219], a[76:79]
M a[76:79], a[156:159], a[212:215], a[76:79]
buffer_load_dwordx4 v9, s[12:15], s25 offen offset:3072 lds
s_waitcnt lgkmcnt(10)
M a[80:83], a[140:143], a[220:223], a[80:83]
ds_read_b128 a[196:199], v10 offset:14336
ds_read_b128 a[200:203], v11 offset:14336
M a[80:83], a[144:147], a[224:227], a[80:83]
M a[84:87], a[152:155], a[224:227], a[84:87]
ds_read_b64_tr_b16 a[176:177], v15 offset:12288
ds_read_b64_tr_b16 a[178:179], v15 offset:13824
M a[84:87], a[148:151], a[220:223], a[84:87]
M a[88:91], a[156:159], a[220:223], a[88:91]
s_add_u32 m0, s30, 102400
s_nop 0
buffer_load_dwordx4 v21, s[12:15], s25 offen offset:0 lds
M a[88:91], a[160:163], a[224:227], a[88:91]
s_waitcnt lgkmcnt(10)
M a[92:95], a[144:147], a[232:235], a[92:95]
ds_read_b128 a[204:207], v10 offset:16384
ds_read_b128 a[208:211], v11 offset:16384
M a[92:95], a[140:143], a[228:231], a[92:95]
M a[96:99], a[148:151], a[228:231], a[96:99]
ds_read_b64_tr_b16 a[184:185], v16 offset:12288
ds_read_b64_tr_b16 a[186:187], v16 offset:13824
M a[96:99], a[152:155], a[232:235], a[96:99]
buffer_load_dwordx4 v22, s[12:15], s25 offen offset:1024 lds
M a[100:103], a[160:163], a[232:235], a[100:103]
M a[100:103], a[156:159], a[228:231], a[100:103]
s_waitcnt lgkmcnt(10)
M a[104:107], a[140:143], a[188:191], a[104:107]
s_sub_u32 s54, s54, 1
s_cmp_eq_u32 s54, 0
s_cselect_b32 s58, s55, s56
s_add_u32 s25, s25, s58
M a[104:107], a[144:147], a[192:195], a[104:107]
M a[108:111], a[152:155], a[192:195], a[108:111]
M a[108:111], a[148:151], a[188:191], a[108:111]
M a[112:115], a[156:159], a[188:191], a[112:115]
s_waitcnt vmcnt(11) lgkmcnt(0)
s_barrier
ds_read_b128 a[212:215], v10 offset:18432
ds_read_b128 a[216:219], v11 offset:18432
s_cmp_lg_u32 s101, 0
s_cbranch_scc1 Lk1_arr
v_mov_b32 v23, 1
s_and_b32 s3, s2, 1
s_lshl_b32 s3, s3, 7
s_mov_b64 exec, 1
buffer_atomic_add v23, off, s[60:63], s3 sc1
s_mov_b64 exec, -1
Lk1_arr:
M a[112:115], a[160:163], a[192:195], a[112:115]
s_add_u32 m0, s28, 0
s_mov_b32 exec_hi, 0
buffer_load_dwordx4 v20, s[8:11], s24 offen lds
s_mov_b32 exec_hi, -1
M a[116:119], a[144:147], a[200:203], a[116:119]
ds_read_b128 a[220:223], v10 offset:20480
ds_read_b128 a[224:227], v11 offset:20480
M a[116:119], a[140:143], a[196:199], a[116:119]
M a[120:123], a[148:151], a[196:199], a[120:123]
s_add_u32 m0, s29, 2048
s_nop 0
buffer_load_dwordx4 v2, s[8:11], s23 offen offset:0 lds
M a[120:123], a[152:155], a[200:203], a[120:123]
M a[124:127], a[160:163], a[200:203], a[124:127]
M a[124:127], a[156:159], a[196:199], a[124:127]
buffer_load_dwordx4 v3, s[8:11], s23 offen offset:1024 lds
M a[128:131], a[140:143], a[204:207], a[128:131]
ds_read_b128 a[228:231], v10 offset:22528
ds_read_b128 a[232:235], v11 offset:22528
M a[128:131], a[144:147], a[208:211], a[128:131]
M a[132:135], a[152:155], a[208:211], a[132:135]
M a[132:135], a[148:151], a[204:207], a[132:135]
buffer_load_dwordx4 v4, s[8:11], s23 offen offset:2048 lds
M a[136:139], a[156:159], a[204:207], a[136:139]
M a[136:139], a[160:163], a[208:211], a[136:139]
s_waitcnt lgkmcnt(4)
M a[32:35], a[164:167], a[212:215], a[32:35]
ds_read_b128 a[188:191], v10 offset:24576
ds_read_b128 a[192:195], v11 offset:24576
M a[32:35], a[168:171], a[216:219], a[32:35]
buffer_load_dwordx4 v5, s[8:11], s23 offen offset:3072 lds
M a[36:39], a[176:179], a[216:219], a[36:39]
ds_read_b64_tr_b16 a[140:141], v14 offset:28672
ds_read_b64_tr_b16 a[142:143], v14 offset:30208
M a[36:39], a[172:175], a[212:215], a[36:39]
M a[40:43], a[180:183], a[212:215], a[40:43]
M a[40:43], a[184:187], a[216:219], a[40:43]
s_sub_u32 s31, s31, 1
s_cmp_eq_u32 s31, 0
s_cselect_b32 s58, -1920, s57
s_add_u32 s23, s23, s58
s_add_u32 s24, s24, s58
s_waitcnt lgkmcnt(6)
M a[44:47], a[168:171], a[224:227], a[44:47]
ds_read_b128 a[196:199], v10 offset:26624
ds_read_b128 a[200:203], v11 offset:26624
M a[44:47], a[164:167], a[220:223], a[44:47]
M a[48:51], a[172:175], a[220:223], a[48:51]
ds_read_b64_tr_b16 a[148:149], v15 offset:28672
ds_read_b64_tr_b16 a[150:151], v15 offset:30208
M a[48:51], a[176:179], a[224:227], a[48:51]
M a[52:55], a[184:187], a[224:227], a[52:55]
s_add_u32 m0, s30, 36864
s_nop 0
buffer_load_dwordx4 v6, s[12:15], s25 offen offset:0 lds
M a[52:55], a[180:183], a[220:223], a[52:55]
s_waitcnt lgkmcnt(8)
M a[56:59], a[164:167], a[228:231], a[56:59]
ds_read_b128 a[204:207], v10 offset:28672
ds_read_b128 a[208:211], v11 offset:28672
M a[56:59], a[168:171], a[232:235], a[56:59]
M a[60:63], a[176:179], a[232:235], a[60:63]
ds_read_b64_tr_b16 a[156:157], v16 offset:28672
ds_read_b64_tr_b16 a[158:159], v16 offset:30208
M a[60:63], a[172:175], a[228:231], a[60:63]
buffer_load_dwordx4 v7, s[12:15], s25 offen offset:1024 lds
M a[64:67], a[180:183], a[228:231], a[64:67]
M a[64:67], a[184:187], a[232:235], a[64:67]
s_waitcnt lgkmcnt(10)
M a[68:71], a[168:171], a[192:195], a[68:71]
ds_read_b128 a[212:215], v10 offset:30720
ds_read_b128 a[216:219], v11 offset:30720
M a[68:71], a[164:167], a[188:191], a[68:71]
buffer_load_dwordx4 v8, s[12:15], s25 offen offset:2048 lds
M a[72:75], a[172:175], a[188:191], a[72:75]
ds_read_b64_tr_b16 a[144:145], v14 offset:40960
ds_read_b64_tr_b16 a[146:147], v14 offset:42496
M a[72:75], a[176:179], a[192:195], a[72:75]
M a[76:79], a[184:187], a[192:195], a[76:79]
M a[76:79], a[180:183], a[188:191], a[76:79]
buffer_load_dwordx4 v9, s[12:15], s25 offen offset:3072 lds
s_waitcnt lgkmcnt(10)
M a[80:83], a[164:167], a[196:199], a[80:83]
ds_read_b128 a[220:223], v10 offset:32768
ds_read_b128 a[224:227], v11 offset:32768
M a[80:83], a[168:171], a[200:203], a[80:83]
M a[84:87], a[176:179], a[200:203], a[84:87]
ds_read_b64_tr_b16 a[152:153], v15 offset:40960
ds_read_b64_tr_b16 a[154:155], v15 offset:42496
M a[84:87], a[172:175], a[196:199], a[84:87]
M a[88:91], a[180:183], a[196:199], a[88:91]
s_add_u32 m0, s30, 40960
s_nop 0
buffer_load_dwordx4 v21, s[12:15], s25 offen offset:0 lds
M a[88:91], a[184:187], a[200:203], a[88:91]
s_waitcnt lgkmcnt(10)
M a[92:95], a[168:171], a[208:211], a[92:95]
ds_read_b128 a[228:231], v10 offset:34816
ds_read_b128 a[232:235], v11 offset:34816
M a[92:95], a[164:167], a[204:207], a[92:95]
M a[96:99], a[172:175], a[204:207], a[96:99]
ds_read_b64_tr_b16 a[160:161], v16 offset:40960
ds_read_b64_tr_b16 a[162:163], v16 offset:42496
M a[96:99], a[176:179], a[208:211], a[96:99]
buffer_load_dwordx4 v22, s[12:15], s25 offen offset:1024 lds
M a[100:103], a[184:187], a[208:211], a[100:103]
M a[100:103], a[180:183], a[204:207], a[100:103]
s_waitcnt lgkmcnt(10)
M a[104:107], a[164:167], a[212:215], a[104:107]
s_sub_u32 s54, s54, 1
s_cmp_eq_u32 s54, 0
s_cselect_b32 s58, s55, s56
s_add_u32 s25, s25, s58
M a[104:107], a[168:171], a[216:219], a[104:107]
M a[108:111], a[176:179], a[216:219], a[108:111]
M a[108:111], a[172:175], a[212:215], a[108:111]
M a[112:115], a[180:183], a[212:215], a[112:115]
s_waitcnt vmcnt(11) lgkmcnt(0)
s_barrier
ds_read_b128 a[188:191], v12 offset:0
ds_read_b128 a[192:195], v13 offset:0
M a[112:115], a[184:187], a[216:219], a[112:115]
s_add_u32 m0, s28, 18432
s_mov_b32 exec_hi, 0
buffer_load_dwordx4 v20, s[8:11], s24 offen lds
s_mov_b32 exec_hi, -1
M a[116:119], a[168:171], a[224:227], a[116:119]
ds_read_b128 a[196:199], v12 offset:2048
ds_read_b128 a[200:203], v13 offset:2048
M a[116:119], a[164:167], a[220:223], a[116:119]
M a[120:123], a[172:175], a[220:223], a[120:123]
s_add_u32 m0, s29, 20480
s_nop 0
buffer_load_dwordx4 v2, s[8:11], s23 offen offset:0 lds
M a[120:123], a[176:179], a[224:227], a[120:123]
M a[124:127], a[184:187], a[224:227], a[124:127]
M a[124:127], a[180:183], a[220:223], a[124:127]
buffer_load_dwordx4 v3, s[8:11], s23 offen offset:1024 lds
M a[128:131], a[164:167], a[228:231], a[128:131]
ds_read_b128 a[204:207], v12 offset:4096
ds_read_b128 a[208:211], v13 offset:4096
M a[128:131], a[168:171], a[232:235], a[128:131]
M a[132:135], a[176:179], a[232:235], a[132:135]
M a[132:135], a[172:175], a[228:231], a[132:135]
buffer_load_dwordx4 v4, s[8:11], s23 offen offset:2048 lds
M a[136:139], a[180:183], a[228:231], a[136:139]
M a[136:139], a[184:187], a[232:235], a[136:139]
s_waitcnt lgkmcnt(4)
M a[32:35], a[140:143], a[188:191], a[32:35]
ds_read_b128 a[212:215], v12 offset:6144
ds_read_b128 a[216:219], v13 offset:6144
M a[32:35], a[144:147], a[192:195], a[32:35]
buffer_load_dwordx4 v5, s[8:11], s23 offen offset:3072 lds
M a[36:39], a[152:155], a[192:195], a[36:39]
ds_read_b64_tr_b16 a[164:165], v17 offset:0
ds_read_b64_tr_b16 a[166:167], v17 offset:1536
M a[36:39], a[148:151], a[188:191], a[36:39]
M a[40:43], a[156:159], a[188:191], a[40:43]
M a[40:43], a[160:163], a[192:195], a[40:43]
s_sub_u32 s31, s31, 1
s_cmp_eq_u32 s31, 0
s_cselect_b32 s58, -1920, s57
s_add_u32 s23, s23, s58
s_add_u32 s24, s24, s58
s_waitcnt lgkmcnt(6)
M a[44:47], a[144:147], a[200:203], a[44:47]
ds_read_b128 a[220:223], v12 offset:8192
ds_read_b128 a[224:227], v13 offset:8192
M a[44:47], a[140:143], a[196:199], a[44:47]
M a[48:51], a[148:151], a[196:199], a[48:51]
ds_read_b64_tr_b16 a[172:173], v18 offset:0
ds_read_b64_tr_b16 a[174:175], v18 offset:1536
M a[48:51], a[152:155], a[200:203], a[48:51]
M a[52:55], a[160:163], a[200:203], a[52:55]
s_add_u32 m0, s30, 65536
s_nop 0
buffer_load_dwordx4 v6, s[12:15], s25 offen offset:0 lds
M a[52:55], a[156:159], a[196:199], a[52:55]
s_waitcnt lgkmcnt(8)
M a[56:59], a[140:143], a[204:207], a[56:59]
ds_read_b128 a[228:231], v12 offset:10240
ds_read_b128 a[232:235], v13 offset:10240
M a[56:59], a[144:147], a[208:211], a[56:59]
M a[60:63], a[152:155], a[208:211], a[60:63]
ds_read_b64_tr_b16 a[180:181], v19 offset:0
ds_read_b64_tr_b16 a[182:183], v19 offset:1536
M a[60:63], a[148:151], a[204:207], a[60:63]
buffer_load_dwordx4 v7, s[12:15], s25 offen offset:1024 lds
M a[64:67], a[156:159], a[204:207], a[64:67]
M a[64:67], a[160:163], a[208:211], a[64:67]
s_waitcnt lgkmcnt(10)
M a[68:71], a[144:147], a[216:219], a[68:71]
ds_read_b128 a[188:191], v12 offset:12288
ds_read_b128 a[192:195], v13 offset:12288
M a[68:71], a[140:143], a[212:215], a[68:71]
buffer_load_dwordx4 v8, s[12:15], s25 offen offset:2048 lds
M a[72:75], a[148:151], a[212:215], a[72:75]
ds_read_b64_tr_b16 a[168:169], v17 offset:12288
ds_read_b64_tr_b16 a[170:171], v17 offset:13824
M a[72:75], a[152:155], a[216:219], a[72:75]
M a[76:79], a[160:163], a[216:219], a[76:79]
M a[76:79], a[156:159], a[212:215], a[76:79]
buffer_load_dwordx4 v9, s[12:15], s25 offen offset:3072 lds
s_waitcnt lgkmcnt(10)
M a[80:83], a[140:143], a[220:223], a[80:83]
ds_read_b128 a[196:199], v12 offset:14336
ds_read_b128 a[200:203], v13 offset:14336
M a[80:83], a[144:147], a[224:227], a[80:83]
M a[84:87], a[152:155], a[224:227], a[84:87]
ds_read_b64_tr_b16 a[176:177], v18 offset:12288
ds_read_b64_tr_b16 a[178:179], v18 offset:13824
M a[84:87], a[148:151], a[220:223], a[84:87]
M a[88:91], a[156:159], a[220:223], a[88:91]
s_add_u32 m0, s30, 69632
s_nop 0
buffer_load_dwordx4 v21, s[12:15], s25 offen offset:0 lds
M a[88:91], a[160:163], a[224:227], a[88:91]
s_waitcnt lgkmcnt(10)
M a[92:95], a[144:147], a[232:235], a[92:95]
ds_read_b128 a[204:207], v12 offset:16384
ds_read_b128 a[208:211], v13 offset:16384
M a[92:95], a[140:143], a[228:231], a[92:95]
M a[96:99], a[148:151], a[228:231], a[96:99]
ds_read_b64_tr_b16 a[184:185], v19 offset:12288
ds_read_b64_tr_b16 a[186:187], v19 offset:13824
M a[96:99], a[152:155], a[232:235], a[96:99]
buffer_load_dwordx4 v22, s[12:15], s25 offen offset:1024 lds
M a[100:103], a[160:163], a[232:235], a[100:103]
M a[100:103], a[156:159], a[228:231], a[100:103]
s_waitcnt lgkmcnt(10)
M a[104:107], a[140:143], a[188:191], a[104:107]
s_sub_u32 s54, s54, 1
s_cmp_eq_u32 s54, 0
s_cselect_b32 s58, s55, s56
s_add_u32 s25, s25, s58
M a[104:107], a[144:147], a[192:195], a[104:107]
M a[108:111], a[152:155], a[192:195], a[108:111]
M a[108:111], a[148:151], a[188:191], a[108:111]
M a[112:115], a[156:159], a[188:191], a[112:115]
s_waitcnt vmcnt(11) lgkmcnt(0)
s_barrier
ds_read_b128 a[212:215], v10 offset:0
ds_read_b128 a[216:219], v11 offset:0
M a[112:115], a[160:163], a[192:195], a[112:115]
s_add_u32 m0, s28, 131072
s_mov_b32 exec_hi, 0
buffer_load_dwordx4 v20, s[8:11], s24 offen lds
s_mov_b32 exec_hi, -1
M a[116:119], a[144:147], a[200:203], a[116:119]
ds_read_b128 a[220:223], v10 offset:2048
ds_read_b128 a[224:227], v11 offset:2048
M a[116:119], a[140:143], a[196:199], a[116:119]
M a[120:123], a[148:151], a[196:199], a[120:123]
s_add_u32 m0, s29, 133120
s_nop 0
buffer_load_dwordx4 v2, s[8:11], s23 offen offset:0 lds
M a[120:123], a[152:155], a[200:203], a[120:123]
M a[124:127], a[160:163], a[200:203], a[124:127]
M a[124:127], a[156:159], a[196:199], a[124:127]
buffer_load_dwordx4 v3, s[8:11], s23 offen offset:1024 lds
M a[128:131], a[140:143], a[204:207], a[128:131]
ds_read_b128 a[228:231], v10 offset:4096
ds_read_b128 a[232:235], v11 offset:4096
M a[128:131], a[144:147], a[208:211], a[128:131]
M a[132:135], a[152:155], a[208:211], a[132:135]
M a[132:135], a[148:151], a[204:207], a[132:135]
buffer_load_dwordx4 v4, s[8:11], s23 offen offset:2048 lds
M a[136:139], a[156:159], a[204:207], a[136:139]
M a[136:139], a[160:163], a[208:211], a[136:139]
s_waitcnt lgkmcnt(4)
M a[32:35], a[164:167], a[212:215], a[32:35]
ds_read_b128 a[188:191], v10 offset:6144
ds_read_b128 a[192:195], v11 offset:6144
M a[32:35], a[168:171], a[216:219], a[32:35]
buffer_load_dwordx4 v5, s[8:11], s23 offen offset:3072 lds
M a[36:39], a[176:179], a[216:219], a[36:39]
ds_read_b64_tr_b16 a[140:141], v14 offset:0
ds_read_b64_tr_b16 a[142:143], v14 offset:1536
M a[36:39], a[172:175], a[212:215], a[36:39]
M a[40:43], a[180:183], a[212:215], a[40:43]
M a[40:43], a[184:187], a[216:219], a[40:43]
s_waitcnt lgkmcnt(6)
M a[44:47], a[168:171], a[224:227], a[44:47]
ds_read_b128 a[196:199], v10 offset:8192
ds_read_b128 a[200:203], v11 offset:8192
M a[44:47], a[164:167], a[220:223], a[44:47]
M a[48:51], a[172:175], a[220:223], a[48:51]
ds_read_b64_tr_b16 a[148:149], v15 offset:0
ds_read_b64_tr_b16 a[150:151], v15 offset:1536
M a[48:51], a[176:179], a[224:227], a[48:51]
M a[52:55], a[184:187], a[224:227], a[52:55]
M a[52:55], a[180:183], a[220:223], a[52:55]
s_waitcnt lgkmcnt(8)
M a[56:59], a[164:167], a[228:231], a[56:59]
ds_read_b128 a[204:207], v10 offset:10240
ds_read_b128 a[208:211], v11 offset:10240
M a[56:59], a[168:171], a[232:235], a[56:59]
M a[60:63], a[176:179], a[232:235], a[60:63]
ds_read_b64_tr_b16 a[156:157], v16 offset:0
ds_read_b64_tr_b16 a[158:159], v16 offset:1536
M a[60:63], a[172:175], a[228:231], a[60:63]
M a[64:67], a[180:183], a[228:231], a[64:67]
M a[64:67], a[184:187], a[232:235], a[64:67]
s_waitcnt lgkmcnt(10)
M a[68:71], a[168:171], a[192:195], a[68:71]
ds_read_b128 a[212:215], v10 offset:12288
ds_read_b128 a[216:219], v11 offset:12288
M a[68:71], a[164:167], a[188:191], a[68:71]
M a[72:75], a[172:175], a[188:191], a[72:75]
ds_read_b64_tr_b16 a[144:145], v14 offset:12288
ds_read_b64_tr_b16 a[146:147], v14 offset:13824
M a[72:75], a[176:179], a[192:195], a[72:75]
s_sub_u32 s31, s31, 1
s_cmp_eq_u32 s31, 0
s_cselect_b32 s58, -1920, s57
s_add_u32 s23, s23, s58
s_add_u32 s24, s24, s58
M a[76:79], a[184:187], a[192:195], a[76:79]
M a[76:79], a[180:183], a[188:191], a[76:79]
s_waitcnt lgkmcnt(10)
M a[80:83], a[164:167], a[196:199], a[80:83]
ds_read_b128 a[220:223], v10 offset:14336
ds_read_b128 a[224:227], v11 offset:14336
M a[80:83], a[168:171], a[200:203], a[80:83]
M a[84:87], a[176:179], a[200:203], a[84:87]
ds_read_b64_tr_b16 a[152:153], v15 offset:12288
ds_read_b64_tr_b16 a[154:155], v15 offset:13824
M a[84:87], a[172:175], a[196:199], a[84:87]
M a[88:91], a[180:183], a[196:199], a[88:91]
M a[88:91], a[184:187], a[200:203], a[88:91]
s_waitcnt lgkmcnt(10)
M a[92:95], a[168:171], a[208:211], a[92:95]
ds_read_b128 a[228:231], v10 offset:16384
ds_read_b128 a[232:235], v11 offset:16384
M a[92:95], a[164:167], a[204:207], a[92:95]
M a[96:99], a[172:175], a[204:207], a[96:99]
ds_read_b64_tr_b16 a[160:161], v16 offset:12288
ds_read_b64_tr_b16 a[162:163], v16 offset:13824
M a[96:99], a[176:179], a[208:211], a[96:99]
M a[100:103], a[184:187], a[208:211], a[100:103]
M a[100:103], a[180:183], a[204:207], a[100:103]
s_waitcnt lgkmcnt(10)
M a[104:107], a[164:167], a[212:215], a[104:107]
M a[104:107], a[168:171], a[216:219], a[104:107]
M a[108:111], a[176:179], a[216:219], a[108:111]
M a[108:111], a[172:175], a[212:215], a[108:111]
M a[112:115], a[180:183], a[212:215], a[112:115]
s_waitcnt vmcnt(5) lgkmcnt(0)
s_barrier
ds_read_b128 a[188:191], v10 offset:18432
ds_read_b128 a[192:195], v11 offset:18432
M a[112:115], a[184:187], a[216:219], a[112:115]
M a[116:119], a[168:171], a[224:227], a[116:119]
ds_read_b128 a[196:199], v10 offset:20480
ds_read_b128 a[200:203], v11 offset:20480
M a[116:119], a[164:167], a[220:223], a[116:119]
M a[120:123], a[172:175], a[220:223], a[120:123]
M a[120:123], a[176:179], a[224:227], a[120:123]
M a[124:127], a[184:187], a[224:227], a[124:127]
M a[124:127], a[180:183], a[220:223], a[124:127]
M a[128:131], a[164:167], a[228:231], a[128:131]
ds_read_b128 a[204:207], v10 offset:22528
ds_read_b128 a[208:211], v11 offset:22528
M a[128:131], a[168:171], a[232:235], a[128:131]
M a[132:135], a[176:179], a[232:235], a[132:135]
M a[132:135], a[172:175], a[228:231], a[132:135]
M a[136:139], a[180:183], a[228:231], a[136:139]
M a[136:139], a[184:187], a[232:235], a[136:139]
s_waitcnt lgkmcnt(4)
M a[32:35], a[140:143], a[188:191], a[32:35]
ds_read_b128 a[212:215], v10 offset:24576
ds_read_b128 a[216:219], v11 offset:24576
M a[32:35], a[144:147], a[192:195], a[32:35]
M a[36:39], a[152:155], a[192:195], a[36:39]
ds_read_b64_tr_b16 a[164:165], v14 offset:28672
ds_read_b64_tr_b16 a[166:167], v14 offset:30208
M a[36:39], a[148:151], a[188:191], a[36:39]
M a[40:43], a[156:159], a[188:191], a[40:43]
M a[40:43], a[160:163], a[192:195], a[40:43]
s_waitcnt lgkmcnt(6)
M a[44:47], a[144:147], a[200:203], a[44:47]
ds_read_b128 a[220:223], v10 offset:26624
ds_read_b128 a[224:227], v11 offset:26624
M a[44:47], a[140:143], a[196:199], a[44:47]
M a[48:51], a[148:151], a[196:199], a[48:51]
ds_read_b64_tr_b16 a[172:173], v15 offset:28672
ds_read_b64_tr_b16 a[174:175], v15 offset:30208
M a[48:51], a[152:155], a[200:203], a[48:51]
M a[52:55], a[160:163], a[200:203], a[52:55]
M a[52:55], a[156:159], a[196:199], a[52:55]
s_waitcnt lgkmcnt(8)
M a[56:59], a[140:143], a[204:207], a[56:59]
ds_read_b128 a[228:231], v10 offset:28672
ds_read_b128 a[232:235], v11 offset:28672
M a[56:59], a[144:147], a[208:211], a[56:59]
M a[60:63], a[152:155], a[208:211], a[60:63]
ds_read_b64_tr_b16 a[180:181], v16 offset:28672
ds_read_b64_tr_b16 a[182:183], v16 offset:30208
M a[60:63], a[148:151], a[204:207], a[60:63]
M a[64:67], a[156:159], a[204:207], a[64:67]
M a[64:67], a[160:163], a[208:211], a[64:67]
s_waitcnt lgkmcnt(10)
M a[68:71], a[144:147], a[216:219], a[68:71]
ds_read_b128 a[188:191], v10 offset:30720
ds_read_b128 a[192:195], v11 offset:30720
M a[68:71], a[140:143], a[212:215], a[68:71]
M a[72:75], a[148:151], a[212:215], a[72:75]
ds_read_b64_tr_b16 a[168:169], v14 offset:40960
ds_read_b64_tr_b16 a[170:171], v14 offset:42496
M a[72:75], a[152:155], a[216:219], a[72:75]
M a[76:79], a[160:163], a[216:219], a[76:79]
M a[76:79], a[156:159], a[212:215], a[76:79]
s_waitcnt lgkmcnt(10)
M a[80:83], a[140:143], a[220:223], a[80:83]
ds_read_b128 a[196:199], v10 offset:32768
ds_read_b128 a[200:203], v11 offset:32768
M a[80:83], a[144:147], a[224:227], a[80:83]
M a[84:87], a[152:155], a[224:227], a[84:87]
ds_read_b64_tr_b16 a[176:177], v15 offset:40960
ds_read_b64_tr_b16 a[178:179], v15 offset:42496
M a[84:87], a[148:151], a[220:223], a[84:87]
M a[88:91], a[156:159], a[220:223], a[88:91]
M a[88:91], a[160:163], a[224:227], a[88:91]
s_waitcnt lgkmcnt(10)
M a[92:95], a[144:147], a[232:235], a[92:95]
ds_read_b128 a[204:207], v10 offset:34816
ds_read_b128 a[208:211], v11 offset:34816
M a[92:95], a[140:143], a[228:231], a[92:95]
M a[96:99], a[148:151], a[228:231], a[96:99]
ds_read_b64_tr_b16 a[184:185], v16 offset:40960
ds_read_b64_tr_b16 a[186:187], v16 offset:42496
M a[96:99], a[152:155], a[232:235], a[96:99]
M a[100:103], a[160:163], a[232:235], a[100:103]
M a[100:103], a[156:159], a[228:231], a[100:103]
s_waitcnt lgkmcnt(10)
M a[104:107], a[140:143], a[188:191], a[104:107]
M a[104:107], a[144:147], a[192:195], a[104:107]
M a[108:111], a[152:155], a[192:195], a[108:111]
M a[108:111], a[148:151], a[188:191], a[108:111]
M a[112:115], a[156:159], a[188:191], a[112:115]
s_waitcnt vmcnt(0) lgkmcnt(0)
s_barrier
ds_read_b128 a[212:215], v12 offset:0
ds_read_b128 a[216:219], v13 offset:0
M a[112:115], a[160:163], a[192:195], a[112:115]
M a[116:119], a[144:147], a[200:203], a[116:119]
ds_read_b128 a[220:223], v12 offset:2048
ds_read_b128 a[224:227], v13 offset:2048
M a[116:119], a[140:143], a[196:199], a[116:119]
v_and_b32 v7, 1, v0
v_lshlrev_b32 v7, 7, v7
M a[120:123], a[148:151], a[196:199], a[120:123]
M a[120:123], a[152:155], a[200:203], a[120:123]
M a[124:127], a[160:163], a[200:203], a[124:127]
M a[124:127], a[156:159], a[196:199], a[124:127]
M a[128:131], a[140:143], a[204:207], a[128:131]
ds_read_b128 a[228:231], v12 offset:4096
ds_read_b128 a[232:235], v13 offset:4096
M a[128:131], a[144:147], a[208:211], a[128:131]
M a[132:135], a[152:155], a[208:211], a[132:135]
M a[132:135], a[148:151], a[204:207], a[132:135]
M a[136:139], a[156:159], a[204:207], a[136:139]
M a[136:139], a[160:163], a[208:211], a[136:139]
s_waitcnt lgkmcnt(4)
v_and_b32 v24, 15, v0
v_mul_u32_u24 v24, 400, v24
v_lshrrev_b32 v25, 4, v0
v_lshl_add_u32 v24, v25, 3, v24
s_mul_i32 s3, s20, 96
v_add_u32 v2, s3, v24
M a[32:35], a[164:167], a[212:215], a[32:35]
ds_read_b128 a[188:191], v12 offset:6144
ds_read_b128 a[192:195], v13 offset:6144
M a[32:35], a[168:171], a[216:219], a[32:35]
buffer_load_dword v6, v7, s[60:63], 0 offen sc1
M a[36:39], a[176:179], a[216:219], a[36:39]
M a[36:39], a[172:175], a[212:215], a[36:39]
M a[40:43], a[180:183], a[212:215], a[40:43]
M a[40:43], a[184:187], a[216:219], a[40:43]
s_waitcnt lgkmcnt(4)
M a[44:47], a[168:171], a[224:227], a[44:47]
ds_read_b128 a[196:199], v12 offset:8192
ds_read_b128 a[200:203], v13 offset:8192
M a[44:47], a[164:167], a[220:223], a[44:47]
M a[48:51], a[172:175], a[220:223], a[48:51]
M a[48:51], a[176:179], a[224:227], a[48:51]
M a[52:55], a[184:187], a[224:227], a[52:55]
M a[52:55], a[180:183], a[220:223], a[52:55]
s_waitcnt lgkmcnt(4)
M a[56:59], a[164:167], a[228:231], a[56:59]
ds_read_b128 a[204:207], v12 offset:10240
ds_read_b128 a[208:211], v13 offset:10240
v_accvgpr_read_b32 v24, a32
v_accvgpr_read_b32 v25, a33
v_accvgpr_read_b32 v26, a34
M a[56:59], a[168:171], a[232:235], a[56:59]
v_accvgpr_read_b32 v27, a35
v_cvt_pk_bf16_f32 v24, v24, v25
v_cvt_pk_bf16_f32 v25, v26, v27
ds_write_b64 v2, v[24:25] offset:0
M a[60:63], a[176:179], a[232:235], a[60:63]
v_accvgpr_read_b32 v28, a36
v_accvgpr_read_b32 v29, a37
v_accvgpr_read_b32 v30, a38
M a[60:63], a[172:175], a[228:231], a[60:63]
v_accvgpr_read_b32 v31, a39
v_cvt_pk_bf16_f32 v28, v28, v29
v_cvt_pk_bf16_f32 v29, v30, v31
ds_write_b64 v2, v[28:29] offset:32
M a[64:67], a[180:183], a[228:231], a[64:67]
v_accvgpr_read_b32 v24, a40
v_accvgpr_read_b32 v25, a41
v_accvgpr_read_b32 v26, a42
M a[64:67], a[184:187], a[232:235], a[64:67]
s_waitcnt lgkmcnt(6)
v_accvgpr_read_b32 v27, a43
v_cvt_pk_bf16_f32 v24, v24, v25
v_cvt_pk_bf16_f32 v25, v26, v27
ds_write_b64 v2, v[24:25] offset:64
M a[68:71], a[168:171], a[192:195], a[68:71]
ds_read_b128 a[212:215], v12 offset:12288
ds_read_b128 a[216:219], v13 offset:12288
v_accvgpr_read_b32 v24, a44
v_accvgpr_read_b32 v25, a45
v_accvgpr_read_b32 v26, a46
M a[68:71], a[164:167], a[188:191], a[68:71]
v_accvgpr_read_b32 v27, a47
v_cvt_pk_bf16_f32 v24, v24, v25
v_cvt_pk_bf16_f32 v25, v26, v27
ds_write_b64 v2, v[24:25] offset:6400
M a[72:75], a[172:175], a[188:191], a[72:75]
v_accvgpr_read_b32 v28, a48
v_accvgpr_read_b32 v29, a49
v_accvgpr_read_b32 v30, a50
M a[72:75], a[176:179], a[192:195], a[72:75]
v_accvgpr_read_b32 v31, a51
v_cvt_pk_bf16_f32 v28, v28, v29
v_cvt_pk_bf16_f32 v29, v30, v31
ds_write_b64 v2, v[28:29] offset:6432
M a[76:79], a[184:187], a[192:195], a[76:79]
v_accvgpr_read_b32 v24, a52
v_accvgpr_read_b32 v25, a53
v_accvgpr_read_b32 v26, a54
M a[76:79], a[180:183], a[188:191], a[76:79]
s_waitcnt lgkmcnt(9)
v_accvgpr_read_b32 v27, a55
v_cvt_pk_bf16_f32 v24, v24, v25
v_cvt_pk_bf16_f32 v25, v26, v27
ds_write_b64 v2, v[24:25] offset:6464
M a[80:83], a[164:167], a[196:199], a[80:83]
ds_read_b128 a[220:223], v12 offset:14336
ds_read_b128 a[224:227], v13 offset:14336
v_accvgpr_read_b32 v24, a56
v_accvgpr_read_b32 v25, a57
v_accvgpr_read_b32 v26, a58
M a[80:83], a[168:171], a[200:203], a[80:83]
v_accvgpr_read_b32 v27, a59
v_cvt_pk_bf16_f32 v24, v24, v25
v_cvt_pk_bf16_f32 v25, v26, v27
ds_write_b64 v2, v[24:25] offset:12800
M a[84:87], a[176:179], a[200:203], a[84:87]
v_accvgpr_read_b32 v28, a60
v_accvgpr_read_b32 v29, a61
v_accvgpr_read_b32 v30, a62
M a[84:87], a[172:175], a[196:199], a[84:87]
v_accvgpr_read_b32 v31, a63
v_cvt_pk_bf16_f32 v28, v28, v29
v_cvt_pk_bf16_f32 v29, v30, v31
ds_write_b64 v2, v[28:29] offset:12832
M a[88:91], a[180:183], a[196:199], a[88:91]
v_accvgpr_read_b32 v24, a64
v_accvgpr_read_b32 v25, a65
v_accvgpr_read_b32 v26, a66
M a[88:91], a[184:187], a[200:203], a[88:91]
s_waitcnt lgkmcnt(12)
v_accvgpr_read_b32 v27, a67
v_cvt_pk_bf16_f32 v24, v24, v25
v_cvt_pk_bf16_f32 v25, v26, v27
ds_write_b64 v2, v[24:25] offset:12864
M a[92:95], a[168:171], a[208:211], a[92:95]
ds_read_b128 a[228:231], v12 offset:16384
ds_read_b128 a[232:235], v13 offset:16384
v_accvgpr_read_b32 v24, a68
v_accvgpr_read_b32 v25, a69
v_accvgpr_read_b32 v26, a70
M a[92:95], a[164:167], a[204:207], a[92:95]
v_accvgpr_read_b32 v27, a71
v_cvt_pk_bf16_f32 v24, v24, v25
v_cvt_pk_bf16_f32 v25, v26, v27
ds_write_b64 v2, v[24:25] offset:19200
M a[96:99], a[172:175], a[204:207], a[96:99]
v_accvgpr_read_b32 v28, a72
v_accvgpr_read_b32 v29, a73
v_accvgpr_read_b32 v30, a74
M a[96:99], a[176:179], a[208:211], a[96:99]
v_accvgpr_read_b32 v31, a75
v_cvt_pk_bf16_f32 v28, v28, v29
v_cvt_pk_bf16_f32 v29, v30, v31
ds_write_b64 v2, v[28:29] offset:19232
M a[100:103], a[184:187], a[208:211], a[100:103]
v_accvgpr_read_b32 v24, a76
v_accvgpr_read_b32 v25, a77
v_accvgpr_read_b32 v26, a78
M a[100:103], a[180:183], a[204:207], a[100:103]
s_waitcnt lgkmcnt(12)
v_accvgpr_read_b32 v27, a79
v_cvt_pk_bf16_f32 v24, v24, v25
v_cvt_pk_bf16_f32 v25, v26, v27
ds_write_b64 v2, v[24:25] offset:19264
M a[104:107], a[164:167], a[212:215], a[104:107]
v_accvgpr_read_b32 v24, a80
v_accvgpr_read_b32 v25, a81
v_accvgpr_read_b32 v26, a82
M a[104:107], a[168:171], a[216:219], a[104:107]
v_accvgpr_read_b32 v27, a83
v_cvt_pk_bf16_f32 v24, v24, v25
v_cvt_pk_bf16_f32 v25, v26, v27
ds_write_b64 v2, v[24:25] offset:25600
M a[108:111], a[176:179], a[216:219], a[108:111]
v_accvgpr_read_b32 v28, a84
v_accvgpr_read_b32 v29, a85
v_accvgpr_read_b32 v30, a86
M a[108:111], a[172:175], a[212:215], a[108:111]
v_accvgpr_read_b32 v31, a87
v_cvt_pk_bf16_f32 v28, v28, v29
v_cvt_pk_bf16_f32 v29, v30, v31
ds_write_b64 v2, v[28:29] offset:25632
M a[112:115], a[180:183], a[212:215], a[112:115]
v_accvgpr_read_b32 v24, a88
v_accvgpr_read_b32 v25, a89
v_accvgpr_read_b32 v26, a90
M a[112:115], a[184:187], a[216:219], a[112:115]
s_waitcnt lgkmcnt(10)
v_accvgpr_read_b32 v27, a91
v_cvt_pk_bf16_f32 v24, v24, v25
v_cvt_pk_bf16_f32 v25, v26, v27
ds_write_b64 v2, v[24:25] offset:25664
M a[116:119], a[168:171], a[224:227], a[116:119]
v_accvgpr_read_b32 v24, a92
v_accvgpr_read_b32 v25, a93
v_accvgpr_read_b32 v26, a94
M a[116:119], a[164:167], a[220:223], a[116:119]
v_accvgpr_read_b32 v27, a95
v_cvt_pk_bf16_f32 v24, v24, v25
v_cvt_pk_bf16_f32 v25, v26, v27
ds_write_b64 v2, v[24:25] offset:32000
M a[120:123], a[172:175], a[220:223], a[120:123]
v_accvgpr_read_b32 v28, a96
v_accvgpr_read_b32 v29, a97
v_accvgpr_read_b32 v30, a98
M a[120:123], a[176:179], a[224:227], a[120:123]
v_accvgpr_read_b32 v31, a99
v_cvt_pk_bf16_f32 v28, v28, v29
v_cvt_pk_bf16_f32 v29, v30, v31
ds_write_b64 v2, v[28:29] offset:32032
M a[124:127], a[184:187], a[224:227], a[124:127]
v_accvgpr_read_b32 v24, a100
v_accvgpr_read_b32 v25, a101
v_accvgpr_read_b32 v26, a102
M a[124:127], a[180:183], a[220:223], a[124:127]
s_waitcnt lgkmcnt(8)
v_accvgpr_read_b32 v27, a103
v_cvt_pk_bf16_f32 v24, v24, v25
v_cvt_pk_bf16_f32 v25, v26, v27
ds_write_b64 v2, v[24:25] offset:32064
M a[128:131], a[164:167], a[228:231], a[128:131]
v_accvgpr_read_b32 v24, a104
v_accvgpr_read_b32 v25, a105
v_accvgpr_read_b32 v26, a106
M a[128:131], a[168:171], a[232:235], a[128:131]
v_accvgpr_read_b32 v27, a107
v_cvt_pk_bf16_f32 v24, v24, v25
v_cvt_pk_bf16_f32 v25, v26, v27
ds_write_b64 v2, v[24:25] offset:38400
M a[132:135], a[176:179], a[232:235], a[132:135]
v_accvgpr_read_b32 v28, a108
v_accvgpr_read_b32 v29, a109
v_accvgpr_read_b32 v30, a110
M a[132:135], a[172:175], a[228:231], a[132:135]
v_accvgpr_read_b32 v31, a111
v_cvt_pk_bf16_f32 v28, v28, v29
v_cvt_pk_bf16_f32 v29, v30, v31
ds_write_b64 v2, v[28:29] offset:38432
M a[136:139], a[180:183], a[228:231], a[136:139]
v_accvgpr_read_b32 v24, a112
v_accvgpr_read_b32 v25, a113
v_accvgpr_read_b32 v26, a114
M a[136:139], a[184:187], a[232:235], a[136:139]
v_accvgpr_read_b32 v27, a115
v_cvt_pk_bf16_f32 v24, v24, v25
v_cvt_pk_bf16_f32 v25, v26, v27
ds_write_b64 v2, v[24:25] offset:38464
v_accvgpr_read_b32 v24, a116
v_accvgpr_read_b32 v25, a117
v_accvgpr_read_b32 v26, a118
v_accvgpr_read_b32 v27, a119
v_cvt_pk_bf16_f32 v24, v24, v25
v_cvt_pk_bf16_f32 v25, v26, v27
ds_write_b64 v2, v[24:25] offset:44800
v_accvgpr_read_b32 v28, a120
v_accvgpr_read_b32 v29, a121
v_accvgpr_read_b32 v30, a122
v_accvgpr_read_b32 v31, a123
v_cvt_pk_bf16_f32 v28, v28, v29
v_cvt_pk_bf16_f32 v29, v30, v31
ds_write_b64 v2, v[28:29] offset:44832
v_accvgpr_read_b32 v24, a124
v_accvgpr_read_b32 v25, a125
v_accvgpr_read_b32 v26, a126
v_accvgpr_read_b32 v27, a127
v_cvt_pk_bf16_f32 v24, v24, v25
v_cvt_pk_bf16_f32 v25, v26, v27
ds_write_b64 v2, v[24:25] offset:44864
v_accvgpr_read_b32 v24, a128
v_accvgpr_read_b32 v25, a129
v_accvgpr_read_b32 v26, a130
v_accvgpr_read_b32 v27, a131
v_cvt_pk_bf16_f32 v24, v24, v25
v_cvt_pk_bf16_f32 v25, v26, v27
ds_write_b64 v2, v[24:25] offset:51200
v_accvgpr_read_b32 v28, a132
v_accvgpr_read_b32 v29, a133
v_accvgpr_read_b32 v30, a134
v_accvgpr_read_b32 v31, a135
v_cvt_pk_bf16_f32 v28, v28, v29
v_cvt_pk_bf16_f32 v29, v30, v31
ds_write_b64 v2, v[28:29] offset:51232
v_accvgpr_read_b32 v24, a136
v_accvgpr_read_b32 v25, a137
v_accvgpr_read_b32 v26, a138
v_accvgpr_read_b32 v27, a139
v_cvt_pk_bf16_f32 v24, v24, v25
v_cvt_pk_bf16_f32 v25, v26, v27
ds_write_b64 v2, v[24:25] offset:51264
v_and_b32 v24, 15, v0
v_lshrrev_b32 v25, 4, v0
s_add_u32 s3, s21, 16
v_lshl_add_u32 v26, v24, 1, s3
s_lshl_b32 s4, s22, 6
v_mul_u32_u24 v2, 400, v26
v_lshl_add_u32 v2, v25, 4, v2
v_add_u32 v2, s4, v2
v_subrev_u32 v26, 32, v26
v_max_i32 v26, 0, v26
v_mul_u32_u24 v3, 400, v26
v_lshl_add_u32 v3, v25, 4, v3
v_add_u32 v3, s4, v3
v_bfe_u32 v27, v0, 2, 2
v_lshl_add_u32 v27, v25, 2, v27
v_lshl_add_u32 v27, v27, 1, s3
v_and_b32 v28, 3, v0
v_lshlrev_b32 v28, 3, v28
v_add_u32 v28, s4, v28
s_movk_i32 s5, 400
v_mad_u32_u24 v4, v27, s5, v28
v_subrev_u32 v27, 32, v27
v_max_i32 v27, 0, v27
v_mad_u32_u24 v5, v27, s5, v28
v_lshlrev_b32 v25, 2, v25
v_sub_u32 v24, v24, v25
v_mov_b32 v25, 0xf149f2ca
s_cmp_eq_u32 s26, 0
s_cselect_b32 s3, 0xf149f2ca, 0
v_cmp_lt_i32 vcc, -9, v24
s_nop 1
v_cndmask_b32 v8, 0, v25, vcc
v_subrev_u32 v26, 0, v24
v_cmp_lt_u32 vcc, 7, v26
s_nop 1
v_cndmask_b32 v12, 0, v25, vcc
v_min_f32 v16, s3, v8
v_mov_b32 v20, 0x3f803f80
v_cmp_lt_i32 vcc, -8, v24
s_nop 1
v_cndmask_b32 v9, 0, v25, vcc
v_subrev_u32 v26, 1, v24
v_cmp_lt_u32 vcc, 7, v26
s_nop 1
v_cndmask_b32 v13, 0, v25, vcc
v_min_f32 v17, s3, v9
v_mov_b32 v21, 0x3f803f80
v_cmp_lt_i32 vcc, -7, v24
s_nop 1
v_cndmask_b32 v10, 0, v25, vcc
v_subrev_u32 v26, 2, v24
v_cmp_lt_u32 vcc, 7, v26
s_nop 1
v_cndmask_b32 v14, 0, v25, vcc
v_min_f32 v18, s3, v10
v_mov_b32 v22, 0x3f803f80
v_cmp_lt_i32 vcc, -6, v24
s_nop 1
v_cndmask_b32 v11, 0, v25, vcc
v_subrev_u32 v26, 3, v24
v_cmp_lt_u32 vcc, 7, v26
s_nop 1
v_cndmask_b32 v15, 0, v25, vcc
v_min_f32 v19, s3, v11
v_mov_b32 v23, 0x3f803f80
s_add_u32 s16, s50, 83886080
s_addc_u32 s17, s51, 0
s_mov_b32 s18, 4194304
s_mov_b32 s19, 0x00020000
s_lshl_b32 s3, s26, 18
s_lshl_b32 s4, s27, 14
s_add_u32 s3, s3, s4
s_lshl_b32 s4, s21, 13
s_add_u32 s3, s3, s4
s_lshl_b32 s4, s22, 10
s_add_u32 s6, s3, s4
s_mov_b32 s7, 0x3e8293ee
s_lshl_b32 s65, s26, 8
s_lshl_b32 s3, s27, 4
s_add_u32 s65, s65, s3
s_lshl_b32 s3, s101, 2
s_add_u32 s65, s65, s3
s_add_u32 s65, s65, 8400896
s_mov_b32 s59, 0
s_waitcnt vmcnt(0)
v_cmp_gt_u32 vcc, 0x80, v6
s_nop 0
s_cbranch_vccnz Lk1_spin
Lk1_got:
s_mov_b64 s[4:5], s[50:51]
s_mov_b64 s[44:45], s[42:43]
s_and_b32 s20, s2, 7
s_lshr_b32 s33, s2, 6
s_lshl_b32 s33, s33, 3
s_add_u32 s20, s20, s33
s_bfe_u32 s21, s2, 0x30003
s_mov_b32 s22, s101
s_and_b32 s23, s22, 1
s_lshr_b32 s24, s22, 1
s_lshl_b32 s33, s24, 14
s_lshl_b32 s34, s23, 13
s_add_u32 s29, s33, s34
s_lshl_b32 s28, s20, 20
s_add_u32 s28, s28, s34
s_lshl_b32 s33, s21, 16
s_add_u32 s27, s28, s33
s_add_u32 s27, s27, 65536
s_sub_u32 s34, 491520, s33
s_cmp_eq_u32 s24, 0
s_cselect_b32 s34, 0, s34
s_cselect_b32 s27, s27, 0x7fffffff
s_add_u32 s25, s28, s34
s_add_u32 s26, s25, 16384
s_add_u32 s62, s27, 16384
s_add_u32 s63, s28, 16384
s_sub_u32 s35, 15, s21
s_lshl_b32 s31, s21, 7
s_cmp_eq_u32 s24, 0
s_cselect_b32 s35, s21, s35
s_cselect_b32 s31, s31, 960
s_mov_b32 s60, 0
s_add_u32 s12, s4, 16777216
s_addc_u32 s13, s5, 0
s_mov_b32 s14, 33554432
s_mov_b32 s15, 0x00020000
s_mov_b32 s8, s4
s_mov_b32 s9, s5
s_mov_b32 s10, 16777216
s_mov_b32 s11, 0x00020000
s_add_u32 m0, s29, 65536
s_add_u32 s32, s25, 4096
buffer_load_dwordx4 v1, s[12:15], s25 offen offset:0 sc1 lds
buffer_load_dwordx4 v1, s[12:15], s25 offen offset:1024 sc1 lds
buffer_load_dwordx4 v1, s[12:15], s25 offen offset:2048 sc1 lds
buffer_load_dwordx4 v1, s[12:15], s25 offen offset:3072 sc1 lds
s_add_u32 m0, s29, 69632
s_nop 0
buffer_load_dwordx4 v1, s[12:15], s32 offen offset:0 sc1 lds
buffer_load_dwordx4 v1, s[12:15], s32 offen offset:1024 sc1 lds
buffer_load_dwordx4 v1, s[12:15], s32 offen offset:2048 sc1 lds
buffer_load_dwordx4 v1, s[12:15], s32 offen offset:3072 sc1 lds
s_add_u32 s25, s25, 32768
s_cmp_eq_u32 s25, s27
s_cselect_b32 s25, s28, s25
s_cselect_b32 s27, -1, s27
s_lshl_b32 s33, s20, 7
s_lshl_b32 s34, s35, 3
s_add_u32 s33, s33, s34
s_lshl_b32 s34, s23, 2
s_add_u32 s33, s33, s34
s_lshl_b32 s33, s33, 12
buffer_load_dwordx4 a[52:55], v1, s[8:11], s33 offen offset:0 sc1
buffer_load_dwordx4 a[56:59], v1, s[8:11], s33 offen offset:1024 sc1
buffer_load_dwordx4 a[60:63], v1, s[8:11], s33 offen offset:2048 sc1
buffer_load_dwordx4 a[64:67], v1, s[8:11], s33 offen offset:3072 sc1
s_add_u32 s33, s33, 4096
buffer_load_dwordx4 a[68:71], v1, s[8:11], s33 offen offset:0 sc1
buffer_load_dwordx4 a[72:75], v1, s[8:11], s33 offen offset:1024 sc1
buffer_load_dwordx4 a[76:79], v1, s[8:11], s33 offen offset:2048 sc1
buffer_load_dwordx4 a[80:83], v1, s[8:11], s33 offen offset:3072 sc1
s_add_u32 s33, s33, 4096
buffer_load_dwordx4 a[84:87], v1, s[8:11], s33 offen offset:0 sc1
buffer_load_dwordx4 a[88:91], v1, s[8:11], s33 offen offset:1024 sc1
buffer_load_dwordx4 a[92:95], v1, s[8:11], s33 offen offset:2048 sc1
buffer_load_dwordx4 a[96:99], v1, s[8:11], s33 offen offset:3072 sc1
s_add_u32 s33, s33, 4096
buffer_load_dwordx4 a[100:103], v1, s[8:11], s33 offen offset:0 sc1
buffer_load_dwordx4 a[104:107], v1, s[8:11], s33 offen offset:1024 sc1
buffer_load_dwordx4 a[108:111], v1, s[8:11], s33 offen offset:2048 sc1
buffer_load_dwordx4 a[112:115], v1, s[8:11], s33 offen offset:3072 sc1
s_waitcnt lgkmcnt(0)
s_barrier
ds_read_b128 v[48:51], v3 offset:128
ds_read_b128 v[32:35], v2 offset:0
ds_read_b128 v[52:55], v2 offset:128
ds_read_b128 v[36:39], v2 offset:12800
ds_read_b128 v[56:59], v2 offset:12928
ds_read_b128 v[40:43], v2 offset:25600
ds_read_b128 v[60:63], v2 offset:25728
ds_read_b128 v[44:47], v2 offset:38400
ds_read_b128 v[64:67], v2 offset:38528
ds_read_b64_tr_b16 v[68:69], v5 offset:256
ds_read_b64_tr_b16 v[70:71], v4 offset:256
ds_read_b64_tr_b16 v[72:73], v4 offset:13056
ds_read_b64_tr_b16 v[74:75], v4 offset:25856
ds_read_b64_tr_b16 v[76:77], v4 offset:38656
ds_read_b64_tr_b16 v[78:79], v5 offset:288
ds_read_b64_tr_b16 v[80:81], v4 offset:288
ds_read_b64_tr_b16 v[82:83], v4 offset:13088
ds_read_b64_tr_b16 v[84:85], v4 offset:25888
ds_read_b64_tr_b16 v[86:87], v4 offset:38688
s_waitcnt lgkmcnt(15)
M v[88:91], v[48:51], v[32:35], v[16:19]
M v[92:95], v[52:55], v[32:35], v[12:15]
M v[96:99], v[52:55], v[36:39], v[8:11]
s_waitcnt lgkmcnt(14)
M v[100:103], v[56:59], v[36:39], v[12:15]
s_waitcnt lgkmcnt(13)
M v[104:107], v[56:59], v[40:43], v[8:11]
s_waitcnt lgkmcnt(12)
M v[108:111], v[60:63], v[40:43], v[12:15]
s_waitcnt lgkmcnt(11)
M v[112:115], v[60:63], v[44:47], v[8:11]
s_waitcnt lgkmcnt(10)
M v[116:119], v[64:67], v[44:47], v[12:15]
v_max3_f32 v168, v88, v89, v90
v_max3_f32 v168, v168, v91, v92
v_max3_f32 v168, v168, v93, v94
v_max_f32 v168, v168, v95
v_max3_f32 v169, v96, v97, v98
v_max3_f32 v169, v169, v99, v100
v_max3_f32 v169, v169, v101, v102
v_max_f32 v169, v169, v103
v_max3_f32 v170, v104, v105, v106
v_max3_f32 v170, v170, v107, v108
v_max3_f32 v170, v170, v109, v110
v_max_f32 v170, v170, v111
v_max3_f32 v171, v112, v113, v114
v_max3_f32 v171, v171, v115, v116
v_max3_f32 v171, v171, v117, v118
v_max_f32 v171, v171, v119
v_mov_b32 v172, v168
v_mov_b32 v173, v169
v_mov_b32 v174, v170
v_mov_b32 v175, v171
v_permlane16_swap_b32 v168, v172
v_permlane16_swap_b32 v169, v173
v_permlane16_swap_b32 v170, v174
v_permlane16_swap_b32 v171, v175
v_max_f32 v168, v168, v172
v_max_f32 v169, v169, v173
v_max_f32 v170, v170, v174
v_max_f32 v171, v171, v175
v_mov_b32 v172, v168
v_mov_b32 v173, v169
v_mov_b32 v174, v170
v_mov_b32 v175, v171
v_permlane32_swap_b32 v168, v172
v_permlane32_swap_b32 v169, v173
v_permlane32_swap_b32 v170, v174
v_permlane32_swap_b32 v171, v175
v_max_f32 v168, v168, v172
v_max_f32 v169, v169, v173
v_max_f32 v170, v170, v174
v_max_f32 v171, v171, v175
v_mul_f32 v168, s7, v168
v_mul_f32 v169, s7, v169
v_mul_f32 v170, s7, v170
v_mul_f32 v171, s7, v171
v_fma_f32 v88, v88, s7, -v168
v_fma_f32 v89, v89, s7, -v168
v_fma_f32 v90, v90, s7, -v168
v_fma_f32 v91, v91, s7, -v168
v_fma_f32 v92, v92, s7, -v168
v_fma_f32 v93, v93, s7, -v168
v_fma_f32 v94, v94, s7, -v168
v_fma_f32 v95, v95, s7, -v168
v_exp_f32 v88, v88
v_exp_f32 v89, v89
v_exp_f32 v90, v90
v_exp_f32 v91, v91
v_exp_f32 v92, v92
v_exp_f32 v93, v93
v_exp_f32 v94, v94
v_exp_f32 v95, v95
v_fma_f32 v96, v96, s7, -v169
v_fma_f32 v97, v97, s7, -v169
v_fma_f32 v98, v98, s7, -v169
v_fma_f32 v99, v99, s7, -v169
v_fma_f32 v100, v100, s7, -v169
v_fma_f32 v101, v101, s7, -v169
v_fma_f32 v102, v102, s7, -v169
v_fma_f32 v103, v103, s7, -v169
v_exp_f32 v96, v96
v_exp_f32 v97, v97
v_exp_f32 v98, v98
v_exp_f32 v99, v99
v_exp_f32 v100, v100
v_exp_f32 v101, v101
v_exp_f32 v102, v102
v_exp_f32 v103, v103
v_fma_f32 v104, v104, s7, -v170
v_fma_f32 v105, v105, s7, -v170
v_fma_f32 v106, v106, s7, -v170
v_fma_f32 v107, v107, s7, -v170
v_fma_f32 v108, v108, s7, -v170
v_fma_f32 v109, v109, s7, -v170
v_fma_f32 v110, v110, s7, -v170
v_fma_f32 v111, v111, s7, -v170
v_exp_f32 v104, v104
v_exp_f32 v105, v105
v_exp_f32 v106, v106
v_exp_f32 v107, v107
v_exp_f32 v108, v108
v_exp_f32 v109, v109
v_exp_f32 v110, v110
v_exp_f32 v111, v111
v_fma_f32 v112, v112, s7, -v171
v_fma_f32 v113, v113, s7, -v171
v_fma_f32 v114, v114, s7, -v171
v_fma_f32 v115, v115, s7, -v171
v_fma_f32 v116, v116, s7, -v171
v_fma_f32 v117, v117, s7, -v171
v_fma_f32 v118, v118, s7, -v171
v_fma_f32 v119, v119, s7, -v171
v_exp_f32 v112, v112
v_exp_f32 v113, v113
v_exp_f32 v114, v114
v_exp_f32 v115, v115
v_exp_f32 v116, v116
v_exp_f32 v117, v117
v_exp_f32 v118, v118
v_exp_f32 v119, v119
v_cvt_pk_bf16_f32 v88, v88, v89
v_cvt_pk_bf16_f32 v89, v90, v91
v_cvt_pk_bf16_f32 v90, v92, v93
v_cvt_pk_bf16_f32 v91, v94, v95
v_cvt_pk_bf16_f32 v96, v96, v97
v_cvt_pk_bf16_f32 v97, v98, v99
v_cvt_pk_bf16_f32 v98, v100, v101
v_cvt_pk_bf16_f32 v99, v102, v103
v_cvt_pk_bf16_f32 v104, v104, v105
v_cvt_pk_bf16_f32 v105, v106, v107
v_cvt_pk_bf16_f32 v106, v108, v109
v_cvt_pk_bf16_f32 v107, v110, v111
v_cvt_pk_bf16_f32 v112, v112, v113
v_cvt_pk_bf16_f32 v113, v114, v115
v_cvt_pk_bf16_f32 v114, v116, v117
v_cvt_pk_bf16_f32 v115, v118, v119
M v[152:155], v[20:23], v[88:91], 0
s_waitcnt lgkmcnt(8)
M v[120:123], v[68:71], v[88:91], 0
s_waitcnt lgkmcnt(3)
M v[124:127], v[78:81], v[88:91], 0
M v[156:159], v[20:23], v[96:99], 0
M v[128:131], v[70:73], v[96:99], 0
s_waitcnt lgkmcnt(2)
M v[132:135], v[80:83], v[96:99], 0
M v[160:163], v[20:23], v[104:107], 0
M v[136:139], v[72:75], v[104:107], 0
s_waitcnt lgkmcnt(1)
M v[140:143], v[82:85], v[104:107], 0
M v[164:167], v[20:23], v[112:115], 0
M v[144:147], v[74:77], v[112:115], 0
s_waitcnt lgkmcnt(0)
M v[148:151], v[84:87], v[112:115], 0
v_rcp_f32 v152, v152
v_rcp_f32 v156, v156
v_rcp_f32 v160, v160
s_nop 1
v_rcp_f32 v164, v164
v_pk_mul_f32 v[120:121], v[120:121], v[152:153] op_sel_hi:[1,0]
v_pk_mul_f32 v[122:123], v[122:123], v[152:153] op_sel_hi:[1,0]
v_pk_mul_f32 v[124:125], v[124:125], v[152:153] op_sel_hi:[1,0]
v_pk_mul_f32 v[126:127], v[126:127], v[152:153] op_sel_hi:[1,0]
v_cvt_pk_bf16_f32 v120, v120, v121
v_cvt_pk_bf16_f32 v121, v122, v123
v_cvt_pk_bf16_f32 v122, v124, v125
v_cvt_pk_bf16_f32 v123, v126, v127
s_add_u32 s3, s6, 0
buffer_store_dwordx4 v[120:123], v1, s[16:19], s3 offen sc1
v_pk_mul_f32 v[128:129], v[128:129], v[156:157] op_sel_hi:[1,0]
v_pk_mul_f32 v[130:131], v[130:131], v[156:157] op_sel_hi:[1,0]
v_pk_mul_f32 v[132:133], v[132:133], v[156:157] op_sel_hi:[1,0]
v_pk_mul_f32 v[134:135], v[134:135], v[156:157] op_sel_hi:[1,0]
v_cvt_pk_bf16_f32 v128, v128, v129
v_cvt_pk_bf16_f32 v129, v130, v131
v_cvt_pk_bf16_f32 v130, v132, v133
v_cvt_pk_bf16_f32 v131, v134, v135
s_add_u32 s3, s6, 2048
buffer_store_dwordx4 v[128:131], v1, s[16:19], s3 offen sc1
v_pk_mul_f32 v[136:137], v[136:137], v[160:161] op_sel_hi:[1,0]
v_pk_mul_f32 v[138:139], v[138:139], v[160:161] op_sel_hi:[1,0]
v_pk_mul_f32 v[140:141], v[140:141], v[160:161] op_sel_hi:[1,0]
v_pk_mul_f32 v[142:143], v[142:143], v[160:161] op_sel_hi:[1,0]
v_cvt_pk_bf16_f32 v136, v136, v137
v_cvt_pk_bf16_f32 v137, v138, v139
v_cvt_pk_bf16_f32 v138, v140, v141
v_cvt_pk_bf16_f32 v139, v142, v143
s_add_u32 s3, s6, 4096
buffer_store_dwordx4 v[136:139], v1, s[16:19], s3 offen sc1
v_pk_mul_f32 v[144:145], v[144:145], v[164:165] op_sel_hi:[1,0]
v_pk_mul_f32 v[146:147], v[146:147], v[164:165] op_sel_hi:[1,0]
v_pk_mul_f32 v[148:149], v[148:149], v[164:165] op_sel_hi:[1,0]
v_pk_mul_f32 v[150:151], v[150:151], v[164:165] op_sel_hi:[1,0]
v_cvt_pk_bf16_f32 v144, v144, v145
v_cvt_pk_bf16_f32 v145, v146, v147
v_cvt_pk_bf16_f32 v146, v148, v149
v_cvt_pk_bf16_f32 v147, v150, v151
s_add_u32 s3, s6, 6144
buffer_store_dwordx4 v[144:147], v1, s[16:19], s3 offen sc1
s_add_u32 s16, s4, 67108864
s_addc_u32 s17, s5, 0
s_mov_b32 s18, 16777216
s_mov_b32 s19, 0x00020000
s_add_u32 s52, s4, 100663296
s_addc_u32 s53, s5, 0
s_mov_b32 s54, 8404992
s_mov_b32 s55, 0x00020000
s_mov_b32 s46, 8388608
s_mov_b32 s47, 0x00020000
s_mov_b32 s50, 2097152
s_mov_b32 s51, 0x00020000
s_lshl_b32 s33, s24, 14
v_add_u32 v2, s33, v1
v_add_u32 v3, 0x10000, v2
v_and_b32 v8, 15, v0
v_bfe_u32 v9, v0, 4, 2
v_lshlrev_b32 v9, 2, v9
v_sub_u32 v8, v8, v9
v_mov_b32 v4, 0xf149f2ca
v_cmp_gt_i32 vcc, 0, v8
s_nop 1
v_cndmask_b32 v16, 0, v4, vcc
v_cmp_gt_i32 vcc, 1, v8
s_nop 1
v_cndmask_b32 v17, 0, v4, vcc
v_cmp_gt_i32 vcc, 2, v8
s_nop 1
v_cndmask_b32 v18, 0, v4, vcc
v_cmp_gt_i32 vcc, 3, v8
s_nop 1
v_cndmask_b32 v19, 0, v4, vcc
v_mov_b32 v8, 0x3f803f80
v_accvgpr_write_b32 a48, v8
v_accvgpr_write_b32 a49, v8
v_accvgpr_write_b32 a50, v8
v_accvgpr_write_b32 a51, v8
v_accvgpr_write_b32 a0, 0
v_accvgpr_write_b32 a1, 0
v_accvgpr_write_b32 a2, 0
v_accvgpr_write_b32 a3, 0
v_accvgpr_write_b32 a4, 0
v_accvgpr_write_b32 a5, 0
v_accvgpr_write_b32 a6, 0
v_accvgpr_write_b32 a7, 0
v_accvgpr_write_b32 a8, 0
v_accvgpr_write_b32 a9, 0
v_accvgpr_write_b32 a10, 0
v_accvgpr_write_b32 a11, 0
v_accvgpr_write_b32 a12, 0
v_accvgpr_write_b32 a13, 0
v_accvgpr_write_b32 a14, 0
v_accvgpr_write_b32 a15, 0
v_accvgpr_write_b32 a16, 0
v_accvgpr_write_b32 a17, 0
v_accvgpr_write_b32 a18, 0
v_accvgpr_write_b32 a19, 0
v_accvgpr_write_b32 a20, 0
v_accvgpr_write_b32 a21, 0
v_accvgpr_write_b32 a22, 0
v_accvgpr_write_b32 a23, 0
v_accvgpr_write_b32 a24, 0
v_accvgpr_write_b32 a25, 0
v_accvgpr_write_b32 a26, 0
v_accvgpr_write_b32 a27, 0
v_accvgpr_write_b32 a28, 0
v_accvgpr_write_b32 a29, 0
v_accvgpr_write_b32 a30, 0
v_accvgpr_write_b32 a31, 0
v_accvgpr_write_b32 a32, 0
v_accvgpr_write_b32 a33, 0
v_accvgpr_write_b32 a34, 0
v_accvgpr_write_b32 a35, 0
v_accvgpr_write_b32 a36, 0
v_accvgpr_write_b32 a37, 0
v_accvgpr_write_b32 a38, 0
v_accvgpr_write_b32 a39, 0
v_accvgpr_write_b32 a40, 0
v_accvgpr_write_b32 a41, 0
v_accvgpr_write_b32 a42, 0
v_accvgpr_write_b32 a43, 0
v_accvgpr_write_b32 a44, 0
v_accvgpr_write_b32 a45, 0
v_accvgpr_write_b32 a46, 0
v_accvgpr_write_b32 a47, 0
v_mov_b32 v160, 0
v_mov_b32 v161, 0
v_mov_b32 v162, 0
v_mov_b32 v163, 0
v_mov_b32 v164, 0
v_mov_b32 v165, 0
v_mov_b32 v166, 0
v_mov_b32 v167, 0
v_mov_b32 v168, 0
v_mov_b32 v169, 0
v_mov_b32 v170, 0
v_mov_b32 v171, 0
v_mov_b32 v172, 0
v_mov_b32 v173, 0
v_mov_b32 v174, 0
v_mov_b32 v175, 0
v_mov_b32 v176, 0
v_mov_b32 v177, 0
v_mov_b32 v178, 0
v_mov_b32 v179, 0
v_mov_b32 v180, 0
v_mov_b32 v181, 0
v_mov_b32 v182, 0
v_mov_b32 v183, 0
v_mov_b32 v184, 0
v_mov_b32 v185, 0
v_mov_b32 v186, 0
v_mov_b32 v187, 0
v_mov_b32 v188, 0
v_mov_b32 v189, 0
v_mov_b32 v190, 0
v_mov_b32 v191, 0
v_mov_b32 v192, 0
v_mov_b32 v193, 0
v_mov_b32 v194, 0
v_mov_b32 v195, 0
v_mov_b32 v196, 0
v_mov_b32 v197, 0
v_mov_b32 v198, 0
v_mov_b32 v199, 0
v_mov_b32 v200, 0
v_mov_b32 v201, 0
v_mov_b32 v202, 0
v_mov_b32 v203, 0
v_mov_b32 v204, 0
v_mov_b32 v205, 0
v_mov_b32 v206, 0
v_mov_b32 v207, 0
v_mov_b32 v208, 0
v_mov_b32 v209, 0
v_mov_b32 v210, 0
v_mov_b32 v211, 0
v_mov_b32 v212, 0
v_mov_b32 v213, 0
v_mov_b32 v214, 0
v_mov_b32 v215, 0
v_mov_b32 v216, 0
v_mov_b32 v217, 0
v_mov_b32 v218, 0
v_mov_b32 v219, 0
v_mov_b32 v220, 0
v_mov_b32 v221, 0
v_mov_b32 v222, 0
v_mov_b32 v223, 0
v_mov_b32 v224, 0
v_mov_b32 v225, 0
v_mov_b32 v226, 0
v_mov_b32 v227, 0
v_mov_b32 v228, 0
v_mov_b32 v229, 0
v_mov_b32 v230, 0
v_mov_b32 v231, 0
v_mov_b32 v232, 0
v_mov_b32 v233, 0
v_mov_b32 v234, 0
v_mov_b32 v235, 0
v_mov_b32 v236, 0
v_mov_b32 v237, 0
v_mov_b32 v238, 0
v_mov_b32 v239, 0
v_mov_b32 v240, 0
v_mov_b32 v241, 0
v_mov_b32 v242, 0
v_mov_b32 v243, 0
v_mov_b32 v244, 0
v_mov_b32 v245, 0
v_mov_b32 v246, 0
v_mov_b32 v247, 0
v_mov_b32 v248, 0
v_mov_b32 v249, 0
v_mov_b32 v250, 0
v_mov_b32 v251, 0
v_mov_b32 v252, 0
v_mov_b32 v253, 0
v_mov_b32 v254, 0
v_mov_b32 v255, 0
s_lshl_b32 s33, s23, 6
s_add_i32 s33, s33, s31
s_cmp_gt_i32 s33, 0
s_cselect_b32 s34, 0, 0xf149f2ca
s_cmp_lt_i32 s33, 0
s_cselect_b32 s33, 0xf149f2ca, 0
v_mov_b32 v20, s34
v_mov_b32 v21, s34
v_mov_b32 v22, s34
v_mov_b32 v23, s34
v_mov_b32 v28, s33
v_mov_b32 v29, s33
v_mov_b32 v30, s33
v_mov_b32 v31, s33
v_med3_f32 v24, v16, v20, v28
v_med3_f32 v25, v17, v20, v28
v_med3_f32 v26, v18, v20, v28
v_med3_f32 v27, v19, v20, v28
v_mov_b32 v5, 0
v_mov_b32 v6, 1
s_waitcnt vmcnt(0)
s_mov_b64 exec, 1
buffer_store_dword v6, v5, s[52:55], s65 offen sc1
s_mov_b64 exec, -1
s_barrier
ds_read_b128 a[116:119], v3 offset:0
ds_read_b128 a[120:123], v3 offset:1024
ds_read_b128 a[124:127], v3 offset:2048
ds_read_b128 a[128:131], v3 offset:3072
ds_read_b128 a[132:135], v3 offset:4096
ds_read_b128 a[136:139], v3 offset:5120
ds_read_b128 a[140:143], v3 offset:6144
ds_read_b128 a[144:147], v3 offset:7168
s_add_u32 m0, s29, 0
s_add_u32 s32, s25, 4096
buffer_load_dwordx4 v1, s[12:15], s25 offen offset:0 sc1 lds
buffer_load_dwordx4 v1, s[12:15], s25 offen offset:1024 sc1 lds
buffer_load_dwordx4 v1, s[12:15], s25 offen offset:2048 sc1 lds
buffer_load_dwordx4 v1, s[12:15], s25 offen offset:3072 sc1 lds
s_add_u32 m0, s29, 4096
s_nop 0
buffer_load_dwordx4 v1, s[12:15], s32 offen offset:0 sc1 lds
buffer_load_dwordx4 v1, s[12:15], s32 offen offset:1024 sc1 lds
buffer_load_dwordx4 v1, s[12:15], s32 offen offset:2048 sc1 lds
buffer_load_dwordx4 v1, s[12:15], s32 offen offset:3072 sc1 lds
s_add_u32 s25, s25, 32768
s_cmp_eq_u32 s25, s27
s_cselect_b32 s25, s28, s25
s_cselect_b32 s27, -1, s27
s_waitcnt lgkmcnt(4)
s_add_u32 m0, s29, 32768
M v[32:35], a[116:119], a[52:55], v[24:27]
M v[32:35], a[120:123], a[56:59], v[32:35]
ds_read_b128 a[148:151], v3 offset:8192
ds_read_b128 a[152:155], v3 offset:9216
M v[32:35], a[124:127], a[60:63], v[32:35]
M v[32:35], a[128:131], a[64:67], v[32:35]
buffer_load_dwordx4 v1, s[12:15], s26 offen offset:0 sc1 lds
s_add_u32 s32, s26, 4096
M v[36:39], a[128:131], a[80:83], v[28:31]
M v[36:39], a[124:127], a[76:79], v[36:39]
M v[36:39], a[120:123], a[72:75], v[36:39]
M v[36:39], a[116:119], a[68:71], v[36:39]
buffer_load_dwordx4 v1, s[12:15], s26 offen offset:1024 sc1 lds
M v[40:43], a[116:119], a[84:87], v[28:31]
M v[40:43], a[120:123], a[88:91], v[40:43]
ds_read_b128 a[156:159], v3 offset:10240
ds_read_b128 a[160:163], v3 offset:11264
M v[40:43], a[124:127], a[92:95], v[40:43]
M v[40:43], a[128:131], a[96:99], v[40:43]
buffer_load_dwordx4 v1, s[12:15], s26 offen offset:2048 sc1 lds
M v[44:47], a[128:131], a[112:115], v[28:31]
M v[44:47], a[124:127], a[108:111], v[44:47]
M v[44:47], a[120:123], a[104:107], v[44:47]
M v[44:47], a[116:119], a[100:103], v[44:47]
buffer_load_dwordx4 v1, s[12:15], s26 offen offset:3072 sc1 lds
s_add_u32 m0, s29, 36864
s_waitcnt lgkmcnt(4)
M v[48:51], a[132:135], a[52:55], v[20:23]
M v[48:51], a[136:139], a[56:59], v[48:51]
ds_read_b128 a[164:167], v3 offset:12288
ds_read_b128 a[168:171], v3 offset:13312
M v[48:51], a[140:143], a[60:63], v[48:51]
M v[48:51], a[144:147], a[64:67], v[48:51]
buffer_load_dwordx4 v1, s[12:15], s32 offen offset:0 sc1 lds
M v[52:55], a[144:147], a[80:83], v[24:27]
M v[52:55], a[140:143], a[76:79], v[52:55]
M v[52:55], a[136:139], a[72:75], v[52:55]
M v[52:55], a[132:135], a[68:71], v[52:55]
buffer_load_dwordx4 v1, s[12:15], s32 offen offset:1024 sc1 lds
M v[56:59], a[132:135], a[84:87], v[28:31]
M v[56:59], a[136:139], a[88:91], v[56:59]
ds_read_b128 a[172:175], v3 offset:14336
ds_read_b128 a[176:179], v3 offset:15360
M v[56:59], a[140:143], a[92:95], v[56:59]
M v[56:59], a[144:147], a[96:99], v[56:59]
buffer_load_dwordx4 v1, s[12:15], s32 offen offset:2048 sc1 lds
M v[60:63], a[144:147], a[112:115], v[28:31]
M v[60:63], a[140:143], a[108:111], v[60:63]
M v[60:63], a[136:139], a[104:107], v[60:63]
M v[60:63], a[132:135], a[100:103], v[60:63]
buffer_load_dwordx4 v1, s[12:15], s32 offen offset:3072 sc1 lds
s_waitcnt lgkmcnt(4)
M v[64:67], a[148:151], a[52:55], v[20:23]
M v[64:67], a[152:155], a[56:59], v[64:67]
s_add_u32 s26, s26, 32768
s_cmp_eq_u32 s26, s62
s_cselect_b32 s26, s63, s26
s_cselect_b32 s62, -1, s62
M v[64:67], a[156:159], a[60:63], v[64:67]
M v[64:67], a[160:163], a[64:67], v[64:67]
M v[68:71], a[160:163], a[80:83], v[20:23]
M v[68:71], a[156:159], a[76:79], v[68:71]
M v[68:71], a[152:155], a[72:75], v[68:71]
M v[68:71], a[148:151], a[68:71], v[68:71]
M v[72:75], a[148:151], a[84:87], v[24:27]
M v[72:75], a[152:155], a[88:91], v[72:75]
M v[72:75], a[156:159], a[92:95], v[72:75]
M v[72:75], a[160:163], a[96:99], v[72:75]
M v[76:79], a[160:163], a[112:115], v[28:31]
M v[76:79], a[156:159], a[108:111], v[76:79]
s_waitcnt vmcnt(8) lgkmcnt(0)
s_barrier
ds_read_b128 a[116:119], v2 offset:0
ds_read_b128 a[120:123], v2 offset:1024
ds_read_b128 a[124:127], v2 offset:2048
ds_read_b128 a[128:131], v2 offset:3072
M v[76:79], a[152:155], a[104:107], v[76:79]
M v[76:79], a[148:151], a[100:103], v[76:79]
M v[80:83], a[164:167], a[52:55], v[20:23]
M v[80:83], a[168:171], a[56:59], v[80:83]
ds_read_b128 a[132:135], v2 offset:4096
ds_read_b128 a[136:139], v2 offset:5120
M v[80:83], a[172:175], a[60:63], v[80:83]
M v[80:83], a[176:179], a[64:67], v[80:83]
M v[84:87], a[176:179], a[80:83], v[20:23]
M v[84:87], a[172:175], a[76:79], v[84:87]
M v[84:87], a[168:171], a[72:75], v[84:87]
M v[84:87], a[164:167], a[68:71], v[84:87]
M v[88:91], a[164:167], a[84:87], v[20:23]
M v[88:91], a[168:171], a[88:91], v[88:91]
ds_read_b128 a[140:143], v2 offset:6144
ds_read_b128 a[144:147], v2 offset:7168
M v[88:91], a[172:175], a[92:95], v[88:91]
M v[88:91], a[176:179], a[96:99], v[88:91]
M v[92:95], a[176:179], a[112:115], v[24:27]
M v[92:95], a[172:175], a[108:111], v[92:95]
M v[92:95], a[168:171], a[104:107], v[92:95]
M v[92:95], a[164:167], a[100:103], v[92:95]
s_add_u32 m0, s29, 65536
s_add_u32 s32, s25, 4096
buffer_load_dwordx4 v1, s[12:15], s25 offen offset:0 sc1 lds
buffer_load_dwordx4 v1, s[12:15], s25 offen offset:1024 sc1 lds
buffer_load_dwordx4 v1, s[12:15], s25 offen offset:2048 sc1 lds
buffer_load_dwordx4 v1, s[12:15], s25 offen offset:3072 sc1 lds
s_add_u32 m0, s29, 69632
s_nop 0
buffer_load_dwordx4 v1, s[12:15], s32 offen offset:0 sc1 lds
buffer_load_dwordx4 v1, s[12:15], s32 offen offset:1024 sc1 lds
buffer_load_dwordx4 v1, s[12:15], s32 offen offset:2048 sc1 lds
buffer_load_dwordx4 v1, s[12:15], s32 offen offset:3072 sc1 lds
s_add_u32 s25, s25, 32768
s_cmp_eq_u32 s25, s27
s_cselect_b32 s25, s28, s25
s_cselect_b32 s27, -1, s27
v_exp_f32 v32, v32
v_exp_f32 v33, v33
v_exp_f32 v34, v34
v_exp_f32 v35, v35
v_exp_f32 v48, v48
v_exp_f32 v49, v49
v_exp_f32 v50, v50
v_exp_f32 v51, v51
v_cvt_pk_bf16_f32 v32, v32, v33
v_cvt_pk_bf16_f32 v33, v34, v35
v_exp_f32 v36, v36
v_exp_f32 v37, v37
v_exp_f32 v38, v38
v_exp_f32 v39, v39
v_cvt_pk_bf16_f32 v34, v48, v49
v_cvt_pk_bf16_f32 v35, v50, v51
v_exp_f32 v52, v52
v_exp_f32 v53, v53
v_exp_f32 v54, v54
v_exp_f32 v55, v55
v_cvt_pk_bf16_f32 v36, v36, v37
v_cvt_pk_bf16_f32 v37, v38, v39
v_exp_f32 v40, v40
v_exp_f32 v41, v41
v_exp_f32 v42, v42
v_exp_f32 v43, v43
v_cvt_pk_bf16_f32 v38, v52, v53
v_cvt_pk_bf16_f32 v39, v54, v55
v_exp_f32 v56, v56
v_exp_f32 v57, v57
v_exp_f32 v58, v58
v_exp_f32 v59, v59
v_cvt_pk_bf16_f32 v40, v40, v41
v_cvt_pk_bf16_f32 v41, v42, v43
v_exp_f32 v44, v44
v_exp_f32 v45, v45
v_exp_f32 v46, v46
v_exp_f32 v47, v47
v_cvt_pk_bf16_f32 v42, v56, v57
v_cvt_pk_bf16_f32 v43, v58, v59
v_exp_f32 v60, v60
v_exp_f32 v61, v61
v_exp_f32 v62, v62
v_exp_f32 v63, v63
v_cvt_pk_bf16_f32 v44, v44, v45
v_cvt_pk_bf16_f32 v45, v46, v47
v_cvt_pk_bf16_f32 v46, v60, v61
v_cvt_pk_bf16_f32 v47, v62, v63
s_cmp_eq_u32 s24, 1
s_cbranch_scc1 Lk2_g1
s_mov_b32 s30, s21
s_cmp_eq_u32 s21, 0
s_cbranch_scc1 Lk2_m2
Lk2_l1:
s_waitcnt lgkmcnt(4)
s_add_u32 m0, s29, 98304
M v[96:99], a[116:119], a[52:55], 0
v_exp_f32 v64, v64
M v[96:99], a[120:123], a[56:59], v[96:99]
ds_read_b128 a[148:151], v2 offset:8192
ds_read_b128 a[152:155], v2 offset:9216
M v[96:99], a[124:127], a[60:63], v[96:99]
v_exp_f32 v65, v65
M v[96:99], a[128:131], a[64:67], v[96:99]
buffer_load_dwordx4 v1, s[12:15], s26 offen offset:0 sc1 lds
s_add_u32 s32, s26, 4096
M v[100:103], a[128:131], a[80:83], 0
v_exp_f32 v66, v66
M v[100:103], a[124:127], a[76:79], v[100:103]
v_cvt_pk_bf16_f32 v64, v64, v65
M v[100:103], a[120:123], a[72:75], v[100:103]
v_exp_f32 v67, v67
M v[100:103], a[116:119], a[68:71], v[100:103]
buffer_load_dwordx4 v1, s[12:15], s26 offen offset:1024 sc1 lds
M v[104:107], a[116:119], a[84:87], 0
v_exp_f32 v80, v80
M v[104:107], a[120:123], a[88:91], v[104:107]
ds_read_b128 a[156:159], v2 offset:10240
ds_read_b128 a[160:163], v2 offset:11264
M v[104:107], a[124:127], a[92:95], v[104:107]
v_exp_f32 v81, v81
M v[104:107], a[128:131], a[96:99], v[104:107]
buffer_load_dwordx4 v1, s[12:15], s26 offen offset:2048 sc1 lds
M v[108:111], a[128:131], a[112:115], 0
v_exp_f32 v82, v82
M v[108:111], a[124:127], a[108:111], v[108:111]
v_cvt_pk_bf16_f32 v65, v66, v67
v_cvt_pk_bf16_f32 v66, v80, v81
M v[108:111], a[120:123], a[104:107], v[108:111]
v_exp_f32 v83, v83
M v[108:111], a[116:119], a[100:103], v[108:111]
buffer_load_dwordx4 v1, s[12:15], s26 offen offset:3072 sc1 lds
s_add_u32 m0, s29, 102400
s_waitcnt lgkmcnt(4)
M v[112:115], a[132:135], a[52:55], 0
v_exp_f32 v68, v68
M v[112:115], a[136:139], a[56:59], v[112:115]
ds_read_b128 a[164:167], v2 offset:12288
ds_read_b128 a[168:171], v2 offset:13312
M v[112:115], a[140:143], a[60:63], v[112:115]
v_exp_f32 v69, v69
M v[112:115], a[144:147], a[64:67], v[112:115]
buffer_load_dwordx4 v1, s[12:15], s32 offen offset:0 sc1 lds
M v[116:119], a[144:147], a[80:83], 0
v_exp_f32 v70, v70
M v[116:119], a[140:143], a[76:79], v[116:119]
v_cvt_pk_bf16_f32 v67, v82, v83
v_cvt_pk_bf16_f32 v68, v68, v69
M v[116:119], a[136:139], a[72:75], v[116:119]
v_exp_f32 v71, v71
M v[116:119], a[132:135], a[68:71], v[116:119]
buffer_load_dwordx4 v1, s[12:15], s32 offen offset:1024 sc1 lds
M v[120:123], a[132:135], a[84:87], 0
v_exp_f32 v84, v84
M v[120:123], a[136:139], a[88:91], v[120:123]
ds_read_b128 a[172:175], v2 offset:14336
ds_read_b128 a[176:179], v2 offset:15360
M v[120:123], a[140:143], a[92:95], v[120:123]
v_exp_f32 v85, v85
M v[120:123], a[144:147], a[96:99], v[120:123]
buffer_load_dwordx4 v1, s[12:15], s32 offen offset:2048 sc1 lds
M v[124:127], a[144:147], a[112:115], 0
v_exp_f32 v86, v86
M v[124:127], a[140:143], a[108:111], v[124:127]
v_cvt_pk_bf16_f32 v69, v70, v71
v_cvt_pk_bf16_f32 v70, v84, v85
M v[124:127], a[136:139], a[104:107], v[124:127]
v_exp_f32 v87, v87
M v[124:127], a[132:135], a[100:103], v[124:127]
buffer_load_dwordx4 v1, s[12:15], s32 offen offset:3072 sc1 lds
s_waitcnt lgkmcnt(4)
M v[128:131], a[148:151], a[52:55], 0
v_exp_f32 v72, v72
M v[128:131], a[152:155], a[56:59], v[128:131]
s_add_u32 s26, s26, 32768
s_cmp_eq_u32 s26, s62
s_cselect_b32 s26, s63, s26
s_cselect_b32 s62, -1, s62
M v[128:131], a[156:159], a[60:63], v[128:131]
v_exp_f32 v73, v73
M v[128:131], a[160:163], a[64:67], v[128:131]
v_cvt_pk_bf16_f32 v71, v86, v87
v_cvt_pk_bf16_f32 v72, v72, v73
M v[132:135], a[160:163], a[80:83], 0
v_exp_f32 v74, v74
M v[132:135], a[156:159], a[76:79], v[132:135]
M v[132:135], a[152:155], a[72:75], v[132:135]
v_exp_f32 v75, v75
M v[132:135], a[148:151], a[68:71], v[132:135]
v_cvt_pk_bf16_f32 v73, v74, v75
M v[136:139], a[148:151], a[84:87], 0
v_exp_f32 v88, v88
M v[136:139], a[152:155], a[88:91], v[136:139]
M v[136:139], a[156:159], a[92:95], v[136:139]
v_exp_f32 v89, v89
M v[136:139], a[160:163], a[96:99], v[136:139]
v_cvt_pk_bf16_f32 v74, v88, v89
M v[140:143], a[160:163], a[112:115], 0
v_exp_f32 v90, v90
M v[140:143], a[156:159], a[108:111], v[140:143]
s_waitcnt vmcnt(16) lgkmcnt(0)
s_barrier
ds_read_b128 a[116:119], v2 offset:32768
ds_read_b128 a[120:123], v2 offset:40960
ds_read_b128 a[124:127], v2 offset:33792
ds_read_b128 a[128:131], v2 offset:41984
M v[140:143], a[152:155], a[104:107], v[140:143]
v_exp_f32 v91, v91
M v[140:143], a[148:151], a[100:103], v[140:143]
v_cvt_pk_bf16_f32 v75, v90, v91
M v[144:147], a[164:167], a[52:55], 0
v_exp_f32 v76, v76
M v[144:147], a[168:171], a[56:59], v[144:147]
ds_read_b128 a[132:135], v2 offset:34816
ds_read_b128 a[136:139], v2 offset:43008
M v[144:147], a[172:175], a[60:63], v[144:147]
v_exp_f32 v77, v77
M v[144:147], a[176:179], a[64:67], v[144:147]
v_cvt_pk_bf16_f32 v76, v76, v77
M v[148:151], a[176:179], a[80:83], 0
v_exp_f32 v78, v78
M v[148:151], a[172:175], a[76:79], v[148:151]
M v[148:151], a[168:171], a[72:75], v[148:151]
v_exp_f32 v79, v79
M v[148:151], a[164:167], a[68:71], v[148:151]
v_cvt_pk_bf16_f32 v77, v78, v79
M v[152:155], a[164:167], a[84:87], 0
v_exp_f32 v92, v92
M v[152:155], a[168:171], a[88:91], v[152:155]
ds_read_b128 a[140:143], v2 offset:35840
ds_read_b128 a[144:147], v2 offset:44032
M v[152:155], a[172:175], a[92:95], v[152:155]
v_exp_f32 v93, v93
M v[152:155], a[176:179], a[96:99], v[152:155]
v_cvt_pk_bf16_f32 v78, v92, v93
M v[156:159], a[176:179], a[112:115], 0
v_exp_f32 v94, v94
M v[156:159], a[172:175], a[108:111], v[156:159]
M v[156:159], a[168:171], a[104:107], v[156:159]
v_exp_f32 v95, v95
M v[156:159], a[164:167], a[100:103], v[156:159]
v_cvt_pk_bf16_f32 v79, v94, v95
s_waitcnt lgkmcnt(6)
s_add_u32 m0, s29, 0
M v[160:163], a[116:119], v[32:35], v[160:163]
v_exp_f32 v96, v96
M v[160:163], a[120:123], v[64:67], v[160:163]
ds_read_b128 a[148:151], v2 offset:36864
ds_read_b128 a[152:155], v2 offset:45056
M v[164:167], a[120:123], v[68:71], v[164:167]
v_exp_f32 v97, v97
M v[164:167], a[116:119], v[36:39], v[164:167]
buffer_load_dwordx4 v1, s[12:15], s25 offen offset:0 sc1 lds
s_add_u32 s32, s25, 4096
M v[168:171], a[116:119], v[40:43], v[168:171]
v_exp_f32 v98, v98
M v[168:171], a[120:123], v[72:75], v[168:171]
v_cvt_pk_bf16_f32 v96, v96, v97
M v[172:175], a[120:123], v[76:79], v[172:175]
v_exp_f32 v99, v99
M v[172:175], a[116:119], v[44:47], v[172:175]
buffer_load_dwordx4 v1, s[12:15], s25 offen offset:1024 sc1 lds
s_waitcnt lgkmcnt(6)
M a[32:35], a[48:51], v[32:35], a[32:35]
M a[32:35], a[48:51], v[64:67], a[32:35]
M v[176:179], a[124:127], v[32:35], v[176:179]
v_exp_f32 v112, v112
M v[176:179], a[128:131], v[64:67], v[176:179]
ds_read_b128 a[156:159], v2 offset:37888
ds_read_b128 a[160:163], v2 offset:46080
M v[180:183], a[128:131], v[68:71], v[180:183]
v_exp_f32 v113, v113
M v[180:183], a[124:127], v[36:39], v[180:183]
buffer_load_dwordx4 v1, s[12:15], s25 offen offset:2048 sc1 lds
M v[184:187], a[124:127], v[40:43], v[184:187]
v_exp_f32 v114, v114
M v[184:187], a[128:131], v[72:75], v[184:187]
v_cvt_pk_bf16_f32 v97, v98, v99
v_cvt_pk_bf16_f32 v98, v112, v113
M v[188:191], a[128:131], v[76:79], v[188:191]
v_exp_f32 v115, v115
M v[188:191], a[124:127], v[44:47], v[188:191]
buffer_load_dwordx4 v1, s[12:15], s25 offen offset:3072 sc1 lds
s_add_u32 m0, s29, 4096
s_waitcnt lgkmcnt(6)
M a[36:39], a[48:51], v[36:39], a[36:39]
M a[36:39], a[48:51], v[68:71], a[36:39]
M v[192:195], a[132:135], v[32:35], v[192:195]
v_exp_f32 v100, v100
M v[192:195], a[136:139], v[64:67], v[192:195]
ds_read_b128 a[164:167], v2 offset:38912
ds_read_b128 a[168:171], v2 offset:47104
M v[196:199], a[136:139], v[68:71], v[196:199]
v_exp_f32 v101, v101
M v[196:199], a[132:135], v[36:39], v[196:199]
buffer_load_dwordx4 v1, s[12:15], s32 offen offset:0 sc1 lds
M v[200:203], a[132:135], v[40:43], v[200:203]
v_exp_f32 v102, v102
M v[200:203], a[136:139], v[72:75], v[200:203]
v_cvt_pk_bf16_f32 v99, v114, v115
v_cvt_pk_bf16_f32 v100, v100, v101
M v[204:207], a[136:139], v[76:79], v[204:207]
v_exp_f32 v103, v103
M v[204:207], a[132:135], v[44:47], v[204:207]
buffer_load_dwordx4 v1, s[12:15], s32 offen offset:1024 sc1 lds
s_waitcnt lgkmcnt(6)
M a[40:43], a[48:51], v[40:43], a[40:43]
M a[40:43], a[48:51], v[72:75], a[40:43]
M v[208:211], a[140:143], v[32:35], v[208:211]
v_exp_f32 v116, v116
M v[208:211], a[144:147], v[64:67], v[208:211]
ds_read_b128 a[172:175], v2 offset:39936
ds_read_b128 a[176:179], v2 offset:48128
M v[212:215], a[144:147], v[68:71], v[212:215]
v_exp_f32 v117, v117
M v[212:215], a[140:143], v[36:39], v[212:215]
buffer_load_dwordx4 v1, s[12:15], s32 offen offset:2048 sc1 lds
M v[216:219], a[140:143], v[40:43], v[216:219]
v_exp_f32 v118, v118
M v[216:219], a[144:147], v[72:75], v[216:219]
v_cvt_pk_bf16_f32 v101, v102, v103
v_cvt_pk_bf16_f32 v102, v116, v117
M v[220:223], a[144:147], v[76:79], v[220:223]
v_exp_f32 v119, v119
M v[220:223], a[140:143], v[44:47], v[220:223]
buffer_load_dwordx4 v1, s[12:15], s32 offen offset:3072 sc1 lds
s_waitcnt lgkmcnt(6)
M a[44:47], a[48:51], v[44:47], a[44:47]
M a[44:47], a[48:51], v[76:79], a[44:47]
M v[224:227], a[148:151], v[32:35], v[224:227]
v_exp_f32 v104, v104
M v[224:227], a[152:155], v[64:67], v[224:227]
s_add_u32 s25, s25, 32768
s_cmp_eq_u32 s25, s27
s_cselect_b32 s25, s28, s25
s_cselect_b32 s27, -1, s27
M v[228:231], a[152:155], v[68:71], v[228:231]
v_exp_f32 v105, v105
M v[228:231], a[148:151], v[36:39], v[228:231]
v_cvt_pk_bf16_f32 v103, v118, v119
v_cvt_pk_bf16_f32 v104, v104, v105
M v[232:235], a[148:151], v[40:43], v[232:235]
v_exp_f32 v106, v106
M v[232:235], a[152:155], v[72:75], v[232:235]
M v[236:239], a[152:155], v[76:79], v[236:239]
v_exp_f32 v107, v107
M v[236:239], a[148:151], v[44:47], v[236:239]
v_cvt_pk_bf16_f32 v105, v106, v107
s_waitcnt lgkmcnt(4)
M v[240:243], a[156:159], v[32:35], v[240:243]
v_exp_f32 v120, v120
M v[240:243], a[160:163], v[64:67], v[240:243]
M v[244:247], a[160:163], v[68:71], v[244:247]
v_exp_f32 v121, v121
M v[244:247], a[156:159], v[36:39], v[244:247]
v_cvt_pk_bf16_f32 v106, v120, v121
M v[248:251], a[156:159], v[40:43], v[248:251]
v_exp_f32 v122, v122
M v[248:251], a[160:163], v[72:75], v[248:251]
s_waitcnt vmcnt(16) lgkmcnt(0)
s_barrier
ds_read_b128 a[116:119], v3 offset:0
ds_read_b128 a[120:123], v3 offset:1024
ds_read_b128 a[124:127], v3 offset:2048
ds_read_b128 a[128:131], v3 offset:3072
M v[252:255], a[160:163], v[76:79], v[252:255]
v_exp_f32 v123, v123
M v[252:255], a[156:159], v[44:47], v[252:255]
v_cvt_pk_bf16_f32 v107, v122, v123
M a[0:3], a[164:167], v[32:35], a[0:3]
v_exp_f32 v108, v108
M a[0:3], a[168:171], v[64:67], a[0:3]
ds_read_b128 a[132:135], v3 offset:4096
ds_read_b128 a[136:139], v3 offset:5120
M a[4:7], a[168:171], v[68:71], a[4:7]
v_exp_f32 v109, v109
M a[4:7], a[164:167], v[36:39], a[4:7]
v_cvt_pk_bf16_f32 v108, v108, v109
M a[8:11], a[164:167], v[40:43], a[8:11]
v_exp_f32 v110, v110
M a[8:11], a[168:171], v[72:75], a[8:11]
M a[12:15], a[168:171], v[76:79], a[12:15]
v_exp_f32 v111, v111
M a[12:15], a[164:167], v[44:47], a[12:15]
v_cvt_pk_bf16_f32 v109, v110, v111
M a[16:19], a[172:175], v[32:35], a[16:19]
v_exp_f32 v124, v124
M a[16:19], a[176:179], v[64:67], a[16:19]
ds_read_b128 a[140:143], v3 offset:6144
ds_read_b128 a[144:147], v3 offset:7168
M a[20:23], a[176:179], v[68:71], a[20:23]
v_exp_f32 v125, v125
M a[20:23], a[172:175], v[36:39], a[20:23]
v_cvt_pk_bf16_f32 v110, v124, v125
M a[24:27], a[172:175], v[40:43], a[24:27]
v_exp_f32 v126, v126
M a[24:27], a[176:179], v[72:75], a[24:27]
M a[28:31], a[176:179], v[76:79], a[28:31]
v_exp_f32 v127, v127
M a[28:31], a[172:175], v[44:47], a[28:31]
v_cvt_pk_bf16_f32 v111, v126, v127
s_sub_u32 s30, s30, 1
s_cmp_eq_u32 s30, 0
s_cbranch_scc1 Lk2_m1
s_waitcnt lgkmcnt(4)
s_add_u32 m0, s29, 32768
M v[32:35], a[116:119], a[52:55], 0
v_exp_f32 v128, v128
M v[32:35], a[120:123], a[56:59], v[32:35]
ds_read_b128 a[148:151], v3 offset:8192
ds_read_b128 a[152:155], v3 offset:9216
M v[32:35], a[124:127], a[60:63], v[32:35]
v_exp_f32 v129, v129
M v[32:35], a[128:131], a[64:67], v[32:35]
buffer_load_dwordx4 v1, s[12:15], s26 offen offset:0 sc1 lds
s_add_u32 s32, s26, 4096
M v[36:39], a[128:131], a[80:83], 0
v_exp_f32 v130, v130
M v[36:39], a[124:127], a[76:79], v[36:39]
v_cvt_pk_bf16_f32 v128, v128, v129
M v[36:39], a[120:123], a[72:75], v[36:39]
v_exp_f32 v131, v131
M v[36:39], a[116:119], a[68:71], v[36:39]
buffer_load_dwordx4 v1, s[12:15], s26 offen offset:1024 sc1 lds
M v[40:43], a[116:119], a[84:87], 0
v_exp_f32 v144, v144
M v[40:43], a[120:123], a[88:91], v[40:43]
ds_read_b128 a[156:159], v3 offset:10240
ds_read_b128 a[160:163], v3 offset:11264
M v[40:43], a[124:127], a[92:95], v[40:43]
v_exp_f32 v145, v145
M v[40:43], a[128:131], a[96:99], v[40:43]
buffer_load_dwordx4 v1, s[12:15], s26 offen offset:2048 sc1 lds
M v[44:47], a[128:131], a[112:115], 0
v_exp_f32 v146, v146
M v[44:47], a[124:127], a[108:111], v[44:47]
v_cvt_pk_bf16_f32 v129, v130, v131
v_cvt_pk_bf16_f32 v130, v144, v145
M v[44:47], a[120:123], a[104:107], v[44:47]
v_exp_f32 v147, v147
M v[44:47], a[116:119], a[100:103], v[44:47]
buffer_load_dwordx4 v1, s[12:15], s26 offen offset:3072 sc1 lds
s_add_u32 m0, s29, 36864
s_waitcnt lgkmcnt(4)
M v[48:51], a[132:135], a[52:55], 0
v_exp_f32 v132, v132
M v[48:51], a[136:139], a[56:59], v[48:51]
ds_read_b128 a[164:167], v3 offset:12288
ds_read_b128 a[168:171], v3 offset:13312
M v[48:51], a[140:143], a[60:63], v[48:51]
v_exp_f32 v133, v133
M v[48:51], a[144:147], a[64:67], v[48:51]
buffer_load_dwordx4 v1, s[12:15], s32 offen offset:0 sc1 lds
M v[52:55], a[144:147], a[80:83], 0
v_exp_f32 v134, v134
M v[52:55], a[140:143], a[76:79], v[52:55]
v_cvt_pk_bf16_f32 v131, v146, v147
v_cvt_pk_bf16_f32 v132, v132, v133
M v[52:55], a[136:139], a[72:75], v[52:55]
v_exp_f32 v135, v135
M v[52:55], a[132:135], a[68:71], v[52:55]
buffer_load_dwordx4 v1, s[12:15], s32 offen offset:1024 sc1 lds
M v[56:59], a[132:135], a[84:87], 0
v_exp_f32 v148, v148
M v[56:59], a[136:139], a[88:91], v[56:59]
ds_read_b128 a[172:175], v3 offset:14336
ds_read_b128 a[176:179], v3 offset:15360
M v[56:59], a[140:143], a[92:95], v[56:59]
v_exp_f32 v149, v149
M v[56:59], a[144:147], a[96:99], v[56:59]
buffer_load_dwordx4 v1, s[12:15], s32 offen offset:2048 sc1 lds
M v[60:63], a[144:147], a[112:115], 0
v_exp_f32 v150, v150
M v[60:63], a[140:143], a[108:111], v[60:63]
v_cvt_pk_bf16_f32 v133, v134, v135
v_cvt_pk_bf16_f32 v134, v148, v149
M v[60:63], a[136:139], a[104:107], v[60:63]
v_exp_f32 v151, v151
M v[60:63], a[132:135], a[100:103], v[60:63]
buffer_load_dwordx4 v1, s[12:15], s32 offen offset:3072 sc1 lds
s_waitcnt lgkmcnt(4)
M v[64:67], a[148:151], a[52:55], 0
v_exp_f32 v136, v136
M v[64:67], a[152:155], a[56:59], v[64:67]
s_add_u32 s26, s26, 32768
s_cmp_eq_u32 s26, s62
s_cselect_b32 s26, s63, s26
s_cselect_b32 s62, -1, s62
M v[64:67], a[156:159], a[60:63], v[64:67]
v_exp_f32 v137, v137
M v[64:67], a[160:163], a[64:67], v[64:67]
v_cvt_pk_bf16_f32 v135, v150, v151
v_cvt_pk_bf16_f32 v136, v136, v137
M v[68:71], a[160:163], a[80:83], 0
v_exp_f32 v138, v138
M v[68:71], a[156:159], a[76:79], v[68:71]
M v[68:71], a[152:155], a[72:75], v[68:71]
v_exp_f32 v139, v139
M v[68:71], a[148:151], a[68:71], v[68:71]
v_cvt_pk_bf16_f32 v137, v138, v139
M v[72:75], a[148:151], a[84:87], 0
v_exp_f32 v152, v152
M v[72:75], a[152:155], a[88:91], v[72:75]
M v[72:75], a[156:159], a[92:95], v[72:75]
v_exp_f32 v153, v153
M v[72:75], a[160:163], a[96:99], v[72:75]
v_cvt_pk_bf16_f32 v138, v152, v153
M v[76:79], a[160:163], a[112:115], 0
v_exp_f32 v154, v154
M v[76:79], a[156:159], a[108:111], v[76:79]
s_waitcnt vmcnt(16) lgkmcnt(0)
s_barrier
ds_read_b128 a[116:119], v3 offset:32768
ds_read_b128 a[120:123], v3 offset:40960
ds_read_b128 a[124:127], v3 offset:33792
ds_read_b128 a[128:131], v3 offset:41984
M v[76:79], a[152:155], a[104:107], v[76:79]
v_exp_f32 v155, v155
M v[76:79], a[148:151], a[100:103], v[76:79]
v_cvt_pk_bf16_f32 v139, v154, v155
M v[80:83], a[164:167], a[52:55], 0
v_exp_f32 v140, v140
M v[80:83], a[168:171], a[56:59], v[80:83]
ds_read_b128 a[132:135], v3 offset:34816
ds_read_b128 a[136:139], v3 offset:43008
M v[80:83], a[172:175], a[60:63], v[80:83]
v_exp_f32 v141, v141
M v[80:83], a[176:179], a[64:67], v[80:83]
v_cvt_pk_bf16_f32 v140, v140, v141
M v[84:87], a[176:179], a[80:83], 0
v_exp_f32 v142, v142
M v[84:87], a[172:175], a[76:79], v[84:87]
M v[84:87], a[168:171], a[72:75], v[84:87]
v_exp_f32 v143, v143
M v[84:87], a[164:167], a[68:71], v[84:87]
v_cvt_pk_bf16_f32 v141, v142, v143
M v[88:91], a[164:167], a[84:87], 0
v_exp_f32 v156, v156
M v[88:91], a[168:171], a[88:91], v[88:91]
ds_read_b128 a[140:143], v3 offset:35840
ds_read_b128 a[144:147], v3 offset:44032
M v[88:91], a[172:175], a[92:95], v[88:91]
v_exp_f32 v157, v157
M v[88:91], a[176:179], a[96:99], v[88:91]
v_cvt_pk_bf16_f32 v142, v156, v157
M v[92:95], a[176:179], a[112:115], 0
v_exp_f32 v158, v158
M v[92:95], a[172:175], a[108:111], v[92:95]
M v[92:95], a[168:171], a[104:107], v[92:95]
v_exp_f32 v159, v159
M v[92:95], a[164:167], a[100:103], v[92:95]
v_cvt_pk_bf16_f32 v143, v158, v159
s_waitcnt lgkmcnt(6)
s_add_u32 m0, s29, 65536
M v[160:163], a[116:119], v[96:99], v[160:163]
v_exp_f32 v32, v32
M v[160:163], a[120:123], v[128:131], v[160:163]
ds_read_b128 a[148:151], v3 offset:36864
ds_read_b128 a[152:155], v3 offset:45056
M v[164:167], a[120:123], v[132:135], v[164:167]
v_exp_f32 v33, v33
M v[164:167], a[116:119], v[100:103], v[164:167]
buffer_load_dwordx4 v1, s[12:15], s25 offen offset:0 sc1 lds
s_add_u32 s32, s25, 4096
M v[168:171], a[116:119], v[104:107], v[168:171]
v_exp_f32 v34, v34
M v[168:171], a[120:123], v[136:139], v[168:171]
v_cvt_pk_bf16_f32 v32, v32, v33
M v[172:175], a[120:123], v[140:143], v[172:175]
v_exp_f32 v35, v35
M v[172:175], a[116:119], v[108:111], v[172:175]
buffer_load_dwordx4 v1, s[12:15], s25 offen offset:1024 sc1 lds
s_waitcnt lgkmcnt(6)
M a[32:35], a[48:51], v[96:99], a[32:35]
M a[32:35], a[48:51], v[128:131], a[32:35]
M v[176:179], a[124:127], v[96:99], v[176:179]
v_exp_f32 v48, v48
M v[176:179], a[128:131], v[128:131], v[176:179]
ds_read_b128 a[156:159], v3 offset:37888
ds_read_b128 a[160:163], v3 offset:46080
M v[180:183], a[128:131], v[132:135], v[180:183]
v_exp_f32 v49, v49
M v[180:183], a[124:127], v[100:103], v[180:183]
buffer_load_dwordx4 v1, s[12:15], s25 offen offset:2048 sc1 lds
M v[184:187], a[124:127], v[104:107], v[184:187]
v_exp_f32 v50, v50
M v[184:187], a[128:131], v[136:139], v[184:187]
v_cvt_pk_bf16_f32 v33, v34, v35
v_cvt_pk_bf16_f32 v34, v48, v49
M v[188:191], a[128:131], v[140:143], v[188:191]
v_exp_f32 v51, v51
M v[188:191], a[124:127], v[108:111], v[188:191]
buffer_load_dwordx4 v1, s[12:15], s25 offen offset:3072 sc1 lds
s_add_u32 m0, s29, 69632
s_waitcnt lgkmcnt(6)
M a[36:39], a[48:51], v[100:103], a[36:39]
M a[36:39], a[48:51], v[132:135], a[36:39]
M v[192:195], a[132:135], v[96:99], v[192:195]
v_exp_f32 v36, v36
M v[192:195], a[136:139], v[128:131], v[192:195]
ds_read_b128 a[164:167], v3 offset:38912
ds_read_b128 a[168:171], v3 offset:47104
M v[196:199], a[136:139], v[132:135], v[196:199]
v_exp_f32 v37, v37
M v[196:199], a[132:135], v[100:103], v[196:199]
buffer_load_dwordx4 v1, s[12:15], s32 offen offset:0 sc1 lds
M v[200:203], a[132:135], v[104:107], v[200:203]
v_exp_f32 v38, v38
M v[200:203], a[136:139], v[136:139], v[200:203]
v_cvt_pk_bf16_f32 v35, v50, v51
v_cvt_pk_bf16_f32 v36, v36, v37
M v[204:207], a[136:139], v[140:143], v[204:207]
v_exp_f32 v39, v39
M v[204:207], a[132:135], v[108:111], v[204:207]
buffer_load_dwordx4 v1, s[12:15], s32 offen offset:1024 sc1 lds
s_waitcnt lgkmcnt(6)
M a[40:43], a[48:51], v[104:107], a[40:43]
M a[40:43], a[48:51], v[136:139], a[40:43]
M v[208:211], a[140:143], v[96:99], v[208:211]
v_exp_f32 v52, v52
M v[208:211], a[144:147], v[128:131], v[208:211]
ds_read_b128 a[172:175], v3 offset:39936
ds_read_b128 a[176:179], v3 offset:48128
M v[212:215], a[144:147], v[132:135], v[212:215]
v_exp_f32 v53, v53
M v[212:215], a[140:143], v[100:103], v[212:215]
buffer_load_dwordx4 v1, s[12:15], s32 offen offset:2048 sc1 lds
M v[216:219], a[140:143], v[104:107], v[216:219]
v_exp_f32 v54, v54
M v[216:219], a[144:147], v[136:139], v[216:219]
v_cvt_pk_bf16_f32 v37, v38, v39
v_cvt_pk_bf16_f32 v38, v52, v53
M v[220:223], a[144:147], v[140:143], v[220:223]
v_exp_f32 v55, v55
M v[220:223], a[140:143], v[108:111], v[220:223]
buffer_load_dwordx4 v1, s[12:15], s32 offen offset:3072 sc1 lds
s_waitcnt lgkmcnt(6)
M a[44:47], a[48:51], v[108:111], a[44:47]
M a[44:47], a[48:51], v[140:143], a[44:47]
M v[224:227], a[148:151], v[96:99], v[224:227]
v_exp_f32 v40, v40
M v[224:227], a[152:155], v[128:131], v[224:227]
s_add_u32 s25, s25, 32768
s_cmp_eq_u32 s25, s27
s_cselect_b32 s25, s28, s25
s_cselect_b32 s27, -1, s27
M v[228:231], a[152:155], v[132:135], v[228:231]
v_exp_f32 v41, v41
M v[228:231], a[148:151], v[100:103], v[228:231]
v_cvt_pk_bf16_f32 v39, v54, v55
v_cvt_pk_bf16_f32 v40, v40, v41
M v[232:235], a[148:151], v[104:107], v[232:235]
v_exp_f32 v42, v42
M v[232:235], a[152:155], v[136:139], v[232:235]
M v[236:239], a[152:155], v[140:143], v[236:239]
v_exp_f32 v43, v43
M v[236:239], a[148:151], v[108:111], v[236:239]
v_cvt_pk_bf16_f32 v41, v42, v43
s_waitcnt lgkmcnt(4)
M v[240:243], a[156:159], v[96:99], v[240:243]
v_exp_f32 v56, v56
M v[240:243], a[160:163], v[128:131], v[240:243]
M v[244:247], a[160:163], v[132:135], v[244:247]
v_exp_f32 v57, v57
M v[244:247], a[156:159], v[100:103], v[244:247]
v_cvt_pk_bf16_f32 v42, v56, v57
M v[248:251], a[156:159], v[104:107], v[248:251]
v_exp_f32 v58, v58
M v[248:251], a[160:163], v[136:139], v[248:251]
s_waitcnt vmcnt(16) lgkmcnt(0)
s_barrier
ds_read_b128 a[116:119], v2 offset:0
ds_read_b128 a[120:123], v2 offset:1024
ds_read_b128 a[124:127], v2 offset:2048
ds_read_b128 a[128:131], v2 offset:3072
M v[252:255], a[160:163], v[140:143], v[252:255]
v_exp_f32 v59, v59
M v[252:255], a[156:159], v[108:111], v[252:255]
v_cvt_pk_bf16_f32 v43, v58, v59
M a[0:3], a[164:167], v[96:99], a[0:3]
v_exp_f32 v44, v44
M a[0:3], a[168:171], v[128:131], a[0:3]
ds_read_b128 a[132:135], v2 offset:4096
ds_read_b128 a[136:139], v2 offset:5120
M a[4:7], a[168:171], v[132:135], a[4:7]
v_exp_f32 v45, v45
M a[4:7], a[164:167], v[100:103], a[4:7]
v_cvt_pk_bf16_f32 v44, v44, v45
M a[8:11], a[164:167], v[104:107], a[8:11]
v_exp_f32 v46, v46
M a[8:11], a[168:171], v[136:139], a[8:11]
M a[12:15], a[168:171], v[140:143], a[12:15]
v_exp_f32 v47, v47
M a[12:15], a[164:167], v[108:111], a[12:15]
v_cvt_pk_bf16_f32 v45, v46, v47
M a[16:19], a[172:175], v[96:99], a[16:19]
v_exp_f32 v60, v60
M a[16:19], a[176:179], v[128:131], a[16:19]
ds_read_b128 a[140:143], v2 offset:6144
ds_read_b128 a[144:147], v2 offset:7168
M a[20:23], a[176:179], v[132:135], a[20:23]
v_exp_f32 v61, v61
M a[20:23], a[172:175], v[100:103], a[20:23]
v_cvt_pk_bf16_f32 v46, v60, v61
M a[24:27], a[172:175], v[104:107], a[24:27]
v_exp_f32 v62, v62
M a[24:27], a[176:179], v[136:139], a[24:27]
M a[28:31], a[176:179], v[140:143], a[28:31]
v_exp_f32 v63, v63
M a[28:31], a[172:175], v[108:111], a[28:31]
v_cvt_pk_bf16_f32 v47, v62, v63
s_branch Lk2_l1
Lk2_m1:
s_lshl_b32 s33, s23, 6
s_add_i32 s33, s33, 0
s_cmp_gt_i32 s33, 0
s_cselect_b32 s34, 0, 0xf149f2ca
s_cmp_lt_i32 s33, 0
s_cselect_b32 s33, 0xf149f2ca, 0
v_mov_b32 v20, s34
v_mov_b32 v21, s34
v_mov_b32 v22, s34
v_mov_b32 v23, s34
v_mov_b32 v28, s33
v_mov_b32 v29, s33
v_mov_b32 v30, s33
v_mov_b32 v31, s33
v_med3_f32 v24, v16, v20, v28
v_med3_f32 v25, v17, v20, v28
v_med3_f32 v26, v18, v20, v28
v_med3_f32 v27, v19, v20, v28
s_waitcnt lgkmcnt(4)
s_add_u32 m0, s29, 32768
M v[32:35], a[116:119], a[52:55], v[24:27]
v_exp_f32 v128, v128
M v[32:35], a[120:123], a[56:59], v[32:35]
ds_read_b128 a[148:151], v3 offset:8192
ds_read_b128 a[152:155], v3 offset:9216
M v[32:35], a[124:127], a[60:63], v[32:35]
v_exp_f32 v129, v129
M v[32:35], a[128:131], a[64:67], v[32:35]
buffer_load_dwordx4 v1, s[12:15], s26 offen offset:0 sc1 lds
s_add_u32 s32, s26, 4096
M v[36:39], a[128:131], a[80:83], v[28:31]
v_exp_f32 v130, v130
M v[36:39], a[124:127], a[76:79], v[36:39]
v_cvt_pk_bf16_f32 v128, v128, v129
M v[36:39], a[120:123], a[72:75], v[36:39]
v_exp_f32 v131, v131
M v[36:39], a[116:119], a[68:71], v[36:39]
buffer_load_dwordx4 v1, s[12:15], s26 offen offset:1024 sc1 lds
M v[40:43], a[116:119], a[84:87], v[28:31]
v_exp_f32 v144, v144
M v[40:43], a[120:123], a[88:91], v[40:43]
ds_read_b128 a[156:159], v3 offset:10240
ds_read_b128 a[160:163], v3 offset:11264
M v[40:43], a[124:127], a[92:95], v[40:43]
v_exp_f32 v145, v145
M v[40:43], a[128:131], a[96:99], v[40:43]
buffer_load_dwordx4 v1, s[12:15], s26 offen offset:2048 sc1 lds
M v[44:47], a[128:131], a[112:115], v[28:31]
v_exp_f32 v146, v146
M v[44:47], a[124:127], a[108:111], v[44:47]
v_cvt_pk_bf16_f32 v129, v130, v131
v_cvt_pk_bf16_f32 v130, v144, v145
M v[44:47], a[120:123], a[104:107], v[44:47]
v_exp_f32 v147, v147
M v[44:47], a[116:119], a[100:103], v[44:47]
buffer_load_dwordx4 v1, s[12:15], s26 offen offset:3072 sc1 lds
s_add_u32 m0, s29, 36864
s_waitcnt lgkmcnt(4)
M v[48:51], a[132:135], a[52:55], v[20:23]
v_exp_f32 v132, v132
M v[48:51], a[136:139], a[56:59], v[48:51]
ds_read_b128 a[164:167], v3 offset:12288
ds_read_b128 a[168:171], v3 offset:13312
M v[48:51], a[140:143], a[60:63], v[48:51]
v_exp_f32 v133, v133
M v[48:51], a[144:147], a[64:67], v[48:51]
buffer_load_dwordx4 v1, s[12:15], s32 offen offset:0 sc1 lds
M v[52:55], a[144:147], a[80:83], v[24:27]
v_exp_f32 v134, v134
M v[52:55], a[140:143], a[76:79], v[52:55]
v_cvt_pk_bf16_f32 v131, v146, v147
v_cvt_pk_bf16_f32 v132, v132, v133
M v[52:55], a[136:139], a[72:75], v[52:55]
v_exp_f32 v135, v135
M v[52:55], a[132:135], a[68:71], v[52:55]
buffer_load_dwordx4 v1, s[12:15], s32 offen offset:1024 sc1 lds
M v[56:59], a[132:135], a[84:87], v[28:31]
v_exp_f32 v148, v148
M v[56:59], a[136:139], a[88:91], v[56:59]
ds_read_b128 a[172:175], v3 offset:14336
ds_read_b128 a[176:179], v3 offset:15360
M v[56:59], a[140:143], a[92:95], v[56:59]
v_exp_f32 v149, v149
M v[56:59], a[144:147], a[96:99], v[56:59]
buffer_load_dwordx4 v1, s[12:15], s32 offen offset:2048 sc1 lds
M v[60:63], a[144:147], a[112:115], v[28:31]
v_exp_f32 v150, v150
M v[60:63], a[140:143], a[108:111], v[60:63]
v_cvt_pk_bf16_f32 v133, v134, v135
v_cvt_pk_bf16_f32 v134, v148, v149
M v[60:63], a[136:139], a[104:107], v[60:63]
v_exp_f32 v151, v151
M v[60:63], a[132:135], a[100:103], v[60:63]
buffer_load_dwordx4 v1, s[12:15], s32 offen offset:3072 sc1 lds
s_waitcnt lgkmcnt(4)
M v[64:67], a[148:151], a[52:55], v[20:23]
v_exp_f32 v136, v136
M v[64:67], a[152:155], a[56:59], v[64:67]
s_add_u32 s26, s26, 32768
s_cmp_eq_u32 s26, s62
s_cselect_b32 s26, s63, s26
s_cselect_b32 s62, -1, s62
M v[64:67], a[156:159], a[60:63], v[64:67]
v_exp_f32 v137, v137
M v[64:67], a[160:163], a[64:67], v[64:67]
v_cvt_pk_bf16_f32 v135, v150, v151
v_cvt_pk_bf16_f32 v136, v136, v137
M v[68:71], a[160:163], a[80:83], v[20:23]
v_exp_f32 v138, v138
M v[68:71], a[156:159], a[76:79], v[68:71]
M v[68:71], a[152:155], a[72:75], v[68:71]
v_exp_f32 v139, v139
M v[68:71], a[148:151], a[68:71], v[68:71]
v_cvt_pk_bf16_f32 v137, v138, v139
M v[72:75], a[148:151], a[84:87], v[24:27]
v_exp_f32 v152, v152
M v[72:75], a[152:155], a[88:91], v[72:75]
M v[72:75], a[156:159], a[92:95], v[72:75]
v_exp_f32 v153, v153
M v[72:75], a[160:163], a[96:99], v[72:75]
v_cvt_pk_bf16_f32 v138, v152, v153
M v[76:79], a[160:163], a[112:115], v[28:31]
v_exp_f32 v154, v154
M v[76:79], a[156:159], a[108:111], v[76:79]
s_waitcnt vmcnt(16) lgkmcnt(0)
s_barrier
ds_read_b128 a[116:119], v3 offset:32768
ds_read_b128 a[120:123], v3 offset:40960
ds_read_b128 a[124:127], v3 offset:33792
ds_read_b128 a[128:131], v3 offset:41984
M v[76:79], a[152:155], a[104:107], v[76:79]
v_exp_f32 v155, v155
M v[76:79], a[148:151], a[100:103], v[76:79]
v_cvt_pk_bf16_f32 v139, v154, v155
M v[80:83], a[164:167], a[52:55], v[20:23]
v_exp_f32 v140, v140
M v[80:83], a[168:171], a[56:59], v[80:83]
ds_read_b128 a[132:135], v3 offset:34816
ds_read_b128 a[136:139], v3 offset:43008
M v[80:83], a[172:175], a[60:63], v[80:83]
v_exp_f32 v141, v141
M v[80:83], a[176:179], a[64:67], v[80:83]
v_cvt_pk_bf16_f32 v140, v140, v141
M v[84:87], a[176:179], a[80:83], v[20:23]
v_exp_f32 v142, v142
M v[84:87], a[172:175], a[76:79], v[84:87]
M v[84:87], a[168:171], a[72:75], v[84:87]
v_exp_f32 v143, v143
M v[84:87], a[164:167], a[68:71], v[84:87]
v_cvt_pk_bf16_f32 v141, v142, v143
M v[88:91], a[164:167], a[84:87], v[20:23]
v_exp_f32 v156, v156
M v[88:91], a[168:171], a[88:91], v[88:91]
ds_read_b128 a[140:143], v3 offset:35840
ds_read_b128 a[144:147], v3 offset:44032
M v[88:91], a[172:175], a[92:95], v[88:91]
v_exp_f32 v157, v157
M v[88:91], a[176:179], a[96:99], v[88:91]
v_cvt_pk_bf16_f32 v142, v156, v157
M v[92:95], a[176:179], a[112:115], v[24:27]
v_exp_f32 v158, v158
M v[92:95], a[172:175], a[108:111], v[92:95]
M v[92:95], a[168:171], a[104:107], v[92:95]
v_exp_f32 v159, v159
M v[92:95], a[164:167], a[100:103], v[92:95]
v_cvt_pk_bf16_f32 v143, v158, v159
s_waitcnt lgkmcnt(6)
s_add_u32 m0, s29, 65536
M v[160:163], a[116:119], v[96:99], v[160:163]
v_exp_f32 v32, v32
M v[160:163], a[120:123], v[128:131], v[160:163]
ds_read_b128 a[148:151], v3 offset:36864
ds_read_b128 a[152:155], v3 offset:45056
M v[164:167], a[120:123], v[132:135], v[164:167]
v_exp_f32 v33, v33
M v[164:167], a[116:119], v[100:103], v[164:167]
buffer_load_dwordx4 v1, s[12:15], s25 offen offset:0 sc1 lds
s_add_u32 s32, s25, 4096
M v[168:171], a[116:119], v[104:107], v[168:171]
v_exp_f32 v34, v34
M v[168:171], a[120:123], v[136:139], v[168:171]
v_cvt_pk_bf16_f32 v32, v32, v33
M v[172:175], a[120:123], v[140:143], v[172:175]
v_exp_f32 v35, v35
M v[172:175], a[116:119], v[108:111], v[172:175]
buffer_load_dwordx4 v1, s[12:15], s25 offen offset:1024 sc1 lds
s_waitcnt lgkmcnt(6)
M a[32:35], a[48:51], v[96:99], a[32:35]
M a[32:35], a[48:51], v[128:131], a[32:35]
M v[176:179], a[124:127], v[96:99], v[176:179]
v_exp_f32 v48, v48
M v[176:179], a[128:131], v[128:131], v[176:179]
ds_read_b128 a[156:159], v3 offset:37888
ds_read_b128 a[160:163], v3 offset:46080
M v[180:183], a[128:131], v[132:135], v[180:183]
v_exp_f32 v49, v49
M v[180:183], a[124:127], v[100:103], v[180:183]
buffer_load_dwordx4 v1, s[12:15], s25 offen offset:2048 sc1 lds
M v[184:187], a[124:127], v[104:107], v[184:187]
v_exp_f32 v50, v50
M v[184:187], a[128:131], v[136:139], v[184:187]
v_cvt_pk_bf16_f32 v33, v34, v35
v_cvt_pk_bf16_f32 v34, v48, v49
M v[188:191], a[128:131], v[140:143], v[188:191]
v_exp_f32 v51, v51
M v[188:191], a[124:127], v[108:111], v[188:191]
buffer_load_dwordx4 v1, s[12:15], s25 offen offset:3072 sc1 lds
s_add_u32 m0, s29, 69632
s_waitcnt lgkmcnt(6)
M a[36:39], a[48:51], v[100:103], a[36:39]
M a[36:39], a[48:51], v[132:135], a[36:39]
M v[192:195], a[132:135], v[96:99], v[192:195]
v_exp_f32 v36, v36
M v[192:195], a[136:139], v[128:131], v[192:195]
ds_read_b128 a[164:167], v3 offset:38912
ds_read_b128 a[168:171], v3 offset:47104
M v[196:199], a[136:139], v[132:135], v[196:199]
v_exp_f32 v37, v37
M v[196:199], a[132:135], v[100:103], v[196:199]
buffer_load_dwordx4 v1, s[12:15], s32 offen offset:0 sc1 lds
M v[200:203], a[132:135], v[104:107], v[200:203]
v_exp_f32 v38, v38
M v[200:203], a[136:139], v[136:139], v[200:203]
v_cvt_pk_bf16_f32 v35, v50, v51
v_cvt_pk_bf16_f32 v36, v36, v37
M v[204:207], a[136:139], v[140:143], v[204:207]
v_exp_f32 v39, v39
M v[204:207], a[132:135], v[108:111], v[204:207]
buffer_load_dwordx4 v1, s[12:15], s32 offen offset:1024 sc1 lds
s_waitcnt lgkmcnt(6)
M a[40:43], a[48:51], v[104:107], a[40:43]
M a[40:43], a[48:51], v[136:139], a[40:43]
M v[208:211], a[140:143], v[96:99], v[208:211]
v_exp_f32 v52, v52
M v[208:211], a[144:147], v[128:131], v[208:211]
ds_read_b128 a[172:175], v3 offset:39936
ds_read_b128 a[176:179], v3 offset:48128
M v[212:215], a[144:147], v[132:135], v[212:215]
v_exp_f32 v53, v53
M v[212:215], a[140:143], v[100:103], v[212:215]
buffer_load_dwordx4 v1, s[12:15], s32 offen offset:2048 sc1 lds
M v[216:219], a[140:143], v[104:107], v[216:219]
v_exp_f32 v54, v54
M v[216:219], a[144:147], v[136:139], v[216:219]
v_cvt_pk_bf16_f32 v37, v38, v39
v_cvt_pk_bf16_f32 v38, v52, v53
M v[220:223], a[144:147], v[140:143], v[220:223]
v_exp_f32 v55, v55
M v[220:223], a[140:143], v[108:111], v[220:223]
buffer_load_dwordx4 v1, s[12:15], s32 offen offset:3072 sc1 lds
s_waitcnt lgkmcnt(6)
M a[44:47], a[48:51], v[108:111], a[44:47]
M a[44:47], a[48:51], v[140:143], a[44:47]
M v[224:227], a[148:151], v[96:99], v[224:227]
v_exp_f32 v40, v40
M v[224:227], a[152:155], v[128:131], v[224:227]
s_add_u32 s25, s25, 32768
s_cmp_eq_u32 s25, s27
s_cselect_b32 s25, s28, s25
s_cselect_b32 s27, -1, s27
M v[228:231], a[152:155], v[132:135], v[228:231]
v_exp_f32 v41, v41
M v[228:231], a[148:151], v[100:103], v[228:231]
v_cvt_pk_bf16_f32 v39, v54, v55
v_cvt_pk_bf16_f32 v40, v40, v41
M v[232:235], a[148:151], v[104:107], v[232:235]
v_exp_f32 v42, v42
M v[232:235], a[152:155], v[136:139], v[232:235]
M v[236:239], a[152:155], v[140:143], v[236:239]
v_exp_f32 v43, v43
M v[236:239], a[148:151], v[108:111], v[236:239]
v_cvt_pk_bf16_f32 v41, v42, v43
s_waitcnt lgkmcnt(4)
M v[240:243], a[156:159], v[96:99], v[240:243]
v_exp_f32 v56, v56
M v[240:243], a[160:163], v[128:131], v[240:243]
M v[244:247], a[160:163], v[132:135], v[244:247]
v_exp_f32 v57, v57
M v[244:247], a[156:159], v[100:103], v[244:247]
v_cvt_pk_bf16_f32 v42, v56, v57
M v[248:251], a[156:159], v[104:107], v[248:251]
v_exp_f32 v58, v58
M v[248:251], a[160:163], v[136:139], v[248:251]
s_waitcnt vmcnt(16) lgkmcnt(0)
s_barrier
ds_read_b128 a[116:119], v2 offset:0
ds_read_b128 a[120:123], v2 offset:1024
ds_read_b128 a[124:127], v2 offset:2048
ds_read_b128 a[128:131], v2 offset:3072
M v[252:255], a[160:163], v[140:143], v[252:255]
v_exp_f32 v59, v59
M v[252:255], a[156:159], v[108:111], v[252:255]
v_cvt_pk_bf16_f32 v43, v58, v59
M a[0:3], a[164:167], v[96:99], a[0:3]
v_exp_f32 v44, v44
M a[0:3], a[168:171], v[128:131], a[0:3]
ds_read_b128 a[132:135], v2 offset:4096
ds_read_b128 a[136:139], v2 offset:5120
M a[4:7], a[168:171], v[132:135], a[4:7]
v_exp_f32 v45, v45
M a[4:7], a[164:167], v[100:103], a[4:7]
v_cvt_pk_bf16_f32 v44, v44, v45
M a[8:11], a[164:167], v[104:107], a[8:11]
v_exp_f32 v46, v46
M a[8:11], a[168:171], v[136:139], a[8:11]
M a[12:15], a[168:171], v[140:143], a[12:15]
v_exp_f32 v47, v47
M a[12:15], a[164:167], v[108:111], a[12:15]
v_cvt_pk_bf16_f32 v45, v46, v47
M a[16:19], a[172:175], v[96:99], a[16:19]
v_exp_f32 v60, v60
M a[16:19], a[176:179], v[128:131], a[16:19]
ds_read_b128 a[140:143], v2 offset:6144
ds_read_b128 a[144:147], v2 offset:7168
M a[20:23], a[176:179], v[132:135], a[20:23]
v_exp_f32 v61, v61
M a[20:23], a[172:175], v[100:103], a[20:23]
v_cvt_pk_bf16_f32 v46, v60, v61
M a[24:27], a[172:175], v[104:107], a[24:27]
v_exp_f32 v62, v62
M a[24:27], a[176:179], v[136:139], a[24:27]
M a[28:31], a[176:179], v[140:143], a[28:31]
v_exp_f32 v63, v63
M a[28:31], a[172:175], v[108:111], a[28:31]
v_cvt_pk_bf16_f32 v47, v62, v63
Lk2_m2:
s_sub_u32 s35, 15, s21
s_lshl_b32 s33, s20, 7
s_lshl_b32 s34, s35, 3
s_add_u32 s33, s33, s34
s_lshl_b32 s34, s23, 2
s_add_u32 s33, s33, s34
s_lshl_b32 s33, s33, 12
buffer_load_dwordx4 a[180:183], v1, s[8:11], s33 offen offset:0 sc1
buffer_load_dwordx4 a[184:187], v1, s[8:11], s33 offen offset:1024 sc1
buffer_load_dwordx4 a[188:191], v1, s[8:11], s33 offen offset:2048 sc1
buffer_load_dwordx4 a[192:195], v1, s[8:11], s33 offen offset:3072 sc1
s_add_u32 s33, s33, 4096
buffer_load_dwordx4 a[196:199], v1, s[8:11], s33 offen offset:0 sc1
buffer_load_dwordx4 a[200:203], v1, s[8:11], s33 offen offset:1024 sc1
buffer_load_dwordx4 a[204:207], v1, s[8:11], s33 offen offset:2048 sc1
buffer_load_dwordx4 a[208:211], v1, s[8:11], s33 offen offset:3072 sc1
s_add_u32 s33, s33, 4096
buffer_load_dwordx4 a[212:215], v1, s[8:11], s33 offen offset:0 sc1
buffer_load_dwordx4 a[216:219], v1, s[8:11], s33 offen offset:1024 sc1
buffer_load_dwordx4 a[220:223], v1, s[8:11], s33 offen offset:2048 sc1
buffer_load_dwordx4 a[224:227], v1, s[8:11], s33 offen offset:3072 sc1
s_add_u32 s33, s33, 4096
buffer_load_dwordx4 a[228:231], v1, s[8:11], s33 offen offset:0 sc1
buffer_load_dwordx4 a[232:235], v1, s[8:11], s33 offen offset:1024 sc1
buffer_load_dwordx4 a[236:239], v1, s[8:11], s33 offen offset:2048 sc1
buffer_load_dwordx4 a[240:243], v1, s[8:11], s33 offen offset:3072 sc1
s_lshl_b32 s33, s23, 6
s_add_i32 s33, s33, -64
s_cmp_gt_i32 s33, 0
s_cselect_b32 s34, 0, 0xf149f2ca
s_cmp_lt_i32 s33, 0
s_cselect_b32 s33, 0xf149f2ca, 0
v_mov_b32 v20, s34
v_mov_b32 v21, s34
v_mov_b32 v22, s34
v_mov_b32 v23, s34
v_mov_b32 v28, s33
v_mov_b32 v29, s33
v_mov_b32 v30, s33
v_mov_b32 v31, s33
v_med3_f32 v24, v16, v20, v28
v_med3_f32 v25, v17, v20, v28
v_med3_f32 v26, v18, v20, v28
v_med3_f32 v27, v19, v20, v28
s_waitcnt lgkmcnt(4)
s_add_u32 m0, s29, 98304
M v[96:99], a[116:119], a[52:55], v[24:27]
v_exp_f32 v64, v64
M v[96:99], a[120:123], a[56:59], v[96:99]
ds_read_b128 a[148:151], v2 offset:8192
ds_read_b128 a[152:155], v2 offset:9216
M v[96:99], a[124:127], a[60:63], v[96:99]
v_exp_f32 v65, v65
M v[96:99], a[128:131], a[64:67], v[96:99]
buffer_load_dwordx4 v1, s[12:15], s26 offen offset:0 sc1 lds
s_add_u32 s32, s26, 4096
M v[100:103], a[128:131], a[80:83], v[28:31]
v_exp_f32 v66, v66
M v[100:103], a[124:127], a[76:79], v[100:103]
v_cvt_pk_bf16_f32 v64, v64, v65
M v[100:103], a[120:123], a[72:75], v[100:103]
v_exp_f32 v67, v67
M v[100:103], a[116:119], a[68:71], v[100:103]
buffer_load_dwordx4 v1, s[12:15], s26 offen offset:1024 sc1 lds
M v[104:107], a[116:119], a[84:87], v[28:31]
v_exp_f32 v80, v80
M v[104:107], a[120:123], a[88:91], v[104:107]
ds_read_b128 a[156:159], v2 offset:10240
ds_read_b128 a[160:163], v2 offset:11264
M v[104:107], a[124:127], a[92:95], v[104:107]
v_exp_f32 v81, v81
M v[104:107], a[128:131], a[96:99], v[104:107]
buffer_load_dwordx4 v1, s[12:15], s26 offen offset:2048 sc1 lds
M v[108:111], a[128:131], a[112:115], v[28:31]
v_exp_f32 v82, v82
M v[108:111], a[124:127], a[108:111], v[108:111]
v_cvt_pk_bf16_f32 v65, v66, v67
v_cvt_pk_bf16_f32 v66, v80, v81
M v[108:111], a[120:123], a[104:107], v[108:111]
v_exp_f32 v83, v83
M v[108:111], a[116:119], a[100:103], v[108:111]
buffer_load_dwordx4 v1, s[12:15], s26 offen offset:3072 sc1 lds
s_add_u32 m0, s29, 102400
s_waitcnt lgkmcnt(4)
M v[112:115], a[132:135], a[52:55], v[20:23]
v_exp_f32 v68, v68
M v[112:115], a[136:139], a[56:59], v[112:115]
ds_read_b128 a[164:167], v2 offset:12288
ds_read_b128 a[168:171], v2 offset:13312
M v[112:115], a[140:143], a[60:63], v[112:115]
v_exp_f32 v69, v69
M v[112:115], a[144:147], a[64:67], v[112:115]
buffer_load_dwordx4 v1, s[12:15], s32 offen offset:0 sc1 lds
M v[116:119], a[144:147], a[80:83], v[24:27]
v_exp_f32 v70, v70
M v[116:119], a[140:143], a[76:79], v[116:119]
v_cvt_pk_bf16_f32 v67, v82, v83
v_cvt_pk_bf16_f32 v68, v68, v69
M v[116:119], a[136:139], a[72:75], v[116:119]
v_exp_f32 v71, v71
M v[116:119], a[132:135], a[68:71], v[116:119]
buffer_load_dwordx4 v1, s[12:15], s32 offen offset:1024 sc1 lds
M v[120:123], a[132:135], a[84:87], v[28:31]
v_exp_f32 v84, v84
M v[120:123], a[136:139], a[88:91], v[120:123]
ds_read_b128 a[172:175], v2 offset:14336
ds_read_b128 a[176:179], v2 offset:15360
M v[120:123], a[140:143], a[92:95], v[120:123]
v_exp_f32 v85, v85
M v[120:123], a[144:147], a[96:99], v[120:123]
buffer_load_dwordx4 v1, s[12:15], s32 offen offset:2048 sc1 lds
M v[124:127], a[144:147], a[112:115], v[28:31]
v_exp_f32 v86, v86
M v[124:127], a[140:143], a[108:111], v[124:127]
v_cvt_pk_bf16_f32 v69, v70, v71
v_cvt_pk_bf16_f32 v70, v84, v85
M v[124:127], a[136:139], a[104:107], v[124:127]
v_exp_f32 v87, v87
M v[124:127], a[132:135], a[100:103], v[124:127]
buffer_load_dwordx4 v1, s[12:15], s32 offen offset:3072 sc1 lds
s_waitcnt lgkmcnt(4)
M v[128:131], a[148:151], a[52:55], v[20:23]
v_exp_f32 v72, v72
M v[128:131], a[152:155], a[56:59], v[128:131]
s_add_u32 s26, s26, 32768
s_cmp_eq_u32 s26, s62
s_cselect_b32 s26, s63, s26
s_cselect_b32 s62, -1, s62
M v[128:131], a[156:159], a[60:63], v[128:131]
v_exp_f32 v73, v73
M v[128:131], a[160:163], a[64:67], v[128:131]
v_cvt_pk_bf16_f32 v71, v86, v87
v_cvt_pk_bf16_f32 v72, v72, v73
M v[132:135], a[160:163], a[80:83], v[20:23]
v_exp_f32 v74, v74
M v[132:135], a[156:159], a[76:79], v[132:135]
M v[132:135], a[152:155], a[72:75], v[132:135]
v_exp_f32 v75, v75
M v[132:135], a[148:151], a[68:71], v[132:135]
v_cvt_pk_bf16_f32 v73, v74, v75
M v[136:139], a[148:151], a[84:87], v[24:27]
v_exp_f32 v88, v88
M v[136:139], a[152:155], a[88:91], v[136:139]
M v[136:139], a[156:159], a[92:95], v[136:139]
v_exp_f32 v89, v89
M v[136:139], a[160:163], a[96:99], v[136:139]
v_cvt_pk_bf16_f32 v74, v88, v89
M v[140:143], a[160:163], a[112:115], v[28:31]
v_exp_f32 v90, v90
M v[140:143], a[156:159], a[108:111], v[140:143]
s_waitcnt vmcnt(32) lgkmcnt(0)
s_barrier
ds_read_b128 a[116:119], v2 offset:32768
ds_read_b128 a[120:123], v2 offset:40960
ds_read_b128 a[124:127], v2 offset:33792
ds_read_b128 a[128:131], v2 offset:41984
M v[140:143], a[152:155], a[104:107], v[140:143]
v_exp_f32 v91, v91
M v[140:143], a[148:151], a[100:103], v[140:143]
v_cvt_pk_bf16_f32 v75, v90, v91
M v[144:147], a[164:167], a[52:55], v[20:23]
v_exp_f32 v76, v76
M v[144:147], a[168:171], a[56:59], v[144:147]
ds_read_b128 a[132:135], v2 offset:34816
ds_read_b128 a[136:139], v2 offset:43008
M v[144:147], a[172:175], a[60:63], v[144:147]
v_exp_f32 v77, v77
M v[144:147], a[176:179], a[64:67], v[144:147]
v_cvt_pk_bf16_f32 v76, v76, v77
M v[148:151], a[176:179], a[80:83], v[20:23]
v_exp_f32 v78, v78
M v[148:151], a[172:175], a[76:79], v[148:151]
M v[148:151], a[168:171], a[72:75], v[148:151]
v_exp_f32 v79, v79
M v[148:151], a[164:167], a[68:71], v[148:151]
v_cvt_pk_bf16_f32 v77, v78, v79
M v[152:155], a[164:167], a[84:87], v[20:23]
v_exp_f32 v92, v92
M v[152:155], a[168:171], a[88:91], v[152:155]
ds_read_b128 a[140:143], v2 offset:35840
ds_read_b128 a[144:147], v2 offset:44032
M v[152:155], a[172:175], a[92:95], v[152:155]
v_exp_f32 v93, v93
M v[152:155], a[176:179], a[96:99], v[152:155]
v_cvt_pk_bf16_f32 v78, v92, v93
M v[156:159], a[176:179], a[112:115], v[24:27]
v_exp_f32 v94, v94
M v[156:159], a[172:175], a[108:111], v[156:159]
M v[156:159], a[168:171], a[104:107], v[156:159]
v_exp_f32 v95, v95
M v[156:159], a[164:167], a[100:103], v[156:159]
v_cvt_pk_bf16_f32 v79, v94, v95
s_waitcnt lgkmcnt(6)
s_add_u32 m0, s29, 0
M v[160:163], a[116:119], v[32:35], v[160:163]
v_exp_f32 v96, v96
M v[160:163], a[120:123], v[64:67], v[160:163]
ds_read_b128 a[148:151], v2 offset:36864
ds_read_b128 a[152:155], v2 offset:45056
M v[164:167], a[120:123], v[68:71], v[164:167]
v_exp_f32 v97, v97
M v[164:167], a[116:119], v[36:39], v[164:167]
buffer_load_dwordx4 v1, s[12:15], s25 offen offset:0 sc1 lds
s_add_u32 s32, s25, 4096
M v[168:171], a[116:119], v[40:43], v[168:171]
v_exp_f32 v98, v98
M v[168:171], a[120:123], v[72:75], v[168:171]
v_cvt_pk_bf16_f32 v96, v96, v97
M v[172:175], a[120:123], v[76:79], v[172:175]
v_exp_f32 v99, v99
M v[172:175], a[116:119], v[44:47], v[172:175]
buffer_load_dwordx4 v1, s[12:15], s25 offen offset:1024 sc1 lds
s_waitcnt lgkmcnt(6)
M a[32:35], a[48:51], v[32:35], a[32:35]
M a[32:35], a[48:51], v[64:67], a[32:35]
M v[176:179], a[124:127], v[32:35], v[176:179]
v_exp_f32 v112, v112
M v[176:179], a[128:131], v[64:67], v[176:179]
ds_read_b128 a[156:159], v2 offset:37888
ds_read_b128 a[160:163], v2 offset:46080
M v[180:183], a[128:131], v[68:71], v[180:183]
v_exp_f32 v113, v113
M v[180:183], a[124:127], v[36:39], v[180:183]
buffer_load_dwordx4 v1, s[12:15], s25 offen offset:2048 sc1 lds
M v[184:187], a[124:127], v[40:43], v[184:187]
v_exp_f32 v114, v114
M v[184:187], a[128:131], v[72:75], v[184:187]
v_cvt_pk_bf16_f32 v97, v98, v99
v_cvt_pk_bf16_f32 v98, v112, v113
M v[188:191], a[128:131], v[76:79], v[188:191]
v_exp_f32 v115, v115
M v[188:191], a[124:127], v[44:47], v[188:191]
buffer_load_dwordx4 v1, s[12:15], s25 offen offset:3072 sc1 lds
s_add_u32 m0, s29, 4096
s_waitcnt lgkmcnt(6)
M a[36:39], a[48:51], v[36:39], a[36:39]
M a[36:39], a[48:51], v[68:71], a[36:39]
M v[192:195], a[132:135], v[32:35], v[192:195]
v_exp_f32 v100, v100
M v[192:195], a[136:139], v[64:67], v[192:195]
ds_read_b128 a[164:167], v2 offset:38912
ds_read_b128 a[168:171], v2 offset:47104
M v[196:199], a[136:139], v[68:71], v[196:199]
v_exp_f32 v101, v101
M v[196:199], a[132:135], v[36:39], v[196:199]
buffer_load_dwordx4 v1, s[12:15], s32 offen offset:0 sc1 lds
M v[200:203], a[132:135], v[40:43], v[200:203]
v_exp_f32 v102, v102
M v[200:203], a[136:139], v[72:75], v[200:203]
v_cvt_pk_bf16_f32 v99, v114, v115
v_cvt_pk_bf16_f32 v100, v100, v101
M v[204:207], a[136:139], v[76:79], v[204:207]
v_exp_f32 v103, v103
M v[204:207], a[132:135], v[44:47], v[204:207]
buffer_load_dwordx4 v1, s[12:15], s32 offen offset:1024 sc1 lds
s_waitcnt lgkmcnt(6)
M a[40:43], a[48:51], v[40:43], a[40:43]
M a[40:43], a[48:51], v[72:75], a[40:43]
M v[208:211], a[140:143], v[32:35], v[208:211]
v_exp_f32 v116, v116
M v[208:211], a[144:147], v[64:67], v[208:211]
ds_read_b128 a[172:175], v2 offset:39936
ds_read_b128 a[176:179], v2 offset:48128
M v[212:215], a[144:147], v[68:71], v[212:215]
v_exp_f32 v117, v117
M v[212:215], a[140:143], v[36:39], v[212:215]
buffer_load_dwordx4 v1, s[12:15], s32 offen offset:2048 sc1 lds
M v[216:219], a[140:143], v[40:43], v[216:219]
v_exp_f32 v118, v118
M v[216:219], a[144:147], v[72:75], v[216:219]
v_cvt_pk_bf16_f32 v101, v102, v103
v_cvt_pk_bf16_f32 v102, v116, v117
M v[220:223], a[144:147], v[76:79], v[220:223]
v_exp_f32 v119, v119
M v[220:223], a[140:143], v[44:47], v[220:223]
buffer_load_dwordx4 v1, s[12:15], s32 offen offset:3072 sc1 lds
s_waitcnt lgkmcnt(6)
M a[44:47], a[48:51], v[44:47], a[44:47]
M a[44:47], a[48:51], v[76:79], a[44:47]
M v[224:227], a[148:151], v[32:35], v[224:227]
v_exp_f32 v104, v104
M v[224:227], a[152:155], v[64:67], v[224:227]
s_add_u32 s25, s25, 32768
s_cmp_eq_u32 s25, s27
s_cselect_b32 s25, s28, s25
s_cselect_b32 s27, -1, s27
M v[228:231], a[152:155], v[68:71], v[228:231]
v_exp_f32 v105, v105
M v[228:231], a[148:151], v[36:39], v[228:231]
v_cvt_pk_bf16_f32 v103, v118, v119
v_cvt_pk_bf16_f32 v104, v104, v105
M v[232:235], a[148:151], v[40:43], v[232:235]
v_exp_f32 v106, v106
M v[232:235], a[152:155], v[72:75], v[232:235]
M v[236:239], a[152:155], v[76:79], v[236:239]
v_exp_f32 v107, v107
M v[236:239], a[148:151], v[44:47], v[236:239]
v_cvt_pk_bf16_f32 v105, v106, v107
s_waitcnt lgkmcnt(4)
M v[240:243], a[156:159], v[32:35], v[240:243]
v_exp_f32 v120, v120
M v[240:243], a[160:163], v[64:67], v[240:243]
M v[244:247], a[160:163], v[68:71], v[244:247]
v_exp_f32 v121, v121
M v[244:247], a[156:159], v[36:39], v[244:247]
v_cvt_pk_bf16_f32 v106, v120, v121
M v[248:251], a[156:159], v[40:43], v[248:251]
v_exp_f32 v122, v122
M v[248:251], a[160:163], v[72:75], v[248:251]
s_waitcnt vmcnt(32) lgkmcnt(0)
s_barrier
ds_read_b128 a[116:119], v3 offset:0
ds_read_b128 a[120:123], v3 offset:1024
ds_read_b128 a[124:127], v3 offset:2048
ds_read_b128 a[128:131], v3 offset:3072
M v[252:255], a[160:163], v[76:79], v[252:255]
v_exp_f32 v123, v123
M v[252:255], a[156:159], v[44:47], v[252:255]
v_cvt_pk_bf16_f32 v107, v122, v123
M a[0:3], a[164:167], v[32:35], a[0:3]
v_exp_f32 v108, v108
M a[0:3], a[168:171], v[64:67], a[0:3]
ds_read_b128 a[132:135], v3 offset:4096
ds_read_b128 a[136:139], v3 offset:5120
M a[4:7], a[168:171], v[68:71], a[4:7]
v_exp_f32 v109, v109
M a[4:7], a[164:167], v[36:39], a[4:7]
v_cvt_pk_bf16_f32 v108, v108, v109
M a[8:11], a[164:167], v[40:43], a[8:11]
v_exp_f32 v110, v110
M a[8:11], a[168:171], v[72:75], a[8:11]
M a[12:15], a[168:171], v[76:79], a[12:15]
v_exp_f32 v111, v111
M a[12:15], a[164:167], v[44:47], a[12:15]
v_cvt_pk_bf16_f32 v109, v110, v111
M a[16:19], a[172:175], v[32:35], a[16:19]
v_exp_f32 v124, v124
M a[16:19], a[176:179], v[64:67], a[16:19]
ds_read_b128 a[140:143], v3 offset:6144
ds_read_b128 a[144:147], v3 offset:7168
M a[20:23], a[176:179], v[68:71], a[20:23]
v_exp_f32 v125, v125
M a[20:23], a[172:175], v[36:39], a[20:23]
v_cvt_pk_bf16_f32 v110, v124, v125
M a[24:27], a[172:175], v[40:43], a[24:27]
v_exp_f32 v126, v126
M a[24:27], a[176:179], v[72:75], a[24:27]
M a[28:31], a[176:179], v[76:79], a[28:31]
v_exp_f32 v127, v127
M a[28:31], a[172:175], v[44:47], a[28:31]
v_cvt_pk_bf16_f32 v111, v126, v127
s_waitcnt vmcnt(16)
s_waitcnt lgkmcnt(4)
s_add_u32 m0, s29, 32768
M v[32:35], a[116:119], a[180:183], 0
v_exp_f32 v128, v128
M v[32:35], a[120:123], a[184:187], v[32:35]
ds_read_b128 a[148:151], v3 offset:8192
ds_read_b128 a[152:155], v3 offset:9216
M v[32:35], a[124:127], a[188:191], v[32:35]
v_exp_f32 v129, v129
M v[32:35], a[128:131], a[192:195], v[32:35]
buffer_load_dwordx4 v1, s[12:15], s26 offen offset:0 sc1 lds
s_add_u32 s32, s26, 4096
M v[36:39], a[128:131], a[208:211], 0
v_exp_f32 v130, v130
M v[36:39], a[124:127], a[204:207], v[36:39]
v_cvt_pk_bf16_f32 v128, v128, v129
M v[36:39], a[120:123], a[200:203], v[36:39]
v_exp_f32 v131, v131
M v[36:39], a[116:119], a[196:199], v[36:39]
buffer_load_dwordx4 v1, s[12:15], s26 offen offset:1024 sc1 lds
M v[40:43], a[116:119], a[212:215], 0
v_exp_f32 v144, v144
M v[40:43], a[120:123], a[216:219], v[40:43]
ds_read_b128 a[156:159], v3 offset:10240
ds_read_b128 a[160:163], v3 offset:11264
M v[40:43], a[124:127], a[220:223], v[40:43]
v_exp_f32 v145, v145
M v[40:43], a[128:131], a[224:227], v[40:43]
buffer_load_dwordx4 v1, s[12:15], s26 offen offset:2048 sc1 lds
M v[44:47], a[128:131], a[240:243], 0
v_exp_f32 v146, v146
M v[44:47], a[124:127], a[236:239], v[44:47]
v_cvt_pk_bf16_f32 v129, v130, v131
v_cvt_pk_bf16_f32 v130, v144, v145
M v[44:47], a[120:123], a[232:235], v[44:47]
v_exp_f32 v147, v147
M v[44:47], a[116:119], a[228:231], v[44:47]
buffer_load_dwordx4 v1, s[12:15], s26 offen offset:3072 sc1 lds
s_add_u32 m0, s29, 36864
s_waitcnt lgkmcnt(4)
M v[48:51], a[132:135], a[180:183], 0
v_exp_f32 v132, v132
M v[48:51], a[136:139], a[184:187], v[48:51]
ds_read_b128 a[164:167], v3 offset:12288
ds_read_b128 a[168:171], v3 offset:13312
M v[48:51], a[140:143], a[188:191], v[48:51]
v_exp_f32 v133, v133
M v[48:51], a[144:147], a[192:195], v[48:51]
buffer_load_dwordx4 v1, s[12:15], s32 offen offset:0 sc1 lds
M v[52:55], a[144:147], a[208:211], 0
v_exp_f32 v134, v134
M v[52:55], a[140:143], a[204:207], v[52:55]
v_cvt_pk_bf16_f32 v131, v146, v147
v_cvt_pk_bf16_f32 v132, v132, v133
M v[52:55], a[136:139], a[200:203], v[52:55]
v_exp_f32 v135, v135
M v[52:55], a[132:135], a[196:199], v[52:55]
buffer_load_dwordx4 v1, s[12:15], s32 offen offset:1024 sc1 lds
M v[56:59], a[132:135], a[212:215], 0
v_exp_f32 v148, v148
M v[56:59], a[136:139], a[216:219], v[56:59]
ds_read_b128 a[172:175], v3 offset:14336
ds_read_b128 a[176:179], v3 offset:15360
M v[56:59], a[140:143], a[220:223], v[56:59]
v_exp_f32 v149, v149
M v[56:59], a[144:147], a[224:227], v[56:59]
buffer_load_dwordx4 v1, s[12:15], s32 offen offset:2048 sc1 lds
M v[60:63], a[144:147], a[240:243], 0
v_exp_f32 v150, v150
M v[60:63], a[140:143], a[236:239], v[60:63]
v_cvt_pk_bf16_f32 v133, v134, v135
v_cvt_pk_bf16_f32 v134, v148, v149
M v[60:63], a[136:139], a[232:235], v[60:63]
v_exp_f32 v151, v151
M v[60:63], a[132:135], a[228:231], v[60:63]
buffer_load_dwordx4 v1, s[12:15], s32 offen offset:3072 sc1 lds
s_waitcnt lgkmcnt(4)
M v[64:67], a[148:151], a[180:183], 0
v_exp_f32 v136, v136
M v[64:67], a[152:155], a[184:187], v[64:67]
s_add_u32 s26, s26, 32768
s_cmp_eq_u32 s26, s62
s_cselect_b32 s26, s63, s26
s_cselect_b32 s62, -1, s62
M v[64:67], a[156:159], a[188:191], v[64:67]
v_exp_f32 v137, v137
M v[64:67], a[160:163], a[192:195], v[64:67]
v_cvt_pk_bf16_f32 v135, v150, v151
v_cvt_pk_bf16_f32 v136, v136, v137
M v[68:71], a[160:163], a[208:211], 0
v_exp_f32 v138, v138
M v[68:71], a[156:159], a[204:207], v[68:71]
M v[68:71], a[152:155], a[200:203], v[68:71]
v_exp_f32 v139, v139
M v[68:71], a[148:151], a[196:199], v[68:71]
v_cvt_pk_bf16_f32 v137, v138, v139
M v[72:75], a[148:151], a[212:215], 0
v_exp_f32 v152, v152
M v[72:75], a[152:155], a[216:219], v[72:75]
M v[72:75], a[156:159], a[220:223], v[72:75]
v_exp_f32 v153, v153
M v[72:75], a[160:163], a[224:227], v[72:75]
v_cvt_pk_bf16_f32 v138, v152, v153
M v[76:79], a[160:163], a[240:243], 0
v_exp_f32 v154, v154
M v[76:79], a[156:159], a[236:239], v[76:79]
s_waitcnt vmcnt(16) lgkmcnt(0)
s_barrier
ds_read_b128 a[116:119], v3 offset:32768
ds_read_b128 a[120:123], v3 offset:40960
ds_read_b128 a[124:127], v3 offset:33792
ds_read_b128 a[128:131], v3 offset:41984
M v[76:79], a[152:155], a[232:235], v[76:79]
v_exp_f32 v155, v155
M v[76:79], a[148:151], a[228:231], v[76:79]
v_cvt_pk_bf16_f32 v139, v154, v155
M v[80:83], a[164:167], a[180:183], 0
v_exp_f32 v140, v140
M v[80:83], a[168:171], a[184:187], v[80:83]
ds_read_b128 a[132:135], v3 offset:34816
ds_read_b128 a[136:139], v3 offset:43008
M v[80:83], a[172:175], a[188:191], v[80:83]
v_exp_f32 v141, v141
M v[80:83], a[176:179], a[192:195], v[80:83]
v_cvt_pk_bf16_f32 v140, v140, v141
M v[84:87], a[176:179], a[208:211], 0
v_exp_f32 v142, v142
M v[84:87], a[172:175], a[204:207], v[84:87]
M v[84:87], a[168:171], a[200:203], v[84:87]
v_exp_f32 v143, v143
M v[84:87], a[164:167], a[196:199], v[84:87]
v_cvt_pk_bf16_f32 v141, v142, v143
M v[88:91], a[164:167], a[212:215], 0
v_exp_f32 v156, v156
M v[88:91], a[168:171], a[216:219], v[88:91]
ds_read_b128 a[140:143], v3 offset:35840
ds_read_b128 a[144:147], v3 offset:44032
M v[88:91], a[172:175], a[220:223], v[88:91]
v_exp_f32 v157, v157
M v[88:91], a[176:179], a[224:227], v[88:91]
v_cvt_pk_bf16_f32 v142, v156, v157
M v[92:95], a[176:179], a[240:243], 0
v_exp_f32 v158, v158
M v[92:95], a[172:175], a[236:239], v[92:95]
M v[92:95], a[168:171], a[232:235], v[92:95]
v_exp_f32 v159, v159
M v[92:95], a[164:167], a[228:231], v[92:95]
v_cvt_pk_bf16_f32 v143, v158, v159
s_waitcnt lgkmcnt(6)
s_add_u32 m0, s29, 65536
M v[160:163], a[116:119], v[96:99], v[160:163]
v_exp_f32 v32, v32
M v[160:163], a[120:123], v[128:131], v[160:163]
ds_read_b128 a[148:151], v3 offset:36864
ds_read_b128 a[152:155], v3 offset:45056
M v[164:167], a[120:123], v[132:135], v[164:167]
v_exp_f32 v33, v33
M v[164:167], a[116:119], v[100:103], v[164:167]
buffer_load_dwordx4 v1, s[12:15], s25 offen offset:0 sc1 lds
s_add_u32 s32, s25, 4096
M v[168:171], a[116:119], v[104:107], v[168:171]
v_exp_f32 v34, v34
M v[168:171], a[120:123], v[136:139], v[168:171]
v_cvt_pk_bf16_f32 v32, v32, v33
M v[172:175], a[120:123], v[140:143], v[172:175]
v_exp_f32 v35, v35
M v[172:175], a[116:119], v[108:111], v[172:175]
buffer_load_dwordx4 v1, s[12:15], s25 offen offset:1024 sc1 lds
s_waitcnt lgkmcnt(6)
M a[32:35], a[48:51], v[96:99], a[32:35]
M a[32:35], a[48:51], v[128:131], a[32:35]
M v[176:179], a[124:127], v[96:99], v[176:179]
v_exp_f32 v48, v48
M v[176:179], a[128:131], v[128:131], v[176:179]
ds_read_b128 a[156:159], v3 offset:37888
ds_read_b128 a[160:163], v3 offset:46080
M v[180:183], a[128:131], v[132:135], v[180:183]
v_exp_f32 v49, v49
M v[180:183], a[124:127], v[100:103], v[180:183]
buffer_load_dwordx4 v1, s[12:15], s25 offen offset:2048 sc1 lds
M v[184:187], a[124:127], v[104:107], v[184:187]
v_exp_f32 v50, v50
M v[184:187], a[128:131], v[136:139], v[184:187]
v_cvt_pk_bf16_f32 v33, v34, v35
v_cvt_pk_bf16_f32 v34, v48, v49
M v[188:191], a[128:131], v[140:143], v[188:191]
v_exp_f32 v51, v51
M v[188:191], a[124:127], v[108:111], v[188:191]
buffer_load_dwordx4 v1, s[12:15], s25 offen offset:3072 sc1 lds
s_add_u32 m0, s29, 69632
s_waitcnt lgkmcnt(6)
M a[36:39], a[48:51], v[100:103], a[36:39]
M a[36:39], a[48:51], v[132:135], a[36:39]
M v[192:195], a[132:135], v[96:99], v[192:195]
v_exp_f32 v36, v36
M v[192:195], a[136:139], v[128:131], v[192:195]
ds_read_b128 a[164:167], v3 offset:38912
ds_read_b128 a[168:171], v3 offset:47104
M v[196:199], a[136:139], v[132:135], v[196:199]
v_exp_f32 v37, v37
M v[196:199], a[132:135], v[100:103], v[196:199]
buffer_load_dwordx4 v1, s[12:15], s32 offen offset:0 sc1 lds
M v[200:203], a[132:135], v[104:107], v[200:203]
v_exp_f32 v38, v38
M v[200:203], a[136:139], v[136:139], v[200:203]
v_cvt_pk_bf16_f32 v35, v50, v51
v_cvt_pk_bf16_f32 v36, v36, v37
M v[204:207], a[136:139], v[140:143], v[204:207]
v_exp_f32 v39, v39
M v[204:207], a[132:135], v[108:111], v[204:207]
buffer_load_dwordx4 v1, s[12:15], s32 offen offset:1024 sc1 lds
s_waitcnt lgkmcnt(6)
M a[40:43], a[48:51], v[104:107], a[40:43]
M a[40:43], a[48:51], v[136:139], a[40:43]
M v[208:211], a[140:143], v[96:99], v[208:211]
v_exp_f32 v52, v52
M v[208:211], a[144:147], v[128:131], v[208:211]
ds_read_b128 a[172:175], v3 offset:39936
ds_read_b128 a[176:179], v3 offset:48128
M v[212:215], a[144:147], v[132:135], v[212:215]
v_exp_f32 v53, v53
M v[212:215], a[140:143], v[100:103], v[212:215]
buffer_load_dwordx4 v1, s[12:15], s32 offen offset:2048 sc1 lds
M v[216:219], a[140:143], v[104:107], v[216:219]
v_exp_f32 v54, v54
M v[216:219], a[144:147], v[136:139], v[216:219]
v_cvt_pk_bf16_f32 v37, v38, v39
v_cvt_pk_bf16_f32 v38, v52, v53
M v[220:223], a[144:147], v[140:143], v[220:223]
v_exp_f32 v55, v55
M v[220:223], a[140:143], v[108:111], v[220:223]
buffer_load_dwordx4 v1, s[12:15], s32 offen offset:3072 sc1 lds
s_waitcnt lgkmcnt(6)
M a[44:47], a[48:51], v[108:111], a[44:47]
M a[44:47], a[48:51], v[140:143], a[44:47]
M v[224:227], a[148:151], v[96:99], v[224:227]
v_exp_f32 v40, v40
M v[224:227], a[152:155], v[128:131], v[224:227]
s_add_u32 s25, s25, 32768
s_cmp_eq_u32 s25, s27
s_cselect_b32 s25, s28, s25
s_cselect_b32 s27, -1, s27
M v[228:231], a[152:155], v[132:135], v[228:231]
v_exp_f32 v41, v41
M v[228:231], a[148:151], v[100:103], v[228:231]
v_cvt_pk_bf16_f32 v39, v54, v55
v_cvt_pk_bf16_f32 v40, v40, v41
M v[232:235], a[148:151], v[104:107], v[232:235]
v_exp_f32 v42, v42
M v[232:235], a[152:155], v[136:139], v[232:235]
M v[236:239], a[152:155], v[140:143], v[236:239]
v_exp_f32 v43, v43
M v[236:239], a[148:151], v[108:111], v[236:239]
v_cvt_pk_bf16_f32 v41, v42, v43
s_waitcnt lgkmcnt(4)
M v[240:243], a[156:159], v[96:99], v[240:243]
v_exp_f32 v56, v56
M v[240:243], a[160:163], v[128:131], v[240:243]
M v[244:247], a[160:163], v[132:135], v[244:247]
v_exp_f32 v57, v57
M v[244:247], a[156:159], v[100:103], v[244:247]
v_cvt_pk_bf16_f32 v42, v56, v57
M v[248:251], a[156:159], v[104:107], v[248:251]
v_exp_f32 v58, v58
M v[248:251], a[160:163], v[136:139], v[248:251]
s_waitcnt vmcnt(16) lgkmcnt(0)
s_barrier
ds_read_b128 a[116:119], v2 offset:0
ds_read_b128 a[120:123], v2 offset:1024
ds_read_b128 a[124:127], v2 offset:2048
ds_read_b128 a[128:131], v2 offset:3072
M v[252:255], a[160:163], v[140:143], v[252:255]
v_exp_f32 v59, v59
M v[252:255], a[156:159], v[108:111], v[252:255]
v_cvt_pk_bf16_f32 v43, v58, v59
M a[0:3], a[164:167], v[96:99], a[0:3]
v_exp_f32 v44, v44
M a[0:3], a[168:171], v[128:131], a[0:3]
ds_read_b128 a[132:135], v2 offset:4096
ds_read_b128 a[136:139], v2 offset:5120
M a[4:7], a[168:171], v[132:135], a[4:7]
v_exp_f32 v45, v45
M a[4:7], a[164:167], v[100:103], a[4:7]
v_cvt_pk_bf16_f32 v44, v44, v45
M a[8:11], a[164:167], v[104:107], a[8:11]
v_exp_f32 v46, v46
M a[8:11], a[168:171], v[136:139], a[8:11]
M a[12:15], a[168:171], v[140:143], a[12:15]
v_exp_f32 v47, v47
M a[12:15], a[164:167], v[108:111], a[12:15]
v_cvt_pk_bf16_f32 v45, v46, v47
M a[16:19], a[172:175], v[96:99], a[16:19]
v_exp_f32 v60, v60
M a[16:19], a[176:179], v[128:131], a[16:19]
ds_read_b128 a[140:143], v2 offset:6144
ds_read_b128 a[144:147], v2 offset:7168
M a[20:23], a[176:179], v[132:135], a[20:23]
v_exp_f32 v61, v61
M a[20:23], a[172:175], v[100:103], a[20:23]
v_cvt_pk_bf16_f32 v46, v60, v61
M a[24:27], a[172:175], v[104:107], a[24:27]
v_exp_f32 v62, v62
M a[24:27], a[176:179], v[136:139], a[24:27]
M a[28:31], a[176:179], v[140:143], a[28:31]
v_exp_f32 v63, v63
M a[28:31], a[172:175], v[108:111], a[28:31]
v_cvt_pk_bf16_f32 v47, v62, v63
v_accvgpr_read_b32 v20, a32
v_accvgpr_read_b32 v21, a36
v_accvgpr_read_b32 v22, a40
v_accvgpr_read_b32 v23, a44
v_rcp_f32 v8, v20
v_rcp_f32 v9, v21
v_rcp_f32 v10, v22
v_rcp_f32 v11, v23
v_subrev_u32 v20, 0x21800000, v20
v_subrev_u32 v21, 0x21800000, v21
v_subrev_u32 v22, 0x21800000, v22
v_subrev_u32 v23, 0x21800000, v23
v_max_u32 v12, v20, v21
v_max3_u32 v12, v12, v22, v23
s_mov_b32 s64, 0x207
v_pk_mul_f32 v[160:161], v[160:161], v[8:9] op_sel:[0,0] op_sel_hi:[1,0]
v_pk_mul_f32 v[162:163], v[162:163], v[8:9] op_sel:[0,0] op_sel_hi:[1,0]
v_pk_mul_f32 v[176:177], v[176:177], v[8:9] op_sel:[0,0] op_sel_hi:[1,0]
v_pk_mul_f32 v[178:179], v[178:179], v[8:9] op_sel:[0,0] op_sel_hi:[1,0]
v_cvt_pk_bf16_f32 v160, v160, v161
v_cvt_pk_bf16_f32 v161, v162, v163
v_cvt_pk_bf16_f32 v162, v176, v177
v_cvt_pk_bf16_f32 v163, v178, v179
s_nop 1
M v[24:27], a[48:51], v[160:163], 0
v_pk_mul_f32 v[164:165], v[164:165], v[8:9] op_sel:[0,1] op_sel_hi:[1,1]
v_pk_mul_f32 v[166:167], v[166:167], v[8:9] op_sel:[0,1] op_sel_hi:[1,1]
v_pk_mul_f32 v[180:181], v[180:181], v[8:9] op_sel:[0,1] op_sel_hi:[1,1]
v_pk_mul_f32 v[182:183], v[182:183], v[8:9] op_sel:[0,1] op_sel_hi:[1,1]
v_cvt_pk_bf16_f32 v164, v164, v165
v_cvt_pk_bf16_f32 v165, v166, v167
v_cvt_pk_bf16_f32 v166, v180, v181
v_cvt_pk_bf16_f32 v167, v182, v183
s_nop 1
M v[24:27], a[48:51], v[164:167], v[24:27]
v_pk_mul_f32 v[168:169], v[168:169], v[10:11] op_sel:[0,0] op_sel_hi:[1,0]
v_pk_mul_f32 v[170:171], v[170:171], v[10:11] op_sel:[0,0] op_sel_hi:[1,0]
v_pk_mul_f32 v[184:185], v[184:185], v[10:11] op_sel:[0,0] op_sel_hi:[1,0]
v_pk_mul_f32 v[186:187], v[186:187], v[10:11] op_sel:[0,0] op_sel_hi:[1,0]
v_cvt_pk_bf16_f32 v168, v168, v169
v_cvt_pk_bf16_f32 v169, v170, v171
v_cvt_pk_bf16_f32 v170, v184, v185
v_cvt_pk_bf16_f32 v171, v186, v187
s_nop 1
M v[24:27], a[48:51], v[168:171], v[24:27]
v_pk_mul_f32 v[172:173], v[172:173], v[10:11] op_sel:[0,1] op_sel_hi:[1,1]
v_pk_mul_f32 v[174:175], v[174:175], v[10:11] op_sel:[0,1] op_sel_hi:[1,1]
v_pk_mul_f32 v[188:189], v[188:189], v[10:11] op_sel:[0,1] op_sel_hi:[1,1]
v_pk_mul_f32 v[190:191], v[190:191], v[10:11] op_sel:[0,1] op_sel_hi:[1,1]
v_cvt_pk_bf16_f32 v172, v172, v173
v_cvt_pk_bf16_f32 v173, v174, v175
v_cvt_pk_bf16_f32 v174, v188, v189
v_cvt_pk_bf16_f32 v175, v190, v191
s_nop 1
M v[24:27], a[48:51], v[172:175], v[24:27]
v_pk_mul_f32 v[192:193], v[192:193], v[8:9] op_sel:[0,0] op_sel_hi:[1,0]
v_pk_mul_f32 v[194:195], v[194:195], v[8:9] op_sel:[0,0] op_sel_hi:[1,0]
v_pk_mul_f32 v[208:209], v[208:209], v[8:9] op_sel:[0,0] op_sel_hi:[1,0]
v_pk_mul_f32 v[210:211], v[210:211], v[8:9] op_sel:[0,0] op_sel_hi:[1,0]
v_cvt_pk_bf16_f32 v192, v192, v193
v_cvt_pk_bf16_f32 v193, v194, v195
v_cvt_pk_bf16_f32 v194, v208, v209
v_cvt_pk_bf16_f32 v195, v210, v211
s_nop 1
M v[24:27], a[48:51], v[192:195], v[24:27]
v_pk_mul_f32 v[196:197], v[196:197], v[8:9] op_sel:[0,1] op_sel_hi:[1,1]
v_pk_mul_f32 v[198:199], v[198:199], v[8:9] op_sel:[0,1] op_sel_hi:[1,1]
v_pk_mul_f32 v[212:213], v[212:213], v[8:9] op_sel:[0,1] op_sel_hi:[1,1]
v_pk_mul_f32 v[214:215], v[214:215], v[8:9] op_sel:[0,1] op_sel_hi:[1,1]
v_cvt_pk_bf16_f32 v196, v196, v197
v_cvt_pk_bf16_f32 v197, v198, v199
v_cvt_pk_bf16_f32 v198, v212, v213
v_cvt_pk_bf16_f32 v199, v214, v215
s_nop 1
M v[24:27], a[48:51], v[196:199], v[24:27]
v_pk_mul_f32 v[200:201], v[200:201], v[10:11] op_sel:[0,0] op_sel_hi:[1,0]
v_pk_mul_f32 v[202:203], v[202:203], v[10:11] op_sel:[0,0] op_sel_hi:[1,0]
v_pk_mul_f32 v[216:217], v[216:217], v[10:11] op_sel:[0,0] op_sel_hi:[1,0]
v_pk_mul_f32 v[218:219], v[218:219], v[10:11] op_sel:[0,0] op_sel_hi:[1,0]
v_cvt_pk_bf16_f32 v200, v200, v201
v_cvt_pk_bf16_f32 v201, v202, v203
v_cvt_pk_bf16_f32 v202, v216, v217
v_cvt_pk_bf16_f32 v203, v218, v219
s_nop 1
M v[24:27], a[48:51], v[200:203], v[24:27]
v_pk_mul_f32 v[204:205], v[204:205], v[10:11] op_sel:[0,1] op_sel_hi:[1,1]
v_pk_mul_f32 v[206:207], v[206:207], v[10:11] op_sel:[0,1] op_sel_hi:[1,1]
v_pk_mul_f32 v[220:221], v[220:221], v[10:11] op_sel:[0,1] op_sel_hi:[1,1]
v_pk_mul_f32 v[222:223], v[222:223], v[10:11] op_sel:[0,1] op_sel_hi:[1,1]
v_cvt_pk_bf16_f32 v204, v204, v205
v_cvt_pk_bf16_f32 v205, v206, v207
v_cvt_pk_bf16_f32 v206, v220, v221
v_cvt_pk_bf16_f32 v207, v222, v223
s_nop 1
M v[24:27], a[48:51], v[204:207], v[24:27]
v_pk_mul_f32 v[224:225], v[224:225], v[8:9] op_sel:[0,0] op_sel_hi:[1,0]
v_pk_mul_f32 v[226:227], v[226:227], v[8:9] op_sel:[0,0] op_sel_hi:[1,0]
v_pk_mul_f32 v[240:241], v[240:241], v[8:9] op_sel:[0,0] op_sel_hi:[1,0]
v_pk_mul_f32 v[242:243], v[242:243], v[8:9] op_sel:[0,0] op_sel_hi:[1,0]
v_cvt_pk_bf16_f32 v224, v224, v225
v_cvt_pk_bf16_f32 v225, v226, v227
v_cvt_pk_bf16_f32 v226, v240, v241
v_cvt_pk_bf16_f32 v227, v242, v243
s_nop 1
M v[24:27], a[48:51], v[224:227], v[24:27]
v_pk_mul_f32 v[228:229], v[228:229], v[8:9] op_sel:[0,1] op_sel_hi:[1,1]
v_pk_mul_f32 v[230:231], v[230:231], v[8:9] op_sel:[0,1] op_sel_hi:[1,1]
v_pk_mul_f32 v[244:245], v[244:245], v[8:9] op_sel:[0,1] op_sel_hi:[1,1]
v_pk_mul_f32 v[246:247], v[246:247], v[8:9] op_sel:[0,1] op_sel_hi:[1,1]
v_cvt_pk_bf16_f32 v228, v228, v229
v_cvt_pk_bf16_f32 v229, v230, v231
v_cvt_pk_bf16_f32 v230, v244, v245
v_cvt_pk_bf16_f32 v231, v246, v247
s_nop 1
M v[24:27], a[48:51], v[228:231], v[24:27]
v_pk_mul_f32 v[232:233], v[232:233], v[10:11] op_sel:[0,0] op_sel_hi:[1,0]
v_pk_mul_f32 v[234:235], v[234:235], v[10:11] op_sel:[0,0] op_sel_hi:[1,0]
v_pk_mul_f32 v[248:249], v[248:249], v[10:11] op_sel:[0,0] op_sel_hi:[1,0]
v_pk_mul_f32 v[250:251], v[250:251], v[10:11] op_sel:[0,0] op_sel_hi:[1,0]
v_cvt_pk_bf16_f32 v232, v232, v233
v_cvt_pk_bf16_f32 v233, v234, v235
v_cvt_pk_bf16_f32 v234, v248, v249
v_cvt_pk_bf16_f32 v235, v250, v251
s_nop 1
M v[24:27], a[48:51], v[232:235], v[24:27]
v_pk_mul_f32 v[236:237], v[236:237], v[10:11] op_sel:[0,1] op_sel_hi:[1,1]
v_pk_mul_f32 v[238:239], v[238:239], v[10:11] op_sel:[0,1] op_sel_hi:[1,1]
v_pk_mul_f32 v[252:253], v[252:253], v[10:11] op_sel:[0,1] op_sel_hi:[1,1]
v_pk_mul_f32 v[254:255], v[254:255], v[10:11] op_sel:[0,1] op_sel_hi:[1,1]
v_cvt_pk_bf16_f32 v236, v236, v237
v_cvt_pk_bf16_f32 v237, v238, v239
v_cvt_pk_bf16_f32 v238, v252, v253
v_cvt_pk_bf16_f32 v239, v254, v255
v_accvgpr_read_b32 v176, a0
v_accvgpr_read_b32 v177, a1
v_accvgpr_read_b32 v178, a2
v_accvgpr_read_b32 v179, a3
v_accvgpr_read_b32 v180, a16
v_accvgpr_read_b32 v181, a17
v_accvgpr_read_b32 v182, a18
v_accvgpr_read_b32 v183, a19
M v[24:27], a[48:51], v[236:239], v[24:27]
v_pk_mul_f32 v[176:177], v[176:177], v[8:9] op_sel:[0,0] op_sel_hi:[1,0]
v_pk_mul_f32 v[178:179], v[178:179], v[8:9] op_sel:[0,0] op_sel_hi:[1,0]
v_pk_mul_f32 v[180:181], v[180:181], v[8:9] op_sel:[0,0] op_sel_hi:[1,0]
v_pk_mul_f32 v[182:183], v[182:183], v[8:9] op_sel:[0,0] op_sel_hi:[1,0]
v_cvt_pk_bf16_f32 v176, v176, v177
v_cvt_pk_bf16_f32 v177, v178, v179
v_cvt_pk_bf16_f32 v178, v180, v181
v_cvt_pk_bf16_f32 v179, v182, v183
v_accvgpr_read_b32 v184, a4
v_accvgpr_read_b32 v185, a5
v_accvgpr_read_b32 v186, a6
v_accvgpr_read_b32 v187, a7
v_accvgpr_read_b32 v188, a20
v_accvgpr_read_b32 v189, a21
v_accvgpr_read_b32 v190, a22
v_accvgpr_read_b32 v191, a23
M v[24:27], a[48:51], v[176:179], v[24:27]
v_pk_mul_f32 v[184:185], v[184:185], v[8:9] op_sel:[0,1] op_sel_hi:[1,1]
v_pk_mul_f32 v[186:187], v[186:187], v[8:9] op_sel:[0,1] op_sel_hi:[1,1]
v_pk_mul_f32 v[188:189], v[188:189], v[8:9] op_sel:[0,1] op_sel_hi:[1,1]
v_pk_mul_f32 v[190:191], v[190:191], v[8:9] op_sel:[0,1] op_sel_hi:[1,1]
v_cvt_pk_bf16_f32 v184, v184, v185
v_cvt_pk_bf16_f32 v185, v186, v187
v_cvt_pk_bf16_f32 v186, v188, v189
v_cvt_pk_bf16_f32 v187, v190, v191
v_accvgpr_read_b32 v208, a8
v_accvgpr_read_b32 v209, a9
v_accvgpr_read_b32 v210, a10
v_accvgpr_read_b32 v211, a11
v_accvgpr_read_b32 v212, a24
v_accvgpr_read_b32 v213, a25
v_accvgpr_read_b32 v214, a26
v_accvgpr_read_b32 v215, a27
M v[24:27], a[48:51], v[184:187], v[24:27]
v_pk_mul_f32 v[208:209], v[208:209], v[10:11] op_sel:[0,0] op_sel_hi:[1,0]
v_pk_mul_f32 v[210:211], v[210:211], v[10:11] op_sel:[0,0] op_sel_hi:[1,0]
v_pk_mul_f32 v[212:213], v[212:213], v[10:11] op_sel:[0,0] op_sel_hi:[1,0]
v_pk_mul_f32 v[214:215], v[214:215], v[10:11] op_sel:[0,0] op_sel_hi:[1,0]
v_cvt_pk_bf16_f32 v208, v208, v209
v_cvt_pk_bf16_f32 v209, v210, v211
v_cvt_pk_bf16_f32 v210, v212, v213
v_cvt_pk_bf16_f32 v211, v214, v215
v_accvgpr_read_b32 v216, a12
v_accvgpr_read_b32 v217, a13
v_accvgpr_read_b32 v218, a14
v_accvgpr_read_b32 v219, a15
v_accvgpr_read_b32 v220, a28
v_accvgpr_read_b32 v221, a29
v_accvgpr_read_b32 v222, a30
v_accvgpr_read_b32 v223, a31
M v[24:27], a[48:51], v[208:211], v[24:27]
v_pk_mul_f32 v[216:217], v[216:217], v[10:11] op_sel:[0,1] op_sel_hi:[1,1]
v_pk_mul_f32 v[218:219], v[218:219], v[10:11] op_sel:[0,1] op_sel_hi:[1,1]
v_pk_mul_f32 v[220:221], v[220:221], v[10:11] op_sel:[0,1] op_sel_hi:[1,1]
v_pk_mul_f32 v[222:223], v[222:223], v[10:11] op_sel:[0,1] op_sel_hi:[1,1]
v_cvt_pk_bf16_f32 v216, v216, v217
v_cvt_pk_bf16_f32 v217, v218, v219
v_cvt_pk_bf16_f32 v218, v220, v221
v_cvt_pk_bf16_f32 v219, v222, v223
s_nop 1
M v[24:27], a[48:51], v[216:219], v[24:27]
v_cmp_lt_u32 vcc, 0x3c000000, v12
s_nop 6
v_cmp_class_f32 s[40:41], v24, s64
s_nop 0
s_or_b64 vcc, vcc, s[40:41]
s_cbranch_vccnz Lbad_1
s_lshl_b32 s33, s21, 20
s_lshl_b32 s34, s20, 15
s_add_u32 s33, s33, s34
s_lshl_b32 s34, s23, 13
s_add_u32 s36, s33, s34
s_add_u32 s37, s36, 4096
s_add_u32 s38, s36, 16384
s_add_u32 s39, s36, 20480
buffer_store_dwordx4 v[160:163], v1, s[16:19], s36 offen offset:0 sc1
buffer_store_dwordx4 v[164:167], v1, s[16:19], s36 offen offset:2048 sc1
buffer_store_dwordx4 v[168:171], v1, s[16:19], s37 offen offset:0 sc1
buffer_store_dwordx4 v[172:175], v1, s[16:19], s37 offen offset:2048 sc1
buffer_store_dwordx4 v[192:195], v1, s[16:19], s36 offen offset:1024 sc1
buffer_store_dwordx4 v[196:199], v1, s[16:19], s36 offen offset:3072 sc1
buffer_store_dwordx4 v[200:203], v1, s[16:19], s37 offen offset:1024 sc1
buffer_store_dwordx4 v[204:207], v1, s[16:19], s37 offen offset:3072 sc1
buffer_store_dwordx4 v[224:227], v1, s[16:19], s38 offen offset:0 sc1
buffer_store_dwordx4 v[228:231], v1, s[16:19], s38 offen offset:2048 sc1
buffer_store_dwordx4 v[232:235], v1, s[16:19], s39 offen offset:0 sc1
buffer_store_dwordx4 v[236:239], v1, s[16:19], s39 offen offset:2048 sc1
buffer_store_dwordx4 v[176:179], v1, s[16:19], s38 offen offset:1024 sc1
buffer_store_dwordx4 v[184:187], v1, s[16:19], s38 offen offset:3072 sc1
buffer_store_dwordx4 v[208:211], v1, s[16:19], s39 offen offset:1024 sc1
buffer_store_dwordx4 v[216:219], v1, s[16:19], s39 offen offset:3072 sc1
s_branch Lfd_2
Lbad_1:
s_or_b32 s60, s60, 1
Lfd_2:
s_sub_u32 s30, 7, s21
s_cmp_lg_u32 s30, 0
s_cbranch_scc1 Lk2_b0
s_waitcnt vmcnt(8)
s_waitcnt lgkmcnt(0)
s_barrier
s_lshl_b32 s33, s2, 2
s_add_u32 s33, s33, s22
s_lshl_b32 s34, s33, 11
s_lshl_b32 s33, s33, 13
v_lshlrev_b32 v8, 3, v1
v_lshlrev_b32 v9, 1, v1
buffer_load_dword v5, v8, s[44:47], s33 offen
buffer_load_dword v6, v9, s[48:51], s34 offen
s_and_b32 s3, s2, 3
s_lshl_b32 s3, s3, 2
s_bfe_u32 s27, s2, 0x20003
s_add_u32 s27, s3, s27
s_lshl_b32 s43, s27, 8
s_add_u32 s43, s43, 8400896
v_lshlrev_b32 v15, 2, v0
buffer_load_dword v7, v15, s[52:55], s43 offen sc1
ds_read_b128 a[116:119], v2 offset:32768
ds_read_b128 a[120:123], v2 offset:40960
ds_read_b128 a[124:127], v2 offset:33792
ds_read_b128 a[128:131], v2 offset:41984
ds_read_b128 a[132:135], v2 offset:34816
ds_read_b128 a[136:139], v2 offset:43008
ds_read_b128 a[140:143], v2 offset:35840
ds_read_b128 a[144:147], v2 offset:44032
v_exp_f32 v64, v64
v_exp_f32 v65, v65
v_exp_f32 v66, v66
v_exp_f32 v67, v67
v_exp_f32 v80, v80
v_exp_f32 v81, v81
v_exp_f32 v82, v82
v_exp_f32 v83, v83
v_cvt_pk_bf16_f32 v64, v64, v65
v_cvt_pk_bf16_f32 v65, v66, v67
v_exp_f32 v68, v68
v_exp_f32 v69, v69
v_exp_f32 v70, v70
v_exp_f32 v71, v71
v_cvt_pk_bf16_f32 v66, v80, v81
v_cvt_pk_bf16_f32 v67, v82, v83
v_exp_f32 v84, v84
v_exp_f32 v85, v85
v_exp_f32 v86, v86
v_exp_f32 v87, v87
v_cvt_pk_bf16_f32 v68, v68, v69
v_cvt_pk_bf16_f32 v69, v70, v71
v_exp_f32 v72, v72
v_exp_f32 v73, v73
v_exp_f32 v74, v74
v_exp_f32 v75, v75
v_cvt_pk_bf16_f32 v70, v84, v85
v_cvt_pk_bf16_f32 v71, v86, v87
v_exp_f32 v88, v88
v_exp_f32 v89, v89
v_exp_f32 v90, v90
v_exp_f32 v91, v91
v_cvt_pk_bf16_f32 v72, v72, v73
v_cvt_pk_bf16_f32 v73, v74, v75
v_exp_f32 v76, v76
v_exp_f32 v77, v77
v_exp_f32 v78, v78
v_exp_f32 v79, v79
v_cvt_pk_bf16_f32 v74, v88, v89
v_cvt_pk_bf16_f32 v75, v90, v91
v_exp_f32 v92, v92
v_exp_f32 v93, v93
v_exp_f32 v94, v94
v_exp_f32 v95, v95
v_cvt_pk_bf16_f32 v76, v76, v77
v_cvt_pk_bf16_f32 v77, v78, v79
v_cvt_pk_bf16_f32 v78, v92, v93
v_cvt_pk_bf16_f32 v79, v94, v95
s_waitcnt lgkmcnt(6)
M v[160:163], a[116:119], v[32:35], 0
M v[160:163], a[120:123], v[64:67], v[160:163]
ds_read_b128 a[148:151], v2 offset:36864
ds_read_b128 a[152:155], v2 offset:45056
M v[164:167], a[120:123], v[68:71], 0
M v[164:167], a[116:119], v[36:39], v[164:167]
M v[168:171], a[116:119], v[40:43], 0
M v[168:171], a[120:123], v[72:75], v[168:171]
M v[172:175], a[120:123], v[76:79], 0
M v[172:175], a[116:119], v[44:47], v[172:175]
s_waitcnt lgkmcnt(6)
M a[32:35], a[48:51], v[32:35], 0
M a[32:35], a[48:51], v[64:67], a[32:35]
M v[176:179], a[124:127], v[32:35], 0
M v[176:179], a[128:131], v[64:67], v[176:179]
ds_read_b128 a[156:159], v2 offset:37888
ds_read_b128 a[160:163], v2 offset:46080
M v[180:183], a[128:131], v[68:71], 0
M v[180:183], a[124:127], v[36:39], v[180:183]
M v[184:187], a[124:127], v[40:43], 0
M v[184:187], a[128:131], v[72:75], v[184:187]
M v[188:191], a[128:131], v[76:79], 0
M v[188:191], a[124:127], v[44:47], v[188:191]
s_waitcnt lgkmcnt(6)
M a[36:39], a[48:51], v[36:39], 0
M a[36:39], a[48:51], v[68:71], a[36:39]
M v[192:195], a[132:135], v[32:35], 0
M v[192:195], a[136:139], v[64:67], v[192:195]
ds_read_b128 a[164:167], v2 offset:38912
ds_read_b128 a[168:171], v2 offset:47104
M v[196:199], a[136:139], v[68:71], 0
M v[196:199], a[132:135], v[36:39], v[196:199]
M v[200:203], a[132:135], v[40:43], 0
M v[200:203], a[136:139], v[72:75], v[200:203]
M v[204:207], a[136:139], v[76:79], 0
M v[204:207], a[132:135], v[44:47], v[204:207]
s_waitcnt lgkmcnt(6)
M a[40:43], a[48:51], v[40:43], 0
M a[40:43], a[48:51], v[72:75], a[40:43]
M v[208:211], a[140:143], v[32:35], 0
M v[208:211], a[144:147], v[64:67], v[208:211]
ds_read_b128 a[172:175], v2 offset:39936
ds_read_b128 a[176:179], v2 offset:48128
M v[212:215], a[144:147], v[68:71], 0
M v[212:215], a[140:143], v[36:39], v[212:215]
M v[216:219], a[140:143], v[40:43], 0
M v[216:219], a[144:147], v[72:75], v[216:219]
M v[220:223], a[144:147], v[76:79], 0
M v[220:223], a[140:143], v[44:47], v[220:223]
s_waitcnt lgkmcnt(6)
M a[44:47], a[48:51], v[44:47], 0
M a[44:47], a[48:51], v[76:79], a[44:47]
M v[224:227], a[148:151], v[32:35], 0
M v[224:227], a[152:155], v[64:67], v[224:227]
M v[228:231], a[152:155], v[68:71], 0
M v[228:231], a[148:151], v[36:39], v[228:231]
M v[232:235], a[148:151], v[40:43], 0
M v[232:235], a[152:155], v[72:75], v[232:235]
M v[236:239], a[152:155], v[76:79], 0
M v[236:239], a[148:151], v[44:47], v[236:239]
s_waitcnt lgkmcnt(4)
M v[240:243], a[156:159], v[32:35], 0
M v[240:243], a[160:163], v[64:67], v[240:243]
M v[244:247], a[160:163], v[68:71], 0
M v[244:247], a[156:159], v[36:39], v[244:247]
M v[248:251], a[156:159], v[40:43], 0
M v[248:251], a[160:163], v[72:75], v[248:251]
s_waitcnt vmcnt(63) lgkmcnt(0)
s_barrier
M v[252:255], a[160:163], v[76:79], 0
M v[252:255], a[156:159], v[44:47], v[252:255]
M a[0:3], a[164:167], v[32:35], 0
M a[0:3], a[168:171], v[64:67], a[0:3]
M a[4:7], a[168:171], v[68:71], 0
M a[4:7], a[164:167], v[36:39], a[4:7]
M a[8:11], a[164:167], v[40:43], 0
M a[8:11], a[168:171], v[72:75], a[8:11]
M a[12:15], a[168:171], v[76:79], 0
M a[12:15], a[164:167], v[44:47], a[12:15]
M a[16:19], a[172:175], v[32:35], 0
M a[16:19], a[176:179], v[64:67], a[16:19]
M a[20:23], a[176:179], v[68:71], 0
M a[20:23], a[172:175], v[36:39], a[20:23]
M a[24:27], a[172:175], v[40:43], 0
M a[24:27], a[176:179], v[72:75], a[24:27]
M a[28:31], a[176:179], v[76:79], 0
M a[28:31], a[172:175], v[44:47], a[28:31]
s_branch Lk2_merge
Lk2_b0:
s_waitcnt lgkmcnt(4)
s_add_u32 m0, s29, 98304
M v[96:99], a[116:119], a[180:183], 0
v_exp_f32 v64, v64
M v[96:99], a[120:123], a[184:187], v[96:99]
ds_read_b128 a[148:151], v2 offset:8192
ds_read_b128 a[152:155], v2 offset:9216
M v[96:99], a[124:127], a[188:191], v[96:99]
v_exp_f32 v65, v65
M v[96:99], a[128:131], a[192:195], v[96:99]
buffer_load_dwordx4 v1, s[12:15], s26 offen offset:0 sc1 lds
s_add_u32 s32, s26, 4096
M v[100:103], a[128:131], a[208:211], 0
v_exp_f32 v66, v66
M v[100:103], a[124:127], a[204:207], v[100:103]
v_cvt_pk_bf16_f32 v64, v64, v65
M v[100:103], a[120:123], a[200:203], v[100:103]
v_exp_f32 v67, v67
M v[100:103], a[116:119], a[196:199], v[100:103]
buffer_load_dwordx4 v1, s[12:15], s26 offen offset:1024 sc1 lds
M v[104:107], a[116:119], a[212:215], 0
v_exp_f32 v80, v80
M v[104:107], a[120:123], a[216:219], v[104:107]
ds_read_b128 a[156:159], v2 offset:10240
ds_read_b128 a[160:163], v2 offset:11264
M v[104:107], a[124:127], a[220:223], v[104:107]
v_exp_f32 v81, v81
M v[104:107], a[128:131], a[224:227], v[104:107]
buffer_load_dwordx4 v1, s[12:15], s26 offen offset:2048 sc1 lds
M v[108:111], a[128:131], a[240:243], 0
v_exp_f32 v82, v82
M v[108:111], a[124:127], a[236:239], v[108:111]
v_cvt_pk_bf16_f32 v65, v66, v67
v_cvt_pk_bf16_f32 v66, v80, v81
M v[108:111], a[120:123], a[232:235], v[108:111]
v_exp_f32 v83, v83
M v[108:111], a[116:119], a[228:231], v[108:111]
buffer_load_dwordx4 v1, s[12:15], s26 offen offset:3072 sc1 lds
s_add_u32 m0, s29, 102400
s_waitcnt lgkmcnt(4)
M v[112:115], a[132:135], a[180:183], 0
v_exp_f32 v68, v68
M v[112:115], a[136:139], a[184:187], v[112:115]
ds_read_b128 a[164:167], v2 offset:12288
ds_read_b128 a[168:171], v2 offset:13312
M v[112:115], a[140:143], a[188:191], v[112:115]
v_exp_f32 v69, v69
M v[112:115], a[144:147], a[192:195], v[112:115]
buffer_load_dwordx4 v1, s[12:15], s32 offen offset:0 sc1 lds
M v[116:119], a[144:147], a[208:211], 0
v_exp_f32 v70, v70
M v[116:119], a[140:143], a[204:207], v[116:119]
v_cvt_pk_bf16_f32 v67, v82, v83
v_cvt_pk_bf16_f32 v68, v68, v69
M v[116:119], a[136:139], a[200:203], v[116:119]
v_exp_f32 v71, v71
M v[116:119], a[132:135], a[196:199], v[116:119]
buffer_load_dwordx4 v1, s[12:15], s32 offen offset:1024 sc1 lds
M v[120:123], a[132:135], a[212:215], 0
v_exp_f32 v84, v84
M v[120:123], a[136:139], a[216:219], v[120:123]
ds_read_b128 a[172:175], v2 offset:14336
ds_read_b128 a[176:179], v2 offset:15360
M v[120:123], a[140:143], a[220:223], v[120:123]
v_exp_f32 v85, v85
M v[120:123], a[144:147], a[224:227], v[120:123]
buffer_load_dwordx4 v1, s[12:15], s32 offen offset:2048 sc1 lds
M v[124:127], a[144:147], a[240:243], 0
v_exp_f32 v86, v86
M v[124:127], a[140:143], a[236:239], v[124:127]
v_cvt_pk_bf16_f32 v69, v70, v71
v_cvt_pk_bf16_f32 v70, v84, v85
M v[124:127], a[136:139], a[232:235], v[124:127]
v_exp_f32 v87, v87
M v[124:127], a[132:135], a[228:231], v[124:127]
buffer_load_dwordx4 v1, s[12:15], s32 offen offset:3072 sc1 lds
s_waitcnt lgkmcnt(4)
M v[128:131], a[148:151], a[180:183], 0
v_exp_f32 v72, v72
M v[128:131], a[152:155], a[184:187], v[128:131]
s_add_u32 s26, s26, 32768
s_cmp_eq_u32 s26, s62
s_cselect_b32 s26, s63, s26
s_cselect_b32 s62, -1, s62
M v[128:131], a[156:159], a[188:191], v[128:131]
v_exp_f32 v73, v73
M v[128:131], a[160:163], a[192:195], v[128:131]
v_cvt_pk_bf16_f32 v71, v86, v87
v_cvt_pk_bf16_f32 v72, v72, v73
M v[132:135], a[160:163], a[208:211], 0
v_exp_f32 v74, v74
M v[132:135], a[156:159], a[204:207], v[132:135]
M v[132:135], a[152:155], a[200:203], v[132:135]
v_exp_f32 v75, v75
M v[132:135], a[148:151], a[196:199], v[132:135]
v_cvt_pk_bf16_f32 v73, v74, v75
M v[136:139], a[148:151], a[212:215], 0
v_exp_f32 v88, v88
M v[136:139], a[152:155], a[216:219], v[136:139]
M v[136:139], a[156:159], a[220:223], v[136:139]
v_exp_f32 v89, v89
M v[136:139], a[160:163], a[224:227], v[136:139]
v_cvt_pk_bf16_f32 v74, v88, v89
M v[140:143], a[160:163], a[240:243], 0
v_exp_f32 v90, v90
M v[140:143], a[156:159], a[236:239], v[140:143]
s_waitcnt vmcnt(16) lgkmcnt(0)
s_barrier
ds_read_b128 a[116:119], v2 offset:32768
ds_read_b128 a[120:123], v2 offset:40960
ds_read_b128 a[124:127], v2 offset:33792
ds_read_b128 a[128:131], v2 offset:41984
M v[140:143], a[152:155], a[232:235], v[140:143]
v_exp_f32 v91, v91
M v[140:143], a[148:151], a[228:231], v[140:143]
v_cvt_pk_bf16_f32 v75, v90, v91
M v[144:147], a[164:167], a[180:183], 0
v_exp_f32 v76, v76
M v[144:147], a[168:171], a[184:187], v[144:147]
ds_read_b128 a[132:135], v2 offset:34816
ds_read_b128 a[136:139], v2 offset:43008
M v[144:147], a[172:175], a[188:191], v[144:147]
v_exp_f32 v77, v77
M v[144:147], a[176:179], a[192:195], v[144:147]
v_cvt_pk_bf16_f32 v76, v76, v77
M v[148:151], a[176:179], a[208:211], 0
v_exp_f32 v78, v78
M v[148:151], a[172:175], a[204:207], v[148:151]
M v[148:151], a[168:171], a[200:203], v[148:151]
v_exp_f32 v79, v79
M v[148:151], a[164:167], a[196:199], v[148:151]
v_cvt_pk_bf16_f32 v77, v78, v79
M v[152:155], a[164:167], a[212:215], 0
v_exp_f32 v92, v92
M v[152:155], a[168:171], a[216:219], v[152:155]
ds_read_b128 a[140:143], v2 offset:35840
ds_read_b128 a[144:147], v2 offset:44032
M v[152:155], a[172:175], a[220:223], v[152:155]
v_exp_f32 v93, v93
M v[152:155], a[176:179], a[224:227], v[152:155]
v_cvt_pk_bf16_f32 v78, v92, v93
M v[156:159], a[176:179], a[240:243], 0
v_exp_f32 v94, v94
M v[156:159], a[172:175], a[236:239], v[156:159]
M v[156:159], a[168:171], a[232:235], v[156:159]
v_exp_f32 v95, v95
M v[156:159], a[164:167], a[228:231], v[156:159]
v_cvt_pk_bf16_f32 v79, v94, v95
s_waitcnt lgkmcnt(6)
s_add_u32 m0, s29, 0
M v[160:163], a[116:119], v[32:35], 0
v_exp_f32 v96, v96
M v[160:163], a[120:123], v[64:67], v[160:163]
ds_read_b128 a[148:151], v2 offset:36864
ds_read_b128 a[152:155], v2 offset:45056
M v[164:167], a[120:123], v[68:71], 0
v_exp_f32 v97, v97
M v[164:167], a[116:119], v[36:39], v[164:167]
buffer_load_dwordx4 v1, s[12:15], s25 offen offset:0 sc1 lds
s_add_u32 s32, s25, 4096
M v[168:171], a[116:119], v[40:43], 0
v_exp_f32 v98, v98
M v[168:171], a[120:123], v[72:75], v[168:171]
v_cvt_pk_bf16_f32 v96, v96, v97
M v[172:175], a[120:123], v[76:79], 0
v_exp_f32 v99, v99
M v[172:175], a[116:119], v[44:47], v[172:175]
buffer_load_dwordx4 v1, s[12:15], s25 offen offset:1024 sc1 lds
s_waitcnt lgkmcnt(6)
M a[32:35], a[48:51], v[32:35], 0
M a[32:35], a[48:51], v[64:67], a[32:35]
M v[176:179], a[124:127], v[32:35], 0
v_exp_f32 v112, v112
M v[176:179], a[128:131], v[64:67], v[176:179]
ds_read_b128 a[156:159], v2 offset:37888
ds_read_b128 a[160:163], v2 offset:46080
M v[180:183], a[128:131], v[68:71], 0
v_exp_f32 v113, v113
M v[180:183], a[124:127], v[36:39], v[180:183]
buffer_load_dwordx4 v1, s[12:15], s25 offen offset:2048 sc1 lds
M v[184:187], a[124:127], v[40:43], 0
v_exp_f32 v114, v114
M v[184:187], a[128:131], v[72:75], v[184:187]
v_cvt_pk_bf16_f32 v97, v98, v99
v_cvt_pk_bf16_f32 v98, v112, v113
M v[188:191], a[128:131], v[76:79], 0
v_exp_f32 v115, v115
M v[188:191], a[124:127], v[44:47], v[188:191]
buffer_load_dwordx4 v1, s[12:15], s25 offen offset:3072 sc1 lds
s_add_u32 m0, s29, 4096
s_waitcnt lgkmcnt(6)
M a[36:39], a[48:51], v[36:39], 0
M a[36:39], a[48:51], v[68:71], a[36:39]
M v[192:195], a[132:135], v[32:35], 0
v_exp_f32 v100, v100
M v[192:195], a[136:139], v[64:67], v[192:195]
ds_read_b128 a[164:167], v2 offset:38912
ds_read_b128 a[168:171], v2 offset:47104
M v[196:199], a[136:139], v[68:71], 0
v_exp_f32 v101, v101
M v[196:199], a[132:135], v[36:39], v[196:199]
buffer_load_dwordx4 v1, s[12:15], s32 offen offset:0 sc1 lds
M v[200:203], a[132:135], v[40:43], 0
v_exp_f32 v102, v102
M v[200:203], a[136:139], v[72:75], v[200:203]
v_cvt_pk_bf16_f32 v99, v114, v115
v_cvt_pk_bf16_f32 v100, v100, v101
M v[204:207], a[136:139], v[76:79], 0
v_exp_f32 v103, v103
M v[204:207], a[132:135], v[44:47], v[204:207]
buffer_load_dwordx4 v1, s[12:15], s32 offen offset:1024 sc1 lds
s_waitcnt lgkmcnt(6)
M a[40:43], a[48:51], v[40:43], 0
M a[40:43], a[48:51], v[72:75], a[40:43]
M v[208:211], a[140:143], v[32:35], 0
v_exp_f32 v116, v116
M v[208:211], a[144:147], v[64:67], v[208:211]
ds_read_b128 a[172:175], v2 offset:39936
ds_read_b128 a[176:179], v2 offset:48128
M v[212:215], a[144:147], v[68:71], 0
v_exp_f32 v117, v117
M v[212:215], a[140:143], v[36:39], v[212:215]
buffer_load_dwordx4 v1, s[12:15], s32 offen offset:2048 sc1 lds
M v[216:219], a[140:143], v[40:43], 0
v_exp_f32 v118, v118
M v[216:219], a[144:147], v[72:75], v[216:219]
v_cvt_pk_bf16_f32 v101, v102, v103
v_cvt_pk_bf16_f32 v102, v116, v117
M v[220:223], a[144:147], v[76:79], 0
v_exp_f32 v119, v119
M v[220:223], a[140:143], v[44:47], v[220:223]
buffer_load_dwordx4 v1, s[12:15], s32 offen offset:3072 sc1 lds
s_waitcnt lgkmcnt(6)
M a[44:47], a[48:51], v[44:47], 0
M a[44:47], a[48:51], v[76:79], a[44:47]
M v[224:227], a[148:151], v[32:35], 0
v_exp_f32 v104, v104
M v[224:227], a[152:155], v[64:67], v[224:227]
s_add_u32 s25, s25, 32768
s_cmp_eq_u32 s25, s27
s_cselect_b32 s25, s28, s25
s_cselect_b32 s27, -1, s27
M v[228:231], a[152:155], v[68:71], 0
v_exp_f32 v105, v105
M v[228:231], a[148:151], v[36:39], v[228:231]
v_cvt_pk_bf16_f32 v103, v118, v119
v_cvt_pk_bf16_f32 v104, v104, v105
M v[232:235], a[148:151], v[40:43], 0
v_exp_f32 v106, v106
M v[232:235], a[152:155], v[72:75], v[232:235]
M v[236:239], a[152:155], v[76:79], 0
v_exp_f32 v107, v107
M v[236:239], a[148:151], v[44:47], v[236:239]
v_cvt_pk_bf16_f32 v105, v106, v107
s_waitcnt lgkmcnt(4)
M v[240:243], a[156:159], v[32:35], 0
v_exp_f32 v120, v120
M v[240:243], a[160:163], v[64:67], v[240:243]
M v[244:247], a[160:163], v[68:71], 0
v_exp_f32 v121, v121
M v[244:247], a[156:159], v[36:39], v[244:247]
v_cvt_pk_bf16_f32 v106, v120, v121
M v[248:251], a[156:159], v[40:43], 0
v_exp_f32 v122, v122
M v[248:251], a[160:163], v[72:75], v[248:251]
s_waitcnt vmcnt(16) lgkmcnt(0)
s_barrier
ds_read_b128 a[116:119], v3 offset:0
ds_read_b128 a[120:123], v3 offset:1024
ds_read_b128 a[124:127], v3 offset:2048
ds_read_b128 a[128:131], v3 offset:3072
M v[252:255], a[160:163], v[76:79], 0
v_exp_f32 v123, v123
M v[252:255], a[156:159], v[44:47], v[252:255]
v_cvt_pk_bf16_f32 v107, v122, v123
M a[0:3], a[164:167], v[32:35], 0
v_exp_f32 v108, v108
M a[0:3], a[168:171], v[64:67], a[0:3]
ds_read_b128 a[132:135], v3 offset:4096
ds_read_b128 a[136:139], v3 offset:5120
M a[4:7], a[168:171], v[68:71], 0
v_exp_f32 v109, v109
M a[4:7], a[164:167], v[36:39], a[4:7]
v_cvt_pk_bf16_f32 v108, v108, v109
M a[8:11], a[164:167], v[40:43], 0
v_exp_f32 v110, v110
M a[8:11], a[168:171], v[72:75], a[8:11]
M a[12:15], a[168:171], v[76:79], 0
v_exp_f32 v111, v111
M a[12:15], a[164:167], v[44:47], a[12:15]
v_cvt_pk_bf16_f32 v109, v110, v111
M a[16:19], a[172:175], v[32:35], 0
v_exp_f32 v124, v124
M a[16:19], a[176:179], v[64:67], a[16:19]
ds_read_b128 a[140:143], v3 offset:6144
ds_read_b128 a[144:147], v3 offset:7168
M a[20:23], a[176:179], v[68:71], 0
v_exp_f32 v125, v125
M a[20:23], a[172:175], v[36:39], a[20:23]
v_cvt_pk_bf16_f32 v110, v124, v125
M a[24:27], a[172:175], v[40:43], 0
v_exp_f32 v126, v126
M a[24:27], a[176:179], v[72:75], a[24:27]
M a[28:31], a[176:179], v[76:79], 0
v_exp_f32 v127, v127
M a[28:31], a[172:175], v[44:47], a[28:31]
v_cvt_pk_bf16_f32 v111, v126, v127
s_branch Lk2_l2b
Lk2_l2:
s_waitcnt lgkmcnt(4)
s_add_u32 m0, s29, 98304
M v[96:99], a[116:119], a[180:183], 0
v_exp_f32 v64, v64
M v[96:99], a[120:123], a[184:187], v[96:99]
ds_read_b128 a[148:151], v2 offset:8192
ds_read_b128 a[152:155], v2 offset:9216
M v[96:99], a[124:127], a[188:191], v[96:99]
v_exp_f32 v65, v65
M v[96:99], a[128:131], a[192:195], v[96:99]
buffer_load_dwordx4 v1, s[12:15], s26 offen offset:0 sc1 lds
s_add_u32 s32, s26, 4096
M v[100:103], a[128:131], a[208:211], 0
v_exp_f32 v66, v66
M v[100:103], a[124:127], a[204:207], v[100:103]
v_cvt_pk_bf16_f32 v64, v64, v65
M v[100:103], a[120:123], a[200:203], v[100:103]
v_exp_f32 v67, v67
M v[100:103], a[116:119], a[196:199], v[100:103]
buffer_load_dwordx4 v1, s[12:15], s26 offen offset:1024 sc1 lds
M v[104:107], a[116:119], a[212:215], 0
v_exp_f32 v80, v80
M v[104:107], a[120:123], a[216:219], v[104:107]
ds_read_b128 a[156:159], v2 offset:10240
ds_read_b128 a[160:163], v2 offset:11264
M v[104:107], a[124:127], a[220:223], v[104:107]
v_exp_f32 v81, v81
M v[104:107], a[128:131], a[224:227], v[104:107]
buffer_load_dwordx4 v1, s[12:15], s26 offen offset:2048 sc1 lds
M v[108:111], a[128:131], a[240:243], 0
v_exp_f32 v82, v82
M v[108:111], a[124:127], a[236:239], v[108:111]
v_cvt_pk_bf16_f32 v65, v66, v67
v_cvt_pk_bf16_f32 v66, v80, v81
M v[108:111], a[120:123], a[232:235], v[108:111]
v_exp_f32 v83, v83
M v[108:111], a[116:119], a[228:231], v[108:111]
buffer_load_dwordx4 v1, s[12:15], s26 offen offset:3072 sc1 lds
s_add_u32 m0, s29, 102400
s_waitcnt lgkmcnt(4)
M v[112:115], a[132:135], a[180:183], 0
v_exp_f32 v68, v68
M v[112:115], a[136:139], a[184:187], v[112:115]
ds_read_b128 a[164:167], v2 offset:12288
ds_read_b128 a[168:171], v2 offset:13312
M v[112:115], a[140:143], a[188:191], v[112:115]
v_exp_f32 v69, v69
M v[112:115], a[144:147], a[192:195], v[112:115]
buffer_load_dwordx4 v1, s[12:15], s32 offen offset:0 sc1 lds
M v[116:119], a[144:147], a[208:211], 0
v_exp_f32 v70, v70
M v[116:119], a[140:143], a[204:207], v[116:119]
v_cvt_pk_bf16_f32 v67, v82, v83
v_cvt_pk_bf16_f32 v68, v68, v69
M v[116:119], a[136:139], a[200:203], v[116:119]
v_exp_f32 v71, v71
M v[116:119], a[132:135], a[196:199], v[116:119]
buffer_load_dwordx4 v1, s[12:15], s32 offen offset:1024 sc1 lds
M v[120:123], a[132:135], a[212:215], 0
v_exp_f32 v84, v84
M v[120:123], a[136:139], a[216:219], v[120:123]
ds_read_b128 a[172:175], v2 offset:14336
ds_read_b128 a[176:179], v2 offset:15360
M v[120:123], a[140:143], a[220:223], v[120:123]
v_exp_f32 v85, v85
M v[120:123], a[144:147], a[224:227], v[120:123]
buffer_load_dwordx4 v1, s[12:15], s32 offen offset:2048 sc1 lds
M v[124:127], a[144:147], a[240:243], 0
v_exp_f32 v86, v86
M v[124:127], a[140:143], a[236:239], v[124:127]
v_cvt_pk_bf16_f32 v69, v70, v71
v_cvt_pk_bf16_f32 v70, v84, v85
M v[124:127], a[136:139], a[232:235], v[124:127]
v_exp_f32 v87, v87
M v[124:127], a[132:135], a[228:231], v[124:127]
buffer_load_dwordx4 v1, s[12:15], s32 offen offset:3072 sc1 lds
s_waitcnt lgkmcnt(4)
M v[128:131], a[148:151], a[180:183], 0
v_exp_f32 v72, v72
M v[128:131], a[152:155], a[184:187], v[128:131]
s_add_u32 s26, s26, 32768
s_cmp_eq_u32 s26, s62
s_cselect_b32 s26, s63, s26
s_cselect_b32 s62, -1, s62
M v[128:131], a[156:159], a[188:191], v[128:131]
v_exp_f32 v73, v73
M v[128:131], a[160:163], a[192:195], v[128:131]
v_cvt_pk_bf16_f32 v71, v86, v87
v_cvt_pk_bf16_f32 v72, v72, v73
M v[132:135], a[160:163], a[208:211], 0
v_exp_f32 v74, v74
M v[132:135], a[156:159], a[204:207], v[132:135]
M v[132:135], a[152:155], a[200:203], v[132:135]
v_exp_f32 v75, v75
M v[132:135], a[148:151], a[196:199], v[132:135]
v_cvt_pk_bf16_f32 v73, v74, v75
M v[136:139], a[148:151], a[212:215], 0
v_exp_f32 v88, v88
M v[136:139], a[152:155], a[216:219], v[136:139]
M v[136:139], a[156:159], a[220:223], v[136:139]
v_exp_f32 v89, v89
M v[136:139], a[160:163], a[224:227], v[136:139]
v_cvt_pk_bf16_f32 v74, v88, v89
M v[140:143], a[160:163], a[240:243], 0
v_exp_f32 v90, v90
M v[140:143], a[156:159], a[236:239], v[140:143]
s_waitcnt vmcnt(16) lgkmcnt(0)
s_barrier
ds_read_b128 a[116:119], v2 offset:32768
ds_read_b128 a[120:123], v2 offset:40960
ds_read_b128 a[124:127], v2 offset:33792
ds_read_b128 a[128:131], v2 offset:41984
M v[140:143], a[152:155], a[232:235], v[140:143]
v_exp_f32 v91, v91
M v[140:143], a[148:151], a[228:231], v[140:143]
v_cvt_pk_bf16_f32 v75, v90, v91
M v[144:147], a[164:167], a[180:183], 0
v_exp_f32 v76, v76
M v[144:147], a[168:171], a[184:187], v[144:147]
ds_read_b128 a[132:135], v2 offset:34816
ds_read_b128 a[136:139], v2 offset:43008
M v[144:147], a[172:175], a[188:191], v[144:147]
v_exp_f32 v77, v77
M v[144:147], a[176:179], a[192:195], v[144:147]
v_cvt_pk_bf16_f32 v76, v76, v77
M v[148:151], a[176:179], a[208:211], 0
v_exp_f32 v78, v78
M v[148:151], a[172:175], a[204:207], v[148:151]
M v[148:151], a[168:171], a[200:203], v[148:151]
v_exp_f32 v79, v79
M v[148:151], a[164:167], a[196:199], v[148:151]
v_cvt_pk_bf16_f32 v77, v78, v79
M v[152:155], a[164:167], a[212:215], 0
v_exp_f32 v92, v92
M v[152:155], a[168:171], a[216:219], v[152:155]
ds_read_b128 a[140:143], v2 offset:35840
ds_read_b128 a[144:147], v2 offset:44032
M v[152:155], a[172:175], a[220:223], v[152:155]
v_exp_f32 v93, v93
M v[152:155], a[176:179], a[224:227], v[152:155]
v_cvt_pk_bf16_f32 v78, v92, v93
M v[156:159], a[176:179], a[240:243], 0
v_exp_f32 v94, v94
M v[156:159], a[172:175], a[236:239], v[156:159]
M v[156:159], a[168:171], a[232:235], v[156:159]
v_exp_f32 v95, v95
M v[156:159], a[164:167], a[228:231], v[156:159]
v_cvt_pk_bf16_f32 v79, v94, v95
s_waitcnt lgkmcnt(6)
s_add_u32 m0, s29, 0
M v[160:163], a[116:119], v[32:35], v[160:163]
v_exp_f32 v96, v96
M v[160:163], a[120:123], v[64:67], v[160:163]
ds_read_b128 a[148:151], v2 offset:36864
ds_read_b128 a[152:155], v2 offset:45056
M v[164:167], a[120:123], v[68:71], v[164:167]
v_exp_f32 v97, v97
M v[164:167], a[116:119], v[36:39], v[164:167]
buffer_load_dwordx4 v1, s[12:15], s25 offen offset:0 sc1 lds
s_add_u32 s32, s25, 4096
M v[168:171], a[116:119], v[40:43], v[168:171]
v_exp_f32 v98, v98
M v[168:171], a[120:123], v[72:75], v[168:171]
v_cvt_pk_bf16_f32 v96, v96, v97
M v[172:175], a[120:123], v[76:79], v[172:175]
v_exp_f32 v99, v99
M v[172:175], a[116:119], v[44:47], v[172:175]
buffer_load_dwordx4 v1, s[12:15], s25 offen offset:1024 sc1 lds
s_waitcnt lgkmcnt(6)
M a[32:35], a[48:51], v[32:35], a[32:35]
M a[32:35], a[48:51], v[64:67], a[32:35]
M v[176:179], a[124:127], v[32:35], v[176:179]
v_exp_f32 v112, v112
M v[176:179], a[128:131], v[64:67], v[176:179]
ds_read_b128 a[156:159], v2 offset:37888
ds_read_b128 a[160:163], v2 offset:46080
M v[180:183], a[128:131], v[68:71], v[180:183]
v_exp_f32 v113, v113
M v[180:183], a[124:127], v[36:39], v[180:183]
buffer_load_dwordx4 v1, s[12:15], s25 offen offset:2048 sc1 lds
M v[184:187], a[124:127], v[40:43], v[184:187]
v_exp_f32 v114, v114
M v[184:187], a[128:131], v[72:75], v[184:187]
v_cvt_pk_bf16_f32 v97, v98, v99
v_cvt_pk_bf16_f32 v98, v112, v113
M v[188:191], a[128:131], v[76:79], v[188:191]
v_exp_f32 v115, v115
M v[188:191], a[124:127], v[44:47], v[188:191]
buffer_load_dwordx4 v1, s[12:15], s25 offen offset:3072 sc1 lds
s_add_u32 m0, s29, 4096
s_waitcnt lgkmcnt(6)
M a[36:39], a[48:51], v[36:39], a[36:39]
M a[36:39], a[48:51], v[68:71], a[36:39]
M v[192:195], a[132:135], v[32:35], v[192:195]
v_exp_f32 v100, v100
M v[192:195], a[136:139], v[64:67], v[192:195]
ds_read_b128 a[164:167], v2 offset:38912
ds_read_b128 a[168:171], v2 offset:47104
M v[196:199], a[136:139], v[68:71], v[196:199]
v_exp_f32 v101, v101
M v[196:199], a[132:135], v[36:39], v[196:199]
buffer_load_dwordx4 v1, s[12:15], s32 offen offset:0 sc1 lds
M v[200:203], a[132:135], v[40:43], v[200:203]
v_exp_f32 v102, v102
M v[200:203], a[136:139], v[72:75], v[200:203]
v_cvt_pk_bf16_f32 v99, v114, v115
v_cvt_pk_bf16_f32 v100, v100, v101
M v[204:207], a[136:139], v[76:79], v[204:207]
v_exp_f32 v103, v103
M v[204:207], a[132:135], v[44:47], v[204:207]
buffer_load_dwordx4 v1, s[12:15], s32 offen offset:1024 sc1 lds
s_waitcnt lgkmcnt(6)
M a[40:43], a[48:51], v[40:43], a[40:43]
M a[40:43], a[48:51], v[72:75], a[40:43]
M v[208:211], a[140:143], v[32:35], v[208:211]
v_exp_f32 v116, v116
M v[208:211], a[144:147], v[64:67], v[208:211]
ds_read_b128 a[172:175], v2 offset:39936
ds_read_b128 a[176:179], v2 offset:48128
M v[212:215], a[144:147], v[68:71], v[212:215]
v_exp_f32 v117, v117
M v[212:215], a[140:143], v[36:39], v[212:215]
buffer_load_dwordx4 v1, s[12:15], s32 offen offset:2048 sc1 lds
M v[216:219], a[140:143], v[40:43], v[216:219]
v_exp_f32 v118, v118
M v[216:219], a[144:147], v[72:75], v[216:219]
v_cvt_pk_bf16_f32 v101, v102, v103
v_cvt_pk_bf16_f32 v102, v116, v117
M v[220:223], a[144:147], v[76:79], v[220:223]
v_exp_f32 v119, v119
M v[220:223], a[140:143], v[44:47], v[220:223]
buffer_load_dwordx4 v1, s[12:15], s32 offen offset:3072 sc1 lds
s_waitcnt lgkmcnt(6)
M a[44:47], a[48:51], v[44:47], a[44:47]
M a[44:47], a[48:51], v[76:79], a[44:47]
M v[224:227], a[148:151], v[32:35], v[224:227]
v_exp_f32 v104, v104
M v[224:227], a[152:155], v[64:67], v[224:227]
s_add_u32 s25, s25, 32768
s_cmp_eq_u32 s25, s27
s_cselect_b32 s25, s28, s25
s_cselect_b32 s27, -1, s27
M v[228:231], a[152:155], v[68:71], v[228:231]
v_exp_f32 v105, v105
M v[228:231], a[148:151], v[36:39], v[228:231]
v_cvt_pk_bf16_f32 v103, v118, v119
v_cvt_pk_bf16_f32 v104, v104, v105
M v[232:235], a[148:151], v[40:43], v[232:235]
v_exp_f32 v106, v106
M v[232:235], a[152:155], v[72:75], v[232:235]
M v[236:239], a[152:155], v[76:79], v[236:239]
v_exp_f32 v107, v107
M v[236:239], a[148:151], v[44:47], v[236:239]
v_cvt_pk_bf16_f32 v105, v106, v107
s_waitcnt lgkmcnt(4)
M v[240:243], a[156:159], v[32:35], v[240:243]
v_exp_f32 v120, v120
M v[240:243], a[160:163], v[64:67], v[240:243]
M v[244:247], a[160:163], v[68:71], v[244:247]
v_exp_f32 v121, v121
M v[244:247], a[156:159], v[36:39], v[244:247]
v_cvt_pk_bf16_f32 v106, v120, v121
M v[248:251], a[156:159], v[40:43], v[248:251]
v_exp_f32 v122, v122
M v[248:251], a[160:163], v[72:75], v[248:251]
s_waitcnt vmcnt(16) lgkmcnt(0)
s_barrier
ds_read_b128 a[116:119], v3 offset:0
ds_read_b128 a[120:123], v3 offset:1024
ds_read_b128 a[124:127], v3 offset:2048
ds_read_b128 a[128:131], v3 offset:3072
M v[252:255], a[160:163], v[76:79], v[252:255]
v_exp_f32 v123, v123
M v[252:255], a[156:159], v[44:47], v[252:255]
v_cvt_pk_bf16_f32 v107, v122, v123
M a[0:3], a[164:167], v[32:35], a[0:3]
v_exp_f32 v108, v108
M a[0:3], a[168:171], v[64:67], a[0:3]
ds_read_b128 a[132:135], v3 offset:4096
ds_read_b128 a[136:139], v3 offset:5120
M a[4:7], a[168:171], v[68:71], a[4:7]
v_exp_f32 v109, v109
M a[4:7], a[164:167], v[36:39], a[4:7]
v_cvt_pk_bf16_f32 v108, v108, v109
M a[8:11], a[164:167], v[40:43], a[8:11]
v_exp_f32 v110, v110
M a[8:11], a[168:171], v[72:75], a[8:11]
M a[12:15], a[168:171], v[76:79], a[12:15]
v_exp_f32 v111, v111
M a[12:15], a[164:167], v[44:47], a[12:15]
v_cvt_pk_bf16_f32 v109, v110, v111
M a[16:19], a[172:175], v[32:35], a[16:19]
v_exp_f32 v124, v124
M a[16:19], a[176:179], v[64:67], a[16:19]
ds_read_b128 a[140:143], v3 offset:6144
ds_read_b128 a[144:147], v3 offset:7168
M a[20:23], a[176:179], v[68:71], a[20:23]
v_exp_f32 v125, v125
M a[20:23], a[172:175], v[36:39], a[20:23]
v_cvt_pk_bf16_f32 v110, v124, v125
M a[24:27], a[172:175], v[40:43], a[24:27]
v_exp_f32 v126, v126
M a[24:27], a[176:179], v[72:75], a[24:27]
M a[28:31], a[176:179], v[76:79], a[28:31]
v_exp_f32 v127, v127
M a[28:31], a[172:175], v[44:47], a[28:31]
v_cvt_pk_bf16_f32 v111, v126, v127
Lk2_l2b:
s_waitcnt lgkmcnt(4)
s_add_u32 m0, s29, 32768
M v[32:35], a[116:119], a[180:183], 0
v_exp_f32 v128, v128
M v[32:35], a[120:123], a[184:187], v[32:35]
ds_read_b128 a[148:151], v3 offset:8192
ds_read_b128 a[152:155], v3 offset:9216
M v[32:35], a[124:127], a[188:191], v[32:35]
v_exp_f32 v129, v129
M v[32:35], a[128:131], a[192:195], v[32:35]
buffer_load_dwordx4 v1, s[12:15], s26 offen offset:0 sc1 lds
s_add_u32 s32, s26, 4096
M v[36:39], a[128:131], a[208:211], 0
v_exp_f32 v130, v130
M v[36:39], a[124:127], a[204:207], v[36:39]
v_cvt_pk_bf16_f32 v128, v128, v129
M v[36:39], a[120:123], a[200:203], v[36:39]
v_exp_f32 v131, v131
M v[36:39], a[116:119], a[196:199], v[36:39]
buffer_load_dwordx4 v1, s[12:15], s26 offen offset:1024 sc1 lds
M v[40:43], a[116:119], a[212:215], 0
v_exp_f32 v144, v144
M v[40:43], a[120:123], a[216:219], v[40:43]
ds_read_b128 a[156:159], v3 offset:10240
ds_read_b128 a[160:163], v3 offset:11264
M v[40:43], a[124:127], a[220:223], v[40:43]
v_exp_f32 v145, v145
M v[40:43], a[128:131], a[224:227], v[40:43]
buffer_load_dwordx4 v1, s[12:15], s26 offen offset:2048 sc1 lds
M v[44:47], a[128:131], a[240:243], 0
v_exp_f32 v146, v146
M v[44:47], a[124:127], a[236:239], v[44:47]
v_cvt_pk_bf16_f32 v129, v130, v131
v_cvt_pk_bf16_f32 v130, v144, v145
M v[44:47], a[120:123], a[232:235], v[44:47]
v_exp_f32 v147, v147
M v[44:47], a[116:119], a[228:231], v[44:47]
buffer_load_dwordx4 v1, s[12:15], s26 offen offset:3072 sc1 lds
s_add_u32 m0, s29, 36864
s_waitcnt lgkmcnt(4)
M v[48:51], a[132:135], a[180:183], 0
v_exp_f32 v132, v132
M v[48:51], a[136:139], a[184:187], v[48:51]
ds_read_b128 a[164:167], v3 offset:12288
ds_read_b128 a[168:171], v3 offset:13312
M v[48:51], a[140:143], a[188:191], v[48:51]
v_exp_f32 v133, v133
M v[48:51], a[144:147], a[192:195], v[48:51]
buffer_load_dwordx4 v1, s[12:15], s32 offen offset:0 sc1 lds
M v[52:55], a[144:147], a[208:211], 0
v_exp_f32 v134, v134
M v[52:55], a[140:143], a[204:207], v[52:55]
v_cvt_pk_bf16_f32 v131, v146, v147
v_cvt_pk_bf16_f32 v132, v132, v133
M v[52:55], a[136:139], a[200:203], v[52:55]
v_exp_f32 v135, v135
M v[52:55], a[132:135], a[196:199], v[52:55]
buffer_load_dwordx4 v1, s[12:15], s32 offen offset:1024 sc1 lds
M v[56:59], a[132:135], a[212:215], 0
v_exp_f32 v148, v148
M v[56:59], a[136:139], a[216:219], v[56:59]
ds_read_b128 a[172:175], v3 offset:14336
ds_read_b128 a[176:179], v3 offset:15360
M v[56:59], a[140:143], a[220:223], v[56:59]
v_exp_f32 v149, v149
M v[56:59], a[144:147], a[224:227], v[56:59]
buffer_load_dwordx4 v1, s[12:15], s32 offen offset:2048 sc1 lds
M v[60:63], a[144:147], a[240:243], 0
v_exp_f32 v150, v150
M v[60:63], a[140:143], a[236:239], v[60:63]
v_cvt_pk_bf16_f32 v133, v134, v135
v_cvt_pk_bf16_f32 v134, v148, v149
M v[60:63], a[136:139], a[232:235], v[60:63]
v_exp_f32 v151, v151
M v[60:63], a[132:135], a[228:231], v[60:63]
buffer_load_dwordx4 v1, s[12:15], s32 offen offset:3072 sc1 lds
s_waitcnt lgkmcnt(4)
M v[64:67], a[148:151], a[180:183], 0
v_exp_f32 v136, v136
M v[64:67], a[152:155], a[184:187], v[64:67]
s_add_u32 s26, s26, 32768
s_cmp_eq_u32 s26, s62
s_cselect_b32 s26, s63, s26
s_cselect_b32 s62, -1, s62
M v[64:67], a[156:159], a[188:191], v[64:67]
v_exp_f32 v137, v137
M v[64:67], a[160:163], a[192:195], v[64:67]
v_cvt_pk_bf16_f32 v135, v150, v151
v_cvt_pk_bf16_f32 v136, v136, v137
M v[68:71], a[160:163], a[208:211], 0
v_exp_f32 v138, v138
M v[68:71], a[156:159], a[204:207], v[68:71]
M v[68:71], a[152:155], a[200:203], v[68:71]
v_exp_f32 v139, v139
M v[68:71], a[148:151], a[196:199], v[68:71]
v_cvt_pk_bf16_f32 v137, v138, v139
M v[72:75], a[148:151], a[212:215], 0
v_exp_f32 v152, v152
M v[72:75], a[152:155], a[216:219], v[72:75]
M v[72:75], a[156:159], a[220:223], v[72:75]
v_exp_f32 v153, v153
M v[72:75], a[160:163], a[224:227], v[72:75]
v_cvt_pk_bf16_f32 v138, v152, v153
M v[76:79], a[160:163], a[240:243], 0
v_exp_f32 v154, v154
M v[76:79], a[156:159], a[236:239], v[76:79]
s_waitcnt vmcnt(16) lgkmcnt(0)
s_barrier
ds_read_b128 a[116:119], v3 offset:32768
ds_read_b128 a[120:123], v3 offset:40960
ds_read_b128 a[124:127], v3 offset:33792
ds_read_b128 a[128:131], v3 offset:41984
M v[76:79], a[152:155], a[232:235], v[76:79]
v_exp_f32 v155, v155
M v[76:79], a[148:151], a[228:231], v[76:79]
v_cvt_pk_bf16_f32 v139, v154, v155
M v[80:83], a[164:167], a[180:183], 0
v_exp_f32 v140, v140
M v[80:83], a[168:171], a[184:187], v[80:83]
ds_read_b128 a[132:135], v3 offset:34816
ds_read_b128 a[136:139], v3 offset:43008
M v[80:83], a[172:175], a[188:191], v[80:83]
v_exp_f32 v141, v141
M v[80:83], a[176:179], a[192:195], v[80:83]
v_cvt_pk_bf16_f32 v140, v140, v141
M v[84:87], a[176:179], a[208:211], 0
v_exp_f32 v142, v142
M v[84:87], a[172:175], a[204:207], v[84:87]
M v[84:87], a[168:171], a[200:203], v[84:87]
v_exp_f32 v143, v143
M v[84:87], a[164:167], a[196:199], v[84:87]
v_cvt_pk_bf16_f32 v141, v142, v143
M v[88:91], a[164:167], a[212:215], 0
v_exp_f32 v156, v156
M v[88:91], a[168:171], a[216:219], v[88:91]
ds_read_b128 a[140:143], v3 offset:35840
ds_read_b128 a[144:147], v3 offset:44032
M v[88:91], a[172:175], a[220:223], v[88:91]
v_exp_f32 v157, v157
M v[88:91], a[176:179], a[224:227], v[88:91]
v_cvt_pk_bf16_f32 v142, v156, v157
M v[92:95], a[176:179], a[240:243], 0
v_exp_f32 v158, v158
M v[92:95], a[172:175], a[236:239], v[92:95]
M v[92:95], a[168:171], a[232:235], v[92:95]
v_exp_f32 v159, v159
M v[92:95], a[164:167], a[228:231], v[92:95]
v_cvt_pk_bf16_f32 v143, v158, v159
s_waitcnt lgkmcnt(6)
s_add_u32 m0, s29, 65536
M v[160:163], a[116:119], v[96:99], v[160:163]
v_exp_f32 v32, v32
M v[160:163], a[120:123], v[128:131], v[160:163]
ds_read_b128 a[148:151], v3 offset:36864
ds_read_b128 a[152:155], v3 offset:45056
M v[164:167], a[120:123], v[132:135], v[164:167]
v_exp_f32 v33, v33
M v[164:167], a[116:119], v[100:103], v[164:167]
buffer_load_dwordx4 v1, s[12:15], s25 offen offset:0 sc1 lds
s_add_u32 s32, s25, 4096
M v[168:171], a[116:119], v[104:107], v[168:171]
v_exp_f32 v34, v34
M v[168:171], a[120:123], v[136:139], v[168:171]
v_cvt_pk_bf16_f32 v32, v32, v33
M v[172:175], a[120:123], v[140:143], v[172:175]
v_exp_f32 v35, v35
M v[172:175], a[116:119], v[108:111], v[172:175]
buffer_load_dwordx4 v1, s[12:15], s25 offen offset:1024 sc1 lds
s_waitcnt lgkmcnt(6)
M a[32:35], a[48:51], v[96:99], a[32:35]
M a[32:35], a[48:51], v[128:131], a[32:35]
M v[176:179], a[124:127], v[96:99], v[176:179]
v_exp_f32 v48, v48
M v[176:179], a[128:131], v[128:131], v[176:179]
ds_read_b128 a[156:159], v3 offset:37888
ds_read_b128 a[160:163], v3 offset:46080
M v[180:183], a[128:131], v[132:135], v[180:183]
v_exp_f32 v49, v49
M v[180:183], a[124:127], v[100:103], v[180:183]
buffer_load_dwordx4 v1, s[12:15], s25 offen offset:2048 sc1 lds
M v[184:187], a[124:127], v[104:107], v[184:187]
v_exp_f32 v50, v50
M v[184:187], a[128:131], v[136:139], v[184:187]
v_cvt_pk_bf16_f32 v33, v34, v35
v_cvt_pk_bf16_f32 v34, v48, v49
M v[188:191], a[128:131], v[140:143], v[188:191]
v_exp_f32 v51, v51
M v[188:191], a[124:127], v[108:111], v[188:191]
buffer_load_dwordx4 v1, s[12:15], s25 offen offset:3072 sc1 lds
s_add_u32 m0, s29, 69632
s_waitcnt lgkmcnt(6)
M a[36:39], a[48:51], v[100:103], a[36:39]
M a[36:39], a[48:51], v[132:135], a[36:39]
M v[192:195], a[132:135], v[96:99], v[192:195]
v_exp_f32 v36, v36
M v[192:195], a[136:139], v[128:131], v[192:195]
ds_read_b128 a[164:167], v3 offset:38912
ds_read_b128 a[168:171], v3 offset:47104
M v[196:199], a[136:139], v[132:135], v[196:199]
v_exp_f32 v37, v37
M v[196:199], a[132:135], v[100:103], v[196:199]
buffer_load_dwordx4 v1, s[12:15], s32 offen offset:0 sc1 lds
M v[200:203], a[132:135], v[104:107], v[200:203]
v_exp_f32 v38, v38
M v[200:203], a[136:139], v[136:139], v[200:203]
v_cvt_pk_bf16_f32 v35, v50, v51
v_cvt_pk_bf16_f32 v36, v36, v37
M v[204:207], a[136:139], v[140:143], v[204:207]
v_exp_f32 v39, v39
M v[204:207], a[132:135], v[108:111], v[204:207]
buffer_load_dwordx4 v1, s[12:15], s32 offen offset:1024 sc1 lds
s_waitcnt lgkmcnt(6)
M a[40:43], a[48:51], v[104:107], a[40:43]
M a[40:43], a[48:51], v[136:139], a[40:43]
M v[208:211], a[140:143], v[96:99], v[208:211]
v_exp_f32 v52, v52
M v[208:211], a[144:147], v[128:131], v[208:211]
ds_read_b128 a[172:175], v3 offset:39936
ds_read_b128 a[176:179], v3 offset:48128
M v[212:215], a[144:147], v[132:135], v[212:215]
v_exp_f32 v53, v53
M v[212:215], a[140:143], v[100:103], v[212:215]
buffer_load_dwordx4 v1, s[12:15], s32 offen offset:2048 sc1 lds
M v[216:219], a[140:143], v[104:107], v[216:219]
v_exp_f32 v54, v54
M v[216:219], a[144:147], v[136:139], v[216:219]
v_cvt_pk_bf16_f32 v37, v38, v39
v_cvt_pk_bf16_f32 v38, v52, v53
M v[220:223], a[144:147], v[140:143], v[220:223]
v_exp_f32 v55, v55
M v[220:223], a[140:143], v[108:111], v[220:223]
buffer_load_dwordx4 v1, s[12:15], s32 offen offset:3072 sc1 lds
s_waitcnt lgkmcnt(6)
M a[44:47], a[48:51], v[108:111], a[44:47]
M a[44:47], a[48:51], v[140:143], a[44:47]
M v[224:227], a[148:151], v[96:99], v[224:227]
v_exp_f32 v40, v40
M v[224:227], a[152:155], v[128:131], v[224:227]
s_add_u32 s25, s25, 32768
s_cmp_eq_u32 s25, s27
s_cselect_b32 s25, s28, s25
s_cselect_b32 s27, -1, s27
M v[228:231], a[152:155], v[132:135], v[228:231]
v_exp_f32 v41, v41
M v[228:231], a[148:151], v[100:103], v[228:231]
v_cvt_pk_bf16_f32 v39, v54, v55
v_cvt_pk_bf16_f32 v40, v40, v41
M v[232:235], a[148:151], v[104:107], v[232:235]
v_exp_f32 v42, v42
M v[232:235], a[152:155], v[136:139], v[232:235]
M v[236:239], a[152:155], v[140:143], v[236:239]
v_exp_f32 v43, v43
M v[236:239], a[148:151], v[108:111], v[236:239]
v_cvt_pk_bf16_f32 v41, v42, v43
s_waitcnt lgkmcnt(4)
M v[240:243], a[156:159], v[96:99], v[240:243]
v_exp_f32 v56, v56
M v[240:243], a[160:163], v[128:131], v[240:243]
M v[244:247], a[160:163], v[132:135], v[244:247]
v_exp_f32 v57, v57
M v[244:247], a[156:159], v[100:103], v[244:247]
v_cvt_pk_bf16_f32 v42, v56, v57
M v[248:251], a[156:159], v[104:107], v[248:251]
v_exp_f32 v58, v58
M v[248:251], a[160:163], v[136:139], v[248:251]
s_waitcnt vmcnt(16) lgkmcnt(0)
s_barrier
ds_read_b128 a[116:119], v2 offset:0
ds_read_b128 a[120:123], v2 offset:1024
ds_read_b128 a[124:127], v2 offset:2048
ds_read_b128 a[128:131], v2 offset:3072
M v[252:255], a[160:163], v[140:143], v[252:255]
v_exp_f32 v59, v59
M v[252:255], a[156:159], v[108:111], v[252:255]
v_cvt_pk_bf16_f32 v43, v58, v59
M a[0:3], a[164:167], v[96:99], a[0:3]
v_exp_f32 v44, v44
M a[0:3], a[168:171], v[128:131], a[0:3]
ds_read_b128 a[132:135], v2 offset:4096
ds_read_b128 a[136:139], v2 offset:5120
M a[4:7], a[168:171], v[132:135], a[4:7]
v_exp_f32 v45, v45
M a[4:7], a[164:167], v[100:103], a[4:7]
v_cvt_pk_bf16_f32 v44, v44, v45
M a[8:11], a[164:167], v[104:107], a[8:11]
v_exp_f32 v46, v46
M a[8:11], a[168:171], v[136:139], a[8:11]
M a[12:15], a[168:171], v[140:143], a[12:15]
v_exp_f32 v47, v47
M a[12:15], a[164:167], v[108:111], a[12:15]
v_cvt_pk_bf16_f32 v45, v46, v47
M a[16:19], a[172:175], v[96:99], a[16:19]
v_exp_f32 v60, v60
M a[16:19], a[176:179], v[128:131], a[16:19]
ds_read_b128 a[140:143], v2 offset:6144
ds_read_b128 a[144:147], v2 offset:7168
M a[20:23], a[176:179], v[132:135], a[20:23]
v_exp_f32 v61, v61
M a[20:23], a[172:175], v[100:103], a[20:23]
v_cvt_pk_bf16_f32 v46, v60, v61
M a[24:27], a[172:175], v[104:107], a[24:27]
v_exp_f32 v62, v62
M a[24:27], a[176:179], v[136:139], a[24:27]
M a[28:31], a[176:179], v[140:143], a[28:31]
v_exp_f32 v63, v63
M a[28:31], a[172:175], v[108:111], a[28:31]
v_cvt_pk_bf16_f32 v47, v62, v63
s_sub_u32 s30, s30, 1
s_cmp_lg_u32 s30, 0
s_cbranch_scc1 Lk2_l2
s_branch Lk2_fin
Lk2_g1:
s_mov_b32 s30, 7
Lk2_l3:
s_waitcnt lgkmcnt(4)
s_add_u32 m0, s29, 98304
M v[96:99], a[116:119], a[52:55], 0
v_exp_f32 v64, v64
M v[96:99], a[120:123], a[56:59], v[96:99]
ds_read_b128 a[148:151], v2 offset:8192
ds_read_b128 a[152:155], v2 offset:9216
M v[96:99], a[124:127], a[60:63], v[96:99]
v_exp_f32 v65, v65
M v[96:99], a[128:131], a[64:67], v[96:99]
buffer_load_dwordx4 v1, s[12:15], s26 offen offset:0 sc1 lds
s_add_u32 s32, s26, 4096
M v[100:103], a[128:131], a[80:83], 0
v_exp_f32 v66, v66
M v[100:103], a[124:127], a[76:79], v[100:103]
v_cvt_pk_bf16_f32 v64, v64, v65
M v[100:103], a[120:123], a[72:75], v[100:103]
v_exp_f32 v67, v67
M v[100:103], a[116:119], a[68:71], v[100:103]
buffer_load_dwordx4 v1, s[12:15], s26 offen offset:1024 sc1 lds
M v[104:107], a[116:119], a[84:87], 0
v_exp_f32 v80, v80
M v[104:107], a[120:123], a[88:91], v[104:107]
ds_read_b128 a[156:159], v2 offset:10240
ds_read_b128 a[160:163], v2 offset:11264
M v[104:107], a[124:127], a[92:95], v[104:107]
v_exp_f32 v81, v81
M v[104:107], a[128:131], a[96:99], v[104:107]
buffer_load_dwordx4 v1, s[12:15], s26 offen offset:2048 sc1 lds
M v[108:111], a[128:131], a[112:115], 0
v_exp_f32 v82, v82
M v[108:111], a[124:127], a[108:111], v[108:111]
v_cvt_pk_bf16_f32 v65, v66, v67
v_cvt_pk_bf16_f32 v66, v80, v81
M v[108:111], a[120:123], a[104:107], v[108:111]
v_exp_f32 v83, v83
M v[108:111], a[116:119], a[100:103], v[108:111]
buffer_load_dwordx4 v1, s[12:15], s26 offen offset:3072 sc1 lds
s_add_u32 m0, s29, 102400
s_waitcnt lgkmcnt(4)
M v[112:115], a[132:135], a[52:55], 0
v_exp_f32 v68, v68
M v[112:115], a[136:139], a[56:59], v[112:115]
ds_read_b128 a[164:167], v2 offset:12288
ds_read_b128 a[168:171], v2 offset:13312
M v[112:115], a[140:143], a[60:63], v[112:115]
v_exp_f32 v69, v69
M v[112:115], a[144:147], a[64:67], v[112:115]
buffer_load_dwordx4 v1, s[12:15], s32 offen offset:0 sc1 lds
M v[116:119], a[144:147], a[80:83], 0
v_exp_f32 v70, v70
M v[116:119], a[140:143], a[76:79], v[116:119]
v_cvt_pk_bf16_f32 v67, v82, v83
v_cvt_pk_bf16_f32 v68, v68, v69
M v[116:119], a[136:139], a[72:75], v[116:119]
v_exp_f32 v71, v71
M v[116:119], a[132:135], a[68:71], v[116:119]
buffer_load_dwordx4 v1, s[12:15], s32 offen offset:1024 sc1 lds
M v[120:123], a[132:135], a[84:87], 0
v_exp_f32 v84, v84
M v[120:123], a[136:139], a[88:91], v[120:123]
ds_read_b128 a[172:175], v2 offset:14336
ds_read_b128 a[176:179], v2 offset:15360
M v[120:123], a[140:143], a[92:95], v[120:123]
v_exp_f32 v85, v85
M v[120:123], a[144:147], a[96:99], v[120:123]
buffer_load_dwordx4 v1, s[12:15], s32 offen offset:2048 sc1 lds
M v[124:127], a[144:147], a[112:115], 0
v_exp_f32 v86, v86
M v[124:127], a[140:143], a[108:111], v[124:127]
v_cvt_pk_bf16_f32 v69, v70, v71
v_cvt_pk_bf16_f32 v70, v84, v85
M v[124:127], a[136:139], a[104:107], v[124:127]
v_exp_f32 v87, v87
M v[124:127], a[132:135], a[100:103], v[124:127]
buffer_load_dwordx4 v1, s[12:15], s32 offen offset:3072 sc1 lds
s_waitcnt lgkmcnt(4)
M v[128:131], a[148:151], a[52:55], 0
v_exp_f32 v72, v72
M v[128:131], a[152:155], a[56:59], v[128:131]
s_add_u32 s26, s26, 32768
s_cmp_eq_u32 s26, s62
s_cselect_b32 s26, s63, s26
s_cselect_b32 s62, -1, s62
M v[128:131], a[156:159], a[60:63], v[128:131]
v_exp_f32 v73, v73
M v[128:131], a[160:163], a[64:67], v[128:131]
v_cvt_pk_bf16_f32 v71, v86, v87
v_cvt_pk_bf16_f32 v72, v72, v73
M v[132:135], a[160:163], a[80:83], 0
v_exp_f32 v74, v74
M v[132:135], a[156:159], a[76:79], v[132:135]
M v[132:135], a[152:155], a[72:75], v[132:135]
v_exp_f32 v75, v75
M v[132:135], a[148:151], a[68:71], v[132:135]
v_cvt_pk_bf16_f32 v73, v74, v75
M v[136:139], a[148:151], a[84:87], 0
v_exp_f32 v88, v88
M v[136:139], a[152:155], a[88:91], v[136:139]
M v[136:139], a[156:159], a[92:95], v[136:139]
v_exp_f32 v89, v89
M v[136:139], a[160:163], a[96:99], v[136:139]
v_cvt_pk_bf16_f32 v74, v88, v89
M v[140:143], a[160:163], a[112:115], 0
v_exp_f32 v90, v90
M v[140:143], a[156:159], a[108:111], v[140:143]
s_waitcnt vmcnt(16) lgkmcnt(0)
s_barrier
ds_read_b128 a[116:119], v2 offset:32768
ds_read_b128 a[120:123], v2 offset:40960
ds_read_b128 a[124:127], v2 offset:33792
ds_read_b128 a[128:131], v2 offset:41984
M v[140:143], a[152:155], a[104:107], v[140:143]
v_exp_f32 v91, v91
M v[140:143], a[148:151], a[100:103], v[140:143]
v_cvt_pk_bf16_f32 v75, v90, v91
M v[144:147], a[164:167], a[52:55], 0
v_exp_f32 v76, v76
M v[144:147], a[168:171], a[56:59], v[144:147]
ds_read_b128 a[132:135], v2 offset:34816
ds_read_b128 a[136:139], v2 offset:43008
M v[144:147], a[172:175], a[60:63], v[144:147]
v_exp_f32 v77, v77
M v[144:147], a[176:179], a[64:67], v[144:147]
v_cvt_pk_bf16_f32 v76, v76, v77
M v[148:151], a[176:179], a[80:83], 0
v_exp_f32 v78, v78
M v[148:151], a[172:175], a[76:79], v[148:151]
M v[148:151], a[168:171], a[72:75], v[148:151]
v_exp_f32 v79, v79
M v[148:151], a[164:167], a[68:71], v[148:151]
v_cvt_pk_bf16_f32 v77, v78, v79
M v[152:155], a[164:167], a[84:87], 0
v_exp_f32 v92, v92
M v[152:155], a[168:171], a[88:91], v[152:155]
ds_read_b128 a[140:143], v2 offset:35840
ds_read_b128 a[144:147], v2 offset:44032
M v[152:155], a[172:175], a[92:95], v[152:155]
v_exp_f32 v93, v93
M v[152:155], a[176:179], a[96:99], v[152:155]
v_cvt_pk_bf16_f32 v78, v92, v93
M v[156:159], a[176:179], a[112:115], 0
v_exp_f32 v94, v94
M v[156:159], a[172:175], a[108:111], v[156:159]
M v[156:159], a[168:171], a[104:107], v[156:159]
v_exp_f32 v95, v95
M v[156:159], a[164:167], a[100:103], v[156:159]
v_cvt_pk_bf16_f32 v79, v94, v95
s_waitcnt lgkmcnt(6)
s_add_u32 m0, s29, 0
M v[160:163], a[116:119], v[32:35], v[160:163]
v_exp_f32 v96, v96
M v[160:163], a[120:123], v[64:67], v[160:163]
ds_read_b128 a[148:151], v2 offset:36864
ds_read_b128 a[152:155], v2 offset:45056
M v[164:167], a[120:123], v[68:71], v[164:167]
v_exp_f32 v97, v97
M v[164:167], a[116:119], v[36:39], v[164:167]
buffer_load_dwordx4 v1, s[12:15], s25 offen offset:0 sc1 lds
s_add_u32 s32, s25, 4096
M v[168:171], a[116:119], v[40:43], v[168:171]
v_exp_f32 v98, v98
M v[168:171], a[120:123], v[72:75], v[168:171]
v_cvt_pk_bf16_f32 v96, v96, v97
M v[172:175], a[120:123], v[76:79], v[172:175]
v_exp_f32 v99, v99
M v[172:175], a[116:119], v[44:47], v[172:175]
buffer_load_dwordx4 v1, s[12:15], s25 offen offset:1024 sc1 lds
s_waitcnt lgkmcnt(6)
M a[32:35], a[48:51], v[32:35], a[32:35]
M a[32:35], a[48:51], v[64:67], a[32:35]
M v[176:179], a[124:127], v[32:35], v[176:179]
v_exp_f32 v112, v112
M v[176:179], a[128:131], v[64:67], v[176:179]
ds_read_b128 a[156:159], v2 offset:37888
ds_read_b128 a[160:163], v2 offset:46080
M v[180:183], a[128:131], v[68:71], v[180:183]
v_exp_f32 v113, v113
M v[180:183], a[124:127], v[36:39], v[180:183]
buffer_load_dwordx4 v1, s[12:15], s25 offen offset:2048 sc1 lds
M v[184:187], a[124:127], v[40:43], v[184:187]
v_exp_f32 v114, v114
M v[184:187], a[128:131], v[72:75], v[184:187]
v_cvt_pk_bf16_f32 v97, v98, v99
v_cvt_pk_bf16_f32 v98, v112, v113
M v[188:191], a[128:131], v[76:79], v[188:191]
v_exp_f32 v115, v115
M v[188:191], a[124:127], v[44:47], v[188:191]
buffer_load_dwordx4 v1, s[12:15], s25 offen offset:3072 sc1 lds
s_add_u32 m0, s29, 4096
s_waitcnt lgkmcnt(6)
M a[36:39], a[48:51], v[36:39], a[36:39]
M a[36:39], a[48:51], v[68:71], a[36:39]
M v[192:195], a[132:135], v[32:35], v[192:195]
v_exp_f32 v100, v100
M v[192:195], a[136:139], v[64:67], v[192:195]
ds_read_b128 a[164:167], v2 offset:38912
ds_read_b128 a[168:171], v2 offset:47104
M v[196:199], a[136:139], v[68:71], v[196:199]
v_exp_f32 v101, v101
M v[196:199], a[132:135], v[36:39], v[196:199]
buffer_load_dwordx4 v1, s[12:15], s32 offen offset:0 sc1 lds
M v[200:203], a[132:135], v[40:43], v[200:203]
v_exp_f32 v102, v102
M v[200:203], a[136:139], v[72:75], v[200:203]
v_cvt_pk_bf16_f32 v99, v114, v115
v_cvt_pk_bf16_f32 v100, v100, v101
M v[204:207], a[136:139], v[76:79], v[204:207]
v_exp_f32 v103, v103
M v[204:207], a[132:135], v[44:47], v[204:207]
buffer_load_dwordx4 v1, s[12:15], s32 offen offset:1024 sc1 lds
s_waitcnt lgkmcnt(6)
M a[40:43], a[48:51], v[40:43], a[40:43]
M a[40:43], a[48:51], v[72:75], a[40:43]
M v[208:211], a[140:143], v[32:35], v[208:211]
v_exp_f32 v116, v116
M v[208:211], a[144:147], v[64:67], v[208:211]
ds_read_b128 a[172:175], v2 offset:39936
ds_read_b128 a[176:179], v2 offset:48128
M v[212:215], a[144:147], v[68:71], v[212:215]
v_exp_f32 v117, v117
M v[212:215], a[140:143], v[36:39], v[212:215]
buffer_load_dwordx4 v1, s[12:15], s32 offen offset:2048 sc1 lds
M v[216:219], a[140:143], v[40:43], v[216:219]
v_exp_f32 v118, v118
M v[216:219], a[144:147], v[72:75], v[216:219]
v_cvt_pk_bf16_f32 v101, v102, v103
v_cvt_pk_bf16_f32 v102, v116, v117
M v[220:223], a[144:147], v[76:79], v[220:223]
v_exp_f32 v119, v119
M v[220:223], a[140:143], v[44:47], v[220:223]
buffer_load_dwordx4 v1, s[12:15], s32 offen offset:3072 sc1 lds
s_waitcnt lgkmcnt(6)
M a[44:47], a[48:51], v[44:47], a[44:47]
M a[44:47], a[48:51], v[76:79], a[44:47]
M v[224:227], a[148:151], v[32:35], v[224:227]
v_exp_f32 v104, v104
M v[224:227], a[152:155], v[64:67], v[224:227]
s_add_u32 s25, s25, 32768
s_cmp_eq_u32 s25, s27
s_cselect_b32 s25, s28, s25
s_cselect_b32 s27, -1, s27
M v[228:231], a[152:155], v[68:71], v[228:231]
v_exp_f32 v105, v105
M v[228:231], a[148:151], v[36:39], v[228:231]
v_cvt_pk_bf16_f32 v103, v118, v119
v_cvt_pk_bf16_f32 v104, v104, v105
M v[232:235], a[148:151], v[40:43], v[232:235]
v_exp_f32 v106, v106
M v[232:235], a[152:155], v[72:75], v[232:235]
M v[236:239], a[152:155], v[76:79], v[236:239]
v_exp_f32 v107, v107
M v[236:239], a[148:151], v[44:47], v[236:239]
v_cvt_pk_bf16_f32 v105, v106, v107
s_waitcnt lgkmcnt(4)
M v[240:243], a[156:159], v[32:35], v[240:243]
v_exp_f32 v120, v120
M v[240:243], a[160:163], v[64:67], v[240:243]
M v[244:247], a[160:163], v[68:71], v[244:247]
v_exp_f32 v121, v121
M v[244:247], a[156:159], v[36:39], v[244:247]
v_cvt_pk_bf16_f32 v106, v120, v121
M v[248:251], a[156:159], v[40:43], v[248:251]
v_exp_f32 v122, v122
M v[248:251], a[160:163], v[72:75], v[248:251]
s_waitcnt vmcnt(16) lgkmcnt(0)
s_barrier
ds_read_b128 a[116:119], v3 offset:0
ds_read_b128 a[120:123], v3 offset:1024
ds_read_b128 a[124:127], v3 offset:2048
ds_read_b128 a[128:131], v3 offset:3072
M v[252:255], a[160:163], v[76:79], v[252:255]
v_exp_f32 v123, v123
M v[252:255], a[156:159], v[44:47], v[252:255]
v_cvt_pk_bf16_f32 v107, v122, v123
M a[0:3], a[164:167], v[32:35], a[0:3]
v_exp_f32 v108, v108
M a[0:3], a[168:171], v[64:67], a[0:3]
ds_read_b128 a[132:135], v3 offset:4096
ds_read_b128 a[136:139], v3 offset:5120
M a[4:7], a[168:171], v[68:71], a[4:7]
v_exp_f32 v109, v109
M a[4:7], a[164:167], v[36:39], a[4:7]
v_cvt_pk_bf16_f32 v108, v108, v109
M a[8:11], a[164:167], v[40:43], a[8:11]
v_exp_f32 v110, v110
M a[8:11], a[168:171], v[72:75], a[8:11]
M a[12:15], a[168:171], v[76:79], a[12:15]
v_exp_f32 v111, v111
M a[12:15], a[164:167], v[44:47], a[12:15]
v_cvt_pk_bf16_f32 v109, v110, v111
M a[16:19], a[172:175], v[32:35], a[16:19]
v_exp_f32 v124, v124
M a[16:19], a[176:179], v[64:67], a[16:19]
ds_read_b128 a[140:143], v3 offset:6144
ds_read_b128 a[144:147], v3 offset:7168
M a[20:23], a[176:179], v[68:71], a[20:23]
v_exp_f32 v125, v125
M a[20:23], a[172:175], v[36:39], a[20:23]
v_cvt_pk_bf16_f32 v110, v124, v125
M a[24:27], a[172:175], v[40:43], a[24:27]
v_exp_f32 v126, v126
M a[24:27], a[176:179], v[72:75], a[24:27]
M a[28:31], a[176:179], v[76:79], a[28:31]
v_exp_f32 v127, v127
M a[28:31], a[172:175], v[44:47], a[28:31]
v_cvt_pk_bf16_f32 v111, v126, v127
s_waitcnt lgkmcnt(4)
s_add_u32 m0, s29, 32768
M v[32:35], a[116:119], a[52:55], 0
v_exp_f32 v128, v128
M v[32:35], a[120:123], a[56:59], v[32:35]
ds_read_b128 a[148:151], v3 offset:8192
ds_read_b128 a[152:155], v3 offset:9216
M v[32:35], a[124:127], a[60:63], v[32:35]
v_exp_f32 v129, v129
M v[32:35], a[128:131], a[64:67], v[32:35]
buffer_load_dwordx4 v1, s[12:15], s26 offen offset:0 sc1 lds
s_add_u32 s32, s26, 4096
M v[36:39], a[128:131], a[80:83], 0
v_exp_f32 v130, v130
M v[36:39], a[124:127], a[76:79], v[36:39]
v_cvt_pk_bf16_f32 v128, v128, v129
M v[36:39], a[120:123], a[72:75], v[36:39]
v_exp_f32 v131, v131
M v[36:39], a[116:119], a[68:71], v[36:39]
buffer_load_dwordx4 v1, s[12:15], s26 offen offset:1024 sc1 lds
M v[40:43], a[116:119], a[84:87], 0
v_exp_f32 v144, v144
M v[40:43], a[120:123], a[88:91], v[40:43]
ds_read_b128 a[156:159], v3 offset:10240
ds_read_b128 a[160:163], v3 offset:11264
M v[40:43], a[124:127], a[92:95], v[40:43]
v_exp_f32 v145, v145
M v[40:43], a[128:131], a[96:99], v[40:43]
buffer_load_dwordx4 v1, s[12:15], s26 offen offset:2048 sc1 lds
M v[44:47], a[128:131], a[112:115], 0
v_exp_f32 v146, v146
M v[44:47], a[124:127], a[108:111], v[44:47]
v_cvt_pk_bf16_f32 v129, v130, v131
v_cvt_pk_bf16_f32 v130, v144, v145
M v[44:47], a[120:123], a[104:107], v[44:47]
v_exp_f32 v147, v147
M v[44:47], a[116:119], a[100:103], v[44:47]
buffer_load_dwordx4 v1, s[12:15], s26 offen offset:3072 sc1 lds
s_add_u32 m0, s29, 36864
s_waitcnt lgkmcnt(4)
M v[48:51], a[132:135], a[52:55], 0
v_exp_f32 v132, v132
M v[48:51], a[136:139], a[56:59], v[48:51]
ds_read_b128 a[164:167], v3 offset:12288
ds_read_b128 a[168:171], v3 offset:13312
M v[48:51], a[140:143], a[60:63], v[48:51]
v_exp_f32 v133, v133
M v[48:51], a[144:147], a[64:67], v[48:51]
buffer_load_dwordx4 v1, s[12:15], s32 offen offset:0 sc1 lds
M v[52:55], a[144:147], a[80:83], 0
v_exp_f32 v134, v134
M v[52:55], a[140:143], a[76:79], v[52:55]
v_cvt_pk_bf16_f32 v131, v146, v147
v_cvt_pk_bf16_f32 v132, v132, v133
M v[52:55], a[136:139], a[72:75], v[52:55]
v_exp_f32 v135, v135
M v[52:55], a[132:135], a[68:71], v[52:55]
buffer_load_dwordx4 v1, s[12:15], s32 offen offset:1024 sc1 lds
M v[56:59], a[132:135], a[84:87], 0
v_exp_f32 v148, v148
M v[56:59], a[136:139], a[88:91], v[56:59]
ds_read_b128 a[172:175], v3 offset:14336
ds_read_b128 a[176:179], v3 offset:15360
M v[56:59], a[140:143], a[92:95], v[56:59]
v_exp_f32 v149, v149
M v[56:59], a[144:147], a[96:99], v[56:59]
buffer_load_dwordx4 v1, s[12:15], s32 offen offset:2048 sc1 lds
M v[60:63], a[144:147], a[112:115], 0
v_exp_f32 v150, v150
M v[60:63], a[140:143], a[108:111], v[60:63]
v_cvt_pk_bf16_f32 v133, v134, v135
v_cvt_pk_bf16_f32 v134, v148, v149
M v[60:63], a[136:139], a[104:107], v[60:63]
v_exp_f32 v151, v151
M v[60:63], a[132:135], a[100:103], v[60:63]
buffer_load_dwordx4 v1, s[12:15], s32 offen offset:3072 sc1 lds
s_waitcnt lgkmcnt(4)
M v[64:67], a[148:151], a[52:55], 0
v_exp_f32 v136, v136
M v[64:67], a[152:155], a[56:59], v[64:67]
s_add_u32 s26, s26, 32768
s_cmp_eq_u32 s26, s62
s_cselect_b32 s26, s63, s26
s_cselect_b32 s62, -1, s62
M v[64:67], a[156:159], a[60:63], v[64:67]
v_exp_f32 v137, v137
M v[64:67], a[160:163], a[64:67], v[64:67]
v_cvt_pk_bf16_f32 v135, v150, v151
v_cvt_pk_bf16_f32 v136, v136, v137
M v[68:71], a[160:163], a[80:83], 0
v_exp_f32 v138, v138
M v[68:71], a[156:159], a[76:79], v[68:71]
M v[68:71], a[152:155], a[72:75], v[68:71]
v_exp_f32 v139, v139
M v[68:71], a[148:151], a[68:71], v[68:71]
v_cvt_pk_bf16_f32 v137, v138, v139
M v[72:75], a[148:151], a[84:87], 0
v_exp_f32 v152, v152
M v[72:75], a[152:155], a[88:91], v[72:75]
M v[72:75], a[156:159], a[92:95], v[72:75]
v_exp_f32 v153, v153
M v[72:75], a[160:163], a[96:99], v[72:75]
v_cvt_pk_bf16_f32 v138, v152, v153
M v[76:79], a[160:163], a[112:115], 0
v_exp_f32 v154, v154
M v[76:79], a[156:159], a[108:111], v[76:79]
s_waitcnt vmcnt(16) lgkmcnt(0)
s_barrier
ds_read_b128 a[116:119], v3 offset:32768
ds_read_b128 a[120:123], v3 offset:40960
ds_read_b128 a[124:127], v3 offset:33792
ds_read_b128 a[128:131], v3 offset:41984
M v[76:79], a[152:155], a[104:107], v[76:79]
v_exp_f32 v155, v155
M v[76:79], a[148:151], a[100:103], v[76:79]
v_cvt_pk_bf16_f32 v139, v154, v155
M v[80:83], a[164:167], a[52:55], 0
v_exp_f32 v140, v140
M v[80:83], a[168:171], a[56:59], v[80:83]
ds_read_b128 a[132:135], v3 offset:34816
ds_read_b128 a[136:139], v3 offset:43008
M v[80:83], a[172:175], a[60:63], v[80:83]
v_exp_f32 v141, v141
M v[80:83], a[176:179], a[64:67], v[80:83]
v_cvt_pk_bf16_f32 v140, v140, v141
M v[84:87], a[176:179], a[80:83], 0
v_exp_f32 v142, v142
M v[84:87], a[172:175], a[76:79], v[84:87]
M v[84:87], a[168:171], a[72:75], v[84:87]
v_exp_f32 v143, v143
M v[84:87], a[164:167], a[68:71], v[84:87]
v_cvt_pk_bf16_f32 v141, v142, v143
M v[88:91], a[164:167], a[84:87], 0
v_exp_f32 v156, v156
M v[88:91], a[168:171], a[88:91], v[88:91]
ds_read_b128 a[140:143], v3 offset:35840
ds_read_b128 a[144:147], v3 offset:44032
M v[88:91], a[172:175], a[92:95], v[88:91]
v_exp_f32 v157, v157
M v[88:91], a[176:179], a[96:99], v[88:91]
v_cvt_pk_bf16_f32 v142, v156, v157
M v[92:95], a[176:179], a[112:115], 0
v_exp_f32 v158, v158
M v[92:95], a[172:175], a[108:111], v[92:95]
M v[92:95], a[168:171], a[104:107], v[92:95]
v_exp_f32 v159, v159
M v[92:95], a[164:167], a[100:103], v[92:95]
v_cvt_pk_bf16_f32 v143, v158, v159
s_waitcnt lgkmcnt(6)
s_add_u32 m0, s29, 65536
M v[160:163], a[116:119], v[96:99], v[160:163]
v_exp_f32 v32, v32
M v[160:163], a[120:123], v[128:131], v[160:163]
ds_read_b128 a[148:151], v3 offset:36864
ds_read_b128 a[152:155], v3 offset:45056
M v[164:167], a[120:123], v[132:135], v[164:167]
v_exp_f32 v33, v33
M v[164:167], a[116:119], v[100:103], v[164:167]
buffer_load_dwordx4 v1, s[12:15], s25 offen offset:0 sc1 lds
s_add_u32 s32, s25, 4096
M v[168:171], a[116:119], v[104:107], v[168:171]
v_exp_f32 v34, v34
M v[168:171], a[120:123], v[136:139], v[168:171]
v_cvt_pk_bf16_f32 v32, v32, v33
M v[172:175], a[120:123], v[140:143], v[172:175]
v_exp_f32 v35, v35
M v[172:175], a[116:119], v[108:111], v[172:175]
buffer_load_dwordx4 v1, s[12:15], s25 offen offset:1024 sc1 lds
s_waitcnt lgkmcnt(6)
M a[32:35], a[48:51], v[96:99], a[32:35]
M a[32:35], a[48:51], v[128:131], a[32:35]
M v[176:179], a[124:127], v[96:99], v[176:179]
v_exp_f32 v48, v48
M v[176:179], a[128:131], v[128:131], v[176:179]
ds_read_b128 a[156:159], v3 offset:37888
ds_read_b128 a[160:163], v3 offset:46080
M v[180:183], a[128:131], v[132:135], v[180:183]
v_exp_f32 v49, v49
M v[180:183], a[124:127], v[100:103], v[180:183]
buffer_load_dwordx4 v1, s[12:15], s25 offen offset:2048 sc1 lds
M v[184:187], a[124:127], v[104:107], v[184:187]
v_exp_f32 v50, v50
M v[184:187], a[128:131], v[136:139], v[184:187]
v_cvt_pk_bf16_f32 v33, v34, v35
v_cvt_pk_bf16_f32 v34, v48, v49
M v[188:191], a[128:131], v[140:143], v[188:191]
v_exp_f32 v51, v51
M v[188:191], a[124:127], v[108:111], v[188:191]
buffer_load_dwordx4 v1, s[12:15], s25 offen offset:3072 sc1 lds
s_add_u32 m0, s29, 69632
s_waitcnt lgkmcnt(6)
M a[36:39], a[48:51], v[100:103], a[36:39]
M a[36:39], a[48:51], v[132:135], a[36:39]
M v[192:195], a[132:135], v[96:99], v[192:195]
v_exp_f32 v36, v36
M v[192:195], a[136:139], v[128:131], v[192:195]
ds_read_b128 a[164:167], v3 offset:38912
ds_read_b128 a[168:171], v3 offset:47104
M v[196:199], a[136:139], v[132:135], v[196:199]
v_exp_f32 v37, v37
M v[196:199], a[132:135], v[100:103], v[196:199]
buffer_load_dwordx4 v1, s[12:15], s32 offen offset:0 sc1 lds
M v[200:203], a[132:135], v[104:107], v[200:203]
v_exp_f32 v38, v38
M v[200:203], a[136:139], v[136:139], v[200:203]
v_cvt_pk_bf16_f32 v35, v50, v51
v_cvt_pk_bf16_f32 v36, v36, v37
M v[204:207], a[136:139], v[140:143], v[204:207]
v_exp_f32 v39, v39
M v[204:207], a[132:135], v[108:111], v[204:207]
buffer_load_dwordx4 v1, s[12:15], s32 offen offset:1024 sc1 lds
s_waitcnt lgkmcnt(6)
M a[40:43], a[48:51], v[104:107], a[40:43]
M a[40:43], a[48:51], v[136:139], a[40:43]
M v[208:211], a[140:143], v[96:99], v[208:211]
v_exp_f32 v52, v52
M v[208:211], a[144:147], v[128:131], v[208:211]
ds_read_b128 a[172:175], v3 offset:39936
ds_read_b128 a[176:179], v3 offset:48128
M v[212:215], a[144:147], v[132:135], v[212:215]
v_exp_f32 v53, v53
M v[212:215], a[140:143], v[100:103], v[212:215]
buffer_load_dwordx4 v1, s[12:15], s32 offen offset:2048 sc1 lds
M v[216:219], a[140:143], v[104:107], v[216:219]
v_exp_f32 v54, v54
M v[216:219], a[144:147], v[136:139], v[216:219]
v_cvt_pk_bf16_f32 v37, v38, v39
v_cvt_pk_bf16_f32 v38, v52, v53
M v[220:223], a[144:147], v[140:143], v[220:223]
v_exp_f32 v55, v55
M v[220:223], a[140:143], v[108:111], v[220:223]
buffer_load_dwordx4 v1, s[12:15], s32 offen offset:3072 sc1 lds
s_waitcnt lgkmcnt(6)
M a[44:47], a[48:51], v[108:111], a[44:47]
M a[44:47], a[48:51], v[140:143], a[44:47]
M v[224:227], a[148:151], v[96:99], v[224:227]
v_exp_f32 v40, v40
M v[224:227], a[152:155], v[128:131], v[224:227]
s_add_u32 s25, s25, 32768
s_cmp_eq_u32 s25, s27
s_cselect_b32 s25, s28, s25
s_cselect_b32 s27, -1, s27
M v[228:231], a[152:155], v[132:135], v[228:231]
v_exp_f32 v41, v41
M v[228:231], a[148:151], v[100:103], v[228:231]
v_cvt_pk_bf16_f32 v39, v54, v55
v_cvt_pk_bf16_f32 v40, v40, v41
M v[232:235], a[148:151], v[104:107], v[232:235]
v_exp_f32 v42, v42
M v[232:235], a[152:155], v[136:139], v[232:235]
M v[236:239], a[152:155], v[140:143], v[236:239]
v_exp_f32 v43, v43
M v[236:239], a[148:151], v[108:111], v[236:239]
v_cvt_pk_bf16_f32 v41, v42, v43
s_waitcnt lgkmcnt(4)
M v[240:243], a[156:159], v[96:99], v[240:243]
v_exp_f32 v56, v56
M v[240:243], a[160:163], v[128:131], v[240:243]
M v[244:247], a[160:163], v[132:135], v[244:247]
v_exp_f32 v57, v57
M v[244:247], a[156:159], v[100:103], v[244:247]
v_cvt_pk_bf16_f32 v42, v56, v57
M v[248:251], a[156:159], v[104:107], v[248:251]
v_exp_f32 v58, v58
M v[248:251], a[160:163], v[136:139], v[248:251]
s_waitcnt vmcnt(16) lgkmcnt(0)
s_barrier
ds_read_b128 a[116:119], v2 offset:0
ds_read_b128 a[120:123], v2 offset:1024
ds_read_b128 a[124:127], v2 offset:2048
ds_read_b128 a[128:131], v2 offset:3072
M v[252:255], a[160:163], v[140:143], v[252:255]
v_exp_f32 v59, v59
M v[252:255], a[156:159], v[108:111], v[252:255]
v_cvt_pk_bf16_f32 v43, v58, v59
M a[0:3], a[164:167], v[96:99], a[0:3]
v_exp_f32 v44, v44
M a[0:3], a[168:171], v[128:131], a[0:3]
ds_read_b128 a[132:135], v2 offset:4096
ds_read_b128 a[136:139], v2 offset:5120
M a[4:7], a[168:171], v[132:135], a[4:7]
v_exp_f32 v45, v45
M a[4:7], a[164:167], v[100:103], a[4:7]
v_cvt_pk_bf16_f32 v44, v44, v45
M a[8:11], a[164:167], v[104:107], a[8:11]
v_exp_f32 v46, v46
M a[8:11], a[168:171], v[136:139], a[8:11]
M a[12:15], a[168:171], v[140:143], a[12:15]
v_exp_f32 v47, v47
M a[12:15], a[164:167], v[108:111], a[12:15]
v_cvt_pk_bf16_f32 v45, v46, v47
M a[16:19], a[172:175], v[96:99], a[16:19]
v_exp_f32 v60, v60
M a[16:19], a[176:179], v[128:131], a[16:19]
ds_read_b128 a[140:143], v2 offset:6144
ds_read_b128 a[144:147], v2 offset:7168
M a[20:23], a[176:179], v[132:135], a[20:23]
v_exp_f32 v61, v61
M a[20:23], a[172:175], v[100:103], a[20:23]
v_cvt_pk_bf16_f32 v46, v60, v61
M a[24:27], a[172:175], v[104:107], a[24:27]
v_exp_f32 v62, v62
M a[24:27], a[176:179], v[136:139], a[24:27]
M a[28:31], a[176:179], v[140:143], a[28:31]
v_exp_f32 v63, v63
M a[28:31], a[172:175], v[108:111], a[28:31]
v_cvt_pk_bf16_f32 v47, v62, v63
s_sub_u32 s30, s30, 1
s_cmp_lg_u32 s30, 0
s_cbranch_scc1 Lk2_l3
s_lshl_b32 s33, s23, 6
s_add_i32 s33, s33, 0
s_cmp_gt_i32 s33, 0
s_cselect_b32 s34, 0, 0xf149f2ca
s_cmp_lt_i32 s33, 0
s_cselect_b32 s33, 0xf149f2ca, 0
v_mov_b32 v20, s34
v_mov_b32 v21, s34
v_mov_b32 v22, s34
v_mov_b32 v23, s34
v_mov_b32 v28, s33
v_mov_b32 v29, s33
v_mov_b32 v30, s33
v_mov_b32 v31, s33
v_med3_f32 v24, v16, v20, v28
v_med3_f32 v25, v17, v20, v28
v_med3_f32 v26, v18, v20, v28
v_med3_f32 v27, v19, v20, v28
s_waitcnt lgkmcnt(4)
s_add_u32 m0, s29, 98304
M v[96:99], a[116:119], a[52:55], v[24:27]
v_exp_f32 v64, v64
M v[96:99], a[120:123], a[56:59], v[96:99]
ds_read_b128 a[148:151], v2 offset:8192
ds_read_b128 a[152:155], v2 offset:9216
M v[96:99], a[124:127], a[60:63], v[96:99]
v_exp_f32 v65, v65
M v[96:99], a[128:131], a[64:67], v[96:99]
buffer_load_dwordx4 v1, s[12:15], s26 offen offset:0 sc1 lds
s_add_u32 s32, s26, 4096
M v[100:103], a[128:131], a[80:83], v[28:31]
v_exp_f32 v66, v66
M v[100:103], a[124:127], a[76:79], v[100:103]
v_cvt_pk_bf16_f32 v64, v64, v65
M v[100:103], a[120:123], a[72:75], v[100:103]
v_exp_f32 v67, v67
M v[100:103], a[116:119], a[68:71], v[100:103]
buffer_load_dwordx4 v1, s[12:15], s26 offen offset:1024 sc1 lds
M v[104:107], a[116:119], a[84:87], v[28:31]
v_exp_f32 v80, v80
M v[104:107], a[120:123], a[88:91], v[104:107]
ds_read_b128 a[156:159], v2 offset:10240
ds_read_b128 a[160:163], v2 offset:11264
M v[104:107], a[124:127], a[92:95], v[104:107]
v_exp_f32 v81, v81
M v[104:107], a[128:131], a[96:99], v[104:107]
buffer_load_dwordx4 v1, s[12:15], s26 offen offset:2048 sc1 lds
M v[108:111], a[128:131], a[112:115], v[28:31]
v_exp_f32 v82, v82
M v[108:111], a[124:127], a[108:111], v[108:111]
v_cvt_pk_bf16_f32 v65, v66, v67
v_cvt_pk_bf16_f32 v66, v80, v81
M v[108:111], a[120:123], a[104:107], v[108:111]
v_exp_f32 v83, v83
M v[108:111], a[116:119], a[100:103], v[108:111]
buffer_load_dwordx4 v1, s[12:15], s26 offen offset:3072 sc1 lds
s_add_u32 m0, s29, 102400
s_waitcnt lgkmcnt(4)
M v[112:115], a[132:135], a[52:55], v[20:23]
v_exp_f32 v68, v68
M v[112:115], a[136:139], a[56:59], v[112:115]
ds_read_b128 a[164:167], v2 offset:12288
ds_read_b128 a[168:171], v2 offset:13312
M v[112:115], a[140:143], a[60:63], v[112:115]
v_exp_f32 v69, v69
M v[112:115], a[144:147], a[64:67], v[112:115]
buffer_load_dwordx4 v1, s[12:15], s32 offen offset:0 sc1 lds
M v[116:119], a[144:147], a[80:83], v[24:27]
v_exp_f32 v70, v70
M v[116:119], a[140:143], a[76:79], v[116:119]
v_cvt_pk_bf16_f32 v67, v82, v83
v_cvt_pk_bf16_f32 v68, v68, v69
M v[116:119], a[136:139], a[72:75], v[116:119]
v_exp_f32 v71, v71
M v[116:119], a[132:135], a[68:71], v[116:119]
buffer_load_dwordx4 v1, s[12:15], s32 offen offset:1024 sc1 lds
M v[120:123], a[132:135], a[84:87], v[28:31]
v_exp_f32 v84, v84
M v[120:123], a[136:139], a[88:91], v[120:123]
ds_read_b128 a[172:175], v2 offset:14336
ds_read_b128 a[176:179], v2 offset:15360
M v[120:123], a[140:143], a[92:95], v[120:123]
v_exp_f32 v85, v85
M v[120:123], a[144:147], a[96:99], v[120:123]
buffer_load_dwordx4 v1, s[12:15], s32 offen offset:2048 sc1 lds
M v[124:127], a[144:147], a[112:115], v[28:31]
v_exp_f32 v86, v86
M v[124:127], a[140:143], a[108:111], v[124:127]
v_cvt_pk_bf16_f32 v69, v70, v71
v_cvt_pk_bf16_f32 v70, v84, v85
M v[124:127], a[136:139], a[104:107], v[124:127]
v_exp_f32 v87, v87
M v[124:127], a[132:135], a[100:103], v[124:127]
buffer_load_dwordx4 v1, s[12:15], s32 offen offset:3072 sc1 lds
s_waitcnt lgkmcnt(4)
M v[128:131], a[148:151], a[52:55], v[20:23]
v_exp_f32 v72, v72
M v[128:131], a[152:155], a[56:59], v[128:131]
s_add_u32 s26, s26, 32768
s_cmp_eq_u32 s26, s62
s_cselect_b32 s26, s63, s26
s_cselect_b32 s62, -1, s62
M v[128:131], a[156:159], a[60:63], v[128:131]
v_exp_f32 v73, v73
M v[128:131], a[160:163], a[64:67], v[128:131]
v_cvt_pk_bf16_f32 v71, v86, v87
v_cvt_pk_bf16_f32 v72, v72, v73
M v[132:135], a[160:163], a[80:83], v[20:23]
v_exp_f32 v74, v74
M v[132:135], a[156:159], a[76:79], v[132:135]
M v[132:135], a[152:155], a[72:75], v[132:135]
v_exp_f32 v75, v75
M v[132:135], a[148:151], a[68:71], v[132:135]
v_cvt_pk_bf16_f32 v73, v74, v75
M v[136:139], a[148:151], a[84:87], v[24:27]
v_exp_f32 v88, v88
M v[136:139], a[152:155], a[88:91], v[136:139]
M v[136:139], a[156:159], a[92:95], v[136:139]
v_exp_f32 v89, v89
M v[136:139], a[160:163], a[96:99], v[136:139]
v_cvt_pk_bf16_f32 v74, v88, v89
M v[140:143], a[160:163], a[112:115], v[28:31]
v_exp_f32 v90, v90
M v[140:143], a[156:159], a[108:111], v[140:143]
s_waitcnt vmcnt(16) lgkmcnt(0)
s_barrier
ds_read_b128 a[116:119], v2 offset:32768
ds_read_b128 a[120:123], v2 offset:40960
ds_read_b128 a[124:127], v2 offset:33792
ds_read_b128 a[128:131], v2 offset:41984
M v[140:143], a[152:155], a[104:107], v[140:143]
v_exp_f32 v91, v91
M v[140:143], a[148:151], a[100:103], v[140:143]
v_cvt_pk_bf16_f32 v75, v90, v91
M v[144:147], a[164:167], a[52:55], v[20:23]
v_exp_f32 v76, v76
M v[144:147], a[168:171], a[56:59], v[144:147]
ds_read_b128 a[132:135], v2 offset:34816
ds_read_b128 a[136:139], v2 offset:43008
M v[144:147], a[172:175], a[60:63], v[144:147]
v_exp_f32 v77, v77
M v[144:147], a[176:179], a[64:67], v[144:147]
v_cvt_pk_bf16_f32 v76, v76, v77
M v[148:151], a[176:179], a[80:83], v[20:23]
v_exp_f32 v78, v78
M v[148:151], a[172:175], a[76:79], v[148:151]
M v[148:151], a[168:171], a[72:75], v[148:151]
v_exp_f32 v79, v79
M v[148:151], a[164:167], a[68:71], v[148:151]
v_cvt_pk_bf16_f32 v77, v78, v79
M v[152:155], a[164:167], a[84:87], v[20:23]
v_exp_f32 v92, v92
M v[152:155], a[168:171], a[88:91], v[152:155]
ds_read_b128 a[140:143], v2 offset:35840
ds_read_b128 a[144:147], v2 offset:44032
M v[152:155], a[172:175], a[92:95], v[152:155]
v_exp_f32 v93, v93
M v[152:155], a[176:179], a[96:99], v[152:155]
v_cvt_pk_bf16_f32 v78, v92, v93
M v[156:159], a[176:179], a[112:115], v[24:27]
v_exp_f32 v94, v94
M v[156:159], a[172:175], a[108:111], v[156:159]
M v[156:159], a[168:171], a[104:107], v[156:159]
v_exp_f32 v95, v95
M v[156:159], a[164:167], a[100:103], v[156:159]
v_cvt_pk_bf16_f32 v79, v94, v95
s_waitcnt lgkmcnt(6)
s_add_u32 m0, s29, 0
M v[160:163], a[116:119], v[32:35], v[160:163]
v_exp_f32 v96, v96
M v[160:163], a[120:123], v[64:67], v[160:163]
ds_read_b128 a[148:151], v2 offset:36864
ds_read_b128 a[152:155], v2 offset:45056
M v[164:167], a[120:123], v[68:71], v[164:167]
v_exp_f32 v97, v97
M v[164:167], a[116:119], v[36:39], v[164:167]
buffer_load_dwordx4 v1, s[12:15], s25 offen offset:0 sc1 lds
s_add_u32 s32, s25, 4096
M v[168:171], a[116:119], v[40:43], v[168:171]
v_exp_f32 v98, v98
M v[168:171], a[120:123], v[72:75], v[168:171]
v_cvt_pk_bf16_f32 v96, v96, v97
M v[172:175], a[120:123], v[76:79], v[172:175]
v_exp_f32 v99, v99
M v[172:175], a[116:119], v[44:47], v[172:175]
buffer_load_dwordx4 v1, s[12:15], s25 offen offset:1024 sc1 lds
s_waitcnt lgkmcnt(6)
M a[32:35], a[48:51], v[32:35], a[32:35]
M a[32:35], a[48:51], v[64:67], a[32:35]
M v[176:179], a[124:127], v[32:35], v[176:179]
v_exp_f32 v112, v112
M v[176:179], a[128:131], v[64:67], v[176:179]
ds_read_b128 a[156:159], v2 offset:37888
ds_read_b128 a[160:163], v2 offset:46080
M v[180:183], a[128:131], v[68:71], v[180:183]
v_exp_f32 v113, v113
M v[180:183], a[124:127], v[36:39], v[180:183]
buffer_load_dwordx4 v1, s[12:15], s25 offen offset:2048 sc1 lds
M v[184:187], a[124:127], v[40:43], v[184:187]
v_exp_f32 v114, v114
M v[184:187], a[128:131], v[72:75], v[184:187]
v_cvt_pk_bf16_f32 v97, v98, v99
v_cvt_pk_bf16_f32 v98, v112, v113
M v[188:191], a[128:131], v[76:79], v[188:191]
v_exp_f32 v115, v115
M v[188:191], a[124:127], v[44:47], v[188:191]
buffer_load_dwordx4 v1, s[12:15], s25 offen offset:3072 sc1 lds
s_add_u32 m0, s29, 4096
s_waitcnt lgkmcnt(6)
M a[36:39], a[48:51], v[36:39], a[36:39]
M a[36:39], a[48:51], v[68:71], a[36:39]
M v[192:195], a[132:135], v[32:35], v[192:195]
v_exp_f32 v100, v100
M v[192:195], a[136:139], v[64:67], v[192:195]
ds_read_b128 a[164:167], v2 offset:38912
ds_read_b128 a[168:171], v2 offset:47104
M v[196:199], a[136:139], v[68:71], v[196:199]
v_exp_f32 v101, v101
M v[196:199], a[132:135], v[36:39], v[196:199]
buffer_load_dwordx4 v1, s[12:15], s32 offen offset:0 sc1 lds
M v[200:203], a[132:135], v[40:43], v[200:203]
v_exp_f32 v102, v102
M v[200:203], a[136:139], v[72:75], v[200:203]
v_cvt_pk_bf16_f32 v99, v114, v115
v_cvt_pk_bf16_f32 v100, v100, v101
M v[204:207], a[136:139], v[76:79], v[204:207]
v_exp_f32 v103, v103
M v[204:207], a[132:135], v[44:47], v[204:207]
buffer_load_dwordx4 v1, s[12:15], s32 offen offset:1024 sc1 lds
s_waitcnt lgkmcnt(6)
M a[40:43], a[48:51], v[40:43], a[40:43]
M a[40:43], a[48:51], v[72:75], a[40:43]
M v[208:211], a[140:143], v[32:35], v[208:211]
v_exp_f32 v116, v116
M v[208:211], a[144:147], v[64:67], v[208:211]
ds_read_b128 a[172:175], v2 offset:39936
ds_read_b128 a[176:179], v2 offset:48128
M v[212:215], a[144:147], v[68:71], v[212:215]
v_exp_f32 v117, v117
M v[212:215], a[140:143], v[36:39], v[212:215]
buffer_load_dwordx4 v1, s[12:15], s32 offen offset:2048 sc1 lds
M v[216:219], a[140:143], v[40:43], v[216:219]
v_exp_f32 v118, v118
M v[216:219], a[144:147], v[72:75], v[216:219]
v_cvt_pk_bf16_f32 v101, v102, v103
v_cvt_pk_bf16_f32 v102, v116, v117
M v[220:223], a[144:147], v[76:79], v[220:223]
v_exp_f32 v119, v119
M v[220:223], a[140:143], v[44:47], v[220:223]
buffer_load_dwordx4 v1, s[12:15], s32 offen offset:3072 sc1 lds
s_waitcnt lgkmcnt(6)
M a[44:47], a[48:51], v[44:47], a[44:47]
M a[44:47], a[48:51], v[76:79], a[44:47]
M v[224:227], a[148:151], v[32:35], v[224:227]
v_exp_f32 v104, v104
M v[224:227], a[152:155], v[64:67], v[224:227]
s_add_u32 s25, s25, 32768
s_cmp_eq_u32 s25, s27
s_cselect_b32 s25, s28, s25
s_cselect_b32 s27, -1, s27
M v[228:231], a[152:155], v[68:71], v[228:231]
v_exp_f32 v105, v105
M v[228:231], a[148:151], v[36:39], v[228:231]
v_cvt_pk_bf16_f32 v103, v118, v119
v_cvt_pk_bf16_f32 v104, v104, v105
M v[232:235], a[148:151], v[40:43], v[232:235]
v_exp_f32 v106, v106
M v[232:235], a[152:155], v[72:75], v[232:235]
M v[236:239], a[152:155], v[76:79], v[236:239]
v_exp_f32 v107, v107
M v[236:239], a[148:151], v[44:47], v[236:239]
v_cvt_pk_bf16_f32 v105, v106, v107
s_waitcnt lgkmcnt(4)
M v[240:243], a[156:159], v[32:35], v[240:243]
v_exp_f32 v120, v120
M v[240:243], a[160:163], v[64:67], v[240:243]
M v[244:247], a[160:163], v[68:71], v[244:247]
v_exp_f32 v121, v121
M v[244:247], a[156:159], v[36:39], v[244:247]
v_cvt_pk_bf16_f32 v106, v120, v121
M v[248:251], a[156:159], v[40:43], v[248:251]
v_exp_f32 v122, v122
M v[248:251], a[160:163], v[72:75], v[248:251]
s_waitcnt vmcnt(16) lgkmcnt(0)
s_barrier
ds_read_b128 a[116:119], v3 offset:0
ds_read_b128 a[120:123], v3 offset:1024
ds_read_b128 a[124:127], v3 offset:2048
ds_read_b128 a[128:131], v3 offset:3072
M v[252:255], a[160:163], v[76:79], v[252:255]
v_exp_f32 v123, v123
M v[252:255], a[156:159], v[44:47], v[252:255]
v_cvt_pk_bf16_f32 v107, v122, v123
M a[0:3], a[164:167], v[32:35], a[0:3]
v_exp_f32 v108, v108
M a[0:3], a[168:171], v[64:67], a[0:3]
ds_read_b128 a[132:135], v3 offset:4096
ds_read_b128 a[136:139], v3 offset:5120
M a[4:7], a[168:171], v[68:71], a[4:7]
v_exp_f32 v109, v109
M a[4:7], a[164:167], v[36:39], a[4:7]
v_cvt_pk_bf16_f32 v108, v108, v109
M a[8:11], a[164:167], v[40:43], a[8:11]
v_exp_f32 v110, v110
M a[8:11], a[168:171], v[72:75], a[8:11]
M a[12:15], a[168:171], v[76:79], a[12:15]
v_exp_f32 v111, v111
M a[12:15], a[164:167], v[44:47], a[12:15]
v_cvt_pk_bf16_f32 v109, v110, v111
M a[16:19], a[172:175], v[32:35], a[16:19]
v_exp_f32 v124, v124
M a[16:19], a[176:179], v[64:67], a[16:19]
ds_read_b128 a[140:143], v3 offset:6144
ds_read_b128 a[144:147], v3 offset:7168
M a[20:23], a[176:179], v[68:71], a[20:23]
v_exp_f32 v125, v125
M a[20:23], a[172:175], v[36:39], a[20:23]
v_cvt_pk_bf16_f32 v110, v124, v125
M a[24:27], a[172:175], v[40:43], a[24:27]
v_exp_f32 v126, v126
M a[24:27], a[176:179], v[72:75], a[24:27]
M a[28:31], a[176:179], v[76:79], a[28:31]
v_exp_f32 v127, v127
M a[28:31], a[172:175], v[44:47], a[28:31]
v_cvt_pk_bf16_f32 v111, v126, v127
s_lshl_b32 s33, s23, 6
s_add_i32 s33, s33, -64
s_cmp_gt_i32 s33, 0
s_cselect_b32 s34, 0, 0xf149f2ca
s_cmp_lt_i32 s33, 0
s_cselect_b32 s33, 0xf149f2ca, 0
v_mov_b32 v20, s34
v_mov_b32 v21, s34
v_mov_b32 v22, s34
v_mov_b32 v23, s34
v_mov_b32 v28, s33
v_mov_b32 v29, s33
v_mov_b32 v30, s33
v_mov_b32 v31, s33
v_med3_f32 v24, v16, v20, v28
v_med3_f32 v25, v17, v20, v28
v_med3_f32 v26, v18, v20, v28
v_med3_f32 v27, v19, v20, v28
s_waitcnt lgkmcnt(4)
s_add_u32 m0, s29, 32768
M v[32:35], a[116:119], a[52:55], v[24:27]
v_exp_f32 v128, v128
M v[32:35], a[120:123], a[56:59], v[32:35]
ds_read_b128 a[148:151], v3 offset:8192
ds_read_b128 a[152:155], v3 offset:9216
M v[32:35], a[124:127], a[60:63], v[32:35]
v_exp_f32 v129, v129
M v[32:35], a[128:131], a[64:67], v[32:35]
buffer_load_dwordx4 v1, s[12:15], s26 offen offset:0 sc1 lds
s_add_u32 s32, s26, 4096
M v[36:39], a[128:131], a[80:83], v[28:31]
v_exp_f32 v130, v130
M v[36:39], a[124:127], a[76:79], v[36:39]
v_cvt_pk_bf16_f32 v128, v128, v129
M v[36:39], a[120:123], a[72:75], v[36:39]
v_exp_f32 v131, v131
M v[36:39], a[116:119], a[68:71], v[36:39]
buffer_load_dwordx4 v1, s[12:15], s26 offen offset:1024 sc1 lds
M v[40:43], a[116:119], a[84:87], v[28:31]
v_exp_f32 v144, v144
M v[40:43], a[120:123], a[88:91], v[40:43]
ds_read_b128 a[156:159], v3 offset:10240
ds_read_b128 a[160:163], v3 offset:11264
M v[40:43], a[124:127], a[92:95], v[40:43]
v_exp_f32 v145, v145
M v[40:43], a[128:131], a[96:99], v[40:43]
buffer_load_dwordx4 v1, s[12:15], s26 offen offset:2048 sc1 lds
M v[44:47], a[128:131], a[112:115], v[28:31]
v_exp_f32 v146, v146
M v[44:47], a[124:127], a[108:111], v[44:47]
v_cvt_pk_bf16_f32 v129, v130, v131
v_cvt_pk_bf16_f32 v130, v144, v145
M v[44:47], a[120:123], a[104:107], v[44:47]
v_exp_f32 v147, v147
M v[44:47], a[116:119], a[100:103], v[44:47]
buffer_load_dwordx4 v1, s[12:15], s26 offen offset:3072 sc1 lds
s_add_u32 m0, s29, 36864
s_waitcnt lgkmcnt(4)
M v[48:51], a[132:135], a[52:55], v[20:23]
v_exp_f32 v132, v132
M v[48:51], a[136:139], a[56:59], v[48:51]
ds_read_b128 a[164:167], v3 offset:12288
ds_read_b128 a[168:171], v3 offset:13312
M v[48:51], a[140:143], a[60:63], v[48:51]
v_exp_f32 v133, v133
M v[48:51], a[144:147], a[64:67], v[48:51]
buffer_load_dwordx4 v1, s[12:15], s32 offen offset:0 sc1 lds
M v[52:55], a[144:147], a[80:83], v[24:27]
v_exp_f32 v134, v134
M v[52:55], a[140:143], a[76:79], v[52:55]
v_cvt_pk_bf16_f32 v131, v146, v147
v_cvt_pk_bf16_f32 v132, v132, v133
M v[52:55], a[136:139], a[72:75], v[52:55]
v_exp_f32 v135, v135
M v[52:55], a[132:135], a[68:71], v[52:55]
buffer_load_dwordx4 v1, s[12:15], s32 offen offset:1024 sc1 lds
M v[56:59], a[132:135], a[84:87], v[28:31]
v_exp_f32 v148, v148
M v[56:59], a[136:139], a[88:91], v[56:59]
ds_read_b128 a[172:175], v3 offset:14336
ds_read_b128 a[176:179], v3 offset:15360
M v[56:59], a[140:143], a[92:95], v[56:59]
v_exp_f32 v149, v149
M v[56:59], a[144:147], a[96:99], v[56:59]
buffer_load_dwordx4 v1, s[12:15], s32 offen offset:2048 sc1 lds
M v[60:63], a[144:147], a[112:115], v[28:31]
v_exp_f32 v150, v150
M v[60:63], a[140:143], a[108:111], v[60:63]
v_cvt_pk_bf16_f32 v133, v134, v135
v_cvt_pk_bf16_f32 v134, v148, v149
M v[60:63], a[136:139], a[104:107], v[60:63]
v_exp_f32 v151, v151
M v[60:63], a[132:135], a[100:103], v[60:63]
buffer_load_dwordx4 v1, s[12:15], s32 offen offset:3072 sc1 lds
s_waitcnt lgkmcnt(4)
M v[64:67], a[148:151], a[52:55], v[20:23]
v_exp_f32 v136, v136
M v[64:67], a[152:155], a[56:59], v[64:67]
s_add_u32 s26, s26, 32768
s_cmp_eq_u32 s26, s62
s_cselect_b32 s26, s63, s26
s_cselect_b32 s62, -1, s62
M v[64:67], a[156:159], a[60:63], v[64:67]
v_exp_f32 v137, v137
M v[64:67], a[160:163], a[64:67], v[64:67]
v_cvt_pk_bf16_f32 v135, v150, v151
v_cvt_pk_bf16_f32 v136, v136, v137
M v[68:71], a[160:163], a[80:83], v[20:23]
v_exp_f32 v138, v138
M v[68:71], a[156:159], a[76:79], v[68:71]
M v[68:71], a[152:155], a[72:75], v[68:71]
v_exp_f32 v139, v139
M v[68:71], a[148:151], a[68:71], v[68:71]
v_cvt_pk_bf16_f32 v137, v138, v139
M v[72:75], a[148:151], a[84:87], v[24:27]
v_exp_f32 v152, v152
M v[72:75], a[152:155], a[88:91], v[72:75]
M v[72:75], a[156:159], a[92:95], v[72:75]
v_exp_f32 v153, v153
M v[72:75], a[160:163], a[96:99], v[72:75]
v_cvt_pk_bf16_f32 v138, v152, v153
M v[76:79], a[160:163], a[112:115], v[28:31]
v_exp_f32 v154, v154
M v[76:79], a[156:159], a[108:111], v[76:79]
s_waitcnt vmcnt(16) lgkmcnt(0)
s_barrier
ds_read_b128 a[116:119], v3 offset:32768
ds_read_b128 a[120:123], v3 offset:40960
ds_read_b128 a[124:127], v3 offset:33792
ds_read_b128 a[128:131], v3 offset:41984
M v[76:79], a[152:155], a[104:107], v[76:79]
v_exp_f32 v155, v155
M v[76:79], a[148:151], a[100:103], v[76:79]
v_cvt_pk_bf16_f32 v139, v154, v155
M v[80:83], a[164:167], a[52:55], v[20:23]
v_exp_f32 v140, v140
M v[80:83], a[168:171], a[56:59], v[80:83]
ds_read_b128 a[132:135], v3 offset:34816
ds_read_b128 a[136:139], v3 offset:43008
M v[80:83], a[172:175], a[60:63], v[80:83]
v_exp_f32 v141, v141
M v[80:83], a[176:179], a[64:67], v[80:83]
v_cvt_pk_bf16_f32 v140, v140, v141
M v[84:87], a[176:179], a[80:83], v[20:23]
v_exp_f32 v142, v142
M v[84:87], a[172:175], a[76:79], v[84:87]
M v[84:87], a[168:171], a[72:75], v[84:87]
v_exp_f32 v143, v143
M v[84:87], a[164:167], a[68:71], v[84:87]
v_cvt_pk_bf16_f32 v141, v142, v143
M v[88:91], a[164:167], a[84:87], v[20:23]
v_exp_f32 v156, v156
M v[88:91], a[168:171], a[88:91], v[88:91]
ds_read_b128 a[140:143], v3 offset:35840
ds_read_b128 a[144:147], v3 offset:44032
M v[88:91], a[172:175], a[92:95], v[88:91]
v_exp_f32 v157, v157
M v[88:91], a[176:179], a[96:99], v[88:91]
v_cvt_pk_bf16_f32 v142, v156, v157
M v[92:95], a[176:179], a[112:115], v[24:27]
v_exp_f32 v158, v158
M v[92:95], a[172:175], a[108:111], v[92:95]
M v[92:95], a[168:171], a[104:107], v[92:95]
v_exp_f32 v159, v159
M v[92:95], a[164:167], a[100:103], v[92:95]
v_cvt_pk_bf16_f32 v143, v158, v159
s_waitcnt lgkmcnt(6)
s_add_u32 m0, s29, 65536
M v[160:163], a[116:119], v[96:99], v[160:163]
v_exp_f32 v32, v32
M v[160:163], a[120:123], v[128:131], v[160:163]
ds_read_b128 a[148:151], v3 offset:36864
ds_read_b128 a[152:155], v3 offset:45056
M v[164:167], a[120:123], v[132:135], v[164:167]
v_exp_f32 v33, v33
M v[164:167], a[116:119], v[100:103], v[164:167]
buffer_load_dwordx4 v1, s[12:15], s25 offen offset:0 sc1 lds
s_add_u32 s32, s25, 4096
M v[168:171], a[116:119], v[104:107], v[168:171]
v_exp_f32 v34, v34
M v[168:171], a[120:123], v[136:139], v[168:171]
v_cvt_pk_bf16_f32 v32, v32, v33
M v[172:175], a[120:123], v[140:143], v[172:175]
v_exp_f32 v35, v35
M v[172:175], a[116:119], v[108:111], v[172:175]
buffer_load_dwordx4 v1, s[12:15], s25 offen offset:1024 sc1 lds
s_waitcnt lgkmcnt(6)
M a[32:35], a[48:51], v[96:99], a[32:35]
M a[32:35], a[48:51], v[128:131], a[32:35]
M v[176:179], a[124:127], v[96:99], v[176:179]
v_exp_f32 v48, v48
M v[176:179], a[128:131], v[128:131], v[176:179]
ds_read_b128 a[156:159], v3 offset:37888
ds_read_b128 a[160:163], v3 offset:46080
M v[180:183], a[128:131], v[132:135], v[180:183]
v_exp_f32 v49, v49
M v[180:183], a[124:127], v[100:103], v[180:183]
buffer_load_dwordx4 v1, s[12:15], s25 offen offset:2048 sc1 lds
M v[184:187], a[124:127], v[104:107], v[184:187]
v_exp_f32 v50, v50
M v[184:187], a[128:131], v[136:139], v[184:187]
v_cvt_pk_bf16_f32 v33, v34, v35
v_cvt_pk_bf16_f32 v34, v48, v49
M v[188:191], a[128:131], v[140:143], v[188:191]
v_exp_f32 v51, v51
M v[188:191], a[124:127], v[108:111], v[188:191]
buffer_load_dwordx4 v1, s[12:15], s25 offen offset:3072 sc1 lds
s_add_u32 m0, s29, 69632
s_waitcnt lgkmcnt(6)
M a[36:39], a[48:51], v[100:103], a[36:39]
M a[36:39], a[48:51], v[132:135], a[36:39]
M v[192:195], a[132:135], v[96:99], v[192:195]
v_exp_f32 v36, v36
M v[192:195], a[136:139], v[128:131], v[192:195]
ds_read_b128 a[164:167], v3 offset:38912
ds_read_b128 a[168:171], v3 offset:47104
M v[196:199], a[136:139], v[132:135], v[196:199]
v_exp_f32 v37, v37
M v[196:199], a[132:135], v[100:103], v[196:199]
buffer_load_dwordx4 v1, s[12:15], s32 offen offset:0 sc1 lds
M v[200:203], a[132:135], v[104:107], v[200:203]
v_exp_f32 v38, v38
M v[200:203], a[136:139], v[136:139], v[200:203]
v_cvt_pk_bf16_f32 v35, v50, v51
v_cvt_pk_bf16_f32 v36, v36, v37
M v[204:207], a[136:139], v[140:143], v[204:207]
v_exp_f32 v39, v39
M v[204:207], a[132:135], v[108:111], v[204:207]
buffer_load_dwordx4 v1, s[12:15], s32 offen offset:1024 sc1 lds
s_waitcnt lgkmcnt(6)
M a[40:43], a[48:51], v[104:107], a[40:43]
M a[40:43], a[48:51], v[136:139], a[40:43]
M v[208:211], a[140:143], v[96:99], v[208:211]
v_exp_f32 v52, v52
M v[208:211], a[144:147], v[128:131], v[208:211]
ds_read_b128 a[172:175], v3 offset:39936
ds_read_b128 a[176:179], v3 offset:48128
M v[212:215], a[144:147], v[132:135], v[212:215]
v_exp_f32 v53, v53
M v[212:215], a[140:143], v[100:103], v[212:215]
buffer_load_dwordx4 v1, s[12:15], s32 offen offset:2048 sc1 lds
M v[216:219], a[140:143], v[104:107], v[216:219]
v_exp_f32 v54, v54
M v[216:219], a[144:147], v[136:139], v[216:219]
v_cvt_pk_bf16_f32 v37, v38, v39
v_cvt_pk_bf16_f32 v38, v52, v53
M v[220:223], a[144:147], v[140:143], v[220:223]
v_exp_f32 v55, v55
M v[220:223], a[140:143], v[108:111], v[220:223]
buffer_load_dwordx4 v1, s[12:15], s32 offen offset:3072 sc1 lds
s_waitcnt lgkmcnt(6)
M a[44:47], a[48:51], v[108:111], a[44:47]
M a[44:47], a[48:51], v[140:143], a[44:47]
M v[224:227], a[148:151], v[96:99], v[224:227]
v_exp_f32 v40, v40
M v[224:227], a[152:155], v[128:131], v[224:227]
s_add_u32 s25, s25, 32768
s_cmp_eq_u32 s25, s27
s_cselect_b32 s25, s28, s25
s_cselect_b32 s27, -1, s27
M v[228:231], a[152:155], v[132:135], v[228:231]
v_exp_f32 v41, v41
M v[228:231], a[148:151], v[100:103], v[228:231]
v_cvt_pk_bf16_f32 v39, v54, v55
v_cvt_pk_bf16_f32 v40, v40, v41
M v[232:235], a[148:151], v[104:107], v[232:235]
v_exp_f32 v42, v42
M v[232:235], a[152:155], v[136:139], v[232:235]
M v[236:239], a[152:155], v[140:143], v[236:239]
v_exp_f32 v43, v43
M v[236:239], a[148:151], v[108:111], v[236:239]
v_cvt_pk_bf16_f32 v41, v42, v43
s_waitcnt lgkmcnt(4)
M v[240:243], a[156:159], v[96:99], v[240:243]
v_exp_f32 v56, v56
M v[240:243], a[160:163], v[128:131], v[240:243]
M v[244:247], a[160:163], v[132:135], v[244:247]
v_exp_f32 v57, v57
M v[244:247], a[156:159], v[100:103], v[244:247]
v_cvt_pk_bf16_f32 v42, v56, v57
M v[248:251], a[156:159], v[104:107], v[248:251]
v_exp_f32 v58, v58
M v[248:251], a[160:163], v[136:139], v[248:251]
s_waitcnt vmcnt(16) lgkmcnt(0)
s_barrier
ds_read_b128 a[116:119], v2 offset:0
ds_read_b128 a[120:123], v2 offset:1024
ds_read_b128 a[124:127], v2 offset:2048
ds_read_b128 a[128:131], v2 offset:3072
M v[252:255], a[160:163], v[140:143], v[252:255]
v_exp_f32 v59, v59
M v[252:255], a[156:159], v[108:111], v[252:255]
v_cvt_pk_bf16_f32 v43, v58, v59
M a[0:3], a[164:167], v[96:99], a[0:3]
v_exp_f32 v44, v44
M a[0:3], a[168:171], v[128:131], a[0:3]
ds_read_b128 a[132:135], v2 offset:4096
ds_read_b128 a[136:139], v2 offset:5120
M a[4:7], a[168:171], v[132:135], a[4:7]
v_exp_f32 v45, v45
M a[4:7], a[164:167], v[100:103], a[4:7]
v_cvt_pk_bf16_f32 v44, v44, v45
M a[8:11], a[164:167], v[104:107], a[8:11]
v_exp_f32 v46, v46
M a[8:11], a[168:171], v[136:139], a[8:11]
M a[12:15], a[168:171], v[140:143], a[12:15]
v_exp_f32 v47, v47
M a[12:15], a[164:167], v[108:111], a[12:15]
v_cvt_pk_bf16_f32 v45, v46, v47
M a[16:19], a[172:175], v[96:99], a[16:19]
v_exp_f32 v60, v60
M a[16:19], a[176:179], v[128:131], a[16:19]
ds_read_b128 a[140:143], v2 offset:6144
ds_read_b128 a[144:147], v2 offset:7168
M a[20:23], a[176:179], v[132:135], a[20:23]
v_exp_f32 v61, v61
M a[20:23], a[172:175], v[100:103], a[20:23]
v_cvt_pk_bf16_f32 v46, v60, v61
M a[24:27], a[172:175], v[104:107], a[24:27]
v_exp_f32 v62, v62
M a[24:27], a[176:179], v[136:139], a[24:27]
M a[28:31], a[176:179], v[140:143], a[28:31]
v_exp_f32 v63, v63
M a[28:31], a[172:175], v[108:111], a[28:31]
v_cvt_pk_bf16_f32 v47, v62, v63
s_waitcnt lgkmcnt(0)
Lk2_fin:
s_waitcnt vmcnt(8)
s_barrier
s_lshl_b32 s33, s2, 2
s_add_u32 s33, s33, s22
s_lshl_b32 s34, s33, 11
s_lshl_b32 s33, s33, 13
v_lshlrev_b32 v8, 3, v1
v_lshlrev_b32 v9, 1, v1
buffer_load_dword v5, v8, s[44:47], s33 offen
buffer_load_dword v6, v9, s[48:51], s34 offen
s_and_b32 s3, s2, 3
s_lshl_b32 s3, s3, 2
s_bfe_u32 s27, s2, 0x20003
s_add_u32 s27, s3, s27
s_lshl_b32 s43, s27, 8
s_add_u32 s43, s43, 8400896
v_lshlrev_b32 v15, 2, v0
buffer_load_dword v7, v15, s[52:55], s43 offen sc1
ds_read_b128 a[116:119], v2 offset:32768
ds_read_b128 a[120:123], v2 offset:40960
ds_read_b128 a[124:127], v2 offset:33792
ds_read_b128 a[128:131], v2 offset:41984
ds_read_b128 a[132:135], v2 offset:34816
ds_read_b128 a[136:139], v2 offset:43008
ds_read_b128 a[140:143], v2 offset:35840
ds_read_b128 a[144:147], v2 offset:44032
v_exp_f32 v64, v64
v_exp_f32 v65, v65
v_exp_f32 v66, v66
v_exp_f32 v67, v67
v_exp_f32 v80, v80
v_exp_f32 v81, v81
v_exp_f32 v82, v82
v_exp_f32 v83, v83
v_cvt_pk_bf16_f32 v64, v64, v65
v_cvt_pk_bf16_f32 v65, v66, v67
v_exp_f32 v68, v68
v_exp_f32 v69, v69
v_exp_f32 v70, v70
v_exp_f32 v71, v71
v_cvt_pk_bf16_f32 v66, v80, v81
v_cvt_pk_bf16_f32 v67, v82, v83
v_exp_f32 v84, v84
v_exp_f32 v85, v85
v_exp_f32 v86, v86
v_exp_f32 v87, v87
v_cvt_pk_bf16_f32 v68, v68, v69
v_cvt_pk_bf16_f32 v69, v70, v71
v_exp_f32 v72, v72
v_exp_f32 v73, v73
v_exp_f32 v74, v74
v_exp_f32 v75, v75
v_cvt_pk_bf16_f32 v70, v84, v85
v_cvt_pk_bf16_f32 v71, v86, v87
v_exp_f32 v88, v88
v_exp_f32 v89, v89
v_exp_f32 v90, v90
v_exp_f32 v91, v91
v_cvt_pk_bf16_f32 v72, v72, v73
v_cvt_pk_bf16_f32 v73, v74, v75
v_exp_f32 v76, v76
v_exp_f32 v77, v77
v_exp_f32 v78, v78
v_exp_f32 v79, v79
v_cvt_pk_bf16_f32 v74, v88, v89
v_cvt_pk_bf16_f32 v75, v90, v91
v_exp_f32 v92, v92
v_exp_f32 v93, v93
v_exp_f32 v94, v94
v_exp_f32 v95, v95
v_cvt_pk_bf16_f32 v76, v76, v77
v_cvt_pk_bf16_f32 v77, v78, v79
v_cvt_pk_bf16_f32 v78, v92, v93
v_cvt_pk_bf16_f32 v79, v94, v95
s_waitcnt lgkmcnt(6)
M v[160:163], a[116:119], v[32:35], v[160:163]
M v[160:163], a[120:123], v[64:67], v[160:163]
ds_read_b128 a[148:151], v2 offset:36864
ds_read_b128 a[152:155], v2 offset:45056
M v[164:167], a[120:123], v[68:71], v[164:167]
M v[164:167], a[116:119], v[36:39], v[164:167]
M v[168:171], a[116:119], v[40:43], v[168:171]
M v[168:171], a[120:123], v[72:75], v[168:171]
M v[172:175], a[120:123], v[76:79], v[172:175]
M v[172:175], a[116:119], v[44:47], v[172:175]
s_waitcnt lgkmcnt(6)
M a[32:35], a[48:51], v[32:35], a[32:35]
M a[32:35], a[48:51], v[64:67], a[32:35]
M v[176:179], a[124:127], v[32:35], v[176:179]
M v[176:179], a[128:131], v[64:67], v[176:179]
ds_read_b128 a[156:159], v2 offset:37888
ds_read_b128 a[160:163], v2 offset:46080
M v[180:183], a[128:131], v[68:71], v[180:183]
M v[180:183], a[124:127], v[36:39], v[180:183]
M v[184:187], a[124:127], v[40:43], v[184:187]
M v[184:187], a[128:131], v[72:75], v[184:187]
M v[188:191], a[128:131], v[76:79], v[188:191]
M v[188:191], a[124:127], v[44:47], v[188:191]
s_waitcnt lgkmcnt(6)
M a[36:39], a[48:51], v[36:39], a[36:39]
M a[36:39], a[48:51], v[68:71], a[36:39]
M v[192:195], a[132:135], v[32:35], v[192:195]
M v[192:195], a[136:139], v[64:67], v[192:195]
ds_read_b128 a[164:167], v2 offset:38912
ds_read_b128 a[168:171], v2 offset:47104
M v[196:199], a[136:139], v[68:71], v[196:199]
M v[196:199], a[132:135], v[36:39], v[196:199]
M v[200:203], a[132:135], v[40:43], v[200:203]
M v[200:203], a[136:139], v[72:75], v[200:203]
M v[204:207], a[136:139], v[76:79], v[204:207]
M v[204:207], a[132:135], v[44:47], v[204:207]
s_waitcnt lgkmcnt(6)
M a[40:43], a[48:51], v[40:43], a[40:43]
M a[40:43], a[48:51], v[72:75], a[40:43]
M v[208:211], a[140:143], v[32:35], v[208:211]
M v[208:211], a[144:147], v[64:67], v[208:211]
ds_read_b128 a[172:175], v2 offset:39936
ds_read_b128 a[176:179], v2 offset:48128
M v[212:215], a[144:147], v[68:71], v[212:215]
M v[212:215], a[140:143], v[36:39], v[212:215]
M v[216:219], a[140:143], v[40:43], v[216:219]
M v[216:219], a[144:147], v[72:75], v[216:219]
M v[220:223], a[144:147], v[76:79], v[220:223]
M v[220:223], a[140:143], v[44:47], v[220:223]
s_waitcnt lgkmcnt(6)
M a[44:47], a[48:51], v[44:47], a[44:47]
M a[44:47], a[48:51], v[76:79], a[44:47]
M v[224:227], a[148:151], v[32:35], v[224:227]
M v[224:227], a[152:155], v[64:67], v[224:227]
M v[228:231], a[152:155], v[68:71], v[228:231]
M v[228:231], a[148:151], v[36:39], v[228:231]
M v[232:235], a[148:151], v[40:43], v[232:235]
M v[232:235], a[152:155], v[72:75], v[232:235]
M v[236:239], a[152:155], v[76:79], v[236:239]
M v[236:239], a[148:151], v[44:47], v[236:239]
s_waitcnt lgkmcnt(4)
M v[240:243], a[156:159], v[32:35], v[240:243]
M v[240:243], a[160:163], v[64:67], v[240:243]
M v[244:247], a[160:163], v[68:71], v[244:247]
M v[244:247], a[156:159], v[36:39], v[244:247]
M v[248:251], a[156:159], v[40:43], v[248:251]
M v[248:251], a[160:163], v[72:75], v[248:251]
s_waitcnt vmcnt(63) lgkmcnt(0)
s_barrier
M v[252:255], a[160:163], v[76:79], v[252:255]
M v[252:255], a[156:159], v[44:47], v[252:255]
M a[0:3], a[164:167], v[32:35], a[0:3]
M a[0:3], a[168:171], v[64:67], a[0:3]
M a[4:7], a[168:171], v[68:71], a[4:7]
M a[4:7], a[164:167], v[36:39], a[4:7]
M a[8:11], a[164:167], v[40:43], a[8:11]
M a[8:11], a[168:171], v[72:75], a[8:11]
M a[12:15], a[168:171], v[76:79], a[12:15]
M a[12:15], a[164:167], v[44:47], a[12:15]
M a[16:19], a[172:175], v[32:35], a[16:19]
M a[16:19], a[176:179], v[64:67], a[16:19]
M a[20:23], a[176:179], v[68:71], a[20:23]
M a[20:23], a[172:175], v[36:39], a[20:23]
M a[24:27], a[172:175], v[40:43], a[24:27]
M a[24:27], a[176:179], v[72:75], a[24:27]
M a[28:31], a[176:179], v[76:79], a[28:31]
M a[28:31], a[172:175], v[44:47], a[28:31]
Lk2_merge:
s_lshl_b32 s33, s23, 14
s_add_u32 s34, s33, 131072
s_add_u32 s33, s33, 32768
s_cmp_eq_u32 s24, 0
s_cselect_b32 s35, s34, s33
s_cselect_b32 s36, s33, s34
v_add_u32 v2, s35, v1
v_add_u32 v3, s36, v1
s_lshl_b32 s33, s22, 10
s_add_u32 s33, s33, 28672
s_xor_b32 s34, s33, 2048
v_add_u32 v14, s33, v1
v_add_u32 v15, s34, v1
v_accvgpr_read_b32 v20, a32
v_accvgpr_read_b32 v21, a36
v_accvgpr_read_b32 v22, a40
v_accvgpr_read_b32 v23, a44
ds_write_b128 v14, v[20:23]
s_cmp_eq_u32 s24, 1
s_waitcnt lgkmcnt(0)
s_cbranch_scc1 Lk2_mg1
ds_write_b128 v2, v[224:227] offset:0
ds_write_b128 v2, v[228:231] offset:1024
ds_write_b128 v2, v[232:235] offset:2048
ds_write_b128 v2, v[236:239] offset:3072
ds_write_b128 v2, v[240:243] offset:4096
ds_write_b128 v2, v[244:247] offset:5120
ds_write_b128 v2, v[248:251] offset:6144
ds_write_b128 v2, v[252:255] offset:7168
ds_write_b128 v2, a[0:3] offset:8192
ds_write_b128 v2, a[4:7] offset:9216
ds_write_b128 v2, a[8:11] offset:10240
ds_write_b128 v2, a[12:15] offset:11264
ds_write_b128 v2, a[16:19] offset:12288
ds_write_b128 v2, a[20:23] offset:13312
ds_write_b128 v2, a[24:27] offset:14336
ds_write_b128 v2, a[28:31] offset:15360
s_waitcnt vmcnt(0) lgkmcnt(0)
s_barrier
ds_read_b128 v[28:31], v15
ds_read_b128 v[32:35], v3 offset:0
ds_read_b128 v[36:39], v3 offset:1024
ds_read_b128 v[40:43], v3 offset:2048
ds_read_b128 v[44:47], v3 offset:3072
ds_read_b128 v[48:51], v3 offset:4096
ds_read_b128 v[52:55], v3 offset:5120
ds_read_b128 v[56:59], v3 offset:6144
ds_read_b128 v[60:63], v3 offset:7168
ds_read_b128 v[64:67], v3 offset:8192
ds_read_b128 v[68:71], v3 offset:9216
ds_read_b128 v[72:75], v3 offset:10240
ds_read_b128 v[76:79], v3 offset:11264
ds_read_b128 v[80:83], v3 offset:12288
ds_read_b128 v[84:87], v3 offset:13312
ds_read_b128 v[88:91], v3 offset:14336
ds_read_b128 v[92:95], v3 offset:15360
s_mov_b32 s61, 0
v_cmp_ne_u32 vcc, 1, v7
s_nop 0
s_cbranch_vccnz Lk3_spinb0
Lk3_gotb0:
s_bfe_u32 s3, s2, 0x10002
s_lshl_b32 s3, s3, 3
s_lshr_b32 s28, s2, 5
s_add_u32 s28, s3, s28
s_lshl_b32 s25, s27, 18
s_lshl_b32 s3, s101, 12
s_add_u32 s25, s25, s3
s_lshl_b32 s26, s28, 7
s_lshl_b32 s42, s101, 11
s_add_u32 s44, s4, 83886080
s_addc_u32 s45, s5, 0
s_mov_b32 s46, 4194304
s_mov_b32 s47, 0x00020000
s_mov_b32 s50, 2097152
s_mov_b32 s51, 0x00020000
s_lshl_b32 s3, s101, 4
v_lshrrev_b32 v96, 3, v0
v_and_b32 v97, 6, v96
v_and_b32 v98, 7, v0
v_xor_b32 v97, v97, v98
v_add_u32 v96, s3, v96
v_lshlrev_b32 v96, 11, v96
v_lshl_add_u32 v99, v97, 4, v96
v_add_u32 v100, 15360, v99
s_add_u32 m0, s42, 65536
s_nop 0
buffer_load_dwordx4 v99, s[48:51], s26 offen offset:0 lds
buffer_load_dwordx4 v100, s[48:51], s26 offen offset:1024 lds
buffer_load_dwordx4 a[192:195], v1, s[44:47], s25 offen offset:0 sc1
buffer_load_dwordx4 a[196:199], v1, s[44:47], s25 offen offset:1024 sc1
buffer_load_dwordx4 a[200:203], v1, s[44:47], s25 offen offset:2048 sc1
buffer_load_dwordx4 a[204:207], v1, s[44:47], s25 offen offset:3072 sc1
s_add_u32 s25, s25, 16384
s_add_u32 s26, s26, 131072
s_add_u32 m0, s42, 81920
s_nop 0
buffer_load_dwordx4 v99, s[48:51], s26 offen offset:0 lds
buffer_load_dwordx4 v100, s[48:51], s26 offen offset:1024 lds
buffer_load_dwordx4 a[208:211], v1, s[44:47], s25 offen offset:0 sc1
buffer_load_dwordx4 a[212:215], v1, s[44:47], s25 offen offset:1024 sc1
buffer_load_dwordx4 a[216:219], v1, s[44:47], s25 offen offset:2048 sc1
buffer_load_dwordx4 a[220:223], v1, s[44:47], s25 offen offset:3072 sc1
s_add_u32 s25, s25, 16384
s_add_u32 s26, s26, 131072
s_add_u32 m0, s42, 98304
s_nop 0
buffer_load_dwordx4 v99, s[48:51], s26 offen offset:0 lds
buffer_load_dwordx4 v100, s[48:51], s26 offen offset:1024 lds
buffer_load_dwordx4 a[224:227], v1, s[44:47], s25 offen offset:0 sc1
buffer_load_dwordx4 a[228:231], v1, s[44:47], s25 offen offset:1024 sc1
buffer_load_dwordx4 a[232:235], v1, s[44:47], s25 offen offset:2048 sc1
buffer_load_dwordx4 a[236:239], v1, s[44:47], s25 offen offset:3072 sc1
s_add_u32 s25, s25, 16384
s_add_u32 s26, s26, 131072
s_add_u32 m0, s42, 114688
s_nop 0
buffer_load_dwordx4 v99, s[48:51], s26 offen offset:0 lds
buffer_load_dwordx4 v100, s[48:51], s26 offen offset:1024 lds
buffer_load_dwordx4 a[240:243], v1, s[44:47], s25 offen offset:0 sc1
buffer_load_dwordx4 a[244:247], v1, s[44:47], s25 offen offset:1024 sc1
buffer_load_dwordx4 a[248:251], v1, s[44:47], s25 offen offset:2048 sc1
buffer_load_dwordx4 a[252:255], v1, s[44:47], s25 offen offset:3072 sc1
s_add_u32 s25, s25, 16384
s_add_u32 s26, s26, 131072
s_add_u32 m0, s42, 0
s_nop 0
buffer_load_dwordx4 v99, s[48:51], s26 offen offset:0 lds
buffer_load_dwordx4 v100, s[48:51], s26 offen offset:1024 lds
buffer_load_dwordx4 a[128:131], v1, s[44:47], s25 offen offset:0 sc1
buffer_load_dwordx4 a[132:135], v1, s[44:47], s25 offen offset:1024 sc1
buffer_load_dwordx4 a[136:139], v1, s[44:47], s25 offen offset:2048 sc1
buffer_load_dwordx4 a[140:143], v1, s[44:47], s25 offen offset:3072 sc1
s_add_u32 s25, s25, 16384
s_add_u32 s26, s26, 131072
s_waitcnt lgkmcnt(15)
v_add_f32 v20, v20, v28
v_add_f32 v21, v21, v29
v_add_f32 v22, v22, v30
v_add_f32 v23, v23, v31
s_sub_u32 s35, 15, s21
v_rcp_f32 v8, v20
v_rcp_f32 v9, v21
v_rcp_f32 v10, v22
v_rcp_f32 v11, v23
v_subrev_u32 v20, 0x21800000, v20
v_subrev_u32 v21, 0x21800000, v21
v_subrev_u32 v22, 0x21800000, v22
v_subrev_u32 v23, 0x21800000, v23
v_max_u32 v12, v20, v21
v_max3_u32 v12, v12, v22, v23
s_mov_b32 s64, 0x207
v_pk_add_f32 v[160:161], v[160:161], v[32:33]
v_pk_add_f32 v[162:163], v[162:163], v[34:35]
s_waitcnt lgkmcnt(11)
v_pk_add_f32 v[176:177], v[176:177], v[48:49]
v_pk_add_f32 v[178:179], v[178:179], v[50:51]
v_pk_mul_f32 v[160:161], v[160:161], v[8:9] op_sel:[0,0] op_sel_hi:[1,0]
v_pk_mul_f32 v[162:163], v[162:163], v[8:9] op_sel:[0,0] op_sel_hi:[1,0]
v_pk_mul_f32 v[176:177], v[176:177], v[8:9] op_sel:[0,0] op_sel_hi:[1,0]
v_pk_mul_f32 v[178:179], v[178:179], v[8:9] op_sel:[0,0] op_sel_hi:[1,0]
v_cvt_pk_bf16_f32 v160, v160, v161
v_cvt_pk_bf16_f32 v161, v162, v163
v_cvt_pk_bf16_f32 v162, v176, v177
v_cvt_pk_bf16_f32 v163, v178, v179
v_pk_add_f32 v[164:165], v[164:165], v[36:37]
v_pk_add_f32 v[166:167], v[166:167], v[38:39]
s_waitcnt lgkmcnt(10)
v_pk_add_f32 v[180:181], v[180:181], v[52:53]
v_pk_add_f32 v[182:183], v[182:183], v[54:55]
M v[24:27], a[48:51], v[160:163], 0
v_pk_mul_f32 v[164:165], v[164:165], v[8:9] op_sel:[0,1] op_sel_hi:[1,1]
v_pk_mul_f32 v[166:167], v[166:167], v[8:9] op_sel:[0,1] op_sel_hi:[1,1]
v_pk_mul_f32 v[180:181], v[180:181], v[8:9] op_sel:[0,1] op_sel_hi:[1,1]
v_pk_mul_f32 v[182:183], v[182:183], v[8:9] op_sel:[0,1] op_sel_hi:[1,1]
v_cvt_pk_bf16_f32 v164, v164, v165
v_cvt_pk_bf16_f32 v165, v166, v167
v_cvt_pk_bf16_f32 v166, v180, v181
v_cvt_pk_bf16_f32 v167, v182, v183
v_pk_add_f32 v[168:169], v[168:169], v[40:41]
v_pk_add_f32 v[170:171], v[170:171], v[42:43]
s_waitcnt lgkmcnt(9)
v_pk_add_f32 v[184:185], v[184:185], v[56:57]
v_pk_add_f32 v[186:187], v[186:187], v[58:59]
M v[24:27], a[48:51], v[164:167], v[24:27]
v_pk_mul_f32 v[168:169], v[168:169], v[10:11] op_sel:[0,0] op_sel_hi:[1,0]
v_pk_mul_f32 v[170:171], v[170:171], v[10:11] op_sel:[0,0] op_sel_hi:[1,0]
v_pk_mul_f32 v[184:185], v[184:185], v[10:11] op_sel:[0,0] op_sel_hi:[1,0]
v_pk_mul_f32 v[186:187], v[186:187], v[10:11] op_sel:[0,0] op_sel_hi:[1,0]
v_cvt_pk_bf16_f32 v168, v168, v169
v_cvt_pk_bf16_f32 v169, v170, v171
v_cvt_pk_bf16_f32 v170, v184, v185
v_cvt_pk_bf16_f32 v171, v186, v187
v_pk_add_f32 v[172:173], v[172:173], v[44:45]
v_pk_add_f32 v[174:175], v[174:175], v[46:47]
s_waitcnt lgkmcnt(8)
v_pk_add_f32 v[188:189], v[188:189], v[60:61]
v_pk_add_f32 v[190:191], v[190:191], v[62:63]
M v[24:27], a[48:51], v[168:171], v[24:27]
v_pk_mul_f32 v[172:173], v[172:173], v[10:11] op_sel:[0,1] op_sel_hi:[1,1]
v_pk_mul_f32 v[174:175], v[174:175], v[10:11] op_sel:[0,1] op_sel_hi:[1,1]
v_pk_mul_f32 v[188:189], v[188:189], v[10:11] op_sel:[0,1] op_sel_hi:[1,1]
v_pk_mul_f32 v[190:191], v[190:191], v[10:11] op_sel:[0,1] op_sel_hi:[1,1]
v_cvt_pk_bf16_f32 v172, v172, v173
v_cvt_pk_bf16_f32 v173, v174, v175
v_cvt_pk_bf16_f32 v174, v188, v189
v_cvt_pk_bf16_f32 v175, v190, v191
s_waitcnt lgkmcnt(7)
v_pk_add_f32 v[192:193], v[192:193], v[64:65]
v_pk_add_f32 v[194:195], v[194:195], v[66:67]
s_waitcnt lgkmcnt(3)
v_pk_add_f32 v[208:209], v[208:209], v[80:81]
v_pk_add_f32 v[210:211], v[210:211], v[82:83]
M v[24:27], a[48:51], v[172:175], v[24:27]
v_pk_mul_f32 v[192:193], v[192:193], v[8:9] op_sel:[0,0] op_sel_hi:[1,0]
v_pk_mul_f32 v[194:195], v[194:195], v[8:9] op_sel:[0,0] op_sel_hi:[1,0]
v_pk_mul_f32 v[208:209], v[208:209], v[8:9] op_sel:[0,0] op_sel_hi:[1,0]
v_pk_mul_f32 v[210:211], v[210:211], v[8:9] op_sel:[0,0] op_sel_hi:[1,0]
v_cvt_pk_bf16_f32 v192, v192, v193
v_cvt_pk_bf16_f32 v193, v194, v195
v_cvt_pk_bf16_f32 v194, v208, v209
v_cvt_pk_bf16_f32 v195, v210, v211
v_pk_add_f32 v[196:197], v[196:197], v[68:69]
v_pk_add_f32 v[198:199], v[198:199], v[70:71]
s_waitcnt lgkmcnt(2)
v_pk_add_f32 v[212:213], v[212:213], v[84:85]
v_pk_add_f32 v[214:215], v[214:215], v[86:87]
M v[24:27], a[48:51], v[192:195], v[24:27]
v_pk_mul_f32 v[196:197], v[196:197], v[8:9] op_sel:[0,1] op_sel_hi:[1,1]
v_pk_mul_f32 v[198:199], v[198:199], v[8:9] op_sel:[0,1] op_sel_hi:[1,1]
v_pk_mul_f32 v[212:213], v[212:213], v[8:9] op_sel:[0,1] op_sel_hi:[1,1]
v_pk_mul_f32 v[214:215], v[214:215], v[8:9] op_sel:[0,1] op_sel_hi:[1,1]
v_cvt_pk_bf16_f32 v196, v196, v197
v_cvt_pk_bf16_f32 v197, v198, v199
v_cvt_pk_bf16_f32 v198, v212, v213
v_cvt_pk_bf16_f32 v199, v214, v215
v_pk_add_f32 v[200:201], v[200:201], v[72:73]
v_pk_add_f32 v[202:203], v[202:203], v[74:75]
s_waitcnt lgkmcnt(1)
v_pk_add_f32 v[216:217], v[216:217], v[88:89]
v_pk_add_f32 v[218:219], v[218:219], v[90:91]
M v[24:27], a[48:51], v[196:199], v[24:27]
v_pk_mul_f32 v[200:201], v[200:201], v[10:11] op_sel:[0,0] op_sel_hi:[1,0]
v_pk_mul_f32 v[202:203], v[202:203], v[10:11] op_sel:[0,0] op_sel_hi:[1,0]
v_pk_mul_f32 v[216:217], v[216:217], v[10:11] op_sel:[0,0] op_sel_hi:[1,0]
v_pk_mul_f32 v[218:219], v[218:219], v[10:11] op_sel:[0,0] op_sel_hi:[1,0]
v_cvt_pk_bf16_f32 v200, v200, v201
v_cvt_pk_bf16_f32 v201, v202, v203
v_cvt_pk_bf16_f32 v202, v216, v217
v_cvt_pk_bf16_f32 v203, v218, v219
v_pk_add_f32 v[204:205], v[204:205], v[76:77]
v_pk_add_f32 v[206:207], v[206:207], v[78:79]
s_waitcnt lgkmcnt(0)
v_pk_add_f32 v[220:221], v[220:221], v[92:93]
v_pk_add_f32 v[222:223], v[222:223], v[94:95]
M v[24:27], a[48:51], v[200:203], v[24:27]
v_pk_mul_f32 v[204:205], v[204:205], v[10:11] op_sel:[0,1] op_sel_hi:[1,1]
v_pk_mul_f32 v[206:207], v[206:207], v[10:11] op_sel:[0,1] op_sel_hi:[1,1]
v_pk_mul_f32 v[220:221], v[220:221], v[10:11] op_sel:[0,1] op_sel_hi:[1,1]
v_pk_mul_f32 v[222:223], v[222:223], v[10:11] op_sel:[0,1] op_sel_hi:[1,1]
v_cvt_pk_bf16_f32 v204, v204, v205
v_cvt_pk_bf16_f32 v205, v206, v207
v_cvt_pk_bf16_f32 v206, v220, v221
v_cvt_pk_bf16_f32 v207, v222, v223
s_nop 1
M v[24:27], a[48:51], v[204:207], v[24:27]
v_cmp_lt_u32 vcc, 0x3c000000, v12
s_nop 6
v_cmp_class_f32 s[40:41], v24, s64
s_nop 0
s_or_b64 vcc, vcc, s[40:41]
s_cbranch_vccnz Lbad_3
s_lshl_b32 s33, s35, 20
s_lshl_b32 s34, s20, 15
s_add_u32 s33, s33, s34
s_lshl_b32 s34, s23, 13
s_add_u32 s36, s33, s34
s_add_u32 s37, s36, 4096
s_add_u32 s38, s36, 16384
s_add_u32 s39, s36, 20480
buffer_store_dwordx4 v[160:163], v1, s[16:19], s36 offen offset:0 sc1
buffer_store_dwordx4 v[164:167], v1, s[16:19], s36 offen offset:2048 sc1
buffer_store_dwordx4 v[168:171], v1, s[16:19], s37 offen offset:0 sc1
buffer_store_dwordx4 v[172:175], v1, s[16:19], s37 offen offset:2048 sc1
buffer_store_dwordx4 v[192:195], v1, s[16:19], s36 offen offset:1024 sc1
buffer_store_dwordx4 v[196:199], v1, s[16:19], s36 offen offset:3072 sc1
buffer_store_dwordx4 v[200:203], v1, s[16:19], s37 offen offset:1024 sc1
buffer_store_dwordx4 v[204:207], v1, s[16:19], s37 offen offset:3072 sc1
s_branch Lfd_4
Lbad_3:
s_or_b32 s60, s60, 2
Lfd_4:
s_branch Lk2_chk
Lk2_mg1:
ds_write_b128 v2, v[160:163] offset:0
ds_write_b128 v2, v[164:167] offset:1024
ds_write_b128 v2, v[168:171] offset:2048
ds_write_b128 v2, v[172:175] offset:3072
ds_write_b128 v2, v[176:179] offset:4096
ds_write_b128 v2, v[180:183] offset:5120
ds_write_b128 v2, v[184:187] offset:6144
ds_write_b128 v2, v[188:191] offset:7168
ds_write_b128 v2, v[192:195] offset:8192
ds_write_b128 v2, v[196:199] offset:9216
ds_write_b128 v2, v[200:203] offset:10240
ds_write_b128 v2, v[204:207] offset:11264
ds_write_b128 v2, v[208:211] offset:12288
ds_write_b128 v2, v[212:215] offset:13312
ds_write_b128 v2, v[216:219] offset:14336
ds_write_b128 v2, v[220:223] offset:15360
s_waitcnt vmcnt(0) lgkmcnt(0)
s_barrier
ds_read_b128 v[28:31], v15
ds_read_b128 v[32:35], v3 offset:0
ds_read_b128 v[36:39], v3 offset:1024
ds_read_b128 v[40:43], v3 offset:2048
ds_read_b128 v[44:47], v3 offset:3072
ds_read_b128 v[48:51], v3 offset:4096
ds_read_b128 v[52:55], v3 offset:5120
ds_read_b128 v[56:59], v3 offset:6144
ds_read_b128 v[60:63], v3 offset:7168
ds_read_b128 v[64:67], v3 offset:8192
ds_read_b128 v[68:71], v3 offset:9216
ds_read_b128 v[72:75], v3 offset:10240
ds_read_b128 v[76:79], v3 offset:11264
ds_read_b128 v[80:83], v3 offset:12288
ds_read_b128 v[84:87], v3 offset:13312
ds_read_b128 v[88:91], v3 offset:14336
ds_read_b128 v[92:95], v3 offset:15360
s_mov_b32 s61, 0
v_cmp_ne_u32 vcc, 1, v7
s_nop 0
s_cbranch_vccnz Lk3_spinb1
Lk3_gotb1:
s_bfe_u32 s3, s2, 0x10002
s_lshl_b32 s3, s3, 3
s_lshr_b32 s28, s2, 5
s_add_u32 s28, s3, s28
s_lshl_b32 s25, s27, 18
s_lshl_b32 s3, s101, 12
s_add_u32 s25, s25, s3
s_lshl_b32 s26, s28, 7
s_lshl_b32 s42, s101, 11
s_add_u32 s44, s4, 83886080
s_addc_u32 s45, s5, 0
s_mov_b32 s46, 4194304
s_mov_b32 s47, 0x00020000
s_mov_b32 s50, 2097152
s_mov_b32 s51, 0x00020000
s_lshl_b32 s3, s101, 4
v_lshrrev_b32 v96, 3, v0
v_and_b32 v97, 6, v96
v_and_b32 v98, 7, v0
v_xor_b32 v97, v97, v98
v_add_u32 v96, s3, v96
v_lshlrev_b32 v96, 11, v96
v_lshl_add_u32 v99, v97, 4, v96
v_add_u32 v100, 15360, v99
s_add_u32 m0, s42, 65536
s_nop 0
buffer_load_dwordx4 v99, s[48:51], s26 offen offset:0 lds
buffer_load_dwordx4 v100, s[48:51], s26 offen offset:1024 lds
buffer_load_dwordx4 a[192:195], v1, s[44:47], s25 offen offset:0 sc1
buffer_load_dwordx4 a[196:199], v1, s[44:47], s25 offen offset:1024 sc1
buffer_load_dwordx4 a[200:203], v1, s[44:47], s25 offen offset:2048 sc1
buffer_load_dwordx4 a[204:207], v1, s[44:47], s25 offen offset:3072 sc1
s_add_u32 s25, s25, 16384
s_add_u32 s26, s26, 131072
s_add_u32 m0, s42, 81920
s_nop 0
buffer_load_dwordx4 v99, s[48:51], s26 offen offset:0 lds
buffer_load_dwordx4 v100, s[48:51], s26 offen offset:1024 lds
buffer_load_dwordx4 a[208:211], v1, s[44:47], s25 offen offset:0 sc1
buffer_load_dwordx4 a[212:215], v1, s[44:47], s25 offen offset:1024 sc1
buffer_load_dwordx4 a[216:219], v1, s[44:47], s25 offen offset:2048 sc1
buffer_load_dwordx4 a[220:223], v1, s[44:47], s25 offen offset:3072 sc1
s_add_u32 s25, s25, 16384
s_add_u32 s26, s26, 131072
s_add_u32 m0, s42, 98304
s_nop 0
buffer_load_dwordx4 v99, s[48:51], s26 offen offset:0 lds
buffer_load_dwordx4 v100, s[48:51], s26 offen offset:1024 lds
buffer_load_dwordx4 a[224:227], v1, s[44:47], s25 offen offset:0 sc1
buffer_load_dwordx4 a[228:231], v1, s[44:47], s25 offen offset:1024 sc1
buffer_load_dwordx4 a[232:235], v1, s[44:47], s25 offen offset:2048 sc1
buffer_load_dwordx4 a[236:239], v1, s[44:47], s25 offen offset:3072 sc1
s_add_u32 s25, s25, 16384
s_add_u32 s26, s26, 131072
s_add_u32 m0, s42, 114688
s_nop 0
buffer_load_dwordx4 v99, s[48:51], s26 offen offset:0 lds
buffer_load_dwordx4 v100, s[48:51], s26 offen offset:1024 lds
buffer_load_dwordx4 a[240:243], v1, s[44:47], s25 offen offset:0 sc1
buffer_load_dwordx4 a[244:247], v1, s[44:47], s25 offen offset:1024 sc1
buffer_load_dwordx4 a[248:251], v1, s[44:47], s25 offen offset:2048 sc1
buffer_load_dwordx4 a[252:255], v1, s[44:47], s25 offen offset:3072 sc1
s_add_u32 s25, s25, 16384
s_add_u32 s26, s26, 131072
s_add_u32 m0, s42, 0
s_nop 0
buffer_load_dwordx4 v99, s[48:51], s26 offen offset:0 lds
buffer_load_dwordx4 v100, s[48:51], s26 offen offset:1024 lds
buffer_load_dwordx4 a[128:131], v1, s[44:47], s25 offen offset:0 sc1
buffer_load_dwordx4 a[132:135], v1, s[44:47], s25 offen offset:1024 sc1
buffer_load_dwordx4 a[136:139], v1, s[44:47], s25 offen offset:2048 sc1
buffer_load_dwordx4 a[140:143], v1, s[44:47], s25 offen offset:3072 sc1
s_add_u32 s25, s25, 16384
s_add_u32 s26, s26, 131072
s_waitcnt lgkmcnt(15)
v_add_f32 v20, v20, v28
v_add_f32 v21, v21, v29
v_add_f32 v22, v22, v30
v_add_f32 v23, v23, v31
s_sub_u32 s35, 15, s21
v_rcp_f32 v8, v20
v_rcp_f32 v9, v21
v_rcp_f32 v10, v22
v_rcp_f32 v11, v23
v_subrev_u32 v20, 0x21800000, v20
v_subrev_u32 v21, 0x21800000, v21
v_subrev_u32 v22, 0x21800000, v22
v_subrev_u32 v23, 0x21800000, v23
v_max_u32 v12, v20, v21
v_max3_u32 v12, v12, v22, v23
s_mov_b32 s64, 0x207
v_pk_add_f32 v[224:225], v[224:225], v[32:33]
v_pk_add_f32 v[226:227], v[226:227], v[34:35]
s_waitcnt lgkmcnt(11)
v_pk_add_f32 v[240:241], v[240:241], v[48:49]
v_pk_add_f32 v[242:243], v[242:243], v[50:51]
v_pk_mul_f32 v[224:225], v[224:225], v[8:9] op_sel:[0,0] op_sel_hi:[1,0]
v_pk_mul_f32 v[226:227], v[226:227], v[8:9] op_sel:[0,0] op_sel_hi:[1,0]
v_pk_mul_f32 v[240:241], v[240:241], v[8:9] op_sel:[0,0] op_sel_hi:[1,0]
v_pk_mul_f32 v[242:243], v[242:243], v[8:9] op_sel:[0,0] op_sel_hi:[1,0]
v_cvt_pk_bf16_f32 v224, v224, v225
v_cvt_pk_bf16_f32 v225, v226, v227
v_cvt_pk_bf16_f32 v226, v240, v241
v_cvt_pk_bf16_f32 v227, v242, v243
v_pk_add_f32 v[228:229], v[228:229], v[36:37]
v_pk_add_f32 v[230:231], v[230:231], v[38:39]
s_waitcnt lgkmcnt(10)
v_pk_add_f32 v[244:245], v[244:245], v[52:53]
v_pk_add_f32 v[246:247], v[246:247], v[54:55]
M v[24:27], a[48:51], v[224:227], 0
v_pk_mul_f32 v[228:229], v[228:229], v[8:9] op_sel:[0,1] op_sel_hi:[1,1]
v_pk_mul_f32 v[230:231], v[230:231], v[8:9] op_sel:[0,1] op_sel_hi:[1,1]
v_pk_mul_f32 v[244:245], v[244:245], v[8:9] op_sel:[0,1] op_sel_hi:[1,1]
v_pk_mul_f32 v[246:247], v[246:247], v[8:9] op_sel:[0,1] op_sel_hi:[1,1]
v_cvt_pk_bf16_f32 v228, v228, v229
v_cvt_pk_bf16_f32 v229, v230, v231
v_cvt_pk_bf16_f32 v230, v244, v245
v_cvt_pk_bf16_f32 v231, v246, v247
v_pk_add_f32 v[232:233], v[232:233], v[40:41]
v_pk_add_f32 v[234:235], v[234:235], v[42:43]
s_waitcnt lgkmcnt(9)
v_pk_add_f32 v[248:249], v[248:249], v[56:57]
v_pk_add_f32 v[250:251], v[250:251], v[58:59]
M v[24:27], a[48:51], v[228:231], v[24:27]
v_pk_mul_f32 v[232:233], v[232:233], v[10:11] op_sel:[0,0] op_sel_hi:[1,0]
v_pk_mul_f32 v[234:235], v[234:235], v[10:11] op_sel:[0,0] op_sel_hi:[1,0]
v_pk_mul_f32 v[248:249], v[248:249], v[10:11] op_sel:[0,0] op_sel_hi:[1,0]
v_pk_mul_f32 v[250:251], v[250:251], v[10:11] op_sel:[0,0] op_sel_hi:[1,0]
v_cvt_pk_bf16_f32 v232, v232, v233
v_cvt_pk_bf16_f32 v233, v234, v235
v_cvt_pk_bf16_f32 v234, v248, v249
v_cvt_pk_bf16_f32 v235, v250, v251
v_pk_add_f32 v[236:237], v[236:237], v[44:45]
v_pk_add_f32 v[238:239], v[238:239], v[46:47]
s_waitcnt lgkmcnt(8)
v_pk_add_f32 v[252:253], v[252:253], v[60:61]
v_pk_add_f32 v[254:255], v[254:255], v[62:63]
M v[24:27], a[48:51], v[232:235], v[24:27]
v_pk_mul_f32 v[236:237], v[236:237], v[10:11] op_sel:[0,1] op_sel_hi:[1,1]
v_pk_mul_f32 v[238:239], v[238:239], v[10:11] op_sel:[0,1] op_sel_hi:[1,1]
v_pk_mul_f32 v[252:253], v[252:253], v[10:11] op_sel:[0,1] op_sel_hi:[1,1]
v_pk_mul_f32 v[254:255], v[254:255], v[10:11] op_sel:[0,1] op_sel_hi:[1,1]
v_cvt_pk_bf16_f32 v236, v236, v237
v_cvt_pk_bf16_f32 v237, v238, v239
v_cvt_pk_bf16_f32 v238, v252, v253
v_cvt_pk_bf16_f32 v239, v254, v255
v_accvgpr_read_b32 v32, a0
v_accvgpr_read_b32 v33, a1
v_accvgpr_read_b32 v34, a2
v_accvgpr_read_b32 v35, a3
s_waitcnt lgkmcnt(7)
v_pk_add_f32 v[32:33], v[32:33], v[64:65]
v_pk_add_f32 v[34:35], v[34:35], v[66:67]
v_accvgpr_read_b32 v48, a16
v_accvgpr_read_b32 v49, a17
v_accvgpr_read_b32 v50, a18
v_accvgpr_read_b32 v51, a19
s_waitcnt lgkmcnt(3)
v_pk_add_f32 v[48:49], v[48:49], v[80:81]
v_pk_add_f32 v[50:51], v[50:51], v[82:83]
M v[24:27], a[48:51], v[236:239], v[24:27]
v_pk_mul_f32 v[32:33], v[32:33], v[8:9] op_sel:[0,0] op_sel_hi:[1,0]
v_pk_mul_f32 v[34:35], v[34:35], v[8:9] op_sel:[0,0] op_sel_hi:[1,0]
v_pk_mul_f32 v[48:49], v[48:49], v[8:9] op_sel:[0,0] op_sel_hi:[1,0]
v_pk_mul_f32 v[50:51], v[50:51], v[8:9] op_sel:[0,0] op_sel_hi:[1,0]
v_cvt_pk_bf16_f32 v32, v32, v33
v_cvt_pk_bf16_f32 v33, v34, v35
v_cvt_pk_bf16_f32 v34, v48, v49
v_cvt_pk_bf16_f32 v35, v50, v51
v_accvgpr_read_b32 v240, a4
v_accvgpr_read_b32 v241, a5
v_accvgpr_read_b32 v242, a6
v_accvgpr_read_b32 v243, a7
v_pk_add_f32 v[240:241], v[240:241], v[68:69]
v_pk_add_f32 v[242:243], v[242:243], v[70:71]
v_accvgpr_read_b32 v36, a20
v_accvgpr_read_b32 v37, a21
v_accvgpr_read_b32 v38, a22
v_accvgpr_read_b32 v39, a23
s_waitcnt lgkmcnt(2)
v_pk_add_f32 v[36:37], v[36:37], v[84:85]
v_pk_add_f32 v[38:39], v[38:39], v[86:87]
M v[24:27], a[48:51], v[32:35], v[24:27]
v_pk_mul_f32 v[240:241], v[240:241], v[8:9] op_sel:[0,1] op_sel_hi:[1,1]
v_pk_mul_f32 v[242:243], v[242:243], v[8:9] op_sel:[0,1] op_sel_hi:[1,1]
v_pk_mul_f32 v[36:37], v[36:37], v[8:9] op_sel:[0,1] op_sel_hi:[1,1]
v_pk_mul_f32 v[38:39], v[38:39], v[8:9] op_sel:[0,1] op_sel_hi:[1,1]
v_cvt_pk_bf16_f32 v240, v240, v241
v_cvt_pk_bf16_f32 v241, v242, v243
v_cvt_pk_bf16_f32 v242, v36, v37
v_cvt_pk_bf16_f32 v243, v38, v39
v_accvgpr_read_b32 v52, a8
v_accvgpr_read_b32 v53, a9
v_accvgpr_read_b32 v54, a10
v_accvgpr_read_b32 v55, a11
v_pk_add_f32 v[52:53], v[52:53], v[72:73]
v_pk_add_f32 v[54:55], v[54:55], v[74:75]
v_accvgpr_read_b32 v244, a24
v_accvgpr_read_b32 v245, a25
v_accvgpr_read_b32 v246, a26
v_accvgpr_read_b32 v247, a27
s_waitcnt lgkmcnt(1)
v_pk_add_f32 v[244:245], v[244:245], v[88:89]
v_pk_add_f32 v[246:247], v[246:247], v[90:91]
M v[24:27], a[48:51], v[240:243], v[24:27]
v_pk_mul_f32 v[52:53], v[52:53], v[10:11] op_sel:[0,0] op_sel_hi:[1,0]
v_pk_mul_f32 v[54:55], v[54:55], v[10:11] op_sel:[0,0] op_sel_hi:[1,0]
v_pk_mul_f32 v[244:245], v[244:245], v[10:11] op_sel:[0,0] op_sel_hi:[1,0]
v_pk_mul_f32 v[246:247], v[246:247], v[10:11] op_sel:[0,0] op_sel_hi:[1,0]
v_cvt_pk_bf16_f32 v52, v52, v53
v_cvt_pk_bf16_f32 v53, v54, v55
v_cvt_pk_bf16_f32 v54, v244, v245
v_cvt_pk_bf16_f32 v55, v246, v247
v_accvgpr_read_b32 v40, a12
v_accvgpr_read_b32 v41, a13
v_accvgpr_read_b32 v42, a14
v_accvgpr_read_b32 v43, a15
v_pk_add_f32 v[40:41], v[40:41], v[76:77]
v_pk_add_f32 v[42:43], v[42:43], v[78:79]
v_accvgpr_read_b32 v56, a28
v_accvgpr_read_b32 v57, a29
v_accvgpr_read_b32 v58, a30
v_accvgpr_read_b32 v59, a31
s_waitcnt lgkmcnt(0)
v_pk_add_f32 v[56:57], v[56:57], v[92:93]
v_pk_add_f32 v[58:59], v[58:59], v[94:95]
M v[24:27], a[48:51], v[52:55], v[24:27]
v_pk_mul_f32 v[40:41], v[40:41], v[10:11] op_sel:[0,1] op_sel_hi:[1,1]
v_pk_mul_f32 v[42:43], v[42:43], v[10:11] op_sel:[0,1] op_sel_hi:[1,1]
v_pk_mul_f32 v[56:57], v[56:57], v[10:11] op_sel:[0,1] op_sel_hi:[1,1]
v_pk_mul_f32 v[58:59], v[58:59], v[10:11] op_sel:[0,1] op_sel_hi:[1,1]
v_cvt_pk_bf16_f32 v40, v40, v41
v_cvt_pk_bf16_f32 v41, v42, v43
v_cvt_pk_bf16_f32 v42, v56, v57
v_cvt_pk_bf16_f32 v43, v58, v59
s_nop 1
M v[24:27], a[48:51], v[40:43], v[24:27]
v_cmp_lt_u32 vcc, 0x3c000000, v12
s_nop 6
v_cmp_class_f32 s[40:41], v24, s64
s_nop 0
s_or_b64 vcc, vcc, s[40:41]
s_cbranch_vccnz Lbad_5
s_lshl_b32 s33, s35, 20
s_lshl_b32 s34, s20, 15
s_add_u32 s33, s33, s34
s_lshl_b32 s34, s23, 13
s_add_u32 s36, s33, s34
s_add_u32 s37, s36, 4096
s_add_u32 s38, s36, 16384
s_add_u32 s39, s36, 20480
buffer_store_dwordx4 v[224:227], v1, s[16:19], s38 offen offset:0 sc1
buffer_store_dwordx4 v[228:231], v1, s[16:19], s38 offen offset:2048 sc1
buffer_store_dwordx4 v[232:235], v1, s[16:19], s39 offen offset:0 sc1
buffer_store_dwordx4 v[236:239], v1, s[16:19], s39 offen offset:2048 sc1
buffer_store_dwordx4 v[32:35], v1, s[16:19], s38 offen offset:1024 sc1
buffer_store_dwordx4 v[240:243], v1, s[16:19], s38 offen offset:3072 sc1
buffer_store_dwordx4 v[52:55], v1, s[16:19], s39 offen offset:1024 sc1
buffer_store_dwordx4 v[40:43], v1, s[16:19], s39 offen offset:3072 sc1
s_branch Lfd_6
Lbad_5:
s_or_b32 s60, s60, 2
Lfd_6:
Lk2_chk:
s_cmp_eq_u32 s60, 0
s_cbranch_scc1 Lk2_done
s_sub_u32 s56, 15, s21
s_lshl_b32 s33, s24, 1
s_lshl_b32 s61, 3, s33
s_and_b32 s34, s60, 2
s_bitcmp1_b32 s60, 0
s_cselect_b32 s56, s21, s56
s_cselect_b32 s61, 15, s61
s_cselect_b32 s60, s34, 0
s_waitcnt vmcnt(0)
s_lshl_b32 s33, s20, 7
s_lshl_b32 s34, s56, 3
s_add_u32 s33, s33, s34
s_lshl_b32 s34, s23, 2
s_add_u32 s33, s33, s34
s_lshl_b32 s33, s33, 12
buffer_load_dwordx4 a[52:55], v1, s[8:11], s33 offen offset:0 sc1
buffer_load_dwordx4 a[56:59], v1, s[8:11], s33 offen offset:1024 sc1
buffer_load_dwordx4 a[60:63], v1, s[8:11], s33 offen offset:2048 sc1
buffer_load_dwordx4 a[64:67], v1, s[8:11], s33 offen offset:3072 sc1
s_add_u32 s33, s33, 4096
buffer_load_dwordx4 a[68:71], v1, s[8:11], s33 offen offset:0 sc1
buffer_load_dwordx4 a[72:75], v1, s[8:11], s33 offen offset:1024 sc1
buffer_load_dwordx4 a[76:79], v1, s[8:11], s33 offen offset:2048 sc1
buffer_load_dwordx4 a[80:83], v1, s[8:11], s33 offen offset:3072 sc1
s_add_u32 s33, s33, 4096
buffer_load_dwordx4 a[84:87], v1, s[8:11], s33 offen offset:0 sc1
buffer_load_dwordx4 a[88:91], v1, s[8:11], s33 offen offset:1024 sc1
buffer_load_dwordx4 a[92:95], v1, s[8:11], s33 offen offset:2048 sc1
buffer_load_dwordx4 a[96:99], v1, s[8:11], s33 offen offset:3072 sc1
s_add_u32 s33, s33, 4096
buffer_load_dwordx4 a[100:103], v1, s[8:11], s33 offen offset:0 sc1
buffer_load_dwordx4 a[104:107], v1, s[8:11], s33 offen offset:1024 sc1
buffer_load_dwordx4 a[108:111], v1, s[8:11], s33 offen offset:2048 sc1
buffer_load_dwordx4 a[112:115], v1, s[8:11], s33 offen offset:3072 sc1
v_accvgpr_write_b32 a0, 0
v_accvgpr_write_b32 a1, 0
v_accvgpr_write_b32 a2, 0
v_accvgpr_write_b32 a3, 0
v_accvgpr_write_b32 a4, 0
v_accvgpr_write_b32 a5, 0
v_accvgpr_write_b32 a6, 0
v_accvgpr_write_b32 a7, 0
v_accvgpr_write_b32 a8, 0
v_accvgpr_write_b32 a9, 0
v_accvgpr_write_b32 a10, 0
v_accvgpr_write_b32 a11, 0
v_accvgpr_write_b32 a12, 0
v_accvgpr_write_b32 a13, 0
v_accvgpr_write_b32 a14, 0
v_accvgpr_write_b32 a15, 0
v_accvgpr_write_b32 a16, 0
v_accvgpr_write_b32 a17, 0
v_accvgpr_write_b32 a18, 0
v_accvgpr_write_b32 a19, 0
v_accvgpr_write_b32 a20, 0
v_accvgpr_write_b32 a21, 0
v_accvgpr_write_b32 a22, 0
v_accvgpr_write_b32 a23, 0
v_accvgpr_write_b32 a24, 0
v_accvgpr_write_b32 a25, 0
v_accvgpr_write_b32 a26, 0
v_accvgpr_write_b32 a27, 0
v_accvgpr_write_b32 a28, 0
v_accvgpr_write_b32 a29, 0
v_accvgpr_write_b32 a30, 0
v_accvgpr_write_b32 a31, 0
v_accvgpr_write_b32 a32, 0
v_accvgpr_write_b32 a33, 0
v_accvgpr_write_b32 a34, 0
v_accvgpr_write_b32 a35, 0
v_accvgpr_write_b32 a36, 0
v_accvgpr_write_b32 a37, 0
v_accvgpr_write_b32 a38, 0
v_accvgpr_write_b32 a39, 0
v_accvgpr_write_b32 a40, 0
v_accvgpr_write_b32 a41, 0
v_accvgpr_write_b32 a42, 0
v_accvgpr_write_b32 a43, 0
v_accvgpr_write_b32 a44, 0
v_accvgpr_write_b32 a45, 0
v_accvgpr_write_b32 a46, 0
v_accvgpr_write_b32 a47, 0
v_mov_b32 v160, 0
v_mov_b32 v161, 0
v_mov_b32 v162, 0
v_mov_b32 v163, 0
v_mov_b32 v164, 0
v_mov_b32 v165, 0
v_mov_b32 v166, 0
v_mov_b32 v167, 0
v_mov_b32 v168, 0
v_mov_b32 v169, 0
v_mov_b32 v170, 0
v_mov_b32 v171, 0
v_mov_b32 v172, 0
v_mov_b32 v173, 0
v_mov_b32 v174, 0
v_mov_b32 v175, 0
v_mov_b32 v176, 0
v_mov_b32 v177, 0
v_mov_b32 v178, 0
v_mov_b32 v179, 0
v_mov_b32 v180, 0
v_mov_b32 v181, 0
v_mov_b32 v182, 0
v_mov_b32 v183, 0
v_mov_b32 v184, 0
v_mov_b32 v185, 0
v_mov_b32 v186, 0
v_mov_b32 v187, 0
v_mov_b32 v188, 0
v_mov_b32 v189, 0
v_mov_b32 v190, 0
v_mov_b32 v191, 0
v_mov_b32 v192, 0
v_mov_b32 v193, 0
v_mov_b32 v194, 0
v_mov_b32 v195, 0
v_mov_b32 v196, 0
v_mov_b32 v197, 0
v_mov_b32 v198, 0
v_mov_b32 v199, 0
v_mov_b32 v200, 0
v_mov_b32 v201, 0
v_mov_b32 v202, 0
v_mov_b32 v203, 0
v_mov_b32 v204, 0
v_mov_b32 v205, 0
v_mov_b32 v206, 0
v_mov_b32 v207, 0
v_mov_b32 v208, 0
v_mov_b32 v209, 0
v_mov_b32 v210, 0
v_mov_b32 v211, 0
v_mov_b32 v212, 0
v_mov_b32 v213, 0
v_mov_b32 v214, 0
v_mov_b32 v215, 0
v_mov_b32 v216, 0
v_mov_b32 v217, 0
v_mov_b32 v218, 0
v_mov_b32 v219, 0
v_mov_b32 v220, 0
v_mov_b32 v221, 0
v_mov_b32 v222, 0
v_mov_b32 v223, 0
v_mov_b32 v224, 0
v_mov_b32 v225, 0
v_mov_b32 v226, 0
v_mov_b32 v227, 0
v_mov_b32 v228, 0
v_mov_b32 v229, 0
v_mov_b32 v230, 0
v_mov_b32 v231, 0
v_mov_b32 v232, 0
v_mov_b32 v233, 0
v_mov_b32 v234, 0
v_mov_b32 v235, 0
v_mov_b32 v236, 0
v_mov_b32 v237, 0
v_mov_b32 v238, 0
v_mov_b32 v239, 0
v_mov_b32 v240, 0
v_mov_b32 v241, 0
v_mov_b32 v242, 0
v_mov_b32 v243, 0
v_mov_b32 v244, 0
v_mov_b32 v245, 0
v_mov_b32 v246, 0
v_mov_b32 v247, 0
v_mov_b32 v248, 0
v_mov_b32 v249, 0
v_mov_b32 v250, 0
v_mov_b32 v251, 0
v_mov_b32 v252, 0
v_mov_b32 v253, 0
v_mov_b32 v254, 0
v_mov_b32 v255, 0
v_mov_b32 v8, v4
v_mov_b32 v9, v4
v_mov_b32 v10, v4
v_mov_b32 v11, v4
s_lshl_b32 s57, s20, 20
s_lshl_b32 s58, s56, 7
s_lshl_b32 s59, s56, 1
s_add_u32 s59, s59, 2
Lslow_7:
s_add_u32 s35, s57, 0
buffer_load_dwordx4 v[96:99], v1, s[12:15], s35 offen offset:0 sc1
buffer_load_dwordx4 v[100:103], v1, s[12:15], s35 offen offset:1024 sc1
buffer_load_dwordx4 v[104:107], v1, s[12:15], s35 offen offset:2048 sc1
buffer_load_dwordx4 v[108:111], v1, s[12:15], s35 offen offset:3072 sc1
s_add_u32 s35, s57, 4096
buffer_load_dwordx4 v[112:115], v1, s[12:15], s35 offen offset:0 sc1
buffer_load_dwordx4 v[116:119], v1, s[12:15], s35 offen offset:1024 sc1
buffer_load_dwordx4 v[120:123], v1, s[12:15], s35 offen offset:2048 sc1
buffer_load_dwordx4 v[124:127], v1, s[12:15], s35 offen offset:3072 sc1
s_add_u32 s35, s57, 8192
buffer_load_dwordx4 v[128:131], v1, s[12:15], s35 offen offset:0 sc1
buffer_load_dwordx4 v[132:135], v1, s[12:15], s35 offen offset:1024 sc1
buffer_load_dwordx4 v[136:139], v1, s[12:15], s35 offen offset:2048 sc1
buffer_load_dwordx4 v[140:143], v1, s[12:15], s35 offen offset:3072 sc1
s_add_u32 s35, s57, 12288
buffer_load_dwordx4 v[144:147], v1, s[12:15], s35 offen offset:0 sc1
buffer_load_dwordx4 v[148:151], v1, s[12:15], s35 offen offset:1024 sc1
buffer_load_dwordx4 v[152:155], v1, s[12:15], s35 offen offset:2048 sc1
buffer_load_dwordx4 v[156:159], v1, s[12:15], s35 offen offset:3072 sc1
s_lshl_b32 s33, s23, 6
s_add_i32 s33, s33, s58
s_cmp_gt_i32 s33, 0
s_cselect_b32 s34, 0, 0xf149f2ca
s_cmp_lt_i32 s33, 0
s_cselect_b32 s33, 0xf149f2ca, 0
v_mov_b32 v20, s34
v_mov_b32 v21, s34
v_mov_b32 v22, s34
v_mov_b32 v23, s34
v_mov_b32 v28, s33
v_mov_b32 v29, s33
v_mov_b32 v30, s33
v_mov_b32 v31, s33
v_med3_f32 v24, v16, v20, v28
v_med3_f32 v25, v17, v20, v28
v_med3_f32 v26, v18, v20, v28
v_med3_f32 v27, v19, v20, v28
s_waitcnt vmcnt(0)
s_nop 0
M v[32:35], v[96:99], a[52:55], v[24:27]
M v[32:35], v[100:103], a[56:59], v[32:35]
M v[32:35], v[104:107], a[60:63], v[32:35]
M v[32:35], v[108:111], a[64:67], v[32:35]
M v[36:39], v[96:99], a[68:71], v[28:31]
M v[36:39], v[100:103], a[72:75], v[36:39]
M v[36:39], v[104:107], a[76:79], v[36:39]
M v[36:39], v[108:111], a[80:83], v[36:39]
M v[40:43], v[96:99], a[84:87], v[28:31]
M v[40:43], v[100:103], a[88:91], v[40:43]
M v[40:43], v[104:107], a[92:95], v[40:43]
M v[40:43], v[108:111], a[96:99], v[40:43]
M v[44:47], v[96:99], a[100:103], v[28:31]
M v[44:47], v[100:103], a[104:107], v[44:47]
M v[44:47], v[104:107], a[108:111], v[44:47]
M v[44:47], v[108:111], a[112:115], v[44:47]
M v[48:51], v[112:115], a[52:55], v[20:23]
M v[48:51], v[116:119], a[56:59], v[48:51]
M v[48:51], v[120:123], a[60:63], v[48:51]
M v[48:51], v[124:127], a[64:67], v[48:51]
M v[52:55], v[112:115], a[68:71], v[24:27]
M v[52:55], v[116:119], a[72:75], v[52:55]
M v[52:55], v[120:123], a[76:79], v[52:55]
M v[52:55], v[124:127], a[80:83], v[52:55]
M v[56:59], v[112:115], a[84:87], v[28:31]
M v[56:59], v[116:119], a[88:91], v[56:59]
M v[56:59], v[120:123], a[92:95], v[56:59]
M v[56:59], v[124:127], a[96:99], v[56:59]
M v[60:63], v[112:115], a[100:103], v[28:31]
M v[60:63], v[116:119], a[104:107], v[60:63]
M v[60:63], v[120:123], a[108:111], v[60:63]
M v[60:63], v[124:127], a[112:115], v[60:63]
M v[64:67], v[128:131], a[52:55], v[20:23]
M v[64:67], v[132:135], a[56:59], v[64:67]
M v[64:67], v[136:139], a[60:63], v[64:67]
M v[64:67], v[140:143], a[64:67], v[64:67]
M v[68:71], v[128:131], a[68:71], v[20:23]
M v[68:71], v[132:135], a[72:75], v[68:71]
M v[68:71], v[136:139], a[76:79], v[68:71]
M v[68:71], v[140:143], a[80:83], v[68:71]
M v[72:75], v[128:131], a[84:87], v[24:27]
M v[72:75], v[132:135], a[88:91], v[72:75]
M v[72:75], v[136:139], a[92:95], v[72:75]
M v[72:75], v[140:143], a[96:99], v[72:75]
M v[76:79], v[128:131], a[100:103], v[28:31]
M v[76:79], v[132:135], a[104:107], v[76:79]
M v[76:79], v[136:139], a[108:111], v[76:79]
M v[76:79], v[140:143], a[112:115], v[76:79]
M v[80:83], v[144:147], a[52:55], v[20:23]
M v[80:83], v[148:151], a[56:59], v[80:83]
M v[80:83], v[152:155], a[60:63], v[80:83]
M v[80:83], v[156:159], a[64:67], v[80:83]
M v[84:87], v[144:147], a[68:71], v[20:23]
M v[84:87], v[148:151], a[72:75], v[84:87]
M v[84:87], v[152:155], a[76:79], v[84:87]
M v[84:87], v[156:159], a[80:83], v[84:87]
M v[88:91], v[144:147], a[84:87], v[20:23]
M v[88:91], v[148:151], a[88:91], v[88:91]
M v[88:91], v[152:155], a[92:95], v[88:91]
M v[88:91], v[156:159], a[96:99], v[88:91]
M v[92:95], v[144:147], a[100:103], v[24:27]
M v[92:95], v[148:151], a[104:107], v[92:95]
M v[92:95], v[152:155], a[108:111], v[92:95]
M v[92:95], v[156:159], a[112:115], v[92:95]
s_nop 7
s_add_u32 s35, s57, 16384
buffer_load_dwordx4 v[96:99], v1, s[12:15], s35 offen offset:0 sc1
buffer_load_dwordx4 v[100:103], v1, s[12:15], s35 offen offset:1024 sc1
buffer_load_dwordx4 v[104:107], v1, s[12:15], s35 offen offset:2048 sc1
buffer_load_dwordx4 v[108:111], v1, s[12:15], s35 offen offset:3072 sc1
s_add_u32 s35, s57, 20480
buffer_load_dwordx4 v[112:115], v1, s[12:15], s35 offen offset:0 sc1
buffer_load_dwordx4 v[116:119], v1, s[12:15], s35 offen offset:1024 sc1
buffer_load_dwordx4 v[120:123], v1, s[12:15], s35 offen offset:2048 sc1
buffer_load_dwordx4 v[124:127], v1, s[12:15], s35 offen offset:3072 sc1
s_add_u32 s35, s57, 24576
buffer_load_dwordx4 v[128:131], v1, s[12:15], s35 offen offset:0 sc1
buffer_load_dwordx4 v[132:135], v1, s[12:15], s35 offen offset:1024 sc1
buffer_load_dwordx4 v[136:139], v1, s[12:15], s35 offen offset:2048 sc1
buffer_load_dwordx4 v[140:143], v1, s[12:15], s35 offen offset:3072 sc1
s_add_u32 s35, s57, 28672
buffer_load_dwordx4 v[144:147], v1, s[12:15], s35 offen offset:0 sc1
buffer_load_dwordx4 v[148:151], v1, s[12:15], s35 offen offset:1024 sc1
buffer_load_dwordx4 v[152:155], v1, s[12:15], s35 offen offset:2048 sc1
buffer_load_dwordx4 v[156:159], v1, s[12:15], s35 offen offset:3072 sc1
v_max3_f32 v13, v32, v33, v8
v_max3_f32 v13, v13, v34, v35
v_max3_f32 v13, v13, v48, v49
v_max3_f32 v13, v13, v50, v51
v_max3_f32 v13, v13, v64, v65
v_max3_f32 v13, v13, v66, v67
v_max3_f32 v13, v13, v80, v81
v_max3_f32 v13, v13, v82, v83
v_mov_b32 v14, v13
s_nop 1
v_permlane16_swap_b32 v13, v14
v_max_f32 v13, v13, v14
v_mov_b32 v14, v13
s_nop 1
v_permlane32_swap_b32 v13, v14
v_max_f32 v13, v13, v14
v_sub_f32 v12, v8, v13
v_exp_f32 v12, v12
v_mov_b32 v8, v13
v_sub_f32 v32, v32, v13
v_sub_f32 v33, v33, v13
v_sub_f32 v34, v34, v13
v_sub_f32 v35, v35, v13
v_sub_f32 v48, v48, v13
v_sub_f32 v49, v49, v13
v_sub_f32 v50, v50, v13
v_sub_f32 v51, v51, v13
v_sub_f32 v64, v64, v13
v_sub_f32 v65, v65, v13
v_sub_f32 v66, v66, v13
v_sub_f32 v67, v67, v13
v_sub_f32 v80, v80, v13
v_sub_f32 v81, v81, v13
v_sub_f32 v82, v82, v13
v_sub_f32 v83, v83, v13
v_mul_f32 v160, v160, v12
v_mul_f32 v161, v161, v12
v_mul_f32 v162, v162, v12
v_mul_f32 v163, v163, v12
v_mul_f32 v176, v176, v12
v_mul_f32 v177, v177, v12
v_mul_f32 v178, v178, v12
v_mul_f32 v179, v179, v12
v_mul_f32 v192, v192, v12
v_mul_f32 v193, v193, v12
v_mul_f32 v194, v194, v12
v_mul_f32 v195, v195, v12
v_mul_f32 v208, v208, v12
v_mul_f32 v209, v209, v12
v_mul_f32 v210, v210, v12
v_mul_f32 v211, v211, v12
v_mul_f32 v224, v224, v12
v_mul_f32 v225, v225, v12
v_mul_f32 v226, v226, v12
v_mul_f32 v227, v227, v12
v_mul_f32 v240, v240, v12
v_mul_f32 v241, v241, v12
v_mul_f32 v242, v242, v12
v_mul_f32 v243, v243, v12
v_accvgpr_read_b32 v14, a0
v_mul_f32 v14, v14, v12
v_accvgpr_write_b32 a0, v14
v_accvgpr_read_b32 v14, a1
v_mul_f32 v14, v14, v12
v_accvgpr_write_b32 a1, v14
v_accvgpr_read_b32 v14, a2
v_mul_f32 v14, v14, v12
v_accvgpr_write_b32 a2, v14
v_accvgpr_read_b32 v14, a3
v_mul_f32 v14, v14, v12
v_accvgpr_write_b32 a3, v14
v_accvgpr_read_b32 v14, a16
v_mul_f32 v14, v14, v12
v_accvgpr_write_b32 a16, v14
v_accvgpr_read_b32 v14, a17
v_mul_f32 v14, v14, v12
v_accvgpr_write_b32 a17, v14
v_accvgpr_read_b32 v14, a18
v_mul_f32 v14, v14, v12
v_accvgpr_write_b32 a18, v14
v_accvgpr_read_b32 v14, a19
v_mul_f32 v14, v14, v12
v_accvgpr_write_b32 a19, v14
v_accvgpr_read_b32 v14, a32
v_mul_f32 v14, v14, v12
v_accvgpr_write_b32 a32, v14
v_accvgpr_read_b32 v14, a33
v_mul_f32 v14, v14, v12
v_accvgpr_write_b32 a33, v14
v_accvgpr_read_b32 v14, a34
v_mul_f32 v14, v14, v12
v_accvgpr_write_b32 a34, v14
v_accvgpr_read_b32 v14, a35
v_mul_f32 v14, v14, v12
v_accvgpr_write_b32 a35, v14
v_max3_f32 v13, v36, v37, v9
v_max3_f32 v13, v13, v38, v39
v_max3_f32 v13, v13, v52, v53
v_max3_f32 v13, v13, v54, v55
v_max3_f32 v13, v13, v68, v69
v_max3_f32 v13, v13, v70, v71
v_max3_f32 v13, v13, v84, v85
v_max3_f32 v13, v13, v86, v87
v_mov_b32 v14, v13
s_nop 1
v_permlane16_swap_b32 v13, v14
v_max_f32 v13, v13, v14
v_mov_b32 v14, v13
s_nop 1
v_permlane32_swap_b32 v13, v14
v_max_f32 v13, v13, v14
v_sub_f32 v12, v9, v13
v_exp_f32 v12, v12
v_mov_b32 v9, v13
v_sub_f32 v36, v36, v13
v_sub_f32 v37, v37, v13
v_sub_f32 v38, v38, v13
v_sub_f32 v39, v39, v13
v_sub_f32 v52, v52, v13
v_sub_f32 v53, v53, v13
v_sub_f32 v54, v54, v13
v_sub_f32 v55, v55, v13
v_sub_f32 v68, v68, v13
v_sub_f32 v69, v69, v13
v_sub_f32 v70, v70, v13
v_sub_f32 v71, v71, v13
v_sub_f32 v84, v84, v13
v_sub_f32 v85, v85, v13
v_sub_f32 v86, v86, v13
v_sub_f32 v87, v87, v13
v_mul_f32 v164, v164, v12
v_mul_f32 v165, v165, v12
v_mul_f32 v166, v166, v12
v_mul_f32 v167, v167, v12
v_mul_f32 v180, v180, v12
v_mul_f32 v181, v181, v12
v_mul_f32 v182, v182, v12
v_mul_f32 v183, v183, v12
v_mul_f32 v196, v196, v12
v_mul_f32 v197, v197, v12
v_mul_f32 v198, v198, v12
v_mul_f32 v199, v199, v12
v_mul_f32 v212, v212, v12
v_mul_f32 v213, v213, v12
v_mul_f32 v214, v214, v12
v_mul_f32 v215, v215, v12
v_mul_f32 v228, v228, v12
v_mul_f32 v229, v229, v12
v_mul_f32 v230, v230, v12
v_mul_f32 v231, v231, v12
v_mul_f32 v244, v244, v12
v_mul_f32 v245, v245, v12
v_mul_f32 v246, v246, v12
v_mul_f32 v247, v247, v12
v_accvgpr_read_b32 v14, a4
v_mul_f32 v14, v14, v12
v_accvgpr_write_b32 a4, v14
v_accvgpr_read_b32 v14, a5
v_mul_f32 v14, v14, v12
v_accvgpr_write_b32 a5, v14
v_accvgpr_read_b32 v14, a6
v_mul_f32 v14, v14, v12
v_accvgpr_write_b32 a6, v14
v_accvgpr_read_b32 v14, a7
v_mul_f32 v14, v14, v12
v_accvgpr_write_b32 a7, v14
v_accvgpr_read_b32 v14, a20
v_mul_f32 v14, v14, v12
v_accvgpr_write_b32 a20, v14
v_accvgpr_read_b32 v14, a21
v_mul_f32 v14, v14, v12
v_accvgpr_write_b32 a21, v14
v_accvgpr_read_b32 v14, a22
v_mul_f32 v14, v14, v12
v_accvgpr_write_b32 a22, v14
v_accvgpr_read_b32 v14, a23
v_mul_f32 v14, v14, v12
v_accvgpr_write_b32 a23, v14
v_accvgpr_read_b32 v14, a36
v_mul_f32 v14, v14, v12
v_accvgpr_write_b32 a36, v14
v_accvgpr_read_b32 v14, a37
v_mul_f32 v14, v14, v12
v_accvgpr_write_b32 a37, v14
v_accvgpr_read_b32 v14, a38
v_mul_f32 v14, v14, v12
v_accvgpr_write_b32 a38, v14
v_accvgpr_read_b32 v14, a39
v_mul_f32 v14, v14, v12
v_accvgpr_write_b32 a39, v14
v_max3_f32 v13, v40, v41, v10
v_max3_f32 v13, v13, v42, v43
v_max3_f32 v13, v13, v56, v57
v_max3_f32 v13, v13, v58, v59
v_max3_f32 v13, v13, v72, v73
v_max3_f32 v13, v13, v74, v75
v_max3_f32 v13, v13, v88, v89
v_max3_f32 v13, v13, v90, v91
v_mov_b32 v14, v13
s_nop 1
v_permlane16_swap_b32 v13, v14
v_max_f32 v13, v13, v14
v_mov_b32 v14, v13
s_nop 1
v_permlane32_swap_b32 v13, v14
v_max_f32 v13, v13, v14
v_sub_f32 v12, v10, v13
v_exp_f32 v12, v12
v_mov_b32 v10, v13
v_sub_f32 v40, v40, v13
v_sub_f32 v41, v41, v13
v_sub_f32 v42, v42, v13
v_sub_f32 v43, v43, v13
v_sub_f32 v56, v56, v13
v_sub_f32 v57, v57, v13
v_sub_f32 v58, v58, v13
v_sub_f32 v59, v59, v13
v_sub_f32 v72, v72, v13
v_sub_f32 v73, v73, v13
v_sub_f32 v74, v74, v13
v_sub_f32 v75, v75, v13
v_sub_f32 v88, v88, v13
v_sub_f32 v89, v89, v13
v_sub_f32 v90, v90, v13
v_sub_f32 v91, v91, v13
v_mul_f32 v168, v168, v12
v_mul_f32 v169, v169, v12
v_mul_f32 v170, v170, v12
v_mul_f32 v171, v171, v12
v_mul_f32 v184, v184, v12
v_mul_f32 v185, v185, v12
v_mul_f32 v186, v186, v12
v_mul_f32 v187, v187, v12
v_mul_f32 v200, v200, v12
v_mul_f32 v201, v201, v12
v_mul_f32 v202, v202, v12
v_mul_f32 v203, v203, v12
v_mul_f32 v216, v216, v12
v_mul_f32 v217, v217, v12
v_mul_f32 v218, v218, v12
v_mul_f32 v219, v219, v12
v_mul_f32 v232, v232, v12
v_mul_f32 v233, v233, v12
v_mul_f32 v234, v234, v12
v_mul_f32 v235, v235, v12
v_mul_f32 v248, v248, v12
v_mul_f32 v249, v249, v12
v_mul_f32 v250, v250, v12
v_mul_f32 v251, v251, v12
v_accvgpr_read_b32 v14, a8
v_mul_f32 v14, v14, v12
v_accvgpr_write_b32 a8, v14
v_accvgpr_read_b32 v14, a9
v_mul_f32 v14, v14, v12
v_accvgpr_write_b32 a9, v14
v_accvgpr_read_b32 v14, a10
v_mul_f32 v14, v14, v12
v_accvgpr_write_b32 a10, v14
v_accvgpr_read_b32 v14, a11
v_mul_f32 v14, v14, v12
v_accvgpr_write_b32 a11, v14
v_accvgpr_read_b32 v14, a24
v_mul_f32 v14, v14, v12
v_accvgpr_write_b32 a24, v14
v_accvgpr_read_b32 v14, a25
v_mul_f32 v14, v14, v12
v_accvgpr_write_b32 a25, v14
v_accvgpr_read_b32 v14, a26
v_mul_f32 v14, v14, v12
v_accvgpr_write_b32 a26, v14
v_accvgpr_read_b32 v14, a27
v_mul_f32 v14, v14, v12
v_accvgpr_write_b32 a27, v14
v_accvgpr_read_b32 v14, a40
v_mul_f32 v14, v14, v12
v_accvgpr_write_b32 a40, v14
v_accvgpr_read_b32 v14, a41
v_mul_f32 v14, v14, v12
v_accvgpr_write_b32 a41, v14
v_accvgpr_read_b32 v14, a42
v_mul_f32 v14, v14, v12
v_accvgpr_write_b32 a42, v14
v_accvgpr_read_b32 v14, a43
v_mul_f32 v14, v14, v12
v_accvgpr_write_b32 a43, v14
v_max3_f32 v13, v44, v45, v11
v_max3_f32 v13, v13, v46, v47
v_max3_f32 v13, v13, v60, v61
v_max3_f32 v13, v13, v62, v63
v_max3_f32 v13, v13, v76, v77
v_max3_f32 v13, v13, v78, v79
v_max3_f32 v13, v13, v92, v93
v_max3_f32 v13, v13, v94, v95
v_mov_b32 v14, v13
s_nop 1
v_permlane16_swap_b32 v13, v14
v_max_f32 v13, v13, v14
v_mov_b32 v14, v13
s_nop 1
v_permlane32_swap_b32 v13, v14
v_max_f32 v13, v13, v14
v_sub_f32 v12, v11, v13
v_exp_f32 v12, v12
v_mov_b32 v11, v13
v_sub_f32 v44, v44, v13
v_sub_f32 v45, v45, v13
v_sub_f32 v46, v46, v13
v_sub_f32 v47, v47, v13
v_sub_f32 v60, v60, v13
v_sub_f32 v61, v61, v13
v_sub_f32 v62, v62, v13
v_sub_f32 v63, v63, v13
v_sub_f32 v76, v76, v13
v_sub_f32 v77, v77, v13
v_sub_f32 v78, v78, v13
v_sub_f32 v79, v79, v13
v_sub_f32 v92, v92, v13
v_sub_f32 v93, v93, v13
v_sub_f32 v94, v94, v13
v_sub_f32 v95, v95, v13
v_mul_f32 v172, v172, v12
v_mul_f32 v173, v173, v12
v_mul_f32 v174, v174, v12
v_mul_f32 v175, v175, v12
v_mul_f32 v188, v188, v12
v_mul_f32 v189, v189, v12
v_mul_f32 v190, v190, v12
v_mul_f32 v191, v191, v12
v_mul_f32 v204, v204, v12
v_mul_f32 v205, v205, v12
v_mul_f32 v206, v206, v12
v_mul_f32 v207, v207, v12
v_mul_f32 v220, v220, v12
v_mul_f32 v221, v221, v12
v_mul_f32 v222, v222, v12
v_mul_f32 v223, v223, v12
v_mul_f32 v236, v236, v12
v_mul_f32 v237, v237, v12
v_mul_f32 v238, v238, v12
v_mul_f32 v239, v239, v12
v_mul_f32 v252, v252, v12
v_mul_f32 v253, v253, v12
v_mul_f32 v254, v254, v12
v_mul_f32 v255, v255, v12
v_accvgpr_read_b32 v14, a12
v_mul_f32 v14, v14, v12
v_accvgpr_write_b32 a12, v14
v_accvgpr_read_b32 v14, a13
v_mul_f32 v14, v14, v12
v_accvgpr_write_b32 a13, v14
v_accvgpr_read_b32 v14, a14
v_mul_f32 v14, v14, v12
v_accvgpr_write_b32 a14, v14
v_accvgpr_read_b32 v14, a15
v_mul_f32 v14, v14, v12
v_accvgpr_write_b32 a15, v14
v_accvgpr_read_b32 v14, a28
v_mul_f32 v14, v14, v12
v_accvgpr_write_b32 a28, v14
v_accvgpr_read_b32 v14, a29
v_mul_f32 v14, v14, v12
v_accvgpr_write_b32 a29, v14
v_accvgpr_read_b32 v14, a30
v_mul_f32 v14, v14, v12
v_accvgpr_write_b32 a30, v14
v_accvgpr_read_b32 v14, a31
v_mul_f32 v14, v14, v12
v_accvgpr_write_b32 a31, v14
v_accvgpr_read_b32 v14, a44
v_mul_f32 v14, v14, v12
v_accvgpr_write_b32 a44, v14
v_accvgpr_read_b32 v14, a45
v_mul_f32 v14, v14, v12
v_accvgpr_write_b32 a45, v14
v_accvgpr_read_b32 v14, a46
v_mul_f32 v14, v14, v12
v_accvgpr_write_b32 a46, v14
v_accvgpr_read_b32 v14, a47
v_mul_f32 v14, v14, v12
v_accvgpr_write_b32 a47, v14
v_exp_f32 v32, v32
v_exp_f32 v33, v33
v_exp_f32 v34, v34
v_exp_f32 v35, v35
v_exp_f32 v48, v48
v_exp_f32 v49, v49
v_exp_f32 v50, v50
v_exp_f32 v51, v51
v_cvt_pk_bf16_f32 v32, v32, v33
v_cvt_pk_bf16_f32 v33, v34, v35
v_exp_f32 v36, v36
v_exp_f32 v37, v37
v_exp_f32 v38, v38
v_exp_f32 v39, v39
v_cvt_pk_bf16_f32 v34, v48, v49
v_cvt_pk_bf16_f32 v35, v50, v51
v_exp_f32 v52, v52
v_exp_f32 v53, v53
v_exp_f32 v54, v54
v_exp_f32 v55, v55
v_cvt_pk_bf16_f32 v36, v36, v37
v_cvt_pk_bf16_f32 v37, v38, v39
v_exp_f32 v40, v40
v_exp_f32 v41, v41
v_exp_f32 v42, v42
v_exp_f32 v43, v43
v_cvt_pk_bf16_f32 v38, v52, v53
v_cvt_pk_bf16_f32 v39, v54, v55
v_exp_f32 v56, v56
v_exp_f32 v57, v57
v_exp_f32 v58, v58
v_exp_f32 v59, v59
v_cvt_pk_bf16_f32 v40, v40, v41
v_cvt_pk_bf16_f32 v41, v42, v43
v_exp_f32 v44, v44
v_exp_f32 v45, v45
v_exp_f32 v46, v46
v_exp_f32 v47, v47
v_cvt_pk_bf16_f32 v42, v56, v57
v_cvt_pk_bf16_f32 v43, v58, v59
v_exp_f32 v60, v60
v_exp_f32 v61, v61
v_exp_f32 v62, v62
v_exp_f32 v63, v63
v_cvt_pk_bf16_f32 v44, v44, v45
v_cvt_pk_bf16_f32 v45, v46, v47
v_cvt_pk_bf16_f32 v46, v60, v61
v_cvt_pk_bf16_f32 v47, v62, v63
v_exp_f32 v64, v64
v_exp_f32 v65, v65
v_exp_f32 v66, v66
v_exp_f32 v67, v67
v_exp_f32 v80, v80
v_exp_f32 v81, v81
v_exp_f32 v82, v82
v_exp_f32 v83, v83
v_cvt_pk_bf16_f32 v64, v64, v65
v_cvt_pk_bf16_f32 v65, v66, v67
v_exp_f32 v68, v68
v_exp_f32 v69, v69
v_exp_f32 v70, v70
v_exp_f32 v71, v71
v_cvt_pk_bf16_f32 v66, v80, v81
v_cvt_pk_bf16_f32 v67, v82, v83
v_exp_f32 v84, v84
v_exp_f32 v85, v85
v_exp_f32 v86, v86
v_exp_f32 v87, v87
v_cvt_pk_bf16_f32 v68, v68, v69
v_cvt_pk_bf16_f32 v69, v70, v71
v_exp_f32 v72, v72
v_exp_f32 v73, v73
v_exp_f32 v74, v74
v_exp_f32 v75, v75
v_cvt_pk_bf16_f32 v70, v84, v85
v_cvt_pk_bf16_f32 v71, v86, v87
v_exp_f32 v88, v88
v_exp_f32 v89, v89
v_exp_f32 v90, v90
v_exp_f32 v91, v91
v_cvt_pk_bf16_f32 v72, v72, v73
v_cvt_pk_bf16_f32 v73, v74, v75
v_exp_f32 v76, v76
v_exp_f32 v77, v77
v_exp_f32 v78, v78
v_exp_f32 v79, v79
v_cvt_pk_bf16_f32 v74, v88, v89
v_cvt_pk_bf16_f32 v75, v90, v91
v_exp_f32 v92, v92
v_exp_f32 v93, v93
v_exp_f32 v94, v94
v_exp_f32 v95, v95
v_cvt_pk_bf16_f32 v76, v76, v77
v_cvt_pk_bf16_f32 v77, v78, v79
v_cvt_pk_bf16_f32 v78, v92, v93
v_cvt_pk_bf16_f32 v79, v94, v95
s_waitcnt vmcnt(0)
M a[32:35], a[48:51], v[32:35], a[32:35]
M a[36:39], a[48:51], v[36:39], a[36:39]
M a[40:43], a[48:51], v[40:43], a[40:43]
M a[44:47], a[48:51], v[44:47], a[44:47]
M v[160:163], v[96:99], v[32:35], v[160:163]
M v[164:167], v[96:99], v[36:39], v[164:167]
M v[168:171], v[96:99], v[40:43], v[168:171]
M v[172:175], v[96:99], v[44:47], v[172:175]
M v[176:179], v[100:103], v[32:35], v[176:179]
M v[180:183], v[100:103], v[36:39], v[180:183]
M v[184:187], v[100:103], v[40:43], v[184:187]
M v[188:191], v[100:103], v[44:47], v[188:191]
M v[192:195], v[104:107], v[32:35], v[192:195]
M v[196:199], v[104:107], v[36:39], v[196:199]
M v[200:203], v[104:107], v[40:43], v[200:203]
M v[204:207], v[104:107], v[44:47], v[204:207]
M v[208:211], v[108:111], v[32:35], v[208:211]
M v[212:215], v[108:111], v[36:39], v[212:215]
M v[216:219], v[108:111], v[40:43], v[216:219]
M v[220:223], v[108:111], v[44:47], v[220:223]
M v[224:227], v[112:115], v[32:35], v[224:227]
M v[228:231], v[112:115], v[36:39], v[228:231]
M v[232:235], v[112:115], v[40:43], v[232:235]
M v[236:239], v[112:115], v[44:47], v[236:239]
M v[240:243], v[116:119], v[32:35], v[240:243]
M v[244:247], v[116:119], v[36:39], v[244:247]
M v[248:251], v[116:119], v[40:43], v[248:251]
M v[252:255], v[116:119], v[44:47], v[252:255]
M a[0:3], v[120:123], v[32:35], a[0:3]
M a[4:7], v[120:123], v[36:39], a[4:7]
M a[8:11], v[120:123], v[40:43], a[8:11]
M a[12:15], v[120:123], v[44:47], a[12:15]
M a[16:19], v[124:127], v[32:35], a[16:19]
M a[20:23], v[124:127], v[36:39], a[20:23]
M a[24:27], v[124:127], v[40:43], a[24:27]
M a[28:31], v[124:127], v[44:47], a[28:31]
M a[32:35], a[48:51], v[64:67], a[32:35]
M a[36:39], a[48:51], v[68:71], a[36:39]
M a[40:43], a[48:51], v[72:75], a[40:43]
M a[44:47], a[48:51], v[76:79], a[44:47]
M v[160:163], v[128:131], v[64:67], v[160:163]
M v[164:167], v[128:131], v[68:71], v[164:167]
M v[168:171], v[128:131], v[72:75], v[168:171]
M v[172:175], v[128:131], v[76:79], v[172:175]
M v[176:179], v[132:135], v[64:67], v[176:179]
M v[180:183], v[132:135], v[68:71], v[180:183]
M v[184:187], v[132:135], v[72:75], v[184:187]
M v[188:191], v[132:135], v[76:79], v[188:191]
M v[192:195], v[136:139], v[64:67], v[192:195]
M v[196:199], v[136:139], v[68:71], v[196:199]
M v[200:203], v[136:139], v[72:75], v[200:203]
M v[204:207], v[136:139], v[76:79], v[204:207]
M v[208:211], v[140:143], v[64:67], v[208:211]
M v[212:215], v[140:143], v[68:71], v[212:215]
M v[216:219], v[140:143], v[72:75], v[216:219]
M v[220:223], v[140:143], v[76:79], v[220:223]
M v[224:227], v[144:147], v[64:67], v[224:227]
M v[228:231], v[144:147], v[68:71], v[228:231]
M v[232:235], v[144:147], v[72:75], v[232:235]
M v[236:239], v[144:147], v[76:79], v[236:239]
M v[240:243], v[148:151], v[64:67], v[240:243]
M v[244:247], v[148:151], v[68:71], v[244:247]
M v[248:251], v[148:151], v[72:75], v[248:251]
M v[252:255], v[148:151], v[76:79], v[252:255]
M a[0:3], v[152:155], v[64:67], a[0:3]
M a[4:7], v[152:155], v[68:71], a[4:7]
M a[8:11], v[152:155], v[72:75], a[8:11]
M a[12:15], v[152:155], v[76:79], a[12:15]
M a[16:19], v[156:159], v[64:67], a[16:19]
M a[20:23], v[156:159], v[68:71], a[20:23]
M a[24:27], v[156:159], v[72:75], a[24:27]
M a[28:31], v[156:159], v[76:79], a[28:31]
s_nop 7
s_add_u32 s57, s57, 32768
s_sub_u32 s58, s58, 64
s_sub_u32 s59, s59, 1
s_cmp_lg_u32 s59, 0
s_cbranch_scc1 Lslow_7
v_accvgpr_read_b32 v20, a32
v_accvgpr_read_b32 v21, a36
v_accvgpr_read_b32 v22, a40
v_accvgpr_read_b32 v23, a44
v_rcp_f32 v8, v20
v_rcp_f32 v9, v21
v_rcp_f32 v10, v22
v_rcp_f32 v11, v23
v_pk_mul_f32 v[160:161], v[160:161], v[8:9] op_sel:[0,0] op_sel_hi:[1,0]
v_pk_mul_f32 v[162:163], v[162:163], v[8:9] op_sel:[0,0] op_sel_hi:[1,0]
v_pk_mul_f32 v[176:177], v[176:177], v[8:9] op_sel:[0,0] op_sel_hi:[1,0]
v_pk_mul_f32 v[178:179], v[178:179], v[8:9] op_sel:[0,0] op_sel_hi:[1,0]
v_cvt_pk_bf16_f32 v160, v160, v161
v_cvt_pk_bf16_f32 v161, v162, v163
v_cvt_pk_bf16_f32 v162, v176, v177
v_cvt_pk_bf16_f32 v163, v178, v179
v_pk_mul_f32 v[164:165], v[164:165], v[8:9] op_sel:[0,1] op_sel_hi:[1,1]
v_pk_mul_f32 v[166:167], v[166:167], v[8:9] op_sel:[0,1] op_sel_hi:[1,1]
v_pk_mul_f32 v[180:181], v[180:181], v[8:9] op_sel:[0,1] op_sel_hi:[1,1]
v_pk_mul_f32 v[182:183], v[182:183], v[8:9] op_sel:[0,1] op_sel_hi:[1,1]
v_cvt_pk_bf16_f32 v164, v164, v165
v_cvt_pk_bf16_f32 v165, v166, v167
v_cvt_pk_bf16_f32 v166, v180, v181
v_cvt_pk_bf16_f32 v167, v182, v183
v_pk_mul_f32 v[168:169], v[168:169], v[10:11] op_sel:[0,0] op_sel_hi:[1,0]
v_pk_mul_f32 v[170:171], v[170:171], v[10:11] op_sel:[0,0] op_sel_hi:[1,0]
v_pk_mul_f32 v[184:185], v[184:185], v[10:11] op_sel:[0,0] op_sel_hi:[1,0]
v_pk_mul_f32 v[186:187], v[186:187], v[10:11] op_sel:[0,0] op_sel_hi:[1,0]
v_cvt_pk_bf16_f32 v168, v168, v169
v_cvt_pk_bf16_f32 v169, v170, v171
v_cvt_pk_bf16_f32 v170, v184, v185
v_cvt_pk_bf16_f32 v171, v186, v187
v_pk_mul_f32 v[172:173], v[172:173], v[10:11] op_sel:[0,1] op_sel_hi:[1,1]
v_pk_mul_f32 v[174:175], v[174:175], v[10:11] op_sel:[0,1] op_sel_hi:[1,1]
v_pk_mul_f32 v[188:189], v[188:189], v[10:11] op_sel:[0,1] op_sel_hi:[1,1]
v_pk_mul_f32 v[190:191], v[190:191], v[10:11] op_sel:[0,1] op_sel_hi:[1,1]
v_cvt_pk_bf16_f32 v172, v172, v173
v_cvt_pk_bf16_f32 v173, v174, v175
v_cvt_pk_bf16_f32 v174, v188, v189
v_cvt_pk_bf16_f32 v175, v190, v191
v_pk_mul_f32 v[192:193], v[192:193], v[8:9] op_sel:[0,0] op_sel_hi:[1,0]
v_pk_mul_f32 v[194:195], v[194:195], v[8:9] op_sel:[0,0] op_sel_hi:[1,0]
v_pk_mul_f32 v[208:209], v[208:209], v[8:9] op_sel:[0,0] op_sel_hi:[1,0]
v_pk_mul_f32 v[210:211], v[210:211], v[8:9] op_sel:[0,0] op_sel_hi:[1,0]
v_cvt_pk_bf16_f32 v192, v192, v193
v_cvt_pk_bf16_f32 v193, v194, v195
v_cvt_pk_bf16_f32 v194, v208, v209
v_cvt_pk_bf16_f32 v195, v210, v211
v_pk_mul_f32 v[196:197], v[196:197], v[8:9] op_sel:[0,1] op_sel_hi:[1,1]
v_pk_mul_f32 v[198:199], v[198:199], v[8:9] op_sel:[0,1] op_sel_hi:[1,1]
v_pk_mul_f32 v[212:213], v[212:213], v[8:9] op_sel:[0,1] op_sel_hi:[1,1]
v_pk_mul_f32 v[214:215], v[214:215], v[8:9] op_sel:[0,1] op_sel_hi:[1,1]
v_cvt_pk_bf16_f32 v196, v196, v197
v_cvt_pk_bf16_f32 v197, v198, v199
v_cvt_pk_bf16_f32 v198, v212, v213
v_cvt_pk_bf16_f32 v199, v214, v215
v_pk_mul_f32 v[200:201], v[200:201], v[10:11] op_sel:[0,0] op_sel_hi:[1,0]
v_pk_mul_f32 v[202:203], v[202:203], v[10:11] op_sel:[0,0] op_sel_hi:[1,0]
v_pk_mul_f32 v[216:217], v[216:217], v[10:11] op_sel:[0,0] op_sel_hi:[1,0]
v_pk_mul_f32 v[218:219], v[218:219], v[10:11] op_sel:[0,0] op_sel_hi:[1,0]
v_cvt_pk_bf16_f32 v200, v200, v201
v_cvt_pk_bf16_f32 v201, v202, v203
v_cvt_pk_bf16_f32 v202, v216, v217
v_cvt_pk_bf16_f32 v203, v218, v219
v_pk_mul_f32 v[204:205], v[204:205], v[10:11] op_sel:[0,1] op_sel_hi:[1,1]
v_pk_mul_f32 v[206:207], v[206:207], v[10:11] op_sel:[0,1] op_sel_hi:[1,1]
v_pk_mul_f32 v[220:221], v[220:221], v[10:11] op_sel:[0,1] op_sel_hi:[1,1]
v_pk_mul_f32 v[222:223], v[222:223], v[10:11] op_sel:[0,1] op_sel_hi:[1,1]
v_cvt_pk_bf16_f32 v204, v204, v205
v_cvt_pk_bf16_f32 v205, v206, v207
v_cvt_pk_bf16_f32 v206, v220, v221
v_cvt_pk_bf16_f32 v207, v222, v223
v_pk_mul_f32 v[224:225], v[224:225], v[8:9] op_sel:[0,0] op_sel_hi:[1,0]
v_pk_mul_f32 v[226:227], v[226:227], v[8:9] op_sel:[0,0] op_sel_hi:[1,0]
v_pk_mul_f32 v[240:241], v[240:241], v[8:9] op_sel:[0,0] op_sel_hi:[1,0]
v_pk_mul_f32 v[242:243], v[242:243], v[8:9] op_sel:[0,0] op_sel_hi:[1,0]
v_cvt_pk_bf16_f32 v224, v224, v225
v_cvt_pk_bf16_f32 v225, v226, v227
v_cvt_pk_bf16_f32 v226, v240, v241
v_cvt_pk_bf16_f32 v227, v242, v243
v_pk_mul_f32 v[228:229], v[228:229], v[8:9] op_sel:[0,1] op_sel_hi:[1,1]
v_pk_mul_f32 v[230:231], v[230:231], v[8:9] op_sel:[0,1] op_sel_hi:[1,1]
v_pk_mul_f32 v[244:245], v[244:245], v[8:9] op_sel:[0,1] op_sel_hi:[1,1]
v_pk_mul_f32 v[246:247], v[246:247], v[8:9] op_sel:[0,1] op_sel_hi:[1,1]
v_cvt_pk_bf16_f32 v228, v228, v229
v_cvt_pk_bf16_f32 v229, v230, v231
v_cvt_pk_bf16_f32 v230, v244, v245
v_cvt_pk_bf16_f32 v231, v246, v247
v_pk_mul_f32 v[232:233], v[232:233], v[10:11] op_sel:[0,0] op_sel_hi:[1,0]
v_pk_mul_f32 v[234:235], v[234:235], v[10:11] op_sel:[0,0] op_sel_hi:[1,0]
v_pk_mul_f32 v[248:249], v[248:249], v[10:11] op_sel:[0,0] op_sel_hi:[1,0]
v_pk_mul_f32 v[250:251], v[250:251], v[10:11] op_sel:[0,0] op_sel_hi:[1,0]
v_cvt_pk_bf16_f32 v232, v232, v233
v_cvt_pk_bf16_f32 v233, v234, v235
v_cvt_pk_bf16_f32 v234, v248, v249
v_cvt_pk_bf16_f32 v235, v250, v251
v_pk_mul_f32 v[236:237], v[236:237], v[10:11] op_sel:[0,1] op_sel_hi:[1,1]
v_pk_mul_f32 v[238:239], v[238:239], v[10:11] op_sel:[0,1] op_sel_hi:[1,1]
v_pk_mul_f32 v[252:253], v[252:253], v[10:11] op_sel:[0,1] op_sel_hi:[1,1]
v_pk_mul_f32 v[254:255], v[254:255], v[10:11] op_sel:[0,1] op_sel_hi:[1,1]
v_cvt_pk_bf16_f32 v236, v236, v237
v_cvt_pk_bf16_f32 v237, v238, v239
v_cvt_pk_bf16_f32 v238, v252, v253
v_cvt_pk_bf16_f32 v239, v254, v255
v_accvgpr_read_b32 v176, a0
v_accvgpr_read_b32 v177, a1
v_accvgpr_read_b32 v178, a2
v_accvgpr_read_b32 v179, a3
v_accvgpr_read_b32 v180, a16
v_accvgpr_read_b32 v181, a17
v_accvgpr_read_b32 v182, a18
v_accvgpr_read_b32 v183, a19
v_pk_mul_f32 v[176:177], v[176:177], v[8:9] op_sel:[0,0] op_sel_hi:[1,0]
v_pk_mul_f32 v[178:179], v[178:179], v[8:9] op_sel:[0,0] op_sel_hi:[1,0]
v_pk_mul_f32 v[180:181], v[180:181], v[8:9] op_sel:[0,0] op_sel_hi:[1,0]
v_pk_mul_f32 v[182:183], v[182:183], v[8:9] op_sel:[0,0] op_sel_hi:[1,0]
v_cvt_pk_bf16_f32 v176, v176, v177
v_cvt_pk_bf16_f32 v177, v178, v179
v_cvt_pk_bf16_f32 v178, v180, v181
v_cvt_pk_bf16_f32 v179, v182, v183
v_accvgpr_read_b32 v184, a4
v_accvgpr_read_b32 v185, a5
v_accvgpr_read_b32 v186, a6
v_accvgpr_read_b32 v187, a7
v_accvgpr_read_b32 v188, a20
v_accvgpr_read_b32 v189, a21
v_accvgpr_read_b32 v190, a22
v_accvgpr_read_b32 v191, a23
v_pk_mul_f32 v[184:185], v[184:185], v[8:9] op_sel:[0,1] op_sel_hi:[1,1]
v_pk_mul_f32 v[186:187], v[186:187], v[8:9] op_sel:[0,1] op_sel_hi:[1,1]
v_pk_mul_f32 v[188:189], v[188:189], v[8:9] op_sel:[0,1] op_sel_hi:[1,1]
v_pk_mul_f32 v[190:191], v[190:191], v[8:9] op_sel:[0,1] op_sel_hi:[1,1]
v_cvt_pk_bf16_f32 v184, v184, v185
v_cvt_pk_bf16_f32 v185, v186, v187
v_cvt_pk_bf16_f32 v186, v188, v189
v_cvt_pk_bf16_f32 v187, v190, v191
v_accvgpr_read_b32 v208, a8
v_accvgpr_read_b32 v209, a9
v_accvgpr_read_b32 v210, a10
v_accvgpr_read_b32 v211, a11
v_accvgpr_read_b32 v212, a24
v_accvgpr_read_b32 v213, a25
v_accvgpr_read_b32 v214, a26
v_accvgpr_read_b32 v215, a27
v_pk_mul_f32 v[208:209], v[208:209], v[10:11] op_sel:[0,0] op_sel_hi:[1,0]
v_pk_mul_f32 v[210:211], v[210:211], v[10:11] op_sel:[0,0] op_sel_hi:[1,0]
v_pk_mul_f32 v[212:213], v[212:213], v[10:11] op_sel:[0,0] op_sel_hi:[1,0]
v_pk_mul_f32 v[214:215], v[214:215], v[10:11] op_sel:[0,0] op_sel_hi:[1,0]
v_cvt_pk_bf16_f32 v208, v208, v209
v_cvt_pk_bf16_f32 v209, v210, v211
v_cvt_pk_bf16_f32 v210, v212, v213
v_cvt_pk_bf16_f32 v211, v214, v215
v_accvgpr_read_b32 v216, a12
v_accvgpr_read_b32 v217, a13
v_accvgpr_read_b32 v218, a14
v_accvgpr_read_b32 v219, a15
v_accvgpr_read_b32 v220, a28
v_accvgpr_read_b32 v221, a29
v_accvgpr_read_b32 v222, a30
v_accvgpr_read_b32 v223, a31
v_pk_mul_f32 v[216:217], v[216:217], v[10:11] op_sel:[0,1] op_sel_hi:[1,1]
v_pk_mul_f32 v[218:219], v[218:219], v[10:11] op_sel:[0,1] op_sel_hi:[1,1]
v_pk_mul_f32 v[220:221], v[220:221], v[10:11] op_sel:[0,1] op_sel_hi:[1,1]
v_pk_mul_f32 v[222:223], v[222:223], v[10:11] op_sel:[0,1] op_sel_hi:[1,1]
v_cvt_pk_bf16_f32 v216, v216, v217
v_cvt_pk_bf16_f32 v217, v218, v219
v_cvt_pk_bf16_f32 v218, v220, v221
v_cvt_pk_bf16_f32 v219, v222, v223
s_lshl_b32 s33, s56, 20
s_lshl_b32 s34, s20, 15
s_add_u32 s33, s33, s34
s_lshl_b32 s34, s23, 13
s_add_u32 s36, s33, s34
s_add_u32 s37, s36, 4096
s_add_u32 s38, s36, 16384
s_add_u32 s39, s36, 20480
s_bitcmp1_b32 s61, 0
s_cbranch_scc0 Lss_10
buffer_store_dwordx4 v[160:163], v1, s[16:19], s36 offen offset:0 sc1
buffer_store_dwordx4 v[164:167], v1, s[16:19], s36 offen offset:2048 sc1
buffer_store_dwordx4 v[168:171], v1, s[16:19], s37 offen offset:0 sc1
buffer_store_dwordx4 v[172:175], v1, s[16:19], s37 offen offset:2048 sc1
Lss_10:
s_bitcmp1_b32 s61, 1
s_cbranch_scc0 Lss_11
buffer_store_dwordx4 v[192:195], v1, s[16:19], s36 offen offset:1024 sc1
buffer_store_dwordx4 v[196:199], v1, s[16:19], s36 offen offset:3072 sc1
buffer_store_dwordx4 v[200:203], v1, s[16:19], s37 offen offset:1024 sc1
buffer_store_dwordx4 v[204:207], v1, s[16:19], s37 offen offset:3072 sc1
Lss_11:
s_bitcmp1_b32 s61, 2
s_cbranch_scc0 Lss_12
buffer_store_dwordx4 v[224:227], v1, s[16:19], s38 offen offset:0 sc1
buffer_store_dwordx4 v[228:231], v1, s[16:19], s38 offen offset:2048 sc1
buffer_store_dwordx4 v[232:235], v1, s[16:19], s39 offen offset:0 sc1
buffer_store_dwordx4 v[236:239], v1, s[16:19], s39 offen offset:2048 sc1
Lss_12:
s_bitcmp1_b32 s61, 3
s_cbranch_scc0 Lss_13
buffer_store_dwordx4 v[176:179], v1, s[16:19], s38 offen offset:1024 sc1
buffer_store_dwordx4 v[184:187], v1, s[16:19], s38 offen offset:3072 sc1
buffer_store_dwordx4 v[208:211], v1, s[16:19], s39 offen offset:1024 sc1
buffer_store_dwordx4 v[216:219], v1, s[16:19], s39 offen offset:3072 sc1
Lss_13:
s_branch Lk2_chk
Lk2_done:
s_lshl_b32 s33, s20, 4
s_add_u32 s33, s33, 8392704
s_sub_u32 s34, 15, s21
s_lshl_b32 s34, s34, 9
s_add_u32 s92, s33, s34
s_lshl_b32 s34, s22, 2
s_add_u32 s92, s92, s34
s_lshl_b32 s34, s21, 9
s_add_u32 s93, s33, s34
s_lshl_b32 s34, s23, 3
s_add_u32 s93, s93, s34
s_cmp_eq_u32 s24, 0
s_cselect_b32 s93, s93, s92
s_cselect_b32 s94, 4, 0
s_add_u32 s94, s94, s93
s_load_dwordx2 s[10:11], s[0:1], 40
s_load_dwordx2 s[14:15], s[0:1], 72
s_lshl_b32 s21, s27, 7
s_lshl_b32 s22, s28, 6
s_lshl_b32 s3, s101, 4
v_lshrrev_b32 v224, 3, v0
v_and_b32 v225, 6, v224
v_and_b32 v226, 7, v0
v_xor_b32 v225, v225, v226
v_add_u32 v224, s3, v224
v_lshlrev_b32 v224, 11, v224
v_lshl_add_u32 v6, v225, 4, v224
v_add_u32 v7, 15360, v6
v_lshrrev_b32 v224, 2, v0
v_and_b32 v226, 1, v0
v_bfe_u32 v229, v0, 1, 1
v_lshlrev_b32 v225, 7, v224
v_lshl_add_u32 v225, v226, 3, v225
v_and_b32 v228, 6, v224
v_add_u32 v227, 0, v229
v_xor_b32 v227, v227, v228
v_lshl_add_u32 v24, v227, 4, v225
v_add_u32 v28, 0x10000, v24
v_add_u32 v227, 2, v229
v_xor_b32 v227, v227, v228
v_lshl_add_u32 v25, v227, 4, v225
v_add_u32 v29, 0x10000, v25
v_add_u32 v227, 4, v229
v_xor_b32 v227, v227, v228
v_lshl_add_u32 v26, v227, 4, v225
v_add_u32 v30, 0x10000, v26
v_add_u32 v227, 6, v229
v_xor_b32 v227, v227, v228
v_lshl_add_u32 v27, v227, 4, v225
v_add_u32 v31, 0x10000, v27
s_waitcnt vmcnt(32)
s_barrier
ds_read_b64_tr_b16 v[96:97], v28 offset:0
ds_read_b64_tr_b16 v[98:99], v28 offset:2048
ds_read_b64_tr_b16 v[100:101], v28 offset:4096
ds_read_b64_tr_b16 v[102:103], v28 offset:6144
ds_read_b64_tr_b16 v[104:105], v29 offset:0
ds_read_b64_tr_b16 v[106:107], v29 offset:2048
ds_read_b64_tr_b16 v[108:109], v29 offset:4096
ds_read_b64_tr_b16 v[110:111], v29 offset:6144
ds_read_b64_tr_b16 v[112:113], v30 offset:0
ds_read_b64_tr_b16 v[114:115], v30 offset:2048
ds_read_b64_tr_b16 v[116:117], v30 offset:4096
ds_read_b64_tr_b16 v[118:119], v30 offset:6144
ds_read_b64_tr_b16 v[120:121], v31 offset:0
ds_read_b64_tr_b16 v[122:123], v31 offset:2048
ds_read_b64_tr_b16 v[124:125], v31 offset:4096
ds_read_b64_tr_b16 v[126:127], v31 offset:6144
s_and_b32 s40, s2, 1
s_bfe_u32 s3, s2, 0x10001
s_lshl_b32 s3, s3, 3
s_bfe_u32 s36, s2, 0x30003
s_add_u32 s36, s3, s36
s_lshl_b32 s29, s36, 7
s_bfe_u32 s3, s2, 0x10002
s_lshl_b32 s3, s3, 2
s_lshr_b32 s37, s2, 6
s_add_u32 s3, s3, s37
s_lshl_b32 s13, s3, 8
s_lshl_b32 s30, s3, 7
s_lshl_b32 s3, s40, 6
s_add_u32 s30, s30, s3
s_lshl_b32 s41, s101, 12
s_lshl_b32 s12, s36, 20
s_add_u32 s12, s12, s41
s_lshl_b32 s62, s36, 9
s_lshl_b32 s3, s40, 8
s_add_u32 s62, s62, s3
s_add_u32 s62, s62, 8392704
s_lshr_b32 s3, s2, 1
s_lshr_b32 s38, s2, 2
s_xor_b32 s3, s3, s38
s_and_b32 s3, s3, 1
s_lshl_b32 s3, s3, 4
s_sub_u32 s39, 32, s3
s_lshl_b32 s38, s40, 5
s_add_u32 s3, s3, s38
s_lshl_b32 s3, s3, 14
s_add_u32 s12, s12, s3
s_lshl_b32 s3, s3, 3
s_add_u32 s13, s13, s3
s_mov_b32 s64, 4294459392
s_mov_b32 s65, 16384
s_add_u32 s8, s4, 67108864
s_addc_u32 s9, s5, 0
s_lshl_b32 s56, s2, 15
s_lshl_b32 s38, s101, 13
s_add_u32 s56, s56, s38
s_xor_b32 s57, s56, 32768
s_lshl_b32 s58, s2, 2
s_add_u32 s58, s58, 8388608
s_xor_b32 s59, s58, 4
s_mov_b32 s61, 0
s_lshl_b32 s3, s101, 4
v_lshrrev_b32 v232, 4, v0
v_and_b32 v234, 15, v0
v_add_u32 v233, 0, v232
v_lshlrev_b32 v233, 1, v233
v_xor_b32 v233, v233, v234
v_add_u32 v235, s3, v232
v_lshlrev_b32 v235, 11, v235
v_lshl_add_u32 v235, v233, 4, v235
v_add_u32 v2, 0, v235
v_add_u32 v233, 4, v232
v_lshlrev_b32 v233, 1, v233
v_xor_b32 v233, v233, v234
v_add_u32 v235, s3, v232
v_lshlrev_b32 v235, 11, v235
v_lshl_add_u32 v235, v233, 4, v235
v_add_u32 v3, 7168, v235
v_add_u32 v233, 0, v232
v_lshlrev_b32 v233, 1, v233
v_xor_b32 v233, v233, v234
v_add_u32 v235, s3, v232
v_lshlrev_b32 v235, 11, v235
v_lshl_add_u32 v235, v233, 4, v235
v_add_u32 v4, 14336, v235
v_add_u32 v233, 4, v232
v_lshlrev_b32 v233, 1, v233
v_xor_b32 v233, v233, v234
v_add_u32 v235, s3, v232
v_lshlrev_b32 v235, 11, v235
v_lshl_add_u32 v235, v233, 4, v235
v_add_u32 v5, 21504, v235
v_lshlrev_b32 v225, 8, v224
v_lshl_add_u32 v225, v226, 3, v225
v_and_b32 v228, 7, v224
v_lshlrev_b32 v228, 1, v228
s_lshl_b32 s38, s40, 3
v_xor_b32 v228, s38, v228
v_add_u32 v227, 0, v229
v_xor_b32 v227, v227, v228
v_lshl_add_u32 v8, v227, 4, v225
v_add_u32 v16, 0x10000, v8
v_add_u32 v227, 2, v229
v_xor_b32 v227, v227, v228
v_lshl_add_u32 v9, v227, 4, v225
v_add_u32 v17, 0x10000, v9
v_add_u32 v227, 4, v229
v_xor_b32 v227, v227, v228
v_lshl_add_u32 v10, v227, 4, v225
v_add_u32 v18, 0x10000, v10
v_add_u32 v227, 6, v229
v_xor_b32 v227, v227, v228
v_lshl_add_u32 v11, v227, 4, v225
v_add_u32 v19, 0x10000, v11
v_add_u32 v227, 8, v229
v_xor_b32 v227, v227, v228
v_lshl_add_u32 v12, v227, 4, v225
v_add_u32 v20, 0x10000, v12
v_add_u32 v227, 10, v229
v_xor_b32 v227, v227, v228
v_lshl_add_u32 v13, v227, 4, v225
v_add_u32 v21, 0x10000, v13
v_add_u32 v227, 12, v229
v_xor_b32 v227, v227, v228
v_lshl_add_u32 v14, v227, 4, v225
v_add_u32 v22, 0x10000, v14
v_add_u32 v227, 14, v229
v_xor_b32 v227, v227, v228
v_lshl_add_u32 v15, v227, 4, v225
v_add_u32 v23, 0x10000, v15
v_mov_b32 v253, 0
v_mov_b32 v254, 1
v_lshlrev_b32 v255, 2, v0
s_waitcnt lgkmcnt(0)
s_mov_b32 s16, s14
s_mov_b32 s17, s15
s_mov_b32 s18, 8388608
s_mov_b32 s19, 0x00020000
s_waitcnt vmcnt(26) lgkmcnt(0)
s_barrier
M a[0:3], v[96:99], a[192:195], 0
s_add_u32 m0, s42, 16384
s_nop 0
buffer_load_dwordx4 v6, s[48:51], s26 offen offset:0 lds
ds_read_b64_tr_b16 v[160:161], v28 offset:16384
ds_read_b64_tr_b16 v[162:163], v28 offset:18432
M a[0:3], v[100:103], a[196:199], a[0:3]
buffer_load_dwordx4 v7, s[48:51], s26 offen offset:1024 lds
M a[4:7], v[108:111], a[196:199], 0
ds_read_b64_tr_b16 v[164:165], v28 offset:20480
ds_read_b64_tr_b16 v[166:167], v28 offset:22528
M a[4:7], v[104:107], a[192:195], a[4:7]
buffer_load_dwordx4 a[144:147], v1, s[44:47], s25 offen offset:0 sc1
M a[8:11], v[112:115], a[192:195], 0
ds_read_b64_tr_b16 v[168:169], v29 offset:16384
ds_read_b64_tr_b16 v[170:171], v29 offset:18432
M a[8:11], v[116:119], a[196:199], a[8:11]
buffer_load_dwordx4 a[148:151], v1, s[44:47], s25 offen offset:1024 sc1
M a[12:15], v[124:127], a[196:199], 0
ds_read_b64_tr_b16 v[172:173], v29 offset:20480
ds_read_b64_tr_b16 v[174:175], v29 offset:22528
M a[12:15], v[120:123], a[192:195], a[12:15]
buffer_load_dwordx4 a[152:155], v1, s[44:47], s25 offen offset:2048 sc1
M a[16:19], v[96:99], a[200:203], 0
ds_read_b64_tr_b16 v[176:177], v30 offset:16384
ds_read_b64_tr_b16 v[178:179], v30 offset:18432
M a[16:19], v[100:103], a[204:207], a[16:19]
buffer_load_dwordx4 a[156:159], v1, s[44:47], s25 offen offset:3072 sc1
M a[20:23], v[108:111], a[204:207], 0
ds_read_b64_tr_b16 v[180:181], v30 offset:20480
ds_read_b64_tr_b16 v[182:183], v30 offset:22528
M a[20:23], v[104:107], a[200:203], a[20:23]
s_add_u32 s25, s25, 16384
s_add_u32 s26, s26, 131072
M a[24:27], v[112:115], a[200:203], 0
ds_read_b64_tr_b16 v[184:185], v31 offset:16384
ds_read_b64_tr_b16 v[186:187], v31 offset:18432
M a[24:27], v[116:119], a[204:207], a[24:27]
ds_read_b64_tr_b16 v[188:189], v31 offset:20480
ds_read_b64_tr_b16 v[190:191], v31 offset:22528
M a[28:31], v[124:127], a[204:207], 0
M a[28:31], v[120:123], a[200:203], a[28:31]
s_waitcnt vmcnt(6) lgkmcnt(0)
s_barrier
s_mov_b64 exec, 1
buffer_store_dword v254, v253, s[52:55], s92 offen sc1
buffer_store_dword v254, v253, s[52:55], s93 offen sc1
buffer_store_dword v254, v253, s[52:55], s94 offen sc1
s_mov_b64 exec, -1
M a[0:3], v[160:163], a[208:211], a[0:3]
s_add_u32 m0, s42, 32768
s_nop 0
buffer_load_dwordx4 v6, s[48:51], s26 offen offset:0 lds
ds_read_b64_tr_b16 v[96:97], v28 offset:32768
ds_read_b64_tr_b16 v[98:99], v28 offset:34816
M a[0:3], v[164:167], a[212:215], a[0:3]
buffer_load_dwordx4 v7, s[48:51], s26 offen offset:1024 lds
M a[4:7], v[172:175], a[212:215], a[4:7]
ds_read_b64_tr_b16 v[100:101], v28 offset:36864
ds_read_b64_tr_b16 v[102:103], v28 offset:38912
M a[4:7], v[168:171], a[208:211], a[4:7]
buffer_load_dwordx4 a[160:163], v1, s[44:47], s25 offen offset:0 sc1
M a[8:11], v[176:179], a[208:211], a[8:11]
ds_read_b64_tr_b16 v[104:105], v29 offset:32768
ds_read_b64_tr_b16 v[106:107], v29 offset:34816
M a[8:11], v[180:183], a[212:215], a[8:11]
buffer_load_dwordx4 a[164:167], v1, s[44:47], s25 offen offset:1024 sc1
M a[12:15], v[188:191], a[212:215], a[12:15]
ds_read_b64_tr_b16 v[108:109], v29 offset:36864
ds_read_b64_tr_b16 v[110:111], v29 offset:38912
M a[12:15], v[184:187], a[208:211], a[12:15]
buffer_load_dwordx4 a[168:171], v1, s[44:47], s25 offen offset:2048 sc1
M a[16:19], v[160:163], a[216:219], a[16:19]
ds_read_b64_tr_b16 v[112:113], v30 offset:32768
ds_read_b64_tr_b16 v[114:115], v30 offset:34816
M a[16:19], v[164:167], a[220:223], a[16:19]
buffer_load_dwordx4 a[172:175], v1, s[44:47], s25 offen offset:3072 sc1
M a[20:23], v[172:175], a[220:223], a[20:23]
ds_read_b64_tr_b16 v[116:117], v30 offset:36864
ds_read_b64_tr_b16 v[118:119], v30 offset:38912
M a[20:23], v[168:171], a[216:219], a[20:23]
s_add_u32 s25, s25, 16384
s_add_u32 s26, s26, 131072
M a[24:27], v[176:179], a[216:219], a[24:27]
ds_read_b64_tr_b16 v[120:121], v31 offset:32768
ds_read_b64_tr_b16 v[122:123], v31 offset:34816
M a[24:27], v[180:183], a[220:223], a[24:27]
ds_read_b64_tr_b16 v[124:125], v31 offset:36864
ds_read_b64_tr_b16 v[126:127], v31 offset:38912
M a[28:31], v[188:191], a[220:223], a[28:31]
M a[28:31], v[184:187], a[216:219], a[28:31]
s_waitcnt vmcnt(29) lgkmcnt(0)
s_barrier
M a[0:3], v[96:99], a[224:227], a[0:3]
s_add_u32 m0, s42, 49152
s_nop 0
buffer_load_dwordx4 v6, s[48:51], s26 offen offset:0 lds
ds_read_b64_tr_b16 v[160:161], v28 offset:49152
ds_read_b64_tr_b16 v[162:163], v28 offset:51200
M a[0:3], v[100:103], a[228:231], a[0:3]
buffer_load_dwordx4 v7, s[48:51], s26 offen offset:1024 lds
M a[4:7], v[108:111], a[228:231], a[4:7]
ds_read_b64_tr_b16 v[164:165], v28 offset:53248
ds_read_b64_tr_b16 v[166:167], v28 offset:55296
M a[4:7], v[104:107], a[224:227], a[4:7]
buffer_load_dwordx4 a[176:179], v1, s[44:47], s25 offen offset:0 sc1
M a[8:11], v[112:115], a[224:227], a[8:11]
ds_read_b64_tr_b16 v[168:169], v29 offset:49152
ds_read_b64_tr_b16 v[170:171], v29 offset:51200
M a[8:11], v[116:119], a[228:231], a[8:11]
buffer_load_dwordx4 a[180:183], v1, s[44:47], s25 offen offset:1024 sc1
M a[12:15], v[124:127], a[228:231], a[12:15]
ds_read_b64_tr_b16 v[172:173], v29 offset:53248
ds_read_b64_tr_b16 v[174:175], v29 offset:55296
M a[12:15], v[120:123], a[224:227], a[12:15]
buffer_load_dwordx4 a[184:187], v1, s[44:47], s25 offen offset:2048 sc1
ds_read_b64_tr_b16 v[176:177], v30 offset:49152
ds_read_b64_tr_b16 v[178:179], v30 offset:51200
M a[16:19], v[96:99], a[232:235], a[16:19]
buffer_load_dwordx4 a[188:191], v1, s[44:47], s25 offen offset:3072 sc1
M a[16:19], v[100:103], a[236:239], a[16:19]
ds_read_b64_tr_b16 v[180:181], v30 offset:53248
ds_read_b64_tr_b16 v[182:183], v30 offset:55296
M a[20:23], v[108:111], a[236:239], a[20:23]
s_add_u32 s25, s25, 16384
s_add_u32 s26, s26, 131072
M a[20:23], v[104:107], a[232:235], a[20:23]
ds_read_b64_tr_b16 v[184:185], v31 offset:49152
ds_read_b64_tr_b16 v[186:187], v31 offset:51200
M a[24:27], v[112:115], a[232:235], a[24:27]
buffer_load_dword v252, v255, s[52:55], s62 offen sc1
M a[24:27], v[116:119], a[236:239], a[24:27]
ds_read_b64_tr_b16 v[188:189], v31 offset:53248
ds_read_b64_tr_b16 v[190:191], v31 offset:55296
M a[28:31], v[124:127], a[236:239], a[28:31]
M a[28:31], v[120:123], a[232:235], a[28:31]
s_waitcnt vmcnt(30) lgkmcnt(0)
s_barrier
s_waitcnt vmcnt(0)
v_cmp_ne_u32 vcc, 1, v252
s_nop 0
s_cbranch_vccnz Lk3_spinft
Lk3_gotft:
M a[0:3], v[160:163], a[240:243], a[0:3]
s_mov_b32 s32, s25
s_mov_b32 s33, s26
s_mov_b64 s[34:35], s[44:45]
s_mov_b64 s[36:37], s[48:49]
s_mov_b64 s[44:45], s[8:9]
s_mov_b32 s46, 16777216
s_mov_b64 s[48:49], s[10:11]
s_mov_b32 s50, 8388608
s_mov_b32 s25, s12
s_mov_b32 s26, s13
s_add_u32 m0, s41, 65536
s_nop 0
buffer_load_dwordx4 v2, s[48:51], s26 offen offset:0 lds
ds_read_b64_tr_b16 v[96:97], v24 offset:0
ds_read_b64_tr_b16 v[98:99], v24 offset:2048
M a[0:3], v[164:167], a[244:247], a[0:3]
buffer_load_dwordx4 v3, s[48:51], s26 offen offset:1024 lds
M a[4:7], v[172:175], a[244:247], a[4:7]
ds_read_b64_tr_b16 v[100:101], v24 offset:4096
ds_read_b64_tr_b16 v[102:103], v24 offset:6144
M a[4:7], v[168:171], a[240:243], a[4:7]
buffer_load_dwordx4 v4, s[48:51], s26 offen offset:2048 lds
ds_read_b64_tr_b16 v[104:105], v25 offset:0
ds_read_b64_tr_b16 v[106:107], v25 offset:2048
M a[8:11], v[176:179], a[240:243], a[8:11]
buffer_load_dwordx4 v5, s[48:51], s26 offen offset:3072 lds
M a[8:11], v[180:183], a[244:247], a[8:11]
ds_read_b64_tr_b16 v[108:109], v25 offset:4096
ds_read_b64_tr_b16 v[110:111], v25 offset:6144
M a[12:15], v[188:191], a[244:247], a[12:15]
buffer_load_dwordx4 a[192:195], v1, s[44:47], s25 offen offset:0 sc1
M a[12:15], v[184:187], a[240:243], a[12:15]
ds_read_b64_tr_b16 v[112:113], v26 offset:0
ds_read_b64_tr_b16 v[114:115], v26 offset:2048
buffer_load_dwordx4 a[196:199], v1, s[44:47], s25 offen offset:1024 sc1
M a[16:19], v[160:163], a[248:251], a[16:19]
ds_read_b64_tr_b16 v[116:117], v26 offset:4096
ds_read_b64_tr_b16 v[118:119], v26 offset:6144
M a[16:19], v[164:167], a[252:255], a[16:19]
buffer_load_dwordx4 a[200:203], v1, s[44:47], s25 offen offset:2048 sc1
M a[20:23], v[172:175], a[252:255], a[20:23]
ds_read_b64_tr_b16 v[120:121], v27 offset:0
ds_read_b64_tr_b16 v[122:123], v27 offset:2048
buffer_load_dwordx4 a[204:207], v1, s[44:47], s25 offen offset:3072 sc1
M a[20:23], v[168:171], a[248:251], a[20:23]
ds_read_b64_tr_b16 v[124:125], v27 offset:4096
ds_read_b64_tr_b16 v[126:127], v27 offset:6144
M a[24:27], v[176:179], a[248:251], a[24:27]
s_sub_u32 s39, s39, 1
s_cmp_eq_u32 s39, 0
s_cselect_b32 s3, s64, s65
M a[24:27], v[180:183], a[252:255], a[24:27]
s_add_u32 s25, s25, s3
s_lshl_b32 s3, s3, 3
s_add_u32 s26, s26, s3
M a[28:31], v[188:191], a[252:255], a[28:31]
M a[28:31], v[184:187], a[248:251], a[28:31]
s_waitcnt vmcnt(24) lgkmcnt(0)
s_barrier
M a[0:3], v[96:99], a[128:131], a[0:3]
s_add_u32 m0, s41, 81920
s_nop 0
buffer_load_dwordx4 v2, s[48:51], s26 offen offset:0 lds
ds_read_b64_tr_b16 v[160:161], v24 offset:16384
ds_read_b64_tr_b16 v[162:163], v24 offset:18432
M a[0:3], v[100:103], a[132:135], a[0:3]
buffer_load_dwordx4 v3, s[48:51], s26 offen offset:1024 lds
M a[4:7], v[108:111], a[132:135], a[4:7]
ds_read_b64_tr_b16 v[164:165], v24 offset:20480
ds_read_b64_tr_b16 v[166:167], v24 offset:22528
M a[4:7], v[104:107], a[128:131], a[4:7]
buffer_load_dwordx4 v4, s[48:51], s26 offen offset:2048 lds
ds_read_b64_tr_b16 v[168:169], v25 offset:16384
ds_read_b64_tr_b16 v[170:171], v25 offset:18432
M a[8:11], v[112:115], a[128:131], a[8:11]
buffer_load_dwordx4 v5, s[48:51], s26 offen offset:3072 lds
M a[8:11], v[116:119], a[132:135], a[8:11]
ds_read_b64_tr_b16 v[172:173], v25 offset:20480
ds_read_b64_tr_b16 v[174:175], v25 offset:22528
M a[12:15], v[124:127], a[132:135], a[12:15]
buffer_load_dwordx4 a[208:211], v1, s[44:47], s25 offen offset:0 sc1
M a[12:15], v[120:123], a[128:131], a[12:15]
ds_read_b64_tr_b16 v[176:177], v26 offset:16384
ds_read_b64_tr_b16 v[178:179], v26 offset:18432
buffer_load_dwordx4 a[212:215], v1, s[44:47], s25 offen offset:1024 sc1
M a[16:19], v[96:99], a[136:139], a[16:19]
ds_read_b64_tr_b16 v[180:181], v26 offset:20480
ds_read_b64_tr_b16 v[182:183], v26 offset:22528
M a[16:19], v[100:103], a[140:143], a[16:19]
buffer_load_dwordx4 a[216:219], v1, s[44:47], s25 offen offset:2048 sc1
M a[20:23], v[108:111], a[140:143], a[20:23]
ds_read_b64_tr_b16 v[184:185], v27 offset:16384
ds_read_b64_tr_b16 v[186:187], v27 offset:18432
buffer_load_dwordx4 a[220:223], v1, s[44:47], s25 offen offset:3072 sc1
M a[20:23], v[104:107], a[136:139], a[20:23]
ds_read_b64_tr_b16 v[188:189], v27 offset:20480
ds_read_b64_tr_b16 v[190:191], v27 offset:22528
M a[24:27], v[112:115], a[136:139], a[24:27]
s_sub_u32 s39, s39, 1
s_cmp_eq_u32 s39, 0
s_cselect_b32 s3, s64, s65
M a[24:27], v[116:119], a[140:143], a[24:27]
s_add_u32 s25, s25, s3
s_lshl_b32 s3, s3, 3
s_add_u32 s26, s26, s3
M a[28:31], v[124:127], a[140:143], a[28:31]
M a[28:31], v[120:123], a[136:139], a[28:31]
s_waitcnt vmcnt(23) lgkmcnt(0)
s_barrier
M a[0:3], v[160:163], a[144:147], a[0:3]
s_add_u32 m0, s41, 98304
s_nop 0
buffer_load_dwordx4 v2, s[48:51], s26 offen offset:0 lds
ds_read_b64_tr_b16 v[96:97], v24 offset:32768
ds_read_b64_tr_b16 v[98:99], v24 offset:34816
M a[0:3], v[164:167], a[148:151], a[0:3]
buffer_load_dwordx4 v3, s[48:51], s26 offen offset:1024 lds
M a[4:7], v[172:175], a[148:151], a[4:7]
ds_read_b64_tr_b16 v[100:101], v24 offset:36864
ds_read_b64_tr_b16 v[102:103], v24 offset:38912
M a[4:7], v[168:171], a[144:147], a[4:7]
buffer_load_dwordx4 v4, s[48:51], s26 offen offset:2048 lds
ds_read_b64_tr_b16 v[104:105], v25 offset:32768
ds_read_b64_tr_b16 v[106:107], v25 offset:34816
M a[8:11], v[176:179], a[144:147], a[8:11]
buffer_load_dwordx4 v5, s[48:51], s26 offen offset:3072 lds
M a[8:11], v[180:183], a[148:151], a[8:11]
ds_read_b64_tr_b16 v[108:109], v25 offset:36864
ds_read_b64_tr_b16 v[110:111], v25 offset:38912
M a[12:15], v[188:191], a[148:151], a[12:15]
buffer_load_dwordx4 a[224:227], v1, s[44:47], s25 offen offset:0 sc1
M a[12:15], v[184:187], a[144:147], a[12:15]
ds_read_b64_tr_b16 v[112:113], v26 offset:32768
ds_read_b64_tr_b16 v[114:115], v26 offset:34816
buffer_load_dwordx4 a[228:231], v1, s[44:47], s25 offen offset:1024 sc1
M a[16:19], v[160:163], a[152:155], a[16:19]
ds_read_b64_tr_b16 v[116:117], v26 offset:36864
ds_read_b64_tr_b16 v[118:119], v26 offset:38912
M a[16:19], v[164:167], a[156:159], a[16:19]
buffer_load_dwordx4 a[232:235], v1, s[44:47], s25 offen offset:2048 sc1
M a[20:23], v[172:175], a[156:159], a[20:23]
ds_read_b64_tr_b16 v[120:121], v27 offset:32768
ds_read_b64_tr_b16 v[122:123], v27 offset:34816
buffer_load_dwordx4 a[236:239], v1, s[44:47], s25 offen offset:3072 sc1
M a[20:23], v[168:171], a[152:155], a[20:23]
ds_read_b64_tr_b16 v[124:125], v27 offset:36864
ds_read_b64_tr_b16 v[126:127], v27 offset:38912
M a[24:27], v[176:179], a[152:155], a[24:27]
s_sub_u32 s39, s39, 1
s_cmp_eq_u32 s39, 0
s_cselect_b32 s3, s64, s65
M a[24:27], v[180:183], a[156:159], a[24:27]
s_add_u32 s25, s25, s3
s_lshl_b32 s3, s3, 3
s_add_u32 s26, s26, s3
M a[28:31], v[188:191], a[156:159], a[28:31]
M a[28:31], v[184:187], a[152:155], a[28:31]
s_waitcnt vmcnt(25) lgkmcnt(0)
s_barrier
M a[0:3], v[96:99], a[160:163], a[0:3]
s_add_u32 m0, s41, 114688
s_nop 0
buffer_load_dwordx4 v2, s[48:51], s26 offen offset:0 lds
ds_read_b64_tr_b16 v[160:161], v24 offset:49152
ds_read_b64_tr_b16 v[162:163], v24 offset:51200
M a[0:3], v[100:103], a[164:167], a[0:3]
buffer_load_dwordx4 v3, s[48:51], s26 offen offset:1024 lds
M a[4:7], v[108:111], a[164:167], a[4:7]
ds_read_b64_tr_b16 v[164:165], v24 offset:53248
ds_read_b64_tr_b16 v[166:167], v24 offset:55296
M a[4:7], v[104:107], a[160:163], a[4:7]
buffer_load_dwordx4 v4, s[48:51], s26 offen offset:2048 lds
ds_read_b64_tr_b16 v[168:169], v25 offset:49152
ds_read_b64_tr_b16 v[170:171], v25 offset:51200
M a[8:11], v[112:115], a[160:163], a[8:11]
buffer_load_dwordx4 v5, s[48:51], s26 offen offset:3072 lds
M a[8:11], v[116:119], a[164:167], a[8:11]
ds_read_b64_tr_b16 v[172:173], v25 offset:53248
ds_read_b64_tr_b16 v[174:175], v25 offset:55296
M a[12:15], v[124:127], a[164:167], a[12:15]
buffer_load_dwordx4 a[240:243], v1, s[44:47], s25 offen offset:0 sc1
M a[12:15], v[120:123], a[160:163], a[12:15]
ds_read_b64_tr_b16 v[176:177], v26 offset:49152
ds_read_b64_tr_b16 v[178:179], v26 offset:51200
buffer_load_dwordx4 a[244:247], v1, s[44:47], s25 offen offset:1024 sc1
M a[16:19], v[96:99], a[168:171], a[16:19]
ds_read_b64_tr_b16 v[180:181], v26 offset:53248
ds_read_b64_tr_b16 v[182:183], v26 offset:55296
M a[16:19], v[100:103], a[172:175], a[16:19]
buffer_load_dwordx4 a[248:251], v1, s[44:47], s25 offen offset:2048 sc1
M a[20:23], v[108:111], a[172:175], a[20:23]
ds_read_b64_tr_b16 v[184:185], v27 offset:49152
ds_read_b64_tr_b16 v[186:187], v27 offset:51200
buffer_load_dwordx4 a[252:255], v1, s[44:47], s25 offen offset:3072 sc1
M a[20:23], v[104:107], a[168:171], a[20:23]
ds_read_b64_tr_b16 v[188:189], v27 offset:53248
ds_read_b64_tr_b16 v[190:191], v27 offset:55296
M a[24:27], v[112:115], a[168:171], a[24:27]
s_sub_u32 s39, s39, 1
s_cmp_eq_u32 s39, 0
s_cselect_b32 s3, s64, s65
M a[24:27], v[116:119], a[172:175], a[24:27]
s_add_u32 s25, s25, s3
s_lshl_b32 s3, s3, 3
s_add_u32 s26, s26, s3
M a[28:31], v[124:127], a[172:175], a[28:31]
M a[28:31], v[120:123], a[168:171], a[28:31]
s_waitcnt vmcnt(24) lgkmcnt(0)
s_barrier
M a[0:3], v[160:163], a[176:179], a[0:3]
s_add_u32 m0, s41, 0
s_nop 0
buffer_load_dwordx4 v2, s[48:51], s26 offen offset:0 lds
ds_read_b64_tr_b16 v[96:97], v16 offset:0
ds_read_b64_tr_b16 v[98:99], v16 offset:4096
M a[0:3], v[164:167], a[180:183], a[0:3]
buffer_load_dwordx4 v3, s[48:51], s26 offen offset:1024 lds
ds_read_b64_tr_b16 v[100:101], v16 offset:8192
ds_read_b64_tr_b16 v[102:103], v16 offset:12288
M a[4:7], v[172:175], a[180:183], a[4:7]
buffer_load_dwordx4 v4, s[48:51], s26 offen offset:2048 lds
ds_read_b64_tr_b16 v[104:105], v17 offset:0
ds_read_b64_tr_b16 v[106:107], v17 offset:4096
M a[4:7], v[168:171], a[176:179], a[4:7]
buffer_load_dwordx4 v5, s[48:51], s26 offen offset:3072 lds
ds_read_b64_tr_b16 v[108:109], v17 offset:8192
ds_read_b64_tr_b16 v[110:111], v17 offset:12288
M a[8:11], v[176:179], a[176:179], a[8:11]
buffer_load_dwordx4 a[128:131], v1, s[44:47], s25 offen offset:0 sc1
ds_read_b64_tr_b16 v[112:113], v18 offset:0
ds_read_b64_tr_b16 v[114:115], v18 offset:4096
M a[8:11], v[180:183], a[180:183], a[8:11]
buffer_load_dwordx4 a[132:135], v1, s[44:47], s25 offen offset:1024 sc1
ds_read_b64_tr_b16 v[116:117], v18 offset:8192
ds_read_b64_tr_b16 v[118:119], v18 offset:12288
M a[12:15], v[188:191], a[180:183], a[12:15]
buffer_load_dwordx4 a[136:139], v1, s[44:47], s25 offen offset:2048 sc1
M a[12:15], v[184:187], a[176:179], a[12:15]
ds_read_b64_tr_b16 v[120:121], v19 offset:0
ds_read_b64_tr_b16 v[122:123], v19 offset:4096
buffer_load_dwordx4 a[140:143], v1, s[44:47], s25 offen offset:3072 sc1
M a[16:19], v[160:163], a[184:187], a[16:19]
ds_read_b64_tr_b16 v[124:125], v19 offset:8192
ds_read_b64_tr_b16 v[126:127], v19 offset:12288
s_sub_u32 s39, s39, 1
s_cmp_eq_u32 s39, 0
s_cselect_b32 s3, s64, s65
M a[16:19], v[164:167], a[188:191], a[16:19]
ds_read_b64_tr_b16 v[128:129], v20 offset:0
ds_read_b64_tr_b16 v[130:131], v20 offset:4096
s_add_u32 s25, s25, s3
s_lshl_b32 s3, s3, 3
s_add_u32 s26, s26, s3
M a[20:23], v[172:175], a[188:191], a[20:23]
ds_read_b64_tr_b16 v[132:133], v20 offset:8192
ds_read_b64_tr_b16 v[134:135], v20 offset:12288
ds_read_b64_tr_b16 v[136:137], v21 offset:0
ds_read_b64_tr_b16 v[138:139], v21 offset:4096
M a[20:23], v[168:171], a[184:187], a[20:23]
ds_read_b64_tr_b16 v[140:141], v21 offset:8192
ds_read_b64_tr_b16 v[142:143], v21 offset:12288
ds_read_b64_tr_b16 v[144:145], v22 offset:0
ds_read_b64_tr_b16 v[146:147], v22 offset:4096
M a[24:27], v[176:179], a[184:187], a[24:27]
ds_read_b64_tr_b16 v[148:149], v22 offset:8192
ds_read_b64_tr_b16 v[150:151], v22 offset:12288
ds_read_b64_tr_b16 v[152:153], v23 offset:0
ds_read_b64_tr_b16 v[154:155], v23 offset:4096
M a[24:27], v[180:183], a[188:191], a[24:27]
ds_read_b64_tr_b16 v[156:157], v23 offset:8192
ds_read_b64_tr_b16 v[158:159], v23 offset:12288
M a[28:31], v[188:191], a[188:191], a[28:31]
M a[28:31], v[184:187], a[184:187], a[28:31]
s_waitcnt vmcnt(24) lgkmcnt(0)
s_barrier
M v[32:35], v[96:99], a[192:195], 0
s_add_u32 m0, s41, 16384
s_nop 0
buffer_load_dwordx4 v2, s[48:51], s26 offen offset:0 lds
M v[32:35], v[100:103], a[196:199], v[32:35]
ds_read_b64_tr_b16 v[160:161], v16 offset:16384
ds_read_b64_tr_b16 v[162:163], v16 offset:20480
M v[36:39], v[108:111], a[196:199], 0
buffer_load_dwordx4 v3, s[48:51], s26 offen offset:1024 lds
M v[36:39], v[104:107], a[192:195], v[36:39]
ds_read_b64_tr_b16 v[164:165], v16 offset:24576
ds_read_b64_tr_b16 v[166:167], v16 offset:28672
M v[40:43], v[112:115], a[192:195], 0
buffer_load_dwordx4 v4, s[48:51], s26 offen offset:2048 lds
M v[40:43], v[116:119], a[196:199], v[40:43]
ds_read_b64_tr_b16 v[168:169], v17 offset:16384
ds_read_b64_tr_b16 v[170:171], v17 offset:20480
M v[44:47], v[124:127], a[196:199], 0
buffer_load_dwordx4 v5, s[48:51], s26 offen offset:3072 lds
M v[44:47], v[120:123], a[192:195], v[44:47]
M v[48:51], v[128:131], a[192:195], 0
ds_read_b64_tr_b16 v[172:173], v17 offset:24576
ds_read_b64_tr_b16 v[174:175], v17 offset:28672
M v[48:51], v[132:135], a[196:199], v[48:51]
buffer_load_dwordx4 a[144:147], v1, s[44:47], s25 offen offset:0 sc1
M v[52:55], v[140:143], a[196:199], 0
ds_read_b64_tr_b16 v[176:177], v18 offset:16384
ds_read_b64_tr_b16 v[178:179], v18 offset:20480
M v[52:55], v[136:139], a[192:195], v[52:55]
buffer_load_dwordx4 a[148:151], v1, s[44:47], s25 offen offset:1024 sc1
M v[56:59], v[144:147], a[192:195], 0
ds_read_b64_tr_b16 v[180:181], v18 offset:24576
ds_read_b64_tr_b16 v[182:183], v18 offset:28672
M v[56:59], v[148:151], a[196:199], v[56:59]
buffer_load_dwordx4 a[152:155], v1, s[44:47], s25 offen offset:2048 sc1
M v[60:63], v[156:159], a[196:199], 0
M v[60:63], v[152:155], a[192:195], v[60:63]
ds_read_b64_tr_b16 v[184:185], v19 offset:16384
ds_read_b64_tr_b16 v[186:187], v19 offset:20480
M v[64:67], v[96:99], a[200:203], 0
buffer_load_dwordx4 a[156:159], v1, s[44:47], s25 offen offset:3072 sc1
M v[64:67], v[100:103], a[204:207], v[64:67]
ds_read_b64_tr_b16 v[188:189], v19 offset:24576
ds_read_b64_tr_b16 v[190:191], v19 offset:28672
M v[68:71], v[108:111], a[204:207], 0
s_sub_u32 s39, s39, 1
s_cmp_eq_u32 s39, 0
s_cselect_b32 s3, s64, s65
M v[68:71], v[104:107], a[200:203], v[68:71]
ds_read_b64_tr_b16 v[192:193], v20 offset:16384
ds_read_b64_tr_b16 v[194:195], v20 offset:20480
M v[72:75], v[112:115], a[200:203], 0
s_add_u32 s25, s25, s3
s_lshl_b32 s3, s3, 3
s_add_u32 s26, s26, s3
M v[72:75], v[116:119], a[204:207], v[72:75]
ds_read_b64_tr_b16 v[196:197], v20 offset:24576
ds_read_b64_tr_b16 v[198:199], v20 offset:28672
M v[76:79], v[124:127], a[204:207], 0
M v[76:79], v[120:123], a[200:203], v[76:79]
ds_read_b64_tr_b16 v[200:201], v21 offset:16384
ds_read_b64_tr_b16 v[202:203], v21 offset:20480
M v[80:83], v[128:131], a[200:203], 0
ds_read_b64_tr_b16 v[204:205], v21 offset:24576
ds_read_b64_tr_b16 v[206:207], v21 offset:28672
M v[80:83], v[132:135], a[204:207], v[80:83]
ds_read_b64_tr_b16 v[208:209], v22 offset:16384
ds_read_b64_tr_b16 v[210:211], v22 offset:20480
M v[84:87], v[140:143], a[204:207], 0
ds_read_b64_tr_b16 v[212:213], v22 offset:24576
ds_read_b64_tr_b16 v[214:215], v22 offset:28672
M v[84:87], v[136:139], a[200:203], v[84:87]
ds_read_b64_tr_b16 v[216:217], v23 offset:16384
ds_read_b64_tr_b16 v[218:219], v23 offset:20480
M v[88:91], v[144:147], a[200:203], 0
ds_read_b64_tr_b16 v[220:221], v23 offset:24576
ds_read_b64_tr_b16 v[222:223], v23 offset:28672
M v[88:91], v[148:151], a[204:207], v[88:91]
M v[92:95], v[156:159], a[204:207], 0
M v[92:95], v[152:155], a[200:203], v[92:95]
s_mov_b32 s28, 3
Lk3_la:
s_waitcnt vmcnt(24) lgkmcnt(0)
s_barrier
M v[32:35], v[160:163], a[208:211], v[32:35]
s_add_u32 m0, s41, 32768
s_nop 0
buffer_load_dwordx4 v2, s[48:51], s26 offen offset:0 lds
M v[32:35], v[164:167], a[212:215], v[32:35]
ds_read_b64_tr_b16 v[96:97], v16 offset:32768
ds_read_b64_tr_b16 v[98:99], v16 offset:36864
M v[36:39], v[172:175], a[212:215], v[36:39]
buffer_load_dwordx4 v3, s[48:51], s26 offen offset:1024 lds
M v[36:39], v[168:171], a[208:211], v[36:39]
ds_read_b64_tr_b16 v[100:101], v16 offset:40960
ds_read_b64_tr_b16 v[102:103], v16 offset:45056
M v[40:43], v[176:179], a[208:211], v[40:43]
buffer_load_dwordx4 v4, s[48:51], s26 offen offset:2048 lds
M v[40:43], v[180:183], a[212:215], v[40:43]
ds_read_b64_tr_b16 v[104:105], v17 offset:32768
ds_read_b64_tr_b16 v[106:107], v17 offset:36864
M v[44:47], v[188:191], a[212:215], v[44:47]
buffer_load_dwordx4 v5, s[48:51], s26 offen offset:3072 lds
M v[44:47], v[184:187], a[208:211], v[44:47]
M v[48:51], v[192:195], a[208:211], v[48:51]
ds_read_b64_tr_b16 v[108:109], v17 offset:40960
ds_read_b64_tr_b16 v[110:111], v17 offset:45056
M v[48:51], v[196:199], a[212:215], v[48:51]
buffer_load_dwordx4 a[160:163], v1, s[44:47], s25 offen offset:0 sc1
M v[52:55], v[204:207], a[212:215], v[52:55]
ds_read_b64_tr_b16 v[112:113], v18 offset:32768
ds_read_b64_tr_b16 v[114:115], v18 offset:36864
M v[52:55], v[200:203], a[208:211], v[52:55]
buffer_load_dwordx4 a[164:167], v1, s[44:47], s25 offen offset:1024 sc1
M v[56:59], v[208:211], a[208:211], v[56:59]
ds_read_b64_tr_b16 v[116:117], v18 offset:40960
ds_read_b64_tr_b16 v[118:119], v18 offset:45056
M v[56:59], v[212:215], a[212:215], v[56:59]
buffer_load_dwordx4 a[168:171], v1, s[44:47], s25 offen offset:2048 sc1
M v[60:63], v[220:223], a[212:215], v[60:63]
M v[60:63], v[216:219], a[208:211], v[60:63]
ds_read_b64_tr_b16 v[120:121], v19 offset:32768
ds_read_b64_tr_b16 v[122:123], v19 offset:36864
M v[64:67], v[160:163], a[216:219], v[64:67]
buffer_load_dwordx4 a[172:175], v1, s[44:47], s25 offen offset:3072 sc1
M v[64:67], v[164:167], a[220:223], v[64:67]
ds_read_b64_tr_b16 v[124:125], v19 offset:40960
ds_read_b64_tr_b16 v[126:127], v19 offset:45056
M v[68:71], v[172:175], a[220:223], v[68:71]
s_sub_u32 s39, s39, 1
s_cmp_eq_u32 s39, 0
s_cselect_b32 s3, s64, s65
M v[68:71], v[168:171], a[216:219], v[68:71]
ds_read_b64_tr_b16 v[128:129], v20 offset:32768
ds_read_b64_tr_b16 v[130:131], v20 offset:36864
M v[72:75], v[176:179], a[216:219], v[72:75]
s_add_u32 s25, s25, s3
s_lshl_b32 s3, s3, 3
s_add_u32 s26, s26, s3
M v[72:75], v[180:183], a[220:223], v[72:75]
ds_read_b64_tr_b16 v[132:133], v20 offset:40960
ds_read_b64_tr_b16 v[134:135], v20 offset:45056
M v[76:79], v[188:191], a[220:223], v[76:79]
M v[76:79], v[184:187], a[216:219], v[76:79]
ds_read_b64_tr_b16 v[136:137], v21 offset:32768
ds_read_b64_tr_b16 v[138:139], v21 offset:36864
M v[80:83], v[192:195], a[216:219], v[80:83]
ds_read_b64_tr_b16 v[140:141], v21 offset:40960
ds_read_b64_tr_b16 v[142:143], v21 offset:45056
M v[80:83], v[196:199], a[220:223], v[80:83]
ds_read_b64_tr_b16 v[144:145], v22 offset:32768
ds_read_b64_tr_b16 v[146:147], v22 offset:36864
M v[84:87], v[204:207], a[220:223], v[84:87]
ds_read_b64_tr_b16 v[148:149], v22 offset:40960
ds_read_b64_tr_b16 v[150:151], v22 offset:45056
M v[84:87], v[200:203], a[216:219], v[84:87]
ds_read_b64_tr_b16 v[152:153], v23 offset:32768
ds_read_b64_tr_b16 v[154:155], v23 offset:36864
M v[88:91], v[208:211], a[216:219], v[88:91]
ds_read_b64_tr_b16 v[156:157], v23 offset:40960
ds_read_b64_tr_b16 v[158:159], v23 offset:45056
M v[88:91], v[212:215], a[220:223], v[88:91]
M v[92:95], v[220:223], a[220:223], v[92:95]
M v[92:95], v[216:219], a[216:219], v[92:95]
s_waitcnt vmcnt(24) lgkmcnt(0)
s_barrier
M v[32:35], v[96:99], a[224:227], v[32:35]
s_add_u32 m0, s41, 49152
s_nop 0
buffer_load_dwordx4 v2, s[48:51], s26 offen offset:0 lds
M v[32:35], v[100:103], a[228:231], v[32:35]
ds_read_b64_tr_b16 v[160:161], v16 offset:49152
ds_read_b64_tr_b16 v[162:163], v16 offset:53248
M v[36:39], v[108:111], a[228:231], v[36:39]
buffer_load_dwordx4 v3, s[48:51], s26 offen offset:1024 lds
M v[36:39], v[104:107], a[224:227], v[36:39]
ds_read_b64_tr_b16 v[164:165], v16 offset:57344
ds_read_b64_tr_b16 v[166:167], v16 offset:61440
M v[40:43], v[112:115], a[224:227], v[40:43]
buffer_load_dwordx4 v4, s[48:51], s26 offen offset:2048 lds
M v[40:43], v[116:119], a[228:231], v[40:43]
ds_read_b64_tr_b16 v[168:169], v17 offset:49152
ds_read_b64_tr_b16 v[170:171], v17 offset:53248
M v[44:47], v[124:127], a[228:231], v[44:47]
buffer_load_dwordx4 v5, s[48:51], s26 offen offset:3072 lds
M v[44:47], v[120:123], a[224:227], v[44:47]
M v[48:51], v[128:131], a[224:227], v[48:51]
ds_read_b64_tr_b16 v[172:173], v17 offset:57344
ds_read_b64_tr_b16 v[174:175], v17 offset:61440
M v[48:51], v[132:135], a[228:231], v[48:51]
buffer_load_dwordx4 a[176:179], v1, s[44:47], s25 offen offset:0 sc1
M v[52:55], v[140:143], a[228:231], v[52:55]
ds_read_b64_tr_b16 v[176:177], v18 offset:49152
ds_read_b64_tr_b16 v[178:179], v18 offset:53248
M v[52:55], v[136:139], a[224:227], v[52:55]
buffer_load_dwordx4 a[180:183], v1, s[44:47], s25 offen offset:1024 sc1
M v[56:59], v[144:147], a[224:227], v[56:59]
ds_read_b64_tr_b16 v[180:181], v18 offset:57344
ds_read_b64_tr_b16 v[182:183], v18 offset:61440
M v[56:59], v[148:151], a[228:231], v[56:59]
buffer_load_dwordx4 a[184:187], v1, s[44:47], s25 offen offset:2048 sc1
M v[60:63], v[156:159], a[228:231], v[60:63]
M v[60:63], v[152:155], a[224:227], v[60:63]
ds_read_b64_tr_b16 v[184:185], v19 offset:49152
ds_read_b64_tr_b16 v[186:187], v19 offset:53248
M v[64:67], v[96:99], a[232:235], v[64:67]
buffer_load_dwordx4 a[188:191], v1, s[44:47], s25 offen offset:3072 sc1
M v[64:67], v[100:103], a[236:239], v[64:67]
ds_read_b64_tr_b16 v[188:189], v19 offset:57344
ds_read_b64_tr_b16 v[190:191], v19 offset:61440
M v[68:71], v[108:111], a[236:239], v[68:71]
s_sub_u32 s39, s39, 1
s_cmp_eq_u32 s39, 0
s_cselect_b32 s3, s64, s65
M v[68:71], v[104:107], a[232:235], v[68:71]
ds_read_b64_tr_b16 v[192:193], v20 offset:49152
ds_read_b64_tr_b16 v[194:195], v20 offset:53248
M v[72:75], v[112:115], a[232:235], v[72:75]
s_add_u32 s25, s25, s3
s_lshl_b32 s3, s3, 3
s_add_u32 s26, s26, s3
M v[72:75], v[116:119], a[236:239], v[72:75]
ds_read_b64_tr_b16 v[196:197], v20 offset:57344
ds_read_b64_tr_b16 v[198:199], v20 offset:61440
M v[76:79], v[124:127], a[236:239], v[76:79]
M v[76:79], v[120:123], a[232:235], v[76:79]
ds_read_b64_tr_b16 v[200:201], v21 offset:49152
ds_read_b64_tr_b16 v[202:203], v21 offset:53248
M v[80:83], v[128:131], a[232:235], v[80:83]
ds_read_b64_tr_b16 v[204:205], v21 offset:57344
ds_read_b64_tr_b16 v[206:207], v21 offset:61440
M v[80:83], v[132:135], a[236:239], v[80:83]
ds_read_b64_tr_b16 v[208:209], v22 offset:49152
ds_read_b64_tr_b16 v[210:211], v22 offset:53248
M v[84:87], v[140:143], a[236:239], v[84:87]
ds_read_b64_tr_b16 v[212:213], v22 offset:57344
ds_read_b64_tr_b16 v[214:215], v22 offset:61440
M v[84:87], v[136:139], a[232:235], v[84:87]
ds_read_b64_tr_b16 v[216:217], v23 offset:49152
ds_read_b64_tr_b16 v[218:219], v23 offset:53248
M v[88:91], v[144:147], a[232:235], v[88:91]
ds_read_b64_tr_b16 v[220:221], v23 offset:57344
ds_read_b64_tr_b16 v[222:223], v23 offset:61440
M v[88:91], v[148:151], a[236:239], v[88:91]
M v[92:95], v[156:159], a[236:239], v[92:95]
M v[92:95], v[152:155], a[232:235], v[92:95]
s_waitcnt vmcnt(24) lgkmcnt(0)
s_barrier
M v[32:35], v[160:163], a[240:243], v[32:35]
s_add_u32 m0, s41, 65536
s_nop 0
buffer_load_dwordx4 v2, s[48:51], s26 offen offset:0 lds
M v[32:35], v[164:167], a[244:247], v[32:35]
ds_read_b64_tr_b16 v[96:97], v8 offset:0
ds_read_b64_tr_b16 v[98:99], v8 offset:4096
M v[36:39], v[172:175], a[244:247], v[36:39]
buffer_load_dwordx4 v3, s[48:51], s26 offen offset:1024 lds
M v[36:39], v[168:171], a[240:243], v[36:39]
ds_read_b64_tr_b16 v[100:101], v8 offset:8192
ds_read_b64_tr_b16 v[102:103], v8 offset:12288
M v[40:43], v[176:179], a[240:243], v[40:43]
buffer_load_dwordx4 v4, s[48:51], s26 offen offset:2048 lds
M v[40:43], v[180:183], a[244:247], v[40:43]
ds_read_b64_tr_b16 v[104:105], v9 offset:0
ds_read_b64_tr_b16 v[106:107], v9 offset:4096
M v[44:47], v[188:191], a[244:247], v[44:47]
buffer_load_dwordx4 v5, s[48:51], s26 offen offset:3072 lds
M v[44:47], v[184:187], a[240:243], v[44:47]
M v[48:51], v[192:195], a[240:243], v[48:51]
ds_read_b64_tr_b16 v[108:109], v9 offset:8192
ds_read_b64_tr_b16 v[110:111], v9 offset:12288
M v[48:51], v[196:199], a[244:247], v[48:51]
buffer_load_dwordx4 a[192:195], v1, s[44:47], s25 offen offset:0 sc1
M v[52:55], v[204:207], a[244:247], v[52:55]
ds_read_b64_tr_b16 v[112:113], v10 offset:0
ds_read_b64_tr_b16 v[114:115], v10 offset:4096
M v[52:55], v[200:203], a[240:243], v[52:55]
buffer_load_dwordx4 a[196:199], v1, s[44:47], s25 offen offset:1024 sc1
M v[56:59], v[208:211], a[240:243], v[56:59]
ds_read_b64_tr_b16 v[116:117], v10 offset:8192
ds_read_b64_tr_b16 v[118:119], v10 offset:12288
M v[56:59], v[212:215], a[244:247], v[56:59]
buffer_load_dwordx4 a[200:203], v1, s[44:47], s25 offen offset:2048 sc1
M v[60:63], v[220:223], a[244:247], v[60:63]
M v[60:63], v[216:219], a[240:243], v[60:63]
ds_read_b64_tr_b16 v[120:121], v11 offset:0
ds_read_b64_tr_b16 v[122:123], v11 offset:4096
M v[64:67], v[160:163], a[248:251], v[64:67]
buffer_load_dwordx4 a[204:207], v1, s[44:47], s25 offen offset:3072 sc1
M v[64:67], v[164:167], a[252:255], v[64:67]
ds_read_b64_tr_b16 v[124:125], v11 offset:8192
ds_read_b64_tr_b16 v[126:127], v11 offset:12288
M v[68:71], v[172:175], a[252:255], v[68:71]
s_sub_u32 s39, s39, 1
s_cmp_eq_u32 s39, 0
s_cselect_b32 s3, s64, s65
M v[68:71], v[168:171], a[248:251], v[68:71]
ds_read_b64_tr_b16 v[128:129], v12 offset:0
ds_read_b64_tr_b16 v[130:131], v12 offset:4096
M v[72:75], v[176:179], a[248:251], v[72:75]
s_add_u32 s25, s25, s3
s_lshl_b32 s3, s3, 3
s_add_u32 s26, s26, s3
M v[72:75], v[180:183], a[252:255], v[72:75]
ds_read_b64_tr_b16 v[132:133], v12 offset:8192
ds_read_b64_tr_b16 v[134:135], v12 offset:12288
M v[76:79], v[188:191], a[252:255], v[76:79]
M v[76:79], v[184:187], a[248:251], v[76:79]
ds_read_b64_tr_b16 v[136:137], v13 offset:0
ds_read_b64_tr_b16 v[138:139], v13 offset:4096
M v[80:83], v[192:195], a[248:251], v[80:83]
ds_read_b64_tr_b16 v[140:141], v13 offset:8192
ds_read_b64_tr_b16 v[142:143], v13 offset:12288
M v[80:83], v[196:199], a[252:255], v[80:83]
ds_read_b64_tr_b16 v[144:145], v14 offset:0
ds_read_b64_tr_b16 v[146:147], v14 offset:4096
M v[84:87], v[204:207], a[252:255], v[84:87]
ds_read_b64_tr_b16 v[148:149], v14 offset:8192
ds_read_b64_tr_b16 v[150:151], v14 offset:12288
M v[84:87], v[200:203], a[248:251], v[84:87]
ds_read_b64_tr_b16 v[152:153], v15 offset:0
ds_read_b64_tr_b16 v[154:155], v15 offset:4096
M v[88:91], v[208:211], a[248:251], v[88:91]
ds_read_b64_tr_b16 v[156:157], v15 offset:8192
ds_read_b64_tr_b16 v[158:159], v15 offset:12288
M v[88:91], v[212:215], a[252:255], v[88:91]
M v[92:95], v[220:223], a[252:255], v[92:95]
M v[92:95], v[216:219], a[248:251], v[92:95]
s_waitcnt vmcnt(24) lgkmcnt(0)
s_barrier
M v[32:35], v[96:99], a[128:131], v[32:35]
s_add_u32 m0, s41, 81920
s_nop 0
buffer_load_dwordx4 v2, s[48:51], s26 offen offset:0 lds
M v[32:35], v[100:103], a[132:135], v[32:35]
ds_read_b64_tr_b16 v[160:161], v8 offset:16384
ds_read_b64_tr_b16 v[162:163], v8 offset:20480
M v[36:39], v[108:111], a[132:135], v[36:39]
buffer_load_dwordx4 v3, s[48:51], s26 offen offset:1024 lds
M v[36:39], v[104:107], a[128:131], v[36:39]
ds_read_b64_tr_b16 v[164:165], v8 offset:24576
ds_read_b64_tr_b16 v[166:167], v8 offset:28672
M v[40:43], v[112:115], a[128:131], v[40:43]
buffer_load_dwordx4 v4, s[48:51], s26 offen offset:2048 lds
M v[40:43], v[116:119], a[132:135], v[40:43]
ds_read_b64_tr_b16 v[168:169], v9 offset:16384
ds_read_b64_tr_b16 v[170:171], v9 offset:20480
M v[44:47], v[124:127], a[132:135], v[44:47]
buffer_load_dwordx4 v5, s[48:51], s26 offen offset:3072 lds
M v[44:47], v[120:123], a[128:131], v[44:47]
M v[48:51], v[128:131], a[128:131], v[48:51]
ds_read_b64_tr_b16 v[172:173], v9 offset:24576
ds_read_b64_tr_b16 v[174:175], v9 offset:28672
M v[48:51], v[132:135], a[132:135], v[48:51]
buffer_load_dwordx4 a[208:211], v1, s[44:47], s25 offen offset:0 sc1
M v[52:55], v[140:143], a[132:135], v[52:55]
ds_read_b64_tr_b16 v[176:177], v10 offset:16384
ds_read_b64_tr_b16 v[178:179], v10 offset:20480
M v[52:55], v[136:139], a[128:131], v[52:55]
buffer_load_dwordx4 a[212:215], v1, s[44:47], s25 offen offset:1024 sc1
M v[56:59], v[144:147], a[128:131], v[56:59]
ds_read_b64_tr_b16 v[180:181], v10 offset:24576
ds_read_b64_tr_b16 v[182:183], v10 offset:28672
M v[56:59], v[148:151], a[132:135], v[56:59]
buffer_load_dwordx4 a[216:219], v1, s[44:47], s25 offen offset:2048 sc1
M v[60:63], v[156:159], a[132:135], v[60:63]
M v[60:63], v[152:155], a[128:131], v[60:63]
ds_read_b64_tr_b16 v[184:185], v11 offset:16384
ds_read_b64_tr_b16 v[186:187], v11 offset:20480
M v[64:67], v[96:99], a[136:139], v[64:67]
buffer_load_dwordx4 a[220:223], v1, s[44:47], s25 offen offset:3072 sc1
M v[64:67], v[100:103], a[140:143], v[64:67]
ds_read_b64_tr_b16 v[188:189], v11 offset:24576
ds_read_b64_tr_b16 v[190:191], v11 offset:28672
M v[68:71], v[108:111], a[140:143], v[68:71]
s_sub_u32 s39, s39, 1
s_cmp_eq_u32 s39, 0
s_cselect_b32 s3, s64, s65
M v[68:71], v[104:107], a[136:139], v[68:71]
ds_read_b64_tr_b16 v[192:193], v12 offset:16384
ds_read_b64_tr_b16 v[194:195], v12 offset:20480
M v[72:75], v[112:115], a[136:139], v[72:75]
s_add_u32 s25, s25, s3
s_lshl_b32 s3, s3, 3
s_add_u32 s26, s26, s3
M v[72:75], v[116:119], a[140:143], v[72:75]
ds_read_b64_tr_b16 v[196:197], v12 offset:24576
ds_read_b64_tr_b16 v[198:199], v12 offset:28672
M v[76:79], v[124:127], a[140:143], v[76:79]
M v[76:79], v[120:123], a[136:139], v[76:79]
ds_read_b64_tr_b16 v[200:201], v13 offset:16384
ds_read_b64_tr_b16 v[202:203], v13 offset:20480
M v[80:83], v[128:131], a[136:139], v[80:83]
ds_read_b64_tr_b16 v[204:205], v13 offset:24576
ds_read_b64_tr_b16 v[206:207], v13 offset:28672
M v[80:83], v[132:135], a[140:143], v[80:83]
ds_read_b64_tr_b16 v[208:209], v14 offset:16384
ds_read_b64_tr_b16 v[210:211], v14 offset:20480
M v[84:87], v[140:143], a[140:143], v[84:87]
ds_read_b64_tr_b16 v[212:213], v14 offset:24576
ds_read_b64_tr_b16 v[214:215], v14 offset:28672
M v[84:87], v[136:139], a[136:139], v[84:87]
ds_read_b64_tr_b16 v[216:217], v15 offset:16384
ds_read_b64_tr_b16 v[218:219], v15 offset:20480
M v[88:91], v[144:147], a[136:139], v[88:91]
ds_read_b64_tr_b16 v[220:221], v15 offset:24576
ds_read_b64_tr_b16 v[222:223], v15 offset:28672
M v[88:91], v[148:151], a[140:143], v[88:91]
M v[92:95], v[156:159], a[140:143], v[92:95]
M v[92:95], v[152:155], a[136:139], v[92:95]
s_waitcnt vmcnt(24) lgkmcnt(0)
s_barrier
M v[32:35], v[160:163], a[144:147], v[32:35]
s_add_u32 m0, s41, 98304
s_nop 0
buffer_load_dwordx4 v2, s[48:51], s26 offen offset:0 lds
M v[32:35], v[164:167], a[148:151], v[32:35]
ds_read_b64_tr_b16 v[96:97], v8 offset:32768
ds_read_b64_tr_b16 v[98:99], v8 offset:36864
M v[36:39], v[172:175], a[148:151], v[36:39]
buffer_load_dwordx4 v3, s[48:51], s26 offen offset:1024 lds
M v[36:39], v[168:171], a[144:147], v[36:39]
ds_read_b64_tr_b16 v[100:101], v8 offset:40960
ds_read_b64_tr_b16 v[102:103], v8 offset:45056
M v[40:43], v[176:179], a[144:147], v[40:43]
buffer_load_dwordx4 v4, s[48:51], s26 offen offset:2048 lds
M v[40:43], v[180:183], a[148:151], v[40:43]
ds_read_b64_tr_b16 v[104:105], v9 offset:32768
ds_read_b64_tr_b16 v[106:107], v9 offset:36864
M v[44:47], v[188:191], a[148:151], v[44:47]
buffer_load_dwordx4 v5, s[48:51], s26 offen offset:3072 lds
M v[44:47], v[184:187], a[144:147], v[44:47]
M v[48:51], v[192:195], a[144:147], v[48:51]
ds_read_b64_tr_b16 v[108:109], v9 offset:40960
ds_read_b64_tr_b16 v[110:111], v9 offset:45056
M v[48:51], v[196:199], a[148:151], v[48:51]
buffer_load_dwordx4 a[224:227], v1, s[44:47], s25 offen offset:0 sc1
M v[52:55], v[204:207], a[148:151], v[52:55]
ds_read_b64_tr_b16 v[112:113], v10 offset:32768
ds_read_b64_tr_b16 v[114:115], v10 offset:36864
M v[52:55], v[200:203], a[144:147], v[52:55]
buffer_load_dwordx4 a[228:231], v1, s[44:47], s25 offen offset:1024 sc1
M v[56:59], v[208:211], a[144:147], v[56:59]
ds_read_b64_tr_b16 v[116:117], v10 offset:40960
ds_read_b64_tr_b16 v[118:119], v10 offset:45056
M v[56:59], v[212:215], a[148:151], v[56:59]
buffer_load_dwordx4 a[232:235], v1, s[44:47], s25 offen offset:2048 sc1
M v[60:63], v[220:223], a[148:151], v[60:63]
M v[60:63], v[216:219], a[144:147], v[60:63]
ds_read_b64_tr_b16 v[120:121], v11 offset:32768
ds_read_b64_tr_b16 v[122:123], v11 offset:36864
M v[64:67], v[160:163], a[152:155], v[64:67]
buffer_load_dwordx4 a[236:239], v1, s[44:47], s25 offen offset:3072 sc1
M v[64:67], v[164:167], a[156:159], v[64:67]
ds_read_b64_tr_b16 v[124:125], v11 offset:40960
ds_read_b64_tr_b16 v[126:127], v11 offset:45056
M v[68:71], v[172:175], a[156:159], v[68:71]
s_sub_u32 s39, s39, 1
s_cmp_eq_u32 s39, 0
s_cselect_b32 s3, s64, s65
M v[68:71], v[168:171], a[152:155], v[68:71]
ds_read_b64_tr_b16 v[128:129], v12 offset:32768
ds_read_b64_tr_b16 v[130:131], v12 offset:36864
M v[72:75], v[176:179], a[152:155], v[72:75]
s_add_u32 s25, s25, s3
s_lshl_b32 s3, s3, 3
s_add_u32 s26, s26, s3
M v[72:75], v[180:183], a[156:159], v[72:75]
ds_read_b64_tr_b16 v[132:133], v12 offset:40960
ds_read_b64_tr_b16 v[134:135], v12 offset:45056
M v[76:79], v[188:191], a[156:159], v[76:79]
M v[76:79], v[184:187], a[152:155], v[76:79]
ds_read_b64_tr_b16 v[136:137], v13 offset:32768
ds_read_b64_tr_b16 v[138:139], v13 offset:36864
M v[80:83], v[192:195], a[152:155], v[80:83]
ds_read_b64_tr_b16 v[140:141], v13 offset:40960
ds_read_b64_tr_b16 v[142:143], v13 offset:45056
M v[80:83], v[196:199], a[156:159], v[80:83]
ds_read_b64_tr_b16 v[144:145], v14 offset:32768
ds_read_b64_tr_b16 v[146:147], v14 offset:36864
M v[84:87], v[204:207], a[156:159], v[84:87]
ds_read_b64_tr_b16 v[148:149], v14 offset:40960
ds_read_b64_tr_b16 v[150:151], v14 offset:45056
M v[84:87], v[200:203], a[152:155], v[84:87]
ds_read_b64_tr_b16 v[152:153], v15 offset:32768
ds_read_b64_tr_b16 v[154:155], v15 offset:36864
M v[88:91], v[208:211], a[152:155], v[88:91]
ds_read_b64_tr_b16 v[156:157], v15 offset:40960
ds_read_b64_tr_b16 v[158:159], v15 offset:45056
M v[88:91], v[212:215], a[156:159], v[88:91]
M v[92:95], v[220:223], a[156:159], v[92:95]
M v[92:95], v[216:219], a[152:155], v[92:95]
s_waitcnt vmcnt(24) lgkmcnt(0)
s_barrier
M v[32:35], v[96:99], a[160:163], v[32:35]
s_add_u32 m0, s41, 114688
s_nop 0
buffer_load_dwordx4 v2, s[48:51], s26 offen offset:0 lds
M v[32:35], v[100:103], a[164:167], v[32:35]
ds_read_b64_tr_b16 v[160:161], v8 offset:49152
ds_read_b64_tr_b16 v[162:163], v8 offset:53248
M v[36:39], v[108:111], a[164:167], v[36:39]
buffer_load_dwordx4 v3, s[48:51], s26 offen offset:1024 lds
M v[36:39], v[104:107], a[160:163], v[36:39]
ds_read_b64_tr_b16 v[164:165], v8 offset:57344
ds_read_b64_tr_b16 v[166:167], v8 offset:61440
M v[40:43], v[112:115], a[160:163], v[40:43]
buffer_load_dwordx4 v4, s[48:51], s26 offen offset:2048 lds
M v[40:43], v[116:119], a[164:167], v[40:43]
ds_read_b64_tr_b16 v[168:169], v9 offset:49152
ds_read_b64_tr_b16 v[170:171], v9 offset:53248
M v[44:47], v[124:127], a[164:167], v[44:47]
buffer_load_dwordx4 v5, s[48:51], s26 offen offset:3072 lds
M v[44:47], v[120:123], a[160:163], v[44:47]
M v[48:51], v[128:131], a[160:163], v[48:51]
ds_read_b64_tr_b16 v[172:173], v9 offset:57344
ds_read_b64_tr_b16 v[174:175], v9 offset:61440
M v[48:51], v[132:135], a[164:167], v[48:51]
buffer_load_dwordx4 a[240:243], v1, s[44:47], s25 offen offset:0 sc1
M v[52:55], v[140:143], a[164:167], v[52:55]
ds_read_b64_tr_b16 v[176:177], v10 offset:49152
ds_read_b64_tr_b16 v[178:179], v10 offset:53248
M v[52:55], v[136:139], a[160:163], v[52:55]
buffer_load_dwordx4 a[244:247], v1, s[44:47], s25 offen offset:1024 sc1
M v[56:59], v[144:147], a[160:163], v[56:59]
ds_read_b64_tr_b16 v[180:181], v10 offset:57344
ds_read_b64_tr_b16 v[182:183], v10 offset:61440
M v[56:59], v[148:151], a[164:167], v[56:59]
buffer_load_dwordx4 a[248:251], v1, s[44:47], s25 offen offset:2048 sc1
M v[60:63], v[156:159], a[164:167], v[60:63]
M v[60:63], v[152:155], a[160:163], v[60:63]
ds_read_b64_tr_b16 v[184:185], v11 offset:49152
ds_read_b64_tr_b16 v[186:187], v11 offset:53248
M v[64:67], v[96:99], a[168:171], v[64:67]
buffer_load_dwordx4 a[252:255], v1, s[44:47], s25 offen offset:3072 sc1
M v[64:67], v[100:103], a[172:175], v[64:67]
ds_read_b64_tr_b16 v[188:189], v11 offset:57344
ds_read_b64_tr_b16 v[190:191], v11 offset:61440
M v[68:71], v[108:111], a[172:175], v[68:71]
s_sub_u32 s39, s39, 1
s_cmp_eq_u32 s39, 0
s_cselect_b32 s3, s64, s65
M v[68:71], v[104:107], a[168:171], v[68:71]
ds_read_b64_tr_b16 v[192:193], v12 offset:49152
ds_read_b64_tr_b16 v[194:195], v12 offset:53248
M v[72:75], v[112:115], a[168:171], v[72:75]
s_add_u32 s25, s25, s3
s_lshl_b32 s3, s3, 3
s_add_u32 s26, s26, s3
M v[72:75], v[116:119], a[172:175], v[72:75]
ds_read_b64_tr_b16 v[196:197], v12 offset:57344
ds_read_b64_tr_b16 v[198:199], v12 offset:61440
M v[76:79], v[124:127], a[172:175], v[76:79]
M v[76:79], v[120:123], a[168:171], v[76:79]
ds_read_b64_tr_b16 v[200:201], v13 offset:49152
ds_read_b64_tr_b16 v[202:203], v13 offset:53248
M v[80:83], v[128:131], a[168:171], v[80:83]
ds_read_b64_tr_b16 v[204:205], v13 offset:57344
ds_read_b64_tr_b16 v[206:207], v13 offset:61440
M v[80:83], v[132:135], a[172:175], v[80:83]
ds_read_b64_tr_b16 v[208:209], v14 offset:49152
ds_read_b64_tr_b16 v[210:211], v14 offset:53248
M v[84:87], v[140:143], a[172:175], v[84:87]
ds_read_b64_tr_b16 v[212:213], v14 offset:57344
ds_read_b64_tr_b16 v[214:215], v14 offset:61440
M v[84:87], v[136:139], a[168:171], v[84:87]
ds_read_b64_tr_b16 v[216:217], v15 offset:49152
ds_read_b64_tr_b16 v[218:219], v15 offset:53248
M v[88:91], v[144:147], a[168:171], v[88:91]
ds_read_b64_tr_b16 v[220:221], v15 offset:57344
ds_read_b64_tr_b16 v[222:223], v15 offset:61440
M v[88:91], v[148:151], a[172:175], v[88:91]
M v[92:95], v[156:159], a[172:175], v[92:95]
M v[92:95], v[152:155], a[168:171], v[92:95]
s_waitcnt vmcnt(24) lgkmcnt(0)
s_barrier
M v[32:35], v[160:163], a[176:179], v[32:35]
s_add_u32 m0, s41, 0
s_nop 0
buffer_load_dwordx4 v2, s[48:51], s26 offen offset:0 lds
M v[32:35], v[164:167], a[180:183], v[32:35]
ds_read_b64_tr_b16 v[96:97], v16 offset:0
ds_read_b64_tr_b16 v[98:99], v16 offset:4096
M v[36:39], v[172:175], a[180:183], v[36:39]
buffer_load_dwordx4 v3, s[48:51], s26 offen offset:1024 lds
M v[36:39], v[168:171], a[176:179], v[36:39]
ds_read_b64_tr_b16 v[100:101], v16 offset:8192
ds_read_b64_tr_b16 v[102:103], v16 offset:12288
M v[40:43], v[176:179], a[176:179], v[40:43]
buffer_load_dwordx4 v4, s[48:51], s26 offen offset:2048 lds
M v[40:43], v[180:183], a[180:183], v[40:43]
ds_read_b64_tr_b16 v[104:105], v17 offset:0
ds_read_b64_tr_b16 v[106:107], v17 offset:4096
M v[44:47], v[188:191], a[180:183], v[44:47]
buffer_load_dwordx4 v5, s[48:51], s26 offen offset:3072 lds
M v[44:47], v[184:187], a[176:179], v[44:47]
M v[48:51], v[192:195], a[176:179], v[48:51]
ds_read_b64_tr_b16 v[108:109], v17 offset:8192
ds_read_b64_tr_b16 v[110:111], v17 offset:12288
M v[48:51], v[196:199], a[180:183], v[48:51]
buffer_load_dwordx4 a[128:131], v1, s[44:47], s25 offen offset:0 sc1
M v[52:55], v[204:207], a[180:183], v[52:55]
ds_read_b64_tr_b16 v[112:113], v18 offset:0
ds_read_b64_tr_b16 v[114:115], v18 offset:4096
M v[52:55], v[200:203], a[176:179], v[52:55]
buffer_load_dwordx4 a[132:135], v1, s[44:47], s25 offen offset:1024 sc1
M v[56:59], v[208:211], a[176:179], v[56:59]
ds_read_b64_tr_b16 v[116:117], v18 offset:8192
ds_read_b64_tr_b16 v[118:119], v18 offset:12288
M v[56:59], v[212:215], a[180:183], v[56:59]
buffer_load_dwordx4 a[136:139], v1, s[44:47], s25 offen offset:2048 sc1
M v[60:63], v[220:223], a[180:183], v[60:63]
M v[60:63], v[216:219], a[176:179], v[60:63]
ds_read_b64_tr_b16 v[120:121], v19 offset:0
ds_read_b64_tr_b16 v[122:123], v19 offset:4096
M v[64:67], v[160:163], a[184:187], v[64:67]
buffer_load_dwordx4 a[140:143], v1, s[44:47], s25 offen offset:3072 sc1
M v[64:67], v[164:167], a[188:191], v[64:67]
ds_read_b64_tr_b16 v[124:125], v19 offset:8192
ds_read_b64_tr_b16 v[126:127], v19 offset:12288
M v[68:71], v[172:175], a[188:191], v[68:71]
s_sub_u32 s39, s39, 1
s_cmp_eq_u32 s39, 0
s_cselect_b32 s3, s64, s65
M v[68:71], v[168:171], a[184:187], v[68:71]
ds_read_b64_tr_b16 v[128:129], v20 offset:0
ds_read_b64_tr_b16 v[130:131], v20 offset:4096
M v[72:75], v[176:179], a[184:187], v[72:75]
s_add_u32 s25, s25, s3
s_lshl_b32 s3, s3, 3
s_add_u32 s26, s26, s3
M v[72:75], v[180:183], a[188:191], v[72:75]
ds_read_b64_tr_b16 v[132:133], v20 offset:8192
ds_read_b64_tr_b16 v[134:135], v20 offset:12288
M v[76:79], v[188:191], a[188:191], v[76:79]
M v[76:79], v[184:187], a[184:187], v[76:79]
ds_read_b64_tr_b16 v[136:137], v21 offset:0
ds_read_b64_tr_b16 v[138:139], v21 offset:4096
M v[80:83], v[192:195], a[184:187], v[80:83]
ds_read_b64_tr_b16 v[140:141], v21 offset:8192
ds_read_b64_tr_b16 v[142:143], v21 offset:12288
M v[80:83], v[196:199], a[188:191], v[80:83]
ds_read_b64_tr_b16 v[144:145], v22 offset:0
ds_read_b64_tr_b16 v[146:147], v22 offset:4096
M v[84:87], v[204:207], a[188:191], v[84:87]
ds_read_b64_tr_b16 v[148:149], v22 offset:8192
ds_read_b64_tr_b16 v[150:151], v22 offset:12288
M v[84:87], v[200:203], a[184:187], v[84:87]
ds_read_b64_tr_b16 v[152:153], v23 offset:0
ds_read_b64_tr_b16 v[154:155], v23 offset:4096
M v[88:91], v[208:211], a[184:187], v[88:91]
ds_read_b64_tr_b16 v[156:157], v23 offset:8192
ds_read_b64_tr_b16 v[158:159], v23 offset:12288
M v[88:91], v[212:215], a[188:191], v[88:91]
M v[92:95], v[220:223], a[188:191], v[92:95]
M v[92:95], v[216:219], a[184:187], v[92:95]
s_waitcnt vmcnt(24) lgkmcnt(0)
s_barrier
M v[32:35], v[96:99], a[192:195], v[32:35]
s_add_u32 m0, s41, 16384
s_nop 0
buffer_load_dwordx4 v2, s[48:51], s26 offen offset:0 lds
M v[32:35], v[100:103], a[196:199], v[32:35]
ds_read_b64_tr_b16 v[160:161], v16 offset:16384
ds_read_b64_tr_b16 v[162:163], v16 offset:20480
M v[36:39], v[108:111], a[196:199], v[36:39]
buffer_load_dwordx4 v3, s[48:51], s26 offen offset:1024 lds
M v[36:39], v[104:107], a[192:195], v[36:39]
ds_read_b64_tr_b16 v[164:165], v16 offset:24576
ds_read_b64_tr_b16 v[166:167], v16 offset:28672
M v[40:43], v[112:115], a[192:195], v[40:43]
buffer_load_dwordx4 v4, s[48:51], s26 offen offset:2048 lds
M v[40:43], v[116:119], a[196:199], v[40:43]
ds_read_b64_tr_b16 v[168:169], v17 offset:16384
ds_read_b64_tr_b16 v[170:171], v17 offset:20480
M v[44:47], v[124:127], a[196:199], v[44:47]
buffer_load_dwordx4 v5, s[48:51], s26 offen offset:3072 lds
M v[44:47], v[120:123], a[192:195], v[44:47]
M v[48:51], v[128:131], a[192:195], v[48:51]
ds_read_b64_tr_b16 v[172:173], v17 offset:24576
ds_read_b64_tr_b16 v[174:175], v17 offset:28672
M v[48:51], v[132:135], a[196:199], v[48:51]
buffer_load_dwordx4 a[144:147], v1, s[44:47], s25 offen offset:0 sc1
M v[52:55], v[140:143], a[196:199], v[52:55]
ds_read_b64_tr_b16 v[176:177], v18 offset:16384
ds_read_b64_tr_b16 v[178:179], v18 offset:20480
M v[52:55], v[136:139], a[192:195], v[52:55]
buffer_load_dwordx4 a[148:151], v1, s[44:47], s25 offen offset:1024 sc1
M v[56:59], v[144:147], a[192:195], v[56:59]
ds_read_b64_tr_b16 v[180:181], v18 offset:24576
ds_read_b64_tr_b16 v[182:183], v18 offset:28672
M v[56:59], v[148:151], a[196:199], v[56:59]
buffer_load_dwordx4 a[152:155], v1, s[44:47], s25 offen offset:2048 sc1
M v[60:63], v[156:159], a[196:199], v[60:63]
M v[60:63], v[152:155], a[192:195], v[60:63]
ds_read_b64_tr_b16 v[184:185], v19 offset:16384
ds_read_b64_tr_b16 v[186:187], v19 offset:20480
M v[64:67], v[96:99], a[200:203], v[64:67]
buffer_load_dwordx4 a[156:159], v1, s[44:47], s25 offen offset:3072 sc1
M v[64:67], v[100:103], a[204:207], v[64:67]
ds_read_b64_tr_b16 v[188:189], v19 offset:24576
ds_read_b64_tr_b16 v[190:191], v19 offset:28672
M v[68:71], v[108:111], a[204:207], v[68:71]
s_sub_u32 s39, s39, 1
s_cmp_eq_u32 s39, 0
s_cselect_b32 s3, s64, s65
M v[68:71], v[104:107], a[200:203], v[68:71]
ds_read_b64_tr_b16 v[192:193], v20 offset:16384
ds_read_b64_tr_b16 v[194:195], v20 offset:20480
M v[72:75], v[112:115], a[200:203], v[72:75]
s_add_u32 s25, s25, s3
s_lshl_b32 s3, s3, 3
s_add_u32 s26, s26, s3
M v[72:75], v[116:119], a[204:207], v[72:75]
ds_read_b64_tr_b16 v[196:197], v20 offset:24576
ds_read_b64_tr_b16 v[198:199], v20 offset:28672
M v[76:79], v[124:127], a[204:207], v[76:79]
M v[76:79], v[120:123], a[200:203], v[76:79]
ds_read_b64_tr_b16 v[200:201], v21 offset:16384
ds_read_b64_tr_b16 v[202:203], v21 offset:20480
M v[80:83], v[128:131], a[200:203], v[80:83]
ds_read_b64_tr_b16 v[204:205], v21 offset:24576
ds_read_b64_tr_b16 v[206:207], v21 offset:28672
M v[80:83], v[132:135], a[204:207], v[80:83]
ds_read_b64_tr_b16 v[208:209], v22 offset:16384
ds_read_b64_tr_b16 v[210:211], v22 offset:20480
M v[84:87], v[140:143], a[204:207], v[84:87]
ds_read_b64_tr_b16 v[212:213], v22 offset:24576
ds_read_b64_tr_b16 v[214:215], v22 offset:28672
M v[84:87], v[136:139], a[200:203], v[84:87]
ds_read_b64_tr_b16 v[216:217], v23 offset:16384
ds_read_b64_tr_b16 v[218:219], v23 offset:20480
M v[88:91], v[144:147], a[200:203], v[88:91]
ds_read_b64_tr_b16 v[220:221], v23 offset:24576
ds_read_b64_tr_b16 v[222:223], v23 offset:28672
M v[88:91], v[148:151], a[204:207], v[88:91]
M v[92:95], v[156:159], a[204:207], v[92:95]
M v[92:95], v[152:155], a[200:203], v[92:95]
s_sub_u32 s28, s28, 1
s_cmp_lg_u32 s28, 0
s_cbranch_scc1 Lk3_la
s_waitcnt vmcnt(24) lgkmcnt(0)
s_barrier
M v[32:35], v[160:163], a[208:211], v[32:35]
s_add_u32 m0, s41, 32768
s_nop 0
buffer_load_dwordx4 v2, s[48:51], s26 offen offset:0 lds
M v[32:35], v[164:167], a[212:215], v[32:35]
ds_read_b64_tr_b16 v[96:97], v16 offset:32768
ds_read_b64_tr_b16 v[98:99], v16 offset:36864
M v[36:39], v[172:175], a[212:215], v[36:39]
buffer_load_dwordx4 v3, s[48:51], s26 offen offset:1024 lds
M v[36:39], v[168:171], a[208:211], v[36:39]
ds_read_b64_tr_b16 v[100:101], v16 offset:40960
ds_read_b64_tr_b16 v[102:103], v16 offset:45056
M v[40:43], v[176:179], a[208:211], v[40:43]
buffer_load_dwordx4 v4, s[48:51], s26 offen offset:2048 lds
M v[40:43], v[180:183], a[212:215], v[40:43]
ds_read_b64_tr_b16 v[104:105], v17 offset:32768
ds_read_b64_tr_b16 v[106:107], v17 offset:36864
M v[44:47], v[188:191], a[212:215], v[44:47]
buffer_load_dwordx4 v5, s[48:51], s26 offen offset:3072 lds
M v[44:47], v[184:187], a[208:211], v[44:47]
M v[48:51], v[192:195], a[208:211], v[48:51]
ds_read_b64_tr_b16 v[108:109], v17 offset:40960
ds_read_b64_tr_b16 v[110:111], v17 offset:45056
M v[48:51], v[196:199], a[212:215], v[48:51]
buffer_load_dwordx4 a[160:163], v1, s[44:47], s25 offen offset:0 sc1
M v[52:55], v[204:207], a[212:215], v[52:55]
ds_read_b64_tr_b16 v[112:113], v18 offset:32768
ds_read_b64_tr_b16 v[114:115], v18 offset:36864
M v[52:55], v[200:203], a[208:211], v[52:55]
buffer_load_dwordx4 a[164:167], v1, s[44:47], s25 offen offset:1024 sc1
M v[56:59], v[208:211], a[208:211], v[56:59]
ds_read_b64_tr_b16 v[116:117], v18 offset:40960
ds_read_b64_tr_b16 v[118:119], v18 offset:45056
M v[56:59], v[212:215], a[212:215], v[56:59]
buffer_load_dwordx4 a[168:171], v1, s[44:47], s25 offen offset:2048 sc1
M v[60:63], v[220:223], a[212:215], v[60:63]
M v[60:63], v[216:219], a[208:211], v[60:63]
ds_read_b64_tr_b16 v[120:121], v19 offset:32768
ds_read_b64_tr_b16 v[122:123], v19 offset:36864
M v[64:67], v[160:163], a[216:219], v[64:67]
buffer_load_dwordx4 a[172:175], v1, s[44:47], s25 offen offset:3072 sc1
M v[64:67], v[164:167], a[220:223], v[64:67]
ds_read_b64_tr_b16 v[124:125], v19 offset:40960
ds_read_b64_tr_b16 v[126:127], v19 offset:45056
M v[68:71], v[172:175], a[220:223], v[68:71]
s_sub_u32 s39, s39, 1
s_cmp_eq_u32 s39, 0
s_cselect_b32 s3, s64, s65
M v[68:71], v[168:171], a[216:219], v[68:71]
ds_read_b64_tr_b16 v[128:129], v20 offset:32768
ds_read_b64_tr_b16 v[130:131], v20 offset:36864
M v[72:75], v[176:179], a[216:219], v[72:75]
s_add_u32 s25, s25, s3
s_lshl_b32 s3, s3, 3
s_add_u32 s26, s26, s3
M v[72:75], v[180:183], a[220:223], v[72:75]
ds_read_b64_tr_b16 v[132:133], v20 offset:40960
ds_read_b64_tr_b16 v[134:135], v20 offset:45056
M v[76:79], v[188:191], a[220:223], v[76:79]
M v[76:79], v[184:187], a[216:219], v[76:79]
ds_read_b64_tr_b16 v[136:137], v21 offset:32768
ds_read_b64_tr_b16 v[138:139], v21 offset:36864
M v[80:83], v[192:195], a[216:219], v[80:83]
ds_read_b64_tr_b16 v[140:141], v21 offset:40960
ds_read_b64_tr_b16 v[142:143], v21 offset:45056
M v[80:83], v[196:199], a[220:223], v[80:83]
ds_read_b64_tr_b16 v[144:145], v22 offset:32768
ds_read_b64_tr_b16 v[146:147], v22 offset:36864
M v[84:87], v[204:207], a[220:223], v[84:87]
ds_read_b64_tr_b16 v[148:149], v22 offset:40960
ds_read_b64_tr_b16 v[150:151], v22 offset:45056
M v[84:87], v[200:203], a[216:219], v[84:87]
ds_read_b64_tr_b16 v[152:153], v23 offset:32768
ds_read_b64_tr_b16 v[154:155], v23 offset:36864
M v[88:91], v[208:211], a[216:219], v[88:91]
ds_read_b64_tr_b16 v[156:157], v23 offset:40960
ds_read_b64_tr_b16 v[158:159], v23 offset:45056
M v[88:91], v[212:215], a[220:223], v[88:91]
M v[92:95], v[220:223], a[220:223], v[92:95]
M v[92:95], v[216:219], a[216:219], v[92:95]
s_waitcnt vmcnt(24) lgkmcnt(0)
s_barrier
M v[32:35], v[96:99], a[224:227], v[32:35]
s_add_u32 m0, s41, 49152
s_nop 0
buffer_load_dwordx4 v2, s[48:51], s26 offen offset:0 lds
M v[32:35], v[100:103], a[228:231], v[32:35]
ds_read_b64_tr_b16 v[160:161], v16 offset:49152
ds_read_b64_tr_b16 v[162:163], v16 offset:53248
M v[36:39], v[108:111], a[228:231], v[36:39]
buffer_load_dwordx4 v3, s[48:51], s26 offen offset:1024 lds
M v[36:39], v[104:107], a[224:227], v[36:39]
ds_read_b64_tr_b16 v[164:165], v16 offset:57344
ds_read_b64_tr_b16 v[166:167], v16 offset:61440
M v[40:43], v[112:115], a[224:227], v[40:43]
buffer_load_dwordx4 v4, s[48:51], s26 offen offset:2048 lds
M v[40:43], v[116:119], a[228:231], v[40:43]
ds_read_b64_tr_b16 v[168:169], v17 offset:49152
ds_read_b64_tr_b16 v[170:171], v17 offset:53248
M v[44:47], v[124:127], a[228:231], v[44:47]
buffer_load_dwordx4 v5, s[48:51], s26 offen offset:3072 lds
M v[44:47], v[120:123], a[224:227], v[44:47]
M v[48:51], v[128:131], a[224:227], v[48:51]
ds_read_b64_tr_b16 v[172:173], v17 offset:57344
ds_read_b64_tr_b16 v[174:175], v17 offset:61440
M v[48:51], v[132:135], a[228:231], v[48:51]
buffer_load_dwordx4 a[176:179], v1, s[44:47], s25 offen offset:0 sc1
M v[52:55], v[140:143], a[228:231], v[52:55]
ds_read_b64_tr_b16 v[176:177], v18 offset:49152
ds_read_b64_tr_b16 v[178:179], v18 offset:53248
M v[52:55], v[136:139], a[224:227], v[52:55]
buffer_load_dwordx4 a[180:183], v1, s[44:47], s25 offen offset:1024 sc1
M v[56:59], v[144:147], a[224:227], v[56:59]
ds_read_b64_tr_b16 v[180:181], v18 offset:57344
ds_read_b64_tr_b16 v[182:183], v18 offset:61440
M v[56:59], v[148:151], a[228:231], v[56:59]
buffer_load_dwordx4 a[184:187], v1, s[44:47], s25 offen offset:2048 sc1
M v[60:63], v[156:159], a[228:231], v[60:63]
M v[60:63], v[152:155], a[224:227], v[60:63]
ds_read_b64_tr_b16 v[184:185], v19 offset:49152
ds_read_b64_tr_b16 v[186:187], v19 offset:53248
M v[64:67], v[96:99], a[232:235], v[64:67]
buffer_load_dwordx4 a[188:191], v1, s[44:47], s25 offen offset:3072 sc1
M v[64:67], v[100:103], a[236:239], v[64:67]
ds_read_b64_tr_b16 v[188:189], v19 offset:57344
ds_read_b64_tr_b16 v[190:191], v19 offset:61440
M v[68:71], v[108:111], a[236:239], v[68:71]
s_sub_u32 s39, s39, 1
s_cmp_eq_u32 s39, 0
s_cselect_b32 s3, s64, s65
M v[68:71], v[104:107], a[232:235], v[68:71]
ds_read_b64_tr_b16 v[192:193], v20 offset:49152
ds_read_b64_tr_b16 v[194:195], v20 offset:53248
M v[72:75], v[112:115], a[232:235], v[72:75]
s_add_u32 s25, s25, s3
s_lshl_b32 s3, s3, 3
s_add_u32 s26, s26, s3
M v[72:75], v[116:119], a[236:239], v[72:75]
ds_read_b64_tr_b16 v[196:197], v20 offset:57344
ds_read_b64_tr_b16 v[198:199], v20 offset:61440
M v[76:79], v[124:127], a[236:239], v[76:79]
M v[76:79], v[120:123], a[232:235], v[76:79]
ds_read_b64_tr_b16 v[200:201], v21 offset:49152
ds_read_b64_tr_b16 v[202:203], v21 offset:53248
M v[80:83], v[128:131], a[232:235], v[80:83]
ds_read_b64_tr_b16 v[204:205], v21 offset:57344
ds_read_b64_tr_b16 v[206:207], v21 offset:61440
M v[80:83], v[132:135], a[236:239], v[80:83]
ds_read_b64_tr_b16 v[208:209], v22 offset:49152
ds_read_b64_tr_b16 v[210:211], v22 offset:53248
M v[84:87], v[140:143], a[236:239], v[84:87]
ds_read_b64_tr_b16 v[212:213], v22 offset:57344
ds_read_b64_tr_b16 v[214:215], v22 offset:61440
M v[84:87], v[136:139], a[232:235], v[84:87]
ds_read_b64_tr_b16 v[216:217], v23 offset:49152
ds_read_b64_tr_b16 v[218:219], v23 offset:53248
M v[88:91], v[144:147], a[232:235], v[88:91]
ds_read_b64_tr_b16 v[220:221], v23 offset:57344
ds_read_b64_tr_b16 v[222:223], v23 offset:61440
M v[88:91], v[148:151], a[236:239], v[88:91]
M v[92:95], v[156:159], a[236:239], v[92:95]
M v[92:95], v[152:155], a[232:235], v[92:95]
s_waitcnt vmcnt(24) lgkmcnt(0)
s_barrier
M v[32:35], v[160:163], a[240:243], v[32:35]
s_mov_b64 s[44:45], s[34:35]
s_mov_b32 s46, 4194304
s_mov_b64 s[48:49], s[36:37]
s_mov_b32 s50, 2097152
s_mov_b32 s25, s32
s_mov_b32 s26, s33
s_add_u32 m0, s42, 65536
s_nop 0
buffer_load_dwordx4 v6, s[48:51], s26 offen offset:0 lds
M v[32:35], v[164:167], a[244:247], v[32:35]
ds_read_b64_tr_b16 v[96:97], v8 offset:0
ds_read_b64_tr_b16 v[98:99], v8 offset:4096
M v[36:39], v[172:175], a[244:247], v[36:39]
buffer_load_dwordx4 v7, s[48:51], s26 offen offset:1024 lds
M v[36:39], v[168:171], a[240:243], v[36:39]
ds_read_b64_tr_b16 v[100:101], v8 offset:8192
ds_read_b64_tr_b16 v[102:103], v8 offset:12288
M v[40:43], v[176:179], a[240:243], v[40:43]
M v[40:43], v[180:183], a[244:247], v[40:43]
buffer_load_dwordx4 a[192:195], v1, s[44:47], s25 offen offset:0 sc1
M v[44:47], v[188:191], a[244:247], v[44:47]
ds_read_b64_tr_b16 v[104:105], v9 offset:0
ds_read_b64_tr_b16 v[106:107], v9 offset:4096
M v[44:47], v[184:187], a[240:243], v[44:47]
buffer_load_dwordx4 a[196:199], v1, s[44:47], s25 offen offset:1024 sc1
M v[48:51], v[192:195], a[240:243], v[48:51]
M v[48:51], v[196:199], a[244:247], v[48:51]
ds_read_b64_tr_b16 v[108:109], v9 offset:8192
ds_read_b64_tr_b16 v[110:111], v9 offset:12288
M v[52:55], v[204:207], a[244:247], v[52:55]
buffer_load_dwordx4 a[200:203], v1, s[44:47], s25 offen offset:2048 sc1
M v[52:55], v[200:203], a[240:243], v[52:55]
ds_read_b64_tr_b16 v[112:113], v10 offset:0
ds_read_b64_tr_b16 v[114:115], v10 offset:4096
M v[56:59], v[208:211], a[240:243], v[56:59]
M v[56:59], v[212:215], a[244:247], v[56:59]
buffer_load_dwordx4 a[204:207], v1, s[44:47], s25 offen offset:3072 sc1
M v[60:63], v[220:223], a[244:247], v[60:63]
ds_read_b64_tr_b16 v[116:117], v10 offset:8192
ds_read_b64_tr_b16 v[118:119], v10 offset:12288
M v[60:63], v[216:219], a[240:243], v[60:63]
s_add_u32 s25, s25, 16384
s_add_u32 s26, s26, 131072
M v[64:67], v[160:163], a[248:251], v[64:67]
ds_read_b64_tr_b16 v[120:121], v11 offset:0
ds_read_b64_tr_b16 v[122:123], v11 offset:4096
M v[64:67], v[164:167], a[252:255], v[64:67]
M v[68:71], v[172:175], a[252:255], v[68:71]
ds_read_b64_tr_b16 v[124:125], v11 offset:8192
ds_read_b64_tr_b16 v[126:127], v11 offset:12288
M v[68:71], v[168:171], a[248:251], v[68:71]
ds_read_b64_tr_b16 v[128:129], v12 offset:0
ds_read_b64_tr_b16 v[130:131], v12 offset:4096
M v[72:75], v[176:179], a[248:251], v[72:75]
ds_read_b64_tr_b16 v[132:133], v12 offset:8192
ds_read_b64_tr_b16 v[134:135], v12 offset:12288
M v[72:75], v[180:183], a[252:255], v[72:75]
M v[76:79], v[188:191], a[252:255], v[76:79]
ds_read_b64_tr_b16 v[136:137], v13 offset:0
ds_read_b64_tr_b16 v[138:139], v13 offset:4096
M v[76:79], v[184:187], a[248:251], v[76:79]
ds_read_b64_tr_b16 v[140:141], v13 offset:8192
ds_read_b64_tr_b16 v[142:143], v13 offset:12288
M v[80:83], v[192:195], a[248:251], v[80:83]
ds_read_b64_tr_b16 v[144:145], v14 offset:0
ds_read_b64_tr_b16 v[146:147], v14 offset:4096
M v[80:83], v[196:199], a[252:255], v[80:83]
M v[84:87], v[204:207], a[252:255], v[84:87]
ds_read_b64_tr_b16 v[148:149], v14 offset:8192
ds_read_b64_tr_b16 v[150:151], v14 offset:12288
M v[84:87], v[200:203], a[248:251], v[84:87]
ds_read_b64_tr_b16 v[152:153], v15 offset:0
ds_read_b64_tr_b16 v[154:155], v15 offset:4096
M v[88:91], v[208:211], a[248:251], v[88:91]
ds_read_b64_tr_b16 v[156:157], v15 offset:8192
ds_read_b64_tr_b16 v[158:159], v15 offset:12288
M v[88:91], v[212:215], a[252:255], v[88:91]
M v[92:95], v[220:223], a[252:255], v[92:95]
M v[92:95], v[216:219], a[248:251], v[92:95]
s_waitcnt vmcnt(22) lgkmcnt(0)
s_barrier
M v[32:35], v[96:99], a[128:131], v[32:35]
s_add_u32 m0, s42, 81920
s_nop 0
buffer_load_dwordx4 v6, s[48:51], s26 offen offset:0 lds
M v[32:35], v[100:103], a[132:135], v[32:35]
ds_read_b64_tr_b16 v[160:161], v8 offset:16384
ds_read_b64_tr_b16 v[162:163], v8 offset:20480
M v[36:39], v[108:111], a[132:135], v[36:39]
buffer_load_dwordx4 v7, s[48:51], s26 offen offset:1024 lds
M v[36:39], v[104:107], a[128:131], v[36:39]
ds_read_b64_tr_b16 v[164:165], v8 offset:24576
ds_read_b64_tr_b16 v[166:167], v8 offset:28672
M v[40:43], v[112:115], a[128:131], v[40:43]
M v[40:43], v[116:119], a[132:135], v[40:43]
buffer_load_dwordx4 a[208:211], v1, s[44:47], s25 offen offset:0 sc1
M v[44:47], v[124:127], a[132:135], v[44:47]
ds_read_b64_tr_b16 v[168:169], v9 offset:16384
ds_read_b64_tr_b16 v[170:171], v9 offset:20480
M v[44:47], v[120:123], a[128:131], v[44:47]
buffer_load_dwordx4 a[212:215], v1, s[44:47], s25 offen offset:1024 sc1
M v[48:51], v[128:131], a[128:131], v[48:51]
M v[48:51], v[132:135], a[132:135], v[48:51]
ds_read_b64_tr_b16 v[172:173], v9 offset:24576
ds_read_b64_tr_b16 v[174:175], v9 offset:28672
M v[52:55], v[140:143], a[132:135], v[52:55]
buffer_load_dwordx4 a[216:219], v1, s[44:47], s25 offen offset:2048 sc1
M v[52:55], v[136:139], a[128:131], v[52:55]
ds_read_b64_tr_b16 v[176:177], v10 offset:16384
ds_read_b64_tr_b16 v[178:179], v10 offset:20480
M v[56:59], v[144:147], a[128:131], v[56:59]
M v[56:59], v[148:151], a[132:135], v[56:59]
buffer_load_dwordx4 a[220:223], v1, s[44:47], s25 offen offset:3072 sc1
M v[60:63], v[156:159], a[132:135], v[60:63]
ds_read_b64_tr_b16 v[180:181], v10 offset:24576
ds_read_b64_tr_b16 v[182:183], v10 offset:28672
M v[60:63], v[152:155], a[128:131], v[60:63]
s_add_u32 s25, s25, 16384
s_add_u32 s26, s26, 131072
M v[64:67], v[96:99], a[136:139], v[64:67]
ds_read_b64_tr_b16 v[184:185], v11 offset:16384
ds_read_b64_tr_b16 v[186:187], v11 offset:20480
M v[64:67], v[100:103], a[140:143], v[64:67]
M v[68:71], v[108:111], a[140:143], v[68:71]
ds_read_b64_tr_b16 v[188:189], v11 offset:24576
ds_read_b64_tr_b16 v[190:191], v11 offset:28672
M v[68:71], v[104:107], a[136:139], v[68:71]
ds_read_b64_tr_b16 v[192:193], v12 offset:16384
ds_read_b64_tr_b16 v[194:195], v12 offset:20480
M v[72:75], v[112:115], a[136:139], v[72:75]
ds_read_b64_tr_b16 v[196:197], v12 offset:24576
ds_read_b64_tr_b16 v[198:199], v12 offset:28672
M v[72:75], v[116:119], a[140:143], v[72:75]
M v[76:79], v[124:127], a[140:143], v[76:79]
ds_read_b64_tr_b16 v[200:201], v13 offset:16384
ds_read_b64_tr_b16 v[202:203], v13 offset:20480
M v[76:79], v[120:123], a[136:139], v[76:79]
ds_read_b64_tr_b16 v[204:205], v13 offset:24576
ds_read_b64_tr_b16 v[206:207], v13 offset:28672
M v[80:83], v[128:131], a[136:139], v[80:83]
ds_read_b64_tr_b16 v[208:209], v14 offset:16384
ds_read_b64_tr_b16 v[210:211], v14 offset:20480
M v[80:83], v[132:135], a[140:143], v[80:83]
M v[84:87], v[140:143], a[140:143], v[84:87]
ds_read_b64_tr_b16 v[212:213], v14 offset:24576
ds_read_b64_tr_b16 v[214:215], v14 offset:28672
M v[84:87], v[136:139], a[136:139], v[84:87]
ds_read_b64_tr_b16 v[216:217], v15 offset:16384
ds_read_b64_tr_b16 v[218:219], v15 offset:20480
M v[88:91], v[144:147], a[136:139], v[88:91]
ds_read_b64_tr_b16 v[220:221], v15 offset:24576
ds_read_b64_tr_b16 v[222:223], v15 offset:28672
M v[88:91], v[148:151], a[140:143], v[88:91]
M v[92:95], v[156:159], a[140:143], v[92:95]
M v[92:95], v[152:155], a[136:139], v[92:95]
s_waitcnt vmcnt(20) lgkmcnt(0)
s_barrier
M v[32:35], v[160:163], a[144:147], v[32:35]
s_add_u32 m0, s42, 98304
s_nop 0
buffer_load_dwordx4 v6, s[48:51], s26 offen offset:0 lds
M v[32:35], v[164:167], a[148:151], v[32:35]
ds_read_b64_tr_b16 v[96:97], v8 offset:32768
ds_read_b64_tr_b16 v[98:99], v8 offset:36864
M v[36:39], v[172:175], a[148:151], v[36:39]
buffer_load_dwordx4 v7, s[48:51], s26 offen offset:1024 lds
M v[36:39], v[168:171], a[144:147], v[36:39]
ds_read_b64_tr_b16 v[100:101], v8 offset:40960
ds_read_b64_tr_b16 v[102:103], v8 offset:45056
M v[40:43], v[176:179], a[144:147], v[40:43]
M v[40:43], v[180:183], a[148:151], v[40:43]
buffer_load_dwordx4 a[224:227], v1, s[44:47], s25 offen offset:0 sc1
M v[44:47], v[188:191], a[148:151], v[44:47]
ds_read_b64_tr_b16 v[104:105], v9 offset:32768
ds_read_b64_tr_b16 v[106:107], v9 offset:36864
M v[44:47], v[184:187], a[144:147], v[44:47]
buffer_load_dwordx4 a[228:231], v1, s[44:47], s25 offen offset:1024 sc1
M v[48:51], v[192:195], a[144:147], v[48:51]
M v[48:51], v[196:199], a[148:151], v[48:51]
ds_read_b64_tr_b16 v[108:109], v9 offset:40960
ds_read_b64_tr_b16 v[110:111], v9 offset:45056
M v[52:55], v[204:207], a[148:151], v[52:55]
buffer_load_dwordx4 a[232:235], v1, s[44:47], s25 offen offset:2048 sc1
M v[52:55], v[200:203], a[144:147], v[52:55]
ds_read_b64_tr_b16 v[112:113], v10 offset:32768
ds_read_b64_tr_b16 v[114:115], v10 offset:36864
M v[56:59], v[208:211], a[144:147], v[56:59]
M v[56:59], v[212:215], a[148:151], v[56:59]
buffer_load_dwordx4 a[236:239], v1, s[44:47], s25 offen offset:3072 sc1
M v[60:63], v[220:223], a[148:151], v[60:63]
ds_read_b64_tr_b16 v[116:117], v10 offset:40960
ds_read_b64_tr_b16 v[118:119], v10 offset:45056
M v[60:63], v[216:219], a[144:147], v[60:63]
s_add_u32 s25, s25, 16384
s_add_u32 s26, s26, 131072
M v[64:67], v[160:163], a[152:155], v[64:67]
ds_read_b64_tr_b16 v[120:121], v11 offset:32768
ds_read_b64_tr_b16 v[122:123], v11 offset:36864
M v[64:67], v[164:167], a[156:159], v[64:67]
M v[68:71], v[172:175], a[156:159], v[68:71]
ds_read_b64_tr_b16 v[124:125], v11 offset:40960
ds_read_b64_tr_b16 v[126:127], v11 offset:45056
M v[68:71], v[168:171], a[152:155], v[68:71]
ds_read_b64_tr_b16 v[128:129], v12 offset:32768
ds_read_b64_tr_b16 v[130:131], v12 offset:36864
M v[72:75], v[176:179], a[152:155], v[72:75]
ds_read_b64_tr_b16 v[132:133], v12 offset:40960
ds_read_b64_tr_b16 v[134:135], v12 offset:45056
M v[72:75], v[180:183], a[156:159], v[72:75]
M v[76:79], v[188:191], a[156:159], v[76:79]
ds_read_b64_tr_b16 v[136:137], v13 offset:32768
ds_read_b64_tr_b16 v[138:139], v13 offset:36864
M v[76:79], v[184:187], a[152:155], v[76:79]
ds_read_b64_tr_b16 v[140:141], v13 offset:40960
ds_read_b64_tr_b16 v[142:143], v13 offset:45056
M v[80:83], v[192:195], a[152:155], v[80:83]
ds_read_b64_tr_b16 v[144:145], v14 offset:32768
ds_read_b64_tr_b16 v[146:147], v14 offset:36864
M v[80:83], v[196:199], a[156:159], v[80:83]
M v[84:87], v[204:207], a[156:159], v[84:87]
ds_read_b64_tr_b16 v[148:149], v14 offset:40960
ds_read_b64_tr_b16 v[150:151], v14 offset:45056
M v[84:87], v[200:203], a[152:155], v[84:87]
ds_read_b64_tr_b16 v[152:153], v15 offset:32768
ds_read_b64_tr_b16 v[154:155], v15 offset:36864
M v[88:91], v[208:211], a[152:155], v[88:91]
ds_read_b64_tr_b16 v[156:157], v15 offset:40960
ds_read_b64_tr_b16 v[158:159], v15 offset:45056
M v[88:91], v[212:215], a[156:159], v[88:91]
M v[92:95], v[220:223], a[156:159], v[92:95]
M v[92:95], v[216:219], a[152:155], v[92:95]
s_waitcnt vmcnt(18) lgkmcnt(0)
s_barrier
M v[32:35], v[96:99], a[160:163], v[32:35]
s_add_u32 m0, s42, 114688
s_nop 0
buffer_load_dwordx4 v6, s[48:51], s26 offen offset:0 lds
M v[32:35], v[100:103], a[164:167], v[32:35]
ds_read_b64_tr_b16 v[160:161], v8 offset:49152
ds_read_b64_tr_b16 v[162:163], v8 offset:53248
M v[36:39], v[108:111], a[164:167], v[36:39]
buffer_load_dwordx4 v7, s[48:51], s26 offen offset:1024 lds
M v[36:39], v[104:107], a[160:163], v[36:39]
ds_read_b64_tr_b16 v[164:165], v8 offset:57344
ds_read_b64_tr_b16 v[166:167], v8 offset:61440
M v[40:43], v[112:115], a[160:163], v[40:43]
M v[40:43], v[116:119], a[164:167], v[40:43]
buffer_load_dwordx4 a[240:243], v1, s[44:47], s25 offen offset:0 sc1
M v[44:47], v[124:127], a[164:167], v[44:47]
ds_read_b64_tr_b16 v[168:169], v9 offset:49152
ds_read_b64_tr_b16 v[170:171], v9 offset:53248
M v[44:47], v[120:123], a[160:163], v[44:47]
buffer_load_dwordx4 a[244:247], v1, s[44:47], s25 offen offset:1024 sc1
M v[48:51], v[128:131], a[160:163], v[48:51]
M v[48:51], v[132:135], a[164:167], v[48:51]
ds_read_b64_tr_b16 v[172:173], v9 offset:57344
ds_read_b64_tr_b16 v[174:175], v9 offset:61440
M v[52:55], v[140:143], a[164:167], v[52:55]
buffer_load_dwordx4 a[248:251], v1, s[44:47], s25 offen offset:2048 sc1
M v[52:55], v[136:139], a[160:163], v[52:55]
ds_read_b64_tr_b16 v[176:177], v10 offset:49152
ds_read_b64_tr_b16 v[178:179], v10 offset:53248
M v[56:59], v[144:147], a[160:163], v[56:59]
M v[56:59], v[148:151], a[164:167], v[56:59]
buffer_load_dwordx4 a[252:255], v1, s[44:47], s25 offen offset:3072 sc1
M v[60:63], v[156:159], a[164:167], v[60:63]
ds_read_b64_tr_b16 v[180:181], v10 offset:57344
ds_read_b64_tr_b16 v[182:183], v10 offset:61440
M v[60:63], v[152:155], a[160:163], v[60:63]
s_add_u32 s25, s25, 16384
s_add_u32 s26, s26, 131072
M v[64:67], v[96:99], a[168:171], v[64:67]
ds_read_b64_tr_b16 v[184:185], v11 offset:49152
ds_read_b64_tr_b16 v[186:187], v11 offset:53248
M v[64:67], v[100:103], a[172:175], v[64:67]
M v[68:71], v[108:111], a[172:175], v[68:71]
ds_read_b64_tr_b16 v[188:189], v11 offset:57344
ds_read_b64_tr_b16 v[190:191], v11 offset:61440
M v[68:71], v[104:107], a[168:171], v[68:71]
ds_read_b64_tr_b16 v[192:193], v12 offset:49152
ds_read_b64_tr_b16 v[194:195], v12 offset:53248
M v[72:75], v[112:115], a[168:171], v[72:75]
ds_read_b64_tr_b16 v[196:197], v12 offset:57344
ds_read_b64_tr_b16 v[198:199], v12 offset:61440
M v[72:75], v[116:119], a[172:175], v[72:75]
M v[76:79], v[124:127], a[172:175], v[76:79]
ds_read_b64_tr_b16 v[200:201], v13 offset:49152
ds_read_b64_tr_b16 v[202:203], v13 offset:53248
M v[76:79], v[120:123], a[168:171], v[76:79]
ds_read_b64_tr_b16 v[204:205], v13 offset:57344
ds_read_b64_tr_b16 v[206:207], v13 offset:61440
M v[80:83], v[128:131], a[168:171], v[80:83]
ds_read_b64_tr_b16 v[208:209], v14 offset:49152
ds_read_b64_tr_b16 v[210:211], v14 offset:53248
M v[80:83], v[132:135], a[172:175], v[80:83]
M v[84:87], v[140:143], a[172:175], v[84:87]
ds_read_b64_tr_b16 v[212:213], v14 offset:57344
ds_read_b64_tr_b16 v[214:215], v14 offset:61440
M v[84:87], v[136:139], a[168:171], v[84:87]
ds_read_b64_tr_b16 v[216:217], v15 offset:49152
ds_read_b64_tr_b16 v[218:219], v15 offset:53248
M v[88:91], v[144:147], a[168:171], v[88:91]
ds_read_b64_tr_b16 v[220:221], v15 offset:57344
ds_read_b64_tr_b16 v[222:223], v15 offset:61440
M v[88:91], v[148:151], a[172:175], v[88:91]
M v[92:95], v[156:159], a[172:175], v[92:95]
M v[92:95], v[152:155], a[168:171], v[92:95]
s_waitcnt vmcnt(18) lgkmcnt(0)
s_barrier
M v[32:35], v[160:163], a[176:179], v[32:35]
s_add_u32 m0, s42, 0
s_nop 0
buffer_load_dwordx4 v6, s[48:51], s26 offen offset:0 lds
M v[32:35], v[164:167], a[180:183], v[32:35]
M v[36:39], v[172:175], a[180:183], v[36:39]
ds_read_b64_tr_b16 v[96:97], v28 offset:0
ds_read_b64_tr_b16 v[98:99], v28 offset:2048
M v[36:39], v[168:171], a[176:179], v[36:39]
M v[40:43], v[176:179], a[176:179], v[40:43]
buffer_load_dwordx4 v7, s[48:51], s26 offen offset:1024 lds
M v[40:43], v[180:183], a[180:183], v[40:43]
M v[44:47], v[188:191], a[180:183], v[44:47]
ds_read_b64_tr_b16 v[100:101], v28 offset:4096
ds_read_b64_tr_b16 v[102:103], v28 offset:6144
M v[44:47], v[184:187], a[176:179], v[44:47]
M v[48:51], v[192:195], a[176:179], v[48:51]
buffer_load_dwordx4 a[128:131], v1, s[44:47], s25 offen offset:0 sc1
M v[48:51], v[196:199], a[180:183], v[48:51]
M v[52:55], v[204:207], a[180:183], v[52:55]
ds_read_b64_tr_b16 v[104:105], v29 offset:0
ds_read_b64_tr_b16 v[106:107], v29 offset:2048
M v[52:55], v[200:203], a[176:179], v[52:55]
M v[56:59], v[208:211], a[176:179], v[56:59]
buffer_load_dwordx4 a[132:135], v1, s[44:47], s25 offen offset:1024 sc1
M v[56:59], v[212:215], a[180:183], v[56:59]
M v[60:63], v[220:223], a[180:183], v[60:63]
ds_read_b64_tr_b16 v[108:109], v29 offset:4096
ds_read_b64_tr_b16 v[110:111], v29 offset:6144
M v[60:63], v[216:219], a[176:179], v[60:63]
M v[64:67], v[160:163], a[184:187], v[64:67]
buffer_load_dwordx4 a[136:139], v1, s[44:47], s25 offen offset:2048 sc1
M v[64:67], v[164:167], a[188:191], v[64:67]
M v[68:71], v[172:175], a[188:191], v[68:71]
ds_read_b64_tr_b16 v[112:113], v30 offset:0
ds_read_b64_tr_b16 v[114:115], v30 offset:2048
M v[68:71], v[168:171], a[184:187], v[68:71]
M v[72:75], v[176:179], a[184:187], v[72:75]
buffer_load_dwordx4 a[140:143], v1, s[44:47], s25 offen offset:3072 sc1
M v[72:75], v[180:183], a[188:191], v[72:75]
M v[76:79], v[188:191], a[188:191], v[76:79]
ds_read_b64_tr_b16 v[116:117], v30 offset:4096
ds_read_b64_tr_b16 v[118:119], v30 offset:6144
M v[76:79], v[184:187], a[184:187], v[76:79]
M v[80:83], v[192:195], a[184:187], v[80:83]
s_add_u32 s25, s25, 16384
s_add_u32 s26, s26, 131072
M v[80:83], v[196:199], a[188:191], v[80:83]
M v[84:87], v[204:207], a[188:191], v[84:87]
ds_read_b64_tr_b16 v[120:121], v31 offset:0
ds_read_b64_tr_b16 v[122:123], v31 offset:2048
M v[84:87], v[200:203], a[184:187], v[84:87]
M v[88:91], v[208:211], a[184:187], v[88:91]
ds_read_b64_tr_b16 v[124:125], v31 offset:4096
ds_read_b64_tr_b16 v[126:127], v31 offset:6144
M v[88:91], v[212:215], a[188:191], v[88:91]
M v[92:95], v[220:223], a[188:191], v[92:95]
M v[92:95], v[216:219], a[184:187], v[92:95]
s_waitcnt vmcnt(18) lgkmcnt(0)
s_barrier
M a[0:3], v[96:99], a[192:195], a[0:3]
s_add_u32 m0, s42, 16384
s_nop 0
buffer_load_dwordx4 v6, s[48:51], s26 offen offset:0 lds
ds_read_b64_tr_b16 v[160:161], v28 offset:16384
ds_read_b64_tr_b16 v[162:163], v28 offset:18432
M a[0:3], v[100:103], a[196:199], a[0:3]
buffer_load_dwordx4 v7, s[48:51], s26 offen offset:1024 lds
ds_read_b64_tr_b16 v[164:165], v28 offset:20480
ds_read_b64_tr_b16 v[166:167], v28 offset:22528
M a[4:7], v[108:111], a[196:199], a[4:7]
buffer_load_dwordx4 a[144:147], v1, s[44:47], s25 offen offset:0 sc1
ds_read_b64_tr_b16 v[168:169], v29 offset:16384
ds_read_b64_tr_b16 v[170:171], v29 offset:18432
M a[4:7], v[104:107], a[192:195], a[4:7]
buffer_load_dwordx4 a[148:151], v1, s[44:47], s25 offen offset:1024 sc1
M a[8:11], v[112:115], a[192:195], a[8:11]
ds_read_b64_tr_b16 v[172:173], v29 offset:20480
ds_read_b64_tr_b16 v[174:175], v29 offset:22528
buffer_load_dwordx4 a[152:155], v1, s[44:47], s25 offen offset:2048 sc1
M a[8:11], v[116:119], a[196:199], a[8:11]
ds_read_b64_tr_b16 v[176:177], v30 offset:16384
ds_read_b64_tr_b16 v[178:179], v30 offset:18432
buffer_load_dwordx4 a[156:159], v1, s[44:47], s25 offen offset:3072 sc1
M a[12:15], v[124:127], a[196:199], a[12:15]
ds_read_b64_tr_b16 v[180:181], v30 offset:20480
ds_read_b64_tr_b16 v[182:183], v30 offset:22528
M a[12:15], v[120:123], a[192:195], a[12:15]
s_add_u32 s25, s25, 16384
s_add_u32 s26, s26, 131072
ds_read_b64_tr_b16 v[184:185], v31 offset:16384
ds_read_b64_tr_b16 v[186:187], v31 offset:18432
M a[16:19], v[96:99], a[200:203], a[16:19]
s_add_u32 s60, s56, 0
buffer_store_dwordx4 v[48:51], v1, s[52:55], s60 offen offset:0 sc1
ds_read_b64_tr_b16 v[188:189], v31 offset:20480
ds_read_b64_tr_b16 v[190:191], v31 offset:22528
M a[16:19], v[100:103], a[204:207], a[16:19]
buffer_store_dwordx4 v[52:55], v1, s[52:55], s60 offen offset:1024 sc1
buffer_store_dwordx4 v[56:59], v1, s[52:55], s60 offen offset:2048 sc1
M a[20:23], v[108:111], a[204:207], a[20:23]
buffer_store_dwordx4 v[60:63], v1, s[52:55], s60 offen offset:3072 sc1
M a[20:23], v[104:107], a[200:203], a[20:23]
s_add_u32 s60, s56, 4096
buffer_store_dwordx4 v[80:83], v1, s[52:55], s60 offen offset:0 sc1
buffer_store_dwordx4 v[84:87], v1, s[52:55], s60 offen offset:1024 sc1
M a[24:27], v[112:115], a[200:203], a[24:27]
buffer_store_dwordx4 v[88:91], v1, s[52:55], s60 offen offset:2048 sc1
buffer_store_dwordx4 v[92:95], v1, s[52:55], s60 offen offset:3072 sc1
M a[24:27], v[116:119], a[204:207], a[24:27]
v_mov_b32 v11, 0
M a[28:31], v[124:127], a[204:207], a[28:31]
M a[28:31], v[120:123], a[200:203], a[28:31]
s_waitcnt vmcnt(26) lgkmcnt(0)
s_barrier
M a[0:3], v[160:163], a[208:211], a[0:3]
s_add_u32 m0, s42, 32768
s_nop 0
buffer_load_dwordx4 v6, s[48:51], s26 offen offset:0 lds
ds_read_b64_tr_b16 v[96:97], v28 offset:32768
ds_read_b64_tr_b16 v[98:99], v28 offset:34816
M a[0:3], v[164:167], a[212:215], a[0:3]
buffer_load_dwordx4 v7, s[48:51], s26 offen offset:1024 lds
M a[4:7], v[172:175], a[212:215], a[4:7]
ds_read_b64_tr_b16 v[100:101], v28 offset:36864
ds_read_b64_tr_b16 v[102:103], v28 offset:38912
M a[4:7], v[168:171], a[208:211], a[4:7]
buffer_load_dwordx4 a[160:163], v1, s[44:47], s25 offen offset:0 sc1
M a[8:11], v[176:179], a[208:211], a[8:11]
ds_read_b64_tr_b16 v[104:105], v29 offset:32768
ds_read_b64_tr_b16 v[106:107], v29 offset:34816
M a[8:11], v[180:183], a[212:215], a[8:11]
buffer_load_dwordx4 a[164:167], v1, s[44:47], s25 offen offset:1024 sc1
M a[12:15], v[188:191], a[212:215], a[12:15]
ds_read_b64_tr_b16 v[108:109], v29 offset:36864
ds_read_b64_tr_b16 v[110:111], v29 offset:38912
M a[12:15], v[184:187], a[208:211], a[12:15]
buffer_load_dwordx4 a[168:171], v1, s[44:47], s25 offen offset:2048 sc1
M a[16:19], v[160:163], a[216:219], a[16:19]
ds_read_b64_tr_b16 v[112:113], v30 offset:32768
ds_read_b64_tr_b16 v[114:115], v30 offset:34816
M a[16:19], v[164:167], a[220:223], a[16:19]
buffer_load_dwordx4 a[172:175], v1, s[44:47], s25 offen offset:3072 sc1
M a[20:23], v[172:175], a[220:223], a[20:23]
ds_read_b64_tr_b16 v[116:117], v30 offset:36864
ds_read_b64_tr_b16 v[118:119], v30 offset:38912
M a[20:23], v[168:171], a[216:219], a[20:23]
s_add_u32 s25, s25, 16384
s_add_u32 s26, s26, 131072
M a[24:27], v[176:179], a[216:219], a[24:27]
ds_read_b64_tr_b16 v[120:121], v31 offset:32768
ds_read_b64_tr_b16 v[122:123], v31 offset:34816
M a[24:27], v[180:183], a[220:223], a[24:27]
ds_read_b64_tr_b16 v[124:125], v31 offset:36864
ds_read_b64_tr_b16 v[126:127], v31 offset:38912
M a[28:31], v[188:191], a[220:223], a[28:31]
M a[28:31], v[184:187], a[216:219], a[28:31]
s_waitcnt vmcnt(6) lgkmcnt(0)
s_barrier
s_cmp_lg_u32 s101, 0
s_cbranch_scc1 Lk3f_14
v_mov_b32 v9, 1
s_mov_b64 exec, 1
buffer_store_dword v9, v11, s[52:55], s58 offen sc1
s_mov_b64 exec, -1
Lk3f_14:
M a[0:3], v[96:99], a[224:227], a[0:3]
s_add_u32 m0, s42, 49152
s_nop 0
buffer_load_dwordx4 v6, s[48:51], s26 offen offset:0 lds
ds_read_b64_tr_b16 v[160:161], v28 offset:49152
ds_read_b64_tr_b16 v[162:163], v28 offset:51200
M a[0:3], v[100:103], a[228:231], a[0:3]
buffer_load_dwordx4 v7, s[48:51], s26 offen offset:1024 lds
M a[4:7], v[108:111], a[228:231], a[4:7]
ds_read_b64_tr_b16 v[164:165], v28 offset:53248
ds_read_b64_tr_b16 v[166:167], v28 offset:55296
M a[4:7], v[104:107], a[224:227], a[4:7]
buffer_load_dwordx4 a[176:179], v1, s[44:47], s25 offen offset:0 sc1
M a[8:11], v[112:115], a[224:227], a[8:11]
ds_read_b64_tr_b16 v[168:169], v29 offset:49152
ds_read_b64_tr_b16 v[170:171], v29 offset:51200
M a[8:11], v[116:119], a[228:231], a[8:11]
buffer_load_dwordx4 a[180:183], v1, s[44:47], s25 offen offset:1024 sc1
M a[12:15], v[124:127], a[228:231], a[12:15]
ds_read_b64_tr_b16 v[172:173], v29 offset:53248
ds_read_b64_tr_b16 v[174:175], v29 offset:55296
M a[12:15], v[120:123], a[224:227], a[12:15]
buffer_load_dwordx4 a[184:187], v1, s[44:47], s25 offen offset:2048 sc1
M a[16:19], v[96:99], a[232:235], a[16:19]
ds_read_b64_tr_b16 v[176:177], v30 offset:49152
ds_read_b64_tr_b16 v[178:179], v30 offset:51200
M a[16:19], v[100:103], a[236:239], a[16:19]
buffer_load_dwordx4 a[188:191], v1, s[44:47], s25 offen offset:3072 sc1
M a[20:23], v[108:111], a[236:239], a[20:23]
ds_read_b64_tr_b16 v[180:181], v30 offset:53248
ds_read_b64_tr_b16 v[182:183], v30 offset:55296
M a[20:23], v[104:107], a[232:235], a[20:23]
s_add_u32 s25, s25, 16384
s_add_u32 s26, s26, 131072
M a[24:27], v[112:115], a[232:235], a[24:27]
ds_read_b64_tr_b16 v[184:185], v31 offset:49152
ds_read_b64_tr_b16 v[186:187], v31 offset:51200
M a[24:27], v[116:119], a[236:239], a[24:27]
ds_read_b64_tr_b16 v[188:189], v31 offset:53248
ds_read_b64_tr_b16 v[190:191], v31 offset:55296
M a[28:31], v[124:127], a[236:239], a[28:31]
M a[28:31], v[120:123], a[232:235], a[28:31]
s_waitcnt vmcnt(26) lgkmcnt(0)
s_barrier
M a[0:3], v[160:163], a[240:243], a[0:3]
ds_read_b64_tr_b16 v[96:97], v24 offset:0
ds_read_b64_tr_b16 v[98:99], v24 offset:2048
M a[0:3], v[164:167], a[244:247], a[0:3]
ds_read_b64_tr_b16 v[100:101], v24 offset:4096
ds_read_b64_tr_b16 v[102:103], v24 offset:6144
M a[4:7], v[172:175], a[244:247], a[4:7]
M a[4:7], v[168:171], a[240:243], a[4:7]
ds_read_b64_tr_b16 v[104:105], v25 offset:0
ds_read_b64_tr_b16 v[106:107], v25 offset:2048
M a[8:11], v[176:179], a[240:243], a[8:11]
M a[8:11], v[180:183], a[244:247], a[8:11]
ds_read_b64_tr_b16 v[108:109], v25 offset:4096
ds_read_b64_tr_b16 v[110:111], v25 offset:6144
M a[12:15], v[188:191], a[244:247], a[12:15]
M a[12:15], v[184:187], a[240:243], a[12:15]
ds_read_b64_tr_b16 v[112:113], v26 offset:0
ds_read_b64_tr_b16 v[114:115], v26 offset:2048
M a[16:19], v[160:163], a[248:251], a[16:19]
ds_read_b64_tr_b16 v[116:117], v26 offset:4096
ds_read_b64_tr_b16 v[118:119], v26 offset:6144
M a[16:19], v[164:167], a[252:255], a[16:19]
M a[20:23], v[172:175], a[252:255], a[20:23]
ds_read_b64_tr_b16 v[120:121], v27 offset:0
ds_read_b64_tr_b16 v[122:123], v27 offset:2048
M a[20:23], v[168:171], a[248:251], a[20:23]
M a[24:27], v[176:179], a[248:251], a[24:27]
ds_read_b64_tr_b16 v[124:125], v27 offset:4096
ds_read_b64_tr_b16 v[126:127], v27 offset:6144
M a[24:27], v[180:183], a[252:255], a[24:27]
M a[28:31], v[188:191], a[252:255], a[28:31]
M a[28:31], v[184:187], a[248:251], a[28:31]
s_waitcnt vmcnt(20) lgkmcnt(0)
s_barrier
M a[0:3], v[96:99], a[128:131], a[0:3]
ds_read_b64_tr_b16 v[160:161], v24 offset:16384
ds_read_b64_tr_b16 v[162:163], v24 offset:18432
M a[0:3], v[100:103], a[132:135], a[0:3]
ds_read_b64_tr_b16 v[164:165], v24 offset:20480
ds_read_b64_tr_b16 v[166:167], v24 offset:22528
M a[4:7], v[108:111], a[132:135], a[4:7]
M a[4:7], v[104:107], a[128:131], a[4:7]
ds_read_b64_tr_b16 v[168:169], v25 offset:16384
ds_read_b64_tr_b16 v[170:171], v25 offset:18432
M a[8:11], v[112:115], a[128:131], a[8:11]
M a[8:11], v[116:119], a[132:135], a[8:11]
ds_read_b64_tr_b16 v[172:173], v25 offset:20480
ds_read_b64_tr_b16 v[174:175], v25 offset:22528
M a[12:15], v[124:127], a[132:135], a[12:15]
M a[12:15], v[120:123], a[128:131], a[12:15]
ds_read_b64_tr_b16 v[176:177], v26 offset:16384
ds_read_b64_tr_b16 v[178:179], v26 offset:18432
M a[16:19], v[96:99], a[136:139], a[16:19]
ds_read_b64_tr_b16 v[180:181], v26 offset:20480
ds_read_b64_tr_b16 v[182:183], v26 offset:22528
M a[16:19], v[100:103], a[140:143], a[16:19]
M a[20:23], v[108:111], a[140:143], a[20:23]
ds_read_b64_tr_b16 v[184:185], v27 offset:16384
ds_read_b64_tr_b16 v[186:187], v27 offset:18432
M a[20:23], v[104:107], a[136:139], a[20:23]
M a[24:27], v[112:115], a[136:139], a[24:27]
ds_read_b64_tr_b16 v[188:189], v27 offset:20480
ds_read_b64_tr_b16 v[190:191], v27 offset:22528
M a[24:27], v[116:119], a[140:143], a[24:27]
M a[28:31], v[124:127], a[140:143], a[28:31]
M a[28:31], v[120:123], a[136:139], a[28:31]
s_waitcnt vmcnt(6) lgkmcnt(0)
s_barrier
M a[0:3], v[160:163], a[144:147], a[0:3]
buffer_load_dword v8, v11, s[52:55], s59 offen sc1
M a[0:3], v[164:167], a[148:151], a[0:3]
ds_read_b64_tr_b16 v[96:97], v24 offset:32768
ds_read_b64_tr_b16 v[98:99], v24 offset:34816
M a[4:7], v[172:175], a[148:151], a[4:7]
M a[4:7], v[168:171], a[144:147], a[4:7]
ds_read_b64_tr_b16 v[100:101], v24 offset:36864
ds_read_b64_tr_b16 v[102:103], v24 offset:38912
M a[8:11], v[176:179], a[144:147], a[8:11]
ds_read_b64_tr_b16 v[104:105], v25 offset:32768
ds_read_b64_tr_b16 v[106:107], v25 offset:34816
M a[8:11], v[180:183], a[148:151], a[8:11]
M a[12:15], v[188:191], a[148:151], a[12:15]
ds_read_b64_tr_b16 v[108:109], v25 offset:36864
ds_read_b64_tr_b16 v[110:111], v25 offset:38912
M a[12:15], v[184:187], a[144:147], a[12:15]
ds_read_b64_tr_b16 v[112:113], v26 offset:32768
ds_read_b64_tr_b16 v[114:115], v26 offset:34816
M a[16:19], v[160:163], a[152:155], a[16:19]
M a[16:19], v[164:167], a[156:159], a[16:19]
ds_read_b64_tr_b16 v[116:117], v26 offset:36864
ds_read_b64_tr_b16 v[118:119], v26 offset:38912
M a[20:23], v[172:175], a[156:159], a[20:23]
ds_read_b64_tr_b16 v[120:121], v27 offset:32768
ds_read_b64_tr_b16 v[122:123], v27 offset:34816
M a[20:23], v[168:171], a[152:155], a[20:23]
M a[24:27], v[176:179], a[152:155], a[24:27]
ds_read_b64_tr_b16 v[124:125], v27 offset:36864
ds_read_b64_tr_b16 v[126:127], v27 offset:38912
M a[24:27], v[180:183], a[156:159], a[24:27]
M a[28:31], v[188:191], a[156:159], a[28:31]
M a[28:31], v[184:187], a[152:155], a[28:31]
s_waitcnt vmcnt(1) lgkmcnt(0)
s_barrier
s_waitcnt vmcnt(0)
v_cmp_ne_u32 vcc, 1, v8
s_nop 0
s_cbranch_vccnz Lk3_spinfl
Lk3_gotfl:
M a[0:3], v[96:99], a[160:163], a[0:3]
s_add_u32 s60, s57, 0
buffer_load_dwordx4 v[224:227], v1, s[52:55], s60 offen offset:0 sc1
ds_read_b64_tr_b16 v[160:161], v24 offset:49152
ds_read_b64_tr_b16 v[162:163], v24 offset:51200
M a[0:3], v[100:103], a[164:167], a[0:3]
buffer_load_dwordx4 v[228:231], v1, s[52:55], s60 offen offset:1024 sc1
M a[4:7], v[108:111], a[164:167], a[4:7]
ds_read_b64_tr_b16 v[164:165], v24 offset:53248
ds_read_b64_tr_b16 v[166:167], v24 offset:55296
M a[4:7], v[104:107], a[160:163], a[4:7]
buffer_load_dwordx4 v[232:235], v1, s[52:55], s60 offen offset:2048 sc1
M a[8:11], v[112:115], a[160:163], a[8:11]
ds_read_b64_tr_b16 v[168:169], v25 offset:49152
ds_read_b64_tr_b16 v[170:171], v25 offset:51200
M a[8:11], v[116:119], a[164:167], a[8:11]
buffer_load_dwordx4 v[236:239], v1, s[52:55], s60 offen offset:3072 sc1
M a[12:15], v[124:127], a[164:167], a[12:15]
ds_read_b64_tr_b16 v[172:173], v25 offset:53248
ds_read_b64_tr_b16 v[174:175], v25 offset:55296
M a[12:15], v[120:123], a[160:163], a[12:15]
s_add_u32 s60, s57, 4096
buffer_load_dwordx4 v[240:243], v1, s[52:55], s60 offen offset:0 sc1
ds_read_b64_tr_b16 v[176:177], v26 offset:49152
ds_read_b64_tr_b16 v[178:179], v26 offset:51200
M a[16:19], v[96:99], a[168:171], a[16:19]
buffer_load_dwordx4 v[244:247], v1, s[52:55], s60 offen offset:1024 sc1
M a[16:19], v[100:103], a[172:175], a[16:19]
ds_read_b64_tr_b16 v[180:181], v26 offset:53248
ds_read_b64_tr_b16 v[182:183], v26 offset:55296
M a[20:23], v[108:111], a[172:175], a[20:23]
buffer_load_dwordx4 v[248:251], v1, s[52:55], s60 offen offset:2048 sc1
M a[20:23], v[104:107], a[168:171], a[20:23]
ds_read_b64_tr_b16 v[184:185], v27 offset:49152
ds_read_b64_tr_b16 v[186:187], v27 offset:51200
M a[24:27], v[112:115], a[168:171], a[24:27]
buffer_load_dwordx4 v[252:255], v1, s[52:55], s60 offen offset:3072 sc1
M a[24:27], v[116:119], a[172:175], a[24:27]
ds_read_b64_tr_b16 v[188:189], v27 offset:53248
ds_read_b64_tr_b16 v[190:191], v27 offset:55296
M a[28:31], v[124:127], a[172:175], a[28:31]
M a[28:31], v[120:123], a[168:171], a[28:31]
s_waitcnt lgkmcnt(0)
M a[0:3], v[160:163], a[176:179], a[0:3]
M a[0:3], v[164:167], a[180:183], a[0:3]
M a[4:7], v[172:175], a[180:183], a[4:7]
M a[4:7], v[168:171], a[176:179], a[4:7]
M a[8:11], v[176:179], a[176:179], a[8:11]
M a[8:11], v[180:183], a[180:183], a[8:11]
M a[12:15], v[188:191], a[180:183], a[12:15]
M a[12:15], v[184:187], a[176:179], a[12:15]
M a[16:19], v[160:163], a[184:187], a[16:19]
M a[16:19], v[164:167], a[188:191], a[16:19]
M a[20:23], v[172:175], a[188:191], a[20:23]
M a[20:23], v[168:171], a[184:187], a[20:23]
M a[24:27], v[176:179], a[184:187], a[24:27]
M a[24:27], v[180:183], a[188:191], a[24:27]
M a[28:31], v[188:191], a[188:191], a[28:31]
M a[28:31], v[184:187], a[184:187], a[28:31]
v_bfe_u32 v96, v0, 4, 1
v_lshrrev_b32 v97, 5, v0
v_lshl_or_b32 v96, v96, 1, v97
v_and_b32 v97, 15, v0
v_lshlrev_b32 v97, 13, v97
v_lshl_add_u32 v96, v96, 4, v97
s_and_b32 s3, s101, 1
s_lshl_b32 s3, s3, 6
s_lshr_b32 s6, s101, 1
s_add_u32 s3, s3, s6
s_add_u32 s3, s3, s21
s_lshl_b32 s3, s3, 12
s_lshl_b32 s6, s22, 1
s_add_u32 s3, s3, s6
s_add_u32 s3, s3, 2048
v_accvgpr_read_b32 v108, a0
v_accvgpr_read_b32 v109, a1
v_accvgpr_read_b32 v110, a2
v_accvgpr_read_b32 v111, a3
v_accvgpr_read_b32 v112, a4
v_accvgpr_read_b32 v113, a5
v_accvgpr_read_b32 v114, a6
v_accvgpr_read_b32 v115, a7
v_cvt_pk_bf16_f32 v100, v108, v109
v_cvt_pk_bf16_f32 v101, v110, v111
v_cvt_pk_bf16_f32 v102, v112, v113
v_cvt_pk_bf16_f32 v103, v114, v115
s_nop 0
v_permlane16_swap_b32 v100, v102
v_permlane16_swap_b32 v101, v103
buffer_store_dwordx4 v[100:103], v96, s[16:19], s3 offen offset:0
v_accvgpr_read_b32 v108, a8
v_accvgpr_read_b32 v109, a9
v_accvgpr_read_b32 v110, a10
v_accvgpr_read_b32 v111, a11
v_accvgpr_read_b32 v112, a12
v_accvgpr_read_b32 v113, a13
v_accvgpr_read_b32 v114, a14
v_accvgpr_read_b32 v115, a15
v_cvt_pk_bf16_f32 v104, v108, v109
v_cvt_pk_bf16_f32 v105, v110, v111
v_cvt_pk_bf16_f32 v106, v112, v113
v_cvt_pk_bf16_f32 v107, v114, v115
s_nop 0
v_permlane16_swap_b32 v104, v106
v_permlane16_swap_b32 v105, v107
buffer_store_dwordx4 v[104:107], v96, s[16:19], s3 offen offset:64
s_add_u32 s3, s3, 131072
v_accvgpr_read_b32 v108, a16
v_accvgpr_read_b32 v109, a17
v_accvgpr_read_b32 v110, a18
v_accvgpr_read_b32 v111, a19
v_accvgpr_read_b32 v112, a20
v_accvgpr_read_b32 v113, a21
v_accvgpr_read_b32 v114, a22
v_accvgpr_read_b32 v115, a23
v_cvt_pk_bf16_f32 v100, v108, v109
v_cvt_pk_bf16_f32 v101, v110, v111
v_cvt_pk_bf16_f32 v102, v112, v113
v_cvt_pk_bf16_f32 v103, v114, v115
s_nop 0
v_permlane16_swap_b32 v100, v102
v_permlane16_swap_b32 v101, v103
buffer_store_dwordx4 v[100:103], v96, s[16:19], s3 offen offset:0
v_accvgpr_read_b32 v108, a24
v_accvgpr_read_b32 v109, a25
v_accvgpr_read_b32 v110, a26
v_accvgpr_read_b32 v111, a27
v_accvgpr_read_b32 v112, a28
v_accvgpr_read_b32 v113, a29
v_accvgpr_read_b32 v114, a30
v_accvgpr_read_b32 v115, a31
v_cvt_pk_bf16_f32 v104, v108, v109
v_cvt_pk_bf16_f32 v105, v110, v111
v_cvt_pk_bf16_f32 v106, v112, v113
v_cvt_pk_bf16_f32 v107, v114, v115
s_nop 0
v_permlane16_swap_b32 v104, v106
v_permlane16_swap_b32 v105, v107
buffer_store_dwordx4 v[104:107], v96, s[16:19], s3 offen offset:64
v_bfe_u32 v128, v0, 4, 1
v_lshrrev_b32 v129, 5, v0
v_lshl_or_b32 v128, v128, 1, v129
v_and_b32 v129, 15, v0
v_lshlrev_b32 v129, 12, v129
v_lshl_add_u32 v128, v128, 4, v129
s_lshl_b32 s3, s101, 5
s_add_u32 s3, s3, s29
s_lshl_b32 s3, s3, 12
s_lshl_b32 s6, s30, 1
s_add_u32 s3, s3, s6
s_waitcnt vmcnt(4)
v_pk_add_f32 v[32:33], v[32:33], v[224:225]
v_pk_add_f32 v[34:35], v[34:35], v[226:227]
v_pk_add_f32 v[36:37], v[36:37], v[228:229]
v_pk_add_f32 v[38:39], v[38:39], v[230:231]
v_cvt_pk_bf16_f32 v132, v32, v33
v_cvt_pk_bf16_f32 v133, v34, v35
v_cvt_pk_bf16_f32 v134, v36, v37
v_cvt_pk_bf16_f32 v135, v38, v39
s_nop 0
v_permlane16_swap_b32 v132, v134
v_permlane16_swap_b32 v133, v135
buffer_store_dwordx4 v[132:135], v128, s[16:19], s3 offen offset:0
v_pk_add_f32 v[40:41], v[40:41], v[232:233]
v_pk_add_f32 v[42:43], v[42:43], v[234:235]
v_pk_add_f32 v[44:45], v[44:45], v[236:237]
v_pk_add_f32 v[46:47], v[46:47], v[238:239]
v_cvt_pk_bf16_f32 v136, v40, v41
v_cvt_pk_bf16_f32 v137, v42, v43
v_cvt_pk_bf16_f32 v138, v44, v45
v_cvt_pk_bf16_f32 v139, v46, v47
s_nop 0
v_permlane16_swap_b32 v136, v138
v_permlane16_swap_b32 v137, v139
buffer_store_dwordx4 v[136:139], v128, s[16:19], s3 offen offset:64
s_add_u32 s3, s3, 65536
v_pk_add_f32 v[64:65], v[64:65], v[240:241]
v_pk_add_f32 v[66:67], v[66:67], v[242:243]
v_pk_add_f32 v[68:69], v[68:69], v[244:245]
v_pk_add_f32 v[70:71], v[70:71], v[246:247]
v_cvt_pk_bf16_f32 v132, v64, v65
v_cvt_pk_bf16_f32 v133, v66, v67
v_cvt_pk_bf16_f32 v134, v68, v69
v_cvt_pk_bf16_f32 v135, v70, v71
s_nop 0
v_permlane16_swap_b32 v132, v134
v_permlane16_swap_b32 v133, v135
buffer_store_dwordx4 v[132:135], v128, s[16:19], s3 offen offset:0
v_pk_add_f32 v[72:73], v[72:73], v[248:249]
v_pk_add_f32 v[74:75], v[74:75], v[250:251]
v_pk_add_f32 v[76:77], v[76:77], v[252:253]
v_pk_add_f32 v[78:79], v[78:79], v[254:255]
v_cvt_pk_bf16_f32 v136, v72, v73
v_cvt_pk_bf16_f32 v137, v74, v75
v_cvt_pk_bf16_f32 v138, v76, v77
v_cvt_pk_bf16_f32 v139, v78, v79
s_nop 0
v_permlane16_swap_b32 v136, v138
v_permlane16_swap_b32 v137, v139
buffer_store_dwordx4 v[136:139], v128, s[16:19], s3 offen offset:64
s_endpgm
Lk3_spinb0:
v_lshlrev_b32 v96, 2, v0
Lk3_spinb0_:
s_add_u32 s61, s61, 1
s_cmp_gt_u32 s61, 1048576
s_cbranch_scc1 Lk3_gotb0
s_sleep 2
buffer_load_dword v7, v96, s[52:55], s43 offen sc1
s_waitcnt vmcnt(0)
v_cmp_ne_u32 vcc, 1, v7
s_nop 0
s_cbranch_vccnz Lk3_spinb0_
s_branch Lk3_gotb0
Lk3_spinb1:
v_lshlrev_b32 v96, 2, v0
Lk3_spinb1_:
s_add_u32 s61, s61, 1
s_cmp_gt_u32 s61, 1048576
s_cbranch_scc1 Lk3_gotb1
s_sleep 2
buffer_load_dword v7, v96, s[52:55], s43 offen sc1
s_waitcnt vmcnt(0)
v_cmp_ne_u32 vcc, 1, v7
s_nop 0
s_cbranch_vccnz Lk3_spinb1_
s_branch Lk3_gotb1
Lk3_spinft:
s_add_u32 s61, s61, 1
s_cmp_gt_u32 s61, 1048576
s_cbranch_scc1 Lk3_gotft
s_sleep 2
buffer_load_dword v252, v255, s[52:55], s62 offen sc1
s_waitcnt vmcnt(0)
v_cmp_ne_u32 vcc, 1, v252
s_nop 0
s_cbranch_vccnz Lk3_spinft
s_branch Lk3_gotft
Lk3_spinfl:
s_add_u32 s61, s61, 1
s_cmp_gt_u32 s61, 1048576
s_cbranch_scc1 Lk3_gotfl
s_sleep 2
buffer_load_dword v8, v11, s[52:55], s59 offen sc1
s_waitcnt vmcnt(0)
v_cmp_ne_u32 vcc, 1, v8
s_nop 0
s_cbranch_vccnz Lk3_spinfl
s_branch Lk3_gotfl
.section .rodata,"a"
.p2align 6
.amdhsa_kernel concat_heads__compressed_kv_cla__sliding_local_dilated__prompt_kernel
  .amdhsa_next_free_vgpr 512
  .amdhsa_next_free_sgpr 102
  .amdhsa_accum_offset 256
  .amdhsa_group_segment_fixed_size 0
  .amdhsa_kernarg_size 96
  .amdhsa_user_sgpr_count 2
  .amdhsa_user_sgpr_kernarg_segment_ptr 1
  .amdhsa_system_sgpr_workgroup_id_x 1
.end_amdhsa_kernel
```

```asm
; @launch grid=(256,1,1) block=(256,1,1) lds=163840
.amdgcn_target "amdgcn-amd-amdhsa--gfx950"
.text
.macro M d, a, b, c
v_mfma_f32_16x16x32_bf16 \d, \a, \b, \c
.endm
.globl concat_heads__compressed_kv_cla__sliding_local_dilated__prompt_kernel
.p2align 8
.type concat_heads__compressed_kv_cla__sliding_local_dilated__prompt_kernel,@function
concat_heads__compressed_kv_cla__sliding_local_dilated__prompt_kernel:
s_cmp_lt_u32 s2, 256
s_cbranch_scc1 Lk1_go
s_endpgm
Lk1_go:
s_load_dwordx16 s[32:47], s[0:1], 0
s_load_dwordx2 s[48:49], s[0:1], 64
s_load_dwordx2 s[50:51], s[0:1], 88
s_load_dwordx2 s[90:91], s[0:1], 80
v_lshrrev_b32 v24, 6, v0
s_nop 0
v_readfirstlane_b32 s20, v24
v_and_b32 v0, 63, v0
v_lshlrev_b32 v1, 4, v0
s_mov_b32 s101, s20
s_lshr_b32 s21, s20, 1
s_and_b32 s22, s20, 1
s_lshl_b32 s29, s20, 12
s_and_b32 s3, s2, 1
s_lshl_b32 s3, s3, 2
s_bfe_u32 s6, s2, 0x20003
s_add_u32 s3, s3, s6
s_lshl_b32 s52, s3, 8
s_bfe_u32 s3, s2, 0x20001
s_lshl_b32 s3, s3, 2
s_bfe_u32 s7, s2, 0x20005
s_add_u32 s3, s3, s7
s_lshl_b32 s53, s3, 8
s_cmp_lt_u32 s2, 128
s_cselect_b32 s5, 11, 10
s_lshl_b32 s3, s21, 7
s_lshl_b32 s4, s22, 5
s_add_u32 s3, s3, s4
v_lshrrev_b32 v24, 3, v0
v_add_u32 v24, s3, v24
v_and_b32 v25, 7, v0
v_add_u32 v26, 0, v24
v_bfe_u32 v27, v26, 1, 3
v_xor_b32 v27, v27, v25
v_lshlrev_b32 v26, s5, v26
v_lshl_add_u32 v26, v27, 4, v26
v_subrev_u32 v2, 0, v26
v_add_u32 v26, 8, v24
v_bfe_u32 v27, v26, 1, 3
v_xor_b32 v27, v27, v25
v_lshlrev_b32 v26, s5, v26
v_lshl_add_u32 v26, v27, 4, v26
v_subrev_u32 v3, 1024, v26
v_add_u32 v26, 16, v24
v_bfe_u32 v27, v26, 1, 3
v_xor_b32 v27, v27, v25
v_lshlrev_b32 v26, s5, v26
v_lshl_add_u32 v26, v27, 4, v26
v_subrev_u32 v4, 2048, v26
v_add_u32 v26, 24, v24
v_bfe_u32 v27, v26, 1, 3
v_xor_b32 v27, v27, v25
v_lshlrev_b32 v26, s5, v26
v_lshl_add_u32 v26, v27, 4, v26
v_subrev_u32 v5, 3072, v26
s_lshl_b32 s3, s20, 3
v_lshrrev_b32 v24, 5, v0
v_add_u32 v24, s3, v24
v_and_b32 v25, 31, v0
v_add_u32 v26, 0, v24
v_and_b32 v27, 3, v26
v_lshlrev_b32 v27, 1, v27
v_and_or_b32 v27, v26, 8, v27
v_xor_b32 v27, v27, v25
v_lshlrev_b32 v26, 13, v26
v_lshl_add_u32 v26, v27, 4, v26
v_subrev_u32 v6, 0, v26
v_add_u32 v26, 2, v24
v_and_b32 v27, 3, v26
v_lshlrev_b32 v27, 1, v27
v_and_or_b32 v27, v26, 8, v27
v_xor_b32 v27, v27, v25
v_lshlrev_b32 v26, 13, v26
v_lshl_add_u32 v26, v27, 4, v26
v_subrev_u32 v7, 1024, v26
v_add_u32 v26, 4, v24
v_and_b32 v27, 3, v26
v_lshlrev_b32 v27, 1, v27
v_and_or_b32 v27, v26, 8, v27
v_xor_b32 v27, v27, v25
v_lshlrev_b32 v26, 13, v26
v_lshl_add_u32 v26, v27, 4, v26
v_subrev_u32 v8, 2048, v26
v_add_u32 v26, 6, v24
v_and_b32 v27, 3, v26
v_lshlrev_b32 v27, 1, v27
v_and_or_b32 v27, v26, 8, v27
v_xor_b32 v27, v27, v25
v_lshlrev_b32 v26, 13, v26
v_lshl_add_u32 v26, v27, 4, v26
v_subrev_u32 v9, 3072, v26
s_lshl_b32 s23, s52, s5
s_lshl_b32 s31, 64, s5
s_mov_b32 s26, s23
s_lshl_b32 s24, s53, 1
s_mov_b32 s28, s24
s_lshl_b32 s3, 1, s5
s_add_u32 s25, s23, s3
s_lshl_b32 s3, s3, 12
s_add_u32 s27, s24, s3
s_bfe_u32 s3, s2, 0x20001
s_and_b32 s4, s2, 1
s_lshl_b32 s4, s4, 1
s_add_u32 s3, s3, s4
s_and_b32 s3, s3, 3
s_sub_u32 s4, s5, 2
s_lshl_b32 s3, s3, s4
s_add_u32 s23, s23, s3
s_lshl_b32 s3, s3, 12
s_add_u32 s24, s24, s3
s_mov_b32 s95, s6
s_cmp_lt_u32 s2, 128
s_cselect_b32 s6, -1, 8
s_waitcnt lgkmcnt(0)
s_cmp_lt_u32 s2, 128
s_cselect_b64 s[8:9], s[32:33], s[34:35]
s_mov_b32 s10, 2097152
s_cselect_b32 s10, 4194304, s10
s_mov_b32 s11, 0x00020000
s_cselect_b64 s[12:13], s[36:37], s[38:39]
s_mov_b32 s14, 4194304
s_cselect_b32 s14, 8388608, s14
s_mov_b32 s15, 0x00020000
s_mov_b64 s[64:65], s[40:41]
s_add_u32 m0, s29, 65536
s_nop 0
buffer_load_dwordx4 v6, s[12:15], s24 offen offset:0 lds
buffer_load_dwordx4 v7, s[12:15], s24 offen offset:1024 lds
buffer_load_dwordx4 v8, s[12:15], s24 offen offset:2048 lds
buffer_load_dwordx4 v9, s[12:15], s24 offen offset:3072 lds
s_add_u32 s24, s24, 262144
s_add_u32 m0, s29, 0
s_nop 0
buffer_load_dwordx4 v2, s[8:11], s23 offen offset:0 lds
buffer_load_dwordx4 v3, s[8:11], s23 offen offset:1024 lds
buffer_load_dwordx4 v4, s[8:11], s23 offen offset:2048 lds
buffer_load_dwordx4 v5, s[8:11], s23 offen offset:3072 lds
s_add_u32 m0, s29, 81920
s_nop 0
buffer_load_dwordx4 v6, s[12:15], s24 offen offset:0 lds
buffer_load_dwordx4 v7, s[12:15], s24 offen offset:1024 lds
buffer_load_dwordx4 v8, s[12:15], s24 offen offset:2048 lds
buffer_load_dwordx4 v9, s[12:15], s24 offen offset:3072 lds
s_add_u32 s24, s24, 262144
s_cmp_eq_u32 s24, s27
s_cselect_b32 s24, s28, s24
s_sub_u32 s6, s6, 1
s_cmp_eq_u32 s6, 0
s_cselect_b64 s[12:13], s[64:65], s[12:13]
s_add_u32 m0, s29, 98304
s_nop 0
buffer_load_dwordx4 v6, s[12:15], s24 offen offset:0 lds
buffer_load_dwordx4 v7, s[12:15], s24 offen offset:1024 lds
buffer_load_dwordx4 v8, s[12:15], s24 offen offset:2048 lds
buffer_load_dwordx4 v9, s[12:15], s24 offen offset:3072 lds
s_add_u32 s24, s24, 262144
s_add_u32 m0, s29, 16384
s_add_u32 s3, s23, s31
s_nop 0
buffer_load_dwordx4 v2, s[8:11], s3 offen offset:0 lds
buffer_load_dwordx4 v3, s[8:11], s3 offen offset:1024 lds
buffer_load_dwordx4 v4, s[8:11], s3 offen offset:2048 lds
buffer_load_dwordx4 v5, s[8:11], s3 offen offset:3072 lds
s_add_u32 s23, s23, 128
s_cmp_eq_u32 s23, s25
s_cselect_b32 s23, s26, s23
s_add_u32 m0, s29, 114688
s_nop 0
buffer_load_dwordx4 v6, s[12:15], s24 offen offset:0 lds
buffer_load_dwordx4 v7, s[12:15], s24 offen offset:1024 lds
buffer_load_dwordx4 v8, s[12:15], s24 offen offset:2048 lds
buffer_load_dwordx4 v9, s[12:15], s24 offen offset:3072 lds
s_add_u32 s24, s24, 262144
s_cmp_eq_u32 s24, s27
s_cselect_b32 s24, s28, s24
s_sub_u32 s6, s6, 1
s_cmp_eq_u32 s6, 0
s_cselect_b64 s[12:13], s[64:65], s[12:13]
s_add_u32 s16, s50, 109051904
s_addc_u32 s17, s51, 0
s_mov_b32 s18, 16384
s_mov_b32 s19, 0x00020000
v_mov_b32 v24, 0
v_mov_b32 v25, 0
v_mov_b32 v26, 0
v_mov_b32 v27, 0
s_lshl_b32 s3, s2, 2
buffer_store_dword v24, v24, s[16:19], s3 offen sc1
s_and_b32 s3, s2, 7
s_lshr_b32 s4, s2, 6
s_lshl_b32 s4, s4, 3
s_add_u32 s3, s3, s4
s_lshl_b32 s3, s3, 4
s_add_u32 s3, s3, 4096
s_bfe_u32 s4, s2, 0x30003
s_lshl_b32 s4, s4, 9
s_add_u32 s92, s3, s4
s_sub_u32 s4, 7680, s4
s_add_u32 s93, s3, s4
buffer_store_dwordx4 v[24:27], v24, s[16:19], s92 offen sc1
buffer_store_dwordx4 v[24:27], v24, s[16:19], s93 offen sc1
s_and_b32 s3, s2, 1
s_lshl_b32 s3, s3, 3
s_bfe_u32 s4, s2, 0x30003
s_add_u32 s92, s3, s4
s_bfe_u32 s3, s2, 0x20001
s_lshl_b32 s3, s3, 2
s_lshr_b32 s4, s2, 6
s_add_u32 s93, s3, s4
s_lshl_b32 s92, s92, 8
s_lshl_b32 s93, s93, 4
s_add_u32 s92, s92, s93
s_add_u32 s92, s92, 12288
buffer_store_dwordx4 v[24:27], v24, s[16:19], s92 offen sc1
s_mov_b32 s63, 0x00020000
s_cmp_eq_u32 s20, 1
s_cbranch_scc1 Lk1_pfo
s_cmp_eq_u32 s20, 0
s_cbranch_scc0 Lk1_pfw
s_bfe_u32 s4, s2, 0x20001
s_lshl_b32 s3, s7, 2
s_add_u32 s3, s3, s4
s_lshl_b32 s3, s3, 4
v_and_b32 v24, 15, v0
v_add_u32 v24, s3, v24
v_lshlrev_b32 v20, s5, v24
s_mov_b64 s[60:61], s[8:9]
s_mov_b64 s[58:59], s[8:9]
s_mov_b32 s62, s10
s_mov_b32 s7, s10
s_add_u32 s54, s26, 768
s_mov_b32 s55, 128
s_mov_b32 s56, s25
s_mov_b32 s57, s26
s_branch Lk1_pfc
Lk1_pfw:
s_lshl_b32 s3, s95, 4
s_and_b32 s4, s2, 1
s_lshl_b32 s4, s4, 3
s_add_u32 s3, s3, s4
s_lshl_b32 s4, s22, 2
s_add_u32 s3, s3, s4
v_bfe_u32 v24, v0, 2, 2
v_add_u32 v24, s3, v24
v_and_b32 v25, 3, v0
v_lshlrev_b32 v25, 7, v25
v_lshl_add_u32 v20, v24, 13, v25
s_mov_b64 s[60:61], s[12:13]
s_mov_b64 s[58:59], s[40:41]
s_mov_b32 s62, s14
s_mov_b32 s7, s14
s_add_u32 s54, s28, 3670016
s_mov_b32 s55, 524288
s_mov_b32 s56, s27
s_mov_b32 s57, s28
Lk1_pfc:
s_mov_b32 s62, 0
s_mov_b32 s7, 0
v_lshrrev_b32 v24, 4, v0
v_mul_lo_u32 v24, v24, s55
v_add_u32 v24, v24, v20
s_mul_i32 s3, s55, 4
s_sub_u32 s3, s54, s3
buffer_load_dword v21, v24, s[60:63], s3 offen
s_branch Lk1_pfd
Lk1_pfo:
v_lshlrev_b32 v20, 7, v0
s_and_b32 s3, s2, 127
s_lshl_b32 s54, s3, 13
s_mov_b32 s57, s54
s_mov_b32 s55, 1048576
s_cmp_lt_u32 s2, 128
s_cselect_b64 s[60:61], s[46:47], s[42:43]
s_cselect_b64 s[58:59], s[44:45], s[48:49]
s_mov_b32 s4, 8388608
s_cselect_b32 s4, 6291456, s4
s_add_u32 s56, s54, s4
s_mov_b32 s62, s4
s_cmp_lt_u32 s2, 128
s_mov_b32 s7, 2097152
s_cselect_b32 s7, 4194304, s7
s_cselect_b32 s62, s62, 0
s_cselect_b32 s7, s7, 0
buffer_load_dword v21, v20, s[60:63], s54 offen
s_add_u32 s54, s54, s55
s_cmp_eq_u32 s54, s56
s_cselect_b32 s54, s57, s54
s_cselect_b64 s[60:61], s[58:59], s[60:61]
s_cselect_b32 s62, s7, s62
Lk1_pfd:
s_add_u32 m0, s29, 32768
s_nop 0
buffer_load_dwordx4 v2, s[8:11], s23 offen offset:0 lds
buffer_load_dwordx4 v3, s[8:11], s23 offen offset:1024 lds
buffer_load_dwordx4 v4, s[8:11], s23 offen offset:2048 lds
buffer_load_dwordx4 v5, s[8:11], s23 offen offset:3072 lds
s_lshl_b32 s4, s21, 13
v_and_b32 v24, 15, v0
v_lshlrev_b32 v24, 7, v24
v_add_u32 v24, s4, v24
v_bfe_u32 v25, v0, 1, 3
v_lshrrev_b32 v26, 4, v0
v_xor_b32 v25, v25, v26
v_lshl_add_u32 v10, v25, 4, v24
v_xor_b32 v11, 64, v10
v_bfe_u32 v24, v0, 2, 2
v_lshl_add_u32 v29, v26, 3, v24
v_lshlrev_b32 v25, 9, v29
v_and_b32 v27, 1, v0
v_lshl_add_u32 v25, v27, 3, v25
v_add_u32 v25, 65536, v25
v_lshlrev_b32 v24, 1, v24
v_and_or_b32 v24, v29, 8, v24
v_bfe_u32 v26, v0, 1, 1
s_lshl_b32 s4, s22, 4
s_add_u32 s3, s4, 0
v_add_u32 v27, s3, v26
v_xor_b32 v27, v27, v24
v_lshl_add_u32 v12, v27, 4, v25
s_add_u32 s3, s4, 2
v_add_u32 v27, s3, v26
v_xor_b32 v27, v27, v24
v_lshl_add_u32 v13, v27, 4, v25
s_add_u32 s3, s4, 4
v_add_u32 v27, s3, v26
v_xor_b32 v27, v27, v24
v_lshl_add_u32 v14, v27, 4, v25
s_add_u32 s3, s4, 6
v_add_u32 v27, s3, v26
v_xor_b32 v27, v27, v24
v_lshl_add_u32 v15, v27, 4, v25
s_add_u32 s3, s4, 8
v_add_u32 v27, s3, v26
v_xor_b32 v27, v27, v24
v_lshl_add_u32 v16, v27, 4, v25
s_add_u32 s3, s4, 10
v_add_u32 v27, s3, v26
v_xor_b32 v27, v27, v24
v_lshl_add_u32 v17, v27, 4, v25
s_add_u32 s3, s4, 12
v_add_u32 v27, s3, v26
v_xor_b32 v27, v27, v24
v_lshl_add_u32 v18, v27, 4, v25
s_add_u32 s3, s4, 14
v_add_u32 v27, s3, v26
v_xor_b32 v27, v27, v24
v_lshl_add_u32 v19, v27, 4, v25
s_waitcnt vmcnt(21)
s_barrier
ds_read_b64_tr_b16 a[32:33], v12 offset:0
ds_read_b64_tr_b16 a[34:35], v12 offset:2048
ds_read_b64_tr_b16 a[40:41], v13 offset:0
ds_read_b64_tr_b16 a[42:43], v13 offset:2048
ds_read_b64_tr_b16 a[48:49], v14 offset:0
ds_read_b64_tr_b16 a[50:51], v14 offset:2048
ds_read_b64_tr_b16 a[56:57], v15 offset:0
ds_read_b64_tr_b16 a[58:59], v15 offset:2048
ds_read_b64_tr_b16 a[64:65], v16 offset:0
ds_read_b64_tr_b16 a[66:67], v16 offset:2048
ds_read_b64_tr_b16 a[72:73], v17 offset:0
ds_read_b64_tr_b16 a[74:75], v17 offset:2048
ds_read_b64_tr_b16 a[80:81], v18 offset:0
ds_read_b64_tr_b16 a[82:83], v18 offset:2048
ds_read_b64_tr_b16 a[88:89], v19 offset:0
ds_read_b64_tr_b16 a[90:91], v19 offset:2048
ds_read_b64_tr_b16 a[36:37], v12 offset:16384
ds_read_b64_tr_b16 a[38:39], v12 offset:18432
ds_read_b64_tr_b16 a[44:45], v13 offset:16384
ds_read_b64_tr_b16 a[46:47], v13 offset:18432
ds_read_b64_tr_b16 a[52:53], v14 offset:16384
ds_read_b64_tr_b16 a[54:55], v14 offset:18432
ds_read_b64_tr_b16 a[60:61], v15 offset:16384
ds_read_b64_tr_b16 a[62:63], v15 offset:18432
ds_read_b64_tr_b16 a[68:69], v16 offset:16384
ds_read_b64_tr_b16 a[70:71], v16 offset:18432
ds_read_b64_tr_b16 a[76:77], v17 offset:16384
ds_read_b64_tr_b16 a[78:79], v17 offset:18432
ds_read_b64_tr_b16 a[84:85], v18 offset:16384
ds_read_b64_tr_b16 a[86:87], v18 offset:18432
ds_read_b64_tr_b16 a[92:93], v19 offset:16384
ds_read_b64_tr_b16 a[94:95], v19 offset:18432
ds_read_b128 a[160:163], v10 offset:0
ds_read_b128 a[164:167], v11 offset:0
ds_read_b128 a[168:171], v10 offset:2048
ds_read_b128 a[172:175], v11 offset:2048
s_waitcnt vmcnt(17) lgkmcnt(0)
s_barrier
s_add_u32 m0, s29, 65536
s_nop 0
buffer_load_dwordx4 v6, s[12:15], s24 offen offset:0 lds
buffer_load_dwordx4 v7, s[12:15], s24 offen offset:1024 lds
buffer_load_dwordx4 v8, s[12:15], s24 offen offset:2048 lds
buffer_load_dwordx4 v9, s[12:15], s24 offen offset:3072 lds
s_add_u32 s24, s24, 262144
s_add_u32 m0, s29, 49152
s_add_u32 s3, s23, s31
s_nop 0
buffer_load_dwordx4 v2, s[8:11], s3 offen offset:0 lds
buffer_load_dwordx4 v3, s[8:11], s3 offen offset:1024 lds
buffer_load_dwordx4 v4, s[8:11], s3 offen offset:2048 lds
buffer_load_dwordx4 v5, s[8:11], s3 offen offset:3072 lds
s_cmp_lt_u32 s2, 128
s_cbranch_scc0 Lk1_kv
M v[32:35], a[32:35], a[160:163], 0
s_add_u32 s23, s23, 128
s_cmp_eq_u32 s23, s25
s_cselect_b32 s23, s26, s23
M v[32:35], a[36:39], a[164:167], v[32:35]
ds_read_b128 a[176:179], v10 offset:4096
ds_read_b128 a[180:183], v11 offset:4096
M v[36:39], a[44:47], a[164:167], 0
M v[36:39], a[40:43], a[160:163], v[36:39]
ds_read_b64_tr_b16 a[96:97], v12 offset:32768
ds_read_b64_tr_b16 a[98:99], v12 offset:34816
M v[40:43], a[48:51], a[160:163], 0
M v[40:43], a[52:55], a[164:167], v[40:43]
M v[44:47], a[60:63], a[164:167], 0
s_add_u32 m0, s29, 81920
s_nop 0
buffer_load_dwordx4 v6, s[12:15], s24 offen offset:0 lds
M v[44:47], a[56:59], a[160:163], v[44:47]
ds_read_b64_tr_b16 a[104:105], v13 offset:32768
ds_read_b64_tr_b16 a[106:107], v13 offset:34816
M v[48:51], a[64:67], a[160:163], 0
M v[48:51], a[68:71], a[164:167], v[48:51]
M v[52:55], a[76:79], a[164:167], 0
M v[52:55], a[72:75], a[160:163], v[52:55]
ds_read_b64_tr_b16 a[112:113], v14 offset:32768
ds_read_b64_tr_b16 a[114:115], v14 offset:34816
M v[56:59], a[80:83], a[160:163], 0
M v[56:59], a[84:87], a[164:167], v[56:59]
buffer_load_dwordx4 v7, s[12:15], s24 offen offset:1024 lds
M v[60:63], a[92:95], a[164:167], 0
M v[60:63], a[88:91], a[160:163], v[60:63]
ds_read_b64_tr_b16 a[120:121], v15 offset:32768
ds_read_b64_tr_b16 a[122:123], v15 offset:34816
M v[64:67], a[32:35], a[168:171], 0
M v[64:67], a[36:39], a[172:175], v[64:67]
ds_read_b128 a[184:187], v10 offset:6144
ds_read_b128 a[188:191], v11 offset:6144
M v[68:71], a[44:47], a[172:175], 0
M v[68:71], a[40:43], a[168:171], v[68:71]
ds_read_b64_tr_b16 a[128:129], v16 offset:32768
ds_read_b64_tr_b16 a[130:131], v16 offset:34816
M v[72:75], a[48:51], a[168:171], 0
buffer_load_dwordx4 v8, s[12:15], s24 offen offset:2048 lds
M v[72:75], a[52:55], a[172:175], v[72:75]
M v[76:79], a[60:63], a[172:175], 0
M v[76:79], a[56:59], a[168:171], v[76:79]
ds_read_b64_tr_b16 a[136:137], v17 offset:32768
ds_read_b64_tr_b16 a[138:139], v17 offset:34816
M v[80:83], a[64:67], a[168:171], 0
M v[80:83], a[68:71], a[172:175], v[80:83]
M v[84:87], a[76:79], a[172:175], 0
buffer_load_dwordx4 v9, s[12:15], s24 offen offset:3072 lds
M v[84:87], a[72:75], a[168:171], v[84:87]
ds_read_b64_tr_b16 a[144:145], v18 offset:32768
ds_read_b64_tr_b16 a[146:147], v18 offset:34816
M v[88:91], a[80:83], a[168:171], 0
M v[88:91], a[84:87], a[172:175], v[88:91]
M v[92:95], a[92:95], a[172:175], 0
M v[92:95], a[88:91], a[168:171], v[92:95]
s_waitcnt lgkmcnt(15)
ds_read_b64_tr_b16 a[152:153], v19 offset:32768
ds_read_b64_tr_b16 a[154:155], v19 offset:34816
M v[96:99], a[32:35], a[176:179], 0
s_add_u32 s24, s24, 262144
s_cmp_eq_u32 s24, s27
s_cselect_b32 s24, s28, s24
s_sub_u32 s6, s6, 1
s_cmp_eq_u32 s6, 0
s_cselect_b64 s[12:13], s[64:65], s[12:13]
M v[96:99], a[36:39], a[180:183], v[96:99]
M v[100:103], a[44:47], a[180:183], 0
M v[100:103], a[40:43], a[176:179], v[100:103]
M v[104:107], a[48:51], a[176:179], 0
M v[104:107], a[52:55], a[180:183], v[104:107]
M v[108:111], a[60:63], a[180:183], 0
M v[108:111], a[56:59], a[176:179], v[108:111]
s_waitcnt vmcnt(17) lgkmcnt(0)
s_barrier
ds_read_b128 a[160:163], v10 offset:16384
ds_read_b128 a[164:167], v11 offset:16384
M v[112:115], a[64:67], a[176:179], 0
s_add_u32 m0, s29, 0
s_nop 0
buffer_load_dwordx4 v2, s[8:11], s23 offen offset:0 lds
M v[112:115], a[68:71], a[180:183], v[112:115]
M v[116:119], a[76:79], a[180:183], 0
M v[116:119], a[72:75], a[176:179], v[116:119]
ds_read_b64_tr_b16 a[100:101], v12 offset:49152
ds_read_b64_tr_b16 a[102:103], v12 offset:51200
M v[120:123], a[80:83], a[176:179], 0
M v[120:123], a[84:87], a[180:183], v[120:123]
buffer_load_dwordx4 v3, s[8:11], s23 offen offset:1024 lds
M v[124:127], a[92:95], a[180:183], 0
M v[124:127], a[88:91], a[176:179], v[124:127]
M v[128:131], a[32:35], a[184:187], 0
M v[128:131], a[36:39], a[188:191], v[128:131]
ds_read_b128 a[168:171], v10 offset:18432
ds_read_b128 a[172:175], v11 offset:18432
ds_read_b64_tr_b16 a[108:109], v13 offset:49152
ds_read_b64_tr_b16 a[110:111], v13 offset:51200
M v[132:135], a[44:47], a[188:191], 0
M v[132:135], a[40:43], a[184:187], v[132:135]
buffer_load_dwordx4 v4, s[8:11], s23 offen offset:2048 lds
M v[136:139], a[48:51], a[184:187], 0
M v[136:139], a[52:55], a[188:191], v[136:139]
M v[140:143], a[60:63], a[188:191], 0
M v[140:143], a[56:59], a[184:187], v[140:143]
ds_read_b64_tr_b16 a[116:117], v14 offset:49152
ds_read_b64_tr_b16 a[118:119], v14 offset:51200
M v[144:147], a[64:67], a[184:187], 0
M v[144:147], a[68:71], a[188:191], v[144:147]
buffer_load_dwordx4 v5, s[8:11], s23 offen offset:3072 lds
M v[148:151], a[76:79], a[188:191], 0
M v[148:151], a[72:75], a[184:187], v[148:151]
M v[152:155], a[80:83], a[184:187], 0
M v[152:155], a[84:87], a[188:191], v[152:155]
ds_read_b64_tr_b16 a[124:125], v15 offset:49152
ds_read_b64_tr_b16 a[126:127], v15 offset:51200
M v[156:159], a[92:95], a[188:191], 0
s_add_u32 m0, s29, 98304
s_nop 0
buffer_load_dwordx4 v6, s[12:15], s24 offen offset:0 lds
M v[156:159], a[88:91], a[184:187], v[156:159]
s_waitcnt lgkmcnt(10)
M v[160:163], a[32:35], a[160:163], 0
M v[160:163], a[36:39], a[164:167], v[160:163]
ds_read_b128 a[176:179], v10 offset:20480
ds_read_b128 a[180:183], v11 offset:20480
M v[164:167], a[44:47], a[164:167], 0
M v[164:167], a[40:43], a[160:163], v[164:167]
ds_read_b64_tr_b16 a[132:133], v16 offset:49152
ds_read_b64_tr_b16 a[134:135], v16 offset:51200
M v[168:171], a[48:51], a[160:163], 0
M v[168:171], a[52:55], a[164:167], v[168:171]
buffer_load_dwordx4 v7, s[12:15], s24 offen offset:1024 lds
M v[172:175], a[60:63], a[164:167], 0
M v[172:175], a[56:59], a[160:163], v[172:175]
M v[176:179], a[64:67], a[160:163], 0
M v[176:179], a[68:71], a[164:167], v[176:179]
ds_read_b64_tr_b16 a[140:141], v17 offset:49152
ds_read_b64_tr_b16 a[142:143], v17 offset:51200
M v[180:183], a[76:79], a[164:167], 0
M v[180:183], a[72:75], a[160:163], v[180:183]
buffer_load_dwordx4 v8, s[12:15], s24 offen offset:2048 lds
M v[184:187], a[80:83], a[160:163], 0
M v[184:187], a[84:87], a[164:167], v[184:187]
M v[188:191], a[92:95], a[164:167], 0
M v[188:191], a[88:91], a[160:163], v[188:191]
s_waitcnt lgkmcnt(12)
ds_read_b64_tr_b16 a[148:149], v18 offset:49152
ds_read_b64_tr_b16 a[150:151], v18 offset:51200
M v[192:195], a[32:35], a[168:171], 0
buffer_load_dwordx4 v9, s[12:15], s24 offen offset:3072 lds
M v[192:195], a[36:39], a[172:175], v[192:195]
ds_read_b128 a[184:187], v10 offset:22528
ds_read_b128 a[188:191], v11 offset:22528
M v[196:199], a[44:47], a[172:175], 0
M v[196:199], a[40:43], a[168:171], v[196:199]
M v[200:203], a[48:51], a[168:171], 0
M v[200:203], a[52:55], a[172:175], v[200:203]
ds_read_b64_tr_b16 a[156:157], v19 offset:49152
ds_read_b64_tr_b16 a[158:159], v19 offset:51200
M v[204:207], a[60:63], a[172:175], 0
s_add_u32 s24, s24, 262144
M v[204:207], a[56:59], a[168:171], v[204:207]
M v[208:211], a[64:67], a[168:171], 0
M v[208:211], a[68:71], a[172:175], v[208:211]
M v[212:215], a[76:79], a[172:175], 0
M v[212:215], a[72:75], a[168:171], v[212:215]
buffer_load_dword v21, v20, s[60:63], s54 offen
s_add_u32 s54, s54, s55
M v[216:219], a[80:83], a[168:171], 0
M v[216:219], a[84:87], a[172:175], v[216:219]
M v[220:223], a[92:95], a[172:175], 0
M v[220:223], a[88:91], a[168:171], v[220:223]
s_waitcnt lgkmcnt(10)
M v[224:227], a[32:35], a[176:179], 0
s_cmp_eq_u32 s54, s56
s_cselect_b32 s54, s57, s54
s_cselect_b64 s[60:61], s[58:59], s[60:61]
s_cselect_b32 s62, s7, s62
M v[224:227], a[36:39], a[180:183], v[224:227]
M v[228:231], a[44:47], a[180:183], 0
M v[228:231], a[40:43], a[176:179], v[228:231]
M v[232:235], a[48:51], a[176:179], 0
M v[232:235], a[52:55], a[180:183], v[232:235]
M v[236:239], a[60:63], a[180:183], 0
M v[236:239], a[56:59], a[176:179], v[236:239]
s_waitcnt vmcnt(17) lgkmcnt(0)
s_barrier
ds_read_b128 a[160:163], v10 offset:32768
ds_read_b128 a[164:167], v11 offset:32768
M v[240:243], a[64:67], a[176:179], 0
s_add_u32 m0, s29, 16384
s_add_u32 s3, s23, s31
buffer_load_dwordx4 v2, s[8:11], s3 offen offset:0 lds
M v[240:243], a[68:71], a[180:183], v[240:243]
M v[244:247], a[76:79], a[180:183], 0
M v[244:247], a[72:75], a[176:179], v[244:247]
M v[248:251], a[80:83], a[176:179], 0
M v[248:251], a[84:87], a[180:183], v[248:251]
buffer_load_dwordx4 v3, s[8:11], s3 offen offset:1024 lds
M v[252:255], a[92:95], a[180:183], 0
M v[252:255], a[88:91], a[176:179], v[252:255]
M a[0:3], a[32:35], a[184:187], 0
M a[0:3], a[36:39], a[188:191], a[0:3]
ds_read_b128 a[168:171], v10 offset:34816
ds_read_b128 a[172:175], v11 offset:34816
M a[4:7], a[44:47], a[188:191], 0
M a[4:7], a[40:43], a[184:187], a[4:7]
M a[8:11], a[48:51], a[184:187], 0
buffer_load_dwordx4 v4, s[8:11], s3 offen offset:2048 lds
M a[8:11], a[52:55], a[188:191], a[8:11]
M a[12:15], a[60:63], a[188:191], 0
M a[12:15], a[56:59], a[184:187], a[12:15]
M a[16:19], a[64:67], a[184:187], 0
M a[16:19], a[68:71], a[188:191], a[16:19]
buffer_load_dwordx4 v5, s[8:11], s3 offen offset:3072 lds
M a[20:23], a[76:79], a[188:191], 0
M a[20:23], a[72:75], a[184:187], a[20:23]
M a[24:27], a[80:83], a[184:187], 0
M a[24:27], a[84:87], a[188:191], a[24:27]
M a[28:31], a[92:95], a[188:191], 0
M a[28:31], a[88:91], a[184:187], a[28:31]
s_waitcnt lgkmcnt(2)
M v[32:35], a[96:99], a[160:163], v[32:35]
s_add_u32 s23, s23, 128
s_cmp_eq_u32 s23, s25
s_cselect_b32 s23, s26, s23
M v[32:35], a[100:103], a[164:167], v[32:35]
ds_read_b128 a[176:179], v10 offset:36864
ds_read_b128 a[180:183], v11 offset:36864
M v[36:39], a[108:111], a[164:167], v[36:39]
M v[36:39], a[104:107], a[160:163], v[36:39]
ds_read_b64_tr_b16 a[32:33], v12 offset:0
ds_read_b64_tr_b16 a[34:35], v12 offset:2048
M v[40:43], a[112:115], a[160:163], v[40:43]
M v[40:43], a[116:119], a[164:167], v[40:43]
M v[44:47], a[124:127], a[164:167], v[44:47]
s_add_u32 m0, s29, 114688
s_nop 0
buffer_load_dwordx4 v6, s[12:15], s24 offen offset:0 lds
M v[44:47], a[120:123], a[160:163], v[44:47]
ds_read_b64_tr_b16 a[40:41], v13 offset:0
ds_read_b64_tr_b16 a[42:43], v13 offset:2048
M v[48:51], a[128:131], a[160:163], v[48:51]
M v[48:51], a[132:135], a[164:167], v[48:51]
M v[52:55], a[140:143], a[164:167], v[52:55]
M v[52:55], a[136:139], a[160:163], v[52:55]
ds_read_b64_tr_b16 a[48:49], v14 offset:0
ds_read_b64_tr_b16 a[50:51], v14 offset:2048
M v[56:59], a[144:147], a[160:163], v[56:59]
M v[56:59], a[148:151], a[164:167], v[56:59]
buffer_load_dwordx4 v7, s[12:15], s24 offen offset:1024 lds
M v[60:63], a[156:159], a[164:167], v[60:63]
M v[60:63], a[152:155], a[160:163], v[60:63]
s_waitcnt lgkmcnt(8)
ds_read_b64_tr_b16 a[56:57], v15 offset:0
ds_read_b64_tr_b16 a[58:59], v15 offset:2048
M v[64:67], a[96:99], a[168:171], v[64:67]
M v[64:67], a[100:103], a[172:175], v[64:67]
ds_read_b128 a[184:187], v10 offset:38912
ds_read_b128 a[188:191], v11 offset:38912
M v[68:71], a[108:111], a[172:175], v[68:71]
M v[68:71], a[104:107], a[168:171], v[68:71]
ds_read_b64_tr_b16 a[64:65], v16 offset:0
ds_read_b64_tr_b16 a[66:67], v16 offset:2048
M v[72:75], a[112:115], a[168:171], v[72:75]
buffer_load_dwordx4 v8, s[12:15], s24 offen offset:2048 lds
M v[72:75], a[116:119], a[172:175], v[72:75]
M v[76:79], a[124:127], a[172:175], v[76:79]
M v[76:79], a[120:123], a[168:171], v[76:79]
ds_read_b64_tr_b16 a[72:73], v17 offset:0
ds_read_b64_tr_b16 a[74:75], v17 offset:2048
M v[80:83], a[128:131], a[168:171], v[80:83]
M v[80:83], a[132:135], a[172:175], v[80:83]
M v[84:87], a[140:143], a[172:175], v[84:87]
buffer_load_dwordx4 v9, s[12:15], s24 offen offset:3072 lds
M v[84:87], a[136:139], a[168:171], v[84:87]
ds_read_b64_tr_b16 a[80:81], v18 offset:0
ds_read_b64_tr_b16 a[82:83], v18 offset:2048
M v[88:91], a[144:147], a[168:171], v[88:91]
M v[88:91], a[148:151], a[172:175], v[88:91]
M v[92:95], a[156:159], a[172:175], v[92:95]
M v[92:95], a[152:155], a[168:171], v[92:95]
s_waitcnt lgkmcnt(15)
ds_read_b64_tr_b16 a[88:89], v19 offset:0
ds_read_b64_tr_b16 a[90:91], v19 offset:2048
M v[96:99], a[96:99], a[176:179], v[96:99]
s_add_u32 s24, s24, 262144
s_cmp_eq_u32 s24, s27
s_cselect_b32 s24, s28, s24
s_sub_u32 s6, s6, 1
s_cmp_eq_u32 s6, 0
s_cselect_b64 s[12:13], s[64:65], s[12:13]
M v[96:99], a[100:103], a[180:183], v[96:99]
M v[100:103], a[108:111], a[180:183], v[100:103]
M v[100:103], a[104:107], a[176:179], v[100:103]
M v[104:107], a[112:115], a[176:179], v[104:107]
M v[104:107], a[116:119], a[180:183], v[104:107]
M v[108:111], a[124:127], a[180:183], v[108:111]
M v[108:111], a[120:123], a[176:179], v[108:111]
s_waitcnt vmcnt(17) lgkmcnt(0)
s_barrier
ds_read_b128 a[160:163], v10 offset:49152
ds_read_b128 a[164:167], v11 offset:49152
M v[112:115], a[128:131], a[176:179], v[112:115]
s_add_u32 m0, s29, 32768
s_nop 0
buffer_load_dwordx4 v2, s[8:11], s23 offen offset:0 lds
M v[112:115], a[132:135], a[180:183], v[112:115]
M v[116:119], a[140:143], a[180:183], v[116:119]
M v[116:119], a[136:139], a[176:179], v[116:119]
ds_read_b64_tr_b16 a[36:37], v12 offset:16384
ds_read_b64_tr_b16 a[38:39], v12 offset:18432
M v[120:123], a[144:147], a[176:179], v[120:123]
M v[120:123], a[148:151], a[180:183], v[120:123]
buffer_load_dwordx4 v3, s[8:11], s23 offen offset:1024 lds
M v[124:127], a[156:159], a[180:183], v[124:127]
M v[124:127], a[152:155], a[176:179], v[124:127]
M v[128:131], a[96:99], a[184:187], v[128:131]
M v[128:131], a[100:103], a[188:191], v[128:131]
ds_read_b128 a[168:171], v10 offset:51200
ds_read_b128 a[172:175], v11 offset:51200
ds_read_b64_tr_b16 a[44:45], v13 offset:16384
ds_read_b64_tr_b16 a[46:47], v13 offset:18432
M v[132:135], a[108:111], a[188:191], v[132:135]
M v[132:135], a[104:107], a[184:187], v[132:135]
buffer_load_dwordx4 v4, s[8:11], s23 offen offset:2048 lds
M v[136:139], a[112:115], a[184:187], v[136:139]
M v[136:139], a[116:119], a[188:191], v[136:139]
M v[140:143], a[124:127], a[188:191], v[140:143]
M v[140:143], a[120:123], a[184:187], v[140:143]
ds_read_b64_tr_b16 a[52:53], v14 offset:16384
ds_read_b64_tr_b16 a[54:55], v14 offset:18432
M v[144:147], a[128:131], a[184:187], v[144:147]
M v[144:147], a[132:135], a[188:191], v[144:147]
buffer_load_dwordx4 v5, s[8:11], s23 offen offset:3072 lds
M v[148:151], a[140:143], a[188:191], v[148:151]
M v[148:151], a[136:139], a[184:187], v[148:151]
M v[152:155], a[144:147], a[184:187], v[152:155]
M v[152:155], a[148:151], a[188:191], v[152:155]
ds_read_b64_tr_b16 a[60:61], v15 offset:16384
ds_read_b64_tr_b16 a[62:63], v15 offset:18432
M v[156:159], a[156:159], a[188:191], v[156:159]
s_add_u32 m0, s29, 65536
s_nop 0
buffer_load_dwordx4 v6, s[12:15], s24 offen offset:0 lds
M v[156:159], a[152:155], a[184:187], v[156:159]
s_waitcnt lgkmcnt(10)
M v[160:163], a[96:99], a[160:163], v[160:163]
M v[160:163], a[100:103], a[164:167], v[160:163]
ds_read_b128 a[176:179], v10 offset:53248
ds_read_b128 a[180:183], v11 offset:53248
M v[164:167], a[108:111], a[164:167], v[164:167]
M v[164:167], a[104:107], a[160:163], v[164:167]
ds_read_b64_tr_b16 a[68:69], v16 offset:16384
ds_read_b64_tr_b16 a[70:71], v16 offset:18432
M v[168:171], a[112:115], a[160:163], v[168:171]
M v[168:171], a[116:119], a[164:167], v[168:171]
buffer_load_dwordx4 v7, s[12:15], s24 offen offset:1024 lds
M v[172:175], a[124:127], a[164:167], v[172:175]
M v[172:175], a[120:123], a[160:163], v[172:175]
M v[176:179], a[128:131], a[160:163], v[176:179]
M v[176:179], a[132:135], a[164:167], v[176:179]
ds_read_b64_tr_b16 a[76:77], v17 offset:16384
ds_read_b64_tr_b16 a[78:79], v17 offset:18432
M v[180:183], a[140:143], a[164:167], v[180:183]
M v[180:183], a[136:139], a[160:163], v[180:183]
buffer_load_dwordx4 v8, s[12:15], s24 offen offset:2048 lds
M v[184:187], a[144:147], a[160:163], v[184:187]
M v[184:187], a[148:151], a[164:167], v[184:187]
M v[188:191], a[156:159], a[164:167], v[188:191]
M v[188:191], a[152:155], a[160:163], v[188:191]
s_waitcnt lgkmcnt(12)
ds_read_b64_tr_b16 a[84:85], v18 offset:16384
ds_read_b64_tr_b16 a[86:87], v18 offset:18432
M v[192:195], a[96:99], a[168:171], v[192:195]
buffer_load_dwordx4 v9, s[12:15], s24 offen offset:3072 lds
M v[192:195], a[100:103], a[172:175], v[192:195]
ds_read_b128 a[184:187], v10 offset:55296
ds_read_b128 a[188:191], v11 offset:55296
M v[196:199], a[108:111], a[172:175], v[196:199]
M v[196:199], a[104:107], a[168:171], v[196:199]
M v[200:203], a[112:115], a[168:171], v[200:203]
M v[200:203], a[116:119], a[172:175], v[200:203]
ds_read_b64_tr_b16 a[92:93], v19 offset:16384
ds_read_b64_tr_b16 a[94:95], v19 offset:18432
M v[204:207], a[124:127], a[172:175], v[204:207]
s_add_u32 s24, s24, 262144
M v[204:207], a[120:123], a[168:171], v[204:207]
M v[208:211], a[128:131], a[168:171], v[208:211]
M v[208:211], a[132:135], a[172:175], v[208:211]
M v[212:215], a[140:143], a[172:175], v[212:215]
M v[212:215], a[136:139], a[168:171], v[212:215]
buffer_load_dword v21, v20, s[60:63], s54 offen
s_add_u32 s54, s54, s55
M v[216:219], a[144:147], a[168:171], v[216:219]
M v[216:219], a[148:151], a[172:175], v[216:219]
M v[220:223], a[156:159], a[172:175], v[220:223]
M v[220:223], a[152:155], a[168:171], v[220:223]
s_waitcnt lgkmcnt(10)
M v[224:227], a[96:99], a[176:179], v[224:227]
s_cmp_eq_u32 s54, s56
s_cselect_b32 s54, s57, s54
s_cselect_b64 s[60:61], s[58:59], s[60:61]
s_cselect_b32 s62, s7, s62
M v[224:227], a[100:103], a[180:183], v[224:227]
M v[228:231], a[108:111], a[180:183], v[228:231]
M v[228:231], a[104:107], a[176:179], v[228:231]
M v[232:235], a[112:115], a[176:179], v[232:235]
M v[232:235], a[116:119], a[180:183], v[232:235]
M v[236:239], a[124:127], a[180:183], v[236:239]
M v[236:239], a[120:123], a[176:179], v[236:239]
s_waitcnt vmcnt(18) lgkmcnt(0)
s_barrier
ds_read_b128 a[160:163], v10 offset:0
ds_read_b128 a[164:167], v11 offset:0
M v[240:243], a[128:131], a[176:179], v[240:243]
s_add_u32 m0, s29, 49152
s_add_u32 s3, s23, s31
buffer_load_dwordx4 v2, s[8:11], s3 offen offset:0 lds
M v[240:243], a[132:135], a[180:183], v[240:243]
M v[244:247], a[140:143], a[180:183], v[244:247]
M v[244:247], a[136:139], a[176:179], v[244:247]
M v[248:251], a[144:147], a[176:179], v[248:251]
M v[248:251], a[148:151], a[180:183], v[248:251]
buffer_load_dwordx4 v3, s[8:11], s3 offen offset:1024 lds
M v[252:255], a[156:159], a[180:183], v[252:255]
M v[252:255], a[152:155], a[176:179], v[252:255]
M a[0:3], a[96:99], a[184:187], a[0:3]
M a[0:3], a[100:103], a[188:191], a[0:3]
ds_read_b128 a[168:171], v10 offset:2048
ds_read_b128 a[172:175], v11 offset:2048
M a[4:7], a[108:111], a[188:191], a[4:7]
M a[4:7], a[104:107], a[184:187], a[4:7]
M a[8:11], a[112:115], a[184:187], a[8:11]
buffer_load_dwordx4 v4, s[8:11], s3 offen offset:2048 lds
M a[8:11], a[116:119], a[188:191], a[8:11]
M a[12:15], a[124:127], a[188:191], a[12:15]
M a[12:15], a[120:123], a[184:187], a[12:15]
M a[16:19], a[128:131], a[184:187], a[16:19]
M a[16:19], a[132:135], a[188:191], a[16:19]
buffer_load_dwordx4 v5, s[8:11], s3 offen offset:3072 lds
M a[20:23], a[140:143], a[188:191], a[20:23]
M a[20:23], a[136:139], a[184:187], a[20:23]
M a[24:27], a[144:147], a[184:187], a[24:27]
M a[24:27], a[148:151], a[188:191], a[24:27]
M a[28:31], a[156:159], a[188:191], a[28:31]
M a[28:31], a[152:155], a[184:187], a[28:31]
s_waitcnt lgkmcnt(2)
s_mov_b32 s30, 5
Lk1_ql:
M v[32:35], a[32:35], a[160:163], v[32:35]
s_add_u32 s23, s23, 128
s_cmp_eq_u32 s23, s25
s_cselect_b32 s23, s26, s23
M v[32:35], a[36:39], a[164:167], v[32:35]
ds_read_b128 a[176:179], v10 offset:4096
ds_read_b128 a[180:183], v11 offset:4096
M v[36:39], a[44:47], a[164:167], v[36:39]
M v[36:39], a[40:43], a[160:163], v[36:39]
ds_read_b64_tr_b16 a[96:97], v12 offset:32768
ds_read_b64_tr_b16 a[98:99], v12 offset:34816
M v[40:43], a[48:51], a[160:163], v[40:43]
M v[40:43], a[52:55], a[164:167], v[40:43]
M v[44:47], a[60:63], a[164:167], v[44:47]
s_add_u32 m0, s29, 81920
s_nop 0
buffer_load_dwordx4 v6, s[12:15], s24 offen offset:0 lds
M v[44:47], a[56:59], a[160:163], v[44:47]
ds_read_b64_tr_b16 a[104:105], v13 offset:32768
ds_read_b64_tr_b16 a[106:107], v13 offset:34816
M v[48:51], a[64:67], a[160:163], v[48:51]
M v[48:51], a[68:71], a[164:167], v[48:51]
M v[52:55], a[76:79], a[164:167], v[52:55]
M v[52:55], a[72:75], a[160:163], v[52:55]
ds_read_b64_tr_b16 a[112:113], v14 offset:32768
ds_read_b64_tr_b16 a[114:115], v14 offset:34816
M v[56:59], a[80:83], a[160:163], v[56:59]
M v[56:59], a[84:87], a[164:167], v[56:59]
buffer_load_dwordx4 v7, s[12:15], s24 offen offset:1024 lds
M v[60:63], a[92:95], a[164:167], v[60:63]
M v[60:63], a[88:91], a[160:163], v[60:63]
s_waitcnt lgkmcnt(8)
ds_read_b64_tr_b16 a[120:121], v15 offset:32768
ds_read_b64_tr_b16 a[122:123], v15 offset:34816
M v[64:67], a[32:35], a[168:171], v[64:67]
M v[64:67], a[36:39], a[172:175], v[64:67]
ds_read_b128 a[184:187], v10 offset:6144
ds_read_b128 a[188:191], v11 offset:6144
M v[68:71], a[44:47], a[172:175], v[68:71]
M v[68:71], a[40:43], a[168:171], v[68:71]
ds_read_b64_tr_b16 a[128:129], v16 offset:32768
ds_read_b64_tr_b16 a[130:131], v16 offset:34816
M v[72:75], a[48:51], a[168:171], v[72:75]
buffer_load_dwordx4 v8, s[12:15], s24 offen offset:2048 lds
M v[72:75], a[52:55], a[172:175], v[72:75]
M v[76:79], a[60:63], a[172:175], v[76:79]
M v[76:79], a[56:59], a[168:171], v[76:79]
ds_read_b64_tr_b16 a[136:137], v17 offset:32768
ds_read_b64_tr_b16 a[138:139], v17 offset:34816
M v[80:83], a[64:67], a[168:171], v[80:83]
M v[80:83], a[68:71], a[172:175], v[80:83]
M v[84:87], a[76:79], a[172:175], v[84:87]
buffer_load_dwordx4 v9, s[12:15], s24 offen offset:3072 lds
M v[84:87], a[72:75], a[168:171], v[84:87]
ds_read_b64_tr_b16 a[144:145], v18 offset:32768
ds_read_b64_tr_b16 a[146:147], v18 offset:34816
M v[88:91], a[80:83], a[168:171], v[88:91]
M v[88:91], a[84:87], a[172:175], v[88:91]
M v[92:95], a[92:95], a[172:175], v[92:95]
M v[92:95], a[88:91], a[168:171], v[92:95]
s_waitcnt lgkmcnt(15)
ds_read_b64_tr_b16 a[152:153], v19 offset:32768
ds_read_b64_tr_b16 a[154:155], v19 offset:34816
M v[96:99], a[32:35], a[176:179], v[96:99]
s_add_u32 s24, s24, 262144
s_cmp_eq_u32 s24, s27
s_cselect_b32 s24, s28, s24
s_sub_u32 s6, s6, 1
s_cmp_eq_u32 s6, 0
s_cselect_b64 s[12:13], s[64:65], s[12:13]
M v[96:99], a[36:39], a[180:183], v[96:99]
M v[100:103], a[44:47], a[180:183], v[100:103]
M v[100:103], a[40:43], a[176:179], v[100:103]
M v[104:107], a[48:51], a[176:179], v[104:107]
M v[104:107], a[52:55], a[180:183], v[104:107]
M v[108:111], a[60:63], a[180:183], v[108:111]
M v[108:111], a[56:59], a[176:179], v[108:111]
s_waitcnt vmcnt(17) lgkmcnt(0)
s_barrier
ds_read_b128 a[160:163], v10 offset:16384
ds_read_b128 a[164:167], v11 offset:16384
M v[112:115], a[64:67], a[176:179], v[112:115]
s_add_u32 m0, s29, 0
s_nop 0
buffer_load_dwordx4 v2, s[8:11], s23 offen offset:0 lds
M v[112:115], a[68:71], a[180:183], v[112:115]
M v[116:119], a[76:79], a[180:183], v[116:119]
M v[116:119], a[72:75], a[176:179], v[116:119]
ds_read_b64_tr_b16 a[100:101], v12 offset:49152
ds_read_b64_tr_b16 a[102:103], v12 offset:51200
M v[120:123], a[80:83], a[176:179], v[120:123]
M v[120:123], a[84:87], a[180:183], v[120:123]
buffer_load_dwordx4 v3, s[8:11], s23 offen offset:1024 lds
M v[124:127], a[92:95], a[180:183], v[124:127]
M v[124:127], a[88:91], a[176:179], v[124:127]
M v[128:131], a[32:35], a[184:187], v[128:131]
M v[128:131], a[36:39], a[188:191], v[128:131]
ds_read_b128 a[168:171], v10 offset:18432
ds_read_b128 a[172:175], v11 offset:18432
ds_read_b64_tr_b16 a[108:109], v13 offset:49152
ds_read_b64_tr_b16 a[110:111], v13 offset:51200
M v[132:135], a[44:47], a[188:191], v[132:135]
M v[132:135], a[40:43], a[184:187], v[132:135]
buffer_load_dwordx4 v4, s[8:11], s23 offen offset:2048 lds
M v[136:139], a[48:51], a[184:187], v[136:139]
M v[136:139], a[52:55], a[188:191], v[136:139]
M v[140:143], a[60:63], a[188:191], v[140:143]
M v[140:143], a[56:59], a[184:187], v[140:143]
ds_read_b64_tr_b16 a[116:117], v14 offset:49152
ds_read_b64_tr_b16 a[118:119], v14 offset:51200
M v[144:147], a[64:67], a[184:187], v[144:147]
M v[144:147], a[68:71], a[188:191], v[144:147]
buffer_load_dwordx4 v5, s[8:11], s23 offen offset:3072 lds
M v[148:151], a[76:79], a[188:191], v[148:151]
M v[148:151], a[72:75], a[184:187], v[148:151]
M v[152:155], a[80:83], a[184:187], v[152:155]
M v[152:155], a[84:87], a[188:191], v[152:155]
ds_read_b64_tr_b16 a[124:125], v15 offset:49152
ds_read_b64_tr_b16 a[126:127], v15 offset:51200
M v[156:159], a[92:95], a[188:191], v[156:159]
s_add_u32 m0, s29, 98304
s_nop 0
buffer_load_dwordx4 v6, s[12:15], s24 offen offset:0 lds
M v[156:159], a[88:91], a[184:187], v[156:159]
s_waitcnt lgkmcnt(10)
M v[160:163], a[32:35], a[160:163], v[160:163]
M v[160:163], a[36:39], a[164:167], v[160:163]
ds_read_b128 a[176:179], v10 offset:20480
ds_read_b128 a[180:183], v11 offset:20480
M v[164:167], a[44:47], a[164:167], v[164:167]
M v[164:167], a[40:43], a[160:163], v[164:167]
ds_read_b64_tr_b16 a[132:133], v16 offset:49152
ds_read_b64_tr_b16 a[134:135], v16 offset:51200
M v[168:171], a[48:51], a[160:163], v[168:171]
M v[168:171], a[52:55], a[164:167], v[168:171]
buffer_load_dwordx4 v7, s[12:15], s24 offen offset:1024 lds
M v[172:175], a[60:63], a[164:167], v[172:175]
M v[172:175], a[56:59], a[160:163], v[172:175]
M v[176:179], a[64:67], a[160:163], v[176:179]
M v[176:179], a[68:71], a[164:167], v[176:179]
ds_read_b64_tr_b16 a[140:141], v17 offset:49152
ds_read_b64_tr_b16 a[142:143], v17 offset:51200
M v[180:183], a[76:79], a[164:167], v[180:183]
M v[180:183], a[72:75], a[160:163], v[180:183]
buffer_load_dwordx4 v8, s[12:15], s24 offen offset:2048 lds
M v[184:187], a[80:83], a[160:163], v[184:187]
M v[184:187], a[84:87], a[164:167], v[184:187]
M v[188:191], a[92:95], a[164:167], v[188:191]
M v[188:191], a[88:91], a[160:163], v[188:191]
s_waitcnt lgkmcnt(12)
ds_read_b64_tr_b16 a[148:149], v18 offset:49152
ds_read_b64_tr_b16 a[150:151], v18 offset:51200
M v[192:195], a[32:35], a[168:171], v[192:195]
buffer_load_dwordx4 v9, s[12:15], s24 offen offset:3072 lds
M v[192:195], a[36:39], a[172:175], v[192:195]
ds_read_b128 a[184:187], v10 offset:22528
ds_read_b128 a[188:191], v11 offset:22528
M v[196:199], a[44:47], a[172:175], v[196:199]
M v[196:199], a[40:43], a[168:171], v[196:199]
M v[200:203], a[48:51], a[168:171], v[200:203]
M v[200:203], a[52:55], a[172:175], v[200:203]
ds_read_b64_tr_b16 a[156:157], v19 offset:49152
ds_read_b64_tr_b16 a[158:159], v19 offset:51200
M v[204:207], a[60:63], a[172:175], v[204:207]
s_add_u32 s24, s24, 262144
M v[204:207], a[56:59], a[168:171], v[204:207]
M v[208:211], a[64:67], a[168:171], v[208:211]
M v[208:211], a[68:71], a[172:175], v[208:211]
M v[212:215], a[76:79], a[172:175], v[212:215]
M v[212:215], a[72:75], a[168:171], v[212:215]
buffer_load_dword v21, v20, s[60:63], s54 offen
s_add_u32 s54, s54, s55
M v[216:219], a[80:83], a[168:171], v[216:219]
M v[216:219], a[84:87], a[172:175], v[216:219]
M v[220:223], a[92:95], a[172:175], v[220:223]
M v[220:223], a[88:91], a[168:171], v[220:223]
s_waitcnt lgkmcnt(10)
M v[224:227], a[32:35], a[176:179], v[224:227]
s_cmp_eq_u32 s54, s56
s_cselect_b32 s54, s57, s54
s_cselect_b64 s[60:61], s[58:59], s[60:61]
s_cselect_b32 s62, s7, s62
M v[224:227], a[36:39], a[180:183], v[224:227]
M v[228:231], a[44:47], a[180:183], v[228:231]
M v[228:231], a[40:43], a[176:179], v[228:231]
M v[232:235], a[48:51], a[176:179], v[232:235]
M v[232:235], a[52:55], a[180:183], v[232:235]
M v[236:239], a[60:63], a[180:183], v[236:239]
M v[236:239], a[56:59], a[176:179], v[236:239]
s_waitcnt vmcnt(18) lgkmcnt(0)
s_barrier
ds_read_b128 a[160:163], v10 offset:32768
ds_read_b128 a[164:167], v11 offset:32768
M v[240:243], a[64:67], a[176:179], v[240:243]
s_add_u32 m0, s29, 16384
s_add_u32 s3, s23, s31
buffer_load_dwordx4 v2, s[8:11], s3 offen offset:0 lds
M v[240:243], a[68:71], a[180:183], v[240:243]
M v[244:247], a[76:79], a[180:183], v[244:247]
M v[244:247], a[72:75], a[176:179], v[244:247]
M v[248:251], a[80:83], a[176:179], v[248:251]
M v[248:251], a[84:87], a[180:183], v[248:251]
buffer_load_dwordx4 v3, s[8:11], s3 offen offset:1024 lds
M v[252:255], a[92:95], a[180:183], v[252:255]
M v[252:255], a[88:91], a[176:179], v[252:255]
M a[0:3], a[32:35], a[184:187], a[0:3]
M a[0:3], a[36:39], a[188:191], a[0:3]
ds_read_b128 a[168:171], v10 offset:34816
ds_read_b128 a[172:175], v11 offset:34816
M a[4:7], a[44:47], a[188:191], a[4:7]
M a[4:7], a[40:43], a[184:187], a[4:7]
M a[8:11], a[48:51], a[184:187], a[8:11]
buffer_load_dwordx4 v4, s[8:11], s3 offen offset:2048 lds
M a[8:11], a[52:55], a[188:191], a[8:11]
M a[12:15], a[60:63], a[188:191], a[12:15]
M a[12:15], a[56:59], a[184:187], a[12:15]
M a[16:19], a[64:67], a[184:187], a[16:19]
M a[16:19], a[68:71], a[188:191], a[16:19]
buffer_load_dwordx4 v5, s[8:11], s3 offen offset:3072 lds
M a[20:23], a[76:79], a[188:191], a[20:23]
M a[20:23], a[72:75], a[184:187], a[20:23]
M a[24:27], a[80:83], a[184:187], a[24:27]
M a[24:27], a[84:87], a[188:191], a[24:27]
M a[28:31], a[92:95], a[188:191], a[28:31]
M a[28:31], a[88:91], a[184:187], a[28:31]
s_waitcnt lgkmcnt(2)
M v[32:35], a[96:99], a[160:163], v[32:35]
s_add_u32 s23, s23, 128
s_cmp_eq_u32 s23, s25
s_cselect_b32 s23, s26, s23
M v[32:35], a[100:103], a[164:167], v[32:35]
ds_read_b128 a[176:179], v10 offset:36864
ds_read_b128 a[180:183], v11 offset:36864
M v[36:39], a[108:111], a[164:167], v[36:39]
M v[36:39], a[104:107], a[160:163], v[36:39]
ds_read_b64_tr_b16 a[32:33], v12 offset:0
ds_read_b64_tr_b16 a[34:35], v12 offset:2048
M v[40:43], a[112:115], a[160:163], v[40:43]
M v[40:43], a[116:119], a[164:167], v[40:43]
M v[44:47], a[124:127], a[164:167], v[44:47]
s_add_u32 m0, s29, 114688
s_nop 0
buffer_load_dwordx4 v6, s[12:15], s24 offen offset:0 lds
M v[44:47], a[120:123], a[160:163], v[44:47]
ds_read_b64_tr_b16 a[40:41], v13 offset:0
ds_read_b64_tr_b16 a[42:43], v13 offset:2048
M v[48:51], a[128:131], a[160:163], v[48:51]
M v[48:51], a[132:135], a[164:167], v[48:51]
M v[52:55], a[140:143], a[164:167], v[52:55]
M v[52:55], a[136:139], a[160:163], v[52:55]
ds_read_b64_tr_b16 a[48:49], v14 offset:0
ds_read_b64_tr_b16 a[50:51], v14 offset:2048
M v[56:59], a[144:147], a[160:163], v[56:59]
M v[56:59], a[148:151], a[164:167], v[56:59]
buffer_load_dwordx4 v7, s[12:15], s24 offen offset:1024 lds
M v[60:63], a[156:159], a[164:167], v[60:63]
M v[60:63], a[152:155], a[160:163], v[60:63]
s_waitcnt lgkmcnt(8)
ds_read_b64_tr_b16 a[56:57], v15 offset:0
ds_read_b64_tr_b16 a[58:59], v15 offset:2048
M v[64:67], a[96:99], a[168:171], v[64:67]
M v[64:67], a[100:103], a[172:175], v[64:67]
ds_read_b128 a[184:187], v10 offset:38912
ds_read_b128 a[188:191], v11 offset:38912
M v[68:71], a[108:111], a[172:175], v[68:71]
M v[68:71], a[104:107], a[168:171], v[68:71]
ds_read_b64_tr_b16 a[64:65], v16 offset:0
ds_read_b64_tr_b16 a[66:67], v16 offset:2048
M v[72:75], a[112:115], a[168:171], v[72:75]
buffer_load_dwordx4 v8, s[12:15], s24 offen offset:2048 lds
M v[72:75], a[116:119], a[172:175], v[72:75]
M v[76:79], a[124:127], a[172:175], v[76:79]
M v[76:79], a[120:123], a[168:171], v[76:79]
ds_read_b64_tr_b16 a[72:73], v17 offset:0
ds_read_b64_tr_b16 a[74:75], v17 offset:2048
M v[80:83], a[128:131], a[168:171], v[80:83]
M v[80:83], a[132:135], a[172:175], v[80:83]
M v[84:87], a[140:143], a[172:175], v[84:87]
buffer_load_dwordx4 v9, s[12:15], s24 offen offset:3072 lds
M v[84:87], a[136:139], a[168:171], v[84:87]
ds_read_b64_tr_b16 a[80:81], v18 offset:0
ds_read_b64_tr_b16 a[82:83], v18 offset:2048
M v[88:91], a[144:147], a[168:171], v[88:91]
M v[88:91], a[148:151], a[172:175], v[88:91]
M v[92:95], a[156:159], a[172:175], v[92:95]
M v[92:95], a[152:155], a[168:171], v[92:95]
s_waitcnt lgkmcnt(15)
ds_read_b64_tr_b16 a[88:89], v19 offset:0
ds_read_b64_tr_b16 a[90:91], v19 offset:2048
M v[96:99], a[96:99], a[176:179], v[96:99]
s_add_u32 s24, s24, 262144
s_cmp_eq_u32 s24, s27
s_cselect_b32 s24, s28, s24
s_sub_u32 s6, s6, 1
s_cmp_eq_u32 s6, 0
s_cselect_b64 s[12:13], s[64:65], s[12:13]
M v[96:99], a[100:103], a[180:183], v[96:99]
M v[100:103], a[108:111], a[180:183], v[100:103]
M v[100:103], a[104:107], a[176:179], v[100:103]
M v[104:107], a[112:115], a[176:179], v[104:107]
M v[104:107], a[116:119], a[180:183], v[104:107]
M v[108:111], a[124:127], a[180:183], v[108:111]
M v[108:111], a[120:123], a[176:179], v[108:111]
s_waitcnt vmcnt(17) lgkmcnt(0)
s_barrier
ds_read_b128 a[160:163], v10 offset:49152
ds_read_b128 a[164:167], v11 offset:49152
M v[112:115], a[128:131], a[176:179], v[112:115]
s_add_u32 m0, s29, 32768
s_nop 0
buffer_load_dwordx4 v2, s[8:11], s23 offen offset:0 lds
M v[112:115], a[132:135], a[180:183], v[112:115]
M v[116:119], a[140:143], a[180:183], v[116:119]
M v[116:119], a[136:139], a[176:179], v[116:119]
ds_read_b64_tr_b16 a[36:37], v12 offset:16384
ds_read_b64_tr_b16 a[38:39], v12 offset:18432
M v[120:123], a[144:147], a[176:179], v[120:123]
M v[120:123], a[148:151], a[180:183], v[120:123]
buffer_load_dwordx4 v3, s[8:11], s23 offen offset:1024 lds
M v[124:127], a[156:159], a[180:183], v[124:127]
M v[124:127], a[152:155], a[176:179], v[124:127]
M v[128:131], a[96:99], a[184:187], v[128:131]
M v[128:131], a[100:103], a[188:191], v[128:131]
ds_read_b128 a[168:171], v10 offset:51200
ds_read_b128 a[172:175], v11 offset:51200
ds_read_b64_tr_b16 a[44:45], v13 offset:16384
ds_read_b64_tr_b16 a[46:47], v13 offset:18432
M v[132:135], a[108:111], a[188:191], v[132:135]
M v[132:135], a[104:107], a[184:187], v[132:135]
buffer_load_dwordx4 v4, s[8:11], s23 offen offset:2048 lds
M v[136:139], a[112:115], a[184:187], v[136:139]
M v[136:139], a[116:119], a[188:191], v[136:139]
M v[140:143], a[124:127], a[188:191], v[140:143]
M v[140:143], a[120:123], a[184:187], v[140:143]
ds_read_b64_tr_b16 a[52:53], v14 offset:16384
ds_read_b64_tr_b16 a[54:55], v14 offset:18432
M v[144:147], a[128:131], a[184:187], v[144:147]
M v[144:147], a[132:135], a[188:191], v[144:147]
buffer_load_dwordx4 v5, s[8:11], s23 offen offset:3072 lds
M v[148:151], a[140:143], a[188:191], v[148:151]
M v[148:151], a[136:139], a[184:187], v[148:151]
M v[152:155], a[144:147], a[184:187], v[152:155]
M v[152:155], a[148:151], a[188:191], v[152:155]
ds_read_b64_tr_b16 a[60:61], v15 offset:16384
ds_read_b64_tr_b16 a[62:63], v15 offset:18432
M v[156:159], a[156:159], a[188:191], v[156:159]
s_add_u32 m0, s29, 65536
s_nop 0
buffer_load_dwordx4 v6, s[12:15], s24 offen offset:0 lds
M v[156:159], a[152:155], a[184:187], v[156:159]
s_waitcnt lgkmcnt(10)
M v[160:163], a[96:99], a[160:163], v[160:163]
M v[160:163], a[100:103], a[164:167], v[160:163]
ds_read_b128 a[176:179], v10 offset:53248
ds_read_b128 a[180:183], v11 offset:53248
M v[164:167], a[108:111], a[164:167], v[164:167]
M v[164:167], a[104:107], a[160:163], v[164:167]
ds_read_b64_tr_b16 a[68:69], v16 offset:16384
ds_read_b64_tr_b16 a[70:71], v16 offset:18432
M v[168:171], a[112:115], a[160:163], v[168:171]
M v[168:171], a[116:119], a[164:167], v[168:171]
buffer_load_dwordx4 v7, s[12:15], s24 offen offset:1024 lds
M v[172:175], a[124:127], a[164:167], v[172:175]
M v[172:175], a[120:123], a[160:163], v[172:175]
M v[176:179], a[128:131], a[160:163], v[176:179]
M v[176:179], a[132:135], a[164:167], v[176:179]
ds_read_b64_tr_b16 a[76:77], v17 offset:16384
ds_read_b64_tr_b16 a[78:79], v17 offset:18432
M v[180:183], a[140:143], a[164:167], v[180:183]
M v[180:183], a[136:139], a[160:163], v[180:183]
buffer_load_dwordx4 v8, s[12:15], s24 offen offset:2048 lds
M v[184:187], a[144:147], a[160:163], v[184:187]
M v[184:187], a[148:151], a[164:167], v[184:187]
M v[188:191], a[156:159], a[164:167], v[188:191]
M v[188:191], a[152:155], a[160:163], v[188:191]
s_waitcnt lgkmcnt(12)
ds_read_b64_tr_b16 a[84:85], v18 offset:16384
ds_read_b64_tr_b16 a[86:87], v18 offset:18432
M v[192:195], a[96:99], a[168:171], v[192:195]
buffer_load_dwordx4 v9, s[12:15], s24 offen offset:3072 lds
M v[192:195], a[100:103], a[172:175], v[192:195]
ds_read_b128 a[184:187], v10 offset:55296
ds_read_b128 a[188:191], v11 offset:55296
M v[196:199], a[108:111], a[172:175], v[196:199]
M v[196:199], a[104:107], a[168:171], v[196:199]
M v[200:203], a[112:115], a[168:171], v[200:203]
M v[200:203], a[116:119], a[172:175], v[200:203]
ds_read_b64_tr_b16 a[92:93], v19 offset:16384
ds_read_b64_tr_b16 a[94:95], v19 offset:18432
M v[204:207], a[124:127], a[172:175], v[204:207]
s_add_u32 s24, s24, 262144
M v[204:207], a[120:123], a[168:171], v[204:207]
M v[208:211], a[128:131], a[168:171], v[208:211]
M v[208:211], a[132:135], a[172:175], v[208:211]
M v[212:215], a[140:143], a[172:175], v[212:215]
M v[212:215], a[136:139], a[168:171], v[212:215]
buffer_load_dword v21, v20, s[60:63], s54 offen
s_add_u32 s54, s54, s55
M v[216:219], a[144:147], a[168:171], v[216:219]
M v[216:219], a[148:151], a[172:175], v[216:219]
M v[220:223], a[156:159], a[172:175], v[220:223]
M v[220:223], a[152:155], a[168:171], v[220:223]
s_waitcnt lgkmcnt(10)
M v[224:227], a[96:99], a[176:179], v[224:227]
s_cmp_eq_u32 s54, s56
s_cselect_b32 s54, s57, s54
s_cselect_b64 s[60:61], s[58:59], s[60:61]
s_cselect_b32 s62, s7, s62
M v[224:227], a[100:103], a[180:183], v[224:227]
M v[228:231], a[108:111], a[180:183], v[228:231]
M v[228:231], a[104:107], a[176:179], v[228:231]
M v[232:235], a[112:115], a[176:179], v[232:235]
M v[232:235], a[116:119], a[180:183], v[232:235]
M v[236:239], a[124:127], a[180:183], v[236:239]
M v[236:239], a[120:123], a[176:179], v[236:239]
s_waitcnt vmcnt(18) lgkmcnt(0)
s_barrier
ds_read_b128 a[160:163], v10 offset:0
ds_read_b128 a[164:167], v11 offset:0
M v[240:243], a[128:131], a[176:179], v[240:243]
s_add_u32 m0, s29, 49152
s_add_u32 s3, s23, s31
buffer_load_dwordx4 v2, s[8:11], s3 offen offset:0 lds
M v[240:243], a[132:135], a[180:183], v[240:243]
M v[244:247], a[140:143], a[180:183], v[244:247]
M v[244:247], a[136:139], a[176:179], v[244:247]
M v[248:251], a[144:147], a[176:179], v[248:251]
M v[248:251], a[148:151], a[180:183], v[248:251]
buffer_load_dwordx4 v3, s[8:11], s3 offen offset:1024 lds
M v[252:255], a[156:159], a[180:183], v[252:255]
M v[252:255], a[152:155], a[176:179], v[252:255]
M a[0:3], a[96:99], a[184:187], a[0:3]
M a[0:3], a[100:103], a[188:191], a[0:3]
ds_read_b128 a[168:171], v10 offset:2048
ds_read_b128 a[172:175], v11 offset:2048
M a[4:7], a[108:111], a[188:191], a[4:7]
M a[4:7], a[104:107], a[184:187], a[4:7]
M a[8:11], a[112:115], a[184:187], a[8:11]
buffer_load_dwordx4 v4, s[8:11], s3 offen offset:2048 lds
M a[8:11], a[116:119], a[188:191], a[8:11]
M a[12:15], a[124:127], a[188:191], a[12:15]
M a[12:15], a[120:123], a[184:187], a[12:15]
M a[16:19], a[128:131], a[184:187], a[16:19]
M a[16:19], a[132:135], a[188:191], a[16:19]
buffer_load_dwordx4 v5, s[8:11], s3 offen offset:3072 lds
M a[20:23], a[140:143], a[188:191], a[20:23]
M a[20:23], a[136:139], a[184:187], a[20:23]
M a[24:27], a[144:147], a[184:187], a[24:27]
M a[24:27], a[148:151], a[188:191], a[24:27]
M a[28:31], a[156:159], a[188:191], a[28:31]
M a[28:31], a[152:155], a[184:187], a[28:31]
s_waitcnt lgkmcnt(2)
s_sub_u32 s30, s30, 1
s_cmp_lg_u32 s30, 0
s_cbranch_scc1 Lk1_ql
M v[32:35], a[32:35], a[160:163], v[32:35]
s_add_u32 s23, s23, 128
s_cmp_eq_u32 s23, s25
s_cselect_b32 s23, s26, s23
M v[32:35], a[36:39], a[164:167], v[32:35]
ds_read_b128 a[176:179], v10 offset:4096
ds_read_b128 a[180:183], v11 offset:4096
M v[36:39], a[44:47], a[164:167], v[36:39]
M v[36:39], a[40:43], a[160:163], v[36:39]
ds_read_b64_tr_b16 a[96:97], v12 offset:32768
ds_read_b64_tr_b16 a[98:99], v12 offset:34816
M v[40:43], a[48:51], a[160:163], v[40:43]
M v[40:43], a[52:55], a[164:167], v[40:43]
M v[44:47], a[60:63], a[164:167], v[44:47]
s_add_u32 m0, s29, 81920
s_nop 0
buffer_load_dwordx4 v6, s[12:15], s24 offen offset:0 lds
M v[44:47], a[56:59], a[160:163], v[44:47]
ds_read_b64_tr_b16 a[104:105], v13 offset:32768
ds_read_b64_tr_b16 a[106:107], v13 offset:34816
M v[48:51], a[64:67], a[160:163], v[48:51]
M v[48:51], a[68:71], a[164:167], v[48:51]
M v[52:55], a[76:79], a[164:167], v[52:55]
M v[52:55], a[72:75], a[160:163], v[52:55]
ds_read_b64_tr_b16 a[112:113], v14 offset:32768
ds_read_b64_tr_b16 a[114:115], v14 offset:34816
M v[56:59], a[80:83], a[160:163], v[56:59]
M v[56:59], a[84:87], a[164:167], v[56:59]
buffer_load_dwordx4 v7, s[12:15], s24 offen offset:1024 lds
M v[60:63], a[92:95], a[164:167], v[60:63]
M v[60:63], a[88:91], a[160:163], v[60:63]
s_waitcnt lgkmcnt(8)
ds_read_b64_tr_b16 a[120:121], v15 offset:32768
ds_read_b64_tr_b16 a[122:123], v15 offset:34816
M v[64:67], a[32:35], a[168:171], v[64:67]
M v[64:67], a[36:39], a[172:175], v[64:67]
ds_read_b128 a[184:187], v10 offset:6144
ds_read_b128 a[188:191], v11 offset:6144
M v[68:71], a[44:47], a[172:175], v[68:71]
M v[68:71], a[40:43], a[168:171], v[68:71]
ds_read_b64_tr_b16 a[128:129], v16 offset:32768
ds_read_b64_tr_b16 a[130:131], v16 offset:34816
M v[72:75], a[48:51], a[168:171], v[72:75]
buffer_load_dwordx4 v8, s[12:15], s24 offen offset:2048 lds
M v[72:75], a[52:55], a[172:175], v[72:75]
M v[76:79], a[60:63], a[172:175], v[76:79]
M v[76:79], a[56:59], a[168:171], v[76:79]
ds_read_b64_tr_b16 a[136:137], v17 offset:32768
ds_read_b64_tr_b16 a[138:139], v17 offset:34816
M v[80:83], a[64:67], a[168:171], v[80:83]
M v[80:83], a[68:71], a[172:175], v[80:83]
M v[84:87], a[76:79], a[172:175], v[84:87]
buffer_load_dwordx4 v9, s[12:15], s24 offen offset:3072 lds
M v[84:87], a[72:75], a[168:171], v[84:87]
ds_read_b64_tr_b16 a[144:145], v18 offset:32768
ds_read_b64_tr_b16 a[146:147], v18 offset:34816
M v[88:91], a[80:83], a[168:171], v[88:91]
M v[88:91], a[84:87], a[172:175], v[88:91]
M v[92:95], a[92:95], a[172:175], v[92:95]
M v[92:95], a[88:91], a[168:171], v[92:95]
s_waitcnt lgkmcnt(15)
ds_read_b64_tr_b16 a[152:153], v19 offset:32768
ds_read_b64_tr_b16 a[154:155], v19 offset:34816
M v[96:99], a[32:35], a[176:179], v[96:99]
s_add_u32 s24, s24, 262144
s_cmp_eq_u32 s24, s27
s_cselect_b32 s24, s28, s24
s_sub_u32 s6, s6, 1
s_cmp_eq_u32 s6, 0
s_cselect_b64 s[12:13], s[64:65], s[12:13]
M v[96:99], a[36:39], a[180:183], v[96:99]
M v[100:103], a[44:47], a[180:183], v[100:103]
M v[100:103], a[40:43], a[176:179], v[100:103]
M v[104:107], a[48:51], a[176:179], v[104:107]
M v[104:107], a[52:55], a[180:183], v[104:107]
M v[108:111], a[60:63], a[180:183], v[108:111]
M v[108:111], a[56:59], a[176:179], v[108:111]
s_waitcnt vmcnt(17) lgkmcnt(0)
s_barrier
ds_read_b128 a[160:163], v10 offset:16384
ds_read_b128 a[164:167], v11 offset:16384
M v[112:115], a[64:67], a[176:179], v[112:115]
s_add_u32 m0, s29, 0
s_nop 0
buffer_load_dwordx4 v2, s[8:11], s23 offen offset:0 lds
M v[112:115], a[68:71], a[180:183], v[112:115]
M v[116:119], a[76:79], a[180:183], v[116:119]
M v[116:119], a[72:75], a[176:179], v[116:119]
ds_read_b64_tr_b16 a[100:101], v12 offset:49152
ds_read_b64_tr_b16 a[102:103], v12 offset:51200
M v[120:123], a[80:83], a[176:179], v[120:123]
M v[120:123], a[84:87], a[180:183], v[120:123]
M v[124:127], a[92:95], a[180:183], v[124:127]
buffer_load_dwordx4 v3, s[8:11], s23 offen offset:1024 lds
M v[124:127], a[88:91], a[176:179], v[124:127]
M v[128:131], a[32:35], a[184:187], v[128:131]
M v[128:131], a[36:39], a[188:191], v[128:131]
ds_read_b128 a[168:171], v10 offset:18432
ds_read_b128 a[172:175], v11 offset:18432
ds_read_b64_tr_b16 a[108:109], v13 offset:49152
ds_read_b64_tr_b16 a[110:111], v13 offset:51200
M v[132:135], a[44:47], a[188:191], v[132:135]
M v[132:135], a[40:43], a[184:187], v[132:135]
M v[136:139], a[48:51], a[184:187], v[136:139]
M v[136:139], a[52:55], a[188:191], v[136:139]
buffer_load_dwordx4 v4, s[8:11], s23 offen offset:2048 lds
M v[140:143], a[60:63], a[188:191], v[140:143]
M v[140:143], a[56:59], a[184:187], v[140:143]
ds_read_b64_tr_b16 a[116:117], v14 offset:49152
ds_read_b64_tr_b16 a[118:119], v14 offset:51200
M v[144:147], a[64:67], a[184:187], v[144:147]
M v[144:147], a[68:71], a[188:191], v[144:147]
M v[148:151], a[76:79], a[188:191], v[148:151]
M v[148:151], a[72:75], a[184:187], v[148:151]
M v[152:155], a[80:83], a[184:187], v[152:155]
buffer_load_dwordx4 v5, s[8:11], s23 offen offset:3072 lds
M v[152:155], a[84:87], a[188:191], v[152:155]
ds_read_b64_tr_b16 a[124:125], v15 offset:49152
ds_read_b64_tr_b16 a[126:127], v15 offset:51200
M v[156:159], a[92:95], a[188:191], v[156:159]
M v[156:159], a[88:91], a[184:187], v[156:159]
s_waitcnt lgkmcnt(10)
M v[160:163], a[32:35], a[160:163], v[160:163]
M v[160:163], a[36:39], a[164:167], v[160:163]
ds_read_b128 a[176:179], v10 offset:20480
ds_read_b128 a[180:183], v11 offset:20480
M v[164:167], a[44:47], a[164:167], v[164:167]
M v[164:167], a[40:43], a[160:163], v[164:167]
ds_read_b64_tr_b16 a[132:133], v16 offset:49152
ds_read_b64_tr_b16 a[134:135], v16 offset:51200
M v[168:171], a[48:51], a[160:163], v[168:171]
M v[168:171], a[52:55], a[164:167], v[168:171]
s_add_u32 m0, s29, 98304
s_nop 0
buffer_load_dwordx4 v6, s[12:15], s24 offen offset:0 lds
M v[172:175], a[60:63], a[164:167], v[172:175]
M v[172:175], a[56:59], a[160:163], v[172:175]
M v[176:179], a[64:67], a[160:163], v[176:179]
M v[176:179], a[68:71], a[164:167], v[176:179]
ds_read_b64_tr_b16 a[140:141], v17 offset:49152
ds_read_b64_tr_b16 a[142:143], v17 offset:51200
M v[180:183], a[76:79], a[164:167], v[180:183]
M v[180:183], a[72:75], a[160:163], v[180:183]
buffer_load_dwordx4 v7, s[12:15], s24 offen offset:1024 lds
M v[184:187], a[80:83], a[160:163], v[184:187]
M v[184:187], a[84:87], a[164:167], v[184:187]
M v[188:191], a[92:95], a[164:167], v[188:191]
M v[188:191], a[88:91], a[160:163], v[188:191]
s_waitcnt lgkmcnt(12)
ds_read_b64_tr_b16 a[148:149], v18 offset:49152
ds_read_b64_tr_b16 a[150:151], v18 offset:51200
M v[192:195], a[32:35], a[168:171], v[192:195]
M v[192:195], a[36:39], a[172:175], v[192:195]
ds_read_b128 a[184:187], v10 offset:22528
ds_read_b128 a[188:191], v11 offset:22528
M v[196:199], a[44:47], a[172:175], v[196:199]
M v[196:199], a[40:43], a[168:171], v[196:199]
buffer_load_dwordx4 v8, s[12:15], s24 offen offset:2048 lds
M v[200:203], a[48:51], a[168:171], v[200:203]
M v[200:203], a[52:55], a[172:175], v[200:203]
ds_read_b64_tr_b16 a[156:157], v19 offset:49152
ds_read_b64_tr_b16 a[158:159], v19 offset:51200
M v[204:207], a[60:63], a[172:175], v[204:207]
M v[204:207], a[56:59], a[168:171], v[204:207]
M v[208:211], a[64:67], a[168:171], v[208:211]
M v[208:211], a[68:71], a[172:175], v[208:211]
buffer_load_dwordx4 v9, s[12:15], s24 offen offset:3072 lds
M v[212:215], a[76:79], a[172:175], v[212:215]
M v[212:215], a[72:75], a[168:171], v[212:215]
M v[216:219], a[80:83], a[168:171], v[216:219]
M v[216:219], a[84:87], a[172:175], v[216:219]
M v[220:223], a[92:95], a[172:175], v[220:223]
s_add_u32 s24, s24, 262144
M v[220:223], a[88:91], a[168:171], v[220:223]
s_waitcnt lgkmcnt(10)
M v[224:227], a[32:35], a[176:179], v[224:227]
M v[224:227], a[36:39], a[180:183], v[224:227]
M v[228:231], a[44:47], a[180:183], v[228:231]
M v[228:231], a[40:43], a[176:179], v[228:231]
M v[232:235], a[48:51], a[176:179], v[232:235]
M v[232:235], a[52:55], a[180:183], v[232:235]
M v[236:239], a[60:63], a[180:183], v[236:239]
M v[236:239], a[56:59], a[176:179], v[236:239]
s_waitcnt vmcnt(17) lgkmcnt(0)
s_barrier
ds_read_b128 a[160:163], v10 offset:32768
ds_read_b128 a[164:167], v11 offset:32768
M v[240:243], a[64:67], a[176:179], v[240:243]
s_add_u32 m0, s29, 16384
s_add_u32 s3, s23, s31
buffer_load_dwordx4 v2, s[8:11], s3 offen offset:0 lds
M v[240:243], a[68:71], a[180:183], v[240:243]
M v[244:247], a[76:79], a[180:183], v[244:247]
M v[244:247], a[72:75], a[176:179], v[244:247]
M v[248:251], a[80:83], a[176:179], v[248:251]
M v[248:251], a[84:87], a[180:183], v[248:251]
buffer_load_dwordx4 v3, s[8:11], s3 offen offset:1024 lds
M v[252:255], a[92:95], a[180:183], v[252:255]
M v[252:255], a[88:91], a[176:179], v[252:255]
M a[0:3], a[32:35], a[184:187], a[0:3]
M a[0:3], a[36:39], a[188:191], a[0:3]
ds_read_b128 a[168:171], v10 offset:34816
ds_read_b128 a[172:175], v11 offset:34816
M a[4:7], a[44:47], a[188:191], a[4:7]
M a[4:7], a[40:43], a[184:187], a[4:7]
M a[8:11], a[48:51], a[184:187], a[8:11]
buffer_load_dwordx4 v4, s[8:11], s3 offen offset:2048 lds
M a[8:11], a[52:55], a[188:191], a[8:11]
M a[12:15], a[60:63], a[188:191], a[12:15]
M a[12:15], a[56:59], a[184:187], a[12:15]
M a[16:19], a[64:67], a[184:187], a[16:19]
M a[16:19], a[68:71], a[188:191], a[16:19]
buffer_load_dwordx4 v5, s[8:11], s3 offen offset:3072 lds
M a[20:23], a[76:79], a[188:191], a[20:23]
M a[20:23], a[72:75], a[184:187], a[20:23]
M a[24:27], a[80:83], a[184:187], a[24:27]
M a[24:27], a[84:87], a[188:191], a[24:27]
M a[28:31], a[92:95], a[188:191], a[28:31]
M a[28:31], a[88:91], a[184:187], a[28:31]
s_waitcnt lgkmcnt(2)
M v[32:35], a[96:99], a[160:163], v[32:35]
s_add_u32 s23, s23, 128
s_cmp_eq_u32 s23, s25
s_cselect_b32 s23, s26, s23
M v[32:35], a[100:103], a[164:167], v[32:35]
ds_read_b128 a[176:179], v10 offset:36864
ds_read_b128 a[180:183], v11 offset:36864
M v[36:39], a[108:111], a[164:167], v[36:39]
M v[36:39], a[104:107], a[160:163], v[36:39]
ds_read_b64_tr_b16 a[32:33], v12 offset:0
ds_read_b64_tr_b16 a[34:35], v12 offset:2048
M v[40:43], a[112:115], a[160:163], v[40:43]
M v[40:43], a[116:119], a[164:167], v[40:43]
M v[44:47], a[124:127], a[164:167], v[44:47]
s_add_u32 m0, s29, 114688
s_nop 0
buffer_load_dwordx4 v6, s[12:15], s24 offen offset:0 lds
M v[44:47], a[120:123], a[160:163], v[44:47]
ds_read_b64_tr_b16 a[40:41], v13 offset:0
ds_read_b64_tr_b16 a[42:43], v13 offset:2048
M v[48:51], a[128:131], a[160:163], v[48:51]
M v[48:51], a[132:135], a[164:167], v[48:51]
M v[52:55], a[140:143], a[164:167], v[52:55]
M v[52:55], a[136:139], a[160:163], v[52:55]
ds_read_b64_tr_b16 a[48:49], v14 offset:0
ds_read_b64_tr_b16 a[50:51], v14 offset:2048
M v[56:59], a[144:147], a[160:163], v[56:59]
M v[56:59], a[148:151], a[164:167], v[56:59]
buffer_load_dwordx4 v7, s[12:15], s24 offen offset:1024 lds
M v[60:63], a[156:159], a[164:167], v[60:63]
M v[60:63], a[152:155], a[160:163], v[60:63]
s_waitcnt lgkmcnt(8)
ds_read_b64_tr_b16 a[56:57], v15 offset:0
ds_read_b64_tr_b16 a[58:59], v15 offset:2048
M v[64:67], a[96:99], a[168:171], v[64:67]
M v[64:67], a[100:103], a[172:175], v[64:67]
ds_read_b128 a[184:187], v10 offset:38912
ds_read_b128 a[188:191], v11 offset:38912
M v[68:71], a[108:111], a[172:175], v[68:71]
M v[68:71], a[104:107], a[168:171], v[68:71]
ds_read_b64_tr_b16 a[64:65], v16 offset:0
ds_read_b64_tr_b16 a[66:67], v16 offset:2048
M v[72:75], a[112:115], a[168:171], v[72:75]
buffer_load_dwordx4 v8, s[12:15], s24 offen offset:2048 lds
M v[72:75], a[116:119], a[172:175], v[72:75]
M v[76:79], a[124:127], a[172:175], v[76:79]
M v[76:79], a[120:123], a[168:171], v[76:79]
ds_read_b64_tr_b16 a[72:73], v17 offset:0
ds_read_b64_tr_b16 a[74:75], v17 offset:2048
M v[80:83], a[128:131], a[168:171], v[80:83]
M v[80:83], a[132:135], a[172:175], v[80:83]
M v[84:87], a[140:143], a[172:175], v[84:87]
buffer_load_dwordx4 v9, s[12:15], s24 offen offset:3072 lds
M v[84:87], a[136:139], a[168:171], v[84:87]
ds_read_b64_tr_b16 a[80:81], v18 offset:0
ds_read_b64_tr_b16 a[82:83], v18 offset:2048
M v[88:91], a[144:147], a[168:171], v[88:91]
M v[88:91], a[148:151], a[172:175], v[88:91]
M v[92:95], a[156:159], a[172:175], v[92:95]
M v[92:95], a[152:155], a[168:171], v[92:95]
s_waitcnt lgkmcnt(15)
ds_read_b64_tr_b16 a[88:89], v19 offset:0
ds_read_b64_tr_b16 a[90:91], v19 offset:2048
M v[96:99], a[96:99], a[176:179], v[96:99]
s_add_u32 s24, s24, 262144
s_cmp_eq_u32 s24, s27
s_cselect_b32 s24, s28, s24
s_sub_u32 s6, s6, 1
s_cmp_eq_u32 s6, 0
s_cselect_b64 s[12:13], s[64:65], s[12:13]
M v[96:99], a[100:103], a[180:183], v[96:99]
M v[100:103], a[108:111], a[180:183], v[100:103]
M v[100:103], a[104:107], a[176:179], v[100:103]
M v[104:107], a[112:115], a[176:179], v[104:107]
M v[104:107], a[116:119], a[180:183], v[104:107]
M v[108:111], a[124:127], a[180:183], v[108:111]
M v[108:111], a[120:123], a[176:179], v[108:111]
s_waitcnt vmcnt(16) lgkmcnt(0)
s_barrier
ds_read_b128 a[160:163], v10 offset:49152
ds_read_b128 a[164:167], v11 offset:49152
M v[112:115], a[128:131], a[176:179], v[112:115]
s_add_u32 m0, s29, 32768
s_nop 0
buffer_load_dwordx4 v2, s[8:11], s23 offen offset:0 lds
M v[112:115], a[132:135], a[180:183], v[112:115]
M v[116:119], a[140:143], a[180:183], v[116:119]
M v[116:119], a[136:139], a[176:179], v[116:119]
ds_read_b64_tr_b16 a[36:37], v12 offset:16384
ds_read_b64_tr_b16 a[38:39], v12 offset:18432
M v[120:123], a[144:147], a[176:179], v[120:123]
M v[120:123], a[148:151], a[180:183], v[120:123]
M v[124:127], a[156:159], a[180:183], v[124:127]
M v[124:127], a[152:155], a[176:179], v[124:127]
M v[128:131], a[96:99], a[184:187], v[128:131]
M v[128:131], a[100:103], a[188:191], v[128:131]
ds_read_b128 a[168:171], v10 offset:51200
ds_read_b128 a[172:175], v11 offset:51200
ds_read_b64_tr_b16 a[44:45], v13 offset:16384
ds_read_b64_tr_b16 a[46:47], v13 offset:18432
M v[132:135], a[108:111], a[188:191], v[132:135]
M v[132:135], a[104:107], a[184:187], v[132:135]
M v[136:139], a[112:115], a[184:187], v[136:139]
M v[136:139], a[116:119], a[188:191], v[136:139]
M v[140:143], a[124:127], a[188:191], v[140:143]
M v[140:143], a[120:123], a[184:187], v[140:143]
ds_read_b64_tr_b16 a[52:53], v14 offset:16384
ds_read_b64_tr_b16 a[54:55], v14 offset:18432
M v[144:147], a[128:131], a[184:187], v[144:147]
buffer_load_dwordx4 v3, s[8:11], s23 offen offset:1024 lds
M v[144:147], a[132:135], a[188:191], v[144:147]
M v[148:151], a[140:143], a[188:191], v[148:151]
M v[148:151], a[136:139], a[184:187], v[148:151]
M v[152:155], a[144:147], a[184:187], v[152:155]
M v[152:155], a[148:151], a[188:191], v[152:155]
ds_read_b64_tr_b16 a[60:61], v15 offset:16384
ds_read_b64_tr_b16 a[62:63], v15 offset:18432
M v[156:159], a[156:159], a[188:191], v[156:159]
M v[156:159], a[152:155], a[184:187], v[156:159]
s_waitcnt lgkmcnt(10)
M v[160:163], a[96:99], a[160:163], v[160:163]
M v[160:163], a[100:103], a[164:167], v[160:163]
ds_read_b128 a[176:179], v10 offset:53248
ds_read_b128 a[180:183], v11 offset:53248
M v[164:167], a[108:111], a[164:167], v[164:167]
M v[164:167], a[104:107], a[160:163], v[164:167]
ds_read_b64_tr_b16 a[68:69], v16 offset:16384
ds_read_b64_tr_b16 a[70:71], v16 offset:18432
M v[168:171], a[112:115], a[160:163], v[168:171]
M v[168:171], a[116:119], a[164:167], v[168:171]
M v[172:175], a[124:127], a[164:167], v[172:175]
M v[172:175], a[120:123], a[160:163], v[172:175]
M v[176:179], a[128:131], a[160:163], v[176:179]
buffer_load_dwordx4 v4, s[8:11], s23 offen offset:2048 lds
M v[176:179], a[132:135], a[164:167], v[176:179]
ds_read_b64_tr_b16 a[76:77], v17 offset:16384
ds_read_b64_tr_b16 a[78:79], v17 offset:18432
M v[180:183], a[140:143], a[164:167], v[180:183]
M v[180:183], a[136:139], a[160:163], v[180:183]
M v[184:187], a[144:147], a[160:163], v[184:187]
M v[184:187], a[148:151], a[164:167], v[184:187]
M v[188:191], a[156:159], a[164:167], v[188:191]
M v[188:191], a[152:155], a[160:163], v[188:191]
s_waitcnt lgkmcnt(12)
ds_read_b64_tr_b16 a[84:85], v18 offset:16384
ds_read_b64_tr_b16 a[86:87], v18 offset:18432
M v[192:195], a[96:99], a[168:171], v[192:195]
M v[192:195], a[100:103], a[172:175], v[192:195]
ds_read_b128 a[184:187], v10 offset:55296
ds_read_b128 a[188:191], v11 offset:55296
M v[196:199], a[108:111], a[172:175], v[196:199]
M v[196:199], a[104:107], a[168:171], v[196:199]
M v[200:203], a[112:115], a[168:171], v[200:203]
M v[200:203], a[116:119], a[172:175], v[200:203]
ds_read_b64_tr_b16 a[92:93], v19 offset:16384
ds_read_b64_tr_b16 a[94:95], v19 offset:18432
M v[204:207], a[124:127], a[172:175], v[204:207]
M v[204:207], a[120:123], a[168:171], v[204:207]
M v[208:211], a[128:131], a[168:171], v[208:211]
buffer_load_dwordx4 v5, s[8:11], s23 offen offset:3072 lds
M v[208:211], a[132:135], a[172:175], v[208:211]
M v[212:215], a[140:143], a[172:175], v[212:215]
M v[212:215], a[136:139], a[168:171], v[212:215]
M v[216:219], a[144:147], a[168:171], v[216:219]
M v[216:219], a[148:151], a[172:175], v[216:219]
M v[220:223], a[156:159], a[172:175], v[220:223]
M v[220:223], a[152:155], a[168:171], v[220:223]
s_waitcnt lgkmcnt(10)
M v[224:227], a[96:99], a[176:179], v[224:227]
M v[224:227], a[100:103], a[180:183], v[224:227]
M v[228:231], a[108:111], a[180:183], v[228:231]
M v[228:231], a[104:107], a[176:179], v[228:231]
M v[232:235], a[112:115], a[176:179], v[232:235]
M v[232:235], a[116:119], a[180:183], v[232:235]
M v[236:239], a[124:127], a[180:183], v[236:239]
M v[236:239], a[120:123], a[176:179], v[236:239]
s_waitcnt vmcnt(12) lgkmcnt(0)
s_barrier
ds_read_b128 a[160:163], v10 offset:0
ds_read_b128 a[164:167], v11 offset:0
M v[240:243], a[128:131], a[176:179], v[240:243]
s_add_u32 m0, s29, 49152
s_add_u32 s3, s23, s31
buffer_load_dwordx4 v2, s[8:11], s3 offen offset:0 lds
M v[240:243], a[132:135], a[180:183], v[240:243]
M v[244:247], a[140:143], a[180:183], v[244:247]
M v[244:247], a[136:139], a[176:179], v[244:247]
M v[248:251], a[144:147], a[176:179], v[248:251]
M v[248:251], a[148:151], a[180:183], v[248:251]
M v[252:255], a[156:159], a[180:183], v[252:255]
M v[252:255], a[152:155], a[176:179], v[252:255]
M a[0:3], a[96:99], a[184:187], a[0:3]
M a[0:3], a[100:103], a[188:191], a[0:3]
ds_read_b128 a[168:171], v10 offset:2048
ds_read_b128 a[172:175], v11 offset:2048
M a[4:7], a[108:111], a[188:191], a[4:7]
M a[4:7], a[104:107], a[184:187], a[4:7]
M a[8:11], a[112:115], a[184:187], a[8:11]
buffer_load_dwordx4 v3, s[8:11], s3 offen offset:1024 lds
M a[8:11], a[116:119], a[188:191], a[8:11]
M a[12:15], a[124:127], a[188:191], a[12:15]
M a[12:15], a[120:123], a[184:187], a[12:15]
M a[16:19], a[128:131], a[184:187], a[16:19]
M a[16:19], a[132:135], a[188:191], a[16:19]
M a[20:23], a[140:143], a[188:191], a[20:23]
M a[20:23], a[136:139], a[184:187], a[20:23]
M a[24:27], a[144:147], a[184:187], a[24:27]
M a[24:27], a[148:151], a[188:191], a[24:27]
M a[28:31], a[156:159], a[188:191], a[28:31]
M a[28:31], a[152:155], a[184:187], a[28:31]
s_waitcnt lgkmcnt(2)
M v[32:35], a[32:35], a[160:163], v[32:35]
buffer_load_dwordx4 v4, s[8:11], s3 offen offset:2048 lds
M v[32:35], a[36:39], a[164:167], v[32:35]
ds_read_b128 a[176:179], v10 offset:4096
ds_read_b128 a[180:183], v11 offset:4096
M v[36:39], a[44:47], a[164:167], v[36:39]
M v[36:39], a[40:43], a[160:163], v[36:39]
ds_read_b64_tr_b16 a[96:97], v12 offset:32768
ds_read_b64_tr_b16 a[98:99], v12 offset:34816
M v[40:43], a[48:51], a[160:163], v[40:43]
M v[40:43], a[52:55], a[164:167], v[40:43]
M v[44:47], a[60:63], a[164:167], v[44:47]
M v[44:47], a[56:59], a[160:163], v[44:47]
ds_read_b64_tr_b16 a[104:105], v13 offset:32768
ds_read_b64_tr_b16 a[106:107], v13 offset:34816
M v[48:51], a[64:67], a[160:163], v[48:51]
M v[48:51], a[68:71], a[164:167], v[48:51]
M v[52:55], a[76:79], a[164:167], v[52:55]
M v[52:55], a[72:75], a[160:163], v[52:55]
ds_read_b64_tr_b16 a[112:113], v14 offset:32768
ds_read_b64_tr_b16 a[114:115], v14 offset:34816
M v[56:59], a[80:83], a[160:163], v[56:59]
M v[56:59], a[84:87], a[164:167], v[56:59]
buffer_load_dwordx4 v5, s[8:11], s3 offen offset:3072 lds
M v[60:63], a[92:95], a[164:167], v[60:63]
M v[60:63], a[88:91], a[160:163], v[60:63]
s_waitcnt lgkmcnt(8)
ds_read_b64_tr_b16 a[120:121], v15 offset:32768
ds_read_b64_tr_b16 a[122:123], v15 offset:34816
M v[64:67], a[32:35], a[168:171], v[64:67]
M v[64:67], a[36:39], a[172:175], v[64:67]
ds_read_b128 a[184:187], v10 offset:6144
ds_read_b128 a[188:191], v11 offset:6144
M v[68:71], a[44:47], a[172:175], v[68:71]
M v[68:71], a[40:43], a[168:171], v[68:71]
ds_read_b64_tr_b16 a[128:129], v16 offset:32768
ds_read_b64_tr_b16 a[130:131], v16 offset:34816
M v[72:75], a[48:51], a[168:171], v[72:75]
M v[72:75], a[52:55], a[172:175], v[72:75]
M v[76:79], a[60:63], a[172:175], v[76:79]
M v[76:79], a[56:59], a[168:171], v[76:79]
ds_read_b64_tr_b16 a[136:137], v17 offset:32768
ds_read_b64_tr_b16 a[138:139], v17 offset:34816
M v[80:83], a[64:67], a[168:171], v[80:83]
M v[80:83], a[68:71], a[172:175], v[80:83]
M v[84:87], a[76:79], a[172:175], v[84:87]
s_add_u32 s23, s23, 128
s_cmp_eq_u32 s23, s25
s_cselect_b32 s23, s26, s23
M v[84:87], a[72:75], a[168:171], v[84:87]
ds_read_b64_tr_b16 a[144:145], v18 offset:32768
ds_read_b64_tr_b16 a[146:147], v18 offset:34816
M v[88:91], a[80:83], a[168:171], v[88:91]
M v[88:91], a[84:87], a[172:175], v[88:91]
M v[92:95], a[92:95], a[172:175], v[92:95]
M v[92:95], a[88:91], a[168:171], v[92:95]
s_waitcnt lgkmcnt(15)
ds_read_b64_tr_b16 a[152:153], v19 offset:32768
ds_read_b64_tr_b16 a[154:155], v19 offset:34816
M v[96:99], a[32:35], a[176:179], v[96:99]
M v[96:99], a[36:39], a[180:183], v[96:99]
M v[100:103], a[44:47], a[180:183], v[100:103]
M v[100:103], a[40:43], a[176:179], v[100:103]
M v[104:107], a[48:51], a[176:179], v[104:107]
M v[104:107], a[52:55], a[180:183], v[104:107]
M v[108:111], a[60:63], a[180:183], v[108:111]
M v[108:111], a[56:59], a[176:179], v[108:111]
s_waitcnt vmcnt(8) lgkmcnt(0)
s_barrier
ds_read_b128 a[160:163], v10 offset:16384
ds_read_b128 a[164:167], v11 offset:16384
M v[112:115], a[64:67], a[176:179], v[112:115]
M v[112:115], a[68:71], a[180:183], v[112:115]
s_and_b32 s3, s2, 1
s_lshl_b32 s3, s3, 3
s_bfe_u32 s4, s2, 0x30003
M v[116:119], a[76:79], a[180:183], v[116:119]
s_add_u32 s26, s3, s4
s_bfe_u32 s3, s2, 0x20001
M v[116:119], a[72:75], a[176:179], v[116:119]
ds_read_b64_tr_b16 a[100:101], v12 offset:49152
ds_read_b64_tr_b16 a[102:103], v12 offset:51200
s_lshl_b32 s3, s3, 2
s_lshr_b32 s4, s2, 6
s_add_u32 s27, s3, s4
M v[120:123], a[80:83], a[176:179], v[120:123]
s_lshl_b32 s23, s26, 18
s_sub_u32 s24, s23, 32768
M v[120:123], a[84:87], a[180:183], v[120:123]
s_max_i32 s24, s24, 0
s_lshl_b32 s25, s27, 7
s_xor_b32 s3, s26, s27
M v[124:127], a[92:95], a[180:183], v[124:127]
s_and_b32 s3, s3, 0
s_lshl_b32 s3, s3, 3
M v[124:127], a[88:91], a[176:179], v[124:127]
s_sub_u32 s31, 16, s3
s_mov_b32 s54, s31
s_movk_i32 s57, 128
M v[128:131], a[32:35], a[184:187], v[128:131]
s_mov_b32 s55, 4289069056
s_mov_b32 s56, 393216
M v[128:131], a[36:39], a[188:191], v[128:131]
ds_read_b128 a[168:171], v10 offset:18432
ds_read_b128 a[172:175], v11 offset:18432
ds_read_b64_tr_b16 a[108:109], v13 offset:49152
ds_read_b64_tr_b16 a[110:111], v13 offset:51200
s_lshl_b32 s4, s3, 7
s_add_u32 s23, s23, s4
s_add_u32 s24, s24, s4
M v[132:135], a[44:47], a[188:191], v[132:135]
s_mul_i32 s4, s3, 393216
s_add_u32 s25, s25, s4
M v[132:135], a[40:43], a[184:187], v[132:135]
s_mov_b64 s[8:9], s[44:45]
s_mov_b32 s10, 4194304
s_mov_b64 s[12:13], s[46:47]
M v[136:139], a[48:51], a[184:187], v[136:139]
s_mov_b32 s14, 6291456
s_mov_b64 s[36:37], s[90:91]
M v[136:139], a[52:55], a[188:191], v[136:139]
s_mov_b32 s38, 256
s_mov_b32 s39, 0x00020000
s_lshl_b32 s28, s20, 9
M v[140:143], a[60:63], a[188:191], v[140:143]
s_mul_i32 s30, s20, 6144
s_lshl_b32 s3, s20, 5
M v[140:143], a[56:59], a[184:187], v[140:143]
ds_read_b64_tr_b16 a[116:117], v14 offset:49152
ds_read_b64_tr_b16 a[118:119], v14 offset:51200
v_lshrrev_b32 v24, 3, v0
v_and_b32 v25, 7, v0
v_add_u32 v28, s3, v24
M v[144:147], a[64:67], a[184:187], v[144:147]
v_add_u32 v26, 0, v28
v_bfe_u32 v27, v26, 1, 3
M v[144:147], a[68:71], a[188:191], v[144:147]
v_xor_b32 v27, v27, v25
v_lshlrev_b32 v26, 11, v26
v_lshl_add_u32 v26, v27, 4, v26
M v[148:151], a[76:79], a[188:191], v[148:151]
v_subrev_u32 v2, 0, v26
v_add_u32 v26, 8, v28
M v[148:151], a[72:75], a[184:187], v[148:151]
v_bfe_u32 v27, v26, 1, 3
v_xor_b32 v27, v27, v25
v_lshlrev_b32 v26, 11, v26
M v[152:155], a[80:83], a[184:187], v[152:155]
v_lshl_add_u32 v26, v27, 4, v26
v_subrev_u32 v3, 1024, v26
M v[152:155], a[84:87], a[188:191], v[152:155]
ds_read_b64_tr_b16 a[124:125], v15 offset:49152
ds_read_b64_tr_b16 a[126:127], v15 offset:51200
v_add_u32 v26, 16, v28
v_bfe_u32 v27, v26, 1, 3
v_xor_b32 v27, v27, v25
M v[156:159], a[92:95], a[188:191], v[156:159]
v_lshlrev_b32 v26, 11, v26
v_lshl_add_u32 v26, v27, 4, v26
M v[156:159], a[88:91], a[184:187], v[156:159]
s_waitcnt lgkmcnt(10)
v_subrev_u32 v4, 2048, v26
v_add_u32 v26, 24, v28
v_bfe_u32 v27, v26, 1, 3
M v[160:163], a[32:35], a[160:163], v[160:163]
v_xor_b32 v27, v27, v25
v_lshlrev_b32 v26, 11, v26
M v[160:163], a[36:39], a[164:167], v[160:163]
ds_read_b128 a[176:179], v10 offset:20480
ds_read_b128 a[180:183], v11 offset:20480
v_lshl_add_u32 v26, v27, 4, v26
v_subrev_u32 v5, 3072, v26
s_lshl_b32 s3, s20, 2
M v[164:167], a[44:47], a[164:167], v[164:167]
v_add_u32 v26, s3, v24
v_bfe_u32 v27, v26, 1, 3
M v[164:167], a[40:43], a[160:163], v[164:167]
ds_read_b64_tr_b16 a[132:133], v16 offset:49152
ds_read_b64_tr_b16 a[134:135], v16 offset:51200
v_xor_b32 v27, v27, v25
v_lshlrev_b32 v26, 11, v26
v_lshl_add_u32 v20, v27, 4, v26
M v[168:171], a[48:51], a[160:163], v[168:171]
s_mul_i32 s3, s20, 48
v_add_u32 v28, s3, v24
M v[168:171], a[52:55], a[164:167], v[168:171]
v_add_u32 v26, 0, v28
v_mul_u32_u24 v27, 0xaaab, v26
v_lshrrev_b32 v27, 17, v27
M v[172:175], a[60:63], a[164:167], v[172:175]
v_lshrrev_b32 v29, 1, v27
v_and_b32 v29, 4, v29
M v[172:175], a[56:59], a[160:163], v[172:175]
v_and_or_b32 v27, v27, 2, v29
v_xor_b32 v27, v27, v25
v_lshlrev_b32 v26, 11, v26
M v[176:179], a[64:67], a[160:163], v[176:179]
v_lshl_add_u32 v26, v27, 4, v26
v_subrev_u32 v6, 0, v26
M v[176:179], a[68:71], a[164:167], v[176:179]
ds_read_b64_tr_b16 a[140:141], v17 offset:49152
ds_read_b64_tr_b16 a[142:143], v17 offset:51200
v_add_u32 v26, 8, v28
v_mul_u32_u24 v27, 0xaaab, v26
v_lshrrev_b32 v27, 17, v27
M v[180:183], a[76:79], a[164:167], v[180:183]
v_lshrrev_b32 v29, 1, v27
v_and_b32 v29, 4, v29
M v[180:183], a[72:75], a[160:163], v[180:183]
v_and_or_b32 v27, v27, 2, v29
v_xor_b32 v27, v27, v25
v_lshlrev_b32 v26, 11, v26
M v[184:187], a[80:83], a[160:163], v[184:187]
v_lshl_add_u32 v26, v27, 4, v26
v_subrev_u32 v7, 1024, v26
M v[184:187], a[84:87], a[164:167], v[184:187]
v_add_u32 v26, 16, v28
v_mul_u32_u24 v27, 0xaaab, v26
v_lshrrev_b32 v27, 17, v27
M v[188:191], a[92:95], a[164:167], v[188:191]
v_lshrrev_b32 v29, 1, v27
v_and_b32 v29, 4, v29
M v[188:191], a[88:91], a[160:163], v[188:191]
s_waitcnt lgkmcnt(12)
ds_read_b64_tr_b16 a[148:149], v18 offset:49152
ds_read_b64_tr_b16 a[150:151], v18 offset:51200
v_and_or_b32 v27, v27, 2, v29
v_xor_b32 v27, v27, v25
v_lshlrev_b32 v26, 11, v26
M v[192:195], a[32:35], a[168:171], v[192:195]
v_lshl_add_u32 v26, v27, 4, v26
v_subrev_u32 v8, 2048, v26
M v[192:195], a[36:39], a[172:175], v[192:195]
ds_read_b128 a[184:187], v10 offset:22528
ds_read_b128 a[188:191], v11 offset:22528
v_add_u32 v26, 24, v28
v_mul_u32_u24 v27, 0xaaab, v26
v_lshrrev_b32 v27, 17, v27
M v[196:199], a[44:47], a[172:175], v[196:199]
v_lshrrev_b32 v29, 1, v27
v_and_b32 v29, 4, v29
M v[196:199], a[40:43], a[168:171], v[196:199]
v_and_or_b32 v27, v27, 2, v29
v_xor_b32 v27, v27, v25
v_lshlrev_b32 v26, 11, v26
M v[200:203], a[48:51], a[168:171], v[200:203]
v_lshl_add_u32 v26, v27, 4, v26
v_subrev_u32 v9, 3072, v26
M v[200:203], a[52:55], a[172:175], v[200:203]
ds_read_b64_tr_b16 a[156:157], v19 offset:49152
ds_read_b64_tr_b16 a[158:159], v19 offset:51200
v_add_u32 v26, 32, v28
v_mul_u32_u24 v27, 0xaaab, v26
v_lshrrev_b32 v27, 17, v27
M v[204:207], a[60:63], a[172:175], v[204:207]
v_lshrrev_b32 v29, 1, v27
v_and_b32 v29, 4, v29
M v[204:207], a[56:59], a[168:171], v[204:207]
v_and_or_b32 v27, v27, 2, v29
v_xor_b32 v27, v27, v25
v_lshlrev_b32 v26, 11, v26
M v[208:211], a[64:67], a[168:171], v[208:211]
v_lshl_add_u32 v26, v27, 4, v26
v_subrev_u32 v21, 0, v26
M v[208:211], a[68:71], a[172:175], v[208:211]
v_add_u32 v26, 40, v28
v_mul_u32_u24 v27, 0xaaab, v26
v_lshrrev_b32 v27, 17, v27
M v[212:215], a[76:79], a[172:175], v[212:215]
v_lshrrev_b32 v29, 1, v27
v_and_b32 v29, 4, v29
M v[212:215], a[72:75], a[168:171], v[212:215]
v_and_or_b32 v27, v27, 2, v29
v_xor_b32 v27, v27, v25
v_lshlrev_b32 v26, 11, v26
M v[216:219], a[80:83], a[168:171], v[216:219]
v_lshl_add_u32 v26, v27, 4, v26
v_subrev_u32 v22, 1024, v26
M v[216:219], a[84:87], a[172:175], v[216:219]
s_lshr_b32 s3, s53, 7
s_add_u32 s3, s3, s22
s_lshl_b32 s3, s3, 5
M v[220:223], a[92:95], a[172:175], v[220:223]
s_lshr_b32 s19, s52, 6
s_add_u32 s3, s3, s19
M v[220:223], a[88:91], a[168:171], v[220:223]
s_waitcnt lgkmcnt(10)
s_lshl_b32 s19, s21, 1
s_add_u32 s3, s3, s19
s_lshl_b32 s92, s3, 14
M v[224:227], a[32:35], a[176:179], v[224:227]
s_add_u32 s93, s92, 16384
s_add_u32 s16, s50, 0
M v[224:227], a[36:39], a[180:183], v[224:227]
s_addc_u32 s17, s51, 0
s_mov_b32 s18, 16777216
s_mov_b32 s19, 0x00020000
M v[228:231], a[44:47], a[180:183], v[228:231]
s_mov_b32 s4, 0x3e0293ee
s_mov_b32 s5, 0x3e0293ee
M v[228:231], a[40:43], a[176:179], v[228:231]
M v[232:235], a[48:51], a[176:179], v[232:235]
M v[232:235], a[52:55], a[180:183], v[232:235]
M v[236:239], a[60:63], a[180:183], v[236:239]
M v[236:239], a[56:59], a[176:179], v[236:239]
s_waitcnt vmcnt(4) lgkmcnt(0)
s_barrier
ds_read_b128 a[160:163], v10 offset:32768
ds_read_b128 a[164:167], v11 offset:32768
M v[240:243], a[64:67], a[176:179], v[240:243]
s_add_u32 m0, s28, 131072
s_mov_b32 exec_hi, 0
buffer_load_dwordx4 v20, s[8:11], s24 offen lds
s_mov_b32 exec_hi, -1
M v[240:243], a[68:71], a[180:183], v[240:243]
M v[244:247], a[76:79], a[180:183], v[244:247]
M v[244:247], a[72:75], a[176:179], v[244:247]
s_add_u32 m0, s29, 133120
s_nop 0
buffer_load_dwordx4 v2, s[8:11], s23 offen offset:0 lds
M v[248:251], a[80:83], a[176:179], v[248:251]
M v[248:251], a[84:87], a[180:183], v[248:251]
M v[252:255], a[92:95], a[180:183], v[252:255]
M v[252:255], a[88:91], a[176:179], v[252:255]
M a[0:3], a[32:35], a[184:187], a[0:3]
buffer_load_dwordx4 v3, s[8:11], s23 offen offset:1024 lds
M a[0:3], a[36:39], a[188:191], a[0:3]
ds_read_b128 a[168:171], v10 offset:34816
ds_read_b128 a[172:175], v11 offset:34816
M a[4:7], a[44:47], a[188:191], a[4:7]
M a[4:7], a[40:43], a[184:187], a[4:7]
M a[8:11], a[48:51], a[184:187], a[8:11]
buffer_load_dwordx4 v4, s[8:11], s23 offen offset:2048 lds
M a[8:11], a[52:55], a[188:191], a[8:11]
M a[12:15], a[60:63], a[188:191], a[12:15]
M a[12:15], a[56:59], a[184:187], a[12:15]
M a[16:19], a[64:67], a[184:187], a[16:19]
buffer_load_dwordx4 v5, s[8:11], s23 offen offset:3072 lds
M a[16:19], a[68:71], a[188:191], a[16:19]
M a[20:23], a[76:79], a[188:191], a[20:23]
M a[20:23], a[72:75], a[184:187], a[20:23]
s_sub_u32 s31, s31, 1
s_cmp_eq_u32 s31, 0
s_cselect_b32 s58, -1920, s57
s_add_u32 s23, s23, s58
s_add_u32 s24, s24, s58
M a[24:27], a[80:83], a[184:187], a[24:27]
M a[24:27], a[84:87], a[188:191], a[24:27]
M a[28:31], a[92:95], a[188:191], a[28:31]
M a[28:31], a[88:91], a[184:187], a[28:31]
s_waitcnt lgkmcnt(2)
M v[32:35], a[96:99], a[160:163], v[32:35]
s_add_u32 m0, s30, 65536
s_nop 0
buffer_load_dwordx4 v6, s[12:15], s25 offen offset:0 lds
M v[32:35], a[100:103], a[164:167], v[32:35]
ds_read_b128 a[176:179], v10 offset:36864
ds_read_b128 a[180:183], v11 offset:36864
M v[36:39], a[108:111], a[164:167], v[36:39]
M v[36:39], a[104:107], a[160:163], v[36:39]
M v[40:43], a[112:115], a[160:163], v[40:43]
M v[40:43], a[116:119], a[164:167], v[40:43]
buffer_load_dwordx4 v7, s[12:15], s25 offen offset:1024 lds
M v[44:47], a[124:127], a[164:167], v[44:47]
M v[44:47], a[120:123], a[160:163], v[44:47]
M v[48:51], a[128:131], a[160:163], v[48:51]
M v[48:51], a[132:135], a[164:167], v[48:51]
M v[52:55], a[140:143], a[164:167], v[52:55]
buffer_load_dwordx4 v8, s[12:15], s25 offen offset:2048 lds
M v[52:55], a[136:139], a[160:163], v[52:55]
M v[56:59], a[144:147], a[160:163], v[56:59]
M v[56:59], a[148:151], a[164:167], v[56:59]
M v[60:63], a[156:159], a[164:167], v[60:63]
M v[60:63], a[152:155], a[160:163], v[60:63]
s_waitcnt lgkmcnt(2)
M v[64:67], a[96:99], a[168:171], v[64:67]
buffer_load_dwordx4 v9, s[12:15], s25 offen offset:3072 lds
M v[64:67], a[100:103], a[172:175], v[64:67]
ds_read_b128 a[184:187], v10 offset:38912
ds_read_b128 a[188:191], v11 offset:38912
M v[68:71], a[108:111], a[172:175], v[68:71]
M v[68:71], a[104:107], a[168:171], v[68:71]
v_pk_mul_f32 v[32:33], v[32:33], s[4:5]
v_pk_mul_f32 v[34:35], v[34:35], s[4:5]
v_pk_mul_f32 v[36:37], v[36:37], s[4:5]
M v[72:75], a[112:115], a[168:171], v[72:75]
v_pk_mul_f32 v[38:39], v[38:39], s[4:5]
v_cvt_pk_bf16_f32 v32, v32, v33
M v[72:75], a[116:119], a[172:175], v[72:75]
s_add_u32 m0, s30, 69632
s_nop 0
buffer_load_dwordx4 v21, s[12:15], s25 offen offset:0 lds
v_cvt_pk_bf16_f32 v33, v34, v35
v_cvt_pk_bf16_f32 v34, v36, v37
M v[76:79], a[124:127], a[172:175], v[76:79]
v_cvt_pk_bf16_f32 v35, v38, v39
v_pk_mul_f32 v[40:41], v[40:41], s[4:5]
v_pk_mul_f32 v[42:43], v[42:43], s[4:5]
M v[76:79], a[120:123], a[168:171], v[76:79]
v_pk_mul_f32 v[44:45], v[44:45], s[4:5]
v_pk_mul_f32 v[46:47], v[46:47], s[4:5]
M v[80:83], a[128:131], a[168:171], v[80:83]
v_cvt_pk_bf16_f32 v40, v40, v41
v_cvt_pk_bf16_f32 v41, v42, v43
M v[80:83], a[132:135], a[172:175], v[80:83]
v_cvt_pk_bf16_f32 v42, v44, v45
v_cvt_pk_bf16_f32 v43, v46, v47
M v[84:87], a[140:143], a[172:175], v[84:87]
buffer_load_dwordx4 v22, s[12:15], s25 offen offset:1024 lds
v_pk_mul_f32 v[48:49], v[48:49], s[4:5]
v_pk_mul_f32 v[50:51], v[50:51], s[4:5]
v_pk_mul_f32 v[52:53], v[52:53], s[4:5]
M v[84:87], a[136:139], a[168:171], v[84:87]
v_pk_mul_f32 v[54:55], v[54:55], s[4:5]
v_cvt_pk_bf16_f32 v48, v48, v49
M v[88:91], a[144:147], a[168:171], v[88:91]
v_cvt_pk_bf16_f32 v49, v50, v51
v_cvt_pk_bf16_f32 v50, v52, v53
M v[88:91], a[148:151], a[172:175], v[88:91]
v_cvt_pk_bf16_f32 v51, v54, v55
v_pk_mul_f32 v[56:57], v[56:57], s[4:5]
v_pk_mul_f32 v[58:59], v[58:59], s[4:5]
M v[92:95], a[156:159], a[172:175], v[92:95]
v_pk_mul_f32 v[60:61], v[60:61], s[4:5]
v_pk_mul_f32 v[62:63], v[62:63], s[4:5]
M v[92:95], a[152:155], a[168:171], v[92:95]
s_waitcnt lgkmcnt(2)
v_cvt_pk_bf16_f32 v56, v56, v57
v_cvt_pk_bf16_f32 v57, v58, v59
M v[96:99], a[96:99], a[176:179], v[96:99]
s_sub_u32 s54, s54, 1
s_cmp_eq_u32 s54, 0
s_cselect_b32 s58, s55, s56
s_add_u32 s25, s25, s58
v_cvt_pk_bf16_f32 v58, v60, v61
v_cvt_pk_bf16_f32 v59, v62, v63
M v[96:99], a[100:103], a[180:183], v[96:99]
M v[100:103], a[108:111], a[180:183], v[100:103]
M v[100:103], a[104:107], a[176:179], v[100:103]
v_pk_mul_f32 v[64:65], v[64:65], s[4:5]
v_pk_mul_f32 v[66:67], v[66:67], s[4:5]
v_pk_mul_f32 v[68:69], v[68:69], s[4:5]
M v[104:107], a[112:115], a[176:179], v[104:107]
v_pk_mul_f32 v[70:71], v[70:71], s[4:5]
v_cvt_pk_bf16_f32 v64, v64, v65
M v[104:107], a[116:119], a[180:183], v[104:107]
v_cvt_pk_bf16_f32 v65, v66, v67
v_cvt_pk_bf16_f32 v66, v68, v69
M v[108:111], a[124:127], a[180:183], v[108:111]
v_cvt_pk_bf16_f32 v67, v70, v71
v_pk_mul_f32 v[72:73], v[72:73], s[4:5]
v_pk_mul_f32 v[74:75], v[74:75], s[4:5]
M v[108:111], a[120:123], a[176:179], v[108:111]
s_waitcnt vmcnt(11) lgkmcnt(0)
s_barrier
ds_read_b128 a[160:163], v10 offset:49152
ds_read_b128 a[164:167], v11 offset:49152
v_pk_mul_f32 v[76:77], v[76:77], s[4:5]
v_pk_mul_f32 v[78:79], v[78:79], s[4:5]
M v[112:115], a[128:131], a[176:179], v[112:115]
s_add_u32 m0, s28, 0
s_mov_b32 exec_hi, 0
buffer_load_dwordx4 v20, s[8:11], s24 offen lds
s_mov_b32 exec_hi, -1
v_cvt_pk_bf16_f32 v72, v72, v73
v_cvt_pk_bf16_f32 v73, v74, v75
M v[112:115], a[132:135], a[180:183], v[112:115]
v_cvt_pk_bf16_f32 v74, v76, v77
v_cvt_pk_bf16_f32 v75, v78, v79
M v[116:119], a[140:143], a[180:183], v[116:119]
v_pk_mul_f32 v[80:81], v[80:81], s[4:5]
v_pk_mul_f32 v[82:83], v[82:83], s[4:5]
v_pk_mul_f32 v[84:85], v[84:85], s[4:5]
M v[116:119], a[136:139], a[176:179], v[116:119]
v_pk_mul_f32 v[86:87], v[86:87], s[4:5]
v_cvt_pk_bf16_f32 v80, v80, v81
M v[120:123], a[144:147], a[176:179], v[120:123]
s_add_u32 m0, s29, 2048
s_nop 0
buffer_load_dwordx4 v2, s[8:11], s23 offen offset:0 lds
v_cvt_pk_bf16_f32 v81, v82, v83
v_cvt_pk_bf16_f32 v82, v84, v85
M v[120:123], a[148:151], a[180:183], v[120:123]
v_cvt_pk_bf16_f32 v83, v86, v87
v_pk_mul_f32 v[88:89], v[88:89], s[4:5]
v_pk_mul_f32 v[90:91], v[90:91], s[4:5]
M v[124:127], a[156:159], a[180:183], v[124:127]
v_pk_mul_f32 v[92:93], v[92:93], s[4:5]
v_pk_mul_f32 v[94:95], v[94:95], s[4:5]
M v[124:127], a[152:155], a[176:179], v[124:127]
v_cvt_pk_bf16_f32 v88, v88, v89
v_cvt_pk_bf16_f32 v89, v90, v91
M v[128:131], a[96:99], a[184:187], v[128:131]
v_cvt_pk_bf16_f32 v90, v92, v93
v_cvt_pk_bf16_f32 v91, v94, v95
M v[128:131], a[100:103], a[188:191], v[128:131]
ds_read_b128 a[168:171], v10 offset:51200
ds_read_b128 a[172:175], v11 offset:51200
M v[132:135], a[108:111], a[188:191], v[132:135]
buffer_load_dwordx4 v3, s[8:11], s23 offen offset:1024 lds
M v[132:135], a[104:107], a[184:187], v[132:135]
v_pk_mul_f32 v[96:97], v[96:97], s[4:5]
v_pk_mul_f32 v[98:99], v[98:99], s[4:5]
v_pk_mul_f32 v[100:101], v[100:101], s[4:5]
M v[136:139], a[112:115], a[184:187], v[136:139]
v_pk_mul_f32 v[102:103], v[102:103], s[4:5]
v_cvt_pk_bf16_f32 v96, v96, v97
M v[136:139], a[116:119], a[188:191], v[136:139]
v_cvt_pk_bf16_f32 v97, v98, v99
v_cvt_pk_bf16_f32 v98, v100, v101
M v[140:143], a[124:127], a[188:191], v[140:143]
buffer_load_dwordx4 v4, s[8:11], s23 offen offset:2048 lds
v_cvt_pk_bf16_f32 v99, v102, v103
v_pk_mul_f32 v[104:105], v[104:105], s[4:5]
v_pk_mul_f32 v[106:107], v[106:107], s[4:5]
M v[140:143], a[120:123], a[184:187], v[140:143]
v_pk_mul_f32 v[108:109], v[108:109], s[4:5]
v_pk_mul_f32 v[110:111], v[110:111], s[4:5]
M v[144:147], a[128:131], a[184:187], v[144:147]
v_cvt_pk_bf16_f32 v104, v104, v105
v_cvt_pk_bf16_f32 v105, v106, v107
M v[144:147], a[132:135], a[188:191], v[144:147]
v_cvt_pk_bf16_f32 v106, v108, v109
v_cvt_pk_bf16_f32 v107, v110, v111
M v[148:151], a[140:143], a[188:191], v[148:151]
buffer_load_dwordx4 v5, s[8:11], s23 offen offset:3072 lds
v_pk_mul_f32 v[112:113], v[112:113], s[4:5]
v_pk_mul_f32 v[114:115], v[114:115], s[4:5]
v_pk_mul_f32 v[116:117], v[116:117], s[4:5]
M v[148:151], a[136:139], a[184:187], v[148:151]
v_pk_mul_f32 v[118:119], v[118:119], s[4:5]
v_cvt_pk_bf16_f32 v112, v112, v113
M v[152:155], a[144:147], a[184:187], v[152:155]
v_cvt_pk_bf16_f32 v113, v114, v115
v_cvt_pk_bf16_f32 v114, v116, v117
M v[152:155], a[148:151], a[188:191], v[152:155]
v_cvt_pk_bf16_f32 v115, v118, v119
v_pk_mul_f32 v[120:121], v[120:121], s[4:5]
v_pk_mul_f32 v[122:123], v[122:123], s[4:5]
M v[156:159], a[156:159], a[188:191], v[156:159]
s_sub_u32 s31, s31, 1
s_cmp_eq_u32 s31, 0
s_cselect_b32 s58, -1920, s57
s_add_u32 s23, s23, s58
s_add_u32 s24, s24, s58
v_pk_mul_f32 v[124:125], v[124:125], s[4:5]
v_pk_mul_f32 v[126:127], v[126:127], s[4:5]
M v[156:159], a[152:155], a[184:187], v[156:159]
s_waitcnt lgkmcnt(2)
v_cvt_pk_bf16_f32 v120, v120, v121
v_cvt_pk_bf16_f32 v121, v122, v123
M v[160:163], a[96:99], a[160:163], v[160:163]
v_cvt_pk_bf16_f32 v122, v124, v125
v_cvt_pk_bf16_f32 v123, v126, v127
M v[160:163], a[100:103], a[164:167], v[160:163]
ds_read_b128 a[176:179], v10 offset:53248
ds_read_b128 a[180:183], v11 offset:53248
M v[164:167], a[108:111], a[164:167], v[164:167]
M v[164:167], a[104:107], a[160:163], v[164:167]
v_pk_mul_f32 v[128:129], v[128:129], s[4:5]
v_pk_mul_f32 v[130:131], v[130:131], s[4:5]
v_pk_mul_f32 v[132:133], v[132:133], s[4:5]
M v[168:171], a[112:115], a[160:163], v[168:171]
s_add_u32 m0, s30, 98304
s_nop 0
buffer_load_dwordx4 v6, s[12:15], s25 offen offset:0 lds
v_pk_mul_f32 v[134:135], v[134:135], s[4:5]
v_cvt_pk_bf16_f32 v128, v128, v129
M v[168:171], a[116:119], a[164:167], v[168:171]
v_cvt_pk_bf16_f32 v129, v130, v131
v_cvt_pk_bf16_f32 v130, v132, v133
M v[172:175], a[124:127], a[164:167], v[172:175]
v_cvt_pk_bf16_f32 v131, v134, v135
v_pk_mul_f32 v[136:137], v[136:137], s[4:5]
v_pk_mul_f32 v[138:139], v[138:139], s[4:5]
M v[172:175], a[120:123], a[160:163], v[172:175]
v_pk_mul_f32 v[140:141], v[140:141], s[4:5]
v_pk_mul_f32 v[142:143], v[142:143], s[4:5]
M v[176:179], a[128:131], a[160:163], v[176:179]
v_cvt_pk_bf16_f32 v136, v136, v137
v_cvt_pk_bf16_f32 v137, v138, v139
M v[176:179], a[132:135], a[164:167], v[176:179]
buffer_load_dwordx4 v7, s[12:15], s25 offen offset:1024 lds
v_cvt_pk_bf16_f32 v138, v140, v141
v_cvt_pk_bf16_f32 v139, v142, v143
M v[180:183], a[140:143], a[164:167], v[180:183]
v_pk_mul_f32 v[144:145], v[144:145], s[4:5]
v_pk_mul_f32 v[146:147], v[146:147], s[4:5]
v_pk_mul_f32 v[148:149], v[148:149], s[4:5]
M v[180:183], a[136:139], a[160:163], v[180:183]
v_pk_mul_f32 v[150:151], v[150:151], s[4:5]
v_cvt_pk_bf16_f32 v144, v144, v145
M v[184:187], a[144:147], a[160:163], v[184:187]
v_cvt_pk_bf16_f32 v145, v146, v147
v_cvt_pk_bf16_f32 v146, v148, v149
M v[184:187], a[148:151], a[164:167], v[184:187]
buffer_load_dwordx4 v8, s[12:15], s25 offen offset:2048 lds
v_cvt_pk_bf16_f32 v147, v150, v151
v_pk_mul_f32 v[152:153], v[152:153], s[4:5]
v_pk_mul_f32 v[154:155], v[154:155], s[4:5]
M v[188:191], a[156:159], a[164:167], v[188:191]
v_pk_mul_f32 v[156:157], v[156:157], s[4:5]
v_pk_mul_f32 v[158:159], v[158:159], s[4:5]
M v[188:191], a[152:155], a[160:163], v[188:191]
s_waitcnt lgkmcnt(2)
v_cvt_pk_bf16_f32 v152, v152, v153
v_cvt_pk_bf16_f32 v153, v154, v155
M v[192:195], a[96:99], a[168:171], v[192:195]
v_cvt_pk_bf16_f32 v154, v156, v157
v_cvt_pk_bf16_f32 v155, v158, v159
M v[192:195], a[100:103], a[172:175], v[192:195]
ds_read_b128 a[184:187], v10 offset:55296
ds_read_b128 a[188:191], v11 offset:55296
M v[196:199], a[108:111], a[172:175], v[196:199]
M v[196:199], a[104:107], a[168:171], v[196:199]
buffer_load_dwordx4 v9, s[12:15], s25 offen offset:3072 lds
v_pk_mul_f32 v[160:161], v[160:161], s[4:5]
v_pk_mul_f32 v[162:163], v[162:163], s[4:5]
v_pk_mul_f32 v[164:165], v[164:165], s[4:5]
M v[200:203], a[112:115], a[168:171], v[200:203]
v_pk_mul_f32 v[166:167], v[166:167], s[4:5]
v_cvt_pk_bf16_f32 v160, v160, v161
M v[200:203], a[116:119], a[172:175], v[200:203]
v_cvt_pk_bf16_f32 v161, v162, v163
v_cvt_pk_bf16_f32 v162, v164, v165
M v[204:207], a[124:127], a[172:175], v[204:207]
v_cvt_pk_bf16_f32 v163, v166, v167
v_pk_mul_f32 v[168:169], v[168:169], s[4:5]
v_pk_mul_f32 v[170:171], v[170:171], s[4:5]
M v[204:207], a[120:123], a[168:171], v[204:207]
s_add_u32 m0, s30, 102400
s_nop 0
buffer_load_dwordx4 v21, s[12:15], s25 offen offset:0 lds
v_pk_mul_f32 v[172:173], v[172:173], s[4:5]
v_pk_mul_f32 v[174:175], v[174:175], s[4:5]
M v[208:211], a[128:131], a[168:171], v[208:211]
v_cvt_pk_bf16_f32 v168, v168, v169
v_cvt_pk_bf16_f32 v169, v170, v171
M v[208:211], a[132:135], a[172:175], v[208:211]
v_cvt_pk_bf16_f32 v170, v172, v173
v_cvt_pk_bf16_f32 v171, v174, v175
M v[212:215], a[140:143], a[172:175], v[212:215]
v_pk_mul_f32 v[176:177], v[176:177], s[4:5]
v_pk_mul_f32 v[178:179], v[178:179], s[4:5]
v_pk_mul_f32 v[180:181], v[180:181], s[4:5]
M v[212:215], a[136:139], a[168:171], v[212:215]
buffer_load_dwordx4 v22, s[12:15], s25 offen offset:1024 lds
v_pk_mul_f32 v[182:183], v[182:183], s[4:5]
v_cvt_pk_bf16_f32 v176, v176, v177
M v[216:219], a[144:147], a[168:171], v[216:219]
v_cvt_pk_bf16_f32 v177, v178, v179
v_cvt_pk_bf16_f32 v178, v180, v181
M v[216:219], a[148:151], a[172:175], v[216:219]
v_cvt_pk_bf16_f32 v179, v182, v183
v_pk_mul_f32 v[184:185], v[184:185], s[4:5]
v_pk_mul_f32 v[186:187], v[186:187], s[4:5]
M v[220:223], a[156:159], a[172:175], v[220:223]
v_pk_mul_f32 v[188:189], v[188:189], s[4:5]
v_pk_mul_f32 v[190:191], v[190:191], s[4:5]
M v[220:223], a[152:155], a[168:171], v[220:223]
s_waitcnt lgkmcnt(2)
v_cvt_pk_bf16_f32 v184, v184, v185
v_cvt_pk_bf16_f32 v185, v186, v187
M v[224:227], a[96:99], a[176:179], v[224:227]
s_sub_u32 s54, s54, 1
s_cmp_eq_u32 s54, 0
s_cselect_b32 s58, s55, s56
s_add_u32 s25, s25, s58
v_cvt_pk_bf16_f32 v186, v188, v189
v_cvt_pk_bf16_f32 v187, v190, v191
M v[224:227], a[100:103], a[180:183], v[224:227]
M v[228:231], a[108:111], a[180:183], v[228:231]
M v[228:231], a[104:107], a[176:179], v[228:231]
v_pk_mul_f32 v[192:193], v[192:193], s[4:5]
v_pk_mul_f32 v[194:195], v[194:195], s[4:5]
v_pk_mul_f32 v[196:197], v[196:197], s[4:5]
M v[232:235], a[112:115], a[176:179], v[232:235]
v_pk_mul_f32 v[198:199], v[198:199], s[4:5]
v_cvt_pk_bf16_f32 v192, v192, v193
M v[232:235], a[116:119], a[180:183], v[232:235]
v_cvt_pk_bf16_f32 v193, v194, v195
v_cvt_pk_bf16_f32 v194, v196, v197
M v[236:239], a[124:127], a[180:183], v[236:239]
v_cvt_pk_bf16_f32 v195, v198, v199
v_pk_mul_f32 v[200:201], v[200:201], s[4:5]
v_pk_mul_f32 v[202:203], v[202:203], s[4:5]
M v[236:239], a[120:123], a[176:179], v[236:239]
s_waitcnt vmcnt(63) lgkmcnt(0)
s_barrier
v_pk_mul_f32 v[204:205], v[204:205], s[4:5]
v_pk_mul_f32 v[206:207], v[206:207], s[4:5]
M v[240:243], a[128:131], a[176:179], v[240:243]
s_add_u32 m0, s28, 18432
s_mov_b32 exec_hi, 0
buffer_load_dwordx4 v20, s[8:11], s24 offen lds
s_mov_b32 exec_hi, -1
v_cvt_pk_bf16_f32 v200, v200, v201
v_cvt_pk_bf16_f32 v201, v202, v203
M v[240:243], a[132:135], a[180:183], v[240:243]
v_cvt_pk_bf16_f32 v202, v204, v205
v_cvt_pk_bf16_f32 v203, v206, v207
M v[244:247], a[140:143], a[180:183], v[244:247]
v_pk_mul_f32 v[208:209], v[208:209], s[4:5]
v_pk_mul_f32 v[210:211], v[210:211], s[4:5]
v_pk_mul_f32 v[212:213], v[212:213], s[4:5]
M v[244:247], a[136:139], a[176:179], v[244:247]
s_add_u32 m0, s29, 20480
s_nop 0
buffer_load_dwordx4 v2, s[8:11], s23 offen offset:0 lds
v_pk_mul_f32 v[214:215], v[214:215], s[4:5]
v_cvt_pk_bf16_f32 v208, v208, v209
M v[248:251], a[144:147], a[176:179], v[248:251]
v_cvt_pk_bf16_f32 v209, v210, v211
v_cvt_pk_bf16_f32 v210, v212, v213
M v[248:251], a[148:151], a[180:183], v[248:251]
v_cvt_pk_bf16_f32 v211, v214, v215
v_pk_mul_f32 v[216:217], v[216:217], s[4:5]
v_pk_mul_f32 v[218:219], v[218:219], s[4:5]
M v[252:255], a[156:159], a[180:183], v[252:255]
v_pk_mul_f32 v[220:221], v[220:221], s[4:5]
v_pk_mul_f32 v[222:223], v[222:223], s[4:5]
M v[252:255], a[152:155], a[176:179], v[252:255]
v_cvt_pk_bf16_f32 v216, v216, v217
v_cvt_pk_bf16_f32 v217, v218, v219
M a[0:3], a[96:99], a[184:187], a[0:3]
buffer_load_dwordx4 v3, s[8:11], s23 offen offset:1024 lds
v_cvt_pk_bf16_f32 v218, v220, v221
v_cvt_pk_bf16_f32 v219, v222, v223
M a[0:3], a[100:103], a[188:191], a[0:3]
M a[4:7], a[108:111], a[188:191], a[4:7]
M a[4:7], a[104:107], a[184:187], a[4:7]
v_pk_mul_f32 v[224:225], v[224:225], s[4:5]
v_pk_mul_f32 v[226:227], v[226:227], s[4:5]
v_pk_mul_f32 v[228:229], v[228:229], s[4:5]
M a[8:11], a[112:115], a[184:187], a[8:11]
buffer_load_dwordx4 v4, s[8:11], s23 offen offset:2048 lds
v_pk_mul_f32 v[230:231], v[230:231], s[4:5]
v_cvt_pk_bf16_f32 v224, v224, v225
M a[8:11], a[116:119], a[188:191], a[8:11]
v_cvt_pk_bf16_f32 v225, v226, v227
v_cvt_pk_bf16_f32 v226, v228, v229
M a[12:15], a[124:127], a[188:191], a[12:15]
v_cvt_pk_bf16_f32 v227, v230, v231
v_pk_mul_f32 v[232:233], v[232:233], s[4:5]
v_pk_mul_f32 v[234:235], v[234:235], s[4:5]
M a[12:15], a[120:123], a[184:187], a[12:15]
buffer_load_dwordx4 v5, s[8:11], s23 offen offset:3072 lds
v_pk_mul_f32 v[236:237], v[236:237], s[4:5]
v_pk_mul_f32 v[238:239], v[238:239], s[4:5]
M a[16:19], a[128:131], a[184:187], a[16:19]
v_cvt_pk_bf16_f32 v232, v232, v233
v_cvt_pk_bf16_f32 v233, v234, v235
M a[16:19], a[132:135], a[188:191], a[16:19]
v_cvt_pk_bf16_f32 v234, v236, v237
v_cvt_pk_bf16_f32 v235, v238, v239
M a[20:23], a[140:143], a[188:191], a[20:23]
v_pk_mul_f32 v[240:241], v[240:241], s[4:5]
v_pk_mul_f32 v[242:243], v[242:243], s[4:5]
v_pk_mul_f32 v[244:245], v[244:245], s[4:5]
M a[20:23], a[136:139], a[184:187], a[20:23]
s_sub_u32 s31, s31, 1
s_cmp_eq_u32 s31, 0
s_cselect_b32 s58, -1920, s57
s_add_u32 s23, s23, s58
s_add_u32 s24, s24, s58
v_pk_mul_f32 v[246:247], v[246:247], s[4:5]
v_cvt_pk_bf16_f32 v240, v240, v241
M a[24:27], a[144:147], a[184:187], a[24:27]
v_cvt_pk_bf16_f32 v241, v242, v243
v_cvt_pk_bf16_f32 v242, v244, v245
M a[24:27], a[148:151], a[188:191], a[24:27]
v_cvt_pk_bf16_f32 v243, v246, v247
v_pk_mul_f32 v[248:249], v[248:249], s[4:5]
v_pk_mul_f32 v[250:251], v[250:251], s[4:5]
M a[28:31], a[156:159], a[188:191], a[28:31]
v_pk_mul_f32 v[252:253], v[252:253], s[4:5]
v_pk_mul_f32 v[254:255], v[254:255], s[4:5]
M a[28:31], a[152:155], a[184:187], a[28:31]
v_cvt_pk_bf16_f32 v248, v248, v249
v_cvt_pk_bf16_f32 v249, v250, v251
v_cvt_pk_bf16_f32 v250, v252, v253
v_cvt_pk_bf16_f32 v251, v254, v255
v_accvgpr_read_b32 v24, a0
v_accvgpr_read_b32 v25, a1
v_accvgpr_read_b32 v26, a2
v_accvgpr_read_b32 v27, a3
v_accvgpr_read_b32 v28, a4
v_accvgpr_read_b32 v29, a5
v_accvgpr_read_b32 v30, a6
v_accvgpr_read_b32 v31, a7
v_pk_mul_f32 v[24:25], v[24:25], s[4:5]
v_pk_mul_f32 v[26:27], v[26:27], s[4:5]
v_pk_mul_f32 v[28:29], v[28:29], s[4:5]
v_pk_mul_f32 v[30:31], v[30:31], s[4:5]
v_cvt_pk_bf16_f32 v36, v24, v25
v_cvt_pk_bf16_f32 v37, v26, v27
v_cvt_pk_bf16_f32 v38, v28, v29
v_cvt_pk_bf16_f32 v39, v30, v31
v_accvgpr_read_b32 v24, a8
v_accvgpr_read_b32 v25, a9
v_accvgpr_read_b32 v26, a10
v_accvgpr_read_b32 v27, a11
v_accvgpr_read_b32 v28, a12
v_accvgpr_read_b32 v29, a13
v_accvgpr_read_b32 v30, a14
v_accvgpr_read_b32 v31, a15
v_pk_mul_f32 v[24:25], v[24:25], s[4:5]
v_pk_mul_f32 v[26:27], v[26:27], s[4:5]
v_pk_mul_f32 v[28:29], v[28:29], s[4:5]
v_pk_mul_f32 v[30:31], v[30:31], s[4:5]
v_cvt_pk_bf16_f32 v44, v24, v25
v_cvt_pk_bf16_f32 v45, v26, v27
v_cvt_pk_bf16_f32 v46, v28, v29
v_cvt_pk_bf16_f32 v47, v30, v31
v_accvgpr_read_b32 v24, a16
v_accvgpr_read_b32 v25, a17
v_accvgpr_read_b32 v26, a18
v_accvgpr_read_b32 v27, a19
v_accvgpr_read_b32 v28, a20
v_accvgpr_read_b32 v29, a21
v_accvgpr_read_b32 v30, a22
v_accvgpr_read_b32 v31, a23
v_pk_mul_f32 v[24:25], v[24:25], s[4:5]
v_pk_mul_f32 v[26:27], v[26:27], s[4:5]
v_pk_mul_f32 v[28:29], v[28:29], s[4:5]
v_pk_mul_f32 v[30:31], v[30:31], s[4:5]
v_cvt_pk_bf16_f32 v52, v24, v25
v_cvt_pk_bf16_f32 v53, v26, v27
v_cvt_pk_bf16_f32 v54, v28, v29
v_cvt_pk_bf16_f32 v55, v30, v31
v_accvgpr_read_b32 v24, a24
v_accvgpr_read_b32 v25, a25
v_accvgpr_read_b32 v26, a26
v_accvgpr_read_b32 v27, a27
v_accvgpr_read_b32 v28, a28
v_accvgpr_read_b32 v29, a29
v_accvgpr_read_b32 v30, a30
v_accvgpr_read_b32 v31, a31
v_pk_mul_f32 v[24:25], v[24:25], s[4:5]
v_pk_mul_f32 v[26:27], v[26:27], s[4:5]
v_pk_mul_f32 v[28:29], v[28:29], s[4:5]
v_pk_mul_f32 v[30:31], v[30:31], s[4:5]
v_cvt_pk_bf16_f32 v60, v24, v25
v_cvt_pk_bf16_f32 v61, v26, v27
v_cvt_pk_bf16_f32 v62, v28, v29
v_cvt_pk_bf16_f32 v63, v30, v31
s_branch Lk1_b
Lk1_spin:
s_add_u32 s40, s40, 1
s_cmp_gt_u32 s40, 1048576
s_cbranch_scc1 Lk1_got
s_sleep 2
buffer_load_dword v126, v23, s[36:39], 0 offen offset:128 sc1
s_waitcnt vmcnt(0)
v_cmp_gt_u32 vcc, 0x80, v126
s_nop 0
s_cbranch_vccnz Lk1_spin
s_branch Lk1_got
Lk1_spinq:
s_add_u32 s40, s40, 1
s_cmp_gt_u32 s40, 1048576
s_cbranch_scc1 Lk1_gotq
s_sleep 2
buffer_load_dword v125, v23, s[36:39], 0 offen offset:0 sc1
s_waitcnt vmcnt(0)
v_cmp_gt_u32 vcc, 0x80, v125
s_nop 0
s_cbranch_vccnz Lk1_spinq
s_branch Lk1_gotq
Lk1_kv:
M v[32:35], a[32:35], a[160:163], 0
s_add_u32 s23, s23, 128
s_cmp_eq_u32 s23, s25
s_cselect_b32 s23, s26, s23
M v[32:35], a[36:39], a[164:167], v[32:35]
ds_read_b128 a[176:179], v10 offset:4096
ds_read_b128 a[180:183], v11 offset:4096
M v[36:39], a[44:47], a[164:167], 0
M v[36:39], a[40:43], a[160:163], v[36:39]
ds_read_b64_tr_b16 a[96:97], v12 offset:32768
ds_read_b64_tr_b16 a[98:99], v12 offset:34816
M v[40:43], a[48:51], a[160:163], 0
M v[40:43], a[52:55], a[164:167], v[40:43]
M v[44:47], a[60:63], a[164:167], 0
s_add_u32 m0, s29, 81920
s_nop 0
buffer_load_dwordx4 v6, s[12:15], s24 offen offset:0 lds
M v[44:47], a[56:59], a[160:163], v[44:47]
ds_read_b64_tr_b16 a[104:105], v13 offset:32768
ds_read_b64_tr_b16 a[106:107], v13 offset:34816
M v[48:51], a[64:67], a[160:163], 0
M v[48:51], a[68:71], a[164:167], v[48:51]
M v[52:55], a[76:79], a[164:167], 0
M v[52:55], a[72:75], a[160:163], v[52:55]
ds_read_b64_tr_b16 a[112:113], v14 offset:32768
ds_read_b64_tr_b16 a[114:115], v14 offset:34816
M v[56:59], a[80:83], a[160:163], 0
M v[56:59], a[84:87], a[164:167], v[56:59]
buffer_load_dwordx4 v7, s[12:15], s24 offen offset:1024 lds
M v[60:63], a[92:95], a[164:167], 0
M v[60:63], a[88:91], a[160:163], v[60:63]
ds_read_b64_tr_b16 a[120:121], v15 offset:32768
ds_read_b64_tr_b16 a[122:123], v15 offset:34816
M v[64:67], a[32:35], a[168:171], 0
M v[64:67], a[36:39], a[172:175], v[64:67]
ds_read_b128 a[184:187], v10 offset:6144
ds_read_b128 a[188:191], v11 offset:6144
M v[68:71], a[44:47], a[172:175], 0
M v[68:71], a[40:43], a[168:171], v[68:71]
ds_read_b64_tr_b16 a[128:129], v16 offset:32768
ds_read_b64_tr_b16 a[130:131], v16 offset:34816
M v[72:75], a[48:51], a[168:171], 0
buffer_load_dwordx4 v8, s[12:15], s24 offen offset:2048 lds
M v[72:75], a[52:55], a[172:175], v[72:75]
M v[76:79], a[60:63], a[172:175], 0
M v[76:79], a[56:59], a[168:171], v[76:79]
ds_read_b64_tr_b16 a[136:137], v17 offset:32768
ds_read_b64_tr_b16 a[138:139], v17 offset:34816
M v[80:83], a[64:67], a[168:171], 0
M v[80:83], a[68:71], a[172:175], v[80:83]
M v[84:87], a[76:79], a[172:175], 0
buffer_load_dwordx4 v9, s[12:15], s24 offen offset:3072 lds
M v[84:87], a[72:75], a[168:171], v[84:87]
ds_read_b64_tr_b16 a[144:145], v18 offset:32768
ds_read_b64_tr_b16 a[146:147], v18 offset:34816
M v[88:91], a[80:83], a[168:171], 0
M v[88:91], a[84:87], a[172:175], v[88:91]
M v[92:95], a[92:95], a[172:175], 0
M v[92:95], a[88:91], a[168:171], v[92:95]
s_waitcnt lgkmcnt(15)
ds_read_b64_tr_b16 a[152:153], v19 offset:32768
ds_read_b64_tr_b16 a[154:155], v19 offset:34816
M v[96:99], a[32:35], a[176:179], 0
s_add_u32 s24, s24, 262144
s_cmp_eq_u32 s24, s27
s_cselect_b32 s24, s28, s24
s_sub_u32 s6, s6, 1
s_cmp_eq_u32 s6, 0
s_cselect_b64 s[12:13], s[64:65], s[12:13]
M v[96:99], a[36:39], a[180:183], v[96:99]
M v[100:103], a[44:47], a[180:183], 0
M v[100:103], a[40:43], a[176:179], v[100:103]
M v[104:107], a[48:51], a[176:179], 0
M v[104:107], a[52:55], a[180:183], v[104:107]
M v[108:111], a[60:63], a[180:183], 0
M v[108:111], a[56:59], a[176:179], v[108:111]
s_waitcnt vmcnt(17) lgkmcnt(0)
s_barrier
ds_read_b128 a[160:163], v10 offset:16384
ds_read_b128 a[164:167], v11 offset:16384
M v[112:115], a[64:67], a[176:179], 0
s_add_u32 m0, s29, 0
s_nop 0
buffer_load_dwordx4 v2, s[8:11], s23 offen offset:0 lds
M v[112:115], a[68:71], a[180:183], v[112:115]
M v[116:119], a[76:79], a[180:183], 0
M v[116:119], a[72:75], a[176:179], v[116:119]
ds_read_b64_tr_b16 a[100:101], v12 offset:49152
ds_read_b64_tr_b16 a[102:103], v12 offset:51200
M v[120:123], a[80:83], a[176:179], 0
M v[120:123], a[84:87], a[180:183], v[120:123]
buffer_load_dwordx4 v3, s[8:11], s23 offen offset:1024 lds
M v[124:127], a[92:95], a[180:183], 0
M v[124:127], a[88:91], a[176:179], v[124:127]
M v[128:131], a[32:35], a[184:187], 0
M v[128:131], a[36:39], a[188:191], v[128:131]
ds_read_b128 a[168:171], v10 offset:18432
ds_read_b128 a[172:175], v11 offset:18432
ds_read_b64_tr_b16 a[108:109], v13 offset:49152
ds_read_b64_tr_b16 a[110:111], v13 offset:51200
M v[132:135], a[44:47], a[188:191], 0
M v[132:135], a[40:43], a[184:187], v[132:135]
buffer_load_dwordx4 v4, s[8:11], s23 offen offset:2048 lds
M v[136:139], a[48:51], a[184:187], 0
M v[136:139], a[52:55], a[188:191], v[136:139]
M v[140:143], a[60:63], a[188:191], 0
M v[140:143], a[56:59], a[184:187], v[140:143]
ds_read_b64_tr_b16 a[116:117], v14 offset:49152
ds_read_b64_tr_b16 a[118:119], v14 offset:51200
M v[144:147], a[64:67], a[184:187], 0
M v[144:147], a[68:71], a[188:191], v[144:147]
buffer_load_dwordx4 v5, s[8:11], s23 offen offset:3072 lds
M v[148:151], a[76:79], a[188:191], 0
M v[148:151], a[72:75], a[184:187], v[148:151]
M v[152:155], a[80:83], a[184:187], 0
M v[152:155], a[84:87], a[188:191], v[152:155]
ds_read_b64_tr_b16 a[124:125], v15 offset:49152
ds_read_b64_tr_b16 a[126:127], v15 offset:51200
M v[156:159], a[92:95], a[188:191], 0
s_add_u32 m0, s29, 98304
s_nop 0
buffer_load_dwordx4 v6, s[12:15], s24 offen offset:0 lds
M v[156:159], a[88:91], a[184:187], v[156:159]
s_waitcnt lgkmcnt(10)
M v[160:163], a[32:35], a[160:163], 0
M v[160:163], a[36:39], a[164:167], v[160:163]
ds_read_b128 a[176:179], v10 offset:20480
ds_read_b128 a[180:183], v11 offset:20480
M v[164:167], a[44:47], a[164:167], 0
M v[164:167], a[40:43], a[160:163], v[164:167]
ds_read_b64_tr_b16 a[132:133], v16 offset:49152
ds_read_b64_tr_b16 a[134:135], v16 offset:51200
M v[168:171], a[48:51], a[160:163], 0
M v[168:171], a[52:55], a[164:167], v[168:171]
buffer_load_dwordx4 v7, s[12:15], s24 offen offset:1024 lds
M v[172:175], a[60:63], a[164:167], 0
M v[172:175], a[56:59], a[160:163], v[172:175]
M v[176:179], a[64:67], a[160:163], 0
M v[176:179], a[68:71], a[164:167], v[176:179]
ds_read_b64_tr_b16 a[140:141], v17 offset:49152
ds_read_b64_tr_b16 a[142:143], v17 offset:51200
M v[180:183], a[76:79], a[164:167], 0
M v[180:183], a[72:75], a[160:163], v[180:183]
buffer_load_dwordx4 v8, s[12:15], s24 offen offset:2048 lds
M v[184:187], a[80:83], a[160:163], 0
M v[184:187], a[84:87], a[164:167], v[184:187]
M v[188:191], a[92:95], a[164:167], 0
M v[188:191], a[88:91], a[160:163], v[188:191]
s_waitcnt lgkmcnt(12)
ds_read_b64_tr_b16 a[148:149], v18 offset:49152
ds_read_b64_tr_b16 a[150:151], v18 offset:51200
M v[192:195], a[32:35], a[168:171], 0
buffer_load_dwordx4 v9, s[12:15], s24 offen offset:3072 lds
M v[192:195], a[36:39], a[172:175], v[192:195]
ds_read_b128 a[184:187], v10 offset:22528
ds_read_b128 a[188:191], v11 offset:22528
M v[196:199], a[44:47], a[172:175], 0
M v[196:199], a[40:43], a[168:171], v[196:199]
M v[200:203], a[48:51], a[168:171], 0
M v[200:203], a[52:55], a[172:175], v[200:203]
ds_read_b64_tr_b16 a[156:157], v19 offset:49152
ds_read_b64_tr_b16 a[158:159], v19 offset:51200
M v[204:207], a[60:63], a[172:175], 0
s_add_u32 s24, s24, 262144
M v[204:207], a[56:59], a[168:171], v[204:207]
M v[208:211], a[64:67], a[168:171], 0
M v[208:211], a[68:71], a[172:175], v[208:211]
M v[212:215], a[76:79], a[172:175], 0
M v[212:215], a[72:75], a[168:171], v[212:215]
buffer_load_dword v21, v20, s[60:63], s54 offen
s_add_u32 s54, s54, s55
M v[216:219], a[80:83], a[168:171], 0
M v[216:219], a[84:87], a[172:175], v[216:219]
M v[220:223], a[92:95], a[172:175], 0
M v[220:223], a[88:91], a[168:171], v[220:223]
s_waitcnt lgkmcnt(10)
M v[224:227], a[32:35], a[176:179], 0
s_cmp_eq_u32 s54, s56
s_cselect_b32 s54, s57, s54
s_cselect_b64 s[60:61], s[58:59], s[60:61]
s_cselect_b32 s62, s7, s62
M v[224:227], a[36:39], a[180:183], v[224:227]
M v[228:231], a[44:47], a[180:183], 0
M v[228:231], a[40:43], a[176:179], v[228:231]
M v[232:235], a[48:51], a[176:179], 0
M v[232:235], a[52:55], a[180:183], v[232:235]
M v[236:239], a[60:63], a[180:183], 0
M v[236:239], a[56:59], a[176:179], v[236:239]
s_waitcnt vmcnt(17) lgkmcnt(0)
s_barrier
ds_read_b128 a[160:163], v10 offset:32768
ds_read_b128 a[164:167], v11 offset:32768
M v[240:243], a[64:67], a[176:179], 0
s_add_u32 m0, s29, 16384
s_add_u32 s3, s23, s31
buffer_load_dwordx4 v2, s[8:11], s3 offen offset:0 lds
M v[240:243], a[68:71], a[180:183], v[240:243]
M v[244:247], a[76:79], a[180:183], 0
M v[244:247], a[72:75], a[176:179], v[244:247]
M v[248:251], a[80:83], a[176:179], 0
M v[248:251], a[84:87], a[180:183], v[248:251]
buffer_load_dwordx4 v3, s[8:11], s3 offen offset:1024 lds
M v[252:255], a[92:95], a[180:183], 0
M v[252:255], a[88:91], a[176:179], v[252:255]
M a[0:3], a[32:35], a[184:187], 0
M a[0:3], a[36:39], a[188:191], a[0:3]
ds_read_b128 a[168:171], v10 offset:34816
ds_read_b128 a[172:175], v11 offset:34816
M a[4:7], a[44:47], a[188:191], 0
M a[4:7], a[40:43], a[184:187], a[4:7]
M a[8:11], a[48:51], a[184:187], 0
buffer_load_dwordx4 v4, s[8:11], s3 offen offset:2048 lds
M a[8:11], a[52:55], a[188:191], a[8:11]
M a[12:15], a[60:63], a[188:191], 0
M a[12:15], a[56:59], a[184:187], a[12:15]
M a[16:19], a[64:67], a[184:187], 0
M a[16:19], a[68:71], a[188:191], a[16:19]
buffer_load_dwordx4 v5, s[8:11], s3 offen offset:3072 lds
M a[20:23], a[76:79], a[188:191], 0
M a[20:23], a[72:75], a[184:187], a[20:23]
M a[24:27], a[80:83], a[184:187], 0
M a[24:27], a[84:87], a[188:191], a[24:27]
M a[28:31], a[92:95], a[188:191], 0
M a[28:31], a[88:91], a[184:187], a[28:31]
s_waitcnt lgkmcnt(2)
M v[32:35], a[96:99], a[160:163], v[32:35]
s_add_u32 s23, s23, 128
s_cmp_eq_u32 s23, s25
s_cselect_b32 s23, s26, s23
M v[32:35], a[100:103], a[164:167], v[32:35]
ds_read_b128 a[176:179], v10 offset:36864
ds_read_b128 a[180:183], v11 offset:36864
M v[36:39], a[108:111], a[164:167], v[36:39]
M v[36:39], a[104:107], a[160:163], v[36:39]
ds_read_b64_tr_b16 a[32:33], v12 offset:0
ds_read_b64_tr_b16 a[34:35], v12 offset:2048
M v[40:43], a[112:115], a[160:163], v[40:43]
M v[40:43], a[116:119], a[164:167], v[40:43]
M v[44:47], a[124:127], a[164:167], v[44:47]
s_add_u32 m0, s29, 114688
s_nop 0
buffer_load_dwordx4 v6, s[12:15], s24 offen offset:0 lds
M v[44:47], a[120:123], a[160:163], v[44:47]
ds_read_b64_tr_b16 a[40:41], v13 offset:0
ds_read_b64_tr_b16 a[42:43], v13 offset:2048
M v[48:51], a[128:131], a[160:163], v[48:51]
M v[48:51], a[132:135], a[164:167], v[48:51]
M v[52:55], a[140:143], a[164:167], v[52:55]
M v[52:55], a[136:139], a[160:163], v[52:55]
ds_read_b64_tr_b16 a[48:49], v14 offset:0
ds_read_b64_tr_b16 a[50:51], v14 offset:2048
M v[56:59], a[144:147], a[160:163], v[56:59]
M v[56:59], a[148:151], a[164:167], v[56:59]
buffer_load_dwordx4 v7, s[12:15], s24 offen offset:1024 lds
M v[60:63], a[156:159], a[164:167], v[60:63]
M v[60:63], a[152:155], a[160:163], v[60:63]
s_waitcnt lgkmcnt(8)
ds_read_b64_tr_b16 a[56:57], v15 offset:0
ds_read_b64_tr_b16 a[58:59], v15 offset:2048
M v[64:67], a[96:99], a[168:171], v[64:67]
M v[64:67], a[100:103], a[172:175], v[64:67]
ds_read_b128 a[184:187], v10 offset:38912
ds_read_b128 a[188:191], v11 offset:38912
M v[68:71], a[108:111], a[172:175], v[68:71]
M v[68:71], a[104:107], a[168:171], v[68:71]
ds_read_b64_tr_b16 a[64:65], v16 offset:0
ds_read_b64_tr_b16 a[66:67], v16 offset:2048
M v[72:75], a[112:115], a[168:171], v[72:75]
buffer_load_dwordx4 v8, s[12:15], s24 offen offset:2048 lds
M v[72:75], a[116:119], a[172:175], v[72:75]
M v[76:79], a[124:127], a[172:175], v[76:79]
M v[76:79], a[120:123], a[168:171], v[76:79]
ds_read_b64_tr_b16 a[72:73], v17 offset:0
ds_read_b64_tr_b16 a[74:75], v17 offset:2048
M v[80:83], a[128:131], a[168:171], v[80:83]
M v[80:83], a[132:135], a[172:175], v[80:83]
M v[84:87], a[140:143], a[172:175], v[84:87]
buffer_load_dwordx4 v9, s[12:15], s24 offen offset:3072 lds
M v[84:87], a[136:139], a[168:171], v[84:87]
ds_read_b64_tr_b16 a[80:81], v18 offset:0
ds_read_b64_tr_b16 a[82:83], v18 offset:2048
M v[88:91], a[144:147], a[168:171], v[88:91]
M v[88:91], a[148:151], a[172:175], v[88:91]
M v[92:95], a[156:159], a[172:175], v[92:95]
M v[92:95], a[152:155], a[168:171], v[92:95]
s_waitcnt lgkmcnt(15)
ds_read_b64_tr_b16 a[88:89], v19 offset:0
ds_read_b64_tr_b16 a[90:91], v19 offset:2048
M v[96:99], a[96:99], a[176:179], v[96:99]
s_add_u32 s24, s24, 262144
s_cmp_eq_u32 s24, s27
s_cselect_b32 s24, s28, s24
s_sub_u32 s6, s6, 1
s_cmp_eq_u32 s6, 0
s_cselect_b64 s[12:13], s[64:65], s[12:13]
M v[96:99], a[100:103], a[180:183], v[96:99]
M v[100:103], a[108:111], a[180:183], v[100:103]
M v[100:103], a[104:107], a[176:179], v[100:103]
M v[104:107], a[112:115], a[176:179], v[104:107]
M v[104:107], a[116:119], a[180:183], v[104:107]
M v[108:111], a[124:127], a[180:183], v[108:111]
M v[108:111], a[120:123], a[176:179], v[108:111]
s_waitcnt vmcnt(17) lgkmcnt(0)
s_barrier
ds_read_b128 a[160:163], v10 offset:49152
ds_read_b128 a[164:167], v11 offset:49152
M v[112:115], a[128:131], a[176:179], v[112:115]
s_add_u32 m0, s29, 32768
s_nop 0
buffer_load_dwordx4 v2, s[8:11], s23 offen offset:0 lds
M v[112:115], a[132:135], a[180:183], v[112:115]
M v[116:119], a[140:143], a[180:183], v[116:119]
M v[116:119], a[136:139], a[176:179], v[116:119]
ds_read_b64_tr_b16 a[36:37], v12 offset:16384
ds_read_b64_tr_b16 a[38:39], v12 offset:18432
M v[120:123], a[144:147], a[176:179], v[120:123]
M v[120:123], a[148:151], a[180:183], v[120:123]
buffer_load_dwordx4 v3, s[8:11], s23 offen offset:1024 lds
M v[124:127], a[156:159], a[180:183], v[124:127]
M v[124:127], a[152:155], a[176:179], v[124:127]
M v[128:131], a[96:99], a[184:187], v[128:131]
M v[128:131], a[100:103], a[188:191], v[128:131]
ds_read_b128 a[168:171], v10 offset:51200
ds_read_b128 a[172:175], v11 offset:51200
ds_read_b64_tr_b16 a[44:45], v13 offset:16384
ds_read_b64_tr_b16 a[46:47], v13 offset:18432
M v[132:135], a[108:111], a[188:191], v[132:135]
M v[132:135], a[104:107], a[184:187], v[132:135]
buffer_load_dwordx4 v4, s[8:11], s23 offen offset:2048 lds
M v[136:139], a[112:115], a[184:187], v[136:139]
M v[136:139], a[116:119], a[188:191], v[136:139]
M v[140:143], a[124:127], a[188:191], v[140:143]
M v[140:143], a[120:123], a[184:187], v[140:143]
ds_read_b64_tr_b16 a[52:53], v14 offset:16384
ds_read_b64_tr_b16 a[54:55], v14 offset:18432
M v[144:147], a[128:131], a[184:187], v[144:147]
M v[144:147], a[132:135], a[188:191], v[144:147]
buffer_load_dwordx4 v5, s[8:11], s23 offen offset:3072 lds
M v[148:151], a[140:143], a[188:191], v[148:151]
M v[148:151], a[136:139], a[184:187], v[148:151]
M v[152:155], a[144:147], a[184:187], v[152:155]
M v[152:155], a[148:151], a[188:191], v[152:155]
ds_read_b64_tr_b16 a[60:61], v15 offset:16384
ds_read_b64_tr_b16 a[62:63], v15 offset:18432
M v[156:159], a[156:159], a[188:191], v[156:159]
s_add_u32 m0, s29, 65536
s_nop 0
buffer_load_dwordx4 v6, s[12:15], s24 offen offset:0 lds
M v[156:159], a[152:155], a[184:187], v[156:159]
s_waitcnt lgkmcnt(10)
M v[160:163], a[96:99], a[160:163], v[160:163]
M v[160:163], a[100:103], a[164:167], v[160:163]
ds_read_b128 a[176:179], v10 offset:53248
ds_read_b128 a[180:183], v11 offset:53248
M v[164:167], a[108:111], a[164:167], v[164:167]
M v[164:167], a[104:107], a[160:163], v[164:167]
ds_read_b64_tr_b16 a[68:69], v16 offset:16384
ds_read_b64_tr_b16 a[70:71], v16 offset:18432
M v[168:171], a[112:115], a[160:163], v[168:171]
M v[168:171], a[116:119], a[164:167], v[168:171]
buffer_load_dwordx4 v7, s[12:15], s24 offen offset:1024 lds
M v[172:175], a[124:127], a[164:167], v[172:175]
M v[172:175], a[120:123], a[160:163], v[172:175]
M v[176:179], a[128:131], a[160:163], v[176:179]
M v[176:179], a[132:135], a[164:167], v[176:179]
ds_read_b64_tr_b16 a[76:77], v17 offset:16384
ds_read_b64_tr_b16 a[78:79], v17 offset:18432
M v[180:183], a[140:143], a[164:167], v[180:183]
M v[180:183], a[136:139], a[160:163], v[180:183]
buffer_load_dwordx4 v8, s[12:15], s24 offen offset:2048 lds
M v[184:187], a[144:147], a[160:163], v[184:187]
M v[184:187], a[148:151], a[164:167], v[184:187]
M v[188:191], a[156:159], a[164:167], v[188:191]
M v[188:191], a[152:155], a[160:163], v[188:191]
s_waitcnt lgkmcnt(12)
ds_read_b64_tr_b16 a[84:85], v18 offset:16384
ds_read_b64_tr_b16 a[86:87], v18 offset:18432
M v[192:195], a[96:99], a[168:171], v[192:195]
buffer_load_dwordx4 v9, s[12:15], s24 offen offset:3072 lds
M v[192:195], a[100:103], a[172:175], v[192:195]
ds_read_b128 a[184:187], v10 offset:55296
ds_read_b128 a[188:191], v11 offset:55296
M v[196:199], a[108:111], a[172:175], v[196:199]
M v[196:199], a[104:107], a[168:171], v[196:199]
M v[200:203], a[112:115], a[168:171], v[200:203]
M v[200:203], a[116:119], a[172:175], v[200:203]
ds_read_b64_tr_b16 a[92:93], v19 offset:16384
ds_read_b64_tr_b16 a[94:95], v19 offset:18432
M v[204:207], a[124:127], a[172:175], v[204:207]
s_add_u32 s24, s24, 262144
M v[204:207], a[120:123], a[168:171], v[204:207]
M v[208:211], a[128:131], a[168:171], v[208:211]
M v[208:211], a[132:135], a[172:175], v[208:211]
M v[212:215], a[140:143], a[172:175], v[212:215]
M v[212:215], a[136:139], a[168:171], v[212:215]
buffer_load_dword v21, v20, s[60:63], s54 offen
s_add_u32 s54, s54, s55
M v[216:219], a[144:147], a[168:171], v[216:219]
M v[216:219], a[148:151], a[172:175], v[216:219]
M v[220:223], a[156:159], a[172:175], v[220:223]
M v[220:223], a[152:155], a[168:171], v[220:223]
s_waitcnt lgkmcnt(10)
M v[224:227], a[96:99], a[176:179], v[224:227]
s_cmp_eq_u32 s54, s56
s_cselect_b32 s54, s57, s54
s_cselect_b64 s[60:61], s[58:59], s[60:61]
s_cselect_b32 s62, s7, s62
M v[224:227], a[100:103], a[180:183], v[224:227]
M v[228:231], a[108:111], a[180:183], v[228:231]
M v[228:231], a[104:107], a[176:179], v[228:231]
M v[232:235], a[112:115], a[176:179], v[232:235]
M v[232:235], a[116:119], a[180:183], v[232:235]
M v[236:239], a[124:127], a[180:183], v[236:239]
M v[236:239], a[120:123], a[176:179], v[236:239]
s_waitcnt vmcnt(18) lgkmcnt(0)
s_barrier
ds_read_b128 a[160:163], v10 offset:0
ds_read_b128 a[164:167], v11 offset:0
M v[240:243], a[128:131], a[176:179], v[240:243]
s_add_u32 m0, s29, 49152
s_add_u32 s3, s23, s31
buffer_load_dwordx4 v2, s[8:11], s3 offen offset:0 lds
M v[240:243], a[132:135], a[180:183], v[240:243]
M v[244:247], a[140:143], a[180:183], v[244:247]
M v[244:247], a[136:139], a[176:179], v[244:247]
M v[248:251], a[144:147], a[176:179], v[248:251]
M v[248:251], a[148:151], a[180:183], v[248:251]
buffer_load_dwordx4 v3, s[8:11], s3 offen offset:1024 lds
M v[252:255], a[156:159], a[180:183], v[252:255]
M v[252:255], a[152:155], a[176:179], v[252:255]
M a[0:3], a[96:99], a[184:187], a[0:3]
M a[0:3], a[100:103], a[188:191], a[0:3]
ds_read_b128 a[168:171], v10 offset:2048
ds_read_b128 a[172:175], v11 offset:2048
M a[4:7], a[108:111], a[188:191], a[4:7]
M a[4:7], a[104:107], a[184:187], a[4:7]
M a[8:11], a[112:115], a[184:187], a[8:11]
buffer_load_dwordx4 v4, s[8:11], s3 offen offset:2048 lds
M a[8:11], a[116:119], a[188:191], a[8:11]
M a[12:15], a[124:127], a[188:191], a[12:15]
M a[12:15], a[120:123], a[184:187], a[12:15]
M a[16:19], a[128:131], a[184:187], a[16:19]
M a[16:19], a[132:135], a[188:191], a[16:19]
buffer_load_dwordx4 v5, s[8:11], s3 offen offset:3072 lds
M a[20:23], a[140:143], a[188:191], a[20:23]
M a[20:23], a[136:139], a[184:187], a[20:23]
M a[24:27], a[144:147], a[184:187], a[24:27]
M a[24:27], a[148:151], a[188:191], a[24:27]
M a[28:31], a[156:159], a[188:191], a[28:31]
M a[28:31], a[152:155], a[184:187], a[28:31]
s_waitcnt lgkmcnt(2)
s_mov_b32 s30, 2
Lk1_kl:
M v[32:35], a[32:35], a[160:163], v[32:35]
s_add_u32 s23, s23, 128
s_cmp_eq_u32 s23, s25
s_cselect_b32 s23, s26, s23
M v[32:35], a[36:39], a[164:167], v[32:35]
ds_read_b128 a[176:179], v10 offset:4096
ds_read_b128 a[180:183], v11 offset:4096
M v[36:39], a[44:47], a[164:167], v[36:39]
M v[36:39], a[40:43], a[160:163], v[36:39]
ds_read_b64_tr_b16 a[96:97], v12 offset:32768
ds_read_b64_tr_b16 a[98:99], v12 offset:34816
M v[40:43], a[48:51], a[160:163], v[40:43]
M v[40:43], a[52:55], a[164:167], v[40:43]
M v[44:47], a[60:63], a[164:167], v[44:47]
s_add_u32 m0, s29, 81920
s_nop 0
buffer_load_dwordx4 v6, s[12:15], s24 offen offset:0 lds
M v[44:47], a[56:59], a[160:163], v[44:47]
ds_read_b64_tr_b16 a[104:105], v13 offset:32768
ds_read_b64_tr_b16 a[106:107], v13 offset:34816
M v[48:51], a[64:67], a[160:163], v[48:51]
M v[48:51], a[68:71], a[164:167], v[48:51]
M v[52:55], a[76:79], a[164:167], v[52:55]
M v[52:55], a[72:75], a[160:163], v[52:55]
ds_read_b64_tr_b16 a[112:113], v14 offset:32768
ds_read_b64_tr_b16 a[114:115], v14 offset:34816
M v[56:59], a[80:83], a[160:163], v[56:59]
M v[56:59], a[84:87], a[164:167], v[56:59]
buffer_load_dwordx4 v7, s[12:15], s24 offen offset:1024 lds
M v[60:63], a[92:95], a[164:167], v[60:63]
M v[60:63], a[88:91], a[160:163], v[60:63]
s_waitcnt lgkmcnt(8)
ds_read_b64_tr_b16 a[120:121], v15 offset:32768
ds_read_b64_tr_b16 a[122:123], v15 offset:34816
M v[64:67], a[32:35], a[168:171], v[64:67]
M v[64:67], a[36:39], a[172:175], v[64:67]
ds_read_b128 a[184:187], v10 offset:6144
ds_read_b128 a[188:191], v11 offset:6144
M v[68:71], a[44:47], a[172:175], v[68:71]
M v[68:71], a[40:43], a[168:171], v[68:71]
ds_read_b64_tr_b16 a[128:129], v16 offset:32768
ds_read_b64_tr_b16 a[130:131], v16 offset:34816
M v[72:75], a[48:51], a[168:171], v[72:75]
buffer_load_dwordx4 v8, s[12:15], s24 offen offset:2048 lds
M v[72:75], a[52:55], a[172:175], v[72:75]
M v[76:79], a[60:63], a[172:175], v[76:79]
M v[76:79], a[56:59], a[168:171], v[76:79]
ds_read_b64_tr_b16 a[136:137], v17 offset:32768
ds_read_b64_tr_b16 a[138:139], v17 offset:34816
M v[80:83], a[64:67], a[168:171], v[80:83]
M v[80:83], a[68:71], a[172:175], v[80:83]
M v[84:87], a[76:79], a[172:175], v[84:87]
buffer_load_dwordx4 v9, s[12:15], s24 offen offset:3072 lds
M v[84:87], a[72:75], a[168:171], v[84:87]
ds_read_b64_tr_b16 a[144:145], v18 offset:32768
ds_read_b64_tr_b16 a[146:147], v18 offset:34816
M v[88:91], a[80:83], a[168:171], v[88:91]
M v[88:91], a[84:87], a[172:175], v[88:91]
M v[92:95], a[92:95], a[172:175], v[92:95]
M v[92:95], a[88:91], a[168:171], v[92:95]
s_waitcnt lgkmcnt(15)
ds_read_b64_tr_b16 a[152:153], v19 offset:32768
ds_read_b64_tr_b16 a[154:155], v19 offset:34816
M v[96:99], a[32:35], a[176:179], v[96:99]
s_add_u32 s24, s24, 262144
s_cmp_eq_u32 s24, s27
s_cselect_b32 s24, s28, s24
s_sub_u32 s6, s6, 1
s_cmp_eq_u32 s6, 0
s_cselect_b64 s[12:13], s[64:65], s[12:13]
M v[96:99], a[36:39], a[180:183], v[96:99]
M v[100:103], a[44:47], a[180:183], v[100:103]
M v[100:103], a[40:43], a[176:179], v[100:103]
M v[104:107], a[48:51], a[176:179], v[104:107]
M v[104:107], a[52:55], a[180:183], v[104:107]
M v[108:111], a[60:63], a[180:183], v[108:111]
M v[108:111], a[56:59], a[176:179], v[108:111]
s_waitcnt vmcnt(17) lgkmcnt(0)
s_barrier
ds_read_b128 a[160:163], v10 offset:16384
ds_read_b128 a[164:167], v11 offset:16384
M v[112:115], a[64:67], a[176:179], v[112:115]
s_add_u32 m0, s29, 0
s_nop 0
buffer_load_dwordx4 v2, s[8:11], s23 offen offset:0 lds
M v[112:115], a[68:71], a[180:183], v[112:115]
M v[116:119], a[76:79], a[180:183], v[116:119]
M v[116:119], a[72:75], a[176:179], v[116:119]
ds_read_b64_tr_b16 a[100:101], v12 offset:49152
ds_read_b64_tr_b16 a[102:103], v12 offset:51200
M v[120:123], a[80:83], a[176:179], v[120:123]
M v[120:123], a[84:87], a[180:183], v[120:123]
buffer_load_dwordx4 v3, s[8:11], s23 offen offset:1024 lds
M v[124:127], a[92:95], a[180:183], v[124:127]
M v[124:127], a[88:91], a[176:179], v[124:127]
M v[128:131], a[32:35], a[184:187], v[128:131]
M v[128:131], a[36:39], a[188:191], v[128:131]
ds_read_b128 a[168:171], v10 offset:18432
ds_read_b128 a[172:175], v11 offset:18432
ds_read_b64_tr_b16 a[108:109], v13 offset:49152
ds_read_b64_tr_b16 a[110:111], v13 offset:51200
M v[132:135], a[44:47], a[188:191], v[132:135]
M v[132:135], a[40:43], a[184:187], v[132:135]
buffer_load_dwordx4 v4, s[8:11], s23 offen offset:2048 lds
M v[136:139], a[48:51], a[184:187], v[136:139]
M v[136:139], a[52:55], a[188:191], v[136:139]
M v[140:143], a[60:63], a[188:191], v[140:143]
M v[140:143], a[56:59], a[184:187], v[140:143]
ds_read_b64_tr_b16 a[116:117], v14 offset:49152
ds_read_b64_tr_b16 a[118:119], v14 offset:51200
M v[144:147], a[64:67], a[184:187], v[144:147]
M v[144:147], a[68:71], a[188:191], v[144:147]
buffer_load_dwordx4 v5, s[8:11], s23 offen offset:3072 lds
M v[148:151], a[76:79], a[188:191], v[148:151]
M v[148:151], a[72:75], a[184:187], v[148:151]
M v[152:155], a[80:83], a[184:187], v[152:155]
M v[152:155], a[84:87], a[188:191], v[152:155]
ds_read_b64_tr_b16 a[124:125], v15 offset:49152
ds_read_b64_tr_b16 a[126:127], v15 offset:51200
M v[156:159], a[92:95], a[188:191], v[156:159]
s_add_u32 m0, s29, 98304
s_nop 0
buffer_load_dwordx4 v6, s[12:15], s24 offen offset:0 lds
M v[156:159], a[88:91], a[184:187], v[156:159]
s_waitcnt lgkmcnt(10)
M v[160:163], a[32:35], a[160:163], v[160:163]
M v[160:163], a[36:39], a[164:167], v[160:163]
ds_read_b128 a[176:179], v10 offset:20480
ds_read_b128 a[180:183], v11 offset:20480
M v[164:167], a[44:47], a[164:167], v[164:167]
M v[164:167], a[40:43], a[160:163], v[164:167]
ds_read_b64_tr_b16 a[132:133], v16 offset:49152
ds_read_b64_tr_b16 a[134:135], v16 offset:51200
M v[168:171], a[48:51], a[160:163], v[168:171]
M v[168:171], a[52:55], a[164:167], v[168:171]
buffer_load_dwordx4 v7, s[12:15], s24 offen offset:1024 lds
M v[172:175], a[60:63], a[164:167], v[172:175]
M v[172:175], a[56:59], a[160:163], v[172:175]
M v[176:179], a[64:67], a[160:163], v[176:179]
M v[176:179], a[68:71], a[164:167], v[176:179]
ds_read_b64_tr_b16 a[140:141], v17 offset:49152
ds_read_b64_tr_b16 a[142:143], v17 offset:51200
M v[180:183], a[76:79], a[164:167], v[180:183]
M v[180:183], a[72:75], a[160:163], v[180:183]
buffer_load_dwordx4 v8, s[12:15], s24 offen offset:2048 lds
M v[184:187], a[80:83], a[160:163], v[184:187]
M v[184:187], a[84:87], a[164:167], v[184:187]
M v[188:191], a[92:95], a[164:167], v[188:191]
M v[188:191], a[88:91], a[160:163], v[188:191]
s_waitcnt lgkmcnt(12)
ds_read_b64_tr_b16 a[148:149], v18 offset:49152
ds_read_b64_tr_b16 a[150:151], v18 offset:51200
M v[192:195], a[32:35], a[168:171], v[192:195]
buffer_load_dwordx4 v9, s[12:15], s24 offen offset:3072 lds
M v[192:195], a[36:39], a[172:175], v[192:195]
ds_read_b128 a[184:187], v10 offset:22528
ds_read_b128 a[188:191], v11 offset:22528
M v[196:199], a[44:47], a[172:175], v[196:199]
M v[196:199], a[40:43], a[168:171], v[196:199]
M v[200:203], a[48:51], a[168:171], v[200:203]
M v[200:203], a[52:55], a[172:175], v[200:203]
ds_read_b64_tr_b16 a[156:157], v19 offset:49152
ds_read_b64_tr_b16 a[158:159], v19 offset:51200
M v[204:207], a[60:63], a[172:175], v[204:207]
s_add_u32 s24, s24, 262144
M v[204:207], a[56:59], a[168:171], v[204:207]
M v[208:211], a[64:67], a[168:171], v[208:211]
M v[208:211], a[68:71], a[172:175], v[208:211]
M v[212:215], a[76:79], a[172:175], v[212:215]
M v[212:215], a[72:75], a[168:171], v[212:215]
buffer_load_dword v21, v20, s[60:63], s54 offen
s_add_u32 s54, s54, s55
M v[216:219], a[80:83], a[168:171], v[216:219]
M v[216:219], a[84:87], a[172:175], v[216:219]
M v[220:223], a[92:95], a[172:175], v[220:223]
M v[220:223], a[88:91], a[168:171], v[220:223]
s_waitcnt lgkmcnt(10)
M v[224:227], a[32:35], a[176:179], v[224:227]
s_cmp_eq_u32 s54, s56
s_cselect_b32 s54, s57, s54
s_cselect_b64 s[60:61], s[58:59], s[60:61]
s_cselect_b32 s62, s7, s62
M v[224:227], a[36:39], a[180:183], v[224:227]
M v[228:231], a[44:47], a[180:183], v[228:231]
M v[228:231], a[40:43], a[176:179], v[228:231]
M v[232:235], a[48:51], a[176:179], v[232:235]
M v[232:235], a[52:55], a[180:183], v[232:235]
M v[236:239], a[60:63], a[180:183], v[236:239]
M v[236:239], a[56:59], a[176:179], v[236:239]
s_waitcnt vmcnt(18) lgkmcnt(0)
s_barrier
ds_read_b128 a[160:163], v10 offset:32768
ds_read_b128 a[164:167], v11 offset:32768
M v[240:243], a[64:67], a[176:179], v[240:243]
s_add_u32 m0, s29, 16384
s_add_u32 s3, s23, s31
buffer_load_dwordx4 v2, s[8:11], s3 offen offset:0 lds
M v[240:243], a[68:71], a[180:183], v[240:243]
M v[244:247], a[76:79], a[180:183], v[244:247]
M v[244:247], a[72:75], a[176:179], v[244:247]
M v[248:251], a[80:83], a[176:179], v[248:251]
M v[248:251], a[84:87], a[180:183], v[248:251]
buffer_load_dwordx4 v3, s[8:11], s3 offen offset:1024 lds
M v[252:255], a[92:95], a[180:183], v[252:255]
M v[252:255], a[88:91], a[176:179], v[252:255]
M a[0:3], a[32:35], a[184:187], a[0:3]
M a[0:3], a[36:39], a[188:191], a[0:3]
ds_read_b128 a[168:171], v10 offset:34816
ds_read_b128 a[172:175], v11 offset:34816
M a[4:7], a[44:47], a[188:191], a[4:7]
M a[4:7], a[40:43], a[184:187], a[4:7]
M a[8:11], a[48:51], a[184:187], a[8:11]
buffer_load_dwordx4 v4, s[8:11], s3 offen offset:2048 lds
M a[8:11], a[52:55], a[188:191], a[8:11]
M a[12:15], a[60:63], a[188:191], a[12:15]
M a[12:15], a[56:59], a[184:187], a[12:15]
M a[16:19], a[64:67], a[184:187], a[16:19]
M a[16:19], a[68:71], a[188:191], a[16:19]
buffer_load_dwordx4 v5, s[8:11], s3 offen offset:3072 lds
M a[20:23], a[76:79], a[188:191], a[20:23]
M a[20:23], a[72:75], a[184:187], a[20:23]
M a[24:27], a[80:83], a[184:187], a[24:27]
M a[24:27], a[84:87], a[188:191], a[24:27]
M a[28:31], a[92:95], a[188:191], a[28:31]
M a[28:31], a[88:91], a[184:187], a[28:31]
s_waitcnt lgkmcnt(2)
M v[32:35], a[96:99], a[160:163], v[32:35]
s_add_u32 s23, s23, 128
s_cmp_eq_u32 s23, s25
s_cselect_b32 s23, s26, s23
M v[32:35], a[100:103], a[164:167], v[32:35]
ds_read_b128 a[176:179], v10 offset:36864
ds_read_b128 a[180:183], v11 offset:36864
M v[36:39], a[108:111], a[164:167], v[36:39]
M v[36:39], a[104:107], a[160:163], v[36:39]
ds_read_b64_tr_b16 a[32:33], v12 offset:0
ds_read_b64_tr_b16 a[34:35], v12 offset:2048
M v[40:43], a[112:115], a[160:163], v[40:43]
M v[40:43], a[116:119], a[164:167], v[40:43]
M v[44:47], a[124:127], a[164:167], v[44:47]
s_add_u32 m0, s29, 114688
s_nop 0
buffer_load_dwordx4 v6, s[12:15], s24 offen offset:0 lds
M v[44:47], a[120:123], a[160:163], v[44:47]
ds_read_b64_tr_b16 a[40:41], v13 offset:0
ds_read_b64_tr_b16 a[42:43], v13 offset:2048
M v[48:51], a[128:131], a[160:163], v[48:51]
M v[48:51], a[132:135], a[164:167], v[48:51]
M v[52:55], a[140:143], a[164:167], v[52:55]
M v[52:55], a[136:139], a[160:163], v[52:55]
ds_read_b64_tr_b16 a[48:49], v14 offset:0
ds_read_b64_tr_b16 a[50:51], v14 offset:2048
M v[56:59], a[144:147], a[160:163], v[56:59]
M v[56:59], a[148:151], a[164:167], v[56:59]
buffer_load_dwordx4 v7, s[12:15], s24 offen offset:1024 lds
M v[60:63], a[156:159], a[164:167], v[60:63]
M v[60:63], a[152:155], a[160:163], v[60:63]
s_waitcnt lgkmcnt(8)
ds_read_b64_tr_b16 a[56:57], v15 offset:0
ds_read_b64_tr_b16 a[58:59], v15 offset:2048
M v[64:67], a[96:99], a[168:171], v[64:67]
M v[64:67], a[100:103], a[172:175], v[64:67]
ds_read_b128 a[184:187], v10 offset:38912
ds_read_b128 a[188:191], v11 offset:38912
M v[68:71], a[108:111], a[172:175], v[68:71]
M v[68:71], a[104:107], a[168:171], v[68:71]
ds_read_b64_tr_b16 a[64:65], v16 offset:0
ds_read_b64_tr_b16 a[66:67], v16 offset:2048
M v[72:75], a[112:115], a[168:171], v[72:75]
buffer_load_dwordx4 v8, s[12:15], s24 offen offset:2048 lds
M v[72:75], a[116:119], a[172:175], v[72:75]
M v[76:79], a[124:127], a[172:175], v[76:79]
M v[76:79], a[120:123], a[168:171], v[76:79]
ds_read_b64_tr_b16 a[72:73], v17 offset:0
ds_read_b64_tr_b16 a[74:75], v17 offset:2048
M v[80:83], a[128:131], a[168:171], v[80:83]
M v[80:83], a[132:135], a[172:175], v[80:83]
M v[84:87], a[140:143], a[172:175], v[84:87]
buffer_load_dwordx4 v9, s[12:15], s24 offen offset:3072 lds
M v[84:87], a[136:139], a[168:171], v[84:87]
ds_read_b64_tr_b16 a[80:81], v18 offset:0
ds_read_b64_tr_b16 a[82:83], v18 offset:2048
M v[88:91], a[144:147], a[168:171], v[88:91]
M v[88:91], a[148:151], a[172:175], v[88:91]
M v[92:95], a[156:159], a[172:175], v[92:95]
M v[92:95], a[152:155], a[168:171], v[92:95]
s_waitcnt lgkmcnt(15)
ds_read_b64_tr_b16 a[88:89], v19 offset:0
ds_read_b64_tr_b16 a[90:91], v19 offset:2048
M v[96:99], a[96:99], a[176:179], v[96:99]
s_add_u32 s24, s24, 262144
s_cmp_eq_u32 s24, s27
s_cselect_b32 s24, s28, s24
s_sub_u32 s6, s6, 1
s_cmp_eq_u32 s6, 0
s_cselect_b64 s[12:13], s[64:65], s[12:13]
M v[96:99], a[100:103], a[180:183], v[96:99]
M v[100:103], a[108:111], a[180:183], v[100:103]
M v[100:103], a[104:107], a[176:179], v[100:103]
M v[104:107], a[112:115], a[176:179], v[104:107]
M v[104:107], a[116:119], a[180:183], v[104:107]
M v[108:111], a[124:127], a[180:183], v[108:111]
M v[108:111], a[120:123], a[176:179], v[108:111]
s_waitcnt vmcnt(17) lgkmcnt(0)
s_barrier
ds_read_b128 a[160:163], v10 offset:49152
ds_read_b128 a[164:167], v11 offset:49152
M v[112:115], a[128:131], a[176:179], v[112:115]
s_add_u32 m0, s29, 32768
s_nop 0
buffer_load_dwordx4 v2, s[8:11], s23 offen offset:0 lds
M v[112:115], a[132:135], a[180:183], v[112:115]
M v[116:119], a[140:143], a[180:183], v[116:119]
M v[116:119], a[136:139], a[176:179], v[116:119]
ds_read_b64_tr_b16 a[36:37], v12 offset:16384
ds_read_b64_tr_b16 a[38:39], v12 offset:18432
M v[120:123], a[144:147], a[176:179], v[120:123]
M v[120:123], a[148:151], a[180:183], v[120:123]
buffer_load_dwordx4 v3, s[8:11], s23 offen offset:1024 lds
M v[124:127], a[156:159], a[180:183], v[124:127]
M v[124:127], a[152:155], a[176:179], v[124:127]
M v[128:131], a[96:99], a[184:187], v[128:131]
M v[128:131], a[100:103], a[188:191], v[128:131]
ds_read_b128 a[168:171], v10 offset:51200
ds_read_b128 a[172:175], v11 offset:51200
ds_read_b64_tr_b16 a[44:45], v13 offset:16384
ds_read_b64_tr_b16 a[46:47], v13 offset:18432
M v[132:135], a[108:111], a[188:191], v[132:135]
M v[132:135], a[104:107], a[184:187], v[132:135]
buffer_load_dwordx4 v4, s[8:11], s23 offen offset:2048 lds
M v[136:139], a[112:115], a[184:187], v[136:139]
M v[136:139], a[116:119], a[188:191], v[136:139]
M v[140:143], a[124:127], a[188:191], v[140:143]
M v[140:143], a[120:123], a[184:187], v[140:143]
ds_read_b64_tr_b16 a[52:53], v14 offset:16384
ds_read_b64_tr_b16 a[54:55], v14 offset:18432
M v[144:147], a[128:131], a[184:187], v[144:147]
M v[144:147], a[132:135], a[188:191], v[144:147]
buffer_load_dwordx4 v5, s[8:11], s23 offen offset:3072 lds
M v[148:151], a[140:143], a[188:191], v[148:151]
M v[148:151], a[136:139], a[184:187], v[148:151]
M v[152:155], a[144:147], a[184:187], v[152:155]
M v[152:155], a[148:151], a[188:191], v[152:155]
ds_read_b64_tr_b16 a[60:61], v15 offset:16384
ds_read_b64_tr_b16 a[62:63], v15 offset:18432
M v[156:159], a[156:159], a[188:191], v[156:159]
s_add_u32 m0, s29, 65536
s_nop 0
buffer_load_dwordx4 v6, s[12:15], s24 offen offset:0 lds
M v[156:159], a[152:155], a[184:187], v[156:159]
s_waitcnt lgkmcnt(10)
M v[160:163], a[96:99], a[160:163], v[160:163]
M v[160:163], a[100:103], a[164:167], v[160:163]
ds_read_b128 a[176:179], v10 offset:53248
ds_read_b128 a[180:183], v11 offset:53248
M v[164:167], a[108:111], a[164:167], v[164:167]
M v[164:167], a[104:107], a[160:163], v[164:167]
ds_read_b64_tr_b16 a[68:69], v16 offset:16384
ds_read_b64_tr_b16 a[70:71], v16 offset:18432
M v[168:171], a[112:115], a[160:163], v[168:171]
M v[168:171], a[116:119], a[164:167], v[168:171]
buffer_load_dwordx4 v7, s[12:15], s24 offen offset:1024 lds
M v[172:175], a[124:127], a[164:167], v[172:175]
M v[172:175], a[120:123], a[160:163], v[172:175]
M v[176:179], a[128:131], a[160:163], v[176:179]
M v[176:179], a[132:135], a[164:167], v[176:179]
ds_read_b64_tr_b16 a[76:77], v17 offset:16384
ds_read_b64_tr_b16 a[78:79], v17 offset:18432
M v[180:183], a[140:143], a[164:167], v[180:183]
M v[180:183], a[136:139], a[160:163], v[180:183]
buffer_load_dwordx4 v8, s[12:15], s24 offen offset:2048 lds
M v[184:187], a[144:147], a[160:163], v[184:187]
M v[184:187], a[148:151], a[164:167], v[184:187]
M v[188:191], a[156:159], a[164:167], v[188:191]
M v[188:191], a[152:155], a[160:163], v[188:191]
s_waitcnt lgkmcnt(12)
ds_read_b64_tr_b16 a[84:85], v18 offset:16384
ds_read_b64_tr_b16 a[86:87], v18 offset:18432
M v[192:195], a[96:99], a[168:171], v[192:195]
buffer_load_dwordx4 v9, s[12:15], s24 offen offset:3072 lds
M v[192:195], a[100:103], a[172:175], v[192:195]
ds_read_b128 a[184:187], v10 offset:55296
ds_read_b128 a[188:191], v11 offset:55296
M v[196:199], a[108:111], a[172:175], v[196:199]
M v[196:199], a[104:107], a[168:171], v[196:199]
M v[200:203], a[112:115], a[168:171], v[200:203]
M v[200:203], a[116:119], a[172:175], v[200:203]
ds_read_b64_tr_b16 a[92:93], v19 offset:16384
ds_read_b64_tr_b16 a[94:95], v19 offset:18432
M v[204:207], a[124:127], a[172:175], v[204:207]
s_add_u32 s24, s24, 262144
M v[204:207], a[120:123], a[168:171], v[204:207]
M v[208:211], a[128:131], a[168:171], v[208:211]
M v[208:211], a[132:135], a[172:175], v[208:211]
M v[212:215], a[140:143], a[172:175], v[212:215]
M v[212:215], a[136:139], a[168:171], v[212:215]
buffer_load_dword v21, v20, s[60:63], s54 offen
s_add_u32 s54, s54, s55
M v[216:219], a[144:147], a[168:171], v[216:219]
M v[216:219], a[148:151], a[172:175], v[216:219]
M v[220:223], a[156:159], a[172:175], v[220:223]
M v[220:223], a[152:155], a[168:171], v[220:223]
s_waitcnt lgkmcnt(10)
M v[224:227], a[96:99], a[176:179], v[224:227]
s_cmp_eq_u32 s54, s56
s_cselect_b32 s54, s57, s54
s_cselect_b64 s[60:61], s[58:59], s[60:61]
s_cselect_b32 s62, s7, s62
M v[224:227], a[100:103], a[180:183], v[224:227]
M v[228:231], a[108:111], a[180:183], v[228:231]
M v[228:231], a[104:107], a[176:179], v[228:231]
M v[232:235], a[112:115], a[176:179], v[232:235]
M v[232:235], a[116:119], a[180:183], v[232:235]
M v[236:239], a[124:127], a[180:183], v[236:239]
M v[236:239], a[120:123], a[176:179], v[236:239]
s_waitcnt vmcnt(18) lgkmcnt(0)
s_barrier
ds_read_b128 a[160:163], v10 offset:0
ds_read_b128 a[164:167], v11 offset:0
M v[240:243], a[128:131], a[176:179], v[240:243]
s_add_u32 m0, s29, 49152
s_add_u32 s3, s23, s31
buffer_load_dwordx4 v2, s[8:11], s3 offen offset:0 lds
M v[240:243], a[132:135], a[180:183], v[240:243]
M v[244:247], a[140:143], a[180:183], v[244:247]
M v[244:247], a[136:139], a[176:179], v[244:247]
M v[248:251], a[144:147], a[176:179], v[248:251]
M v[248:251], a[148:151], a[180:183], v[248:251]
buffer_load_dwordx4 v3, s[8:11], s3 offen offset:1024 lds
M v[252:255], a[156:159], a[180:183], v[252:255]
M v[252:255], a[152:155], a[176:179], v[252:255]
M a[0:3], a[96:99], a[184:187], a[0:3]
M a[0:3], a[100:103], a[188:191], a[0:3]
ds_read_b128 a[168:171], v10 offset:2048
ds_read_b128 a[172:175], v11 offset:2048
M a[4:7], a[108:111], a[188:191], a[4:7]
M a[4:7], a[104:107], a[184:187], a[4:7]
M a[8:11], a[112:115], a[184:187], a[8:11]
buffer_load_dwordx4 v4, s[8:11], s3 offen offset:2048 lds
M a[8:11], a[116:119], a[188:191], a[8:11]
M a[12:15], a[124:127], a[188:191], a[12:15]
M a[12:15], a[120:123], a[184:187], a[12:15]
M a[16:19], a[128:131], a[184:187], a[16:19]
M a[16:19], a[132:135], a[188:191], a[16:19]
buffer_load_dwordx4 v5, s[8:11], s3 offen offset:3072 lds
M a[20:23], a[140:143], a[188:191], a[20:23]
M a[20:23], a[136:139], a[184:187], a[20:23]
M a[24:27], a[144:147], a[184:187], a[24:27]
M a[24:27], a[148:151], a[188:191], a[24:27]
M a[28:31], a[156:159], a[188:191], a[28:31]
M a[28:31], a[152:155], a[184:187], a[28:31]
s_waitcnt lgkmcnt(2)
s_sub_u32 s30, s30, 1
s_cmp_lg_u32 s30, 0
s_cbranch_scc1 Lk1_kl
M v[32:35], a[32:35], a[160:163], v[32:35]
s_add_u32 s23, s23, 128
s_cmp_eq_u32 s23, s25
s_cselect_b32 s23, s26, s23
M v[32:35], a[36:39], a[164:167], v[32:35]
ds_read_b128 a[176:179], v10 offset:4096
ds_read_b128 a[180:183], v11 offset:4096
M v[36:39], a[44:47], a[164:167], v[36:39]
M v[36:39], a[40:43], a[160:163], v[36:39]
ds_read_b64_tr_b16 a[96:97], v12 offset:32768
ds_read_b64_tr_b16 a[98:99], v12 offset:34816
M v[40:43], a[48:51], a[160:163], v[40:43]
M v[40:43], a[52:55], a[164:167], v[40:43]
M v[44:47], a[60:63], a[164:167], v[44:47]
s_add_u32 m0, s29, 81920
s_nop 0
buffer_load_dwordx4 v6, s[12:15], s24 offen offset:0 lds
M v[44:47], a[56:59], a[160:163], v[44:47]
ds_read_b64_tr_b16 a[104:105], v13 offset:32768
ds_read_b64_tr_b16 a[106:107], v13 offset:34816
M v[48:51], a[64:67], a[160:163], v[48:51]
M v[48:51], a[68:71], a[164:167], v[48:51]
M v[52:55], a[76:79], a[164:167], v[52:55]
M v[52:55], a[72:75], a[160:163], v[52:55]
ds_read_b64_tr_b16 a[112:113], v14 offset:32768
ds_read_b64_tr_b16 a[114:115], v14 offset:34816
M v[56:59], a[80:83], a[160:163], v[56:59]
M v[56:59], a[84:87], a[164:167], v[56:59]
buffer_load_dwordx4 v7, s[12:15], s24 offen offset:1024 lds
M v[60:63], a[92:95], a[164:167], v[60:63]
M v[60:63], a[88:91], a[160:163], v[60:63]
s_waitcnt lgkmcnt(8)
ds_read_b64_tr_b16 a[120:121], v15 offset:32768
ds_read_b64_tr_b16 a[122:123], v15 offset:34816
M v[64:67], a[32:35], a[168:171], v[64:67]
M v[64:67], a[36:39], a[172:175], v[64:67]
ds_read_b128 a[184:187], v10 offset:6144
ds_read_b128 a[188:191], v11 offset:6144
M v[68:71], a[44:47], a[172:175], v[68:71]
M v[68:71], a[40:43], a[168:171], v[68:71]
ds_read_b64_tr_b16 a[128:129], v16 offset:32768
ds_read_b64_tr_b16 a[130:131], v16 offset:34816
M v[72:75], a[48:51], a[168:171], v[72:75]
buffer_load_dwordx4 v8, s[12:15], s24 offen offset:2048 lds
M v[72:75], a[52:55], a[172:175], v[72:75]
M v[76:79], a[60:63], a[172:175], v[76:79]
M v[76:79], a[56:59], a[168:171], v[76:79]
ds_read_b64_tr_b16 a[136:137], v17 offset:32768
ds_read_b64_tr_b16 a[138:139], v17 offset:34816
M v[80:83], a[64:67], a[168:171], v[80:83]
M v[80:83], a[68:71], a[172:175], v[80:83]
M v[84:87], a[76:79], a[172:175], v[84:87]
buffer_load_dwordx4 v9, s[12:15], s24 offen offset:3072 lds
M v[84:87], a[72:75], a[168:171], v[84:87]
ds_read_b64_tr_b16 a[144:145], v18 offset:32768
ds_read_b64_tr_b16 a[146:147], v18 offset:34816
M v[88:91], a[80:83], a[168:171], v[88:91]
M v[88:91], a[84:87], a[172:175], v[88:91]
M v[92:95], a[92:95], a[172:175], v[92:95]
M v[92:95], a[88:91], a[168:171], v[92:95]
s_waitcnt lgkmcnt(15)
ds_read_b64_tr_b16 a[152:153], v19 offset:32768
ds_read_b64_tr_b16 a[154:155], v19 offset:34816
M v[96:99], a[32:35], a[176:179], v[96:99]
s_add_u32 s24, s24, 262144
s_cmp_eq_u32 s24, s27
s_cselect_b32 s24, s28, s24
s_sub_u32 s6, s6, 1
s_cmp_eq_u32 s6, 0
s_cselect_b64 s[12:13], s[64:65], s[12:13]
M v[96:99], a[36:39], a[180:183], v[96:99]
M v[100:103], a[44:47], a[180:183], v[100:103]
M v[100:103], a[40:43], a[176:179], v[100:103]
M v[104:107], a[48:51], a[176:179], v[104:107]
M v[104:107], a[52:55], a[180:183], v[104:107]
M v[108:111], a[60:63], a[180:183], v[108:111]
M v[108:111], a[56:59], a[176:179], v[108:111]
s_waitcnt vmcnt(17) lgkmcnt(0)
s_barrier
ds_read_b128 a[160:163], v10 offset:16384
ds_read_b128 a[164:167], v11 offset:16384
M v[112:115], a[64:67], a[176:179], v[112:115]
s_add_u32 m0, s29, 0
s_nop 0
buffer_load_dwordx4 v2, s[8:11], s23 offen offset:0 lds
M v[112:115], a[68:71], a[180:183], v[112:115]
M v[116:119], a[76:79], a[180:183], v[116:119]
M v[116:119], a[72:75], a[176:179], v[116:119]
ds_read_b64_tr_b16 a[100:101], v12 offset:49152
ds_read_b64_tr_b16 a[102:103], v12 offset:51200
M v[120:123], a[80:83], a[176:179], v[120:123]
M v[120:123], a[84:87], a[180:183], v[120:123]
buffer_load_dwordx4 v3, s[8:11], s23 offen offset:1024 lds
M v[124:127], a[92:95], a[180:183], v[124:127]
M v[124:127], a[88:91], a[176:179], v[124:127]
M v[128:131], a[32:35], a[184:187], v[128:131]
M v[128:131], a[36:39], a[188:191], v[128:131]
ds_read_b128 a[168:171], v10 offset:18432
ds_read_b128 a[172:175], v11 offset:18432
ds_read_b64_tr_b16 a[108:109], v13 offset:49152
ds_read_b64_tr_b16 a[110:111], v13 offset:51200
M v[132:135], a[44:47], a[188:191], v[132:135]
M v[132:135], a[40:43], a[184:187], v[132:135]
buffer_load_dwordx4 v4, s[8:11], s23 offen offset:2048 lds
M v[136:139], a[48:51], a[184:187], v[136:139]
M v[136:139], a[52:55], a[188:191], v[136:139]
M v[140:143], a[60:63], a[188:191], v[140:143]
M v[140:143], a[56:59], a[184:187], v[140:143]
ds_read_b64_tr_b16 a[116:117], v14 offset:49152
ds_read_b64_tr_b16 a[118:119], v14 offset:51200
M v[144:147], a[64:67], a[184:187], v[144:147]
M v[144:147], a[68:71], a[188:191], v[144:147]
buffer_load_dwordx4 v5, s[8:11], s23 offen offset:3072 lds
M v[148:151], a[76:79], a[188:191], v[148:151]
M v[148:151], a[72:75], a[184:187], v[148:151]
M v[152:155], a[80:83], a[184:187], v[152:155]
s_lshr_b32 s3, s53, 7
s_add_u32 s3, s3, s22
M v[152:155], a[84:87], a[188:191], v[152:155]
ds_read_b64_tr_b16 a[124:125], v15 offset:49152
ds_read_b64_tr_b16 a[126:127], v15 offset:51200
s_lshl_b32 s3, s3, 5
s_lshr_b32 s19, s52, 6
M v[156:159], a[92:95], a[188:191], v[156:159]
s_add_u32 m0, s29, 98304
s_nop 0
buffer_load_dwordx4 v6, s[12:15], s24 offen offset:0 lds
s_add_u32 s3, s3, s19
s_lshl_b32 s19, s21, 1
M v[156:159], a[88:91], a[184:187], v[156:159]
s_waitcnt lgkmcnt(10)
s_add_u32 s3, s3, s19
s_lshl_b32 s92, s3, 15
M v[160:163], a[32:35], a[160:163], v[160:163]
s_add_u32 s93, s92, 32768
s_add_u32 s16, s50, 16777216
M v[160:163], a[36:39], a[164:167], v[160:163]
ds_read_b128 a[176:179], v10 offset:20480
ds_read_b128 a[180:183], v11 offset:20480
s_addc_u32 s17, s51, 0
s_mov_b32 s18, 33554432
M v[164:167], a[44:47], a[164:167], v[164:167]
s_mov_b32 s19, 0x00020000
M v[164:167], a[40:43], a[160:163], v[164:167]
ds_read_b64_tr_b16 a[132:133], v16 offset:49152
ds_read_b64_tr_b16 a[134:135], v16 offset:51200
M v[168:171], a[48:51], a[160:163], v[168:171]
M v[168:171], a[52:55], a[164:167], v[168:171]
buffer_load_dwordx4 v7, s[12:15], s24 offen offset:1024 lds
M v[172:175], a[60:63], a[164:167], v[172:175]
M v[172:175], a[56:59], a[160:163], v[172:175]
M v[176:179], a[64:67], a[160:163], v[176:179]
M v[176:179], a[68:71], a[164:167], v[176:179]
ds_read_b64_tr_b16 a[140:141], v17 offset:49152
ds_read_b64_tr_b16 a[142:143], v17 offset:51200
M v[180:183], a[76:79], a[164:167], v[180:183]
M v[180:183], a[72:75], a[160:163], v[180:183]
buffer_load_dwordx4 v8, s[12:15], s24 offen offset:2048 lds
M v[184:187], a[80:83], a[160:163], v[184:187]
M v[184:187], a[84:87], a[164:167], v[184:187]
M v[188:191], a[92:95], a[164:167], v[188:191]
M v[188:191], a[88:91], a[160:163], v[188:191]
s_waitcnt lgkmcnt(12)
ds_read_b64_tr_b16 a[148:149], v18 offset:49152
ds_read_b64_tr_b16 a[150:151], v18 offset:51200
M v[192:195], a[32:35], a[168:171], v[192:195]
buffer_load_dwordx4 v9, s[12:15], s24 offen offset:3072 lds
M v[192:195], a[36:39], a[172:175], v[192:195]
ds_read_b128 a[184:187], v10 offset:22528
ds_read_b128 a[188:191], v11 offset:22528
M v[196:199], a[44:47], a[172:175], v[196:199]
M v[196:199], a[40:43], a[168:171], v[196:199]
M v[200:203], a[48:51], a[168:171], v[200:203]
M v[200:203], a[52:55], a[172:175], v[200:203]
ds_read_b64_tr_b16 a[156:157], v19 offset:49152
ds_read_b64_tr_b16 a[158:159], v19 offset:51200
M v[204:207], a[60:63], a[172:175], v[204:207]
s_add_u32 s24, s24, 262144
M v[204:207], a[56:59], a[168:171], v[204:207]
M v[208:211], a[64:67], a[168:171], v[208:211]
M v[208:211], a[68:71], a[172:175], v[208:211]
M v[212:215], a[76:79], a[172:175], v[212:215]
M v[212:215], a[72:75], a[168:171], v[212:215]
buffer_load_dword v21, v20, s[60:63], s54 offen
s_add_u32 s54, s54, s55
M v[216:219], a[80:83], a[168:171], v[216:219]
M v[216:219], a[84:87], a[172:175], v[216:219]
M v[220:223], a[92:95], a[172:175], v[220:223]
M v[220:223], a[88:91], a[168:171], v[220:223]
s_waitcnt lgkmcnt(10)
M v[224:227], a[32:35], a[176:179], v[224:227]
s_cmp_eq_u32 s54, s56
s_cselect_b32 s54, s57, s54
s_cselect_b64 s[60:61], s[58:59], s[60:61]
s_cselect_b32 s62, s7, s62
M v[224:227], a[36:39], a[180:183], v[224:227]
M v[228:231], a[44:47], a[180:183], v[228:231]
M v[228:231], a[40:43], a[176:179], v[228:231]
M v[232:235], a[48:51], a[176:179], v[232:235]
M v[232:235], a[52:55], a[180:183], v[232:235]
M v[236:239], a[60:63], a[180:183], v[236:239]
M v[236:239], a[56:59], a[176:179], v[236:239]
s_waitcnt vmcnt(18) lgkmcnt(0)
s_barrier
ds_read_b128 a[160:163], v10 offset:32768
ds_read_b128 a[164:167], v11 offset:32768
M v[240:243], a[64:67], a[176:179], v[240:243]
s_add_u32 m0, s29, 16384
s_add_u32 s3, s23, s31
buffer_load_dwordx4 v2, s[8:11], s3 offen offset:0 lds
M v[240:243], a[68:71], a[180:183], v[240:243]
M v[244:247], a[76:79], a[180:183], v[244:247]
M v[244:247], a[72:75], a[176:179], v[244:247]
M v[248:251], a[80:83], a[176:179], v[248:251]
M v[248:251], a[84:87], a[180:183], v[248:251]
buffer_load_dwordx4 v3, s[8:11], s3 offen offset:1024 lds
M v[252:255], a[92:95], a[180:183], v[252:255]
M v[252:255], a[88:91], a[176:179], v[252:255]
M a[0:3], a[32:35], a[184:187], a[0:3]
M a[0:3], a[36:39], a[188:191], a[0:3]
ds_read_b128 a[168:171], v10 offset:34816
ds_read_b128 a[172:175], v11 offset:34816
M a[4:7], a[44:47], a[188:191], a[4:7]
M a[4:7], a[40:43], a[184:187], a[4:7]
M a[8:11], a[48:51], a[184:187], a[8:11]
buffer_load_dwordx4 v4, s[8:11], s3 offen offset:2048 lds
M a[8:11], a[52:55], a[188:191], a[8:11]
M a[12:15], a[60:63], a[188:191], a[12:15]
M a[12:15], a[56:59], a[184:187], a[12:15]
M a[16:19], a[64:67], a[184:187], a[16:19]
M a[16:19], a[68:71], a[188:191], a[16:19]
buffer_load_dwordx4 v5, s[8:11], s3 offen offset:3072 lds
M a[20:23], a[76:79], a[188:191], a[20:23]
M a[20:23], a[72:75], a[184:187], a[20:23]
M a[24:27], a[80:83], a[184:187], a[24:27]
M a[24:27], a[84:87], a[188:191], a[24:27]
M a[28:31], a[92:95], a[188:191], a[28:31]
M a[28:31], a[88:91], a[184:187], a[28:31]
s_waitcnt lgkmcnt(2)
M v[32:35], a[96:99], a[160:163], v[32:35]
s_add_u32 s23, s23, 128
s_cmp_eq_u32 s23, s25
s_cselect_b32 s23, s26, s23
M v[32:35], a[100:103], a[164:167], v[32:35]
ds_read_b128 a[176:179], v10 offset:36864
ds_read_b128 a[180:183], v11 offset:36864
M v[36:39], a[108:111], a[164:167], v[36:39]
M v[36:39], a[104:107], a[160:163], v[36:39]
ds_read_b64_tr_b16 a[32:33], v12 offset:0
ds_read_b64_tr_b16 a[34:35], v12 offset:2048
M v[40:43], a[112:115], a[160:163], v[40:43]
M v[40:43], a[116:119], a[164:167], v[40:43]
M v[44:47], a[124:127], a[164:167], v[44:47]
s_add_u32 m0, s29, 114688
s_nop 0
buffer_load_dwordx4 v6, s[12:15], s24 offen offset:0 lds
M v[44:47], a[120:123], a[160:163], v[44:47]
ds_read_b64_tr_b16 a[40:41], v13 offset:0
ds_read_b64_tr_b16 a[42:43], v13 offset:2048
M v[48:51], a[128:131], a[160:163], v[48:51]
M v[48:51], a[132:135], a[164:167], v[48:51]
M v[52:55], a[140:143], a[164:167], v[52:55]
M v[52:55], a[136:139], a[160:163], v[52:55]
ds_read_b64_tr_b16 a[48:49], v14 offset:0
ds_read_b64_tr_b16 a[50:51], v14 offset:2048
M v[56:59], a[144:147], a[160:163], v[56:59]
buffer_load_dwordx4 v7, s[12:15], s24 offen offset:1024 lds
M v[56:59], a[148:151], a[164:167], v[56:59]
M v[60:63], a[156:159], a[164:167], v[60:63]
M v[60:63], a[152:155], a[160:163], v[60:63]
s_waitcnt lgkmcnt(8)
ds_read_b64_tr_b16 a[56:57], v15 offset:0
ds_read_b64_tr_b16 a[58:59], v15 offset:2048
M v[64:67], a[96:99], a[168:171], v[64:67]
M v[64:67], a[100:103], a[172:175], v[64:67]
ds_read_b128 a[184:187], v10 offset:38912
ds_read_b128 a[188:191], v11 offset:38912
M v[68:71], a[108:111], a[172:175], v[68:71]
M v[68:71], a[104:107], a[168:171], v[68:71]
ds_read_b64_tr_b16 a[64:65], v16 offset:0
ds_read_b64_tr_b16 a[66:67], v16 offset:2048
v_cvt_pk_bf16_f32 v32, v32, v33
v_cvt_pk_bf16_f32 v33, v34, v35
M v[72:75], a[112:115], a[168:171], v[72:75]
buffer_load_dwordx4 v8, s[12:15], s24 offen offset:2048 lds
v_cvt_pk_bf16_f32 v34, v36, v37
v_cvt_pk_bf16_f32 v35, v38, v39
M v[72:75], a[116:119], a[172:175], v[72:75]
v_cvt_pk_bf16_f32 v40, v40, v41
v_cvt_pk_bf16_f32 v41, v42, v43
M v[76:79], a[124:127], a[172:175], v[76:79]
v_cvt_pk_bf16_f32 v42, v44, v45
v_cvt_pk_bf16_f32 v43, v46, v47
M v[76:79], a[120:123], a[168:171], v[76:79]
ds_read_b64_tr_b16 a[72:73], v17 offset:0
ds_read_b64_tr_b16 a[74:75], v17 offset:2048
v_cvt_pk_bf16_f32 v48, v48, v49
v_cvt_pk_bf16_f32 v49, v50, v51
M v[80:83], a[128:131], a[168:171], v[80:83]
v_cvt_pk_bf16_f32 v50, v52, v53
v_cvt_pk_bf16_f32 v51, v54, v55
M v[80:83], a[132:135], a[172:175], v[80:83]
buffer_load_dwordx4 v9, s[12:15], s24 offen offset:3072 lds
v_cvt_pk_bf16_f32 v56, v56, v57
v_cvt_pk_bf16_f32 v57, v58, v59
M v[84:87], a[140:143], a[172:175], v[84:87]
v_cvt_pk_bf16_f32 v58, v60, v61
v_cvt_pk_bf16_f32 v59, v62, v63
M v[84:87], a[136:139], a[168:171], v[84:87]
ds_read_b64_tr_b16 a[80:81], v18 offset:0
ds_read_b64_tr_b16 a[82:83], v18 offset:2048
M v[88:91], a[144:147], a[168:171], v[88:91]
M v[88:91], a[148:151], a[172:175], v[88:91]
M v[92:95], a[156:159], a[172:175], v[92:95]
s_add_u32 s94, s92, 0
buffer_store_dwordx4 v[32:35], v1, s[16:19], s94 offen offset:0 sc1
M v[92:95], a[152:155], a[168:171], v[92:95]
s_waitcnt lgkmcnt(15)
ds_read_b64_tr_b16 a[88:89], v19 offset:0
ds_read_b64_tr_b16 a[90:91], v19 offset:2048
M v[96:99], a[96:99], a[176:179], v[96:99]
s_add_u32 s24, s24, 262144
s_cmp_eq_u32 s24, s27
s_cselect_b32 s24, s28, s24
s_sub_u32 s6, s6, 1
s_cmp_eq_u32 s6, 0
s_cselect_b64 s[12:13], s[64:65], s[12:13]
M v[96:99], a[100:103], a[180:183], v[96:99]
M v[100:103], a[108:111], a[180:183], v[100:103]
M v[100:103], a[104:107], a[176:179], v[100:103]
v_cvt_pk_bf16_f32 v64, v64, v65
v_cvt_pk_bf16_f32 v65, v66, v67
M v[104:107], a[112:115], a[176:179], v[104:107]
v_cvt_pk_bf16_f32 v66, v68, v69
v_cvt_pk_bf16_f32 v67, v70, v71
M v[104:107], a[116:119], a[180:183], v[104:107]
s_add_u32 s94, s92, 0
buffer_store_dwordx4 v[40:43], v1, s[16:19], s94 offen offset:1024 sc1
v_cvt_pk_bf16_f32 v72, v72, v73
v_cvt_pk_bf16_f32 v73, v74, v75
M v[108:111], a[124:127], a[180:183], v[108:111]
v_cvt_pk_bf16_f32 v74, v76, v77
v_cvt_pk_bf16_f32 v75, v78, v79
M v[108:111], a[120:123], a[176:179], v[108:111]
s_waitcnt vmcnt(19) lgkmcnt(0)
s_barrier
ds_read_b128 a[160:163], v10 offset:49152
ds_read_b128 a[164:167], v11 offset:49152
v_cvt_pk_bf16_f32 v80, v80, v81
v_cvt_pk_bf16_f32 v81, v82, v83
M v[112:115], a[128:131], a[176:179], v[112:115]
s_add_u32 m0, s29, 32768
s_nop 0
buffer_load_dwordx4 v2, s[8:11], s23 offen offset:0 lds
v_cvt_pk_bf16_f32 v82, v84, v85
v_cvt_pk_bf16_f32 v83, v86, v87
M v[112:115], a[132:135], a[180:183], v[112:115]
v_cvt_pk_bf16_f32 v88, v88, v89
v_cvt_pk_bf16_f32 v89, v90, v91
M v[116:119], a[140:143], a[180:183], v[116:119]
v_cvt_pk_bf16_f32 v90, v92, v93
v_cvt_pk_bf16_f32 v91, v94, v95
M v[116:119], a[136:139], a[176:179], v[116:119]
ds_read_b64_tr_b16 a[36:37], v12 offset:16384
ds_read_b64_tr_b16 a[38:39], v12 offset:18432
M v[120:123], a[144:147], a[176:179], v[120:123]
s_add_u32 s94, s92, 0
buffer_store_dwordx4 v[48:51], v1, s[16:19], s94 offen offset:2048 sc1
M v[120:123], a[148:151], a[180:183], v[120:123]
buffer_load_dwordx4 v3, s[8:11], s23 offen offset:1024 lds
M v[124:127], a[156:159], a[180:183], v[124:127]
M v[124:127], a[152:155], a[176:179], v[124:127]
M v[128:131], a[96:99], a[184:187], v[128:131]
M v[128:131], a[100:103], a[188:191], v[128:131]
ds_read_b128 a[168:171], v10 offset:51200
ds_read_b128 a[172:175], v11 offset:51200
ds_read_b64_tr_b16 a[44:45], v13 offset:16384
ds_read_b64_tr_b16 a[46:47], v13 offset:18432
M v[132:135], a[108:111], a[188:191], v[132:135]
M v[132:135], a[104:107], a[184:187], v[132:135]
s_add_u32 s94, s92, 0
buffer_store_dwordx4 v[56:59], v1, s[16:19], s94 offen offset:3072 sc1
v_cvt_pk_bf16_f32 v96, v96, v97
v_cvt_pk_bf16_f32 v97, v98, v99
M v[136:139], a[112:115], a[184:187], v[136:139]
buffer_load_dwordx4 v4, s[8:11], s23 offen offset:2048 lds
v_cvt_pk_bf16_f32 v98, v100, v101
v_cvt_pk_bf16_f32 v99, v102, v103
M v[136:139], a[116:119], a[188:191], v[136:139]
v_cvt_pk_bf16_f32 v104, v104, v105
v_cvt_pk_bf16_f32 v105, v106, v107
M v[140:143], a[124:127], a[188:191], v[140:143]
v_cvt_pk_bf16_f32 v106, v108, v109
v_cvt_pk_bf16_f32 v107, v110, v111
M v[140:143], a[120:123], a[184:187], v[140:143]
ds_read_b64_tr_b16 a[52:53], v14 offset:16384
ds_read_b64_tr_b16 a[54:55], v14 offset:18432
v_cvt_pk_bf16_f32 v112, v112, v113
v_cvt_pk_bf16_f32 v113, v114, v115
M v[144:147], a[128:131], a[184:187], v[144:147]
buffer_load_dwordx4 v5, s[8:11], s23 offen offset:3072 lds
v_cvt_pk_bf16_f32 v114, v116, v117
v_cvt_pk_bf16_f32 v115, v118, v119
M v[144:147], a[132:135], a[188:191], v[144:147]
v_cvt_pk_bf16_f32 v120, v120, v121
v_cvt_pk_bf16_f32 v121, v122, v123
M v[148:151], a[140:143], a[188:191], v[148:151]
s_add_u32 s94, s92, 4096
buffer_store_dwordx4 v[64:67], v1, s[16:19], s94 offen offset:0 sc1
v_cvt_pk_bf16_f32 v122, v124, v125
v_cvt_pk_bf16_f32 v123, v126, v127
M v[148:151], a[136:139], a[184:187], v[148:151]
M v[152:155], a[144:147], a[184:187], v[152:155]
M v[152:155], a[148:151], a[188:191], v[152:155]
ds_read_b64_tr_b16 a[60:61], v15 offset:16384
ds_read_b64_tr_b16 a[62:63], v15 offset:18432
M v[156:159], a[156:159], a[188:191], v[156:159]
s_add_u32 m0, s29, 65536
s_nop 0
buffer_load_dwordx4 v6, s[12:15], s24 offen offset:0 lds
M v[156:159], a[152:155], a[184:187], v[156:159]
s_waitcnt lgkmcnt(10)
M v[160:163], a[96:99], a[160:163], v[160:163]
M v[160:163], a[100:103], a[164:167], v[160:163]
ds_read_b128 a[176:179], v10 offset:53248
ds_read_b128 a[180:183], v11 offset:53248
M v[164:167], a[108:111], a[164:167], v[164:167]
s_add_u32 s94, s92, 4096
buffer_store_dwordx4 v[72:75], v1, s[16:19], s94 offen offset:1024 sc1
M v[164:167], a[104:107], a[160:163], v[164:167]
ds_read_b64_tr_b16 a[68:69], v16 offset:16384
ds_read_b64_tr_b16 a[70:71], v16 offset:18432
v_cvt_pk_bf16_f32 v128, v128, v129
v_cvt_pk_bf16_f32 v129, v130, v131
M v[168:171], a[112:115], a[160:163], v[168:171]
v_cvt_pk_bf16_f32 v130, v132, v133
v_cvt_pk_bf16_f32 v131, v134, v135
M v[168:171], a[116:119], a[164:167], v[168:171]
buffer_load_dwordx4 v7, s[12:15], s24 offen offset:1024 lds
v_cvt_pk_bf16_f32 v136, v136, v137
v_cvt_pk_bf16_f32 v137, v138, v139
M v[172:175], a[124:127], a[164:167], v[172:175]
v_cvt_pk_bf16_f32 v138, v140, v141
v_cvt_pk_bf16_f32 v139, v142, v143
M v[172:175], a[120:123], a[160:163], v[172:175]
v_cvt_pk_bf16_f32 v144, v144, v145
v_cvt_pk_bf16_f32 v145, v146, v147
M v[176:179], a[128:131], a[160:163], v[176:179]
s_add_u32 s94, s92, 4096
buffer_store_dwordx4 v[80:83], v1, s[16:19], s94 offen offset:2048 sc1
v_cvt_pk_bf16_f32 v146, v148, v149
v_cvt_pk_bf16_f32 v147, v150, v151
M v[176:179], a[132:135], a[164:167], v[176:179]
ds_read_b64_tr_b16 a[76:77], v17 offset:16384
ds_read_b64_tr_b16 a[78:79], v17 offset:18432
v_cvt_pk_bf16_f32 v152, v152, v153
v_cvt_pk_bf16_f32 v153, v154, v155
M v[180:183], a[140:143], a[164:167], v[180:183]
v_cvt_pk_bf16_f32 v154, v156, v157
v_cvt_pk_bf16_f32 v155, v158, v159
M v[180:183], a[136:139], a[160:163], v[180:183]
buffer_load_dwordx4 v8, s[12:15], s24 offen offset:2048 lds
M v[184:187], a[144:147], a[160:163], v[184:187]
M v[184:187], a[148:151], a[164:167], v[184:187]
M v[188:191], a[156:159], a[164:167], v[188:191]
buffer_load_dwordx4 v9, s[12:15], s24 offen offset:3072 lds
M v[188:191], a[152:155], a[160:163], v[188:191]
s_waitcnt lgkmcnt(12)
ds_read_b64_tr_b16 a[84:85], v18 offset:16384
ds_read_b64_tr_b16 a[86:87], v18 offset:18432
M v[192:195], a[96:99], a[168:171], v[192:195]
s_add_u32 s94, s92, 4096
buffer_store_dwordx4 v[88:91], v1, s[16:19], s94 offen offset:3072 sc1
M v[192:195], a[100:103], a[172:175], v[192:195]
ds_read_b128 a[184:187], v10 offset:55296
ds_read_b128 a[188:191], v11 offset:55296
M v[196:199], a[108:111], a[172:175], v[196:199]
M v[196:199], a[104:107], a[168:171], v[196:199]
v_cvt_pk_bf16_f32 v160, v160, v161
v_cvt_pk_bf16_f32 v161, v162, v163
M v[200:203], a[112:115], a[168:171], v[200:203]
v_cvt_pk_bf16_f32 v162, v164, v165
v_cvt_pk_bf16_f32 v163, v166, v167
M v[200:203], a[116:119], a[172:175], v[200:203]
ds_read_b64_tr_b16 a[92:93], v19 offset:16384
ds_read_b64_tr_b16 a[94:95], v19 offset:18432
v_cvt_pk_bf16_f32 v168, v168, v169
v_cvt_pk_bf16_f32 v169, v170, v171
M v[204:207], a[124:127], a[172:175], v[204:207]
s_add_u32 s94, s92, 8192
buffer_store_dwordx4 v[96:99], v1, s[16:19], s94 offen offset:0 sc1
v_cvt_pk_bf16_f32 v170, v172, v173
v_cvt_pk_bf16_f32 v171, v174, v175
M v[204:207], a[120:123], a[168:171], v[204:207]
s_add_u32 s24, s24, 262144
v_cvt_pk_bf16_f32 v176, v176, v177
v_cvt_pk_bf16_f32 v177, v178, v179
M v[208:211], a[128:131], a[168:171], v[208:211]
v_cvt_pk_bf16_f32 v178, v180, v181
v_cvt_pk_bf16_f32 v179, v182, v183
M v[208:211], a[132:135], a[172:175], v[208:211]
v_cvt_pk_bf16_f32 v184, v184, v185
v_cvt_pk_bf16_f32 v185, v186, v187
M v[212:215], a[140:143], a[172:175], v[212:215]
buffer_load_dword v21, v20, s[60:63], s54 offen
s_add_u32 s54, s54, s55
v_cvt_pk_bf16_f32 v186, v188, v189
v_cvt_pk_bf16_f32 v187, v190, v191
M v[212:215], a[136:139], a[168:171], v[212:215]
M v[216:219], a[144:147], a[168:171], v[216:219]
M v[216:219], a[148:151], a[172:175], v[216:219]
s_add_u32 s94, s92, 8192
buffer_store_dwordx4 v[104:107], v1, s[16:19], s94 offen offset:1024 sc1
M v[220:223], a[156:159], a[172:175], v[220:223]
M v[220:223], a[152:155], a[168:171], v[220:223]
s_waitcnt lgkmcnt(10)
M v[224:227], a[96:99], a[176:179], v[224:227]
s_cmp_eq_u32 s54, s56
s_cselect_b32 s54, s57, s54
s_cselect_b64 s[60:61], s[58:59], s[60:61]
s_cselect_b32 s62, s7, s62
M v[224:227], a[100:103], a[180:183], v[224:227]
M v[228:231], a[108:111], a[180:183], v[228:231]
M v[228:231], a[104:107], a[176:179], v[228:231]
v_cvt_pk_bf16_f32 v192, v192, v193
v_cvt_pk_bf16_f32 v193, v194, v195
M v[232:235], a[112:115], a[176:179], v[232:235]
s_add_u32 s94, s92, 8192
buffer_store_dwordx4 v[112:115], v1, s[16:19], s94 offen offset:2048 sc1
v_cvt_pk_bf16_f32 v194, v196, v197
v_cvt_pk_bf16_f32 v195, v198, v199
M v[232:235], a[116:119], a[180:183], v[232:235]
v_cvt_pk_bf16_f32 v200, v200, v201
v_cvt_pk_bf16_f32 v201, v202, v203
M v[236:239], a[124:127], a[180:183], v[236:239]
v_cvt_pk_bf16_f32 v202, v204, v205
v_cvt_pk_bf16_f32 v203, v206, v207
M v[236:239], a[120:123], a[176:179], v[236:239]
s_waitcnt vmcnt(29) lgkmcnt(0)
s_barrier
ds_read_b128 a[160:163], v10 offset:0
ds_read_b128 a[164:167], v11 offset:0
v_cvt_pk_bf16_f32 v208, v208, v209
v_cvt_pk_bf16_f32 v209, v210, v211
M v[240:243], a[128:131], a[176:179], v[240:243]
s_add_u32 m0, s29, 49152
s_add_u32 s3, s23, s31
buffer_load_dwordx4 v2, s[8:11], s3 offen offset:0 lds
v_cvt_pk_bf16_f32 v210, v212, v213
v_cvt_pk_bf16_f32 v211, v214, v215
M v[240:243], a[132:135], a[180:183], v[240:243]
v_cvt_pk_bf16_f32 v216, v216, v217
v_cvt_pk_bf16_f32 v217, v218, v219
M v[244:247], a[140:143], a[180:183], v[244:247]
v_cvt_pk_bf16_f32 v218, v220, v221
v_cvt_pk_bf16_f32 v219, v222, v223
M v[244:247], a[136:139], a[176:179], v[244:247]
s_add_u32 s94, s92, 8192
buffer_store_dwordx4 v[120:123], v1, s[16:19], s94 offen offset:3072 sc1
M v[248:251], a[144:147], a[176:179], v[248:251]
M v[248:251], a[148:151], a[180:183], v[248:251]
buffer_load_dwordx4 v3, s[8:11], s3 offen offset:1024 lds
M v[252:255], a[156:159], a[180:183], v[252:255]
M v[252:255], a[152:155], a[176:179], v[252:255]
M a[0:3], a[96:99], a[184:187], a[0:3]
M a[0:3], a[100:103], a[188:191], a[0:3]
ds_read_b128 a[168:171], v10 offset:2048
ds_read_b128 a[172:175], v11 offset:2048
M a[4:7], a[108:111], a[188:191], a[4:7]
s_add_u32 s94, s92, 12288
buffer_store_dwordx4 v[128:131], v1, s[16:19], s94 offen offset:0 sc1
M a[4:7], a[104:107], a[184:187], a[4:7]
v_cvt_pk_bf16_f32 v224, v224, v225
v_cvt_pk_bf16_f32 v225, v226, v227
M a[8:11], a[112:115], a[184:187], a[8:11]
v_cvt_pk_bf16_f32 v226, v228, v229
v_cvt_pk_bf16_f32 v227, v230, v231
M a[8:11], a[116:119], a[188:191], a[8:11]
buffer_load_dwordx4 v4, s[8:11], s3 offen offset:2048 lds
v_cvt_pk_bf16_f32 v232, v232, v233
v_cvt_pk_bf16_f32 v233, v234, v235
M a[12:15], a[124:127], a[188:191], a[12:15]
v_cvt_pk_bf16_f32 v234, v236, v237
v_cvt_pk_bf16_f32 v235, v238, v239
M a[12:15], a[120:123], a[184:187], a[12:15]
v_cvt_pk_bf16_f32 v240, v240, v241
v_cvt_pk_bf16_f32 v241, v242, v243
M a[16:19], a[128:131], a[184:187], a[16:19]
v_cvt_pk_bf16_f32 v242, v244, v245
v_cvt_pk_bf16_f32 v243, v246, v247
M a[16:19], a[132:135], a[188:191], a[16:19]
s_add_u32 s94, s92, 12288
buffer_store_dwordx4 v[136:139], v1, s[16:19], s94 offen offset:1024 sc1
v_cvt_pk_bf16_f32 v248, v248, v249
v_cvt_pk_bf16_f32 v249, v250, v251
M a[20:23], a[140:143], a[188:191], a[20:23]
buffer_load_dwordx4 v5, s[8:11], s3 offen offset:3072 lds
v_cvt_pk_bf16_f32 v250, v252, v253
v_cvt_pk_bf16_f32 v251, v254, v255
M a[20:23], a[136:139], a[184:187], a[20:23]
M a[24:27], a[144:147], a[184:187], a[24:27]
M a[24:27], a[148:151], a[188:191], a[24:27]
M a[28:31], a[156:159], a[188:191], a[28:31]
M a[28:31], a[152:155], a[184:187], a[28:31]
s_waitcnt lgkmcnt(2)
M v[32:35], a[160:163], a[32:35], 0
s_add_u32 s94, s92, 12288
buffer_store_dwordx4 v[144:147], v1, s[16:19], s94 offen offset:2048 sc1
M v[32:35], a[164:167], a[36:39], v[32:35]
ds_read_b128 a[176:179], v10 offset:4096
ds_read_b128 a[180:183], v11 offset:4096
M v[36:39], a[164:167], a[44:47], 0
s_add_u32 s23, s23, 128
s_cmp_eq_u32 s23, s25
s_cselect_b32 s23, s26, s23
M v[36:39], a[160:163], a[40:43], v[36:39]
ds_read_b64_tr_b16 a[96:97], v12 offset:32768
ds_read_b64_tr_b16 a[98:99], v12 offset:34816
M v[40:43], a[160:163], a[48:51], 0
M v[40:43], a[164:167], a[52:55], v[40:43]
M v[44:47], a[164:167], a[60:63], 0
s_add_u32 m0, s29, 81920
s_nop 0
buffer_load_dwordx4 v6, s[12:15], s24 offen offset:0 lds
v_accvgpr_read_b32 v24, a0
v_accvgpr_read_b32 v25, a1
M v[44:47], a[160:163], a[56:59], v[44:47]
ds_read_b64_tr_b16 a[104:105], v13 offset:32768
ds_read_b64_tr_b16 a[106:107], v13 offset:34816
v_accvgpr_read_b32 v26, a2
v_accvgpr_read_b32 v27, a3
M v[48:51], a[160:163], a[64:67], 0
s_add_u32 s94, s92, 12288
buffer_store_dwordx4 v[152:155], v1, s[16:19], s94 offen offset:3072 sc1
v_accvgpr_read_b32 v28, a4
v_accvgpr_read_b32 v29, a5
M v[48:51], a[164:167], a[68:71], v[48:51]
v_accvgpr_read_b32 v30, a6
v_accvgpr_read_b32 v31, a7
M v[52:55], a[164:167], a[76:79], 0
v_cvt_pk_bf16_f32 v24, v24, v25
v_cvt_pk_bf16_f32 v25, v26, v27
M v[52:55], a[160:163], a[72:75], v[52:55]
ds_read_b64_tr_b16 a[112:113], v14 offset:32768
ds_read_b64_tr_b16 a[114:115], v14 offset:34816
v_cvt_pk_bf16_f32 v26, v28, v29
v_cvt_pk_bf16_f32 v27, v30, v31
M v[56:59], a[160:163], a[80:83], 0
buffer_load_dwordx4 v7, s[12:15], s24 offen offset:1024 lds
M v[56:59], a[164:167], a[84:87], v[56:59]
M v[60:63], a[164:167], a[92:95], 0
s_add_u32 s94, s93, 0
buffer_store_dwordx4 v[160:163], v1, s[16:19], s94 offen offset:0 sc1
M v[60:63], a[160:163], a[88:91], v[60:63]
s_waitcnt lgkmcnt(8)
ds_read_b64_tr_b16 a[120:121], v15 offset:32768
ds_read_b64_tr_b16 a[122:123], v15 offset:34816
M v[64:67], a[168:171], a[32:35], 0
s_add_u32 s94, s93, 12288
buffer_store_dwordx4 v[24:27], v1, s[16:19], s94 offen offset:0 sc1
M v[64:67], a[172:175], a[36:39], v[64:67]
ds_read_b128 a[184:187], v10 offset:6144
ds_read_b128 a[188:191], v11 offset:6144
M v[68:71], a[172:175], a[44:47], 0
M v[68:71], a[168:171], a[40:43], v[68:71]
ds_read_b64_tr_b16 a[128:129], v16 offset:32768
ds_read_b64_tr_b16 a[130:131], v16 offset:34816
M v[72:75], a[168:171], a[48:51], 0
M v[72:75], a[172:175], a[52:55], v[72:75]
s_add_u32 s94, s93, 0
buffer_store_dwordx4 v[168:171], v1, s[16:19], s94 offen offset:1024 sc1
M v[76:79], a[172:175], a[60:63], 0
buffer_load_dwordx4 v8, s[12:15], s24 offen offset:2048 lds
M v[76:79], a[168:171], a[56:59], v[76:79]
ds_read_b64_tr_b16 a[136:137], v17 offset:32768
ds_read_b64_tr_b16 a[138:139], v17 offset:34816
M v[80:83], a[168:171], a[64:67], 0
M v[80:83], a[172:175], a[68:71], v[80:83]
M v[84:87], a[172:175], a[76:79], 0
buffer_load_dwordx4 v9, s[12:15], s24 offen offset:3072 lds
M v[84:87], a[168:171], a[72:75], v[84:87]
ds_read_b64_tr_b16 a[144:145], v18 offset:32768
ds_read_b64_tr_b16 a[146:147], v18 offset:34816
M v[88:91], a[168:171], a[80:83], 0
s_add_u32 s94, s93, 0
buffer_store_dwordx4 v[176:179], v1, s[16:19], s94 offen offset:2048 sc1
M v[88:91], a[172:175], a[84:87], v[88:91]
M v[92:95], a[172:175], a[92:95], 0
M v[92:95], a[168:171], a[88:91], v[92:95]
s_waitcnt lgkmcnt(15)
ds_read_b64_tr_b16 a[152:153], v19 offset:32768
ds_read_b64_tr_b16 a[154:155], v19 offset:34816
M v[96:99], a[176:179], a[32:35], 0
s_add_u32 s24, s24, 262144
s_cmp_eq_u32 s24, s27
s_cselect_b32 s24, s28, s24
s_sub_u32 s6, s6, 1
s_cmp_eq_u32 s6, 0
s_cselect_b64 s[12:13], s[64:65], s[12:13]
v_accvgpr_read_b32 v24, a8
v_accvgpr_read_b32 v25, a9
M v[96:99], a[180:183], a[36:39], v[96:99]
v_accvgpr_read_b32 v26, a10
v_accvgpr_read_b32 v27, a11
M v[100:103], a[180:183], a[44:47], 0
v_accvgpr_read_b32 v28, a12
v_accvgpr_read_b32 v29, a13
M v[100:103], a[176:179], a[40:43], v[100:103]
s_add_u32 s94, s93, 0
buffer_store_dwordx4 v[184:187], v1, s[16:19], s94 offen offset:3072 sc1
v_accvgpr_read_b32 v30, a14
v_accvgpr_read_b32 v31, a15
M v[104:107], a[176:179], a[48:51], 0
v_cvt_pk_bf16_f32 v24, v24, v25
v_cvt_pk_bf16_f32 v25, v26, v27
M v[104:107], a[180:183], a[52:55], v[104:107]
v_cvt_pk_bf16_f32 v26, v28, v29
v_cvt_pk_bf16_f32 v27, v30, v31
M v[108:111], a[180:183], a[60:63], 0
M v[108:111], a[176:179], a[56:59], v[108:111]
s_waitcnt vmcnt(38) lgkmcnt(0)
s_barrier
ds_read_b128 a[160:163], v10 offset:16384
ds_read_b128 a[164:167], v11 offset:16384
M v[112:115], a[176:179], a[64:67], 0
s_add_u32 m0, s29, 0
s_nop 0
buffer_load_dwordx4 v2, s[8:11], s23 offen offset:0 lds
M v[112:115], a[180:183], a[68:71], v[112:115]
s_add_u32 s94, s93, 12288
buffer_store_dwordx4 v[24:27], v1, s[16:19], s94 offen offset:1024 sc1
M v[116:119], a[180:183], a[76:79], 0
s_add_u32 s94, s93, 4096
buffer_store_dwordx4 v[192:195], v1, s[16:19], s94 offen offset:0 sc1
M v[116:119], a[176:179], a[72:75], v[116:119]
ds_read_b64_tr_b16 a[100:101], v12 offset:49152
ds_read_b64_tr_b16 a[102:103], v12 offset:51200
M v[120:123], a[176:179], a[80:83], 0
M v[120:123], a[180:183], a[84:87], v[120:123]
M v[124:127], a[180:183], a[92:95], 0
buffer_load_dwordx4 v3, s[8:11], s23 offen offset:1024 lds
M v[124:127], a[176:179], a[88:91], v[124:127]
M v[128:131], a[184:187], a[32:35], 0
M v[128:131], a[188:191], a[36:39], v[128:131]
ds_read_b128 a[168:171], v10 offset:18432
ds_read_b128 a[172:175], v11 offset:18432
ds_read_b64_tr_b16 a[108:109], v13 offset:49152
ds_read_b64_tr_b16 a[110:111], v13 offset:51200
M v[132:135], a[188:191], a[44:47], 0
s_add_u32 s94, s93, 4096
buffer_store_dwordx4 v[200:203], v1, s[16:19], s94 offen offset:1024 sc1
M v[132:135], a[184:187], a[40:43], v[132:135]
M v[136:139], a[184:187], a[48:51], 0
buffer_load_dwordx4 v4, s[8:11], s23 offen offset:2048 lds
M v[136:139], a[188:191], a[52:55], v[136:139]
M v[140:143], a[188:191], a[60:63], 0
M v[140:143], a[184:187], a[56:59], v[140:143]
ds_read_b64_tr_b16 a[116:117], v14 offset:49152
ds_read_b64_tr_b16 a[118:119], v14 offset:51200
M v[144:147], a[184:187], a[64:67], 0
s_add_u32 s94, s93, 4096
buffer_store_dwordx4 v[208:211], v1, s[16:19], s94 offen offset:2048 sc1
M v[144:147], a[188:191], a[68:71], v[144:147]
M v[148:151], a[188:191], a[76:79], 0
buffer_load_dwordx4 v5, s[8:11], s23 offen offset:3072 lds
v_accvgpr_read_b32 v24, a16
v_accvgpr_read_b32 v25, a17
M v[148:151], a[184:187], a[72:75], v[148:151]
v_accvgpr_read_b32 v26, a18
v_accvgpr_read_b32 v27, a19
M v[152:155], a[184:187], a[80:83], 0
v_accvgpr_read_b32 v28, a20
v_accvgpr_read_b32 v29, a21
M v[152:155], a[188:191], a[84:87], v[152:155]
ds_read_b64_tr_b16 a[124:125], v15 offset:49152
ds_read_b64_tr_b16 a[126:127], v15 offset:51200
v_accvgpr_read_b32 v30, a22
v_accvgpr_read_b32 v31, a23
M v[156:159], a[188:191], a[92:95], 0
s_add_u32 m0, s29, 98304
s_nop 0
buffer_load_dwordx4 v6, s[12:15], s24 offen offset:0 lds
v_cvt_pk_bf16_f32 v24, v24, v25
v_cvt_pk_bf16_f32 v25, v26, v27
M v[156:159], a[184:187], a[88:91], v[156:159]
s_add_u32 s94, s93, 4096
buffer_store_dwordx4 v[216:219], v1, s[16:19], s94 offen offset:3072 sc1
s_waitcnt lgkmcnt(10)
v_cvt_pk_bf16_f32 v26, v28, v29
v_cvt_pk_bf16_f32 v27, v30, v31
M v[160:163], a[160:163], a[32:35], 0
M v[160:163], a[164:167], a[36:39], v[160:163]
ds_read_b128 a[176:179], v10 offset:20480
ds_read_b128 a[180:183], v11 offset:20480
M v[164:167], a[164:167], a[44:47], 0
M v[164:167], a[160:163], a[40:43], v[164:167]
ds_read_b64_tr_b16 a[132:133], v16 offset:49152
ds_read_b64_tr_b16 a[134:135], v16 offset:51200
M v[168:171], a[160:163], a[48:51], 0
s_add_u32 s94, s93, 12288
buffer_store_dwordx4 v[24:27], v1, s[16:19], s94 offen offset:2048 sc1
M v[168:171], a[164:167], a[52:55], v[168:171]
M v[172:175], a[164:167], a[60:63], 0
s_add_u32 s94, s93, 8192
buffer_store_dwordx4 v[224:227], v1, s[16:19], s94 offen offset:0 sc1
M v[172:175], a[160:163], a[56:59], v[172:175]
buffer_load_dwordx4 v7, s[12:15], s24 offen offset:1024 lds
M v[176:179], a[160:163], a[64:67], 0
M v[176:179], a[164:167], a[68:71], v[176:179]
ds_read_b64_tr_b16 a[140:141], v17 offset:49152
ds_read_b64_tr_b16 a[142:143], v17 offset:51200
M v[180:183], a[164:167], a[76:79], 0
M v[180:183], a[160:163], a[72:75], v[180:183]
buffer_load_dwordx4 v8, s[12:15], s24 offen offset:2048 lds
M v[184:187], a[160:163], a[80:83], 0
M v[184:187], a[164:167], a[84:87], v[184:187]
s_add_u32 s94, s93, 8192
buffer_store_dwordx4 v[232:235], v1, s[16:19], s94 offen offset:1024 sc1
M v[188:191], a[164:167], a[92:95], 0
M v[188:191], a[160:163], a[88:91], v[188:191]
s_waitcnt lgkmcnt(12)
ds_read_b64_tr_b16 a[148:149], v18 offset:49152
ds_read_b64_tr_b16 a[150:151], v18 offset:51200
M v[192:195], a[168:171], a[32:35], 0
M v[192:195], a[172:175], a[36:39], v[192:195]
ds_read_b128 a[184:187], v10 offset:22528
ds_read_b128 a[188:191], v11 offset:22528
M v[196:199], a[172:175], a[44:47], 0
buffer_load_dwordx4 v9, s[12:15], s24 offen offset:3072 lds
M v[196:199], a[168:171], a[40:43], v[196:199]
M v[200:203], a[168:171], a[48:51], 0
s_add_u32 s94, s93, 8192
buffer_store_dwordx4 v[240:243], v1, s[16:19], s94 offen offset:2048 sc1
v_accvgpr_read_b32 v24, a24
v_accvgpr_read_b32 v25, a25
M v[200:203], a[172:175], a[52:55], v[200:203]
ds_read_b64_tr_b16 a[156:157], v19 offset:49152
ds_read_b64_tr_b16 a[158:159], v19 offset:51200
v_accvgpr_read_b32 v26, a26
v_accvgpr_read_b32 v27, a27
M v[204:207], a[172:175], a[60:63], 0
v_accvgpr_read_b32 v28, a28
v_accvgpr_read_b32 v29, a29
M v[204:207], a[168:171], a[56:59], v[204:207]
s_add_u32 s24, s24, 262144
v_accvgpr_read_b32 v30, a30
v_accvgpr_read_b32 v31, a31
M v[208:211], a[168:171], a[64:67], 0
v_cvt_pk_bf16_f32 v24, v24, v25
v_cvt_pk_bf16_f32 v25, v26, v27
M v[208:211], a[172:175], a[68:71], v[208:211]
v_cvt_pk_bf16_f32 v26, v28, v29
v_cvt_pk_bf16_f32 v27, v30, v31
M v[212:215], a[172:175], a[76:79], 0
M v[212:215], a[168:171], a[72:75], v[212:215]
s_add_u32 s94, s93, 8192
buffer_store_dwordx4 v[248:251], v1, s[16:19], s94 offen offset:3072 sc1
M v[216:219], a[168:171], a[80:83], 0
buffer_load_dword v21, v20, s[60:63], s54 offen
s_add_u32 s54, s54, s55
M v[216:219], a[172:175], a[84:87], v[216:219]
s_add_u32 s94, s93, 12288
buffer_store_dwordx4 v[24:27], v1, s[16:19], s94 offen offset:3072 sc1
M v[220:223], a[172:175], a[92:95], 0
M v[220:223], a[168:171], a[88:91], v[220:223]
s_waitcnt lgkmcnt(10)
M v[224:227], a[176:179], a[32:35], 0
M v[224:227], a[180:183], a[36:39], v[224:227]
s_cmp_eq_u32 s54, s56
s_cselect_b32 s54, s57, s54
s_cselect_b64 s[60:61], s[58:59], s[60:61]
s_cselect_b32 s62, s7, s62
M v[228:231], a[180:183], a[44:47], 0
M v[228:231], a[176:179], a[40:43], v[228:231]
M v[232:235], a[176:179], a[48:51], 0
M v[232:235], a[180:183], a[52:55], v[232:235]
M v[236:239], a[180:183], a[60:63], 0
M v[236:239], a[176:179], a[56:59], v[236:239]
s_waitcnt vmcnt(43) lgkmcnt(0)
s_barrier
ds_read_b128 a[160:163], v10 offset:32768
ds_read_b128 a[164:167], v11 offset:32768
M v[240:243], a[176:179], a[64:67], 0
s_add_u32 m0, s29, 16384
s_add_u32 s3, s23, s31
buffer_load_dwordx4 v2, s[8:11], s3 offen offset:0 lds
M v[240:243], a[180:183], a[68:71], v[240:243]
M v[244:247], a[180:183], a[76:79], 0
M v[244:247], a[176:179], a[72:75], v[244:247]
M v[248:251], a[176:179], a[80:83], 0
M v[248:251], a[180:183], a[84:87], v[248:251]
buffer_load_dwordx4 v3, s[8:11], s3 offen offset:1024 lds
M v[252:255], a[180:183], a[92:95], 0
M v[252:255], a[176:179], a[88:91], v[252:255]
M a[0:3], a[184:187], a[32:35], 0
M a[0:3], a[188:191], a[36:39], a[0:3]
ds_read_b128 a[168:171], v10 offset:34816
ds_read_b128 a[172:175], v11 offset:34816
M a[4:7], a[188:191], a[44:47], 0
M a[4:7], a[184:187], a[40:43], a[4:7]
M a[8:11], a[184:187], a[48:51], 0
buffer_load_dwordx4 v4, s[8:11], s3 offen offset:2048 lds
M a[8:11], a[188:191], a[52:55], a[8:11]
M a[12:15], a[188:191], a[60:63], 0
M a[12:15], a[184:187], a[56:59], a[12:15]
M a[16:19], a[184:187], a[64:67], 0
M a[16:19], a[188:191], a[68:71], a[16:19]
buffer_load_dwordx4 v5, s[8:11], s3 offen offset:3072 lds
M a[20:23], a[188:191], a[76:79], 0
M a[20:23], a[184:187], a[72:75], a[20:23]
M a[24:27], a[184:187], a[80:83], 0
M a[24:27], a[188:191], a[84:87], a[24:27]
M a[28:31], a[188:191], a[92:95], 0
M a[28:31], a[184:187], a[88:91], a[28:31]
s_waitcnt lgkmcnt(2)
M v[32:35], a[160:163], a[96:99], v[32:35]
s_add_u32 s23, s23, 128
s_cmp_eq_u32 s23, s25
s_cselect_b32 s23, s26, s23
M v[32:35], a[164:167], a[100:103], v[32:35]
ds_read_b128 a[176:179], v10 offset:36864
ds_read_b128 a[180:183], v11 offset:36864
M v[36:39], a[164:167], a[108:111], v[36:39]
M v[36:39], a[160:163], a[104:107], v[36:39]
ds_read_b64_tr_b16 a[32:33], v12 offset:0
ds_read_b64_tr_b16 a[34:35], v12 offset:2048
M v[40:43], a[160:163], a[112:115], v[40:43]
M v[40:43], a[164:167], a[116:119], v[40:43]
M v[44:47], a[164:167], a[124:127], v[44:47]
s_add_u32 m0, s29, 114688
s_nop 0
buffer_load_dwordx4 v6, s[12:15], s24 offen offset:0 lds
M v[44:47], a[160:163], a[120:123], v[44:47]
ds_read_b64_tr_b16 a[40:41], v13 offset:0
ds_read_b64_tr_b16 a[42:43], v13 offset:2048
M v[48:51], a[160:163], a[128:131], v[48:51]
M v[48:51], a[164:167], a[132:135], v[48:51]
M v[52:55], a[164:167], a[140:143], v[52:55]
M v[52:55], a[160:163], a[136:139], v[52:55]
ds_read_b64_tr_b16 a[48:49], v14 offset:0
ds_read_b64_tr_b16 a[50:51], v14 offset:2048
M v[56:59], a[160:163], a[144:147], v[56:59]
M v[56:59], a[164:167], a[148:151], v[56:59]
buffer_load_dwordx4 v7, s[12:15], s24 offen offset:1024 lds
M v[60:63], a[164:167], a[156:159], v[60:63]
M v[60:63], a[160:163], a[152:155], v[60:63]
s_waitcnt lgkmcnt(8)
ds_read_b64_tr_b16 a[56:57], v15 offset:0
ds_read_b64_tr_b16 a[58:59], v15 offset:2048
M v[64:67], a[168:171], a[96:99], v[64:67]
M v[64:67], a[172:175], a[100:103], v[64:67]
ds_read_b128 a[184:187], v10 offset:38912
ds_read_b128 a[188:191], v11 offset:38912
M v[68:71], a[172:175], a[108:111], v[68:71]
M v[68:71], a[168:171], a[104:107], v[68:71]
ds_read_b64_tr_b16 a[64:65], v16 offset:0
ds_read_b64_tr_b16 a[66:67], v16 offset:2048
M v[72:75], a[168:171], a[112:115], v[72:75]
buffer_load_dwordx4 v8, s[12:15], s24 offen offset:2048 lds
M v[72:75], a[172:175], a[116:119], v[72:75]
M v[76:79], a[172:175], a[124:127], v[76:79]
M v[76:79], a[168:171], a[120:123], v[76:79]
ds_read_b64_tr_b16 a[72:73], v17 offset:0
ds_read_b64_tr_b16 a[74:75], v17 offset:2048
M v[80:83], a[168:171], a[128:131], v[80:83]
M v[80:83], a[172:175], a[132:135], v[80:83]
M v[84:87], a[172:175], a[140:143], v[84:87]
buffer_load_dwordx4 v9, s[12:15], s24 offen offset:3072 lds
M v[84:87], a[168:171], a[136:139], v[84:87]
ds_read_b64_tr_b16 a[80:81], v18 offset:0
ds_read_b64_tr_b16 a[82:83], v18 offset:2048
M v[88:91], a[168:171], a[144:147], v[88:91]
M v[88:91], a[172:175], a[148:151], v[88:91]
M v[92:95], a[172:175], a[156:159], v[92:95]
M v[92:95], a[168:171], a[152:155], v[92:95]
s_waitcnt lgkmcnt(15)
ds_read_b64_tr_b16 a[88:89], v19 offset:0
ds_read_b64_tr_b16 a[90:91], v19 offset:2048
M v[96:99], a[176:179], a[96:99], v[96:99]
s_add_u32 s24, s24, 262144
s_cmp_eq_u32 s24, s27
s_cselect_b32 s24, s28, s24
s_sub_u32 s6, s6, 1
s_cmp_eq_u32 s6, 0
s_cselect_b64 s[12:13], s[64:65], s[12:13]
M v[96:99], a[180:183], a[100:103], v[96:99]
M v[100:103], a[180:183], a[108:111], v[100:103]
M v[100:103], a[176:179], a[104:107], v[100:103]
M v[104:107], a[176:179], a[112:115], v[104:107]
M v[104:107], a[180:183], a[116:119], v[104:107]
M v[108:111], a[180:183], a[124:127], v[108:111]
M v[108:111], a[176:179], a[120:123], v[108:111]
s_waitcnt vmcnt(30) lgkmcnt(0)
s_barrier
ds_read_b128 a[160:163], v10 offset:49152
ds_read_b128 a[164:167], v11 offset:49152
M v[112:115], a[176:179], a[128:131], v[112:115]
s_add_u32 m0, s29, 32768
s_nop 0
buffer_load_dwordx4 v2, s[8:11], s23 offen offset:0 lds
M v[112:115], a[180:183], a[132:135], v[112:115]
M v[116:119], a[180:183], a[140:143], v[116:119]
M v[116:119], a[176:179], a[136:139], v[116:119]
ds_read_b64_tr_b16 a[36:37], v12 offset:16384
ds_read_b64_tr_b16 a[38:39], v12 offset:18432
M v[120:123], a[176:179], a[144:147], v[120:123]
M v[120:123], a[180:183], a[148:151], v[120:123]
buffer_load_dwordx4 v3, s[8:11], s23 offen offset:1024 lds
M v[124:127], a[180:183], a[156:159], v[124:127]
M v[124:127], a[176:179], a[152:155], v[124:127]
M v[128:131], a[184:187], a[96:99], v[128:131]
M v[128:131], a[188:191], a[100:103], v[128:131]
ds_read_b128 a[168:171], v10 offset:51200
ds_read_b128 a[172:175], v11 offset:51200
ds_read_b64_tr_b16 a[44:45], v13 offset:16384
ds_read_b64_tr_b16 a[46:47], v13 offset:18432
M v[132:135], a[188:191], a[108:111], v[132:135]
M v[132:135], a[184:187], a[104:107], v[132:135]
buffer_load_dwordx4 v4, s[8:11], s23 offen offset:2048 lds
M v[136:139], a[184:187], a[112:115], v[136:139]
M v[136:139], a[188:191], a[116:119], v[136:139]
M v[140:143], a[188:191], a[124:127], v[140:143]
M v[140:143], a[184:187], a[120:123], v[140:143]
ds_read_b64_tr_b16 a[52:53], v14 offset:16384
ds_read_b64_tr_b16 a[54:55], v14 offset:18432
M v[144:147], a[184:187], a[128:131], v[144:147]
M v[144:147], a[188:191], a[132:135], v[144:147]
buffer_load_dwordx4 v5, s[8:11], s23 offen offset:3072 lds
M v[148:151], a[188:191], a[140:143], v[148:151]
M v[148:151], a[184:187], a[136:139], v[148:151]
M v[152:155], a[184:187], a[144:147], v[152:155]
M v[152:155], a[188:191], a[148:151], v[152:155]
ds_read_b64_tr_b16 a[60:61], v15 offset:16384
ds_read_b64_tr_b16 a[62:63], v15 offset:18432
M v[156:159], a[188:191], a[156:159], v[156:159]
s_add_u32 m0, s29, 65536
s_nop 0
buffer_load_dwordx4 v6, s[12:15], s24 offen offset:0 lds
M v[156:159], a[184:187], a[152:155], v[156:159]
s_waitcnt lgkmcnt(10)
M v[160:163], a[160:163], a[96:99], v[160:163]
M v[160:163], a[164:167], a[100:103], v[160:163]
ds_read_b128 a[176:179], v10 offset:53248
ds_read_b128 a[180:183], v11 offset:53248
M v[164:167], a[164:167], a[108:111], v[164:167]
M v[164:167], a[160:163], a[104:107], v[164:167]
ds_read_b64_tr_b16 a[68:69], v16 offset:16384
ds_read_b64_tr_b16 a[70:71], v16 offset:18432
M v[168:171], a[160:163], a[112:115], v[168:171]
M v[168:171], a[164:167], a[116:119], v[168:171]
buffer_load_dwordx4 v7, s[12:15], s24 offen offset:1024 lds
M v[172:175], a[164:167], a[124:127], v[172:175]
M v[172:175], a[160:163], a[120:123], v[172:175]
M v[176:179], a[160:163], a[128:131], v[176:179]
M v[176:179], a[164:167], a[132:135], v[176:179]
ds_read_b64_tr_b16 a[76:77], v17 offset:16384
ds_read_b64_tr_b16 a[78:79], v17 offset:18432
M v[180:183], a[164:167], a[140:143], v[180:183]
M v[180:183], a[160:163], a[136:139], v[180:183]
buffer_load_dwordx4 v8, s[12:15], s24 offen offset:2048 lds
M v[184:187], a[160:163], a[144:147], v[184:187]
M v[184:187], a[164:167], a[148:151], v[184:187]
M v[188:191], a[164:167], a[156:159], v[188:191]
M v[188:191], a[160:163], a[152:155], v[188:191]
s_waitcnt lgkmcnt(12)
ds_read_b64_tr_b16 a[84:85], v18 offset:16384
ds_read_b64_tr_b16 a[86:87], v18 offset:18432
M v[192:195], a[168:171], a[96:99], v[192:195]
buffer_load_dwordx4 v9, s[12:15], s24 offen offset:3072 lds
M v[192:195], a[172:175], a[100:103], v[192:195]
ds_read_b128 a[184:187], v10 offset:55296
ds_read_b128 a[188:191], v11 offset:55296
M v[196:199], a[172:175], a[108:111], v[196:199]
M v[196:199], a[168:171], a[104:107], v[196:199]
M v[200:203], a[168:171], a[112:115], v[200:203]
M v[200:203], a[172:175], a[116:119], v[200:203]
ds_read_b64_tr_b16 a[92:93], v19 offset:16384
ds_read_b64_tr_b16 a[94:95], v19 offset:18432
M v[204:207], a[172:175], a[124:127], v[204:207]
s_add_u32 s24, s24, 262144
M v[204:207], a[168:171], a[120:123], v[204:207]
M v[208:211], a[168:171], a[128:131], v[208:211]
M v[208:211], a[172:175], a[132:135], v[208:211]
M v[212:215], a[172:175], a[140:143], v[212:215]
M v[212:215], a[168:171], a[136:139], v[212:215]
buffer_load_dword v21, v20, s[60:63], s54 offen
s_add_u32 s54, s54, s55
M v[216:219], a[168:171], a[144:147], v[216:219]
M v[216:219], a[172:175], a[148:151], v[216:219]
M v[220:223], a[172:175], a[156:159], v[220:223]
M v[220:223], a[168:171], a[152:155], v[220:223]
s_waitcnt lgkmcnt(10)
M v[224:227], a[176:179], a[96:99], v[224:227]
s_cmp_eq_u32 s54, s56
s_cselect_b32 s54, s57, s54
s_cselect_b64 s[60:61], s[58:59], s[60:61]
s_cselect_b32 s62, s7, s62
M v[224:227], a[180:183], a[100:103], v[224:227]
M v[228:231], a[180:183], a[108:111], v[228:231]
M v[228:231], a[176:179], a[104:107], v[228:231]
M v[232:235], a[176:179], a[112:115], v[232:235]
M v[232:235], a[180:183], a[116:119], v[232:235]
M v[236:239], a[180:183], a[124:127], v[236:239]
M v[236:239], a[176:179], a[120:123], v[236:239]
s_waitcnt vmcnt(21) lgkmcnt(0)
s_barrier
ds_read_b128 a[160:163], v10 offset:0
ds_read_b128 a[164:167], v11 offset:0
M v[240:243], a[176:179], a[128:131], v[240:243]
s_add_u32 m0, s29, 49152
s_add_u32 s3, s23, s31
buffer_load_dwordx4 v2, s[8:11], s3 offen offset:0 lds
M v[240:243], a[180:183], a[132:135], v[240:243]
M v[244:247], a[180:183], a[140:143], v[244:247]
M v[244:247], a[176:179], a[136:139], v[244:247]
M v[248:251], a[176:179], a[144:147], v[248:251]
M v[248:251], a[180:183], a[148:151], v[248:251]
buffer_load_dwordx4 v3, s[8:11], s3 offen offset:1024 lds
M v[252:255], a[180:183], a[156:159], v[252:255]
M v[252:255], a[176:179], a[152:155], v[252:255]
M a[0:3], a[184:187], a[96:99], a[0:3]
M a[0:3], a[188:191], a[100:103], a[0:3]
ds_read_b128 a[168:171], v10 offset:2048
ds_read_b128 a[172:175], v11 offset:2048
M a[4:7], a[188:191], a[108:111], a[4:7]
M a[4:7], a[184:187], a[104:107], a[4:7]
M a[8:11], a[184:187], a[112:115], a[8:11]
buffer_load_dwordx4 v4, s[8:11], s3 offen offset:2048 lds
M a[8:11], a[188:191], a[116:119], a[8:11]
M a[12:15], a[188:191], a[124:127], a[12:15]
M a[12:15], a[184:187], a[120:123], a[12:15]
M a[16:19], a[184:187], a[128:131], a[16:19]
M a[16:19], a[188:191], a[132:135], a[16:19]
buffer_load_dwordx4 v5, s[8:11], s3 offen offset:3072 lds
M a[20:23], a[188:191], a[140:143], a[20:23]
M a[20:23], a[184:187], a[136:139], a[20:23]
M a[24:27], a[184:187], a[144:147], a[24:27]
M a[24:27], a[188:191], a[148:151], a[24:27]
M a[28:31], a[188:191], a[156:159], a[28:31]
M a[28:31], a[184:187], a[152:155], a[28:31]
s_waitcnt lgkmcnt(2)
M v[32:35], a[160:163], a[32:35], v[32:35]
s_add_u32 s23, s23, 128
s_cmp_eq_u32 s23, s25
s_cselect_b32 s23, s26, s23
M v[32:35], a[164:167], a[36:39], v[32:35]
ds_read_b128 a[176:179], v10 offset:4096
ds_read_b128 a[180:183], v11 offset:4096
M v[36:39], a[164:167], a[44:47], v[36:39]
M v[36:39], a[160:163], a[40:43], v[36:39]
ds_read_b64_tr_b16 a[96:97], v12 offset:32768
ds_read_b64_tr_b16 a[98:99], v12 offset:34816
M v[40:43], a[160:163], a[48:51], v[40:43]
M v[40:43], a[164:167], a[52:55], v[40:43]
M v[44:47], a[164:167], a[60:63], v[44:47]
s_add_u32 m0, s29, 81920
s_nop 0
buffer_load_dwordx4 v6, s[12:15], s24 offen offset:0 lds
M v[44:47], a[160:163], a[56:59], v[44:47]
ds_read_b64_tr_b16 a[104:105], v13 offset:32768
ds_read_b64_tr_b16 a[106:107], v13 offset:34816
M v[48:51], a[160:163], a[64:67], v[48:51]
M v[48:51], a[164:167], a[68:71], v[48:51]
M v[52:55], a[164:167], a[76:79], v[52:55]
M v[52:55], a[160:163], a[72:75], v[52:55]
ds_read_b64_tr_b16 a[112:113], v14 offset:32768
ds_read_b64_tr_b16 a[114:115], v14 offset:34816
M v[56:59], a[160:163], a[80:83], v[56:59]
M v[56:59], a[164:167], a[84:87], v[56:59]
buffer_load_dwordx4 v7, s[12:15], s24 offen offset:1024 lds
M v[60:63], a[164:167], a[92:95], v[60:63]
M v[60:63], a[160:163], a[88:91], v[60:63]
s_waitcnt lgkmcnt(8)
ds_read_b64_tr_b16 a[120:121], v15 offset:32768
ds_read_b64_tr_b16 a[122:123], v15 offset:34816
M v[64:67], a[168:171], a[32:35], v[64:67]
M v[64:67], a[172:175], a[36:39], v[64:67]
ds_read_b128 a[184:187], v10 offset:6144
ds_read_b128 a[188:191], v11 offset:6144
M v[68:71], a[172:175], a[44:47], v[68:71]
M v[68:71], a[168:171], a[40:43], v[68:71]
ds_read_b64_tr_b16 a[128:129], v16 offset:32768
ds_read_b64_tr_b16 a[130:131], v16 offset:34816
M v[72:75], a[168:171], a[48:51], v[72:75]
buffer_load_dwordx4 v8, s[12:15], s24 offen offset:2048 lds
M v[72:75], a[172:175], a[52:55], v[72:75]
M v[76:79], a[172:175], a[60:63], v[76:79]
M v[76:79], a[168:171], a[56:59], v[76:79]
ds_read_b64_tr_b16 a[136:137], v17 offset:32768
ds_read_b64_tr_b16 a[138:139], v17 offset:34816
M v[80:83], a[168:171], a[64:67], v[80:83]
M v[80:83], a[172:175], a[68:71], v[80:83]
M v[84:87], a[172:175], a[76:79], v[84:87]
buffer_load_dwordx4 v9, s[12:15], s24 offen offset:3072 lds
M v[84:87], a[168:171], a[72:75], v[84:87]
ds_read_b64_tr_b16 a[144:145], v18 offset:32768
ds_read_b64_tr_b16 a[146:147], v18 offset:34816
M v[88:91], a[168:171], a[80:83], v[88:91]
M v[88:91], a[172:175], a[84:87], v[88:91]
M v[92:95], a[172:175], a[92:95], v[92:95]
M v[92:95], a[168:171], a[88:91], v[92:95]
s_waitcnt lgkmcnt(15)
ds_read_b64_tr_b16 a[152:153], v19 offset:32768
ds_read_b64_tr_b16 a[154:155], v19 offset:34816
M v[96:99], a[176:179], a[32:35], v[96:99]
s_add_u32 s24, s24, 262144
s_cmp_eq_u32 s24, s27
s_cselect_b32 s24, s28, s24
s_sub_u32 s6, s6, 1
s_cmp_eq_u32 s6, 0
s_cselect_b64 s[12:13], s[64:65], s[12:13]
M v[96:99], a[180:183], a[36:39], v[96:99]
M v[100:103], a[180:183], a[44:47], v[100:103]
M v[100:103], a[176:179], a[40:43], v[100:103]
M v[104:107], a[176:179], a[48:51], v[104:107]
M v[104:107], a[180:183], a[52:55], v[104:107]
M v[108:111], a[180:183], a[60:63], v[108:111]
M v[108:111], a[176:179], a[56:59], v[108:111]
s_waitcnt vmcnt(17) lgkmcnt(0)
s_barrier
ds_read_b128 a[160:163], v10 offset:16384
ds_read_b128 a[164:167], v11 offset:16384
M v[112:115], a[176:179], a[64:67], v[112:115]
s_add_u32 m0, s29, 0
s_nop 0
buffer_load_dwordx4 v2, s[8:11], s23 offen offset:0 lds
M v[112:115], a[180:183], a[68:71], v[112:115]
M v[116:119], a[180:183], a[76:79], v[116:119]
M v[116:119], a[176:179], a[72:75], v[116:119]
ds_read_b64_tr_b16 a[100:101], v12 offset:49152
ds_read_b64_tr_b16 a[102:103], v12 offset:51200
M v[120:123], a[176:179], a[80:83], v[120:123]
M v[120:123], a[180:183], a[84:87], v[120:123]
buffer_load_dwordx4 v3, s[8:11], s23 offen offset:1024 lds
M v[124:127], a[180:183], a[92:95], v[124:127]
M v[124:127], a[176:179], a[88:91], v[124:127]
M v[128:131], a[184:187], a[32:35], v[128:131]
M v[128:131], a[188:191], a[36:39], v[128:131]
ds_read_b128 a[168:171], v10 offset:18432
ds_read_b128 a[172:175], v11 offset:18432
ds_read_b64_tr_b16 a[108:109], v13 offset:49152
ds_read_b64_tr_b16 a[110:111], v13 offset:51200
M v[132:135], a[188:191], a[44:47], v[132:135]
M v[132:135], a[184:187], a[40:43], v[132:135]
buffer_load_dwordx4 v4, s[8:11], s23 offen offset:2048 lds
M v[136:139], a[184:187], a[48:51], v[136:139]
M v[136:139], a[188:191], a[52:55], v[136:139]
M v[140:143], a[188:191], a[60:63], v[140:143]
M v[140:143], a[184:187], a[56:59], v[140:143]
ds_read_b64_tr_b16 a[116:117], v14 offset:49152
ds_read_b64_tr_b16 a[118:119], v14 offset:51200
M v[144:147], a[184:187], a[64:67], v[144:147]
M v[144:147], a[188:191], a[68:71], v[144:147]
buffer_load_dwordx4 v5, s[8:11], s23 offen offset:3072 lds
M v[148:151], a[188:191], a[76:79], v[148:151]
M v[148:151], a[184:187], a[72:75], v[148:151]
M v[152:155], a[184:187], a[80:83], v[152:155]
M v[152:155], a[188:191], a[84:87], v[152:155]
ds_read_b64_tr_b16 a[124:125], v15 offset:49152
ds_read_b64_tr_b16 a[126:127], v15 offset:51200
M v[156:159], a[188:191], a[92:95], v[156:159]
s_add_u32 m0, s29, 98304
s_nop 0
buffer_load_dwordx4 v6, s[12:15], s24 offen offset:0 lds
M v[156:159], a[184:187], a[88:91], v[156:159]
s_waitcnt lgkmcnt(10)
M v[160:163], a[160:163], a[32:35], v[160:163]
M v[160:163], a[164:167], a[36:39], v[160:163]
ds_read_b128 a[176:179], v10 offset:20480
ds_read_b128 a[180:183], v11 offset:20480
M v[164:167], a[164:167], a[44:47], v[164:167]
M v[164:167], a[160:163], a[40:43], v[164:167]
ds_read_b64_tr_b16 a[132:133], v16 offset:49152
ds_read_b64_tr_b16 a[134:135], v16 offset:51200
M v[168:171], a[160:163], a[48:51], v[168:171]
M v[168:171], a[164:167], a[52:55], v[168:171]
buffer_load_dwordx4 v7, s[12:15], s24 offen offset:1024 lds
M v[172:175], a[164:167], a[60:63], v[172:175]
M v[172:175], a[160:163], a[56:59], v[172:175]
M v[176:179], a[160:163], a[64:67], v[176:179]
M v[176:179], a[164:167], a[68:71], v[176:179]
ds_read_b64_tr_b16 a[140:141], v17 offset:49152
ds_read_b64_tr_b16 a[142:143], v17 offset:51200
M v[180:183], a[164:167], a[76:79], v[180:183]
M v[180:183], a[160:163], a[72:75], v[180:183]
buffer_load_dwordx4 v8, s[12:15], s24 offen offset:2048 lds
M v[184:187], a[160:163], a[80:83], v[184:187]
M v[184:187], a[164:167], a[84:87], v[184:187]
M v[188:191], a[164:167], a[92:95], v[188:191]
M v[188:191], a[160:163], a[88:91], v[188:191]
s_waitcnt lgkmcnt(12)
ds_read_b64_tr_b16 a[148:149], v18 offset:49152
ds_read_b64_tr_b16 a[150:151], v18 offset:51200
M v[192:195], a[168:171], a[32:35], v[192:195]
buffer_load_dwordx4 v9, s[12:15], s24 offen offset:3072 lds
M v[192:195], a[172:175], a[36:39], v[192:195]
ds_read_b128 a[184:187], v10 offset:22528
ds_read_b128 a[188:191], v11 offset:22528
M v[196:199], a[172:175], a[44:47], v[196:199]
M v[196:199], a[168:171], a[40:43], v[196:199]
M v[200:203], a[168:171], a[48:51], v[200:203]
M v[200:203], a[172:175], a[52:55], v[200:203]
ds_read_b64_tr_b16 a[156:157], v19 offset:49152
ds_read_b64_tr_b16 a[158:159], v19 offset:51200
M v[204:207], a[172:175], a[60:63], v[204:207]
s_add_u32 s24, s24, 262144
M v[204:207], a[168:171], a[56:59], v[204:207]
M v[208:211], a[168:171], a[64:67], v[208:211]
M v[208:211], a[172:175], a[68:71], v[208:211]
M v[212:215], a[172:175], a[76:79], v[212:215]
M v[212:215], a[168:171], a[72:75], v[212:215]
buffer_load_dword v21, v20, s[60:63], s54 offen
s_add_u32 s54, s54, s55
M v[216:219], a[168:171], a[80:83], v[216:219]
M v[216:219], a[172:175], a[84:87], v[216:219]
M v[220:223], a[172:175], a[92:95], v[220:223]
M v[220:223], a[168:171], a[88:91], v[220:223]
s_waitcnt lgkmcnt(10)
M v[224:227], a[176:179], a[32:35], v[224:227]
s_cmp_eq_u32 s54, s56
s_cselect_b32 s54, s57, s54
s_cselect_b64 s[60:61], s[58:59], s[60:61]
s_cselect_b32 s62, s7, s62
M v[224:227], a[180:183], a[36:39], v[224:227]
M v[228:231], a[180:183], a[44:47], v[228:231]
M v[228:231], a[176:179], a[40:43], v[228:231]
M v[232:235], a[176:179], a[48:51], v[232:235]
M v[232:235], a[180:183], a[52:55], v[232:235]
M v[236:239], a[180:183], a[60:63], v[236:239]
M v[236:239], a[176:179], a[56:59], v[236:239]
s_waitcnt vmcnt(18) lgkmcnt(0)
s_barrier
ds_read_b128 a[160:163], v10 offset:32768
ds_read_b128 a[164:167], v11 offset:32768
M v[240:243], a[176:179], a[64:67], v[240:243]
s_add_u32 m0, s29, 16384
s_add_u32 s3, s23, s31
buffer_load_dwordx4 v2, s[8:11], s3 offen offset:0 lds
M v[240:243], a[180:183], a[68:71], v[240:243]
M v[244:247], a[180:183], a[76:79], v[244:247]
M v[244:247], a[176:179], a[72:75], v[244:247]
M v[248:251], a[176:179], a[80:83], v[248:251]
M v[248:251], a[180:183], a[84:87], v[248:251]
buffer_load_dwordx4 v3, s[8:11], s3 offen offset:1024 lds
M v[252:255], a[180:183], a[92:95], v[252:255]
M v[252:255], a[176:179], a[88:91], v[252:255]
M a[0:3], a[184:187], a[32:35], a[0:3]
M a[0:3], a[188:191], a[36:39], a[0:3]
ds_read_b128 a[168:171], v10 offset:34816
ds_read_b128 a[172:175], v11 offset:34816
M a[4:7], a[188:191], a[44:47], a[4:7]
M a[4:7], a[184:187], a[40:43], a[4:7]
M a[8:11], a[184:187], a[48:51], a[8:11]
buffer_load_dwordx4 v4, s[8:11], s3 offen offset:2048 lds
M a[8:11], a[188:191], a[52:55], a[8:11]
M a[12:15], a[188:191], a[60:63], a[12:15]
M a[12:15], a[184:187], a[56:59], a[12:15]
M a[16:19], a[184:187], a[64:67], a[16:19]
M a[16:19], a[188:191], a[68:71], a[16:19]
buffer_load_dwordx4 v5, s[8:11], s3 offen offset:3072 lds
M a[20:23], a[188:191], a[76:79], a[20:23]
M a[20:23], a[184:187], a[72:75], a[20:23]
M a[24:27], a[184:187], a[80:83], a[24:27]
M a[24:27], a[188:191], a[84:87], a[24:27]
M a[28:31], a[188:191], a[92:95], a[28:31]
M a[28:31], a[184:187], a[88:91], a[28:31]
s_waitcnt lgkmcnt(2)
M v[32:35], a[160:163], a[96:99], v[32:35]
s_add_u32 s23, s23, 128
s_cmp_eq_u32 s23, s25
s_cselect_b32 s23, s26, s23
M v[32:35], a[164:167], a[100:103], v[32:35]
ds_read_b128 a[176:179], v10 offset:36864
ds_read_b128 a[180:183], v11 offset:36864
M v[36:39], a[164:167], a[108:111], v[36:39]
M v[36:39], a[160:163], a[104:107], v[36:39]
ds_read_b64_tr_b16 a[32:33], v12 offset:0
ds_read_b64_tr_b16 a[34:35], v12 offset:2048
M v[40:43], a[160:163], a[112:115], v[40:43]
M v[40:43], a[164:167], a[116:119], v[40:43]
M v[44:47], a[164:167], a[124:127], v[44:47]
s_add_u32 m0, s29, 114688
s_nop 0
buffer_load_dwordx4 v6, s[12:15], s24 offen offset:0 lds
M v[44:47], a[160:163], a[120:123], v[44:47]
ds_read_b64_tr_b16 a[40:41], v13 offset:0
ds_read_b64_tr_b16 a[42:43], v13 offset:2048
M v[48:51], a[160:163], a[128:131], v[48:51]
M v[48:51], a[164:167], a[132:135], v[48:51]
M v[52:55], a[164:167], a[140:143], v[52:55]
M v[52:55], a[160:163], a[136:139], v[52:55]
ds_read_b64_tr_b16 a[48:49], v14 offset:0
ds_read_b64_tr_b16 a[50:51], v14 offset:2048
M v[56:59], a[160:163], a[144:147], v[56:59]
M v[56:59], a[164:167], a[148:151], v[56:59]
buffer_load_dwordx4 v7, s[12:15], s24 offen offset:1024 lds
M v[60:63], a[164:167], a[156:159], v[60:63]
M v[60:63], a[160:163], a[152:155], v[60:63]
s_waitcnt lgkmcnt(8)
ds_read_b64_tr_b16 a[56:57], v15 offset:0
ds_read_b64_tr_b16 a[58:59], v15 offset:2048
M v[64:67], a[168:171], a[96:99], v[64:67]
M v[64:67], a[172:175], a[100:103], v[64:67]
ds_read_b128 a[184:187], v10 offset:38912
ds_read_b128 a[188:191], v11 offset:38912
M v[68:71], a[172:175], a[108:111], v[68:71]
M v[68:71], a[168:171], a[104:107], v[68:71]
ds_read_b64_tr_b16 a[64:65], v16 offset:0
ds_read_b64_tr_b16 a[66:67], v16 offset:2048
M v[72:75], a[168:171], a[112:115], v[72:75]
buffer_load_dwordx4 v8, s[12:15], s24 offen offset:2048 lds
M v[72:75], a[172:175], a[116:119], v[72:75]
M v[76:79], a[172:175], a[124:127], v[76:79]
M v[76:79], a[168:171], a[120:123], v[76:79]
ds_read_b64_tr_b16 a[72:73], v17 offset:0
ds_read_b64_tr_b16 a[74:75], v17 offset:2048
M v[80:83], a[168:171], a[128:131], v[80:83]
M v[80:83], a[172:175], a[132:135], v[80:83]
M v[84:87], a[172:175], a[140:143], v[84:87]
buffer_load_dwordx4 v9, s[12:15], s24 offen offset:3072 lds
M v[84:87], a[168:171], a[136:139], v[84:87]
ds_read_b64_tr_b16 a[80:81], v18 offset:0
ds_read_b64_tr_b16 a[82:83], v18 offset:2048
M v[88:91], a[168:171], a[144:147], v[88:91]
M v[88:91], a[172:175], a[148:151], v[88:91]
M v[92:95], a[172:175], a[156:159], v[92:95]
M v[92:95], a[168:171], a[152:155], v[92:95]
s_waitcnt lgkmcnt(15)
ds_read_b64_tr_b16 a[88:89], v19 offset:0
ds_read_b64_tr_b16 a[90:91], v19 offset:2048
M v[96:99], a[176:179], a[96:99], v[96:99]
s_add_u32 s24, s24, 262144
s_cmp_eq_u32 s24, s27
s_cselect_b32 s24, s28, s24
s_sub_u32 s6, s6, 1
s_cmp_eq_u32 s6, 0
s_cselect_b64 s[12:13], s[64:65], s[12:13]
M v[96:99], a[180:183], a[100:103], v[96:99]
M v[100:103], a[180:183], a[108:111], v[100:103]
M v[100:103], a[176:179], a[104:107], v[100:103]
M v[104:107], a[176:179], a[112:115], v[104:107]
M v[104:107], a[180:183], a[116:119], v[104:107]
M v[108:111], a[180:183], a[124:127], v[108:111]
M v[108:111], a[176:179], a[120:123], v[108:111]
s_waitcnt vmcnt(17) lgkmcnt(0)
s_barrier
ds_read_b128 a[160:163], v10 offset:49152
ds_read_b128 a[164:167], v11 offset:49152
M v[112:115], a[176:179], a[128:131], v[112:115]
s_add_u32 m0, s29, 32768
s_nop 0
buffer_load_dwordx4 v2, s[8:11], s23 offen offset:0 lds
M v[112:115], a[180:183], a[132:135], v[112:115]
M v[116:119], a[180:183], a[140:143], v[116:119]
M v[116:119], a[176:179], a[136:139], v[116:119]
ds_read_b64_tr_b16 a[36:37], v12 offset:16384
ds_read_b64_tr_b16 a[38:39], v12 offset:18432
M v[120:123], a[176:179], a[144:147], v[120:123]
M v[120:123], a[180:183], a[148:151], v[120:123]
buffer_load_dwordx4 v3, s[8:11], s23 offen offset:1024 lds
M v[124:127], a[180:183], a[156:159], v[124:127]
M v[124:127], a[176:179], a[152:155], v[124:127]
M v[128:131], a[184:187], a[96:99], v[128:131]
M v[128:131], a[188:191], a[100:103], v[128:131]
ds_read_b128 a[168:171], v10 offset:51200
ds_read_b128 a[172:175], v11 offset:51200
ds_read_b64_tr_b16 a[44:45], v13 offset:16384
ds_read_b64_tr_b16 a[46:47], v13 offset:18432
M v[132:135], a[188:191], a[108:111], v[132:135]
M v[132:135], a[184:187], a[104:107], v[132:135]
buffer_load_dwordx4 v4, s[8:11], s23 offen offset:2048 lds
M v[136:139], a[184:187], a[112:115], v[136:139]
M v[136:139], a[188:191], a[116:119], v[136:139]
M v[140:143], a[188:191], a[124:127], v[140:143]
M v[140:143], a[184:187], a[120:123], v[140:143]
ds_read_b64_tr_b16 a[52:53], v14 offset:16384
ds_read_b64_tr_b16 a[54:55], v14 offset:18432
M v[144:147], a[184:187], a[128:131], v[144:147]
M v[144:147], a[188:191], a[132:135], v[144:147]
buffer_load_dwordx4 v5, s[8:11], s23 offen offset:3072 lds
M v[148:151], a[188:191], a[140:143], v[148:151]
M v[148:151], a[184:187], a[136:139], v[148:151]
M v[152:155], a[184:187], a[144:147], v[152:155]
M v[152:155], a[188:191], a[148:151], v[152:155]
ds_read_b64_tr_b16 a[60:61], v15 offset:16384
ds_read_b64_tr_b16 a[62:63], v15 offset:18432
M v[156:159], a[188:191], a[156:159], v[156:159]
s_add_u32 m0, s29, 65536
s_nop 0
buffer_load_dwordx4 v6, s[12:15], s24 offen offset:0 lds
M v[156:159], a[184:187], a[152:155], v[156:159]
s_waitcnt lgkmcnt(10)
M v[160:163], a[160:163], a[96:99], v[160:163]
M v[160:163], a[164:167], a[100:103], v[160:163]
ds_read_b128 a[176:179], v10 offset:53248
ds_read_b128 a[180:183], v11 offset:53248
M v[164:167], a[164:167], a[108:111], v[164:167]
M v[164:167], a[160:163], a[104:107], v[164:167]
ds_read_b64_tr_b16 a[68:69], v16 offset:16384
ds_read_b64_tr_b16 a[70:71], v16 offset:18432
M v[168:171], a[160:163], a[112:115], v[168:171]
M v[168:171], a[164:167], a[116:119], v[168:171]
buffer_load_dwordx4 v7, s[12:15], s24 offen offset:1024 lds
M v[172:175], a[164:167], a[124:127], v[172:175]
M v[172:175], a[160:163], a[120:123], v[172:175]
M v[176:179], a[160:163], a[128:131], v[176:179]
M v[176:179], a[164:167], a[132:135], v[176:179]
ds_read_b64_tr_b16 a[76:77], v17 offset:16384
ds_read_b64_tr_b16 a[78:79], v17 offset:18432
M v[180:183], a[164:167], a[140:143], v[180:183]
M v[180:183], a[160:163], a[136:139], v[180:183]
buffer_load_dwordx4 v8, s[12:15], s24 offen offset:2048 lds
M v[184:187], a[160:163], a[144:147], v[184:187]
M v[184:187], a[164:167], a[148:151], v[184:187]
M v[188:191], a[164:167], a[156:159], v[188:191]
M v[188:191], a[160:163], a[152:155], v[188:191]
s_waitcnt lgkmcnt(12)
ds_read_b64_tr_b16 a[84:85], v18 offset:16384
ds_read_b64_tr_b16 a[86:87], v18 offset:18432
M v[192:195], a[168:171], a[96:99], v[192:195]
buffer_load_dwordx4 v9, s[12:15], s24 offen offset:3072 lds
M v[192:195], a[172:175], a[100:103], v[192:195]
ds_read_b128 a[184:187], v10 offset:55296
ds_read_b128 a[188:191], v11 offset:55296
M v[196:199], a[172:175], a[108:111], v[196:199]
M v[196:199], a[168:171], a[104:107], v[196:199]
M v[200:203], a[168:171], a[112:115], v[200:203]
M v[200:203], a[172:175], a[116:119], v[200:203]
ds_read_b64_tr_b16 a[92:93], v19 offset:16384
ds_read_b64_tr_b16 a[94:95], v19 offset:18432
M v[204:207], a[172:175], a[124:127], v[204:207]
s_add_u32 s24, s24, 262144
M v[204:207], a[168:171], a[120:123], v[204:207]
M v[208:211], a[168:171], a[128:131], v[208:211]
M v[208:211], a[172:175], a[132:135], v[208:211]
M v[212:215], a[172:175], a[140:143], v[212:215]
M v[212:215], a[168:171], a[136:139], v[212:215]
buffer_load_dword v21, v20, s[60:63], s54 offen
s_add_u32 s54, s54, s55
M v[216:219], a[168:171], a[144:147], v[216:219]
M v[216:219], a[172:175], a[148:151], v[216:219]
M v[220:223], a[172:175], a[156:159], v[220:223]
M v[220:223], a[168:171], a[152:155], v[220:223]
s_waitcnt lgkmcnt(10)
M v[224:227], a[176:179], a[96:99], v[224:227]
s_cmp_eq_u32 s54, s56
s_cselect_b32 s54, s57, s54
s_cselect_b64 s[60:61], s[58:59], s[60:61]
s_cselect_b32 s62, s7, s62
M v[224:227], a[180:183], a[100:103], v[224:227]
M v[228:231], a[180:183], a[108:111], v[228:231]
M v[228:231], a[176:179], a[104:107], v[228:231]
M v[232:235], a[176:179], a[112:115], v[232:235]
M v[232:235], a[180:183], a[116:119], v[232:235]
M v[236:239], a[180:183], a[124:127], v[236:239]
M v[236:239], a[176:179], a[120:123], v[236:239]
s_waitcnt vmcnt(18) lgkmcnt(0)
s_barrier
ds_read_b128 a[160:163], v10 offset:0
ds_read_b128 a[164:167], v11 offset:0
M v[240:243], a[176:179], a[128:131], v[240:243]
s_add_u32 m0, s29, 49152
s_add_u32 s3, s23, s31
buffer_load_dwordx4 v2, s[8:11], s3 offen offset:0 lds
M v[240:243], a[180:183], a[132:135], v[240:243]
M v[244:247], a[180:183], a[140:143], v[244:247]
M v[244:247], a[176:179], a[136:139], v[244:247]
M v[248:251], a[176:179], a[144:147], v[248:251]
M v[248:251], a[180:183], a[148:151], v[248:251]
buffer_load_dwordx4 v3, s[8:11], s3 offen offset:1024 lds
M v[252:255], a[180:183], a[156:159], v[252:255]
M v[252:255], a[176:179], a[152:155], v[252:255]
M a[0:3], a[184:187], a[96:99], a[0:3]
M a[0:3], a[188:191], a[100:103], a[0:3]
ds_read_b128 a[168:171], v10 offset:2048
ds_read_b128 a[172:175], v11 offset:2048
M a[4:7], a[188:191], a[108:111], a[4:7]
M a[4:7], a[184:187], a[104:107], a[4:7]
M a[8:11], a[184:187], a[112:115], a[8:11]
buffer_load_dwordx4 v4, s[8:11], s3 offen offset:2048 lds
M a[8:11], a[188:191], a[116:119], a[8:11]
M a[12:15], a[188:191], a[124:127], a[12:15]
M a[12:15], a[184:187], a[120:123], a[12:15]
M a[16:19], a[184:187], a[128:131], a[16:19]
M a[16:19], a[188:191], a[132:135], a[16:19]
buffer_load_dwordx4 v5, s[8:11], s3 offen offset:3072 lds
M a[20:23], a[188:191], a[140:143], a[20:23]
M a[20:23], a[184:187], a[136:139], a[20:23]
M a[24:27], a[184:187], a[144:147], a[24:27]
M a[24:27], a[188:191], a[148:151], a[24:27]
M a[28:31], a[188:191], a[156:159], a[28:31]
M a[28:31], a[184:187], a[152:155], a[28:31]
s_waitcnt lgkmcnt(2)
M v[32:35], a[160:163], a[32:35], v[32:35]
s_add_u32 s23, s23, 128
s_cmp_eq_u32 s23, s25
s_cselect_b32 s23, s26, s23
M v[32:35], a[164:167], a[36:39], v[32:35]
ds_read_b128 a[176:179], v10 offset:4096
ds_read_b128 a[180:183], v11 offset:4096
M v[36:39], a[164:167], a[44:47], v[36:39]
M v[36:39], a[160:163], a[40:43], v[36:39]
ds_read_b64_tr_b16 a[96:97], v12 offset:32768
ds_read_b64_tr_b16 a[98:99], v12 offset:34816
M v[40:43], a[160:163], a[48:51], v[40:43]
M v[40:43], a[164:167], a[52:55], v[40:43]
M v[44:47], a[164:167], a[60:63], v[44:47]
s_add_u32 m0, s29, 81920
s_nop 0
buffer_load_dwordx4 v6, s[12:15], s24 offen offset:0 lds
M v[44:47], a[160:163], a[56:59], v[44:47]
ds_read_b64_tr_b16 a[104:105], v13 offset:32768
ds_read_b64_tr_b16 a[106:107], v13 offset:34816
M v[48:51], a[160:163], a[64:67], v[48:51]
M v[48:51], a[164:167], a[68:71], v[48:51]
M v[52:55], a[164:167], a[76:79], v[52:55]
M v[52:55], a[160:163], a[72:75], v[52:55]
ds_read_b64_tr_b16 a[112:113], v14 offset:32768
ds_read_b64_tr_b16 a[114:115], v14 offset:34816
M v[56:59], a[160:163], a[80:83], v[56:59]
M v[56:59], a[164:167], a[84:87], v[56:59]
buffer_load_dwordx4 v7, s[12:15], s24 offen offset:1024 lds
M v[60:63], a[164:167], a[92:95], v[60:63]
M v[60:63], a[160:163], a[88:91], v[60:63]
s_waitcnt lgkmcnt(8)
ds_read_b64_tr_b16 a[120:121], v15 offset:32768
ds_read_b64_tr_b16 a[122:123], v15 offset:34816
M v[64:67], a[168:171], a[32:35], v[64:67]
M v[64:67], a[172:175], a[36:39], v[64:67]
ds_read_b128 a[184:187], v10 offset:6144
ds_read_b128 a[188:191], v11 offset:6144
M v[68:71], a[172:175], a[44:47], v[68:71]
M v[68:71], a[168:171], a[40:43], v[68:71]
ds_read_b64_tr_b16 a[128:129], v16 offset:32768
ds_read_b64_tr_b16 a[130:131], v16 offset:34816
M v[72:75], a[168:171], a[48:51], v[72:75]
buffer_load_dwordx4 v8, s[12:15], s24 offen offset:2048 lds
M v[72:75], a[172:175], a[52:55], v[72:75]
M v[76:79], a[172:175], a[60:63], v[76:79]
M v[76:79], a[168:171], a[56:59], v[76:79]
ds_read_b64_tr_b16 a[136:137], v17 offset:32768
ds_read_b64_tr_b16 a[138:139], v17 offset:34816
M v[80:83], a[168:171], a[64:67], v[80:83]
M v[80:83], a[172:175], a[68:71], v[80:83]
M v[84:87], a[172:175], a[76:79], v[84:87]
buffer_load_dwordx4 v9, s[12:15], s24 offen offset:3072 lds
M v[84:87], a[168:171], a[72:75], v[84:87]
ds_read_b64_tr_b16 a[144:145], v18 offset:32768
ds_read_b64_tr_b16 a[146:147], v18 offset:34816
M v[88:91], a[168:171], a[80:83], v[88:91]
M v[88:91], a[172:175], a[84:87], v[88:91]
M v[92:95], a[172:175], a[92:95], v[92:95]
M v[92:95], a[168:171], a[88:91], v[92:95]
s_waitcnt lgkmcnt(15)
ds_read_b64_tr_b16 a[152:153], v19 offset:32768
ds_read_b64_tr_b16 a[154:155], v19 offset:34816
M v[96:99], a[176:179], a[32:35], v[96:99]
s_add_u32 s24, s24, 262144
s_cmp_eq_u32 s24, s27
s_cselect_b32 s24, s28, s24
s_sub_u32 s6, s6, 1
s_cmp_eq_u32 s6, 0
s_cselect_b64 s[12:13], s[64:65], s[12:13]
M v[96:99], a[180:183], a[36:39], v[96:99]
M v[100:103], a[180:183], a[44:47], v[100:103]
M v[100:103], a[176:179], a[40:43], v[100:103]
M v[104:107], a[176:179], a[48:51], v[104:107]
M v[104:107], a[180:183], a[52:55], v[104:107]
M v[108:111], a[180:183], a[60:63], v[108:111]
M v[108:111], a[176:179], a[56:59], v[108:111]
s_waitcnt vmcnt(17) lgkmcnt(0)
s_barrier
ds_read_b128 a[160:163], v10 offset:16384
ds_read_b128 a[164:167], v11 offset:16384
M v[112:115], a[176:179], a[64:67], v[112:115]
s_add_u32 m0, s29, 0
s_nop 0
buffer_load_dwordx4 v2, s[8:11], s23 offen offset:0 lds
M v[112:115], a[180:183], a[68:71], v[112:115]
M v[116:119], a[180:183], a[76:79], v[116:119]
M v[116:119], a[176:179], a[72:75], v[116:119]
ds_read_b64_tr_b16 a[100:101], v12 offset:49152
ds_read_b64_tr_b16 a[102:103], v12 offset:51200
M v[120:123], a[176:179], a[80:83], v[120:123]
M v[120:123], a[180:183], a[84:87], v[120:123]
M v[124:127], a[180:183], a[92:95], v[124:127]
buffer_load_dwordx4 v3, s[8:11], s23 offen offset:1024 lds
M v[124:127], a[176:179], a[88:91], v[124:127]
M v[128:131], a[184:187], a[32:35], v[128:131]
M v[128:131], a[188:191], a[36:39], v[128:131]
ds_read_b128 a[168:171], v10 offset:18432
ds_read_b128 a[172:175], v11 offset:18432
ds_read_b64_tr_b16 a[108:109], v13 offset:49152
ds_read_b64_tr_b16 a[110:111], v13 offset:51200
M v[132:135], a[188:191], a[44:47], v[132:135]
M v[132:135], a[184:187], a[40:43], v[132:135]
M v[136:139], a[184:187], a[48:51], v[136:139]
M v[136:139], a[188:191], a[52:55], v[136:139]
buffer_load_dwordx4 v4, s[8:11], s23 offen offset:2048 lds
M v[140:143], a[188:191], a[60:63], v[140:143]
M v[140:143], a[184:187], a[56:59], v[140:143]
ds_read_b64_tr_b16 a[116:117], v14 offset:49152
ds_read_b64_tr_b16 a[118:119], v14 offset:51200
M v[144:147], a[184:187], a[64:67], v[144:147]
M v[144:147], a[188:191], a[68:71], v[144:147]
M v[148:151], a[188:191], a[76:79], v[148:151]
M v[148:151], a[184:187], a[72:75], v[148:151]
M v[152:155], a[184:187], a[80:83], v[152:155]
buffer_load_dwordx4 v5, s[8:11], s23 offen offset:3072 lds
M v[152:155], a[188:191], a[84:87], v[152:155]
ds_read_b64_tr_b16 a[124:125], v15 offset:49152
ds_read_b64_tr_b16 a[126:127], v15 offset:51200
M v[156:159], a[188:191], a[92:95], v[156:159]
M v[156:159], a[184:187], a[88:91], v[156:159]
s_waitcnt lgkmcnt(10)
M v[160:163], a[160:163], a[32:35], v[160:163]
M v[160:163], a[164:167], a[36:39], v[160:163]
ds_read_b128 a[176:179], v10 offset:20480
ds_read_b128 a[180:183], v11 offset:20480
M v[164:167], a[164:167], a[44:47], v[164:167]
M v[164:167], a[160:163], a[40:43], v[164:167]
ds_read_b64_tr_b16 a[132:133], v16 offset:49152
ds_read_b64_tr_b16 a[134:135], v16 offset:51200
M v[168:171], a[160:163], a[48:51], v[168:171]
M v[168:171], a[164:167], a[52:55], v[168:171]
s_add_u32 m0, s29, 98304
s_nop 0
buffer_load_dwordx4 v6, s[12:15], s24 offen offset:0 lds
M v[172:175], a[164:167], a[60:63], v[172:175]
M v[172:175], a[160:163], a[56:59], v[172:175]
M v[176:179], a[160:163], a[64:67], v[176:179]
M v[176:179], a[164:167], a[68:71], v[176:179]
ds_read_b64_tr_b16 a[140:141], v17 offset:49152
ds_read_b64_tr_b16 a[142:143], v17 offset:51200
M v[180:183], a[164:167], a[76:79], v[180:183]
M v[180:183], a[160:163], a[72:75], v[180:183]
buffer_load_dwordx4 v7, s[12:15], s24 offen offset:1024 lds
M v[184:187], a[160:163], a[80:83], v[184:187]
M v[184:187], a[164:167], a[84:87], v[184:187]
M v[188:191], a[164:167], a[92:95], v[188:191]
M v[188:191], a[160:163], a[88:91], v[188:191]
s_waitcnt lgkmcnt(12)
ds_read_b64_tr_b16 a[148:149], v18 offset:49152
ds_read_b64_tr_b16 a[150:151], v18 offset:51200
M v[192:195], a[168:171], a[32:35], v[192:195]
M v[192:195], a[172:175], a[36:39], v[192:195]
ds_read_b128 a[184:187], v10 offset:22528
ds_read_b128 a[188:191], v11 offset:22528
M v[196:199], a[172:175], a[44:47], v[196:199]
M v[196:199], a[168:171], a[40:43], v[196:199]
buffer_load_dwordx4 v8, s[12:15], s24 offen offset:2048 lds
M v[200:203], a[168:171], a[48:51], v[200:203]
M v[200:203], a[172:175], a[52:55], v[200:203]
ds_read_b64_tr_b16 a[156:157], v19 offset:49152
ds_read_b64_tr_b16 a[158:159], v19 offset:51200
M v[204:207], a[172:175], a[60:63], v[204:207]
M v[204:207], a[168:171], a[56:59], v[204:207]
M v[208:211], a[168:171], a[64:67], v[208:211]
M v[208:211], a[172:175], a[68:71], v[208:211]
buffer_load_dwordx4 v9, s[12:15], s24 offen offset:3072 lds
M v[212:215], a[172:175], a[76:79], v[212:215]
M v[212:215], a[168:171], a[72:75], v[212:215]
M v[216:219], a[168:171], a[80:83], v[216:219]
M v[216:219], a[172:175], a[84:87], v[216:219]
M v[220:223], a[172:175], a[92:95], v[220:223]
s_add_u32 s24, s24, 262144
M v[220:223], a[168:171], a[88:91], v[220:223]
s_waitcnt lgkmcnt(10)
M v[224:227], a[176:179], a[32:35], v[224:227]
M v[224:227], a[180:183], a[36:39], v[224:227]
M v[228:231], a[180:183], a[44:47], v[228:231]
M v[228:231], a[176:179], a[40:43], v[228:231]
M v[232:235], a[176:179], a[48:51], v[232:235]
M v[232:235], a[180:183], a[52:55], v[232:235]
M v[236:239], a[180:183], a[60:63], v[236:239]
M v[236:239], a[176:179], a[56:59], v[236:239]
s_waitcnt vmcnt(17) lgkmcnt(0)
s_barrier
ds_read_b128 a[160:163], v10 offset:32768
ds_read_b128 a[164:167], v11 offset:32768
M v[240:243], a[176:179], a[64:67], v[240:243]
s_add_u32 m0, s29, 16384
s_add_u32 s3, s23, s31
buffer_load_dwordx4 v2, s[8:11], s3 offen offset:0 lds
M v[240:243], a[180:183], a[68:71], v[240:243]
M v[244:247], a[180:183], a[76:79], v[244:247]
M v[244:247], a[176:179], a[72:75], v[244:247]
M v[248:251], a[176:179], a[80:83], v[248:251]
M v[248:251], a[180:183], a[84:87], v[248:251]
buffer_load_dwordx4 v3, s[8:11], s3 offen offset:1024 lds
M v[252:255], a[180:183], a[92:95], v[252:255]
M v[252:255], a[176:179], a[88:91], v[252:255]
M a[0:3], a[184:187], a[32:35], a[0:3]
M a[0:3], a[188:191], a[36:39], a[0:3]
ds_read_b128 a[168:171], v10 offset:34816
ds_read_b128 a[172:175], v11 offset:34816
M a[4:7], a[188:191], a[44:47], a[4:7]
M a[4:7], a[184:187], a[40:43], a[4:7]
M a[8:11], a[184:187], a[48:51], a[8:11]
buffer_load_dwordx4 v4, s[8:11], s3 offen offset:2048 lds
M a[8:11], a[188:191], a[52:55], a[8:11]
M a[12:15], a[188:191], a[60:63], a[12:15]
M a[12:15], a[184:187], a[56:59], a[12:15]
M a[16:19], a[184:187], a[64:67], a[16:19]
M a[16:19], a[188:191], a[68:71], a[16:19]
buffer_load_dwordx4 v5, s[8:11], s3 offen offset:3072 lds
M a[20:23], a[188:191], a[76:79], a[20:23]
M a[20:23], a[184:187], a[72:75], a[20:23]
M a[24:27], a[184:187], a[80:83], a[24:27]
M a[24:27], a[188:191], a[84:87], a[24:27]
M a[28:31], a[188:191], a[92:95], a[28:31]
M a[28:31], a[184:187], a[88:91], a[28:31]
s_waitcnt lgkmcnt(2)
M v[32:35], a[160:163], a[96:99], v[32:35]
s_add_u32 s23, s23, 128
s_cmp_eq_u32 s23, s25
s_cselect_b32 s23, s26, s23
M v[32:35], a[164:167], a[100:103], v[32:35]
ds_read_b128 a[176:179], v10 offset:36864
ds_read_b128 a[180:183], v11 offset:36864
M v[36:39], a[164:167], a[108:111], v[36:39]
M v[36:39], a[160:163], a[104:107], v[36:39]
ds_read_b64_tr_b16 a[32:33], v12 offset:0
ds_read_b64_tr_b16 a[34:35], v12 offset:2048
M v[40:43], a[160:163], a[112:115], v[40:43]
M v[40:43], a[164:167], a[116:119], v[40:43]
M v[44:47], a[164:167], a[124:127], v[44:47]
s_add_u32 m0, s29, 114688
s_nop 0
buffer_load_dwordx4 v6, s[12:15], s24 offen offset:0 lds
M v[44:47], a[160:163], a[120:123], v[44:47]
ds_read_b64_tr_b16 a[40:41], v13 offset:0
ds_read_b64_tr_b16 a[42:43], v13 offset:2048
M v[48:51], a[160:163], a[128:131], v[48:51]
M v[48:51], a[164:167], a[132:135], v[48:51]
M v[52:55], a[164:167], a[140:143], v[52:55]
M v[52:55], a[160:163], a[136:139], v[52:55]
ds_read_b64_tr_b16 a[48:49], v14 offset:0
ds_read_b64_tr_b16 a[50:51], v14 offset:2048
M v[56:59], a[160:163], a[144:147], v[56:59]
M v[56:59], a[164:167], a[148:151], v[56:59]
buffer_load_dwordx4 v7, s[12:15], s24 offen offset:1024 lds
M v[60:63], a[164:167], a[156:159], v[60:63]
M v[60:63], a[160:163], a[152:155], v[60:63]
s_waitcnt lgkmcnt(8)
ds_read_b64_tr_b16 a[56:57], v15 offset:0
ds_read_b64_tr_b16 a[58:59], v15 offset:2048
M v[64:67], a[168:171], a[96:99], v[64:67]
M v[64:67], a[172:175], a[100:103], v[64:67]
ds_read_b128 a[184:187], v10 offset:38912
ds_read_b128 a[188:191], v11 offset:38912
M v[68:71], a[172:175], a[108:111], v[68:71]
M v[68:71], a[168:171], a[104:107], v[68:71]
ds_read_b64_tr_b16 a[64:65], v16 offset:0
ds_read_b64_tr_b16 a[66:67], v16 offset:2048
M v[72:75], a[168:171], a[112:115], v[72:75]
buffer_load_dwordx4 v8, s[12:15], s24 offen offset:2048 lds
M v[72:75], a[172:175], a[116:119], v[72:75]
M v[76:79], a[172:175], a[124:127], v[76:79]
M v[76:79], a[168:171], a[120:123], v[76:79]
ds_read_b64_tr_b16 a[72:73], v17 offset:0
ds_read_b64_tr_b16 a[74:75], v17 offset:2048
M v[80:83], a[168:171], a[128:131], v[80:83]
M v[80:83], a[172:175], a[132:135], v[80:83]
M v[84:87], a[172:175], a[140:143], v[84:87]
buffer_load_dwordx4 v9, s[12:15], s24 offen offset:3072 lds
M v[84:87], a[168:171], a[136:139], v[84:87]
ds_read_b64_tr_b16 a[80:81], v18 offset:0
ds_read_b64_tr_b16 a[82:83], v18 offset:2048
M v[88:91], a[168:171], a[144:147], v[88:91]
M v[88:91], a[172:175], a[148:151], v[88:91]
M v[92:95], a[172:175], a[156:159], v[92:95]
M v[92:95], a[168:171], a[152:155], v[92:95]
s_waitcnt lgkmcnt(15)
ds_read_b64_tr_b16 a[88:89], v19 offset:0
ds_read_b64_tr_b16 a[90:91], v19 offset:2048
M v[96:99], a[176:179], a[96:99], v[96:99]
s_add_u32 s24, s24, 262144
s_cmp_eq_u32 s24, s27
s_cselect_b32 s24, s28, s24
s_sub_u32 s6, s6, 1
s_cmp_eq_u32 s6, 0
s_cselect_b64 s[12:13], s[64:65], s[12:13]
M v[96:99], a[180:183], a[100:103], v[96:99]
M v[100:103], a[180:183], a[108:111], v[100:103]
M v[100:103], a[176:179], a[104:107], v[100:103]
M v[104:107], a[176:179], a[112:115], v[104:107]
M v[104:107], a[180:183], a[116:119], v[104:107]
M v[108:111], a[180:183], a[124:127], v[108:111]
M v[108:111], a[176:179], a[120:123], v[108:111]
s_waitcnt vmcnt(16) lgkmcnt(0)
s_barrier
ds_read_b128 a[160:163], v10 offset:49152
ds_read_b128 a[164:167], v11 offset:49152
M v[112:115], a[176:179], a[128:131], v[112:115]
s_add_u32 m0, s29, 32768
s_nop 0
buffer_load_dwordx4 v2, s[8:11], s23 offen offset:0 lds
M v[112:115], a[180:183], a[132:135], v[112:115]
M v[116:119], a[180:183], a[140:143], v[116:119]
M v[116:119], a[176:179], a[136:139], v[116:119]
ds_read_b64_tr_b16 a[36:37], v12 offset:16384
ds_read_b64_tr_b16 a[38:39], v12 offset:18432
M v[120:123], a[176:179], a[144:147], v[120:123]
M v[120:123], a[180:183], a[148:151], v[120:123]
M v[124:127], a[180:183], a[156:159], v[124:127]
M v[124:127], a[176:179], a[152:155], v[124:127]
M v[128:131], a[184:187], a[96:99], v[128:131]
M v[128:131], a[188:191], a[100:103], v[128:131]
ds_read_b128 a[168:171], v10 offset:51200
ds_read_b128 a[172:175], v11 offset:51200
ds_read_b64_tr_b16 a[44:45], v13 offset:16384
ds_read_b64_tr_b16 a[46:47], v13 offset:18432
M v[132:135], a[188:191], a[108:111], v[132:135]
M v[132:135], a[184:187], a[104:107], v[132:135]
M v[136:139], a[184:187], a[112:115], v[136:139]
M v[136:139], a[188:191], a[116:119], v[136:139]
M v[140:143], a[188:191], a[124:127], v[140:143]
M v[140:143], a[184:187], a[120:123], v[140:143]
ds_read_b64_tr_b16 a[52:53], v14 offset:16384
ds_read_b64_tr_b16 a[54:55], v14 offset:18432
M v[144:147], a[184:187], a[128:131], v[144:147]
buffer_load_dwordx4 v3, s[8:11], s23 offen offset:1024 lds
M v[144:147], a[188:191], a[132:135], v[144:147]
M v[148:151], a[188:191], a[140:143], v[148:151]
M v[148:151], a[184:187], a[136:139], v[148:151]
M v[152:155], a[184:187], a[144:147], v[152:155]
M v[152:155], a[188:191], a[148:151], v[152:155]
ds_read_b64_tr_b16 a[60:61], v15 offset:16384
ds_read_b64_tr_b16 a[62:63], v15 offset:18432
M v[156:159], a[188:191], a[156:159], v[156:159]
M v[156:159], a[184:187], a[152:155], v[156:159]
s_waitcnt lgkmcnt(10)
M v[160:163], a[160:163], a[96:99], v[160:163]
M v[160:163], a[164:167], a[100:103], v[160:163]
ds_read_b128 a[176:179], v10 offset:53248
ds_read_b128 a[180:183], v11 offset:53248
M v[164:167], a[164:167], a[108:111], v[164:167]
M v[164:167], a[160:163], a[104:107], v[164:167]
ds_read_b64_tr_b16 a[68:69], v16 offset:16384
ds_read_b64_tr_b16 a[70:71], v16 offset:18432
M v[168:171], a[160:163], a[112:115], v[168:171]
M v[168:171], a[164:167], a[116:119], v[168:171]
M v[172:175], a[164:167], a[124:127], v[172:175]
M v[172:175], a[160:163], a[120:123], v[172:175]
M v[176:179], a[160:163], a[128:131], v[176:179]
buffer_load_dwordx4 v4, s[8:11], s23 offen offset:2048 lds
M v[176:179], a[164:167], a[132:135], v[176:179]
ds_read_b64_tr_b16 a[76:77], v17 offset:16384
ds_read_b64_tr_b16 a[78:79], v17 offset:18432
M v[180:183], a[164:167], a[140:143], v[180:183]
M v[180:183], a[160:163], a[136:139], v[180:183]
M v[184:187], a[160:163], a[144:147], v[184:187]
M v[184:187], a[164:167], a[148:151], v[184:187]
M v[188:191], a[164:167], a[156:159], v[188:191]
M v[188:191], a[160:163], a[152:155], v[188:191]
s_waitcnt lgkmcnt(12)
ds_read_b64_tr_b16 a[84:85], v18 offset:16384
ds_read_b64_tr_b16 a[86:87], v18 offset:18432
M v[192:195], a[168:171], a[96:99], v[192:195]
M v[192:195], a[172:175], a[100:103], v[192:195]
ds_read_b128 a[184:187], v10 offset:55296
ds_read_b128 a[188:191], v11 offset:55296
M v[196:199], a[172:175], a[108:111], v[196:199]
M v[196:199], a[168:171], a[104:107], v[196:199]
M v[200:203], a[168:171], a[112:115], v[200:203]
M v[200:203], a[172:175], a[116:119], v[200:203]
ds_read_b64_tr_b16 a[92:93], v19 offset:16384
ds_read_b64_tr_b16 a[94:95], v19 offset:18432
M v[204:207], a[172:175], a[124:127], v[204:207]
M v[204:207], a[168:171], a[120:123], v[204:207]
M v[208:211], a[168:171], a[128:131], v[208:211]
buffer_load_dwordx4 v5, s[8:11], s23 offen offset:3072 lds
M v[208:211], a[172:175], a[132:135], v[208:211]
M v[212:215], a[172:175], a[140:143], v[212:215]
M v[212:215], a[168:171], a[136:139], v[212:215]
M v[216:219], a[168:171], a[144:147], v[216:219]
M v[216:219], a[172:175], a[148:151], v[216:219]
M v[220:223], a[172:175], a[156:159], v[220:223]
M v[220:223], a[168:171], a[152:155], v[220:223]
s_waitcnt lgkmcnt(10)
M v[224:227], a[176:179], a[96:99], v[224:227]
M v[224:227], a[180:183], a[100:103], v[224:227]
M v[228:231], a[180:183], a[108:111], v[228:231]
M v[228:231], a[176:179], a[104:107], v[228:231]
M v[232:235], a[176:179], a[112:115], v[232:235]
M v[232:235], a[180:183], a[116:119], v[232:235]
M v[236:239], a[180:183], a[124:127], v[236:239]
M v[236:239], a[176:179], a[120:123], v[236:239]
s_waitcnt vmcnt(12) lgkmcnt(0)
s_barrier
ds_read_b128 a[160:163], v10 offset:0
ds_read_b128 a[164:167], v11 offset:0
M v[240:243], a[176:179], a[128:131], v[240:243]
s_add_u32 m0, s29, 49152
s_add_u32 s3, s23, s31
buffer_load_dwordx4 v2, s[8:11], s3 offen offset:0 lds
M v[240:243], a[180:183], a[132:135], v[240:243]
M v[244:247], a[180:183], a[140:143], v[244:247]
M v[244:247], a[176:179], a[136:139], v[244:247]
M v[248:251], a[176:179], a[144:147], v[248:251]
M v[248:251], a[180:183], a[148:151], v[248:251]
M v[252:255], a[180:183], a[156:159], v[252:255]
M v[252:255], a[176:179], a[152:155], v[252:255]
M a[0:3], a[184:187], a[96:99], a[0:3]
M a[0:3], a[188:191], a[100:103], a[0:3]
ds_read_b128 a[168:171], v10 offset:2048
ds_read_b128 a[172:175], v11 offset:2048
M a[4:7], a[188:191], a[108:111], a[4:7]
M a[4:7], a[184:187], a[104:107], a[4:7]
M a[8:11], a[184:187], a[112:115], a[8:11]
buffer_load_dwordx4 v3, s[8:11], s3 offen offset:1024 lds
M a[8:11], a[188:191], a[116:119], a[8:11]
M a[12:15], a[188:191], a[124:127], a[12:15]
M a[12:15], a[184:187], a[120:123], a[12:15]
M a[16:19], a[184:187], a[128:131], a[16:19]
M a[16:19], a[188:191], a[132:135], a[16:19]
M a[20:23], a[188:191], a[140:143], a[20:23]
M a[20:23], a[184:187], a[136:139], a[20:23]
M a[24:27], a[184:187], a[144:147], a[24:27]
M a[24:27], a[188:191], a[148:151], a[24:27]
M a[28:31], a[188:191], a[156:159], a[28:31]
M a[28:31], a[184:187], a[152:155], a[28:31]
s_waitcnt lgkmcnt(2)
M v[32:35], a[160:163], a[32:35], v[32:35]
buffer_load_dwordx4 v4, s[8:11], s3 offen offset:2048 lds
M v[32:35], a[164:167], a[36:39], v[32:35]
ds_read_b128 a[176:179], v10 offset:4096
ds_read_b128 a[180:183], v11 offset:4096
M v[36:39], a[164:167], a[44:47], v[36:39]
M v[36:39], a[160:163], a[40:43], v[36:39]
ds_read_b64_tr_b16 a[96:97], v12 offset:32768
ds_read_b64_tr_b16 a[98:99], v12 offset:34816
M v[40:43], a[160:163], a[48:51], v[40:43]
M v[40:43], a[164:167], a[52:55], v[40:43]
M v[44:47], a[164:167], a[60:63], v[44:47]
M v[44:47], a[160:163], a[56:59], v[44:47]
ds_read_b64_tr_b16 a[104:105], v13 offset:32768
ds_read_b64_tr_b16 a[106:107], v13 offset:34816
M v[48:51], a[160:163], a[64:67], v[48:51]
M v[48:51], a[164:167], a[68:71], v[48:51]
M v[52:55], a[164:167], a[76:79], v[52:55]
M v[52:55], a[160:163], a[72:75], v[52:55]
ds_read_b64_tr_b16 a[112:113], v14 offset:32768
ds_read_b64_tr_b16 a[114:115], v14 offset:34816
M v[56:59], a[160:163], a[80:83], v[56:59]
M v[56:59], a[164:167], a[84:87], v[56:59]
buffer_load_dwordx4 v5, s[8:11], s3 offen offset:3072 lds
M v[60:63], a[164:167], a[92:95], v[60:63]
M v[60:63], a[160:163], a[88:91], v[60:63]
s_waitcnt lgkmcnt(8)
ds_read_b64_tr_b16 a[120:121], v15 offset:32768
ds_read_b64_tr_b16 a[122:123], v15 offset:34816
M v[64:67], a[168:171], a[32:35], v[64:67]
M v[64:67], a[172:175], a[36:39], v[64:67]
ds_read_b128 a[184:187], v10 offset:6144
ds_read_b128 a[188:191], v11 offset:6144
M v[68:71], a[172:175], a[44:47], v[68:71]
M v[68:71], a[168:171], a[40:43], v[68:71]
ds_read_b64_tr_b16 a[128:129], v16 offset:32768
ds_read_b64_tr_b16 a[130:131], v16 offset:34816
M v[72:75], a[168:171], a[48:51], v[72:75]
M v[72:75], a[172:175], a[52:55], v[72:75]
M v[76:79], a[172:175], a[60:63], v[76:79]
M v[76:79], a[168:171], a[56:59], v[76:79]
ds_read_b64_tr_b16 a[136:137], v17 offset:32768
ds_read_b64_tr_b16 a[138:139], v17 offset:34816
M v[80:83], a[168:171], a[64:67], v[80:83]
M v[80:83], a[172:175], a[68:71], v[80:83]
M v[84:87], a[172:175], a[76:79], v[84:87]
s_add_u32 s23, s23, 128
s_cmp_eq_u32 s23, s25
s_cselect_b32 s23, s26, s23
M v[84:87], a[168:171], a[72:75], v[84:87]
ds_read_b64_tr_b16 a[144:145], v18 offset:32768
ds_read_b64_tr_b16 a[146:147], v18 offset:34816
M v[88:91], a[168:171], a[80:83], v[88:91]
M v[88:91], a[172:175], a[84:87], v[88:91]
M v[92:95], a[172:175], a[92:95], v[92:95]
M v[92:95], a[168:171], a[88:91], v[92:95]
s_waitcnt lgkmcnt(15)
ds_read_b64_tr_b16 a[152:153], v19 offset:32768
ds_read_b64_tr_b16 a[154:155], v19 offset:34816
M v[96:99], a[176:179], a[32:35], v[96:99]
M v[96:99], a[180:183], a[36:39], v[96:99]
M v[100:103], a[180:183], a[44:47], v[100:103]
M v[100:103], a[176:179], a[40:43], v[100:103]
M v[104:107], a[176:179], a[48:51], v[104:107]
M v[104:107], a[180:183], a[52:55], v[104:107]
M v[108:111], a[180:183], a[60:63], v[108:111]
M v[108:111], a[176:179], a[56:59], v[108:111]
s_waitcnt vmcnt(8) lgkmcnt(0)
s_barrier
ds_read_b128 a[160:163], v10 offset:16384
ds_read_b128 a[164:167], v11 offset:16384
M v[112:115], a[176:179], a[64:67], v[112:115]
M v[112:115], a[180:183], a[68:71], v[112:115]
s_and_b32 s3, s2, 1
s_lshl_b32 s3, s3, 3
s_bfe_u32 s4, s2, 0x30003
M v[116:119], a[180:183], a[76:79], v[116:119]
s_add_u32 s26, s3, s4
s_bfe_u32 s3, s2, 0x20001
M v[116:119], a[176:179], a[72:75], v[116:119]
ds_read_b64_tr_b16 a[100:101], v12 offset:49152
ds_read_b64_tr_b16 a[102:103], v12 offset:51200
s_lshl_b32 s3, s3, 2
s_lshr_b32 s4, s2, 6
s_add_u32 s27, s3, s4
M v[120:123], a[176:179], a[80:83], v[120:123]
s_lshl_b32 s23, s26, 18
s_sub_u32 s24, s23, 32768
M v[120:123], a[180:183], a[84:87], v[120:123]
s_max_i32 s24, s24, 0
s_lshl_b32 s25, s27, 7
s_xor_b32 s3, s26, s27
M v[124:127], a[180:183], a[92:95], v[124:127]
s_and_b32 s3, s3, 0
s_lshl_b32 s3, s3, 3
M v[124:127], a[176:179], a[88:91], v[124:127]
s_sub_u32 s31, 16, s3
s_mov_b32 s54, s31
s_movk_i32 s57, 128
M v[128:131], a[184:187], a[32:35], v[128:131]
s_mov_b32 s55, 4289069056
s_mov_b32 s56, 393216
M v[128:131], a[188:191], a[36:39], v[128:131]
ds_read_b128 a[168:171], v10 offset:18432
ds_read_b128 a[172:175], v11 offset:18432
ds_read_b64_tr_b16 a[108:109], v13 offset:49152
ds_read_b64_tr_b16 a[110:111], v13 offset:51200
s_lshl_b32 s4, s3, 7
s_add_u32 s23, s23, s4
s_add_u32 s24, s24, s4
M v[132:135], a[188:191], a[44:47], v[132:135]
s_mul_i32 s4, s3, 393216
s_add_u32 s25, s25, s4
M v[132:135], a[184:187], a[40:43], v[132:135]
s_mov_b64 s[8:9], s[44:45]
s_mov_b32 s10, 4194304
s_mov_b64 s[12:13], s[46:47]
M v[136:139], a[184:187], a[48:51], v[136:139]
s_mov_b32 s14, 6291456
s_mov_b64 s[36:37], s[90:91]
M v[136:139], a[188:191], a[52:55], v[136:139]
s_mov_b32 s38, 256
s_mov_b32 s39, 0x00020000
s_lshl_b32 s28, s20, 9
M v[140:143], a[188:191], a[60:63], v[140:143]
s_mul_i32 s30, s20, 6144
s_lshl_b32 s3, s20, 5
M v[140:143], a[184:187], a[56:59], v[140:143]
ds_read_b64_tr_b16 a[116:117], v14 offset:49152
ds_read_b64_tr_b16 a[118:119], v14 offset:51200
v_lshrrev_b32 v24, 3, v0
v_and_b32 v25, 7, v0
v_add_u32 v28, s3, v24
M v[144:147], a[184:187], a[64:67], v[144:147]
v_add_u32 v26, 0, v28
v_bfe_u32 v27, v26, 1, 3
M v[144:147], a[188:191], a[68:71], v[144:147]
v_xor_b32 v27, v27, v25
v_lshlrev_b32 v26, 11, v26
v_lshl_add_u32 v26, v27, 4, v26
M v[148:151], a[188:191], a[76:79], v[148:151]
v_subrev_u32 v2, 0, v26
v_add_u32 v26, 8, v28
M v[148:151], a[184:187], a[72:75], v[148:151]
v_bfe_u32 v27, v26, 1, 3
v_xor_b32 v27, v27, v25
v_lshlrev_b32 v26, 11, v26
M v[152:155], a[184:187], a[80:83], v[152:155]
v_lshl_add_u32 v26, v27, 4, v26
v_subrev_u32 v3, 1024, v26
M v[152:155], a[188:191], a[84:87], v[152:155]
ds_read_b64_tr_b16 a[124:125], v15 offset:49152
ds_read_b64_tr_b16 a[126:127], v15 offset:51200
v_add_u32 v26, 16, v28
v_bfe_u32 v27, v26, 1, 3
v_xor_b32 v27, v27, v25
M v[156:159], a[188:191], a[92:95], v[156:159]
v_lshlrev_b32 v26, 11, v26
v_lshl_add_u32 v26, v27, 4, v26
M v[156:159], a[184:187], a[88:91], v[156:159]
s_waitcnt lgkmcnt(10)
v_subrev_u32 v4, 2048, v26
v_add_u32 v26, 24, v28
v_bfe_u32 v27, v26, 1, 3
M v[160:163], a[160:163], a[32:35], v[160:163]
v_xor_b32 v27, v27, v25
v_lshlrev_b32 v26, 11, v26
M v[160:163], a[164:167], a[36:39], v[160:163]
ds_read_b128 a[176:179], v10 offset:20480
ds_read_b128 a[180:183], v11 offset:20480
v_lshl_add_u32 v26, v27, 4, v26
v_subrev_u32 v5, 3072, v26
s_lshl_b32 s3, s20, 2
M v[164:167], a[164:167], a[44:47], v[164:167]
v_add_u32 v26, s3, v24
v_bfe_u32 v27, v26, 1, 3
M v[164:167], a[160:163], a[40:43], v[164:167]
ds_read_b64_tr_b16 a[132:133], v16 offset:49152
ds_read_b64_tr_b16 a[134:135], v16 offset:51200
v_xor_b32 v27, v27, v25
v_lshlrev_b32 v26, 11, v26
v_lshl_add_u32 v20, v27, 4, v26
M v[168:171], a[160:163], a[48:51], v[168:171]
s_mul_i32 s3, s20, 48
v_add_u32 v28, s3, v24
M v[168:171], a[164:167], a[52:55], v[168:171]
v_add_u32 v26, 0, v28
v_mul_u32_u24 v27, 0xaaab, v26
M v[172:175], a[164:167], a[60:63], v[172:175]
v_lshrrev_b32 v27, 17, v27
v_lshrrev_b32 v29, 1, v27
v_and_b32 v29, 4, v29
M v[172:175], a[160:163], a[56:59], v[172:175]
v_and_or_b32 v27, v27, 2, v29
v_xor_b32 v27, v27, v25
M v[176:179], a[160:163], a[64:67], v[176:179]
v_lshlrev_b32 v26, 11, v26
v_lshl_add_u32 v26, v27, 4, v26
v_subrev_u32 v6, 0, v26
M v[176:179], a[164:167], a[68:71], v[176:179]
ds_read_b64_tr_b16 a[140:141], v17 offset:49152
ds_read_b64_tr_b16 a[142:143], v17 offset:51200
v_add_u32 v26, 8, v28
v_mul_u32_u24 v27, 0xaaab, v26
M v[180:183], a[164:167], a[76:79], v[180:183]
v_lshrrev_b32 v27, 17, v27
v_lshrrev_b32 v29, 1, v27
v_and_b32 v29, 4, v29
M v[180:183], a[160:163], a[72:75], v[180:183]
v_and_or_b32 v27, v27, 2, v29
v_xor_b32 v27, v27, v25
M v[184:187], a[160:163], a[80:83], v[184:187]
v_lshlrev_b32 v26, 11, v26
v_lshl_add_u32 v26, v27, 4, v26
v_subrev_u32 v7, 1024, v26
M v[184:187], a[164:167], a[84:87], v[184:187]
v_add_u32 v26, 16, v28
v_mul_u32_u24 v27, 0xaaab, v26
M v[188:191], a[164:167], a[92:95], v[188:191]
v_lshrrev_b32 v27, 17, v27
v_lshrrev_b32 v29, 1, v27
v_and_b32 v29, 4, v29
M v[188:191], a[160:163], a[88:91], v[188:191]
s_waitcnt lgkmcnt(12)
ds_read_b64_tr_b16 a[148:149], v18 offset:49152
ds_read_b64_tr_b16 a[150:151], v18 offset:51200
v_and_or_b32 v27, v27, 2, v29
v_xor_b32 v27, v27, v25
M v[192:195], a[168:171], a[32:35], v[192:195]
v_lshlrev_b32 v26, 11, v26
v_lshl_add_u32 v26, v27, 4, v26
v_subrev_u32 v8, 2048, v26
M v[192:195], a[172:175], a[36:39], v[192:195]
ds_read_b128 a[184:187], v10 offset:22528
ds_read_b128 a[188:191], v11 offset:22528
v_add_u32 v26, 24, v28
v_mul_u32_u24 v27, 0xaaab, v26
M v[196:199], a[172:175], a[44:47], v[196:199]
v_lshrrev_b32 v27, 17, v27
v_lshrrev_b32 v29, 1, v27
v_and_b32 v29, 4, v29
M v[196:199], a[168:171], a[40:43], v[196:199]
v_and_or_b32 v27, v27, 2, v29
v_xor_b32 v27, v27, v25
M v[200:203], a[168:171], a[48:51], v[200:203]
v_lshlrev_b32 v26, 11, v26
v_lshl_add_u32 v26, v27, 4, v26
v_subrev_u32 v9, 3072, v26
M v[200:203], a[172:175], a[52:55], v[200:203]
ds_read_b64_tr_b16 a[156:157], v19 offset:49152
ds_read_b64_tr_b16 a[158:159], v19 offset:51200
v_add_u32 v26, 32, v28
v_mul_u32_u24 v27, 0xaaab, v26
M v[204:207], a[172:175], a[60:63], v[204:207]
v_lshrrev_b32 v27, 17, v27
v_lshrrev_b32 v29, 1, v27
v_and_b32 v29, 4, v29
M v[204:207], a[168:171], a[56:59], v[204:207]
v_and_or_b32 v27, v27, 2, v29
v_xor_b32 v27, v27, v25
M v[208:211], a[168:171], a[64:67], v[208:211]
v_lshlrev_b32 v26, 11, v26
v_lshl_add_u32 v26, v27, 4, v26
v_subrev_u32 v21, 0, v26
M v[208:211], a[172:175], a[68:71], v[208:211]
v_add_u32 v26, 40, v28
v_mul_u32_u24 v27, 0xaaab, v26
M v[212:215], a[172:175], a[76:79], v[212:215]
v_lshrrev_b32 v27, 17, v27
v_lshrrev_b32 v29, 1, v27
v_and_b32 v29, 4, v29
M v[212:215], a[168:171], a[72:75], v[212:215]
v_and_or_b32 v27, v27, 2, v29
v_xor_b32 v27, v27, v25
M v[216:219], a[168:171], a[80:83], v[216:219]
v_lshlrev_b32 v26, 11, v26
v_lshl_add_u32 v26, v27, 4, v26
v_subrev_u32 v22, 1024, v26
M v[216:219], a[172:175], a[84:87], v[216:219]
s_lshr_b32 s3, s53, 7
s_add_u32 s3, s3, s22
M v[220:223], a[172:175], a[92:95], v[220:223]
s_lshl_b32 s3, s3, 5
s_lshr_b32 s19, s52, 6
s_add_u32 s3, s3, s19
M v[220:223], a[168:171], a[88:91], v[220:223]
s_waitcnt lgkmcnt(10)
s_lshl_b32 s19, s21, 1
s_add_u32 s3, s3, s19
M v[224:227], a[176:179], a[32:35], v[224:227]
s_lshl_b32 s92, s3, 15
s_add_u32 s92, s92, 16384
s_add_u32 s93, s92, 32768
M v[224:227], a[180:183], a[36:39], v[224:227]
s_add_u32 s16, s50, 16777216
s_addc_u32 s17, s51, 0
M v[228:231], a[180:183], a[44:47], v[228:231]
s_mov_b32 s18, 33554432
s_mov_b32 s19, 0x00020000
M v[228:231], a[176:179], a[40:43], v[228:231]
M v[232:235], a[176:179], a[48:51], v[232:235]
M v[232:235], a[180:183], a[52:55], v[232:235]
M v[236:239], a[180:183], a[60:63], v[236:239]
M v[236:239], a[176:179], a[56:59], v[236:239]
s_waitcnt vmcnt(4) lgkmcnt(0)
s_barrier
ds_read_b128 a[160:163], v10 offset:32768
ds_read_b128 a[164:167], v11 offset:32768
M v[240:243], a[176:179], a[64:67], v[240:243]
s_add_u32 m0, s28, 131072
s_mov_b32 exec_hi, 0
buffer_load_dwordx4 v20, s[8:11], s24 offen lds
s_mov_b32 exec_hi, -1
M v[240:243], a[180:183], a[68:71], v[240:243]
M v[244:247], a[180:183], a[76:79], v[244:247]
M v[244:247], a[176:179], a[72:75], v[244:247]
s_add_u32 m0, s29, 133120
s_nop 0
buffer_load_dwordx4 v2, s[8:11], s23 offen offset:0 lds
M v[248:251], a[176:179], a[80:83], v[248:251]
M v[248:251], a[180:183], a[84:87], v[248:251]
M v[252:255], a[180:183], a[92:95], v[252:255]
M v[252:255], a[176:179], a[88:91], v[252:255]
M a[0:3], a[184:187], a[32:35], a[0:3]
buffer_load_dwordx4 v3, s[8:11], s23 offen offset:1024 lds
M a[0:3], a[188:191], a[36:39], a[0:3]
ds_read_b128 a[168:171], v10 offset:34816
ds_read_b128 a[172:175], v11 offset:34816
M a[4:7], a[188:191], a[44:47], a[4:7]
M a[4:7], a[184:187], a[40:43], a[4:7]
M a[8:11], a[184:187], a[48:51], a[8:11]
buffer_load_dwordx4 v4, s[8:11], s23 offen offset:2048 lds
M a[8:11], a[188:191], a[52:55], a[8:11]
M a[12:15], a[188:191], a[60:63], a[12:15]
M a[12:15], a[184:187], a[56:59], a[12:15]
M a[16:19], a[184:187], a[64:67], a[16:19]
buffer_load_dwordx4 v5, s[8:11], s23 offen offset:3072 lds
M a[16:19], a[188:191], a[68:71], a[16:19]
M a[20:23], a[188:191], a[76:79], a[20:23]
M a[20:23], a[184:187], a[72:75], a[20:23]
s_sub_u32 s31, s31, 1
s_cmp_eq_u32 s31, 0
s_cselect_b32 s58, -1920, s57
s_add_u32 s23, s23, s58
s_add_u32 s24, s24, s58
M a[24:27], a[184:187], a[80:83], a[24:27]
M a[24:27], a[188:191], a[84:87], a[24:27]
M a[28:31], a[188:191], a[92:95], a[28:31]
M a[28:31], a[184:187], a[88:91], a[28:31]
s_waitcnt lgkmcnt(2)
M v[32:35], a[160:163], a[96:99], v[32:35]
s_add_u32 m0, s30, 65536
s_nop 0
buffer_load_dwordx4 v6, s[12:15], s25 offen offset:0 lds
M v[32:35], a[164:167], a[100:103], v[32:35]
ds_read_b128 a[176:179], v10 offset:36864
ds_read_b128 a[180:183], v11 offset:36864
M v[36:39], a[164:167], a[108:111], v[36:39]
M v[36:39], a[160:163], a[104:107], v[36:39]
M v[40:43], a[160:163], a[112:115], v[40:43]
M v[40:43], a[164:167], a[116:119], v[40:43]
buffer_load_dwordx4 v7, s[12:15], s25 offen offset:1024 lds
M v[44:47], a[164:167], a[124:127], v[44:47]
M v[44:47], a[160:163], a[120:123], v[44:47]
M v[48:51], a[160:163], a[128:131], v[48:51]
M v[48:51], a[164:167], a[132:135], v[48:51]
M v[52:55], a[164:167], a[140:143], v[52:55]
buffer_load_dwordx4 v8, s[12:15], s25 offen offset:2048 lds
M v[52:55], a[160:163], a[136:139], v[52:55]
M v[56:59], a[160:163], a[144:147], v[56:59]
M v[56:59], a[164:167], a[148:151], v[56:59]
M v[60:63], a[164:167], a[156:159], v[60:63]
M v[60:63], a[160:163], a[152:155], v[60:63]
s_waitcnt lgkmcnt(2)
M v[64:67], a[168:171], a[96:99], v[64:67]
buffer_load_dwordx4 v9, s[12:15], s25 offen offset:3072 lds
M v[64:67], a[172:175], a[100:103], v[64:67]
ds_read_b128 a[184:187], v10 offset:38912
ds_read_b128 a[188:191], v11 offset:38912
M v[68:71], a[172:175], a[108:111], v[68:71]
M v[68:71], a[168:171], a[104:107], v[68:71]
M v[72:75], a[168:171], a[112:115], v[72:75]
M v[72:75], a[172:175], a[116:119], v[72:75]
s_add_u32 m0, s30, 69632
s_nop 0
buffer_load_dwordx4 v21, s[12:15], s25 offen offset:0 lds
M v[76:79], a[172:175], a[124:127], v[76:79]
M v[76:79], a[168:171], a[120:123], v[76:79]
M v[80:83], a[168:171], a[128:131], v[80:83]
M v[80:83], a[172:175], a[132:135], v[80:83]
M v[84:87], a[172:175], a[140:143], v[84:87]
buffer_load_dwordx4 v22, s[12:15], s25 offen offset:1024 lds
M v[84:87], a[168:171], a[136:139], v[84:87]
M v[88:91], a[168:171], a[144:147], v[88:91]
M v[88:91], a[172:175], a[148:151], v[88:91]
M v[92:95], a[172:175], a[156:159], v[92:95]
M v[92:95], a[168:171], a[152:155], v[92:95]
s_waitcnt lgkmcnt(2)
M v[96:99], a[176:179], a[96:99], v[96:99]
s_sub_u32 s54, s54, 1
s_cmp_eq_u32 s54, 0
s_cselect_b32 s58, s55, s56
s_add_u32 s25, s25, s58
M v[96:99], a[180:183], a[100:103], v[96:99]
M v[100:103], a[180:183], a[108:111], v[100:103]
M v[100:103], a[176:179], a[104:107], v[100:103]
v_cvt_pk_bf16_f32 v32, v32, v33
v_cvt_pk_bf16_f32 v33, v34, v35
M v[104:107], a[176:179], a[112:115], v[104:107]
v_cvt_pk_bf16_f32 v34, v64, v65
v_cvt_pk_bf16_f32 v35, v66, v67
M v[104:107], a[180:183], a[116:119], v[104:107]
v_cvt_pk_bf16_f32 v64, v48, v49
M v[108:111], a[180:183], a[124:127], v[108:111]
v_cvt_pk_bf16_f32 v65, v50, v51
v_cvt_pk_bf16_f32 v66, v80, v81
M v[108:111], a[176:179], a[120:123], v[108:111]
s_waitcnt vmcnt(11) lgkmcnt(0)
s_barrier
ds_read_b128 a[160:163], v10 offset:49152
ds_read_b128 a[164:167], v11 offset:49152
v_cvt_pk_bf16_f32 v67, v82, v83
M v[112:115], a[176:179], a[128:131], v[112:115]
s_add_u32 m0, s28, 0
s_mov_b32 exec_hi, 0
buffer_load_dwordx4 v20, s[8:11], s24 offen lds
s_mov_b32 exec_hi, -1
v_cvt_pk_bf16_f32 v48, v40, v41
v_cvt_pk_bf16_f32 v49, v42, v43
M v[112:115], a[180:183], a[132:135], v[112:115]
v_cvt_pk_bf16_f32 v50, v72, v73
v_cvt_pk_bf16_f32 v51, v74, v75
M v[116:119], a[180:183], a[140:143], v[116:119]
v_cvt_pk_bf16_f32 v80, v56, v57
M v[116:119], a[176:179], a[136:139], v[116:119]
v_cvt_pk_bf16_f32 v81, v58, v59
v_cvt_pk_bf16_f32 v82, v88, v89
M v[120:123], a[176:179], a[144:147], v[120:123]
s_add_u32 m0, s29, 2048
s_nop 0
buffer_load_dwordx4 v2, s[8:11], s23 offen offset:0 lds
v_cvt_pk_bf16_f32 v83, v90, v91
M v[120:123], a[180:183], a[148:151], v[120:123]
v_cvt_pk_bf16_f32 v40, v36, v37
v_cvt_pk_bf16_f32 v41, v38, v39
M v[124:127], a[180:183], a[156:159], v[124:127]
v_cvt_pk_bf16_f32 v42, v68, v69
v_cvt_pk_bf16_f32 v43, v70, v71
M v[124:127], a[176:179], a[152:155], v[124:127]
v_cvt_pk_bf16_f32 v72, v52, v53
M v[128:131], a[184:187], a[96:99], v[128:131]
v_cvt_pk_bf16_f32 v73, v54, v55
v_cvt_pk_bf16_f32 v74, v84, v85
M v[128:131], a[188:191], a[100:103], v[128:131]
ds_read_b128 a[168:171], v10 offset:51200
ds_read_b128 a[172:175], v11 offset:51200
v_cvt_pk_bf16_f32 v75, v86, v87
M v[132:135], a[188:191], a[108:111], v[132:135]
buffer_load_dwordx4 v3, s[8:11], s23 offen offset:1024 lds
v_cvt_pk_bf16_f32 v56, v44, v45
v_cvt_pk_bf16_f32 v57, v46, v47
M v[132:135], a[184:187], a[104:107], v[132:135]
v_cvt_pk_bf16_f32 v58, v76, v77
v_cvt_pk_bf16_f32 v59, v78, v79
M v[136:139], a[184:187], a[112:115], v[136:139]
v_cvt_pk_bf16_f32 v88, v60, v61
M v[136:139], a[188:191], a[116:119], v[136:139]
v_cvt_pk_bf16_f32 v89, v62, v63
v_cvt_pk_bf16_f32 v90, v92, v93
M v[140:143], a[188:191], a[124:127], v[140:143]
buffer_load_dwordx4 v4, s[8:11], s23 offen offset:2048 lds
v_cvt_pk_bf16_f32 v91, v94, v95
M v[140:143], a[184:187], a[120:123], v[140:143]
M v[144:147], a[184:187], a[128:131], v[144:147]
M v[144:147], a[188:191], a[132:135], v[144:147]
M v[148:151], a[188:191], a[140:143], v[148:151]
buffer_load_dwordx4 v5, s[8:11], s23 offen offset:3072 lds
M v[148:151], a[184:187], a[136:139], v[148:151]
M v[152:155], a[184:187], a[144:147], v[152:155]
M v[152:155], a[188:191], a[148:151], v[152:155]
M v[156:159], a[188:191], a[156:159], v[156:159]
s_sub_u32 s31, s31, 1
s_cmp_eq_u32 s31, 0
s_cselect_b32 s58, -1920, s57
s_add_u32 s23, s23, s58
s_add_u32 s24, s24, s58
M v[156:159], a[184:187], a[152:155], v[156:159]
s_waitcnt lgkmcnt(2)
M v[160:163], a[160:163], a[96:99], v[160:163]
M v[160:163], a[164:167], a[100:103], v[160:163]
ds_read_b128 a[176:179], v10 offset:53248
ds_read_b128 a[180:183], v11 offset:53248
M v[164:167], a[164:167], a[108:111], v[164:167]
M v[164:167], a[160:163], a[104:107], v[164:167]
v_cvt_pk_bf16_f32 v96, v96, v97
v_cvt_pk_bf16_f32 v97, v98, v99
M v[168:171], a[160:163], a[112:115], v[168:171]
s_add_u32 m0, s30, 98304
s_nop 0
buffer_load_dwordx4 v6, s[12:15], s25 offen offset:0 lds
v_cvt_pk_bf16_f32 v98, v128, v129
v_cvt_pk_bf16_f32 v99, v130, v131
M v[168:171], a[164:167], a[116:119], v[168:171]
v_cvt_pk_bf16_f32 v128, v112, v113
M v[172:175], a[164:167], a[124:127], v[172:175]
v_cvt_pk_bf16_f32 v129, v114, v115
v_cvt_pk_bf16_f32 v130, v144, v145
M v[172:175], a[160:163], a[120:123], v[172:175]
v_cvt_pk_bf16_f32 v131, v146, v147
M v[176:179], a[160:163], a[128:131], v[176:179]
v_cvt_pk_bf16_f32 v112, v104, v105
v_cvt_pk_bf16_f32 v113, v106, v107
M v[176:179], a[164:167], a[132:135], v[176:179]
buffer_load_dwordx4 v7, s[12:15], s25 offen offset:1024 lds
v_cvt_pk_bf16_f32 v114, v136, v137
v_cvt_pk_bf16_f32 v115, v138, v139
M v[180:183], a[164:167], a[140:143], v[180:183]
v_cvt_pk_bf16_f32 v144, v120, v121
M v[180:183], a[160:163], a[136:139], v[180:183]
v_cvt_pk_bf16_f32 v145, v122, v123
v_cvt_pk_bf16_f32 v146, v152, v153
M v[184:187], a[160:163], a[144:147], v[184:187]
v_cvt_pk_bf16_f32 v147, v154, v155
M v[184:187], a[164:167], a[148:151], v[184:187]
buffer_load_dwordx4 v8, s[12:15], s25 offen offset:2048 lds
v_cvt_pk_bf16_f32 v104, v100, v101
v_cvt_pk_bf16_f32 v105, v102, v103
M v[188:191], a[164:167], a[156:159], v[188:191]
v_cvt_pk_bf16_f32 v106, v132, v133
v_cvt_pk_bf16_f32 v107, v134, v135
M v[188:191], a[160:163], a[152:155], v[188:191]
s_waitcnt lgkmcnt(2)
v_cvt_pk_bf16_f32 v136, v116, v117
M v[192:195], a[168:171], a[96:99], v[192:195]
v_cvt_pk_bf16_f32 v137, v118, v119
v_cvt_pk_bf16_f32 v138, v148, v149
M v[192:195], a[172:175], a[100:103], v[192:195]
ds_read_b128 a[184:187], v10 offset:55296
ds_read_b128 a[188:191], v11 offset:55296
v_cvt_pk_bf16_f32 v139, v150, v151
M v[196:199], a[172:175], a[108:111], v[196:199]
v_cvt_pk_bf16_f32 v120, v108, v109
v_cvt_pk_bf16_f32 v121, v110, v111
M v[196:199], a[168:171], a[104:107], v[196:199]
buffer_load_dwordx4 v9, s[12:15], s25 offen offset:3072 lds
v_cvt_pk_bf16_f32 v122, v140, v141
v_cvt_pk_bf16_f32 v123, v142, v143
M v[200:203], a[168:171], a[112:115], v[200:203]
v_cvt_pk_bf16_f32 v152, v124, v125
M v[200:203], a[172:175], a[116:119], v[200:203]
v_cvt_pk_bf16_f32 v153, v126, v127
v_cvt_pk_bf16_f32 v154, v156, v157
M v[204:207], a[172:175], a[124:127], v[204:207]
v_cvt_pk_bf16_f32 v155, v158, v159
M v[204:207], a[168:171], a[120:123], v[204:207]
s_add_u32 m0, s30, 102400
s_nop 0
buffer_load_dwordx4 v21, s[12:15], s25 offen offset:0 lds
M v[208:211], a[168:171], a[128:131], v[208:211]
M v[208:211], a[172:175], a[132:135], v[208:211]
M v[212:215], a[172:175], a[140:143], v[212:215]
M v[212:215], a[168:171], a[136:139], v[212:215]
buffer_load_dwordx4 v22, s[12:15], s25 offen offset:1024 lds
M v[216:219], a[168:171], a[144:147], v[216:219]
M v[216:219], a[172:175], a[148:151], v[216:219]
M v[220:223], a[172:175], a[156:159], v[220:223]
M v[220:223], a[168:171], a[152:155], v[220:223]
s_waitcnt lgkmcnt(2)
M v[224:227], a[176:179], a[96:99], v[224:227]
s_sub_u32 s54, s54, 1
s_cmp_eq_u32 s54, 0
s_cselect_b32 s58, s55, s56
s_add_u32 s25, s25, s58
M v[224:227], a[180:183], a[100:103], v[224:227]
M v[228:231], a[180:183], a[108:111], v[228:231]
M v[228:231], a[176:179], a[104:107], v[228:231]
v_cvt_pk_bf16_f32 v160, v160, v161
v_cvt_pk_bf16_f32 v161, v162, v163
M v[232:235], a[176:179], a[112:115], v[232:235]
v_cvt_pk_bf16_f32 v162, v192, v193
v_cvt_pk_bf16_f32 v163, v194, v195
M v[232:235], a[180:183], a[116:119], v[232:235]
v_cvt_pk_bf16_f32 v192, v176, v177
M v[236:239], a[180:183], a[124:127], v[236:239]
v_cvt_pk_bf16_f32 v193, v178, v179
v_cvt_pk_bf16_f32 v194, v208, v209
M v[236:239], a[176:179], a[120:123], v[236:239]
s_waitcnt vmcnt(63) lgkmcnt(0)
s_barrier
v_cvt_pk_bf16_f32 v195, v210, v211
M v[240:243], a[176:179], a[128:131], v[240:243]
s_add_u32 m0, s28, 18432
s_mov_b32 exec_hi, 0
buffer_load_dwordx4 v20, s[8:11], s24 offen lds
s_mov_b32 exec_hi, -1
v_cvt_pk_bf16_f32 v176, v168, v169
v_cvt_pk_bf16_f32 v177, v170, v171
M v[240:243], a[180:183], a[132:135], v[240:243]
v_cvt_pk_bf16_f32 v178, v200, v201
v_cvt_pk_bf16_f32 v179, v202, v203
M v[244:247], a[180:183], a[140:143], v[244:247]
v_cvt_pk_bf16_f32 v208, v184, v185
M v[244:247], a[176:179], a[136:139], v[244:247]
s_add_u32 m0, s29, 20480
s_nop 0
buffer_load_dwordx4 v2, s[8:11], s23 offen offset:0 lds
v_cvt_pk_bf16_f32 v209, v186, v187
v_cvt_pk_bf16_f32 v210, v216, v217
M v[248:251], a[176:179], a[144:147], v[248:251]
v_cvt_pk_bf16_f32 v211, v218, v219
M v[248:251], a[180:183], a[148:151], v[248:251]
v_cvt_pk_bf16_f32 v168, v164, v165
v_cvt_pk_bf16_f32 v169, v166, v167
M v[252:255], a[180:183], a[156:159], v[252:255]
v_cvt_pk_bf16_f32 v170, v196, v197
v_cvt_pk_bf16_f32 v171, v198, v199
M v[252:255], a[176:179], a[152:155], v[252:255]
v_cvt_pk_bf16_f32 v200, v180, v181
M a[0:3], a[184:187], a[96:99], a[0:3]
buffer_load_dwordx4 v3, s[8:11], s23 offen offset:1024 lds
v_cvt_pk_bf16_f32 v201, v182, v183
v_cvt_pk_bf16_f32 v202, v212, v213
M a[0:3], a[188:191], a[100:103], a[0:3]
v_cvt_pk_bf16_f32 v203, v214, v215
M a[4:7], a[188:191], a[108:111], a[4:7]
v_cvt_pk_bf16_f32 v184, v172, v173
v_cvt_pk_bf16_f32 v185, v174, v175
M a[4:7], a[184:187], a[104:107], a[4:7]
v_cvt_pk_bf16_f32 v186, v204, v205
v_cvt_pk_bf16_f32 v187, v206, v207
M a[8:11], a[184:187], a[112:115], a[8:11]
buffer_load_dwordx4 v4, s[8:11], s23 offen offset:2048 lds
v_cvt_pk_bf16_f32 v216, v188, v189
M a[8:11], a[188:191], a[116:119], a[8:11]
v_cvt_pk_bf16_f32 v217, v190, v191
v_cvt_pk_bf16_f32 v218, v220, v221
M a[12:15], a[188:191], a[124:127], a[12:15]
v_cvt_pk_bf16_f32 v219, v222, v223
M a[12:15], a[184:187], a[120:123], a[12:15]
buffer_load_dwordx4 v5, s[8:11], s23 offen offset:3072 lds
M a[16:19], a[184:187], a[128:131], a[16:19]
M a[16:19], a[188:191], a[132:135], a[16:19]
M a[20:23], a[188:191], a[140:143], a[20:23]
M a[20:23], a[184:187], a[136:139], a[20:23]
s_sub_u32 s31, s31, 1
s_cmp_eq_u32 s31, 0
s_cselect_b32 s58, -1920, s57
s_add_u32 s23, s23, s58
s_add_u32 s24, s24, s58
M a[24:27], a[184:187], a[144:147], a[24:27]
M a[24:27], a[188:191], a[148:151], a[24:27]
M a[28:31], a[188:191], a[156:159], a[28:31]
M a[28:31], a[184:187], a[152:155], a[28:31]
v_accvgpr_read_b32 v24, a0
v_accvgpr_read_b32 v25, a1
v_accvgpr_read_b32 v26, a2
v_accvgpr_read_b32 v27, a3
v_cvt_pk_bf16_f32 v224, v224, v225
v_cvt_pk_bf16_f32 v225, v226, v227
v_cvt_pk_bf16_f32 v226, v24, v25
v_cvt_pk_bf16_f32 v227, v26, v27
v_accvgpr_read_b32 v24, a16
v_accvgpr_read_b32 v25, a17
v_accvgpr_read_b32 v26, a18
v_accvgpr_read_b32 v27, a19
v_cvt_pk_bf16_f32 v36, v240, v241
v_cvt_pk_bf16_f32 v37, v242, v243
v_cvt_pk_bf16_f32 v38, v24, v25
v_cvt_pk_bf16_f32 v39, v26, v27
v_accvgpr_read_b32 v24, a24
v_accvgpr_read_b32 v25, a25
v_accvgpr_read_b32 v26, a26
v_accvgpr_read_b32 v27, a27
v_cvt_pk_bf16_f32 v52, v248, v249
v_cvt_pk_bf16_f32 v53, v250, v251
v_cvt_pk_bf16_f32 v54, v24, v25
v_cvt_pk_bf16_f32 v55, v26, v27
v_accvgpr_read_b32 v24, a8
v_accvgpr_read_b32 v25, a9
v_accvgpr_read_b32 v26, a10
v_accvgpr_read_b32 v27, a11
v_cvt_pk_bf16_f32 v240, v232, v233
v_cvt_pk_bf16_f32 v241, v234, v235
v_cvt_pk_bf16_f32 v242, v24, v25
v_cvt_pk_bf16_f32 v243, v26, v27
v_accvgpr_read_b32 v28, a4
v_accvgpr_read_b32 v29, a5
v_accvgpr_read_b32 v30, a6
v_accvgpr_read_b32 v31, a7
v_cvt_pk_bf16_f32 v232, v228, v229
v_cvt_pk_bf16_f32 v233, v230, v231
v_cvt_pk_bf16_f32 v234, v28, v29
v_cvt_pk_bf16_f32 v235, v30, v31
v_accvgpr_read_b32 v28, a12
v_accvgpr_read_b32 v29, a13
v_accvgpr_read_b32 v30, a14
v_accvgpr_read_b32 v31, a15
v_cvt_pk_bf16_f32 v248, v236, v237
v_cvt_pk_bf16_f32 v249, v238, v239
v_cvt_pk_bf16_f32 v250, v28, v29
v_cvt_pk_bf16_f32 v251, v30, v31
v_accvgpr_read_b32 v28, a20
v_accvgpr_read_b32 v29, a21
v_accvgpr_read_b32 v30, a22
v_accvgpr_read_b32 v31, a23
v_cvt_pk_bf16_f32 v44, v244, v245
v_cvt_pk_bf16_f32 v45, v246, v247
v_cvt_pk_bf16_f32 v46, v28, v29
v_cvt_pk_bf16_f32 v47, v30, v31
v_accvgpr_read_b32 v28, a28
v_accvgpr_read_b32 v29, a29
v_accvgpr_read_b32 v30, a30
v_accvgpr_read_b32 v31, a31
v_cvt_pk_bf16_f32 v60, v252, v253
v_cvt_pk_bf16_f32 v61, v254, v255
v_cvt_pk_bf16_f32 v62, v28, v29
v_cvt_pk_bf16_f32 v63, v30, v31
Lk1_b:
v_and_b32 v24, 15, v0
v_lshlrev_b32 v24, 7, v24
v_bfe_u32 v25, v0, 1, 3
v_lshrrev_b32 v26, 4, v0
v_xor_b32 v25, v25, v26
v_lshl_add_u32 v10, v25, 4, v24
v_xor_b32 v11, 64, v10
v_add_u32 v12, 131072, v10
v_add_u32 v13, 131072, v11
v_bfe_u32 v24, v0, 2, 2
v_lshl_add_u32 v29, v26, 3, v24
v_mul_u32_u24 v25, 384, v29
v_and_b32 v27, 1, v0
v_lshl_add_u32 v25, v27, 3, v25
v_add_u32 v25, 36864, v25
v_lshrrev_b32 v24, 1, v29
v_and_b32 v24, 4, v24
v_and_or_b32 v24, v29, 2, v24
v_bfe_u32 v26, v0, 1, 1
s_mul_i32 s4, s20, 3
s_add_u32 s3, s4, 0
s_and_b32 s5, s3, 3
s_lshl_b32 s5, s5, 1
s_lshr_b32 s3, s3, 2
s_lshl_b32 s3, s3, 7
v_add_u32 v27, s5, v26
v_xor_b32 v27, v27, v24
v_lshl_add_u32 v27, v27, 4, v25
v_add_u32 v14, s3, v27
v_add_u32 v17, 61440, v14
s_add_u32 s3, s4, 1
s_and_b32 s5, s3, 3
s_lshl_b32 s5, s5, 1
s_lshr_b32 s3, s3, 2
s_lshl_b32 s3, s3, 7
v_add_u32 v27, s5, v26
v_xor_b32 v27, v27, v24
v_lshl_add_u32 v27, v27, 4, v25
v_add_u32 v15, s3, v27
v_add_u32 v18, 61440, v15
s_add_u32 s3, s4, 2
s_and_b32 s5, s3, 3
s_lshl_b32 s5, s5, 1
s_lshr_b32 s3, s3, 2
s_lshl_b32 s3, s3, 7
v_add_u32 v27, s5, v26
v_xor_b32 v27, v27, v24
v_lshl_add_u32 v27, v27, 4, v25
v_add_u32 v16, s3, v27
v_add_u32 v19, 61440, v16
s_waitcnt vmcnt(5)
s_barrier
ds_read_b64_tr_b16 a[176:177], v14 offset:28672
ds_read_b64_tr_b16 a[178:179], v14 offset:30208
ds_read_b64_tr_b16 a[184:185], v15 offset:28672
ds_read_b64_tr_b16 a[186:187], v15 offset:30208
ds_read_b64_tr_b16 a[192:193], v16 offset:28672
ds_read_b64_tr_b16 a[194:195], v16 offset:30208
ds_read_b64_tr_b16 a[180:181], v14 offset:40960
ds_read_b64_tr_b16 a[182:183], v14 offset:42496
ds_read_b64_tr_b16 a[188:189], v15 offset:40960
ds_read_b64_tr_b16 a[190:191], v15 offset:42496
ds_read_b64_tr_b16 a[196:197], v16 offset:40960
ds_read_b64_tr_b16 a[198:199], v16 offset:42496
ds_read_b128 a[224:227], v12 offset:0
ds_read_b128 a[228:231], v13 offset:0
ds_read_b128 a[232:235], v12 offset:2048
ds_read_b128 a[236:239], v13 offset:2048
ds_read_b128 a[240:243], v12 offset:4096
ds_read_b128 a[244:247], v13 offset:4096
s_waitcnt lgkmcnt(0)
s_barrier
M a[68:71], a[176:179], a[224:227], 0
ds_read_b128 a[248:251], v12 offset:6144
ds_read_b128 a[252:255], v13 offset:6144
M a[68:71], a[180:183], a[228:231], a[68:71]
s_add_u32 m0, s30, 36864
s_nop 0
buffer_load_dwordx4 v6, s[12:15], s25 offen offset:0 lds
M a[72:75], a[188:191], a[228:231], 0
ds_read_b64_tr_b16 a[200:201], v17 offset:0
ds_read_b64_tr_b16 a[202:203], v17 offset:1536
M a[72:75], a[184:187], a[224:227], a[72:75]
buffer_load_dwordx4 v7, s[12:15], s25 offen offset:1024 lds
M a[76:79], a[192:195], a[224:227], 0
M a[76:79], a[196:199], a[228:231], a[76:79]
buffer_load_dwordx4 v8, s[12:15], s25 offen offset:2048 lds
M a[80:83], a[180:183], a[236:239], 0
ds_read_b128 a[224:227], v12 offset:8192
ds_read_b128 a[228:231], v13 offset:8192
M a[80:83], a[176:179], a[232:235], a[80:83]
M a[84:87], a[184:187], a[232:235], 0
ds_read_b64_tr_b16 a[208:209], v18 offset:0
ds_read_b64_tr_b16 a[210:211], v18 offset:1536
M a[84:87], a[188:191], a[236:239], a[84:87]
buffer_load_dwordx4 v9, s[12:15], s25 offen offset:3072 lds
M a[88:91], a[196:199], a[236:239], 0
M a[88:91], a[192:195], a[232:235], a[88:91]
s_add_u32 m0, s30, 40960
s_nop 0
buffer_load_dwordx4 v21, s[12:15], s25 offen offset:0 lds
M a[92:95], a[176:179], a[240:243], 0
ds_read_b128 a[232:235], v12 offset:10240
ds_read_b128 a[236:239], v13 offset:10240
M a[92:95], a[180:183], a[244:247], a[92:95]
M a[96:99], a[188:191], a[244:247], 0
ds_read_b64_tr_b16 a[216:217], v19 offset:0
ds_read_b64_tr_b16 a[218:219], v19 offset:1536
M a[96:99], a[184:187], a[240:243], a[96:99]
buffer_load_dwordx4 v22, s[12:15], s25 offen offset:1024 lds
M a[100:103], a[192:195], a[240:243], 0
M a[100:103], a[196:199], a[244:247], a[100:103]
s_sub_u32 s54, s54, 1
s_cmp_eq_u32 s54, 0
s_cselect_b32 s58, s55, s56
s_add_u32 s25, s25, s58
s_waitcnt lgkmcnt(10)
M a[104:107], a[180:183], a[252:255], 0
ds_read_b128 a[240:243], v12 offset:12288
ds_read_b128 a[244:247], v13 offset:12288
M a[104:107], a[176:179], a[248:251], a[104:107]
M a[108:111], a[184:187], a[248:251], 0
ds_read_b64_tr_b16 a[204:205], v17 offset:12288
ds_read_b64_tr_b16 a[206:207], v17 offset:13824
M a[108:111], a[188:191], a[252:255], a[108:111]
s_add_u32 m0, s30, 65536
s_nop 0
buffer_load_dwordx4 v6, s[12:15], s25 offen offset:0 lds
M a[112:115], a[196:199], a[252:255], 0
M a[112:115], a[192:195], a[248:251], a[112:115]
buffer_load_dwordx4 v7, s[12:15], s25 offen offset:1024 lds
s_waitcnt lgkmcnt(10)
M a[116:119], a[176:179], a[224:227], 0
ds_read_b128 a[248:251], v12 offset:14336
ds_read_b128 a[252:255], v13 offset:14336
M a[116:119], a[180:183], a[228:231], a[116:119]
M a[120:123], a[188:191], a[228:231], 0
ds_read_b64_tr_b16 a[212:213], v18 offset:12288
ds_read_b64_tr_b16 a[214:215], v18 offset:13824
M a[120:123], a[184:187], a[224:227], a[120:123]
buffer_load_dwordx4 v8, s[12:15], s25 offen offset:2048 lds
M a[124:127], a[192:195], a[224:227], 0
M a[124:127], a[196:199], a[228:231], a[124:127]
buffer_load_dwordx4 v9, s[12:15], s25 offen offset:3072 lds
s_waitcnt lgkmcnt(10)
M a[128:131], a[180:183], a[236:239], 0
ds_read_b128 a[224:227], v12 offset:16384
ds_read_b128 a[228:231], v13 offset:16384
M a[128:131], a[176:179], a[232:235], a[128:131]
M a[132:135], a[184:187], a[232:235], 0
ds_read_b64_tr_b16 a[220:221], v19 offset:12288
ds_read_b64_tr_b16 a[222:223], v19 offset:13824
M a[132:135], a[188:191], a[236:239], a[132:135]
s_add_u32 m0, s30, 69632
s_nop 0
buffer_load_dwordx4 v21, s[12:15], s25 offen offset:0 lds
M a[136:139], a[196:199], a[236:239], 0
M a[136:139], a[192:195], a[232:235], a[136:139]
buffer_load_dwordx4 v22, s[12:15], s25 offen offset:1024 lds
s_waitcnt lgkmcnt(10)
M a[140:143], a[176:179], a[240:243], 0
M a[140:143], a[180:183], a[244:247], a[140:143]
s_sub_u32 s54, s54, 1
s_cmp_eq_u32 s54, 0
s_cselect_b32 s58, s55, s56
s_add_u32 s25, s25, s58
M a[144:147], a[188:191], a[244:247], 0
M a[144:147], a[184:187], a[240:243], a[144:147]
M a[148:151], a[192:195], a[240:243], 0
s_waitcnt vmcnt(6) lgkmcnt(0)
s_barrier
ds_read_b128 a[232:235], v10 offset:0
ds_read_b128 a[236:239], v11 offset:0
M a[148:151], a[196:199], a[244:247], a[148:151]
s_add_u32 s94, s92, 0
buffer_store_dwordx4 v[32:35], v1, s[16:19], s94 offen offset:0 sc1
M a[152:155], a[180:183], a[252:255], 0
ds_read_b128 a[240:243], v10 offset:2048
ds_read_b128 a[244:247], v11 offset:2048
M a[152:155], a[176:179], a[248:251], a[152:155]
M a[156:159], a[184:187], a[248:251], 0
s_add_u32 s94, s92, 0
buffer_store_dwordx4 v[40:43], v1, s[16:19], s94 offen offset:1024 sc1
M a[156:159], a[188:191], a[252:255], a[156:159]
M a[160:163], a[196:199], a[252:255], 0
M a[160:163], a[192:195], a[248:251], a[160:163]
s_add_u32 s94, s92, 0
buffer_store_dwordx4 v[48:51], v1, s[16:19], s94 offen offset:2048 sc1
M a[164:167], a[176:179], a[224:227], 0
ds_read_b128 a[248:251], v10 offset:4096
ds_read_b128 a[252:255], v11 offset:4096
M a[164:167], a[180:183], a[228:231], a[164:167]
M a[168:171], a[188:191], a[228:231], 0
M a[168:171], a[184:187], a[224:227], a[168:171]
s_add_u32 s94, s92, 0
buffer_store_dwordx4 v[56:59], v1, s[16:19], s94 offen offset:3072 sc1
M a[172:175], a[192:195], a[224:227], 0
M a[172:175], a[196:199], a[228:231], a[172:175]
s_waitcnt lgkmcnt(4)
M a[68:71], a[200:203], a[232:235], a[68:71]
ds_read_b128 a[224:227], v10 offset:6144
ds_read_b128 a[228:231], v11 offset:6144
M a[68:71], a[204:207], a[236:239], a[68:71]
s_add_u32 m0, s28, 131072
s_mov_b32 exec_hi, 0
buffer_load_dwordx4 v20, s[8:11], s24 offen lds
s_mov_b32 exec_hi, -1
M a[72:75], a[212:215], a[236:239], a[72:75]
ds_read_b64_tr_b16 a[176:177], v14 offset:0
ds_read_b64_tr_b16 a[178:179], v14 offset:1536
M a[72:75], a[208:211], a[232:235], a[72:75]
M a[76:79], a[216:219], a[232:235], a[76:79]
s_add_u32 m0, s29, 133120
s_nop 0
buffer_load_dwordx4 v2, s[8:11], s23 offen offset:0 lds
M a[76:79], a[220:223], a[236:239], a[76:79]
s_waitcnt lgkmcnt(6)
M a[80:83], a[204:207], a[244:247], a[80:83]
ds_read_b128 a[232:235], v10 offset:8192
ds_read_b128 a[236:239], v11 offset:8192
M a[80:83], a[200:203], a[240:243], a[80:83]
buffer_load_dwordx4 v3, s[8:11], s23 offen offset:1024 lds
M a[84:87], a[208:211], a[240:243], a[84:87]
ds_read_b64_tr_b16 a[184:185], v15 offset:0
ds_read_b64_tr_b16 a[186:187], v15 offset:1536
M a[84:87], a[212:215], a[244:247], a[84:87]
M a[88:91], a[220:223], a[244:247], a[88:91]
buffer_load_dwordx4 v4, s[8:11], s23 offen offset:2048 lds
M a[88:91], a[216:219], a[240:243], a[88:91]
s_waitcnt lgkmcnt(8)
M a[92:95], a[200:203], a[248:251], a[92:95]
ds_read_b128 a[240:243], v10 offset:10240
ds_read_b128 a[244:247], v11 offset:10240
M a[92:95], a[204:207], a[252:255], a[92:95]
buffer_load_dwordx4 v5, s[8:11], s23 offen offset:3072 lds
M a[96:99], a[212:215], a[252:255], a[96:99]
ds_read_b64_tr_b16 a[192:193], v16 offset:0
ds_read_b64_tr_b16 a[194:195], v16 offset:1536
M a[96:99], a[208:211], a[248:251], a[96:99]
M a[100:103], a[216:219], a[248:251], a[100:103]
s_sub_u32 s31, s31, 1
s_cmp_eq_u32 s31, 0
s_cselect_b32 s58, -1920, s57
s_add_u32 s23, s23, s58
s_add_u32 s24, s24, s58
M a[100:103], a[220:223], a[252:255], a[100:103]
s_waitcnt lgkmcnt(10)
M a[104:107], a[204:207], a[228:231], a[104:107]
ds_read_b128 a[248:251], v10 offset:12288
ds_read_b128 a[252:255], v11 offset:12288
M a[104:107], a[200:203], a[224:227], a[104:107]
s_add_u32 m0, s30, 98304
s_nop 0
buffer_load_dwordx4 v6, s[12:15], s25 offen offset:0 lds
M a[108:111], a[208:211], a[224:227], a[108:111]
ds_read_b64_tr_b16 a[180:181], v14 offset:12288
ds_read_b64_tr_b16 a[182:183], v14 offset:13824
M a[108:111], a[212:215], a[228:231], a[108:111]
M a[112:115], a[220:223], a[228:231], a[112:115]
buffer_load_dwordx4 v7, s[12:15], s25 offen offset:1024 lds
M a[112:115], a[216:219], a[224:227], a[112:115]
s_waitcnt lgkmcnt(10)
M a[116:119], a[200:203], a[232:235], a[116:119]
ds_read_b128 a[224:227], v10 offset:14336
ds_read_b128 a[228:231], v11 offset:14336
M a[116:119], a[204:207], a[236:239], a[116:119]
buffer_load_dwordx4 v8, s[12:15], s25 offen offset:2048 lds
M a[120:123], a[212:215], a[236:239], a[120:123]
ds_read_b64_tr_b16 a[188:189], v15 offset:12288
ds_read_b64_tr_b16 a[190:191], v15 offset:13824
M a[120:123], a[208:211], a[232:235], a[120:123]
M a[124:127], a[216:219], a[232:235], a[124:127]
buffer_load_dwordx4 v9, s[12:15], s25 offen offset:3072 lds
M a[124:127], a[220:223], a[236:239], a[124:127]
s_waitcnt lgkmcnt(10)
M a[128:131], a[204:207], a[244:247], a[128:131]
ds_read_b128 a[232:235], v10 offset:16384
ds_read_b128 a[236:239], v11 offset:16384
M a[128:131], a[200:203], a[240:243], a[128:131]
s_add_u32 m0, s30, 102400
s_nop 0
buffer_load_dwordx4 v21, s[12:15], s25 offen offset:0 lds
M a[132:135], a[208:211], a[240:243], a[132:135]
ds_read_b64_tr_b16 a[196:197], v16 offset:12288
ds_read_b64_tr_b16 a[198:199], v16 offset:13824
M a[132:135], a[212:215], a[244:247], a[132:135]
M a[136:139], a[220:223], a[244:247], a[136:139]
buffer_load_dwordx4 v22, s[12:15], s25 offen offset:1024 lds
M a[136:139], a[216:219], a[240:243], a[136:139]
s_waitcnt lgkmcnt(10)
M a[140:143], a[200:203], a[248:251], a[140:143]
s_sub_u32 s54, s54, 1
s_cmp_eq_u32 s54, 0
s_cselect_b32 s58, s55, s56
s_add_u32 s25, s25, s58
M a[140:143], a[204:207], a[252:255], a[140:143]
M a[144:147], a[212:215], a[252:255], a[144:147]
M a[144:147], a[208:211], a[248:251], a[144:147]
M a[148:151], a[216:219], a[248:251], a[148:151]
s_waitcnt vmcnt(15) lgkmcnt(0)
s_barrier
ds_read_b128 a[240:243], v10 offset:18432
ds_read_b128 a[244:247], v11 offset:18432
M a[148:151], a[220:223], a[252:255], a[148:151]
s_add_u32 s94, s92, 4096
buffer_store_dwordx4 v[64:67], v1, s[16:19], s94 offen offset:0 sc1
M a[152:155], a[204:207], a[228:231], a[152:155]
ds_read_b128 a[248:251], v10 offset:20480
ds_read_b128 a[252:255], v11 offset:20480
M a[152:155], a[200:203], a[224:227], a[152:155]
M a[156:159], a[208:211], a[224:227], a[156:159]
s_add_u32 s94, s92, 4096
buffer_store_dwordx4 v[72:75], v1, s[16:19], s94 offen offset:1024 sc1
M a[156:159], a[212:215], a[228:231], a[156:159]
M a[160:163], a[220:223], a[228:231], a[160:163]
M a[160:163], a[216:219], a[224:227], a[160:163]
s_add_u32 s94, s92, 4096
buffer_store_dwordx4 v[80:83], v1, s[16:19], s94 offen offset:2048 sc1
M a[164:167], a[200:203], a[232:235], a[164:167]
ds_read_b128 a[224:227], v10 offset:22528
ds_read_b128 a[228:231], v11 offset:22528
M a[164:167], a[204:207], a[236:239], a[164:167]
M a[168:171], a[212:215], a[236:239], a[168:171]
M a[168:171], a[208:211], a[232:235], a[168:171]
s_add_u32 s94, s92, 4096
buffer_store_dwordx4 v[88:91], v1, s[16:19], s94 offen offset:3072 sc1
M a[172:175], a[216:219], a[232:235], a[172:175]
M a[172:175], a[220:223], a[236:239], a[172:175]
s_waitcnt lgkmcnt(4)
M a[68:71], a[176:179], a[240:243], a[68:71]
ds_read_b128 a[232:235], v10 offset:24576
ds_read_b128 a[236:239], v11 offset:24576
M a[68:71], a[180:183], a[244:247], a[68:71]
s_add_u32 m0, s28, 0
s_mov_b32 exec_hi, 0
buffer_load_dwordx4 v20, s[8:11], s24 offen lds
s_mov_b32 exec_hi, -1
M a[72:75], a[188:191], a[244:247], a[72:75]
ds_read_b64_tr_b16 a[200:201], v14 offset:28672
ds_read_b64_tr_b16 a[202:203], v14 offset:30208
M a[72:75], a[184:187], a[240:243], a[72:75]
M a[76:79], a[192:195], a[240:243], a[76:79]
s_add_u32 m0, s29, 2048
s_nop 0
buffer_load_dwordx4 v2, s[8:11], s23 offen offset:0 lds
M a[76:79], a[196:199], a[244:247], a[76:79]
s_waitcnt lgkmcnt(6)
M a[80:83], a[180:183], a[252:255], a[80:83]
ds_read_b128 a[240:243], v10 offset:26624
ds_read_b128 a[244:247], v11 offset:26624
M a[80:83], a[176:179], a[248:251], a[80:83]
buffer_load_dwordx4 v3, s[8:11], s23 offen offset:1024 lds
M a[84:87], a[184:187], a[248:251], a[84:87]
ds_read_b64_tr_b16 a[208:209], v15 offset:28672
ds_read_b64_tr_b16 a[210:211], v15 offset:30208
M a[84:87], a[188:191], a[252:255], a[84:87]
M a[88:91], a[196:199], a[252:255], a[88:91]
buffer_load_dwordx4 v4, s[8:11], s23 offen offset:2048 lds
M a[88:91], a[192:195], a[248:251], a[88:91]
s_waitcnt lgkmcnt(8)
M a[92:95], a[176:179], a[224:227], a[92:95]
ds_read_b128 a[248:251], v10 offset:28672
ds_read_b128 a[252:255], v11 offset:28672
M a[92:95], a[180:183], a[228:231], a[92:95]
buffer_load_dwordx4 v5, s[8:11], s23 offen offset:3072 lds
M a[96:99], a[188:191], a[228:231], a[96:99]
ds_read_b64_tr_b16 a[216:217], v16 offset:28672
ds_read_b64_tr_b16 a[218:219], v16 offset:30208
M a[96:99], a[184:187], a[224:227], a[96:99]
M a[100:103], a[192:195], a[224:227], a[100:103]
s_sub_u32 s31, s31, 1
s_cmp_eq_u32 s31, 0
s_cselect_b32 s58, -1920, s57
s_add_u32 s23, s23, s58
s_add_u32 s24, s24, s58
M a[100:103], a[196:199], a[228:231], a[100:103]
s_waitcnt lgkmcnt(10)
M a[104:107], a[180:183], a[236:239], a[104:107]
ds_read_b128 a[224:227], v10 offset:30720
ds_read_b128 a[228:231], v11 offset:30720
M a[104:107], a[176:179], a[232:235], a[104:107]
s_add_u32 m0, s30, 36864
s_nop 0
buffer_load_dwordx4 v6, s[12:15], s25 offen offset:0 lds
M a[108:111], a[184:187], a[232:235], a[108:111]
ds_read_b64_tr_b16 a[204:205], v14 offset:40960
ds_read_b64_tr_b16 a[206:207], v14 offset:42496
M a[108:111], a[188:191], a[236:239], a[108:111]
M a[112:115], a[196:199], a[236:239], a[112:115]
buffer_load_dwordx4 v7, s[12:15], s25 offen offset:1024 lds
M a[112:115], a[192:195], a[232:235], a[112:115]
s_waitcnt lgkmcnt(10)
M a[116:119], a[176:179], a[240:243], a[116:119]
ds_read_b128 a[232:235], v10 offset:32768
ds_read_b128 a[236:239], v11 offset:32768
M a[116:119], a[180:183], a[244:247], a[116:119]
buffer_load_dwordx4 v8, s[12:15], s25 offen offset:2048 lds
M a[120:123], a[188:191], a[244:247], a[120:123]
ds_read_b64_tr_b16 a[212:213], v15 offset:40960
ds_read_b64_tr_b16 a[214:215], v15 offset:42496
M a[120:123], a[184:187], a[240:243], a[120:123]
M a[124:127], a[192:195], a[240:243], a[124:127]
buffer_load_dwordx4 v9, s[12:15], s25 offen offset:3072 lds
M a[124:127], a[196:199], a[244:247], a[124:127]
s_waitcnt lgkmcnt(10)
M a[128:131], a[180:183], a[252:255], a[128:131]
ds_read_b128 a[240:243], v10 offset:34816
ds_read_b128 a[244:247], v11 offset:34816
M a[128:131], a[176:179], a[248:251], a[128:131]
s_add_u32 m0, s30, 40960
s_nop 0
buffer_load_dwordx4 v21, s[12:15], s25 offen offset:0 lds
M a[132:135], a[184:187], a[248:251], a[132:135]
ds_read_b64_tr_b16 a[220:221], v16 offset:40960
ds_read_b64_tr_b16 a[222:223], v16 offset:42496
M a[132:135], a[188:191], a[252:255], a[132:135]
M a[136:139], a[196:199], a[252:255], a[136:139]
buffer_load_dwordx4 v22, s[12:15], s25 offen offset:1024 lds
M a[136:139], a[192:195], a[248:251], a[136:139]
s_waitcnt lgkmcnt(10)
M a[140:143], a[176:179], a[224:227], a[140:143]
s_sub_u32 s54, s54, 1
s_cmp_eq_u32 s54, 0
s_cselect_b32 s58, s55, s56
s_add_u32 s25, s25, s58
M a[140:143], a[180:183], a[228:231], a[140:143]
M a[144:147], a[188:191], a[228:231], a[144:147]
M a[144:147], a[184:187], a[224:227], a[144:147]
M a[148:151], a[192:195], a[224:227], a[148:151]
s_waitcnt vmcnt(15) lgkmcnt(0)
s_barrier
ds_read_b128 a[248:251], v12 offset:0
ds_read_b128 a[252:255], v13 offset:0
M a[148:151], a[196:199], a[228:231], a[148:151]
s_add_u32 s94, s92, 8192
buffer_store_dwordx4 v[96:99], v1, s[16:19], s94 offen offset:0 sc1
M a[152:155], a[180:183], a[236:239], a[152:155]
ds_read_b128 a[224:227], v12 offset:2048
ds_read_b128 a[228:231], v13 offset:2048
M a[152:155], a[176:179], a[232:235], a[152:155]
M a[156:159], a[184:187], a[232:235], a[156:159]
s_add_u32 s94, s92, 8192
buffer_store_dwordx4 v[104:107], v1, s[16:19], s94 offen offset:1024 sc1
M a[156:159], a[188:191], a[236:239], a[156:159]
M a[160:163], a[196:199], a[236:239], a[160:163]
M a[160:163], a[192:195], a[232:235], a[160:163]
s_add_u32 s94, s92, 8192
buffer_store_dwordx4 v[112:115], v1, s[16:19], s94 offen offset:2048 sc1
M a[164:167], a[176:179], a[240:243], a[164:167]
ds_read_b128 a[232:235], v12 offset:4096
ds_read_b128 a[236:239], v13 offset:4096
M a[164:167], a[180:183], a[244:247], a[164:167]
M a[168:171], a[188:191], a[244:247], a[168:171]
M a[168:171], a[184:187], a[240:243], a[168:171]
s_add_u32 s94, s92, 8192
buffer_store_dwordx4 v[120:123], v1, s[16:19], s94 offen offset:3072 sc1
M a[172:175], a[192:195], a[240:243], a[172:175]
M a[172:175], a[196:199], a[244:247], a[172:175]
s_waitcnt lgkmcnt(4)
M a[68:71], a[200:203], a[248:251], a[68:71]
ds_read_b128 a[240:243], v12 offset:6144
ds_read_b128 a[244:247], v13 offset:6144
M a[68:71], a[204:207], a[252:255], a[68:71]
s_add_u32 m0, s28, 18432
s_mov_b32 exec_hi, 0
buffer_load_dwordx4 v20, s[8:11], s24 offen lds
s_mov_b32 exec_hi, -1
M a[72:75], a[212:215], a[252:255], a[72:75]
ds_read_b64_tr_b16 a[176:177], v17 offset:0
ds_read_b64_tr_b16 a[178:179], v17 offset:1536
M a[72:75], a[208:211], a[248:251], a[72:75]
M a[76:79], a[216:219], a[248:251], a[76:79]
s_add_u32 m0, s29, 20480
s_nop 0
buffer_load_dwordx4 v2, s[8:11], s23 offen offset:0 lds
M a[76:79], a[220:223], a[252:255], a[76:79]
s_waitcnt lgkmcnt(6)
M a[80:83], a[204:207], a[228:231], a[80:83]
ds_read_b128 a[248:251], v12 offset:8192
ds_read_b128 a[252:255], v13 offset:8192
M a[80:83], a[200:203], a[224:227], a[80:83]
buffer_load_dwordx4 v3, s[8:11], s23 offen offset:1024 lds
M a[84:87], a[208:211], a[224:227], a[84:87]
ds_read_b64_tr_b16 a[184:185], v18 offset:0
ds_read_b64_tr_b16 a[186:187], v18 offset:1536
M a[84:87], a[212:215], a[228:231], a[84:87]
M a[88:91], a[220:223], a[228:231], a[88:91]
buffer_load_dwordx4 v4, s[8:11], s23 offen offset:2048 lds
M a[88:91], a[216:219], a[224:227], a[88:91]
s_waitcnt lgkmcnt(8)
M a[92:95], a[200:203], a[232:235], a[92:95]
ds_read_b128 a[224:227], v12 offset:10240
ds_read_b128 a[228:231], v13 offset:10240
M a[92:95], a[204:207], a[236:239], a[92:95]
buffer_load_dwordx4 v5, s[8:11], s23 offen offset:3072 lds
M a[96:99], a[212:215], a[236:239], a[96:99]
ds_read_b64_tr_b16 a[192:193], v19 offset:0
ds_read_b64_tr_b16 a[194:195], v19 offset:1536
M a[96:99], a[208:211], a[232:235], a[96:99]
M a[100:103], a[216:219], a[232:235], a[100:103]
s_sub_u32 s31, s31, 1
s_cmp_eq_u32 s31, 0
s_cselect_b32 s58, -1920, s57
s_add_u32 s23, s23, s58
s_add_u32 s24, s24, s58
M a[100:103], a[220:223], a[236:239], a[100:103]
s_waitcnt lgkmcnt(10)
M a[104:107], a[204:207], a[244:247], a[104:107]
ds_read_b128 a[232:235], v12 offset:12288
ds_read_b128 a[236:239], v13 offset:12288
M a[104:107], a[200:203], a[240:243], a[104:107]
s_add_u32 m0, s30, 65536
s_nop 0
buffer_load_dwordx4 v6, s[12:15], s25 offen offset:0 lds
M a[108:111], a[208:211], a[240:243], a[108:111]
ds_read_b64_tr_b16 a[180:181], v17 offset:12288
ds_read_b64_tr_b16 a[182:183], v17 offset:13824
M a[108:111], a[212:215], a[244:247], a[108:111]
M a[112:115], a[220:223], a[244:247], a[112:115]
buffer_load_dwordx4 v7, s[12:15], s25 offen offset:1024 lds
M a[112:115], a[216:219], a[240:243], a[112:115]
s_waitcnt lgkmcnt(10)
M a[116:119], a[200:203], a[248:251], a[116:119]
ds_read_b128 a[240:243], v12 offset:14336
ds_read_b128 a[244:247], v13 offset:14336
M a[116:119], a[204:207], a[252:255], a[116:119]
buffer_load_dwordx4 v8, s[12:15], s25 offen offset:2048 lds
M a[120:123], a[212:215], a[252:255], a[120:123]
ds_read_b64_tr_b16 a[188:189], v18 offset:12288
ds_read_b64_tr_b16 a[190:191], v18 offset:13824
M a[120:123], a[208:211], a[248:251], a[120:123]
M a[124:127], a[216:219], a[248:251], a[124:127]
buffer_load_dwordx4 v9, s[12:15], s25 offen offset:3072 lds
M a[124:127], a[220:223], a[252:255], a[124:127]
s_waitcnt lgkmcnt(10)
M a[128:131], a[204:207], a[228:231], a[128:131]
ds_read_b128 a[248:251], v12 offset:16384
ds_read_b128 a[252:255], v13 offset:16384
M a[128:131], a[200:203], a[224:227], a[128:131]
s_add_u32 m0, s30, 69632
s_nop 0
buffer_load_dwordx4 v21, s[12:15], s25 offen offset:0 lds
M a[132:135], a[208:211], a[224:227], a[132:135]
ds_read_b64_tr_b16 a[196:197], v19 offset:12288
ds_read_b64_tr_b16 a[198:199], v19 offset:13824
M a[132:135], a[212:215], a[228:231], a[132:135]
M a[136:139], a[220:223], a[228:231], a[136:139]
buffer_load_dwordx4 v22, s[12:15], s25 offen offset:1024 lds
M a[136:139], a[216:219], a[224:227], a[136:139]
s_waitcnt lgkmcnt(10)
M a[140:143], a[200:203], a[232:235], a[140:143]
s_sub_u32 s54, s54, 1
s_cmp_eq_u32 s54, 0
s_cselect_b32 s58, s55, s56
s_add_u32 s25, s25, s58
M a[140:143], a[204:207], a[236:239], a[140:143]
M a[144:147], a[212:215], a[236:239], a[144:147]
M a[144:147], a[208:211], a[232:235], a[144:147]
M a[148:151], a[216:219], a[232:235], a[148:151]
s_waitcnt vmcnt(15) lgkmcnt(0)
s_barrier
ds_read_b128 a[224:227], v10 offset:0
ds_read_b128 a[228:231], v11 offset:0
M a[148:151], a[220:223], a[236:239], a[148:151]
s_add_u32 s94, s92, 12288
buffer_store_dwordx4 v[128:131], v1, s[16:19], s94 offen offset:0 sc1
M a[152:155], a[204:207], a[244:247], a[152:155]
ds_read_b128 a[232:235], v10 offset:2048
ds_read_b128 a[236:239], v11 offset:2048
M a[152:155], a[200:203], a[240:243], a[152:155]
M a[156:159], a[208:211], a[240:243], a[156:159]
s_add_u32 s94, s92, 12288
buffer_store_dwordx4 v[136:139], v1, s[16:19], s94 offen offset:1024 sc1
M a[156:159], a[212:215], a[244:247], a[156:159]
M a[160:163], a[220:223], a[244:247], a[160:163]
M a[160:163], a[216:219], a[240:243], a[160:163]
s_add_u32 s94, s92, 12288
buffer_store_dwordx4 v[144:147], v1, s[16:19], s94 offen offset:2048 sc1
M a[164:167], a[200:203], a[248:251], a[164:167]
ds_read_b128 a[240:243], v10 offset:4096
ds_read_b128 a[244:247], v11 offset:4096
M a[164:167], a[204:207], a[252:255], a[164:167]
M a[168:171], a[212:215], a[252:255], a[168:171]
M a[168:171], a[208:211], a[248:251], a[168:171]
s_add_u32 s94, s92, 12288
buffer_store_dwordx4 v[152:155], v1, s[16:19], s94 offen offset:3072 sc1
M a[172:175], a[216:219], a[248:251], a[172:175]
M a[172:175], a[220:223], a[252:255], a[172:175]
s_waitcnt lgkmcnt(4)
M a[68:71], a[176:179], a[224:227], a[68:71]
ds_read_b128 a[248:251], v10 offset:6144
ds_read_b128 a[252:255], v11 offset:6144
M a[68:71], a[180:183], a[228:231], a[68:71]
s_add_u32 m0, s28, 131072
s_mov_b32 exec_hi, 0
buffer_load_dwordx4 v20, s[8:11], s24 offen lds
s_mov_b32 exec_hi, -1
M a[72:75], a[188:191], a[228:231], a[72:75]
ds_read_b64_tr_b16 a[200:201], v14 offset:0
ds_read_b64_tr_b16 a[202:203], v14 offset:1536
M a[72:75], a[184:187], a[224:227], a[72:75]
M a[76:79], a[192:195], a[224:227], a[76:79]
s_add_u32 m0, s29, 133120
s_nop 0
buffer_load_dwordx4 v2, s[8:11], s23 offen offset:0 lds
M a[76:79], a[196:199], a[228:231], a[76:79]
s_waitcnt lgkmcnt(6)
M a[80:83], a[180:183], a[236:239], a[80:83]
ds_read_b128 a[224:227], v10 offset:8192
ds_read_b128 a[228:231], v11 offset:8192
M a[80:83], a[176:179], a[232:235], a[80:83]
buffer_load_dwordx4 v3, s[8:11], s23 offen offset:1024 lds
M a[84:87], a[184:187], a[232:235], a[84:87]
ds_read_b64_tr_b16 a[208:209], v15 offset:0
ds_read_b64_tr_b16 a[210:211], v15 offset:1536
M a[84:87], a[188:191], a[236:239], a[84:87]
M a[88:91], a[196:199], a[236:239], a[88:91]
buffer_load_dwordx4 v4, s[8:11], s23 offen offset:2048 lds
M a[88:91], a[192:195], a[232:235], a[88:91]
s_waitcnt lgkmcnt(8)
M a[92:95], a[176:179], a[240:243], a[92:95]
ds_read_b128 a[232:235], v10 offset:10240
ds_read_b128 a[236:239], v11 offset:10240
M a[92:95], a[180:183], a[244:247], a[92:95]
buffer_load_dwordx4 v5, s[8:11], s23 offen offset:3072 lds
M a[96:99], a[188:191], a[244:247], a[96:99]
ds_read_b64_tr_b16 a[216:217], v16 offset:0
ds_read_b64_tr_b16 a[218:219], v16 offset:1536
M a[96:99], a[184:187], a[240:243], a[96:99]
M a[100:103], a[192:195], a[240:243], a[100:103]
s_sub_u32 s31, s31, 1
s_cmp_eq_u32 s31, 0
s_cselect_b32 s58, -1920, s57
s_add_u32 s23, s23, s58
s_add_u32 s24, s24, s58
M a[100:103], a[196:199], a[244:247], a[100:103]
s_waitcnt lgkmcnt(10)
M a[104:107], a[180:183], a[252:255], a[104:107]
ds_read_b128 a[240:243], v10 offset:12288
ds_read_b128 a[244:247], v11 offset:12288
M a[104:107], a[176:179], a[248:251], a[104:107]
s_add_u32 m0, s30, 98304
s_nop 0
buffer_load_dwordx4 v6, s[12:15], s25 offen offset:0 lds
M a[108:111], a[184:187], a[248:251], a[108:111]
ds_read_b64_tr_b16 a[204:205], v14 offset:12288
ds_read_b64_tr_b16 a[206:207], v14 offset:13824
M a[108:111], a[188:191], a[252:255], a[108:111]
M a[112:115], a[196:199], a[252:255], a[112:115]
buffer_load_dwordx4 v7, s[12:15], s25 offen offset:1024 lds
M a[112:115], a[192:195], a[248:251], a[112:115]
s_waitcnt lgkmcnt(10)
M a[116:119], a[176:179], a[224:227], a[116:119]
ds_read_b128 a[248:251], v10 offset:14336
ds_read_b128 a[252:255], v11 offset:14336
M a[116:119], a[180:183], a[228:231], a[116:119]
buffer_load_dwordx4 v8, s[12:15], s25 offen offset:2048 lds
M a[120:123], a[188:191], a[228:231], a[120:123]
ds_read_b64_tr_b16 a[212:213], v15 offset:12288
ds_read_b64_tr_b16 a[214:215], v15 offset:13824
M a[120:123], a[184:187], a[224:227], a[120:123]
M a[124:127], a[192:195], a[224:227], a[124:127]
buffer_load_dwordx4 v9, s[12:15], s25 offen offset:3072 lds
M a[124:127], a[196:199], a[228:231], a[124:127]
s_waitcnt lgkmcnt(10)
M a[128:131], a[180:183], a[236:239], a[128:131]
ds_read_b128 a[224:227], v10 offset:16384
ds_read_b128 a[228:231], v11 offset:16384
M a[128:131], a[176:179], a[232:235], a[128:131]
s_add_u32 m0, s30, 102400
s_nop 0
buffer_load_dwordx4 v21, s[12:15], s25 offen offset:0 lds
M a[132:135], a[184:187], a[232:235], a[132:135]
ds_read_b64_tr_b16 a[220:221], v16 offset:12288
ds_read_b64_tr_b16 a[222:223], v16 offset:13824
M a[132:135], a[188:191], a[236:239], a[132:135]
M a[136:139], a[196:199], a[236:239], a[136:139]
buffer_load_dwordx4 v22, s[12:15], s25 offen offset:1024 lds
M a[136:139], a[192:195], a[232:235], a[136:139]
s_waitcnt lgkmcnt(10)
M a[140:143], a[176:179], a[240:243], a[140:143]
s_sub_u32 s54, s54, 1
s_cmp_eq_u32 s54, 0
s_cselect_b32 s58, s55, s56
s_add_u32 s25, s25, s58
M a[140:143], a[180:183], a[244:247], a[140:143]
M a[144:147], a[188:191], a[244:247], a[144:147]
M a[144:147], a[184:187], a[240:243], a[144:147]
M a[148:151], a[192:195], a[240:243], a[148:151]
s_waitcnt vmcnt(15) lgkmcnt(0)
s_barrier
ds_read_b128 a[232:235], v10 offset:18432
ds_read_b128 a[236:239], v11 offset:18432
M a[148:151], a[196:199], a[244:247], a[148:151]
s_add_u32 s94, s93, 0
buffer_store_dwordx4 v[160:163], v1, s[16:19], s94 offen offset:0 sc1
M a[152:155], a[180:183], a[252:255], a[152:155]
ds_read_b128 a[240:243], v10 offset:20480
ds_read_b128 a[244:247], v11 offset:20480
M a[152:155], a[176:179], a[248:251], a[152:155]
M a[156:159], a[184:187], a[248:251], a[156:159]
s_add_u32 s94, s93, 0
buffer_store_dwordx4 v[168:171], v1, s[16:19], s94 offen offset:1024 sc1
M a[156:159], a[188:191], a[252:255], a[156:159]
M a[160:163], a[196:199], a[252:255], a[160:163]
M a[160:163], a[192:195], a[248:251], a[160:163]
s_add_u32 s94, s93, 0
buffer_store_dwordx4 v[176:179], v1, s[16:19], s94 offen offset:2048 sc1
M a[164:167], a[176:179], a[224:227], a[164:167]
ds_read_b128 a[248:251], v10 offset:22528
ds_read_b128 a[252:255], v11 offset:22528
M a[164:167], a[180:183], a[228:231], a[164:167]
M a[168:171], a[188:191], a[228:231], a[168:171]
M a[168:171], a[184:187], a[224:227], a[168:171]
s_add_u32 s94, s93, 0
buffer_store_dwordx4 v[184:187], v1, s[16:19], s94 offen offset:3072 sc1
M a[172:175], a[192:195], a[224:227], a[172:175]
M a[172:175], a[196:199], a[228:231], a[172:175]
s_waitcnt lgkmcnt(4)
M a[68:71], a[200:203], a[232:235], a[68:71]
ds_read_b128 a[224:227], v10 offset:24576
ds_read_b128 a[228:231], v11 offset:24576
M a[68:71], a[204:207], a[236:239], a[68:71]
s_add_u32 m0, s28, 0
s_mov_b32 exec_hi, 0
buffer_load_dwordx4 v20, s[8:11], s24 offen lds
s_mov_b32 exec_hi, -1
M a[72:75], a[212:215], a[236:239], a[72:75]
ds_read_b64_tr_b16 a[176:177], v14 offset:28672
ds_read_b64_tr_b16 a[178:179], v14 offset:30208
M a[72:75], a[208:211], a[232:235], a[72:75]
M a[76:79], a[216:219], a[232:235], a[76:79]
s_add_u32 m0, s29, 2048
s_nop 0
buffer_load_dwordx4 v2, s[8:11], s23 offen offset:0 lds
M a[76:79], a[220:223], a[236:239], a[76:79]
s_waitcnt lgkmcnt(6)
M a[80:83], a[204:207], a[244:247], a[80:83]
ds_read_b128 a[232:235], v10 offset:26624
ds_read_b128 a[236:239], v11 offset:26624
M a[80:83], a[200:203], a[240:243], a[80:83]
buffer_load_dwordx4 v3, s[8:11], s23 offen offset:1024 lds
M a[84:87], a[208:211], a[240:243], a[84:87]
ds_read_b64_tr_b16 a[184:185], v15 offset:28672
ds_read_b64_tr_b16 a[186:187], v15 offset:30208
M a[84:87], a[212:215], a[244:247], a[84:87]
M a[88:91], a[220:223], a[244:247], a[88:91]
buffer_load_dwordx4 v4, s[8:11], s23 offen offset:2048 lds
M a[88:91], a[216:219], a[240:243], a[88:91]
s_waitcnt lgkmcnt(8)
M a[92:95], a[200:203], a[248:251], a[92:95]
ds_read_b128 a[240:243], v10 offset:28672
ds_read_b128 a[244:247], v11 offset:28672
M a[92:95], a[204:207], a[252:255], a[92:95]
buffer_load_dwordx4 v5, s[8:11], s23 offen offset:3072 lds
M a[96:99], a[212:215], a[252:255], a[96:99]
ds_read_b64_tr_b16 a[192:193], v16 offset:28672
ds_read_b64_tr_b16 a[194:195], v16 offset:30208
M a[96:99], a[208:211], a[248:251], a[96:99]
M a[100:103], a[216:219], a[248:251], a[100:103]
s_sub_u32 s31, s31, 1
s_cmp_eq_u32 s31, 0
s_cselect_b32 s58, -1920, s57
s_add_u32 s23, s23, s58
s_add_u32 s24, s24, s58
M a[100:103], a[220:223], a[252:255], a[100:103]
s_waitcnt lgkmcnt(10)
M a[104:107], a[204:207], a[228:231], a[104:107]
ds_read_b128 a[248:251], v10 offset:30720
ds_read_b128 a[252:255], v11 offset:30720
M a[104:107], a[200:203], a[224:227], a[104:107]
s_add_u32 m0, s30, 36864
s_nop 0
buffer_load_dwordx4 v6, s[12:15], s25 offen offset:0 lds
M a[108:111], a[208:211], a[224:227], a[108:111]
ds_read_b64_tr_b16 a[180:181], v14 offset:40960
ds_read_b64_tr_b16 a[182:183], v14 offset:42496
M a[108:111], a[212:215], a[228:231], a[108:111]
M a[112:115], a[220:223], a[228:231], a[112:115]
buffer_load_dwordx4 v7, s[12:15], s25 offen offset:1024 lds
M a[112:115], a[216:219], a[224:227], a[112:115]
s_waitcnt lgkmcnt(10)
M a[116:119], a[200:203], a[232:235], a[116:119]
ds_read_b128 a[224:227], v10 offset:32768
ds_read_b128 a[228:231], v11 offset:32768
M a[116:119], a[204:207], a[236:239], a[116:119]
buffer_load_dwordx4 v8, s[12:15], s25 offen offset:2048 lds
M a[120:123], a[212:215], a[236:239], a[120:123]
ds_read_b64_tr_b16 a[188:189], v15 offset:40960
ds_read_b64_tr_b16 a[190:191], v15 offset:42496
M a[120:123], a[208:211], a[232:235], a[120:123]
M a[124:127], a[216:219], a[232:235], a[124:127]
buffer_load_dwordx4 v9, s[12:15], s25 offen offset:3072 lds
M a[124:127], a[220:223], a[236:239], a[124:127]
s_waitcnt lgkmcnt(10)
M a[128:131], a[204:207], a[244:247], a[128:131]
ds_read_b128 a[232:235], v10 offset:34816
ds_read_b128 a[236:239], v11 offset:34816
M a[128:131], a[200:203], a[240:243], a[128:131]
s_add_u32 m0, s30, 40960
s_nop 0
buffer_load_dwordx4 v21, s[12:15], s25 offen offset:0 lds
M a[132:135], a[208:211], a[240:243], a[132:135]
ds_read_b64_tr_b16 a[196:197], v16 offset:40960
ds_read_b64_tr_b16 a[198:199], v16 offset:42496
M a[132:135], a[212:215], a[244:247], a[132:135]
M a[136:139], a[220:223], a[244:247], a[136:139]
buffer_load_dwordx4 v22, s[12:15], s25 offen offset:1024 lds
M a[136:139], a[216:219], a[240:243], a[136:139]
s_waitcnt lgkmcnt(10)
M a[140:143], a[200:203], a[248:251], a[140:143]
s_sub_u32 s54, s54, 1
s_cmp_eq_u32 s54, 0
s_cselect_b32 s58, s55, s56
s_add_u32 s25, s25, s58
M a[140:143], a[204:207], a[252:255], a[140:143]
M a[144:147], a[212:215], a[252:255], a[144:147]
M a[144:147], a[208:211], a[248:251], a[144:147]
M a[148:151], a[216:219], a[248:251], a[148:151]
s_waitcnt vmcnt(15) lgkmcnt(0)
s_barrier
ds_read_b128 a[240:243], v12 offset:0
ds_read_b128 a[244:247], v13 offset:0
M a[148:151], a[220:223], a[252:255], a[148:151]
s_add_u32 s94, s93, 4096
buffer_store_dwordx4 v[192:195], v1, s[16:19], s94 offen offset:0 sc1
M a[152:155], a[204:207], a[228:231], a[152:155]
ds_read_b128 a[248:251], v12 offset:2048
ds_read_b128 a[252:255], v13 offset:2048
M a[152:155], a[200:203], a[224:227], a[152:155]
M a[156:159], a[208:211], a[224:227], a[156:159]
s_add_u32 s94, s93, 4096
buffer_store_dwordx4 v[200:203], v1, s[16:19], s94 offen offset:1024 sc1
M a[156:159], a[212:215], a[228:231], a[156:159]
M a[160:163], a[220:223], a[228:231], a[160:163]
M a[160:163], a[216:219], a[224:227], a[160:163]
s_add_u32 s94, s93, 4096
buffer_store_dwordx4 v[208:211], v1, s[16:19], s94 offen offset:2048 sc1
M a[164:167], a[200:203], a[232:235], a[164:167]
ds_read_b128 a[224:227], v12 offset:4096
ds_read_b128 a[228:231], v13 offset:4096
M a[164:167], a[204:207], a[236:239], a[164:167]
M a[168:171], a[212:215], a[236:239], a[168:171]
M a[168:171], a[208:211], a[232:235], a[168:171]
s_add_u32 s94, s93, 4096
buffer_store_dwordx4 v[216:219], v1, s[16:19], s94 offen offset:3072 sc1
M a[172:175], a[216:219], a[232:235], a[172:175]
M a[172:175], a[220:223], a[236:239], a[172:175]
s_waitcnt lgkmcnt(4)
M a[68:71], a[176:179], a[240:243], a[68:71]
ds_read_b128 a[232:235], v12 offset:6144
ds_read_b128 a[236:239], v13 offset:6144
M a[68:71], a[180:183], a[244:247], a[68:71]
s_add_u32 m0, s28, 18432
s_mov_b32 exec_hi, 0
buffer_load_dwordx4 v20, s[8:11], s24 offen lds
s_mov_b32 exec_hi, -1
M a[72:75], a[188:191], a[244:247], a[72:75]
ds_read_b64_tr_b16 a[200:201], v17 offset:0
ds_read_b64_tr_b16 a[202:203], v17 offset:1536
M a[72:75], a[184:187], a[240:243], a[72:75]
M a[76:79], a[192:195], a[240:243], a[76:79]
s_add_u32 m0, s29, 20480
s_nop 0
buffer_load_dwordx4 v2, s[8:11], s23 offen offset:0 lds
M a[76:79], a[196:199], a[244:247], a[76:79]
s_waitcnt lgkmcnt(6)
M a[80:83], a[180:183], a[252:255], a[80:83]
ds_read_b128 a[240:243], v12 offset:8192
ds_read_b128 a[244:247], v13 offset:8192
M a[80:83], a[176:179], a[248:251], a[80:83]
buffer_load_dwordx4 v3, s[8:11], s23 offen offset:1024 lds
M a[84:87], a[184:187], a[248:251], a[84:87]
ds_read_b64_tr_b16 a[208:209], v18 offset:0
ds_read_b64_tr_b16 a[210:211], v18 offset:1536
M a[84:87], a[188:191], a[252:255], a[84:87]
M a[88:91], a[196:199], a[252:255], a[88:91]
buffer_load_dwordx4 v4, s[8:11], s23 offen offset:2048 lds
M a[88:91], a[192:195], a[248:251], a[88:91]
s_waitcnt lgkmcnt(8)
M a[92:95], a[176:179], a[224:227], a[92:95]
ds_read_b128 a[248:251], v12 offset:10240
ds_read_b128 a[252:255], v13 offset:10240
M a[92:95], a[180:183], a[228:231], a[92:95]
buffer_load_dwordx4 v5, s[8:11], s23 offen offset:3072 lds
M a[96:99], a[188:191], a[228:231], a[96:99]
ds_read_b64_tr_b16 a[216:217], v19 offset:0
ds_read_b64_tr_b16 a[218:219], v19 offset:1536
M a[96:99], a[184:187], a[224:227], a[96:99]
M a[100:103], a[192:195], a[224:227], a[100:103]
s_sub_u32 s31, s31, 1
s_cmp_eq_u32 s31, 0
s_cselect_b32 s58, -1920, s57
s_add_u32 s23, s23, s58
s_add_u32 s24, s24, s58
M a[100:103], a[196:199], a[228:231], a[100:103]
s_waitcnt lgkmcnt(10)
M a[104:107], a[180:183], a[236:239], a[104:107]
ds_read_b128 a[224:227], v12 offset:12288
ds_read_b128 a[228:231], v13 offset:12288
M a[104:107], a[176:179], a[232:235], a[104:107]
s_add_u32 m0, s30, 65536
s_nop 0
buffer_load_dwordx4 v6, s[12:15], s25 offen offset:0 lds
M a[108:111], a[184:187], a[232:235], a[108:111]
ds_read_b64_tr_b16 a[204:205], v17 offset:12288
ds_read_b64_tr_b16 a[206:207], v17 offset:13824
M a[108:111], a[188:191], a[236:239], a[108:111]
M a[112:115], a[196:199], a[236:239], a[112:115]
buffer_load_dwordx4 v7, s[12:15], s25 offen offset:1024 lds
M a[112:115], a[192:195], a[232:235], a[112:115]
s_waitcnt lgkmcnt(10)
M a[116:119], a[176:179], a[240:243], a[116:119]
ds_read_b128 a[232:235], v12 offset:14336
ds_read_b128 a[236:239], v13 offset:14336
M a[116:119], a[180:183], a[244:247], a[116:119]
buffer_load_dwordx4 v8, s[12:15], s25 offen offset:2048 lds
M a[120:123], a[188:191], a[244:247], a[120:123]
ds_read_b64_tr_b16 a[212:213], v18 offset:12288
ds_read_b64_tr_b16 a[214:215], v18 offset:13824
M a[120:123], a[184:187], a[240:243], a[120:123]
M a[124:127], a[192:195], a[240:243], a[124:127]
buffer_load_dwordx4 v9, s[12:15], s25 offen offset:3072 lds
M a[124:127], a[196:199], a[244:247], a[124:127]
s_waitcnt lgkmcnt(10)
M a[128:131], a[180:183], a[252:255], a[128:131]
ds_read_b128 a[240:243], v12 offset:16384
ds_read_b128 a[244:247], v13 offset:16384
M a[128:131], a[176:179], a[248:251], a[128:131]
s_add_u32 m0, s30, 69632
s_nop 0
buffer_load_dwordx4 v21, s[12:15], s25 offen offset:0 lds
M a[132:135], a[184:187], a[248:251], a[132:135]
ds_read_b64_tr_b16 a[220:221], v19 offset:12288
ds_read_b64_tr_b16 a[222:223], v19 offset:13824
M a[132:135], a[188:191], a[252:255], a[132:135]
M a[136:139], a[196:199], a[252:255], a[136:139]
buffer_load_dwordx4 v22, s[12:15], s25 offen offset:1024 lds
M a[136:139], a[192:195], a[248:251], a[136:139]
s_waitcnt lgkmcnt(10)
M a[140:143], a[176:179], a[224:227], a[140:143]
s_sub_u32 s54, s54, 1
s_cmp_eq_u32 s54, 0
s_cselect_b32 s58, s55, s56
s_add_u32 s25, s25, s58
M a[140:143], a[180:183], a[228:231], a[140:143]
M a[144:147], a[188:191], a[228:231], a[144:147]
M a[144:147], a[184:187], a[224:227], a[144:147]
M a[148:151], a[192:195], a[224:227], a[148:151]
s_waitcnt vmcnt(15) lgkmcnt(0)
s_barrier
ds_read_b128 a[248:251], v10 offset:0
ds_read_b128 a[252:255], v11 offset:0
M a[148:151], a[196:199], a[228:231], a[148:151]
s_add_u32 s94, s93, 8192
buffer_store_dwordx4 v[224:227], v1, s[16:19], s94 offen offset:0 sc1
M a[152:155], a[180:183], a[236:239], a[152:155]
ds_read_b128 a[224:227], v10 offset:2048
ds_read_b128 a[228:231], v11 offset:2048
M a[152:155], a[176:179], a[232:235], a[152:155]
M a[156:159], a[184:187], a[232:235], a[156:159]
s_add_u32 s94, s93, 8192
buffer_store_dwordx4 v[232:235], v1, s[16:19], s94 offen offset:1024 sc1
M a[156:159], a[188:191], a[236:239], a[156:159]
M a[160:163], a[196:199], a[236:239], a[160:163]
M a[160:163], a[192:195], a[232:235], a[160:163]
s_add_u32 s94, s93, 8192
buffer_store_dwordx4 v[240:243], v1, s[16:19], s94 offen offset:2048 sc1
M a[164:167], a[176:179], a[240:243], a[164:167]
ds_read_b128 a[232:235], v10 offset:4096
ds_read_b128 a[236:239], v11 offset:4096
M a[164:167], a[180:183], a[244:247], a[164:167]
M a[168:171], a[188:191], a[244:247], a[168:171]
M a[168:171], a[184:187], a[240:243], a[168:171]
s_add_u32 s94, s93, 8192
buffer_store_dwordx4 v[248:251], v1, s[16:19], s94 offen offset:3072 sc1
M a[172:175], a[192:195], a[240:243], a[172:175]
M a[172:175], a[196:199], a[244:247], a[172:175]
s_waitcnt lgkmcnt(4)
M a[68:71], a[200:203], a[248:251], a[68:71]
ds_read_b128 a[240:243], v10 offset:6144
ds_read_b128 a[244:247], v11 offset:6144
M a[68:71], a[204:207], a[252:255], a[68:71]
s_add_u32 m0, s28, 131072
s_mov_b32 exec_hi, 0
buffer_load_dwordx4 v20, s[8:11], s24 offen lds
s_mov_b32 exec_hi, -1
M a[72:75], a[212:215], a[252:255], a[72:75]
ds_read_b64_tr_b16 a[176:177], v14 offset:0
ds_read_b64_tr_b16 a[178:179], v14 offset:1536
M a[72:75], a[208:211], a[248:251], a[72:75]
M a[76:79], a[216:219], a[248:251], a[76:79]
s_add_u32 m0, s29, 133120
s_nop 0
buffer_load_dwordx4 v2, s[8:11], s23 offen offset:0 lds
M a[76:79], a[220:223], a[252:255], a[76:79]
s_waitcnt lgkmcnt(6)
M a[80:83], a[204:207], a[228:231], a[80:83]
ds_read_b128 a[248:251], v10 offset:8192
ds_read_b128 a[252:255], v11 offset:8192
M a[80:83], a[200:203], a[224:227], a[80:83]
buffer_load_dwordx4 v3, s[8:11], s23 offen offset:1024 lds
M a[84:87], a[208:211], a[224:227], a[84:87]
ds_read_b64_tr_b16 a[184:185], v15 offset:0
ds_read_b64_tr_b16 a[186:187], v15 offset:1536
M a[84:87], a[212:215], a[228:231], a[84:87]
M a[88:91], a[220:223], a[228:231], a[88:91]
buffer_load_dwordx4 v4, s[8:11], s23 offen offset:2048 lds
M a[88:91], a[216:219], a[224:227], a[88:91]
s_waitcnt lgkmcnt(8)
M a[92:95], a[200:203], a[232:235], a[92:95]
ds_read_b128 a[224:227], v10 offset:10240
ds_read_b128 a[228:231], v11 offset:10240
M a[92:95], a[204:207], a[236:239], a[92:95]
buffer_load_dwordx4 v5, s[8:11], s23 offen offset:3072 lds
M a[96:99], a[212:215], a[236:239], a[96:99]
ds_read_b64_tr_b16 a[192:193], v16 offset:0
ds_read_b64_tr_b16 a[194:195], v16 offset:1536
M a[96:99], a[208:211], a[232:235], a[96:99]
M a[100:103], a[216:219], a[232:235], a[100:103]
s_sub_u32 s31, s31, 1
s_cmp_eq_u32 s31, 0
s_cselect_b32 s58, -1920, s57
s_add_u32 s23, s23, s58
s_add_u32 s24, s24, s58
M a[100:103], a[220:223], a[236:239], a[100:103]
s_waitcnt lgkmcnt(10)
M a[104:107], a[204:207], a[244:247], a[104:107]
ds_read_b128 a[232:235], v10 offset:12288
ds_read_b128 a[236:239], v11 offset:12288
M a[104:107], a[200:203], a[240:243], a[104:107]
s_add_u32 m0, s30, 98304
s_nop 0
buffer_load_dwordx4 v6, s[12:15], s25 offen offset:0 lds
M a[108:111], a[208:211], a[240:243], a[108:111]
ds_read_b64_tr_b16 a[180:181], v14 offset:12288
ds_read_b64_tr_b16 a[182:183], v14 offset:13824
M a[108:111], a[212:215], a[244:247], a[108:111]
M a[112:115], a[220:223], a[244:247], a[112:115]
buffer_load_dwordx4 v7, s[12:15], s25 offen offset:1024 lds
M a[112:115], a[216:219], a[240:243], a[112:115]
s_waitcnt lgkmcnt(10)
M a[116:119], a[200:203], a[248:251], a[116:119]
ds_read_b128 a[240:243], v10 offset:14336
ds_read_b128 a[244:247], v11 offset:14336
M a[116:119], a[204:207], a[252:255], a[116:119]
buffer_load_dwordx4 v8, s[12:15], s25 offen offset:2048 lds
M a[120:123], a[212:215], a[252:255], a[120:123]
ds_read_b64_tr_b16 a[188:189], v15 offset:12288
ds_read_b64_tr_b16 a[190:191], v15 offset:13824
M a[120:123], a[208:211], a[248:251], a[120:123]
M a[124:127], a[216:219], a[248:251], a[124:127]
buffer_load_dwordx4 v9, s[12:15], s25 offen offset:3072 lds
M a[124:127], a[220:223], a[252:255], a[124:127]
s_waitcnt lgkmcnt(10)
M a[128:131], a[204:207], a[228:231], a[128:131]
ds_read_b128 a[248:251], v10 offset:16384
ds_read_b128 a[252:255], v11 offset:16384
M a[128:131], a[200:203], a[224:227], a[128:131]
s_add_u32 m0, s30, 102400
s_nop 0
buffer_load_dwordx4 v21, s[12:15], s25 offen offset:0 lds
M a[132:135], a[208:211], a[224:227], a[132:135]
ds_read_b64_tr_b16 a[196:197], v16 offset:12288
ds_read_b64_tr_b16 a[198:199], v16 offset:13824
M a[132:135], a[212:215], a[228:231], a[132:135]
M a[136:139], a[220:223], a[228:231], a[136:139]
buffer_load_dwordx4 v22, s[12:15], s25 offen offset:1024 lds
M a[136:139], a[216:219], a[224:227], a[136:139]
s_waitcnt lgkmcnt(10)
M a[140:143], a[200:203], a[232:235], a[140:143]
s_sub_u32 s54, s54, 1
s_cmp_eq_u32 s54, 0
s_cselect_b32 s58, s55, s56
s_add_u32 s25, s25, s58
M a[140:143], a[204:207], a[236:239], a[140:143]
M a[144:147], a[212:215], a[236:239], a[144:147]
M a[144:147], a[208:211], a[232:235], a[144:147]
M a[148:151], a[216:219], a[232:235], a[148:151]
s_waitcnt vmcnt(15) lgkmcnt(0)
s_barrier
ds_read_b128 a[224:227], v10 offset:18432
ds_read_b128 a[228:231], v11 offset:18432
M a[148:151], a[220:223], a[236:239], a[148:151]
s_add_u32 s94, s93, 12288
buffer_store_dwordx4 v[36:39], v1, s[16:19], s94 offen offset:0 sc1
M a[152:155], a[204:207], a[244:247], a[152:155]
ds_read_b128 a[232:235], v10 offset:20480
ds_read_b128 a[236:239], v11 offset:20480
M a[152:155], a[200:203], a[240:243], a[152:155]
M a[156:159], a[208:211], a[240:243], a[156:159]
s_add_u32 s94, s93, 12288
buffer_store_dwordx4 v[44:47], v1, s[16:19], s94 offen offset:1024 sc1
M a[156:159], a[212:215], a[244:247], a[156:159]
M a[160:163], a[220:223], a[244:247], a[160:163]
M a[160:163], a[216:219], a[240:243], a[160:163]
s_add_u32 s94, s93, 12288
buffer_store_dwordx4 v[52:55], v1, s[16:19], s94 offen offset:2048 sc1
M a[164:167], a[200:203], a[248:251], a[164:167]
ds_read_b128 a[240:243], v10 offset:22528
ds_read_b128 a[244:247], v11 offset:22528
M a[164:167], a[204:207], a[252:255], a[164:167]
M a[168:171], a[212:215], a[252:255], a[168:171]
M a[168:171], a[208:211], a[248:251], a[168:171]
s_add_u32 s94, s93, 12288
buffer_store_dwordx4 v[60:63], v1, s[16:19], s94 offen offset:3072 sc1
M a[172:175], a[216:219], a[248:251], a[172:175]
M a[172:175], a[220:223], a[252:255], a[172:175]
s_waitcnt lgkmcnt(4)
M a[68:71], a[176:179], a[224:227], a[68:71]
ds_read_b128 a[248:251], v10 offset:24576
ds_read_b128 a[252:255], v11 offset:24576
v_mov_b32 v160, 0
v_mov_b32 v161, 0
M a[68:71], a[180:183], a[228:231], a[68:71]
s_add_u32 m0, s28, 0
s_mov_b32 exec_hi, 0
buffer_load_dwordx4 v20, s[8:11], s24 offen lds
s_mov_b32 exec_hi, -1
M a[72:75], a[188:191], a[228:231], a[72:75]
ds_read_b64_tr_b16 a[200:201], v14 offset:28672
ds_read_b64_tr_b16 a[202:203], v14 offset:30208
v_mov_b32 v162, 0
v_mov_b32 v163, 0
M a[72:75], a[184:187], a[224:227], a[72:75]
M a[76:79], a[192:195], a[224:227], a[76:79]
s_add_u32 m0, s29, 2048
s_nop 0
buffer_load_dwordx4 v2, s[8:11], s23 offen offset:0 lds
v_mov_b32 v164, 0
v_mov_b32 v165, 0
M a[76:79], a[196:199], a[228:231], a[76:79]
s_waitcnt lgkmcnt(6)
M a[80:83], a[180:183], a[236:239], a[80:83]
ds_read_b128 a[224:227], v10 offset:26624
ds_read_b128 a[228:231], v11 offset:26624
v_mov_b32 v166, 0
v_mov_b32 v167, 0
M a[80:83], a[176:179], a[232:235], a[80:83]
buffer_load_dwordx4 v3, s[8:11], s23 offen offset:1024 lds
M a[84:87], a[184:187], a[232:235], a[84:87]
ds_read_b64_tr_b16 a[208:209], v15 offset:28672
ds_read_b64_tr_b16 a[210:211], v15 offset:30208
M a[84:87], a[188:191], a[236:239], a[84:87]
v_mov_b32 v168, 0
v_mov_b32 v169, 0
M a[88:91], a[196:199], a[236:239], a[88:91]
buffer_load_dwordx4 v4, s[8:11], s23 offen offset:2048 lds
M a[88:91], a[192:195], a[232:235], a[88:91]
s_waitcnt lgkmcnt(8)
v_mov_b32 v170, 0
v_mov_b32 v171, 0
M a[92:95], a[176:179], a[240:243], a[92:95]
ds_read_b128 a[232:235], v10 offset:28672
ds_read_b128 a[236:239], v11 offset:28672
M a[92:95], a[180:183], a[244:247], a[92:95]
buffer_load_dwordx4 v5, s[8:11], s23 offen offset:3072 lds
v_mov_b32 v172, 0
v_mov_b32 v173, 0
M a[96:99], a[188:191], a[244:247], a[96:99]
ds_read_b64_tr_b16 a[216:217], v16 offset:28672
ds_read_b64_tr_b16 a[218:219], v16 offset:30208
M a[96:99], a[184:187], a[240:243], a[96:99]
v_mov_b32 v174, 0
v_mov_b32 v175, 0
M a[100:103], a[192:195], a[240:243], a[100:103]
s_sub_u32 s31, s31, 1
s_cmp_eq_u32 s31, 0
s_cselect_b32 s58, -1920, s57
s_add_u32 s23, s23, s58
s_add_u32 s24, s24, s58
M a[100:103], a[196:199], a[244:247], a[100:103]
s_waitcnt lgkmcnt(10)
M a[104:107], a[180:183], a[252:255], a[104:107]
ds_read_b128 a[240:243], v10 offset:30720
ds_read_b128 a[244:247], v11 offset:30720
v_mov_b32 v176, 0
v_mov_b32 v177, 0
M a[104:107], a[176:179], a[248:251], a[104:107]
s_add_u32 m0, s30, 36864
s_nop 0
buffer_load_dwordx4 v6, s[12:15], s25 offen offset:0 lds
M a[108:111], a[184:187], a[248:251], a[108:111]
ds_read_b64_tr_b16 a[204:205], v14 offset:40960
ds_read_b64_tr_b16 a[206:207], v14 offset:42496
v_mov_b32 v178, 0
v_mov_b32 v179, 0
M a[108:111], a[188:191], a[252:255], a[108:111]
M a[112:115], a[196:199], a[252:255], a[112:115]
buffer_load_dwordx4 v7, s[12:15], s25 offen offset:1024 lds
v_mov_b32 v180, 0
v_mov_b32 v181, 0
M a[112:115], a[192:195], a[248:251], a[112:115]
s_waitcnt lgkmcnt(10)
M a[116:119], a[176:179], a[224:227], a[116:119]
ds_read_b128 a[248:251], v10 offset:32768
ds_read_b128 a[252:255], v11 offset:32768
v_mov_b32 v182, 0
v_mov_b32 v183, 0
M a[116:119], a[180:183], a[228:231], a[116:119]
buffer_load_dwordx4 v8, s[12:15], s25 offen offset:2048 lds
M a[120:123], a[188:191], a[228:231], a[120:123]
ds_read_b64_tr_b16 a[212:213], v15 offset:40960
ds_read_b64_tr_b16 a[214:215], v15 offset:42496
M a[120:123], a[184:187], a[224:227], a[120:123]
v_mov_b32 v184, 0
v_mov_b32 v185, 0
M a[124:127], a[192:195], a[224:227], a[124:127]
buffer_load_dwordx4 v9, s[12:15], s25 offen offset:3072 lds
M a[124:127], a[196:199], a[228:231], a[124:127]
s_waitcnt lgkmcnt(10)
v_mov_b32 v186, 0
v_mov_b32 v187, 0
M a[128:131], a[180:183], a[236:239], a[128:131]
ds_read_b128 a[224:227], v10 offset:34816
ds_read_b128 a[228:231], v11 offset:34816
M a[128:131], a[176:179], a[232:235], a[128:131]
s_add_u32 m0, s30, 40960
s_nop 0
buffer_load_dwordx4 v21, s[12:15], s25 offen offset:0 lds
v_mov_b32 v188, 0
v_mov_b32 v189, 0
M a[132:135], a[184:187], a[232:235], a[132:135]
ds_read_b64_tr_b16 a[220:221], v16 offset:40960
ds_read_b64_tr_b16 a[222:223], v16 offset:42496
M a[132:135], a[188:191], a[236:239], a[132:135]
v_mov_b32 v190, 0
v_mov_b32 v191, 0
M a[136:139], a[196:199], a[236:239], a[136:139]
buffer_load_dwordx4 v22, s[12:15], s25 offen offset:1024 lds
M a[136:139], a[192:195], a[232:235], a[136:139]
s_waitcnt lgkmcnt(10)
M a[140:143], a[176:179], a[240:243], a[140:143]
s_sub_u32 s54, s54, 1
s_cmp_eq_u32 s54, 0
s_cselect_b32 s58, s55, s56
s_add_u32 s25, s25, s58
v_mov_b32 v192, 0
v_mov_b32 v193, 0
M a[140:143], a[180:183], a[244:247], a[140:143]
M a[144:147], a[188:191], a[244:247], a[144:147]
v_mov_b32 v194, 0
v_mov_b32 v195, 0
M a[144:147], a[184:187], a[240:243], a[144:147]
M a[148:151], a[192:195], a[240:243], a[148:151]
s_waitcnt vmcnt(15) lgkmcnt(0)
s_barrier
ds_read_b128 a[232:235], v12 offset:0
ds_read_b128 a[236:239], v13 offset:0
v_mov_b32 v196, 0
v_mov_b32 v197, 0
M a[148:151], a[196:199], a[244:247], a[148:151]
s_add_u32 m0, s28, 18432
s_mov_b32 exec_hi, 0
buffer_load_dwordx4 v20, s[8:11], s24 offen lds
s_mov_b32 exec_hi, -1
M a[152:155], a[180:183], a[252:255], a[152:155]
ds_read_b128 a[240:243], v12 offset:2048
ds_read_b128 a[244:247], v13 offset:2048
v_mov_b32 v198, 0
v_mov_b32 v199, 0
M a[152:155], a[176:179], a[248:251], a[152:155]
M a[156:159], a[184:187], a[248:251], a[156:159]
s_add_u32 m0, s29, 20480
s_nop 0
buffer_load_dwordx4 v2, s[8:11], s23 offen offset:0 lds
M a[156:159], a[188:191], a[252:255], a[156:159]
v_mov_b32 v200, 0
v_mov_b32 v201, 0
M a[160:163], a[196:199], a[252:255], a[160:163]
M a[160:163], a[192:195], a[248:251], a[160:163]
buffer_load_dwordx4 v3, s[8:11], s23 offen offset:1024 lds
v_mov_b32 v202, 0
v_mov_b32 v203, 0
M a[164:167], a[176:179], a[224:227], a[164:167]
ds_read_b128 a[248:251], v12 offset:4096
ds_read_b128 a[252:255], v13 offset:4096
M a[164:167], a[180:183], a[228:231], a[164:167]
v_mov_b32 v204, 0
v_mov_b32 v205, 0
M a[168:171], a[188:191], a[228:231], a[168:171]
M a[168:171], a[184:187], a[224:227], a[168:171]
buffer_load_dwordx4 v4, s[8:11], s23 offen offset:2048 lds
v_mov_b32 v206, 0
v_mov_b32 v207, 0
M a[172:175], a[192:195], a[224:227], a[172:175]
M a[172:175], a[196:199], a[228:231], a[172:175]
s_waitcnt lgkmcnt(4)
M a[68:71], a[200:203], a[232:235], a[68:71]
ds_read_b128 a[224:227], v12 offset:6144
ds_read_b128 a[228:231], v13 offset:6144
v_and_b32 v128, 15, v0
v_mul_u32_u24 v128, 400, v128
M a[68:71], a[204:207], a[236:239], a[68:71]
buffer_load_dwordx4 v5, s[8:11], s23 offen offset:3072 lds
M a[72:75], a[212:215], a[236:239], a[72:75]
ds_read_b64_tr_b16 a[176:177], v17 offset:0
ds_read_b64_tr_b16 a[178:179], v17 offset:1536
v_lshrrev_b32 v129, 4, v0
v_lshl_add_u32 v128, v129, 3, v128
M a[72:75], a[208:211], a[232:235], a[72:75]
M a[76:79], a[216:219], a[232:235], a[76:79]
s_mul_i32 s3, s20, 96
s_add_u32 s3, s3, 98304
M a[76:79], a[220:223], a[236:239], a[76:79]
s_sub_u32 s31, s31, 1
s_cmp_eq_u32 s31, 0
s_cselect_b32 s58, -1920, s57
s_add_u32 s23, s23, s58
s_add_u32 s24, s24, s58
s_waitcnt lgkmcnt(6)
M a[80:83], a[204:207], a[244:247], a[80:83]
ds_read_b128 a[232:235], v12 offset:8192
ds_read_b128 a[236:239], v13 offset:8192
v_add_u32 v124, s3, v128
v_and_b32 v128, 15, v0
M a[80:83], a[200:203], a[240:243], a[80:83]
M a[84:87], a[208:211], a[240:243], a[84:87]
ds_read_b64_tr_b16 a[184:185], v18 offset:0
ds_read_b64_tr_b16 a[186:187], v18 offset:1536
v_lshrrev_b32 v129, 4, v0
s_add_u32 s3, s21, 16
M a[84:87], a[212:215], a[244:247], a[84:87]
M a[88:91], a[220:223], a[244:247], a[88:91]
s_add_u32 m0, s30, 65536
s_nop 0
buffer_load_dwordx4 v6, s[12:15], s25 offen offset:0 lds
v_lshl_add_u32 v130, v128, 1, s3
s_lshl_b32 s4, s22, 6
M a[88:91], a[216:219], a[240:243], a[88:91]
s_waitcnt lgkmcnt(8)
M a[92:95], a[200:203], a[248:251], a[92:95]
ds_read_b128 a[240:243], v12 offset:10240
ds_read_b128 a[244:247], v13 offset:10240
s_add_u32 s4, s4, 98304
v_mul_u32_u24 v120, 400, v130
M a[92:95], a[204:207], a[252:255], a[92:95]
M a[96:99], a[212:215], a[252:255], a[96:99]
ds_read_b64_tr_b16 a[192:193], v19 offset:0
ds_read_b64_tr_b16 a[194:195], v19 offset:1536
M a[96:99], a[208:211], a[248:251], a[96:99]
buffer_load_dwordx4 v7, s[12:15], s25 offen offset:1024 lds
v_lshl_add_u32 v120, v129, 4, v120
v_add_u32 v120, s4, v120
M a[100:103], a[216:219], a[248:251], a[100:103]
M a[100:103], a[220:223], a[252:255], a[100:103]
s_waitcnt lgkmcnt(10)
v_subrev_u32 v130, 32, v130
v_max_i32 v130, 0, v130
M a[104:107], a[204:207], a[228:231], a[104:107]
ds_read_b128 a[248:251], v12 offset:12288
ds_read_b128 a[252:255], v13 offset:12288
M a[104:107], a[200:203], a[224:227], a[104:107]
buffer_load_dwordx4 v8, s[12:15], s25 offen offset:2048 lds
v_mul_u32_u24 v121, 400, v130
v_lshl_add_u32 v121, v129, 4, v121
M a[108:111], a[208:211], a[224:227], a[108:111]
ds_read_b64_tr_b16 a[180:181], v17 offset:12288
ds_read_b64_tr_b16 a[182:183], v17 offset:13824
M a[108:111], a[212:215], a[228:231], a[108:111]
v_add_u32 v121, s4, v121
v_bfe_u32 v131, v0, 2, 2
M a[112:115], a[220:223], a[228:231], a[112:115]
M a[112:115], a[216:219], a[224:227], a[112:115]
buffer_load_dwordx4 v9, s[12:15], s25 offen offset:3072 lds
s_waitcnt lgkmcnt(10)
v_lshl_add_u32 v131, v129, 2, v131
v_lshl_add_u32 v131, v131, 1, s3
M a[116:119], a[200:203], a[232:235], a[116:119]
ds_read_b128 a[224:227], v12 offset:14336
ds_read_b128 a[228:231], v13 offset:14336
M a[116:119], a[204:207], a[236:239], a[116:119]
v_and_b32 v132, 3, v0
v_lshlrev_b32 v132, 3, v132
M a[120:123], a[212:215], a[236:239], a[120:123]
ds_read_b64_tr_b16 a[188:189], v18 offset:12288
ds_read_b64_tr_b16 a[190:191], v18 offset:13824
M a[120:123], a[208:211], a[232:235], a[120:123]
M a[124:127], a[216:219], a[232:235], a[124:127]
s_add_u32 m0, s30, 69632
s_nop 0
buffer_load_dwordx4 v21, s[12:15], s25 offen offset:0 lds
v_add_u32 v132, s4, v132
s_movk_i32 s5, 400
M a[124:127], a[220:223], a[236:239], a[124:127]
s_waitcnt lgkmcnt(10)
M a[128:131], a[204:207], a[244:247], a[128:131]
ds_read_b128 a[232:235], v12 offset:16384
ds_read_b128 a[236:239], v13 offset:16384
v_mad_u32_u24 v122, v131, s5, v132
v_subrev_u32 v131, 32, v131
M a[128:131], a[200:203], a[240:243], a[128:131]
M a[132:135], a[208:211], a[240:243], a[132:135]
ds_read_b64_tr_b16 a[196:197], v19 offset:12288
ds_read_b64_tr_b16 a[198:199], v19 offset:13824
v_max_i32 v131, 0, v131
v_mad_u32_u24 v123, v131, s5, v132
M a[132:135], a[212:215], a[244:247], a[132:135]
buffer_load_dwordx4 v22, s[12:15], s25 offen offset:1024 lds
M a[136:139], a[220:223], a[244:247], a[136:139]
v_lshlrev_b32 v129, 2, v129
v_sub_u32 v128, v128, v129
M a[136:139], a[216:219], a[240:243], a[136:139]
s_waitcnt lgkmcnt(10)
M a[140:143], a[200:203], a[248:251], a[140:143]
s_sub_u32 s54, s54, 1
s_cmp_eq_u32 s54, 0
s_cselect_b32 s58, s55, s56
s_add_u32 s25, s25, s58
v_mov_b32 v129, 0xf149f2ca
s_cmp_eq_u32 s26, 0
s_cselect_b32 s3, 0xf149f2ca, 0
M a[140:143], a[204:207], a[252:255], a[140:143]
M a[144:147], a[212:215], a[252:255], a[144:147]
v_cmp_lt_i32 vcc, -9, v128
s_nop 1
v_cndmask_b32 v144, 0, v129, vcc
M a[144:147], a[208:211], a[248:251], a[144:147]
M a[148:151], a[216:219], a[248:251], a[148:151]
s_waitcnt vmcnt(11) lgkmcnt(0)
s_barrier
ds_read_b128 a[240:243], v10 offset:0
ds_read_b128 a[244:247], v11 offset:0
s_cmp_lg_u32 s101, 0
s_cbranch_scc1 Lk1_arr
v_mov_b32 v127, 1
s_and_b32 s41, s2, 128
s_mov_b64 exec, 1
buffer_atomic_add v127, off, s[36:39], s41 sc1
s_mov_b64 exec, -1
Lk1_arr:
M a[148:151], a[220:223], a[252:255], a[148:151]
s_add_u32 m0, s28, 131072
s_mov_b32 exec_hi, 0
buffer_load_dwordx4 v20, s[8:11], s24 offen lds
s_mov_b32 exec_hi, -1
v_subrev_u32 v130, 0, v128
v_cmp_lt_u32 vcc, 7, v130
s_nop 1
v_cndmask_b32 v148, 0, v129, vcc
M a[152:155], a[204:207], a[228:231], a[152:155]
ds_read_b128 a[248:251], v10 offset:2048
ds_read_b128 a[252:255], v11 offset:2048
M a[152:155], a[200:203], a[224:227], a[152:155]
v_min_f32 v152, s3, v144
v_mov_b32 v156, 0x3f803f80
M a[156:159], a[208:211], a[224:227], a[156:159]
s_add_u32 m0, s29, 133120
s_nop 0
buffer_load_dwordx4 v2, s[8:11], s23 offen offset:0 lds
M a[156:159], a[212:215], a[228:231], a[156:159]
v_cmp_lt_i32 vcc, -8, v128
s_nop 1
v_cndmask_b32 v145, 0, v129, vcc
M a[160:163], a[220:223], a[228:231], a[160:163]
M a[160:163], a[216:219], a[224:227], a[160:163]
buffer_load_dwordx4 v3, s[8:11], s23 offen offset:1024 lds
v_subrev_u32 v130, 1, v128
v_cmp_lt_u32 vcc, 7, v130
s_nop 1
v_cndmask_b32 v149, 0, v129, vcc
M a[164:167], a[200:203], a[232:235], a[164:167]
ds_read_b128 a[224:227], v10 offset:4096
ds_read_b128 a[228:231], v11 offset:4096
M a[164:167], a[204:207], a[236:239], a[164:167]
v_min_f32 v153, s3, v145
v_mov_b32 v157, 0x3f803f80
M a[168:171], a[212:215], a[236:239], a[168:171]
M a[168:171], a[208:211], a[232:235], a[168:171]
buffer_load_dwordx4 v4, s[8:11], s23 offen offset:2048 lds
v_cmp_lt_i32 vcc, -7, v128
s_nop 1
v_cndmask_b32 v146, 0, v129, vcc
M a[172:175], a[216:219], a[232:235], a[172:175]
M a[172:175], a[220:223], a[236:239], a[172:175]
s_waitcnt lgkmcnt(4)
M a[68:71], a[176:179], a[240:243], a[68:71]
ds_read_b128 a[232:235], v10 offset:6144
ds_read_b128 a[236:239], v11 offset:6144
v_subrev_u32 v130, 2, v128
v_cmp_lt_u32 vcc, 7, v130
s_nop 1
v_cndmask_b32 v150, 0, v129, vcc
M a[68:71], a[180:183], a[244:247], a[68:71]
buffer_load_dwordx4 v5, s[8:11], s23 offen offset:3072 lds
v_min_f32 v154, s3, v146
v_mov_b32 v158, 0x3f803f80
M a[72:75], a[188:191], a[244:247], a[72:75]
ds_read_b64_tr_b16 a[200:201], v14 offset:0
ds_read_b64_tr_b16 a[202:203], v14 offset:1536
M a[72:75], a[184:187], a[240:243], a[72:75]
v_cmp_lt_i32 vcc, -6, v128
s_nop 1
v_cndmask_b32 v147, 0, v129, vcc
M a[76:79], a[192:195], a[240:243], a[76:79]
v_subrev_u32 v130, 3, v128
v_cmp_lt_u32 vcc, 7, v130
s_nop 1
v_cndmask_b32 v151, 0, v129, vcc
M a[76:79], a[196:199], a[244:247], a[76:79]
s_sub_u32 s31, s31, 1
s_cmp_eq_u32 s31, 0
s_cselect_b32 s58, -1920, s57
s_add_u32 s23, s23, s58
s_add_u32 s24, s24, s58
s_waitcnt lgkmcnt(6)
M a[80:83], a[180:183], a[252:255], a[80:83]
ds_read_b128 a[240:243], v10 offset:8192
ds_read_b128 a[244:247], v11 offset:8192
v_min_f32 v155, s3, v147
v_mov_b32 v159, 0x3f803f80
M a[80:83], a[176:179], a[248:251], a[80:83]
s_add_u32 s16, s50, 83886080
s_addc_u32 s17, s51, 0
M a[84:87], a[184:187], a[248:251], a[84:87]
ds_read_b64_tr_b16 a[208:209], v15 offset:0
ds_read_b64_tr_b16 a[210:211], v15 offset:1536
M a[84:87], a[188:191], a[252:255], a[84:87]
s_mov_b32 s18, 4194304
s_mov_b32 s19, 0x00020000
M a[88:91], a[196:199], a[252:255], a[88:91]
s_add_u32 m0, s30, 98304
s_nop 0
buffer_load_dwordx4 v6, s[12:15], s25 offen offset:0 lds
s_lshl_b32 s3, s26, 18
s_lshl_b32 s4, s27, 14
M a[88:91], a[192:195], a[248:251], a[88:91]
s_waitcnt lgkmcnt(8)
M a[92:95], a[176:179], a[224:227], a[92:95]
ds_read_b128 a[248:251], v10 offset:10240
ds_read_b128 a[252:255], v11 offset:10240
s_add_u32 s3, s3, s4
s_lshl_b32 s4, s21, 13
M a[92:95], a[180:183], a[228:231], a[92:95]
s_add_u32 s3, s3, s4
s_lshl_b32 s4, s22, 10
M a[96:99], a[188:191], a[228:231], a[96:99]
ds_read_b64_tr_b16 a[216:217], v16 offset:0
ds_read_b64_tr_b16 a[218:219], v16 offset:1536
M a[96:99], a[184:187], a[224:227], a[96:99]
buffer_load_dwordx4 v7, s[12:15], s25 offen offset:1024 lds
s_add_u32 s6, s3, s4
s_mov_b32 s7, 0x3e8293ee
M a[100:103], a[192:195], a[224:227], a[100:103]
s_lshl_b32 s65, s26, 8
s_lshl_b32 s3, s27, 4
M a[100:103], a[196:199], a[228:231], a[100:103]
s_waitcnt lgkmcnt(10)
M a[104:107], a[180:183], a[236:239], a[104:107]
ds_read_b128 a[224:227], v10 offset:12288
ds_read_b128 a[228:231], v11 offset:12288
s_add_u32 s65, s65, s3
s_lshl_b32 s3, s101, 2
M a[104:107], a[176:179], a[232:235], a[104:107]
buffer_load_dwordx4 v8, s[12:15], s25 offen offset:2048 lds
s_add_u32 s65, s65, s3
s_add_u32 s65, s65, 8400896
M a[108:111], a[184:187], a[232:235], a[108:111]
ds_read_b64_tr_b16 a[204:205], v14 offset:12288
ds_read_b64_tr_b16 a[206:207], v14 offset:13824
M a[108:111], a[188:191], a[236:239], a[108:111]
s_mov_b32 s40, 0
v_mov_b32 v23, 0
M a[112:115], a[196:199], a[236:239], a[112:115]
s_mov_b64 s[4:5], s[50:51]
s_and_b32 s20, s2, 7
M a[112:115], a[192:195], a[232:235], a[112:115]
buffer_load_dwordx4 v9, s[12:15], s25 offen offset:3072 lds
s_waitcnt lgkmcnt(10)
M a[116:119], a[176:179], a[240:243], a[116:119]
ds_read_b128 a[232:235], v10 offset:14336
ds_read_b128 a[236:239], v11 offset:14336
s_lshr_b32 s33, s2, 6
s_lshl_b32 s33, s33, 3
M a[116:119], a[180:183], a[244:247], a[116:119]
s_add_u32 s20, s20, s33
s_bfe_u32 s21, s2, 0x30003
M a[120:123], a[188:191], a[244:247], a[120:123]
ds_read_b64_tr_b16 a[212:213], v15 offset:12288
ds_read_b64_tr_b16 a[214:215], v15 offset:13824
M a[120:123], a[184:187], a[240:243], a[120:123]
s_sub_u32 s35, 15, s21
s_cmp_lt_u32 s101, 2
s_cselect_b32 s35, s21, s35
M a[124:127], a[192:195], a[240:243], a[124:127]
s_add_u32 m0, s30, 102400
s_nop 0
buffer_load_dwordx4 v21, s[12:15], s25 offen offset:0 lds
s_lshl_b32 s33, s20, 7
s_lshl_b32 s34, s35, 3
M a[124:127], a[196:199], a[244:247], a[124:127]
s_waitcnt lgkmcnt(10)
M a[128:131], a[180:183], a[252:255], a[128:131]
ds_read_b128 a[240:243], v10 offset:16384
ds_read_b128 a[244:247], v11 offset:16384
s_add_u32 s33, s33, s34
s_and_b32 s34, s101, 1
M a[128:131], a[176:179], a[248:251], a[128:131]
s_lshl_b32 s34, s34, 2
s_add_u32 s33, s33, s34
M a[132:135], a[184:187], a[248:251], a[132:135]
ds_read_b64_tr_b16 a[220:221], v16 offset:12288
ds_read_b64_tr_b16 a[222:223], v16 offset:13824
M a[132:135], a[188:191], a[252:255], a[132:135]
buffer_load_dwordx4 v22, s[12:15], s25 offen offset:1024 lds
s_lshl_b32 s64, s33, 12
s_mov_b32 s44, s4
M a[136:139], a[196:199], a[252:255], a[136:139]
s_mov_b32 s45, s5
s_mov_b32 s46, 16777216
M a[136:139], a[192:195], a[248:251], a[136:139]
s_waitcnt lgkmcnt(10)
M a[140:143], a[176:179], a[224:227], a[140:143]
s_sub_u32 s54, s54, 1
s_cmp_eq_u32 s54, 0
s_cselect_b32 s58, s55, s56
s_add_u32 s25, s25, s58
s_mov_b32 s47, 0x00020000
M a[140:143], a[180:183], a[228:231], a[140:143]
M a[144:147], a[188:191], a[228:231], a[144:147]
M a[144:147], a[184:187], a[224:227], a[144:147]
M a[148:151], a[192:195], a[224:227], a[148:151]
s_waitcnt vmcnt(11) lgkmcnt(0)
s_barrier
ds_read_b128 a[248:251], v10 offset:18432
ds_read_b128 a[252:255], v11 offset:18432
M a[148:151], a[196:199], a[228:231], a[148:151]
s_add_u32 m0, s28, 0
s_mov_b32 exec_hi, 0
buffer_load_dwordx4 v20, s[8:11], s24 offen lds
s_mov_b32 exec_hi, -1
M a[152:155], a[180:183], a[236:239], a[152:155]
ds_read_b128 a[224:227], v10 offset:20480
ds_read_b128 a[228:231], v11 offset:20480
M a[152:155], a[176:179], a[232:235], a[152:155]
M a[156:159], a[184:187], a[232:235], a[156:159]
s_add_u32 m0, s29, 2048
s_nop 0
buffer_load_dwordx4 v2, s[8:11], s23 offen offset:0 lds
M a[156:159], a[188:191], a[236:239], a[156:159]
M a[160:163], a[196:199], a[236:239], a[160:163]
M a[160:163], a[192:195], a[232:235], a[160:163]
buffer_load_dwordx4 v3, s[8:11], s23 offen offset:1024 lds
M a[164:167], a[176:179], a[240:243], a[164:167]
ds_read_b128 a[232:235], v10 offset:22528
ds_read_b128 a[236:239], v11 offset:22528
M a[164:167], a[180:183], a[244:247], a[164:167]
M a[168:171], a[188:191], a[244:247], a[168:171]
M a[168:171], a[184:187], a[240:243], a[168:171]
buffer_load_dwordx4 v4, s[8:11], s23 offen offset:2048 lds
M a[172:175], a[192:195], a[240:243], a[172:175]
M a[172:175], a[196:199], a[244:247], a[172:175]
s_waitcnt lgkmcnt(4)
M a[68:71], a[200:203], a[248:251], a[68:71]
ds_read_b128 a[240:243], v10 offset:24576
ds_read_b128 a[244:247], v11 offset:24576
M a[68:71], a[204:207], a[252:255], a[68:71]
buffer_load_dwordx4 v5, s[8:11], s23 offen offset:3072 lds
M a[72:75], a[212:215], a[252:255], a[72:75]
ds_read_b64_tr_b16 a[176:177], v14 offset:28672
ds_read_b64_tr_b16 a[178:179], v14 offset:30208
M a[72:75], a[208:211], a[248:251], a[72:75]
M a[76:79], a[216:219], a[248:251], a[76:79]
M a[76:79], a[220:223], a[252:255], a[76:79]
s_sub_u32 s31, s31, 1
s_cmp_eq_u32 s31, 0
s_cselect_b32 s58, -1920, s57
s_add_u32 s23, s23, s58
s_add_u32 s24, s24, s58
s_waitcnt lgkmcnt(6)
M a[80:83], a[204:207], a[228:231], a[80:83]
ds_read_b128 a[248:251], v10 offset:26624
ds_read_b128 a[252:255], v11 offset:26624
M a[80:83], a[200:203], a[224:227], a[80:83]
M a[84:87], a[208:211], a[224:227], a[84:87]
ds_read_b64_tr_b16 a[184:185], v15 offset:28672
ds_read_b64_tr_b16 a[186:187], v15 offset:30208
M a[84:87], a[212:215], a[228:231], a[84:87]
M a[88:91], a[220:223], a[228:231], a[88:91]
s_add_u32 m0, s30, 36864
s_nop 0
buffer_load_dwordx4 v6, s[12:15], s25 offen offset:0 lds
M a[88:91], a[216:219], a[224:227], a[88:91]
s_waitcnt lgkmcnt(8)
M a[92:95], a[200:203], a[232:235], a[92:95]
ds_read_b128 a[224:227], v10 offset:28672
ds_read_b128 a[228:231], v11 offset:28672
M a[92:95], a[204:207], a[236:239], a[92:95]
M a[96:99], a[212:215], a[236:239], a[96:99]
ds_read_b64_tr_b16 a[192:193], v16 offset:28672
ds_read_b64_tr_b16 a[194:195], v16 offset:30208
M a[96:99], a[208:211], a[232:235], a[96:99]
buffer_load_dwordx4 v7, s[12:15], s25 offen offset:1024 lds
M a[100:103], a[216:219], a[232:235], a[100:103]
M a[100:103], a[220:223], a[236:239], a[100:103]
s_waitcnt lgkmcnt(10)
M a[104:107], a[204:207], a[244:247], a[104:107]
ds_read_b128 a[232:235], v10 offset:30720
ds_read_b128 a[236:239], v11 offset:30720
M a[104:107], a[200:203], a[240:243], a[104:107]
buffer_load_dwordx4 v8, s[12:15], s25 offen offset:2048 lds
M a[108:111], a[208:211], a[240:243], a[108:111]
ds_read_b64_tr_b16 a[180:181], v14 offset:40960
ds_read_b64_tr_b16 a[182:183], v14 offset:42496
M a[108:111], a[212:215], a[244:247], a[108:111]
M a[112:115], a[220:223], a[244:247], a[112:115]
M a[112:115], a[216:219], a[240:243], a[112:115]
buffer_load_dwordx4 v9, s[12:15], s25 offen offset:3072 lds
s_waitcnt lgkmcnt(10)
M a[116:119], a[200:203], a[248:251], a[116:119]
ds_read_b128 a[240:243], v10 offset:32768
ds_read_b128 a[244:247], v11 offset:32768
M a[116:119], a[204:207], a[252:255], a[116:119]
M a[120:123], a[212:215], a[252:255], a[120:123]
ds_read_b64_tr_b16 a[188:189], v15 offset:40960
ds_read_b64_tr_b16 a[190:191], v15 offset:42496
M a[120:123], a[208:211], a[248:251], a[120:123]
M a[124:127], a[216:219], a[248:251], a[124:127]
s_add_u32 m0, s30, 40960
s_nop 0
buffer_load_dwordx4 v21, s[12:15], s25 offen offset:0 lds
M a[124:127], a[220:223], a[252:255], a[124:127]
s_waitcnt lgkmcnt(10)
M a[128:131], a[204:207], a[228:231], a[128:131]
ds_read_b128 a[248:251], v10 offset:34816
ds_read_b128 a[252:255], v11 offset:34816
M a[128:131], a[200:203], a[224:227], a[128:131]
M a[132:135], a[208:211], a[224:227], a[132:135]
ds_read_b64_tr_b16 a[196:197], v16 offset:40960
ds_read_b64_tr_b16 a[198:199], v16 offset:42496
M a[132:135], a[212:215], a[228:231], a[132:135]
buffer_load_dwordx4 v22, s[12:15], s25 offen offset:1024 lds
M a[136:139], a[220:223], a[228:231], a[136:139]
M a[136:139], a[216:219], a[224:227], a[136:139]
s_waitcnt lgkmcnt(10)
M a[140:143], a[200:203], a[232:235], a[140:143]
s_sub_u32 s54, s54, 1
s_cmp_eq_u32 s54, 0
s_cselect_b32 s58, s55, s56
s_add_u32 s25, s25, s58
M a[140:143], a[204:207], a[236:239], a[140:143]
M a[144:147], a[212:215], a[236:239], a[144:147]
M a[144:147], a[208:211], a[232:235], a[144:147]
M a[148:151], a[216:219], a[232:235], a[148:151]
s_waitcnt vmcnt(11) lgkmcnt(0)
s_barrier
ds_read_b128 a[224:227], v12 offset:0
ds_read_b128 a[228:231], v13 offset:0
M a[148:151], a[220:223], a[236:239], a[148:151]
s_add_u32 m0, s28, 18432
s_mov_b32 exec_hi, 0
buffer_load_dwordx4 v20, s[8:11], s24 offen lds
s_mov_b32 exec_hi, -1
M a[152:155], a[204:207], a[244:247], a[152:155]
ds_read_b128 a[232:235], v12 offset:2048
ds_read_b128 a[236:239], v13 offset:2048
M a[152:155], a[200:203], a[240:243], a[152:155]
M a[156:159], a[208:211], a[240:243], a[156:159]
s_add_u32 m0, s29, 20480
s_nop 0
buffer_load_dwordx4 v2, s[8:11], s23 offen offset:0 lds
M a[156:159], a[212:215], a[244:247], a[156:159]
M a[160:163], a[220:223], a[244:247], a[160:163]
M a[160:163], a[216:219], a[240:243], a[160:163]
buffer_load_dwordx4 v3, s[8:11], s23 offen offset:1024 lds
M a[164:167], a[200:203], a[248:251], a[164:167]
ds_read_b128 a[240:243], v12 offset:4096
ds_read_b128 a[244:247], v13 offset:4096
M a[164:167], a[204:207], a[252:255], a[164:167]
M a[168:171], a[212:215], a[252:255], a[168:171]
M a[168:171], a[208:211], a[248:251], a[168:171]
buffer_load_dwordx4 v4, s[8:11], s23 offen offset:2048 lds
M a[172:175], a[216:219], a[248:251], a[172:175]
M a[172:175], a[220:223], a[252:255], a[172:175]
s_waitcnt lgkmcnt(4)
M a[68:71], a[176:179], a[224:227], a[68:71]
ds_read_b128 a[248:251], v12 offset:6144
ds_read_b128 a[252:255], v13 offset:6144
M a[68:71], a[180:183], a[228:231], a[68:71]
buffer_load_dwordx4 v5, s[8:11], s23 offen offset:3072 lds
M a[72:75], a[188:191], a[228:231], a[72:75]
ds_read_b64_tr_b16 a[200:201], v17 offset:0
ds_read_b64_tr_b16 a[202:203], v17 offset:1536
M a[72:75], a[184:187], a[224:227], a[72:75]
M a[76:79], a[192:195], a[224:227], a[76:79]
s_sub_u32 s31, s31, 1
s_cmp_eq_u32 s31, 0
s_cselect_b32 s58, -1920, s57
s_add_u32 s23, s23, s58
s_add_u32 s24, s24, s58
M a[76:79], a[196:199], a[228:231], a[76:79]
s_waitcnt lgkmcnt(6)
M a[80:83], a[180:183], a[236:239], a[80:83]
ds_read_b128 a[224:227], v12 offset:8192
ds_read_b128 a[228:231], v13 offset:8192
M a[80:83], a[176:179], a[232:235], a[80:83]
M a[84:87], a[184:187], a[232:235], a[84:87]
ds_read_b64_tr_b16 a[208:209], v18 offset:0
ds_read_b64_tr_b16 a[210:211], v18 offset:1536
M a[84:87], a[188:191], a[236:239], a[84:87]
s_add_u32 m0, s30, 65536
s_nop 0
buffer_load_dwordx4 v6, s[12:15], s25 offen offset:0 lds
M a[88:91], a[196:199], a[236:239], a[88:91]
M a[88:91], a[192:195], a[232:235], a[88:91]
s_waitcnt lgkmcnt(8)
M a[92:95], a[176:179], a[240:243], a[92:95]
ds_read_b128 a[232:235], v12 offset:10240
ds_read_b128 a[236:239], v13 offset:10240
M a[92:95], a[180:183], a[244:247], a[92:95]
buffer_load_dwordx4 v7, s[12:15], s25 offen offset:1024 lds
M a[96:99], a[188:191], a[244:247], a[96:99]
ds_read_b64_tr_b16 a[216:217], v19 offset:0
ds_read_b64_tr_b16 a[218:219], v19 offset:1536
M a[96:99], a[184:187], a[240:243], a[96:99]
M a[100:103], a[192:195], a[240:243], a[100:103]
buffer_load_dwordx4 v8, s[12:15], s25 offen offset:2048 lds
M a[100:103], a[196:199], a[244:247], a[100:103]
s_waitcnt lgkmcnt(10)
M a[104:107], a[180:183], a[252:255], a[104:107]
ds_read_b128 a[240:243], v12 offset:12288
ds_read_b128 a[244:247], v13 offset:12288
M a[104:107], a[176:179], a[248:251], a[104:107]
M a[108:111], a[184:187], a[248:251], a[108:111]
ds_read_b64_tr_b16 a[204:205], v17 offset:12288
ds_read_b64_tr_b16 a[206:207], v17 offset:13824
M a[108:111], a[188:191], a[252:255], a[108:111]
buffer_load_dwordx4 v9, s[12:15], s25 offen offset:3072 lds
M a[112:115], a[196:199], a[252:255], a[112:115]
M a[112:115], a[192:195], a[248:251], a[112:115]
s_waitcnt lgkmcnt(10)
M a[116:119], a[176:179], a[224:227], a[116:119]
ds_read_b128 a[248:251], v12 offset:14336
ds_read_b128 a[252:255], v13 offset:14336
M a[116:119], a[180:183], a[228:231], a[116:119]
s_add_u32 m0, s30, 69632
s_nop 0
buffer_load_dwordx4 v21, s[12:15], s25 offen offset:0 lds
M a[120:123], a[188:191], a[228:231], a[120:123]
ds_read_b64_tr_b16 a[212:213], v18 offset:12288
ds_read_b64_tr_b16 a[214:215], v18 offset:13824
M a[120:123], a[184:187], a[224:227], a[120:123]
M a[124:127], a[192:195], a[224:227], a[124:127]
buffer_load_dwordx4 v22, s[12:15], s25 offen offset:1024 lds
M a[124:127], a[196:199], a[228:231], a[124:127]
s_waitcnt lgkmcnt(10)
M a[128:131], a[180:183], a[236:239], a[128:131]
ds_read_b128 a[224:227], v12 offset:16384
ds_read_b128 a[228:231], v13 offset:16384
M a[128:131], a[176:179], a[232:235], a[128:131]
M a[132:135], a[184:187], a[232:235], a[132:135]
ds_read_b64_tr_b16 a[220:221], v19 offset:12288
ds_read_b64_tr_b16 a[222:223], v19 offset:13824
M a[132:135], a[188:191], a[236:239], a[132:135]
s_sub_u32 s54, s54, 1
s_cmp_eq_u32 s54, 0
s_cselect_b32 s58, s55, s56
s_add_u32 s25, s25, s58
M a[136:139], a[196:199], a[236:239], a[136:139]
M a[136:139], a[192:195], a[232:235], a[136:139]
s_waitcnt lgkmcnt(10)
M a[140:143], a[176:179], a[240:243], a[140:143]
buffer_load_dword v125, v23, s[36:39], 0 offen sc1
M a[140:143], a[180:183], a[244:247], a[140:143]
M a[144:147], a[188:191], a[244:247], a[144:147]
M a[144:147], a[184:187], a[240:243], a[144:147]
M a[148:151], a[192:195], a[240:243], a[148:151]
s_waitcnt vmcnt(12) lgkmcnt(0)
s_barrier
ds_read_b128 a[232:235], v10 offset:0
ds_read_b128 a[236:239], v11 offset:0
s_waitcnt vmcnt(0)
v_cmp_gt_u32 vcc, 0x80, v125
s_nop 0
s_cbranch_vccnz Lk1_spinq
Lk1_gotq:
M a[148:151], a[196:199], a[244:247], a[148:151]
s_add_u32 m0, s28, 131072
s_mov_b32 exec_hi, 0
buffer_load_dwordx4 v20, s[8:11], s24 offen lds
s_mov_b32 exec_hi, -1
M a[152:155], a[180:183], a[252:255], a[152:155]
ds_read_b128 a[240:243], v10 offset:2048
ds_read_b128 a[244:247], v11 offset:2048
M a[152:155], a[176:179], a[248:251], a[152:155]
M a[156:159], a[184:187], a[248:251], a[156:159]
s_add_u32 m0, s29, 133120
s_nop 0
buffer_load_dwordx4 v2, s[8:11], s23 offen offset:0 lds
M a[156:159], a[188:191], a[252:255], a[156:159]
M a[160:163], a[196:199], a[252:255], a[160:163]
M a[160:163], a[192:195], a[248:251], a[160:163]
buffer_load_dwordx4 v3, s[8:11], s23 offen offset:1024 lds
M a[164:167], a[176:179], a[224:227], a[164:167]
ds_read_b128 a[248:251], v10 offset:4096
ds_read_b128 a[252:255], v11 offset:4096
M a[164:167], a[180:183], a[228:231], a[164:167]
M a[168:171], a[188:191], a[228:231], a[168:171]
M a[168:171], a[184:187], a[224:227], a[168:171]
buffer_load_dwordx4 v4, s[8:11], s23 offen offset:2048 lds
M a[172:175], a[192:195], a[224:227], a[172:175]
M a[172:175], a[196:199], a[228:231], a[172:175]
s_waitcnt lgkmcnt(4)
M a[68:71], a[200:203], a[232:235], a[68:71]
ds_read_b128 a[224:227], v10 offset:6144
ds_read_b128 a[228:231], v11 offset:6144
v_mov_b32 v208, 0
v_mov_b32 v209, 0
M a[68:71], a[204:207], a[236:239], a[68:71]
buffer_load_dwordx4 v5, s[8:11], s23 offen offset:3072 lds
M a[72:75], a[212:215], a[236:239], a[72:75]
ds_read_b64_tr_b16 a[176:177], v14 offset:0
ds_read_b64_tr_b16 a[178:179], v14 offset:1536
v_mov_b32 v210, 0
v_mov_b32 v211, 0
M a[72:75], a[208:211], a[232:235], a[72:75]
M a[76:79], a[216:219], a[232:235], a[76:79]
s_sub_u32 s31, s31, 1
s_cmp_eq_u32 s31, 0
s_cselect_b32 s58, -1920, s57
s_add_u32 s23, s23, s58
s_add_u32 s24, s24, s58
v_mov_b32 v212, 0
v_mov_b32 v213, 0
M a[76:79], a[220:223], a[236:239], a[76:79]
s_waitcnt lgkmcnt(6)
M a[80:83], a[204:207], a[244:247], a[80:83]
ds_read_b128 a[232:235], v10 offset:8192
ds_read_b128 a[236:239], v11 offset:8192
v_mov_b32 v214, 0
v_mov_b32 v215, 0
M a[80:83], a[200:203], a[240:243], a[80:83]
M a[84:87], a[208:211], a[240:243], a[84:87]
ds_read_b64_tr_b16 a[184:185], v15 offset:0
ds_read_b64_tr_b16 a[186:187], v15 offset:1536
M a[84:87], a[212:215], a[244:247], a[84:87]
buffer_load_dwordx4 a[0:3], v1, s[44:47], s64 offen offset:0 sc1
v_mov_b32 v216, 0
v_mov_b32 v217, 0
M a[88:91], a[220:223], a[244:247], a[88:91]
M a[88:91], a[216:219], a[240:243], a[88:91]
s_waitcnt lgkmcnt(8)
v_mov_b32 v218, 0
v_mov_b32 v219, 0
M a[92:95], a[200:203], a[248:251], a[92:95]
ds_read_b128 a[240:243], v10 offset:10240
ds_read_b128 a[244:247], v11 offset:10240
M a[92:95], a[204:207], a[252:255], a[92:95]
buffer_load_dwordx4 a[4:7], v1, s[44:47], s64 offen offset:1024 sc1
v_mov_b32 v220, 0
v_mov_b32 v221, 0
M a[96:99], a[212:215], a[252:255], a[96:99]
ds_read_b64_tr_b16 a[192:193], v16 offset:0
ds_read_b64_tr_b16 a[194:195], v16 offset:1536
M a[96:99], a[208:211], a[248:251], a[96:99]
v_mov_b32 v222, 0
v_mov_b32 v223, 0
M a[100:103], a[216:219], a[248:251], a[100:103]
buffer_load_dwordx4 a[8:11], v1, s[44:47], s64 offen offset:2048 sc1
M a[100:103], a[220:223], a[252:255], a[100:103]
s_waitcnt lgkmcnt(10)
M a[104:107], a[204:207], a[228:231], a[104:107]
ds_read_b128 a[248:251], v10 offset:12288
ds_read_b128 a[252:255], v11 offset:12288
v_mov_b32 v224, 0
v_mov_b32 v225, 0
M a[104:107], a[200:203], a[224:227], a[104:107]
M a[108:111], a[208:211], a[224:227], a[108:111]
ds_read_b64_tr_b16 a[180:181], v14 offset:12288
ds_read_b64_tr_b16 a[182:183], v14 offset:13824
v_mov_b32 v226, 0
v_mov_b32 v227, 0
M a[108:111], a[212:215], a[228:231], a[108:111]
buffer_load_dwordx4 a[12:15], v1, s[44:47], s64 offen offset:3072 sc1
s_add_u32 s64, s64, 4096
M a[112:115], a[220:223], a[228:231], a[112:115]
v_mov_b32 v228, 0
v_mov_b32 v229, 0
M a[112:115], a[216:219], a[224:227], a[112:115]
s_waitcnt lgkmcnt(10)
M a[116:119], a[200:203], a[232:235], a[116:119]
ds_read_b128 a[224:227], v10 offset:14336
ds_read_b128 a[228:231], v11 offset:14336
v_mov_b32 v230, 0
v_mov_b32 v231, 0
M a[116:119], a[204:207], a[236:239], a[116:119]
buffer_load_dwordx4 a[16:19], v1, s[44:47], s64 offen offset:0 sc1
M a[120:123], a[212:215], a[236:239], a[120:123]
ds_read_b64_tr_b16 a[188:189], v15 offset:12288
ds_read_b64_tr_b16 a[190:191], v15 offset:13824
M a[120:123], a[208:211], a[232:235], a[120:123]
v_mov_b32 v232, 0
v_mov_b32 v233, 0
M a[124:127], a[216:219], a[232:235], a[124:127]
buffer_load_dwordx4 a[20:23], v1, s[44:47], s64 offen offset:1024 sc1
M a[124:127], a[220:223], a[236:239], a[124:127]
s_waitcnt lgkmcnt(10)
v_mov_b32 v234, 0
v_mov_b32 v235, 0
M a[128:131], a[204:207], a[244:247], a[128:131]
ds_read_b128 a[232:235], v10 offset:16384
ds_read_b128 a[236:239], v11 offset:16384
M a[128:131], a[200:203], a[240:243], a[128:131]
v_mov_b32 v236, 0
v_mov_b32 v237, 0
M a[132:135], a[208:211], a[240:243], a[132:135]
ds_read_b64_tr_b16 a[196:197], v16 offset:12288
ds_read_b64_tr_b16 a[198:199], v16 offset:13824
M a[132:135], a[212:215], a[244:247], a[132:135]
buffer_load_dwordx4 a[24:27], v1, s[44:47], s64 offen offset:2048 sc1
v_mov_b32 v238, 0
v_mov_b32 v239, 0
M a[136:139], a[220:223], a[244:247], a[136:139]
M a[136:139], a[216:219], a[240:243], a[136:139]
s_waitcnt lgkmcnt(10)
M a[140:143], a[200:203], a[248:251], a[140:143]
buffer_load_dwordx4 a[28:31], v1, s[44:47], s64 offen offset:3072 sc1
s_add_u32 s64, s64, 4096
v_mov_b32 v240, 0
v_mov_b32 v241, 0
M a[140:143], a[204:207], a[252:255], a[140:143]
M a[144:147], a[212:215], a[252:255], a[144:147]
v_mov_b32 v242, 0
v_mov_b32 v243, 0
M a[144:147], a[208:211], a[248:251], a[144:147]
M a[148:151], a[216:219], a[248:251], a[148:151]
s_waitcnt vmcnt(14) lgkmcnt(0)
s_barrier
ds_read_b128 a[240:243], v10 offset:18432
ds_read_b128 a[244:247], v11 offset:18432
v_mov_b32 v244, 0
v_mov_b32 v245, 0
M a[148:151], a[220:223], a[252:255], a[148:151]
buffer_load_dwordx4 a[32:35], v1, s[44:47], s64 offen offset:0 sc1
M a[152:155], a[204:207], a[228:231], a[152:155]
ds_read_b128 a[248:251], v10 offset:20480
ds_read_b128 a[252:255], v11 offset:20480
v_mov_b32 v246, 0
v_mov_b32 v247, 0
M a[152:155], a[200:203], a[224:227], a[152:155]
M a[156:159], a[208:211], a[224:227], a[156:159]
buffer_load_dwordx4 a[36:39], v1, s[44:47], s64 offen offset:1024 sc1
M a[156:159], a[212:215], a[228:231], a[156:159]
v_mov_b32 v248, 0
v_mov_b32 v249, 0
M a[160:163], a[220:223], a[228:231], a[160:163]
M a[160:163], a[216:219], a[224:227], a[160:163]
buffer_load_dwordx4 a[40:43], v1, s[44:47], s64 offen offset:2048 sc1
v_mov_b32 v250, 0
v_mov_b32 v251, 0
M a[164:167], a[200:203], a[232:235], a[164:167]
ds_read_b128 a[224:227], v10 offset:22528
ds_read_b128 a[228:231], v11 offset:22528
M a[164:167], a[204:207], a[236:239], a[164:167]
v_mov_b32 v252, 0
v_mov_b32 v253, 0
M a[168:171], a[212:215], a[236:239], a[168:171]
M a[168:171], a[208:211], a[232:235], a[168:171]
buffer_load_dwordx4 a[44:47], v1, s[44:47], s64 offen offset:3072 sc1
s_add_u32 s64, s64, 4096
v_mov_b32 v254, 0
v_mov_b32 v255, 0
M a[172:175], a[216:219], a[232:235], a[172:175]
M a[172:175], a[220:223], a[236:239], a[172:175]
s_waitcnt lgkmcnt(4)
M a[68:71], a[176:179], a[240:243], a[68:71]
ds_read_b128 a[232:235], v10 offset:24576
ds_read_b128 a[236:239], v11 offset:24576
s_mov_b32 s22, s101
s_and_b32 s23, s22, 1
M a[68:71], a[180:183], a[244:247], a[68:71]
buffer_load_dwordx4 a[48:51], v1, s[44:47], s64 offen offset:0 sc1
M a[72:75], a[188:191], a[244:247], a[72:75]
ds_read_b64_tr_b16 a[200:201], v14 offset:28672
ds_read_b64_tr_b16 a[202:203], v14 offset:30208
s_lshr_b32 s24, s22, 1
s_lshl_b32 s33, s24, 14
M a[72:75], a[184:187], a[240:243], a[72:75]
M a[76:79], a[192:195], a[240:243], a[76:79]
M a[76:79], a[196:199], a[244:247], a[76:79]
s_waitcnt lgkmcnt(6)
s_lshl_b32 s34, s23, 13
s_add_u32 s29, s33, s34
M a[80:83], a[180:183], a[252:255], a[80:83]
ds_read_b128 a[240:243], v10 offset:26624
ds_read_b128 a[244:247], v11 offset:26624
M a[80:83], a[176:179], a[248:251], a[80:83]
s_lshl_b32 s28, s20, 20
s_add_u32 s28, s28, s34
M a[84:87], a[184:187], a[248:251], a[84:87]
ds_read_b64_tr_b16 a[208:209], v15 offset:28672
ds_read_b64_tr_b16 a[210:211], v15 offset:30208
M a[84:87], a[188:191], a[252:255], a[84:87]
buffer_load_dwordx4 a[52:55], v1, s[44:47], s64 offen offset:1024 sc1
M a[88:91], a[196:199], a[252:255], a[88:91]
s_mov_b32 s25, s28
s_lshl_b32 s33, s21, 16
M a[88:91], a[192:195], a[248:251], a[88:91]
s_waitcnt lgkmcnt(8)
M a[92:95], a[176:179], a[224:227], a[92:95]
ds_read_b128 a[248:251], v10 offset:28672
ds_read_b128 a[252:255], v11 offset:28672
s_add_u32 s34, s28, s33
s_add_u32 s34, s34, 65536
M a[92:95], a[180:183], a[228:231], a[92:95]
M a[96:99], a[188:191], a[228:231], a[96:99]
ds_read_b64_tr_b16 a[216:217], v16 offset:28672
ds_read_b64_tr_b16 a[218:219], v16 offset:30208
M a[96:99], a[184:187], a[224:227], a[96:99]
s_add_u32 s32, s28, 491520
s_sub_u32 s33, s32, s33
M a[100:103], a[192:195], a[224:227], a[100:103]
buffer_load_dwordx4 a[56:59], v1, s[44:47], s64 offen offset:2048 sc1
M a[100:103], a[196:199], a[228:231], a[100:103]
s_waitcnt lgkmcnt(10)
s_add_u32 s33, s33, 491520
s_cmp_eq_u32 s24, 0
s_cselect_b32 s27, s34, s32
s_cselect_b32 s28, s32, s33
M a[104:107], a[180:183], a[236:239], a[104:107]
ds_read_b128 a[224:227], v10 offset:30720
ds_read_b128 a[228:231], v11 offset:30720
M a[104:107], a[176:179], a[232:235], a[104:107]
M a[108:111], a[184:187], a[232:235], a[108:111]
ds_read_b64_tr_b16 a[204:205], v14 offset:40960
ds_read_b64_tr_b16 a[206:207], v14 offset:42496
s_add_u32 s26, s25, 16384
s_add_u32 s62, s27, 16384
M a[108:111], a[188:191], a[236:239], a[108:111]
M a[112:115], a[196:199], a[236:239], a[112:115]
s_add_u32 s63, s28, 16384
s_lshl_b32 s31, s21, 7
M a[112:115], a[192:195], a[232:235], a[112:115]
s_waitcnt lgkmcnt(10)
M a[116:119], a[176:179], a[240:243], a[116:119]
ds_read_b128 a[232:235], v10 offset:32768
ds_read_b128 a[236:239], v11 offset:32768
M a[116:119], a[180:183], a[244:247], a[116:119]
buffer_load_dwordx4 a[60:63], v1, s[44:47], s64 offen offset:3072 sc1
s_cmp_eq_u32 s24, 0
s_cselect_b32 s31, s31, 960
M a[120:123], a[188:191], a[244:247], a[120:123]
ds_read_b64_tr_b16 a[212:213], v15 offset:40960
ds_read_b64_tr_b16 a[214:215], v15 offset:42496
M a[120:123], a[184:187], a[240:243], a[120:123]
s_mov_b32 s60, 0
s_add_u32 s12, s4, 16777216
s_addc_u32 s13, s5, 0
M a[124:127], a[192:195], a[240:243], a[124:127]
M a[124:127], a[196:199], a[244:247], a[124:127]
s_waitcnt lgkmcnt(10)
M a[128:131], a[180:183], a[252:255], a[128:131]
ds_read_b128 a[240:243], v10 offset:34816
ds_read_b128 a[244:247], v11 offset:34816
s_mov_b32 s14, 33554432
s_mov_b32 s15, 0x00020000
M a[128:131], a[176:179], a[248:251], a[128:131]
M a[132:135], a[184:187], a[248:251], a[132:135]
ds_read_b64_tr_b16 a[220:221], v16 offset:40960
ds_read_b64_tr_b16 a[222:223], v16 offset:42496
s_mov_b32 s8, s4
s_mov_b32 s9, s5
M a[132:135], a[188:191], a[252:255], a[132:135]
buffer_load_dword v126, v23, s[36:39], 0 offen offset:128 sc1
M a[136:139], a[196:199], a[252:255], a[136:139]
M a[136:139], a[192:195], a[248:251], a[136:139]
s_waitcnt lgkmcnt(10)
s_mov_b32 s10, 16777216
s_mov_b32 s11, 0x00020000
M a[140:143], a[176:179], a[224:227], a[140:143]
M a[140:143], a[180:183], a[228:231], a[140:143]
M a[144:147], a[188:191], a[228:231], a[144:147]
M a[144:147], a[184:187], a[224:227], a[144:147]
M a[148:151], a[192:195], a[224:227], a[148:151]
s_waitcnt vmcnt(17) lgkmcnt(0)
s_barrier
ds_read_b128 a[248:251], v12 offset:0
ds_read_b128 a[252:255], v13 offset:0
s_waitcnt vmcnt(0)
v_cmp_gt_u32 vcc, 0x80, v126
s_nop 0
s_cbranch_vccnz Lk1_spin
Lk1_got:
M a[148:151], a[196:199], a[228:231], a[148:151]
s_add_u32 m0, s29, 65536
s_add_u32 s32, s25, 4096
buffer_load_dwordx4 v1, s[12:15], s25 offen offset:0 sc1 lds
M a[152:155], a[180:183], a[236:239], a[152:155]
ds_read_b128 a[224:227], v12 offset:2048
ds_read_b128 a[228:231], v13 offset:2048
M a[152:155], a[176:179], a[232:235], a[152:155]
buffer_load_dwordx4 v1, s[12:15], s25 offen offset:1024 sc1 lds
M a[156:159], a[184:187], a[232:235], a[156:159]
M a[156:159], a[188:191], a[236:239], a[156:159]
buffer_load_dwordx4 v1, s[12:15], s25 offen offset:2048 sc1 lds
M a[160:163], a[196:199], a[236:239], a[160:163]
buffer_load_dwordx4 v1, s[12:15], s25 offen offset:3072 sc1 lds
M a[160:163], a[192:195], a[232:235], a[160:163]
M a[164:167], a[176:179], a[240:243], a[164:167]
ds_read_b128 a[232:235], v12 offset:4096
ds_read_b128 a[236:239], v13 offset:4096
M a[164:167], a[180:183], a[244:247], a[164:167]
s_add_u32 m0, s29, 69632
s_nop 0
buffer_load_dwordx4 v1, s[12:15], s32 offen offset:0 sc1 lds
M a[168:171], a[188:191], a[244:247], a[168:171]
buffer_load_dwordx4 v1, s[12:15], s32 offen offset:1024 sc1 lds
M a[168:171], a[184:187], a[240:243], a[168:171]
M a[172:175], a[192:195], a[240:243], a[172:175]
buffer_load_dwordx4 v1, s[12:15], s32 offen offset:2048 sc1 lds
M a[172:175], a[196:199], a[244:247], a[172:175]
s_waitcnt lgkmcnt(4)
M a[68:71], a[200:203], a[248:251], a[68:71]
ds_read_b128 a[240:243], v12 offset:6144
ds_read_b128 a[244:247], v13 offset:6144
M a[68:71], a[204:207], a[252:255], a[68:71]
buffer_load_dwordx4 v1, s[12:15], s32 offen offset:3072 sc1 lds
M a[72:75], a[212:215], a[252:255], a[72:75]
M a[72:75], a[208:211], a[248:251], a[72:75]
M a[76:79], a[216:219], a[248:251], a[76:79]
M a[76:79], a[220:223], a[252:255], a[76:79]
s_waitcnt lgkmcnt(4)
M a[80:83], a[204:207], a[228:231], a[80:83]
ds_read_b128 a[248:251], v12 offset:8192
ds_read_b128 a[252:255], v13 offset:8192
M a[80:83], a[200:203], a[224:227], a[80:83]
M a[84:87], a[208:211], a[224:227], a[84:87]
M a[84:87], a[212:215], a[228:231], a[84:87]
M a[88:91], a[220:223], a[228:231], a[88:91]
M a[88:91], a[216:219], a[224:227], a[88:91]
s_waitcnt lgkmcnt(4)
M a[92:95], a[200:203], a[232:235], a[92:95]
ds_read_b128 a[224:227], v12 offset:10240
ds_read_b128 a[228:231], v13 offset:10240
v_accvgpr_read_b32 v24, a68
v_accvgpr_read_b32 v25, a69
v_accvgpr_read_b32 v26, a70
M a[92:95], a[204:207], a[236:239], a[92:95]
v_accvgpr_read_b32 v27, a71
v_cvt_pk_bf16_f32 v24, v24, v25
v_cvt_pk_bf16_f32 v25, v26, v27
ds_write_b64 v124, v[24:25] offset:0
M a[96:99], a[212:215], a[236:239], a[96:99]
v_accvgpr_read_b32 v28, a72
v_accvgpr_read_b32 v29, a73
v_accvgpr_read_b32 v30, a74
M a[96:99], a[208:211], a[232:235], a[96:99]
v_accvgpr_read_b32 v31, a75
v_cvt_pk_bf16_f32 v28, v28, v29
v_cvt_pk_bf16_f32 v29, v30, v31
ds_write_b64 v124, v[28:29] offset:32
M a[100:103], a[216:219], a[232:235], a[100:103]
v_accvgpr_read_b32 v24, a76
v_accvgpr_read_b32 v25, a77
v_accvgpr_read_b32 v26, a78
M a[100:103], a[220:223], a[236:239], a[100:103]
s_waitcnt lgkmcnt(6)
v_accvgpr_read_b32 v27, a79
v_cvt_pk_bf16_f32 v24, v24, v25
v_cvt_pk_bf16_f32 v25, v26, v27
ds_write_b64 v124, v[24:25] offset:64
M a[104:107], a[204:207], a[244:247], a[104:107]
ds_read_b128 a[232:235], v12 offset:12288
ds_read_b128 a[236:239], v13 offset:12288
v_accvgpr_read_b32 v24, a80
v_accvgpr_read_b32 v25, a81
v_accvgpr_read_b32 v26, a82
M a[104:107], a[200:203], a[240:243], a[104:107]
v_accvgpr_read_b32 v27, a83
v_cvt_pk_bf16_f32 v24, v24, v25
v_cvt_pk_bf16_f32 v25, v26, v27
ds_write_b64 v124, v[24:25] offset:6400
M a[108:111], a[208:211], a[240:243], a[108:111]
v_accvgpr_read_b32 v28, a84
v_accvgpr_read_b32 v29, a85
v_accvgpr_read_b32 v30, a86
M a[108:111], a[212:215], a[244:247], a[108:111]
v_accvgpr_read_b32 v31, a87
v_cvt_pk_bf16_f32 v28, v28, v29
v_cvt_pk_bf16_f32 v29, v30, v31
ds_write_b64 v124, v[28:29] offset:6432
M a[112:115], a[220:223], a[244:247], a[112:115]
v_accvgpr_read_b32 v24, a88
v_accvgpr_read_b32 v25, a89
v_accvgpr_read_b32 v26, a90
M a[112:115], a[216:219], a[240:243], a[112:115]
s_waitcnt lgkmcnt(9)
v_accvgpr_read_b32 v27, a91
v_cvt_pk_bf16_f32 v24, v24, v25
v_cvt_pk_bf16_f32 v25, v26, v27
ds_write_b64 v124, v[24:25] offset:6464
M a[116:119], a[200:203], a[248:251], a[116:119]
ds_read_b128 a[240:243], v12 offset:14336
ds_read_b128 a[244:247], v13 offset:14336
v_accvgpr_read_b32 v24, a92
v_accvgpr_read_b32 v25, a93
v_accvgpr_read_b32 v26, a94
M a[116:119], a[204:207], a[252:255], a[116:119]
v_accvgpr_read_b32 v27, a95
v_cvt_pk_bf16_f32 v24, v24, v25
v_cvt_pk_bf16_f32 v25, v26, v27
ds_write_b64 v124, v[24:25] offset:12800
M a[120:123], a[212:215], a[252:255], a[120:123]
v_accvgpr_read_b32 v28, a96
v_accvgpr_read_b32 v29, a97
v_accvgpr_read_b32 v30, a98
M a[120:123], a[208:211], a[248:251], a[120:123]
v_accvgpr_read_b32 v31, a99
v_cvt_pk_bf16_f32 v28, v28, v29
v_cvt_pk_bf16_f32 v29, v30, v31
ds_write_b64 v124, v[28:29] offset:12832
M a[124:127], a[216:219], a[248:251], a[124:127]
v_accvgpr_read_b32 v24, a100
v_accvgpr_read_b32 v25, a101
v_accvgpr_read_b32 v26, a102
M a[124:127], a[220:223], a[252:255], a[124:127]
s_add_u32 s25, s25, 32768
s_cmp_eq_u32 s25, s27
s_cselect_b32 s25, s28, s25
s_cselect_b32 s27, -1, s27
s_waitcnt lgkmcnt(12)
v_accvgpr_read_b32 v27, a103
v_cvt_pk_bf16_f32 v24, v24, v25
v_cvt_pk_bf16_f32 v25, v26, v27
ds_write_b64 v124, v[24:25] offset:12864
M a[128:131], a[204:207], a[228:231], a[128:131]
ds_read_b128 a[248:251], v12 offset:16384
ds_read_b128 a[252:255], v13 offset:16384
v_accvgpr_read_b32 v24, a104
v_accvgpr_read_b32 v25, a105
v_accvgpr_read_b32 v26, a106
M a[128:131], a[200:203], a[224:227], a[128:131]
v_accvgpr_read_b32 v27, a107
v_cvt_pk_bf16_f32 v24, v24, v25
v_cvt_pk_bf16_f32 v25, v26, v27
ds_write_b64 v124, v[24:25] offset:19200
M a[132:135], a[208:211], a[224:227], a[132:135]
v_accvgpr_read_b32 v28, a108
v_accvgpr_read_b32 v29, a109
v_accvgpr_read_b32 v30, a110
M a[132:135], a[212:215], a[228:231], a[132:135]
v_accvgpr_read_b32 v31, a111
v_cvt_pk_bf16_f32 v28, v28, v29
v_cvt_pk_bf16_f32 v29, v30, v31
ds_write_b64 v124, v[28:29] offset:19232
M a[136:139], a[220:223], a[228:231], a[136:139]
v_accvgpr_read_b32 v24, a112
v_accvgpr_read_b32 v25, a113
v_accvgpr_read_b32 v26, a114
M a[136:139], a[216:219], a[224:227], a[136:139]
s_waitcnt lgkmcnt(12)
v_accvgpr_read_b32 v27, a115
v_cvt_pk_bf16_f32 v24, v24, v25
v_cvt_pk_bf16_f32 v25, v26, v27
ds_write_b64 v124, v[24:25] offset:19264
M a[140:143], a[200:203], a[232:235], a[140:143]
v_accvgpr_read_b32 v24, a116
v_accvgpr_read_b32 v25, a117
v_accvgpr_read_b32 v26, a118
M a[140:143], a[204:207], a[236:239], a[140:143]
v_accvgpr_read_b32 v27, a119
v_cvt_pk_bf16_f32 v24, v24, v25
v_cvt_pk_bf16_f32 v25, v26, v27
ds_write_b64 v124, v[24:25] offset:25600
M a[144:147], a[212:215], a[236:239], a[144:147]
v_accvgpr_read_b32 v28, a120
v_accvgpr_read_b32 v29, a121
v_accvgpr_read_b32 v30, a122
M a[144:147], a[208:211], a[232:235], a[144:147]
v_accvgpr_read_b32 v31, a123
v_cvt_pk_bf16_f32 v28, v28, v29
v_cvt_pk_bf16_f32 v29, v30, v31
ds_write_b64 v124, v[28:29] offset:25632
M a[148:151], a[216:219], a[232:235], a[148:151]
s_waitcnt lgkmcnt(0)
s_barrier
v_accvgpr_read_b32 v24, a124
v_accvgpr_read_b32 v25, a125
v_accvgpr_read_b32 v26, a126
M a[148:151], a[220:223], a[236:239], a[148:151]
v_accvgpr_read_b32 v27, a127
v_cvt_pk_bf16_f32 v24, v24, v25
v_cvt_pk_bf16_f32 v25, v26, v27
ds_write_b64 v124, v[24:25] offset:25664
v_accvgpr_read_b32 v24, a128
v_accvgpr_read_b32 v25, a129
v_accvgpr_read_b32 v26, a130
M a[152:155], a[204:207], a[244:247], a[152:155]
v_accvgpr_read_b32 v27, a131
v_cvt_pk_bf16_f32 v24, v24, v25
v_cvt_pk_bf16_f32 v25, v26, v27
M a[152:155], a[200:203], a[240:243], a[152:155]
ds_write_b64 v124, v[24:25] offset:32000
v_accvgpr_read_b32 v28, a132
v_accvgpr_read_b32 v29, a133
M a[156:159], a[208:211], a[240:243], a[156:159]
v_accvgpr_read_b32 v30, a134
v_accvgpr_read_b32 v31, a135
v_cvt_pk_bf16_f32 v28, v28, v29
M a[156:159], a[212:215], a[244:247], a[156:159]
v_cvt_pk_bf16_f32 v29, v30, v31
ds_write_b64 v124, v[28:29] offset:32032
v_accvgpr_read_b32 v24, a136
M a[160:163], a[220:223], a[244:247], a[160:163]
v_accvgpr_read_b32 v25, a137
v_accvgpr_read_b32 v26, a138
v_accvgpr_read_b32 v27, a139
M a[160:163], a[216:219], a[240:243], a[160:163]
v_cvt_pk_bf16_f32 v24, v24, v25
v_cvt_pk_bf16_f32 v25, v26, v27
ds_write_b64 v124, v[24:25] offset:32064
M a[164:167], a[200:203], a[248:251], a[164:167]
v_accvgpr_read_b32 v24, a140
v_accvgpr_read_b32 v25, a141
v_accvgpr_read_b32 v26, a142
M a[164:167], a[204:207], a[252:255], a[164:167]
v_accvgpr_read_b32 v27, a143
v_cvt_pk_bf16_f32 v24, v24, v25
v_cvt_pk_bf16_f32 v25, v26, v27
ds_write_b64 v124, v[24:25] offset:38400
M a[168:171], a[212:215], a[252:255], a[168:171]
v_accvgpr_read_b32 v28, a144
v_accvgpr_read_b32 v29, a145
v_accvgpr_read_b32 v30, a146
M a[168:171], a[208:211], a[248:251], a[168:171]
v_accvgpr_read_b32 v31, a147
v_cvt_pk_bf16_f32 v28, v28, v29
v_cvt_pk_bf16_f32 v29, v30, v31
ds_write_b64 v124, v[28:29] offset:38432
M a[172:175], a[216:219], a[248:251], a[172:175]
v_accvgpr_read_b32 v24, a148
v_accvgpr_read_b32 v25, a149
v_accvgpr_read_b32 v26, a150
M a[172:175], a[220:223], a[252:255], a[172:175]
v_accvgpr_read_b32 v27, a151
v_cvt_pk_bf16_f32 v24, v24, v25
v_cvt_pk_bf16_f32 v25, v26, v27
ds_write_b64 v124, v[24:25] offset:38464
s_mov_b64 s[44:45], s[42:43]
v_accvgpr_read_b32 v24, a152
v_accvgpr_read_b32 v25, a153
v_accvgpr_read_b32 v26, a154
v_accvgpr_read_b32 v27, a155
v_cvt_pk_bf16_f32 v24, v24, v25
v_cvt_pk_bf16_f32 v25, v26, v27
ds_write_b64 v124, v[24:25] offset:44800
v_accvgpr_read_b32 v28, a156
v_accvgpr_read_b32 v29, a157
v_accvgpr_read_b32 v30, a158
v_accvgpr_read_b32 v31, a159
v_cvt_pk_bf16_f32 v28, v28, v29
v_cvt_pk_bf16_f32 v29, v30, v31
ds_write_b64 v124, v[28:29] offset:44832
v_accvgpr_read_b32 v24, a160
v_accvgpr_read_b32 v25, a161
v_accvgpr_read_b32 v26, a162
v_accvgpr_read_b32 v27, a163
v_cvt_pk_bf16_f32 v24, v24, v25
v_cvt_pk_bf16_f32 v25, v26, v27
ds_write_b64 v124, v[24:25] offset:44864
v_accvgpr_read_b32 v24, a164
v_accvgpr_read_b32 v25, a165
v_accvgpr_read_b32 v26, a166
v_accvgpr_read_b32 v27, a167
v_cvt_pk_bf16_f32 v24, v24, v25
v_cvt_pk_bf16_f32 v25, v26, v27
ds_write_b64 v124, v[24:25] offset:51200
v_accvgpr_read_b32 v28, a168
v_accvgpr_read_b32 v29, a169
v_accvgpr_read_b32 v30, a170
v_accvgpr_read_b32 v31, a171
v_cvt_pk_bf16_f32 v28, v28, v29
v_cvt_pk_bf16_f32 v29, v30, v31
ds_write_b64 v124, v[28:29] offset:51232
v_accvgpr_read_b32 v24, a172
v_accvgpr_read_b32 v25, a173
v_accvgpr_read_b32 v26, a174
v_accvgpr_read_b32 v27, a175
v_cvt_pk_bf16_f32 v24, v24, v25
v_cvt_pk_bf16_f32 v25, v26, v27
ds_write_b64 v124, v[24:25] offset:51264
s_waitcnt lgkmcnt(0)
s_barrier
ds_read_b128 v[48:51], v121 offset:128
ds_read_b128 v[32:35], v120 offset:0
ds_read_b128 v[52:55], v120 offset:128
ds_read_b128 v[36:39], v120 offset:12800
ds_read_b128 v[56:59], v120 offset:12928
ds_read_b128 v[40:43], v120 offset:25600
ds_read_b128 v[60:63], v120 offset:25728
ds_read_b128 v[44:47], v120 offset:38400
ds_read_b128 v[64:67], v120 offset:38528
ds_read_b64_tr_b16 v[68:69], v123 offset:256
ds_read_b64_tr_b16 v[70:71], v122 offset:256
ds_read_b64_tr_b16 v[72:73], v122 offset:13056
ds_read_b64_tr_b16 v[74:75], v122 offset:25856
ds_read_b64_tr_b16 v[76:77], v122 offset:38656
ds_read_b64_tr_b16 v[78:79], v123 offset:288
ds_read_b64_tr_b16 v[80:81], v122 offset:288
ds_read_b64_tr_b16 v[82:83], v122 offset:13088
ds_read_b64_tr_b16 v[84:85], v122 offset:25888
ds_read_b64_tr_b16 v[86:87], v122 offset:38688
v_accvgpr_write_b32 a64, 0
v_accvgpr_write_b32 a65, 0
v_accvgpr_write_b32 a66, 0
v_accvgpr_write_b32 a67, 0
v_accvgpr_write_b32 a68, 0
v_accvgpr_write_b32 a69, 0
v_accvgpr_write_b32 a70, 0
v_accvgpr_write_b32 a71, 0
v_accvgpr_write_b32 a72, 0
v_accvgpr_write_b32 a73, 0
v_accvgpr_write_b32 a74, 0
v_accvgpr_write_b32 a75, 0
s_add_u32 m0, s29, 0
s_add_u32 s32, s25, 4096
buffer_load_dwordx4 v1, s[12:15], s25 offen offset:0 sc1 lds
v_accvgpr_write_b32 a76, 0
v_accvgpr_write_b32 a77, 0
v_accvgpr_write_b32 a78, 0
v_accvgpr_write_b32 a79, 0
v_accvgpr_write_b32 a80, 0
v_accvgpr_write_b32 a81, 0
v_accvgpr_write_b32 a82, 0
v_accvgpr_write_b32 a83, 0
v_accvgpr_write_b32 a84, 0
v_accvgpr_write_b32 a85, 0
v_accvgpr_write_b32 a86, 0
buffer_load_dwordx4 v1, s[12:15], s25 offen offset:1024 sc1 lds
v_accvgpr_write_b32 a87, 0
v_accvgpr_write_b32 a88, 0
v_accvgpr_write_b32 a89, 0
v_accvgpr_write_b32 a90, 0
v_accvgpr_write_b32 a91, 0
v_accvgpr_write_b32 a92, 0
v_accvgpr_write_b32 a93, 0
v_accvgpr_write_b32 a94, 0
v_accvgpr_write_b32 a95, 0
v_accvgpr_write_b32 a96, 0
buffer_load_dwordx4 v1, s[12:15], s25 offen offset:2048 sc1 lds
v_accvgpr_write_b32 a97, 0
v_accvgpr_write_b32 a98, 0
v_accvgpr_write_b32 a99, 0
v_accvgpr_write_b32 a100, 0
v_accvgpr_write_b32 a101, 0
v_accvgpr_write_b32 a102, 0
v_accvgpr_write_b32 a103, 0
v_accvgpr_write_b32 a104, 0
v_accvgpr_write_b32 a105, 0
v_accvgpr_write_b32 a106, 0
v_accvgpr_write_b32 a107, 0
buffer_load_dwordx4 v1, s[12:15], s25 offen offset:3072 sc1 lds
v_accvgpr_write_b32 a108, 0
v_accvgpr_write_b32 a109, 0
v_accvgpr_write_b32 a110, 0
v_accvgpr_write_b32 a111, 0
s_waitcnt lgkmcnt(15)
M v[88:91], v[48:51], v[32:35], v[152:155]
M v[92:95], v[52:55], v[32:35], v[148:151]
M v[96:99], v[52:55], v[36:39], v[144:147]
s_waitcnt lgkmcnt(14)
M v[100:103], v[56:59], v[36:39], v[148:151]
s_waitcnt lgkmcnt(13)
M v[104:107], v[56:59], v[40:43], v[144:147]
s_waitcnt lgkmcnt(12)
M v[108:111], v[60:63], v[40:43], v[148:151]
s_add_u32 m0, s29, 4096
s_nop 0
buffer_load_dwordx4 v1, s[12:15], s32 offen offset:0 sc1 lds
s_waitcnt lgkmcnt(11)
M v[112:115], v[60:63], v[44:47], v[144:147]
s_waitcnt lgkmcnt(10)
M v[116:119], v[64:67], v[44:47], v[148:151]
v_max3_f32 v136, v88, v89, v90
v_max3_f32 v136, v136, v91, v92
v_max3_f32 v136, v136, v93, v94
v_max_f32 v136, v136, v95
v_max3_f32 v137, v96, v97, v98
v_max3_f32 v137, v137, v99, v100
v_max3_f32 v137, v137, v101, v102
v_max_f32 v137, v137, v103
v_max3_f32 v138, v104, v105, v106
buffer_load_dwordx4 v1, s[12:15], s32 offen offset:1024 sc1 lds
v_max3_f32 v138, v138, v107, v108
v_max3_f32 v138, v138, v109, v110
v_max_f32 v138, v138, v111
v_max3_f32 v139, v112, v113, v114
v_max3_f32 v139, v139, v115, v116
v_max3_f32 v139, v139, v117, v118
v_max_f32 v139, v139, v119
v_mov_b32 v140, v136
v_mov_b32 v141, v137
v_mov_b32 v142, v138
buffer_load_dwordx4 v1, s[12:15], s32 offen offset:2048 sc1 lds
v_mov_b32 v143, v139
v_permlane16_swap_b32 v136, v140
v_permlane16_swap_b32 v137, v141
v_permlane16_swap_b32 v138, v142
v_permlane16_swap_b32 v139, v143
v_max_f32 v136, v136, v140
v_max_f32 v137, v137, v141
v_max_f32 v138, v138, v142
v_max_f32 v139, v139, v143
v_mov_b32 v140, v136
v_mov_b32 v141, v137
buffer_load_dwordx4 v1, s[12:15], s32 offen offset:3072 sc1 lds
v_mov_b32 v142, v138
v_mov_b32 v143, v139
v_permlane32_swap_b32 v136, v140
v_permlane32_swap_b32 v137, v141
v_permlane32_swap_b32 v138, v142
v_permlane32_swap_b32 v139, v143
v_max_f32 v136, v136, v140
v_max_f32 v137, v137, v141
v_max_f32 v138, v138, v142
v_max_f32 v139, v139, v143
s_add_u32 s25, s25, 32768
s_cmp_eq_u32 s25, s27
s_cselect_b32 s25, s28, s25
s_cselect_b32 s27, -1, s27
v_mul_f32 v136, s7, v136
v_mul_f32 v137, s7, v137
v_mul_f32 v138, s7, v138
v_mul_f32 v139, s7, v139
v_fma_f32 v88, v88, s7, -v136
v_fma_f32 v89, v89, s7, -v136
v_fma_f32 v90, v90, s7, -v136
v_fma_f32 v91, v91, s7, -v136
v_fma_f32 v92, v92, s7, -v136
v_fma_f32 v93, v93, s7, -v136
v_fma_f32 v94, v94, s7, -v136
s_add_u32 m0, s29, 32768
s_add_u32 s32, s26, 4096
buffer_load_dwordx4 v1, s[12:15], s26 offen offset:0 sc1 lds
v_fma_f32 v95, v95, s7, -v136
v_exp_f32 v88, v88
v_exp_f32 v89, v89
v_exp_f32 v90, v90
v_exp_f32 v91, v91
v_exp_f32 v92, v92
v_exp_f32 v93, v93
v_exp_f32 v94, v94
v_exp_f32 v95, v95
v_fma_f32 v96, v96, s7, -v137
v_fma_f32 v97, v97, s7, -v137
buffer_load_dwordx4 v1, s[12:15], s26 offen offset:1024 sc1 lds
v_fma_f32 v98, v98, s7, -v137
v_fma_f32 v99, v99, s7, -v137
v_fma_f32 v100, v100, s7, -v137
v_fma_f32 v101, v101, s7, -v137
v_fma_f32 v102, v102, s7, -v137
v_fma_f32 v103, v103, s7, -v137
v_exp_f32 v96, v96
v_exp_f32 v97, v97
v_exp_f32 v98, v98
v_exp_f32 v99, v99
buffer_load_dwordx4 v1, s[12:15], s26 offen offset:2048 sc1 lds
v_exp_f32 v100, v100
v_exp_f32 v101, v101
v_exp_f32 v102, v102
v_exp_f32 v103, v103
v_fma_f32 v104, v104, s7, -v138
v_fma_f32 v105, v105, s7, -v138
v_fma_f32 v106, v106, s7, -v138
v_fma_f32 v107, v107, s7, -v138
v_fma_f32 v108, v108, s7, -v138
v_fma_f32 v109, v109, s7, -v138
v_fma_f32 v110, v110, s7, -v138
buffer_load_dwordx4 v1, s[12:15], s26 offen offset:3072 sc1 lds
v_fma_f32 v111, v111, s7, -v138
v_exp_f32 v104, v104
v_exp_f32 v105, v105
v_exp_f32 v106, v106
v_exp_f32 v107, v107
v_exp_f32 v108, v108
v_exp_f32 v109, v109
v_exp_f32 v110, v110
v_exp_f32 v111, v111
v_fma_f32 v112, v112, s7, -v139
s_add_u32 m0, s29, 36864
s_nop 0
buffer_load_dwordx4 v1, s[12:15], s32 offen offset:0 sc1 lds
v_fma_f32 v113, v113, s7, -v139
v_fma_f32 v114, v114, s7, -v139
v_fma_f32 v115, v115, s7, -v139
v_fma_f32 v116, v116, s7, -v139
v_fma_f32 v117, v117, s7, -v139
v_fma_f32 v118, v118, s7, -v139
v_fma_f32 v119, v119, s7, -v139
v_exp_f32 v112, v112
v_exp_f32 v113, v113
v_exp_f32 v114, v114
v_exp_f32 v115, v115
buffer_load_dwordx4 v1, s[12:15], s32 offen offset:1024 sc1 lds
v_exp_f32 v116, v116
v_exp_f32 v117, v117
v_exp_f32 v118, v118
v_exp_f32 v119, v119
v_cvt_pk_bf16_f32 v88, v88, v89
v_cvt_pk_bf16_f32 v89, v90, v91
v_cvt_pk_bf16_f32 v90, v92, v93
v_cvt_pk_bf16_f32 v91, v94, v95
v_cvt_pk_bf16_f32 v96, v96, v97
v_cvt_pk_bf16_f32 v97, v98, v99
buffer_load_dwordx4 v1, s[12:15], s32 offen offset:2048 sc1 lds
v_cvt_pk_bf16_f32 v98, v100, v101
v_cvt_pk_bf16_f32 v99, v102, v103
v_cvt_pk_bf16_f32 v104, v104, v105
v_cvt_pk_bf16_f32 v105, v106, v107
v_cvt_pk_bf16_f32 v106, v108, v109
v_cvt_pk_bf16_f32 v107, v110, v111
v_cvt_pk_bf16_f32 v112, v112, v113
v_cvt_pk_bf16_f32 v113, v114, v115
v_cvt_pk_bf16_f32 v114, v116, v117
v_cvt_pk_bf16_f32 v115, v118, v119
M v[120:123], v[156:159], v[88:91], 0
buffer_load_dwordx4 v1, s[12:15], s32 offen offset:3072 sc1 lds
s_waitcnt lgkmcnt(8)
M v[32:35], v[68:71], v[88:91], 0
s_waitcnt lgkmcnt(3)
M v[36:39], v[78:81], v[88:91], 0
M v[124:127], v[156:159], v[96:99], 0
M v[40:43], v[70:73], v[96:99], 0
s_waitcnt lgkmcnt(2)
M v[44:47], v[80:83], v[96:99], 0
M v[128:131], v[156:159], v[104:107], 0
M v[48:51], v[72:75], v[104:107], 0
s_waitcnt lgkmcnt(1)
M v[52:55], v[82:85], v[104:107], 0
M v[132:135], v[156:159], v[112:115], 0
M v[56:59], v[74:77], v[112:115], 0
s_add_u32 s26, s26, 32768
s_cmp_eq_u32 s26, s62
s_cselect_b32 s26, s63, s26
s_cselect_b32 s62, -1, s62
s_waitcnt lgkmcnt(0)
M v[60:63], v[84:87], v[112:115], 0
v_rcp_f32 v120, v120
v_rcp_f32 v124, v124
v_rcp_f32 v128, v128
v_rcp_f32 v132, v132
v_pk_mul_f32 v[32:33], v[32:33], v[120:121] op_sel_hi:[1,0]
v_pk_mul_f32 v[34:35], v[34:35], v[120:121] op_sel_hi:[1,0]
v_pk_mul_f32 v[36:37], v[36:37], v[120:121] op_sel_hi:[1,0]
v_pk_mul_f32 v[38:39], v[38:39], v[120:121] op_sel_hi:[1,0]
v_cvt_pk_bf16_f32 v32, v32, v33
v_cvt_pk_bf16_f32 v33, v34, v35
v_cvt_pk_bf16_f32 v34, v36, v37
v_cvt_pk_bf16_f32 v35, v38, v39
s_add_u32 s3, s6, 0
buffer_store_dwordx4 v[32:35], v1, s[16:19], s3 offen sc1
v_pk_mul_f32 v[40:41], v[40:41], v[124:125] op_sel_hi:[1,0]
v_pk_mul_f32 v[42:43], v[42:43], v[124:125] op_sel_hi:[1,0]
v_pk_mul_f32 v[44:45], v[44:45], v[124:125] op_sel_hi:[1,0]
v_pk_mul_f32 v[46:47], v[46:47], v[124:125] op_sel_hi:[1,0]
v_cvt_pk_bf16_f32 v40, v40, v41
v_cvt_pk_bf16_f32 v41, v42, v43
v_cvt_pk_bf16_f32 v42, v44, v45
v_cvt_pk_bf16_f32 v43, v46, v47
s_add_u32 s3, s6, 2048
buffer_store_dwordx4 v[40:43], v1, s[16:19], s3 offen sc1
v_pk_mul_f32 v[48:49], v[48:49], v[128:129] op_sel_hi:[1,0]
v_pk_mul_f32 v[50:51], v[50:51], v[128:129] op_sel_hi:[1,0]
v_pk_mul_f32 v[52:53], v[52:53], v[128:129] op_sel_hi:[1,0]
v_pk_mul_f32 v[54:55], v[54:55], v[128:129] op_sel_hi:[1,0]
v_cvt_pk_bf16_f32 v48, v48, v49
v_cvt_pk_bf16_f32 v49, v50, v51
v_cvt_pk_bf16_f32 v50, v52, v53
v_cvt_pk_bf16_f32 v51, v54, v55
s_add_u32 s3, s6, 4096
buffer_store_dwordx4 v[48:51], v1, s[16:19], s3 offen sc1
v_pk_mul_f32 v[56:57], v[56:57], v[132:133] op_sel_hi:[1,0]
v_pk_mul_f32 v[58:59], v[58:59], v[132:133] op_sel_hi:[1,0]
v_pk_mul_f32 v[60:61], v[60:61], v[132:133] op_sel_hi:[1,0]
v_pk_mul_f32 v[62:63], v[62:63], v[132:133] op_sel_hi:[1,0]
v_cvt_pk_bf16_f32 v56, v56, v57
v_cvt_pk_bf16_f32 v57, v58, v59
v_cvt_pk_bf16_f32 v58, v60, v61
v_cvt_pk_bf16_f32 v59, v62, v63
s_add_u32 s3, s6, 6144
buffer_store_dwordx4 v[56:59], v1, s[16:19], s3 offen sc1
s_add_u32 s16, s4, 67108864
s_addc_u32 s17, s5, 0
s_mov_b32 s18, 16777216
s_mov_b32 s19, 0x00020000
s_add_u32 s52, s4, 100663296
s_addc_u32 s53, s5, 0
s_mov_b32 s54, 8404992
s_mov_b32 s55, 0x00020000
s_mov_b32 s46, 8388608
s_mov_b32 s47, 0x00020000
s_mov_b32 s50, 2097152
s_mov_b32 s51, 0x00020000
s_lshl_b32 s33, s24, 14
v_add_u32 v2, s33, v1
v_add_u32 v3, 0x10000, v2
v_and_b32 v8, 15, v0
v_bfe_u32 v9, v0, 4, 2
v_lshlrev_b32 v9, 2, v9
v_sub_u32 v8, v8, v9
v_mov_b32 v4, 0xf149f2ca
v_cmp_gt_i32 vcc, 0, v8
s_nop 1
v_cndmask_b32 v16, 0, v4, vcc
v_cmp_gt_i32 vcc, 1, v8
s_nop 1
v_cndmask_b32 v17, 0, v4, vcc
v_cmp_gt_i32 vcc, 2, v8
s_nop 1
v_cndmask_b32 v18, 0, v4, vcc
v_cmp_gt_i32 vcc, 3, v8
s_nop 1
v_cndmask_b32 v19, 0, v4, vcc
v_mov_b32 v8, 0x3f803f80
v_accvgpr_write_b32 a112, v8
v_accvgpr_write_b32 a113, v8
v_accvgpr_write_b32 a114, v8
v_accvgpr_write_b32 a115, v8
s_lshl_b32 s33, s23, 6
s_add_i32 s33, s33, s31
s_cmp_gt_i32 s33, 0
s_cselect_b32 s34, 0, 0xf149f2ca
s_cmp_lt_i32 s33, 0
s_cselect_b32 s33, 0xf149f2ca, 0
v_mov_b32 v20, s34
v_mov_b32 v21, s34
v_mov_b32 v22, s34
v_mov_b32 v23, s34
v_mov_b32 v28, s33
v_mov_b32 v29, s33
v_mov_b32 v30, s33
v_mov_b32 v31, s33
v_med3_f32 v24, v16, v20, v28
v_med3_f32 v25, v17, v20, v28
v_med3_f32 v26, v18, v20, v28
v_med3_f32 v27, v19, v20, v28
v_mov_b32 v5, 0
v_mov_b32 v6, 1
s_waitcnt vmcnt(20)
s_barrier
ds_read_b128 a[116:119], v3 offset:0
ds_read_b128 a[120:123], v3 offset:1024
ds_read_b128 a[124:127], v3 offset:2048
ds_read_b128 a[128:131], v3 offset:3072
ds_read_b128 a[132:135], v3 offset:4096
ds_read_b128 a[136:139], v3 offset:5120
ds_read_b128 a[140:143], v3 offset:6144
ds_read_b128 a[144:147], v3 offset:7168
s_waitcnt lgkmcnt(4)
M v[32:35], a[116:119], a[0:3], v[24:27]
M v[32:35], a[120:123], a[4:7], v[32:35]
ds_read_b128 a[148:151], v3 offset:8192
ds_read_b128 a[152:155], v3 offset:9216
M v[32:35], a[124:127], a[8:11], v[32:35]
M v[32:35], a[128:131], a[12:15], v[32:35]
M v[36:39], a[128:131], a[28:31], v[28:31]
M v[36:39], a[124:127], a[24:27], v[36:39]
M v[36:39], a[120:123], a[20:23], v[36:39]
M v[36:39], a[116:119], a[16:19], v[36:39]
M v[40:43], a[116:119], a[32:35], v[28:31]
M v[40:43], a[120:123], a[36:39], v[40:43]
ds_read_b128 a[156:159], v3 offset:10240
ds_read_b128 a[160:163], v3 offset:11264
M v[40:43], a[124:127], a[40:43], v[40:43]
M v[40:43], a[128:131], a[44:47], v[40:43]
M v[44:47], a[128:131], a[60:63], v[28:31]
M v[44:47], a[124:127], a[56:59], v[44:47]
M v[44:47], a[120:123], a[52:55], v[44:47]
M v[44:47], a[116:119], a[48:51], v[44:47]
s_waitcnt lgkmcnt(4)
M v[48:51], a[132:135], a[0:3], v[20:23]
M v[48:51], a[136:139], a[4:7], v[48:51]
ds_read_b128 a[164:167], v3 offset:12288
ds_read_b128 a[168:171], v3 offset:13312
M v[48:51], a[140:143], a[8:11], v[48:51]
M v[48:51], a[144:147], a[12:15], v[48:51]
M v[52:55], a[144:147], a[28:31], v[24:27]
M v[52:55], a[140:143], a[24:27], v[52:55]
M v[52:55], a[136:139], a[20:23], v[52:55]
M v[52:55], a[132:135], a[16:19], v[52:55]
M v[56:59], a[132:135], a[32:35], v[28:31]
M v[56:59], a[136:139], a[36:39], v[56:59]
ds_read_b128 a[172:175], v3 offset:14336
ds_read_b128 a[176:179], v3 offset:15360
M v[56:59], a[140:143], a[40:43], v[56:59]
M v[56:59], a[144:147], a[44:47], v[56:59]
M v[60:63], a[144:147], a[60:63], v[28:31]
M v[60:63], a[140:143], a[56:59], v[60:63]
M v[60:63], a[136:139], a[52:55], v[60:63]
M v[60:63], a[132:135], a[48:51], v[60:63]
s_waitcnt lgkmcnt(4)
M v[64:67], a[148:151], a[0:3], v[20:23]
M v[64:67], a[152:155], a[4:7], v[64:67]
M v[64:67], a[156:159], a[8:11], v[64:67]
M v[64:67], a[160:163], a[12:15], v[64:67]
M v[68:71], a[160:163], a[28:31], v[20:23]
M v[68:71], a[156:159], a[24:27], v[68:71]
M v[68:71], a[152:155], a[20:23], v[68:71]
M v[68:71], a[148:151], a[16:19], v[68:71]
M v[72:75], a[148:151], a[32:35], v[24:27]
M v[72:75], a[152:155], a[36:39], v[72:75]
M v[72:75], a[156:159], a[40:43], v[72:75]
M v[72:75], a[160:163], a[44:47], v[72:75]
M v[76:79], a[160:163], a[60:63], v[28:31]
M v[76:79], a[156:159], a[56:59], v[76:79]
s_waitcnt vmcnt(12) lgkmcnt(0)
s_barrier
ds_read_b128 a[116:119], v2 offset:0
ds_read_b128 a[120:123], v2 offset:1024
ds_read_b128 a[124:127], v2 offset:2048
ds_read_b128 a[128:131], v2 offset:3072
M v[76:79], a[152:155], a[52:55], v[76:79]
M v[76:79], a[148:151], a[48:51], v[76:79]
M v[80:83], a[164:167], a[0:3], v[20:23]
M v[80:83], a[168:171], a[4:7], v[80:83]
ds_read_b128 a[132:135], v2 offset:4096
ds_read_b128 a[136:139], v2 offset:5120
M v[80:83], a[172:175], a[8:11], v[80:83]
M v[80:83], a[176:179], a[12:15], v[80:83]
M v[84:87], a[176:179], a[28:31], v[20:23]
M v[84:87], a[172:175], a[24:27], v[84:87]
M v[84:87], a[168:171], a[20:23], v[84:87]
M v[84:87], a[164:167], a[16:19], v[84:87]
M v[88:91], a[164:167], a[32:35], v[20:23]
M v[88:91], a[168:171], a[36:39], v[88:91]
ds_read_b128 a[140:143], v2 offset:6144
ds_read_b128 a[144:147], v2 offset:7168
M v[88:91], a[172:175], a[40:43], v[88:91]
M v[88:91], a[176:179], a[44:47], v[88:91]
M v[92:95], a[176:179], a[60:63], v[24:27]
M v[92:95], a[172:175], a[56:59], v[92:95]
M v[92:95], a[168:171], a[52:55], v[92:95]
M v[92:95], a[164:167], a[48:51], v[92:95]
s_waitcnt vmcnt(0)
s_mov_b64 exec, 1
buffer_store_dword v6, v5, s[52:55], s65 offen sc1
s_mov_b64 exec, -1
s_add_u32 m0, s29, 65536
s_add_u32 s32, s25, 4096
buffer_load_dwordx4 v1, s[12:15], s25 offen offset:0 sc1 lds
buffer_load_dwordx4 v1, s[12:15], s25 offen offset:1024 sc1 lds
buffer_load_dwordx4 v1, s[12:15], s25 offen offset:2048 sc1 lds
buffer_load_dwordx4 v1, s[12:15], s25 offen offset:3072 sc1 lds
s_add_u32 m0, s29, 69632
s_nop 0
buffer_load_dwordx4 v1, s[12:15], s32 offen offset:0 sc1 lds
buffer_load_dwordx4 v1, s[12:15], s32 offen offset:1024 sc1 lds
buffer_load_dwordx4 v1, s[12:15], s32 offen offset:2048 sc1 lds
buffer_load_dwordx4 v1, s[12:15], s32 offen offset:3072 sc1 lds
s_add_u32 s25, s25, 32768
s_cmp_eq_u32 s25, s27
s_cselect_b32 s25, s28, s25
s_cselect_b32 s27, -1, s27
v_exp_f32 v32, v32
v_exp_f32 v33, v33
v_exp_f32 v34, v34
v_exp_f32 v35, v35
v_exp_f32 v48, v48
v_exp_f32 v49, v49
v_exp_f32 v50, v50
v_exp_f32 v51, v51
v_cvt_pk_bf16_f32 v32, v32, v33
v_cvt_pk_bf16_f32 v33, v34, v35
v_exp_f32 v36, v36
v_exp_f32 v37, v37
v_exp_f32 v38, v38
v_exp_f32 v39, v39
v_cvt_pk_bf16_f32 v34, v48, v49
v_cvt_pk_bf16_f32 v35, v50, v51
v_exp_f32 v52, v52
v_exp_f32 v53, v53
v_exp_f32 v54, v54
v_exp_f32 v55, v55
v_cvt_pk_bf16_f32 v36, v36, v37
v_cvt_pk_bf16_f32 v37, v38, v39
v_exp_f32 v40, v40
v_exp_f32 v41, v41
v_exp_f32 v42, v42
v_exp_f32 v43, v43
v_cvt_pk_bf16_f32 v38, v52, v53
v_cvt_pk_bf16_f32 v39, v54, v55
v_exp_f32 v56, v56
v_exp_f32 v57, v57
v_exp_f32 v58, v58
v_exp_f32 v59, v59
v_cvt_pk_bf16_f32 v40, v40, v41
v_cvt_pk_bf16_f32 v41, v42, v43
v_exp_f32 v44, v44
v_exp_f32 v45, v45
v_exp_f32 v46, v46
v_exp_f32 v47, v47
v_cvt_pk_bf16_f32 v42, v56, v57
v_cvt_pk_bf16_f32 v43, v58, v59
v_exp_f32 v60, v60
v_exp_f32 v61, v61
v_exp_f32 v62, v62
v_exp_f32 v63, v63
v_cvt_pk_bf16_f32 v44, v44, v45
v_cvt_pk_bf16_f32 v45, v46, v47
v_cvt_pk_bf16_f32 v46, v60, v61
v_cvt_pk_bf16_f32 v47, v62, v63
s_cmp_eq_u32 s24, 1
s_cbranch_scc1 Lk2_g1
s_mov_b32 s30, s21
s_cmp_eq_u32 s21, 0
s_cbranch_scc1 Lk2_m2
Lk2_l1:
s_waitcnt lgkmcnt(4)
s_add_u32 m0, s29, 98304
M v[96:99], a[116:119], a[0:3], 0
v_exp_f32 v64, v64
M v[96:99], a[120:123], a[4:7], v[96:99]
ds_read_b128 a[148:151], v2 offset:8192
ds_read_b128 a[152:155], v2 offset:9216
M v[96:99], a[124:127], a[8:11], v[96:99]
v_exp_f32 v65, v65
M v[96:99], a[128:131], a[12:15], v[96:99]
buffer_load_dwordx4 v1, s[12:15], s26 offen offset:0 sc1 lds
s_add_u32 s32, s26, 4096
M v[100:103], a[128:131], a[28:31], 0
v_exp_f32 v66, v66
M v[100:103], a[124:127], a[24:27], v[100:103]
v_cvt_pk_bf16_f32 v64, v64, v65
M v[100:103], a[120:123], a[20:23], v[100:103]
v_exp_f32 v67, v67
M v[100:103], a[116:119], a[16:19], v[100:103]
buffer_load_dwordx4 v1, s[12:15], s26 offen offset:1024 sc1 lds
M v[104:107], a[116:119], a[32:35], 0
v_exp_f32 v80, v80
M v[104:107], a[120:123], a[36:39], v[104:107]
ds_read_b128 a[156:159], v2 offset:10240
ds_read_b128 a[160:163], v2 offset:11264
M v[104:107], a[124:127], a[40:43], v[104:107]
v_exp_f32 v81, v81
M v[104:107], a[128:131], a[44:47], v[104:107]
buffer_load_dwordx4 v1, s[12:15], s26 offen offset:2048 sc1 lds
M v[108:111], a[128:131], a[60:63], 0
v_exp_f32 v82, v82
M v[108:111], a[124:127], a[56:59], v[108:111]
v_cvt_pk_bf16_f32 v65, v66, v67
v_cvt_pk_bf16_f32 v66, v80, v81
M v[108:111], a[120:123], a[52:55], v[108:111]
v_exp_f32 v83, v83
M v[108:111], a[116:119], a[48:51], v[108:111]
buffer_load_dwordx4 v1, s[12:15], s26 offen offset:3072 sc1 lds
s_add_u32 m0, s29, 102400
s_waitcnt lgkmcnt(4)
M v[112:115], a[132:135], a[0:3], 0
v_exp_f32 v68, v68
M v[112:115], a[136:139], a[4:7], v[112:115]
ds_read_b128 a[164:167], v2 offset:12288
ds_read_b128 a[168:171], v2 offset:13312
M v[112:115], a[140:143], a[8:11], v[112:115]
v_exp_f32 v69, v69
M v[112:115], a[144:147], a[12:15], v[112:115]
buffer_load_dwordx4 v1, s[12:15], s32 offen offset:0 sc1 lds
M v[116:119], a[144:147], a[28:31], 0
v_exp_f32 v70, v70
M v[116:119], a[140:143], a[24:27], v[116:119]
v_cvt_pk_bf16_f32 v67, v82, v83
v_cvt_pk_bf16_f32 v68, v68, v69
M v[116:119], a[136:139], a[20:23], v[116:119]
v_exp_f32 v71, v71
M v[116:119], a[132:135], a[16:19], v[116:119]
buffer_load_dwordx4 v1, s[12:15], s32 offen offset:1024 sc1 lds
M v[120:123], a[132:135], a[32:35], 0
v_exp_f32 v84, v84
M v[120:123], a[136:139], a[36:39], v[120:123]
ds_read_b128 a[172:175], v2 offset:14336
ds_read_b128 a[176:179], v2 offset:15360
M v[120:123], a[140:143], a[40:43], v[120:123]
v_exp_f32 v85, v85
M v[120:123], a[144:147], a[44:47], v[120:123]
buffer_load_dwordx4 v1, s[12:15], s32 offen offset:2048 sc1 lds
M v[124:127], a[144:147], a[60:63], 0
v_exp_f32 v86, v86
M v[124:127], a[140:143], a[56:59], v[124:127]
v_cvt_pk_bf16_f32 v69, v70, v71
v_cvt_pk_bf16_f32 v70, v84, v85
M v[124:127], a[136:139], a[52:55], v[124:127]
v_exp_f32 v87, v87
M v[124:127], a[132:135], a[48:51], v[124:127]
buffer_load_dwordx4 v1, s[12:15], s32 offen offset:3072 sc1 lds
s_waitcnt lgkmcnt(4)
M v[128:131], a[148:151], a[0:3], 0
v_exp_f32 v72, v72
M v[128:131], a[152:155], a[4:7], v[128:131]
s_add_u32 s26, s26, 32768
s_cmp_eq_u32 s26, s62
s_cselect_b32 s26, s63, s26
s_cselect_b32 s62, -1, s62
M v[128:131], a[156:159], a[8:11], v[128:131]
v_exp_f32 v73, v73
M v[128:131], a[160:163], a[12:15], v[128:131]
v_cvt_pk_bf16_f32 v71, v86, v87
v_cvt_pk_bf16_f32 v72, v72, v73
M v[132:135], a[160:163], a[28:31], 0
v_exp_f32 v74, v74
M v[132:135], a[156:159], a[24:27], v[132:135]
M v[132:135], a[152:155], a[20:23], v[132:135]
v_exp_f32 v75, v75
M v[132:135], a[148:151], a[16:19], v[132:135]
v_cvt_pk_bf16_f32 v73, v74, v75
M v[136:139], a[148:151], a[32:35], 0
v_exp_f32 v88, v88
M v[136:139], a[152:155], a[36:39], v[136:139]
M v[136:139], a[156:159], a[40:43], v[136:139]
v_exp_f32 v89, v89
M v[136:139], a[160:163], a[44:47], v[136:139]
v_cvt_pk_bf16_f32 v74, v88, v89
M v[140:143], a[160:163], a[60:63], 0
v_exp_f32 v90, v90
M v[140:143], a[156:159], a[56:59], v[140:143]
s_waitcnt vmcnt(16) lgkmcnt(0)
s_barrier
ds_read_b128 a[116:119], v2 offset:32768
ds_read_b128 a[120:123], v2 offset:40960
ds_read_b128 a[124:127], v2 offset:33792
ds_read_b128 a[128:131], v2 offset:41984
M v[140:143], a[152:155], a[52:55], v[140:143]
v_exp_f32 v91, v91
M v[140:143], a[148:151], a[48:51], v[140:143]
v_cvt_pk_bf16_f32 v75, v90, v91
M v[144:147], a[164:167], a[0:3], 0
v_exp_f32 v76, v76
M v[144:147], a[168:171], a[4:7], v[144:147]
ds_read_b128 a[132:135], v2 offset:34816
ds_read_b128 a[136:139], v2 offset:43008
M v[144:147], a[172:175], a[8:11], v[144:147]
v_exp_f32 v77, v77
M v[144:147], a[176:179], a[12:15], v[144:147]
v_cvt_pk_bf16_f32 v76, v76, v77
M v[148:151], a[176:179], a[28:31], 0
v_exp_f32 v78, v78
M v[148:151], a[172:175], a[24:27], v[148:151]
M v[148:151], a[168:171], a[20:23], v[148:151]
v_exp_f32 v79, v79
M v[148:151], a[164:167], a[16:19], v[148:151]
v_cvt_pk_bf16_f32 v77, v78, v79
M v[152:155], a[164:167], a[32:35], 0
v_exp_f32 v92, v92
M v[152:155], a[168:171], a[36:39], v[152:155]
ds_read_b128 a[140:143], v2 offset:35840
ds_read_b128 a[144:147], v2 offset:44032
M v[152:155], a[172:175], a[40:43], v[152:155]
v_exp_f32 v93, v93
M v[152:155], a[176:179], a[44:47], v[152:155]
v_cvt_pk_bf16_f32 v78, v92, v93
M v[156:159], a[176:179], a[60:63], 0
v_exp_f32 v94, v94
M v[156:159], a[172:175], a[56:59], v[156:159]
M v[156:159], a[168:171], a[52:55], v[156:159]
v_exp_f32 v95, v95
M v[156:159], a[164:167], a[48:51], v[156:159]
v_cvt_pk_bf16_f32 v79, v94, v95
s_waitcnt lgkmcnt(6)
s_add_u32 m0, s29, 0
M v[160:163], a[116:119], v[32:35], v[160:163]
v_exp_f32 v96, v96
M v[160:163], a[120:123], v[64:67], v[160:163]
ds_read_b128 a[148:151], v2 offset:36864
ds_read_b128 a[152:155], v2 offset:45056
M v[164:167], a[120:123], v[68:71], v[164:167]
v_exp_f32 v97, v97
M v[164:167], a[116:119], v[36:39], v[164:167]
buffer_load_dwordx4 v1, s[12:15], s25 offen offset:0 sc1 lds
s_add_u32 s32, s25, 4096
M v[168:171], a[116:119], v[40:43], v[168:171]
v_exp_f32 v98, v98
M v[168:171], a[120:123], v[72:75], v[168:171]
v_cvt_pk_bf16_f32 v96, v96, v97
M v[172:175], a[120:123], v[76:79], v[172:175]
v_exp_f32 v99, v99
M v[172:175], a[116:119], v[44:47], v[172:175]
buffer_load_dwordx4 v1, s[12:15], s25 offen offset:1024 sc1 lds
s_waitcnt lgkmcnt(6)
M a[96:99], a[112:115], v[32:35], a[96:99]
M a[96:99], a[112:115], v[64:67], a[96:99]
M v[176:179], a[124:127], v[32:35], v[176:179]
v_exp_f32 v112, v112
M v[176:179], a[128:131], v[64:67], v[176:179]
ds_read_b128 a[156:159], v2 offset:37888
ds_read_b128 a[160:163], v2 offset:46080
M v[180:183], a[128:131], v[68:71], v[180:183]
v_exp_f32 v113, v113
M v[180:183], a[124:127], v[36:39], v[180:183]
buffer_load_dwordx4 v1, s[12:15], s25 offen offset:2048 sc1 lds
M v[184:187], a[124:127], v[40:43], v[184:187]
v_exp_f32 v114, v114
M v[184:187], a[128:131], v[72:75], v[184:187]
v_cvt_pk_bf16_f32 v97, v98, v99
v_cvt_pk_bf16_f32 v98, v112, v113
M v[188:191], a[128:131], v[76:79], v[188:191]
v_exp_f32 v115, v115
M v[188:191], a[124:127], v[44:47], v[188:191]
buffer_load_dwordx4 v1, s[12:15], s25 offen offset:3072 sc1 lds
s_add_u32 m0, s29, 4096
s_waitcnt lgkmcnt(6)
M a[100:103], a[112:115], v[36:39], a[100:103]
M a[100:103], a[112:115], v[68:71], a[100:103]
M v[192:195], a[132:135], v[32:35], v[192:195]
v_exp_f32 v100, v100
M v[192:195], a[136:139], v[64:67], v[192:195]
ds_read_b128 a[164:167], v2 offset:38912
ds_read_b128 a[168:171], v2 offset:47104
M v[196:199], a[136:139], v[68:71], v[196:199]
v_exp_f32 v101, v101
M v[196:199], a[132:135], v[36:39], v[196:199]
buffer_load_dwordx4 v1, s[12:15], s32 offen offset:0 sc1 lds
M v[200:203], a[132:135], v[40:43], v[200:203]
v_exp_f32 v102, v102
M v[200:203], a[136:139], v[72:75], v[200:203]
v_cvt_pk_bf16_f32 v99, v114, v115
v_cvt_pk_bf16_f32 v100, v100, v101
M v[204:207], a[136:139], v[76:79], v[204:207]
v_exp_f32 v103, v103
M v[204:207], a[132:135], v[44:47], v[204:207]
buffer_load_dwordx4 v1, s[12:15], s32 offen offset:1024 sc1 lds
s_waitcnt lgkmcnt(6)
M a[104:107], a[112:115], v[40:43], a[104:107]
M a[104:107], a[112:115], v[72:75], a[104:107]
M v[208:211], a[140:143], v[32:35], v[208:211]
v_exp_f32 v116, v116
M v[208:211], a[144:147], v[64:67], v[208:211]
ds_read_b128 a[172:175], v2 offset:39936
ds_read_b128 a[176:179], v2 offset:48128
M v[212:215], a[144:147], v[68:71], v[212:215]
v_exp_f32 v117, v117
M v[212:215], a[140:143], v[36:39], v[212:215]
buffer_load_dwordx4 v1, s[12:15], s32 offen offset:2048 sc1 lds
M v[216:219], a[140:143], v[40:43], v[216:219]
v_exp_f32 v118, v118
M v[216:219], a[144:147], v[72:75], v[216:219]
v_cvt_pk_bf16_f32 v101, v102, v103
v_cvt_pk_bf16_f32 v102, v116, v117
M v[220:223], a[144:147], v[76:79], v[220:223]
v_exp_f32 v119, v119
M v[220:223], a[140:143], v[44:47], v[220:223]
buffer_load_dwordx4 v1, s[12:15], s32 offen offset:3072 sc1 lds
s_waitcnt lgkmcnt(6)
M a[108:111], a[112:115], v[44:47], a[108:111]
M a[108:111], a[112:115], v[76:79], a[108:111]
M v[224:227], a[148:151], v[32:35], v[224:227]
v_exp_f32 v104, v104
M v[224:227], a[152:155], v[64:67], v[224:227]
s_add_u32 s25, s25, 32768
s_cmp_eq_u32 s25, s27
s_cselect_b32 s25, s28, s25
s_cselect_b32 s27, -1, s27
M v[228:231], a[152:155], v[68:71], v[228:231]
v_exp_f32 v105, v105
M v[228:231], a[148:151], v[36:39], v[228:231]
v_cvt_pk_bf16_f32 v103, v118, v119
v_cvt_pk_bf16_f32 v104, v104, v105
M v[232:235], a[148:151], v[40:43], v[232:235]
v_exp_f32 v106, v106
M v[232:235], a[152:155], v[72:75], v[232:235]
M v[236:239], a[152:155], v[76:79], v[236:239]
v_exp_f32 v107, v107
M v[236:239], a[148:151], v[44:47], v[236:239]
v_cvt_pk_bf16_f32 v105, v106, v107
s_waitcnt lgkmcnt(4)
M v[240:243], a[156:159], v[32:35], v[240:243]
v_exp_f32 v120, v120
M v[240:243], a[160:163], v[64:67], v[240:243]
M v[244:247], a[160:163], v[68:71], v[244:247]
v_exp_f32 v121, v121
M v[244:247], a[156:159], v[36:39], v[244:247]
v_cvt_pk_bf16_f32 v106, v120, v121
M v[248:251], a[156:159], v[40:43], v[248:251]
v_exp_f32 v122, v122
M v[248:251], a[160:163], v[72:75], v[248:251]
s_waitcnt vmcnt(16) lgkmcnt(0)
s_barrier
ds_read_b128 a[116:119], v3 offset:0
ds_read_b128 a[120:123], v3 offset:1024
ds_read_b128 a[124:127], v3 offset:2048
ds_read_b128 a[128:131], v3 offset:3072
M v[252:255], a[160:163], v[76:79], v[252:255]
v_exp_f32 v123, v123
M v[252:255], a[156:159], v[44:47], v[252:255]
v_cvt_pk_bf16_f32 v107, v122, v123
M a[64:67], a[164:167], v[32:35], a[64:67]
v_exp_f32 v108, v108
M a[64:67], a[168:171], v[64:67], a[64:67]
ds_read_b128 a[132:135], v3 offset:4096
ds_read_b128 a[136:139], v3 offset:5120
M a[68:71], a[168:171], v[68:71], a[68:71]
v_exp_f32 v109, v109
M a[68:71], a[164:167], v[36:39], a[68:71]
v_cvt_pk_bf16_f32 v108, v108, v109
M a[72:75], a[164:167], v[40:43], a[72:75]
v_exp_f32 v110, v110
M a[72:75], a[168:171], v[72:75], a[72:75]
M a[76:79], a[168:171], v[76:79], a[76:79]
v_exp_f32 v111, v111
M a[76:79], a[164:167], v[44:47], a[76:79]
v_cvt_pk_bf16_f32 v109, v110, v111
M a[80:83], a[172:175], v[32:35], a[80:83]
v_exp_f32 v124, v124
M a[80:83], a[176:179], v[64:67], a[80:83]
ds_read_b128 a[140:143], v3 offset:6144
ds_read_b128 a[144:147], v3 offset:7168
M a[84:87], a[176:179], v[68:71], a[84:87]
v_exp_f32 v125, v125
M a[84:87], a[172:175], v[36:39], a[84:87]
v_cvt_pk_bf16_f32 v110, v124, v125
M a[88:91], a[172:175], v[40:43], a[88:91]
v_exp_f32 v126, v126
M a[88:91], a[176:179], v[72:75], a[88:91]
M a[92:95], a[176:179], v[76:79], a[92:95]
v_exp_f32 v127, v127
M a[92:95], a[172:175], v[44:47], a[92:95]
v_cvt_pk_bf16_f32 v111, v126, v127
s_sub_u32 s30, s30, 1
s_cmp_eq_u32 s30, 0
s_cbranch_scc1 Lk2_m1
s_waitcnt lgkmcnt(4)
s_add_u32 m0, s29, 32768
M v[32:35], a[116:119], a[0:3], 0
v_exp_f32 v128, v128
M v[32:35], a[120:123], a[4:7], v[32:35]
ds_read_b128 a[148:151], v3 offset:8192
ds_read_b128 a[152:155], v3 offset:9216
M v[32:35], a[124:127], a[8:11], v[32:35]
v_exp_f32 v129, v129
M v[32:35], a[128:131], a[12:15], v[32:35]
buffer_load_dwordx4 v1, s[12:15], s26 offen offset:0 sc1 lds
s_add_u32 s32, s26, 4096
M v[36:39], a[128:131], a[28:31], 0
v_exp_f32 v130, v130
M v[36:39], a[124:127], a[24:27], v[36:39]
v_cvt_pk_bf16_f32 v128, v128, v129
M v[36:39], a[120:123], a[20:23], v[36:39]
v_exp_f32 v131, v131
M v[36:39], a[116:119], a[16:19], v[36:39]
buffer_load_dwordx4 v1, s[12:15], s26 offen offset:1024 sc1 lds
M v[40:43], a[116:119], a[32:35], 0
v_exp_f32 v144, v144
M v[40:43], a[120:123], a[36:39], v[40:43]
ds_read_b128 a[156:159], v3 offset:10240
ds_read_b128 a[160:163], v3 offset:11264
M v[40:43], a[124:127], a[40:43], v[40:43]
v_exp_f32 v145, v145
M v[40:43], a[128:131], a[44:47], v[40:43]
buffer_load_dwordx4 v1, s[12:15], s26 offen offset:2048 sc1 lds
M v[44:47], a[128:131], a[60:63], 0
v_exp_f32 v146, v146
M v[44:47], a[124:127], a[56:59], v[44:47]
v_cvt_pk_bf16_f32 v129, v130, v131
v_cvt_pk_bf16_f32 v130, v144, v145
M v[44:47], a[120:123], a[52:55], v[44:47]
v_exp_f32 v147, v147
M v[44:47], a[116:119], a[48:51], v[44:47]
buffer_load_dwordx4 v1, s[12:15], s26 offen offset:3072 sc1 lds
s_add_u32 m0, s29, 36864
s_waitcnt lgkmcnt(4)
M v[48:51], a[132:135], a[0:3], 0
v_exp_f32 v132, v132
M v[48:51], a[136:139], a[4:7], v[48:51]
ds_read_b128 a[164:167], v3 offset:12288
ds_read_b128 a[168:171], v3 offset:13312
M v[48:51], a[140:143], a[8:11], v[48:51]
v_exp_f32 v133, v133
M v[48:51], a[144:147], a[12:15], v[48:51]
buffer_load_dwordx4 v1, s[12:15], s32 offen offset:0 sc1 lds
M v[52:55], a[144:147], a[28:31], 0
v_exp_f32 v134, v134
M v[52:55], a[140:143], a[24:27], v[52:55]
v_cvt_pk_bf16_f32 v131, v146, v147
v_cvt_pk_bf16_f32 v132, v132, v133
M v[52:55], a[136:139], a[20:23], v[52:55]
v_exp_f32 v135, v135
M v[52:55], a[132:135], a[16:19], v[52:55]
buffer_load_dwordx4 v1, s[12:15], s32 offen offset:1024 sc1 lds
M v[56:59], a[132:135], a[32:35], 0
v_exp_f32 v148, v148
M v[56:59], a[136:139], a[36:39], v[56:59]
ds_read_b128 a[172:175], v3 offset:14336
ds_read_b128 a[176:179], v3 offset:15360
M v[56:59], a[140:143], a[40:43], v[56:59]
v_exp_f32 v149, v149
M v[56:59], a[144:147], a[44:47], v[56:59]
buffer_load_dwordx4 v1, s[12:15], s32 offen offset:2048 sc1 lds
M v[60:63], a[144:147], a[60:63], 0
v_exp_f32 v150, v150
M v[60:63], a[140:143], a[56:59], v[60:63]
v_cvt_pk_bf16_f32 v133, v134, v135
v_cvt_pk_bf16_f32 v134, v148, v149
M v[60:63], a[136:139], a[52:55], v[60:63]
v_exp_f32 v151, v151
M v[60:63], a[132:135], a[48:51], v[60:63]
buffer_load_dwordx4 v1, s[12:15], s32 offen offset:3072 sc1 lds
s_waitcnt lgkmcnt(4)
M v[64:67], a[148:151], a[0:3], 0
v_exp_f32 v136, v136
M v[64:67], a[152:155], a[4:7], v[64:67]
s_add_u32 s26, s26, 32768
s_cmp_eq_u32 s26, s62
s_cselect_b32 s26, s63, s26
s_cselect_b32 s62, -1, s62
M v[64:67], a[156:159], a[8:11], v[64:67]
v_exp_f32 v137, v137
M v[64:67], a[160:163], a[12:15], v[64:67]
v_cvt_pk_bf16_f32 v135, v150, v151
v_cvt_pk_bf16_f32 v136, v136, v137
M v[68:71], a[160:163], a[28:31], 0
v_exp_f32 v138, v138
M v[68:71], a[156:159], a[24:27], v[68:71]
M v[68:71], a[152:155], a[20:23], v[68:71]
v_exp_f32 v139, v139
M v[68:71], a[148:151], a[16:19], v[68:71]
v_cvt_pk_bf16_f32 v137, v138, v139
M v[72:75], a[148:151], a[32:35], 0
v_exp_f32 v152, v152
M v[72:75], a[152:155], a[36:39], v[72:75]
M v[72:75], a[156:159], a[40:43], v[72:75]
v_exp_f32 v153, v153
M v[72:75], a[160:163], a[44:47], v[72:75]
v_cvt_pk_bf16_f32 v138, v152, v153
M v[76:79], a[160:163], a[60:63], 0
v_exp_f32 v154, v154
M v[76:79], a[156:159], a[56:59], v[76:79]
s_waitcnt vmcnt(16) lgkmcnt(0)
s_barrier
ds_read_b128 a[116:119], v3 offset:32768
ds_read_b128 a[120:123], v3 offset:40960
ds_read_b128 a[124:127], v3 offset:33792
ds_read_b128 a[128:131], v3 offset:41984
M v[76:79], a[152:155], a[52:55], v[76:79]
v_exp_f32 v155, v155
M v[76:79], a[148:151], a[48:51], v[76:79]
v_cvt_pk_bf16_f32 v139, v154, v155
M v[80:83], a[164:167], a[0:3], 0
v_exp_f32 v140, v140
M v[80:83], a[168:171], a[4:7], v[80:83]
ds_read_b128 a[132:135], v3 offset:34816
ds_read_b128 a[136:139], v3 offset:43008
M v[80:83], a[172:175], a[8:11], v[80:83]
v_exp_f32 v141, v141
M v[80:83], a[176:179], a[12:15], v[80:83]
v_cvt_pk_bf16_f32 v140, v140, v141
M v[84:87], a[176:179], a[28:31], 0
v_exp_f32 v142, v142
M v[84:87], a[172:175], a[24:27], v[84:87]
M v[84:87], a[168:171], a[20:23], v[84:87]
v_exp_f32 v143, v143
M v[84:87], a[164:167], a[16:19], v[84:87]
v_cvt_pk_bf16_f32 v141, v142, v143
M v[88:91], a[164:167], a[32:35], 0
v_exp_f32 v156, v156
M v[88:91], a[168:171], a[36:39], v[88:91]
ds_read_b128 a[140:143], v3 offset:35840
ds_read_b128 a[144:147], v3 offset:44032
M v[88:91], a[172:175], a[40:43], v[88:91]
v_exp_f32 v157, v157
M v[88:91], a[176:179], a[44:47], v[88:91]
v_cvt_pk_bf16_f32 v142, v156, v157
M v[92:95], a[176:179], a[60:63], 0
v_exp_f32 v158, v158
M v[92:95], a[172:175], a[56:59], v[92:95]
M v[92:95], a[168:171], a[52:55], v[92:95]
v_exp_f32 v159, v159
M v[92:95], a[164:167], a[48:51], v[92:95]
v_cvt_pk_bf16_f32 v143, v158, v159
s_waitcnt lgkmcnt(6)
s_add_u32 m0, s29, 65536
M v[160:163], a[116:119], v[96:99], v[160:163]
v_exp_f32 v32, v32
M v[160:163], a[120:123], v[128:131], v[160:163]
ds_read_b128 a[148:151], v3 offset:36864
ds_read_b128 a[152:155], v3 offset:45056
M v[164:167], a[120:123], v[132:135], v[164:167]
v_exp_f32 v33, v33
M v[164:167], a[116:119], v[100:103], v[164:167]
buffer_load_dwordx4 v1, s[12:15], s25 offen offset:0 sc1 lds
s_add_u32 s32, s25, 4096
M v[168:171], a[116:119], v[104:107], v[168:171]
v_exp_f32 v34, v34
M v[168:171], a[120:123], v[136:139], v[168:171]
v_cvt_pk_bf16_f32 v32, v32, v33
M v[172:175], a[120:123], v[140:143], v[172:175]
v_exp_f32 v35, v35
M v[172:175], a[116:119], v[108:111], v[172:175]
buffer_load_dwordx4 v1, s[12:15], s25 offen offset:1024 sc1 lds
s_waitcnt lgkmcnt(6)
M a[96:99], a[112:115], v[96:99], a[96:99]
M a[96:99], a[112:115], v[128:131], a[96:99]
M v[176:179], a[124:127], v[96:99], v[176:179]
v_exp_f32 v48, v48
M v[176:179], a[128:131], v[128:131], v[176:179]
ds_read_b128 a[156:159], v3 offset:37888
ds_read_b128 a[160:163], v3 offset:46080
M v[180:183], a[128:131], v[132:135], v[180:183]
v_exp_f32 v49, v49
M v[180:183], a[124:127], v[100:103], v[180:183]
buffer_load_dwordx4 v1, s[12:15], s25 offen offset:2048 sc1 lds
M v[184:187], a[124:127], v[104:107], v[184:187]
v_exp_f32 v50, v50
M v[184:187], a[128:131], v[136:139], v[184:187]
v_cvt_pk_bf16_f32 v33, v34, v35
v_cvt_pk_bf16_f32 v34, v48, v49
M v[188:191], a[128:131], v[140:143], v[188:191]
v_exp_f32 v51, v51
M v[188:191], a[124:127], v[108:111], v[188:191]
buffer_load_dwordx4 v1, s[12:15], s25 offen offset:3072 sc1 lds
s_add_u32 m0, s29, 69632
s_waitcnt lgkmcnt(6)
M a[100:103], a[112:115], v[100:103], a[100:103]
M a[100:103], a[112:115], v[132:135], a[100:103]
M v[192:195], a[132:135], v[96:99], v[192:195]
v_exp_f32 v36, v36
M v[192:195], a[136:139], v[128:131], v[192:195]
ds_read_b128 a[164:167], v3 offset:38912
ds_read_b128 a[168:171], v3 offset:47104
M v[196:199], a[136:139], v[132:135], v[196:199]
v_exp_f32 v37, v37
M v[196:199], a[132:135], v[100:103], v[196:199]
buffer_load_dwordx4 v1, s[12:15], s32 offen offset:0 sc1 lds
M v[200:203], a[132:135], v[104:107], v[200:203]
v_exp_f32 v38, v38
M v[200:203], a[136:139], v[136:139], v[200:203]
v_cvt_pk_bf16_f32 v35, v50, v51
v_cvt_pk_bf16_f32 v36, v36, v37
M v[204:207], a[136:139], v[140:143], v[204:207]
v_exp_f32 v39, v39
M v[204:207], a[132:135], v[108:111], v[204:207]
buffer_load_dwordx4 v1, s[12:15], s32 offen offset:1024 sc1 lds
s_waitcnt lgkmcnt(6)
M a[104:107], a[112:115], v[104:107], a[104:107]
M a[104:107], a[112:115], v[136:139], a[104:107]
M v[208:211], a[140:143], v[96:99], v[208:211]
v_exp_f32 v52, v52
M v[208:211], a[144:147], v[128:131], v[208:211]
ds_read_b128 a[172:175], v3 offset:39936
ds_read_b128 a[176:179], v3 offset:48128
M v[212:215], a[144:147], v[132:135], v[212:215]
v_exp_f32 v53, v53
M v[212:215], a[140:143], v[100:103], v[212:215]
buffer_load_dwordx4 v1, s[12:15], s32 offen offset:2048 sc1 lds
M v[216:219], a[140:143], v[104:107], v[216:219]
v_exp_f32 v54, v54
M v[216:219], a[144:147], v[136:139], v[216:219]
v_cvt_pk_bf16_f32 v37, v38, v39
v_cvt_pk_bf16_f32 v38, v52, v53
M v[220:223], a[144:147], v[140:143], v[220:223]
v_exp_f32 v55, v55
M v[220:223], a[140:143], v[108:111], v[220:223]
buffer_load_dwordx4 v1, s[12:15], s32 offen offset:3072 sc1 lds
s_waitcnt lgkmcnt(6)
M a[108:111], a[112:115], v[108:111], a[108:111]
M a[108:111], a[112:115], v[140:143], a[108:111]
M v[224:227], a[148:151], v[96:99], v[224:227]
v_exp_f32 v40, v40
M v[224:227], a[152:155], v[128:131], v[224:227]
s_add_u32 s25, s25, 32768
s_cmp_eq_u32 s25, s27
s_cselect_b32 s25, s28, s25
s_cselect_b32 s27, -1, s27
M v[228:231], a[152:155], v[132:135], v[228:231]
v_exp_f32 v41, v41
M v[228:231], a[148:151], v[100:103], v[228:231]
v_cvt_pk_bf16_f32 v39, v54, v55
v_cvt_pk_bf16_f32 v40, v40, v41
M v[232:235], a[148:151], v[104:107], v[232:235]
v_exp_f32 v42, v42
M v[232:235], a[152:155], v[136:139], v[232:235]
M v[236:239], a[152:155], v[140:143], v[236:239]
v_exp_f32 v43, v43
M v[236:239], a[148:151], v[108:111], v[236:239]
v_cvt_pk_bf16_f32 v41, v42, v43
s_waitcnt lgkmcnt(4)
M v[240:243], a[156:159], v[96:99], v[240:243]
v_exp_f32 v56, v56
M v[240:243], a[160:163], v[128:131], v[240:243]
M v[244:247], a[160:163], v[132:135], v[244:247]
v_exp_f32 v57, v57
M v[244:247], a[156:159], v[100:103], v[244:247]
v_cvt_pk_bf16_f32 v42, v56, v57
M v[248:251], a[156:159], v[104:107], v[248:251]
v_exp_f32 v58, v58
M v[248:251], a[160:163], v[136:139], v[248:251]
s_waitcnt vmcnt(16) lgkmcnt(0)
s_barrier
ds_read_b128 a[116:119], v2 offset:0
ds_read_b128 a[120:123], v2 offset:1024
ds_read_b128 a[124:127], v2 offset:2048
ds_read_b128 a[128:131], v2 offset:3072
M v[252:255], a[160:163], v[140:143], v[252:255]
v_exp_f32 v59, v59
M v[252:255], a[156:159], v[108:111], v[252:255]
v_cvt_pk_bf16_f32 v43, v58, v59
M a[64:67], a[164:167], v[96:99], a[64:67]
v_exp_f32 v44, v44
M a[64:67], a[168:171], v[128:131], a[64:67]
ds_read_b128 a[132:135], v2 offset:4096
ds_read_b128 a[136:139], v2 offset:5120
M a[68:71], a[168:171], v[132:135], a[68:71]
v_exp_f32 v45, v45
M a[68:71], a[164:167], v[100:103], a[68:71]
v_cvt_pk_bf16_f32 v44, v44, v45
M a[72:75], a[164:167], v[104:107], a[72:75]
v_exp_f32 v46, v46
M a[72:75], a[168:171], v[136:139], a[72:75]
M a[76:79], a[168:171], v[140:143], a[76:79]
v_exp_f32 v47, v47
M a[76:79], a[164:167], v[108:111], a[76:79]
v_cvt_pk_bf16_f32 v45, v46, v47
M a[80:83], a[172:175], v[96:99], a[80:83]
v_exp_f32 v60, v60
M a[80:83], a[176:179], v[128:131], a[80:83]
ds_read_b128 a[140:143], v2 offset:6144
ds_read_b128 a[144:147], v2 offset:7168
M a[84:87], a[176:179], v[132:135], a[84:87]
v_exp_f32 v61, v61
M a[84:87], a[172:175], v[100:103], a[84:87]
v_cvt_pk_bf16_f32 v46, v60, v61
M a[88:91], a[172:175], v[104:107], a[88:91]
v_exp_f32 v62, v62
M a[88:91], a[176:179], v[136:139], a[88:91]
M a[92:95], a[176:179], v[140:143], a[92:95]
v_exp_f32 v63, v63
M a[92:95], a[172:175], v[108:111], a[92:95]
v_cvt_pk_bf16_f32 v47, v62, v63
s_branch Lk2_l1
Lk2_m1:
s_lshl_b32 s33, s23, 6
s_add_i32 s33, s33, 0
s_cmp_gt_i32 s33, 0
s_cselect_b32 s34, 0, 0xf149f2ca
s_cmp_lt_i32 s33, 0
s_cselect_b32 s33, 0xf149f2ca, 0
v_mov_b32 v20, s34
v_mov_b32 v21, s34
v_mov_b32 v22, s34
v_mov_b32 v23, s34
v_mov_b32 v28, s33
v_mov_b32 v29, s33
v_mov_b32 v30, s33
v_mov_b32 v31, s33
v_med3_f32 v24, v16, v20, v28
v_med3_f32 v25, v17, v20, v28
v_med3_f32 v26, v18, v20, v28
v_med3_f32 v27, v19, v20, v28
s_waitcnt lgkmcnt(4)
s_add_u32 m0, s29, 32768
M v[32:35], a[116:119], a[0:3], v[24:27]
v_exp_f32 v128, v128
M v[32:35], a[120:123], a[4:7], v[32:35]
ds_read_b128 a[148:151], v3 offset:8192
ds_read_b128 a[152:155], v3 offset:9216
M v[32:35], a[124:127], a[8:11], v[32:35]
v_exp_f32 v129, v129
M v[32:35], a[128:131], a[12:15], v[32:35]
buffer_load_dwordx4 v1, s[12:15], s26 offen offset:0 sc1 lds
s_add_u32 s32, s26, 4096
M v[36:39], a[128:131], a[28:31], v[28:31]
v_exp_f32 v130, v130
M v[36:39], a[124:127], a[24:27], v[36:39]
v_cvt_pk_bf16_f32 v128, v128, v129
M v[36:39], a[120:123], a[20:23], v[36:39]
v_exp_f32 v131, v131
M v[36:39], a[116:119], a[16:19], v[36:39]
buffer_load_dwordx4 v1, s[12:15], s26 offen offset:1024 sc1 lds
M v[40:43], a[116:119], a[32:35], v[28:31]
v_exp_f32 v144, v144
M v[40:43], a[120:123], a[36:39], v[40:43]
ds_read_b128 a[156:159], v3 offset:10240
ds_read_b128 a[160:163], v3 offset:11264
M v[40:43], a[124:127], a[40:43], v[40:43]
v_exp_f32 v145, v145
M v[40:43], a[128:131], a[44:47], v[40:43]
buffer_load_dwordx4 v1, s[12:15], s26 offen offset:2048 sc1 lds
M v[44:47], a[128:131], a[60:63], v[28:31]
v_exp_f32 v146, v146
M v[44:47], a[124:127], a[56:59], v[44:47]
v_cvt_pk_bf16_f32 v129, v130, v131
v_cvt_pk_bf16_f32 v130, v144, v145
M v[44:47], a[120:123], a[52:55], v[44:47]
v_exp_f32 v147, v147
M v[44:47], a[116:119], a[48:51], v[44:47]
buffer_load_dwordx4 v1, s[12:15], s26 offen offset:3072 sc1 lds
s_add_u32 m0, s29, 36864
s_waitcnt lgkmcnt(4)
M v[48:51], a[132:135], a[0:3], v[20:23]
v_exp_f32 v132, v132
M v[48:51], a[136:139], a[4:7], v[48:51]
ds_read_b128 a[164:167], v3 offset:12288
ds_read_b128 a[168:171], v3 offset:13312
M v[48:51], a[140:143], a[8:11], v[48:51]
v_exp_f32 v133, v133
M v[48:51], a[144:147], a[12:15], v[48:51]
buffer_load_dwordx4 v1, s[12:15], s32 offen offset:0 sc1 lds
M v[52:55], a[144:147], a[28:31], v[24:27]
v_exp_f32 v134, v134
M v[52:55], a[140:143], a[24:27], v[52:55]
v_cvt_pk_bf16_f32 v131, v146, v147
v_cvt_pk_bf16_f32 v132, v132, v133
M v[52:55], a[136:139], a[20:23], v[52:55]
v_exp_f32 v135, v135
M v[52:55], a[132:135], a[16:19], v[52:55]
buffer_load_dwordx4 v1, s[12:15], s32 offen offset:1024 sc1 lds
M v[56:59], a[132:135], a[32:35], v[28:31]
v_exp_f32 v148, v148
M v[56:59], a[136:139], a[36:39], v[56:59]
ds_read_b128 a[172:175], v3 offset:14336
ds_read_b128 a[176:179], v3 offset:15360
M v[56:59], a[140:143], a[40:43], v[56:59]
v_exp_f32 v149, v149
M v[56:59], a[144:147], a[44:47], v[56:59]
buffer_load_dwordx4 v1, s[12:15], s32 offen offset:2048 sc1 lds
M v[60:63], a[144:147], a[60:63], v[28:31]
v_exp_f32 v150, v150
M v[60:63], a[140:143], a[56:59], v[60:63]
v_cvt_pk_bf16_f32 v133, v134, v135
v_cvt_pk_bf16_f32 v134, v148, v149
M v[60:63], a[136:139], a[52:55], v[60:63]
v_exp_f32 v151, v151
M v[60:63], a[132:135], a[48:51], v[60:63]
buffer_load_dwordx4 v1, s[12:15], s32 offen offset:3072 sc1 lds
s_waitcnt lgkmcnt(4)
M v[64:67], a[148:151], a[0:3], v[20:23]
v_exp_f32 v136, v136
M v[64:67], a[152:155], a[4:7], v[64:67]
s_add_u32 s26, s26, 32768
s_cmp_eq_u32 s26, s62
s_cselect_b32 s26, s63, s26
s_cselect_b32 s62, -1, s62
M v[64:67], a[156:159], a[8:11], v[64:67]
v_exp_f32 v137, v137
M v[64:67], a[160:163], a[12:15], v[64:67]
v_cvt_pk_bf16_f32 v135, v150, v151
v_cvt_pk_bf16_f32 v136, v136, v137
M v[68:71], a[160:163], a[28:31], v[20:23]
v_exp_f32 v138, v138
M v[68:71], a[156:159], a[24:27], v[68:71]
M v[68:71], a[152:155], a[20:23], v[68:71]
v_exp_f32 v139, v139
M v[68:71], a[148:151], a[16:19], v[68:71]
v_cvt_pk_bf16_f32 v137, v138, v139
M v[72:75], a[148:151], a[32:35], v[24:27]
v_exp_f32 v152, v152
M v[72:75], a[152:155], a[36:39], v[72:75]
M v[72:75], a[156:159], a[40:43], v[72:75]
v_exp_f32 v153, v153
M v[72:75], a[160:163], a[44:47], v[72:75]
v_cvt_pk_bf16_f32 v138, v152, v153
M v[76:79], a[160:163], a[60:63], v[28:31]
v_exp_f32 v154, v154
M v[76:79], a[156:159], a[56:59], v[76:79]
s_waitcnt vmcnt(16) lgkmcnt(0)
s_barrier
ds_read_b128 a[116:119], v3 offset:32768
ds_read_b128 a[120:123], v3 offset:40960
ds_read_b128 a[124:127], v3 offset:33792
ds_read_b128 a[128:131], v3 offset:41984
M v[76:79], a[152:155], a[52:55], v[76:79]
v_exp_f32 v155, v155
M v[76:79], a[148:151], a[48:51], v[76:79]
v_cvt_pk_bf16_f32 v139, v154, v155
M v[80:83], a[164:167], a[0:3], v[20:23]
v_exp_f32 v140, v140
M v[80:83], a[168:171], a[4:7], v[80:83]
ds_read_b128 a[132:135], v3 offset:34816
ds_read_b128 a[136:139], v3 offset:43008
M v[80:83], a[172:175], a[8:11], v[80:83]
v_exp_f32 v141, v141
M v[80:83], a[176:179], a[12:15], v[80:83]
v_cvt_pk_bf16_f32 v140, v140, v141
M v[84:87], a[176:179], a[28:31], v[20:23]
v_exp_f32 v142, v142
M v[84:87], a[172:175], a[24:27], v[84:87]
M v[84:87], a[168:171], a[20:23], v[84:87]
v_exp_f32 v143, v143
M v[84:87], a[164:167], a[16:19], v[84:87]
v_cvt_pk_bf16_f32 v141, v142, v143
M v[88:91], a[164:167], a[32:35], v[20:23]
v_exp_f32 v156, v156
M v[88:91], a[168:171], a[36:39], v[88:91]
ds_read_b128 a[140:143], v3 offset:35840
ds_read_b128 a[144:147], v3 offset:44032
M v[88:91], a[172:175], a[40:43], v[88:91]
v_exp_f32 v157, v157
M v[88:91], a[176:179], a[44:47], v[88:91]
v_cvt_pk_bf16_f32 v142, v156, v157
M v[92:95], a[176:179], a[60:63], v[24:27]
v_exp_f32 v158, v158
M v[92:95], a[172:175], a[56:59], v[92:95]
M v[92:95], a[168:171], a[52:55], v[92:95]
v_exp_f32 v159, v159
M v[92:95], a[164:167], a[48:51], v[92:95]
v_cvt_pk_bf16_f32 v143, v158, v159
s_waitcnt lgkmcnt(6)
s_add_u32 m0, s29, 65536
M v[160:163], a[116:119], v[96:99], v[160:163]
v_exp_f32 v32, v32
M v[160:163], a[120:123], v[128:131], v[160:163]
ds_read_b128 a[148:151], v3 offset:36864
ds_read_b128 a[152:155], v3 offset:45056
M v[164:167], a[120:123], v[132:135], v[164:167]
v_exp_f32 v33, v33
M v[164:167], a[116:119], v[100:103], v[164:167]
buffer_load_dwordx4 v1, s[12:15], s25 offen offset:0 sc1 lds
s_add_u32 s32, s25, 4096
M v[168:171], a[116:119], v[104:107], v[168:171]
v_exp_f32 v34, v34
M v[168:171], a[120:123], v[136:139], v[168:171]
v_cvt_pk_bf16_f32 v32, v32, v33
M v[172:175], a[120:123], v[140:143], v[172:175]
v_exp_f32 v35, v35
M v[172:175], a[116:119], v[108:111], v[172:175]
buffer_load_dwordx4 v1, s[12:15], s25 offen offset:1024 sc1 lds
s_waitcnt lgkmcnt(6)
M a[96:99], a[112:115], v[96:99], a[96:99]
M a[96:99], a[112:115], v[128:131], a[96:99]
M v[176:179], a[124:127], v[96:99], v[176:179]
v_exp_f32 v48, v48
M v[176:179], a[128:131], v[128:131], v[176:179]
ds_read_b128 a[156:159], v3 offset:37888
ds_read_b128 a[160:163], v3 offset:46080
M v[180:183], a[128:131], v[132:135], v[180:183]
v_exp_f32 v49, v49
M v[180:183], a[124:127], v[100:103], v[180:183]
buffer_load_dwordx4 v1, s[12:15], s25 offen offset:2048 sc1 lds
M v[184:187], a[124:127], v[104:107], v[184:187]
v_exp_f32 v50, v50
M v[184:187], a[128:131], v[136:139], v[184:187]
v_cvt_pk_bf16_f32 v33, v34, v35
v_cvt_pk_bf16_f32 v34, v48, v49
M v[188:191], a[128:131], v[140:143], v[188:191]
v_exp_f32 v51, v51
M v[188:191], a[124:127], v[108:111], v[188:191]
buffer_load_dwordx4 v1, s[12:15], s25 offen offset:3072 sc1 lds
s_add_u32 m0, s29, 69632
s_waitcnt lgkmcnt(6)
M a[100:103], a[112:115], v[100:103], a[100:103]
M a[100:103], a[112:115], v[132:135], a[100:103]
M v[192:195], a[132:135], v[96:99], v[192:195]
v_exp_f32 v36, v36
M v[192:195], a[136:139], v[128:131], v[192:195]
ds_read_b128 a[164:167], v3 offset:38912
ds_read_b128 a[168:171], v3 offset:47104
M v[196:199], a[136:139], v[132:135], v[196:199]
v_exp_f32 v37, v37
M v[196:199], a[132:135], v[100:103], v[196:199]
buffer_load_dwordx4 v1, s[12:15], s32 offen offset:0 sc1 lds
M v[200:203], a[132:135], v[104:107], v[200:203]
v_exp_f32 v38, v38
M v[200:203], a[136:139], v[136:139], v[200:203]
v_cvt_pk_bf16_f32 v35, v50, v51
v_cvt_pk_bf16_f32 v36, v36, v37
M v[204:207], a[136:139], v[140:143], v[204:207]
v_exp_f32 v39, v39
M v[204:207], a[132:135], v[108:111], v[204:207]
buffer_load_dwordx4 v1, s[12:15], s32 offen offset:1024 sc1 lds
s_waitcnt lgkmcnt(6)
M a[104:107], a[112:115], v[104:107], a[104:107]
M a[104:107], a[112:115], v[136:139], a[104:107]
M v[208:211], a[140:143], v[96:99], v[208:211]
v_exp_f32 v52, v52
M v[208:211], a[144:147], v[128:131], v[208:211]
ds_read_b128 a[172:175], v3 offset:39936
ds_read_b128 a[176:179], v3 offset:48128
M v[212:215], a[144:147], v[132:135], v[212:215]
v_exp_f32 v53, v53
M v[212:215], a[140:143], v[100:103], v[212:215]
buffer_load_dwordx4 v1, s[12:15], s32 offen offset:2048 sc1 lds
M v[216:219], a[140:143], v[104:107], v[216:219]
v_exp_f32 v54, v54
M v[216:219], a[144:147], v[136:139], v[216:219]
v_cvt_pk_bf16_f32 v37, v38, v39
v_cvt_pk_bf16_f32 v38, v52, v53
M v[220:223], a[144:147], v[140:143], v[220:223]
v_exp_f32 v55, v55
M v[220:223], a[140:143], v[108:111], v[220:223]
buffer_load_dwordx4 v1, s[12:15], s32 offen offset:3072 sc1 lds
s_waitcnt lgkmcnt(6)
M a[108:111], a[112:115], v[108:111], a[108:111]
M a[108:111], a[112:115], v[140:143], a[108:111]
M v[224:227], a[148:151], v[96:99], v[224:227]
v_exp_f32 v40, v40
M v[224:227], a[152:155], v[128:131], v[224:227]
s_add_u32 s25, s25, 32768
s_cmp_eq_u32 s25, s27
s_cselect_b32 s25, s28, s25
s_cselect_b32 s27, -1, s27
M v[228:231], a[152:155], v[132:135], v[228:231]
v_exp_f32 v41, v41
M v[228:231], a[148:151], v[100:103], v[228:231]
v_cvt_pk_bf16_f32 v39, v54, v55
v_cvt_pk_bf16_f32 v40, v40, v41
M v[232:235], a[148:151], v[104:107], v[232:235]
v_exp_f32 v42, v42
M v[232:235], a[152:155], v[136:139], v[232:235]
M v[236:239], a[152:155], v[140:143], v[236:239]
v_exp_f32 v43, v43
M v[236:239], a[148:151], v[108:111], v[236:239]
v_cvt_pk_bf16_f32 v41, v42, v43
s_waitcnt lgkmcnt(4)
M v[240:243], a[156:159], v[96:99], v[240:243]
v_exp_f32 v56, v56
M v[240:243], a[160:163], v[128:131], v[240:243]
M v[244:247], a[160:163], v[132:135], v[244:247]
v_exp_f32 v57, v57
M v[244:247], a[156:159], v[100:103], v[244:247]
v_cvt_pk_bf16_f32 v42, v56, v57
M v[248:251], a[156:159], v[104:107], v[248:251]
v_exp_f32 v58, v58
M v[248:251], a[160:163], v[136:139], v[248:251]
s_waitcnt vmcnt(16) lgkmcnt(0)
s_barrier
ds_read_b128 a[116:119], v2 offset:0
ds_read_b128 a[120:123], v2 offset:1024
ds_read_b128 a[124:127], v2 offset:2048
ds_read_b128 a[128:131], v2 offset:3072
M v[252:255], a[160:163], v[140:143], v[252:255]
v_exp_f32 v59, v59
M v[252:255], a[156:159], v[108:111], v[252:255]
v_cvt_pk_bf16_f32 v43, v58, v59
M a[64:67], a[164:167], v[96:99], a[64:67]
v_exp_f32 v44, v44
M a[64:67], a[168:171], v[128:131], a[64:67]
ds_read_b128 a[132:135], v2 offset:4096
ds_read_b128 a[136:139], v2 offset:5120
M a[68:71], a[168:171], v[132:135], a[68:71]
v_exp_f32 v45, v45
M a[68:71], a[164:167], v[100:103], a[68:71]
v_cvt_pk_bf16_f32 v44, v44, v45
M a[72:75], a[164:167], v[104:107], a[72:75]
v_exp_f32 v46, v46
M a[72:75], a[168:171], v[136:139], a[72:75]
M a[76:79], a[168:171], v[140:143], a[76:79]
v_exp_f32 v47, v47
M a[76:79], a[164:167], v[108:111], a[76:79]
v_cvt_pk_bf16_f32 v45, v46, v47
M a[80:83], a[172:175], v[96:99], a[80:83]
v_exp_f32 v60, v60
M a[80:83], a[176:179], v[128:131], a[80:83]
ds_read_b128 a[140:143], v2 offset:6144
ds_read_b128 a[144:147], v2 offset:7168
M a[84:87], a[176:179], v[132:135], a[84:87]
v_exp_f32 v61, v61
M a[84:87], a[172:175], v[100:103], a[84:87]
v_cvt_pk_bf16_f32 v46, v60, v61
M a[88:91], a[172:175], v[104:107], a[88:91]
v_exp_f32 v62, v62
M a[88:91], a[176:179], v[136:139], a[88:91]
M a[92:95], a[176:179], v[140:143], a[92:95]
v_exp_f32 v63, v63
M a[92:95], a[172:175], v[108:111], a[92:95]
v_cvt_pk_bf16_f32 v47, v62, v63
Lk2_m2:
s_sub_u32 s35, 15, s21
s_lshl_b32 s33, s20, 7
s_lshl_b32 s34, s35, 3
s_add_u32 s33, s33, s34
s_lshl_b32 s34, s23, 2
s_add_u32 s33, s33, s34
s_lshl_b32 s33, s33, 12
buffer_load_dwordx4 a[180:183], v1, s[8:11], s33 offen offset:0 sc1
buffer_load_dwordx4 a[184:187], v1, s[8:11], s33 offen offset:1024 sc1
buffer_load_dwordx4 a[188:191], v1, s[8:11], s33 offen offset:2048 sc1
buffer_load_dwordx4 a[192:195], v1, s[8:11], s33 offen offset:3072 sc1
s_add_u32 s33, s33, 4096
buffer_load_dwordx4 a[196:199], v1, s[8:11], s33 offen offset:0 sc1
buffer_load_dwordx4 a[200:203], v1, s[8:11], s33 offen offset:1024 sc1
buffer_load_dwordx4 a[204:207], v1, s[8:11], s33 offen offset:2048 sc1
buffer_load_dwordx4 a[208:211], v1, s[8:11], s33 offen offset:3072 sc1
s_add_u32 s33, s33, 4096
buffer_load_dwordx4 a[212:215], v1, s[8:11], s33 offen offset:0 sc1
buffer_load_dwordx4 a[216:219], v1, s[8:11], s33 offen offset:1024 sc1
buffer_load_dwordx4 a[220:223], v1, s[8:11], s33 offen offset:2048 sc1
buffer_load_dwordx4 a[224:227], v1, s[8:11], s33 offen offset:3072 sc1
s_add_u32 s33, s33, 4096
buffer_load_dwordx4 a[228:231], v1, s[8:11], s33 offen offset:0 sc1
buffer_load_dwordx4 a[232:235], v1, s[8:11], s33 offen offset:1024 sc1
buffer_load_dwordx4 a[236:239], v1, s[8:11], s33 offen offset:2048 sc1
buffer_load_dwordx4 a[240:243], v1, s[8:11], s33 offen offset:3072 sc1
s_lshl_b32 s33, s23, 6
s_add_i32 s33, s33, -64
s_cmp_gt_i32 s33, 0
s_cselect_b32 s34, 0, 0xf149f2ca
s_cmp_lt_i32 s33, 0
s_cselect_b32 s33, 0xf149f2ca, 0
v_mov_b32 v20, s34
v_mov_b32 v21, s34
v_mov_b32 v22, s34
v_mov_b32 v23, s34
v_mov_b32 v28, s33
v_mov_b32 v29, s33
v_mov_b32 v30, s33
v_mov_b32 v31, s33
v_med3_f32 v24, v16, v20, v28
v_med3_f32 v25, v17, v20, v28
v_med3_f32 v26, v18, v20, v28
v_med3_f32 v27, v19, v20, v28
s_waitcnt lgkmcnt(4)
s_add_u32 m0, s29, 98304
M v[96:99], a[116:119], a[0:3], v[24:27]
v_exp_f32 v64, v64
M v[96:99], a[120:123], a[4:7], v[96:99]
ds_read_b128 a[148:151], v2 offset:8192
ds_read_b128 a[152:155], v2 offset:9216
M v[96:99], a[124:127], a[8:11], v[96:99]
v_exp_f32 v65, v65
M v[96:99], a[128:131], a[12:15], v[96:99]
buffer_load_dwordx4 v1, s[12:15], s26 offen offset:0 sc1 lds
s_add_u32 s32, s26, 4096
M v[100:103], a[128:131], a[28:31], v[28:31]
v_exp_f32 v66, v66
M v[100:103], a[124:127], a[24:27], v[100:103]
v_cvt_pk_bf16_f32 v64, v64, v65
M v[100:103], a[120:123], a[20:23], v[100:103]
v_exp_f32 v67, v67
M v[100:103], a[116:119], a[16:19], v[100:103]
buffer_load_dwordx4 v1, s[12:15], s26 offen offset:1024 sc1 lds
M v[104:107], a[116:119], a[32:35], v[28:31]
v_exp_f32 v80, v80
M v[104:107], a[120:123], a[36:39], v[104:107]
ds_read_b128 a[156:159], v2 offset:10240
ds_read_b128 a[160:163], v2 offset:11264
M v[104:107], a[124:127], a[40:43], v[104:107]
v_exp_f32 v81, v81
M v[104:107], a[128:131], a[44:47], v[104:107]
buffer_load_dwordx4 v1, s[12:15], s26 offen offset:2048 sc1 lds
M v[108:111], a[128:131], a[60:63], v[28:31]
v_exp_f32 v82, v82
M v[108:111], a[124:127], a[56:59], v[108:111]
v_cvt_pk_bf16_f32 v65, v66, v67
v_cvt_pk_bf16_f32 v66, v80, v81
M v[108:111], a[120:123], a[52:55], v[108:111]
v_exp_f32 v83, v83
M v[108:111], a[116:119], a[48:51], v[108:111]
buffer_load_dwordx4 v1, s[12:15], s26 offen offset:3072 sc1 lds
s_add_u32 m0, s29, 102400
s_waitcnt lgkmcnt(4)
M v[112:115], a[132:135], a[0:3], v[20:23]
v_exp_f32 v68, v68
M v[112:115], a[136:139], a[4:7], v[112:115]
ds_read_b128 a[164:167], v2 offset:12288
ds_read_b128 a[168:171], v2 offset:13312
M v[112:115], a[140:143], a[8:11], v[112:115]
v_exp_f32 v69, v69
M v[112:115], a[144:147], a[12:15], v[112:115]
buffer_load_dwordx4 v1, s[12:15], s32 offen offset:0 sc1 lds
M v[116:119], a[144:147], a[28:31], v[24:27]
v_exp_f32 v70, v70
M v[116:119], a[140:143], a[24:27], v[116:119]
v_cvt_pk_bf16_f32 v67, v82, v83
v_cvt_pk_bf16_f32 v68, v68, v69
M v[116:119], a[136:139], a[20:23], v[116:119]
v_exp_f32 v71, v71
M v[116:119], a[132:135], a[16:19], v[116:119]
buffer_load_dwordx4 v1, s[12:15], s32 offen offset:1024 sc1 lds
M v[120:123], a[132:135], a[32:35], v[28:31]
v_exp_f32 v84, v84
M v[120:123], a[136:139], a[36:39], v[120:123]
ds_read_b128 a[172:175], v2 offset:14336
ds_read_b128 a[176:179], v2 offset:15360
M v[120:123], a[140:143], a[40:43], v[120:123]
v_exp_f32 v85, v85
M v[120:123], a[144:147], a[44:47], v[120:123]
buffer_load_dwordx4 v1, s[12:15], s32 offen offset:2048 sc1 lds
M v[124:127], a[144:147], a[60:63], v[28:31]
v_exp_f32 v86, v86
M v[124:127], a[140:143], a[56:59], v[124:127]
v_cvt_pk_bf16_f32 v69, v70, v71
v_cvt_pk_bf16_f32 v70, v84, v85
M v[124:127], a[136:139], a[52:55], v[124:127]
v_exp_f32 v87, v87
M v[124:127], a[132:135], a[48:51], v[124:127]
buffer_load_dwordx4 v1, s[12:15], s32 offen offset:3072 sc1 lds
s_waitcnt lgkmcnt(4)
M v[128:131], a[148:151], a[0:3], v[20:23]
v_exp_f32 v72, v72
M v[128:131], a[152:155], a[4:7], v[128:131]
s_add_u32 s26, s26, 32768
s_cmp_eq_u32 s26, s62
s_cselect_b32 s26, s63, s26
s_cselect_b32 s62, -1, s62
M v[128:131], a[156:159], a[8:11], v[128:131]
v_exp_f32 v73, v73
M v[128:131], a[160:163], a[12:15], v[128:131]
v_cvt_pk_bf16_f32 v71, v86, v87
v_cvt_pk_bf16_f32 v72, v72, v73
M v[132:135], a[160:163], a[28:31], v[20:23]
v_exp_f32 v74, v74
M v[132:135], a[156:159], a[24:27], v[132:135]
M v[132:135], a[152:155], a[20:23], v[132:135]
v_exp_f32 v75, v75
M v[132:135], a[148:151], a[16:19], v[132:135]
v_cvt_pk_bf16_f32 v73, v74, v75
M v[136:139], a[148:151], a[32:35], v[24:27]
v_exp_f32 v88, v88
M v[136:139], a[152:155], a[36:39], v[136:139]
M v[136:139], a[156:159], a[40:43], v[136:139]
v_exp_f32 v89, v89
M v[136:139], a[160:163], a[44:47], v[136:139]
v_cvt_pk_bf16_f32 v74, v88, v89
M v[140:143], a[160:163], a[60:63], v[28:31]
v_exp_f32 v90, v90
M v[140:143], a[156:159], a[56:59], v[140:143]
s_waitcnt vmcnt(32) lgkmcnt(0)
s_barrier
ds_read_b128 a[116:119], v2 offset:32768
ds_read_b128 a[120:123], v2 offset:40960
ds_read_b128 a[124:127], v2 offset:33792
ds_read_b128 a[128:131], v2 offset:41984
M v[140:143], a[152:155], a[52:55], v[140:143]
v_exp_f32 v91, v91
M v[140:143], a[148:151], a[48:51], v[140:143]
v_cvt_pk_bf16_f32 v75, v90, v91
M v[144:147], a[164:167], a[0:3], v[20:23]
v_exp_f32 v76, v76
M v[144:147], a[168:171], a[4:7], v[144:147]
ds_read_b128 a[132:135], v2 offset:34816
ds_read_b128 a[136:139], v2 offset:43008
M v[144:147], a[172:175], a[8:11], v[144:147]
v_exp_f32 v77, v77
M v[144:147], a[176:179], a[12:15], v[144:147]
v_cvt_pk_bf16_f32 v76, v76, v77
M v[148:151], a[176:179], a[28:31], v[20:23]
v_exp_f32 v78, v78
M v[148:151], a[172:175], a[24:27], v[148:151]
M v[148:151], a[168:171], a[20:23], v[148:151]
v_exp_f32 v79, v79
M v[148:151], a[164:167], a[16:19], v[148:151]
v_cvt_pk_bf16_f32 v77, v78, v79
M v[152:155], a[164:167], a[32:35], v[20:23]
v_exp_f32 v92, v92
M v[152:155], a[168:171], a[36:39], v[152:155]
ds_read_b128 a[140:143], v2 offset:35840
ds_read_b128 a[144:147], v2 offset:44032
M v[152:155], a[172:175], a[40:43], v[152:155]
v_exp_f32 v93, v93
M v[152:155], a[176:179], a[44:47], v[152:155]
v_cvt_pk_bf16_f32 v78, v92, v93
M v[156:159], a[176:179], a[60:63], v[24:27]
v_exp_f32 v94, v94
M v[156:159], a[172:175], a[56:59], v[156:159]
M v[156:159], a[168:171], a[52:55], v[156:159]
v_exp_f32 v95, v95
M v[156:159], a[164:167], a[48:51], v[156:159]
v_cvt_pk_bf16_f32 v79, v94, v95
s_waitcnt lgkmcnt(6)
s_add_u32 m0, s29, 0
M v[160:163], a[116:119], v[32:35], v[160:163]
v_exp_f32 v96, v96
M v[160:163], a[120:123], v[64:67], v[160:163]
ds_read_b128 a[148:151], v2 offset:36864
ds_read_b128 a[152:155], v2 offset:45056
M v[164:167], a[120:123], v[68:71], v[164:167]
v_exp_f32 v97, v97
M v[164:167], a[116:119], v[36:39], v[164:167]
buffer_load_dwordx4 v1, s[12:15], s25 offen offset:0 sc1 lds
s_add_u32 s32, s25, 4096
M v[168:171], a[116:119], v[40:43], v[168:171]
v_exp_f32 v98, v98
M v[168:171], a[120:123], v[72:75], v[168:171]
v_cvt_pk_bf16_f32 v96, v96, v97
M v[172:175], a[120:123], v[76:79], v[172:175]
v_exp_f32 v99, v99
M v[172:175], a[116:119], v[44:47], v[172:175]
buffer_load_dwordx4 v1, s[12:15], s25 offen offset:1024 sc1 lds
s_waitcnt lgkmcnt(6)
M a[96:99], a[112:115], v[32:35], a[96:99]
M a[96:99], a[112:115], v[64:67], a[96:99]
M v[176:179], a[124:127], v[32:35], v[176:179]
v_exp_f32 v112, v112
M v[176:179], a[128:131], v[64:67], v[176:179]
ds_read_b128 a[156:159], v2 offset:37888
ds_read_b128 a[160:163], v2 offset:46080
M v[180:183], a[128:131], v[68:71], v[180:183]
v_exp_f32 v113, v113
M v[180:183], a[124:127], v[36:39], v[180:183]
buffer_load_dwordx4 v1, s[12:15], s25 offen offset:2048 sc1 lds
M v[184:187], a[124:127], v[40:43], v[184:187]
v_exp_f32 v114, v114
M v[184:187], a[128:131], v[72:75], v[184:187]
v_cvt_pk_bf16_f32 v97, v98, v99
v_cvt_pk_bf16_f32 v98, v112, v113
M v[188:191], a[128:131], v[76:79], v[188:191]
v_exp_f32 v115, v115
M v[188:191], a[124:127], v[44:47], v[188:191]
buffer_load_dwordx4 v1, s[12:15], s25 offen offset:3072 sc1 lds
s_add_u32 m0, s29, 4096
s_waitcnt lgkmcnt(6)
M a[100:103], a[112:115], v[36:39], a[100:103]
M a[100:103], a[112:115], v[68:71], a[100:103]
M v[192:195], a[132:135], v[32:35], v[192:195]
v_exp_f32 v100, v100
M v[192:195], a[136:139], v[64:67], v[192:195]
ds_read_b128 a[164:167], v2 offset:38912
ds_read_b128 a[168:171], v2 offset:47104
M v[196:199], a[136:139], v[68:71], v[196:199]
v_exp_f32 v101, v101
M v[196:199], a[132:135], v[36:39], v[196:199]
buffer_load_dwordx4 v1, s[12:15], s32 offen offset:0 sc1 lds
M v[200:203], a[132:135], v[40:43], v[200:203]
v_exp_f32 v102, v102
M v[200:203], a[136:139], v[72:75], v[200:203]
v_cvt_pk_bf16_f32 v99, v114, v115
v_cvt_pk_bf16_f32 v100, v100, v101
M v[204:207], a[136:139], v[76:79], v[204:207]
v_exp_f32 v103, v103
M v[204:207], a[132:135], v[44:47], v[204:207]
buffer_load_dwordx4 v1, s[12:15], s32 offen offset:1024 sc1 lds
s_waitcnt lgkmcnt(6)
M a[104:107], a[112:115], v[40:43], a[104:107]
M a[104:107], a[112:115], v[72:75], a[104:107]
M v[208:211], a[140:143], v[32:35], v[208:211]
v_exp_f32 v116, v116
M v[208:211], a[144:147], v[64:67], v[208:211]
ds_read_b128 a[172:175], v2 offset:39936
ds_read_b128 a[176:179], v2 offset:48128
M v[212:215], a[144:147], v[68:71], v[212:215]
v_exp_f32 v117, v117
M v[212:215], a[140:143], v[36:39], v[212:215]
buffer_load_dwordx4 v1, s[12:15], s32 offen offset:2048 sc1 lds
M v[216:219], a[140:143], v[40:43], v[216:219]
v_exp_f32 v118, v118
M v[216:219], a[144:147], v[72:75], v[216:219]
v_cvt_pk_bf16_f32 v101, v102, v103
v_cvt_pk_bf16_f32 v102, v116, v117
M v[220:223], a[144:147], v[76:79], v[220:223]
v_exp_f32 v119, v119
M v[220:223], a[140:143], v[44:47], v[220:223]
buffer_load_dwordx4 v1, s[12:15], s32 offen offset:3072 sc1 lds
s_waitcnt lgkmcnt(6)
M a[108:111], a[112:115], v[44:47], a[108:111]
M a[108:111], a[112:115], v[76:79], a[108:111]
M v[224:227], a[148:151], v[32:35], v[224:227]
v_exp_f32 v104, v104
M v[224:227], a[152:155], v[64:67], v[224:227]
s_add_u32 s25, s25, 32768
s_cmp_eq_u32 s25, s27
s_cselect_b32 s25, s28, s25
s_cselect_b32 s27, -1, s27
M v[228:231], a[152:155], v[68:71], v[228:231]
v_exp_f32 v105, v105
M v[228:231], a[148:151], v[36:39], v[228:231]
v_cvt_pk_bf16_f32 v103, v118, v119
v_cvt_pk_bf16_f32 v104, v104, v105
M v[232:235], a[148:151], v[40:43], v[232:235]
v_exp_f32 v106, v106
M v[232:235], a[152:155], v[72:75], v[232:235]
M v[236:239], a[152:155], v[76:79], v[236:239]
v_exp_f32 v107, v107
M v[236:239], a[148:151], v[44:47], v[236:239]
v_cvt_pk_bf16_f32 v105, v106, v107
s_waitcnt lgkmcnt(4)
M v[240:243], a[156:159], v[32:35], v[240:243]
v_exp_f32 v120, v120
M v[240:243], a[160:163], v[64:67], v[240:243]
M v[244:247], a[160:163], v[68:71], v[244:247]
v_exp_f32 v121, v121
M v[244:247], a[156:159], v[36:39], v[244:247]
v_cvt_pk_bf16_f32 v106, v120, v121
M v[248:251], a[156:159], v[40:43], v[248:251]
v_exp_f32 v122, v122
M v[248:251], a[160:163], v[72:75], v[248:251]
s_waitcnt vmcnt(32) lgkmcnt(0)
s_barrier
ds_read_b128 a[116:119], v3 offset:0
ds_read_b128 a[120:123], v3 offset:1024
ds_read_b128 a[124:127], v3 offset:2048
ds_read_b128 a[128:131], v3 offset:3072
M v[252:255], a[160:163], v[76:79], v[252:255]
v_exp_f32 v123, v123
M v[252:255], a[156:159], v[44:47], v[252:255]
v_cvt_pk_bf16_f32 v107, v122, v123
M a[64:67], a[164:167], v[32:35], a[64:67]
v_exp_f32 v108, v108
M a[64:67], a[168:171], v[64:67], a[64:67]
ds_read_b128 a[132:135], v3 offset:4096
ds_read_b128 a[136:139], v3 offset:5120
M a[68:71], a[168:171], v[68:71], a[68:71]
v_exp_f32 v109, v109
M a[68:71], a[164:167], v[36:39], a[68:71]
v_cvt_pk_bf16_f32 v108, v108, v109
M a[72:75], a[164:167], v[40:43], a[72:75]
v_exp_f32 v110, v110
M a[72:75], a[168:171], v[72:75], a[72:75]
M a[76:79], a[168:171], v[76:79], a[76:79]
v_exp_f32 v111, v111
M a[76:79], a[164:167], v[44:47], a[76:79]
v_cvt_pk_bf16_f32 v109, v110, v111
M a[80:83], a[172:175], v[32:35], a[80:83]
v_exp_f32 v124, v124
M a[80:83], a[176:179], v[64:67], a[80:83]
ds_read_b128 a[140:143], v3 offset:6144
ds_read_b128 a[144:147], v3 offset:7168
M a[84:87], a[176:179], v[68:71], a[84:87]
v_exp_f32 v125, v125
M a[84:87], a[172:175], v[36:39], a[84:87]
v_cvt_pk_bf16_f32 v110, v124, v125
M a[88:91], a[172:175], v[40:43], a[88:91]
v_exp_f32 v126, v126
M a[88:91], a[176:179], v[72:75], a[88:91]
M a[92:95], a[176:179], v[76:79], a[92:95]
v_exp_f32 v127, v127
M a[92:95], a[172:175], v[44:47], a[92:95]
v_cvt_pk_bf16_f32 v111, v126, v127
s_waitcnt vmcnt(16)
s_waitcnt lgkmcnt(4)
s_add_u32 m0, s29, 32768
M v[32:35], a[116:119], a[180:183], 0
v_exp_f32 v128, v128
M v[32:35], a[120:123], a[184:187], v[32:35]
ds_read_b128 a[148:151], v3 offset:8192
ds_read_b128 a[152:155], v3 offset:9216
M v[32:35], a[124:127], a[188:191], v[32:35]
v_exp_f32 v129, v129
M v[32:35], a[128:131], a[192:195], v[32:35]
buffer_load_dwordx4 v1, s[12:15], s26 offen offset:0 sc1 lds
s_add_u32 s32, s26, 4096
M v[36:39], a[128:131], a[208:211], 0
v_exp_f32 v130, v130
M v[36:39], a[124:127], a[204:207], v[36:39]
v_cvt_pk_bf16_f32 v128, v128, v129
M v[36:39], a[120:123], a[200:203], v[36:39]
v_exp_f32 v131, v131
M v[36:39], a[116:119], a[196:199], v[36:39]
buffer_load_dwordx4 v1, s[12:15], s26 offen offset:1024 sc1 lds
M v[40:43], a[116:119], a[212:215], 0
v_exp_f32 v144, v144
M v[40:43], a[120:123], a[216:219], v[40:43]
ds_read_b128 a[156:159], v3 offset:10240
ds_read_b128 a[160:163], v3 offset:11264
M v[40:43], a[124:127], a[220:223], v[40:43]
v_exp_f32 v145, v145
M v[40:43], a[128:131], a[224:227], v[40:43]
buffer_load_dwordx4 v1, s[12:15], s26 offen offset:2048 sc1 lds
M v[44:47], a[128:131], a[240:243], 0
v_exp_f32 v146, v146
M v[44:47], a[124:127], a[236:239], v[44:47]
v_cvt_pk_bf16_f32 v129, v130, v131
v_cvt_pk_bf16_f32 v130, v144, v145
M v[44:47], a[120:123], a[232:235], v[44:47]
v_exp_f32 v147, v147
M v[44:47], a[116:119], a[228:231], v[44:47]
buffer_load_dwordx4 v1, s[12:15], s26 offen offset:3072 sc1 lds
s_add_u32 m0, s29, 36864
s_waitcnt lgkmcnt(4)
M v[48:51], a[132:135], a[180:183], 0
v_exp_f32 v132, v132
M v[48:51], a[136:139], a[184:187], v[48:51]
ds_read_b128 a[164:167], v3 offset:12288
ds_read_b128 a[168:171], v3 offset:13312
M v[48:51], a[140:143], a[188:191], v[48:51]
v_exp_f32 v133, v133
M v[48:51], a[144:147], a[192:195], v[48:51]
buffer_load_dwordx4 v1, s[12:15], s32 offen offset:0 sc1 lds
M v[52:55], a[144:147], a[208:211], 0
v_exp_f32 v134, v134
M v[52:55], a[140:143], a[204:207], v[52:55]
v_cvt_pk_bf16_f32 v131, v146, v147
v_cvt_pk_bf16_f32 v132, v132, v133
M v[52:55], a[136:139], a[200:203], v[52:55]
v_exp_f32 v135, v135
M v[52:55], a[132:135], a[196:199], v[52:55]
buffer_load_dwordx4 v1, s[12:15], s32 offen offset:1024 sc1 lds
M v[56:59], a[132:135], a[212:215], 0
v_exp_f32 v148, v148
M v[56:59], a[136:139], a[216:219], v[56:59]
ds_read_b128 a[172:175], v3 offset:14336
ds_read_b128 a[176:179], v3 offset:15360
M v[56:59], a[140:143], a[220:223], v[56:59]
v_exp_f32 v149, v149
M v[56:59], a[144:147], a[224:227], v[56:59]
buffer_load_dwordx4 v1, s[12:15], s32 offen offset:2048 sc1 lds
M v[60:63], a[144:147], a[240:243], 0
v_exp_f32 v150, v150
M v[60:63], a[140:143], a[236:239], v[60:63]
v_cvt_pk_bf16_f32 v133, v134, v135
v_cvt_pk_bf16_f32 v134, v148, v149
M v[60:63], a[136:139], a[232:235], v[60:63]
v_exp_f32 v151, v151
M v[60:63], a[132:135], a[228:231], v[60:63]
buffer_load_dwordx4 v1, s[12:15], s32 offen offset:3072 sc1 lds
s_waitcnt lgkmcnt(4)
M v[64:67], a[148:151], a[180:183], 0
v_exp_f32 v136, v136
M v[64:67], a[152:155], a[184:187], v[64:67]
s_add_u32 s26, s26, 32768
s_cmp_eq_u32 s26, s62
s_cselect_b32 s26, s63, s26
s_cselect_b32 s62, -1, s62
M v[64:67], a[156:159], a[188:191], v[64:67]
v_exp_f32 v137, v137
M v[64:67], a[160:163], a[192:195], v[64:67]
v_cvt_pk_bf16_f32 v135, v150, v151
v_cvt_pk_bf16_f32 v136, v136, v137
M v[68:71], a[160:163], a[208:211], 0
v_exp_f32 v138, v138
M v[68:71], a[156:159], a[204:207], v[68:71]
M v[68:71], a[152:155], a[200:203], v[68:71]
v_exp_f32 v139, v139
M v[68:71], a[148:151], a[196:199], v[68:71]
v_cvt_pk_bf16_f32 v137, v138, v139
M v[72:75], a[148:151], a[212:215], 0
v_exp_f32 v152, v152
M v[72:75], a[152:155], a[216:219], v[72:75]
M v[72:75], a[156:159], a[220:223], v[72:75]
v_exp_f32 v153, v153
M v[72:75], a[160:163], a[224:227], v[72:75]
v_cvt_pk_bf16_f32 v138, v152, v153
M v[76:79], a[160:163], a[240:243], 0
v_exp_f32 v154, v154
M v[76:79], a[156:159], a[236:239], v[76:79]
s_waitcnt vmcnt(16) lgkmcnt(0)
s_barrier
ds_read_b128 a[116:119], v3 offset:32768
ds_read_b128 a[120:123], v3 offset:40960
ds_read_b128 a[124:127], v3 offset:33792
ds_read_b128 a[128:131], v3 offset:41984
M v[76:79], a[152:155], a[232:235], v[76:79]
v_exp_f32 v155, v155
M v[76:79], a[148:151], a[228:231], v[76:79]
v_cvt_pk_bf16_f32 v139, v154, v155
M v[80:83], a[164:167], a[180:183], 0
v_exp_f32 v140, v140
M v[80:83], a[168:171], a[184:187], v[80:83]
ds_read_b128 a[132:135], v3 offset:34816
ds_read_b128 a[136:139], v3 offset:43008
M v[80:83], a[172:175], a[188:191], v[80:83]
v_exp_f32 v141, v141
M v[80:83], a[176:179], a[192:195], v[80:83]
v_cvt_pk_bf16_f32 v140, v140, v141
M v[84:87], a[176:179], a[208:211], 0
v_exp_f32 v142, v142
M v[84:87], a[172:175], a[204:207], v[84:87]
M v[84:87], a[168:171], a[200:203], v[84:87]
v_exp_f32 v143, v143
M v[84:87], a[164:167], a[196:199], v[84:87]
v_cvt_pk_bf16_f32 v141, v142, v143
M v[88:91], a[164:167], a[212:215], 0
v_exp_f32 v156, v156
M v[88:91], a[168:171], a[216:219], v[88:91]
ds_read_b128 a[140:143], v3 offset:35840
ds_read_b128 a[144:147], v3 offset:44032
M v[88:91], a[172:175], a[220:223], v[88:91]
v_exp_f32 v157, v157
M v[88:91], a[176:179], a[224:227], v[88:91]
v_cvt_pk_bf16_f32 v142, v156, v157
M v[92:95], a[176:179], a[240:243], 0
v_exp_f32 v158, v158
M v[92:95], a[172:175], a[236:239], v[92:95]
M v[92:95], a[168:171], a[232:235], v[92:95]
v_exp_f32 v159, v159
M v[92:95], a[164:167], a[228:231], v[92:95]
v_cvt_pk_bf16_f32 v143, v158, v159
s_waitcnt lgkmcnt(6)
s_add_u32 m0, s29, 65536
M v[160:163], a[116:119], v[96:99], v[160:163]
v_exp_f32 v32, v32
M v[160:163], a[120:123], v[128:131], v[160:163]
ds_read_b128 a[148:151], v3 offset:36864
ds_read_b128 a[152:155], v3 offset:45056
M v[164:167], a[120:123], v[132:135], v[164:167]
v_exp_f32 v33, v33
M v[164:167], a[116:119], v[100:103], v[164:167]
buffer_load_dwordx4 v1, s[12:15], s25 offen offset:0 sc1 lds
s_add_u32 s32, s25, 4096
M v[168:171], a[116:119], v[104:107], v[168:171]
v_exp_f32 v34, v34
M v[168:171], a[120:123], v[136:139], v[168:171]
v_cvt_pk_bf16_f32 v32, v32, v33
M v[172:175], a[120:123], v[140:143], v[172:175]
v_exp_f32 v35, v35
M v[172:175], a[116:119], v[108:111], v[172:175]
buffer_load_dwordx4 v1, s[12:15], s25 offen offset:1024 sc1 lds
s_waitcnt lgkmcnt(6)
M a[96:99], a[112:115], v[96:99], a[96:99]
M a[96:99], a[112:115], v[128:131], a[96:99]
M v[176:179], a[124:127], v[96:99], v[176:179]
v_exp_f32 v48, v48
M v[176:179], a[128:131], v[128:131], v[176:179]
ds_read_b128 a[156:159], v3 offset:37888
ds_read_b128 a[160:163], v3 offset:46080
M v[180:183], a[128:131], v[132:135], v[180:183]
v_exp_f32 v49, v49
M v[180:183], a[124:127], v[100:103], v[180:183]
buffer_load_dwordx4 v1, s[12:15], s25 offen offset:2048 sc1 lds
M v[184:187], a[124:127], v[104:107], v[184:187]
v_exp_f32 v50, v50
M v[184:187], a[128:131], v[136:139], v[184:187]
v_cvt_pk_bf16_f32 v33, v34, v35
v_cvt_pk_bf16_f32 v34, v48, v49
M v[188:191], a[128:131], v[140:143], v[188:191]
v_exp_f32 v51, v51
M v[188:191], a[124:127], v[108:111], v[188:191]
buffer_load_dwordx4 v1, s[12:15], s25 offen offset:3072 sc1 lds
s_add_u32 m0, s29, 69632
s_waitcnt lgkmcnt(6)
M a[100:103], a[112:115], v[100:103], a[100:103]
M a[100:103], a[112:115], v[132:135], a[100:103]
M v[192:195], a[132:135], v[96:99], v[192:195]
v_exp_f32 v36, v36
M v[192:195], a[136:139], v[128:131], v[192:195]
ds_read_b128 a[164:167], v3 offset:38912
ds_read_b128 a[168:171], v3 offset:47104
M v[196:199], a[136:139], v[132:135], v[196:199]
v_exp_f32 v37, v37
M v[196:199], a[132:135], v[100:103], v[196:199]
buffer_load_dwordx4 v1, s[12:15], s32 offen offset:0 sc1 lds
M v[200:203], a[132:135], v[104:107], v[200:203]
v_exp_f32 v38, v38
M v[200:203], a[136:139], v[136:139], v[200:203]
v_cvt_pk_bf16_f32 v35, v50, v51
v_cvt_pk_bf16_f32 v36, v36, v37
M v[204:207], a[136:139], v[140:143], v[204:207]
v_exp_f32 v39, v39
M v[204:207], a[132:135], v[108:111], v[204:207]
buffer_load_dwordx4 v1, s[12:15], s32 offen offset:1024 sc1 lds
s_waitcnt lgkmcnt(6)
M a[104:107], a[112:115], v[104:107], a[104:107]
M a[104:107], a[112:115], v[136:139], a[104:107]
M v[208:211], a[140:143], v[96:99], v[208:211]
v_exp_f32 v52, v52
M v[208:211], a[144:147], v[128:131], v[208:211]
ds_read_b128 a[172:175], v3 offset:39936
ds_read_b128 a[176:179], v3 offset:48128
M v[212:215], a[144:147], v[132:135], v[212:215]
v_exp_f32 v53, v53
M v[212:215], a[140:143], v[100:103], v[212:215]
buffer_load_dwordx4 v1, s[12:15], s32 offen offset:2048 sc1 lds
M v[216:219], a[140:143], v[104:107], v[216:219]
v_exp_f32 v54, v54
M v[216:219], a[144:147], v[136:139], v[216:219]
v_cvt_pk_bf16_f32 v37, v38, v39
v_cvt_pk_bf16_f32 v38, v52, v53
M v[220:223], a[144:147], v[140:143], v[220:223]
v_exp_f32 v55, v55
M v[220:223], a[140:143], v[108:111], v[220:223]
buffer_load_dwordx4 v1, s[12:15], s32 offen offset:3072 sc1 lds
s_waitcnt lgkmcnt(6)
M a[108:111], a[112:115], v[108:111], a[108:111]
M a[108:111], a[112:115], v[140:143], a[108:111]
M v[224:227], a[148:151], v[96:99], v[224:227]
v_exp_f32 v40, v40
M v[224:227], a[152:155], v[128:131], v[224:227]
s_add_u32 s25, s25, 32768
s_cmp_eq_u32 s25, s27
s_cselect_b32 s25, s28, s25
s_cselect_b32 s27, -1, s27
M v[228:231], a[152:155], v[132:135], v[228:231]
v_exp_f32 v41, v41
M v[228:231], a[148:151], v[100:103], v[228:231]
v_cvt_pk_bf16_f32 v39, v54, v55
v_cvt_pk_bf16_f32 v40, v40, v41
M v[232:235], a[148:151], v[104:107], v[232:235]
v_exp_f32 v42, v42
M v[232:235], a[152:155], v[136:139], v[232:235]
M v[236:239], a[152:155], v[140:143], v[236:239]
v_exp_f32 v43, v43
M v[236:239], a[148:151], v[108:111], v[236:239]
v_cvt_pk_bf16_f32 v41, v42, v43
s_waitcnt lgkmcnt(4)
M v[240:243], a[156:159], v[96:99], v[240:243]
v_exp_f32 v56, v56
M v[240:243], a[160:163], v[128:131], v[240:243]
M v[244:247], a[160:163], v[132:135], v[244:247]
v_exp_f32 v57, v57
M v[244:247], a[156:159], v[100:103], v[244:247]
v_cvt_pk_bf16_f32 v42, v56, v57
M v[248:251], a[156:159], v[104:107], v[248:251]
v_exp_f32 v58, v58
M v[248:251], a[160:163], v[136:139], v[248:251]
s_waitcnt vmcnt(16) lgkmcnt(0)
s_barrier
ds_read_b128 a[116:119], v2 offset:0
ds_read_b128 a[120:123], v2 offset:1024
ds_read_b128 a[124:127], v2 offset:2048
ds_read_b128 a[128:131], v2 offset:3072
M v[252:255], a[160:163], v[140:143], v[252:255]
v_exp_f32 v59, v59
M v[252:255], a[156:159], v[108:111], v[252:255]
v_cvt_pk_bf16_f32 v43, v58, v59
M a[64:67], a[164:167], v[96:99], a[64:67]
v_exp_f32 v44, v44
M a[64:67], a[168:171], v[128:131], a[64:67]
ds_read_b128 a[132:135], v2 offset:4096
ds_read_b128 a[136:139], v2 offset:5120
M a[68:71], a[168:171], v[132:135], a[68:71]
v_exp_f32 v45, v45
M a[68:71], a[164:167], v[100:103], a[68:71]
v_cvt_pk_bf16_f32 v44, v44, v45
M a[72:75], a[164:167], v[104:107], a[72:75]
v_exp_f32 v46, v46
M a[72:75], a[168:171], v[136:139], a[72:75]
M a[76:79], a[168:171], v[140:143], a[76:79]
v_exp_f32 v47, v47
M a[76:79], a[164:167], v[108:111], a[76:79]
v_cvt_pk_bf16_f32 v45, v46, v47
M a[80:83], a[172:175], v[96:99], a[80:83]
v_exp_f32 v60, v60
M a[80:83], a[176:179], v[128:131], a[80:83]
ds_read_b128 a[140:143], v2 offset:6144
ds_read_b128 a[144:147], v2 offset:7168
M a[84:87], a[176:179], v[132:135], a[84:87]
v_exp_f32 v61, v61
M a[84:87], a[172:175], v[100:103], a[84:87]
v_cvt_pk_bf16_f32 v46, v60, v61
M a[88:91], a[172:175], v[104:107], a[88:91]
v_exp_f32 v62, v62
M a[88:91], a[176:179], v[136:139], a[88:91]
M a[92:95], a[176:179], v[140:143], a[92:95]
v_exp_f32 v63, v63
M a[92:95], a[172:175], v[108:111], a[92:95]
v_cvt_pk_bf16_f32 v47, v62, v63
v_accvgpr_read_b32 v20, a96
v_accvgpr_read_b32 v21, a100
v_accvgpr_read_b32 v22, a104
v_accvgpr_read_b32 v23, a108
v_rcp_f32 v8, v20
v_rcp_f32 v9, v21
v_rcp_f32 v10, v22
v_rcp_f32 v11, v23
v_subrev_u32 v20, 0x21800000, v20
v_subrev_u32 v21, 0x21800000, v21
v_subrev_u32 v22, 0x21800000, v22
v_subrev_u32 v23, 0x21800000, v23
v_max_u32 v12, v20, v21
v_max3_u32 v12, v12, v22, v23
s_mov_b32 s64, 0x207
v_pk_mul_f32 v[160:161], v[160:161], v[8:9] op_sel:[0,0] op_sel_hi:[1,0]
v_pk_mul_f32 v[162:163], v[162:163], v[8:9] op_sel:[0,0] op_sel_hi:[1,0]
v_pk_mul_f32 v[176:177], v[176:177], v[8:9] op_sel:[0,0] op_sel_hi:[1,0]
v_pk_mul_f32 v[178:179], v[178:179], v[8:9] op_sel:[0,0] op_sel_hi:[1,0]
v_cvt_pk_bf16_f32 v160, v160, v161
v_cvt_pk_bf16_f32 v161, v162, v163
v_cvt_pk_bf16_f32 v162, v176, v177
v_cvt_pk_bf16_f32 v163, v178, v179
s_nop 1
M v[24:27], a[112:115], v[160:163], 0
v_pk_mul_f32 v[164:165], v[164:165], v[8:9] op_sel:[0,1] op_sel_hi:[1,1]
v_pk_mul_f32 v[166:167], v[166:167], v[8:9] op_sel:[0,1] op_sel_hi:[1,1]
v_pk_mul_f32 v[180:181], v[180:181], v[8:9] op_sel:[0,1] op_sel_hi:[1,1]
v_pk_mul_f32 v[182:183], v[182:183], v[8:9] op_sel:[0,1] op_sel_hi:[1,1]
v_cvt_pk_bf16_f32 v164, v164, v165
v_cvt_pk_bf16_f32 v165, v166, v167
v_cvt_pk_bf16_f32 v166, v180, v181
v_cvt_pk_bf16_f32 v167, v182, v183
s_nop 1
M v[24:27], a[112:115], v[164:167], v[24:27]
v_pk_mul_f32 v[168:169], v[168:169], v[10:11] op_sel:[0,0] op_sel_hi:[1,0]
v_pk_mul_f32 v[170:171], v[170:171], v[10:11] op_sel:[0,0] op_sel_hi:[1,0]
v_pk_mul_f32 v[184:185], v[184:185], v[10:11] op_sel:[0,0] op_sel_hi:[1,0]
v_pk_mul_f32 v[186:187], v[186:187], v[10:11] op_sel:[0,0] op_sel_hi:[1,0]
v_cvt_pk_bf16_f32 v168, v168, v169
v_cvt_pk_bf16_f32 v169, v170, v171
v_cvt_pk_bf16_f32 v170, v184, v185
v_cvt_pk_bf16_f32 v171, v186, v187
s_nop 1
M v[24:27], a[112:115], v[168:171], v[24:27]
v_pk_mul_f32 v[172:173], v[172:173], v[10:11] op_sel:[0,1] op_sel_hi:[1,1]
v_pk_mul_f32 v[174:175], v[174:175], v[10:11] op_sel:[0,1] op_sel_hi:[1,1]
v_pk_mul_f32 v[188:189], v[188:189], v[10:11] op_sel:[0,1] op_sel_hi:[1,1]
v_pk_mul_f32 v[190:191], v[190:191], v[10:11] op_sel:[0,1] op_sel_hi:[1,1]
v_cvt_pk_bf16_f32 v172, v172, v173
v_cvt_pk_bf16_f32 v173, v174, v175
v_cvt_pk_bf16_f32 v174, v188, v189
v_cvt_pk_bf16_f32 v175, v190, v191
s_nop 1
M v[24:27], a[112:115], v[172:175], v[24:27]
v_pk_mul_f32 v[192:193], v[192:193], v[8:9] op_sel:[0,0] op_sel_hi:[1,0]
v_pk_mul_f32 v[194:195], v[194:195], v[8:9] op_sel:[0,0] op_sel_hi:[1,0]
v_pk_mul_f32 v[208:209], v[208:209], v[8:9] op_sel:[0,0] op_sel_hi:[1,0]
v_pk_mul_f32 v[210:211], v[210:211], v[8:9] op_sel:[0,0] op_sel_hi:[1,0]
v_cvt_pk_bf16_f32 v192, v192, v193
v_cvt_pk_bf16_f32 v193, v194, v195
v_cvt_pk_bf16_f32 v194, v208, v209
v_cvt_pk_bf16_f32 v195, v210, v211
s_nop 1
M v[24:27], a[112:115], v[192:195], v[24:27]
v_pk_mul_f32 v[196:197], v[196:197], v[8:9] op_sel:[0,1] op_sel_hi:[1,1]
v_pk_mul_f32 v[198:199], v[198:199], v[8:9] op_sel:[0,1] op_sel_hi:[1,1]
v_pk_mul_f32 v[212:213], v[212:213], v[8:9] op_sel:[0,1] op_sel_hi:[1,1]
v_pk_mul_f32 v[214:215], v[214:215], v[8:9] op_sel:[0,1] op_sel_hi:[1,1]
v_cvt_pk_bf16_f32 v196, v196, v197
v_cvt_pk_bf16_f32 v197, v198, v199
v_cvt_pk_bf16_f32 v198, v212, v213
v_cvt_pk_bf16_f32 v199, v214, v215
s_nop 1
M v[24:27], a[112:115], v[196:199], v[24:27]
v_pk_mul_f32 v[200:201], v[200:201], v[10:11] op_sel:[0,0] op_sel_hi:[1,0]
v_pk_mul_f32 v[202:203], v[202:203], v[10:11] op_sel:[0,0] op_sel_hi:[1,0]
v_pk_mul_f32 v[216:217], v[216:217], v[10:11] op_sel:[0,0] op_sel_hi:[1,0]
v_pk_mul_f32 v[218:219], v[218:219], v[10:11] op_sel:[0,0] op_sel_hi:[1,0]
v_cvt_pk_bf16_f32 v200, v200, v201
v_cvt_pk_bf16_f32 v201, v202, v203
v_cvt_pk_bf16_f32 v202, v216, v217
v_cvt_pk_bf16_f32 v203, v218, v219
s_nop 1
M v[24:27], a[112:115], v[200:203], v[24:27]
v_pk_mul_f32 v[204:205], v[204:205], v[10:11] op_sel:[0,1] op_sel_hi:[1,1]
v_pk_mul_f32 v[206:207], v[206:207], v[10:11] op_sel:[0,1] op_sel_hi:[1,1]
v_pk_mul_f32 v[220:221], v[220:221], v[10:11] op_sel:[0,1] op_sel_hi:[1,1]
v_pk_mul_f32 v[222:223], v[222:223], v[10:11] op_sel:[0,1] op_sel_hi:[1,1]
v_cvt_pk_bf16_f32 v204, v204, v205
v_cvt_pk_bf16_f32 v205, v206, v207
v_cvt_pk_bf16_f32 v206, v220, v221
v_cvt_pk_bf16_f32 v207, v222, v223
s_nop 1
M v[24:27], a[112:115], v[204:207], v[24:27]
v_pk_mul_f32 v[224:225], v[224:225], v[8:9] op_sel:[0,0] op_sel_hi:[1,0]
v_pk_mul_f32 v[226:227], v[226:227], v[8:9] op_sel:[0,0] op_sel_hi:[1,0]
v_pk_mul_f32 v[240:241], v[240:241], v[8:9] op_sel:[0,0] op_sel_hi:[1,0]
v_pk_mul_f32 v[242:243], v[242:243], v[8:9] op_sel:[0,0] op_sel_hi:[1,0]
v_cvt_pk_bf16_f32 v224, v224, v225
v_cvt_pk_bf16_f32 v225, v226, v227
v_cvt_pk_bf16_f32 v226, v240, v241
v_cvt_pk_bf16_f32 v227, v242, v243
s_nop 1
M v[24:27], a[112:115], v[224:227], v[24:27]
v_pk_mul_f32 v[228:229], v[228:229], v[8:9] op_sel:[0,1] op_sel_hi:[1,1]
v_pk_mul_f32 v[230:231], v[230:231], v[8:9] op_sel:[0,1] op_sel_hi:[1,1]
v_pk_mul_f32 v[244:245], v[244:245], v[8:9] op_sel:[0,1] op_sel_hi:[1,1]
v_pk_mul_f32 v[246:247], v[246:247], v[8:9] op_sel:[0,1] op_sel_hi:[1,1]
v_cvt_pk_bf16_f32 v228, v228, v229
v_cvt_pk_bf16_f32 v229, v230, v231
v_cvt_pk_bf16_f32 v230, v244, v245
v_cvt_pk_bf16_f32 v231, v246, v247
s_nop 1
M v[24:27], a[112:115], v[228:231], v[24:27]
v_pk_mul_f32 v[232:233], v[232:233], v[10:11] op_sel:[0,0] op_sel_hi:[1,0]
v_pk_mul_f32 v[234:235], v[234:235], v[10:11] op_sel:[0,0] op_sel_hi:[1,0]
v_pk_mul_f32 v[248:249], v[248:249], v[10:11] op_sel:[0,0] op_sel_hi:[1,0]
v_pk_mul_f32 v[250:251], v[250:251], v[10:11] op_sel:[0,0] op_sel_hi:[1,0]
v_cvt_pk_bf16_f32 v232, v232, v233
v_cvt_pk_bf16_f32 v233, v234, v235
v_cvt_pk_bf16_f32 v234, v248, v249
v_cvt_pk_bf16_f32 v235, v250, v251
s_nop 1
M v[24:27], a[112:115], v[232:235], v[24:27]
v_pk_mul_f32 v[236:237], v[236:237], v[10:11] op_sel:[0,1] op_sel_hi:[1,1]
v_pk_mul_f32 v[238:239], v[238:239], v[10:11] op_sel:[0,1] op_sel_hi:[1,1]
v_pk_mul_f32 v[252:253], v[252:253], v[10:11] op_sel:[0,1] op_sel_hi:[1,1]
v_pk_mul_f32 v[254:255], v[254:255], v[10:11] op_sel:[0,1] op_sel_hi:[1,1]
v_cvt_pk_bf16_f32 v236, v236, v237
v_cvt_pk_bf16_f32 v237, v238, v239
v_cvt_pk_bf16_f32 v238, v252, v253
v_cvt_pk_bf16_f32 v239, v254, v255
v_accvgpr_read_b32 v176, a64
v_accvgpr_read_b32 v177, a65
v_accvgpr_read_b32 v178, a66
v_accvgpr_read_b32 v179, a67
v_accvgpr_read_b32 v180, a80
v_accvgpr_read_b32 v181, a81
v_accvgpr_read_b32 v182, a82
v_accvgpr_read_b32 v183, a83
M v[24:27], a[112:115], v[236:239], v[24:27]
v_pk_mul_f32 v[176:177], v[176:177], v[8:9] op_sel:[0,0] op_sel_hi:[1,0]
v_pk_mul_f32 v[178:179], v[178:179], v[8:9] op_sel:[0,0] op_sel_hi:[1,0]
v_pk_mul_f32 v[180:181], v[180:181], v[8:9] op_sel:[0,0] op_sel_hi:[1,0]
v_pk_mul_f32 v[182:183], v[182:183], v[8:9] op_sel:[0,0] op_sel_hi:[1,0]
v_cvt_pk_bf16_f32 v176, v176, v177
v_cvt_pk_bf16_f32 v177, v178, v179
v_cvt_pk_bf16_f32 v178, v180, v181
v_cvt_pk_bf16_f32 v179, v182, v183
v_accvgpr_read_b32 v184, a68
v_accvgpr_read_b32 v185, a69
v_accvgpr_read_b32 v186, a70
v_accvgpr_read_b32 v187, a71
v_accvgpr_read_b32 v188, a84
v_accvgpr_read_b32 v189, a85
v_accvgpr_read_b32 v190, a86
v_accvgpr_read_b32 v191, a87
M v[24:27], a[112:115], v[176:179], v[24:27]
v_pk_mul_f32 v[184:185], v[184:185], v[8:9] op_sel:[0,1] op_sel_hi:[1,1]
v_pk_mul_f32 v[186:187], v[186:187], v[8:9] op_sel:[0,1] op_sel_hi:[1,1]
v_pk_mul_f32 v[188:189], v[188:189], v[8:9] op_sel:[0,1] op_sel_hi:[1,1]
v_pk_mul_f32 v[190:191], v[190:191], v[8:9] op_sel:[0,1] op_sel_hi:[1,1]
v_cvt_pk_bf16_f32 v184, v184, v185
v_cvt_pk_bf16_f32 v185, v186, v187
v_cvt_pk_bf16_f32 v186, v188, v189
v_cvt_pk_bf16_f32 v187, v190, v191
v_accvgpr_read_b32 v208, a72
v_accvgpr_read_b32 v209, a73
v_accvgpr_read_b32 v210, a74
v_accvgpr_read_b32 v211, a75
v_accvgpr_read_b32 v212, a88
v_accvgpr_read_b32 v213, a89
v_accvgpr_read_b32 v214, a90
v_accvgpr_read_b32 v215, a91
M v[24:27], a[112:115], v[184:187], v[24:27]
v_pk_mul_f32 v[208:209], v[208:209], v[10:11] op_sel:[0,0] op_sel_hi:[1,0]
v_pk_mul_f32 v[210:211], v[210:211], v[10:11] op_sel:[0,0] op_sel_hi:[1,0]
v_pk_mul_f32 v[212:213], v[212:213], v[10:11] op_sel:[0,0] op_sel_hi:[1,0]
v_pk_mul_f32 v[214:215], v[214:215], v[10:11] op_sel:[0,0] op_sel_hi:[1,0]
v_cvt_pk_bf16_f32 v208, v208, v209
v_cvt_pk_bf16_f32 v209, v210, v211
v_cvt_pk_bf16_f32 v210, v212, v213
v_cvt_pk_bf16_f32 v211, v214, v215
v_accvgpr_read_b32 v216, a76
v_accvgpr_read_b32 v217, a77
v_accvgpr_read_b32 v218, a78
v_accvgpr_read_b32 v219, a79
v_accvgpr_read_b32 v220, a92
v_accvgpr_read_b32 v221, a93
v_accvgpr_read_b32 v222, a94
v_accvgpr_read_b32 v223, a95
M v[24:27], a[112:115], v[208:211], v[24:27]
v_pk_mul_f32 v[216:217], v[216:217], v[10:11] op_sel:[0,1] op_sel_hi:[1,1]
v_pk_mul_f32 v[218:219], v[218:219], v[10:11] op_sel:[0,1] op_sel_hi:[1,1]
v_pk_mul_f32 v[220:221], v[220:221], v[10:11] op_sel:[0,1] op_sel_hi:[1,1]
v_pk_mul_f32 v[222:223], v[222:223], v[10:11] op_sel:[0,1] op_sel_hi:[1,1]
v_cvt_pk_bf16_f32 v216, v216, v217
v_cvt_pk_bf16_f32 v217, v218, v219
v_cvt_pk_bf16_f32 v218, v220, v221
v_cvt_pk_bf16_f32 v219, v222, v223
s_nop 1
M v[24:27], a[112:115], v[216:219], v[24:27]
v_cmp_lt_u32 vcc, 0x3c000000, v12
s_nop 6
v_cmp_class_f32 s[40:41], v24, s64
s_nop 0
s_or_b64 vcc, vcc, s[40:41]
s_cbranch_vccnz Lbad_1
s_lshl_b32 s33, s21, 20
s_lshl_b32 s34, s20, 15
s_add_u32 s33, s33, s34
s_lshl_b32 s34, s23, 13
s_add_u32 s36, s33, s34
s_add_u32 s37, s36, 4096
s_add_u32 s38, s36, 16384
s_add_u32 s39, s36, 20480
buffer_store_dwordx4 v[160:163], v1, s[16:19], s36 offen offset:0 sc1
buffer_store_dwordx4 v[164:167], v1, s[16:19], s36 offen offset:2048 sc1
buffer_store_dwordx4 v[168:171], v1, s[16:19], s37 offen offset:0 sc1
buffer_store_dwordx4 v[172:175], v1, s[16:19], s37 offen offset:2048 sc1
buffer_store_dwordx4 v[192:195], v1, s[16:19], s36 offen offset:1024 sc1
buffer_store_dwordx4 v[196:199], v1, s[16:19], s36 offen offset:3072 sc1
buffer_store_dwordx4 v[200:203], v1, s[16:19], s37 offen offset:1024 sc1
buffer_store_dwordx4 v[204:207], v1, s[16:19], s37 offen offset:3072 sc1
buffer_store_dwordx4 v[224:227], v1, s[16:19], s38 offen offset:0 sc1
buffer_store_dwordx4 v[228:231], v1, s[16:19], s38 offen offset:2048 sc1
buffer_store_dwordx4 v[232:235], v1, s[16:19], s39 offen offset:0 sc1
buffer_store_dwordx4 v[236:239], v1, s[16:19], s39 offen offset:2048 sc1
buffer_store_dwordx4 v[176:179], v1, s[16:19], s38 offen offset:1024 sc1
buffer_store_dwordx4 v[184:187], v1, s[16:19], s38 offen offset:3072 sc1
buffer_store_dwordx4 v[208:211], v1, s[16:19], s39 offen offset:1024 sc1
buffer_store_dwordx4 v[216:219], v1, s[16:19], s39 offen offset:3072 sc1
s_branch Lfd_2
Lbad_1:
s_or_b32 s60, s60, 1
Lfd_2:
s_sub_u32 s30, 7, s21
s_cmp_lg_u32 s30, 0
s_cbranch_scc1 Lk2_b0
s_waitcnt vmcnt(8)
s_waitcnt lgkmcnt(0)
s_barrier
s_and_b32 s3, s2, 3
s_lshl_b32 s3, s3, 2
s_bfe_u32 s27, s2, 0x20003
s_add_u32 s27, s3, s27
s_lshl_b32 s43, s27, 8
s_add_u32 s43, s43, 8400896
v_lshlrev_b32 v15, 2, v0
buffer_load_dword v7, v15, s[52:55], s43 offen sc1
s_lshl_b32 s33, s2, 2
s_add_u32 s33, s33, s22
s_lshl_b32 s34, s33, 11
s_lshl_b32 s33, s33, 13
v_lshlrev_b32 v8, 3, v1
v_lshlrev_b32 v9, 1, v1
buffer_load_dword v5, v8, s[44:47], s33 offen
buffer_load_dword v6, v9, s[48:51], s34 offen
ds_read_b128 a[116:119], v2 offset:32768
ds_read_b128 a[120:123], v2 offset:40960
ds_read_b128 a[124:127], v2 offset:33792
ds_read_b128 a[128:131], v2 offset:41984
ds_read_b128 a[132:135], v2 offset:34816
ds_read_b128 a[136:139], v2 offset:43008
ds_read_b128 a[140:143], v2 offset:35840
ds_read_b128 a[144:147], v2 offset:44032
v_exp_f32 v64, v64
v_exp_f32 v65, v65
v_exp_f32 v66, v66
v_exp_f32 v67, v67
v_exp_f32 v80, v80
v_exp_f32 v81, v81
v_exp_f32 v82, v82
v_exp_f32 v83, v83
v_cvt_pk_bf16_f32 v64, v64, v65
v_cvt_pk_bf16_f32 v65, v66, v67
v_exp_f32 v68, v68
v_exp_f32 v69, v69
v_exp_f32 v70, v70
v_exp_f32 v71, v71
v_cvt_pk_bf16_f32 v66, v80, v81
v_cvt_pk_bf16_f32 v67, v82, v83
v_exp_f32 v84, v84
v_exp_f32 v85, v85
v_exp_f32 v86, v86
v_exp_f32 v87, v87
v_cvt_pk_bf16_f32 v68, v68, v69
v_cvt_pk_bf16_f32 v69, v70, v71
v_exp_f32 v72, v72
v_exp_f32 v73, v73
v_exp_f32 v74, v74
v_exp_f32 v75, v75
v_cvt_pk_bf16_f32 v70, v84, v85
v_cvt_pk_bf16_f32 v71, v86, v87
v_exp_f32 v88, v88
v_exp_f32 v89, v89
v_exp_f32 v90, v90
v_exp_f32 v91, v91
v_cvt_pk_bf16_f32 v72, v72, v73
v_cvt_pk_bf16_f32 v73, v74, v75
v_exp_f32 v76, v76
v_exp_f32 v77, v77
v_exp_f32 v78, v78
v_exp_f32 v79, v79
v_cvt_pk_bf16_f32 v74, v88, v89
v_cvt_pk_bf16_f32 v75, v90, v91
v_exp_f32 v92, v92
v_exp_f32 v93, v93
v_exp_f32 v94, v94
v_exp_f32 v95, v95
v_cvt_pk_bf16_f32 v76, v76, v77
v_cvt_pk_bf16_f32 v77, v78, v79
v_cvt_pk_bf16_f32 v78, v92, v93
v_cvt_pk_bf16_f32 v79, v94, v95
s_waitcnt lgkmcnt(6)
M v[160:163], a[116:119], v[32:35], 0
M v[160:163], a[120:123], v[64:67], v[160:163]
ds_read_b128 a[148:151], v2 offset:36864
ds_read_b128 a[152:155], v2 offset:45056
s_mov_b32 s61, 0
M v[164:167], a[120:123], v[68:71], 0
M v[164:167], a[116:119], v[36:39], v[164:167]
s_bfe_u32 s3, s2, 0x10002
M v[168:171], a[116:119], v[40:43], 0
M v[168:171], a[120:123], v[72:75], v[168:171]
s_lshl_b32 s3, s3, 3
M v[172:175], a[120:123], v[76:79], 0
M v[172:175], a[116:119], v[44:47], v[172:175]
s_waitcnt lgkmcnt(6)
s_lshr_b32 s28, s2, 5
M a[96:99], a[112:115], v[32:35], 0
M a[96:99], a[112:115], v[64:67], a[96:99]
M v[176:179], a[124:127], v[32:35], 0
M v[176:179], a[128:131], v[64:67], v[176:179]
ds_read_b128 a[156:159], v2 offset:37888
ds_read_b128 a[160:163], v2 offset:46080
s_add_u32 s28, s3, s28
M v[180:183], a[128:131], v[68:71], 0
s_lshl_b32 s25, s27, 18
M v[180:183], a[124:127], v[36:39], v[180:183]
M v[184:187], a[124:127], v[40:43], 0
s_lshl_b32 s3, s101, 12
M v[184:187], a[128:131], v[72:75], v[184:187]
M v[188:191], a[128:131], v[76:79], 0
s_add_u32 s25, s25, s3
M v[188:191], a[124:127], v[44:47], v[188:191]
s_waitcnt lgkmcnt(6)
M a[100:103], a[112:115], v[36:39], 0
M a[100:103], a[112:115], v[68:71], a[100:103]
M v[192:195], a[132:135], v[32:35], 0
s_lshl_b32 s26, s28, 7
M v[192:195], a[136:139], v[64:67], v[192:195]
ds_read_b128 a[164:167], v2 offset:38912
ds_read_b128 a[168:171], v2 offset:47104
M v[196:199], a[136:139], v[68:71], 0
s_lshl_b32 s42, s101, 11
M v[196:199], a[132:135], v[36:39], v[196:199]
M v[200:203], a[132:135], v[40:43], 0
s_add_u32 s44, s4, 83886080
s_addc_u32 s45, s5, 0
M v[200:203], a[136:139], v[72:75], v[200:203]
s_mov_b32 s46, 4194304
M v[204:207], a[136:139], v[76:79], 0
M v[204:207], a[132:135], v[44:47], v[204:207]
s_waitcnt lgkmcnt(6)
s_mov_b32 s47, 0x00020000
M a[104:107], a[112:115], v[40:43], 0
M a[104:107], a[112:115], v[72:75], a[104:107]
M v[208:211], a[140:143], v[32:35], 0
M v[208:211], a[144:147], v[64:67], v[208:211]
ds_read_b128 a[172:175], v2 offset:39936
ds_read_b128 a[176:179], v2 offset:48128
s_mov_b32 s50, 2097152
M v[212:215], a[144:147], v[68:71], 0
M v[212:215], a[140:143], v[36:39], v[212:215]
s_mov_b32 s51, 0x00020000
M v[216:219], a[140:143], v[40:43], 0
M v[216:219], a[144:147], v[72:75], v[216:219]
s_lshl_b32 s3, s101, 4
M v[220:223], a[144:147], v[76:79], 0
M v[220:223], a[140:143], v[44:47], v[220:223]
s_waitcnt lgkmcnt(6)
v_lshrrev_b32 v96, 3, v0
M a[108:111], a[112:115], v[44:47], 0
M a[108:111], a[112:115], v[76:79], a[108:111]
M v[224:227], a[148:151], v[32:35], 0
v_and_b32 v97, 6, v96
M v[224:227], a[152:155], v[64:67], v[224:227]
M v[228:231], a[152:155], v[68:71], 0
v_and_b32 v98, 7, v0
M v[228:231], a[148:151], v[36:39], v[228:231]
M v[232:235], a[148:151], v[40:43], 0
v_xor_b32 v97, v97, v98
M v[232:235], a[152:155], v[72:75], v[232:235]
M v[236:239], a[152:155], v[76:79], 0
v_add_u32 v96, s3, v96
M v[236:239], a[148:151], v[44:47], v[236:239]
s_waitcnt lgkmcnt(4)
M v[240:243], a[156:159], v[32:35], 0
v_lshlrev_b32 v96, 11, v96
M v[240:243], a[160:163], v[64:67], v[240:243]
M v[244:247], a[160:163], v[68:71], 0
v_lshl_add_u32 v99, v97, 4, v96
M v[244:247], a[156:159], v[36:39], v[244:247]
v_add_u32 v100, 15360, v99
M v[248:251], a[156:159], v[40:43], 0
M v[248:251], a[160:163], v[72:75], v[248:251]
s_waitcnt vmcnt(2) lgkmcnt(0)
s_barrier
v_cmp_ne_u32 vcc, 1, v7
s_nop 0
s_cbranch_vccnz Lk3_spinb1
Lk3_gotb1:
M v[252:255], a[160:163], v[76:79], 0
s_add_u32 m0, s42, 65536
s_nop 0
buffer_load_dwordx4 v99, s[48:51], s26 offen offset:0 lds
buffer_load_dwordx4 v100, s[48:51], s26 offen offset:1024 lds
M v[252:255], a[156:159], v[44:47], v[252:255]
buffer_load_dwordx4 a[192:195], v1, s[44:47], s25 offen offset:0 sc1
buffer_load_dwordx4 a[196:199], v1, s[44:47], s25 offen offset:1024 sc1
M a[64:67], a[164:167], v[32:35], 0
buffer_load_dwordx4 a[200:203], v1, s[44:47], s25 offen offset:2048 sc1
buffer_load_dwordx4 a[204:207], v1, s[44:47], s25 offen offset:3072 sc1
M a[64:67], a[168:171], v[64:67], a[64:67]
s_add_u32 s25, s25, 16384
s_add_u32 s26, s26, 131072
s_add_u32 m0, s42, 81920
s_nop 0
buffer_load_dwordx4 v99, s[48:51], s26 offen offset:0 lds
M a[68:71], a[168:171], v[68:71], 0
buffer_load_dwordx4 v100, s[48:51], s26 offen offset:1024 lds
buffer_load_dwordx4 a[208:211], v1, s[44:47], s25 offen offset:0 sc1
M a[68:71], a[164:167], v[36:39], a[68:71]
buffer_load_dwordx4 a[212:215], v1, s[44:47], s25 offen offset:1024 sc1
buffer_load_dwordx4 a[216:219], v1, s[44:47], s25 offen offset:2048 sc1
M a[72:75], a[164:167], v[40:43], 0
buffer_load_dwordx4 a[220:223], v1, s[44:47], s25 offen offset:3072 sc1
s_add_u32 s25, s25, 16384
s_add_u32 s26, s26, 131072
M a[72:75], a[168:171], v[72:75], a[72:75]
s_add_u32 m0, s42, 98304
s_nop 0
buffer_load_dwordx4 v99, s[48:51], s26 offen offset:0 lds
buffer_load_dwordx4 v100, s[48:51], s26 offen offset:1024 lds
M a[76:79], a[168:171], v[76:79], 0
buffer_load_dwordx4 a[224:227], v1, s[44:47], s25 offen offset:0 sc1
M a[76:79], a[164:167], v[44:47], a[76:79]
buffer_load_dwordx4 a[228:231], v1, s[44:47], s25 offen offset:1024 sc1
buffer_load_dwordx4 a[232:235], v1, s[44:47], s25 offen offset:2048 sc1
M a[80:83], a[172:175], v[32:35], 0
buffer_load_dwordx4 a[236:239], v1, s[44:47], s25 offen offset:3072 sc1
s_add_u32 s25, s25, 16384
s_add_u32 s26, s26, 131072
M a[80:83], a[176:179], v[64:67], a[80:83]
s_add_u32 m0, s42, 114688
s_nop 0
buffer_load_dwordx4 v99, s[48:51], s26 offen offset:0 lds
buffer_load_dwordx4 v100, s[48:51], s26 offen offset:1024 lds
M a[84:87], a[176:179], v[68:71], 0
buffer_load_dwordx4 a[240:243], v1, s[44:47], s25 offen offset:0 sc1
buffer_load_dwordx4 a[244:247], v1, s[44:47], s25 offen offset:1024 sc1
M a[84:87], a[172:175], v[36:39], a[84:87]
buffer_load_dwordx4 a[248:251], v1, s[44:47], s25 offen offset:2048 sc1
buffer_load_dwordx4 a[252:255], v1, s[44:47], s25 offen offset:3072 sc1
M a[88:91], a[172:175], v[40:43], 0
s_add_u32 s25, s25, 16384
s_add_u32 s26, s26, 131072
s_add_u32 m0, s42, 0
s_nop 0
buffer_load_dwordx4 v99, s[48:51], s26 offen offset:0 lds
M a[88:91], a[176:179], v[72:75], a[88:91]
buffer_load_dwordx4 v100, s[48:51], s26 offen offset:1024 lds
buffer_load_dwordx4 a[128:131], v1, s[44:47], s25 offen offset:0 sc1
M a[92:95], a[176:179], v[76:79], 0
buffer_load_dwordx4 a[132:135], v1, s[44:47], s25 offen offset:1024 sc1
buffer_load_dwordx4 a[136:139], v1, s[44:47], s25 offen offset:2048 sc1
M a[92:95], a[172:175], v[44:47], a[92:95]
buffer_load_dwordx4 a[140:143], v1, s[44:47], s25 offen offset:3072 sc1
s_add_u32 s25, s25, 16384
s_add_u32 s26, s26, 131072
s_branch Lk2_merge
Lk2_b0:
s_waitcnt lgkmcnt(4)
s_add_u32 m0, s29, 98304
M v[96:99], a[116:119], a[180:183], 0
v_exp_f32 v64, v64
M v[96:99], a[120:123], a[184:187], v[96:99]
ds_read_b128 a[148:151], v2 offset:8192
ds_read_b128 a[152:155], v2 offset:9216
M v[96:99], a[124:127], a[188:191], v[96:99]
v_exp_f32 v65, v65
M v[96:99], a[128:131], a[192:195], v[96:99]
buffer_load_dwordx4 v1, s[12:15], s26 offen offset:0 sc1 lds
s_add_u32 s32, s26, 4096
M v[100:103], a[128:131], a[208:211], 0
v_exp_f32 v66, v66
M v[100:103], a[124:127], a[204:207], v[100:103]
v_cvt_pk_bf16_f32 v64, v64, v65
M v[100:103], a[120:123], a[200:203], v[100:103]
v_exp_f32 v67, v67
M v[100:103], a[116:119], a[196:199], v[100:103]
buffer_load_dwordx4 v1, s[12:15], s26 offen offset:1024 sc1 lds
M v[104:107], a[116:119], a[212:215], 0
v_exp_f32 v80, v80
M v[104:107], a[120:123], a[216:219], v[104:107]
ds_read_b128 a[156:159], v2 offset:10240
ds_read_b128 a[160:163], v2 offset:11264
M v[104:107], a[124:127], a[220:223], v[104:107]
v_exp_f32 v81, v81
M v[104:107], a[128:131], a[224:227], v[104:107]
buffer_load_dwordx4 v1, s[12:15], s26 offen offset:2048 sc1 lds
M v[108:111], a[128:131], a[240:243], 0
v_exp_f32 v82, v82
M v[108:111], a[124:127], a[236:239], v[108:111]
v_cvt_pk_bf16_f32 v65, v66, v67
v_cvt_pk_bf16_f32 v66, v80, v81
M v[108:111], a[120:123], a[232:235], v[108:111]
v_exp_f32 v83, v83
M v[108:111], a[116:119], a[228:231], v[108:111]
buffer_load_dwordx4 v1, s[12:15], s26 offen offset:3072 sc1 lds
s_add_u32 m0, s29, 102400
s_waitcnt lgkmcnt(4)
M v[112:115], a[132:135], a[180:183], 0
v_exp_f32 v68, v68
M v[112:115], a[136:139], a[184:187], v[112:115]
ds_read_b128 a[164:167], v2 offset:12288
ds_read_b128 a[168:171], v2 offset:13312
M v[112:115], a[140:143], a[188:191], v[112:115]
v_exp_f32 v69, v69
M v[112:115], a[144:147], a[192:195], v[112:115]
buffer_load_dwordx4 v1, s[12:15], s32 offen offset:0 sc1 lds
M v[116:119], a[144:147], a[208:211], 0
v_exp_f32 v70, v70
M v[116:119], a[140:143], a[204:207], v[116:119]
v_cvt_pk_bf16_f32 v67, v82, v83
v_cvt_pk_bf16_f32 v68, v68, v69
M v[116:119], a[136:139], a[200:203], v[116:119]
v_exp_f32 v71, v71
M v[116:119], a[132:135], a[196:199], v[116:119]
buffer_load_dwordx4 v1, s[12:15], s32 offen offset:1024 sc1 lds
M v[120:123], a[132:135], a[212:215], 0
v_exp_f32 v84, v84
M v[120:123], a[136:139], a[216:219], v[120:123]
ds_read_b128 a[172:175], v2 offset:14336
ds_read_b128 a[176:179], v2 offset:15360
M v[120:123], a[140:143], a[220:223], v[120:123]
v_exp_f32 v85, v85
M v[120:123], a[144:147], a[224:227], v[120:123]
buffer_load_dwordx4 v1, s[12:15], s32 offen offset:2048 sc1 lds
M v[124:127], a[144:147], a[240:243], 0
v_exp_f32 v86, v86
M v[124:127], a[140:143], a[236:239], v[124:127]
v_cvt_pk_bf16_f32 v69, v70, v71
v_cvt_pk_bf16_f32 v70, v84, v85
M v[124:127], a[136:139], a[232:235], v[124:127]
v_exp_f32 v87, v87
M v[124:127], a[132:135], a[228:231], v[124:127]
buffer_load_dwordx4 v1, s[12:15], s32 offen offset:3072 sc1 lds
s_waitcnt lgkmcnt(4)
M v[128:131], a[148:151], a[180:183], 0
v_exp_f32 v72, v72
M v[128:131], a[152:155], a[184:187], v[128:131]
s_add_u32 s26, s26, 32768
s_cmp_eq_u32 s26, s62
s_cselect_b32 s26, s63, s26
s_cselect_b32 s62, -1, s62
M v[128:131], a[156:159], a[188:191], v[128:131]
v_exp_f32 v73, v73
M v[128:131], a[160:163], a[192:195], v[128:131]
v_cvt_pk_bf16_f32 v71, v86, v87
v_cvt_pk_bf16_f32 v72, v72, v73
M v[132:135], a[160:163], a[208:211], 0
v_exp_f32 v74, v74
M v[132:135], a[156:159], a[204:207], v[132:135]
M v[132:135], a[152:155], a[200:203], v[132:135]
v_exp_f32 v75, v75
M v[132:135], a[148:151], a[196:199], v[132:135]
v_cvt_pk_bf16_f32 v73, v74, v75
M v[136:139], a[148:151], a[212:215], 0
v_exp_f32 v88, v88
M v[136:139], a[152:155], a[216:219], v[136:139]
M v[136:139], a[156:159], a[220:223], v[136:139]
v_exp_f32 v89, v89
M v[136:139], a[160:163], a[224:227], v[136:139]
v_cvt_pk_bf16_f32 v74, v88, v89
M v[140:143], a[160:163], a[240:243], 0
v_exp_f32 v90, v90
M v[140:143], a[156:159], a[236:239], v[140:143]
s_waitcnt vmcnt(16) lgkmcnt(0)
s_barrier
ds_read_b128 a[116:119], v2 offset:32768
ds_read_b128 a[120:123], v2 offset:40960
ds_read_b128 a[124:127], v2 offset:33792
ds_read_b128 a[128:131], v2 offset:41984
M v[140:143], a[152:155], a[232:235], v[140:143]
v_exp_f32 v91, v91
M v[140:143], a[148:151], a[228:231], v[140:143]
v_cvt_pk_bf16_f32 v75, v90, v91
M v[144:147], a[164:167], a[180:183], 0
v_exp_f32 v76, v76
M v[144:147], a[168:171], a[184:187], v[144:147]
ds_read_b128 a[132:135], v2 offset:34816
ds_read_b128 a[136:139], v2 offset:43008
M v[144:147], a[172:175], a[188:191], v[144:147]
v_exp_f32 v77, v77
M v[144:147], a[176:179], a[192:195], v[144:147]
v_cvt_pk_bf16_f32 v76, v76, v77
M v[148:151], a[176:179], a[208:211], 0
v_exp_f32 v78, v78
M v[148:151], a[172:175], a[204:207], v[148:151]
M v[148:151], a[168:171], a[200:203], v[148:151]
v_exp_f32 v79, v79
M v[148:151], a[164:167], a[196:199], v[148:151]
v_cvt_pk_bf16_f32 v77, v78, v79
M v[152:155], a[164:167], a[212:215], 0
v_exp_f32 v92, v92
M v[152:155], a[168:171], a[216:219], v[152:155]
ds_read_b128 a[140:143], v2 offset:35840
ds_read_b128 a[144:147], v2 offset:44032
M v[152:155], a[172:175], a[220:223], v[152:155]
v_exp_f32 v93, v93
M v[152:155], a[176:179], a[224:227], v[152:155]
v_cvt_pk_bf16_f32 v78, v92, v93
M v[156:159], a[176:179], a[240:243], 0
v_exp_f32 v94, v94
M v[156:159], a[172:175], a[236:239], v[156:159]
M v[156:159], a[168:171], a[232:235], v[156:159]
v_exp_f32 v95, v95
M v[156:159], a[164:167], a[228:231], v[156:159]
v_cvt_pk_bf16_f32 v79, v94, v95
s_waitcnt lgkmcnt(6)
s_add_u32 m0, s29, 0
M v[160:163], a[116:119], v[32:35], 0
v_exp_f32 v96, v96
M v[160:163], a[120:123], v[64:67], v[160:163]
ds_read_b128 a[148:151], v2 offset:36864
ds_read_b128 a[152:155], v2 offset:45056
M v[164:167], a[120:123], v[68:71], 0
v_exp_f32 v97, v97
M v[164:167], a[116:119], v[36:39], v[164:167]
buffer_load_dwordx4 v1, s[12:15], s25 offen offset:0 sc1 lds
s_add_u32 s32, s25, 4096
M v[168:171], a[116:119], v[40:43], 0
v_exp_f32 v98, v98
M v[168:171], a[120:123], v[72:75], v[168:171]
v_cvt_pk_bf16_f32 v96, v96, v97
M v[172:175], a[120:123], v[76:79], 0
v_exp_f32 v99, v99
M v[172:175], a[116:119], v[44:47], v[172:175]
buffer_load_dwordx4 v1, s[12:15], s25 offen offset:1024 sc1 lds
s_waitcnt lgkmcnt(6)
M a[96:99], a[112:115], v[32:35], 0
M a[96:99], a[112:115], v[64:67], a[96:99]
M v[176:179], a[124:127], v[32:35], 0
v_exp_f32 v112, v112
M v[176:179], a[128:131], v[64:67], v[176:179]
ds_read_b128 a[156:159], v2 offset:37888
ds_read_b128 a[160:163], v2 offset:46080
M v[180:183], a[128:131], v[68:71], 0
v_exp_f32 v113, v113
M v[180:183], a[124:127], v[36:39], v[180:183]
buffer_load_dwordx4 v1, s[12:15], s25 offen offset:2048 sc1 lds
M v[184:187], a[124:127], v[40:43], 0
v_exp_f32 v114, v114
M v[184:187], a[128:131], v[72:75], v[184:187]
v_cvt_pk_bf16_f32 v97, v98, v99
v_cvt_pk_bf16_f32 v98, v112, v113
M v[188:191], a[128:131], v[76:79], 0
v_exp_f32 v115, v115
M v[188:191], a[124:127], v[44:47], v[188:191]
buffer_load_dwordx4 v1, s[12:15], s25 offen offset:3072 sc1 lds
s_add_u32 m0, s29, 4096
s_waitcnt lgkmcnt(6)
M a[100:103], a[112:115], v[36:39], 0
M a[100:103], a[112:115], v[68:71], a[100:103]
M v[192:195], a[132:135], v[32:35], 0
v_exp_f32 v100, v100
M v[192:195], a[136:139], v[64:67], v[192:195]
ds_read_b128 a[164:167], v2 offset:38912
ds_read_b128 a[168:171], v2 offset:47104
M v[196:199], a[136:139], v[68:71], 0
v_exp_f32 v101, v101
M v[196:199], a[132:135], v[36:39], v[196:199]
buffer_load_dwordx4 v1, s[12:15], s32 offen offset:0 sc1 lds
M v[200:203], a[132:135], v[40:43], 0
v_exp_f32 v102, v102
M v[200:203], a[136:139], v[72:75], v[200:203]
v_cvt_pk_bf16_f32 v99, v114, v115
v_cvt_pk_bf16_f32 v100, v100, v101
M v[204:207], a[136:139], v[76:79], 0
v_exp_f32 v103, v103
M v[204:207], a[132:135], v[44:47], v[204:207]
buffer_load_dwordx4 v1, s[12:15], s32 offen offset:1024 sc1 lds
s_waitcnt lgkmcnt(6)
M a[104:107], a[112:115], v[40:43], 0
M a[104:107], a[112:115], v[72:75], a[104:107]
M v[208:211], a[140:143], v[32:35], 0
v_exp_f32 v116, v116
M v[208:211], a[144:147], v[64:67], v[208:211]
ds_read_b128 a[172:175], v2 offset:39936
ds_read_b128 a[176:179], v2 offset:48128
M v[212:215], a[144:147], v[68:71], 0
v_exp_f32 v117, v117
M v[212:215], a[140:143], v[36:39], v[212:215]
buffer_load_dwordx4 v1, s[12:15], s32 offen offset:2048 sc1 lds
M v[216:219], a[140:143], v[40:43], 0
v_exp_f32 v118, v118
M v[216:219], a[144:147], v[72:75], v[216:219]
v_cvt_pk_bf16_f32 v101, v102, v103
v_cvt_pk_bf16_f32 v102, v116, v117
M v[220:223], a[144:147], v[76:79], 0
v_exp_f32 v119, v119
M v[220:223], a[140:143], v[44:47], v[220:223]
buffer_load_dwordx4 v1, s[12:15], s32 offen offset:3072 sc1 lds
s_waitcnt lgkmcnt(6)
M a[108:111], a[112:115], v[44:47], 0
M a[108:111], a[112:115], v[76:79], a[108:111]
M v[224:227], a[148:151], v[32:35], 0
v_exp_f32 v104, v104
M v[224:227], a[152:155], v[64:67], v[224:227]
s_add_u32 s25, s25, 32768
s_cmp_eq_u32 s25, s27
s_cselect_b32 s25, s28, s25
s_cselect_b32 s27, -1, s27
M v[228:231], a[152:155], v[68:71], 0
v_exp_f32 v105, v105
M v[228:231], a[148:151], v[36:39], v[228:231]
v_cvt_pk_bf16_f32 v103, v118, v119
v_cvt_pk_bf16_f32 v104, v104, v105
M v[232:235], a[148:151], v[40:43], 0
v_exp_f32 v106, v106
M v[232:235], a[152:155], v[72:75], v[232:235]
M v[236:239], a[152:155], v[76:79], 0
v_exp_f32 v107, v107
M v[236:239], a[148:151], v[44:47], v[236:239]
v_cvt_pk_bf16_f32 v105, v106, v107
s_waitcnt lgkmcnt(4)
M v[240:243], a[156:159], v[32:35], 0
v_exp_f32 v120, v120
M v[240:243], a[160:163], v[64:67], v[240:243]
M v[244:247], a[160:163], v[68:71], 0
v_exp_f32 v121, v121
M v[244:247], a[156:159], v[36:39], v[244:247]
v_cvt_pk_bf16_f32 v106, v120, v121
M v[248:251], a[156:159], v[40:43], 0
v_exp_f32 v122, v122
M v[248:251], a[160:163], v[72:75], v[248:251]
s_waitcnt vmcnt(16) lgkmcnt(0)
s_barrier
ds_read_b128 a[116:119], v3 offset:0
ds_read_b128 a[120:123], v3 offset:1024
ds_read_b128 a[124:127], v3 offset:2048
ds_read_b128 a[128:131], v3 offset:3072
M v[252:255], a[160:163], v[76:79], 0
v_exp_f32 v123, v123
M v[252:255], a[156:159], v[44:47], v[252:255]
v_cvt_pk_bf16_f32 v107, v122, v123
M a[64:67], a[164:167], v[32:35], 0
v_exp_f32 v108, v108
M a[64:67], a[168:171], v[64:67], a[64:67]
ds_read_b128 a[132:135], v3 offset:4096
ds_read_b128 a[136:139], v3 offset:5120
M a[68:71], a[168:171], v[68:71], 0
v_exp_f32 v109, v109
M a[68:71], a[164:167], v[36:39], a[68:71]
v_cvt_pk_bf16_f32 v108, v108, v109
M a[72:75], a[164:167], v[40:43], 0
v_exp_f32 v110, v110
M a[72:75], a[168:171], v[72:75], a[72:75]
M a[76:79], a[168:171], v[76:79], 0
v_exp_f32 v111, v111
M a[76:79], a[164:167], v[44:47], a[76:79]
v_cvt_pk_bf16_f32 v109, v110, v111
M a[80:83], a[172:175], v[32:35], 0
v_exp_f32 v124, v124
M a[80:83], a[176:179], v[64:67], a[80:83]
ds_read_b128 a[140:143], v3 offset:6144
ds_read_b128 a[144:147], v3 offset:7168
M a[84:87], a[176:179], v[68:71], 0
v_exp_f32 v125, v125
M a[84:87], a[172:175], v[36:39], a[84:87]
v_cvt_pk_bf16_f32 v110, v124, v125
M a[88:91], a[172:175], v[40:43], 0
v_exp_f32 v126, v126
M a[88:91], a[176:179], v[72:75], a[88:91]
M a[92:95], a[176:179], v[76:79], 0
v_exp_f32 v127, v127
M a[92:95], a[172:175], v[44:47], a[92:95]
v_cvt_pk_bf16_f32 v111, v126, v127
s_branch Lk2_l2b
Lk2_l2:
s_waitcnt lgkmcnt(4)
s_add_u32 m0, s29, 98304
M v[96:99], a[116:119], a[180:183], 0
v_exp_f32 v64, v64
M v[96:99], a[120:123], a[184:187], v[96:99]
ds_read_b128 a[148:151], v2 offset:8192
ds_read_b128 a[152:155], v2 offset:9216
M v[96:99], a[124:127], a[188:191], v[96:99]
v_exp_f32 v65, v65
M v[96:99], a[128:131], a[192:195], v[96:99]
buffer_load_dwordx4 v1, s[12:15], s26 offen offset:0 sc1 lds
s_add_u32 s32, s26, 4096
M v[100:103], a[128:131], a[208:211], 0
v_exp_f32 v66, v66
M v[100:103], a[124:127], a[204:207], v[100:103]
v_cvt_pk_bf16_f32 v64, v64, v65
M v[100:103], a[120:123], a[200:203], v[100:103]
v_exp_f32 v67, v67
M v[100:103], a[116:119], a[196:199], v[100:103]
buffer_load_dwordx4 v1, s[12:15], s26 offen offset:1024 sc1 lds
M v[104:107], a[116:119], a[212:215], 0
v_exp_f32 v80, v80
M v[104:107], a[120:123], a[216:219], v[104:107]
ds_read_b128 a[156:159], v2 offset:10240
ds_read_b128 a[160:163], v2 offset:11264
M v[104:107], a[124:127], a[220:223], v[104:107]
v_exp_f32 v81, v81
M v[104:107], a[128:131], a[224:227], v[104:107]
buffer_load_dwordx4 v1, s[12:15], s26 offen offset:2048 sc1 lds
M v[108:111], a[128:131], a[240:243], 0
v_exp_f32 v82, v82
M v[108:111], a[124:127], a[236:239], v[108:111]
v_cvt_pk_bf16_f32 v65, v66, v67
v_cvt_pk_bf16_f32 v66, v80, v81
M v[108:111], a[120:123], a[232:235], v[108:111]
v_exp_f32 v83, v83
M v[108:111], a[116:119], a[228:231], v[108:111]
buffer_load_dwordx4 v1, s[12:15], s26 offen offset:3072 sc1 lds
s_add_u32 m0, s29, 102400
s_waitcnt lgkmcnt(4)
M v[112:115], a[132:135], a[180:183], 0
v_exp_f32 v68, v68
M v[112:115], a[136:139], a[184:187], v[112:115]
ds_read_b128 a[164:167], v2 offset:12288
ds_read_b128 a[168:171], v2 offset:13312
M v[112:115], a[140:143], a[188:191], v[112:115]
v_exp_f32 v69, v69
M v[112:115], a[144:147], a[192:195], v[112:115]
buffer_load_dwordx4 v1, s[12:15], s32 offen offset:0 sc1 lds
M v[116:119], a[144:147], a[208:211], 0
v_exp_f32 v70, v70
M v[116:119], a[140:143], a[204:207], v[116:119]
v_cvt_pk_bf16_f32 v67, v82, v83
v_cvt_pk_bf16_f32 v68, v68, v69
M v[116:119], a[136:139], a[200:203], v[116:119]
v_exp_f32 v71, v71
M v[116:119], a[132:135], a[196:199], v[116:119]
buffer_load_dwordx4 v1, s[12:15], s32 offen offset:1024 sc1 lds
M v[120:123], a[132:135], a[212:215], 0
v_exp_f32 v84, v84
M v[120:123], a[136:139], a[216:219], v[120:123]
ds_read_b128 a[172:175], v2 offset:14336
ds_read_b128 a[176:179], v2 offset:15360
M v[120:123], a[140:143], a[220:223], v[120:123]
v_exp_f32 v85, v85
M v[120:123], a[144:147], a[224:227], v[120:123]
buffer_load_dwordx4 v1, s[12:15], s32 offen offset:2048 sc1 lds
M v[124:127], a[144:147], a[240:243], 0
v_exp_f32 v86, v86
M v[124:127], a[140:143], a[236:239], v[124:127]
v_cvt_pk_bf16_f32 v69, v70, v71
v_cvt_pk_bf16_f32 v70, v84, v85
M v[124:127], a[136:139], a[232:235], v[124:127]
v_exp_f32 v87, v87
M v[124:127], a[132:135], a[228:231], v[124:127]
buffer_load_dwordx4 v1, s[12:15], s32 offen offset:3072 sc1 lds
s_waitcnt lgkmcnt(4)
M v[128:131], a[148:151], a[180:183], 0
v_exp_f32 v72, v72
M v[128:131], a[152:155], a[184:187], v[128:131]
s_add_u32 s26, s26, 32768
s_cmp_eq_u32 s26, s62
s_cselect_b32 s26, s63, s26
s_cselect_b32 s62, -1, s62
M v[128:131], a[156:159], a[188:191], v[128:131]
v_exp_f32 v73, v73
M v[128:131], a[160:163], a[192:195], v[128:131]
v_cvt_pk_bf16_f32 v71, v86, v87
v_cvt_pk_bf16_f32 v72, v72, v73
M v[132:135], a[160:163], a[208:211], 0
v_exp_f32 v74, v74
M v[132:135], a[156:159], a[204:207], v[132:135]
M v[132:135], a[152:155], a[200:203], v[132:135]
v_exp_f32 v75, v75
M v[132:135], a[148:151], a[196:199], v[132:135]
v_cvt_pk_bf16_f32 v73, v74, v75
M v[136:139], a[148:151], a[212:215], 0
v_exp_f32 v88, v88
M v[136:139], a[152:155], a[216:219], v[136:139]
M v[136:139], a[156:159], a[220:223], v[136:139]
v_exp_f32 v89, v89
M v[136:139], a[160:163], a[224:227], v[136:139]
v_cvt_pk_bf16_f32 v74, v88, v89
M v[140:143], a[160:163], a[240:243], 0
v_exp_f32 v90, v90
M v[140:143], a[156:159], a[236:239], v[140:143]
s_waitcnt vmcnt(16) lgkmcnt(0)
s_barrier
ds_read_b128 a[116:119], v2 offset:32768
ds_read_b128 a[120:123], v2 offset:40960
ds_read_b128 a[124:127], v2 offset:33792
ds_read_b128 a[128:131], v2 offset:41984
M v[140:143], a[152:155], a[232:235], v[140:143]
v_exp_f32 v91, v91
M v[140:143], a[148:151], a[228:231], v[140:143]
v_cvt_pk_bf16_f32 v75, v90, v91
M v[144:147], a[164:167], a[180:183], 0
v_exp_f32 v76, v76
M v[144:147], a[168:171], a[184:187], v[144:147]
ds_read_b128 a[132:135], v2 offset:34816
ds_read_b128 a[136:139], v2 offset:43008
M v[144:147], a[172:175], a[188:191], v[144:147]
v_exp_f32 v77, v77
M v[144:147], a[176:179], a[192:195], v[144:147]
v_cvt_pk_bf16_f32 v76, v76, v77
M v[148:151], a[176:179], a[208:211], 0
v_exp_f32 v78, v78
M v[148:151], a[172:175], a[204:207], v[148:151]
M v[148:151], a[168:171], a[200:203], v[148:151]
v_exp_f32 v79, v79
M v[148:151], a[164:167], a[196:199], v[148:151]
v_cvt_pk_bf16_f32 v77, v78, v79
M v[152:155], a[164:167], a[212:215], 0
v_exp_f32 v92, v92
M v[152:155], a[168:171], a[216:219], v[152:155]
ds_read_b128 a[140:143], v2 offset:35840
ds_read_b128 a[144:147], v2 offset:44032
M v[152:155], a[172:175], a[220:223], v[152:155]
v_exp_f32 v93, v93
M v[152:155], a[176:179], a[224:227], v[152:155]
v_cvt_pk_bf16_f32 v78, v92, v93
M v[156:159], a[176:179], a[240:243], 0
v_exp_f32 v94, v94
M v[156:159], a[172:175], a[236:239], v[156:159]
M v[156:159], a[168:171], a[232:235], v[156:159]
v_exp_f32 v95, v95
M v[156:159], a[164:167], a[228:231], v[156:159]
v_cvt_pk_bf16_f32 v79, v94, v95
s_waitcnt lgkmcnt(6)
s_add_u32 m0, s29, 0
M v[160:163], a[116:119], v[32:35], v[160:163]
v_exp_f32 v96, v96
M v[160:163], a[120:123], v[64:67], v[160:163]
ds_read_b128 a[148:151], v2 offset:36864
ds_read_b128 a[152:155], v2 offset:45056
M v[164:167], a[120:123], v[68:71], v[164:167]
v_exp_f32 v97, v97
M v[164:167], a[116:119], v[36:39], v[164:167]
buffer_load_dwordx4 v1, s[12:15], s25 offen offset:0 sc1 lds
s_add_u32 s32, s25, 4096
M v[168:171], a[116:119], v[40:43], v[168:171]
v_exp_f32 v98, v98
M v[168:171], a[120:123], v[72:75], v[168:171]
v_cvt_pk_bf16_f32 v96, v96, v97
M v[172:175], a[120:123], v[76:79], v[172:175]
v_exp_f32 v99, v99
M v[172:175], a[116:119], v[44:47], v[172:175]
buffer_load_dwordx4 v1, s[12:15], s25 offen offset:1024 sc1 lds
s_waitcnt lgkmcnt(6)
M a[96:99], a[112:115], v[32:35], a[96:99]
M a[96:99], a[112:115], v[64:67], a[96:99]
M v[176:179], a[124:127], v[32:35], v[176:179]
v_exp_f32 v112, v112
M v[176:179], a[128:131], v[64:67], v[176:179]
ds_read_b128 a[156:159], v2 offset:37888
ds_read_b128 a[160:163], v2 offset:46080
M v[180:183], a[128:131], v[68:71], v[180:183]
v_exp_f32 v113, v113
M v[180:183], a[124:127], v[36:39], v[180:183]
buffer_load_dwordx4 v1, s[12:15], s25 offen offset:2048 sc1 lds
M v[184:187], a[124:127], v[40:43], v[184:187]
v_exp_f32 v114, v114
M v[184:187], a[128:131], v[72:75], v[184:187]
v_cvt_pk_bf16_f32 v97, v98, v99
v_cvt_pk_bf16_f32 v98, v112, v113
M v[188:191], a[128:131], v[76:79], v[188:191]
v_exp_f32 v115, v115
M v[188:191], a[124:127], v[44:47], v[188:191]
buffer_load_dwordx4 v1, s[12:15], s25 offen offset:3072 sc1 lds
s_add_u32 m0, s29, 4096
s_waitcnt lgkmcnt(6)
M a[100:103], a[112:115], v[36:39], a[100:103]
M a[100:103], a[112:115], v[68:71], a[100:103]
M v[192:195], a[132:135], v[32:35], v[192:195]
v_exp_f32 v100, v100
M v[192:195], a[136:139], v[64:67], v[192:195]
ds_read_b128 a[164:167], v2 offset:38912
ds_read_b128 a[168:171], v2 offset:47104
M v[196:199], a[136:139], v[68:71], v[196:199]
v_exp_f32 v101, v101
M v[196:199], a[132:135], v[36:39], v[196:199]
buffer_load_dwordx4 v1, s[12:15], s32 offen offset:0 sc1 lds
M v[200:203], a[132:135], v[40:43], v[200:203]
v_exp_f32 v102, v102
M v[200:203], a[136:139], v[72:75], v[200:203]
v_cvt_pk_bf16_f32 v99, v114, v115
v_cvt_pk_bf16_f32 v100, v100, v101
M v[204:207], a[136:139], v[76:79], v[204:207]
v_exp_f32 v103, v103
M v[204:207], a[132:135], v[44:47], v[204:207]
buffer_load_dwordx4 v1, s[12:15], s32 offen offset:1024 sc1 lds
s_waitcnt lgkmcnt(6)
M a[104:107], a[112:115], v[40:43], a[104:107]
M a[104:107], a[112:115], v[72:75], a[104:107]
M v[208:211], a[140:143], v[32:35], v[208:211]
v_exp_f32 v116, v116
M v[208:211], a[144:147], v[64:67], v[208:211]
ds_read_b128 a[172:175], v2 offset:39936
ds_read_b128 a[176:179], v2 offset:48128
M v[212:215], a[144:147], v[68:71], v[212:215]
v_exp_f32 v117, v117
M v[212:215], a[140:143], v[36:39], v[212:215]
buffer_load_dwordx4 v1, s[12:15], s32 offen offset:2048 sc1 lds
M v[216:219], a[140:143], v[40:43], v[216:219]
v_exp_f32 v118, v118
M v[216:219], a[144:147], v[72:75], v[216:219]
v_cvt_pk_bf16_f32 v101, v102, v103
v_cvt_pk_bf16_f32 v102, v116, v117
M v[220:223], a[144:147], v[76:79], v[220:223]
v_exp_f32 v119, v119
M v[220:223], a[140:143], v[44:47], v[220:223]
buffer_load_dwordx4 v1, s[12:15], s32 offen offset:3072 sc1 lds
s_waitcnt lgkmcnt(6)
M a[108:111], a[112:115], v[44:47], a[108:111]
M a[108:111], a[112:115], v[76:79], a[108:111]
M v[224:227], a[148:151], v[32:35], v[224:227]
v_exp_f32 v104, v104
M v[224:227], a[152:155], v[64:67], v[224:227]
s_add_u32 s25, s25, 32768
s_cmp_eq_u32 s25, s27
s_cselect_b32 s25, s28, s25
s_cselect_b32 s27, -1, s27
M v[228:231], a[152:155], v[68:71], v[228:231]
v_exp_f32 v105, v105
M v[228:231], a[148:151], v[36:39], v[228:231]
v_cvt_pk_bf16_f32 v103, v118, v119
v_cvt_pk_bf16_f32 v104, v104, v105
M v[232:235], a[148:151], v[40:43], v[232:235]
v_exp_f32 v106, v106
M v[232:235], a[152:155], v[72:75], v[232:235]
M v[236:239], a[152:155], v[76:79], v[236:239]
v_exp_f32 v107, v107
M v[236:239], a[148:151], v[44:47], v[236:239]
v_cvt_pk_bf16_f32 v105, v106, v107
s_waitcnt lgkmcnt(4)
M v[240:243], a[156:159], v[32:35], v[240:243]
v_exp_f32 v120, v120
M v[240:243], a[160:163], v[64:67], v[240:243]
M v[244:247], a[160:163], v[68:71], v[244:247]
v_exp_f32 v121, v121
M v[244:247], a[156:159], v[36:39], v[244:247]
v_cvt_pk_bf16_f32 v106, v120, v121
M v[248:251], a[156:159], v[40:43], v[248:251]
v_exp_f32 v122, v122
M v[248:251], a[160:163], v[72:75], v[248:251]
s_waitcnt vmcnt(16) lgkmcnt(0)
s_barrier
ds_read_b128 a[116:119], v3 offset:0
ds_read_b128 a[120:123], v3 offset:1024
ds_read_b128 a[124:127], v3 offset:2048
ds_read_b128 a[128:131], v3 offset:3072
M v[252:255], a[160:163], v[76:79], v[252:255]
v_exp_f32 v123, v123
M v[252:255], a[156:159], v[44:47], v[252:255]
v_cvt_pk_bf16_f32 v107, v122, v123
M a[64:67], a[164:167], v[32:35], a[64:67]
v_exp_f32 v108, v108
M a[64:67], a[168:171], v[64:67], a[64:67]
ds_read_b128 a[132:135], v3 offset:4096
ds_read_b128 a[136:139], v3 offset:5120
M a[68:71], a[168:171], v[68:71], a[68:71]
v_exp_f32 v109, v109
M a[68:71], a[164:167], v[36:39], a[68:71]
v_cvt_pk_bf16_f32 v108, v108, v109
M a[72:75], a[164:167], v[40:43], a[72:75]
v_exp_f32 v110, v110
M a[72:75], a[168:171], v[72:75], a[72:75]
M a[76:79], a[168:171], v[76:79], a[76:79]
v_exp_f32 v111, v111
M a[76:79], a[164:167], v[44:47], a[76:79]
v_cvt_pk_bf16_f32 v109, v110, v111
M a[80:83], a[172:175], v[32:35], a[80:83]
v_exp_f32 v124, v124
M a[80:83], a[176:179], v[64:67], a[80:83]
ds_read_b128 a[140:143], v3 offset:6144
ds_read_b128 a[144:147], v3 offset:7168
M a[84:87], a[176:179], v[68:71], a[84:87]
v_exp_f32 v125, v125
M a[84:87], a[172:175], v[36:39], a[84:87]
v_cvt_pk_bf16_f32 v110, v124, v125
M a[88:91], a[172:175], v[40:43], a[88:91]
v_exp_f32 v126, v126
M a[88:91], a[176:179], v[72:75], a[88:91]
M a[92:95], a[176:179], v[76:79], a[92:95]
v_exp_f32 v127, v127
M a[92:95], a[172:175], v[44:47], a[92:95]
v_cvt_pk_bf16_f32 v111, v126, v127
Lk2_l2b:
s_waitcnt lgkmcnt(4)
s_add_u32 m0, s29, 32768
M v[32:35], a[116:119], a[180:183], 0
v_exp_f32 v128, v128
M v[32:35], a[120:123], a[184:187], v[32:35]
ds_read_b128 a[148:151], v3 offset:8192
ds_read_b128 a[152:155], v3 offset:9216
M v[32:35], a[124:127], a[188:191], v[32:35]
v_exp_f32 v129, v129
M v[32:35], a[128:131], a[192:195], v[32:35]
buffer_load_dwordx4 v1, s[12:15], s26 offen offset:0 sc1 lds
s_add_u32 s32, s26, 4096
M v[36:39], a[128:131], a[208:211], 0
v_exp_f32 v130, v130
M v[36:39], a[124:127], a[204:207], v[36:39]
v_cvt_pk_bf16_f32 v128, v128, v129
M v[36:39], a[120:123], a[200:203], v[36:39]
v_exp_f32 v131, v131
M v[36:39], a[116:119], a[196:199], v[36:39]
buffer_load_dwordx4 v1, s[12:15], s26 offen offset:1024 sc1 lds
M v[40:43], a[116:119], a[212:215], 0
v_exp_f32 v144, v144
M v[40:43], a[120:123], a[216:219], v[40:43]
ds_read_b128 a[156:159], v3 offset:10240
ds_read_b128 a[160:163], v3 offset:11264
M v[40:43], a[124:127], a[220:223], v[40:43]
v_exp_f32 v145, v145
M v[40:43], a[128:131], a[224:227], v[40:43]
buffer_load_dwordx4 v1, s[12:15], s26 offen offset:2048 sc1 lds
M v[44:47], a[128:131], a[240:243], 0
v_exp_f32 v146, v146
M v[44:47], a[124:127], a[236:239], v[44:47]
v_cvt_pk_bf16_f32 v129, v130, v131
v_cvt_pk_bf16_f32 v130, v144, v145
M v[44:47], a[120:123], a[232:235], v[44:47]
v_exp_f32 v147, v147
M v[44:47], a[116:119], a[228:231], v[44:47]
buffer_load_dwordx4 v1, s[12:15], s26 offen offset:3072 sc1 lds
s_add_u32 m0, s29, 36864
s_waitcnt lgkmcnt(4)
M v[48:51], a[132:135], a[180:183], 0
v_exp_f32 v132, v132
M v[48:51], a[136:139], a[184:187], v[48:51]
ds_read_b128 a[164:167], v3 offset:12288
ds_read_b128 a[168:171], v3 offset:13312
M v[48:51], a[140:143], a[188:191], v[48:51]
v_exp_f32 v133, v133
M v[48:51], a[144:147], a[192:195], v[48:51]
buffer_load_dwordx4 v1, s[12:15], s32 offen offset:0 sc1 lds
M v[52:55], a[144:147], a[208:211], 0
v_exp_f32 v134, v134
M v[52:55], a[140:143], a[204:207], v[52:55]
v_cvt_pk_bf16_f32 v131, v146, v147
v_cvt_pk_bf16_f32 v132, v132, v133
M v[52:55], a[136:139], a[200:203], v[52:55]
v_exp_f32 v135, v135
M v[52:55], a[132:135], a[196:199], v[52:55]
buffer_load_dwordx4 v1, s[12:15], s32 offen offset:1024 sc1 lds
M v[56:59], a[132:135], a[212:215], 0
v_exp_f32 v148, v148
M v[56:59], a[136:139], a[216:219], v[56:59]
ds_read_b128 a[172:175], v3 offset:14336
ds_read_b128 a[176:179], v3 offset:15360
M v[56:59], a[140:143], a[220:223], v[56:59]
v_exp_f32 v149, v149
M v[56:59], a[144:147], a[224:227], v[56:59]
buffer_load_dwordx4 v1, s[12:15], s32 offen offset:2048 sc1 lds
M v[60:63], a[144:147], a[240:243], 0
v_exp_f32 v150, v150
M v[60:63], a[140:143], a[236:239], v[60:63]
v_cvt_pk_bf16_f32 v133, v134, v135
v_cvt_pk_bf16_f32 v134, v148, v149
M v[60:63], a[136:139], a[232:235], v[60:63]
v_exp_f32 v151, v151
M v[60:63], a[132:135], a[228:231], v[60:63]
buffer_load_dwordx4 v1, s[12:15], s32 offen offset:3072 sc1 lds
s_waitcnt lgkmcnt(4)
M v[64:67], a[148:151], a[180:183], 0
v_exp_f32 v136, v136
M v[64:67], a[152:155], a[184:187], v[64:67]
s_add_u32 s26, s26, 32768
s_cmp_eq_u32 s26, s62
s_cselect_b32 s26, s63, s26
s_cselect_b32 s62, -1, s62
M v[64:67], a[156:159], a[188:191], v[64:67]
v_exp_f32 v137, v137
M v[64:67], a[160:163], a[192:195], v[64:67]
v_cvt_pk_bf16_f32 v135, v150, v151
v_cvt_pk_bf16_f32 v136, v136, v137
M v[68:71], a[160:163], a[208:211], 0
v_exp_f32 v138, v138
M v[68:71], a[156:159], a[204:207], v[68:71]
M v[68:71], a[152:155], a[200:203], v[68:71]
v_exp_f32 v139, v139
M v[68:71], a[148:151], a[196:199], v[68:71]
v_cvt_pk_bf16_f32 v137, v138, v139
M v[72:75], a[148:151], a[212:215], 0
v_exp_f32 v152, v152
M v[72:75], a[152:155], a[216:219], v[72:75]
M v[72:75], a[156:159], a[220:223], v[72:75]
v_exp_f32 v153, v153
M v[72:75], a[160:163], a[224:227], v[72:75]
v_cvt_pk_bf16_f32 v138, v152, v153
M v[76:79], a[160:163], a[240:243], 0
v_exp_f32 v154, v154
M v[76:79], a[156:159], a[236:239], v[76:79]
s_waitcnt vmcnt(16) lgkmcnt(0)
s_barrier
ds_read_b128 a[116:119], v3 offset:32768
ds_read_b128 a[120:123], v3 offset:40960
ds_read_b128 a[124:127], v3 offset:33792
ds_read_b128 a[128:131], v3 offset:41984
M v[76:79], a[152:155], a[232:235], v[76:79]
v_exp_f32 v155, v155
M v[76:79], a[148:151], a[228:231], v[76:79]
v_cvt_pk_bf16_f32 v139, v154, v155
M v[80:83], a[164:167], a[180:183], 0
v_exp_f32 v140, v140
M v[80:83], a[168:171], a[184:187], v[80:83]
ds_read_b128 a[132:135], v3 offset:34816
ds_read_b128 a[136:139], v3 offset:43008
M v[80:83], a[172:175], a[188:191], v[80:83]
v_exp_f32 v141, v141
M v[80:83], a[176:179], a[192:195], v[80:83]
v_cvt_pk_bf16_f32 v140, v140, v141
M v[84:87], a[176:179], a[208:211], 0
v_exp_f32 v142, v142
M v[84:87], a[172:175], a[204:207], v[84:87]
M v[84:87], a[168:171], a[200:203], v[84:87]
v_exp_f32 v143, v143
M v[84:87], a[164:167], a[196:199], v[84:87]
v_cvt_pk_bf16_f32 v141, v142, v143
M v[88:91], a[164:167], a[212:215], 0
v_exp_f32 v156, v156
M v[88:91], a[168:171], a[216:219], v[88:91]
ds_read_b128 a[140:143], v3 offset:35840
ds_read_b128 a[144:147], v3 offset:44032
M v[88:91], a[172:175], a[220:223], v[88:91]
v_exp_f32 v157, v157
M v[88:91], a[176:179], a[224:227], v[88:91]
v_cvt_pk_bf16_f32 v142, v156, v157
M v[92:95], a[176:179], a[240:243], 0
v_exp_f32 v158, v158
M v[92:95], a[172:175], a[236:239], v[92:95]
M v[92:95], a[168:171], a[232:235], v[92:95]
v_exp_f32 v159, v159
M v[92:95], a[164:167], a[228:231], v[92:95]
v_cvt_pk_bf16_f32 v143, v158, v159
s_waitcnt lgkmcnt(6)
s_add_u32 m0, s29, 65536
M v[160:163], a[116:119], v[96:99], v[160:163]
v_exp_f32 v32, v32
M v[160:163], a[120:123], v[128:131], v[160:163]
ds_read_b128 a[148:151], v3 offset:36864
ds_read_b128 a[152:155], v3 offset:45056
M v[164:167], a[120:123], v[132:135], v[164:167]
v_exp_f32 v33, v33
M v[164:167], a[116:119], v[100:103], v[164:167]
buffer_load_dwordx4 v1, s[12:15], s25 offen offset:0 sc1 lds
s_add_u32 s32, s25, 4096
M v[168:171], a[116:119], v[104:107], v[168:171]
v_exp_f32 v34, v34
M v[168:171], a[120:123], v[136:139], v[168:171]
v_cvt_pk_bf16_f32 v32, v32, v33
M v[172:175], a[120:123], v[140:143], v[172:175]
v_exp_f32 v35, v35
M v[172:175], a[116:119], v[108:111], v[172:175]
buffer_load_dwordx4 v1, s[12:15], s25 offen offset:1024 sc1 lds
s_waitcnt lgkmcnt(6)
M a[96:99], a[112:115], v[96:99], a[96:99]
M a[96:99], a[112:115], v[128:131], a[96:99]
M v[176:179], a[124:127], v[96:99], v[176:179]
v_exp_f32 v48, v48
M v[176:179], a[128:131], v[128:131], v[176:179]
ds_read_b128 a[156:159], v3 offset:37888
ds_read_b128 a[160:163], v3 offset:46080
M v[180:183], a[128:131], v[132:135], v[180:183]
v_exp_f32 v49, v49
M v[180:183], a[124:127], v[100:103], v[180:183]
buffer_load_dwordx4 v1, s[12:15], s25 offen offset:2048 sc1 lds
M v[184:187], a[124:127], v[104:107], v[184:187]
v_exp_f32 v50, v50
M v[184:187], a[128:131], v[136:139], v[184:187]
v_cvt_pk_bf16_f32 v33, v34, v35
v_cvt_pk_bf16_f32 v34, v48, v49
M v[188:191], a[128:131], v[140:143], v[188:191]
v_exp_f32 v51, v51
M v[188:191], a[124:127], v[108:111], v[188:191]
buffer_load_dwordx4 v1, s[12:15], s25 offen offset:3072 sc1 lds
s_add_u32 m0, s29, 69632
s_waitcnt lgkmcnt(6)
M a[100:103], a[112:115], v[100:103], a[100:103]
M a[100:103], a[112:115], v[132:135], a[100:103]
M v[192:195], a[132:135], v[96:99], v[192:195]
v_exp_f32 v36, v36
M v[192:195], a[136:139], v[128:131], v[192:195]
ds_read_b128 a[164:167], v3 offset:38912
ds_read_b128 a[168:171], v3 offset:47104
M v[196:199], a[136:139], v[132:135], v[196:199]
v_exp_f32 v37, v37
M v[196:199], a[132:135], v[100:103], v[196:199]
buffer_load_dwordx4 v1, s[12:15], s32 offen offset:0 sc1 lds
M v[200:203], a[132:135], v[104:107], v[200:203]
v_exp_f32 v38, v38
M v[200:203], a[136:139], v[136:139], v[200:203]
v_cvt_pk_bf16_f32 v35, v50, v51
v_cvt_pk_bf16_f32 v36, v36, v37
M v[204:207], a[136:139], v[140:143], v[204:207]
v_exp_f32 v39, v39
M v[204:207], a[132:135], v[108:111], v[204:207]
buffer_load_dwordx4 v1, s[12:15], s32 offen offset:1024 sc1 lds
s_waitcnt lgkmcnt(6)
M a[104:107], a[112:115], v[104:107], a[104:107]
M a[104:107], a[112:115], v[136:139], a[104:107]
M v[208:211], a[140:143], v[96:99], v[208:211]
v_exp_f32 v52, v52
M v[208:211], a[144:147], v[128:131], v[208:211]
ds_read_b128 a[172:175], v3 offset:39936
ds_read_b128 a[176:179], v3 offset:48128
M v[212:215], a[144:147], v[132:135], v[212:215]
v_exp_f32 v53, v53
M v[212:215], a[140:143], v[100:103], v[212:215]
buffer_load_dwordx4 v1, s[12:15], s32 offen offset:2048 sc1 lds
M v[216:219], a[140:143], v[104:107], v[216:219]
v_exp_f32 v54, v54
M v[216:219], a[144:147], v[136:139], v[216:219]
v_cvt_pk_bf16_f32 v37, v38, v39
v_cvt_pk_bf16_f32 v38, v52, v53
M v[220:223], a[144:147], v[140:143], v[220:223]
v_exp_f32 v55, v55
M v[220:223], a[140:143], v[108:111], v[220:223]
buffer_load_dwordx4 v1, s[12:15], s32 offen offset:3072 sc1 lds
s_waitcnt lgkmcnt(6)
M a[108:111], a[112:115], v[108:111], a[108:111]
M a[108:111], a[112:115], v[140:143], a[108:111]
M v[224:227], a[148:151], v[96:99], v[224:227]
v_exp_f32 v40, v40
M v[224:227], a[152:155], v[128:131], v[224:227]
s_add_u32 s25, s25, 32768
s_cmp_eq_u32 s25, s27
s_cselect_b32 s25, s28, s25
s_cselect_b32 s27, -1, s27
M v[228:231], a[152:155], v[132:135], v[228:231]
v_exp_f32 v41, v41
M v[228:231], a[148:151], v[100:103], v[228:231]
v_cvt_pk_bf16_f32 v39, v54, v55
v_cvt_pk_bf16_f32 v40, v40, v41
M v[232:235], a[148:151], v[104:107], v[232:235]
v_exp_f32 v42, v42
M v[232:235], a[152:155], v[136:139], v[232:235]
M v[236:239], a[152:155], v[140:143], v[236:239]
v_exp_f32 v43, v43
M v[236:239], a[148:151], v[108:111], v[236:239]
v_cvt_pk_bf16_f32 v41, v42, v43
s_waitcnt lgkmcnt(4)
M v[240:243], a[156:159], v[96:99], v[240:243]
v_exp_f32 v56, v56
M v[240:243], a[160:163], v[128:131], v[240:243]
M v[244:247], a[160:163], v[132:135], v[244:247]
v_exp_f32 v57, v57
M v[244:247], a[156:159], v[100:103], v[244:247]
v_cvt_pk_bf16_f32 v42, v56, v57
M v[248:251], a[156:159], v[104:107], v[248:251]
v_exp_f32 v58, v58
M v[248:251], a[160:163], v[136:139], v[248:251]
s_waitcnt vmcnt(16) lgkmcnt(0)
s_barrier
ds_read_b128 a[116:119], v2 offset:0
ds_read_b128 a[120:123], v2 offset:1024
ds_read_b128 a[124:127], v2 offset:2048
ds_read_b128 a[128:131], v2 offset:3072
M v[252:255], a[160:163], v[140:143], v[252:255]
v_exp_f32 v59, v59
M v[252:255], a[156:159], v[108:111], v[252:255]
v_cvt_pk_bf16_f32 v43, v58, v59
M a[64:67], a[164:167], v[96:99], a[64:67]
v_exp_f32 v44, v44
M a[64:67], a[168:171], v[128:131], a[64:67]
ds_read_b128 a[132:135], v2 offset:4096
ds_read_b128 a[136:139], v2 offset:5120
M a[68:71], a[168:171], v[132:135], a[68:71]
v_exp_f32 v45, v45
M a[68:71], a[164:167], v[100:103], a[68:71]
v_cvt_pk_bf16_f32 v44, v44, v45
M a[72:75], a[164:167], v[104:107], a[72:75]
v_exp_f32 v46, v46
M a[72:75], a[168:171], v[136:139], a[72:75]
M a[76:79], a[168:171], v[140:143], a[76:79]
v_exp_f32 v47, v47
M a[76:79], a[164:167], v[108:111], a[76:79]
v_cvt_pk_bf16_f32 v45, v46, v47
M a[80:83], a[172:175], v[96:99], a[80:83]
v_exp_f32 v60, v60
M a[80:83], a[176:179], v[128:131], a[80:83]
ds_read_b128 a[140:143], v2 offset:6144
ds_read_b128 a[144:147], v2 offset:7168
M a[84:87], a[176:179], v[132:135], a[84:87]
v_exp_f32 v61, v61
M a[84:87], a[172:175], v[100:103], a[84:87]
v_cvt_pk_bf16_f32 v46, v60, v61
M a[88:91], a[172:175], v[104:107], a[88:91]
v_exp_f32 v62, v62
M a[88:91], a[176:179], v[136:139], a[88:91]
M a[92:95], a[176:179], v[140:143], a[92:95]
v_exp_f32 v63, v63
M a[92:95], a[172:175], v[108:111], a[92:95]
v_cvt_pk_bf16_f32 v47, v62, v63
s_sub_u32 s30, s30, 1
s_cmp_lg_u32 s30, 0
s_cbranch_scc1 Lk2_l2
s_branch Lk2_fin
Lk2_g1:
s_mov_b32 s30, 7
Lk2_l3:
s_waitcnt lgkmcnt(4)
s_add_u32 m0, s29, 98304
M v[96:99], a[116:119], a[0:3], 0
v_exp_f32 v64, v64
M v[96:99], a[120:123], a[4:7], v[96:99]
ds_read_b128 a[148:151], v2 offset:8192
ds_read_b128 a[152:155], v2 offset:9216
M v[96:99], a[124:127], a[8:11], v[96:99]
v_exp_f32 v65, v65
M v[96:99], a[128:131], a[12:15], v[96:99]
buffer_load_dwordx4 v1, s[12:15], s26 offen offset:0 sc1 lds
s_add_u32 s32, s26, 4096
M v[100:103], a[128:131], a[28:31], 0
v_exp_f32 v66, v66
M v[100:103], a[124:127], a[24:27], v[100:103]
v_cvt_pk_bf16_f32 v64, v64, v65
M v[100:103], a[120:123], a[20:23], v[100:103]
v_exp_f32 v67, v67
M v[100:103], a[116:119], a[16:19], v[100:103]
buffer_load_dwordx4 v1, s[12:15], s26 offen offset:1024 sc1 lds
M v[104:107], a[116:119], a[32:35], 0
v_exp_f32 v80, v80
M v[104:107], a[120:123], a[36:39], v[104:107]
ds_read_b128 a[156:159], v2 offset:10240
ds_read_b128 a[160:163], v2 offset:11264
M v[104:107], a[124:127], a[40:43], v[104:107]
v_exp_f32 v81, v81
M v[104:107], a[128:131], a[44:47], v[104:107]
buffer_load_dwordx4 v1, s[12:15], s26 offen offset:2048 sc1 lds
M v[108:111], a[128:131], a[60:63], 0
v_exp_f32 v82, v82
M v[108:111], a[124:127], a[56:59], v[108:111]
v_cvt_pk_bf16_f32 v65, v66, v67
v_cvt_pk_bf16_f32 v66, v80, v81
M v[108:111], a[120:123], a[52:55], v[108:111]
v_exp_f32 v83, v83
M v[108:111], a[116:119], a[48:51], v[108:111]
buffer_load_dwordx4 v1, s[12:15], s26 offen offset:3072 sc1 lds
s_add_u32 m0, s29, 102400
s_waitcnt lgkmcnt(4)
M v[112:115], a[132:135], a[0:3], 0
v_exp_f32 v68, v68
M v[112:115], a[136:139], a[4:7], v[112:115]
ds_read_b128 a[164:167], v2 offset:12288
ds_read_b128 a[168:171], v2 offset:13312
M v[112:115], a[140:143], a[8:11], v[112:115]
v_exp_f32 v69, v69
M v[112:115], a[144:147], a[12:15], v[112:115]
buffer_load_dwordx4 v1, s[12:15], s32 offen offset:0 sc1 lds
M v[116:119], a[144:147], a[28:31], 0
v_exp_f32 v70, v70
M v[116:119], a[140:143], a[24:27], v[116:119]
v_cvt_pk_bf16_f32 v67, v82, v83
v_cvt_pk_bf16_f32 v68, v68, v69
M v[116:119], a[136:139], a[20:23], v[116:119]
v_exp_f32 v71, v71
M v[116:119], a[132:135], a[16:19], v[116:119]
buffer_load_dwordx4 v1, s[12:15], s32 offen offset:1024 sc1 lds
M v[120:123], a[132:135], a[32:35], 0
v_exp_f32 v84, v84
M v[120:123], a[136:139], a[36:39], v[120:123]
ds_read_b128 a[172:175], v2 offset:14336
ds_read_b128 a[176:179], v2 offset:15360
M v[120:123], a[140:143], a[40:43], v[120:123]
v_exp_f32 v85, v85
M v[120:123], a[144:147], a[44:47], v[120:123]
buffer_load_dwordx4 v1, s[12:15], s32 offen offset:2048 sc1 lds
M v[124:127], a[144:147], a[60:63], 0
v_exp_f32 v86, v86
M v[124:127], a[140:143], a[56:59], v[124:127]
v_cvt_pk_bf16_f32 v69, v70, v71
v_cvt_pk_bf16_f32 v70, v84, v85
M v[124:127], a[136:139], a[52:55], v[124:127]
v_exp_f32 v87, v87
M v[124:127], a[132:135], a[48:51], v[124:127]
buffer_load_dwordx4 v1, s[12:15], s32 offen offset:3072 sc1 lds
s_waitcnt lgkmcnt(4)
M v[128:131], a[148:151], a[0:3], 0
v_exp_f32 v72, v72
M v[128:131], a[152:155], a[4:7], v[128:131]
s_add_u32 s26, s26, 32768
s_cmp_eq_u32 s26, s62
s_cselect_b32 s26, s63, s26
s_cselect_b32 s62, -1, s62
M v[128:131], a[156:159], a[8:11], v[128:131]
v_exp_f32 v73, v73
M v[128:131], a[160:163], a[12:15], v[128:131]
v_cvt_pk_bf16_f32 v71, v86, v87
v_cvt_pk_bf16_f32 v72, v72, v73
M v[132:135], a[160:163], a[28:31], 0
v_exp_f32 v74, v74
M v[132:135], a[156:159], a[24:27], v[132:135]
M v[132:135], a[152:155], a[20:23], v[132:135]
v_exp_f32 v75, v75
M v[132:135], a[148:151], a[16:19], v[132:135]
v_cvt_pk_bf16_f32 v73, v74, v75
M v[136:139], a[148:151], a[32:35], 0
v_exp_f32 v88, v88
M v[136:139], a[152:155], a[36:39], v[136:139]
M v[136:139], a[156:159], a[40:43], v[136:139]
v_exp_f32 v89, v89
M v[136:139], a[160:163], a[44:47], v[136:139]
v_cvt_pk_bf16_f32 v74, v88, v89
M v[140:143], a[160:163], a[60:63], 0
v_exp_f32 v90, v90
M v[140:143], a[156:159], a[56:59], v[140:143]
s_waitcnt vmcnt(16) lgkmcnt(0)
s_barrier
ds_read_b128 a[116:119], v2 offset:32768
ds_read_b128 a[120:123], v2 offset:40960
ds_read_b128 a[124:127], v2 offset:33792
ds_read_b128 a[128:131], v2 offset:41984
M v[140:143], a[152:155], a[52:55], v[140:143]
v_exp_f32 v91, v91
M v[140:143], a[148:151], a[48:51], v[140:143]
v_cvt_pk_bf16_f32 v75, v90, v91
M v[144:147], a[164:167], a[0:3], 0
v_exp_f32 v76, v76
M v[144:147], a[168:171], a[4:7], v[144:147]
ds_read_b128 a[132:135], v2 offset:34816
ds_read_b128 a[136:139], v2 offset:43008
M v[144:147], a[172:175], a[8:11], v[144:147]
v_exp_f32 v77, v77
M v[144:147], a[176:179], a[12:15], v[144:147]
v_cvt_pk_bf16_f32 v76, v76, v77
M v[148:151], a[176:179], a[28:31], 0
v_exp_f32 v78, v78
M v[148:151], a[172:175], a[24:27], v[148:151]
M v[148:151], a[168:171], a[20:23], v[148:151]
v_exp_f32 v79, v79
M v[148:151], a[164:167], a[16:19], v[148:151]
v_cvt_pk_bf16_f32 v77, v78, v79
M v[152:155], a[164:167], a[32:35], 0
v_exp_f32 v92, v92
M v[152:155], a[168:171], a[36:39], v[152:155]
ds_read_b128 a[140:143], v2 offset:35840
ds_read_b128 a[144:147], v2 offset:44032
M v[152:155], a[172:175], a[40:43], v[152:155]
v_exp_f32 v93, v93
M v[152:155], a[176:179], a[44:47], v[152:155]
v_cvt_pk_bf16_f32 v78, v92, v93
M v[156:159], a[176:179], a[60:63], 0
v_exp_f32 v94, v94
M v[156:159], a[172:175], a[56:59], v[156:159]
M v[156:159], a[168:171], a[52:55], v[156:159]
v_exp_f32 v95, v95
M v[156:159], a[164:167], a[48:51], v[156:159]
v_cvt_pk_bf16_f32 v79, v94, v95
s_waitcnt lgkmcnt(6)
s_add_u32 m0, s29, 0
M v[160:163], a[116:119], v[32:35], v[160:163]
v_exp_f32 v96, v96
M v[160:163], a[120:123], v[64:67], v[160:163]
ds_read_b128 a[148:151], v2 offset:36864
ds_read_b128 a[152:155], v2 offset:45056
M v[164:167], a[120:123], v[68:71], v[164:167]
v_exp_f32 v97, v97
M v[164:167], a[116:119], v[36:39], v[164:167]
buffer_load_dwordx4 v1, s[12:15], s25 offen offset:0 sc1 lds
s_add_u32 s32, s25, 4096
M v[168:171], a[116:119], v[40:43], v[168:171]
v_exp_f32 v98, v98
M v[168:171], a[120:123], v[72:75], v[168:171]
v_cvt_pk_bf16_f32 v96, v96, v97
M v[172:175], a[120:123], v[76:79], v[172:175]
v_exp_f32 v99, v99
M v[172:175], a[116:119], v[44:47], v[172:175]
buffer_load_dwordx4 v1, s[12:15], s25 offen offset:1024 sc1 lds
s_waitcnt lgkmcnt(6)
M a[96:99], a[112:115], v[32:35], a[96:99]
M a[96:99], a[112:115], v[64:67], a[96:99]
M v[176:179], a[124:127], v[32:35], v[176:179]
v_exp_f32 v112, v112
M v[176:179], a[128:131], v[64:67], v[176:179]
ds_read_b128 a[156:159], v2 offset:37888
ds_read_b128 a[160:163], v2 offset:46080
M v[180:183], a[128:131], v[68:71], v[180:183]
v_exp_f32 v113, v113
M v[180:183], a[124:127], v[36:39], v[180:183]
buffer_load_dwordx4 v1, s[12:15], s25 offen offset:2048 sc1 lds
M v[184:187], a[124:127], v[40:43], v[184:187]
v_exp_f32 v114, v114
M v[184:187], a[128:131], v[72:75], v[184:187]
v_cvt_pk_bf16_f32 v97, v98, v99
v_cvt_pk_bf16_f32 v98, v112, v113
M v[188:191], a[128:131], v[76:79], v[188:191]
v_exp_f32 v115, v115
M v[188:191], a[124:127], v[44:47], v[188:191]
buffer_load_dwordx4 v1, s[12:15], s25 offen offset:3072 sc1 lds
s_add_u32 m0, s29, 4096
s_waitcnt lgkmcnt(6)
M a[100:103], a[112:115], v[36:39], a[100:103]
M a[100:103], a[112:115], v[68:71], a[100:103]
M v[192:195], a[132:135], v[32:35], v[192:195]
v_exp_f32 v100, v100
M v[192:195], a[136:139], v[64:67], v[192:195]
ds_read_b128 a[164:167], v2 offset:38912
ds_read_b128 a[168:171], v2 offset:47104
M v[196:199], a[136:139], v[68:71], v[196:199]
v_exp_f32 v101, v101
M v[196:199], a[132:135], v[36:39], v[196:199]
buffer_load_dwordx4 v1, s[12:15], s32 offen offset:0 sc1 lds
M v[200:203], a[132:135], v[40:43], v[200:203]
v_exp_f32 v102, v102
M v[200:203], a[136:139], v[72:75], v[200:203]
v_cvt_pk_bf16_f32 v99, v114, v115
v_cvt_pk_bf16_f32 v100, v100, v101
M v[204:207], a[136:139], v[76:79], v[204:207]
v_exp_f32 v103, v103
M v[204:207], a[132:135], v[44:47], v[204:207]
buffer_load_dwordx4 v1, s[12:15], s32 offen offset:1024 sc1 lds
s_waitcnt lgkmcnt(6)
M a[104:107], a[112:115], v[40:43], a[104:107]
M a[104:107], a[112:115], v[72:75], a[104:107]
M v[208:211], a[140:143], v[32:35], v[208:211]
v_exp_f32 v116, v116
M v[208:211], a[144:147], v[64:67], v[208:211]
ds_read_b128 a[172:175], v2 offset:39936
ds_read_b128 a[176:179], v2 offset:48128
M v[212:215], a[144:147], v[68:71], v[212:215]
v_exp_f32 v117, v117
M v[212:215], a[140:143], v[36:39], v[212:215]
buffer_load_dwordx4 v1, s[12:15], s32 offen offset:2048 sc1 lds
M v[216:219], a[140:143], v[40:43], v[216:219]
v_exp_f32 v118, v118
M v[216:219], a[144:147], v[72:75], v[216:219]
v_cvt_pk_bf16_f32 v101, v102, v103
v_cvt_pk_bf16_f32 v102, v116, v117
M v[220:223], a[144:147], v[76:79], v[220:223]
v_exp_f32 v119, v119
M v[220:223], a[140:143], v[44:47], v[220:223]
buffer_load_dwordx4 v1, s[12:15], s32 offen offset:3072 sc1 lds
s_waitcnt lgkmcnt(6)
M a[108:111], a[112:115], v[44:47], a[108:111]
M a[108:111], a[112:115], v[76:79], a[108:111]
M v[224:227], a[148:151], v[32:35], v[224:227]
v_exp_f32 v104, v104
M v[224:227], a[152:155], v[64:67], v[224:227]
s_add_u32 s25, s25, 32768
s_cmp_eq_u32 s25, s27
s_cselect_b32 s25, s28, s25
s_cselect_b32 s27, -1, s27
M v[228:231], a[152:155], v[68:71], v[228:231]
v_exp_f32 v105, v105
M v[228:231], a[148:151], v[36:39], v[228:231]
v_cvt_pk_bf16_f32 v103, v118, v119
v_cvt_pk_bf16_f32 v104, v104, v105
M v[232:235], a[148:151], v[40:43], v[232:235]
v_exp_f32 v106, v106
M v[232:235], a[152:155], v[72:75], v[232:235]
M v[236:239], a[152:155], v[76:79], v[236:239]
v_exp_f32 v107, v107
M v[236:239], a[148:151], v[44:47], v[236:239]
v_cvt_pk_bf16_f32 v105, v106, v107
s_waitcnt lgkmcnt(4)
M v[240:243], a[156:159], v[32:35], v[240:243]
v_exp_f32 v120, v120
M v[240:243], a[160:163], v[64:67], v[240:243]
M v[244:247], a[160:163], v[68:71], v[244:247]
v_exp_f32 v121, v121
M v[244:247], a[156:159], v[36:39], v[244:247]
v_cvt_pk_bf16_f32 v106, v120, v121
M v[248:251], a[156:159], v[40:43], v[248:251]
v_exp_f32 v122, v122
M v[248:251], a[160:163], v[72:75], v[248:251]
s_waitcnt vmcnt(16) lgkmcnt(0)
s_barrier
ds_read_b128 a[116:119], v3 offset:0
ds_read_b128 a[120:123], v3 offset:1024
ds_read_b128 a[124:127], v3 offset:2048
ds_read_b128 a[128:131], v3 offset:3072
M v[252:255], a[160:163], v[76:79], v[252:255]
v_exp_f32 v123, v123
M v[252:255], a[156:159], v[44:47], v[252:255]
v_cvt_pk_bf16_f32 v107, v122, v123
M a[64:67], a[164:167], v[32:35], a[64:67]
v_exp_f32 v108, v108
M a[64:67], a[168:171], v[64:67], a[64:67]
ds_read_b128 a[132:135], v3 offset:4096
ds_read_b128 a[136:139], v3 offset:5120
M a[68:71], a[168:171], v[68:71], a[68:71]
v_exp_f32 v109, v109
M a[68:71], a[164:167], v[36:39], a[68:71]
v_cvt_pk_bf16_f32 v108, v108, v109
M a[72:75], a[164:167], v[40:43], a[72:75]
v_exp_f32 v110, v110
M a[72:75], a[168:171], v[72:75], a[72:75]
M a[76:79], a[168:171], v[76:79], a[76:79]
v_exp_f32 v111, v111
M a[76:79], a[164:167], v[44:47], a[76:79]
v_cvt_pk_bf16_f32 v109, v110, v111
M a[80:83], a[172:175], v[32:35], a[80:83]
v_exp_f32 v124, v124
M a[80:83], a[176:179], v[64:67], a[80:83]
ds_read_b128 a[140:143], v3 offset:6144
ds_read_b128 a[144:147], v3 offset:7168
M a[84:87], a[176:179], v[68:71], a[84:87]
v_exp_f32 v125, v125
M a[84:87], a[172:175], v[36:39], a[84:87]
v_cvt_pk_bf16_f32 v110, v124, v125
M a[88:91], a[172:175], v[40:43], a[88:91]
v_exp_f32 v126, v126
M a[88:91], a[176:179], v[72:75], a[88:91]
M a[92:95], a[176:179], v[76:79], a[92:95]
v_exp_f32 v127, v127
M a[92:95], a[172:175], v[44:47], a[92:95]
v_cvt_pk_bf16_f32 v111, v126, v127
s_waitcnt lgkmcnt(4)
s_add_u32 m0, s29, 32768
M v[32:35], a[116:119], a[0:3], 0
v_exp_f32 v128, v128
M v[32:35], a[120:123], a[4:7], v[32:35]
ds_read_b128 a[148:151], v3 offset:8192
ds_read_b128 a[152:155], v3 offset:9216
M v[32:35], a[124:127], a[8:11], v[32:35]
v_exp_f32 v129, v129
M v[32:35], a[128:131], a[12:15], v[32:35]
buffer_load_dwordx4 v1, s[12:15], s26 offen offset:0 sc1 lds
s_add_u32 s32, s26, 4096
M v[36:39], a[128:131], a[28:31], 0
v_exp_f32 v130, v130
M v[36:39], a[124:127], a[24:27], v[36:39]
v_cvt_pk_bf16_f32 v128, v128, v129
M v[36:39], a[120:123], a[20:23], v[36:39]
v_exp_f32 v131, v131
M v[36:39], a[116:119], a[16:19], v[36:39]
buffer_load_dwordx4 v1, s[12:15], s26 offen offset:1024 sc1 lds
M v[40:43], a[116:119], a[32:35], 0
v_exp_f32 v144, v144
M v[40:43], a[120:123], a[36:39], v[40:43]
ds_read_b128 a[156:159], v3 offset:10240
ds_read_b128 a[160:163], v3 offset:11264
M v[40:43], a[124:127], a[40:43], v[40:43]
v_exp_f32 v145, v145
M v[40:43], a[128:131], a[44:47], v[40:43]
buffer_load_dwordx4 v1, s[12:15], s26 offen offset:2048 sc1 lds
M v[44:47], a[128:131], a[60:63], 0
v_exp_f32 v146, v146
M v[44:47], a[124:127], a[56:59], v[44:47]
v_cvt_pk_bf16_f32 v129, v130, v131
v_cvt_pk_bf16_f32 v130, v144, v145
M v[44:47], a[120:123], a[52:55], v[44:47]
v_exp_f32 v147, v147
M v[44:47], a[116:119], a[48:51], v[44:47]
buffer_load_dwordx4 v1, s[12:15], s26 offen offset:3072 sc1 lds
s_add_u32 m0, s29, 36864
s_waitcnt lgkmcnt(4)
M v[48:51], a[132:135], a[0:3], 0
v_exp_f32 v132, v132
M v[48:51], a[136:139], a[4:7], v[48:51]
ds_read_b128 a[164:167], v3 offset:12288
ds_read_b128 a[168:171], v3 offset:13312
M v[48:51], a[140:143], a[8:11], v[48:51]
v_exp_f32 v133, v133
M v[48:51], a[144:147], a[12:15], v[48:51]
buffer_load_dwordx4 v1, s[12:15], s32 offen offset:0 sc1 lds
M v[52:55], a[144:147], a[28:31], 0
v_exp_f32 v134, v134
M v[52:55], a[140:143], a[24:27], v[52:55]
v_cvt_pk_bf16_f32 v131, v146, v147
v_cvt_pk_bf16_f32 v132, v132, v133
M v[52:55], a[136:139], a[20:23], v[52:55]
v_exp_f32 v135, v135
M v[52:55], a[132:135], a[16:19], v[52:55]
buffer_load_dwordx4 v1, s[12:15], s32 offen offset:1024 sc1 lds
M v[56:59], a[132:135], a[32:35], 0
v_exp_f32 v148, v148
M v[56:59], a[136:139], a[36:39], v[56:59]
ds_read_b128 a[172:175], v3 offset:14336
ds_read_b128 a[176:179], v3 offset:15360
M v[56:59], a[140:143], a[40:43], v[56:59]
v_exp_f32 v149, v149
M v[56:59], a[144:147], a[44:47], v[56:59]
buffer_load_dwordx4 v1, s[12:15], s32 offen offset:2048 sc1 lds
M v[60:63], a[144:147], a[60:63], 0
v_exp_f32 v150, v150
M v[60:63], a[140:143], a[56:59], v[60:63]
v_cvt_pk_bf16_f32 v133, v134, v135
v_cvt_pk_bf16_f32 v134, v148, v149
M v[60:63], a[136:139], a[52:55], v[60:63]
v_exp_f32 v151, v151
M v[60:63], a[132:135], a[48:51], v[60:63]
buffer_load_dwordx4 v1, s[12:15], s32 offen offset:3072 sc1 lds
s_waitcnt lgkmcnt(4)
M v[64:67], a[148:151], a[0:3], 0
v_exp_f32 v136, v136
M v[64:67], a[152:155], a[4:7], v[64:67]
s_add_u32 s26, s26, 32768
s_cmp_eq_u32 s26, s62
s_cselect_b32 s26, s63, s26
s_cselect_b32 s62, -1, s62
M v[64:67], a[156:159], a[8:11], v[64:67]
v_exp_f32 v137, v137
M v[64:67], a[160:163], a[12:15], v[64:67]
v_cvt_pk_bf16_f32 v135, v150, v151
v_cvt_pk_bf16_f32 v136, v136, v137
M v[68:71], a[160:163], a[28:31], 0
v_exp_f32 v138, v138
M v[68:71], a[156:159], a[24:27], v[68:71]
M v[68:71], a[152:155], a[20:23], v[68:71]
v_exp_f32 v139, v139
M v[68:71], a[148:151], a[16:19], v[68:71]
v_cvt_pk_bf16_f32 v137, v138, v139
M v[72:75], a[148:151], a[32:35], 0
v_exp_f32 v152, v152
M v[72:75], a[152:155], a[36:39], v[72:75]
M v[72:75], a[156:159], a[40:43], v[72:75]
v_exp_f32 v153, v153
M v[72:75], a[160:163], a[44:47], v[72:75]
v_cvt_pk_bf16_f32 v138, v152, v153
M v[76:79], a[160:163], a[60:63], 0
v_exp_f32 v154, v154
M v[76:79], a[156:159], a[56:59], v[76:79]
s_waitcnt vmcnt(16) lgkmcnt(0)
s_barrier
ds_read_b128 a[116:119], v3 offset:32768
ds_read_b128 a[120:123], v3 offset:40960
ds_read_b128 a[124:127], v3 offset:33792
ds_read_b128 a[128:131], v3 offset:41984
M v[76:79], a[152:155], a[52:55], v[76:79]
v_exp_f32 v155, v155
M v[76:79], a[148:151], a[48:51], v[76:79]
v_cvt_pk_bf16_f32 v139, v154, v155
M v[80:83], a[164:167], a[0:3], 0
v_exp_f32 v140, v140
M v[80:83], a[168:171], a[4:7], v[80:83]
ds_read_b128 a[132:135], v3 offset:34816
ds_read_b128 a[136:139], v3 offset:43008
M v[80:83], a[172:175], a[8:11], v[80:83]
v_exp_f32 v141, v141
M v[80:83], a[176:179], a[12:15], v[80:83]
v_cvt_pk_bf16_f32 v140, v140, v141
M v[84:87], a[176:179], a[28:31], 0
v_exp_f32 v142, v142
M v[84:87], a[172:175], a[24:27], v[84:87]
M v[84:87], a[168:171], a[20:23], v[84:87]
v_exp_f32 v143, v143
M v[84:87], a[164:167], a[16:19], v[84:87]
v_cvt_pk_bf16_f32 v141, v142, v143
M v[88:91], a[164:167], a[32:35], 0
v_exp_f32 v156, v156
M v[88:91], a[168:171], a[36:39], v[88:91]
ds_read_b128 a[140:143], v3 offset:35840
ds_read_b128 a[144:147], v3 offset:44032
M v[88:91], a[172:175], a[40:43], v[88:91]
v_exp_f32 v157, v157
M v[88:91], a[176:179], a[44:47], v[88:91]
v_cvt_pk_bf16_f32 v142, v156, v157
M v[92:95], a[176:179], a[60:63], 0
v_exp_f32 v158, v158
M v[92:95], a[172:175], a[56:59], v[92:95]
M v[92:95], a[168:171], a[52:55], v[92:95]
v_exp_f32 v159, v159
M v[92:95], a[164:167], a[48:51], v[92:95]
v_cvt_pk_bf16_f32 v143, v158, v159
s_waitcnt lgkmcnt(6)
s_add_u32 m0, s29, 65536
M v[160:163], a[116:119], v[96:99], v[160:163]
v_exp_f32 v32, v32
M v[160:163], a[120:123], v[128:131], v[160:163]
ds_read_b128 a[148:151], v3 offset:36864
ds_read_b128 a[152:155], v3 offset:45056
M v[164:167], a[120:123], v[132:135], v[164:167]
v_exp_f32 v33, v33
M v[164:167], a[116:119], v[100:103], v[164:167]
buffer_load_dwordx4 v1, s[12:15], s25 offen offset:0 sc1 lds
s_add_u32 s32, s25, 4096
M v[168:171], a[116:119], v[104:107], v[168:171]
v_exp_f32 v34, v34
M v[168:171], a[120:123], v[136:139], v[168:171]
v_cvt_pk_bf16_f32 v32, v32, v33
M v[172:175], a[120:123], v[140:143], v[172:175]
v_exp_f32 v35, v35
M v[172:175], a[116:119], v[108:111], v[172:175]
buffer_load_dwordx4 v1, s[12:15], s25 offen offset:1024 sc1 lds
s_waitcnt lgkmcnt(6)
M a[96:99], a[112:115], v[96:99], a[96:99]
M a[96:99], a[112:115], v[128:131], a[96:99]
M v[176:179], a[124:127], v[96:99], v[176:179]
v_exp_f32 v48, v48
M v[176:179], a[128:131], v[128:131], v[176:179]
ds_read_b128 a[156:159], v3 offset:37888
ds_read_b128 a[160:163], v3 offset:46080
M v[180:183], a[128:131], v[132:135], v[180:183]
v_exp_f32 v49, v49
M v[180:183], a[124:127], v[100:103], v[180:183]
buffer_load_dwordx4 v1, s[12:15], s25 offen offset:2048 sc1 lds
M v[184:187], a[124:127], v[104:107], v[184:187]
v_exp_f32 v50, v50
M v[184:187], a[128:131], v[136:139], v[184:187]
v_cvt_pk_bf16_f32 v33, v34, v35
v_cvt_pk_bf16_f32 v34, v48, v49
M v[188:191], a[128:131], v[140:143], v[188:191]
v_exp_f32 v51, v51
M v[188:191], a[124:127], v[108:111], v[188:191]
buffer_load_dwordx4 v1, s[12:15], s25 offen offset:3072 sc1 lds
s_add_u32 m0, s29, 69632
s_waitcnt lgkmcnt(6)
M a[100:103], a[112:115], v[100:103], a[100:103]
M a[100:103], a[112:115], v[132:135], a[100:103]
M v[192:195], a[132:135], v[96:99], v[192:195]
v_exp_f32 v36, v36
M v[192:195], a[136:139], v[128:131], v[192:195]
ds_read_b128 a[164:167], v3 offset:38912
ds_read_b128 a[168:171], v3 offset:47104
M v[196:199], a[136:139], v[132:135], v[196:199]
v_exp_f32 v37, v37
M v[196:199], a[132:135], v[100:103], v[196:199]
buffer_load_dwordx4 v1, s[12:15], s32 offen offset:0 sc1 lds
M v[200:203], a[132:135], v[104:107], v[200:203]
v_exp_f32 v38, v38
M v[200:203], a[136:139], v[136:139], v[200:203]
v_cvt_pk_bf16_f32 v35, v50, v51
v_cvt_pk_bf16_f32 v36, v36, v37
M v[204:207], a[136:139], v[140:143], v[204:207]
v_exp_f32 v39, v39
M v[204:207], a[132:135], v[108:111], v[204:207]
buffer_load_dwordx4 v1, s[12:15], s32 offen offset:1024 sc1 lds
s_waitcnt lgkmcnt(6)
M a[104:107], a[112:115], v[104:107], a[104:107]
M a[104:107], a[112:115], v[136:139], a[104:107]
M v[208:211], a[140:143], v[96:99], v[208:211]
v_exp_f32 v52, v52
M v[208:211], a[144:147], v[128:131], v[208:211]
ds_read_b128 a[172:175], v3 offset:39936
ds_read_b128 a[176:179], v3 offset:48128
M v[212:215], a[144:147], v[132:135], v[212:215]
v_exp_f32 v53, v53
M v[212:215], a[140:143], v[100:103], v[212:215]
buffer_load_dwordx4 v1, s[12:15], s32 offen offset:2048 sc1 lds
M v[216:219], a[140:143], v[104:107], v[216:219]
v_exp_f32 v54, v54
M v[216:219], a[144:147], v[136:139], v[216:219]
v_cvt_pk_bf16_f32 v37, v38, v39
v_cvt_pk_bf16_f32 v38, v52, v53
M v[220:223], a[144:147], v[140:143], v[220:223]
v_exp_f32 v55, v55
M v[220:223], a[140:143], v[108:111], v[220:223]
buffer_load_dwordx4 v1, s[12:15], s32 offen offset:3072 sc1 lds
s_waitcnt lgkmcnt(6)
M a[108:111], a[112:115], v[108:111], a[108:111]
M a[108:111], a[112:115], v[140:143], a[108:111]
M v[224:227], a[148:151], v[96:99], v[224:227]
v_exp_f32 v40, v40
M v[224:227], a[152:155], v[128:131], v[224:227]
s_add_u32 s25, s25, 32768
s_cmp_eq_u32 s25, s27
s_cselect_b32 s25, s28, s25
s_cselect_b32 s27, -1, s27
M v[228:231], a[152:155], v[132:135], v[228:231]
v_exp_f32 v41, v41
M v[228:231], a[148:151], v[100:103], v[228:231]
v_cvt_pk_bf16_f32 v39, v54, v55
v_cvt_pk_bf16_f32 v40, v40, v41
M v[232:235], a[148:151], v[104:107], v[232:235]
v_exp_f32 v42, v42
M v[232:235], a[152:155], v[136:139], v[232:235]
M v[236:239], a[152:155], v[140:143], v[236:239]
v_exp_f32 v43, v43
M v[236:239], a[148:151], v[108:111], v[236:239]
v_cvt_pk_bf16_f32 v41, v42, v43
s_waitcnt lgkmcnt(4)
M v[240:243], a[156:159], v[96:99], v[240:243]
v_exp_f32 v56, v56
M v[240:243], a[160:163], v[128:131], v[240:243]
M v[244:247], a[160:163], v[132:135], v[244:247]
v_exp_f32 v57, v57
M v[244:247], a[156:159], v[100:103], v[244:247]
v_cvt_pk_bf16_f32 v42, v56, v57
M v[248:251], a[156:159], v[104:107], v[248:251]
v_exp_f32 v58, v58
M v[248:251], a[160:163], v[136:139], v[248:251]
s_waitcnt vmcnt(16) lgkmcnt(0)
s_barrier
ds_read_b128 a[116:119], v2 offset:0
ds_read_b128 a[120:123], v2 offset:1024
ds_read_b128 a[124:127], v2 offset:2048
ds_read_b128 a[128:131], v2 offset:3072
M v[252:255], a[160:163], v[140:143], v[252:255]
v_exp_f32 v59, v59
M v[252:255], a[156:159], v[108:111], v[252:255]
v_cvt_pk_bf16_f32 v43, v58, v59
M a[64:67], a[164:167], v[96:99], a[64:67]
v_exp_f32 v44, v44
M a[64:67], a[168:171], v[128:131], a[64:67]
ds_read_b128 a[132:135], v2 offset:4096
ds_read_b128 a[136:139], v2 offset:5120
M a[68:71], a[168:171], v[132:135], a[68:71]
v_exp_f32 v45, v45
M a[68:71], a[164:167], v[100:103], a[68:71]
v_cvt_pk_bf16_f32 v44, v44, v45
M a[72:75], a[164:167], v[104:107], a[72:75]
v_exp_f32 v46, v46
M a[72:75], a[168:171], v[136:139], a[72:75]
M a[76:79], a[168:171], v[140:143], a[76:79]
v_exp_f32 v47, v47
M a[76:79], a[164:167], v[108:111], a[76:79]
v_cvt_pk_bf16_f32 v45, v46, v47
M a[80:83], a[172:175], v[96:99], a[80:83]
v_exp_f32 v60, v60
M a[80:83], a[176:179], v[128:131], a[80:83]
ds_read_b128 a[140:143], v2 offset:6144
ds_read_b128 a[144:147], v2 offset:7168
M a[84:87], a[176:179], v[132:135], a[84:87]
v_exp_f32 v61, v61
M a[84:87], a[172:175], v[100:103], a[84:87]
v_cvt_pk_bf16_f32 v46, v60, v61
M a[88:91], a[172:175], v[104:107], a[88:91]
v_exp_f32 v62, v62
M a[88:91], a[176:179], v[136:139], a[88:91]
M a[92:95], a[176:179], v[140:143], a[92:95]
v_exp_f32 v63, v63
M a[92:95], a[172:175], v[108:111], a[92:95]
v_cvt_pk_bf16_f32 v47, v62, v63
s_sub_u32 s30, s30, 1
s_cmp_lg_u32 s30, 0
s_cbranch_scc1 Lk2_l3
s_lshl_b32 s33, s23, 6
s_add_i32 s33, s33, 0
s_cmp_gt_i32 s33, 0
s_cselect_b32 s34, 0, 0xf149f2ca
s_cmp_lt_i32 s33, 0
s_cselect_b32 s33, 0xf149f2ca, 0
v_mov_b32 v20, s34
v_mov_b32 v21, s34
v_mov_b32 v22, s34
v_mov_b32 v23, s34
v_mov_b32 v28, s33
v_mov_b32 v29, s33
v_mov_b32 v30, s33
v_mov_b32 v31, s33
v_med3_f32 v24, v16, v20, v28
v_med3_f32 v25, v17, v20, v28
v_med3_f32 v26, v18, v20, v28
v_med3_f32 v27, v19, v20, v28
s_waitcnt lgkmcnt(4)
s_add_u32 m0, s29, 98304
M v[96:99], a[116:119], a[0:3], v[24:27]
v_exp_f32 v64, v64
M v[96:99], a[120:123], a[4:7], v[96:99]
ds_read_b128 a[148:151], v2 offset:8192
ds_read_b128 a[152:155], v2 offset:9216
M v[96:99], a[124:127], a[8:11], v[96:99]
v_exp_f32 v65, v65
M v[96:99], a[128:131], a[12:15], v[96:99]
buffer_load_dwordx4 v1, s[12:15], s26 offen offset:0 sc1 lds
s_add_u32 s32, s26, 4096
M v[100:103], a[128:131], a[28:31], v[28:31]
v_exp_f32 v66, v66
M v[100:103], a[124:127], a[24:27], v[100:103]
v_cvt_pk_bf16_f32 v64, v64, v65
M v[100:103], a[120:123], a[20:23], v[100:103]
v_exp_f32 v67, v67
M v[100:103], a[116:119], a[16:19], v[100:103]
buffer_load_dwordx4 v1, s[12:15], s26 offen offset:1024 sc1 lds
M v[104:107], a[116:119], a[32:35], v[28:31]
v_exp_f32 v80, v80
M v[104:107], a[120:123], a[36:39], v[104:107]
ds_read_b128 a[156:159], v2 offset:10240
ds_read_b128 a[160:163], v2 offset:11264
M v[104:107], a[124:127], a[40:43], v[104:107]
v_exp_f32 v81, v81
M v[104:107], a[128:131], a[44:47], v[104:107]
buffer_load_dwordx4 v1, s[12:15], s26 offen offset:2048 sc1 lds
M v[108:111], a[128:131], a[60:63], v[28:31]
v_exp_f32 v82, v82
M v[108:111], a[124:127], a[56:59], v[108:111]
v_cvt_pk_bf16_f32 v65, v66, v67
v_cvt_pk_bf16_f32 v66, v80, v81
M v[108:111], a[120:123], a[52:55], v[108:111]
v_exp_f32 v83, v83
M v[108:111], a[116:119], a[48:51], v[108:111]
buffer_load_dwordx4 v1, s[12:15], s26 offen offset:3072 sc1 lds
s_add_u32 m0, s29, 102400
s_waitcnt lgkmcnt(4)
M v[112:115], a[132:135], a[0:3], v[20:23]
v_exp_f32 v68, v68
M v[112:115], a[136:139], a[4:7], v[112:115]
ds_read_b128 a[164:167], v2 offset:12288
ds_read_b128 a[168:171], v2 offset:13312
M v[112:115], a[140:143], a[8:11], v[112:115]
v_exp_f32 v69, v69
M v[112:115], a[144:147], a[12:15], v[112:115]
buffer_load_dwordx4 v1, s[12:15], s32 offen offset:0 sc1 lds
M v[116:119], a[144:147], a[28:31], v[24:27]
v_exp_f32 v70, v70
M v[116:119], a[140:143], a[24:27], v[116:119]
v_cvt_pk_bf16_f32 v67, v82, v83
v_cvt_pk_bf16_f32 v68, v68, v69
M v[116:119], a[136:139], a[20:23], v[116:119]
v_exp_f32 v71, v71
M v[116:119], a[132:135], a[16:19], v[116:119]
buffer_load_dwordx4 v1, s[12:15], s32 offen offset:1024 sc1 lds
M v[120:123], a[132:135], a[32:35], v[28:31]
v_exp_f32 v84, v84
M v[120:123], a[136:139], a[36:39], v[120:123]
ds_read_b128 a[172:175], v2 offset:14336
ds_read_b128 a[176:179], v2 offset:15360
M v[120:123], a[140:143], a[40:43], v[120:123]
v_exp_f32 v85, v85
M v[120:123], a[144:147], a[44:47], v[120:123]
buffer_load_dwordx4 v1, s[12:15], s32 offen offset:2048 sc1 lds
M v[124:127], a[144:147], a[60:63], v[28:31]
v_exp_f32 v86, v86
M v[124:127], a[140:143], a[56:59], v[124:127]
v_cvt_pk_bf16_f32 v69, v70, v71
v_cvt_pk_bf16_f32 v70, v84, v85
M v[124:127], a[136:139], a[52:55], v[124:127]
v_exp_f32 v87, v87
M v[124:127], a[132:135], a[48:51], v[124:127]
buffer_load_dwordx4 v1, s[12:15], s32 offen offset:3072 sc1 lds
s_waitcnt lgkmcnt(4)
M v[128:131], a[148:151], a[0:3], v[20:23]
v_exp_f32 v72, v72
M v[128:131], a[152:155], a[4:7], v[128:131]
s_add_u32 s26, s26, 32768
s_cmp_eq_u32 s26, s62
s_cselect_b32 s26, s63, s26
s_cselect_b32 s62, -1, s62
M v[128:131], a[156:159], a[8:11], v[128:131]
v_exp_f32 v73, v73
M v[128:131], a[160:163], a[12:15], v[128:131]
v_cvt_pk_bf16_f32 v71, v86, v87
v_cvt_pk_bf16_f32 v72, v72, v73
M v[132:135], a[160:163], a[28:31], v[20:23]
v_exp_f32 v74, v74
M v[132:135], a[156:159], a[24:27], v[132:135]
M v[132:135], a[152:155], a[20:23], v[132:135]
v_exp_f32 v75, v75
M v[132:135], a[148:151], a[16:19], v[132:135]
v_cvt_pk_bf16_f32 v73, v74, v75
M v[136:139], a[148:151], a[32:35], v[24:27]
v_exp_f32 v88, v88
M v[136:139], a[152:155], a[36:39], v[136:139]
M v[136:139], a[156:159], a[40:43], v[136:139]
v_exp_f32 v89, v89
M v[136:139], a[160:163], a[44:47], v[136:139]
v_cvt_pk_bf16_f32 v74, v88, v89
M v[140:143], a[160:163], a[60:63], v[28:31]
v_exp_f32 v90, v90
M v[140:143], a[156:159], a[56:59], v[140:143]
s_waitcnt vmcnt(16) lgkmcnt(0)
s_barrier
ds_read_b128 a[116:119], v2 offset:32768
ds_read_b128 a[120:123], v2 offset:40960
ds_read_b128 a[124:127], v2 offset:33792
ds_read_b128 a[128:131], v2 offset:41984
M v[140:143], a[152:155], a[52:55], v[140:143]
v_exp_f32 v91, v91
M v[140:143], a[148:151], a[48:51], v[140:143]
v_cvt_pk_bf16_f32 v75, v90, v91
M v[144:147], a[164:167], a[0:3], v[20:23]
v_exp_f32 v76, v76
M v[144:147], a[168:171], a[4:7], v[144:147]
ds_read_b128 a[132:135], v2 offset:34816
ds_read_b128 a[136:139], v2 offset:43008
M v[144:147], a[172:175], a[8:11], v[144:147]
v_exp_f32 v77, v77
M v[144:147], a[176:179], a[12:15], v[144:147]
v_cvt_pk_bf16_f32 v76, v76, v77
M v[148:151], a[176:179], a[28:31], v[20:23]
v_exp_f32 v78, v78
M v[148:151], a[172:175], a[24:27], v[148:151]
M v[148:151], a[168:171], a[20:23], v[148:151]
v_exp_f32 v79, v79
M v[148:151], a[164:167], a[16:19], v[148:151]
v_cvt_pk_bf16_f32 v77, v78, v79
M v[152:155], a[164:167], a[32:35], v[20:23]
v_exp_f32 v92, v92
M v[152:155], a[168:171], a[36:39], v[152:155]
ds_read_b128 a[140:143], v2 offset:35840
ds_read_b128 a[144:147], v2 offset:44032
M v[152:155], a[172:175], a[40:43], v[152:155]
v_exp_f32 v93, v93
M v[152:155], a[176:179], a[44:47], v[152:155]
v_cvt_pk_bf16_f32 v78, v92, v93
M v[156:159], a[176:179], a[60:63], v[24:27]
v_exp_f32 v94, v94
M v[156:159], a[172:175], a[56:59], v[156:159]
M v[156:159], a[168:171], a[52:55], v[156:159]
v_exp_f32 v95, v95
M v[156:159], a[164:167], a[48:51], v[156:159]
v_cvt_pk_bf16_f32 v79, v94, v95
s_waitcnt lgkmcnt(6)
s_add_u32 m0, s29, 0
M v[160:163], a[116:119], v[32:35], v[160:163]
v_exp_f32 v96, v96
M v[160:163], a[120:123], v[64:67], v[160:163]
ds_read_b128 a[148:151], v2 offset:36864
ds_read_b128 a[152:155], v2 offset:45056
M v[164:167], a[120:123], v[68:71], v[164:167]
v_exp_f32 v97, v97
M v[164:167], a[116:119], v[36:39], v[164:167]
buffer_load_dwordx4 v1, s[12:15], s25 offen offset:0 sc1 lds
s_add_u32 s32, s25, 4096
M v[168:171], a[116:119], v[40:43], v[168:171]
v_exp_f32 v98, v98
M v[168:171], a[120:123], v[72:75], v[168:171]
v_cvt_pk_bf16_f32 v96, v96, v97
M v[172:175], a[120:123], v[76:79], v[172:175]
v_exp_f32 v99, v99
M v[172:175], a[116:119], v[44:47], v[172:175]
buffer_load_dwordx4 v1, s[12:15], s25 offen offset:1024 sc1 lds
s_waitcnt lgkmcnt(6)
M a[96:99], a[112:115], v[32:35], a[96:99]
M a[96:99], a[112:115], v[64:67], a[96:99]
M v[176:179], a[124:127], v[32:35], v[176:179]
v_exp_f32 v112, v112
M v[176:179], a[128:131], v[64:67], v[176:179]
ds_read_b128 a[156:159], v2 offset:37888
ds_read_b128 a[160:163], v2 offset:46080
M v[180:183], a[128:131], v[68:71], v[180:183]
v_exp_f32 v113, v113
M v[180:183], a[124:127], v[36:39], v[180:183]
buffer_load_dwordx4 v1, s[12:15], s25 offen offset:2048 sc1 lds
M v[184:187], a[124:127], v[40:43], v[184:187]
v_exp_f32 v114, v114
M v[184:187], a[128:131], v[72:75], v[184:187]
v_cvt_pk_bf16_f32 v97, v98, v99
v_cvt_pk_bf16_f32 v98, v112, v113
M v[188:191], a[128:131], v[76:79], v[188:191]
v_exp_f32 v115, v115
M v[188:191], a[124:127], v[44:47], v[188:191]
buffer_load_dwordx4 v1, s[12:15], s25 offen offset:3072 sc1 lds
s_add_u32 m0, s29, 4096
s_waitcnt lgkmcnt(6)
M a[100:103], a[112:115], v[36:39], a[100:103]
M a[100:103], a[112:115], v[68:71], a[100:103]
M v[192:195], a[132:135], v[32:35], v[192:195]
v_exp_f32 v100, v100
M v[192:195], a[136:139], v[64:67], v[192:195]
ds_read_b128 a[164:167], v2 offset:38912
ds_read_b128 a[168:171], v2 offset:47104
M v[196:199], a[136:139], v[68:71], v[196:199]
v_exp_f32 v101, v101
M v[196:199], a[132:135], v[36:39], v[196:199]
buffer_load_dwordx4 v1, s[12:15], s32 offen offset:0 sc1 lds
M v[200:203], a[132:135], v[40:43], v[200:203]
v_exp_f32 v102, v102
M v[200:203], a[136:139], v[72:75], v[200:203]
v_cvt_pk_bf16_f32 v99, v114, v115
v_cvt_pk_bf16_f32 v100, v100, v101
M v[204:207], a[136:139], v[76:79], v[204:207]
v_exp_f32 v103, v103
M v[204:207], a[132:135], v[44:47], v[204:207]
buffer_load_dwordx4 v1, s[12:15], s32 offen offset:1024 sc1 lds
s_waitcnt lgkmcnt(6)
M a[104:107], a[112:115], v[40:43], a[104:107]
M a[104:107], a[112:115], v[72:75], a[104:107]
M v[208:211], a[140:143], v[32:35], v[208:211]
v_exp_f32 v116, v116
M v[208:211], a[144:147], v[64:67], v[208:211]
ds_read_b128 a[172:175], v2 offset:39936
ds_read_b128 a[176:179], v2 offset:48128
M v[212:215], a[144:147], v[68:71], v[212:215]
v_exp_f32 v117, v117
M v[212:215], a[140:143], v[36:39], v[212:215]
buffer_load_dwordx4 v1, s[12:15], s32 offen offset:2048 sc1 lds
M v[216:219], a[140:143], v[40:43], v[216:219]
v_exp_f32 v118, v118
M v[216:219], a[144:147], v[72:75], v[216:219]
v_cvt_pk_bf16_f32 v101, v102, v103
v_cvt_pk_bf16_f32 v102, v116, v117
M v[220:223], a[144:147], v[76:79], v[220:223]
v_exp_f32 v119, v119
M v[220:223], a[140:143], v[44:47], v[220:223]
buffer_load_dwordx4 v1, s[12:15], s32 offen offset:3072 sc1 lds
s_waitcnt lgkmcnt(6)
M a[108:111], a[112:115], v[44:47], a[108:111]
M a[108:111], a[112:115], v[76:79], a[108:111]
M v[224:227], a[148:151], v[32:35], v[224:227]
v_exp_f32 v104, v104
M v[224:227], a[152:155], v[64:67], v[224:227]
s_add_u32 s25, s25, 32768
s_cmp_eq_u32 s25, s27
s_cselect_b32 s25, s28, s25
s_cselect_b32 s27, -1, s27
M v[228:231], a[152:155], v[68:71], v[228:231]
v_exp_f32 v105, v105
M v[228:231], a[148:151], v[36:39], v[228:231]
v_cvt_pk_bf16_f32 v103, v118, v119
v_cvt_pk_bf16_f32 v104, v104, v105
M v[232:235], a[148:151], v[40:43], v[232:235]
v_exp_f32 v106, v106
M v[232:235], a[152:155], v[72:75], v[232:235]
M v[236:239], a[152:155], v[76:79], v[236:239]
v_exp_f32 v107, v107
M v[236:239], a[148:151], v[44:47], v[236:239]
v_cvt_pk_bf16_f32 v105, v106, v107
s_waitcnt lgkmcnt(4)
M v[240:243], a[156:159], v[32:35], v[240:243]
v_exp_f32 v120, v120
M v[240:243], a[160:163], v[64:67], v[240:243]
M v[244:247], a[160:163], v[68:71], v[244:247]
v_exp_f32 v121, v121
M v[244:247], a[156:159], v[36:39], v[244:247]
v_cvt_pk_bf16_f32 v106, v120, v121
M v[248:251], a[156:159], v[40:43], v[248:251]
v_exp_f32 v122, v122
M v[248:251], a[160:163], v[72:75], v[248:251]
s_waitcnt vmcnt(16) lgkmcnt(0)
s_barrier
ds_read_b128 a[116:119], v3 offset:0
ds_read_b128 a[120:123], v3 offset:1024
ds_read_b128 a[124:127], v3 offset:2048
ds_read_b128 a[128:131], v3 offset:3072
M v[252:255], a[160:163], v[76:79], v[252:255]
v_exp_f32 v123, v123
M v[252:255], a[156:159], v[44:47], v[252:255]
v_cvt_pk_bf16_f32 v107, v122, v123
M a[64:67], a[164:167], v[32:35], a[64:67]
v_exp_f32 v108, v108
M a[64:67], a[168:171], v[64:67], a[64:67]
ds_read_b128 a[132:135], v3 offset:4096
ds_read_b128 a[136:139], v3 offset:5120
M a[68:71], a[168:171], v[68:71], a[68:71]
v_exp_f32 v109, v109
M a[68:71], a[164:167], v[36:39], a[68:71]
v_cvt_pk_bf16_f32 v108, v108, v109
M a[72:75], a[164:167], v[40:43], a[72:75]
v_exp_f32 v110, v110
M a[72:75], a[168:171], v[72:75], a[72:75]
M a[76:79], a[168:171], v[76:79], a[76:79]
v_exp_f32 v111, v111
M a[76:79], a[164:167], v[44:47], a[76:79]
v_cvt_pk_bf16_f32 v109, v110, v111
M a[80:83], a[172:175], v[32:35], a[80:83]
v_exp_f32 v124, v124
M a[80:83], a[176:179], v[64:67], a[80:83]
ds_read_b128 a[140:143], v3 offset:6144
ds_read_b128 a[144:147], v3 offset:7168
M a[84:87], a[176:179], v[68:71], a[84:87]
v_exp_f32 v125, v125
M a[84:87], a[172:175], v[36:39], a[84:87]
v_cvt_pk_bf16_f32 v110, v124, v125
M a[88:91], a[172:175], v[40:43], a[88:91]
v_exp_f32 v126, v126
M a[88:91], a[176:179], v[72:75], a[88:91]
M a[92:95], a[176:179], v[76:79], a[92:95]
v_exp_f32 v127, v127
M a[92:95], a[172:175], v[44:47], a[92:95]
v_cvt_pk_bf16_f32 v111, v126, v127
s_lshl_b32 s33, s23, 6
s_add_i32 s33, s33, -64
s_cmp_gt_i32 s33, 0
s_cselect_b32 s34, 0, 0xf149f2ca
s_cmp_lt_i32 s33, 0
s_cselect_b32 s33, 0xf149f2ca, 0
v_mov_b32 v20, s34
v_mov_b32 v21, s34
v_mov_b32 v22, s34
v_mov_b32 v23, s34
v_mov_b32 v28, s33
v_mov_b32 v29, s33
v_mov_b32 v30, s33
v_mov_b32 v31, s33
v_med3_f32 v24, v16, v20, v28
v_med3_f32 v25, v17, v20, v28
v_med3_f32 v26, v18, v20, v28
v_med3_f32 v27, v19, v20, v28
s_waitcnt lgkmcnt(4)
s_add_u32 m0, s29, 32768
M v[32:35], a[116:119], a[0:3], v[24:27]
v_exp_f32 v128, v128
M v[32:35], a[120:123], a[4:7], v[32:35]
ds_read_b128 a[148:151], v3 offset:8192
ds_read_b128 a[152:155], v3 offset:9216
M v[32:35], a[124:127], a[8:11], v[32:35]
v_exp_f32 v129, v129
M v[32:35], a[128:131], a[12:15], v[32:35]
buffer_load_dwordx4 v1, s[12:15], s26 offen offset:0 sc1 lds
s_add_u32 s32, s26, 4096
M v[36:39], a[128:131], a[28:31], v[28:31]
v_exp_f32 v130, v130
M v[36:39], a[124:127], a[24:27], v[36:39]
v_cvt_pk_bf16_f32 v128, v128, v129
M v[36:39], a[120:123], a[20:23], v[36:39]
v_exp_f32 v131, v131
M v[36:39], a[116:119], a[16:19], v[36:39]
buffer_load_dwordx4 v1, s[12:15], s26 offen offset:1024 sc1 lds
M v[40:43], a[116:119], a[32:35], v[28:31]
v_exp_f32 v144, v144
M v[40:43], a[120:123], a[36:39], v[40:43]
ds_read_b128 a[156:159], v3 offset:10240
ds_read_b128 a[160:163], v3 offset:11264
M v[40:43], a[124:127], a[40:43], v[40:43]
v_exp_f32 v145, v145
M v[40:43], a[128:131], a[44:47], v[40:43]
buffer_load_dwordx4 v1, s[12:15], s26 offen offset:2048 sc1 lds
M v[44:47], a[128:131], a[60:63], v[28:31]
v_exp_f32 v146, v146
M v[44:47], a[124:127], a[56:59], v[44:47]
v_cvt_pk_bf16_f32 v129, v130, v131
v_cvt_pk_bf16_f32 v130, v144, v145
M v[44:47], a[120:123], a[52:55], v[44:47]
v_exp_f32 v147, v147
M v[44:47], a[116:119], a[48:51], v[44:47]
buffer_load_dwordx4 v1, s[12:15], s26 offen offset:3072 sc1 lds
s_add_u32 m0, s29, 36864
s_waitcnt lgkmcnt(4)
M v[48:51], a[132:135], a[0:3], v[20:23]
v_exp_f32 v132, v132
M v[48:51], a[136:139], a[4:7], v[48:51]
ds_read_b128 a[164:167], v3 offset:12288
ds_read_b128 a[168:171], v3 offset:13312
M v[48:51], a[140:143], a[8:11], v[48:51]
v_exp_f32 v133, v133
M v[48:51], a[144:147], a[12:15], v[48:51]
buffer_load_dwordx4 v1, s[12:15], s32 offen offset:0 sc1 lds
M v[52:55], a[144:147], a[28:31], v[24:27]
v_exp_f32 v134, v134
M v[52:55], a[140:143], a[24:27], v[52:55]
v_cvt_pk_bf16_f32 v131, v146, v147
v_cvt_pk_bf16_f32 v132, v132, v133
M v[52:55], a[136:139], a[20:23], v[52:55]
v_exp_f32 v135, v135
M v[52:55], a[132:135], a[16:19], v[52:55]
buffer_load_dwordx4 v1, s[12:15], s32 offen offset:1024 sc1 lds
M v[56:59], a[132:135], a[32:35], v[28:31]
v_exp_f32 v148, v148
M v[56:59], a[136:139], a[36:39], v[56:59]
ds_read_b128 a[172:175], v3 offset:14336
ds_read_b128 a[176:179], v3 offset:15360
M v[56:59], a[140:143], a[40:43], v[56:59]
v_exp_f32 v149, v149
M v[56:59], a[144:147], a[44:47], v[56:59]
buffer_load_dwordx4 v1, s[12:15], s32 offen offset:2048 sc1 lds
M v[60:63], a[144:147], a[60:63], v[28:31]
v_exp_f32 v150, v150
M v[60:63], a[140:143], a[56:59], v[60:63]
v_cvt_pk_bf16_f32 v133, v134, v135
v_cvt_pk_bf16_f32 v134, v148, v149
M v[60:63], a[136:139], a[52:55], v[60:63]
v_exp_f32 v151, v151
M v[60:63], a[132:135], a[48:51], v[60:63]
buffer_load_dwordx4 v1, s[12:15], s32 offen offset:3072 sc1 lds
s_waitcnt lgkmcnt(4)
M v[64:67], a[148:151], a[0:3], v[20:23]
v_exp_f32 v136, v136
M v[64:67], a[152:155], a[4:7], v[64:67]
s_add_u32 s26, s26, 32768
s_cmp_eq_u32 s26, s62
s_cselect_b32 s26, s63, s26
s_cselect_b32 s62, -1, s62
M v[64:67], a[156:159], a[8:11], v[64:67]
v_exp_f32 v137, v137
M v[64:67], a[160:163], a[12:15], v[64:67]
v_cvt_pk_bf16_f32 v135, v150, v151
v_cvt_pk_bf16_f32 v136, v136, v137
M v[68:71], a[160:163], a[28:31], v[20:23]
v_exp_f32 v138, v138
M v[68:71], a[156:159], a[24:27], v[68:71]
M v[68:71], a[152:155], a[20:23], v[68:71]
v_exp_f32 v139, v139
M v[68:71], a[148:151], a[16:19], v[68:71]
v_cvt_pk_bf16_f32 v137, v138, v139
M v[72:75], a[148:151], a[32:35], v[24:27]
v_exp_f32 v152, v152
M v[72:75], a[152:155], a[36:39], v[72:75]
M v[72:75], a[156:159], a[40:43], v[72:75]
v_exp_f32 v153, v153
M v[72:75], a[160:163], a[44:47], v[72:75]
v_cvt_pk_bf16_f32 v138, v152, v153
M v[76:79], a[160:163], a[60:63], v[28:31]
v_exp_f32 v154, v154
M v[76:79], a[156:159], a[56:59], v[76:79]
s_waitcnt vmcnt(16) lgkmcnt(0)
s_barrier
ds_read_b128 a[116:119], v3 offset:32768
ds_read_b128 a[120:123], v3 offset:40960
ds_read_b128 a[124:127], v3 offset:33792
ds_read_b128 a[128:131], v3 offset:41984
M v[76:79], a[152:155], a[52:55], v[76:79]
v_exp_f32 v155, v155
M v[76:79], a[148:151], a[48:51], v[76:79]
v_cvt_pk_bf16_f32 v139, v154, v155
M v[80:83], a[164:167], a[0:3], v[20:23]
v_exp_f32 v140, v140
M v[80:83], a[168:171], a[4:7], v[80:83]
ds_read_b128 a[132:135], v3 offset:34816
ds_read_b128 a[136:139], v3 offset:43008
M v[80:83], a[172:175], a[8:11], v[80:83]
v_exp_f32 v141, v141
M v[80:83], a[176:179], a[12:15], v[80:83]
v_cvt_pk_bf16_f32 v140, v140, v141
M v[84:87], a[176:179], a[28:31], v[20:23]
v_exp_f32 v142, v142
M v[84:87], a[172:175], a[24:27], v[84:87]
M v[84:87], a[168:171], a[20:23], v[84:87]
v_exp_f32 v143, v143
M v[84:87], a[164:167], a[16:19], v[84:87]
v_cvt_pk_bf16_f32 v141, v142, v143
M v[88:91], a[164:167], a[32:35], v[20:23]
v_exp_f32 v156, v156
M v[88:91], a[168:171], a[36:39], v[88:91]
ds_read_b128 a[140:143], v3 offset:35840
ds_read_b128 a[144:147], v3 offset:44032
M v[88:91], a[172:175], a[40:43], v[88:91]
v_exp_f32 v157, v157
M v[88:91], a[176:179], a[44:47], v[88:91]
v_cvt_pk_bf16_f32 v142, v156, v157
M v[92:95], a[176:179], a[60:63], v[24:27]
v_exp_f32 v158, v158
M v[92:95], a[172:175], a[56:59], v[92:95]
M v[92:95], a[168:171], a[52:55], v[92:95]
v_exp_f32 v159, v159
M v[92:95], a[164:167], a[48:51], v[92:95]
v_cvt_pk_bf16_f32 v143, v158, v159
s_waitcnt lgkmcnt(6)
s_add_u32 m0, s29, 65536
M v[160:163], a[116:119], v[96:99], v[160:163]
v_exp_f32 v32, v32
M v[160:163], a[120:123], v[128:131], v[160:163]
ds_read_b128 a[148:151], v3 offset:36864
ds_read_b128 a[152:155], v3 offset:45056
M v[164:167], a[120:123], v[132:135], v[164:167]
v_exp_f32 v33, v33
M v[164:167], a[116:119], v[100:103], v[164:167]
buffer_load_dwordx4 v1, s[12:15], s25 offen offset:0 sc1 lds
s_add_u32 s32, s25, 4096
M v[168:171], a[116:119], v[104:107], v[168:171]
v_exp_f32 v34, v34
M v[168:171], a[120:123], v[136:139], v[168:171]
v_cvt_pk_bf16_f32 v32, v32, v33
M v[172:175], a[120:123], v[140:143], v[172:175]
v_exp_f32 v35, v35
M v[172:175], a[116:119], v[108:111], v[172:175]
buffer_load_dwordx4 v1, s[12:15], s25 offen offset:1024 sc1 lds
s_waitcnt lgkmcnt(6)
M a[96:99], a[112:115], v[96:99], a[96:99]
M a[96:99], a[112:115], v[128:131], a[96:99]
M v[176:179], a[124:127], v[96:99], v[176:179]
v_exp_f32 v48, v48
M v[176:179], a[128:131], v[128:131], v[176:179]
ds_read_b128 a[156:159], v3 offset:37888
ds_read_b128 a[160:163], v3 offset:46080
M v[180:183], a[128:131], v[132:135], v[180:183]
v_exp_f32 v49, v49
M v[180:183], a[124:127], v[100:103], v[180:183]
buffer_load_dwordx4 v1, s[12:15], s25 offen offset:2048 sc1 lds
M v[184:187], a[124:127], v[104:107], v[184:187]
v_exp_f32 v50, v50
M v[184:187], a[128:131], v[136:139], v[184:187]
v_cvt_pk_bf16_f32 v33, v34, v35
v_cvt_pk_bf16_f32 v34, v48, v49
M v[188:191], a[128:131], v[140:143], v[188:191]
v_exp_f32 v51, v51
M v[188:191], a[124:127], v[108:111], v[188:191]
buffer_load_dwordx4 v1, s[12:15], s25 offen offset:3072 sc1 lds
s_add_u32 m0, s29, 69632
s_waitcnt lgkmcnt(6)
M a[100:103], a[112:115], v[100:103], a[100:103]
M a[100:103], a[112:115], v[132:135], a[100:103]
M v[192:195], a[132:135], v[96:99], v[192:195]
v_exp_f32 v36, v36
M v[192:195], a[136:139], v[128:131], v[192:195]
ds_read_b128 a[164:167], v3 offset:38912
ds_read_b128 a[168:171], v3 offset:47104
M v[196:199], a[136:139], v[132:135], v[196:199]
v_exp_f32 v37, v37
M v[196:199], a[132:135], v[100:103], v[196:199]
buffer_load_dwordx4 v1, s[12:15], s32 offen offset:0 sc1 lds
M v[200:203], a[132:135], v[104:107], v[200:203]
v_exp_f32 v38, v38
M v[200:203], a[136:139], v[136:139], v[200:203]
v_cvt_pk_bf16_f32 v35, v50, v51
v_cvt_pk_bf16_f32 v36, v36, v37
M v[204:207], a[136:139], v[140:143], v[204:207]
v_exp_f32 v39, v39
M v[204:207], a[132:135], v[108:111], v[204:207]
buffer_load_dwordx4 v1, s[12:15], s32 offen offset:1024 sc1 lds
s_waitcnt lgkmcnt(6)
M a[104:107], a[112:115], v[104:107], a[104:107]
M a[104:107], a[112:115], v[136:139], a[104:107]
M v[208:211], a[140:143], v[96:99], v[208:211]
v_exp_f32 v52, v52
M v[208:211], a[144:147], v[128:131], v[208:211]
ds_read_b128 a[172:175], v3 offset:39936
ds_read_b128 a[176:179], v3 offset:48128
M v[212:215], a[144:147], v[132:135], v[212:215]
v_exp_f32 v53, v53
M v[212:215], a[140:143], v[100:103], v[212:215]
buffer_load_dwordx4 v1, s[12:15], s32 offen offset:2048 sc1 lds
M v[216:219], a[140:143], v[104:107], v[216:219]
v_exp_f32 v54, v54
M v[216:219], a[144:147], v[136:139], v[216:219]
v_cvt_pk_bf16_f32 v37, v38, v39
v_cvt_pk_bf16_f32 v38, v52, v53
M v[220:223], a[144:147], v[140:143], v[220:223]
v_exp_f32 v55, v55
M v[220:223], a[140:143], v[108:111], v[220:223]
buffer_load_dwordx4 v1, s[12:15], s32 offen offset:3072 sc1 lds
s_waitcnt lgkmcnt(6)
M a[108:111], a[112:115], v[108:111], a[108:111]
M a[108:111], a[112:115], v[140:143], a[108:111]
M v[224:227], a[148:151], v[96:99], v[224:227]
v_exp_f32 v40, v40
M v[224:227], a[152:155], v[128:131], v[224:227]
s_add_u32 s25, s25, 32768
s_cmp_eq_u32 s25, s27
s_cselect_b32 s25, s28, s25
s_cselect_b32 s27, -1, s27
M v[228:231], a[152:155], v[132:135], v[228:231]
v_exp_f32 v41, v41
M v[228:231], a[148:151], v[100:103], v[228:231]
v_cvt_pk_bf16_f32 v39, v54, v55
v_cvt_pk_bf16_f32 v40, v40, v41
M v[232:235], a[148:151], v[104:107], v[232:235]
v_exp_f32 v42, v42
M v[232:235], a[152:155], v[136:139], v[232:235]
M v[236:239], a[152:155], v[140:143], v[236:239]
v_exp_f32 v43, v43
M v[236:239], a[148:151], v[108:111], v[236:239]
v_cvt_pk_bf16_f32 v41, v42, v43
s_waitcnt lgkmcnt(4)
M v[240:243], a[156:159], v[96:99], v[240:243]
v_exp_f32 v56, v56
M v[240:243], a[160:163], v[128:131], v[240:243]
M v[244:247], a[160:163], v[132:135], v[244:247]
v_exp_f32 v57, v57
M v[244:247], a[156:159], v[100:103], v[244:247]
v_cvt_pk_bf16_f32 v42, v56, v57
M v[248:251], a[156:159], v[104:107], v[248:251]
v_exp_f32 v58, v58
M v[248:251], a[160:163], v[136:139], v[248:251]
s_waitcnt vmcnt(16) lgkmcnt(0)
s_barrier
ds_read_b128 a[116:119], v2 offset:0
ds_read_b128 a[120:123], v2 offset:1024
ds_read_b128 a[124:127], v2 offset:2048
ds_read_b128 a[128:131], v2 offset:3072
M v[252:255], a[160:163], v[140:143], v[252:255]
v_exp_f32 v59, v59
M v[252:255], a[156:159], v[108:111], v[252:255]
v_cvt_pk_bf16_f32 v43, v58, v59
M a[64:67], a[164:167], v[96:99], a[64:67]
v_exp_f32 v44, v44
M a[64:67], a[168:171], v[128:131], a[64:67]
ds_read_b128 a[132:135], v2 offset:4096
ds_read_b128 a[136:139], v2 offset:5120
M a[68:71], a[168:171], v[132:135], a[68:71]
v_exp_f32 v45, v45
M a[68:71], a[164:167], v[100:103], a[68:71]
v_cvt_pk_bf16_f32 v44, v44, v45
M a[72:75], a[164:167], v[104:107], a[72:75]
v_exp_f32 v46, v46
M a[72:75], a[168:171], v[136:139], a[72:75]
M a[76:79], a[168:171], v[140:143], a[76:79]
v_exp_f32 v47, v47
M a[76:79], a[164:167], v[108:111], a[76:79]
v_cvt_pk_bf16_f32 v45, v46, v47
M a[80:83], a[172:175], v[96:99], a[80:83]
v_exp_f32 v60, v60
M a[80:83], a[176:179], v[128:131], a[80:83]
ds_read_b128 a[140:143], v2 offset:6144
ds_read_b128 a[144:147], v2 offset:7168
M a[84:87], a[176:179], v[132:135], a[84:87]
v_exp_f32 v61, v61
M a[84:87], a[172:175], v[100:103], a[84:87]
v_cvt_pk_bf16_f32 v46, v60, v61
M a[88:91], a[172:175], v[104:107], a[88:91]
v_exp_f32 v62, v62
M a[88:91], a[176:179], v[136:139], a[88:91]
M a[92:95], a[176:179], v[140:143], a[92:95]
v_exp_f32 v63, v63
M a[92:95], a[172:175], v[108:111], a[92:95]
v_cvt_pk_bf16_f32 v47, v62, v63
s_waitcnt lgkmcnt(0)
Lk2_fin:
s_waitcnt vmcnt(8)
s_barrier
s_and_b32 s3, s2, 3
s_lshl_b32 s3, s3, 2
s_bfe_u32 s27, s2, 0x20003
s_add_u32 s27, s3, s27
s_lshl_b32 s43, s27, 8
s_add_u32 s43, s43, 8400896
v_lshlrev_b32 v15, 2, v0
buffer_load_dword v7, v15, s[52:55], s43 offen sc1
s_lshl_b32 s33, s2, 2
s_add_u32 s33, s33, s22
s_lshl_b32 s34, s33, 11
s_lshl_b32 s33, s33, 13
v_lshlrev_b32 v8, 3, v1
v_lshlrev_b32 v9, 1, v1
buffer_load_dword v5, v8, s[44:47], s33 offen
buffer_load_dword v6, v9, s[48:51], s34 offen
ds_read_b128 a[116:119], v2 offset:32768
ds_read_b128 a[120:123], v2 offset:40960
ds_read_b128 a[124:127], v2 offset:33792
ds_read_b128 a[128:131], v2 offset:41984
ds_read_b128 a[132:135], v2 offset:34816
ds_read_b128 a[136:139], v2 offset:43008
ds_read_b128 a[140:143], v2 offset:35840
ds_read_b128 a[144:147], v2 offset:44032
v_exp_f32 v64, v64
v_exp_f32 v65, v65
v_exp_f32 v66, v66
v_exp_f32 v67, v67
v_exp_f32 v80, v80
v_exp_f32 v81, v81
v_exp_f32 v82, v82
v_exp_f32 v83, v83
v_cvt_pk_bf16_f32 v64, v64, v65
v_cvt_pk_bf16_f32 v65, v66, v67
v_exp_f32 v68, v68
v_exp_f32 v69, v69
v_exp_f32 v70, v70
v_exp_f32 v71, v71
v_cvt_pk_bf16_f32 v66, v80, v81
v_cvt_pk_bf16_f32 v67, v82, v83
v_exp_f32 v84, v84
v_exp_f32 v85, v85
v_exp_f32 v86, v86
v_exp_f32 v87, v87
v_cvt_pk_bf16_f32 v68, v68, v69
v_cvt_pk_bf16_f32 v69, v70, v71
v_exp_f32 v72, v72
v_exp_f32 v73, v73
v_exp_f32 v74, v74
v_exp_f32 v75, v75
v_cvt_pk_bf16_f32 v70, v84, v85
v_cvt_pk_bf16_f32 v71, v86, v87
v_exp_f32 v88, v88
v_exp_f32 v89, v89
v_exp_f32 v90, v90
v_exp_f32 v91, v91
v_cvt_pk_bf16_f32 v72, v72, v73
v_cvt_pk_bf16_f32 v73, v74, v75
v_exp_f32 v76, v76
v_exp_f32 v77, v77
v_exp_f32 v78, v78
v_exp_f32 v79, v79
v_cvt_pk_bf16_f32 v74, v88, v89
v_cvt_pk_bf16_f32 v75, v90, v91
v_exp_f32 v92, v92
v_exp_f32 v93, v93
v_exp_f32 v94, v94
v_exp_f32 v95, v95
v_cvt_pk_bf16_f32 v76, v76, v77
v_cvt_pk_bf16_f32 v77, v78, v79
v_cvt_pk_bf16_f32 v78, v92, v93
v_cvt_pk_bf16_f32 v79, v94, v95
s_waitcnt lgkmcnt(6)
M v[160:163], a[116:119], v[32:35], v[160:163]
M v[160:163], a[120:123], v[64:67], v[160:163]
ds_read_b128 a[148:151], v2 offset:36864
ds_read_b128 a[152:155], v2 offset:45056
s_mov_b32 s61, 0
M v[164:167], a[120:123], v[68:71], v[164:167]
M v[164:167], a[116:119], v[36:39], v[164:167]
s_bfe_u32 s3, s2, 0x10002
M v[168:171], a[116:119], v[40:43], v[168:171]
M v[168:171], a[120:123], v[72:75], v[168:171]
s_lshl_b32 s3, s3, 3
M v[172:175], a[120:123], v[76:79], v[172:175]
M v[172:175], a[116:119], v[44:47], v[172:175]
s_waitcnt lgkmcnt(6)
s_lshr_b32 s28, s2, 5
M a[96:99], a[112:115], v[32:35], a[96:99]
M a[96:99], a[112:115], v[64:67], a[96:99]
M v[176:179], a[124:127], v[32:35], v[176:179]
M v[176:179], a[128:131], v[64:67], v[176:179]
ds_read_b128 a[156:159], v2 offset:37888
ds_read_b128 a[160:163], v2 offset:46080
s_add_u32 s28, s3, s28
M v[180:183], a[128:131], v[68:71], v[180:183]
s_lshl_b32 s25, s27, 18
M v[180:183], a[124:127], v[36:39], v[180:183]
M v[184:187], a[124:127], v[40:43], v[184:187]
s_lshl_b32 s3, s101, 12
M v[184:187], a[128:131], v[72:75], v[184:187]
M v[188:191], a[128:131], v[76:79], v[188:191]
s_add_u32 s25, s25, s3
M v[188:191], a[124:127], v[44:47], v[188:191]
s_waitcnt lgkmcnt(6)
M a[100:103], a[112:115], v[36:39], a[100:103]
M a[100:103], a[112:115], v[68:71], a[100:103]
M v[192:195], a[132:135], v[32:35], v[192:195]
s_lshl_b32 s26, s28, 7
M v[192:195], a[136:139], v[64:67], v[192:195]
ds_read_b128 a[164:167], v2 offset:38912
ds_read_b128 a[168:171], v2 offset:47104
M v[196:199], a[136:139], v[68:71], v[196:199]
s_lshl_b32 s42, s101, 11
M v[196:199], a[132:135], v[36:39], v[196:199]
M v[200:203], a[132:135], v[40:43], v[200:203]
s_add_u32 s44, s4, 83886080
s_addc_u32 s45, s5, 0
M v[200:203], a[136:139], v[72:75], v[200:203]
s_mov_b32 s46, 4194304
M v[204:207], a[136:139], v[76:79], v[204:207]
M v[204:207], a[132:135], v[44:47], v[204:207]
s_waitcnt lgkmcnt(6)
s_mov_b32 s47, 0x00020000
M a[104:107], a[112:115], v[40:43], a[104:107]
M a[104:107], a[112:115], v[72:75], a[104:107]
M v[208:211], a[140:143], v[32:35], v[208:211]
M v[208:211], a[144:147], v[64:67], v[208:211]
ds_read_b128 a[172:175], v2 offset:39936
ds_read_b128 a[176:179], v2 offset:48128
s_mov_b32 s50, 2097152
M v[212:215], a[144:147], v[68:71], v[212:215]
M v[212:215], a[140:143], v[36:39], v[212:215]
s_mov_b32 s51, 0x00020000
M v[216:219], a[140:143], v[40:43], v[216:219]
M v[216:219], a[144:147], v[72:75], v[216:219]
s_lshl_b32 s3, s101, 4
M v[220:223], a[144:147], v[76:79], v[220:223]
M v[220:223], a[140:143], v[44:47], v[220:223]
s_waitcnt lgkmcnt(6)
v_lshrrev_b32 v96, 3, v0
M a[108:111], a[112:115], v[44:47], a[108:111]
M a[108:111], a[112:115], v[76:79], a[108:111]
M v[224:227], a[148:151], v[32:35], v[224:227]
v_and_b32 v97, 6, v96
M v[224:227], a[152:155], v[64:67], v[224:227]
M v[228:231], a[152:155], v[68:71], v[228:231]
v_and_b32 v98, 7, v0
M v[228:231], a[148:151], v[36:39], v[228:231]
M v[232:235], a[148:151], v[40:43], v[232:235]
v_xor_b32 v97, v97, v98
M v[232:235], a[152:155], v[72:75], v[232:235]
M v[236:239], a[152:155], v[76:79], v[236:239]
v_add_u32 v96, s3, v96
M v[236:239], a[148:151], v[44:47], v[236:239]
s_waitcnt lgkmcnt(4)
M v[240:243], a[156:159], v[32:35], v[240:243]
v_lshlrev_b32 v96, 11, v96
M v[240:243], a[160:163], v[64:67], v[240:243]
M v[244:247], a[160:163], v[68:71], v[244:247]
v_lshl_add_u32 v99, v97, 4, v96
M v[244:247], a[156:159], v[36:39], v[244:247]
v_add_u32 v100, 15360, v99
M v[248:251], a[156:159], v[40:43], v[248:251]
M v[248:251], a[160:163], v[72:75], v[248:251]
s_waitcnt vmcnt(2) lgkmcnt(0)
s_barrier
v_cmp_ne_u32 vcc, 1, v7
s_nop 0
s_cbranch_vccnz Lk3_spinb0
Lk3_gotb0:
M v[252:255], a[160:163], v[76:79], v[252:255]
s_add_u32 m0, s42, 65536
s_nop 0
buffer_load_dwordx4 v99, s[48:51], s26 offen offset:0 lds
buffer_load_dwordx4 v100, s[48:51], s26 offen offset:1024 lds
M v[252:255], a[156:159], v[44:47], v[252:255]
buffer_load_dwordx4 a[192:195], v1, s[44:47], s25 offen offset:0 sc1
buffer_load_dwordx4 a[196:199], v1, s[44:47], s25 offen offset:1024 sc1
M a[64:67], a[164:167], v[32:35], a[64:67]
buffer_load_dwordx4 a[200:203], v1, s[44:47], s25 offen offset:2048 sc1
buffer_load_dwordx4 a[204:207], v1, s[44:47], s25 offen offset:3072 sc1
M a[64:67], a[168:171], v[64:67], a[64:67]
s_add_u32 s25, s25, 16384
s_add_u32 s26, s26, 131072
s_add_u32 m0, s42, 81920
s_nop 0
buffer_load_dwordx4 v99, s[48:51], s26 offen offset:0 lds
M a[68:71], a[168:171], v[68:71], a[68:71]
buffer_load_dwordx4 v100, s[48:51], s26 offen offset:1024 lds
buffer_load_dwordx4 a[208:211], v1, s[44:47], s25 offen offset:0 sc1
M a[68:71], a[164:167], v[36:39], a[68:71]
buffer_load_dwordx4 a[212:215], v1, s[44:47], s25 offen offset:1024 sc1
buffer_load_dwordx4 a[216:219], v1, s[44:47], s25 offen offset:2048 sc1
M a[72:75], a[164:167], v[40:43], a[72:75]
buffer_load_dwordx4 a[220:223], v1, s[44:47], s25 offen offset:3072 sc1
s_add_u32 s25, s25, 16384
s_add_u32 s26, s26, 131072
M a[72:75], a[168:171], v[72:75], a[72:75]
s_add_u32 m0, s42, 98304
s_nop 0
buffer_load_dwordx4 v99, s[48:51], s26 offen offset:0 lds
buffer_load_dwordx4 v100, s[48:51], s26 offen offset:1024 lds
M a[76:79], a[168:171], v[76:79], a[76:79]
buffer_load_dwordx4 a[224:227], v1, s[44:47], s25 offen offset:0 sc1
M a[76:79], a[164:167], v[44:47], a[76:79]
buffer_load_dwordx4 a[228:231], v1, s[44:47], s25 offen offset:1024 sc1
buffer_load_dwordx4 a[232:235], v1, s[44:47], s25 offen offset:2048 sc1
M a[80:83], a[172:175], v[32:35], a[80:83]
buffer_load_dwordx4 a[236:239], v1, s[44:47], s25 offen offset:3072 sc1
s_add_u32 s25, s25, 16384
s_add_u32 s26, s26, 131072
M a[80:83], a[176:179], v[64:67], a[80:83]
s_add_u32 m0, s42, 114688
s_nop 0
buffer_load_dwordx4 v99, s[48:51], s26 offen offset:0 lds
buffer_load_dwordx4 v100, s[48:51], s26 offen offset:1024 lds
M a[84:87], a[176:179], v[68:71], a[84:87]
buffer_load_dwordx4 a[240:243], v1, s[44:47], s25 offen offset:0 sc1
buffer_load_dwordx4 a[244:247], v1, s[44:47], s25 offen offset:1024 sc1
M a[84:87], a[172:175], v[36:39], a[84:87]
buffer_load_dwordx4 a[248:251], v1, s[44:47], s25 offen offset:2048 sc1
buffer_load_dwordx4 a[252:255], v1, s[44:47], s25 offen offset:3072 sc1
M a[88:91], a[172:175], v[40:43], a[88:91]
s_add_u32 s25, s25, 16384
s_add_u32 s26, s26, 131072
s_add_u32 m0, s42, 0
s_nop 0
buffer_load_dwordx4 v99, s[48:51], s26 offen offset:0 lds
M a[88:91], a[176:179], v[72:75], a[88:91]
buffer_load_dwordx4 v100, s[48:51], s26 offen offset:1024 lds
buffer_load_dwordx4 a[128:131], v1, s[44:47], s25 offen offset:0 sc1
M a[92:95], a[176:179], v[76:79], a[92:95]
buffer_load_dwordx4 a[132:135], v1, s[44:47], s25 offen offset:1024 sc1
buffer_load_dwordx4 a[136:139], v1, s[44:47], s25 offen offset:2048 sc1
M a[92:95], a[172:175], v[44:47], a[92:95]
buffer_load_dwordx4 a[140:143], v1, s[44:47], s25 offen offset:3072 sc1
s_add_u32 s25, s25, 16384
s_add_u32 s26, s26, 131072
Lk2_merge:
s_lshl_b32 s33, s23, 14
s_add_u32 s34, s33, 131072
s_add_u32 s33, s33, 32768
s_cmp_eq_u32 s24, 0
s_cselect_b32 s35, s34, s33
s_cselect_b32 s36, s33, s34
v_add_u32 v2, s35, v1
v_add_u32 v3, s36, v1
s_lshl_b32 s33, s22, 10
s_add_u32 s33, s33, 28672
s_xor_b32 s34, s33, 2048
v_add_u32 v14, s33, v1
v_add_u32 v15, s34, v1
v_accvgpr_read_b32 v20, a96
v_accvgpr_read_b32 v21, a100
v_accvgpr_read_b32 v22, a104
v_accvgpr_read_b32 v23, a108
ds_write_b128 v14, v[20:23]
s_cmp_eq_u32 s24, 1
s_waitcnt lgkmcnt(0)
s_cbranch_scc1 Lk2_mg1
ds_write_b128 v2, v[224:227] offset:0
ds_write_b128 v2, v[228:231] offset:1024
ds_write_b128 v2, v[232:235] offset:2048
ds_write_b128 v2, v[236:239] offset:3072
ds_write_b128 v2, v[240:243] offset:4096
ds_write_b128 v2, v[244:247] offset:5120
ds_write_b128 v2, v[248:251] offset:6144
ds_write_b128 v2, v[252:255] offset:7168
ds_write_b128 v2, a[64:67] offset:8192
ds_write_b128 v2, a[68:71] offset:9216
ds_write_b128 v2, a[72:75] offset:10240
ds_write_b128 v2, a[76:79] offset:11264
ds_write_b128 v2, a[80:83] offset:12288
ds_write_b128 v2, a[84:87] offset:13312
ds_write_b128 v2, a[88:91] offset:14336
ds_write_b128 v2, a[92:95] offset:15360
s_waitcnt lgkmcnt(0)
s_barrier
ds_read_b128 v[28:31], v15
ds_read_b128 v[32:35], v3 offset:0
ds_read_b128 v[36:39], v3 offset:1024
ds_read_b128 v[40:43], v3 offset:2048
ds_read_b128 v[44:47], v3 offset:3072
ds_read_b128 v[48:51], v3 offset:4096
ds_read_b128 v[52:55], v3 offset:5120
ds_read_b128 v[56:59], v3 offset:6144
ds_read_b128 v[60:63], v3 offset:7168
ds_read_b128 v[64:67], v3 offset:8192
ds_read_b128 v[68:71], v3 offset:9216
ds_read_b128 v[72:75], v3 offset:10240
ds_read_b128 v[76:79], v3 offset:11264
ds_read_b128 v[80:83], v3 offset:12288
ds_read_b128 v[84:87], v3 offset:13312
ds_read_b128 v[88:91], v3 offset:14336
ds_read_b128 v[92:95], v3 offset:15360
s_waitcnt lgkmcnt(15)
v_add_f32 v20, v20, v28
v_add_f32 v21, v21, v29
v_add_f32 v22, v22, v30
v_add_f32 v23, v23, v31
s_sub_u32 s35, 15, s21
v_rcp_f32 v8, v20
v_rcp_f32 v9, v21
v_rcp_f32 v10, v22
v_rcp_f32 v11, v23
v_subrev_u32 v20, 0x21800000, v20
v_subrev_u32 v21, 0x21800000, v21
v_subrev_u32 v22, 0x21800000, v22
v_subrev_u32 v23, 0x21800000, v23
v_max_u32 v12, v20, v21
v_max3_u32 v12, v12, v22, v23
s_mov_b32 s64, 0x207
v_pk_add_f32 v[160:161], v[160:161], v[32:33]
v_pk_add_f32 v[162:163], v[162:163], v[34:35]
s_waitcnt lgkmcnt(11)
v_pk_add_f32 v[176:177], v[176:177], v[48:49]
v_pk_add_f32 v[178:179], v[178:179], v[50:51]
v_pk_mul_f32 v[160:161], v[160:161], v[8:9] op_sel:[0,0] op_sel_hi:[1,0]
v_pk_mul_f32 v[162:163], v[162:163], v[8:9] op_sel:[0,0] op_sel_hi:[1,0]
v_pk_mul_f32 v[176:177], v[176:177], v[8:9] op_sel:[0,0] op_sel_hi:[1,0]
v_pk_mul_f32 v[178:179], v[178:179], v[8:9] op_sel:[0,0] op_sel_hi:[1,0]
v_cvt_pk_bf16_f32 v160, v160, v161
v_cvt_pk_bf16_f32 v161, v162, v163
v_cvt_pk_bf16_f32 v162, v176, v177
v_cvt_pk_bf16_f32 v163, v178, v179
v_pk_add_f32 v[164:165], v[164:165], v[36:37]
v_pk_add_f32 v[166:167], v[166:167], v[38:39]
s_waitcnt lgkmcnt(10)
v_pk_add_f32 v[180:181], v[180:181], v[52:53]
v_pk_add_f32 v[182:183], v[182:183], v[54:55]
M v[24:27], a[112:115], v[160:163], 0
v_pk_mul_f32 v[164:165], v[164:165], v[8:9] op_sel:[0,1] op_sel_hi:[1,1]
v_pk_mul_f32 v[166:167], v[166:167], v[8:9] op_sel:[0,1] op_sel_hi:[1,1]
v_pk_mul_f32 v[180:181], v[180:181], v[8:9] op_sel:[0,1] op_sel_hi:[1,1]
v_pk_mul_f32 v[182:183], v[182:183], v[8:9] op_sel:[0,1] op_sel_hi:[1,1]
v_cvt_pk_bf16_f32 v164, v164, v165
v_cvt_pk_bf16_f32 v165, v166, v167
v_cvt_pk_bf16_f32 v166, v180, v181
v_cvt_pk_bf16_f32 v167, v182, v183
v_pk_add_f32 v[168:169], v[168:169], v[40:41]
v_pk_add_f32 v[170:171], v[170:171], v[42:43]
s_waitcnt lgkmcnt(9)
v_pk_add_f32 v[184:185], v[184:185], v[56:57]
v_pk_add_f32 v[186:187], v[186:187], v[58:59]
M v[24:27], a[112:115], v[164:167], v[24:27]
v_pk_mul_f32 v[168:169], v[168:169], v[10:11] op_sel:[0,0] op_sel_hi:[1,0]
v_pk_mul_f32 v[170:171], v[170:171], v[10:11] op_sel:[0,0] op_sel_hi:[1,0]
v_pk_mul_f32 v[184:185], v[184:185], v[10:11] op_sel:[0,0] op_sel_hi:[1,0]
v_pk_mul_f32 v[186:187], v[186:187], v[10:11] op_sel:[0,0] op_sel_hi:[1,0]
v_cvt_pk_bf16_f32 v168, v168, v169
v_cvt_pk_bf16_f32 v169, v170, v171
v_cvt_pk_bf16_f32 v170, v184, v185
v_cvt_pk_bf16_f32 v171, v186, v187
v_pk_add_f32 v[172:173], v[172:173], v[44:45]
v_pk_add_f32 v[174:175], v[174:175], v[46:47]
s_waitcnt lgkmcnt(8)
v_pk_add_f32 v[188:189], v[188:189], v[60:61]
v_pk_add_f32 v[190:191], v[190:191], v[62:63]
M v[24:27], a[112:115], v[168:171], v[24:27]
v_pk_mul_f32 v[172:173], v[172:173], v[10:11] op_sel:[0,1] op_sel_hi:[1,1]
v_pk_mul_f32 v[174:175], v[174:175], v[10:11] op_sel:[0,1] op_sel_hi:[1,1]
v_pk_mul_f32 v[188:189], v[188:189], v[10:11] op_sel:[0,1] op_sel_hi:[1,1]
v_pk_mul_f32 v[190:191], v[190:191], v[10:11] op_sel:[0,1] op_sel_hi:[1,1]
v_cvt_pk_bf16_f32 v172, v172, v173
v_cvt_pk_bf16_f32 v173, v174, v175
v_cvt_pk_bf16_f32 v174, v188, v189
v_cvt_pk_bf16_f32 v175, v190, v191
s_waitcnt lgkmcnt(7)
v_pk_add_f32 v[192:193], v[192:193], v[64:65]
v_pk_add_f32 v[194:195], v[194:195], v[66:67]
s_waitcnt lgkmcnt(3)
v_pk_add_f32 v[208:209], v[208:209], v[80:81]
v_pk_add_f32 v[210:211], v[210:211], v[82:83]
M v[24:27], a[112:115], v[172:175], v[24:27]
v_pk_mul_f32 v[192:193], v[192:193], v[8:9] op_sel:[0,0] op_sel_hi:[1,0]
v_pk_mul_f32 v[194:195], v[194:195], v[8:9] op_sel:[0,0] op_sel_hi:[1,0]
v_pk_mul_f32 v[208:209], v[208:209], v[8:9] op_sel:[0,0] op_sel_hi:[1,0]
v_pk_mul_f32 v[210:211], v[210:211], v[8:9] op_sel:[0,0] op_sel_hi:[1,0]
v_cvt_pk_bf16_f32 v192, v192, v193
v_cvt_pk_bf16_f32 v193, v194, v195
v_cvt_pk_bf16_f32 v194, v208, v209
v_cvt_pk_bf16_f32 v195, v210, v211
v_pk_add_f32 v[196:197], v[196:197], v[68:69]
v_pk_add_f32 v[198:199], v[198:199], v[70:71]
s_waitcnt lgkmcnt(2)
v_pk_add_f32 v[212:213], v[212:213], v[84:85]
v_pk_add_f32 v[214:215], v[214:215], v[86:87]
M v[24:27], a[112:115], v[192:195], v[24:27]
v_pk_mul_f32 v[196:197], v[196:197], v[8:9] op_sel:[0,1] op_sel_hi:[1,1]
v_pk_mul_f32 v[198:199], v[198:199], v[8:9] op_sel:[0,1] op_sel_hi:[1,1]
v_pk_mul_f32 v[212:213], v[212:213], v[8:9] op_sel:[0,1] op_sel_hi:[1,1]
v_pk_mul_f32 v[214:215], v[214:215], v[8:9] op_sel:[0,1] op_sel_hi:[1,1]
v_cvt_pk_bf16_f32 v196, v196, v197
v_cvt_pk_bf16_f32 v197, v198, v199
v_cvt_pk_bf16_f32 v198, v212, v213
v_cvt_pk_bf16_f32 v199, v214, v215
v_pk_add_f32 v[200:201], v[200:201], v[72:73]
v_pk_add_f32 v[202:203], v[202:203], v[74:75]
s_waitcnt lgkmcnt(1)
v_pk_add_f32 v[216:217], v[216:217], v[88:89]
v_pk_add_f32 v[218:219], v[218:219], v[90:91]
M v[24:27], a[112:115], v[196:199], v[24:27]
v_pk_mul_f32 v[200:201], v[200:201], v[10:11] op_sel:[0,0] op_sel_hi:[1,0]
v_pk_mul_f32 v[202:203], v[202:203], v[10:11] op_sel:[0,0] op_sel_hi:[1,0]
v_pk_mul_f32 v[216:217], v[216:217], v[10:11] op_sel:[0,0] op_sel_hi:[1,0]
v_pk_mul_f32 v[218:219], v[218:219], v[10:11] op_sel:[0,0] op_sel_hi:[1,0]
v_cvt_pk_bf16_f32 v200, v200, v201
v_cvt_pk_bf16_f32 v201, v202, v203
v_cvt_pk_bf16_f32 v202, v216, v217
v_cvt_pk_bf16_f32 v203, v218, v219
v_pk_add_f32 v[204:205], v[204:205], v[76:77]
v_pk_add_f32 v[206:207], v[206:207], v[78:79]
s_waitcnt lgkmcnt(0)
v_pk_add_f32 v[220:221], v[220:221], v[92:93]
v_pk_add_f32 v[222:223], v[222:223], v[94:95]
M v[24:27], a[112:115], v[200:203], v[24:27]
v_pk_mul_f32 v[204:205], v[204:205], v[10:11] op_sel:[0,1] op_sel_hi:[1,1]
v_pk_mul_f32 v[206:207], v[206:207], v[10:11] op_sel:[0,1] op_sel_hi:[1,1]
v_pk_mul_f32 v[220:221], v[220:221], v[10:11] op_sel:[0,1] op_sel_hi:[1,1]
v_pk_mul_f32 v[222:223], v[222:223], v[10:11] op_sel:[0,1] op_sel_hi:[1,1]
v_cvt_pk_bf16_f32 v204, v204, v205
v_cvt_pk_bf16_f32 v205, v206, v207
v_cvt_pk_bf16_f32 v206, v220, v221
v_cvt_pk_bf16_f32 v207, v222, v223
s_nop 1
M v[24:27], a[112:115], v[204:207], v[24:27]
v_cmp_lt_u32 vcc, 0x3c000000, v12
s_nop 6
v_cmp_class_f32 s[40:41], v24, s64
s_nop 0
s_or_b64 vcc, vcc, s[40:41]
s_cbranch_vccnz Lbad_3
s_lshl_b32 s33, s35, 20
s_lshl_b32 s34, s20, 15
s_add_u32 s33, s33, s34
s_lshl_b32 s34, s23, 13
s_add_u32 s36, s33, s34
s_add_u32 s37, s36, 4096
s_add_u32 s38, s36, 16384
s_add_u32 s39, s36, 20480
buffer_store_dwordx4 v[160:163], v1, s[16:19], s36 offen offset:0 sc1
buffer_store_dwordx4 v[164:167], v1, s[16:19], s36 offen offset:2048 sc1
buffer_store_dwordx4 v[168:171], v1, s[16:19], s37 offen offset:0 sc1
buffer_store_dwordx4 v[172:175], v1, s[16:19], s37 offen offset:2048 sc1
buffer_store_dwordx4 v[192:195], v1, s[16:19], s36 offen offset:1024 sc1
buffer_store_dwordx4 v[196:199], v1, s[16:19], s36 offen offset:3072 sc1
buffer_store_dwordx4 v[200:203], v1, s[16:19], s37 offen offset:1024 sc1
buffer_store_dwordx4 v[204:207], v1, s[16:19], s37 offen offset:3072 sc1
s_branch Lfd_4
Lbad_3:
s_or_b32 s60, s60, 2
Lfd_4:
s_branch Lk2_chk
Lk2_mg1:
ds_write_b128 v2, v[160:163] offset:0
ds_write_b128 v2, v[164:167] offset:1024
ds_write_b128 v2, v[168:171] offset:2048
ds_write_b128 v2, v[172:175] offset:3072
ds_write_b128 v2, v[176:179] offset:4096
ds_write_b128 v2, v[180:183] offset:5120
ds_write_b128 v2, v[184:187] offset:6144
ds_write_b128 v2, v[188:191] offset:7168
ds_write_b128 v2, v[192:195] offset:8192
ds_write_b128 v2, v[196:199] offset:9216
ds_write_b128 v2, v[200:203] offset:10240
ds_write_b128 v2, v[204:207] offset:11264
ds_write_b128 v2, v[208:211] offset:12288
ds_write_b128 v2, v[212:215] offset:13312
ds_write_b128 v2, v[216:219] offset:14336
ds_write_b128 v2, v[220:223] offset:15360
s_waitcnt lgkmcnt(0)
s_barrier
ds_read_b128 v[28:31], v15
ds_read_b128 v[32:35], v3 offset:0
ds_read_b128 v[36:39], v3 offset:1024
ds_read_b128 v[40:43], v3 offset:2048
ds_read_b128 v[44:47], v3 offset:3072
ds_read_b128 v[48:51], v3 offset:4096
ds_read_b128 v[52:55], v3 offset:5120
ds_read_b128 v[56:59], v3 offset:6144
ds_read_b128 v[60:63], v3 offset:7168
ds_read_b128 v[64:67], v3 offset:8192
ds_read_b128 v[68:71], v3 offset:9216
ds_read_b128 v[72:75], v3 offset:10240
ds_read_b128 v[76:79], v3 offset:11264
ds_read_b128 v[80:83], v3 offset:12288
ds_read_b128 v[84:87], v3 offset:13312
ds_read_b128 v[88:91], v3 offset:14336
ds_read_b128 v[92:95], v3 offset:15360
s_waitcnt lgkmcnt(15)
v_add_f32 v20, v20, v28
v_add_f32 v21, v21, v29
v_add_f32 v22, v22, v30
v_add_f32 v23, v23, v31
s_sub_u32 s35, 15, s21
v_rcp_f32 v8, v20
v_rcp_f32 v9, v21
v_rcp_f32 v10, v22
v_rcp_f32 v11, v23
v_subrev_u32 v20, 0x21800000, v20
v_subrev_u32 v21, 0x21800000, v21
v_subrev_u32 v22, 0x21800000, v22
v_subrev_u32 v23, 0x21800000, v23
v_max_u32 v12, v20, v21
v_max3_u32 v12, v12, v22, v23
s_mov_b32 s64, 0x207
v_pk_add_f32 v[224:225], v[224:225], v[32:33]
v_pk_add_f32 v[226:227], v[226:227], v[34:35]
s_waitcnt lgkmcnt(11)
v_pk_add_f32 v[240:241], v[240:241], v[48:49]
v_pk_add_f32 v[242:243], v[242:243], v[50:51]
v_pk_mul_f32 v[224:225], v[224:225], v[8:9] op_sel:[0,0] op_sel_hi:[1,0]
v_pk_mul_f32 v[226:227], v[226:227], v[8:9] op_sel:[0,0] op_sel_hi:[1,0]
v_pk_mul_f32 v[240:241], v[240:241], v[8:9] op_sel:[0,0] op_sel_hi:[1,0]
v_pk_mul_f32 v[242:243], v[242:243], v[8:9] op_sel:[0,0] op_sel_hi:[1,0]
v_cvt_pk_bf16_f32 v224, v224, v225
v_cvt_pk_bf16_f32 v225, v226, v227
v_cvt_pk_bf16_f32 v226, v240, v241
v_cvt_pk_bf16_f32 v227, v242, v243
v_pk_add_f32 v[228:229], v[228:229], v[36:37]
v_pk_add_f32 v[230:231], v[230:231], v[38:39]
s_waitcnt lgkmcnt(10)
v_pk_add_f32 v[244:245], v[244:245], v[52:53]
v_pk_add_f32 v[246:247], v[246:247], v[54:55]
M v[24:27], a[112:115], v[224:227], 0
v_pk_mul_f32 v[228:229], v[228:229], v[8:9] op_sel:[0,1] op_sel_hi:[1,1]
v_pk_mul_f32 v[230:231], v[230:231], v[8:9] op_sel:[0,1] op_sel_hi:[1,1]
v_pk_mul_f32 v[244:245], v[244:245], v[8:9] op_sel:[0,1] op_sel_hi:[1,1]
v_pk_mul_f32 v[246:247], v[246:247], v[8:9] op_sel:[0,1] op_sel_hi:[1,1]
v_cvt_pk_bf16_f32 v228, v228, v229
v_cvt_pk_bf16_f32 v229, v230, v231
v_cvt_pk_bf16_f32 v230, v244, v245
v_cvt_pk_bf16_f32 v231, v246, v247
v_pk_add_f32 v[232:233], v[232:233], v[40:41]
v_pk_add_f32 v[234:235], v[234:235], v[42:43]
s_waitcnt lgkmcnt(9)
v_pk_add_f32 v[248:249], v[248:249], v[56:57]
v_pk_add_f32 v[250:251], v[250:251], v[58:59]
M v[24:27], a[112:115], v[228:231], v[24:27]
v_pk_mul_f32 v[232:233], v[232:233], v[10:11] op_sel:[0,0] op_sel_hi:[1,0]
v_pk_mul_f32 v[234:235], v[234:235], v[10:11] op_sel:[0,0] op_sel_hi:[1,0]
v_pk_mul_f32 v[248:249], v[248:249], v[10:11] op_sel:[0,0] op_sel_hi:[1,0]
v_pk_mul_f32 v[250:251], v[250:251], v[10:11] op_sel:[0,0] op_sel_hi:[1,0]
v_cvt_pk_bf16_f32 v232, v232, v233
v_cvt_pk_bf16_f32 v233, v234, v235
v_cvt_pk_bf16_f32 v234, v248, v249
v_cvt_pk_bf16_f32 v235, v250, v251
v_pk_add_f32 v[236:237], v[236:237], v[44:45]
v_pk_add_f32 v[238:239], v[238:239], v[46:47]
s_waitcnt lgkmcnt(8)
v_pk_add_f32 v[252:253], v[252:253], v[60:61]
v_pk_add_f32 v[254:255], v[254:255], v[62:63]
M v[24:27], a[112:115], v[232:235], v[24:27]
v_pk_mul_f32 v[236:237], v[236:237], v[10:11] op_sel:[0,1] op_sel_hi:[1,1]
v_pk_mul_f32 v[238:239], v[238:239], v[10:11] op_sel:[0,1] op_sel_hi:[1,1]
v_pk_mul_f32 v[252:253], v[252:253], v[10:11] op_sel:[0,1] op_sel_hi:[1,1]
v_pk_mul_f32 v[254:255], v[254:255], v[10:11] op_sel:[0,1] op_sel_hi:[1,1]
v_cvt_pk_bf16_f32 v236, v236, v237
v_cvt_pk_bf16_f32 v237, v238, v239
v_cvt_pk_bf16_f32 v238, v252, v253
v_cvt_pk_bf16_f32 v239, v254, v255
v_accvgpr_read_b32 v32, a64
v_accvgpr_read_b32 v33, a65
v_accvgpr_read_b32 v34, a66
v_accvgpr_read_b32 v35, a67
s_waitcnt lgkmcnt(7)
v_pk_add_f32 v[32:33], v[32:33], v[64:65]
v_pk_add_f32 v[34:35], v[34:35], v[66:67]
v_accvgpr_read_b32 v48, a80
v_accvgpr_read_b32 v49, a81
v_accvgpr_read_b32 v50, a82
v_accvgpr_read_b32 v51, a83
s_waitcnt lgkmcnt(3)
v_pk_add_f32 v[48:49], v[48:49], v[80:81]
v_pk_add_f32 v[50:51], v[50:51], v[82:83]
M v[24:27], a[112:115], v[236:239], v[24:27]
v_pk_mul_f32 v[32:33], v[32:33], v[8:9] op_sel:[0,0] op_sel_hi:[1,0]
v_pk_mul_f32 v[34:35], v[34:35], v[8:9] op_sel:[0,0] op_sel_hi:[1,0]
v_pk_mul_f32 v[48:49], v[48:49], v[8:9] op_sel:[0,0] op_sel_hi:[1,0]
v_pk_mul_f32 v[50:51], v[50:51], v[8:9] op_sel:[0,0] op_sel_hi:[1,0]
v_cvt_pk_bf16_f32 v32, v32, v33
v_cvt_pk_bf16_f32 v33, v34, v35
v_cvt_pk_bf16_f32 v34, v48, v49
v_cvt_pk_bf16_f32 v35, v50, v51
v_accvgpr_read_b32 v240, a68
v_accvgpr_read_b32 v241, a69
v_accvgpr_read_b32 v242, a70
v_accvgpr_read_b32 v243, a71
v_pk_add_f32 v[240:241], v[240:241], v[68:69]
v_pk_add_f32 v[242:243], v[242:243], v[70:71]
v_accvgpr_read_b32 v36, a84
v_accvgpr_read_b32 v37, a85
v_accvgpr_read_b32 v38, a86
v_accvgpr_read_b32 v39, a87
s_waitcnt lgkmcnt(2)
v_pk_add_f32 v[36:37], v[36:37], v[84:85]
v_pk_add_f32 v[38:39], v[38:39], v[86:87]
M v[24:27], a[112:115], v[32:35], v[24:27]
v_pk_mul_f32 v[240:241], v[240:241], v[8:9] op_sel:[0,1] op_sel_hi:[1,1]
v_pk_mul_f32 v[242:243], v[242:243], v[8:9] op_sel:[0,1] op_sel_hi:[1,1]
v_pk_mul_f32 v[36:37], v[36:37], v[8:9] op_sel:[0,1] op_sel_hi:[1,1]
v_pk_mul_f32 v[38:39], v[38:39], v[8:9] op_sel:[0,1] op_sel_hi:[1,1]
v_cvt_pk_bf16_f32 v240, v240, v241
v_cvt_pk_bf16_f32 v241, v242, v243
v_cvt_pk_bf16_f32 v242, v36, v37
v_cvt_pk_bf16_f32 v243, v38, v39
v_accvgpr_read_b32 v52, a72
v_accvgpr_read_b32 v53, a73
v_accvgpr_read_b32 v54, a74
v_accvgpr_read_b32 v55, a75
v_pk_add_f32 v[52:53], v[52:53], v[72:73]
v_pk_add_f32 v[54:55], v[54:55], v[74:75]
v_accvgpr_read_b32 v244, a88
v_accvgpr_read_b32 v245, a89
v_accvgpr_read_b32 v246, a90
v_accvgpr_read_b32 v247, a91
s_waitcnt lgkmcnt(1)
v_pk_add_f32 v[244:245], v[244:245], v[88:89]
v_pk_add_f32 v[246:247], v[246:247], v[90:91]
M v[24:27], a[112:115], v[240:243], v[24:27]
v_pk_mul_f32 v[52:53], v[52:53], v[10:11] op_sel:[0,0] op_sel_hi:[1,0]
v_pk_mul_f32 v[54:55], v[54:55], v[10:11] op_sel:[0,0] op_sel_hi:[1,0]
v_pk_mul_f32 v[244:245], v[244:245], v[10:11] op_sel:[0,0] op_sel_hi:[1,0]
v_pk_mul_f32 v[246:247], v[246:247], v[10:11] op_sel:[0,0] op_sel_hi:[1,0]
v_cvt_pk_bf16_f32 v52, v52, v53
v_cvt_pk_bf16_f32 v53, v54, v55
v_cvt_pk_bf16_f32 v54, v244, v245
v_cvt_pk_bf16_f32 v55, v246, v247
v_accvgpr_read_b32 v40, a76
v_accvgpr_read_b32 v41, a77
v_accvgpr_read_b32 v42, a78
v_accvgpr_read_b32 v43, a79
v_pk_add_f32 v[40:41], v[40:41], v[76:77]
v_pk_add_f32 v[42:43], v[42:43], v[78:79]
v_accvgpr_read_b32 v56, a92
v_accvgpr_read_b32 v57, a93
v_accvgpr_read_b32 v58, a94
v_accvgpr_read_b32 v59, a95
s_waitcnt lgkmcnt(0)
v_pk_add_f32 v[56:57], v[56:57], v[92:93]
v_pk_add_f32 v[58:59], v[58:59], v[94:95]
M v[24:27], a[112:115], v[52:55], v[24:27]
v_pk_mul_f32 v[40:41], v[40:41], v[10:11] op_sel:[0,1] op_sel_hi:[1,1]
v_pk_mul_f32 v[42:43], v[42:43], v[10:11] op_sel:[0,1] op_sel_hi:[1,1]
v_pk_mul_f32 v[56:57], v[56:57], v[10:11] op_sel:[0,1] op_sel_hi:[1,1]
v_pk_mul_f32 v[58:59], v[58:59], v[10:11] op_sel:[0,1] op_sel_hi:[1,1]
v_cvt_pk_bf16_f32 v40, v40, v41
v_cvt_pk_bf16_f32 v41, v42, v43
v_cvt_pk_bf16_f32 v42, v56, v57
v_cvt_pk_bf16_f32 v43, v58, v59
s_nop 1
M v[24:27], a[112:115], v[40:43], v[24:27]
v_cmp_lt_u32 vcc, 0x3c000000, v12
s_nop 6
v_cmp_class_f32 s[40:41], v24, s64
s_nop 0
s_or_b64 vcc, vcc, s[40:41]
s_cbranch_vccnz Lbad_5
s_lshl_b32 s33, s35, 20
s_lshl_b32 s34, s20, 15
s_add_u32 s33, s33, s34
s_lshl_b32 s34, s23, 13
s_add_u32 s36, s33, s34
s_add_u32 s37, s36, 4096
s_add_u32 s38, s36, 16384
s_add_u32 s39, s36, 20480
buffer_store_dwordx4 v[224:227], v1, s[16:19], s38 offen offset:0 sc1
buffer_store_dwordx4 v[228:231], v1, s[16:19], s38 offen offset:2048 sc1
buffer_store_dwordx4 v[232:235], v1, s[16:19], s39 offen offset:0 sc1
buffer_store_dwordx4 v[236:239], v1, s[16:19], s39 offen offset:2048 sc1
buffer_store_dwordx4 v[32:35], v1, s[16:19], s38 offen offset:1024 sc1
buffer_store_dwordx4 v[240:243], v1, s[16:19], s38 offen offset:3072 sc1
buffer_store_dwordx4 v[52:55], v1, s[16:19], s39 offen offset:1024 sc1
buffer_store_dwordx4 v[40:43], v1, s[16:19], s39 offen offset:3072 sc1
s_branch Lfd_6
Lbad_5:
s_or_b32 s60, s60, 2
Lfd_6:
Lk2_chk:
s_cmp_eq_u32 s60, 0
s_cbranch_scc1 Lk2_done
s_sub_u32 s56, 15, s21
s_lshl_b32 s33, s24, 1
s_lshl_b32 s61, 3, s33
s_and_b32 s34, s60, 2
s_bitcmp1_b32 s60, 0
s_cselect_b32 s56, s21, s56
s_cselect_b32 s61, 15, s61
s_cselect_b32 s60, s34, 0
s_waitcnt vmcnt(0)
s_lshl_b32 s33, s20, 7
s_lshl_b32 s34, s56, 3
s_add_u32 s33, s33, s34
s_lshl_b32 s34, s23, 2
s_add_u32 s33, s33, s34
s_lshl_b32 s33, s33, 12
buffer_load_dwordx4 a[0:3], v1, s[8:11], s33 offen offset:0 sc1
buffer_load_dwordx4 a[4:7], v1, s[8:11], s33 offen offset:1024 sc1
buffer_load_dwordx4 a[8:11], v1, s[8:11], s33 offen offset:2048 sc1
buffer_load_dwordx4 a[12:15], v1, s[8:11], s33 offen offset:3072 sc1
s_add_u32 s33, s33, 4096
buffer_load_dwordx4 a[16:19], v1, s[8:11], s33 offen offset:0 sc1
buffer_load_dwordx4 a[20:23], v1, s[8:11], s33 offen offset:1024 sc1
buffer_load_dwordx4 a[24:27], v1, s[8:11], s33 offen offset:2048 sc1
buffer_load_dwordx4 a[28:31], v1, s[8:11], s33 offen offset:3072 sc1
s_add_u32 s33, s33, 4096
buffer_load_dwordx4 a[32:35], v1, s[8:11], s33 offen offset:0 sc1
buffer_load_dwordx4 a[36:39], v1, s[8:11], s33 offen offset:1024 sc1
buffer_load_dwordx4 a[40:43], v1, s[8:11], s33 offen offset:2048 sc1
buffer_load_dwordx4 a[44:47], v1, s[8:11], s33 offen offset:3072 sc1
s_add_u32 s33, s33, 4096
buffer_load_dwordx4 a[48:51], v1, s[8:11], s33 offen offset:0 sc1
buffer_load_dwordx4 a[52:55], v1, s[8:11], s33 offen offset:1024 sc1
buffer_load_dwordx4 a[56:59], v1, s[8:11], s33 offen offset:2048 sc1
buffer_load_dwordx4 a[60:63], v1, s[8:11], s33 offen offset:3072 sc1
v_accvgpr_write_b32 a64, 0
v_accvgpr_write_b32 a65, 0
v_accvgpr_write_b32 a66, 0
v_accvgpr_write_b32 a67, 0
v_accvgpr_write_b32 a68, 0
v_accvgpr_write_b32 a69, 0
v_accvgpr_write_b32 a70, 0
v_accvgpr_write_b32 a71, 0
v_accvgpr_write_b32 a72, 0
v_accvgpr_write_b32 a73, 0
v_accvgpr_write_b32 a74, 0
v_accvgpr_write_b32 a75, 0
v_accvgpr_write_b32 a76, 0
v_accvgpr_write_b32 a77, 0
v_accvgpr_write_b32 a78, 0
v_accvgpr_write_b32 a79, 0
v_accvgpr_write_b32 a80, 0
v_accvgpr_write_b32 a81, 0
v_accvgpr_write_b32 a82, 0
v_accvgpr_write_b32 a83, 0
v_accvgpr_write_b32 a84, 0
v_accvgpr_write_b32 a85, 0
v_accvgpr_write_b32 a86, 0
v_accvgpr_write_b32 a87, 0
v_accvgpr_write_b32 a88, 0
v_accvgpr_write_b32 a89, 0
v_accvgpr_write_b32 a90, 0
v_accvgpr_write_b32 a91, 0
v_accvgpr_write_b32 a92, 0
v_accvgpr_write_b32 a93, 0
v_accvgpr_write_b32 a94, 0
v_accvgpr_write_b32 a95, 0
v_accvgpr_write_b32 a96, 0
v_accvgpr_write_b32 a97, 0
v_accvgpr_write_b32 a98, 0
v_accvgpr_write_b32 a99, 0
v_accvgpr_write_b32 a100, 0
v_accvgpr_write_b32 a101, 0
v_accvgpr_write_b32 a102, 0
v_accvgpr_write_b32 a103, 0
v_accvgpr_write_b32 a104, 0
v_accvgpr_write_b32 a105, 0
v_accvgpr_write_b32 a106, 0
v_accvgpr_write_b32 a107, 0
v_accvgpr_write_b32 a108, 0
v_accvgpr_write_b32 a109, 0
v_accvgpr_write_b32 a110, 0
v_accvgpr_write_b32 a111, 0
v_mov_b32 v160, 0
v_mov_b32 v161, 0
v_mov_b32 v162, 0
v_mov_b32 v163, 0
v_mov_b32 v164, 0
v_mov_b32 v165, 0
v_mov_b32 v166, 0
v_mov_b32 v167, 0
v_mov_b32 v168, 0
v_mov_b32 v169, 0
v_mov_b32 v170, 0
v_mov_b32 v171, 0
v_mov_b32 v172, 0
v_mov_b32 v173, 0
v_mov_b32 v174, 0
v_mov_b32 v175, 0
v_mov_b32 v176, 0
v_mov_b32 v177, 0
v_mov_b32 v178, 0
v_mov_b32 v179, 0
v_mov_b32 v180, 0
v_mov_b32 v181, 0
v_mov_b32 v182, 0
v_mov_b32 v183, 0
v_mov_b32 v184, 0
v_mov_b32 v185, 0
v_mov_b32 v186, 0
v_mov_b32 v187, 0
v_mov_b32 v188, 0
v_mov_b32 v189, 0
v_mov_b32 v190, 0
v_mov_b32 v191, 0
v_mov_b32 v192, 0
v_mov_b32 v193, 0
v_mov_b32 v194, 0
v_mov_b32 v195, 0
v_mov_b32 v196, 0
v_mov_b32 v197, 0
v_mov_b32 v198, 0
v_mov_b32 v199, 0
v_mov_b32 v200, 0
v_mov_b32 v201, 0
v_mov_b32 v202, 0
v_mov_b32 v203, 0
v_mov_b32 v204, 0
v_mov_b32 v205, 0
v_mov_b32 v206, 0
v_mov_b32 v207, 0
v_mov_b32 v208, 0
v_mov_b32 v209, 0
v_mov_b32 v210, 0
v_mov_b32 v211, 0
v_mov_b32 v212, 0
v_mov_b32 v213, 0
v_mov_b32 v214, 0
v_mov_b32 v215, 0
v_mov_b32 v216, 0
v_mov_b32 v217, 0
v_mov_b32 v218, 0
v_mov_b32 v219, 0
v_mov_b32 v220, 0
v_mov_b32 v221, 0
v_mov_b32 v222, 0
v_mov_b32 v223, 0
v_mov_b32 v224, 0
v_mov_b32 v225, 0
v_mov_b32 v226, 0
v_mov_b32 v227, 0
v_mov_b32 v228, 0
v_mov_b32 v229, 0
v_mov_b32 v230, 0
v_mov_b32 v231, 0
v_mov_b32 v232, 0
v_mov_b32 v233, 0
v_mov_b32 v234, 0
v_mov_b32 v235, 0
v_mov_b32 v236, 0
v_mov_b32 v237, 0
v_mov_b32 v238, 0
v_mov_b32 v239, 0
v_mov_b32 v240, 0
v_mov_b32 v241, 0
v_mov_b32 v242, 0
v_mov_b32 v243, 0
v_mov_b32 v244, 0
v_mov_b32 v245, 0
v_mov_b32 v246, 0
v_mov_b32 v247, 0
v_mov_b32 v248, 0
v_mov_b32 v249, 0
v_mov_b32 v250, 0
v_mov_b32 v251, 0
v_mov_b32 v252, 0
v_mov_b32 v253, 0
v_mov_b32 v254, 0
v_mov_b32 v255, 0
v_mov_b32 v8, v4
v_mov_b32 v9, v4
v_mov_b32 v10, v4
v_mov_b32 v11, v4
s_lshl_b32 s57, s20, 20
s_lshl_b32 s58, s56, 7
s_lshl_b32 s59, s56, 1
s_add_u32 s59, s59, 2
Lslow_7:
s_add_u32 s35, s57, 0
buffer_load_dwordx4 v[96:99], v1, s[12:15], s35 offen offset:0 sc1
buffer_load_dwordx4 v[100:103], v1, s[12:15], s35 offen offset:1024 sc1
buffer_load_dwordx4 v[104:107], v1, s[12:15], s35 offen offset:2048 sc1
buffer_load_dwordx4 v[108:111], v1, s[12:15], s35 offen offset:3072 sc1
s_add_u32 s35, s57, 4096
buffer_load_dwordx4 v[112:115], v1, s[12:15], s35 offen offset:0 sc1
buffer_load_dwordx4 v[116:119], v1, s[12:15], s35 offen offset:1024 sc1
buffer_load_dwordx4 v[120:123], v1, s[12:15], s35 offen offset:2048 sc1
buffer_load_dwordx4 v[124:127], v1, s[12:15], s35 offen offset:3072 sc1
s_add_u32 s35, s57, 8192
buffer_load_dwordx4 v[128:131], v1, s[12:15], s35 offen offset:0 sc1
buffer_load_dwordx4 v[132:135], v1, s[12:15], s35 offen offset:1024 sc1
buffer_load_dwordx4 v[136:139], v1, s[12:15], s35 offen offset:2048 sc1
buffer_load_dwordx4 v[140:143], v1, s[12:15], s35 offen offset:3072 sc1
s_add_u32 s35, s57, 12288
buffer_load_dwordx4 v[144:147], v1, s[12:15], s35 offen offset:0 sc1
buffer_load_dwordx4 v[148:151], v1, s[12:15], s35 offen offset:1024 sc1
buffer_load_dwordx4 v[152:155], v1, s[12:15], s35 offen offset:2048 sc1
buffer_load_dwordx4 v[156:159], v1, s[12:15], s35 offen offset:3072 sc1
s_lshl_b32 s33, s23, 6
s_add_i32 s33, s33, s58
s_cmp_gt_i32 s33, 0
s_cselect_b32 s34, 0, 0xf149f2ca
s_cmp_lt_i32 s33, 0
s_cselect_b32 s33, 0xf149f2ca, 0
v_mov_b32 v20, s34
v_mov_b32 v21, s34
v_mov_b32 v22, s34
v_mov_b32 v23, s34
v_mov_b32 v28, s33
v_mov_b32 v29, s33
v_mov_b32 v30, s33
v_mov_b32 v31, s33
v_med3_f32 v24, v16, v20, v28
v_med3_f32 v25, v17, v20, v28
v_med3_f32 v26, v18, v20, v28
v_med3_f32 v27, v19, v20, v28
s_waitcnt vmcnt(0)
s_nop 0
M v[32:35], v[96:99], a[0:3], v[24:27]
M v[32:35], v[100:103], a[4:7], v[32:35]
M v[32:35], v[104:107], a[8:11], v[32:35]
M v[32:35], v[108:111], a[12:15], v[32:35]
M v[36:39], v[96:99], a[16:19], v[28:31]
M v[36:39], v[100:103], a[20:23], v[36:39]
M v[36:39], v[104:107], a[24:27], v[36:39]
M v[36:39], v[108:111], a[28:31], v[36:39]
M v[40:43], v[96:99], a[32:35], v[28:31]
M v[40:43], v[100:103], a[36:39], v[40:43]
M v[40:43], v[104:107], a[40:43], v[40:43]
M v[40:43], v[108:111], a[44:47], v[40:43]
M v[44:47], v[96:99], a[48:51], v[28:31]
M v[44:47], v[100:103], a[52:55], v[44:47]
M v[44:47], v[104:107], a[56:59], v[44:47]
M v[44:47], v[108:111], a[60:63], v[44:47]
M v[48:51], v[112:115], a[0:3], v[20:23]
M v[48:51], v[116:119], a[4:7], v[48:51]
M v[48:51], v[120:123], a[8:11], v[48:51]
M v[48:51], v[124:127], a[12:15], v[48:51]
M v[52:55], v[112:115], a[16:19], v[24:27]
M v[52:55], v[116:119], a[20:23], v[52:55]
M v[52:55], v[120:123], a[24:27], v[52:55]
M v[52:55], v[124:127], a[28:31], v[52:55]
M v[56:59], v[112:115], a[32:35], v[28:31]
M v[56:59], v[116:119], a[36:39], v[56:59]
M v[56:59], v[120:123], a[40:43], v[56:59]
M v[56:59], v[124:127], a[44:47], v[56:59]
M v[60:63], v[112:115], a[48:51], v[28:31]
M v[60:63], v[116:119], a[52:55], v[60:63]
M v[60:63], v[120:123], a[56:59], v[60:63]
M v[60:63], v[124:127], a[60:63], v[60:63]
M v[64:67], v[128:131], a[0:3], v[20:23]
M v[64:67], v[132:135], a[4:7], v[64:67]
M v[64:67], v[136:139], a[8:11], v[64:67]
M v[64:67], v[140:143], a[12:15], v[64:67]
M v[68:71], v[128:131], a[16:19], v[20:23]
M v[68:71], v[132:135], a[20:23], v[68:71]
M v[68:71], v[136:139], a[24:27], v[68:71]
M v[68:71], v[140:143], a[28:31], v[68:71]
M v[72:75], v[128:131], a[32:35], v[24:27]
M v[72:75], v[132:135], a[36:39], v[72:75]
M v[72:75], v[136:139], a[40:43], v[72:75]
M v[72:75], v[140:143], a[44:47], v[72:75]
M v[76:79], v[128:131], a[48:51], v[28:31]
M v[76:79], v[132:135], a[52:55], v[76:79]
M v[76:79], v[136:139], a[56:59], v[76:79]
M v[76:79], v[140:143], a[60:63], v[76:79]
M v[80:83], v[144:147], a[0:3], v[20:23]
M v[80:83], v[148:151], a[4:7], v[80:83]
M v[80:83], v[152:155], a[8:11], v[80:83]
M v[80:83], v[156:159], a[12:15], v[80:83]
M v[84:87], v[144:147], a[16:19], v[20:23]
M v[84:87], v[148:151], a[20:23], v[84:87]
M v[84:87], v[152:155], a[24:27], v[84:87]
M v[84:87], v[156:159], a[28:31], v[84:87]
M v[88:91], v[144:147], a[32:35], v[20:23]
M v[88:91], v[148:151], a[36:39], v[88:91]
M v[88:91], v[152:155], a[40:43], v[88:91]
M v[88:91], v[156:159], a[44:47], v[88:91]
M v[92:95], v[144:147], a[48:51], v[24:27]
M v[92:95], v[148:151], a[52:55], v[92:95]
M v[92:95], v[152:155], a[56:59], v[92:95]
M v[92:95], v[156:159], a[60:63], v[92:95]
s_nop 7
s_add_u32 s35, s57, 16384
buffer_load_dwordx4 v[96:99], v1, s[12:15], s35 offen offset:0 sc1
buffer_load_dwordx4 v[100:103], v1, s[12:15], s35 offen offset:1024 sc1
buffer_load_dwordx4 v[104:107], v1, s[12:15], s35 offen offset:2048 sc1
buffer_load_dwordx4 v[108:111], v1, s[12:15], s35 offen offset:3072 sc1
s_add_u32 s35, s57, 20480
buffer_load_dwordx4 v[112:115], v1, s[12:15], s35 offen offset:0 sc1
buffer_load_dwordx4 v[116:119], v1, s[12:15], s35 offen offset:1024 sc1
buffer_load_dwordx4 v[120:123], v1, s[12:15], s35 offen offset:2048 sc1
buffer_load_dwordx4 v[124:127], v1, s[12:15], s35 offen offset:3072 sc1
s_add_u32 s35, s57, 24576
buffer_load_dwordx4 v[128:131], v1, s[12:15], s35 offen offset:0 sc1
buffer_load_dwordx4 v[132:135], v1, s[12:15], s35 offen offset:1024 sc1
buffer_load_dwordx4 v[136:139], v1, s[12:15], s35 offen offset:2048 sc1
buffer_load_dwordx4 v[140:143], v1, s[12:15], s35 offen offset:3072 sc1
s_add_u32 s35, s57, 28672
buffer_load_dwordx4 v[144:147], v1, s[12:15], s35 offen offset:0 sc1
buffer_load_dwordx4 v[148:151], v1, s[12:15], s35 offen offset:1024 sc1
buffer_load_dwordx4 v[152:155], v1, s[12:15], s35 offen offset:2048 sc1
buffer_load_dwordx4 v[156:159], v1, s[12:15], s35 offen offset:3072 sc1
v_max3_f32 v13, v32, v33, v8
v_max3_f32 v13, v13, v34, v35
v_max3_f32 v13, v13, v48, v49
v_max3_f32 v13, v13, v50, v51
v_max3_f32 v13, v13, v64, v65
v_max3_f32 v13, v13, v66, v67
v_max3_f32 v13, v13, v80, v81
v_max3_f32 v13, v13, v82, v83
v_mov_b32 v14, v13
s_nop 1
v_permlane16_swap_b32 v13, v14
v_max_f32 v13, v13, v14
v_mov_b32 v14, v13
s_nop 1
v_permlane32_swap_b32 v13, v14
v_max_f32 v13, v13, v14
v_sub_f32 v12, v8, v13
v_exp_f32 v12, v12
v_mov_b32 v8, v13
v_sub_f32 v32, v32, v13
v_sub_f32 v33, v33, v13
v_sub_f32 v34, v34, v13
v_sub_f32 v35, v35, v13
v_sub_f32 v48, v48, v13
v_sub_f32 v49, v49, v13
v_sub_f32 v50, v50, v13
v_sub_f32 v51, v51, v13
v_sub_f32 v64, v64, v13
v_sub_f32 v65, v65, v13
v_sub_f32 v66, v66, v13
v_sub_f32 v67, v67, v13
v_sub_f32 v80, v80, v13
v_sub_f32 v81, v81, v13
v_sub_f32 v82, v82, v13
v_sub_f32 v83, v83, v13
v_mul_f32 v160, v160, v12
v_mul_f32 v161, v161, v12
v_mul_f32 v162, v162, v12
v_mul_f32 v163, v163, v12
v_mul_f32 v176, v176, v12
v_mul_f32 v177, v177, v12
v_mul_f32 v178, v178, v12
v_mul_f32 v179, v179, v12
v_mul_f32 v192, v192, v12
v_mul_f32 v193, v193, v12
v_mul_f32 v194, v194, v12
v_mul_f32 v195, v195, v12
v_mul_f32 v208, v208, v12
v_mul_f32 v209, v209, v12
v_mul_f32 v210, v210, v12
v_mul_f32 v211, v211, v12
v_mul_f32 v224, v224, v12
v_mul_f32 v225, v225, v12
v_mul_f32 v226, v226, v12
v_mul_f32 v227, v227, v12
v_mul_f32 v240, v240, v12
v_mul_f32 v241, v241, v12
v_mul_f32 v242, v242, v12
v_mul_f32 v243, v243, v12
v_accvgpr_read_b32 v14, a64
v_mul_f32 v14, v14, v12
v_accvgpr_write_b32 a64, v14
v_accvgpr_read_b32 v14, a65
v_mul_f32 v14, v14, v12
v_accvgpr_write_b32 a65, v14
v_accvgpr_read_b32 v14, a66
v_mul_f32 v14, v14, v12
v_accvgpr_write_b32 a66, v14
v_accvgpr_read_b32 v14, a67
v_mul_f32 v14, v14, v12
v_accvgpr_write_b32 a67, v14
v_accvgpr_read_b32 v14, a80
v_mul_f32 v14, v14, v12
v_accvgpr_write_b32 a80, v14
v_accvgpr_read_b32 v14, a81
v_mul_f32 v14, v14, v12
v_accvgpr_write_b32 a81, v14
v_accvgpr_read_b32 v14, a82
v_mul_f32 v14, v14, v12
v_accvgpr_write_b32 a82, v14
v_accvgpr_read_b32 v14, a83
v_mul_f32 v14, v14, v12
v_accvgpr_write_b32 a83, v14
v_accvgpr_read_b32 v14, a96
v_mul_f32 v14, v14, v12
v_accvgpr_write_b32 a96, v14
v_accvgpr_read_b32 v14, a97
v_mul_f32 v14, v14, v12
v_accvgpr_write_b32 a97, v14
v_accvgpr_read_b32 v14, a98
v_mul_f32 v14, v14, v12
v_accvgpr_write_b32 a98, v14
v_accvgpr_read_b32 v14, a99
v_mul_f32 v14, v14, v12
v_accvgpr_write_b32 a99, v14
v_max3_f32 v13, v36, v37, v9
v_max3_f32 v13, v13, v38, v39
v_max3_f32 v13, v13, v52, v53
v_max3_f32 v13, v13, v54, v55
v_max3_f32 v13, v13, v68, v69
v_max3_f32 v13, v13, v70, v71
v_max3_f32 v13, v13, v84, v85
v_max3_f32 v13, v13, v86, v87
v_mov_b32 v14, v13
s_nop 1
v_permlane16_swap_b32 v13, v14
v_max_f32 v13, v13, v14
v_mov_b32 v14, v13
s_nop 1
v_permlane32_swap_b32 v13, v14
v_max_f32 v13, v13, v14
v_sub_f32 v12, v9, v13
v_exp_f32 v12, v12
v_mov_b32 v9, v13
v_sub_f32 v36, v36, v13
v_sub_f32 v37, v37, v13
v_sub_f32 v38, v38, v13
v_sub_f32 v39, v39, v13
v_sub_f32 v52, v52, v13
v_sub_f32 v53, v53, v13
v_sub_f32 v54, v54, v13
v_sub_f32 v55, v55, v13
v_sub_f32 v68, v68, v13
v_sub_f32 v69, v69, v13
v_sub_f32 v70, v70, v13
v_sub_f32 v71, v71, v13
v_sub_f32 v84, v84, v13
v_sub_f32 v85, v85, v13
v_sub_f32 v86, v86, v13
v_sub_f32 v87, v87, v13
v_mul_f32 v164, v164, v12
v_mul_f32 v165, v165, v12
v_mul_f32 v166, v166, v12
v_mul_f32 v167, v167, v12
v_mul_f32 v180, v180, v12
v_mul_f32 v181, v181, v12
v_mul_f32 v182, v182, v12
v_mul_f32 v183, v183, v12
v_mul_f32 v196, v196, v12
v_mul_f32 v197, v197, v12
v_mul_f32 v198, v198, v12
v_mul_f32 v199, v199, v12
v_mul_f32 v212, v212, v12
v_mul_f32 v213, v213, v12
v_mul_f32 v214, v214, v12
v_mul_f32 v215, v215, v12
v_mul_f32 v228, v228, v12
v_mul_f32 v229, v229, v12
v_mul_f32 v230, v230, v12
v_mul_f32 v231, v231, v12
v_mul_f32 v244, v244, v12
v_mul_f32 v245, v245, v12
v_mul_f32 v246, v246, v12
v_mul_f32 v247, v247, v12
v_accvgpr_read_b32 v14, a68
v_mul_f32 v14, v14, v12
v_accvgpr_write_b32 a68, v14
v_accvgpr_read_b32 v14, a69
v_mul_f32 v14, v14, v12
v_accvgpr_write_b32 a69, v14
v_accvgpr_read_b32 v14, a70
v_mul_f32 v14, v14, v12
v_accvgpr_write_b32 a70, v14
v_accvgpr_read_b32 v14, a71
v_mul_f32 v14, v14, v12
v_accvgpr_write_b32 a71, v14
v_accvgpr_read_b32 v14, a84
v_mul_f32 v14, v14, v12
v_accvgpr_write_b32 a84, v14
v_accvgpr_read_b32 v14, a85
v_mul_f32 v14, v14, v12
v_accvgpr_write_b32 a85, v14
v_accvgpr_read_b32 v14, a86
v_mul_f32 v14, v14, v12
v_accvgpr_write_b32 a86, v14
v_accvgpr_read_b32 v14, a87
v_mul_f32 v14, v14, v12
v_accvgpr_write_b32 a87, v14
v_accvgpr_read_b32 v14, a100
v_mul_f32 v14, v14, v12
v_accvgpr_write_b32 a100, v14
v_accvgpr_read_b32 v14, a101
v_mul_f32 v14, v14, v12
v_accvgpr_write_b32 a101, v14
v_accvgpr_read_b32 v14, a102
v_mul_f32 v14, v14, v12
v_accvgpr_write_b32 a102, v14
v_accvgpr_read_b32 v14, a103
v_mul_f32 v14, v14, v12
v_accvgpr_write_b32 a103, v14
v_max3_f32 v13, v40, v41, v10
v_max3_f32 v13, v13, v42, v43
v_max3_f32 v13, v13, v56, v57
v_max3_f32 v13, v13, v58, v59
v_max3_f32 v13, v13, v72, v73
v_max3_f32 v13, v13, v74, v75
v_max3_f32 v13, v13, v88, v89
v_max3_f32 v13, v13, v90, v91
v_mov_b32 v14, v13
s_nop 1
v_permlane16_swap_b32 v13, v14
v_max_f32 v13, v13, v14
v_mov_b32 v14, v13
s_nop 1
v_permlane32_swap_b32 v13, v14
v_max_f32 v13, v13, v14
v_sub_f32 v12, v10, v13
v_exp_f32 v12, v12
v_mov_b32 v10, v13
v_sub_f32 v40, v40, v13
v_sub_f32 v41, v41, v13
v_sub_f32 v42, v42, v13
v_sub_f32 v43, v43, v13
v_sub_f32 v56, v56, v13
v_sub_f32 v57, v57, v13
v_sub_f32 v58, v58, v13
v_sub_f32 v59, v59, v13
v_sub_f32 v72, v72, v13
v_sub_f32 v73, v73, v13
v_sub_f32 v74, v74, v13
v_sub_f32 v75, v75, v13
v_sub_f32 v88, v88, v13
v_sub_f32 v89, v89, v13
v_sub_f32 v90, v90, v13
v_sub_f32 v91, v91, v13
v_mul_f32 v168, v168, v12
v_mul_f32 v169, v169, v12
v_mul_f32 v170, v170, v12
v_mul_f32 v171, v171, v12
v_mul_f32 v184, v184, v12
v_mul_f32 v185, v185, v12
v_mul_f32 v186, v186, v12
v_mul_f32 v187, v187, v12
v_mul_f32 v200, v200, v12
v_mul_f32 v201, v201, v12
v_mul_f32 v202, v202, v12
v_mul_f32 v203, v203, v12
v_mul_f32 v216, v216, v12
v_mul_f32 v217, v217, v12
v_mul_f32 v218, v218, v12
v_mul_f32 v219, v219, v12
v_mul_f32 v232, v232, v12
v_mul_f32 v233, v233, v12
v_mul_f32 v234, v234, v12
v_mul_f32 v235, v235, v12
v_mul_f32 v248, v248, v12
v_mul_f32 v249, v249, v12
v_mul_f32 v250, v250, v12
v_mul_f32 v251, v251, v12
v_accvgpr_read_b32 v14, a72
v_mul_f32 v14, v14, v12
v_accvgpr_write_b32 a72, v14
v_accvgpr_read_b32 v14, a73
v_mul_f32 v14, v14, v12
v_accvgpr_write_b32 a73, v14
v_accvgpr_read_b32 v14, a74
v_mul_f32 v14, v14, v12
v_accvgpr_write_b32 a74, v14
v_accvgpr_read_b32 v14, a75
v_mul_f32 v14, v14, v12
v_accvgpr_write_b32 a75, v14
v_accvgpr_read_b32 v14, a88
v_mul_f32 v14, v14, v12
v_accvgpr_write_b32 a88, v14
v_accvgpr_read_b32 v14, a89
v_mul_f32 v14, v14, v12
v_accvgpr_write_b32 a89, v14
v_accvgpr_read_b32 v14, a90
v_mul_f32 v14, v14, v12
v_accvgpr_write_b32 a90, v14
v_accvgpr_read_b32 v14, a91
v_mul_f32 v14, v14, v12
v_accvgpr_write_b32 a91, v14
v_accvgpr_read_b32 v14, a104
v_mul_f32 v14, v14, v12
v_accvgpr_write_b32 a104, v14
v_accvgpr_read_b32 v14, a105
v_mul_f32 v14, v14, v12
v_accvgpr_write_b32 a105, v14
v_accvgpr_read_b32 v14, a106
v_mul_f32 v14, v14, v12
v_accvgpr_write_b32 a106, v14
v_accvgpr_read_b32 v14, a107
v_mul_f32 v14, v14, v12
v_accvgpr_write_b32 a107, v14
v_max3_f32 v13, v44, v45, v11
v_max3_f32 v13, v13, v46, v47
v_max3_f32 v13, v13, v60, v61
v_max3_f32 v13, v13, v62, v63
v_max3_f32 v13, v13, v76, v77
v_max3_f32 v13, v13, v78, v79
v_max3_f32 v13, v13, v92, v93
v_max3_f32 v13, v13, v94, v95
v_mov_b32 v14, v13
s_nop 1
v_permlane16_swap_b32 v13, v14
v_max_f32 v13, v13, v14
v_mov_b32 v14, v13
s_nop 1
v_permlane32_swap_b32 v13, v14
v_max_f32 v13, v13, v14
v_sub_f32 v12, v11, v13
v_exp_f32 v12, v12
v_mov_b32 v11, v13
v_sub_f32 v44, v44, v13
v_sub_f32 v45, v45, v13
v_sub_f32 v46, v46, v13
v_sub_f32 v47, v47, v13
v_sub_f32 v60, v60, v13
v_sub_f32 v61, v61, v13
v_sub_f32 v62, v62, v13
v_sub_f32 v63, v63, v13
v_sub_f32 v76, v76, v13
v_sub_f32 v77, v77, v13
v_sub_f32 v78, v78, v13
v_sub_f32 v79, v79, v13
v_sub_f32 v92, v92, v13
v_sub_f32 v93, v93, v13
v_sub_f32 v94, v94, v13
v_sub_f32 v95, v95, v13
v_mul_f32 v172, v172, v12
v_mul_f32 v173, v173, v12
v_mul_f32 v174, v174, v12
v_mul_f32 v175, v175, v12
v_mul_f32 v188, v188, v12
v_mul_f32 v189, v189, v12
v_mul_f32 v190, v190, v12
v_mul_f32 v191, v191, v12
v_mul_f32 v204, v204, v12
v_mul_f32 v205, v205, v12
v_mul_f32 v206, v206, v12
v_mul_f32 v207, v207, v12
v_mul_f32 v220, v220, v12
v_mul_f32 v221, v221, v12
v_mul_f32 v222, v222, v12
v_mul_f32 v223, v223, v12
v_mul_f32 v236, v236, v12
v_mul_f32 v237, v237, v12
v_mul_f32 v238, v238, v12
v_mul_f32 v239, v239, v12
v_mul_f32 v252, v252, v12
v_mul_f32 v253, v253, v12
v_mul_f32 v254, v254, v12
v_mul_f32 v255, v255, v12
v_accvgpr_read_b32 v14, a76
v_mul_f32 v14, v14, v12
v_accvgpr_write_b32 a76, v14
v_accvgpr_read_b32 v14, a77
v_mul_f32 v14, v14, v12
v_accvgpr_write_b32 a77, v14
v_accvgpr_read_b32 v14, a78
v_mul_f32 v14, v14, v12
v_accvgpr_write_b32 a78, v14
v_accvgpr_read_b32 v14, a79
v_mul_f32 v14, v14, v12
v_accvgpr_write_b32 a79, v14
v_accvgpr_read_b32 v14, a92
v_mul_f32 v14, v14, v12
v_accvgpr_write_b32 a92, v14
v_accvgpr_read_b32 v14, a93
v_mul_f32 v14, v14, v12
v_accvgpr_write_b32 a93, v14
v_accvgpr_read_b32 v14, a94
v_mul_f32 v14, v14, v12
v_accvgpr_write_b32 a94, v14
v_accvgpr_read_b32 v14, a95
v_mul_f32 v14, v14, v12
v_accvgpr_write_b32 a95, v14
v_accvgpr_read_b32 v14, a108
v_mul_f32 v14, v14, v12
v_accvgpr_write_b32 a108, v14
v_accvgpr_read_b32 v14, a109
v_mul_f32 v14, v14, v12
v_accvgpr_write_b32 a109, v14
v_accvgpr_read_b32 v14, a110
v_mul_f32 v14, v14, v12
v_accvgpr_write_b32 a110, v14
v_accvgpr_read_b32 v14, a111
v_mul_f32 v14, v14, v12
v_accvgpr_write_b32 a111, v14
v_exp_f32 v32, v32
v_exp_f32 v33, v33
v_exp_f32 v34, v34
v_exp_f32 v35, v35
v_exp_f32 v48, v48
v_exp_f32 v49, v49
v_exp_f32 v50, v50
v_exp_f32 v51, v51
v_cvt_pk_bf16_f32 v32, v32, v33
v_cvt_pk_bf16_f32 v33, v34, v35
v_exp_f32 v36, v36
v_exp_f32 v37, v37
v_exp_f32 v38, v38
v_exp_f32 v39, v39
v_cvt_pk_bf16_f32 v34, v48, v49
v_cvt_pk_bf16_f32 v35, v50, v51
v_exp_f32 v52, v52
v_exp_f32 v53, v53
v_exp_f32 v54, v54
v_exp_f32 v55, v55
v_cvt_pk_bf16_f32 v36, v36, v37
v_cvt_pk_bf16_f32 v37, v38, v39
v_exp_f32 v40, v40
v_exp_f32 v41, v41
v_exp_f32 v42, v42
v_exp_f32 v43, v43
v_cvt_pk_bf16_f32 v38, v52, v53
v_cvt_pk_bf16_f32 v39, v54, v55
v_exp_f32 v56, v56
v_exp_f32 v57, v57
v_exp_f32 v58, v58
v_exp_f32 v59, v59
v_cvt_pk_bf16_f32 v40, v40, v41
v_cvt_pk_bf16_f32 v41, v42, v43
v_exp_f32 v44, v44
v_exp_f32 v45, v45
v_exp_f32 v46, v46
v_exp_f32 v47, v47
v_cvt_pk_bf16_f32 v42, v56, v57
v_cvt_pk_bf16_f32 v43, v58, v59
v_exp_f32 v60, v60
v_exp_f32 v61, v61
v_exp_f32 v62, v62
v_exp_f32 v63, v63
v_cvt_pk_bf16_f32 v44, v44, v45
v_cvt_pk_bf16_f32 v45, v46, v47
v_cvt_pk_bf16_f32 v46, v60, v61
v_cvt_pk_bf16_f32 v47, v62, v63
v_exp_f32 v64, v64
v_exp_f32 v65, v65
v_exp_f32 v66, v66
v_exp_f32 v67, v67
v_exp_f32 v80, v80
v_exp_f32 v81, v81
v_exp_f32 v82, v82
v_exp_f32 v83, v83
v_cvt_pk_bf16_f32 v64, v64, v65
v_cvt_pk_bf16_f32 v65, v66, v67
v_exp_f32 v68, v68
v_exp_f32 v69, v69
v_exp_f32 v70, v70
v_exp_f32 v71, v71
v_cvt_pk_bf16_f32 v66, v80, v81
v_cvt_pk_bf16_f32 v67, v82, v83
v_exp_f32 v84, v84
v_exp_f32 v85, v85
v_exp_f32 v86, v86
v_exp_f32 v87, v87
v_cvt_pk_bf16_f32 v68, v68, v69
v_cvt_pk_bf16_f32 v69, v70, v71
v_exp_f32 v72, v72
v_exp_f32 v73, v73
v_exp_f32 v74, v74
v_exp_f32 v75, v75
v_cvt_pk_bf16_f32 v70, v84, v85
v_cvt_pk_bf16_f32 v71, v86, v87
v_exp_f32 v88, v88
v_exp_f32 v89, v89
v_exp_f32 v90, v90
v_exp_f32 v91, v91
v_cvt_pk_bf16_f32 v72, v72, v73
v_cvt_pk_bf16_f32 v73, v74, v75
v_exp_f32 v76, v76
v_exp_f32 v77, v77
v_exp_f32 v78, v78
v_exp_f32 v79, v79
v_cvt_pk_bf16_f32 v74, v88, v89
v_cvt_pk_bf16_f32 v75, v90, v91
v_exp_f32 v92, v92
v_exp_f32 v93, v93
v_exp_f32 v94, v94
v_exp_f32 v95, v95
v_cvt_pk_bf16_f32 v76, v76, v77
v_cvt_pk_bf16_f32 v77, v78, v79
v_cvt_pk_bf16_f32 v78, v92, v93
v_cvt_pk_bf16_f32 v79, v94, v95
s_waitcnt vmcnt(0)
M a[96:99], a[112:115], v[32:35], a[96:99]
M a[100:103], a[112:115], v[36:39], a[100:103]
M a[104:107], a[112:115], v[40:43], a[104:107]
M a[108:111], a[112:115], v[44:47], a[108:111]
M v[160:163], v[96:99], v[32:35], v[160:163]
M v[164:167], v[96:99], v[36:39], v[164:167]
M v[168:171], v[96:99], v[40:43], v[168:171]
M v[172:175], v[96:99], v[44:47], v[172:175]
M v[176:179], v[100:103], v[32:35], v[176:179]
M v[180:183], v[100:103], v[36:39], v[180:183]
M v[184:187], v[100:103], v[40:43], v[184:187]
M v[188:191], v[100:103], v[44:47], v[188:191]
M v[192:195], v[104:107], v[32:35], v[192:195]
M v[196:199], v[104:107], v[36:39], v[196:199]
M v[200:203], v[104:107], v[40:43], v[200:203]
M v[204:207], v[104:107], v[44:47], v[204:207]
M v[208:211], v[108:111], v[32:35], v[208:211]
M v[212:215], v[108:111], v[36:39], v[212:215]
M v[216:219], v[108:111], v[40:43], v[216:219]
M v[220:223], v[108:111], v[44:47], v[220:223]
M v[224:227], v[112:115], v[32:35], v[224:227]
M v[228:231], v[112:115], v[36:39], v[228:231]
M v[232:235], v[112:115], v[40:43], v[232:235]
M v[236:239], v[112:115], v[44:47], v[236:239]
M v[240:243], v[116:119], v[32:35], v[240:243]
M v[244:247], v[116:119], v[36:39], v[244:247]
M v[248:251], v[116:119], v[40:43], v[248:251]
M v[252:255], v[116:119], v[44:47], v[252:255]
M a[64:67], v[120:123], v[32:35], a[64:67]
M a[68:71], v[120:123], v[36:39], a[68:71]
M a[72:75], v[120:123], v[40:43], a[72:75]
M a[76:79], v[120:123], v[44:47], a[76:79]
M a[80:83], v[124:127], v[32:35], a[80:83]
M a[84:87], v[124:127], v[36:39], a[84:87]
M a[88:91], v[124:127], v[40:43], a[88:91]
M a[92:95], v[124:127], v[44:47], a[92:95]
M a[96:99], a[112:115], v[64:67], a[96:99]
M a[100:103], a[112:115], v[68:71], a[100:103]
M a[104:107], a[112:115], v[72:75], a[104:107]
M a[108:111], a[112:115], v[76:79], a[108:111]
M v[160:163], v[128:131], v[64:67], v[160:163]
M v[164:167], v[128:131], v[68:71], v[164:167]
M v[168:171], v[128:131], v[72:75], v[168:171]
M v[172:175], v[128:131], v[76:79], v[172:175]
M v[176:179], v[132:135], v[64:67], v[176:179]
M v[180:183], v[132:135], v[68:71], v[180:183]
M v[184:187], v[132:135], v[72:75], v[184:187]
M v[188:191], v[132:135], v[76:79], v[188:191]
M v[192:195], v[136:139], v[64:67], v[192:195]
M v[196:199], v[136:139], v[68:71], v[196:199]
M v[200:203], v[136:139], v[72:75], v[200:203]
M v[204:207], v[136:139], v[76:79], v[204:207]
M v[208:211], v[140:143], v[64:67], v[208:211]
M v[212:215], v[140:143], v[68:71], v[212:215]
M v[216:219], v[140:143], v[72:75], v[216:219]
M v[220:223], v[140:143], v[76:79], v[220:223]
M v[224:227], v[144:147], v[64:67], v[224:227]
M v[228:231], v[144:147], v[68:71], v[228:231]
M v[232:235], v[144:147], v[72:75], v[232:235]
M v[236:239], v[144:147], v[76:79], v[236:239]
M v[240:243], v[148:151], v[64:67], v[240:243]
M v[244:247], v[148:151], v[68:71], v[244:247]
M v[248:251], v[148:151], v[72:75], v[248:251]
M v[252:255], v[148:151], v[76:79], v[252:255]
M a[64:67], v[152:155], v[64:67], a[64:67]
M a[68:71], v[152:155], v[68:71], a[68:71]
M a[72:75], v[152:155], v[72:75], a[72:75]
M a[76:79], v[152:155], v[76:79], a[76:79]
M a[80:83], v[156:159], v[64:67], a[80:83]
M a[84:87], v[156:159], v[68:71], a[84:87]
M a[88:91], v[156:159], v[72:75], a[88:91]
M a[92:95], v[156:159], v[76:79], a[92:95]
s_nop 7
s_add_u32 s57, s57, 32768
s_sub_u32 s58, s58, 64
s_sub_u32 s59, s59, 1
s_cmp_lg_u32 s59, 0
s_cbranch_scc1 Lslow_7
v_accvgpr_read_b32 v20, a96
v_accvgpr_read_b32 v21, a100
v_accvgpr_read_b32 v22, a104
v_accvgpr_read_b32 v23, a108
v_rcp_f32 v8, v20
v_rcp_f32 v9, v21
v_rcp_f32 v10, v22
v_rcp_f32 v11, v23
v_pk_mul_f32 v[160:161], v[160:161], v[8:9] op_sel:[0,0] op_sel_hi:[1,0]
v_pk_mul_f32 v[162:163], v[162:163], v[8:9] op_sel:[0,0] op_sel_hi:[1,0]
v_pk_mul_f32 v[176:177], v[176:177], v[8:9] op_sel:[0,0] op_sel_hi:[1,0]
v_pk_mul_f32 v[178:179], v[178:179], v[8:9] op_sel:[0,0] op_sel_hi:[1,0]
v_cvt_pk_bf16_f32 v160, v160, v161
v_cvt_pk_bf16_f32 v161, v162, v163
v_cvt_pk_bf16_f32 v162, v176, v177
v_cvt_pk_bf16_f32 v163, v178, v179
v_pk_mul_f32 v[164:165], v[164:165], v[8:9] op_sel:[0,1] op_sel_hi:[1,1]
v_pk_mul_f32 v[166:167], v[166:167], v[8:9] op_sel:[0,1] op_sel_hi:[1,1]
v_pk_mul_f32 v[180:181], v[180:181], v[8:9] op_sel:[0,1] op_sel_hi:[1,1]
v_pk_mul_f32 v[182:183], v[182:183], v[8:9] op_sel:[0,1] op_sel_hi:[1,1]
v_cvt_pk_bf16_f32 v164, v164, v165
v_cvt_pk_bf16_f32 v165, v166, v167
v_cvt_pk_bf16_f32 v166, v180, v181
v_cvt_pk_bf16_f32 v167, v182, v183
v_pk_mul_f32 v[168:169], v[168:169], v[10:11] op_sel:[0,0] op_sel_hi:[1,0]
v_pk_mul_f32 v[170:171], v[170:171], v[10:11] op_sel:[0,0] op_sel_hi:[1,0]
v_pk_mul_f32 v[184:185], v[184:185], v[10:11] op_sel:[0,0] op_sel_hi:[1,0]
v_pk_mul_f32 v[186:187], v[186:187], v[10:11] op_sel:[0,0] op_sel_hi:[1,0]
v_cvt_pk_bf16_f32 v168, v168, v169
v_cvt_pk_bf16_f32 v169, v170, v171
v_cvt_pk_bf16_f32 v170, v184, v185
v_cvt_pk_bf16_f32 v171, v186, v187
v_pk_mul_f32 v[172:173], v[172:173], v[10:11] op_sel:[0,1] op_sel_hi:[1,1]
v_pk_mul_f32 v[174:175], v[174:175], v[10:11] op_sel:[0,1] op_sel_hi:[1,1]
v_pk_mul_f32 v[188:189], v[188:189], v[10:11] op_sel:[0,1] op_sel_hi:[1,1]
v_pk_mul_f32 v[190:191], v[190:191], v[10:11] op_sel:[0,1] op_sel_hi:[1,1]
v_cvt_pk_bf16_f32 v172, v172, v173
v_cvt_pk_bf16_f32 v173, v174, v175
v_cvt_pk_bf16_f32 v174, v188, v189
v_cvt_pk_bf16_f32 v175, v190, v191
v_pk_mul_f32 v[192:193], v[192:193], v[8:9] op_sel:[0,0] op_sel_hi:[1,0]
v_pk_mul_f32 v[194:195], v[194:195], v[8:9] op_sel:[0,0] op_sel_hi:[1,0]
v_pk_mul_f32 v[208:209], v[208:209], v[8:9] op_sel:[0,0] op_sel_hi:[1,0]
v_pk_mul_f32 v[210:211], v[210:211], v[8:9] op_sel:[0,0] op_sel_hi:[1,0]
v_cvt_pk_bf16_f32 v192, v192, v193
v_cvt_pk_bf16_f32 v193, v194, v195
v_cvt_pk_bf16_f32 v194, v208, v209
v_cvt_pk_bf16_f32 v195, v210, v211
v_pk_mul_f32 v[196:197], v[196:197], v[8:9] op_sel:[0,1] op_sel_hi:[1,1]
v_pk_mul_f32 v[198:199], v[198:199], v[8:9] op_sel:[0,1] op_sel_hi:[1,1]
v_pk_mul_f32 v[212:213], v[212:213], v[8:9] op_sel:[0,1] op_sel_hi:[1,1]
v_pk_mul_f32 v[214:215], v[214:215], v[8:9] op_sel:[0,1] op_sel_hi:[1,1]
v_cvt_pk_bf16_f32 v196, v196, v197
v_cvt_pk_bf16_f32 v197, v198, v199
v_cvt_pk_bf16_f32 v198, v212, v213
v_cvt_pk_bf16_f32 v199, v214, v215
v_pk_mul_f32 v[200:201], v[200:201], v[10:11] op_sel:[0,0] op_sel_hi:[1,0]
v_pk_mul_f32 v[202:203], v[202:203], v[10:11] op_sel:[0,0] op_sel_hi:[1,0]
v_pk_mul_f32 v[216:217], v[216:217], v[10:11] op_sel:[0,0] op_sel_hi:[1,0]
v_pk_mul_f32 v[218:219], v[218:219], v[10:11] op_sel:[0,0] op_sel_hi:[1,0]
v_cvt_pk_bf16_f32 v200, v200, v201
v_cvt_pk_bf16_f32 v201, v202, v203
v_cvt_pk_bf16_f32 v202, v216, v217
v_cvt_pk_bf16_f32 v203, v218, v219
v_pk_mul_f32 v[204:205], v[204:205], v[10:11] op_sel:[0,1] op_sel_hi:[1,1]
v_pk_mul_f32 v[206:207], v[206:207], v[10:11] op_sel:[0,1] op_sel_hi:[1,1]
v_pk_mul_f32 v[220:221], v[220:221], v[10:11] op_sel:[0,1] op_sel_hi:[1,1]
v_pk_mul_f32 v[222:223], v[222:223], v[10:11] op_sel:[0,1] op_sel_hi:[1,1]
v_cvt_pk_bf16_f32 v204, v204, v205
v_cvt_pk_bf16_f32 v205, v206, v207
v_cvt_pk_bf16_f32 v206, v220, v221
v_cvt_pk_bf16_f32 v207, v222, v223
v_pk_mul_f32 v[224:225], v[224:225], v[8:9] op_sel:[0,0] op_sel_hi:[1,0]
v_pk_mul_f32 v[226:227], v[226:227], v[8:9] op_sel:[0,0] op_sel_hi:[1,0]
v_pk_mul_f32 v[240:241], v[240:241], v[8:9] op_sel:[0,0] op_sel_hi:[1,0]
v_pk_mul_f32 v[242:243], v[242:243], v[8:9] op_sel:[0,0] op_sel_hi:[1,0]
v_cvt_pk_bf16_f32 v224, v224, v225
v_cvt_pk_bf16_f32 v225, v226, v227
v_cvt_pk_bf16_f32 v226, v240, v241
v_cvt_pk_bf16_f32 v227, v242, v243
v_pk_mul_f32 v[228:229], v[228:229], v[8:9] op_sel:[0,1] op_sel_hi:[1,1]
v_pk_mul_f32 v[230:231], v[230:231], v[8:9] op_sel:[0,1] op_sel_hi:[1,1]
v_pk_mul_f32 v[244:245], v[244:245], v[8:9] op_sel:[0,1] op_sel_hi:[1,1]
v_pk_mul_f32 v[246:247], v[246:247], v[8:9] op_sel:[0,1] op_sel_hi:[1,1]
v_cvt_pk_bf16_f32 v228, v228, v229
v_cvt_pk_bf16_f32 v229, v230, v231
v_cvt_pk_bf16_f32 v230, v244, v245
v_cvt_pk_bf16_f32 v231, v246, v247
v_pk_mul_f32 v[232:233], v[232:233], v[10:11] op_sel:[0,0] op_sel_hi:[1,0]
v_pk_mul_f32 v[234:235], v[234:235], v[10:11] op_sel:[0,0] op_sel_hi:[1,0]
v_pk_mul_f32 v[248:249], v[248:249], v[10:11] op_sel:[0,0] op_sel_hi:[1,0]
v_pk_mul_f32 v[250:251], v[250:251], v[10:11] op_sel:[0,0] op_sel_hi:[1,0]
v_cvt_pk_bf16_f32 v232, v232, v233
v_cvt_pk_bf16_f32 v233, v234, v235
v_cvt_pk_bf16_f32 v234, v248, v249
v_cvt_pk_bf16_f32 v235, v250, v251
v_pk_mul_f32 v[236:237], v[236:237], v[10:11] op_sel:[0,1] op_sel_hi:[1,1]
v_pk_mul_f32 v[238:239], v[238:239], v[10:11] op_sel:[0,1] op_sel_hi:[1,1]
v_pk_mul_f32 v[252:253], v[252:253], v[10:11] op_sel:[0,1] op_sel_hi:[1,1]
v_pk_mul_f32 v[254:255], v[254:255], v[10:11] op_sel:[0,1] op_sel_hi:[1,1]
v_cvt_pk_bf16_f32 v236, v236, v237
v_cvt_pk_bf16_f32 v237, v238, v239
v_cvt_pk_bf16_f32 v238, v252, v253
v_cvt_pk_bf16_f32 v239, v254, v255
v_accvgpr_read_b32 v176, a64
v_accvgpr_read_b32 v177, a65
v_accvgpr_read_b32 v178, a66
v_accvgpr_read_b32 v179, a67
v_accvgpr_read_b32 v180, a80
v_accvgpr_read_b32 v181, a81
v_accvgpr_read_b32 v182, a82
v_accvgpr_read_b32 v183, a83
v_pk_mul_f32 v[176:177], v[176:177], v[8:9] op_sel:[0,0] op_sel_hi:[1,0]
v_pk_mul_f32 v[178:179], v[178:179], v[8:9] op_sel:[0,0] op_sel_hi:[1,0]
v_pk_mul_f32 v[180:181], v[180:181], v[8:9] op_sel:[0,0] op_sel_hi:[1,0]
v_pk_mul_f32 v[182:183], v[182:183], v[8:9] op_sel:[0,0] op_sel_hi:[1,0]
v_cvt_pk_bf16_f32 v176, v176, v177
v_cvt_pk_bf16_f32 v177, v178, v179
v_cvt_pk_bf16_f32 v178, v180, v181
v_cvt_pk_bf16_f32 v179, v182, v183
v_accvgpr_read_b32 v184, a68
v_accvgpr_read_b32 v185, a69
v_accvgpr_read_b32 v186, a70
v_accvgpr_read_b32 v187, a71
v_accvgpr_read_b32 v188, a84
v_accvgpr_read_b32 v189, a85
v_accvgpr_read_b32 v190, a86
v_accvgpr_read_b32 v191, a87
v_pk_mul_f32 v[184:185], v[184:185], v[8:9] op_sel:[0,1] op_sel_hi:[1,1]
v_pk_mul_f32 v[186:187], v[186:187], v[8:9] op_sel:[0,1] op_sel_hi:[1,1]
v_pk_mul_f32 v[188:189], v[188:189], v[8:9] op_sel:[0,1] op_sel_hi:[1,1]
v_pk_mul_f32 v[190:191], v[190:191], v[8:9] op_sel:[0,1] op_sel_hi:[1,1]
v_cvt_pk_bf16_f32 v184, v184, v185
v_cvt_pk_bf16_f32 v185, v186, v187
v_cvt_pk_bf16_f32 v186, v188, v189
v_cvt_pk_bf16_f32 v187, v190, v191
v_accvgpr_read_b32 v208, a72
v_accvgpr_read_b32 v209, a73
v_accvgpr_read_b32 v210, a74
v_accvgpr_read_b32 v211, a75
v_accvgpr_read_b32 v212, a88
v_accvgpr_read_b32 v213, a89
v_accvgpr_read_b32 v214, a90
v_accvgpr_read_b32 v215, a91
v_pk_mul_f32 v[208:209], v[208:209], v[10:11] op_sel:[0,0] op_sel_hi:[1,0]
v_pk_mul_f32 v[210:211], v[210:211], v[10:11] op_sel:[0,0] op_sel_hi:[1,0]
v_pk_mul_f32 v[212:213], v[212:213], v[10:11] op_sel:[0,0] op_sel_hi:[1,0]
v_pk_mul_f32 v[214:215], v[214:215], v[10:11] op_sel:[0,0] op_sel_hi:[1,0]
v_cvt_pk_bf16_f32 v208, v208, v209
v_cvt_pk_bf16_f32 v209, v210, v211
v_cvt_pk_bf16_f32 v210, v212, v213
v_cvt_pk_bf16_f32 v211, v214, v215
v_accvgpr_read_b32 v216, a76
v_accvgpr_read_b32 v217, a77
v_accvgpr_read_b32 v218, a78
v_accvgpr_read_b32 v219, a79
v_accvgpr_read_b32 v220, a92
v_accvgpr_read_b32 v221, a93
v_accvgpr_read_b32 v222, a94
v_accvgpr_read_b32 v223, a95
v_pk_mul_f32 v[216:217], v[216:217], v[10:11] op_sel:[0,1] op_sel_hi:[1,1]
v_pk_mul_f32 v[218:219], v[218:219], v[10:11] op_sel:[0,1] op_sel_hi:[1,1]
v_pk_mul_f32 v[220:221], v[220:221], v[10:11] op_sel:[0,1] op_sel_hi:[1,1]
v_pk_mul_f32 v[222:223], v[222:223], v[10:11] op_sel:[0,1] op_sel_hi:[1,1]
v_cvt_pk_bf16_f32 v216, v216, v217
v_cvt_pk_bf16_f32 v217, v218, v219
v_cvt_pk_bf16_f32 v218, v220, v221
v_cvt_pk_bf16_f32 v219, v222, v223
s_lshl_b32 s33, s56, 20
s_lshl_b32 s34, s20, 15
s_add_u32 s33, s33, s34
s_lshl_b32 s34, s23, 13
s_add_u32 s36, s33, s34
s_add_u32 s37, s36, 4096
s_add_u32 s38, s36, 16384
s_add_u32 s39, s36, 20480
s_bitcmp1_b32 s61, 0
s_cbranch_scc0 Lss_10
buffer_store_dwordx4 v[160:163], v1, s[16:19], s36 offen offset:0 sc1
buffer_store_dwordx4 v[164:167], v1, s[16:19], s36 offen offset:2048 sc1
buffer_store_dwordx4 v[168:171], v1, s[16:19], s37 offen offset:0 sc1
buffer_store_dwordx4 v[172:175], v1, s[16:19], s37 offen offset:2048 sc1
Lss_10:
s_bitcmp1_b32 s61, 1
s_cbranch_scc0 Lss_11
buffer_store_dwordx4 v[192:195], v1, s[16:19], s36 offen offset:1024 sc1
buffer_store_dwordx4 v[196:199], v1, s[16:19], s36 offen offset:3072 sc1
buffer_store_dwordx4 v[200:203], v1, s[16:19], s37 offen offset:1024 sc1
buffer_store_dwordx4 v[204:207], v1, s[16:19], s37 offen offset:3072 sc1
Lss_11:
s_bitcmp1_b32 s61, 2
s_cbranch_scc0 Lss_12
buffer_store_dwordx4 v[224:227], v1, s[16:19], s38 offen offset:0 sc1
buffer_store_dwordx4 v[228:231], v1, s[16:19], s38 offen offset:2048 sc1
buffer_store_dwordx4 v[232:235], v1, s[16:19], s39 offen offset:0 sc1
buffer_store_dwordx4 v[236:239], v1, s[16:19], s39 offen offset:2048 sc1
Lss_12:
s_bitcmp1_b32 s61, 3
s_cbranch_scc0 Lss_13
buffer_store_dwordx4 v[176:179], v1, s[16:19], s38 offen offset:1024 sc1
buffer_store_dwordx4 v[184:187], v1, s[16:19], s38 offen offset:3072 sc1
buffer_store_dwordx4 v[208:211], v1, s[16:19], s39 offen offset:1024 sc1
buffer_store_dwordx4 v[216:219], v1, s[16:19], s39 offen offset:3072 sc1
Lss_13:
s_branch Lk2_chk
Lk2_done:
s_lshl_b32 s33, s20, 4
s_add_u32 s33, s33, 8392704
s_sub_u32 s34, 15, s21
s_lshl_b32 s34, s34, 9
s_add_u32 s92, s33, s34
s_lshl_b32 s34, s22, 2
s_add_u32 s92, s92, s34
s_lshl_b32 s34, s21, 9
s_add_u32 s93, s33, s34
s_lshl_b32 s34, s23, 3
s_add_u32 s93, s93, s34
s_cmp_eq_u32 s24, 0
s_cselect_b32 s93, s93, s92
s_cselect_b32 s94, 4, 0
s_add_u32 s94, s94, s93
s_load_dwordx2 s[10:11], s[0:1], 40
s_load_dwordx2 s[14:15], s[0:1], 72
s_lshl_b32 s21, s27, 7
s_lshl_b32 s22, s28, 6
s_lshl_b32 s3, s101, 4
v_lshrrev_b32 v224, 3, v0
v_and_b32 v225, 6, v224
v_and_b32 v226, 7, v0
v_xor_b32 v225, v225, v226
v_add_u32 v224, s3, v224
v_lshlrev_b32 v224, 11, v224
v_lshl_add_u32 v6, v225, 4, v224
v_add_u32 v7, 15360, v6
v_lshrrev_b32 v224, 2, v0
v_and_b32 v226, 1, v0
v_bfe_u32 v229, v0, 1, 1
v_lshlrev_b32 v225, 7, v224
v_lshl_add_u32 v225, v226, 3, v225
v_and_b32 v228, 6, v224
v_add_u32 v227, 0, v229
v_xor_b32 v227, v227, v228
v_lshl_add_u32 v24, v227, 4, v225
v_add_u32 v28, 0x10000, v24
v_add_u32 v227, 2, v229
v_xor_b32 v227, v227, v228
v_lshl_add_u32 v25, v227, 4, v225
v_add_u32 v29, 0x10000, v25
v_add_u32 v227, 4, v229
v_xor_b32 v227, v227, v228
v_lshl_add_u32 v26, v227, 4, v225
v_add_u32 v30, 0x10000, v26
v_add_u32 v227, 6, v229
v_xor_b32 v227, v227, v228
v_lshl_add_u32 v27, v227, 4, v225
v_add_u32 v31, 0x10000, v27
s_waitcnt vmcnt(32)
s_barrier
ds_read_b64_tr_b16 v[96:97], v28 offset:0
ds_read_b64_tr_b16 v[98:99], v28 offset:2048
ds_read_b64_tr_b16 v[100:101], v28 offset:4096
ds_read_b64_tr_b16 v[102:103], v28 offset:6144
ds_read_b64_tr_b16 v[104:105], v29 offset:0
ds_read_b64_tr_b16 v[106:107], v29 offset:2048
ds_read_b64_tr_b16 v[108:109], v29 offset:4096
ds_read_b64_tr_b16 v[110:111], v29 offset:6144
ds_read_b64_tr_b16 v[112:113], v30 offset:0
ds_read_b64_tr_b16 v[114:115], v30 offset:2048
ds_read_b64_tr_b16 v[116:117], v30 offset:4096
ds_read_b64_tr_b16 v[118:119], v30 offset:6144
ds_read_b64_tr_b16 v[120:121], v31 offset:0
ds_read_b64_tr_b16 v[122:123], v31 offset:2048
ds_read_b64_tr_b16 v[124:125], v31 offset:4096
ds_read_b64_tr_b16 v[126:127], v31 offset:6144
s_and_b32 s40, s2, 1
s_bfe_u32 s3, s2, 0x10001
s_lshl_b32 s3, s3, 3
s_bfe_u32 s36, s2, 0x30003
s_add_u32 s36, s3, s36
s_lshl_b32 s29, s36, 7
s_bfe_u32 s3, s2, 0x10002
s_lshl_b32 s3, s3, 2
s_lshr_b32 s37, s2, 6
s_add_u32 s3, s3, s37
s_lshl_b32 s13, s3, 8
s_lshl_b32 s30, s3, 7
s_lshl_b32 s3, s40, 6
s_add_u32 s30, s30, s3
s_lshl_b32 s41, s101, 12
s_lshl_b32 s12, s36, 20
s_add_u32 s12, s12, s41
s_lshl_b32 s62, s36, 9
s_lshl_b32 s3, s40, 8
s_add_u32 s62, s62, s3
s_add_u32 s62, s62, 8392704
s_lshr_b32 s3, s2, 1
s_lshr_b32 s38, s2, 2
s_xor_b32 s3, s3, s38
s_and_b32 s3, s3, 1
s_lshl_b32 s3, s3, 4
s_sub_u32 s39, 32, s3
s_lshl_b32 s38, s40, 5
s_add_u32 s3, s3, s38
s_lshl_b32 s3, s3, 14
s_add_u32 s12, s12, s3
s_lshl_b32 s3, s3, 3
s_add_u32 s13, s13, s3
s_mov_b32 s64, 4294459392
s_mov_b32 s65, 16384
s_add_u32 s8, s4, 67108864
s_addc_u32 s9, s5, 0
s_lshl_b32 s56, s2, 15
s_lshl_b32 s38, s101, 13
s_add_u32 s56, s56, s38
s_xor_b32 s57, s56, 32768
s_lshl_b32 s58, s2, 2
s_add_u32 s58, s58, 8388608
s_xor_b32 s59, s58, 4
s_mov_b32 s61, 0
s_lshl_b32 s3, s101, 4
v_lshrrev_b32 v232, 4, v0
v_and_b32 v234, 15, v0
v_add_u32 v233, 0, v232
v_lshlrev_b32 v233, 1, v233
v_xor_b32 v233, v233, v234
v_add_u32 v235, s3, v232
v_lshlrev_b32 v235, 11, v235
v_lshl_add_u32 v235, v233, 4, v235
v_add_u32 v2, 0, v235
v_add_u32 v233, 4, v232
v_lshlrev_b32 v233, 1, v233
v_xor_b32 v233, v233, v234
v_add_u32 v235, s3, v232
v_lshlrev_b32 v235, 11, v235
v_lshl_add_u32 v235, v233, 4, v235
v_add_u32 v3, 7168, v235
v_add_u32 v233, 0, v232
v_lshlrev_b32 v233, 1, v233
v_xor_b32 v233, v233, v234
v_add_u32 v235, s3, v232
v_lshlrev_b32 v235, 11, v235
v_lshl_add_u32 v235, v233, 4, v235
v_add_u32 v4, 14336, v235
v_add_u32 v233, 4, v232
v_lshlrev_b32 v233, 1, v233
v_xor_b32 v233, v233, v234
v_add_u32 v235, s3, v232
v_lshlrev_b32 v235, 11, v235
v_lshl_add_u32 v235, v233, 4, v235
v_add_u32 v5, 21504, v235
v_lshlrev_b32 v225, 8, v224
v_lshl_add_u32 v225, v226, 3, v225
v_and_b32 v228, 7, v224
v_lshlrev_b32 v228, 1, v228
s_lshl_b32 s38, s40, 3
v_xor_b32 v228, s38, v228
v_add_u32 v227, 0, v229
v_xor_b32 v227, v227, v228
v_lshl_add_u32 v8, v227, 4, v225
v_add_u32 v16, 0x10000, v8
v_add_u32 v227, 2, v229
v_xor_b32 v227, v227, v228
v_lshl_add_u32 v9, v227, 4, v225
v_add_u32 v17, 0x10000, v9
v_add_u32 v227, 4, v229
v_xor_b32 v227, v227, v228
v_lshl_add_u32 v10, v227, 4, v225
v_add_u32 v18, 0x10000, v10
v_add_u32 v227, 6, v229
v_xor_b32 v227, v227, v228
v_lshl_add_u32 v11, v227, 4, v225
v_add_u32 v19, 0x10000, v11
v_add_u32 v227, 8, v229
v_xor_b32 v227, v227, v228
v_lshl_add_u32 v12, v227, 4, v225
v_add_u32 v20, 0x10000, v12
v_add_u32 v227, 10, v229
v_xor_b32 v227, v227, v228
v_lshl_add_u32 v13, v227, 4, v225
v_add_u32 v21, 0x10000, v13
v_add_u32 v227, 12, v229
v_xor_b32 v227, v227, v228
v_lshl_add_u32 v14, v227, 4, v225
v_add_u32 v22, 0x10000, v14
v_add_u32 v227, 14, v229
v_xor_b32 v227, v227, v228
v_lshl_add_u32 v15, v227, 4, v225
v_add_u32 v23, 0x10000, v15
v_mov_b32 v253, 0
v_mov_b32 v254, 1
v_lshlrev_b32 v255, 2, v0
s_waitcnt lgkmcnt(0)
s_mov_b32 s16, s14
s_mov_b32 s17, s15
s_mov_b32 s18, 8388608
s_mov_b32 s19, 0x00020000
s_waitcnt vmcnt(26) lgkmcnt(0)
s_barrier
M a[0:3], v[96:99], a[192:195], 0
s_add_u32 m0, s42, 16384
s_nop 0
buffer_load_dwordx4 v6, s[48:51], s26 offen offset:0 lds
ds_read_b64_tr_b16 v[160:161], v28 offset:16384
ds_read_b64_tr_b16 v[162:163], v28 offset:18432
M a[0:3], v[100:103], a[196:199], a[0:3]
buffer_load_dwordx4 v7, s[48:51], s26 offen offset:1024 lds
M a[4:7], v[108:111], a[196:199], 0
ds_read_b64_tr_b16 v[164:165], v28 offset:20480
ds_read_b64_tr_b16 v[166:167], v28 offset:22528
M a[4:7], v[104:107], a[192:195], a[4:7]
buffer_load_dwordx4 a[144:147], v1, s[44:47], s25 offen offset:0 sc1
M a[8:11], v[112:115], a[192:195], 0
ds_read_b64_tr_b16 v[168:169], v29 offset:16384
ds_read_b64_tr_b16 v[170:171], v29 offset:18432
M a[8:11], v[116:119], a[196:199], a[8:11]
buffer_load_dwordx4 a[148:151], v1, s[44:47], s25 offen offset:1024 sc1
M a[12:15], v[124:127], a[196:199], 0
ds_read_b64_tr_b16 v[172:173], v29 offset:20480
ds_read_b64_tr_b16 v[174:175], v29 offset:22528
M a[12:15], v[120:123], a[192:195], a[12:15]
buffer_load_dwordx4 a[152:155], v1, s[44:47], s25 offen offset:2048 sc1
M a[16:19], v[96:99], a[200:203], 0
ds_read_b64_tr_b16 v[176:177], v30 offset:16384
ds_read_b64_tr_b16 v[178:179], v30 offset:18432
M a[16:19], v[100:103], a[204:207], a[16:19]
buffer_load_dwordx4 a[156:159], v1, s[44:47], s25 offen offset:3072 sc1
M a[20:23], v[108:111], a[204:207], 0
ds_read_b64_tr_b16 v[180:181], v30 offset:20480
ds_read_b64_tr_b16 v[182:183], v30 offset:22528
M a[20:23], v[104:107], a[200:203], a[20:23]
s_add_u32 s25, s25, 16384
s_add_u32 s26, s26, 131072
M a[24:27], v[112:115], a[200:203], 0
ds_read_b64_tr_b16 v[184:185], v31 offset:16384
ds_read_b64_tr_b16 v[186:187], v31 offset:18432
M a[24:27], v[116:119], a[204:207], a[24:27]
ds_read_b64_tr_b16 v[188:189], v31 offset:20480
ds_read_b64_tr_b16 v[190:191], v31 offset:22528
M a[28:31], v[124:127], a[204:207], 0
M a[28:31], v[120:123], a[200:203], a[28:31]
s_waitcnt vmcnt(6) lgkmcnt(0)
s_barrier
s_mov_b64 exec, 1
buffer_store_dword v254, v253, s[52:55], s92 offen sc1
buffer_store_dword v254, v253, s[52:55], s93 offen sc1
buffer_store_dword v254, v253, s[52:55], s94 offen sc1
s_mov_b64 exec, -1
M a[0:3], v[160:163], a[208:211], a[0:3]
s_add_u32 m0, s42, 32768
s_nop 0
buffer_load_dwordx4 v6, s[48:51], s26 offen offset:0 lds
ds_read_b64_tr_b16 v[96:97], v28 offset:32768
ds_read_b64_tr_b16 v[98:99], v28 offset:34816
M a[0:3], v[164:167], a[212:215], a[0:3]
buffer_load_dwordx4 v7, s[48:51], s26 offen offset:1024 lds
M a[4:7], v[172:175], a[212:215], a[4:7]
ds_read_b64_tr_b16 v[100:101], v28 offset:36864
ds_read_b64_tr_b16 v[102:103], v28 offset:38912
M a[4:7], v[168:171], a[208:211], a[4:7]
buffer_load_dwordx4 a[160:163], v1, s[44:47], s25 offen offset:0 sc1
M a[8:11], v[176:179], a[208:211], a[8:11]
ds_read_b64_tr_b16 v[104:105], v29 offset:32768
ds_read_b64_tr_b16 v[106:107], v29 offset:34816
M a[8:11], v[180:183], a[212:215], a[8:11]
buffer_load_dwordx4 a[164:167], v1, s[44:47], s25 offen offset:1024 sc1
M a[12:15], v[188:191], a[212:215], a[12:15]
ds_read_b64_tr_b16 v[108:109], v29 offset:36864
ds_read_b64_tr_b16 v[110:111], v29 offset:38912
M a[12:15], v[184:187], a[208:211], a[12:15]
buffer_load_dwordx4 a[168:171], v1, s[44:47], s25 offen offset:2048 sc1
M a[16:19], v[160:163], a[216:219], a[16:19]
ds_read_b64_tr_b16 v[112:113], v30 offset:32768
ds_read_b64_tr_b16 v[114:115], v30 offset:34816
M a[16:19], v[164:167], a[220:223], a[16:19]
buffer_load_dwordx4 a[172:175], v1, s[44:47], s25 offen offset:3072 sc1
M a[20:23], v[172:175], a[220:223], a[20:23]
ds_read_b64_tr_b16 v[116:117], v30 offset:36864
ds_read_b64_tr_b16 v[118:119], v30 offset:38912
M a[20:23], v[168:171], a[216:219], a[20:23]
s_add_u32 s25, s25, 16384
s_add_u32 s26, s26, 131072
M a[24:27], v[176:179], a[216:219], a[24:27]
ds_read_b64_tr_b16 v[120:121], v31 offset:32768
ds_read_b64_tr_b16 v[122:123], v31 offset:34816
M a[24:27], v[180:183], a[220:223], a[24:27]
ds_read_b64_tr_b16 v[124:125], v31 offset:36864
ds_read_b64_tr_b16 v[126:127], v31 offset:38912
M a[28:31], v[188:191], a[220:223], a[28:31]
M a[28:31], v[184:187], a[216:219], a[28:31]
s_waitcnt vmcnt(29) lgkmcnt(0)
s_barrier
M a[0:3], v[96:99], a[224:227], a[0:3]
s_add_u32 m0, s42, 49152
s_nop 0
buffer_load_dwordx4 v6, s[48:51], s26 offen offset:0 lds
ds_read_b64_tr_b16 v[160:161], v28 offset:49152
ds_read_b64_tr_b16 v[162:163], v28 offset:51200
M a[0:3], v[100:103], a[228:231], a[0:3]
buffer_load_dwordx4 v7, s[48:51], s26 offen offset:1024 lds
M a[4:7], v[108:111], a[228:231], a[4:7]
ds_read_b64_tr_b16 v[164:165], v28 offset:53248
ds_read_b64_tr_b16 v[166:167], v28 offset:55296
M a[4:7], v[104:107], a[224:227], a[4:7]
buffer_load_dwordx4 a[176:179], v1, s[44:47], s25 offen offset:0 sc1
M a[8:11], v[112:115], a[224:227], a[8:11]
ds_read_b64_tr_b16 v[168:169], v29 offset:49152
ds_read_b64_tr_b16 v[170:171], v29 offset:51200
M a[8:11], v[116:119], a[228:231], a[8:11]
buffer_load_dwordx4 a[180:183], v1, s[44:47], s25 offen offset:1024 sc1
M a[12:15], v[124:127], a[228:231], a[12:15]
ds_read_b64_tr_b16 v[172:173], v29 offset:53248
ds_read_b64_tr_b16 v[174:175], v29 offset:55296
M a[12:15], v[120:123], a[224:227], a[12:15]
buffer_load_dwordx4 a[184:187], v1, s[44:47], s25 offen offset:2048 sc1
ds_read_b64_tr_b16 v[176:177], v30 offset:49152
ds_read_b64_tr_b16 v[178:179], v30 offset:51200
M a[16:19], v[96:99], a[232:235], a[16:19]
buffer_load_dwordx4 a[188:191], v1, s[44:47], s25 offen offset:3072 sc1
M a[16:19], v[100:103], a[236:239], a[16:19]
ds_read_b64_tr_b16 v[180:181], v30 offset:53248
ds_read_b64_tr_b16 v[182:183], v30 offset:55296
M a[20:23], v[108:111], a[236:239], a[20:23]
s_add_u32 s25, s25, 16384
s_add_u32 s26, s26, 131072
M a[20:23], v[104:107], a[232:235], a[20:23]
ds_read_b64_tr_b16 v[184:185], v31 offset:49152
ds_read_b64_tr_b16 v[186:187], v31 offset:51200
M a[24:27], v[112:115], a[232:235], a[24:27]
buffer_load_dword v252, v255, s[52:55], s62 offen sc1
M a[24:27], v[116:119], a[236:239], a[24:27]
ds_read_b64_tr_b16 v[188:189], v31 offset:53248
ds_read_b64_tr_b16 v[190:191], v31 offset:55296
M a[28:31], v[124:127], a[236:239], a[28:31]
M a[28:31], v[120:123], a[232:235], a[28:31]
s_waitcnt vmcnt(30) lgkmcnt(0)
s_barrier
s_waitcnt vmcnt(0)
v_cmp_ne_u32 vcc, 1, v252
s_nop 0
s_cbranch_vccnz Lk3_spinft
Lk3_gotft:
M a[0:3], v[160:163], a[240:243], a[0:3]
s_mov_b32 s32, s25
s_mov_b32 s33, s26
s_mov_b64 s[34:35], s[44:45]
s_mov_b64 s[36:37], s[48:49]
s_mov_b64 s[44:45], s[8:9]
s_mov_b32 s46, 16777216
s_mov_b64 s[48:49], s[10:11]
s_mov_b32 s50, 8388608
s_mov_b32 s25, s12
s_mov_b32 s26, s13
s_add_u32 m0, s41, 65536
s_nop 0
buffer_load_dwordx4 v2, s[48:51], s26 offen offset:0 lds
ds_read_b64_tr_b16 v[96:97], v24 offset:0
ds_read_b64_tr_b16 v[98:99], v24 offset:2048
M a[0:3], v[164:167], a[244:247], a[0:3]
buffer_load_dwordx4 v3, s[48:51], s26 offen offset:1024 lds
M a[4:7], v[172:175], a[244:247], a[4:7]
ds_read_b64_tr_b16 v[100:101], v24 offset:4096
ds_read_b64_tr_b16 v[102:103], v24 offset:6144
M a[4:7], v[168:171], a[240:243], a[4:7]
buffer_load_dwordx4 v4, s[48:51], s26 offen offset:2048 lds
ds_read_b64_tr_b16 v[104:105], v25 offset:0
ds_read_b64_tr_b16 v[106:107], v25 offset:2048
M a[8:11], v[176:179], a[240:243], a[8:11]
buffer_load_dwordx4 v5, s[48:51], s26 offen offset:3072 lds
M a[8:11], v[180:183], a[244:247], a[8:11]
ds_read_b64_tr_b16 v[108:109], v25 offset:4096
ds_read_b64_tr_b16 v[110:111], v25 offset:6144
M a[12:15], v[188:191], a[244:247], a[12:15]
buffer_load_dwordx4 a[192:195], v1, s[44:47], s25 offen offset:0 sc1
M a[12:15], v[184:187], a[240:243], a[12:15]
ds_read_b64_tr_b16 v[112:113], v26 offset:0
ds_read_b64_tr_b16 v[114:115], v26 offset:2048
buffer_load_dwordx4 a[196:199], v1, s[44:47], s25 offen offset:1024 sc1
M a[16:19], v[160:163], a[248:251], a[16:19]
ds_read_b64_tr_b16 v[116:117], v26 offset:4096
ds_read_b64_tr_b16 v[118:119], v26 offset:6144
M a[16:19], v[164:167], a[252:255], a[16:19]
buffer_load_dwordx4 a[200:203], v1, s[44:47], s25 offen offset:2048 sc1
M a[20:23], v[172:175], a[252:255], a[20:23]
ds_read_b64_tr_b16 v[120:121], v27 offset:0
ds_read_b64_tr_b16 v[122:123], v27 offset:2048
buffer_load_dwordx4 a[204:207], v1, s[44:47], s25 offen offset:3072 sc1
M a[20:23], v[168:171], a[248:251], a[20:23]
ds_read_b64_tr_b16 v[124:125], v27 offset:4096
ds_read_b64_tr_b16 v[126:127], v27 offset:6144
M a[24:27], v[176:179], a[248:251], a[24:27]
s_sub_u32 s39, s39, 1
s_cmp_eq_u32 s39, 0
s_cselect_b32 s3, s64, s65
M a[24:27], v[180:183], a[252:255], a[24:27]
s_add_u32 s25, s25, s3
s_lshl_b32 s3, s3, 3
s_add_u32 s26, s26, s3
M a[28:31], v[188:191], a[252:255], a[28:31]
M a[28:31], v[184:187], a[248:251], a[28:31]
s_waitcnt vmcnt(24) lgkmcnt(0)
s_barrier
M a[0:3], v[96:99], a[128:131], a[0:3]
s_add_u32 m0, s41, 81920
s_nop 0
buffer_load_dwordx4 v2, s[48:51], s26 offen offset:0 lds
ds_read_b64_tr_b16 v[160:161], v24 offset:16384
ds_read_b64_tr_b16 v[162:163], v24 offset:18432
M a[0:3], v[100:103], a[132:135], a[0:3]
buffer_load_dwordx4 v3, s[48:51], s26 offen offset:1024 lds
M a[4:7], v[108:111], a[132:135], a[4:7]
ds_read_b64_tr_b16 v[164:165], v24 offset:20480
ds_read_b64_tr_b16 v[166:167], v24 offset:22528
M a[4:7], v[104:107], a[128:131], a[4:7]
buffer_load_dwordx4 v4, s[48:51], s26 offen offset:2048 lds
ds_read_b64_tr_b16 v[168:169], v25 offset:16384
ds_read_b64_tr_b16 v[170:171], v25 offset:18432
M a[8:11], v[112:115], a[128:131], a[8:11]
buffer_load_dwordx4 v5, s[48:51], s26 offen offset:3072 lds
M a[8:11], v[116:119], a[132:135], a[8:11]
ds_read_b64_tr_b16 v[172:173], v25 offset:20480
ds_read_b64_tr_b16 v[174:175], v25 offset:22528
M a[12:15], v[124:127], a[132:135], a[12:15]
buffer_load_dwordx4 a[208:211], v1, s[44:47], s25 offen offset:0 sc1
M a[12:15], v[120:123], a[128:131], a[12:15]
ds_read_b64_tr_b16 v[176:177], v26 offset:16384
ds_read_b64_tr_b16 v[178:179], v26 offset:18432
buffer_load_dwordx4 a[212:215], v1, s[44:47], s25 offen offset:1024 sc1
M a[16:19], v[96:99], a[136:139], a[16:19]
ds_read_b64_tr_b16 v[180:181], v26 offset:20480
ds_read_b64_tr_b16 v[182:183], v26 offset:22528
M a[16:19], v[100:103], a[140:143], a[16:19]
buffer_load_dwordx4 a[216:219], v1, s[44:47], s25 offen offset:2048 sc1
M a[20:23], v[108:111], a[140:143], a[20:23]
ds_read_b64_tr_b16 v[184:185], v27 offset:16384
ds_read_b64_tr_b16 v[186:187], v27 offset:18432
buffer_load_dwordx4 a[220:223], v1, s[44:47], s25 offen offset:3072 sc1
M a[20:23], v[104:107], a[136:139], a[20:23]
ds_read_b64_tr_b16 v[188:189], v27 offset:20480
ds_read_b64_tr_b16 v[190:191], v27 offset:22528
M a[24:27], v[112:115], a[136:139], a[24:27]
s_sub_u32 s39, s39, 1
s_cmp_eq_u32 s39, 0
s_cselect_b32 s3, s64, s65
M a[24:27], v[116:119], a[140:143], a[24:27]
s_add_u32 s25, s25, s3
s_lshl_b32 s3, s3, 3
s_add_u32 s26, s26, s3
M a[28:31], v[124:127], a[140:143], a[28:31]
M a[28:31], v[120:123], a[136:139], a[28:31]
s_waitcnt vmcnt(23) lgkmcnt(0)
s_barrier
M a[0:3], v[160:163], a[144:147], a[0:3]
s_add_u32 m0, s41, 98304
s_nop 0
buffer_load_dwordx4 v2, s[48:51], s26 offen offset:0 lds
ds_read_b64_tr_b16 v[96:97], v24 offset:32768
ds_read_b64_tr_b16 v[98:99], v24 offset:34816
M a[0:3], v[164:167], a[148:151], a[0:3]
buffer_load_dwordx4 v3, s[48:51], s26 offen offset:1024 lds
M a[4:7], v[172:175], a[148:151], a[4:7]
ds_read_b64_tr_b16 v[100:101], v24 offset:36864
ds_read_b64_tr_b16 v[102:103], v24 offset:38912
M a[4:7], v[168:171], a[144:147], a[4:7]
buffer_load_dwordx4 v4, s[48:51], s26 offen offset:2048 lds
ds_read_b64_tr_b16 v[104:105], v25 offset:32768
ds_read_b64_tr_b16 v[106:107], v25 offset:34816
M a[8:11], v[176:179], a[144:147], a[8:11]
buffer_load_dwordx4 v5, s[48:51], s26 offen offset:3072 lds
M a[8:11], v[180:183], a[148:151], a[8:11]
ds_read_b64_tr_b16 v[108:109], v25 offset:36864
ds_read_b64_tr_b16 v[110:111], v25 offset:38912
M a[12:15], v[188:191], a[148:151], a[12:15]
buffer_load_dwordx4 a[224:227], v1, s[44:47], s25 offen offset:0 sc1
M a[12:15], v[184:187], a[144:147], a[12:15]
ds_read_b64_tr_b16 v[112:113], v26 offset:32768
ds_read_b64_tr_b16 v[114:115], v26 offset:34816
buffer_load_dwordx4 a[228:231], v1, s[44:47], s25 offen offset:1024 sc1
M a[16:19], v[160:163], a[152:155], a[16:19]
ds_read_b64_tr_b16 v[116:117], v26 offset:36864
ds_read_b64_tr_b16 v[118:119], v26 offset:38912
M a[16:19], v[164:167], a[156:159], a[16:19]
buffer_load_dwordx4 a[232:235], v1, s[44:47], s25 offen offset:2048 sc1
M a[20:23], v[172:175], a[156:159], a[20:23]
ds_read_b64_tr_b16 v[120:121], v27 offset:32768
ds_read_b64_tr_b16 v[122:123], v27 offset:34816
buffer_load_dwordx4 a[236:239], v1, s[44:47], s25 offen offset:3072 sc1
M a[20:23], v[168:171], a[152:155], a[20:23]
ds_read_b64_tr_b16 v[124:125], v27 offset:36864
ds_read_b64_tr_b16 v[126:127], v27 offset:38912
M a[24:27], v[176:179], a[152:155], a[24:27]
s_sub_u32 s39, s39, 1
s_cmp_eq_u32 s39, 0
s_cselect_b32 s3, s64, s65
M a[24:27], v[180:183], a[156:159], a[24:27]
s_add_u32 s25, s25, s3
s_lshl_b32 s3, s3, 3
s_add_u32 s26, s26, s3
M a[28:31], v[188:191], a[156:159], a[28:31]
M a[28:31], v[184:187], a[152:155], a[28:31]
s_waitcnt vmcnt(25) lgkmcnt(0)
s_barrier
M a[0:3], v[96:99], a[160:163], a[0:3]
s_add_u32 m0, s41, 114688
s_nop 0
buffer_load_dwordx4 v2, s[48:51], s26 offen offset:0 lds
ds_read_b64_tr_b16 v[160:161], v24 offset:49152
ds_read_b64_tr_b16 v[162:163], v24 offset:51200
M a[0:3], v[100:103], a[164:167], a[0:3]
buffer_load_dwordx4 v3, s[48:51], s26 offen offset:1024 lds
M a[4:7], v[108:111], a[164:167], a[4:7]
ds_read_b64_tr_b16 v[164:165], v24 offset:53248
ds_read_b64_tr_b16 v[166:167], v24 offset:55296
M a[4:7], v[104:107], a[160:163], a[4:7]
buffer_load_dwordx4 v4, s[48:51], s26 offen offset:2048 lds
ds_read_b64_tr_b16 v[168:169], v25 offset:49152
ds_read_b64_tr_b16 v[170:171], v25 offset:51200
M a[8:11], v[112:115], a[160:163], a[8:11]
buffer_load_dwordx4 v5, s[48:51], s26 offen offset:3072 lds
M a[8:11], v[116:119], a[164:167], a[8:11]
ds_read_b64_tr_b16 v[172:173], v25 offset:53248
ds_read_b64_tr_b16 v[174:175], v25 offset:55296
M a[12:15], v[124:127], a[164:167], a[12:15]
buffer_load_dwordx4 a[240:243], v1, s[44:47], s25 offen offset:0 sc1
M a[12:15], v[120:123], a[160:163], a[12:15]
ds_read_b64_tr_b16 v[176:177], v26 offset:49152
ds_read_b64_tr_b16 v[178:179], v26 offset:51200
buffer_load_dwordx4 a[244:247], v1, s[44:47], s25 offen offset:1024 sc1
M a[16:19], v[96:99], a[168:171], a[16:19]
ds_read_b64_tr_b16 v[180:181], v26 offset:53248
ds_read_b64_tr_b16 v[182:183], v26 offset:55296
M a[16:19], v[100:103], a[172:175], a[16:19]
buffer_load_dwordx4 a[248:251], v1, s[44:47], s25 offen offset:2048 sc1
M a[20:23], v[108:111], a[172:175], a[20:23]
ds_read_b64_tr_b16 v[184:185], v27 offset:49152
ds_read_b64_tr_b16 v[186:187], v27 offset:51200
buffer_load_dwordx4 a[252:255], v1, s[44:47], s25 offen offset:3072 sc1
M a[20:23], v[104:107], a[168:171], a[20:23]
ds_read_b64_tr_b16 v[188:189], v27 offset:53248
ds_read_b64_tr_b16 v[190:191], v27 offset:55296
M a[24:27], v[112:115], a[168:171], a[24:27]
s_sub_u32 s39, s39, 1
s_cmp_eq_u32 s39, 0
s_cselect_b32 s3, s64, s65
M a[24:27], v[116:119], a[172:175], a[24:27]
s_add_u32 s25, s25, s3
s_lshl_b32 s3, s3, 3
s_add_u32 s26, s26, s3
M a[28:31], v[124:127], a[172:175], a[28:31]
M a[28:31], v[120:123], a[168:171], a[28:31]
s_waitcnt vmcnt(24) lgkmcnt(0)
s_barrier
M a[0:3], v[160:163], a[176:179], a[0:3]
s_add_u32 m0, s41, 0
s_nop 0
buffer_load_dwordx4 v2, s[48:51], s26 offen offset:0 lds
ds_read_b64_tr_b16 v[96:97], v16 offset:0
ds_read_b64_tr_b16 v[98:99], v16 offset:4096
M a[0:3], v[164:167], a[180:183], a[0:3]
buffer_load_dwordx4 v3, s[48:51], s26 offen offset:1024 lds
ds_read_b64_tr_b16 v[100:101], v16 offset:8192
ds_read_b64_tr_b16 v[102:103], v16 offset:12288
M a[4:7], v[172:175], a[180:183], a[4:7]
buffer_load_dwordx4 v4, s[48:51], s26 offen offset:2048 lds
ds_read_b64_tr_b16 v[104:105], v17 offset:0
ds_read_b64_tr_b16 v[106:107], v17 offset:4096
M a[4:7], v[168:171], a[176:179], a[4:7]
buffer_load_dwordx4 v5, s[48:51], s26 offen offset:3072 lds
ds_read_b64_tr_b16 v[108:109], v17 offset:8192
ds_read_b64_tr_b16 v[110:111], v17 offset:12288
M a[8:11], v[176:179], a[176:179], a[8:11]
buffer_load_dwordx4 a[128:131], v1, s[44:47], s25 offen offset:0 sc1
ds_read_b64_tr_b16 v[112:113], v18 offset:0
ds_read_b64_tr_b16 v[114:115], v18 offset:4096
M a[8:11], v[180:183], a[180:183], a[8:11]
buffer_load_dwordx4 a[132:135], v1, s[44:47], s25 offen offset:1024 sc1
ds_read_b64_tr_b16 v[116:117], v18 offset:8192
ds_read_b64_tr_b16 v[118:119], v18 offset:12288
M a[12:15], v[188:191], a[180:183], a[12:15]
buffer_load_dwordx4 a[136:139], v1, s[44:47], s25 offen offset:2048 sc1
M a[12:15], v[184:187], a[176:179], a[12:15]
ds_read_b64_tr_b16 v[120:121], v19 offset:0
ds_read_b64_tr_b16 v[122:123], v19 offset:4096
buffer_load_dwordx4 a[140:143], v1, s[44:47], s25 offen offset:3072 sc1
M a[16:19], v[160:163], a[184:187], a[16:19]
ds_read_b64_tr_b16 v[124:125], v19 offset:8192
ds_read_b64_tr_b16 v[126:127], v19 offset:12288
s_sub_u32 s39, s39, 1
s_cmp_eq_u32 s39, 0
s_cselect_b32 s3, s64, s65
M a[16:19], v[164:167], a[188:191], a[16:19]
ds_read_b64_tr_b16 v[128:129], v20 offset:0
ds_read_b64_tr_b16 v[130:131], v20 offset:4096
s_add_u32 s25, s25, s3
s_lshl_b32 s3, s3, 3
s_add_u32 s26, s26, s3
M a[20:23], v[172:175], a[188:191], a[20:23]
ds_read_b64_tr_b16 v[132:133], v20 offset:8192
ds_read_b64_tr_b16 v[134:135], v20 offset:12288
ds_read_b64_tr_b16 v[136:137], v21 offset:0
ds_read_b64_tr_b16 v[138:139], v21 offset:4096
M a[20:23], v[168:171], a[184:187], a[20:23]
ds_read_b64_tr_b16 v[140:141], v21 offset:8192
ds_read_b64_tr_b16 v[142:143], v21 offset:12288
ds_read_b64_tr_b16 v[144:145], v22 offset:0
ds_read_b64_tr_b16 v[146:147], v22 offset:4096
M a[24:27], v[176:179], a[184:187], a[24:27]
ds_read_b64_tr_b16 v[148:149], v22 offset:8192
ds_read_b64_tr_b16 v[150:151], v22 offset:12288
ds_read_b64_tr_b16 v[152:153], v23 offset:0
ds_read_b64_tr_b16 v[154:155], v23 offset:4096
M a[24:27], v[180:183], a[188:191], a[24:27]
ds_read_b64_tr_b16 v[156:157], v23 offset:8192
ds_read_b64_tr_b16 v[158:159], v23 offset:12288
M a[28:31], v[188:191], a[188:191], a[28:31]
M a[28:31], v[184:187], a[184:187], a[28:31]
s_waitcnt vmcnt(24) lgkmcnt(0)
s_barrier
M v[32:35], v[96:99], a[192:195], 0
s_add_u32 m0, s41, 16384
s_nop 0
buffer_load_dwordx4 v2, s[48:51], s26 offen offset:0 lds
M v[32:35], v[100:103], a[196:199], v[32:35]
ds_read_b64_tr_b16 v[160:161], v16 offset:16384
ds_read_b64_tr_b16 v[162:163], v16 offset:20480
M v[36:39], v[108:111], a[196:199], 0
buffer_load_dwordx4 v3, s[48:51], s26 offen offset:1024 lds
M v[36:39], v[104:107], a[192:195], v[36:39]
ds_read_b64_tr_b16 v[164:165], v16 offset:24576
ds_read_b64_tr_b16 v[166:167], v16 offset:28672
M v[40:43], v[112:115], a[192:195], 0
buffer_load_dwordx4 v4, s[48:51], s26 offen offset:2048 lds
M v[40:43], v[116:119], a[196:199], v[40:43]
ds_read_b64_tr_b16 v[168:169], v17 offset:16384
ds_read_b64_tr_b16 v[170:171], v17 offset:20480
M v[44:47], v[124:127], a[196:199], 0
buffer_load_dwordx4 v5, s[48:51], s26 offen offset:3072 lds
M v[44:47], v[120:123], a[192:195], v[44:47]
M v[48:51], v[128:131], a[192:195], 0
ds_read_b64_tr_b16 v[172:173], v17 offset:24576
ds_read_b64_tr_b16 v[174:175], v17 offset:28672
M v[48:51], v[132:135], a[196:199], v[48:51]
buffer_load_dwordx4 a[144:147], v1, s[44:47], s25 offen offset:0 sc1
M v[52:55], v[140:143], a[196:199], 0
ds_read_b64_tr_b16 v[176:177], v18 offset:16384
ds_read_b64_tr_b16 v[178:179], v18 offset:20480
M v[52:55], v[136:139], a[192:195], v[52:55]
buffer_load_dwordx4 a[148:151], v1, s[44:47], s25 offen offset:1024 sc1
M v[56:59], v[144:147], a[192:195], 0
ds_read_b64_tr_b16 v[180:181], v18 offset:24576
ds_read_b64_tr_b16 v[182:183], v18 offset:28672
M v[56:59], v[148:151], a[196:199], v[56:59]
buffer_load_dwordx4 a[152:155], v1, s[44:47], s25 offen offset:2048 sc1
M v[60:63], v[156:159], a[196:199], 0
M v[60:63], v[152:155], a[192:195], v[60:63]
ds_read_b64_tr_b16 v[184:185], v19 offset:16384
ds_read_b64_tr_b16 v[186:187], v19 offset:20480
M v[64:67], v[96:99], a[200:203], 0
buffer_load_dwordx4 a[156:159], v1, s[44:47], s25 offen offset:3072 sc1
M v[64:67], v[100:103], a[204:207], v[64:67]
ds_read_b64_tr_b16 v[188:189], v19 offset:24576
ds_read_b64_tr_b16 v[190:191], v19 offset:28672
M v[68:71], v[108:111], a[204:207], 0
s_sub_u32 s39, s39, 1
s_cmp_eq_u32 s39, 0
s_cselect_b32 s3, s64, s65
M v[68:71], v[104:107], a[200:203], v[68:71]
ds_read_b64_tr_b16 v[192:193], v20 offset:16384
ds_read_b64_tr_b16 v[194:195], v20 offset:20480
M v[72:75], v[112:115], a[200:203], 0
s_add_u32 s25, s25, s3
s_lshl_b32 s3, s3, 3
s_add_u32 s26, s26, s3
M v[72:75], v[116:119], a[204:207], v[72:75]
ds_read_b64_tr_b16 v[196:197], v20 offset:24576
ds_read_b64_tr_b16 v[198:199], v20 offset:28672
M v[76:79], v[124:127], a[204:207], 0
M v[76:79], v[120:123], a[200:203], v[76:79]
ds_read_b64_tr_b16 v[200:201], v21 offset:16384
ds_read_b64_tr_b16 v[202:203], v21 offset:20480
M v[80:83], v[128:131], a[200:203], 0
ds_read_b64_tr_b16 v[204:205], v21 offset:24576
ds_read_b64_tr_b16 v[206:207], v21 offset:28672
M v[80:83], v[132:135], a[204:207], v[80:83]
ds_read_b64_tr_b16 v[208:209], v22 offset:16384
ds_read_b64_tr_b16 v[210:211], v22 offset:20480
M v[84:87], v[140:143], a[204:207], 0
ds_read_b64_tr_b16 v[212:213], v22 offset:24576
ds_read_b64_tr_b16 v[214:215], v22 offset:28672
M v[84:87], v[136:139], a[200:203], v[84:87]
ds_read_b64_tr_b16 v[216:217], v23 offset:16384
ds_read_b64_tr_b16 v[218:219], v23 offset:20480
M v[88:91], v[144:147], a[200:203], 0
ds_read_b64_tr_b16 v[220:221], v23 offset:24576
ds_read_b64_tr_b16 v[222:223], v23 offset:28672
M v[88:91], v[148:151], a[204:207], v[88:91]
M v[92:95], v[156:159], a[204:207], 0
M v[92:95], v[152:155], a[200:203], v[92:95]
s_mov_b32 s28, 3
Lk3_la:
s_waitcnt vmcnt(24) lgkmcnt(0)
s_barrier
M v[32:35], v[160:163], a[208:211], v[32:35]
s_add_u32 m0, s41, 32768
s_nop 0
buffer_load_dwordx4 v2, s[48:51], s26 offen offset:0 lds
M v[32:35], v[164:167], a[212:215], v[32:35]
ds_read_b64_tr_b16 v[96:97], v16 offset:32768
ds_read_b64_tr_b16 v[98:99], v16 offset:36864
M v[36:39], v[172:175], a[212:215], v[36:39]
buffer_load_dwordx4 v3, s[48:51], s26 offen offset:1024 lds
M v[36:39], v[168:171], a[208:211], v[36:39]
ds_read_b64_tr_b16 v[100:101], v16 offset:40960
ds_read_b64_tr_b16 v[102:103], v16 offset:45056
M v[40:43], v[176:179], a[208:211], v[40:43]
buffer_load_dwordx4 v4, s[48:51], s26 offen offset:2048 lds
M v[40:43], v[180:183], a[212:215], v[40:43]
ds_read_b64_tr_b16 v[104:105], v17 offset:32768
ds_read_b64_tr_b16 v[106:107], v17 offset:36864
M v[44:47], v[188:191], a[212:215], v[44:47]
buffer_load_dwordx4 v5, s[48:51], s26 offen offset:3072 lds
M v[44:47], v[184:187], a[208:211], v[44:47]
M v[48:51], v[192:195], a[208:211], v[48:51]
ds_read_b64_tr_b16 v[108:109], v17 offset:40960
ds_read_b64_tr_b16 v[110:111], v17 offset:45056
M v[48:51], v[196:199], a[212:215], v[48:51]
buffer_load_dwordx4 a[160:163], v1, s[44:47], s25 offen offset:0 sc1
M v[52:55], v[204:207], a[212:215], v[52:55]
ds_read_b64_tr_b16 v[112:113], v18 offset:32768
ds_read_b64_tr_b16 v[114:115], v18 offset:36864
M v[52:55], v[200:203], a[208:211], v[52:55]
buffer_load_dwordx4 a[164:167], v1, s[44:47], s25 offen offset:1024 sc1
M v[56:59], v[208:211], a[208:211], v[56:59]
ds_read_b64_tr_b16 v[116:117], v18 offset:40960
ds_read_b64_tr_b16 v[118:119], v18 offset:45056
M v[56:59], v[212:215], a[212:215], v[56:59]
buffer_load_dwordx4 a[168:171], v1, s[44:47], s25 offen offset:2048 sc1
M v[60:63], v[220:223], a[212:215], v[60:63]
M v[60:63], v[216:219], a[208:211], v[60:63]
ds_read_b64_tr_b16 v[120:121], v19 offset:32768
ds_read_b64_tr_b16 v[122:123], v19 offset:36864
M v[64:67], v[160:163], a[216:219], v[64:67]
buffer_load_dwordx4 a[172:175], v1, s[44:47], s25 offen offset:3072 sc1
M v[64:67], v[164:167], a[220:223], v[64:67]
ds_read_b64_tr_b16 v[124:125], v19 offset:40960
ds_read_b64_tr_b16 v[126:127], v19 offset:45056
M v[68:71], v[172:175], a[220:223], v[68:71]
s_sub_u32 s39, s39, 1
s_cmp_eq_u32 s39, 0
s_cselect_b32 s3, s64, s65
M v[68:71], v[168:171], a[216:219], v[68:71]
ds_read_b64_tr_b16 v[128:129], v20 offset:32768
ds_read_b64_tr_b16 v[130:131], v20 offset:36864
M v[72:75], v[176:179], a[216:219], v[72:75]
s_add_u32 s25, s25, s3
s_lshl_b32 s3, s3, 3
s_add_u32 s26, s26, s3
M v[72:75], v[180:183], a[220:223], v[72:75]
ds_read_b64_tr_b16 v[132:133], v20 offset:40960
ds_read_b64_tr_b16 v[134:135], v20 offset:45056
M v[76:79], v[188:191], a[220:223], v[76:79]
M v[76:79], v[184:187], a[216:219], v[76:79]
ds_read_b64_tr_b16 v[136:137], v21 offset:32768
ds_read_b64_tr_b16 v[138:139], v21 offset:36864
M v[80:83], v[192:195], a[216:219], v[80:83]
ds_read_b64_tr_b16 v[140:141], v21 offset:40960
ds_read_b64_tr_b16 v[142:143], v21 offset:45056
M v[80:83], v[196:199], a[220:223], v[80:83]
ds_read_b64_tr_b16 v[144:145], v22 offset:32768
ds_read_b64_tr_b16 v[146:147], v22 offset:36864
M v[84:87], v[204:207], a[220:223], v[84:87]
ds_read_b64_tr_b16 v[148:149], v22 offset:40960
ds_read_b64_tr_b16 v[150:151], v22 offset:45056
M v[84:87], v[200:203], a[216:219], v[84:87]
ds_read_b64_tr_b16 v[152:153], v23 offset:32768
ds_read_b64_tr_b16 v[154:155], v23 offset:36864
M v[88:91], v[208:211], a[216:219], v[88:91]
ds_read_b64_tr_b16 v[156:157], v23 offset:40960
ds_read_b64_tr_b16 v[158:159], v23 offset:45056
M v[88:91], v[212:215], a[220:223], v[88:91]
M v[92:95], v[220:223], a[220:223], v[92:95]
M v[92:95], v[216:219], a[216:219], v[92:95]
s_waitcnt vmcnt(24) lgkmcnt(0)
s_barrier
M v[32:35], v[96:99], a[224:227], v[32:35]
s_add_u32 m0, s41, 49152
s_nop 0
buffer_load_dwordx4 v2, s[48:51], s26 offen offset:0 lds
M v[32:35], v[100:103], a[228:231], v[32:35]
ds_read_b64_tr_b16 v[160:161], v16 offset:49152
ds_read_b64_tr_b16 v[162:163], v16 offset:53248
M v[36:39], v[108:111], a[228:231], v[36:39]
buffer_load_dwordx4 v3, s[48:51], s26 offen offset:1024 lds
M v[36:39], v[104:107], a[224:227], v[36:39]
ds_read_b64_tr_b16 v[164:165], v16 offset:57344
ds_read_b64_tr_b16 v[166:167], v16 offset:61440
M v[40:43], v[112:115], a[224:227], v[40:43]
buffer_load_dwordx4 v4, s[48:51], s26 offen offset:2048 lds
M v[40:43], v[116:119], a[228:231], v[40:43]
ds_read_b64_tr_b16 v[168:169], v17 offset:49152
ds_read_b64_tr_b16 v[170:171], v17 offset:53248
M v[44:47], v[124:127], a[228:231], v[44:47]
buffer_load_dwordx4 v5, s[48:51], s26 offen offset:3072 lds
M v[44:47], v[120:123], a[224:227], v[44:47]
M v[48:51], v[128:131], a[224:227], v[48:51]
ds_read_b64_tr_b16 v[172:173], v17 offset:57344
ds_read_b64_tr_b16 v[174:175], v17 offset:61440
M v[48:51], v[132:135], a[228:231], v[48:51]
buffer_load_dwordx4 a[176:179], v1, s[44:47], s25 offen offset:0 sc1
M v[52:55], v[140:143], a[228:231], v[52:55]
ds_read_b64_tr_b16 v[176:177], v18 offset:49152
ds_read_b64_tr_b16 v[178:179], v18 offset:53248
M v[52:55], v[136:139], a[224:227], v[52:55]
buffer_load_dwordx4 a[180:183], v1, s[44:47], s25 offen offset:1024 sc1
M v[56:59], v[144:147], a[224:227], v[56:59]
ds_read_b64_tr_b16 v[180:181], v18 offset:57344
ds_read_b64_tr_b16 v[182:183], v18 offset:61440
M v[56:59], v[148:151], a[228:231], v[56:59]
buffer_load_dwordx4 a[184:187], v1, s[44:47], s25 offen offset:2048 sc1
M v[60:63], v[156:159], a[228:231], v[60:63]
M v[60:63], v[152:155], a[224:227], v[60:63]
ds_read_b64_tr_b16 v[184:185], v19 offset:49152
ds_read_b64_tr_b16 v[186:187], v19 offset:53248
M v[64:67], v[96:99], a[232:235], v[64:67]
buffer_load_dwordx4 a[188:191], v1, s[44:47], s25 offen offset:3072 sc1
M v[64:67], v[100:103], a[236:239], v[64:67]
ds_read_b64_tr_b16 v[188:189], v19 offset:57344
ds_read_b64_tr_b16 v[190:191], v19 offset:61440
M v[68:71], v[108:111], a[236:239], v[68:71]
s_sub_u32 s39, s39, 1
s_cmp_eq_u32 s39, 0
s_cselect_b32 s3, s64, s65
M v[68:71], v[104:107], a[232:235], v[68:71]
ds_read_b64_tr_b16 v[192:193], v20 offset:49152
ds_read_b64_tr_b16 v[194:195], v20 offset:53248
M v[72:75], v[112:115], a[232:235], v[72:75]
s_add_u32 s25, s25, s3
s_lshl_b32 s3, s3, 3
s_add_u32 s26, s26, s3
M v[72:75], v[116:119], a[236:239], v[72:75]
ds_read_b64_tr_b16 v[196:197], v20 offset:57344
ds_read_b64_tr_b16 v[198:199], v20 offset:61440
M v[76:79], v[124:127], a[236:239], v[76:79]
M v[76:79], v[120:123], a[232:235], v[76:79]
ds_read_b64_tr_b16 v[200:201], v21 offset:49152
ds_read_b64_tr_b16 v[202:203], v21 offset:53248
M v[80:83], v[128:131], a[232:235], v[80:83]
ds_read_b64_tr_b16 v[204:205], v21 offset:57344
ds_read_b64_tr_b16 v[206:207], v21 offset:61440
M v[80:83], v[132:135], a[236:239], v[80:83]
ds_read_b64_tr_b16 v[208:209], v22 offset:49152
ds_read_b64_tr_b16 v[210:211], v22 offset:53248
M v[84:87], v[140:143], a[236:239], v[84:87]
ds_read_b64_tr_b16 v[212:213], v22 offset:57344
ds_read_b64_tr_b16 v[214:215], v22 offset:61440
M v[84:87], v[136:139], a[232:235], v[84:87]
ds_read_b64_tr_b16 v[216:217], v23 offset:49152
ds_read_b64_tr_b16 v[218:219], v23 offset:53248
M v[88:91], v[144:147], a[232:235], v[88:91]
ds_read_b64_tr_b16 v[220:221], v23 offset:57344
ds_read_b64_tr_b16 v[222:223], v23 offset:61440
M v[88:91], v[148:151], a[236:239], v[88:91]
M v[92:95], v[156:159], a[236:239], v[92:95]
M v[92:95], v[152:155], a[232:235], v[92:95]
s_waitcnt vmcnt(24) lgkmcnt(0)
s_barrier
M v[32:35], v[160:163], a[240:243], v[32:35]
s_add_u32 m0, s41, 65536
s_nop 0
buffer_load_dwordx4 v2, s[48:51], s26 offen offset:0 lds
M v[32:35], v[164:167], a[244:247], v[32:35]
ds_read_b64_tr_b16 v[96:97], v8 offset:0
ds_read_b64_tr_b16 v[98:99], v8 offset:4096
M v[36:39], v[172:175], a[244:247], v[36:39]
buffer_load_dwordx4 v3, s[48:51], s26 offen offset:1024 lds
M v[36:39], v[168:171], a[240:243], v[36:39]
ds_read_b64_tr_b16 v[100:101], v8 offset:8192
ds_read_b64_tr_b16 v[102:103], v8 offset:12288
M v[40:43], v[176:179], a[240:243], v[40:43]
buffer_load_dwordx4 v4, s[48:51], s26 offen offset:2048 lds
M v[40:43], v[180:183], a[244:247], v[40:43]
ds_read_b64_tr_b16 v[104:105], v9 offset:0
ds_read_b64_tr_b16 v[106:107], v9 offset:4096
M v[44:47], v[188:191], a[244:247], v[44:47]
buffer_load_dwordx4 v5, s[48:51], s26 offen offset:3072 lds
M v[44:47], v[184:187], a[240:243], v[44:47]
M v[48:51], v[192:195], a[240:243], v[48:51]
ds_read_b64_tr_b16 v[108:109], v9 offset:8192
ds_read_b64_tr_b16 v[110:111], v9 offset:12288
M v[48:51], v[196:199], a[244:247], v[48:51]
buffer_load_dwordx4 a[192:195], v1, s[44:47], s25 offen offset:0 sc1
M v[52:55], v[204:207], a[244:247], v[52:55]
ds_read_b64_tr_b16 v[112:113], v10 offset:0
ds_read_b64_tr_b16 v[114:115], v10 offset:4096
M v[52:55], v[200:203], a[240:243], v[52:55]
buffer_load_dwordx4 a[196:199], v1, s[44:47], s25 offen offset:1024 sc1
M v[56:59], v[208:211], a[240:243], v[56:59]
ds_read_b64_tr_b16 v[116:117], v10 offset:8192
ds_read_b64_tr_b16 v[118:119], v10 offset:12288
M v[56:59], v[212:215], a[244:247], v[56:59]
buffer_load_dwordx4 a[200:203], v1, s[44:47], s25 offen offset:2048 sc1
M v[60:63], v[220:223], a[244:247], v[60:63]
M v[60:63], v[216:219], a[240:243], v[60:63]
ds_read_b64_tr_b16 v[120:121], v11 offset:0
ds_read_b64_tr_b16 v[122:123], v11 offset:4096
M v[64:67], v[160:163], a[248:251], v[64:67]
buffer_load_dwordx4 a[204:207], v1, s[44:47], s25 offen offset:3072 sc1
M v[64:67], v[164:167], a[252:255], v[64:67]
ds_read_b64_tr_b16 v[124:125], v11 offset:8192
ds_read_b64_tr_b16 v[126:127], v11 offset:12288
M v[68:71], v[172:175], a[252:255], v[68:71]
s_sub_u32 s39, s39, 1
s_cmp_eq_u32 s39, 0
s_cselect_b32 s3, s64, s65
M v[68:71], v[168:171], a[248:251], v[68:71]
ds_read_b64_tr_b16 v[128:129], v12 offset:0
ds_read_b64_tr_b16 v[130:131], v12 offset:4096
M v[72:75], v[176:179], a[248:251], v[72:75]
s_add_u32 s25, s25, s3
s_lshl_b32 s3, s3, 3
s_add_u32 s26, s26, s3
M v[72:75], v[180:183], a[252:255], v[72:75]
ds_read_b64_tr_b16 v[132:133], v12 offset:8192
ds_read_b64_tr_b16 v[134:135], v12 offset:12288
M v[76:79], v[188:191], a[252:255], v[76:79]
M v[76:79], v[184:187], a[248:251], v[76:79]
ds_read_b64_tr_b16 v[136:137], v13 offset:0
ds_read_b64_tr_b16 v[138:139], v13 offset:4096
M v[80:83], v[192:195], a[248:251], v[80:83]
ds_read_b64_tr_b16 v[140:141], v13 offset:8192
ds_read_b64_tr_b16 v[142:143], v13 offset:12288
M v[80:83], v[196:199], a[252:255], v[80:83]
ds_read_b64_tr_b16 v[144:145], v14 offset:0
ds_read_b64_tr_b16 v[146:147], v14 offset:4096
M v[84:87], v[204:207], a[252:255], v[84:87]
ds_read_b64_tr_b16 v[148:149], v14 offset:8192
ds_read_b64_tr_b16 v[150:151], v14 offset:12288
M v[84:87], v[200:203], a[248:251], v[84:87]
ds_read_b64_tr_b16 v[152:153], v15 offset:0
ds_read_b64_tr_b16 v[154:155], v15 offset:4096
M v[88:91], v[208:211], a[248:251], v[88:91]
ds_read_b64_tr_b16 v[156:157], v15 offset:8192
ds_read_b64_tr_b16 v[158:159], v15 offset:12288
M v[88:91], v[212:215], a[252:255], v[88:91]
M v[92:95], v[220:223], a[252:255], v[92:95]
M v[92:95], v[216:219], a[248:251], v[92:95]
s_waitcnt vmcnt(24) lgkmcnt(0)
s_barrier
M v[32:35], v[96:99], a[128:131], v[32:35]
s_add_u32 m0, s41, 81920
s_nop 0
buffer_load_dwordx4 v2, s[48:51], s26 offen offset:0 lds
M v[32:35], v[100:103], a[132:135], v[32:35]
ds_read_b64_tr_b16 v[160:161], v8 offset:16384
ds_read_b64_tr_b16 v[162:163], v8 offset:20480
M v[36:39], v[108:111], a[132:135], v[36:39]
buffer_load_dwordx4 v3, s[48:51], s26 offen offset:1024 lds
M v[36:39], v[104:107], a[128:131], v[36:39]
ds_read_b64_tr_b16 v[164:165], v8 offset:24576
ds_read_b64_tr_b16 v[166:167], v8 offset:28672
M v[40:43], v[112:115], a[128:131], v[40:43]
buffer_load_dwordx4 v4, s[48:51], s26 offen offset:2048 lds
M v[40:43], v[116:119], a[132:135], v[40:43]
ds_read_b64_tr_b16 v[168:169], v9 offset:16384
ds_read_b64_tr_b16 v[170:171], v9 offset:20480
M v[44:47], v[124:127], a[132:135], v[44:47]
buffer_load_dwordx4 v5, s[48:51], s26 offen offset:3072 lds
M v[44:47], v[120:123], a[128:131], v[44:47]
M v[48:51], v[128:131], a[128:131], v[48:51]
ds_read_b64_tr_b16 v[172:173], v9 offset:24576
ds_read_b64_tr_b16 v[174:175], v9 offset:28672
M v[48:51], v[132:135], a[132:135], v[48:51]
buffer_load_dwordx4 a[208:211], v1, s[44:47], s25 offen offset:0 sc1
M v[52:55], v[140:143], a[132:135], v[52:55]
ds_read_b64_tr_b16 v[176:177], v10 offset:16384
ds_read_b64_tr_b16 v[178:179], v10 offset:20480
M v[52:55], v[136:139], a[128:131], v[52:55]
buffer_load_dwordx4 a[212:215], v1, s[44:47], s25 offen offset:1024 sc1
M v[56:59], v[144:147], a[128:131], v[56:59]
ds_read_b64_tr_b16 v[180:181], v10 offset:24576
ds_read_b64_tr_b16 v[182:183], v10 offset:28672
M v[56:59], v[148:151], a[132:135], v[56:59]
buffer_load_dwordx4 a[216:219], v1, s[44:47], s25 offen offset:2048 sc1
M v[60:63], v[156:159], a[132:135], v[60:63]
M v[60:63], v[152:155], a[128:131], v[60:63]
ds_read_b64_tr_b16 v[184:185], v11 offset:16384
ds_read_b64_tr_b16 v[186:187], v11 offset:20480
M v[64:67], v[96:99], a[136:139], v[64:67]
buffer_load_dwordx4 a[220:223], v1, s[44:47], s25 offen offset:3072 sc1
M v[64:67], v[100:103], a[140:143], v[64:67]
ds_read_b64_tr_b16 v[188:189], v11 offset:24576
ds_read_b64_tr_b16 v[190:191], v11 offset:28672
M v[68:71], v[108:111], a[140:143], v[68:71]
s_sub_u32 s39, s39, 1
s_cmp_eq_u32 s39, 0
s_cselect_b32 s3, s64, s65
M v[68:71], v[104:107], a[136:139], v[68:71]
ds_read_b64_tr_b16 v[192:193], v12 offset:16384
ds_read_b64_tr_b16 v[194:195], v12 offset:20480
M v[72:75], v[112:115], a[136:139], v[72:75]
s_add_u32 s25, s25, s3
s_lshl_b32 s3, s3, 3
s_add_u32 s26, s26, s3
M v[72:75], v[116:119], a[140:143], v[72:75]
ds_read_b64_tr_b16 v[196:197], v12 offset:24576
ds_read_b64_tr_b16 v[198:199], v12 offset:28672
M v[76:79], v[124:127], a[140:143], v[76:79]
M v[76:79], v[120:123], a[136:139], v[76:79]
ds_read_b64_tr_b16 v[200:201], v13 offset:16384
ds_read_b64_tr_b16 v[202:203], v13 offset:20480
M v[80:83], v[128:131], a[136:139], v[80:83]
ds_read_b64_tr_b16 v[204:205], v13 offset:24576
ds_read_b64_tr_b16 v[206:207], v13 offset:28672
M v[80:83], v[132:135], a[140:143], v[80:83]
ds_read_b64_tr_b16 v[208:209], v14 offset:16384
ds_read_b64_tr_b16 v[210:211], v14 offset:20480
M v[84:87], v[140:143], a[140:143], v[84:87]
ds_read_b64_tr_b16 v[212:213], v14 offset:24576
ds_read_b64_tr_b16 v[214:215], v14 offset:28672
M v[84:87], v[136:139], a[136:139], v[84:87]
ds_read_b64_tr_b16 v[216:217], v15 offset:16384
ds_read_b64_tr_b16 v[218:219], v15 offset:20480
M v[88:91], v[144:147], a[136:139], v[88:91]
ds_read_b64_tr_b16 v[220:221], v15 offset:24576
ds_read_b64_tr_b16 v[222:223], v15 offset:28672
M v[88:91], v[148:151], a[140:143], v[88:91]
M v[92:95], v[156:159], a[140:143], v[92:95]
M v[92:95], v[152:155], a[136:139], v[92:95]
s_waitcnt vmcnt(24) lgkmcnt(0)
s_barrier
M v[32:35], v[160:163], a[144:147], v[32:35]
s_add_u32 m0, s41, 98304
s_nop 0
buffer_load_dwordx4 v2, s[48:51], s26 offen offset:0 lds
M v[32:35], v[164:167], a[148:151], v[32:35]
ds_read_b64_tr_b16 v[96:97], v8 offset:32768
ds_read_b64_tr_b16 v[98:99], v8 offset:36864
M v[36:39], v[172:175], a[148:151], v[36:39]
buffer_load_dwordx4 v3, s[48:51], s26 offen offset:1024 lds
M v[36:39], v[168:171], a[144:147], v[36:39]
ds_read_b64_tr_b16 v[100:101], v8 offset:40960
ds_read_b64_tr_b16 v[102:103], v8 offset:45056
M v[40:43], v[176:179], a[144:147], v[40:43]
buffer_load_dwordx4 v4, s[48:51], s26 offen offset:2048 lds
M v[40:43], v[180:183], a[148:151], v[40:43]
ds_read_b64_tr_b16 v[104:105], v9 offset:32768
ds_read_b64_tr_b16 v[106:107], v9 offset:36864
M v[44:47], v[188:191], a[148:151], v[44:47]
buffer_load_dwordx4 v5, s[48:51], s26 offen offset:3072 lds
M v[44:47], v[184:187], a[144:147], v[44:47]
M v[48:51], v[192:195], a[144:147], v[48:51]
ds_read_b64_tr_b16 v[108:109], v9 offset:40960
ds_read_b64_tr_b16 v[110:111], v9 offset:45056
M v[48:51], v[196:199], a[148:151], v[48:51]
buffer_load_dwordx4 a[224:227], v1, s[44:47], s25 offen offset:0 sc1
M v[52:55], v[204:207], a[148:151], v[52:55]
ds_read_b64_tr_b16 v[112:113], v10 offset:32768
ds_read_b64_tr_b16 v[114:115], v10 offset:36864
M v[52:55], v[200:203], a[144:147], v[52:55]
buffer_load_dwordx4 a[228:231], v1, s[44:47], s25 offen offset:1024 sc1
M v[56:59], v[208:211], a[144:147], v[56:59]
ds_read_b64_tr_b16 v[116:117], v10 offset:40960
ds_read_b64_tr_b16 v[118:119], v10 offset:45056
M v[56:59], v[212:215], a[148:151], v[56:59]
buffer_load_dwordx4 a[232:235], v1, s[44:47], s25 offen offset:2048 sc1
M v[60:63], v[220:223], a[148:151], v[60:63]
M v[60:63], v[216:219], a[144:147], v[60:63]
ds_read_b64_tr_b16 v[120:121], v11 offset:32768
ds_read_b64_tr_b16 v[122:123], v11 offset:36864
M v[64:67], v[160:163], a[152:155], v[64:67]
buffer_load_dwordx4 a[236:239], v1, s[44:47], s25 offen offset:3072 sc1
M v[64:67], v[164:167], a[156:159], v[64:67]
ds_read_b64_tr_b16 v[124:125], v11 offset:40960
ds_read_b64_tr_b16 v[126:127], v11 offset:45056
M v[68:71], v[172:175], a[156:159], v[68:71]
s_sub_u32 s39, s39, 1
s_cmp_eq_u32 s39, 0
s_cselect_b32 s3, s64, s65
M v[68:71], v[168:171], a[152:155], v[68:71]
ds_read_b64_tr_b16 v[128:129], v12 offset:32768
ds_read_b64_tr_b16 v[130:131], v12 offset:36864
M v[72:75], v[176:179], a[152:155], v[72:75]
s_add_u32 s25, s25, s3
s_lshl_b32 s3, s3, 3
s_add_u32 s26, s26, s3
M v[72:75], v[180:183], a[156:159], v[72:75]
ds_read_b64_tr_b16 v[132:133], v12 offset:40960
ds_read_b64_tr_b16 v[134:135], v12 offset:45056
M v[76:79], v[188:191], a[156:159], v[76:79]
M v[76:79], v[184:187], a[152:155], v[76:79]
ds_read_b64_tr_b16 v[136:137], v13 offset:32768
ds_read_b64_tr_b16 v[138:139], v13 offset:36864
M v[80:83], v[192:195], a[152:155], v[80:83]
ds_read_b64_tr_b16 v[140:141], v13 offset:40960
ds_read_b64_tr_b16 v[142:143], v13 offset:45056
M v[80:83], v[196:199], a[156:159], v[80:83]
ds_read_b64_tr_b16 v[144:145], v14 offset:32768
ds_read_b64_tr_b16 v[146:147], v14 offset:36864
M v[84:87], v[204:207], a[156:159], v[84:87]
ds_read_b64_tr_b16 v[148:149], v14 offset:40960
ds_read_b64_tr_b16 v[150:151], v14 offset:45056
M v[84:87], v[200:203], a[152:155], v[84:87]
ds_read_b64_tr_b16 v[152:153], v15 offset:32768
ds_read_b64_tr_b16 v[154:155], v15 offset:36864
M v[88:91], v[208:211], a[152:155], v[88:91]
ds_read_b64_tr_b16 v[156:157], v15 offset:40960
ds_read_b64_tr_b16 v[158:159], v15 offset:45056
M v[88:91], v[212:215], a[156:159], v[88:91]
M v[92:95], v[220:223], a[156:159], v[92:95]
M v[92:95], v[216:219], a[152:155], v[92:95]
s_waitcnt vmcnt(24) lgkmcnt(0)
s_barrier
M v[32:35], v[96:99], a[160:163], v[32:35]
s_add_u32 m0, s41, 114688
s_nop 0
buffer_load_dwordx4 v2, s[48:51], s26 offen offset:0 lds
M v[32:35], v[100:103], a[164:167], v[32:35]
ds_read_b64_tr_b16 v[160:161], v8 offset:49152
ds_read_b64_tr_b16 v[162:163], v8 offset:53248
M v[36:39], v[108:111], a[164:167], v[36:39]
buffer_load_dwordx4 v3, s[48:51], s26 offen offset:1024 lds
M v[36:39], v[104:107], a[160:163], v[36:39]
ds_read_b64_tr_b16 v[164:165], v8 offset:57344
ds_read_b64_tr_b16 v[166:167], v8 offset:61440
M v[40:43], v[112:115], a[160:163], v[40:43]
buffer_load_dwordx4 v4, s[48:51], s26 offen offset:2048 lds
M v[40:43], v[116:119], a[164:167], v[40:43]
ds_read_b64_tr_b16 v[168:169], v9 offset:49152
ds_read_b64_tr_b16 v[170:171], v9 offset:53248
M v[44:47], v[124:127], a[164:167], v[44:47]
buffer_load_dwordx4 v5, s[48:51], s26 offen offset:3072 lds
M v[44:47], v[120:123], a[160:163], v[44:47]
M v[48:51], v[128:131], a[160:163], v[48:51]
ds_read_b64_tr_b16 v[172:173], v9 offset:57344
ds_read_b64_tr_b16 v[174:175], v9 offset:61440
M v[48:51], v[132:135], a[164:167], v[48:51]
buffer_load_dwordx4 a[240:243], v1, s[44:47], s25 offen offset:0 sc1
M v[52:55], v[140:143], a[164:167], v[52:55]
ds_read_b64_tr_b16 v[176:177], v10 offset:49152
ds_read_b64_tr_b16 v[178:179], v10 offset:53248
M v[52:55], v[136:139], a[160:163], v[52:55]
buffer_load_dwordx4 a[244:247], v1, s[44:47], s25 offen offset:1024 sc1
M v[56:59], v[144:147], a[160:163], v[56:59]
ds_read_b64_tr_b16 v[180:181], v10 offset:57344
ds_read_b64_tr_b16 v[182:183], v10 offset:61440
M v[56:59], v[148:151], a[164:167], v[56:59]
buffer_load_dwordx4 a[248:251], v1, s[44:47], s25 offen offset:2048 sc1
M v[60:63], v[156:159], a[164:167], v[60:63]
M v[60:63], v[152:155], a[160:163], v[60:63]
ds_read_b64_tr_b16 v[184:185], v11 offset:49152
ds_read_b64_tr_b16 v[186:187], v11 offset:53248
M v[64:67], v[96:99], a[168:171], v[64:67]
buffer_load_dwordx4 a[252:255], v1, s[44:47], s25 offen offset:3072 sc1
M v[64:67], v[100:103], a[172:175], v[64:67]
ds_read_b64_tr_b16 v[188:189], v11 offset:57344
ds_read_b64_tr_b16 v[190:191], v11 offset:61440
M v[68:71], v[108:111], a[172:175], v[68:71]
s_sub_u32 s39, s39, 1
s_cmp_eq_u32 s39, 0
s_cselect_b32 s3, s64, s65
M v[68:71], v[104:107], a[168:171], v[68:71]
ds_read_b64_tr_b16 v[192:193], v12 offset:49152
ds_read_b64_tr_b16 v[194:195], v12 offset:53248
M v[72:75], v[112:115], a[168:171], v[72:75]
s_add_u32 s25, s25, s3
s_lshl_b32 s3, s3, 3
s_add_u32 s26, s26, s3
M v[72:75], v[116:119], a[172:175], v[72:75]
ds_read_b64_tr_b16 v[196:197], v12 offset:57344
ds_read_b64_tr_b16 v[198:199], v12 offset:61440
M v[76:79], v[124:127], a[172:175], v[76:79]
M v[76:79], v[120:123], a[168:171], v[76:79]
ds_read_b64_tr_b16 v[200:201], v13 offset:49152
ds_read_b64_tr_b16 v[202:203], v13 offset:53248
M v[80:83], v[128:131], a[168:171], v[80:83]
ds_read_b64_tr_b16 v[204:205], v13 offset:57344
ds_read_b64_tr_b16 v[206:207], v13 offset:61440
M v[80:83], v[132:135], a[172:175], v[80:83]
ds_read_b64_tr_b16 v[208:209], v14 offset:49152
ds_read_b64_tr_b16 v[210:211], v14 offset:53248
M v[84:87], v[140:143], a[172:175], v[84:87]
ds_read_b64_tr_b16 v[212:213], v14 offset:57344
ds_read_b64_tr_b16 v[214:215], v14 offset:61440
M v[84:87], v[136:139], a[168:171], v[84:87]
ds_read_b64_tr_b16 v[216:217], v15 offset:49152
ds_read_b64_tr_b16 v[218:219], v15 offset:53248
M v[88:91], v[144:147], a[168:171], v[88:91]
ds_read_b64_tr_b16 v[220:221], v15 offset:57344
ds_read_b64_tr_b16 v[222:223], v15 offset:61440
M v[88:91], v[148:151], a[172:175], v[88:91]
M v[92:95], v[156:159], a[172:175], v[92:95]
M v[92:95], v[152:155], a[168:171], v[92:95]
s_waitcnt vmcnt(24) lgkmcnt(0)
s_barrier
M v[32:35], v[160:163], a[176:179], v[32:35]
s_add_u32 m0, s41, 0
s_nop 0
buffer_load_dwordx4 v2, s[48:51], s26 offen offset:0 lds
M v[32:35], v[164:167], a[180:183], v[32:35]
ds_read_b64_tr_b16 v[96:97], v16 offset:0
ds_read_b64_tr_b16 v[98:99], v16 offset:4096
M v[36:39], v[172:175], a[180:183], v[36:39]
buffer_load_dwordx4 v3, s[48:51], s26 offen offset:1024 lds
M v[36:39], v[168:171], a[176:179], v[36:39]
ds_read_b64_tr_b16 v[100:101], v16 offset:8192
ds_read_b64_tr_b16 v[102:103], v16 offset:12288
M v[40:43], v[176:179], a[176:179], v[40:43]
buffer_load_dwordx4 v4, s[48:51], s26 offen offset:2048 lds
M v[40:43], v[180:183], a[180:183], v[40:43]
ds_read_b64_tr_b16 v[104:105], v17 offset:0
ds_read_b64_tr_b16 v[106:107], v17 offset:4096
M v[44:47], v[188:191], a[180:183], v[44:47]
buffer_load_dwordx4 v5, s[48:51], s26 offen offset:3072 lds
M v[44:47], v[184:187], a[176:179], v[44:47]
M v[48:51], v[192:195], a[176:179], v[48:51]
ds_read_b64_tr_b16 v[108:109], v17 offset:8192
ds_read_b64_tr_b16 v[110:111], v17 offset:12288
M v[48:51], v[196:199], a[180:183], v[48:51]
buffer_load_dwordx4 a[128:131], v1, s[44:47], s25 offen offset:0 sc1
M v[52:55], v[204:207], a[180:183], v[52:55]
ds_read_b64_tr_b16 v[112:113], v18 offset:0
ds_read_b64_tr_b16 v[114:115], v18 offset:4096
M v[52:55], v[200:203], a[176:179], v[52:55]
buffer_load_dwordx4 a[132:135], v1, s[44:47], s25 offen offset:1024 sc1
M v[56:59], v[208:211], a[176:179], v[56:59]
ds_read_b64_tr_b16 v[116:117], v18 offset:8192
ds_read_b64_tr_b16 v[118:119], v18 offset:12288
M v[56:59], v[212:215], a[180:183], v[56:59]
buffer_load_dwordx4 a[136:139], v1, s[44:47], s25 offen offset:2048 sc1
M v[60:63], v[220:223], a[180:183], v[60:63]
M v[60:63], v[216:219], a[176:179], v[60:63]
ds_read_b64_tr_b16 v[120:121], v19 offset:0
ds_read_b64_tr_b16 v[122:123], v19 offset:4096
M v[64:67], v[160:163], a[184:187], v[64:67]
buffer_load_dwordx4 a[140:143], v1, s[44:47], s25 offen offset:3072 sc1
M v[64:67], v[164:167], a[188:191], v[64:67]
ds_read_b64_tr_b16 v[124:125], v19 offset:8192
ds_read_b64_tr_b16 v[126:127], v19 offset:12288
M v[68:71], v[172:175], a[188:191], v[68:71]
s_sub_u32 s39, s39, 1
s_cmp_eq_u32 s39, 0
s_cselect_b32 s3, s64, s65
M v[68:71], v[168:171], a[184:187], v[68:71]
ds_read_b64_tr_b16 v[128:129], v20 offset:0
ds_read_b64_tr_b16 v[130:131], v20 offset:4096
M v[72:75], v[176:179], a[184:187], v[72:75]
s_add_u32 s25, s25, s3
s_lshl_b32 s3, s3, 3
s_add_u32 s26, s26, s3
M v[72:75], v[180:183], a[188:191], v[72:75]
ds_read_b64_tr_b16 v[132:133], v20 offset:8192
ds_read_b64_tr_b16 v[134:135], v20 offset:12288
M v[76:79], v[188:191], a[188:191], v[76:79]
M v[76:79], v[184:187], a[184:187], v[76:79]
ds_read_b64_tr_b16 v[136:137], v21 offset:0
ds_read_b64_tr_b16 v[138:139], v21 offset:4096
M v[80:83], v[192:195], a[184:187], v[80:83]
ds_read_b64_tr_b16 v[140:141], v21 offset:8192
ds_read_b64_tr_b16 v[142:143], v21 offset:12288
M v[80:83], v[196:199], a[188:191], v[80:83]
ds_read_b64_tr_b16 v[144:145], v22 offset:0
ds_read_b64_tr_b16 v[146:147], v22 offset:4096
M v[84:87], v[204:207], a[188:191], v[84:87]
ds_read_b64_tr_b16 v[148:149], v22 offset:8192
ds_read_b64_tr_b16 v[150:151], v22 offset:12288
M v[84:87], v[200:203], a[184:187], v[84:87]
ds_read_b64_tr_b16 v[152:153], v23 offset:0
ds_read_b64_tr_b16 v[154:155], v23 offset:4096
M v[88:91], v[208:211], a[184:187], v[88:91]
ds_read_b64_tr_b16 v[156:157], v23 offset:8192
ds_read_b64_tr_b16 v[158:159], v23 offset:12288
M v[88:91], v[212:215], a[188:191], v[88:91]
M v[92:95], v[220:223], a[188:191], v[92:95]
M v[92:95], v[216:219], a[184:187], v[92:95]
s_waitcnt vmcnt(24) lgkmcnt(0)
s_barrier
M v[32:35], v[96:99], a[192:195], v[32:35]
s_add_u32 m0, s41, 16384
s_nop 0
buffer_load_dwordx4 v2, s[48:51], s26 offen offset:0 lds
M v[32:35], v[100:103], a[196:199], v[32:35]
ds_read_b64_tr_b16 v[160:161], v16 offset:16384
ds_read_b64_tr_b16 v[162:163], v16 offset:20480
M v[36:39], v[108:111], a[196:199], v[36:39]
buffer_load_dwordx4 v3, s[48:51], s26 offen offset:1024 lds
M v[36:39], v[104:107], a[192:195], v[36:39]
ds_read_b64_tr_b16 v[164:165], v16 offset:24576
ds_read_b64_tr_b16 v[166:167], v16 offset:28672
M v[40:43], v[112:115], a[192:195], v[40:43]
buffer_load_dwordx4 v4, s[48:51], s26 offen offset:2048 lds
M v[40:43], v[116:119], a[196:199], v[40:43]
ds_read_b64_tr_b16 v[168:169], v17 offset:16384
ds_read_b64_tr_b16 v[170:171], v17 offset:20480
M v[44:47], v[124:127], a[196:199], v[44:47]
buffer_load_dwordx4 v5, s[48:51], s26 offen offset:3072 lds
M v[44:47], v[120:123], a[192:195], v[44:47]
M v[48:51], v[128:131], a[192:195], v[48:51]
ds_read_b64_tr_b16 v[172:173], v17 offset:24576
ds_read_b64_tr_b16 v[174:175], v17 offset:28672
M v[48:51], v[132:135], a[196:199], v[48:51]
buffer_load_dwordx4 a[144:147], v1, s[44:47], s25 offen offset:0 sc1
M v[52:55], v[140:143], a[196:199], v[52:55]
ds_read_b64_tr_b16 v[176:177], v18 offset:16384
ds_read_b64_tr_b16 v[178:179], v18 offset:20480
M v[52:55], v[136:139], a[192:195], v[52:55]
buffer_load_dwordx4 a[148:151], v1, s[44:47], s25 offen offset:1024 sc1
M v[56:59], v[144:147], a[192:195], v[56:59]
ds_read_b64_tr_b16 v[180:181], v18 offset:24576
ds_read_b64_tr_b16 v[182:183], v18 offset:28672
M v[56:59], v[148:151], a[196:199], v[56:59]
buffer_load_dwordx4 a[152:155], v1, s[44:47], s25 offen offset:2048 sc1
M v[60:63], v[156:159], a[196:199], v[60:63]
M v[60:63], v[152:155], a[192:195], v[60:63]
ds_read_b64_tr_b16 v[184:185], v19 offset:16384
ds_read_b64_tr_b16 v[186:187], v19 offset:20480
M v[64:67], v[96:99], a[200:203], v[64:67]
buffer_load_dwordx4 a[156:159], v1, s[44:47], s25 offen offset:3072 sc1
M v[64:67], v[100:103], a[204:207], v[64:67]
ds_read_b64_tr_b16 v[188:189], v19 offset:24576
ds_read_b64_tr_b16 v[190:191], v19 offset:28672
M v[68:71], v[108:111], a[204:207], v[68:71]
s_sub_u32 s39, s39, 1
s_cmp_eq_u32 s39, 0
s_cselect_b32 s3, s64, s65
M v[68:71], v[104:107], a[200:203], v[68:71]
ds_read_b64_tr_b16 v[192:193], v20 offset:16384
ds_read_b64_tr_b16 v[194:195], v20 offset:20480
M v[72:75], v[112:115], a[200:203], v[72:75]
s_add_u32 s25, s25, s3
s_lshl_b32 s3, s3, 3
s_add_u32 s26, s26, s3
M v[72:75], v[116:119], a[204:207], v[72:75]
ds_read_b64_tr_b16 v[196:197], v20 offset:24576
ds_read_b64_tr_b16 v[198:199], v20 offset:28672
M v[76:79], v[124:127], a[204:207], v[76:79]
M v[76:79], v[120:123], a[200:203], v[76:79]
ds_read_b64_tr_b16 v[200:201], v21 offset:16384
ds_read_b64_tr_b16 v[202:203], v21 offset:20480
M v[80:83], v[128:131], a[200:203], v[80:83]
ds_read_b64_tr_b16 v[204:205], v21 offset:24576
ds_read_b64_tr_b16 v[206:207], v21 offset:28672
M v[80:83], v[132:135], a[204:207], v[80:83]
ds_read_b64_tr_b16 v[208:209], v22 offset:16384
ds_read_b64_tr_b16 v[210:211], v22 offset:20480
M v[84:87], v[140:143], a[204:207], v[84:87]
ds_read_b64_tr_b16 v[212:213], v22 offset:24576
ds_read_b64_tr_b16 v[214:215], v22 offset:28672
M v[84:87], v[136:139], a[200:203], v[84:87]
ds_read_b64_tr_b16 v[216:217], v23 offset:16384
ds_read_b64_tr_b16 v[218:219], v23 offset:20480
M v[88:91], v[144:147], a[200:203], v[88:91]
ds_read_b64_tr_b16 v[220:221], v23 offset:24576
ds_read_b64_tr_b16 v[222:223], v23 offset:28672
M v[88:91], v[148:151], a[204:207], v[88:91]
M v[92:95], v[156:159], a[204:207], v[92:95]
M v[92:95], v[152:155], a[200:203], v[92:95]
s_sub_u32 s28, s28, 1
s_cmp_lg_u32 s28, 0
s_cbranch_scc1 Lk3_la
s_waitcnt vmcnt(24) lgkmcnt(0)
s_barrier
M v[32:35], v[160:163], a[208:211], v[32:35]
s_add_u32 m0, s41, 32768
s_nop 0
buffer_load_dwordx4 v2, s[48:51], s26 offen offset:0 lds
M v[32:35], v[164:167], a[212:215], v[32:35]
ds_read_b64_tr_b16 v[96:97], v16 offset:32768
ds_read_b64_tr_b16 v[98:99], v16 offset:36864
M v[36:39], v[172:175], a[212:215], v[36:39]
buffer_load_dwordx4 v3, s[48:51], s26 offen offset:1024 lds
M v[36:39], v[168:171], a[208:211], v[36:39]
ds_read_b64_tr_b16 v[100:101], v16 offset:40960
ds_read_b64_tr_b16 v[102:103], v16 offset:45056
M v[40:43], v[176:179], a[208:211], v[40:43]
buffer_load_dwordx4 v4, s[48:51], s26 offen offset:2048 lds
M v[40:43], v[180:183], a[212:215], v[40:43]
ds_read_b64_tr_b16 v[104:105], v17 offset:32768
ds_read_b64_tr_b16 v[106:107], v17 offset:36864
M v[44:47], v[188:191], a[212:215], v[44:47]
buffer_load_dwordx4 v5, s[48:51], s26 offen offset:3072 lds
M v[44:47], v[184:187], a[208:211], v[44:47]
M v[48:51], v[192:195], a[208:211], v[48:51]
ds_read_b64_tr_b16 v[108:109], v17 offset:40960
ds_read_b64_tr_b16 v[110:111], v17 offset:45056
M v[48:51], v[196:199], a[212:215], v[48:51]
buffer_load_dwordx4 a[160:163], v1, s[44:47], s25 offen offset:0 sc1
M v[52:55], v[204:207], a[212:215], v[52:55]
ds_read_b64_tr_b16 v[112:113], v18 offset:32768
ds_read_b64_tr_b16 v[114:115], v18 offset:36864
M v[52:55], v[200:203], a[208:211], v[52:55]
buffer_load_dwordx4 a[164:167], v1, s[44:47], s25 offen offset:1024 sc1
M v[56:59], v[208:211], a[208:211], v[56:59]
ds_read_b64_tr_b16 v[116:117], v18 offset:40960
ds_read_b64_tr_b16 v[118:119], v18 offset:45056
M v[56:59], v[212:215], a[212:215], v[56:59]
buffer_load_dwordx4 a[168:171], v1, s[44:47], s25 offen offset:2048 sc1
M v[60:63], v[220:223], a[212:215], v[60:63]
M v[60:63], v[216:219], a[208:211], v[60:63]
ds_read_b64_tr_b16 v[120:121], v19 offset:32768
ds_read_b64_tr_b16 v[122:123], v19 offset:36864
M v[64:67], v[160:163], a[216:219], v[64:67]
buffer_load_dwordx4 a[172:175], v1, s[44:47], s25 offen offset:3072 sc1
M v[64:67], v[164:167], a[220:223], v[64:67]
ds_read_b64_tr_b16 v[124:125], v19 offset:40960
ds_read_b64_tr_b16 v[126:127], v19 offset:45056
M v[68:71], v[172:175], a[220:223], v[68:71]
s_sub_u32 s39, s39, 1
s_cmp_eq_u32 s39, 0
s_cselect_b32 s3, s64, s65
M v[68:71], v[168:171], a[216:219], v[68:71]
ds_read_b64_tr_b16 v[128:129], v20 offset:32768
ds_read_b64_tr_b16 v[130:131], v20 offset:36864
M v[72:75], v[176:179], a[216:219], v[72:75]
s_add_u32 s25, s25, s3
s_lshl_b32 s3, s3, 3
s_add_u32 s26, s26, s3
M v[72:75], v[180:183], a[220:223], v[72:75]
ds_read_b64_tr_b16 v[132:133], v20 offset:40960
ds_read_b64_tr_b16 v[134:135], v20 offset:45056
M v[76:79], v[188:191], a[220:223], v[76:79]
M v[76:79], v[184:187], a[216:219], v[76:79]
ds_read_b64_tr_b16 v[136:137], v21 offset:32768
ds_read_b64_tr_b16 v[138:139], v21 offset:36864
M v[80:83], v[192:195], a[216:219], v[80:83]
ds_read_b64_tr_b16 v[140:141], v21 offset:40960
ds_read_b64_tr_b16 v[142:143], v21 offset:45056
M v[80:83], v[196:199], a[220:223], v[80:83]
ds_read_b64_tr_b16 v[144:145], v22 offset:32768
ds_read_b64_tr_b16 v[146:147], v22 offset:36864
M v[84:87], v[204:207], a[220:223], v[84:87]
ds_read_b64_tr_b16 v[148:149], v22 offset:40960
ds_read_b64_tr_b16 v[150:151], v22 offset:45056
M v[84:87], v[200:203], a[216:219], v[84:87]
ds_read_b64_tr_b16 v[152:153], v23 offset:32768
ds_read_b64_tr_b16 v[154:155], v23 offset:36864
M v[88:91], v[208:211], a[216:219], v[88:91]
ds_read_b64_tr_b16 v[156:157], v23 offset:40960
ds_read_b64_tr_b16 v[158:159], v23 offset:45056
M v[88:91], v[212:215], a[220:223], v[88:91]
M v[92:95], v[220:223], a[220:223], v[92:95]
M v[92:95], v[216:219], a[216:219], v[92:95]
s_waitcnt vmcnt(24) lgkmcnt(0)
s_barrier
M v[32:35], v[96:99], a[224:227], v[32:35]
s_add_u32 m0, s41, 49152
s_nop 0
buffer_load_dwordx4 v2, s[48:51], s26 offen offset:0 lds
M v[32:35], v[100:103], a[228:231], v[32:35]
ds_read_b64_tr_b16 v[160:161], v16 offset:49152
ds_read_b64_tr_b16 v[162:163], v16 offset:53248
M v[36:39], v[108:111], a[228:231], v[36:39]
buffer_load_dwordx4 v3, s[48:51], s26 offen offset:1024 lds
M v[36:39], v[104:107], a[224:227], v[36:39]
ds_read_b64_tr_b16 v[164:165], v16 offset:57344
ds_read_b64_tr_b16 v[166:167], v16 offset:61440
M v[40:43], v[112:115], a[224:227], v[40:43]
buffer_load_dwordx4 v4, s[48:51], s26 offen offset:2048 lds
M v[40:43], v[116:119], a[228:231], v[40:43]
ds_read_b64_tr_b16 v[168:169], v17 offset:49152
ds_read_b64_tr_b16 v[170:171], v17 offset:53248
M v[44:47], v[124:127], a[228:231], v[44:47]
buffer_load_dwordx4 v5, s[48:51], s26 offen offset:3072 lds
M v[44:47], v[120:123], a[224:227], v[44:47]
M v[48:51], v[128:131], a[224:227], v[48:51]
ds_read_b64_tr_b16 v[172:173], v17 offset:57344
ds_read_b64_tr_b16 v[174:175], v17 offset:61440
M v[48:51], v[132:135], a[228:231], v[48:51]
buffer_load_dwordx4 a[176:179], v1, s[44:47], s25 offen offset:0 sc1
M v[52:55], v[140:143], a[228:231], v[52:55]
ds_read_b64_tr_b16 v[176:177], v18 offset:49152
ds_read_b64_tr_b16 v[178:179], v18 offset:53248
M v[52:55], v[136:139], a[224:227], v[52:55]
buffer_load_dwordx4 a[180:183], v1, s[44:47], s25 offen offset:1024 sc1
M v[56:59], v[144:147], a[224:227], v[56:59]
ds_read_b64_tr_b16 v[180:181], v18 offset:57344
ds_read_b64_tr_b16 v[182:183], v18 offset:61440
M v[56:59], v[148:151], a[228:231], v[56:59]
buffer_load_dwordx4 a[184:187], v1, s[44:47], s25 offen offset:2048 sc1
M v[60:63], v[156:159], a[228:231], v[60:63]
M v[60:63], v[152:155], a[224:227], v[60:63]
ds_read_b64_tr_b16 v[184:185], v19 offset:49152
ds_read_b64_tr_b16 v[186:187], v19 offset:53248
M v[64:67], v[96:99], a[232:235], v[64:67]
buffer_load_dwordx4 a[188:191], v1, s[44:47], s25 offen offset:3072 sc1
M v[64:67], v[100:103], a[236:239], v[64:67]
ds_read_b64_tr_b16 v[188:189], v19 offset:57344
ds_read_b64_tr_b16 v[190:191], v19 offset:61440
M v[68:71], v[108:111], a[236:239], v[68:71]
s_sub_u32 s39, s39, 1
s_cmp_eq_u32 s39, 0
s_cselect_b32 s3, s64, s65
M v[68:71], v[104:107], a[232:235], v[68:71]
ds_read_b64_tr_b16 v[192:193], v20 offset:49152
ds_read_b64_tr_b16 v[194:195], v20 offset:53248
M v[72:75], v[112:115], a[232:235], v[72:75]
s_add_u32 s25, s25, s3
s_lshl_b32 s3, s3, 3
s_add_u32 s26, s26, s3
M v[72:75], v[116:119], a[236:239], v[72:75]
ds_read_b64_tr_b16 v[196:197], v20 offset:57344
ds_read_b64_tr_b16 v[198:199], v20 offset:61440
M v[76:79], v[124:127], a[236:239], v[76:79]
M v[76:79], v[120:123], a[232:235], v[76:79]
ds_read_b64_tr_b16 v[200:201], v21 offset:49152
ds_read_b64_tr_b16 v[202:203], v21 offset:53248
M v[80:83], v[128:131], a[232:235], v[80:83]
ds_read_b64_tr_b16 v[204:205], v21 offset:57344
ds_read_b64_tr_b16 v[206:207], v21 offset:61440
M v[80:83], v[132:135], a[236:239], v[80:83]
ds_read_b64_tr_b16 v[208:209], v22 offset:49152
ds_read_b64_tr_b16 v[210:211], v22 offset:53248
M v[84:87], v[140:143], a[236:239], v[84:87]
ds_read_b64_tr_b16 v[212:213], v22 offset:57344
ds_read_b64_tr_b16 v[214:215], v22 offset:61440
M v[84:87], v[136:139], a[232:235], v[84:87]
ds_read_b64_tr_b16 v[216:217], v23 offset:49152
ds_read_b64_tr_b16 v[218:219], v23 offset:53248
M v[88:91], v[144:147], a[232:235], v[88:91]
ds_read_b64_tr_b16 v[220:221], v23 offset:57344
ds_read_b64_tr_b16 v[222:223], v23 offset:61440
M v[88:91], v[148:151], a[236:239], v[88:91]
M v[92:95], v[156:159], a[236:239], v[92:95]
M v[92:95], v[152:155], a[232:235], v[92:95]
s_waitcnt vmcnt(24) lgkmcnt(0)
s_barrier
M v[32:35], v[160:163], a[240:243], v[32:35]
s_mov_b64 s[44:45], s[34:35]
s_mov_b32 s46, 4194304
s_mov_b64 s[48:49], s[36:37]
s_mov_b32 s50, 2097152
s_mov_b32 s25, s32
s_mov_b32 s26, s33
s_add_u32 m0, s42, 65536
s_nop 0
buffer_load_dwordx4 v6, s[48:51], s26 offen offset:0 lds
M v[32:35], v[164:167], a[244:247], v[32:35]
ds_read_b64_tr_b16 v[96:97], v8 offset:0
ds_read_b64_tr_b16 v[98:99], v8 offset:4096
M v[36:39], v[172:175], a[244:247], v[36:39]
buffer_load_dwordx4 v7, s[48:51], s26 offen offset:1024 lds
M v[36:39], v[168:171], a[240:243], v[36:39]
ds_read_b64_tr_b16 v[100:101], v8 offset:8192
ds_read_b64_tr_b16 v[102:103], v8 offset:12288
M v[40:43], v[176:179], a[240:243], v[40:43]
M v[40:43], v[180:183], a[244:247], v[40:43]
buffer_load_dwordx4 a[192:195], v1, s[44:47], s25 offen offset:0 sc1
M v[44:47], v[188:191], a[244:247], v[44:47]
ds_read_b64_tr_b16 v[104:105], v9 offset:0
ds_read_b64_tr_b16 v[106:107], v9 offset:4096
M v[44:47], v[184:187], a[240:243], v[44:47]
buffer_load_dwordx4 a[196:199], v1, s[44:47], s25 offen offset:1024 sc1
M v[48:51], v[192:195], a[240:243], v[48:51]
M v[48:51], v[196:199], a[244:247], v[48:51]
ds_read_b64_tr_b16 v[108:109], v9 offset:8192
ds_read_b64_tr_b16 v[110:111], v9 offset:12288
M v[52:55], v[204:207], a[244:247], v[52:55]
buffer_load_dwordx4 a[200:203], v1, s[44:47], s25 offen offset:2048 sc1
M v[52:55], v[200:203], a[240:243], v[52:55]
ds_read_b64_tr_b16 v[112:113], v10 offset:0
ds_read_b64_tr_b16 v[114:115], v10 offset:4096
M v[56:59], v[208:211], a[240:243], v[56:59]
M v[56:59], v[212:215], a[244:247], v[56:59]
buffer_load_dwordx4 a[204:207], v1, s[44:47], s25 offen offset:3072 sc1
M v[60:63], v[220:223], a[244:247], v[60:63]
ds_read_b64_tr_b16 v[116:117], v10 offset:8192
ds_read_b64_tr_b16 v[118:119], v10 offset:12288
M v[60:63], v[216:219], a[240:243], v[60:63]
s_add_u32 s25, s25, 16384
s_add_u32 s26, s26, 131072
M v[64:67], v[160:163], a[248:251], v[64:67]
ds_read_b64_tr_b16 v[120:121], v11 offset:0
ds_read_b64_tr_b16 v[122:123], v11 offset:4096
M v[64:67], v[164:167], a[252:255], v[64:67]
M v[68:71], v[172:175], a[252:255], v[68:71]
ds_read_b64_tr_b16 v[124:125], v11 offset:8192
ds_read_b64_tr_b16 v[126:127], v11 offset:12288
M v[68:71], v[168:171], a[248:251], v[68:71]
ds_read_b64_tr_b16 v[128:129], v12 offset:0
ds_read_b64_tr_b16 v[130:131], v12 offset:4096
M v[72:75], v[176:179], a[248:251], v[72:75]
ds_read_b64_tr_b16 v[132:133], v12 offset:8192
ds_read_b64_tr_b16 v[134:135], v12 offset:12288
M v[72:75], v[180:183], a[252:255], v[72:75]
M v[76:79], v[188:191], a[252:255], v[76:79]
ds_read_b64_tr_b16 v[136:137], v13 offset:0
ds_read_b64_tr_b16 v[138:139], v13 offset:4096
M v[76:79], v[184:187], a[248:251], v[76:79]
ds_read_b64_tr_b16 v[140:141], v13 offset:8192
ds_read_b64_tr_b16 v[142:143], v13 offset:12288
M v[80:83], v[192:195], a[248:251], v[80:83]
ds_read_b64_tr_b16 v[144:145], v14 offset:0
ds_read_b64_tr_b16 v[146:147], v14 offset:4096
M v[80:83], v[196:199], a[252:255], v[80:83]
M v[84:87], v[204:207], a[252:255], v[84:87]
ds_read_b64_tr_b16 v[148:149], v14 offset:8192
ds_read_b64_tr_b16 v[150:151], v14 offset:12288
M v[84:87], v[200:203], a[248:251], v[84:87]
ds_read_b64_tr_b16 v[152:153], v15 offset:0
ds_read_b64_tr_b16 v[154:155], v15 offset:4096
M v[88:91], v[208:211], a[248:251], v[88:91]
ds_read_b64_tr_b16 v[156:157], v15 offset:8192
ds_read_b64_tr_b16 v[158:159], v15 offset:12288
M v[88:91], v[212:215], a[252:255], v[88:91]
M v[92:95], v[220:223], a[252:255], v[92:95]
M v[92:95], v[216:219], a[248:251], v[92:95]
s_waitcnt vmcnt(22) lgkmcnt(0)
s_barrier
M v[32:35], v[96:99], a[128:131], v[32:35]
s_add_u32 m0, s42, 81920
s_nop 0
buffer_load_dwordx4 v6, s[48:51], s26 offen offset:0 lds
M v[32:35], v[100:103], a[132:135], v[32:35]
ds_read_b64_tr_b16 v[160:161], v8 offset:16384
ds_read_b64_tr_b16 v[162:163], v8 offset:20480
M v[36:39], v[108:111], a[132:135], v[36:39]
buffer_load_dwordx4 v7, s[48:51], s26 offen offset:1024 lds
M v[36:39], v[104:107], a[128:131], v[36:39]
ds_read_b64_tr_b16 v[164:165], v8 offset:24576
ds_read_b64_tr_b16 v[166:167], v8 offset:28672
M v[40:43], v[112:115], a[128:131], v[40:43]
M v[40:43], v[116:119], a[132:135], v[40:43]
buffer_load_dwordx4 a[208:211], v1, s[44:47], s25 offen offset:0 sc1
M v[44:47], v[124:127], a[132:135], v[44:47]
ds_read_b64_tr_b16 v[168:169], v9 offset:16384
ds_read_b64_tr_b16 v[170:171], v9 offset:20480
M v[44:47], v[120:123], a[128:131], v[44:47]
buffer_load_dwordx4 a[212:215], v1, s[44:47], s25 offen offset:1024 sc1
M v[48:51], v[128:131], a[128:131], v[48:51]
M v[48:51], v[132:135], a[132:135], v[48:51]
ds_read_b64_tr_b16 v[172:173], v9 offset:24576
ds_read_b64_tr_b16 v[174:175], v9 offset:28672
M v[52:55], v[140:143], a[132:135], v[52:55]
buffer_load_dwordx4 a[216:219], v1, s[44:47], s25 offen offset:2048 sc1
M v[52:55], v[136:139], a[128:131], v[52:55]
ds_read_b64_tr_b16 v[176:177], v10 offset:16384
ds_read_b64_tr_b16 v[178:179], v10 offset:20480
M v[56:59], v[144:147], a[128:131], v[56:59]
M v[56:59], v[148:151], a[132:135], v[56:59]
buffer_load_dwordx4 a[220:223], v1, s[44:47], s25 offen offset:3072 sc1
M v[60:63], v[156:159], a[132:135], v[60:63]
ds_read_b64_tr_b16 v[180:181], v10 offset:24576
ds_read_b64_tr_b16 v[182:183], v10 offset:28672
M v[60:63], v[152:155], a[128:131], v[60:63]
s_add_u32 s25, s25, 16384
s_add_u32 s26, s26, 131072
M v[64:67], v[96:99], a[136:139], v[64:67]
ds_read_b64_tr_b16 v[184:185], v11 offset:16384
ds_read_b64_tr_b16 v[186:187], v11 offset:20480
M v[64:67], v[100:103], a[140:143], v[64:67]
M v[68:71], v[108:111], a[140:143], v[68:71]
ds_read_b64_tr_b16 v[188:189], v11 offset:24576
ds_read_b64_tr_b16 v[190:191], v11 offset:28672
M v[68:71], v[104:107], a[136:139], v[68:71]
ds_read_b64_tr_b16 v[192:193], v12 offset:16384
ds_read_b64_tr_b16 v[194:195], v12 offset:20480
M v[72:75], v[112:115], a[136:139], v[72:75]
ds_read_b64_tr_b16 v[196:197], v12 offset:24576
ds_read_b64_tr_b16 v[198:199], v12 offset:28672
M v[72:75], v[116:119], a[140:143], v[72:75]
M v[76:79], v[124:127], a[140:143], v[76:79]
ds_read_b64_tr_b16 v[200:201], v13 offset:16384
ds_read_b64_tr_b16 v[202:203], v13 offset:20480
M v[76:79], v[120:123], a[136:139], v[76:79]
ds_read_b64_tr_b16 v[204:205], v13 offset:24576
ds_read_b64_tr_b16 v[206:207], v13 offset:28672
M v[80:83], v[128:131], a[136:139], v[80:83]
ds_read_b64_tr_b16 v[208:209], v14 offset:16384
ds_read_b64_tr_b16 v[210:211], v14 offset:20480
M v[80:83], v[132:135], a[140:143], v[80:83]
M v[84:87], v[140:143], a[140:143], v[84:87]
ds_read_b64_tr_b16 v[212:213], v14 offset:24576
ds_read_b64_tr_b16 v[214:215], v14 offset:28672
M v[84:87], v[136:139], a[136:139], v[84:87]
ds_read_b64_tr_b16 v[216:217], v15 offset:16384
ds_read_b64_tr_b16 v[218:219], v15 offset:20480
M v[88:91], v[144:147], a[136:139], v[88:91]
ds_read_b64_tr_b16 v[220:221], v15 offset:24576
ds_read_b64_tr_b16 v[222:223], v15 offset:28672
M v[88:91], v[148:151], a[140:143], v[88:91]
M v[92:95], v[156:159], a[140:143], v[92:95]
M v[92:95], v[152:155], a[136:139], v[92:95]
s_waitcnt vmcnt(20) lgkmcnt(0)
s_barrier
M v[32:35], v[160:163], a[144:147], v[32:35]
s_add_u32 m0, s42, 98304
s_nop 0
buffer_load_dwordx4 v6, s[48:51], s26 offen offset:0 lds
M v[32:35], v[164:167], a[148:151], v[32:35]
ds_read_b64_tr_b16 v[96:97], v8 offset:32768
ds_read_b64_tr_b16 v[98:99], v8 offset:36864
M v[36:39], v[172:175], a[148:151], v[36:39]
buffer_load_dwordx4 v7, s[48:51], s26 offen offset:1024 lds
M v[36:39], v[168:171], a[144:147], v[36:39]
ds_read_b64_tr_b16 v[100:101], v8 offset:40960
ds_read_b64_tr_b16 v[102:103], v8 offset:45056
M v[40:43], v[176:179], a[144:147], v[40:43]
M v[40:43], v[180:183], a[148:151], v[40:43]
buffer_load_dwordx4 a[224:227], v1, s[44:47], s25 offen offset:0 sc1
M v[44:47], v[188:191], a[148:151], v[44:47]
ds_read_b64_tr_b16 v[104:105], v9 offset:32768
ds_read_b64_tr_b16 v[106:107], v9 offset:36864
M v[44:47], v[184:187], a[144:147], v[44:47]
buffer_load_dwordx4 a[228:231], v1, s[44:47], s25 offen offset:1024 sc1
M v[48:51], v[192:195], a[144:147], v[48:51]
M v[48:51], v[196:199], a[148:151], v[48:51]
ds_read_b64_tr_b16 v[108:109], v9 offset:40960
ds_read_b64_tr_b16 v[110:111], v9 offset:45056
M v[52:55], v[204:207], a[148:151], v[52:55]
buffer_load_dwordx4 a[232:235], v1, s[44:47], s25 offen offset:2048 sc1
M v[52:55], v[200:203], a[144:147], v[52:55]
ds_read_b64_tr_b16 v[112:113], v10 offset:32768
ds_read_b64_tr_b16 v[114:115], v10 offset:36864
M v[56:59], v[208:211], a[144:147], v[56:59]
M v[56:59], v[212:215], a[148:151], v[56:59]
buffer_load_dwordx4 a[236:239], v1, s[44:47], s25 offen offset:3072 sc1
M v[60:63], v[220:223], a[148:151], v[60:63]
ds_read_b64_tr_b16 v[116:117], v10 offset:40960
ds_read_b64_tr_b16 v[118:119], v10 offset:45056
M v[60:63], v[216:219], a[144:147], v[60:63]
s_add_u32 s25, s25, 16384
s_add_u32 s26, s26, 131072
M v[64:67], v[160:163], a[152:155], v[64:67]
ds_read_b64_tr_b16 v[120:121], v11 offset:32768
ds_read_b64_tr_b16 v[122:123], v11 offset:36864
M v[64:67], v[164:167], a[156:159], v[64:67]
M v[68:71], v[172:175], a[156:159], v[68:71]
ds_read_b64_tr_b16 v[124:125], v11 offset:40960
ds_read_b64_tr_b16 v[126:127], v11 offset:45056
M v[68:71], v[168:171], a[152:155], v[68:71]
ds_read_b64_tr_b16 v[128:129], v12 offset:32768
ds_read_b64_tr_b16 v[130:131], v12 offset:36864
M v[72:75], v[176:179], a[152:155], v[72:75]
ds_read_b64_tr_b16 v[132:133], v12 offset:40960
ds_read_b64_tr_b16 v[134:135], v12 offset:45056
M v[72:75], v[180:183], a[156:159], v[72:75]
M v[76:79], v[188:191], a[156:159], v[76:79]
ds_read_b64_tr_b16 v[136:137], v13 offset:32768
ds_read_b64_tr_b16 v[138:139], v13 offset:36864
M v[76:79], v[184:187], a[152:155], v[76:79]
ds_read_b64_tr_b16 v[140:141], v13 offset:40960
ds_read_b64_tr_b16 v[142:143], v13 offset:45056
M v[80:83], v[192:195], a[152:155], v[80:83]
ds_read_b64_tr_b16 v[144:145], v14 offset:32768
ds_read_b64_tr_b16 v[146:147], v14 offset:36864
M v[80:83], v[196:199], a[156:159], v[80:83]
M v[84:87], v[204:207], a[156:159], v[84:87]
ds_read_b64_tr_b16 v[148:149], v14 offset:40960
ds_read_b64_tr_b16 v[150:151], v14 offset:45056
M v[84:87], v[200:203], a[152:155], v[84:87]
ds_read_b64_tr_b16 v[152:153], v15 offset:32768
ds_read_b64_tr_b16 v[154:155], v15 offset:36864
M v[88:91], v[208:211], a[152:155], v[88:91]
ds_read_b64_tr_b16 v[156:157], v15 offset:40960
ds_read_b64_tr_b16 v[158:159], v15 offset:45056
M v[88:91], v[212:215], a[156:159], v[88:91]
M v[92:95], v[220:223], a[156:159], v[92:95]
M v[92:95], v[216:219], a[152:155], v[92:95]
s_waitcnt vmcnt(18) lgkmcnt(0)
s_barrier
M v[32:35], v[96:99], a[160:163], v[32:35]
s_add_u32 m0, s42, 114688
s_nop 0
buffer_load_dwordx4 v6, s[48:51], s26 offen offset:0 lds
M v[32:35], v[100:103], a[164:167], v[32:35]
ds_read_b64_tr_b16 v[160:161], v8 offset:49152
ds_read_b64_tr_b16 v[162:163], v8 offset:53248
M v[36:39], v[108:111], a[164:167], v[36:39]
buffer_load_dwordx4 v7, s[48:51], s26 offen offset:1024 lds
M v[36:39], v[104:107], a[160:163], v[36:39]
ds_read_b64_tr_b16 v[164:165], v8 offset:57344
ds_read_b64_tr_b16 v[166:167], v8 offset:61440
M v[40:43], v[112:115], a[160:163], v[40:43]
M v[40:43], v[116:119], a[164:167], v[40:43]
buffer_load_dwordx4 a[240:243], v1, s[44:47], s25 offen offset:0 sc1
M v[44:47], v[124:127], a[164:167], v[44:47]
ds_read_b64_tr_b16 v[168:169], v9 offset:49152
ds_read_b64_tr_b16 v[170:171], v9 offset:53248
M v[44:47], v[120:123], a[160:163], v[44:47]
buffer_load_dwordx4 a[244:247], v1, s[44:47], s25 offen offset:1024 sc1
M v[48:51], v[128:131], a[160:163], v[48:51]
M v[48:51], v[132:135], a[164:167], v[48:51]
ds_read_b64_tr_b16 v[172:173], v9 offset:57344
ds_read_b64_tr_b16 v[174:175], v9 offset:61440
M v[52:55], v[140:143], a[164:167], v[52:55]
buffer_load_dwordx4 a[248:251], v1, s[44:47], s25 offen offset:2048 sc1
M v[52:55], v[136:139], a[160:163], v[52:55]
ds_read_b64_tr_b16 v[176:177], v10 offset:49152
ds_read_b64_tr_b16 v[178:179], v10 offset:53248
M v[56:59], v[144:147], a[160:163], v[56:59]
M v[56:59], v[148:151], a[164:167], v[56:59]
buffer_load_dwordx4 a[252:255], v1, s[44:47], s25 offen offset:3072 sc1
M v[60:63], v[156:159], a[164:167], v[60:63]
ds_read_b64_tr_b16 v[180:181], v10 offset:57344
ds_read_b64_tr_b16 v[182:183], v10 offset:61440
M v[60:63], v[152:155], a[160:163], v[60:63]
s_add_u32 s25, s25, 16384
s_add_u32 s26, s26, 131072
M v[64:67], v[96:99], a[168:171], v[64:67]
ds_read_b64_tr_b16 v[184:185], v11 offset:49152
ds_read_b64_tr_b16 v[186:187], v11 offset:53248
M v[64:67], v[100:103], a[172:175], v[64:67]
M v[68:71], v[108:111], a[172:175], v[68:71]
ds_read_b64_tr_b16 v[188:189], v11 offset:57344
ds_read_b64_tr_b16 v[190:191], v11 offset:61440
M v[68:71], v[104:107], a[168:171], v[68:71]
ds_read_b64_tr_b16 v[192:193], v12 offset:49152
ds_read_b64_tr_b16 v[194:195], v12 offset:53248
M v[72:75], v[112:115], a[168:171], v[72:75]
ds_read_b64_tr_b16 v[196:197], v12 offset:57344
ds_read_b64_tr_b16 v[198:199], v12 offset:61440
M v[72:75], v[116:119], a[172:175], v[72:75]
M v[76:79], v[124:127], a[172:175], v[76:79]
ds_read_b64_tr_b16 v[200:201], v13 offset:49152
ds_read_b64_tr_b16 v[202:203], v13 offset:53248
M v[76:79], v[120:123], a[168:171], v[76:79]
ds_read_b64_tr_b16 v[204:205], v13 offset:57344
ds_read_b64_tr_b16 v[206:207], v13 offset:61440
M v[80:83], v[128:131], a[168:171], v[80:83]
ds_read_b64_tr_b16 v[208:209], v14 offset:49152
ds_read_b64_tr_b16 v[210:211], v14 offset:53248
M v[80:83], v[132:135], a[172:175], v[80:83]
M v[84:87], v[140:143], a[172:175], v[84:87]
ds_read_b64_tr_b16 v[212:213], v14 offset:57344
ds_read_b64_tr_b16 v[214:215], v14 offset:61440
M v[84:87], v[136:139], a[168:171], v[84:87]
ds_read_b64_tr_b16 v[216:217], v15 offset:49152
ds_read_b64_tr_b16 v[218:219], v15 offset:53248
M v[88:91], v[144:147], a[168:171], v[88:91]
ds_read_b64_tr_b16 v[220:221], v15 offset:57344
ds_read_b64_tr_b16 v[222:223], v15 offset:61440
M v[88:91], v[148:151], a[172:175], v[88:91]
M v[92:95], v[156:159], a[172:175], v[92:95]
M v[92:95], v[152:155], a[168:171], v[92:95]
s_waitcnt vmcnt(18) lgkmcnt(0)
s_barrier
M v[32:35], v[160:163], a[176:179], v[32:35]
s_add_u32 m0, s42, 0
s_nop 0
buffer_load_dwordx4 v6, s[48:51], s26 offen offset:0 lds
M v[32:35], v[164:167], a[180:183], v[32:35]
M v[36:39], v[172:175], a[180:183], v[36:39]
ds_read_b64_tr_b16 v[96:97], v28 offset:0
ds_read_b64_tr_b16 v[98:99], v28 offset:2048
M v[36:39], v[168:171], a[176:179], v[36:39]
M v[40:43], v[176:179], a[176:179], v[40:43]
buffer_load_dwordx4 v7, s[48:51], s26 offen offset:1024 lds
M v[40:43], v[180:183], a[180:183], v[40:43]
M v[44:47], v[188:191], a[180:183], v[44:47]
ds_read_b64_tr_b16 v[100:101], v28 offset:4096
ds_read_b64_tr_b16 v[102:103], v28 offset:6144
M v[44:47], v[184:187], a[176:179], v[44:47]
M v[48:51], v[192:195], a[176:179], v[48:51]
buffer_load_dwordx4 a[128:131], v1, s[44:47], s25 offen offset:0 sc1
M v[48:51], v[196:199], a[180:183], v[48:51]
M v[52:55], v[204:207], a[180:183], v[52:55]
ds_read_b64_tr_b16 v[104:105], v29 offset:0
ds_read_b64_tr_b16 v[106:107], v29 offset:2048
M v[52:55], v[200:203], a[176:179], v[52:55]
M v[56:59], v[208:211], a[176:179], v[56:59]
buffer_load_dwordx4 a[132:135], v1, s[44:47], s25 offen offset:1024 sc1
M v[56:59], v[212:215], a[180:183], v[56:59]
M v[60:63], v[220:223], a[180:183], v[60:63]
ds_read_b64_tr_b16 v[108:109], v29 offset:4096
ds_read_b64_tr_b16 v[110:111], v29 offset:6144
M v[60:63], v[216:219], a[176:179], v[60:63]
M v[64:67], v[160:163], a[184:187], v[64:67]
buffer_load_dwordx4 a[136:139], v1, s[44:47], s25 offen offset:2048 sc1
M v[64:67], v[164:167], a[188:191], v[64:67]
M v[68:71], v[172:175], a[188:191], v[68:71]
ds_read_b64_tr_b16 v[112:113], v30 offset:0
ds_read_b64_tr_b16 v[114:115], v30 offset:2048
M v[68:71], v[168:171], a[184:187], v[68:71]
M v[72:75], v[176:179], a[184:187], v[72:75]
buffer_load_dwordx4 a[140:143], v1, s[44:47], s25 offen offset:3072 sc1
M v[72:75], v[180:183], a[188:191], v[72:75]
M v[76:79], v[188:191], a[188:191], v[76:79]
ds_read_b64_tr_b16 v[116:117], v30 offset:4096
ds_read_b64_tr_b16 v[118:119], v30 offset:6144
M v[76:79], v[184:187], a[184:187], v[76:79]
M v[80:83], v[192:195], a[184:187], v[80:83]
s_add_u32 s25, s25, 16384
s_add_u32 s26, s26, 131072
M v[80:83], v[196:199], a[188:191], v[80:83]
M v[84:87], v[204:207], a[188:191], v[84:87]
ds_read_b64_tr_b16 v[120:121], v31 offset:0
ds_read_b64_tr_b16 v[122:123], v31 offset:2048
M v[84:87], v[200:203], a[184:187], v[84:87]
M v[88:91], v[208:211], a[184:187], v[88:91]
ds_read_b64_tr_b16 v[124:125], v31 offset:4096
ds_read_b64_tr_b16 v[126:127], v31 offset:6144
M v[88:91], v[212:215], a[188:191], v[88:91]
M v[92:95], v[220:223], a[188:191], v[92:95]
M v[92:95], v[216:219], a[184:187], v[92:95]
s_waitcnt vmcnt(18) lgkmcnt(0)
s_barrier
M a[0:3], v[96:99], a[192:195], a[0:3]
s_add_u32 m0, s42, 16384
s_nop 0
buffer_load_dwordx4 v6, s[48:51], s26 offen offset:0 lds
ds_read_b64_tr_b16 v[160:161], v28 offset:16384
ds_read_b64_tr_b16 v[162:163], v28 offset:18432
M a[0:3], v[100:103], a[196:199], a[0:3]
buffer_load_dwordx4 v7, s[48:51], s26 offen offset:1024 lds
ds_read_b64_tr_b16 v[164:165], v28 offset:20480
ds_read_b64_tr_b16 v[166:167], v28 offset:22528
M a[4:7], v[108:111], a[196:199], a[4:7]
buffer_load_dwordx4 a[144:147], v1, s[44:47], s25 offen offset:0 sc1
ds_read_b64_tr_b16 v[168:169], v29 offset:16384
ds_read_b64_tr_b16 v[170:171], v29 offset:18432
M a[4:7], v[104:107], a[192:195], a[4:7]
buffer_load_dwordx4 a[148:151], v1, s[44:47], s25 offen offset:1024 sc1
M a[8:11], v[112:115], a[192:195], a[8:11]
ds_read_b64_tr_b16 v[172:173], v29 offset:20480
ds_read_b64_tr_b16 v[174:175], v29 offset:22528
buffer_load_dwordx4 a[152:155], v1, s[44:47], s25 offen offset:2048 sc1
M a[8:11], v[116:119], a[196:199], a[8:11]
ds_read_b64_tr_b16 v[176:177], v30 offset:16384
ds_read_b64_tr_b16 v[178:179], v30 offset:18432
buffer_load_dwordx4 a[156:159], v1, s[44:47], s25 offen offset:3072 sc1
M a[12:15], v[124:127], a[196:199], a[12:15]
ds_read_b64_tr_b16 v[180:181], v30 offset:20480
ds_read_b64_tr_b16 v[182:183], v30 offset:22528
M a[12:15], v[120:123], a[192:195], a[12:15]
s_add_u32 s25, s25, 16384
s_add_u32 s26, s26, 131072
ds_read_b64_tr_b16 v[184:185], v31 offset:16384
ds_read_b64_tr_b16 v[186:187], v31 offset:18432
M a[16:19], v[96:99], a[200:203], a[16:19]
s_add_u32 s60, s56, 0
buffer_store_dwordx4 v[48:51], v1, s[52:55], s60 offen offset:0 sc1
ds_read_b64_tr_b16 v[188:189], v31 offset:20480
ds_read_b64_tr_b16 v[190:191], v31 offset:22528
M a[16:19], v[100:103], a[204:207], a[16:19]
buffer_store_dwordx4 v[52:55], v1, s[52:55], s60 offen offset:1024 sc1
buffer_store_dwordx4 v[56:59], v1, s[52:55], s60 offen offset:2048 sc1
M a[20:23], v[108:111], a[204:207], a[20:23]
buffer_store_dwordx4 v[60:63], v1, s[52:55], s60 offen offset:3072 sc1
M a[20:23], v[104:107], a[200:203], a[20:23]
s_add_u32 s60, s56, 4096
buffer_store_dwordx4 v[80:83], v1, s[52:55], s60 offen offset:0 sc1
buffer_store_dwordx4 v[84:87], v1, s[52:55], s60 offen offset:1024 sc1
M a[24:27], v[112:115], a[200:203], a[24:27]
buffer_store_dwordx4 v[88:91], v1, s[52:55], s60 offen offset:2048 sc1
buffer_store_dwordx4 v[92:95], v1, s[52:55], s60 offen offset:3072 sc1
M a[24:27], v[116:119], a[204:207], a[24:27]
v_mov_b32 v11, 0
M a[28:31], v[124:127], a[204:207], a[28:31]
M a[28:31], v[120:123], a[200:203], a[28:31]
s_waitcnt vmcnt(26) lgkmcnt(0)
s_barrier
M a[0:3], v[160:163], a[208:211], a[0:3]
s_add_u32 m0, s42, 32768
s_nop 0
buffer_load_dwordx4 v6, s[48:51], s26 offen offset:0 lds
ds_read_b64_tr_b16 v[96:97], v28 offset:32768
ds_read_b64_tr_b16 v[98:99], v28 offset:34816
M a[0:3], v[164:167], a[212:215], a[0:3]
buffer_load_dwordx4 v7, s[48:51], s26 offen offset:1024 lds
M a[4:7], v[172:175], a[212:215], a[4:7]
ds_read_b64_tr_b16 v[100:101], v28 offset:36864
ds_read_b64_tr_b16 v[102:103], v28 offset:38912
M a[4:7], v[168:171], a[208:211], a[4:7]
buffer_load_dwordx4 a[160:163], v1, s[44:47], s25 offen offset:0 sc1
M a[8:11], v[176:179], a[208:211], a[8:11]
ds_read_b64_tr_b16 v[104:105], v29 offset:32768
ds_read_b64_tr_b16 v[106:107], v29 offset:34816
M a[8:11], v[180:183], a[212:215], a[8:11]
buffer_load_dwordx4 a[164:167], v1, s[44:47], s25 offen offset:1024 sc1
M a[12:15], v[188:191], a[212:215], a[12:15]
ds_read_b64_tr_b16 v[108:109], v29 offset:36864
ds_read_b64_tr_b16 v[110:111], v29 offset:38912
M a[12:15], v[184:187], a[208:211], a[12:15]
buffer_load_dwordx4 a[168:171], v1, s[44:47], s25 offen offset:2048 sc1
M a[16:19], v[160:163], a[216:219], a[16:19]
ds_read_b64_tr_b16 v[112:113], v30 offset:32768
ds_read_b64_tr_b16 v[114:115], v30 offset:34816
M a[16:19], v[164:167], a[220:223], a[16:19]
buffer_load_dwordx4 a[172:175], v1, s[44:47], s25 offen offset:3072 sc1
M a[20:23], v[172:175], a[220:223], a[20:23]
ds_read_b64_tr_b16 v[116:117], v30 offset:36864
ds_read_b64_tr_b16 v[118:119], v30 offset:38912
M a[20:23], v[168:171], a[216:219], a[20:23]
s_add_u32 s25, s25, 16384
s_add_u32 s26, s26, 131072
M a[24:27], v[176:179], a[216:219], a[24:27]
ds_read_b64_tr_b16 v[120:121], v31 offset:32768
ds_read_b64_tr_b16 v[122:123], v31 offset:34816
M a[24:27], v[180:183], a[220:223], a[24:27]
ds_read_b64_tr_b16 v[124:125], v31 offset:36864
ds_read_b64_tr_b16 v[126:127], v31 offset:38912
M a[28:31], v[188:191], a[220:223], a[28:31]
M a[28:31], v[184:187], a[216:219], a[28:31]
s_waitcnt vmcnt(6) lgkmcnt(0)
s_barrier
s_cmp_lg_u32 s101, 0
s_cbranch_scc1 Lk3f_14
v_mov_b32 v9, 1
s_mov_b64 exec, 1
buffer_store_dword v9, v11, s[52:55], s58 offen sc1
s_mov_b64 exec, -1
Lk3f_14:
M a[0:3], v[96:99], a[224:227], a[0:3]
s_add_u32 m0, s42, 49152
s_nop 0
buffer_load_dwordx4 v6, s[48:51], s26 offen offset:0 lds
ds_read_b64_tr_b16 v[160:161], v28 offset:49152
ds_read_b64_tr_b16 v[162:163], v28 offset:51200
M a[0:3], v[100:103], a[228:231], a[0:3]
buffer_load_dwordx4 v7, s[48:51], s26 offen offset:1024 lds
M a[4:7], v[108:111], a[228:231], a[4:7]
ds_read_b64_tr_b16 v[164:165], v28 offset:53248
ds_read_b64_tr_b16 v[166:167], v28 offset:55296
M a[4:7], v[104:107], a[224:227], a[4:7]
buffer_load_dwordx4 a[176:179], v1, s[44:47], s25 offen offset:0 sc1
M a[8:11], v[112:115], a[224:227], a[8:11]
ds_read_b64_tr_b16 v[168:169], v29 offset:49152
ds_read_b64_tr_b16 v[170:171], v29 offset:51200
M a[8:11], v[116:119], a[228:231], a[8:11]
buffer_load_dwordx4 a[180:183], v1, s[44:47], s25 offen offset:1024 sc1
M a[12:15], v[124:127], a[228:231], a[12:15]
ds_read_b64_tr_b16 v[172:173], v29 offset:53248
ds_read_b64_tr_b16 v[174:175], v29 offset:55296
M a[12:15], v[120:123], a[224:227], a[12:15]
buffer_load_dwordx4 a[184:187], v1, s[44:47], s25 offen offset:2048 sc1
M a[16:19], v[96:99], a[232:235], a[16:19]
ds_read_b64_tr_b16 v[176:177], v30 offset:49152
ds_read_b64_tr_b16 v[178:179], v30 offset:51200
M a[16:19], v[100:103], a[236:239], a[16:19]
buffer_load_dwordx4 a[188:191], v1, s[44:47], s25 offen offset:3072 sc1
M a[20:23], v[108:111], a[236:239], a[20:23]
ds_read_b64_tr_b16 v[180:181], v30 offset:53248
ds_read_b64_tr_b16 v[182:183], v30 offset:55296
M a[20:23], v[104:107], a[232:235], a[20:23]
s_add_u32 s25, s25, 16384
s_add_u32 s26, s26, 131072
M a[24:27], v[112:115], a[232:235], a[24:27]
ds_read_b64_tr_b16 v[184:185], v31 offset:49152
ds_read_b64_tr_b16 v[186:187], v31 offset:51200
M a[24:27], v[116:119], a[236:239], a[24:27]
ds_read_b64_tr_b16 v[188:189], v31 offset:53248
ds_read_b64_tr_b16 v[190:191], v31 offset:55296
M a[28:31], v[124:127], a[236:239], a[28:31]
M a[28:31], v[120:123], a[232:235], a[28:31]
s_waitcnt vmcnt(26) lgkmcnt(0)
s_barrier
M a[0:3], v[160:163], a[240:243], a[0:3]
ds_read_b64_tr_b16 v[96:97], v24 offset:0
ds_read_b64_tr_b16 v[98:99], v24 offset:2048
M a[0:3], v[164:167], a[244:247], a[0:3]
ds_read_b64_tr_b16 v[100:101], v24 offset:4096
ds_read_b64_tr_b16 v[102:103], v24 offset:6144
M a[4:7], v[172:175], a[244:247], a[4:7]
M a[4:7], v[168:171], a[240:243], a[4:7]
ds_read_b64_tr_b16 v[104:105], v25 offset:0
ds_read_b64_tr_b16 v[106:107], v25 offset:2048
M a[8:11], v[176:179], a[240:243], a[8:11]
M a[8:11], v[180:183], a[244:247], a[8:11]
ds_read_b64_tr_b16 v[108:109], v25 offset:4096
ds_read_b64_tr_b16 v[110:111], v25 offset:6144
M a[12:15], v[188:191], a[244:247], a[12:15]
M a[12:15], v[184:187], a[240:243], a[12:15]
ds_read_b64_tr_b16 v[112:113], v26 offset:0
ds_read_b64_tr_b16 v[114:115], v26 offset:2048
M a[16:19], v[160:163], a[248:251], a[16:19]
ds_read_b64_tr_b16 v[116:117], v26 offset:4096
ds_read_b64_tr_b16 v[118:119], v26 offset:6144
M a[16:19], v[164:167], a[252:255], a[16:19]
M a[20:23], v[172:175], a[252:255], a[20:23]
ds_read_b64_tr_b16 v[120:121], v27 offset:0
ds_read_b64_tr_b16 v[122:123], v27 offset:2048
M a[20:23], v[168:171], a[248:251], a[20:23]
M a[24:27], v[176:179], a[248:251], a[24:27]
ds_read_b64_tr_b16 v[124:125], v27 offset:4096
ds_read_b64_tr_b16 v[126:127], v27 offset:6144
M a[24:27], v[180:183], a[252:255], a[24:27]
M a[28:31], v[188:191], a[252:255], a[28:31]
M a[28:31], v[184:187], a[248:251], a[28:31]
s_waitcnt vmcnt(20) lgkmcnt(0)
s_barrier
M a[0:3], v[96:99], a[128:131], a[0:3]
ds_read_b64_tr_b16 v[160:161], v24 offset:16384
ds_read_b64_tr_b16 v[162:163], v24 offset:18432
M a[0:3], v[100:103], a[132:135], a[0:3]
ds_read_b64_tr_b16 v[164:165], v24 offset:20480
ds_read_b64_tr_b16 v[166:167], v24 offset:22528
M a[4:7], v[108:111], a[132:135], a[4:7]
M a[4:7], v[104:107], a[128:131], a[4:7]
ds_read_b64_tr_b16 v[168:169], v25 offset:16384
ds_read_b64_tr_b16 v[170:171], v25 offset:18432
M a[8:11], v[112:115], a[128:131], a[8:11]
M a[8:11], v[116:119], a[132:135], a[8:11]
ds_read_b64_tr_b16 v[172:173], v25 offset:20480
ds_read_b64_tr_b16 v[174:175], v25 offset:22528
M a[12:15], v[124:127], a[132:135], a[12:15]
M a[12:15], v[120:123], a[128:131], a[12:15]
ds_read_b64_tr_b16 v[176:177], v26 offset:16384
ds_read_b64_tr_b16 v[178:179], v26 offset:18432
M a[16:19], v[96:99], a[136:139], a[16:19]
ds_read_b64_tr_b16 v[180:181], v26 offset:20480
ds_read_b64_tr_b16 v[182:183], v26 offset:22528
M a[16:19], v[100:103], a[140:143], a[16:19]
M a[20:23], v[108:111], a[140:143], a[20:23]
ds_read_b64_tr_b16 v[184:185], v27 offset:16384
ds_read_b64_tr_b16 v[186:187], v27 offset:18432
M a[20:23], v[104:107], a[136:139], a[20:23]
M a[24:27], v[112:115], a[136:139], a[24:27]
ds_read_b64_tr_b16 v[188:189], v27 offset:20480
ds_read_b64_tr_b16 v[190:191], v27 offset:22528
M a[24:27], v[116:119], a[140:143], a[24:27]
M a[28:31], v[124:127], a[140:143], a[28:31]
M a[28:31], v[120:123], a[136:139], a[28:31]
s_waitcnt vmcnt(6) lgkmcnt(0)
s_barrier
M a[0:3], v[160:163], a[144:147], a[0:3]
buffer_load_dword v8, v11, s[52:55], s59 offen sc1
M a[0:3], v[164:167], a[148:151], a[0:3]
ds_read_b64_tr_b16 v[96:97], v24 offset:32768
ds_read_b64_tr_b16 v[98:99], v24 offset:34816
M a[4:7], v[172:175], a[148:151], a[4:7]
M a[4:7], v[168:171], a[144:147], a[4:7]
ds_read_b64_tr_b16 v[100:101], v24 offset:36864
ds_read_b64_tr_b16 v[102:103], v24 offset:38912
M a[8:11], v[176:179], a[144:147], a[8:11]
ds_read_b64_tr_b16 v[104:105], v25 offset:32768
ds_read_b64_tr_b16 v[106:107], v25 offset:34816
M a[8:11], v[180:183], a[148:151], a[8:11]
M a[12:15], v[188:191], a[148:151], a[12:15]
ds_read_b64_tr_b16 v[108:109], v25 offset:36864
ds_read_b64_tr_b16 v[110:111], v25 offset:38912
M a[12:15], v[184:187], a[144:147], a[12:15]
ds_read_b64_tr_b16 v[112:113], v26 offset:32768
ds_read_b64_tr_b16 v[114:115], v26 offset:34816
M a[16:19], v[160:163], a[152:155], a[16:19]
M a[16:19], v[164:167], a[156:159], a[16:19]
ds_read_b64_tr_b16 v[116:117], v26 offset:36864
ds_read_b64_tr_b16 v[118:119], v26 offset:38912
M a[20:23], v[172:175], a[156:159], a[20:23]
ds_read_b64_tr_b16 v[120:121], v27 offset:32768
ds_read_b64_tr_b16 v[122:123], v27 offset:34816
M a[20:23], v[168:171], a[152:155], a[20:23]
M a[24:27], v[176:179], a[152:155], a[24:27]
ds_read_b64_tr_b16 v[124:125], v27 offset:36864
ds_read_b64_tr_b16 v[126:127], v27 offset:38912
M a[24:27], v[180:183], a[156:159], a[24:27]
M a[28:31], v[188:191], a[156:159], a[28:31]
M a[28:31], v[184:187], a[152:155], a[28:31]
s_waitcnt vmcnt(1) lgkmcnt(0)
s_barrier
s_waitcnt vmcnt(0)
v_cmp_ne_u32 vcc, 1, v8
s_nop 0
s_cbranch_vccnz Lk3_spinfl
Lk3_gotfl:
M a[0:3], v[96:99], a[160:163], a[0:3]
s_add_u32 s60, s57, 0
buffer_load_dwordx4 v[224:227], v1, s[52:55], s60 offen offset:0 sc1
ds_read_b64_tr_b16 v[160:161], v24 offset:49152
ds_read_b64_tr_b16 v[162:163], v24 offset:51200
M a[0:3], v[100:103], a[164:167], a[0:3]
buffer_load_dwordx4 v[228:231], v1, s[52:55], s60 offen offset:1024 sc1
M a[4:7], v[108:111], a[164:167], a[4:7]
ds_read_b64_tr_b16 v[164:165], v24 offset:53248
ds_read_b64_tr_b16 v[166:167], v24 offset:55296
M a[4:7], v[104:107], a[160:163], a[4:7]
buffer_load_dwordx4 v[232:235], v1, s[52:55], s60 offen offset:2048 sc1
M a[8:11], v[112:115], a[160:163], a[8:11]
ds_read_b64_tr_b16 v[168:169], v25 offset:49152
ds_read_b64_tr_b16 v[170:171], v25 offset:51200
M a[8:11], v[116:119], a[164:167], a[8:11]
buffer_load_dwordx4 v[236:239], v1, s[52:55], s60 offen offset:3072 sc1
M a[12:15], v[124:127], a[164:167], a[12:15]
ds_read_b64_tr_b16 v[172:173], v25 offset:53248
ds_read_b64_tr_b16 v[174:175], v25 offset:55296
M a[12:15], v[120:123], a[160:163], a[12:15]
s_add_u32 s60, s57, 4096
buffer_load_dwordx4 v[240:243], v1, s[52:55], s60 offen offset:0 sc1
ds_read_b64_tr_b16 v[176:177], v26 offset:49152
ds_read_b64_tr_b16 v[178:179], v26 offset:51200
M a[16:19], v[96:99], a[168:171], a[16:19]
buffer_load_dwordx4 v[244:247], v1, s[52:55], s60 offen offset:1024 sc1
M a[16:19], v[100:103], a[172:175], a[16:19]
ds_read_b64_tr_b16 v[180:181], v26 offset:53248
ds_read_b64_tr_b16 v[182:183], v26 offset:55296
M a[20:23], v[108:111], a[172:175], a[20:23]
buffer_load_dwordx4 v[248:251], v1, s[52:55], s60 offen offset:2048 sc1
M a[20:23], v[104:107], a[168:171], a[20:23]
ds_read_b64_tr_b16 v[184:185], v27 offset:49152
ds_read_b64_tr_b16 v[186:187], v27 offset:51200
M a[24:27], v[112:115], a[168:171], a[24:27]
buffer_load_dwordx4 v[252:255], v1, s[52:55], s60 offen offset:3072 sc1
M a[24:27], v[116:119], a[172:175], a[24:27]
ds_read_b64_tr_b16 v[188:189], v27 offset:53248
ds_read_b64_tr_b16 v[190:191], v27 offset:55296
M a[28:31], v[124:127], a[172:175], a[28:31]
M a[28:31], v[120:123], a[168:171], a[28:31]
s_waitcnt lgkmcnt(0)
M a[0:3], v[160:163], a[176:179], a[0:3]
M a[0:3], v[164:167], a[180:183], a[0:3]
M a[4:7], v[172:175], a[180:183], a[4:7]
M a[4:7], v[168:171], a[176:179], a[4:7]
M a[8:11], v[176:179], a[176:179], a[8:11]
M a[8:11], v[180:183], a[180:183], a[8:11]
M a[12:15], v[188:191], a[180:183], a[12:15]
M a[12:15], v[184:187], a[176:179], a[12:15]
M a[16:19], v[160:163], a[184:187], a[16:19]
M a[16:19], v[164:167], a[188:191], a[16:19]
M a[20:23], v[172:175], a[188:191], a[20:23]
M a[20:23], v[168:171], a[184:187], a[20:23]
M a[24:27], v[176:179], a[184:187], a[24:27]
M a[24:27], v[180:183], a[188:191], a[24:27]
M a[28:31], v[188:191], a[188:191], a[28:31]
M a[28:31], v[184:187], a[184:187], a[28:31]
v_bfe_u32 v96, v0, 4, 1
v_lshrrev_b32 v97, 5, v0
v_lshl_or_b32 v96, v96, 1, v97
v_and_b32 v97, 15, v0
v_lshlrev_b32 v97, 13, v97
v_lshl_add_u32 v96, v96, 4, v97
s_and_b32 s3, s101, 1
s_lshl_b32 s3, s3, 6
s_lshr_b32 s6, s101, 1
s_add_u32 s3, s3, s6
s_add_u32 s3, s3, s21
s_lshl_b32 s3, s3, 12
s_lshl_b32 s6, s22, 1
s_add_u32 s3, s3, s6
s_add_u32 s3, s3, 2048
v_accvgpr_read_b32 v108, a0
v_accvgpr_read_b32 v109, a1
v_accvgpr_read_b32 v110, a2
v_accvgpr_read_b32 v111, a3
v_accvgpr_read_b32 v112, a4
v_accvgpr_read_b32 v113, a5
v_accvgpr_read_b32 v114, a6
v_accvgpr_read_b32 v115, a7
v_cvt_pk_bf16_f32 v100, v108, v109
v_cvt_pk_bf16_f32 v101, v110, v111
v_cvt_pk_bf16_f32 v102, v112, v113
v_cvt_pk_bf16_f32 v103, v114, v115
s_nop 0
v_permlane16_swap_b32 v100, v102
v_permlane16_swap_b32 v101, v103
buffer_store_dwordx4 v[100:103], v96, s[16:19], s3 offen offset:0
v_accvgpr_read_b32 v108, a8
v_accvgpr_read_b32 v109, a9
v_accvgpr_read_b32 v110, a10
v_accvgpr_read_b32 v111, a11
v_accvgpr_read_b32 v112, a12
v_accvgpr_read_b32 v113, a13
v_accvgpr_read_b32 v114, a14
v_accvgpr_read_b32 v115, a15
v_cvt_pk_bf16_f32 v104, v108, v109
v_cvt_pk_bf16_f32 v105, v110, v111
v_cvt_pk_bf16_f32 v106, v112, v113
v_cvt_pk_bf16_f32 v107, v114, v115
s_nop 0
v_permlane16_swap_b32 v104, v106
v_permlane16_swap_b32 v105, v107
buffer_store_dwordx4 v[104:107], v96, s[16:19], s3 offen offset:64
s_add_u32 s3, s3, 131072
v_accvgpr_read_b32 v108, a16
v_accvgpr_read_b32 v109, a17
v_accvgpr_read_b32 v110, a18
v_accvgpr_read_b32 v111, a19
v_accvgpr_read_b32 v112, a20
v_accvgpr_read_b32 v113, a21
v_accvgpr_read_b32 v114, a22
v_accvgpr_read_b32 v115, a23
v_cvt_pk_bf16_f32 v100, v108, v109
v_cvt_pk_bf16_f32 v101, v110, v111
v_cvt_pk_bf16_f32 v102, v112, v113
v_cvt_pk_bf16_f32 v103, v114, v115
s_nop 0
v_permlane16_swap_b32 v100, v102
v_permlane16_swap_b32 v101, v103
buffer_store_dwordx4 v[100:103], v96, s[16:19], s3 offen offset:0
v_accvgpr_read_b32 v108, a24
v_accvgpr_read_b32 v109, a25
v_accvgpr_read_b32 v110, a26
v_accvgpr_read_b32 v111, a27
v_accvgpr_read_b32 v112, a28
v_accvgpr_read_b32 v113, a29
v_accvgpr_read_b32 v114, a30
v_accvgpr_read_b32 v115, a31
v_cvt_pk_bf16_f32 v104, v108, v109
v_cvt_pk_bf16_f32 v105, v110, v111
v_cvt_pk_bf16_f32 v106, v112, v113
v_cvt_pk_bf16_f32 v107, v114, v115
s_nop 0
v_permlane16_swap_b32 v104, v106
v_permlane16_swap_b32 v105, v107
buffer_store_dwordx4 v[104:107], v96, s[16:19], s3 offen offset:64
v_bfe_u32 v128, v0, 4, 1
v_lshrrev_b32 v129, 5, v0
v_lshl_or_b32 v128, v128, 1, v129
v_and_b32 v129, 15, v0
v_lshlrev_b32 v129, 12, v129
v_lshl_add_u32 v128, v128, 4, v129
s_lshl_b32 s3, s101, 5
s_add_u32 s3, s3, s29
s_lshl_b32 s3, s3, 12
s_lshl_b32 s6, s30, 1
s_add_u32 s3, s3, s6
s_waitcnt vmcnt(4)
v_pk_add_f32 v[32:33], v[32:33], v[224:225]
v_pk_add_f32 v[34:35], v[34:35], v[226:227]
v_pk_add_f32 v[36:37], v[36:37], v[228:229]
v_pk_add_f32 v[38:39], v[38:39], v[230:231]
v_cvt_pk_bf16_f32 v132, v32, v33
v_cvt_pk_bf16_f32 v133, v34, v35
v_cvt_pk_bf16_f32 v134, v36, v37
v_cvt_pk_bf16_f32 v135, v38, v39
s_nop 0
v_permlane16_swap_b32 v132, v134
v_permlane16_swap_b32 v133, v135
buffer_store_dwordx4 v[132:135], v128, s[16:19], s3 offen offset:0
v_pk_add_f32 v[40:41], v[40:41], v[232:233]
v_pk_add_f32 v[42:43], v[42:43], v[234:235]
v_pk_add_f32 v[44:45], v[44:45], v[236:237]
v_pk_add_f32 v[46:47], v[46:47], v[238:239]
v_cvt_pk_bf16_f32 v136, v40, v41
v_cvt_pk_bf16_f32 v137, v42, v43
v_cvt_pk_bf16_f32 v138, v44, v45
v_cvt_pk_bf16_f32 v139, v46, v47
s_nop 0
v_permlane16_swap_b32 v136, v138
v_permlane16_swap_b32 v137, v139
buffer_store_dwordx4 v[136:139], v128, s[16:19], s3 offen offset:64
s_add_u32 s3, s3, 65536
v_pk_add_f32 v[64:65], v[64:65], v[240:241]
v_pk_add_f32 v[66:67], v[66:67], v[242:243]
v_pk_add_f32 v[68:69], v[68:69], v[244:245]
v_pk_add_f32 v[70:71], v[70:71], v[246:247]
v_cvt_pk_bf16_f32 v132, v64, v65
v_cvt_pk_bf16_f32 v133, v66, v67
v_cvt_pk_bf16_f32 v134, v68, v69
v_cvt_pk_bf16_f32 v135, v70, v71
s_nop 0
v_permlane16_swap_b32 v132, v134
v_permlane16_swap_b32 v133, v135
buffer_store_dwordx4 v[132:135], v128, s[16:19], s3 offen offset:0
v_pk_add_f32 v[72:73], v[72:73], v[248:249]
v_pk_add_f32 v[74:75], v[74:75], v[250:251]
v_pk_add_f32 v[76:77], v[76:77], v[252:253]
v_pk_add_f32 v[78:79], v[78:79], v[254:255]
v_cvt_pk_bf16_f32 v136, v72, v73
v_cvt_pk_bf16_f32 v137, v74, v75
v_cvt_pk_bf16_f32 v138, v76, v77
v_cvt_pk_bf16_f32 v139, v78, v79
s_nop 0
v_permlane16_swap_b32 v136, v138
v_permlane16_swap_b32 v137, v139
buffer_store_dwordx4 v[136:139], v128, s[16:19], s3 offen offset:64
s_endpgm
Lk3_spinb0:
Lk3_spinb0_:
s_add_u32 s61, s61, 1
s_cmp_gt_u32 s61, 1048576
s_cbranch_scc1 Lk3_gotb0
s_sleep 2
buffer_load_dword v7, v15, s[52:55], s43 offen sc1
s_waitcnt vmcnt(0)
v_cmp_ne_u32 vcc, 1, v7
s_nop 0
s_cbranch_vccnz Lk3_spinb0_
s_branch Lk3_gotb0
Lk3_spinb1:
Lk3_spinb1_:
s_add_u32 s61, s61, 1
s_cmp_gt_u32 s61, 1048576
s_cbranch_scc1 Lk3_gotb1
s_sleep 2
buffer_load_dword v7, v15, s[52:55], s43 offen sc1
s_waitcnt vmcnt(0)
v_cmp_ne_u32 vcc, 1, v7
s_nop 0
s_cbranch_vccnz Lk3_spinb1_
s_branch Lk3_gotb1
Lk3_spinft:
s_add_u32 s61, s61, 1
s_cmp_gt_u32 s61, 1048576
s_cbranch_scc1 Lk3_gotft
s_sleep 2
buffer_load_dword v252, v255, s[52:55], s62 offen sc1
s_waitcnt vmcnt(0)
v_cmp_ne_u32 vcc, 1, v252
s_nop 0
s_cbranch_vccnz Lk3_spinft
s_branch Lk3_gotft
Lk3_spinfl:
s_add_u32 s61, s61, 1
s_cmp_gt_u32 s61, 1048576
s_cbranch_scc1 Lk3_gotfl
s_sleep 2
buffer_load_dword v8, v11, s[52:55], s59 offen sc1
s_waitcnt vmcnt(0)
v_cmp_ne_u32 vcc, 1, v8
s_nop 0
s_cbranch_vccnz Lk3_spinfl
s_branch Lk3_gotfl
.section .rodata,"a"
.p2align 6
.amdhsa_kernel concat_heads__compressed_kv_cla__sliding_local_dilated__prompt_kernel
  .amdhsa_next_free_vgpr 512
  .amdhsa_next_free_sgpr 102
  .amdhsa_accum_offset 256
  .amdhsa_group_segment_fixed_size 0
  .amdhsa_kernarg_size 96
  .amdhsa_user_sgpr_count 2
  .amdhsa_user_sgpr_kernarg_segment_ptr 1
  .amdhsa_system_sgpr_workgroup_id_x 1
.end_amdhsa_kernel
```

```asm
; @launch grid=(256,1,1) block=(256,1,1) lds=163840
.amdgcn_target "amdgcn-amd-amdhsa--gfx950"
.text
.macro M d, a, b, c
v_mfma_f32_16x16x32_bf16 \d, \a, \b, \c
.endm
.globl concat_heads__compressed_kv_cla__sliding_local_dilated__prompt_kernel
.p2align 8
.type concat_heads__compressed_kv_cla__sliding_local_dilated__prompt_kernel,@function
concat_heads__compressed_kv_cla__sliding_local_dilated__prompt_kernel:
s_cmp_lt_u32 s2, 256
s_cbranch_scc1 Lk1_go
s_endpgm
Lk1_go:
s_load_dwordx16 s[32:47], s[0:1], 0
s_load_dwordx2 s[48:49], s[0:1], 64
s_load_dwordx2 s[50:51], s[0:1], 88
s_load_dwordx2 s[90:91], s[0:1], 80
v_lshrrev_b32 v24, 6, v0
s_nop 0
v_readfirstlane_b32 s20, v24
v_and_b32 v0, 63, v0
v_lshlrev_b32 v1, 4, v0
s_mov_b32 s101, s20
s_lshr_b32 s21, s20, 1
s_and_b32 s22, s20, 1
s_lshl_b32 s29, s20, 12
s_and_b32 s3, s2, 1
s_lshl_b32 s3, s3, 2
s_bfe_u32 s6, s2, 0x20003
s_add_u32 s3, s3, s6
s_lshl_b32 s52, s3, 8
s_bfe_u32 s3, s2, 0x20001
s_lshl_b32 s3, s3, 2
s_bfe_u32 s7, s2, 0x20005
s_add_u32 s3, s3, s7
s_lshl_b32 s53, s3, 8
s_cmp_lt_u32 s2, 128
s_cselect_b32 s5, 11, 10
s_lshl_b32 s3, s21, 7
s_lshl_b32 s4, s22, 5
s_add_u32 s3, s3, s4
v_lshrrev_b32 v24, 3, v0
v_add_u32 v24, s3, v24
v_and_b32 v25, 7, v0
v_add_u32 v26, 0, v24
v_bfe_u32 v27, v26, 1, 3
v_xor_b32 v27, v27, v25
v_lshlrev_b32 v26, s5, v26
v_lshl_add_u32 v26, v27, 4, v26
v_subrev_u32 v2, 0, v26
v_add_u32 v26, 8, v24
v_bfe_u32 v27, v26, 1, 3
v_xor_b32 v27, v27, v25
v_lshlrev_b32 v26, s5, v26
v_lshl_add_u32 v26, v27, 4, v26
v_subrev_u32 v3, 1024, v26
v_add_u32 v26, 16, v24
v_bfe_u32 v27, v26, 1, 3
v_xor_b32 v27, v27, v25
v_lshlrev_b32 v26, s5, v26
v_lshl_add_u32 v26, v27, 4, v26
v_subrev_u32 v4, 2048, v26
v_add_u32 v26, 24, v24
v_bfe_u32 v27, v26, 1, 3
v_xor_b32 v27, v27, v25
v_lshlrev_b32 v26, s5, v26
v_lshl_add_u32 v26, v27, 4, v26
v_subrev_u32 v5, 3072, v26
s_lshl_b32 s3, s20, 3
v_lshrrev_b32 v24, 5, v0
v_add_u32 v24, s3, v24
v_and_b32 v25, 31, v0
v_add_u32 v26, 0, v24
v_and_b32 v27, 3, v26
v_lshlrev_b32 v27, 1, v27
v_and_or_b32 v27, v26, 8, v27
v_xor_b32 v27, v27, v25
v_lshlrev_b32 v26, 13, v26
v_lshl_add_u32 v26, v27, 4, v26
v_subrev_u32 v6, 0, v26
v_add_u32 v26, 2, v24
v_and_b32 v27, 3, v26
v_lshlrev_b32 v27, 1, v27
v_and_or_b32 v27, v26, 8, v27
v_xor_b32 v27, v27, v25
v_lshlrev_b32 v26, 13, v26
v_lshl_add_u32 v26, v27, 4, v26
v_subrev_u32 v7, 1024, v26
v_add_u32 v26, 4, v24
v_and_b32 v27, 3, v26
v_lshlrev_b32 v27, 1, v27
v_and_or_b32 v27, v26, 8, v27
v_xor_b32 v27, v27, v25
v_lshlrev_b32 v26, 13, v26
v_lshl_add_u32 v26, v27, 4, v26
v_subrev_u32 v8, 2048, v26
v_add_u32 v26, 6, v24
v_and_b32 v27, 3, v26
v_lshlrev_b32 v27, 1, v27
v_and_or_b32 v27, v26, 8, v27
v_xor_b32 v27, v27, v25
v_lshlrev_b32 v26, 13, v26
v_lshl_add_u32 v26, v27, 4, v26
v_subrev_u32 v9, 3072, v26
s_lshl_b32 s23, s52, s5
s_lshl_b32 s31, 64, s5
s_mov_b32 s26, s23
s_lshl_b32 s24, s53, 1
s_mov_b32 s28, s24
s_lshl_b32 s3, 1, s5
s_add_u32 s25, s23, s3
s_lshl_b32 s3, s3, 12
s_add_u32 s27, s24, s3
s_bfe_u32 s3, s2, 0x20001
s_and_b32 s4, s2, 1
s_lshl_b32 s4, s4, 1
s_add_u32 s3, s3, s4
s_and_b32 s3, s3, 3
s_sub_u32 s4, s5, 2
s_lshl_b32 s3, s3, s4
s_add_u32 s23, s23, s3
s_lshl_b32 s3, s3, 12
s_add_u32 s24, s24, s3
s_mov_b32 s95, s6
s_cmp_lt_u32 s2, 128
s_cselect_b32 s6, -1, 8
s_waitcnt lgkmcnt(0)
s_cmp_lt_u32 s2, 128
s_cselect_b64 s[8:9], s[32:33], s[34:35]
s_mov_b32 s10, 2097152
s_cselect_b32 s10, 4194304, s10
s_mov_b32 s11, 0x00020000
s_cselect_b64 s[12:13], s[36:37], s[38:39]
s_mov_b32 s14, 4194304
s_cselect_b32 s14, 8388608, s14
s_mov_b32 s15, 0x00020000
s_mov_b64 s[64:65], s[40:41]
s_add_u32 m0, s29, 65536
s_nop 0
buffer_load_dwordx4 v6, s[12:15], s24 offen offset:0 lds
buffer_load_dwordx4 v7, s[12:15], s24 offen offset:1024 lds
buffer_load_dwordx4 v8, s[12:15], s24 offen offset:2048 lds
buffer_load_dwordx4 v9, s[12:15], s24 offen offset:3072 lds
s_add_u32 s24, s24, 262144
s_add_u32 m0, s29, 0
s_nop 0
buffer_load_dwordx4 v2, s[8:11], s23 offen offset:0 lds
buffer_load_dwordx4 v3, s[8:11], s23 offen offset:1024 lds
buffer_load_dwordx4 v4, s[8:11], s23 offen offset:2048 lds
buffer_load_dwordx4 v5, s[8:11], s23 offen offset:3072 lds
s_add_u32 m0, s29, 81920
s_nop 0
buffer_load_dwordx4 v6, s[12:15], s24 offen offset:0 lds
buffer_load_dwordx4 v7, s[12:15], s24 offen offset:1024 lds
buffer_load_dwordx4 v8, s[12:15], s24 offen offset:2048 lds
buffer_load_dwordx4 v9, s[12:15], s24 offen offset:3072 lds
s_add_u32 s24, s24, 262144
s_cmp_eq_u32 s24, s27
s_cselect_b32 s24, s28, s24
s_sub_u32 s6, s6, 1
s_cmp_eq_u32 s6, 0
s_cselect_b64 s[12:13], s[64:65], s[12:13]
s_add_u32 m0, s29, 98304
s_nop 0
buffer_load_dwordx4 v6, s[12:15], s24 offen offset:0 lds
buffer_load_dwordx4 v7, s[12:15], s24 offen offset:1024 lds
buffer_load_dwordx4 v8, s[12:15], s24 offen offset:2048 lds
buffer_load_dwordx4 v9, s[12:15], s24 offen offset:3072 lds
s_add_u32 s24, s24, 262144
s_add_u32 m0, s29, 16384
s_add_u32 s3, s23, s31
s_nop 0
buffer_load_dwordx4 v2, s[8:11], s3 offen offset:0 lds
buffer_load_dwordx4 v3, s[8:11], s3 offen offset:1024 lds
buffer_load_dwordx4 v4, s[8:11], s3 offen offset:2048 lds
buffer_load_dwordx4 v5, s[8:11], s3 offen offset:3072 lds
s_add_u32 s23, s23, 128
s_cmp_eq_u32 s23, s25
s_cselect_b32 s23, s26, s23
s_add_u32 m0, s29, 114688
s_nop 0
buffer_load_dwordx4 v6, s[12:15], s24 offen offset:0 lds
buffer_load_dwordx4 v7, s[12:15], s24 offen offset:1024 lds
buffer_load_dwordx4 v8, s[12:15], s24 offen offset:2048 lds
buffer_load_dwordx4 v9, s[12:15], s24 offen offset:3072 lds
s_add_u32 s24, s24, 262144
s_cmp_eq_u32 s24, s27
s_cselect_b32 s24, s28, s24
s_sub_u32 s6, s6, 1
s_cmp_eq_u32 s6, 0
s_cselect_b64 s[12:13], s[64:65], s[12:13]
s_add_u32 s16, s50, 109051904
s_addc_u32 s17, s51, 0
s_mov_b32 s18, 16384
s_mov_b32 s19, 0x00020000
v_mov_b32 v24, 0
v_mov_b32 v25, 0
v_mov_b32 v26, 0
v_mov_b32 v27, 0
s_lshl_b32 s3, s2, 2
buffer_store_dword v24, v24, s[16:19], s3 offen sc1
s_and_b32 s3, s2, 7
s_lshr_b32 s4, s2, 6
s_lshl_b32 s4, s4, 3
s_add_u32 s3, s3, s4
s_lshl_b32 s3, s3, 4
s_add_u32 s3, s3, 4096
s_bfe_u32 s4, s2, 0x30003
s_lshl_b32 s4, s4, 9
s_add_u32 s92, s3, s4
s_sub_u32 s4, 7680, s4
s_add_u32 s93, s3, s4
buffer_store_dwordx4 v[24:27], v24, s[16:19], s92 offen sc1
buffer_store_dwordx4 v[24:27], v24, s[16:19], s93 offen sc1
s_and_b32 s3, s2, 1
s_lshl_b32 s3, s3, 3
s_bfe_u32 s4, s2, 0x30003
s_add_u32 s92, s3, s4
s_bfe_u32 s3, s2, 0x20001
s_lshl_b32 s3, s3, 2
s_lshr_b32 s4, s2, 6
s_xor_b32 s4, s4, 2
s_add_u32 s93, s3, s4
s_lshl_b32 s92, s92, 8
s_lshl_b32 s93, s93, 4
s_add_u32 s92, s92, s93
s_add_u32 s92, s92, 12288
buffer_store_dwordx4 v[24:27], v24, s[16:19], s92 offen sc1
v_lshlrev_b32 v20, 7, v0
s_lshl_b32 s54, s2, 13
s_mov_b64 s[60:61], s[40:41]
s_mov_b32 s62, 0
s_cmp_eq_u32 s20, 1
s_cselect_b64 s[60:61], s[46:47], s[60:61]
s_cselect_b32 s62, 6291456, s62
s_cmp_eq_u32 s20, 2
s_cselect_b64 s[60:61], s[44:45], s[60:61]
s_cselect_b32 s62, 4194304, s62
s_cmp_eq_u32 s20, 3
s_cselect_b32 s62, 0, s62
s_mov_b32 s63, 0x00020000
s_mov_b32 s3, 0
s_cmp_eq_u32 s20, 1
s_cselect_b32 s3, 6291456, s3
s_cmp_eq_u32 s20, 2
s_cselect_b32 s3, 6291456, s3
s_sub_u32 s54, s54, s3
Lc0:
s_getpc_b64 s[92:93]
Lpc_1:
s_add_u32 s92, s92, Lc1-Lpc_1
s_addc_u32 s93, s93, 0
s_lshr_b32 s94, s2, 3
s_mul_i32 s94, s94, ((Lc3-Lc1)/32+127)&~127
v_lshlrev_b32 v24, 7, v0
v_add_u32 v24, s94, v24
v_min_u32 v24, Lc3-Lc1-4, v24
global_load_dword v21, v24, s[92:93]
s_add_u32 m0, s29, 32768
s_nop 0
buffer_load_dwordx4 v2, s[8:11], s23 offen offset:0 lds
buffer_load_dwordx4 v3, s[8:11], s23 offen offset:1024 lds
buffer_load_dwordx4 v4, s[8:11], s23 offen offset:2048 lds
buffer_load_dwordx4 v5, s[8:11], s23 offen offset:3072 lds
s_lshl_b32 s4, s21, 13
v_and_b32 v24, 15, v0
v_lshlrev_b32 v24, 7, v24
v_add_u32 v24, s4, v24
v_bfe_u32 v25, v0, 1, 3
v_lshrrev_b32 v26, 4, v0
v_xor_b32 v25, v25, v26
v_lshl_add_u32 v10, v25, 4, v24
v_xor_b32 v11, 64, v10
v_bfe_u32 v24, v0, 2, 2
v_lshl_add_u32 v29, v26, 3, v24
v_lshlrev_b32 v25, 9, v29
v_and_b32 v27, 1, v0
v_lshl_add_u32 v25, v27, 3, v25
v_add_u32 v25, 65536, v25
v_lshlrev_b32 v24, 1, v24
v_and_or_b32 v24, v29, 8, v24
v_bfe_u32 v26, v0, 1, 1
s_lshl_b32 s4, s22, 4
s_add_u32 s3, s4, 0
v_add_u32 v27, s3, v26
v_xor_b32 v27, v27, v24
v_lshl_add_u32 v12, v27, 4, v25
s_add_u32 s3, s4, 2
v_add_u32 v27, s3, v26
v_xor_b32 v27, v27, v24
v_lshl_add_u32 v13, v27, 4, v25
s_add_u32 s3, s4, 4
v_add_u32 v27, s3, v26
v_xor_b32 v27, v27, v24
v_lshl_add_u32 v14, v27, 4, v25
s_add_u32 s3, s4, 6
v_add_u32 v27, s3, v26
v_xor_b32 v27, v27, v24
v_lshl_add_u32 v15, v27, 4, v25
s_add_u32 s3, s4, 8
v_add_u32 v27, s3, v26
v_xor_b32 v27, v27, v24
v_lshl_add_u32 v16, v27, 4, v25
s_add_u32 s3, s4, 10
v_add_u32 v27, s3, v26
v_xor_b32 v27, v27, v24
v_lshl_add_u32 v17, v27, 4, v25
s_add_u32 s3, s4, 12
v_add_u32 v27, s3, v26
v_xor_b32 v27, v27, v24
v_lshl_add_u32 v18, v27, 4, v25
s_add_u32 s3, s4, 14
v_add_u32 v27, s3, v26
v_xor_b32 v27, v27, v24
v_lshl_add_u32 v19, v27, 4, v25
s_waitcnt vmcnt(21)
s_barrier
ds_read_b64_tr_b16 a[32:33], v12 offset:0
ds_read_b64_tr_b16 a[34:35], v12 offset:2048
ds_read_b64_tr_b16 a[40:41], v13 offset:0
ds_read_b64_tr_b16 a[42:43], v13 offset:2048
ds_read_b64_tr_b16 a[48:49], v14 offset:0
ds_read_b64_tr_b16 a[50:51], v14 offset:2048
ds_read_b64_tr_b16 a[56:57], v15 offset:0
ds_read_b64_tr_b16 a[58:59], v15 offset:2048
ds_read_b64_tr_b16 a[64:65], v16 offset:0
ds_read_b64_tr_b16 a[66:67], v16 offset:2048
ds_read_b64_tr_b16 a[72:73], v17 offset:0
ds_read_b64_tr_b16 a[74:75], v17 offset:2048
ds_read_b64_tr_b16 a[80:81], v18 offset:0
ds_read_b64_tr_b16 a[82:83], v18 offset:2048
ds_read_b64_tr_b16 a[88:89], v19 offset:0
ds_read_b64_tr_b16 a[90:91], v19 offset:2048
ds_read_b64_tr_b16 a[36:37], v12 offset:16384
ds_read_b64_tr_b16 a[38:39], v12 offset:18432
ds_read_b64_tr_b16 a[44:45], v13 offset:16384
ds_read_b64_tr_b16 a[46:47], v13 offset:18432
ds_read_b64_tr_b16 a[52:53], v14 offset:16384
ds_read_b64_tr_b16 a[54:55], v14 offset:18432
ds_read_b64_tr_b16 a[60:61], v15 offset:16384
ds_read_b64_tr_b16 a[62:63], v15 offset:18432
ds_read_b64_tr_b16 a[68:69], v16 offset:16384
ds_read_b64_tr_b16 a[70:71], v16 offset:18432
ds_read_b64_tr_b16 a[76:77], v17 offset:16384
ds_read_b64_tr_b16 a[78:79], v17 offset:18432
ds_read_b64_tr_b16 a[84:85], v18 offset:16384
ds_read_b64_tr_b16 a[86:87], v18 offset:18432
ds_read_b64_tr_b16 a[92:93], v19 offset:16384
ds_read_b64_tr_b16 a[94:95], v19 offset:18432
ds_read_b128 a[160:163], v10 offset:0
ds_read_b128 a[164:167], v11 offset:0
ds_read_b128 a[168:171], v10 offset:2048
ds_read_b128 a[172:175], v11 offset:2048
s_waitcnt vmcnt(17) lgkmcnt(0)
s_barrier
s_add_u32 m0, s29, 65536
s_nop 0
buffer_load_dwordx4 v6, s[12:15], s24 offen offset:0 lds
buffer_load_dwordx4 v7, s[12:15], s24 offen offset:1024 lds
buffer_load_dwordx4 v8, s[12:15], s24 offen offset:2048 lds
buffer_load_dwordx4 v9, s[12:15], s24 offen offset:3072 lds
s_add_u32 s24, s24, 262144
s_add_u32 m0, s29, 49152
s_add_u32 s3, s23, s31
s_nop 0
buffer_load_dwordx4 v2, s[8:11], s3 offen offset:0 lds
buffer_load_dwordx4 v3, s[8:11], s3 offen offset:1024 lds
buffer_load_dwordx4 v4, s[8:11], s3 offen offset:2048 lds
buffer_load_dwordx4 v5, s[8:11], s3 offen offset:3072 lds
Lc1:
s_cmp_lt_u32 s2, 128
s_cbranch_scc0 Lk1_kv
M v[32:35], a[32:35], a[160:163], 0
s_add_u32 s23, s23, 128
s_cmp_eq_u32 s23, s25
s_cselect_b32 s23, s26, s23
M v[32:35], a[36:39], a[164:167], v[32:35]
ds_read_b128 a[176:179], v10 offset:4096
ds_read_b128 a[180:183], v11 offset:4096
M v[36:39], a[44:47], a[164:167], 0
M v[36:39], a[40:43], a[160:163], v[36:39]
ds_read_b64_tr_b16 a[96:97], v12 offset:32768
ds_read_b64_tr_b16 a[98:99], v12 offset:34816
M v[40:43], a[48:51], a[160:163], 0
M v[40:43], a[52:55], a[164:167], v[40:43]
M v[44:47], a[60:63], a[164:167], 0
s_add_u32 m0, s29, 81920
s_nop 0
buffer_load_dwordx4 v6, s[12:15], s24 offen offset:0 lds
M v[44:47], a[56:59], a[160:163], v[44:47]
ds_read_b64_tr_b16 a[104:105], v13 offset:32768
ds_read_b64_tr_b16 a[106:107], v13 offset:34816
M v[48:51], a[64:67], a[160:163], 0
M v[48:51], a[68:71], a[164:167], v[48:51]
M v[52:55], a[76:79], a[164:167], 0
M v[52:55], a[72:75], a[160:163], v[52:55]
ds_read_b64_tr_b16 a[112:113], v14 offset:32768
ds_read_b64_tr_b16 a[114:115], v14 offset:34816
M v[56:59], a[80:83], a[160:163], 0
M v[56:59], a[84:87], a[164:167], v[56:59]
buffer_load_dwordx4 v7, s[12:15], s24 offen offset:1024 lds
M v[60:63], a[92:95], a[164:167], 0
M v[60:63], a[88:91], a[160:163], v[60:63]
ds_read_b64_tr_b16 a[120:121], v15 offset:32768
ds_read_b64_tr_b16 a[122:123], v15 offset:34816
M v[64:67], a[32:35], a[168:171], 0
M v[64:67], a[36:39], a[172:175], v[64:67]
ds_read_b128 a[184:187], v10 offset:6144
ds_read_b128 a[188:191], v11 offset:6144
M v[68:71], a[44:47], a[172:175], 0
M v[68:71], a[40:43], a[168:171], v[68:71]
ds_read_b64_tr_b16 a[128:129], v16 offset:32768
ds_read_b64_tr_b16 a[130:131], v16 offset:34816
M v[72:75], a[48:51], a[168:171], 0
buffer_load_dwordx4 v8, s[12:15], s24 offen offset:2048 lds
M v[72:75], a[52:55], a[172:175], v[72:75]
M v[76:79], a[60:63], a[172:175], 0
M v[76:79], a[56:59], a[168:171], v[76:79]
ds_read_b64_tr_b16 a[136:137], v17 offset:32768
ds_read_b64_tr_b16 a[138:139], v17 offset:34816
M v[80:83], a[64:67], a[168:171], 0
M v[80:83], a[68:71], a[172:175], v[80:83]
M v[84:87], a[76:79], a[172:175], 0
buffer_load_dwordx4 v9, s[12:15], s24 offen offset:3072 lds
M v[84:87], a[72:75], a[168:171], v[84:87]
ds_read_b64_tr_b16 a[144:145], v18 offset:32768
ds_read_b64_tr_b16 a[146:147], v18 offset:34816
M v[88:91], a[80:83], a[168:171], 0
M v[88:91], a[84:87], a[172:175], v[88:91]
M v[92:95], a[92:95], a[172:175], 0
M v[92:95], a[88:91], a[168:171], v[92:95]
s_waitcnt lgkmcnt(15)
ds_read_b64_tr_b16 a[152:153], v19 offset:32768
ds_read_b64_tr_b16 a[154:155], v19 offset:34816
M v[96:99], a[32:35], a[176:179], 0
s_add_u32 s24, s24, 262144
s_cmp_eq_u32 s24, s27
s_cselect_b32 s24, s28, s24
s_sub_u32 s6, s6, 1
s_cmp_eq_u32 s6, 0
s_cselect_b64 s[12:13], s[64:65], s[12:13]
M v[96:99], a[36:39], a[180:183], v[96:99]
M v[100:103], a[44:47], a[180:183], 0
M v[100:103], a[40:43], a[176:179], v[100:103]
M v[104:107], a[48:51], a[176:179], 0
M v[104:107], a[52:55], a[180:183], v[104:107]
M v[108:111], a[60:63], a[180:183], 0
M v[108:111], a[56:59], a[176:179], v[108:111]
s_waitcnt vmcnt(17) lgkmcnt(0)
s_barrier
ds_read_b128 a[160:163], v10 offset:16384
ds_read_b128 a[164:167], v11 offset:16384
M v[112:115], a[64:67], a[176:179], 0
s_add_u32 m0, s29, 0
s_nop 0
buffer_load_dwordx4 v2, s[8:11], s23 offen offset:0 lds
M v[112:115], a[68:71], a[180:183], v[112:115]
M v[116:119], a[76:79], a[180:183], 0
M v[116:119], a[72:75], a[176:179], v[116:119]
ds_read_b64_tr_b16 a[100:101], v12 offset:49152
ds_read_b64_tr_b16 a[102:103], v12 offset:51200
M v[120:123], a[80:83], a[176:179], 0
M v[120:123], a[84:87], a[180:183], v[120:123]
buffer_load_dwordx4 v3, s[8:11], s23 offen offset:1024 lds
M v[124:127], a[92:95], a[180:183], 0
M v[124:127], a[88:91], a[176:179], v[124:127]
M v[128:131], a[32:35], a[184:187], 0
M v[128:131], a[36:39], a[188:191], v[128:131]
ds_read_b128 a[168:171], v10 offset:18432
ds_read_b128 a[172:175], v11 offset:18432
ds_read_b64_tr_b16 a[108:109], v13 offset:49152
ds_read_b64_tr_b16 a[110:111], v13 offset:51200
M v[132:135], a[44:47], a[188:191], 0
M v[132:135], a[40:43], a[184:187], v[132:135]
M v[136:139], a[48:51], a[184:187], 0
buffer_load_dwordx4 v4, s[8:11], s23 offen offset:2048 lds
M v[136:139], a[52:55], a[188:191], v[136:139]
M v[140:143], a[60:63], a[188:191], 0
M v[140:143], a[56:59], a[184:187], v[140:143]
ds_read_b64_tr_b16 a[116:117], v14 offset:49152
ds_read_b64_tr_b16 a[118:119], v14 offset:51200
M v[144:147], a[64:67], a[184:187], 0
M v[144:147], a[68:71], a[188:191], v[144:147]
M v[148:151], a[76:79], a[188:191], 0
buffer_load_dwordx4 v5, s[8:11], s23 offen offset:3072 lds
M v[148:151], a[72:75], a[184:187], v[148:151]
M v[152:155], a[80:83], a[184:187], 0
M v[152:155], a[84:87], a[188:191], v[152:155]
ds_read_b64_tr_b16 a[124:125], v15 offset:49152
ds_read_b64_tr_b16 a[126:127], v15 offset:51200
M v[156:159], a[92:95], a[188:191], 0
M v[156:159], a[88:91], a[184:187], v[156:159]
s_waitcnt lgkmcnt(10)
M v[160:163], a[32:35], a[160:163], 0
M v[160:163], a[36:39], a[164:167], v[160:163]
ds_read_b128 a[176:179], v10 offset:20480
ds_read_b128 a[180:183], v11 offset:20480
M v[164:167], a[44:47], a[164:167], 0
s_add_u32 m0, s29, 98304
s_nop 0
buffer_load_dwordx4 v6, s[12:15], s24 offen offset:0 lds
M v[164:167], a[40:43], a[160:163], v[164:167]
ds_read_b64_tr_b16 a[132:133], v16 offset:49152
ds_read_b64_tr_b16 a[134:135], v16 offset:51200
M v[168:171], a[48:51], a[160:163], 0
M v[168:171], a[52:55], a[164:167], v[168:171]
M v[172:175], a[60:63], a[164:167], 0
M v[172:175], a[56:59], a[160:163], v[172:175]
M v[176:179], a[64:67], a[160:163], 0
buffer_load_dwordx4 v7, s[12:15], s24 offen offset:1024 lds
M v[176:179], a[68:71], a[164:167], v[176:179]
ds_read_b64_tr_b16 a[140:141], v17 offset:49152
ds_read_b64_tr_b16 a[142:143], v17 offset:51200
M v[180:183], a[76:79], a[164:167], 0
M v[180:183], a[72:75], a[160:163], v[180:183]
M v[184:187], a[80:83], a[160:163], 0
M v[184:187], a[84:87], a[164:167], v[184:187]
buffer_load_dwordx4 v8, s[12:15], s24 offen offset:2048 lds
M v[188:191], a[92:95], a[164:167], 0
M v[188:191], a[88:91], a[160:163], v[188:191]
s_waitcnt lgkmcnt(12)
ds_read_b64_tr_b16 a[148:149], v18 offset:49152
ds_read_b64_tr_b16 a[150:151], v18 offset:51200
M v[192:195], a[32:35], a[168:171], 0
M v[192:195], a[36:39], a[172:175], v[192:195]
ds_read_b128 a[184:187], v10 offset:22528
ds_read_b128 a[188:191], v11 offset:22528
M v[196:199], a[44:47], a[172:175], 0
M v[196:199], a[40:43], a[168:171], v[196:199]
M v[200:203], a[48:51], a[168:171], 0
buffer_load_dwordx4 v9, s[12:15], s24 offen offset:3072 lds
M v[200:203], a[52:55], a[172:175], v[200:203]
ds_read_b64_tr_b16 a[156:157], v19 offset:49152
ds_read_b64_tr_b16 a[158:159], v19 offset:51200
M v[204:207], a[60:63], a[172:175], 0
M v[204:207], a[56:59], a[168:171], v[204:207]
M v[208:211], a[64:67], a[168:171], 0
M v[208:211], a[68:71], a[172:175], v[208:211]
M v[212:215], a[76:79], a[172:175], 0
s_add_u32 s24, s24, 262144
M v[212:215], a[72:75], a[168:171], v[212:215]
M v[216:219], a[80:83], a[168:171], 0
M v[216:219], a[84:87], a[172:175], v[216:219]
M v[220:223], a[92:95], a[172:175], 0
M v[220:223], a[88:91], a[168:171], v[220:223]
s_waitcnt lgkmcnt(10)
M v[224:227], a[32:35], a[176:179], 0
buffer_load_dword v21, v20, s[60:63], s54 offen
s_add_u32 s54, s54, 1048576
M v[224:227], a[36:39], a[180:183], v[224:227]
M v[228:231], a[44:47], a[180:183], 0
M v[228:231], a[40:43], a[176:179], v[228:231]
M v[232:235], a[48:51], a[176:179], 0
M v[232:235], a[52:55], a[180:183], v[232:235]
M v[236:239], a[60:63], a[180:183], 0
M v[236:239], a[56:59], a[176:179], v[236:239]
s_waitcnt vmcnt(17) lgkmcnt(0)
s_barrier
ds_read_b128 a[160:163], v10 offset:32768
ds_read_b128 a[164:167], v11 offset:32768
M v[240:243], a[64:67], a[176:179], 0
s_add_u32 m0, s29, 16384
s_add_u32 s3, s23, s31
buffer_load_dwordx4 v2, s[8:11], s3 offen offset:0 lds
M v[240:243], a[68:71], a[180:183], v[240:243]
M v[244:247], a[76:79], a[180:183], 0
M v[244:247], a[72:75], a[176:179], v[244:247]
M v[248:251], a[80:83], a[176:179], 0
M v[248:251], a[84:87], a[180:183], v[248:251]
buffer_load_dwordx4 v3, s[8:11], s3 offen offset:1024 lds
M v[252:255], a[92:95], a[180:183], 0
M v[252:255], a[88:91], a[176:179], v[252:255]
M a[0:3], a[32:35], a[184:187], 0
M a[0:3], a[36:39], a[188:191], a[0:3]
ds_read_b128 a[168:171], v10 offset:34816
ds_read_b128 a[172:175], v11 offset:34816
M a[4:7], a[44:47], a[188:191], 0
M a[4:7], a[40:43], a[184:187], a[4:7]
M a[8:11], a[48:51], a[184:187], 0
buffer_load_dwordx4 v4, s[8:11], s3 offen offset:2048 lds
M a[8:11], a[52:55], a[188:191], a[8:11]
M a[12:15], a[60:63], a[188:191], 0
M a[12:15], a[56:59], a[184:187], a[12:15]
M a[16:19], a[64:67], a[184:187], 0
M a[16:19], a[68:71], a[188:191], a[16:19]
buffer_load_dwordx4 v5, s[8:11], s3 offen offset:3072 lds
M a[20:23], a[76:79], a[188:191], 0
M a[20:23], a[72:75], a[184:187], a[20:23]
M a[24:27], a[80:83], a[184:187], 0
M a[24:27], a[84:87], a[188:191], a[24:27]
M a[28:31], a[92:95], a[188:191], 0
M a[28:31], a[88:91], a[184:187], a[28:31]
s_waitcnt lgkmcnt(2)
M v[32:35], a[96:99], a[160:163], v[32:35]
s_add_u32 s23, s23, 128
s_cmp_eq_u32 s23, s25
s_cselect_b32 s23, s26, s23
M v[32:35], a[100:103], a[164:167], v[32:35]
ds_read_b128 a[176:179], v10 offset:36864
ds_read_b128 a[180:183], v11 offset:36864
M v[36:39], a[108:111], a[164:167], v[36:39]
M v[36:39], a[104:107], a[160:163], v[36:39]
ds_read_b64_tr_b16 a[32:33], v12 offset:0
ds_read_b64_tr_b16 a[34:35], v12 offset:2048
M v[40:43], a[112:115], a[160:163], v[40:43]
M v[40:43], a[116:119], a[164:167], v[40:43]
M v[44:47], a[124:127], a[164:167], v[44:47]
s_add_u32 m0, s29, 114688
s_nop 0
buffer_load_dwordx4 v6, s[12:15], s24 offen offset:0 lds
M v[44:47], a[120:123], a[160:163], v[44:47]
ds_read_b64_tr_b16 a[40:41], v13 offset:0
ds_read_b64_tr_b16 a[42:43], v13 offset:2048
M v[48:51], a[128:131], a[160:163], v[48:51]
M v[48:51], a[132:135], a[164:167], v[48:51]
M v[52:55], a[140:143], a[164:167], v[52:55]
M v[52:55], a[136:139], a[160:163], v[52:55]
ds_read_b64_tr_b16 a[48:49], v14 offset:0
ds_read_b64_tr_b16 a[50:51], v14 offset:2048
M v[56:59], a[144:147], a[160:163], v[56:59]
M v[56:59], a[148:151], a[164:167], v[56:59]
buffer_load_dwordx4 v7, s[12:15], s24 offen offset:1024 lds
M v[60:63], a[156:159], a[164:167], v[60:63]
M v[60:63], a[152:155], a[160:163], v[60:63]
s_waitcnt lgkmcnt(8)
ds_read_b64_tr_b16 a[56:57], v15 offset:0
ds_read_b64_tr_b16 a[58:59], v15 offset:2048
M v[64:67], a[96:99], a[168:171], v[64:67]
M v[64:67], a[100:103], a[172:175], v[64:67]
ds_read_b128 a[184:187], v10 offset:38912
ds_read_b128 a[188:191], v11 offset:38912
M v[68:71], a[108:111], a[172:175], v[68:71]
M v[68:71], a[104:107], a[168:171], v[68:71]
ds_read_b64_tr_b16 a[64:65], v16 offset:0
ds_read_b64_tr_b16 a[66:67], v16 offset:2048
M v[72:75], a[112:115], a[168:171], v[72:75]
buffer_load_dwordx4 v8, s[12:15], s24 offen offset:2048 lds
M v[72:75], a[116:119], a[172:175], v[72:75]
M v[76:79], a[124:127], a[172:175], v[76:79]
M v[76:79], a[120:123], a[168:171], v[76:79]
ds_read_b64_tr_b16 a[72:73], v17 offset:0
ds_read_b64_tr_b16 a[74:75], v17 offset:2048
M v[80:83], a[128:131], a[168:171], v[80:83]
M v[80:83], a[132:135], a[172:175], v[80:83]
M v[84:87], a[140:143], a[172:175], v[84:87]
buffer_load_dwordx4 v9, s[12:15], s24 offen offset:3072 lds
M v[84:87], a[136:139], a[168:171], v[84:87]
ds_read_b64_tr_b16 a[80:81], v18 offset:0
ds_read_b64_tr_b16 a[82:83], v18 offset:2048
M v[88:91], a[144:147], a[168:171], v[88:91]
M v[88:91], a[148:151], a[172:175], v[88:91]
M v[92:95], a[156:159], a[172:175], v[92:95]
M v[92:95], a[152:155], a[168:171], v[92:95]
s_waitcnt lgkmcnt(15)
ds_read_b64_tr_b16 a[88:89], v19 offset:0
ds_read_b64_tr_b16 a[90:91], v19 offset:2048
M v[96:99], a[96:99], a[176:179], v[96:99]
s_add_u32 s24, s24, 262144
s_cmp_eq_u32 s24, s27
s_cselect_b32 s24, s28, s24
s_sub_u32 s6, s6, 1
s_cmp_eq_u32 s6, 0
s_cselect_b64 s[12:13], s[64:65], s[12:13]
M v[96:99], a[100:103], a[180:183], v[96:99]
M v[100:103], a[108:111], a[180:183], v[100:103]
M v[100:103], a[104:107], a[176:179], v[100:103]
M v[104:107], a[112:115], a[176:179], v[104:107]
M v[104:107], a[116:119], a[180:183], v[104:107]
M v[108:111], a[124:127], a[180:183], v[108:111]
M v[108:111], a[120:123], a[176:179], v[108:111]
s_waitcnt vmcnt(17) lgkmcnt(0)
s_barrier
ds_read_b128 a[160:163], v10 offset:49152
ds_read_b128 a[164:167], v11 offset:49152
M v[112:115], a[128:131], a[176:179], v[112:115]
s_add_u32 m0, s29, 32768
s_nop 0
buffer_load_dwordx4 v2, s[8:11], s23 offen offset:0 lds
M v[112:115], a[132:135], a[180:183], v[112:115]
M v[116:119], a[140:143], a[180:183], v[116:119]
M v[116:119], a[136:139], a[176:179], v[116:119]
ds_read_b64_tr_b16 a[36:37], v12 offset:16384
ds_read_b64_tr_b16 a[38:39], v12 offset:18432
M v[120:123], a[144:147], a[176:179], v[120:123]
M v[120:123], a[148:151], a[180:183], v[120:123]
buffer_load_dwordx4 v3, s[8:11], s23 offen offset:1024 lds
M v[124:127], a[156:159], a[180:183], v[124:127]
M v[124:127], a[152:155], a[176:179], v[124:127]
M v[128:131], a[96:99], a[184:187], v[128:131]
M v[128:131], a[100:103], a[188:191], v[128:131]
ds_read_b128 a[168:171], v10 offset:51200
ds_read_b128 a[172:175], v11 offset:51200
ds_read_b64_tr_b16 a[44:45], v13 offset:16384
ds_read_b64_tr_b16 a[46:47], v13 offset:18432
M v[132:135], a[108:111], a[188:191], v[132:135]
M v[132:135], a[104:107], a[184:187], v[132:135]
M v[136:139], a[112:115], a[184:187], v[136:139]
buffer_load_dwordx4 v4, s[8:11], s23 offen offset:2048 lds
M v[136:139], a[116:119], a[188:191], v[136:139]
M v[140:143], a[124:127], a[188:191], v[140:143]
M v[140:143], a[120:123], a[184:187], v[140:143]
ds_read_b64_tr_b16 a[52:53], v14 offset:16384
ds_read_b64_tr_b16 a[54:55], v14 offset:18432
M v[144:147], a[128:131], a[184:187], v[144:147]
M v[144:147], a[132:135], a[188:191], v[144:147]
M v[148:151], a[140:143], a[188:191], v[148:151]
buffer_load_dwordx4 v5, s[8:11], s23 offen offset:3072 lds
M v[148:151], a[136:139], a[184:187], v[148:151]
M v[152:155], a[144:147], a[184:187], v[152:155]
M v[152:155], a[148:151], a[188:191], v[152:155]
ds_read_b64_tr_b16 a[60:61], v15 offset:16384
ds_read_b64_tr_b16 a[62:63], v15 offset:18432
M v[156:159], a[156:159], a[188:191], v[156:159]
M v[156:159], a[152:155], a[184:187], v[156:159]
s_waitcnt lgkmcnt(10)
M v[160:163], a[96:99], a[160:163], v[160:163]
M v[160:163], a[100:103], a[164:167], v[160:163]
ds_read_b128 a[176:179], v10 offset:53248
ds_read_b128 a[180:183], v11 offset:53248
M v[164:167], a[108:111], a[164:167], v[164:167]
s_add_u32 m0, s29, 65536
s_nop 0
buffer_load_dwordx4 v6, s[12:15], s24 offen offset:0 lds
M v[164:167], a[104:107], a[160:163], v[164:167]
ds_read_b64_tr_b16 a[68:69], v16 offset:16384
ds_read_b64_tr_b16 a[70:71], v16 offset:18432
M v[168:171], a[112:115], a[160:163], v[168:171]
M v[168:171], a[116:119], a[164:167], v[168:171]
M v[172:175], a[124:127], a[164:167], v[172:175]
M v[172:175], a[120:123], a[160:163], v[172:175]
M v[176:179], a[128:131], a[160:163], v[176:179]
buffer_load_dwordx4 v7, s[12:15], s24 offen offset:1024 lds
M v[176:179], a[132:135], a[164:167], v[176:179]
ds_read_b64_tr_b16 a[76:77], v17 offset:16384
ds_read_b64_tr_b16 a[78:79], v17 offset:18432
M v[180:183], a[140:143], a[164:167], v[180:183]
M v[180:183], a[136:139], a[160:163], v[180:183]
M v[184:187], a[144:147], a[160:163], v[184:187]
M v[184:187], a[148:151], a[164:167], v[184:187]
buffer_load_dwordx4 v8, s[12:15], s24 offen offset:2048 lds
M v[188:191], a[156:159], a[164:167], v[188:191]
M v[188:191], a[152:155], a[160:163], v[188:191]
s_waitcnt lgkmcnt(12)
ds_read_b64_tr_b16 a[84:85], v18 offset:16384
ds_read_b64_tr_b16 a[86:87], v18 offset:18432
M v[192:195], a[96:99], a[168:171], v[192:195]
M v[192:195], a[100:103], a[172:175], v[192:195]
ds_read_b128 a[184:187], v10 offset:55296
ds_read_b128 a[188:191], v11 offset:55296
M v[196:199], a[108:111], a[172:175], v[196:199]
M v[196:199], a[104:107], a[168:171], v[196:199]
M v[200:203], a[112:115], a[168:171], v[200:203]
buffer_load_dwordx4 v9, s[12:15], s24 offen offset:3072 lds
M v[200:203], a[116:119], a[172:175], v[200:203]
ds_read_b64_tr_b16 a[92:93], v19 offset:16384
ds_read_b64_tr_b16 a[94:95], v19 offset:18432
M v[204:207], a[124:127], a[172:175], v[204:207]
M v[204:207], a[120:123], a[168:171], v[204:207]
M v[208:211], a[128:131], a[168:171], v[208:211]
M v[208:211], a[132:135], a[172:175], v[208:211]
M v[212:215], a[140:143], a[172:175], v[212:215]
s_add_u32 s24, s24, 262144
M v[212:215], a[136:139], a[168:171], v[212:215]
M v[216:219], a[144:147], a[168:171], v[216:219]
M v[216:219], a[148:151], a[172:175], v[216:219]
M v[220:223], a[156:159], a[172:175], v[220:223]
M v[220:223], a[152:155], a[168:171], v[220:223]
s_waitcnt lgkmcnt(10)
M v[224:227], a[96:99], a[176:179], v[224:227]
buffer_load_dword v21, v20, s[60:63], s54 offen
s_add_u32 s54, s54, 1048576
M v[224:227], a[100:103], a[180:183], v[224:227]
M v[228:231], a[108:111], a[180:183], v[228:231]
M v[228:231], a[104:107], a[176:179], v[228:231]
M v[232:235], a[112:115], a[176:179], v[232:235]
M v[232:235], a[116:119], a[180:183], v[232:235]
M v[236:239], a[124:127], a[180:183], v[236:239]
M v[236:239], a[120:123], a[176:179], v[236:239]
s_waitcnt vmcnt(18) lgkmcnt(0)
s_barrier
ds_read_b128 a[160:163], v10 offset:0
ds_read_b128 a[164:167], v11 offset:0
M v[240:243], a[128:131], a[176:179], v[240:243]
s_add_u32 m0, s29, 49152
s_add_u32 s3, s23, s31
buffer_load_dwordx4 v2, s[8:11], s3 offen offset:0 lds
M v[240:243], a[132:135], a[180:183], v[240:243]
M v[244:247], a[140:143], a[180:183], v[244:247]
M v[244:247], a[136:139], a[176:179], v[244:247]
M v[248:251], a[144:147], a[176:179], v[248:251]
M v[248:251], a[148:151], a[180:183], v[248:251]
buffer_load_dwordx4 v3, s[8:11], s3 offen offset:1024 lds
M v[252:255], a[156:159], a[180:183], v[252:255]
M v[252:255], a[152:155], a[176:179], v[252:255]
M a[0:3], a[96:99], a[184:187], a[0:3]
M a[0:3], a[100:103], a[188:191], a[0:3]
ds_read_b128 a[168:171], v10 offset:2048
ds_read_b128 a[172:175], v11 offset:2048
M a[4:7], a[108:111], a[188:191], a[4:7]
M a[4:7], a[104:107], a[184:187], a[4:7]
M a[8:11], a[112:115], a[184:187], a[8:11]
buffer_load_dwordx4 v4, s[8:11], s3 offen offset:2048 lds
M a[8:11], a[116:119], a[188:191], a[8:11]
M a[12:15], a[124:127], a[188:191], a[12:15]
M a[12:15], a[120:123], a[184:187], a[12:15]
M a[16:19], a[128:131], a[184:187], a[16:19]
M a[16:19], a[132:135], a[188:191], a[16:19]
buffer_load_dwordx4 v5, s[8:11], s3 offen offset:3072 lds
M a[20:23], a[140:143], a[188:191], a[20:23]
M a[20:23], a[136:139], a[184:187], a[20:23]
M a[24:27], a[144:147], a[184:187], a[24:27]
M a[24:27], a[148:151], a[188:191], a[24:27]
M a[28:31], a[156:159], a[188:191], a[28:31]
M a[28:31], a[152:155], a[184:187], a[28:31]
s_waitcnt lgkmcnt(2)
s_mov_b32 s30, 5
Lk1_ql:
M v[32:35], a[32:35], a[160:163], v[32:35]
s_add_u32 s23, s23, 128
s_cmp_eq_u32 s23, s25
s_cselect_b32 s23, s26, s23
M v[32:35], a[36:39], a[164:167], v[32:35]
ds_read_b128 a[176:179], v10 offset:4096
ds_read_b128 a[180:183], v11 offset:4096
M v[36:39], a[44:47], a[164:167], v[36:39]
M v[36:39], a[40:43], a[160:163], v[36:39]
ds_read_b64_tr_b16 a[96:97], v12 offset:32768
ds_read_b64_tr_b16 a[98:99], v12 offset:34816
M v[40:43], a[48:51], a[160:163], v[40:43]
M v[40:43], a[52:55], a[164:167], v[40:43]
M v[44:47], a[60:63], a[164:167], v[44:47]
s_add_u32 m0, s29, 81920
s_nop 0
buffer_load_dwordx4 v6, s[12:15], s24 offen offset:0 lds
M v[44:47], a[56:59], a[160:163], v[44:47]
ds_read_b64_tr_b16 a[104:105], v13 offset:32768
ds_read_b64_tr_b16 a[106:107], v13 offset:34816
M v[48:51], a[64:67], a[160:163], v[48:51]
M v[48:51], a[68:71], a[164:167], v[48:51]
M v[52:55], a[76:79], a[164:167], v[52:55]
M v[52:55], a[72:75], a[160:163], v[52:55]
ds_read_b64_tr_b16 a[112:113], v14 offset:32768
ds_read_b64_tr_b16 a[114:115], v14 offset:34816
M v[56:59], a[80:83], a[160:163], v[56:59]
M v[56:59], a[84:87], a[164:167], v[56:59]
buffer_load_dwordx4 v7, s[12:15], s24 offen offset:1024 lds
M v[60:63], a[92:95], a[164:167], v[60:63]
M v[60:63], a[88:91], a[160:163], v[60:63]
s_waitcnt lgkmcnt(8)
ds_read_b64_tr_b16 a[120:121], v15 offset:32768
ds_read_b64_tr_b16 a[122:123], v15 offset:34816
M v[64:67], a[32:35], a[168:171], v[64:67]
M v[64:67], a[36:39], a[172:175], v[64:67]
ds_read_b128 a[184:187], v10 offset:6144
ds_read_b128 a[188:191], v11 offset:6144
M v[68:71], a[44:47], a[172:175], v[68:71]
M v[68:71], a[40:43], a[168:171], v[68:71]
ds_read_b64_tr_b16 a[128:129], v16 offset:32768
ds_read_b64_tr_b16 a[130:131], v16 offset:34816
M v[72:75], a[48:51], a[168:171], v[72:75]
buffer_load_dwordx4 v8, s[12:15], s24 offen offset:2048 lds
M v[72:75], a[52:55], a[172:175], v[72:75]
M v[76:79], a[60:63], a[172:175], v[76:79]
M v[76:79], a[56:59], a[168:171], v[76:79]
ds_read_b64_tr_b16 a[136:137], v17 offset:32768
ds_read_b64_tr_b16 a[138:139], v17 offset:34816
M v[80:83], a[64:67], a[168:171], v[80:83]
M v[80:83], a[68:71], a[172:175], v[80:83]
M v[84:87], a[76:79], a[172:175], v[84:87]
buffer_load_dwordx4 v9, s[12:15], s24 offen offset:3072 lds
M v[84:87], a[72:75], a[168:171], v[84:87]
ds_read_b64_tr_b16 a[144:145], v18 offset:32768
ds_read_b64_tr_b16 a[146:147], v18 offset:34816
M v[88:91], a[80:83], a[168:171], v[88:91]
M v[88:91], a[84:87], a[172:175], v[88:91]
M v[92:95], a[92:95], a[172:175], v[92:95]
M v[92:95], a[88:91], a[168:171], v[92:95]
s_waitcnt lgkmcnt(15)
ds_read_b64_tr_b16 a[152:153], v19 offset:32768
ds_read_b64_tr_b16 a[154:155], v19 offset:34816
M v[96:99], a[32:35], a[176:179], v[96:99]
s_add_u32 s24, s24, 262144
s_cmp_eq_u32 s24, s27
s_cselect_b32 s24, s28, s24
s_sub_u32 s6, s6, 1
s_cmp_eq_u32 s6, 0
s_cselect_b64 s[12:13], s[64:65], s[12:13]
M v[96:99], a[36:39], a[180:183], v[96:99]
M v[100:103], a[44:47], a[180:183], v[100:103]
M v[100:103], a[40:43], a[176:179], v[100:103]
M v[104:107], a[48:51], a[176:179], v[104:107]
M v[104:107], a[52:55], a[180:183], v[104:107]
M v[108:111], a[60:63], a[180:183], v[108:111]
M v[108:111], a[56:59], a[176:179], v[108:111]
s_waitcnt vmcnt(17) lgkmcnt(0)
s_barrier
ds_read_b128 a[160:163], v10 offset:16384
ds_read_b128 a[164:167], v11 offset:16384
M v[112:115], a[64:67], a[176:179], v[112:115]
s_add_u32 m0, s29, 0
s_nop 0
buffer_load_dwordx4 v2, s[8:11], s23 offen offset:0 lds
M v[112:115], a[68:71], a[180:183], v[112:115]
M v[116:119], a[76:79], a[180:183], v[116:119]
M v[116:119], a[72:75], a[176:179], v[116:119]
ds_read_b64_tr_b16 a[100:101], v12 offset:49152
ds_read_b64_tr_b16 a[102:103], v12 offset:51200
M v[120:123], a[80:83], a[176:179], v[120:123]
M v[120:123], a[84:87], a[180:183], v[120:123]
buffer_load_dwordx4 v3, s[8:11], s23 offen offset:1024 lds
M v[124:127], a[92:95], a[180:183], v[124:127]
M v[124:127], a[88:91], a[176:179], v[124:127]
M v[128:131], a[32:35], a[184:187], v[128:131]
M v[128:131], a[36:39], a[188:191], v[128:131]
ds_read_b128 a[168:171], v10 offset:18432
ds_read_b128 a[172:175], v11 offset:18432
ds_read_b64_tr_b16 a[108:109], v13 offset:49152
ds_read_b64_tr_b16 a[110:111], v13 offset:51200
M v[132:135], a[44:47], a[188:191], v[132:135]
M v[132:135], a[40:43], a[184:187], v[132:135]
M v[136:139], a[48:51], a[184:187], v[136:139]
buffer_load_dwordx4 v4, s[8:11], s23 offen offset:2048 lds
M v[136:139], a[52:55], a[188:191], v[136:139]
M v[140:143], a[60:63], a[188:191], v[140:143]
M v[140:143], a[56:59], a[184:187], v[140:143]
ds_read_b64_tr_b16 a[116:117], v14 offset:49152
ds_read_b64_tr_b16 a[118:119], v14 offset:51200
M v[144:147], a[64:67], a[184:187], v[144:147]
M v[144:147], a[68:71], a[188:191], v[144:147]
M v[148:151], a[76:79], a[188:191], v[148:151]
buffer_load_dwordx4 v5, s[8:11], s23 offen offset:3072 lds
M v[148:151], a[72:75], a[184:187], v[148:151]
M v[152:155], a[80:83], a[184:187], v[152:155]
M v[152:155], a[84:87], a[188:191], v[152:155]
ds_read_b64_tr_b16 a[124:125], v15 offset:49152
ds_read_b64_tr_b16 a[126:127], v15 offset:51200
M v[156:159], a[92:95], a[188:191], v[156:159]
M v[156:159], a[88:91], a[184:187], v[156:159]
s_waitcnt lgkmcnt(10)
M v[160:163], a[32:35], a[160:163], v[160:163]
M v[160:163], a[36:39], a[164:167], v[160:163]
ds_read_b128 a[176:179], v10 offset:20480
ds_read_b128 a[180:183], v11 offset:20480
M v[164:167], a[44:47], a[164:167], v[164:167]
s_add_u32 m0, s29, 98304
s_nop 0
buffer_load_dwordx4 v6, s[12:15], s24 offen offset:0 lds
M v[164:167], a[40:43], a[160:163], v[164:167]
ds_read_b64_tr_b16 a[132:133], v16 offset:49152
ds_read_b64_tr_b16 a[134:135], v16 offset:51200
M v[168:171], a[48:51], a[160:163], v[168:171]
M v[168:171], a[52:55], a[164:167], v[168:171]
M v[172:175], a[60:63], a[164:167], v[172:175]
M v[172:175], a[56:59], a[160:163], v[172:175]
M v[176:179], a[64:67], a[160:163], v[176:179]
buffer_load_dwordx4 v7, s[12:15], s24 offen offset:1024 lds
M v[176:179], a[68:71], a[164:167], v[176:179]
ds_read_b64_tr_b16 a[140:141], v17 offset:49152
ds_read_b64_tr_b16 a[142:143], v17 offset:51200
M v[180:183], a[76:79], a[164:167], v[180:183]
M v[180:183], a[72:75], a[160:163], v[180:183]
M v[184:187], a[80:83], a[160:163], v[184:187]
M v[184:187], a[84:87], a[164:167], v[184:187]
buffer_load_dwordx4 v8, s[12:15], s24 offen offset:2048 lds
M v[188:191], a[92:95], a[164:167], v[188:191]
M v[188:191], a[88:91], a[160:163], v[188:191]
s_waitcnt lgkmcnt(12)
ds_read_b64_tr_b16 a[148:149], v18 offset:49152
ds_read_b64_tr_b16 a[150:151], v18 offset:51200
M v[192:195], a[32:35], a[168:171], v[192:195]
M v[192:195], a[36:39], a[172:175], v[192:195]
ds_read_b128 a[184:187], v10 offset:22528
ds_read_b128 a[188:191], v11 offset:22528
M v[196:199], a[44:47], a[172:175], v[196:199]
M v[196:199], a[40:43], a[168:171], v[196:199]
M v[200:203], a[48:51], a[168:171], v[200:203]
buffer_load_dwordx4 v9, s[12:15], s24 offen offset:3072 lds
M v[200:203], a[52:55], a[172:175], v[200:203]
ds_read_b64_tr_b16 a[156:157], v19 offset:49152
ds_read_b64_tr_b16 a[158:159], v19 offset:51200
M v[204:207], a[60:63], a[172:175], v[204:207]
M v[204:207], a[56:59], a[168:171], v[204:207]
M v[208:211], a[64:67], a[168:171], v[208:211]
M v[208:211], a[68:71], a[172:175], v[208:211]
M v[212:215], a[76:79], a[172:175], v[212:215]
s_add_u32 s24, s24, 262144
M v[212:215], a[72:75], a[168:171], v[212:215]
M v[216:219], a[80:83], a[168:171], v[216:219]
M v[216:219], a[84:87], a[172:175], v[216:219]
M v[220:223], a[92:95], a[172:175], v[220:223]
M v[220:223], a[88:91], a[168:171], v[220:223]
s_waitcnt lgkmcnt(10)
M v[224:227], a[32:35], a[176:179], v[224:227]
buffer_load_dword v21, v20, s[60:63], s54 offen
s_add_u32 s54, s54, 1048576
M v[224:227], a[36:39], a[180:183], v[224:227]
M v[228:231], a[44:47], a[180:183], v[228:231]
M v[228:231], a[40:43], a[176:179], v[228:231]
M v[232:235], a[48:51], a[176:179], v[232:235]
M v[232:235], a[52:55], a[180:183], v[232:235]
M v[236:239], a[60:63], a[180:183], v[236:239]
M v[236:239], a[56:59], a[176:179], v[236:239]
s_waitcnt vmcnt(18) lgkmcnt(0)
s_barrier
ds_read_b128 a[160:163], v10 offset:32768
ds_read_b128 a[164:167], v11 offset:32768
M v[240:243], a[64:67], a[176:179], v[240:243]
s_add_u32 m0, s29, 16384
s_add_u32 s3, s23, s31
buffer_load_dwordx4 v2, s[8:11], s3 offen offset:0 lds
M v[240:243], a[68:71], a[180:183], v[240:243]
M v[244:247], a[76:79], a[180:183], v[244:247]
M v[244:247], a[72:75], a[176:179], v[244:247]
M v[248:251], a[80:83], a[176:179], v[248:251]
M v[248:251], a[84:87], a[180:183], v[248:251]
buffer_load_dwordx4 v3, s[8:11], s3 offen offset:1024 lds
M v[252:255], a[92:95], a[180:183], v[252:255]
M v[252:255], a[88:91], a[176:179], v[252:255]
M a[0:3], a[32:35], a[184:187], a[0:3]
M a[0:3], a[36:39], a[188:191], a[0:3]
ds_read_b128 a[168:171], v10 offset:34816
ds_read_b128 a[172:175], v11 offset:34816
M a[4:7], a[44:47], a[188:191], a[4:7]
M a[4:7], a[40:43], a[184:187], a[4:7]
M a[8:11], a[48:51], a[184:187], a[8:11]
buffer_load_dwordx4 v4, s[8:11], s3 offen offset:2048 lds
M a[8:11], a[52:55], a[188:191], a[8:11]
M a[12:15], a[60:63], a[188:191], a[12:15]
M a[12:15], a[56:59], a[184:187], a[12:15]
M a[16:19], a[64:67], a[184:187], a[16:19]
M a[16:19], a[68:71], a[188:191], a[16:19]
buffer_load_dwordx4 v5, s[8:11], s3 offen offset:3072 lds
M a[20:23], a[76:79], a[188:191], a[20:23]
M a[20:23], a[72:75], a[184:187], a[20:23]
M a[24:27], a[80:83], a[184:187], a[24:27]
M a[24:27], a[84:87], a[188:191], a[24:27]
M a[28:31], a[92:95], a[188:191], a[28:31]
M a[28:31], a[88:91], a[184:187], a[28:31]
s_waitcnt lgkmcnt(2)
M v[32:35], a[96:99], a[160:163], v[32:35]
s_add_u32 s23, s23, 128
s_cmp_eq_u32 s23, s25
s_cselect_b32 s23, s26, s23
M v[32:35], a[100:103], a[164:167], v[32:35]
ds_read_b128 a[176:179], v10 offset:36864
ds_read_b128 a[180:183], v11 offset:36864
M v[36:39], a[108:111], a[164:167], v[36:39]
M v[36:39], a[104:107], a[160:163], v[36:39]
ds_read_b64_tr_b16 a[32:33], v12 offset:0
ds_read_b64_tr_b16 a[34:35], v12 offset:2048
M v[40:43], a[112:115], a[160:163], v[40:43]
M v[40:43], a[116:119], a[164:167], v[40:43]
M v[44:47], a[124:127], a[164:167], v[44:47]
s_add_u32 m0, s29, 114688
s_nop 0
buffer_load_dwordx4 v6, s[12:15], s24 offen offset:0 lds
M v[44:47], a[120:123], a[160:163], v[44:47]
ds_read_b64_tr_b16 a[40:41], v13 offset:0
ds_read_b64_tr_b16 a[42:43], v13 offset:2048
M v[48:51], a[128:131], a[160:163], v[48:51]
M v[48:51], a[132:135], a[164:167], v[48:51]
M v[52:55], a[140:143], a[164:167], v[52:55]
M v[52:55], a[136:139], a[160:163], v[52:55]
ds_read_b64_tr_b16 a[48:49], v14 offset:0
ds_read_b64_tr_b16 a[50:51], v14 offset:2048
M v[56:59], a[144:147], a[160:163], v[56:59]
M v[56:59], a[148:151], a[164:167], v[56:59]
buffer_load_dwordx4 v7, s[12:15], s24 offen offset:1024 lds
M v[60:63], a[156:159], a[164:167], v[60:63]
M v[60:63], a[152:155], a[160:163], v[60:63]
s_waitcnt lgkmcnt(8)
ds_read_b64_tr_b16 a[56:57], v15 offset:0
ds_read_b64_tr_b16 a[58:59], v15 offset:2048
M v[64:67], a[96:99], a[168:171], v[64:67]
M v[64:67], a[100:103], a[172:175], v[64:67]
ds_read_b128 a[184:187], v10 offset:38912
ds_read_b128 a[188:191], v11 offset:38912
M v[68:71], a[108:111], a[172:175], v[68:71]
M v[68:71], a[104:107], a[168:171], v[68:71]
ds_read_b64_tr_b16 a[64:65], v16 offset:0
ds_read_b64_tr_b16 a[66:67], v16 offset:2048
M v[72:75], a[112:115], a[168:171], v[72:75]
buffer_load_dwordx4 v8, s[12:15], s24 offen offset:2048 lds
M v[72:75], a[116:119], a[172:175], v[72:75]
M v[76:79], a[124:127], a[172:175], v[76:79]
M v[76:79], a[120:123], a[168:171], v[76:79]
ds_read_b64_tr_b16 a[72:73], v17 offset:0
ds_read_b64_tr_b16 a[74:75], v17 offset:2048
M v[80:83], a[128:131], a[168:171], v[80:83]
M v[80:83], a[132:135], a[172:175], v[80:83]
M v[84:87], a[140:143], a[172:175], v[84:87]
buffer_load_dwordx4 v9, s[12:15], s24 offen offset:3072 lds
M v[84:87], a[136:139], a[168:171], v[84:87]
ds_read_b64_tr_b16 a[80:81], v18 offset:0
ds_read_b64_tr_b16 a[82:83], v18 offset:2048
M v[88:91], a[144:147], a[168:171], v[88:91]
M v[88:91], a[148:151], a[172:175], v[88:91]
M v[92:95], a[156:159], a[172:175], v[92:95]
M v[92:95], a[152:155], a[168:171], v[92:95]
s_waitcnt lgkmcnt(15)
ds_read_b64_tr_b16 a[88:89], v19 offset:0
ds_read_b64_tr_b16 a[90:91], v19 offset:2048
M v[96:99], a[96:99], a[176:179], v[96:99]
s_add_u32 s24, s24, 262144
s_cmp_eq_u32 s24, s27
s_cselect_b32 s24, s28, s24
s_sub_u32 s6, s6, 1
s_cmp_eq_u32 s6, 0
s_cselect_b64 s[12:13], s[64:65], s[12:13]
M v[96:99], a[100:103], a[180:183], v[96:99]
M v[100:103], a[108:111], a[180:183], v[100:103]
M v[100:103], a[104:107], a[176:179], v[100:103]
M v[104:107], a[112:115], a[176:179], v[104:107]
M v[104:107], a[116:119], a[180:183], v[104:107]
M v[108:111], a[124:127], a[180:183], v[108:111]
M v[108:111], a[120:123], a[176:179], v[108:111]
s_waitcnt vmcnt(17) lgkmcnt(0)
s_barrier
ds_read_b128 a[160:163], v10 offset:49152
ds_read_b128 a[164:167], v11 offset:49152
M v[112:115], a[128:131], a[176:179], v[112:115]
s_add_u32 m0, s29, 32768
s_nop 0
buffer_load_dwordx4 v2, s[8:11], s23 offen offset:0 lds
M v[112:115], a[132:135], a[180:183], v[112:115]
M v[116:119], a[140:143], a[180:183], v[116:119]
M v[116:119], a[136:139], a[176:179], v[116:119]
ds_read_b64_tr_b16 a[36:37], v12 offset:16384
ds_read_b64_tr_b16 a[38:39], v12 offset:18432
M v[120:123], a[144:147], a[176:179], v[120:123]
M v[120:123], a[148:151], a[180:183], v[120:123]
buffer_load_dwordx4 v3, s[8:11], s23 offen offset:1024 lds
M v[124:127], a[156:159], a[180:183], v[124:127]
M v[124:127], a[152:155], a[176:179], v[124:127]
M v[128:131], a[96:99], a[184:187], v[128:131]
M v[128:131], a[100:103], a[188:191], v[128:131]
ds_read_b128 a[168:171], v10 offset:51200
ds_read_b128 a[172:175], v11 offset:51200
ds_read_b64_tr_b16 a[44:45], v13 offset:16384
ds_read_b64_tr_b16 a[46:47], v13 offset:18432
M v[132:135], a[108:111], a[188:191], v[132:135]
M v[132:135], a[104:107], a[184:187], v[132:135]
M v[136:139], a[112:115], a[184:187], v[136:139]
buffer_load_dwordx4 v4, s[8:11], s23 offen offset:2048 lds
M v[136:139], a[116:119], a[188:191], v[136:139]
M v[140:143], a[124:127], a[188:191], v[140:143]
M v[140:143], a[120:123], a[184:187], v[140:143]
ds_read_b64_tr_b16 a[52:53], v14 offset:16384
ds_read_b64_tr_b16 a[54:55], v14 offset:18432
M v[144:147], a[128:131], a[184:187], v[144:147]
M v[144:147], a[132:135], a[188:191], v[144:147]
M v[148:151], a[140:143], a[188:191], v[148:151]
buffer_load_dwordx4 v5, s[8:11], s23 offen offset:3072 lds
M v[148:151], a[136:139], a[184:187], v[148:151]
M v[152:155], a[144:147], a[184:187], v[152:155]
M v[152:155], a[148:151], a[188:191], v[152:155]
ds_read_b64_tr_b16 a[60:61], v15 offset:16384
ds_read_b64_tr_b16 a[62:63], v15 offset:18432
M v[156:159], a[156:159], a[188:191], v[156:159]
M v[156:159], a[152:155], a[184:187], v[156:159]
s_waitcnt lgkmcnt(10)
M v[160:163], a[96:99], a[160:163], v[160:163]
M v[160:163], a[100:103], a[164:167], v[160:163]
ds_read_b128 a[176:179], v10 offset:53248
ds_read_b128 a[180:183], v11 offset:53248
M v[164:167], a[108:111], a[164:167], v[164:167]
s_add_u32 m0, s29, 65536
s_nop 0
buffer_load_dwordx4 v6, s[12:15], s24 offen offset:0 lds
M v[164:167], a[104:107], a[160:163], v[164:167]
ds_read_b64_tr_b16 a[68:69], v16 offset:16384
ds_read_b64_tr_b16 a[70:71], v16 offset:18432
M v[168:171], a[112:115], a[160:163], v[168:171]
M v[168:171], a[116:119], a[164:167], v[168:171]
M v[172:175], a[124:127], a[164:167], v[172:175]
M v[172:175], a[120:123], a[160:163], v[172:175]
M v[176:179], a[128:131], a[160:163], v[176:179]
buffer_load_dwordx4 v7, s[12:15], s24 offen offset:1024 lds
M v[176:179], a[132:135], a[164:167], v[176:179]
ds_read_b64_tr_b16 a[76:77], v17 offset:16384
ds_read_b64_tr_b16 a[78:79], v17 offset:18432
M v[180:183], a[140:143], a[164:167], v[180:183]
M v[180:183], a[136:139], a[160:163], v[180:183]
M v[184:187], a[144:147], a[160:163], v[184:187]
M v[184:187], a[148:151], a[164:167], v[184:187]
buffer_load_dwordx4 v8, s[12:15], s24 offen offset:2048 lds
M v[188:191], a[156:159], a[164:167], v[188:191]
M v[188:191], a[152:155], a[160:163], v[188:191]
s_waitcnt lgkmcnt(12)
ds_read_b64_tr_b16 a[84:85], v18 offset:16384
ds_read_b64_tr_b16 a[86:87], v18 offset:18432
M v[192:195], a[96:99], a[168:171], v[192:195]
M v[192:195], a[100:103], a[172:175], v[192:195]
ds_read_b128 a[184:187], v10 offset:55296
ds_read_b128 a[188:191], v11 offset:55296
M v[196:199], a[108:111], a[172:175], v[196:199]
M v[196:199], a[104:107], a[168:171], v[196:199]
M v[200:203], a[112:115], a[168:171], v[200:203]
buffer_load_dwordx4 v9, s[12:15], s24 offen offset:3072 lds
M v[200:203], a[116:119], a[172:175], v[200:203]
ds_read_b64_tr_b16 a[92:93], v19 offset:16384
ds_read_b64_tr_b16 a[94:95], v19 offset:18432
M v[204:207], a[124:127], a[172:175], v[204:207]
M v[204:207], a[120:123], a[168:171], v[204:207]
M v[208:211], a[128:131], a[168:171], v[208:211]
M v[208:211], a[132:135], a[172:175], v[208:211]
M v[212:215], a[140:143], a[172:175], v[212:215]
s_add_u32 s24, s24, 262144
M v[212:215], a[136:139], a[168:171], v[212:215]
M v[216:219], a[144:147], a[168:171], v[216:219]
M v[216:219], a[148:151], a[172:175], v[216:219]
M v[220:223], a[156:159], a[172:175], v[220:223]
M v[220:223], a[152:155], a[168:171], v[220:223]
s_waitcnt lgkmcnt(10)
M v[224:227], a[96:99], a[176:179], v[224:227]
buffer_load_dword v21, v20, s[60:63], s54 offen
s_add_u32 s54, s54, 1048576
M v[224:227], a[100:103], a[180:183], v[224:227]
M v[228:231], a[108:111], a[180:183], v[228:231]
M v[228:231], a[104:107], a[176:179], v[228:231]
M v[232:235], a[112:115], a[176:179], v[232:235]
M v[232:235], a[116:119], a[180:183], v[232:235]
M v[236:239], a[124:127], a[180:183], v[236:239]
M v[236:239], a[120:123], a[176:179], v[236:239]
s_waitcnt vmcnt(18) lgkmcnt(0)
s_barrier
ds_read_b128 a[160:163], v10 offset:0
ds_read_b128 a[164:167], v11 offset:0
M v[240:243], a[128:131], a[176:179], v[240:243]
s_add_u32 m0, s29, 49152
s_add_u32 s3, s23, s31
buffer_load_dwordx4 v2, s[8:11], s3 offen offset:0 lds
M v[240:243], a[132:135], a[180:183], v[240:243]
M v[244:247], a[140:143], a[180:183], v[244:247]
M v[244:247], a[136:139], a[176:179], v[244:247]
M v[248:251], a[144:147], a[176:179], v[248:251]
M v[248:251], a[148:151], a[180:183], v[248:251]
buffer_load_dwordx4 v3, s[8:11], s3 offen offset:1024 lds
M v[252:255], a[156:159], a[180:183], v[252:255]
M v[252:255], a[152:155], a[176:179], v[252:255]
M a[0:3], a[96:99], a[184:187], a[0:3]
M a[0:3], a[100:103], a[188:191], a[0:3]
ds_read_b128 a[168:171], v10 offset:2048
ds_read_b128 a[172:175], v11 offset:2048
M a[4:7], a[108:111], a[188:191], a[4:7]
M a[4:7], a[104:107], a[184:187], a[4:7]
M a[8:11], a[112:115], a[184:187], a[8:11]
buffer_load_dwordx4 v4, s[8:11], s3 offen offset:2048 lds
M a[8:11], a[116:119], a[188:191], a[8:11]
M a[12:15], a[124:127], a[188:191], a[12:15]
M a[12:15], a[120:123], a[184:187], a[12:15]
M a[16:19], a[128:131], a[184:187], a[16:19]
M a[16:19], a[132:135], a[188:191], a[16:19]
buffer_load_dwordx4 v5, s[8:11], s3 offen offset:3072 lds
M a[20:23], a[140:143], a[188:191], a[20:23]
M a[20:23], a[136:139], a[184:187], a[20:23]
M a[24:27], a[144:147], a[184:187], a[24:27]
M a[24:27], a[148:151], a[188:191], a[24:27]
M a[28:31], a[156:159], a[188:191], a[28:31]
M a[28:31], a[152:155], a[184:187], a[28:31]
s_waitcnt lgkmcnt(2)
s_sub_u32 s30, s30, 1
s_cmp_lg_u32 s30, 0
s_cbranch_scc1 Lk1_ql
M v[32:35], a[32:35], a[160:163], v[32:35]
s_add_u32 s23, s23, 128
s_cmp_eq_u32 s23, s25
s_cselect_b32 s23, s26, s23
M v[32:35], a[36:39], a[164:167], v[32:35]
ds_read_b128 a[176:179], v10 offset:4096
ds_read_b128 a[180:183], v11 offset:4096
M v[36:39], a[44:47], a[164:167], v[36:39]
M v[36:39], a[40:43], a[160:163], v[36:39]
ds_read_b64_tr_b16 a[96:97], v12 offset:32768
ds_read_b64_tr_b16 a[98:99], v12 offset:34816
M v[40:43], a[48:51], a[160:163], v[40:43]
M v[40:43], a[52:55], a[164:167], v[40:43]
M v[44:47], a[60:63], a[164:167], v[44:47]
s_add_u32 m0, s29, 81920
s_nop 0
buffer_load_dwordx4 v6, s[12:15], s24 offen offset:0 lds
M v[44:47], a[56:59], a[160:163], v[44:47]
ds_read_b64_tr_b16 a[104:105], v13 offset:32768
ds_read_b64_tr_b16 a[106:107], v13 offset:34816
M v[48:51], a[64:67], a[160:163], v[48:51]
M v[48:51], a[68:71], a[164:167], v[48:51]
M v[52:55], a[76:79], a[164:167], v[52:55]
M v[52:55], a[72:75], a[160:163], v[52:55]
ds_read_b64_tr_b16 a[112:113], v14 offset:32768
ds_read_b64_tr_b16 a[114:115], v14 offset:34816
M v[56:59], a[80:83], a[160:163], v[56:59]
M v[56:59], a[84:87], a[164:167], v[56:59]
buffer_load_dwordx4 v7, s[12:15], s24 offen offset:1024 lds
M v[60:63], a[92:95], a[164:167], v[60:63]
M v[60:63], a[88:91], a[160:163], v[60:63]
s_waitcnt lgkmcnt(8)
ds_read_b64_tr_b16 a[120:121], v15 offset:32768
ds_read_b64_tr_b16 a[122:123], v15 offset:34816
M v[64:67], a[32:35], a[168:171], v[64:67]
M v[64:67], a[36:39], a[172:175], v[64:67]
ds_read_b128 a[184:187], v10 offset:6144
ds_read_b128 a[188:191], v11 offset:6144
M v[68:71], a[44:47], a[172:175], v[68:71]
M v[68:71], a[40:43], a[168:171], v[68:71]
ds_read_b64_tr_b16 a[128:129], v16 offset:32768
ds_read_b64_tr_b16 a[130:131], v16 offset:34816
M v[72:75], a[48:51], a[168:171], v[72:75]
buffer_load_dwordx4 v8, s[12:15], s24 offen offset:2048 lds
M v[72:75], a[52:55], a[172:175], v[72:75]
M v[76:79], a[60:63], a[172:175], v[76:79]
M v[76:79], a[56:59], a[168:171], v[76:79]
ds_read_b64_tr_b16 a[136:137], v17 offset:32768
ds_read_b64_tr_b16 a[138:139], v17 offset:34816
M v[80:83], a[64:67], a[168:171], v[80:83]
M v[80:83], a[68:71], a[172:175], v[80:83]
M v[84:87], a[76:79], a[172:175], v[84:87]
buffer_load_dwordx4 v9, s[12:15], s24 offen offset:3072 lds
M v[84:87], a[72:75], a[168:171], v[84:87]
ds_read_b64_tr_b16 a[144:145], v18 offset:32768
ds_read_b64_tr_b16 a[146:147], v18 offset:34816
M v[88:91], a[80:83], a[168:171], v[88:91]
M v[88:91], a[84:87], a[172:175], v[88:91]
M v[92:95], a[92:95], a[172:175], v[92:95]
M v[92:95], a[88:91], a[168:171], v[92:95]
s_waitcnt lgkmcnt(15)
ds_read_b64_tr_b16 a[152:153], v19 offset:32768
ds_read_b64_tr_b16 a[154:155], v19 offset:34816
M v[96:99], a[32:35], a[176:179], v[96:99]
s_add_u32 s24, s24, 262144
s_cmp_eq_u32 s24, s27
s_cselect_b32 s24, s28, s24
s_sub_u32 s6, s6, 1
s_cmp_eq_u32 s6, 0
s_cselect_b64 s[12:13], s[64:65], s[12:13]
M v[96:99], a[36:39], a[180:183], v[96:99]
M v[100:103], a[44:47], a[180:183], v[100:103]
M v[100:103], a[40:43], a[176:179], v[100:103]
M v[104:107], a[48:51], a[176:179], v[104:107]
M v[104:107], a[52:55], a[180:183], v[104:107]
M v[108:111], a[60:63], a[180:183], v[108:111]
M v[108:111], a[56:59], a[176:179], v[108:111]
s_waitcnt vmcnt(17) lgkmcnt(0)
s_barrier
ds_read_b128 a[160:163], v10 offset:16384
ds_read_b128 a[164:167], v11 offset:16384
M v[112:115], a[64:67], a[176:179], v[112:115]
s_add_u32 m0, s29, 0
s_nop 0
buffer_load_dwordx4 v2, s[8:11], s23 offen offset:0 lds
M v[112:115], a[68:71], a[180:183], v[112:115]
M v[116:119], a[76:79], a[180:183], v[116:119]
M v[116:119], a[72:75], a[176:179], v[116:119]
ds_read_b64_tr_b16 a[100:101], v12 offset:49152
ds_read_b64_tr_b16 a[102:103], v12 offset:51200
M v[120:123], a[80:83], a[176:179], v[120:123]
M v[120:123], a[84:87], a[180:183], v[120:123]
M v[124:127], a[92:95], a[180:183], v[124:127]
buffer_load_dwordx4 v3, s[8:11], s23 offen offset:1024 lds
M v[124:127], a[88:91], a[176:179], v[124:127]
M v[128:131], a[32:35], a[184:187], v[128:131]
M v[128:131], a[36:39], a[188:191], v[128:131]
ds_read_b128 a[168:171], v10 offset:18432
ds_read_b128 a[172:175], v11 offset:18432
ds_read_b64_tr_b16 a[108:109], v13 offset:49152
ds_read_b64_tr_b16 a[110:111], v13 offset:51200
M v[132:135], a[44:47], a[188:191], v[132:135]
M v[132:135], a[40:43], a[184:187], v[132:135]
M v[136:139], a[48:51], a[184:187], v[136:139]
M v[136:139], a[52:55], a[188:191], v[136:139]
buffer_load_dwordx4 v4, s[8:11], s23 offen offset:2048 lds
M v[140:143], a[60:63], a[188:191], v[140:143]
M v[140:143], a[56:59], a[184:187], v[140:143]
ds_read_b64_tr_b16 a[116:117], v14 offset:49152
ds_read_b64_tr_b16 a[118:119], v14 offset:51200
M v[144:147], a[64:67], a[184:187], v[144:147]
M v[144:147], a[68:71], a[188:191], v[144:147]
M v[148:151], a[76:79], a[188:191], v[148:151]
M v[148:151], a[72:75], a[184:187], v[148:151]
M v[152:155], a[80:83], a[184:187], v[152:155]
buffer_load_dwordx4 v5, s[8:11], s23 offen offset:3072 lds
M v[152:155], a[84:87], a[188:191], v[152:155]
ds_read_b64_tr_b16 a[124:125], v15 offset:49152
ds_read_b64_tr_b16 a[126:127], v15 offset:51200
M v[156:159], a[92:95], a[188:191], v[156:159]
M v[156:159], a[88:91], a[184:187], v[156:159]
s_waitcnt lgkmcnt(10)
M v[160:163], a[32:35], a[160:163], v[160:163]
M v[160:163], a[36:39], a[164:167], v[160:163]
ds_read_b128 a[176:179], v10 offset:20480
ds_read_b128 a[180:183], v11 offset:20480
M v[164:167], a[44:47], a[164:167], v[164:167]
M v[164:167], a[40:43], a[160:163], v[164:167]
ds_read_b64_tr_b16 a[132:133], v16 offset:49152
ds_read_b64_tr_b16 a[134:135], v16 offset:51200
M v[168:171], a[48:51], a[160:163], v[168:171]
M v[168:171], a[52:55], a[164:167], v[168:171]
s_add_u32 m0, s29, 98304
s_nop 0
buffer_load_dwordx4 v6, s[12:15], s24 offen offset:0 lds
M v[172:175], a[60:63], a[164:167], v[172:175]
M v[172:175], a[56:59], a[160:163], v[172:175]
M v[176:179], a[64:67], a[160:163], v[176:179]
M v[176:179], a[68:71], a[164:167], v[176:179]
ds_read_b64_tr_b16 a[140:141], v17 offset:49152
ds_read_b64_tr_b16 a[142:143], v17 offset:51200
M v[180:183], a[76:79], a[164:167], v[180:183]
M v[180:183], a[72:75], a[160:163], v[180:183]
buffer_load_dwordx4 v7, s[12:15], s24 offen offset:1024 lds
M v[184:187], a[80:83], a[160:163], v[184:187]
M v[184:187], a[84:87], a[164:167], v[184:187]
M v[188:191], a[92:95], a[164:167], v[188:191]
M v[188:191], a[88:91], a[160:163], v[188:191]
s_waitcnt lgkmcnt(12)
ds_read_b64_tr_b16 a[148:149], v18 offset:49152
ds_read_b64_tr_b16 a[150:151], v18 offset:51200
M v[192:195], a[32:35], a[168:171], v[192:195]
M v[192:195], a[36:39], a[172:175], v[192:195]
ds_read_b128 a[184:187], v10 offset:22528
ds_read_b128 a[188:191], v11 offset:22528
M v[196:199], a[44:47], a[172:175], v[196:199]
M v[196:199], a[40:43], a[168:171], v[196:199]
buffer_load_dwordx4 v8, s[12:15], s24 offen offset:2048 lds
M v[200:203], a[48:51], a[168:171], v[200:203]
M v[200:203], a[52:55], a[172:175], v[200:203]
ds_read_b64_tr_b16 a[156:157], v19 offset:49152
ds_read_b64_tr_b16 a[158:159], v19 offset:51200
M v[204:207], a[60:63], a[172:175], v[204:207]
M v[204:207], a[56:59], a[168:171], v[204:207]
M v[208:211], a[64:67], a[168:171], v[208:211]
M v[208:211], a[68:71], a[172:175], v[208:211]
buffer_load_dwordx4 v9, s[12:15], s24 offen offset:3072 lds
M v[212:215], a[76:79], a[172:175], v[212:215]
M v[212:215], a[72:75], a[168:171], v[212:215]
M v[216:219], a[80:83], a[168:171], v[216:219]
M v[216:219], a[84:87], a[172:175], v[216:219]
M v[220:223], a[92:95], a[172:175], v[220:223]
s_add_u32 s24, s24, 262144
M v[220:223], a[88:91], a[168:171], v[220:223]
s_waitcnt lgkmcnt(10)
M v[224:227], a[32:35], a[176:179], v[224:227]
M v[224:227], a[36:39], a[180:183], v[224:227]
M v[228:231], a[44:47], a[180:183], v[228:231]
M v[228:231], a[40:43], a[176:179], v[228:231]
M v[232:235], a[48:51], a[176:179], v[232:235]
M v[232:235], a[52:55], a[180:183], v[232:235]
M v[236:239], a[60:63], a[180:183], v[236:239]
M v[236:239], a[56:59], a[176:179], v[236:239]
s_waitcnt vmcnt(17) lgkmcnt(0)
s_barrier
ds_read_b128 a[160:163], v10 offset:32768
ds_read_b128 a[164:167], v11 offset:32768
M v[240:243], a[64:67], a[176:179], v[240:243]
s_add_u32 m0, s29, 16384
s_add_u32 s3, s23, s31
buffer_load_dwordx4 v2, s[8:11], s3 offen offset:0 lds
M v[240:243], a[68:71], a[180:183], v[240:243]
M v[244:247], a[76:79], a[180:183], v[244:247]
M v[244:247], a[72:75], a[176:179], v[244:247]
M v[248:251], a[80:83], a[176:179], v[248:251]
M v[248:251], a[84:87], a[180:183], v[248:251]
buffer_load_dwordx4 v3, s[8:11], s3 offen offset:1024 lds
M v[252:255], a[92:95], a[180:183], v[252:255]
M v[252:255], a[88:91], a[176:179], v[252:255]
M a[0:3], a[32:35], a[184:187], a[0:3]
M a[0:3], a[36:39], a[188:191], a[0:3]
ds_read_b128 a[168:171], v10 offset:34816
ds_read_b128 a[172:175], v11 offset:34816
M a[4:7], a[44:47], a[188:191], a[4:7]
M a[4:7], a[40:43], a[184:187], a[4:7]
M a[8:11], a[48:51], a[184:187], a[8:11]
buffer_load_dwordx4 v4, s[8:11], s3 offen offset:2048 lds
M a[8:11], a[52:55], a[188:191], a[8:11]
M a[12:15], a[60:63], a[188:191], a[12:15]
M a[12:15], a[56:59], a[184:187], a[12:15]
M a[16:19], a[64:67], a[184:187], a[16:19]
M a[16:19], a[68:71], a[188:191], a[16:19]
buffer_load_dwordx4 v5, s[8:11], s3 offen offset:3072 lds
M a[20:23], a[76:79], a[188:191], a[20:23]
M a[20:23], a[72:75], a[184:187], a[20:23]
M a[24:27], a[80:83], a[184:187], a[24:27]
M a[24:27], a[84:87], a[188:191], a[24:27]
M a[28:31], a[92:95], a[188:191], a[28:31]
M a[28:31], a[88:91], a[184:187], a[28:31]
s_waitcnt lgkmcnt(2)
M v[32:35], a[96:99], a[160:163], v[32:35]
s_add_u32 s23, s23, 128
s_cmp_eq_u32 s23, s25
s_cselect_b32 s23, s26, s23
M v[32:35], a[100:103], a[164:167], v[32:35]
ds_read_b128 a[176:179], v10 offset:36864
ds_read_b128 a[180:183], v11 offset:36864
M v[36:39], a[108:111], a[164:167], v[36:39]
M v[36:39], a[104:107], a[160:163], v[36:39]
ds_read_b64_tr_b16 a[32:33], v12 offset:0
ds_read_b64_tr_b16 a[34:35], v12 offset:2048
M v[40:43], a[112:115], a[160:163], v[40:43]
M v[40:43], a[116:119], a[164:167], v[40:43]
M v[44:47], a[124:127], a[164:167], v[44:47]
s_add_u32 m0, s29, 114688
s_nop 0
buffer_load_dwordx4 v6, s[12:15], s24 offen offset:0 lds
M v[44:47], a[120:123], a[160:163], v[44:47]
ds_read_b64_tr_b16 a[40:41], v13 offset:0
ds_read_b64_tr_b16 a[42:43], v13 offset:2048
M v[48:51], a[128:131], a[160:163], v[48:51]
M v[48:51], a[132:135], a[164:167], v[48:51]
M v[52:55], a[140:143], a[164:167], v[52:55]
M v[52:55], a[136:139], a[160:163], v[52:55]
ds_read_b64_tr_b16 a[48:49], v14 offset:0
ds_read_b64_tr_b16 a[50:51], v14 offset:2048
M v[56:59], a[144:147], a[160:163], v[56:59]
M v[56:59], a[148:151], a[164:167], v[56:59]
buffer_load_dwordx4 v7, s[12:15], s24 offen offset:1024 lds
M v[60:63], a[156:159], a[164:167], v[60:63]
M v[60:63], a[152:155], a[160:163], v[60:63]
s_waitcnt lgkmcnt(8)
ds_read_b64_tr_b16 a[56:57], v15 offset:0
ds_read_b64_tr_b16 a[58:59], v15 offset:2048
M v[64:67], a[96:99], a[168:171], v[64:67]
M v[64:67], a[100:103], a[172:175], v[64:67]
ds_read_b128 a[184:187], v10 offset:38912
ds_read_b128 a[188:191], v11 offset:38912
M v[68:71], a[108:111], a[172:175], v[68:71]
M v[68:71], a[104:107], a[168:171], v[68:71]
ds_read_b64_tr_b16 a[64:65], v16 offset:0
ds_read_b64_tr_b16 a[66:67], v16 offset:2048
M v[72:75], a[112:115], a[168:171], v[72:75]
buffer_load_dwordx4 v8, s[12:15], s24 offen offset:2048 lds
M v[72:75], a[116:119], a[172:175], v[72:75]
M v[76:79], a[124:127], a[172:175], v[76:79]
M v[76:79], a[120:123], a[168:171], v[76:79]
ds_read_b64_tr_b16 a[72:73], v17 offset:0
ds_read_b64_tr_b16 a[74:75], v17 offset:2048
M v[80:83], a[128:131], a[168:171], v[80:83]
M v[80:83], a[132:135], a[172:175], v[80:83]
M v[84:87], a[140:143], a[172:175], v[84:87]
buffer_load_dwordx4 v9, s[12:15], s24 offen offset:3072 lds
M v[84:87], a[136:139], a[168:171], v[84:87]
ds_read_b64_tr_b16 a[80:81], v18 offset:0
ds_read_b64_tr_b16 a[82:83], v18 offset:2048
M v[88:91], a[144:147], a[168:171], v[88:91]
M v[88:91], a[148:151], a[172:175], v[88:91]
M v[92:95], a[156:159], a[172:175], v[92:95]
M v[92:95], a[152:155], a[168:171], v[92:95]
s_waitcnt lgkmcnt(15)
ds_read_b64_tr_b16 a[88:89], v19 offset:0
ds_read_b64_tr_b16 a[90:91], v19 offset:2048
M v[96:99], a[96:99], a[176:179], v[96:99]
s_add_u32 s24, s24, 262144
s_cmp_eq_u32 s24, s27
s_cselect_b32 s24, s28, s24
s_sub_u32 s6, s6, 1
s_cmp_eq_u32 s6, 0
s_cselect_b64 s[12:13], s[64:65], s[12:13]
M v[96:99], a[100:103], a[180:183], v[96:99]
M v[100:103], a[108:111], a[180:183], v[100:103]
M v[100:103], a[104:107], a[176:179], v[100:103]
M v[104:107], a[112:115], a[176:179], v[104:107]
M v[104:107], a[116:119], a[180:183], v[104:107]
M v[108:111], a[124:127], a[180:183], v[108:111]
M v[108:111], a[120:123], a[176:179], v[108:111]
s_waitcnt vmcnt(16) lgkmcnt(0)
s_barrier
ds_read_b128 a[160:163], v10 offset:49152
ds_read_b128 a[164:167], v11 offset:49152
M v[112:115], a[128:131], a[176:179], v[112:115]
s_add_u32 m0, s29, 32768
s_nop 0
buffer_load_dwordx4 v2, s[8:11], s23 offen offset:0 lds
M v[112:115], a[132:135], a[180:183], v[112:115]
M v[116:119], a[140:143], a[180:183], v[116:119]
M v[116:119], a[136:139], a[176:179], v[116:119]
ds_read_b64_tr_b16 a[36:37], v12 offset:16384
ds_read_b64_tr_b16 a[38:39], v12 offset:18432
M v[120:123], a[144:147], a[176:179], v[120:123]
M v[120:123], a[148:151], a[180:183], v[120:123]
M v[124:127], a[156:159], a[180:183], v[124:127]
M v[124:127], a[152:155], a[176:179], v[124:127]
M v[128:131], a[96:99], a[184:187], v[128:131]
M v[128:131], a[100:103], a[188:191], v[128:131]
ds_read_b128 a[168:171], v10 offset:51200
ds_read_b128 a[172:175], v11 offset:51200
ds_read_b64_tr_b16 a[44:45], v13 offset:16384
ds_read_b64_tr_b16 a[46:47], v13 offset:18432
M v[132:135], a[108:111], a[188:191], v[132:135]
M v[132:135], a[104:107], a[184:187], v[132:135]
M v[136:139], a[112:115], a[184:187], v[136:139]
M v[136:139], a[116:119], a[188:191], v[136:139]
M v[140:143], a[124:127], a[188:191], v[140:143]
M v[140:143], a[120:123], a[184:187], v[140:143]
ds_read_b64_tr_b16 a[52:53], v14 offset:16384
ds_read_b64_tr_b16 a[54:55], v14 offset:18432
M v[144:147], a[128:131], a[184:187], v[144:147]
buffer_load_dwordx4 v3, s[8:11], s23 offen offset:1024 lds
M v[144:147], a[132:135], a[188:191], v[144:147]
M v[148:151], a[140:143], a[188:191], v[148:151]
M v[148:151], a[136:139], a[184:187], v[148:151]
M v[152:155], a[144:147], a[184:187], v[152:155]
M v[152:155], a[148:151], a[188:191], v[152:155]
ds_read_b64_tr_b16 a[60:61], v15 offset:16384
ds_read_b64_tr_b16 a[62:63], v15 offset:18432
M v[156:159], a[156:159], a[188:191], v[156:159]
M v[156:159], a[152:155], a[184:187], v[156:159]
s_waitcnt lgkmcnt(10)
M v[160:163], a[96:99], a[160:163], v[160:163]
M v[160:163], a[100:103], a[164:167], v[160:163]
ds_read_b128 a[176:179], v10 offset:53248
ds_read_b128 a[180:183], v11 offset:53248
M v[164:167], a[108:111], a[164:167], v[164:167]
M v[164:167], a[104:107], a[160:163], v[164:167]
ds_read_b64_tr_b16 a[68:69], v16 offset:16384
ds_read_b64_tr_b16 a[70:71], v16 offset:18432
M v[168:171], a[112:115], a[160:163], v[168:171]
M v[168:171], a[116:119], a[164:167], v[168:171]
M v[172:175], a[124:127], a[164:167], v[172:175]
M v[172:175], a[120:123], a[160:163], v[172:175]
M v[176:179], a[128:131], a[160:163], v[176:179]
buffer_load_dwordx4 v4, s[8:11], s23 offen offset:2048 lds
M v[176:179], a[132:135], a[164:167], v[176:179]
ds_read_b64_tr_b16 a[76:77], v17 offset:16384
ds_read_b64_tr_b16 a[78:79], v17 offset:18432
M v[180:183], a[140:143], a[164:167], v[180:183]
M v[180:183], a[136:139], a[160:163], v[180:183]
M v[184:187], a[144:147], a[160:163], v[184:187]
M v[184:187], a[148:151], a[164:167], v[184:187]
M v[188:191], a[156:159], a[164:167], v[188:191]
M v[188:191], a[152:155], a[160:163], v[188:191]
s_waitcnt lgkmcnt(12)
ds_read_b64_tr_b16 a[84:85], v18 offset:16384
ds_read_b64_tr_b16 a[86:87], v18 offset:18432
M v[192:195], a[96:99], a[168:171], v[192:195]
M v[192:195], a[100:103], a[172:175], v[192:195]
ds_read_b128 a[184:187], v10 offset:55296
ds_read_b128 a[188:191], v11 offset:55296
M v[196:199], a[108:111], a[172:175], v[196:199]
M v[196:199], a[104:107], a[168:171], v[196:199]
M v[200:203], a[112:115], a[168:171], v[200:203]
M v[200:203], a[116:119], a[172:175], v[200:203]
ds_read_b64_tr_b16 a[92:93], v19 offset:16384
ds_read_b64_tr_b16 a[94:95], v19 offset:18432
M v[204:207], a[124:127], a[172:175], v[204:207]
M v[204:207], a[120:123], a[168:171], v[204:207]
M v[208:211], a[128:131], a[168:171], v[208:211]
buffer_load_dwordx4 v5, s[8:11], s23 offen offset:3072 lds
M v[208:211], a[132:135], a[172:175], v[208:211]
M v[212:215], a[140:143], a[172:175], v[212:215]
M v[212:215], a[136:139], a[168:171], v[212:215]
M v[216:219], a[144:147], a[168:171], v[216:219]
M v[216:219], a[148:151], a[172:175], v[216:219]
M v[220:223], a[156:159], a[172:175], v[220:223]
M v[220:223], a[152:155], a[168:171], v[220:223]
s_waitcnt lgkmcnt(10)
M v[224:227], a[96:99], a[176:179], v[224:227]
M v[224:227], a[100:103], a[180:183], v[224:227]
M v[228:231], a[108:111], a[180:183], v[228:231]
M v[228:231], a[104:107], a[176:179], v[228:231]
M v[232:235], a[112:115], a[176:179], v[232:235]
M v[232:235], a[116:119], a[180:183], v[232:235]
M v[236:239], a[124:127], a[180:183], v[236:239]
M v[236:239], a[120:123], a[176:179], v[236:239]
s_waitcnt vmcnt(12) lgkmcnt(0)
s_barrier
ds_read_b128 a[160:163], v10 offset:0
ds_read_b128 a[164:167], v11 offset:0
M v[240:243], a[128:131], a[176:179], v[240:243]
s_add_u32 m0, s29, 49152
s_add_u32 s3, s23, s31
buffer_load_dwordx4 v2, s[8:11], s3 offen offset:0 lds
M v[240:243], a[132:135], a[180:183], v[240:243]
M v[244:247], a[140:143], a[180:183], v[244:247]
M v[244:247], a[136:139], a[176:179], v[244:247]
M v[248:251], a[144:147], a[176:179], v[248:251]
M v[248:251], a[148:151], a[180:183], v[248:251]
M v[252:255], a[156:159], a[180:183], v[252:255]
M v[252:255], a[152:155], a[176:179], v[252:255]
M a[0:3], a[96:99], a[184:187], a[0:3]
M a[0:3], a[100:103], a[188:191], a[0:3]
ds_read_b128 a[168:171], v10 offset:2048
ds_read_b128 a[172:175], v11 offset:2048
M a[4:7], a[108:111], a[188:191], a[4:7]
M a[4:7], a[104:107], a[184:187], a[4:7]
M a[8:11], a[112:115], a[184:187], a[8:11]
buffer_load_dwordx4 v3, s[8:11], s3 offen offset:1024 lds
M a[8:11], a[116:119], a[188:191], a[8:11]
M a[12:15], a[124:127], a[188:191], a[12:15]
M a[12:15], a[120:123], a[184:187], a[12:15]
M a[16:19], a[128:131], a[184:187], a[16:19]
M a[16:19], a[132:135], a[188:191], a[16:19]
M a[20:23], a[140:143], a[188:191], a[20:23]
M a[20:23], a[136:139], a[184:187], a[20:23]
M a[24:27], a[144:147], a[184:187], a[24:27]
M a[24:27], a[148:151], a[188:191], a[24:27]
M a[28:31], a[156:159], a[188:191], a[28:31]
M a[28:31], a[152:155], a[184:187], a[28:31]
s_waitcnt lgkmcnt(2)
M v[32:35], a[32:35], a[160:163], v[32:35]
buffer_load_dwordx4 v4, s[8:11], s3 offen offset:2048 lds
M v[32:35], a[36:39], a[164:167], v[32:35]
ds_read_b128 a[176:179], v10 offset:4096
ds_read_b128 a[180:183], v11 offset:4096
M v[36:39], a[44:47], a[164:167], v[36:39]
M v[36:39], a[40:43], a[160:163], v[36:39]
ds_read_b64_tr_b16 a[96:97], v12 offset:32768
ds_read_b64_tr_b16 a[98:99], v12 offset:34816
M v[40:43], a[48:51], a[160:163], v[40:43]
M v[40:43], a[52:55], a[164:167], v[40:43]
M v[44:47], a[60:63], a[164:167], v[44:47]
M v[44:47], a[56:59], a[160:163], v[44:47]
ds_read_b64_tr_b16 a[104:105], v13 offset:32768
ds_read_b64_tr_b16 a[106:107], v13 offset:34816
M v[48:51], a[64:67], a[160:163], v[48:51]
M v[48:51], a[68:71], a[164:167], v[48:51]
M v[52:55], a[76:79], a[164:167], v[52:55]
M v[52:55], a[72:75], a[160:163], v[52:55]
ds_read_b64_tr_b16 a[112:113], v14 offset:32768
ds_read_b64_tr_b16 a[114:115], v14 offset:34816
M v[56:59], a[80:83], a[160:163], v[56:59]
M v[56:59], a[84:87], a[164:167], v[56:59]
buffer_load_dwordx4 v5, s[8:11], s3 offen offset:3072 lds
M v[60:63], a[92:95], a[164:167], v[60:63]
M v[60:63], a[88:91], a[160:163], v[60:63]
s_waitcnt lgkmcnt(8)
ds_read_b64_tr_b16 a[120:121], v15 offset:32768
ds_read_b64_tr_b16 a[122:123], v15 offset:34816
M v[64:67], a[32:35], a[168:171], v[64:67]
M v[64:67], a[36:39], a[172:175], v[64:67]
ds_read_b128 a[184:187], v10 offset:6144
ds_read_b128 a[188:191], v11 offset:6144
M v[68:71], a[44:47], a[172:175], v[68:71]
M v[68:71], a[40:43], a[168:171], v[68:71]
ds_read_b64_tr_b16 a[128:129], v16 offset:32768
ds_read_b64_tr_b16 a[130:131], v16 offset:34816
M v[72:75], a[48:51], a[168:171], v[72:75]
M v[72:75], a[52:55], a[172:175], v[72:75]
M v[76:79], a[60:63], a[172:175], v[76:79]
M v[76:79], a[56:59], a[168:171], v[76:79]
ds_read_b64_tr_b16 a[136:137], v17 offset:32768
ds_read_b64_tr_b16 a[138:139], v17 offset:34816
M v[80:83], a[64:67], a[168:171], v[80:83]
M v[80:83], a[68:71], a[172:175], v[80:83]
M v[84:87], a[76:79], a[172:175], v[84:87]
s_add_u32 s23, s23, 128
s_cmp_eq_u32 s23, s25
s_cselect_b32 s23, s26, s23
M v[84:87], a[72:75], a[168:171], v[84:87]
ds_read_b64_tr_b16 a[144:145], v18 offset:32768
ds_read_b64_tr_b16 a[146:147], v18 offset:34816
M v[88:91], a[80:83], a[168:171], v[88:91]
M v[88:91], a[84:87], a[172:175], v[88:91]
M v[92:95], a[92:95], a[172:175], v[92:95]
M v[92:95], a[88:91], a[168:171], v[92:95]
s_waitcnt lgkmcnt(15)
ds_read_b64_tr_b16 a[152:153], v19 offset:32768
ds_read_b64_tr_b16 a[154:155], v19 offset:34816
M v[96:99], a[32:35], a[176:179], v[96:99]
M v[96:99], a[36:39], a[180:183], v[96:99]
M v[100:103], a[44:47], a[180:183], v[100:103]
M v[100:103], a[40:43], a[176:179], v[100:103]
M v[104:107], a[48:51], a[176:179], v[104:107]
M v[104:107], a[52:55], a[180:183], v[104:107]
M v[108:111], a[60:63], a[180:183], v[108:111]
M v[108:111], a[56:59], a[176:179], v[108:111]
s_waitcnt vmcnt(8) lgkmcnt(0)
s_barrier
ds_read_b128 a[160:163], v10 offset:16384
ds_read_b128 a[164:167], v11 offset:16384
M v[112:115], a[64:67], a[176:179], v[112:115]
M v[112:115], a[68:71], a[180:183], v[112:115]
s_and_b32 s3, s2, 1
s_lshl_b32 s3, s3, 3
s_bfe_u32 s4, s2, 0x30003
M v[116:119], a[76:79], a[180:183], v[116:119]
s_add_u32 s26, s3, s4
s_bfe_u32 s3, s2, 0x20001
s_lshl_b32 s3, s3, 2
M v[116:119], a[72:75], a[176:179], v[116:119]
ds_read_b64_tr_b16 a[100:101], v12 offset:49152
ds_read_b64_tr_b16 a[102:103], v12 offset:51200
s_lshr_b32 s4, s2, 6
s_xor_b32 s4, s4, 2
s_add_u32 s27, s3, s4
M v[120:123], a[80:83], a[176:179], v[120:123]
s_lshl_b32 s23, s26, 18
s_sub_u32 s24, s23, 32768
M v[120:123], a[84:87], a[180:183], v[120:123]
s_max_i32 s24, s24, 0
s_lshl_b32 s25, s27, 7
s_xor_b32 s3, s26, s27
M v[124:127], a[92:95], a[180:183], v[124:127]
s_and_b32 s3, s3, 0
s_lshl_b32 s3, s3, 3
s_sub_u32 s31, 16, s3
M v[124:127], a[88:91], a[176:179], v[124:127]
s_mov_b32 s54, s31
s_movk_i32 s57, 128
s_mov_b32 s55, 4289069056
M v[128:131], a[32:35], a[184:187], v[128:131]
s_mov_b32 s56, 393216
s_lshl_b32 s4, s3, 7
M v[128:131], a[36:39], a[188:191], v[128:131]
ds_read_b128 a[168:171], v10 offset:18432
ds_read_b128 a[172:175], v11 offset:18432
ds_read_b64_tr_b16 a[108:109], v13 offset:49152
ds_read_b64_tr_b16 a[110:111], v13 offset:51200
s_add_u32 s23, s23, s4
s_add_u32 s24, s24, s4
s_mul_i32 s4, s3, 393216
M v[132:135], a[44:47], a[188:191], v[132:135]
s_add_u32 s25, s25, s4
s_mov_b64 s[8:9], s[44:45]
s_mov_b32 s10, 4194304
M v[132:135], a[40:43], a[184:187], v[132:135]
s_mov_b64 s[12:13], s[46:47]
s_mov_b32 s14, 6291456
M v[136:139], a[48:51], a[184:187], v[136:139]
s_mov_b64 s[36:37], s[90:91]
s_mov_b32 s38, 256
s_mov_b32 s39, 0x00020000
M v[136:139], a[52:55], a[188:191], v[136:139]
s_lshl_b32 s28, s20, 9
s_mul_i32 s30, s20, 6144
s_lshl_b32 s3, s20, 5
M v[140:143], a[60:63], a[188:191], v[140:143]
v_lshrrev_b32 v24, 3, v0
v_and_b32 v25, 7, v0
v_add_u32 v28, s3, v24
M v[140:143], a[56:59], a[184:187], v[140:143]
ds_read_b64_tr_b16 a[116:117], v14 offset:49152
ds_read_b64_tr_b16 a[118:119], v14 offset:51200
v_add_u32 v26, 0, v28
v_bfe_u32 v27, v26, 1, 3
M v[144:147], a[64:67], a[184:187], v[144:147]
v_xor_b32 v27, v27, v25
v_lshlrev_b32 v26, 11, v26
v_lshl_add_u32 v26, v27, 4, v26
M v[144:147], a[68:71], a[188:191], v[144:147]
v_subrev_u32 v2, 0, v26
v_add_u32 v26, 8, v28
v_bfe_u32 v27, v26, 1, 3
M v[148:151], a[76:79], a[188:191], v[148:151]
v_xor_b32 v27, v27, v25
v_lshlrev_b32 v26, 11, v26
v_lshl_add_u32 v26, v27, 4, v26
M v[148:151], a[72:75], a[184:187], v[148:151]
v_subrev_u32 v3, 1024, v26
v_add_u32 v26, 16, v28
M v[152:155], a[80:83], a[184:187], v[152:155]
v_bfe_u32 v27, v26, 1, 3
v_xor_b32 v27, v27, v25
v_lshlrev_b32 v26, 11, v26
M v[152:155], a[84:87], a[188:191], v[152:155]
ds_read_b64_tr_b16 a[124:125], v15 offset:49152
ds_read_b64_tr_b16 a[126:127], v15 offset:51200
v_lshl_add_u32 v26, v27, 4, v26
v_subrev_u32 v4, 2048, v26
v_add_u32 v26, 24, v28
M v[156:159], a[92:95], a[188:191], v[156:159]
v_bfe_u32 v27, v26, 1, 3
v_xor_b32 v27, v27, v25
M v[156:159], a[88:91], a[184:187], v[156:159]
s_waitcnt lgkmcnt(10)
v_lshlrev_b32 v26, 11, v26
v_lshl_add_u32 v26, v27, 4, v26
v_subrev_u32 v5, 3072, v26
M v[160:163], a[32:35], a[160:163], v[160:163]
s_lshl_b32 s3, s20, 2
v_lshrrev_b32 v26, 5, v0
v_add_u32 v26, s3, v26
M v[160:163], a[36:39], a[164:167], v[160:163]
ds_read_b128 a[176:179], v10 offset:20480
ds_read_b128 a[180:183], v11 offset:20480
v_bfe_u32 v29, v0, 2, 3
v_bfe_u32 v27, v26, 1, 3
v_xor_b32 v27, v27, v29
M v[164:167], a[44:47], a[164:167], v[164:167]
v_lshlrev_b32 v27, 4, v27
v_and_b32 v30, 3, v0
M v[164:167], a[40:43], a[160:163], v[164:167]
ds_read_b64_tr_b16 a[132:133], v16 offset:49152
ds_read_b64_tr_b16 a[134:135], v16 offset:51200
v_lshl_add_u32 v27, v30, 2, v27
v_lshl_add_u32 v20, v26, 11, v27
v_add_u32 v26, 2, v26
M v[168:171], a[48:51], a[160:163], v[168:171]
v_bfe_u32 v27, v26, 1, 3
v_xor_b32 v27, v27, v29
v_lshlrev_b32 v27, 4, v27
M v[168:171], a[52:55], a[164:167], v[168:171]
v_and_b32 v30, 3, v0
v_lshl_add_u32 v27, v30, 2, v27
M v[172:175], a[60:63], a[164:167], v[172:175]
v_lshl_add_u32 v23, v26, 11, v27
v_subrev_u32 v23, 256, v23
s_mul_i32 s3, s20, 48
M v[172:175], a[56:59], a[160:163], v[172:175]
v_add_u32 v28, s3, v24
v_add_u32 v26, 0, v28
v_mul_u32_u24 v27, 0xaaab, v26
M v[176:179], a[64:67], a[160:163], v[176:179]
v_lshrrev_b32 v27, 17, v27
v_lshrrev_b32 v29, 1, v27
v_and_b32 v29, 4, v29
M v[176:179], a[68:71], a[164:167], v[176:179]
ds_read_b64_tr_b16 a[140:141], v17 offset:49152
ds_read_b64_tr_b16 a[142:143], v17 offset:51200
v_and_or_b32 v27, v27, 2, v29
v_xor_b32 v27, v27, v25
M v[180:183], a[76:79], a[164:167], v[180:183]
v_lshlrev_b32 v26, 11, v26
v_lshl_add_u32 v26, v27, 4, v26
v_subrev_u32 v6, 0, v26
M v[180:183], a[72:75], a[160:163], v[180:183]
v_add_u32 v26, 8, v28
v_mul_u32_u24 v27, 0xaaab, v26
v_lshrrev_b32 v27, 17, v27
M v[184:187], a[80:83], a[160:163], v[184:187]
v_lshrrev_b32 v29, 1, v27
v_and_b32 v29, 4, v29
v_and_or_b32 v27, v27, 2, v29
M v[184:187], a[84:87], a[164:167], v[184:187]
v_xor_b32 v27, v27, v25
v_lshlrev_b32 v26, 11, v26
M v[188:191], a[92:95], a[164:167], v[188:191]
v_lshl_add_u32 v26, v27, 4, v26
v_subrev_u32 v7, 1024, v26
v_add_u32 v26, 16, v28
M v[188:191], a[88:91], a[160:163], v[188:191]
s_waitcnt lgkmcnt(12)
ds_read_b64_tr_b16 a[148:149], v18 offset:49152
ds_read_b64_tr_b16 a[150:151], v18 offset:51200
v_mul_u32_u24 v27, 0xaaab, v26
v_lshrrev_b32 v27, 17, v27
v_lshrrev_b32 v29, 1, v27
M v[192:195], a[32:35], a[168:171], v[192:195]
v_and_b32 v29, 4, v29
v_and_or_b32 v27, v27, 2, v29
M v[192:195], a[36:39], a[172:175], v[192:195]
ds_read_b128 a[184:187], v10 offset:22528
ds_read_b128 a[188:191], v11 offset:22528
v_xor_b32 v27, v27, v25
v_lshlrev_b32 v26, 11, v26
v_lshl_add_u32 v26, v27, 4, v26
M v[196:199], a[44:47], a[172:175], v[196:199]
v_subrev_u32 v8, 2048, v26
v_add_u32 v26, 24, v28
v_mul_u32_u24 v27, 0xaaab, v26
M v[196:199], a[40:43], a[168:171], v[196:199]
v_lshrrev_b32 v27, 17, v27
v_lshrrev_b32 v29, 1, v27
v_and_b32 v29, 4, v29
M v[200:203], a[48:51], a[168:171], v[200:203]
v_and_or_b32 v27, v27, 2, v29
v_xor_b32 v27, v27, v25
M v[200:203], a[52:55], a[172:175], v[200:203]
ds_read_b64_tr_b16 a[156:157], v19 offset:49152
ds_read_b64_tr_b16 a[158:159], v19 offset:51200
v_lshlrev_b32 v26, 11, v26
v_lshl_add_u32 v26, v27, 4, v26
v_subrev_u32 v9, 3072, v26
M v[204:207], a[60:63], a[172:175], v[204:207]
v_add_u32 v26, 32, v28
v_mul_u32_u24 v27, 0xaaab, v26
v_lshrrev_b32 v27, 17, v27
M v[204:207], a[56:59], a[168:171], v[204:207]
v_lshrrev_b32 v29, 1, v27
v_and_b32 v29, 4, v29
v_and_or_b32 v27, v27, 2, v29
M v[208:211], a[64:67], a[168:171], v[208:211]
v_xor_b32 v27, v27, v25
v_lshlrev_b32 v26, 11, v26
M v[208:211], a[68:71], a[172:175], v[208:211]
v_lshl_add_u32 v26, v27, 4, v26
v_subrev_u32 v21, 0, v26
v_add_u32 v26, 40, v28
M v[212:215], a[76:79], a[172:175], v[212:215]
v_mul_u32_u24 v27, 0xaaab, v26
v_lshrrev_b32 v27, 17, v27
v_lshrrev_b32 v29, 1, v27
M v[212:215], a[72:75], a[168:171], v[212:215]
v_and_b32 v29, 4, v29
v_and_or_b32 v27, v27, 2, v29
M v[216:219], a[80:83], a[168:171], v[216:219]
v_xor_b32 v27, v27, v25
v_lshlrev_b32 v26, 11, v26
v_lshl_add_u32 v26, v27, 4, v26
M v[216:219], a[84:87], a[172:175], v[216:219]
v_subrev_u32 v22, 1024, v26
s_lshr_b32 s3, s53, 7
s_add_u32 s3, s3, s22
M v[220:223], a[92:95], a[172:175], v[220:223]
s_lshl_b32 s3, s3, 5
s_lshr_b32 s19, s52, 6
s_add_u32 s3, s3, s19
M v[220:223], a[88:91], a[168:171], v[220:223]
s_waitcnt lgkmcnt(10)
s_lshl_b32 s19, s21, 1
s_add_u32 s3, s3, s19
M v[224:227], a[32:35], a[176:179], v[224:227]
s_lshl_b32 s92, s3, 14
s_add_u32 s93, s92, 16384
s_add_u32 s16, s50, 0
M v[224:227], a[36:39], a[180:183], v[224:227]
s_addc_u32 s17, s51, 0
s_mov_b32 s18, 16777216
s_mov_b32 s19, 0x00020000
M v[228:231], a[44:47], a[180:183], v[228:231]
s_mov_b32 s4, 0x3e0293ee
s_mov_b32 s5, 0x3e0293ee
M v[228:231], a[40:43], a[176:179], v[228:231]
M v[232:235], a[48:51], a[176:179], v[232:235]
M v[232:235], a[52:55], a[180:183], v[232:235]
M v[236:239], a[60:63], a[180:183], v[236:239]
M v[236:239], a[56:59], a[176:179], v[236:239]
s_waitcnt vmcnt(4) lgkmcnt(0)
s_barrier
ds_read_b128 a[160:163], v10 offset:32768
ds_read_b128 a[164:167], v11 offset:32768
M v[240:243], a[64:67], a[176:179], v[240:243]
s_add_u32 m0, s28, 131072
s_nop 0
buffer_load_dword v20, s[8:11], s24 offen lds
M v[240:243], a[68:71], a[180:183], v[240:243]
M v[244:247], a[76:79], a[180:183], v[244:247]
M v[244:247], a[72:75], a[176:179], v[244:247]
buffer_load_dword v23, s[8:11], s24 offen offset:256 lds
M v[248:251], a[80:83], a[176:179], v[248:251]
M v[248:251], a[84:87], a[180:183], v[248:251]
M v[252:255], a[92:95], a[180:183], v[252:255]
M v[252:255], a[88:91], a[176:179], v[252:255]
M a[0:3], a[32:35], a[184:187], a[0:3]
s_add_u32 m0, s29, 133120
s_nop 0
buffer_load_dwordx4 v2, s[8:11], s23 offen offset:0 lds
M a[0:3], a[36:39], a[188:191], a[0:3]
ds_read_b128 a[168:171], v10 offset:34816
ds_read_b128 a[172:175], v11 offset:34816
M a[4:7], a[44:47], a[188:191], a[4:7]
M a[4:7], a[40:43], a[184:187], a[4:7]
M a[8:11], a[48:51], a[184:187], a[8:11]
buffer_load_dwordx4 v3, s[8:11], s23 offen offset:1024 lds
M a[8:11], a[52:55], a[188:191], a[8:11]
M a[12:15], a[60:63], a[188:191], a[12:15]
M a[12:15], a[56:59], a[184:187], a[12:15]
M a[16:19], a[64:67], a[184:187], a[16:19]
buffer_load_dwordx4 v4, s[8:11], s23 offen offset:2048 lds
M a[16:19], a[68:71], a[188:191], a[16:19]
M a[20:23], a[76:79], a[188:191], a[20:23]
M a[20:23], a[72:75], a[184:187], a[20:23]
buffer_load_dwordx4 v5, s[8:11], s23 offen offset:3072 lds
M a[24:27], a[80:83], a[184:187], a[24:27]
M a[24:27], a[84:87], a[188:191], a[24:27]
M a[28:31], a[92:95], a[188:191], a[28:31]
M a[28:31], a[88:91], a[184:187], a[28:31]
s_waitcnt lgkmcnt(2)
M v[32:35], a[96:99], a[160:163], v[32:35]
s_sub_u32 s31, s31, 1
s_cmp_eq_u32 s31, 0
s_cselect_b32 s58, -1920, s57
s_add_u32 s23, s23, s58
s_add_u32 s24, s24, s58
M v[32:35], a[100:103], a[164:167], v[32:35]
ds_read_b128 a[176:179], v10 offset:36864
ds_read_b128 a[180:183], v11 offset:36864
M v[36:39], a[108:111], a[164:167], v[36:39]
M v[36:39], a[104:107], a[160:163], v[36:39]
M v[40:43], a[112:115], a[160:163], v[40:43]
M v[40:43], a[116:119], a[164:167], v[40:43]
s_add_u32 m0, s30, 65536
s_nop 0
buffer_load_dwordx4 v6, s[12:15], s25 offen offset:0 lds
M v[44:47], a[124:127], a[164:167], v[44:47]
M v[44:47], a[120:123], a[160:163], v[44:47]
M v[48:51], a[128:131], a[160:163], v[48:51]
M v[48:51], a[132:135], a[164:167], v[48:51]
buffer_load_dwordx4 v7, s[12:15], s25 offen offset:1024 lds
M v[52:55], a[140:143], a[164:167], v[52:55]
M v[52:55], a[136:139], a[160:163], v[52:55]
M v[56:59], a[144:147], a[160:163], v[56:59]
M v[56:59], a[148:151], a[164:167], v[56:59]
buffer_load_dwordx4 v8, s[12:15], s25 offen offset:2048 lds
M v[60:63], a[156:159], a[164:167], v[60:63]
M v[60:63], a[152:155], a[160:163], v[60:63]
s_waitcnt lgkmcnt(2)
M v[64:67], a[96:99], a[168:171], v[64:67]
M v[64:67], a[100:103], a[172:175], v[64:67]
ds_read_b128 a[184:187], v10 offset:38912
ds_read_b128 a[188:191], v11 offset:38912
M v[68:71], a[108:111], a[172:175], v[68:71]
M v[68:71], a[104:107], a[168:171], v[68:71]
buffer_load_dwordx4 v9, s[12:15], s25 offen offset:3072 lds
v_pk_mul_f32 v[32:33], v[32:33], s[4:5]
v_pk_mul_f32 v[34:35], v[34:35], s[4:5]
v_pk_mul_f32 v[36:37], v[36:37], s[4:5]
M v[72:75], a[112:115], a[168:171], v[72:75]
v_pk_mul_f32 v[38:39], v[38:39], s[4:5]
v_cvt_pk_bf16_f32 v32, v32, v33
M v[72:75], a[116:119], a[172:175], v[72:75]
v_cvt_pk_bf16_f32 v33, v34, v35
v_cvt_pk_bf16_f32 v34, v36, v37
M v[76:79], a[124:127], a[172:175], v[76:79]
v_cvt_pk_bf16_f32 v35, v38, v39
v_pk_mul_f32 v[40:41], v[40:41], s[4:5]
v_pk_mul_f32 v[42:43], v[42:43], s[4:5]
M v[76:79], a[120:123], a[168:171], v[76:79]
s_add_u32 m0, s30, 69632
s_nop 0
buffer_load_dwordx4 v21, s[12:15], s25 offen offset:0 lds
v_pk_mul_f32 v[44:45], v[44:45], s[4:5]
v_pk_mul_f32 v[46:47], v[46:47], s[4:5]
M v[80:83], a[128:131], a[168:171], v[80:83]
v_cvt_pk_bf16_f32 v40, v40, v41
v_cvt_pk_bf16_f32 v41, v42, v43
M v[80:83], a[132:135], a[172:175], v[80:83]
v_cvt_pk_bf16_f32 v42, v44, v45
v_cvt_pk_bf16_f32 v43, v46, v47
M v[84:87], a[140:143], a[172:175], v[84:87]
v_pk_mul_f32 v[48:49], v[48:49], s[4:5]
v_pk_mul_f32 v[50:51], v[50:51], s[4:5]
v_pk_mul_f32 v[52:53], v[52:53], s[4:5]
M v[84:87], a[136:139], a[168:171], v[84:87]
buffer_load_dwordx4 v22, s[12:15], s25 offen offset:1024 lds
v_pk_mul_f32 v[54:55], v[54:55], s[4:5]
v_cvt_pk_bf16_f32 v48, v48, v49
M v[88:91], a[144:147], a[168:171], v[88:91]
v_cvt_pk_bf16_f32 v49, v50, v51
v_cvt_pk_bf16_f32 v50, v52, v53
M v[88:91], a[148:151], a[172:175], v[88:91]
v_cvt_pk_bf16_f32 v51, v54, v55
v_pk_mul_f32 v[56:57], v[56:57], s[4:5]
v_pk_mul_f32 v[58:59], v[58:59], s[4:5]
M v[92:95], a[156:159], a[172:175], v[92:95]
v_pk_mul_f32 v[60:61], v[60:61], s[4:5]
v_pk_mul_f32 v[62:63], v[62:63], s[4:5]
M v[92:95], a[152:155], a[168:171], v[92:95]
s_waitcnt lgkmcnt(2)
v_cvt_pk_bf16_f32 v56, v56, v57
v_cvt_pk_bf16_f32 v57, v58, v59
M v[96:99], a[96:99], a[176:179], v[96:99]
s_sub_u32 s54, s54, 1
s_cmp_eq_u32 s54, 0
s_cselect_b32 s58, s55, s56
s_add_u32 s25, s25, s58
v_cvt_pk_bf16_f32 v58, v60, v61
v_cvt_pk_bf16_f32 v59, v62, v63
M v[96:99], a[100:103], a[180:183], v[96:99]
M v[100:103], a[108:111], a[180:183], v[100:103]
M v[100:103], a[104:107], a[176:179], v[100:103]
v_pk_mul_f32 v[64:65], v[64:65], s[4:5]
v_pk_mul_f32 v[66:67], v[66:67], s[4:5]
v_pk_mul_f32 v[68:69], v[68:69], s[4:5]
M v[104:107], a[112:115], a[176:179], v[104:107]
v_pk_mul_f32 v[70:71], v[70:71], s[4:5]
v_cvt_pk_bf16_f32 v64, v64, v65
M v[104:107], a[116:119], a[180:183], v[104:107]
v_cvt_pk_bf16_f32 v65, v66, v67
v_cvt_pk_bf16_f32 v66, v68, v69
M v[108:111], a[124:127], a[180:183], v[108:111]
v_cvt_pk_bf16_f32 v67, v70, v71
v_pk_mul_f32 v[72:73], v[72:73], s[4:5]
v_pk_mul_f32 v[74:75], v[74:75], s[4:5]
M v[108:111], a[120:123], a[176:179], v[108:111]
s_waitcnt vmcnt(12) lgkmcnt(0)
s_barrier
ds_read_b128 a[160:163], v10 offset:49152
ds_read_b128 a[164:167], v11 offset:49152
v_pk_mul_f32 v[76:77], v[76:77], s[4:5]
v_pk_mul_f32 v[78:79], v[78:79], s[4:5]
M v[112:115], a[128:131], a[176:179], v[112:115]
s_add_u32 m0, s28, 0
s_nop 0
buffer_load_dword v20, s[8:11], s24 offen lds
v_cvt_pk_bf16_f32 v72, v72, v73
v_cvt_pk_bf16_f32 v73, v74, v75
M v[112:115], a[132:135], a[180:183], v[112:115]
v_cvt_pk_bf16_f32 v74, v76, v77
v_cvt_pk_bf16_f32 v75, v78, v79
M v[116:119], a[140:143], a[180:183], v[116:119]
v_pk_mul_f32 v[80:81], v[80:81], s[4:5]
v_pk_mul_f32 v[82:83], v[82:83], s[4:5]
v_pk_mul_f32 v[84:85], v[84:85], s[4:5]
M v[116:119], a[136:139], a[176:179], v[116:119]
buffer_load_dword v23, s[8:11], s24 offen offset:256 lds
v_pk_mul_f32 v[86:87], v[86:87], s[4:5]
v_cvt_pk_bf16_f32 v80, v80, v81
M v[120:123], a[144:147], a[176:179], v[120:123]
v_cvt_pk_bf16_f32 v81, v82, v83
v_cvt_pk_bf16_f32 v82, v84, v85
M v[120:123], a[148:151], a[180:183], v[120:123]
v_cvt_pk_bf16_f32 v83, v86, v87
v_pk_mul_f32 v[88:89], v[88:89], s[4:5]
v_pk_mul_f32 v[90:91], v[90:91], s[4:5]
M v[124:127], a[156:159], a[180:183], v[124:127]
v_pk_mul_f32 v[92:93], v[92:93], s[4:5]
v_pk_mul_f32 v[94:95], v[94:95], s[4:5]
M v[124:127], a[152:155], a[176:179], v[124:127]
v_cvt_pk_bf16_f32 v88, v88, v89
v_cvt_pk_bf16_f32 v89, v90, v91
M v[128:131], a[96:99], a[184:187], v[128:131]
s_add_u32 m0, s29, 2048
s_nop 0
buffer_load_dwordx4 v2, s[8:11], s23 offen offset:0 lds
v_cvt_pk_bf16_f32 v90, v92, v93
v_cvt_pk_bf16_f32 v91, v94, v95
M v[128:131], a[100:103], a[188:191], v[128:131]
ds_read_b128 a[168:171], v10 offset:51200
ds_read_b128 a[172:175], v11 offset:51200
M v[132:135], a[108:111], a[188:191], v[132:135]
M v[132:135], a[104:107], a[184:187], v[132:135]
v_pk_mul_f32 v[96:97], v[96:97], s[4:5]
v_pk_mul_f32 v[98:99], v[98:99], s[4:5]
v_pk_mul_f32 v[100:101], v[100:101], s[4:5]
M v[136:139], a[112:115], a[184:187], v[136:139]
v_pk_mul_f32 v[102:103], v[102:103], s[4:5]
v_cvt_pk_bf16_f32 v96, v96, v97
M v[136:139], a[116:119], a[188:191], v[136:139]
buffer_load_dwordx4 v3, s[8:11], s23 offen offset:1024 lds
v_cvt_pk_bf16_f32 v97, v98, v99
v_cvt_pk_bf16_f32 v98, v100, v101
M v[140:143], a[124:127], a[188:191], v[140:143]
v_cvt_pk_bf16_f32 v99, v102, v103
v_pk_mul_f32 v[104:105], v[104:105], s[4:5]
v_pk_mul_f32 v[106:107], v[106:107], s[4:5]
M v[140:143], a[120:123], a[184:187], v[140:143]
v_pk_mul_f32 v[108:109], v[108:109], s[4:5]
v_pk_mul_f32 v[110:111], v[110:111], s[4:5]
M v[144:147], a[128:131], a[184:187], v[144:147]
v_cvt_pk_bf16_f32 v104, v104, v105
v_cvt_pk_bf16_f32 v105, v106, v107
M v[144:147], a[132:135], a[188:191], v[144:147]
buffer_load_dwordx4 v4, s[8:11], s23 offen offset:2048 lds
v_cvt_pk_bf16_f32 v106, v108, v109
v_cvt_pk_bf16_f32 v107, v110, v111
M v[148:151], a[140:143], a[188:191], v[148:151]
v_pk_mul_f32 v[112:113], v[112:113], s[4:5]
v_pk_mul_f32 v[114:115], v[114:115], s[4:5]
v_pk_mul_f32 v[116:117], v[116:117], s[4:5]
M v[148:151], a[136:139], a[184:187], v[148:151]
v_pk_mul_f32 v[118:119], v[118:119], s[4:5]
v_cvt_pk_bf16_f32 v112, v112, v113
M v[152:155], a[144:147], a[184:187], v[152:155]
v_cvt_pk_bf16_f32 v113, v114, v115
v_cvt_pk_bf16_f32 v114, v116, v117
M v[152:155], a[148:151], a[188:191], v[152:155]
buffer_load_dwordx4 v5, s[8:11], s23 offen offset:3072 lds
v_cvt_pk_bf16_f32 v115, v118, v119
v_pk_mul_f32 v[120:121], v[120:121], s[4:5]
v_pk_mul_f32 v[122:123], v[122:123], s[4:5]
M v[156:159], a[156:159], a[188:191], v[156:159]
v_pk_mul_f32 v[124:125], v[124:125], s[4:5]
v_pk_mul_f32 v[126:127], v[126:127], s[4:5]
M v[156:159], a[152:155], a[184:187], v[156:159]
s_waitcnt lgkmcnt(2)
v_cvt_pk_bf16_f32 v120, v120, v121
v_cvt_pk_bf16_f32 v121, v122, v123
M v[160:163], a[96:99], a[160:163], v[160:163]
v_cvt_pk_bf16_f32 v122, v124, v125
v_cvt_pk_bf16_f32 v123, v126, v127
M v[160:163], a[100:103], a[164:167], v[160:163]
ds_read_b128 a[176:179], v10 offset:53248
ds_read_b128 a[180:183], v11 offset:53248
M v[164:167], a[108:111], a[164:167], v[164:167]
M v[164:167], a[104:107], a[160:163], v[164:167]
s_sub_u32 s31, s31, 1
s_cmp_eq_u32 s31, 0
s_cselect_b32 s58, -1920, s57
s_add_u32 s23, s23, s58
s_add_u32 s24, s24, s58
v_pk_mul_f32 v[128:129], v[128:129], s[4:5]
v_pk_mul_f32 v[130:131], v[130:131], s[4:5]
v_pk_mul_f32 v[132:133], v[132:133], s[4:5]
M v[168:171], a[112:115], a[160:163], v[168:171]
v_pk_mul_f32 v[134:135], v[134:135], s[4:5]
v_cvt_pk_bf16_f32 v128, v128, v129
M v[168:171], a[116:119], a[164:167], v[168:171]
v_cvt_pk_bf16_f32 v129, v130, v131
v_cvt_pk_bf16_f32 v130, v132, v133
M v[172:175], a[124:127], a[164:167], v[172:175]
v_cvt_pk_bf16_f32 v131, v134, v135
v_pk_mul_f32 v[136:137], v[136:137], s[4:5]
v_pk_mul_f32 v[138:139], v[138:139], s[4:5]
M v[172:175], a[120:123], a[160:163], v[172:175]
s_add_u32 m0, s30, 98304
s_nop 0
buffer_load_dwordx4 v6, s[12:15], s25 offen offset:0 lds
v_pk_mul_f32 v[140:141], v[140:141], s[4:5]
v_pk_mul_f32 v[142:143], v[142:143], s[4:5]
M v[176:179], a[128:131], a[160:163], v[176:179]
v_cvt_pk_bf16_f32 v136, v136, v137
v_cvt_pk_bf16_f32 v137, v138, v139
M v[176:179], a[132:135], a[164:167], v[176:179]
v_cvt_pk_bf16_f32 v138, v140, v141
v_cvt_pk_bf16_f32 v139, v142, v143
M v[180:183], a[140:143], a[164:167], v[180:183]
buffer_load_dwordx4 v7, s[12:15], s25 offen offset:1024 lds
v_pk_mul_f32 v[144:145], v[144:145], s[4:5]
v_pk_mul_f32 v[146:147], v[146:147], s[4:5]
v_pk_mul_f32 v[148:149], v[148:149], s[4:5]
M v[180:183], a[136:139], a[160:163], v[180:183]
v_pk_mul_f32 v[150:151], v[150:151], s[4:5]
v_cvt_pk_bf16_f32 v144, v144, v145
M v[184:187], a[144:147], a[160:163], v[184:187]
v_cvt_pk_bf16_f32 v145, v146, v147
v_cvt_pk_bf16_f32 v146, v148, v149
M v[184:187], a[148:151], a[164:167], v[184:187]
v_cvt_pk_bf16_f32 v147, v150, v151
v_pk_mul_f32 v[152:153], v[152:153], s[4:5]
v_pk_mul_f32 v[154:155], v[154:155], s[4:5]
M v[188:191], a[156:159], a[164:167], v[188:191]
buffer_load_dwordx4 v8, s[12:15], s25 offen offset:2048 lds
v_pk_mul_f32 v[156:157], v[156:157], s[4:5]
v_pk_mul_f32 v[158:159], v[158:159], s[4:5]
M v[188:191], a[152:155], a[160:163], v[188:191]
s_waitcnt lgkmcnt(2)
v_cvt_pk_bf16_f32 v152, v152, v153
v_cvt_pk_bf16_f32 v153, v154, v155
M v[192:195], a[96:99], a[168:171], v[192:195]
v_cvt_pk_bf16_f32 v154, v156, v157
v_cvt_pk_bf16_f32 v155, v158, v159
M v[192:195], a[100:103], a[172:175], v[192:195]
ds_read_b128 a[184:187], v10 offset:55296
ds_read_b128 a[188:191], v11 offset:55296
M v[196:199], a[108:111], a[172:175], v[196:199]
M v[196:199], a[104:107], a[168:171], v[196:199]
v_pk_mul_f32 v[160:161], v[160:161], s[4:5]
v_pk_mul_f32 v[162:163], v[162:163], s[4:5]
v_pk_mul_f32 v[164:165], v[164:165], s[4:5]
M v[200:203], a[112:115], a[168:171], v[200:203]
buffer_load_dwordx4 v9, s[12:15], s25 offen offset:3072 lds
v_pk_mul_f32 v[166:167], v[166:167], s[4:5]
v_cvt_pk_bf16_f32 v160, v160, v161
M v[200:203], a[116:119], a[172:175], v[200:203]
v_cvt_pk_bf16_f32 v161, v162, v163
v_cvt_pk_bf16_f32 v162, v164, v165
M v[204:207], a[124:127], a[172:175], v[204:207]
v_cvt_pk_bf16_f32 v163, v166, v167
v_pk_mul_f32 v[168:169], v[168:169], s[4:5]
v_pk_mul_f32 v[170:171], v[170:171], s[4:5]
M v[204:207], a[120:123], a[168:171], v[204:207]
v_pk_mul_f32 v[172:173], v[172:173], s[4:5]
v_pk_mul_f32 v[174:175], v[174:175], s[4:5]
M v[208:211], a[128:131], a[168:171], v[208:211]
s_add_u32 m0, s30, 102400
s_nop 0
buffer_load_dwordx4 v21, s[12:15], s25 offen offset:0 lds
v_cvt_pk_bf16_f32 v168, v168, v169
v_cvt_pk_bf16_f32 v169, v170, v171
M v[208:211], a[132:135], a[172:175], v[208:211]
v_cvt_pk_bf16_f32 v170, v172, v173
v_cvt_pk_bf16_f32 v171, v174, v175
M v[212:215], a[140:143], a[172:175], v[212:215]
v_pk_mul_f32 v[176:177], v[176:177], s[4:5]
v_pk_mul_f32 v[178:179], v[178:179], s[4:5]
v_pk_mul_f32 v[180:181], v[180:181], s[4:5]
M v[212:215], a[136:139], a[168:171], v[212:215]
v_pk_mul_f32 v[182:183], v[182:183], s[4:5]
v_cvt_pk_bf16_f32 v176, v176, v177
M v[216:219], a[144:147], a[168:171], v[216:219]
buffer_load_dwordx4 v22, s[12:15], s25 offen offset:1024 lds
v_cvt_pk_bf16_f32 v177, v178, v179
v_cvt_pk_bf16_f32 v178, v180, v181
M v[216:219], a[148:151], a[172:175], v[216:219]
v_cvt_pk_bf16_f32 v179, v182, v183
v_pk_mul_f32 v[184:185], v[184:185], s[4:5]
v_pk_mul_f32 v[186:187], v[186:187], s[4:5]
M v[220:223], a[156:159], a[172:175], v[220:223]
v_pk_mul_f32 v[188:189], v[188:189], s[4:5]
v_pk_mul_f32 v[190:191], v[190:191], s[4:5]
M v[220:223], a[152:155], a[168:171], v[220:223]
s_waitcnt lgkmcnt(2)
v_cvt_pk_bf16_f32 v184, v184, v185
v_cvt_pk_bf16_f32 v185, v186, v187
M v[224:227], a[96:99], a[176:179], v[224:227]
v_cvt_pk_bf16_f32 v186, v188, v189
v_cvt_pk_bf16_f32 v187, v190, v191
M v[224:227], a[100:103], a[180:183], v[224:227]
s_sub_u32 s54, s54, 1
s_cmp_eq_u32 s54, 0
s_cselect_b32 s58, s55, s56
s_add_u32 s25, s25, s58
M v[228:231], a[108:111], a[180:183], v[228:231]
M v[228:231], a[104:107], a[176:179], v[228:231]
v_pk_mul_f32 v[192:193], v[192:193], s[4:5]
v_pk_mul_f32 v[194:195], v[194:195], s[4:5]
v_pk_mul_f32 v[196:197], v[196:197], s[4:5]
M v[232:235], a[112:115], a[176:179], v[232:235]
v_pk_mul_f32 v[198:199], v[198:199], s[4:5]
v_cvt_pk_bf16_f32 v192, v192, v193
M v[232:235], a[116:119], a[180:183], v[232:235]
v_cvt_pk_bf16_f32 v193, v194, v195
v_cvt_pk_bf16_f32 v194, v196, v197
M v[236:239], a[124:127], a[180:183], v[236:239]
v_cvt_pk_bf16_f32 v195, v198, v199
v_pk_mul_f32 v[200:201], v[200:201], s[4:5]
v_pk_mul_f32 v[202:203], v[202:203], s[4:5]
M v[236:239], a[120:123], a[176:179], v[236:239]
s_waitcnt vmcnt(63) lgkmcnt(0)
s_barrier
v_pk_mul_f32 v[204:205], v[204:205], s[4:5]
v_pk_mul_f32 v[206:207], v[206:207], s[4:5]
M v[240:243], a[128:131], a[176:179], v[240:243]
s_add_u32 m0, s28, 18432
s_nop 0
buffer_load_dword v20, s[8:11], s24 offen lds
v_cvt_pk_bf16_f32 v200, v200, v201
v_cvt_pk_bf16_f32 v201, v202, v203
M v[240:243], a[132:135], a[180:183], v[240:243]
v_cvt_pk_bf16_f32 v202, v204, v205
v_cvt_pk_bf16_f32 v203, v206, v207
M v[244:247], a[140:143], a[180:183], v[244:247]
v_pk_mul_f32 v[208:209], v[208:209], s[4:5]
v_pk_mul_f32 v[210:211], v[210:211], s[4:5]
v_pk_mul_f32 v[212:213], v[212:213], s[4:5]
M v[244:247], a[136:139], a[176:179], v[244:247]
buffer_load_dword v23, s[8:11], s24 offen offset:256 lds
v_pk_mul_f32 v[214:215], v[214:215], s[4:5]
v_cvt_pk_bf16_f32 v208, v208, v209
M v[248:251], a[144:147], a[176:179], v[248:251]
v_cvt_pk_bf16_f32 v209, v210, v211
v_cvt_pk_bf16_f32 v210, v212, v213
M v[248:251], a[148:151], a[180:183], v[248:251]
v_cvt_pk_bf16_f32 v211, v214, v215
v_pk_mul_f32 v[216:217], v[216:217], s[4:5]
v_pk_mul_f32 v[218:219], v[218:219], s[4:5]
M v[252:255], a[156:159], a[180:183], v[252:255]
v_pk_mul_f32 v[220:221], v[220:221], s[4:5]
v_pk_mul_f32 v[222:223], v[222:223], s[4:5]
M v[252:255], a[152:155], a[176:179], v[252:255]
v_cvt_pk_bf16_f32 v216, v216, v217
v_cvt_pk_bf16_f32 v217, v218, v219
M a[0:3], a[96:99], a[184:187], a[0:3]
s_add_u32 m0, s29, 20480
s_nop 0
buffer_load_dwordx4 v2, s[8:11], s23 offen offset:0 lds
v_cvt_pk_bf16_f32 v218, v220, v221
v_cvt_pk_bf16_f32 v219, v222, v223
M a[0:3], a[100:103], a[188:191], a[0:3]
M a[4:7], a[108:111], a[188:191], a[4:7]
M a[4:7], a[104:107], a[184:187], a[4:7]
v_pk_mul_f32 v[224:225], v[224:225], s[4:5]
v_pk_mul_f32 v[226:227], v[226:227], s[4:5]
v_pk_mul_f32 v[228:229], v[228:229], s[4:5]
M a[8:11], a[112:115], a[184:187], a[8:11]
buffer_load_dwordx4 v3, s[8:11], s23 offen offset:1024 lds
v_pk_mul_f32 v[230:231], v[230:231], s[4:5]
v_cvt_pk_bf16_f32 v224, v224, v225
M a[8:11], a[116:119], a[188:191], a[8:11]
v_cvt_pk_bf16_f32 v225, v226, v227
v_cvt_pk_bf16_f32 v226, v228, v229
M a[12:15], a[124:127], a[188:191], a[12:15]
v_cvt_pk_bf16_f32 v227, v230, v231
v_pk_mul_f32 v[232:233], v[232:233], s[4:5]
v_pk_mul_f32 v[234:235], v[234:235], s[4:5]
M a[12:15], a[120:123], a[184:187], a[12:15]
buffer_load_dwordx4 v4, s[8:11], s23 offen offset:2048 lds
v_pk_mul_f32 v[236:237], v[236:237], s[4:5]
v_pk_mul_f32 v[238:239], v[238:239], s[4:5]
M a[16:19], a[128:131], a[184:187], a[16:19]
v_cvt_pk_bf16_f32 v232, v232, v233
v_cvt_pk_bf16_f32 v233, v234, v235
M a[16:19], a[132:135], a[188:191], a[16:19]
v_cvt_pk_bf16_f32 v234, v236, v237
v_cvt_pk_bf16_f32 v235, v238, v239
M a[20:23], a[140:143], a[188:191], a[20:23]
v_pk_mul_f32 v[240:241], v[240:241], s[4:5]
v_pk_mul_f32 v[242:243], v[242:243], s[4:5]
v_pk_mul_f32 v[244:245], v[244:245], s[4:5]
M a[20:23], a[136:139], a[184:187], a[20:23]
buffer_load_dwordx4 v5, s[8:11], s23 offen offset:3072 lds
v_pk_mul_f32 v[246:247], v[246:247], s[4:5]
v_cvt_pk_bf16_f32 v240, v240, v241
M a[24:27], a[144:147], a[184:187], a[24:27]
v_cvt_pk_bf16_f32 v241, v242, v243
v_cvt_pk_bf16_f32 v242, v244, v245
M a[24:27], a[148:151], a[188:191], a[24:27]
v_cvt_pk_bf16_f32 v243, v246, v247
v_pk_mul_f32 v[248:249], v[248:249], s[4:5]
v_pk_mul_f32 v[250:251], v[250:251], s[4:5]
M a[28:31], a[156:159], a[188:191], a[28:31]
v_pk_mul_f32 v[252:253], v[252:253], s[4:5]
v_pk_mul_f32 v[254:255], v[254:255], s[4:5]
M a[28:31], a[152:155], a[184:187], a[28:31]
v_cvt_pk_bf16_f32 v248, v248, v249
v_cvt_pk_bf16_f32 v249, v250, v251
v_cvt_pk_bf16_f32 v250, v252, v253
v_cvt_pk_bf16_f32 v251, v254, v255
v_accvgpr_read_b32 v24, a0
v_accvgpr_read_b32 v25, a1
v_accvgpr_read_b32 v26, a2
v_accvgpr_read_b32 v27, a3
v_accvgpr_read_b32 v28, a4
v_accvgpr_read_b32 v29, a5
v_accvgpr_read_b32 v30, a6
v_accvgpr_read_b32 v31, a7
v_pk_mul_f32 v[24:25], v[24:25], s[4:5]
v_pk_mul_f32 v[26:27], v[26:27], s[4:5]
v_pk_mul_f32 v[28:29], v[28:29], s[4:5]
v_pk_mul_f32 v[30:31], v[30:31], s[4:5]
v_cvt_pk_bf16_f32 v36, v24, v25
v_cvt_pk_bf16_f32 v37, v26, v27
v_cvt_pk_bf16_f32 v38, v28, v29
v_cvt_pk_bf16_f32 v39, v30, v31
v_accvgpr_read_b32 v24, a8
v_accvgpr_read_b32 v25, a9
v_accvgpr_read_b32 v26, a10
v_accvgpr_read_b32 v27, a11
v_accvgpr_read_b32 v28, a12
v_accvgpr_read_b32 v29, a13
v_accvgpr_read_b32 v30, a14
v_accvgpr_read_b32 v31, a15
v_pk_mul_f32 v[24:25], v[24:25], s[4:5]
v_pk_mul_f32 v[26:27], v[26:27], s[4:5]
v_pk_mul_f32 v[28:29], v[28:29], s[4:5]
v_pk_mul_f32 v[30:31], v[30:31], s[4:5]
v_cvt_pk_bf16_f32 v44, v24, v25
v_cvt_pk_bf16_f32 v45, v26, v27
v_cvt_pk_bf16_f32 v46, v28, v29
v_cvt_pk_bf16_f32 v47, v30, v31
v_accvgpr_read_b32 v24, a16
v_accvgpr_read_b32 v25, a17
v_accvgpr_read_b32 v26, a18
v_accvgpr_read_b32 v27, a19
v_accvgpr_read_b32 v28, a20
v_accvgpr_read_b32 v29, a21
v_accvgpr_read_b32 v30, a22
v_accvgpr_read_b32 v31, a23
v_pk_mul_f32 v[24:25], v[24:25], s[4:5]
v_pk_mul_f32 v[26:27], v[26:27], s[4:5]
v_pk_mul_f32 v[28:29], v[28:29], s[4:5]
v_pk_mul_f32 v[30:31], v[30:31], s[4:5]
v_cvt_pk_bf16_f32 v52, v24, v25
v_cvt_pk_bf16_f32 v53, v26, v27
v_cvt_pk_bf16_f32 v54, v28, v29
v_cvt_pk_bf16_f32 v55, v30, v31
v_accvgpr_read_b32 v24, a24
v_accvgpr_read_b32 v25, a25
v_accvgpr_read_b32 v26, a26
v_accvgpr_read_b32 v27, a27
v_accvgpr_read_b32 v28, a28
v_accvgpr_read_b32 v29, a29
v_accvgpr_read_b32 v30, a30
v_accvgpr_read_b32 v31, a31
v_pk_mul_f32 v[24:25], v[24:25], s[4:5]
v_pk_mul_f32 v[26:27], v[26:27], s[4:5]
v_pk_mul_f32 v[28:29], v[28:29], s[4:5]
v_pk_mul_f32 v[30:31], v[30:31], s[4:5]
v_cvt_pk_bf16_f32 v60, v24, v25
v_cvt_pk_bf16_f32 v61, v26, v27
v_cvt_pk_bf16_f32 v62, v28, v29
v_cvt_pk_bf16_f32 v63, v30, v31
s_branch Lk1_b
Lk1_spin:
s_add_u32 s40, s40, 1
s_cmp_gt_u32 s40, 1048576
s_cbranch_scc1 Lk1_got
s_sleep 2
buffer_load_dword v126, v119, s[36:39], 0 offen offset:128 sc1
s_waitcnt vmcnt(0)
v_cmp_gt_u32 vcc, 0x80, v126
s_nop 0
s_cbranch_vccnz Lk1_spin
s_branch Lk1_got
Lk1_spinq:
s_add_u32 s40, s40, 1
s_cmp_gt_u32 s40, 1048576
s_cbranch_scc1 Lk1_gotq
s_sleep 2
buffer_load_dword v125, v119, s[36:39], 0 offen offset:0 sc1
s_waitcnt vmcnt(0)
v_cmp_gt_u32 vcc, 0x80, v125
s_nop 0
s_cbranch_vccnz Lk1_spinq
s_branch Lk1_gotq
Lk1_kv:
M v[32:35], a[32:35], a[160:163], 0
s_add_u32 s23, s23, 128
s_cmp_eq_u32 s23, s25
s_cselect_b32 s23, s26, s23
M v[32:35], a[36:39], a[164:167], v[32:35]
ds_read_b128 a[176:179], v10 offset:4096
ds_read_b128 a[180:183], v11 offset:4096
M v[36:39], a[44:47], a[164:167], 0
M v[36:39], a[40:43], a[160:163], v[36:39]
ds_read_b64_tr_b16 a[96:97], v12 offset:32768
ds_read_b64_tr_b16 a[98:99], v12 offset:34816
M v[40:43], a[48:51], a[160:163], 0
M v[40:43], a[52:55], a[164:167], v[40:43]
M v[44:47], a[60:63], a[164:167], 0
s_add_u32 m0, s29, 81920
s_nop 0
buffer_load_dwordx4 v6, s[12:15], s24 offen offset:0 lds
M v[44:47], a[56:59], a[160:163], v[44:47]
ds_read_b64_tr_b16 a[104:105], v13 offset:32768
ds_read_b64_tr_b16 a[106:107], v13 offset:34816
M v[48:51], a[64:67], a[160:163], 0
M v[48:51], a[68:71], a[164:167], v[48:51]
M v[52:55], a[76:79], a[164:167], 0
M v[52:55], a[72:75], a[160:163], v[52:55]
ds_read_b64_tr_b16 a[112:113], v14 offset:32768
ds_read_b64_tr_b16 a[114:115], v14 offset:34816
M v[56:59], a[80:83], a[160:163], 0
M v[56:59], a[84:87], a[164:167], v[56:59]
buffer_load_dwordx4 v7, s[12:15], s24 offen offset:1024 lds
M v[60:63], a[92:95], a[164:167], 0
M v[60:63], a[88:91], a[160:163], v[60:63]
ds_read_b64_tr_b16 a[120:121], v15 offset:32768
ds_read_b64_tr_b16 a[122:123], v15 offset:34816
M v[64:67], a[32:35], a[168:171], 0
M v[64:67], a[36:39], a[172:175], v[64:67]
ds_read_b128 a[184:187], v10 offset:6144
ds_read_b128 a[188:191], v11 offset:6144
M v[68:71], a[44:47], a[172:175], 0
M v[68:71], a[40:43], a[168:171], v[68:71]
ds_read_b64_tr_b16 a[128:129], v16 offset:32768
ds_read_b64_tr_b16 a[130:131], v16 offset:34816
M v[72:75], a[48:51], a[168:171], 0
buffer_load_dwordx4 v8, s[12:15], s24 offen offset:2048 lds
M v[72:75], a[52:55], a[172:175], v[72:75]
M v[76:79], a[60:63], a[172:175], 0
M v[76:79], a[56:59], a[168:171], v[76:79]
ds_read_b64_tr_b16 a[136:137], v17 offset:32768
ds_read_b64_tr_b16 a[138:139], v17 offset:34816
M v[80:83], a[64:67], a[168:171], 0
M v[80:83], a[68:71], a[172:175], v[80:83]
M v[84:87], a[76:79], a[172:175], 0
buffer_load_dwordx4 v9, s[12:15], s24 offen offset:3072 lds
M v[84:87], a[72:75], a[168:171], v[84:87]
ds_read_b64_tr_b16 a[144:145], v18 offset:32768
ds_read_b64_tr_b16 a[146:147], v18 offset:34816
M v[88:91], a[80:83], a[168:171], 0
M v[88:91], a[84:87], a[172:175], v[88:91]
M v[92:95], a[92:95], a[172:175], 0
M v[92:95], a[88:91], a[168:171], v[92:95]
s_waitcnt lgkmcnt(15)
ds_read_b64_tr_b16 a[152:153], v19 offset:32768
ds_read_b64_tr_b16 a[154:155], v19 offset:34816
M v[96:99], a[32:35], a[176:179], 0
s_add_u32 s24, s24, 262144
s_cmp_eq_u32 s24, s27
s_cselect_b32 s24, s28, s24
s_sub_u32 s6, s6, 1
s_cmp_eq_u32 s6, 0
s_cselect_b64 s[12:13], s[64:65], s[12:13]
M v[96:99], a[36:39], a[180:183], v[96:99]
M v[100:103], a[44:47], a[180:183], 0
M v[100:103], a[40:43], a[176:179], v[100:103]
M v[104:107], a[48:51], a[176:179], 0
M v[104:107], a[52:55], a[180:183], v[104:107]
M v[108:111], a[60:63], a[180:183], 0
M v[108:111], a[56:59], a[176:179], v[108:111]
s_waitcnt vmcnt(16) lgkmcnt(0)
s_barrier
ds_read_b128 a[160:163], v10 offset:16384
ds_read_b128 a[164:167], v11 offset:16384
M v[112:115], a[64:67], a[176:179], 0
s_add_u32 m0, s29, 0
s_nop 0
buffer_load_dwordx4 v2, s[8:11], s23 offen offset:0 lds
M v[112:115], a[68:71], a[180:183], v[112:115]
M v[116:119], a[76:79], a[180:183], 0
M v[116:119], a[72:75], a[176:179], v[116:119]
ds_read_b64_tr_b16 a[100:101], v12 offset:49152
ds_read_b64_tr_b16 a[102:103], v12 offset:51200
M v[120:123], a[80:83], a[176:179], 0
M v[120:123], a[84:87], a[180:183], v[120:123]
M v[124:127], a[92:95], a[180:183], 0
buffer_load_dwordx4 v3, s[8:11], s23 offen offset:1024 lds
M v[124:127], a[88:91], a[176:179], v[124:127]
M v[128:131], a[32:35], a[184:187], 0
M v[128:131], a[36:39], a[188:191], v[128:131]
ds_read_b128 a[168:171], v10 offset:18432
ds_read_b128 a[172:175], v11 offset:18432
ds_read_b64_tr_b16 a[108:109], v13 offset:49152
ds_read_b64_tr_b16 a[110:111], v13 offset:51200
M v[132:135], a[44:47], a[188:191], 0
M v[132:135], a[40:43], a[184:187], v[132:135]
M v[136:139], a[48:51], a[184:187], 0
M v[136:139], a[52:55], a[188:191], v[136:139]
buffer_load_dwordx4 v4, s[8:11], s23 offen offset:2048 lds
M v[140:143], a[60:63], a[188:191], 0
M v[140:143], a[56:59], a[184:187], v[140:143]
ds_read_b64_tr_b16 a[116:117], v14 offset:49152
ds_read_b64_tr_b16 a[118:119], v14 offset:51200
M v[144:147], a[64:67], a[184:187], 0
M v[144:147], a[68:71], a[188:191], v[144:147]
M v[148:151], a[76:79], a[188:191], 0
M v[148:151], a[72:75], a[184:187], v[148:151]
M v[152:155], a[80:83], a[184:187], 0
buffer_load_dwordx4 v5, s[8:11], s23 offen offset:3072 lds
M v[152:155], a[84:87], a[188:191], v[152:155]
ds_read_b64_tr_b16 a[124:125], v15 offset:49152
ds_read_b64_tr_b16 a[126:127], v15 offset:51200
M v[156:159], a[92:95], a[188:191], 0
M v[156:159], a[88:91], a[184:187], v[156:159]
s_waitcnt lgkmcnt(10)
M v[160:163], a[32:35], a[160:163], 0
M v[160:163], a[36:39], a[164:167], v[160:163]
ds_read_b128 a[176:179], v10 offset:20480
ds_read_b128 a[180:183], v11 offset:20480
M v[164:167], a[44:47], a[164:167], 0
M v[164:167], a[40:43], a[160:163], v[164:167]
ds_read_b64_tr_b16 a[132:133], v16 offset:49152
ds_read_b64_tr_b16 a[134:135], v16 offset:51200
M v[168:171], a[48:51], a[160:163], 0
M v[168:171], a[52:55], a[164:167], v[168:171]
s_add_u32 m0, s29, 98304
s_nop 0
buffer_load_dwordx4 v6, s[12:15], s24 offen offset:0 lds
M v[172:175], a[60:63], a[164:167], 0
M v[172:175], a[56:59], a[160:163], v[172:175]
M v[176:179], a[64:67], a[160:163], 0
M v[176:179], a[68:71], a[164:167], v[176:179]
ds_read_b64_tr_b16 a[140:141], v17 offset:49152
ds_read_b64_tr_b16 a[142:143], v17 offset:51200
M v[180:183], a[76:79], a[164:167], 0
M v[180:183], a[72:75], a[160:163], v[180:183]
buffer_load_dwordx4 v7, s[12:15], s24 offen offset:1024 lds
M v[184:187], a[80:83], a[160:163], 0
M v[184:187], a[84:87], a[164:167], v[184:187]
M v[188:191], a[92:95], a[164:167], 0
M v[188:191], a[88:91], a[160:163], v[188:191]
s_waitcnt lgkmcnt(12)
ds_read_b64_tr_b16 a[148:149], v18 offset:49152
ds_read_b64_tr_b16 a[150:151], v18 offset:51200
M v[192:195], a[32:35], a[168:171], 0
M v[192:195], a[36:39], a[172:175], v[192:195]
ds_read_b128 a[184:187], v10 offset:22528
ds_read_b128 a[188:191], v11 offset:22528
M v[196:199], a[44:47], a[172:175], 0
M v[196:199], a[40:43], a[168:171], v[196:199]
buffer_load_dwordx4 v8, s[12:15], s24 offen offset:2048 lds
M v[200:203], a[48:51], a[168:171], 0
M v[200:203], a[52:55], a[172:175], v[200:203]
ds_read_b64_tr_b16 a[156:157], v19 offset:49152
ds_read_b64_tr_b16 a[158:159], v19 offset:51200
M v[204:207], a[60:63], a[172:175], 0
M v[204:207], a[56:59], a[168:171], v[204:207]
M v[208:211], a[64:67], a[168:171], 0
M v[208:211], a[68:71], a[172:175], v[208:211]
buffer_load_dwordx4 v9, s[12:15], s24 offen offset:3072 lds
M v[212:215], a[76:79], a[172:175], 0
M v[212:215], a[72:75], a[168:171], v[212:215]
M v[216:219], a[80:83], a[168:171], 0
M v[216:219], a[84:87], a[172:175], v[216:219]
M v[220:223], a[92:95], a[172:175], 0
s_add_u32 s24, s24, 262144
M v[220:223], a[88:91], a[168:171], v[220:223]
s_waitcnt lgkmcnt(10)
M v[224:227], a[32:35], a[176:179], 0
M v[224:227], a[36:39], a[180:183], v[224:227]
M v[228:231], a[44:47], a[180:183], 0
M v[228:231], a[40:43], a[176:179], v[228:231]
M v[232:235], a[48:51], a[176:179], 0
M v[232:235], a[52:55], a[180:183], v[232:235]
M v[236:239], a[60:63], a[180:183], 0
M v[236:239], a[56:59], a[176:179], v[236:239]
s_waitcnt vmcnt(16) lgkmcnt(0)
s_barrier
ds_read_b128 a[160:163], v10 offset:32768
ds_read_b128 a[164:167], v11 offset:32768
M v[240:243], a[64:67], a[176:179], 0
s_add_u32 m0, s29, 16384
s_add_u32 s3, s23, s31
buffer_load_dwordx4 v2, s[8:11], s3 offen offset:0 lds
M v[240:243], a[68:71], a[180:183], v[240:243]
M v[244:247], a[76:79], a[180:183], 0
M v[244:247], a[72:75], a[176:179], v[244:247]
M v[248:251], a[80:83], a[176:179], 0
M v[248:251], a[84:87], a[180:183], v[248:251]
buffer_load_dwordx4 v3, s[8:11], s3 offen offset:1024 lds
M v[252:255], a[92:95], a[180:183], 0
M v[252:255], a[88:91], a[176:179], v[252:255]
M a[0:3], a[32:35], a[184:187], 0
M a[0:3], a[36:39], a[188:191], a[0:3]
ds_read_b128 a[168:171], v10 offset:34816
ds_read_b128 a[172:175], v11 offset:34816
M a[4:7], a[44:47], a[188:191], 0
M a[4:7], a[40:43], a[184:187], a[4:7]
M a[8:11], a[48:51], a[184:187], 0
buffer_load_dwordx4 v4, s[8:11], s3 offen offset:2048 lds
M a[8:11], a[52:55], a[188:191], a[8:11]
M a[12:15], a[60:63], a[188:191], 0
M a[12:15], a[56:59], a[184:187], a[12:15]
M a[16:19], a[64:67], a[184:187], 0
M a[16:19], a[68:71], a[188:191], a[16:19]
buffer_load_dwordx4 v5, s[8:11], s3 offen offset:3072 lds
M a[20:23], a[76:79], a[188:191], 0
M a[20:23], a[72:75], a[184:187], a[20:23]
M a[24:27], a[80:83], a[184:187], 0
M a[24:27], a[84:87], a[188:191], a[24:27]
M a[28:31], a[92:95], a[188:191], 0
M a[28:31], a[88:91], a[184:187], a[28:31]
s_waitcnt lgkmcnt(2)
M v[32:35], a[96:99], a[160:163], v[32:35]
s_add_u32 s23, s23, 128
s_cmp_eq_u32 s23, s25
s_cselect_b32 s23, s26, s23
M v[32:35], a[100:103], a[164:167], v[32:35]
ds_read_b128 a[176:179], v10 offset:36864
ds_read_b128 a[180:183], v11 offset:36864
M v[36:39], a[108:111], a[164:167], v[36:39]
M v[36:39], a[104:107], a[160:163], v[36:39]
ds_read_b64_tr_b16 a[32:33], v12 offset:0
ds_read_b64_tr_b16 a[34:35], v12 offset:2048
M v[40:43], a[112:115], a[160:163], v[40:43]
M v[40:43], a[116:119], a[164:167], v[40:43]
M v[44:47], a[124:127], a[164:167], v[44:47]
s_add_u32 m0, s29, 114688
s_nop 0
buffer_load_dwordx4 v6, s[12:15], s24 offen offset:0 lds
M v[44:47], a[120:123], a[160:163], v[44:47]
ds_read_b64_tr_b16 a[40:41], v13 offset:0
ds_read_b64_tr_b16 a[42:43], v13 offset:2048
M v[48:51], a[128:131], a[160:163], v[48:51]
M v[48:51], a[132:135], a[164:167], v[48:51]
M v[52:55], a[140:143], a[164:167], v[52:55]
M v[52:55], a[136:139], a[160:163], v[52:55]
ds_read_b64_tr_b16 a[48:49], v14 offset:0
ds_read_b64_tr_b16 a[50:51], v14 offset:2048
M v[56:59], a[144:147], a[160:163], v[56:59]
M v[56:59], a[148:151], a[164:167], v[56:59]
buffer_load_dwordx4 v7, s[12:15], s24 offen offset:1024 lds
M v[60:63], a[156:159], a[164:167], v[60:63]
M v[60:63], a[152:155], a[160:163], v[60:63]
s_waitcnt lgkmcnt(8)
ds_read_b64_tr_b16 a[56:57], v15 offset:0
ds_read_b64_tr_b16 a[58:59], v15 offset:2048
M v[64:67], a[96:99], a[168:171], v[64:67]
M v[64:67], a[100:103], a[172:175], v[64:67]
ds_read_b128 a[184:187], v10 offset:38912
ds_read_b128 a[188:191], v11 offset:38912
M v[68:71], a[108:111], a[172:175], v[68:71]
M v[68:71], a[104:107], a[168:171], v[68:71]
ds_read_b64_tr_b16 a[64:65], v16 offset:0
ds_read_b64_tr_b16 a[66:67], v16 offset:2048
M v[72:75], a[112:115], a[168:171], v[72:75]
buffer_load_dwordx4 v8, s[12:15], s24 offen offset:2048 lds
M v[72:75], a[116:119], a[172:175], v[72:75]
M v[76:79], a[124:127], a[172:175], v[76:79]
M v[76:79], a[120:123], a[168:171], v[76:79]
ds_read_b64_tr_b16 a[72:73], v17 offset:0
ds_read_b64_tr_b16 a[74:75], v17 offset:2048
M v[80:83], a[128:131], a[168:171], v[80:83]
M v[80:83], a[132:135], a[172:175], v[80:83]
M v[84:87], a[140:143], a[172:175], v[84:87]
buffer_load_dwordx4 v9, s[12:15], s24 offen offset:3072 lds
M v[84:87], a[136:139], a[168:171], v[84:87]
ds_read_b64_tr_b16 a[80:81], v18 offset:0
ds_read_b64_tr_b16 a[82:83], v18 offset:2048
M v[88:91], a[144:147], a[168:171], v[88:91]
M v[88:91], a[148:151], a[172:175], v[88:91]
M v[92:95], a[156:159], a[172:175], v[92:95]
M v[92:95], a[152:155], a[168:171], v[92:95]
s_waitcnt lgkmcnt(15)
ds_read_b64_tr_b16 a[88:89], v19 offset:0
ds_read_b64_tr_b16 a[90:91], v19 offset:2048
M v[96:99], a[96:99], a[176:179], v[96:99]
s_add_u32 s24, s24, 262144
s_cmp_eq_u32 s24, s27
s_cselect_b32 s24, s28, s24
s_sub_u32 s6, s6, 1
s_cmp_eq_u32 s6, 0
s_cselect_b64 s[12:13], s[64:65], s[12:13]
M v[96:99], a[100:103], a[180:183], v[96:99]
M v[100:103], a[108:111], a[180:183], v[100:103]
M v[100:103], a[104:107], a[176:179], v[100:103]
M v[104:107], a[112:115], a[176:179], v[104:107]
M v[104:107], a[116:119], a[180:183], v[104:107]
M v[108:111], a[124:127], a[180:183], v[108:111]
M v[108:111], a[120:123], a[176:179], v[108:111]
s_waitcnt vmcnt(16) lgkmcnt(0)
s_barrier
ds_read_b128 a[160:163], v10 offset:49152
ds_read_b128 a[164:167], v11 offset:49152
M v[112:115], a[128:131], a[176:179], v[112:115]
s_add_u32 m0, s29, 32768
s_nop 0
buffer_load_dwordx4 v2, s[8:11], s23 offen offset:0 lds
M v[112:115], a[132:135], a[180:183], v[112:115]
M v[116:119], a[140:143], a[180:183], v[116:119]
M v[116:119], a[136:139], a[176:179], v[116:119]
ds_read_b64_tr_b16 a[36:37], v12 offset:16384
ds_read_b64_tr_b16 a[38:39], v12 offset:18432
M v[120:123], a[144:147], a[176:179], v[120:123]
M v[120:123], a[148:151], a[180:183], v[120:123]
M v[124:127], a[156:159], a[180:183], v[124:127]
buffer_load_dwordx4 v3, s[8:11], s23 offen offset:1024 lds
M v[124:127], a[152:155], a[176:179], v[124:127]
M v[128:131], a[96:99], a[184:187], v[128:131]
M v[128:131], a[100:103], a[188:191], v[128:131]
ds_read_b128 a[168:171], v10 offset:51200
ds_read_b128 a[172:175], v11 offset:51200
ds_read_b64_tr_b16 a[44:45], v13 offset:16384
ds_read_b64_tr_b16 a[46:47], v13 offset:18432
M v[132:135], a[108:111], a[188:191], v[132:135]
M v[132:135], a[104:107], a[184:187], v[132:135]
M v[136:139], a[112:115], a[184:187], v[136:139]
M v[136:139], a[116:119], a[188:191], v[136:139]
buffer_load_dwordx4 v4, s[8:11], s23 offen offset:2048 lds
M v[140:143], a[124:127], a[188:191], v[140:143]
M v[140:143], a[120:123], a[184:187], v[140:143]
ds_read_b64_tr_b16 a[52:53], v14 offset:16384
ds_read_b64_tr_b16 a[54:55], v14 offset:18432
M v[144:147], a[128:131], a[184:187], v[144:147]
M v[144:147], a[132:135], a[188:191], v[144:147]
M v[148:151], a[140:143], a[188:191], v[148:151]
M v[148:151], a[136:139], a[184:187], v[148:151]
M v[152:155], a[144:147], a[184:187], v[152:155]
buffer_load_dwordx4 v5, s[8:11], s23 offen offset:3072 lds
M v[152:155], a[148:151], a[188:191], v[152:155]
ds_read_b64_tr_b16 a[60:61], v15 offset:16384
ds_read_b64_tr_b16 a[62:63], v15 offset:18432
M v[156:159], a[156:159], a[188:191], v[156:159]
M v[156:159], a[152:155], a[184:187], v[156:159]
s_waitcnt lgkmcnt(10)
M v[160:163], a[96:99], a[160:163], v[160:163]
M v[160:163], a[100:103], a[164:167], v[160:163]
ds_read_b128 a[176:179], v10 offset:53248
ds_read_b128 a[180:183], v11 offset:53248
M v[164:167], a[108:111], a[164:167], v[164:167]
M v[164:167], a[104:107], a[160:163], v[164:167]
ds_read_b64_tr_b16 a[68:69], v16 offset:16384
ds_read_b64_tr_b16 a[70:71], v16 offset:18432
M v[168:171], a[112:115], a[160:163], v[168:171]
M v[168:171], a[116:119], a[164:167], v[168:171]
s_add_u32 m0, s29, 65536
s_nop 0
buffer_load_dwordx4 v6, s[12:15], s24 offen offset:0 lds
M v[172:175], a[124:127], a[164:167], v[172:175]
M v[172:175], a[120:123], a[160:163], v[172:175]
M v[176:179], a[128:131], a[160:163], v[176:179]
M v[176:179], a[132:135], a[164:167], v[176:179]
ds_read_b64_tr_b16 a[76:77], v17 offset:16384
ds_read_b64_tr_b16 a[78:79], v17 offset:18432
M v[180:183], a[140:143], a[164:167], v[180:183]
M v[180:183], a[136:139], a[160:163], v[180:183]
buffer_load_dwordx4 v7, s[12:15], s24 offen offset:1024 lds
M v[184:187], a[144:147], a[160:163], v[184:187]
M v[184:187], a[148:151], a[164:167], v[184:187]
M v[188:191], a[156:159], a[164:167], v[188:191]
M v[188:191], a[152:155], a[160:163], v[188:191]
s_waitcnt lgkmcnt(12)
ds_read_b64_tr_b16 a[84:85], v18 offset:16384
ds_read_b64_tr_b16 a[86:87], v18 offset:18432
M v[192:195], a[96:99], a[168:171], v[192:195]
M v[192:195], a[100:103], a[172:175], v[192:195]
ds_read_b128 a[184:187], v10 offset:55296
ds_read_b128 a[188:191], v11 offset:55296
M v[196:199], a[108:111], a[172:175], v[196:199]
M v[196:199], a[104:107], a[168:171], v[196:199]
buffer_load_dwordx4 v8, s[12:15], s24 offen offset:2048 lds
M v[200:203], a[112:115], a[168:171], v[200:203]
M v[200:203], a[116:119], a[172:175], v[200:203]
ds_read_b64_tr_b16 a[92:93], v19 offset:16384
ds_read_b64_tr_b16 a[94:95], v19 offset:18432
M v[204:207], a[124:127], a[172:175], v[204:207]
M v[204:207], a[120:123], a[168:171], v[204:207]
M v[208:211], a[128:131], a[168:171], v[208:211]
M v[208:211], a[132:135], a[172:175], v[208:211]
buffer_load_dwordx4 v9, s[12:15], s24 offen offset:3072 lds
M v[212:215], a[140:143], a[172:175], v[212:215]
M v[212:215], a[136:139], a[168:171], v[212:215]
M v[216:219], a[144:147], a[168:171], v[216:219]
M v[216:219], a[148:151], a[172:175], v[216:219]
M v[220:223], a[156:159], a[172:175], v[220:223]
s_add_u32 s24, s24, 262144
M v[220:223], a[152:155], a[168:171], v[220:223]
s_waitcnt lgkmcnt(10)
M v[224:227], a[96:99], a[176:179], v[224:227]
M v[224:227], a[100:103], a[180:183], v[224:227]
M v[228:231], a[108:111], a[180:183], v[228:231]
M v[228:231], a[104:107], a[176:179], v[228:231]
M v[232:235], a[112:115], a[176:179], v[232:235]
M v[232:235], a[116:119], a[180:183], v[232:235]
M v[236:239], a[124:127], a[180:183], v[236:239]
M v[236:239], a[120:123], a[176:179], v[236:239]
s_waitcnt vmcnt(16) lgkmcnt(0)
s_barrier
ds_read_b128 a[160:163], v10 offset:0
ds_read_b128 a[164:167], v11 offset:0
M v[240:243], a[128:131], a[176:179], v[240:243]
s_add_u32 m0, s29, 49152
s_add_u32 s3, s23, s31
buffer_load_dwordx4 v2, s[8:11], s3 offen offset:0 lds
M v[240:243], a[132:135], a[180:183], v[240:243]
M v[244:247], a[140:143], a[180:183], v[244:247]
M v[244:247], a[136:139], a[176:179], v[244:247]
M v[248:251], a[144:147], a[176:179], v[248:251]
M v[248:251], a[148:151], a[180:183], v[248:251]
buffer_load_dwordx4 v3, s[8:11], s3 offen offset:1024 lds
M v[252:255], a[156:159], a[180:183], v[252:255]
M v[252:255], a[152:155], a[176:179], v[252:255]
M a[0:3], a[96:99], a[184:187], a[0:3]
M a[0:3], a[100:103], a[188:191], a[0:3]
ds_read_b128 a[168:171], v10 offset:2048
ds_read_b128 a[172:175], v11 offset:2048
M a[4:7], a[108:111], a[188:191], a[4:7]
M a[4:7], a[104:107], a[184:187], a[4:7]
M a[8:11], a[112:115], a[184:187], a[8:11]
buffer_load_dwordx4 v4, s[8:11], s3 offen offset:2048 lds
M a[8:11], a[116:119], a[188:191], a[8:11]
M a[12:15], a[124:127], a[188:191], a[12:15]
M a[12:15], a[120:123], a[184:187], a[12:15]
M a[16:19], a[128:131], a[184:187], a[16:19]
M a[16:19], a[132:135], a[188:191], a[16:19]
buffer_load_dwordx4 v5, s[8:11], s3 offen offset:3072 lds
M a[20:23], a[140:143], a[188:191], a[20:23]
M a[20:23], a[136:139], a[184:187], a[20:23]
M a[24:27], a[144:147], a[184:187], a[24:27]
M a[24:27], a[148:151], a[188:191], a[24:27]
M a[28:31], a[156:159], a[188:191], a[28:31]
M a[28:31], a[152:155], a[184:187], a[28:31]
s_waitcnt lgkmcnt(2)
s_mov_b32 s30, 2
Lk1_kl:
M v[32:35], a[32:35], a[160:163], v[32:35]
s_add_u32 s23, s23, 128
s_cmp_eq_u32 s23, s25
s_cselect_b32 s23, s26, s23
M v[32:35], a[36:39], a[164:167], v[32:35]
ds_read_b128 a[176:179], v10 offset:4096
ds_read_b128 a[180:183], v11 offset:4096
M v[36:39], a[44:47], a[164:167], v[36:39]
M v[36:39], a[40:43], a[160:163], v[36:39]
ds_read_b64_tr_b16 a[96:97], v12 offset:32768
ds_read_b64_tr_b16 a[98:99], v12 offset:34816
M v[40:43], a[48:51], a[160:163], v[40:43]
M v[40:43], a[52:55], a[164:167], v[40:43]
M v[44:47], a[60:63], a[164:167], v[44:47]
s_add_u32 m0, s29, 81920
s_nop 0
buffer_load_dwordx4 v6, s[12:15], s24 offen offset:0 lds
M v[44:47], a[56:59], a[160:163], v[44:47]
ds_read_b64_tr_b16 a[104:105], v13 offset:32768
ds_read_b64_tr_b16 a[106:107], v13 offset:34816
M v[48:51], a[64:67], a[160:163], v[48:51]
M v[48:51], a[68:71], a[164:167], v[48:51]
M v[52:55], a[76:79], a[164:167], v[52:55]
M v[52:55], a[72:75], a[160:163], v[52:55]
ds_read_b64_tr_b16 a[112:113], v14 offset:32768
ds_read_b64_tr_b16 a[114:115], v14 offset:34816
M v[56:59], a[80:83], a[160:163], v[56:59]
M v[56:59], a[84:87], a[164:167], v[56:59]
buffer_load_dwordx4 v7, s[12:15], s24 offen offset:1024 lds
M v[60:63], a[92:95], a[164:167], v[60:63]
M v[60:63], a[88:91], a[160:163], v[60:63]
s_waitcnt lgkmcnt(8)
ds_read_b64_tr_b16 a[120:121], v15 offset:32768
ds_read_b64_tr_b16 a[122:123], v15 offset:34816
M v[64:67], a[32:35], a[168:171], v[64:67]
M v[64:67], a[36:39], a[172:175], v[64:67]
ds_read_b128 a[184:187], v10 offset:6144
ds_read_b128 a[188:191], v11 offset:6144
M v[68:71], a[44:47], a[172:175], v[68:71]
M v[68:71], a[40:43], a[168:171], v[68:71]
ds_read_b64_tr_b16 a[128:129], v16 offset:32768
ds_read_b64_tr_b16 a[130:131], v16 offset:34816
M v[72:75], a[48:51], a[168:171], v[72:75]
buffer_load_dwordx4 v8, s[12:15], s24 offen offset:2048 lds
M v[72:75], a[52:55], a[172:175], v[72:75]
M v[76:79], a[60:63], a[172:175], v[76:79]
M v[76:79], a[56:59], a[168:171], v[76:79]
ds_read_b64_tr_b16 a[136:137], v17 offset:32768
ds_read_b64_tr_b16 a[138:139], v17 offset:34816
M v[80:83], a[64:67], a[168:171], v[80:83]
M v[80:83], a[68:71], a[172:175], v[80:83]
M v[84:87], a[76:79], a[172:175], v[84:87]
buffer_load_dwordx4 v9, s[12:15], s24 offen offset:3072 lds
M v[84:87], a[72:75], a[168:171], v[84:87]
ds_read_b64_tr_b16 a[144:145], v18 offset:32768
ds_read_b64_tr_b16 a[146:147], v18 offset:34816
M v[88:91], a[80:83], a[168:171], v[88:91]
M v[88:91], a[84:87], a[172:175], v[88:91]
M v[92:95], a[92:95], a[172:175], v[92:95]
M v[92:95], a[88:91], a[168:171], v[92:95]
s_waitcnt lgkmcnt(15)
ds_read_b64_tr_b16 a[152:153], v19 offset:32768
ds_read_b64_tr_b16 a[154:155], v19 offset:34816
M v[96:99], a[32:35], a[176:179], v[96:99]
s_add_u32 s24, s24, 262144
s_cmp_eq_u32 s24, s27
s_cselect_b32 s24, s28, s24
s_sub_u32 s6, s6, 1
s_cmp_eq_u32 s6, 0
s_cselect_b64 s[12:13], s[64:65], s[12:13]
M v[96:99], a[36:39], a[180:183], v[96:99]
M v[100:103], a[44:47], a[180:183], v[100:103]
M v[100:103], a[40:43], a[176:179], v[100:103]
M v[104:107], a[48:51], a[176:179], v[104:107]
M v[104:107], a[52:55], a[180:183], v[104:107]
M v[108:111], a[60:63], a[180:183], v[108:111]
M v[108:111], a[56:59], a[176:179], v[108:111]
s_waitcnt vmcnt(16) lgkmcnt(0)
s_barrier
ds_read_b128 a[160:163], v10 offset:16384
ds_read_b128 a[164:167], v11 offset:16384
M v[112:115], a[64:67], a[176:179], v[112:115]
s_add_u32 m0, s29, 0
s_nop 0
buffer_load_dwordx4 v2, s[8:11], s23 offen offset:0 lds
M v[112:115], a[68:71], a[180:183], v[112:115]
M v[116:119], a[76:79], a[180:183], v[116:119]
M v[116:119], a[72:75], a[176:179], v[116:119]
ds_read_b64_tr_b16 a[100:101], v12 offset:49152
ds_read_b64_tr_b16 a[102:103], v12 offset:51200
M v[120:123], a[80:83], a[176:179], v[120:123]
M v[120:123], a[84:87], a[180:183], v[120:123]
M v[124:127], a[92:95], a[180:183], v[124:127]
buffer_load_dwordx4 v3, s[8:11], s23 offen offset:1024 lds
M v[124:127], a[88:91], a[176:179], v[124:127]
M v[128:131], a[32:35], a[184:187], v[128:131]
M v[128:131], a[36:39], a[188:191], v[128:131]
ds_read_b128 a[168:171], v10 offset:18432
ds_read_b128 a[172:175], v11 offset:18432
ds_read_b64_tr_b16 a[108:109], v13 offset:49152
ds_read_b64_tr_b16 a[110:111], v13 offset:51200
M v[132:135], a[44:47], a[188:191], v[132:135]
M v[132:135], a[40:43], a[184:187], v[132:135]
M v[136:139], a[48:51], a[184:187], v[136:139]
M v[136:139], a[52:55], a[188:191], v[136:139]
buffer_load_dwordx4 v4, s[8:11], s23 offen offset:2048 lds
M v[140:143], a[60:63], a[188:191], v[140:143]
M v[140:143], a[56:59], a[184:187], v[140:143]
ds_read_b64_tr_b16 a[116:117], v14 offset:49152
ds_read_b64_tr_b16 a[118:119], v14 offset:51200
M v[144:147], a[64:67], a[184:187], v[144:147]
M v[144:147], a[68:71], a[188:191], v[144:147]
M v[148:151], a[76:79], a[188:191], v[148:151]
M v[148:151], a[72:75], a[184:187], v[148:151]
M v[152:155], a[80:83], a[184:187], v[152:155]
buffer_load_dwordx4 v5, s[8:11], s23 offen offset:3072 lds
M v[152:155], a[84:87], a[188:191], v[152:155]
ds_read_b64_tr_b16 a[124:125], v15 offset:49152
ds_read_b64_tr_b16 a[126:127], v15 offset:51200
M v[156:159], a[92:95], a[188:191], v[156:159]
M v[156:159], a[88:91], a[184:187], v[156:159]
s_waitcnt lgkmcnt(10)
M v[160:163], a[32:35], a[160:163], v[160:163]
M v[160:163], a[36:39], a[164:167], v[160:163]
ds_read_b128 a[176:179], v10 offset:20480
ds_read_b128 a[180:183], v11 offset:20480
M v[164:167], a[44:47], a[164:167], v[164:167]
M v[164:167], a[40:43], a[160:163], v[164:167]
ds_read_b64_tr_b16 a[132:133], v16 offset:49152
ds_read_b64_tr_b16 a[134:135], v16 offset:51200
M v[168:171], a[48:51], a[160:163], v[168:171]
M v[168:171], a[52:55], a[164:167], v[168:171]
s_add_u32 m0, s29, 98304
s_nop 0
buffer_load_dwordx4 v6, s[12:15], s24 offen offset:0 lds
M v[172:175], a[60:63], a[164:167], v[172:175]
M v[172:175], a[56:59], a[160:163], v[172:175]
M v[176:179], a[64:67], a[160:163], v[176:179]
M v[176:179], a[68:71], a[164:167], v[176:179]
ds_read_b64_tr_b16 a[140:141], v17 offset:49152
ds_read_b64_tr_b16 a[142:143], v17 offset:51200
M v[180:183], a[76:79], a[164:167], v[180:183]
M v[180:183], a[72:75], a[160:163], v[180:183]
buffer_load_dwordx4 v7, s[12:15], s24 offen offset:1024 lds
M v[184:187], a[80:83], a[160:163], v[184:187]
M v[184:187], a[84:87], a[164:167], v[184:187]
M v[188:191], a[92:95], a[164:167], v[188:191]
M v[188:191], a[88:91], a[160:163], v[188:191]
s_waitcnt lgkmcnt(12)
ds_read_b64_tr_b16 a[148:149], v18 offset:49152
ds_read_b64_tr_b16 a[150:151], v18 offset:51200
M v[192:195], a[32:35], a[168:171], v[192:195]
M v[192:195], a[36:39], a[172:175], v[192:195]
ds_read_b128 a[184:187], v10 offset:22528
ds_read_b128 a[188:191], v11 offset:22528
M v[196:199], a[44:47], a[172:175], v[196:199]
M v[196:199], a[40:43], a[168:171], v[196:199]
buffer_load_dwordx4 v8, s[12:15], s24 offen offset:2048 lds
M v[200:203], a[48:51], a[168:171], v[200:203]
M v[200:203], a[52:55], a[172:175], v[200:203]
ds_read_b64_tr_b16 a[156:157], v19 offset:49152
ds_read_b64_tr_b16 a[158:159], v19 offset:51200
M v[204:207], a[60:63], a[172:175], v[204:207]
M v[204:207], a[56:59], a[168:171], v[204:207]
M v[208:211], a[64:67], a[168:171], v[208:211]
M v[208:211], a[68:71], a[172:175], v[208:211]
buffer_load_dwordx4 v9, s[12:15], s24 offen offset:3072 lds
M v[212:215], a[76:79], a[172:175], v[212:215]
M v[212:215], a[72:75], a[168:171], v[212:215]
M v[216:219], a[80:83], a[168:171], v[216:219]
M v[216:219], a[84:87], a[172:175], v[216:219]
M v[220:223], a[92:95], a[172:175], v[220:223]
s_add_u32 s24, s24, 262144
M v[220:223], a[88:91], a[168:171], v[220:223]
s_waitcnt lgkmcnt(10)
M v[224:227], a[32:35], a[176:179], v[224:227]
M v[224:227], a[36:39], a[180:183], v[224:227]
M v[228:231], a[44:47], a[180:183], v[228:231]
M v[228:231], a[40:43], a[176:179], v[228:231]
M v[232:235], a[48:51], a[176:179], v[232:235]
M v[232:235], a[52:55], a[180:183], v[232:235]
M v[236:239], a[60:63], a[180:183], v[236:239]
M v[236:239], a[56:59], a[176:179], v[236:239]
s_waitcnt vmcnt(16) lgkmcnt(0)
s_barrier
ds_read_b128 a[160:163], v10 offset:32768
ds_read_b128 a[164:167], v11 offset:32768
M v[240:243], a[64:67], a[176:179], v[240:243]
s_add_u32 m0, s29, 16384
s_add_u32 s3, s23, s31
buffer_load_dwordx4 v2, s[8:11], s3 offen offset:0 lds
M v[240:243], a[68:71], a[180:183], v[240:243]
M v[244:247], a[76:79], a[180:183], v[244:247]
M v[244:247], a[72:75], a[176:179], v[244:247]
M v[248:251], a[80:83], a[176:179], v[248:251]
M v[248:251], a[84:87], a[180:183], v[248:251]
buffer_load_dwordx4 v3, s[8:11], s3 offen offset:1024 lds
M v[252:255], a[92:95], a[180:183], v[252:255]
M v[252:255], a[88:91], a[176:179], v[252:255]
M a[0:3], a[32:35], a[184:187], a[0:3]
M a[0:3], a[36:39], a[188:191], a[0:3]
ds_read_b128 a[168:171], v10 offset:34816
ds_read_b128 a[172:175], v11 offset:34816
M a[4:7], a[44:47], a[188:191], a[4:7]
M a[4:7], a[40:43], a[184:187], a[4:7]
M a[8:11], a[48:51], a[184:187], a[8:11]
buffer_load_dwordx4 v4, s[8:11], s3 offen offset:2048 lds
M a[8:11], a[52:55], a[188:191], a[8:11]
M a[12:15], a[60:63], a[188:191], a[12:15]
M a[12:15], a[56:59], a[184:187], a[12:15]
M a[16:19], a[64:67], a[184:187], a[16:19]
M a[16:19], a[68:71], a[188:191], a[16:19]
buffer_load_dwordx4 v5, s[8:11], s3 offen offset:3072 lds
M a[20:23], a[76:79], a[188:191], a[20:23]
M a[20:23], a[72:75], a[184:187], a[20:23]
M a[24:27], a[80:83], a[184:187], a[24:27]
M a[24:27], a[84:87], a[188:191], a[24:27]
M a[28:31], a[92:95], a[188:191], a[28:31]
M a[28:31], a[88:91], a[184:187], a[28:31]
s_waitcnt lgkmcnt(2)
M v[32:35], a[96:99], a[160:163], v[32:35]
s_add_u32 s23, s23, 128
s_cmp_eq_u32 s23, s25
s_cselect_b32 s23, s26, s23
M v[32:35], a[100:103], a[164:167], v[32:35]
ds_read_b128 a[176:179], v10 offset:36864
ds_read_b128 a[180:183], v11 offset:36864
M v[36:39], a[108:111], a[164:167], v[36:39]
M v[36:39], a[104:107], a[160:163], v[36:39]
ds_read_b64_tr_b16 a[32:33], v12 offset:0
ds_read_b64_tr_b16 a[34:35], v12 offset:2048
M v[40:43], a[112:115], a[160:163], v[40:43]
M v[40:43], a[116:119], a[164:167], v[40:43]
M v[44:47], a[124:127], a[164:167], v[44:47]
s_add_u32 m0, s29, 114688
s_nop 0
buffer_load_dwordx4 v6, s[12:15], s24 offen offset:0 lds
M v[44:47], a[120:123], a[160:163], v[44:47]
ds_read_b64_tr_b16 a[40:41], v13 offset:0
ds_read_b64_tr_b16 a[42:43], v13 offset:2048
M v[48:51], a[128:131], a[160:163], v[48:51]
M v[48:51], a[132:135], a[164:167], v[48:51]
M v[52:55], a[140:143], a[164:167], v[52:55]
M v[52:55], a[136:139], a[160:163], v[52:55]
ds_read_b64_tr_b16 a[48:49], v14 offset:0
ds_read_b64_tr_b16 a[50:51], v14 offset:2048
M v[56:59], a[144:147], a[160:163], v[56:59]
M v[56:59], a[148:151], a[164:167], v[56:59]
buffer_load_dwordx4 v7, s[12:15], s24 offen offset:1024 lds
M v[60:63], a[156:159], a[164:167], v[60:63]
M v[60:63], a[152:155], a[160:163], v[60:63]
s_waitcnt lgkmcnt(8)
ds_read_b64_tr_b16 a[56:57], v15 offset:0
ds_read_b64_tr_b16 a[58:59], v15 offset:2048
M v[64:67], a[96:99], a[168:171], v[64:67]
M v[64:67], a[100:103], a[172:175], v[64:67]
ds_read_b128 a[184:187], v10 offset:38912
ds_read_b128 a[188:191], v11 offset:38912
M v[68:71], a[108:111], a[172:175], v[68:71]
M v[68:71], a[104:107], a[168:171], v[68:71]
ds_read_b64_tr_b16 a[64:65], v16 offset:0
ds_read_b64_tr_b16 a[66:67], v16 offset:2048
M v[72:75], a[112:115], a[168:171], v[72:75]
buffer_load_dwordx4 v8, s[12:15], s24 offen offset:2048 lds
M v[72:75], a[116:119], a[172:175], v[72:75]
M v[76:79], a[124:127], a[172:175], v[76:79]
M v[76:79], a[120:123], a[168:171], v[76:79]
ds_read_b64_tr_b16 a[72:73], v17 offset:0
ds_read_b64_tr_b16 a[74:75], v17 offset:2048
M v[80:83], a[128:131], a[168:171], v[80:83]
M v[80:83], a[132:135], a[172:175], v[80:83]
M v[84:87], a[140:143], a[172:175], v[84:87]
buffer_load_dwordx4 v9, s[12:15], s24 offen offset:3072 lds
M v[84:87], a[136:139], a[168:171], v[84:87]
ds_read_b64_tr_b16 a[80:81], v18 offset:0
ds_read_b64_tr_b16 a[82:83], v18 offset:2048
M v[88:91], a[144:147], a[168:171], v[88:91]
M v[88:91], a[148:151], a[172:175], v[88:91]
M v[92:95], a[156:159], a[172:175], v[92:95]
M v[92:95], a[152:155], a[168:171], v[92:95]
s_waitcnt lgkmcnt(15)
ds_read_b64_tr_b16 a[88:89], v19 offset:0
ds_read_b64_tr_b16 a[90:91], v19 offset:2048
M v[96:99], a[96:99], a[176:179], v[96:99]
s_add_u32 s24, s24, 262144
s_cmp_eq_u32 s24, s27
s_cselect_b32 s24, s28, s24
s_sub_u32 s6, s6, 1
s_cmp_eq_u32 s6, 0
s_cselect_b64 s[12:13], s[64:65], s[12:13]
M v[96:99], a[100:103], a[180:183], v[96:99]
M v[100:103], a[108:111], a[180:183], v[100:103]
M v[100:103], a[104:107], a[176:179], v[100:103]
M v[104:107], a[112:115], a[176:179], v[104:107]
M v[104:107], a[116:119], a[180:183], v[104:107]
M v[108:111], a[124:127], a[180:183], v[108:111]
M v[108:111], a[120:123], a[176:179], v[108:111]
s_waitcnt vmcnt(16) lgkmcnt(0)
s_barrier
ds_read_b128 a[160:163], v10 offset:49152
ds_read_b128 a[164:167], v11 offset:49152
M v[112:115], a[128:131], a[176:179], v[112:115]
s_add_u32 m0, s29, 32768
s_nop 0
buffer_load_dwordx4 v2, s[8:11], s23 offen offset:0 lds
M v[112:115], a[132:135], a[180:183], v[112:115]
M v[116:119], a[140:143], a[180:183], v[116:119]
M v[116:119], a[136:139], a[176:179], v[116:119]
ds_read_b64_tr_b16 a[36:37], v12 offset:16384
ds_read_b64_tr_b16 a[38:39], v12 offset:18432
M v[120:123], a[144:147], a[176:179], v[120:123]
M v[120:123], a[148:151], a[180:183], v[120:123]
M v[124:127], a[156:159], a[180:183], v[124:127]
buffer_load_dwordx4 v3, s[8:11], s23 offen offset:1024 lds
M v[124:127], a[152:155], a[176:179], v[124:127]
M v[128:131], a[96:99], a[184:187], v[128:131]
M v[128:131], a[100:103], a[188:191], v[128:131]
ds_read_b128 a[168:171], v10 offset:51200
ds_read_b128 a[172:175], v11 offset:51200
ds_read_b64_tr_b16 a[44:45], v13 offset:16384
ds_read_b64_tr_b16 a[46:47], v13 offset:18432
M v[132:135], a[108:111], a[188:191], v[132:135]
M v[132:135], a[104:107], a[184:187], v[132:135]
M v[136:139], a[112:115], a[184:187], v[136:139]
M v[136:139], a[116:119], a[188:191], v[136:139]
buffer_load_dwordx4 v4, s[8:11], s23 offen offset:2048 lds
M v[140:143], a[124:127], a[188:191], v[140:143]
M v[140:143], a[120:123], a[184:187], v[140:143]
ds_read_b64_tr_b16 a[52:53], v14 offset:16384
ds_read_b64_tr_b16 a[54:55], v14 offset:18432
M v[144:147], a[128:131], a[184:187], v[144:147]
M v[144:147], a[132:135], a[188:191], v[144:147]
M v[148:151], a[140:143], a[188:191], v[148:151]
M v[148:151], a[136:139], a[184:187], v[148:151]
M v[152:155], a[144:147], a[184:187], v[152:155]
buffer_load_dwordx4 v5, s[8:11], s23 offen offset:3072 lds
M v[152:155], a[148:151], a[188:191], v[152:155]
ds_read_b64_tr_b16 a[60:61], v15 offset:16384
ds_read_b64_tr_b16 a[62:63], v15 offset:18432
M v[156:159], a[156:159], a[188:191], v[156:159]
M v[156:159], a[152:155], a[184:187], v[156:159]
s_waitcnt lgkmcnt(10)
M v[160:163], a[96:99], a[160:163], v[160:163]
M v[160:163], a[100:103], a[164:167], v[160:163]
ds_read_b128 a[176:179], v10 offset:53248
ds_read_b128 a[180:183], v11 offset:53248
M v[164:167], a[108:111], a[164:167], v[164:167]
M v[164:167], a[104:107], a[160:163], v[164:167]
ds_read_b64_tr_b16 a[68:69], v16 offset:16384
ds_read_b64_tr_b16 a[70:71], v16 offset:18432
M v[168:171], a[112:115], a[160:163], v[168:171]
M v[168:171], a[116:119], a[164:167], v[168:171]
s_add_u32 m0, s29, 65536
s_nop 0
buffer_load_dwordx4 v6, s[12:15], s24 offen offset:0 lds
M v[172:175], a[124:127], a[164:167], v[172:175]
M v[172:175], a[120:123], a[160:163], v[172:175]
M v[176:179], a[128:131], a[160:163], v[176:179]
M v[176:179], a[132:135], a[164:167], v[176:179]
ds_read_b64_tr_b16 a[76:77], v17 offset:16384
ds_read_b64_tr_b16 a[78:79], v17 offset:18432
M v[180:183], a[140:143], a[164:167], v[180:183]
M v[180:183], a[136:139], a[160:163], v[180:183]
buffer_load_dwordx4 v7, s[12:15], s24 offen offset:1024 lds
M v[184:187], a[144:147], a[160:163], v[184:187]
M v[184:187], a[148:151], a[164:167], v[184:187]
M v[188:191], a[156:159], a[164:167], v[188:191]
M v[188:191], a[152:155], a[160:163], v[188:191]
s_waitcnt lgkmcnt(12)
ds_read_b64_tr_b16 a[84:85], v18 offset:16384
ds_read_b64_tr_b16 a[86:87], v18 offset:18432
M v[192:195], a[96:99], a[168:171], v[192:195]
M v[192:195], a[100:103], a[172:175], v[192:195]
ds_read_b128 a[184:187], v10 offset:55296
ds_read_b128 a[188:191], v11 offset:55296
M v[196:199], a[108:111], a[172:175], v[196:199]
M v[196:199], a[104:107], a[168:171], v[196:199]
buffer_load_dwordx4 v8, s[12:15], s24 offen offset:2048 lds
M v[200:203], a[112:115], a[168:171], v[200:203]
M v[200:203], a[116:119], a[172:175], v[200:203]
ds_read_b64_tr_b16 a[92:93], v19 offset:16384
ds_read_b64_tr_b16 a[94:95], v19 offset:18432
M v[204:207], a[124:127], a[172:175], v[204:207]
M v[204:207], a[120:123], a[168:171], v[204:207]
M v[208:211], a[128:131], a[168:171], v[208:211]
M v[208:211], a[132:135], a[172:175], v[208:211]
buffer_load_dwordx4 v9, s[12:15], s24 offen offset:3072 lds
M v[212:215], a[140:143], a[172:175], v[212:215]
M v[212:215], a[136:139], a[168:171], v[212:215]
M v[216:219], a[144:147], a[168:171], v[216:219]
M v[216:219], a[148:151], a[172:175], v[216:219]
M v[220:223], a[156:159], a[172:175], v[220:223]
s_add_u32 s24, s24, 262144
M v[220:223], a[152:155], a[168:171], v[220:223]
s_waitcnt lgkmcnt(10)
M v[224:227], a[96:99], a[176:179], v[224:227]
M v[224:227], a[100:103], a[180:183], v[224:227]
M v[228:231], a[108:111], a[180:183], v[228:231]
M v[228:231], a[104:107], a[176:179], v[228:231]
M v[232:235], a[112:115], a[176:179], v[232:235]
M v[232:235], a[116:119], a[180:183], v[232:235]
M v[236:239], a[124:127], a[180:183], v[236:239]
M v[236:239], a[120:123], a[176:179], v[236:239]
s_waitcnt vmcnt(16) lgkmcnt(0)
s_barrier
ds_read_b128 a[160:163], v10 offset:0
ds_read_b128 a[164:167], v11 offset:0
M v[240:243], a[128:131], a[176:179], v[240:243]
s_add_u32 m0, s29, 49152
s_add_u32 s3, s23, s31
buffer_load_dwordx4 v2, s[8:11], s3 offen offset:0 lds
M v[240:243], a[132:135], a[180:183], v[240:243]
M v[244:247], a[140:143], a[180:183], v[244:247]
M v[244:247], a[136:139], a[176:179], v[244:247]
M v[248:251], a[144:147], a[176:179], v[248:251]
M v[248:251], a[148:151], a[180:183], v[248:251]
buffer_load_dwordx4 v3, s[8:11], s3 offen offset:1024 lds
M v[252:255], a[156:159], a[180:183], v[252:255]
M v[252:255], a[152:155], a[176:179], v[252:255]
M a[0:3], a[96:99], a[184:187], a[0:3]
M a[0:3], a[100:103], a[188:191], a[0:3]
ds_read_b128 a[168:171], v10 offset:2048
ds_read_b128 a[172:175], v11 offset:2048
M a[4:7], a[108:111], a[188:191], a[4:7]
M a[4:7], a[104:107], a[184:187], a[4:7]
M a[8:11], a[112:115], a[184:187], a[8:11]
buffer_load_dwordx4 v4, s[8:11], s3 offen offset:2048 lds
M a[8:11], a[116:119], a[188:191], a[8:11]
M a[12:15], a[124:127], a[188:191], a[12:15]
M a[12:15], a[120:123], a[184:187], a[12:15]
M a[16:19], a[128:131], a[184:187], a[16:19]
M a[16:19], a[132:135], a[188:191], a[16:19]
buffer_load_dwordx4 v5, s[8:11], s3 offen offset:3072 lds
M a[20:23], a[140:143], a[188:191], a[20:23]
M a[20:23], a[136:139], a[184:187], a[20:23]
M a[24:27], a[144:147], a[184:187], a[24:27]
M a[24:27], a[148:151], a[188:191], a[24:27]
M a[28:31], a[156:159], a[188:191], a[28:31]
M a[28:31], a[152:155], a[184:187], a[28:31]
s_waitcnt lgkmcnt(2)
s_sub_u32 s30, s30, 1
s_cmp_lg_u32 s30, 0
s_cbranch_scc1 Lk1_kl
M v[32:35], a[32:35], a[160:163], v[32:35]
s_add_u32 s23, s23, 128
s_cmp_eq_u32 s23, s25
s_cselect_b32 s23, s26, s23
M v[32:35], a[36:39], a[164:167], v[32:35]
ds_read_b128 a[176:179], v10 offset:4096
ds_read_b128 a[180:183], v11 offset:4096
M v[36:39], a[44:47], a[164:167], v[36:39]
M v[36:39], a[40:43], a[160:163], v[36:39]
ds_read_b64_tr_b16 a[96:97], v12 offset:32768
ds_read_b64_tr_b16 a[98:99], v12 offset:34816
M v[40:43], a[48:51], a[160:163], v[40:43]
M v[40:43], a[52:55], a[164:167], v[40:43]
M v[44:47], a[60:63], a[164:167], v[44:47]
s_add_u32 m0, s29, 81920
s_nop 0
buffer_load_dwordx4 v6, s[12:15], s24 offen offset:0 lds
M v[44:47], a[56:59], a[160:163], v[44:47]
ds_read_b64_tr_b16 a[104:105], v13 offset:32768
ds_read_b64_tr_b16 a[106:107], v13 offset:34816
M v[48:51], a[64:67], a[160:163], v[48:51]
M v[48:51], a[68:71], a[164:167], v[48:51]
M v[52:55], a[76:79], a[164:167], v[52:55]
M v[52:55], a[72:75], a[160:163], v[52:55]
ds_read_b64_tr_b16 a[112:113], v14 offset:32768
ds_read_b64_tr_b16 a[114:115], v14 offset:34816
M v[56:59], a[80:83], a[160:163], v[56:59]
M v[56:59], a[84:87], a[164:167], v[56:59]
buffer_load_dwordx4 v7, s[12:15], s24 offen offset:1024 lds
M v[60:63], a[92:95], a[164:167], v[60:63]
M v[60:63], a[88:91], a[160:163], v[60:63]
s_waitcnt lgkmcnt(8)
ds_read_b64_tr_b16 a[120:121], v15 offset:32768
ds_read_b64_tr_b16 a[122:123], v15 offset:34816
M v[64:67], a[32:35], a[168:171], v[64:67]
M v[64:67], a[36:39], a[172:175], v[64:67]
ds_read_b128 a[184:187], v10 offset:6144
ds_read_b128 a[188:191], v11 offset:6144
M v[68:71], a[44:47], a[172:175], v[68:71]
M v[68:71], a[40:43], a[168:171], v[68:71]
ds_read_b64_tr_b16 a[128:129], v16 offset:32768
ds_read_b64_tr_b16 a[130:131], v16 offset:34816
M v[72:75], a[48:51], a[168:171], v[72:75]
buffer_load_dwordx4 v8, s[12:15], s24 offen offset:2048 lds
M v[72:75], a[52:55], a[172:175], v[72:75]
M v[76:79], a[60:63], a[172:175], v[76:79]
M v[76:79], a[56:59], a[168:171], v[76:79]
ds_read_b64_tr_b16 a[136:137], v17 offset:32768
ds_read_b64_tr_b16 a[138:139], v17 offset:34816
M v[80:83], a[64:67], a[168:171], v[80:83]
M v[80:83], a[68:71], a[172:175], v[80:83]
M v[84:87], a[76:79], a[172:175], v[84:87]
buffer_load_dwordx4 v9, s[12:15], s24 offen offset:3072 lds
M v[84:87], a[72:75], a[168:171], v[84:87]
ds_read_b64_tr_b16 a[144:145], v18 offset:32768
ds_read_b64_tr_b16 a[146:147], v18 offset:34816
M v[88:91], a[80:83], a[168:171], v[88:91]
M v[88:91], a[84:87], a[172:175], v[88:91]
M v[92:95], a[92:95], a[172:175], v[92:95]
M v[92:95], a[88:91], a[168:171], v[92:95]
s_waitcnt lgkmcnt(15)
ds_read_b64_tr_b16 a[152:153], v19 offset:32768
ds_read_b64_tr_b16 a[154:155], v19 offset:34816
M v[96:99], a[32:35], a[176:179], v[96:99]
s_add_u32 s24, s24, 262144
s_cmp_eq_u32 s24, s27
s_cselect_b32 s24, s28, s24
s_sub_u32 s6, s6, 1
s_cmp_eq_u32 s6, 0
s_cselect_b64 s[12:13], s[64:65], s[12:13]
M v[96:99], a[36:39], a[180:183], v[96:99]
M v[100:103], a[44:47], a[180:183], v[100:103]
M v[100:103], a[40:43], a[176:179], v[100:103]
M v[104:107], a[48:51], a[176:179], v[104:107]
M v[104:107], a[52:55], a[180:183], v[104:107]
M v[108:111], a[60:63], a[180:183], v[108:111]
M v[108:111], a[56:59], a[176:179], v[108:111]
s_waitcnt vmcnt(16) lgkmcnt(0)
s_barrier
ds_read_b128 a[160:163], v10 offset:16384
ds_read_b128 a[164:167], v11 offset:16384
M v[112:115], a[64:67], a[176:179], v[112:115]
s_add_u32 m0, s29, 0
s_nop 0
buffer_load_dwordx4 v2, s[8:11], s23 offen offset:0 lds
M v[112:115], a[68:71], a[180:183], v[112:115]
M v[116:119], a[76:79], a[180:183], v[116:119]
M v[116:119], a[72:75], a[176:179], v[116:119]
ds_read_b64_tr_b16 a[100:101], v12 offset:49152
ds_read_b64_tr_b16 a[102:103], v12 offset:51200
M v[120:123], a[80:83], a[176:179], v[120:123]
M v[120:123], a[84:87], a[180:183], v[120:123]
M v[124:127], a[92:95], a[180:183], v[124:127]
buffer_load_dwordx4 v3, s[8:11], s23 offen offset:1024 lds
M v[124:127], a[88:91], a[176:179], v[124:127]
M v[128:131], a[32:35], a[184:187], v[128:131]
M v[128:131], a[36:39], a[188:191], v[128:131]
ds_read_b128 a[168:171], v10 offset:18432
ds_read_b128 a[172:175], v11 offset:18432
ds_read_b64_tr_b16 a[108:109], v13 offset:49152
ds_read_b64_tr_b16 a[110:111], v13 offset:51200
M v[132:135], a[44:47], a[188:191], v[132:135]
M v[132:135], a[40:43], a[184:187], v[132:135]
M v[136:139], a[48:51], a[184:187], v[136:139]
M v[136:139], a[52:55], a[188:191], v[136:139]
buffer_load_dwordx4 v4, s[8:11], s23 offen offset:2048 lds
M v[140:143], a[60:63], a[188:191], v[140:143]
M v[140:143], a[56:59], a[184:187], v[140:143]
ds_read_b64_tr_b16 a[116:117], v14 offset:49152
ds_read_b64_tr_b16 a[118:119], v14 offset:51200
M v[144:147], a[64:67], a[184:187], v[144:147]
M v[144:147], a[68:71], a[188:191], v[144:147]
M v[148:151], a[76:79], a[188:191], v[148:151]
M v[148:151], a[72:75], a[184:187], v[148:151]
M v[152:155], a[80:83], a[184:187], v[152:155]
buffer_load_dwordx4 v5, s[8:11], s23 offen offset:3072 lds
s_lshr_b32 s3, s53, 7
s_add_u32 s3, s3, s22
M v[152:155], a[84:87], a[188:191], v[152:155]
ds_read_b64_tr_b16 a[124:125], v15 offset:49152
ds_read_b64_tr_b16 a[126:127], v15 offset:51200
s_lshl_b32 s3, s3, 5
s_lshr_b32 s19, s52, 6
M v[156:159], a[92:95], a[188:191], v[156:159]
s_add_u32 s3, s3, s19
s_lshl_b32 s19, s21, 1
M v[156:159], a[88:91], a[184:187], v[156:159]
s_waitcnt lgkmcnt(10)
s_add_u32 s3, s3, s19
s_lshl_b32 s92, s3, 15
M v[160:163], a[32:35], a[160:163], v[160:163]
s_add_u32 s93, s92, 32768
s_add_u32 s16, s50, 16777216
M v[160:163], a[36:39], a[164:167], v[160:163]
ds_read_b128 a[176:179], v10 offset:20480
ds_read_b128 a[180:183], v11 offset:20480
s_addc_u32 s17, s51, 0
s_mov_b32 s18, 33554432
M v[164:167], a[44:47], a[164:167], v[164:167]
s_mov_b32 s19, 0x00020000
M v[164:167], a[40:43], a[160:163], v[164:167]
ds_read_b64_tr_b16 a[132:133], v16 offset:49152
ds_read_b64_tr_b16 a[134:135], v16 offset:51200
M v[168:171], a[48:51], a[160:163], v[168:171]
M v[168:171], a[52:55], a[164:167], v[168:171]
s_add_u32 m0, s29, 98304
s_nop 0
buffer_load_dwordx4 v6, s[12:15], s24 offen offset:0 lds
M v[172:175], a[60:63], a[164:167], v[172:175]
M v[172:175], a[56:59], a[160:163], v[172:175]
M v[176:179], a[64:67], a[160:163], v[176:179]
M v[176:179], a[68:71], a[164:167], v[176:179]
ds_read_b64_tr_b16 a[140:141], v17 offset:49152
ds_read_b64_tr_b16 a[142:143], v17 offset:51200
M v[180:183], a[76:79], a[164:167], v[180:183]
M v[180:183], a[72:75], a[160:163], v[180:183]
buffer_load_dwordx4 v7, s[12:15], s24 offen offset:1024 lds
M v[184:187], a[80:83], a[160:163], v[184:187]
M v[184:187], a[84:87], a[164:167], v[184:187]
M v[188:191], a[92:95], a[164:167], v[188:191]
M v[188:191], a[88:91], a[160:163], v[188:191]
s_waitcnt lgkmcnt(12)
ds_read_b64_tr_b16 a[148:149], v18 offset:49152
ds_read_b64_tr_b16 a[150:151], v18 offset:51200
M v[192:195], a[32:35], a[168:171], v[192:195]
M v[192:195], a[36:39], a[172:175], v[192:195]
ds_read_b128 a[184:187], v10 offset:22528
ds_read_b128 a[188:191], v11 offset:22528
M v[196:199], a[44:47], a[172:175], v[196:199]
M v[196:199], a[40:43], a[168:171], v[196:199]
buffer_load_dwordx4 v8, s[12:15], s24 offen offset:2048 lds
M v[200:203], a[48:51], a[168:171], v[200:203]
M v[200:203], a[52:55], a[172:175], v[200:203]
ds_read_b64_tr_b16 a[156:157], v19 offset:49152
ds_read_b64_tr_b16 a[158:159], v19 offset:51200
M v[204:207], a[60:63], a[172:175], v[204:207]
M v[204:207], a[56:59], a[168:171], v[204:207]
M v[208:211], a[64:67], a[168:171], v[208:211]
M v[208:211], a[68:71], a[172:175], v[208:211]
buffer_load_dwordx4 v9, s[12:15], s24 offen offset:3072 lds
M v[212:215], a[76:79], a[172:175], v[212:215]
M v[212:215], a[72:75], a[168:171], v[212:215]
M v[216:219], a[80:83], a[168:171], v[216:219]
M v[216:219], a[84:87], a[172:175], v[216:219]
M v[220:223], a[92:95], a[172:175], v[220:223]
s_add_u32 s24, s24, 262144
M v[220:223], a[88:91], a[168:171], v[220:223]
s_waitcnt lgkmcnt(10)
M v[224:227], a[32:35], a[176:179], v[224:227]
M v[224:227], a[36:39], a[180:183], v[224:227]
M v[228:231], a[44:47], a[180:183], v[228:231]
M v[228:231], a[40:43], a[176:179], v[228:231]
M v[232:235], a[48:51], a[176:179], v[232:235]
M v[232:235], a[52:55], a[180:183], v[232:235]
M v[236:239], a[60:63], a[180:183], v[236:239]
M v[236:239], a[56:59], a[176:179], v[236:239]
s_waitcnt vmcnt(16) lgkmcnt(0)
s_barrier
ds_read_b128 a[160:163], v10 offset:32768
ds_read_b128 a[164:167], v11 offset:32768
M v[240:243], a[64:67], a[176:179], v[240:243]
s_add_u32 m0, s29, 16384
s_add_u32 s3, s23, s31
buffer_load_dwordx4 v2, s[8:11], s3 offen offset:0 lds
M v[240:243], a[68:71], a[180:183], v[240:243]
M v[244:247], a[76:79], a[180:183], v[244:247]
M v[244:247], a[72:75], a[176:179], v[244:247]
M v[248:251], a[80:83], a[176:179], v[248:251]
M v[248:251], a[84:87], a[180:183], v[248:251]
buffer_load_dwordx4 v3, s[8:11], s3 offen offset:1024 lds
M v[252:255], a[92:95], a[180:183], v[252:255]
M v[252:255], a[88:91], a[176:179], v[252:255]
M a[0:3], a[32:35], a[184:187], a[0:3]
M a[0:3], a[36:39], a[188:191], a[0:3]
ds_read_b128 a[168:171], v10 offset:34816
ds_read_b128 a[172:175], v11 offset:34816
M a[4:7], a[44:47], a[188:191], a[4:7]
M a[4:7], a[40:43], a[184:187], a[4:7]
M a[8:11], a[48:51], a[184:187], a[8:11]
buffer_load_dwordx4 v4, s[8:11], s3 offen offset:2048 lds
M a[8:11], a[52:55], a[188:191], a[8:11]
M a[12:15], a[60:63], a[188:191], a[12:15]
M a[12:15], a[56:59], a[184:187], a[12:15]
M a[16:19], a[64:67], a[184:187], a[16:19]
M a[16:19], a[68:71], a[188:191], a[16:19]
buffer_load_dwordx4 v5, s[8:11], s3 offen offset:3072 lds
M a[20:23], a[76:79], a[188:191], a[20:23]
M a[20:23], a[72:75], a[184:187], a[20:23]
M a[24:27], a[80:83], a[184:187], a[24:27]
M a[24:27], a[84:87], a[188:191], a[24:27]
M a[28:31], a[92:95], a[188:191], a[28:31]
M a[28:31], a[88:91], a[184:187], a[28:31]
s_waitcnt lgkmcnt(2)
M v[32:35], a[96:99], a[160:163], v[32:35]
s_add_u32 s23, s23, 128
s_cmp_eq_u32 s23, s25
s_cselect_b32 s23, s26, s23
M v[32:35], a[100:103], a[164:167], v[32:35]
ds_read_b128 a[176:179], v10 offset:36864
ds_read_b128 a[180:183], v11 offset:36864
M v[36:39], a[108:111], a[164:167], v[36:39]
M v[36:39], a[104:107], a[160:163], v[36:39]
ds_read_b64_tr_b16 a[32:33], v12 offset:0
ds_read_b64_tr_b16 a[34:35], v12 offset:2048
M v[40:43], a[112:115], a[160:163], v[40:43]
M v[40:43], a[116:119], a[164:167], v[40:43]
M v[44:47], a[124:127], a[164:167], v[44:47]
s_add_u32 m0, s29, 114688
s_nop 0
buffer_load_dwordx4 v6, s[12:15], s24 offen offset:0 lds
M v[44:47], a[120:123], a[160:163], v[44:47]
ds_read_b64_tr_b16 a[40:41], v13 offset:0
ds_read_b64_tr_b16 a[42:43], v13 offset:2048
M v[48:51], a[128:131], a[160:163], v[48:51]
M v[48:51], a[132:135], a[164:167], v[48:51]
M v[52:55], a[140:143], a[164:167], v[52:55]
M v[52:55], a[136:139], a[160:163], v[52:55]
ds_read_b64_tr_b16 a[48:49], v14 offset:0
ds_read_b64_tr_b16 a[50:51], v14 offset:2048
M v[56:59], a[144:147], a[160:163], v[56:59]
buffer_load_dwordx4 v7, s[12:15], s24 offen offset:1024 lds
M v[56:59], a[148:151], a[164:167], v[56:59]
M v[60:63], a[156:159], a[164:167], v[60:63]
M v[60:63], a[152:155], a[160:163], v[60:63]
s_waitcnt lgkmcnt(8)
ds_read_b64_tr_b16 a[56:57], v15 offset:0
ds_read_b64_tr_b16 a[58:59], v15 offset:2048
M v[64:67], a[96:99], a[168:171], v[64:67]
M v[64:67], a[100:103], a[172:175], v[64:67]
ds_read_b128 a[184:187], v10 offset:38912
ds_read_b128 a[188:191], v11 offset:38912
M v[68:71], a[108:111], a[172:175], v[68:71]
M v[68:71], a[104:107], a[168:171], v[68:71]
ds_read_b64_tr_b16 a[64:65], v16 offset:0
ds_read_b64_tr_b16 a[66:67], v16 offset:2048
v_cvt_pk_bf16_f32 v32, v32, v33
v_cvt_pk_bf16_f32 v33, v34, v35
M v[72:75], a[112:115], a[168:171], v[72:75]
buffer_load_dwordx4 v8, s[12:15], s24 offen offset:2048 lds
v_cvt_pk_bf16_f32 v34, v36, v37
v_cvt_pk_bf16_f32 v35, v38, v39
M v[72:75], a[116:119], a[172:175], v[72:75]
v_cvt_pk_bf16_f32 v40, v40, v41
v_cvt_pk_bf16_f32 v41, v42, v43
M v[76:79], a[124:127], a[172:175], v[76:79]
v_cvt_pk_bf16_f32 v42, v44, v45
v_cvt_pk_bf16_f32 v43, v46, v47
M v[76:79], a[120:123], a[168:171], v[76:79]
ds_read_b64_tr_b16 a[72:73], v17 offset:0
ds_read_b64_tr_b16 a[74:75], v17 offset:2048
v_cvt_pk_bf16_f32 v48, v48, v49
v_cvt_pk_bf16_f32 v49, v50, v51
M v[80:83], a[128:131], a[168:171], v[80:83]
v_cvt_pk_bf16_f32 v50, v52, v53
v_cvt_pk_bf16_f32 v51, v54, v55
M v[80:83], a[132:135], a[172:175], v[80:83]
buffer_load_dwordx4 v9, s[12:15], s24 offen offset:3072 lds
v_cvt_pk_bf16_f32 v56, v56, v57
v_cvt_pk_bf16_f32 v57, v58, v59
M v[84:87], a[140:143], a[172:175], v[84:87]
v_cvt_pk_bf16_f32 v58, v60, v61
v_cvt_pk_bf16_f32 v59, v62, v63
M v[84:87], a[136:139], a[168:171], v[84:87]
ds_read_b64_tr_b16 a[80:81], v18 offset:0
ds_read_b64_tr_b16 a[82:83], v18 offset:2048
M v[88:91], a[144:147], a[168:171], v[88:91]
M v[88:91], a[148:151], a[172:175], v[88:91]
M v[92:95], a[156:159], a[172:175], v[92:95]
s_add_u32 s94, s92, 0
buffer_store_dwordx4 v[32:35], v1, s[16:19], s94 offen offset:0 sc1
M v[92:95], a[152:155], a[168:171], v[92:95]
s_waitcnt lgkmcnt(15)
ds_read_b64_tr_b16 a[88:89], v19 offset:0
ds_read_b64_tr_b16 a[90:91], v19 offset:2048
M v[96:99], a[96:99], a[176:179], v[96:99]
s_add_u32 s24, s24, 262144
s_cmp_eq_u32 s24, s27
s_cselect_b32 s24, s28, s24
s_sub_u32 s6, s6, 1
s_cmp_eq_u32 s6, 0
s_cselect_b64 s[12:13], s[64:65], s[12:13]
M v[96:99], a[100:103], a[180:183], v[96:99]
M v[100:103], a[108:111], a[180:183], v[100:103]
M v[100:103], a[104:107], a[176:179], v[100:103]
v_cvt_pk_bf16_f32 v64, v64, v65
v_cvt_pk_bf16_f32 v65, v66, v67
M v[104:107], a[112:115], a[176:179], v[104:107]
v_cvt_pk_bf16_f32 v66, v68, v69
v_cvt_pk_bf16_f32 v67, v70, v71
M v[104:107], a[116:119], a[180:183], v[104:107]
s_add_u32 s94, s92, 0
buffer_store_dwordx4 v[40:43], v1, s[16:19], s94 offen offset:1024 sc1
v_cvt_pk_bf16_f32 v72, v72, v73
v_cvt_pk_bf16_f32 v73, v74, v75
M v[108:111], a[124:127], a[180:183], v[108:111]
v_cvt_pk_bf16_f32 v74, v76, v77
v_cvt_pk_bf16_f32 v75, v78, v79
M v[108:111], a[120:123], a[176:179], v[108:111]
s_waitcnt vmcnt(18) lgkmcnt(0)
s_barrier
ds_read_b128 a[160:163], v10 offset:49152
ds_read_b128 a[164:167], v11 offset:49152
v_cvt_pk_bf16_f32 v80, v80, v81
v_cvt_pk_bf16_f32 v81, v82, v83
M v[112:115], a[128:131], a[176:179], v[112:115]
s_add_u32 m0, s29, 32768
s_nop 0
buffer_load_dwordx4 v2, s[8:11], s23 offen offset:0 lds
v_cvt_pk_bf16_f32 v82, v84, v85
v_cvt_pk_bf16_f32 v83, v86, v87
M v[112:115], a[132:135], a[180:183], v[112:115]
v_cvt_pk_bf16_f32 v88, v88, v89
v_cvt_pk_bf16_f32 v89, v90, v91
M v[116:119], a[140:143], a[180:183], v[116:119]
v_cvt_pk_bf16_f32 v90, v92, v93
v_cvt_pk_bf16_f32 v91, v94, v95
M v[116:119], a[136:139], a[176:179], v[116:119]
ds_read_b64_tr_b16 a[36:37], v12 offset:16384
ds_read_b64_tr_b16 a[38:39], v12 offset:18432
M v[120:123], a[144:147], a[176:179], v[120:123]
s_add_u32 s94, s92, 0
buffer_store_dwordx4 v[48:51], v1, s[16:19], s94 offen offset:2048 sc1
M v[120:123], a[148:151], a[180:183], v[120:123]
M v[124:127], a[156:159], a[180:183], v[124:127]
buffer_load_dwordx4 v3, s[8:11], s23 offen offset:1024 lds
M v[124:127], a[152:155], a[176:179], v[124:127]
M v[128:131], a[96:99], a[184:187], v[128:131]
M v[128:131], a[100:103], a[188:191], v[128:131]
ds_read_b128 a[168:171], v10 offset:51200
ds_read_b128 a[172:175], v11 offset:51200
ds_read_b64_tr_b16 a[44:45], v13 offset:16384
ds_read_b64_tr_b16 a[46:47], v13 offset:18432
M v[132:135], a[108:111], a[188:191], v[132:135]
M v[132:135], a[104:107], a[184:187], v[132:135]
s_add_u32 s94, s92, 0
buffer_store_dwordx4 v[56:59], v1, s[16:19], s94 offen offset:3072 sc1
v_cvt_pk_bf16_f32 v96, v96, v97
v_cvt_pk_bf16_f32 v97, v98, v99
M v[136:139], a[112:115], a[184:187], v[136:139]
v_cvt_pk_bf16_f32 v98, v100, v101
v_cvt_pk_bf16_f32 v99, v102, v103
M v[136:139], a[116:119], a[188:191], v[136:139]
buffer_load_dwordx4 v4, s[8:11], s23 offen offset:2048 lds
v_cvt_pk_bf16_f32 v104, v104, v105
v_cvt_pk_bf16_f32 v105, v106, v107
M v[140:143], a[124:127], a[188:191], v[140:143]
v_cvt_pk_bf16_f32 v106, v108, v109
v_cvt_pk_bf16_f32 v107, v110, v111
M v[140:143], a[120:123], a[184:187], v[140:143]
ds_read_b64_tr_b16 a[52:53], v14 offset:16384
ds_read_b64_tr_b16 a[54:55], v14 offset:18432
v_cvt_pk_bf16_f32 v112, v112, v113
v_cvt_pk_bf16_f32 v113, v114, v115
M v[144:147], a[128:131], a[184:187], v[144:147]
v_cvt_pk_bf16_f32 v114, v116, v117
v_cvt_pk_bf16_f32 v115, v118, v119
M v[144:147], a[132:135], a[188:191], v[144:147]
v_cvt_pk_bf16_f32 v120, v120, v121
v_cvt_pk_bf16_f32 v121, v122, v123
M v[148:151], a[140:143], a[188:191], v[148:151]
s_add_u32 s94, s92, 4096
buffer_store_dwordx4 v[64:67], v1, s[16:19], s94 offen offset:0 sc1
v_cvt_pk_bf16_f32 v122, v124, v125
v_cvt_pk_bf16_f32 v123, v126, v127
M v[148:151], a[136:139], a[184:187], v[148:151]
M v[152:155], a[144:147], a[184:187], v[152:155]
buffer_load_dwordx4 v5, s[8:11], s23 offen offset:3072 lds
M v[152:155], a[148:151], a[188:191], v[152:155]
ds_read_b64_tr_b16 a[60:61], v15 offset:16384
ds_read_b64_tr_b16 a[62:63], v15 offset:18432
M v[156:159], a[156:159], a[188:191], v[156:159]
M v[156:159], a[152:155], a[184:187], v[156:159]
s_waitcnt lgkmcnt(10)
M v[160:163], a[96:99], a[160:163], v[160:163]
M v[160:163], a[100:103], a[164:167], v[160:163]
ds_read_b128 a[176:179], v10 offset:53248
ds_read_b128 a[180:183], v11 offset:53248
M v[164:167], a[108:111], a[164:167], v[164:167]
s_add_u32 s94, s92, 4096
buffer_store_dwordx4 v[72:75], v1, s[16:19], s94 offen offset:1024 sc1
M v[164:167], a[104:107], a[160:163], v[164:167]
ds_read_b64_tr_b16 a[68:69], v16 offset:16384
ds_read_b64_tr_b16 a[70:71], v16 offset:18432
v_cvt_pk_bf16_f32 v128, v128, v129
v_cvt_pk_bf16_f32 v129, v130, v131
M v[168:171], a[112:115], a[160:163], v[168:171]
v_cvt_pk_bf16_f32 v130, v132, v133
v_cvt_pk_bf16_f32 v131, v134, v135
M v[168:171], a[116:119], a[164:167], v[168:171]
s_add_u32 m0, s29, 65536
s_nop 0
buffer_load_dwordx4 v6, s[12:15], s24 offen offset:0 lds
v_cvt_pk_bf16_f32 v136, v136, v137
v_cvt_pk_bf16_f32 v137, v138, v139
M v[172:175], a[124:127], a[164:167], v[172:175]
v_cvt_pk_bf16_f32 v138, v140, v141
v_cvt_pk_bf16_f32 v139, v142, v143
M v[172:175], a[120:123], a[160:163], v[172:175]
v_cvt_pk_bf16_f32 v144, v144, v145
v_cvt_pk_bf16_f32 v145, v146, v147
M v[176:179], a[128:131], a[160:163], v[176:179]
s_add_u32 s94, s92, 4096
buffer_store_dwordx4 v[80:83], v1, s[16:19], s94 offen offset:2048 sc1
v_cvt_pk_bf16_f32 v146, v148, v149
v_cvt_pk_bf16_f32 v147, v150, v151
M v[176:179], a[132:135], a[164:167], v[176:179]
ds_read_b64_tr_b16 a[76:77], v17 offset:16384
ds_read_b64_tr_b16 a[78:79], v17 offset:18432
v_cvt_pk_bf16_f32 v152, v152, v153
v_cvt_pk_bf16_f32 v153, v154, v155
M v[180:183], a[140:143], a[164:167], v[180:183]
v_cvt_pk_bf16_f32 v154, v156, v157
v_cvt_pk_bf16_f32 v155, v158, v159
M v[180:183], a[136:139], a[160:163], v[180:183]
buffer_load_dwordx4 v7, s[12:15], s24 offen offset:1024 lds
M v[184:187], a[144:147], a[160:163], v[184:187]
M v[184:187], a[148:151], a[164:167], v[184:187]
M v[188:191], a[156:159], a[164:167], v[188:191]
M v[188:191], a[152:155], a[160:163], v[188:191]
s_waitcnt lgkmcnt(12)
ds_read_b64_tr_b16 a[84:85], v18 offset:16384
ds_read_b64_tr_b16 a[86:87], v18 offset:18432
M v[192:195], a[96:99], a[168:171], v[192:195]
s_add_u32 s94, s92, 4096
buffer_store_dwordx4 v[88:91], v1, s[16:19], s94 offen offset:3072 sc1
M v[192:195], a[100:103], a[172:175], v[192:195]
ds_read_b128 a[184:187], v10 offset:55296
ds_read_b128 a[188:191], v11 offset:55296
M v[196:199], a[108:111], a[172:175], v[196:199]
M v[196:199], a[104:107], a[168:171], v[196:199]
buffer_load_dwordx4 v8, s[12:15], s24 offen offset:2048 lds
v_cvt_pk_bf16_f32 v160, v160, v161
v_cvt_pk_bf16_f32 v161, v162, v163
M v[200:203], a[112:115], a[168:171], v[200:203]
v_cvt_pk_bf16_f32 v162, v164, v165
v_cvt_pk_bf16_f32 v163, v166, v167
M v[200:203], a[116:119], a[172:175], v[200:203]
ds_read_b64_tr_b16 a[92:93], v19 offset:16384
ds_read_b64_tr_b16 a[94:95], v19 offset:18432
v_cvt_pk_bf16_f32 v168, v168, v169
v_cvt_pk_bf16_f32 v169, v170, v171
M v[204:207], a[124:127], a[172:175], v[204:207]
s_add_u32 s94, s92, 8192
buffer_store_dwordx4 v[96:99], v1, s[16:19], s94 offen offset:0 sc1
v_cvt_pk_bf16_f32 v170, v172, v173
v_cvt_pk_bf16_f32 v171, v174, v175
M v[204:207], a[120:123], a[168:171], v[204:207]
v_cvt_pk_bf16_f32 v176, v176, v177
v_cvt_pk_bf16_f32 v177, v178, v179
M v[208:211], a[128:131], a[168:171], v[208:211]
v_cvt_pk_bf16_f32 v178, v180, v181
v_cvt_pk_bf16_f32 v179, v182, v183
M v[208:211], a[132:135], a[172:175], v[208:211]
buffer_load_dwordx4 v9, s[12:15], s24 offen offset:3072 lds
v_cvt_pk_bf16_f32 v184, v184, v185
v_cvt_pk_bf16_f32 v185, v186, v187
M v[212:215], a[140:143], a[172:175], v[212:215]
v_cvt_pk_bf16_f32 v186, v188, v189
v_cvt_pk_bf16_f32 v187, v190, v191
M v[212:215], a[136:139], a[168:171], v[212:215]
M v[216:219], a[144:147], a[168:171], v[216:219]
M v[216:219], a[148:151], a[172:175], v[216:219]
s_add_u32 s94, s92, 8192
buffer_store_dwordx4 v[104:107], v1, s[16:19], s94 offen offset:1024 sc1
M v[220:223], a[156:159], a[172:175], v[220:223]
s_add_u32 s24, s24, 262144
M v[220:223], a[152:155], a[168:171], v[220:223]
s_waitcnt lgkmcnt(10)
M v[224:227], a[96:99], a[176:179], v[224:227]
M v[224:227], a[100:103], a[180:183], v[224:227]
M v[228:231], a[108:111], a[180:183], v[228:231]
M v[228:231], a[104:107], a[176:179], v[228:231]
v_cvt_pk_bf16_f32 v192, v192, v193
v_cvt_pk_bf16_f32 v193, v194, v195
M v[232:235], a[112:115], a[176:179], v[232:235]
s_add_u32 s94, s92, 8192
buffer_store_dwordx4 v[112:115], v1, s[16:19], s94 offen offset:2048 sc1
v_cvt_pk_bf16_f32 v194, v196, v197
v_cvt_pk_bf16_f32 v195, v198, v199
M v[232:235], a[116:119], a[180:183], v[232:235]
v_cvt_pk_bf16_f32 v200, v200, v201
v_cvt_pk_bf16_f32 v201, v202, v203
M v[236:239], a[124:127], a[180:183], v[236:239]
v_cvt_pk_bf16_f32 v202, v204, v205
v_cvt_pk_bf16_f32 v203, v206, v207
M v[236:239], a[120:123], a[176:179], v[236:239]
s_waitcnt vmcnt(27) lgkmcnt(0)
s_barrier
ds_read_b128 a[160:163], v10 offset:0
ds_read_b128 a[164:167], v11 offset:0
v_cvt_pk_bf16_f32 v208, v208, v209
v_cvt_pk_bf16_f32 v209, v210, v211
M v[240:243], a[128:131], a[176:179], v[240:243]
s_add_u32 m0, s29, 49152
s_add_u32 s3, s23, s31
buffer_load_dwordx4 v2, s[8:11], s3 offen offset:0 lds
v_cvt_pk_bf16_f32 v210, v212, v213
v_cvt_pk_bf16_f32 v211, v214, v215
M v[240:243], a[132:135], a[180:183], v[240:243]
v_cvt_pk_bf16_f32 v216, v216, v217
v_cvt_pk_bf16_f32 v217, v218, v219
M v[244:247], a[140:143], a[180:183], v[244:247]
v_cvt_pk_bf16_f32 v218, v220, v221
v_cvt_pk_bf16_f32 v219, v222, v223
M v[244:247], a[136:139], a[176:179], v[244:247]
s_add_u32 s94, s92, 8192
buffer_store_dwordx4 v[120:123], v1, s[16:19], s94 offen offset:3072 sc1
M v[248:251], a[144:147], a[176:179], v[248:251]
M v[248:251], a[148:151], a[180:183], v[248:251]
buffer_load_dwordx4 v3, s[8:11], s3 offen offset:1024 lds
M v[252:255], a[156:159], a[180:183], v[252:255]
M v[252:255], a[152:155], a[176:179], v[252:255]
M a[0:3], a[96:99], a[184:187], a[0:3]
M a[0:3], a[100:103], a[188:191], a[0:3]
ds_read_b128 a[168:171], v10 offset:2048
ds_read_b128 a[172:175], v11 offset:2048
M a[4:7], a[108:111], a[188:191], a[4:7]
s_add_u32 s94, s92, 12288
buffer_store_dwordx4 v[128:131], v1, s[16:19], s94 offen offset:0 sc1
M a[4:7], a[104:107], a[184:187], a[4:7]
v_cvt_pk_bf16_f32 v224, v224, v225
v_cvt_pk_bf16_f32 v225, v226, v227
M a[8:11], a[112:115], a[184:187], a[8:11]
v_cvt_pk_bf16_f32 v226, v228, v229
v_cvt_pk_bf16_f32 v227, v230, v231
M a[8:11], a[116:119], a[188:191], a[8:11]
buffer_load_dwordx4 v4, s[8:11], s3 offen offset:2048 lds
v_cvt_pk_bf16_f32 v232, v232, v233
v_cvt_pk_bf16_f32 v233, v234, v235
M a[12:15], a[124:127], a[188:191], a[12:15]
v_cvt_pk_bf16_f32 v234, v236, v237
v_cvt_pk_bf16_f32 v235, v238, v239
M a[12:15], a[120:123], a[184:187], a[12:15]
v_cvt_pk_bf16_f32 v240, v240, v241
v_cvt_pk_bf16_f32 v241, v242, v243
M a[16:19], a[128:131], a[184:187], a[16:19]
v_cvt_pk_bf16_f32 v242, v244, v245
v_cvt_pk_bf16_f32 v243, v246, v247
M a[16:19], a[132:135], a[188:191], a[16:19]
s_add_u32 s94, s92, 12288
buffer_store_dwordx4 v[136:139], v1, s[16:19], s94 offen offset:1024 sc1
v_cvt_pk_bf16_f32 v248, v248, v249
v_cvt_pk_bf16_f32 v249, v250, v251
M a[20:23], a[140:143], a[188:191], a[20:23]
buffer_load_dwordx4 v5, s[8:11], s3 offen offset:3072 lds
v_cvt_pk_bf16_f32 v250, v252, v253
v_cvt_pk_bf16_f32 v251, v254, v255
M a[20:23], a[136:139], a[184:187], a[20:23]
M a[24:27], a[144:147], a[184:187], a[24:27]
M a[24:27], a[148:151], a[188:191], a[24:27]
M a[28:31], a[156:159], a[188:191], a[28:31]
M a[28:31], a[152:155], a[184:187], a[28:31]
s_waitcnt lgkmcnt(2)
M v[32:35], a[160:163], a[32:35], 0
s_add_u32 s94, s92, 12288
buffer_store_dwordx4 v[144:147], v1, s[16:19], s94 offen offset:2048 sc1
M v[32:35], a[164:167], a[36:39], v[32:35]
ds_read_b128 a[176:179], v10 offset:4096
ds_read_b128 a[180:183], v11 offset:4096
M v[36:39], a[164:167], a[44:47], 0
s_add_u32 s23, s23, 128
s_cmp_eq_u32 s23, s25
s_cselect_b32 s23, s26, s23
M v[36:39], a[160:163], a[40:43], v[36:39]
ds_read_b64_tr_b16 a[96:97], v12 offset:32768
ds_read_b64_tr_b16 a[98:99], v12 offset:34816
M v[40:43], a[160:163], a[48:51], 0
M v[40:43], a[164:167], a[52:55], v[40:43]
M v[44:47], a[164:167], a[60:63], 0
s_add_u32 m0, s29, 81920
s_nop 0
buffer_load_dwordx4 v6, s[12:15], s24 offen offset:0 lds
v_accvgpr_read_b32 v24, a0
v_accvgpr_read_b32 v25, a1
M v[44:47], a[160:163], a[56:59], v[44:47]
ds_read_b64_tr_b16 a[104:105], v13 offset:32768
ds_read_b64_tr_b16 a[106:107], v13 offset:34816
v_accvgpr_read_b32 v26, a2
v_accvgpr_read_b32 v27, a3
M v[48:51], a[160:163], a[64:67], 0
s_add_u32 s94, s92, 12288
buffer_store_dwordx4 v[152:155], v1, s[16:19], s94 offen offset:3072 sc1
v_accvgpr_read_b32 v28, a4
v_accvgpr_read_b32 v29, a5
M v[48:51], a[164:167], a[68:71], v[48:51]
v_accvgpr_read_b32 v30, a6
v_accvgpr_read_b32 v31, a7
M v[52:55], a[164:167], a[76:79], 0
v_cvt_pk_bf16_f32 v24, v24, v25
v_cvt_pk_bf16_f32 v25, v26, v27
M v[52:55], a[160:163], a[72:75], v[52:55]
ds_read_b64_tr_b16 a[112:113], v14 offset:32768
ds_read_b64_tr_b16 a[114:115], v14 offset:34816
v_cvt_pk_bf16_f32 v26, v28, v29
v_cvt_pk_bf16_f32 v27, v30, v31
M v[56:59], a[160:163], a[80:83], 0
buffer_load_dwordx4 v7, s[12:15], s24 offen offset:1024 lds
M v[56:59], a[164:167], a[84:87], v[56:59]
M v[60:63], a[164:167], a[92:95], 0
s_add_u32 s94, s93, 0
buffer_store_dwordx4 v[160:163], v1, s[16:19], s94 offen offset:0 sc1
M v[60:63], a[160:163], a[88:91], v[60:63]
s_waitcnt lgkmcnt(8)
ds_read_b64_tr_b16 a[120:121], v15 offset:32768
ds_read_b64_tr_b16 a[122:123], v15 offset:34816
M v[64:67], a[168:171], a[32:35], 0
s_add_u32 s94, s93, 12288
buffer_store_dwordx4 v[24:27], v1, s[16:19], s94 offen offset:0 sc1
M v[64:67], a[172:175], a[36:39], v[64:67]
ds_read_b128 a[184:187], v10 offset:6144
ds_read_b128 a[188:191], v11 offset:6144
M v[68:71], a[172:175], a[44:47], 0
M v[68:71], a[168:171], a[40:43], v[68:71]
ds_read_b64_tr_b16 a[128:129], v16 offset:32768
ds_read_b64_tr_b16 a[130:131], v16 offset:34816
M v[72:75], a[168:171], a[48:51], 0
M v[72:75], a[172:175], a[52:55], v[72:75]
s_add_u32 s94, s93, 0
buffer_store_dwordx4 v[168:171], v1, s[16:19], s94 offen offset:1024 sc1
M v[76:79], a[172:175], a[60:63], 0
buffer_load_dwordx4 v8, s[12:15], s24 offen offset:2048 lds
M v[76:79], a[168:171], a[56:59], v[76:79]
ds_read_b64_tr_b16 a[136:137], v17 offset:32768
ds_read_b64_tr_b16 a[138:139], v17 offset:34816
M v[80:83], a[168:171], a[64:67], 0
M v[80:83], a[172:175], a[68:71], v[80:83]
M v[84:87], a[172:175], a[76:79], 0
buffer_load_dwordx4 v9, s[12:15], s24 offen offset:3072 lds
M v[84:87], a[168:171], a[72:75], v[84:87]
ds_read_b64_tr_b16 a[144:145], v18 offset:32768
ds_read_b64_tr_b16 a[146:147], v18 offset:34816
M v[88:91], a[168:171], a[80:83], 0
s_add_u32 s94, s93, 0
buffer_store_dwordx4 v[176:179], v1, s[16:19], s94 offen offset:2048 sc1
M v[88:91], a[172:175], a[84:87], v[88:91]
M v[92:95], a[172:175], a[92:95], 0
M v[92:95], a[168:171], a[88:91], v[92:95]
s_waitcnt lgkmcnt(15)
ds_read_b64_tr_b16 a[152:153], v19 offset:32768
ds_read_b64_tr_b16 a[154:155], v19 offset:34816
M v[96:99], a[176:179], a[32:35], 0
s_add_u32 s24, s24, 262144
s_cmp_eq_u32 s24, s27
s_cselect_b32 s24, s28, s24
s_sub_u32 s6, s6, 1
s_cmp_eq_u32 s6, 0
s_cselect_b64 s[12:13], s[64:65], s[12:13]
v_accvgpr_read_b32 v24, a8
v_accvgpr_read_b32 v25, a9
M v[96:99], a[180:183], a[36:39], v[96:99]
v_accvgpr_read_b32 v26, a10
v_accvgpr_read_b32 v27, a11
M v[100:103], a[180:183], a[44:47], 0
v_accvgpr_read_b32 v28, a12
v_accvgpr_read_b32 v29, a13
M v[100:103], a[176:179], a[40:43], v[100:103]
s_add_u32 s94, s93, 0
buffer_store_dwordx4 v[184:187], v1, s[16:19], s94 offen offset:3072 sc1
v_accvgpr_read_b32 v30, a14
v_accvgpr_read_b32 v31, a15
M v[104:107], a[176:179], a[48:51], 0
v_cvt_pk_bf16_f32 v24, v24, v25
v_cvt_pk_bf16_f32 v25, v26, v27
M v[104:107], a[180:183], a[52:55], v[104:107]
v_cvt_pk_bf16_f32 v26, v28, v29
v_cvt_pk_bf16_f32 v27, v30, v31
M v[108:111], a[180:183], a[60:63], 0
M v[108:111], a[176:179], a[56:59], v[108:111]
s_waitcnt vmcnt(37) lgkmcnt(0)
s_barrier
ds_read_b128 a[160:163], v10 offset:16384
ds_read_b128 a[164:167], v11 offset:16384
M v[112:115], a[176:179], a[64:67], 0
s_add_u32 m0, s29, 0
s_nop 0
buffer_load_dwordx4 v2, s[8:11], s23 offen offset:0 lds
M v[112:115], a[180:183], a[68:71], v[112:115]
s_add_u32 s94, s93, 12288
buffer_store_dwordx4 v[24:27], v1, s[16:19], s94 offen offset:1024 sc1
M v[116:119], a[180:183], a[76:79], 0
s_add_u32 s94, s93, 4096
buffer_store_dwordx4 v[192:195], v1, s[16:19], s94 offen offset:0 sc1
M v[116:119], a[176:179], a[72:75], v[116:119]
ds_read_b64_tr_b16 a[100:101], v12 offset:49152
ds_read_b64_tr_b16 a[102:103], v12 offset:51200
M v[120:123], a[176:179], a[80:83], 0
M v[120:123], a[180:183], a[84:87], v[120:123]
M v[124:127], a[180:183], a[92:95], 0
M v[124:127], a[176:179], a[88:91], v[124:127]
M v[128:131], a[184:187], a[32:35], 0
buffer_load_dwordx4 v3, s[8:11], s23 offen offset:1024 lds
M v[128:131], a[188:191], a[36:39], v[128:131]
ds_read_b128 a[168:171], v10 offset:18432
ds_read_b128 a[172:175], v11 offset:18432
ds_read_b64_tr_b16 a[108:109], v13 offset:49152
ds_read_b64_tr_b16 a[110:111], v13 offset:51200
M v[132:135], a[188:191], a[44:47], 0
s_add_u32 s94, s93, 4096
buffer_store_dwordx4 v[200:203], v1, s[16:19], s94 offen offset:1024 sc1
M v[132:135], a[184:187], a[40:43], v[132:135]
M v[136:139], a[184:187], a[48:51], 0
M v[136:139], a[188:191], a[52:55], v[136:139]
M v[140:143], a[188:191], a[60:63], 0
buffer_load_dwordx4 v4, s[8:11], s23 offen offset:2048 lds
M v[140:143], a[184:187], a[56:59], v[140:143]
ds_read_b64_tr_b16 a[116:117], v14 offset:49152
ds_read_b64_tr_b16 a[118:119], v14 offset:51200
M v[144:147], a[184:187], a[64:67], 0
s_add_u32 s94, s93, 4096
buffer_store_dwordx4 v[208:211], v1, s[16:19], s94 offen offset:2048 sc1
M v[144:147], a[188:191], a[68:71], v[144:147]
M v[148:151], a[188:191], a[76:79], 0
v_accvgpr_read_b32 v24, a16
v_accvgpr_read_b32 v25, a17
M v[148:151], a[184:187], a[72:75], v[148:151]
v_accvgpr_read_b32 v26, a18
v_accvgpr_read_b32 v27, a19
M v[152:155], a[184:187], a[80:83], 0
buffer_load_dwordx4 v5, s[8:11], s23 offen offset:3072 lds
v_accvgpr_read_b32 v28, a20
v_accvgpr_read_b32 v29, a21
M v[152:155], a[188:191], a[84:87], v[152:155]
ds_read_b64_tr_b16 a[124:125], v15 offset:49152
ds_read_b64_tr_b16 a[126:127], v15 offset:51200
v_accvgpr_read_b32 v30, a22
v_accvgpr_read_b32 v31, a23
M v[156:159], a[188:191], a[92:95], 0
v_cvt_pk_bf16_f32 v24, v24, v25
v_cvt_pk_bf16_f32 v25, v26, v27
M v[156:159], a[184:187], a[88:91], v[156:159]
s_add_u32 s94, s93, 4096
buffer_store_dwordx4 v[216:219], v1, s[16:19], s94 offen offset:3072 sc1
s_waitcnt lgkmcnt(10)
v_cvt_pk_bf16_f32 v26, v28, v29
v_cvt_pk_bf16_f32 v27, v30, v31
M v[160:163], a[160:163], a[32:35], 0
M v[160:163], a[164:167], a[36:39], v[160:163]
ds_read_b128 a[176:179], v10 offset:20480
ds_read_b128 a[180:183], v11 offset:20480
M v[164:167], a[164:167], a[44:47], 0
M v[164:167], a[160:163], a[40:43], v[164:167]
ds_read_b64_tr_b16 a[132:133], v16 offset:49152
ds_read_b64_tr_b16 a[134:135], v16 offset:51200
M v[168:171], a[160:163], a[48:51], 0
s_add_u32 s94, s93, 12288
buffer_store_dwordx4 v[24:27], v1, s[16:19], s94 offen offset:2048 sc1
M v[168:171], a[164:167], a[52:55], v[168:171]
s_add_u32 m0, s29, 98304
s_nop 0
buffer_load_dwordx4 v6, s[12:15], s24 offen offset:0 lds
M v[172:175], a[164:167], a[60:63], 0
s_add_u32 s94, s93, 8192
buffer_store_dwordx4 v[224:227], v1, s[16:19], s94 offen offset:0 sc1
M v[172:175], a[160:163], a[56:59], v[172:175]
M v[176:179], a[160:163], a[64:67], 0
M v[176:179], a[164:167], a[68:71], v[176:179]
ds_read_b64_tr_b16 a[140:141], v17 offset:49152
ds_read_b64_tr_b16 a[142:143], v17 offset:51200
M v[180:183], a[164:167], a[76:79], 0
M v[180:183], a[160:163], a[72:75], v[180:183]
M v[184:187], a[160:163], a[80:83], 0
buffer_load_dwordx4 v7, s[12:15], s24 offen offset:1024 lds
M v[184:187], a[164:167], a[84:87], v[184:187]
s_add_u32 s94, s93, 8192
buffer_store_dwordx4 v[232:235], v1, s[16:19], s94 offen offset:1024 sc1
M v[188:191], a[164:167], a[92:95], 0
M v[188:191], a[160:163], a[88:91], v[188:191]
s_waitcnt lgkmcnt(12)
ds_read_b64_tr_b16 a[148:149], v18 offset:49152
ds_read_b64_tr_b16 a[150:151], v18 offset:51200
M v[192:195], a[168:171], a[32:35], 0
M v[192:195], a[172:175], a[36:39], v[192:195]
ds_read_b128 a[184:187], v10 offset:22528
ds_read_b128 a[188:191], v11 offset:22528
M v[196:199], a[172:175], a[44:47], 0
M v[196:199], a[168:171], a[40:43], v[196:199]
buffer_load_dwordx4 v8, s[12:15], s24 offen offset:2048 lds
M v[200:203], a[168:171], a[48:51], 0
s_add_u32 s94, s93, 8192
buffer_store_dwordx4 v[240:243], v1, s[16:19], s94 offen offset:2048 sc1
v_accvgpr_read_b32 v24, a24
v_accvgpr_read_b32 v25, a25
M v[200:203], a[172:175], a[52:55], v[200:203]
ds_read_b64_tr_b16 a[156:157], v19 offset:49152
ds_read_b64_tr_b16 a[158:159], v19 offset:51200
v_accvgpr_read_b32 v26, a26
v_accvgpr_read_b32 v27, a27
M v[204:207], a[172:175], a[60:63], 0
v_accvgpr_read_b32 v28, a28
v_accvgpr_read_b32 v29, a29
M v[204:207], a[168:171], a[56:59], v[204:207]
v_accvgpr_read_b32 v30, a30
v_accvgpr_read_b32 v31, a31
M v[208:211], a[168:171], a[64:67], 0
v_cvt_pk_bf16_f32 v24, v24, v25
v_cvt_pk_bf16_f32 v25, v26, v27
M v[208:211], a[172:175], a[68:71], v[208:211]
buffer_load_dwordx4 v9, s[12:15], s24 offen offset:3072 lds
v_cvt_pk_bf16_f32 v26, v28, v29
v_cvt_pk_bf16_f32 v27, v30, v31
M v[212:215], a[172:175], a[76:79], 0
M v[212:215], a[168:171], a[72:75], v[212:215]
s_add_u32 s94, s93, 8192
buffer_store_dwordx4 v[248:251], v1, s[16:19], s94 offen offset:3072 sc1
M v[216:219], a[168:171], a[80:83], 0
M v[216:219], a[172:175], a[84:87], v[216:219]
s_add_u32 s94, s93, 12288
buffer_store_dwordx4 v[24:27], v1, s[16:19], s94 offen offset:3072 sc1
M v[220:223], a[172:175], a[92:95], 0
M v[220:223], a[168:171], a[88:91], v[220:223]
s_waitcnt lgkmcnt(10)
M v[224:227], a[176:179], a[32:35], 0
s_add_u32 s24, s24, 262144
M v[224:227], a[180:183], a[36:39], v[224:227]
M v[228:231], a[180:183], a[44:47], 0
M v[228:231], a[176:179], a[40:43], v[228:231]
M v[232:235], a[176:179], a[48:51], 0
M v[232:235], a[180:183], a[52:55], v[232:235]
M v[236:239], a[180:183], a[60:63], 0
M v[236:239], a[176:179], a[56:59], v[236:239]
s_waitcnt vmcnt(39) lgkmcnt(0)
s_barrier
ds_read_b128 a[160:163], v10 offset:32768
ds_read_b128 a[164:167], v11 offset:32768
M v[240:243], a[176:179], a[64:67], 0
s_add_u32 m0, s29, 16384
s_add_u32 s3, s23, s31
buffer_load_dwordx4 v2, s[8:11], s3 offen offset:0 lds
M v[240:243], a[180:183], a[68:71], v[240:243]
M v[244:247], a[180:183], a[76:79], 0
M v[244:247], a[176:179], a[72:75], v[244:247]
M v[248:251], a[176:179], a[80:83], 0
M v[248:251], a[180:183], a[84:87], v[248:251]
buffer_load_dwordx4 v3, s[8:11], s3 offen offset:1024 lds
M v[252:255], a[180:183], a[92:95], 0
M v[252:255], a[176:179], a[88:91], v[252:255]
M a[0:3], a[184:187], a[32:35], 0
M a[0:3], a[188:191], a[36:39], a[0:3]
ds_read_b128 a[168:171], v10 offset:34816
ds_read_b128 a[172:175], v11 offset:34816
M a[4:7], a[188:191], a[44:47], 0
M a[4:7], a[184:187], a[40:43], a[4:7]
M a[8:11], a[184:187], a[48:51], 0
buffer_load_dwordx4 v4, s[8:11], s3 offen offset:2048 lds
M a[8:11], a[188:191], a[52:55], a[8:11]
M a[12:15], a[188:191], a[60:63], 0
M a[12:15], a[184:187], a[56:59], a[12:15]
M a[16:19], a[184:187], a[64:67], 0
M a[16:19], a[188:191], a[68:71], a[16:19]
buffer_load_dwordx4 v5, s[8:11], s3 offen offset:3072 lds
M a[20:23], a[188:191], a[76:79], 0
M a[20:23], a[184:187], a[72:75], a[20:23]
M a[24:27], a[184:187], a[80:83], 0
M a[24:27], a[188:191], a[84:87], a[24:27]
M a[28:31], a[188:191], a[92:95], 0
M a[28:31], a[184:187], a[88:91], a[28:31]
s_waitcnt lgkmcnt(2)
M v[32:35], a[160:163], a[96:99], v[32:35]
s_add_u32 s23, s23, 128
s_cmp_eq_u32 s23, s25
s_cselect_b32 s23, s26, s23
M v[32:35], a[164:167], a[100:103], v[32:35]
ds_read_b128 a[176:179], v10 offset:36864
ds_read_b128 a[180:183], v11 offset:36864
M v[36:39], a[164:167], a[108:111], v[36:39]
M v[36:39], a[160:163], a[104:107], v[36:39]
ds_read_b64_tr_b16 a[32:33], v12 offset:0
ds_read_b64_tr_b16 a[34:35], v12 offset:2048
M v[40:43], a[160:163], a[112:115], v[40:43]
M v[40:43], a[164:167], a[116:119], v[40:43]
M v[44:47], a[164:167], a[124:127], v[44:47]
s_add_u32 m0, s29, 114688
s_nop 0
buffer_load_dwordx4 v6, s[12:15], s24 offen offset:0 lds
M v[44:47], a[160:163], a[120:123], v[44:47]
ds_read_b64_tr_b16 a[40:41], v13 offset:0
ds_read_b64_tr_b16 a[42:43], v13 offset:2048
M v[48:51], a[160:163], a[128:131], v[48:51]
M v[48:51], a[164:167], a[132:135], v[48:51]
M v[52:55], a[164:167], a[140:143], v[52:55]
M v[52:55], a[160:163], a[136:139], v[52:55]
ds_read_b64_tr_b16 a[48:49], v14 offset:0
ds_read_b64_tr_b16 a[50:51], v14 offset:2048
M v[56:59], a[160:163], a[144:147], v[56:59]
M v[56:59], a[164:167], a[148:151], v[56:59]
buffer_load_dwordx4 v7, s[12:15], s24 offen offset:1024 lds
M v[60:63], a[164:167], a[156:159], v[60:63]
M v[60:63], a[160:163], a[152:155], v[60:63]
s_waitcnt lgkmcnt(8)
ds_read_b64_tr_b16 a[56:57], v15 offset:0
ds_read_b64_tr_b16 a[58:59], v15 offset:2048
M v[64:67], a[168:171], a[96:99], v[64:67]
M v[64:67], a[172:175], a[100:103], v[64:67]
ds_read_b128 a[184:187], v10 offset:38912
ds_read_b128 a[188:191], v11 offset:38912
M v[68:71], a[172:175], a[108:111], v[68:71]
M v[68:71], a[168:171], a[104:107], v[68:71]
ds_read_b64_tr_b16 a[64:65], v16 offset:0
ds_read_b64_tr_b16 a[66:67], v16 offset:2048
M v[72:75], a[168:171], a[112:115], v[72:75]
buffer_load_dwordx4 v8, s[12:15], s24 offen offset:2048 lds
M v[72:75], a[172:175], a[116:119], v[72:75]
M v[76:79], a[172:175], a[124:127], v[76:79]
M v[76:79], a[168:171], a[120:123], v[76:79]
ds_read_b64_tr_b16 a[72:73], v17 offset:0
ds_read_b64_tr_b16 a[74:75], v17 offset:2048
M v[80:83], a[168:171], a[128:131], v[80:83]
M v[80:83], a[172:175], a[132:135], v[80:83]
M v[84:87], a[172:175], a[140:143], v[84:87]
buffer_load_dwordx4 v9, s[12:15], s24 offen offset:3072 lds
M v[84:87], a[168:171], a[136:139], v[84:87]
ds_read_b64_tr_b16 a[80:81], v18 offset:0
ds_read_b64_tr_b16 a[82:83], v18 offset:2048
M v[88:91], a[168:171], a[144:147], v[88:91]
M v[88:91], a[172:175], a[148:151], v[88:91]
M v[92:95], a[172:175], a[156:159], v[92:95]
M v[92:95], a[168:171], a[152:155], v[92:95]
s_waitcnt lgkmcnt(15)
ds_read_b64_tr_b16 a[88:89], v19 offset:0
ds_read_b64_tr_b16 a[90:91], v19 offset:2048
M v[96:99], a[176:179], a[96:99], v[96:99]
s_add_u32 s24, s24, 262144
s_cmp_eq_u32 s24, s27
s_cselect_b32 s24, s28, s24
s_sub_u32 s6, s6, 1
s_cmp_eq_u32 s6, 0
s_cselect_b64 s[12:13], s[64:65], s[12:13]
M v[96:99], a[180:183], a[100:103], v[96:99]
M v[100:103], a[180:183], a[108:111], v[100:103]
M v[100:103], a[176:179], a[104:107], v[100:103]
M v[104:107], a[176:179], a[112:115], v[104:107]
M v[104:107], a[180:183], a[116:119], v[104:107]
M v[108:111], a[180:183], a[124:127], v[108:111]
M v[108:111], a[176:179], a[120:123], v[108:111]
s_waitcnt vmcnt(29) lgkmcnt(0)
s_barrier
ds_read_b128 a[160:163], v10 offset:49152
ds_read_b128 a[164:167], v11 offset:49152
M v[112:115], a[176:179], a[128:131], v[112:115]
s_add_u32 m0, s29, 32768
s_nop 0
buffer_load_dwordx4 v2, s[8:11], s23 offen offset:0 lds
M v[112:115], a[180:183], a[132:135], v[112:115]
M v[116:119], a[180:183], a[140:143], v[116:119]
M v[116:119], a[176:179], a[136:139], v[116:119]
ds_read_b64_tr_b16 a[36:37], v12 offset:16384
ds_read_b64_tr_b16 a[38:39], v12 offset:18432
M v[120:123], a[176:179], a[144:147], v[120:123]
M v[120:123], a[180:183], a[148:151], v[120:123]
M v[124:127], a[180:183], a[156:159], v[124:127]
buffer_load_dwordx4 v3, s[8:11], s23 offen offset:1024 lds
M v[124:127], a[176:179], a[152:155], v[124:127]
M v[128:131], a[184:187], a[96:99], v[128:131]
M v[128:131], a[188:191], a[100:103], v[128:131]
ds_read_b128 a[168:171], v10 offset:51200
ds_read_b128 a[172:175], v11 offset:51200
ds_read_b64_tr_b16 a[44:45], v13 offset:16384
ds_read_b64_tr_b16 a[46:47], v13 offset:18432
M v[132:135], a[188:191], a[108:111], v[132:135]
M v[132:135], a[184:187], a[104:107], v[132:135]
M v[136:139], a[184:187], a[112:115], v[136:139]
M v[136:139], a[188:191], a[116:119], v[136:139]
buffer_load_dwordx4 v4, s[8:11], s23 offen offset:2048 lds
M v[140:143], a[188:191], a[124:127], v[140:143]
M v[140:143], a[184:187], a[120:123], v[140:143]
ds_read_b64_tr_b16 a[52:53], v14 offset:16384
ds_read_b64_tr_b16 a[54:55], v14 offset:18432
M v[144:147], a[184:187], a[128:131], v[144:147]
M v[144:147], a[188:191], a[132:135], v[144:147]
M v[148:151], a[188:191], a[140:143], v[148:151]
M v[148:151], a[184:187], a[136:139], v[148:151]
M v[152:155], a[184:187], a[144:147], v[152:155]
buffer_load_dwordx4 v5, s[8:11], s23 offen offset:3072 lds
M v[152:155], a[188:191], a[148:151], v[152:155]
ds_read_b64_tr_b16 a[60:61], v15 offset:16384
ds_read_b64_tr_b16 a[62:63], v15 offset:18432
M v[156:159], a[188:191], a[156:159], v[156:159]
M v[156:159], a[184:187], a[152:155], v[156:159]
s_waitcnt lgkmcnt(10)
M v[160:163], a[160:163], a[96:99], v[160:163]
M v[160:163], a[164:167], a[100:103], v[160:163]
ds_read_b128 a[176:179], v10 offset:53248
ds_read_b128 a[180:183], v11 offset:53248
M v[164:167], a[164:167], a[108:111], v[164:167]
M v[164:167], a[160:163], a[104:107], v[164:167]
ds_read_b64_tr_b16 a[68:69], v16 offset:16384
ds_read_b64_tr_b16 a[70:71], v16 offset:18432
M v[168:171], a[160:163], a[112:115], v[168:171]
M v[168:171], a[164:167], a[116:119], v[168:171]
s_add_u32 m0, s29, 65536
s_nop 0
buffer_load_dwordx4 v6, s[12:15], s24 offen offset:0 lds
M v[172:175], a[164:167], a[124:127], v[172:175]
M v[172:175], a[160:163], a[120:123], v[172:175]
M v[176:179], a[160:163], a[128:131], v[176:179]
M v[176:179], a[164:167], a[132:135], v[176:179]
ds_read_b64_tr_b16 a[76:77], v17 offset:16384
ds_read_b64_tr_b16 a[78:79], v17 offset:18432
M v[180:183], a[164:167], a[140:143], v[180:183]
M v[180:183], a[160:163], a[136:139], v[180:183]
buffer_load_dwordx4 v7, s[12:15], s24 offen offset:1024 lds
M v[184:187], a[160:163], a[144:147], v[184:187]
M v[184:187], a[164:167], a[148:151], v[184:187]
M v[188:191], a[164:167], a[156:159], v[188:191]
M v[188:191], a[160:163], a[152:155], v[188:191]
s_waitcnt lgkmcnt(12)
ds_read_b64_tr_b16 a[84:85], v18 offset:16384
ds_read_b64_tr_b16 a[86:87], v18 offset:18432
M v[192:195], a[168:171], a[96:99], v[192:195]
M v[192:195], a[172:175], a[100:103], v[192:195]
ds_read_b128 a[184:187], v10 offset:55296
ds_read_b128 a[188:191], v11 offset:55296
M v[196:199], a[172:175], a[108:111], v[196:199]
M v[196:199], a[168:171], a[104:107], v[196:199]
buffer_load_dwordx4 v8, s[12:15], s24 offen offset:2048 lds
M v[200:203], a[168:171], a[112:115], v[200:203]
M v[200:203], a[172:175], a[116:119], v[200:203]
ds_read_b64_tr_b16 a[92:93], v19 offset:16384
ds_read_b64_tr_b16 a[94:95], v19 offset:18432
M v[204:207], a[172:175], a[124:127], v[204:207]
M v[204:207], a[168:171], a[120:123], v[204:207]
M v[208:211], a[168:171], a[128:131], v[208:211]
M v[208:211], a[172:175], a[132:135], v[208:211]
buffer_load_dwordx4 v9, s[12:15], s24 offen offset:3072 lds
M v[212:215], a[172:175], a[140:143], v[212:215]
M v[212:215], a[168:171], a[136:139], v[212:215]
M v[216:219], a[168:171], a[144:147], v[216:219]
M v[216:219], a[172:175], a[148:151], v[216:219]
M v[220:223], a[172:175], a[156:159], v[220:223]
s_add_u32 s24, s24, 262144
M v[220:223], a[168:171], a[152:155], v[220:223]
s_waitcnt lgkmcnt(10)
M v[224:227], a[176:179], a[96:99], v[224:227]
M v[224:227], a[180:183], a[100:103], v[224:227]
M v[228:231], a[180:183], a[108:111], v[228:231]
M v[228:231], a[176:179], a[104:107], v[228:231]
M v[232:235], a[176:179], a[112:115], v[232:235]
M v[232:235], a[180:183], a[116:119], v[232:235]
M v[236:239], a[180:183], a[124:127], v[236:239]
M v[236:239], a[176:179], a[120:123], v[236:239]
s_waitcnt vmcnt(18) lgkmcnt(0)
s_barrier
ds_read_b128 a[160:163], v10 offset:0
ds_read_b128 a[164:167], v11 offset:0
M v[240:243], a[176:179], a[128:131], v[240:243]
s_add_u32 m0, s29, 49152
s_add_u32 s3, s23, s31
buffer_load_dwordx4 v2, s[8:11], s3 offen offset:0 lds
M v[240:243], a[180:183], a[132:135], v[240:243]
M v[244:247], a[180:183], a[140:143], v[244:247]
M v[244:247], a[176:179], a[136:139], v[244:247]
M v[248:251], a[176:179], a[144:147], v[248:251]
M v[248:251], a[180:183], a[148:151], v[248:251]
buffer_load_dwordx4 v3, s[8:11], s3 offen offset:1024 lds
M v[252:255], a[180:183], a[156:159], v[252:255]
M v[252:255], a[176:179], a[152:155], v[252:255]
M a[0:3], a[184:187], a[96:99], a[0:3]
M a[0:3], a[188:191], a[100:103], a[0:3]
ds_read_b128 a[168:171], v10 offset:2048
ds_read_b128 a[172:175], v11 offset:2048
M a[4:7], a[188:191], a[108:111], a[4:7]
M a[4:7], a[184:187], a[104:107], a[4:7]
M a[8:11], a[184:187], a[112:115], a[8:11]
buffer_load_dwordx4 v4, s[8:11], s3 offen offset:2048 lds
M a[8:11], a[188:191], a[116:119], a[8:11]
M a[12:15], a[188:191], a[124:127], a[12:15]
M a[12:15], a[184:187], a[120:123], a[12:15]
M a[16:19], a[184:187], a[128:131], a[16:19]
M a[16:19], a[188:191], a[132:135], a[16:19]
buffer_load_dwordx4 v5, s[8:11], s3 offen offset:3072 lds
M a[20:23], a[188:191], a[140:143], a[20:23]
M a[20:23], a[184:187], a[136:139], a[20:23]
M a[24:27], a[184:187], a[144:147], a[24:27]
M a[24:27], a[188:191], a[148:151], a[24:27]
M a[28:31], a[188:191], a[156:159], a[28:31]
M a[28:31], a[184:187], a[152:155], a[28:31]
s_waitcnt lgkmcnt(2)
M v[32:35], a[160:163], a[32:35], v[32:35]
s_add_u32 s23, s23, 128
s_cmp_eq_u32 s23, s25
s_cselect_b32 s23, s26, s23
M v[32:35], a[164:167], a[36:39], v[32:35]
ds_read_b128 a[176:179], v10 offset:4096
ds_read_b128 a[180:183], v11 offset:4096
M v[36:39], a[164:167], a[44:47], v[36:39]
M v[36:39], a[160:163], a[40:43], v[36:39]
ds_read_b64_tr_b16 a[96:97], v12 offset:32768
ds_read_b64_tr_b16 a[98:99], v12 offset:34816
M v[40:43], a[160:163], a[48:51], v[40:43]
M v[40:43], a[164:167], a[52:55], v[40:43]
M v[44:47], a[164:167], a[60:63], v[44:47]
s_add_u32 m0, s29, 81920
s_nop 0
buffer_load_dwordx4 v6, s[12:15], s24 offen offset:0 lds
M v[44:47], a[160:163], a[56:59], v[44:47]
ds_read_b64_tr_b16 a[104:105], v13 offset:32768
ds_read_b64_tr_b16 a[106:107], v13 offset:34816
M v[48:51], a[160:163], a[64:67], v[48:51]
M v[48:51], a[164:167], a[68:71], v[48:51]
M v[52:55], a[164:167], a[76:79], v[52:55]
M v[52:55], a[160:163], a[72:75], v[52:55]
ds_read_b64_tr_b16 a[112:113], v14 offset:32768
ds_read_b64_tr_b16 a[114:115], v14 offset:34816
M v[56:59], a[160:163], a[80:83], v[56:59]
M v[56:59], a[164:167], a[84:87], v[56:59]
buffer_load_dwordx4 v7, s[12:15], s24 offen offset:1024 lds
M v[60:63], a[164:167], a[92:95], v[60:63]
M v[60:63], a[160:163], a[88:91], v[60:63]
s_waitcnt lgkmcnt(8)
ds_read_b64_tr_b16 a[120:121], v15 offset:32768
ds_read_b64_tr_b16 a[122:123], v15 offset:34816
M v[64:67], a[168:171], a[32:35], v[64:67]
M v[64:67], a[172:175], a[36:39], v[64:67]
ds_read_b128 a[184:187], v10 offset:6144
ds_read_b128 a[188:191], v11 offset:6144
M v[68:71], a[172:175], a[44:47], v[68:71]
M v[68:71], a[168:171], a[40:43], v[68:71]
ds_read_b64_tr_b16 a[128:129], v16 offset:32768
ds_read_b64_tr_b16 a[130:131], v16 offset:34816
M v[72:75], a[168:171], a[48:51], v[72:75]
buffer_load_dwordx4 v8, s[12:15], s24 offen offset:2048 lds
M v[72:75], a[172:175], a[52:55], v[72:75]
M v[76:79], a[172:175], a[60:63], v[76:79]
M v[76:79], a[168:171], a[56:59], v[76:79]
ds_read_b64_tr_b16 a[136:137], v17 offset:32768
ds_read_b64_tr_b16 a[138:139], v17 offset:34816
M v[80:83], a[168:171], a[64:67], v[80:83]
M v[80:83], a[172:175], a[68:71], v[80:83]
M v[84:87], a[172:175], a[76:79], v[84:87]
buffer_load_dwordx4 v9, s[12:15], s24 offen offset:3072 lds
M v[84:87], a[168:171], a[72:75], v[84:87]
ds_read_b64_tr_b16 a[144:145], v18 offset:32768
ds_read_b64_tr_b16 a[146:147], v18 offset:34816
M v[88:91], a[168:171], a[80:83], v[88:91]
M v[88:91], a[172:175], a[84:87], v[88:91]
M v[92:95], a[172:175], a[92:95], v[92:95]
M v[92:95], a[168:171], a[88:91], v[92:95]
s_waitcnt lgkmcnt(15)
ds_read_b64_tr_b16 a[152:153], v19 offset:32768
ds_read_b64_tr_b16 a[154:155], v19 offset:34816
M v[96:99], a[176:179], a[32:35], v[96:99]
s_add_u32 s24, s24, 262144
s_cmp_eq_u32 s24, s27
s_cselect_b32 s24, s28, s24
s_sub_u32 s6, s6, 1
s_cmp_eq_u32 s6, 0
s_cselect_b64 s[12:13], s[64:65], s[12:13]
M v[96:99], a[180:183], a[36:39], v[96:99]
M v[100:103], a[180:183], a[44:47], v[100:103]
M v[100:103], a[176:179], a[40:43], v[100:103]
M v[104:107], a[176:179], a[48:51], v[104:107]
M v[104:107], a[180:183], a[52:55], v[104:107]
M v[108:111], a[180:183], a[60:63], v[108:111]
M v[108:111], a[176:179], a[56:59], v[108:111]
s_waitcnt vmcnt(16) lgkmcnt(0)
s_barrier
ds_read_b128 a[160:163], v10 offset:16384
ds_read_b128 a[164:167], v11 offset:16384
M v[112:115], a[176:179], a[64:67], v[112:115]
s_add_u32 m0, s29, 0
s_nop 0
buffer_load_dwordx4 v2, s[8:11], s23 offen offset:0 lds
M v[112:115], a[180:183], a[68:71], v[112:115]
M v[116:119], a[180:183], a[76:79], v[116:119]
M v[116:119], a[176:179], a[72:75], v[116:119]
ds_read_b64_tr_b16 a[100:101], v12 offset:49152
ds_read_b64_tr_b16 a[102:103], v12 offset:51200
M v[120:123], a[176:179], a[80:83], v[120:123]
M v[120:123], a[180:183], a[84:87], v[120:123]
M v[124:127], a[180:183], a[92:95], v[124:127]
buffer_load_dwordx4 v3, s[8:11], s23 offen offset:1024 lds
M v[124:127], a[176:179], a[88:91], v[124:127]
M v[128:131], a[184:187], a[32:35], v[128:131]
M v[128:131], a[188:191], a[36:39], v[128:131]
ds_read_b128 a[168:171], v10 offset:18432
ds_read_b128 a[172:175], v11 offset:18432
ds_read_b64_tr_b16 a[108:109], v13 offset:49152
ds_read_b64_tr_b16 a[110:111], v13 offset:51200
M v[132:135], a[188:191], a[44:47], v[132:135]
M v[132:135], a[184:187], a[40:43], v[132:135]
M v[136:139], a[184:187], a[48:51], v[136:139]
M v[136:139], a[188:191], a[52:55], v[136:139]
buffer_load_dwordx4 v4, s[8:11], s23 offen offset:2048 lds
M v[140:143], a[188:191], a[60:63], v[140:143]
M v[140:143], a[184:187], a[56:59], v[140:143]
ds_read_b64_tr_b16 a[116:117], v14 offset:49152
ds_read_b64_tr_b16 a[118:119], v14 offset:51200
M v[144:147], a[184:187], a[64:67], v[144:147]
M v[144:147], a[188:191], a[68:71], v[144:147]
M v[148:151], a[188:191], a[76:79], v[148:151]
M v[148:151], a[184:187], a[72:75], v[148:151]
M v[152:155], a[184:187], a[80:83], v[152:155]
buffer_load_dwordx4 v5, s[8:11], s23 offen offset:3072 lds
M v[152:155], a[188:191], a[84:87], v[152:155]
ds_read_b64_tr_b16 a[124:125], v15 offset:49152
ds_read_b64_tr_b16 a[126:127], v15 offset:51200
M v[156:159], a[188:191], a[92:95], v[156:159]
M v[156:159], a[184:187], a[88:91], v[156:159]
s_waitcnt lgkmcnt(10)
M v[160:163], a[160:163], a[32:35], v[160:163]
M v[160:163], a[164:167], a[36:39], v[160:163]
ds_read_b128 a[176:179], v10 offset:20480
ds_read_b128 a[180:183], v11 offset:20480
M v[164:167], a[164:167], a[44:47], v[164:167]
M v[164:167], a[160:163], a[40:43], v[164:167]
ds_read_b64_tr_b16 a[132:133], v16 offset:49152
ds_read_b64_tr_b16 a[134:135], v16 offset:51200
M v[168:171], a[160:163], a[48:51], v[168:171]
M v[168:171], a[164:167], a[52:55], v[168:171]
s_add_u32 m0, s29, 98304
s_nop 0
buffer_load_dwordx4 v6, s[12:15], s24 offen offset:0 lds
M v[172:175], a[164:167], a[60:63], v[172:175]
M v[172:175], a[160:163], a[56:59], v[172:175]
M v[176:179], a[160:163], a[64:67], v[176:179]
M v[176:179], a[164:167], a[68:71], v[176:179]
ds_read_b64_tr_b16 a[140:141], v17 offset:49152
ds_read_b64_tr_b16 a[142:143], v17 offset:51200
M v[180:183], a[164:167], a[76:79], v[180:183]
M v[180:183], a[160:163], a[72:75], v[180:183]
buffer_load_dwordx4 v7, s[12:15], s24 offen offset:1024 lds
M v[184:187], a[160:163], a[80:83], v[184:187]
M v[184:187], a[164:167], a[84:87], v[184:187]
M v[188:191], a[164:167], a[92:95], v[188:191]
M v[188:191], a[160:163], a[88:91], v[188:191]
s_waitcnt lgkmcnt(12)
ds_read_b64_tr_b16 a[148:149], v18 offset:49152
ds_read_b64_tr_b16 a[150:151], v18 offset:51200
M v[192:195], a[168:171], a[32:35], v[192:195]
M v[192:195], a[172:175], a[36:39], v[192:195]
ds_read_b128 a[184:187], v10 offset:22528
ds_read_b128 a[188:191], v11 offset:22528
M v[196:199], a[172:175], a[44:47], v[196:199]
M v[196:199], a[168:171], a[40:43], v[196:199]
buffer_load_dwordx4 v8, s[12:15], s24 offen offset:2048 lds
M v[200:203], a[168:171], a[48:51], v[200:203]
M v[200:203], a[172:175], a[52:55], v[200:203]
ds_read_b64_tr_b16 a[156:157], v19 offset:49152
ds_read_b64_tr_b16 a[158:159], v19 offset:51200
M v[204:207], a[172:175], a[60:63], v[204:207]
M v[204:207], a[168:171], a[56:59], v[204:207]
M v[208:211], a[168:171], a[64:67], v[208:211]
M v[208:211], a[172:175], a[68:71], v[208:211]
buffer_load_dwordx4 v9, s[12:15], s24 offen offset:3072 lds
M v[212:215], a[172:175], a[76:79], v[212:215]
M v[212:215], a[168:171], a[72:75], v[212:215]
M v[216:219], a[168:171], a[80:83], v[216:219]
M v[216:219], a[172:175], a[84:87], v[216:219]
M v[220:223], a[172:175], a[92:95], v[220:223]
s_add_u32 s24, s24, 262144
M v[220:223], a[168:171], a[88:91], v[220:223]
s_waitcnt lgkmcnt(10)
M v[224:227], a[176:179], a[32:35], v[224:227]
M v[224:227], a[180:183], a[36:39], v[224:227]
M v[228:231], a[180:183], a[44:47], v[228:231]
M v[228:231], a[176:179], a[40:43], v[228:231]
M v[232:235], a[176:179], a[48:51], v[232:235]
M v[232:235], a[180:183], a[52:55], v[232:235]
M v[236:239], a[180:183], a[60:63], v[236:239]
M v[236:239], a[176:179], a[56:59], v[236:239]
s_waitcnt vmcnt(16) lgkmcnt(0)
s_barrier
ds_read_b128 a[160:163], v10 offset:32768
ds_read_b128 a[164:167], v11 offset:32768
M v[240:243], a[176:179], a[64:67], v[240:243]
s_add_u32 m0, s29, 16384
s_add_u32 s3, s23, s31
buffer_load_dwordx4 v2, s[8:11], s3 offen offset:0 lds
M v[240:243], a[180:183], a[68:71], v[240:243]
M v[244:247], a[180:183], a[76:79], v[244:247]
M v[244:247], a[176:179], a[72:75], v[244:247]
M v[248:251], a[176:179], a[80:83], v[248:251]
M v[248:251], a[180:183], a[84:87], v[248:251]
buffer_load_dwordx4 v3, s[8:11], s3 offen offset:1024 lds
M v[252:255], a[180:183], a[92:95], v[252:255]
M v[252:255], a[176:179], a[88:91], v[252:255]
M a[0:3], a[184:187], a[32:35], a[0:3]
M a[0:3], a[188:191], a[36:39], a[0:3]
ds_read_b128 a[168:171], v10 offset:34816
ds_read_b128 a[172:175], v11 offset:34816
M a[4:7], a[188:191], a[44:47], a[4:7]
M a[4:7], a[184:187], a[40:43], a[4:7]
M a[8:11], a[184:187], a[48:51], a[8:11]
buffer_load_dwordx4 v4, s[8:11], s3 offen offset:2048 lds
M a[8:11], a[188:191], a[52:55], a[8:11]
M a[12:15], a[188:191], a[60:63], a[12:15]
M a[12:15], a[184:187], a[56:59], a[12:15]
M a[16:19], a[184:187], a[64:67], a[16:19]
M a[16:19], a[188:191], a[68:71], a[16:19]
buffer_load_dwordx4 v5, s[8:11], s3 offen offset:3072 lds
M a[20:23], a[188:191], a[76:79], a[20:23]
M a[20:23], a[184:187], a[72:75], a[20:23]
M a[24:27], a[184:187], a[80:83], a[24:27]
M a[24:27], a[188:191], a[84:87], a[24:27]
M a[28:31], a[188:191], a[92:95], a[28:31]
M a[28:31], a[184:187], a[88:91], a[28:31]
s_waitcnt lgkmcnt(2)
M v[32:35], a[160:163], a[96:99], v[32:35]
s_add_u32 s23, s23, 128
s_cmp_eq_u32 s23, s25
s_cselect_b32 s23, s26, s23
M v[32:35], a[164:167], a[100:103], v[32:35]
ds_read_b128 a[176:179], v10 offset:36864
ds_read_b128 a[180:183], v11 offset:36864
M v[36:39], a[164:167], a[108:111], v[36:39]
M v[36:39], a[160:163], a[104:107], v[36:39]
ds_read_b64_tr_b16 a[32:33], v12 offset:0
ds_read_b64_tr_b16 a[34:35], v12 offset:2048
M v[40:43], a[160:163], a[112:115], v[40:43]
M v[40:43], a[164:167], a[116:119], v[40:43]
M v[44:47], a[164:167], a[124:127], v[44:47]
s_add_u32 m0, s29, 114688
s_nop 0
buffer_load_dwordx4 v6, s[12:15], s24 offen offset:0 lds
M v[44:47], a[160:163], a[120:123], v[44:47]
ds_read_b64_tr_b16 a[40:41], v13 offset:0
ds_read_b64_tr_b16 a[42:43], v13 offset:2048
M v[48:51], a[160:163], a[128:131], v[48:51]
M v[48:51], a[164:167], a[132:135], v[48:51]
M v[52:55], a[164:167], a[140:143], v[52:55]
M v[52:55], a[160:163], a[136:139], v[52:55]
ds_read_b64_tr_b16 a[48:49], v14 offset:0
ds_read_b64_tr_b16 a[50:51], v14 offset:2048
M v[56:59], a[160:163], a[144:147], v[56:59]
M v[56:59], a[164:167], a[148:151], v[56:59]
buffer_load_dwordx4 v7, s[12:15], s24 offen offset:1024 lds
M v[60:63], a[164:167], a[156:159], v[60:63]
M v[60:63], a[160:163], a[152:155], v[60:63]
s_waitcnt lgkmcnt(8)
ds_read_b64_tr_b16 a[56:57], v15 offset:0
ds_read_b64_tr_b16 a[58:59], v15 offset:2048
M v[64:67], a[168:171], a[96:99], v[64:67]
M v[64:67], a[172:175], a[100:103], v[64:67]
ds_read_b128 a[184:187], v10 offset:38912
ds_read_b128 a[188:191], v11 offset:38912
M v[68:71], a[172:175], a[108:111], v[68:71]
M v[68:71], a[168:171], a[104:107], v[68:71]
ds_read_b64_tr_b16 a[64:65], v16 offset:0
ds_read_b64_tr_b16 a[66:67], v16 offset:2048
M v[72:75], a[168:171], a[112:115], v[72:75]
buffer_load_dwordx4 v8, s[12:15], s24 offen offset:2048 lds
M v[72:75], a[172:175], a[116:119], v[72:75]
M v[76:79], a[172:175], a[124:127], v[76:79]
M v[76:79], a[168:171], a[120:123], v[76:79]
ds_read_b64_tr_b16 a[72:73], v17 offset:0
ds_read_b64_tr_b16 a[74:75], v17 offset:2048
M v[80:83], a[168:171], a[128:131], v[80:83]
M v[80:83], a[172:175], a[132:135], v[80:83]
M v[84:87], a[172:175], a[140:143], v[84:87]
buffer_load_dwordx4 v9, s[12:15], s24 offen offset:3072 lds
M v[84:87], a[168:171], a[136:139], v[84:87]
ds_read_b64_tr_b16 a[80:81], v18 offset:0
ds_read_b64_tr_b16 a[82:83], v18 offset:2048
M v[88:91], a[168:171], a[144:147], v[88:91]
M v[88:91], a[172:175], a[148:151], v[88:91]
M v[92:95], a[172:175], a[156:159], v[92:95]
M v[92:95], a[168:171], a[152:155], v[92:95]
s_waitcnt lgkmcnt(15)
ds_read_b64_tr_b16 a[88:89], v19 offset:0
ds_read_b64_tr_b16 a[90:91], v19 offset:2048
M v[96:99], a[176:179], a[96:99], v[96:99]
s_add_u32 s24, s24, 262144
s_cmp_eq_u32 s24, s27
s_cselect_b32 s24, s28, s24
s_sub_u32 s6, s6, 1
s_cmp_eq_u32 s6, 0
s_cselect_b64 s[12:13], s[64:65], s[12:13]
M v[96:99], a[180:183], a[100:103], v[96:99]
M v[100:103], a[180:183], a[108:111], v[100:103]
M v[100:103], a[176:179], a[104:107], v[100:103]
M v[104:107], a[176:179], a[112:115], v[104:107]
M v[104:107], a[180:183], a[116:119], v[104:107]
M v[108:111], a[180:183], a[124:127], v[108:111]
M v[108:111], a[176:179], a[120:123], v[108:111]
s_waitcnt vmcnt(16) lgkmcnt(0)
s_barrier
ds_read_b128 a[160:163], v10 offset:49152
ds_read_b128 a[164:167], v11 offset:49152
M v[112:115], a[176:179], a[128:131], v[112:115]
s_add_u32 m0, s29, 32768
s_nop 0
buffer_load_dwordx4 v2, s[8:11], s23 offen offset:0 lds
M v[112:115], a[180:183], a[132:135], v[112:115]
M v[116:119], a[180:183], a[140:143], v[116:119]
M v[116:119], a[176:179], a[136:139], v[116:119]
ds_read_b64_tr_b16 a[36:37], v12 offset:16384
ds_read_b64_tr_b16 a[38:39], v12 offset:18432
M v[120:123], a[176:179], a[144:147], v[120:123]
M v[120:123], a[180:183], a[148:151], v[120:123]
M v[124:127], a[180:183], a[156:159], v[124:127]
buffer_load_dwordx4 v3, s[8:11], s23 offen offset:1024 lds
M v[124:127], a[176:179], a[152:155], v[124:127]
M v[128:131], a[184:187], a[96:99], v[128:131]
M v[128:131], a[188:191], a[100:103], v[128:131]
ds_read_b128 a[168:171], v10 offset:51200
ds_read_b128 a[172:175], v11 offset:51200
ds_read_b64_tr_b16 a[44:45], v13 offset:16384
ds_read_b64_tr_b16 a[46:47], v13 offset:18432
M v[132:135], a[188:191], a[108:111], v[132:135]
M v[132:135], a[184:187], a[104:107], v[132:135]
M v[136:139], a[184:187], a[112:115], v[136:139]
M v[136:139], a[188:191], a[116:119], v[136:139]
buffer_load_dwordx4 v4, s[8:11], s23 offen offset:2048 lds
M v[140:143], a[188:191], a[124:127], v[140:143]
M v[140:143], a[184:187], a[120:123], v[140:143]
ds_read_b64_tr_b16 a[52:53], v14 offset:16384
ds_read_b64_tr_b16 a[54:55], v14 offset:18432
M v[144:147], a[184:187], a[128:131], v[144:147]
M v[144:147], a[188:191], a[132:135], v[144:147]
M v[148:151], a[188:191], a[140:143], v[148:151]
M v[148:151], a[184:187], a[136:139], v[148:151]
M v[152:155], a[184:187], a[144:147], v[152:155]
buffer_load_dwordx4 v5, s[8:11], s23 offen offset:3072 lds
M v[152:155], a[188:191], a[148:151], v[152:155]
ds_read_b64_tr_b16 a[60:61], v15 offset:16384
ds_read_b64_tr_b16 a[62:63], v15 offset:18432
M v[156:159], a[188:191], a[156:159], v[156:159]
M v[156:159], a[184:187], a[152:155], v[156:159]
s_waitcnt lgkmcnt(10)
M v[160:163], a[160:163], a[96:99], v[160:163]
M v[160:163], a[164:167], a[100:103], v[160:163]
ds_read_b128 a[176:179], v10 offset:53248
ds_read_b128 a[180:183], v11 offset:53248
M v[164:167], a[164:167], a[108:111], v[164:167]
M v[164:167], a[160:163], a[104:107], v[164:167]
ds_read_b64_tr_b16 a[68:69], v16 offset:16384
ds_read_b64_tr_b16 a[70:71], v16 offset:18432
M v[168:171], a[160:163], a[112:115], v[168:171]
M v[168:171], a[164:167], a[116:119], v[168:171]
s_add_u32 m0, s29, 65536
s_nop 0
buffer_load_dwordx4 v6, s[12:15], s24 offen offset:0 lds
M v[172:175], a[164:167], a[124:127], v[172:175]
M v[172:175], a[160:163], a[120:123], v[172:175]
M v[176:179], a[160:163], a[128:131], v[176:179]
M v[176:179], a[164:167], a[132:135], v[176:179]
ds_read_b64_tr_b16 a[76:77], v17 offset:16384
ds_read_b64_tr_b16 a[78:79], v17 offset:18432
M v[180:183], a[164:167], a[140:143], v[180:183]
M v[180:183], a[160:163], a[136:139], v[180:183]
buffer_load_dwordx4 v7, s[12:15], s24 offen offset:1024 lds
M v[184:187], a[160:163], a[144:147], v[184:187]
M v[184:187], a[164:167], a[148:151], v[184:187]
M v[188:191], a[164:167], a[156:159], v[188:191]
M v[188:191], a[160:163], a[152:155], v[188:191]
s_waitcnt lgkmcnt(12)
ds_read_b64_tr_b16 a[84:85], v18 offset:16384
ds_read_b64_tr_b16 a[86:87], v18 offset:18432
M v[192:195], a[168:171], a[96:99], v[192:195]
M v[192:195], a[172:175], a[100:103], v[192:195]
ds_read_b128 a[184:187], v10 offset:55296
ds_read_b128 a[188:191], v11 offset:55296
M v[196:199], a[172:175], a[108:111], v[196:199]
M v[196:199], a[168:171], a[104:107], v[196:199]
buffer_load_dwordx4 v8, s[12:15], s24 offen offset:2048 lds
M v[200:203], a[168:171], a[112:115], v[200:203]
M v[200:203], a[172:175], a[116:119], v[200:203]
ds_read_b64_tr_b16 a[92:93], v19 offset:16384
ds_read_b64_tr_b16 a[94:95], v19 offset:18432
M v[204:207], a[172:175], a[124:127], v[204:207]
M v[204:207], a[168:171], a[120:123], v[204:207]
M v[208:211], a[168:171], a[128:131], v[208:211]
M v[208:211], a[172:175], a[132:135], v[208:211]
buffer_load_dwordx4 v9, s[12:15], s24 offen offset:3072 lds
M v[212:215], a[172:175], a[140:143], v[212:215]
M v[212:215], a[168:171], a[136:139], v[212:215]
M v[216:219], a[168:171], a[144:147], v[216:219]
M v[216:219], a[172:175], a[148:151], v[216:219]
M v[220:223], a[172:175], a[156:159], v[220:223]
s_add_u32 s24, s24, 262144
M v[220:223], a[168:171], a[152:155], v[220:223]
s_waitcnt lgkmcnt(10)
M v[224:227], a[176:179], a[96:99], v[224:227]
M v[224:227], a[180:183], a[100:103], v[224:227]
M v[228:231], a[180:183], a[108:111], v[228:231]
M v[228:231], a[176:179], a[104:107], v[228:231]
M v[232:235], a[176:179], a[112:115], v[232:235]
M v[232:235], a[180:183], a[116:119], v[232:235]
M v[236:239], a[180:183], a[124:127], v[236:239]
M v[236:239], a[176:179], a[120:123], v[236:239]
s_waitcnt vmcnt(16) lgkmcnt(0)
s_barrier
ds_read_b128 a[160:163], v10 offset:0
ds_read_b128 a[164:167], v11 offset:0
M v[240:243], a[176:179], a[128:131], v[240:243]
s_add_u32 m0, s29, 49152
s_add_u32 s3, s23, s31
buffer_load_dwordx4 v2, s[8:11], s3 offen offset:0 lds
M v[240:243], a[180:183], a[132:135], v[240:243]
M v[244:247], a[180:183], a[140:143], v[244:247]
M v[244:247], a[176:179], a[136:139], v[244:247]
M v[248:251], a[176:179], a[144:147], v[248:251]
M v[248:251], a[180:183], a[148:151], v[248:251]
buffer_load_dwordx4 v3, s[8:11], s3 offen offset:1024 lds
M v[252:255], a[180:183], a[156:159], v[252:255]
M v[252:255], a[176:179], a[152:155], v[252:255]
M a[0:3], a[184:187], a[96:99], a[0:3]
M a[0:3], a[188:191], a[100:103], a[0:3]
ds_read_b128 a[168:171], v10 offset:2048
ds_read_b128 a[172:175], v11 offset:2048
M a[4:7], a[188:191], a[108:111], a[4:7]
M a[4:7], a[184:187], a[104:107], a[4:7]
M a[8:11], a[184:187], a[112:115], a[8:11]
buffer_load_dwordx4 v4, s[8:11], s3 offen offset:2048 lds
M a[8:11], a[188:191], a[116:119], a[8:11]
M a[12:15], a[188:191], a[124:127], a[12:15]
M a[12:15], a[184:187], a[120:123], a[12:15]
M a[16:19], a[184:187], a[128:131], a[16:19]
M a[16:19], a[188:191], a[132:135], a[16:19]
buffer_load_dwordx4 v5, s[8:11], s3 offen offset:3072 lds
M a[20:23], a[188:191], a[140:143], a[20:23]
M a[20:23], a[184:187], a[136:139], a[20:23]
M a[24:27], a[184:187], a[144:147], a[24:27]
M a[24:27], a[188:191], a[148:151], a[24:27]
M a[28:31], a[188:191], a[156:159], a[28:31]
M a[28:31], a[184:187], a[152:155], a[28:31]
s_waitcnt lgkmcnt(2)
M v[32:35], a[160:163], a[32:35], v[32:35]
s_add_u32 s23, s23, 128
s_cmp_eq_u32 s23, s25
s_cselect_b32 s23, s26, s23
M v[32:35], a[164:167], a[36:39], v[32:35]
ds_read_b128 a[176:179], v10 offset:4096
ds_read_b128 a[180:183], v11 offset:4096
M v[36:39], a[164:167], a[44:47], v[36:39]
M v[36:39], a[160:163], a[40:43], v[36:39]
ds_read_b64_tr_b16 a[96:97], v12 offset:32768
ds_read_b64_tr_b16 a[98:99], v12 offset:34816
M v[40:43], a[160:163], a[48:51], v[40:43]
M v[40:43], a[164:167], a[52:55], v[40:43]
M v[44:47], a[164:167], a[60:63], v[44:47]
s_add_u32 m0, s29, 81920
s_nop 0
buffer_load_dwordx4 v6, s[12:15], s24 offen offset:0 lds
M v[44:47], a[160:163], a[56:59], v[44:47]
ds_read_b64_tr_b16 a[104:105], v13 offset:32768
ds_read_b64_tr_b16 a[106:107], v13 offset:34816
M v[48:51], a[160:163], a[64:67], v[48:51]
M v[48:51], a[164:167], a[68:71], v[48:51]
M v[52:55], a[164:167], a[76:79], v[52:55]
M v[52:55], a[160:163], a[72:75], v[52:55]
ds_read_b64_tr_b16 a[112:113], v14 offset:32768
ds_read_b64_tr_b16 a[114:115], v14 offset:34816
M v[56:59], a[160:163], a[80:83], v[56:59]
M v[56:59], a[164:167], a[84:87], v[56:59]
buffer_load_dwordx4 v7, s[12:15], s24 offen offset:1024 lds
M v[60:63], a[164:167], a[92:95], v[60:63]
M v[60:63], a[160:163], a[88:91], v[60:63]
s_waitcnt lgkmcnt(8)
ds_read_b64_tr_b16 a[120:121], v15 offset:32768
ds_read_b64_tr_b16 a[122:123], v15 offset:34816
M v[64:67], a[168:171], a[32:35], v[64:67]
M v[64:67], a[172:175], a[36:39], v[64:67]
ds_read_b128 a[184:187], v10 offset:6144
ds_read_b128 a[188:191], v11 offset:6144
M v[68:71], a[172:175], a[44:47], v[68:71]
M v[68:71], a[168:171], a[40:43], v[68:71]
ds_read_b64_tr_b16 a[128:129], v16 offset:32768
ds_read_b64_tr_b16 a[130:131], v16 offset:34816
M v[72:75], a[168:171], a[48:51], v[72:75]
buffer_load_dwordx4 v8, s[12:15], s24 offen offset:2048 lds
M v[72:75], a[172:175], a[52:55], v[72:75]
M v[76:79], a[172:175], a[60:63], v[76:79]
M v[76:79], a[168:171], a[56:59], v[76:79]
ds_read_b64_tr_b16 a[136:137], v17 offset:32768
ds_read_b64_tr_b16 a[138:139], v17 offset:34816
M v[80:83], a[168:171], a[64:67], v[80:83]
M v[80:83], a[172:175], a[68:71], v[80:83]
M v[84:87], a[172:175], a[76:79], v[84:87]
buffer_load_dwordx4 v9, s[12:15], s24 offen offset:3072 lds
M v[84:87], a[168:171], a[72:75], v[84:87]
ds_read_b64_tr_b16 a[144:145], v18 offset:32768
ds_read_b64_tr_b16 a[146:147], v18 offset:34816
M v[88:91], a[168:171], a[80:83], v[88:91]
M v[88:91], a[172:175], a[84:87], v[88:91]
M v[92:95], a[172:175], a[92:95], v[92:95]
M v[92:95], a[168:171], a[88:91], v[92:95]
s_waitcnt lgkmcnt(15)
ds_read_b64_tr_b16 a[152:153], v19 offset:32768
ds_read_b64_tr_b16 a[154:155], v19 offset:34816
M v[96:99], a[176:179], a[32:35], v[96:99]
s_add_u32 s24, s24, 262144
s_cmp_eq_u32 s24, s27
s_cselect_b32 s24, s28, s24
s_sub_u32 s6, s6, 1
s_cmp_eq_u32 s6, 0
s_cselect_b64 s[12:13], s[64:65], s[12:13]
M v[96:99], a[180:183], a[36:39], v[96:99]
M v[100:103], a[180:183], a[44:47], v[100:103]
M v[100:103], a[176:179], a[40:43], v[100:103]
M v[104:107], a[176:179], a[48:51], v[104:107]
M v[104:107], a[180:183], a[52:55], v[104:107]
M v[108:111], a[180:183], a[60:63], v[108:111]
M v[108:111], a[176:179], a[56:59], v[108:111]
s_waitcnt vmcnt(16) lgkmcnt(0)
s_barrier
ds_read_b128 a[160:163], v10 offset:16384
ds_read_b128 a[164:167], v11 offset:16384
M v[112:115], a[176:179], a[64:67], v[112:115]
s_add_u32 m0, s29, 0
s_nop 0
buffer_load_dwordx4 v2, s[8:11], s23 offen offset:0 lds
M v[112:115], a[180:183], a[68:71], v[112:115]
M v[116:119], a[180:183], a[76:79], v[116:119]
M v[116:119], a[176:179], a[72:75], v[116:119]
ds_read_b64_tr_b16 a[100:101], v12 offset:49152
ds_read_b64_tr_b16 a[102:103], v12 offset:51200
M v[120:123], a[176:179], a[80:83], v[120:123]
M v[120:123], a[180:183], a[84:87], v[120:123]
M v[124:127], a[180:183], a[92:95], v[124:127]
buffer_load_dwordx4 v3, s[8:11], s23 offen offset:1024 lds
M v[124:127], a[176:179], a[88:91], v[124:127]
M v[128:131], a[184:187], a[32:35], v[128:131]
M v[128:131], a[188:191], a[36:39], v[128:131]
ds_read_b128 a[168:171], v10 offset:18432
ds_read_b128 a[172:175], v11 offset:18432
ds_read_b64_tr_b16 a[108:109], v13 offset:49152
ds_read_b64_tr_b16 a[110:111], v13 offset:51200
M v[132:135], a[188:191], a[44:47], v[132:135]
M v[132:135], a[184:187], a[40:43], v[132:135]
M v[136:139], a[184:187], a[48:51], v[136:139]
M v[136:139], a[188:191], a[52:55], v[136:139]
buffer_load_dwordx4 v4, s[8:11], s23 offen offset:2048 lds
M v[140:143], a[188:191], a[60:63], v[140:143]
M v[140:143], a[184:187], a[56:59], v[140:143]
ds_read_b64_tr_b16 a[116:117], v14 offset:49152
ds_read_b64_tr_b16 a[118:119], v14 offset:51200
M v[144:147], a[184:187], a[64:67], v[144:147]
M v[144:147], a[188:191], a[68:71], v[144:147]
M v[148:151], a[188:191], a[76:79], v[148:151]
M v[148:151], a[184:187], a[72:75], v[148:151]
M v[152:155], a[184:187], a[80:83], v[152:155]
buffer_load_dwordx4 v5, s[8:11], s23 offen offset:3072 lds
M v[152:155], a[188:191], a[84:87], v[152:155]
ds_read_b64_tr_b16 a[124:125], v15 offset:49152
ds_read_b64_tr_b16 a[126:127], v15 offset:51200
M v[156:159], a[188:191], a[92:95], v[156:159]
M v[156:159], a[184:187], a[88:91], v[156:159]
s_waitcnt lgkmcnt(10)
M v[160:163], a[160:163], a[32:35], v[160:163]
M v[160:163], a[164:167], a[36:39], v[160:163]
ds_read_b128 a[176:179], v10 offset:20480
ds_read_b128 a[180:183], v11 offset:20480
M v[164:167], a[164:167], a[44:47], v[164:167]
M v[164:167], a[160:163], a[40:43], v[164:167]
ds_read_b64_tr_b16 a[132:133], v16 offset:49152
ds_read_b64_tr_b16 a[134:135], v16 offset:51200
M v[168:171], a[160:163], a[48:51], v[168:171]
M v[168:171], a[164:167], a[52:55], v[168:171]
s_add_u32 m0, s29, 98304
s_nop 0
buffer_load_dwordx4 v6, s[12:15], s24 offen offset:0 lds
M v[172:175], a[164:167], a[60:63], v[172:175]
M v[172:175], a[160:163], a[56:59], v[172:175]
M v[176:179], a[160:163], a[64:67], v[176:179]
M v[176:179], a[164:167], a[68:71], v[176:179]
ds_read_b64_tr_b16 a[140:141], v17 offset:49152
ds_read_b64_tr_b16 a[142:143], v17 offset:51200
M v[180:183], a[164:167], a[76:79], v[180:183]
M v[180:183], a[160:163], a[72:75], v[180:183]
buffer_load_dwordx4 v7, s[12:15], s24 offen offset:1024 lds
M v[184:187], a[160:163], a[80:83], v[184:187]
M v[184:187], a[164:167], a[84:87], v[184:187]
M v[188:191], a[164:167], a[92:95], v[188:191]
M v[188:191], a[160:163], a[88:91], v[188:191]
s_waitcnt lgkmcnt(12)
ds_read_b64_tr_b16 a[148:149], v18 offset:49152
ds_read_b64_tr_b16 a[150:151], v18 offset:51200
M v[192:195], a[168:171], a[32:35], v[192:195]
M v[192:195], a[172:175], a[36:39], v[192:195]
ds_read_b128 a[184:187], v10 offset:22528
ds_read_b128 a[188:191], v11 offset:22528
M v[196:199], a[172:175], a[44:47], v[196:199]
M v[196:199], a[168:171], a[40:43], v[196:199]
buffer_load_dwordx4 v8, s[12:15], s24 offen offset:2048 lds
M v[200:203], a[168:171], a[48:51], v[200:203]
M v[200:203], a[172:175], a[52:55], v[200:203]
ds_read_b64_tr_b16 a[156:157], v19 offset:49152
ds_read_b64_tr_b16 a[158:159], v19 offset:51200
M v[204:207], a[172:175], a[60:63], v[204:207]
M v[204:207], a[168:171], a[56:59], v[204:207]
M v[208:211], a[168:171], a[64:67], v[208:211]
M v[208:211], a[172:175], a[68:71], v[208:211]
buffer_load_dwordx4 v9, s[12:15], s24 offen offset:3072 lds
M v[212:215], a[172:175], a[76:79], v[212:215]
M v[212:215], a[168:171], a[72:75], v[212:215]
M v[216:219], a[168:171], a[80:83], v[216:219]
M v[216:219], a[172:175], a[84:87], v[216:219]
M v[220:223], a[172:175], a[92:95], v[220:223]
s_add_u32 s24, s24, 262144
M v[220:223], a[168:171], a[88:91], v[220:223]
s_waitcnt lgkmcnt(10)
M v[224:227], a[176:179], a[32:35], v[224:227]
M v[224:227], a[180:183], a[36:39], v[224:227]
M v[228:231], a[180:183], a[44:47], v[228:231]
M v[228:231], a[176:179], a[40:43], v[228:231]
M v[232:235], a[176:179], a[48:51], v[232:235]
M v[232:235], a[180:183], a[52:55], v[232:235]
M v[236:239], a[180:183], a[60:63], v[236:239]
M v[236:239], a[176:179], a[56:59], v[236:239]
s_waitcnt vmcnt(16) lgkmcnt(0)
s_barrier
ds_read_b128 a[160:163], v10 offset:32768
ds_read_b128 a[164:167], v11 offset:32768
M v[240:243], a[176:179], a[64:67], v[240:243]
s_add_u32 m0, s29, 16384
s_add_u32 s3, s23, s31
buffer_load_dwordx4 v2, s[8:11], s3 offen offset:0 lds
M v[240:243], a[180:183], a[68:71], v[240:243]
M v[244:247], a[180:183], a[76:79], v[244:247]
M v[244:247], a[176:179], a[72:75], v[244:247]
M v[248:251], a[176:179], a[80:83], v[248:251]
M v[248:251], a[180:183], a[84:87], v[248:251]
buffer_load_dwordx4 v3, s[8:11], s3 offen offset:1024 lds
M v[252:255], a[180:183], a[92:95], v[252:255]
M v[252:255], a[176:179], a[88:91], v[252:255]
M a[0:3], a[184:187], a[32:35], a[0:3]
M a[0:3], a[188:191], a[36:39], a[0:3]
ds_read_b128 a[168:171], v10 offset:34816
ds_read_b128 a[172:175], v11 offset:34816
M a[4:7], a[188:191], a[44:47], a[4:7]
M a[4:7], a[184:187], a[40:43], a[4:7]
M a[8:11], a[184:187], a[48:51], a[8:11]
buffer_load_dwordx4 v4, s[8:11], s3 offen offset:2048 lds
M a[8:11], a[188:191], a[52:55], a[8:11]
M a[12:15], a[188:191], a[60:63], a[12:15]
M a[12:15], a[184:187], a[56:59], a[12:15]
M a[16:19], a[184:187], a[64:67], a[16:19]
M a[16:19], a[188:191], a[68:71], a[16:19]
buffer_load_dwordx4 v5, s[8:11], s3 offen offset:3072 lds
M a[20:23], a[188:191], a[76:79], a[20:23]
M a[20:23], a[184:187], a[72:75], a[20:23]
M a[24:27], a[184:187], a[80:83], a[24:27]
M a[24:27], a[188:191], a[84:87], a[24:27]
M a[28:31], a[188:191], a[92:95], a[28:31]
M a[28:31], a[184:187], a[88:91], a[28:31]
s_waitcnt lgkmcnt(2)
M v[32:35], a[160:163], a[96:99], v[32:35]
s_add_u32 s23, s23, 128
s_cmp_eq_u32 s23, s25
s_cselect_b32 s23, s26, s23
M v[32:35], a[164:167], a[100:103], v[32:35]
ds_read_b128 a[176:179], v10 offset:36864
ds_read_b128 a[180:183], v11 offset:36864
M v[36:39], a[164:167], a[108:111], v[36:39]
M v[36:39], a[160:163], a[104:107], v[36:39]
ds_read_b64_tr_b16 a[32:33], v12 offset:0
ds_read_b64_tr_b16 a[34:35], v12 offset:2048
M v[40:43], a[160:163], a[112:115], v[40:43]
M v[40:43], a[164:167], a[116:119], v[40:43]
M v[44:47], a[164:167], a[124:127], v[44:47]
s_add_u32 m0, s29, 114688
s_nop 0
buffer_load_dwordx4 v6, s[12:15], s24 offen offset:0 lds
M v[44:47], a[160:163], a[120:123], v[44:47]
ds_read_b64_tr_b16 a[40:41], v13 offset:0
ds_read_b64_tr_b16 a[42:43], v13 offset:2048
M v[48:51], a[160:163], a[128:131], v[48:51]
M v[48:51], a[164:167], a[132:135], v[48:51]
M v[52:55], a[164:167], a[140:143], v[52:55]
M v[52:55], a[160:163], a[136:139], v[52:55]
ds_read_b64_tr_b16 a[48:49], v14 offset:0
ds_read_b64_tr_b16 a[50:51], v14 offset:2048
M v[56:59], a[160:163], a[144:147], v[56:59]
M v[56:59], a[164:167], a[148:151], v[56:59]
buffer_load_dwordx4 v7, s[12:15], s24 offen offset:1024 lds
M v[60:63], a[164:167], a[156:159], v[60:63]
M v[60:63], a[160:163], a[152:155], v[60:63]
s_waitcnt lgkmcnt(8)
ds_read_b64_tr_b16 a[56:57], v15 offset:0
ds_read_b64_tr_b16 a[58:59], v15 offset:2048
M v[64:67], a[168:171], a[96:99], v[64:67]
M v[64:67], a[172:175], a[100:103], v[64:67]
ds_read_b128 a[184:187], v10 offset:38912
ds_read_b128 a[188:191], v11 offset:38912
M v[68:71], a[172:175], a[108:111], v[68:71]
M v[68:71], a[168:171], a[104:107], v[68:71]
ds_read_b64_tr_b16 a[64:65], v16 offset:0
ds_read_b64_tr_b16 a[66:67], v16 offset:2048
M v[72:75], a[168:171], a[112:115], v[72:75]
buffer_load_dwordx4 v8, s[12:15], s24 offen offset:2048 lds
M v[72:75], a[172:175], a[116:119], v[72:75]
M v[76:79], a[172:175], a[124:127], v[76:79]
M v[76:79], a[168:171], a[120:123], v[76:79]
ds_read_b64_tr_b16 a[72:73], v17 offset:0
ds_read_b64_tr_b16 a[74:75], v17 offset:2048
M v[80:83], a[168:171], a[128:131], v[80:83]
M v[80:83], a[172:175], a[132:135], v[80:83]
M v[84:87], a[172:175], a[140:143], v[84:87]
buffer_load_dwordx4 v9, s[12:15], s24 offen offset:3072 lds
M v[84:87], a[168:171], a[136:139], v[84:87]
ds_read_b64_tr_b16 a[80:81], v18 offset:0
ds_read_b64_tr_b16 a[82:83], v18 offset:2048
M v[88:91], a[168:171], a[144:147], v[88:91]
M v[88:91], a[172:175], a[148:151], v[88:91]
M v[92:95], a[172:175], a[156:159], v[92:95]
M v[92:95], a[168:171], a[152:155], v[92:95]
s_waitcnt lgkmcnt(15)
ds_read_b64_tr_b16 a[88:89], v19 offset:0
ds_read_b64_tr_b16 a[90:91], v19 offset:2048
M v[96:99], a[176:179], a[96:99], v[96:99]
s_add_u32 s24, s24, 262144
s_cmp_eq_u32 s24, s27
s_cselect_b32 s24, s28, s24
s_sub_u32 s6, s6, 1
s_cmp_eq_u32 s6, 0
s_cselect_b64 s[12:13], s[64:65], s[12:13]
M v[96:99], a[180:183], a[100:103], v[96:99]
M v[100:103], a[180:183], a[108:111], v[100:103]
M v[100:103], a[176:179], a[104:107], v[100:103]
M v[104:107], a[176:179], a[112:115], v[104:107]
M v[104:107], a[180:183], a[116:119], v[104:107]
M v[108:111], a[180:183], a[124:127], v[108:111]
M v[108:111], a[176:179], a[120:123], v[108:111]
s_waitcnt vmcnt(16) lgkmcnt(0)
s_barrier
ds_read_b128 a[160:163], v10 offset:49152
ds_read_b128 a[164:167], v11 offset:49152
M v[112:115], a[176:179], a[128:131], v[112:115]
s_add_u32 m0, s29, 32768
s_nop 0
buffer_load_dwordx4 v2, s[8:11], s23 offen offset:0 lds
M v[112:115], a[180:183], a[132:135], v[112:115]
M v[116:119], a[180:183], a[140:143], v[116:119]
M v[116:119], a[176:179], a[136:139], v[116:119]
ds_read_b64_tr_b16 a[36:37], v12 offset:16384
ds_read_b64_tr_b16 a[38:39], v12 offset:18432
M v[120:123], a[176:179], a[144:147], v[120:123]
M v[120:123], a[180:183], a[148:151], v[120:123]
M v[124:127], a[180:183], a[156:159], v[124:127]
M v[124:127], a[176:179], a[152:155], v[124:127]
M v[128:131], a[184:187], a[96:99], v[128:131]
M v[128:131], a[188:191], a[100:103], v[128:131]
ds_read_b128 a[168:171], v10 offset:51200
ds_read_b128 a[172:175], v11 offset:51200
ds_read_b64_tr_b16 a[44:45], v13 offset:16384
ds_read_b64_tr_b16 a[46:47], v13 offset:18432
M v[132:135], a[188:191], a[108:111], v[132:135]
M v[132:135], a[184:187], a[104:107], v[132:135]
M v[136:139], a[184:187], a[112:115], v[136:139]
M v[136:139], a[188:191], a[116:119], v[136:139]
M v[140:143], a[188:191], a[124:127], v[140:143]
M v[140:143], a[184:187], a[120:123], v[140:143]
ds_read_b64_tr_b16 a[52:53], v14 offset:16384
ds_read_b64_tr_b16 a[54:55], v14 offset:18432
M v[144:147], a[184:187], a[128:131], v[144:147]
buffer_load_dwordx4 v3, s[8:11], s23 offen offset:1024 lds
M v[144:147], a[188:191], a[132:135], v[144:147]
M v[148:151], a[188:191], a[140:143], v[148:151]
M v[148:151], a[184:187], a[136:139], v[148:151]
M v[152:155], a[184:187], a[144:147], v[152:155]
M v[152:155], a[188:191], a[148:151], v[152:155]
ds_read_b64_tr_b16 a[60:61], v15 offset:16384
ds_read_b64_tr_b16 a[62:63], v15 offset:18432
M v[156:159], a[188:191], a[156:159], v[156:159]
M v[156:159], a[184:187], a[152:155], v[156:159]
s_waitcnt lgkmcnt(10)
M v[160:163], a[160:163], a[96:99], v[160:163]
M v[160:163], a[164:167], a[100:103], v[160:163]
ds_read_b128 a[176:179], v10 offset:53248
ds_read_b128 a[180:183], v11 offset:53248
M v[164:167], a[164:167], a[108:111], v[164:167]
M v[164:167], a[160:163], a[104:107], v[164:167]
ds_read_b64_tr_b16 a[68:69], v16 offset:16384
ds_read_b64_tr_b16 a[70:71], v16 offset:18432
M v[168:171], a[160:163], a[112:115], v[168:171]
M v[168:171], a[164:167], a[116:119], v[168:171]
M v[172:175], a[164:167], a[124:127], v[172:175]
M v[172:175], a[160:163], a[120:123], v[172:175]
M v[176:179], a[160:163], a[128:131], v[176:179]
buffer_load_dwordx4 v4, s[8:11], s23 offen offset:2048 lds
M v[176:179], a[164:167], a[132:135], v[176:179]
ds_read_b64_tr_b16 a[76:77], v17 offset:16384
ds_read_b64_tr_b16 a[78:79], v17 offset:18432
M v[180:183], a[164:167], a[140:143], v[180:183]
M v[180:183], a[160:163], a[136:139], v[180:183]
M v[184:187], a[160:163], a[144:147], v[184:187]
M v[184:187], a[164:167], a[148:151], v[184:187]
M v[188:191], a[164:167], a[156:159], v[188:191]
M v[188:191], a[160:163], a[152:155], v[188:191]
s_waitcnt lgkmcnt(12)
ds_read_b64_tr_b16 a[84:85], v18 offset:16384
ds_read_b64_tr_b16 a[86:87], v18 offset:18432
M v[192:195], a[168:171], a[96:99], v[192:195]
M v[192:195], a[172:175], a[100:103], v[192:195]
ds_read_b128 a[184:187], v10 offset:55296
ds_read_b128 a[188:191], v11 offset:55296
M v[196:199], a[172:175], a[108:111], v[196:199]
M v[196:199], a[168:171], a[104:107], v[196:199]
M v[200:203], a[168:171], a[112:115], v[200:203]
M v[200:203], a[172:175], a[116:119], v[200:203]
ds_read_b64_tr_b16 a[92:93], v19 offset:16384
ds_read_b64_tr_b16 a[94:95], v19 offset:18432
M v[204:207], a[172:175], a[124:127], v[204:207]
M v[204:207], a[168:171], a[120:123], v[204:207]
M v[208:211], a[168:171], a[128:131], v[208:211]
buffer_load_dwordx4 v5, s[8:11], s23 offen offset:3072 lds
M v[208:211], a[172:175], a[132:135], v[208:211]
M v[212:215], a[172:175], a[140:143], v[212:215]
M v[212:215], a[168:171], a[136:139], v[212:215]
M v[216:219], a[168:171], a[144:147], v[216:219]
M v[216:219], a[172:175], a[148:151], v[216:219]
M v[220:223], a[172:175], a[156:159], v[220:223]
M v[220:223], a[168:171], a[152:155], v[220:223]
s_waitcnt lgkmcnt(10)
M v[224:227], a[176:179], a[96:99], v[224:227]
M v[224:227], a[180:183], a[100:103], v[224:227]
M v[228:231], a[180:183], a[108:111], v[228:231]
M v[228:231], a[176:179], a[104:107], v[228:231]
M v[232:235], a[176:179], a[112:115], v[232:235]
M v[232:235], a[180:183], a[116:119], v[232:235]
M v[236:239], a[180:183], a[124:127], v[236:239]
M v[236:239], a[176:179], a[120:123], v[236:239]
s_waitcnt vmcnt(12) lgkmcnt(0)
s_barrier
ds_read_b128 a[160:163], v10 offset:0
ds_read_b128 a[164:167], v11 offset:0
M v[240:243], a[176:179], a[128:131], v[240:243]
s_add_u32 m0, s29, 49152
s_add_u32 s3, s23, s31
buffer_load_dwordx4 v2, s[8:11], s3 offen offset:0 lds
M v[240:243], a[180:183], a[132:135], v[240:243]
M v[244:247], a[180:183], a[140:143], v[244:247]
M v[244:247], a[176:179], a[136:139], v[244:247]
M v[248:251], a[176:179], a[144:147], v[248:251]
M v[248:251], a[180:183], a[148:151], v[248:251]
M v[252:255], a[180:183], a[156:159], v[252:255]
M v[252:255], a[176:179], a[152:155], v[252:255]
M a[0:3], a[184:187], a[96:99], a[0:3]
M a[0:3], a[188:191], a[100:103], a[0:3]
ds_read_b128 a[168:171], v10 offset:2048
ds_read_b128 a[172:175], v11 offset:2048
M a[4:7], a[188:191], a[108:111], a[4:7]
M a[4:7], a[184:187], a[104:107], a[4:7]
M a[8:11], a[184:187], a[112:115], a[8:11]
buffer_load_dwordx4 v3, s[8:11], s3 offen offset:1024 lds
M a[8:11], a[188:191], a[116:119], a[8:11]
M a[12:15], a[188:191], a[124:127], a[12:15]
M a[12:15], a[184:187], a[120:123], a[12:15]
M a[16:19], a[184:187], a[128:131], a[16:19]
M a[16:19], a[188:191], a[132:135], a[16:19]
M a[20:23], a[188:191], a[140:143], a[20:23]
M a[20:23], a[184:187], a[136:139], a[20:23]
M a[24:27], a[184:187], a[144:147], a[24:27]
M a[24:27], a[188:191], a[148:151], a[24:27]
M a[28:31], a[188:191], a[156:159], a[28:31]
M a[28:31], a[184:187], a[152:155], a[28:31]
s_waitcnt lgkmcnt(2)
M v[32:35], a[160:163], a[32:35], v[32:35]
buffer_load_dwordx4 v4, s[8:11], s3 offen offset:2048 lds
M v[32:35], a[164:167], a[36:39], v[32:35]
ds_read_b128 a[176:179], v10 offset:4096
ds_read_b128 a[180:183], v11 offset:4096
M v[36:39], a[164:167], a[44:47], v[36:39]
M v[36:39], a[160:163], a[40:43], v[36:39]
ds_read_b64_tr_b16 a[96:97], v12 offset:32768
ds_read_b64_tr_b16 a[98:99], v12 offset:34816
M v[40:43], a[160:163], a[48:51], v[40:43]
M v[40:43], a[164:167], a[52:55], v[40:43]
M v[44:47], a[164:167], a[60:63], v[44:47]
M v[44:47], a[160:163], a[56:59], v[44:47]
ds_read_b64_tr_b16 a[104:105], v13 offset:32768
ds_read_b64_tr_b16 a[106:107], v13 offset:34816
M v[48:51], a[160:163], a[64:67], v[48:51]
M v[48:51], a[164:167], a[68:71], v[48:51]
M v[52:55], a[164:167], a[76:79], v[52:55]
M v[52:55], a[160:163], a[72:75], v[52:55]
ds_read_b64_tr_b16 a[112:113], v14 offset:32768
ds_read_b64_tr_b16 a[114:115], v14 offset:34816
M v[56:59], a[160:163], a[80:83], v[56:59]
M v[56:59], a[164:167], a[84:87], v[56:59]
buffer_load_dwordx4 v5, s[8:11], s3 offen offset:3072 lds
M v[60:63], a[164:167], a[92:95], v[60:63]
M v[60:63], a[160:163], a[88:91], v[60:63]
s_waitcnt lgkmcnt(8)
ds_read_b64_tr_b16 a[120:121], v15 offset:32768
ds_read_b64_tr_b16 a[122:123], v15 offset:34816
M v[64:67], a[168:171], a[32:35], v[64:67]
M v[64:67], a[172:175], a[36:39], v[64:67]
ds_read_b128 a[184:187], v10 offset:6144
ds_read_b128 a[188:191], v11 offset:6144
M v[68:71], a[172:175], a[44:47], v[68:71]
M v[68:71], a[168:171], a[40:43], v[68:71]
ds_read_b64_tr_b16 a[128:129], v16 offset:32768
ds_read_b64_tr_b16 a[130:131], v16 offset:34816
M v[72:75], a[168:171], a[48:51], v[72:75]
M v[72:75], a[172:175], a[52:55], v[72:75]
M v[76:79], a[172:175], a[60:63], v[76:79]
M v[76:79], a[168:171], a[56:59], v[76:79]
ds_read_b64_tr_b16 a[136:137], v17 offset:32768
ds_read_b64_tr_b16 a[138:139], v17 offset:34816
M v[80:83], a[168:171], a[64:67], v[80:83]
M v[80:83], a[172:175], a[68:71], v[80:83]
M v[84:87], a[172:175], a[76:79], v[84:87]
s_add_u32 s23, s23, 128
s_cmp_eq_u32 s23, s25
s_cselect_b32 s23, s26, s23
M v[84:87], a[168:171], a[72:75], v[84:87]
ds_read_b64_tr_b16 a[144:145], v18 offset:32768
ds_read_b64_tr_b16 a[146:147], v18 offset:34816
M v[88:91], a[168:171], a[80:83], v[88:91]
M v[88:91], a[172:175], a[84:87], v[88:91]
M v[92:95], a[172:175], a[92:95], v[92:95]
M v[92:95], a[168:171], a[88:91], v[92:95]
s_waitcnt lgkmcnt(15)
ds_read_b64_tr_b16 a[152:153], v19 offset:32768
ds_read_b64_tr_b16 a[154:155], v19 offset:34816
M v[96:99], a[176:179], a[32:35], v[96:99]
M v[96:99], a[180:183], a[36:39], v[96:99]
M v[100:103], a[180:183], a[44:47], v[100:103]
M v[100:103], a[176:179], a[40:43], v[100:103]
M v[104:107], a[176:179], a[48:51], v[104:107]
M v[104:107], a[180:183], a[52:55], v[104:107]
M v[108:111], a[180:183], a[60:63], v[108:111]
M v[108:111], a[176:179], a[56:59], v[108:111]
s_waitcnt vmcnt(8) lgkmcnt(0)
s_barrier
ds_read_b128 a[160:163], v10 offset:16384
ds_read_b128 a[164:167], v11 offset:16384
M v[112:115], a[176:179], a[64:67], v[112:115]
M v[112:115], a[180:183], a[68:71], v[112:115]
s_and_b32 s3, s2, 1
s_lshl_b32 s3, s3, 3
s_bfe_u32 s4, s2, 0x30003
M v[116:119], a[180:183], a[76:79], v[116:119]
s_add_u32 s26, s3, s4
s_bfe_u32 s3, s2, 0x20001
s_lshl_b32 s3, s3, 2
M v[116:119], a[176:179], a[72:75], v[116:119]
ds_read_b64_tr_b16 a[100:101], v12 offset:49152
ds_read_b64_tr_b16 a[102:103], v12 offset:51200
s_lshr_b32 s4, s2, 6
s_xor_b32 s4, s4, 2
s_add_u32 s27, s3, s4
M v[120:123], a[176:179], a[80:83], v[120:123]
s_lshl_b32 s23, s26, 18
s_sub_u32 s24, s23, 32768
M v[120:123], a[180:183], a[84:87], v[120:123]
s_max_i32 s24, s24, 0
s_lshl_b32 s25, s27, 7
s_xor_b32 s3, s26, s27
M v[124:127], a[180:183], a[92:95], v[124:127]
s_and_b32 s3, s3, 0
s_lshl_b32 s3, s3, 3
s_sub_u32 s31, 16, s3
M v[124:127], a[176:179], a[88:91], v[124:127]
s_mov_b32 s54, s31
s_movk_i32 s57, 128
M v[128:131], a[184:187], a[32:35], v[128:131]
s_mov_b32 s55, 4289069056
s_mov_b32 s56, 393216
s_lshl_b32 s4, s3, 7
M v[128:131], a[188:191], a[36:39], v[128:131]
ds_read_b128 a[168:171], v10 offset:18432
ds_read_b128 a[172:175], v11 offset:18432
ds_read_b64_tr_b16 a[108:109], v13 offset:49152
ds_read_b64_tr_b16 a[110:111], v13 offset:51200
s_add_u32 s23, s23, s4
s_add_u32 s24, s24, s4
s_mul_i32 s4, s3, 393216
M v[132:135], a[188:191], a[44:47], v[132:135]
s_add_u32 s25, s25, s4
s_mov_b64 s[8:9], s[44:45]
s_mov_b32 s10, 4194304
M v[132:135], a[184:187], a[40:43], v[132:135]
s_mov_b64 s[12:13], s[46:47]
s_mov_b32 s14, 6291456
M v[136:139], a[184:187], a[48:51], v[136:139]
s_mov_b64 s[36:37], s[90:91]
s_mov_b32 s38, 256
s_mov_b32 s39, 0x00020000
M v[136:139], a[188:191], a[52:55], v[136:139]
s_lshl_b32 s28, s20, 9
s_mul_i32 s30, s20, 6144
s_lshl_b32 s3, s20, 5
M v[140:143], a[188:191], a[60:63], v[140:143]
v_lshrrev_b32 v24, 3, v0
v_and_b32 v25, 7, v0
M v[140:143], a[184:187], a[56:59], v[140:143]
ds_read_b64_tr_b16 a[116:117], v14 offset:49152
ds_read_b64_tr_b16 a[118:119], v14 offset:51200
v_add_u32 v28, s3, v24
v_add_u32 v26, 0, v28
v_bfe_u32 v27, v26, 1, 3
M v[144:147], a[184:187], a[64:67], v[144:147]
v_xor_b32 v27, v27, v25
v_lshlrev_b32 v26, 11, v26
v_lshl_add_u32 v26, v27, 4, v26
M v[144:147], a[188:191], a[68:71], v[144:147]
v_subrev_u32 v2, 0, v26
v_add_u32 v26, 8, v28
v_bfe_u32 v27, v26, 1, 3
M v[148:151], a[188:191], a[76:79], v[148:151]
v_xor_b32 v27, v27, v25
v_lshlrev_b32 v26, 11, v26
M v[148:151], a[184:187], a[72:75], v[148:151]
v_lshl_add_u32 v26, v27, 4, v26
v_subrev_u32 v3, 1024, v26
v_add_u32 v26, 16, v28
M v[152:155], a[184:187], a[80:83], v[152:155]
v_bfe_u32 v27, v26, 1, 3
v_xor_b32 v27, v27, v25
v_lshlrev_b32 v26, 11, v26
M v[152:155], a[188:191], a[84:87], v[152:155]
ds_read_b64_tr_b16 a[124:125], v15 offset:49152
ds_read_b64_tr_b16 a[126:127], v15 offset:51200
v_lshl_add_u32 v26, v27, 4, v26
v_subrev_u32 v4, 2048, v26
M v[156:159], a[188:191], a[92:95], v[156:159]
v_add_u32 v26, 24, v28
v_bfe_u32 v27, v26, 1, 3
v_xor_b32 v27, v27, v25
M v[156:159], a[184:187], a[88:91], v[156:159]
s_waitcnt lgkmcnt(10)
v_lshlrev_b32 v26, 11, v26
v_lshl_add_u32 v26, v27, 4, v26
v_subrev_u32 v5, 3072, v26
M v[160:163], a[160:163], a[32:35], v[160:163]
s_lshl_b32 s3, s20, 2
v_lshrrev_b32 v26, 5, v0
M v[160:163], a[164:167], a[36:39], v[160:163]
ds_read_b128 a[176:179], v10 offset:20480
ds_read_b128 a[180:183], v11 offset:20480
v_add_u32 v26, s3, v26
v_bfe_u32 v29, v0, 2, 3
v_bfe_u32 v27, v26, 1, 3
M v[164:167], a[164:167], a[44:47], v[164:167]
v_xor_b32 v27, v27, v29
v_lshlrev_b32 v27, 4, v27
v_and_b32 v30, 3, v0
M v[164:167], a[160:163], a[40:43], v[164:167]
ds_read_b64_tr_b16 a[132:133], v16 offset:49152
ds_read_b64_tr_b16 a[134:135], v16 offset:51200
v_lshl_add_u32 v27, v30, 2, v27
v_lshl_add_u32 v20, v26, 11, v27
v_add_u32 v26, 2, v26
M v[168:171], a[160:163], a[48:51], v[168:171]
v_bfe_u32 v27, v26, 1, 3
v_xor_b32 v27, v27, v29
M v[168:171], a[164:167], a[52:55], v[168:171]
v_lshlrev_b32 v27, 4, v27
v_and_b32 v30, 3, v0
v_lshl_add_u32 v27, v30, 2, v27
M v[172:175], a[164:167], a[60:63], v[172:175]
v_lshl_add_u32 v23, v26, 11, v27
v_subrev_u32 v23, 256, v23
s_mul_i32 s3, s20, 48
M v[172:175], a[160:163], a[56:59], v[172:175]
v_add_u32 v28, s3, v24
v_add_u32 v26, 0, v28
M v[176:179], a[160:163], a[64:67], v[176:179]
v_mul_u32_u24 v27, 0xaaab, v26
v_lshrrev_b32 v27, 17, v27
v_lshrrev_b32 v29, 1, v27
M v[176:179], a[164:167], a[68:71], v[176:179]
ds_read_b64_tr_b16 a[140:141], v17 offset:49152
ds_read_b64_tr_b16 a[142:143], v17 offset:51200
v_and_b32 v29, 4, v29
v_and_or_b32 v27, v27, 2, v29
v_xor_b32 v27, v27, v25
M v[180:183], a[164:167], a[76:79], v[180:183]
v_lshlrev_b32 v26, 11, v26
v_lshl_add_u32 v26, v27, 4, v26
v_subrev_u32 v6, 0, v26
M v[180:183], a[160:163], a[72:75], v[180:183]
v_add_u32 v26, 8, v28
v_mul_u32_u24 v27, 0xaaab, v26
M v[184:187], a[160:163], a[80:83], v[184:187]
v_lshrrev_b32 v27, 17, v27
v_lshrrev_b32 v29, 1, v27
v_and_b32 v29, 4, v29
M v[184:187], a[164:167], a[84:87], v[184:187]
v_and_or_b32 v27, v27, 2, v29
v_xor_b32 v27, v27, v25
v_lshlrev_b32 v26, 11, v26
M v[188:191], a[164:167], a[92:95], v[188:191]
v_lshl_add_u32 v26, v27, 4, v26
v_subrev_u32 v7, 1024, v26
M v[188:191], a[160:163], a[88:91], v[188:191]
s_waitcnt lgkmcnt(12)
ds_read_b64_tr_b16 a[148:149], v18 offset:49152
ds_read_b64_tr_b16 a[150:151], v18 offset:51200
v_add_u32 v26, 16, v28
v_mul_u32_u24 v27, 0xaaab, v26
v_lshrrev_b32 v27, 17, v27
M v[192:195], a[168:171], a[32:35], v[192:195]
v_lshrrev_b32 v29, 1, v27
v_and_b32 v29, 4, v29
v_and_or_b32 v27, v27, 2, v29
M v[192:195], a[172:175], a[36:39], v[192:195]
ds_read_b128 a[184:187], v10 offset:22528
ds_read_b128 a[188:191], v11 offset:22528
v_xor_b32 v27, v27, v25
v_lshlrev_b32 v26, 11, v26
M v[196:199], a[172:175], a[44:47], v[196:199]
v_lshl_add_u32 v26, v27, 4, v26
v_subrev_u32 v8, 2048, v26
v_add_u32 v26, 24, v28
M v[196:199], a[168:171], a[40:43], v[196:199]
v_mul_u32_u24 v27, 0xaaab, v26
v_lshrrev_b32 v27, 17, v27
v_lshrrev_b32 v29, 1, v27
M v[200:203], a[168:171], a[48:51], v[200:203]
v_and_b32 v29, 4, v29
v_and_or_b32 v27, v27, 2, v29
v_xor_b32 v27, v27, v25
M v[200:203], a[172:175], a[52:55], v[200:203]
ds_read_b64_tr_b16 a[156:157], v19 offset:49152
ds_read_b64_tr_b16 a[158:159], v19 offset:51200
v_lshlrev_b32 v26, 11, v26
v_lshl_add_u32 v26, v27, 4, v26
M v[204:207], a[172:175], a[60:63], v[204:207]
v_subrev_u32 v9, 3072, v26
v_add_u32 v26, 32, v28
v_mul_u32_u24 v27, 0xaaab, v26
M v[204:207], a[168:171], a[56:59], v[204:207]
v_lshrrev_b32 v27, 17, v27
v_lshrrev_b32 v29, 1, v27
v_and_b32 v29, 4, v29
M v[208:211], a[168:171], a[64:67], v[208:211]
v_and_or_b32 v27, v27, 2, v29
v_xor_b32 v27, v27, v25
M v[208:211], a[172:175], a[68:71], v[208:211]
v_lshlrev_b32 v26, 11, v26
v_lshl_add_u32 v26, v27, 4, v26
v_subrev_u32 v21, 0, v26
M v[212:215], a[172:175], a[76:79], v[212:215]
v_add_u32 v26, 40, v28
v_mul_u32_u24 v27, 0xaaab, v26
v_lshrrev_b32 v27, 17, v27
M v[212:215], a[168:171], a[72:75], v[212:215]
v_lshrrev_b32 v29, 1, v27
v_and_b32 v29, 4, v29
v_and_or_b32 v27, v27, 2, v29
M v[216:219], a[168:171], a[80:83], v[216:219]
v_xor_b32 v27, v27, v25
v_lshlrev_b32 v26, 11, v26
M v[216:219], a[172:175], a[84:87], v[216:219]
v_lshl_add_u32 v26, v27, 4, v26
v_subrev_u32 v22, 1024, v26
s_lshr_b32 s3, s53, 7
M v[220:223], a[172:175], a[92:95], v[220:223]
s_add_u32 s3, s3, s22
s_lshl_b32 s3, s3, 5
s_lshr_b32 s19, s52, 6
M v[220:223], a[168:171], a[88:91], v[220:223]
s_waitcnt lgkmcnt(10)
s_add_u32 s3, s3, s19
s_lshl_b32 s19, s21, 1
M v[224:227], a[176:179], a[32:35], v[224:227]
s_add_u32 s3, s3, s19
s_lshl_b32 s92, s3, 15
s_add_u32 s92, s92, 16384
M v[224:227], a[180:183], a[36:39], v[224:227]
s_add_u32 s93, s92, 32768
s_add_u32 s16, s50, 16777216
s_addc_u32 s17, s51, 0
M v[228:231], a[180:183], a[44:47], v[228:231]
s_mov_b32 s18, 33554432
s_mov_b32 s19, 0x00020000
M v[228:231], a[176:179], a[40:43], v[228:231]
M v[232:235], a[176:179], a[48:51], v[232:235]
M v[232:235], a[180:183], a[52:55], v[232:235]
M v[236:239], a[180:183], a[60:63], v[236:239]
M v[236:239], a[176:179], a[56:59], v[236:239]
s_waitcnt vmcnt(4) lgkmcnt(0)
s_barrier
ds_read_b128 a[160:163], v10 offset:32768
ds_read_b128 a[164:167], v11 offset:32768
M v[240:243], a[176:179], a[64:67], v[240:243]
s_add_u32 m0, s28, 131072
s_nop 0
buffer_load_dword v20, s[8:11], s24 offen lds
M v[240:243], a[180:183], a[68:71], v[240:243]
M v[244:247], a[180:183], a[76:79], v[244:247]
M v[244:247], a[176:179], a[72:75], v[244:247]
buffer_load_dword v23, s[8:11], s24 offen offset:256 lds
M v[248:251], a[176:179], a[80:83], v[248:251]
M v[248:251], a[180:183], a[84:87], v[248:251]
M v[252:255], a[180:183], a[92:95], v[252:255]
M v[252:255], a[176:179], a[88:91], v[252:255]
M a[0:3], a[184:187], a[32:35], a[0:3]
s_add_u32 m0, s29, 133120
s_nop 0
buffer_load_dwordx4 v2, s[8:11], s23 offen offset:0 lds
M a[0:3], a[188:191], a[36:39], a[0:3]
ds_read_b128 a[168:171], v10 offset:34816
ds_read_b128 a[172:175], v11 offset:34816
M a[4:7], a[188:191], a[44:47], a[4:7]
M a[4:7], a[184:187], a[40:43], a[4:7]
M a[8:11], a[184:187], a[48:51], a[8:11]
buffer_load_dwordx4 v3, s[8:11], s23 offen offset:1024 lds
M a[8:11], a[188:191], a[52:55], a[8:11]
M a[12:15], a[188:191], a[60:63], a[12:15]
M a[12:15], a[184:187], a[56:59], a[12:15]
M a[16:19], a[184:187], a[64:67], a[16:19]
buffer_load_dwordx4 v4, s[8:11], s23 offen offset:2048 lds
M a[16:19], a[188:191], a[68:71], a[16:19]
M a[20:23], a[188:191], a[76:79], a[20:23]
M a[20:23], a[184:187], a[72:75], a[20:23]
buffer_load_dwordx4 v5, s[8:11], s23 offen offset:3072 lds
M a[24:27], a[184:187], a[80:83], a[24:27]
M a[24:27], a[188:191], a[84:87], a[24:27]
M a[28:31], a[188:191], a[92:95], a[28:31]
M a[28:31], a[184:187], a[88:91], a[28:31]
s_waitcnt lgkmcnt(2)
M v[32:35], a[160:163], a[96:99], v[32:35]
s_sub_u32 s31, s31, 1
s_cmp_eq_u32 s31, 0
s_cselect_b32 s58, -1920, s57
s_add_u32 s23, s23, s58
s_add_u32 s24, s24, s58
M v[32:35], a[164:167], a[100:103], v[32:35]
ds_read_b128 a[176:179], v10 offset:36864
ds_read_b128 a[180:183], v11 offset:36864
M v[36:39], a[164:167], a[108:111], v[36:39]
M v[36:39], a[160:163], a[104:107], v[36:39]
M v[40:43], a[160:163], a[112:115], v[40:43]
M v[40:43], a[164:167], a[116:119], v[40:43]
s_add_u32 m0, s30, 65536
s_nop 0
buffer_load_dwordx4 v6, s[12:15], s25 offen offset:0 lds
M v[44:47], a[164:167], a[124:127], v[44:47]
M v[44:47], a[160:163], a[120:123], v[44:47]
M v[48:51], a[160:163], a[128:131], v[48:51]
M v[48:51], a[164:167], a[132:135], v[48:51]
buffer_load_dwordx4 v7, s[12:15], s25 offen offset:1024 lds
M v[52:55], a[164:167], a[140:143], v[52:55]
M v[52:55], a[160:163], a[136:139], v[52:55]
M v[56:59], a[160:163], a[144:147], v[56:59]
M v[56:59], a[164:167], a[148:151], v[56:59]
buffer_load_dwordx4 v8, s[12:15], s25 offen offset:2048 lds
M v[60:63], a[164:167], a[156:159], v[60:63]
M v[60:63], a[160:163], a[152:155], v[60:63]
s_waitcnt lgkmcnt(2)
M v[64:67], a[168:171], a[96:99], v[64:67]
M v[64:67], a[172:175], a[100:103], v[64:67]
ds_read_b128 a[184:187], v10 offset:38912
ds_read_b128 a[188:191], v11 offset:38912
M v[68:71], a[172:175], a[108:111], v[68:71]
M v[68:71], a[168:171], a[104:107], v[68:71]
buffer_load_dwordx4 v9, s[12:15], s25 offen offset:3072 lds
M v[72:75], a[168:171], a[112:115], v[72:75]
M v[72:75], a[172:175], a[116:119], v[72:75]
M v[76:79], a[172:175], a[124:127], v[76:79]
M v[76:79], a[168:171], a[120:123], v[76:79]
s_add_u32 m0, s30, 69632
s_nop 0
buffer_load_dwordx4 v21, s[12:15], s25 offen offset:0 lds
M v[80:83], a[168:171], a[128:131], v[80:83]
M v[80:83], a[172:175], a[132:135], v[80:83]
M v[84:87], a[172:175], a[140:143], v[84:87]
M v[84:87], a[168:171], a[136:139], v[84:87]
buffer_load_dwordx4 v22, s[12:15], s25 offen offset:1024 lds
M v[88:91], a[168:171], a[144:147], v[88:91]
M v[88:91], a[172:175], a[148:151], v[88:91]
M v[92:95], a[172:175], a[156:159], v[92:95]
M v[92:95], a[168:171], a[152:155], v[92:95]
s_waitcnt lgkmcnt(2)
M v[96:99], a[176:179], a[96:99], v[96:99]
s_sub_u32 s54, s54, 1
s_cmp_eq_u32 s54, 0
s_cselect_b32 s58, s55, s56
s_add_u32 s25, s25, s58
M v[96:99], a[180:183], a[100:103], v[96:99]
M v[100:103], a[180:183], a[108:111], v[100:103]
M v[100:103], a[176:179], a[104:107], v[100:103]
v_cvt_pk_bf16_f32 v32, v32, v33
v_cvt_pk_bf16_f32 v33, v34, v35
M v[104:107], a[176:179], a[112:115], v[104:107]
v_cvt_pk_bf16_f32 v34, v64, v65
v_cvt_pk_bf16_f32 v35, v66, v67
M v[104:107], a[180:183], a[116:119], v[104:107]
v_cvt_pk_bf16_f32 v64, v48, v49
M v[108:111], a[180:183], a[124:127], v[108:111]
v_cvt_pk_bf16_f32 v65, v50, v51
v_cvt_pk_bf16_f32 v66, v80, v81
M v[108:111], a[176:179], a[120:123], v[108:111]
s_waitcnt vmcnt(12) lgkmcnt(0)
s_barrier
ds_read_b128 a[160:163], v10 offset:49152
ds_read_b128 a[164:167], v11 offset:49152
v_cvt_pk_bf16_f32 v67, v82, v83
M v[112:115], a[176:179], a[128:131], v[112:115]
s_add_u32 m0, s28, 0
s_nop 0
buffer_load_dword v20, s[8:11], s24 offen lds
v_cvt_pk_bf16_f32 v48, v40, v41
v_cvt_pk_bf16_f32 v49, v42, v43
M v[112:115], a[180:183], a[132:135], v[112:115]
v_cvt_pk_bf16_f32 v50, v72, v73
v_cvt_pk_bf16_f32 v51, v74, v75
M v[116:119], a[180:183], a[140:143], v[116:119]
v_cvt_pk_bf16_f32 v80, v56, v57
M v[116:119], a[176:179], a[136:139], v[116:119]
buffer_load_dword v23, s[8:11], s24 offen offset:256 lds
v_cvt_pk_bf16_f32 v81, v58, v59
v_cvt_pk_bf16_f32 v82, v88, v89
M v[120:123], a[176:179], a[144:147], v[120:123]
v_cvt_pk_bf16_f32 v83, v90, v91
M v[120:123], a[180:183], a[148:151], v[120:123]
v_cvt_pk_bf16_f32 v40, v36, v37
v_cvt_pk_bf16_f32 v41, v38, v39
M v[124:127], a[180:183], a[156:159], v[124:127]
v_cvt_pk_bf16_f32 v42, v68, v69
v_cvt_pk_bf16_f32 v43, v70, v71
M v[124:127], a[176:179], a[152:155], v[124:127]
v_cvt_pk_bf16_f32 v72, v52, v53
M v[128:131], a[184:187], a[96:99], v[128:131]
s_add_u32 m0, s29, 2048
s_nop 0
buffer_load_dwordx4 v2, s[8:11], s23 offen offset:0 lds
v_cvt_pk_bf16_f32 v73, v54, v55
v_cvt_pk_bf16_f32 v74, v84, v85
M v[128:131], a[188:191], a[100:103], v[128:131]
ds_read_b128 a[168:171], v10 offset:51200
ds_read_b128 a[172:175], v11 offset:51200
v_cvt_pk_bf16_f32 v75, v86, v87
M v[132:135], a[188:191], a[108:111], v[132:135]
v_cvt_pk_bf16_f32 v56, v44, v45
v_cvt_pk_bf16_f32 v57, v46, v47
M v[132:135], a[184:187], a[104:107], v[132:135]
v_cvt_pk_bf16_f32 v58, v76, v77
v_cvt_pk_bf16_f32 v59, v78, v79
M v[136:139], a[184:187], a[112:115], v[136:139]
v_cvt_pk_bf16_f32 v88, v60, v61
M v[136:139], a[188:191], a[116:119], v[136:139]
buffer_load_dwordx4 v3, s[8:11], s23 offen offset:1024 lds
v_cvt_pk_bf16_f32 v89, v62, v63
v_cvt_pk_bf16_f32 v90, v92, v93
M v[140:143], a[188:191], a[124:127], v[140:143]
v_cvt_pk_bf16_f32 v91, v94, v95
M v[140:143], a[184:187], a[120:123], v[140:143]
M v[144:147], a[184:187], a[128:131], v[144:147]
M v[144:147], a[188:191], a[132:135], v[144:147]
buffer_load_dwordx4 v4, s[8:11], s23 offen offset:2048 lds
M v[148:151], a[188:191], a[140:143], v[148:151]
M v[148:151], a[184:187], a[136:139], v[148:151]
M v[152:155], a[184:187], a[144:147], v[152:155]
M v[152:155], a[188:191], a[148:151], v[152:155]
buffer_load_dwordx4 v5, s[8:11], s23 offen offset:3072 lds
M v[156:159], a[188:191], a[156:159], v[156:159]
M v[156:159], a[184:187], a[152:155], v[156:159]
s_waitcnt lgkmcnt(2)
M v[160:163], a[160:163], a[96:99], v[160:163]
M v[160:163], a[164:167], a[100:103], v[160:163]
ds_read_b128 a[176:179], v10 offset:53248
ds_read_b128 a[180:183], v11 offset:53248
M v[164:167], a[164:167], a[108:111], v[164:167]
M v[164:167], a[160:163], a[104:107], v[164:167]
s_sub_u32 s31, s31, 1
s_cmp_eq_u32 s31, 0
s_cselect_b32 s58, -1920, s57
s_add_u32 s23, s23, s58
s_add_u32 s24, s24, s58
v_cvt_pk_bf16_f32 v96, v96, v97
v_cvt_pk_bf16_f32 v97, v98, v99
M v[168:171], a[160:163], a[112:115], v[168:171]
v_cvt_pk_bf16_f32 v98, v128, v129
v_cvt_pk_bf16_f32 v99, v130, v131
M v[168:171], a[164:167], a[116:119], v[168:171]
v_cvt_pk_bf16_f32 v128, v112, v113
M v[172:175], a[164:167], a[124:127], v[172:175]
v_cvt_pk_bf16_f32 v129, v114, v115
v_cvt_pk_bf16_f32 v130, v144, v145
M v[172:175], a[160:163], a[120:123], v[172:175]
s_add_u32 m0, s30, 98304
s_nop 0
buffer_load_dwordx4 v6, s[12:15], s25 offen offset:0 lds
v_cvt_pk_bf16_f32 v131, v146, v147
M v[176:179], a[160:163], a[128:131], v[176:179]
v_cvt_pk_bf16_f32 v112, v104, v105
v_cvt_pk_bf16_f32 v113, v106, v107
M v[176:179], a[164:167], a[132:135], v[176:179]
v_cvt_pk_bf16_f32 v114, v136, v137
v_cvt_pk_bf16_f32 v115, v138, v139
M v[180:183], a[164:167], a[140:143], v[180:183]
buffer_load_dwordx4 v7, s[12:15], s25 offen offset:1024 lds
v_cvt_pk_bf16_f32 v144, v120, v121
M v[180:183], a[160:163], a[136:139], v[180:183]
v_cvt_pk_bf16_f32 v145, v122, v123
v_cvt_pk_bf16_f32 v146, v152, v153
M v[184:187], a[160:163], a[144:147], v[184:187]
v_cvt_pk_bf16_f32 v147, v154, v155
M v[184:187], a[164:167], a[148:151], v[184:187]
v_cvt_pk_bf16_f32 v104, v100, v101
v_cvt_pk_bf16_f32 v105, v102, v103
M v[188:191], a[164:167], a[156:159], v[188:191]
buffer_load_dwordx4 v8, s[12:15], s25 offen offset:2048 lds
v_cvt_pk_bf16_f32 v106, v132, v133
v_cvt_pk_bf16_f32 v107, v134, v135
M v[188:191], a[160:163], a[152:155], v[188:191]
s_waitcnt lgkmcnt(2)
v_cvt_pk_bf16_f32 v136, v116, v117
M v[192:195], a[168:171], a[96:99], v[192:195]
v_cvt_pk_bf16_f32 v137, v118, v119
v_cvt_pk_bf16_f32 v138, v148, v149
M v[192:195], a[172:175], a[100:103], v[192:195]
ds_read_b128 a[184:187], v10 offset:55296
ds_read_b128 a[188:191], v11 offset:55296
v_cvt_pk_bf16_f32 v139, v150, v151
M v[196:199], a[172:175], a[108:111], v[196:199]
v_cvt_pk_bf16_f32 v120, v108, v109
v_cvt_pk_bf16_f32 v121, v110, v111
M v[196:199], a[168:171], a[104:107], v[196:199]
v_cvt_pk_bf16_f32 v122, v140, v141
v_cvt_pk_bf16_f32 v123, v142, v143
M v[200:203], a[168:171], a[112:115], v[200:203]
buffer_load_dwordx4 v9, s[12:15], s25 offen offset:3072 lds
v_cvt_pk_bf16_f32 v152, v124, v125
M v[200:203], a[172:175], a[116:119], v[200:203]
v_cvt_pk_bf16_f32 v153, v126, v127
v_cvt_pk_bf16_f32 v154, v156, v157
M v[204:207], a[172:175], a[124:127], v[204:207]
v_cvt_pk_bf16_f32 v155, v158, v159
M v[204:207], a[168:171], a[120:123], v[204:207]
M v[208:211], a[168:171], a[128:131], v[208:211]
s_add_u32 m0, s30, 102400
s_nop 0
buffer_load_dwordx4 v21, s[12:15], s25 offen offset:0 lds
M v[208:211], a[172:175], a[132:135], v[208:211]
M v[212:215], a[172:175], a[140:143], v[212:215]
M v[212:215], a[168:171], a[136:139], v[212:215]
M v[216:219], a[168:171], a[144:147], v[216:219]
buffer_load_dwordx4 v22, s[12:15], s25 offen offset:1024 lds
M v[216:219], a[172:175], a[148:151], v[216:219]
M v[220:223], a[172:175], a[156:159], v[220:223]
M v[220:223], a[168:171], a[152:155], v[220:223]
s_waitcnt lgkmcnt(2)
M v[224:227], a[176:179], a[96:99], v[224:227]
M v[224:227], a[180:183], a[100:103], v[224:227]
s_sub_u32 s54, s54, 1
s_cmp_eq_u32 s54, 0
s_cselect_b32 s58, s55, s56
s_add_u32 s25, s25, s58
M v[228:231], a[180:183], a[108:111], v[228:231]
M v[228:231], a[176:179], a[104:107], v[228:231]
v_cvt_pk_bf16_f32 v160, v160, v161
v_cvt_pk_bf16_f32 v161, v162, v163
M v[232:235], a[176:179], a[112:115], v[232:235]
v_cvt_pk_bf16_f32 v162, v192, v193
v_cvt_pk_bf16_f32 v163, v194, v195
M v[232:235], a[180:183], a[116:119], v[232:235]
v_cvt_pk_bf16_f32 v192, v176, v177
M v[236:239], a[180:183], a[124:127], v[236:239]
v_cvt_pk_bf16_f32 v193, v178, v179
v_cvt_pk_bf16_f32 v194, v208, v209
M v[236:239], a[176:179], a[120:123], v[236:239]
s_waitcnt vmcnt(63) lgkmcnt(0)
s_barrier
v_cvt_pk_bf16_f32 v195, v210, v211
M v[240:243], a[176:179], a[128:131], v[240:243]
s_add_u32 m0, s28, 18432
s_nop 0
buffer_load_dword v20, s[8:11], s24 offen lds
v_cvt_pk_bf16_f32 v176, v168, v169
v_cvt_pk_bf16_f32 v177, v170, v171
M v[240:243], a[180:183], a[132:135], v[240:243]
v_cvt_pk_bf16_f32 v178, v200, v201
v_cvt_pk_bf16_f32 v179, v202, v203
M v[244:247], a[180:183], a[140:143], v[244:247]
v_cvt_pk_bf16_f32 v208, v184, v185
M v[244:247], a[176:179], a[136:139], v[244:247]
buffer_load_dword v23, s[8:11], s24 offen offset:256 lds
v_cvt_pk_bf16_f32 v209, v186, v187
v_cvt_pk_bf16_f32 v210, v216, v217
M v[248:251], a[176:179], a[144:147], v[248:251]
v_cvt_pk_bf16_f32 v211, v218, v219
M v[248:251], a[180:183], a[148:151], v[248:251]
v_cvt_pk_bf16_f32 v168, v164, v165
v_cvt_pk_bf16_f32 v169, v166, v167
M v[252:255], a[180:183], a[156:159], v[252:255]
v_cvt_pk_bf16_f32 v170, v196, v197
v_cvt_pk_bf16_f32 v171, v198, v199
M v[252:255], a[176:179], a[152:155], v[252:255]
v_cvt_pk_bf16_f32 v200, v180, v181
M a[0:3], a[184:187], a[96:99], a[0:3]
s_add_u32 m0, s29, 20480
s_nop 0
buffer_load_dwordx4 v2, s[8:11], s23 offen offset:0 lds
v_cvt_pk_bf16_f32 v201, v182, v183
v_cvt_pk_bf16_f32 v202, v212, v213
M a[0:3], a[188:191], a[100:103], a[0:3]
v_cvt_pk_bf16_f32 v203, v214, v215
M a[4:7], a[188:191], a[108:111], a[4:7]
v_cvt_pk_bf16_f32 v184, v172, v173
v_cvt_pk_bf16_f32 v185, v174, v175
M a[4:7], a[184:187], a[104:107], a[4:7]
v_cvt_pk_bf16_f32 v186, v204, v205
v_cvt_pk_bf16_f32 v187, v206, v207
M a[8:11], a[184:187], a[112:115], a[8:11]
buffer_load_dwordx4 v3, s[8:11], s23 offen offset:1024 lds
v_cvt_pk_bf16_f32 v216, v188, v189
M a[8:11], a[188:191], a[116:119], a[8:11]
v_cvt_pk_bf16_f32 v217, v190, v191
v_cvt_pk_bf16_f32 v218, v220, v221
M a[12:15], a[188:191], a[124:127], a[12:15]
v_cvt_pk_bf16_f32 v219, v222, v223
M a[12:15], a[184:187], a[120:123], a[12:15]
buffer_load_dwordx4 v4, s[8:11], s23 offen offset:2048 lds
M a[16:19], a[184:187], a[128:131], a[16:19]
M a[16:19], a[188:191], a[132:135], a[16:19]
M a[20:23], a[188:191], a[140:143], a[20:23]
M a[20:23], a[184:187], a[136:139], a[20:23]
buffer_load_dwordx4 v5, s[8:11], s23 offen offset:3072 lds
M a[24:27], a[184:187], a[144:147], a[24:27]
M a[24:27], a[188:191], a[148:151], a[24:27]
M a[28:31], a[188:191], a[156:159], a[28:31]
M a[28:31], a[184:187], a[152:155], a[28:31]
v_accvgpr_read_b32 v24, a0
v_accvgpr_read_b32 v25, a1
v_accvgpr_read_b32 v26, a2
v_accvgpr_read_b32 v27, a3
v_cvt_pk_bf16_f32 v224, v224, v225
v_cvt_pk_bf16_f32 v225, v226, v227
v_cvt_pk_bf16_f32 v226, v24, v25
v_cvt_pk_bf16_f32 v227, v26, v27
v_accvgpr_read_b32 v24, a16
v_accvgpr_read_b32 v25, a17
v_accvgpr_read_b32 v26, a18
v_accvgpr_read_b32 v27, a19
v_cvt_pk_bf16_f32 v36, v240, v241
v_cvt_pk_bf16_f32 v37, v242, v243
v_cvt_pk_bf16_f32 v38, v24, v25
v_cvt_pk_bf16_f32 v39, v26, v27
v_accvgpr_read_b32 v24, a24
v_accvgpr_read_b32 v25, a25
v_accvgpr_read_b32 v26, a26
v_accvgpr_read_b32 v27, a27
v_cvt_pk_bf16_f32 v52, v248, v249
v_cvt_pk_bf16_f32 v53, v250, v251
v_cvt_pk_bf16_f32 v54, v24, v25
v_cvt_pk_bf16_f32 v55, v26, v27
v_accvgpr_read_b32 v24, a8
v_accvgpr_read_b32 v25, a9
v_accvgpr_read_b32 v26, a10
v_accvgpr_read_b32 v27, a11
v_cvt_pk_bf16_f32 v240, v232, v233
v_cvt_pk_bf16_f32 v241, v234, v235
v_cvt_pk_bf16_f32 v242, v24, v25
v_cvt_pk_bf16_f32 v243, v26, v27
v_accvgpr_read_b32 v28, a4
v_accvgpr_read_b32 v29, a5
v_accvgpr_read_b32 v30, a6
v_accvgpr_read_b32 v31, a7
v_cvt_pk_bf16_f32 v232, v228, v229
v_cvt_pk_bf16_f32 v233, v230, v231
v_cvt_pk_bf16_f32 v234, v28, v29
v_cvt_pk_bf16_f32 v235, v30, v31
v_accvgpr_read_b32 v28, a12
v_accvgpr_read_b32 v29, a13
v_accvgpr_read_b32 v30, a14
v_accvgpr_read_b32 v31, a15
v_cvt_pk_bf16_f32 v248, v236, v237
v_cvt_pk_bf16_f32 v249, v238, v239
v_cvt_pk_bf16_f32 v250, v28, v29
v_cvt_pk_bf16_f32 v251, v30, v31
v_accvgpr_read_b32 v28, a20
v_accvgpr_read_b32 v29, a21
v_accvgpr_read_b32 v30, a22
v_accvgpr_read_b32 v31, a23
v_cvt_pk_bf16_f32 v44, v244, v245
v_cvt_pk_bf16_f32 v45, v246, v247
v_cvt_pk_bf16_f32 v46, v28, v29
v_cvt_pk_bf16_f32 v47, v30, v31
v_accvgpr_read_b32 v28, a28
v_accvgpr_read_b32 v29, a29
v_accvgpr_read_b32 v30, a30
v_accvgpr_read_b32 v31, a31
v_cvt_pk_bf16_f32 v60, v252, v253
v_cvt_pk_bf16_f32 v61, v254, v255
v_cvt_pk_bf16_f32 v62, v28, v29
v_cvt_pk_bf16_f32 v63, v30, v31
Lk1_b:
v_and_b32 v24, 15, v0
v_lshlrev_b32 v24, 7, v24
v_bfe_u32 v25, v0, 1, 3
v_lshrrev_b32 v26, 4, v0
v_xor_b32 v25, v25, v26
v_lshl_add_u32 v10, v25, 4, v24
v_xor_b32 v11, 64, v10
v_add_u32 v12, 131072, v10
v_add_u32 v13, 131072, v11
v_bfe_u32 v24, v0, 2, 2
v_lshl_add_u32 v29, v26, 3, v24
v_mul_u32_u24 v25, 384, v29
v_and_b32 v27, 1, v0
v_lshl_add_u32 v25, v27, 3, v25
v_add_u32 v25, 36864, v25
v_lshrrev_b32 v24, 1, v29
v_and_b32 v24, 4, v24
v_and_or_b32 v24, v29, 2, v24
v_bfe_u32 v26, v0, 1, 1
s_mul_i32 s4, s20, 3
s_add_u32 s3, s4, 0
s_and_b32 s5, s3, 3
s_lshl_b32 s5, s5, 1
s_lshr_b32 s3, s3, 2
s_lshl_b32 s3, s3, 7
v_add_u32 v27, s5, v26
v_xor_b32 v27, v27, v24
v_lshl_add_u32 v27, v27, 4, v25
v_add_u32 v14, s3, v27
v_add_u32 v17, 61440, v14
s_add_u32 s3, s4, 1
s_and_b32 s5, s3, 3
s_lshl_b32 s5, s5, 1
s_lshr_b32 s3, s3, 2
s_lshl_b32 s3, s3, 7
v_add_u32 v27, s5, v26
v_xor_b32 v27, v27, v24
v_lshl_add_u32 v27, v27, 4, v25
v_add_u32 v15, s3, v27
v_add_u32 v18, 61440, v15
s_add_u32 s3, s4, 2
s_and_b32 s5, s3, 3
s_lshl_b32 s5, s5, 1
s_lshr_b32 s3, s3, 2
s_lshl_b32 s3, s3, 7
v_add_u32 v27, s5, v26
v_xor_b32 v27, v27, v24
v_lshl_add_u32 v27, v27, 4, v25
v_add_u32 v16, s3, v27
v_add_u32 v19, 61440, v16
s_waitcnt vmcnt(6)
s_barrier
ds_read_b64_tr_b16 a[176:177], v14 offset:28672
ds_read_b64_tr_b16 a[178:179], v14 offset:30208
ds_read_b64_tr_b16 a[184:185], v15 offset:28672
ds_read_b64_tr_b16 a[186:187], v15 offset:30208
ds_read_b64_tr_b16 a[192:193], v16 offset:28672
ds_read_b64_tr_b16 a[194:195], v16 offset:30208
ds_read_b64_tr_b16 a[180:181], v14 offset:40960
ds_read_b64_tr_b16 a[182:183], v14 offset:42496
ds_read_b64_tr_b16 a[188:189], v15 offset:40960
ds_read_b64_tr_b16 a[190:191], v15 offset:42496
ds_read_b64_tr_b16 a[196:197], v16 offset:40960
ds_read_b64_tr_b16 a[198:199], v16 offset:42496
ds_read_b128 a[224:227], v12 offset:0
ds_read_b128 a[228:231], v13 offset:0
ds_read_b128 a[232:235], v12 offset:2048
ds_read_b128 a[236:239], v13 offset:2048
ds_read_b128 a[240:243], v12 offset:4096
ds_read_b128 a[244:247], v13 offset:4096
s_waitcnt lgkmcnt(0)
s_barrier
M a[68:71], a[176:179], a[224:227], 0
ds_read_b128 a[248:251], v12 offset:6144
ds_read_b128 a[252:255], v13 offset:6144
M a[68:71], a[180:183], a[228:231], a[68:71]
s_sub_u32 s31, s31, 1
s_cmp_eq_u32 s31, 0
s_cselect_b32 s58, -1920, s57
s_add_u32 s23, s23, s58
s_add_u32 s24, s24, s58
M a[72:75], a[188:191], a[228:231], 0
ds_read_b64_tr_b16 a[200:201], v17 offset:0
ds_read_b64_tr_b16 a[202:203], v17 offset:1536
M a[72:75], a[184:187], a[224:227], a[72:75]
s_add_u32 m0, s30, 36864
s_nop 0
buffer_load_dwordx4 v6, s[12:15], s25 offen offset:0 lds
M a[76:79], a[192:195], a[224:227], 0
M a[76:79], a[196:199], a[228:231], a[76:79]
buffer_load_dwordx4 v7, s[12:15], s25 offen offset:1024 lds
M a[80:83], a[180:183], a[236:239], 0
ds_read_b128 a[224:227], v12 offset:8192
ds_read_b128 a[228:231], v13 offset:8192
M a[80:83], a[176:179], a[232:235], a[80:83]
M a[84:87], a[184:187], a[232:235], 0
ds_read_b64_tr_b16 a[208:209], v18 offset:0
ds_read_b64_tr_b16 a[210:211], v18 offset:1536
M a[84:87], a[188:191], a[236:239], a[84:87]
buffer_load_dwordx4 v8, s[12:15], s25 offen offset:2048 lds
M a[88:91], a[196:199], a[236:239], 0
M a[88:91], a[192:195], a[232:235], a[88:91]
buffer_load_dwordx4 v9, s[12:15], s25 offen offset:3072 lds
M a[92:95], a[176:179], a[240:243], 0
ds_read_b128 a[232:235], v12 offset:10240
ds_read_b128 a[236:239], v13 offset:10240
M a[92:95], a[180:183], a[244:247], a[92:95]
M a[96:99], a[188:191], a[244:247], 0
ds_read_b64_tr_b16 a[216:217], v19 offset:0
ds_read_b64_tr_b16 a[218:219], v19 offset:1536
M a[96:99], a[184:187], a[240:243], a[96:99]
s_add_u32 m0, s30, 40960
s_nop 0
buffer_load_dwordx4 v21, s[12:15], s25 offen offset:0 lds
M a[100:103], a[192:195], a[240:243], 0
buffer_load_dwordx4 v22, s[12:15], s25 offen offset:1024 lds
M a[100:103], a[196:199], a[244:247], a[100:103]
s_waitcnt lgkmcnt(10)
M a[104:107], a[180:183], a[252:255], 0
ds_read_b128 a[240:243], v12 offset:12288
ds_read_b128 a[244:247], v13 offset:12288
M a[104:107], a[176:179], a[248:251], a[104:107]
s_sub_u32 s54, s54, 1
s_cmp_eq_u32 s54, 0
s_cselect_b32 s58, s55, s56
s_add_u32 s25, s25, s58
M a[108:111], a[184:187], a[248:251], 0
ds_read_b64_tr_b16 a[204:205], v17 offset:12288
ds_read_b64_tr_b16 a[206:207], v17 offset:13824
M a[108:111], a[188:191], a[252:255], a[108:111]
M a[112:115], a[196:199], a[252:255], 0
s_add_u32 m0, s30, 65536
s_nop 0
buffer_load_dwordx4 v6, s[12:15], s25 offen offset:0 lds
M a[112:115], a[192:195], a[248:251], a[112:115]
s_waitcnt lgkmcnt(10)
M a[116:119], a[176:179], a[224:227], 0
ds_read_b128 a[248:251], v12 offset:14336
ds_read_b128 a[252:255], v13 offset:14336
M a[116:119], a[180:183], a[228:231], a[116:119]
buffer_load_dwordx4 v7, s[12:15], s25 offen offset:1024 lds
M a[120:123], a[188:191], a[228:231], 0
ds_read_b64_tr_b16 a[212:213], v18 offset:12288
ds_read_b64_tr_b16 a[214:215], v18 offset:13824
M a[120:123], a[184:187], a[224:227], a[120:123]
M a[124:127], a[192:195], a[224:227], 0
buffer_load_dwordx4 v8, s[12:15], s25 offen offset:2048 lds
M a[124:127], a[196:199], a[228:231], a[124:127]
buffer_load_dwordx4 v9, s[12:15], s25 offen offset:3072 lds
s_waitcnt lgkmcnt(10)
M a[128:131], a[180:183], a[236:239], 0
ds_read_b128 a[224:227], v12 offset:16384
ds_read_b128 a[228:231], v13 offset:16384
M a[128:131], a[176:179], a[232:235], a[128:131]
M a[132:135], a[184:187], a[232:235], 0
ds_read_b64_tr_b16 a[220:221], v19 offset:12288
ds_read_b64_tr_b16 a[222:223], v19 offset:13824
M a[132:135], a[188:191], a[236:239], a[132:135]
s_add_u32 m0, s30, 69632
s_nop 0
buffer_load_dwordx4 v21, s[12:15], s25 offen offset:0 lds
M a[136:139], a[196:199], a[236:239], 0
M a[136:139], a[192:195], a[232:235], a[136:139]
buffer_load_dwordx4 v22, s[12:15], s25 offen offset:1024 lds
s_waitcnt lgkmcnt(10)
M a[140:143], a[176:179], a[240:243], 0
M a[140:143], a[180:183], a[244:247], a[140:143]
s_sub_u32 s54, s54, 1
s_cmp_eq_u32 s54, 0
s_cselect_b32 s58, s55, s56
s_add_u32 s25, s25, s58
M a[144:147], a[188:191], a[244:247], 0
M a[144:147], a[184:187], a[240:243], a[144:147]
M a[148:151], a[192:195], a[240:243], 0
s_waitcnt vmcnt(6) lgkmcnt(0)
s_barrier
ds_read_b128 a[232:235], v10 offset:0
ds_read_b128 a[236:239], v11 offset:0
M a[148:151], a[196:199], a[244:247], a[148:151]
s_add_u32 m0, s28, 131072
s_nop 0
buffer_load_dword v20, s[8:11], s24 offen lds
M a[152:155], a[180:183], a[252:255], 0
ds_read_b128 a[240:243], v10 offset:2048
ds_read_b128 a[244:247], v11 offset:2048
M a[152:155], a[176:179], a[248:251], a[152:155]
M a[156:159], a[184:187], a[248:251], 0
buffer_load_dword v23, s[8:11], s24 offen offset:256 lds
M a[156:159], a[188:191], a[252:255], a[156:159]
M a[160:163], a[196:199], a[252:255], 0
M a[160:163], a[192:195], a[248:251], a[160:163]
s_add_u32 m0, s29, 133120
s_nop 0
buffer_load_dwordx4 v2, s[8:11], s23 offen offset:0 lds
M a[164:167], a[176:179], a[224:227], 0
ds_read_b128 a[248:251], v10 offset:4096
ds_read_b128 a[252:255], v11 offset:4096
M a[164:167], a[180:183], a[228:231], a[164:167]
M a[168:171], a[188:191], a[228:231], 0
M a[168:171], a[184:187], a[224:227], a[168:171]
buffer_load_dwordx4 v3, s[8:11], s23 offen offset:1024 lds
M a[172:175], a[192:195], a[224:227], 0
M a[172:175], a[196:199], a[228:231], a[172:175]
s_waitcnt lgkmcnt(4)
M a[68:71], a[200:203], a[232:235], a[68:71]
ds_read_b128 a[224:227], v10 offset:6144
ds_read_b128 a[228:231], v11 offset:6144
M a[68:71], a[204:207], a[236:239], a[68:71]
buffer_load_dwordx4 v4, s[8:11], s23 offen offset:2048 lds
M a[72:75], a[212:215], a[236:239], a[72:75]
ds_read_b64_tr_b16 a[176:177], v14 offset:0
ds_read_b64_tr_b16 a[178:179], v14 offset:1536
M a[72:75], a[208:211], a[232:235], a[72:75]
buffer_load_dwordx4 v5, s[8:11], s23 offen offset:3072 lds
M a[76:79], a[216:219], a[232:235], a[76:79]
M a[76:79], a[220:223], a[236:239], a[76:79]
s_sub_u32 s31, s31, 1
s_cmp_eq_u32 s31, 0
s_cselect_b32 s58, -1920, s57
s_add_u32 s23, s23, s58
s_add_u32 s24, s24, s58
s_waitcnt lgkmcnt(6)
M a[80:83], a[204:207], a[244:247], a[80:83]
ds_read_b128 a[232:235], v10 offset:8192
ds_read_b128 a[236:239], v11 offset:8192
M a[80:83], a[200:203], a[240:243], a[80:83]
M a[84:87], a[208:211], a[240:243], a[84:87]
ds_read_b64_tr_b16 a[184:185], v15 offset:0
ds_read_b64_tr_b16 a[186:187], v15 offset:1536
M a[84:87], a[212:215], a[244:247], a[84:87]
s_add_u32 m0, s30, 98304
s_nop 0
buffer_load_dwordx4 v6, s[12:15], s25 offen offset:0 lds
M a[88:91], a[220:223], a[244:247], a[88:91]
M a[88:91], a[216:219], a[240:243], a[88:91]
buffer_load_dwordx4 v7, s[12:15], s25 offen offset:1024 lds
s_waitcnt lgkmcnt(8)
M a[92:95], a[200:203], a[248:251], a[92:95]
ds_read_b128 a[240:243], v10 offset:10240
ds_read_b128 a[244:247], v11 offset:10240
M a[92:95], a[204:207], a[252:255], a[92:95]
M a[96:99], a[212:215], a[252:255], a[96:99]
ds_read_b64_tr_b16 a[192:193], v16 offset:0
ds_read_b64_tr_b16 a[194:195], v16 offset:1536
M a[96:99], a[208:211], a[248:251], a[96:99]
buffer_load_dwordx4 v8, s[12:15], s25 offen offset:2048 lds
M a[100:103], a[216:219], a[248:251], a[100:103]
M a[100:103], a[220:223], a[252:255], a[100:103]
buffer_load_dwordx4 v9, s[12:15], s25 offen offset:3072 lds
s_waitcnt lgkmcnt(10)
M a[104:107], a[204:207], a[228:231], a[104:107]
ds_read_b128 a[248:251], v10 offset:12288
ds_read_b128 a[252:255], v11 offset:12288
M a[104:107], a[200:203], a[224:227], a[104:107]
M a[108:111], a[208:211], a[224:227], a[108:111]
ds_read_b64_tr_b16 a[180:181], v14 offset:12288
ds_read_b64_tr_b16 a[182:183], v14 offset:13824
M a[108:111], a[212:215], a[228:231], a[108:111]
s_add_u32 m0, s30, 102400
s_nop 0
buffer_load_dwordx4 v21, s[12:15], s25 offen offset:0 lds
M a[112:115], a[220:223], a[228:231], a[112:115]
M a[112:115], a[216:219], a[224:227], a[112:115]
buffer_load_dwordx4 v22, s[12:15], s25 offen offset:1024 lds
s_waitcnt lgkmcnt(10)
M a[116:119], a[200:203], a[232:235], a[116:119]
ds_read_b128 a[224:227], v10 offset:14336
ds_read_b128 a[228:231], v11 offset:14336
M a[116:119], a[204:207], a[236:239], a[116:119]
M a[120:123], a[212:215], a[236:239], a[120:123]
ds_read_b64_tr_b16 a[188:189], v15 offset:12288
ds_read_b64_tr_b16 a[190:191], v15 offset:13824
M a[120:123], a[208:211], a[232:235], a[120:123]
s_sub_u32 s54, s54, 1
s_cmp_eq_u32 s54, 0
s_cselect_b32 s58, s55, s56
s_add_u32 s25, s25, s58
M a[124:127], a[216:219], a[232:235], a[124:127]
M a[124:127], a[220:223], a[236:239], a[124:127]
s_add_u32 s94, s92, 0
buffer_store_dwordx4 v[32:35], v1, s[16:19], s94 offen offset:0 sc1
s_waitcnt lgkmcnt(10)
M a[128:131], a[204:207], a[244:247], a[128:131]
ds_read_b128 a[232:235], v10 offset:16384
ds_read_b128 a[236:239], v11 offset:16384
M a[128:131], a[200:203], a[240:243], a[128:131]
M a[132:135], a[208:211], a[240:243], a[132:135]
ds_read_b64_tr_b16 a[196:197], v16 offset:12288
ds_read_b64_tr_b16 a[198:199], v16 offset:13824
M a[132:135], a[212:215], a[244:247], a[132:135]
s_add_u32 s94, s92, 0
buffer_store_dwordx4 v[40:43], v1, s[16:19], s94 offen offset:1024 sc1
M a[136:139], a[220:223], a[244:247], a[136:139]
M a[136:139], a[216:219], a[240:243], a[136:139]
s_add_u32 s94, s92, 0
buffer_store_dwordx4 v[48:51], v1, s[16:19], s94 offen offset:2048 sc1
s_waitcnt lgkmcnt(10)
M a[140:143], a[200:203], a[248:251], a[140:143]
M a[140:143], a[204:207], a[252:255], a[140:143]
s_add_u32 s94, s92, 0
buffer_store_dwordx4 v[56:59], v1, s[16:19], s94 offen offset:3072 sc1
M a[144:147], a[212:215], a[252:255], a[144:147]
M a[144:147], a[208:211], a[248:251], a[144:147]
M a[148:151], a[216:219], a[248:251], a[148:151]
s_waitcnt vmcnt(16) lgkmcnt(0)
s_barrier
ds_read_b128 a[240:243], v10 offset:18432
ds_read_b128 a[244:247], v11 offset:18432
M a[148:151], a[220:223], a[252:255], a[148:151]
s_add_u32 m0, s28, 0
s_nop 0
buffer_load_dword v20, s[8:11], s24 offen lds
M a[152:155], a[204:207], a[228:231], a[152:155]
ds_read_b128 a[248:251], v10 offset:20480
ds_read_b128 a[252:255], v11 offset:20480
M a[152:155], a[200:203], a[224:227], a[152:155]
M a[156:159], a[208:211], a[224:227], a[156:159]
buffer_load_dword v23, s[8:11], s24 offen offset:256 lds
M a[156:159], a[212:215], a[228:231], a[156:159]
M a[160:163], a[220:223], a[228:231], a[160:163]
M a[160:163], a[216:219], a[224:227], a[160:163]
s_add_u32 m0, s29, 2048
s_nop 0
buffer_load_dwordx4 v2, s[8:11], s23 offen offset:0 lds
M a[164:167], a[200:203], a[232:235], a[164:167]
ds_read_b128 a[224:227], v10 offset:22528
ds_read_b128 a[228:231], v11 offset:22528
M a[164:167], a[204:207], a[236:239], a[164:167]
M a[168:171], a[212:215], a[236:239], a[168:171]
M a[168:171], a[208:211], a[232:235], a[168:171]
buffer_load_dwordx4 v3, s[8:11], s23 offen offset:1024 lds
M a[172:175], a[216:219], a[232:235], a[172:175]
M a[172:175], a[220:223], a[236:239], a[172:175]
s_waitcnt lgkmcnt(4)
M a[68:71], a[176:179], a[240:243], a[68:71]
ds_read_b128 a[232:235], v10 offset:24576
ds_read_b128 a[236:239], v11 offset:24576
M a[68:71], a[180:183], a[244:247], a[68:71]
buffer_load_dwordx4 v4, s[8:11], s23 offen offset:2048 lds
M a[72:75], a[188:191], a[244:247], a[72:75]
ds_read_b64_tr_b16 a[200:201], v14 offset:28672
ds_read_b64_tr_b16 a[202:203], v14 offset:30208
M a[72:75], a[184:187], a[240:243], a[72:75]
buffer_load_dwordx4 v5, s[8:11], s23 offen offset:3072 lds
M a[76:79], a[192:195], a[240:243], a[76:79]
M a[76:79], a[196:199], a[244:247], a[76:79]
s_sub_u32 s31, s31, 1
s_cmp_eq_u32 s31, 0
s_cselect_b32 s58, -1920, s57
s_add_u32 s23, s23, s58
s_add_u32 s24, s24, s58
s_waitcnt lgkmcnt(6)
M a[80:83], a[180:183], a[252:255], a[80:83]
ds_read_b128 a[240:243], v10 offset:26624
ds_read_b128 a[244:247], v11 offset:26624
M a[80:83], a[176:179], a[248:251], a[80:83]
M a[84:87], a[184:187], a[248:251], a[84:87]
ds_read_b64_tr_b16 a[208:209], v15 offset:28672
ds_read_b64_tr_b16 a[210:211], v15 offset:30208
M a[84:87], a[188:191], a[252:255], a[84:87]
s_add_u32 m0, s30, 36864
s_nop 0
buffer_load_dwordx4 v6, s[12:15], s25 offen offset:0 lds
M a[88:91], a[196:199], a[252:255], a[88:91]
M a[88:91], a[192:195], a[248:251], a[88:91]
buffer_load_dwordx4 v7, s[12:15], s25 offen offset:1024 lds
s_waitcnt lgkmcnt(8)
M a[92:95], a[176:179], a[224:227], a[92:95]
ds_read_b128 a[248:251], v10 offset:28672
ds_read_b128 a[252:255], v11 offset:28672
M a[92:95], a[180:183], a[228:231], a[92:95]
M a[96:99], a[188:191], a[228:231], a[96:99]
ds_read_b64_tr_b16 a[216:217], v16 offset:28672
ds_read_b64_tr_b16 a[218:219], v16 offset:30208
M a[96:99], a[184:187], a[224:227], a[96:99]
buffer_load_dwordx4 v8, s[12:15], s25 offen offset:2048 lds
M a[100:103], a[192:195], a[224:227], a[100:103]
M a[100:103], a[196:199], a[228:231], a[100:103]
buffer_load_dwordx4 v9, s[12:15], s25 offen offset:3072 lds
s_waitcnt lgkmcnt(10)
M a[104:107], a[180:183], a[236:239], a[104:107]
ds_read_b128 a[224:227], v10 offset:30720
ds_read_b128 a[228:231], v11 offset:30720
M a[104:107], a[176:179], a[232:235], a[104:107]
M a[108:111], a[184:187], a[232:235], a[108:111]
ds_read_b64_tr_b16 a[204:205], v14 offset:40960
ds_read_b64_tr_b16 a[206:207], v14 offset:42496
M a[108:111], a[188:191], a[236:239], a[108:111]
s_add_u32 m0, s30, 40960
s_nop 0
buffer_load_dwordx4 v21, s[12:15], s25 offen offset:0 lds
M a[112:115], a[196:199], a[236:239], a[112:115]
M a[112:115], a[192:195], a[232:235], a[112:115]
buffer_load_dwordx4 v22, s[12:15], s25 offen offset:1024 lds
s_waitcnt lgkmcnt(10)
M a[116:119], a[176:179], a[240:243], a[116:119]
ds_read_b128 a[232:235], v10 offset:32768
ds_read_b128 a[236:239], v11 offset:32768
M a[116:119], a[180:183], a[244:247], a[116:119]
M a[120:123], a[188:191], a[244:247], a[120:123]
ds_read_b64_tr_b16 a[212:213], v15 offset:40960
ds_read_b64_tr_b16 a[214:215], v15 offset:42496
M a[120:123], a[184:187], a[240:243], a[120:123]
s_sub_u32 s54, s54, 1
s_cmp_eq_u32 s54, 0
s_cselect_b32 s58, s55, s56
s_add_u32 s25, s25, s58
M a[124:127], a[192:195], a[240:243], a[124:127]
M a[124:127], a[196:199], a[244:247], a[124:127]
s_add_u32 s94, s92, 4096
buffer_store_dwordx4 v[64:67], v1, s[16:19], s94 offen offset:0 sc1
s_waitcnt lgkmcnt(10)
M a[128:131], a[180:183], a[252:255], a[128:131]
ds_read_b128 a[240:243], v10 offset:34816
ds_read_b128 a[244:247], v11 offset:34816
M a[128:131], a[176:179], a[248:251], a[128:131]
M a[132:135], a[184:187], a[248:251], a[132:135]
ds_read_b64_tr_b16 a[220:221], v16 offset:40960
ds_read_b64_tr_b16 a[222:223], v16 offset:42496
M a[132:135], a[188:191], a[252:255], a[132:135]
s_add_u32 s94, s92, 4096
buffer_store_dwordx4 v[72:75], v1, s[16:19], s94 offen offset:1024 sc1
M a[136:139], a[196:199], a[252:255], a[136:139]
M a[136:139], a[192:195], a[248:251], a[136:139]
s_add_u32 s94, s92, 4096
buffer_store_dwordx4 v[80:83], v1, s[16:19], s94 offen offset:2048 sc1
s_waitcnt lgkmcnt(10)
M a[140:143], a[176:179], a[224:227], a[140:143]
M a[140:143], a[180:183], a[228:231], a[140:143]
s_add_u32 s94, s92, 4096
buffer_store_dwordx4 v[88:91], v1, s[16:19], s94 offen offset:3072 sc1
M a[144:147], a[188:191], a[228:231], a[144:147]
M a[144:147], a[184:187], a[224:227], a[144:147]
M a[148:151], a[192:195], a[224:227], a[148:151]
s_waitcnt vmcnt(20) lgkmcnt(0)
s_barrier
ds_read_b128 a[248:251], v12 offset:0
ds_read_b128 a[252:255], v13 offset:0
M a[148:151], a[196:199], a[228:231], a[148:151]
s_add_u32 m0, s28, 18432
s_nop 0
buffer_load_dword v20, s[8:11], s24 offen lds
M a[152:155], a[180:183], a[236:239], a[152:155]
ds_read_b128 a[224:227], v12 offset:2048
ds_read_b128 a[228:231], v13 offset:2048
M a[152:155], a[176:179], a[232:235], a[152:155]
M a[156:159], a[184:187], a[232:235], a[156:159]
buffer_load_dword v23, s[8:11], s24 offen offset:256 lds
M a[156:159], a[188:191], a[236:239], a[156:159]
M a[160:163], a[196:199], a[236:239], a[160:163]
M a[160:163], a[192:195], a[232:235], a[160:163]
s_add_u32 m0, s29, 20480
s_nop 0
buffer_load_dwordx4 v2, s[8:11], s23 offen offset:0 lds
M a[164:167], a[176:179], a[240:243], a[164:167]
ds_read_b128 a[232:235], v12 offset:4096
ds_read_b128 a[236:239], v13 offset:4096
M a[164:167], a[180:183], a[244:247], a[164:167]
M a[168:171], a[188:191], a[244:247], a[168:171]
M a[168:171], a[184:187], a[240:243], a[168:171]
buffer_load_dwordx4 v3, s[8:11], s23 offen offset:1024 lds
M a[172:175], a[192:195], a[240:243], a[172:175]
M a[172:175], a[196:199], a[244:247], a[172:175]
s_waitcnt lgkmcnt(4)
M a[68:71], a[200:203], a[248:251], a[68:71]
ds_read_b128 a[240:243], v12 offset:6144
ds_read_b128 a[244:247], v13 offset:6144
M a[68:71], a[204:207], a[252:255], a[68:71]
buffer_load_dwordx4 v4, s[8:11], s23 offen offset:2048 lds
M a[72:75], a[212:215], a[252:255], a[72:75]
ds_read_b64_tr_b16 a[176:177], v17 offset:0
ds_read_b64_tr_b16 a[178:179], v17 offset:1536
M a[72:75], a[208:211], a[248:251], a[72:75]
buffer_load_dwordx4 v5, s[8:11], s23 offen offset:3072 lds
M a[76:79], a[216:219], a[248:251], a[76:79]
M a[76:79], a[220:223], a[252:255], a[76:79]
s_sub_u32 s31, s31, 1
s_cmp_eq_u32 s31, 0
s_cselect_b32 s58, -1920, s57
s_add_u32 s23, s23, s58
s_add_u32 s24, s24, s58
s_waitcnt lgkmcnt(6)
M a[80:83], a[204:207], a[228:231], a[80:83]
ds_read_b128 a[248:251], v12 offset:8192
ds_read_b128 a[252:255], v13 offset:8192
M a[80:83], a[200:203], a[224:227], a[80:83]
M a[84:87], a[208:211], a[224:227], a[84:87]
ds_read_b64_tr_b16 a[184:185], v18 offset:0
ds_read_b64_tr_b16 a[186:187], v18 offset:1536
M a[84:87], a[212:215], a[228:231], a[84:87]
s_add_u32 m0, s30, 65536
s_nop 0
buffer_load_dwordx4 v6, s[12:15], s25 offen offset:0 lds
M a[88:91], a[220:223], a[228:231], a[88:91]
M a[88:91], a[216:219], a[224:227], a[88:91]
buffer_load_dwordx4 v7, s[12:15], s25 offen offset:1024 lds
s_waitcnt lgkmcnt(8)
M a[92:95], a[200:203], a[232:235], a[92:95]
ds_read_b128 a[224:227], v12 offset:10240
ds_read_b128 a[228:231], v13 offset:10240
M a[92:95], a[204:207], a[236:239], a[92:95]
M a[96:99], a[212:215], a[236:239], a[96:99]
ds_read_b64_tr_b16 a[192:193], v19 offset:0
ds_read_b64_tr_b16 a[194:195], v19 offset:1536
M a[96:99], a[208:211], a[232:235], a[96:99]
buffer_load_dwordx4 v8, s[12:15], s25 offen offset:2048 lds
M a[100:103], a[216:219], a[232:235], a[100:103]
M a[100:103], a[220:223], a[236:239], a[100:103]
buffer_load_dwordx4 v9, s[12:15], s25 offen offset:3072 lds
s_waitcnt lgkmcnt(10)
M a[104:107], a[204:207], a[244:247], a[104:107]
ds_read_b128 a[232:235], v12 offset:12288
ds_read_b128 a[236:239], v13 offset:12288
M a[104:107], a[200:203], a[240:243], a[104:107]
M a[108:111], a[208:211], a[240:243], a[108:111]
ds_read_b64_tr_b16 a[180:181], v17 offset:12288
ds_read_b64_tr_b16 a[182:183], v17 offset:13824
M a[108:111], a[212:215], a[244:247], a[108:111]
s_add_u32 m0, s30, 69632
s_nop 0
buffer_load_dwordx4 v21, s[12:15], s25 offen offset:0 lds
M a[112:115], a[220:223], a[244:247], a[112:115]
M a[112:115], a[216:219], a[240:243], a[112:115]
buffer_load_dwordx4 v22, s[12:15], s25 offen offset:1024 lds
s_waitcnt lgkmcnt(10)
M a[116:119], a[200:203], a[248:251], a[116:119]
ds_read_b128 a[240:243], v12 offset:14336
ds_read_b128 a[244:247], v13 offset:14336
M a[116:119], a[204:207], a[252:255], a[116:119]
M a[120:123], a[212:215], a[252:255], a[120:123]
ds_read_b64_tr_b16 a[188:189], v18 offset:12288
ds_read_b64_tr_b16 a[190:191], v18 offset:13824
M a[120:123], a[208:211], a[248:251], a[120:123]
s_sub_u32 s54, s54, 1
s_cmp_eq_u32 s54, 0
s_cselect_b32 s58, s55, s56
s_add_u32 s25, s25, s58
M a[124:127], a[216:219], a[248:251], a[124:127]
M a[124:127], a[220:223], a[252:255], a[124:127]
s_add_u32 s94, s92, 8192
buffer_store_dwordx4 v[96:99], v1, s[16:19], s94 offen offset:0 sc1
s_waitcnt lgkmcnt(10)
M a[128:131], a[204:207], a[228:231], a[128:131]
ds_read_b128 a[248:251], v12 offset:16384
ds_read_b128 a[252:255], v13 offset:16384
M a[128:131], a[200:203], a[224:227], a[128:131]
M a[132:135], a[208:211], a[224:227], a[132:135]
ds_read_b64_tr_b16 a[196:197], v19 offset:12288
ds_read_b64_tr_b16 a[198:199], v19 offset:13824
M a[132:135], a[212:215], a[228:231], a[132:135]
s_add_u32 s94, s92, 8192
buffer_store_dwordx4 v[104:107], v1, s[16:19], s94 offen offset:1024 sc1
M a[136:139], a[220:223], a[228:231], a[136:139]
M a[136:139], a[216:219], a[224:227], a[136:139]
s_add_u32 s94, s92, 8192
buffer_store_dwordx4 v[112:115], v1, s[16:19], s94 offen offset:2048 sc1
s_waitcnt lgkmcnt(10)
M a[140:143], a[200:203], a[232:235], a[140:143]
M a[140:143], a[204:207], a[236:239], a[140:143]
s_add_u32 s94, s92, 8192
buffer_store_dwordx4 v[120:123], v1, s[16:19], s94 offen offset:3072 sc1
M a[144:147], a[212:215], a[236:239], a[144:147]
M a[144:147], a[208:211], a[232:235], a[144:147]
M a[148:151], a[216:219], a[232:235], a[148:151]
s_waitcnt vmcnt(20) lgkmcnt(0)
s_barrier
ds_read_b128 a[224:227], v10 offset:0
ds_read_b128 a[228:231], v11 offset:0
M a[148:151], a[220:223], a[236:239], a[148:151]
s_add_u32 m0, s28, 131072
s_nop 0
buffer_load_dword v20, s[8:11], s24 offen lds
M a[152:155], a[204:207], a[244:247], a[152:155]
ds_read_b128 a[232:235], v10 offset:2048
ds_read_b128 a[236:239], v11 offset:2048
M a[152:155], a[200:203], a[240:243], a[152:155]
M a[156:159], a[208:211], a[240:243], a[156:159]
buffer_load_dword v23, s[8:11], s24 offen offset:256 lds
M a[156:159], a[212:215], a[244:247], a[156:159]
M a[160:163], a[220:223], a[244:247], a[160:163]
M a[160:163], a[216:219], a[240:243], a[160:163]
s_add_u32 m0, s29, 133120
s_nop 0
buffer_load_dwordx4 v2, s[8:11], s23 offen offset:0 lds
M a[164:167], a[200:203], a[248:251], a[164:167]
ds_read_b128 a[240:243], v10 offset:4096
ds_read_b128 a[244:247], v11 offset:4096
M a[164:167], a[204:207], a[252:255], a[164:167]
M a[168:171], a[212:215], a[252:255], a[168:171]
M a[168:171], a[208:211], a[248:251], a[168:171]
buffer_load_dwordx4 v3, s[8:11], s23 offen offset:1024 lds
M a[172:175], a[216:219], a[248:251], a[172:175]
M a[172:175], a[220:223], a[252:255], a[172:175]
s_waitcnt lgkmcnt(4)
M a[68:71], a[176:179], a[224:227], a[68:71]
ds_read_b128 a[248:251], v10 offset:6144
ds_read_b128 a[252:255], v11 offset:6144
M a[68:71], a[180:183], a[228:231], a[68:71]
buffer_load_dwordx4 v4, s[8:11], s23 offen offset:2048 lds
M a[72:75], a[188:191], a[228:231], a[72:75]
ds_read_b64_tr_b16 a[200:201], v14 offset:0
ds_read_b64_tr_b16 a[202:203], v14 offset:1536
M a[72:75], a[184:187], a[224:227], a[72:75]
buffer_load_dwordx4 v5, s[8:11], s23 offen offset:3072 lds
M a[76:79], a[192:195], a[224:227], a[76:79]
M a[76:79], a[196:199], a[228:231], a[76:79]
s_sub_u32 s31, s31, 1
s_cmp_eq_u32 s31, 0
s_cselect_b32 s58, -1920, s57
s_add_u32 s23, s23, s58
s_add_u32 s24, s24, s58
s_waitcnt lgkmcnt(6)
M a[80:83], a[180:183], a[236:239], a[80:83]
ds_read_b128 a[224:227], v10 offset:8192
ds_read_b128 a[228:231], v11 offset:8192
M a[80:83], a[176:179], a[232:235], a[80:83]
M a[84:87], a[184:187], a[232:235], a[84:87]
ds_read_b64_tr_b16 a[208:209], v15 offset:0
ds_read_b64_tr_b16 a[210:211], v15 offset:1536
M a[84:87], a[188:191], a[236:239], a[84:87]
s_add_u32 m0, s30, 98304
s_nop 0
buffer_load_dwordx4 v6, s[12:15], s25 offen offset:0 lds
M a[88:91], a[196:199], a[236:239], a[88:91]
M a[88:91], a[192:195], a[232:235], a[88:91]
buffer_load_dwordx4 v7, s[12:15], s25 offen offset:1024 lds
s_waitcnt lgkmcnt(8)
M a[92:95], a[176:179], a[240:243], a[92:95]
ds_read_b128 a[232:235], v10 offset:10240
ds_read_b128 a[236:239], v11 offset:10240
M a[92:95], a[180:183], a[244:247], a[92:95]
M a[96:99], a[188:191], a[244:247], a[96:99]
ds_read_b64_tr_b16 a[216:217], v16 offset:0
ds_read_b64_tr_b16 a[218:219], v16 offset:1536
M a[96:99], a[184:187], a[240:243], a[96:99]
buffer_load_dwordx4 v8, s[12:15], s25 offen offset:2048 lds
M a[100:103], a[192:195], a[240:243], a[100:103]
M a[100:103], a[196:199], a[244:247], a[100:103]
buffer_load_dwordx4 v9, s[12:15], s25 offen offset:3072 lds
s_waitcnt lgkmcnt(10)
M a[104:107], a[180:183], a[252:255], a[104:107]
ds_read_b128 a[240:243], v10 offset:12288
ds_read_b128 a[244:247], v11 offset:12288
M a[104:107], a[176:179], a[248:251], a[104:107]
M a[108:111], a[184:187], a[248:251], a[108:111]
ds_read_b64_tr_b16 a[204:205], v14 offset:12288
ds_read_b64_tr_b16 a[206:207], v14 offset:13824
M a[108:111], a[188:191], a[252:255], a[108:111]
s_add_u32 m0, s30, 102400
s_nop 0
buffer_load_dwordx4 v21, s[12:15], s25 offen offset:0 lds
M a[112:115], a[196:199], a[252:255], a[112:115]
M a[112:115], a[192:195], a[248:251], a[112:115]
buffer_load_dwordx4 v22, s[12:15], s25 offen offset:1024 lds
s_waitcnt lgkmcnt(10)
M a[116:119], a[176:179], a[224:227], a[116:119]
ds_read_b128 a[248:251], v10 offset:14336
ds_read_b128 a[252:255], v11 offset:14336
M a[116:119], a[180:183], a[228:231], a[116:119]
M a[120:123], a[188:191], a[228:231], a[120:123]
ds_read_b64_tr_b16 a[212:213], v15 offset:12288
ds_read_b64_tr_b16 a[214:215], v15 offset:13824
M a[120:123], a[184:187], a[224:227], a[120:123]
s_sub_u32 s54, s54, 1
s_cmp_eq_u32 s54, 0
s_cselect_b32 s58, s55, s56
s_add_u32 s25, s25, s58
M a[124:127], a[192:195], a[224:227], a[124:127]
M a[124:127], a[196:199], a[228:231], a[124:127]
s_add_u32 s94, s92, 12288
buffer_store_dwordx4 v[128:131], v1, s[16:19], s94 offen offset:0 sc1
s_waitcnt lgkmcnt(10)
M a[128:131], a[180:183], a[236:239], a[128:131]
ds_read_b128 a[224:227], v10 offset:16384
ds_read_b128 a[228:231], v11 offset:16384
M a[128:131], a[176:179], a[232:235], a[128:131]
M a[132:135], a[184:187], a[232:235], a[132:135]
ds_read_b64_tr_b16 a[220:221], v16 offset:12288
ds_read_b64_tr_b16 a[222:223], v16 offset:13824
M a[132:135], a[188:191], a[236:239], a[132:135]
s_add_u32 s94, s92, 12288
buffer_store_dwordx4 v[136:139], v1, s[16:19], s94 offen offset:1024 sc1
M a[136:139], a[196:199], a[236:239], a[136:139]
M a[136:139], a[192:195], a[232:235], a[136:139]
s_add_u32 s94, s92, 12288
buffer_store_dwordx4 v[144:147], v1, s[16:19], s94 offen offset:2048 sc1
s_waitcnt lgkmcnt(10)
M a[140:143], a[176:179], a[240:243], a[140:143]
M a[140:143], a[180:183], a[244:247], a[140:143]
s_add_u32 s94, s92, 12288
buffer_store_dwordx4 v[152:155], v1, s[16:19], s94 offen offset:3072 sc1
M a[144:147], a[188:191], a[244:247], a[144:147]
M a[144:147], a[184:187], a[240:243], a[144:147]
M a[148:151], a[192:195], a[240:243], a[148:151]
s_waitcnt vmcnt(20) lgkmcnt(0)
s_barrier
ds_read_b128 a[232:235], v10 offset:18432
ds_read_b128 a[236:239], v11 offset:18432
M a[148:151], a[196:199], a[244:247], a[148:151]
s_add_u32 m0, s28, 0
s_nop 0
buffer_load_dword v20, s[8:11], s24 offen lds
M a[152:155], a[180:183], a[252:255], a[152:155]
ds_read_b128 a[240:243], v10 offset:20480
ds_read_b128 a[244:247], v11 offset:20480
M a[152:155], a[176:179], a[248:251], a[152:155]
M a[156:159], a[184:187], a[248:251], a[156:159]
buffer_load_dword v23, s[8:11], s24 offen offset:256 lds
M a[156:159], a[188:191], a[252:255], a[156:159]
M a[160:163], a[196:199], a[252:255], a[160:163]
M a[160:163], a[192:195], a[248:251], a[160:163]
s_add_u32 m0, s29, 2048
s_nop 0
buffer_load_dwordx4 v2, s[8:11], s23 offen offset:0 lds
M a[164:167], a[176:179], a[224:227], a[164:167]
ds_read_b128 a[248:251], v10 offset:22528
ds_read_b128 a[252:255], v11 offset:22528
M a[164:167], a[180:183], a[228:231], a[164:167]
M a[168:171], a[188:191], a[228:231], a[168:171]
M a[168:171], a[184:187], a[224:227], a[168:171]
buffer_load_dwordx4 v3, s[8:11], s23 offen offset:1024 lds
M a[172:175], a[192:195], a[224:227], a[172:175]
M a[172:175], a[196:199], a[228:231], a[172:175]
s_waitcnt lgkmcnt(4)
M a[68:71], a[200:203], a[232:235], a[68:71]
ds_read_b128 a[224:227], v10 offset:24576
ds_read_b128 a[228:231], v11 offset:24576
M a[68:71], a[204:207], a[236:239], a[68:71]
buffer_load_dwordx4 v4, s[8:11], s23 offen offset:2048 lds
M a[72:75], a[212:215], a[236:239], a[72:75]
ds_read_b64_tr_b16 a[176:177], v14 offset:28672
ds_read_b64_tr_b16 a[178:179], v14 offset:30208
M a[72:75], a[208:211], a[232:235], a[72:75]
buffer_load_dwordx4 v5, s[8:11], s23 offen offset:3072 lds
M a[76:79], a[216:219], a[232:235], a[76:79]
M a[76:79], a[220:223], a[236:239], a[76:79]
s_sub_u32 s31, s31, 1
s_cmp_eq_u32 s31, 0
s_cselect_b32 s58, -1920, s57
s_add_u32 s23, s23, s58
s_add_u32 s24, s24, s58
s_waitcnt lgkmcnt(6)
M a[80:83], a[204:207], a[244:247], a[80:83]
ds_read_b128 a[232:235], v10 offset:26624
ds_read_b128 a[236:239], v11 offset:26624
M a[80:83], a[200:203], a[240:243], a[80:83]
M a[84:87], a[208:211], a[240:243], a[84:87]
ds_read_b64_tr_b16 a[184:185], v15 offset:28672
ds_read_b64_tr_b16 a[186:187], v15 offset:30208
M a[84:87], a[212:215], a[244:247], a[84:87]
s_add_u32 m0, s30, 36864
s_nop 0
buffer_load_dwordx4 v6, s[12:15], s25 offen offset:0 lds
M a[88:91], a[220:223], a[244:247], a[88:91]
M a[88:91], a[216:219], a[240:243], a[88:91]
buffer_load_dwordx4 v7, s[12:15], s25 offen offset:1024 lds
s_waitcnt lgkmcnt(8)
M a[92:95], a[200:203], a[248:251], a[92:95]
ds_read_b128 a[240:243], v10 offset:28672
ds_read_b128 a[244:247], v11 offset:28672
M a[92:95], a[204:207], a[252:255], a[92:95]
M a[96:99], a[212:215], a[252:255], a[96:99]
ds_read_b64_tr_b16 a[192:193], v16 offset:28672
ds_read_b64_tr_b16 a[194:195], v16 offset:30208
M a[96:99], a[208:211], a[248:251], a[96:99]
buffer_load_dwordx4 v8, s[12:15], s25 offen offset:2048 lds
M a[100:103], a[216:219], a[248:251], a[100:103]
M a[100:103], a[220:223], a[252:255], a[100:103]
buffer_load_dwordx4 v9, s[12:15], s25 offen offset:3072 lds
s_waitcnt lgkmcnt(10)
M a[104:107], a[204:207], a[228:231], a[104:107]
ds_read_b128 a[248:251], v10 offset:30720
ds_read_b128 a[252:255], v11 offset:30720
M a[104:107], a[200:203], a[224:227], a[104:107]
M a[108:111], a[208:211], a[224:227], a[108:111]
ds_read_b64_tr_b16 a[180:181], v14 offset:40960
ds_read_b64_tr_b16 a[182:183], v14 offset:42496
M a[108:111], a[212:215], a[228:231], a[108:111]
s_add_u32 m0, s30, 40960
s_nop 0
buffer_load_dwordx4 v21, s[12:15], s25 offen offset:0 lds
M a[112:115], a[220:223], a[228:231], a[112:115]
M a[112:115], a[216:219], a[224:227], a[112:115]
buffer_load_dwordx4 v22, s[12:15], s25 offen offset:1024 lds
s_waitcnt lgkmcnt(10)
M a[116:119], a[200:203], a[232:235], a[116:119]
ds_read_b128 a[224:227], v10 offset:32768
ds_read_b128 a[228:231], v11 offset:32768
M a[116:119], a[204:207], a[236:239], a[116:119]
M a[120:123], a[212:215], a[236:239], a[120:123]
ds_read_b64_tr_b16 a[188:189], v15 offset:40960
ds_read_b64_tr_b16 a[190:191], v15 offset:42496
M a[120:123], a[208:211], a[232:235], a[120:123]
s_sub_u32 s54, s54, 1
s_cmp_eq_u32 s54, 0
s_cselect_b32 s58, s55, s56
s_add_u32 s25, s25, s58
M a[124:127], a[216:219], a[232:235], a[124:127]
M a[124:127], a[220:223], a[236:239], a[124:127]
s_add_u32 s94, s93, 0
buffer_store_dwordx4 v[160:163], v1, s[16:19], s94 offen offset:0 sc1
s_waitcnt lgkmcnt(10)
M a[128:131], a[204:207], a[244:247], a[128:131]
ds_read_b128 a[232:235], v10 offset:34816
ds_read_b128 a[236:239], v11 offset:34816
M a[128:131], a[200:203], a[240:243], a[128:131]
M a[132:135], a[208:211], a[240:243], a[132:135]
ds_read_b64_tr_b16 a[196:197], v16 offset:40960
ds_read_b64_tr_b16 a[198:199], v16 offset:42496
M a[132:135], a[212:215], a[244:247], a[132:135]
s_add_u32 s94, s93, 0
buffer_store_dwordx4 v[168:171], v1, s[16:19], s94 offen offset:1024 sc1
M a[136:139], a[220:223], a[244:247], a[136:139]
M a[136:139], a[216:219], a[240:243], a[136:139]
s_add_u32 s94, s93, 0
buffer_store_dwordx4 v[176:179], v1, s[16:19], s94 offen offset:2048 sc1
s_waitcnt lgkmcnt(10)
M a[140:143], a[200:203], a[248:251], a[140:143]
M a[140:143], a[204:207], a[252:255], a[140:143]
s_add_u32 s94, s93, 0
buffer_store_dwordx4 v[184:187], v1, s[16:19], s94 offen offset:3072 sc1
M a[144:147], a[212:215], a[252:255], a[144:147]
M a[144:147], a[208:211], a[248:251], a[144:147]
M a[148:151], a[216:219], a[248:251], a[148:151]
s_waitcnt vmcnt(20) lgkmcnt(0)
s_barrier
ds_read_b128 a[240:243], v12 offset:0
ds_read_b128 a[244:247], v13 offset:0
M a[148:151], a[220:223], a[252:255], a[148:151]
s_add_u32 m0, s28, 18432
s_nop 0
buffer_load_dword v20, s[8:11], s24 offen lds
M a[152:155], a[204:207], a[228:231], a[152:155]
ds_read_b128 a[248:251], v12 offset:2048
ds_read_b128 a[252:255], v13 offset:2048
M a[152:155], a[200:203], a[224:227], a[152:155]
M a[156:159], a[208:211], a[224:227], a[156:159]
buffer_load_dword v23, s[8:11], s24 offen offset:256 lds
M a[156:159], a[212:215], a[228:231], a[156:159]
M a[160:163], a[220:223], a[228:231], a[160:163]
M a[160:163], a[216:219], a[224:227], a[160:163]
s_add_u32 m0, s29, 20480
s_nop 0
buffer_load_dwordx4 v2, s[8:11], s23 offen offset:0 lds
M a[164:167], a[200:203], a[232:235], a[164:167]
ds_read_b128 a[224:227], v12 offset:4096
ds_read_b128 a[228:231], v13 offset:4096
M a[164:167], a[204:207], a[236:239], a[164:167]
M a[168:171], a[212:215], a[236:239], a[168:171]
M a[168:171], a[208:211], a[232:235], a[168:171]
buffer_load_dwordx4 v3, s[8:11], s23 offen offset:1024 lds
M a[172:175], a[216:219], a[232:235], a[172:175]
M a[172:175], a[220:223], a[236:239], a[172:175]
s_waitcnt lgkmcnt(4)
M a[68:71], a[176:179], a[240:243], a[68:71]
ds_read_b128 a[232:235], v12 offset:6144
ds_read_b128 a[236:239], v13 offset:6144
M a[68:71], a[180:183], a[244:247], a[68:71]
buffer_load_dwordx4 v4, s[8:11], s23 offen offset:2048 lds
M a[72:75], a[188:191], a[244:247], a[72:75]
ds_read_b64_tr_b16 a[200:201], v17 offset:0
ds_read_b64_tr_b16 a[202:203], v17 offset:1536
M a[72:75], a[184:187], a[240:243], a[72:75]
buffer_load_dwordx4 v5, s[8:11], s23 offen offset:3072 lds
M a[76:79], a[192:195], a[240:243], a[76:79]
M a[76:79], a[196:199], a[244:247], a[76:79]
s_sub_u32 s31, s31, 1
s_cmp_eq_u32 s31, 0
s_cselect_b32 s58, -1920, s57
s_add_u32 s23, s23, s58
s_add_u32 s24, s24, s58
s_waitcnt lgkmcnt(6)
M a[80:83], a[180:183], a[252:255], a[80:83]
ds_read_b128 a[240:243], v12 offset:8192
ds_read_b128 a[244:247], v13 offset:8192
M a[80:83], a[176:179], a[248:251], a[80:83]
M a[84:87], a[184:187], a[248:251], a[84:87]
ds_read_b64_tr_b16 a[208:209], v18 offset:0
ds_read_b64_tr_b16 a[210:211], v18 offset:1536
M a[84:87], a[188:191], a[252:255], a[84:87]
s_add_u32 m0, s30, 65536
s_nop 0
buffer_load_dwordx4 v6, s[12:15], s25 offen offset:0 lds
M a[88:91], a[196:199], a[252:255], a[88:91]
M a[88:91], a[192:195], a[248:251], a[88:91]
buffer_load_dwordx4 v7, s[12:15], s25 offen offset:1024 lds
s_waitcnt lgkmcnt(8)
M a[92:95], a[176:179], a[224:227], a[92:95]
ds_read_b128 a[248:251], v12 offset:10240
ds_read_b128 a[252:255], v13 offset:10240
M a[92:95], a[180:183], a[228:231], a[92:95]
M a[96:99], a[188:191], a[228:231], a[96:99]
ds_read_b64_tr_b16 a[216:217], v19 offset:0
ds_read_b64_tr_b16 a[218:219], v19 offset:1536
M a[96:99], a[184:187], a[224:227], a[96:99]
buffer_load_dwordx4 v8, s[12:15], s25 offen offset:2048 lds
M a[100:103], a[192:195], a[224:227], a[100:103]
M a[100:103], a[196:199], a[228:231], a[100:103]
buffer_load_dwordx4 v9, s[12:15], s25 offen offset:3072 lds
s_waitcnt lgkmcnt(10)
M a[104:107], a[180:183], a[236:239], a[104:107]
ds_read_b128 a[224:227], v12 offset:12288
ds_read_b128 a[228:231], v13 offset:12288
M a[104:107], a[176:179], a[232:235], a[104:107]
M a[108:111], a[184:187], a[232:235], a[108:111]
ds_read_b64_tr_b16 a[204:205], v17 offset:12288
ds_read_b64_tr_b16 a[206:207], v17 offset:13824
M a[108:111], a[188:191], a[236:239], a[108:111]
s_add_u32 m0, s30, 69632
s_nop 0
buffer_load_dwordx4 v21, s[12:15], s25 offen offset:0 lds
M a[112:115], a[196:199], a[236:239], a[112:115]
M a[112:115], a[192:195], a[232:235], a[112:115]
buffer_load_dwordx4 v22, s[12:15], s25 offen offset:1024 lds
s_waitcnt lgkmcnt(10)
M a[116:119], a[176:179], a[240:243], a[116:119]
ds_read_b128 a[232:235], v12 offset:14336
ds_read_b128 a[236:239], v13 offset:14336
M a[116:119], a[180:183], a[244:247], a[116:119]
M a[120:123], a[188:191], a[244:247], a[120:123]
ds_read_b64_tr_b16 a[212:213], v18 offset:12288
ds_read_b64_tr_b16 a[214:215], v18 offset:13824
M a[120:123], a[184:187], a[240:243], a[120:123]
s_sub_u32 s54, s54, 1
s_cmp_eq_u32 s54, 0
s_cselect_b32 s58, s55, s56
s_add_u32 s25, s25, s58
M a[124:127], a[192:195], a[240:243], a[124:127]
M a[124:127], a[196:199], a[244:247], a[124:127]
s_add_u32 s94, s93, 4096
buffer_store_dwordx4 v[192:195], v1, s[16:19], s94 offen offset:0 sc1
s_waitcnt lgkmcnt(10)
M a[128:131], a[180:183], a[252:255], a[128:131]
ds_read_b128 a[240:243], v12 offset:16384
ds_read_b128 a[244:247], v13 offset:16384
M a[128:131], a[176:179], a[248:251], a[128:131]
M a[132:135], a[184:187], a[248:251], a[132:135]
ds_read_b64_tr_b16 a[220:221], v19 offset:12288
ds_read_b64_tr_b16 a[222:223], v19 offset:13824
M a[132:135], a[188:191], a[252:255], a[132:135]
s_add_u32 s94, s93, 4096
buffer_store_dwordx4 v[200:203], v1, s[16:19], s94 offen offset:1024 sc1
M a[136:139], a[196:199], a[252:255], a[136:139]
M a[136:139], a[192:195], a[248:251], a[136:139]
s_add_u32 s94, s93, 4096
buffer_store_dwordx4 v[208:211], v1, s[16:19], s94 offen offset:2048 sc1
s_waitcnt lgkmcnt(10)
M a[140:143], a[176:179], a[224:227], a[140:143]
M a[140:143], a[180:183], a[228:231], a[140:143]
s_add_u32 s94, s93, 4096
buffer_store_dwordx4 v[216:219], v1, s[16:19], s94 offen offset:3072 sc1
M a[144:147], a[188:191], a[228:231], a[144:147]
M a[144:147], a[184:187], a[224:227], a[144:147]
M a[148:151], a[192:195], a[224:227], a[148:151]
s_waitcnt vmcnt(20) lgkmcnt(0)
s_barrier
ds_read_b128 a[248:251], v10 offset:0
ds_read_b128 a[252:255], v11 offset:0
M a[148:151], a[196:199], a[228:231], a[148:151]
s_add_u32 m0, s28, 131072
s_nop 0
buffer_load_dword v20, s[8:11], s24 offen lds
M a[152:155], a[180:183], a[236:239], a[152:155]
ds_read_b128 a[224:227], v10 offset:2048
ds_read_b128 a[228:231], v11 offset:2048
M a[152:155], a[176:179], a[232:235], a[152:155]
M a[156:159], a[184:187], a[232:235], a[156:159]
buffer_load_dword v23, s[8:11], s24 offen offset:256 lds
M a[156:159], a[188:191], a[236:239], a[156:159]
M a[160:163], a[196:199], a[236:239], a[160:163]
M a[160:163], a[192:195], a[232:235], a[160:163]
s_add_u32 m0, s29, 133120
s_nop 0
buffer_load_dwordx4 v2, s[8:11], s23 offen offset:0 lds
M a[164:167], a[176:179], a[240:243], a[164:167]
ds_read_b128 a[232:235], v10 offset:4096
ds_read_b128 a[236:239], v11 offset:4096
M a[164:167], a[180:183], a[244:247], a[164:167]
M a[168:171], a[188:191], a[244:247], a[168:171]
M a[168:171], a[184:187], a[240:243], a[168:171]
buffer_load_dwordx4 v3, s[8:11], s23 offen offset:1024 lds
M a[172:175], a[192:195], a[240:243], a[172:175]
M a[172:175], a[196:199], a[244:247], a[172:175]
s_waitcnt lgkmcnt(4)
M a[68:71], a[200:203], a[248:251], a[68:71]
ds_read_b128 a[240:243], v10 offset:6144
ds_read_b128 a[244:247], v11 offset:6144
M a[68:71], a[204:207], a[252:255], a[68:71]
buffer_load_dwordx4 v4, s[8:11], s23 offen offset:2048 lds
M a[72:75], a[212:215], a[252:255], a[72:75]
ds_read_b64_tr_b16 a[176:177], v14 offset:0
ds_read_b64_tr_b16 a[178:179], v14 offset:1536
M a[72:75], a[208:211], a[248:251], a[72:75]
buffer_load_dwordx4 v5, s[8:11], s23 offen offset:3072 lds
M a[76:79], a[216:219], a[248:251], a[76:79]
M a[76:79], a[220:223], a[252:255], a[76:79]
s_sub_u32 s31, s31, 1
s_cmp_eq_u32 s31, 0
s_cselect_b32 s58, -1920, s57
s_add_u32 s23, s23, s58
s_add_u32 s24, s24, s58
s_waitcnt lgkmcnt(6)
M a[80:83], a[204:207], a[228:231], a[80:83]
ds_read_b128 a[248:251], v10 offset:8192
ds_read_b128 a[252:255], v11 offset:8192
M a[80:83], a[200:203], a[224:227], a[80:83]
M a[84:87], a[208:211], a[224:227], a[84:87]
ds_read_b64_tr_b16 a[184:185], v15 offset:0
ds_read_b64_tr_b16 a[186:187], v15 offset:1536
M a[84:87], a[212:215], a[228:231], a[84:87]
s_add_u32 m0, s30, 98304
s_nop 0
buffer_load_dwordx4 v6, s[12:15], s25 offen offset:0 lds
M a[88:91], a[220:223], a[228:231], a[88:91]
M a[88:91], a[216:219], a[224:227], a[88:91]
buffer_load_dwordx4 v7, s[12:15], s25 offen offset:1024 lds
s_waitcnt lgkmcnt(8)
M a[92:95], a[200:203], a[232:235], a[92:95]
ds_read_b128 a[224:227], v10 offset:10240
ds_read_b128 a[228:231], v11 offset:10240
M a[92:95], a[204:207], a[236:239], a[92:95]
M a[96:99], a[212:215], a[236:239], a[96:99]
ds_read_b64_tr_b16 a[192:193], v16 offset:0
ds_read_b64_tr_b16 a[194:195], v16 offset:1536
M a[96:99], a[208:211], a[232:235], a[96:99]
buffer_load_dwordx4 v8, s[12:15], s25 offen offset:2048 lds
M a[100:103], a[216:219], a[232:235], a[100:103]
M a[100:103], a[220:223], a[236:239], a[100:103]
buffer_load_dwordx4 v9, s[12:15], s25 offen offset:3072 lds
s_waitcnt lgkmcnt(10)
M a[104:107], a[204:207], a[244:247], a[104:107]
ds_read_b128 a[232:235], v10 offset:12288
ds_read_b128 a[236:239], v11 offset:12288
M a[104:107], a[200:203], a[240:243], a[104:107]
M a[108:111], a[208:211], a[240:243], a[108:111]
ds_read_b64_tr_b16 a[180:181], v14 offset:12288
ds_read_b64_tr_b16 a[182:183], v14 offset:13824
M a[108:111], a[212:215], a[244:247], a[108:111]
s_add_u32 m0, s30, 102400
s_nop 0
buffer_load_dwordx4 v21, s[12:15], s25 offen offset:0 lds
M a[112:115], a[220:223], a[244:247], a[112:115]
M a[112:115], a[216:219], a[240:243], a[112:115]
buffer_load_dwordx4 v22, s[12:15], s25 offen offset:1024 lds
s_waitcnt lgkmcnt(10)
M a[116:119], a[200:203], a[248:251], a[116:119]
ds_read_b128 a[240:243], v10 offset:14336
ds_read_b128 a[244:247], v11 offset:14336
M a[116:119], a[204:207], a[252:255], a[116:119]
M a[120:123], a[212:215], a[252:255], a[120:123]
ds_read_b64_tr_b16 a[188:189], v15 offset:12288
ds_read_b64_tr_b16 a[190:191], v15 offset:13824
M a[120:123], a[208:211], a[248:251], a[120:123]
s_sub_u32 s54, s54, 1
s_cmp_eq_u32 s54, 0
s_cselect_b32 s58, s55, s56
s_add_u32 s25, s25, s58
M a[124:127], a[216:219], a[248:251], a[124:127]
M a[124:127], a[220:223], a[252:255], a[124:127]
s_add_u32 s94, s93, 8192
buffer_store_dwordx4 v[224:227], v1, s[16:19], s94 offen offset:0 sc1
s_waitcnt lgkmcnt(10)
M a[128:131], a[204:207], a[228:231], a[128:131]
ds_read_b128 a[248:251], v10 offset:16384
ds_read_b128 a[252:255], v11 offset:16384
M a[128:131], a[200:203], a[224:227], a[128:131]
M a[132:135], a[208:211], a[224:227], a[132:135]
ds_read_b64_tr_b16 a[196:197], v16 offset:12288
ds_read_b64_tr_b16 a[198:199], v16 offset:13824
M a[132:135], a[212:215], a[228:231], a[132:135]
s_add_u32 s94, s93, 8192
buffer_store_dwordx4 v[232:235], v1, s[16:19], s94 offen offset:1024 sc1
M a[136:139], a[220:223], a[228:231], a[136:139]
M a[136:139], a[216:219], a[224:227], a[136:139]
s_add_u32 s94, s93, 8192
buffer_store_dwordx4 v[240:243], v1, s[16:19], s94 offen offset:2048 sc1
s_waitcnt lgkmcnt(10)
M a[140:143], a[200:203], a[232:235], a[140:143]
M a[140:143], a[204:207], a[236:239], a[140:143]
s_add_u32 s94, s93, 8192
buffer_store_dwordx4 v[248:251], v1, s[16:19], s94 offen offset:3072 sc1
M a[144:147], a[212:215], a[236:239], a[144:147]
M a[144:147], a[208:211], a[232:235], a[144:147]
M a[148:151], a[216:219], a[232:235], a[148:151]
s_waitcnt vmcnt(20) lgkmcnt(0)
s_barrier
ds_read_b128 a[224:227], v10 offset:18432
ds_read_b128 a[228:231], v11 offset:18432
M a[148:151], a[220:223], a[236:239], a[148:151]
s_add_u32 m0, s28, 0
s_nop 0
buffer_load_dword v20, s[8:11], s24 offen lds
M a[152:155], a[204:207], a[244:247], a[152:155]
ds_read_b128 a[232:235], v10 offset:20480
ds_read_b128 a[236:239], v11 offset:20480
M a[152:155], a[200:203], a[240:243], a[152:155]
M a[156:159], a[208:211], a[240:243], a[156:159]
buffer_load_dword v23, s[8:11], s24 offen offset:256 lds
M a[156:159], a[212:215], a[244:247], a[156:159]
M a[160:163], a[220:223], a[244:247], a[160:163]
M a[160:163], a[216:219], a[240:243], a[160:163]
s_add_u32 m0, s29, 2048
s_nop 0
buffer_load_dwordx4 v2, s[8:11], s23 offen offset:0 lds
M a[164:167], a[200:203], a[248:251], a[164:167]
ds_read_b128 a[240:243], v10 offset:22528
ds_read_b128 a[244:247], v11 offset:22528
M a[164:167], a[204:207], a[252:255], a[164:167]
M a[168:171], a[212:215], a[252:255], a[168:171]
M a[168:171], a[208:211], a[248:251], a[168:171]
buffer_load_dwordx4 v3, s[8:11], s23 offen offset:1024 lds
M a[172:175], a[216:219], a[248:251], a[172:175]
M a[172:175], a[220:223], a[252:255], a[172:175]
s_waitcnt lgkmcnt(4)
M a[68:71], a[176:179], a[224:227], a[68:71]
ds_read_b128 a[248:251], v10 offset:24576
ds_read_b128 a[252:255], v11 offset:24576
v_mov_b32 v160, 0
v_mov_b32 v161, 0
M a[68:71], a[180:183], a[228:231], a[68:71]
buffer_load_dwordx4 v4, s[8:11], s23 offen offset:2048 lds
M a[72:75], a[188:191], a[228:231], a[72:75]
ds_read_b64_tr_b16 a[200:201], v14 offset:28672
ds_read_b64_tr_b16 a[202:203], v14 offset:30208
v_mov_b32 v162, 0
v_mov_b32 v163, 0
M a[72:75], a[184:187], a[224:227], a[72:75]
buffer_load_dwordx4 v5, s[8:11], s23 offen offset:3072 lds
M a[76:79], a[192:195], a[224:227], a[76:79]
v_mov_b32 v164, 0
v_mov_b32 v165, 0
M a[76:79], a[196:199], a[228:231], a[76:79]
s_sub_u32 s31, s31, 1
s_cmp_eq_u32 s31, 0
s_cselect_b32 s58, -1920, s57
s_add_u32 s23, s23, s58
s_add_u32 s24, s24, s58
s_waitcnt lgkmcnt(6)
M a[80:83], a[180:183], a[236:239], a[80:83]
ds_read_b128 a[224:227], v10 offset:26624
ds_read_b128 a[228:231], v11 offset:26624
v_mov_b32 v166, 0
v_mov_b32 v167, 0
M a[80:83], a[176:179], a[232:235], a[80:83]
M a[84:87], a[184:187], a[232:235], a[84:87]
ds_read_b64_tr_b16 a[208:209], v15 offset:28672
ds_read_b64_tr_b16 a[210:211], v15 offset:30208
M a[84:87], a[188:191], a[236:239], a[84:87]
s_add_u32 m0, s30, 36864
s_nop 0
buffer_load_dwordx4 v6, s[12:15], s25 offen offset:0 lds
v_mov_b32 v168, 0
v_mov_b32 v169, 0
M a[88:91], a[196:199], a[236:239], a[88:91]
M a[88:91], a[192:195], a[232:235], a[88:91]
buffer_load_dwordx4 v7, s[12:15], s25 offen offset:1024 lds
s_waitcnt lgkmcnt(8)
v_mov_b32 v170, 0
v_mov_b32 v171, 0
M a[92:95], a[176:179], a[240:243], a[92:95]
ds_read_b128 a[232:235], v10 offset:28672
ds_read_b128 a[236:239], v11 offset:28672
M a[92:95], a[180:183], a[244:247], a[92:95]
v_mov_b32 v172, 0
v_mov_b32 v173, 0
M a[96:99], a[188:191], a[244:247], a[96:99]
ds_read_b64_tr_b16 a[216:217], v16 offset:28672
ds_read_b64_tr_b16 a[218:219], v16 offset:30208
M a[96:99], a[184:187], a[240:243], a[96:99]
buffer_load_dwordx4 v8, s[12:15], s25 offen offset:2048 lds
v_mov_b32 v174, 0
v_mov_b32 v175, 0
M a[100:103], a[192:195], a[240:243], a[100:103]
M a[100:103], a[196:199], a[244:247], a[100:103]
buffer_load_dwordx4 v9, s[12:15], s25 offen offset:3072 lds
s_waitcnt lgkmcnt(10)
M a[104:107], a[180:183], a[252:255], a[104:107]
ds_read_b128 a[240:243], v10 offset:30720
ds_read_b128 a[244:247], v11 offset:30720
v_mov_b32 v176, 0
v_mov_b32 v177, 0
M a[104:107], a[176:179], a[248:251], a[104:107]
M a[108:111], a[184:187], a[248:251], a[108:111]
ds_read_b64_tr_b16 a[204:205], v14 offset:40960
ds_read_b64_tr_b16 a[206:207], v14 offset:42496
v_mov_b32 v178, 0
v_mov_b32 v179, 0
M a[108:111], a[188:191], a[252:255], a[108:111]
s_add_u32 m0, s30, 40960
s_nop 0
buffer_load_dwordx4 v21, s[12:15], s25 offen offset:0 lds
M a[112:115], a[196:199], a[252:255], a[112:115]
v_mov_b32 v180, 0
v_mov_b32 v181, 0
M a[112:115], a[192:195], a[248:251], a[112:115]
buffer_load_dwordx4 v22, s[12:15], s25 offen offset:1024 lds
s_waitcnt lgkmcnt(10)
M a[116:119], a[176:179], a[224:227], a[116:119]
ds_read_b128 a[248:251], v10 offset:32768
ds_read_b128 a[252:255], v11 offset:32768
v_mov_b32 v182, 0
v_mov_b32 v183, 0
M a[116:119], a[180:183], a[228:231], a[116:119]
M a[120:123], a[188:191], a[228:231], a[120:123]
ds_read_b64_tr_b16 a[212:213], v15 offset:40960
ds_read_b64_tr_b16 a[214:215], v15 offset:42496
M a[120:123], a[184:187], a[224:227], a[120:123]
s_sub_u32 s54, s54, 1
s_cmp_eq_u32 s54, 0
s_cselect_b32 s58, s55, s56
s_add_u32 s25, s25, s58
v_mov_b32 v184, 0
v_mov_b32 v185, 0
M a[124:127], a[192:195], a[224:227], a[124:127]
M a[124:127], a[196:199], a[228:231], a[124:127]
s_add_u32 s94, s93, 12288
buffer_store_dwordx4 v[36:39], v1, s[16:19], s94 offen offset:0 sc1
s_waitcnt lgkmcnt(10)
v_mov_b32 v186, 0
v_mov_b32 v187, 0
M a[128:131], a[180:183], a[236:239], a[128:131]
ds_read_b128 a[224:227], v10 offset:34816
ds_read_b128 a[228:231], v11 offset:34816
M a[128:131], a[176:179], a[232:235], a[128:131]
v_mov_b32 v188, 0
v_mov_b32 v189, 0
M a[132:135], a[184:187], a[232:235], a[132:135]
ds_read_b64_tr_b16 a[220:221], v16 offset:40960
ds_read_b64_tr_b16 a[222:223], v16 offset:42496
M a[132:135], a[188:191], a[236:239], a[132:135]
s_add_u32 s94, s93, 12288
buffer_store_dwordx4 v[44:47], v1, s[16:19], s94 offen offset:1024 sc1
v_mov_b32 v190, 0
v_mov_b32 v191, 0
M a[136:139], a[196:199], a[236:239], a[136:139]
M a[136:139], a[192:195], a[232:235], a[136:139]
s_add_u32 s94, s93, 12288
buffer_store_dwordx4 v[52:55], v1, s[16:19], s94 offen offset:2048 sc1
s_waitcnt lgkmcnt(10)
M a[140:143], a[176:179], a[240:243], a[140:143]
v_mov_b32 v192, 0
v_mov_b32 v193, 0
M a[140:143], a[180:183], a[244:247], a[140:143]
s_add_u32 s94, s93, 12288
buffer_store_dwordx4 v[60:63], v1, s[16:19], s94 offen offset:3072 sc1
M a[144:147], a[188:191], a[244:247], a[144:147]
v_mov_b32 v194, 0
v_mov_b32 v195, 0
M a[144:147], a[184:187], a[240:243], a[144:147]
M a[148:151], a[192:195], a[240:243], a[148:151]
s_waitcnt vmcnt(20) lgkmcnt(0)
s_barrier
ds_read_b128 a[232:235], v12 offset:0
ds_read_b128 a[236:239], v13 offset:0
v_mov_b32 v196, 0
v_mov_b32 v197, 0
M a[148:151], a[196:199], a[244:247], a[148:151]
s_add_u32 m0, s28, 18432
s_nop 0
buffer_load_dword v20, s[8:11], s24 offen lds
M a[152:155], a[180:183], a[252:255], a[152:155]
ds_read_b128 a[240:243], v12 offset:2048
ds_read_b128 a[244:247], v13 offset:2048
v_mov_b32 v198, 0
v_mov_b32 v199, 0
M a[152:155], a[176:179], a[248:251], a[152:155]
M a[156:159], a[184:187], a[248:251], a[156:159]
buffer_load_dword v23, s[8:11], s24 offen offset:256 lds
M a[156:159], a[188:191], a[252:255], a[156:159]
v_mov_b32 v200, 0
v_mov_b32 v201, 0
M a[160:163], a[196:199], a[252:255], a[160:163]
M a[160:163], a[192:195], a[248:251], a[160:163]
s_add_u32 m0, s29, 20480
s_nop 0
buffer_load_dwordx4 v2, s[8:11], s23 offen offset:0 lds
v_mov_b32 v202, 0
v_mov_b32 v203, 0
M a[164:167], a[176:179], a[224:227], a[164:167]
ds_read_b128 a[248:251], v12 offset:4096
ds_read_b128 a[252:255], v13 offset:4096
M a[164:167], a[180:183], a[228:231], a[164:167]
v_mov_b32 v204, 0
v_mov_b32 v205, 0
M a[168:171], a[188:191], a[228:231], a[168:171]
M a[168:171], a[184:187], a[224:227], a[168:171]
buffer_load_dwordx4 v3, s[8:11], s23 offen offset:1024 lds
v_mov_b32 v206, 0
v_mov_b32 v207, 0
M a[172:175], a[192:195], a[224:227], a[172:175]
M a[172:175], a[196:199], a[228:231], a[172:175]
s_waitcnt lgkmcnt(4)
M a[68:71], a[200:203], a[232:235], a[68:71]
ds_read_b128 a[224:227], v12 offset:6144
ds_read_b128 a[228:231], v13 offset:6144
v_and_b32 v128, 15, v0
v_mul_u32_u24 v128, 400, v128
M a[68:71], a[204:207], a[236:239], a[68:71]
buffer_load_dwordx4 v4, s[8:11], s23 offen offset:2048 lds
M a[72:75], a[212:215], a[236:239], a[72:75]
ds_read_b64_tr_b16 a[176:177], v17 offset:0
ds_read_b64_tr_b16 a[178:179], v17 offset:1536
v_lshrrev_b32 v129, 4, v0
v_lshl_add_u32 v128, v129, 3, v128
M a[72:75], a[208:211], a[232:235], a[72:75]
M a[76:79], a[216:219], a[232:235], a[76:79]
buffer_load_dwordx4 v5, s[8:11], s23 offen offset:3072 lds
s_mul_i32 s3, s20, 96
s_add_u32 s3, s3, 98304
M a[76:79], a[220:223], a[236:239], a[76:79]
s_waitcnt lgkmcnt(6)
M a[80:83], a[204:207], a[244:247], a[80:83]
ds_read_b128 a[232:235], v12 offset:8192
ds_read_b128 a[236:239], v13 offset:8192
v_add_u32 v124, s3, v128
v_and_b32 v128, 15, v0
M a[80:83], a[200:203], a[240:243], a[80:83]
M a[84:87], a[208:211], a[240:243], a[84:87]
ds_read_b64_tr_b16 a[184:185], v18 offset:0
ds_read_b64_tr_b16 a[186:187], v18 offset:1536
v_lshrrev_b32 v129, 4, v0
s_add_u32 s3, s21, 16
M a[84:87], a[212:215], a[244:247], a[84:87]
s_sub_u32 s31, s31, 1
s_cmp_eq_u32 s31, 0
s_cselect_b32 s58, -1920, s57
s_add_u32 s23, s23, s58
s_add_u32 s24, s24, s58
M a[88:91], a[220:223], a[244:247], a[88:91]
v_lshl_add_u32 v130, v128, 1, s3
s_lshl_b32 s4, s22, 6
M a[88:91], a[216:219], a[240:243], a[88:91]
s_waitcnt lgkmcnt(8)
M a[92:95], a[200:203], a[248:251], a[92:95]
ds_read_b128 a[240:243], v12 offset:10240
ds_read_b128 a[244:247], v13 offset:10240
s_add_u32 s4, s4, 98304
v_mul_u32_u24 v120, 400, v130
M a[92:95], a[204:207], a[252:255], a[92:95]
s_add_u32 m0, s30, 65536
s_nop 0
buffer_load_dwordx4 v6, s[12:15], s25 offen offset:0 lds
M a[96:99], a[212:215], a[252:255], a[96:99]
ds_read_b64_tr_b16 a[192:193], v19 offset:0
ds_read_b64_tr_b16 a[194:195], v19 offset:1536
M a[96:99], a[208:211], a[248:251], a[96:99]
v_lshl_add_u32 v120, v129, 4, v120
v_add_u32 v120, s4, v120
M a[100:103], a[216:219], a[248:251], a[100:103]
buffer_load_dwordx4 v7, s[12:15], s25 offen offset:1024 lds
M a[100:103], a[220:223], a[252:255], a[100:103]
s_waitcnt lgkmcnt(10)
v_subrev_u32 v130, 32, v130
v_max_i32 v130, 0, v130
M a[104:107], a[204:207], a[228:231], a[104:107]
ds_read_b128 a[248:251], v12 offset:12288
ds_read_b128 a[252:255], v13 offset:12288
M a[104:107], a[200:203], a[224:227], a[104:107]
v_mul_u32_u24 v121, 400, v130
v_lshl_add_u32 v121, v129, 4, v121
M a[108:111], a[208:211], a[224:227], a[108:111]
ds_read_b64_tr_b16 a[180:181], v17 offset:12288
ds_read_b64_tr_b16 a[182:183], v17 offset:13824
M a[108:111], a[212:215], a[228:231], a[108:111]
buffer_load_dwordx4 v8, s[12:15], s25 offen offset:2048 lds
v_add_u32 v121, s4, v121
v_bfe_u32 v131, v0, 2, 2
M a[112:115], a[220:223], a[228:231], a[112:115]
M a[112:115], a[216:219], a[224:227], a[112:115]
s_waitcnt lgkmcnt(10)
v_lshl_add_u32 v131, v129, 2, v131
v_lshl_add_u32 v131, v131, 1, s3
M a[116:119], a[200:203], a[232:235], a[116:119]
ds_read_b128 a[224:227], v12 offset:14336
ds_read_b128 a[228:231], v13 offset:14336
M a[116:119], a[204:207], a[236:239], a[116:119]
buffer_load_dwordx4 v9, s[12:15], s25 offen offset:3072 lds
v_and_b32 v132, 3, v0
v_lshlrev_b32 v132, 3, v132
M a[120:123], a[212:215], a[236:239], a[120:123]
ds_read_b64_tr_b16 a[188:189], v18 offset:12288
ds_read_b64_tr_b16 a[190:191], v18 offset:13824
M a[120:123], a[208:211], a[232:235], a[120:123]
M a[124:127], a[216:219], a[232:235], a[124:127]
s_add_u32 m0, s30, 69632
s_nop 0
buffer_load_dwordx4 v21, s[12:15], s25 offen offset:0 lds
v_add_u32 v132, s4, v132
s_movk_i32 s5, 400
M a[124:127], a[220:223], a[236:239], a[124:127]
s_waitcnt lgkmcnt(10)
M a[128:131], a[204:207], a[244:247], a[128:131]
ds_read_b128 a[232:235], v12 offset:16384
ds_read_b128 a[236:239], v13 offset:16384
v_mad_u32_u24 v122, v131, s5, v132
v_subrev_u32 v131, 32, v131
M a[128:131], a[200:203], a[240:243], a[128:131]
M a[132:135], a[208:211], a[240:243], a[132:135]
ds_read_b64_tr_b16 a[196:197], v19 offset:12288
ds_read_b64_tr_b16 a[198:199], v19 offset:13824
v_max_i32 v131, 0, v131
v_mad_u32_u24 v123, v131, s5, v132
M a[132:135], a[212:215], a[244:247], a[132:135]
buffer_load_dwordx4 v22, s[12:15], s25 offen offset:1024 lds
M a[136:139], a[220:223], a[244:247], a[136:139]
v_lshlrev_b32 v129, 2, v129
v_sub_u32 v128, v128, v129
M a[136:139], a[216:219], a[240:243], a[136:139]
s_waitcnt lgkmcnt(10)
M a[140:143], a[200:203], a[248:251], a[140:143]
s_sub_u32 s54, s54, 1
s_cmp_eq_u32 s54, 0
s_cselect_b32 s58, s55, s56
s_add_u32 s25, s25, s58
v_mov_b32 v129, 0xf149f2ca
s_cmp_eq_u32 s26, 0
s_cselect_b32 s3, 0xf149f2ca, 0
M a[140:143], a[204:207], a[252:255], a[140:143]
M a[144:147], a[212:215], a[252:255], a[144:147]
v_cmp_lt_i32 vcc, -9, v128
s_nop 1
v_cndmask_b32 v144, 0, v129, vcc
M a[144:147], a[208:211], a[248:251], a[144:147]
M a[148:151], a[216:219], a[248:251], a[148:151]
s_waitcnt vmcnt(12) lgkmcnt(0)
s_barrier
ds_read_b128 a[240:243], v10 offset:0
ds_read_b128 a[244:247], v11 offset:0
s_cmp_lg_u32 s101, 0
s_cbranch_scc1 Lk1_arr
v_mov_b32 v127, 1
s_and_b32 s41, s2, 128
s_mov_b64 exec, 1
buffer_atomic_add v127, off, s[36:39], s41 sc1
s_mov_b64 exec, -1
Lk1_arr:
M a[148:151], a[220:223], a[252:255], a[148:151]
s_add_u32 m0, s28, 131072
s_nop 0
buffer_load_dword v20, s[8:11], s24 offen lds
v_subrev_u32 v130, 0, v128
v_cmp_lt_u32 vcc, 7, v130
s_nop 1
v_cndmask_b32 v148, 0, v129, vcc
M a[152:155], a[204:207], a[228:231], a[152:155]
ds_read_b128 a[248:251], v10 offset:2048
ds_read_b128 a[252:255], v11 offset:2048
M a[152:155], a[200:203], a[224:227], a[152:155]
v_min_f32 v152, s3, v144
v_mov_b32 v156, 0x3f803f80
M a[156:159], a[208:211], a[224:227], a[156:159]
buffer_load_dword v23, s[8:11], s24 offen offset:256 lds
M a[156:159], a[212:215], a[228:231], a[156:159]
v_cmp_lt_i32 vcc, -8, v128
s_nop 1
v_cndmask_b32 v145, 0, v129, vcc
M a[160:163], a[220:223], a[228:231], a[160:163]
M a[160:163], a[216:219], a[224:227], a[160:163]
s_add_u32 m0, s29, 133120
s_nop 0
buffer_load_dwordx4 v2, s[8:11], s23 offen offset:0 lds
v_subrev_u32 v130, 1, v128
v_cmp_lt_u32 vcc, 7, v130
s_nop 1
v_cndmask_b32 v149, 0, v129, vcc
M a[164:167], a[200:203], a[232:235], a[164:167]
ds_read_b128 a[224:227], v10 offset:4096
ds_read_b128 a[228:231], v11 offset:4096
M a[164:167], a[204:207], a[236:239], a[164:167]
v_min_f32 v153, s3, v145
v_mov_b32 v157, 0x3f803f80
M a[168:171], a[212:215], a[236:239], a[168:171]
M a[168:171], a[208:211], a[232:235], a[168:171]
buffer_load_dwordx4 v3, s[8:11], s23 offen offset:1024 lds
v_cmp_lt_i32 vcc, -7, v128
s_nop 1
v_cndmask_b32 v146, 0, v129, vcc
M a[172:175], a[216:219], a[232:235], a[172:175]
M a[172:175], a[220:223], a[236:239], a[172:175]
s_waitcnt lgkmcnt(4)
M a[68:71], a[176:179], a[240:243], a[68:71]
ds_read_b128 a[232:235], v10 offset:6144
ds_read_b128 a[236:239], v11 offset:6144
v_subrev_u32 v130, 2, v128
v_cmp_lt_u32 vcc, 7, v130
s_nop 1
v_cndmask_b32 v150, 0, v129, vcc
M a[68:71], a[180:183], a[244:247], a[68:71]
buffer_load_dwordx4 v4, s[8:11], s23 offen offset:2048 lds
v_min_f32 v154, s3, v146
v_mov_b32 v158, 0x3f803f80
M a[72:75], a[188:191], a[244:247], a[72:75]
ds_read_b64_tr_b16 a[200:201], v14 offset:0
ds_read_b64_tr_b16 a[202:203], v14 offset:1536
M a[72:75], a[184:187], a[240:243], a[72:75]
v_cmp_lt_i32 vcc, -6, v128
s_nop 1
v_cndmask_b32 v147, 0, v129, vcc
M a[76:79], a[192:195], a[240:243], a[76:79]
buffer_load_dwordx4 v5, s[8:11], s23 offen offset:3072 lds
v_subrev_u32 v130, 3, v128
v_cmp_lt_u32 vcc, 7, v130
s_nop 1
v_cndmask_b32 v151, 0, v129, vcc
M a[76:79], a[196:199], a[244:247], a[76:79]
s_waitcnt lgkmcnt(6)
M a[80:83], a[180:183], a[252:255], a[80:83]
ds_read_b128 a[240:243], v10 offset:8192
ds_read_b128 a[244:247], v11 offset:8192
v_min_f32 v155, s3, v147
v_mov_b32 v159, 0x3f803f80
M a[80:83], a[176:179], a[248:251], a[80:83]
s_add_u32 s16, s50, 83886080
s_addc_u32 s17, s51, 0
M a[84:87], a[184:187], a[248:251], a[84:87]
ds_read_b64_tr_b16 a[208:209], v15 offset:0
ds_read_b64_tr_b16 a[210:211], v15 offset:1536
M a[84:87], a[188:191], a[252:255], a[84:87]
s_sub_u32 s31, s31, 1
s_cmp_eq_u32 s31, 0
s_cselect_b32 s58, -1920, s57
s_add_u32 s23, s23, s58
s_add_u32 s24, s24, s58
s_mov_b32 s18, 4194304
s_mov_b32 s19, 0x00020000
M a[88:91], a[196:199], a[252:255], a[88:91]
s_lshl_b32 s3, s26, 18
s_lshl_b32 s4, s27, 14
M a[88:91], a[192:195], a[248:251], a[88:91]
s_waitcnt lgkmcnt(8)
M a[92:95], a[176:179], a[224:227], a[92:95]
ds_read_b128 a[248:251], v10 offset:10240
ds_read_b128 a[252:255], v11 offset:10240
s_add_u32 s3, s3, s4
s_lshl_b32 s4, s21, 13
M a[92:95], a[180:183], a[228:231], a[92:95]
s_add_u32 m0, s30, 98304
s_nop 0
buffer_load_dwordx4 v6, s[12:15], s25 offen offset:0 lds
s_add_u32 s3, s3, s4
s_lshl_b32 s4, s22, 10
M a[96:99], a[188:191], a[228:231], a[96:99]
ds_read_b64_tr_b16 a[216:217], v16 offset:0
ds_read_b64_tr_b16 a[218:219], v16 offset:1536
M a[96:99], a[184:187], a[224:227], a[96:99]
s_add_u32 s6, s3, s4
s_mov_b32 s7, 0x3e8293ee
M a[100:103], a[192:195], a[224:227], a[100:103]
buffer_load_dwordx4 v7, s[12:15], s25 offen offset:1024 lds
s_lshl_b32 s65, s26, 8
s_lshl_b32 s3, s27, 4
M a[100:103], a[196:199], a[228:231], a[100:103]
s_waitcnt lgkmcnt(10)
M a[104:107], a[180:183], a[236:239], a[104:107]
ds_read_b128 a[224:227], v10 offset:12288
ds_read_b128 a[228:231], v11 offset:12288
s_add_u32 s65, s65, s3
s_lshl_b32 s3, s101, 2
M a[104:107], a[176:179], a[232:235], a[104:107]
s_add_u32 s65, s65, s3
s_add_u32 s65, s65, 8400896
M a[108:111], a[184:187], a[232:235], a[108:111]
ds_read_b64_tr_b16 a[204:205], v14 offset:12288
ds_read_b64_tr_b16 a[206:207], v14 offset:13824
M a[108:111], a[188:191], a[236:239], a[108:111]
buffer_load_dwordx4 v8, s[12:15], s25 offen offset:2048 lds
s_mov_b32 s40, 0
v_mov_b32 v119, 0
M a[112:115], a[196:199], a[236:239], a[112:115]
s_mov_b64 s[4:5], s[50:51]
s_and_b32 s20, s2, 7
M a[112:115], a[192:195], a[232:235], a[112:115]
s_waitcnt lgkmcnt(10)
M a[116:119], a[176:179], a[240:243], a[116:119]
ds_read_b128 a[232:235], v10 offset:14336
ds_read_b128 a[236:239], v11 offset:14336
s_lshr_b32 s33, s2, 6
s_lshl_b32 s33, s33, 3
M a[116:119], a[180:183], a[244:247], a[116:119]
buffer_load_dwordx4 v9, s[12:15], s25 offen offset:3072 lds
s_add_u32 s20, s20, s33
s_bfe_u32 s21, s2, 0x30003
M a[120:123], a[188:191], a[244:247], a[120:123]
ds_read_b64_tr_b16 a[212:213], v15 offset:12288
ds_read_b64_tr_b16 a[214:215], v15 offset:13824
M a[120:123], a[184:187], a[240:243], a[120:123]
s_sub_u32 s35, 15, s21
s_cmp_lt_u32 s101, 2
s_cselect_b32 s35, s21, s35
M a[124:127], a[192:195], a[240:243], a[124:127]
s_add_u32 m0, s30, 102400
s_nop 0
buffer_load_dwordx4 v21, s[12:15], s25 offen offset:0 lds
s_lshl_b32 s33, s20, 7
s_lshl_b32 s34, s35, 3
M a[124:127], a[196:199], a[244:247], a[124:127]
s_waitcnt lgkmcnt(10)
M a[128:131], a[180:183], a[252:255], a[128:131]
ds_read_b128 a[240:243], v10 offset:16384
ds_read_b128 a[244:247], v11 offset:16384
s_add_u32 s33, s33, s34
s_and_b32 s34, s101, 1
M a[128:131], a[176:179], a[248:251], a[128:131]
s_lshl_b32 s34, s34, 2
s_add_u32 s33, s33, s34
M a[132:135], a[184:187], a[248:251], a[132:135]
ds_read_b64_tr_b16 a[220:221], v16 offset:12288
ds_read_b64_tr_b16 a[222:223], v16 offset:13824
M a[132:135], a[188:191], a[252:255], a[132:135]
buffer_load_dwordx4 v22, s[12:15], s25 offen offset:1024 lds
s_lshl_b32 s64, s33, 12
s_mov_b32 s44, s4
M a[136:139], a[196:199], a[252:255], a[136:139]
s_mov_b32 s45, s5
s_mov_b32 s46, 16777216
M a[136:139], a[192:195], a[248:251], a[136:139]
s_waitcnt lgkmcnt(10)
M a[140:143], a[176:179], a[224:227], a[140:143]
s_sub_u32 s54, s54, 1
s_cmp_eq_u32 s54, 0
s_cselect_b32 s58, s55, s56
s_add_u32 s25, s25, s58
s_mov_b32 s47, 0x00020000
M a[140:143], a[180:183], a[228:231], a[140:143]
M a[144:147], a[188:191], a[228:231], a[144:147]
M a[144:147], a[184:187], a[224:227], a[144:147]
M a[148:151], a[192:195], a[224:227], a[148:151]
s_waitcnt vmcnt(12) lgkmcnt(0)
s_barrier
ds_read_b128 a[248:251], v10 offset:18432
ds_read_b128 a[252:255], v11 offset:18432
M a[148:151], a[196:199], a[228:231], a[148:151]
s_add_u32 m0, s28, 0
s_nop 0
buffer_load_dword v20, s[8:11], s24 offen lds
M a[152:155], a[180:183], a[236:239], a[152:155]
ds_read_b128 a[224:227], v10 offset:20480
ds_read_b128 a[228:231], v11 offset:20480
M a[152:155], a[176:179], a[232:235], a[152:155]
M a[156:159], a[184:187], a[232:235], a[156:159]
buffer_load_dword v23, s[8:11], s24 offen offset:256 lds
M a[156:159], a[188:191], a[236:239], a[156:159]
M a[160:163], a[196:199], a[236:239], a[160:163]
M a[160:163], a[192:195], a[232:235], a[160:163]
s_add_u32 m0, s29, 2048
s_nop 0
buffer_load_dwordx4 v2, s[8:11], s23 offen offset:0 lds
M a[164:167], a[176:179], a[240:243], a[164:167]
ds_read_b128 a[232:235], v10 offset:22528
ds_read_b128 a[236:239], v11 offset:22528
M a[164:167], a[180:183], a[244:247], a[164:167]
M a[168:171], a[188:191], a[244:247], a[168:171]
M a[168:171], a[184:187], a[240:243], a[168:171]
buffer_load_dwordx4 v3, s[8:11], s23 offen offset:1024 lds
M a[172:175], a[192:195], a[240:243], a[172:175]
M a[172:175], a[196:199], a[244:247], a[172:175]
s_waitcnt lgkmcnt(4)
M a[68:71], a[200:203], a[248:251], a[68:71]
ds_read_b128 a[240:243], v10 offset:24576
ds_read_b128 a[244:247], v11 offset:24576
M a[68:71], a[204:207], a[252:255], a[68:71]
buffer_load_dwordx4 v4, s[8:11], s23 offen offset:2048 lds
M a[72:75], a[212:215], a[252:255], a[72:75]
ds_read_b64_tr_b16 a[176:177], v14 offset:28672
ds_read_b64_tr_b16 a[178:179], v14 offset:30208
M a[72:75], a[208:211], a[248:251], a[72:75]
M a[76:79], a[216:219], a[248:251], a[76:79]
buffer_load_dwordx4 v5, s[8:11], s23 offen offset:3072 lds
M a[76:79], a[220:223], a[252:255], a[76:79]
s_waitcnt lgkmcnt(6)
M a[80:83], a[204:207], a[228:231], a[80:83]
ds_read_b128 a[248:251], v10 offset:26624
ds_read_b128 a[252:255], v11 offset:26624
M a[80:83], a[200:203], a[224:227], a[80:83]
M a[84:87], a[208:211], a[224:227], a[84:87]
ds_read_b64_tr_b16 a[184:185], v15 offset:28672
ds_read_b64_tr_b16 a[186:187], v15 offset:30208
M a[84:87], a[212:215], a[228:231], a[84:87]
s_sub_u32 s31, s31, 1
s_cmp_eq_u32 s31, 0
s_cselect_b32 s58, -1920, s57
s_add_u32 s23, s23, s58
s_add_u32 s24, s24, s58
M a[88:91], a[220:223], a[228:231], a[88:91]
M a[88:91], a[216:219], a[224:227], a[88:91]
s_waitcnt lgkmcnt(8)
M a[92:95], a[200:203], a[232:235], a[92:95]
ds_read_b128 a[224:227], v10 offset:28672
ds_read_b128 a[228:231], v11 offset:28672
M a[92:95], a[204:207], a[236:239], a[92:95]
s_add_u32 m0, s30, 36864
s_nop 0
buffer_load_dwordx4 v6, s[12:15], s25 offen offset:0 lds
M a[96:99], a[212:215], a[236:239], a[96:99]
ds_read_b64_tr_b16 a[192:193], v16 offset:28672
ds_read_b64_tr_b16 a[194:195], v16 offset:30208
M a[96:99], a[208:211], a[232:235], a[96:99]
M a[100:103], a[216:219], a[232:235], a[100:103]
buffer_load_dwordx4 v7, s[12:15], s25 offen offset:1024 lds
M a[100:103], a[220:223], a[236:239], a[100:103]
s_waitcnt lgkmcnt(10)
M a[104:107], a[204:207], a[244:247], a[104:107]
ds_read_b128 a[232:235], v10 offset:30720
ds_read_b128 a[236:239], v11 offset:30720
M a[104:107], a[200:203], a[240:243], a[104:107]
M a[108:111], a[208:211], a[240:243], a[108:111]
ds_read_b64_tr_b16 a[180:181], v14 offset:40960
ds_read_b64_tr_b16 a[182:183], v14 offset:42496
M a[108:111], a[212:215], a[244:247], a[108:111]
buffer_load_dwordx4 v8, s[12:15], s25 offen offset:2048 lds
M a[112:115], a[220:223], a[244:247], a[112:115]
M a[112:115], a[216:219], a[240:243], a[112:115]
s_waitcnt lgkmcnt(10)
M a[116:119], a[200:203], a[248:251], a[116:119]
ds_read_b128 a[240:243], v10 offset:32768
ds_read_b128 a[244:247], v11 offset:32768
M a[116:119], a[204:207], a[252:255], a[116:119]
buffer_load_dwordx4 v9, s[12:15], s25 offen offset:3072 lds
M a[120:123], a[212:215], a[252:255], a[120:123]
ds_read_b64_tr_b16 a[188:189], v15 offset:40960
ds_read_b64_tr_b16 a[190:191], v15 offset:42496
M a[120:123], a[208:211], a[248:251], a[120:123]
M a[124:127], a[216:219], a[248:251], a[124:127]
s_add_u32 m0, s30, 40960
s_nop 0
buffer_load_dwordx4 v21, s[12:15], s25 offen offset:0 lds
M a[124:127], a[220:223], a[252:255], a[124:127]
s_waitcnt lgkmcnt(10)
M a[128:131], a[204:207], a[228:231], a[128:131]
ds_read_b128 a[248:251], v10 offset:34816
ds_read_b128 a[252:255], v11 offset:34816
M a[128:131], a[200:203], a[224:227], a[128:131]
M a[132:135], a[208:211], a[224:227], a[132:135]
ds_read_b64_tr_b16 a[196:197], v16 offset:40960
ds_read_b64_tr_b16 a[198:199], v16 offset:42496
M a[132:135], a[212:215], a[228:231], a[132:135]
buffer_load_dwordx4 v22, s[12:15], s25 offen offset:1024 lds
M a[136:139], a[220:223], a[228:231], a[136:139]
M a[136:139], a[216:219], a[224:227], a[136:139]
s_waitcnt lgkmcnt(10)
M a[140:143], a[200:203], a[232:235], a[140:143]
s_sub_u32 s54, s54, 1
s_cmp_eq_u32 s54, 0
s_cselect_b32 s58, s55, s56
s_add_u32 s25, s25, s58
M a[140:143], a[204:207], a[236:239], a[140:143]
M a[144:147], a[212:215], a[236:239], a[144:147]
M a[144:147], a[208:211], a[232:235], a[144:147]
M a[148:151], a[216:219], a[232:235], a[148:151]
s_waitcnt vmcnt(12) lgkmcnt(0)
s_barrier
ds_read_b128 a[224:227], v12 offset:0
ds_read_b128 a[228:231], v13 offset:0
M a[148:151], a[220:223], a[236:239], a[148:151]
s_add_u32 m0, s28, 18432
s_nop 0
buffer_load_dword v20, s[8:11], s24 offen lds
M a[152:155], a[204:207], a[244:247], a[152:155]
ds_read_b128 a[232:235], v12 offset:2048
ds_read_b128 a[236:239], v13 offset:2048
M a[152:155], a[200:203], a[240:243], a[152:155]
M a[156:159], a[208:211], a[240:243], a[156:159]
buffer_load_dword v23, s[8:11], s24 offen offset:256 lds
M a[156:159], a[212:215], a[244:247], a[156:159]
M a[160:163], a[220:223], a[244:247], a[160:163]
M a[160:163], a[216:219], a[240:243], a[160:163]
s_add_u32 m0, s29, 20480
s_nop 0
buffer_load_dwordx4 v2, s[8:11], s23 offen offset:0 lds
M a[164:167], a[200:203], a[248:251], a[164:167]
ds_read_b128 a[240:243], v12 offset:4096
ds_read_b128 a[244:247], v13 offset:4096
M a[164:167], a[204:207], a[252:255], a[164:167]
M a[168:171], a[212:215], a[252:255], a[168:171]
M a[168:171], a[208:211], a[248:251], a[168:171]
buffer_load_dwordx4 v3, s[8:11], s23 offen offset:1024 lds
M a[172:175], a[216:219], a[248:251], a[172:175]
M a[172:175], a[220:223], a[252:255], a[172:175]
s_waitcnt lgkmcnt(4)
M a[68:71], a[176:179], a[224:227], a[68:71]
ds_read_b128 a[248:251], v12 offset:6144
ds_read_b128 a[252:255], v13 offset:6144
M a[68:71], a[180:183], a[228:231], a[68:71]
buffer_load_dwordx4 v4, s[8:11], s23 offen offset:2048 lds
M a[72:75], a[188:191], a[228:231], a[72:75]
ds_read_b64_tr_b16 a[200:201], v17 offset:0
ds_read_b64_tr_b16 a[202:203], v17 offset:1536
M a[72:75], a[184:187], a[224:227], a[72:75]
M a[76:79], a[192:195], a[224:227], a[76:79]
buffer_load_dwordx4 v5, s[8:11], s23 offen offset:3072 lds
M a[76:79], a[196:199], a[228:231], a[76:79]
s_waitcnt lgkmcnt(6)
M a[80:83], a[180:183], a[236:239], a[80:83]
ds_read_b128 a[224:227], v12 offset:8192
ds_read_b128 a[228:231], v13 offset:8192
M a[80:83], a[176:179], a[232:235], a[80:83]
s_sub_u32 s31, s31, 1
s_cmp_eq_u32 s31, 0
s_cselect_b32 s58, -1920, s57
s_add_u32 s23, s23, s58
s_add_u32 s24, s24, s58
M a[84:87], a[184:187], a[232:235], a[84:87]
ds_read_b64_tr_b16 a[208:209], v18 offset:0
ds_read_b64_tr_b16 a[210:211], v18 offset:1536
M a[84:87], a[188:191], a[236:239], a[84:87]
M a[88:91], a[196:199], a[236:239], a[88:91]
M a[88:91], a[192:195], a[232:235], a[88:91]
s_add_u32 m0, s30, 65536
s_nop 0
buffer_load_dwordx4 v6, s[12:15], s25 offen offset:0 lds
s_waitcnt lgkmcnt(8)
M a[92:95], a[176:179], a[240:243], a[92:95]
ds_read_b128 a[232:235], v12 offset:10240
ds_read_b128 a[236:239], v13 offset:10240
M a[92:95], a[180:183], a[244:247], a[92:95]
M a[96:99], a[188:191], a[244:247], a[96:99]
ds_read_b64_tr_b16 a[216:217], v19 offset:0
ds_read_b64_tr_b16 a[218:219], v19 offset:1536
M a[96:99], a[184:187], a[240:243], a[96:99]
buffer_load_dwordx4 v7, s[12:15], s25 offen offset:1024 lds
M a[100:103], a[192:195], a[240:243], a[100:103]
M a[100:103], a[196:199], a[244:247], a[100:103]
s_waitcnt lgkmcnt(10)
M a[104:107], a[180:183], a[252:255], a[104:107]
ds_read_b128 a[240:243], v12 offset:12288
ds_read_b128 a[244:247], v13 offset:12288
M a[104:107], a[176:179], a[248:251], a[104:107]
buffer_load_dwordx4 v8, s[12:15], s25 offen offset:2048 lds
M a[108:111], a[184:187], a[248:251], a[108:111]
ds_read_b64_tr_b16 a[204:205], v17 offset:12288
ds_read_b64_tr_b16 a[206:207], v17 offset:13824
M a[108:111], a[188:191], a[252:255], a[108:111]
M a[112:115], a[196:199], a[252:255], a[112:115]
buffer_load_dwordx4 v9, s[12:15], s25 offen offset:3072 lds
M a[112:115], a[192:195], a[248:251], a[112:115]
s_waitcnt lgkmcnt(10)
M a[116:119], a[176:179], a[224:227], a[116:119]
ds_read_b128 a[248:251], v12 offset:14336
ds_read_b128 a[252:255], v13 offset:14336
M a[116:119], a[180:183], a[228:231], a[116:119]
M a[120:123], a[188:191], a[228:231], a[120:123]
ds_read_b64_tr_b16 a[212:213], v18 offset:12288
ds_read_b64_tr_b16 a[214:215], v18 offset:13824
M a[120:123], a[184:187], a[224:227], a[120:123]
s_add_u32 m0, s30, 69632
s_nop 0
buffer_load_dwordx4 v21, s[12:15], s25 offen offset:0 lds
M a[124:127], a[192:195], a[224:227], a[124:127]
M a[124:127], a[196:199], a[228:231], a[124:127]
buffer_load_dwordx4 v22, s[12:15], s25 offen offset:1024 lds
s_waitcnt lgkmcnt(10)
M a[128:131], a[180:183], a[236:239], a[128:131]
ds_read_b128 a[224:227], v12 offset:16384
ds_read_b128 a[228:231], v13 offset:16384
M a[128:131], a[176:179], a[232:235], a[128:131]
M a[132:135], a[184:187], a[232:235], a[132:135]
ds_read_b64_tr_b16 a[220:221], v19 offset:12288
ds_read_b64_tr_b16 a[222:223], v19 offset:13824
M a[132:135], a[188:191], a[236:239], a[132:135]
M a[136:139], a[196:199], a[236:239], a[136:139]
s_sub_u32 s54, s54, 1
s_cmp_eq_u32 s54, 0
s_cselect_b32 s58, s55, s56
s_add_u32 s25, s25, s58
M a[136:139], a[192:195], a[232:235], a[136:139]
s_waitcnt lgkmcnt(10)
M a[140:143], a[176:179], a[240:243], a[140:143]
buffer_load_dword v125, v119, s[36:39], 0 offen sc1
M a[140:143], a[180:183], a[244:247], a[140:143]
M a[144:147], a[188:191], a[244:247], a[144:147]
M a[144:147], a[184:187], a[240:243], a[144:147]
M a[148:151], a[192:195], a[240:243], a[148:151]
s_waitcnt vmcnt(13) lgkmcnt(0)
s_barrier
ds_read_b128 a[232:235], v10 offset:0
ds_read_b128 a[236:239], v11 offset:0
s_waitcnt vmcnt(0)
v_cmp_gt_u32 vcc, 0x80, v125
s_nop 0
s_cbranch_vccnz Lk1_spinq
Lk1_gotq:
M a[148:151], a[196:199], a[244:247], a[148:151]
s_add_u32 m0, s28, 131072
s_nop 0
buffer_load_dword v20, s[8:11], s24 offen lds
M a[152:155], a[180:183], a[252:255], a[152:155]
ds_read_b128 a[240:243], v10 offset:2048
ds_read_b128 a[244:247], v11 offset:2048
M a[152:155], a[176:179], a[248:251], a[152:155]
M a[156:159], a[184:187], a[248:251], a[156:159]
buffer_load_dword v23, s[8:11], s24 offen offset:256 lds
M a[156:159], a[188:191], a[252:255], a[156:159]
M a[160:163], a[196:199], a[252:255], a[160:163]
M a[160:163], a[192:195], a[248:251], a[160:163]
s_add_u32 m0, s29, 133120
s_nop 0
buffer_load_dwordx4 v2, s[8:11], s23 offen offset:0 lds
M a[164:167], a[176:179], a[224:227], a[164:167]
ds_read_b128 a[248:251], v10 offset:4096
ds_read_b128 a[252:255], v11 offset:4096
M a[164:167], a[180:183], a[228:231], a[164:167]
M a[168:171], a[188:191], a[228:231], a[168:171]
M a[168:171], a[184:187], a[224:227], a[168:171]
buffer_load_dwordx4 v3, s[8:11], s23 offen offset:1024 lds
M a[172:175], a[192:195], a[224:227], a[172:175]
M a[172:175], a[196:199], a[228:231], a[172:175]
s_waitcnt lgkmcnt(4)
M a[68:71], a[200:203], a[232:235], a[68:71]
ds_read_b128 a[224:227], v10 offset:6144
ds_read_b128 a[228:231], v11 offset:6144
v_mov_b32 v208, 0
v_mov_b32 v209, 0
M a[68:71], a[204:207], a[236:239], a[68:71]
buffer_load_dwordx4 v4, s[8:11], s23 offen offset:2048 lds
M a[72:75], a[212:215], a[236:239], a[72:75]
ds_read_b64_tr_b16 a[176:177], v14 offset:0
ds_read_b64_tr_b16 a[178:179], v14 offset:1536
v_mov_b32 v210, 0
v_mov_b32 v211, 0
M a[72:75], a[208:211], a[232:235], a[72:75]
M a[76:79], a[216:219], a[232:235], a[76:79]
buffer_load_dwordx4 v5, s[8:11], s23 offen offset:3072 lds
v_mov_b32 v212, 0
v_mov_b32 v213, 0
M a[76:79], a[220:223], a[236:239], a[76:79]
s_waitcnt lgkmcnt(6)
M a[80:83], a[204:207], a[244:247], a[80:83]
ds_read_b128 a[232:235], v10 offset:8192
ds_read_b128 a[236:239], v11 offset:8192
v_mov_b32 v214, 0
v_mov_b32 v215, 0
M a[80:83], a[200:203], a[240:243], a[80:83]
s_sub_u32 s31, s31, 1
s_cmp_eq_u32 s31, 0
s_cselect_b32 s58, -1920, s57
s_add_u32 s23, s23, s58
s_add_u32 s24, s24, s58
M a[84:87], a[208:211], a[240:243], a[84:87]
ds_read_b64_tr_b16 a[184:185], v15 offset:0
ds_read_b64_tr_b16 a[186:187], v15 offset:1536
M a[84:87], a[212:215], a[244:247], a[84:87]
v_mov_b32 v216, 0
v_mov_b32 v217, 0
M a[88:91], a[220:223], a[244:247], a[88:91]
M a[88:91], a[216:219], a[240:243], a[88:91]
buffer_load_dwordx4 a[0:3], v1, s[44:47], s64 offen offset:0 sc1
s_waitcnt lgkmcnt(8)
v_mov_b32 v218, 0
v_mov_b32 v219, 0
M a[92:95], a[200:203], a[248:251], a[92:95]
ds_read_b128 a[240:243], v10 offset:10240
ds_read_b128 a[244:247], v11 offset:10240
M a[92:95], a[204:207], a[252:255], a[92:95]
v_mov_b32 v220, 0
v_mov_b32 v221, 0
M a[96:99], a[212:215], a[252:255], a[96:99]
ds_read_b64_tr_b16 a[192:193], v16 offset:0
ds_read_b64_tr_b16 a[194:195], v16 offset:1536
M a[96:99], a[208:211], a[248:251], a[96:99]
buffer_load_dwordx4 a[4:7], v1, s[44:47], s64 offen offset:1024 sc1
v_mov_b32 v222, 0
v_mov_b32 v223, 0
M a[100:103], a[216:219], a[248:251], a[100:103]
M a[100:103], a[220:223], a[252:255], a[100:103]
s_waitcnt lgkmcnt(10)
M a[104:107], a[204:207], a[228:231], a[104:107]
ds_read_b128 a[248:251], v10 offset:12288
ds_read_b128 a[252:255], v11 offset:12288
v_mov_b32 v224, 0
v_mov_b32 v225, 0
M a[104:107], a[200:203], a[224:227], a[104:107]
buffer_load_dwordx4 a[8:11], v1, s[44:47], s64 offen offset:2048 sc1
M a[108:111], a[208:211], a[224:227], a[108:111]
ds_read_b64_tr_b16 a[180:181], v14 offset:12288
ds_read_b64_tr_b16 a[182:183], v14 offset:13824
v_mov_b32 v226, 0
v_mov_b32 v227, 0
M a[108:111], a[212:215], a[228:231], a[108:111]
M a[112:115], a[220:223], a[228:231], a[112:115]
buffer_load_dwordx4 a[12:15], v1, s[44:47], s64 offen offset:3072 sc1
s_add_u32 s64, s64, 4096
v_mov_b32 v228, 0
v_mov_b32 v229, 0
M a[112:115], a[216:219], a[224:227], a[112:115]
s_waitcnt lgkmcnt(10)
M a[116:119], a[200:203], a[232:235], a[116:119]
ds_read_b128 a[224:227], v10 offset:14336
ds_read_b128 a[228:231], v11 offset:14336
v_mov_b32 v230, 0
v_mov_b32 v231, 0
M a[116:119], a[204:207], a[236:239], a[116:119]
M a[120:123], a[212:215], a[236:239], a[120:123]
ds_read_b64_tr_b16 a[188:189], v15 offset:12288
ds_read_b64_tr_b16 a[190:191], v15 offset:13824
M a[120:123], a[208:211], a[232:235], a[120:123]
buffer_load_dwordx4 a[16:19], v1, s[44:47], s64 offen offset:0 sc1
v_mov_b32 v232, 0
v_mov_b32 v233, 0
M a[124:127], a[216:219], a[232:235], a[124:127]
M a[124:127], a[220:223], a[236:239], a[124:127]
buffer_load_dwordx4 a[20:23], v1, s[44:47], s64 offen offset:1024 sc1
s_waitcnt lgkmcnt(10)
v_mov_b32 v234, 0
v_mov_b32 v235, 0
M a[128:131], a[204:207], a[244:247], a[128:131]
ds_read_b128 a[232:235], v10 offset:16384
ds_read_b128 a[236:239], v11 offset:16384
M a[128:131], a[200:203], a[240:243], a[128:131]
v_mov_b32 v236, 0
v_mov_b32 v237, 0
M a[132:135], a[208:211], a[240:243], a[132:135]
ds_read_b64_tr_b16 a[196:197], v16 offset:12288
ds_read_b64_tr_b16 a[198:199], v16 offset:13824
M a[132:135], a[212:215], a[244:247], a[132:135]
v_mov_b32 v238, 0
v_mov_b32 v239, 0
M a[136:139], a[220:223], a[244:247], a[136:139]
buffer_load_dwordx4 a[24:27], v1, s[44:47], s64 offen offset:2048 sc1
M a[136:139], a[216:219], a[240:243], a[136:139]
s_waitcnt lgkmcnt(10)
M a[140:143], a[200:203], a[248:251], a[140:143]
buffer_load_dwordx4 a[28:31], v1, s[44:47], s64 offen offset:3072 sc1
s_add_u32 s64, s64, 4096
v_mov_b32 v240, 0
v_mov_b32 v241, 0
M a[140:143], a[204:207], a[252:255], a[140:143]
M a[144:147], a[212:215], a[252:255], a[144:147]
v_mov_b32 v242, 0
v_mov_b32 v243, 0
M a[144:147], a[208:211], a[248:251], a[144:147]
M a[148:151], a[216:219], a[248:251], a[148:151]
s_waitcnt vmcnt(15) lgkmcnt(0)
s_barrier
ds_read_b128 a[240:243], v10 offset:18432
ds_read_b128 a[244:247], v11 offset:18432
v_mov_b32 v244, 0
v_mov_b32 v245, 0
M a[148:151], a[220:223], a[252:255], a[148:151]
buffer_load_dwordx4 a[32:35], v1, s[44:47], s64 offen offset:0 sc1
M a[152:155], a[204:207], a[228:231], a[152:155]
ds_read_b128 a[248:251], v10 offset:20480
ds_read_b128 a[252:255], v11 offset:20480
v_mov_b32 v246, 0
v_mov_b32 v247, 0
M a[152:155], a[200:203], a[224:227], a[152:155]
M a[156:159], a[208:211], a[224:227], a[156:159]
buffer_load_dwordx4 a[36:39], v1, s[44:47], s64 offen offset:1024 sc1
M a[156:159], a[212:215], a[228:231], a[156:159]
v_mov_b32 v248, 0
v_mov_b32 v249, 0
M a[160:163], a[220:223], a[228:231], a[160:163]
M a[160:163], a[216:219], a[224:227], a[160:163]
buffer_load_dwordx4 a[40:43], v1, s[44:47], s64 offen offset:2048 sc1
v_mov_b32 v250, 0
v_mov_b32 v251, 0
M a[164:167], a[200:203], a[232:235], a[164:167]
ds_read_b128 a[224:227], v10 offset:22528
ds_read_b128 a[228:231], v11 offset:22528
M a[164:167], a[204:207], a[236:239], a[164:167]
v_mov_b32 v252, 0
v_mov_b32 v253, 0
M a[168:171], a[212:215], a[236:239], a[168:171]
M a[168:171], a[208:211], a[232:235], a[168:171]
buffer_load_dwordx4 a[44:47], v1, s[44:47], s64 offen offset:3072 sc1
s_add_u32 s64, s64, 4096
v_mov_b32 v254, 0
v_mov_b32 v255, 0
M a[172:175], a[216:219], a[232:235], a[172:175]
M a[172:175], a[220:223], a[236:239], a[172:175]
s_waitcnt lgkmcnt(4)
M a[68:71], a[176:179], a[240:243], a[68:71]
ds_read_b128 a[232:235], v10 offset:24576
ds_read_b128 a[236:239], v11 offset:24576
s_mov_b32 s22, s101
s_and_b32 s23, s22, 1
M a[68:71], a[180:183], a[244:247], a[68:71]
buffer_load_dwordx4 a[48:51], v1, s[44:47], s64 offen offset:0 sc1
M a[72:75], a[188:191], a[244:247], a[72:75]
ds_read_b64_tr_b16 a[200:201], v14 offset:28672
ds_read_b64_tr_b16 a[202:203], v14 offset:30208
s_lshr_b32 s24, s22, 1
s_lshl_b32 s33, s24, 14
M a[72:75], a[184:187], a[240:243], a[72:75]
M a[76:79], a[192:195], a[240:243], a[76:79]
M a[76:79], a[196:199], a[244:247], a[76:79]
s_waitcnt lgkmcnt(6)
s_lshl_b32 s34, s23, 13
s_add_u32 s29, s33, s34
M a[80:83], a[180:183], a[252:255], a[80:83]
ds_read_b128 a[240:243], v10 offset:26624
ds_read_b128 a[244:247], v11 offset:26624
M a[80:83], a[176:179], a[248:251], a[80:83]
s_lshl_b32 s28, s20, 20
s_add_u32 s28, s28, s34
M a[84:87], a[184:187], a[248:251], a[84:87]
ds_read_b64_tr_b16 a[208:209], v15 offset:28672
ds_read_b64_tr_b16 a[210:211], v15 offset:30208
M a[84:87], a[188:191], a[252:255], a[84:87]
buffer_load_dwordx4 a[52:55], v1, s[44:47], s64 offen offset:1024 sc1
M a[88:91], a[196:199], a[252:255], a[88:91]
s_mov_b32 s25, s28
s_lshl_b32 s33, s21, 16
M a[88:91], a[192:195], a[248:251], a[88:91]
s_waitcnt lgkmcnt(8)
M a[92:95], a[176:179], a[224:227], a[92:95]
ds_read_b128 a[248:251], v10 offset:28672
ds_read_b128 a[252:255], v11 offset:28672
s_add_u32 s34, s28, s33
s_add_u32 s34, s34, 65536
M a[92:95], a[180:183], a[228:231], a[92:95]
M a[96:99], a[188:191], a[228:231], a[96:99]
ds_read_b64_tr_b16 a[216:217], v16 offset:28672
ds_read_b64_tr_b16 a[218:219], v16 offset:30208
M a[96:99], a[184:187], a[224:227], a[96:99]
s_add_u32 s32, s28, 491520
s_sub_u32 s33, s32, s33
M a[100:103], a[192:195], a[224:227], a[100:103]
buffer_load_dwordx4 a[56:59], v1, s[44:47], s64 offen offset:2048 sc1
M a[100:103], a[196:199], a[228:231], a[100:103]
s_waitcnt lgkmcnt(10)
s_add_u32 s33, s33, 491520
s_cmp_eq_u32 s24, 0
s_cselect_b32 s27, s34, s32
s_cselect_b32 s28, s32, s33
M a[104:107], a[180:183], a[236:239], a[104:107]
ds_read_b128 a[224:227], v10 offset:30720
ds_read_b128 a[228:231], v11 offset:30720
M a[104:107], a[176:179], a[232:235], a[104:107]
M a[108:111], a[184:187], a[232:235], a[108:111]
ds_read_b64_tr_b16 a[204:205], v14 offset:40960
ds_read_b64_tr_b16 a[206:207], v14 offset:42496
s_add_u32 s26, s25, 16384
s_add_u32 s62, s27, 16384
M a[108:111], a[188:191], a[236:239], a[108:111]
M a[112:115], a[196:199], a[236:239], a[112:115]
s_add_u32 s63, s28, 16384
s_lshl_b32 s31, s21, 7
M a[112:115], a[192:195], a[232:235], a[112:115]
s_waitcnt lgkmcnt(10)
M a[116:119], a[176:179], a[240:243], a[116:119]
ds_read_b128 a[232:235], v10 offset:32768
ds_read_b128 a[236:239], v11 offset:32768
M a[116:119], a[180:183], a[244:247], a[116:119]
buffer_load_dwordx4 a[60:63], v1, s[44:47], s64 offen offset:3072 sc1
s_cmp_eq_u32 s24, 0
s_cselect_b32 s31, s31, 960
M a[120:123], a[188:191], a[244:247], a[120:123]
ds_read_b64_tr_b16 a[212:213], v15 offset:40960
ds_read_b64_tr_b16 a[214:215], v15 offset:42496
M a[120:123], a[184:187], a[240:243], a[120:123]
s_mov_b32 s60, 0
s_add_u32 s12, s4, 16777216
s_addc_u32 s13, s5, 0
M a[124:127], a[192:195], a[240:243], a[124:127]
M a[124:127], a[196:199], a[244:247], a[124:127]
s_waitcnt lgkmcnt(10)
M a[128:131], a[180:183], a[252:255], a[128:131]
ds_read_b128 a[240:243], v10 offset:34816
ds_read_b128 a[244:247], v11 offset:34816
s_mov_b32 s14, 33554432
s_mov_b32 s15, 0x00020000
M a[128:131], a[176:179], a[248:251], a[128:131]
M a[132:135], a[184:187], a[248:251], a[132:135]
ds_read_b64_tr_b16 a[220:221], v16 offset:40960
ds_read_b64_tr_b16 a[222:223], v16 offset:42496
s_mov_b32 s8, s4
s_mov_b32 s9, s5
M a[132:135], a[188:191], a[252:255], a[132:135]
buffer_load_dword v126, v119, s[36:39], 0 offen offset:128 sc1
M a[136:139], a[196:199], a[252:255], a[136:139]
M a[136:139], a[192:195], a[248:251], a[136:139]
s_waitcnt lgkmcnt(10)
s_mov_b32 s10, 16777216
s_mov_b32 s11, 0x00020000
M a[140:143], a[176:179], a[224:227], a[140:143]
M a[140:143], a[180:183], a[228:231], a[140:143]
M a[144:147], a[188:191], a[228:231], a[144:147]
M a[144:147], a[184:187], a[224:227], a[144:147]
M a[148:151], a[192:195], a[224:227], a[148:151]
s_waitcnt vmcnt(17) lgkmcnt(0)
s_barrier
ds_read_b128 a[248:251], v12 offset:0
ds_read_b128 a[252:255], v13 offset:0
s_waitcnt vmcnt(0)
v_cmp_gt_u32 vcc, 0x80, v126
s_nop 0
s_cbranch_vccnz Lk1_spin
Lk1_got:
M a[148:151], a[196:199], a[228:231], a[148:151]
s_add_u32 m0, s29, 65536
s_add_u32 s32, s25, 4096
buffer_load_dwordx4 v1, s[12:15], s25 offen offset:0 sc1 lds
M a[152:155], a[180:183], a[236:239], a[152:155]
ds_read_b128 a[224:227], v12 offset:2048
ds_read_b128 a[228:231], v13 offset:2048
M a[152:155], a[176:179], a[232:235], a[152:155]
buffer_load_dwordx4 v1, s[12:15], s25 offen offset:1024 sc1 lds
M a[156:159], a[184:187], a[232:235], a[156:159]
M a[156:159], a[188:191], a[236:239], a[156:159]
buffer_load_dwordx4 v1, s[12:15], s25 offen offset:2048 sc1 lds
M a[160:163], a[196:199], a[236:239], a[160:163]
buffer_load_dwordx4 v1, s[12:15], s25 offen offset:3072 sc1 lds
M a[160:163], a[192:195], a[232:235], a[160:163]
M a[164:167], a[176:179], a[240:243], a[164:167]
ds_read_b128 a[232:235], v12 offset:4096
ds_read_b128 a[236:239], v13 offset:4096
M a[164:167], a[180:183], a[244:247], a[164:167]
s_add_u32 m0, s29, 69632
s_nop 0
buffer_load_dwordx4 v1, s[12:15], s32 offen offset:0 sc1 lds
M a[168:171], a[188:191], a[244:247], a[168:171]
buffer_load_dwordx4 v1, s[12:15], s32 offen offset:1024 sc1 lds
M a[168:171], a[184:187], a[240:243], a[168:171]
M a[172:175], a[192:195], a[240:243], a[172:175]
buffer_load_dwordx4 v1, s[12:15], s32 offen offset:2048 sc1 lds
M a[172:175], a[196:199], a[244:247], a[172:175]
s_waitcnt lgkmcnt(4)
M a[68:71], a[200:203], a[248:251], a[68:71]
ds_read_b128 a[240:243], v12 offset:6144
ds_read_b128 a[244:247], v13 offset:6144
M a[68:71], a[204:207], a[252:255], a[68:71]
buffer_load_dwordx4 v1, s[12:15], s32 offen offset:3072 sc1 lds
M a[72:75], a[212:215], a[252:255], a[72:75]
M a[72:75], a[208:211], a[248:251], a[72:75]
M a[76:79], a[216:219], a[248:251], a[76:79]
M a[76:79], a[220:223], a[252:255], a[76:79]
s_waitcnt lgkmcnt(4)
M a[80:83], a[204:207], a[228:231], a[80:83]
ds_read_b128 a[248:251], v12 offset:8192
ds_read_b128 a[252:255], v13 offset:8192
M a[80:83], a[200:203], a[224:227], a[80:83]
M a[84:87], a[208:211], a[224:227], a[84:87]
M a[84:87], a[212:215], a[228:231], a[84:87]
M a[88:91], a[220:223], a[228:231], a[88:91]
M a[88:91], a[216:219], a[224:227], a[88:91]
s_waitcnt lgkmcnt(4)
M a[92:95], a[200:203], a[232:235], a[92:95]
ds_read_b128 a[224:227], v12 offset:10240
ds_read_b128 a[228:231], v13 offset:10240
v_accvgpr_read_b32 v24, a68
v_accvgpr_read_b32 v25, a69
v_accvgpr_read_b32 v26, a70
M a[92:95], a[204:207], a[236:239], a[92:95]
v_accvgpr_read_b32 v27, a71
v_cvt_pk_bf16_f32 v24, v24, v25
v_cvt_pk_bf16_f32 v25, v26, v27
ds_write_b64 v124, v[24:25] offset:0
M a[96:99], a[212:215], a[236:239], a[96:99]
v_accvgpr_read_b32 v28, a72
v_accvgpr_read_b32 v29, a73
v_accvgpr_read_b32 v30, a74
M a[96:99], a[208:211], a[232:235], a[96:99]
v_accvgpr_read_b32 v31, a75
v_cvt_pk_bf16_f32 v28, v28, v29
v_cvt_pk_bf16_f32 v29, v30, v31
ds_write_b64 v124, v[28:29] offset:32
M a[100:103], a[216:219], a[232:235], a[100:103]
v_accvgpr_read_b32 v24, a76
v_accvgpr_read_b32 v25, a77
v_accvgpr_read_b32 v26, a78
M a[100:103], a[220:223], a[236:239], a[100:103]
s_waitcnt lgkmcnt(6)
v_accvgpr_read_b32 v27, a79
v_cvt_pk_bf16_f32 v24, v24, v25
v_cvt_pk_bf16_f32 v25, v26, v27
ds_write_b64 v124, v[24:25] offset:64
M a[104:107], a[204:207], a[244:247], a[104:107]
ds_read_b128 a[232:235], v12 offset:12288
ds_read_b128 a[236:239], v13 offset:12288
v_accvgpr_read_b32 v24, a80
v_accvgpr_read_b32 v25, a81
v_accvgpr_read_b32 v26, a82
M a[104:107], a[200:203], a[240:243], a[104:107]
v_accvgpr_read_b32 v27, a83
v_cvt_pk_bf16_f32 v24, v24, v25
v_cvt_pk_bf16_f32 v25, v26, v27
ds_write_b64 v124, v[24:25] offset:6400
M a[108:111], a[208:211], a[240:243], a[108:111]
v_accvgpr_read_b32 v28, a84
v_accvgpr_read_b32 v29, a85
v_accvgpr_read_b32 v30, a86
M a[108:111], a[212:215], a[244:247], a[108:111]
v_accvgpr_read_b32 v31, a87
v_cvt_pk_bf16_f32 v28, v28, v29
v_cvt_pk_bf16_f32 v29, v30, v31
ds_write_b64 v124, v[28:29] offset:6432
M a[112:115], a[220:223], a[244:247], a[112:115]
v_accvgpr_read_b32 v24, a88
v_accvgpr_read_b32 v25, a89
v_accvgpr_read_b32 v26, a90
M a[112:115], a[216:219], a[240:243], a[112:115]
s_waitcnt lgkmcnt(9)
v_accvgpr_read_b32 v27, a91
v_cvt_pk_bf16_f32 v24, v24, v25
v_cvt_pk_bf16_f32 v25, v26, v27
ds_write_b64 v124, v[24:25] offset:6464
M a[116:119], a[200:203], a[248:251], a[116:119]
ds_read_b128 a[240:243], v12 offset:14336
ds_read_b128 a[244:247], v13 offset:14336
v_accvgpr_read_b32 v24, a92
v_accvgpr_read_b32 v25, a93
v_accvgpr_read_b32 v26, a94
M a[116:119], a[204:207], a[252:255], a[116:119]
v_accvgpr_read_b32 v27, a95
v_cvt_pk_bf16_f32 v24, v24, v25
v_cvt_pk_bf16_f32 v25, v26, v27
ds_write_b64 v124, v[24:25] offset:12800
M a[120:123], a[212:215], a[252:255], a[120:123]
v_accvgpr_read_b32 v28, a96
v_accvgpr_read_b32 v29, a97
v_accvgpr_read_b32 v30, a98
M a[120:123], a[208:211], a[248:251], a[120:123]
v_accvgpr_read_b32 v31, a99
v_cvt_pk_bf16_f32 v28, v28, v29
v_cvt_pk_bf16_f32 v29, v30, v31
ds_write_b64 v124, v[28:29] offset:12832
M a[124:127], a[216:219], a[248:251], a[124:127]
v_accvgpr_read_b32 v24, a100
v_accvgpr_read_b32 v25, a101
v_accvgpr_read_b32 v26, a102
M a[124:127], a[220:223], a[252:255], a[124:127]
s_add_u32 s25, s25, 32768
s_cmp_eq_u32 s25, s27
s_cselect_b32 s25, s28, s25
s_cselect_b32 s27, -1, s27
s_waitcnt lgkmcnt(12)
v_accvgpr_read_b32 v27, a103
v_cvt_pk_bf16_f32 v24, v24, v25
v_cvt_pk_bf16_f32 v25, v26, v27
ds_write_b64 v124, v[24:25] offset:12864
M a[128:131], a[204:207], a[228:231], a[128:131]
ds_read_b128 a[248:251], v12 offset:16384
ds_read_b128 a[252:255], v13 offset:16384
v_accvgpr_read_b32 v24, a104
v_accvgpr_read_b32 v25, a105
v_accvgpr_read_b32 v26, a106
M a[128:131], a[200:203], a[224:227], a[128:131]
v_accvgpr_read_b32 v27, a107
v_cvt_pk_bf16_f32 v24, v24, v25
v_cvt_pk_bf16_f32 v25, v26, v27
ds_write_b64 v124, v[24:25] offset:19200
M a[132:135], a[208:211], a[224:227], a[132:135]
v_accvgpr_read_b32 v28, a108
v_accvgpr_read_b32 v29, a109
v_accvgpr_read_b32 v30, a110
M a[132:135], a[212:215], a[228:231], a[132:135]
v_accvgpr_read_b32 v31, a111
v_cvt_pk_bf16_f32 v28, v28, v29
v_cvt_pk_bf16_f32 v29, v30, v31
ds_write_b64 v124, v[28:29] offset:19232
M a[136:139], a[220:223], a[228:231], a[136:139]
v_accvgpr_read_b32 v24, a112
v_accvgpr_read_b32 v25, a113
v_accvgpr_read_b32 v26, a114
M a[136:139], a[216:219], a[224:227], a[136:139]
s_waitcnt lgkmcnt(12)
v_accvgpr_read_b32 v27, a115
v_cvt_pk_bf16_f32 v24, v24, v25
v_cvt_pk_bf16_f32 v25, v26, v27
ds_write_b64 v124, v[24:25] offset:19264
M a[140:143], a[200:203], a[232:235], a[140:143]
v_accvgpr_read_b32 v24, a116
v_accvgpr_read_b32 v25, a117
v_accvgpr_read_b32 v26, a118
M a[140:143], a[204:207], a[236:239], a[140:143]
v_accvgpr_read_b32 v27, a119
v_cvt_pk_bf16_f32 v24, v24, v25
v_cvt_pk_bf16_f32 v25, v26, v27
ds_write_b64 v124, v[24:25] offset:25600
M a[144:147], a[212:215], a[236:239], a[144:147]
v_accvgpr_read_b32 v28, a120
v_accvgpr_read_b32 v29, a121
v_accvgpr_read_b32 v30, a122
M a[144:147], a[208:211], a[232:235], a[144:147]
v_accvgpr_read_b32 v31, a123
v_cvt_pk_bf16_f32 v28, v28, v29
v_cvt_pk_bf16_f32 v29, v30, v31
ds_write_b64 v124, v[28:29] offset:25632
M a[148:151], a[216:219], a[232:235], a[148:151]
s_waitcnt lgkmcnt(0)
s_barrier
v_accvgpr_read_b32 v24, a124
v_accvgpr_read_b32 v25, a125
v_accvgpr_read_b32 v26, a126
M a[148:151], a[220:223], a[236:239], a[148:151]
v_accvgpr_read_b32 v27, a127
v_cvt_pk_bf16_f32 v24, v24, v25
v_cvt_pk_bf16_f32 v25, v26, v27
ds_write_b64 v124, v[24:25] offset:25664
v_accvgpr_read_b32 v24, a128
v_accvgpr_read_b32 v25, a129
v_accvgpr_read_b32 v26, a130
M a[152:155], a[204:207], a[244:247], a[152:155]
v_accvgpr_read_b32 v27, a131
v_cvt_pk_bf16_f32 v24, v24, v25
v_cvt_pk_bf16_f32 v25, v26, v27
M a[152:155], a[200:203], a[240:243], a[152:155]
ds_write_b64 v124, v[24:25] offset:32000
v_accvgpr_read_b32 v28, a132
v_accvgpr_read_b32 v29, a133
M a[156:159], a[208:211], a[240:243], a[156:159]
v_accvgpr_read_b32 v30, a134
v_accvgpr_read_b32 v31, a135
v_cvt_pk_bf16_f32 v28, v28, v29
M a[156:159], a[212:215], a[244:247], a[156:159]
v_cvt_pk_bf16_f32 v29, v30, v31
ds_write_b64 v124, v[28:29] offset:32032
v_accvgpr_read_b32 v24, a136
M a[160:163], a[220:223], a[244:247], a[160:163]
v_accvgpr_read_b32 v25, a137
v_accvgpr_read_b32 v26, a138
v_accvgpr_read_b32 v27, a139
M a[160:163], a[216:219], a[240:243], a[160:163]
v_cvt_pk_bf16_f32 v24, v24, v25
v_cvt_pk_bf16_f32 v25, v26, v27
ds_write_b64 v124, v[24:25] offset:32064
M a[164:167], a[200:203], a[248:251], a[164:167]
v_accvgpr_read_b32 v24, a140
v_accvgpr_read_b32 v25, a141
v_accvgpr_read_b32 v26, a142
M a[164:167], a[204:207], a[252:255], a[164:167]
v_accvgpr_read_b32 v27, a143
v_cvt_pk_bf16_f32 v24, v24, v25
v_cvt_pk_bf16_f32 v25, v26, v27
ds_write_b64 v124, v[24:25] offset:38400
M a[168:171], a[212:215], a[252:255], a[168:171]
v_accvgpr_read_b32 v28, a144
v_accvgpr_read_b32 v29, a145
v_accvgpr_read_b32 v30, a146
M a[168:171], a[208:211], a[248:251], a[168:171]
v_accvgpr_read_b32 v31, a147
v_cvt_pk_bf16_f32 v28, v28, v29
v_cvt_pk_bf16_f32 v29, v30, v31
ds_write_b64 v124, v[28:29] offset:38432
M a[172:175], a[216:219], a[248:251], a[172:175]
v_accvgpr_read_b32 v24, a148
v_accvgpr_read_b32 v25, a149
v_accvgpr_read_b32 v26, a150
M a[172:175], a[220:223], a[252:255], a[172:175]
v_accvgpr_read_b32 v27, a151
v_cvt_pk_bf16_f32 v24, v24, v25
v_cvt_pk_bf16_f32 v25, v26, v27
ds_write_b64 v124, v[24:25] offset:38464
s_mov_b64 s[44:45], s[42:43]
v_accvgpr_read_b32 v24, a152
v_accvgpr_read_b32 v25, a153
v_accvgpr_read_b32 v26, a154
v_accvgpr_read_b32 v27, a155
v_cvt_pk_bf16_f32 v24, v24, v25
v_cvt_pk_bf16_f32 v25, v26, v27
ds_write_b64 v124, v[24:25] offset:44800
v_accvgpr_read_b32 v28, a156
v_accvgpr_read_b32 v29, a157
v_accvgpr_read_b32 v30, a158
v_accvgpr_read_b32 v31, a159
v_cvt_pk_bf16_f32 v28, v28, v29
v_cvt_pk_bf16_f32 v29, v30, v31
ds_write_b64 v124, v[28:29] offset:44832
v_accvgpr_read_b32 v24, a160
v_accvgpr_read_b32 v25, a161
v_accvgpr_read_b32 v26, a162
v_accvgpr_read_b32 v27, a163
v_cvt_pk_bf16_f32 v24, v24, v25
v_cvt_pk_bf16_f32 v25, v26, v27
ds_write_b64 v124, v[24:25] offset:44864
v_accvgpr_read_b32 v24, a164
v_accvgpr_read_b32 v25, a165
v_accvgpr_read_b32 v26, a166
v_accvgpr_read_b32 v27, a167
v_cvt_pk_bf16_f32 v24, v24, v25
v_cvt_pk_bf16_f32 v25, v26, v27
ds_write_b64 v124, v[24:25] offset:51200
v_accvgpr_read_b32 v28, a168
v_accvgpr_read_b32 v29, a169
v_accvgpr_read_b32 v30, a170
v_accvgpr_read_b32 v31, a171
v_cvt_pk_bf16_f32 v28, v28, v29
v_cvt_pk_bf16_f32 v29, v30, v31
ds_write_b64 v124, v[28:29] offset:51232
v_accvgpr_read_b32 v24, a172
v_accvgpr_read_b32 v25, a173
v_accvgpr_read_b32 v26, a174
v_accvgpr_read_b32 v27, a175
v_cvt_pk_bf16_f32 v24, v24, v25
v_cvt_pk_bf16_f32 v25, v26, v27
ds_write_b64 v124, v[24:25] offset:51264
s_waitcnt lgkmcnt(0)
s_barrier
ds_read_b128 v[48:51], v121 offset:128
ds_read_b128 v[32:35], v120 offset:0
ds_read_b128 v[52:55], v120 offset:128
ds_read_b128 v[36:39], v120 offset:12800
ds_read_b128 v[56:59], v120 offset:12928
ds_read_b128 v[40:43], v120 offset:25600
ds_read_b128 v[60:63], v120 offset:25728
ds_read_b128 v[44:47], v120 offset:38400
ds_read_b128 v[64:67], v120 offset:38528
ds_read_b64_tr_b16 v[68:69], v123 offset:256
ds_read_b64_tr_b16 v[70:71], v122 offset:256
ds_read_b64_tr_b16 v[72:73], v122 offset:13056
ds_read_b64_tr_b16 v[74:75], v122 offset:25856
ds_read_b64_tr_b16 v[76:77], v122 offset:38656
ds_read_b64_tr_b16 v[78:79], v123 offset:288
ds_read_b64_tr_b16 v[80:81], v122 offset:288
ds_read_b64_tr_b16 v[82:83], v122 offset:13088
ds_read_b64_tr_b16 v[84:85], v122 offset:25888
ds_read_b64_tr_b16 v[86:87], v122 offset:38688
v_accvgpr_write_b32 a64, 0
v_accvgpr_write_b32 a65, 0
v_accvgpr_write_b32 a66, 0
v_accvgpr_write_b32 a67, 0
v_accvgpr_write_b32 a68, 0
v_accvgpr_write_b32 a69, 0
v_accvgpr_write_b32 a70, 0
v_accvgpr_write_b32 a71, 0
v_accvgpr_write_b32 a72, 0
v_accvgpr_write_b32 a73, 0
v_accvgpr_write_b32 a74, 0
v_accvgpr_write_b32 a75, 0
s_add_u32 m0, s29, 0
s_add_u32 s32, s25, 4096
buffer_load_dwordx4 v1, s[12:15], s25 offen offset:0 sc1 lds
v_accvgpr_write_b32 a76, 0
v_accvgpr_write_b32 a77, 0
v_accvgpr_write_b32 a78, 0
v_accvgpr_write_b32 a79, 0
v_accvgpr_write_b32 a80, 0
v_accvgpr_write_b32 a81, 0
v_accvgpr_write_b32 a82, 0
v_accvgpr_write_b32 a83, 0
v_accvgpr_write_b32 a84, 0
v_accvgpr_write_b32 a85, 0
v_accvgpr_write_b32 a86, 0
buffer_load_dwordx4 v1, s[12:15], s25 offen offset:1024 sc1 lds
v_accvgpr_write_b32 a87, 0
v_accvgpr_write_b32 a88, 0
v_accvgpr_write_b32 a89, 0
v_accvgpr_write_b32 a90, 0
v_accvgpr_write_b32 a91, 0
v_accvgpr_write_b32 a92, 0
v_accvgpr_write_b32 a93, 0
v_accvgpr_write_b32 a94, 0
v_accvgpr_write_b32 a95, 0
v_accvgpr_write_b32 a96, 0
buffer_load_dwordx4 v1, s[12:15], s25 offen offset:2048 sc1 lds
v_accvgpr_write_b32 a97, 0
v_accvgpr_write_b32 a98, 0
v_accvgpr_write_b32 a99, 0
v_accvgpr_write_b32 a100, 0
v_accvgpr_write_b32 a101, 0
v_accvgpr_write_b32 a102, 0
v_accvgpr_write_b32 a103, 0
v_accvgpr_write_b32 a104, 0
v_accvgpr_write_b32 a105, 0
v_accvgpr_write_b32 a106, 0
v_accvgpr_write_b32 a107, 0
buffer_load_dwordx4 v1, s[12:15], s25 offen offset:3072 sc1 lds
v_accvgpr_write_b32 a108, 0
v_accvgpr_write_b32 a109, 0
v_accvgpr_write_b32 a110, 0
v_accvgpr_write_b32 a111, 0
s_waitcnt lgkmcnt(15)
M v[88:91], v[48:51], v[32:35], v[152:155]
M v[92:95], v[52:55], v[32:35], v[148:151]
M v[96:99], v[52:55], v[36:39], v[144:147]
s_waitcnt lgkmcnt(14)
M v[100:103], v[56:59], v[36:39], v[148:151]
s_waitcnt lgkmcnt(13)
M v[104:107], v[56:59], v[40:43], v[144:147]
s_waitcnt lgkmcnt(12)
M v[108:111], v[60:63], v[40:43], v[148:151]
s_add_u32 m0, s29, 4096
s_nop 0
buffer_load_dwordx4 v1, s[12:15], s32 offen offset:0 sc1 lds
s_waitcnt lgkmcnt(11)
M v[112:115], v[60:63], v[44:47], v[144:147]
s_waitcnt lgkmcnt(10)
M v[116:119], v[64:67], v[44:47], v[148:151]
v_max3_f32 v136, v88, v89, v90
v_max3_f32 v136, v136, v91, v92
v_max3_f32 v136, v136, v93, v94
v_max_f32 v136, v136, v95
v_max3_f32 v137, v96, v97, v98
v_max3_f32 v137, v137, v99, v100
v_max3_f32 v137, v137, v101, v102
v_max_f32 v137, v137, v103
v_max3_f32 v138, v104, v105, v106
buffer_load_dwordx4 v1, s[12:15], s32 offen offset:1024 sc1 lds
v_max3_f32 v138, v138, v107, v108
v_max3_f32 v138, v138, v109, v110
v_max_f32 v138, v138, v111
v_max3_f32 v139, v112, v113, v114
v_max3_f32 v139, v139, v115, v116
v_max3_f32 v139, v139, v117, v118
v_max_f32 v139, v139, v119
v_mov_b32 v140, v136
v_mov_b32 v141, v137
v_mov_b32 v142, v138
buffer_load_dwordx4 v1, s[12:15], s32 offen offset:2048 sc1 lds
v_mov_b32 v143, v139
v_permlane16_swap_b32 v136, v140
v_permlane16_swap_b32 v137, v141
v_permlane16_swap_b32 v138, v142
v_permlane16_swap_b32 v139, v143
v_max_f32 v136, v136, v140
v_max_f32 v137, v137, v141
v_max_f32 v138, v138, v142
v_max_f32 v139, v139, v143
v_mov_b32 v140, v136
v_mov_b32 v141, v137
buffer_load_dwordx4 v1, s[12:15], s32 offen offset:3072 sc1 lds
v_mov_b32 v142, v138
v_mov_b32 v143, v139
v_permlane32_swap_b32 v136, v140
v_permlane32_swap_b32 v137, v141
v_permlane32_swap_b32 v138, v142
v_permlane32_swap_b32 v139, v143
v_max_f32 v136, v136, v140
v_max_f32 v137, v137, v141
v_max_f32 v138, v138, v142
v_max_f32 v139, v139, v143
s_add_u32 s25, s25, 32768
s_cmp_eq_u32 s25, s27
s_cselect_b32 s25, s28, s25
s_cselect_b32 s27, -1, s27
v_mul_f32 v136, s7, v136
v_mul_f32 v137, s7, v137
v_mul_f32 v138, s7, v138
v_mul_f32 v139, s7, v139
v_fma_f32 v88, v88, s7, -v136
v_fma_f32 v89, v89, s7, -v136
v_fma_f32 v90, v90, s7, -v136
v_fma_f32 v91, v91, s7, -v136
v_fma_f32 v92, v92, s7, -v136
v_fma_f32 v93, v93, s7, -v136
v_fma_f32 v94, v94, s7, -v136
s_add_u32 m0, s29, 32768
s_add_u32 s32, s26, 4096
buffer_load_dwordx4 v1, s[12:15], s26 offen offset:0 sc1 lds
v_fma_f32 v95, v95, s7, -v136
v_exp_f32 v88, v88
v_exp_f32 v89, v89
v_exp_f32 v90, v90
v_exp_f32 v91, v91
v_exp_f32 v92, v92
v_exp_f32 v93, v93
v_exp_f32 v94, v94
v_exp_f32 v95, v95
v_fma_f32 v96, v96, s7, -v137
v_fma_f32 v97, v97, s7, -v137
buffer_load_dwordx4 v1, s[12:15], s26 offen offset:1024 sc1 lds
v_fma_f32 v98, v98, s7, -v137
v_fma_f32 v99, v99, s7, -v137
v_fma_f32 v100, v100, s7, -v137
v_fma_f32 v101, v101, s7, -v137
v_fma_f32 v102, v102, s7, -v137
v_fma_f32 v103, v103, s7, -v137
v_exp_f32 v96, v96
v_exp_f32 v97, v97
v_exp_f32 v98, v98
v_exp_f32 v99, v99
buffer_load_dwordx4 v1, s[12:15], s26 offen offset:2048 sc1 lds
v_exp_f32 v100, v100
v_exp_f32 v101, v101
v_exp_f32 v102, v102
v_exp_f32 v103, v103
v_fma_f32 v104, v104, s7, -v138
v_fma_f32 v105, v105, s7, -v138
v_fma_f32 v106, v106, s7, -v138
v_fma_f32 v107, v107, s7, -v138
v_fma_f32 v108, v108, s7, -v138
v_fma_f32 v109, v109, s7, -v138
v_fma_f32 v110, v110, s7, -v138
buffer_load_dwordx4 v1, s[12:15], s26 offen offset:3072 sc1 lds
v_fma_f32 v111, v111, s7, -v138
v_exp_f32 v104, v104
v_exp_f32 v105, v105
v_exp_f32 v106, v106
v_exp_f32 v107, v107
v_exp_f32 v108, v108
v_exp_f32 v109, v109
v_exp_f32 v110, v110
v_exp_f32 v111, v111
v_fma_f32 v112, v112, s7, -v139
s_add_u32 m0, s29, 36864
s_nop 0
buffer_load_dwordx4 v1, s[12:15], s32 offen offset:0 sc1 lds
v_fma_f32 v113, v113, s7, -v139
v_fma_f32 v114, v114, s7, -v139
v_fma_f32 v115, v115, s7, -v139
v_fma_f32 v116, v116, s7, -v139
v_fma_f32 v117, v117, s7, -v139
v_fma_f32 v118, v118, s7, -v139
v_fma_f32 v119, v119, s7, -v139
v_exp_f32 v112, v112
v_exp_f32 v113, v113
v_exp_f32 v114, v114
v_exp_f32 v115, v115
buffer_load_dwordx4 v1, s[12:15], s32 offen offset:1024 sc1 lds
v_exp_f32 v116, v116
v_exp_f32 v117, v117
v_exp_f32 v118, v118
v_exp_f32 v119, v119
v_cvt_pk_bf16_f32 v88, v88, v89
v_cvt_pk_bf16_f32 v89, v90, v91
v_cvt_pk_bf16_f32 v90, v92, v93
v_cvt_pk_bf16_f32 v91, v94, v95
v_cvt_pk_bf16_f32 v96, v96, v97
v_cvt_pk_bf16_f32 v97, v98, v99
buffer_load_dwordx4 v1, s[12:15], s32 offen offset:2048 sc1 lds
v_cvt_pk_bf16_f32 v98, v100, v101
v_cvt_pk_bf16_f32 v99, v102, v103
v_cvt_pk_bf16_f32 v104, v104, v105
v_cvt_pk_bf16_f32 v105, v106, v107
v_cvt_pk_bf16_f32 v106, v108, v109
v_cvt_pk_bf16_f32 v107, v110, v111
v_cvt_pk_bf16_f32 v112, v112, v113
v_cvt_pk_bf16_f32 v113, v114, v115
v_cvt_pk_bf16_f32 v114, v116, v117
v_cvt_pk_bf16_f32 v115, v118, v119
M v[120:123], v[156:159], v[88:91], 0
buffer_load_dwordx4 v1, s[12:15], s32 offen offset:3072 sc1 lds
s_waitcnt lgkmcnt(8)
M v[32:35], v[68:71], v[88:91], 0
s_waitcnt lgkmcnt(3)
M v[36:39], v[78:81], v[88:91], 0
M v[124:127], v[156:159], v[96:99], 0
M v[40:43], v[70:73], v[96:99], 0
s_waitcnt lgkmcnt(2)
M v[44:47], v[80:83], v[96:99], 0
M v[128:131], v[156:159], v[104:107], 0
M v[48:51], v[72:75], v[104:107], 0
s_waitcnt lgkmcnt(1)
M v[52:55], v[82:85], v[104:107], 0
M v[132:135], v[156:159], v[112:115], 0
M v[56:59], v[74:77], v[112:115], 0
s_add_u32 s26, s26, 32768
s_cmp_eq_u32 s26, s62
s_cselect_b32 s26, s63, s26
s_cselect_b32 s62, -1, s62
s_waitcnt lgkmcnt(0)
M v[60:63], v[84:87], v[112:115], 0
v_rcp_f32 v120, v120
v_rcp_f32 v124, v124
v_rcp_f32 v128, v128
v_rcp_f32 v132, v132
v_pk_mul_f32 v[32:33], v[32:33], v[120:121] op_sel_hi:[1,0]
v_pk_mul_f32 v[34:35], v[34:35], v[120:121] op_sel_hi:[1,0]
v_pk_mul_f32 v[36:37], v[36:37], v[120:121] op_sel_hi:[1,0]
v_pk_mul_f32 v[38:39], v[38:39], v[120:121] op_sel_hi:[1,0]
v_cvt_pk_bf16_f32 v32, v32, v33
v_cvt_pk_bf16_f32 v33, v34, v35
v_cvt_pk_bf16_f32 v34, v36, v37
v_cvt_pk_bf16_f32 v35, v38, v39
s_add_u32 s3, s6, 0
buffer_store_dwordx4 v[32:35], v1, s[16:19], s3 offen sc1
v_pk_mul_f32 v[40:41], v[40:41], v[124:125] op_sel_hi:[1,0]
v_pk_mul_f32 v[42:43], v[42:43], v[124:125] op_sel_hi:[1,0]
v_pk_mul_f32 v[44:45], v[44:45], v[124:125] op_sel_hi:[1,0]
v_pk_mul_f32 v[46:47], v[46:47], v[124:125] op_sel_hi:[1,0]
v_cvt_pk_bf16_f32 v40, v40, v41
v_cvt_pk_bf16_f32 v41, v42, v43
v_cvt_pk_bf16_f32 v42, v44, v45
v_cvt_pk_bf16_f32 v43, v46, v47
s_add_u32 s3, s6, 2048
buffer_store_dwordx4 v[40:43], v1, s[16:19], s3 offen sc1
v_pk_mul_f32 v[48:49], v[48:49], v[128:129] op_sel_hi:[1,0]
v_pk_mul_f32 v[50:51], v[50:51], v[128:129] op_sel_hi:[1,0]
v_pk_mul_f32 v[52:53], v[52:53], v[128:129] op_sel_hi:[1,0]
v_pk_mul_f32 v[54:55], v[54:55], v[128:129] op_sel_hi:[1,0]
v_cvt_pk_bf16_f32 v48, v48, v49
v_cvt_pk_bf16_f32 v49, v50, v51
v_cvt_pk_bf16_f32 v50, v52, v53
v_cvt_pk_bf16_f32 v51, v54, v55
s_add_u32 s3, s6, 4096
buffer_store_dwordx4 v[48:51], v1, s[16:19], s3 offen sc1
v_pk_mul_f32 v[56:57], v[56:57], v[132:133] op_sel_hi:[1,0]
v_pk_mul_f32 v[58:59], v[58:59], v[132:133] op_sel_hi:[1,0]
v_pk_mul_f32 v[60:61], v[60:61], v[132:133] op_sel_hi:[1,0]
v_pk_mul_f32 v[62:63], v[62:63], v[132:133] op_sel_hi:[1,0]
v_cvt_pk_bf16_f32 v56, v56, v57
v_cvt_pk_bf16_f32 v57, v58, v59
v_cvt_pk_bf16_f32 v58, v60, v61
v_cvt_pk_bf16_f32 v59, v62, v63
s_add_u32 s3, s6, 6144
buffer_store_dwordx4 v[56:59], v1, s[16:19], s3 offen sc1
Lc2:
s_add_u32 s16, s4, 67108864
s_addc_u32 s17, s5, 0
s_mov_b32 s18, 16777216
s_mov_b32 s19, 0x00020000
s_add_u32 s52, s4, 100663296
s_addc_u32 s53, s5, 0
s_mov_b32 s54, 8404992
s_mov_b32 s55, 0x00020000
s_mov_b32 s46, 8388608
s_mov_b32 s47, 0x00020000
s_mov_b32 s50, 2097152
s_mov_b32 s51, 0x00020000
s_lshl_b32 s33, s24, 14
v_add_u32 v2, s33, v1
v_add_u32 v3, 0x10000, v2
v_and_b32 v8, 15, v0
v_bfe_u32 v9, v0, 4, 2
v_lshlrev_b32 v9, 2, v9
v_sub_u32 v8, v8, v9
v_mov_b32 v4, 0xf149f2ca
v_cmp_gt_i32 vcc, 0, v8
s_nop 1
v_cndmask_b32 v16, 0, v4, vcc
v_cmp_gt_i32 vcc, 1, v8
s_nop 1
v_cndmask_b32 v17, 0, v4, vcc
v_cmp_gt_i32 vcc, 2, v8
s_nop 1
v_cndmask_b32 v18, 0, v4, vcc
v_cmp_gt_i32 vcc, 3, v8
s_nop 1
v_cndmask_b32 v19, 0, v4, vcc
v_mov_b32 v8, 0x3f803f80
v_accvgpr_write_b32 a112, v8
v_accvgpr_write_b32 a113, v8
v_accvgpr_write_b32 a114, v8
v_accvgpr_write_b32 a115, v8
s_lshl_b32 s33, s23, 6
s_add_i32 s33, s33, s31
s_cmp_gt_i32 s33, 0
s_cselect_b32 s34, 0, 0xf149f2ca
s_cmp_lt_i32 s33, 0
s_cselect_b32 s33, 0xf149f2ca, 0
v_mov_b32 v20, s34
v_mov_b32 v21, s34
v_mov_b32 v22, s34
v_mov_b32 v23, s34
v_mov_b32 v28, s33
v_mov_b32 v29, s33
v_mov_b32 v30, s33
v_mov_b32 v31, s33
v_med3_f32 v24, v16, v20, v28
v_med3_f32 v25, v17, v20, v28
v_med3_f32 v26, v18, v20, v28
v_med3_f32 v27, v19, v20, v28
v_mov_b32 v5, 0
v_mov_b32 v6, 1
s_waitcnt vmcnt(20)
s_barrier
ds_read_b128 a[116:119], v3 offset:0
ds_read_b128 a[120:123], v3 offset:1024
ds_read_b128 a[124:127], v3 offset:2048
ds_read_b128 a[128:131], v3 offset:3072
ds_read_b128 a[132:135], v3 offset:4096
ds_read_b128 a[136:139], v3 offset:5120
ds_read_b128 a[140:143], v3 offset:6144
ds_read_b128 a[144:147], v3 offset:7168
s_waitcnt lgkmcnt(4)
M v[32:35], a[116:119], a[0:3], v[24:27]
M v[32:35], a[120:123], a[4:7], v[32:35]
ds_read_b128 a[148:151], v3 offset:8192
ds_read_b128 a[152:155], v3 offset:9216
M v[32:35], a[124:127], a[8:11], v[32:35]
M v[32:35], a[128:131], a[12:15], v[32:35]
M v[36:39], a[128:131], a[28:31], v[28:31]
M v[36:39], a[124:127], a[24:27], v[36:39]
M v[36:39], a[120:123], a[20:23], v[36:39]
M v[36:39], a[116:119], a[16:19], v[36:39]
M v[40:43], a[116:119], a[32:35], v[28:31]
M v[40:43], a[120:123], a[36:39], v[40:43]
ds_read_b128 a[156:159], v3 offset:10240
ds_read_b128 a[160:163], v3 offset:11264
M v[40:43], a[124:127], a[40:43], v[40:43]
M v[40:43], a[128:131], a[44:47], v[40:43]
M v[44:47], a[128:131], a[60:63], v[28:31]
M v[44:47], a[124:127], a[56:59], v[44:47]
M v[44:47], a[120:123], a[52:55], v[44:47]
M v[44:47], a[116:119], a[48:51], v[44:47]
s_waitcnt lgkmcnt(4)
M v[48:51], a[132:135], a[0:3], v[20:23]
M v[48:51], a[136:139], a[4:7], v[48:51]
ds_read_b128 a[164:167], v3 offset:12288
ds_read_b128 a[168:171], v3 offset:13312
M v[48:51], a[140:143], a[8:11], v[48:51]
M v[48:51], a[144:147], a[12:15], v[48:51]
M v[52:55], a[144:147], a[28:31], v[24:27]
M v[52:55], a[140:143], a[24:27], v[52:55]
M v[52:55], a[136:139], a[20:23], v[52:55]
M v[52:55], a[132:135], a[16:19], v[52:55]
M v[56:59], a[132:135], a[32:35], v[28:31]
M v[56:59], a[136:139], a[36:39], v[56:59]
ds_read_b128 a[172:175], v3 offset:14336
ds_read_b128 a[176:179], v3 offset:15360
M v[56:59], a[140:143], a[40:43], v[56:59]
M v[56:59], a[144:147], a[44:47], v[56:59]
M v[60:63], a[144:147], a[60:63], v[28:31]
M v[60:63], a[140:143], a[56:59], v[60:63]
M v[60:63], a[136:139], a[52:55], v[60:63]
M v[60:63], a[132:135], a[48:51], v[60:63]
s_waitcnt lgkmcnt(4)
M v[64:67], a[148:151], a[0:3], v[20:23]
M v[64:67], a[152:155], a[4:7], v[64:67]
M v[64:67], a[156:159], a[8:11], v[64:67]
M v[64:67], a[160:163], a[12:15], v[64:67]
M v[68:71], a[160:163], a[28:31], v[20:23]
M v[68:71], a[156:159], a[24:27], v[68:71]
M v[68:71], a[152:155], a[20:23], v[68:71]
M v[68:71], a[148:151], a[16:19], v[68:71]
M v[72:75], a[148:151], a[32:35], v[24:27]
M v[72:75], a[152:155], a[36:39], v[72:75]
M v[72:75], a[156:159], a[40:43], v[72:75]
M v[72:75], a[160:163], a[44:47], v[72:75]
M v[76:79], a[160:163], a[60:63], v[28:31]
M v[76:79], a[156:159], a[56:59], v[76:79]
s_waitcnt vmcnt(12) lgkmcnt(0)
s_barrier
ds_read_b128 a[116:119], v2 offset:0
ds_read_b128 a[120:123], v2 offset:1024
ds_read_b128 a[124:127], v2 offset:2048
ds_read_b128 a[128:131], v2 offset:3072
M v[76:79], a[152:155], a[52:55], v[76:79]
M v[76:79], a[148:151], a[48:51], v[76:79]
M v[80:83], a[164:167], a[0:3], v[20:23]
M v[80:83], a[168:171], a[4:7], v[80:83]
ds_read_b128 a[132:135], v2 offset:4096
ds_read_b128 a[136:139], v2 offset:5120
M v[80:83], a[172:175], a[8:11], v[80:83]
M v[80:83], a[176:179], a[12:15], v[80:83]
M v[84:87], a[176:179], a[28:31], v[20:23]
M v[84:87], a[172:175], a[24:27], v[84:87]
M v[84:87], a[168:171], a[20:23], v[84:87]
M v[84:87], a[164:167], a[16:19], v[84:87]
M v[88:91], a[164:167], a[32:35], v[20:23]
M v[88:91], a[168:171], a[36:39], v[88:91]
ds_read_b128 a[140:143], v2 offset:6144
ds_read_b128 a[144:147], v2 offset:7168
M v[88:91], a[172:175], a[40:43], v[88:91]
M v[88:91], a[176:179], a[44:47], v[88:91]
M v[92:95], a[176:179], a[60:63], v[24:27]
M v[92:95], a[172:175], a[56:59], v[92:95]
M v[92:95], a[168:171], a[52:55], v[92:95]
M v[92:95], a[164:167], a[48:51], v[92:95]
s_waitcnt vmcnt(0)
s_mov_b64 exec, 1
buffer_store_dword v6, v5, s[52:55], s65 offen sc1
s_mov_b64 exec, -1
s_add_u32 m0, s29, 65536
s_add_u32 s32, s25, 4096
buffer_load_dwordx4 v1, s[12:15], s25 offen offset:0 sc1 lds
buffer_load_dwordx4 v1, s[12:15], s25 offen offset:1024 sc1 lds
buffer_load_dwordx4 v1, s[12:15], s25 offen offset:2048 sc1 lds
buffer_load_dwordx4 v1, s[12:15], s25 offen offset:3072 sc1 lds
s_add_u32 m0, s29, 69632
s_nop 0
buffer_load_dwordx4 v1, s[12:15], s32 offen offset:0 sc1 lds
buffer_load_dwordx4 v1, s[12:15], s32 offen offset:1024 sc1 lds
buffer_load_dwordx4 v1, s[12:15], s32 offen offset:2048 sc1 lds
buffer_load_dwordx4 v1, s[12:15], s32 offen offset:3072 sc1 lds
s_add_u32 s25, s25, 32768
s_cmp_eq_u32 s25, s27
s_cselect_b32 s25, s28, s25
s_cselect_b32 s27, -1, s27
v_exp_f32 v32, v32
v_exp_f32 v33, v33
v_exp_f32 v34, v34
v_exp_f32 v35, v35
v_exp_f32 v48, v48
v_exp_f32 v49, v49
v_exp_f32 v50, v50
v_exp_f32 v51, v51
v_cvt_pk_bf16_f32 v32, v32, v33
v_cvt_pk_bf16_f32 v33, v34, v35
v_exp_f32 v36, v36
v_exp_f32 v37, v37
v_exp_f32 v38, v38
v_exp_f32 v39, v39
v_cvt_pk_bf16_f32 v34, v48, v49
v_cvt_pk_bf16_f32 v35, v50, v51
v_exp_f32 v52, v52
v_exp_f32 v53, v53
v_exp_f32 v54, v54
v_exp_f32 v55, v55
v_cvt_pk_bf16_f32 v36, v36, v37
v_cvt_pk_bf16_f32 v37, v38, v39
v_exp_f32 v40, v40
v_exp_f32 v41, v41
v_exp_f32 v42, v42
v_exp_f32 v43, v43
v_cvt_pk_bf16_f32 v38, v52, v53
v_cvt_pk_bf16_f32 v39, v54, v55
v_exp_f32 v56, v56
v_exp_f32 v57, v57
v_exp_f32 v58, v58
v_exp_f32 v59, v59
v_cvt_pk_bf16_f32 v40, v40, v41
v_cvt_pk_bf16_f32 v41, v42, v43
v_exp_f32 v44, v44
v_exp_f32 v45, v45
v_exp_f32 v46, v46
v_exp_f32 v47, v47
v_cvt_pk_bf16_f32 v42, v56, v57
v_cvt_pk_bf16_f32 v43, v58, v59
v_exp_f32 v60, v60
v_exp_f32 v61, v61
v_exp_f32 v62, v62
v_exp_f32 v63, v63
v_cvt_pk_bf16_f32 v44, v44, v45
v_cvt_pk_bf16_f32 v45, v46, v47
v_cvt_pk_bf16_f32 v46, v60, v61
v_cvt_pk_bf16_f32 v47, v62, v63
s_cmp_eq_u32 s24, 1
s_cbranch_scc1 Lk2_g1
s_mov_b32 s30, s21
s_cmp_eq_u32 s21, 0
s_cbranch_scc1 Lk2_m2
Lk2_l1:
s_waitcnt lgkmcnt(4)
s_add_u32 m0, s29, 98304
M v[96:99], a[116:119], a[0:3], 0
v_exp_f32 v64, v64
M v[96:99], a[120:123], a[4:7], v[96:99]
ds_read_b128 a[148:151], v2 offset:8192
ds_read_b128 a[152:155], v2 offset:9216
M v[96:99], a[124:127], a[8:11], v[96:99]
v_exp_f32 v65, v65
M v[96:99], a[128:131], a[12:15], v[96:99]
buffer_load_dwordx4 v1, s[12:15], s26 offen offset:0 sc1 lds
s_add_u32 s32, s26, 4096
M v[100:103], a[128:131], a[28:31], 0
v_exp_f32 v66, v66
M v[100:103], a[124:127], a[24:27], v[100:103]
v_cvt_pk_bf16_f32 v64, v64, v65
M v[100:103], a[120:123], a[20:23], v[100:103]
v_exp_f32 v67, v67
M v[100:103], a[116:119], a[16:19], v[100:103]
buffer_load_dwordx4 v1, s[12:15], s26 offen offset:1024 sc1 lds
M v[104:107], a[116:119], a[32:35], 0
v_exp_f32 v80, v80
M v[104:107], a[120:123], a[36:39], v[104:107]
ds_read_b128 a[156:159], v2 offset:10240
ds_read_b128 a[160:163], v2 offset:11264
M v[104:107], a[124:127], a[40:43], v[104:107]
v_exp_f32 v81, v81
M v[104:107], a[128:131], a[44:47], v[104:107]
buffer_load_dwordx4 v1, s[12:15], s26 offen offset:2048 sc1 lds
M v[108:111], a[128:131], a[60:63], 0
v_exp_f32 v82, v82
M v[108:111], a[124:127], a[56:59], v[108:111]
v_cvt_pk_bf16_f32 v65, v66, v67
v_cvt_pk_bf16_f32 v66, v80, v81
M v[108:111], a[120:123], a[52:55], v[108:111]
v_exp_f32 v83, v83
M v[108:111], a[116:119], a[48:51], v[108:111]
buffer_load_dwordx4 v1, s[12:15], s26 offen offset:3072 sc1 lds
s_add_u32 m0, s29, 102400
s_waitcnt lgkmcnt(4)
M v[112:115], a[132:135], a[0:3], 0
v_exp_f32 v68, v68
M v[112:115], a[136:139], a[4:7], v[112:115]
ds_read_b128 a[164:167], v2 offset:12288
ds_read_b128 a[168:171], v2 offset:13312
M v[112:115], a[140:143], a[8:11], v[112:115]
v_exp_f32 v69, v69
M v[112:115], a[144:147], a[12:15], v[112:115]
buffer_load_dwordx4 v1, s[12:15], s32 offen offset:0 sc1 lds
M v[116:119], a[144:147], a[28:31], 0
v_exp_f32 v70, v70
M v[116:119], a[140:143], a[24:27], v[116:119]
v_cvt_pk_bf16_f32 v67, v82, v83
v_cvt_pk_bf16_f32 v68, v68, v69
M v[116:119], a[136:139], a[20:23], v[116:119]
v_exp_f32 v71, v71
M v[116:119], a[132:135], a[16:19], v[116:119]
buffer_load_dwordx4 v1, s[12:15], s32 offen offset:1024 sc1 lds
M v[120:123], a[132:135], a[32:35], 0
v_exp_f32 v84, v84
M v[120:123], a[136:139], a[36:39], v[120:123]
ds_read_b128 a[172:175], v2 offset:14336
ds_read_b128 a[176:179], v2 offset:15360
M v[120:123], a[140:143], a[40:43], v[120:123]
v_exp_f32 v85, v85
M v[120:123], a[144:147], a[44:47], v[120:123]
buffer_load_dwordx4 v1, s[12:15], s32 offen offset:2048 sc1 lds
M v[124:127], a[144:147], a[60:63], 0
v_exp_f32 v86, v86
M v[124:127], a[140:143], a[56:59], v[124:127]
v_cvt_pk_bf16_f32 v69, v70, v71
v_cvt_pk_bf16_f32 v70, v84, v85
M v[124:127], a[136:139], a[52:55], v[124:127]
v_exp_f32 v87, v87
M v[124:127], a[132:135], a[48:51], v[124:127]
buffer_load_dwordx4 v1, s[12:15], s32 offen offset:3072 sc1 lds
s_waitcnt lgkmcnt(4)
M v[128:131], a[148:151], a[0:3], 0
v_exp_f32 v72, v72
M v[128:131], a[152:155], a[4:7], v[128:131]
s_add_u32 s26, s26, 32768
s_cmp_eq_u32 s26, s62
s_cselect_b32 s26, s63, s26
s_cselect_b32 s62, -1, s62
M v[128:131], a[156:159], a[8:11], v[128:131]
v_exp_f32 v73, v73
M v[128:131], a[160:163], a[12:15], v[128:131]
v_cvt_pk_bf16_f32 v71, v86, v87
v_cvt_pk_bf16_f32 v72, v72, v73
M v[132:135], a[160:163], a[28:31], 0
v_exp_f32 v74, v74
M v[132:135], a[156:159], a[24:27], v[132:135]
M v[132:135], a[152:155], a[20:23], v[132:135]
v_exp_f32 v75, v75
M v[132:135], a[148:151], a[16:19], v[132:135]
v_cvt_pk_bf16_f32 v73, v74, v75
M v[136:139], a[148:151], a[32:35], 0
v_exp_f32 v88, v88
M v[136:139], a[152:155], a[36:39], v[136:139]
M v[136:139], a[156:159], a[40:43], v[136:139]
v_exp_f32 v89, v89
M v[136:139], a[160:163], a[44:47], v[136:139]
v_cvt_pk_bf16_f32 v74, v88, v89
M v[140:143], a[160:163], a[60:63], 0
v_exp_f32 v90, v90
M v[140:143], a[156:159], a[56:59], v[140:143]
s_waitcnt vmcnt(16) lgkmcnt(0)
s_barrier
ds_read_b128 a[116:119], v2 offset:32768
ds_read_b128 a[120:123], v2 offset:40960
ds_read_b128 a[124:127], v2 offset:33792
ds_read_b128 a[128:131], v2 offset:41984
M v[140:143], a[152:155], a[52:55], v[140:143]
v_exp_f32 v91, v91
M v[140:143], a[148:151], a[48:51], v[140:143]
v_cvt_pk_bf16_f32 v75, v90, v91
M v[144:147], a[164:167], a[0:3], 0
v_exp_f32 v76, v76
M v[144:147], a[168:171], a[4:7], v[144:147]
ds_read_b128 a[132:135], v2 offset:34816
ds_read_b128 a[136:139], v2 offset:43008
M v[144:147], a[172:175], a[8:11], v[144:147]
v_exp_f32 v77, v77
M v[144:147], a[176:179], a[12:15], v[144:147]
v_cvt_pk_bf16_f32 v76, v76, v77
M v[148:151], a[176:179], a[28:31], 0
v_exp_f32 v78, v78
M v[148:151], a[172:175], a[24:27], v[148:151]
M v[148:151], a[168:171], a[20:23], v[148:151]
v_exp_f32 v79, v79
M v[148:151], a[164:167], a[16:19], v[148:151]
v_cvt_pk_bf16_f32 v77, v78, v79
M v[152:155], a[164:167], a[32:35], 0
v_exp_f32 v92, v92
M v[152:155], a[168:171], a[36:39], v[152:155]
ds_read_b128 a[140:143], v2 offset:35840
ds_read_b128 a[144:147], v2 offset:44032
M v[152:155], a[172:175], a[40:43], v[152:155]
v_exp_f32 v93, v93
M v[152:155], a[176:179], a[44:47], v[152:155]
v_cvt_pk_bf16_f32 v78, v92, v93
M v[156:159], a[176:179], a[60:63], 0
v_exp_f32 v94, v94
M v[156:159], a[172:175], a[56:59], v[156:159]
M v[156:159], a[168:171], a[52:55], v[156:159]
v_exp_f32 v95, v95
M v[156:159], a[164:167], a[48:51], v[156:159]
v_cvt_pk_bf16_f32 v79, v94, v95
s_waitcnt lgkmcnt(6)
s_add_u32 m0, s29, 0
M v[160:163], a[116:119], v[32:35], v[160:163]
v_exp_f32 v96, v96
M v[160:163], a[120:123], v[64:67], v[160:163]
ds_read_b128 a[148:151], v2 offset:36864
ds_read_b128 a[152:155], v2 offset:45056
M v[164:167], a[120:123], v[68:71], v[164:167]
v_exp_f32 v97, v97
M v[164:167], a[116:119], v[36:39], v[164:167]
buffer_load_dwordx4 v1, s[12:15], s25 offen offset:0 sc1 lds
s_add_u32 s32, s25, 4096
M v[168:171], a[116:119], v[40:43], v[168:171]
v_exp_f32 v98, v98
M v[168:171], a[120:123], v[72:75], v[168:171]
v_cvt_pk_bf16_f32 v96, v96, v97
M v[172:175], a[120:123], v[76:79], v[172:175]
v_exp_f32 v99, v99
M v[172:175], a[116:119], v[44:47], v[172:175]
buffer_load_dwordx4 v1, s[12:15], s25 offen offset:1024 sc1 lds
s_waitcnt lgkmcnt(6)
M a[96:99], a[112:115], v[32:35], a[96:99]
M a[96:99], a[112:115], v[64:67], a[96:99]
M v[176:179], a[124:127], v[32:35], v[176:179]
v_exp_f32 v112, v112
M v[176:179], a[128:131], v[64:67], v[176:179]
ds_read_b128 a[156:159], v2 offset:37888
ds_read_b128 a[160:163], v2 offset:46080
M v[180:183], a[128:131], v[68:71], v[180:183]
v_exp_f32 v113, v113
M v[180:183], a[124:127], v[36:39], v[180:183]
buffer_load_dwordx4 v1, s[12:15], s25 offen offset:2048 sc1 lds
M v[184:187], a[124:127], v[40:43], v[184:187]
v_exp_f32 v114, v114
M v[184:187], a[128:131], v[72:75], v[184:187]
v_cvt_pk_bf16_f32 v97, v98, v99
v_cvt_pk_bf16_f32 v98, v112, v113
M v[188:191], a[128:131], v[76:79], v[188:191]
v_exp_f32 v115, v115
M v[188:191], a[124:127], v[44:47], v[188:191]
buffer_load_dwordx4 v1, s[12:15], s25 offen offset:3072 sc1 lds
s_add_u32 m0, s29, 4096
s_waitcnt lgkmcnt(6)
M a[100:103], a[112:115], v[36:39], a[100:103]
M a[100:103], a[112:115], v[68:71], a[100:103]
M v[192:195], a[132:135], v[32:35], v[192:195]
v_exp_f32 v100, v100
M v[192:195], a[136:139], v[64:67], v[192:195]
ds_read_b128 a[164:167], v2 offset:38912
ds_read_b128 a[168:171], v2 offset:47104
M v[196:199], a[136:139], v[68:71], v[196:199]
v_exp_f32 v101, v101
M v[196:199], a[132:135], v[36:39], v[196:199]
buffer_load_dwordx4 v1, s[12:15], s32 offen offset:0 sc1 lds
M v[200:203], a[132:135], v[40:43], v[200:203]
v_exp_f32 v102, v102
M v[200:203], a[136:139], v[72:75], v[200:203]
v_cvt_pk_bf16_f32 v99, v114, v115
v_cvt_pk_bf16_f32 v100, v100, v101
M v[204:207], a[136:139], v[76:79], v[204:207]
v_exp_f32 v103, v103
M v[204:207], a[132:135], v[44:47], v[204:207]
buffer_load_dwordx4 v1, s[12:15], s32 offen offset:1024 sc1 lds
s_waitcnt lgkmcnt(6)
M a[104:107], a[112:115], v[40:43], a[104:107]
M a[104:107], a[112:115], v[72:75], a[104:107]
M v[208:211], a[140:143], v[32:35], v[208:211]
v_exp_f32 v116, v116
M v[208:211], a[144:147], v[64:67], v[208:211]
ds_read_b128 a[172:175], v2 offset:39936
ds_read_b128 a[176:179], v2 offset:48128
M v[212:215], a[144:147], v[68:71], v[212:215]
v_exp_f32 v117, v117
M v[212:215], a[140:143], v[36:39], v[212:215]
buffer_load_dwordx4 v1, s[12:15], s32 offen offset:2048 sc1 lds
M v[216:219], a[140:143], v[40:43], v[216:219]
v_exp_f32 v118, v118
M v[216:219], a[144:147], v[72:75], v[216:219]
v_cvt_pk_bf16_f32 v101, v102, v103
v_cvt_pk_bf16_f32 v102, v116, v117
M v[220:223], a[144:147], v[76:79], v[220:223]
v_exp_f32 v119, v119
M v[220:223], a[140:143], v[44:47], v[220:223]
buffer_load_dwordx4 v1, s[12:15], s32 offen offset:3072 sc1 lds
s_waitcnt lgkmcnt(6)
M a[108:111], a[112:115], v[44:47], a[108:111]
M a[108:111], a[112:115], v[76:79], a[108:111]
M v[224:227], a[148:151], v[32:35], v[224:227]
v_exp_f32 v104, v104
M v[224:227], a[152:155], v[64:67], v[224:227]
s_add_u32 s25, s25, 32768
s_cmp_eq_u32 s25, s27
s_cselect_b32 s25, s28, s25
s_cselect_b32 s27, -1, s27
M v[228:231], a[152:155], v[68:71], v[228:231]
v_exp_f32 v105, v105
M v[228:231], a[148:151], v[36:39], v[228:231]
v_cvt_pk_bf16_f32 v103, v118, v119
v_cvt_pk_bf16_f32 v104, v104, v105
M v[232:235], a[148:151], v[40:43], v[232:235]
v_exp_f32 v106, v106
M v[232:235], a[152:155], v[72:75], v[232:235]
M v[236:239], a[152:155], v[76:79], v[236:239]
v_exp_f32 v107, v107
M v[236:239], a[148:151], v[44:47], v[236:239]
v_cvt_pk_bf16_f32 v105, v106, v107
s_waitcnt lgkmcnt(4)
M v[240:243], a[156:159], v[32:35], v[240:243]
v_exp_f32 v120, v120
M v[240:243], a[160:163], v[64:67], v[240:243]
M v[244:247], a[160:163], v[68:71], v[244:247]
v_exp_f32 v121, v121
M v[244:247], a[156:159], v[36:39], v[244:247]
v_cvt_pk_bf16_f32 v106, v120, v121
M v[248:251], a[156:159], v[40:43], v[248:251]
v_exp_f32 v122, v122
M v[248:251], a[160:163], v[72:75], v[248:251]
s_waitcnt vmcnt(16) lgkmcnt(0)
s_barrier
ds_read_b128 a[116:119], v3 offset:0
ds_read_b128 a[120:123], v3 offset:1024
ds_read_b128 a[124:127], v3 offset:2048
ds_read_b128 a[128:131], v3 offset:3072
M v[252:255], a[160:163], v[76:79], v[252:255]
v_exp_f32 v123, v123
M v[252:255], a[156:159], v[44:47], v[252:255]
v_cvt_pk_bf16_f32 v107, v122, v123
M a[64:67], a[164:167], v[32:35], a[64:67]
v_exp_f32 v108, v108
M a[64:67], a[168:171], v[64:67], a[64:67]
ds_read_b128 a[132:135], v3 offset:4096
ds_read_b128 a[136:139], v3 offset:5120
M a[68:71], a[168:171], v[68:71], a[68:71]
v_exp_f32 v109, v109
M a[68:71], a[164:167], v[36:39], a[68:71]
v_cvt_pk_bf16_f32 v108, v108, v109
M a[72:75], a[164:167], v[40:43], a[72:75]
v_exp_f32 v110, v110
M a[72:75], a[168:171], v[72:75], a[72:75]
M a[76:79], a[168:171], v[76:79], a[76:79]
v_exp_f32 v111, v111
M a[76:79], a[164:167], v[44:47], a[76:79]
v_cvt_pk_bf16_f32 v109, v110, v111
M a[80:83], a[172:175], v[32:35], a[80:83]
v_exp_f32 v124, v124
M a[80:83], a[176:179], v[64:67], a[80:83]
ds_read_b128 a[140:143], v3 offset:6144
ds_read_b128 a[144:147], v3 offset:7168
M a[84:87], a[176:179], v[68:71], a[84:87]
v_exp_f32 v125, v125
M a[84:87], a[172:175], v[36:39], a[84:87]
v_cvt_pk_bf16_f32 v110, v124, v125
M a[88:91], a[172:175], v[40:43], a[88:91]
v_exp_f32 v126, v126
M a[88:91], a[176:179], v[72:75], a[88:91]
M a[92:95], a[176:179], v[76:79], a[92:95]
v_exp_f32 v127, v127
M a[92:95], a[172:175], v[44:47], a[92:95]
v_cvt_pk_bf16_f32 v111, v126, v127
s_sub_u32 s30, s30, 1
s_cmp_eq_u32 s30, 0
s_cbranch_scc1 Lk2_m1
s_waitcnt lgkmcnt(4)
s_add_u32 m0, s29, 32768
M v[32:35], a[116:119], a[0:3], 0
v_exp_f32 v128, v128
M v[32:35], a[120:123], a[4:7], v[32:35]
ds_read_b128 a[148:151], v3 offset:8192
ds_read_b128 a[152:155], v3 offset:9216
M v[32:35], a[124:127], a[8:11], v[32:35]
v_exp_f32 v129, v129
M v[32:35], a[128:131], a[12:15], v[32:35]
buffer_load_dwordx4 v1, s[12:15], s26 offen offset:0 sc1 lds
s_add_u32 s32, s26, 4096
M v[36:39], a[128:131], a[28:31], 0
v_exp_f32 v130, v130
M v[36:39], a[124:127], a[24:27], v[36:39]
v_cvt_pk_bf16_f32 v128, v128, v129
M v[36:39], a[120:123], a[20:23], v[36:39]
v_exp_f32 v131, v131
M v[36:39], a[116:119], a[16:19], v[36:39]
buffer_load_dwordx4 v1, s[12:15], s26 offen offset:1024 sc1 lds
M v[40:43], a[116:119], a[32:35], 0
v_exp_f32 v144, v144
M v[40:43], a[120:123], a[36:39], v[40:43]
ds_read_b128 a[156:159], v3 offset:10240
ds_read_b128 a[160:163], v3 offset:11264
M v[40:43], a[124:127], a[40:43], v[40:43]
v_exp_f32 v145, v145
M v[40:43], a[128:131], a[44:47], v[40:43]
buffer_load_dwordx4 v1, s[12:15], s26 offen offset:2048 sc1 lds
M v[44:47], a[128:131], a[60:63], 0
v_exp_f32 v146, v146
M v[44:47], a[124:127], a[56:59], v[44:47]
v_cvt_pk_bf16_f32 v129, v130, v131
v_cvt_pk_bf16_f32 v130, v144, v145
M v[44:47], a[120:123], a[52:55], v[44:47]
v_exp_f32 v147, v147
M v[44:47], a[116:119], a[48:51], v[44:47]
buffer_load_dwordx4 v1, s[12:15], s26 offen offset:3072 sc1 lds
s_add_u32 m0, s29, 36864
s_waitcnt lgkmcnt(4)
M v[48:51], a[132:135], a[0:3], 0
v_exp_f32 v132, v132
M v[48:51], a[136:139], a[4:7], v[48:51]
ds_read_b128 a[164:167], v3 offset:12288
ds_read_b128 a[168:171], v3 offset:13312
M v[48:51], a[140:143], a[8:11], v[48:51]
v_exp_f32 v133, v133
M v[48:51], a[144:147], a[12:15], v[48:51]
buffer_load_dwordx4 v1, s[12:15], s32 offen offset:0 sc1 lds
M v[52:55], a[144:147], a[28:31], 0
v_exp_f32 v134, v134
M v[52:55], a[140:143], a[24:27], v[52:55]
v_cvt_pk_bf16_f32 v131, v146, v147
v_cvt_pk_bf16_f32 v132, v132, v133
M v[52:55], a[136:139], a[20:23], v[52:55]
v_exp_f32 v135, v135
M v[52:55], a[132:135], a[16:19], v[52:55]
buffer_load_dwordx4 v1, s[12:15], s32 offen offset:1024 sc1 lds
M v[56:59], a[132:135], a[32:35], 0
v_exp_f32 v148, v148
M v[56:59], a[136:139], a[36:39], v[56:59]
ds_read_b128 a[172:175], v3 offset:14336
ds_read_b128 a[176:179], v3 offset:15360
M v[56:59], a[140:143], a[40:43], v[56:59]
v_exp_f32 v149, v149
M v[56:59], a[144:147], a[44:47], v[56:59]
buffer_load_dwordx4 v1, s[12:15], s32 offen offset:2048 sc1 lds
M v[60:63], a[144:147], a[60:63], 0
v_exp_f32 v150, v150
M v[60:63], a[140:143], a[56:59], v[60:63]
v_cvt_pk_bf16_f32 v133, v134, v135
v_cvt_pk_bf16_f32 v134, v148, v149
M v[60:63], a[136:139], a[52:55], v[60:63]
v_exp_f32 v151, v151
M v[60:63], a[132:135], a[48:51], v[60:63]
buffer_load_dwordx4 v1, s[12:15], s32 offen offset:3072 sc1 lds
s_waitcnt lgkmcnt(4)
M v[64:67], a[148:151], a[0:3], 0
v_exp_f32 v136, v136
M v[64:67], a[152:155], a[4:7], v[64:67]
s_add_u32 s26, s26, 32768
s_cmp_eq_u32 s26, s62
s_cselect_b32 s26, s63, s26
s_cselect_b32 s62, -1, s62
M v[64:67], a[156:159], a[8:11], v[64:67]
v_exp_f32 v137, v137
M v[64:67], a[160:163], a[12:15], v[64:67]
v_cvt_pk_bf16_f32 v135, v150, v151
v_cvt_pk_bf16_f32 v136, v136, v137
M v[68:71], a[160:163], a[28:31], 0
v_exp_f32 v138, v138
M v[68:71], a[156:159], a[24:27], v[68:71]
M v[68:71], a[152:155], a[20:23], v[68:71]
v_exp_f32 v139, v139
M v[68:71], a[148:151], a[16:19], v[68:71]
v_cvt_pk_bf16_f32 v137, v138, v139
M v[72:75], a[148:151], a[32:35], 0
v_exp_f32 v152, v152
M v[72:75], a[152:155], a[36:39], v[72:75]
M v[72:75], a[156:159], a[40:43], v[72:75]
v_exp_f32 v153, v153
M v[72:75], a[160:163], a[44:47], v[72:75]
v_cvt_pk_bf16_f32 v138, v152, v153
M v[76:79], a[160:163], a[60:63], 0
v_exp_f32 v154, v154
M v[76:79], a[156:159], a[56:59], v[76:79]
s_waitcnt vmcnt(16) lgkmcnt(0)
s_barrier
ds_read_b128 a[116:119], v3 offset:32768
ds_read_b128 a[120:123], v3 offset:40960
ds_read_b128 a[124:127], v3 offset:33792
ds_read_b128 a[128:131], v3 offset:41984
M v[76:79], a[152:155], a[52:55], v[76:79]
v_exp_f32 v155, v155
M v[76:79], a[148:151], a[48:51], v[76:79]
v_cvt_pk_bf16_f32 v139, v154, v155
M v[80:83], a[164:167], a[0:3], 0
v_exp_f32 v140, v140
M v[80:83], a[168:171], a[4:7], v[80:83]
ds_read_b128 a[132:135], v3 offset:34816
ds_read_b128 a[136:139], v3 offset:43008
M v[80:83], a[172:175], a[8:11], v[80:83]
v_exp_f32 v141, v141
M v[80:83], a[176:179], a[12:15], v[80:83]
v_cvt_pk_bf16_f32 v140, v140, v141
M v[84:87], a[176:179], a[28:31], 0
v_exp_f32 v142, v142
M v[84:87], a[172:175], a[24:27], v[84:87]
M v[84:87], a[168:171], a[20:23], v[84:87]
v_exp_f32 v143, v143
M v[84:87], a[164:167], a[16:19], v[84:87]
v_cvt_pk_bf16_f32 v141, v142, v143
M v[88:91], a[164:167], a[32:35], 0
v_exp_f32 v156, v156
M v[88:91], a[168:171], a[36:39], v[88:91]
ds_read_b128 a[140:143], v3 offset:35840
ds_read_b128 a[144:147], v3 offset:44032
M v[88:91], a[172:175], a[40:43], v[88:91]
v_exp_f32 v157, v157
M v[88:91], a[176:179], a[44:47], v[88:91]
v_cvt_pk_bf16_f32 v142, v156, v157
M v[92:95], a[176:179], a[60:63], 0
v_exp_f32 v158, v158
M v[92:95], a[172:175], a[56:59], v[92:95]
M v[92:95], a[168:171], a[52:55], v[92:95]
v_exp_f32 v159, v159
M v[92:95], a[164:167], a[48:51], v[92:95]
v_cvt_pk_bf16_f32 v143, v158, v159
s_waitcnt lgkmcnt(6)
s_add_u32 m0, s29, 65536
M v[160:163], a[116:119], v[96:99], v[160:163]
v_exp_f32 v32, v32
M v[160:163], a[120:123], v[128:131], v[160:163]
ds_read_b128 a[148:151], v3 offset:36864
ds_read_b128 a[152:155], v3 offset:45056
M v[164:167], a[120:123], v[132:135], v[164:167]
v_exp_f32 v33, v33
M v[164:167], a[116:119], v[100:103], v[164:167]
buffer_load_dwordx4 v1, s[12:15], s25 offen offset:0 sc1 lds
s_add_u32 s32, s25, 4096
M v[168:171], a[116:119], v[104:107], v[168:171]
v_exp_f32 v34, v34
M v[168:171], a[120:123], v[136:139], v[168:171]
v_cvt_pk_bf16_f32 v32, v32, v33
M v[172:175], a[120:123], v[140:143], v[172:175]
v_exp_f32 v35, v35
M v[172:175], a[116:119], v[108:111], v[172:175]
buffer_load_dwordx4 v1, s[12:15], s25 offen offset:1024 sc1 lds
s_waitcnt lgkmcnt(6)
M a[96:99], a[112:115], v[96:99], a[96:99]
M a[96:99], a[112:115], v[128:131], a[96:99]
M v[176:179], a[124:127], v[96:99], v[176:179]
v_exp_f32 v48, v48
M v[176:179], a[128:131], v[128:131], v[176:179]
ds_read_b128 a[156:159], v3 offset:37888
ds_read_b128 a[160:163], v3 offset:46080
M v[180:183], a[128:131], v[132:135], v[180:183]
v_exp_f32 v49, v49
M v[180:183], a[124:127], v[100:103], v[180:183]
buffer_load_dwordx4 v1, s[12:15], s25 offen offset:2048 sc1 lds
M v[184:187], a[124:127], v[104:107], v[184:187]
v_exp_f32 v50, v50
M v[184:187], a[128:131], v[136:139], v[184:187]
v_cvt_pk_bf16_f32 v33, v34, v35
v_cvt_pk_bf16_f32 v34, v48, v49
M v[188:191], a[128:131], v[140:143], v[188:191]
v_exp_f32 v51, v51
M v[188:191], a[124:127], v[108:111], v[188:191]
buffer_load_dwordx4 v1, s[12:15], s25 offen offset:3072 sc1 lds
s_add_u32 m0, s29, 69632
s_waitcnt lgkmcnt(6)
M a[100:103], a[112:115], v[100:103], a[100:103]
M a[100:103], a[112:115], v[132:135], a[100:103]
M v[192:195], a[132:135], v[96:99], v[192:195]
v_exp_f32 v36, v36
M v[192:195], a[136:139], v[128:131], v[192:195]
ds_read_b128 a[164:167], v3 offset:38912
ds_read_b128 a[168:171], v3 offset:47104
M v[196:199], a[136:139], v[132:135], v[196:199]
v_exp_f32 v37, v37
M v[196:199], a[132:135], v[100:103], v[196:199]
buffer_load_dwordx4 v1, s[12:15], s32 offen offset:0 sc1 lds
M v[200:203], a[132:135], v[104:107], v[200:203]
v_exp_f32 v38, v38
M v[200:203], a[136:139], v[136:139], v[200:203]
v_cvt_pk_bf16_f32 v35, v50, v51
v_cvt_pk_bf16_f32 v36, v36, v37
M v[204:207], a[136:139], v[140:143], v[204:207]
v_exp_f32 v39, v39
M v[204:207], a[132:135], v[108:111], v[204:207]
buffer_load_dwordx4 v1, s[12:15], s32 offen offset:1024 sc1 lds
s_waitcnt lgkmcnt(6)
M a[104:107], a[112:115], v[104:107], a[104:107]
M a[104:107], a[112:115], v[136:139], a[104:107]
M v[208:211], a[140:143], v[96:99], v[208:211]
v_exp_f32 v52, v52
M v[208:211], a[144:147], v[128:131], v[208:211]
ds_read_b128 a[172:175], v3 offset:39936
ds_read_b128 a[176:179], v3 offset:48128
M v[212:215], a[144:147], v[132:135], v[212:215]
v_exp_f32 v53, v53
M v[212:215], a[140:143], v[100:103], v[212:215]
buffer_load_dwordx4 v1, s[12:15], s32 offen offset:2048 sc1 lds
M v[216:219], a[140:143], v[104:107], v[216:219]
v_exp_f32 v54, v54
M v[216:219], a[144:147], v[136:139], v[216:219]
v_cvt_pk_bf16_f32 v37, v38, v39
v_cvt_pk_bf16_f32 v38, v52, v53
M v[220:223], a[144:147], v[140:143], v[220:223]
v_exp_f32 v55, v55
M v[220:223], a[140:143], v[108:111], v[220:223]
buffer_load_dwordx4 v1, s[12:15], s32 offen offset:3072 sc1 lds
s_waitcnt lgkmcnt(6)
M a[108:111], a[112:115], v[108:111], a[108:111]
M a[108:111], a[112:115], v[140:143], a[108:111]
M v[224:227], a[148:151], v[96:99], v[224:227]
v_exp_f32 v40, v40
M v[224:227], a[152:155], v[128:131], v[224:227]
s_add_u32 s25, s25, 32768
s_cmp_eq_u32 s25, s27
s_cselect_b32 s25, s28, s25
s_cselect_b32 s27, -1, s27
M v[228:231], a[152:155], v[132:135], v[228:231]
v_exp_f32 v41, v41
M v[228:231], a[148:151], v[100:103], v[228:231]
v_cvt_pk_bf16_f32 v39, v54, v55
v_cvt_pk_bf16_f32 v40, v40, v41
M v[232:235], a[148:151], v[104:107], v[232:235]
v_exp_f32 v42, v42
M v[232:235], a[152:155], v[136:139], v[232:235]
M v[236:239], a[152:155], v[140:143], v[236:239]
v_exp_f32 v43, v43
M v[236:239], a[148:151], v[108:111], v[236:239]
v_cvt_pk_bf16_f32 v41, v42, v43
s_waitcnt lgkmcnt(4)
M v[240:243], a[156:159], v[96:99], v[240:243]
v_exp_f32 v56, v56
M v[240:243], a[160:163], v[128:131], v[240:243]
M v[244:247], a[160:163], v[132:135], v[244:247]
v_exp_f32 v57, v57
M v[244:247], a[156:159], v[100:103], v[244:247]
v_cvt_pk_bf16_f32 v42, v56, v57
M v[248:251], a[156:159], v[104:107], v[248:251]
v_exp_f32 v58, v58
M v[248:251], a[160:163], v[136:139], v[248:251]
s_waitcnt vmcnt(16) lgkmcnt(0)
s_barrier
ds_read_b128 a[116:119], v2 offset:0
ds_read_b128 a[120:123], v2 offset:1024
ds_read_b128 a[124:127], v2 offset:2048
ds_read_b128 a[128:131], v2 offset:3072
M v[252:255], a[160:163], v[140:143], v[252:255]
v_exp_f32 v59, v59
M v[252:255], a[156:159], v[108:111], v[252:255]
v_cvt_pk_bf16_f32 v43, v58, v59
M a[64:67], a[164:167], v[96:99], a[64:67]
v_exp_f32 v44, v44
M a[64:67], a[168:171], v[128:131], a[64:67]
ds_read_b128 a[132:135], v2 offset:4096
ds_read_b128 a[136:139], v2 offset:5120
M a[68:71], a[168:171], v[132:135], a[68:71]
v_exp_f32 v45, v45
M a[68:71], a[164:167], v[100:103], a[68:71]
v_cvt_pk_bf16_f32 v44, v44, v45
M a[72:75], a[164:167], v[104:107], a[72:75]
v_exp_f32 v46, v46
M a[72:75], a[168:171], v[136:139], a[72:75]
M a[76:79], a[168:171], v[140:143], a[76:79]
v_exp_f32 v47, v47
M a[76:79], a[164:167], v[108:111], a[76:79]
v_cvt_pk_bf16_f32 v45, v46, v47
M a[80:83], a[172:175], v[96:99], a[80:83]
v_exp_f32 v60, v60
M a[80:83], a[176:179], v[128:131], a[80:83]
ds_read_b128 a[140:143], v2 offset:6144
ds_read_b128 a[144:147], v2 offset:7168
M a[84:87], a[176:179], v[132:135], a[84:87]
v_exp_f32 v61, v61
M a[84:87], a[172:175], v[100:103], a[84:87]
v_cvt_pk_bf16_f32 v46, v60, v61
M a[88:91], a[172:175], v[104:107], a[88:91]
v_exp_f32 v62, v62
M a[88:91], a[176:179], v[136:139], a[88:91]
M a[92:95], a[176:179], v[140:143], a[92:95]
v_exp_f32 v63, v63
M a[92:95], a[172:175], v[108:111], a[92:95]
v_cvt_pk_bf16_f32 v47, v62, v63
s_branch Lk2_l1
Lk2_m1:
s_lshl_b32 s33, s23, 6
s_add_i32 s33, s33, 0
s_cmp_gt_i32 s33, 0
s_cselect_b32 s34, 0, 0xf149f2ca
s_cmp_lt_i32 s33, 0
s_cselect_b32 s33, 0xf149f2ca, 0
v_mov_b32 v20, s34
v_mov_b32 v21, s34
v_mov_b32 v22, s34
v_mov_b32 v23, s34
v_mov_b32 v28, s33
v_mov_b32 v29, s33
v_mov_b32 v30, s33
v_mov_b32 v31, s33
v_med3_f32 v24, v16, v20, v28
v_med3_f32 v25, v17, v20, v28
v_med3_f32 v26, v18, v20, v28
v_med3_f32 v27, v19, v20, v28
s_waitcnt lgkmcnt(4)
s_add_u32 m0, s29, 32768
M v[32:35], a[116:119], a[0:3], v[24:27]
v_exp_f32 v128, v128
M v[32:35], a[120:123], a[4:7], v[32:35]
ds_read_b128 a[148:151], v3 offset:8192
ds_read_b128 a[152:155], v3 offset:9216
M v[32:35], a[124:127], a[8:11], v[32:35]
v_exp_f32 v129, v129
M v[32:35], a[128:131], a[12:15], v[32:35]
buffer_load_dwordx4 v1, s[12:15], s26 offen offset:0 sc1 lds
s_add_u32 s32, s26, 4096
M v[36:39], a[128:131], a[28:31], v[28:31]
v_exp_f32 v130, v130
M v[36:39], a[124:127], a[24:27], v[36:39]
v_cvt_pk_bf16_f32 v128, v128, v129
M v[36:39], a[120:123], a[20:23], v[36:39]
v_exp_f32 v131, v131
M v[36:39], a[116:119], a[16:19], v[36:39]
buffer_load_dwordx4 v1, s[12:15], s26 offen offset:1024 sc1 lds
M v[40:43], a[116:119], a[32:35], v[28:31]
v_exp_f32 v144, v144
M v[40:43], a[120:123], a[36:39], v[40:43]
ds_read_b128 a[156:159], v3 offset:10240
ds_read_b128 a[160:163], v3 offset:11264
M v[40:43], a[124:127], a[40:43], v[40:43]
v_exp_f32 v145, v145
M v[40:43], a[128:131], a[44:47], v[40:43]
buffer_load_dwordx4 v1, s[12:15], s26 offen offset:2048 sc1 lds
M v[44:47], a[128:131], a[60:63], v[28:31]
v_exp_f32 v146, v146
M v[44:47], a[124:127], a[56:59], v[44:47]
v_cvt_pk_bf16_f32 v129, v130, v131
v_cvt_pk_bf16_f32 v130, v144, v145
M v[44:47], a[120:123], a[52:55], v[44:47]
v_exp_f32 v147, v147
M v[44:47], a[116:119], a[48:51], v[44:47]
buffer_load_dwordx4 v1, s[12:15], s26 offen offset:3072 sc1 lds
s_add_u32 m0, s29, 36864
s_waitcnt lgkmcnt(4)
M v[48:51], a[132:135], a[0:3], v[20:23]
v_exp_f32 v132, v132
M v[48:51], a[136:139], a[4:7], v[48:51]
ds_read_b128 a[164:167], v3 offset:12288
ds_read_b128 a[168:171], v3 offset:13312
M v[48:51], a[140:143], a[8:11], v[48:51]
v_exp_f32 v133, v133
M v[48:51], a[144:147], a[12:15], v[48:51]
buffer_load_dwordx4 v1, s[12:15], s32 offen offset:0 sc1 lds
M v[52:55], a[144:147], a[28:31], v[24:27]
v_exp_f32 v134, v134
M v[52:55], a[140:143], a[24:27], v[52:55]
v_cvt_pk_bf16_f32 v131, v146, v147
v_cvt_pk_bf16_f32 v132, v132, v133
M v[52:55], a[136:139], a[20:23], v[52:55]
v_exp_f32 v135, v135
M v[52:55], a[132:135], a[16:19], v[52:55]
buffer_load_dwordx4 v1, s[12:15], s32 offen offset:1024 sc1 lds
M v[56:59], a[132:135], a[32:35], v[28:31]
v_exp_f32 v148, v148
M v[56:59], a[136:139], a[36:39], v[56:59]
ds_read_b128 a[172:175], v3 offset:14336
ds_read_b128 a[176:179], v3 offset:15360
M v[56:59], a[140:143], a[40:43], v[56:59]
v_exp_f32 v149, v149
M v[56:59], a[144:147], a[44:47], v[56:59]
buffer_load_dwordx4 v1, s[12:15], s32 offen offset:2048 sc1 lds
M v[60:63], a[144:147], a[60:63], v[28:31]
v_exp_f32 v150, v150
M v[60:63], a[140:143], a[56:59], v[60:63]
v_cvt_pk_bf16_f32 v133, v134, v135
v_cvt_pk_bf16_f32 v134, v148, v149
M v[60:63], a[136:139], a[52:55], v[60:63]
v_exp_f32 v151, v151
M v[60:63], a[132:135], a[48:51], v[60:63]
buffer_load_dwordx4 v1, s[12:15], s32 offen offset:3072 sc1 lds
s_waitcnt lgkmcnt(4)
M v[64:67], a[148:151], a[0:3], v[20:23]
v_exp_f32 v136, v136
M v[64:67], a[152:155], a[4:7], v[64:67]
s_add_u32 s26, s26, 32768
s_cmp_eq_u32 s26, s62
s_cselect_b32 s26, s63, s26
s_cselect_b32 s62, -1, s62
M v[64:67], a[156:159], a[8:11], v[64:67]
v_exp_f32 v137, v137
M v[64:67], a[160:163], a[12:15], v[64:67]
v_cvt_pk_bf16_f32 v135, v150, v151
v_cvt_pk_bf16_f32 v136, v136, v137
M v[68:71], a[160:163], a[28:31], v[20:23]
v_exp_f32 v138, v138
M v[68:71], a[156:159], a[24:27], v[68:71]
M v[68:71], a[152:155], a[20:23], v[68:71]
v_exp_f32 v139, v139
M v[68:71], a[148:151], a[16:19], v[68:71]
v_cvt_pk_bf16_f32 v137, v138, v139
M v[72:75], a[148:151], a[32:35], v[24:27]
v_exp_f32 v152, v152
M v[72:75], a[152:155], a[36:39], v[72:75]
M v[72:75], a[156:159], a[40:43], v[72:75]
v_exp_f32 v153, v153
M v[72:75], a[160:163], a[44:47], v[72:75]
v_cvt_pk_bf16_f32 v138, v152, v153
M v[76:79], a[160:163], a[60:63], v[28:31]
v_exp_f32 v154, v154
M v[76:79], a[156:159], a[56:59], v[76:79]
s_waitcnt vmcnt(16) lgkmcnt(0)
s_barrier
ds_read_b128 a[116:119], v3 offset:32768
ds_read_b128 a[120:123], v3 offset:40960
ds_read_b128 a[124:127], v3 offset:33792
ds_read_b128 a[128:131], v3 offset:41984
M v[76:79], a[152:155], a[52:55], v[76:79]
v_exp_f32 v155, v155
M v[76:79], a[148:151], a[48:51], v[76:79]
v_cvt_pk_bf16_f32 v139, v154, v155
M v[80:83], a[164:167], a[0:3], v[20:23]
v_exp_f32 v140, v140
M v[80:83], a[168:171], a[4:7], v[80:83]
ds_read_b128 a[132:135], v3 offset:34816
ds_read_b128 a[136:139], v3 offset:43008
M v[80:83], a[172:175], a[8:11], v[80:83]
v_exp_f32 v141, v141
M v[80:83], a[176:179], a[12:15], v[80:83]
v_cvt_pk_bf16_f32 v140, v140, v141
M v[84:87], a[176:179], a[28:31], v[20:23]
v_exp_f32 v142, v142
M v[84:87], a[172:175], a[24:27], v[84:87]
M v[84:87], a[168:171], a[20:23], v[84:87]
v_exp_f32 v143, v143
M v[84:87], a[164:167], a[16:19], v[84:87]
v_cvt_pk_bf16_f32 v141, v142, v143
M v[88:91], a[164:167], a[32:35], v[20:23]
v_exp_f32 v156, v156
M v[88:91], a[168:171], a[36:39], v[88:91]
ds_read_b128 a[140:143], v3 offset:35840
ds_read_b128 a[144:147], v3 offset:44032
M v[88:91], a[172:175], a[40:43], v[88:91]
v_exp_f32 v157, v157
M v[88:91], a[176:179], a[44:47], v[88:91]
v_cvt_pk_bf16_f32 v142, v156, v157
M v[92:95], a[176:179], a[60:63], v[24:27]
v_exp_f32 v158, v158
M v[92:95], a[172:175], a[56:59], v[92:95]
M v[92:95], a[168:171], a[52:55], v[92:95]
v_exp_f32 v159, v159
M v[92:95], a[164:167], a[48:51], v[92:95]
v_cvt_pk_bf16_f32 v143, v158, v159
s_waitcnt lgkmcnt(6)
s_add_u32 m0, s29, 65536
M v[160:163], a[116:119], v[96:99], v[160:163]
v_exp_f32 v32, v32
M v[160:163], a[120:123], v[128:131], v[160:163]
ds_read_b128 a[148:151], v3 offset:36864
ds_read_b128 a[152:155], v3 offset:45056
M v[164:167], a[120:123], v[132:135], v[164:167]
v_exp_f32 v33, v33
M v[164:167], a[116:119], v[100:103], v[164:167]
buffer_load_dwordx4 v1, s[12:15], s25 offen offset:0 sc1 lds
s_add_u32 s32, s25, 4096
M v[168:171], a[116:119], v[104:107], v[168:171]
v_exp_f32 v34, v34
M v[168:171], a[120:123], v[136:139], v[168:171]
v_cvt_pk_bf16_f32 v32, v32, v33
M v[172:175], a[120:123], v[140:143], v[172:175]
v_exp_f32 v35, v35
M v[172:175], a[116:119], v[108:111], v[172:175]
buffer_load_dwordx4 v1, s[12:15], s25 offen offset:1024 sc1 lds
s_waitcnt lgkmcnt(6)
M a[96:99], a[112:115], v[96:99], a[96:99]
M a[96:99], a[112:115], v[128:131], a[96:99]
M v[176:179], a[124:127], v[96:99], v[176:179]
v_exp_f32 v48, v48
M v[176:179], a[128:131], v[128:131], v[176:179]
ds_read_b128 a[156:159], v3 offset:37888
ds_read_b128 a[160:163], v3 offset:46080
M v[180:183], a[128:131], v[132:135], v[180:183]
v_exp_f32 v49, v49
M v[180:183], a[124:127], v[100:103], v[180:183]
buffer_load_dwordx4 v1, s[12:15], s25 offen offset:2048 sc1 lds
M v[184:187], a[124:127], v[104:107], v[184:187]
v_exp_f32 v50, v50
M v[184:187], a[128:131], v[136:139], v[184:187]
v_cvt_pk_bf16_f32 v33, v34, v35
v_cvt_pk_bf16_f32 v34, v48, v49
M v[188:191], a[128:131], v[140:143], v[188:191]
v_exp_f32 v51, v51
M v[188:191], a[124:127], v[108:111], v[188:191]
buffer_load_dwordx4 v1, s[12:15], s25 offen offset:3072 sc1 lds
s_add_u32 m0, s29, 69632
s_waitcnt lgkmcnt(6)
M a[100:103], a[112:115], v[100:103], a[100:103]
M a[100:103], a[112:115], v[132:135], a[100:103]
M v[192:195], a[132:135], v[96:99], v[192:195]
v_exp_f32 v36, v36
M v[192:195], a[136:139], v[128:131], v[192:195]
ds_read_b128 a[164:167], v3 offset:38912
ds_read_b128 a[168:171], v3 offset:47104
M v[196:199], a[136:139], v[132:135], v[196:199]
v_exp_f32 v37, v37
M v[196:199], a[132:135], v[100:103], v[196:199]
buffer_load_dwordx4 v1, s[12:15], s32 offen offset:0 sc1 lds
M v[200:203], a[132:135], v[104:107], v[200:203]
v_exp_f32 v38, v38
M v[200:203], a[136:139], v[136:139], v[200:203]
v_cvt_pk_bf16_f32 v35, v50, v51
v_cvt_pk_bf16_f32 v36, v36, v37
M v[204:207], a[136:139], v[140:143], v[204:207]
v_exp_f32 v39, v39
M v[204:207], a[132:135], v[108:111], v[204:207]
buffer_load_dwordx4 v1, s[12:15], s32 offen offset:1024 sc1 lds
s_waitcnt lgkmcnt(6)
M a[104:107], a[112:115], v[104:107], a[104:107]
M a[104:107], a[112:115], v[136:139], a[104:107]
M v[208:211], a[140:143], v[96:99], v[208:211]
v_exp_f32 v52, v52
M v[208:211], a[144:147], v[128:131], v[208:211]
ds_read_b128 a[172:175], v3 offset:39936
ds_read_b128 a[176:179], v3 offset:48128
M v[212:215], a[144:147], v[132:135], v[212:215]
v_exp_f32 v53, v53
M v[212:215], a[140:143], v[100:103], v[212:215]
buffer_load_dwordx4 v1, s[12:15], s32 offen offset:2048 sc1 lds
M v[216:219], a[140:143], v[104:107], v[216:219]
v_exp_f32 v54, v54
M v[216:219], a[144:147], v[136:139], v[216:219]
v_cvt_pk_bf16_f32 v37, v38, v39
v_cvt_pk_bf16_f32 v38, v52, v53
M v[220:223], a[144:147], v[140:143], v[220:223]
v_exp_f32 v55, v55
M v[220:223], a[140:143], v[108:111], v[220:223]
buffer_load_dwordx4 v1, s[12:15], s32 offen offset:3072 sc1 lds
s_waitcnt lgkmcnt(6)
M a[108:111], a[112:115], v[108:111], a[108:111]
M a[108:111], a[112:115], v[140:143], a[108:111]
M v[224:227], a[148:151], v[96:99], v[224:227]
v_exp_f32 v40, v40
M v[224:227], a[152:155], v[128:131], v[224:227]
s_add_u32 s25, s25, 32768
s_cmp_eq_u32 s25, s27
s_cselect_b32 s25, s28, s25
s_cselect_b32 s27, -1, s27
M v[228:231], a[152:155], v[132:135], v[228:231]
v_exp_f32 v41, v41
M v[228:231], a[148:151], v[100:103], v[228:231]
v_cvt_pk_bf16_f32 v39, v54, v55
v_cvt_pk_bf16_f32 v40, v40, v41
M v[232:235], a[148:151], v[104:107], v[232:235]
v_exp_f32 v42, v42
M v[232:235], a[152:155], v[136:139], v[232:235]
M v[236:239], a[152:155], v[140:143], v[236:239]
v_exp_f32 v43, v43
M v[236:239], a[148:151], v[108:111], v[236:239]
v_cvt_pk_bf16_f32 v41, v42, v43
s_waitcnt lgkmcnt(4)
M v[240:243], a[156:159], v[96:99], v[240:243]
v_exp_f32 v56, v56
M v[240:243], a[160:163], v[128:131], v[240:243]
M v[244:247], a[160:163], v[132:135], v[244:247]
v_exp_f32 v57, v57
M v[244:247], a[156:159], v[100:103], v[244:247]
v_cvt_pk_bf16_f32 v42, v56, v57
M v[248:251], a[156:159], v[104:107], v[248:251]
v_exp_f32 v58, v58
M v[248:251], a[160:163], v[136:139], v[248:251]
s_waitcnt vmcnt(16) lgkmcnt(0)
s_barrier
ds_read_b128 a[116:119], v2 offset:0
ds_read_b128 a[120:123], v2 offset:1024
ds_read_b128 a[124:127], v2 offset:2048
ds_read_b128 a[128:131], v2 offset:3072
M v[252:255], a[160:163], v[140:143], v[252:255]
v_exp_f32 v59, v59
M v[252:255], a[156:159], v[108:111], v[252:255]
v_cvt_pk_bf16_f32 v43, v58, v59
M a[64:67], a[164:167], v[96:99], a[64:67]
v_exp_f32 v44, v44
M a[64:67], a[168:171], v[128:131], a[64:67]
ds_read_b128 a[132:135], v2 offset:4096
ds_read_b128 a[136:139], v2 offset:5120
M a[68:71], a[168:171], v[132:135], a[68:71]
v_exp_f32 v45, v45
M a[68:71], a[164:167], v[100:103], a[68:71]
v_cvt_pk_bf16_f32 v44, v44, v45
M a[72:75], a[164:167], v[104:107], a[72:75]
v_exp_f32 v46, v46
M a[72:75], a[168:171], v[136:139], a[72:75]
M a[76:79], a[168:171], v[140:143], a[76:79]
v_exp_f32 v47, v47
M a[76:79], a[164:167], v[108:111], a[76:79]
v_cvt_pk_bf16_f32 v45, v46, v47
M a[80:83], a[172:175], v[96:99], a[80:83]
v_exp_f32 v60, v60
M a[80:83], a[176:179], v[128:131], a[80:83]
ds_read_b128 a[140:143], v2 offset:6144
ds_read_b128 a[144:147], v2 offset:7168
M a[84:87], a[176:179], v[132:135], a[84:87]
v_exp_f32 v61, v61
M a[84:87], a[172:175], v[100:103], a[84:87]
v_cvt_pk_bf16_f32 v46, v60, v61
M a[88:91], a[172:175], v[104:107], a[88:91]
v_exp_f32 v62, v62
M a[88:91], a[176:179], v[136:139], a[88:91]
M a[92:95], a[176:179], v[140:143], a[92:95]
v_exp_f32 v63, v63
M a[92:95], a[172:175], v[108:111], a[92:95]
v_cvt_pk_bf16_f32 v47, v62, v63
Lk2_m2:
s_sub_u32 s35, 15, s21
s_lshl_b32 s33, s20, 7
s_lshl_b32 s34, s35, 3
s_add_u32 s33, s33, s34
s_lshl_b32 s34, s23, 2
s_add_u32 s33, s33, s34
s_lshl_b32 s33, s33, 12
buffer_load_dwordx4 a[180:183], v1, s[8:11], s33 offen offset:0 sc1
buffer_load_dwordx4 a[184:187], v1, s[8:11], s33 offen offset:1024 sc1
buffer_load_dwordx4 a[188:191], v1, s[8:11], s33 offen offset:2048 sc1
buffer_load_dwordx4 a[192:195], v1, s[8:11], s33 offen offset:3072 sc1
s_add_u32 s33, s33, 4096
buffer_load_dwordx4 a[196:199], v1, s[8:11], s33 offen offset:0 sc1
buffer_load_dwordx4 a[200:203], v1, s[8:11], s33 offen offset:1024 sc1
buffer_load_dwordx4 a[204:207], v1, s[8:11], s33 offen offset:2048 sc1
buffer_load_dwordx4 a[208:211], v1, s[8:11], s33 offen offset:3072 sc1
s_add_u32 s33, s33, 4096
buffer_load_dwordx4 a[212:215], v1, s[8:11], s33 offen offset:0 sc1
buffer_load_dwordx4 a[216:219], v1, s[8:11], s33 offen offset:1024 sc1
buffer_load_dwordx4 a[220:223], v1, s[8:11], s33 offen offset:2048 sc1
buffer_load_dwordx4 a[224:227], v1, s[8:11], s33 offen offset:3072 sc1
s_add_u32 s33, s33, 4096
buffer_load_dwordx4 a[228:231], v1, s[8:11], s33 offen offset:0 sc1
buffer_load_dwordx4 a[232:235], v1, s[8:11], s33 offen offset:1024 sc1
buffer_load_dwordx4 a[236:239], v1, s[8:11], s33 offen offset:2048 sc1
buffer_load_dwordx4 a[240:243], v1, s[8:11], s33 offen offset:3072 sc1
s_lshl_b32 s33, s23, 6
s_add_i32 s33, s33, -64
s_cmp_gt_i32 s33, 0
s_cselect_b32 s34, 0, 0xf149f2ca
s_cmp_lt_i32 s33, 0
s_cselect_b32 s33, 0xf149f2ca, 0
v_mov_b32 v20, s34
v_mov_b32 v21, s34
v_mov_b32 v22, s34
v_mov_b32 v23, s34
v_mov_b32 v28, s33
v_mov_b32 v29, s33
v_mov_b32 v30, s33
v_mov_b32 v31, s33
v_med3_f32 v24, v16, v20, v28
v_med3_f32 v25, v17, v20, v28
v_med3_f32 v26, v18, v20, v28
v_med3_f32 v27, v19, v20, v28
s_waitcnt lgkmcnt(4)
s_add_u32 m0, s29, 98304
M v[96:99], a[116:119], a[0:3], v[24:27]
v_exp_f32 v64, v64
M v[96:99], a[120:123], a[4:7], v[96:99]
ds_read_b128 a[148:151], v2 offset:8192
ds_read_b128 a[152:155], v2 offset:9216
M v[96:99], a[124:127], a[8:11], v[96:99]
v_exp_f32 v65, v65
M v[96:99], a[128:131], a[12:15], v[96:99]
buffer_load_dwordx4 v1, s[12:15], s26 offen offset:0 sc1 lds
s_add_u32 s32, s26, 4096
M v[100:103], a[128:131], a[28:31], v[28:31]
v_exp_f32 v66, v66
M v[100:103], a[124:127], a[24:27], v[100:103]
v_cvt_pk_bf16_f32 v64, v64, v65
M v[100:103], a[120:123], a[20:23], v[100:103]
v_exp_f32 v67, v67
M v[100:103], a[116:119], a[16:19], v[100:103]
buffer_load_dwordx4 v1, s[12:15], s26 offen offset:1024 sc1 lds
M v[104:107], a[116:119], a[32:35], v[28:31]
v_exp_f32 v80, v80
M v[104:107], a[120:123], a[36:39], v[104:107]
ds_read_b128 a[156:159], v2 offset:10240
ds_read_b128 a[160:163], v2 offset:11264
M v[104:107], a[124:127], a[40:43], v[104:107]
v_exp_f32 v81, v81
M v[104:107], a[128:131], a[44:47], v[104:107]
buffer_load_dwordx4 v1, s[12:15], s26 offen offset:2048 sc1 lds
M v[108:111], a[128:131], a[60:63], v[28:31]
v_exp_f32 v82, v82
M v[108:111], a[124:127], a[56:59], v[108:111]
v_cvt_pk_bf16_f32 v65, v66, v67
v_cvt_pk_bf16_f32 v66, v80, v81
M v[108:111], a[120:123], a[52:55], v[108:111]
v_exp_f32 v83, v83
M v[108:111], a[116:119], a[48:51], v[108:111]
buffer_load_dwordx4 v1, s[12:15], s26 offen offset:3072 sc1 lds
s_add_u32 m0, s29, 102400
s_waitcnt lgkmcnt(4)
M v[112:115], a[132:135], a[0:3], v[20:23]
v_exp_f32 v68, v68
M v[112:115], a[136:139], a[4:7], v[112:115]
ds_read_b128 a[164:167], v2 offset:12288
ds_read_b128 a[168:171], v2 offset:13312
M v[112:115], a[140:143], a[8:11], v[112:115]
v_exp_f32 v69, v69
M v[112:115], a[144:147], a[12:15], v[112:115]
buffer_load_dwordx4 v1, s[12:15], s32 offen offset:0 sc1 lds
M v[116:119], a[144:147], a[28:31], v[24:27]
v_exp_f32 v70, v70
M v[116:119], a[140:143], a[24:27], v[116:119]
v_cvt_pk_bf16_f32 v67, v82, v83
v_cvt_pk_bf16_f32 v68, v68, v69
M v[116:119], a[136:139], a[20:23], v[116:119]
v_exp_f32 v71, v71
M v[116:119], a[132:135], a[16:19], v[116:119]
buffer_load_dwordx4 v1, s[12:15], s32 offen offset:1024 sc1 lds
M v[120:123], a[132:135], a[32:35], v[28:31]
v_exp_f32 v84, v84
M v[120:123], a[136:139], a[36:39], v[120:123]
ds_read_b128 a[172:175], v2 offset:14336
ds_read_b128 a[176:179], v2 offset:15360
M v[120:123], a[140:143], a[40:43], v[120:123]
v_exp_f32 v85, v85
M v[120:123], a[144:147], a[44:47], v[120:123]
buffer_load_dwordx4 v1, s[12:15], s32 offen offset:2048 sc1 lds
M v[124:127], a[144:147], a[60:63], v[28:31]
v_exp_f32 v86, v86
M v[124:127], a[140:143], a[56:59], v[124:127]
v_cvt_pk_bf16_f32 v69, v70, v71
v_cvt_pk_bf16_f32 v70, v84, v85
M v[124:127], a[136:139], a[52:55], v[124:127]
v_exp_f32 v87, v87
M v[124:127], a[132:135], a[48:51], v[124:127]
buffer_load_dwordx4 v1, s[12:15], s32 offen offset:3072 sc1 lds
s_waitcnt lgkmcnt(4)
M v[128:131], a[148:151], a[0:3], v[20:23]
v_exp_f32 v72, v72
M v[128:131], a[152:155], a[4:7], v[128:131]
s_add_u32 s26, s26, 32768
s_cmp_eq_u32 s26, s62
s_cselect_b32 s26, s63, s26
s_cselect_b32 s62, -1, s62
M v[128:131], a[156:159], a[8:11], v[128:131]
v_exp_f32 v73, v73
M v[128:131], a[160:163], a[12:15], v[128:131]
v_cvt_pk_bf16_f32 v71, v86, v87
v_cvt_pk_bf16_f32 v72, v72, v73
M v[132:135], a[160:163], a[28:31], v[20:23]
v_exp_f32 v74, v74
M v[132:135], a[156:159], a[24:27], v[132:135]
M v[132:135], a[152:155], a[20:23], v[132:135]
v_exp_f32 v75, v75
M v[132:135], a[148:151], a[16:19], v[132:135]
v_cvt_pk_bf16_f32 v73, v74, v75
M v[136:139], a[148:151], a[32:35], v[24:27]
v_exp_f32 v88, v88
M v[136:139], a[152:155], a[36:39], v[136:139]
M v[136:139], a[156:159], a[40:43], v[136:139]
v_exp_f32 v89, v89
M v[136:139], a[160:163], a[44:47], v[136:139]
v_cvt_pk_bf16_f32 v74, v88, v89
M v[140:143], a[160:163], a[60:63], v[28:31]
v_exp_f32 v90, v90
M v[140:143], a[156:159], a[56:59], v[140:143]
s_waitcnt vmcnt(32) lgkmcnt(0)
s_barrier
ds_read_b128 a[116:119], v2 offset:32768
ds_read_b128 a[120:123], v2 offset:40960
ds_read_b128 a[124:127], v2 offset:33792
ds_read_b128 a[128:131], v2 offset:41984
M v[140:143], a[152:155], a[52:55], v[140:143]
v_exp_f32 v91, v91
M v[140:143], a[148:151], a[48:51], v[140:143]
v_cvt_pk_bf16_f32 v75, v90, v91
M v[144:147], a[164:167], a[0:3], v[20:23]
v_exp_f32 v76, v76
M v[144:147], a[168:171], a[4:7], v[144:147]
ds_read_b128 a[132:135], v2 offset:34816
ds_read_b128 a[136:139], v2 offset:43008
M v[144:147], a[172:175], a[8:11], v[144:147]
v_exp_f32 v77, v77
M v[144:147], a[176:179], a[12:15], v[144:147]
v_cvt_pk_bf16_f32 v76, v76, v77
M v[148:151], a[176:179], a[28:31], v[20:23]
v_exp_f32 v78, v78
M v[148:151], a[172:175], a[24:27], v[148:151]
M v[148:151], a[168:171], a[20:23], v[148:151]
v_exp_f32 v79, v79
M v[148:151], a[164:167], a[16:19], v[148:151]
v_cvt_pk_bf16_f32 v77, v78, v79
M v[152:155], a[164:167], a[32:35], v[20:23]
v_exp_f32 v92, v92
M v[152:155], a[168:171], a[36:39], v[152:155]
ds_read_b128 a[140:143], v2 offset:35840
ds_read_b128 a[144:147], v2 offset:44032
M v[152:155], a[172:175], a[40:43], v[152:155]
v_exp_f32 v93, v93
M v[152:155], a[176:179], a[44:47], v[152:155]
v_cvt_pk_bf16_f32 v78, v92, v93
M v[156:159], a[176:179], a[60:63], v[24:27]
v_exp_f32 v94, v94
M v[156:159], a[172:175], a[56:59], v[156:159]
M v[156:159], a[168:171], a[52:55], v[156:159]
v_exp_f32 v95, v95
M v[156:159], a[164:167], a[48:51], v[156:159]
v_cvt_pk_bf16_f32 v79, v94, v95
s_waitcnt lgkmcnt(6)
s_add_u32 m0, s29, 0
M v[160:163], a[116:119], v[32:35], v[160:163]
v_exp_f32 v96, v96
M v[160:163], a[120:123], v[64:67], v[160:163]
ds_read_b128 a[148:151], v2 offset:36864
ds_read_b128 a[152:155], v2 offset:45056
M v[164:167], a[120:123], v[68:71], v[164:167]
v_exp_f32 v97, v97
M v[164:167], a[116:119], v[36:39], v[164:167]
buffer_load_dwordx4 v1, s[12:15], s25 offen offset:0 sc1 lds
s_add_u32 s32, s25, 4096
M v[168:171], a[116:119], v[40:43], v[168:171]
v_exp_f32 v98, v98
M v[168:171], a[120:123], v[72:75], v[168:171]
v_cvt_pk_bf16_f32 v96, v96, v97
M v[172:175], a[120:123], v[76:79], v[172:175]
v_exp_f32 v99, v99
M v[172:175], a[116:119], v[44:47], v[172:175]
buffer_load_dwordx4 v1, s[12:15], s25 offen offset:1024 sc1 lds
s_waitcnt lgkmcnt(6)
M a[96:99], a[112:115], v[32:35], a[96:99]
M a[96:99], a[112:115], v[64:67], a[96:99]
M v[176:179], a[124:127], v[32:35], v[176:179]
v_exp_f32 v112, v112
M v[176:179], a[128:131], v[64:67], v[176:179]
ds_read_b128 a[156:159], v2 offset:37888
ds_read_b128 a[160:163], v2 offset:46080
M v[180:183], a[128:131], v[68:71], v[180:183]
v_exp_f32 v113, v113
M v[180:183], a[124:127], v[36:39], v[180:183]
buffer_load_dwordx4 v1, s[12:15], s25 offen offset:2048 sc1 lds
M v[184:187], a[124:127], v[40:43], v[184:187]
v_exp_f32 v114, v114
M v[184:187], a[128:131], v[72:75], v[184:187]
v_cvt_pk_bf16_f32 v97, v98, v99
v_cvt_pk_bf16_f32 v98, v112, v113
M v[188:191], a[128:131], v[76:79], v[188:191]
v_exp_f32 v115, v115
M v[188:191], a[124:127], v[44:47], v[188:191]
buffer_load_dwordx4 v1, s[12:15], s25 offen offset:3072 sc1 lds
s_add_u32 m0, s29, 4096
s_waitcnt lgkmcnt(6)
M a[100:103], a[112:115], v[36:39], a[100:103]
M a[100:103], a[112:115], v[68:71], a[100:103]
M v[192:195], a[132:135], v[32:35], v[192:195]
v_exp_f32 v100, v100
M v[192:195], a[136:139], v[64:67], v[192:195]
ds_read_b128 a[164:167], v2 offset:38912
ds_read_b128 a[168:171], v2 offset:47104
M v[196:199], a[136:139], v[68:71], v[196:199]
v_exp_f32 v101, v101
M v[196:199], a[132:135], v[36:39], v[196:199]
buffer_load_dwordx4 v1, s[12:15], s32 offen offset:0 sc1 lds
M v[200:203], a[132:135], v[40:43], v[200:203]
v_exp_f32 v102, v102
M v[200:203], a[136:139], v[72:75], v[200:203]
v_cvt_pk_bf16_f32 v99, v114, v115
v_cvt_pk_bf16_f32 v100, v100, v101
M v[204:207], a[136:139], v[76:79], v[204:207]
v_exp_f32 v103, v103
M v[204:207], a[132:135], v[44:47], v[204:207]
buffer_load_dwordx4 v1, s[12:15], s32 offen offset:1024 sc1 lds
s_waitcnt lgkmcnt(6)
M a[104:107], a[112:115], v[40:43], a[104:107]
M a[104:107], a[112:115], v[72:75], a[104:107]
M v[208:211], a[140:143], v[32:35], v[208:211]
v_exp_f32 v116, v116
M v[208:211], a[144:147], v[64:67], v[208:211]
ds_read_b128 a[172:175], v2 offset:39936
ds_read_b128 a[176:179], v2 offset:48128
M v[212:215], a[144:147], v[68:71], v[212:215]
v_exp_f32 v117, v117
M v[212:215], a[140:143], v[36:39], v[212:215]
buffer_load_dwordx4 v1, s[12:15], s32 offen offset:2048 sc1 lds
M v[216:219], a[140:143], v[40:43], v[216:219]
v_exp_f32 v118, v118
M v[216:219], a[144:147], v[72:75], v[216:219]
v_cvt_pk_bf16_f32 v101, v102, v103
v_cvt_pk_bf16_f32 v102, v116, v117
M v[220:223], a[144:147], v[76:79], v[220:223]
v_exp_f32 v119, v119
M v[220:223], a[140:143], v[44:47], v[220:223]
buffer_load_dwordx4 v1, s[12:15], s32 offen offset:3072 sc1 lds
s_waitcnt lgkmcnt(6)
M a[108:111], a[112:115], v[44:47], a[108:111]
M a[108:111], a[112:115], v[76:79], a[108:111]
M v[224:227], a[148:151], v[32:35], v[224:227]
v_exp_f32 v104, v104
M v[224:227], a[152:155], v[64:67], v[224:227]
s_add_u32 s25, s25, 32768
s_cmp_eq_u32 s25, s27
s_cselect_b32 s25, s28, s25
s_cselect_b32 s27, -1, s27
M v[228:231], a[152:155], v[68:71], v[228:231]
v_exp_f32 v105, v105
M v[228:231], a[148:151], v[36:39], v[228:231]
v_cvt_pk_bf16_f32 v103, v118, v119
v_cvt_pk_bf16_f32 v104, v104, v105
M v[232:235], a[148:151], v[40:43], v[232:235]
v_exp_f32 v106, v106
M v[232:235], a[152:155], v[72:75], v[232:235]
M v[236:239], a[152:155], v[76:79], v[236:239]
v_exp_f32 v107, v107
M v[236:239], a[148:151], v[44:47], v[236:239]
v_cvt_pk_bf16_f32 v105, v106, v107
s_waitcnt lgkmcnt(4)
M v[240:243], a[156:159], v[32:35], v[240:243]
v_exp_f32 v120, v120
M v[240:243], a[160:163], v[64:67], v[240:243]
M v[244:247], a[160:163], v[68:71], v[244:247]
v_exp_f32 v121, v121
M v[244:247], a[156:159], v[36:39], v[244:247]
v_cvt_pk_bf16_f32 v106, v120, v121
M v[248:251], a[156:159], v[40:43], v[248:251]
v_exp_f32 v122, v122
M v[248:251], a[160:163], v[72:75], v[248:251]
s_waitcnt vmcnt(32) lgkmcnt(0)
s_barrier
ds_read_b128 a[116:119], v3 offset:0
ds_read_b128 a[120:123], v3 offset:1024
ds_read_b128 a[124:127], v3 offset:2048
ds_read_b128 a[128:131], v3 offset:3072
M v[252:255], a[160:163], v[76:79], v[252:255]
v_exp_f32 v123, v123
M v[252:255], a[156:159], v[44:47], v[252:255]
v_cvt_pk_bf16_f32 v107, v122, v123
M a[64:67], a[164:167], v[32:35], a[64:67]
v_exp_f32 v108, v108
M a[64:67], a[168:171], v[64:67], a[64:67]
ds_read_b128 a[132:135], v3 offset:4096
ds_read_b128 a[136:139], v3 offset:5120
M a[68:71], a[168:171], v[68:71], a[68:71]
v_exp_f32 v109, v109
M a[68:71], a[164:167], v[36:39], a[68:71]
v_cvt_pk_bf16_f32 v108, v108, v109
M a[72:75], a[164:167], v[40:43], a[72:75]
v_exp_f32 v110, v110
M a[72:75], a[168:171], v[72:75], a[72:75]
M a[76:79], a[168:171], v[76:79], a[76:79]
v_exp_f32 v111, v111
M a[76:79], a[164:167], v[44:47], a[76:79]
v_cvt_pk_bf16_f32 v109, v110, v111
M a[80:83], a[172:175], v[32:35], a[80:83]
v_exp_f32 v124, v124
M a[80:83], a[176:179], v[64:67], a[80:83]
ds_read_b128 a[140:143], v3 offset:6144
ds_read_b128 a[144:147], v3 offset:7168
M a[84:87], a[176:179], v[68:71], a[84:87]
v_exp_f32 v125, v125
M a[84:87], a[172:175], v[36:39], a[84:87]
v_cvt_pk_bf16_f32 v110, v124, v125
M a[88:91], a[172:175], v[40:43], a[88:91]
v_exp_f32 v126, v126
M a[88:91], a[176:179], v[72:75], a[88:91]
M a[92:95], a[176:179], v[76:79], a[92:95]
v_exp_f32 v127, v127
M a[92:95], a[172:175], v[44:47], a[92:95]
v_cvt_pk_bf16_f32 v111, v126, v127
s_waitcnt vmcnt(16)
s_waitcnt lgkmcnt(4)
s_add_u32 m0, s29, 32768
M v[32:35], a[116:119], a[180:183], 0
v_exp_f32 v128, v128
M v[32:35], a[120:123], a[184:187], v[32:35]
ds_read_b128 a[148:151], v3 offset:8192
ds_read_b128 a[152:155], v3 offset:9216
M v[32:35], a[124:127], a[188:191], v[32:35]
v_exp_f32 v129, v129
M v[32:35], a[128:131], a[192:195], v[32:35]
buffer_load_dwordx4 v1, s[12:15], s26 offen offset:0 sc1 lds
s_add_u32 s32, s26, 4096
M v[36:39], a[128:131], a[208:211], 0
v_exp_f32 v130, v130
M v[36:39], a[124:127], a[204:207], v[36:39]
v_cvt_pk_bf16_f32 v128, v128, v129
M v[36:39], a[120:123], a[200:203], v[36:39]
v_exp_f32 v131, v131
M v[36:39], a[116:119], a[196:199], v[36:39]
buffer_load_dwordx4 v1, s[12:15], s26 offen offset:1024 sc1 lds
M v[40:43], a[116:119], a[212:215], 0
v_exp_f32 v144, v144
M v[40:43], a[120:123], a[216:219], v[40:43]
ds_read_b128 a[156:159], v3 offset:10240
ds_read_b128 a[160:163], v3 offset:11264
M v[40:43], a[124:127], a[220:223], v[40:43]
v_exp_f32 v145, v145
M v[40:43], a[128:131], a[224:227], v[40:43]
buffer_load_dwordx4 v1, s[12:15], s26 offen offset:2048 sc1 lds
M v[44:47], a[128:131], a[240:243], 0
v_exp_f32 v146, v146
M v[44:47], a[124:127], a[236:239], v[44:47]
v_cvt_pk_bf16_f32 v129, v130, v131
v_cvt_pk_bf16_f32 v130, v144, v145
M v[44:47], a[120:123], a[232:235], v[44:47]
v_exp_f32 v147, v147
M v[44:47], a[116:119], a[228:231], v[44:47]
buffer_load_dwordx4 v1, s[12:15], s26 offen offset:3072 sc1 lds
s_add_u32 m0, s29, 36864
s_waitcnt lgkmcnt(4)
M v[48:51], a[132:135], a[180:183], 0
v_exp_f32 v132, v132
M v[48:51], a[136:139], a[184:187], v[48:51]
ds_read_b128 a[164:167], v3 offset:12288
ds_read_b128 a[168:171], v3 offset:13312
M v[48:51], a[140:143], a[188:191], v[48:51]
v_exp_f32 v133, v133
M v[48:51], a[144:147], a[192:195], v[48:51]
buffer_load_dwordx4 v1, s[12:15], s32 offen offset:0 sc1 lds
M v[52:55], a[144:147], a[208:211], 0
v_exp_f32 v134, v134
M v[52:55], a[140:143], a[204:207], v[52:55]
v_cvt_pk_bf16_f32 v131, v146, v147
v_cvt_pk_bf16_f32 v132, v132, v133
M v[52:55], a[136:139], a[200:203], v[52:55]
v_exp_f32 v135, v135
M v[52:55], a[132:135], a[196:199], v[52:55]
buffer_load_dwordx4 v1, s[12:15], s32 offen offset:1024 sc1 lds
M v[56:59], a[132:135], a[212:215], 0
v_exp_f32 v148, v148
M v[56:59], a[136:139], a[216:219], v[56:59]
ds_read_b128 a[172:175], v3 offset:14336
ds_read_b128 a[176:179], v3 offset:15360
M v[56:59], a[140:143], a[220:223], v[56:59]
v_exp_f32 v149, v149
M v[56:59], a[144:147], a[224:227], v[56:59]
buffer_load_dwordx4 v1, s[12:15], s32 offen offset:2048 sc1 lds
M v[60:63], a[144:147], a[240:243], 0
v_exp_f32 v150, v150
M v[60:63], a[140:143], a[236:239], v[60:63]
v_cvt_pk_bf16_f32 v133, v134, v135
v_cvt_pk_bf16_f32 v134, v148, v149
M v[60:63], a[136:139], a[232:235], v[60:63]
v_exp_f32 v151, v151
M v[60:63], a[132:135], a[228:231], v[60:63]
buffer_load_dwordx4 v1, s[12:15], s32 offen offset:3072 sc1 lds
s_waitcnt lgkmcnt(4)
M v[64:67], a[148:151], a[180:183], 0
v_exp_f32 v136, v136
M v[64:67], a[152:155], a[184:187], v[64:67]
s_add_u32 s26, s26, 32768
s_cmp_eq_u32 s26, s62
s_cselect_b32 s26, s63, s26
s_cselect_b32 s62, -1, s62
M v[64:67], a[156:159], a[188:191], v[64:67]
v_exp_f32 v137, v137
M v[64:67], a[160:163], a[192:195], v[64:67]
v_cvt_pk_bf16_f32 v135, v150, v151
v_cvt_pk_bf16_f32 v136, v136, v137
M v[68:71], a[160:163], a[208:211], 0
v_exp_f32 v138, v138
M v[68:71], a[156:159], a[204:207], v[68:71]
M v[68:71], a[152:155], a[200:203], v[68:71]
v_exp_f32 v139, v139
M v[68:71], a[148:151], a[196:199], v[68:71]
v_cvt_pk_bf16_f32 v137, v138, v139
M v[72:75], a[148:151], a[212:215], 0
v_exp_f32 v152, v152
M v[72:75], a[152:155], a[216:219], v[72:75]
M v[72:75], a[156:159], a[220:223], v[72:75]
v_exp_f32 v153, v153
M v[72:75], a[160:163], a[224:227], v[72:75]
v_cvt_pk_bf16_f32 v138, v152, v153
M v[76:79], a[160:163], a[240:243], 0
v_exp_f32 v154, v154
M v[76:79], a[156:159], a[236:239], v[76:79]
s_waitcnt vmcnt(16) lgkmcnt(0)
s_barrier
ds_read_b128 a[116:119], v3 offset:32768
ds_read_b128 a[120:123], v3 offset:40960
ds_read_b128 a[124:127], v3 offset:33792
ds_read_b128 a[128:131], v3 offset:41984
M v[76:79], a[152:155], a[232:235], v[76:79]
v_exp_f32 v155, v155
M v[76:79], a[148:151], a[228:231], v[76:79]
v_cvt_pk_bf16_f32 v139, v154, v155
M v[80:83], a[164:167], a[180:183], 0
v_exp_f32 v140, v140
M v[80:83], a[168:171], a[184:187], v[80:83]
ds_read_b128 a[132:135], v3 offset:34816
ds_read_b128 a[136:139], v3 offset:43008
M v[80:83], a[172:175], a[188:191], v[80:83]
v_exp_f32 v141, v141
M v[80:83], a[176:179], a[192:195], v[80:83]
v_cvt_pk_bf16_f32 v140, v140, v141
M v[84:87], a[176:179], a[208:211], 0
v_exp_f32 v142, v142
M v[84:87], a[172:175], a[204:207], v[84:87]
M v[84:87], a[168:171], a[200:203], v[84:87]
v_exp_f32 v143, v143
M v[84:87], a[164:167], a[196:199], v[84:87]
v_cvt_pk_bf16_f32 v141, v142, v143
M v[88:91], a[164:167], a[212:215], 0
v_exp_f32 v156, v156
M v[88:91], a[168:171], a[216:219], v[88:91]
ds_read_b128 a[140:143], v3 offset:35840
ds_read_b128 a[144:147], v3 offset:44032
M v[88:91], a[172:175], a[220:223], v[88:91]
v_exp_f32 v157, v157
M v[88:91], a[176:179], a[224:227], v[88:91]
v_cvt_pk_bf16_f32 v142, v156, v157
M v[92:95], a[176:179], a[240:243], 0
v_exp_f32 v158, v158
M v[92:95], a[172:175], a[236:239], v[92:95]
M v[92:95], a[168:171], a[232:235], v[92:95]
v_exp_f32 v159, v159
M v[92:95], a[164:167], a[228:231], v[92:95]
v_cvt_pk_bf16_f32 v143, v158, v159
s_waitcnt lgkmcnt(6)
s_add_u32 m0, s29, 65536
M v[160:163], a[116:119], v[96:99], v[160:163]
v_exp_f32 v32, v32
M v[160:163], a[120:123], v[128:131], v[160:163]
ds_read_b128 a[148:151], v3 offset:36864
ds_read_b128 a[152:155], v3 offset:45056
M v[164:167], a[120:123], v[132:135], v[164:167]
v_exp_f32 v33, v33
M v[164:167], a[116:119], v[100:103], v[164:167]
buffer_load_dwordx4 v1, s[12:15], s25 offen offset:0 sc1 lds
s_add_u32 s32, s25, 4096
M v[168:171], a[116:119], v[104:107], v[168:171]
v_exp_f32 v34, v34
M v[168:171], a[120:123], v[136:139], v[168:171]
v_cvt_pk_bf16_f32 v32, v32, v33
M v[172:175], a[120:123], v[140:143], v[172:175]
v_exp_f32 v35, v35
M v[172:175], a[116:119], v[108:111], v[172:175]
buffer_load_dwordx4 v1, s[12:15], s25 offen offset:1024 sc1 lds
s_waitcnt lgkmcnt(6)
M a[96:99], a[112:115], v[96:99], a[96:99]
M a[96:99], a[112:115], v[128:131], a[96:99]
M v[176:179], a[124:127], v[96:99], v[176:179]
v_exp_f32 v48, v48
M v[176:179], a[128:131], v[128:131], v[176:179]
ds_read_b128 a[156:159], v3 offset:37888
ds_read_b128 a[160:163], v3 offset:46080
M v[180:183], a[128:131], v[132:135], v[180:183]
v_exp_f32 v49, v49
M v[180:183], a[124:127], v[100:103], v[180:183]
buffer_load_dwordx4 v1, s[12:15], s25 offen offset:2048 sc1 lds
M v[184:187], a[124:127], v[104:107], v[184:187]
v_exp_f32 v50, v50
M v[184:187], a[128:131], v[136:139], v[184:187]
v_cvt_pk_bf16_f32 v33, v34, v35
v_cvt_pk_bf16_f32 v34, v48, v49
M v[188:191], a[128:131], v[140:143], v[188:191]
v_exp_f32 v51, v51
M v[188:191], a[124:127], v[108:111], v[188:191]
buffer_load_dwordx4 v1, s[12:15], s25 offen offset:3072 sc1 lds
s_add_u32 m0, s29, 69632
s_waitcnt lgkmcnt(6)
M a[100:103], a[112:115], v[100:103], a[100:103]
M a[100:103], a[112:115], v[132:135], a[100:103]
M v[192:195], a[132:135], v[96:99], v[192:195]
v_exp_f32 v36, v36
M v[192:195], a[136:139], v[128:131], v[192:195]
ds_read_b128 a[164:167], v3 offset:38912
ds_read_b128 a[168:171], v3 offset:47104
M v[196:199], a[136:139], v[132:135], v[196:199]
v_exp_f32 v37, v37
M v[196:199], a[132:135], v[100:103], v[196:199]
buffer_load_dwordx4 v1, s[12:15], s32 offen offset:0 sc1 lds
M v[200:203], a[132:135], v[104:107], v[200:203]
v_exp_f32 v38, v38
M v[200:203], a[136:139], v[136:139], v[200:203]
v_cvt_pk_bf16_f32 v35, v50, v51
v_cvt_pk_bf16_f32 v36, v36, v37
M v[204:207], a[136:139], v[140:143], v[204:207]
v_exp_f32 v39, v39
M v[204:207], a[132:135], v[108:111], v[204:207]
buffer_load_dwordx4 v1, s[12:15], s32 offen offset:1024 sc1 lds
s_waitcnt lgkmcnt(6)
M a[104:107], a[112:115], v[104:107], a[104:107]
M a[104:107], a[112:115], v[136:139], a[104:107]
M v[208:211], a[140:143], v[96:99], v[208:211]
v_exp_f32 v52, v52
M v[208:211], a[144:147], v[128:131], v[208:211]
ds_read_b128 a[172:175], v3 offset:39936
ds_read_b128 a[176:179], v3 offset:48128
M v[212:215], a[144:147], v[132:135], v[212:215]
v_exp_f32 v53, v53
M v[212:215], a[140:143], v[100:103], v[212:215]
buffer_load_dwordx4 v1, s[12:15], s32 offen offset:2048 sc1 lds
M v[216:219], a[140:143], v[104:107], v[216:219]
v_exp_f32 v54, v54
M v[216:219], a[144:147], v[136:139], v[216:219]
v_cvt_pk_bf16_f32 v37, v38, v39
v_cvt_pk_bf16_f32 v38, v52, v53
M v[220:223], a[144:147], v[140:143], v[220:223]
v_exp_f32 v55, v55
M v[220:223], a[140:143], v[108:111], v[220:223]
buffer_load_dwordx4 v1, s[12:15], s32 offen offset:3072 sc1 lds
s_waitcnt lgkmcnt(6)
M a[108:111], a[112:115], v[108:111], a[108:111]
M a[108:111], a[112:115], v[140:143], a[108:111]
M v[224:227], a[148:151], v[96:99], v[224:227]
v_exp_f32 v40, v40
M v[224:227], a[152:155], v[128:131], v[224:227]
s_add_u32 s25, s25, 32768
s_cmp_eq_u32 s25, s27
s_cselect_b32 s25, s28, s25
s_cselect_b32 s27, -1, s27
M v[228:231], a[152:155], v[132:135], v[228:231]
v_exp_f32 v41, v41
M v[228:231], a[148:151], v[100:103], v[228:231]
v_cvt_pk_bf16_f32 v39, v54, v55
v_cvt_pk_bf16_f32 v40, v40, v41
M v[232:235], a[148:151], v[104:107], v[232:235]
v_exp_f32 v42, v42
M v[232:235], a[152:155], v[136:139], v[232:235]
M v[236:239], a[152:155], v[140:143], v[236:239]
v_exp_f32 v43, v43
M v[236:239], a[148:151], v[108:111], v[236:239]
v_cvt_pk_bf16_f32 v41, v42, v43
s_waitcnt lgkmcnt(4)
M v[240:243], a[156:159], v[96:99], v[240:243]
v_exp_f32 v56, v56
M v[240:243], a[160:163], v[128:131], v[240:243]
M v[244:247], a[160:163], v[132:135], v[244:247]
v_exp_f32 v57, v57
M v[244:247], a[156:159], v[100:103], v[244:247]
v_cvt_pk_bf16_f32 v42, v56, v57
M v[248:251], a[156:159], v[104:107], v[248:251]
v_exp_f32 v58, v58
M v[248:251], a[160:163], v[136:139], v[248:251]
s_waitcnt vmcnt(16) lgkmcnt(0)
s_barrier
ds_read_b128 a[116:119], v2 offset:0
ds_read_b128 a[120:123], v2 offset:1024
ds_read_b128 a[124:127], v2 offset:2048
ds_read_b128 a[128:131], v2 offset:3072
M v[252:255], a[160:163], v[140:143], v[252:255]
v_exp_f32 v59, v59
M v[252:255], a[156:159], v[108:111], v[252:255]
v_cvt_pk_bf16_f32 v43, v58, v59
M a[64:67], a[164:167], v[96:99], a[64:67]
v_exp_f32 v44, v44
M a[64:67], a[168:171], v[128:131], a[64:67]
ds_read_b128 a[132:135], v2 offset:4096
ds_read_b128 a[136:139], v2 offset:5120
M a[68:71], a[168:171], v[132:135], a[68:71]
v_exp_f32 v45, v45
M a[68:71], a[164:167], v[100:103], a[68:71]
v_cvt_pk_bf16_f32 v44, v44, v45
M a[72:75], a[164:167], v[104:107], a[72:75]
v_exp_f32 v46, v46
M a[72:75], a[168:171], v[136:139], a[72:75]
M a[76:79], a[168:171], v[140:143], a[76:79]
v_exp_f32 v47, v47
M a[76:79], a[164:167], v[108:111], a[76:79]
v_cvt_pk_bf16_f32 v45, v46, v47
M a[80:83], a[172:175], v[96:99], a[80:83]
v_exp_f32 v60, v60
M a[80:83], a[176:179], v[128:131], a[80:83]
ds_read_b128 a[140:143], v2 offset:6144
ds_read_b128 a[144:147], v2 offset:7168
M a[84:87], a[176:179], v[132:135], a[84:87]
v_exp_f32 v61, v61
M a[84:87], a[172:175], v[100:103], a[84:87]
v_cvt_pk_bf16_f32 v46, v60, v61
M a[88:91], a[172:175], v[104:107], a[88:91]
v_exp_f32 v62, v62
M a[88:91], a[176:179], v[136:139], a[88:91]
M a[92:95], a[176:179], v[140:143], a[92:95]
v_exp_f32 v63, v63
M a[92:95], a[172:175], v[108:111], a[92:95]
v_cvt_pk_bf16_f32 v47, v62, v63
v_accvgpr_read_b32 v20, a96
v_accvgpr_read_b32 v21, a100
v_accvgpr_read_b32 v22, a104
v_accvgpr_read_b32 v23, a108
v_rcp_f32 v8, v20
v_rcp_f32 v9, v21
v_rcp_f32 v10, v22
v_rcp_f32 v11, v23
v_subrev_u32 v20, 0x21800000, v20
v_subrev_u32 v21, 0x21800000, v21
v_subrev_u32 v22, 0x21800000, v22
v_subrev_u32 v23, 0x21800000, v23
v_max_u32 v12, v20, v21
v_max3_u32 v12, v12, v22, v23
s_mov_b32 s64, 0x207
v_pk_mul_f32 v[160:161], v[160:161], v[8:9] op_sel:[0,0] op_sel_hi:[1,0]
v_pk_mul_f32 v[162:163], v[162:163], v[8:9] op_sel:[0,0] op_sel_hi:[1,0]
v_pk_mul_f32 v[176:177], v[176:177], v[8:9] op_sel:[0,0] op_sel_hi:[1,0]
v_pk_mul_f32 v[178:179], v[178:179], v[8:9] op_sel:[0,0] op_sel_hi:[1,0]
v_cvt_pk_bf16_f32 v160, v160, v161
v_cvt_pk_bf16_f32 v161, v162, v163
v_cvt_pk_bf16_f32 v162, v176, v177
v_cvt_pk_bf16_f32 v163, v178, v179
s_nop 1
M v[24:27], a[112:115], v[160:163], 0
v_pk_mul_f32 v[164:165], v[164:165], v[8:9] op_sel:[0,1] op_sel_hi:[1,1]
v_pk_mul_f32 v[166:167], v[166:167], v[8:9] op_sel:[0,1] op_sel_hi:[1,1]
v_pk_mul_f32 v[180:181], v[180:181], v[8:9] op_sel:[0,1] op_sel_hi:[1,1]
v_pk_mul_f32 v[182:183], v[182:183], v[8:9] op_sel:[0,1] op_sel_hi:[1,1]
v_cvt_pk_bf16_f32 v164, v164, v165
v_cvt_pk_bf16_f32 v165, v166, v167
v_cvt_pk_bf16_f32 v166, v180, v181
v_cvt_pk_bf16_f32 v167, v182, v183
s_nop 1
M v[24:27], a[112:115], v[164:167], v[24:27]
v_pk_mul_f32 v[168:169], v[168:169], v[10:11] op_sel:[0,0] op_sel_hi:[1,0]
v_pk_mul_f32 v[170:171], v[170:171], v[10:11] op_sel:[0,0] op_sel_hi:[1,0]
v_pk_mul_f32 v[184:185], v[184:185], v[10:11] op_sel:[0,0] op_sel_hi:[1,0]
v_pk_mul_f32 v[186:187], v[186:187], v[10:11] op_sel:[0,0] op_sel_hi:[1,0]
v_cvt_pk_bf16_f32 v168, v168, v169
v_cvt_pk_bf16_f32 v169, v170, v171
v_cvt_pk_bf16_f32 v170, v184, v185
v_cvt_pk_bf16_f32 v171, v186, v187
s_nop 1
M v[24:27], a[112:115], v[168:171], v[24:27]
v_pk_mul_f32 v[172:173], v[172:173], v[10:11] op_sel:[0,1] op_sel_hi:[1,1]
v_pk_mul_f32 v[174:175], v[174:175], v[10:11] op_sel:[0,1] op_sel_hi:[1,1]
v_pk_mul_f32 v[188:189], v[188:189], v[10:11] op_sel:[0,1] op_sel_hi:[1,1]
v_pk_mul_f32 v[190:191], v[190:191], v[10:11] op_sel:[0,1] op_sel_hi:[1,1]
v_cvt_pk_bf16_f32 v172, v172, v173
v_cvt_pk_bf16_f32 v173, v174, v175
v_cvt_pk_bf16_f32 v174, v188, v189
v_cvt_pk_bf16_f32 v175, v190, v191
s_nop 1
M v[24:27], a[112:115], v[172:175], v[24:27]
v_pk_mul_f32 v[192:193], v[192:193], v[8:9] op_sel:[0,0] op_sel_hi:[1,0]
v_pk_mul_f32 v[194:195], v[194:195], v[8:9] op_sel:[0,0] op_sel_hi:[1,0]
v_pk_mul_f32 v[208:209], v[208:209], v[8:9] op_sel:[0,0] op_sel_hi:[1,0]
v_pk_mul_f32 v[210:211], v[210:211], v[8:9] op_sel:[0,0] op_sel_hi:[1,0]
v_cvt_pk_bf16_f32 v192, v192, v193
v_cvt_pk_bf16_f32 v193, v194, v195
v_cvt_pk_bf16_f32 v194, v208, v209
v_cvt_pk_bf16_f32 v195, v210, v211
s_nop 1
M v[24:27], a[112:115], v[192:195], v[24:27]
v_pk_mul_f32 v[196:197], v[196:197], v[8:9] op_sel:[0,1] op_sel_hi:[1,1]
v_pk_mul_f32 v[198:199], v[198:199], v[8:9] op_sel:[0,1] op_sel_hi:[1,1]
v_pk_mul_f32 v[212:213], v[212:213], v[8:9] op_sel:[0,1] op_sel_hi:[1,1]
v_pk_mul_f32 v[214:215], v[214:215], v[8:9] op_sel:[0,1] op_sel_hi:[1,1]
v_cvt_pk_bf16_f32 v196, v196, v197
v_cvt_pk_bf16_f32 v197, v198, v199
v_cvt_pk_bf16_f32 v198, v212, v213
v_cvt_pk_bf16_f32 v199, v214, v215
s_nop 1
M v[24:27], a[112:115], v[196:199], v[24:27]
v_pk_mul_f32 v[200:201], v[200:201], v[10:11] op_sel:[0,0] op_sel_hi:[1,0]
v_pk_mul_f32 v[202:203], v[202:203], v[10:11] op_sel:[0,0] op_sel_hi:[1,0]
v_pk_mul_f32 v[216:217], v[216:217], v[10:11] op_sel:[0,0] op_sel_hi:[1,0]
v_pk_mul_f32 v[218:219], v[218:219], v[10:11] op_sel:[0,0] op_sel_hi:[1,0]
v_cvt_pk_bf16_f32 v200, v200, v201
v_cvt_pk_bf16_f32 v201, v202, v203
v_cvt_pk_bf16_f32 v202, v216, v217
v_cvt_pk_bf16_f32 v203, v218, v219
s_nop 1
M v[24:27], a[112:115], v[200:203], v[24:27]
v_pk_mul_f32 v[204:205], v[204:205], v[10:11] op_sel:[0,1] op_sel_hi:[1,1]
v_pk_mul_f32 v[206:207], v[206:207], v[10:11] op_sel:[0,1] op_sel_hi:[1,1]
v_pk_mul_f32 v[220:221], v[220:221], v[10:11] op_sel:[0,1] op_sel_hi:[1,1]
v_pk_mul_f32 v[222:223], v[222:223], v[10:11] op_sel:[0,1] op_sel_hi:[1,1]
v_cvt_pk_bf16_f32 v204, v204, v205
v_cvt_pk_bf16_f32 v205, v206, v207
v_cvt_pk_bf16_f32 v206, v220, v221
v_cvt_pk_bf16_f32 v207, v222, v223
s_nop 1
M v[24:27], a[112:115], v[204:207], v[24:27]
v_pk_mul_f32 v[224:225], v[224:225], v[8:9] op_sel:[0,0] op_sel_hi:[1,0]
v_pk_mul_f32 v[226:227], v[226:227], v[8:9] op_sel:[0,0] op_sel_hi:[1,0]
v_pk_mul_f32 v[240:241], v[240:241], v[8:9] op_sel:[0,0] op_sel_hi:[1,0]
v_pk_mul_f32 v[242:243], v[242:243], v[8:9] op_sel:[0,0] op_sel_hi:[1,0]
v_cvt_pk_bf16_f32 v224, v224, v225
v_cvt_pk_bf16_f32 v225, v226, v227
v_cvt_pk_bf16_f32 v226, v240, v241
v_cvt_pk_bf16_f32 v227, v242, v243
s_nop 1
M v[24:27], a[112:115], v[224:227], v[24:27]
v_pk_mul_f32 v[228:229], v[228:229], v[8:9] op_sel:[0,1] op_sel_hi:[1,1]
v_pk_mul_f32 v[230:231], v[230:231], v[8:9] op_sel:[0,1] op_sel_hi:[1,1]
v_pk_mul_f32 v[244:245], v[244:245], v[8:9] op_sel:[0,1] op_sel_hi:[1,1]
v_pk_mul_f32 v[246:247], v[246:247], v[8:9] op_sel:[0,1] op_sel_hi:[1,1]
v_cvt_pk_bf16_f32 v228, v228, v229
v_cvt_pk_bf16_f32 v229, v230, v231
v_cvt_pk_bf16_f32 v230, v244, v245
v_cvt_pk_bf16_f32 v231, v246, v247
s_nop 1
M v[24:27], a[112:115], v[228:231], v[24:27]
v_pk_mul_f32 v[232:233], v[232:233], v[10:11] op_sel:[0,0] op_sel_hi:[1,0]
v_pk_mul_f32 v[234:235], v[234:235], v[10:11] op_sel:[0,0] op_sel_hi:[1,0]
v_pk_mul_f32 v[248:249], v[248:249], v[10:11] op_sel:[0,0] op_sel_hi:[1,0]
v_pk_mul_f32 v[250:251], v[250:251], v[10:11] op_sel:[0,0] op_sel_hi:[1,0]
v_cvt_pk_bf16_f32 v232, v232, v233
v_cvt_pk_bf16_f32 v233, v234, v235
v_cvt_pk_bf16_f32 v234, v248, v249
v_cvt_pk_bf16_f32 v235, v250, v251
s_nop 1
M v[24:27], a[112:115], v[232:235], v[24:27]
v_pk_mul_f32 v[236:237], v[236:237], v[10:11] op_sel:[0,1] op_sel_hi:[1,1]
v_pk_mul_f32 v[238:239], v[238:239], v[10:11] op_sel:[0,1] op_sel_hi:[1,1]
v_pk_mul_f32 v[252:253], v[252:253], v[10:11] op_sel:[0,1] op_sel_hi:[1,1]
v_pk_mul_f32 v[254:255], v[254:255], v[10:11] op_sel:[0,1] op_sel_hi:[1,1]
v_cvt_pk_bf16_f32 v236, v236, v237
v_cvt_pk_bf16_f32 v237, v238, v239
v_cvt_pk_bf16_f32 v238, v252, v253
v_cvt_pk_bf16_f32 v239, v254, v255
v_accvgpr_read_b32 v176, a64
v_accvgpr_read_b32 v177, a65
v_accvgpr_read_b32 v178, a66
v_accvgpr_read_b32 v179, a67
v_accvgpr_read_b32 v180, a80
v_accvgpr_read_b32 v181, a81
v_accvgpr_read_b32 v182, a82
v_accvgpr_read_b32 v183, a83
M v[24:27], a[112:115], v[236:239], v[24:27]
v_pk_mul_f32 v[176:177], v[176:177], v[8:9] op_sel:[0,0] op_sel_hi:[1,0]
v_pk_mul_f32 v[178:179], v[178:179], v[8:9] op_sel:[0,0] op_sel_hi:[1,0]
v_pk_mul_f32 v[180:181], v[180:181], v[8:9] op_sel:[0,0] op_sel_hi:[1,0]
v_pk_mul_f32 v[182:183], v[182:183], v[8:9] op_sel:[0,0] op_sel_hi:[1,0]
v_cvt_pk_bf16_f32 v176, v176, v177
v_cvt_pk_bf16_f32 v177, v178, v179
v_cvt_pk_bf16_f32 v178, v180, v181
v_cvt_pk_bf16_f32 v179, v182, v183
v_accvgpr_read_b32 v184, a68
v_accvgpr_read_b32 v185, a69
v_accvgpr_read_b32 v186, a70
v_accvgpr_read_b32 v187, a71
v_accvgpr_read_b32 v188, a84
v_accvgpr_read_b32 v189, a85
v_accvgpr_read_b32 v190, a86
v_accvgpr_read_b32 v191, a87
M v[24:27], a[112:115], v[176:179], v[24:27]
v_pk_mul_f32 v[184:185], v[184:185], v[8:9] op_sel:[0,1] op_sel_hi:[1,1]
v_pk_mul_f32 v[186:187], v[186:187], v[8:9] op_sel:[0,1] op_sel_hi:[1,1]
v_pk_mul_f32 v[188:189], v[188:189], v[8:9] op_sel:[0,1] op_sel_hi:[1,1]
v_pk_mul_f32 v[190:191], v[190:191], v[8:9] op_sel:[0,1] op_sel_hi:[1,1]
v_cvt_pk_bf16_f32 v184, v184, v185
v_cvt_pk_bf16_f32 v185, v186, v187
v_cvt_pk_bf16_f32 v186, v188, v189
v_cvt_pk_bf16_f32 v187, v190, v191
v_accvgpr_read_b32 v208, a72
v_accvgpr_read_b32 v209, a73
v_accvgpr_read_b32 v210, a74
v_accvgpr_read_b32 v211, a75
v_accvgpr_read_b32 v212, a88
v_accvgpr_read_b32 v213, a89
v_accvgpr_read_b32 v214, a90
v_accvgpr_read_b32 v215, a91
M v[24:27], a[112:115], v[184:187], v[24:27]
v_pk_mul_f32 v[208:209], v[208:209], v[10:11] op_sel:[0,0] op_sel_hi:[1,0]
v_pk_mul_f32 v[210:211], v[210:211], v[10:11] op_sel:[0,0] op_sel_hi:[1,0]
v_pk_mul_f32 v[212:213], v[212:213], v[10:11] op_sel:[0,0] op_sel_hi:[1,0]
v_pk_mul_f32 v[214:215], v[214:215], v[10:11] op_sel:[0,0] op_sel_hi:[1,0]
v_cvt_pk_bf16_f32 v208, v208, v209
v_cvt_pk_bf16_f32 v209, v210, v211
v_cvt_pk_bf16_f32 v210, v212, v213
v_cvt_pk_bf16_f32 v211, v214, v215
v_accvgpr_read_b32 v216, a76
v_accvgpr_read_b32 v217, a77
v_accvgpr_read_b32 v218, a78
v_accvgpr_read_b32 v219, a79
v_accvgpr_read_b32 v220, a92
v_accvgpr_read_b32 v221, a93
v_accvgpr_read_b32 v222, a94
v_accvgpr_read_b32 v223, a95
M v[24:27], a[112:115], v[208:211], v[24:27]
v_pk_mul_f32 v[216:217], v[216:217], v[10:11] op_sel:[0,1] op_sel_hi:[1,1]
v_pk_mul_f32 v[218:219], v[218:219], v[10:11] op_sel:[0,1] op_sel_hi:[1,1]
v_pk_mul_f32 v[220:221], v[220:221], v[10:11] op_sel:[0,1] op_sel_hi:[1,1]
v_pk_mul_f32 v[222:223], v[222:223], v[10:11] op_sel:[0,1] op_sel_hi:[1,1]
v_cvt_pk_bf16_f32 v216, v216, v217
v_cvt_pk_bf16_f32 v217, v218, v219
v_cvt_pk_bf16_f32 v218, v220, v221
v_cvt_pk_bf16_f32 v219, v222, v223
s_nop 1
M v[24:27], a[112:115], v[216:219], v[24:27]
v_cmp_lt_u32 vcc, 0x3c000000, v12
s_nop 6
v_cmp_class_f32 s[40:41], v24, s64
s_nop 0
s_or_b64 vcc, vcc, s[40:41]
s_cbranch_vccnz Lbad_2
s_lshl_b32 s33, s21, 20
s_lshl_b32 s34, s20, 15
s_add_u32 s33, s33, s34
s_lshl_b32 s34, s23, 13
s_add_u32 s36, s33, s34
s_add_u32 s37, s36, 4096
s_add_u32 s38, s36, 16384
s_add_u32 s39, s36, 20480
buffer_store_dwordx4 v[160:163], v1, s[16:19], s36 offen offset:0 sc1
buffer_store_dwordx4 v[164:167], v1, s[16:19], s36 offen offset:2048 sc1
buffer_store_dwordx4 v[168:171], v1, s[16:19], s37 offen offset:0 sc1
buffer_store_dwordx4 v[172:175], v1, s[16:19], s37 offen offset:2048 sc1
buffer_store_dwordx4 v[192:195], v1, s[16:19], s36 offen offset:1024 sc1
buffer_store_dwordx4 v[196:199], v1, s[16:19], s36 offen offset:3072 sc1
buffer_store_dwordx4 v[200:203], v1, s[16:19], s37 offen offset:1024 sc1
buffer_store_dwordx4 v[204:207], v1, s[16:19], s37 offen offset:3072 sc1
buffer_store_dwordx4 v[224:227], v1, s[16:19], s38 offen offset:0 sc1
buffer_store_dwordx4 v[228:231], v1, s[16:19], s38 offen offset:2048 sc1
buffer_store_dwordx4 v[232:235], v1, s[16:19], s39 offen offset:0 sc1
buffer_store_dwordx4 v[236:239], v1, s[16:19], s39 offen offset:2048 sc1
buffer_store_dwordx4 v[176:179], v1, s[16:19], s38 offen offset:1024 sc1
buffer_store_dwordx4 v[184:187], v1, s[16:19], s38 offen offset:3072 sc1
buffer_store_dwordx4 v[208:211], v1, s[16:19], s39 offen offset:1024 sc1
buffer_store_dwordx4 v[216:219], v1, s[16:19], s39 offen offset:3072 sc1
s_branch Lfd_3
Lbad_2:
s_or_b32 s60, s60, 1
Lfd_3:
s_sub_u32 s30, 7, s21
s_cmp_lg_u32 s30, 0
s_cbranch_scc1 Lk2_b0
s_waitcnt vmcnt(8)
s_waitcnt lgkmcnt(0)
s_barrier
s_and_b32 s3, s2, 3
s_lshl_b32 s3, s3, 2
s_bfe_u32 s27, s2, 0x20003
s_add_u32 s27, s3, s27
s_lshl_b32 s43, s27, 8
s_add_u32 s43, s43, 8400896
v_lshlrev_b32 v15, 2, v0
buffer_load_dword v7, v15, s[52:55], s43 offen sc1
s_lshl_b32 s33, s2, 2
s_add_u32 s33, s33, s22
s_lshl_b32 s34, s33, 11
s_lshl_b32 s33, s33, 13
v_lshlrev_b32 v8, 3, v1
v_lshlrev_b32 v9, 1, v1
buffer_load_dword v5, v8, s[44:47], s33 offen
buffer_load_dword v6, v9, s[48:51], s34 offen
ds_read_b128 a[116:119], v2 offset:32768
ds_read_b128 a[120:123], v2 offset:40960
ds_read_b128 a[124:127], v2 offset:33792
ds_read_b128 a[128:131], v2 offset:41984
ds_read_b128 a[132:135], v2 offset:34816
ds_read_b128 a[136:139], v2 offset:43008
ds_read_b128 a[140:143], v2 offset:35840
ds_read_b128 a[144:147], v2 offset:44032
v_exp_f32 v64, v64
v_exp_f32 v65, v65
v_exp_f32 v66, v66
v_exp_f32 v67, v67
v_exp_f32 v80, v80
v_exp_f32 v81, v81
v_exp_f32 v82, v82
v_exp_f32 v83, v83
v_cvt_pk_bf16_f32 v64, v64, v65
v_cvt_pk_bf16_f32 v65, v66, v67
v_exp_f32 v68, v68
v_exp_f32 v69, v69
v_exp_f32 v70, v70
v_exp_f32 v71, v71
v_cvt_pk_bf16_f32 v66, v80, v81
v_cvt_pk_bf16_f32 v67, v82, v83
v_exp_f32 v84, v84
v_exp_f32 v85, v85
v_exp_f32 v86, v86
v_exp_f32 v87, v87
v_cvt_pk_bf16_f32 v68, v68, v69
v_cvt_pk_bf16_f32 v69, v70, v71
v_exp_f32 v72, v72
v_exp_f32 v73, v73
v_exp_f32 v74, v74
v_exp_f32 v75, v75
v_cvt_pk_bf16_f32 v70, v84, v85
v_cvt_pk_bf16_f32 v71, v86, v87
v_exp_f32 v88, v88
v_exp_f32 v89, v89
v_exp_f32 v90, v90
v_exp_f32 v91, v91
v_cvt_pk_bf16_f32 v72, v72, v73
v_cvt_pk_bf16_f32 v73, v74, v75
v_exp_f32 v76, v76
v_exp_f32 v77, v77
v_exp_f32 v78, v78
v_exp_f32 v79, v79
v_cvt_pk_bf16_f32 v74, v88, v89
v_cvt_pk_bf16_f32 v75, v90, v91
v_exp_f32 v92, v92
v_exp_f32 v93, v93
v_exp_f32 v94, v94
v_exp_f32 v95, v95
v_cvt_pk_bf16_f32 v76, v76, v77
v_cvt_pk_bf16_f32 v77, v78, v79
v_cvt_pk_bf16_f32 v78, v92, v93
v_cvt_pk_bf16_f32 v79, v94, v95
s_waitcnt lgkmcnt(6)
M v[160:163], a[116:119], v[32:35], 0
M v[160:163], a[120:123], v[64:67], v[160:163]
ds_read_b128 a[148:151], v2 offset:36864
ds_read_b128 a[152:155], v2 offset:45056
s_mov_b32 s61, 0
M v[164:167], a[120:123], v[68:71], 0
M v[164:167], a[116:119], v[36:39], v[164:167]
s_bfe_u32 s3, s2, 0x10002
M v[168:171], a[116:119], v[40:43], 0
M v[168:171], a[120:123], v[72:75], v[168:171]
s_lshl_b32 s3, s3, 3
M v[172:175], a[120:123], v[76:79], 0
M v[172:175], a[116:119], v[44:47], v[172:175]
s_waitcnt lgkmcnt(6)
s_lshr_b32 s28, s2, 5
M a[96:99], a[112:115], v[32:35], 0
M a[96:99], a[112:115], v[64:67], a[96:99]
M v[176:179], a[124:127], v[32:35], 0
M v[176:179], a[128:131], v[64:67], v[176:179]
ds_read_b128 a[156:159], v2 offset:37888
ds_read_b128 a[160:163], v2 offset:46080
s_add_u32 s28, s3, s28
M v[180:183], a[128:131], v[68:71], 0
s_lshl_b32 s25, s27, 18
M v[180:183], a[124:127], v[36:39], v[180:183]
M v[184:187], a[124:127], v[40:43], 0
s_lshl_b32 s3, s101, 12
M v[184:187], a[128:131], v[72:75], v[184:187]
M v[188:191], a[128:131], v[76:79], 0
s_add_u32 s25, s25, s3
M v[188:191], a[124:127], v[44:47], v[188:191]
s_waitcnt lgkmcnt(6)
M a[100:103], a[112:115], v[36:39], 0
M a[100:103], a[112:115], v[68:71], a[100:103]
M v[192:195], a[132:135], v[32:35], 0
s_lshl_b32 s26, s28, 7
M v[192:195], a[136:139], v[64:67], v[192:195]
ds_read_b128 a[164:167], v2 offset:38912
ds_read_b128 a[168:171], v2 offset:47104
M v[196:199], a[136:139], v[68:71], 0
s_lshl_b32 s42, s101, 11
M v[196:199], a[132:135], v[36:39], v[196:199]
M v[200:203], a[132:135], v[40:43], 0
s_add_u32 s44, s4, 83886080
s_addc_u32 s45, s5, 0
M v[200:203], a[136:139], v[72:75], v[200:203]
s_mov_b32 s46, 4194304
M v[204:207], a[136:139], v[76:79], 0
M v[204:207], a[132:135], v[44:47], v[204:207]
s_waitcnt lgkmcnt(6)
s_mov_b32 s47, 0x00020000
M a[104:107], a[112:115], v[40:43], 0
M a[104:107], a[112:115], v[72:75], a[104:107]
M v[208:211], a[140:143], v[32:35], 0
M v[208:211], a[144:147], v[64:67], v[208:211]
ds_read_b128 a[172:175], v2 offset:39936
ds_read_b128 a[176:179], v2 offset:48128
s_mov_b32 s50, 2097152
M v[212:215], a[144:147], v[68:71], 0
M v[212:215], a[140:143], v[36:39], v[212:215]
s_mov_b32 s51, 0x00020000
M v[216:219], a[140:143], v[40:43], 0
M v[216:219], a[144:147], v[72:75], v[216:219]
s_lshl_b32 s3, s101, 4
M v[220:223], a[144:147], v[76:79], 0
M v[220:223], a[140:143], v[44:47], v[220:223]
s_waitcnt lgkmcnt(6)
v_lshrrev_b32 v96, 3, v0
M a[108:111], a[112:115], v[44:47], 0
M a[108:111], a[112:115], v[76:79], a[108:111]
M v[224:227], a[148:151], v[32:35], 0
v_and_b32 v97, 6, v96
M v[224:227], a[152:155], v[64:67], v[224:227]
M v[228:231], a[152:155], v[68:71], 0
v_and_b32 v98, 7, v0
M v[228:231], a[148:151], v[36:39], v[228:231]
M v[232:235], a[148:151], v[40:43], 0
v_xor_b32 v97, v97, v98
M v[232:235], a[152:155], v[72:75], v[232:235]
M v[236:239], a[152:155], v[76:79], 0
v_add_u32 v96, s3, v96
M v[236:239], a[148:151], v[44:47], v[236:239]
s_waitcnt lgkmcnt(4)
M v[240:243], a[156:159], v[32:35], 0
v_lshlrev_b32 v96, 11, v96
M v[240:243], a[160:163], v[64:67], v[240:243]
M v[244:247], a[160:163], v[68:71], 0
v_lshl_add_u32 v99, v97, 4, v96
M v[244:247], a[156:159], v[36:39], v[244:247]
v_add_u32 v100, 15360, v99
M v[248:251], a[156:159], v[40:43], 0
M v[248:251], a[160:163], v[72:75], v[248:251]
s_waitcnt vmcnt(2) lgkmcnt(0)
s_barrier
v_cmp_ne_u32 vcc, 1, v7
s_nop 0
s_cbranch_vccnz Lk3_spinb1
Lk3_gotb1:
M v[252:255], a[160:163], v[76:79], 0
s_add_u32 m0, s42, 65536
s_nop 0
buffer_load_dwordx4 v99, s[48:51], s26 offen offset:0 lds
buffer_load_dwordx4 v100, s[48:51], s26 offen offset:1024 lds
M v[252:255], a[156:159], v[44:47], v[252:255]
buffer_load_dwordx4 a[192:195], v1, s[44:47], s25 offen offset:0 sc1
buffer_load_dwordx4 a[196:199], v1, s[44:47], s25 offen offset:1024 sc1
M a[64:67], a[164:167], v[32:35], 0
buffer_load_dwordx4 a[200:203], v1, s[44:47], s25 offen offset:2048 sc1
buffer_load_dwordx4 a[204:207], v1, s[44:47], s25 offen offset:3072 sc1
M a[64:67], a[168:171], v[64:67], a[64:67]
s_add_u32 s25, s25, 16384
s_add_u32 s26, s26, 131072
s_add_u32 m0, s42, 81920
s_nop 0
buffer_load_dwordx4 v99, s[48:51], s26 offen offset:0 lds
M a[68:71], a[168:171], v[68:71], 0
buffer_load_dwordx4 v100, s[48:51], s26 offen offset:1024 lds
buffer_load_dwordx4 a[208:211], v1, s[44:47], s25 offen offset:0 sc1
M a[68:71], a[164:167], v[36:39], a[68:71]
buffer_load_dwordx4 a[212:215], v1, s[44:47], s25 offen offset:1024 sc1
buffer_load_dwordx4 a[216:219], v1, s[44:47], s25 offen offset:2048 sc1
M a[72:75], a[164:167], v[40:43], 0
buffer_load_dwordx4 a[220:223], v1, s[44:47], s25 offen offset:3072 sc1
s_add_u32 s25, s25, 16384
s_add_u32 s26, s26, 131072
M a[72:75], a[168:171], v[72:75], a[72:75]
s_add_u32 m0, s42, 98304
s_nop 0
buffer_load_dwordx4 v99, s[48:51], s26 offen offset:0 lds
buffer_load_dwordx4 v100, s[48:51], s26 offen offset:1024 lds
M a[76:79], a[168:171], v[76:79], 0
buffer_load_dwordx4 a[224:227], v1, s[44:47], s25 offen offset:0 sc1
M a[76:79], a[164:167], v[44:47], a[76:79]
buffer_load_dwordx4 a[228:231], v1, s[44:47], s25 offen offset:1024 sc1
buffer_load_dwordx4 a[232:235], v1, s[44:47], s25 offen offset:2048 sc1
M a[80:83], a[172:175], v[32:35], 0
buffer_load_dwordx4 a[236:239], v1, s[44:47], s25 offen offset:3072 sc1
s_add_u32 s25, s25, 16384
s_add_u32 s26, s26, 131072
M a[80:83], a[176:179], v[64:67], a[80:83]
s_add_u32 m0, s42, 114688
s_nop 0
buffer_load_dwordx4 v99, s[48:51], s26 offen offset:0 lds
buffer_load_dwordx4 v100, s[48:51], s26 offen offset:1024 lds
M a[84:87], a[176:179], v[68:71], 0
buffer_load_dwordx4 a[240:243], v1, s[44:47], s25 offen offset:0 sc1
buffer_load_dwordx4 a[244:247], v1, s[44:47], s25 offen offset:1024 sc1
M a[84:87], a[172:175], v[36:39], a[84:87]
buffer_load_dwordx4 a[248:251], v1, s[44:47], s25 offen offset:2048 sc1
buffer_load_dwordx4 a[252:255], v1, s[44:47], s25 offen offset:3072 sc1
M a[88:91], a[172:175], v[40:43], 0
s_add_u32 s25, s25, 16384
s_add_u32 s26, s26, 131072
s_add_u32 m0, s42, 0
s_nop 0
buffer_load_dwordx4 v99, s[48:51], s26 offen offset:0 lds
M a[88:91], a[176:179], v[72:75], a[88:91]
buffer_load_dwordx4 v100, s[48:51], s26 offen offset:1024 lds
buffer_load_dwordx4 a[128:131], v1, s[44:47], s25 offen offset:0 sc1
M a[92:95], a[176:179], v[76:79], 0
buffer_load_dwordx4 a[132:135], v1, s[44:47], s25 offen offset:1024 sc1
buffer_load_dwordx4 a[136:139], v1, s[44:47], s25 offen offset:2048 sc1
M a[92:95], a[172:175], v[44:47], a[92:95]
buffer_load_dwordx4 a[140:143], v1, s[44:47], s25 offen offset:3072 sc1
s_add_u32 s25, s25, 16384
s_add_u32 s26, s26, 131072
s_branch Lk2_merge
Lk2_b0:
s_waitcnt lgkmcnt(4)
s_add_u32 m0, s29, 98304
M v[96:99], a[116:119], a[180:183], 0
v_exp_f32 v64, v64
M v[96:99], a[120:123], a[184:187], v[96:99]
ds_read_b128 a[148:151], v2 offset:8192
ds_read_b128 a[152:155], v2 offset:9216
M v[96:99], a[124:127], a[188:191], v[96:99]
v_exp_f32 v65, v65
M v[96:99], a[128:131], a[192:195], v[96:99]
buffer_load_dwordx4 v1, s[12:15], s26 offen offset:0 sc1 lds
s_add_u32 s32, s26, 4096
M v[100:103], a[128:131], a[208:211], 0
v_exp_f32 v66, v66
M v[100:103], a[124:127], a[204:207], v[100:103]
v_cvt_pk_bf16_f32 v64, v64, v65
M v[100:103], a[120:123], a[200:203], v[100:103]
v_exp_f32 v67, v67
M v[100:103], a[116:119], a[196:199], v[100:103]
buffer_load_dwordx4 v1, s[12:15], s26 offen offset:1024 sc1 lds
M v[104:107], a[116:119], a[212:215], 0
v_exp_f32 v80, v80
M v[104:107], a[120:123], a[216:219], v[104:107]
ds_read_b128 a[156:159], v2 offset:10240
ds_read_b128 a[160:163], v2 offset:11264
M v[104:107], a[124:127], a[220:223], v[104:107]
v_exp_f32 v81, v81
M v[104:107], a[128:131], a[224:227], v[104:107]
buffer_load_dwordx4 v1, s[12:15], s26 offen offset:2048 sc1 lds
M v[108:111], a[128:131], a[240:243], 0
v_exp_f32 v82, v82
M v[108:111], a[124:127], a[236:239], v[108:111]
v_cvt_pk_bf16_f32 v65, v66, v67
v_cvt_pk_bf16_f32 v66, v80, v81
M v[108:111], a[120:123], a[232:235], v[108:111]
v_exp_f32 v83, v83
M v[108:111], a[116:119], a[228:231], v[108:111]
buffer_load_dwordx4 v1, s[12:15], s26 offen offset:3072 sc1 lds
s_add_u32 m0, s29, 102400
s_waitcnt lgkmcnt(4)
M v[112:115], a[132:135], a[180:183], 0
v_exp_f32 v68, v68
M v[112:115], a[136:139], a[184:187], v[112:115]
ds_read_b128 a[164:167], v2 offset:12288
ds_read_b128 a[168:171], v2 offset:13312
M v[112:115], a[140:143], a[188:191], v[112:115]
v_exp_f32 v69, v69
M v[112:115], a[144:147], a[192:195], v[112:115]
buffer_load_dwordx4 v1, s[12:15], s32 offen offset:0 sc1 lds
M v[116:119], a[144:147], a[208:211], 0
v_exp_f32 v70, v70
M v[116:119], a[140:143], a[204:207], v[116:119]
v_cvt_pk_bf16_f32 v67, v82, v83
v_cvt_pk_bf16_f32 v68, v68, v69
M v[116:119], a[136:139], a[200:203], v[116:119]
v_exp_f32 v71, v71
M v[116:119], a[132:135], a[196:199], v[116:119]
buffer_load_dwordx4 v1, s[12:15], s32 offen offset:1024 sc1 lds
M v[120:123], a[132:135], a[212:215], 0
v_exp_f32 v84, v84
M v[120:123], a[136:139], a[216:219], v[120:123]
ds_read_b128 a[172:175], v2 offset:14336
ds_read_b128 a[176:179], v2 offset:15360
M v[120:123], a[140:143], a[220:223], v[120:123]
v_exp_f32 v85, v85
M v[120:123], a[144:147], a[224:227], v[120:123]
buffer_load_dwordx4 v1, s[12:15], s32 offen offset:2048 sc1 lds
M v[124:127], a[144:147], a[240:243], 0
v_exp_f32 v86, v86
M v[124:127], a[140:143], a[236:239], v[124:127]
v_cvt_pk_bf16_f32 v69, v70, v71
v_cvt_pk_bf16_f32 v70, v84, v85
M v[124:127], a[136:139], a[232:235], v[124:127]
v_exp_f32 v87, v87
M v[124:127], a[132:135], a[228:231], v[124:127]
buffer_load_dwordx4 v1, s[12:15], s32 offen offset:3072 sc1 lds
s_waitcnt lgkmcnt(4)
M v[128:131], a[148:151], a[180:183], 0
v_exp_f32 v72, v72
M v[128:131], a[152:155], a[184:187], v[128:131]
s_add_u32 s26, s26, 32768
s_cmp_eq_u32 s26, s62
s_cselect_b32 s26, s63, s26
s_cselect_b32 s62, -1, s62
M v[128:131], a[156:159], a[188:191], v[128:131]
v_exp_f32 v73, v73
M v[128:131], a[160:163], a[192:195], v[128:131]
v_cvt_pk_bf16_f32 v71, v86, v87
v_cvt_pk_bf16_f32 v72, v72, v73
M v[132:135], a[160:163], a[208:211], 0
v_exp_f32 v74, v74
M v[132:135], a[156:159], a[204:207], v[132:135]
M v[132:135], a[152:155], a[200:203], v[132:135]
v_exp_f32 v75, v75
M v[132:135], a[148:151], a[196:199], v[132:135]
v_cvt_pk_bf16_f32 v73, v74, v75
M v[136:139], a[148:151], a[212:215], 0
v_exp_f32 v88, v88
M v[136:139], a[152:155], a[216:219], v[136:139]
M v[136:139], a[156:159], a[220:223], v[136:139]
v_exp_f32 v89, v89
M v[136:139], a[160:163], a[224:227], v[136:139]
v_cvt_pk_bf16_f32 v74, v88, v89
M v[140:143], a[160:163], a[240:243], 0
v_exp_f32 v90, v90
M v[140:143], a[156:159], a[236:239], v[140:143]
s_waitcnt vmcnt(16) lgkmcnt(0)
s_barrier
ds_read_b128 a[116:119], v2 offset:32768
ds_read_b128 a[120:123], v2 offset:40960
ds_read_b128 a[124:127], v2 offset:33792
ds_read_b128 a[128:131], v2 offset:41984
M v[140:143], a[152:155], a[232:235], v[140:143]
v_exp_f32 v91, v91
M v[140:143], a[148:151], a[228:231], v[140:143]
v_cvt_pk_bf16_f32 v75, v90, v91
M v[144:147], a[164:167], a[180:183], 0
v_exp_f32 v76, v76
M v[144:147], a[168:171], a[184:187], v[144:147]
ds_read_b128 a[132:135], v2 offset:34816
ds_read_b128 a[136:139], v2 offset:43008
M v[144:147], a[172:175], a[188:191], v[144:147]
v_exp_f32 v77, v77
M v[144:147], a[176:179], a[192:195], v[144:147]
v_cvt_pk_bf16_f32 v76, v76, v77
M v[148:151], a[176:179], a[208:211], 0
v_exp_f32 v78, v78
M v[148:151], a[172:175], a[204:207], v[148:151]
M v[148:151], a[168:171], a[200:203], v[148:151]
v_exp_f32 v79, v79
M v[148:151], a[164:167], a[196:199], v[148:151]
v_cvt_pk_bf16_f32 v77, v78, v79
M v[152:155], a[164:167], a[212:215], 0
v_exp_f32 v92, v92
M v[152:155], a[168:171], a[216:219], v[152:155]
ds_read_b128 a[140:143], v2 offset:35840
ds_read_b128 a[144:147], v2 offset:44032
M v[152:155], a[172:175], a[220:223], v[152:155]
v_exp_f32 v93, v93
M v[152:155], a[176:179], a[224:227], v[152:155]
v_cvt_pk_bf16_f32 v78, v92, v93
M v[156:159], a[176:179], a[240:243], 0
v_exp_f32 v94, v94
M v[156:159], a[172:175], a[236:239], v[156:159]
M v[156:159], a[168:171], a[232:235], v[156:159]
v_exp_f32 v95, v95
M v[156:159], a[164:167], a[228:231], v[156:159]
v_cvt_pk_bf16_f32 v79, v94, v95
s_waitcnt lgkmcnt(6)
s_add_u32 m0, s29, 0
M v[160:163], a[116:119], v[32:35], 0
v_exp_f32 v96, v96
M v[160:163], a[120:123], v[64:67], v[160:163]
ds_read_b128 a[148:151], v2 offset:36864
ds_read_b128 a[152:155], v2 offset:45056
M v[164:167], a[120:123], v[68:71], 0
v_exp_f32 v97, v97
M v[164:167], a[116:119], v[36:39], v[164:167]
buffer_load_dwordx4 v1, s[12:15], s25 offen offset:0 sc1 lds
s_add_u32 s32, s25, 4096
M v[168:171], a[116:119], v[40:43], 0
v_exp_f32 v98, v98
M v[168:171], a[120:123], v[72:75], v[168:171]
v_cvt_pk_bf16_f32 v96, v96, v97
M v[172:175], a[120:123], v[76:79], 0
v_exp_f32 v99, v99
M v[172:175], a[116:119], v[44:47], v[172:175]
buffer_load_dwordx4 v1, s[12:15], s25 offen offset:1024 sc1 lds
s_waitcnt lgkmcnt(6)
M a[96:99], a[112:115], v[32:35], 0
M a[96:99], a[112:115], v[64:67], a[96:99]
M v[176:179], a[124:127], v[32:35], 0
v_exp_f32 v112, v112
M v[176:179], a[128:131], v[64:67], v[176:179]
ds_read_b128 a[156:159], v2 offset:37888
ds_read_b128 a[160:163], v2 offset:46080
M v[180:183], a[128:131], v[68:71], 0
v_exp_f32 v113, v113
M v[180:183], a[124:127], v[36:39], v[180:183]
buffer_load_dwordx4 v1, s[12:15], s25 offen offset:2048 sc1 lds
M v[184:187], a[124:127], v[40:43], 0
v_exp_f32 v114, v114
M v[184:187], a[128:131], v[72:75], v[184:187]
v_cvt_pk_bf16_f32 v97, v98, v99
v_cvt_pk_bf16_f32 v98, v112, v113
M v[188:191], a[128:131], v[76:79], 0
v_exp_f32 v115, v115
M v[188:191], a[124:127], v[44:47], v[188:191]
buffer_load_dwordx4 v1, s[12:15], s25 offen offset:3072 sc1 lds
s_add_u32 m0, s29, 4096
s_waitcnt lgkmcnt(6)
M a[100:103], a[112:115], v[36:39], 0
M a[100:103], a[112:115], v[68:71], a[100:103]
M v[192:195], a[132:135], v[32:35], 0
v_exp_f32 v100, v100
M v[192:195], a[136:139], v[64:67], v[192:195]
ds_read_b128 a[164:167], v2 offset:38912
ds_read_b128 a[168:171], v2 offset:47104
M v[196:199], a[136:139], v[68:71], 0
v_exp_f32 v101, v101
M v[196:199], a[132:135], v[36:39], v[196:199]
buffer_load_dwordx4 v1, s[12:15], s32 offen offset:0 sc1 lds
M v[200:203], a[132:135], v[40:43], 0
v_exp_f32 v102, v102
M v[200:203], a[136:139], v[72:75], v[200:203]
v_cvt_pk_bf16_f32 v99, v114, v115
v_cvt_pk_bf16_f32 v100, v100, v101
M v[204:207], a[136:139], v[76:79], 0
v_exp_f32 v103, v103
M v[204:207], a[132:135], v[44:47], v[204:207]
buffer_load_dwordx4 v1, s[12:15], s32 offen offset:1024 sc1 lds
s_waitcnt lgkmcnt(6)
M a[104:107], a[112:115], v[40:43], 0
M a[104:107], a[112:115], v[72:75], a[104:107]
M v[208:211], a[140:143], v[32:35], 0
v_exp_f32 v116, v116
M v[208:211], a[144:147], v[64:67], v[208:211]
ds_read_b128 a[172:175], v2 offset:39936
ds_read_b128 a[176:179], v2 offset:48128
M v[212:215], a[144:147], v[68:71], 0
v_exp_f32 v117, v117
M v[212:215], a[140:143], v[36:39], v[212:215]
buffer_load_dwordx4 v1, s[12:15], s32 offen offset:2048 sc1 lds
M v[216:219], a[140:143], v[40:43], 0
v_exp_f32 v118, v118
M v[216:219], a[144:147], v[72:75], v[216:219]
v_cvt_pk_bf16_f32 v101, v102, v103
v_cvt_pk_bf16_f32 v102, v116, v117
M v[220:223], a[144:147], v[76:79], 0
v_exp_f32 v119, v119
M v[220:223], a[140:143], v[44:47], v[220:223]
buffer_load_dwordx4 v1, s[12:15], s32 offen offset:3072 sc1 lds
s_waitcnt lgkmcnt(6)
M a[108:111], a[112:115], v[44:47], 0
M a[108:111], a[112:115], v[76:79], a[108:111]
M v[224:227], a[148:151], v[32:35], 0
v_exp_f32 v104, v104
M v[224:227], a[152:155], v[64:67], v[224:227]
s_add_u32 s25, s25, 32768
s_cmp_eq_u32 s25, s27
s_cselect_b32 s25, s28, s25
s_cselect_b32 s27, -1, s27
M v[228:231], a[152:155], v[68:71], 0
v_exp_f32 v105, v105
M v[228:231], a[148:151], v[36:39], v[228:231]
v_cvt_pk_bf16_f32 v103, v118, v119
v_cvt_pk_bf16_f32 v104, v104, v105
M v[232:235], a[148:151], v[40:43], 0
v_exp_f32 v106, v106
M v[232:235], a[152:155], v[72:75], v[232:235]
M v[236:239], a[152:155], v[76:79], 0
v_exp_f32 v107, v107
M v[236:239], a[148:151], v[44:47], v[236:239]
v_cvt_pk_bf16_f32 v105, v106, v107
s_waitcnt lgkmcnt(4)
M v[240:243], a[156:159], v[32:35], 0
v_exp_f32 v120, v120
M v[240:243], a[160:163], v[64:67], v[240:243]
M v[244:247], a[160:163], v[68:71], 0
v_exp_f32 v121, v121
M v[244:247], a[156:159], v[36:39], v[244:247]
v_cvt_pk_bf16_f32 v106, v120, v121
M v[248:251], a[156:159], v[40:43], 0
v_exp_f32 v122, v122
M v[248:251], a[160:163], v[72:75], v[248:251]
s_waitcnt vmcnt(16) lgkmcnt(0)
s_barrier
ds_read_b128 a[116:119], v3 offset:0
ds_read_b128 a[120:123], v3 offset:1024
ds_read_b128 a[124:127], v3 offset:2048
ds_read_b128 a[128:131], v3 offset:3072
M v[252:255], a[160:163], v[76:79], 0
v_exp_f32 v123, v123
M v[252:255], a[156:159], v[44:47], v[252:255]
v_cvt_pk_bf16_f32 v107, v122, v123
M a[64:67], a[164:167], v[32:35], 0
v_exp_f32 v108, v108
M a[64:67], a[168:171], v[64:67], a[64:67]
ds_read_b128 a[132:135], v3 offset:4096
ds_read_b128 a[136:139], v3 offset:5120
M a[68:71], a[168:171], v[68:71], 0
v_exp_f32 v109, v109
M a[68:71], a[164:167], v[36:39], a[68:71]
v_cvt_pk_bf16_f32 v108, v108, v109
M a[72:75], a[164:167], v[40:43], 0
v_exp_f32 v110, v110
M a[72:75], a[168:171], v[72:75], a[72:75]
M a[76:79], a[168:171], v[76:79], 0
v_exp_f32 v111, v111
M a[76:79], a[164:167], v[44:47], a[76:79]
v_cvt_pk_bf16_f32 v109, v110, v111
M a[80:83], a[172:175], v[32:35], 0
v_exp_f32 v124, v124
M a[80:83], a[176:179], v[64:67], a[80:83]
ds_read_b128 a[140:143], v3 offset:6144
ds_read_b128 a[144:147], v3 offset:7168
M a[84:87], a[176:179], v[68:71], 0
v_exp_f32 v125, v125
M a[84:87], a[172:175], v[36:39], a[84:87]
v_cvt_pk_bf16_f32 v110, v124, v125
M a[88:91], a[172:175], v[40:43], 0
v_exp_f32 v126, v126
M a[88:91], a[176:179], v[72:75], a[88:91]
M a[92:95], a[176:179], v[76:79], 0
v_exp_f32 v127, v127
M a[92:95], a[172:175], v[44:47], a[92:95]
v_cvt_pk_bf16_f32 v111, v126, v127
s_branch Lk2_l2b
Lk2_l2:
s_waitcnt lgkmcnt(4)
s_add_u32 m0, s29, 98304
M v[96:99], a[116:119], a[180:183], 0
v_exp_f32 v64, v64
M v[96:99], a[120:123], a[184:187], v[96:99]
ds_read_b128 a[148:151], v2 offset:8192
ds_read_b128 a[152:155], v2 offset:9216
M v[96:99], a[124:127], a[188:191], v[96:99]
v_exp_f32 v65, v65
M v[96:99], a[128:131], a[192:195], v[96:99]
buffer_load_dwordx4 v1, s[12:15], s26 offen offset:0 sc1 lds
s_add_u32 s32, s26, 4096
M v[100:103], a[128:131], a[208:211], 0
v_exp_f32 v66, v66
M v[100:103], a[124:127], a[204:207], v[100:103]
v_cvt_pk_bf16_f32 v64, v64, v65
M v[100:103], a[120:123], a[200:203], v[100:103]
v_exp_f32 v67, v67
M v[100:103], a[116:119], a[196:199], v[100:103]
buffer_load_dwordx4 v1, s[12:15], s26 offen offset:1024 sc1 lds
M v[104:107], a[116:119], a[212:215], 0
v_exp_f32 v80, v80
M v[104:107], a[120:123], a[216:219], v[104:107]
ds_read_b128 a[156:159], v2 offset:10240
ds_read_b128 a[160:163], v2 offset:11264
M v[104:107], a[124:127], a[220:223], v[104:107]
v_exp_f32 v81, v81
M v[104:107], a[128:131], a[224:227], v[104:107]
buffer_load_dwordx4 v1, s[12:15], s26 offen offset:2048 sc1 lds
M v[108:111], a[128:131], a[240:243], 0
v_exp_f32 v82, v82
M v[108:111], a[124:127], a[236:239], v[108:111]
v_cvt_pk_bf16_f32 v65, v66, v67
v_cvt_pk_bf16_f32 v66, v80, v81
M v[108:111], a[120:123], a[232:235], v[108:111]
v_exp_f32 v83, v83
M v[108:111], a[116:119], a[228:231], v[108:111]
buffer_load_dwordx4 v1, s[12:15], s26 offen offset:3072 sc1 lds
s_add_u32 m0, s29, 102400
s_waitcnt lgkmcnt(4)
M v[112:115], a[132:135], a[180:183], 0
v_exp_f32 v68, v68
M v[112:115], a[136:139], a[184:187], v[112:115]
ds_read_b128 a[164:167], v2 offset:12288
ds_read_b128 a[168:171], v2 offset:13312
M v[112:115], a[140:143], a[188:191], v[112:115]
v_exp_f32 v69, v69
M v[112:115], a[144:147], a[192:195], v[112:115]
buffer_load_dwordx4 v1, s[12:15], s32 offen offset:0 sc1 lds
M v[116:119], a[144:147], a[208:211], 0
v_exp_f32 v70, v70
M v[116:119], a[140:143], a[204:207], v[116:119]
v_cvt_pk_bf16_f32 v67, v82, v83
v_cvt_pk_bf16_f32 v68, v68, v69
M v[116:119], a[136:139], a[200:203], v[116:119]
v_exp_f32 v71, v71
M v[116:119], a[132:135], a[196:199], v[116:119]
buffer_load_dwordx4 v1, s[12:15], s32 offen offset:1024 sc1 lds
M v[120:123], a[132:135], a[212:215], 0
v_exp_f32 v84, v84
M v[120:123], a[136:139], a[216:219], v[120:123]
ds_read_b128 a[172:175], v2 offset:14336
ds_read_b128 a[176:179], v2 offset:15360
M v[120:123], a[140:143], a[220:223], v[120:123]
v_exp_f32 v85, v85
M v[120:123], a[144:147], a[224:227], v[120:123]
buffer_load_dwordx4 v1, s[12:15], s32 offen offset:2048 sc1 lds
M v[124:127], a[144:147], a[240:243], 0
v_exp_f32 v86, v86
M v[124:127], a[140:143], a[236:239], v[124:127]
v_cvt_pk_bf16_f32 v69, v70, v71
v_cvt_pk_bf16_f32 v70, v84, v85
M v[124:127], a[136:139], a[232:235], v[124:127]
v_exp_f32 v87, v87
M v[124:127], a[132:135], a[228:231], v[124:127]
buffer_load_dwordx4 v1, s[12:15], s32 offen offset:3072 sc1 lds
s_waitcnt lgkmcnt(4)
M v[128:131], a[148:151], a[180:183], 0
v_exp_f32 v72, v72
M v[128:131], a[152:155], a[184:187], v[128:131]
s_add_u32 s26, s26, 32768
s_cmp_eq_u32 s26, s62
s_cselect_b32 s26, s63, s26
s_cselect_b32 s62, -1, s62
M v[128:131], a[156:159], a[188:191], v[128:131]
v_exp_f32 v73, v73
M v[128:131], a[160:163], a[192:195], v[128:131]
v_cvt_pk_bf16_f32 v71, v86, v87
v_cvt_pk_bf16_f32 v72, v72, v73
M v[132:135], a[160:163], a[208:211], 0
v_exp_f32 v74, v74
M v[132:135], a[156:159], a[204:207], v[132:135]
M v[132:135], a[152:155], a[200:203], v[132:135]
v_exp_f32 v75, v75
M v[132:135], a[148:151], a[196:199], v[132:135]
v_cvt_pk_bf16_f32 v73, v74, v75
M v[136:139], a[148:151], a[212:215], 0
v_exp_f32 v88, v88
M v[136:139], a[152:155], a[216:219], v[136:139]
M v[136:139], a[156:159], a[220:223], v[136:139]
v_exp_f32 v89, v89
M v[136:139], a[160:163], a[224:227], v[136:139]
v_cvt_pk_bf16_f32 v74, v88, v89
M v[140:143], a[160:163], a[240:243], 0
v_exp_f32 v90, v90
M v[140:143], a[156:159], a[236:239], v[140:143]
s_waitcnt vmcnt(16) lgkmcnt(0)
s_barrier
ds_read_b128 a[116:119], v2 offset:32768
ds_read_b128 a[120:123], v2 offset:40960
ds_read_b128 a[124:127], v2 offset:33792
ds_read_b128 a[128:131], v2 offset:41984
M v[140:143], a[152:155], a[232:235], v[140:143]
v_exp_f32 v91, v91
M v[140:143], a[148:151], a[228:231], v[140:143]
v_cvt_pk_bf16_f32 v75, v90, v91
M v[144:147], a[164:167], a[180:183], 0
v_exp_f32 v76, v76
M v[144:147], a[168:171], a[184:187], v[144:147]
ds_read_b128 a[132:135], v2 offset:34816
ds_read_b128 a[136:139], v2 offset:43008
M v[144:147], a[172:175], a[188:191], v[144:147]
v_exp_f32 v77, v77
M v[144:147], a[176:179], a[192:195], v[144:147]
v_cvt_pk_bf16_f32 v76, v76, v77
M v[148:151], a[176:179], a[208:211], 0
v_exp_f32 v78, v78
M v[148:151], a[172:175], a[204:207], v[148:151]
M v[148:151], a[168:171], a[200:203], v[148:151]
v_exp_f32 v79, v79
M v[148:151], a[164:167], a[196:199], v[148:151]
v_cvt_pk_bf16_f32 v77, v78, v79
M v[152:155], a[164:167], a[212:215], 0
v_exp_f32 v92, v92
M v[152:155], a[168:171], a[216:219], v[152:155]
ds_read_b128 a[140:143], v2 offset:35840
ds_read_b128 a[144:147], v2 offset:44032
M v[152:155], a[172:175], a[220:223], v[152:155]
v_exp_f32 v93, v93
M v[152:155], a[176:179], a[224:227], v[152:155]
v_cvt_pk_bf16_f32 v78, v92, v93
M v[156:159], a[176:179], a[240:243], 0
v_exp_f32 v94, v94
M v[156:159], a[172:175], a[236:239], v[156:159]
M v[156:159], a[168:171], a[232:235], v[156:159]
v_exp_f32 v95, v95
M v[156:159], a[164:167], a[228:231], v[156:159]
v_cvt_pk_bf16_f32 v79, v94, v95
s_waitcnt lgkmcnt(6)
s_add_u32 m0, s29, 0
M v[160:163], a[116:119], v[32:35], v[160:163]
v_exp_f32 v96, v96
M v[160:163], a[120:123], v[64:67], v[160:163]
ds_read_b128 a[148:151], v2 offset:36864
ds_read_b128 a[152:155], v2 offset:45056
M v[164:167], a[120:123], v[68:71], v[164:167]
v_exp_f32 v97, v97
M v[164:167], a[116:119], v[36:39], v[164:167]
buffer_load_dwordx4 v1, s[12:15], s25 offen offset:0 sc1 lds
s_add_u32 s32, s25, 4096
M v[168:171], a[116:119], v[40:43], v[168:171]
v_exp_f32 v98, v98
M v[168:171], a[120:123], v[72:75], v[168:171]
v_cvt_pk_bf16_f32 v96, v96, v97
M v[172:175], a[120:123], v[76:79], v[172:175]
v_exp_f32 v99, v99
M v[172:175], a[116:119], v[44:47], v[172:175]
buffer_load_dwordx4 v1, s[12:15], s25 offen offset:1024 sc1 lds
s_waitcnt lgkmcnt(6)
M a[96:99], a[112:115], v[32:35], a[96:99]
M a[96:99], a[112:115], v[64:67], a[96:99]
M v[176:179], a[124:127], v[32:35], v[176:179]
v_exp_f32 v112, v112
M v[176:179], a[128:131], v[64:67], v[176:179]
ds_read_b128 a[156:159], v2 offset:37888
ds_read_b128 a[160:163], v2 offset:46080
M v[180:183], a[128:131], v[68:71], v[180:183]
v_exp_f32 v113, v113
M v[180:183], a[124:127], v[36:39], v[180:183]
buffer_load_dwordx4 v1, s[12:15], s25 offen offset:2048 sc1 lds
M v[184:187], a[124:127], v[40:43], v[184:187]
v_exp_f32 v114, v114
M v[184:187], a[128:131], v[72:75], v[184:187]
v_cvt_pk_bf16_f32 v97, v98, v99
v_cvt_pk_bf16_f32 v98, v112, v113
M v[188:191], a[128:131], v[76:79], v[188:191]
v_exp_f32 v115, v115
M v[188:191], a[124:127], v[44:47], v[188:191]
buffer_load_dwordx4 v1, s[12:15], s25 offen offset:3072 sc1 lds
s_add_u32 m0, s29, 4096
s_waitcnt lgkmcnt(6)
M a[100:103], a[112:115], v[36:39], a[100:103]
M a[100:103], a[112:115], v[68:71], a[100:103]
M v[192:195], a[132:135], v[32:35], v[192:195]
v_exp_f32 v100, v100
M v[192:195], a[136:139], v[64:67], v[192:195]
ds_read_b128 a[164:167], v2 offset:38912
ds_read_b128 a[168:171], v2 offset:47104
M v[196:199], a[136:139], v[68:71], v[196:199]
v_exp_f32 v101, v101
M v[196:199], a[132:135], v[36:39], v[196:199]
buffer_load_dwordx4 v1, s[12:15], s32 offen offset:0 sc1 lds
M v[200:203], a[132:135], v[40:43], v[200:203]
v_exp_f32 v102, v102
M v[200:203], a[136:139], v[72:75], v[200:203]
v_cvt_pk_bf16_f32 v99, v114, v115
v_cvt_pk_bf16_f32 v100, v100, v101
M v[204:207], a[136:139], v[76:79], v[204:207]
v_exp_f32 v103, v103
M v[204:207], a[132:135], v[44:47], v[204:207]
buffer_load_dwordx4 v1, s[12:15], s32 offen offset:1024 sc1 lds
s_waitcnt lgkmcnt(6)
M a[104:107], a[112:115], v[40:43], a[104:107]
M a[104:107], a[112:115], v[72:75], a[104:107]
M v[208:211], a[140:143], v[32:35], v[208:211]
v_exp_f32 v116, v116
M v[208:211], a[144:147], v[64:67], v[208:211]
ds_read_b128 a[172:175], v2 offset:39936
ds_read_b128 a[176:179], v2 offset:48128
M v[212:215], a[144:147], v[68:71], v[212:215]
v_exp_f32 v117, v117
M v[212:215], a[140:143], v[36:39], v[212:215]
buffer_load_dwordx4 v1, s[12:15], s32 offen offset:2048 sc1 lds
M v[216:219], a[140:143], v[40:43], v[216:219]
v_exp_f32 v118, v118
M v[216:219], a[144:147], v[72:75], v[216:219]
v_cvt_pk_bf16_f32 v101, v102, v103
v_cvt_pk_bf16_f32 v102, v116, v117
M v[220:223], a[144:147], v[76:79], v[220:223]
v_exp_f32 v119, v119
M v[220:223], a[140:143], v[44:47], v[220:223]
buffer_load_dwordx4 v1, s[12:15], s32 offen offset:3072 sc1 lds
s_waitcnt lgkmcnt(6)
M a[108:111], a[112:115], v[44:47], a[108:111]
M a[108:111], a[112:115], v[76:79], a[108:111]
M v[224:227], a[148:151], v[32:35], v[224:227]
v_exp_f32 v104, v104
M v[224:227], a[152:155], v[64:67], v[224:227]
s_add_u32 s25, s25, 32768
s_cmp_eq_u32 s25, s27
s_cselect_b32 s25, s28, s25
s_cselect_b32 s27, -1, s27
M v[228:231], a[152:155], v[68:71], v[228:231]
v_exp_f32 v105, v105
M v[228:231], a[148:151], v[36:39], v[228:231]
v_cvt_pk_bf16_f32 v103, v118, v119
v_cvt_pk_bf16_f32 v104, v104, v105
M v[232:235], a[148:151], v[40:43], v[232:235]
v_exp_f32 v106, v106
M v[232:235], a[152:155], v[72:75], v[232:235]
M v[236:239], a[152:155], v[76:79], v[236:239]
v_exp_f32 v107, v107
M v[236:239], a[148:151], v[44:47], v[236:239]
v_cvt_pk_bf16_f32 v105, v106, v107
s_waitcnt lgkmcnt(4)
M v[240:243], a[156:159], v[32:35], v[240:243]
v_exp_f32 v120, v120
M v[240:243], a[160:163], v[64:67], v[240:243]
M v[244:247], a[160:163], v[68:71], v[244:247]
v_exp_f32 v121, v121
M v[244:247], a[156:159], v[36:39], v[244:247]
v_cvt_pk_bf16_f32 v106, v120, v121
M v[248:251], a[156:159], v[40:43], v[248:251]
v_exp_f32 v122, v122
M v[248:251], a[160:163], v[72:75], v[248:251]
s_waitcnt vmcnt(16) lgkmcnt(0)
s_barrier
ds_read_b128 a[116:119], v3 offset:0
ds_read_b128 a[120:123], v3 offset:1024
ds_read_b128 a[124:127], v3 offset:2048
ds_read_b128 a[128:131], v3 offset:3072
M v[252:255], a[160:163], v[76:79], v[252:255]
v_exp_f32 v123, v123
M v[252:255], a[156:159], v[44:47], v[252:255]
v_cvt_pk_bf16_f32 v107, v122, v123
M a[64:67], a[164:167], v[32:35], a[64:67]
v_exp_f32 v108, v108
M a[64:67], a[168:171], v[64:67], a[64:67]
ds_read_b128 a[132:135], v3 offset:4096
ds_read_b128 a[136:139], v3 offset:5120
M a[68:71], a[168:171], v[68:71], a[68:71]
v_exp_f32 v109, v109
M a[68:71], a[164:167], v[36:39], a[68:71]
v_cvt_pk_bf16_f32 v108, v108, v109
M a[72:75], a[164:167], v[40:43], a[72:75]
v_exp_f32 v110, v110
M a[72:75], a[168:171], v[72:75], a[72:75]
M a[76:79], a[168:171], v[76:79], a[76:79]
v_exp_f32 v111, v111
M a[76:79], a[164:167], v[44:47], a[76:79]
v_cvt_pk_bf16_f32 v109, v110, v111
M a[80:83], a[172:175], v[32:35], a[80:83]
v_exp_f32 v124, v124
M a[80:83], a[176:179], v[64:67], a[80:83]
ds_read_b128 a[140:143], v3 offset:6144
ds_read_b128 a[144:147], v3 offset:7168
M a[84:87], a[176:179], v[68:71], a[84:87]
v_exp_f32 v125, v125
M a[84:87], a[172:175], v[36:39], a[84:87]
v_cvt_pk_bf16_f32 v110, v124, v125
M a[88:91], a[172:175], v[40:43], a[88:91]
v_exp_f32 v126, v126
M a[88:91], a[176:179], v[72:75], a[88:91]
M a[92:95], a[176:179], v[76:79], a[92:95]
v_exp_f32 v127, v127
M a[92:95], a[172:175], v[44:47], a[92:95]
v_cvt_pk_bf16_f32 v111, v126, v127
Lk2_l2b:
s_waitcnt lgkmcnt(4)
s_add_u32 m0, s29, 32768
M v[32:35], a[116:119], a[180:183], 0
v_exp_f32 v128, v128
M v[32:35], a[120:123], a[184:187], v[32:35]
ds_read_b128 a[148:151], v3 offset:8192
ds_read_b128 a[152:155], v3 offset:9216
M v[32:35], a[124:127], a[188:191], v[32:35]
v_exp_f32 v129, v129
M v[32:35], a[128:131], a[192:195], v[32:35]
buffer_load_dwordx4 v1, s[12:15], s26 offen offset:0 sc1 lds
s_add_u32 s32, s26, 4096
M v[36:39], a[128:131], a[208:211], 0
v_exp_f32 v130, v130
M v[36:39], a[124:127], a[204:207], v[36:39]
v_cvt_pk_bf16_f32 v128, v128, v129
M v[36:39], a[120:123], a[200:203], v[36:39]
v_exp_f32 v131, v131
M v[36:39], a[116:119], a[196:199], v[36:39]
buffer_load_dwordx4 v1, s[12:15], s26 offen offset:1024 sc1 lds
M v[40:43], a[116:119], a[212:215], 0
v_exp_f32 v144, v144
M v[40:43], a[120:123], a[216:219], v[40:43]
ds_read_b128 a[156:159], v3 offset:10240
ds_read_b128 a[160:163], v3 offset:11264
M v[40:43], a[124:127], a[220:223], v[40:43]
v_exp_f32 v145, v145
M v[40:43], a[128:131], a[224:227], v[40:43]
buffer_load_dwordx4 v1, s[12:15], s26 offen offset:2048 sc1 lds
M v[44:47], a[128:131], a[240:243], 0
v_exp_f32 v146, v146
M v[44:47], a[124:127], a[236:239], v[44:47]
v_cvt_pk_bf16_f32 v129, v130, v131
v_cvt_pk_bf16_f32 v130, v144, v145
M v[44:47], a[120:123], a[232:235], v[44:47]
v_exp_f32 v147, v147
M v[44:47], a[116:119], a[228:231], v[44:47]
buffer_load_dwordx4 v1, s[12:15], s26 offen offset:3072 sc1 lds
s_add_u32 m0, s29, 36864
s_waitcnt lgkmcnt(4)
M v[48:51], a[132:135], a[180:183], 0
v_exp_f32 v132, v132
M v[48:51], a[136:139], a[184:187], v[48:51]
ds_read_b128 a[164:167], v3 offset:12288
ds_read_b128 a[168:171], v3 offset:13312
M v[48:51], a[140:143], a[188:191], v[48:51]
v_exp_f32 v133, v133
M v[48:51], a[144:147], a[192:195], v[48:51]
buffer_load_dwordx4 v1, s[12:15], s32 offen offset:0 sc1 lds
M v[52:55], a[144:147], a[208:211], 0
v_exp_f32 v134, v134
M v[52:55], a[140:143], a[204:207], v[52:55]
v_cvt_pk_bf16_f32 v131, v146, v147
v_cvt_pk_bf16_f32 v132, v132, v133
M v[52:55], a[136:139], a[200:203], v[52:55]
v_exp_f32 v135, v135
M v[52:55], a[132:135], a[196:199], v[52:55]
buffer_load_dwordx4 v1, s[12:15], s32 offen offset:1024 sc1 lds
M v[56:59], a[132:135], a[212:215], 0
v_exp_f32 v148, v148
M v[56:59], a[136:139], a[216:219], v[56:59]
ds_read_b128 a[172:175], v3 offset:14336
ds_read_b128 a[176:179], v3 offset:15360
M v[56:59], a[140:143], a[220:223], v[56:59]
v_exp_f32 v149, v149
M v[56:59], a[144:147], a[224:227], v[56:59]
buffer_load_dwordx4 v1, s[12:15], s32 offen offset:2048 sc1 lds
M v[60:63], a[144:147], a[240:243], 0
v_exp_f32 v150, v150
M v[60:63], a[140:143], a[236:239], v[60:63]
v_cvt_pk_bf16_f32 v133, v134, v135
v_cvt_pk_bf16_f32 v134, v148, v149
M v[60:63], a[136:139], a[232:235], v[60:63]
v_exp_f32 v151, v151
M v[60:63], a[132:135], a[228:231], v[60:63]
buffer_load_dwordx4 v1, s[12:15], s32 offen offset:3072 sc1 lds
s_waitcnt lgkmcnt(4)
M v[64:67], a[148:151], a[180:183], 0
v_exp_f32 v136, v136
M v[64:67], a[152:155], a[184:187], v[64:67]
s_add_u32 s26, s26, 32768
s_cmp_eq_u32 s26, s62
s_cselect_b32 s26, s63, s26
s_cselect_b32 s62, -1, s62
M v[64:67], a[156:159], a[188:191], v[64:67]
v_exp_f32 v137, v137
M v[64:67], a[160:163], a[192:195], v[64:67]
v_cvt_pk_bf16_f32 v135, v150, v151
v_cvt_pk_bf16_f32 v136, v136, v137
M v[68:71], a[160:163], a[208:211], 0
v_exp_f32 v138, v138
M v[68:71], a[156:159], a[204:207], v[68:71]
M v[68:71], a[152:155], a[200:203], v[68:71]
v_exp_f32 v139, v139
M v[68:71], a[148:151], a[196:199], v[68:71]
v_cvt_pk_bf16_f32 v137, v138, v139
M v[72:75], a[148:151], a[212:215], 0
v_exp_f32 v152, v152
M v[72:75], a[152:155], a[216:219], v[72:75]
M v[72:75], a[156:159], a[220:223], v[72:75]
v_exp_f32 v153, v153
M v[72:75], a[160:163], a[224:227], v[72:75]
v_cvt_pk_bf16_f32 v138, v152, v153
M v[76:79], a[160:163], a[240:243], 0
v_exp_f32 v154, v154
M v[76:79], a[156:159], a[236:239], v[76:79]
s_waitcnt vmcnt(16) lgkmcnt(0)
s_barrier
ds_read_b128 a[116:119], v3 offset:32768
ds_read_b128 a[120:123], v3 offset:40960
ds_read_b128 a[124:127], v3 offset:33792
ds_read_b128 a[128:131], v3 offset:41984
M v[76:79], a[152:155], a[232:235], v[76:79]
v_exp_f32 v155, v155
M v[76:79], a[148:151], a[228:231], v[76:79]
v_cvt_pk_bf16_f32 v139, v154, v155
M v[80:83], a[164:167], a[180:183], 0
v_exp_f32 v140, v140
M v[80:83], a[168:171], a[184:187], v[80:83]
ds_read_b128 a[132:135], v3 offset:34816
ds_read_b128 a[136:139], v3 offset:43008
M v[80:83], a[172:175], a[188:191], v[80:83]
v_exp_f32 v141, v141
M v[80:83], a[176:179], a[192:195], v[80:83]
v_cvt_pk_bf16_f32 v140, v140, v141
M v[84:87], a[176:179], a[208:211], 0
v_exp_f32 v142, v142
M v[84:87], a[172:175], a[204:207], v[84:87]
M v[84:87], a[168:171], a[200:203], v[84:87]
v_exp_f32 v143, v143
M v[84:87], a[164:167], a[196:199], v[84:87]
v_cvt_pk_bf16_f32 v141, v142, v143
M v[88:91], a[164:167], a[212:215], 0
v_exp_f32 v156, v156
M v[88:91], a[168:171], a[216:219], v[88:91]
ds_read_b128 a[140:143], v3 offset:35840
ds_read_b128 a[144:147], v3 offset:44032
M v[88:91], a[172:175], a[220:223], v[88:91]
v_exp_f32 v157, v157
M v[88:91], a[176:179], a[224:227], v[88:91]
v_cvt_pk_bf16_f32 v142, v156, v157
M v[92:95], a[176:179], a[240:243], 0
v_exp_f32 v158, v158
M v[92:95], a[172:175], a[236:239], v[92:95]
M v[92:95], a[168:171], a[232:235], v[92:95]
v_exp_f32 v159, v159
M v[92:95], a[164:167], a[228:231], v[92:95]
v_cvt_pk_bf16_f32 v143, v158, v159
s_waitcnt lgkmcnt(6)
s_add_u32 m0, s29, 65536
M v[160:163], a[116:119], v[96:99], v[160:163]
v_exp_f32 v32, v32
M v[160:163], a[120:123], v[128:131], v[160:163]
ds_read_b128 a[148:151], v3 offset:36864
ds_read_b128 a[152:155], v3 offset:45056
M v[164:167], a[120:123], v[132:135], v[164:167]
v_exp_f32 v33, v33
M v[164:167], a[116:119], v[100:103], v[164:167]
buffer_load_dwordx4 v1, s[12:15], s25 offen offset:0 sc1 lds
s_add_u32 s32, s25, 4096
M v[168:171], a[116:119], v[104:107], v[168:171]
v_exp_f32 v34, v34
M v[168:171], a[120:123], v[136:139], v[168:171]
v_cvt_pk_bf16_f32 v32, v32, v33
M v[172:175], a[120:123], v[140:143], v[172:175]
v_exp_f32 v35, v35
M v[172:175], a[116:119], v[108:111], v[172:175]
buffer_load_dwordx4 v1, s[12:15], s25 offen offset:1024 sc1 lds
s_waitcnt lgkmcnt(6)
M a[96:99], a[112:115], v[96:99], a[96:99]
M a[96:99], a[112:115], v[128:131], a[96:99]
M v[176:179], a[124:127], v[96:99], v[176:179]
v_exp_f32 v48, v48
M v[176:179], a[128:131], v[128:131], v[176:179]
ds_read_b128 a[156:159], v3 offset:37888
ds_read_b128 a[160:163], v3 offset:46080
M v[180:183], a[128:131], v[132:135], v[180:183]
v_exp_f32 v49, v49
M v[180:183], a[124:127], v[100:103], v[180:183]
buffer_load_dwordx4 v1, s[12:15], s25 offen offset:2048 sc1 lds
M v[184:187], a[124:127], v[104:107], v[184:187]
v_exp_f32 v50, v50
M v[184:187], a[128:131], v[136:139], v[184:187]
v_cvt_pk_bf16_f32 v33, v34, v35
v_cvt_pk_bf16_f32 v34, v48, v49
M v[188:191], a[128:131], v[140:143], v[188:191]
v_exp_f32 v51, v51
M v[188:191], a[124:127], v[108:111], v[188:191]
buffer_load_dwordx4 v1, s[12:15], s25 offen offset:3072 sc1 lds
s_add_u32 m0, s29, 69632
s_waitcnt lgkmcnt(6)
M a[100:103], a[112:115], v[100:103], a[100:103]
M a[100:103], a[112:115], v[132:135], a[100:103]
M v[192:195], a[132:135], v[96:99], v[192:195]
v_exp_f32 v36, v36
M v[192:195], a[136:139], v[128:131], v[192:195]
ds_read_b128 a[164:167], v3 offset:38912
ds_read_b128 a[168:171], v3 offset:47104
M v[196:199], a[136:139], v[132:135], v[196:199]
v_exp_f32 v37, v37
M v[196:199], a[132:135], v[100:103], v[196:199]
buffer_load_dwordx4 v1, s[12:15], s32 offen offset:0 sc1 lds
M v[200:203], a[132:135], v[104:107], v[200:203]
v_exp_f32 v38, v38
M v[200:203], a[136:139], v[136:139], v[200:203]
v_cvt_pk_bf16_f32 v35, v50, v51
v_cvt_pk_bf16_f32 v36, v36, v37
M v[204:207], a[136:139], v[140:143], v[204:207]
v_exp_f32 v39, v39
M v[204:207], a[132:135], v[108:111], v[204:207]
buffer_load_dwordx4 v1, s[12:15], s32 offen offset:1024 sc1 lds
s_waitcnt lgkmcnt(6)
M a[104:107], a[112:115], v[104:107], a[104:107]
M a[104:107], a[112:115], v[136:139], a[104:107]
M v[208:211], a[140:143], v[96:99], v[208:211]
v_exp_f32 v52, v52
M v[208:211], a[144:147], v[128:131], v[208:211]
ds_read_b128 a[172:175], v3 offset:39936
ds_read_b128 a[176:179], v3 offset:48128
M v[212:215], a[144:147], v[132:135], v[212:215]
v_exp_f32 v53, v53
M v[212:215], a[140:143], v[100:103], v[212:215]
buffer_load_dwordx4 v1, s[12:15], s32 offen offset:2048 sc1 lds
M v[216:219], a[140:143], v[104:107], v[216:219]
v_exp_f32 v54, v54
M v[216:219], a[144:147], v[136:139], v[216:219]
v_cvt_pk_bf16_f32 v37, v38, v39
v_cvt_pk_bf16_f32 v38, v52, v53
M v[220:223], a[144:147], v[140:143], v[220:223]
v_exp_f32 v55, v55
M v[220:223], a[140:143], v[108:111], v[220:223]
buffer_load_dwordx4 v1, s[12:15], s32 offen offset:3072 sc1 lds
s_waitcnt lgkmcnt(6)
M a[108:111], a[112:115], v[108:111], a[108:111]
M a[108:111], a[112:115], v[140:143], a[108:111]
M v[224:227], a[148:151], v[96:99], v[224:227]
v_exp_f32 v40, v40
M v[224:227], a[152:155], v[128:131], v[224:227]
s_add_u32 s25, s25, 32768
s_cmp_eq_u32 s25, s27
s_cselect_b32 s25, s28, s25
s_cselect_b32 s27, -1, s27
M v[228:231], a[152:155], v[132:135], v[228:231]
v_exp_f32 v41, v41
M v[228:231], a[148:151], v[100:103], v[228:231]
v_cvt_pk_bf16_f32 v39, v54, v55
v_cvt_pk_bf16_f32 v40, v40, v41
M v[232:235], a[148:151], v[104:107], v[232:235]
v_exp_f32 v42, v42
M v[232:235], a[152:155], v[136:139], v[232:235]
M v[236:239], a[152:155], v[140:143], v[236:239]
v_exp_f32 v43, v43
M v[236:239], a[148:151], v[108:111], v[236:239]
v_cvt_pk_bf16_f32 v41, v42, v43
s_waitcnt lgkmcnt(4)
M v[240:243], a[156:159], v[96:99], v[240:243]
v_exp_f32 v56, v56
M v[240:243], a[160:163], v[128:131], v[240:243]
M v[244:247], a[160:163], v[132:135], v[244:247]
v_exp_f32 v57, v57
M v[244:247], a[156:159], v[100:103], v[244:247]
v_cvt_pk_bf16_f32 v42, v56, v57
M v[248:251], a[156:159], v[104:107], v[248:251]
v_exp_f32 v58, v58
M v[248:251], a[160:163], v[136:139], v[248:251]
s_waitcnt vmcnt(16) lgkmcnt(0)
s_barrier
ds_read_b128 a[116:119], v2 offset:0
ds_read_b128 a[120:123], v2 offset:1024
ds_read_b128 a[124:127], v2 offset:2048
ds_read_b128 a[128:131], v2 offset:3072
M v[252:255], a[160:163], v[140:143], v[252:255]
v_exp_f32 v59, v59
M v[252:255], a[156:159], v[108:111], v[252:255]
v_cvt_pk_bf16_f32 v43, v58, v59
M a[64:67], a[164:167], v[96:99], a[64:67]
v_exp_f32 v44, v44
M a[64:67], a[168:171], v[128:131], a[64:67]
ds_read_b128 a[132:135], v2 offset:4096
ds_read_b128 a[136:139], v2 offset:5120
M a[68:71], a[168:171], v[132:135], a[68:71]
v_exp_f32 v45, v45
M a[68:71], a[164:167], v[100:103], a[68:71]
v_cvt_pk_bf16_f32 v44, v44, v45
M a[72:75], a[164:167], v[104:107], a[72:75]
v_exp_f32 v46, v46
M a[72:75], a[168:171], v[136:139], a[72:75]
M a[76:79], a[168:171], v[140:143], a[76:79]
v_exp_f32 v47, v47
M a[76:79], a[164:167], v[108:111], a[76:79]
v_cvt_pk_bf16_f32 v45, v46, v47
M a[80:83], a[172:175], v[96:99], a[80:83]
v_exp_f32 v60, v60
M a[80:83], a[176:179], v[128:131], a[80:83]
ds_read_b128 a[140:143], v2 offset:6144
ds_read_b128 a[144:147], v2 offset:7168
M a[84:87], a[176:179], v[132:135], a[84:87]
v_exp_f32 v61, v61
M a[84:87], a[172:175], v[100:103], a[84:87]
v_cvt_pk_bf16_f32 v46, v60, v61
M a[88:91], a[172:175], v[104:107], a[88:91]
v_exp_f32 v62, v62
M a[88:91], a[176:179], v[136:139], a[88:91]
M a[92:95], a[176:179], v[140:143], a[92:95]
v_exp_f32 v63, v63
M a[92:95], a[172:175], v[108:111], a[92:95]
v_cvt_pk_bf16_f32 v47, v62, v63
s_sub_u32 s30, s30, 1
s_cmp_lg_u32 s30, 0
s_cbranch_scc1 Lk2_l2
s_branch Lk2_fin
Lk2_g1:
s_mov_b32 s30, 7
Lk2_l3:
s_waitcnt lgkmcnt(4)
s_add_u32 m0, s29, 98304
M v[96:99], a[116:119], a[0:3], 0
v_exp_f32 v64, v64
M v[96:99], a[120:123], a[4:7], v[96:99]
ds_read_b128 a[148:151], v2 offset:8192
ds_read_b128 a[152:155], v2 offset:9216
M v[96:99], a[124:127], a[8:11], v[96:99]
v_exp_f32 v65, v65
M v[96:99], a[128:131], a[12:15], v[96:99]
buffer_load_dwordx4 v1, s[12:15], s26 offen offset:0 sc1 lds
s_add_u32 s32, s26, 4096
M v[100:103], a[128:131], a[28:31], 0
v_exp_f32 v66, v66
M v[100:103], a[124:127], a[24:27], v[100:103]
v_cvt_pk_bf16_f32 v64, v64, v65
M v[100:103], a[120:123], a[20:23], v[100:103]
v_exp_f32 v67, v67
M v[100:103], a[116:119], a[16:19], v[100:103]
buffer_load_dwordx4 v1, s[12:15], s26 offen offset:1024 sc1 lds
M v[104:107], a[116:119], a[32:35], 0
v_exp_f32 v80, v80
M v[104:107], a[120:123], a[36:39], v[104:107]
ds_read_b128 a[156:159], v2 offset:10240
ds_read_b128 a[160:163], v2 offset:11264
M v[104:107], a[124:127], a[40:43], v[104:107]
v_exp_f32 v81, v81
M v[104:107], a[128:131], a[44:47], v[104:107]
buffer_load_dwordx4 v1, s[12:15], s26 offen offset:2048 sc1 lds
M v[108:111], a[128:131], a[60:63], 0
v_exp_f32 v82, v82
M v[108:111], a[124:127], a[56:59], v[108:111]
v_cvt_pk_bf16_f32 v65, v66, v67
v_cvt_pk_bf16_f32 v66, v80, v81
M v[108:111], a[120:123], a[52:55], v[108:111]
v_exp_f32 v83, v83
M v[108:111], a[116:119], a[48:51], v[108:111]
buffer_load_dwordx4 v1, s[12:15], s26 offen offset:3072 sc1 lds
s_add_u32 m0, s29, 102400
s_waitcnt lgkmcnt(4)
M v[112:115], a[132:135], a[0:3], 0
v_exp_f32 v68, v68
M v[112:115], a[136:139], a[4:7], v[112:115]
ds_read_b128 a[164:167], v2 offset:12288
ds_read_b128 a[168:171], v2 offset:13312
M v[112:115], a[140:143], a[8:11], v[112:115]
v_exp_f32 v69, v69
M v[112:115], a[144:147], a[12:15], v[112:115]
buffer_load_dwordx4 v1, s[12:15], s32 offen offset:0 sc1 lds
M v[116:119], a[144:147], a[28:31], 0
v_exp_f32 v70, v70
M v[116:119], a[140:143], a[24:27], v[116:119]
v_cvt_pk_bf16_f32 v67, v82, v83
v_cvt_pk_bf16_f32 v68, v68, v69
M v[116:119], a[136:139], a[20:23], v[116:119]
v_exp_f32 v71, v71
M v[116:119], a[132:135], a[16:19], v[116:119]
buffer_load_dwordx4 v1, s[12:15], s32 offen offset:1024 sc1 lds
M v[120:123], a[132:135], a[32:35], 0
v_exp_f32 v84, v84
M v[120:123], a[136:139], a[36:39], v[120:123]
ds_read_b128 a[172:175], v2 offset:14336
ds_read_b128 a[176:179], v2 offset:15360
M v[120:123], a[140:143], a[40:43], v[120:123]
v_exp_f32 v85, v85
M v[120:123], a[144:147], a[44:47], v[120:123]
buffer_load_dwordx4 v1, s[12:15], s32 offen offset:2048 sc1 lds
M v[124:127], a[144:147], a[60:63], 0
v_exp_f32 v86, v86
M v[124:127], a[140:143], a[56:59], v[124:127]
v_cvt_pk_bf16_f32 v69, v70, v71
v_cvt_pk_bf16_f32 v70, v84, v85
M v[124:127], a[136:139], a[52:55], v[124:127]
v_exp_f32 v87, v87
M v[124:127], a[132:135], a[48:51], v[124:127]
buffer_load_dwordx4 v1, s[12:15], s32 offen offset:3072 sc1 lds
s_waitcnt lgkmcnt(4)
M v[128:131], a[148:151], a[0:3], 0
v_exp_f32 v72, v72
M v[128:131], a[152:155], a[4:7], v[128:131]
s_add_u32 s26, s26, 32768
s_cmp_eq_u32 s26, s62
s_cselect_b32 s26, s63, s26
s_cselect_b32 s62, -1, s62
M v[128:131], a[156:159], a[8:11], v[128:131]
v_exp_f32 v73, v73
M v[128:131], a[160:163], a[12:15], v[128:131]
v_cvt_pk_bf16_f32 v71, v86, v87
v_cvt_pk_bf16_f32 v72, v72, v73
M v[132:135], a[160:163], a[28:31], 0
v_exp_f32 v74, v74
M v[132:135], a[156:159], a[24:27], v[132:135]
M v[132:135], a[152:155], a[20:23], v[132:135]
v_exp_f32 v75, v75
M v[132:135], a[148:151], a[16:19], v[132:135]
v_cvt_pk_bf16_f32 v73, v74, v75
M v[136:139], a[148:151], a[32:35], 0
v_exp_f32 v88, v88
M v[136:139], a[152:155], a[36:39], v[136:139]
M v[136:139], a[156:159], a[40:43], v[136:139]
v_exp_f32 v89, v89
M v[136:139], a[160:163], a[44:47], v[136:139]
v_cvt_pk_bf16_f32 v74, v88, v89
M v[140:143], a[160:163], a[60:63], 0
v_exp_f32 v90, v90
M v[140:143], a[156:159], a[56:59], v[140:143]
s_waitcnt vmcnt(16) lgkmcnt(0)
s_barrier
ds_read_b128 a[116:119], v2 offset:32768
ds_read_b128 a[120:123], v2 offset:40960
ds_read_b128 a[124:127], v2 offset:33792
ds_read_b128 a[128:131], v2 offset:41984
M v[140:143], a[152:155], a[52:55], v[140:143]
v_exp_f32 v91, v91
M v[140:143], a[148:151], a[48:51], v[140:143]
v_cvt_pk_bf16_f32 v75, v90, v91
M v[144:147], a[164:167], a[0:3], 0
v_exp_f32 v76, v76
M v[144:147], a[168:171], a[4:7], v[144:147]
ds_read_b128 a[132:135], v2 offset:34816
ds_read_b128 a[136:139], v2 offset:43008
M v[144:147], a[172:175], a[8:11], v[144:147]
v_exp_f32 v77, v77
M v[144:147], a[176:179], a[12:15], v[144:147]
v_cvt_pk_bf16_f32 v76, v76, v77
M v[148:151], a[176:179], a[28:31], 0
v_exp_f32 v78, v78
M v[148:151], a[172:175], a[24:27], v[148:151]
M v[148:151], a[168:171], a[20:23], v[148:151]
v_exp_f32 v79, v79
M v[148:151], a[164:167], a[16:19], v[148:151]
v_cvt_pk_bf16_f32 v77, v78, v79
M v[152:155], a[164:167], a[32:35], 0
v_exp_f32 v92, v92
M v[152:155], a[168:171], a[36:39], v[152:155]
ds_read_b128 a[140:143], v2 offset:35840
ds_read_b128 a[144:147], v2 offset:44032
M v[152:155], a[172:175], a[40:43], v[152:155]
v_exp_f32 v93, v93
M v[152:155], a[176:179], a[44:47], v[152:155]
v_cvt_pk_bf16_f32 v78, v92, v93
M v[156:159], a[176:179], a[60:63], 0
v_exp_f32 v94, v94
M v[156:159], a[172:175], a[56:59], v[156:159]
M v[156:159], a[168:171], a[52:55], v[156:159]
v_exp_f32 v95, v95
M v[156:159], a[164:167], a[48:51], v[156:159]
v_cvt_pk_bf16_f32 v79, v94, v95
s_waitcnt lgkmcnt(6)
s_add_u32 m0, s29, 0
M v[160:163], a[116:119], v[32:35], v[160:163]
v_exp_f32 v96, v96
M v[160:163], a[120:123], v[64:67], v[160:163]
ds_read_b128 a[148:151], v2 offset:36864
ds_read_b128 a[152:155], v2 offset:45056
M v[164:167], a[120:123], v[68:71], v[164:167]
v_exp_f32 v97, v97
M v[164:167], a[116:119], v[36:39], v[164:167]
buffer_load_dwordx4 v1, s[12:15], s25 offen offset:0 sc1 lds
s_add_u32 s32, s25, 4096
M v[168:171], a[116:119], v[40:43], v[168:171]
v_exp_f32 v98, v98
M v[168:171], a[120:123], v[72:75], v[168:171]
v_cvt_pk_bf16_f32 v96, v96, v97
M v[172:175], a[120:123], v[76:79], v[172:175]
v_exp_f32 v99, v99
M v[172:175], a[116:119], v[44:47], v[172:175]
buffer_load_dwordx4 v1, s[12:15], s25 offen offset:1024 sc1 lds
s_waitcnt lgkmcnt(6)
M a[96:99], a[112:115], v[32:35], a[96:99]
M a[96:99], a[112:115], v[64:67], a[96:99]
M v[176:179], a[124:127], v[32:35], v[176:179]
v_exp_f32 v112, v112
M v[176:179], a[128:131], v[64:67], v[176:179]
ds_read_b128 a[156:159], v2 offset:37888
ds_read_b128 a[160:163], v2 offset:46080
M v[180:183], a[128:131], v[68:71], v[180:183]
v_exp_f32 v113, v113
M v[180:183], a[124:127], v[36:39], v[180:183]
buffer_load_dwordx4 v1, s[12:15], s25 offen offset:2048 sc1 lds
M v[184:187], a[124:127], v[40:43], v[184:187]
v_exp_f32 v114, v114
M v[184:187], a[128:131], v[72:75], v[184:187]
v_cvt_pk_bf16_f32 v97, v98, v99
v_cvt_pk_bf16_f32 v98, v112, v113
M v[188:191], a[128:131], v[76:79], v[188:191]
v_exp_f32 v115, v115
M v[188:191], a[124:127], v[44:47], v[188:191]
buffer_load_dwordx4 v1, s[12:15], s25 offen offset:3072 sc1 lds
s_add_u32 m0, s29, 4096
s_waitcnt lgkmcnt(6)
M a[100:103], a[112:115], v[36:39], a[100:103]
M a[100:103], a[112:115], v[68:71], a[100:103]
M v[192:195], a[132:135], v[32:35], v[192:195]
v_exp_f32 v100, v100
M v[192:195], a[136:139], v[64:67], v[192:195]
ds_read_b128 a[164:167], v2 offset:38912
ds_read_b128 a[168:171], v2 offset:47104
M v[196:199], a[136:139], v[68:71], v[196:199]
v_exp_f32 v101, v101
M v[196:199], a[132:135], v[36:39], v[196:199]
buffer_load_dwordx4 v1, s[12:15], s32 offen offset:0 sc1 lds
M v[200:203], a[132:135], v[40:43], v[200:203]
v_exp_f32 v102, v102
M v[200:203], a[136:139], v[72:75], v[200:203]
v_cvt_pk_bf16_f32 v99, v114, v115
v_cvt_pk_bf16_f32 v100, v100, v101
M v[204:207], a[136:139], v[76:79], v[204:207]
v_exp_f32 v103, v103
M v[204:207], a[132:135], v[44:47], v[204:207]
buffer_load_dwordx4 v1, s[12:15], s32 offen offset:1024 sc1 lds
s_waitcnt lgkmcnt(6)
M a[104:107], a[112:115], v[40:43], a[104:107]
M a[104:107], a[112:115], v[72:75], a[104:107]
M v[208:211], a[140:143], v[32:35], v[208:211]
v_exp_f32 v116, v116
M v[208:211], a[144:147], v[64:67], v[208:211]
ds_read_b128 a[172:175], v2 offset:39936
ds_read_b128 a[176:179], v2 offset:48128
M v[212:215], a[144:147], v[68:71], v[212:215]
v_exp_f32 v117, v117
M v[212:215], a[140:143], v[36:39], v[212:215]
buffer_load_dwordx4 v1, s[12:15], s32 offen offset:2048 sc1 lds
M v[216:219], a[140:143], v[40:43], v[216:219]
v_exp_f32 v118, v118
M v[216:219], a[144:147], v[72:75], v[216:219]
v_cvt_pk_bf16_f32 v101, v102, v103
v_cvt_pk_bf16_f32 v102, v116, v117
M v[220:223], a[144:147], v[76:79], v[220:223]
v_exp_f32 v119, v119
M v[220:223], a[140:143], v[44:47], v[220:223]
buffer_load_dwordx4 v1, s[12:15], s32 offen offset:3072 sc1 lds
s_waitcnt lgkmcnt(6)
M a[108:111], a[112:115], v[44:47], a[108:111]
M a[108:111], a[112:115], v[76:79], a[108:111]
M v[224:227], a[148:151], v[32:35], v[224:227]
v_exp_f32 v104, v104
M v[224:227], a[152:155], v[64:67], v[224:227]
s_add_u32 s25, s25, 32768
s_cmp_eq_u32 s25, s27
s_cselect_b32 s25, s28, s25
s_cselect_b32 s27, -1, s27
M v[228:231], a[152:155], v[68:71], v[228:231]
v_exp_f32 v105, v105
M v[228:231], a[148:151], v[36:39], v[228:231]
v_cvt_pk_bf16_f32 v103, v118, v119
v_cvt_pk_bf16_f32 v104, v104, v105
M v[232:235], a[148:151], v[40:43], v[232:235]
v_exp_f32 v106, v106
M v[232:235], a[152:155], v[72:75], v[232:235]
M v[236:239], a[152:155], v[76:79], v[236:239]
v_exp_f32 v107, v107
M v[236:239], a[148:151], v[44:47], v[236:239]
v_cvt_pk_bf16_f32 v105, v106, v107
s_waitcnt lgkmcnt(4)
M v[240:243], a[156:159], v[32:35], v[240:243]
v_exp_f32 v120, v120
M v[240:243], a[160:163], v[64:67], v[240:243]
M v[244:247], a[160:163], v[68:71], v[244:247]
v_exp_f32 v121, v121
M v[244:247], a[156:159], v[36:39], v[244:247]
v_cvt_pk_bf16_f32 v106, v120, v121
M v[248:251], a[156:159], v[40:43], v[248:251]
v_exp_f32 v122, v122
M v[248:251], a[160:163], v[72:75], v[248:251]
s_waitcnt vmcnt(16) lgkmcnt(0)
s_barrier
ds_read_b128 a[116:119], v3 offset:0
ds_read_b128 a[120:123], v3 offset:1024
ds_read_b128 a[124:127], v3 offset:2048
ds_read_b128 a[128:131], v3 offset:3072
M v[252:255], a[160:163], v[76:79], v[252:255]
v_exp_f32 v123, v123
M v[252:255], a[156:159], v[44:47], v[252:255]
v_cvt_pk_bf16_f32 v107, v122, v123
M a[64:67], a[164:167], v[32:35], a[64:67]
v_exp_f32 v108, v108
M a[64:67], a[168:171], v[64:67], a[64:67]
ds_read_b128 a[132:135], v3 offset:4096
ds_read_b128 a[136:139], v3 offset:5120
M a[68:71], a[168:171], v[68:71], a[68:71]
v_exp_f32 v109, v109
M a[68:71], a[164:167], v[36:39], a[68:71]
v_cvt_pk_bf16_f32 v108, v108, v109
M a[72:75], a[164:167], v[40:43], a[72:75]
v_exp_f32 v110, v110
M a[72:75], a[168:171], v[72:75], a[72:75]
M a[76:79], a[168:171], v[76:79], a[76:79]
v_exp_f32 v111, v111
M a[76:79], a[164:167], v[44:47], a[76:79]
v_cvt_pk_bf16_f32 v109, v110, v111
M a[80:83], a[172:175], v[32:35], a[80:83]
v_exp_f32 v124, v124
M a[80:83], a[176:179], v[64:67], a[80:83]
ds_read_b128 a[140:143], v3 offset:6144
ds_read_b128 a[144:147], v3 offset:7168
M a[84:87], a[176:179], v[68:71], a[84:87]
v_exp_f32 v125, v125
M a[84:87], a[172:175], v[36:39], a[84:87]
v_cvt_pk_bf16_f32 v110, v124, v125
M a[88:91], a[172:175], v[40:43], a[88:91]
v_exp_f32 v126, v126
M a[88:91], a[176:179], v[72:75], a[88:91]
M a[92:95], a[176:179], v[76:79], a[92:95]
v_exp_f32 v127, v127
M a[92:95], a[172:175], v[44:47], a[92:95]
v_cvt_pk_bf16_f32 v111, v126, v127
s_waitcnt lgkmcnt(4)
s_add_u32 m0, s29, 32768
M v[32:35], a[116:119], a[0:3], 0
v_exp_f32 v128, v128
M v[32:35], a[120:123], a[4:7], v[32:35]
ds_read_b128 a[148:151], v3 offset:8192
ds_read_b128 a[152:155], v3 offset:9216
M v[32:35], a[124:127], a[8:11], v[32:35]
v_exp_f32 v129, v129
M v[32:35], a[128:131], a[12:15], v[32:35]
buffer_load_dwordx4 v1, s[12:15], s26 offen offset:0 sc1 lds
s_add_u32 s32, s26, 4096
M v[36:39], a[128:131], a[28:31], 0
v_exp_f32 v130, v130
M v[36:39], a[124:127], a[24:27], v[36:39]
v_cvt_pk_bf16_f32 v128, v128, v129
M v[36:39], a[120:123], a[20:23], v[36:39]
v_exp_f32 v131, v131
M v[36:39], a[116:119], a[16:19], v[36:39]
buffer_load_dwordx4 v1, s[12:15], s26 offen offset:1024 sc1 lds
M v[40:43], a[116:119], a[32:35], 0
v_exp_f32 v144, v144
M v[40:43], a[120:123], a[36:39], v[40:43]
ds_read_b128 a[156:159], v3 offset:10240
ds_read_b128 a[160:163], v3 offset:11264
M v[40:43], a[124:127], a[40:43], v[40:43]
v_exp_f32 v145, v145
M v[40:43], a[128:131], a[44:47], v[40:43]
buffer_load_dwordx4 v1, s[12:15], s26 offen offset:2048 sc1 lds
M v[44:47], a[128:131], a[60:63], 0
v_exp_f32 v146, v146
M v[44:47], a[124:127], a[56:59], v[44:47]
v_cvt_pk_bf16_f32 v129, v130, v131
v_cvt_pk_bf16_f32 v130, v144, v145
M v[44:47], a[120:123], a[52:55], v[44:47]
v_exp_f32 v147, v147
M v[44:47], a[116:119], a[48:51], v[44:47]
buffer_load_dwordx4 v1, s[12:15], s26 offen offset:3072 sc1 lds
s_add_u32 m0, s29, 36864
s_waitcnt lgkmcnt(4)
M v[48:51], a[132:135], a[0:3], 0
v_exp_f32 v132, v132
M v[48:51], a[136:139], a[4:7], v[48:51]
ds_read_b128 a[164:167], v3 offset:12288
ds_read_b128 a[168:171], v3 offset:13312
M v[48:51], a[140:143], a[8:11], v[48:51]
v_exp_f32 v133, v133
M v[48:51], a[144:147], a[12:15], v[48:51]
buffer_load_dwordx4 v1, s[12:15], s32 offen offset:0 sc1 lds
M v[52:55], a[144:147], a[28:31], 0
v_exp_f32 v134, v134
M v[52:55], a[140:143], a[24:27], v[52:55]
v_cvt_pk_bf16_f32 v131, v146, v147
v_cvt_pk_bf16_f32 v132, v132, v133
M v[52:55], a[136:139], a[20:23], v[52:55]
v_exp_f32 v135, v135
M v[52:55], a[132:135], a[16:19], v[52:55]
buffer_load_dwordx4 v1, s[12:15], s32 offen offset:1024 sc1 lds
M v[56:59], a[132:135], a[32:35], 0
v_exp_f32 v148, v148
M v[56:59], a[136:139], a[36:39], v[56:59]
ds_read_b128 a[172:175], v3 offset:14336
ds_read_b128 a[176:179], v3 offset:15360
M v[56:59], a[140:143], a[40:43], v[56:59]
v_exp_f32 v149, v149
M v[56:59], a[144:147], a[44:47], v[56:59]
buffer_load_dwordx4 v1, s[12:15], s32 offen offset:2048 sc1 lds
M v[60:63], a[144:147], a[60:63], 0
v_exp_f32 v150, v150
M v[60:63], a[140:143], a[56:59], v[60:63]
v_cvt_pk_bf16_f32 v133, v134, v135
v_cvt_pk_bf16_f32 v134, v148, v149
M v[60:63], a[136:139], a[52:55], v[60:63]
v_exp_f32 v151, v151
M v[60:63], a[132:135], a[48:51], v[60:63]
buffer_load_dwordx4 v1, s[12:15], s32 offen offset:3072 sc1 lds
s_waitcnt lgkmcnt(4)
M v[64:67], a[148:151], a[0:3], 0
v_exp_f32 v136, v136
M v[64:67], a[152:155], a[4:7], v[64:67]
s_add_u32 s26, s26, 32768
s_cmp_eq_u32 s26, s62
s_cselect_b32 s26, s63, s26
s_cselect_b32 s62, -1, s62
M v[64:67], a[156:159], a[8:11], v[64:67]
v_exp_f32 v137, v137
M v[64:67], a[160:163], a[12:15], v[64:67]
v_cvt_pk_bf16_f32 v135, v150, v151
v_cvt_pk_bf16_f32 v136, v136, v137
M v[68:71], a[160:163], a[28:31], 0
v_exp_f32 v138, v138
M v[68:71], a[156:159], a[24:27], v[68:71]
M v[68:71], a[152:155], a[20:23], v[68:71]
v_exp_f32 v139, v139
M v[68:71], a[148:151], a[16:19], v[68:71]
v_cvt_pk_bf16_f32 v137, v138, v139
M v[72:75], a[148:151], a[32:35], 0
v_exp_f32 v152, v152
M v[72:75], a[152:155], a[36:39], v[72:75]
M v[72:75], a[156:159], a[40:43], v[72:75]
v_exp_f32 v153, v153
M v[72:75], a[160:163], a[44:47], v[72:75]
v_cvt_pk_bf16_f32 v138, v152, v153
M v[76:79], a[160:163], a[60:63], 0
v_exp_f32 v154, v154
M v[76:79], a[156:159], a[56:59], v[76:79]
s_waitcnt vmcnt(16) lgkmcnt(0)
s_barrier
ds_read_b128 a[116:119], v3 offset:32768
ds_read_b128 a[120:123], v3 offset:40960
ds_read_b128 a[124:127], v3 offset:33792
ds_read_b128 a[128:131], v3 offset:41984
M v[76:79], a[152:155], a[52:55], v[76:79]
v_exp_f32 v155, v155
M v[76:79], a[148:151], a[48:51], v[76:79]
v_cvt_pk_bf16_f32 v139, v154, v155
M v[80:83], a[164:167], a[0:3], 0
v_exp_f32 v140, v140
M v[80:83], a[168:171], a[4:7], v[80:83]
ds_read_b128 a[132:135], v3 offset:34816
ds_read_b128 a[136:139], v3 offset:43008
M v[80:83], a[172:175], a[8:11], v[80:83]
v_exp_f32 v141, v141
M v[80:83], a[176:179], a[12:15], v[80:83]
v_cvt_pk_bf16_f32 v140, v140, v141
M v[84:87], a[176:179], a[28:31], 0
v_exp_f32 v142, v142
M v[84:87], a[172:175], a[24:27], v[84:87]
M v[84:87], a[168:171], a[20:23], v[84:87]
v_exp_f32 v143, v143
M v[84:87], a[164:167], a[16:19], v[84:87]
v_cvt_pk_bf16_f32 v141, v142, v143
M v[88:91], a[164:167], a[32:35], 0
v_exp_f32 v156, v156
M v[88:91], a[168:171], a[36:39], v[88:91]
ds_read_b128 a[140:143], v3 offset:35840
ds_read_b128 a[144:147], v3 offset:44032
M v[88:91], a[172:175], a[40:43], v[88:91]
v_exp_f32 v157, v157
M v[88:91], a[176:179], a[44:47], v[88:91]
v_cvt_pk_bf16_f32 v142, v156, v157
M v[92:95], a[176:179], a[60:63], 0
v_exp_f32 v158, v158
M v[92:95], a[172:175], a[56:59], v[92:95]
M v[92:95], a[168:171], a[52:55], v[92:95]
v_exp_f32 v159, v159
M v[92:95], a[164:167], a[48:51], v[92:95]
v_cvt_pk_bf16_f32 v143, v158, v159
s_waitcnt lgkmcnt(6)
s_add_u32 m0, s29, 65536
M v[160:163], a[116:119], v[96:99], v[160:163]
v_exp_f32 v32, v32
M v[160:163], a[120:123], v[128:131], v[160:163]
ds_read_b128 a[148:151], v3 offset:36864
ds_read_b128 a[152:155], v3 offset:45056
M v[164:167], a[120:123], v[132:135], v[164:167]
v_exp_f32 v33, v33
M v[164:167], a[116:119], v[100:103], v[164:167]
buffer_load_dwordx4 v1, s[12:15], s25 offen offset:0 sc1 lds
s_add_u32 s32, s25, 4096
M v[168:171], a[116:119], v[104:107], v[168:171]
v_exp_f32 v34, v34
M v[168:171], a[120:123], v[136:139], v[168:171]
v_cvt_pk_bf16_f32 v32, v32, v33
M v[172:175], a[120:123], v[140:143], v[172:175]
v_exp_f32 v35, v35
M v[172:175], a[116:119], v[108:111], v[172:175]
buffer_load_dwordx4 v1, s[12:15], s25 offen offset:1024 sc1 lds
s_waitcnt lgkmcnt(6)
M a[96:99], a[112:115], v[96:99], a[96:99]
M a[96:99], a[112:115], v[128:131], a[96:99]
M v[176:179], a[124:127], v[96:99], v[176:179]
v_exp_f32 v48, v48
M v[176:179], a[128:131], v[128:131], v[176:179]
ds_read_b128 a[156:159], v3 offset:37888
ds_read_b128 a[160:163], v3 offset:46080
M v[180:183], a[128:131], v[132:135], v[180:183]
v_exp_f32 v49, v49
M v[180:183], a[124:127], v[100:103], v[180:183]
buffer_load_dwordx4 v1, s[12:15], s25 offen offset:2048 sc1 lds
M v[184:187], a[124:127], v[104:107], v[184:187]
v_exp_f32 v50, v50
M v[184:187], a[128:131], v[136:139], v[184:187]
v_cvt_pk_bf16_f32 v33, v34, v35
v_cvt_pk_bf16_f32 v34, v48, v49
M v[188:191], a[128:131], v[140:143], v[188:191]
v_exp_f32 v51, v51
M v[188:191], a[124:127], v[108:111], v[188:191]
buffer_load_dwordx4 v1, s[12:15], s25 offen offset:3072 sc1 lds
s_add_u32 m0, s29, 69632
s_waitcnt lgkmcnt(6)
M a[100:103], a[112:115], v[100:103], a[100:103]
M a[100:103], a[112:115], v[132:135], a[100:103]
M v[192:195], a[132:135], v[96:99], v[192:195]
v_exp_f32 v36, v36
M v[192:195], a[136:139], v[128:131], v[192:195]
ds_read_b128 a[164:167], v3 offset:38912
ds_read_b128 a[168:171], v3 offset:47104
M v[196:199], a[136:139], v[132:135], v[196:199]
v_exp_f32 v37, v37
M v[196:199], a[132:135], v[100:103], v[196:199]
buffer_load_dwordx4 v1, s[12:15], s32 offen offset:0 sc1 lds
M v[200:203], a[132:135], v[104:107], v[200:203]
v_exp_f32 v38, v38
M v[200:203], a[136:139], v[136:139], v[200:203]
v_cvt_pk_bf16_f32 v35, v50, v51
v_cvt_pk_bf16_f32 v36, v36, v37
M v[204:207], a[136:139], v[140:143], v[204:207]
v_exp_f32 v39, v39
M v[204:207], a[132:135], v[108:111], v[204:207]
buffer_load_dwordx4 v1, s[12:15], s32 offen offset:1024 sc1 lds
s_waitcnt lgkmcnt(6)
M a[104:107], a[112:115], v[104:107], a[104:107]
M a[104:107], a[112:115], v[136:139], a[104:107]
M v[208:211], a[140:143], v[96:99], v[208:211]
v_exp_f32 v52, v52
M v[208:211], a[144:147], v[128:131], v[208:211]
ds_read_b128 a[172:175], v3 offset:39936
ds_read_b128 a[176:179], v3 offset:48128
M v[212:215], a[144:147], v[132:135], v[212:215]
v_exp_f32 v53, v53
M v[212:215], a[140:143], v[100:103], v[212:215]
buffer_load_dwordx4 v1, s[12:15], s32 offen offset:2048 sc1 lds
M v[216:219], a[140:143], v[104:107], v[216:219]
v_exp_f32 v54, v54
M v[216:219], a[144:147], v[136:139], v[216:219]
v_cvt_pk_bf16_f32 v37, v38, v39
v_cvt_pk_bf16_f32 v38, v52, v53
M v[220:223], a[144:147], v[140:143], v[220:223]
v_exp_f32 v55, v55
M v[220:223], a[140:143], v[108:111], v[220:223]
buffer_load_dwordx4 v1, s[12:15], s32 offen offset:3072 sc1 lds
s_waitcnt lgkmcnt(6)
M a[108:111], a[112:115], v[108:111], a[108:111]
M a[108:111], a[112:115], v[140:143], a[108:111]
M v[224:227], a[148:151], v[96:99], v[224:227]
v_exp_f32 v40, v40
M v[224:227], a[152:155], v[128:131], v[224:227]
s_add_u32 s25, s25, 32768
s_cmp_eq_u32 s25, s27
s_cselect_b32 s25, s28, s25
s_cselect_b32 s27, -1, s27
M v[228:231], a[152:155], v[132:135], v[228:231]
v_exp_f32 v41, v41
M v[228:231], a[148:151], v[100:103], v[228:231]
v_cvt_pk_bf16_f32 v39, v54, v55
v_cvt_pk_bf16_f32 v40, v40, v41
M v[232:235], a[148:151], v[104:107], v[232:235]
v_exp_f32 v42, v42
M v[232:235], a[152:155], v[136:139], v[232:235]
M v[236:239], a[152:155], v[140:143], v[236:239]
v_exp_f32 v43, v43
M v[236:239], a[148:151], v[108:111], v[236:239]
v_cvt_pk_bf16_f32 v41, v42, v43
s_waitcnt lgkmcnt(4)
M v[240:243], a[156:159], v[96:99], v[240:243]
v_exp_f32 v56, v56
M v[240:243], a[160:163], v[128:131], v[240:243]
M v[244:247], a[160:163], v[132:135], v[244:247]
v_exp_f32 v57, v57
M v[244:247], a[156:159], v[100:103], v[244:247]
v_cvt_pk_bf16_f32 v42, v56, v57
M v[248:251], a[156:159], v[104:107], v[248:251]
v_exp_f32 v58, v58
M v[248:251], a[160:163], v[136:139], v[248:251]
s_waitcnt vmcnt(16) lgkmcnt(0)
s_barrier
ds_read_b128 a[116:119], v2 offset:0
ds_read_b128 a[120:123], v2 offset:1024
ds_read_b128 a[124:127], v2 offset:2048
ds_read_b128 a[128:131], v2 offset:3072
M v[252:255], a[160:163], v[140:143], v[252:255]
v_exp_f32 v59, v59
M v[252:255], a[156:159], v[108:111], v[252:255]
v_cvt_pk_bf16_f32 v43, v58, v59
M a[64:67], a[164:167], v[96:99], a[64:67]
v_exp_f32 v44, v44
M a[64:67], a[168:171], v[128:131], a[64:67]
ds_read_b128 a[132:135], v2 offset:4096
ds_read_b128 a[136:139], v2 offset:5120
M a[68:71], a[168:171], v[132:135], a[68:71]
v_exp_f32 v45, v45
M a[68:71], a[164:167], v[100:103], a[68:71]
v_cvt_pk_bf16_f32 v44, v44, v45
M a[72:75], a[164:167], v[104:107], a[72:75]
v_exp_f32 v46, v46
M a[72:75], a[168:171], v[136:139], a[72:75]
M a[76:79], a[168:171], v[140:143], a[76:79]
v_exp_f32 v47, v47
M a[76:79], a[164:167], v[108:111], a[76:79]
v_cvt_pk_bf16_f32 v45, v46, v47
M a[80:83], a[172:175], v[96:99], a[80:83]
v_exp_f32 v60, v60
M a[80:83], a[176:179], v[128:131], a[80:83]
ds_read_b128 a[140:143], v2 offset:6144
ds_read_b128 a[144:147], v2 offset:7168
M a[84:87], a[176:179], v[132:135], a[84:87]
v_exp_f32 v61, v61
M a[84:87], a[172:175], v[100:103], a[84:87]
v_cvt_pk_bf16_f32 v46, v60, v61
M a[88:91], a[172:175], v[104:107], a[88:91]
v_exp_f32 v62, v62
M a[88:91], a[176:179], v[136:139], a[88:91]
M a[92:95], a[176:179], v[140:143], a[92:95]
v_exp_f32 v63, v63
M a[92:95], a[172:175], v[108:111], a[92:95]
v_cvt_pk_bf16_f32 v47, v62, v63
s_sub_u32 s30, s30, 1
s_cmp_lg_u32 s30, 0
s_cbranch_scc1 Lk2_l3
s_lshl_b32 s33, s23, 6
s_add_i32 s33, s33, 0
s_cmp_gt_i32 s33, 0
s_cselect_b32 s34, 0, 0xf149f2ca
s_cmp_lt_i32 s33, 0
s_cselect_b32 s33, 0xf149f2ca, 0
v_mov_b32 v20, s34
v_mov_b32 v21, s34
v_mov_b32 v22, s34
v_mov_b32 v23, s34
v_mov_b32 v28, s33
v_mov_b32 v29, s33
v_mov_b32 v30, s33
v_mov_b32 v31, s33
v_med3_f32 v24, v16, v20, v28
v_med3_f32 v25, v17, v20, v28
v_med3_f32 v26, v18, v20, v28
v_med3_f32 v27, v19, v20, v28
s_waitcnt lgkmcnt(4)
s_add_u32 m0, s29, 98304
M v[96:99], a[116:119], a[0:3], v[24:27]
v_exp_f32 v64, v64
M v[96:99], a[120:123], a[4:7], v[96:99]
ds_read_b128 a[148:151], v2 offset:8192
ds_read_b128 a[152:155], v2 offset:9216
M v[96:99], a[124:127], a[8:11], v[96:99]
v_exp_f32 v65, v65
M v[96:99], a[128:131], a[12:15], v[96:99]
buffer_load_dwordx4 v1, s[12:15], s26 offen offset:0 sc1 lds
s_add_u32 s32, s26, 4096
M v[100:103], a[128:131], a[28:31], v[28:31]
v_exp_f32 v66, v66
M v[100:103], a[124:127], a[24:27], v[100:103]
v_cvt_pk_bf16_f32 v64, v64, v65
M v[100:103], a[120:123], a[20:23], v[100:103]
v_exp_f32 v67, v67
M v[100:103], a[116:119], a[16:19], v[100:103]
buffer_load_dwordx4 v1, s[12:15], s26 offen offset:1024 sc1 lds
M v[104:107], a[116:119], a[32:35], v[28:31]
v_exp_f32 v80, v80
M v[104:107], a[120:123], a[36:39], v[104:107]
ds_read_b128 a[156:159], v2 offset:10240
ds_read_b128 a[160:163], v2 offset:11264
M v[104:107], a[124:127], a[40:43], v[104:107]
v_exp_f32 v81, v81
M v[104:107], a[128:131], a[44:47], v[104:107]
buffer_load_dwordx4 v1, s[12:15], s26 offen offset:2048 sc1 lds
M v[108:111], a[128:131], a[60:63], v[28:31]
v_exp_f32 v82, v82
M v[108:111], a[124:127], a[56:59], v[108:111]
v_cvt_pk_bf16_f32 v65, v66, v67
v_cvt_pk_bf16_f32 v66, v80, v81
M v[108:111], a[120:123], a[52:55], v[108:111]
v_exp_f32 v83, v83
M v[108:111], a[116:119], a[48:51], v[108:111]
buffer_load_dwordx4 v1, s[12:15], s26 offen offset:3072 sc1 lds
s_add_u32 m0, s29, 102400
s_waitcnt lgkmcnt(4)
M v[112:115], a[132:135], a[0:3], v[20:23]
v_exp_f32 v68, v68
M v[112:115], a[136:139], a[4:7], v[112:115]
ds_read_b128 a[164:167], v2 offset:12288
ds_read_b128 a[168:171], v2 offset:13312
M v[112:115], a[140:143], a[8:11], v[112:115]
v_exp_f32 v69, v69
M v[112:115], a[144:147], a[12:15], v[112:115]
buffer_load_dwordx4 v1, s[12:15], s32 offen offset:0 sc1 lds
M v[116:119], a[144:147], a[28:31], v[24:27]
v_exp_f32 v70, v70
M v[116:119], a[140:143], a[24:27], v[116:119]
v_cvt_pk_bf16_f32 v67, v82, v83
v_cvt_pk_bf16_f32 v68, v68, v69
M v[116:119], a[136:139], a[20:23], v[116:119]
v_exp_f32 v71, v71
M v[116:119], a[132:135], a[16:19], v[116:119]
buffer_load_dwordx4 v1, s[12:15], s32 offen offset:1024 sc1 lds
M v[120:123], a[132:135], a[32:35], v[28:31]
v_exp_f32 v84, v84
M v[120:123], a[136:139], a[36:39], v[120:123]
ds_read_b128 a[172:175], v2 offset:14336
ds_read_b128 a[176:179], v2 offset:15360
M v[120:123], a[140:143], a[40:43], v[120:123]
v_exp_f32 v85, v85
M v[120:123], a[144:147], a[44:47], v[120:123]
buffer_load_dwordx4 v1, s[12:15], s32 offen offset:2048 sc1 lds
M v[124:127], a[144:147], a[60:63], v[28:31]
v_exp_f32 v86, v86
M v[124:127], a[140:143], a[56:59], v[124:127]
v_cvt_pk_bf16_f32 v69, v70, v71
v_cvt_pk_bf16_f32 v70, v84, v85
M v[124:127], a[136:139], a[52:55], v[124:127]
v_exp_f32 v87, v87
M v[124:127], a[132:135], a[48:51], v[124:127]
buffer_load_dwordx4 v1, s[12:15], s32 offen offset:3072 sc1 lds
s_waitcnt lgkmcnt(4)
M v[128:131], a[148:151], a[0:3], v[20:23]
v_exp_f32 v72, v72
M v[128:131], a[152:155], a[4:7], v[128:131]
s_add_u32 s26, s26, 32768
s_cmp_eq_u32 s26, s62
s_cselect_b32 s26, s63, s26
s_cselect_b32 s62, -1, s62
M v[128:131], a[156:159], a[8:11], v[128:131]
v_exp_f32 v73, v73
M v[128:131], a[160:163], a[12:15], v[128:131]
v_cvt_pk_bf16_f32 v71, v86, v87
v_cvt_pk_bf16_f32 v72, v72, v73
M v[132:135], a[160:163], a[28:31], v[20:23]
v_exp_f32 v74, v74
M v[132:135], a[156:159], a[24:27], v[132:135]
M v[132:135], a[152:155], a[20:23], v[132:135]
v_exp_f32 v75, v75
M v[132:135], a[148:151], a[16:19], v[132:135]
v_cvt_pk_bf16_f32 v73, v74, v75
M v[136:139], a[148:151], a[32:35], v[24:27]
v_exp_f32 v88, v88
M v[136:139], a[152:155], a[36:39], v[136:139]
M v[136:139], a[156:159], a[40:43], v[136:139]
v_exp_f32 v89, v89
M v[136:139], a[160:163], a[44:47], v[136:139]
v_cvt_pk_bf16_f32 v74, v88, v89
M v[140:143], a[160:163], a[60:63], v[28:31]
v_exp_f32 v90, v90
M v[140:143], a[156:159], a[56:59], v[140:143]
s_waitcnt vmcnt(16) lgkmcnt(0)
s_barrier
ds_read_b128 a[116:119], v2 offset:32768
ds_read_b128 a[120:123], v2 offset:40960
ds_read_b128 a[124:127], v2 offset:33792
ds_read_b128 a[128:131], v2 offset:41984
M v[140:143], a[152:155], a[52:55], v[140:143]
v_exp_f32 v91, v91
M v[140:143], a[148:151], a[48:51], v[140:143]
v_cvt_pk_bf16_f32 v75, v90, v91
M v[144:147], a[164:167], a[0:3], v[20:23]
v_exp_f32 v76, v76
M v[144:147], a[168:171], a[4:7], v[144:147]
ds_read_b128 a[132:135], v2 offset:34816
ds_read_b128 a[136:139], v2 offset:43008
M v[144:147], a[172:175], a[8:11], v[144:147]
v_exp_f32 v77, v77
M v[144:147], a[176:179], a[12:15], v[144:147]
v_cvt_pk_bf16_f32 v76, v76, v77
M v[148:151], a[176:179], a[28:31], v[20:23]
v_exp_f32 v78, v78
M v[148:151], a[172:175], a[24:27], v[148:151]
M v[148:151], a[168:171], a[20:23], v[148:151]
v_exp_f32 v79, v79
M v[148:151], a[164:167], a[16:19], v[148:151]
v_cvt_pk_bf16_f32 v77, v78, v79
M v[152:155], a[164:167], a[32:35], v[20:23]
v_exp_f32 v92, v92
M v[152:155], a[168:171], a[36:39], v[152:155]
ds_read_b128 a[140:143], v2 offset:35840
ds_read_b128 a[144:147], v2 offset:44032
M v[152:155], a[172:175], a[40:43], v[152:155]
v_exp_f32 v93, v93
M v[152:155], a[176:179], a[44:47], v[152:155]
v_cvt_pk_bf16_f32 v78, v92, v93
M v[156:159], a[176:179], a[60:63], v[24:27]
v_exp_f32 v94, v94
M v[156:159], a[172:175], a[56:59], v[156:159]
M v[156:159], a[168:171], a[52:55], v[156:159]
v_exp_f32 v95, v95
M v[156:159], a[164:167], a[48:51], v[156:159]
v_cvt_pk_bf16_f32 v79, v94, v95
s_waitcnt lgkmcnt(6)
s_add_u32 m0, s29, 0
M v[160:163], a[116:119], v[32:35], v[160:163]
v_exp_f32 v96, v96
M v[160:163], a[120:123], v[64:67], v[160:163]
ds_read_b128 a[148:151], v2 offset:36864
ds_read_b128 a[152:155], v2 offset:45056
M v[164:167], a[120:123], v[68:71], v[164:167]
v_exp_f32 v97, v97
M v[164:167], a[116:119], v[36:39], v[164:167]
buffer_load_dwordx4 v1, s[12:15], s25 offen offset:0 sc1 lds
s_add_u32 s32, s25, 4096
M v[168:171], a[116:119], v[40:43], v[168:171]
v_exp_f32 v98, v98
M v[168:171], a[120:123], v[72:75], v[168:171]
v_cvt_pk_bf16_f32 v96, v96, v97
M v[172:175], a[120:123], v[76:79], v[172:175]
v_exp_f32 v99, v99
M v[172:175], a[116:119], v[44:47], v[172:175]
buffer_load_dwordx4 v1, s[12:15], s25 offen offset:1024 sc1 lds
s_waitcnt lgkmcnt(6)
M a[96:99], a[112:115], v[32:35], a[96:99]
M a[96:99], a[112:115], v[64:67], a[96:99]
M v[176:179], a[124:127], v[32:35], v[176:179]
v_exp_f32 v112, v112
M v[176:179], a[128:131], v[64:67], v[176:179]
ds_read_b128 a[156:159], v2 offset:37888
ds_read_b128 a[160:163], v2 offset:46080
M v[180:183], a[128:131], v[68:71], v[180:183]
v_exp_f32 v113, v113
M v[180:183], a[124:127], v[36:39], v[180:183]
buffer_load_dwordx4 v1, s[12:15], s25 offen offset:2048 sc1 lds
M v[184:187], a[124:127], v[40:43], v[184:187]
v_exp_f32 v114, v114
M v[184:187], a[128:131], v[72:75], v[184:187]
v_cvt_pk_bf16_f32 v97, v98, v99
v_cvt_pk_bf16_f32 v98, v112, v113
M v[188:191], a[128:131], v[76:79], v[188:191]
v_exp_f32 v115, v115
M v[188:191], a[124:127], v[44:47], v[188:191]
buffer_load_dwordx4 v1, s[12:15], s25 offen offset:3072 sc1 lds
s_add_u32 m0, s29, 4096
s_waitcnt lgkmcnt(6)
M a[100:103], a[112:115], v[36:39], a[100:103]
M a[100:103], a[112:115], v[68:71], a[100:103]
M v[192:195], a[132:135], v[32:35], v[192:195]
v_exp_f32 v100, v100
M v[192:195], a[136:139], v[64:67], v[192:195]
ds_read_b128 a[164:167], v2 offset:38912
ds_read_b128 a[168:171], v2 offset:47104
M v[196:199], a[136:139], v[68:71], v[196:199]
v_exp_f32 v101, v101
M v[196:199], a[132:135], v[36:39], v[196:199]
buffer_load_dwordx4 v1, s[12:15], s32 offen offset:0 sc1 lds
M v[200:203], a[132:135], v[40:43], v[200:203]
v_exp_f32 v102, v102
M v[200:203], a[136:139], v[72:75], v[200:203]
v_cvt_pk_bf16_f32 v99, v114, v115
v_cvt_pk_bf16_f32 v100, v100, v101
M v[204:207], a[136:139], v[76:79], v[204:207]
v_exp_f32 v103, v103
M v[204:207], a[132:135], v[44:47], v[204:207]
buffer_load_dwordx4 v1, s[12:15], s32 offen offset:1024 sc1 lds
s_waitcnt lgkmcnt(6)
M a[104:107], a[112:115], v[40:43], a[104:107]
M a[104:107], a[112:115], v[72:75], a[104:107]
M v[208:211], a[140:143], v[32:35], v[208:211]
v_exp_f32 v116, v116
M v[208:211], a[144:147], v[64:67], v[208:211]
ds_read_b128 a[172:175], v2 offset:39936
ds_read_b128 a[176:179], v2 offset:48128
M v[212:215], a[144:147], v[68:71], v[212:215]
v_exp_f32 v117, v117
M v[212:215], a[140:143], v[36:39], v[212:215]
buffer_load_dwordx4 v1, s[12:15], s32 offen offset:2048 sc1 lds
M v[216:219], a[140:143], v[40:43], v[216:219]
v_exp_f32 v118, v118
M v[216:219], a[144:147], v[72:75], v[216:219]
v_cvt_pk_bf16_f32 v101, v102, v103
v_cvt_pk_bf16_f32 v102, v116, v117
M v[220:223], a[144:147], v[76:79], v[220:223]
v_exp_f32 v119, v119
M v[220:223], a[140:143], v[44:47], v[220:223]
buffer_load_dwordx4 v1, s[12:15], s32 offen offset:3072 sc1 lds
s_waitcnt lgkmcnt(6)
M a[108:111], a[112:115], v[44:47], a[108:111]
M a[108:111], a[112:115], v[76:79], a[108:111]
M v[224:227], a[148:151], v[32:35], v[224:227]
v_exp_f32 v104, v104
M v[224:227], a[152:155], v[64:67], v[224:227]
s_add_u32 s25, s25, 32768
s_cmp_eq_u32 s25, s27
s_cselect_b32 s25, s28, s25
s_cselect_b32 s27, -1, s27
M v[228:231], a[152:155], v[68:71], v[228:231]
v_exp_f32 v105, v105
M v[228:231], a[148:151], v[36:39], v[228:231]
v_cvt_pk_bf16_f32 v103, v118, v119
v_cvt_pk_bf16_f32 v104, v104, v105
M v[232:235], a[148:151], v[40:43], v[232:235]
v_exp_f32 v106, v106
M v[232:235], a[152:155], v[72:75], v[232:235]
M v[236:239], a[152:155], v[76:79], v[236:239]
v_exp_f32 v107, v107
M v[236:239], a[148:151], v[44:47], v[236:239]
v_cvt_pk_bf16_f32 v105, v106, v107
s_waitcnt lgkmcnt(4)
M v[240:243], a[156:159], v[32:35], v[240:243]
v_exp_f32 v120, v120
M v[240:243], a[160:163], v[64:67], v[240:243]
M v[244:247], a[160:163], v[68:71], v[244:247]
v_exp_f32 v121, v121
M v[244:247], a[156:159], v[36:39], v[244:247]
v_cvt_pk_bf16_f32 v106, v120, v121
M v[248:251], a[156:159], v[40:43], v[248:251]
v_exp_f32 v122, v122
M v[248:251], a[160:163], v[72:75], v[248:251]
s_waitcnt vmcnt(16) lgkmcnt(0)
s_barrier
ds_read_b128 a[116:119], v3 offset:0
ds_read_b128 a[120:123], v3 offset:1024
ds_read_b128 a[124:127], v3 offset:2048
ds_read_b128 a[128:131], v3 offset:3072
M v[252:255], a[160:163], v[76:79], v[252:255]
v_exp_f32 v123, v123
M v[252:255], a[156:159], v[44:47], v[252:255]
v_cvt_pk_bf16_f32 v107, v122, v123
M a[64:67], a[164:167], v[32:35], a[64:67]
v_exp_f32 v108, v108
M a[64:67], a[168:171], v[64:67], a[64:67]
ds_read_b128 a[132:135], v3 offset:4096
ds_read_b128 a[136:139], v3 offset:5120
M a[68:71], a[168:171], v[68:71], a[68:71]
v_exp_f32 v109, v109
M a[68:71], a[164:167], v[36:39], a[68:71]
v_cvt_pk_bf16_f32 v108, v108, v109
M a[72:75], a[164:167], v[40:43], a[72:75]
v_exp_f32 v110, v110
M a[72:75], a[168:171], v[72:75], a[72:75]
M a[76:79], a[168:171], v[76:79], a[76:79]
v_exp_f32 v111, v111
M a[76:79], a[164:167], v[44:47], a[76:79]
v_cvt_pk_bf16_f32 v109, v110, v111
M a[80:83], a[172:175], v[32:35], a[80:83]
v_exp_f32 v124, v124
M a[80:83], a[176:179], v[64:67], a[80:83]
ds_read_b128 a[140:143], v3 offset:6144
ds_read_b128 a[144:147], v3 offset:7168
M a[84:87], a[176:179], v[68:71], a[84:87]
v_exp_f32 v125, v125
M a[84:87], a[172:175], v[36:39], a[84:87]
v_cvt_pk_bf16_f32 v110, v124, v125
M a[88:91], a[172:175], v[40:43], a[88:91]
v_exp_f32 v126, v126
M a[88:91], a[176:179], v[72:75], a[88:91]
M a[92:95], a[176:179], v[76:79], a[92:95]
v_exp_f32 v127, v127
M a[92:95], a[172:175], v[44:47], a[92:95]
v_cvt_pk_bf16_f32 v111, v126, v127
s_lshl_b32 s33, s23, 6
s_add_i32 s33, s33, -64
s_cmp_gt_i32 s33, 0
s_cselect_b32 s34, 0, 0xf149f2ca
s_cmp_lt_i32 s33, 0
s_cselect_b32 s33, 0xf149f2ca, 0
v_mov_b32 v20, s34
v_mov_b32 v21, s34
v_mov_b32 v22, s34
v_mov_b32 v23, s34
v_mov_b32 v28, s33
v_mov_b32 v29, s33
v_mov_b32 v30, s33
v_mov_b32 v31, s33
v_med3_f32 v24, v16, v20, v28
v_med3_f32 v25, v17, v20, v28
v_med3_f32 v26, v18, v20, v28
v_med3_f32 v27, v19, v20, v28
s_waitcnt lgkmcnt(4)
s_add_u32 m0, s29, 32768
M v[32:35], a[116:119], a[0:3], v[24:27]
v_exp_f32 v128, v128
M v[32:35], a[120:123], a[4:7], v[32:35]
ds_read_b128 a[148:151], v3 offset:8192
ds_read_b128 a[152:155], v3 offset:9216
M v[32:35], a[124:127], a[8:11], v[32:35]
v_exp_f32 v129, v129
M v[32:35], a[128:131], a[12:15], v[32:35]
buffer_load_dwordx4 v1, s[12:15], s26 offen offset:0 sc1 lds
s_add_u32 s32, s26, 4096
M v[36:39], a[128:131], a[28:31], v[28:31]
v_exp_f32 v130, v130
M v[36:39], a[124:127], a[24:27], v[36:39]
v_cvt_pk_bf16_f32 v128, v128, v129
M v[36:39], a[120:123], a[20:23], v[36:39]
v_exp_f32 v131, v131
M v[36:39], a[116:119], a[16:19], v[36:39]
buffer_load_dwordx4 v1, s[12:15], s26 offen offset:1024 sc1 lds
M v[40:43], a[116:119], a[32:35], v[28:31]
v_exp_f32 v144, v144
M v[40:43], a[120:123], a[36:39], v[40:43]
ds_read_b128 a[156:159], v3 offset:10240
ds_read_b128 a[160:163], v3 offset:11264
M v[40:43], a[124:127], a[40:43], v[40:43]
v_exp_f32 v145, v145
M v[40:43], a[128:131], a[44:47], v[40:43]
buffer_load_dwordx4 v1, s[12:15], s26 offen offset:2048 sc1 lds
M v[44:47], a[128:131], a[60:63], v[28:31]
v_exp_f32 v146, v146
M v[44:47], a[124:127], a[56:59], v[44:47]
v_cvt_pk_bf16_f32 v129, v130, v131
v_cvt_pk_bf16_f32 v130, v144, v145
M v[44:47], a[120:123], a[52:55], v[44:47]
v_exp_f32 v147, v147
M v[44:47], a[116:119], a[48:51], v[44:47]
buffer_load_dwordx4 v1, s[12:15], s26 offen offset:3072 sc1 lds
s_add_u32 m0, s29, 36864
s_waitcnt lgkmcnt(4)
M v[48:51], a[132:135], a[0:3], v[20:23]
v_exp_f32 v132, v132
M v[48:51], a[136:139], a[4:7], v[48:51]
ds_read_b128 a[164:167], v3 offset:12288
ds_read_b128 a[168:171], v3 offset:13312
M v[48:51], a[140:143], a[8:11], v[48:51]
v_exp_f32 v133, v133
M v[48:51], a[144:147], a[12:15], v[48:51]
buffer_load_dwordx4 v1, s[12:15], s32 offen offset:0 sc1 lds
M v[52:55], a[144:147], a[28:31], v[24:27]
v_exp_f32 v134, v134
M v[52:55], a[140:143], a[24:27], v[52:55]
v_cvt_pk_bf16_f32 v131, v146, v147
v_cvt_pk_bf16_f32 v132, v132, v133
M v[52:55], a[136:139], a[20:23], v[52:55]
v_exp_f32 v135, v135
M v[52:55], a[132:135], a[16:19], v[52:55]
buffer_load_dwordx4 v1, s[12:15], s32 offen offset:1024 sc1 lds
M v[56:59], a[132:135], a[32:35], v[28:31]
v_exp_f32 v148, v148
M v[56:59], a[136:139], a[36:39], v[56:59]
ds_read_b128 a[172:175], v3 offset:14336
ds_read_b128 a[176:179], v3 offset:15360
M v[56:59], a[140:143], a[40:43], v[56:59]
v_exp_f32 v149, v149
M v[56:59], a[144:147], a[44:47], v[56:59]
buffer_load_dwordx4 v1, s[12:15], s32 offen offset:2048 sc1 lds
M v[60:63], a[144:147], a[60:63], v[28:31]
v_exp_f32 v150, v150
M v[60:63], a[140:143], a[56:59], v[60:63]
v_cvt_pk_bf16_f32 v133, v134, v135
v_cvt_pk_bf16_f32 v134, v148, v149
M v[60:63], a[136:139], a[52:55], v[60:63]
v_exp_f32 v151, v151
M v[60:63], a[132:135], a[48:51], v[60:63]
buffer_load_dwordx4 v1, s[12:15], s32 offen offset:3072 sc1 lds
s_waitcnt lgkmcnt(4)
M v[64:67], a[148:151], a[0:3], v[20:23]
v_exp_f32 v136, v136
M v[64:67], a[152:155], a[4:7], v[64:67]
s_add_u32 s26, s26, 32768
s_cmp_eq_u32 s26, s62
s_cselect_b32 s26, s63, s26
s_cselect_b32 s62, -1, s62
M v[64:67], a[156:159], a[8:11], v[64:67]
v_exp_f32 v137, v137
M v[64:67], a[160:163], a[12:15], v[64:67]
v_cvt_pk_bf16_f32 v135, v150, v151
v_cvt_pk_bf16_f32 v136, v136, v137
M v[68:71], a[160:163], a[28:31], v[20:23]
v_exp_f32 v138, v138
M v[68:71], a[156:159], a[24:27], v[68:71]
M v[68:71], a[152:155], a[20:23], v[68:71]
v_exp_f32 v139, v139
M v[68:71], a[148:151], a[16:19], v[68:71]
v_cvt_pk_bf16_f32 v137, v138, v139
M v[72:75], a[148:151], a[32:35], v[24:27]
v_exp_f32 v152, v152
M v[72:75], a[152:155], a[36:39], v[72:75]
M v[72:75], a[156:159], a[40:43], v[72:75]
v_exp_f32 v153, v153
M v[72:75], a[160:163], a[44:47], v[72:75]
v_cvt_pk_bf16_f32 v138, v152, v153
M v[76:79], a[160:163], a[60:63], v[28:31]
v_exp_f32 v154, v154
M v[76:79], a[156:159], a[56:59], v[76:79]
s_waitcnt vmcnt(16) lgkmcnt(0)
s_barrier
ds_read_b128 a[116:119], v3 offset:32768
ds_read_b128 a[120:123], v3 offset:40960
ds_read_b128 a[124:127], v3 offset:33792
ds_read_b128 a[128:131], v3 offset:41984
M v[76:79], a[152:155], a[52:55], v[76:79]
v_exp_f32 v155, v155
M v[76:79], a[148:151], a[48:51], v[76:79]
v_cvt_pk_bf16_f32 v139, v154, v155
M v[80:83], a[164:167], a[0:3], v[20:23]
v_exp_f32 v140, v140
M v[80:83], a[168:171], a[4:7], v[80:83]
ds_read_b128 a[132:135], v3 offset:34816
ds_read_b128 a[136:139], v3 offset:43008
M v[80:83], a[172:175], a[8:11], v[80:83]
v_exp_f32 v141, v141
M v[80:83], a[176:179], a[12:15], v[80:83]
v_cvt_pk_bf16_f32 v140, v140, v141
M v[84:87], a[176:179], a[28:31], v[20:23]
v_exp_f32 v142, v142
M v[84:87], a[172:175], a[24:27], v[84:87]
M v[84:87], a[168:171], a[20:23], v[84:87]
v_exp_f32 v143, v143
M v[84:87], a[164:167], a[16:19], v[84:87]
v_cvt_pk_bf16_f32 v141, v142, v143
M v[88:91], a[164:167], a[32:35], v[20:23]
v_exp_f32 v156, v156
M v[88:91], a[168:171], a[36:39], v[88:91]
ds_read_b128 a[140:143], v3 offset:35840
ds_read_b128 a[144:147], v3 offset:44032
M v[88:91], a[172:175], a[40:43], v[88:91]
v_exp_f32 v157, v157
M v[88:91], a[176:179], a[44:47], v[88:91]
v_cvt_pk_bf16_f32 v142, v156, v157
M v[92:95], a[176:179], a[60:63], v[24:27]
v_exp_f32 v158, v158
M v[92:95], a[172:175], a[56:59], v[92:95]
M v[92:95], a[168:171], a[52:55], v[92:95]
v_exp_f32 v159, v159
M v[92:95], a[164:167], a[48:51], v[92:95]
v_cvt_pk_bf16_f32 v143, v158, v159
s_waitcnt lgkmcnt(6)
s_add_u32 m0, s29, 65536
M v[160:163], a[116:119], v[96:99], v[160:163]
v_exp_f32 v32, v32
M v[160:163], a[120:123], v[128:131], v[160:163]
ds_read_b128 a[148:151], v3 offset:36864
ds_read_b128 a[152:155], v3 offset:45056
M v[164:167], a[120:123], v[132:135], v[164:167]
v_exp_f32 v33, v33
M v[164:167], a[116:119], v[100:103], v[164:167]
buffer_load_dwordx4 v1, s[12:15], s25 offen offset:0 sc1 lds
s_add_u32 s32, s25, 4096
M v[168:171], a[116:119], v[104:107], v[168:171]
v_exp_f32 v34, v34
M v[168:171], a[120:123], v[136:139], v[168:171]
v_cvt_pk_bf16_f32 v32, v32, v33
M v[172:175], a[120:123], v[140:143], v[172:175]
v_exp_f32 v35, v35
M v[172:175], a[116:119], v[108:111], v[172:175]
buffer_load_dwordx4 v1, s[12:15], s25 offen offset:1024 sc1 lds
s_waitcnt lgkmcnt(6)
M a[96:99], a[112:115], v[96:99], a[96:99]
M a[96:99], a[112:115], v[128:131], a[96:99]
M v[176:179], a[124:127], v[96:99], v[176:179]
v_exp_f32 v48, v48
M v[176:179], a[128:131], v[128:131], v[176:179]
ds_read_b128 a[156:159], v3 offset:37888
ds_read_b128 a[160:163], v3 offset:46080
M v[180:183], a[128:131], v[132:135], v[180:183]
v_exp_f32 v49, v49
M v[180:183], a[124:127], v[100:103], v[180:183]
buffer_load_dwordx4 v1, s[12:15], s25 offen offset:2048 sc1 lds
M v[184:187], a[124:127], v[104:107], v[184:187]
v_exp_f32 v50, v50
M v[184:187], a[128:131], v[136:139], v[184:187]
v_cvt_pk_bf16_f32 v33, v34, v35
v_cvt_pk_bf16_f32 v34, v48, v49
M v[188:191], a[128:131], v[140:143], v[188:191]
v_exp_f32 v51, v51
M v[188:191], a[124:127], v[108:111], v[188:191]
buffer_load_dwordx4 v1, s[12:15], s25 offen offset:3072 sc1 lds
s_add_u32 m0, s29, 69632
s_waitcnt lgkmcnt(6)
M a[100:103], a[112:115], v[100:103], a[100:103]
M a[100:103], a[112:115], v[132:135], a[100:103]
M v[192:195], a[132:135], v[96:99], v[192:195]
v_exp_f32 v36, v36
M v[192:195], a[136:139], v[128:131], v[192:195]
ds_read_b128 a[164:167], v3 offset:38912
ds_read_b128 a[168:171], v3 offset:47104
M v[196:199], a[136:139], v[132:135], v[196:199]
v_exp_f32 v37, v37
M v[196:199], a[132:135], v[100:103], v[196:199]
buffer_load_dwordx4 v1, s[12:15], s32 offen offset:0 sc1 lds
M v[200:203], a[132:135], v[104:107], v[200:203]
v_exp_f32 v38, v38
M v[200:203], a[136:139], v[136:139], v[200:203]
v_cvt_pk_bf16_f32 v35, v50, v51
v_cvt_pk_bf16_f32 v36, v36, v37
M v[204:207], a[136:139], v[140:143], v[204:207]
v_exp_f32 v39, v39
M v[204:207], a[132:135], v[108:111], v[204:207]
buffer_load_dwordx4 v1, s[12:15], s32 offen offset:1024 sc1 lds
s_waitcnt lgkmcnt(6)
M a[104:107], a[112:115], v[104:107], a[104:107]
M a[104:107], a[112:115], v[136:139], a[104:107]
M v[208:211], a[140:143], v[96:99], v[208:211]
v_exp_f32 v52, v52
M v[208:211], a[144:147], v[128:131], v[208:211]
ds_read_b128 a[172:175], v3 offset:39936
ds_read_b128 a[176:179], v3 offset:48128
M v[212:215], a[144:147], v[132:135], v[212:215]
v_exp_f32 v53, v53
M v[212:215], a[140:143], v[100:103], v[212:215]
buffer_load_dwordx4 v1, s[12:15], s32 offen offset:2048 sc1 lds
M v[216:219], a[140:143], v[104:107], v[216:219]
v_exp_f32 v54, v54
M v[216:219], a[144:147], v[136:139], v[216:219]
v_cvt_pk_bf16_f32 v37, v38, v39
v_cvt_pk_bf16_f32 v38, v52, v53
M v[220:223], a[144:147], v[140:143], v[220:223]
v_exp_f32 v55, v55
M v[220:223], a[140:143], v[108:111], v[220:223]
buffer_load_dwordx4 v1, s[12:15], s32 offen offset:3072 sc1 lds
s_waitcnt lgkmcnt(6)
M a[108:111], a[112:115], v[108:111], a[108:111]
M a[108:111], a[112:115], v[140:143], a[108:111]
M v[224:227], a[148:151], v[96:99], v[224:227]
v_exp_f32 v40, v40
M v[224:227], a[152:155], v[128:131], v[224:227]
s_add_u32 s25, s25, 32768
s_cmp_eq_u32 s25, s27
s_cselect_b32 s25, s28, s25
s_cselect_b32 s27, -1, s27
M v[228:231], a[152:155], v[132:135], v[228:231]
v_exp_f32 v41, v41
M v[228:231], a[148:151], v[100:103], v[228:231]
v_cvt_pk_bf16_f32 v39, v54, v55
v_cvt_pk_bf16_f32 v40, v40, v41
M v[232:235], a[148:151], v[104:107], v[232:235]
v_exp_f32 v42, v42
M v[232:235], a[152:155], v[136:139], v[232:235]
M v[236:239], a[152:155], v[140:143], v[236:239]
v_exp_f32 v43, v43
M v[236:239], a[148:151], v[108:111], v[236:239]
v_cvt_pk_bf16_f32 v41, v42, v43
s_waitcnt lgkmcnt(4)
M v[240:243], a[156:159], v[96:99], v[240:243]
v_exp_f32 v56, v56
M v[240:243], a[160:163], v[128:131], v[240:243]
M v[244:247], a[160:163], v[132:135], v[244:247]
v_exp_f32 v57, v57
M v[244:247], a[156:159], v[100:103], v[244:247]
v_cvt_pk_bf16_f32 v42, v56, v57
M v[248:251], a[156:159], v[104:107], v[248:251]
v_exp_f32 v58, v58
M v[248:251], a[160:163], v[136:139], v[248:251]
s_waitcnt vmcnt(16) lgkmcnt(0)
s_barrier
ds_read_b128 a[116:119], v2 offset:0
ds_read_b128 a[120:123], v2 offset:1024
ds_read_b128 a[124:127], v2 offset:2048
ds_read_b128 a[128:131], v2 offset:3072
M v[252:255], a[160:163], v[140:143], v[252:255]
v_exp_f32 v59, v59
M v[252:255], a[156:159], v[108:111], v[252:255]
v_cvt_pk_bf16_f32 v43, v58, v59
M a[64:67], a[164:167], v[96:99], a[64:67]
v_exp_f32 v44, v44
M a[64:67], a[168:171], v[128:131], a[64:67]
ds_read_b128 a[132:135], v2 offset:4096
ds_read_b128 a[136:139], v2 offset:5120
M a[68:71], a[168:171], v[132:135], a[68:71]
v_exp_f32 v45, v45
M a[68:71], a[164:167], v[100:103], a[68:71]
v_cvt_pk_bf16_f32 v44, v44, v45
M a[72:75], a[164:167], v[104:107], a[72:75]
v_exp_f32 v46, v46
M a[72:75], a[168:171], v[136:139], a[72:75]
M a[76:79], a[168:171], v[140:143], a[76:79]
v_exp_f32 v47, v47
M a[76:79], a[164:167], v[108:111], a[76:79]
v_cvt_pk_bf16_f32 v45, v46, v47
M a[80:83], a[172:175], v[96:99], a[80:83]
v_exp_f32 v60, v60
M a[80:83], a[176:179], v[128:131], a[80:83]
ds_read_b128 a[140:143], v2 offset:6144
ds_read_b128 a[144:147], v2 offset:7168
M a[84:87], a[176:179], v[132:135], a[84:87]
v_exp_f32 v61, v61
M a[84:87], a[172:175], v[100:103], a[84:87]
v_cvt_pk_bf16_f32 v46, v60, v61
M a[88:91], a[172:175], v[104:107], a[88:91]
v_exp_f32 v62, v62
M a[88:91], a[176:179], v[136:139], a[88:91]
M a[92:95], a[176:179], v[140:143], a[92:95]
v_exp_f32 v63, v63
M a[92:95], a[172:175], v[108:111], a[92:95]
v_cvt_pk_bf16_f32 v47, v62, v63
s_waitcnt lgkmcnt(0)
Lk2_fin:
s_waitcnt vmcnt(8)
s_barrier
s_and_b32 s3, s2, 3
s_lshl_b32 s3, s3, 2
s_bfe_u32 s27, s2, 0x20003
s_add_u32 s27, s3, s27
s_lshl_b32 s43, s27, 8
s_add_u32 s43, s43, 8400896
v_lshlrev_b32 v15, 2, v0
buffer_load_dword v7, v15, s[52:55], s43 offen sc1
s_lshl_b32 s33, s2, 2
s_add_u32 s33, s33, s22
s_lshl_b32 s34, s33, 11
s_lshl_b32 s33, s33, 13
v_lshlrev_b32 v8, 3, v1
v_lshlrev_b32 v9, 1, v1
buffer_load_dword v5, v8, s[44:47], s33 offen
buffer_load_dword v6, v9, s[48:51], s34 offen
ds_read_b128 a[116:119], v2 offset:32768
ds_read_b128 a[120:123], v2 offset:40960
ds_read_b128 a[124:127], v2 offset:33792
ds_read_b128 a[128:131], v2 offset:41984
ds_read_b128 a[132:135], v2 offset:34816
ds_read_b128 a[136:139], v2 offset:43008
ds_read_b128 a[140:143], v2 offset:35840
ds_read_b128 a[144:147], v2 offset:44032
v_exp_f32 v64, v64
v_exp_f32 v65, v65
v_exp_f32 v66, v66
v_exp_f32 v67, v67
v_exp_f32 v80, v80
v_exp_f32 v81, v81
v_exp_f32 v82, v82
v_exp_f32 v83, v83
v_cvt_pk_bf16_f32 v64, v64, v65
v_cvt_pk_bf16_f32 v65, v66, v67
v_exp_f32 v68, v68
v_exp_f32 v69, v69
v_exp_f32 v70, v70
v_exp_f32 v71, v71
v_cvt_pk_bf16_f32 v66, v80, v81
v_cvt_pk_bf16_f32 v67, v82, v83
v_exp_f32 v84, v84
v_exp_f32 v85, v85
v_exp_f32 v86, v86
v_exp_f32 v87, v87
v_cvt_pk_bf16_f32 v68, v68, v69
v_cvt_pk_bf16_f32 v69, v70, v71
v_exp_f32 v72, v72
v_exp_f32 v73, v73
v_exp_f32 v74, v74
v_exp_f32 v75, v75
v_cvt_pk_bf16_f32 v70, v84, v85
v_cvt_pk_bf16_f32 v71, v86, v87
v_exp_f32 v88, v88
v_exp_f32 v89, v89
v_exp_f32 v90, v90
v_exp_f32 v91, v91
v_cvt_pk_bf16_f32 v72, v72, v73
v_cvt_pk_bf16_f32 v73, v74, v75
v_exp_f32 v76, v76
v_exp_f32 v77, v77
v_exp_f32 v78, v78
v_exp_f32 v79, v79
v_cvt_pk_bf16_f32 v74, v88, v89
v_cvt_pk_bf16_f32 v75, v90, v91
v_exp_f32 v92, v92
v_exp_f32 v93, v93
v_exp_f32 v94, v94
v_exp_f32 v95, v95
v_cvt_pk_bf16_f32 v76, v76, v77
v_cvt_pk_bf16_f32 v77, v78, v79
v_cvt_pk_bf16_f32 v78, v92, v93
v_cvt_pk_bf16_f32 v79, v94, v95
s_waitcnt lgkmcnt(6)
M v[160:163], a[116:119], v[32:35], v[160:163]
M v[160:163], a[120:123], v[64:67], v[160:163]
ds_read_b128 a[148:151], v2 offset:36864
ds_read_b128 a[152:155], v2 offset:45056
s_mov_b32 s61, 0
M v[164:167], a[120:123], v[68:71], v[164:167]
M v[164:167], a[116:119], v[36:39], v[164:167]
s_bfe_u32 s3, s2, 0x10002
M v[168:171], a[116:119], v[40:43], v[168:171]
M v[168:171], a[120:123], v[72:75], v[168:171]
s_lshl_b32 s3, s3, 3
M v[172:175], a[120:123], v[76:79], v[172:175]
M v[172:175], a[116:119], v[44:47], v[172:175]
s_waitcnt lgkmcnt(6)
s_lshr_b32 s28, s2, 5
M a[96:99], a[112:115], v[32:35], a[96:99]
M a[96:99], a[112:115], v[64:67], a[96:99]
M v[176:179], a[124:127], v[32:35], v[176:179]
M v[176:179], a[128:131], v[64:67], v[176:179]
ds_read_b128 a[156:159], v2 offset:37888
ds_read_b128 a[160:163], v2 offset:46080
s_add_u32 s28, s3, s28
M v[180:183], a[128:131], v[68:71], v[180:183]
s_lshl_b32 s25, s27, 18
M v[180:183], a[124:127], v[36:39], v[180:183]
M v[184:187], a[124:127], v[40:43], v[184:187]
s_lshl_b32 s3, s101, 12
M v[184:187], a[128:131], v[72:75], v[184:187]
M v[188:191], a[128:131], v[76:79], v[188:191]
s_add_u32 s25, s25, s3
M v[188:191], a[124:127], v[44:47], v[188:191]
s_waitcnt lgkmcnt(6)
M a[100:103], a[112:115], v[36:39], a[100:103]
M a[100:103], a[112:115], v[68:71], a[100:103]
M v[192:195], a[132:135], v[32:35], v[192:195]
s_lshl_b32 s26, s28, 7
M v[192:195], a[136:139], v[64:67], v[192:195]
ds_read_b128 a[164:167], v2 offset:38912
ds_read_b128 a[168:171], v2 offset:47104
M v[196:199], a[136:139], v[68:71], v[196:199]
s_lshl_b32 s42, s101, 11
M v[196:199], a[132:135], v[36:39], v[196:199]
M v[200:203], a[132:135], v[40:43], v[200:203]
s_add_u32 s44, s4, 83886080
s_addc_u32 s45, s5, 0
M v[200:203], a[136:139], v[72:75], v[200:203]
s_mov_b32 s46, 4194304
M v[204:207], a[136:139], v[76:79], v[204:207]
M v[204:207], a[132:135], v[44:47], v[204:207]
s_waitcnt lgkmcnt(6)
s_mov_b32 s47, 0x00020000
M a[104:107], a[112:115], v[40:43], a[104:107]
M a[104:107], a[112:115], v[72:75], a[104:107]
M v[208:211], a[140:143], v[32:35], v[208:211]
M v[208:211], a[144:147], v[64:67], v[208:211]
ds_read_b128 a[172:175], v2 offset:39936
ds_read_b128 a[176:179], v2 offset:48128
s_mov_b32 s50, 2097152
M v[212:215], a[144:147], v[68:71], v[212:215]
M v[212:215], a[140:143], v[36:39], v[212:215]
s_mov_b32 s51, 0x00020000
M v[216:219], a[140:143], v[40:43], v[216:219]
M v[216:219], a[144:147], v[72:75], v[216:219]
s_lshl_b32 s3, s101, 4
M v[220:223], a[144:147], v[76:79], v[220:223]
M v[220:223], a[140:143], v[44:47], v[220:223]
s_waitcnt lgkmcnt(6)
v_lshrrev_b32 v96, 3, v0
M a[108:111], a[112:115], v[44:47], a[108:111]
M a[108:111], a[112:115], v[76:79], a[108:111]
M v[224:227], a[148:151], v[32:35], v[224:227]
v_and_b32 v97, 6, v96
M v[224:227], a[152:155], v[64:67], v[224:227]
M v[228:231], a[152:155], v[68:71], v[228:231]
v_and_b32 v98, 7, v0
M v[228:231], a[148:151], v[36:39], v[228:231]
M v[232:235], a[148:151], v[40:43], v[232:235]
v_xor_b32 v97, v97, v98
M v[232:235], a[152:155], v[72:75], v[232:235]
M v[236:239], a[152:155], v[76:79], v[236:239]
v_add_u32 v96, s3, v96
M v[236:239], a[148:151], v[44:47], v[236:239]
s_waitcnt lgkmcnt(4)
M v[240:243], a[156:159], v[32:35], v[240:243]
v_lshlrev_b32 v96, 11, v96
M v[240:243], a[160:163], v[64:67], v[240:243]
M v[244:247], a[160:163], v[68:71], v[244:247]
v_lshl_add_u32 v99, v97, 4, v96
M v[244:247], a[156:159], v[36:39], v[244:247]
v_add_u32 v100, 15360, v99
M v[248:251], a[156:159], v[40:43], v[248:251]
M v[248:251], a[160:163], v[72:75], v[248:251]
s_waitcnt vmcnt(2) lgkmcnt(0)
s_barrier
v_cmp_ne_u32 vcc, 1, v7
s_nop 0
s_cbranch_vccnz Lk3_spinb0
Lk3_gotb0:
M v[252:255], a[160:163], v[76:79], v[252:255]
s_add_u32 m0, s42, 65536
s_nop 0
buffer_load_dwordx4 v99, s[48:51], s26 offen offset:0 lds
buffer_load_dwordx4 v100, s[48:51], s26 offen offset:1024 lds
M v[252:255], a[156:159], v[44:47], v[252:255]
buffer_load_dwordx4 a[192:195], v1, s[44:47], s25 offen offset:0 sc1
buffer_load_dwordx4 a[196:199], v1, s[44:47], s25 offen offset:1024 sc1
M a[64:67], a[164:167], v[32:35], a[64:67]
buffer_load_dwordx4 a[200:203], v1, s[44:47], s25 offen offset:2048 sc1
buffer_load_dwordx4 a[204:207], v1, s[44:47], s25 offen offset:3072 sc1
M a[64:67], a[168:171], v[64:67], a[64:67]
s_add_u32 s25, s25, 16384
s_add_u32 s26, s26, 131072
s_add_u32 m0, s42, 81920
s_nop 0
buffer_load_dwordx4 v99, s[48:51], s26 offen offset:0 lds
M a[68:71], a[168:171], v[68:71], a[68:71]
buffer_load_dwordx4 v100, s[48:51], s26 offen offset:1024 lds
buffer_load_dwordx4 a[208:211], v1, s[44:47], s25 offen offset:0 sc1
M a[68:71], a[164:167], v[36:39], a[68:71]
buffer_load_dwordx4 a[212:215], v1, s[44:47], s25 offen offset:1024 sc1
buffer_load_dwordx4 a[216:219], v1, s[44:47], s25 offen offset:2048 sc1
M a[72:75], a[164:167], v[40:43], a[72:75]
buffer_load_dwordx4 a[220:223], v1, s[44:47], s25 offen offset:3072 sc1
s_add_u32 s25, s25, 16384
s_add_u32 s26, s26, 131072
M a[72:75], a[168:171], v[72:75], a[72:75]
s_add_u32 m0, s42, 98304
s_nop 0
buffer_load_dwordx4 v99, s[48:51], s26 offen offset:0 lds
buffer_load_dwordx4 v100, s[48:51], s26 offen offset:1024 lds
M a[76:79], a[168:171], v[76:79], a[76:79]
buffer_load_dwordx4 a[224:227], v1, s[44:47], s25 offen offset:0 sc1
M a[76:79], a[164:167], v[44:47], a[76:79]
buffer_load_dwordx4 a[228:231], v1, s[44:47], s25 offen offset:1024 sc1
buffer_load_dwordx4 a[232:235], v1, s[44:47], s25 offen offset:2048 sc1
M a[80:83], a[172:175], v[32:35], a[80:83]
buffer_load_dwordx4 a[236:239], v1, s[44:47], s25 offen offset:3072 sc1
s_add_u32 s25, s25, 16384
s_add_u32 s26, s26, 131072
M a[80:83], a[176:179], v[64:67], a[80:83]
s_add_u32 m0, s42, 114688
s_nop 0
buffer_load_dwordx4 v99, s[48:51], s26 offen offset:0 lds
buffer_load_dwordx4 v100, s[48:51], s26 offen offset:1024 lds
M a[84:87], a[176:179], v[68:71], a[84:87]
buffer_load_dwordx4 a[240:243], v1, s[44:47], s25 offen offset:0 sc1
buffer_load_dwordx4 a[244:247], v1, s[44:47], s25 offen offset:1024 sc1
M a[84:87], a[172:175], v[36:39], a[84:87]
buffer_load_dwordx4 a[248:251], v1, s[44:47], s25 offen offset:2048 sc1
buffer_load_dwordx4 a[252:255], v1, s[44:47], s25 offen offset:3072 sc1
M a[88:91], a[172:175], v[40:43], a[88:91]
s_add_u32 s25, s25, 16384
s_add_u32 s26, s26, 131072
s_add_u32 m0, s42, 0
s_nop 0
buffer_load_dwordx4 v99, s[48:51], s26 offen offset:0 lds
M a[88:91], a[176:179], v[72:75], a[88:91]
buffer_load_dwordx4 v100, s[48:51], s26 offen offset:1024 lds
buffer_load_dwordx4 a[128:131], v1, s[44:47], s25 offen offset:0 sc1
M a[92:95], a[176:179], v[76:79], a[92:95]
buffer_load_dwordx4 a[132:135], v1, s[44:47], s25 offen offset:1024 sc1
buffer_load_dwordx4 a[136:139], v1, s[44:47], s25 offen offset:2048 sc1
M a[92:95], a[172:175], v[44:47], a[92:95]
buffer_load_dwordx4 a[140:143], v1, s[44:47], s25 offen offset:3072 sc1
s_add_u32 s25, s25, 16384
s_add_u32 s26, s26, 131072
Lk2_merge:
s_lshl_b32 s33, s23, 14
s_add_u32 s34, s33, 131072
s_add_u32 s33, s33, 32768
s_cmp_eq_u32 s24, 0
s_cselect_b32 s35, s34, s33
s_cselect_b32 s36, s33, s34
v_add_u32 v2, s35, v1
v_add_u32 v3, s36, v1
s_lshl_b32 s33, s22, 10
s_add_u32 s33, s33, 28672
s_xor_b32 s34, s33, 2048
v_add_u32 v14, s33, v1
v_add_u32 v15, s34, v1
v_accvgpr_read_b32 v20, a96
v_accvgpr_read_b32 v21, a100
v_accvgpr_read_b32 v22, a104
v_accvgpr_read_b32 v23, a108
ds_write_b128 v14, v[20:23]
s_cmp_eq_u32 s24, 1
s_waitcnt lgkmcnt(0)
s_cbranch_scc1 Lk2_mg1
ds_write_b128 v2, v[224:227] offset:0
ds_write_b128 v2, v[228:231] offset:1024
ds_write_b128 v2, v[232:235] offset:2048
ds_write_b128 v2, v[236:239] offset:3072
ds_write_b128 v2, v[240:243] offset:4096
ds_write_b128 v2, v[244:247] offset:5120
ds_write_b128 v2, v[248:251] offset:6144
ds_write_b128 v2, v[252:255] offset:7168
ds_write_b128 v2, a[64:67] offset:8192
ds_write_b128 v2, a[68:71] offset:9216
ds_write_b128 v2, a[72:75] offset:10240
ds_write_b128 v2, a[76:79] offset:11264
ds_write_b128 v2, a[80:83] offset:12288
ds_write_b128 v2, a[84:87] offset:13312
ds_write_b128 v2, a[88:91] offset:14336
ds_write_b128 v2, a[92:95] offset:15360
s_waitcnt lgkmcnt(0)
s_barrier
ds_read_b128 v[28:31], v15
ds_read_b128 v[32:35], v3 offset:0
ds_read_b128 v[36:39], v3 offset:1024
ds_read_b128 v[40:43], v3 offset:2048
ds_read_b128 v[44:47], v3 offset:3072
ds_read_b128 v[48:51], v3 offset:4096
ds_read_b128 v[52:55], v3 offset:5120
ds_read_b128 v[56:59], v3 offset:6144
ds_read_b128 v[60:63], v3 offset:7168
ds_read_b128 v[64:67], v3 offset:8192
ds_read_b128 v[68:71], v3 offset:9216
ds_read_b128 v[72:75], v3 offset:10240
ds_read_b128 v[76:79], v3 offset:11264
ds_read_b128 v[80:83], v3 offset:12288
ds_read_b128 v[84:87], v3 offset:13312
ds_read_b128 v[88:91], v3 offset:14336
ds_read_b128 v[92:95], v3 offset:15360
s_waitcnt lgkmcnt(15)
v_add_f32 v20, v20, v28
v_add_f32 v21, v21, v29
v_add_f32 v22, v22, v30
v_add_f32 v23, v23, v31
s_sub_u32 s35, 15, s21
v_rcp_f32 v8, v20
v_rcp_f32 v9, v21
v_rcp_f32 v10, v22
v_rcp_f32 v11, v23
v_subrev_u32 v20, 0x21800000, v20
v_subrev_u32 v21, 0x21800000, v21
v_subrev_u32 v22, 0x21800000, v22
v_subrev_u32 v23, 0x21800000, v23
v_max_u32 v12, v20, v21
v_max3_u32 v12, v12, v22, v23
s_mov_b32 s64, 0x207
v_pk_add_f32 v[160:161], v[160:161], v[32:33]
v_pk_add_f32 v[162:163], v[162:163], v[34:35]
s_waitcnt lgkmcnt(11)
v_pk_add_f32 v[176:177], v[176:177], v[48:49]
v_pk_add_f32 v[178:179], v[178:179], v[50:51]
v_pk_mul_f32 v[160:161], v[160:161], v[8:9] op_sel:[0,0] op_sel_hi:[1,0]
v_pk_mul_f32 v[162:163], v[162:163], v[8:9] op_sel:[0,0] op_sel_hi:[1,0]
v_pk_mul_f32 v[176:177], v[176:177], v[8:9] op_sel:[0,0] op_sel_hi:[1,0]
v_pk_mul_f32 v[178:179], v[178:179], v[8:9] op_sel:[0,0] op_sel_hi:[1,0]
v_cvt_pk_bf16_f32 v160, v160, v161
v_cvt_pk_bf16_f32 v161, v162, v163
v_cvt_pk_bf16_f32 v162, v176, v177
v_cvt_pk_bf16_f32 v163, v178, v179
v_pk_add_f32 v[164:165], v[164:165], v[36:37]
v_pk_add_f32 v[166:167], v[166:167], v[38:39]
s_waitcnt lgkmcnt(10)
v_pk_add_f32 v[180:181], v[180:181], v[52:53]
v_pk_add_f32 v[182:183], v[182:183], v[54:55]
M v[24:27], a[112:115], v[160:163], 0
v_pk_mul_f32 v[164:165], v[164:165], v[8:9] op_sel:[0,1] op_sel_hi:[1,1]
v_pk_mul_f32 v[166:167], v[166:167], v[8:9] op_sel:[0,1] op_sel_hi:[1,1]
v_pk_mul_f32 v[180:181], v[180:181], v[8:9] op_sel:[0,1] op_sel_hi:[1,1]
v_pk_mul_f32 v[182:183], v[182:183], v[8:9] op_sel:[0,1] op_sel_hi:[1,1]
v_cvt_pk_bf16_f32 v164, v164, v165
v_cvt_pk_bf16_f32 v165, v166, v167
v_cvt_pk_bf16_f32 v166, v180, v181
v_cvt_pk_bf16_f32 v167, v182, v183
v_pk_add_f32 v[168:169], v[168:169], v[40:41]
v_pk_add_f32 v[170:171], v[170:171], v[42:43]
s_waitcnt lgkmcnt(9)
v_pk_add_f32 v[184:185], v[184:185], v[56:57]
v_pk_add_f32 v[186:187], v[186:187], v[58:59]
M v[24:27], a[112:115], v[164:167], v[24:27]
v_pk_mul_f32 v[168:169], v[168:169], v[10:11] op_sel:[0,0] op_sel_hi:[1,0]
v_pk_mul_f32 v[170:171], v[170:171], v[10:11] op_sel:[0,0] op_sel_hi:[1,0]
v_pk_mul_f32 v[184:185], v[184:185], v[10:11] op_sel:[0,0] op_sel_hi:[1,0]
v_pk_mul_f32 v[186:187], v[186:187], v[10:11] op_sel:[0,0] op_sel_hi:[1,0]
v_cvt_pk_bf16_f32 v168, v168, v169
v_cvt_pk_bf16_f32 v169, v170, v171
v_cvt_pk_bf16_f32 v170, v184, v185
v_cvt_pk_bf16_f32 v171, v186, v187
v_pk_add_f32 v[172:173], v[172:173], v[44:45]
v_pk_add_f32 v[174:175], v[174:175], v[46:47]
s_waitcnt lgkmcnt(8)
v_pk_add_f32 v[188:189], v[188:189], v[60:61]
v_pk_add_f32 v[190:191], v[190:191], v[62:63]
M v[24:27], a[112:115], v[168:171], v[24:27]
v_pk_mul_f32 v[172:173], v[172:173], v[10:11] op_sel:[0,1] op_sel_hi:[1,1]
v_pk_mul_f32 v[174:175], v[174:175], v[10:11] op_sel:[0,1] op_sel_hi:[1,1]
v_pk_mul_f32 v[188:189], v[188:189], v[10:11] op_sel:[0,1] op_sel_hi:[1,1]
v_pk_mul_f32 v[190:191], v[190:191], v[10:11] op_sel:[0,1] op_sel_hi:[1,1]
v_cvt_pk_bf16_f32 v172, v172, v173
v_cvt_pk_bf16_f32 v173, v174, v175
v_cvt_pk_bf16_f32 v174, v188, v189
v_cvt_pk_bf16_f32 v175, v190, v191
s_waitcnt lgkmcnt(7)
v_pk_add_f32 v[192:193], v[192:193], v[64:65]
v_pk_add_f32 v[194:195], v[194:195], v[66:67]
s_waitcnt lgkmcnt(3)
v_pk_add_f32 v[208:209], v[208:209], v[80:81]
v_pk_add_f32 v[210:211], v[210:211], v[82:83]
M v[24:27], a[112:115], v[172:175], v[24:27]
v_pk_mul_f32 v[192:193], v[192:193], v[8:9] op_sel:[0,0] op_sel_hi:[1,0]
v_pk_mul_f32 v[194:195], v[194:195], v[8:9] op_sel:[0,0] op_sel_hi:[1,0]
v_pk_mul_f32 v[208:209], v[208:209], v[8:9] op_sel:[0,0] op_sel_hi:[1,0]
v_pk_mul_f32 v[210:211], v[210:211], v[8:9] op_sel:[0,0] op_sel_hi:[1,0]
v_cvt_pk_bf16_f32 v192, v192, v193
v_cvt_pk_bf16_f32 v193, v194, v195
v_cvt_pk_bf16_f32 v194, v208, v209
v_cvt_pk_bf16_f32 v195, v210, v211
v_pk_add_f32 v[196:197], v[196:197], v[68:69]
v_pk_add_f32 v[198:199], v[198:199], v[70:71]
s_waitcnt lgkmcnt(2)
v_pk_add_f32 v[212:213], v[212:213], v[84:85]
v_pk_add_f32 v[214:215], v[214:215], v[86:87]
M v[24:27], a[112:115], v[192:195], v[24:27]
v_pk_mul_f32 v[196:197], v[196:197], v[8:9] op_sel:[0,1] op_sel_hi:[1,1]
v_pk_mul_f32 v[198:199], v[198:199], v[8:9] op_sel:[0,1] op_sel_hi:[1,1]
v_pk_mul_f32 v[212:213], v[212:213], v[8:9] op_sel:[0,1] op_sel_hi:[1,1]
v_pk_mul_f32 v[214:215], v[214:215], v[8:9] op_sel:[0,1] op_sel_hi:[1,1]
v_cvt_pk_bf16_f32 v196, v196, v197
v_cvt_pk_bf16_f32 v197, v198, v199
v_cvt_pk_bf16_f32 v198, v212, v213
v_cvt_pk_bf16_f32 v199, v214, v215
v_pk_add_f32 v[200:201], v[200:201], v[72:73]
v_pk_add_f32 v[202:203], v[202:203], v[74:75]
s_waitcnt lgkmcnt(1)
v_pk_add_f32 v[216:217], v[216:217], v[88:89]
v_pk_add_f32 v[218:219], v[218:219], v[90:91]
M v[24:27], a[112:115], v[196:199], v[24:27]
v_pk_mul_f32 v[200:201], v[200:201], v[10:11] op_sel:[0,0] op_sel_hi:[1,0]
v_pk_mul_f32 v[202:203], v[202:203], v[10:11] op_sel:[0,0] op_sel_hi:[1,0]
v_pk_mul_f32 v[216:217], v[216:217], v[10:11] op_sel:[0,0] op_sel_hi:[1,0]
v_pk_mul_f32 v[218:219], v[218:219], v[10:11] op_sel:[0,0] op_sel_hi:[1,0]
v_cvt_pk_bf16_f32 v200, v200, v201
v_cvt_pk_bf16_f32 v201, v202, v203
v_cvt_pk_bf16_f32 v202, v216, v217
v_cvt_pk_bf16_f32 v203, v218, v219
v_pk_add_f32 v[204:205], v[204:205], v[76:77]
v_pk_add_f32 v[206:207], v[206:207], v[78:79]
s_waitcnt lgkmcnt(0)
v_pk_add_f32 v[220:221], v[220:221], v[92:93]
v_pk_add_f32 v[222:223], v[222:223], v[94:95]
M v[24:27], a[112:115], v[200:203], v[24:27]
v_pk_mul_f32 v[204:205], v[204:205], v[10:11] op_sel:[0,1] op_sel_hi:[1,1]
v_pk_mul_f32 v[206:207], v[206:207], v[10:11] op_sel:[0,1] op_sel_hi:[1,1]
v_pk_mul_f32 v[220:221], v[220:221], v[10:11] op_sel:[0,1] op_sel_hi:[1,1]
v_pk_mul_f32 v[222:223], v[222:223], v[10:11] op_sel:[0,1] op_sel_hi:[1,1]
v_cvt_pk_bf16_f32 v204, v204, v205
v_cvt_pk_bf16_f32 v205, v206, v207
v_cvt_pk_bf16_f32 v206, v220, v221
v_cvt_pk_bf16_f32 v207, v222, v223
s_nop 1
M v[24:27], a[112:115], v[204:207], v[24:27]
v_cmp_lt_u32 vcc, 0x3c000000, v12
s_nop 6
v_cmp_class_f32 s[40:41], v24, s64
s_nop 0
s_or_b64 vcc, vcc, s[40:41]
s_cbranch_vccnz Lbad_4
s_lshl_b32 s33, s35, 20
s_lshl_b32 s34, s20, 15
s_add_u32 s33, s33, s34
s_lshl_b32 s34, s23, 13
s_add_u32 s36, s33, s34
s_add_u32 s37, s36, 4096
s_add_u32 s38, s36, 16384
s_add_u32 s39, s36, 20480
buffer_store_dwordx4 v[160:163], v1, s[16:19], s36 offen offset:0 sc1
buffer_store_dwordx4 v[164:167], v1, s[16:19], s36 offen offset:2048 sc1
buffer_store_dwordx4 v[168:171], v1, s[16:19], s37 offen offset:0 sc1
buffer_store_dwordx4 v[172:175], v1, s[16:19], s37 offen offset:2048 sc1
buffer_store_dwordx4 v[192:195], v1, s[16:19], s36 offen offset:1024 sc1
buffer_store_dwordx4 v[196:199], v1, s[16:19], s36 offen offset:3072 sc1
buffer_store_dwordx4 v[200:203], v1, s[16:19], s37 offen offset:1024 sc1
buffer_store_dwordx4 v[204:207], v1, s[16:19], s37 offen offset:3072 sc1
s_branch Lfd_5
Lbad_4:
s_or_b32 s60, s60, 2
Lfd_5:
s_branch Lk2_chk
Lk2_mg1:
ds_write_b128 v2, v[160:163] offset:0
ds_write_b128 v2, v[164:167] offset:1024
ds_write_b128 v2, v[168:171] offset:2048
ds_write_b128 v2, v[172:175] offset:3072
ds_write_b128 v2, v[176:179] offset:4096
ds_write_b128 v2, v[180:183] offset:5120
ds_write_b128 v2, v[184:187] offset:6144
ds_write_b128 v2, v[188:191] offset:7168
ds_write_b128 v2, v[192:195] offset:8192
ds_write_b128 v2, v[196:199] offset:9216
ds_write_b128 v2, v[200:203] offset:10240
ds_write_b128 v2, v[204:207] offset:11264
ds_write_b128 v2, v[208:211] offset:12288
ds_write_b128 v2, v[212:215] offset:13312
ds_write_b128 v2, v[216:219] offset:14336
ds_write_b128 v2, v[220:223] offset:15360
s_waitcnt lgkmcnt(0)
s_barrier
ds_read_b128 v[28:31], v15
ds_read_b128 v[32:35], v3 offset:0
ds_read_b128 v[36:39], v3 offset:1024
ds_read_b128 v[40:43], v3 offset:2048
ds_read_b128 v[44:47], v3 offset:3072
ds_read_b128 v[48:51], v3 offset:4096
ds_read_b128 v[52:55], v3 offset:5120
ds_read_b128 v[56:59], v3 offset:6144
ds_read_b128 v[60:63], v3 offset:7168
ds_read_b128 v[64:67], v3 offset:8192
ds_read_b128 v[68:71], v3 offset:9216
ds_read_b128 v[72:75], v3 offset:10240
ds_read_b128 v[76:79], v3 offset:11264
ds_read_b128 v[80:83], v3 offset:12288
ds_read_b128 v[84:87], v3 offset:13312
ds_read_b128 v[88:91], v3 offset:14336
ds_read_b128 v[92:95], v3 offset:15360
s_waitcnt lgkmcnt(15)
v_add_f32 v20, v20, v28
v_add_f32 v21, v21, v29
v_add_f32 v22, v22, v30
v_add_f32 v23, v23, v31
s_sub_u32 s35, 15, s21
v_rcp_f32 v8, v20
v_rcp_f32 v9, v21
v_rcp_f32 v10, v22
v_rcp_f32 v11, v23
v_subrev_u32 v20, 0x21800000, v20
v_subrev_u32 v21, 0x21800000, v21
v_subrev_u32 v22, 0x21800000, v22
v_subrev_u32 v23, 0x21800000, v23
v_max_u32 v12, v20, v21
v_max3_u32 v12, v12, v22, v23
s_mov_b32 s64, 0x207
v_pk_add_f32 v[224:225], v[224:225], v[32:33]
v_pk_add_f32 v[226:227], v[226:227], v[34:35]
s_waitcnt lgkmcnt(11)
v_pk_add_f32 v[240:241], v[240:241], v[48:49]
v_pk_add_f32 v[242:243], v[242:243], v[50:51]
v_pk_mul_f32 v[224:225], v[224:225], v[8:9] op_sel:[0,0] op_sel_hi:[1,0]
v_pk_mul_f32 v[226:227], v[226:227], v[8:9] op_sel:[0,0] op_sel_hi:[1,0]
v_pk_mul_f32 v[240:241], v[240:241], v[8:9] op_sel:[0,0] op_sel_hi:[1,0]
v_pk_mul_f32 v[242:243], v[242:243], v[8:9] op_sel:[0,0] op_sel_hi:[1,0]
v_cvt_pk_bf16_f32 v224, v224, v225
v_cvt_pk_bf16_f32 v225, v226, v227
v_cvt_pk_bf16_f32 v226, v240, v241
v_cvt_pk_bf16_f32 v227, v242, v243
v_pk_add_f32 v[228:229], v[228:229], v[36:37]
v_pk_add_f32 v[230:231], v[230:231], v[38:39]
s_waitcnt lgkmcnt(10)
v_pk_add_f32 v[244:245], v[244:245], v[52:53]
v_pk_add_f32 v[246:247], v[246:247], v[54:55]
M v[24:27], a[112:115], v[224:227], 0
v_pk_mul_f32 v[228:229], v[228:229], v[8:9] op_sel:[0,1] op_sel_hi:[1,1]
v_pk_mul_f32 v[230:231], v[230:231], v[8:9] op_sel:[0,1] op_sel_hi:[1,1]
v_pk_mul_f32 v[244:245], v[244:245], v[8:9] op_sel:[0,1] op_sel_hi:[1,1]
v_pk_mul_f32 v[246:247], v[246:247], v[8:9] op_sel:[0,1] op_sel_hi:[1,1]
v_cvt_pk_bf16_f32 v228, v228, v229
v_cvt_pk_bf16_f32 v229, v230, v231
v_cvt_pk_bf16_f32 v230, v244, v245
v_cvt_pk_bf16_f32 v231, v246, v247
v_pk_add_f32 v[232:233], v[232:233], v[40:41]
v_pk_add_f32 v[234:235], v[234:235], v[42:43]
s_waitcnt lgkmcnt(9)
v_pk_add_f32 v[248:249], v[248:249], v[56:57]
v_pk_add_f32 v[250:251], v[250:251], v[58:59]
M v[24:27], a[112:115], v[228:231], v[24:27]
v_pk_mul_f32 v[232:233], v[232:233], v[10:11] op_sel:[0,0] op_sel_hi:[1,0]
v_pk_mul_f32 v[234:235], v[234:235], v[10:11] op_sel:[0,0] op_sel_hi:[1,0]
v_pk_mul_f32 v[248:249], v[248:249], v[10:11] op_sel:[0,0] op_sel_hi:[1,0]
v_pk_mul_f32 v[250:251], v[250:251], v[10:11] op_sel:[0,0] op_sel_hi:[1,0]
v_cvt_pk_bf16_f32 v232, v232, v233
v_cvt_pk_bf16_f32 v233, v234, v235
v_cvt_pk_bf16_f32 v234, v248, v249
v_cvt_pk_bf16_f32 v235, v250, v251
v_pk_add_f32 v[236:237], v[236:237], v[44:45]
v_pk_add_f32 v[238:239], v[238:239], v[46:47]
s_waitcnt lgkmcnt(8)
v_pk_add_f32 v[252:253], v[252:253], v[60:61]
v_pk_add_f32 v[254:255], v[254:255], v[62:63]
M v[24:27], a[112:115], v[232:235], v[24:27]
v_pk_mul_f32 v[236:237], v[236:237], v[10:11] op_sel:[0,1] op_sel_hi:[1,1]
v_pk_mul_f32 v[238:239], v[238:239], v[10:11] op_sel:[0,1] op_sel_hi:[1,1]
v_pk_mul_f32 v[252:253], v[252:253], v[10:11] op_sel:[0,1] op_sel_hi:[1,1]
v_pk_mul_f32 v[254:255], v[254:255], v[10:11] op_sel:[0,1] op_sel_hi:[1,1]
v_cvt_pk_bf16_f32 v236, v236, v237
v_cvt_pk_bf16_f32 v237, v238, v239
v_cvt_pk_bf16_f32 v238, v252, v253
v_cvt_pk_bf16_f32 v239, v254, v255
v_accvgpr_read_b32 v32, a64
v_accvgpr_read_b32 v33, a65
v_accvgpr_read_b32 v34, a66
v_accvgpr_read_b32 v35, a67
s_waitcnt lgkmcnt(7)
v_pk_add_f32 v[32:33], v[32:33], v[64:65]
v_pk_add_f32 v[34:35], v[34:35], v[66:67]
v_accvgpr_read_b32 v48, a80
v_accvgpr_read_b32 v49, a81
v_accvgpr_read_b32 v50, a82
v_accvgpr_read_b32 v51, a83
s_waitcnt lgkmcnt(3)
v_pk_add_f32 v[48:49], v[48:49], v[80:81]
v_pk_add_f32 v[50:51], v[50:51], v[82:83]
M v[24:27], a[112:115], v[236:239], v[24:27]
v_pk_mul_f32 v[32:33], v[32:33], v[8:9] op_sel:[0,0] op_sel_hi:[1,0]
v_pk_mul_f32 v[34:35], v[34:35], v[8:9] op_sel:[0,0] op_sel_hi:[1,0]
v_pk_mul_f32 v[48:49], v[48:49], v[8:9] op_sel:[0,0] op_sel_hi:[1,0]
v_pk_mul_f32 v[50:51], v[50:51], v[8:9] op_sel:[0,0] op_sel_hi:[1,0]
v_cvt_pk_bf16_f32 v32, v32, v33
v_cvt_pk_bf16_f32 v33, v34, v35
v_cvt_pk_bf16_f32 v34, v48, v49
v_cvt_pk_bf16_f32 v35, v50, v51
v_accvgpr_read_b32 v240, a68
v_accvgpr_read_b32 v241, a69
v_accvgpr_read_b32 v242, a70
v_accvgpr_read_b32 v243, a71
v_pk_add_f32 v[240:241], v[240:241], v[68:69]
v_pk_add_f32 v[242:243], v[242:243], v[70:71]
v_accvgpr_read_b32 v36, a84
v_accvgpr_read_b32 v37, a85
v_accvgpr_read_b32 v38, a86
v_accvgpr_read_b32 v39, a87
s_waitcnt lgkmcnt(2)
v_pk_add_f32 v[36:37], v[36:37], v[84:85]
v_pk_add_f32 v[38:39], v[38:39], v[86:87]
M v[24:27], a[112:115], v[32:35], v[24:27]
v_pk_mul_f32 v[240:241], v[240:241], v[8:9] op_sel:[0,1] op_sel_hi:[1,1]
v_pk_mul_f32 v[242:243], v[242:243], v[8:9] op_sel:[0,1] op_sel_hi:[1,1]
v_pk_mul_f32 v[36:37], v[36:37], v[8:9] op_sel:[0,1] op_sel_hi:[1,1]
v_pk_mul_f32 v[38:39], v[38:39], v[8:9] op_sel:[0,1] op_sel_hi:[1,1]
v_cvt_pk_bf16_f32 v240, v240, v241
v_cvt_pk_bf16_f32 v241, v242, v243
v_cvt_pk_bf16_f32 v242, v36, v37
v_cvt_pk_bf16_f32 v243, v38, v39
v_accvgpr_read_b32 v52, a72
v_accvgpr_read_b32 v53, a73
v_accvgpr_read_b32 v54, a74
v_accvgpr_read_b32 v55, a75
v_pk_add_f32 v[52:53], v[52:53], v[72:73]
v_pk_add_f32 v[54:55], v[54:55], v[74:75]
v_accvgpr_read_b32 v244, a88
v_accvgpr_read_b32 v245, a89
v_accvgpr_read_b32 v246, a90
v_accvgpr_read_b32 v247, a91
s_waitcnt lgkmcnt(1)
v_pk_add_f32 v[244:245], v[244:245], v[88:89]
v_pk_add_f32 v[246:247], v[246:247], v[90:91]
M v[24:27], a[112:115], v[240:243], v[24:27]
v_pk_mul_f32 v[52:53], v[52:53], v[10:11] op_sel:[0,0] op_sel_hi:[1,0]
v_pk_mul_f32 v[54:55], v[54:55], v[10:11] op_sel:[0,0] op_sel_hi:[1,0]
v_pk_mul_f32 v[244:245], v[244:245], v[10:11] op_sel:[0,0] op_sel_hi:[1,0]
v_pk_mul_f32 v[246:247], v[246:247], v[10:11] op_sel:[0,0] op_sel_hi:[1,0]
v_cvt_pk_bf16_f32 v52, v52, v53
v_cvt_pk_bf16_f32 v53, v54, v55
v_cvt_pk_bf16_f32 v54, v244, v245
v_cvt_pk_bf16_f32 v55, v246, v247
v_accvgpr_read_b32 v40, a76
v_accvgpr_read_b32 v41, a77
v_accvgpr_read_b32 v42, a78
v_accvgpr_read_b32 v43, a79
v_pk_add_f32 v[40:41], v[40:41], v[76:77]
v_pk_add_f32 v[42:43], v[42:43], v[78:79]
v_accvgpr_read_b32 v56, a92
v_accvgpr_read_b32 v57, a93
v_accvgpr_read_b32 v58, a94
v_accvgpr_read_b32 v59, a95
s_waitcnt lgkmcnt(0)
v_pk_add_f32 v[56:57], v[56:57], v[92:93]
v_pk_add_f32 v[58:59], v[58:59], v[94:95]
M v[24:27], a[112:115], v[52:55], v[24:27]
v_pk_mul_f32 v[40:41], v[40:41], v[10:11] op_sel:[0,1] op_sel_hi:[1,1]
v_pk_mul_f32 v[42:43], v[42:43], v[10:11] op_sel:[0,1] op_sel_hi:[1,1]
v_pk_mul_f32 v[56:57], v[56:57], v[10:11] op_sel:[0,1] op_sel_hi:[1,1]
v_pk_mul_f32 v[58:59], v[58:59], v[10:11] op_sel:[0,1] op_sel_hi:[1,1]
v_cvt_pk_bf16_f32 v40, v40, v41
v_cvt_pk_bf16_f32 v41, v42, v43
v_cvt_pk_bf16_f32 v42, v56, v57
v_cvt_pk_bf16_f32 v43, v58, v59
s_nop 1
M v[24:27], a[112:115], v[40:43], v[24:27]
v_cmp_lt_u32 vcc, 0x3c000000, v12
s_nop 6
v_cmp_class_f32 s[40:41], v24, s64
s_nop 0
s_or_b64 vcc, vcc, s[40:41]
s_cbranch_vccnz Lbad_6
s_lshl_b32 s33, s35, 20
s_lshl_b32 s34, s20, 15
s_add_u32 s33, s33, s34
s_lshl_b32 s34, s23, 13
s_add_u32 s36, s33, s34
s_add_u32 s37, s36, 4096
s_add_u32 s38, s36, 16384
s_add_u32 s39, s36, 20480
buffer_store_dwordx4 v[224:227], v1, s[16:19], s38 offen offset:0 sc1
buffer_store_dwordx4 v[228:231], v1, s[16:19], s38 offen offset:2048 sc1
buffer_store_dwordx4 v[232:235], v1, s[16:19], s39 offen offset:0 sc1
buffer_store_dwordx4 v[236:239], v1, s[16:19], s39 offen offset:2048 sc1
buffer_store_dwordx4 v[32:35], v1, s[16:19], s38 offen offset:1024 sc1
buffer_store_dwordx4 v[240:243], v1, s[16:19], s38 offen offset:3072 sc1
buffer_store_dwordx4 v[52:55], v1, s[16:19], s39 offen offset:1024 sc1
buffer_store_dwordx4 v[40:43], v1, s[16:19], s39 offen offset:3072 sc1
s_branch Lfd_7
Lbad_6:
s_or_b32 s60, s60, 2
Lfd_7:
Lk2_chk:
s_cmp_eq_u32 s60, 0
s_cbranch_scc1 Lk2_done
s_sub_u32 s56, 15, s21
s_lshl_b32 s33, s24, 1
s_lshl_b32 s61, 3, s33
s_and_b32 s34, s60, 2
s_bitcmp1_b32 s60, 0
s_cselect_b32 s56, s21, s56
s_cselect_b32 s61, 15, s61
s_cselect_b32 s60, s34, 0
s_waitcnt vmcnt(0)
s_lshl_b32 s33, s20, 7
s_lshl_b32 s34, s56, 3
s_add_u32 s33, s33, s34
s_lshl_b32 s34, s23, 2
s_add_u32 s33, s33, s34
s_lshl_b32 s33, s33, 12
buffer_load_dwordx4 a[0:3], v1, s[8:11], s33 offen offset:0 sc1
buffer_load_dwordx4 a[4:7], v1, s[8:11], s33 offen offset:1024 sc1
buffer_load_dwordx4 a[8:11], v1, s[8:11], s33 offen offset:2048 sc1
buffer_load_dwordx4 a[12:15], v1, s[8:11], s33 offen offset:3072 sc1
s_add_u32 s33, s33, 4096
buffer_load_dwordx4 a[16:19], v1, s[8:11], s33 offen offset:0 sc1
buffer_load_dwordx4 a[20:23], v1, s[8:11], s33 offen offset:1024 sc1
buffer_load_dwordx4 a[24:27], v1, s[8:11], s33 offen offset:2048 sc1
buffer_load_dwordx4 a[28:31], v1, s[8:11], s33 offen offset:3072 sc1
s_add_u32 s33, s33, 4096
buffer_load_dwordx4 a[32:35], v1, s[8:11], s33 offen offset:0 sc1
buffer_load_dwordx4 a[36:39], v1, s[8:11], s33 offen offset:1024 sc1
buffer_load_dwordx4 a[40:43], v1, s[8:11], s33 offen offset:2048 sc1
buffer_load_dwordx4 a[44:47], v1, s[8:11], s33 offen offset:3072 sc1
s_add_u32 s33, s33, 4096
buffer_load_dwordx4 a[48:51], v1, s[8:11], s33 offen offset:0 sc1
buffer_load_dwordx4 a[52:55], v1, s[8:11], s33 offen offset:1024 sc1
buffer_load_dwordx4 a[56:59], v1, s[8:11], s33 offen offset:2048 sc1
buffer_load_dwordx4 a[60:63], v1, s[8:11], s33 offen offset:3072 sc1
v_accvgpr_write_b32 a64, 0
v_accvgpr_write_b32 a65, 0
v_accvgpr_write_b32 a66, 0
v_accvgpr_write_b32 a67, 0
v_accvgpr_write_b32 a68, 0
v_accvgpr_write_b32 a69, 0
v_accvgpr_write_b32 a70, 0
v_accvgpr_write_b32 a71, 0
v_accvgpr_write_b32 a72, 0
v_accvgpr_write_b32 a73, 0
v_accvgpr_write_b32 a74, 0
v_accvgpr_write_b32 a75, 0
v_accvgpr_write_b32 a76, 0
v_accvgpr_write_b32 a77, 0
v_accvgpr_write_b32 a78, 0
v_accvgpr_write_b32 a79, 0
v_accvgpr_write_b32 a80, 0
v_accvgpr_write_b32 a81, 0
v_accvgpr_write_b32 a82, 0
v_accvgpr_write_b32 a83, 0
v_accvgpr_write_b32 a84, 0
v_accvgpr_write_b32 a85, 0
v_accvgpr_write_b32 a86, 0
v_accvgpr_write_b32 a87, 0
v_accvgpr_write_b32 a88, 0
v_accvgpr_write_b32 a89, 0
v_accvgpr_write_b32 a90, 0
v_accvgpr_write_b32 a91, 0
v_accvgpr_write_b32 a92, 0
v_accvgpr_write_b32 a93, 0
v_accvgpr_write_b32 a94, 0
v_accvgpr_write_b32 a95, 0
v_accvgpr_write_b32 a96, 0
v_accvgpr_write_b32 a97, 0
v_accvgpr_write_b32 a98, 0
v_accvgpr_write_b32 a99, 0
v_accvgpr_write_b32 a100, 0
v_accvgpr_write_b32 a101, 0
v_accvgpr_write_b32 a102, 0
v_accvgpr_write_b32 a103, 0
v_accvgpr_write_b32 a104, 0
v_accvgpr_write_b32 a105, 0
v_accvgpr_write_b32 a106, 0
v_accvgpr_write_b32 a107, 0
v_accvgpr_write_b32 a108, 0
v_accvgpr_write_b32 a109, 0
v_accvgpr_write_b32 a110, 0
v_accvgpr_write_b32 a111, 0
v_mov_b32 v160, 0
v_mov_b32 v161, 0
v_mov_b32 v162, 0
v_mov_b32 v163, 0
v_mov_b32 v164, 0
v_mov_b32 v165, 0
v_mov_b32 v166, 0
v_mov_b32 v167, 0
v_mov_b32 v168, 0
v_mov_b32 v169, 0
v_mov_b32 v170, 0
v_mov_b32 v171, 0
v_mov_b32 v172, 0
v_mov_b32 v173, 0
v_mov_b32 v174, 0
v_mov_b32 v175, 0
v_mov_b32 v176, 0
v_mov_b32 v177, 0
v_mov_b32 v178, 0
v_mov_b32 v179, 0
v_mov_b32 v180, 0
v_mov_b32 v181, 0
v_mov_b32 v182, 0
v_mov_b32 v183, 0
v_mov_b32 v184, 0
v_mov_b32 v185, 0
v_mov_b32 v186, 0
v_mov_b32 v187, 0
v_mov_b32 v188, 0
v_mov_b32 v189, 0
v_mov_b32 v190, 0
v_mov_b32 v191, 0
v_mov_b32 v192, 0
v_mov_b32 v193, 0
v_mov_b32 v194, 0
v_mov_b32 v195, 0
v_mov_b32 v196, 0
v_mov_b32 v197, 0
v_mov_b32 v198, 0
v_mov_b32 v199, 0
v_mov_b32 v200, 0
v_mov_b32 v201, 0
v_mov_b32 v202, 0
v_mov_b32 v203, 0
v_mov_b32 v204, 0
v_mov_b32 v205, 0
v_mov_b32 v206, 0
v_mov_b32 v207, 0
v_mov_b32 v208, 0
v_mov_b32 v209, 0
v_mov_b32 v210, 0
v_mov_b32 v211, 0
v_mov_b32 v212, 0
v_mov_b32 v213, 0
v_mov_b32 v214, 0
v_mov_b32 v215, 0
v_mov_b32 v216, 0
v_mov_b32 v217, 0
v_mov_b32 v218, 0
v_mov_b32 v219, 0
v_mov_b32 v220, 0
v_mov_b32 v221, 0
v_mov_b32 v222, 0
v_mov_b32 v223, 0
v_mov_b32 v224, 0
v_mov_b32 v225, 0
v_mov_b32 v226, 0
v_mov_b32 v227, 0
v_mov_b32 v228, 0
v_mov_b32 v229, 0
v_mov_b32 v230, 0
v_mov_b32 v231, 0
v_mov_b32 v232, 0
v_mov_b32 v233, 0
v_mov_b32 v234, 0
v_mov_b32 v235, 0
v_mov_b32 v236, 0
v_mov_b32 v237, 0
v_mov_b32 v238, 0
v_mov_b32 v239, 0
v_mov_b32 v240, 0
v_mov_b32 v241, 0
v_mov_b32 v242, 0
v_mov_b32 v243, 0
v_mov_b32 v244, 0
v_mov_b32 v245, 0
v_mov_b32 v246, 0
v_mov_b32 v247, 0
v_mov_b32 v248, 0
v_mov_b32 v249, 0
v_mov_b32 v250, 0
v_mov_b32 v251, 0
v_mov_b32 v252, 0
v_mov_b32 v253, 0
v_mov_b32 v254, 0
v_mov_b32 v255, 0
v_mov_b32 v8, v4
v_mov_b32 v9, v4
v_mov_b32 v10, v4
v_mov_b32 v11, v4
s_lshl_b32 s57, s20, 20
s_lshl_b32 s58, s56, 7
s_lshl_b32 s59, s56, 1
s_add_u32 s59, s59, 2
Lslow_8:
s_add_u32 s35, s57, 0
buffer_load_dwordx4 v[96:99], v1, s[12:15], s35 offen offset:0 sc1
buffer_load_dwordx4 v[100:103], v1, s[12:15], s35 offen offset:1024 sc1
buffer_load_dwordx4 v[104:107], v1, s[12:15], s35 offen offset:2048 sc1
buffer_load_dwordx4 v[108:111], v1, s[12:15], s35 offen offset:3072 sc1
s_add_u32 s35, s57, 4096
buffer_load_dwordx4 v[112:115], v1, s[12:15], s35 offen offset:0 sc1
buffer_load_dwordx4 v[116:119], v1, s[12:15], s35 offen offset:1024 sc1
buffer_load_dwordx4 v[120:123], v1, s[12:15], s35 offen offset:2048 sc1
buffer_load_dwordx4 v[124:127], v1, s[12:15], s35 offen offset:3072 sc1
s_add_u32 s35, s57, 8192
buffer_load_dwordx4 v[128:131], v1, s[12:15], s35 offen offset:0 sc1
buffer_load_dwordx4 v[132:135], v1, s[12:15], s35 offen offset:1024 sc1
buffer_load_dwordx4 v[136:139], v1, s[12:15], s35 offen offset:2048 sc1
buffer_load_dwordx4 v[140:143], v1, s[12:15], s35 offen offset:3072 sc1
s_add_u32 s35, s57, 12288
buffer_load_dwordx4 v[144:147], v1, s[12:15], s35 offen offset:0 sc1
buffer_load_dwordx4 v[148:151], v1, s[12:15], s35 offen offset:1024 sc1
buffer_load_dwordx4 v[152:155], v1, s[12:15], s35 offen offset:2048 sc1
buffer_load_dwordx4 v[156:159], v1, s[12:15], s35 offen offset:3072 sc1
s_lshl_b32 s33, s23, 6
s_add_i32 s33, s33, s58
s_cmp_gt_i32 s33, 0
s_cselect_b32 s34, 0, 0xf149f2ca
s_cmp_lt_i32 s33, 0
s_cselect_b32 s33, 0xf149f2ca, 0
v_mov_b32 v20, s34
v_mov_b32 v21, s34
v_mov_b32 v22, s34
v_mov_b32 v23, s34
v_mov_b32 v28, s33
v_mov_b32 v29, s33
v_mov_b32 v30, s33
v_mov_b32 v31, s33
v_med3_f32 v24, v16, v20, v28
v_med3_f32 v25, v17, v20, v28
v_med3_f32 v26, v18, v20, v28
v_med3_f32 v27, v19, v20, v28
s_waitcnt vmcnt(0)
s_nop 0
M v[32:35], v[96:99], a[0:3], v[24:27]
M v[32:35], v[100:103], a[4:7], v[32:35]
M v[32:35], v[104:107], a[8:11], v[32:35]
M v[32:35], v[108:111], a[12:15], v[32:35]
M v[36:39], v[96:99], a[16:19], v[28:31]
M v[36:39], v[100:103], a[20:23], v[36:39]
M v[36:39], v[104:107], a[24:27], v[36:39]
M v[36:39], v[108:111], a[28:31], v[36:39]
M v[40:43], v[96:99], a[32:35], v[28:31]
M v[40:43], v[100:103], a[36:39], v[40:43]
M v[40:43], v[104:107], a[40:43], v[40:43]
M v[40:43], v[108:111], a[44:47], v[40:43]
M v[44:47], v[96:99], a[48:51], v[28:31]
M v[44:47], v[100:103], a[52:55], v[44:47]
M v[44:47], v[104:107], a[56:59], v[44:47]
M v[44:47], v[108:111], a[60:63], v[44:47]
M v[48:51], v[112:115], a[0:3], v[20:23]
M v[48:51], v[116:119], a[4:7], v[48:51]
M v[48:51], v[120:123], a[8:11], v[48:51]
M v[48:51], v[124:127], a[12:15], v[48:51]
M v[52:55], v[112:115], a[16:19], v[24:27]
M v[52:55], v[116:119], a[20:23], v[52:55]
M v[52:55], v[120:123], a[24:27], v[52:55]
M v[52:55], v[124:127], a[28:31], v[52:55]
M v[56:59], v[112:115], a[32:35], v[28:31]
M v[56:59], v[116:119], a[36:39], v[56:59]
M v[56:59], v[120:123], a[40:43], v[56:59]
M v[56:59], v[124:127], a[44:47], v[56:59]
M v[60:63], v[112:115], a[48:51], v[28:31]
M v[60:63], v[116:119], a[52:55], v[60:63]
M v[60:63], v[120:123], a[56:59], v[60:63]
M v[60:63], v[124:127], a[60:63], v[60:63]
M v[64:67], v[128:131], a[0:3], v[20:23]
M v[64:67], v[132:135], a[4:7], v[64:67]
M v[64:67], v[136:139], a[8:11], v[64:67]
M v[64:67], v[140:143], a[12:15], v[64:67]
M v[68:71], v[128:131], a[16:19], v[20:23]
M v[68:71], v[132:135], a[20:23], v[68:71]
M v[68:71], v[136:139], a[24:27], v[68:71]
M v[68:71], v[140:143], a[28:31], v[68:71]
M v[72:75], v[128:131], a[32:35], v[24:27]
M v[72:75], v[132:135], a[36:39], v[72:75]
M v[72:75], v[136:139], a[40:43], v[72:75]
M v[72:75], v[140:143], a[44:47], v[72:75]
M v[76:79], v[128:131], a[48:51], v[28:31]
M v[76:79], v[132:135], a[52:55], v[76:79]
M v[76:79], v[136:139], a[56:59], v[76:79]
M v[76:79], v[140:143], a[60:63], v[76:79]
M v[80:83], v[144:147], a[0:3], v[20:23]
M v[80:83], v[148:151], a[4:7], v[80:83]
M v[80:83], v[152:155], a[8:11], v[80:83]
M v[80:83], v[156:159], a[12:15], v[80:83]
M v[84:87], v[144:147], a[16:19], v[20:23]
M v[84:87], v[148:151], a[20:23], v[84:87]
M v[84:87], v[152:155], a[24:27], v[84:87]
M v[84:87], v[156:159], a[28:31], v[84:87]
M v[88:91], v[144:147], a[32:35], v[20:23]
M v[88:91], v[148:151], a[36:39], v[88:91]
M v[88:91], v[152:155], a[40:43], v[88:91]
M v[88:91], v[156:159], a[44:47], v[88:91]
M v[92:95], v[144:147], a[48:51], v[24:27]
M v[92:95], v[148:151], a[52:55], v[92:95]
M v[92:95], v[152:155], a[56:59], v[92:95]
M v[92:95], v[156:159], a[60:63], v[92:95]
s_nop 7
s_add_u32 s35, s57, 16384
buffer_load_dwordx4 v[96:99], v1, s[12:15], s35 offen offset:0 sc1
buffer_load_dwordx4 v[100:103], v1, s[12:15], s35 offen offset:1024 sc1
buffer_load_dwordx4 v[104:107], v1, s[12:15], s35 offen offset:2048 sc1
buffer_load_dwordx4 v[108:111], v1, s[12:15], s35 offen offset:3072 sc1
s_add_u32 s35, s57, 20480
buffer_load_dwordx4 v[112:115], v1, s[12:15], s35 offen offset:0 sc1
buffer_load_dwordx4 v[116:119], v1, s[12:15], s35 offen offset:1024 sc1
buffer_load_dwordx4 v[120:123], v1, s[12:15], s35 offen offset:2048 sc1
buffer_load_dwordx4 v[124:127], v1, s[12:15], s35 offen offset:3072 sc1
s_add_u32 s35, s57, 24576
buffer_load_dwordx4 v[128:131], v1, s[12:15], s35 offen offset:0 sc1
buffer_load_dwordx4 v[132:135], v1, s[12:15], s35 offen offset:1024 sc1
buffer_load_dwordx4 v[136:139], v1, s[12:15], s35 offen offset:2048 sc1
buffer_load_dwordx4 v[140:143], v1, s[12:15], s35 offen offset:3072 sc1
s_add_u32 s35, s57, 28672
buffer_load_dwordx4 v[144:147], v1, s[12:15], s35 offen offset:0 sc1
buffer_load_dwordx4 v[148:151], v1, s[12:15], s35 offen offset:1024 sc1
buffer_load_dwordx4 v[152:155], v1, s[12:15], s35 offen offset:2048 sc1
buffer_load_dwordx4 v[156:159], v1, s[12:15], s35 offen offset:3072 sc1
v_max3_f32 v13, v32, v33, v8
v_max3_f32 v13, v13, v34, v35
v_max3_f32 v13, v13, v48, v49
v_max3_f32 v13, v13, v50, v51
v_max3_f32 v13, v13, v64, v65
v_max3_f32 v13, v13, v66, v67
v_max3_f32 v13, v13, v80, v81
v_max3_f32 v13, v13, v82, v83
v_mov_b32 v14, v13
s_nop 1
v_permlane16_swap_b32 v13, v14
v_max_f32 v13, v13, v14
v_mov_b32 v14, v13
s_nop 1
v_permlane32_swap_b32 v13, v14
v_max_f32 v13, v13, v14
v_sub_f32 v12, v8, v13
v_exp_f32 v12, v12
v_mov_b32 v8, v13
v_sub_f32 v32, v32, v13
v_sub_f32 v33, v33, v13
v_sub_f32 v34, v34, v13
v_sub_f32 v35, v35, v13
v_sub_f32 v48, v48, v13
v_sub_f32 v49, v49, v13
v_sub_f32 v50, v50, v13
v_sub_f32 v51, v51, v13
v_sub_f32 v64, v64, v13
v_sub_f32 v65, v65, v13
v_sub_f32 v66, v66, v13
v_sub_f32 v67, v67, v13
v_sub_f32 v80, v80, v13
v_sub_f32 v81, v81, v13
v_sub_f32 v82, v82, v13
v_sub_f32 v83, v83, v13
v_mul_f32 v160, v160, v12
v_mul_f32 v161, v161, v12
v_mul_f32 v162, v162, v12
v_mul_f32 v163, v163, v12
v_mul_f32 v176, v176, v12
v_mul_f32 v177, v177, v12
v_mul_f32 v178, v178, v12
v_mul_f32 v179, v179, v12
v_mul_f32 v192, v192, v12
v_mul_f32 v193, v193, v12
v_mul_f32 v194, v194, v12
v_mul_f32 v195, v195, v12
v_mul_f32 v208, v208, v12
v_mul_f32 v209, v209, v12
v_mul_f32 v210, v210, v12
v_mul_f32 v211, v211, v12
v_mul_f32 v224, v224, v12
v_mul_f32 v225, v225, v12
v_mul_f32 v226, v226, v12
v_mul_f32 v227, v227, v12
v_mul_f32 v240, v240, v12
v_mul_f32 v241, v241, v12
v_mul_f32 v242, v242, v12
v_mul_f32 v243, v243, v12
v_accvgpr_read_b32 v14, a64
v_mul_f32 v14, v14, v12
v_accvgpr_write_b32 a64, v14
v_accvgpr_read_b32 v14, a65
v_mul_f32 v14, v14, v12
v_accvgpr_write_b32 a65, v14
v_accvgpr_read_b32 v14, a66
v_mul_f32 v14, v14, v12
v_accvgpr_write_b32 a66, v14
v_accvgpr_read_b32 v14, a67
v_mul_f32 v14, v14, v12
v_accvgpr_write_b32 a67, v14
v_accvgpr_read_b32 v14, a80
v_mul_f32 v14, v14, v12
v_accvgpr_write_b32 a80, v14
v_accvgpr_read_b32 v14, a81
v_mul_f32 v14, v14, v12
v_accvgpr_write_b32 a81, v14
v_accvgpr_read_b32 v14, a82
v_mul_f32 v14, v14, v12
v_accvgpr_write_b32 a82, v14
v_accvgpr_read_b32 v14, a83
v_mul_f32 v14, v14, v12
v_accvgpr_write_b32 a83, v14
v_accvgpr_read_b32 v14, a96
v_mul_f32 v14, v14, v12
v_accvgpr_write_b32 a96, v14
v_accvgpr_read_b32 v14, a97
v_mul_f32 v14, v14, v12
v_accvgpr_write_b32 a97, v14
v_accvgpr_read_b32 v14, a98
v_mul_f32 v14, v14, v12
v_accvgpr_write_b32 a98, v14
v_accvgpr_read_b32 v14, a99
v_mul_f32 v14, v14, v12
v_accvgpr_write_b32 a99, v14
v_max3_f32 v13, v36, v37, v9
v_max3_f32 v13, v13, v38, v39
v_max3_f32 v13, v13, v52, v53
v_max3_f32 v13, v13, v54, v55
v_max3_f32 v13, v13, v68, v69
v_max3_f32 v13, v13, v70, v71
v_max3_f32 v13, v13, v84, v85
v_max3_f32 v13, v13, v86, v87
v_mov_b32 v14, v13
s_nop 1
v_permlane16_swap_b32 v13, v14
v_max_f32 v13, v13, v14
v_mov_b32 v14, v13
s_nop 1
v_permlane32_swap_b32 v13, v14
v_max_f32 v13, v13, v14
v_sub_f32 v12, v9, v13
v_exp_f32 v12, v12
v_mov_b32 v9, v13
v_sub_f32 v36, v36, v13
v_sub_f32 v37, v37, v13
v_sub_f32 v38, v38, v13
v_sub_f32 v39, v39, v13
v_sub_f32 v52, v52, v13
v_sub_f32 v53, v53, v13
v_sub_f32 v54, v54, v13
v_sub_f32 v55, v55, v13
v_sub_f32 v68, v68, v13
v_sub_f32 v69, v69, v13
v_sub_f32 v70, v70, v13
v_sub_f32 v71, v71, v13
v_sub_f32 v84, v84, v13
v_sub_f32 v85, v85, v13
v_sub_f32 v86, v86, v13
v_sub_f32 v87, v87, v13
v_mul_f32 v164, v164, v12
v_mul_f32 v165, v165, v12
v_mul_f32 v166, v166, v12
v_mul_f32 v167, v167, v12
v_mul_f32 v180, v180, v12
v_mul_f32 v181, v181, v12
v_mul_f32 v182, v182, v12
v_mul_f32 v183, v183, v12
v_mul_f32 v196, v196, v12
v_mul_f32 v197, v197, v12
v_mul_f32 v198, v198, v12
v_mul_f32 v199, v199, v12
v_mul_f32 v212, v212, v12
v_mul_f32 v213, v213, v12
v_mul_f32 v214, v214, v12
v_mul_f32 v215, v215, v12
v_mul_f32 v228, v228, v12
v_mul_f32 v229, v229, v12
v_mul_f32 v230, v230, v12
v_mul_f32 v231, v231, v12
v_mul_f32 v244, v244, v12
v_mul_f32 v245, v245, v12
v_mul_f32 v246, v246, v12
v_mul_f32 v247, v247, v12
v_accvgpr_read_b32 v14, a68
v_mul_f32 v14, v14, v12
v_accvgpr_write_b32 a68, v14
v_accvgpr_read_b32 v14, a69
v_mul_f32 v14, v14, v12
v_accvgpr_write_b32 a69, v14
v_accvgpr_read_b32 v14, a70
v_mul_f32 v14, v14, v12
v_accvgpr_write_b32 a70, v14
v_accvgpr_read_b32 v14, a71
v_mul_f32 v14, v14, v12
v_accvgpr_write_b32 a71, v14
v_accvgpr_read_b32 v14, a84
v_mul_f32 v14, v14, v12
v_accvgpr_write_b32 a84, v14
v_accvgpr_read_b32 v14, a85
v_mul_f32 v14, v14, v12
v_accvgpr_write_b32 a85, v14
v_accvgpr_read_b32 v14, a86
v_mul_f32 v14, v14, v12
v_accvgpr_write_b32 a86, v14
v_accvgpr_read_b32 v14, a87
v_mul_f32 v14, v14, v12
v_accvgpr_write_b32 a87, v14
v_accvgpr_read_b32 v14, a100
v_mul_f32 v14, v14, v12
v_accvgpr_write_b32 a100, v14
v_accvgpr_read_b32 v14, a101
v_mul_f32 v14, v14, v12
v_accvgpr_write_b32 a101, v14
v_accvgpr_read_b32 v14, a102
v_mul_f32 v14, v14, v12
v_accvgpr_write_b32 a102, v14
v_accvgpr_read_b32 v14, a103
v_mul_f32 v14, v14, v12
v_accvgpr_write_b32 a103, v14
v_max3_f32 v13, v40, v41, v10
v_max3_f32 v13, v13, v42, v43
v_max3_f32 v13, v13, v56, v57
v_max3_f32 v13, v13, v58, v59
v_max3_f32 v13, v13, v72, v73
v_max3_f32 v13, v13, v74, v75
v_max3_f32 v13, v13, v88, v89
v_max3_f32 v13, v13, v90, v91
v_mov_b32 v14, v13
s_nop 1
v_permlane16_swap_b32 v13, v14
v_max_f32 v13, v13, v14
v_mov_b32 v14, v13
s_nop 1
v_permlane32_swap_b32 v13, v14
v_max_f32 v13, v13, v14
v_sub_f32 v12, v10, v13
v_exp_f32 v12, v12
v_mov_b32 v10, v13
v_sub_f32 v40, v40, v13
v_sub_f32 v41, v41, v13
v_sub_f32 v42, v42, v13
v_sub_f32 v43, v43, v13
v_sub_f32 v56, v56, v13
v_sub_f32 v57, v57, v13
v_sub_f32 v58, v58, v13
v_sub_f32 v59, v59, v13
v_sub_f32 v72, v72, v13
v_sub_f32 v73, v73, v13
v_sub_f32 v74, v74, v13
v_sub_f32 v75, v75, v13
v_sub_f32 v88, v88, v13
v_sub_f32 v89, v89, v13
v_sub_f32 v90, v90, v13
v_sub_f32 v91, v91, v13
v_mul_f32 v168, v168, v12
v_mul_f32 v169, v169, v12
v_mul_f32 v170, v170, v12
v_mul_f32 v171, v171, v12
v_mul_f32 v184, v184, v12
v_mul_f32 v185, v185, v12
v_mul_f32 v186, v186, v12
v_mul_f32 v187, v187, v12
v_mul_f32 v200, v200, v12
v_mul_f32 v201, v201, v12
v_mul_f32 v202, v202, v12
v_mul_f32 v203, v203, v12
v_mul_f32 v216, v216, v12
v_mul_f32 v217, v217, v12
v_mul_f32 v218, v218, v12
v_mul_f32 v219, v219, v12
v_mul_f32 v232, v232, v12
v_mul_f32 v233, v233, v12
v_mul_f32 v234, v234, v12
v_mul_f32 v235, v235, v12
v_mul_f32 v248, v248, v12
v_mul_f32 v249, v249, v12
v_mul_f32 v250, v250, v12
v_mul_f32 v251, v251, v12
v_accvgpr_read_b32 v14, a72
v_mul_f32 v14, v14, v12
v_accvgpr_write_b32 a72, v14
v_accvgpr_read_b32 v14, a73
v_mul_f32 v14, v14, v12
v_accvgpr_write_b32 a73, v14
v_accvgpr_read_b32 v14, a74
v_mul_f32 v14, v14, v12
v_accvgpr_write_b32 a74, v14
v_accvgpr_read_b32 v14, a75
v_mul_f32 v14, v14, v12
v_accvgpr_write_b32 a75, v14
v_accvgpr_read_b32 v14, a88
v_mul_f32 v14, v14, v12
v_accvgpr_write_b32 a88, v14
v_accvgpr_read_b32 v14, a89
v_mul_f32 v14, v14, v12
v_accvgpr_write_b32 a89, v14
v_accvgpr_read_b32 v14, a90
v_mul_f32 v14, v14, v12
v_accvgpr_write_b32 a90, v14
v_accvgpr_read_b32 v14, a91
v_mul_f32 v14, v14, v12
v_accvgpr_write_b32 a91, v14
v_accvgpr_read_b32 v14, a104
v_mul_f32 v14, v14, v12
v_accvgpr_write_b32 a104, v14
v_accvgpr_read_b32 v14, a105
v_mul_f32 v14, v14, v12
v_accvgpr_write_b32 a105, v14
v_accvgpr_read_b32 v14, a106
v_mul_f32 v14, v14, v12
v_accvgpr_write_b32 a106, v14
v_accvgpr_read_b32 v14, a107
v_mul_f32 v14, v14, v12
v_accvgpr_write_b32 a107, v14
v_max3_f32 v13, v44, v45, v11
v_max3_f32 v13, v13, v46, v47
v_max3_f32 v13, v13, v60, v61
v_max3_f32 v13, v13, v62, v63
v_max3_f32 v13, v13, v76, v77
v_max3_f32 v13, v13, v78, v79
v_max3_f32 v13, v13, v92, v93
v_max3_f32 v13, v13, v94, v95
v_mov_b32 v14, v13
s_nop 1
v_permlane16_swap_b32 v13, v14
v_max_f32 v13, v13, v14
v_mov_b32 v14, v13
s_nop 1
v_permlane32_swap_b32 v13, v14
v_max_f32 v13, v13, v14
v_sub_f32 v12, v11, v13
v_exp_f32 v12, v12
v_mov_b32 v11, v13
v_sub_f32 v44, v44, v13
v_sub_f32 v45, v45, v13
v_sub_f32 v46, v46, v13
v_sub_f32 v47, v47, v13
v_sub_f32 v60, v60, v13
v_sub_f32 v61, v61, v13
v_sub_f32 v62, v62, v13
v_sub_f32 v63, v63, v13
v_sub_f32 v76, v76, v13
v_sub_f32 v77, v77, v13
v_sub_f32 v78, v78, v13
v_sub_f32 v79, v79, v13
v_sub_f32 v92, v92, v13
v_sub_f32 v93, v93, v13
v_sub_f32 v94, v94, v13
v_sub_f32 v95, v95, v13
v_mul_f32 v172, v172, v12
v_mul_f32 v173, v173, v12
v_mul_f32 v174, v174, v12
v_mul_f32 v175, v175, v12
v_mul_f32 v188, v188, v12
v_mul_f32 v189, v189, v12
v_mul_f32 v190, v190, v12
v_mul_f32 v191, v191, v12
v_mul_f32 v204, v204, v12
v_mul_f32 v205, v205, v12
v_mul_f32 v206, v206, v12
v_mul_f32 v207, v207, v12
v_mul_f32 v220, v220, v12
v_mul_f32 v221, v221, v12
v_mul_f32 v222, v222, v12
v_mul_f32 v223, v223, v12
v_mul_f32 v236, v236, v12
v_mul_f32 v237, v237, v12
v_mul_f32 v238, v238, v12
v_mul_f32 v239, v239, v12
v_mul_f32 v252, v252, v12
v_mul_f32 v253, v253, v12
v_mul_f32 v254, v254, v12
v_mul_f32 v255, v255, v12
v_accvgpr_read_b32 v14, a76
v_mul_f32 v14, v14, v12
v_accvgpr_write_b32 a76, v14
v_accvgpr_read_b32 v14, a77
v_mul_f32 v14, v14, v12
v_accvgpr_write_b32 a77, v14
v_accvgpr_read_b32 v14, a78
v_mul_f32 v14, v14, v12
v_accvgpr_write_b32 a78, v14
v_accvgpr_read_b32 v14, a79
v_mul_f32 v14, v14, v12
v_accvgpr_write_b32 a79, v14
v_accvgpr_read_b32 v14, a92
v_mul_f32 v14, v14, v12
v_accvgpr_write_b32 a92, v14
v_accvgpr_read_b32 v14, a93
v_mul_f32 v14, v14, v12
v_accvgpr_write_b32 a93, v14
v_accvgpr_read_b32 v14, a94
v_mul_f32 v14, v14, v12
v_accvgpr_write_b32 a94, v14
v_accvgpr_read_b32 v14, a95
v_mul_f32 v14, v14, v12
v_accvgpr_write_b32 a95, v14
v_accvgpr_read_b32 v14, a108
v_mul_f32 v14, v14, v12
v_accvgpr_write_b32 a108, v14
v_accvgpr_read_b32 v14, a109
v_mul_f32 v14, v14, v12
v_accvgpr_write_b32 a109, v14
v_accvgpr_read_b32 v14, a110
v_mul_f32 v14, v14, v12
v_accvgpr_write_b32 a110, v14
v_accvgpr_read_b32 v14, a111
v_mul_f32 v14, v14, v12
v_accvgpr_write_b32 a111, v14
v_exp_f32 v32, v32
v_exp_f32 v33, v33
v_exp_f32 v34, v34
v_exp_f32 v35, v35
v_exp_f32 v48, v48
v_exp_f32 v49, v49
v_exp_f32 v50, v50
v_exp_f32 v51, v51
v_cvt_pk_bf16_f32 v32, v32, v33
v_cvt_pk_bf16_f32 v33, v34, v35
v_exp_f32 v36, v36
v_exp_f32 v37, v37
v_exp_f32 v38, v38
v_exp_f32 v39, v39
v_cvt_pk_bf16_f32 v34, v48, v49
v_cvt_pk_bf16_f32 v35, v50, v51
v_exp_f32 v52, v52
v_exp_f32 v53, v53
v_exp_f32 v54, v54
v_exp_f32 v55, v55
v_cvt_pk_bf16_f32 v36, v36, v37
v_cvt_pk_bf16_f32 v37, v38, v39
v_exp_f32 v40, v40
v_exp_f32 v41, v41
v_exp_f32 v42, v42
v_exp_f32 v43, v43
v_cvt_pk_bf16_f32 v38, v52, v53
v_cvt_pk_bf16_f32 v39, v54, v55
v_exp_f32 v56, v56
v_exp_f32 v57, v57
v_exp_f32 v58, v58
v_exp_f32 v59, v59
v_cvt_pk_bf16_f32 v40, v40, v41
v_cvt_pk_bf16_f32 v41, v42, v43
v_exp_f32 v44, v44
v_exp_f32 v45, v45
v_exp_f32 v46, v46
v_exp_f32 v47, v47
v_cvt_pk_bf16_f32 v42, v56, v57
v_cvt_pk_bf16_f32 v43, v58, v59
v_exp_f32 v60, v60
v_exp_f32 v61, v61
v_exp_f32 v62, v62
v_exp_f32 v63, v63
v_cvt_pk_bf16_f32 v44, v44, v45
v_cvt_pk_bf16_f32 v45, v46, v47
v_cvt_pk_bf16_f32 v46, v60, v61
v_cvt_pk_bf16_f32 v47, v62, v63
v_exp_f32 v64, v64
v_exp_f32 v65, v65
v_exp_f32 v66, v66
v_exp_f32 v67, v67
v_exp_f32 v80, v80
v_exp_f32 v81, v81
v_exp_f32 v82, v82
v_exp_f32 v83, v83
v_cvt_pk_bf16_f32 v64, v64, v65
v_cvt_pk_bf16_f32 v65, v66, v67
v_exp_f32 v68, v68
v_exp_f32 v69, v69
v_exp_f32 v70, v70
v_exp_f32 v71, v71
v_cvt_pk_bf16_f32 v66, v80, v81
v_cvt_pk_bf16_f32 v67, v82, v83
v_exp_f32 v84, v84
v_exp_f32 v85, v85
v_exp_f32 v86, v86
v_exp_f32 v87, v87
v_cvt_pk_bf16_f32 v68, v68, v69
v_cvt_pk_bf16_f32 v69, v70, v71
v_exp_f32 v72, v72
v_exp_f32 v73, v73
v_exp_f32 v74, v74
v_exp_f32 v75, v75
v_cvt_pk_bf16_f32 v70, v84, v85
v_cvt_pk_bf16_f32 v71, v86, v87
v_exp_f32 v88, v88
v_exp_f32 v89, v89
v_exp_f32 v90, v90
v_exp_f32 v91, v91
v_cvt_pk_bf16_f32 v72, v72, v73
v_cvt_pk_bf16_f32 v73, v74, v75
v_exp_f32 v76, v76
v_exp_f32 v77, v77
v_exp_f32 v78, v78
v_exp_f32 v79, v79
v_cvt_pk_bf16_f32 v74, v88, v89
v_cvt_pk_bf16_f32 v75, v90, v91
v_exp_f32 v92, v92
v_exp_f32 v93, v93
v_exp_f32 v94, v94
v_exp_f32 v95, v95
v_cvt_pk_bf16_f32 v76, v76, v77
v_cvt_pk_bf16_f32 v77, v78, v79
v_cvt_pk_bf16_f32 v78, v92, v93
v_cvt_pk_bf16_f32 v79, v94, v95
s_waitcnt vmcnt(0)
M a[96:99], a[112:115], v[32:35], a[96:99]
M a[100:103], a[112:115], v[36:39], a[100:103]
M a[104:107], a[112:115], v[40:43], a[104:107]
M a[108:111], a[112:115], v[44:47], a[108:111]
M v[160:163], v[96:99], v[32:35], v[160:163]
M v[164:167], v[96:99], v[36:39], v[164:167]
M v[168:171], v[96:99], v[40:43], v[168:171]
M v[172:175], v[96:99], v[44:47], v[172:175]
M v[176:179], v[100:103], v[32:35], v[176:179]
M v[180:183], v[100:103], v[36:39], v[180:183]
M v[184:187], v[100:103], v[40:43], v[184:187]
M v[188:191], v[100:103], v[44:47], v[188:191]
M v[192:195], v[104:107], v[32:35], v[192:195]
M v[196:199], v[104:107], v[36:39], v[196:199]
M v[200:203], v[104:107], v[40:43], v[200:203]
M v[204:207], v[104:107], v[44:47], v[204:207]
M v[208:211], v[108:111], v[32:35], v[208:211]
M v[212:215], v[108:111], v[36:39], v[212:215]
M v[216:219], v[108:111], v[40:43], v[216:219]
M v[220:223], v[108:111], v[44:47], v[220:223]
M v[224:227], v[112:115], v[32:35], v[224:227]
M v[228:231], v[112:115], v[36:39], v[228:231]
M v[232:235], v[112:115], v[40:43], v[232:235]
M v[236:239], v[112:115], v[44:47], v[236:239]
M v[240:243], v[116:119], v[32:35], v[240:243]
M v[244:247], v[116:119], v[36:39], v[244:247]
M v[248:251], v[116:119], v[40:43], v[248:251]
M v[252:255], v[116:119], v[44:47], v[252:255]
M a[64:67], v[120:123], v[32:35], a[64:67]
M a[68:71], v[120:123], v[36:39], a[68:71]
M a[72:75], v[120:123], v[40:43], a[72:75]
M a[76:79], v[120:123], v[44:47], a[76:79]
M a[80:83], v[124:127], v[32:35], a[80:83]
M a[84:87], v[124:127], v[36:39], a[84:87]
M a[88:91], v[124:127], v[40:43], a[88:91]
M a[92:95], v[124:127], v[44:47], a[92:95]
M a[96:99], a[112:115], v[64:67], a[96:99]
M a[100:103], a[112:115], v[68:71], a[100:103]
M a[104:107], a[112:115], v[72:75], a[104:107]
M a[108:111], a[112:115], v[76:79], a[108:111]
M v[160:163], v[128:131], v[64:67], v[160:163]
M v[164:167], v[128:131], v[68:71], v[164:167]
M v[168:171], v[128:131], v[72:75], v[168:171]
M v[172:175], v[128:131], v[76:79], v[172:175]
M v[176:179], v[132:135], v[64:67], v[176:179]
M v[180:183], v[132:135], v[68:71], v[180:183]
M v[184:187], v[132:135], v[72:75], v[184:187]
M v[188:191], v[132:135], v[76:79], v[188:191]
M v[192:195], v[136:139], v[64:67], v[192:195]
M v[196:199], v[136:139], v[68:71], v[196:199]
M v[200:203], v[136:139], v[72:75], v[200:203]
M v[204:207], v[136:139], v[76:79], v[204:207]
M v[208:211], v[140:143], v[64:67], v[208:211]
M v[212:215], v[140:143], v[68:71], v[212:215]
M v[216:219], v[140:143], v[72:75], v[216:219]
M v[220:223], v[140:143], v[76:79], v[220:223]
M v[224:227], v[144:147], v[64:67], v[224:227]
M v[228:231], v[144:147], v[68:71], v[228:231]
M v[232:235], v[144:147], v[72:75], v[232:235]
M v[236:239], v[144:147], v[76:79], v[236:239]
M v[240:243], v[148:151], v[64:67], v[240:243]
M v[244:247], v[148:151], v[68:71], v[244:247]
M v[248:251], v[148:151], v[72:75], v[248:251]
M v[252:255], v[148:151], v[76:79], v[252:255]
M a[64:67], v[152:155], v[64:67], a[64:67]
M a[68:71], v[152:155], v[68:71], a[68:71]
M a[72:75], v[152:155], v[72:75], a[72:75]
M a[76:79], v[152:155], v[76:79], a[76:79]
M a[80:83], v[156:159], v[64:67], a[80:83]
M a[84:87], v[156:159], v[68:71], a[84:87]
M a[88:91], v[156:159], v[72:75], a[88:91]
M a[92:95], v[156:159], v[76:79], a[92:95]
s_nop 7
s_add_u32 s57, s57, 32768
s_sub_u32 s58, s58, 64
s_sub_u32 s59, s59, 1
s_cmp_lg_u32 s59, 0
s_cbranch_scc1 Lslow_8
v_accvgpr_read_b32 v20, a96
v_accvgpr_read_b32 v21, a100
v_accvgpr_read_b32 v22, a104
v_accvgpr_read_b32 v23, a108
v_rcp_f32 v8, v20
v_rcp_f32 v9, v21
v_rcp_f32 v10, v22
v_rcp_f32 v11, v23
v_pk_mul_f32 v[160:161], v[160:161], v[8:9] op_sel:[0,0] op_sel_hi:[1,0]
v_pk_mul_f32 v[162:163], v[162:163], v[8:9] op_sel:[0,0] op_sel_hi:[1,0]
v_pk_mul_f32 v[176:177], v[176:177], v[8:9] op_sel:[0,0] op_sel_hi:[1,0]
v_pk_mul_f32 v[178:179], v[178:179], v[8:9] op_sel:[0,0] op_sel_hi:[1,0]
v_cvt_pk_bf16_f32 v160, v160, v161
v_cvt_pk_bf16_f32 v161, v162, v163
v_cvt_pk_bf16_f32 v162, v176, v177
v_cvt_pk_bf16_f32 v163, v178, v179
v_pk_mul_f32 v[164:165], v[164:165], v[8:9] op_sel:[0,1] op_sel_hi:[1,1]
v_pk_mul_f32 v[166:167], v[166:167], v[8:9] op_sel:[0,1] op_sel_hi:[1,1]
v_pk_mul_f32 v[180:181], v[180:181], v[8:9] op_sel:[0,1] op_sel_hi:[1,1]
v_pk_mul_f32 v[182:183], v[182:183], v[8:9] op_sel:[0,1] op_sel_hi:[1,1]
v_cvt_pk_bf16_f32 v164, v164, v165
v_cvt_pk_bf16_f32 v165, v166, v167
v_cvt_pk_bf16_f32 v166, v180, v181
v_cvt_pk_bf16_f32 v167, v182, v183
v_pk_mul_f32 v[168:169], v[168:169], v[10:11] op_sel:[0,0] op_sel_hi:[1,0]
v_pk_mul_f32 v[170:171], v[170:171], v[10:11] op_sel:[0,0] op_sel_hi:[1,0]
v_pk_mul_f32 v[184:185], v[184:185], v[10:11] op_sel:[0,0] op_sel_hi:[1,0]
v_pk_mul_f32 v[186:187], v[186:187], v[10:11] op_sel:[0,0] op_sel_hi:[1,0]
v_cvt_pk_bf16_f32 v168, v168, v169
v_cvt_pk_bf16_f32 v169, v170, v171
v_cvt_pk_bf16_f32 v170, v184, v185
v_cvt_pk_bf16_f32 v171, v186, v187
v_pk_mul_f32 v[172:173], v[172:173], v[10:11] op_sel:[0,1] op_sel_hi:[1,1]
v_pk_mul_f32 v[174:175], v[174:175], v[10:11] op_sel:[0,1] op_sel_hi:[1,1]
v_pk_mul_f32 v[188:189], v[188:189], v[10:11] op_sel:[0,1] op_sel_hi:[1,1]
v_pk_mul_f32 v[190:191], v[190:191], v[10:11] op_sel:[0,1] op_sel_hi:[1,1]
v_cvt_pk_bf16_f32 v172, v172, v173
v_cvt_pk_bf16_f32 v173, v174, v175
v_cvt_pk_bf16_f32 v174, v188, v189
v_cvt_pk_bf16_f32 v175, v190, v191
v_pk_mul_f32 v[192:193], v[192:193], v[8:9] op_sel:[0,0] op_sel_hi:[1,0]
v_pk_mul_f32 v[194:195], v[194:195], v[8:9] op_sel:[0,0] op_sel_hi:[1,0]
v_pk_mul_f32 v[208:209], v[208:209], v[8:9] op_sel:[0,0] op_sel_hi:[1,0]
v_pk_mul_f32 v[210:211], v[210:211], v[8:9] op_sel:[0,0] op_sel_hi:[1,0]
v_cvt_pk_bf16_f32 v192, v192, v193
v_cvt_pk_bf16_f32 v193, v194, v195
v_cvt_pk_bf16_f32 v194, v208, v209
v_cvt_pk_bf16_f32 v195, v210, v211
v_pk_mul_f32 v[196:197], v[196:197], v[8:9] op_sel:[0,1] op_sel_hi:[1,1]
v_pk_mul_f32 v[198:199], v[198:199], v[8:9] op_sel:[0,1] op_sel_hi:[1,1]
v_pk_mul_f32 v[212:213], v[212:213], v[8:9] op_sel:[0,1] op_sel_hi:[1,1]
v_pk_mul_f32 v[214:215], v[214:215], v[8:9] op_sel:[0,1] op_sel_hi:[1,1]
v_cvt_pk_bf16_f32 v196, v196, v197
v_cvt_pk_bf16_f32 v197, v198, v199
v_cvt_pk_bf16_f32 v198, v212, v213
v_cvt_pk_bf16_f32 v199, v214, v215
v_pk_mul_f32 v[200:201], v[200:201], v[10:11] op_sel:[0,0] op_sel_hi:[1,0]
v_pk_mul_f32 v[202:203], v[202:203], v[10:11] op_sel:[0,0] op_sel_hi:[1,0]
v_pk_mul_f32 v[216:217], v[216:217], v[10:11] op_sel:[0,0] op_sel_hi:[1,0]
v_pk_mul_f32 v[218:219], v[218:219], v[10:11] op_sel:[0,0] op_sel_hi:[1,0]
v_cvt_pk_bf16_f32 v200, v200, v201
v_cvt_pk_bf16_f32 v201, v202, v203
v_cvt_pk_bf16_f32 v202, v216, v217
v_cvt_pk_bf16_f32 v203, v218, v219
v_pk_mul_f32 v[204:205], v[204:205], v[10:11] op_sel:[0,1] op_sel_hi:[1,1]
v_pk_mul_f32 v[206:207], v[206:207], v[10:11] op_sel:[0,1] op_sel_hi:[1,1]
v_pk_mul_f32 v[220:221], v[220:221], v[10:11] op_sel:[0,1] op_sel_hi:[1,1]
v_pk_mul_f32 v[222:223], v[222:223], v[10:11] op_sel:[0,1] op_sel_hi:[1,1]
v_cvt_pk_bf16_f32 v204, v204, v205
v_cvt_pk_bf16_f32 v205, v206, v207
v_cvt_pk_bf16_f32 v206, v220, v221
v_cvt_pk_bf16_f32 v207, v222, v223
v_pk_mul_f32 v[224:225], v[224:225], v[8:9] op_sel:[0,0] op_sel_hi:[1,0]
v_pk_mul_f32 v[226:227], v[226:227], v[8:9] op_sel:[0,0] op_sel_hi:[1,0]
v_pk_mul_f32 v[240:241], v[240:241], v[8:9] op_sel:[0,0] op_sel_hi:[1,0]
v_pk_mul_f32 v[242:243], v[242:243], v[8:9] op_sel:[0,0] op_sel_hi:[1,0]
v_cvt_pk_bf16_f32 v224, v224, v225
v_cvt_pk_bf16_f32 v225, v226, v227
v_cvt_pk_bf16_f32 v226, v240, v241
v_cvt_pk_bf16_f32 v227, v242, v243
v_pk_mul_f32 v[228:229], v[228:229], v[8:9] op_sel:[0,1] op_sel_hi:[1,1]
v_pk_mul_f32 v[230:231], v[230:231], v[8:9] op_sel:[0,1] op_sel_hi:[1,1]
v_pk_mul_f32 v[244:245], v[244:245], v[8:9] op_sel:[0,1] op_sel_hi:[1,1]
v_pk_mul_f32 v[246:247], v[246:247], v[8:9] op_sel:[0,1] op_sel_hi:[1,1]
v_cvt_pk_bf16_f32 v228, v228, v229
v_cvt_pk_bf16_f32 v229, v230, v231
v_cvt_pk_bf16_f32 v230, v244, v245
v_cvt_pk_bf16_f32 v231, v246, v247
v_pk_mul_f32 v[232:233], v[232:233], v[10:11] op_sel:[0,0] op_sel_hi:[1,0]
v_pk_mul_f32 v[234:235], v[234:235], v[10:11] op_sel:[0,0] op_sel_hi:[1,0]
v_pk_mul_f32 v[248:249], v[248:249], v[10:11] op_sel:[0,0] op_sel_hi:[1,0]
v_pk_mul_f32 v[250:251], v[250:251], v[10:11] op_sel:[0,0] op_sel_hi:[1,0]
v_cvt_pk_bf16_f32 v232, v232, v233
v_cvt_pk_bf16_f32 v233, v234, v235
v_cvt_pk_bf16_f32 v234, v248, v249
v_cvt_pk_bf16_f32 v235, v250, v251
v_pk_mul_f32 v[236:237], v[236:237], v[10:11] op_sel:[0,1] op_sel_hi:[1,1]
v_pk_mul_f32 v[238:239], v[238:239], v[10:11] op_sel:[0,1] op_sel_hi:[1,1]
v_pk_mul_f32 v[252:253], v[252:253], v[10:11] op_sel:[0,1] op_sel_hi:[1,1]
v_pk_mul_f32 v[254:255], v[254:255], v[10:11] op_sel:[0,1] op_sel_hi:[1,1]
v_cvt_pk_bf16_f32 v236, v236, v237
v_cvt_pk_bf16_f32 v237, v238, v239
v_cvt_pk_bf16_f32 v238, v252, v253
v_cvt_pk_bf16_f32 v239, v254, v255
v_accvgpr_read_b32 v176, a64
v_accvgpr_read_b32 v177, a65
v_accvgpr_read_b32 v178, a66
v_accvgpr_read_b32 v179, a67
v_accvgpr_read_b32 v180, a80
v_accvgpr_read_b32 v181, a81
v_accvgpr_read_b32 v182, a82
v_accvgpr_read_b32 v183, a83
v_pk_mul_f32 v[176:177], v[176:177], v[8:9] op_sel:[0,0] op_sel_hi:[1,0]
v_pk_mul_f32 v[178:179], v[178:179], v[8:9] op_sel:[0,0] op_sel_hi:[1,0]
v_pk_mul_f32 v[180:181], v[180:181], v[8:9] op_sel:[0,0] op_sel_hi:[1,0]
v_pk_mul_f32 v[182:183], v[182:183], v[8:9] op_sel:[0,0] op_sel_hi:[1,0]
v_cvt_pk_bf16_f32 v176, v176, v177
v_cvt_pk_bf16_f32 v177, v178, v179
v_cvt_pk_bf16_f32 v178, v180, v181
v_cvt_pk_bf16_f32 v179, v182, v183
v_accvgpr_read_b32 v184, a68
v_accvgpr_read_b32 v185, a69
v_accvgpr_read_b32 v186, a70
v_accvgpr_read_b32 v187, a71
v_accvgpr_read_b32 v188, a84
v_accvgpr_read_b32 v189, a85
v_accvgpr_read_b32 v190, a86
v_accvgpr_read_b32 v191, a87
v_pk_mul_f32 v[184:185], v[184:185], v[8:9] op_sel:[0,1] op_sel_hi:[1,1]
v_pk_mul_f32 v[186:187], v[186:187], v[8:9] op_sel:[0,1] op_sel_hi:[1,1]
v_pk_mul_f32 v[188:189], v[188:189], v[8:9] op_sel:[0,1] op_sel_hi:[1,1]
v_pk_mul_f32 v[190:191], v[190:191], v[8:9] op_sel:[0,1] op_sel_hi:[1,1]
v_cvt_pk_bf16_f32 v184, v184, v185
v_cvt_pk_bf16_f32 v185, v186, v187
v_cvt_pk_bf16_f32 v186, v188, v189
v_cvt_pk_bf16_f32 v187, v190, v191
v_accvgpr_read_b32 v208, a72
v_accvgpr_read_b32 v209, a73
v_accvgpr_read_b32 v210, a74
v_accvgpr_read_b32 v211, a75
v_accvgpr_read_b32 v212, a88
v_accvgpr_read_b32 v213, a89
v_accvgpr_read_b32 v214, a90
v_accvgpr_read_b32 v215, a91
v_pk_mul_f32 v[208:209], v[208:209], v[10:11] op_sel:[0,0] op_sel_hi:[1,0]
v_pk_mul_f32 v[210:211], v[210:211], v[10:11] op_sel:[0,0] op_sel_hi:[1,0]
v_pk_mul_f32 v[212:213], v[212:213], v[10:11] op_sel:[0,0] op_sel_hi:[1,0]
v_pk_mul_f32 v[214:215], v[214:215], v[10:11] op_sel:[0,0] op_sel_hi:[1,0]
v_cvt_pk_bf16_f32 v208, v208, v209
v_cvt_pk_bf16_f32 v209, v210, v211
v_cvt_pk_bf16_f32 v210, v212, v213
v_cvt_pk_bf16_f32 v211, v214, v215
v_accvgpr_read_b32 v216, a76
v_accvgpr_read_b32 v217, a77
v_accvgpr_read_b32 v218, a78
v_accvgpr_read_b32 v219, a79
v_accvgpr_read_b32 v220, a92
v_accvgpr_read_b32 v221, a93
v_accvgpr_read_b32 v222, a94
v_accvgpr_read_b32 v223, a95
v_pk_mul_f32 v[216:217], v[216:217], v[10:11] op_sel:[0,1] op_sel_hi:[1,1]
v_pk_mul_f32 v[218:219], v[218:219], v[10:11] op_sel:[0,1] op_sel_hi:[1,1]
v_pk_mul_f32 v[220:221], v[220:221], v[10:11] op_sel:[0,1] op_sel_hi:[1,1]
v_pk_mul_f32 v[222:223], v[222:223], v[10:11] op_sel:[0,1] op_sel_hi:[1,1]
v_cvt_pk_bf16_f32 v216, v216, v217
v_cvt_pk_bf16_f32 v217, v218, v219
v_cvt_pk_bf16_f32 v218, v220, v221
v_cvt_pk_bf16_f32 v219, v222, v223
s_lshl_b32 s33, s56, 20
s_lshl_b32 s34, s20, 15
s_add_u32 s33, s33, s34
s_lshl_b32 s34, s23, 13
s_add_u32 s36, s33, s34
s_add_u32 s37, s36, 4096
s_add_u32 s38, s36, 16384
s_add_u32 s39, s36, 20480
s_bitcmp1_b32 s61, 0
s_cbranch_scc0 Lss_11
buffer_store_dwordx4 v[160:163], v1, s[16:19], s36 offen offset:0 sc1
buffer_store_dwordx4 v[164:167], v1, s[16:19], s36 offen offset:2048 sc1
buffer_store_dwordx4 v[168:171], v1, s[16:19], s37 offen offset:0 sc1
buffer_store_dwordx4 v[172:175], v1, s[16:19], s37 offen offset:2048 sc1
Lss_11:
s_bitcmp1_b32 s61, 1
s_cbranch_scc0 Lss_12
buffer_store_dwordx4 v[192:195], v1, s[16:19], s36 offen offset:1024 sc1
buffer_store_dwordx4 v[196:199], v1, s[16:19], s36 offen offset:3072 sc1
buffer_store_dwordx4 v[200:203], v1, s[16:19], s37 offen offset:1024 sc1
buffer_store_dwordx4 v[204:207], v1, s[16:19], s37 offen offset:3072 sc1
Lss_12:
s_bitcmp1_b32 s61, 2
s_cbranch_scc0 Lss_13
buffer_store_dwordx4 v[224:227], v1, s[16:19], s38 offen offset:0 sc1
buffer_store_dwordx4 v[228:231], v1, s[16:19], s38 offen offset:2048 sc1
buffer_store_dwordx4 v[232:235], v1, s[16:19], s39 offen offset:0 sc1
buffer_store_dwordx4 v[236:239], v1, s[16:19], s39 offen offset:2048 sc1
Lss_13:
s_bitcmp1_b32 s61, 3
s_cbranch_scc0 Lss_14
buffer_store_dwordx4 v[176:179], v1, s[16:19], s38 offen offset:1024 sc1
buffer_store_dwordx4 v[184:187], v1, s[16:19], s38 offen offset:3072 sc1
buffer_store_dwordx4 v[208:211], v1, s[16:19], s39 offen offset:1024 sc1
buffer_store_dwordx4 v[216:219], v1, s[16:19], s39 offen offset:3072 sc1
Lss_14:
s_branch Lk2_chk
Lk2_done:
s_lshl_b32 s33, s20, 4
s_add_u32 s33, s33, 8392704
s_sub_u32 s34, 15, s21
s_lshl_b32 s34, s34, 9
s_add_u32 s92, s33, s34
s_lshl_b32 s34, s22, 2
s_add_u32 s92, s92, s34
s_lshl_b32 s34, s21, 9
s_add_u32 s93, s33, s34
s_lshl_b32 s34, s23, 3
s_add_u32 s93, s93, s34
s_cmp_eq_u32 s24, 0
s_cselect_b32 s93, s93, s92
s_cselect_b32 s94, 4, 0
s_add_u32 s94, s94, s93
s_load_dwordx2 s[10:11], s[0:1], 40
s_load_dwordx2 s[14:15], s[0:1], 72
s_lshl_b32 s21, s27, 7
s_lshl_b32 s22, s28, 6
s_lshl_b32 s3, s101, 4
v_lshrrev_b32 v224, 3, v0
v_and_b32 v225, 6, v224
v_and_b32 v226, 7, v0
v_xor_b32 v225, v225, v226
v_add_u32 v224, s3, v224
v_lshlrev_b32 v224, 11, v224
v_lshl_add_u32 v6, v225, 4, v224
v_add_u32 v7, 15360, v6
v_lshrrev_b32 v224, 2, v0
v_and_b32 v226, 1, v0
v_bfe_u32 v229, v0, 1, 1
v_lshlrev_b32 v225, 7, v224
v_lshl_add_u32 v225, v226, 3, v225
v_and_b32 v228, 6, v224
v_add_u32 v227, 0, v229
v_xor_b32 v227, v227, v228
v_lshl_add_u32 v24, v227, 4, v225
v_add_u32 v28, 0x10000, v24
v_add_u32 v227, 2, v229
v_xor_b32 v227, v227, v228
v_lshl_add_u32 v25, v227, 4, v225
v_add_u32 v29, 0x10000, v25
v_add_u32 v227, 4, v229
v_xor_b32 v227, v227, v228
v_lshl_add_u32 v26, v227, 4, v225
v_add_u32 v30, 0x10000, v26
v_add_u32 v227, 6, v229
v_xor_b32 v227, v227, v228
v_lshl_add_u32 v27, v227, 4, v225
v_add_u32 v31, 0x10000, v27
s_waitcnt vmcnt(32)
s_barrier
ds_read_b64_tr_b16 v[96:97], v28 offset:0
ds_read_b64_tr_b16 v[98:99], v28 offset:2048
ds_read_b64_tr_b16 v[100:101], v28 offset:4096
ds_read_b64_tr_b16 v[102:103], v28 offset:6144
ds_read_b64_tr_b16 v[104:105], v29 offset:0
ds_read_b64_tr_b16 v[106:107], v29 offset:2048
ds_read_b64_tr_b16 v[108:109], v29 offset:4096
ds_read_b64_tr_b16 v[110:111], v29 offset:6144
ds_read_b64_tr_b16 v[112:113], v30 offset:0
ds_read_b64_tr_b16 v[114:115], v30 offset:2048
ds_read_b64_tr_b16 v[116:117], v30 offset:4096
ds_read_b64_tr_b16 v[118:119], v30 offset:6144
ds_read_b64_tr_b16 v[120:121], v31 offset:0
ds_read_b64_tr_b16 v[122:123], v31 offset:2048
ds_read_b64_tr_b16 v[124:125], v31 offset:4096
ds_read_b64_tr_b16 v[126:127], v31 offset:6144
s_and_b32 s40, s2, 1
s_bfe_u32 s3, s2, 0x10001
s_lshl_b32 s3, s3, 3
s_bfe_u32 s36, s2, 0x30003
s_add_u32 s36, s3, s36
s_lshl_b32 s29, s36, 7
s_bfe_u32 s3, s2, 0x10002
s_lshl_b32 s3, s3, 2
s_lshr_b32 s37, s2, 6
s_add_u32 s3, s3, s37
s_lshl_b32 s13, s3, 8
s_lshl_b32 s30, s3, 7
s_lshl_b32 s3, s40, 6
s_add_u32 s30, s30, s3
s_lshl_b32 s41, s101, 12
s_lshl_b32 s12, s36, 20
s_add_u32 s12, s12, s41
s_lshl_b32 s62, s36, 9
s_lshl_b32 s3, s40, 8
s_add_u32 s62, s62, s3
s_add_u32 s62, s62, 8392704
s_lshr_b32 s3, s2, 1
s_lshr_b32 s38, s2, 2
s_xor_b32 s3, s3, s38
s_and_b32 s3, s3, 1
s_lshl_b32 s3, s3, 4
s_sub_u32 s39, 32, s3
s_lshl_b32 s38, s40, 5
s_add_u32 s3, s3, s38
s_lshl_b32 s3, s3, 14
s_add_u32 s12, s12, s3
s_lshl_b32 s3, s3, 3
s_add_u32 s13, s13, s3
s_mov_b32 s64, 4294459392
s_mov_b32 s65, 16384
s_add_u32 s8, s4, 67108864
s_addc_u32 s9, s5, 0
s_lshl_b32 s56, s2, 15
s_lshl_b32 s38, s101, 13
s_add_u32 s56, s56, s38
s_xor_b32 s57, s56, 32768
s_lshl_b32 s58, s2, 2
s_add_u32 s58, s58, 8388608
s_xor_b32 s59, s58, 4
s_mov_b32 s61, 0
s_lshl_b32 s3, s101, 4
v_lshrrev_b32 v232, 4, v0
v_and_b32 v234, 15, v0
v_add_u32 v233, 0, v232
v_lshlrev_b32 v233, 1, v233
v_xor_b32 v233, v233, v234
v_add_u32 v235, s3, v232
v_lshlrev_b32 v235, 11, v235
v_lshl_add_u32 v235, v233, 4, v235
v_add_u32 v2, 0, v235
v_add_u32 v233, 4, v232
v_lshlrev_b32 v233, 1, v233
v_xor_b32 v233, v233, v234
v_add_u32 v235, s3, v232
v_lshlrev_b32 v235, 11, v235
v_lshl_add_u32 v235, v233, 4, v235
v_add_u32 v3, 7168, v235
v_add_u32 v233, 0, v232
v_lshlrev_b32 v233, 1, v233
v_xor_b32 v233, v233, v234
v_add_u32 v235, s3, v232
v_lshlrev_b32 v235, 11, v235
v_lshl_add_u32 v235, v233, 4, v235
v_add_u32 v4, 14336, v235
v_add_u32 v233, 4, v232
v_lshlrev_b32 v233, 1, v233
v_xor_b32 v233, v233, v234
v_add_u32 v235, s3, v232
v_lshlrev_b32 v235, 11, v235
v_lshl_add_u32 v235, v233, 4, v235
v_add_u32 v5, 21504, v235
v_lshlrev_b32 v225, 8, v224
v_lshl_add_u32 v225, v226, 3, v225
v_and_b32 v228, 7, v224
v_lshlrev_b32 v228, 1, v228
s_lshl_b32 s38, s40, 3
v_xor_b32 v228, s38, v228
v_add_u32 v227, 0, v229
v_xor_b32 v227, v227, v228
v_lshl_add_u32 v8, v227, 4, v225
v_add_u32 v16, 0x10000, v8
v_add_u32 v227, 2, v229
v_xor_b32 v227, v227, v228
v_lshl_add_u32 v9, v227, 4, v225
v_add_u32 v17, 0x10000, v9
v_add_u32 v227, 4, v229
v_xor_b32 v227, v227, v228
v_lshl_add_u32 v10, v227, 4, v225
v_add_u32 v18, 0x10000, v10
v_add_u32 v227, 6, v229
v_xor_b32 v227, v227, v228
v_lshl_add_u32 v11, v227, 4, v225
v_add_u32 v19, 0x10000, v11
v_add_u32 v227, 8, v229
v_xor_b32 v227, v227, v228
v_lshl_add_u32 v12, v227, 4, v225
v_add_u32 v20, 0x10000, v12
v_add_u32 v227, 10, v229
v_xor_b32 v227, v227, v228
v_lshl_add_u32 v13, v227, 4, v225
v_add_u32 v21, 0x10000, v13
v_add_u32 v227, 12, v229
v_xor_b32 v227, v227, v228
v_lshl_add_u32 v14, v227, 4, v225
v_add_u32 v22, 0x10000, v14
v_add_u32 v227, 14, v229
v_xor_b32 v227, v227, v228
v_lshl_add_u32 v15, v227, 4, v225
v_add_u32 v23, 0x10000, v15
v_mov_b32 v253, 0
v_mov_b32 v254, 1
v_lshlrev_b32 v255, 2, v0
s_waitcnt lgkmcnt(0)
s_mov_b32 s16, s14
s_mov_b32 s17, s15
s_mov_b32 s18, 8388608
s_mov_b32 s19, 0x00020000
s_waitcnt vmcnt(26) lgkmcnt(0)
s_barrier
M a[0:3], v[96:99], a[192:195], 0
s_add_u32 m0, s42, 16384
s_nop 0
buffer_load_dwordx4 v6, s[48:51], s26 offen offset:0 lds
ds_read_b64_tr_b16 v[160:161], v28 offset:16384
ds_read_b64_tr_b16 v[162:163], v28 offset:18432
M a[0:3], v[100:103], a[196:199], a[0:3]
buffer_load_dwordx4 v7, s[48:51], s26 offen offset:1024 lds
M a[4:7], v[108:111], a[196:199], 0
ds_read_b64_tr_b16 v[164:165], v28 offset:20480
ds_read_b64_tr_b16 v[166:167], v28 offset:22528
M a[4:7], v[104:107], a[192:195], a[4:7]
buffer_load_dwordx4 a[144:147], v1, s[44:47], s25 offen offset:0 sc1
M a[8:11], v[112:115], a[192:195], 0
ds_read_b64_tr_b16 v[168:169], v29 offset:16384
ds_read_b64_tr_b16 v[170:171], v29 offset:18432
M a[8:11], v[116:119], a[196:199], a[8:11]
buffer_load_dwordx4 a[148:151], v1, s[44:47], s25 offen offset:1024 sc1
M a[12:15], v[124:127], a[196:199], 0
ds_read_b64_tr_b16 v[172:173], v29 offset:20480
ds_read_b64_tr_b16 v[174:175], v29 offset:22528
M a[12:15], v[120:123], a[192:195], a[12:15]
buffer_load_dwordx4 a[152:155], v1, s[44:47], s25 offen offset:2048 sc1
M a[16:19], v[96:99], a[200:203], 0
ds_read_b64_tr_b16 v[176:177], v30 offset:16384
ds_read_b64_tr_b16 v[178:179], v30 offset:18432
M a[16:19], v[100:103], a[204:207], a[16:19]
buffer_load_dwordx4 a[156:159], v1, s[44:47], s25 offen offset:3072 sc1
M a[20:23], v[108:111], a[204:207], 0
ds_read_b64_tr_b16 v[180:181], v30 offset:20480
ds_read_b64_tr_b16 v[182:183], v30 offset:22528
M a[20:23], v[104:107], a[200:203], a[20:23]
s_add_u32 s25, s25, 16384
s_add_u32 s26, s26, 131072
M a[24:27], v[112:115], a[200:203], 0
ds_read_b64_tr_b16 v[184:185], v31 offset:16384
ds_read_b64_tr_b16 v[186:187], v31 offset:18432
M a[24:27], v[116:119], a[204:207], a[24:27]
ds_read_b64_tr_b16 v[188:189], v31 offset:20480
ds_read_b64_tr_b16 v[190:191], v31 offset:22528
M a[28:31], v[124:127], a[204:207], 0
M a[28:31], v[120:123], a[200:203], a[28:31]
s_waitcnt vmcnt(6) lgkmcnt(0)
s_barrier
s_mov_b64 exec, 1
buffer_store_dword v254, v253, s[52:55], s92 offen sc1
buffer_store_dword v254, v253, s[52:55], s93 offen sc1
buffer_store_dword v254, v253, s[52:55], s94 offen sc1
s_mov_b64 exec, -1
M a[0:3], v[160:163], a[208:211], a[0:3]
s_add_u32 m0, s42, 32768
s_nop 0
buffer_load_dwordx4 v6, s[48:51], s26 offen offset:0 lds
ds_read_b64_tr_b16 v[96:97], v28 offset:32768
ds_read_b64_tr_b16 v[98:99], v28 offset:34816
M a[0:3], v[164:167], a[212:215], a[0:3]
buffer_load_dwordx4 v7, s[48:51], s26 offen offset:1024 lds
M a[4:7], v[172:175], a[212:215], a[4:7]
ds_read_b64_tr_b16 v[100:101], v28 offset:36864
ds_read_b64_tr_b16 v[102:103], v28 offset:38912
M a[4:7], v[168:171], a[208:211], a[4:7]
buffer_load_dwordx4 a[160:163], v1, s[44:47], s25 offen offset:0 sc1
M a[8:11], v[176:179], a[208:211], a[8:11]
ds_read_b64_tr_b16 v[104:105], v29 offset:32768
ds_read_b64_tr_b16 v[106:107], v29 offset:34816
M a[8:11], v[180:183], a[212:215], a[8:11]
buffer_load_dwordx4 a[164:167], v1, s[44:47], s25 offen offset:1024 sc1
M a[12:15], v[188:191], a[212:215], a[12:15]
ds_read_b64_tr_b16 v[108:109], v29 offset:36864
ds_read_b64_tr_b16 v[110:111], v29 offset:38912
M a[12:15], v[184:187], a[208:211], a[12:15]
buffer_load_dwordx4 a[168:171], v1, s[44:47], s25 offen offset:2048 sc1
M a[16:19], v[160:163], a[216:219], a[16:19]
ds_read_b64_tr_b16 v[112:113], v30 offset:32768
ds_read_b64_tr_b16 v[114:115], v30 offset:34816
M a[16:19], v[164:167], a[220:223], a[16:19]
buffer_load_dwordx4 a[172:175], v1, s[44:47], s25 offen offset:3072 sc1
M a[20:23], v[172:175], a[220:223], a[20:23]
ds_read_b64_tr_b16 v[116:117], v30 offset:36864
ds_read_b64_tr_b16 v[118:119], v30 offset:38912
M a[20:23], v[168:171], a[216:219], a[20:23]
s_add_u32 s25, s25, 16384
s_add_u32 s26, s26, 131072
M a[24:27], v[176:179], a[216:219], a[24:27]
ds_read_b64_tr_b16 v[120:121], v31 offset:32768
ds_read_b64_tr_b16 v[122:123], v31 offset:34816
M a[24:27], v[180:183], a[220:223], a[24:27]
ds_read_b64_tr_b16 v[124:125], v31 offset:36864
ds_read_b64_tr_b16 v[126:127], v31 offset:38912
M a[28:31], v[188:191], a[220:223], a[28:31]
M a[28:31], v[184:187], a[216:219], a[28:31]
s_waitcnt vmcnt(29) lgkmcnt(0)
s_barrier
M a[0:3], v[96:99], a[224:227], a[0:3]
s_add_u32 m0, s42, 49152
s_nop 0
buffer_load_dwordx4 v6, s[48:51], s26 offen offset:0 lds
ds_read_b64_tr_b16 v[160:161], v28 offset:49152
ds_read_b64_tr_b16 v[162:163], v28 offset:51200
M a[0:3], v[100:103], a[228:231], a[0:3]
buffer_load_dwordx4 v7, s[48:51], s26 offen offset:1024 lds
M a[4:7], v[108:111], a[228:231], a[4:7]
ds_read_b64_tr_b16 v[164:165], v28 offset:53248
ds_read_b64_tr_b16 v[166:167], v28 offset:55296
M a[4:7], v[104:107], a[224:227], a[4:7]
buffer_load_dwordx4 a[176:179], v1, s[44:47], s25 offen offset:0 sc1
M a[8:11], v[112:115], a[224:227], a[8:11]
ds_read_b64_tr_b16 v[168:169], v29 offset:49152
ds_read_b64_tr_b16 v[170:171], v29 offset:51200
M a[8:11], v[116:119], a[228:231], a[8:11]
buffer_load_dwordx4 a[180:183], v1, s[44:47], s25 offen offset:1024 sc1
M a[12:15], v[124:127], a[228:231], a[12:15]
ds_read_b64_tr_b16 v[172:173], v29 offset:53248
ds_read_b64_tr_b16 v[174:175], v29 offset:55296
M a[12:15], v[120:123], a[224:227], a[12:15]
buffer_load_dwordx4 a[184:187], v1, s[44:47], s25 offen offset:2048 sc1
ds_read_b64_tr_b16 v[176:177], v30 offset:49152
ds_read_b64_tr_b16 v[178:179], v30 offset:51200
M a[16:19], v[96:99], a[232:235], a[16:19]
buffer_load_dwordx4 a[188:191], v1, s[44:47], s25 offen offset:3072 sc1
M a[16:19], v[100:103], a[236:239], a[16:19]
ds_read_b64_tr_b16 v[180:181], v30 offset:53248
ds_read_b64_tr_b16 v[182:183], v30 offset:55296
M a[20:23], v[108:111], a[236:239], a[20:23]
s_add_u32 s25, s25, 16384
s_add_u32 s26, s26, 131072
M a[20:23], v[104:107], a[232:235], a[20:23]
ds_read_b64_tr_b16 v[184:185], v31 offset:49152
ds_read_b64_tr_b16 v[186:187], v31 offset:51200
M a[24:27], v[112:115], a[232:235], a[24:27]
buffer_load_dword v252, v255, s[52:55], s62 offen sc1
M a[24:27], v[116:119], a[236:239], a[24:27]
ds_read_b64_tr_b16 v[188:189], v31 offset:53248
ds_read_b64_tr_b16 v[190:191], v31 offset:55296
M a[28:31], v[124:127], a[236:239], a[28:31]
M a[28:31], v[120:123], a[232:235], a[28:31]
s_waitcnt vmcnt(30) lgkmcnt(0)
s_barrier
s_waitcnt vmcnt(0)
v_cmp_ne_u32 vcc, 1, v252
s_nop 0
s_cbranch_vccnz Lk3_spinft
Lk3_gotft:
M a[0:3], v[160:163], a[240:243], a[0:3]
s_mov_b32 s32, s25
s_mov_b32 s33, s26
s_mov_b64 s[34:35], s[44:45]
s_mov_b64 s[36:37], s[48:49]
s_mov_b64 s[44:45], s[8:9]
s_mov_b32 s46, 16777216
s_mov_b64 s[48:49], s[10:11]
s_mov_b32 s50, 8388608
s_mov_b32 s25, s12
s_mov_b32 s26, s13
s_add_u32 m0, s41, 65536
s_nop 0
buffer_load_dwordx4 v2, s[48:51], s26 offen offset:0 lds
ds_read_b64_tr_b16 v[96:97], v24 offset:0
ds_read_b64_tr_b16 v[98:99], v24 offset:2048
M a[0:3], v[164:167], a[244:247], a[0:3]
buffer_load_dwordx4 v3, s[48:51], s26 offen offset:1024 lds
M a[4:7], v[172:175], a[244:247], a[4:7]
ds_read_b64_tr_b16 v[100:101], v24 offset:4096
ds_read_b64_tr_b16 v[102:103], v24 offset:6144
M a[4:7], v[168:171], a[240:243], a[4:7]
buffer_load_dwordx4 v4, s[48:51], s26 offen offset:2048 lds
ds_read_b64_tr_b16 v[104:105], v25 offset:0
ds_read_b64_tr_b16 v[106:107], v25 offset:2048
M a[8:11], v[176:179], a[240:243], a[8:11]
buffer_load_dwordx4 v5, s[48:51], s26 offen offset:3072 lds
M a[8:11], v[180:183], a[244:247], a[8:11]
ds_read_b64_tr_b16 v[108:109], v25 offset:4096
ds_read_b64_tr_b16 v[110:111], v25 offset:6144
M a[12:15], v[188:191], a[244:247], a[12:15]
buffer_load_dwordx4 a[192:195], v1, s[44:47], s25 offen offset:0 sc1
M a[12:15], v[184:187], a[240:243], a[12:15]
ds_read_b64_tr_b16 v[112:113], v26 offset:0
ds_read_b64_tr_b16 v[114:115], v26 offset:2048
buffer_load_dwordx4 a[196:199], v1, s[44:47], s25 offen offset:1024 sc1
M a[16:19], v[160:163], a[248:251], a[16:19]
ds_read_b64_tr_b16 v[116:117], v26 offset:4096
ds_read_b64_tr_b16 v[118:119], v26 offset:6144
M a[16:19], v[164:167], a[252:255], a[16:19]
buffer_load_dwordx4 a[200:203], v1, s[44:47], s25 offen offset:2048 sc1
M a[20:23], v[172:175], a[252:255], a[20:23]
ds_read_b64_tr_b16 v[120:121], v27 offset:0
ds_read_b64_tr_b16 v[122:123], v27 offset:2048
buffer_load_dwordx4 a[204:207], v1, s[44:47], s25 offen offset:3072 sc1
M a[20:23], v[168:171], a[248:251], a[20:23]
ds_read_b64_tr_b16 v[124:125], v27 offset:4096
ds_read_b64_tr_b16 v[126:127], v27 offset:6144
M a[24:27], v[176:179], a[248:251], a[24:27]
s_sub_u32 s39, s39, 1
s_cmp_eq_u32 s39, 0
s_cselect_b32 s3, s64, s65
M a[24:27], v[180:183], a[252:255], a[24:27]
s_add_u32 s25, s25, s3
s_lshl_b32 s3, s3, 3
s_add_u32 s26, s26, s3
M a[28:31], v[188:191], a[252:255], a[28:31]
M a[28:31], v[184:187], a[248:251], a[28:31]
s_waitcnt vmcnt(24) lgkmcnt(0)
s_barrier
M a[0:3], v[96:99], a[128:131], a[0:3]
s_add_u32 m0, s41, 81920
s_nop 0
buffer_load_dwordx4 v2, s[48:51], s26 offen offset:0 lds
ds_read_b64_tr_b16 v[160:161], v24 offset:16384
ds_read_b64_tr_b16 v[162:163], v24 offset:18432
M a[0:3], v[100:103], a[132:135], a[0:3]
buffer_load_dwordx4 v3, s[48:51], s26 offen offset:1024 lds
M a[4:7], v[108:111], a[132:135], a[4:7]
ds_read_b64_tr_b16 v[164:165], v24 offset:20480
ds_read_b64_tr_b16 v[166:167], v24 offset:22528
M a[4:7], v[104:107], a[128:131], a[4:7]
buffer_load_dwordx4 v4, s[48:51], s26 offen offset:2048 lds
ds_read_b64_tr_b16 v[168:169], v25 offset:16384
ds_read_b64_tr_b16 v[170:171], v25 offset:18432
M a[8:11], v[112:115], a[128:131], a[8:11]
buffer_load_dwordx4 v5, s[48:51], s26 offen offset:3072 lds
M a[8:11], v[116:119], a[132:135], a[8:11]
ds_read_b64_tr_b16 v[172:173], v25 offset:20480
ds_read_b64_tr_b16 v[174:175], v25 offset:22528
M a[12:15], v[124:127], a[132:135], a[12:15]
buffer_load_dwordx4 a[208:211], v1, s[44:47], s25 offen offset:0 sc1
M a[12:15], v[120:123], a[128:131], a[12:15]
ds_read_b64_tr_b16 v[176:177], v26 offset:16384
ds_read_b64_tr_b16 v[178:179], v26 offset:18432
buffer_load_dwordx4 a[212:215], v1, s[44:47], s25 offen offset:1024 sc1
M a[16:19], v[96:99], a[136:139], a[16:19]
ds_read_b64_tr_b16 v[180:181], v26 offset:20480
ds_read_b64_tr_b16 v[182:183], v26 offset:22528
M a[16:19], v[100:103], a[140:143], a[16:19]
buffer_load_dwordx4 a[216:219], v1, s[44:47], s25 offen offset:2048 sc1
M a[20:23], v[108:111], a[140:143], a[20:23]
ds_read_b64_tr_b16 v[184:185], v27 offset:16384
ds_read_b64_tr_b16 v[186:187], v27 offset:18432
buffer_load_dwordx4 a[220:223], v1, s[44:47], s25 offen offset:3072 sc1
M a[20:23], v[104:107], a[136:139], a[20:23]
ds_read_b64_tr_b16 v[188:189], v27 offset:20480
ds_read_b64_tr_b16 v[190:191], v27 offset:22528
M a[24:27], v[112:115], a[136:139], a[24:27]
s_sub_u32 s39, s39, 1
s_cmp_eq_u32 s39, 0
s_cselect_b32 s3, s64, s65
M a[24:27], v[116:119], a[140:143], a[24:27]
s_add_u32 s25, s25, s3
s_lshl_b32 s3, s3, 3
s_add_u32 s26, s26, s3
M a[28:31], v[124:127], a[140:143], a[28:31]
M a[28:31], v[120:123], a[136:139], a[28:31]
s_waitcnt vmcnt(23) lgkmcnt(0)
s_barrier
M a[0:3], v[160:163], a[144:147], a[0:3]
s_add_u32 m0, s41, 98304
s_nop 0
buffer_load_dwordx4 v2, s[48:51], s26 offen offset:0 lds
ds_read_b64_tr_b16 v[96:97], v24 offset:32768
ds_read_b64_tr_b16 v[98:99], v24 offset:34816
M a[0:3], v[164:167], a[148:151], a[0:3]
buffer_load_dwordx4 v3, s[48:51], s26 offen offset:1024 lds
M a[4:7], v[172:175], a[148:151], a[4:7]
ds_read_b64_tr_b16 v[100:101], v24 offset:36864
ds_read_b64_tr_b16 v[102:103], v24 offset:38912
M a[4:7], v[168:171], a[144:147], a[4:7]
buffer_load_dwordx4 v4, s[48:51], s26 offen offset:2048 lds
ds_read_b64_tr_b16 v[104:105], v25 offset:32768
ds_read_b64_tr_b16 v[106:107], v25 offset:34816
M a[8:11], v[176:179], a[144:147], a[8:11]
buffer_load_dwordx4 v5, s[48:51], s26 offen offset:3072 lds
M a[8:11], v[180:183], a[148:151], a[8:11]
ds_read_b64_tr_b16 v[108:109], v25 offset:36864
ds_read_b64_tr_b16 v[110:111], v25 offset:38912
M a[12:15], v[188:191], a[148:151], a[12:15]
buffer_load_dwordx4 a[224:227], v1, s[44:47], s25 offen offset:0 sc1
M a[12:15], v[184:187], a[144:147], a[12:15]
ds_read_b64_tr_b16 v[112:113], v26 offset:32768
ds_read_b64_tr_b16 v[114:115], v26 offset:34816
buffer_load_dwordx4 a[228:231], v1, s[44:47], s25 offen offset:1024 sc1
M a[16:19], v[160:163], a[152:155], a[16:19]
ds_read_b64_tr_b16 v[116:117], v26 offset:36864
ds_read_b64_tr_b16 v[118:119], v26 offset:38912
M a[16:19], v[164:167], a[156:159], a[16:19]
buffer_load_dwordx4 a[232:235], v1, s[44:47], s25 offen offset:2048 sc1
M a[20:23], v[172:175], a[156:159], a[20:23]
ds_read_b64_tr_b16 v[120:121], v27 offset:32768
ds_read_b64_tr_b16 v[122:123], v27 offset:34816
buffer_load_dwordx4 a[236:239], v1, s[44:47], s25 offen offset:3072 sc1
M a[20:23], v[168:171], a[152:155], a[20:23]
ds_read_b64_tr_b16 v[124:125], v27 offset:36864
ds_read_b64_tr_b16 v[126:127], v27 offset:38912
M a[24:27], v[176:179], a[152:155], a[24:27]
s_sub_u32 s39, s39, 1
s_cmp_eq_u32 s39, 0
s_cselect_b32 s3, s64, s65
M a[24:27], v[180:183], a[156:159], a[24:27]
s_add_u32 s25, s25, s3
s_lshl_b32 s3, s3, 3
s_add_u32 s26, s26, s3
M a[28:31], v[188:191], a[156:159], a[28:31]
M a[28:31], v[184:187], a[152:155], a[28:31]
s_waitcnt vmcnt(25) lgkmcnt(0)
s_barrier
M a[0:3], v[96:99], a[160:163], a[0:3]
s_add_u32 m0, s41, 114688
s_nop 0
buffer_load_dwordx4 v2, s[48:51], s26 offen offset:0 lds
ds_read_b64_tr_b16 v[160:161], v24 offset:49152
ds_read_b64_tr_b16 v[162:163], v24 offset:51200
M a[0:3], v[100:103], a[164:167], a[0:3]
buffer_load_dwordx4 v3, s[48:51], s26 offen offset:1024 lds
M a[4:7], v[108:111], a[164:167], a[4:7]
ds_read_b64_tr_b16 v[164:165], v24 offset:53248
ds_read_b64_tr_b16 v[166:167], v24 offset:55296
M a[4:7], v[104:107], a[160:163], a[4:7]
buffer_load_dwordx4 v4, s[48:51], s26 offen offset:2048 lds
ds_read_b64_tr_b16 v[168:169], v25 offset:49152
ds_read_b64_tr_b16 v[170:171], v25 offset:51200
M a[8:11], v[112:115], a[160:163], a[8:11]
buffer_load_dwordx4 v5, s[48:51], s26 offen offset:3072 lds
M a[8:11], v[116:119], a[164:167], a[8:11]
ds_read_b64_tr_b16 v[172:173], v25 offset:53248
ds_read_b64_tr_b16 v[174:175], v25 offset:55296
M a[12:15], v[124:127], a[164:167], a[12:15]
buffer_load_dwordx4 a[240:243], v1, s[44:47], s25 offen offset:0 sc1
M a[12:15], v[120:123], a[160:163], a[12:15]
ds_read_b64_tr_b16 v[176:177], v26 offset:49152
ds_read_b64_tr_b16 v[178:179], v26 offset:51200
buffer_load_dwordx4 a[244:247], v1, s[44:47], s25 offen offset:1024 sc1
M a[16:19], v[96:99], a[168:171], a[16:19]
ds_read_b64_tr_b16 v[180:181], v26 offset:53248
ds_read_b64_tr_b16 v[182:183], v26 offset:55296
M a[16:19], v[100:103], a[172:175], a[16:19]
buffer_load_dwordx4 a[248:251], v1, s[44:47], s25 offen offset:2048 sc1
M a[20:23], v[108:111], a[172:175], a[20:23]
ds_read_b64_tr_b16 v[184:185], v27 offset:49152
ds_read_b64_tr_b16 v[186:187], v27 offset:51200
buffer_load_dwordx4 a[252:255], v1, s[44:47], s25 offen offset:3072 sc1
M a[20:23], v[104:107], a[168:171], a[20:23]
ds_read_b64_tr_b16 v[188:189], v27 offset:53248
ds_read_b64_tr_b16 v[190:191], v27 offset:55296
M a[24:27], v[112:115], a[168:171], a[24:27]
s_sub_u32 s39, s39, 1
s_cmp_eq_u32 s39, 0
s_cselect_b32 s3, s64, s65
M a[24:27], v[116:119], a[172:175], a[24:27]
s_add_u32 s25, s25, s3
s_lshl_b32 s3, s3, 3
s_add_u32 s26, s26, s3
M a[28:31], v[124:127], a[172:175], a[28:31]
M a[28:31], v[120:123], a[168:171], a[28:31]
s_waitcnt vmcnt(24) lgkmcnt(0)
s_barrier
M a[0:3], v[160:163], a[176:179], a[0:3]
s_add_u32 m0, s41, 0
s_nop 0
buffer_load_dwordx4 v2, s[48:51], s26 offen offset:0 lds
ds_read_b64_tr_b16 v[96:97], v16 offset:0
ds_read_b64_tr_b16 v[98:99], v16 offset:4096
M a[0:3], v[164:167], a[180:183], a[0:3]
buffer_load_dwordx4 v3, s[48:51], s26 offen offset:1024 lds
ds_read_b64_tr_b16 v[100:101], v16 offset:8192
ds_read_b64_tr_b16 v[102:103], v16 offset:12288
M a[4:7], v[172:175], a[180:183], a[4:7]
buffer_load_dwordx4 v4, s[48:51], s26 offen offset:2048 lds
ds_read_b64_tr_b16 v[104:105], v17 offset:0
ds_read_b64_tr_b16 v[106:107], v17 offset:4096
M a[4:7], v[168:171], a[176:179], a[4:7]
buffer_load_dwordx4 v5, s[48:51], s26 offen offset:3072 lds
ds_read_b64_tr_b16 v[108:109], v17 offset:8192
ds_read_b64_tr_b16 v[110:111], v17 offset:12288
M a[8:11], v[176:179], a[176:179], a[8:11]
buffer_load_dwordx4 a[128:131], v1, s[44:47], s25 offen offset:0 sc1
ds_read_b64_tr_b16 v[112:113], v18 offset:0
ds_read_b64_tr_b16 v[114:115], v18 offset:4096
M a[8:11], v[180:183], a[180:183], a[8:11]
buffer_load_dwordx4 a[132:135], v1, s[44:47], s25 offen offset:1024 sc1
ds_read_b64_tr_b16 v[116:117], v18 offset:8192
ds_read_b64_tr_b16 v[118:119], v18 offset:12288
M a[12:15], v[188:191], a[180:183], a[12:15]
buffer_load_dwordx4 a[136:139], v1, s[44:47], s25 offen offset:2048 sc1
M a[12:15], v[184:187], a[176:179], a[12:15]
ds_read_b64_tr_b16 v[120:121], v19 offset:0
ds_read_b64_tr_b16 v[122:123], v19 offset:4096
buffer_load_dwordx4 a[140:143], v1, s[44:47], s25 offen offset:3072 sc1
M a[16:19], v[160:163], a[184:187], a[16:19]
ds_read_b64_tr_b16 v[124:125], v19 offset:8192
ds_read_b64_tr_b16 v[126:127], v19 offset:12288
s_sub_u32 s39, s39, 1
s_cmp_eq_u32 s39, 0
s_cselect_b32 s3, s64, s65
M a[16:19], v[164:167], a[188:191], a[16:19]
ds_read_b64_tr_b16 v[128:129], v20 offset:0
ds_read_b64_tr_b16 v[130:131], v20 offset:4096
s_add_u32 s25, s25, s3
s_lshl_b32 s3, s3, 3
s_add_u32 s26, s26, s3
M a[20:23], v[172:175], a[188:191], a[20:23]
ds_read_b64_tr_b16 v[132:133], v20 offset:8192
ds_read_b64_tr_b16 v[134:135], v20 offset:12288
ds_read_b64_tr_b16 v[136:137], v21 offset:0
ds_read_b64_tr_b16 v[138:139], v21 offset:4096
M a[20:23], v[168:171], a[184:187], a[20:23]
ds_read_b64_tr_b16 v[140:141], v21 offset:8192
ds_read_b64_tr_b16 v[142:143], v21 offset:12288
ds_read_b64_tr_b16 v[144:145], v22 offset:0
ds_read_b64_tr_b16 v[146:147], v22 offset:4096
M a[24:27], v[176:179], a[184:187], a[24:27]
ds_read_b64_tr_b16 v[148:149], v22 offset:8192
ds_read_b64_tr_b16 v[150:151], v22 offset:12288
ds_read_b64_tr_b16 v[152:153], v23 offset:0
ds_read_b64_tr_b16 v[154:155], v23 offset:4096
M a[24:27], v[180:183], a[188:191], a[24:27]
ds_read_b64_tr_b16 v[156:157], v23 offset:8192
ds_read_b64_tr_b16 v[158:159], v23 offset:12288
M a[28:31], v[188:191], a[188:191], a[28:31]
M a[28:31], v[184:187], a[184:187], a[28:31]
s_waitcnt vmcnt(24) lgkmcnt(0)
s_barrier
M v[32:35], v[96:99], a[192:195], 0
s_add_u32 m0, s41, 16384
s_nop 0
buffer_load_dwordx4 v2, s[48:51], s26 offen offset:0 lds
M v[32:35], v[100:103], a[196:199], v[32:35]
ds_read_b64_tr_b16 v[160:161], v16 offset:16384
ds_read_b64_tr_b16 v[162:163], v16 offset:20480
M v[36:39], v[108:111], a[196:199], 0
buffer_load_dwordx4 v3, s[48:51], s26 offen offset:1024 lds
M v[36:39], v[104:107], a[192:195], v[36:39]
ds_read_b64_tr_b16 v[164:165], v16 offset:24576
ds_read_b64_tr_b16 v[166:167], v16 offset:28672
M v[40:43], v[112:115], a[192:195], 0
buffer_load_dwordx4 v4, s[48:51], s26 offen offset:2048 lds
M v[40:43], v[116:119], a[196:199], v[40:43]
ds_read_b64_tr_b16 v[168:169], v17 offset:16384
ds_read_b64_tr_b16 v[170:171], v17 offset:20480
M v[44:47], v[124:127], a[196:199], 0
buffer_load_dwordx4 v5, s[48:51], s26 offen offset:3072 lds
M v[44:47], v[120:123], a[192:195], v[44:47]
M v[48:51], v[128:131], a[192:195], 0
ds_read_b64_tr_b16 v[172:173], v17 offset:24576
ds_read_b64_tr_b16 v[174:175], v17 offset:28672
M v[48:51], v[132:135], a[196:199], v[48:51]
buffer_load_dwordx4 a[144:147], v1, s[44:47], s25 offen offset:0 sc1
M v[52:55], v[140:143], a[196:199], 0
ds_read_b64_tr_b16 v[176:177], v18 offset:16384
ds_read_b64_tr_b16 v[178:179], v18 offset:20480
M v[52:55], v[136:139], a[192:195], v[52:55]
buffer_load_dwordx4 a[148:151], v1, s[44:47], s25 offen offset:1024 sc1
M v[56:59], v[144:147], a[192:195], 0
ds_read_b64_tr_b16 v[180:181], v18 offset:24576
ds_read_b64_tr_b16 v[182:183], v18 offset:28672
M v[56:59], v[148:151], a[196:199], v[56:59]
buffer_load_dwordx4 a[152:155], v1, s[44:47], s25 offen offset:2048 sc1
M v[60:63], v[156:159], a[196:199], 0
M v[60:63], v[152:155], a[192:195], v[60:63]
ds_read_b64_tr_b16 v[184:185], v19 offset:16384
ds_read_b64_tr_b16 v[186:187], v19 offset:20480
M v[64:67], v[96:99], a[200:203], 0
buffer_load_dwordx4 a[156:159], v1, s[44:47], s25 offen offset:3072 sc1
M v[64:67], v[100:103], a[204:207], v[64:67]
ds_read_b64_tr_b16 v[188:189], v19 offset:24576
ds_read_b64_tr_b16 v[190:191], v19 offset:28672
M v[68:71], v[108:111], a[204:207], 0
s_sub_u32 s39, s39, 1
s_cmp_eq_u32 s39, 0
s_cselect_b32 s3, s64, s65
M v[68:71], v[104:107], a[200:203], v[68:71]
ds_read_b64_tr_b16 v[192:193], v20 offset:16384
ds_read_b64_tr_b16 v[194:195], v20 offset:20480
M v[72:75], v[112:115], a[200:203], 0
s_add_u32 s25, s25, s3
s_lshl_b32 s3, s3, 3
s_add_u32 s26, s26, s3
M v[72:75], v[116:119], a[204:207], v[72:75]
ds_read_b64_tr_b16 v[196:197], v20 offset:24576
ds_read_b64_tr_b16 v[198:199], v20 offset:28672
M v[76:79], v[124:127], a[204:207], 0
M v[76:79], v[120:123], a[200:203], v[76:79]
ds_read_b64_tr_b16 v[200:201], v21 offset:16384
ds_read_b64_tr_b16 v[202:203], v21 offset:20480
M v[80:83], v[128:131], a[200:203], 0
ds_read_b64_tr_b16 v[204:205], v21 offset:24576
ds_read_b64_tr_b16 v[206:207], v21 offset:28672
M v[80:83], v[132:135], a[204:207], v[80:83]
ds_read_b64_tr_b16 v[208:209], v22 offset:16384
ds_read_b64_tr_b16 v[210:211], v22 offset:20480
M v[84:87], v[140:143], a[204:207], 0
ds_read_b64_tr_b16 v[212:213], v22 offset:24576
ds_read_b64_tr_b16 v[214:215], v22 offset:28672
M v[84:87], v[136:139], a[200:203], v[84:87]
ds_read_b64_tr_b16 v[216:217], v23 offset:16384
ds_read_b64_tr_b16 v[218:219], v23 offset:20480
M v[88:91], v[144:147], a[200:203], 0
ds_read_b64_tr_b16 v[220:221], v23 offset:24576
ds_read_b64_tr_b16 v[222:223], v23 offset:28672
M v[88:91], v[148:151], a[204:207], v[88:91]
M v[92:95], v[156:159], a[204:207], 0
M v[92:95], v[152:155], a[200:203], v[92:95]
s_mov_b32 s28, 3
Lk3_la:
s_waitcnt vmcnt(24) lgkmcnt(0)
s_barrier
M v[32:35], v[160:163], a[208:211], v[32:35]
s_add_u32 m0, s41, 32768
s_nop 0
buffer_load_dwordx4 v2, s[48:51], s26 offen offset:0 lds
M v[32:35], v[164:167], a[212:215], v[32:35]
ds_read_b64_tr_b16 v[96:97], v16 offset:32768
ds_read_b64_tr_b16 v[98:99], v16 offset:36864
M v[36:39], v[172:175], a[212:215], v[36:39]
buffer_load_dwordx4 v3, s[48:51], s26 offen offset:1024 lds
M v[36:39], v[168:171], a[208:211], v[36:39]
ds_read_b64_tr_b16 v[100:101], v16 offset:40960
ds_read_b64_tr_b16 v[102:103], v16 offset:45056
M v[40:43], v[176:179], a[208:211], v[40:43]
buffer_load_dwordx4 v4, s[48:51], s26 offen offset:2048 lds
M v[40:43], v[180:183], a[212:215], v[40:43]
ds_read_b64_tr_b16 v[104:105], v17 offset:32768
ds_read_b64_tr_b16 v[106:107], v17 offset:36864
M v[44:47], v[188:191], a[212:215], v[44:47]
buffer_load_dwordx4 v5, s[48:51], s26 offen offset:3072 lds
M v[44:47], v[184:187], a[208:211], v[44:47]
M v[48:51], v[192:195], a[208:211], v[48:51]
ds_read_b64_tr_b16 v[108:109], v17 offset:40960
ds_read_b64_tr_b16 v[110:111], v17 offset:45056
M v[48:51], v[196:199], a[212:215], v[48:51]
buffer_load_dwordx4 a[160:163], v1, s[44:47], s25 offen offset:0 sc1
M v[52:55], v[204:207], a[212:215], v[52:55]
ds_read_b64_tr_b16 v[112:113], v18 offset:32768
ds_read_b64_tr_b16 v[114:115], v18 offset:36864
M v[52:55], v[200:203], a[208:211], v[52:55]
buffer_load_dwordx4 a[164:167], v1, s[44:47], s25 offen offset:1024 sc1
M v[56:59], v[208:211], a[208:211], v[56:59]
ds_read_b64_tr_b16 v[116:117], v18 offset:40960
ds_read_b64_tr_b16 v[118:119], v18 offset:45056
M v[56:59], v[212:215], a[212:215], v[56:59]
buffer_load_dwordx4 a[168:171], v1, s[44:47], s25 offen offset:2048 sc1
M v[60:63], v[220:223], a[212:215], v[60:63]
M v[60:63], v[216:219], a[208:211], v[60:63]
ds_read_b64_tr_b16 v[120:121], v19 offset:32768
ds_read_b64_tr_b16 v[122:123], v19 offset:36864
M v[64:67], v[160:163], a[216:219], v[64:67]
buffer_load_dwordx4 a[172:175], v1, s[44:47], s25 offen offset:3072 sc1
M v[64:67], v[164:167], a[220:223], v[64:67]
ds_read_b64_tr_b16 v[124:125], v19 offset:40960
ds_read_b64_tr_b16 v[126:127], v19 offset:45056
M v[68:71], v[172:175], a[220:223], v[68:71]
s_sub_u32 s39, s39, 1
s_cmp_eq_u32 s39, 0
s_cselect_b32 s3, s64, s65
M v[68:71], v[168:171], a[216:219], v[68:71]
ds_read_b64_tr_b16 v[128:129], v20 offset:32768
ds_read_b64_tr_b16 v[130:131], v20 offset:36864
M v[72:75], v[176:179], a[216:219], v[72:75]
s_add_u32 s25, s25, s3
s_lshl_b32 s3, s3, 3
s_add_u32 s26, s26, s3
M v[72:75], v[180:183], a[220:223], v[72:75]
ds_read_b64_tr_b16 v[132:133], v20 offset:40960
ds_read_b64_tr_b16 v[134:135], v20 offset:45056
M v[76:79], v[188:191], a[220:223], v[76:79]
M v[76:79], v[184:187], a[216:219], v[76:79]
ds_read_b64_tr_b16 v[136:137], v21 offset:32768
ds_read_b64_tr_b16 v[138:139], v21 offset:36864
M v[80:83], v[192:195], a[216:219], v[80:83]
ds_read_b64_tr_b16 v[140:141], v21 offset:40960
ds_read_b64_tr_b16 v[142:143], v21 offset:45056
M v[80:83], v[196:199], a[220:223], v[80:83]
ds_read_b64_tr_b16 v[144:145], v22 offset:32768
ds_read_b64_tr_b16 v[146:147], v22 offset:36864
M v[84:87], v[204:207], a[220:223], v[84:87]
ds_read_b64_tr_b16 v[148:149], v22 offset:40960
ds_read_b64_tr_b16 v[150:151], v22 offset:45056
M v[84:87], v[200:203], a[216:219], v[84:87]
ds_read_b64_tr_b16 v[152:153], v23 offset:32768
ds_read_b64_tr_b16 v[154:155], v23 offset:36864
M v[88:91], v[208:211], a[216:219], v[88:91]
ds_read_b64_tr_b16 v[156:157], v23 offset:40960
ds_read_b64_tr_b16 v[158:159], v23 offset:45056
M v[88:91], v[212:215], a[220:223], v[88:91]
M v[92:95], v[220:223], a[220:223], v[92:95]
M v[92:95], v[216:219], a[216:219], v[92:95]
s_waitcnt vmcnt(24) lgkmcnt(0)
s_barrier
M v[32:35], v[96:99], a[224:227], v[32:35]
s_add_u32 m0, s41, 49152
s_nop 0
buffer_load_dwordx4 v2, s[48:51], s26 offen offset:0 lds
M v[32:35], v[100:103], a[228:231], v[32:35]
ds_read_b64_tr_b16 v[160:161], v16 offset:49152
ds_read_b64_tr_b16 v[162:163], v16 offset:53248
M v[36:39], v[108:111], a[228:231], v[36:39]
buffer_load_dwordx4 v3, s[48:51], s26 offen offset:1024 lds
M v[36:39], v[104:107], a[224:227], v[36:39]
ds_read_b64_tr_b16 v[164:165], v16 offset:57344
ds_read_b64_tr_b16 v[166:167], v16 offset:61440
M v[40:43], v[112:115], a[224:227], v[40:43]
buffer_load_dwordx4 v4, s[48:51], s26 offen offset:2048 lds
M v[40:43], v[116:119], a[228:231], v[40:43]
ds_read_b64_tr_b16 v[168:169], v17 offset:49152
ds_read_b64_tr_b16 v[170:171], v17 offset:53248
M v[44:47], v[124:127], a[228:231], v[44:47]
buffer_load_dwordx4 v5, s[48:51], s26 offen offset:3072 lds
M v[44:47], v[120:123], a[224:227], v[44:47]
M v[48:51], v[128:131], a[224:227], v[48:51]
ds_read_b64_tr_b16 v[172:173], v17 offset:57344
ds_read_b64_tr_b16 v[174:175], v17 offset:61440
M v[48:51], v[132:135], a[228:231], v[48:51]
buffer_load_dwordx4 a[176:179], v1, s[44:47], s25 offen offset:0 sc1
M v[52:55], v[140:143], a[228:231], v[52:55]
ds_read_b64_tr_b16 v[176:177], v18 offset:49152
ds_read_b64_tr_b16 v[178:179], v18 offset:53248
M v[52:55], v[136:139], a[224:227], v[52:55]
buffer_load_dwordx4 a[180:183], v1, s[44:47], s25 offen offset:1024 sc1
M v[56:59], v[144:147], a[224:227], v[56:59]
ds_read_b64_tr_b16 v[180:181], v18 offset:57344
ds_read_b64_tr_b16 v[182:183], v18 offset:61440
M v[56:59], v[148:151], a[228:231], v[56:59]
buffer_load_dwordx4 a[184:187], v1, s[44:47], s25 offen offset:2048 sc1
M v[60:63], v[156:159], a[228:231], v[60:63]
M v[60:63], v[152:155], a[224:227], v[60:63]
ds_read_b64_tr_b16 v[184:185], v19 offset:49152
ds_read_b64_tr_b16 v[186:187], v19 offset:53248
M v[64:67], v[96:99], a[232:235], v[64:67]
buffer_load_dwordx4 a[188:191], v1, s[44:47], s25 offen offset:3072 sc1
M v[64:67], v[100:103], a[236:239], v[64:67]
ds_read_b64_tr_b16 v[188:189], v19 offset:57344
ds_read_b64_tr_b16 v[190:191], v19 offset:61440
M v[68:71], v[108:111], a[236:239], v[68:71]
s_sub_u32 s39, s39, 1
s_cmp_eq_u32 s39, 0
s_cselect_b32 s3, s64, s65
M v[68:71], v[104:107], a[232:235], v[68:71]
ds_read_b64_tr_b16 v[192:193], v20 offset:49152
ds_read_b64_tr_b16 v[194:195], v20 offset:53248
M v[72:75], v[112:115], a[232:235], v[72:75]
s_add_u32 s25, s25, s3
s_lshl_b32 s3, s3, 3
s_add_u32 s26, s26, s3
M v[72:75], v[116:119], a[236:239], v[72:75]
ds_read_b64_tr_b16 v[196:197], v20 offset:57344
ds_read_b64_tr_b16 v[198:199], v20 offset:61440
M v[76:79], v[124:127], a[236:239], v[76:79]
M v[76:79], v[120:123], a[232:235], v[76:79]
ds_read_b64_tr_b16 v[200:201], v21 offset:49152
ds_read_b64_tr_b16 v[202:203], v21 offset:53248
M v[80:83], v[128:131], a[232:235], v[80:83]
ds_read_b64_tr_b16 v[204:205], v21 offset:57344
ds_read_b64_tr_b16 v[206:207], v21 offset:61440
M v[80:83], v[132:135], a[236:239], v[80:83]
ds_read_b64_tr_b16 v[208:209], v22 offset:49152
ds_read_b64_tr_b16 v[210:211], v22 offset:53248
M v[84:87], v[140:143], a[236:239], v[84:87]
ds_read_b64_tr_b16 v[212:213], v22 offset:57344
ds_read_b64_tr_b16 v[214:215], v22 offset:61440
M v[84:87], v[136:139], a[232:235], v[84:87]
ds_read_b64_tr_b16 v[216:217], v23 offset:49152
ds_read_b64_tr_b16 v[218:219], v23 offset:53248
M v[88:91], v[144:147], a[232:235], v[88:91]
ds_read_b64_tr_b16 v[220:221], v23 offset:57344
ds_read_b64_tr_b16 v[222:223], v23 offset:61440
M v[88:91], v[148:151], a[236:239], v[88:91]
M v[92:95], v[156:159], a[236:239], v[92:95]
M v[92:95], v[152:155], a[232:235], v[92:95]
s_waitcnt vmcnt(24) lgkmcnt(0)
s_barrier
M v[32:35], v[160:163], a[240:243], v[32:35]
s_add_u32 m0, s41, 65536
s_nop 0
buffer_load_dwordx4 v2, s[48:51], s26 offen offset:0 lds
M v[32:35], v[164:167], a[244:247], v[32:35]
ds_read_b64_tr_b16 v[96:97], v8 offset:0
ds_read_b64_tr_b16 v[98:99], v8 offset:4096
M v[36:39], v[172:175], a[244:247], v[36:39]
buffer_load_dwordx4 v3, s[48:51], s26 offen offset:1024 lds
M v[36:39], v[168:171], a[240:243], v[36:39]
ds_read_b64_tr_b16 v[100:101], v8 offset:8192
ds_read_b64_tr_b16 v[102:103], v8 offset:12288
M v[40:43], v[176:179], a[240:243], v[40:43]
buffer_load_dwordx4 v4, s[48:51], s26 offen offset:2048 lds
M v[40:43], v[180:183], a[244:247], v[40:43]
ds_read_b64_tr_b16 v[104:105], v9 offset:0
ds_read_b64_tr_b16 v[106:107], v9 offset:4096
M v[44:47], v[188:191], a[244:247], v[44:47]
buffer_load_dwordx4 v5, s[48:51], s26 offen offset:3072 lds
M v[44:47], v[184:187], a[240:243], v[44:47]
M v[48:51], v[192:195], a[240:243], v[48:51]
ds_read_b64_tr_b16 v[108:109], v9 offset:8192
ds_read_b64_tr_b16 v[110:111], v9 offset:12288
M v[48:51], v[196:199], a[244:247], v[48:51]
buffer_load_dwordx4 a[192:195], v1, s[44:47], s25 offen offset:0 sc1
M v[52:55], v[204:207], a[244:247], v[52:55]
ds_read_b64_tr_b16 v[112:113], v10 offset:0
ds_read_b64_tr_b16 v[114:115], v10 offset:4096
M v[52:55], v[200:203], a[240:243], v[52:55]
buffer_load_dwordx4 a[196:199], v1, s[44:47], s25 offen offset:1024 sc1
M v[56:59], v[208:211], a[240:243], v[56:59]
ds_read_b64_tr_b16 v[116:117], v10 offset:8192
ds_read_b64_tr_b16 v[118:119], v10 offset:12288
M v[56:59], v[212:215], a[244:247], v[56:59]
buffer_load_dwordx4 a[200:203], v1, s[44:47], s25 offen offset:2048 sc1
M v[60:63], v[220:223], a[244:247], v[60:63]
M v[60:63], v[216:219], a[240:243], v[60:63]
ds_read_b64_tr_b16 v[120:121], v11 offset:0
ds_read_b64_tr_b16 v[122:123], v11 offset:4096
M v[64:67], v[160:163], a[248:251], v[64:67]
buffer_load_dwordx4 a[204:207], v1, s[44:47], s25 offen offset:3072 sc1
M v[64:67], v[164:167], a[252:255], v[64:67]
ds_read_b64_tr_b16 v[124:125], v11 offset:8192
ds_read_b64_tr_b16 v[126:127], v11 offset:12288
M v[68:71], v[172:175], a[252:255], v[68:71]
s_sub_u32 s39, s39, 1
s_cmp_eq_u32 s39, 0
s_cselect_b32 s3, s64, s65
M v[68:71], v[168:171], a[248:251], v[68:71]
ds_read_b64_tr_b16 v[128:129], v12 offset:0
ds_read_b64_tr_b16 v[130:131], v12 offset:4096
M v[72:75], v[176:179], a[248:251], v[72:75]
s_add_u32 s25, s25, s3
s_lshl_b32 s3, s3, 3
s_add_u32 s26, s26, s3
M v[72:75], v[180:183], a[252:255], v[72:75]
ds_read_b64_tr_b16 v[132:133], v12 offset:8192
ds_read_b64_tr_b16 v[134:135], v12 offset:12288
M v[76:79], v[188:191], a[252:255], v[76:79]
M v[76:79], v[184:187], a[248:251], v[76:79]
ds_read_b64_tr_b16 v[136:137], v13 offset:0
ds_read_b64_tr_b16 v[138:139], v13 offset:4096
M v[80:83], v[192:195], a[248:251], v[80:83]
ds_read_b64_tr_b16 v[140:141], v13 offset:8192
ds_read_b64_tr_b16 v[142:143], v13 offset:12288
M v[80:83], v[196:199], a[252:255], v[80:83]
ds_read_b64_tr_b16 v[144:145], v14 offset:0
ds_read_b64_tr_b16 v[146:147], v14 offset:4096
M v[84:87], v[204:207], a[252:255], v[84:87]
ds_read_b64_tr_b16 v[148:149], v14 offset:8192
ds_read_b64_tr_b16 v[150:151], v14 offset:12288
M v[84:87], v[200:203], a[248:251], v[84:87]
ds_read_b64_tr_b16 v[152:153], v15 offset:0
ds_read_b64_tr_b16 v[154:155], v15 offset:4096
M v[88:91], v[208:211], a[248:251], v[88:91]
ds_read_b64_tr_b16 v[156:157], v15 offset:8192
ds_read_b64_tr_b16 v[158:159], v15 offset:12288
M v[88:91], v[212:215], a[252:255], v[88:91]
M v[92:95], v[220:223], a[252:255], v[92:95]
M v[92:95], v[216:219], a[248:251], v[92:95]
s_waitcnt vmcnt(24) lgkmcnt(0)
s_barrier
M v[32:35], v[96:99], a[128:131], v[32:35]
s_add_u32 m0, s41, 81920
s_nop 0
buffer_load_dwordx4 v2, s[48:51], s26 offen offset:0 lds
M v[32:35], v[100:103], a[132:135], v[32:35]
ds_read_b64_tr_b16 v[160:161], v8 offset:16384
ds_read_b64_tr_b16 v[162:163], v8 offset:20480
M v[36:39], v[108:111], a[132:135], v[36:39]
buffer_load_dwordx4 v3, s[48:51], s26 offen offset:1024 lds
M v[36:39], v[104:107], a[128:131], v[36:39]
ds_read_b64_tr_b16 v[164:165], v8 offset:24576
ds_read_b64_tr_b16 v[166:167], v8 offset:28672
M v[40:43], v[112:115], a[128:131], v[40:43]
buffer_load_dwordx4 v4, s[48:51], s26 offen offset:2048 lds
M v[40:43], v[116:119], a[132:135], v[40:43]
ds_read_b64_tr_b16 v[168:169], v9 offset:16384
ds_read_b64_tr_b16 v[170:171], v9 offset:20480
M v[44:47], v[124:127], a[132:135], v[44:47]
buffer_load_dwordx4 v5, s[48:51], s26 offen offset:3072 lds
M v[44:47], v[120:123], a[128:131], v[44:47]
M v[48:51], v[128:131], a[128:131], v[48:51]
ds_read_b64_tr_b16 v[172:173], v9 offset:24576
ds_read_b64_tr_b16 v[174:175], v9 offset:28672
M v[48:51], v[132:135], a[132:135], v[48:51]
buffer_load_dwordx4 a[208:211], v1, s[44:47], s25 offen offset:0 sc1
M v[52:55], v[140:143], a[132:135], v[52:55]
ds_read_b64_tr_b16 v[176:177], v10 offset:16384
ds_read_b64_tr_b16 v[178:179], v10 offset:20480
M v[52:55], v[136:139], a[128:131], v[52:55]
buffer_load_dwordx4 a[212:215], v1, s[44:47], s25 offen offset:1024 sc1
M v[56:59], v[144:147], a[128:131], v[56:59]
ds_read_b64_tr_b16 v[180:181], v10 offset:24576
ds_read_b64_tr_b16 v[182:183], v10 offset:28672
M v[56:59], v[148:151], a[132:135], v[56:59]
buffer_load_dwordx4 a[216:219], v1, s[44:47], s25 offen offset:2048 sc1
M v[60:63], v[156:159], a[132:135], v[60:63]
M v[60:63], v[152:155], a[128:131], v[60:63]
ds_read_b64_tr_b16 v[184:185], v11 offset:16384
ds_read_b64_tr_b16 v[186:187], v11 offset:20480
M v[64:67], v[96:99], a[136:139], v[64:67]
buffer_load_dwordx4 a[220:223], v1, s[44:47], s25 offen offset:3072 sc1
M v[64:67], v[100:103], a[140:143], v[64:67]
ds_read_b64_tr_b16 v[188:189], v11 offset:24576
ds_read_b64_tr_b16 v[190:191], v11 offset:28672
M v[68:71], v[108:111], a[140:143], v[68:71]
s_sub_u32 s39, s39, 1
s_cmp_eq_u32 s39, 0
s_cselect_b32 s3, s64, s65
M v[68:71], v[104:107], a[136:139], v[68:71]
ds_read_b64_tr_b16 v[192:193], v12 offset:16384
ds_read_b64_tr_b16 v[194:195], v12 offset:20480
M v[72:75], v[112:115], a[136:139], v[72:75]
s_add_u32 s25, s25, s3
s_lshl_b32 s3, s3, 3
s_add_u32 s26, s26, s3
M v[72:75], v[116:119], a[140:143], v[72:75]
ds_read_b64_tr_b16 v[196:197], v12 offset:24576
ds_read_b64_tr_b16 v[198:199], v12 offset:28672
M v[76:79], v[124:127], a[140:143], v[76:79]
M v[76:79], v[120:123], a[136:139], v[76:79]
ds_read_b64_tr_b16 v[200:201], v13 offset:16384
ds_read_b64_tr_b16 v[202:203], v13 offset:20480
M v[80:83], v[128:131], a[136:139], v[80:83]
ds_read_b64_tr_b16 v[204:205], v13 offset:24576
ds_read_b64_tr_b16 v[206:207], v13 offset:28672
M v[80:83], v[132:135], a[140:143], v[80:83]
ds_read_b64_tr_b16 v[208:209], v14 offset:16384
ds_read_b64_tr_b16 v[210:211], v14 offset:20480
M v[84:87], v[140:143], a[140:143], v[84:87]
ds_read_b64_tr_b16 v[212:213], v14 offset:24576
ds_read_b64_tr_b16 v[214:215], v14 offset:28672
M v[84:87], v[136:139], a[136:139], v[84:87]
ds_read_b64_tr_b16 v[216:217], v15 offset:16384
ds_read_b64_tr_b16 v[218:219], v15 offset:20480
M v[88:91], v[144:147], a[136:139], v[88:91]
ds_read_b64_tr_b16 v[220:221], v15 offset:24576
ds_read_b64_tr_b16 v[222:223], v15 offset:28672
M v[88:91], v[148:151], a[140:143], v[88:91]
M v[92:95], v[156:159], a[140:143], v[92:95]
M v[92:95], v[152:155], a[136:139], v[92:95]
s_waitcnt vmcnt(24) lgkmcnt(0)
s_barrier
M v[32:35], v[160:163], a[144:147], v[32:35]
s_add_u32 m0, s41, 98304
s_nop 0
buffer_load_dwordx4 v2, s[48:51], s26 offen offset:0 lds
M v[32:35], v[164:167], a[148:151], v[32:35]
ds_read_b64_tr_b16 v[96:97], v8 offset:32768
ds_read_b64_tr_b16 v[98:99], v8 offset:36864
M v[36:39], v[172:175], a[148:151], v[36:39]
buffer_load_dwordx4 v3, s[48:51], s26 offen offset:1024 lds
M v[36:39], v[168:171], a[144:147], v[36:39]
ds_read_b64_tr_b16 v[100:101], v8 offset:40960
ds_read_b64_tr_b16 v[102:103], v8 offset:45056
M v[40:43], v[176:179], a[144:147], v[40:43]
buffer_load_dwordx4 v4, s[48:51], s26 offen offset:2048 lds
M v[40:43], v[180:183], a[148:151], v[40:43]
ds_read_b64_tr_b16 v[104:105], v9 offset:32768
ds_read_b64_tr_b16 v[106:107], v9 offset:36864
M v[44:47], v[188:191], a[148:151], v[44:47]
buffer_load_dwordx4 v5, s[48:51], s26 offen offset:3072 lds
M v[44:47], v[184:187], a[144:147], v[44:47]
M v[48:51], v[192:195], a[144:147], v[48:51]
ds_read_b64_tr_b16 v[108:109], v9 offset:40960
ds_read_b64_tr_b16 v[110:111], v9 offset:45056
M v[48:51], v[196:199], a[148:151], v[48:51]
buffer_load_dwordx4 a[224:227], v1, s[44:47], s25 offen offset:0 sc1
M v[52:55], v[204:207], a[148:151], v[52:55]
ds_read_b64_tr_b16 v[112:113], v10 offset:32768
ds_read_b64_tr_b16 v[114:115], v10 offset:36864
M v[52:55], v[200:203], a[144:147], v[52:55]
buffer_load_dwordx4 a[228:231], v1, s[44:47], s25 offen offset:1024 sc1
M v[56:59], v[208:211], a[144:147], v[56:59]
ds_read_b64_tr_b16 v[116:117], v10 offset:40960
ds_read_b64_tr_b16 v[118:119], v10 offset:45056
M v[56:59], v[212:215], a[148:151], v[56:59]
buffer_load_dwordx4 a[232:235], v1, s[44:47], s25 offen offset:2048 sc1
M v[60:63], v[220:223], a[148:151], v[60:63]
M v[60:63], v[216:219], a[144:147], v[60:63]
ds_read_b64_tr_b16 v[120:121], v11 offset:32768
ds_read_b64_tr_b16 v[122:123], v11 offset:36864
M v[64:67], v[160:163], a[152:155], v[64:67]
buffer_load_dwordx4 a[236:239], v1, s[44:47], s25 offen offset:3072 sc1
M v[64:67], v[164:167], a[156:159], v[64:67]
ds_read_b64_tr_b16 v[124:125], v11 offset:40960
ds_read_b64_tr_b16 v[126:127], v11 offset:45056
M v[68:71], v[172:175], a[156:159], v[68:71]
s_sub_u32 s39, s39, 1
s_cmp_eq_u32 s39, 0
s_cselect_b32 s3, s64, s65
M v[68:71], v[168:171], a[152:155], v[68:71]
ds_read_b64_tr_b16 v[128:129], v12 offset:32768
ds_read_b64_tr_b16 v[130:131], v12 offset:36864
M v[72:75], v[176:179], a[152:155], v[72:75]
s_add_u32 s25, s25, s3
s_lshl_b32 s3, s3, 3
s_add_u32 s26, s26, s3
M v[72:75], v[180:183], a[156:159], v[72:75]
ds_read_b64_tr_b16 v[132:133], v12 offset:40960
ds_read_b64_tr_b16 v[134:135], v12 offset:45056
M v[76:79], v[188:191], a[156:159], v[76:79]
M v[76:79], v[184:187], a[152:155], v[76:79]
ds_read_b64_tr_b16 v[136:137], v13 offset:32768
ds_read_b64_tr_b16 v[138:139], v13 offset:36864
M v[80:83], v[192:195], a[152:155], v[80:83]
ds_read_b64_tr_b16 v[140:141], v13 offset:40960
ds_read_b64_tr_b16 v[142:143], v13 offset:45056
M v[80:83], v[196:199], a[156:159], v[80:83]
ds_read_b64_tr_b16 v[144:145], v14 offset:32768
ds_read_b64_tr_b16 v[146:147], v14 offset:36864
M v[84:87], v[204:207], a[156:159], v[84:87]
ds_read_b64_tr_b16 v[148:149], v14 offset:40960
ds_read_b64_tr_b16 v[150:151], v14 offset:45056
M v[84:87], v[200:203], a[152:155], v[84:87]
ds_read_b64_tr_b16 v[152:153], v15 offset:32768
ds_read_b64_tr_b16 v[154:155], v15 offset:36864
M v[88:91], v[208:211], a[152:155], v[88:91]
ds_read_b64_tr_b16 v[156:157], v15 offset:40960
ds_read_b64_tr_b16 v[158:159], v15 offset:45056
M v[88:91], v[212:215], a[156:159], v[88:91]
M v[92:95], v[220:223], a[156:159], v[92:95]
M v[92:95], v[216:219], a[152:155], v[92:95]
s_waitcnt vmcnt(24) lgkmcnt(0)
s_barrier
M v[32:35], v[96:99], a[160:163], v[32:35]
s_add_u32 m0, s41, 114688
s_nop 0
buffer_load_dwordx4 v2, s[48:51], s26 offen offset:0 lds
M v[32:35], v[100:103], a[164:167], v[32:35]
ds_read_b64_tr_b16 v[160:161], v8 offset:49152
ds_read_b64_tr_b16 v[162:163], v8 offset:53248
M v[36:39], v[108:111], a[164:167], v[36:39]
buffer_load_dwordx4 v3, s[48:51], s26 offen offset:1024 lds
M v[36:39], v[104:107], a[160:163], v[36:39]
ds_read_b64_tr_b16 v[164:165], v8 offset:57344
ds_read_b64_tr_b16 v[166:167], v8 offset:61440
M v[40:43], v[112:115], a[160:163], v[40:43]
buffer_load_dwordx4 v4, s[48:51], s26 offen offset:2048 lds
M v[40:43], v[116:119], a[164:167], v[40:43]
ds_read_b64_tr_b16 v[168:169], v9 offset:49152
ds_read_b64_tr_b16 v[170:171], v9 offset:53248
M v[44:47], v[124:127], a[164:167], v[44:47]
buffer_load_dwordx4 v5, s[48:51], s26 offen offset:3072 lds
M v[44:47], v[120:123], a[160:163], v[44:47]
M v[48:51], v[128:131], a[160:163], v[48:51]
ds_read_b64_tr_b16 v[172:173], v9 offset:57344
ds_read_b64_tr_b16 v[174:175], v9 offset:61440
M v[48:51], v[132:135], a[164:167], v[48:51]
buffer_load_dwordx4 a[240:243], v1, s[44:47], s25 offen offset:0 sc1
M v[52:55], v[140:143], a[164:167], v[52:55]
ds_read_b64_tr_b16 v[176:177], v10 offset:49152
ds_read_b64_tr_b16 v[178:179], v10 offset:53248
M v[52:55], v[136:139], a[160:163], v[52:55]
buffer_load_dwordx4 a[244:247], v1, s[44:47], s25 offen offset:1024 sc1
M v[56:59], v[144:147], a[160:163], v[56:59]
ds_read_b64_tr_b16 v[180:181], v10 offset:57344
ds_read_b64_tr_b16 v[182:183], v10 offset:61440
M v[56:59], v[148:151], a[164:167], v[56:59]
buffer_load_dwordx4 a[248:251], v1, s[44:47], s25 offen offset:2048 sc1
M v[60:63], v[156:159], a[164:167], v[60:63]
M v[60:63], v[152:155], a[160:163], v[60:63]
ds_read_b64_tr_b16 v[184:185], v11 offset:49152
ds_read_b64_tr_b16 v[186:187], v11 offset:53248
M v[64:67], v[96:99], a[168:171], v[64:67]
buffer_load_dwordx4 a[252:255], v1, s[44:47], s25 offen offset:3072 sc1
M v[64:67], v[100:103], a[172:175], v[64:67]
ds_read_b64_tr_b16 v[188:189], v11 offset:57344
ds_read_b64_tr_b16 v[190:191], v11 offset:61440
M v[68:71], v[108:111], a[172:175], v[68:71]
s_sub_u32 s39, s39, 1
s_cmp_eq_u32 s39, 0
s_cselect_b32 s3, s64, s65
M v[68:71], v[104:107], a[168:171], v[68:71]
ds_read_b64_tr_b16 v[192:193], v12 offset:49152
ds_read_b64_tr_b16 v[194:195], v12 offset:53248
M v[72:75], v[112:115], a[168:171], v[72:75]
s_add_u32 s25, s25, s3
s_lshl_b32 s3, s3, 3
s_add_u32 s26, s26, s3
M v[72:75], v[116:119], a[172:175], v[72:75]
ds_read_b64_tr_b16 v[196:197], v12 offset:57344
ds_read_b64_tr_b16 v[198:199], v12 offset:61440
M v[76:79], v[124:127], a[172:175], v[76:79]
M v[76:79], v[120:123], a[168:171], v[76:79]
ds_read_b64_tr_b16 v[200:201], v13 offset:49152
ds_read_b64_tr_b16 v[202:203], v13 offset:53248
M v[80:83], v[128:131], a[168:171], v[80:83]
ds_read_b64_tr_b16 v[204:205], v13 offset:57344
ds_read_b64_tr_b16 v[206:207], v13 offset:61440
M v[80:83], v[132:135], a[172:175], v[80:83]
ds_read_b64_tr_b16 v[208:209], v14 offset:49152
ds_read_b64_tr_b16 v[210:211], v14 offset:53248
M v[84:87], v[140:143], a[172:175], v[84:87]
ds_read_b64_tr_b16 v[212:213], v14 offset:57344
ds_read_b64_tr_b16 v[214:215], v14 offset:61440
M v[84:87], v[136:139], a[168:171], v[84:87]
ds_read_b64_tr_b16 v[216:217], v15 offset:49152
ds_read_b64_tr_b16 v[218:219], v15 offset:53248
M v[88:91], v[144:147], a[168:171], v[88:91]
ds_read_b64_tr_b16 v[220:221], v15 offset:57344
ds_read_b64_tr_b16 v[222:223], v15 offset:61440
M v[88:91], v[148:151], a[172:175], v[88:91]
M v[92:95], v[156:159], a[172:175], v[92:95]
M v[92:95], v[152:155], a[168:171], v[92:95]
s_waitcnt vmcnt(24) lgkmcnt(0)
s_barrier
M v[32:35], v[160:163], a[176:179], v[32:35]
s_add_u32 m0, s41, 0
s_nop 0
buffer_load_dwordx4 v2, s[48:51], s26 offen offset:0 lds
M v[32:35], v[164:167], a[180:183], v[32:35]
ds_read_b64_tr_b16 v[96:97], v16 offset:0
ds_read_b64_tr_b16 v[98:99], v16 offset:4096
M v[36:39], v[172:175], a[180:183], v[36:39]
buffer_load_dwordx4 v3, s[48:51], s26 offen offset:1024 lds
M v[36:39], v[168:171], a[176:179], v[36:39]
ds_read_b64_tr_b16 v[100:101], v16 offset:8192
ds_read_b64_tr_b16 v[102:103], v16 offset:12288
M v[40:43], v[176:179], a[176:179], v[40:43]
buffer_load_dwordx4 v4, s[48:51], s26 offen offset:2048 lds
M v[40:43], v[180:183], a[180:183], v[40:43]
ds_read_b64_tr_b16 v[104:105], v17 offset:0
ds_read_b64_tr_b16 v[106:107], v17 offset:4096
M v[44:47], v[188:191], a[180:183], v[44:47]
buffer_load_dwordx4 v5, s[48:51], s26 offen offset:3072 lds
M v[44:47], v[184:187], a[176:179], v[44:47]
M v[48:51], v[192:195], a[176:179], v[48:51]
ds_read_b64_tr_b16 v[108:109], v17 offset:8192
ds_read_b64_tr_b16 v[110:111], v17 offset:12288
M v[48:51], v[196:199], a[180:183], v[48:51]
buffer_load_dwordx4 a[128:131], v1, s[44:47], s25 offen offset:0 sc1
M v[52:55], v[204:207], a[180:183], v[52:55]
ds_read_b64_tr_b16 v[112:113], v18 offset:0
ds_read_b64_tr_b16 v[114:115], v18 offset:4096
M v[52:55], v[200:203], a[176:179], v[52:55]
buffer_load_dwordx4 a[132:135], v1, s[44:47], s25 offen offset:1024 sc1
M v[56:59], v[208:211], a[176:179], v[56:59]
ds_read_b64_tr_b16 v[116:117], v18 offset:8192
ds_read_b64_tr_b16 v[118:119], v18 offset:12288
M v[56:59], v[212:215], a[180:183], v[56:59]
buffer_load_dwordx4 a[136:139], v1, s[44:47], s25 offen offset:2048 sc1
M v[60:63], v[220:223], a[180:183], v[60:63]
M v[60:63], v[216:219], a[176:179], v[60:63]
ds_read_b64_tr_b16 v[120:121], v19 offset:0
ds_read_b64_tr_b16 v[122:123], v19 offset:4096
M v[64:67], v[160:163], a[184:187], v[64:67]
buffer_load_dwordx4 a[140:143], v1, s[44:47], s25 offen offset:3072 sc1
M v[64:67], v[164:167], a[188:191], v[64:67]
ds_read_b64_tr_b16 v[124:125], v19 offset:8192
ds_read_b64_tr_b16 v[126:127], v19 offset:12288
M v[68:71], v[172:175], a[188:191], v[68:71]
s_sub_u32 s39, s39, 1
s_cmp_eq_u32 s39, 0
s_cselect_b32 s3, s64, s65
M v[68:71], v[168:171], a[184:187], v[68:71]
ds_read_b64_tr_b16 v[128:129], v20 offset:0
ds_read_b64_tr_b16 v[130:131], v20 offset:4096
M v[72:75], v[176:179], a[184:187], v[72:75]
s_add_u32 s25, s25, s3
s_lshl_b32 s3, s3, 3
s_add_u32 s26, s26, s3
M v[72:75], v[180:183], a[188:191], v[72:75]
ds_read_b64_tr_b16 v[132:133], v20 offset:8192
ds_read_b64_tr_b16 v[134:135], v20 offset:12288
M v[76:79], v[188:191], a[188:191], v[76:79]
M v[76:79], v[184:187], a[184:187], v[76:79]
ds_read_b64_tr_b16 v[136:137], v21 offset:0
ds_read_b64_tr_b16 v[138:139], v21 offset:4096
M v[80:83], v[192:195], a[184:187], v[80:83]
ds_read_b64_tr_b16 v[140:141], v21 offset:8192
ds_read_b64_tr_b16 v[142:143], v21 offset:12288
M v[80:83], v[196:199], a[188:191], v[80:83]
ds_read_b64_tr_b16 v[144:145], v22 offset:0
ds_read_b64_tr_b16 v[146:147], v22 offset:4096
M v[84:87], v[204:207], a[188:191], v[84:87]
ds_read_b64_tr_b16 v[148:149], v22 offset:8192
ds_read_b64_tr_b16 v[150:151], v22 offset:12288
M v[84:87], v[200:203], a[184:187], v[84:87]
ds_read_b64_tr_b16 v[152:153], v23 offset:0
ds_read_b64_tr_b16 v[154:155], v23 offset:4096
M v[88:91], v[208:211], a[184:187], v[88:91]
ds_read_b64_tr_b16 v[156:157], v23 offset:8192
ds_read_b64_tr_b16 v[158:159], v23 offset:12288
M v[88:91], v[212:215], a[188:191], v[88:91]
M v[92:95], v[220:223], a[188:191], v[92:95]
M v[92:95], v[216:219], a[184:187], v[92:95]
s_waitcnt vmcnt(24) lgkmcnt(0)
s_barrier
M v[32:35], v[96:99], a[192:195], v[32:35]
s_add_u32 m0, s41, 16384
s_nop 0
buffer_load_dwordx4 v2, s[48:51], s26 offen offset:0 lds
M v[32:35], v[100:103], a[196:199], v[32:35]
ds_read_b64_tr_b16 v[160:161], v16 offset:16384
ds_read_b64_tr_b16 v[162:163], v16 offset:20480
M v[36:39], v[108:111], a[196:199], v[36:39]
buffer_load_dwordx4 v3, s[48:51], s26 offen offset:1024 lds
M v[36:39], v[104:107], a[192:195], v[36:39]
ds_read_b64_tr_b16 v[164:165], v16 offset:24576
ds_read_b64_tr_b16 v[166:167], v16 offset:28672
M v[40:43], v[112:115], a[192:195], v[40:43]
buffer_load_dwordx4 v4, s[48:51], s26 offen offset:2048 lds
M v[40:43], v[116:119], a[196:199], v[40:43]
ds_read_b64_tr_b16 v[168:169], v17 offset:16384
ds_read_b64_tr_b16 v[170:171], v17 offset:20480
M v[44:47], v[124:127], a[196:199], v[44:47]
buffer_load_dwordx4 v5, s[48:51], s26 offen offset:3072 lds
M v[44:47], v[120:123], a[192:195], v[44:47]
M v[48:51], v[128:131], a[192:195], v[48:51]
ds_read_b64_tr_b16 v[172:173], v17 offset:24576
ds_read_b64_tr_b16 v[174:175], v17 offset:28672
M v[48:51], v[132:135], a[196:199], v[48:51]
buffer_load_dwordx4 a[144:147], v1, s[44:47], s25 offen offset:0 sc1
M v[52:55], v[140:143], a[196:199], v[52:55]
ds_read_b64_tr_b16 v[176:177], v18 offset:16384
ds_read_b64_tr_b16 v[178:179], v18 offset:20480
M v[52:55], v[136:139], a[192:195], v[52:55]
buffer_load_dwordx4 a[148:151], v1, s[44:47], s25 offen offset:1024 sc1
M v[56:59], v[144:147], a[192:195], v[56:59]
ds_read_b64_tr_b16 v[180:181], v18 offset:24576
ds_read_b64_tr_b16 v[182:183], v18 offset:28672
M v[56:59], v[148:151], a[196:199], v[56:59]
buffer_load_dwordx4 a[152:155], v1, s[44:47], s25 offen offset:2048 sc1
M v[60:63], v[156:159], a[196:199], v[60:63]
M v[60:63], v[152:155], a[192:195], v[60:63]
ds_read_b64_tr_b16 v[184:185], v19 offset:16384
ds_read_b64_tr_b16 v[186:187], v19 offset:20480
M v[64:67], v[96:99], a[200:203], v[64:67]
buffer_load_dwordx4 a[156:159], v1, s[44:47], s25 offen offset:3072 sc1
M v[64:67], v[100:103], a[204:207], v[64:67]
ds_read_b64_tr_b16 v[188:189], v19 offset:24576
ds_read_b64_tr_b16 v[190:191], v19 offset:28672
M v[68:71], v[108:111], a[204:207], v[68:71]
s_sub_u32 s39, s39, 1
s_cmp_eq_u32 s39, 0
s_cselect_b32 s3, s64, s65
M v[68:71], v[104:107], a[200:203], v[68:71]
ds_read_b64_tr_b16 v[192:193], v20 offset:16384
ds_read_b64_tr_b16 v[194:195], v20 offset:20480
M v[72:75], v[112:115], a[200:203], v[72:75]
s_add_u32 s25, s25, s3
s_lshl_b32 s3, s3, 3
s_add_u32 s26, s26, s3
M v[72:75], v[116:119], a[204:207], v[72:75]
ds_read_b64_tr_b16 v[196:197], v20 offset:24576
ds_read_b64_tr_b16 v[198:199], v20 offset:28672
M v[76:79], v[124:127], a[204:207], v[76:79]
M v[76:79], v[120:123], a[200:203], v[76:79]
ds_read_b64_tr_b16 v[200:201], v21 offset:16384
ds_read_b64_tr_b16 v[202:203], v21 offset:20480
M v[80:83], v[128:131], a[200:203], v[80:83]
ds_read_b64_tr_b16 v[204:205], v21 offset:24576
ds_read_b64_tr_b16 v[206:207], v21 offset:28672
M v[80:83], v[132:135], a[204:207], v[80:83]
ds_read_b64_tr_b16 v[208:209], v22 offset:16384
ds_read_b64_tr_b16 v[210:211], v22 offset:20480
M v[84:87], v[140:143], a[204:207], v[84:87]
ds_read_b64_tr_b16 v[212:213], v22 offset:24576
ds_read_b64_tr_b16 v[214:215], v22 offset:28672
M v[84:87], v[136:139], a[200:203], v[84:87]
ds_read_b64_tr_b16 v[216:217], v23 offset:16384
ds_read_b64_tr_b16 v[218:219], v23 offset:20480
M v[88:91], v[144:147], a[200:203], v[88:91]
ds_read_b64_tr_b16 v[220:221], v23 offset:24576
ds_read_b64_tr_b16 v[222:223], v23 offset:28672
M v[88:91], v[148:151], a[204:207], v[88:91]
M v[92:95], v[156:159], a[204:207], v[92:95]
M v[92:95], v[152:155], a[200:203], v[92:95]
s_sub_u32 s28, s28, 1
s_cmp_lg_u32 s28, 0
s_cbranch_scc1 Lk3_la
s_waitcnt vmcnt(24) lgkmcnt(0)
s_barrier
M v[32:35], v[160:163], a[208:211], v[32:35]
s_add_u32 m0, s41, 32768
s_nop 0
buffer_load_dwordx4 v2, s[48:51], s26 offen offset:0 lds
M v[32:35], v[164:167], a[212:215], v[32:35]
ds_read_b64_tr_b16 v[96:97], v16 offset:32768
ds_read_b64_tr_b16 v[98:99], v16 offset:36864
M v[36:39], v[172:175], a[212:215], v[36:39]
buffer_load_dwordx4 v3, s[48:51], s26 offen offset:1024 lds
M v[36:39], v[168:171], a[208:211], v[36:39]
ds_read_b64_tr_b16 v[100:101], v16 offset:40960
ds_read_b64_tr_b16 v[102:103], v16 offset:45056
M v[40:43], v[176:179], a[208:211], v[40:43]
buffer_load_dwordx4 v4, s[48:51], s26 offen offset:2048 lds
M v[40:43], v[180:183], a[212:215], v[40:43]
ds_read_b64_tr_b16 v[104:105], v17 offset:32768
ds_read_b64_tr_b16 v[106:107], v17 offset:36864
M v[44:47], v[188:191], a[212:215], v[44:47]
buffer_load_dwordx4 v5, s[48:51], s26 offen offset:3072 lds
M v[44:47], v[184:187], a[208:211], v[44:47]
M v[48:51], v[192:195], a[208:211], v[48:51]
ds_read_b64_tr_b16 v[108:109], v17 offset:40960
ds_read_b64_tr_b16 v[110:111], v17 offset:45056
M v[48:51], v[196:199], a[212:215], v[48:51]
buffer_load_dwordx4 a[160:163], v1, s[44:47], s25 offen offset:0 sc1
M v[52:55], v[204:207], a[212:215], v[52:55]
ds_read_b64_tr_b16 v[112:113], v18 offset:32768
ds_read_b64_tr_b16 v[114:115], v18 offset:36864
M v[52:55], v[200:203], a[208:211], v[52:55]
buffer_load_dwordx4 a[164:167], v1, s[44:47], s25 offen offset:1024 sc1
M v[56:59], v[208:211], a[208:211], v[56:59]
ds_read_b64_tr_b16 v[116:117], v18 offset:40960
ds_read_b64_tr_b16 v[118:119], v18 offset:45056
M v[56:59], v[212:215], a[212:215], v[56:59]
buffer_load_dwordx4 a[168:171], v1, s[44:47], s25 offen offset:2048 sc1
M v[60:63], v[220:223], a[212:215], v[60:63]
M v[60:63], v[216:219], a[208:211], v[60:63]
ds_read_b64_tr_b16 v[120:121], v19 offset:32768
ds_read_b64_tr_b16 v[122:123], v19 offset:36864
M v[64:67], v[160:163], a[216:219], v[64:67]
buffer_load_dwordx4 a[172:175], v1, s[44:47], s25 offen offset:3072 sc1
M v[64:67], v[164:167], a[220:223], v[64:67]
ds_read_b64_tr_b16 v[124:125], v19 offset:40960
ds_read_b64_tr_b16 v[126:127], v19 offset:45056
M v[68:71], v[172:175], a[220:223], v[68:71]
s_sub_u32 s39, s39, 1
s_cmp_eq_u32 s39, 0
s_cselect_b32 s3, s64, s65
M v[68:71], v[168:171], a[216:219], v[68:71]
ds_read_b64_tr_b16 v[128:129], v20 offset:32768
ds_read_b64_tr_b16 v[130:131], v20 offset:36864
M v[72:75], v[176:179], a[216:219], v[72:75]
s_add_u32 s25, s25, s3
s_lshl_b32 s3, s3, 3
s_add_u32 s26, s26, s3
M v[72:75], v[180:183], a[220:223], v[72:75]
ds_read_b64_tr_b16 v[132:133], v20 offset:40960
ds_read_b64_tr_b16 v[134:135], v20 offset:45056
M v[76:79], v[188:191], a[220:223], v[76:79]
M v[76:79], v[184:187], a[216:219], v[76:79]
ds_read_b64_tr_b16 v[136:137], v21 offset:32768
ds_read_b64_tr_b16 v[138:139], v21 offset:36864
M v[80:83], v[192:195], a[216:219], v[80:83]
ds_read_b64_tr_b16 v[140:141], v21 offset:40960
ds_read_b64_tr_b16 v[142:143], v21 offset:45056
M v[80:83], v[196:199], a[220:223], v[80:83]
ds_read_b64_tr_b16 v[144:145], v22 offset:32768
ds_read_b64_tr_b16 v[146:147], v22 offset:36864
M v[84:87], v[204:207], a[220:223], v[84:87]
ds_read_b64_tr_b16 v[148:149], v22 offset:40960
ds_read_b64_tr_b16 v[150:151], v22 offset:45056
M v[84:87], v[200:203], a[216:219], v[84:87]
ds_read_b64_tr_b16 v[152:153], v23 offset:32768
ds_read_b64_tr_b16 v[154:155], v23 offset:36864
M v[88:91], v[208:211], a[216:219], v[88:91]
ds_read_b64_tr_b16 v[156:157], v23 offset:40960
ds_read_b64_tr_b16 v[158:159], v23 offset:45056
M v[88:91], v[212:215], a[220:223], v[88:91]
M v[92:95], v[220:223], a[220:223], v[92:95]
M v[92:95], v[216:219], a[216:219], v[92:95]
s_waitcnt vmcnt(24) lgkmcnt(0)
s_barrier
M v[32:35], v[96:99], a[224:227], v[32:35]
s_add_u32 m0, s41, 49152
s_nop 0
buffer_load_dwordx4 v2, s[48:51], s26 offen offset:0 lds
M v[32:35], v[100:103], a[228:231], v[32:35]
ds_read_b64_tr_b16 v[160:161], v16 offset:49152
ds_read_b64_tr_b16 v[162:163], v16 offset:53248
M v[36:39], v[108:111], a[228:231], v[36:39]
buffer_load_dwordx4 v3, s[48:51], s26 offen offset:1024 lds
M v[36:39], v[104:107], a[224:227], v[36:39]
ds_read_b64_tr_b16 v[164:165], v16 offset:57344
ds_read_b64_tr_b16 v[166:167], v16 offset:61440
M v[40:43], v[112:115], a[224:227], v[40:43]
buffer_load_dwordx4 v4, s[48:51], s26 offen offset:2048 lds
M v[40:43], v[116:119], a[228:231], v[40:43]
ds_read_b64_tr_b16 v[168:169], v17 offset:49152
ds_read_b64_tr_b16 v[170:171], v17 offset:53248
M v[44:47], v[124:127], a[228:231], v[44:47]
buffer_load_dwordx4 v5, s[48:51], s26 offen offset:3072 lds
M v[44:47], v[120:123], a[224:227], v[44:47]
M v[48:51], v[128:131], a[224:227], v[48:51]
ds_read_b64_tr_b16 v[172:173], v17 offset:57344
ds_read_b64_tr_b16 v[174:175], v17 offset:61440
M v[48:51], v[132:135], a[228:231], v[48:51]
buffer_load_dwordx4 a[176:179], v1, s[44:47], s25 offen offset:0 sc1
M v[52:55], v[140:143], a[228:231], v[52:55]
ds_read_b64_tr_b16 v[176:177], v18 offset:49152
ds_read_b64_tr_b16 v[178:179], v18 offset:53248
M v[52:55], v[136:139], a[224:227], v[52:55]
buffer_load_dwordx4 a[180:183], v1, s[44:47], s25 offen offset:1024 sc1
M v[56:59], v[144:147], a[224:227], v[56:59]
ds_read_b64_tr_b16 v[180:181], v18 offset:57344
ds_read_b64_tr_b16 v[182:183], v18 offset:61440
M v[56:59], v[148:151], a[228:231], v[56:59]
buffer_load_dwordx4 a[184:187], v1, s[44:47], s25 offen offset:2048 sc1
M v[60:63], v[156:159], a[228:231], v[60:63]
M v[60:63], v[152:155], a[224:227], v[60:63]
ds_read_b64_tr_b16 v[184:185], v19 offset:49152
ds_read_b64_tr_b16 v[186:187], v19 offset:53248
M v[64:67], v[96:99], a[232:235], v[64:67]
buffer_load_dwordx4 a[188:191], v1, s[44:47], s25 offen offset:3072 sc1
M v[64:67], v[100:103], a[236:239], v[64:67]
ds_read_b64_tr_b16 v[188:189], v19 offset:57344
ds_read_b64_tr_b16 v[190:191], v19 offset:61440
M v[68:71], v[108:111], a[236:239], v[68:71]
s_sub_u32 s39, s39, 1
s_cmp_eq_u32 s39, 0
s_cselect_b32 s3, s64, s65
M v[68:71], v[104:107], a[232:235], v[68:71]
ds_read_b64_tr_b16 v[192:193], v20 offset:49152
ds_read_b64_tr_b16 v[194:195], v20 offset:53248
M v[72:75], v[112:115], a[232:235], v[72:75]
s_add_u32 s25, s25, s3
s_lshl_b32 s3, s3, 3
s_add_u32 s26, s26, s3
M v[72:75], v[116:119], a[236:239], v[72:75]
ds_read_b64_tr_b16 v[196:197], v20 offset:57344
ds_read_b64_tr_b16 v[198:199], v20 offset:61440
M v[76:79], v[124:127], a[236:239], v[76:79]
M v[76:79], v[120:123], a[232:235], v[76:79]
ds_read_b64_tr_b16 v[200:201], v21 offset:49152
ds_read_b64_tr_b16 v[202:203], v21 offset:53248
M v[80:83], v[128:131], a[232:235], v[80:83]
ds_read_b64_tr_b16 v[204:205], v21 offset:57344
ds_read_b64_tr_b16 v[206:207], v21 offset:61440
M v[80:83], v[132:135], a[236:239], v[80:83]
ds_read_b64_tr_b16 v[208:209], v22 offset:49152
ds_read_b64_tr_b16 v[210:211], v22 offset:53248
M v[84:87], v[140:143], a[236:239], v[84:87]
ds_read_b64_tr_b16 v[212:213], v22 offset:57344
ds_read_b64_tr_b16 v[214:215], v22 offset:61440
M v[84:87], v[136:139], a[232:235], v[84:87]
ds_read_b64_tr_b16 v[216:217], v23 offset:49152
ds_read_b64_tr_b16 v[218:219], v23 offset:53248
M v[88:91], v[144:147], a[232:235], v[88:91]
ds_read_b64_tr_b16 v[220:221], v23 offset:57344
ds_read_b64_tr_b16 v[222:223], v23 offset:61440
M v[88:91], v[148:151], a[236:239], v[88:91]
M v[92:95], v[156:159], a[236:239], v[92:95]
M v[92:95], v[152:155], a[232:235], v[92:95]
s_waitcnt vmcnt(24) lgkmcnt(0)
s_barrier
M v[32:35], v[160:163], a[240:243], v[32:35]
s_mov_b64 s[44:45], s[34:35]
s_mov_b32 s46, 4194304
s_mov_b64 s[48:49], s[36:37]
s_mov_b32 s50, 2097152
s_mov_b32 s25, s32
s_mov_b32 s26, s33
s_add_u32 m0, s42, 65536
s_nop 0
buffer_load_dwordx4 v6, s[48:51], s26 offen offset:0 lds
M v[32:35], v[164:167], a[244:247], v[32:35]
ds_read_b64_tr_b16 v[96:97], v8 offset:0
ds_read_b64_tr_b16 v[98:99], v8 offset:4096
M v[36:39], v[172:175], a[244:247], v[36:39]
buffer_load_dwordx4 v7, s[48:51], s26 offen offset:1024 lds
M v[36:39], v[168:171], a[240:243], v[36:39]
ds_read_b64_tr_b16 v[100:101], v8 offset:8192
ds_read_b64_tr_b16 v[102:103], v8 offset:12288
M v[40:43], v[176:179], a[240:243], v[40:43]
M v[40:43], v[180:183], a[244:247], v[40:43]
buffer_load_dwordx4 a[192:195], v1, s[44:47], s25 offen offset:0 sc1
M v[44:47], v[188:191], a[244:247], v[44:47]
ds_read_b64_tr_b16 v[104:105], v9 offset:0
ds_read_b64_tr_b16 v[106:107], v9 offset:4096
M v[44:47], v[184:187], a[240:243], v[44:47]
buffer_load_dwordx4 a[196:199], v1, s[44:47], s25 offen offset:1024 sc1
M v[48:51], v[192:195], a[240:243], v[48:51]
M v[48:51], v[196:199], a[244:247], v[48:51]
ds_read_b64_tr_b16 v[108:109], v9 offset:8192
ds_read_b64_tr_b16 v[110:111], v9 offset:12288
M v[52:55], v[204:207], a[244:247], v[52:55]
buffer_load_dwordx4 a[200:203], v1, s[44:47], s25 offen offset:2048 sc1
M v[52:55], v[200:203], a[240:243], v[52:55]
ds_read_b64_tr_b16 v[112:113], v10 offset:0
ds_read_b64_tr_b16 v[114:115], v10 offset:4096
M v[56:59], v[208:211], a[240:243], v[56:59]
M v[56:59], v[212:215], a[244:247], v[56:59]
buffer_load_dwordx4 a[204:207], v1, s[44:47], s25 offen offset:3072 sc1
M v[60:63], v[220:223], a[244:247], v[60:63]
ds_read_b64_tr_b16 v[116:117], v10 offset:8192
ds_read_b64_tr_b16 v[118:119], v10 offset:12288
M v[60:63], v[216:219], a[240:243], v[60:63]
s_add_u32 s25, s25, 16384
s_add_u32 s26, s26, 131072
M v[64:67], v[160:163], a[248:251], v[64:67]
ds_read_b64_tr_b16 v[120:121], v11 offset:0
ds_read_b64_tr_b16 v[122:123], v11 offset:4096
M v[64:67], v[164:167], a[252:255], v[64:67]
M v[68:71], v[172:175], a[252:255], v[68:71]
ds_read_b64_tr_b16 v[124:125], v11 offset:8192
ds_read_b64_tr_b16 v[126:127], v11 offset:12288
M v[68:71], v[168:171], a[248:251], v[68:71]
ds_read_b64_tr_b16 v[128:129], v12 offset:0
ds_read_b64_tr_b16 v[130:131], v12 offset:4096
M v[72:75], v[176:179], a[248:251], v[72:75]
ds_read_b64_tr_b16 v[132:133], v12 offset:8192
ds_read_b64_tr_b16 v[134:135], v12 offset:12288
M v[72:75], v[180:183], a[252:255], v[72:75]
M v[76:79], v[188:191], a[252:255], v[76:79]
ds_read_b64_tr_b16 v[136:137], v13 offset:0
ds_read_b64_tr_b16 v[138:139], v13 offset:4096
M v[76:79], v[184:187], a[248:251], v[76:79]
ds_read_b64_tr_b16 v[140:141], v13 offset:8192
ds_read_b64_tr_b16 v[142:143], v13 offset:12288
M v[80:83], v[192:195], a[248:251], v[80:83]
ds_read_b64_tr_b16 v[144:145], v14 offset:0
ds_read_b64_tr_b16 v[146:147], v14 offset:4096
M v[80:83], v[196:199], a[252:255], v[80:83]
M v[84:87], v[204:207], a[252:255], v[84:87]
ds_read_b64_tr_b16 v[148:149], v14 offset:8192
ds_read_b64_tr_b16 v[150:151], v14 offset:12288
M v[84:87], v[200:203], a[248:251], v[84:87]
ds_read_b64_tr_b16 v[152:153], v15 offset:0
ds_read_b64_tr_b16 v[154:155], v15 offset:4096
M v[88:91], v[208:211], a[248:251], v[88:91]
ds_read_b64_tr_b16 v[156:157], v15 offset:8192
ds_read_b64_tr_b16 v[158:159], v15 offset:12288
M v[88:91], v[212:215], a[252:255], v[88:91]
M v[92:95], v[220:223], a[252:255], v[92:95]
M v[92:95], v[216:219], a[248:251], v[92:95]
s_waitcnt vmcnt(22) lgkmcnt(0)
s_barrier
M v[32:35], v[96:99], a[128:131], v[32:35]
s_add_u32 m0, s42, 81920
s_nop 0
buffer_load_dwordx4 v6, s[48:51], s26 offen offset:0 lds
M v[32:35], v[100:103], a[132:135], v[32:35]
ds_read_b64_tr_b16 v[160:161], v8 offset:16384
ds_read_b64_tr_b16 v[162:163], v8 offset:20480
M v[36:39], v[108:111], a[132:135], v[36:39]
buffer_load_dwordx4 v7, s[48:51], s26 offen offset:1024 lds
M v[36:39], v[104:107], a[128:131], v[36:39]
ds_read_b64_tr_b16 v[164:165], v8 offset:24576
ds_read_b64_tr_b16 v[166:167], v8 offset:28672
M v[40:43], v[112:115], a[128:131], v[40:43]
M v[40:43], v[116:119], a[132:135], v[40:43]
buffer_load_dwordx4 a[208:211], v1, s[44:47], s25 offen offset:0 sc1
M v[44:47], v[124:127], a[132:135], v[44:47]
ds_read_b64_tr_b16 v[168:169], v9 offset:16384
ds_read_b64_tr_b16 v[170:171], v9 offset:20480
M v[44:47], v[120:123], a[128:131], v[44:47]
buffer_load_dwordx4 a[212:215], v1, s[44:47], s25 offen offset:1024 sc1
M v[48:51], v[128:131], a[128:131], v[48:51]
M v[48:51], v[132:135], a[132:135], v[48:51]
ds_read_b64_tr_b16 v[172:173], v9 offset:24576
ds_read_b64_tr_b16 v[174:175], v9 offset:28672
M v[52:55], v[140:143], a[132:135], v[52:55]
buffer_load_dwordx4 a[216:219], v1, s[44:47], s25 offen offset:2048 sc1
M v[52:55], v[136:139], a[128:131], v[52:55]
ds_read_b64_tr_b16 v[176:177], v10 offset:16384
ds_read_b64_tr_b16 v[178:179], v10 offset:20480
M v[56:59], v[144:147], a[128:131], v[56:59]
M v[56:59], v[148:151], a[132:135], v[56:59]
buffer_load_dwordx4 a[220:223], v1, s[44:47], s25 offen offset:3072 sc1
M v[60:63], v[156:159], a[132:135], v[60:63]
ds_read_b64_tr_b16 v[180:181], v10 offset:24576
ds_read_b64_tr_b16 v[182:183], v10 offset:28672
M v[60:63], v[152:155], a[128:131], v[60:63]
s_add_u32 s25, s25, 16384
s_add_u32 s26, s26, 131072
M v[64:67], v[96:99], a[136:139], v[64:67]
ds_read_b64_tr_b16 v[184:185], v11 offset:16384
ds_read_b64_tr_b16 v[186:187], v11 offset:20480
M v[64:67], v[100:103], a[140:143], v[64:67]
M v[68:71], v[108:111], a[140:143], v[68:71]
ds_read_b64_tr_b16 v[188:189], v11 offset:24576
ds_read_b64_tr_b16 v[190:191], v11 offset:28672
M v[68:71], v[104:107], a[136:139], v[68:71]
ds_read_b64_tr_b16 v[192:193], v12 offset:16384
ds_read_b64_tr_b16 v[194:195], v12 offset:20480
M v[72:75], v[112:115], a[136:139], v[72:75]
ds_read_b64_tr_b16 v[196:197], v12 offset:24576
ds_read_b64_tr_b16 v[198:199], v12 offset:28672
M v[72:75], v[116:119], a[140:143], v[72:75]
M v[76:79], v[124:127], a[140:143], v[76:79]
ds_read_b64_tr_b16 v[200:201], v13 offset:16384
ds_read_b64_tr_b16 v[202:203], v13 offset:20480
M v[76:79], v[120:123], a[136:139], v[76:79]
ds_read_b64_tr_b16 v[204:205], v13 offset:24576
ds_read_b64_tr_b16 v[206:207], v13 offset:28672
M v[80:83], v[128:131], a[136:139], v[80:83]
ds_read_b64_tr_b16 v[208:209], v14 offset:16384
ds_read_b64_tr_b16 v[210:211], v14 offset:20480
M v[80:83], v[132:135], a[140:143], v[80:83]
M v[84:87], v[140:143], a[140:143], v[84:87]
ds_read_b64_tr_b16 v[212:213], v14 offset:24576
ds_read_b64_tr_b16 v[214:215], v14 offset:28672
M v[84:87], v[136:139], a[136:139], v[84:87]
ds_read_b64_tr_b16 v[216:217], v15 offset:16384
ds_read_b64_tr_b16 v[218:219], v15 offset:20480
M v[88:91], v[144:147], a[136:139], v[88:91]
ds_read_b64_tr_b16 v[220:221], v15 offset:24576
ds_read_b64_tr_b16 v[222:223], v15 offset:28672
M v[88:91], v[148:151], a[140:143], v[88:91]
M v[92:95], v[156:159], a[140:143], v[92:95]
M v[92:95], v[152:155], a[136:139], v[92:95]
s_waitcnt vmcnt(20) lgkmcnt(0)
s_barrier
M v[32:35], v[160:163], a[144:147], v[32:35]
s_add_u32 m0, s42, 98304
s_nop 0
buffer_load_dwordx4 v6, s[48:51], s26 offen offset:0 lds
M v[32:35], v[164:167], a[148:151], v[32:35]
ds_read_b64_tr_b16 v[96:97], v8 offset:32768
ds_read_b64_tr_b16 v[98:99], v8 offset:36864
M v[36:39], v[172:175], a[148:151], v[36:39]
buffer_load_dwordx4 v7, s[48:51], s26 offen offset:1024 lds
M v[36:39], v[168:171], a[144:147], v[36:39]
ds_read_b64_tr_b16 v[100:101], v8 offset:40960
ds_read_b64_tr_b16 v[102:103], v8 offset:45056
M v[40:43], v[176:179], a[144:147], v[40:43]
M v[40:43], v[180:183], a[148:151], v[40:43]
buffer_load_dwordx4 a[224:227], v1, s[44:47], s25 offen offset:0 sc1
M v[44:47], v[188:191], a[148:151], v[44:47]
ds_read_b64_tr_b16 v[104:105], v9 offset:32768
ds_read_b64_tr_b16 v[106:107], v9 offset:36864
M v[44:47], v[184:187], a[144:147], v[44:47]
buffer_load_dwordx4 a[228:231], v1, s[44:47], s25 offen offset:1024 sc1
M v[48:51], v[192:195], a[144:147], v[48:51]
M v[48:51], v[196:199], a[148:151], v[48:51]
ds_read_b64_tr_b16 v[108:109], v9 offset:40960
ds_read_b64_tr_b16 v[110:111], v9 offset:45056
M v[52:55], v[204:207], a[148:151], v[52:55]
buffer_load_dwordx4 a[232:235], v1, s[44:47], s25 offen offset:2048 sc1
M v[52:55], v[200:203], a[144:147], v[52:55]
ds_read_b64_tr_b16 v[112:113], v10 offset:32768
ds_read_b64_tr_b16 v[114:115], v10 offset:36864
M v[56:59], v[208:211], a[144:147], v[56:59]
M v[56:59], v[212:215], a[148:151], v[56:59]
buffer_load_dwordx4 a[236:239], v1, s[44:47], s25 offen offset:3072 sc1
M v[60:63], v[220:223], a[148:151], v[60:63]
ds_read_b64_tr_b16 v[116:117], v10 offset:40960
ds_read_b64_tr_b16 v[118:119], v10 offset:45056
M v[60:63], v[216:219], a[144:147], v[60:63]
s_add_u32 s25, s25, 16384
s_add_u32 s26, s26, 131072
M v[64:67], v[160:163], a[152:155], v[64:67]
ds_read_b64_tr_b16 v[120:121], v11 offset:32768
ds_read_b64_tr_b16 v[122:123], v11 offset:36864
M v[64:67], v[164:167], a[156:159], v[64:67]
M v[68:71], v[172:175], a[156:159], v[68:71]
ds_read_b64_tr_b16 v[124:125], v11 offset:40960
ds_read_b64_tr_b16 v[126:127], v11 offset:45056
M v[68:71], v[168:171], a[152:155], v[68:71]
ds_read_b64_tr_b16 v[128:129], v12 offset:32768
ds_read_b64_tr_b16 v[130:131], v12 offset:36864
M v[72:75], v[176:179], a[152:155], v[72:75]
ds_read_b64_tr_b16 v[132:133], v12 offset:40960
ds_read_b64_tr_b16 v[134:135], v12 offset:45056
M v[72:75], v[180:183], a[156:159], v[72:75]
M v[76:79], v[188:191], a[156:159], v[76:79]
ds_read_b64_tr_b16 v[136:137], v13 offset:32768
ds_read_b64_tr_b16 v[138:139], v13 offset:36864
M v[76:79], v[184:187], a[152:155], v[76:79]
ds_read_b64_tr_b16 v[140:141], v13 offset:40960
ds_read_b64_tr_b16 v[142:143], v13 offset:45056
M v[80:83], v[192:195], a[152:155], v[80:83]
ds_read_b64_tr_b16 v[144:145], v14 offset:32768
ds_read_b64_tr_b16 v[146:147], v14 offset:36864
M v[80:83], v[196:199], a[156:159], v[80:83]
M v[84:87], v[204:207], a[156:159], v[84:87]
ds_read_b64_tr_b16 v[148:149], v14 offset:40960
ds_read_b64_tr_b16 v[150:151], v14 offset:45056
M v[84:87], v[200:203], a[152:155], v[84:87]
ds_read_b64_tr_b16 v[152:153], v15 offset:32768
ds_read_b64_tr_b16 v[154:155], v15 offset:36864
M v[88:91], v[208:211], a[152:155], v[88:91]
ds_read_b64_tr_b16 v[156:157], v15 offset:40960
ds_read_b64_tr_b16 v[158:159], v15 offset:45056
M v[88:91], v[212:215], a[156:159], v[88:91]
M v[92:95], v[220:223], a[156:159], v[92:95]
M v[92:95], v[216:219], a[152:155], v[92:95]
s_waitcnt vmcnt(18) lgkmcnt(0)
s_barrier
M v[32:35], v[96:99], a[160:163], v[32:35]
s_add_u32 m0, s42, 114688
s_nop 0
buffer_load_dwordx4 v6, s[48:51], s26 offen offset:0 lds
M v[32:35], v[100:103], a[164:167], v[32:35]
ds_read_b64_tr_b16 v[160:161], v8 offset:49152
ds_read_b64_tr_b16 v[162:163], v8 offset:53248
M v[36:39], v[108:111], a[164:167], v[36:39]
buffer_load_dwordx4 v7, s[48:51], s26 offen offset:1024 lds
M v[36:39], v[104:107], a[160:163], v[36:39]
ds_read_b64_tr_b16 v[164:165], v8 offset:57344
ds_read_b64_tr_b16 v[166:167], v8 offset:61440
M v[40:43], v[112:115], a[160:163], v[40:43]
M v[40:43], v[116:119], a[164:167], v[40:43]
buffer_load_dwordx4 a[240:243], v1, s[44:47], s25 offen offset:0 sc1
M v[44:47], v[124:127], a[164:167], v[44:47]
ds_read_b64_tr_b16 v[168:169], v9 offset:49152
ds_read_b64_tr_b16 v[170:171], v9 offset:53248
M v[44:47], v[120:123], a[160:163], v[44:47]
buffer_load_dwordx4 a[244:247], v1, s[44:47], s25 offen offset:1024 sc1
M v[48:51], v[128:131], a[160:163], v[48:51]
M v[48:51], v[132:135], a[164:167], v[48:51]
ds_read_b64_tr_b16 v[172:173], v9 offset:57344
ds_read_b64_tr_b16 v[174:175], v9 offset:61440
M v[52:55], v[140:143], a[164:167], v[52:55]
buffer_load_dwordx4 a[248:251], v1, s[44:47], s25 offen offset:2048 sc1
M v[52:55], v[136:139], a[160:163], v[52:55]
ds_read_b64_tr_b16 v[176:177], v10 offset:49152
ds_read_b64_tr_b16 v[178:179], v10 offset:53248
M v[56:59], v[144:147], a[160:163], v[56:59]
M v[56:59], v[148:151], a[164:167], v[56:59]
buffer_load_dwordx4 a[252:255], v1, s[44:47], s25 offen offset:3072 sc1
M v[60:63], v[156:159], a[164:167], v[60:63]
ds_read_b64_tr_b16 v[180:181], v10 offset:57344
ds_read_b64_tr_b16 v[182:183], v10 offset:61440
M v[60:63], v[152:155], a[160:163], v[60:63]
s_add_u32 s25, s25, 16384
s_add_u32 s26, s26, 131072
M v[64:67], v[96:99], a[168:171], v[64:67]
ds_read_b64_tr_b16 v[184:185], v11 offset:49152
ds_read_b64_tr_b16 v[186:187], v11 offset:53248
M v[64:67], v[100:103], a[172:175], v[64:67]
M v[68:71], v[108:111], a[172:175], v[68:71]
ds_read_b64_tr_b16 v[188:189], v11 offset:57344
ds_read_b64_tr_b16 v[190:191], v11 offset:61440
M v[68:71], v[104:107], a[168:171], v[68:71]
ds_read_b64_tr_b16 v[192:193], v12 offset:49152
ds_read_b64_tr_b16 v[194:195], v12 offset:53248
M v[72:75], v[112:115], a[168:171], v[72:75]
ds_read_b64_tr_b16 v[196:197], v12 offset:57344
ds_read_b64_tr_b16 v[198:199], v12 offset:61440
M v[72:75], v[116:119], a[172:175], v[72:75]
M v[76:79], v[124:127], a[172:175], v[76:79]
ds_read_b64_tr_b16 v[200:201], v13 offset:49152
ds_read_b64_tr_b16 v[202:203], v13 offset:53248
M v[76:79], v[120:123], a[168:171], v[76:79]
ds_read_b64_tr_b16 v[204:205], v13 offset:57344
ds_read_b64_tr_b16 v[206:207], v13 offset:61440
M v[80:83], v[128:131], a[168:171], v[80:83]
ds_read_b64_tr_b16 v[208:209], v14 offset:49152
ds_read_b64_tr_b16 v[210:211], v14 offset:53248
M v[80:83], v[132:135], a[172:175], v[80:83]
M v[84:87], v[140:143], a[172:175], v[84:87]
ds_read_b64_tr_b16 v[212:213], v14 offset:57344
ds_read_b64_tr_b16 v[214:215], v14 offset:61440
M v[84:87], v[136:139], a[168:171], v[84:87]
ds_read_b64_tr_b16 v[216:217], v15 offset:49152
ds_read_b64_tr_b16 v[218:219], v15 offset:53248
M v[88:91], v[144:147], a[168:171], v[88:91]
ds_read_b64_tr_b16 v[220:221], v15 offset:57344
ds_read_b64_tr_b16 v[222:223], v15 offset:61440
M v[88:91], v[148:151], a[172:175], v[88:91]
M v[92:95], v[156:159], a[172:175], v[92:95]
M v[92:95], v[152:155], a[168:171], v[92:95]
s_waitcnt vmcnt(18) lgkmcnt(0)
s_barrier
M v[32:35], v[160:163], a[176:179], v[32:35]
s_add_u32 m0, s42, 0
s_nop 0
buffer_load_dwordx4 v6, s[48:51], s26 offen offset:0 lds
M v[32:35], v[164:167], a[180:183], v[32:35]
M v[36:39], v[172:175], a[180:183], v[36:39]
ds_read_b64_tr_b16 v[96:97], v28 offset:0
ds_read_b64_tr_b16 v[98:99], v28 offset:2048
M v[36:39], v[168:171], a[176:179], v[36:39]
M v[40:43], v[176:179], a[176:179], v[40:43]
buffer_load_dwordx4 v7, s[48:51], s26 offen offset:1024 lds
M v[40:43], v[180:183], a[180:183], v[40:43]
M v[44:47], v[188:191], a[180:183], v[44:47]
ds_read_b64_tr_b16 v[100:101], v28 offset:4096
ds_read_b64_tr_b16 v[102:103], v28 offset:6144
M v[44:47], v[184:187], a[176:179], v[44:47]
M v[48:51], v[192:195], a[176:179], v[48:51]
buffer_load_dwordx4 a[128:131], v1, s[44:47], s25 offen offset:0 sc1
M v[48:51], v[196:199], a[180:183], v[48:51]
M v[52:55], v[204:207], a[180:183], v[52:55]
ds_read_b64_tr_b16 v[104:105], v29 offset:0
ds_read_b64_tr_b16 v[106:107], v29 offset:2048
M v[52:55], v[200:203], a[176:179], v[52:55]
M v[56:59], v[208:211], a[176:179], v[56:59]
buffer_load_dwordx4 a[132:135], v1, s[44:47], s25 offen offset:1024 sc1
M v[56:59], v[212:215], a[180:183], v[56:59]
M v[60:63], v[220:223], a[180:183], v[60:63]
ds_read_b64_tr_b16 v[108:109], v29 offset:4096
ds_read_b64_tr_b16 v[110:111], v29 offset:6144
M v[60:63], v[216:219], a[176:179], v[60:63]
M v[64:67], v[160:163], a[184:187], v[64:67]
buffer_load_dwordx4 a[136:139], v1, s[44:47], s25 offen offset:2048 sc1
M v[64:67], v[164:167], a[188:191], v[64:67]
M v[68:71], v[172:175], a[188:191], v[68:71]
ds_read_b64_tr_b16 v[112:113], v30 offset:0
ds_read_b64_tr_b16 v[114:115], v30 offset:2048
M v[68:71], v[168:171], a[184:187], v[68:71]
M v[72:75], v[176:179], a[184:187], v[72:75]
buffer_load_dwordx4 a[140:143], v1, s[44:47], s25 offen offset:3072 sc1
M v[72:75], v[180:183], a[188:191], v[72:75]
M v[76:79], v[188:191], a[188:191], v[76:79]
ds_read_b64_tr_b16 v[116:117], v30 offset:4096
ds_read_b64_tr_b16 v[118:119], v30 offset:6144
M v[76:79], v[184:187], a[184:187], v[76:79]
M v[80:83], v[192:195], a[184:187], v[80:83]
s_add_u32 s25, s25, 16384
s_add_u32 s26, s26, 131072
M v[80:83], v[196:199], a[188:191], v[80:83]
M v[84:87], v[204:207], a[188:191], v[84:87]
ds_read_b64_tr_b16 v[120:121], v31 offset:0
ds_read_b64_tr_b16 v[122:123], v31 offset:2048
M v[84:87], v[200:203], a[184:187], v[84:87]
M v[88:91], v[208:211], a[184:187], v[88:91]
ds_read_b64_tr_b16 v[124:125], v31 offset:4096
ds_read_b64_tr_b16 v[126:127], v31 offset:6144
M v[88:91], v[212:215], a[188:191], v[88:91]
M v[92:95], v[220:223], a[188:191], v[92:95]
M v[92:95], v[216:219], a[184:187], v[92:95]
s_waitcnt vmcnt(18) lgkmcnt(0)
s_barrier
M a[0:3], v[96:99], a[192:195], a[0:3]
s_add_u32 m0, s42, 16384
s_nop 0
buffer_load_dwordx4 v6, s[48:51], s26 offen offset:0 lds
ds_read_b64_tr_b16 v[160:161], v28 offset:16384
ds_read_b64_tr_b16 v[162:163], v28 offset:18432
M a[0:3], v[100:103], a[196:199], a[0:3]
buffer_load_dwordx4 v7, s[48:51], s26 offen offset:1024 lds
ds_read_b64_tr_b16 v[164:165], v28 offset:20480
ds_read_b64_tr_b16 v[166:167], v28 offset:22528
M a[4:7], v[108:111], a[196:199], a[4:7]
buffer_load_dwordx4 a[144:147], v1, s[44:47], s25 offen offset:0 sc1
ds_read_b64_tr_b16 v[168:169], v29 offset:16384
ds_read_b64_tr_b16 v[170:171], v29 offset:18432
M a[4:7], v[104:107], a[192:195], a[4:7]
buffer_load_dwordx4 a[148:151], v1, s[44:47], s25 offen offset:1024 sc1
M a[8:11], v[112:115], a[192:195], a[8:11]
ds_read_b64_tr_b16 v[172:173], v29 offset:20480
ds_read_b64_tr_b16 v[174:175], v29 offset:22528
buffer_load_dwordx4 a[152:155], v1, s[44:47], s25 offen offset:2048 sc1
M a[8:11], v[116:119], a[196:199], a[8:11]
ds_read_b64_tr_b16 v[176:177], v30 offset:16384
ds_read_b64_tr_b16 v[178:179], v30 offset:18432
buffer_load_dwordx4 a[156:159], v1, s[44:47], s25 offen offset:3072 sc1
M a[12:15], v[124:127], a[196:199], a[12:15]
ds_read_b64_tr_b16 v[180:181], v30 offset:20480
ds_read_b64_tr_b16 v[182:183], v30 offset:22528
M a[12:15], v[120:123], a[192:195], a[12:15]
s_add_u32 s25, s25, 16384
s_add_u32 s26, s26, 131072
ds_read_b64_tr_b16 v[184:185], v31 offset:16384
ds_read_b64_tr_b16 v[186:187], v31 offset:18432
M a[16:19], v[96:99], a[200:203], a[16:19]
s_add_u32 s60, s56, 0
buffer_store_dwordx4 v[48:51], v1, s[52:55], s60 offen offset:0 sc1
ds_read_b64_tr_b16 v[188:189], v31 offset:20480
ds_read_b64_tr_b16 v[190:191], v31 offset:22528
M a[16:19], v[100:103], a[204:207], a[16:19]
buffer_store_dwordx4 v[52:55], v1, s[52:55], s60 offen offset:1024 sc1
buffer_store_dwordx4 v[56:59], v1, s[52:55], s60 offen offset:2048 sc1
M a[20:23], v[108:111], a[204:207], a[20:23]
buffer_store_dwordx4 v[60:63], v1, s[52:55], s60 offen offset:3072 sc1
M a[20:23], v[104:107], a[200:203], a[20:23]
s_add_u32 s60, s56, 4096
buffer_store_dwordx4 v[80:83], v1, s[52:55], s60 offen offset:0 sc1
buffer_store_dwordx4 v[84:87], v1, s[52:55], s60 offen offset:1024 sc1
M a[24:27], v[112:115], a[200:203], a[24:27]
buffer_store_dwordx4 v[88:91], v1, s[52:55], s60 offen offset:2048 sc1
buffer_store_dwordx4 v[92:95], v1, s[52:55], s60 offen offset:3072 sc1
M a[24:27], v[116:119], a[204:207], a[24:27]
v_mov_b32 v11, 0
M a[28:31], v[124:127], a[204:207], a[28:31]
M a[28:31], v[120:123], a[200:203], a[28:31]
s_waitcnt vmcnt(26) lgkmcnt(0)
s_barrier
M a[0:3], v[160:163], a[208:211], a[0:3]
s_add_u32 m0, s42, 32768
s_nop 0
buffer_load_dwordx4 v6, s[48:51], s26 offen offset:0 lds
ds_read_b64_tr_b16 v[96:97], v28 offset:32768
ds_read_b64_tr_b16 v[98:99], v28 offset:34816
M a[0:3], v[164:167], a[212:215], a[0:3]
buffer_load_dwordx4 v7, s[48:51], s26 offen offset:1024 lds
M a[4:7], v[172:175], a[212:215], a[4:7]
ds_read_b64_tr_b16 v[100:101], v28 offset:36864
ds_read_b64_tr_b16 v[102:103], v28 offset:38912
M a[4:7], v[168:171], a[208:211], a[4:7]
buffer_load_dwordx4 a[160:163], v1, s[44:47], s25 offen offset:0 sc1
M a[8:11], v[176:179], a[208:211], a[8:11]
ds_read_b64_tr_b16 v[104:105], v29 offset:32768
ds_read_b64_tr_b16 v[106:107], v29 offset:34816
M a[8:11], v[180:183], a[212:215], a[8:11]
buffer_load_dwordx4 a[164:167], v1, s[44:47], s25 offen offset:1024 sc1
M a[12:15], v[188:191], a[212:215], a[12:15]
ds_read_b64_tr_b16 v[108:109], v29 offset:36864
ds_read_b64_tr_b16 v[110:111], v29 offset:38912
M a[12:15], v[184:187], a[208:211], a[12:15]
buffer_load_dwordx4 a[168:171], v1, s[44:47], s25 offen offset:2048 sc1
M a[16:19], v[160:163], a[216:219], a[16:19]
ds_read_b64_tr_b16 v[112:113], v30 offset:32768
ds_read_b64_tr_b16 v[114:115], v30 offset:34816
M a[16:19], v[164:167], a[220:223], a[16:19]
buffer_load_dwordx4 a[172:175], v1, s[44:47], s25 offen offset:3072 sc1
M a[20:23], v[172:175], a[220:223], a[20:23]
ds_read_b64_tr_b16 v[116:117], v30 offset:36864
ds_read_b64_tr_b16 v[118:119], v30 offset:38912
M a[20:23], v[168:171], a[216:219], a[20:23]
s_add_u32 s25, s25, 16384
s_add_u32 s26, s26, 131072
M a[24:27], v[176:179], a[216:219], a[24:27]
ds_read_b64_tr_b16 v[120:121], v31 offset:32768
ds_read_b64_tr_b16 v[122:123], v31 offset:34816
M a[24:27], v[180:183], a[220:223], a[24:27]
ds_read_b64_tr_b16 v[124:125], v31 offset:36864
ds_read_b64_tr_b16 v[126:127], v31 offset:38912
M a[28:31], v[188:191], a[220:223], a[28:31]
M a[28:31], v[184:187], a[216:219], a[28:31]
s_waitcnt vmcnt(6) lgkmcnt(0)
s_barrier
s_cmp_lg_u32 s101, 0
s_cbranch_scc1 Lk3f_15
v_mov_b32 v9, 1
s_mov_b64 exec, 1
buffer_store_dword v9, v11, s[52:55], s58 offen sc1
s_mov_b64 exec, -1
Lk3f_15:
M a[0:3], v[96:99], a[224:227], a[0:3]
s_add_u32 m0, s42, 49152
s_nop 0
buffer_load_dwordx4 v6, s[48:51], s26 offen offset:0 lds
ds_read_b64_tr_b16 v[160:161], v28 offset:49152
ds_read_b64_tr_b16 v[162:163], v28 offset:51200
M a[0:3], v[100:103], a[228:231], a[0:3]
buffer_load_dwordx4 v7, s[48:51], s26 offen offset:1024 lds
M a[4:7], v[108:111], a[228:231], a[4:7]
ds_read_b64_tr_b16 v[164:165], v28 offset:53248
ds_read_b64_tr_b16 v[166:167], v28 offset:55296
M a[4:7], v[104:107], a[224:227], a[4:7]
buffer_load_dwordx4 a[176:179], v1, s[44:47], s25 offen offset:0 sc1
M a[8:11], v[112:115], a[224:227], a[8:11]
ds_read_b64_tr_b16 v[168:169], v29 offset:49152
ds_read_b64_tr_b16 v[170:171], v29 offset:51200
M a[8:11], v[116:119], a[228:231], a[8:11]
buffer_load_dwordx4 a[180:183], v1, s[44:47], s25 offen offset:1024 sc1
M a[12:15], v[124:127], a[228:231], a[12:15]
ds_read_b64_tr_b16 v[172:173], v29 offset:53248
ds_read_b64_tr_b16 v[174:175], v29 offset:55296
M a[12:15], v[120:123], a[224:227], a[12:15]
buffer_load_dwordx4 a[184:187], v1, s[44:47], s25 offen offset:2048 sc1
M a[16:19], v[96:99], a[232:235], a[16:19]
ds_read_b64_tr_b16 v[176:177], v30 offset:49152
ds_read_b64_tr_b16 v[178:179], v30 offset:51200
M a[16:19], v[100:103], a[236:239], a[16:19]
buffer_load_dwordx4 a[188:191], v1, s[44:47], s25 offen offset:3072 sc1
M a[20:23], v[108:111], a[236:239], a[20:23]
ds_read_b64_tr_b16 v[180:181], v30 offset:53248
ds_read_b64_tr_b16 v[182:183], v30 offset:55296
M a[20:23], v[104:107], a[232:235], a[20:23]
s_add_u32 s25, s25, 16384
s_add_u32 s26, s26, 131072
M a[24:27], v[112:115], a[232:235], a[24:27]
ds_read_b64_tr_b16 v[184:185], v31 offset:49152
ds_read_b64_tr_b16 v[186:187], v31 offset:51200
M a[24:27], v[116:119], a[236:239], a[24:27]
ds_read_b64_tr_b16 v[188:189], v31 offset:53248
ds_read_b64_tr_b16 v[190:191], v31 offset:55296
M a[28:31], v[124:127], a[236:239], a[28:31]
M a[28:31], v[120:123], a[232:235], a[28:31]
s_waitcnt vmcnt(26) lgkmcnt(0)
s_barrier
M a[0:3], v[160:163], a[240:243], a[0:3]
ds_read_b64_tr_b16 v[96:97], v24 offset:0
ds_read_b64_tr_b16 v[98:99], v24 offset:2048
M a[0:3], v[164:167], a[244:247], a[0:3]
ds_read_b64_tr_b16 v[100:101], v24 offset:4096
ds_read_b64_tr_b16 v[102:103], v24 offset:6144
M a[4:7], v[172:175], a[244:247], a[4:7]
M a[4:7], v[168:171], a[240:243], a[4:7]
ds_read_b64_tr_b16 v[104:105], v25 offset:0
ds_read_b64_tr_b16 v[106:107], v25 offset:2048
M a[8:11], v[176:179], a[240:243], a[8:11]
M a[8:11], v[180:183], a[244:247], a[8:11]
ds_read_b64_tr_b16 v[108:109], v25 offset:4096
ds_read_b64_tr_b16 v[110:111], v25 offset:6144
M a[12:15], v[188:191], a[244:247], a[12:15]
M a[12:15], v[184:187], a[240:243], a[12:15]
ds_read_b64_tr_b16 v[112:113], v26 offset:0
ds_read_b64_tr_b16 v[114:115], v26 offset:2048
M a[16:19], v[160:163], a[248:251], a[16:19]
ds_read_b64_tr_b16 v[116:117], v26 offset:4096
ds_read_b64_tr_b16 v[118:119], v26 offset:6144
M a[16:19], v[164:167], a[252:255], a[16:19]
M a[20:23], v[172:175], a[252:255], a[20:23]
ds_read_b64_tr_b16 v[120:121], v27 offset:0
ds_read_b64_tr_b16 v[122:123], v27 offset:2048
M a[20:23], v[168:171], a[248:251], a[20:23]
M a[24:27], v[176:179], a[248:251], a[24:27]
ds_read_b64_tr_b16 v[124:125], v27 offset:4096
ds_read_b64_tr_b16 v[126:127], v27 offset:6144
M a[24:27], v[180:183], a[252:255], a[24:27]
M a[28:31], v[188:191], a[252:255], a[28:31]
M a[28:31], v[184:187], a[248:251], a[28:31]
s_waitcnt vmcnt(20) lgkmcnt(0)
s_barrier
M a[0:3], v[96:99], a[128:131], a[0:3]
ds_read_b64_tr_b16 v[160:161], v24 offset:16384
ds_read_b64_tr_b16 v[162:163], v24 offset:18432
M a[0:3], v[100:103], a[132:135], a[0:3]
ds_read_b64_tr_b16 v[164:165], v24 offset:20480
ds_read_b64_tr_b16 v[166:167], v24 offset:22528
M a[4:7], v[108:111], a[132:135], a[4:7]
M a[4:7], v[104:107], a[128:131], a[4:7]
ds_read_b64_tr_b16 v[168:169], v25 offset:16384
ds_read_b64_tr_b16 v[170:171], v25 offset:18432
M a[8:11], v[112:115], a[128:131], a[8:11]
M a[8:11], v[116:119], a[132:135], a[8:11]
ds_read_b64_tr_b16 v[172:173], v25 offset:20480
ds_read_b64_tr_b16 v[174:175], v25 offset:22528
M a[12:15], v[124:127], a[132:135], a[12:15]
M a[12:15], v[120:123], a[128:131], a[12:15]
ds_read_b64_tr_b16 v[176:177], v26 offset:16384
ds_read_b64_tr_b16 v[178:179], v26 offset:18432
M a[16:19], v[96:99], a[136:139], a[16:19]
ds_read_b64_tr_b16 v[180:181], v26 offset:20480
ds_read_b64_tr_b16 v[182:183], v26 offset:22528
M a[16:19], v[100:103], a[140:143], a[16:19]
M a[20:23], v[108:111], a[140:143], a[20:23]
ds_read_b64_tr_b16 v[184:185], v27 offset:16384
ds_read_b64_tr_b16 v[186:187], v27 offset:18432
M a[20:23], v[104:107], a[136:139], a[20:23]
M a[24:27], v[112:115], a[136:139], a[24:27]
ds_read_b64_tr_b16 v[188:189], v27 offset:20480
ds_read_b64_tr_b16 v[190:191], v27 offset:22528
M a[24:27], v[116:119], a[140:143], a[24:27]
M a[28:31], v[124:127], a[140:143], a[28:31]
M a[28:31], v[120:123], a[136:139], a[28:31]
s_waitcnt vmcnt(6) lgkmcnt(0)
s_barrier
M a[0:3], v[160:163], a[144:147], a[0:3]
buffer_load_dword v8, v11, s[52:55], s59 offen sc1
M a[0:3], v[164:167], a[148:151], a[0:3]
ds_read_b64_tr_b16 v[96:97], v24 offset:32768
ds_read_b64_tr_b16 v[98:99], v24 offset:34816
M a[4:7], v[172:175], a[148:151], a[4:7]
M a[4:7], v[168:171], a[144:147], a[4:7]
ds_read_b64_tr_b16 v[100:101], v24 offset:36864
ds_read_b64_tr_b16 v[102:103], v24 offset:38912
M a[8:11], v[176:179], a[144:147], a[8:11]
ds_read_b64_tr_b16 v[104:105], v25 offset:32768
ds_read_b64_tr_b16 v[106:107], v25 offset:34816
M a[8:11], v[180:183], a[148:151], a[8:11]
M a[12:15], v[188:191], a[148:151], a[12:15]
ds_read_b64_tr_b16 v[108:109], v25 offset:36864
ds_read_b64_tr_b16 v[110:111], v25 offset:38912
M a[12:15], v[184:187], a[144:147], a[12:15]
ds_read_b64_tr_b16 v[112:113], v26 offset:32768
ds_read_b64_tr_b16 v[114:115], v26 offset:34816
M a[16:19], v[160:163], a[152:155], a[16:19]
M a[16:19], v[164:167], a[156:159], a[16:19]
ds_read_b64_tr_b16 v[116:117], v26 offset:36864
ds_read_b64_tr_b16 v[118:119], v26 offset:38912
M a[20:23], v[172:175], a[156:159], a[20:23]
ds_read_b64_tr_b16 v[120:121], v27 offset:32768
ds_read_b64_tr_b16 v[122:123], v27 offset:34816
M a[20:23], v[168:171], a[152:155], a[20:23]
M a[24:27], v[176:179], a[152:155], a[24:27]
ds_read_b64_tr_b16 v[124:125], v27 offset:36864
ds_read_b64_tr_b16 v[126:127], v27 offset:38912
M a[24:27], v[180:183], a[156:159], a[24:27]
M a[28:31], v[188:191], a[156:159], a[28:31]
M a[28:31], v[184:187], a[152:155], a[28:31]
s_waitcnt vmcnt(1) lgkmcnt(0)
s_barrier
s_waitcnt vmcnt(0)
v_cmp_ne_u32 vcc, 1, v8
s_nop 0
s_cbranch_vccnz Lk3_spinfl
Lk3_gotfl:
M a[0:3], v[96:99], a[160:163], a[0:3]
s_add_u32 s60, s57, 0
buffer_load_dwordx4 v[224:227], v1, s[52:55], s60 offen offset:0 sc1
ds_read_b64_tr_b16 v[160:161], v24 offset:49152
ds_read_b64_tr_b16 v[162:163], v24 offset:51200
M a[0:3], v[100:103], a[164:167], a[0:3]
buffer_load_dwordx4 v[228:231], v1, s[52:55], s60 offen offset:1024 sc1
M a[4:7], v[108:111], a[164:167], a[4:7]
ds_read_b64_tr_b16 v[164:165], v24 offset:53248
ds_read_b64_tr_b16 v[166:167], v24 offset:55296
M a[4:7], v[104:107], a[160:163], a[4:7]
buffer_load_dwordx4 v[232:235], v1, s[52:55], s60 offen offset:2048 sc1
M a[8:11], v[112:115], a[160:163], a[8:11]
ds_read_b64_tr_b16 v[168:169], v25 offset:49152
ds_read_b64_tr_b16 v[170:171], v25 offset:51200
M a[8:11], v[116:119], a[164:167], a[8:11]
buffer_load_dwordx4 v[236:239], v1, s[52:55], s60 offen offset:3072 sc1
M a[12:15], v[124:127], a[164:167], a[12:15]
ds_read_b64_tr_b16 v[172:173], v25 offset:53248
ds_read_b64_tr_b16 v[174:175], v25 offset:55296
M a[12:15], v[120:123], a[160:163], a[12:15]
s_add_u32 s60, s57, 4096
buffer_load_dwordx4 v[240:243], v1, s[52:55], s60 offen offset:0 sc1
ds_read_b64_tr_b16 v[176:177], v26 offset:49152
ds_read_b64_tr_b16 v[178:179], v26 offset:51200
M a[16:19], v[96:99], a[168:171], a[16:19]
buffer_load_dwordx4 v[244:247], v1, s[52:55], s60 offen offset:1024 sc1
M a[16:19], v[100:103], a[172:175], a[16:19]
ds_read_b64_tr_b16 v[180:181], v26 offset:53248
ds_read_b64_tr_b16 v[182:183], v26 offset:55296
M a[20:23], v[108:111], a[172:175], a[20:23]
buffer_load_dwordx4 v[248:251], v1, s[52:55], s60 offen offset:2048 sc1
M a[20:23], v[104:107], a[168:171], a[20:23]
ds_read_b64_tr_b16 v[184:185], v27 offset:49152
ds_read_b64_tr_b16 v[186:187], v27 offset:51200
M a[24:27], v[112:115], a[168:171], a[24:27]
buffer_load_dwordx4 v[252:255], v1, s[52:55], s60 offen offset:3072 sc1
M a[24:27], v[116:119], a[172:175], a[24:27]
ds_read_b64_tr_b16 v[188:189], v27 offset:53248
ds_read_b64_tr_b16 v[190:191], v27 offset:55296
M a[28:31], v[124:127], a[172:175], a[28:31]
M a[28:31], v[120:123], a[168:171], a[28:31]
s_waitcnt lgkmcnt(0)
M a[0:3], v[160:163], a[176:179], a[0:3]
M a[0:3], v[164:167], a[180:183], a[0:3]
M a[4:7], v[172:175], a[180:183], a[4:7]
M a[4:7], v[168:171], a[176:179], a[4:7]
M a[8:11], v[176:179], a[176:179], a[8:11]
M a[8:11], v[180:183], a[180:183], a[8:11]
M a[12:15], v[188:191], a[180:183], a[12:15]
M a[12:15], v[184:187], a[176:179], a[12:15]
M a[16:19], v[160:163], a[184:187], a[16:19]
M a[16:19], v[164:167], a[188:191], a[16:19]
M a[20:23], v[172:175], a[188:191], a[20:23]
M a[20:23], v[168:171], a[184:187], a[20:23]
M a[24:27], v[176:179], a[184:187], a[24:27]
M a[24:27], v[180:183], a[188:191], a[24:27]
M a[28:31], v[188:191], a[188:191], a[28:31]
M a[28:31], v[184:187], a[184:187], a[28:31]
v_bfe_u32 v96, v0, 4, 1
v_lshrrev_b32 v97, 5, v0
v_lshl_or_b32 v96, v96, 1, v97
v_and_b32 v97, 15, v0
v_lshlrev_b32 v97, 13, v97
v_lshl_add_u32 v96, v96, 4, v97
s_and_b32 s3, s101, 1
s_lshl_b32 s3, s3, 6
s_lshr_b32 s6, s101, 1
s_add_u32 s3, s3, s6
s_add_u32 s3, s3, s21
s_lshl_b32 s3, s3, 12
s_lshl_b32 s6, s22, 1
s_add_u32 s3, s3, s6
s_add_u32 s3, s3, 2048
v_accvgpr_read_b32 v108, a0
v_accvgpr_read_b32 v109, a1
v_accvgpr_read_b32 v110, a2
v_accvgpr_read_b32 v111, a3
v_accvgpr_read_b32 v112, a4
v_accvgpr_read_b32 v113, a5
v_accvgpr_read_b32 v114, a6
v_accvgpr_read_b32 v115, a7
v_cvt_pk_bf16_f32 v100, v108, v109
v_cvt_pk_bf16_f32 v101, v110, v111
v_cvt_pk_bf16_f32 v102, v112, v113
v_cvt_pk_bf16_f32 v103, v114, v115
s_nop 0
v_permlane16_swap_b32 v100, v102
v_permlane16_swap_b32 v101, v103
buffer_store_dwordx4 v[100:103], v96, s[16:19], s3 offen offset:0
v_accvgpr_read_b32 v108, a8
v_accvgpr_read_b32 v109, a9
v_accvgpr_read_b32 v110, a10
v_accvgpr_read_b32 v111, a11
v_accvgpr_read_b32 v112, a12
v_accvgpr_read_b32 v113, a13
v_accvgpr_read_b32 v114, a14
v_accvgpr_read_b32 v115, a15
v_cvt_pk_bf16_f32 v104, v108, v109
v_cvt_pk_bf16_f32 v105, v110, v111
v_cvt_pk_bf16_f32 v106, v112, v113
v_cvt_pk_bf16_f32 v107, v114, v115
s_nop 0
v_permlane16_swap_b32 v104, v106
v_permlane16_swap_b32 v105, v107
buffer_store_dwordx4 v[104:107], v96, s[16:19], s3 offen offset:64
s_add_u32 s3, s3, 131072
v_accvgpr_read_b32 v108, a16
v_accvgpr_read_b32 v109, a17
v_accvgpr_read_b32 v110, a18
v_accvgpr_read_b32 v111, a19
v_accvgpr_read_b32 v112, a20
v_accvgpr_read_b32 v113, a21
v_accvgpr_read_b32 v114, a22
v_accvgpr_read_b32 v115, a23
v_cvt_pk_bf16_f32 v100, v108, v109
v_cvt_pk_bf16_f32 v101, v110, v111
v_cvt_pk_bf16_f32 v102, v112, v113
v_cvt_pk_bf16_f32 v103, v114, v115
s_nop 0
v_permlane16_swap_b32 v100, v102
v_permlane16_swap_b32 v101, v103
buffer_store_dwordx4 v[100:103], v96, s[16:19], s3 offen offset:0
v_accvgpr_read_b32 v108, a24
v_accvgpr_read_b32 v109, a25
v_accvgpr_read_b32 v110, a26
v_accvgpr_read_b32 v111, a27
v_accvgpr_read_b32 v112, a28
v_accvgpr_read_b32 v113, a29
v_accvgpr_read_b32 v114, a30
v_accvgpr_read_b32 v115, a31
v_cvt_pk_bf16_f32 v104, v108, v109
v_cvt_pk_bf16_f32 v105, v110, v111
v_cvt_pk_bf16_f32 v106, v112, v113
v_cvt_pk_bf16_f32 v107, v114, v115
s_nop 0
v_permlane16_swap_b32 v104, v106
v_permlane16_swap_b32 v105, v107
buffer_store_dwordx4 v[104:107], v96, s[16:19], s3 offen offset:64
v_bfe_u32 v128, v0, 4, 1
v_lshrrev_b32 v129, 5, v0
v_lshl_or_b32 v128, v128, 1, v129
v_and_b32 v129, 15, v0
v_lshlrev_b32 v129, 12, v129
v_lshl_add_u32 v128, v128, 4, v129
s_lshl_b32 s3, s101, 5
s_add_u32 s3, s3, s29
s_lshl_b32 s3, s3, 12
s_lshl_b32 s6, s30, 1
s_add_u32 s3, s3, s6
s_waitcnt vmcnt(4)
v_pk_add_f32 v[32:33], v[32:33], v[224:225]
v_pk_add_f32 v[34:35], v[34:35], v[226:227]
v_pk_add_f32 v[36:37], v[36:37], v[228:229]
v_pk_add_f32 v[38:39], v[38:39], v[230:231]
v_cvt_pk_bf16_f32 v132, v32, v33
v_cvt_pk_bf16_f32 v133, v34, v35
v_cvt_pk_bf16_f32 v134, v36, v37
v_cvt_pk_bf16_f32 v135, v38, v39
s_nop 0
v_permlane16_swap_b32 v132, v134
v_permlane16_swap_b32 v133, v135
buffer_store_dwordx4 v[132:135], v128, s[16:19], s3 offen offset:0
v_pk_add_f32 v[40:41], v[40:41], v[232:233]
v_pk_add_f32 v[42:43], v[42:43], v[234:235]
v_pk_add_f32 v[44:45], v[44:45], v[236:237]
v_pk_add_f32 v[46:47], v[46:47], v[238:239]
v_cvt_pk_bf16_f32 v136, v40, v41
v_cvt_pk_bf16_f32 v137, v42, v43
v_cvt_pk_bf16_f32 v138, v44, v45
v_cvt_pk_bf16_f32 v139, v46, v47
s_nop 0
v_permlane16_swap_b32 v136, v138
v_permlane16_swap_b32 v137, v139
buffer_store_dwordx4 v[136:139], v128, s[16:19], s3 offen offset:64
s_add_u32 s3, s3, 65536
v_pk_add_f32 v[64:65], v[64:65], v[240:241]
v_pk_add_f32 v[66:67], v[66:67], v[242:243]
v_pk_add_f32 v[68:69], v[68:69], v[244:245]
v_pk_add_f32 v[70:71], v[70:71], v[246:247]
v_cvt_pk_bf16_f32 v132, v64, v65
v_cvt_pk_bf16_f32 v133, v66, v67
v_cvt_pk_bf16_f32 v134, v68, v69
v_cvt_pk_bf16_f32 v135, v70, v71
s_nop 0
v_permlane16_swap_b32 v132, v134
v_permlane16_swap_b32 v133, v135
buffer_store_dwordx4 v[132:135], v128, s[16:19], s3 offen offset:0
v_pk_add_f32 v[72:73], v[72:73], v[248:249]
v_pk_add_f32 v[74:75], v[74:75], v[250:251]
v_pk_add_f32 v[76:77], v[76:77], v[252:253]
v_pk_add_f32 v[78:79], v[78:79], v[254:255]
v_cvt_pk_bf16_f32 v136, v72, v73
v_cvt_pk_bf16_f32 v137, v74, v75
v_cvt_pk_bf16_f32 v138, v76, v77
v_cvt_pk_bf16_f32 v139, v78, v79
s_nop 0
v_permlane16_swap_b32 v136, v138
v_permlane16_swap_b32 v137, v139
buffer_store_dwordx4 v[136:139], v128, s[16:19], s3 offen offset:64
s_endpgm
Lk3_spinb0:
Lk3_spinb0_:
s_add_u32 s61, s61, 1
s_cmp_gt_u32 s61, 1048576
s_cbranch_scc1 Lk3_gotb0
s_sleep 2
buffer_load_dword v7, v15, s[52:55], s43 offen sc1
s_waitcnt vmcnt(0)
v_cmp_ne_u32 vcc, 1, v7
s_nop 0
s_cbranch_vccnz Lk3_spinb0_
s_branch Lk3_gotb0
Lk3_spinb1:
Lk3_spinb1_:
s_add_u32 s61, s61, 1
s_cmp_gt_u32 s61, 1048576
s_cbranch_scc1 Lk3_gotb1
s_sleep 2
buffer_load_dword v7, v15, s[52:55], s43 offen sc1
s_waitcnt vmcnt(0)
v_cmp_ne_u32 vcc, 1, v7
s_nop 0
s_cbranch_vccnz Lk3_spinb1_
s_branch Lk3_gotb1
Lk3_spinft:
s_add_u32 s61, s61, 1
s_cmp_gt_u32 s61, 1048576
s_cbranch_scc1 Lk3_gotft
s_sleep 2
buffer_load_dword v252, v255, s[52:55], s62 offen sc1
s_waitcnt vmcnt(0)
v_cmp_ne_u32 vcc, 1, v252
s_nop 0
s_cbranch_vccnz Lk3_spinft
s_branch Lk3_gotft
Lk3_spinfl:
s_add_u32 s61, s61, 1
s_cmp_gt_u32 s61, 1048576
s_cbranch_scc1 Lk3_gotfl
s_sleep 2
buffer_load_dword v8, v11, s[52:55], s59 offen sc1
s_waitcnt vmcnt(0)
v_cmp_ne_u32 vcc, 1, v8
s_nop 0
s_cbranch_vccnz Lk3_spinfl
s_branch Lk3_gotfl
Lc3:
.section .rodata,"a"
.p2align 6
.amdhsa_kernel concat_heads__compressed_kv_cla__sliding_local_dilated__prompt_kernel
  .amdhsa_next_free_vgpr 512
  .amdhsa_next_free_sgpr 102
  .amdhsa_accum_offset 256
  .amdhsa_group_segment_fixed_size 0
  .amdhsa_kernarg_size 96
  .amdhsa_user_sgpr_count 2
  .amdhsa_user_sgpr_kernarg_segment_ptr 1
  .amdhsa_system_sgpr_workgroup_id_x 1
.end_amdhsa_kernel
```

```asm
; @launch grid=(256,1,1) block=(256,1,1) lds=163840
.amdgcn_target "amdgcn-amd-amdhsa--gfx950"
.text
.macro M d, a, b, c
v_mfma_f32_16x16x32_bf16 \d, \a, \b, \c
.endm
.globl concat_heads__compressed_kv_cla__sliding_local_dilated__prompt_kernel
.p2align 8
.type concat_heads__compressed_kv_cla__sliding_local_dilated__prompt_kernel,@function
concat_heads__compressed_kv_cla__sliding_local_dilated__prompt_kernel:
s_cmp_lt_u32 s2, 256
s_cbranch_scc1 Lk1_go
s_endpgm
Lk1_go:
s_load_dwordx16 s[32:47], s[0:1], 0
s_load_dwordx2 s[48:49], s[0:1], 64
s_load_dwordx2 s[50:51], s[0:1], 88
s_load_dwordx2 s[90:91], s[0:1], 80
v_lshrrev_b32 v24, 6, v0
s_nop 0
v_readfirstlane_b32 s20, v24
v_and_b32 v0, 63, v0
v_lshlrev_b32 v1, 4, v0
s_mov_b32 s101, s20
s_lshr_b32 s21, s20, 1
s_and_b32 s22, s20, 1
s_lshl_b32 s29, s20, 12
s_and_b32 s3, s2, 1
s_lshl_b32 s3, s3, 2
s_bfe_u32 s6, s2, 0x20003
s_add_u32 s3, s3, s6
s_lshl_b32 s52, s3, 8
s_bfe_u32 s3, s2, 0x20001
s_lshl_b32 s3, s3, 2
s_bfe_u32 s7, s2, 0x20005
s_add_u32 s3, s3, s7
s_lshl_b32 s53, s3, 8
s_cmp_lt_u32 s2, 128
s_cselect_b32 s5, 11, 10
s_lshl_b32 s3, s21, 7
s_lshl_b32 s4, s22, 5
s_add_u32 s3, s3, s4
v_lshrrev_b32 v24, 3, v0
v_add_u32 v24, s3, v24
v_and_b32 v25, 7, v0
v_add_u32 v26, 0, v24
v_bfe_u32 v27, v26, 1, 3
v_xor_b32 v27, v27, v25
v_lshlrev_b32 v26, s5, v26
v_lshl_add_u32 v26, v27, 4, v26
v_subrev_u32 v2, 0, v26
v_add_u32 v26, 8, v24
v_bfe_u32 v27, v26, 1, 3
v_xor_b32 v27, v27, v25
v_lshlrev_b32 v26, s5, v26
v_lshl_add_u32 v26, v27, 4, v26
v_subrev_u32 v3, 1024, v26
v_add_u32 v26, 16, v24
v_bfe_u32 v27, v26, 1, 3
v_xor_b32 v27, v27, v25
v_lshlrev_b32 v26, s5, v26
v_lshl_add_u32 v26, v27, 4, v26
v_subrev_u32 v4, 2048, v26
v_add_u32 v26, 24, v24
v_bfe_u32 v27, v26, 1, 3
v_xor_b32 v27, v27, v25
v_lshlrev_b32 v26, s5, v26
v_lshl_add_u32 v26, v27, 4, v26
v_subrev_u32 v5, 3072, v26
s_lshl_b32 s3, s20, 3
v_lshrrev_b32 v24, 5, v0
v_add_u32 v24, s3, v24
v_and_b32 v25, 31, v0
v_add_u32 v26, 0, v24
v_and_b32 v27, 3, v26
v_lshlrev_b32 v27, 1, v27
v_and_or_b32 v27, v26, 8, v27
v_xor_b32 v27, v27, v25
v_lshlrev_b32 v26, 13, v26
v_lshl_add_u32 v26, v27, 4, v26
v_subrev_u32 v6, 0, v26
v_add_u32 v26, 2, v24
v_and_b32 v27, 3, v26
v_lshlrev_b32 v27, 1, v27
v_and_or_b32 v27, v26, 8, v27
v_xor_b32 v27, v27, v25
v_lshlrev_b32 v26, 13, v26
v_lshl_add_u32 v26, v27, 4, v26
v_subrev_u32 v7, 1024, v26
v_add_u32 v26, 4, v24
v_and_b32 v27, 3, v26
v_lshlrev_b32 v27, 1, v27
v_and_or_b32 v27, v26, 8, v27
v_xor_b32 v27, v27, v25
v_lshlrev_b32 v26, 13, v26
v_lshl_add_u32 v26, v27, 4, v26
v_subrev_u32 v8, 2048, v26
v_add_u32 v26, 6, v24
v_and_b32 v27, 3, v26
v_lshlrev_b32 v27, 1, v27
v_and_or_b32 v27, v26, 8, v27
v_xor_b32 v27, v27, v25
v_lshlrev_b32 v26, 13, v26
v_lshl_add_u32 v26, v27, 4, v26
v_subrev_u32 v9, 3072, v26
s_lshl_b32 s23, s52, s5
s_lshl_b32 s31, 64, s5
s_mov_b32 s26, s23
s_lshl_b32 s24, s53, 1
s_mov_b32 s28, s24
s_lshl_b32 s3, 1, s5
s_add_u32 s25, s23, s3
s_lshl_b32 s3, s3, 12
s_add_u32 s27, s24, s3
s_bfe_u32 s3, s2, 0x20001
s_and_b32 s4, s2, 1
s_lshl_b32 s4, s4, 1
s_add_u32 s3, s3, s4
s_and_b32 s3, s3, 3
s_sub_u32 s4, s5, 2
s_lshl_b32 s3, s3, s4
s_add_u32 s23, s23, s3
s_lshl_b32 s3, s3, 12
s_add_u32 s24, s24, s3
s_mov_b32 s95, s6
s_cmp_lt_u32 s2, 128
s_cselect_b32 s6, -1, 8
s_waitcnt lgkmcnt(0)
s_cmp_lt_u32 s2, 128
s_cselect_b64 s[8:9], s[32:33], s[34:35]
s_mov_b32 s10, 2097152
s_cselect_b32 s10, 4194304, s10
s_mov_b32 s11, 0x00020000
s_cselect_b64 s[12:13], s[36:37], s[38:39]
s_mov_b32 s14, 4194304
s_cselect_b32 s14, 8388608, s14
s_mov_b32 s15, 0x00020000
s_mov_b64 s[64:65], s[40:41]
s_add_u32 m0, s29, 65536
s_nop 0
buffer_load_dwordx4 v6, s[12:15], s24 offen offset:0 lds
buffer_load_dwordx4 v7, s[12:15], s24 offen offset:1024 lds
buffer_load_dwordx4 v8, s[12:15], s24 offen offset:2048 lds
buffer_load_dwordx4 v9, s[12:15], s24 offen offset:3072 lds
s_add_u32 s24, s24, 262144
s_add_u32 m0, s29, 0
s_nop 0
buffer_load_dwordx4 v2, s[8:11], s23 offen offset:0 lds
buffer_load_dwordx4 v3, s[8:11], s23 offen offset:1024 lds
buffer_load_dwordx4 v4, s[8:11], s23 offen offset:2048 lds
buffer_load_dwordx4 v5, s[8:11], s23 offen offset:3072 lds
s_add_u32 m0, s29, 81920
s_nop 0
buffer_load_dwordx4 v6, s[12:15], s24 offen offset:0 lds
buffer_load_dwordx4 v7, s[12:15], s24 offen offset:1024 lds
buffer_load_dwordx4 v8, s[12:15], s24 offen offset:2048 lds
buffer_load_dwordx4 v9, s[12:15], s24 offen offset:3072 lds
s_add_u32 s24, s24, 262144
s_cmp_eq_u32 s24, s27
s_cselect_b32 s24, s28, s24
s_sub_u32 s6, s6, 1
s_cmp_eq_u32 s6, 0
s_cselect_b64 s[12:13], s[64:65], s[12:13]
s_add_u32 m0, s29, 98304
s_nop 0
buffer_load_dwordx4 v6, s[12:15], s24 offen offset:0 lds
buffer_load_dwordx4 v7, s[12:15], s24 offen offset:1024 lds
buffer_load_dwordx4 v8, s[12:15], s24 offen offset:2048 lds
buffer_load_dwordx4 v9, s[12:15], s24 offen offset:3072 lds
s_add_u32 s24, s24, 262144
s_add_u32 m0, s29, 16384
s_add_u32 s3, s23, s31
s_nop 0
buffer_load_dwordx4 v2, s[8:11], s3 offen offset:0 lds
buffer_load_dwordx4 v3, s[8:11], s3 offen offset:1024 lds
buffer_load_dwordx4 v4, s[8:11], s3 offen offset:2048 lds
buffer_load_dwordx4 v5, s[8:11], s3 offen offset:3072 lds
s_add_u32 s23, s23, 128
s_cmp_eq_u32 s23, s25
s_cselect_b32 s23, s26, s23
s_add_u32 m0, s29, 114688
s_nop 0
buffer_load_dwordx4 v6, s[12:15], s24 offen offset:0 lds
buffer_load_dwordx4 v7, s[12:15], s24 offen offset:1024 lds
buffer_load_dwordx4 v8, s[12:15], s24 offen offset:2048 lds
buffer_load_dwordx4 v9, s[12:15], s24 offen offset:3072 lds
s_add_u32 s24, s24, 262144
s_cmp_eq_u32 s24, s27
s_cselect_b32 s24, s28, s24
s_sub_u32 s6, s6, 1
s_cmp_eq_u32 s6, 0
s_cselect_b64 s[12:13], s[64:65], s[12:13]
s_add_u32 s16, s50, 109051904
s_addc_u32 s17, s51, 0
s_mov_b32 s18, 16384
s_mov_b32 s19, 0x00020000
v_mov_b32 v24, 0
v_mov_b32 v25, 0
v_mov_b32 v26, 0
v_mov_b32 v27, 0
s_lshl_b32 s3, s2, 2
buffer_store_dword v24, v24, s[16:19], s3 offen sc1
s_and_b32 s3, s2, 7
s_lshr_b32 s4, s2, 6
s_lshl_b32 s4, s4, 3
s_add_u32 s3, s3, s4
s_lshl_b32 s3, s3, 4
s_add_u32 s3, s3, 4096
s_bfe_u32 s4, s2, 0x30003
s_lshl_b32 s4, s4, 9
s_add_u32 s92, s3, s4
s_sub_u32 s4, 7680, s4
s_add_u32 s93, s3, s4
buffer_store_dwordx4 v[24:27], v24, s[16:19], s92 offen sc1
buffer_store_dwordx4 v[24:27], v24, s[16:19], s93 offen sc1
s_and_b32 s3, s2, 1
s_lshl_b32 s3, s3, 3
s_bfe_u32 s4, s2, 0x30003
s_add_u32 s92, s3, s4
s_bfe_u32 s3, s2, 0x20001
s_lshl_b32 s3, s3, 2
s_lshr_b32 s4, s2, 6
s_xor_b32 s4, s4, 2
s_add_u32 s93, s3, s4
s_lshl_b32 s92, s92, 8
s_lshl_b32 s93, s93, 4
s_add_u32 s92, s92, s93
s_add_u32 s92, s92, 12288
buffer_store_dwordx4 v[24:27], v24, s[16:19], s92 offen sc1
v_lshlrev_b32 v20, 7, v0
s_lshl_b32 s54, s2, 13
s_mov_b64 s[60:61], s[40:41]
s_mov_b32 s62, 0
s_cmp_eq_u32 s20, 1
s_cselect_b64 s[60:61], s[46:47], s[60:61]
s_cselect_b32 s62, 6291456, s62
s_cmp_eq_u32 s20, 2
s_cselect_b64 s[60:61], s[44:45], s[60:61]
s_cselect_b32 s62, 4194304, s62
s_cmp_eq_u32 s20, 3
s_cselect_b32 s62, 0, s62
s_mov_b32 s63, 0x00020000
s_mov_b32 s3, 0
s_cmp_eq_u32 s20, 1
s_cselect_b32 s3, 6291456, s3
s_cmp_eq_u32 s20, 2
s_cselect_b32 s3, 6291456, s3
s_sub_u32 s54, s54, s3
Lc0:
s_getpc_b64 s[92:93]
Lpc_1:
s_add_u32 s92, s92, Lc1-Lpc_1
s_addc_u32 s93, s93, 0
s_lshr_b32 s94, s2, 3
s_mul_i32 s94, s94, ((Lc3-Lc1)/32+127)&~127
v_lshlrev_b32 v24, 7, v0
v_add_u32 v24, s94, v24
v_min_u32 v24, Lc3-Lc1-4, v24
global_load_dword v21, v24, s[92:93]
s_add_u32 m0, s29, 32768
s_nop 0
buffer_load_dwordx4 v2, s[8:11], s23 offen offset:0 lds
buffer_load_dwordx4 v3, s[8:11], s23 offen offset:1024 lds
buffer_load_dwordx4 v4, s[8:11], s23 offen offset:2048 lds
buffer_load_dwordx4 v5, s[8:11], s23 offen offset:3072 lds
s_lshl_b32 s4, s21, 13
v_and_b32 v24, 15, v0
v_lshlrev_b32 v24, 7, v24
v_add_u32 v24, s4, v24
v_bfe_u32 v25, v0, 1, 3
v_lshrrev_b32 v26, 4, v0
v_xor_b32 v25, v25, v26
v_lshl_add_u32 v10, v25, 4, v24
v_xor_b32 v11, 64, v10
v_bfe_u32 v24, v0, 2, 2
v_lshl_add_u32 v29, v26, 3, v24
v_lshlrev_b32 v25, 9, v29
v_and_b32 v27, 1, v0
v_lshl_add_u32 v25, v27, 3, v25
v_add_u32 v25, 65536, v25
v_lshlrev_b32 v24, 1, v24
v_and_or_b32 v24, v29, 8, v24
v_bfe_u32 v26, v0, 1, 1
s_lshl_b32 s4, s22, 4
s_add_u32 s3, s4, 0
v_add_u32 v27, s3, v26
v_xor_b32 v27, v27, v24
v_lshl_add_u32 v12, v27, 4, v25
s_add_u32 s3, s4, 2
v_add_u32 v27, s3, v26
v_xor_b32 v27, v27, v24
v_lshl_add_u32 v13, v27, 4, v25
s_add_u32 s3, s4, 4
v_add_u32 v27, s3, v26
v_xor_b32 v27, v27, v24
v_lshl_add_u32 v14, v27, 4, v25
s_add_u32 s3, s4, 6
v_add_u32 v27, s3, v26
v_xor_b32 v27, v27, v24
v_lshl_add_u32 v15, v27, 4, v25
s_add_u32 s3, s4, 8
v_add_u32 v27, s3, v26
v_xor_b32 v27, v27, v24
v_lshl_add_u32 v16, v27, 4, v25
s_add_u32 s3, s4, 10
v_add_u32 v27, s3, v26
v_xor_b32 v27, v27, v24
v_lshl_add_u32 v17, v27, 4, v25
s_add_u32 s3, s4, 12
v_add_u32 v27, s3, v26
v_xor_b32 v27, v27, v24
v_lshl_add_u32 v18, v27, 4, v25
s_add_u32 s3, s4, 14
v_add_u32 v27, s3, v26
v_xor_b32 v27, v27, v24
v_lshl_add_u32 v19, v27, 4, v25
s_waitcnt vmcnt(21)
s_barrier
ds_read_b64_tr_b16 a[32:33], v12 offset:0
ds_read_b64_tr_b16 a[34:35], v12 offset:2048
ds_read_b64_tr_b16 a[40:41], v13 offset:0
ds_read_b64_tr_b16 a[42:43], v13 offset:2048
ds_read_b64_tr_b16 a[48:49], v14 offset:0
ds_read_b64_tr_b16 a[50:51], v14 offset:2048
ds_read_b64_tr_b16 a[56:57], v15 offset:0
ds_read_b64_tr_b16 a[58:59], v15 offset:2048
ds_read_b64_tr_b16 a[64:65], v16 offset:0
ds_read_b64_tr_b16 a[66:67], v16 offset:2048
ds_read_b64_tr_b16 a[72:73], v17 offset:0
ds_read_b64_tr_b16 a[74:75], v17 offset:2048
ds_read_b64_tr_b16 a[80:81], v18 offset:0
ds_read_b64_tr_b16 a[82:83], v18 offset:2048
ds_read_b64_tr_b16 a[88:89], v19 offset:0
ds_read_b64_tr_b16 a[90:91], v19 offset:2048
ds_read_b64_tr_b16 a[36:37], v12 offset:16384
ds_read_b64_tr_b16 a[38:39], v12 offset:18432
ds_read_b64_tr_b16 a[44:45], v13 offset:16384
ds_read_b64_tr_b16 a[46:47], v13 offset:18432
ds_read_b64_tr_b16 a[52:53], v14 offset:16384
ds_read_b64_tr_b16 a[54:55], v14 offset:18432
ds_read_b64_tr_b16 a[60:61], v15 offset:16384
ds_read_b64_tr_b16 a[62:63], v15 offset:18432
ds_read_b64_tr_b16 a[68:69], v16 offset:16384
ds_read_b64_tr_b16 a[70:71], v16 offset:18432
ds_read_b64_tr_b16 a[76:77], v17 offset:16384
ds_read_b64_tr_b16 a[78:79], v17 offset:18432
ds_read_b64_tr_b16 a[84:85], v18 offset:16384
ds_read_b64_tr_b16 a[86:87], v18 offset:18432
ds_read_b64_tr_b16 a[92:93], v19 offset:16384
ds_read_b64_tr_b16 a[94:95], v19 offset:18432
ds_read_b128 a[160:163], v10 offset:0
ds_read_b128 a[164:167], v11 offset:0
ds_read_b128 a[168:171], v10 offset:2048
ds_read_b128 a[172:175], v11 offset:2048
s_waitcnt vmcnt(17) lgkmcnt(0)
s_barrier
s_add_u32 m0, s29, 65536
s_nop 0
buffer_load_dwordx4 v6, s[12:15], s24 offen offset:0 lds
buffer_load_dwordx4 v7, s[12:15], s24 offen offset:1024 lds
buffer_load_dwordx4 v8, s[12:15], s24 offen offset:2048 lds
buffer_load_dwordx4 v9, s[12:15], s24 offen offset:3072 lds
s_add_u32 s24, s24, 262144
s_add_u32 m0, s29, 49152
s_add_u32 s3, s23, s31
s_nop 0
buffer_load_dwordx4 v2, s[8:11], s3 offen offset:0 lds
buffer_load_dwordx4 v3, s[8:11], s3 offen offset:1024 lds
buffer_load_dwordx4 v4, s[8:11], s3 offen offset:2048 lds
buffer_load_dwordx4 v5, s[8:11], s3 offen offset:3072 lds
Lc1:
s_cmp_lt_u32 s2, 128
s_cbranch_scc0 Lk1_kv
M v[32:35], a[32:35], a[160:163], 0
s_add_u32 s23, s23, 128
s_cmp_eq_u32 s23, s25
s_cselect_b32 s23, s26, s23
M v[32:35], a[36:39], a[164:167], v[32:35]
ds_read_b128 a[176:179], v10 offset:4096
ds_read_b128 a[180:183], v11 offset:4096
M v[36:39], a[44:47], a[164:167], 0
M v[36:39], a[40:43], a[160:163], v[36:39]
ds_read_b64_tr_b16 a[96:97], v12 offset:32768
ds_read_b64_tr_b16 a[98:99], v12 offset:34816
M v[40:43], a[48:51], a[160:163], 0
M v[40:43], a[52:55], a[164:167], v[40:43]
M v[44:47], a[60:63], a[164:167], 0
s_add_u32 m0, s29, 81920
s_nop 0
buffer_load_dwordx4 v6, s[12:15], s24 offen offset:0 lds
M v[44:47], a[56:59], a[160:163], v[44:47]
ds_read_b64_tr_b16 a[104:105], v13 offset:32768
ds_read_b64_tr_b16 a[106:107], v13 offset:34816
M v[48:51], a[64:67], a[160:163], 0
M v[48:51], a[68:71], a[164:167], v[48:51]
M v[52:55], a[76:79], a[164:167], 0
M v[52:55], a[72:75], a[160:163], v[52:55]
ds_read_b64_tr_b16 a[112:113], v14 offset:32768
ds_read_b64_tr_b16 a[114:115], v14 offset:34816
M v[56:59], a[80:83], a[160:163], 0
M v[56:59], a[84:87], a[164:167], v[56:59]
buffer_load_dwordx4 v7, s[12:15], s24 offen offset:1024 lds
M v[60:63], a[92:95], a[164:167], 0
M v[60:63], a[88:91], a[160:163], v[60:63]
ds_read_b64_tr_b16 a[120:121], v15 offset:32768
ds_read_b64_tr_b16 a[122:123], v15 offset:34816
M v[64:67], a[32:35], a[168:171], 0
M v[64:67], a[36:39], a[172:175], v[64:67]
ds_read_b128 a[184:187], v10 offset:6144
ds_read_b128 a[188:191], v11 offset:6144
M v[68:71], a[44:47], a[172:175], 0
M v[68:71], a[40:43], a[168:171], v[68:71]
ds_read_b64_tr_b16 a[128:129], v16 offset:32768
ds_read_b64_tr_b16 a[130:131], v16 offset:34816
M v[72:75], a[48:51], a[168:171], 0
buffer_load_dwordx4 v8, s[12:15], s24 offen offset:2048 lds
M v[72:75], a[52:55], a[172:175], v[72:75]
M v[76:79], a[60:63], a[172:175], 0
M v[76:79], a[56:59], a[168:171], v[76:79]
ds_read_b64_tr_b16 a[136:137], v17 offset:32768
ds_read_b64_tr_b16 a[138:139], v17 offset:34816
M v[80:83], a[64:67], a[168:171], 0
M v[80:83], a[68:71], a[172:175], v[80:83]
M v[84:87], a[76:79], a[172:175], 0
buffer_load_dwordx4 v9, s[12:15], s24 offen offset:3072 lds
M v[84:87], a[72:75], a[168:171], v[84:87]
ds_read_b64_tr_b16 a[144:145], v18 offset:32768
ds_read_b64_tr_b16 a[146:147], v18 offset:34816
M v[88:91], a[80:83], a[168:171], 0
M v[88:91], a[84:87], a[172:175], v[88:91]
M v[92:95], a[92:95], a[172:175], 0
M v[92:95], a[88:91], a[168:171], v[92:95]
s_waitcnt lgkmcnt(15)
ds_read_b64_tr_b16 a[152:153], v19 offset:32768
ds_read_b64_tr_b16 a[154:155], v19 offset:34816
M v[96:99], a[32:35], a[176:179], 0
s_add_u32 s24, s24, 262144
s_cmp_eq_u32 s24, s27
s_cselect_b32 s24, s28, s24
s_sub_u32 s6, s6, 1
s_cmp_eq_u32 s6, 0
s_cselect_b64 s[12:13], s[64:65], s[12:13]
M v[96:99], a[36:39], a[180:183], v[96:99]
M v[100:103], a[44:47], a[180:183], 0
M v[100:103], a[40:43], a[176:179], v[100:103]
M v[104:107], a[48:51], a[176:179], 0
M v[104:107], a[52:55], a[180:183], v[104:107]
M v[108:111], a[60:63], a[180:183], 0
M v[108:111], a[56:59], a[176:179], v[108:111]
s_waitcnt vmcnt(17) lgkmcnt(0)
s_barrier
ds_read_b128 a[160:163], v10 offset:16384
ds_read_b128 a[164:167], v11 offset:16384
M v[112:115], a[64:67], a[176:179], 0
s_add_u32 m0, s29, 0
s_nop 0
buffer_load_dwordx4 v2, s[8:11], s23 offen offset:0 lds
M v[112:115], a[68:71], a[180:183], v[112:115]
M v[116:119], a[76:79], a[180:183], 0
M v[116:119], a[72:75], a[176:179], v[116:119]
ds_read_b64_tr_b16 a[100:101], v12 offset:49152
ds_read_b64_tr_b16 a[102:103], v12 offset:51200
M v[120:123], a[80:83], a[176:179], 0
M v[120:123], a[84:87], a[180:183], v[120:123]
buffer_load_dwordx4 v3, s[8:11], s23 offen offset:1024 lds
M v[124:127], a[92:95], a[180:183], 0
M v[124:127], a[88:91], a[176:179], v[124:127]
M v[128:131], a[32:35], a[184:187], 0
M v[128:131], a[36:39], a[188:191], v[128:131]
ds_read_b128 a[168:171], v10 offset:18432
ds_read_b128 a[172:175], v11 offset:18432
ds_read_b64_tr_b16 a[108:109], v13 offset:49152
ds_read_b64_tr_b16 a[110:111], v13 offset:51200
M v[132:135], a[44:47], a[188:191], 0
M v[132:135], a[40:43], a[184:187], v[132:135]
M v[136:139], a[48:51], a[184:187], 0
buffer_load_dwordx4 v4, s[8:11], s23 offen offset:2048 lds
M v[136:139], a[52:55], a[188:191], v[136:139]
M v[140:143], a[60:63], a[188:191], 0
M v[140:143], a[56:59], a[184:187], v[140:143]
ds_read_b64_tr_b16 a[116:117], v14 offset:49152
ds_read_b64_tr_b16 a[118:119], v14 offset:51200
M v[144:147], a[64:67], a[184:187], 0
M v[144:147], a[68:71], a[188:191], v[144:147]
M v[148:151], a[76:79], a[188:191], 0
buffer_load_dwordx4 v5, s[8:11], s23 offen offset:3072 lds
M v[148:151], a[72:75], a[184:187], v[148:151]
M v[152:155], a[80:83], a[184:187], 0
M v[152:155], a[84:87], a[188:191], v[152:155]
ds_read_b64_tr_b16 a[124:125], v15 offset:49152
ds_read_b64_tr_b16 a[126:127], v15 offset:51200
M v[156:159], a[92:95], a[188:191], 0
M v[156:159], a[88:91], a[184:187], v[156:159]
s_waitcnt lgkmcnt(10)
M v[160:163], a[32:35], a[160:163], 0
M v[160:163], a[36:39], a[164:167], v[160:163]
ds_read_b128 a[176:179], v10 offset:20480
ds_read_b128 a[180:183], v11 offset:20480
M v[164:167], a[44:47], a[164:167], 0
s_add_u32 m0, s29, 98304
s_nop 0
buffer_load_dwordx4 v6, s[12:15], s24 offen offset:0 lds
M v[164:167], a[40:43], a[160:163], v[164:167]
ds_read_b64_tr_b16 a[132:133], v16 offset:49152
ds_read_b64_tr_b16 a[134:135], v16 offset:51200
M v[168:171], a[48:51], a[160:163], 0
M v[168:171], a[52:55], a[164:167], v[168:171]
M v[172:175], a[60:63], a[164:167], 0
M v[172:175], a[56:59], a[160:163], v[172:175]
M v[176:179], a[64:67], a[160:163], 0
buffer_load_dwordx4 v7, s[12:15], s24 offen offset:1024 lds
M v[176:179], a[68:71], a[164:167], v[176:179]
ds_read_b64_tr_b16 a[140:141], v17 offset:49152
ds_read_b64_tr_b16 a[142:143], v17 offset:51200
M v[180:183], a[76:79], a[164:167], 0
M v[180:183], a[72:75], a[160:163], v[180:183]
M v[184:187], a[80:83], a[160:163], 0
M v[184:187], a[84:87], a[164:167], v[184:187]
buffer_load_dwordx4 v8, s[12:15], s24 offen offset:2048 lds
M v[188:191], a[92:95], a[164:167], 0
M v[188:191], a[88:91], a[160:163], v[188:191]
s_waitcnt lgkmcnt(12)
ds_read_b64_tr_b16 a[148:149], v18 offset:49152
ds_read_b64_tr_b16 a[150:151], v18 offset:51200
M v[192:195], a[32:35], a[168:171], 0
M v[192:195], a[36:39], a[172:175], v[192:195]
ds_read_b128 a[184:187], v10 offset:22528
ds_read_b128 a[188:191], v11 offset:22528
M v[196:199], a[44:47], a[172:175], 0
M v[196:199], a[40:43], a[168:171], v[196:199]
M v[200:203], a[48:51], a[168:171], 0
buffer_load_dwordx4 v9, s[12:15], s24 offen offset:3072 lds
M v[200:203], a[52:55], a[172:175], v[200:203]
ds_read_b64_tr_b16 a[156:157], v19 offset:49152
ds_read_b64_tr_b16 a[158:159], v19 offset:51200
M v[204:207], a[60:63], a[172:175], 0
M v[204:207], a[56:59], a[168:171], v[204:207]
M v[208:211], a[64:67], a[168:171], 0
M v[208:211], a[68:71], a[172:175], v[208:211]
M v[212:215], a[76:79], a[172:175], 0
s_add_u32 s24, s24, 262144
M v[212:215], a[72:75], a[168:171], v[212:215]
M v[216:219], a[80:83], a[168:171], 0
M v[216:219], a[84:87], a[172:175], v[216:219]
M v[220:223], a[92:95], a[172:175], 0
M v[220:223], a[88:91], a[168:171], v[220:223]
s_waitcnt lgkmcnt(10)
M v[224:227], a[32:35], a[176:179], 0
buffer_load_dword v21, v20, s[60:63], s54 offen
s_add_u32 s54, s54, 1048576
M v[224:227], a[36:39], a[180:183], v[224:227]
M v[228:231], a[44:47], a[180:183], 0
M v[228:231], a[40:43], a[176:179], v[228:231]
M v[232:235], a[48:51], a[176:179], 0
M v[232:235], a[52:55], a[180:183], v[232:235]
M v[236:239], a[60:63], a[180:183], 0
M v[236:239], a[56:59], a[176:179], v[236:239]
s_waitcnt vmcnt(17) lgkmcnt(0)
s_barrier
ds_read_b128 a[160:163], v10 offset:32768
ds_read_b128 a[164:167], v11 offset:32768
M v[240:243], a[64:67], a[176:179], 0
s_add_u32 m0, s29, 16384
s_add_u32 s3, s23, s31
buffer_load_dwordx4 v2, s[8:11], s3 offen offset:0 lds
M v[240:243], a[68:71], a[180:183], v[240:243]
M v[244:247], a[76:79], a[180:183], 0
M v[244:247], a[72:75], a[176:179], v[244:247]
M v[248:251], a[80:83], a[176:179], 0
M v[248:251], a[84:87], a[180:183], v[248:251]
buffer_load_dwordx4 v3, s[8:11], s3 offen offset:1024 lds
M v[252:255], a[92:95], a[180:183], 0
M v[252:255], a[88:91], a[176:179], v[252:255]
M a[0:3], a[32:35], a[184:187], 0
M a[0:3], a[36:39], a[188:191], a[0:3]
ds_read_b128 a[168:171], v10 offset:34816
ds_read_b128 a[172:175], v11 offset:34816
M a[4:7], a[44:47], a[188:191], 0
M a[4:7], a[40:43], a[184:187], a[4:7]
M a[8:11], a[48:51], a[184:187], 0
buffer_load_dwordx4 v4, s[8:11], s3 offen offset:2048 lds
M a[8:11], a[52:55], a[188:191], a[8:11]
M a[12:15], a[60:63], a[188:191], 0
M a[12:15], a[56:59], a[184:187], a[12:15]
M a[16:19], a[64:67], a[184:187], 0
M a[16:19], a[68:71], a[188:191], a[16:19]
buffer_load_dwordx4 v5, s[8:11], s3 offen offset:3072 lds
M a[20:23], a[76:79], a[188:191], 0
M a[20:23], a[72:75], a[184:187], a[20:23]
M a[24:27], a[80:83], a[184:187], 0
M a[24:27], a[84:87], a[188:191], a[24:27]
M a[28:31], a[92:95], a[188:191], 0
M a[28:31], a[88:91], a[184:187], a[28:31]
s_waitcnt lgkmcnt(2)
M v[32:35], a[96:99], a[160:163], v[32:35]
s_add_u32 s23, s23, 128
s_cmp_eq_u32 s23, s25
s_cselect_b32 s23, s26, s23
M v[32:35], a[100:103], a[164:167], v[32:35]
ds_read_b128 a[176:179], v10 offset:36864
ds_read_b128 a[180:183], v11 offset:36864
M v[36:39], a[108:111], a[164:167], v[36:39]
M v[36:39], a[104:107], a[160:163], v[36:39]
ds_read_b64_tr_b16 a[32:33], v12 offset:0
ds_read_b64_tr_b16 a[34:35], v12 offset:2048
M v[40:43], a[112:115], a[160:163], v[40:43]
M v[40:43], a[116:119], a[164:167], v[40:43]
M v[44:47], a[124:127], a[164:167], v[44:47]
s_add_u32 m0, s29, 114688
s_nop 0
buffer_load_dwordx4 v6, s[12:15], s24 offen offset:0 lds
M v[44:47], a[120:123], a[160:163], v[44:47]
ds_read_b64_tr_b16 a[40:41], v13 offset:0
ds_read_b64_tr_b16 a[42:43], v13 offset:2048
M v[48:51], a[128:131], a[160:163], v[48:51]
M v[48:51], a[132:135], a[164:167], v[48:51]
M v[52:55], a[140:143], a[164:167], v[52:55]
M v[52:55], a[136:139], a[160:163], v[52:55]
ds_read_b64_tr_b16 a[48:49], v14 offset:0
ds_read_b64_tr_b16 a[50:51], v14 offset:2048
M v[56:59], a[144:147], a[160:163], v[56:59]
M v[56:59], a[148:151], a[164:167], v[56:59]
buffer_load_dwordx4 v7, s[12:15], s24 offen offset:1024 lds
M v[60:63], a[156:159], a[164:167], v[60:63]
M v[60:63], a[152:155], a[160:163], v[60:63]
s_waitcnt lgkmcnt(8)
ds_read_b64_tr_b16 a[56:57], v15 offset:0
ds_read_b64_tr_b16 a[58:59], v15 offset:2048
M v[64:67], a[96:99], a[168:171], v[64:67]
M v[64:67], a[100:103], a[172:175], v[64:67]
ds_read_b128 a[184:187], v10 offset:38912
ds_read_b128 a[188:191], v11 offset:38912
M v[68:71], a[108:111], a[172:175], v[68:71]
M v[68:71], a[104:107], a[168:171], v[68:71]
ds_read_b64_tr_b16 a[64:65], v16 offset:0
ds_read_b64_tr_b16 a[66:67], v16 offset:2048
M v[72:75], a[112:115], a[168:171], v[72:75]
buffer_load_dwordx4 v8, s[12:15], s24 offen offset:2048 lds
M v[72:75], a[116:119], a[172:175], v[72:75]
M v[76:79], a[124:127], a[172:175], v[76:79]
M v[76:79], a[120:123], a[168:171], v[76:79]
ds_read_b64_tr_b16 a[72:73], v17 offset:0
ds_read_b64_tr_b16 a[74:75], v17 offset:2048
M v[80:83], a[128:131], a[168:171], v[80:83]
M v[80:83], a[132:135], a[172:175], v[80:83]
M v[84:87], a[140:143], a[172:175], v[84:87]
buffer_load_dwordx4 v9, s[12:15], s24 offen offset:3072 lds
M v[84:87], a[136:139], a[168:171], v[84:87]
ds_read_b64_tr_b16 a[80:81], v18 offset:0
ds_read_b64_tr_b16 a[82:83], v18 offset:2048
M v[88:91], a[144:147], a[168:171], v[88:91]
M v[88:91], a[148:151], a[172:175], v[88:91]
M v[92:95], a[156:159], a[172:175], v[92:95]
M v[92:95], a[152:155], a[168:171], v[92:95]
s_waitcnt lgkmcnt(15)
ds_read_b64_tr_b16 a[88:89], v19 offset:0
ds_read_b64_tr_b16 a[90:91], v19 offset:2048
M v[96:99], a[96:99], a[176:179], v[96:99]
s_add_u32 s24, s24, 262144
s_cmp_eq_u32 s24, s27
s_cselect_b32 s24, s28, s24
s_sub_u32 s6, s6, 1
s_cmp_eq_u32 s6, 0
s_cselect_b64 s[12:13], s[64:65], s[12:13]
M v[96:99], a[100:103], a[180:183], v[96:99]
M v[100:103], a[108:111], a[180:183], v[100:103]
M v[100:103], a[104:107], a[176:179], v[100:103]
M v[104:107], a[112:115], a[176:179], v[104:107]
M v[104:107], a[116:119], a[180:183], v[104:107]
M v[108:111], a[124:127], a[180:183], v[108:111]
M v[108:111], a[120:123], a[176:179], v[108:111]
s_waitcnt vmcnt(17) lgkmcnt(0)
s_barrier
ds_read_b128 a[160:163], v10 offset:49152
ds_read_b128 a[164:167], v11 offset:49152
M v[112:115], a[128:131], a[176:179], v[112:115]
s_add_u32 m0, s29, 32768
s_nop 0
buffer_load_dwordx4 v2, s[8:11], s23 offen offset:0 lds
M v[112:115], a[132:135], a[180:183], v[112:115]
M v[116:119], a[140:143], a[180:183], v[116:119]
M v[116:119], a[136:139], a[176:179], v[116:119]
ds_read_b64_tr_b16 a[36:37], v12 offset:16384
ds_read_b64_tr_b16 a[38:39], v12 offset:18432
M v[120:123], a[144:147], a[176:179], v[120:123]
M v[120:123], a[148:151], a[180:183], v[120:123]
buffer_load_dwordx4 v3, s[8:11], s23 offen offset:1024 lds
M v[124:127], a[156:159], a[180:183], v[124:127]
M v[124:127], a[152:155], a[176:179], v[124:127]
M v[128:131], a[96:99], a[184:187], v[128:131]
M v[128:131], a[100:103], a[188:191], v[128:131]
ds_read_b128 a[168:171], v10 offset:51200
ds_read_b128 a[172:175], v11 offset:51200
ds_read_b64_tr_b16 a[44:45], v13 offset:16384
ds_read_b64_tr_b16 a[46:47], v13 offset:18432
M v[132:135], a[108:111], a[188:191], v[132:135]
M v[132:135], a[104:107], a[184:187], v[132:135]
M v[136:139], a[112:115], a[184:187], v[136:139]
buffer_load_dwordx4 v4, s[8:11], s23 offen offset:2048 lds
M v[136:139], a[116:119], a[188:191], v[136:139]
M v[140:143], a[124:127], a[188:191], v[140:143]
M v[140:143], a[120:123], a[184:187], v[140:143]
ds_read_b64_tr_b16 a[52:53], v14 offset:16384
ds_read_b64_tr_b16 a[54:55], v14 offset:18432
M v[144:147], a[128:131], a[184:187], v[144:147]
M v[144:147], a[132:135], a[188:191], v[144:147]
M v[148:151], a[140:143], a[188:191], v[148:151]
buffer_load_dwordx4 v5, s[8:11], s23 offen offset:3072 lds
M v[148:151], a[136:139], a[184:187], v[148:151]
M v[152:155], a[144:147], a[184:187], v[152:155]
M v[152:155], a[148:151], a[188:191], v[152:155]
ds_read_b64_tr_b16 a[60:61], v15 offset:16384
ds_read_b64_tr_b16 a[62:63], v15 offset:18432
M v[156:159], a[156:159], a[188:191], v[156:159]
M v[156:159], a[152:155], a[184:187], v[156:159]
s_waitcnt lgkmcnt(10)
M v[160:163], a[96:99], a[160:163], v[160:163]
M v[160:163], a[100:103], a[164:167], v[160:163]
ds_read_b128 a[176:179], v10 offset:53248
ds_read_b128 a[180:183], v11 offset:53248
M v[164:167], a[108:111], a[164:167], v[164:167]
s_add_u32 m0, s29, 65536
s_nop 0
buffer_load_dwordx4 v6, s[12:15], s24 offen offset:0 lds
M v[164:167], a[104:107], a[160:163], v[164:167]
ds_read_b64_tr_b16 a[68:69], v16 offset:16384
ds_read_b64_tr_b16 a[70:71], v16 offset:18432
M v[168:171], a[112:115], a[160:163], v[168:171]
M v[168:171], a[116:119], a[164:167], v[168:171]
M v[172:175], a[124:127], a[164:167], v[172:175]
M v[172:175], a[120:123], a[160:163], v[172:175]
M v[176:179], a[128:131], a[160:163], v[176:179]
buffer_load_dwordx4 v7, s[12:15], s24 offen offset:1024 lds
M v[176:179], a[132:135], a[164:167], v[176:179]
ds_read_b64_tr_b16 a[76:77], v17 offset:16384
ds_read_b64_tr_b16 a[78:79], v17 offset:18432
M v[180:183], a[140:143], a[164:167], v[180:183]
M v[180:183], a[136:139], a[160:163], v[180:183]
M v[184:187], a[144:147], a[160:163], v[184:187]
M v[184:187], a[148:151], a[164:167], v[184:187]
buffer_load_dwordx4 v8, s[12:15], s24 offen offset:2048 lds
M v[188:191], a[156:159], a[164:167], v[188:191]
M v[188:191], a[152:155], a[160:163], v[188:191]
s_waitcnt lgkmcnt(12)
ds_read_b64_tr_b16 a[84:85], v18 offset:16384
ds_read_b64_tr_b16 a[86:87], v18 offset:18432
M v[192:195], a[96:99], a[168:171], v[192:195]
M v[192:195], a[100:103], a[172:175], v[192:195]
ds_read_b128 a[184:187], v10 offset:55296
ds_read_b128 a[188:191], v11 offset:55296
M v[196:199], a[108:111], a[172:175], v[196:199]
M v[196:199], a[104:107], a[168:171], v[196:199]
M v[200:203], a[112:115], a[168:171], v[200:203]
buffer_load_dwordx4 v9, s[12:15], s24 offen offset:3072 lds
M v[200:203], a[116:119], a[172:175], v[200:203]
ds_read_b64_tr_b16 a[92:93], v19 offset:16384
ds_read_b64_tr_b16 a[94:95], v19 offset:18432
M v[204:207], a[124:127], a[172:175], v[204:207]
M v[204:207], a[120:123], a[168:171], v[204:207]
M v[208:211], a[128:131], a[168:171], v[208:211]
M v[208:211], a[132:135], a[172:175], v[208:211]
M v[212:215], a[140:143], a[172:175], v[212:215]
s_add_u32 s24, s24, 262144
M v[212:215], a[136:139], a[168:171], v[212:215]
M v[216:219], a[144:147], a[168:171], v[216:219]
M v[216:219], a[148:151], a[172:175], v[216:219]
M v[220:223], a[156:159], a[172:175], v[220:223]
M v[220:223], a[152:155], a[168:171], v[220:223]
s_waitcnt lgkmcnt(10)
M v[224:227], a[96:99], a[176:179], v[224:227]
buffer_load_dword v21, v20, s[60:63], s54 offen
s_add_u32 s54, s54, 1048576
M v[224:227], a[100:103], a[180:183], v[224:227]
M v[228:231], a[108:111], a[180:183], v[228:231]
M v[228:231], a[104:107], a[176:179], v[228:231]
M v[232:235], a[112:115], a[176:179], v[232:235]
M v[232:235], a[116:119], a[180:183], v[232:235]
M v[236:239], a[124:127], a[180:183], v[236:239]
M v[236:239], a[120:123], a[176:179], v[236:239]
s_waitcnt vmcnt(18) lgkmcnt(0)
s_barrier
ds_read_b128 a[160:163], v10 offset:0
ds_read_b128 a[164:167], v11 offset:0
M v[240:243], a[128:131], a[176:179], v[240:243]
s_add_u32 m0, s29, 49152
s_add_u32 s3, s23, s31
buffer_load_dwordx4 v2, s[8:11], s3 offen offset:0 lds
M v[240:243], a[132:135], a[180:183], v[240:243]
M v[244:247], a[140:143], a[180:183], v[244:247]
M v[244:247], a[136:139], a[176:179], v[244:247]
M v[248:251], a[144:147], a[176:179], v[248:251]
M v[248:251], a[148:151], a[180:183], v[248:251]
buffer_load_dwordx4 v3, s[8:11], s3 offen offset:1024 lds
M v[252:255], a[156:159], a[180:183], v[252:255]
M v[252:255], a[152:155], a[176:179], v[252:255]
M a[0:3], a[96:99], a[184:187], a[0:3]
M a[0:3], a[100:103], a[188:191], a[0:3]
ds_read_b128 a[168:171], v10 offset:2048
ds_read_b128 a[172:175], v11 offset:2048
M a[4:7], a[108:111], a[188:191], a[4:7]
M a[4:7], a[104:107], a[184:187], a[4:7]
M a[8:11], a[112:115], a[184:187], a[8:11]
buffer_load_dwordx4 v4, s[8:11], s3 offen offset:2048 lds
M a[8:11], a[116:119], a[188:191], a[8:11]
M a[12:15], a[124:127], a[188:191], a[12:15]
M a[12:15], a[120:123], a[184:187], a[12:15]
M a[16:19], a[128:131], a[184:187], a[16:19]
M a[16:19], a[132:135], a[188:191], a[16:19]
buffer_load_dwordx4 v5, s[8:11], s3 offen offset:3072 lds
M a[20:23], a[140:143], a[188:191], a[20:23]
M a[20:23], a[136:139], a[184:187], a[20:23]
M a[24:27], a[144:147], a[184:187], a[24:27]
M a[24:27], a[148:151], a[188:191], a[24:27]
M a[28:31], a[156:159], a[188:191], a[28:31]
M a[28:31], a[152:155], a[184:187], a[28:31]
s_waitcnt lgkmcnt(2)
s_mov_b32 s30, 5
Lk1_ql:
M v[32:35], a[32:35], a[160:163], v[32:35]
s_add_u32 s23, s23, 128
s_cmp_eq_u32 s23, s25
s_cselect_b32 s23, s26, s23
M v[32:35], a[36:39], a[164:167], v[32:35]
ds_read_b128 a[176:179], v10 offset:4096
ds_read_b128 a[180:183], v11 offset:4096
M v[36:39], a[44:47], a[164:167], v[36:39]
M v[36:39], a[40:43], a[160:163], v[36:39]
ds_read_b64_tr_b16 a[96:97], v12 offset:32768
ds_read_b64_tr_b16 a[98:99], v12 offset:34816
M v[40:43], a[48:51], a[160:163], v[40:43]
M v[40:43], a[52:55], a[164:167], v[40:43]
M v[44:47], a[60:63], a[164:167], v[44:47]
s_add_u32 m0, s29, 81920
s_nop 0
buffer_load_dwordx4 v6, s[12:15], s24 offen offset:0 lds
M v[44:47], a[56:59], a[160:163], v[44:47]
ds_read_b64_tr_b16 a[104:105], v13 offset:32768
ds_read_b64_tr_b16 a[106:107], v13 offset:34816
M v[48:51], a[64:67], a[160:163], v[48:51]
M v[48:51], a[68:71], a[164:167], v[48:51]
M v[52:55], a[76:79], a[164:167], v[52:55]
M v[52:55], a[72:75], a[160:163], v[52:55]
ds_read_b64_tr_b16 a[112:113], v14 offset:32768
ds_read_b64_tr_b16 a[114:115], v14 offset:34816
M v[56:59], a[80:83], a[160:163], v[56:59]
M v[56:59], a[84:87], a[164:167], v[56:59]
buffer_load_dwordx4 v7, s[12:15], s24 offen offset:1024 lds
M v[60:63], a[92:95], a[164:167], v[60:63]
M v[60:63], a[88:91], a[160:163], v[60:63]
s_waitcnt lgkmcnt(8)
ds_read_b64_tr_b16 a[120:121], v15 offset:32768
ds_read_b64_tr_b16 a[122:123], v15 offset:34816
M v[64:67], a[32:35], a[168:171], v[64:67]
M v[64:67], a[36:39], a[172:175], v[64:67]
ds_read_b128 a[184:187], v10 offset:6144
ds_read_b128 a[188:191], v11 offset:6144
M v[68:71], a[44:47], a[172:175], v[68:71]
M v[68:71], a[40:43], a[168:171], v[68:71]
ds_read_b64_tr_b16 a[128:129], v16 offset:32768
ds_read_b64_tr_b16 a[130:131], v16 offset:34816
M v[72:75], a[48:51], a[168:171], v[72:75]
buffer_load_dwordx4 v8, s[12:15], s24 offen offset:2048 lds
M v[72:75], a[52:55], a[172:175], v[72:75]
M v[76:79], a[60:63], a[172:175], v[76:79]
M v[76:79], a[56:59], a[168:171], v[76:79]
ds_read_b64_tr_b16 a[136:137], v17 offset:32768
ds_read_b64_tr_b16 a[138:139], v17 offset:34816
M v[80:83], a[64:67], a[168:171], v[80:83]
M v[80:83], a[68:71], a[172:175], v[80:83]
M v[84:87], a[76:79], a[172:175], v[84:87]
buffer_load_dwordx4 v9, s[12:15], s24 offen offset:3072 lds
M v[84:87], a[72:75], a[168:171], v[84:87]
ds_read_b64_tr_b16 a[144:145], v18 offset:32768
ds_read_b64_tr_b16 a[146:147], v18 offset:34816
M v[88:91], a[80:83], a[168:171], v[88:91]
M v[88:91], a[84:87], a[172:175], v[88:91]
M v[92:95], a[92:95], a[172:175], v[92:95]
M v[92:95], a[88:91], a[168:171], v[92:95]
s_waitcnt lgkmcnt(15)
ds_read_b64_tr_b16 a[152:153], v19 offset:32768
ds_read_b64_tr_b16 a[154:155], v19 offset:34816
M v[96:99], a[32:35], a[176:179], v[96:99]
s_add_u32 s24, s24, 262144
s_cmp_eq_u32 s24, s27
s_cselect_b32 s24, s28, s24
s_sub_u32 s6, s6, 1
s_cmp_eq_u32 s6, 0
s_cselect_b64 s[12:13], s[64:65], s[12:13]
M v[96:99], a[36:39], a[180:183], v[96:99]
M v[100:103], a[44:47], a[180:183], v[100:103]
M v[100:103], a[40:43], a[176:179], v[100:103]
M v[104:107], a[48:51], a[176:179], v[104:107]
M v[104:107], a[52:55], a[180:183], v[104:107]
M v[108:111], a[60:63], a[180:183], v[108:111]
M v[108:111], a[56:59], a[176:179], v[108:111]
s_waitcnt vmcnt(17) lgkmcnt(0)
s_barrier
ds_read_b128 a[160:163], v10 offset:16384
ds_read_b128 a[164:167], v11 offset:16384
M v[112:115], a[64:67], a[176:179], v[112:115]
s_add_u32 m0, s29, 0
s_nop 0
buffer_load_dwordx4 v2, s[8:11], s23 offen offset:0 lds
M v[112:115], a[68:71], a[180:183], v[112:115]
M v[116:119], a[76:79], a[180:183], v[116:119]
M v[116:119], a[72:75], a[176:179], v[116:119]
ds_read_b64_tr_b16 a[100:101], v12 offset:49152
ds_read_b64_tr_b16 a[102:103], v12 offset:51200
M v[120:123], a[80:83], a[176:179], v[120:123]
M v[120:123], a[84:87], a[180:183], v[120:123]
buffer_load_dwordx4 v3, s[8:11], s23 offen offset:1024 lds
M v[124:127], a[92:95], a[180:183], v[124:127]
M v[124:127], a[88:91], a[176:179], v[124:127]
M v[128:131], a[32:35], a[184:187], v[128:131]
M v[128:131], a[36:39], a[188:191], v[128:131]
ds_read_b128 a[168:171], v10 offset:18432
ds_read_b128 a[172:175], v11 offset:18432
ds_read_b64_tr_b16 a[108:109], v13 offset:49152
ds_read_b64_tr_b16 a[110:111], v13 offset:51200
M v[132:135], a[44:47], a[188:191], v[132:135]
M v[132:135], a[40:43], a[184:187], v[132:135]
M v[136:139], a[48:51], a[184:187], v[136:139]
buffer_load_dwordx4 v4, s[8:11], s23 offen offset:2048 lds
M v[136:139], a[52:55], a[188:191], v[136:139]
M v[140:143], a[60:63], a[188:191], v[140:143]
M v[140:143], a[56:59], a[184:187], v[140:143]
ds_read_b64_tr_b16 a[116:117], v14 offset:49152
ds_read_b64_tr_b16 a[118:119], v14 offset:51200
M v[144:147], a[64:67], a[184:187], v[144:147]
M v[144:147], a[68:71], a[188:191], v[144:147]
M v[148:151], a[76:79], a[188:191], v[148:151]
buffer_load_dwordx4 v5, s[8:11], s23 offen offset:3072 lds
M v[148:151], a[72:75], a[184:187], v[148:151]
M v[152:155], a[80:83], a[184:187], v[152:155]
M v[152:155], a[84:87], a[188:191], v[152:155]
ds_read_b64_tr_b16 a[124:125], v15 offset:49152
ds_read_b64_tr_b16 a[126:127], v15 offset:51200
M v[156:159], a[92:95], a[188:191], v[156:159]
M v[156:159], a[88:91], a[184:187], v[156:159]
s_waitcnt lgkmcnt(10)
M v[160:163], a[32:35], a[160:163], v[160:163]
M v[160:163], a[36:39], a[164:167], v[160:163]
ds_read_b128 a[176:179], v10 offset:20480
ds_read_b128 a[180:183], v11 offset:20480
M v[164:167], a[44:47], a[164:167], v[164:167]
s_add_u32 m0, s29, 98304
s_nop 0
buffer_load_dwordx4 v6, s[12:15], s24 offen offset:0 lds
M v[164:167], a[40:43], a[160:163], v[164:167]
ds_read_b64_tr_b16 a[132:133], v16 offset:49152
ds_read_b64_tr_b16 a[134:135], v16 offset:51200
M v[168:171], a[48:51], a[160:163], v[168:171]
M v[168:171], a[52:55], a[164:167], v[168:171]
M v[172:175], a[60:63], a[164:167], v[172:175]
M v[172:175], a[56:59], a[160:163], v[172:175]
M v[176:179], a[64:67], a[160:163], v[176:179]
buffer_load_dwordx4 v7, s[12:15], s24 offen offset:1024 lds
M v[176:179], a[68:71], a[164:167], v[176:179]
ds_read_b64_tr_b16 a[140:141], v17 offset:49152
ds_read_b64_tr_b16 a[142:143], v17 offset:51200
M v[180:183], a[76:79], a[164:167], v[180:183]
M v[180:183], a[72:75], a[160:163], v[180:183]
M v[184:187], a[80:83], a[160:163], v[184:187]
M v[184:187], a[84:87], a[164:167], v[184:187]
buffer_load_dwordx4 v8, s[12:15], s24 offen offset:2048 lds
M v[188:191], a[92:95], a[164:167], v[188:191]
M v[188:191], a[88:91], a[160:163], v[188:191]
s_waitcnt lgkmcnt(12)
ds_read_b64_tr_b16 a[148:149], v18 offset:49152
ds_read_b64_tr_b16 a[150:151], v18 offset:51200
M v[192:195], a[32:35], a[168:171], v[192:195]
M v[192:195], a[36:39], a[172:175], v[192:195]
ds_read_b128 a[184:187], v10 offset:22528
ds_read_b128 a[188:191], v11 offset:22528
M v[196:199], a[44:47], a[172:175], v[196:199]
M v[196:199], a[40:43], a[168:171], v[196:199]
M v[200:203], a[48:51], a[168:171], v[200:203]
buffer_load_dwordx4 v9, s[12:15], s24 offen offset:3072 lds
M v[200:203], a[52:55], a[172:175], v[200:203]
ds_read_b64_tr_b16 a[156:157], v19 offset:49152
ds_read_b64_tr_b16 a[158:159], v19 offset:51200
M v[204:207], a[60:63], a[172:175], v[204:207]
M v[204:207], a[56:59], a[168:171], v[204:207]
M v[208:211], a[64:67], a[168:171], v[208:211]
M v[208:211], a[68:71], a[172:175], v[208:211]
M v[212:215], a[76:79], a[172:175], v[212:215]
s_add_u32 s24, s24, 262144
M v[212:215], a[72:75], a[168:171], v[212:215]
M v[216:219], a[80:83], a[168:171], v[216:219]
M v[216:219], a[84:87], a[172:175], v[216:219]
M v[220:223], a[92:95], a[172:175], v[220:223]
M v[220:223], a[88:91], a[168:171], v[220:223]
s_waitcnt lgkmcnt(10)
M v[224:227], a[32:35], a[176:179], v[224:227]
buffer_load_dword v21, v20, s[60:63], s54 offen
s_add_u32 s54, s54, 1048576
M v[224:227], a[36:39], a[180:183], v[224:227]
M v[228:231], a[44:47], a[180:183], v[228:231]
M v[228:231], a[40:43], a[176:179], v[228:231]
M v[232:235], a[48:51], a[176:179], v[232:235]
M v[232:235], a[52:55], a[180:183], v[232:235]
M v[236:239], a[60:63], a[180:183], v[236:239]
M v[236:239], a[56:59], a[176:179], v[236:239]
s_waitcnt vmcnt(18) lgkmcnt(0)
s_barrier
ds_read_b128 a[160:163], v10 offset:32768
ds_read_b128 a[164:167], v11 offset:32768
M v[240:243], a[64:67], a[176:179], v[240:243]
s_add_u32 m0, s29, 16384
s_add_u32 s3, s23, s31
buffer_load_dwordx4 v2, s[8:11], s3 offen offset:0 lds
M v[240:243], a[68:71], a[180:183], v[240:243]
M v[244:247], a[76:79], a[180:183], v[244:247]
M v[244:247], a[72:75], a[176:179], v[244:247]
M v[248:251], a[80:83], a[176:179], v[248:251]
M v[248:251], a[84:87], a[180:183], v[248:251]
buffer_load_dwordx4 v3, s[8:11], s3 offen offset:1024 lds
M v[252:255], a[92:95], a[180:183], v[252:255]
M v[252:255], a[88:91], a[176:179], v[252:255]
M a[0:3], a[32:35], a[184:187], a[0:3]
M a[0:3], a[36:39], a[188:191], a[0:3]
ds_read_b128 a[168:171], v10 offset:34816
ds_read_b128 a[172:175], v11 offset:34816
M a[4:7], a[44:47], a[188:191], a[4:7]
M a[4:7], a[40:43], a[184:187], a[4:7]
M a[8:11], a[48:51], a[184:187], a[8:11]
buffer_load_dwordx4 v4, s[8:11], s3 offen offset:2048 lds
M a[8:11], a[52:55], a[188:191], a[8:11]
M a[12:15], a[60:63], a[188:191], a[12:15]
M a[12:15], a[56:59], a[184:187], a[12:15]
M a[16:19], a[64:67], a[184:187], a[16:19]
M a[16:19], a[68:71], a[188:191], a[16:19]
buffer_load_dwordx4 v5, s[8:11], s3 offen offset:3072 lds
M a[20:23], a[76:79], a[188:191], a[20:23]
M a[20:23], a[72:75], a[184:187], a[20:23]
M a[24:27], a[80:83], a[184:187], a[24:27]
M a[24:27], a[84:87], a[188:191], a[24:27]
M a[28:31], a[92:95], a[188:191], a[28:31]
M a[28:31], a[88:91], a[184:187], a[28:31]
s_waitcnt lgkmcnt(2)
M v[32:35], a[96:99], a[160:163], v[32:35]
s_add_u32 s23, s23, 128
s_cmp_eq_u32 s23, s25
s_cselect_b32 s23, s26, s23
M v[32:35], a[100:103], a[164:167], v[32:35]
ds_read_b128 a[176:179], v10 offset:36864
ds_read_b128 a[180:183], v11 offset:36864
M v[36:39], a[108:111], a[164:167], v[36:39]
M v[36:39], a[104:107], a[160:163], v[36:39]
ds_read_b64_tr_b16 a[32:33], v12 offset:0
ds_read_b64_tr_b16 a[34:35], v12 offset:2048
M v[40:43], a[112:115], a[160:163], v[40:43]
M v[40:43], a[116:119], a[164:167], v[40:43]
M v[44:47], a[124:127], a[164:167], v[44:47]
s_add_u32 m0, s29, 114688
s_nop 0
buffer_load_dwordx4 v6, s[12:15], s24 offen offset:0 lds
M v[44:47], a[120:123], a[160:163], v[44:47]
ds_read_b64_tr_b16 a[40:41], v13 offset:0
ds_read_b64_tr_b16 a[42:43], v13 offset:2048
M v[48:51], a[128:131], a[160:163], v[48:51]
M v[48:51], a[132:135], a[164:167], v[48:51]
M v[52:55], a[140:143], a[164:167], v[52:55]
M v[52:55], a[136:139], a[160:163], v[52:55]
ds_read_b64_tr_b16 a[48:49], v14 offset:0
ds_read_b64_tr_b16 a[50:51], v14 offset:2048
M v[56:59], a[144:147], a[160:163], v[56:59]
M v[56:59], a[148:151], a[164:167], v[56:59]
buffer_load_dwordx4 v7, s[12:15], s24 offen offset:1024 lds
M v[60:63], a[156:159], a[164:167], v[60:63]
M v[60:63], a[152:155], a[160:163], v[60:63]
s_waitcnt lgkmcnt(8)
ds_read_b64_tr_b16 a[56:57], v15 offset:0
ds_read_b64_tr_b16 a[58:59], v15 offset:2048
M v[64:67], a[96:99], a[168:171], v[64:67]
M v[64:67], a[100:103], a[172:175], v[64:67]
ds_read_b128 a[184:187], v10 offset:38912
ds_read_b128 a[188:191], v11 offset:38912
M v[68:71], a[108:111], a[172:175], v[68:71]
M v[68:71], a[104:107], a[168:171], v[68:71]
ds_read_b64_tr_b16 a[64:65], v16 offset:0
ds_read_b64_tr_b16 a[66:67], v16 offset:2048
M v[72:75], a[112:115], a[168:171], v[72:75]
buffer_load_dwordx4 v8, s[12:15], s24 offen offset:2048 lds
M v[72:75], a[116:119], a[172:175], v[72:75]
M v[76:79], a[124:127], a[172:175], v[76:79]
M v[76:79], a[120:123], a[168:171], v[76:79]
ds_read_b64_tr_b16 a[72:73], v17 offset:0
ds_read_b64_tr_b16 a[74:75], v17 offset:2048
M v[80:83], a[128:131], a[168:171], v[80:83]
M v[80:83], a[132:135], a[172:175], v[80:83]
M v[84:87], a[140:143], a[172:175], v[84:87]
buffer_load_dwordx4 v9, s[12:15], s24 offen offset:3072 lds
M v[84:87], a[136:139], a[168:171], v[84:87]
ds_read_b64_tr_b16 a[80:81], v18 offset:0
ds_read_b64_tr_b16 a[82:83], v18 offset:2048
M v[88:91], a[144:147], a[168:171], v[88:91]
M v[88:91], a[148:151], a[172:175], v[88:91]
M v[92:95], a[156:159], a[172:175], v[92:95]
M v[92:95], a[152:155], a[168:171], v[92:95]
s_waitcnt lgkmcnt(15)
ds_read_b64_tr_b16 a[88:89], v19 offset:0
ds_read_b64_tr_b16 a[90:91], v19 offset:2048
M v[96:99], a[96:99], a[176:179], v[96:99]
s_add_u32 s24, s24, 262144
s_cmp_eq_u32 s24, s27
s_cselect_b32 s24, s28, s24
s_sub_u32 s6, s6, 1
s_cmp_eq_u32 s6, 0
s_cselect_b64 s[12:13], s[64:65], s[12:13]
M v[96:99], a[100:103], a[180:183], v[96:99]
M v[100:103], a[108:111], a[180:183], v[100:103]
M v[100:103], a[104:107], a[176:179], v[100:103]
M v[104:107], a[112:115], a[176:179], v[104:107]
M v[104:107], a[116:119], a[180:183], v[104:107]
M v[108:111], a[124:127], a[180:183], v[108:111]
M v[108:111], a[120:123], a[176:179], v[108:111]
s_waitcnt vmcnt(17) lgkmcnt(0)
s_barrier
ds_read_b128 a[160:163], v10 offset:49152
ds_read_b128 a[164:167], v11 offset:49152
M v[112:115], a[128:131], a[176:179], v[112:115]
s_add_u32 m0, s29, 32768
s_nop 0
buffer_load_dwordx4 v2, s[8:11], s23 offen offset:0 lds
M v[112:115], a[132:135], a[180:183], v[112:115]
M v[116:119], a[140:143], a[180:183], v[116:119]
M v[116:119], a[136:139], a[176:179], v[116:119]
ds_read_b64_tr_b16 a[36:37], v12 offset:16384
ds_read_b64_tr_b16 a[38:39], v12 offset:18432
M v[120:123], a[144:147], a[176:179], v[120:123]
M v[120:123], a[148:151], a[180:183], v[120:123]
buffer_load_dwordx4 v3, s[8:11], s23 offen offset:1024 lds
M v[124:127], a[156:159], a[180:183], v[124:127]
M v[124:127], a[152:155], a[176:179], v[124:127]
M v[128:131], a[96:99], a[184:187], v[128:131]
M v[128:131], a[100:103], a[188:191], v[128:131]
ds_read_b128 a[168:171], v10 offset:51200
ds_read_b128 a[172:175], v11 offset:51200
ds_read_b64_tr_b16 a[44:45], v13 offset:16384
ds_read_b64_tr_b16 a[46:47], v13 offset:18432
M v[132:135], a[108:111], a[188:191], v[132:135]
M v[132:135], a[104:107], a[184:187], v[132:135]
M v[136:139], a[112:115], a[184:187], v[136:139]
buffer_load_dwordx4 v4, s[8:11], s23 offen offset:2048 lds
M v[136:139], a[116:119], a[188:191], v[136:139]
M v[140:143], a[124:127], a[188:191], v[140:143]
M v[140:143], a[120:123], a[184:187], v[140:143]
ds_read_b64_tr_b16 a[52:53], v14 offset:16384
ds_read_b64_tr_b16 a[54:55], v14 offset:18432
M v[144:147], a[128:131], a[184:187], v[144:147]
M v[144:147], a[132:135], a[188:191], v[144:147]
M v[148:151], a[140:143], a[188:191], v[148:151]
buffer_load_dwordx4 v5, s[8:11], s23 offen offset:3072 lds
M v[148:151], a[136:139], a[184:187], v[148:151]
M v[152:155], a[144:147], a[184:187], v[152:155]
M v[152:155], a[148:151], a[188:191], v[152:155]
ds_read_b64_tr_b16 a[60:61], v15 offset:16384
ds_read_b64_tr_b16 a[62:63], v15 offset:18432
M v[156:159], a[156:159], a[188:191], v[156:159]
M v[156:159], a[152:155], a[184:187], v[156:159]
s_waitcnt lgkmcnt(10)
M v[160:163], a[96:99], a[160:163], v[160:163]
M v[160:163], a[100:103], a[164:167], v[160:163]
ds_read_b128 a[176:179], v10 offset:53248
ds_read_b128 a[180:183], v11 offset:53248
M v[164:167], a[108:111], a[164:167], v[164:167]
s_add_u32 m0, s29, 65536
s_nop 0
buffer_load_dwordx4 v6, s[12:15], s24 offen offset:0 lds
M v[164:167], a[104:107], a[160:163], v[164:167]
ds_read_b64_tr_b16 a[68:69], v16 offset:16384
ds_read_b64_tr_b16 a[70:71], v16 offset:18432
M v[168:171], a[112:115], a[160:163], v[168:171]
M v[168:171], a[116:119], a[164:167], v[168:171]
M v[172:175], a[124:127], a[164:167], v[172:175]
M v[172:175], a[120:123], a[160:163], v[172:175]
M v[176:179], a[128:131], a[160:163], v[176:179]
buffer_load_dwordx4 v7, s[12:15], s24 offen offset:1024 lds
M v[176:179], a[132:135], a[164:167], v[176:179]
ds_read_b64_tr_b16 a[76:77], v17 offset:16384
ds_read_b64_tr_b16 a[78:79], v17 offset:18432
M v[180:183], a[140:143], a[164:167], v[180:183]
M v[180:183], a[136:139], a[160:163], v[180:183]
M v[184:187], a[144:147], a[160:163], v[184:187]
M v[184:187], a[148:151], a[164:167], v[184:187]
buffer_load_dwordx4 v8, s[12:15], s24 offen offset:2048 lds
M v[188:191], a[156:159], a[164:167], v[188:191]
M v[188:191], a[152:155], a[160:163], v[188:191]
s_waitcnt lgkmcnt(12)
ds_read_b64_tr_b16 a[84:85], v18 offset:16384
ds_read_b64_tr_b16 a[86:87], v18 offset:18432
M v[192:195], a[96:99], a[168:171], v[192:195]
M v[192:195], a[100:103], a[172:175], v[192:195]
ds_read_b128 a[184:187], v10 offset:55296
ds_read_b128 a[188:191], v11 offset:55296
M v[196:199], a[108:111], a[172:175], v[196:199]
M v[196:199], a[104:107], a[168:171], v[196:199]
M v[200:203], a[112:115], a[168:171], v[200:203]
buffer_load_dwordx4 v9, s[12:15], s24 offen offset:3072 lds
M v[200:203], a[116:119], a[172:175], v[200:203]
ds_read_b64_tr_b16 a[92:93], v19 offset:16384
ds_read_b64_tr_b16 a[94:95], v19 offset:18432
M v[204:207], a[124:127], a[172:175], v[204:207]
M v[204:207], a[120:123], a[168:171], v[204:207]
M v[208:211], a[128:131], a[168:171], v[208:211]
M v[208:211], a[132:135], a[172:175], v[208:211]
M v[212:215], a[140:143], a[172:175], v[212:215]
s_add_u32 s24, s24, 262144
M v[212:215], a[136:139], a[168:171], v[212:215]
M v[216:219], a[144:147], a[168:171], v[216:219]
M v[216:219], a[148:151], a[172:175], v[216:219]
M v[220:223], a[156:159], a[172:175], v[220:223]
M v[220:223], a[152:155], a[168:171], v[220:223]
s_waitcnt lgkmcnt(10)
M v[224:227], a[96:99], a[176:179], v[224:227]
buffer_load_dword v21, v20, s[60:63], s54 offen
s_add_u32 s54, s54, 1048576
M v[224:227], a[100:103], a[180:183], v[224:227]
M v[228:231], a[108:111], a[180:183], v[228:231]
M v[228:231], a[104:107], a[176:179], v[228:231]
M v[232:235], a[112:115], a[176:179], v[232:235]
M v[232:235], a[116:119], a[180:183], v[232:235]
M v[236:239], a[124:127], a[180:183], v[236:239]
M v[236:239], a[120:123], a[176:179], v[236:239]
s_waitcnt vmcnt(18) lgkmcnt(0)
s_barrier
ds_read_b128 a[160:163], v10 offset:0
ds_read_b128 a[164:167], v11 offset:0
M v[240:243], a[128:131], a[176:179], v[240:243]
s_add_u32 m0, s29, 49152
s_add_u32 s3, s23, s31
buffer_load_dwordx4 v2, s[8:11], s3 offen offset:0 lds
M v[240:243], a[132:135], a[180:183], v[240:243]
M v[244:247], a[140:143], a[180:183], v[244:247]
M v[244:247], a[136:139], a[176:179], v[244:247]
M v[248:251], a[144:147], a[176:179], v[248:251]
M v[248:251], a[148:151], a[180:183], v[248:251]
buffer_load_dwordx4 v3, s[8:11], s3 offen offset:1024 lds
M v[252:255], a[156:159], a[180:183], v[252:255]
M v[252:255], a[152:155], a[176:179], v[252:255]
M a[0:3], a[96:99], a[184:187], a[0:3]
M a[0:3], a[100:103], a[188:191], a[0:3]
ds_read_b128 a[168:171], v10 offset:2048
ds_read_b128 a[172:175], v11 offset:2048
M a[4:7], a[108:111], a[188:191], a[4:7]
M a[4:7], a[104:107], a[184:187], a[4:7]
M a[8:11], a[112:115], a[184:187], a[8:11]
buffer_load_dwordx4 v4, s[8:11], s3 offen offset:2048 lds
M a[8:11], a[116:119], a[188:191], a[8:11]
M a[12:15], a[124:127], a[188:191], a[12:15]
M a[12:15], a[120:123], a[184:187], a[12:15]
M a[16:19], a[128:131], a[184:187], a[16:19]
M a[16:19], a[132:135], a[188:191], a[16:19]
buffer_load_dwordx4 v5, s[8:11], s3 offen offset:3072 lds
M a[20:23], a[140:143], a[188:191], a[20:23]
M a[20:23], a[136:139], a[184:187], a[20:23]
M a[24:27], a[144:147], a[184:187], a[24:27]
M a[24:27], a[148:151], a[188:191], a[24:27]
M a[28:31], a[156:159], a[188:191], a[28:31]
M a[28:31], a[152:155], a[184:187], a[28:31]
s_waitcnt lgkmcnt(2)
s_sub_u32 s30, s30, 1
s_cmp_lg_u32 s30, 0
s_cbranch_scc1 Lk1_ql
M v[32:35], a[32:35], a[160:163], v[32:35]
s_add_u32 s23, s23, 128
s_cmp_eq_u32 s23, s25
s_cselect_b32 s23, s26, s23
M v[32:35], a[36:39], a[164:167], v[32:35]
ds_read_b128 a[176:179], v10 offset:4096
ds_read_b128 a[180:183], v11 offset:4096
M v[36:39], a[44:47], a[164:167], v[36:39]
M v[36:39], a[40:43], a[160:163], v[36:39]
ds_read_b64_tr_b16 a[96:97], v12 offset:32768
ds_read_b64_tr_b16 a[98:99], v12 offset:34816
M v[40:43], a[48:51], a[160:163], v[40:43]
M v[40:43], a[52:55], a[164:167], v[40:43]
M v[44:47], a[60:63], a[164:167], v[44:47]
s_add_u32 m0, s29, 81920
s_nop 0
buffer_load_dwordx4 v6, s[12:15], s24 offen offset:0 lds
M v[44:47], a[56:59], a[160:163], v[44:47]
ds_read_b64_tr_b16 a[104:105], v13 offset:32768
ds_read_b64_tr_b16 a[106:107], v13 offset:34816
M v[48:51], a[64:67], a[160:163], v[48:51]
M v[48:51], a[68:71], a[164:167], v[48:51]
M v[52:55], a[76:79], a[164:167], v[52:55]
M v[52:55], a[72:75], a[160:163], v[52:55]
ds_read_b64_tr_b16 a[112:113], v14 offset:32768
ds_read_b64_tr_b16 a[114:115], v14 offset:34816
M v[56:59], a[80:83], a[160:163], v[56:59]
M v[56:59], a[84:87], a[164:167], v[56:59]
buffer_load_dwordx4 v7, s[12:15], s24 offen offset:1024 lds
M v[60:63], a[92:95], a[164:167], v[60:63]
M v[60:63], a[88:91], a[160:163], v[60:63]
s_waitcnt lgkmcnt(8)
ds_read_b64_tr_b16 a[120:121], v15 offset:32768
ds_read_b64_tr_b16 a[122:123], v15 offset:34816
M v[64:67], a[32:35], a[168:171], v[64:67]
M v[64:67], a[36:39], a[172:175], v[64:67]
ds_read_b128 a[184:187], v10 offset:6144
ds_read_b128 a[188:191], v11 offset:6144
M v[68:71], a[44:47], a[172:175], v[68:71]
M v[68:71], a[40:43], a[168:171], v[68:71]
ds_read_b64_tr_b16 a[128:129], v16 offset:32768
ds_read_b64_tr_b16 a[130:131], v16 offset:34816
M v[72:75], a[48:51], a[168:171], v[72:75]
buffer_load_dwordx4 v8, s[12:15], s24 offen offset:2048 lds
M v[72:75], a[52:55], a[172:175], v[72:75]
M v[76:79], a[60:63], a[172:175], v[76:79]
M v[76:79], a[56:59], a[168:171], v[76:79]
ds_read_b64_tr_b16 a[136:137], v17 offset:32768
ds_read_b64_tr_b16 a[138:139], v17 offset:34816
M v[80:83], a[64:67], a[168:171], v[80:83]
M v[80:83], a[68:71], a[172:175], v[80:83]
M v[84:87], a[76:79], a[172:175], v[84:87]
buffer_load_dwordx4 v9, s[12:15], s24 offen offset:3072 lds
M v[84:87], a[72:75], a[168:171], v[84:87]
ds_read_b64_tr_b16 a[144:145], v18 offset:32768
ds_read_b64_tr_b16 a[146:147], v18 offset:34816
M v[88:91], a[80:83], a[168:171], v[88:91]
M v[88:91], a[84:87], a[172:175], v[88:91]
M v[92:95], a[92:95], a[172:175], v[92:95]
M v[92:95], a[88:91], a[168:171], v[92:95]
s_waitcnt lgkmcnt(15)
ds_read_b64_tr_b16 a[152:153], v19 offset:32768
ds_read_b64_tr_b16 a[154:155], v19 offset:34816
M v[96:99], a[32:35], a[176:179], v[96:99]
s_add_u32 s24, s24, 262144
s_cmp_eq_u32 s24, s27
s_cselect_b32 s24, s28, s24
s_sub_u32 s6, s6, 1
s_cmp_eq_u32 s6, 0
s_cselect_b64 s[12:13], s[64:65], s[12:13]
M v[96:99], a[36:39], a[180:183], v[96:99]
M v[100:103], a[44:47], a[180:183], v[100:103]
M v[100:103], a[40:43], a[176:179], v[100:103]
M v[104:107], a[48:51], a[176:179], v[104:107]
M v[104:107], a[52:55], a[180:183], v[104:107]
M v[108:111], a[60:63], a[180:183], v[108:111]
M v[108:111], a[56:59], a[176:179], v[108:111]
s_waitcnt vmcnt(17) lgkmcnt(0)
s_barrier
ds_read_b128 a[160:163], v10 offset:16384
ds_read_b128 a[164:167], v11 offset:16384
M v[112:115], a[64:67], a[176:179], v[112:115]
s_add_u32 m0, s29, 0
s_nop 0
buffer_load_dwordx4 v2, s[8:11], s23 offen offset:0 lds
M v[112:115], a[68:71], a[180:183], v[112:115]
M v[116:119], a[76:79], a[180:183], v[116:119]
M v[116:119], a[72:75], a[176:179], v[116:119]
ds_read_b64_tr_b16 a[100:101], v12 offset:49152
ds_read_b64_tr_b16 a[102:103], v12 offset:51200
M v[120:123], a[80:83], a[176:179], v[120:123]
M v[120:123], a[84:87], a[180:183], v[120:123]
M v[124:127], a[92:95], a[180:183], v[124:127]
buffer_load_dwordx4 v3, s[8:11], s23 offen offset:1024 lds
M v[124:127], a[88:91], a[176:179], v[124:127]
M v[128:131], a[32:35], a[184:187], v[128:131]
M v[128:131], a[36:39], a[188:191], v[128:131]
ds_read_b128 a[168:171], v10 offset:18432
ds_read_b128 a[172:175], v11 offset:18432
ds_read_b64_tr_b16 a[108:109], v13 offset:49152
ds_read_b64_tr_b16 a[110:111], v13 offset:51200
M v[132:135], a[44:47], a[188:191], v[132:135]
M v[132:135], a[40:43], a[184:187], v[132:135]
M v[136:139], a[48:51], a[184:187], v[136:139]
M v[136:139], a[52:55], a[188:191], v[136:139]
buffer_load_dwordx4 v4, s[8:11], s23 offen offset:2048 lds
M v[140:143], a[60:63], a[188:191], v[140:143]
M v[140:143], a[56:59], a[184:187], v[140:143]
ds_read_b64_tr_b16 a[116:117], v14 offset:49152
ds_read_b64_tr_b16 a[118:119], v14 offset:51200
M v[144:147], a[64:67], a[184:187], v[144:147]
M v[144:147], a[68:71], a[188:191], v[144:147]
M v[148:151], a[76:79], a[188:191], v[148:151]
M v[148:151], a[72:75], a[184:187], v[148:151]
M v[152:155], a[80:83], a[184:187], v[152:155]
buffer_load_dwordx4 v5, s[8:11], s23 offen offset:3072 lds
M v[152:155], a[84:87], a[188:191], v[152:155]
ds_read_b64_tr_b16 a[124:125], v15 offset:49152
ds_read_b64_tr_b16 a[126:127], v15 offset:51200
M v[156:159], a[92:95], a[188:191], v[156:159]
M v[156:159], a[88:91], a[184:187], v[156:159]
s_waitcnt lgkmcnt(10)
M v[160:163], a[32:35], a[160:163], v[160:163]
M v[160:163], a[36:39], a[164:167], v[160:163]
ds_read_b128 a[176:179], v10 offset:20480
ds_read_b128 a[180:183], v11 offset:20480
M v[164:167], a[44:47], a[164:167], v[164:167]
M v[164:167], a[40:43], a[160:163], v[164:167]
ds_read_b64_tr_b16 a[132:133], v16 offset:49152
ds_read_b64_tr_b16 a[134:135], v16 offset:51200
M v[168:171], a[48:51], a[160:163], v[168:171]
M v[168:171], a[52:55], a[164:167], v[168:171]
s_add_u32 m0, s29, 98304
s_nop 0
buffer_load_dwordx4 v6, s[12:15], s24 offen offset:0 lds
M v[172:175], a[60:63], a[164:167], v[172:175]
M v[172:175], a[56:59], a[160:163], v[172:175]
M v[176:179], a[64:67], a[160:163], v[176:179]
M v[176:179], a[68:71], a[164:167], v[176:179]
ds_read_b64_tr_b16 a[140:141], v17 offset:49152
ds_read_b64_tr_b16 a[142:143], v17 offset:51200
M v[180:183], a[76:79], a[164:167], v[180:183]
M v[180:183], a[72:75], a[160:163], v[180:183]
buffer_load_dwordx4 v7, s[12:15], s24 offen offset:1024 lds
M v[184:187], a[80:83], a[160:163], v[184:187]
M v[184:187], a[84:87], a[164:167], v[184:187]
M v[188:191], a[92:95], a[164:167], v[188:191]
M v[188:191], a[88:91], a[160:163], v[188:191]
s_waitcnt lgkmcnt(12)
ds_read_b64_tr_b16 a[148:149], v18 offset:49152
ds_read_b64_tr_b16 a[150:151], v18 offset:51200
M v[192:195], a[32:35], a[168:171], v[192:195]
M v[192:195], a[36:39], a[172:175], v[192:195]
ds_read_b128 a[184:187], v10 offset:22528
ds_read_b128 a[188:191], v11 offset:22528
M v[196:199], a[44:47], a[172:175], v[196:199]
M v[196:199], a[40:43], a[168:171], v[196:199]
buffer_load_dwordx4 v8, s[12:15], s24 offen offset:2048 lds
M v[200:203], a[48:51], a[168:171], v[200:203]
M v[200:203], a[52:55], a[172:175], v[200:203]
ds_read_b64_tr_b16 a[156:157], v19 offset:49152
ds_read_b64_tr_b16 a[158:159], v19 offset:51200
M v[204:207], a[60:63], a[172:175], v[204:207]
M v[204:207], a[56:59], a[168:171], v[204:207]
M v[208:211], a[64:67], a[168:171], v[208:211]
M v[208:211], a[68:71], a[172:175], v[208:211]
buffer_load_dwordx4 v9, s[12:15], s24 offen offset:3072 lds
M v[212:215], a[76:79], a[172:175], v[212:215]
M v[212:215], a[72:75], a[168:171], v[212:215]
M v[216:219], a[80:83], a[168:171], v[216:219]
M v[216:219], a[84:87], a[172:175], v[216:219]
M v[220:223], a[92:95], a[172:175], v[220:223]
s_add_u32 s24, s24, 262144
M v[220:223], a[88:91], a[168:171], v[220:223]
s_waitcnt lgkmcnt(10)
M v[224:227], a[32:35], a[176:179], v[224:227]
M v[224:227], a[36:39], a[180:183], v[224:227]
M v[228:231], a[44:47], a[180:183], v[228:231]
M v[228:231], a[40:43], a[176:179], v[228:231]
M v[232:235], a[48:51], a[176:179], v[232:235]
M v[232:235], a[52:55], a[180:183], v[232:235]
M v[236:239], a[60:63], a[180:183], v[236:239]
M v[236:239], a[56:59], a[176:179], v[236:239]
s_waitcnt vmcnt(17) lgkmcnt(0)
s_barrier
ds_read_b128 a[160:163], v10 offset:32768
ds_read_b128 a[164:167], v11 offset:32768
M v[240:243], a[64:67], a[176:179], v[240:243]
s_add_u32 m0, s29, 16384
s_add_u32 s3, s23, s31
buffer_load_dwordx4 v2, s[8:11], s3 offen offset:0 lds
M v[240:243], a[68:71], a[180:183], v[240:243]
M v[244:247], a[76:79], a[180:183], v[244:247]
M v[244:247], a[72:75], a[176:179], v[244:247]
M v[248:251], a[80:83], a[176:179], v[248:251]
M v[248:251], a[84:87], a[180:183], v[248:251]
buffer_load_dwordx4 v3, s[8:11], s3 offen offset:1024 lds
M v[252:255], a[92:95], a[180:183], v[252:255]
M v[252:255], a[88:91], a[176:179], v[252:255]
M a[0:3], a[32:35], a[184:187], a[0:3]
M a[0:3], a[36:39], a[188:191], a[0:3]
ds_read_b128 a[168:171], v10 offset:34816
ds_read_b128 a[172:175], v11 offset:34816
M a[4:7], a[44:47], a[188:191], a[4:7]
M a[4:7], a[40:43], a[184:187], a[4:7]
M a[8:11], a[48:51], a[184:187], a[8:11]
buffer_load_dwordx4 v4, s[8:11], s3 offen offset:2048 lds
M a[8:11], a[52:55], a[188:191], a[8:11]
M a[12:15], a[60:63], a[188:191], a[12:15]
M a[12:15], a[56:59], a[184:187], a[12:15]
M a[16:19], a[64:67], a[184:187], a[16:19]
M a[16:19], a[68:71], a[188:191], a[16:19]
buffer_load_dwordx4 v5, s[8:11], s3 offen offset:3072 lds
M a[20:23], a[76:79], a[188:191], a[20:23]
M a[20:23], a[72:75], a[184:187], a[20:23]
M a[24:27], a[80:83], a[184:187], a[24:27]
M a[24:27], a[84:87], a[188:191], a[24:27]
M a[28:31], a[92:95], a[188:191], a[28:31]
M a[28:31], a[88:91], a[184:187], a[28:31]
s_waitcnt lgkmcnt(2)
M v[32:35], a[96:99], a[160:163], v[32:35]
s_add_u32 s23, s23, 128
s_cmp_eq_u32 s23, s25
s_cselect_b32 s23, s26, s23
M v[32:35], a[100:103], a[164:167], v[32:35]
ds_read_b128 a[176:179], v10 offset:36864
ds_read_b128 a[180:183], v11 offset:36864
M v[36:39], a[108:111], a[164:167], v[36:39]
M v[36:39], a[104:107], a[160:163], v[36:39]
ds_read_b64_tr_b16 a[32:33], v12 offset:0
ds_read_b64_tr_b16 a[34:35], v12 offset:2048
M v[40:43], a[112:115], a[160:163], v[40:43]
M v[40:43], a[116:119], a[164:167], v[40:43]
M v[44:47], a[124:127], a[164:167], v[44:47]
s_add_u32 m0, s29, 114688
s_nop 0
buffer_load_dwordx4 v6, s[12:15], s24 offen offset:0 lds
M v[44:47], a[120:123], a[160:163], v[44:47]
ds_read_b64_tr_b16 a[40:41], v13 offset:0
ds_read_b64_tr_b16 a[42:43], v13 offset:2048
M v[48:51], a[128:131], a[160:163], v[48:51]
M v[48:51], a[132:135], a[164:167], v[48:51]
M v[52:55], a[140:143], a[164:167], v[52:55]
M v[52:55], a[136:139], a[160:163], v[52:55]
ds_read_b64_tr_b16 a[48:49], v14 offset:0
ds_read_b64_tr_b16 a[50:51], v14 offset:2048
M v[56:59], a[144:147], a[160:163], v[56:59]
M v[56:59], a[148:151], a[164:167], v[56:59]
buffer_load_dwordx4 v7, s[12:15], s24 offen offset:1024 lds
M v[60:63], a[156:159], a[164:167], v[60:63]
M v[60:63], a[152:155], a[160:163], v[60:63]
s_waitcnt lgkmcnt(8)
ds_read_b64_tr_b16 a[56:57], v15 offset:0
ds_read_b64_tr_b16 a[58:59], v15 offset:2048
M v[64:67], a[96:99], a[168:171], v[64:67]
M v[64:67], a[100:103], a[172:175], v[64:67]
ds_read_b128 a[184:187], v10 offset:38912
ds_read_b128 a[188:191], v11 offset:38912
M v[68:71], a[108:111], a[172:175], v[68:71]
M v[68:71], a[104:107], a[168:171], v[68:71]
ds_read_b64_tr_b16 a[64:65], v16 offset:0
ds_read_b64_tr_b16 a[66:67], v16 offset:2048
M v[72:75], a[112:115], a[168:171], v[72:75]
buffer_load_dwordx4 v8, s[12:15], s24 offen offset:2048 lds
M v[72:75], a[116:119], a[172:175], v[72:75]
M v[76:79], a[124:127], a[172:175], v[76:79]
M v[76:79], a[120:123], a[168:171], v[76:79]
ds_read_b64_tr_b16 a[72:73], v17 offset:0
ds_read_b64_tr_b16 a[74:75], v17 offset:2048
M v[80:83], a[128:131], a[168:171], v[80:83]
M v[80:83], a[132:135], a[172:175], v[80:83]
M v[84:87], a[140:143], a[172:175], v[84:87]
buffer_load_dwordx4 v9, s[12:15], s24 offen offset:3072 lds
M v[84:87], a[136:139], a[168:171], v[84:87]
ds_read_b64_tr_b16 a[80:81], v18 offset:0
ds_read_b64_tr_b16 a[82:83], v18 offset:2048
M v[88:91], a[144:147], a[168:171], v[88:91]
M v[88:91], a[148:151], a[172:175], v[88:91]
M v[92:95], a[156:159], a[172:175], v[92:95]
M v[92:95], a[152:155], a[168:171], v[92:95]
s_waitcnt lgkmcnt(15)
ds_read_b64_tr_b16 a[88:89], v19 offset:0
ds_read_b64_tr_b16 a[90:91], v19 offset:2048
M v[96:99], a[96:99], a[176:179], v[96:99]
s_add_u32 s24, s24, 262144
s_cmp_eq_u32 s24, s27
s_cselect_b32 s24, s28, s24
s_sub_u32 s6, s6, 1
s_cmp_eq_u32 s6, 0
s_cselect_b64 s[12:13], s[64:65], s[12:13]
M v[96:99], a[100:103], a[180:183], v[96:99]
M v[100:103], a[108:111], a[180:183], v[100:103]
M v[100:103], a[104:107], a[176:179], v[100:103]
M v[104:107], a[112:115], a[176:179], v[104:107]
M v[104:107], a[116:119], a[180:183], v[104:107]
M v[108:111], a[124:127], a[180:183], v[108:111]
M v[108:111], a[120:123], a[176:179], v[108:111]
s_waitcnt vmcnt(16) lgkmcnt(0)
s_barrier
ds_read_b128 a[160:163], v10 offset:49152
ds_read_b128 a[164:167], v11 offset:49152
M v[112:115], a[128:131], a[176:179], v[112:115]
s_add_u32 m0, s29, 32768
s_nop 0
buffer_load_dwordx4 v2, s[8:11], s23 offen offset:0 lds
M v[112:115], a[132:135], a[180:183], v[112:115]
M v[116:119], a[140:143], a[180:183], v[116:119]
M v[116:119], a[136:139], a[176:179], v[116:119]
ds_read_b64_tr_b16 a[36:37], v12 offset:16384
ds_read_b64_tr_b16 a[38:39], v12 offset:18432
M v[120:123], a[144:147], a[176:179], v[120:123]
M v[120:123], a[148:151], a[180:183], v[120:123]
M v[124:127], a[156:159], a[180:183], v[124:127]
M v[124:127], a[152:155], a[176:179], v[124:127]
M v[128:131], a[96:99], a[184:187], v[128:131]
M v[128:131], a[100:103], a[188:191], v[128:131]
ds_read_b128 a[168:171], v10 offset:51200
ds_read_b128 a[172:175], v11 offset:51200
ds_read_b64_tr_b16 a[44:45], v13 offset:16384
ds_read_b64_tr_b16 a[46:47], v13 offset:18432
M v[132:135], a[108:111], a[188:191], v[132:135]
M v[132:135], a[104:107], a[184:187], v[132:135]
M v[136:139], a[112:115], a[184:187], v[136:139]
M v[136:139], a[116:119], a[188:191], v[136:139]
M v[140:143], a[124:127], a[188:191], v[140:143]
M v[140:143], a[120:123], a[184:187], v[140:143]
ds_read_b64_tr_b16 a[52:53], v14 offset:16384
ds_read_b64_tr_b16 a[54:55], v14 offset:18432
M v[144:147], a[128:131], a[184:187], v[144:147]
buffer_load_dwordx4 v3, s[8:11], s23 offen offset:1024 lds
M v[144:147], a[132:135], a[188:191], v[144:147]
M v[148:151], a[140:143], a[188:191], v[148:151]
M v[148:151], a[136:139], a[184:187], v[148:151]
M v[152:155], a[144:147], a[184:187], v[152:155]
M v[152:155], a[148:151], a[188:191], v[152:155]
ds_read_b64_tr_b16 a[60:61], v15 offset:16384
ds_read_b64_tr_b16 a[62:63], v15 offset:18432
M v[156:159], a[156:159], a[188:191], v[156:159]
M v[156:159], a[152:155], a[184:187], v[156:159]
s_waitcnt lgkmcnt(10)
M v[160:163], a[96:99], a[160:163], v[160:163]
M v[160:163], a[100:103], a[164:167], v[160:163]
ds_read_b128 a[176:179], v10 offset:53248
ds_read_b128 a[180:183], v11 offset:53248
M v[164:167], a[108:111], a[164:167], v[164:167]
M v[164:167], a[104:107], a[160:163], v[164:167]
ds_read_b64_tr_b16 a[68:69], v16 offset:16384
ds_read_b64_tr_b16 a[70:71], v16 offset:18432
M v[168:171], a[112:115], a[160:163], v[168:171]
M v[168:171], a[116:119], a[164:167], v[168:171]
M v[172:175], a[124:127], a[164:167], v[172:175]
M v[172:175], a[120:123], a[160:163], v[172:175]
M v[176:179], a[128:131], a[160:163], v[176:179]
buffer_load_dwordx4 v4, s[8:11], s23 offen offset:2048 lds
M v[176:179], a[132:135], a[164:167], v[176:179]
ds_read_b64_tr_b16 a[76:77], v17 offset:16384
ds_read_b64_tr_b16 a[78:79], v17 offset:18432
M v[180:183], a[140:143], a[164:167], v[180:183]
M v[180:183], a[136:139], a[160:163], v[180:183]
M v[184:187], a[144:147], a[160:163], v[184:187]
M v[184:187], a[148:151], a[164:167], v[184:187]
M v[188:191], a[156:159], a[164:167], v[188:191]
M v[188:191], a[152:155], a[160:163], v[188:191]
s_waitcnt lgkmcnt(12)
ds_read_b64_tr_b16 a[84:85], v18 offset:16384
ds_read_b64_tr_b16 a[86:87], v18 offset:18432
M v[192:195], a[96:99], a[168:171], v[192:195]
M v[192:195], a[100:103], a[172:175], v[192:195]
ds_read_b128 a[184:187], v10 offset:55296
ds_read_b128 a[188:191], v11 offset:55296
M v[196:199], a[108:111], a[172:175], v[196:199]
M v[196:199], a[104:107], a[168:171], v[196:199]
M v[200:203], a[112:115], a[168:171], v[200:203]
M v[200:203], a[116:119], a[172:175], v[200:203]
ds_read_b64_tr_b16 a[92:93], v19 offset:16384
ds_read_b64_tr_b16 a[94:95], v19 offset:18432
M v[204:207], a[124:127], a[172:175], v[204:207]
M v[204:207], a[120:123], a[168:171], v[204:207]
M v[208:211], a[128:131], a[168:171], v[208:211]
buffer_load_dwordx4 v5, s[8:11], s23 offen offset:3072 lds
M v[208:211], a[132:135], a[172:175], v[208:211]
M v[212:215], a[140:143], a[172:175], v[212:215]
M v[212:215], a[136:139], a[168:171], v[212:215]
M v[216:219], a[144:147], a[168:171], v[216:219]
M v[216:219], a[148:151], a[172:175], v[216:219]
M v[220:223], a[156:159], a[172:175], v[220:223]
M v[220:223], a[152:155], a[168:171], v[220:223]
s_waitcnt lgkmcnt(10)
M v[224:227], a[96:99], a[176:179], v[224:227]
M v[224:227], a[100:103], a[180:183], v[224:227]
M v[228:231], a[108:111], a[180:183], v[228:231]
M v[228:231], a[104:107], a[176:179], v[228:231]
M v[232:235], a[112:115], a[176:179], v[232:235]
M v[232:235], a[116:119], a[180:183], v[232:235]
M v[236:239], a[124:127], a[180:183], v[236:239]
M v[236:239], a[120:123], a[176:179], v[236:239]
s_waitcnt vmcnt(12) lgkmcnt(0)
s_barrier
ds_read_b128 a[160:163], v10 offset:0
ds_read_b128 a[164:167], v11 offset:0
M v[240:243], a[128:131], a[176:179], v[240:243]
s_add_u32 m0, s29, 49152
s_add_u32 s3, s23, s31
buffer_load_dwordx4 v2, s[8:11], s3 offen offset:0 lds
M v[240:243], a[132:135], a[180:183], v[240:243]
M v[244:247], a[140:143], a[180:183], v[244:247]
M v[244:247], a[136:139], a[176:179], v[244:247]
M v[248:251], a[144:147], a[176:179], v[248:251]
M v[248:251], a[148:151], a[180:183], v[248:251]
M v[252:255], a[156:159], a[180:183], v[252:255]
M v[252:255], a[152:155], a[176:179], v[252:255]
M a[0:3], a[96:99], a[184:187], a[0:3]
M a[0:3], a[100:103], a[188:191], a[0:3]
ds_read_b128 a[168:171], v10 offset:2048
ds_read_b128 a[172:175], v11 offset:2048
M a[4:7], a[108:111], a[188:191], a[4:7]
M a[4:7], a[104:107], a[184:187], a[4:7]
M a[8:11], a[112:115], a[184:187], a[8:11]
buffer_load_dwordx4 v3, s[8:11], s3 offen offset:1024 lds
M a[8:11], a[116:119], a[188:191], a[8:11]
M a[12:15], a[124:127], a[188:191], a[12:15]
M a[12:15], a[120:123], a[184:187], a[12:15]
M a[16:19], a[128:131], a[184:187], a[16:19]
M a[16:19], a[132:135], a[188:191], a[16:19]
M a[20:23], a[140:143], a[188:191], a[20:23]
M a[20:23], a[136:139], a[184:187], a[20:23]
M a[24:27], a[144:147], a[184:187], a[24:27]
M a[24:27], a[148:151], a[188:191], a[24:27]
M a[28:31], a[156:159], a[188:191], a[28:31]
M a[28:31], a[152:155], a[184:187], a[28:31]
s_waitcnt lgkmcnt(2)
M v[32:35], a[32:35], a[160:163], v[32:35]
buffer_load_dwordx4 v4, s[8:11], s3 offen offset:2048 lds
M v[32:35], a[36:39], a[164:167], v[32:35]
ds_read_b128 a[176:179], v10 offset:4096
ds_read_b128 a[180:183], v11 offset:4096
M v[36:39], a[44:47], a[164:167], v[36:39]
M v[36:39], a[40:43], a[160:163], v[36:39]
ds_read_b64_tr_b16 a[96:97], v12 offset:32768
ds_read_b64_tr_b16 a[98:99], v12 offset:34816
M v[40:43], a[48:51], a[160:163], v[40:43]
M v[40:43], a[52:55], a[164:167], v[40:43]
M v[44:47], a[60:63], a[164:167], v[44:47]
M v[44:47], a[56:59], a[160:163], v[44:47]
ds_read_b64_tr_b16 a[104:105], v13 offset:32768
ds_read_b64_tr_b16 a[106:107], v13 offset:34816
M v[48:51], a[64:67], a[160:163], v[48:51]
M v[48:51], a[68:71], a[164:167], v[48:51]
M v[52:55], a[76:79], a[164:167], v[52:55]
M v[52:55], a[72:75], a[160:163], v[52:55]
ds_read_b64_tr_b16 a[112:113], v14 offset:32768
ds_read_b64_tr_b16 a[114:115], v14 offset:34816
M v[56:59], a[80:83], a[160:163], v[56:59]
M v[56:59], a[84:87], a[164:167], v[56:59]
buffer_load_dwordx4 v5, s[8:11], s3 offen offset:3072 lds
M v[60:63], a[92:95], a[164:167], v[60:63]
M v[60:63], a[88:91], a[160:163], v[60:63]
s_waitcnt lgkmcnt(8)
ds_read_b64_tr_b16 a[120:121], v15 offset:32768
ds_read_b64_tr_b16 a[122:123], v15 offset:34816
M v[64:67], a[32:35], a[168:171], v[64:67]
M v[64:67], a[36:39], a[172:175], v[64:67]
ds_read_b128 a[184:187], v10 offset:6144
ds_read_b128 a[188:191], v11 offset:6144
M v[68:71], a[44:47], a[172:175], v[68:71]
M v[68:71], a[40:43], a[168:171], v[68:71]
ds_read_b64_tr_b16 a[128:129], v16 offset:32768
ds_read_b64_tr_b16 a[130:131], v16 offset:34816
M v[72:75], a[48:51], a[168:171], v[72:75]
M v[72:75], a[52:55], a[172:175], v[72:75]
M v[76:79], a[60:63], a[172:175], v[76:79]
M v[76:79], a[56:59], a[168:171], v[76:79]
ds_read_b64_tr_b16 a[136:137], v17 offset:32768
ds_read_b64_tr_b16 a[138:139], v17 offset:34816
M v[80:83], a[64:67], a[168:171], v[80:83]
M v[80:83], a[68:71], a[172:175], v[80:83]
M v[84:87], a[76:79], a[172:175], v[84:87]
s_add_u32 s23, s23, 128
s_cmp_eq_u32 s23, s25
s_cselect_b32 s23, s26, s23
M v[84:87], a[72:75], a[168:171], v[84:87]
ds_read_b64_tr_b16 a[144:145], v18 offset:32768
ds_read_b64_tr_b16 a[146:147], v18 offset:34816
M v[88:91], a[80:83], a[168:171], v[88:91]
M v[88:91], a[84:87], a[172:175], v[88:91]
M v[92:95], a[92:95], a[172:175], v[92:95]
M v[92:95], a[88:91], a[168:171], v[92:95]
s_waitcnt lgkmcnt(15)
ds_read_b64_tr_b16 a[152:153], v19 offset:32768
ds_read_b64_tr_b16 a[154:155], v19 offset:34816
M v[96:99], a[32:35], a[176:179], v[96:99]
M v[96:99], a[36:39], a[180:183], v[96:99]
M v[100:103], a[44:47], a[180:183], v[100:103]
M v[100:103], a[40:43], a[176:179], v[100:103]
M v[104:107], a[48:51], a[176:179], v[104:107]
M v[104:107], a[52:55], a[180:183], v[104:107]
M v[108:111], a[60:63], a[180:183], v[108:111]
M v[108:111], a[56:59], a[176:179], v[108:111]
s_waitcnt vmcnt(8) lgkmcnt(0)
s_barrier
ds_read_b128 a[160:163], v10 offset:16384
ds_read_b128 a[164:167], v11 offset:16384
M v[112:115], a[64:67], a[176:179], v[112:115]
M v[112:115], a[68:71], a[180:183], v[112:115]
s_and_b32 s3, s2, 1
s_lshl_b32 s3, s3, 3
s_bfe_u32 s4, s2, 0x30003
M v[116:119], a[76:79], a[180:183], v[116:119]
s_add_u32 s26, s3, s4
s_bfe_u32 s3, s2, 0x20001
s_lshl_b32 s3, s3, 2
M v[116:119], a[72:75], a[176:179], v[116:119]
ds_read_b64_tr_b16 a[100:101], v12 offset:49152
ds_read_b64_tr_b16 a[102:103], v12 offset:51200
s_lshr_b32 s4, s2, 6
s_xor_b32 s4, s4, 2
s_add_u32 s27, s3, s4
M v[120:123], a[80:83], a[176:179], v[120:123]
s_lshl_b32 s23, s26, 18
s_sub_u32 s24, s23, 32768
M v[120:123], a[84:87], a[180:183], v[120:123]
s_max_i32 s24, s24, 0
s_lshl_b32 s25, s27, 7
s_xor_b32 s3, s26, s27
M v[124:127], a[92:95], a[180:183], v[124:127]
s_and_b32 s3, s3, 0
s_lshl_b32 s3, s3, 3
s_sub_u32 s31, 16, s3
M v[124:127], a[88:91], a[176:179], v[124:127]
s_mov_b32 s54, s31
s_movk_i32 s57, 128
s_mov_b32 s55, 4289069056
M v[128:131], a[32:35], a[184:187], v[128:131]
s_mov_b32 s56, 393216
s_lshl_b32 s4, s3, 7
M v[128:131], a[36:39], a[188:191], v[128:131]
ds_read_b128 a[168:171], v10 offset:18432
ds_read_b128 a[172:175], v11 offset:18432
ds_read_b64_tr_b16 a[108:109], v13 offset:49152
ds_read_b64_tr_b16 a[110:111], v13 offset:51200
s_add_u32 s23, s23, s4
s_add_u32 s24, s24, s4
s_mul_i32 s4, s3, 393216
M v[132:135], a[44:47], a[188:191], v[132:135]
s_add_u32 s25, s25, s4
s_mov_b64 s[8:9], s[44:45]
s_mov_b32 s10, 4194304
M v[132:135], a[40:43], a[184:187], v[132:135]
s_mov_b64 s[12:13], s[46:47]
s_mov_b32 s14, 6291456
M v[136:139], a[48:51], a[184:187], v[136:139]
s_mov_b64 s[36:37], s[90:91]
s_mov_b32 s38, 256
s_mov_b32 s39, 0x00020000
M v[136:139], a[52:55], a[188:191], v[136:139]
s_lshl_b32 s28, s20, 9
s_mul_i32 s30, s20, 6144
s_lshl_b32 s3, s20, 5
M v[140:143], a[60:63], a[188:191], v[140:143]
v_lshrrev_b32 v24, 3, v0
v_and_b32 v25, 7, v0
v_add_u32 v28, s3, v24
M v[140:143], a[56:59], a[184:187], v[140:143]
ds_read_b64_tr_b16 a[116:117], v14 offset:49152
ds_read_b64_tr_b16 a[118:119], v14 offset:51200
v_add_u32 v26, 0, v28
v_bfe_u32 v27, v26, 1, 3
M v[144:147], a[64:67], a[184:187], v[144:147]
v_xor_b32 v27, v27, v25
v_lshlrev_b32 v26, 11, v26
v_lshl_add_u32 v26, v27, 4, v26
M v[144:147], a[68:71], a[188:191], v[144:147]
v_subrev_u32 v2, 0, v26
v_add_u32 v26, 8, v28
v_bfe_u32 v27, v26, 1, 3
M v[148:151], a[76:79], a[188:191], v[148:151]
v_xor_b32 v27, v27, v25
v_lshlrev_b32 v26, 11, v26
v_lshl_add_u32 v26, v27, 4, v26
M v[148:151], a[72:75], a[184:187], v[148:151]
v_subrev_u32 v3, 1024, v26
v_add_u32 v26, 16, v28
M v[152:155], a[80:83], a[184:187], v[152:155]
v_bfe_u32 v27, v26, 1, 3
v_xor_b32 v27, v27, v25
v_lshlrev_b32 v26, 11, v26
M v[152:155], a[84:87], a[188:191], v[152:155]
ds_read_b64_tr_b16 a[124:125], v15 offset:49152
ds_read_b64_tr_b16 a[126:127], v15 offset:51200
v_lshl_add_u32 v26, v27, 4, v26
v_subrev_u32 v4, 2048, v26
v_add_u32 v26, 24, v28
M v[156:159], a[92:95], a[188:191], v[156:159]
v_bfe_u32 v27, v26, 1, 3
v_xor_b32 v27, v27, v25
M v[156:159], a[88:91], a[184:187], v[156:159]
s_waitcnt lgkmcnt(10)
v_lshlrev_b32 v26, 11, v26
v_lshl_add_u32 v26, v27, 4, v26
v_subrev_u32 v5, 3072, v26
M v[160:163], a[32:35], a[160:163], v[160:163]
s_lshl_b32 s3, s20, 2
v_lshrrev_b32 v26, 5, v0
v_add_u32 v26, s3, v26
M v[160:163], a[36:39], a[164:167], v[160:163]
ds_read_b128 a[176:179], v10 offset:20480
ds_read_b128 a[180:183], v11 offset:20480
v_bfe_u32 v29, v0, 2, 3
v_bfe_u32 v27, v26, 1, 3
v_xor_b32 v27, v27, v29
M v[164:167], a[44:47], a[164:167], v[164:167]
v_lshlrev_b32 v27, 4, v27
v_and_b32 v30, 3, v0
M v[164:167], a[40:43], a[160:163], v[164:167]
ds_read_b64_tr_b16 a[132:133], v16 offset:49152
ds_read_b64_tr_b16 a[134:135], v16 offset:51200
v_lshl_add_u32 v27, v30, 2, v27
v_lshl_add_u32 v20, v26, 11, v27
v_add_u32 v26, 2, v26
M v[168:171], a[48:51], a[160:163], v[168:171]
v_bfe_u32 v27, v26, 1, 3
v_xor_b32 v27, v27, v29
v_lshlrev_b32 v27, 4, v27
M v[168:171], a[52:55], a[164:167], v[168:171]
v_and_b32 v30, 3, v0
v_lshl_add_u32 v27, v30, 2, v27
M v[172:175], a[60:63], a[164:167], v[172:175]
v_lshl_add_u32 v23, v26, 11, v27
v_subrev_u32 v23, 256, v23
s_mul_i32 s3, s20, 48
M v[172:175], a[56:59], a[160:163], v[172:175]
v_add_u32 v28, s3, v24
v_add_u32 v26, 0, v28
v_mul_u32_u24 v27, 0xaaab, v26
M v[176:179], a[64:67], a[160:163], v[176:179]
v_lshrrev_b32 v27, 17, v27
v_lshrrev_b32 v29, 1, v27
v_and_b32 v29, 4, v29
M v[176:179], a[68:71], a[164:167], v[176:179]
ds_read_b64_tr_b16 a[140:141], v17 offset:49152
ds_read_b64_tr_b16 a[142:143], v17 offset:51200
v_and_or_b32 v27, v27, 2, v29
v_xor_b32 v27, v27, v25
M v[180:183], a[76:79], a[164:167], v[180:183]
v_lshlrev_b32 v26, 11, v26
v_lshl_add_u32 v26, v27, 4, v26
v_subrev_u32 v6, 0, v26
M v[180:183], a[72:75], a[160:163], v[180:183]
v_add_u32 v26, 8, v28
v_mul_u32_u24 v27, 0xaaab, v26
v_lshrrev_b32 v27, 17, v27
M v[184:187], a[80:83], a[160:163], v[184:187]
v_lshrrev_b32 v29, 1, v27
v_and_b32 v29, 4, v29
v_and_or_b32 v27, v27, 2, v29
M v[184:187], a[84:87], a[164:167], v[184:187]
v_xor_b32 v27, v27, v25
v_lshlrev_b32 v26, 11, v26
M v[188:191], a[92:95], a[164:167], v[188:191]
v_lshl_add_u32 v26, v27, 4, v26
v_subrev_u32 v7, 1024, v26
v_add_u32 v26, 16, v28
M v[188:191], a[88:91], a[160:163], v[188:191]
s_waitcnt lgkmcnt(12)
ds_read_b64_tr_b16 a[148:149], v18 offset:49152
ds_read_b64_tr_b16 a[150:151], v18 offset:51200
v_mul_u32_u24 v27, 0xaaab, v26
v_lshrrev_b32 v27, 17, v27
v_lshrrev_b32 v29, 1, v27
M v[192:195], a[32:35], a[168:171], v[192:195]
v_and_b32 v29, 4, v29
v_and_or_b32 v27, v27, 2, v29
M v[192:195], a[36:39], a[172:175], v[192:195]
ds_read_b128 a[184:187], v10 offset:22528
ds_read_b128 a[188:191], v11 offset:22528
v_xor_b32 v27, v27, v25
v_lshlrev_b32 v26, 11, v26
v_lshl_add_u32 v26, v27, 4, v26
M v[196:199], a[44:47], a[172:175], v[196:199]
v_subrev_u32 v8, 2048, v26
v_add_u32 v26, 24, v28
v_mul_u32_u24 v27, 0xaaab, v26
M v[196:199], a[40:43], a[168:171], v[196:199]
v_lshrrev_b32 v27, 17, v27
v_lshrrev_b32 v29, 1, v27
v_and_b32 v29, 4, v29
M v[200:203], a[48:51], a[168:171], v[200:203]
v_and_or_b32 v27, v27, 2, v29
v_xor_b32 v27, v27, v25
M v[200:203], a[52:55], a[172:175], v[200:203]
ds_read_b64_tr_b16 a[156:157], v19 offset:49152
ds_read_b64_tr_b16 a[158:159], v19 offset:51200
v_lshlrev_b32 v26, 11, v26
v_lshl_add_u32 v26, v27, 4, v26
v_subrev_u32 v9, 3072, v26
M v[204:207], a[60:63], a[172:175], v[204:207]
v_add_u32 v26, 32, v28
v_mul_u32_u24 v27, 0xaaab, v26
v_lshrrev_b32 v27, 17, v27
M v[204:207], a[56:59], a[168:171], v[204:207]
v_lshrrev_b32 v29, 1, v27
v_and_b32 v29, 4, v29
v_and_or_b32 v27, v27, 2, v29
M v[208:211], a[64:67], a[168:171], v[208:211]
v_xor_b32 v27, v27, v25
v_lshlrev_b32 v26, 11, v26
M v[208:211], a[68:71], a[172:175], v[208:211]
v_lshl_add_u32 v26, v27, 4, v26
v_subrev_u32 v21, 0, v26
v_add_u32 v26, 40, v28
M v[212:215], a[76:79], a[172:175], v[212:215]
v_mul_u32_u24 v27, 0xaaab, v26
v_lshrrev_b32 v27, 17, v27
v_lshrrev_b32 v29, 1, v27
M v[212:215], a[72:75], a[168:171], v[212:215]
v_and_b32 v29, 4, v29
v_and_or_b32 v27, v27, 2, v29
M v[216:219], a[80:83], a[168:171], v[216:219]
v_xor_b32 v27, v27, v25
v_lshlrev_b32 v26, 11, v26
v_lshl_add_u32 v26, v27, 4, v26
M v[216:219], a[84:87], a[172:175], v[216:219]
v_subrev_u32 v22, 1024, v26
s_lshr_b32 s3, s53, 7
s_add_u32 s3, s3, s22
M v[220:223], a[92:95], a[172:175], v[220:223]
s_lshl_b32 s3, s3, 5
s_lshr_b32 s19, s52, 6
s_add_u32 s3, s3, s19
M v[220:223], a[88:91], a[168:171], v[220:223]
s_waitcnt lgkmcnt(10)
s_lshl_b32 s19, s21, 1
s_add_u32 s3, s3, s19
M v[224:227], a[32:35], a[176:179], v[224:227]
s_lshl_b32 s92, s3, 14
s_add_u32 s93, s92, 16384
s_add_u32 s16, s50, 0
M v[224:227], a[36:39], a[180:183], v[224:227]
s_addc_u32 s17, s51, 0
s_mov_b32 s18, 16777216
s_mov_b32 s19, 0x00020000
M v[228:231], a[44:47], a[180:183], v[228:231]
s_mov_b32 s4, 0x3e0293ee
s_mov_b32 s5, 0x3e0293ee
M v[228:231], a[40:43], a[176:179], v[228:231]
M v[232:235], a[48:51], a[176:179], v[232:235]
M v[232:235], a[52:55], a[180:183], v[232:235]
M v[236:239], a[60:63], a[180:183], v[236:239]
M v[236:239], a[56:59], a[176:179], v[236:239]
s_waitcnt vmcnt(4) lgkmcnt(0)
s_barrier
ds_read_b128 a[160:163], v10 offset:32768
ds_read_b128 a[164:167], v11 offset:32768
M v[240:243], a[64:67], a[176:179], v[240:243]
s_add_u32 m0, s28, 131072
s_nop 0
buffer_load_dword v20, s[8:11], s24 offen lds
M v[240:243], a[68:71], a[180:183], v[240:243]
M v[244:247], a[76:79], a[180:183], v[244:247]
M v[244:247], a[72:75], a[176:179], v[244:247]
buffer_load_dword v23, s[8:11], s24 offen offset:256 lds
M v[248:251], a[80:83], a[176:179], v[248:251]
M v[248:251], a[84:87], a[180:183], v[248:251]
M v[252:255], a[92:95], a[180:183], v[252:255]
M v[252:255], a[88:91], a[176:179], v[252:255]
M a[0:3], a[32:35], a[184:187], a[0:3]
s_add_u32 m0, s29, 133120
s_nop 0
buffer_load_dwordx4 v2, s[8:11], s23 offen offset:0 lds
M a[0:3], a[36:39], a[188:191], a[0:3]
ds_read_b128 a[168:171], v10 offset:34816
ds_read_b128 a[172:175], v11 offset:34816
M a[4:7], a[44:47], a[188:191], a[4:7]
M a[4:7], a[40:43], a[184:187], a[4:7]
M a[8:11], a[48:51], a[184:187], a[8:11]
buffer_load_dwordx4 v3, s[8:11], s23 offen offset:1024 lds
M a[8:11], a[52:55], a[188:191], a[8:11]
M a[12:15], a[60:63], a[188:191], a[12:15]
M a[12:15], a[56:59], a[184:187], a[12:15]
M a[16:19], a[64:67], a[184:187], a[16:19]
buffer_load_dwordx4 v4, s[8:11], s23 offen offset:2048 lds
M a[16:19], a[68:71], a[188:191], a[16:19]
M a[20:23], a[76:79], a[188:191], a[20:23]
M a[20:23], a[72:75], a[184:187], a[20:23]
buffer_load_dwordx4 v5, s[8:11], s23 offen offset:3072 lds
M a[24:27], a[80:83], a[184:187], a[24:27]
M a[24:27], a[84:87], a[188:191], a[24:27]
M a[28:31], a[92:95], a[188:191], a[28:31]
M a[28:31], a[88:91], a[184:187], a[28:31]
s_waitcnt lgkmcnt(2)
M v[32:35], a[96:99], a[160:163], v[32:35]
s_sub_u32 s31, s31, 1
s_cmp_eq_u32 s31, 0
s_cselect_b32 s58, -1920, s57
s_add_u32 s23, s23, s58
s_add_u32 s24, s24, s58
M v[32:35], a[100:103], a[164:167], v[32:35]
ds_read_b128 a[176:179], v10 offset:36864
ds_read_b128 a[180:183], v11 offset:36864
M v[36:39], a[108:111], a[164:167], v[36:39]
M v[36:39], a[104:107], a[160:163], v[36:39]
M v[40:43], a[112:115], a[160:163], v[40:43]
M v[40:43], a[116:119], a[164:167], v[40:43]
s_add_u32 m0, s30, 65536
s_nop 0
buffer_load_dwordx4 v6, s[12:15], s25 offen offset:0 lds
M v[44:47], a[124:127], a[164:167], v[44:47]
M v[44:47], a[120:123], a[160:163], v[44:47]
M v[48:51], a[128:131], a[160:163], v[48:51]
M v[48:51], a[132:135], a[164:167], v[48:51]
buffer_load_dwordx4 v7, s[12:15], s25 offen offset:1024 lds
M v[52:55], a[140:143], a[164:167], v[52:55]
M v[52:55], a[136:139], a[160:163], v[52:55]
M v[56:59], a[144:147], a[160:163], v[56:59]
M v[56:59], a[148:151], a[164:167], v[56:59]
buffer_load_dwordx4 v8, s[12:15], s25 offen offset:2048 lds
M v[60:63], a[156:159], a[164:167], v[60:63]
M v[60:63], a[152:155], a[160:163], v[60:63]
s_waitcnt lgkmcnt(2)
M v[64:67], a[96:99], a[168:171], v[64:67]
M v[64:67], a[100:103], a[172:175], v[64:67]
ds_read_b128 a[184:187], v10 offset:38912
ds_read_b128 a[188:191], v11 offset:38912
M v[68:71], a[108:111], a[172:175], v[68:71]
M v[68:71], a[104:107], a[168:171], v[68:71]
buffer_load_dwordx4 v9, s[12:15], s25 offen offset:3072 lds
v_pk_mul_f32 v[32:33], v[32:33], s[4:5]
v_pk_mul_f32 v[34:35], v[34:35], s[4:5]
v_pk_mul_f32 v[36:37], v[36:37], s[4:5]
M v[72:75], a[112:115], a[168:171], v[72:75]
v_pk_mul_f32 v[38:39], v[38:39], s[4:5]
v_cvt_pk_bf16_f32 v32, v32, v33
M v[72:75], a[116:119], a[172:175], v[72:75]
v_cvt_pk_bf16_f32 v33, v34, v35
v_cvt_pk_bf16_f32 v34, v36, v37
M v[76:79], a[124:127], a[172:175], v[76:79]
v_cvt_pk_bf16_f32 v35, v38, v39
v_pk_mul_f32 v[40:41], v[40:41], s[4:5]
v_pk_mul_f32 v[42:43], v[42:43], s[4:5]
M v[76:79], a[120:123], a[168:171], v[76:79]
s_add_u32 m0, s30, 69632
s_nop 0
buffer_load_dwordx4 v21, s[12:15], s25 offen offset:0 lds
v_pk_mul_f32 v[44:45], v[44:45], s[4:5]
v_pk_mul_f32 v[46:47], v[46:47], s[4:5]
M v[80:83], a[128:131], a[168:171], v[80:83]
v_cvt_pk_bf16_f32 v40, v40, v41
v_cvt_pk_bf16_f32 v41, v42, v43
M v[80:83], a[132:135], a[172:175], v[80:83]
v_cvt_pk_bf16_f32 v42, v44, v45
v_cvt_pk_bf16_f32 v43, v46, v47
M v[84:87], a[140:143], a[172:175], v[84:87]
v_pk_mul_f32 v[48:49], v[48:49], s[4:5]
v_pk_mul_f32 v[50:51], v[50:51], s[4:5]
v_pk_mul_f32 v[52:53], v[52:53], s[4:5]
M v[84:87], a[136:139], a[168:171], v[84:87]
buffer_load_dwordx4 v22, s[12:15], s25 offen offset:1024 lds
v_pk_mul_f32 v[54:55], v[54:55], s[4:5]
v_cvt_pk_bf16_f32 v48, v48, v49
M v[88:91], a[144:147], a[168:171], v[88:91]
v_cvt_pk_bf16_f32 v49, v50, v51
v_cvt_pk_bf16_f32 v50, v52, v53
M v[88:91], a[148:151], a[172:175], v[88:91]
v_cvt_pk_bf16_f32 v51, v54, v55
v_pk_mul_f32 v[56:57], v[56:57], s[4:5]
v_pk_mul_f32 v[58:59], v[58:59], s[4:5]
M v[92:95], a[156:159], a[172:175], v[92:95]
v_pk_mul_f32 v[60:61], v[60:61], s[4:5]
v_pk_mul_f32 v[62:63], v[62:63], s[4:5]
M v[92:95], a[152:155], a[168:171], v[92:95]
s_waitcnt lgkmcnt(2)
v_cvt_pk_bf16_f32 v56, v56, v57
v_cvt_pk_bf16_f32 v57, v58, v59
M v[96:99], a[96:99], a[176:179], v[96:99]
s_sub_u32 s54, s54, 1
s_cmp_eq_u32 s54, 0
s_cselect_b32 s58, s55, s56
s_add_u32 s25, s25, s58
v_cvt_pk_bf16_f32 v58, v60, v61
v_cvt_pk_bf16_f32 v59, v62, v63
M v[96:99], a[100:103], a[180:183], v[96:99]
M v[100:103], a[108:111], a[180:183], v[100:103]
M v[100:103], a[104:107], a[176:179], v[100:103]
v_pk_mul_f32 v[64:65], v[64:65], s[4:5]
v_pk_mul_f32 v[66:67], v[66:67], s[4:5]
v_pk_mul_f32 v[68:69], v[68:69], s[4:5]
M v[104:107], a[112:115], a[176:179], v[104:107]
s_add_u32 s94, s92, 0
buffer_store_dwordx4 v[32:35], v1, s[16:19], s94 offen offset:0 sc1
v_pk_mul_f32 v[70:71], v[70:71], s[4:5]
v_cvt_pk_bf16_f32 v64, v64, v65
M v[104:107], a[116:119], a[180:183], v[104:107]
v_cvt_pk_bf16_f32 v65, v66, v67
v_cvt_pk_bf16_f32 v66, v68, v69
M v[108:111], a[124:127], a[180:183], v[108:111]
v_cvt_pk_bf16_f32 v67, v70, v71
v_pk_mul_f32 v[72:73], v[72:73], s[4:5]
v_pk_mul_f32 v[74:75], v[74:75], s[4:5]
M v[108:111], a[120:123], a[176:179], v[108:111]
s_waitcnt vmcnt(12) lgkmcnt(0)
s_barrier
ds_read_b128 a[160:163], v10 offset:49152
ds_read_b128 a[164:167], v11 offset:49152
v_pk_mul_f32 v[76:77], v[76:77], s[4:5]
v_pk_mul_f32 v[78:79], v[78:79], s[4:5]
M v[112:115], a[128:131], a[176:179], v[112:115]
s_add_u32 m0, s28, 0
s_nop 0
buffer_load_dword v20, s[8:11], s24 offen lds
v_cvt_pk_bf16_f32 v72, v72, v73
v_cvt_pk_bf16_f32 v73, v74, v75
M v[112:115], a[132:135], a[180:183], v[112:115]
v_cvt_pk_bf16_f32 v74, v76, v77
v_cvt_pk_bf16_f32 v75, v78, v79
M v[116:119], a[140:143], a[180:183], v[116:119]
s_add_u32 s94, s92, 0
buffer_store_dwordx4 v[40:43], v1, s[16:19], s94 offen offset:1024 sc1
v_pk_mul_f32 v[80:81], v[80:81], s[4:5]
v_pk_mul_f32 v[82:83], v[82:83], s[4:5]
v_pk_mul_f32 v[84:85], v[84:85], s[4:5]
M v[116:119], a[136:139], a[176:179], v[116:119]
v_pk_mul_f32 v[86:87], v[86:87], s[4:5]
v_cvt_pk_bf16_f32 v80, v80, v81
M v[120:123], a[144:147], a[176:179], v[120:123]
buffer_load_dword v23, s[8:11], s24 offen offset:256 lds
v_cvt_pk_bf16_f32 v81, v82, v83
v_cvt_pk_bf16_f32 v82, v84, v85
M v[120:123], a[148:151], a[180:183], v[120:123]
v_cvt_pk_bf16_f32 v83, v86, v87
v_pk_mul_f32 v[88:89], v[88:89], s[4:5]
v_pk_mul_f32 v[90:91], v[90:91], s[4:5]
M v[124:127], a[156:159], a[180:183], v[124:127]
v_pk_mul_f32 v[92:93], v[92:93], s[4:5]
v_pk_mul_f32 v[94:95], v[94:95], s[4:5]
M v[124:127], a[152:155], a[176:179], v[124:127]
v_cvt_pk_bf16_f32 v88, v88, v89
v_cvt_pk_bf16_f32 v89, v90, v91
M v[128:131], a[96:99], a[184:187], v[128:131]
s_add_u32 m0, s29, 2048
s_nop 0
buffer_load_dwordx4 v2, s[8:11], s23 offen offset:0 lds
v_cvt_pk_bf16_f32 v90, v92, v93
v_cvt_pk_bf16_f32 v91, v94, v95
M v[128:131], a[100:103], a[188:191], v[128:131]
ds_read_b128 a[168:171], v10 offset:51200
ds_read_b128 a[172:175], v11 offset:51200
M v[132:135], a[108:111], a[188:191], v[132:135]
s_add_u32 s94, s92, 0
buffer_store_dwordx4 v[48:51], v1, s[16:19], s94 offen offset:2048 sc1
M v[132:135], a[104:107], a[184:187], v[132:135]
v_pk_mul_f32 v[96:97], v[96:97], s[4:5]
v_pk_mul_f32 v[98:99], v[98:99], s[4:5]
v_pk_mul_f32 v[100:101], v[100:101], s[4:5]
M v[136:139], a[112:115], a[184:187], v[136:139]
v_pk_mul_f32 v[102:103], v[102:103], s[4:5]
v_cvt_pk_bf16_f32 v96, v96, v97
M v[136:139], a[116:119], a[188:191], v[136:139]
buffer_load_dwordx4 v3, s[8:11], s23 offen offset:1024 lds
v_cvt_pk_bf16_f32 v97, v98, v99
v_cvt_pk_bf16_f32 v98, v100, v101
M v[140:143], a[124:127], a[188:191], v[140:143]
v_cvt_pk_bf16_f32 v99, v102, v103
v_pk_mul_f32 v[104:105], v[104:105], s[4:5]
v_pk_mul_f32 v[106:107], v[106:107], s[4:5]
M v[140:143], a[120:123], a[184:187], v[140:143]
v_pk_mul_f32 v[108:109], v[108:109], s[4:5]
v_pk_mul_f32 v[110:111], v[110:111], s[4:5]
M v[144:147], a[128:131], a[184:187], v[144:147]
s_add_u32 s94, s92, 0
buffer_store_dwordx4 v[56:59], v1, s[16:19], s94 offen offset:3072 sc1
v_cvt_pk_bf16_f32 v104, v104, v105
v_cvt_pk_bf16_f32 v105, v106, v107
M v[144:147], a[132:135], a[188:191], v[144:147]
v_cvt_pk_bf16_f32 v106, v108, v109
v_cvt_pk_bf16_f32 v107, v110, v111
M v[148:151], a[140:143], a[188:191], v[148:151]
buffer_load_dwordx4 v4, s[8:11], s23 offen offset:2048 lds
v_pk_mul_f32 v[112:113], v[112:113], s[4:5]
v_pk_mul_f32 v[114:115], v[114:115], s[4:5]
v_pk_mul_f32 v[116:117], v[116:117], s[4:5]
M v[148:151], a[136:139], a[184:187], v[148:151]
v_pk_mul_f32 v[118:119], v[118:119], s[4:5]
v_cvt_pk_bf16_f32 v112, v112, v113
M v[152:155], a[144:147], a[184:187], v[152:155]
v_cvt_pk_bf16_f32 v113, v114, v115
v_cvt_pk_bf16_f32 v114, v116, v117
M v[152:155], a[148:151], a[188:191], v[152:155]
buffer_load_dwordx4 v5, s[8:11], s23 offen offset:3072 lds
v_cvt_pk_bf16_f32 v115, v118, v119
v_pk_mul_f32 v[120:121], v[120:121], s[4:5]
v_pk_mul_f32 v[122:123], v[122:123], s[4:5]
M v[156:159], a[156:159], a[188:191], v[156:159]
v_pk_mul_f32 v[124:125], v[124:125], s[4:5]
v_pk_mul_f32 v[126:127], v[126:127], s[4:5]
M v[156:159], a[152:155], a[184:187], v[156:159]
s_add_u32 s94, s92, 4096
buffer_store_dwordx4 v[64:67], v1, s[16:19], s94 offen offset:0 sc1
s_waitcnt lgkmcnt(2)
v_cvt_pk_bf16_f32 v120, v120, v121
v_cvt_pk_bf16_f32 v121, v122, v123
M v[160:163], a[96:99], a[160:163], v[160:163]
v_cvt_pk_bf16_f32 v122, v124, v125
v_cvt_pk_bf16_f32 v123, v126, v127
M v[160:163], a[100:103], a[164:167], v[160:163]
ds_read_b128 a[176:179], v10 offset:53248
ds_read_b128 a[180:183], v11 offset:53248
M v[164:167], a[108:111], a[164:167], v[164:167]
s_sub_u32 s31, s31, 1
s_cmp_eq_u32 s31, 0
s_cselect_b32 s58, -1920, s57
s_add_u32 s23, s23, s58
s_add_u32 s24, s24, s58
M v[164:167], a[104:107], a[160:163], v[164:167]
v_pk_mul_f32 v[128:129], v[128:129], s[4:5]
v_pk_mul_f32 v[130:131], v[130:131], s[4:5]
v_pk_mul_f32 v[132:133], v[132:133], s[4:5]
M v[168:171], a[112:115], a[160:163], v[168:171]
v_pk_mul_f32 v[134:135], v[134:135], s[4:5]
v_cvt_pk_bf16_f32 v128, v128, v129
M v[168:171], a[116:119], a[164:167], v[168:171]
s_add_u32 s94, s92, 4096
buffer_store_dwordx4 v[72:75], v1, s[16:19], s94 offen offset:1024 sc1
v_cvt_pk_bf16_f32 v129, v130, v131
v_cvt_pk_bf16_f32 v130, v132, v133
M v[172:175], a[124:127], a[164:167], v[172:175]
v_cvt_pk_bf16_f32 v131, v134, v135
v_pk_mul_f32 v[136:137], v[136:137], s[4:5]
v_pk_mul_f32 v[138:139], v[138:139], s[4:5]
M v[172:175], a[120:123], a[160:163], v[172:175]
s_add_u32 m0, s30, 98304
s_nop 0
buffer_load_dwordx4 v6, s[12:15], s25 offen offset:0 lds
v_pk_mul_f32 v[140:141], v[140:141], s[4:5]
v_pk_mul_f32 v[142:143], v[142:143], s[4:5]
M v[176:179], a[128:131], a[160:163], v[176:179]
v_cvt_pk_bf16_f32 v136, v136, v137
v_cvt_pk_bf16_f32 v137, v138, v139
M v[176:179], a[132:135], a[164:167], v[176:179]
v_cvt_pk_bf16_f32 v138, v140, v141
v_cvt_pk_bf16_f32 v139, v142, v143
M v[180:183], a[140:143], a[164:167], v[180:183]
buffer_load_dwordx4 v7, s[12:15], s25 offen offset:1024 lds
v_pk_mul_f32 v[144:145], v[144:145], s[4:5]
v_pk_mul_f32 v[146:147], v[146:147], s[4:5]
v_pk_mul_f32 v[148:149], v[148:149], s[4:5]
M v[180:183], a[136:139], a[160:163], v[180:183]
v_pk_mul_f32 v[150:151], v[150:151], s[4:5]
v_cvt_pk_bf16_f32 v144, v144, v145
M v[184:187], a[144:147], a[160:163], v[184:187]
s_add_u32 s94, s92, 4096
buffer_store_dwordx4 v[80:83], v1, s[16:19], s94 offen offset:2048 sc1
v_cvt_pk_bf16_f32 v145, v146, v147
v_cvt_pk_bf16_f32 v146, v148, v149
M v[184:187], a[148:151], a[164:167], v[184:187]
v_cvt_pk_bf16_f32 v147, v150, v151
v_pk_mul_f32 v[152:153], v[152:153], s[4:5]
v_pk_mul_f32 v[154:155], v[154:155], s[4:5]
M v[188:191], a[156:159], a[164:167], v[188:191]
buffer_load_dwordx4 v8, s[12:15], s25 offen offset:2048 lds
v_pk_mul_f32 v[156:157], v[156:157], s[4:5]
v_pk_mul_f32 v[158:159], v[158:159], s[4:5]
M v[188:191], a[152:155], a[160:163], v[188:191]
s_waitcnt lgkmcnt(2)
v_cvt_pk_bf16_f32 v152, v152, v153
v_cvt_pk_bf16_f32 v153, v154, v155
M v[192:195], a[96:99], a[168:171], v[192:195]
v_cvt_pk_bf16_f32 v154, v156, v157
v_cvt_pk_bf16_f32 v155, v158, v159
M v[192:195], a[100:103], a[172:175], v[192:195]
ds_read_b128 a[184:187], v10 offset:55296
ds_read_b128 a[188:191], v11 offset:55296
M v[196:199], a[108:111], a[172:175], v[196:199]
M v[196:199], a[104:107], a[168:171], v[196:199]
s_add_u32 s94, s92, 4096
buffer_store_dwordx4 v[88:91], v1, s[16:19], s94 offen offset:3072 sc1
v_pk_mul_f32 v[160:161], v[160:161], s[4:5]
v_pk_mul_f32 v[162:163], v[162:163], s[4:5]
v_pk_mul_f32 v[164:165], v[164:165], s[4:5]
M v[200:203], a[112:115], a[168:171], v[200:203]
buffer_load_dwordx4 v9, s[12:15], s25 offen offset:3072 lds
v_pk_mul_f32 v[166:167], v[166:167], s[4:5]
v_cvt_pk_bf16_f32 v160, v160, v161
M v[200:203], a[116:119], a[172:175], v[200:203]
v_cvt_pk_bf16_f32 v161, v162, v163
v_cvt_pk_bf16_f32 v162, v164, v165
M v[204:207], a[124:127], a[172:175], v[204:207]
v_cvt_pk_bf16_f32 v163, v166, v167
v_pk_mul_f32 v[168:169], v[168:169], s[4:5]
v_pk_mul_f32 v[170:171], v[170:171], s[4:5]
M v[204:207], a[120:123], a[168:171], v[204:207]
v_pk_mul_f32 v[172:173], v[172:173], s[4:5]
v_pk_mul_f32 v[174:175], v[174:175], s[4:5]
M v[208:211], a[128:131], a[168:171], v[208:211]
s_add_u32 m0, s30, 102400
s_nop 0
buffer_load_dwordx4 v21, s[12:15], s25 offen offset:0 lds
v_cvt_pk_bf16_f32 v168, v168, v169
v_cvt_pk_bf16_f32 v169, v170, v171
M v[208:211], a[132:135], a[172:175], v[208:211]
v_cvt_pk_bf16_f32 v170, v172, v173
v_cvt_pk_bf16_f32 v171, v174, v175
M v[212:215], a[140:143], a[172:175], v[212:215]
s_add_u32 s94, s92, 8192
buffer_store_dwordx4 v[96:99], v1, s[16:19], s94 offen offset:0 sc1
v_pk_mul_f32 v[176:177], v[176:177], s[4:5]
v_pk_mul_f32 v[178:179], v[178:179], s[4:5]
v_pk_mul_f32 v[180:181], v[180:181], s[4:5]
M v[212:215], a[136:139], a[168:171], v[212:215]
v_pk_mul_f32 v[182:183], v[182:183], s[4:5]
v_cvt_pk_bf16_f32 v176, v176, v177
M v[216:219], a[144:147], a[168:171], v[216:219]
buffer_load_dwordx4 v22, s[12:15], s25 offen offset:1024 lds
v_cvt_pk_bf16_f32 v177, v178, v179
v_cvt_pk_bf16_f32 v178, v180, v181
M v[216:219], a[148:151], a[172:175], v[216:219]
v_cvt_pk_bf16_f32 v179, v182, v183
v_pk_mul_f32 v[184:185], v[184:185], s[4:5]
v_pk_mul_f32 v[186:187], v[186:187], s[4:5]
M v[220:223], a[156:159], a[172:175], v[220:223]
v_pk_mul_f32 v[188:189], v[188:189], s[4:5]
v_pk_mul_f32 v[190:191], v[190:191], s[4:5]
M v[220:223], a[152:155], a[168:171], v[220:223]
s_waitcnt lgkmcnt(2)
v_cvt_pk_bf16_f32 v184, v184, v185
v_cvt_pk_bf16_f32 v185, v186, v187
M v[224:227], a[96:99], a[176:179], v[224:227]
s_add_u32 s94, s92, 8192
buffer_store_dwordx4 v[104:107], v1, s[16:19], s94 offen offset:1024 sc1
v_cvt_pk_bf16_f32 v186, v188, v189
v_cvt_pk_bf16_f32 v187, v190, v191
M v[224:227], a[100:103], a[180:183], v[224:227]
s_sub_u32 s54, s54, 1
s_cmp_eq_u32 s54, 0
s_cselect_b32 s58, s55, s56
s_add_u32 s25, s25, s58
M v[228:231], a[108:111], a[180:183], v[228:231]
M v[228:231], a[104:107], a[176:179], v[228:231]
v_pk_mul_f32 v[192:193], v[192:193], s[4:5]
v_pk_mul_f32 v[194:195], v[194:195], s[4:5]
v_pk_mul_f32 v[196:197], v[196:197], s[4:5]
M v[232:235], a[112:115], a[176:179], v[232:235]
v_pk_mul_f32 v[198:199], v[198:199], s[4:5]
v_cvt_pk_bf16_f32 v192, v192, v193
M v[232:235], a[116:119], a[180:183], v[232:235]
v_cvt_pk_bf16_f32 v193, v194, v195
v_cvt_pk_bf16_f32 v194, v196, v197
M v[236:239], a[124:127], a[180:183], v[236:239]
v_cvt_pk_bf16_f32 v195, v198, v199
v_pk_mul_f32 v[200:201], v[200:201], s[4:5]
v_pk_mul_f32 v[202:203], v[202:203], s[4:5]
M v[236:239], a[120:123], a[176:179], v[236:239]
s_waitcnt vmcnt(63) lgkmcnt(0)
s_barrier
v_pk_mul_f32 v[204:205], v[204:205], s[4:5]
v_pk_mul_f32 v[206:207], v[206:207], s[4:5]
M v[240:243], a[128:131], a[176:179], v[240:243]
s_add_u32 s94, s92, 8192
buffer_store_dwordx4 v[112:115], v1, s[16:19], s94 offen offset:2048 sc1
v_cvt_pk_bf16_f32 v200, v200, v201
v_cvt_pk_bf16_f32 v201, v202, v203
M v[240:243], a[132:135], a[180:183], v[240:243]
s_add_u32 m0, s28, 18432
s_nop 0
buffer_load_dword v20, s[8:11], s24 offen lds
v_cvt_pk_bf16_f32 v202, v204, v205
v_cvt_pk_bf16_f32 v203, v206, v207
M v[244:247], a[140:143], a[180:183], v[244:247]
v_pk_mul_f32 v[208:209], v[208:209], s[4:5]
v_pk_mul_f32 v[210:211], v[210:211], s[4:5]
v_pk_mul_f32 v[212:213], v[212:213], s[4:5]
M v[244:247], a[136:139], a[176:179], v[244:247]
v_pk_mul_f32 v[214:215], v[214:215], s[4:5]
v_cvt_pk_bf16_f32 v208, v208, v209
M v[248:251], a[144:147], a[176:179], v[248:251]
buffer_load_dword v23, s[8:11], s24 offen offset:256 lds
v_cvt_pk_bf16_f32 v209, v210, v211
v_cvt_pk_bf16_f32 v210, v212, v213
M v[248:251], a[148:151], a[180:183], v[248:251]
v_cvt_pk_bf16_f32 v211, v214, v215
v_pk_mul_f32 v[216:217], v[216:217], s[4:5]
v_pk_mul_f32 v[218:219], v[218:219], s[4:5]
M v[252:255], a[156:159], a[180:183], v[252:255]
s_add_u32 s94, s92, 8192
buffer_store_dwordx4 v[120:123], v1, s[16:19], s94 offen offset:3072 sc1
v_pk_mul_f32 v[220:221], v[220:221], s[4:5]
v_pk_mul_f32 v[222:223], v[222:223], s[4:5]
M v[252:255], a[152:155], a[176:179], v[252:255]
v_cvt_pk_bf16_f32 v216, v216, v217
v_cvt_pk_bf16_f32 v217, v218, v219
M a[0:3], a[96:99], a[184:187], a[0:3]
v_cvt_pk_bf16_f32 v218, v220, v221
v_cvt_pk_bf16_f32 v219, v222, v223
M a[0:3], a[100:103], a[188:191], a[0:3]
s_add_u32 m0, s29, 20480
s_nop 0
buffer_load_dwordx4 v2, s[8:11], s23 offen offset:0 lds
M a[4:7], a[108:111], a[188:191], a[4:7]
M a[4:7], a[104:107], a[184:187], a[4:7]
v_pk_mul_f32 v[224:225], v[224:225], s[4:5]
v_pk_mul_f32 v[226:227], v[226:227], s[4:5]
v_pk_mul_f32 v[228:229], v[228:229], s[4:5]
M a[8:11], a[112:115], a[184:187], a[8:11]
buffer_load_dwordx4 v3, s[8:11], s23 offen offset:1024 lds
v_pk_mul_f32 v[230:231], v[230:231], s[4:5]
v_cvt_pk_bf16_f32 v224, v224, v225
M a[8:11], a[116:119], a[188:191], a[8:11]
s_add_u32 s94, s92, 12288
buffer_store_dwordx4 v[128:131], v1, s[16:19], s94 offen offset:0 sc1
v_cvt_pk_bf16_f32 v225, v226, v227
v_cvt_pk_bf16_f32 v226, v228, v229
M a[12:15], a[124:127], a[188:191], a[12:15]
v_cvt_pk_bf16_f32 v227, v230, v231
v_pk_mul_f32 v[232:233], v[232:233], s[4:5]
v_pk_mul_f32 v[234:235], v[234:235], s[4:5]
M a[12:15], a[120:123], a[184:187], a[12:15]
v_pk_mul_f32 v[236:237], v[236:237], s[4:5]
v_pk_mul_f32 v[238:239], v[238:239], s[4:5]
M a[16:19], a[128:131], a[184:187], a[16:19]
buffer_load_dwordx4 v4, s[8:11], s23 offen offset:2048 lds
v_cvt_pk_bf16_f32 v232, v232, v233
v_cvt_pk_bf16_f32 v233, v234, v235
M a[16:19], a[132:135], a[188:191], a[16:19]
v_cvt_pk_bf16_f32 v234, v236, v237
v_cvt_pk_bf16_f32 v235, v238, v239
M a[20:23], a[140:143], a[188:191], a[20:23]
v_pk_mul_f32 v[240:241], v[240:241], s[4:5]
v_pk_mul_f32 v[242:243], v[242:243], s[4:5]
v_pk_mul_f32 v[244:245], v[244:245], s[4:5]
M a[20:23], a[136:139], a[184:187], a[20:23]
buffer_load_dwordx4 v5, s[8:11], s23 offen offset:3072 lds
v_pk_mul_f32 v[246:247], v[246:247], s[4:5]
v_cvt_pk_bf16_f32 v240, v240, v241
M a[24:27], a[144:147], a[184:187], a[24:27]
s_add_u32 s94, s92, 12288
buffer_store_dwordx4 v[136:139], v1, s[16:19], s94 offen offset:1024 sc1
v_cvt_pk_bf16_f32 v241, v242, v243
v_cvt_pk_bf16_f32 v242, v244, v245
M a[24:27], a[148:151], a[188:191], a[24:27]
v_cvt_pk_bf16_f32 v243, v246, v247
v_pk_mul_f32 v[248:249], v[248:249], s[4:5]
v_pk_mul_f32 v[250:251], v[250:251], s[4:5]
M a[28:31], a[156:159], a[188:191], a[28:31]
v_pk_mul_f32 v[252:253], v[252:253], s[4:5]
v_pk_mul_f32 v[254:255], v[254:255], s[4:5]
M a[28:31], a[152:155], a[184:187], a[28:31]
v_cvt_pk_bf16_f32 v248, v248, v249
v_cvt_pk_bf16_f32 v249, v250, v251
v_cvt_pk_bf16_f32 v250, v252, v253
v_cvt_pk_bf16_f32 v251, v254, v255
v_accvgpr_read_b32 v24, a0
v_accvgpr_read_b32 v25, a1
v_accvgpr_read_b32 v26, a2
v_accvgpr_read_b32 v27, a3
v_accvgpr_read_b32 v28, a4
v_accvgpr_read_b32 v29, a5
v_accvgpr_read_b32 v30, a6
v_accvgpr_read_b32 v31, a7
v_pk_mul_f32 v[24:25], v[24:25], s[4:5]
v_pk_mul_f32 v[26:27], v[26:27], s[4:5]
v_pk_mul_f32 v[28:29], v[28:29], s[4:5]
v_pk_mul_f32 v[30:31], v[30:31], s[4:5]
v_cvt_pk_bf16_f32 v36, v24, v25
v_cvt_pk_bf16_f32 v37, v26, v27
v_cvt_pk_bf16_f32 v38, v28, v29
v_cvt_pk_bf16_f32 v39, v30, v31
v_accvgpr_read_b32 v24, a8
v_accvgpr_read_b32 v25, a9
v_accvgpr_read_b32 v26, a10
v_accvgpr_read_b32 v27, a11
v_accvgpr_read_b32 v28, a12
v_accvgpr_read_b32 v29, a13
v_accvgpr_read_b32 v30, a14
v_accvgpr_read_b32 v31, a15
v_pk_mul_f32 v[24:25], v[24:25], s[4:5]
v_pk_mul_f32 v[26:27], v[26:27], s[4:5]
v_pk_mul_f32 v[28:29], v[28:29], s[4:5]
v_pk_mul_f32 v[30:31], v[30:31], s[4:5]
v_cvt_pk_bf16_f32 v44, v24, v25
v_cvt_pk_bf16_f32 v45, v26, v27
v_cvt_pk_bf16_f32 v46, v28, v29
v_cvt_pk_bf16_f32 v47, v30, v31
v_accvgpr_read_b32 v24, a16
v_accvgpr_read_b32 v25, a17
v_accvgpr_read_b32 v26, a18
v_accvgpr_read_b32 v27, a19
v_accvgpr_read_b32 v28, a20
v_accvgpr_read_b32 v29, a21
v_accvgpr_read_b32 v30, a22
v_accvgpr_read_b32 v31, a23
v_pk_mul_f32 v[24:25], v[24:25], s[4:5]
v_pk_mul_f32 v[26:27], v[26:27], s[4:5]
v_pk_mul_f32 v[28:29], v[28:29], s[4:5]
v_pk_mul_f32 v[30:31], v[30:31], s[4:5]
v_cvt_pk_bf16_f32 v52, v24, v25
v_cvt_pk_bf16_f32 v53, v26, v27
v_cvt_pk_bf16_f32 v54, v28, v29
v_cvt_pk_bf16_f32 v55, v30, v31
v_accvgpr_read_b32 v24, a24
v_accvgpr_read_b32 v25, a25
v_accvgpr_read_b32 v26, a26
v_accvgpr_read_b32 v27, a27
v_accvgpr_read_b32 v28, a28
v_accvgpr_read_b32 v29, a29
v_accvgpr_read_b32 v30, a30
v_accvgpr_read_b32 v31, a31
v_pk_mul_f32 v[24:25], v[24:25], s[4:5]
v_pk_mul_f32 v[26:27], v[26:27], s[4:5]
v_pk_mul_f32 v[28:29], v[28:29], s[4:5]
v_pk_mul_f32 v[30:31], v[30:31], s[4:5]
v_cvt_pk_bf16_f32 v60, v24, v25
v_cvt_pk_bf16_f32 v61, v26, v27
v_cvt_pk_bf16_f32 v62, v28, v29
v_cvt_pk_bf16_f32 v63, v30, v31
s_branch Lk1_b
Lk1_spin:
s_add_u32 s40, s40, 1
s_cmp_gt_u32 s40, 1048576
s_cbranch_scc1 Lk1_got
s_sleep 2
buffer_load_dword v126, v119, s[36:39], 0 offen offset:128 sc1
s_waitcnt vmcnt(0)
v_cmp_gt_u32 vcc, 0x80, v126
s_nop 0
s_cbranch_vccnz Lk1_spin
s_branch Lk1_got
Lk1_spinq:
s_add_u32 s40, s40, 1
s_cmp_gt_u32 s40, 1048576
s_cbranch_scc1 Lk1_gotq
s_sleep 2
buffer_load_dword v125, v119, s[36:39], 0 offen offset:0 sc1
s_waitcnt vmcnt(0)
v_cmp_gt_u32 vcc, 0x80, v125
s_nop 0
s_cbranch_vccnz Lk1_spinq
s_branch Lk1_gotq
Lk1_kv:
M v[32:35], a[32:35], a[160:163], 0
s_add_u32 s23, s23, 128
s_cmp_eq_u32 s23, s25
s_cselect_b32 s23, s26, s23
M v[32:35], a[36:39], a[164:167], v[32:35]
ds_read_b128 a[176:179], v10 offset:4096
ds_read_b128 a[180:183], v11 offset:4096
M v[36:39], a[44:47], a[164:167], 0
M v[36:39], a[40:43], a[160:163], v[36:39]
ds_read_b64_tr_b16 a[96:97], v12 offset:32768
ds_read_b64_tr_b16 a[98:99], v12 offset:34816
M v[40:43], a[48:51], a[160:163], 0
M v[40:43], a[52:55], a[164:167], v[40:43]
M v[44:47], a[60:63], a[164:167], 0
s_add_u32 m0, s29, 81920
s_nop 0
buffer_load_dwordx4 v6, s[12:15], s24 offen offset:0 lds
M v[44:47], a[56:59], a[160:163], v[44:47]
ds_read_b64_tr_b16 a[104:105], v13 offset:32768
ds_read_b64_tr_b16 a[106:107], v13 offset:34816
M v[48:51], a[64:67], a[160:163], 0
M v[48:51], a[68:71], a[164:167], v[48:51]
M v[52:55], a[76:79], a[164:167], 0
M v[52:55], a[72:75], a[160:163], v[52:55]
ds_read_b64_tr_b16 a[112:113], v14 offset:32768
ds_read_b64_tr_b16 a[114:115], v14 offset:34816
M v[56:59], a[80:83], a[160:163], 0
M v[56:59], a[84:87], a[164:167], v[56:59]
buffer_load_dwordx4 v7, s[12:15], s24 offen offset:1024 lds
M v[60:63], a[92:95], a[164:167], 0
M v[60:63], a[88:91], a[160:163], v[60:63]
ds_read_b64_tr_b16 a[120:121], v15 offset:32768
ds_read_b64_tr_b16 a[122:123], v15 offset:34816
M v[64:67], a[32:35], a[168:171], 0
M v[64:67], a[36:39], a[172:175], v[64:67]
ds_read_b128 a[184:187], v10 offset:6144
ds_read_b128 a[188:191], v11 offset:6144
M v[68:71], a[44:47], a[172:175], 0
M v[68:71], a[40:43], a[168:171], v[68:71]
ds_read_b64_tr_b16 a[128:129], v16 offset:32768
ds_read_b64_tr_b16 a[130:131], v16 offset:34816
M v[72:75], a[48:51], a[168:171], 0
buffer_load_dwordx4 v8, s[12:15], s24 offen offset:2048 lds
M v[72:75], a[52:55], a[172:175], v[72:75]
M v[76:79], a[60:63], a[172:175], 0
M v[76:79], a[56:59], a[168:171], v[76:79]
ds_read_b64_tr_b16 a[136:137], v17 offset:32768
ds_read_b64_tr_b16 a[138:139], v17 offset:34816
M v[80:83], a[64:67], a[168:171], 0
M v[80:83], a[68:71], a[172:175], v[80:83]
M v[84:87], a[76:79], a[172:175], 0
buffer_load_dwordx4 v9, s[12:15], s24 offen offset:3072 lds
M v[84:87], a[72:75], a[168:171], v[84:87]
ds_read_b64_tr_b16 a[144:145], v18 offset:32768
ds_read_b64_tr_b16 a[146:147], v18 offset:34816
M v[88:91], a[80:83], a[168:171], 0
M v[88:91], a[84:87], a[172:175], v[88:91]
M v[92:95], a[92:95], a[172:175], 0
M v[92:95], a[88:91], a[168:171], v[92:95]
s_waitcnt lgkmcnt(15)
ds_read_b64_tr_b16 a[152:153], v19 offset:32768
ds_read_b64_tr_b16 a[154:155], v19 offset:34816
M v[96:99], a[32:35], a[176:179], 0
s_add_u32 s24, s24, 262144
s_cmp_eq_u32 s24, s27
s_cselect_b32 s24, s28, s24
s_sub_u32 s6, s6, 1
s_cmp_eq_u32 s6, 0
s_cselect_b64 s[12:13], s[64:65], s[12:13]
M v[96:99], a[36:39], a[180:183], v[96:99]
M v[100:103], a[44:47], a[180:183], 0
M v[100:103], a[40:43], a[176:179], v[100:103]
M v[104:107], a[48:51], a[176:179], 0
M v[104:107], a[52:55], a[180:183], v[104:107]
M v[108:111], a[60:63], a[180:183], 0
M v[108:111], a[56:59], a[176:179], v[108:111]
s_waitcnt vmcnt(16) lgkmcnt(0)
s_barrier
ds_read_b128 a[160:163], v10 offset:16384
ds_read_b128 a[164:167], v11 offset:16384
M v[112:115], a[64:67], a[176:179], 0
s_add_u32 m0, s29, 0
s_nop 0
buffer_load_dwordx4 v2, s[8:11], s23 offen offset:0 lds
M v[112:115], a[68:71], a[180:183], v[112:115]
M v[116:119], a[76:79], a[180:183], 0
M v[116:119], a[72:75], a[176:179], v[116:119]
ds_read_b64_tr_b16 a[100:101], v12 offset:49152
ds_read_b64_tr_b16 a[102:103], v12 offset:51200
M v[120:123], a[80:83], a[176:179], 0
M v[120:123], a[84:87], a[180:183], v[120:123]
M v[124:127], a[92:95], a[180:183], 0
buffer_load_dwordx4 v3, s[8:11], s23 offen offset:1024 lds
M v[124:127], a[88:91], a[176:179], v[124:127]
M v[128:131], a[32:35], a[184:187], 0
M v[128:131], a[36:39], a[188:191], v[128:131]
ds_read_b128 a[168:171], v10 offset:18432
ds_read_b128 a[172:175], v11 offset:18432
ds_read_b64_tr_b16 a[108:109], v13 offset:49152
ds_read_b64_tr_b16 a[110:111], v13 offset:51200
M v[132:135], a[44:47], a[188:191], 0
M v[132:135], a[40:43], a[184:187], v[132:135]
M v[136:139], a[48:51], a[184:187], 0
M v[136:139], a[52:55], a[188:191], v[136:139]
buffer_load_dwordx4 v4, s[8:11], s23 offen offset:2048 lds
M v[140:143], a[60:63], a[188:191], 0
M v[140:143], a[56:59], a[184:187], v[140:143]
ds_read_b64_tr_b16 a[116:117], v14 offset:49152
ds_read_b64_tr_b16 a[118:119], v14 offset:51200
M v[144:147], a[64:67], a[184:187], 0
M v[144:147], a[68:71], a[188:191], v[144:147]
M v[148:151], a[76:79], a[188:191], 0
M v[148:151], a[72:75], a[184:187], v[148:151]
M v[152:155], a[80:83], a[184:187], 0
buffer_load_dwordx4 v5, s[8:11], s23 offen offset:3072 lds
M v[152:155], a[84:87], a[188:191], v[152:155]
ds_read_b64_tr_b16 a[124:125], v15 offset:49152
ds_read_b64_tr_b16 a[126:127], v15 offset:51200
M v[156:159], a[92:95], a[188:191], 0
M v[156:159], a[88:91], a[184:187], v[156:159]
s_waitcnt lgkmcnt(10)
M v[160:163], a[32:35], a[160:163], 0
M v[160:163], a[36:39], a[164:167], v[160:163]
ds_read_b128 a[176:179], v10 offset:20480
ds_read_b128 a[180:183], v11 offset:20480
M v[164:167], a[44:47], a[164:167], 0
M v[164:167], a[40:43], a[160:163], v[164:167]
ds_read_b64_tr_b16 a[132:133], v16 offset:49152
ds_read_b64_tr_b16 a[134:135], v16 offset:51200
M v[168:171], a[48:51], a[160:163], 0
M v[168:171], a[52:55], a[164:167], v[168:171]
s_add_u32 m0, s29, 98304
s_nop 0
buffer_load_dwordx4 v6, s[12:15], s24 offen offset:0 lds
M v[172:175], a[60:63], a[164:167], 0
M v[172:175], a[56:59], a[160:163], v[172:175]
M v[176:179], a[64:67], a[160:163], 0
M v[176:179], a[68:71], a[164:167], v[176:179]
ds_read_b64_tr_b16 a[140:141], v17 offset:49152
ds_read_b64_tr_b16 a[142:143], v17 offset:51200
M v[180:183], a[76:79], a[164:167], 0
M v[180:183], a[72:75], a[160:163], v[180:183]
buffer_load_dwordx4 v7, s[12:15], s24 offen offset:1024 lds
M v[184:187], a[80:83], a[160:163], 0
M v[184:187], a[84:87], a[164:167], v[184:187]
M v[188:191], a[92:95], a[164:167], 0
M v[188:191], a[88:91], a[160:163], v[188:191]
s_waitcnt lgkmcnt(12)
ds_read_b64_tr_b16 a[148:149], v18 offset:49152
ds_read_b64_tr_b16 a[150:151], v18 offset:51200
M v[192:195], a[32:35], a[168:171], 0
M v[192:195], a[36:39], a[172:175], v[192:195]
ds_read_b128 a[184:187], v10 offset:22528
ds_read_b128 a[188:191], v11 offset:22528
M v[196:199], a[44:47], a[172:175], 0
M v[196:199], a[40:43], a[168:171], v[196:199]
buffer_load_dwordx4 v8, s[12:15], s24 offen offset:2048 lds
M v[200:203], a[48:51], a[168:171], 0
M v[200:203], a[52:55], a[172:175], v[200:203]
ds_read_b64_tr_b16 a[156:157], v19 offset:49152
ds_read_b64_tr_b16 a[158:159], v19 offset:51200
M v[204:207], a[60:63], a[172:175], 0
M v[204:207], a[56:59], a[168:171], v[204:207]
M v[208:211], a[64:67], a[168:171], 0
M v[208:211], a[68:71], a[172:175], v[208:211]
buffer_load_dwordx4 v9, s[12:15], s24 offen offset:3072 lds
M v[212:215], a[76:79], a[172:175], 0
M v[212:215], a[72:75], a[168:171], v[212:215]
M v[216:219], a[80:83], a[168:171], 0
M v[216:219], a[84:87], a[172:175], v[216:219]
M v[220:223], a[92:95], a[172:175], 0
s_add_u32 s24, s24, 262144
M v[220:223], a[88:91], a[168:171], v[220:223]
s_waitcnt lgkmcnt(10)
M v[224:227], a[32:35], a[176:179], 0
M v[224:227], a[36:39], a[180:183], v[224:227]
M v[228:231], a[44:47], a[180:183], 0
M v[228:231], a[40:43], a[176:179], v[228:231]
M v[232:235], a[48:51], a[176:179], 0
M v[232:235], a[52:55], a[180:183], v[232:235]
M v[236:239], a[60:63], a[180:183], 0
M v[236:239], a[56:59], a[176:179], v[236:239]
s_waitcnt vmcnt(16) lgkmcnt(0)
s_barrier
ds_read_b128 a[160:163], v10 offset:32768
ds_read_b128 a[164:167], v11 offset:32768
M v[240:243], a[64:67], a[176:179], 0
s_add_u32 m0, s29, 16384
s_add_u32 s3, s23, s31
buffer_load_dwordx4 v2, s[8:11], s3 offen offset:0 lds
M v[240:243], a[68:71], a[180:183], v[240:243]
M v[244:247], a[76:79], a[180:183], 0
M v[244:247], a[72:75], a[176:179], v[244:247]
M v[248:251], a[80:83], a[176:179], 0
M v[248:251], a[84:87], a[180:183], v[248:251]
buffer_load_dwordx4 v3, s[8:11], s3 offen offset:1024 lds
M v[252:255], a[92:95], a[180:183], 0
M v[252:255], a[88:91], a[176:179], v[252:255]
M a[0:3], a[32:35], a[184:187], 0
M a[0:3], a[36:39], a[188:191], a[0:3]
ds_read_b128 a[168:171], v10 offset:34816
ds_read_b128 a[172:175], v11 offset:34816
M a[4:7], a[44:47], a[188:191], 0
M a[4:7], a[40:43], a[184:187], a[4:7]
M a[8:11], a[48:51], a[184:187], 0
buffer_load_dwordx4 v4, s[8:11], s3 offen offset:2048 lds
M a[8:11], a[52:55], a[188:191], a[8:11]
M a[12:15], a[60:63], a[188:191], 0
M a[12:15], a[56:59], a[184:187], a[12:15]
M a[16:19], a[64:67], a[184:187], 0
M a[16:19], a[68:71], a[188:191], a[16:19]
buffer_load_dwordx4 v5, s[8:11], s3 offen offset:3072 lds
M a[20:23], a[76:79], a[188:191], 0
M a[20:23], a[72:75], a[184:187], a[20:23]
M a[24:27], a[80:83], a[184:187], 0
M a[24:27], a[84:87], a[188:191], a[24:27]
M a[28:31], a[92:95], a[188:191], 0
M a[28:31], a[88:91], a[184:187], a[28:31]
s_waitcnt lgkmcnt(2)
M v[32:35], a[96:99], a[160:163], v[32:35]
s_add_u32 s23, s23, 128
s_cmp_eq_u32 s23, s25
s_cselect_b32 s23, s26, s23
M v[32:35], a[100:103], a[164:167], v[32:35]
ds_read_b128 a[176:179], v10 offset:36864
ds_read_b128 a[180:183], v11 offset:36864
M v[36:39], a[108:111], a[164:167], v[36:39]
M v[36:39], a[104:107], a[160:163], v[36:39]
ds_read_b64_tr_b16 a[32:33], v12 offset:0
ds_read_b64_tr_b16 a[34:35], v12 offset:2048
M v[40:43], a[112:115], a[160:163], v[40:43]
M v[40:43], a[116:119], a[164:167], v[40:43]
M v[44:47], a[124:127], a[164:167], v[44:47]
s_add_u32 m0, s29, 114688
s_nop 0
buffer_load_dwordx4 v6, s[12:15], s24 offen offset:0 lds
M v[44:47], a[120:123], a[160:163], v[44:47]
ds_read_b64_tr_b16 a[40:41], v13 offset:0
ds_read_b64_tr_b16 a[42:43], v13 offset:2048
M v[48:51], a[128:131], a[160:163], v[48:51]
M v[48:51], a[132:135], a[164:167], v[48:51]
M v[52:55], a[140:143], a[164:167], v[52:55]
M v[52:55], a[136:139], a[160:163], v[52:55]
ds_read_b64_tr_b16 a[48:49], v14 offset:0
ds_read_b64_tr_b16 a[50:51], v14 offset:2048
M v[56:59], a[144:147], a[160:163], v[56:59]
M v[56:59], a[148:151], a[164:167], v[56:59]
buffer_load_dwordx4 v7, s[12:15], s24 offen offset:1024 lds
M v[60:63], a[156:159], a[164:167], v[60:63]
M v[60:63], a[152:155], a[160:163], v[60:63]
s_waitcnt lgkmcnt(8)
ds_read_b64_tr_b16 a[56:57], v15 offset:0
ds_read_b64_tr_b16 a[58:59], v15 offset:2048
M v[64:67], a[96:99], a[168:171], v[64:67]
M v[64:67], a[100:103], a[172:175], v[64:67]
ds_read_b128 a[184:187], v10 offset:38912
ds_read_b128 a[188:191], v11 offset:38912
M v[68:71], a[108:111], a[172:175], v[68:71]
M v[68:71], a[104:107], a[168:171], v[68:71]
ds_read_b64_tr_b16 a[64:65], v16 offset:0
ds_read_b64_tr_b16 a[66:67], v16 offset:2048
M v[72:75], a[112:115], a[168:171], v[72:75]
buffer_load_dwordx4 v8, s[12:15], s24 offen offset:2048 lds
M v[72:75], a[116:119], a[172:175], v[72:75]
M v[76:79], a[124:127], a[172:175], v[76:79]
M v[76:79], a[120:123], a[168:171], v[76:79]
ds_read_b64_tr_b16 a[72:73], v17 offset:0
ds_read_b64_tr_b16 a[74:75], v17 offset:2048
M v[80:83], a[128:131], a[168:171], v[80:83]
M v[80:83], a[132:135], a[172:175], v[80:83]
M v[84:87], a[140:143], a[172:175], v[84:87]
buffer_load_dwordx4 v9, s[12:15], s24 offen offset:3072 lds
M v[84:87], a[136:139], a[168:171], v[84:87]
ds_read_b64_tr_b16 a[80:81], v18 offset:0
ds_read_b64_tr_b16 a[82:83], v18 offset:2048
M v[88:91], a[144:147], a[168:171], v[88:91]
M v[88:91], a[148:151], a[172:175], v[88:91]
M v[92:95], a[156:159], a[172:175], v[92:95]
M v[92:95], a[152:155], a[168:171], v[92:95]
s_waitcnt lgkmcnt(15)
ds_read_b64_tr_b16 a[88:89], v19 offset:0
ds_read_b64_tr_b16 a[90:91], v19 offset:2048
M v[96:99], a[96:99], a[176:179], v[96:99]
s_add_u32 s24, s24, 262144
s_cmp_eq_u32 s24, s27
s_cselect_b32 s24, s28, s24
s_sub_u32 s6, s6, 1
s_cmp_eq_u32 s6, 0
s_cselect_b64 s[12:13], s[64:65], s[12:13]
M v[96:99], a[100:103], a[180:183], v[96:99]
M v[100:103], a[108:111], a[180:183], v[100:103]
M v[100:103], a[104:107], a[176:179], v[100:103]
M v[104:107], a[112:115], a[176:179], v[104:107]
M v[104:107], a[116:119], a[180:183], v[104:107]
M v[108:111], a[124:127], a[180:183], v[108:111]
M v[108:111], a[120:123], a[176:179], v[108:111]
s_waitcnt vmcnt(16) lgkmcnt(0)
s_barrier
ds_read_b128 a[160:163], v10 offset:49152
ds_read_b128 a[164:167], v11 offset:49152
M v[112:115], a[128:131], a[176:179], v[112:115]
s_add_u32 m0, s29, 32768
s_nop 0
buffer_load_dwordx4 v2, s[8:11], s23 offen offset:0 lds
M v[112:115], a[132:135], a[180:183], v[112:115]
M v[116:119], a[140:143], a[180:183], v[116:119]
M v[116:119], a[136:139], a[176:179], v[116:119]
ds_read_b64_tr_b16 a[36:37], v12 offset:16384
ds_read_b64_tr_b16 a[38:39], v12 offset:18432
M v[120:123], a[144:147], a[176:179], v[120:123]
M v[120:123], a[148:151], a[180:183], v[120:123]
M v[124:127], a[156:159], a[180:183], v[124:127]
buffer_load_dwordx4 v3, s[8:11], s23 offen offset:1024 lds
M v[124:127], a[152:155], a[176:179], v[124:127]
M v[128:131], a[96:99], a[184:187], v[128:131]
M v[128:131], a[100:103], a[188:191], v[128:131]
ds_read_b128 a[168:171], v10 offset:51200
ds_read_b128 a[172:175], v11 offset:51200
ds_read_b64_tr_b16 a[44:45], v13 offset:16384
ds_read_b64_tr_b16 a[46:47], v13 offset:18432
M v[132:135], a[108:111], a[188:191], v[132:135]
M v[132:135], a[104:107], a[184:187], v[132:135]
M v[136:139], a[112:115], a[184:187], v[136:139]
M v[136:139], a[116:119], a[188:191], v[136:139]
buffer_load_dwordx4 v4, s[8:11], s23 offen offset:2048 lds
M v[140:143], a[124:127], a[188:191], v[140:143]
M v[140:143], a[120:123], a[184:187], v[140:143]
ds_read_b64_tr_b16 a[52:53], v14 offset:16384
ds_read_b64_tr_b16 a[54:55], v14 offset:18432
M v[144:147], a[128:131], a[184:187], v[144:147]
M v[144:147], a[132:135], a[188:191], v[144:147]
M v[148:151], a[140:143], a[188:191], v[148:151]
M v[148:151], a[136:139], a[184:187], v[148:151]
M v[152:155], a[144:147], a[184:187], v[152:155]
buffer_load_dwordx4 v5, s[8:11], s23 offen offset:3072 lds
M v[152:155], a[148:151], a[188:191], v[152:155]
ds_read_b64_tr_b16 a[60:61], v15 offset:16384
ds_read_b64_tr_b16 a[62:63], v15 offset:18432
M v[156:159], a[156:159], a[188:191], v[156:159]
M v[156:159], a[152:155], a[184:187], v[156:159]
s_waitcnt lgkmcnt(10)
M v[160:163], a[96:99], a[160:163], v[160:163]
M v[160:163], a[100:103], a[164:167], v[160:163]
ds_read_b128 a[176:179], v10 offset:53248
ds_read_b128 a[180:183], v11 offset:53248
M v[164:167], a[108:111], a[164:167], v[164:167]
M v[164:167], a[104:107], a[160:163], v[164:167]
ds_read_b64_tr_b16 a[68:69], v16 offset:16384
ds_read_b64_tr_b16 a[70:71], v16 offset:18432
M v[168:171], a[112:115], a[160:163], v[168:171]
M v[168:171], a[116:119], a[164:167], v[168:171]
s_add_u32 m0, s29, 65536
s_nop 0
buffer_load_dwordx4 v6, s[12:15], s24 offen offset:0 lds
M v[172:175], a[124:127], a[164:167], v[172:175]
M v[172:175], a[120:123], a[160:163], v[172:175]
M v[176:179], a[128:131], a[160:163], v[176:179]
M v[176:179], a[132:135], a[164:167], v[176:179]
ds_read_b64_tr_b16 a[76:77], v17 offset:16384
ds_read_b64_tr_b16 a[78:79], v17 offset:18432
M v[180:183], a[140:143], a[164:167], v[180:183]
M v[180:183], a[136:139], a[160:163], v[180:183]
buffer_load_dwordx4 v7, s[12:15], s24 offen offset:1024 lds
M v[184:187], a[144:147], a[160:163], v[184:187]
M v[184:187], a[148:151], a[164:167], v[184:187]
M v[188:191], a[156:159], a[164:167], v[188:191]
M v[188:191], a[152:155], a[160:163], v[188:191]
s_waitcnt lgkmcnt(12)
ds_read_b64_tr_b16 a[84:85], v18 offset:16384
ds_read_b64_tr_b16 a[86:87], v18 offset:18432
M v[192:195], a[96:99], a[168:171], v[192:195]
M v[192:195], a[100:103], a[172:175], v[192:195]
ds_read_b128 a[184:187], v10 offset:55296
ds_read_b128 a[188:191], v11 offset:55296
M v[196:199], a[108:111], a[172:175], v[196:199]
M v[196:199], a[104:107], a[168:171], v[196:199]
buffer_load_dwordx4 v8, s[12:15], s24 offen offset:2048 lds
M v[200:203], a[112:115], a[168:171], v[200:203]
M v[200:203], a[116:119], a[172:175], v[200:203]
ds_read_b64_tr_b16 a[92:93], v19 offset:16384
ds_read_b64_tr_b16 a[94:95], v19 offset:18432
M v[204:207], a[124:127], a[172:175], v[204:207]
M v[204:207], a[120:123], a[168:171], v[204:207]
M v[208:211], a[128:131], a[168:171], v[208:211]
M v[208:211], a[132:135], a[172:175], v[208:211]
buffer_load_dwordx4 v9, s[12:15], s24 offen offset:3072 lds
M v[212:215], a[140:143], a[172:175], v[212:215]
M v[212:215], a[136:139], a[168:171], v[212:215]
M v[216:219], a[144:147], a[168:171], v[216:219]
M v[216:219], a[148:151], a[172:175], v[216:219]
M v[220:223], a[156:159], a[172:175], v[220:223]
s_add_u32 s24, s24, 262144
M v[220:223], a[152:155], a[168:171], v[220:223]
s_waitcnt lgkmcnt(10)
M v[224:227], a[96:99], a[176:179], v[224:227]
M v[224:227], a[100:103], a[180:183], v[224:227]
M v[228:231], a[108:111], a[180:183], v[228:231]
M v[228:231], a[104:107], a[176:179], v[228:231]
M v[232:235], a[112:115], a[176:179], v[232:235]
M v[232:235], a[116:119], a[180:183], v[232:235]
M v[236:239], a[124:127], a[180:183], v[236:239]
M v[236:239], a[120:123], a[176:179], v[236:239]
s_waitcnt vmcnt(16) lgkmcnt(0)
s_barrier
ds_read_b128 a[160:163], v10 offset:0
ds_read_b128 a[164:167], v11 offset:0
M v[240:243], a[128:131], a[176:179], v[240:243]
s_add_u32 m0, s29, 49152
s_add_u32 s3, s23, s31
buffer_load_dwordx4 v2, s[8:11], s3 offen offset:0 lds
M v[240:243], a[132:135], a[180:183], v[240:243]
M v[244:247], a[140:143], a[180:183], v[244:247]
M v[244:247], a[136:139], a[176:179], v[244:247]
M v[248:251], a[144:147], a[176:179], v[248:251]
M v[248:251], a[148:151], a[180:183], v[248:251]
buffer_load_dwordx4 v3, s[8:11], s3 offen offset:1024 lds
M v[252:255], a[156:159], a[180:183], v[252:255]
M v[252:255], a[152:155], a[176:179], v[252:255]
M a[0:3], a[96:99], a[184:187], a[0:3]
M a[0:3], a[100:103], a[188:191], a[0:3]
ds_read_b128 a[168:171], v10 offset:2048
ds_read_b128 a[172:175], v11 offset:2048
M a[4:7], a[108:111], a[188:191], a[4:7]
M a[4:7], a[104:107], a[184:187], a[4:7]
M a[8:11], a[112:115], a[184:187], a[8:11]
buffer_load_dwordx4 v4, s[8:11], s3 offen offset:2048 lds
M a[8:11], a[116:119], a[188:191], a[8:11]
M a[12:15], a[124:127], a[188:191], a[12:15]
M a[12:15], a[120:123], a[184:187], a[12:15]
M a[16:19], a[128:131], a[184:187], a[16:19]
M a[16:19], a[132:135], a[188:191], a[16:19]
buffer_load_dwordx4 v5, s[8:11], s3 offen offset:3072 lds
M a[20:23], a[140:143], a[188:191], a[20:23]
M a[20:23], a[136:139], a[184:187], a[20:23]
M a[24:27], a[144:147], a[184:187], a[24:27]
M a[24:27], a[148:151], a[188:191], a[24:27]
M a[28:31], a[156:159], a[188:191], a[28:31]
M a[28:31], a[152:155], a[184:187], a[28:31]
s_waitcnt lgkmcnt(2)
s_mov_b32 s30, 2
Lk1_kl:
M v[32:35], a[32:35], a[160:163], v[32:35]
s_add_u32 s23, s23, 128
s_cmp_eq_u32 s23, s25
s_cselect_b32 s23, s26, s23
M v[32:35], a[36:39], a[164:167], v[32:35]
ds_read_b128 a[176:179], v10 offset:4096
ds_read_b128 a[180:183], v11 offset:4096
M v[36:39], a[44:47], a[164:167], v[36:39]
M v[36:39], a[40:43], a[160:163], v[36:39]
ds_read_b64_tr_b16 a[96:97], v12 offset:32768
ds_read_b64_tr_b16 a[98:99], v12 offset:34816
M v[40:43], a[48:51], a[160:163], v[40:43]
M v[40:43], a[52:55], a[164:167], v[40:43]
M v[44:47], a[60:63], a[164:167], v[44:47]
s_add_u32 m0, s29, 81920
s_nop 0
buffer_load_dwordx4 v6, s[12:15], s24 offen offset:0 lds
M v[44:47], a[56:59], a[160:163], v[44:47]
ds_read_b64_tr_b16 a[104:105], v13 offset:32768
ds_read_b64_tr_b16 a[106:107], v13 offset:34816
M v[48:51], a[64:67], a[160:163], v[48:51]
M v[48:51], a[68:71], a[164:167], v[48:51]
M v[52:55], a[76:79], a[164:167], v[52:55]
M v[52:55], a[72:75], a[160:163], v[52:55]
ds_read_b64_tr_b16 a[112:113], v14 offset:32768
ds_read_b64_tr_b16 a[114:115], v14 offset:34816
M v[56:59], a[80:83], a[160:163], v[56:59]
M v[56:59], a[84:87], a[164:167], v[56:59]
buffer_load_dwordx4 v7, s[12:15], s24 offen offset:1024 lds
M v[60:63], a[92:95], a[164:167], v[60:63]
M v[60:63], a[88:91], a[160:163], v[60:63]
s_waitcnt lgkmcnt(8)
ds_read_b64_tr_b16 a[120:121], v15 offset:32768
ds_read_b64_tr_b16 a[122:123], v15 offset:34816
M v[64:67], a[32:35], a[168:171], v[64:67]
M v[64:67], a[36:39], a[172:175], v[64:67]
ds_read_b128 a[184:187], v10 offset:6144
ds_read_b128 a[188:191], v11 offset:6144
M v[68:71], a[44:47], a[172:175], v[68:71]
M v[68:71], a[40:43], a[168:171], v[68:71]
ds_read_b64_tr_b16 a[128:129], v16 offset:32768
ds_read_b64_tr_b16 a[130:131], v16 offset:34816
M v[72:75], a[48:51], a[168:171], v[72:75]
buffer_load_dwordx4 v8, s[12:15], s24 offen offset:2048 lds
M v[72:75], a[52:55], a[172:175], v[72:75]
M v[76:79], a[60:63], a[172:175], v[76:79]
M v[76:79], a[56:59], a[168:171], v[76:79]
ds_read_b64_tr_b16 a[136:137], v17 offset:32768
ds_read_b64_tr_b16 a[138:139], v17 offset:34816
M v[80:83], a[64:67], a[168:171], v[80:83]
M v[80:83], a[68:71], a[172:175], v[80:83]
M v[84:87], a[76:79], a[172:175], v[84:87]
buffer_load_dwordx4 v9, s[12:15], s24 offen offset:3072 lds
M v[84:87], a[72:75], a[168:171], v[84:87]
ds_read_b64_tr_b16 a[144:145], v18 offset:32768
ds_read_b64_tr_b16 a[146:147], v18 offset:34816
M v[88:91], a[80:83], a[168:171], v[88:91]
M v[88:91], a[84:87], a[172:175], v[88:91]
M v[92:95], a[92:95], a[172:175], v[92:95]
M v[92:95], a[88:91], a[168:171], v[92:95]
s_waitcnt lgkmcnt(15)
ds_read_b64_tr_b16 a[152:153], v19 offset:32768
ds_read_b64_tr_b16 a[154:155], v19 offset:34816
M v[96:99], a[32:35], a[176:179], v[96:99]
s_add_u32 s24, s24, 262144
s_cmp_eq_u32 s24, s27
s_cselect_b32 s24, s28, s24
s_sub_u32 s6, s6, 1
s_cmp_eq_u32 s6, 0
s_cselect_b64 s[12:13], s[64:65], s[12:13]
M v[96:99], a[36:39], a[180:183], v[96:99]
M v[100:103], a[44:47], a[180:183], v[100:103]
M v[100:103], a[40:43], a[176:179], v[100:103]
M v[104:107], a[48:51], a[176:179], v[104:107]
M v[104:107], a[52:55], a[180:183], v[104:107]
M v[108:111], a[60:63], a[180:183], v[108:111]
M v[108:111], a[56:59], a[176:179], v[108:111]
s_waitcnt vmcnt(16) lgkmcnt(0)
s_barrier
ds_read_b128 a[160:163], v10 offset:16384
ds_read_b128 a[164:167], v11 offset:16384
M v[112:115], a[64:67], a[176:179], v[112:115]
s_add_u32 m0, s29, 0
s_nop 0
buffer_load_dwordx4 v2, s[8:11], s23 offen offset:0 lds
M v[112:115], a[68:71], a[180:183], v[112:115]
M v[116:119], a[76:79], a[180:183], v[116:119]
M v[116:119], a[72:75], a[176:179], v[116:119]
ds_read_b64_tr_b16 a[100:101], v12 offset:49152
ds_read_b64_tr_b16 a[102:103], v12 offset:51200
M v[120:123], a[80:83], a[176:179], v[120:123]
M v[120:123], a[84:87], a[180:183], v[120:123]
M v[124:127], a[92:95], a[180:183], v[124:127]
buffer_load_dwordx4 v3, s[8:11], s23 offen offset:1024 lds
M v[124:127], a[88:91], a[176:179], v[124:127]
M v[128:131], a[32:35], a[184:187], v[128:131]
M v[128:131], a[36:39], a[188:191], v[128:131]
ds_read_b128 a[168:171], v10 offset:18432
ds_read_b128 a[172:175], v11 offset:18432
ds_read_b64_tr_b16 a[108:109], v13 offset:49152
ds_read_b64_tr_b16 a[110:111], v13 offset:51200
M v[132:135], a[44:47], a[188:191], v[132:135]
M v[132:135], a[40:43], a[184:187], v[132:135]
M v[136:139], a[48:51], a[184:187], v[136:139]
M v[136:139], a[52:55], a[188:191], v[136:139]
buffer_load_dwordx4 v4, s[8:11], s23 offen offset:2048 lds
M v[140:143], a[60:63], a[188:191], v[140:143]
M v[140:143], a[56:59], a[184:187], v[140:143]
ds_read_b64_tr_b16 a[116:117], v14 offset:49152
ds_read_b64_tr_b16 a[118:119], v14 offset:51200
M v[144:147], a[64:67], a[184:187], v[144:147]
M v[144:147], a[68:71], a[188:191], v[144:147]
M v[148:151], a[76:79], a[188:191], v[148:151]
M v[148:151], a[72:75], a[184:187], v[148:151]
M v[152:155], a[80:83], a[184:187], v[152:155]
buffer_load_dwordx4 v5, s[8:11], s23 offen offset:3072 lds
M v[152:155], a[84:87], a[188:191], v[152:155]
ds_read_b64_tr_b16 a[124:125], v15 offset:49152
ds_read_b64_tr_b16 a[126:127], v15 offset:51200
M v[156:159], a[92:95], a[188:191], v[156:159]
M v[156:159], a[88:91], a[184:187], v[156:159]
s_waitcnt lgkmcnt(10)
M v[160:163], a[32:35], a[160:163], v[160:163]
M v[160:163], a[36:39], a[164:167], v[160:163]
ds_read_b128 a[176:179], v10 offset:20480
ds_read_b128 a[180:183], v11 offset:20480
M v[164:167], a[44:47], a[164:167], v[164:167]
M v[164:167], a[40:43], a[160:163], v[164:167]
ds_read_b64_tr_b16 a[132:133], v16 offset:49152
ds_read_b64_tr_b16 a[134:135], v16 offset:51200
M v[168:171], a[48:51], a[160:163], v[168:171]
M v[168:171], a[52:55], a[164:167], v[168:171]
s_add_u32 m0, s29, 98304
s_nop 0
buffer_load_dwordx4 v6, s[12:15], s24 offen offset:0 lds
M v[172:175], a[60:63], a[164:167], v[172:175]
M v[172:175], a[56:59], a[160:163], v[172:175]
M v[176:179], a[64:67], a[160:163], v[176:179]
M v[176:179], a[68:71], a[164:167], v[176:179]
ds_read_b64_tr_b16 a[140:141], v17 offset:49152
ds_read_b64_tr_b16 a[142:143], v17 offset:51200
M v[180:183], a[76:79], a[164:167], v[180:183]
M v[180:183], a[72:75], a[160:163], v[180:183]
buffer_load_dwordx4 v7, s[12:15], s24 offen offset:1024 lds
M v[184:187], a[80:83], a[160:163], v[184:187]
M v[184:187], a[84:87], a[164:167], v[184:187]
M v[188:191], a[92:95], a[164:167], v[188:191]
M v[188:191], a[88:91], a[160:163], v[188:191]
s_waitcnt lgkmcnt(12)
ds_read_b64_tr_b16 a[148:149], v18 offset:49152
ds_read_b64_tr_b16 a[150:151], v18 offset:51200
M v[192:195], a[32:35], a[168:171], v[192:195]
M v[192:195], a[36:39], a[172:175], v[192:195]
ds_read_b128 a[184:187], v10 offset:22528
ds_read_b128 a[188:191], v11 offset:22528
M v[196:199], a[44:47], a[172:175], v[196:199]
M v[196:199], a[40:43], a[168:171], v[196:199]
buffer_load_dwordx4 v8, s[12:15], s24 offen offset:2048 lds
M v[200:203], a[48:51], a[168:171], v[200:203]
M v[200:203], a[52:55], a[172:175], v[200:203]
ds_read_b64_tr_b16 a[156:157], v19 offset:49152
ds_read_b64_tr_b16 a[158:159], v19 offset:51200
M v[204:207], a[60:63], a[172:175], v[204:207]
M v[204:207], a[56:59], a[168:171], v[204:207]
M v[208:211], a[64:67], a[168:171], v[208:211]
M v[208:211], a[68:71], a[172:175], v[208:211]
buffer_load_dwordx4 v9, s[12:15], s24 offen offset:3072 lds
M v[212:215], a[76:79], a[172:175], v[212:215]
M v[212:215], a[72:75], a[168:171], v[212:215]
M v[216:219], a[80:83], a[168:171], v[216:219]
M v[216:219], a[84:87], a[172:175], v[216:219]
M v[220:223], a[92:95], a[172:175], v[220:223]
s_add_u32 s24, s24, 262144
M v[220:223], a[88:91], a[168:171], v[220:223]
s_waitcnt lgkmcnt(10)
M v[224:227], a[32:35], a[176:179], v[224:227]
M v[224:227], a[36:39], a[180:183], v[224:227]
M v[228:231], a[44:47], a[180:183], v[228:231]
M v[228:231], a[40:43], a[176:179], v[228:231]
M v[232:235], a[48:51], a[176:179], v[232:235]
M v[232:235], a[52:55], a[180:183], v[232:235]
M v[236:239], a[60:63], a[180:183], v[236:239]
M v[236:239], a[56:59], a[176:179], v[236:239]
s_waitcnt vmcnt(16) lgkmcnt(0)
s_barrier
ds_read_b128 a[160:163], v10 offset:32768
ds_read_b128 a[164:167], v11 offset:32768
M v[240:243], a[64:67], a[176:179], v[240:243]
s_add_u32 m0, s29, 16384
s_add_u32 s3, s23, s31
buffer_load_dwordx4 v2, s[8:11], s3 offen offset:0 lds
M v[240:243], a[68:71], a[180:183], v[240:243]
M v[244:247], a[76:79], a[180:183], v[244:247]
M v[244:247], a[72:75], a[176:179], v[244:247]
M v[248:251], a[80:83], a[176:179], v[248:251]
M v[248:251], a[84:87], a[180:183], v[248:251]
buffer_load_dwordx4 v3, s[8:11], s3 offen offset:1024 lds
M v[252:255], a[92:95], a[180:183], v[252:255]
M v[252:255], a[88:91], a[176:179], v[252:255]
M a[0:3], a[32:35], a[184:187], a[0:3]
M a[0:3], a[36:39], a[188:191], a[0:3]
ds_read_b128 a[168:171], v10 offset:34816
ds_read_b128 a[172:175], v11 offset:34816
M a[4:7], a[44:47], a[188:191], a[4:7]
M a[4:7], a[40:43], a[184:187], a[4:7]
M a[8:11], a[48:51], a[184:187], a[8:11]
buffer_load_dwordx4 v4, s[8:11], s3 offen offset:2048 lds
M a[8:11], a[52:55], a[188:191], a[8:11]
M a[12:15], a[60:63], a[188:191], a[12:15]
M a[12:15], a[56:59], a[184:187], a[12:15]
M a[16:19], a[64:67], a[184:187], a[16:19]
M a[16:19], a[68:71], a[188:191], a[16:19]
buffer_load_dwordx4 v5, s[8:11], s3 offen offset:3072 lds
M a[20:23], a[76:79], a[188:191], a[20:23]
M a[20:23], a[72:75], a[184:187], a[20:23]
M a[24:27], a[80:83], a[184:187], a[24:27]
M a[24:27], a[84:87], a[188:191], a[24:27]
M a[28:31], a[92:95], a[188:191], a[28:31]
M a[28:31], a[88:91], a[184:187], a[28:31]
s_waitcnt lgkmcnt(2)
M v[32:35], a[96:99], a[160:163], v[32:35]
s_add_u32 s23, s23, 128
s_cmp_eq_u32 s23, s25
s_cselect_b32 s23, s26, s23
M v[32:35], a[100:103], a[164:167], v[32:35]
ds_read_b128 a[176:179], v10 offset:36864
ds_read_b128 a[180:183], v11 offset:36864
M v[36:39], a[108:111], a[164:167], v[36:39]
M v[36:39], a[104:107], a[160:163], v[36:39]
ds_read_b64_tr_b16 a[32:33], v12 offset:0
ds_read_b64_tr_b16 a[34:35], v12 offset:2048
M v[40:43], a[112:115], a[160:163], v[40:43]
M v[40:43], a[116:119], a[164:167], v[40:43]
M v[44:47], a[124:127], a[164:167], v[44:47]
s_add_u32 m0, s29, 114688
s_nop 0
buffer_load_dwordx4 v6, s[12:15], s24 offen offset:0 lds
M v[44:47], a[120:123], a[160:163], v[44:47]
ds_read_b64_tr_b16 a[40:41], v13 offset:0
ds_read_b64_tr_b16 a[42:43], v13 offset:2048
M v[48:51], a[128:131], a[160:163], v[48:51]
M v[48:51], a[132:135], a[164:167], v[48:51]
M v[52:55], a[140:143], a[164:167], v[52:55]
M v[52:55], a[136:139], a[160:163], v[52:55]
ds_read_b64_tr_b16 a[48:49], v14 offset:0
ds_read_b64_tr_b16 a[50:51], v14 offset:2048
M v[56:59], a[144:147], a[160:163], v[56:59]
M v[56:59], a[148:151], a[164:167], v[56:59]
buffer_load_dwordx4 v7, s[12:15], s24 offen offset:1024 lds
M v[60:63], a[156:159], a[164:167], v[60:63]
M v[60:63], a[152:155], a[160:163], v[60:63]
s_waitcnt lgkmcnt(8)
ds_read_b64_tr_b16 a[56:57], v15 offset:0
ds_read_b64_tr_b16 a[58:59], v15 offset:2048
M v[64:67], a[96:99], a[168:171], v[64:67]
M v[64:67], a[100:103], a[172:175], v[64:67]
ds_read_b128 a[184:187], v10 offset:38912
ds_read_b128 a[188:191], v11 offset:38912
M v[68:71], a[108:111], a[172:175], v[68:71]
M v[68:71], a[104:107], a[168:171], v[68:71]
ds_read_b64_tr_b16 a[64:65], v16 offset:0
ds_read_b64_tr_b16 a[66:67], v16 offset:2048
M v[72:75], a[112:115], a[168:171], v[72:75]
buffer_load_dwordx4 v8, s[12:15], s24 offen offset:2048 lds
M v[72:75], a[116:119], a[172:175], v[72:75]
M v[76:79], a[124:127], a[172:175], v[76:79]
M v[76:79], a[120:123], a[168:171], v[76:79]
ds_read_b64_tr_b16 a[72:73], v17 offset:0
ds_read_b64_tr_b16 a[74:75], v17 offset:2048
M v[80:83], a[128:131], a[168:171], v[80:83]
M v[80:83], a[132:135], a[172:175], v[80:83]
M v[84:87], a[140:143], a[172:175], v[84:87]
buffer_load_dwordx4 v9, s[12:15], s24 offen offset:3072 lds
M v[84:87], a[136:139], a[168:171], v[84:87]
ds_read_b64_tr_b16 a[80:81], v18 offset:0
ds_read_b64_tr_b16 a[82:83], v18 offset:2048
M v[88:91], a[144:147], a[168:171], v[88:91]
M v[88:91], a[148:151], a[172:175], v[88:91]
M v[92:95], a[156:159], a[172:175], v[92:95]
M v[92:95], a[152:155], a[168:171], v[92:95]
s_waitcnt lgkmcnt(15)
ds_read_b64_tr_b16 a[88:89], v19 offset:0
ds_read_b64_tr_b16 a[90:91], v19 offset:2048
M v[96:99], a[96:99], a[176:179], v[96:99]
s_add_u32 s24, s24, 262144
s_cmp_eq_u32 s24, s27
s_cselect_b32 s24, s28, s24
s_sub_u32 s6, s6, 1
s_cmp_eq_u32 s6, 0
s_cselect_b64 s[12:13], s[64:65], s[12:13]
M v[96:99], a[100:103], a[180:183], v[96:99]
M v[100:103], a[108:111], a[180:183], v[100:103]
M v[100:103], a[104:107], a[176:179], v[100:103]
M v[104:107], a[112:115], a[176:179], v[104:107]
M v[104:107], a[116:119], a[180:183], v[104:107]
M v[108:111], a[124:127], a[180:183], v[108:111]
M v[108:111], a[120:123], a[176:179], v[108:111]
s_waitcnt vmcnt(16) lgkmcnt(0)
s_barrier
ds_read_b128 a[160:163], v10 offset:49152
ds_read_b128 a[164:167], v11 offset:49152
M v[112:115], a[128:131], a[176:179], v[112:115]
s_add_u32 m0, s29, 32768
s_nop 0
buffer_load_dwordx4 v2, s[8:11], s23 offen offset:0 lds
M v[112:115], a[132:135], a[180:183], v[112:115]
M v[116:119], a[140:143], a[180:183], v[116:119]
M v[116:119], a[136:139], a[176:179], v[116:119]
ds_read_b64_tr_b16 a[36:37], v12 offset:16384
ds_read_b64_tr_b16 a[38:39], v12 offset:18432
M v[120:123], a[144:147], a[176:179], v[120:123]
M v[120:123], a[148:151], a[180:183], v[120:123]
M v[124:127], a[156:159], a[180:183], v[124:127]
buffer_load_dwordx4 v3, s[8:11], s23 offen offset:1024 lds
M v[124:127], a[152:155], a[176:179], v[124:127]
M v[128:131], a[96:99], a[184:187], v[128:131]
M v[128:131], a[100:103], a[188:191], v[128:131]
ds_read_b128 a[168:171], v10 offset:51200
ds_read_b128 a[172:175], v11 offset:51200
ds_read_b64_tr_b16 a[44:45], v13 offset:16384
ds_read_b64_tr_b16 a[46:47], v13 offset:18432
M v[132:135], a[108:111], a[188:191], v[132:135]
M v[132:135], a[104:107], a[184:187], v[132:135]
M v[136:139], a[112:115], a[184:187], v[136:139]
M v[136:139], a[116:119], a[188:191], v[136:139]
buffer_load_dwordx4 v4, s[8:11], s23 offen offset:2048 lds
M v[140:143], a[124:127], a[188:191], v[140:143]
M v[140:143], a[120:123], a[184:187], v[140:143]
ds_read_b64_tr_b16 a[52:53], v14 offset:16384
ds_read_b64_tr_b16 a[54:55], v14 offset:18432
M v[144:147], a[128:131], a[184:187], v[144:147]
M v[144:147], a[132:135], a[188:191], v[144:147]
M v[148:151], a[140:143], a[188:191], v[148:151]
M v[148:151], a[136:139], a[184:187], v[148:151]
M v[152:155], a[144:147], a[184:187], v[152:155]
buffer_load_dwordx4 v5, s[8:11], s23 offen offset:3072 lds
M v[152:155], a[148:151], a[188:191], v[152:155]
ds_read_b64_tr_b16 a[60:61], v15 offset:16384
ds_read_b64_tr_b16 a[62:63], v15 offset:18432
M v[156:159], a[156:159], a[188:191], v[156:159]
M v[156:159], a[152:155], a[184:187], v[156:159]
s_waitcnt lgkmcnt(10)
M v[160:163], a[96:99], a[160:163], v[160:163]
M v[160:163], a[100:103], a[164:167], v[160:163]
ds_read_b128 a[176:179], v10 offset:53248
ds_read_b128 a[180:183], v11 offset:53248
M v[164:167], a[108:111], a[164:167], v[164:167]
M v[164:167], a[104:107], a[160:163], v[164:167]
ds_read_b64_tr_b16 a[68:69], v16 offset:16384
ds_read_b64_tr_b16 a[70:71], v16 offset:18432
M v[168:171], a[112:115], a[160:163], v[168:171]
M v[168:171], a[116:119], a[164:167], v[168:171]
s_add_u32 m0, s29, 65536
s_nop 0
buffer_load_dwordx4 v6, s[12:15], s24 offen offset:0 lds
M v[172:175], a[124:127], a[164:167], v[172:175]
M v[172:175], a[120:123], a[160:163], v[172:175]
M v[176:179], a[128:131], a[160:163], v[176:179]
M v[176:179], a[132:135], a[164:167], v[176:179]
ds_read_b64_tr_b16 a[76:77], v17 offset:16384
ds_read_b64_tr_b16 a[78:79], v17 offset:18432
M v[180:183], a[140:143], a[164:167], v[180:183]
M v[180:183], a[136:139], a[160:163], v[180:183]
buffer_load_dwordx4 v7, s[12:15], s24 offen offset:1024 lds
M v[184:187], a[144:147], a[160:163], v[184:187]
M v[184:187], a[148:151], a[164:167], v[184:187]
M v[188:191], a[156:159], a[164:167], v[188:191]
M v[188:191], a[152:155], a[160:163], v[188:191]
s_waitcnt lgkmcnt(12)
ds_read_b64_tr_b16 a[84:85], v18 offset:16384
ds_read_b64_tr_b16 a[86:87], v18 offset:18432
M v[192:195], a[96:99], a[168:171], v[192:195]
M v[192:195], a[100:103], a[172:175], v[192:195]
ds_read_b128 a[184:187], v10 offset:55296
ds_read_b128 a[188:191], v11 offset:55296
M v[196:199], a[108:111], a[172:175], v[196:199]
M v[196:199], a[104:107], a[168:171], v[196:199]
buffer_load_dwordx4 v8, s[12:15], s24 offen offset:2048 lds
M v[200:203], a[112:115], a[168:171], v[200:203]
M v[200:203], a[116:119], a[172:175], v[200:203]
ds_read_b64_tr_b16 a[92:93], v19 offset:16384
ds_read_b64_tr_b16 a[94:95], v19 offset:18432
M v[204:207], a[124:127], a[172:175], v[204:207]
M v[204:207], a[120:123], a[168:171], v[204:207]
M v[208:211], a[128:131], a[168:171], v[208:211]
M v[208:211], a[132:135], a[172:175], v[208:211]
buffer_load_dwordx4 v9, s[12:15], s24 offen offset:3072 lds
M v[212:215], a[140:143], a[172:175], v[212:215]
M v[212:215], a[136:139], a[168:171], v[212:215]
M v[216:219], a[144:147], a[168:171], v[216:219]
M v[216:219], a[148:151], a[172:175], v[216:219]
M v[220:223], a[156:159], a[172:175], v[220:223]
s_add_u32 s24, s24, 262144
M v[220:223], a[152:155], a[168:171], v[220:223]
s_waitcnt lgkmcnt(10)
M v[224:227], a[96:99], a[176:179], v[224:227]
M v[224:227], a[100:103], a[180:183], v[224:227]
M v[228:231], a[108:111], a[180:183], v[228:231]
M v[228:231], a[104:107], a[176:179], v[228:231]
M v[232:235], a[112:115], a[176:179], v[232:235]
M v[232:235], a[116:119], a[180:183], v[232:235]
M v[236:239], a[124:127], a[180:183], v[236:239]
M v[236:239], a[120:123], a[176:179], v[236:239]
s_waitcnt vmcnt(16) lgkmcnt(0)
s_barrier
ds_read_b128 a[160:163], v10 offset:0
ds_read_b128 a[164:167], v11 offset:0
M v[240:243], a[128:131], a[176:179], v[240:243]
s_add_u32 m0, s29, 49152
s_add_u32 s3, s23, s31
buffer_load_dwordx4 v2, s[8:11], s3 offen offset:0 lds
M v[240:243], a[132:135], a[180:183], v[240:243]
M v[244:247], a[140:143], a[180:183], v[244:247]
M v[244:247], a[136:139], a[176:179], v[244:247]
M v[248:251], a[144:147], a[176:179], v[248:251]
M v[248:251], a[148:151], a[180:183], v[248:251]
buffer_load_dwordx4 v3, s[8:11], s3 offen offset:1024 lds
M v[252:255], a[156:159], a[180:183], v[252:255]
M v[252:255], a[152:155], a[176:179], v[252:255]
M a[0:3], a[96:99], a[184:187], a[0:3]
M a[0:3], a[100:103], a[188:191], a[0:3]
ds_read_b128 a[168:171], v10 offset:2048
ds_read_b128 a[172:175], v11 offset:2048
M a[4:7], a[108:111], a[188:191], a[4:7]
M a[4:7], a[104:107], a[184:187], a[4:7]
M a[8:11], a[112:115], a[184:187], a[8:11]
buffer_load_dwordx4 v4, s[8:11], s3 offen offset:2048 lds
M a[8:11], a[116:119], a[188:191], a[8:11]
M a[12:15], a[124:127], a[188:191], a[12:15]
M a[12:15], a[120:123], a[184:187], a[12:15]
M a[16:19], a[128:131], a[184:187], a[16:19]
M a[16:19], a[132:135], a[188:191], a[16:19]
buffer_load_dwordx4 v5, s[8:11], s3 offen offset:3072 lds
M a[20:23], a[140:143], a[188:191], a[20:23]
M a[20:23], a[136:139], a[184:187], a[20:23]
M a[24:27], a[144:147], a[184:187], a[24:27]
M a[24:27], a[148:151], a[188:191], a[24:27]
M a[28:31], a[156:159], a[188:191], a[28:31]
M a[28:31], a[152:155], a[184:187], a[28:31]
s_waitcnt lgkmcnt(2)
s_sub_u32 s30, s30, 1
s_cmp_lg_u32 s30, 0
s_cbranch_scc1 Lk1_kl
M v[32:35], a[32:35], a[160:163], v[32:35]
s_add_u32 s23, s23, 128
s_cmp_eq_u32 s23, s25
s_cselect_b32 s23, s26, s23
M v[32:35], a[36:39], a[164:167], v[32:35]
ds_read_b128 a[176:179], v10 offset:4096
ds_read_b128 a[180:183], v11 offset:4096
M v[36:39], a[44:47], a[164:167], v[36:39]
M v[36:39], a[40:43], a[160:163], v[36:39]
ds_read_b64_tr_b16 a[96:97], v12 offset:32768
ds_read_b64_tr_b16 a[98:99], v12 offset:34816
M v[40:43], a[48:51], a[160:163], v[40:43]
M v[40:43], a[52:55], a[164:167], v[40:43]
M v[44:47], a[60:63], a[164:167], v[44:47]
s_add_u32 m0, s29, 81920
s_nop 0
buffer_load_dwordx4 v6, s[12:15], s24 offen offset:0 lds
M v[44:47], a[56:59], a[160:163], v[44:47]
ds_read_b64_tr_b16 a[104:105], v13 offset:32768
ds_read_b64_tr_b16 a[106:107], v13 offset:34816
M v[48:51], a[64:67], a[160:163], v[48:51]
M v[48:51], a[68:71], a[164:167], v[48:51]
M v[52:55], a[76:79], a[164:167], v[52:55]
M v[52:55], a[72:75], a[160:163], v[52:55]
ds_read_b64_tr_b16 a[112:113], v14 offset:32768
ds_read_b64_tr_b16 a[114:115], v14 offset:34816
M v[56:59], a[80:83], a[160:163], v[56:59]
M v[56:59], a[84:87], a[164:167], v[56:59]
buffer_load_dwordx4 v7, s[12:15], s24 offen offset:1024 lds
M v[60:63], a[92:95], a[164:167], v[60:63]
M v[60:63], a[88:91], a[160:163], v[60:63]
s_waitcnt lgkmcnt(8)
ds_read_b64_tr_b16 a[120:121], v15 offset:32768
ds_read_b64_tr_b16 a[122:123], v15 offset:34816
M v[64:67], a[32:35], a[168:171], v[64:67]
M v[64:67], a[36:39], a[172:175], v[64:67]
ds_read_b128 a[184:187], v10 offset:6144
ds_read_b128 a[188:191], v11 offset:6144
M v[68:71], a[44:47], a[172:175], v[68:71]
M v[68:71], a[40:43], a[168:171], v[68:71]
ds_read_b64_tr_b16 a[128:129], v16 offset:32768
ds_read_b64_tr_b16 a[130:131], v16 offset:34816
M v[72:75], a[48:51], a[168:171], v[72:75]
buffer_load_dwordx4 v8, s[12:15], s24 offen offset:2048 lds
M v[72:75], a[52:55], a[172:175], v[72:75]
M v[76:79], a[60:63], a[172:175], v[76:79]
M v[76:79], a[56:59], a[168:171], v[76:79]
ds_read_b64_tr_b16 a[136:137], v17 offset:32768
ds_read_b64_tr_b16 a[138:139], v17 offset:34816
M v[80:83], a[64:67], a[168:171], v[80:83]
M v[80:83], a[68:71], a[172:175], v[80:83]
M v[84:87], a[76:79], a[172:175], v[84:87]
buffer_load_dwordx4 v9, s[12:15], s24 offen offset:3072 lds
M v[84:87], a[72:75], a[168:171], v[84:87]
ds_read_b64_tr_b16 a[144:145], v18 offset:32768
ds_read_b64_tr_b16 a[146:147], v18 offset:34816
M v[88:91], a[80:83], a[168:171], v[88:91]
M v[88:91], a[84:87], a[172:175], v[88:91]
M v[92:95], a[92:95], a[172:175], v[92:95]
M v[92:95], a[88:91], a[168:171], v[92:95]
s_waitcnt lgkmcnt(15)
ds_read_b64_tr_b16 a[152:153], v19 offset:32768
ds_read_b64_tr_b16 a[154:155], v19 offset:34816
M v[96:99], a[32:35], a[176:179], v[96:99]
s_add_u32 s24, s24, 262144
s_cmp_eq_u32 s24, s27
s_cselect_b32 s24, s28, s24
s_sub_u32 s6, s6, 1
s_cmp_eq_u32 s6, 0
s_cselect_b64 s[12:13], s[64:65], s[12:13]
M v[96:99], a[36:39], a[180:183], v[96:99]
M v[100:103], a[44:47], a[180:183], v[100:103]
M v[100:103], a[40:43], a[176:179], v[100:103]
M v[104:107], a[48:51], a[176:179], v[104:107]
M v[104:107], a[52:55], a[180:183], v[104:107]
M v[108:111], a[60:63], a[180:183], v[108:111]
M v[108:111], a[56:59], a[176:179], v[108:111]
s_waitcnt vmcnt(16) lgkmcnt(0)
s_barrier
ds_read_b128 a[160:163], v10 offset:16384
ds_read_b128 a[164:167], v11 offset:16384
M v[112:115], a[64:67], a[176:179], v[112:115]
s_add_u32 m0, s29, 0
s_nop 0
buffer_load_dwordx4 v2, s[8:11], s23 offen offset:0 lds
M v[112:115], a[68:71], a[180:183], v[112:115]
M v[116:119], a[76:79], a[180:183], v[116:119]
M v[116:119], a[72:75], a[176:179], v[116:119]
ds_read_b64_tr_b16 a[100:101], v12 offset:49152
ds_read_b64_tr_b16 a[102:103], v12 offset:51200
M v[120:123], a[80:83], a[176:179], v[120:123]
M v[120:123], a[84:87], a[180:183], v[120:123]
M v[124:127], a[92:95], a[180:183], v[124:127]
buffer_load_dwordx4 v3, s[8:11], s23 offen offset:1024 lds
M v[124:127], a[88:91], a[176:179], v[124:127]
M v[128:131], a[32:35], a[184:187], v[128:131]
M v[128:131], a[36:39], a[188:191], v[128:131]
ds_read_b128 a[168:171], v10 offset:18432
ds_read_b128 a[172:175], v11 offset:18432
ds_read_b64_tr_b16 a[108:109], v13 offset:49152
ds_read_b64_tr_b16 a[110:111], v13 offset:51200
M v[132:135], a[44:47], a[188:191], v[132:135]
M v[132:135], a[40:43], a[184:187], v[132:135]
M v[136:139], a[48:51], a[184:187], v[136:139]
M v[136:139], a[52:55], a[188:191], v[136:139]
buffer_load_dwordx4 v4, s[8:11], s23 offen offset:2048 lds
M v[140:143], a[60:63], a[188:191], v[140:143]
M v[140:143], a[56:59], a[184:187], v[140:143]
ds_read_b64_tr_b16 a[116:117], v14 offset:49152
ds_read_b64_tr_b16 a[118:119], v14 offset:51200
M v[144:147], a[64:67], a[184:187], v[144:147]
M v[144:147], a[68:71], a[188:191], v[144:147]
M v[148:151], a[76:79], a[188:191], v[148:151]
M v[148:151], a[72:75], a[184:187], v[148:151]
M v[152:155], a[80:83], a[184:187], v[152:155]
buffer_load_dwordx4 v5, s[8:11], s23 offen offset:3072 lds
s_lshr_b32 s3, s53, 7
s_add_u32 s3, s3, s22
M v[152:155], a[84:87], a[188:191], v[152:155]
ds_read_b64_tr_b16 a[124:125], v15 offset:49152
ds_read_b64_tr_b16 a[126:127], v15 offset:51200
s_lshl_b32 s3, s3, 5
s_lshr_b32 s19, s52, 6
M v[156:159], a[92:95], a[188:191], v[156:159]
s_add_u32 s3, s3, s19
s_lshl_b32 s19, s21, 1
M v[156:159], a[88:91], a[184:187], v[156:159]
s_waitcnt lgkmcnt(10)
s_add_u32 s3, s3, s19
s_lshl_b32 s92, s3, 15
M v[160:163], a[32:35], a[160:163], v[160:163]
s_add_u32 s93, s92, 32768
s_add_u32 s16, s50, 16777216
M v[160:163], a[36:39], a[164:167], v[160:163]
ds_read_b128 a[176:179], v10 offset:20480
ds_read_b128 a[180:183], v11 offset:20480
s_addc_u32 s17, s51, 0
s_mov_b32 s18, 33554432
M v[164:167], a[44:47], a[164:167], v[164:167]
s_mov_b32 s19, 0x00020000
M v[164:167], a[40:43], a[160:163], v[164:167]
ds_read_b64_tr_b16 a[132:133], v16 offset:49152
ds_read_b64_tr_b16 a[134:135], v16 offset:51200
M v[168:171], a[48:51], a[160:163], v[168:171]
M v[168:171], a[52:55], a[164:167], v[168:171]
s_add_u32 m0, s29, 98304
s_nop 0
buffer_load_dwordx4 v6, s[12:15], s24 offen offset:0 lds
M v[172:175], a[60:63], a[164:167], v[172:175]
M v[172:175], a[56:59], a[160:163], v[172:175]
M v[176:179], a[64:67], a[160:163], v[176:179]
M v[176:179], a[68:71], a[164:167], v[176:179]
ds_read_b64_tr_b16 a[140:141], v17 offset:49152
ds_read_b64_tr_b16 a[142:143], v17 offset:51200
M v[180:183], a[76:79], a[164:167], v[180:183]
M v[180:183], a[72:75], a[160:163], v[180:183]
buffer_load_dwordx4 v7, s[12:15], s24 offen offset:1024 lds
M v[184:187], a[80:83], a[160:163], v[184:187]
M v[184:187], a[84:87], a[164:167], v[184:187]
M v[188:191], a[92:95], a[164:167], v[188:191]
M v[188:191], a[88:91], a[160:163], v[188:191]
s_waitcnt lgkmcnt(12)
ds_read_b64_tr_b16 a[148:149], v18 offset:49152
ds_read_b64_tr_b16 a[150:151], v18 offset:51200
M v[192:195], a[32:35], a[168:171], v[192:195]
M v[192:195], a[36:39], a[172:175], v[192:195]
ds_read_b128 a[184:187], v10 offset:22528
ds_read_b128 a[188:191], v11 offset:22528
M v[196:199], a[44:47], a[172:175], v[196:199]
M v[196:199], a[40:43], a[168:171], v[196:199]
buffer_load_dwordx4 v8, s[12:15], s24 offen offset:2048 lds
M v[200:203], a[48:51], a[168:171], v[200:203]
M v[200:203], a[52:55], a[172:175], v[200:203]
ds_read_b64_tr_b16 a[156:157], v19 offset:49152
ds_read_b64_tr_b16 a[158:159], v19 offset:51200
M v[204:207], a[60:63], a[172:175], v[204:207]
M v[204:207], a[56:59], a[168:171], v[204:207]
M v[208:211], a[64:67], a[168:171], v[208:211]
M v[208:211], a[68:71], a[172:175], v[208:211]
buffer_load_dwordx4 v9, s[12:15], s24 offen offset:3072 lds
M v[212:215], a[76:79], a[172:175], v[212:215]
M v[212:215], a[72:75], a[168:171], v[212:215]
M v[216:219], a[80:83], a[168:171], v[216:219]
M v[216:219], a[84:87], a[172:175], v[216:219]
M v[220:223], a[92:95], a[172:175], v[220:223]
s_add_u32 s24, s24, 262144
M v[220:223], a[88:91], a[168:171], v[220:223]
s_waitcnt lgkmcnt(10)
M v[224:227], a[32:35], a[176:179], v[224:227]
M v[224:227], a[36:39], a[180:183], v[224:227]
M v[228:231], a[44:47], a[180:183], v[228:231]
M v[228:231], a[40:43], a[176:179], v[228:231]
M v[232:235], a[48:51], a[176:179], v[232:235]
M v[232:235], a[52:55], a[180:183], v[232:235]
M v[236:239], a[60:63], a[180:183], v[236:239]
M v[236:239], a[56:59], a[176:179], v[236:239]
s_waitcnt vmcnt(16) lgkmcnt(0)
s_barrier
ds_read_b128 a[160:163], v10 offset:32768
ds_read_b128 a[164:167], v11 offset:32768
M v[240:243], a[64:67], a[176:179], v[240:243]
s_add_u32 m0, s29, 16384
s_add_u32 s3, s23, s31
buffer_load_dwordx4 v2, s[8:11], s3 offen offset:0 lds
M v[240:243], a[68:71], a[180:183], v[240:243]
M v[244:247], a[76:79], a[180:183], v[244:247]
M v[244:247], a[72:75], a[176:179], v[244:247]
M v[248:251], a[80:83], a[176:179], v[248:251]
M v[248:251], a[84:87], a[180:183], v[248:251]
buffer_load_dwordx4 v3, s[8:11], s3 offen offset:1024 lds
M v[252:255], a[92:95], a[180:183], v[252:255]
M v[252:255], a[88:91], a[176:179], v[252:255]
M a[0:3], a[32:35], a[184:187], a[0:3]
M a[0:3], a[36:39], a[188:191], a[0:3]
ds_read_b128 a[168:171], v10 offset:34816
ds_read_b128 a[172:175], v11 offset:34816
M a[4:7], a[44:47], a[188:191], a[4:7]
M a[4:7], a[40:43], a[184:187], a[4:7]
M a[8:11], a[48:51], a[184:187], a[8:11]
buffer_load_dwordx4 v4, s[8:11], s3 offen offset:2048 lds
M a[8:11], a[52:55], a[188:191], a[8:11]
M a[12:15], a[60:63], a[188:191], a[12:15]
M a[12:15], a[56:59], a[184:187], a[12:15]
M a[16:19], a[64:67], a[184:187], a[16:19]
M a[16:19], a[68:71], a[188:191], a[16:19]
buffer_load_dwordx4 v5, s[8:11], s3 offen offset:3072 lds
M a[20:23], a[76:79], a[188:191], a[20:23]
M a[20:23], a[72:75], a[184:187], a[20:23]
M a[24:27], a[80:83], a[184:187], a[24:27]
M a[24:27], a[84:87], a[188:191], a[24:27]
M a[28:31], a[92:95], a[188:191], a[28:31]
M a[28:31], a[88:91], a[184:187], a[28:31]
s_waitcnt lgkmcnt(2)
M v[32:35], a[96:99], a[160:163], v[32:35]
s_add_u32 s23, s23, 128
s_cmp_eq_u32 s23, s25
s_cselect_b32 s23, s26, s23
M v[32:35], a[100:103], a[164:167], v[32:35]
ds_read_b128 a[176:179], v10 offset:36864
ds_read_b128 a[180:183], v11 offset:36864
M v[36:39], a[108:111], a[164:167], v[36:39]
M v[36:39], a[104:107], a[160:163], v[36:39]
ds_read_b64_tr_b16 a[32:33], v12 offset:0
ds_read_b64_tr_b16 a[34:35], v12 offset:2048
M v[40:43], a[112:115], a[160:163], v[40:43]
M v[40:43], a[116:119], a[164:167], v[40:43]
M v[44:47], a[124:127], a[164:167], v[44:47]
s_add_u32 m0, s29, 114688
s_nop 0
buffer_load_dwordx4 v6, s[12:15], s24 offen offset:0 lds
M v[44:47], a[120:123], a[160:163], v[44:47]
ds_read_b64_tr_b16 a[40:41], v13 offset:0
ds_read_b64_tr_b16 a[42:43], v13 offset:2048
M v[48:51], a[128:131], a[160:163], v[48:51]
M v[48:51], a[132:135], a[164:167], v[48:51]
M v[52:55], a[140:143], a[164:167], v[52:55]
M v[52:55], a[136:139], a[160:163], v[52:55]
ds_read_b64_tr_b16 a[48:49], v14 offset:0
ds_read_b64_tr_b16 a[50:51], v14 offset:2048
M v[56:59], a[144:147], a[160:163], v[56:59]
buffer_load_dwordx4 v7, s[12:15], s24 offen offset:1024 lds
M v[56:59], a[148:151], a[164:167], v[56:59]
M v[60:63], a[156:159], a[164:167], v[60:63]
M v[60:63], a[152:155], a[160:163], v[60:63]
s_waitcnt lgkmcnt(8)
ds_read_b64_tr_b16 a[56:57], v15 offset:0
ds_read_b64_tr_b16 a[58:59], v15 offset:2048
M v[64:67], a[96:99], a[168:171], v[64:67]
M v[64:67], a[100:103], a[172:175], v[64:67]
ds_read_b128 a[184:187], v10 offset:38912
ds_read_b128 a[188:191], v11 offset:38912
M v[68:71], a[108:111], a[172:175], v[68:71]
M v[68:71], a[104:107], a[168:171], v[68:71]
ds_read_b64_tr_b16 a[64:65], v16 offset:0
ds_read_b64_tr_b16 a[66:67], v16 offset:2048
v_cvt_pk_bf16_f32 v32, v32, v33
v_cvt_pk_bf16_f32 v33, v34, v35
M v[72:75], a[112:115], a[168:171], v[72:75]
buffer_load_dwordx4 v8, s[12:15], s24 offen offset:2048 lds
v_cvt_pk_bf16_f32 v34, v36, v37
v_cvt_pk_bf16_f32 v35, v38, v39
M v[72:75], a[116:119], a[172:175], v[72:75]
v_cvt_pk_bf16_f32 v40, v40, v41
v_cvt_pk_bf16_f32 v41, v42, v43
M v[76:79], a[124:127], a[172:175], v[76:79]
v_cvt_pk_bf16_f32 v42, v44, v45
v_cvt_pk_bf16_f32 v43, v46, v47
M v[76:79], a[120:123], a[168:171], v[76:79]
ds_read_b64_tr_b16 a[72:73], v17 offset:0
ds_read_b64_tr_b16 a[74:75], v17 offset:2048
v_cvt_pk_bf16_f32 v48, v48, v49
v_cvt_pk_bf16_f32 v49, v50, v51
M v[80:83], a[128:131], a[168:171], v[80:83]
v_cvt_pk_bf16_f32 v50, v52, v53
v_cvt_pk_bf16_f32 v51, v54, v55
M v[80:83], a[132:135], a[172:175], v[80:83]
buffer_load_dwordx4 v9, s[12:15], s24 offen offset:3072 lds
v_cvt_pk_bf16_f32 v56, v56, v57
v_cvt_pk_bf16_f32 v57, v58, v59
M v[84:87], a[140:143], a[172:175], v[84:87]
v_cvt_pk_bf16_f32 v58, v60, v61
v_cvt_pk_bf16_f32 v59, v62, v63
M v[84:87], a[136:139], a[168:171], v[84:87]
ds_read_b64_tr_b16 a[80:81], v18 offset:0
ds_read_b64_tr_b16 a[82:83], v18 offset:2048
M v[88:91], a[144:147], a[168:171], v[88:91]
M v[88:91], a[148:151], a[172:175], v[88:91]
M v[92:95], a[156:159], a[172:175], v[92:95]
s_add_u32 s94, s92, 0
buffer_store_dwordx4 v[32:35], v1, s[16:19], s94 offen offset:0 sc1
M v[92:95], a[152:155], a[168:171], v[92:95]
s_waitcnt lgkmcnt(15)
ds_read_b64_tr_b16 a[88:89], v19 offset:0
ds_read_b64_tr_b16 a[90:91], v19 offset:2048
M v[96:99], a[96:99], a[176:179], v[96:99]
s_add_u32 s24, s24, 262144
s_cmp_eq_u32 s24, s27
s_cselect_b32 s24, s28, s24
s_sub_u32 s6, s6, 1
s_cmp_eq_u32 s6, 0
s_cselect_b64 s[12:13], s[64:65], s[12:13]
M v[96:99], a[100:103], a[180:183], v[96:99]
M v[100:103], a[108:111], a[180:183], v[100:103]
M v[100:103], a[104:107], a[176:179], v[100:103]
v_cvt_pk_bf16_f32 v64, v64, v65
v_cvt_pk_bf16_f32 v65, v66, v67
M v[104:107], a[112:115], a[176:179], v[104:107]
v_cvt_pk_bf16_f32 v66, v68, v69
v_cvt_pk_bf16_f32 v67, v70, v71
M v[104:107], a[116:119], a[180:183], v[104:107]
s_add_u32 s94, s92, 0
buffer_store_dwordx4 v[40:43], v1, s[16:19], s94 offen offset:1024 sc1
v_cvt_pk_bf16_f32 v72, v72, v73
v_cvt_pk_bf16_f32 v73, v74, v75
M v[108:111], a[124:127], a[180:183], v[108:111]
v_cvt_pk_bf16_f32 v74, v76, v77
v_cvt_pk_bf16_f32 v75, v78, v79
M v[108:111], a[120:123], a[176:179], v[108:111]
s_waitcnt vmcnt(18) lgkmcnt(0)
s_barrier
ds_read_b128 a[160:163], v10 offset:49152
ds_read_b128 a[164:167], v11 offset:49152
v_cvt_pk_bf16_f32 v80, v80, v81
v_cvt_pk_bf16_f32 v81, v82, v83
M v[112:115], a[128:131], a[176:179], v[112:115]
s_add_u32 m0, s29, 32768
s_nop 0
buffer_load_dwordx4 v2, s[8:11], s23 offen offset:0 lds
v_cvt_pk_bf16_f32 v82, v84, v85
v_cvt_pk_bf16_f32 v83, v86, v87
M v[112:115], a[132:135], a[180:183], v[112:115]
v_cvt_pk_bf16_f32 v88, v88, v89
v_cvt_pk_bf16_f32 v89, v90, v91
M v[116:119], a[140:143], a[180:183], v[116:119]
v_cvt_pk_bf16_f32 v90, v92, v93
v_cvt_pk_bf16_f32 v91, v94, v95
M v[116:119], a[136:139], a[176:179], v[116:119]
ds_read_b64_tr_b16 a[36:37], v12 offset:16384
ds_read_b64_tr_b16 a[38:39], v12 offset:18432
M v[120:123], a[144:147], a[176:179], v[120:123]
s_add_u32 s94, s92, 0
buffer_store_dwordx4 v[48:51], v1, s[16:19], s94 offen offset:2048 sc1
M v[120:123], a[148:151], a[180:183], v[120:123]
M v[124:127], a[156:159], a[180:183], v[124:127]
buffer_load_dwordx4 v3, s[8:11], s23 offen offset:1024 lds
M v[124:127], a[152:155], a[176:179], v[124:127]
M v[128:131], a[96:99], a[184:187], v[128:131]
M v[128:131], a[100:103], a[188:191], v[128:131]
ds_read_b128 a[168:171], v10 offset:51200
ds_read_b128 a[172:175], v11 offset:51200
ds_read_b64_tr_b16 a[44:45], v13 offset:16384
ds_read_b64_tr_b16 a[46:47], v13 offset:18432
M v[132:135], a[108:111], a[188:191], v[132:135]
M v[132:135], a[104:107], a[184:187], v[132:135]
s_add_u32 s94, s92, 0
buffer_store_dwordx4 v[56:59], v1, s[16:19], s94 offen offset:3072 sc1
v_cvt_pk_bf16_f32 v96, v96, v97
v_cvt_pk_bf16_f32 v97, v98, v99
M v[136:139], a[112:115], a[184:187], v[136:139]
v_cvt_pk_bf16_f32 v98, v100, v101
v_cvt_pk_bf16_f32 v99, v102, v103
M v[136:139], a[116:119], a[188:191], v[136:139]
buffer_load_dwordx4 v4, s[8:11], s23 offen offset:2048 lds
v_cvt_pk_bf16_f32 v104, v104, v105
v_cvt_pk_bf16_f32 v105, v106, v107
M v[140:143], a[124:127], a[188:191], v[140:143]
v_cvt_pk_bf16_f32 v106, v108, v109
v_cvt_pk_bf16_f32 v107, v110, v111
M v[140:143], a[120:123], a[184:187], v[140:143]
ds_read_b64_tr_b16 a[52:53], v14 offset:16384
ds_read_b64_tr_b16 a[54:55], v14 offset:18432
v_cvt_pk_bf16_f32 v112, v112, v113
v_cvt_pk_bf16_f32 v113, v114, v115
M v[144:147], a[128:131], a[184:187], v[144:147]
v_cvt_pk_bf16_f32 v114, v116, v117
v_cvt_pk_bf16_f32 v115, v118, v119
M v[144:147], a[132:135], a[188:191], v[144:147]
v_cvt_pk_bf16_f32 v120, v120, v121
v_cvt_pk_bf16_f32 v121, v122, v123
M v[148:151], a[140:143], a[188:191], v[148:151]
s_add_u32 s94, s92, 4096
buffer_store_dwordx4 v[64:67], v1, s[16:19], s94 offen offset:0 sc1
v_cvt_pk_bf16_f32 v122, v124, v125
v_cvt_pk_bf16_f32 v123, v126, v127
M v[148:151], a[136:139], a[184:187], v[148:151]
M v[152:155], a[144:147], a[184:187], v[152:155]
buffer_load_dwordx4 v5, s[8:11], s23 offen offset:3072 lds
M v[152:155], a[148:151], a[188:191], v[152:155]
ds_read_b64_tr_b16 a[60:61], v15 offset:16384
ds_read_b64_tr_b16 a[62:63], v15 offset:18432
M v[156:159], a[156:159], a[188:191], v[156:159]
M v[156:159], a[152:155], a[184:187], v[156:159]
s_waitcnt lgkmcnt(10)
M v[160:163], a[96:99], a[160:163], v[160:163]
M v[160:163], a[100:103], a[164:167], v[160:163]
ds_read_b128 a[176:179], v10 offset:53248
ds_read_b128 a[180:183], v11 offset:53248
M v[164:167], a[108:111], a[164:167], v[164:167]
s_add_u32 s94, s92, 4096
buffer_store_dwordx4 v[72:75], v1, s[16:19], s94 offen offset:1024 sc1
M v[164:167], a[104:107], a[160:163], v[164:167]
ds_read_b64_tr_b16 a[68:69], v16 offset:16384
ds_read_b64_tr_b16 a[70:71], v16 offset:18432
v_cvt_pk_bf16_f32 v128, v128, v129
v_cvt_pk_bf16_f32 v129, v130, v131
M v[168:171], a[112:115], a[160:163], v[168:171]
v_cvt_pk_bf16_f32 v130, v132, v133
v_cvt_pk_bf16_f32 v131, v134, v135
M v[168:171], a[116:119], a[164:167], v[168:171]
s_add_u32 m0, s29, 65536
s_nop 0
buffer_load_dwordx4 v6, s[12:15], s24 offen offset:0 lds
v_cvt_pk_bf16_f32 v136, v136, v137
v_cvt_pk_bf16_f32 v137, v138, v139
M v[172:175], a[124:127], a[164:167], v[172:175]
v_cvt_pk_bf16_f32 v138, v140, v141
v_cvt_pk_bf16_f32 v139, v142, v143
M v[172:175], a[120:123], a[160:163], v[172:175]
v_cvt_pk_bf16_f32 v144, v144, v145
v_cvt_pk_bf16_f32 v145, v146, v147
M v[176:179], a[128:131], a[160:163], v[176:179]
s_add_u32 s94, s92, 4096
buffer_store_dwordx4 v[80:83], v1, s[16:19], s94 offen offset:2048 sc1
v_cvt_pk_bf16_f32 v146, v148, v149
v_cvt_pk_bf16_f32 v147, v150, v151
M v[176:179], a[132:135], a[164:167], v[176:179]
ds_read_b64_tr_b16 a[76:77], v17 offset:16384
ds_read_b64_tr_b16 a[78:79], v17 offset:18432
v_cvt_pk_bf16_f32 v152, v152, v153
v_cvt_pk_bf16_f32 v153, v154, v155
M v[180:183], a[140:143], a[164:167], v[180:183]
v_cvt_pk_bf16_f32 v154, v156, v157
v_cvt_pk_bf16_f32 v155, v158, v159
M v[180:183], a[136:139], a[160:163], v[180:183]
buffer_load_dwordx4 v7, s[12:15], s24 offen offset:1024 lds
M v[184:187], a[144:147], a[160:163], v[184:187]
M v[184:187], a[148:151], a[164:167], v[184:187]
M v[188:191], a[156:159], a[164:167], v[188:191]
M v[188:191], a[152:155], a[160:163], v[188:191]
s_waitcnt lgkmcnt(12)
ds_read_b64_tr_b16 a[84:85], v18 offset:16384
ds_read_b64_tr_b16 a[86:87], v18 offset:18432
M v[192:195], a[96:99], a[168:171], v[192:195]
s_add_u32 s94, s92, 4096
buffer_store_dwordx4 v[88:91], v1, s[16:19], s94 offen offset:3072 sc1
M v[192:195], a[100:103], a[172:175], v[192:195]
ds_read_b128 a[184:187], v10 offset:55296
ds_read_b128 a[188:191], v11 offset:55296
M v[196:199], a[108:111], a[172:175], v[196:199]
M v[196:199], a[104:107], a[168:171], v[196:199]
buffer_load_dwordx4 v8, s[12:15], s24 offen offset:2048 lds
v_cvt_pk_bf16_f32 v160, v160, v161
v_cvt_pk_bf16_f32 v161, v162, v163
M v[200:203], a[112:115], a[168:171], v[200:203]
v_cvt_pk_bf16_f32 v162, v164, v165
v_cvt_pk_bf16_f32 v163, v166, v167
M v[200:203], a[116:119], a[172:175], v[200:203]
ds_read_b64_tr_b16 a[92:93], v19 offset:16384
ds_read_b64_tr_b16 a[94:95], v19 offset:18432
v_cvt_pk_bf16_f32 v168, v168, v169
v_cvt_pk_bf16_f32 v169, v170, v171
M v[204:207], a[124:127], a[172:175], v[204:207]
s_add_u32 s94, s92, 8192
buffer_store_dwordx4 v[96:99], v1, s[16:19], s94 offen offset:0 sc1
v_cvt_pk_bf16_f32 v170, v172, v173
v_cvt_pk_bf16_f32 v171, v174, v175
M v[204:207], a[120:123], a[168:171], v[204:207]
v_cvt_pk_bf16_f32 v176, v176, v177
v_cvt_pk_bf16_f32 v177, v178, v179
M v[208:211], a[128:131], a[168:171], v[208:211]
v_cvt_pk_bf16_f32 v178, v180, v181
v_cvt_pk_bf16_f32 v179, v182, v183
M v[208:211], a[132:135], a[172:175], v[208:211]
buffer_load_dwordx4 v9, s[12:15], s24 offen offset:3072 lds
v_cvt_pk_bf16_f32 v184, v184, v185
v_cvt_pk_bf16_f32 v185, v186, v187
M v[212:215], a[140:143], a[172:175], v[212:215]
v_cvt_pk_bf16_f32 v186, v188, v189
v_cvt_pk_bf16_f32 v187, v190, v191
M v[212:215], a[136:139], a[168:171], v[212:215]
M v[216:219], a[144:147], a[168:171], v[216:219]
M v[216:219], a[148:151], a[172:175], v[216:219]
s_add_u32 s94, s92, 8192
buffer_store_dwordx4 v[104:107], v1, s[16:19], s94 offen offset:1024 sc1
M v[220:223], a[156:159], a[172:175], v[220:223]
s_add_u32 s24, s24, 262144
M v[220:223], a[152:155], a[168:171], v[220:223]
s_waitcnt lgkmcnt(10)
M v[224:227], a[96:99], a[176:179], v[224:227]
M v[224:227], a[100:103], a[180:183], v[224:227]
M v[228:231], a[108:111], a[180:183], v[228:231]
M v[228:231], a[104:107], a[176:179], v[228:231]
v_cvt_pk_bf16_f32 v192, v192, v193
v_cvt_pk_bf16_f32 v193, v194, v195
M v[232:235], a[112:115], a[176:179], v[232:235]
s_add_u32 s94, s92, 8192
buffer_store_dwordx4 v[112:115], v1, s[16:19], s94 offen offset:2048 sc1
v_cvt_pk_bf16_f32 v194, v196, v197
v_cvt_pk_bf16_f32 v195, v198, v199
M v[232:235], a[116:119], a[180:183], v[232:235]
v_cvt_pk_bf16_f32 v200, v200, v201
v_cvt_pk_bf16_f32 v201, v202, v203
M v[236:239], a[124:127], a[180:183], v[236:239]
v_cvt_pk_bf16_f32 v202, v204, v205
v_cvt_pk_bf16_f32 v203, v206, v207
M v[236:239], a[120:123], a[176:179], v[236:239]
s_waitcnt vmcnt(27) lgkmcnt(0)
s_barrier
ds_read_b128 a[160:163], v10 offset:0
ds_read_b128 a[164:167], v11 offset:0
v_cvt_pk_bf16_f32 v208, v208, v209
v_cvt_pk_bf16_f32 v209, v210, v211
M v[240:243], a[128:131], a[176:179], v[240:243]
s_add_u32 m0, s29, 49152
s_add_u32 s3, s23, s31
buffer_load_dwordx4 v2, s[8:11], s3 offen offset:0 lds
v_cvt_pk_bf16_f32 v210, v212, v213
v_cvt_pk_bf16_f32 v211, v214, v215
M v[240:243], a[132:135], a[180:183], v[240:243]
v_cvt_pk_bf16_f32 v216, v216, v217
v_cvt_pk_bf16_f32 v217, v218, v219
M v[244:247], a[140:143], a[180:183], v[244:247]
v_cvt_pk_bf16_f32 v218, v220, v221
v_cvt_pk_bf16_f32 v219, v222, v223
M v[244:247], a[136:139], a[176:179], v[244:247]
s_add_u32 s94, s92, 8192
buffer_store_dwordx4 v[120:123], v1, s[16:19], s94 offen offset:3072 sc1
M v[248:251], a[144:147], a[176:179], v[248:251]
M v[248:251], a[148:151], a[180:183], v[248:251]
buffer_load_dwordx4 v3, s[8:11], s3 offen offset:1024 lds
M v[252:255], a[156:159], a[180:183], v[252:255]
M v[252:255], a[152:155], a[176:179], v[252:255]
M a[0:3], a[96:99], a[184:187], a[0:3]
M a[0:3], a[100:103], a[188:191], a[0:3]
ds_read_b128 a[168:171], v10 offset:2048
ds_read_b128 a[172:175], v11 offset:2048
M a[4:7], a[108:111], a[188:191], a[4:7]
s_add_u32 s94, s92, 12288
buffer_store_dwordx4 v[128:131], v1, s[16:19], s94 offen offset:0 sc1
M a[4:7], a[104:107], a[184:187], a[4:7]
v_cvt_pk_bf16_f32 v224, v224, v225
v_cvt_pk_bf16_f32 v225, v226, v227
M a[8:11], a[112:115], a[184:187], a[8:11]
v_cvt_pk_bf16_f32 v226, v228, v229
v_cvt_pk_bf16_f32 v227, v230, v231
M a[8:11], a[116:119], a[188:191], a[8:11]
buffer_load_dwordx4 v4, s[8:11], s3 offen offset:2048 lds
v_cvt_pk_bf16_f32 v232, v232, v233
v_cvt_pk_bf16_f32 v233, v234, v235
M a[12:15], a[124:127], a[188:191], a[12:15]
v_cvt_pk_bf16_f32 v234, v236, v237
v_cvt_pk_bf16_f32 v235, v238, v239
M a[12:15], a[120:123], a[184:187], a[12:15]
v_cvt_pk_bf16_f32 v240, v240, v241
v_cvt_pk_bf16_f32 v241, v242, v243
M a[16:19], a[128:131], a[184:187], a[16:19]
v_cvt_pk_bf16_f32 v242, v244, v245
v_cvt_pk_bf16_f32 v243, v246, v247
M a[16:19], a[132:135], a[188:191], a[16:19]
s_add_u32 s94, s92, 12288
buffer_store_dwordx4 v[136:139], v1, s[16:19], s94 offen offset:1024 sc1
v_cvt_pk_bf16_f32 v248, v248, v249
v_cvt_pk_bf16_f32 v249, v250, v251
M a[20:23], a[140:143], a[188:191], a[20:23]
buffer_load_dwordx4 v5, s[8:11], s3 offen offset:3072 lds
v_cvt_pk_bf16_f32 v250, v252, v253
v_cvt_pk_bf16_f32 v251, v254, v255
M a[20:23], a[136:139], a[184:187], a[20:23]
M a[24:27], a[144:147], a[184:187], a[24:27]
M a[24:27], a[148:151], a[188:191], a[24:27]
M a[28:31], a[156:159], a[188:191], a[28:31]
M a[28:31], a[152:155], a[184:187], a[28:31]
s_waitcnt lgkmcnt(2)
M v[32:35], a[160:163], a[32:35], 0
s_add_u32 s94, s92, 12288
buffer_store_dwordx4 v[144:147], v1, s[16:19], s94 offen offset:2048 sc1
M v[32:35], a[164:167], a[36:39], v[32:35]
ds_read_b128 a[176:179], v10 offset:4096
ds_read_b128 a[180:183], v11 offset:4096
M v[36:39], a[164:167], a[44:47], 0
s_add_u32 s23, s23, 128
s_cmp_eq_u32 s23, s25
s_cselect_b32 s23, s26, s23
M v[36:39], a[160:163], a[40:43], v[36:39]
ds_read_b64_tr_b16 a[96:97], v12 offset:32768
ds_read_b64_tr_b16 a[98:99], v12 offset:34816
M v[40:43], a[160:163], a[48:51], 0
M v[40:43], a[164:167], a[52:55], v[40:43]
M v[44:47], a[164:167], a[60:63], 0
s_add_u32 m0, s29, 81920
s_nop 0
buffer_load_dwordx4 v6, s[12:15], s24 offen offset:0 lds
v_accvgpr_read_b32 v24, a0
v_accvgpr_read_b32 v25, a1
M v[44:47], a[160:163], a[56:59], v[44:47]
ds_read_b64_tr_b16 a[104:105], v13 offset:32768
ds_read_b64_tr_b16 a[106:107], v13 offset:34816
v_accvgpr_read_b32 v26, a2
v_accvgpr_read_b32 v27, a3
M v[48:51], a[160:163], a[64:67], 0
s_add_u32 s94, s92, 12288
buffer_store_dwordx4 v[152:155], v1, s[16:19], s94 offen offset:3072 sc1
v_accvgpr_read_b32 v28, a4
v_accvgpr_read_b32 v29, a5
M v[48:51], a[164:167], a[68:71], v[48:51]
v_accvgpr_read_b32 v30, a6
v_accvgpr_read_b32 v31, a7
M v[52:55], a[164:167], a[76:79], 0
v_cvt_pk_bf16_f32 v24, v24, v25
v_cvt_pk_bf16_f32 v25, v26, v27
M v[52:55], a[160:163], a[72:75], v[52:55]
ds_read_b64_tr_b16 a[112:113], v14 offset:32768
ds_read_b64_tr_b16 a[114:115], v14 offset:34816
v_cvt_pk_bf16_f32 v26, v28, v29
v_cvt_pk_bf16_f32 v27, v30, v31
M v[56:59], a[160:163], a[80:83], 0
buffer_load_dwordx4 v7, s[12:15], s24 offen offset:1024 lds
M v[56:59], a[164:167], a[84:87], v[56:59]
M v[60:63], a[164:167], a[92:95], 0
s_add_u32 s94, s93, 0
buffer_store_dwordx4 v[160:163], v1, s[16:19], s94 offen offset:0 sc1
M v[60:63], a[160:163], a[88:91], v[60:63]
s_waitcnt lgkmcnt(8)
ds_read_b64_tr_b16 a[120:121], v15 offset:32768
ds_read_b64_tr_b16 a[122:123], v15 offset:34816
M v[64:67], a[168:171], a[32:35], 0
s_add_u32 s94, s93, 12288
buffer_store_dwordx4 v[24:27], v1, s[16:19], s94 offen offset:0 sc1
M v[64:67], a[172:175], a[36:39], v[64:67]
ds_read_b128 a[184:187], v10 offset:6144
ds_read_b128 a[188:191], v11 offset:6144
M v[68:71], a[172:175], a[44:47], 0
M v[68:71], a[168:171], a[40:43], v[68:71]
ds_read_b64_tr_b16 a[128:129], v16 offset:32768
ds_read_b64_tr_b16 a[130:131], v16 offset:34816
M v[72:75], a[168:171], a[48:51], 0
M v[72:75], a[172:175], a[52:55], v[72:75]
s_add_u32 s94, s93, 0
buffer_store_dwordx4 v[168:171], v1, s[16:19], s94 offen offset:1024 sc1
M v[76:79], a[172:175], a[60:63], 0
buffer_load_dwordx4 v8, s[12:15], s24 offen offset:2048 lds
M v[76:79], a[168:171], a[56:59], v[76:79]
ds_read_b64_tr_b16 a[136:137], v17 offset:32768
ds_read_b64_tr_b16 a[138:139], v17 offset:34816
M v[80:83], a[168:171], a[64:67], 0
M v[80:83], a[172:175], a[68:71], v[80:83]
M v[84:87], a[172:175], a[76:79], 0
buffer_load_dwordx4 v9, s[12:15], s24 offen offset:3072 lds
M v[84:87], a[168:171], a[72:75], v[84:87]
ds_read_b64_tr_b16 a[144:145], v18 offset:32768
ds_read_b64_tr_b16 a[146:147], v18 offset:34816
M v[88:91], a[168:171], a[80:83], 0
s_add_u32 s94, s93, 0
buffer_store_dwordx4 v[176:179], v1, s[16:19], s94 offen offset:2048 sc1
M v[88:91], a[172:175], a[84:87], v[88:91]
M v[92:95], a[172:175], a[92:95], 0
M v[92:95], a[168:171], a[88:91], v[92:95]
s_waitcnt lgkmcnt(15)
ds_read_b64_tr_b16 a[152:153], v19 offset:32768
ds_read_b64_tr_b16 a[154:155], v19 offset:34816
M v[96:99], a[176:179], a[32:35], 0
s_add_u32 s24, s24, 262144
s_cmp_eq_u32 s24, s27
s_cselect_b32 s24, s28, s24
s_sub_u32 s6, s6, 1
s_cmp_eq_u32 s6, 0
s_cselect_b64 s[12:13], s[64:65], s[12:13]
v_accvgpr_read_b32 v24, a8
v_accvgpr_read_b32 v25, a9
M v[96:99], a[180:183], a[36:39], v[96:99]
v_accvgpr_read_b32 v26, a10
v_accvgpr_read_b32 v27, a11
M v[100:103], a[180:183], a[44:47], 0
v_accvgpr_read_b32 v28, a12
v_accvgpr_read_b32 v29, a13
M v[100:103], a[176:179], a[40:43], v[100:103]
s_add_u32 s94, s93, 0
buffer_store_dwordx4 v[184:187], v1, s[16:19], s94 offen offset:3072 sc1
v_accvgpr_read_b32 v30, a14
v_accvgpr_read_b32 v31, a15
M v[104:107], a[176:179], a[48:51], 0
v_cvt_pk_bf16_f32 v24, v24, v25
v_cvt_pk_bf16_f32 v25, v26, v27
M v[104:107], a[180:183], a[52:55], v[104:107]
v_cvt_pk_bf16_f32 v26, v28, v29
v_cvt_pk_bf16_f32 v27, v30, v31
M v[108:111], a[180:183], a[60:63], 0
M v[108:111], a[176:179], a[56:59], v[108:111]
s_waitcnt vmcnt(37) lgkmcnt(0)
s_barrier
ds_read_b128 a[160:163], v10 offset:16384
ds_read_b128 a[164:167], v11 offset:16384
M v[112:115], a[176:179], a[64:67], 0
s_add_u32 m0, s29, 0
s_nop 0
buffer_load_dwordx4 v2, s[8:11], s23 offen offset:0 lds
M v[112:115], a[180:183], a[68:71], v[112:115]
s_add_u32 s94, s93, 12288
buffer_store_dwordx4 v[24:27], v1, s[16:19], s94 offen offset:1024 sc1
M v[116:119], a[180:183], a[76:79], 0
s_add_u32 s94, s93, 4096
buffer_store_dwordx4 v[192:195], v1, s[16:19], s94 offen offset:0 sc1
M v[116:119], a[176:179], a[72:75], v[116:119]
ds_read_b64_tr_b16 a[100:101], v12 offset:49152
ds_read_b64_tr_b16 a[102:103], v12 offset:51200
M v[120:123], a[176:179], a[80:83], 0
M v[120:123], a[180:183], a[84:87], v[120:123]
M v[124:127], a[180:183], a[92:95], 0
M v[124:127], a[176:179], a[88:91], v[124:127]
M v[128:131], a[184:187], a[32:35], 0
buffer_load_dwordx4 v3, s[8:11], s23 offen offset:1024 lds
M v[128:131], a[188:191], a[36:39], v[128:131]
ds_read_b128 a[168:171], v10 offset:18432
ds_read_b128 a[172:175], v11 offset:18432
ds_read_b64_tr_b16 a[108:109], v13 offset:49152
ds_read_b64_tr_b16 a[110:111], v13 offset:51200
M v[132:135], a[188:191], a[44:47], 0
s_add_u32 s94, s93, 4096
buffer_store_dwordx4 v[200:203], v1, s[16:19], s94 offen offset:1024 sc1
M v[132:135], a[184:187], a[40:43], v[132:135]
M v[136:139], a[184:187], a[48:51], 0
M v[136:139], a[188:191], a[52:55], v[136:139]
M v[140:143], a[188:191], a[60:63], 0
buffer_load_dwordx4 v4, s[8:11], s23 offen offset:2048 lds
M v[140:143], a[184:187], a[56:59], v[140:143]
ds_read_b64_tr_b16 a[116:117], v14 offset:49152
ds_read_b64_tr_b16 a[118:119], v14 offset:51200
M v[144:147], a[184:187], a[64:67], 0
s_add_u32 s94, s93, 4096
buffer_store_dwordx4 v[208:211], v1, s[16:19], s94 offen offset:2048 sc1
M v[144:147], a[188:191], a[68:71], v[144:147]
M v[148:151], a[188:191], a[76:79], 0
v_accvgpr_read_b32 v24, a16
v_accvgpr_read_b32 v25, a17
M v[148:151], a[184:187], a[72:75], v[148:151]
v_accvgpr_read_b32 v26, a18
v_accvgpr_read_b32 v27, a19
M v[152:155], a[184:187], a[80:83], 0
buffer_load_dwordx4 v5, s[8:11], s23 offen offset:3072 lds
v_accvgpr_read_b32 v28, a20
v_accvgpr_read_b32 v29, a21
M v[152:155], a[188:191], a[84:87], v[152:155]
ds_read_b64_tr_b16 a[124:125], v15 offset:49152
ds_read_b64_tr_b16 a[126:127], v15 offset:51200
v_accvgpr_read_b32 v30, a22
v_accvgpr_read_b32 v31, a23
M v[156:159], a[188:191], a[92:95], 0
v_cvt_pk_bf16_f32 v24, v24, v25
v_cvt_pk_bf16_f32 v25, v26, v27
M v[156:159], a[184:187], a[88:91], v[156:159]
s_add_u32 s94, s93, 4096
buffer_store_dwordx4 v[216:219], v1, s[16:19], s94 offen offset:3072 sc1
s_waitcnt lgkmcnt(10)
v_cvt_pk_bf16_f32 v26, v28, v29
v_cvt_pk_bf16_f32 v27, v30, v31
M v[160:163], a[160:163], a[32:35], 0
M v[160:163], a[164:167], a[36:39], v[160:163]
ds_read_b128 a[176:179], v10 offset:20480
ds_read_b128 a[180:183], v11 offset:20480
M v[164:167], a[164:167], a[44:47], 0
M v[164:167], a[160:163], a[40:43], v[164:167]
ds_read_b64_tr_b16 a[132:133], v16 offset:49152
ds_read_b64_tr_b16 a[134:135], v16 offset:51200
M v[168:171], a[160:163], a[48:51], 0
s_add_u32 s94, s93, 12288
buffer_store_dwordx4 v[24:27], v1, s[16:19], s94 offen offset:2048 sc1
M v[168:171], a[164:167], a[52:55], v[168:171]
s_add_u32 m0, s29, 98304
s_nop 0
buffer_load_dwordx4 v6, s[12:15], s24 offen offset:0 lds
M v[172:175], a[164:167], a[60:63], 0
s_add_u32 s94, s93, 8192
buffer_store_dwordx4 v[224:227], v1, s[16:19], s94 offen offset:0 sc1
M v[172:175], a[160:163], a[56:59], v[172:175]
M v[176:179], a[160:163], a[64:67], 0
M v[176:179], a[164:167], a[68:71], v[176:179]
ds_read_b64_tr_b16 a[140:141], v17 offset:49152
ds_read_b64_tr_b16 a[142:143], v17 offset:51200
M v[180:183], a[164:167], a[76:79], 0
M v[180:183], a[160:163], a[72:75], v[180:183]
M v[184:187], a[160:163], a[80:83], 0
buffer_load_dwordx4 v7, s[12:15], s24 offen offset:1024 lds
M v[184:187], a[164:167], a[84:87], v[184:187]
s_add_u32 s94, s93, 8192
buffer_store_dwordx4 v[232:235], v1, s[16:19], s94 offen offset:1024 sc1
M v[188:191], a[164:167], a[92:95], 0
M v[188:191], a[160:163], a[88:91], v[188:191]
s_waitcnt lgkmcnt(12)
ds_read_b64_tr_b16 a[148:149], v18 offset:49152
ds_read_b64_tr_b16 a[150:151], v18 offset:51200
M v[192:195], a[168:171], a[32:35], 0
M v[192:195], a[172:175], a[36:39], v[192:195]
ds_read_b128 a[184:187], v10 offset:22528
ds_read_b128 a[188:191], v11 offset:22528
M v[196:199], a[172:175], a[44:47], 0
M v[196:199], a[168:171], a[40:43], v[196:199]
buffer_load_dwordx4 v8, s[12:15], s24 offen offset:2048 lds
M v[200:203], a[168:171], a[48:51], 0
s_add_u32 s94, s93, 8192
buffer_store_dwordx4 v[240:243], v1, s[16:19], s94 offen offset:2048 sc1
v_accvgpr_read_b32 v24, a24
v_accvgpr_read_b32 v25, a25
M v[200:203], a[172:175], a[52:55], v[200:203]
ds_read_b64_tr_b16 a[156:157], v19 offset:49152
ds_read_b64_tr_b16 a[158:159], v19 offset:51200
v_accvgpr_read_b32 v26, a26
v_accvgpr_read_b32 v27, a27
M v[204:207], a[172:175], a[60:63], 0
v_accvgpr_read_b32 v28, a28
v_accvgpr_read_b32 v29, a29
M v[204:207], a[168:171], a[56:59], v[204:207]
v_accvgpr_read_b32 v30, a30
v_accvgpr_read_b32 v31, a31
M v[208:211], a[168:171], a[64:67], 0
v_cvt_pk_bf16_f32 v24, v24, v25
v_cvt_pk_bf16_f32 v25, v26, v27
M v[208:211], a[172:175], a[68:71], v[208:211]
buffer_load_dwordx4 v9, s[12:15], s24 offen offset:3072 lds
v_cvt_pk_bf16_f32 v26, v28, v29
v_cvt_pk_bf16_f32 v27, v30, v31
M v[212:215], a[172:175], a[76:79], 0
M v[212:215], a[168:171], a[72:75], v[212:215]
s_add_u32 s94, s93, 8192
buffer_store_dwordx4 v[248:251], v1, s[16:19], s94 offen offset:3072 sc1
M v[216:219], a[168:171], a[80:83], 0
M v[216:219], a[172:175], a[84:87], v[216:219]
s_add_u32 s94, s93, 12288
buffer_store_dwordx4 v[24:27], v1, s[16:19], s94 offen offset:3072 sc1
M v[220:223], a[172:175], a[92:95], 0
M v[220:223], a[168:171], a[88:91], v[220:223]
s_waitcnt lgkmcnt(10)
M v[224:227], a[176:179], a[32:35], 0
s_add_u32 s24, s24, 262144
M v[224:227], a[180:183], a[36:39], v[224:227]
M v[228:231], a[180:183], a[44:47], 0
M v[228:231], a[176:179], a[40:43], v[228:231]
M v[232:235], a[176:179], a[48:51], 0
M v[232:235], a[180:183], a[52:55], v[232:235]
M v[236:239], a[180:183], a[60:63], 0
M v[236:239], a[176:179], a[56:59], v[236:239]
s_waitcnt vmcnt(39) lgkmcnt(0)
s_barrier
ds_read_b128 a[160:163], v10 offset:32768
ds_read_b128 a[164:167], v11 offset:32768
M v[240:243], a[176:179], a[64:67], 0
s_add_u32 m0, s29, 16384
s_add_u32 s3, s23, s31
buffer_load_dwordx4 v2, s[8:11], s3 offen offset:0 lds
M v[240:243], a[180:183], a[68:71], v[240:243]
M v[244:247], a[180:183], a[76:79], 0
M v[244:247], a[176:179], a[72:75], v[244:247]
M v[248:251], a[176:179], a[80:83], 0
M v[248:251], a[180:183], a[84:87], v[248:251]
buffer_load_dwordx4 v3, s[8:11], s3 offen offset:1024 lds
M v[252:255], a[180:183], a[92:95], 0
M v[252:255], a[176:179], a[88:91], v[252:255]
M a[0:3], a[184:187], a[32:35], 0
M a[0:3], a[188:191], a[36:39], a[0:3]
ds_read_b128 a[168:171], v10 offset:34816
ds_read_b128 a[172:175], v11 offset:34816
M a[4:7], a[188:191], a[44:47], 0
M a[4:7], a[184:187], a[40:43], a[4:7]
M a[8:11], a[184:187], a[48:51], 0
buffer_load_dwordx4 v4, s[8:11], s3 offen offset:2048 lds
M a[8:11], a[188:191], a[52:55], a[8:11]
M a[12:15], a[188:191], a[60:63], 0
M a[12:15], a[184:187], a[56:59], a[12:15]
M a[16:19], a[184:187], a[64:67], 0
M a[16:19], a[188:191], a[68:71], a[16:19]
buffer_load_dwordx4 v5, s[8:11], s3 offen offset:3072 lds
M a[20:23], a[188:191], a[76:79], 0
M a[20:23], a[184:187], a[72:75], a[20:23]
M a[24:27], a[184:187], a[80:83], 0
M a[24:27], a[188:191], a[84:87], a[24:27]
M a[28:31], a[188:191], a[92:95], 0
M a[28:31], a[184:187], a[88:91], a[28:31]
s_waitcnt lgkmcnt(2)
M v[32:35], a[160:163], a[96:99], v[32:35]
s_add_u32 s23, s23, 128
s_cmp_eq_u32 s23, s25
s_cselect_b32 s23, s26, s23
M v[32:35], a[164:167], a[100:103], v[32:35]
ds_read_b128 a[176:179], v10 offset:36864
ds_read_b128 a[180:183], v11 offset:36864
M v[36:39], a[164:167], a[108:111], v[36:39]
M v[36:39], a[160:163], a[104:107], v[36:39]
ds_read_b64_tr_b16 a[32:33], v12 offset:0
ds_read_b64_tr_b16 a[34:35], v12 offset:2048
M v[40:43], a[160:163], a[112:115], v[40:43]
M v[40:43], a[164:167], a[116:119], v[40:43]
M v[44:47], a[164:167], a[124:127], v[44:47]
s_add_u32 m0, s29, 114688
s_nop 0
buffer_load_dwordx4 v6, s[12:15], s24 offen offset:0 lds
M v[44:47], a[160:163], a[120:123], v[44:47]
ds_read_b64_tr_b16 a[40:41], v13 offset:0
ds_read_b64_tr_b16 a[42:43], v13 offset:2048
M v[48:51], a[160:163], a[128:131], v[48:51]
M v[48:51], a[164:167], a[132:135], v[48:51]
M v[52:55], a[164:167], a[140:143], v[52:55]
M v[52:55], a[160:163], a[136:139], v[52:55]
ds_read_b64_tr_b16 a[48:49], v14 offset:0
ds_read_b64_tr_b16 a[50:51], v14 offset:2048
M v[56:59], a[160:163], a[144:147], v[56:59]
M v[56:59], a[164:167], a[148:151], v[56:59]
buffer_load_dwordx4 v7, s[12:15], s24 offen offset:1024 lds
M v[60:63], a[164:167], a[156:159], v[60:63]
M v[60:63], a[160:163], a[152:155], v[60:63]
s_waitcnt lgkmcnt(8)
ds_read_b64_tr_b16 a[56:57], v15 offset:0
ds_read_b64_tr_b16 a[58:59], v15 offset:2048
M v[64:67], a[168:171], a[96:99], v[64:67]
M v[64:67], a[172:175], a[100:103], v[64:67]
ds_read_b128 a[184:187], v10 offset:38912
ds_read_b128 a[188:191], v11 offset:38912
M v[68:71], a[172:175], a[108:111], v[68:71]
M v[68:71], a[168:171], a[104:107], v[68:71]
ds_read_b64_tr_b16 a[64:65], v16 offset:0
ds_read_b64_tr_b16 a[66:67], v16 offset:2048
M v[72:75], a[168:171], a[112:115], v[72:75]
buffer_load_dwordx4 v8, s[12:15], s24 offen offset:2048 lds
M v[72:75], a[172:175], a[116:119], v[72:75]
M v[76:79], a[172:175], a[124:127], v[76:79]
M v[76:79], a[168:171], a[120:123], v[76:79]
ds_read_b64_tr_b16 a[72:73], v17 offset:0
ds_read_b64_tr_b16 a[74:75], v17 offset:2048
M v[80:83], a[168:171], a[128:131], v[80:83]
M v[80:83], a[172:175], a[132:135], v[80:83]
M v[84:87], a[172:175], a[140:143], v[84:87]
buffer_load_dwordx4 v9, s[12:15], s24 offen offset:3072 lds
M v[84:87], a[168:171], a[136:139], v[84:87]
ds_read_b64_tr_b16 a[80:81], v18 offset:0
ds_read_b64_tr_b16 a[82:83], v18 offset:2048
M v[88:91], a[168:171], a[144:147], v[88:91]
M v[88:91], a[172:175], a[148:151], v[88:91]
M v[92:95], a[172:175], a[156:159], v[92:95]
M v[92:95], a[168:171], a[152:155], v[92:95]
s_waitcnt lgkmcnt(15)
ds_read_b64_tr_b16 a[88:89], v19 offset:0
ds_read_b64_tr_b16 a[90:91], v19 offset:2048
M v[96:99], a[176:179], a[96:99], v[96:99]
s_add_u32 s24, s24, 262144
s_cmp_eq_u32 s24, s27
s_cselect_b32 s24, s28, s24
s_sub_u32 s6, s6, 1
s_cmp_eq_u32 s6, 0
s_cselect_b64 s[12:13], s[64:65], s[12:13]
M v[96:99], a[180:183], a[100:103], v[96:99]
M v[100:103], a[180:183], a[108:111], v[100:103]
M v[100:103], a[176:179], a[104:107], v[100:103]
M v[104:107], a[176:179], a[112:115], v[104:107]
M v[104:107], a[180:183], a[116:119], v[104:107]
M v[108:111], a[180:183], a[124:127], v[108:111]
M v[108:111], a[176:179], a[120:123], v[108:111]
s_waitcnt vmcnt(29) lgkmcnt(0)
s_barrier
ds_read_b128 a[160:163], v10 offset:49152
ds_read_b128 a[164:167], v11 offset:49152
M v[112:115], a[176:179], a[128:131], v[112:115]
s_add_u32 m0, s29, 32768
s_nop 0
buffer_load_dwordx4 v2, s[8:11], s23 offen offset:0 lds
M v[112:115], a[180:183], a[132:135], v[112:115]
M v[116:119], a[180:183], a[140:143], v[116:119]
M v[116:119], a[176:179], a[136:139], v[116:119]
ds_read_b64_tr_b16 a[36:37], v12 offset:16384
ds_read_b64_tr_b16 a[38:39], v12 offset:18432
M v[120:123], a[176:179], a[144:147], v[120:123]
M v[120:123], a[180:183], a[148:151], v[120:123]
M v[124:127], a[180:183], a[156:159], v[124:127]
buffer_load_dwordx4 v3, s[8:11], s23 offen offset:1024 lds
M v[124:127], a[176:179], a[152:155], v[124:127]
M v[128:131], a[184:187], a[96:99], v[128:131]
M v[128:131], a[188:191], a[100:103], v[128:131]
ds_read_b128 a[168:171], v10 offset:51200
ds_read_b128 a[172:175], v11 offset:51200
ds_read_b64_tr_b16 a[44:45], v13 offset:16384
ds_read_b64_tr_b16 a[46:47], v13 offset:18432
M v[132:135], a[188:191], a[108:111], v[132:135]
M v[132:135], a[184:187], a[104:107], v[132:135]
M v[136:139], a[184:187], a[112:115], v[136:139]
M v[136:139], a[188:191], a[116:119], v[136:139]
buffer_load_dwordx4 v4, s[8:11], s23 offen offset:2048 lds
M v[140:143], a[188:191], a[124:127], v[140:143]
M v[140:143], a[184:187], a[120:123], v[140:143]
ds_read_b64_tr_b16 a[52:53], v14 offset:16384
ds_read_b64_tr_b16 a[54:55], v14 offset:18432
M v[144:147], a[184:187], a[128:131], v[144:147]
M v[144:147], a[188:191], a[132:135], v[144:147]
M v[148:151], a[188:191], a[140:143], v[148:151]
M v[148:151], a[184:187], a[136:139], v[148:151]
M v[152:155], a[184:187], a[144:147], v[152:155]
buffer_load_dwordx4 v5, s[8:11], s23 offen offset:3072 lds
M v[152:155], a[188:191], a[148:151], v[152:155]
ds_read_b64_tr_b16 a[60:61], v15 offset:16384
ds_read_b64_tr_b16 a[62:63], v15 offset:18432
M v[156:159], a[188:191], a[156:159], v[156:159]
M v[156:159], a[184:187], a[152:155], v[156:159]
s_waitcnt lgkmcnt(10)
M v[160:163], a[160:163], a[96:99], v[160:163]
M v[160:163], a[164:167], a[100:103], v[160:163]
ds_read_b128 a[176:179], v10 offset:53248
ds_read_b128 a[180:183], v11 offset:53248
M v[164:167], a[164:167], a[108:111], v[164:167]
M v[164:167], a[160:163], a[104:107], v[164:167]
ds_read_b64_tr_b16 a[68:69], v16 offset:16384
ds_read_b64_tr_b16 a[70:71], v16 offset:18432
M v[168:171], a[160:163], a[112:115], v[168:171]
M v[168:171], a[164:167], a[116:119], v[168:171]
s_add_u32 m0, s29, 65536
s_nop 0
buffer_load_dwordx4 v6, s[12:15], s24 offen offset:0 lds
M v[172:175], a[164:167], a[124:127], v[172:175]
M v[172:175], a[160:163], a[120:123], v[172:175]
M v[176:179], a[160:163], a[128:131], v[176:179]
M v[176:179], a[164:167], a[132:135], v[176:179]
ds_read_b64_tr_b16 a[76:77], v17 offset:16384
ds_read_b64_tr_b16 a[78:79], v17 offset:18432
M v[180:183], a[164:167], a[140:143], v[180:183]
M v[180:183], a[160:163], a[136:139], v[180:183]
buffer_load_dwordx4 v7, s[12:15], s24 offen offset:1024 lds
M v[184:187], a[160:163], a[144:147], v[184:187]
M v[184:187], a[164:167], a[148:151], v[184:187]
M v[188:191], a[164:167], a[156:159], v[188:191]
M v[188:191], a[160:163], a[152:155], v[188:191]
s_waitcnt lgkmcnt(12)
ds_read_b64_tr_b16 a[84:85], v18 offset:16384
ds_read_b64_tr_b16 a[86:87], v18 offset:18432
M v[192:195], a[168:171], a[96:99], v[192:195]
M v[192:195], a[172:175], a[100:103], v[192:195]
ds_read_b128 a[184:187], v10 offset:55296
ds_read_b128 a[188:191], v11 offset:55296
M v[196:199], a[172:175], a[108:111], v[196:199]
M v[196:199], a[168:171], a[104:107], v[196:199]
buffer_load_dwordx4 v8, s[12:15], s24 offen offset:2048 lds
M v[200:203], a[168:171], a[112:115], v[200:203]
M v[200:203], a[172:175], a[116:119], v[200:203]
ds_read_b64_tr_b16 a[92:93], v19 offset:16384
ds_read_b64_tr_b16 a[94:95], v19 offset:18432
M v[204:207], a[172:175], a[124:127], v[204:207]
M v[204:207], a[168:171], a[120:123], v[204:207]
M v[208:211], a[168:171], a[128:131], v[208:211]
M v[208:211], a[172:175], a[132:135], v[208:211]
buffer_load_dwordx4 v9, s[12:15], s24 offen offset:3072 lds
M v[212:215], a[172:175], a[140:143], v[212:215]
M v[212:215], a[168:171], a[136:139], v[212:215]
M v[216:219], a[168:171], a[144:147], v[216:219]
M v[216:219], a[172:175], a[148:151], v[216:219]
M v[220:223], a[172:175], a[156:159], v[220:223]
s_add_u32 s24, s24, 262144
M v[220:223], a[168:171], a[152:155], v[220:223]
s_waitcnt lgkmcnt(10)
M v[224:227], a[176:179], a[96:99], v[224:227]
M v[224:227], a[180:183], a[100:103], v[224:227]
M v[228:231], a[180:183], a[108:111], v[228:231]
M v[228:231], a[176:179], a[104:107], v[228:231]
M v[232:235], a[176:179], a[112:115], v[232:235]
M v[232:235], a[180:183], a[116:119], v[232:235]
M v[236:239], a[180:183], a[124:127], v[236:239]
M v[236:239], a[176:179], a[120:123], v[236:239]
s_waitcnt vmcnt(18) lgkmcnt(0)
s_barrier
ds_read_b128 a[160:163], v10 offset:0
ds_read_b128 a[164:167], v11 offset:0
M v[240:243], a[176:179], a[128:131], v[240:243]
s_add_u32 m0, s29, 49152
s_add_u32 s3, s23, s31
buffer_load_dwordx4 v2, s[8:11], s3 offen offset:0 lds
M v[240:243], a[180:183], a[132:135], v[240:243]
M v[244:247], a[180:183], a[140:143], v[244:247]
M v[244:247], a[176:179], a[136:139], v[244:247]
M v[248:251], a[176:179], a[144:147], v[248:251]
M v[248:251], a[180:183], a[148:151], v[248:251]
buffer_load_dwordx4 v3, s[8:11], s3 offen offset:1024 lds
M v[252:255], a[180:183], a[156:159], v[252:255]
M v[252:255], a[176:179], a[152:155], v[252:255]
M a[0:3], a[184:187], a[96:99], a[0:3]
M a[0:3], a[188:191], a[100:103], a[0:3]
ds_read_b128 a[168:171], v10 offset:2048
ds_read_b128 a[172:175], v11 offset:2048
M a[4:7], a[188:191], a[108:111], a[4:7]
M a[4:7], a[184:187], a[104:107], a[4:7]
M a[8:11], a[184:187], a[112:115], a[8:11]
buffer_load_dwordx4 v4, s[8:11], s3 offen offset:2048 lds
M a[8:11], a[188:191], a[116:119], a[8:11]
M a[12:15], a[188:191], a[124:127], a[12:15]
M a[12:15], a[184:187], a[120:123], a[12:15]
M a[16:19], a[184:187], a[128:131], a[16:19]
M a[16:19], a[188:191], a[132:135], a[16:19]
buffer_load_dwordx4 v5, s[8:11], s3 offen offset:3072 lds
M a[20:23], a[188:191], a[140:143], a[20:23]
M a[20:23], a[184:187], a[136:139], a[20:23]
M a[24:27], a[184:187], a[144:147], a[24:27]
M a[24:27], a[188:191], a[148:151], a[24:27]
M a[28:31], a[188:191], a[156:159], a[28:31]
M a[28:31], a[184:187], a[152:155], a[28:31]
s_waitcnt lgkmcnt(2)
M v[32:35], a[160:163], a[32:35], v[32:35]
s_add_u32 s23, s23, 128
s_cmp_eq_u32 s23, s25
s_cselect_b32 s23, s26, s23
M v[32:35], a[164:167], a[36:39], v[32:35]
ds_read_b128 a[176:179], v10 offset:4096
ds_read_b128 a[180:183], v11 offset:4096
M v[36:39], a[164:167], a[44:47], v[36:39]
M v[36:39], a[160:163], a[40:43], v[36:39]
ds_read_b64_tr_b16 a[96:97], v12 offset:32768
ds_read_b64_tr_b16 a[98:99], v12 offset:34816
M v[40:43], a[160:163], a[48:51], v[40:43]
M v[40:43], a[164:167], a[52:55], v[40:43]
M v[44:47], a[164:167], a[60:63], v[44:47]
s_add_u32 m0, s29, 81920
s_nop 0
buffer_load_dwordx4 v6, s[12:15], s24 offen offset:0 lds
M v[44:47], a[160:163], a[56:59], v[44:47]
ds_read_b64_tr_b16 a[104:105], v13 offset:32768
ds_read_b64_tr_b16 a[106:107], v13 offset:34816
M v[48:51], a[160:163], a[64:67], v[48:51]
M v[48:51], a[164:167], a[68:71], v[48:51]
M v[52:55], a[164:167], a[76:79], v[52:55]
M v[52:55], a[160:163], a[72:75], v[52:55]
ds_read_b64_tr_b16 a[112:113], v14 offset:32768
ds_read_b64_tr_b16 a[114:115], v14 offset:34816
M v[56:59], a[160:163], a[80:83], v[56:59]
M v[56:59], a[164:167], a[84:87], v[56:59]
buffer_load_dwordx4 v7, s[12:15], s24 offen offset:1024 lds
M v[60:63], a[164:167], a[92:95], v[60:63]
M v[60:63], a[160:163], a[88:91], v[60:63]
s_waitcnt lgkmcnt(8)
ds_read_b64_tr_b16 a[120:121], v15 offset:32768
ds_read_b64_tr_b16 a[122:123], v15 offset:34816
M v[64:67], a[168:171], a[32:35], v[64:67]
M v[64:67], a[172:175], a[36:39], v[64:67]
ds_read_b128 a[184:187], v10 offset:6144
ds_read_b128 a[188:191], v11 offset:6144
M v[68:71], a[172:175], a[44:47], v[68:71]
M v[68:71], a[168:171], a[40:43], v[68:71]
ds_read_b64_tr_b16 a[128:129], v16 offset:32768
ds_read_b64_tr_b16 a[130:131], v16 offset:34816
M v[72:75], a[168:171], a[48:51], v[72:75]
buffer_load_dwordx4 v8, s[12:15], s24 offen offset:2048 lds
M v[72:75], a[172:175], a[52:55], v[72:75]
M v[76:79], a[172:175], a[60:63], v[76:79]
M v[76:79], a[168:171], a[56:59], v[76:79]
ds_read_b64_tr_b16 a[136:137], v17 offset:32768
ds_read_b64_tr_b16 a[138:139], v17 offset:34816
M v[80:83], a[168:171], a[64:67], v[80:83]
M v[80:83], a[172:175], a[68:71], v[80:83]
M v[84:87], a[172:175], a[76:79], v[84:87]
buffer_load_dwordx4 v9, s[12:15], s24 offen offset:3072 lds
M v[84:87], a[168:171], a[72:75], v[84:87]
ds_read_b64_tr_b16 a[144:145], v18 offset:32768
ds_read_b64_tr_b16 a[146:147], v18 offset:34816
M v[88:91], a[168:171], a[80:83], v[88:91]
M v[88:91], a[172:175], a[84:87], v[88:91]
M v[92:95], a[172:175], a[92:95], v[92:95]
M v[92:95], a[168:171], a[88:91], v[92:95]
s_waitcnt lgkmcnt(15)
ds_read_b64_tr_b16 a[152:153], v19 offset:32768
ds_read_b64_tr_b16 a[154:155], v19 offset:34816
M v[96:99], a[176:179], a[32:35], v[96:99]
s_add_u32 s24, s24, 262144
s_cmp_eq_u32 s24, s27
s_cselect_b32 s24, s28, s24
s_sub_u32 s6, s6, 1
s_cmp_eq_u32 s6, 0
s_cselect_b64 s[12:13], s[64:65], s[12:13]
M v[96:99], a[180:183], a[36:39], v[96:99]
M v[100:103], a[180:183], a[44:47], v[100:103]
M v[100:103], a[176:179], a[40:43], v[100:103]
M v[104:107], a[176:179], a[48:51], v[104:107]
M v[104:107], a[180:183], a[52:55], v[104:107]
M v[108:111], a[180:183], a[60:63], v[108:111]
M v[108:111], a[176:179], a[56:59], v[108:111]
s_waitcnt vmcnt(16) lgkmcnt(0)
s_barrier
ds_read_b128 a[160:163], v10 offset:16384
ds_read_b128 a[164:167], v11 offset:16384
M v[112:115], a[176:179], a[64:67], v[112:115]
s_add_u32 m0, s29, 0
s_nop 0
buffer_load_dwordx4 v2, s[8:11], s23 offen offset:0 lds
M v[112:115], a[180:183], a[68:71], v[112:115]
M v[116:119], a[180:183], a[76:79], v[116:119]
M v[116:119], a[176:179], a[72:75], v[116:119]
ds_read_b64_tr_b16 a[100:101], v12 offset:49152
ds_read_b64_tr_b16 a[102:103], v12 offset:51200
M v[120:123], a[176:179], a[80:83], v[120:123]
M v[120:123], a[180:183], a[84:87], v[120:123]
M v[124:127], a[180:183], a[92:95], v[124:127]
buffer_load_dwordx4 v3, s[8:11], s23 offen offset:1024 lds
M v[124:127], a[176:179], a[88:91], v[124:127]
M v[128:131], a[184:187], a[32:35], v[128:131]
M v[128:131], a[188:191], a[36:39], v[128:131]
ds_read_b128 a[168:171], v10 offset:18432
ds_read_b128 a[172:175], v11 offset:18432
ds_read_b64_tr_b16 a[108:109], v13 offset:49152
ds_read_b64_tr_b16 a[110:111], v13 offset:51200
M v[132:135], a[188:191], a[44:47], v[132:135]
M v[132:135], a[184:187], a[40:43], v[132:135]
M v[136:139], a[184:187], a[48:51], v[136:139]
M v[136:139], a[188:191], a[52:55], v[136:139]
buffer_load_dwordx4 v4, s[8:11], s23 offen offset:2048 lds
M v[140:143], a[188:191], a[60:63], v[140:143]
M v[140:143], a[184:187], a[56:59], v[140:143]
ds_read_b64_tr_b16 a[116:117], v14 offset:49152
ds_read_b64_tr_b16 a[118:119], v14 offset:51200
M v[144:147], a[184:187], a[64:67], v[144:147]
M v[144:147], a[188:191], a[68:71], v[144:147]
M v[148:151], a[188:191], a[76:79], v[148:151]
M v[148:151], a[184:187], a[72:75], v[148:151]
M v[152:155], a[184:187], a[80:83], v[152:155]
buffer_load_dwordx4 v5, s[8:11], s23 offen offset:3072 lds
M v[152:155], a[188:191], a[84:87], v[152:155]
ds_read_b64_tr_b16 a[124:125], v15 offset:49152
ds_read_b64_tr_b16 a[126:127], v15 offset:51200
M v[156:159], a[188:191], a[92:95], v[156:159]
M v[156:159], a[184:187], a[88:91], v[156:159]
s_waitcnt lgkmcnt(10)
M v[160:163], a[160:163], a[32:35], v[160:163]
M v[160:163], a[164:167], a[36:39], v[160:163]
ds_read_b128 a[176:179], v10 offset:20480
ds_read_b128 a[180:183], v11 offset:20480
M v[164:167], a[164:167], a[44:47], v[164:167]
M v[164:167], a[160:163], a[40:43], v[164:167]
ds_read_b64_tr_b16 a[132:133], v16 offset:49152
ds_read_b64_tr_b16 a[134:135], v16 offset:51200
M v[168:171], a[160:163], a[48:51], v[168:171]
M v[168:171], a[164:167], a[52:55], v[168:171]
s_add_u32 m0, s29, 98304
s_nop 0
buffer_load_dwordx4 v6, s[12:15], s24 offen offset:0 lds
M v[172:175], a[164:167], a[60:63], v[172:175]
M v[172:175], a[160:163], a[56:59], v[172:175]
M v[176:179], a[160:163], a[64:67], v[176:179]
M v[176:179], a[164:167], a[68:71], v[176:179]
ds_read_b64_tr_b16 a[140:141], v17 offset:49152
ds_read_b64_tr_b16 a[142:143], v17 offset:51200
M v[180:183], a[164:167], a[76:79], v[180:183]
M v[180:183], a[160:163], a[72:75], v[180:183]
buffer_load_dwordx4 v7, s[12:15], s24 offen offset:1024 lds
M v[184:187], a[160:163], a[80:83], v[184:187]
M v[184:187], a[164:167], a[84:87], v[184:187]
M v[188:191], a[164:167], a[92:95], v[188:191]
M v[188:191], a[160:163], a[88:91], v[188:191]
s_waitcnt lgkmcnt(12)
ds_read_b64_tr_b16 a[148:149], v18 offset:49152
ds_read_b64_tr_b16 a[150:151], v18 offset:51200
M v[192:195], a[168:171], a[32:35], v[192:195]
M v[192:195], a[172:175], a[36:39], v[192:195]
ds_read_b128 a[184:187], v10 offset:22528
ds_read_b128 a[188:191], v11 offset:22528
M v[196:199], a[172:175], a[44:47], v[196:199]
M v[196:199], a[168:171], a[40:43], v[196:199]
buffer_load_dwordx4 v8, s[12:15], s24 offen offset:2048 lds
M v[200:203], a[168:171], a[48:51], v[200:203]
M v[200:203], a[172:175], a[52:55], v[200:203]
ds_read_b64_tr_b16 a[156:157], v19 offset:49152
ds_read_b64_tr_b16 a[158:159], v19 offset:51200
M v[204:207], a[172:175], a[60:63], v[204:207]
M v[204:207], a[168:171], a[56:59], v[204:207]
M v[208:211], a[168:171], a[64:67], v[208:211]
M v[208:211], a[172:175], a[68:71], v[208:211]
buffer_load_dwordx4 v9, s[12:15], s24 offen offset:3072 lds
M v[212:215], a[172:175], a[76:79], v[212:215]
M v[212:215], a[168:171], a[72:75], v[212:215]
M v[216:219], a[168:171], a[80:83], v[216:219]
M v[216:219], a[172:175], a[84:87], v[216:219]
M v[220:223], a[172:175], a[92:95], v[220:223]
s_add_u32 s24, s24, 262144
M v[220:223], a[168:171], a[88:91], v[220:223]
s_waitcnt lgkmcnt(10)
M v[224:227], a[176:179], a[32:35], v[224:227]
M v[224:227], a[180:183], a[36:39], v[224:227]
M v[228:231], a[180:183], a[44:47], v[228:231]
M v[228:231], a[176:179], a[40:43], v[228:231]
M v[232:235], a[176:179], a[48:51], v[232:235]
M v[232:235], a[180:183], a[52:55], v[232:235]
M v[236:239], a[180:183], a[60:63], v[236:239]
M v[236:239], a[176:179], a[56:59], v[236:239]
s_waitcnt vmcnt(16) lgkmcnt(0)
s_barrier
ds_read_b128 a[160:163], v10 offset:32768
ds_read_b128 a[164:167], v11 offset:32768
M v[240:243], a[176:179], a[64:67], v[240:243]
s_add_u32 m0, s29, 16384
s_add_u32 s3, s23, s31
buffer_load_dwordx4 v2, s[8:11], s3 offen offset:0 lds
M v[240:243], a[180:183], a[68:71], v[240:243]
M v[244:247], a[180:183], a[76:79], v[244:247]
M v[244:247], a[176:179], a[72:75], v[244:247]
M v[248:251], a[176:179], a[80:83], v[248:251]
M v[248:251], a[180:183], a[84:87], v[248:251]
buffer_load_dwordx4 v3, s[8:11], s3 offen offset:1024 lds
M v[252:255], a[180:183], a[92:95], v[252:255]
M v[252:255], a[176:179], a[88:91], v[252:255]
M a[0:3], a[184:187], a[32:35], a[0:3]
M a[0:3], a[188:191], a[36:39], a[0:3]
ds_read_b128 a[168:171], v10 offset:34816
ds_read_b128 a[172:175], v11 offset:34816
M a[4:7], a[188:191], a[44:47], a[4:7]
M a[4:7], a[184:187], a[40:43], a[4:7]
M a[8:11], a[184:187], a[48:51], a[8:11]
buffer_load_dwordx4 v4, s[8:11], s3 offen offset:2048 lds
M a[8:11], a[188:191], a[52:55], a[8:11]
M a[12:15], a[188:191], a[60:63], a[12:15]
M a[12:15], a[184:187], a[56:59], a[12:15]
M a[16:19], a[184:187], a[64:67], a[16:19]
M a[16:19], a[188:191], a[68:71], a[16:19]
buffer_load_dwordx4 v5, s[8:11], s3 offen offset:3072 lds
M a[20:23], a[188:191], a[76:79], a[20:23]
M a[20:23], a[184:187], a[72:75], a[20:23]
M a[24:27], a[184:187], a[80:83], a[24:27]
M a[24:27], a[188:191], a[84:87], a[24:27]
M a[28:31], a[188:191], a[92:95], a[28:31]
M a[28:31], a[184:187], a[88:91], a[28:31]
s_waitcnt lgkmcnt(2)
M v[32:35], a[160:163], a[96:99], v[32:35]
s_add_u32 s23, s23, 128
s_cmp_eq_u32 s23, s25
s_cselect_b32 s23, s26, s23
M v[32:35], a[164:167], a[100:103], v[32:35]
ds_read_b128 a[176:179], v10 offset:36864
ds_read_b128 a[180:183], v11 offset:36864
M v[36:39], a[164:167], a[108:111], v[36:39]
M v[36:39], a[160:163], a[104:107], v[36:39]
ds_read_b64_tr_b16 a[32:33], v12 offset:0
ds_read_b64_tr_b16 a[34:35], v12 offset:2048
M v[40:43], a[160:163], a[112:115], v[40:43]
M v[40:43], a[164:167], a[116:119], v[40:43]
M v[44:47], a[164:167], a[124:127], v[44:47]
s_add_u32 m0, s29, 114688
s_nop 0
buffer_load_dwordx4 v6, s[12:15], s24 offen offset:0 lds
M v[44:47], a[160:163], a[120:123], v[44:47]
ds_read_b64_tr_b16 a[40:41], v13 offset:0
ds_read_b64_tr_b16 a[42:43], v13 offset:2048
M v[48:51], a[160:163], a[128:131], v[48:51]
M v[48:51], a[164:167], a[132:135], v[48:51]
M v[52:55], a[164:167], a[140:143], v[52:55]
M v[52:55], a[160:163], a[136:139], v[52:55]
ds_read_b64_tr_b16 a[48:49], v14 offset:0
ds_read_b64_tr_b16 a[50:51], v14 offset:2048
M v[56:59], a[160:163], a[144:147], v[56:59]
M v[56:59], a[164:167], a[148:151], v[56:59]
buffer_load_dwordx4 v7, s[12:15], s24 offen offset:1024 lds
M v[60:63], a[164:167], a[156:159], v[60:63]
M v[60:63], a[160:163], a[152:155], v[60:63]
s_waitcnt lgkmcnt(8)
ds_read_b64_tr_b16 a[56:57], v15 offset:0
ds_read_b64_tr_b16 a[58:59], v15 offset:2048
M v[64:67], a[168:171], a[96:99], v[64:67]
M v[64:67], a[172:175], a[100:103], v[64:67]
ds_read_b128 a[184:187], v10 offset:38912
ds_read_b128 a[188:191], v11 offset:38912
M v[68:71], a[172:175], a[108:111], v[68:71]
M v[68:71], a[168:171], a[104:107], v[68:71]
ds_read_b64_tr_b16 a[64:65], v16 offset:0
ds_read_b64_tr_b16 a[66:67], v16 offset:2048
M v[72:75], a[168:171], a[112:115], v[72:75]
buffer_load_dwordx4 v8, s[12:15], s24 offen offset:2048 lds
M v[72:75], a[172:175], a[116:119], v[72:75]
M v[76:79], a[172:175], a[124:127], v[76:79]
M v[76:79], a[168:171], a[120:123], v[76:79]
ds_read_b64_tr_b16 a[72:73], v17 offset:0
ds_read_b64_tr_b16 a[74:75], v17 offset:2048
M v[80:83], a[168:171], a[128:131], v[80:83]
M v[80:83], a[172:175], a[132:135], v[80:83]
M v[84:87], a[172:175], a[140:143], v[84:87]
buffer_load_dwordx4 v9, s[12:15], s24 offen offset:3072 lds
M v[84:87], a[168:171], a[136:139], v[84:87]
ds_read_b64_tr_b16 a[80:81], v18 offset:0
ds_read_b64_tr_b16 a[82:83], v18 offset:2048
M v[88:91], a[168:171], a[144:147], v[88:91]
M v[88:91], a[172:175], a[148:151], v[88:91]
M v[92:95], a[172:175], a[156:159], v[92:95]
M v[92:95], a[168:171], a[152:155], v[92:95]
s_waitcnt lgkmcnt(15)
ds_read_b64_tr_b16 a[88:89], v19 offset:0
ds_read_b64_tr_b16 a[90:91], v19 offset:2048
M v[96:99], a[176:179], a[96:99], v[96:99]
s_add_u32 s24, s24, 262144
s_cmp_eq_u32 s24, s27
s_cselect_b32 s24, s28, s24
s_sub_u32 s6, s6, 1
s_cmp_eq_u32 s6, 0
s_cselect_b64 s[12:13], s[64:65], s[12:13]
M v[96:99], a[180:183], a[100:103], v[96:99]
M v[100:103], a[180:183], a[108:111], v[100:103]
M v[100:103], a[176:179], a[104:107], v[100:103]
M v[104:107], a[176:179], a[112:115], v[104:107]
M v[104:107], a[180:183], a[116:119], v[104:107]
M v[108:111], a[180:183], a[124:127], v[108:111]
M v[108:111], a[176:179], a[120:123], v[108:111]
s_waitcnt vmcnt(16) lgkmcnt(0)
s_barrier
ds_read_b128 a[160:163], v10 offset:49152
ds_read_b128 a[164:167], v11 offset:49152
M v[112:115], a[176:179], a[128:131], v[112:115]
s_add_u32 m0, s29, 32768
s_nop 0
buffer_load_dwordx4 v2, s[8:11], s23 offen offset:0 lds
M v[112:115], a[180:183], a[132:135], v[112:115]
M v[116:119], a[180:183], a[140:143], v[116:119]
M v[116:119], a[176:179], a[136:139], v[116:119]
ds_read_b64_tr_b16 a[36:37], v12 offset:16384
ds_read_b64_tr_b16 a[38:39], v12 offset:18432
M v[120:123], a[176:179], a[144:147], v[120:123]
M v[120:123], a[180:183], a[148:151], v[120:123]
M v[124:127], a[180:183], a[156:159], v[124:127]
buffer_load_dwordx4 v3, s[8:11], s23 offen offset:1024 lds
M v[124:127], a[176:179], a[152:155], v[124:127]
M v[128:131], a[184:187], a[96:99], v[128:131]
M v[128:131], a[188:191], a[100:103], v[128:131]
ds_read_b128 a[168:171], v10 offset:51200
ds_read_b128 a[172:175], v11 offset:51200
ds_read_b64_tr_b16 a[44:45], v13 offset:16384
ds_read_b64_tr_b16 a[46:47], v13 offset:18432
M v[132:135], a[188:191], a[108:111], v[132:135]
M v[132:135], a[184:187], a[104:107], v[132:135]
M v[136:139], a[184:187], a[112:115], v[136:139]
M v[136:139], a[188:191], a[116:119], v[136:139]
buffer_load_dwordx4 v4, s[8:11], s23 offen offset:2048 lds
M v[140:143], a[188:191], a[124:127], v[140:143]
M v[140:143], a[184:187], a[120:123], v[140:143]
ds_read_b64_tr_b16 a[52:53], v14 offset:16384
ds_read_b64_tr_b16 a[54:55], v14 offset:18432
M v[144:147], a[184:187], a[128:131], v[144:147]
M v[144:147], a[188:191], a[132:135], v[144:147]
M v[148:151], a[188:191], a[140:143], v[148:151]
M v[148:151], a[184:187], a[136:139], v[148:151]
M v[152:155], a[184:187], a[144:147], v[152:155]
buffer_load_dwordx4 v5, s[8:11], s23 offen offset:3072 lds
M v[152:155], a[188:191], a[148:151], v[152:155]
ds_read_b64_tr_b16 a[60:61], v15 offset:16384
ds_read_b64_tr_b16 a[62:63], v15 offset:18432
M v[156:159], a[188:191], a[156:159], v[156:159]
M v[156:159], a[184:187], a[152:155], v[156:159]
s_waitcnt lgkmcnt(10)
M v[160:163], a[160:163], a[96:99], v[160:163]
M v[160:163], a[164:167], a[100:103], v[160:163]
ds_read_b128 a[176:179], v10 offset:53248
ds_read_b128 a[180:183], v11 offset:53248
M v[164:167], a[164:167], a[108:111], v[164:167]
M v[164:167], a[160:163], a[104:107], v[164:167]
ds_read_b64_tr_b16 a[68:69], v16 offset:16384
ds_read_b64_tr_b16 a[70:71], v16 offset:18432
M v[168:171], a[160:163], a[112:115], v[168:171]
M v[168:171], a[164:167], a[116:119], v[168:171]
s_add_u32 m0, s29, 65536
s_nop 0
buffer_load_dwordx4 v6, s[12:15], s24 offen offset:0 lds
M v[172:175], a[164:167], a[124:127], v[172:175]
M v[172:175], a[160:163], a[120:123], v[172:175]
M v[176:179], a[160:163], a[128:131], v[176:179]
M v[176:179], a[164:167], a[132:135], v[176:179]
ds_read_b64_tr_b16 a[76:77], v17 offset:16384
ds_read_b64_tr_b16 a[78:79], v17 offset:18432
M v[180:183], a[164:167], a[140:143], v[180:183]
M v[180:183], a[160:163], a[136:139], v[180:183]
buffer_load_dwordx4 v7, s[12:15], s24 offen offset:1024 lds
M v[184:187], a[160:163], a[144:147], v[184:187]
M v[184:187], a[164:167], a[148:151], v[184:187]
M v[188:191], a[164:167], a[156:159], v[188:191]
M v[188:191], a[160:163], a[152:155], v[188:191]
s_waitcnt lgkmcnt(12)
ds_read_b64_tr_b16 a[84:85], v18 offset:16384
ds_read_b64_tr_b16 a[86:87], v18 offset:18432
M v[192:195], a[168:171], a[96:99], v[192:195]
M v[192:195], a[172:175], a[100:103], v[192:195]
ds_read_b128 a[184:187], v10 offset:55296
ds_read_b128 a[188:191], v11 offset:55296
M v[196:199], a[172:175], a[108:111], v[196:199]
M v[196:199], a[168:171], a[104:107], v[196:199]
buffer_load_dwordx4 v8, s[12:15], s24 offen offset:2048 lds
M v[200:203], a[168:171], a[112:115], v[200:203]
M v[200:203], a[172:175], a[116:119], v[200:203]
ds_read_b64_tr_b16 a[92:93], v19 offset:16384
ds_read_b64_tr_b16 a[94:95], v19 offset:18432
M v[204:207], a[172:175], a[124:127], v[204:207]
M v[204:207], a[168:171], a[120:123], v[204:207]
M v[208:211], a[168:171], a[128:131], v[208:211]
M v[208:211], a[172:175], a[132:135], v[208:211]
buffer_load_dwordx4 v9, s[12:15], s24 offen offset:3072 lds
M v[212:215], a[172:175], a[140:143], v[212:215]
M v[212:215], a[168:171], a[136:139], v[212:215]
M v[216:219], a[168:171], a[144:147], v[216:219]
M v[216:219], a[172:175], a[148:151], v[216:219]
M v[220:223], a[172:175], a[156:159], v[220:223]
s_add_u32 s24, s24, 262144
M v[220:223], a[168:171], a[152:155], v[220:223]
s_waitcnt lgkmcnt(10)
M v[224:227], a[176:179], a[96:99], v[224:227]
M v[224:227], a[180:183], a[100:103], v[224:227]
M v[228:231], a[180:183], a[108:111], v[228:231]
M v[228:231], a[176:179], a[104:107], v[228:231]
M v[232:235], a[176:179], a[112:115], v[232:235]
M v[232:235], a[180:183], a[116:119], v[232:235]
M v[236:239], a[180:183], a[124:127], v[236:239]
M v[236:239], a[176:179], a[120:123], v[236:239]
s_waitcnt vmcnt(16) lgkmcnt(0)
s_barrier
ds_read_b128 a[160:163], v10 offset:0
ds_read_b128 a[164:167], v11 offset:0
M v[240:243], a[176:179], a[128:131], v[240:243]
s_add_u32 m0, s29, 49152
s_add_u32 s3, s23, s31
buffer_load_dwordx4 v2, s[8:11], s3 offen offset:0 lds
M v[240:243], a[180:183], a[132:135], v[240:243]
M v[244:247], a[180:183], a[140:143], v[244:247]
M v[244:247], a[176:179], a[136:139], v[244:247]
M v[248:251], a[176:179], a[144:147], v[248:251]
M v[248:251], a[180:183], a[148:151], v[248:251]
buffer_load_dwordx4 v3, s[8:11], s3 offen offset:1024 lds
M v[252:255], a[180:183], a[156:159], v[252:255]
M v[252:255], a[176:179], a[152:155], v[252:255]
M a[0:3], a[184:187], a[96:99], a[0:3]
M a[0:3], a[188:191], a[100:103], a[0:3]
ds_read_b128 a[168:171], v10 offset:2048
ds_read_b128 a[172:175], v11 offset:2048
M a[4:7], a[188:191], a[108:111], a[4:7]
M a[4:7], a[184:187], a[104:107], a[4:7]
M a[8:11], a[184:187], a[112:115], a[8:11]
buffer_load_dwordx4 v4, s[8:11], s3 offen offset:2048 lds
M a[8:11], a[188:191], a[116:119], a[8:11]
M a[12:15], a[188:191], a[124:127], a[12:15]
M a[12:15], a[184:187], a[120:123], a[12:15]
M a[16:19], a[184:187], a[128:131], a[16:19]
M a[16:19], a[188:191], a[132:135], a[16:19]
buffer_load_dwordx4 v5, s[8:11], s3 offen offset:3072 lds
M a[20:23], a[188:191], a[140:143], a[20:23]
M a[20:23], a[184:187], a[136:139], a[20:23]
M a[24:27], a[184:187], a[144:147], a[24:27]
M a[24:27], a[188:191], a[148:151], a[24:27]
M a[28:31], a[188:191], a[156:159], a[28:31]
M a[28:31], a[184:187], a[152:155], a[28:31]
s_waitcnt lgkmcnt(2)
M v[32:35], a[160:163], a[32:35], v[32:35]
s_add_u32 s23, s23, 128
s_cmp_eq_u32 s23, s25
s_cselect_b32 s23, s26, s23
M v[32:35], a[164:167], a[36:39], v[32:35]
ds_read_b128 a[176:179], v10 offset:4096
ds_read_b128 a[180:183], v11 offset:4096
M v[36:39], a[164:167], a[44:47], v[36:39]
M v[36:39], a[160:163], a[40:43], v[36:39]
ds_read_b64_tr_b16 a[96:97], v12 offset:32768
ds_read_b64_tr_b16 a[98:99], v12 offset:34816
M v[40:43], a[160:163], a[48:51], v[40:43]
M v[40:43], a[164:167], a[52:55], v[40:43]
M v[44:47], a[164:167], a[60:63], v[44:47]
s_add_u32 m0, s29, 81920
s_nop 0
buffer_load_dwordx4 v6, s[12:15], s24 offen offset:0 lds
M v[44:47], a[160:163], a[56:59], v[44:47]
ds_read_b64_tr_b16 a[104:105], v13 offset:32768
ds_read_b64_tr_b16 a[106:107], v13 offset:34816
M v[48:51], a[160:163], a[64:67], v[48:51]
M v[48:51], a[164:167], a[68:71], v[48:51]
M v[52:55], a[164:167], a[76:79], v[52:55]
M v[52:55], a[160:163], a[72:75], v[52:55]
ds_read_b64_tr_b16 a[112:113], v14 offset:32768
ds_read_b64_tr_b16 a[114:115], v14 offset:34816
M v[56:59], a[160:163], a[80:83], v[56:59]
M v[56:59], a[164:167], a[84:87], v[56:59]
buffer_load_dwordx4 v7, s[12:15], s24 offen offset:1024 lds
M v[60:63], a[164:167], a[92:95], v[60:63]
M v[60:63], a[160:163], a[88:91], v[60:63]
s_waitcnt lgkmcnt(8)
ds_read_b64_tr_b16 a[120:121], v15 offset:32768
ds_read_b64_tr_b16 a[122:123], v15 offset:34816
M v[64:67], a[168:171], a[32:35], v[64:67]
M v[64:67], a[172:175], a[36:39], v[64:67]
ds_read_b128 a[184:187], v10 offset:6144
ds_read_b128 a[188:191], v11 offset:6144
M v[68:71], a[172:175], a[44:47], v[68:71]
M v[68:71], a[168:171], a[40:43], v[68:71]
ds_read_b64_tr_b16 a[128:129], v16 offset:32768
ds_read_b64_tr_b16 a[130:131], v16 offset:34816
M v[72:75], a[168:171], a[48:51], v[72:75]
buffer_load_dwordx4 v8, s[12:15], s24 offen offset:2048 lds
M v[72:75], a[172:175], a[52:55], v[72:75]
M v[76:79], a[172:175], a[60:63], v[76:79]
M v[76:79], a[168:171], a[56:59], v[76:79]
ds_read_b64_tr_b16 a[136:137], v17 offset:32768
ds_read_b64_tr_b16 a[138:139], v17 offset:34816
M v[80:83], a[168:171], a[64:67], v[80:83]
M v[80:83], a[172:175], a[68:71], v[80:83]
M v[84:87], a[172:175], a[76:79], v[84:87]
buffer_load_dwordx4 v9, s[12:15], s24 offen offset:3072 lds
M v[84:87], a[168:171], a[72:75], v[84:87]
ds_read_b64_tr_b16 a[144:145], v18 offset:32768
ds_read_b64_tr_b16 a[146:147], v18 offset:34816
M v[88:91], a[168:171], a[80:83], v[88:91]
M v[88:91], a[172:175], a[84:87], v[88:91]
M v[92:95], a[172:175], a[92:95], v[92:95]
M v[92:95], a[168:171], a[88:91], v[92:95]
s_waitcnt lgkmcnt(15)
ds_read_b64_tr_b16 a[152:153], v19 offset:32768
ds_read_b64_tr_b16 a[154:155], v19 offset:34816
M v[96:99], a[176:179], a[32:35], v[96:99]
s_add_u32 s24, s24, 262144
s_cmp_eq_u32 s24, s27
s_cselect_b32 s24, s28, s24
s_sub_u32 s6, s6, 1
s_cmp_eq_u32 s6, 0
s_cselect_b64 s[12:13], s[64:65], s[12:13]
M v[96:99], a[180:183], a[36:39], v[96:99]
M v[100:103], a[180:183], a[44:47], v[100:103]
M v[100:103], a[176:179], a[40:43], v[100:103]
M v[104:107], a[176:179], a[48:51], v[104:107]
M v[104:107], a[180:183], a[52:55], v[104:107]
M v[108:111], a[180:183], a[60:63], v[108:111]
M v[108:111], a[176:179], a[56:59], v[108:111]
s_waitcnt vmcnt(16) lgkmcnt(0)
s_barrier
ds_read_b128 a[160:163], v10 offset:16384
ds_read_b128 a[164:167], v11 offset:16384
M v[112:115], a[176:179], a[64:67], v[112:115]
s_add_u32 m0, s29, 0
s_nop 0
buffer_load_dwordx4 v2, s[8:11], s23 offen offset:0 lds
M v[112:115], a[180:183], a[68:71], v[112:115]
M v[116:119], a[180:183], a[76:79], v[116:119]
M v[116:119], a[176:179], a[72:75], v[116:119]
ds_read_b64_tr_b16 a[100:101], v12 offset:49152
ds_read_b64_tr_b16 a[102:103], v12 offset:51200
M v[120:123], a[176:179], a[80:83], v[120:123]
M v[120:123], a[180:183], a[84:87], v[120:123]
M v[124:127], a[180:183], a[92:95], v[124:127]
buffer_load_dwordx4 v3, s[8:11], s23 offen offset:1024 lds
M v[124:127], a[176:179], a[88:91], v[124:127]
M v[128:131], a[184:187], a[32:35], v[128:131]
M v[128:131], a[188:191], a[36:39], v[128:131]
ds_read_b128 a[168:171], v10 offset:18432
ds_read_b128 a[172:175], v11 offset:18432
ds_read_b64_tr_b16 a[108:109], v13 offset:49152
ds_read_b64_tr_b16 a[110:111], v13 offset:51200
M v[132:135], a[188:191], a[44:47], v[132:135]
M v[132:135], a[184:187], a[40:43], v[132:135]
M v[136:139], a[184:187], a[48:51], v[136:139]
M v[136:139], a[188:191], a[52:55], v[136:139]
buffer_load_dwordx4 v4, s[8:11], s23 offen offset:2048 lds
M v[140:143], a[188:191], a[60:63], v[140:143]
M v[140:143], a[184:187], a[56:59], v[140:143]
ds_read_b64_tr_b16 a[116:117], v14 offset:49152
ds_read_b64_tr_b16 a[118:119], v14 offset:51200
M v[144:147], a[184:187], a[64:67], v[144:147]
M v[144:147], a[188:191], a[68:71], v[144:147]
M v[148:151], a[188:191], a[76:79], v[148:151]
M v[148:151], a[184:187], a[72:75], v[148:151]
M v[152:155], a[184:187], a[80:83], v[152:155]
buffer_load_dwordx4 v5, s[8:11], s23 offen offset:3072 lds
M v[152:155], a[188:191], a[84:87], v[152:155]
ds_read_b64_tr_b16 a[124:125], v15 offset:49152
ds_read_b64_tr_b16 a[126:127], v15 offset:51200
M v[156:159], a[188:191], a[92:95], v[156:159]
M v[156:159], a[184:187], a[88:91], v[156:159]
s_waitcnt lgkmcnt(10)
M v[160:163], a[160:163], a[32:35], v[160:163]
M v[160:163], a[164:167], a[36:39], v[160:163]
ds_read_b128 a[176:179], v10 offset:20480
ds_read_b128 a[180:183], v11 offset:20480
M v[164:167], a[164:167], a[44:47], v[164:167]
M v[164:167], a[160:163], a[40:43], v[164:167]
ds_read_b64_tr_b16 a[132:133], v16 offset:49152
ds_read_b64_tr_b16 a[134:135], v16 offset:51200
M v[168:171], a[160:163], a[48:51], v[168:171]
M v[168:171], a[164:167], a[52:55], v[168:171]
s_add_u32 m0, s29, 98304
s_nop 0
buffer_load_dwordx4 v6, s[12:15], s24 offen offset:0 lds
M v[172:175], a[164:167], a[60:63], v[172:175]
M v[172:175], a[160:163], a[56:59], v[172:175]
M v[176:179], a[160:163], a[64:67], v[176:179]
M v[176:179], a[164:167], a[68:71], v[176:179]
ds_read_b64_tr_b16 a[140:141], v17 offset:49152
ds_read_b64_tr_b16 a[142:143], v17 offset:51200
M v[180:183], a[164:167], a[76:79], v[180:183]
M v[180:183], a[160:163], a[72:75], v[180:183]
buffer_load_dwordx4 v7, s[12:15], s24 offen offset:1024 lds
M v[184:187], a[160:163], a[80:83], v[184:187]
M v[184:187], a[164:167], a[84:87], v[184:187]
M v[188:191], a[164:167], a[92:95], v[188:191]
M v[188:191], a[160:163], a[88:91], v[188:191]
s_waitcnt lgkmcnt(12)
ds_read_b64_tr_b16 a[148:149], v18 offset:49152
ds_read_b64_tr_b16 a[150:151], v18 offset:51200
M v[192:195], a[168:171], a[32:35], v[192:195]
M v[192:195], a[172:175], a[36:39], v[192:195]
ds_read_b128 a[184:187], v10 offset:22528
ds_read_b128 a[188:191], v11 offset:22528
M v[196:199], a[172:175], a[44:47], v[196:199]
M v[196:199], a[168:171], a[40:43], v[196:199]
buffer_load_dwordx4 v8, s[12:15], s24 offen offset:2048 lds
M v[200:203], a[168:171], a[48:51], v[200:203]
M v[200:203], a[172:175], a[52:55], v[200:203]
ds_read_b64_tr_b16 a[156:157], v19 offset:49152
ds_read_b64_tr_b16 a[158:159], v19 offset:51200
M v[204:207], a[172:175], a[60:63], v[204:207]
M v[204:207], a[168:171], a[56:59], v[204:207]
M v[208:211], a[168:171], a[64:67], v[208:211]
M v[208:211], a[172:175], a[68:71], v[208:211]
buffer_load_dwordx4 v9, s[12:15], s24 offen offset:3072 lds
M v[212:215], a[172:175], a[76:79], v[212:215]
M v[212:215], a[168:171], a[72:75], v[212:215]
M v[216:219], a[168:171], a[80:83], v[216:219]
M v[216:219], a[172:175], a[84:87], v[216:219]
M v[220:223], a[172:175], a[92:95], v[220:223]
s_add_u32 s24, s24, 262144
M v[220:223], a[168:171], a[88:91], v[220:223]
s_waitcnt lgkmcnt(10)
M v[224:227], a[176:179], a[32:35], v[224:227]
M v[224:227], a[180:183], a[36:39], v[224:227]
M v[228:231], a[180:183], a[44:47], v[228:231]
M v[228:231], a[176:179], a[40:43], v[228:231]
M v[232:235], a[176:179], a[48:51], v[232:235]
M v[232:235], a[180:183], a[52:55], v[232:235]
M v[236:239], a[180:183], a[60:63], v[236:239]
M v[236:239], a[176:179], a[56:59], v[236:239]
s_waitcnt vmcnt(16) lgkmcnt(0)
s_barrier
ds_read_b128 a[160:163], v10 offset:32768
ds_read_b128 a[164:167], v11 offset:32768
M v[240:243], a[176:179], a[64:67], v[240:243]
s_add_u32 m0, s29, 16384
s_add_u32 s3, s23, s31
buffer_load_dwordx4 v2, s[8:11], s3 offen offset:0 lds
M v[240:243], a[180:183], a[68:71], v[240:243]
M v[244:247], a[180:183], a[76:79], v[244:247]
M v[244:247], a[176:179], a[72:75], v[244:247]
M v[248:251], a[176:179], a[80:83], v[248:251]
M v[248:251], a[180:183], a[84:87], v[248:251]
buffer_load_dwordx4 v3, s[8:11], s3 offen offset:1024 lds
M v[252:255], a[180:183], a[92:95], v[252:255]
M v[252:255], a[176:179], a[88:91], v[252:255]
M a[0:3], a[184:187], a[32:35], a[0:3]
M a[0:3], a[188:191], a[36:39], a[0:3]
ds_read_b128 a[168:171], v10 offset:34816
ds_read_b128 a[172:175], v11 offset:34816
M a[4:7], a[188:191], a[44:47], a[4:7]
M a[4:7], a[184:187], a[40:43], a[4:7]
M a[8:11], a[184:187], a[48:51], a[8:11]
buffer_load_dwordx4 v4, s[8:11], s3 offen offset:2048 lds
M a[8:11], a[188:191], a[52:55], a[8:11]
M a[12:15], a[188:191], a[60:63], a[12:15]
M a[12:15], a[184:187], a[56:59], a[12:15]
M a[16:19], a[184:187], a[64:67], a[16:19]
M a[16:19], a[188:191], a[68:71], a[16:19]
buffer_load_dwordx4 v5, s[8:11], s3 offen offset:3072 lds
M a[20:23], a[188:191], a[76:79], a[20:23]
M a[20:23], a[184:187], a[72:75], a[20:23]
M a[24:27], a[184:187], a[80:83], a[24:27]
M a[24:27], a[188:191], a[84:87], a[24:27]
M a[28:31], a[188:191], a[92:95], a[28:31]
M a[28:31], a[184:187], a[88:91], a[28:31]
s_waitcnt lgkmcnt(2)
M v[32:35], a[160:163], a[96:99], v[32:35]
s_add_u32 s23, s23, 128
s_cmp_eq_u32 s23, s25
s_cselect_b32 s23, s26, s23
M v[32:35], a[164:167], a[100:103], v[32:35]
ds_read_b128 a[176:179], v10 offset:36864
ds_read_b128 a[180:183], v11 offset:36864
M v[36:39], a[164:167], a[108:111], v[36:39]
M v[36:39], a[160:163], a[104:107], v[36:39]
ds_read_b64_tr_b16 a[32:33], v12 offset:0
ds_read_b64_tr_b16 a[34:35], v12 offset:2048
M v[40:43], a[160:163], a[112:115], v[40:43]
M v[40:43], a[164:167], a[116:119], v[40:43]
M v[44:47], a[164:167], a[124:127], v[44:47]
s_add_u32 m0, s29, 114688
s_nop 0
buffer_load_dwordx4 v6, s[12:15], s24 offen offset:0 lds
M v[44:47], a[160:163], a[120:123], v[44:47]
ds_read_b64_tr_b16 a[40:41], v13 offset:0
ds_read_b64_tr_b16 a[42:43], v13 offset:2048
M v[48:51], a[160:163], a[128:131], v[48:51]
M v[48:51], a[164:167], a[132:135], v[48:51]
M v[52:55], a[164:167], a[140:143], v[52:55]
M v[52:55], a[160:163], a[136:139], v[52:55]
ds_read_b64_tr_b16 a[48:49], v14 offset:0
ds_read_b64_tr_b16 a[50:51], v14 offset:2048
M v[56:59], a[160:163], a[144:147], v[56:59]
M v[56:59], a[164:167], a[148:151], v[56:59]
buffer_load_dwordx4 v7, s[12:15], s24 offen offset:1024 lds
M v[60:63], a[164:167], a[156:159], v[60:63]
M v[60:63], a[160:163], a[152:155], v[60:63]
s_waitcnt lgkmcnt(8)
ds_read_b64_tr_b16 a[56:57], v15 offset:0
ds_read_b64_tr_b16 a[58:59], v15 offset:2048
M v[64:67], a[168:171], a[96:99], v[64:67]
M v[64:67], a[172:175], a[100:103], v[64:67]
ds_read_b128 a[184:187], v10 offset:38912
ds_read_b128 a[188:191], v11 offset:38912
M v[68:71], a[172:175], a[108:111], v[68:71]
M v[68:71], a[168:171], a[104:107], v[68:71]
ds_read_b64_tr_b16 a[64:65], v16 offset:0
ds_read_b64_tr_b16 a[66:67], v16 offset:2048
M v[72:75], a[168:171], a[112:115], v[72:75]
buffer_load_dwordx4 v8, s[12:15], s24 offen offset:2048 lds
M v[72:75], a[172:175], a[116:119], v[72:75]
M v[76:79], a[172:175], a[124:127], v[76:79]
M v[76:79], a[168:171], a[120:123], v[76:79]
ds_read_b64_tr_b16 a[72:73], v17 offset:0
ds_read_b64_tr_b16 a[74:75], v17 offset:2048
M v[80:83], a[168:171], a[128:131], v[80:83]
M v[80:83], a[172:175], a[132:135], v[80:83]
M v[84:87], a[172:175], a[140:143], v[84:87]
buffer_load_dwordx4 v9, s[12:15], s24 offen offset:3072 lds
M v[84:87], a[168:171], a[136:139], v[84:87]
ds_read_b64_tr_b16 a[80:81], v18 offset:0
ds_read_b64_tr_b16 a[82:83], v18 offset:2048
M v[88:91], a[168:171], a[144:147], v[88:91]
M v[88:91], a[172:175], a[148:151], v[88:91]
M v[92:95], a[172:175], a[156:159], v[92:95]
M v[92:95], a[168:171], a[152:155], v[92:95]
s_waitcnt lgkmcnt(15)
ds_read_b64_tr_b16 a[88:89], v19 offset:0
ds_read_b64_tr_b16 a[90:91], v19 offset:2048
M v[96:99], a[176:179], a[96:99], v[96:99]
s_add_u32 s24, s24, 262144
s_cmp_eq_u32 s24, s27
s_cselect_b32 s24, s28, s24
s_sub_u32 s6, s6, 1
s_cmp_eq_u32 s6, 0
s_cselect_b64 s[12:13], s[64:65], s[12:13]
M v[96:99], a[180:183], a[100:103], v[96:99]
M v[100:103], a[180:183], a[108:111], v[100:103]
M v[100:103], a[176:179], a[104:107], v[100:103]
M v[104:107], a[176:179], a[112:115], v[104:107]
M v[104:107], a[180:183], a[116:119], v[104:107]
M v[108:111], a[180:183], a[124:127], v[108:111]
M v[108:111], a[176:179], a[120:123], v[108:111]
s_waitcnt vmcnt(16) lgkmcnt(0)
s_barrier
ds_read_b128 a[160:163], v10 offset:49152
ds_read_b128 a[164:167], v11 offset:49152
M v[112:115], a[176:179], a[128:131], v[112:115]
s_add_u32 m0, s29, 32768
s_nop 0
buffer_load_dwordx4 v2, s[8:11], s23 offen offset:0 lds
M v[112:115], a[180:183], a[132:135], v[112:115]
M v[116:119], a[180:183], a[140:143], v[116:119]
M v[116:119], a[176:179], a[136:139], v[116:119]
ds_read_b64_tr_b16 a[36:37], v12 offset:16384
ds_read_b64_tr_b16 a[38:39], v12 offset:18432
M v[120:123], a[176:179], a[144:147], v[120:123]
M v[120:123], a[180:183], a[148:151], v[120:123]
M v[124:127], a[180:183], a[156:159], v[124:127]
M v[124:127], a[176:179], a[152:155], v[124:127]
M v[128:131], a[184:187], a[96:99], v[128:131]
M v[128:131], a[188:191], a[100:103], v[128:131]
ds_read_b128 a[168:171], v10 offset:51200
ds_read_b128 a[172:175], v11 offset:51200
ds_read_b64_tr_b16 a[44:45], v13 offset:16384
ds_read_b64_tr_b16 a[46:47], v13 offset:18432
M v[132:135], a[188:191], a[108:111], v[132:135]
M v[132:135], a[184:187], a[104:107], v[132:135]
M v[136:139], a[184:187], a[112:115], v[136:139]
M v[136:139], a[188:191], a[116:119], v[136:139]
M v[140:143], a[188:191], a[124:127], v[140:143]
M v[140:143], a[184:187], a[120:123], v[140:143]
ds_read_b64_tr_b16 a[52:53], v14 offset:16384
ds_read_b64_tr_b16 a[54:55], v14 offset:18432
M v[144:147], a[184:187], a[128:131], v[144:147]
buffer_load_dwordx4 v3, s[8:11], s23 offen offset:1024 lds
M v[144:147], a[188:191], a[132:135], v[144:147]
M v[148:151], a[188:191], a[140:143], v[148:151]
M v[148:151], a[184:187], a[136:139], v[148:151]
M v[152:155], a[184:187], a[144:147], v[152:155]
M v[152:155], a[188:191], a[148:151], v[152:155]
ds_read_b64_tr_b16 a[60:61], v15 offset:16384
ds_read_b64_tr_b16 a[62:63], v15 offset:18432
M v[156:159], a[188:191], a[156:159], v[156:159]
M v[156:159], a[184:187], a[152:155], v[156:159]
s_waitcnt lgkmcnt(10)
M v[160:163], a[160:163], a[96:99], v[160:163]
M v[160:163], a[164:167], a[100:103], v[160:163]
ds_read_b128 a[176:179], v10 offset:53248
ds_read_b128 a[180:183], v11 offset:53248
M v[164:167], a[164:167], a[108:111], v[164:167]
M v[164:167], a[160:163], a[104:107], v[164:167]
ds_read_b64_tr_b16 a[68:69], v16 offset:16384
ds_read_b64_tr_b16 a[70:71], v16 offset:18432
M v[168:171], a[160:163], a[112:115], v[168:171]
M v[168:171], a[164:167], a[116:119], v[168:171]
M v[172:175], a[164:167], a[124:127], v[172:175]
M v[172:175], a[160:163], a[120:123], v[172:175]
M v[176:179], a[160:163], a[128:131], v[176:179]
buffer_load_dwordx4 v4, s[8:11], s23 offen offset:2048 lds
M v[176:179], a[164:167], a[132:135], v[176:179]
ds_read_b64_tr_b16 a[76:77], v17 offset:16384
ds_read_b64_tr_b16 a[78:79], v17 offset:18432
M v[180:183], a[164:167], a[140:143], v[180:183]
M v[180:183], a[160:163], a[136:139], v[180:183]
M v[184:187], a[160:163], a[144:147], v[184:187]
M v[184:187], a[164:167], a[148:151], v[184:187]
M v[188:191], a[164:167], a[156:159], v[188:191]
M v[188:191], a[160:163], a[152:155], v[188:191]
s_waitcnt lgkmcnt(12)
ds_read_b64_tr_b16 a[84:85], v18 offset:16384
ds_read_b64_tr_b16 a[86:87], v18 offset:18432
M v[192:195], a[168:171], a[96:99], v[192:195]
M v[192:195], a[172:175], a[100:103], v[192:195]
ds_read_b128 a[184:187], v10 offset:55296
ds_read_b128 a[188:191], v11 offset:55296
M v[196:199], a[172:175], a[108:111], v[196:199]
M v[196:199], a[168:171], a[104:107], v[196:199]
M v[200:203], a[168:171], a[112:115], v[200:203]
M v[200:203], a[172:175], a[116:119], v[200:203]
ds_read_b64_tr_b16 a[92:93], v19 offset:16384
ds_read_b64_tr_b16 a[94:95], v19 offset:18432
M v[204:207], a[172:175], a[124:127], v[204:207]
M v[204:207], a[168:171], a[120:123], v[204:207]
M v[208:211], a[168:171], a[128:131], v[208:211]
buffer_load_dwordx4 v5, s[8:11], s23 offen offset:3072 lds
M v[208:211], a[172:175], a[132:135], v[208:211]
M v[212:215], a[172:175], a[140:143], v[212:215]
M v[212:215], a[168:171], a[136:139], v[212:215]
M v[216:219], a[168:171], a[144:147], v[216:219]
M v[216:219], a[172:175], a[148:151], v[216:219]
M v[220:223], a[172:175], a[156:159], v[220:223]
M v[220:223], a[168:171], a[152:155], v[220:223]
s_waitcnt lgkmcnt(10)
M v[224:227], a[176:179], a[96:99], v[224:227]
M v[224:227], a[180:183], a[100:103], v[224:227]
M v[228:231], a[180:183], a[108:111], v[228:231]
M v[228:231], a[176:179], a[104:107], v[228:231]
M v[232:235], a[176:179], a[112:115], v[232:235]
M v[232:235], a[180:183], a[116:119], v[232:235]
M v[236:239], a[180:183], a[124:127], v[236:239]
M v[236:239], a[176:179], a[120:123], v[236:239]
s_waitcnt vmcnt(12) lgkmcnt(0)
s_barrier
ds_read_b128 a[160:163], v10 offset:0
ds_read_b128 a[164:167], v11 offset:0
M v[240:243], a[176:179], a[128:131], v[240:243]
s_add_u32 m0, s29, 49152
s_add_u32 s3, s23, s31
buffer_load_dwordx4 v2, s[8:11], s3 offen offset:0 lds
M v[240:243], a[180:183], a[132:135], v[240:243]
M v[244:247], a[180:183], a[140:143], v[244:247]
M v[244:247], a[176:179], a[136:139], v[244:247]
M v[248:251], a[176:179], a[144:147], v[248:251]
M v[248:251], a[180:183], a[148:151], v[248:251]
M v[252:255], a[180:183], a[156:159], v[252:255]
M v[252:255], a[176:179], a[152:155], v[252:255]
M a[0:3], a[184:187], a[96:99], a[0:3]
M a[0:3], a[188:191], a[100:103], a[0:3]
ds_read_b128 a[168:171], v10 offset:2048
ds_read_b128 a[172:175], v11 offset:2048
M a[4:7], a[188:191], a[108:111], a[4:7]
M a[4:7], a[184:187], a[104:107], a[4:7]
M a[8:11], a[184:187], a[112:115], a[8:11]
buffer_load_dwordx4 v3, s[8:11], s3 offen offset:1024 lds
M a[8:11], a[188:191], a[116:119], a[8:11]
M a[12:15], a[188:191], a[124:127], a[12:15]
M a[12:15], a[184:187], a[120:123], a[12:15]
M a[16:19], a[184:187], a[128:131], a[16:19]
M a[16:19], a[188:191], a[132:135], a[16:19]
M a[20:23], a[188:191], a[140:143], a[20:23]
M a[20:23], a[184:187], a[136:139], a[20:23]
M a[24:27], a[184:187], a[144:147], a[24:27]
M a[24:27], a[188:191], a[148:151], a[24:27]
M a[28:31], a[188:191], a[156:159], a[28:31]
M a[28:31], a[184:187], a[152:155], a[28:31]
s_waitcnt lgkmcnt(2)
M v[32:35], a[160:163], a[32:35], v[32:35]
buffer_load_dwordx4 v4, s[8:11], s3 offen offset:2048 lds
M v[32:35], a[164:167], a[36:39], v[32:35]
ds_read_b128 a[176:179], v10 offset:4096
ds_read_b128 a[180:183], v11 offset:4096
M v[36:39], a[164:167], a[44:47], v[36:39]
M v[36:39], a[160:163], a[40:43], v[36:39]
ds_read_b64_tr_b16 a[96:97], v12 offset:32768
ds_read_b64_tr_b16 a[98:99], v12 offset:34816
M v[40:43], a[160:163], a[48:51], v[40:43]
M v[40:43], a[164:167], a[52:55], v[40:43]
M v[44:47], a[164:167], a[60:63], v[44:47]
M v[44:47], a[160:163], a[56:59], v[44:47]
ds_read_b64_tr_b16 a[104:105], v13 offset:32768
ds_read_b64_tr_b16 a[106:107], v13 offset:34816
M v[48:51], a[160:163], a[64:67], v[48:51]
M v[48:51], a[164:167], a[68:71], v[48:51]
M v[52:55], a[164:167], a[76:79], v[52:55]
M v[52:55], a[160:163], a[72:75], v[52:55]
ds_read_b64_tr_b16 a[112:113], v14 offset:32768
ds_read_b64_tr_b16 a[114:115], v14 offset:34816
M v[56:59], a[160:163], a[80:83], v[56:59]
M v[56:59], a[164:167], a[84:87], v[56:59]
buffer_load_dwordx4 v5, s[8:11], s3 offen offset:3072 lds
M v[60:63], a[164:167], a[92:95], v[60:63]
M v[60:63], a[160:163], a[88:91], v[60:63]
s_waitcnt lgkmcnt(8)
ds_read_b64_tr_b16 a[120:121], v15 offset:32768
ds_read_b64_tr_b16 a[122:123], v15 offset:34816
M v[64:67], a[168:171], a[32:35], v[64:67]
M v[64:67], a[172:175], a[36:39], v[64:67]
ds_read_b128 a[184:187], v10 offset:6144
ds_read_b128 a[188:191], v11 offset:6144
M v[68:71], a[172:175], a[44:47], v[68:71]
M v[68:71], a[168:171], a[40:43], v[68:71]
ds_read_b64_tr_b16 a[128:129], v16 offset:32768
ds_read_b64_tr_b16 a[130:131], v16 offset:34816
M v[72:75], a[168:171], a[48:51], v[72:75]
M v[72:75], a[172:175], a[52:55], v[72:75]
M v[76:79], a[172:175], a[60:63], v[76:79]
M v[76:79], a[168:171], a[56:59], v[76:79]
ds_read_b64_tr_b16 a[136:137], v17 offset:32768
ds_read_b64_tr_b16 a[138:139], v17 offset:34816
M v[80:83], a[168:171], a[64:67], v[80:83]
M v[80:83], a[172:175], a[68:71], v[80:83]
M v[84:87], a[172:175], a[76:79], v[84:87]
s_add_u32 s23, s23, 128
s_cmp_eq_u32 s23, s25
s_cselect_b32 s23, s26, s23
M v[84:87], a[168:171], a[72:75], v[84:87]
ds_read_b64_tr_b16 a[144:145], v18 offset:32768
ds_read_b64_tr_b16 a[146:147], v18 offset:34816
M v[88:91], a[168:171], a[80:83], v[88:91]
M v[88:91], a[172:175], a[84:87], v[88:91]
M v[92:95], a[172:175], a[92:95], v[92:95]
M v[92:95], a[168:171], a[88:91], v[92:95]
s_waitcnt lgkmcnt(15)
ds_read_b64_tr_b16 a[152:153], v19 offset:32768
ds_read_b64_tr_b16 a[154:155], v19 offset:34816
M v[96:99], a[176:179], a[32:35], v[96:99]
M v[96:99], a[180:183], a[36:39], v[96:99]
M v[100:103], a[180:183], a[44:47], v[100:103]
M v[100:103], a[176:179], a[40:43], v[100:103]
M v[104:107], a[176:179], a[48:51], v[104:107]
M v[104:107], a[180:183], a[52:55], v[104:107]
M v[108:111], a[180:183], a[60:63], v[108:111]
M v[108:111], a[176:179], a[56:59], v[108:111]
s_waitcnt vmcnt(8) lgkmcnt(0)
s_barrier
ds_read_b128 a[160:163], v10 offset:16384
ds_read_b128 a[164:167], v11 offset:16384
M v[112:115], a[176:179], a[64:67], v[112:115]
M v[112:115], a[180:183], a[68:71], v[112:115]
s_and_b32 s3, s2, 1
s_lshl_b32 s3, s3, 3
s_bfe_u32 s4, s2, 0x30003
M v[116:119], a[180:183], a[76:79], v[116:119]
s_add_u32 s26, s3, s4
s_bfe_u32 s3, s2, 0x20001
s_lshl_b32 s3, s3, 2
M v[116:119], a[176:179], a[72:75], v[116:119]
ds_read_b64_tr_b16 a[100:101], v12 offset:49152
ds_read_b64_tr_b16 a[102:103], v12 offset:51200
s_lshr_b32 s4, s2, 6
s_xor_b32 s4, s4, 2
s_add_u32 s27, s3, s4
M v[120:123], a[176:179], a[80:83], v[120:123]
s_lshl_b32 s23, s26, 18
s_sub_u32 s24, s23, 32768
M v[120:123], a[180:183], a[84:87], v[120:123]
s_max_i32 s24, s24, 0
s_lshl_b32 s25, s27, 7
s_xor_b32 s3, s26, s27
M v[124:127], a[180:183], a[92:95], v[124:127]
s_and_b32 s3, s3, 0
s_lshl_b32 s3, s3, 3
s_sub_u32 s31, 16, s3
M v[124:127], a[176:179], a[88:91], v[124:127]
s_mov_b32 s54, s31
s_movk_i32 s57, 128
M v[128:131], a[184:187], a[32:35], v[128:131]
s_mov_b32 s55, 4289069056
s_mov_b32 s56, 393216
s_lshl_b32 s4, s3, 7
M v[128:131], a[188:191], a[36:39], v[128:131]
ds_read_b128 a[168:171], v10 offset:18432
ds_read_b128 a[172:175], v11 offset:18432
ds_read_b64_tr_b16 a[108:109], v13 offset:49152
ds_read_b64_tr_b16 a[110:111], v13 offset:51200
s_add_u32 s23, s23, s4
s_add_u32 s24, s24, s4
s_mul_i32 s4, s3, 393216
M v[132:135], a[188:191], a[44:47], v[132:135]
s_add_u32 s25, s25, s4
s_mov_b64 s[8:9], s[44:45]
s_mov_b32 s10, 4194304
M v[132:135], a[184:187], a[40:43], v[132:135]
s_mov_b64 s[12:13], s[46:47]
s_mov_b32 s14, 6291456
M v[136:139], a[184:187], a[48:51], v[136:139]
s_mov_b64 s[36:37], s[90:91]
s_mov_b32 s38, 256
s_mov_b32 s39, 0x00020000
M v[136:139], a[188:191], a[52:55], v[136:139]
s_lshl_b32 s28, s20, 9
s_mul_i32 s30, s20, 6144
s_lshl_b32 s3, s20, 5
M v[140:143], a[188:191], a[60:63], v[140:143]
v_lshrrev_b32 v24, 3, v0
v_and_b32 v25, 7, v0
M v[140:143], a[184:187], a[56:59], v[140:143]
ds_read_b64_tr_b16 a[116:117], v14 offset:49152
ds_read_b64_tr_b16 a[118:119], v14 offset:51200
v_add_u32 v28, s3, v24
v_add_u32 v26, 0, v28
v_bfe_u32 v27, v26, 1, 3
M v[144:147], a[184:187], a[64:67], v[144:147]
v_xor_b32 v27, v27, v25
v_lshlrev_b32 v26, 11, v26
v_lshl_add_u32 v26, v27, 4, v26
M v[144:147], a[188:191], a[68:71], v[144:147]
v_subrev_u32 v2, 0, v26
v_add_u32 v26, 8, v28
v_bfe_u32 v27, v26, 1, 3
M v[148:151], a[188:191], a[76:79], v[148:151]
v_xor_b32 v27, v27, v25
v_lshlrev_b32 v26, 11, v26
M v[148:151], a[184:187], a[72:75], v[148:151]
v_lshl_add_u32 v26, v27, 4, v26
v_subrev_u32 v3, 1024, v26
v_add_u32 v26, 16, v28
M v[152:155], a[184:187], a[80:83], v[152:155]
v_bfe_u32 v27, v26, 1, 3
v_xor_b32 v27, v27, v25
v_lshlrev_b32 v26, 11, v26
M v[152:155], a[188:191], a[84:87], v[152:155]
ds_read_b64_tr_b16 a[124:125], v15 offset:49152
ds_read_b64_tr_b16 a[126:127], v15 offset:51200
v_lshl_add_u32 v26, v27, 4, v26
v_subrev_u32 v4, 2048, v26
M v[156:159], a[188:191], a[92:95], v[156:159]
v_add_u32 v26, 24, v28
v_bfe_u32 v27, v26, 1, 3
v_xor_b32 v27, v27, v25
M v[156:159], a[184:187], a[88:91], v[156:159]
s_waitcnt lgkmcnt(10)
v_lshlrev_b32 v26, 11, v26
v_lshl_add_u32 v26, v27, 4, v26
v_subrev_u32 v5, 3072, v26
M v[160:163], a[160:163], a[32:35], v[160:163]
s_lshl_b32 s3, s20, 2
v_lshrrev_b32 v26, 5, v0
M v[160:163], a[164:167], a[36:39], v[160:163]
ds_read_b128 a[176:179], v10 offset:20480
ds_read_b128 a[180:183], v11 offset:20480
v_add_u32 v26, s3, v26
v_bfe_u32 v29, v0, 2, 3
v_bfe_u32 v27, v26, 1, 3
M v[164:167], a[164:167], a[44:47], v[164:167]
v_xor_b32 v27, v27, v29
v_lshlrev_b32 v27, 4, v27
v_and_b32 v30, 3, v0
M v[164:167], a[160:163], a[40:43], v[164:167]
ds_read_b64_tr_b16 a[132:133], v16 offset:49152
ds_read_b64_tr_b16 a[134:135], v16 offset:51200
v_lshl_add_u32 v27, v30, 2, v27
v_lshl_add_u32 v20, v26, 11, v27
v_add_u32 v26, 2, v26
M v[168:171], a[160:163], a[48:51], v[168:171]
v_bfe_u32 v27, v26, 1, 3
v_xor_b32 v27, v27, v29
M v[168:171], a[164:167], a[52:55], v[168:171]
v_lshlrev_b32 v27, 4, v27
v_and_b32 v30, 3, v0
v_lshl_add_u32 v27, v30, 2, v27
M v[172:175], a[164:167], a[60:63], v[172:175]
v_lshl_add_u32 v23, v26, 11, v27
v_subrev_u32 v23, 256, v23
s_mul_i32 s3, s20, 48
M v[172:175], a[160:163], a[56:59], v[172:175]
v_add_u32 v28, s3, v24
v_add_u32 v26, 0, v28
M v[176:179], a[160:163], a[64:67], v[176:179]
v_mul_u32_u24 v27, 0xaaab, v26
v_lshrrev_b32 v27, 17, v27
v_lshrrev_b32 v29, 1, v27
M v[176:179], a[164:167], a[68:71], v[176:179]
ds_read_b64_tr_b16 a[140:141], v17 offset:49152
ds_read_b64_tr_b16 a[142:143], v17 offset:51200
v_and_b32 v29, 4, v29
v_and_or_b32 v27, v27, 2, v29
v_xor_b32 v27, v27, v25
M v[180:183], a[164:167], a[76:79], v[180:183]
v_lshlrev_b32 v26, 11, v26
v_lshl_add_u32 v26, v27, 4, v26
v_subrev_u32 v6, 0, v26
M v[180:183], a[160:163], a[72:75], v[180:183]
v_add_u32 v26, 8, v28
v_mul_u32_u24 v27, 0xaaab, v26
M v[184:187], a[160:163], a[80:83], v[184:187]
v_lshrrev_b32 v27, 17, v27
v_lshrrev_b32 v29, 1, v27
v_and_b32 v29, 4, v29
M v[184:187], a[164:167], a[84:87], v[184:187]
v_and_or_b32 v27, v27, 2, v29
v_xor_b32 v27, v27, v25
v_lshlrev_b32 v26, 11, v26
M v[188:191], a[164:167], a[92:95], v[188:191]
v_lshl_add_u32 v26, v27, 4, v26
v_subrev_u32 v7, 1024, v26
M v[188:191], a[160:163], a[88:91], v[188:191]
s_waitcnt lgkmcnt(12)
ds_read_b64_tr_b16 a[148:149], v18 offset:49152
ds_read_b64_tr_b16 a[150:151], v18 offset:51200
v_add_u32 v26, 16, v28
v_mul_u32_u24 v27, 0xaaab, v26
v_lshrrev_b32 v27, 17, v27
M v[192:195], a[168:171], a[32:35], v[192:195]
v_lshrrev_b32 v29, 1, v27
v_and_b32 v29, 4, v29
v_and_or_b32 v27, v27, 2, v29
M v[192:195], a[172:175], a[36:39], v[192:195]
ds_read_b128 a[184:187], v10 offset:22528
ds_read_b128 a[188:191], v11 offset:22528
v_xor_b32 v27, v27, v25
v_lshlrev_b32 v26, 11, v26
M v[196:199], a[172:175], a[44:47], v[196:199]
v_lshl_add_u32 v26, v27, 4, v26
v_subrev_u32 v8, 2048, v26
v_add_u32 v26, 24, v28
M v[196:199], a[168:171], a[40:43], v[196:199]
v_mul_u32_u24 v27, 0xaaab, v26
v_lshrrev_b32 v27, 17, v27
v_lshrrev_b32 v29, 1, v27
M v[200:203], a[168:171], a[48:51], v[200:203]
v_and_b32 v29, 4, v29
v_and_or_b32 v27, v27, 2, v29
v_xor_b32 v27, v27, v25
M v[200:203], a[172:175], a[52:55], v[200:203]
ds_read_b64_tr_b16 a[156:157], v19 offset:49152
ds_read_b64_tr_b16 a[158:159], v19 offset:51200
v_lshlrev_b32 v26, 11, v26
v_lshl_add_u32 v26, v27, 4, v26
M v[204:207], a[172:175], a[60:63], v[204:207]
v_subrev_u32 v9, 3072, v26
v_add_u32 v26, 32, v28
v_mul_u32_u24 v27, 0xaaab, v26
M v[204:207], a[168:171], a[56:59], v[204:207]
v_lshrrev_b32 v27, 17, v27
v_lshrrev_b32 v29, 1, v27
v_and_b32 v29, 4, v29
M v[208:211], a[168:171], a[64:67], v[208:211]
v_and_or_b32 v27, v27, 2, v29
v_xor_b32 v27, v27, v25
M v[208:211], a[172:175], a[68:71], v[208:211]
v_lshlrev_b32 v26, 11, v26
v_lshl_add_u32 v26, v27, 4, v26
v_subrev_u32 v21, 0, v26
M v[212:215], a[172:175], a[76:79], v[212:215]
v_add_u32 v26, 40, v28
v_mul_u32_u24 v27, 0xaaab, v26
v_lshrrev_b32 v27, 17, v27
M v[212:215], a[168:171], a[72:75], v[212:215]
v_lshrrev_b32 v29, 1, v27
v_and_b32 v29, 4, v29
v_and_or_b32 v27, v27, 2, v29
M v[216:219], a[168:171], a[80:83], v[216:219]
v_xor_b32 v27, v27, v25
v_lshlrev_b32 v26, 11, v26
M v[216:219], a[172:175], a[84:87], v[216:219]
v_lshl_add_u32 v26, v27, 4, v26
v_subrev_u32 v22, 1024, v26
s_lshr_b32 s3, s53, 7
M v[220:223], a[172:175], a[92:95], v[220:223]
s_add_u32 s3, s3, s22
s_lshl_b32 s3, s3, 5
s_lshr_b32 s19, s52, 6
M v[220:223], a[168:171], a[88:91], v[220:223]
s_waitcnt lgkmcnt(10)
s_add_u32 s3, s3, s19
s_lshl_b32 s19, s21, 1
M v[224:227], a[176:179], a[32:35], v[224:227]
s_add_u32 s3, s3, s19
s_lshl_b32 s92, s3, 15
s_add_u32 s92, s92, 16384
M v[224:227], a[180:183], a[36:39], v[224:227]
s_add_u32 s93, s92, 32768
s_add_u32 s16, s50, 16777216
s_addc_u32 s17, s51, 0
M v[228:231], a[180:183], a[44:47], v[228:231]
s_mov_b32 s18, 33554432
s_mov_b32 s19, 0x00020000
M v[228:231], a[176:179], a[40:43], v[228:231]
M v[232:235], a[176:179], a[48:51], v[232:235]
M v[232:235], a[180:183], a[52:55], v[232:235]
M v[236:239], a[180:183], a[60:63], v[236:239]
M v[236:239], a[176:179], a[56:59], v[236:239]
s_waitcnt vmcnt(4) lgkmcnt(0)
s_barrier
ds_read_b128 a[160:163], v10 offset:32768
ds_read_b128 a[164:167], v11 offset:32768
M v[240:243], a[176:179], a[64:67], v[240:243]
s_add_u32 m0, s28, 131072
s_nop 0
buffer_load_dword v20, s[8:11], s24 offen lds
M v[240:243], a[180:183], a[68:71], v[240:243]
M v[244:247], a[180:183], a[76:79], v[244:247]
M v[244:247], a[176:179], a[72:75], v[244:247]
buffer_load_dword v23, s[8:11], s24 offen offset:256 lds
M v[248:251], a[176:179], a[80:83], v[248:251]
M v[248:251], a[180:183], a[84:87], v[248:251]
M v[252:255], a[180:183], a[92:95], v[252:255]
M v[252:255], a[176:179], a[88:91], v[252:255]
M a[0:3], a[184:187], a[32:35], a[0:3]
s_add_u32 m0, s29, 133120
s_nop 0
buffer_load_dwordx4 v2, s[8:11], s23 offen offset:0 lds
M a[0:3], a[188:191], a[36:39], a[0:3]
ds_read_b128 a[168:171], v10 offset:34816
ds_read_b128 a[172:175], v11 offset:34816
M a[4:7], a[188:191], a[44:47], a[4:7]
M a[4:7], a[184:187], a[40:43], a[4:7]
M a[8:11], a[184:187], a[48:51], a[8:11]
buffer_load_dwordx4 v3, s[8:11], s23 offen offset:1024 lds
M a[8:11], a[188:191], a[52:55], a[8:11]
M a[12:15], a[188:191], a[60:63], a[12:15]
M a[12:15], a[184:187], a[56:59], a[12:15]
M a[16:19], a[184:187], a[64:67], a[16:19]
buffer_load_dwordx4 v4, s[8:11], s23 offen offset:2048 lds
M a[16:19], a[188:191], a[68:71], a[16:19]
M a[20:23], a[188:191], a[76:79], a[20:23]
M a[20:23], a[184:187], a[72:75], a[20:23]
buffer_load_dwordx4 v5, s[8:11], s23 offen offset:3072 lds
M a[24:27], a[184:187], a[80:83], a[24:27]
M a[24:27], a[188:191], a[84:87], a[24:27]
M a[28:31], a[188:191], a[92:95], a[28:31]
M a[28:31], a[184:187], a[88:91], a[28:31]
s_waitcnt lgkmcnt(2)
M v[32:35], a[160:163], a[96:99], v[32:35]
s_sub_u32 s31, s31, 1
s_cmp_eq_u32 s31, 0
s_cselect_b32 s58, -1920, s57
s_add_u32 s23, s23, s58
s_add_u32 s24, s24, s58
M v[32:35], a[164:167], a[100:103], v[32:35]
ds_read_b128 a[176:179], v10 offset:36864
ds_read_b128 a[180:183], v11 offset:36864
M v[36:39], a[164:167], a[108:111], v[36:39]
M v[36:39], a[160:163], a[104:107], v[36:39]
M v[40:43], a[160:163], a[112:115], v[40:43]
M v[40:43], a[164:167], a[116:119], v[40:43]
s_add_u32 m0, s30, 65536
s_nop 0
buffer_load_dwordx4 v6, s[12:15], s25 offen offset:0 lds
M v[44:47], a[164:167], a[124:127], v[44:47]
M v[44:47], a[160:163], a[120:123], v[44:47]
M v[48:51], a[160:163], a[128:131], v[48:51]
M v[48:51], a[164:167], a[132:135], v[48:51]
buffer_load_dwordx4 v7, s[12:15], s25 offen offset:1024 lds
M v[52:55], a[164:167], a[140:143], v[52:55]
M v[52:55], a[160:163], a[136:139], v[52:55]
M v[56:59], a[160:163], a[144:147], v[56:59]
M v[56:59], a[164:167], a[148:151], v[56:59]
buffer_load_dwordx4 v8, s[12:15], s25 offen offset:2048 lds
M v[60:63], a[164:167], a[156:159], v[60:63]
M v[60:63], a[160:163], a[152:155], v[60:63]
s_waitcnt lgkmcnt(2)
M v[64:67], a[168:171], a[96:99], v[64:67]
M v[64:67], a[172:175], a[100:103], v[64:67]
ds_read_b128 a[184:187], v10 offset:38912
ds_read_b128 a[188:191], v11 offset:38912
M v[68:71], a[172:175], a[108:111], v[68:71]
M v[68:71], a[168:171], a[104:107], v[68:71]
buffer_load_dwordx4 v9, s[12:15], s25 offen offset:3072 lds
M v[72:75], a[168:171], a[112:115], v[72:75]
M v[72:75], a[172:175], a[116:119], v[72:75]
M v[76:79], a[172:175], a[124:127], v[76:79]
M v[76:79], a[168:171], a[120:123], v[76:79]
s_add_u32 m0, s30, 69632
s_nop 0
buffer_load_dwordx4 v21, s[12:15], s25 offen offset:0 lds
M v[80:83], a[168:171], a[128:131], v[80:83]
M v[80:83], a[172:175], a[132:135], v[80:83]
M v[84:87], a[172:175], a[140:143], v[84:87]
M v[84:87], a[168:171], a[136:139], v[84:87]
buffer_load_dwordx4 v22, s[12:15], s25 offen offset:1024 lds
M v[88:91], a[168:171], a[144:147], v[88:91]
M v[88:91], a[172:175], a[148:151], v[88:91]
M v[92:95], a[172:175], a[156:159], v[92:95]
M v[92:95], a[168:171], a[152:155], v[92:95]
s_waitcnt lgkmcnt(2)
M v[96:99], a[176:179], a[96:99], v[96:99]
s_sub_u32 s54, s54, 1
s_cmp_eq_u32 s54, 0
s_cselect_b32 s58, s55, s56
s_add_u32 s25, s25, s58
M v[96:99], a[180:183], a[100:103], v[96:99]
M v[100:103], a[180:183], a[108:111], v[100:103]
M v[100:103], a[176:179], a[104:107], v[100:103]
v_cvt_pk_bf16_f32 v32, v32, v33
v_cvt_pk_bf16_f32 v33, v34, v35
M v[104:107], a[176:179], a[112:115], v[104:107]
v_cvt_pk_bf16_f32 v34, v64, v65
v_cvt_pk_bf16_f32 v35, v66, v67
M v[104:107], a[180:183], a[116:119], v[104:107]
v_cvt_pk_bf16_f32 v64, v48, v49
M v[108:111], a[180:183], a[124:127], v[108:111]
v_cvt_pk_bf16_f32 v65, v50, v51
v_cvt_pk_bf16_f32 v66, v80, v81
M v[108:111], a[176:179], a[120:123], v[108:111]
s_waitcnt vmcnt(12) lgkmcnt(0)
s_barrier
ds_read_b128 a[160:163], v10 offset:49152
ds_read_b128 a[164:167], v11 offset:49152
v_cvt_pk_bf16_f32 v67, v82, v83
M v[112:115], a[176:179], a[128:131], v[112:115]
s_add_u32 m0, s28, 0
s_nop 0
buffer_load_dword v20, s[8:11], s24 offen lds
v_cvt_pk_bf16_f32 v48, v40, v41
v_cvt_pk_bf16_f32 v49, v42, v43
M v[112:115], a[180:183], a[132:135], v[112:115]
v_cvt_pk_bf16_f32 v50, v72, v73
v_cvt_pk_bf16_f32 v51, v74, v75
M v[116:119], a[180:183], a[140:143], v[116:119]
v_cvt_pk_bf16_f32 v80, v56, v57
M v[116:119], a[176:179], a[136:139], v[116:119]
buffer_load_dword v23, s[8:11], s24 offen offset:256 lds
v_cvt_pk_bf16_f32 v81, v58, v59
v_cvt_pk_bf16_f32 v82, v88, v89
M v[120:123], a[176:179], a[144:147], v[120:123]
v_cvt_pk_bf16_f32 v83, v90, v91
M v[120:123], a[180:183], a[148:151], v[120:123]
v_cvt_pk_bf16_f32 v40, v36, v37
v_cvt_pk_bf16_f32 v41, v38, v39
M v[124:127], a[180:183], a[156:159], v[124:127]
s_add_u32 m0, s29, 2048
s_nop 0
buffer_load_dwordx4 v2, s[8:11], s23 offen offset:0 lds
v_cvt_pk_bf16_f32 v42, v68, v69
v_cvt_pk_bf16_f32 v43, v70, v71
M v[124:127], a[176:179], a[152:155], v[124:127]
v_cvt_pk_bf16_f32 v72, v52, v53
M v[128:131], a[184:187], a[96:99], v[128:131]
v_cvt_pk_bf16_f32 v73, v54, v55
v_cvt_pk_bf16_f32 v74, v84, v85
M v[128:131], a[188:191], a[100:103], v[128:131]
ds_read_b128 a[168:171], v10 offset:51200
ds_read_b128 a[172:175], v11 offset:51200
v_cvt_pk_bf16_f32 v75, v86, v87
M v[132:135], a[188:191], a[108:111], v[132:135]
v_cvt_pk_bf16_f32 v56, v44, v45
v_cvt_pk_bf16_f32 v57, v46, v47
M v[132:135], a[184:187], a[104:107], v[132:135]
buffer_load_dwordx4 v3, s[8:11], s23 offen offset:1024 lds
v_cvt_pk_bf16_f32 v58, v76, v77
v_cvt_pk_bf16_f32 v59, v78, v79
M v[136:139], a[184:187], a[112:115], v[136:139]
v_cvt_pk_bf16_f32 v88, v60, v61
M v[136:139], a[188:191], a[116:119], v[136:139]
v_cvt_pk_bf16_f32 v89, v62, v63
v_cvt_pk_bf16_f32 v90, v92, v93
M v[140:143], a[188:191], a[124:127], v[140:143]
buffer_load_dwordx4 v4, s[8:11], s23 offen offset:2048 lds
v_cvt_pk_bf16_f32 v91, v94, v95
M v[140:143], a[184:187], a[120:123], v[140:143]
M v[144:147], a[184:187], a[128:131], v[144:147]
M v[144:147], a[188:191], a[132:135], v[144:147]
buffer_load_dwordx4 v5, s[8:11], s23 offen offset:3072 lds
M v[148:151], a[188:191], a[140:143], v[148:151]
s_add_u32 s94, s92, 0
buffer_store_dwordx4 v[32:35], v1, s[16:19], s94 offen offset:0 sc1
M v[148:151], a[184:187], a[136:139], v[148:151]
M v[152:155], a[184:187], a[144:147], v[152:155]
M v[152:155], a[188:191], a[148:151], v[152:155]
s_sub_u32 s31, s31, 1
s_cmp_eq_u32 s31, 0
s_cselect_b32 s58, -1920, s57
s_add_u32 s23, s23, s58
s_add_u32 s24, s24, s58
M v[156:159], a[188:191], a[156:159], v[156:159]
s_add_u32 s94, s92, 0
buffer_store_dwordx4 v[40:43], v1, s[16:19], s94 offen offset:1024 sc1
M v[156:159], a[184:187], a[152:155], v[156:159]
s_waitcnt lgkmcnt(2)
M v[160:163], a[160:163], a[96:99], v[160:163]
M v[160:163], a[164:167], a[100:103], v[160:163]
ds_read_b128 a[176:179], v10 offset:53248
ds_read_b128 a[180:183], v11 offset:53248
M v[164:167], a[164:167], a[108:111], v[164:167]
s_add_u32 s94, s92, 0
buffer_store_dwordx4 v[48:51], v1, s[16:19], s94 offen offset:2048 sc1
M v[164:167], a[160:163], a[104:107], v[164:167]
v_cvt_pk_bf16_f32 v96, v96, v97
v_cvt_pk_bf16_f32 v97, v98, v99
M v[168:171], a[160:163], a[112:115], v[168:171]
v_cvt_pk_bf16_f32 v98, v128, v129
v_cvt_pk_bf16_f32 v99, v130, v131
M v[168:171], a[164:167], a[116:119], v[168:171]
s_add_u32 m0, s30, 98304
s_nop 0
buffer_load_dwordx4 v6, s[12:15], s25 offen offset:0 lds
v_cvt_pk_bf16_f32 v128, v112, v113
M v[172:175], a[164:167], a[124:127], v[172:175]
s_add_u32 s94, s92, 0
buffer_store_dwordx4 v[56:59], v1, s[16:19], s94 offen offset:3072 sc1
v_cvt_pk_bf16_f32 v129, v114, v115
v_cvt_pk_bf16_f32 v130, v144, v145
M v[172:175], a[160:163], a[120:123], v[172:175]
v_cvt_pk_bf16_f32 v131, v146, v147
M v[176:179], a[160:163], a[128:131], v[176:179]
v_cvt_pk_bf16_f32 v112, v104, v105
v_cvt_pk_bf16_f32 v113, v106, v107
M v[176:179], a[164:167], a[132:135], v[176:179]
buffer_load_dwordx4 v7, s[12:15], s25 offen offset:1024 lds
v_cvt_pk_bf16_f32 v114, v136, v137
v_cvt_pk_bf16_f32 v115, v138, v139
M v[180:183], a[164:167], a[140:143], v[180:183]
s_add_u32 s94, s92, 4096
buffer_store_dwordx4 v[64:67], v1, s[16:19], s94 offen offset:0 sc1
v_cvt_pk_bf16_f32 v144, v120, v121
M v[180:183], a[160:163], a[136:139], v[180:183]
v_cvt_pk_bf16_f32 v145, v122, v123
v_cvt_pk_bf16_f32 v146, v152, v153
M v[184:187], a[160:163], a[144:147], v[184:187]
v_cvt_pk_bf16_f32 v147, v154, v155
M v[184:187], a[164:167], a[148:151], v[184:187]
buffer_load_dwordx4 v8, s[12:15], s25 offen offset:2048 lds
v_cvt_pk_bf16_f32 v104, v100, v101
v_cvt_pk_bf16_f32 v105, v102, v103
M v[188:191], a[164:167], a[156:159], v[188:191]
s_add_u32 s94, s92, 4096
buffer_store_dwordx4 v[72:75], v1, s[16:19], s94 offen offset:1024 sc1
v_cvt_pk_bf16_f32 v106, v132, v133
v_cvt_pk_bf16_f32 v107, v134, v135
M v[188:191], a[160:163], a[152:155], v[188:191]
s_waitcnt lgkmcnt(2)
v_cvt_pk_bf16_f32 v136, v116, v117
M v[192:195], a[168:171], a[96:99], v[192:195]
v_cvt_pk_bf16_f32 v137, v118, v119
v_cvt_pk_bf16_f32 v138, v148, v149
M v[192:195], a[172:175], a[100:103], v[192:195]
ds_read_b128 a[184:187], v10 offset:55296
ds_read_b128 a[188:191], v11 offset:55296
v_cvt_pk_bf16_f32 v139, v150, v151
M v[196:199], a[172:175], a[108:111], v[196:199]
s_add_u32 s94, s92, 4096
buffer_store_dwordx4 v[80:83], v1, s[16:19], s94 offen offset:2048 sc1
v_cvt_pk_bf16_f32 v120, v108, v109
v_cvt_pk_bf16_f32 v121, v110, v111
M v[196:199], a[168:171], a[104:107], v[196:199]
v_cvt_pk_bf16_f32 v122, v140, v141
v_cvt_pk_bf16_f32 v123, v142, v143
M v[200:203], a[168:171], a[112:115], v[200:203]
buffer_load_dwordx4 v9, s[12:15], s25 offen offset:3072 lds
v_cvt_pk_bf16_f32 v152, v124, v125
M v[200:203], a[172:175], a[116:119], v[200:203]
v_cvt_pk_bf16_f32 v153, v126, v127
v_cvt_pk_bf16_f32 v154, v156, v157
M v[204:207], a[172:175], a[124:127], v[204:207]
s_add_u32 s94, s92, 4096
buffer_store_dwordx4 v[88:91], v1, s[16:19], s94 offen offset:3072 sc1
v_cvt_pk_bf16_f32 v155, v158, v159
M v[204:207], a[168:171], a[120:123], v[204:207]
M v[208:211], a[168:171], a[128:131], v[208:211]
s_add_u32 m0, s30, 102400
s_nop 0
buffer_load_dwordx4 v21, s[12:15], s25 offen offset:0 lds
M v[208:211], a[172:175], a[132:135], v[208:211]
M v[212:215], a[172:175], a[140:143], v[212:215]
M v[212:215], a[168:171], a[136:139], v[212:215]
buffer_load_dwordx4 v22, s[12:15], s25 offen offset:1024 lds
M v[216:219], a[168:171], a[144:147], v[216:219]
s_add_u32 s94, s92, 8192
buffer_store_dwordx4 v[96:99], v1, s[16:19], s94 offen offset:0 sc1
M v[216:219], a[172:175], a[148:151], v[216:219]
M v[220:223], a[172:175], a[156:159], v[220:223]
M v[220:223], a[168:171], a[152:155], v[220:223]
s_waitcnt lgkmcnt(2)
M v[224:227], a[176:179], a[96:99], v[224:227]
s_sub_u32 s54, s54, 1
s_cmp_eq_u32 s54, 0
s_cselect_b32 s58, s55, s56
s_add_u32 s25, s25, s58
M v[224:227], a[180:183], a[100:103], v[224:227]
M v[228:231], a[180:183], a[108:111], v[228:231]
s_add_u32 s94, s92, 8192
buffer_store_dwordx4 v[104:107], v1, s[16:19], s94 offen offset:1024 sc1
M v[228:231], a[176:179], a[104:107], v[228:231]
v_cvt_pk_bf16_f32 v160, v160, v161
v_cvt_pk_bf16_f32 v161, v162, v163
M v[232:235], a[176:179], a[112:115], v[232:235]
v_cvt_pk_bf16_f32 v162, v192, v193
v_cvt_pk_bf16_f32 v163, v194, v195
M v[232:235], a[180:183], a[116:119], v[232:235]
v_cvt_pk_bf16_f32 v192, v176, v177
M v[236:239], a[180:183], a[124:127], v[236:239]
v_cvt_pk_bf16_f32 v193, v178, v179
v_cvt_pk_bf16_f32 v194, v208, v209
M v[236:239], a[176:179], a[120:123], v[236:239]
s_waitcnt vmcnt(63) lgkmcnt(0)
s_barrier
v_cvt_pk_bf16_f32 v195, v210, v211
M v[240:243], a[176:179], a[128:131], v[240:243]
s_add_u32 s94, s92, 8192
buffer_store_dwordx4 v[112:115], v1, s[16:19], s94 offen offset:2048 sc1
v_cvt_pk_bf16_f32 v176, v168, v169
v_cvt_pk_bf16_f32 v177, v170, v171
M v[240:243], a[180:183], a[132:135], v[240:243]
s_add_u32 m0, s28, 18432
s_nop 0
buffer_load_dword v20, s[8:11], s24 offen lds
v_cvt_pk_bf16_f32 v178, v200, v201
v_cvt_pk_bf16_f32 v179, v202, v203
M v[244:247], a[180:183], a[140:143], v[244:247]
v_cvt_pk_bf16_f32 v208, v184, v185
M v[244:247], a[176:179], a[136:139], v[244:247]
v_cvt_pk_bf16_f32 v209, v186, v187
v_cvt_pk_bf16_f32 v210, v216, v217
M v[248:251], a[176:179], a[144:147], v[248:251]
buffer_load_dword v23, s[8:11], s24 offen offset:256 lds
v_cvt_pk_bf16_f32 v211, v218, v219
M v[248:251], a[180:183], a[148:151], v[248:251]
v_cvt_pk_bf16_f32 v168, v164, v165
v_cvt_pk_bf16_f32 v169, v166, v167
M v[252:255], a[180:183], a[156:159], v[252:255]
s_add_u32 s94, s92, 8192
buffer_store_dwordx4 v[120:123], v1, s[16:19], s94 offen offset:3072 sc1
v_cvt_pk_bf16_f32 v170, v196, v197
v_cvt_pk_bf16_f32 v171, v198, v199
M v[252:255], a[176:179], a[152:155], v[252:255]
v_cvt_pk_bf16_f32 v200, v180, v181
M a[0:3], a[184:187], a[96:99], a[0:3]
v_cvt_pk_bf16_f32 v201, v182, v183
v_cvt_pk_bf16_f32 v202, v212, v213
M a[0:3], a[188:191], a[100:103], a[0:3]
s_add_u32 m0, s29, 20480
s_nop 0
buffer_load_dwordx4 v2, s[8:11], s23 offen offset:0 lds
v_cvt_pk_bf16_f32 v203, v214, v215
M a[4:7], a[188:191], a[108:111], a[4:7]
v_cvt_pk_bf16_f32 v184, v172, v173
v_cvt_pk_bf16_f32 v185, v174, v175
M a[4:7], a[184:187], a[104:107], a[4:7]
v_cvt_pk_bf16_f32 v186, v204, v205
v_cvt_pk_bf16_f32 v187, v206, v207
M a[8:11], a[184:187], a[112:115], a[8:11]
s_add_u32 s94, s92, 12288
buffer_store_dwordx4 v[128:131], v1, s[16:19], s94 offen offset:0 sc1
v_cvt_pk_bf16_f32 v216, v188, v189
M a[8:11], a[188:191], a[116:119], a[8:11]
buffer_load_dwordx4 v3, s[8:11], s23 offen offset:1024 lds
v_cvt_pk_bf16_f32 v217, v190, v191
v_cvt_pk_bf16_f32 v218, v220, v221
M a[12:15], a[188:191], a[124:127], a[12:15]
v_cvt_pk_bf16_f32 v219, v222, v223
M a[12:15], a[184:187], a[120:123], a[12:15]
M a[16:19], a[184:187], a[128:131], a[16:19]
buffer_load_dwordx4 v4, s[8:11], s23 offen offset:2048 lds
M a[16:19], a[188:191], a[132:135], a[16:19]
M a[20:23], a[188:191], a[140:143], a[20:23]
s_add_u32 s94, s92, 12288
buffer_store_dwordx4 v[136:139], v1, s[16:19], s94 offen offset:1024 sc1
M a[20:23], a[184:187], a[136:139], a[20:23]
M a[24:27], a[184:187], a[144:147], a[24:27]
buffer_load_dwordx4 v5, s[8:11], s23 offen offset:3072 lds
M a[24:27], a[188:191], a[148:151], a[24:27]
M a[28:31], a[188:191], a[156:159], a[28:31]
M a[28:31], a[184:187], a[152:155], a[28:31]
v_accvgpr_read_b32 v24, a0
v_accvgpr_read_b32 v25, a1
v_accvgpr_read_b32 v26, a2
v_accvgpr_read_b32 v27, a3
v_cvt_pk_bf16_f32 v224, v224, v225
v_cvt_pk_bf16_f32 v225, v226, v227
v_cvt_pk_bf16_f32 v226, v24, v25
v_cvt_pk_bf16_f32 v227, v26, v27
v_accvgpr_read_b32 v24, a16
v_accvgpr_read_b32 v25, a17
v_accvgpr_read_b32 v26, a18
v_accvgpr_read_b32 v27, a19
v_cvt_pk_bf16_f32 v36, v240, v241
v_cvt_pk_bf16_f32 v37, v242, v243
v_cvt_pk_bf16_f32 v38, v24, v25
v_cvt_pk_bf16_f32 v39, v26, v27
v_accvgpr_read_b32 v24, a24
v_accvgpr_read_b32 v25, a25
v_accvgpr_read_b32 v26, a26
v_accvgpr_read_b32 v27, a27
v_cvt_pk_bf16_f32 v52, v248, v249
v_cvt_pk_bf16_f32 v53, v250, v251
v_cvt_pk_bf16_f32 v54, v24, v25
v_cvt_pk_bf16_f32 v55, v26, v27
v_accvgpr_read_b32 v24, a8
v_accvgpr_read_b32 v25, a9
v_accvgpr_read_b32 v26, a10
v_accvgpr_read_b32 v27, a11
v_cvt_pk_bf16_f32 v240, v232, v233
v_cvt_pk_bf16_f32 v241, v234, v235
v_cvt_pk_bf16_f32 v242, v24, v25
v_cvt_pk_bf16_f32 v243, v26, v27
v_accvgpr_read_b32 v28, a4
v_accvgpr_read_b32 v29, a5
v_accvgpr_read_b32 v30, a6
v_accvgpr_read_b32 v31, a7
v_cvt_pk_bf16_f32 v232, v228, v229
v_cvt_pk_bf16_f32 v233, v230, v231
v_cvt_pk_bf16_f32 v234, v28, v29
v_cvt_pk_bf16_f32 v235, v30, v31
v_accvgpr_read_b32 v28, a12
v_accvgpr_read_b32 v29, a13
v_accvgpr_read_b32 v30, a14
v_accvgpr_read_b32 v31, a15
v_cvt_pk_bf16_f32 v248, v236, v237
v_cvt_pk_bf16_f32 v249, v238, v239
v_cvt_pk_bf16_f32 v250, v28, v29
v_cvt_pk_bf16_f32 v251, v30, v31
v_accvgpr_read_b32 v28, a20
v_accvgpr_read_b32 v29, a21
v_accvgpr_read_b32 v30, a22
v_accvgpr_read_b32 v31, a23
v_cvt_pk_bf16_f32 v44, v244, v245
v_cvt_pk_bf16_f32 v45, v246, v247
v_cvt_pk_bf16_f32 v46, v28, v29
v_cvt_pk_bf16_f32 v47, v30, v31
v_accvgpr_read_b32 v28, a28
v_accvgpr_read_b32 v29, a29
v_accvgpr_read_b32 v30, a30
v_accvgpr_read_b32 v31, a31
v_cvt_pk_bf16_f32 v60, v252, v253
v_cvt_pk_bf16_f32 v61, v254, v255
v_cvt_pk_bf16_f32 v62, v28, v29
v_cvt_pk_bf16_f32 v63, v30, v31
Lk1_b:
v_and_b32 v24, 15, v0
v_lshlrev_b32 v24, 7, v24
v_bfe_u32 v25, v0, 1, 3
v_lshrrev_b32 v26, 4, v0
v_xor_b32 v25, v25, v26
v_lshl_add_u32 v10, v25, 4, v24
v_xor_b32 v11, 64, v10
v_add_u32 v12, 131072, v10
v_add_u32 v13, 131072, v11
v_bfe_u32 v24, v0, 2, 2
v_lshl_add_u32 v29, v26, 3, v24
v_mul_u32_u24 v25, 384, v29
v_and_b32 v27, 1, v0
v_lshl_add_u32 v25, v27, 3, v25
v_add_u32 v25, 36864, v25
v_lshrrev_b32 v24, 1, v29
v_and_b32 v24, 4, v24
v_and_or_b32 v24, v29, 2, v24
v_bfe_u32 v26, v0, 1, 1
s_mul_i32 s4, s20, 3
s_add_u32 s3, s4, 0
s_and_b32 s5, s3, 3
s_lshl_b32 s5, s5, 1
s_lshr_b32 s3, s3, 2
s_lshl_b32 s3, s3, 7
v_add_u32 v27, s5, v26
v_xor_b32 v27, v27, v24
v_lshl_add_u32 v27, v27, 4, v25
v_add_u32 v14, s3, v27
v_add_u32 v17, 61440, v14
s_add_u32 s3, s4, 1
s_and_b32 s5, s3, 3
s_lshl_b32 s5, s5, 1
s_lshr_b32 s3, s3, 2
s_lshl_b32 s3, s3, 7
v_add_u32 v27, s5, v26
v_xor_b32 v27, v27, v24
v_lshl_add_u32 v27, v27, 4, v25
v_add_u32 v15, s3, v27
v_add_u32 v18, 61440, v15
s_add_u32 s3, s4, 2
s_and_b32 s5, s3, 3
s_lshl_b32 s5, s5, 1
s_lshr_b32 s3, s3, 2
s_lshl_b32 s3, s3, 7
v_add_u32 v27, s5, v26
v_xor_b32 v27, v27, v24
v_lshl_add_u32 v27, v27, 4, v25
v_add_u32 v16, s3, v27
v_add_u32 v19, 61440, v16
s_waitcnt vmcnt(6)
s_barrier
ds_read_b64_tr_b16 a[176:177], v14 offset:28672
ds_read_b64_tr_b16 a[178:179], v14 offset:30208
ds_read_b64_tr_b16 a[184:185], v15 offset:28672
ds_read_b64_tr_b16 a[186:187], v15 offset:30208
ds_read_b64_tr_b16 a[192:193], v16 offset:28672
ds_read_b64_tr_b16 a[194:195], v16 offset:30208
ds_read_b64_tr_b16 a[180:181], v14 offset:40960
ds_read_b64_tr_b16 a[182:183], v14 offset:42496
ds_read_b64_tr_b16 a[188:189], v15 offset:40960
ds_read_b64_tr_b16 a[190:191], v15 offset:42496
ds_read_b64_tr_b16 a[196:197], v16 offset:40960
ds_read_b64_tr_b16 a[198:199], v16 offset:42496
ds_read_b128 a[224:227], v12 offset:0
ds_read_b128 a[228:231], v13 offset:0
ds_read_b128 a[232:235], v12 offset:2048
ds_read_b128 a[236:239], v13 offset:2048
ds_read_b128 a[240:243], v12 offset:4096
ds_read_b128 a[244:247], v13 offset:4096
s_waitcnt lgkmcnt(0)
s_barrier
M a[68:71], a[176:179], a[224:227], 0
ds_read_b128 a[248:251], v12 offset:6144
ds_read_b128 a[252:255], v13 offset:6144
M a[68:71], a[180:183], a[228:231], a[68:71]
s_sub_u32 s31, s31, 1
s_cmp_eq_u32 s31, 0
s_cselect_b32 s58, -1920, s57
s_add_u32 s23, s23, s58
s_add_u32 s24, s24, s58
M a[72:75], a[188:191], a[228:231], 0
ds_read_b64_tr_b16 a[200:201], v17 offset:0
ds_read_b64_tr_b16 a[202:203], v17 offset:1536
M a[72:75], a[184:187], a[224:227], a[72:75]
s_add_u32 m0, s30, 36864
s_nop 0
buffer_load_dwordx4 v6, s[12:15], s25 offen offset:0 lds
M a[76:79], a[192:195], a[224:227], 0
M a[76:79], a[196:199], a[228:231], a[76:79]
buffer_load_dwordx4 v7, s[12:15], s25 offen offset:1024 lds
M a[80:83], a[180:183], a[236:239], 0
ds_read_b128 a[224:227], v12 offset:8192
ds_read_b128 a[228:231], v13 offset:8192
M a[80:83], a[176:179], a[232:235], a[80:83]
M a[84:87], a[184:187], a[232:235], 0
ds_read_b64_tr_b16 a[208:209], v18 offset:0
ds_read_b64_tr_b16 a[210:211], v18 offset:1536
M a[84:87], a[188:191], a[236:239], a[84:87]
buffer_load_dwordx4 v8, s[12:15], s25 offen offset:2048 lds
M a[88:91], a[196:199], a[236:239], 0
M a[88:91], a[192:195], a[232:235], a[88:91]
buffer_load_dwordx4 v9, s[12:15], s25 offen offset:3072 lds
M a[92:95], a[176:179], a[240:243], 0
ds_read_b128 a[232:235], v12 offset:10240
ds_read_b128 a[236:239], v13 offset:10240
M a[92:95], a[180:183], a[244:247], a[92:95]
M a[96:99], a[188:191], a[244:247], 0
ds_read_b64_tr_b16 a[216:217], v19 offset:0
ds_read_b64_tr_b16 a[218:219], v19 offset:1536
M a[96:99], a[184:187], a[240:243], a[96:99]
s_add_u32 m0, s30, 40960
s_nop 0
buffer_load_dwordx4 v21, s[12:15], s25 offen offset:0 lds
M a[100:103], a[192:195], a[240:243], 0
buffer_load_dwordx4 v22, s[12:15], s25 offen offset:1024 lds
M a[100:103], a[196:199], a[244:247], a[100:103]
s_waitcnt lgkmcnt(10)
M a[104:107], a[180:183], a[252:255], 0
ds_read_b128 a[240:243], v12 offset:12288
ds_read_b128 a[244:247], v13 offset:12288
M a[104:107], a[176:179], a[248:251], a[104:107]
s_sub_u32 s54, s54, 1
s_cmp_eq_u32 s54, 0
s_cselect_b32 s58, s55, s56
s_add_u32 s25, s25, s58
M a[108:111], a[184:187], a[248:251], 0
ds_read_b64_tr_b16 a[204:205], v17 offset:12288
ds_read_b64_tr_b16 a[206:207], v17 offset:13824
M a[108:111], a[188:191], a[252:255], a[108:111]
M a[112:115], a[196:199], a[252:255], 0
s_add_u32 m0, s30, 65536
s_nop 0
buffer_load_dwordx4 v6, s[12:15], s25 offen offset:0 lds
M a[112:115], a[192:195], a[248:251], a[112:115]
s_waitcnt lgkmcnt(10)
M a[116:119], a[176:179], a[224:227], 0
ds_read_b128 a[248:251], v12 offset:14336
ds_read_b128 a[252:255], v13 offset:14336
M a[116:119], a[180:183], a[228:231], a[116:119]
buffer_load_dwordx4 v7, s[12:15], s25 offen offset:1024 lds
M a[120:123], a[188:191], a[228:231], 0
ds_read_b64_tr_b16 a[212:213], v18 offset:12288
ds_read_b64_tr_b16 a[214:215], v18 offset:13824
M a[120:123], a[184:187], a[224:227], a[120:123]
M a[124:127], a[192:195], a[224:227], 0
buffer_load_dwordx4 v8, s[12:15], s25 offen offset:2048 lds
M a[124:127], a[196:199], a[228:231], a[124:127]
buffer_load_dwordx4 v9, s[12:15], s25 offen offset:3072 lds
s_waitcnt lgkmcnt(10)
M a[128:131], a[180:183], a[236:239], 0
ds_read_b128 a[224:227], v12 offset:16384
ds_read_b128 a[228:231], v13 offset:16384
M a[128:131], a[176:179], a[232:235], a[128:131]
M a[132:135], a[184:187], a[232:235], 0
ds_read_b64_tr_b16 a[220:221], v19 offset:12288
ds_read_b64_tr_b16 a[222:223], v19 offset:13824
M a[132:135], a[188:191], a[236:239], a[132:135]
s_add_u32 m0, s30, 69632
s_nop 0
buffer_load_dwordx4 v21, s[12:15], s25 offen offset:0 lds
M a[136:139], a[196:199], a[236:239], 0
M a[136:139], a[192:195], a[232:235], a[136:139]
buffer_load_dwordx4 v22, s[12:15], s25 offen offset:1024 lds
s_waitcnt lgkmcnt(10)
M a[140:143], a[176:179], a[240:243], 0
M a[140:143], a[180:183], a[244:247], a[140:143]
s_sub_u32 s54, s54, 1
s_cmp_eq_u32 s54, 0
s_cselect_b32 s58, s55, s56
s_add_u32 s25, s25, s58
M a[144:147], a[188:191], a[244:247], 0
M a[144:147], a[184:187], a[240:243], a[144:147]
M a[148:151], a[192:195], a[240:243], 0
s_waitcnt vmcnt(6) lgkmcnt(0)
s_barrier
ds_read_b128 a[232:235], v10 offset:0
ds_read_b128 a[236:239], v11 offset:0
M a[148:151], a[196:199], a[244:247], a[148:151]
s_add_u32 m0, s28, 131072
s_nop 0
buffer_load_dword v20, s[8:11], s24 offen lds
M a[152:155], a[180:183], a[252:255], 0
ds_read_b128 a[240:243], v10 offset:2048
ds_read_b128 a[244:247], v11 offset:2048
M a[152:155], a[176:179], a[248:251], a[152:155]
M a[156:159], a[184:187], a[248:251], 0
buffer_load_dword v23, s[8:11], s24 offen offset:256 lds
M a[156:159], a[188:191], a[252:255], a[156:159]
M a[160:163], a[196:199], a[252:255], 0
M a[160:163], a[192:195], a[248:251], a[160:163]
s_add_u32 m0, s29, 133120
s_nop 0
buffer_load_dwordx4 v2, s[8:11], s23 offen offset:0 lds
M a[164:167], a[176:179], a[224:227], 0
ds_read_b128 a[248:251], v10 offset:4096
ds_read_b128 a[252:255], v11 offset:4096
M a[164:167], a[180:183], a[228:231], a[164:167]
M a[168:171], a[188:191], a[228:231], 0
M a[168:171], a[184:187], a[224:227], a[168:171]
buffer_load_dwordx4 v3, s[8:11], s23 offen offset:1024 lds
M a[172:175], a[192:195], a[224:227], 0
M a[172:175], a[196:199], a[228:231], a[172:175]
s_waitcnt lgkmcnt(4)
M a[68:71], a[200:203], a[232:235], a[68:71]
ds_read_b128 a[224:227], v10 offset:6144
ds_read_b128 a[228:231], v11 offset:6144
M a[68:71], a[204:207], a[236:239], a[68:71]
buffer_load_dwordx4 v4, s[8:11], s23 offen offset:2048 lds
M a[72:75], a[212:215], a[236:239], a[72:75]
ds_read_b64_tr_b16 a[176:177], v14 offset:0
ds_read_b64_tr_b16 a[178:179], v14 offset:1536
M a[72:75], a[208:211], a[232:235], a[72:75]
buffer_load_dwordx4 v5, s[8:11], s23 offen offset:3072 lds
M a[76:79], a[216:219], a[232:235], a[76:79]
M a[76:79], a[220:223], a[236:239], a[76:79]
s_sub_u32 s31, s31, 1
s_cmp_eq_u32 s31, 0
s_cselect_b32 s58, -1920, s57
s_add_u32 s23, s23, s58
s_add_u32 s24, s24, s58
s_waitcnt lgkmcnt(6)
M a[80:83], a[204:207], a[244:247], a[80:83]
ds_read_b128 a[232:235], v10 offset:8192
ds_read_b128 a[236:239], v11 offset:8192
M a[80:83], a[200:203], a[240:243], a[80:83]
M a[84:87], a[208:211], a[240:243], a[84:87]
ds_read_b64_tr_b16 a[184:185], v15 offset:0
ds_read_b64_tr_b16 a[186:187], v15 offset:1536
M a[84:87], a[212:215], a[244:247], a[84:87]
s_add_u32 m0, s30, 98304
s_nop 0
buffer_load_dwordx4 v6, s[12:15], s25 offen offset:0 lds
M a[88:91], a[220:223], a[244:247], a[88:91]
M a[88:91], a[216:219], a[240:243], a[88:91]
buffer_load_dwordx4 v7, s[12:15], s25 offen offset:1024 lds
s_waitcnt lgkmcnt(8)
M a[92:95], a[200:203], a[248:251], a[92:95]
ds_read_b128 a[240:243], v10 offset:10240
ds_read_b128 a[244:247], v11 offset:10240
M a[92:95], a[204:207], a[252:255], a[92:95]
M a[96:99], a[212:215], a[252:255], a[96:99]
ds_read_b64_tr_b16 a[192:193], v16 offset:0
ds_read_b64_tr_b16 a[194:195], v16 offset:1536
M a[96:99], a[208:211], a[248:251], a[96:99]
buffer_load_dwordx4 v8, s[12:15], s25 offen offset:2048 lds
M a[100:103], a[216:219], a[248:251], a[100:103]
M a[100:103], a[220:223], a[252:255], a[100:103]
buffer_load_dwordx4 v9, s[12:15], s25 offen offset:3072 lds
s_waitcnt lgkmcnt(10)
M a[104:107], a[204:207], a[228:231], a[104:107]
ds_read_b128 a[248:251], v10 offset:12288
ds_read_b128 a[252:255], v11 offset:12288
M a[104:107], a[200:203], a[224:227], a[104:107]
M a[108:111], a[208:211], a[224:227], a[108:111]
ds_read_b64_tr_b16 a[180:181], v14 offset:12288
ds_read_b64_tr_b16 a[182:183], v14 offset:13824
M a[108:111], a[212:215], a[228:231], a[108:111]
s_add_u32 m0, s30, 102400
s_nop 0
buffer_load_dwordx4 v21, s[12:15], s25 offen offset:0 lds
M a[112:115], a[220:223], a[228:231], a[112:115]
M a[112:115], a[216:219], a[224:227], a[112:115]
buffer_load_dwordx4 v22, s[12:15], s25 offen offset:1024 lds
s_waitcnt lgkmcnt(10)
M a[116:119], a[200:203], a[232:235], a[116:119]
ds_read_b128 a[224:227], v10 offset:14336
ds_read_b128 a[228:231], v11 offset:14336
M a[116:119], a[204:207], a[236:239], a[116:119]
M a[120:123], a[212:215], a[236:239], a[120:123]
ds_read_b64_tr_b16 a[188:189], v15 offset:12288
ds_read_b64_tr_b16 a[190:191], v15 offset:13824
M a[120:123], a[208:211], a[232:235], a[120:123]
s_sub_u32 s54, s54, 1
s_cmp_eq_u32 s54, 0
s_cselect_b32 s58, s55, s56
s_add_u32 s25, s25, s58
M a[124:127], a[216:219], a[232:235], a[124:127]
M a[124:127], a[220:223], a[236:239], a[124:127]
s_add_u32 s94, s92, 12288
buffer_store_dwordx4 v[144:147], v1, s[16:19], s94 offen offset:2048 sc1
s_waitcnt lgkmcnt(10)
M a[128:131], a[204:207], a[244:247], a[128:131]
ds_read_b128 a[232:235], v10 offset:16384
ds_read_b128 a[236:239], v11 offset:16384
M a[128:131], a[200:203], a[240:243], a[128:131]
M a[132:135], a[208:211], a[240:243], a[132:135]
ds_read_b64_tr_b16 a[196:197], v16 offset:12288
ds_read_b64_tr_b16 a[198:199], v16 offset:13824
M a[132:135], a[212:215], a[244:247], a[132:135]
s_add_u32 s94, s92, 12288
buffer_store_dwordx4 v[152:155], v1, s[16:19], s94 offen offset:3072 sc1
M a[136:139], a[220:223], a[244:247], a[136:139]
M a[136:139], a[216:219], a[240:243], a[136:139]
s_add_u32 s94, s93, 0
buffer_store_dwordx4 v[160:163], v1, s[16:19], s94 offen offset:0 sc1
s_waitcnt lgkmcnt(10)
M a[140:143], a[200:203], a[248:251], a[140:143]
M a[140:143], a[204:207], a[252:255], a[140:143]
s_add_u32 s94, s93, 0
buffer_store_dwordx4 v[168:171], v1, s[16:19], s94 offen offset:1024 sc1
M a[144:147], a[212:215], a[252:255], a[144:147]
M a[144:147], a[208:211], a[248:251], a[144:147]
M a[148:151], a[216:219], a[248:251], a[148:151]
s_waitcnt vmcnt(16) lgkmcnt(0)
s_barrier
ds_read_b128 a[240:243], v10 offset:18432
ds_read_b128 a[244:247], v11 offset:18432
M a[148:151], a[220:223], a[252:255], a[148:151]
s_add_u32 m0, s28, 0
s_nop 0
buffer_load_dword v20, s[8:11], s24 offen lds
M a[152:155], a[204:207], a[228:231], a[152:155]
ds_read_b128 a[248:251], v10 offset:20480
ds_read_b128 a[252:255], v11 offset:20480
M a[152:155], a[200:203], a[224:227], a[152:155]
M a[156:159], a[208:211], a[224:227], a[156:159]
buffer_load_dword v23, s[8:11], s24 offen offset:256 lds
M a[156:159], a[212:215], a[228:231], a[156:159]
M a[160:163], a[220:223], a[228:231], a[160:163]
M a[160:163], a[216:219], a[224:227], a[160:163]
s_add_u32 m0, s29, 2048
s_nop 0
buffer_load_dwordx4 v2, s[8:11], s23 offen offset:0 lds
M a[164:167], a[200:203], a[232:235], a[164:167]
ds_read_b128 a[224:227], v10 offset:22528
ds_read_b128 a[228:231], v11 offset:22528
M a[164:167], a[204:207], a[236:239], a[164:167]
M a[168:171], a[212:215], a[236:239], a[168:171]
M a[168:171], a[208:211], a[232:235], a[168:171]
buffer_load_dwordx4 v3, s[8:11], s23 offen offset:1024 lds
M a[172:175], a[216:219], a[232:235], a[172:175]
M a[172:175], a[220:223], a[236:239], a[172:175]
s_waitcnt lgkmcnt(4)
M a[68:71], a[176:179], a[240:243], a[68:71]
ds_read_b128 a[232:235], v10 offset:24576
ds_read_b128 a[236:239], v11 offset:24576
M a[68:71], a[180:183], a[244:247], a[68:71]
buffer_load_dwordx4 v4, s[8:11], s23 offen offset:2048 lds
M a[72:75], a[188:191], a[244:247], a[72:75]
ds_read_b64_tr_b16 a[200:201], v14 offset:28672
ds_read_b64_tr_b16 a[202:203], v14 offset:30208
M a[72:75], a[184:187], a[240:243], a[72:75]
buffer_load_dwordx4 v5, s[8:11], s23 offen offset:3072 lds
M a[76:79], a[192:195], a[240:243], a[76:79]
M a[76:79], a[196:199], a[244:247], a[76:79]
s_sub_u32 s31, s31, 1
s_cmp_eq_u32 s31, 0
s_cselect_b32 s58, -1920, s57
s_add_u32 s23, s23, s58
s_add_u32 s24, s24, s58
s_waitcnt lgkmcnt(6)
M a[80:83], a[180:183], a[252:255], a[80:83]
ds_read_b128 a[240:243], v10 offset:26624
ds_read_b128 a[244:247], v11 offset:26624
M a[80:83], a[176:179], a[248:251], a[80:83]
M a[84:87], a[184:187], a[248:251], a[84:87]
ds_read_b64_tr_b16 a[208:209], v15 offset:28672
ds_read_b64_tr_b16 a[210:211], v15 offset:30208
M a[84:87], a[188:191], a[252:255], a[84:87]
s_add_u32 m0, s30, 36864
s_nop 0
buffer_load_dwordx4 v6, s[12:15], s25 offen offset:0 lds
M a[88:91], a[196:199], a[252:255], a[88:91]
M a[88:91], a[192:195], a[248:251], a[88:91]
buffer_load_dwordx4 v7, s[12:15], s25 offen offset:1024 lds
s_waitcnt lgkmcnt(8)
M a[92:95], a[176:179], a[224:227], a[92:95]
ds_read_b128 a[248:251], v10 offset:28672
ds_read_b128 a[252:255], v11 offset:28672
M a[92:95], a[180:183], a[228:231], a[92:95]
M a[96:99], a[188:191], a[228:231], a[96:99]
ds_read_b64_tr_b16 a[216:217], v16 offset:28672
ds_read_b64_tr_b16 a[218:219], v16 offset:30208
M a[96:99], a[184:187], a[224:227], a[96:99]
buffer_load_dwordx4 v8, s[12:15], s25 offen offset:2048 lds
M a[100:103], a[192:195], a[224:227], a[100:103]
M a[100:103], a[196:199], a[228:231], a[100:103]
buffer_load_dwordx4 v9, s[12:15], s25 offen offset:3072 lds
s_waitcnt lgkmcnt(10)
M a[104:107], a[180:183], a[236:239], a[104:107]
ds_read_b128 a[224:227], v10 offset:30720
ds_read_b128 a[228:231], v11 offset:30720
M a[104:107], a[176:179], a[232:235], a[104:107]
M a[108:111], a[184:187], a[232:235], a[108:111]
ds_read_b64_tr_b16 a[204:205], v14 offset:40960
ds_read_b64_tr_b16 a[206:207], v14 offset:42496
M a[108:111], a[188:191], a[236:239], a[108:111]
s_add_u32 m0, s30, 40960
s_nop 0
buffer_load_dwordx4 v21, s[12:15], s25 offen offset:0 lds
M a[112:115], a[196:199], a[236:239], a[112:115]
M a[112:115], a[192:195], a[232:235], a[112:115]
buffer_load_dwordx4 v22, s[12:15], s25 offen offset:1024 lds
s_waitcnt lgkmcnt(10)
M a[116:119], a[176:179], a[240:243], a[116:119]
ds_read_b128 a[232:235], v10 offset:32768
ds_read_b128 a[236:239], v11 offset:32768
M a[116:119], a[180:183], a[244:247], a[116:119]
M a[120:123], a[188:191], a[244:247], a[120:123]
ds_read_b64_tr_b16 a[212:213], v15 offset:40960
ds_read_b64_tr_b16 a[214:215], v15 offset:42496
M a[120:123], a[184:187], a[240:243], a[120:123]
s_sub_u32 s54, s54, 1
s_cmp_eq_u32 s54, 0
s_cselect_b32 s58, s55, s56
s_add_u32 s25, s25, s58
M a[124:127], a[192:195], a[240:243], a[124:127]
M a[124:127], a[196:199], a[244:247], a[124:127]
s_add_u32 s94, s93, 0
buffer_store_dwordx4 v[176:179], v1, s[16:19], s94 offen offset:2048 sc1
s_waitcnt lgkmcnt(10)
M a[128:131], a[180:183], a[252:255], a[128:131]
ds_read_b128 a[240:243], v10 offset:34816
ds_read_b128 a[244:247], v11 offset:34816
M a[128:131], a[176:179], a[248:251], a[128:131]
M a[132:135], a[184:187], a[248:251], a[132:135]
ds_read_b64_tr_b16 a[220:221], v16 offset:40960
ds_read_b64_tr_b16 a[222:223], v16 offset:42496
M a[132:135], a[188:191], a[252:255], a[132:135]
s_add_u32 s94, s93, 0
buffer_store_dwordx4 v[184:187], v1, s[16:19], s94 offen offset:3072 sc1
M a[136:139], a[196:199], a[252:255], a[136:139]
M a[136:139], a[192:195], a[248:251], a[136:139]
s_add_u32 s94, s93, 4096
buffer_store_dwordx4 v[192:195], v1, s[16:19], s94 offen offset:0 sc1
s_waitcnt lgkmcnt(10)
M a[140:143], a[176:179], a[224:227], a[140:143]
M a[140:143], a[180:183], a[228:231], a[140:143]
s_add_u32 s94, s93, 4096
buffer_store_dwordx4 v[200:203], v1, s[16:19], s94 offen offset:1024 sc1
M a[144:147], a[188:191], a[228:231], a[144:147]
M a[144:147], a[184:187], a[224:227], a[144:147]
M a[148:151], a[192:195], a[224:227], a[148:151]
s_waitcnt vmcnt(20) lgkmcnt(0)
s_barrier
ds_read_b128 a[248:251], v12 offset:0
ds_read_b128 a[252:255], v13 offset:0
M a[148:151], a[196:199], a[228:231], a[148:151]
s_add_u32 m0, s28, 18432
s_nop 0
buffer_load_dword v20, s[8:11], s24 offen lds
M a[152:155], a[180:183], a[236:239], a[152:155]
ds_read_b128 a[224:227], v12 offset:2048
ds_read_b128 a[228:231], v13 offset:2048
M a[152:155], a[176:179], a[232:235], a[152:155]
M a[156:159], a[184:187], a[232:235], a[156:159]
buffer_load_dword v23, s[8:11], s24 offen offset:256 lds
M a[156:159], a[188:191], a[236:239], a[156:159]
M a[160:163], a[196:199], a[236:239], a[160:163]
M a[160:163], a[192:195], a[232:235], a[160:163]
s_add_u32 m0, s29, 20480
s_nop 0
buffer_load_dwordx4 v2, s[8:11], s23 offen offset:0 lds
M a[164:167], a[176:179], a[240:243], a[164:167]
ds_read_b128 a[232:235], v12 offset:4096
ds_read_b128 a[236:239], v13 offset:4096
M a[164:167], a[180:183], a[244:247], a[164:167]
M a[168:171], a[188:191], a[244:247], a[168:171]
M a[168:171], a[184:187], a[240:243], a[168:171]
buffer_load_dwordx4 v3, s[8:11], s23 offen offset:1024 lds
M a[172:175], a[192:195], a[240:243], a[172:175]
M a[172:175], a[196:199], a[244:247], a[172:175]
s_waitcnt lgkmcnt(4)
M a[68:71], a[200:203], a[248:251], a[68:71]
ds_read_b128 a[240:243], v12 offset:6144
ds_read_b128 a[244:247], v13 offset:6144
M a[68:71], a[204:207], a[252:255], a[68:71]
buffer_load_dwordx4 v4, s[8:11], s23 offen offset:2048 lds
M a[72:75], a[212:215], a[252:255], a[72:75]
ds_read_b64_tr_b16 a[176:177], v17 offset:0
ds_read_b64_tr_b16 a[178:179], v17 offset:1536
M a[72:75], a[208:211], a[248:251], a[72:75]
buffer_load_dwordx4 v5, s[8:11], s23 offen offset:3072 lds
M a[76:79], a[216:219], a[248:251], a[76:79]
M a[76:79], a[220:223], a[252:255], a[76:79]
s_sub_u32 s31, s31, 1
s_cmp_eq_u32 s31, 0
s_cselect_b32 s58, -1920, s57
s_add_u32 s23, s23, s58
s_add_u32 s24, s24, s58
s_waitcnt lgkmcnt(6)
M a[80:83], a[204:207], a[228:231], a[80:83]
ds_read_b128 a[248:251], v12 offset:8192
ds_read_b128 a[252:255], v13 offset:8192
M a[80:83], a[200:203], a[224:227], a[80:83]
M a[84:87], a[208:211], a[224:227], a[84:87]
ds_read_b64_tr_b16 a[184:185], v18 offset:0
ds_read_b64_tr_b16 a[186:187], v18 offset:1536
M a[84:87], a[212:215], a[228:231], a[84:87]
s_add_u32 m0, s30, 65536
s_nop 0
buffer_load_dwordx4 v6, s[12:15], s25 offen offset:0 lds
M a[88:91], a[220:223], a[228:231], a[88:91]
M a[88:91], a[216:219], a[224:227], a[88:91]
buffer_load_dwordx4 v7, s[12:15], s25 offen offset:1024 lds
s_waitcnt lgkmcnt(8)
M a[92:95], a[200:203], a[232:235], a[92:95]
ds_read_b128 a[224:227], v12 offset:10240
ds_read_b128 a[228:231], v13 offset:10240
M a[92:95], a[204:207], a[236:239], a[92:95]
M a[96:99], a[212:215], a[236:239], a[96:99]
ds_read_b64_tr_b16 a[192:193], v19 offset:0
ds_read_b64_tr_b16 a[194:195], v19 offset:1536
M a[96:99], a[208:211], a[232:235], a[96:99]
buffer_load_dwordx4 v8, s[12:15], s25 offen offset:2048 lds
M a[100:103], a[216:219], a[232:235], a[100:103]
M a[100:103], a[220:223], a[236:239], a[100:103]
buffer_load_dwordx4 v9, s[12:15], s25 offen offset:3072 lds
s_waitcnt lgkmcnt(10)
M a[104:107], a[204:207], a[244:247], a[104:107]
ds_read_b128 a[232:235], v12 offset:12288
ds_read_b128 a[236:239], v13 offset:12288
M a[104:107], a[200:203], a[240:243], a[104:107]
M a[108:111], a[208:211], a[240:243], a[108:111]
ds_read_b64_tr_b16 a[180:181], v17 offset:12288
ds_read_b64_tr_b16 a[182:183], v17 offset:13824
M a[108:111], a[212:215], a[244:247], a[108:111]
s_add_u32 m0, s30, 69632
s_nop 0
buffer_load_dwordx4 v21, s[12:15], s25 offen offset:0 lds
M a[112:115], a[220:223], a[244:247], a[112:115]
M a[112:115], a[216:219], a[240:243], a[112:115]
buffer_load_dwordx4 v22, s[12:15], s25 offen offset:1024 lds
s_waitcnt lgkmcnt(10)
M a[116:119], a[200:203], a[248:251], a[116:119]
ds_read_b128 a[240:243], v12 offset:14336
ds_read_b128 a[244:247], v13 offset:14336
M a[116:119], a[204:207], a[252:255], a[116:119]
M a[120:123], a[212:215], a[252:255], a[120:123]
ds_read_b64_tr_b16 a[188:189], v18 offset:12288
ds_read_b64_tr_b16 a[190:191], v18 offset:13824
M a[120:123], a[208:211], a[248:251], a[120:123]
s_sub_u32 s54, s54, 1
s_cmp_eq_u32 s54, 0
s_cselect_b32 s58, s55, s56
s_add_u32 s25, s25, s58
M a[124:127], a[216:219], a[248:251], a[124:127]
M a[124:127], a[220:223], a[252:255], a[124:127]
s_add_u32 s94, s93, 4096
buffer_store_dwordx4 v[208:211], v1, s[16:19], s94 offen offset:2048 sc1
s_waitcnt lgkmcnt(10)
M a[128:131], a[204:207], a[228:231], a[128:131]
ds_read_b128 a[248:251], v12 offset:16384
ds_read_b128 a[252:255], v13 offset:16384
M a[128:131], a[200:203], a[224:227], a[128:131]
M a[132:135], a[208:211], a[224:227], a[132:135]
ds_read_b64_tr_b16 a[196:197], v19 offset:12288
ds_read_b64_tr_b16 a[198:199], v19 offset:13824
M a[132:135], a[212:215], a[228:231], a[132:135]
s_add_u32 s94, s93, 4096
buffer_store_dwordx4 v[216:219], v1, s[16:19], s94 offen offset:3072 sc1
M a[136:139], a[220:223], a[228:231], a[136:139]
M a[136:139], a[216:219], a[224:227], a[136:139]
s_add_u32 s94, s93, 8192
buffer_store_dwordx4 v[224:227], v1, s[16:19], s94 offen offset:0 sc1
s_waitcnt lgkmcnt(10)
M a[140:143], a[200:203], a[232:235], a[140:143]
M a[140:143], a[204:207], a[236:239], a[140:143]
s_add_u32 s94, s93, 8192
buffer_store_dwordx4 v[232:235], v1, s[16:19], s94 offen offset:1024 sc1
M a[144:147], a[212:215], a[236:239], a[144:147]
M a[144:147], a[208:211], a[232:235], a[144:147]
M a[148:151], a[216:219], a[232:235], a[148:151]
s_waitcnt vmcnt(20) lgkmcnt(0)
s_barrier
ds_read_b128 a[224:227], v10 offset:0
ds_read_b128 a[228:231], v11 offset:0
M a[148:151], a[220:223], a[236:239], a[148:151]
s_add_u32 m0, s28, 131072
s_nop 0
buffer_load_dword v20, s[8:11], s24 offen lds
M a[152:155], a[204:207], a[244:247], a[152:155]
ds_read_b128 a[232:235], v10 offset:2048
ds_read_b128 a[236:239], v11 offset:2048
M a[152:155], a[200:203], a[240:243], a[152:155]
M a[156:159], a[208:211], a[240:243], a[156:159]
buffer_load_dword v23, s[8:11], s24 offen offset:256 lds
M a[156:159], a[212:215], a[244:247], a[156:159]
M a[160:163], a[220:223], a[244:247], a[160:163]
M a[160:163], a[216:219], a[240:243], a[160:163]
s_add_u32 m0, s29, 133120
s_nop 0
buffer_load_dwordx4 v2, s[8:11], s23 offen offset:0 lds
M a[164:167], a[200:203], a[248:251], a[164:167]
ds_read_b128 a[240:243], v10 offset:4096
ds_read_b128 a[244:247], v11 offset:4096
M a[164:167], a[204:207], a[252:255], a[164:167]
M a[168:171], a[212:215], a[252:255], a[168:171]
M a[168:171], a[208:211], a[248:251], a[168:171]
buffer_load_dwordx4 v3, s[8:11], s23 offen offset:1024 lds
M a[172:175], a[216:219], a[248:251], a[172:175]
M a[172:175], a[220:223], a[252:255], a[172:175]
s_waitcnt lgkmcnt(4)
M a[68:71], a[176:179], a[224:227], a[68:71]
ds_read_b128 a[248:251], v10 offset:6144
ds_read_b128 a[252:255], v11 offset:6144
M a[68:71], a[180:183], a[228:231], a[68:71]
buffer_load_dwordx4 v4, s[8:11], s23 offen offset:2048 lds
M a[72:75], a[188:191], a[228:231], a[72:75]
ds_read_b64_tr_b16 a[200:201], v14 offset:0
ds_read_b64_tr_b16 a[202:203], v14 offset:1536
M a[72:75], a[184:187], a[224:227], a[72:75]
buffer_load_dwordx4 v5, s[8:11], s23 offen offset:3072 lds
M a[76:79], a[192:195], a[224:227], a[76:79]
M a[76:79], a[196:199], a[228:231], a[76:79]
s_sub_u32 s31, s31, 1
s_cmp_eq_u32 s31, 0
s_cselect_b32 s58, -1920, s57
s_add_u32 s23, s23, s58
s_add_u32 s24, s24, s58
s_waitcnt lgkmcnt(6)
M a[80:83], a[180:183], a[236:239], a[80:83]
ds_read_b128 a[224:227], v10 offset:8192
ds_read_b128 a[228:231], v11 offset:8192
M a[80:83], a[176:179], a[232:235], a[80:83]
M a[84:87], a[184:187], a[232:235], a[84:87]
ds_read_b64_tr_b16 a[208:209], v15 offset:0
ds_read_b64_tr_b16 a[210:211], v15 offset:1536
M a[84:87], a[188:191], a[236:239], a[84:87]
s_add_u32 m0, s30, 98304
s_nop 0
buffer_load_dwordx4 v6, s[12:15], s25 offen offset:0 lds
M a[88:91], a[196:199], a[236:239], a[88:91]
M a[88:91], a[192:195], a[232:235], a[88:91]
buffer_load_dwordx4 v7, s[12:15], s25 offen offset:1024 lds
s_waitcnt lgkmcnt(8)
M a[92:95], a[176:179], a[240:243], a[92:95]
ds_read_b128 a[232:235], v10 offset:10240
ds_read_b128 a[236:239], v11 offset:10240
M a[92:95], a[180:183], a[244:247], a[92:95]
M a[96:99], a[188:191], a[244:247], a[96:99]
ds_read_b64_tr_b16 a[216:217], v16 offset:0
ds_read_b64_tr_b16 a[218:219], v16 offset:1536
M a[96:99], a[184:187], a[240:243], a[96:99]
buffer_load_dwordx4 v8, s[12:15], s25 offen offset:2048 lds
M a[100:103], a[192:195], a[240:243], a[100:103]
M a[100:103], a[196:199], a[244:247], a[100:103]
buffer_load_dwordx4 v9, s[12:15], s25 offen offset:3072 lds
s_waitcnt lgkmcnt(10)
M a[104:107], a[180:183], a[252:255], a[104:107]
ds_read_b128 a[240:243], v10 offset:12288
ds_read_b128 a[244:247], v11 offset:12288
M a[104:107], a[176:179], a[248:251], a[104:107]
M a[108:111], a[184:187], a[248:251], a[108:111]
ds_read_b64_tr_b16 a[204:205], v14 offset:12288
ds_read_b64_tr_b16 a[206:207], v14 offset:13824
M a[108:111], a[188:191], a[252:255], a[108:111]
s_add_u32 m0, s30, 102400
s_nop 0
buffer_load_dwordx4 v21, s[12:15], s25 offen offset:0 lds
M a[112:115], a[196:199], a[252:255], a[112:115]
M a[112:115], a[192:195], a[248:251], a[112:115]
buffer_load_dwordx4 v22, s[12:15], s25 offen offset:1024 lds
s_waitcnt lgkmcnt(10)
M a[116:119], a[176:179], a[224:227], a[116:119]
ds_read_b128 a[248:251], v10 offset:14336
ds_read_b128 a[252:255], v11 offset:14336
M a[116:119], a[180:183], a[228:231], a[116:119]
M a[120:123], a[188:191], a[228:231], a[120:123]
ds_read_b64_tr_b16 a[212:213], v15 offset:12288
ds_read_b64_tr_b16 a[214:215], v15 offset:13824
M a[120:123], a[184:187], a[224:227], a[120:123]
s_sub_u32 s54, s54, 1
s_cmp_eq_u32 s54, 0
s_cselect_b32 s58, s55, s56
s_add_u32 s25, s25, s58
M a[124:127], a[192:195], a[224:227], a[124:127]
M a[124:127], a[196:199], a[228:231], a[124:127]
s_add_u32 s94, s93, 8192
buffer_store_dwordx4 v[240:243], v1, s[16:19], s94 offen offset:2048 sc1
s_waitcnt lgkmcnt(10)
M a[128:131], a[180:183], a[236:239], a[128:131]
ds_read_b128 a[224:227], v10 offset:16384
ds_read_b128 a[228:231], v11 offset:16384
M a[128:131], a[176:179], a[232:235], a[128:131]
M a[132:135], a[184:187], a[232:235], a[132:135]
ds_read_b64_tr_b16 a[220:221], v16 offset:12288
ds_read_b64_tr_b16 a[222:223], v16 offset:13824
M a[132:135], a[188:191], a[236:239], a[132:135]
s_add_u32 s94, s93, 8192
buffer_store_dwordx4 v[248:251], v1, s[16:19], s94 offen offset:3072 sc1
M a[136:139], a[196:199], a[236:239], a[136:139]
M a[136:139], a[192:195], a[232:235], a[136:139]
s_add_u32 s94, s93, 12288
buffer_store_dwordx4 v[36:39], v1, s[16:19], s94 offen offset:0 sc1
s_waitcnt lgkmcnt(10)
M a[140:143], a[176:179], a[240:243], a[140:143]
M a[140:143], a[180:183], a[244:247], a[140:143]
s_add_u32 s94, s93, 12288
buffer_store_dwordx4 v[44:47], v1, s[16:19], s94 offen offset:1024 sc1
M a[144:147], a[188:191], a[244:247], a[144:147]
M a[144:147], a[184:187], a[240:243], a[144:147]
M a[148:151], a[192:195], a[240:243], a[148:151]
s_waitcnt vmcnt(20) lgkmcnt(0)
s_barrier
ds_read_b128 a[232:235], v10 offset:18432
ds_read_b128 a[236:239], v11 offset:18432
M a[148:151], a[196:199], a[244:247], a[148:151]
s_add_u32 m0, s28, 0
s_nop 0
buffer_load_dword v20, s[8:11], s24 offen lds
M a[152:155], a[180:183], a[252:255], a[152:155]
ds_read_b128 a[240:243], v10 offset:20480
ds_read_b128 a[244:247], v11 offset:20480
M a[152:155], a[176:179], a[248:251], a[152:155]
M a[156:159], a[184:187], a[248:251], a[156:159]
buffer_load_dword v23, s[8:11], s24 offen offset:256 lds
M a[156:159], a[188:191], a[252:255], a[156:159]
M a[160:163], a[196:199], a[252:255], a[160:163]
M a[160:163], a[192:195], a[248:251], a[160:163]
s_add_u32 m0, s29, 2048
s_nop 0
buffer_load_dwordx4 v2, s[8:11], s23 offen offset:0 lds
M a[164:167], a[176:179], a[224:227], a[164:167]
ds_read_b128 a[248:251], v10 offset:22528
ds_read_b128 a[252:255], v11 offset:22528
M a[164:167], a[180:183], a[228:231], a[164:167]
M a[168:171], a[188:191], a[228:231], a[168:171]
M a[168:171], a[184:187], a[224:227], a[168:171]
buffer_load_dwordx4 v3, s[8:11], s23 offen offset:1024 lds
M a[172:175], a[192:195], a[224:227], a[172:175]
M a[172:175], a[196:199], a[228:231], a[172:175]
s_waitcnt lgkmcnt(4)
M a[68:71], a[200:203], a[232:235], a[68:71]
ds_read_b128 a[224:227], v10 offset:24576
ds_read_b128 a[228:231], v11 offset:24576
M a[68:71], a[204:207], a[236:239], a[68:71]
buffer_load_dwordx4 v4, s[8:11], s23 offen offset:2048 lds
M a[72:75], a[212:215], a[236:239], a[72:75]
ds_read_b64_tr_b16 a[176:177], v14 offset:28672
ds_read_b64_tr_b16 a[178:179], v14 offset:30208
M a[72:75], a[208:211], a[232:235], a[72:75]
M a[76:79], a[216:219], a[232:235], a[76:79]
buffer_load_dwordx4 v5, s[8:11], s23 offen offset:3072 lds
M a[76:79], a[220:223], a[236:239], a[76:79]
s_waitcnt lgkmcnt(6)
M a[80:83], a[204:207], a[244:247], a[80:83]
ds_read_b128 a[232:235], v10 offset:26624
ds_read_b128 a[236:239], v11 offset:26624
M a[80:83], a[200:203], a[240:243], a[80:83]
s_sub_u32 s31, s31, 1
s_cmp_eq_u32 s31, 0
s_cselect_b32 s58, -1920, s57
s_add_u32 s23, s23, s58
s_add_u32 s24, s24, s58
M a[84:87], a[208:211], a[240:243], a[84:87]
ds_read_b64_tr_b16 a[184:185], v15 offset:28672
ds_read_b64_tr_b16 a[186:187], v15 offset:30208
M a[84:87], a[212:215], a[244:247], a[84:87]
M a[88:91], a[220:223], a[244:247], a[88:91]
s_add_u32 m0, s30, 36864
s_nop 0
buffer_load_dwordx4 v6, s[12:15], s25 offen offset:0 lds
M a[88:91], a[216:219], a[240:243], a[88:91]
s_waitcnt lgkmcnt(8)
M a[92:95], a[200:203], a[248:251], a[92:95]
ds_read_b128 a[240:243], v10 offset:28672
ds_read_b128 a[244:247], v11 offset:28672
M a[92:95], a[204:207], a[252:255], a[92:95]
M a[96:99], a[212:215], a[252:255], a[96:99]
ds_read_b64_tr_b16 a[192:193], v16 offset:28672
ds_read_b64_tr_b16 a[194:195], v16 offset:30208
M a[96:99], a[208:211], a[248:251], a[96:99]
buffer_load_dwordx4 v7, s[12:15], s25 offen offset:1024 lds
M a[100:103], a[216:219], a[248:251], a[100:103]
M a[100:103], a[220:223], a[252:255], a[100:103]
buffer_load_dwordx4 v8, s[12:15], s25 offen offset:2048 lds
s_waitcnt lgkmcnt(10)
M a[104:107], a[204:207], a[228:231], a[104:107]
ds_read_b128 a[248:251], v10 offset:30720
ds_read_b128 a[252:255], v11 offset:30720
M a[104:107], a[200:203], a[224:227], a[104:107]
M a[108:111], a[208:211], a[224:227], a[108:111]
ds_read_b64_tr_b16 a[180:181], v14 offset:40960
ds_read_b64_tr_b16 a[182:183], v14 offset:42496
M a[108:111], a[212:215], a[228:231], a[108:111]
buffer_load_dwordx4 v9, s[12:15], s25 offen offset:3072 lds
M a[112:115], a[220:223], a[228:231], a[112:115]
M a[112:115], a[216:219], a[224:227], a[112:115]
s_add_u32 m0, s30, 40960
s_nop 0
buffer_load_dwordx4 v21, s[12:15], s25 offen offset:0 lds
s_waitcnt lgkmcnt(10)
M a[116:119], a[200:203], a[232:235], a[116:119]
ds_read_b128 a[224:227], v10 offset:32768
ds_read_b128 a[228:231], v11 offset:32768
M a[116:119], a[204:207], a[236:239], a[116:119]
M a[120:123], a[212:215], a[236:239], a[120:123]
ds_read_b64_tr_b16 a[188:189], v15 offset:40960
ds_read_b64_tr_b16 a[190:191], v15 offset:42496
M a[120:123], a[208:211], a[232:235], a[120:123]
M a[124:127], a[216:219], a[232:235], a[124:127]
buffer_load_dwordx4 v22, s[12:15], s25 offen offset:1024 lds
M a[124:127], a[220:223], a[236:239], a[124:127]
s_waitcnt lgkmcnt(10)
M a[128:131], a[204:207], a[244:247], a[128:131]
ds_read_b128 a[232:235], v10 offset:34816
ds_read_b128 a[236:239], v11 offset:34816
M a[128:131], a[200:203], a[240:243], a[128:131]
s_sub_u32 s54, s54, 1
s_cmp_eq_u32 s54, 0
s_cselect_b32 s58, s55, s56
s_add_u32 s25, s25, s58
M a[132:135], a[208:211], a[240:243], a[132:135]
ds_read_b64_tr_b16 a[196:197], v16 offset:40960
ds_read_b64_tr_b16 a[198:199], v16 offset:42496
M a[132:135], a[212:215], a[244:247], a[132:135]
M a[136:139], a[220:223], a[244:247], a[136:139]
s_add_u32 s94, s93, 12288
buffer_store_dwordx4 v[52:55], v1, s[16:19], s94 offen offset:2048 sc1
M a[136:139], a[216:219], a[240:243], a[136:139]
s_waitcnt lgkmcnt(10)
M a[140:143], a[200:203], a[248:251], a[140:143]
s_add_u32 s94, s93, 12288
buffer_store_dwordx4 v[60:63], v1, s[16:19], s94 offen offset:3072 sc1
M a[140:143], a[204:207], a[252:255], a[140:143]
M a[144:147], a[212:215], a[252:255], a[144:147]
M a[144:147], a[208:211], a[248:251], a[144:147]
M a[148:151], a[216:219], a[248:251], a[148:151]
s_waitcnt vmcnt(18) lgkmcnt(0)
s_barrier
ds_read_b128 a[240:243], v12 offset:0
ds_read_b128 a[244:247], v13 offset:0
M a[148:151], a[220:223], a[252:255], a[148:151]
s_add_u32 m0, s28, 18432
s_nop 0
buffer_load_dword v20, s[8:11], s24 offen lds
M a[152:155], a[204:207], a[228:231], a[152:155]
ds_read_b128 a[248:251], v12 offset:2048
ds_read_b128 a[252:255], v13 offset:2048
M a[152:155], a[200:203], a[224:227], a[152:155]
M a[156:159], a[208:211], a[224:227], a[156:159]
buffer_load_dword v23, s[8:11], s24 offen offset:256 lds
M a[156:159], a[212:215], a[228:231], a[156:159]
M a[160:163], a[220:223], a[228:231], a[160:163]
M a[160:163], a[216:219], a[224:227], a[160:163]
s_add_u32 m0, s29, 20480
s_nop 0
buffer_load_dwordx4 v2, s[8:11], s23 offen offset:0 lds
M a[164:167], a[200:203], a[232:235], a[164:167]
ds_read_b128 a[224:227], v12 offset:4096
ds_read_b128 a[228:231], v13 offset:4096
M a[164:167], a[204:207], a[236:239], a[164:167]
M a[168:171], a[212:215], a[236:239], a[168:171]
M a[168:171], a[208:211], a[232:235], a[168:171]
buffer_load_dwordx4 v3, s[8:11], s23 offen offset:1024 lds
M a[172:175], a[216:219], a[232:235], a[172:175]
M a[172:175], a[220:223], a[236:239], a[172:175]
s_waitcnt lgkmcnt(4)
M a[68:71], a[176:179], a[240:243], a[68:71]
ds_read_b128 a[232:235], v12 offset:6144
ds_read_b128 a[236:239], v13 offset:6144
M a[68:71], a[180:183], a[244:247], a[68:71]
buffer_load_dwordx4 v4, s[8:11], s23 offen offset:2048 lds
M a[72:75], a[188:191], a[244:247], a[72:75]
ds_read_b64_tr_b16 a[200:201], v17 offset:0
ds_read_b64_tr_b16 a[202:203], v17 offset:1536
M a[72:75], a[184:187], a[240:243], a[72:75]
M a[76:79], a[192:195], a[240:243], a[76:79]
buffer_load_dwordx4 v5, s[8:11], s23 offen offset:3072 lds
M a[76:79], a[196:199], a[244:247], a[76:79]
s_waitcnt lgkmcnt(6)
M a[80:83], a[180:183], a[252:255], a[80:83]
ds_read_b128 a[240:243], v12 offset:8192
ds_read_b128 a[244:247], v13 offset:8192
M a[80:83], a[176:179], a[248:251], a[80:83]
M a[84:87], a[184:187], a[248:251], a[84:87]
ds_read_b64_tr_b16 a[208:209], v18 offset:0
ds_read_b64_tr_b16 a[210:211], v18 offset:1536
M a[84:87], a[188:191], a[252:255], a[84:87]
s_sub_u32 s31, s31, 1
s_cmp_eq_u32 s31, 0
s_cselect_b32 s58, -1920, s57
s_add_u32 s23, s23, s58
s_add_u32 s24, s24, s58
M a[88:91], a[196:199], a[252:255], a[88:91]
M a[88:91], a[192:195], a[248:251], a[88:91]
s_waitcnt lgkmcnt(8)
M a[92:95], a[176:179], a[224:227], a[92:95]
ds_read_b128 a[248:251], v12 offset:10240
ds_read_b128 a[252:255], v13 offset:10240
M a[92:95], a[180:183], a[228:231], a[92:95]
s_add_u32 m0, s30, 65536
s_nop 0
buffer_load_dwordx4 v6, s[12:15], s25 offen offset:0 lds
M a[96:99], a[188:191], a[228:231], a[96:99]
ds_read_b64_tr_b16 a[216:217], v19 offset:0
ds_read_b64_tr_b16 a[218:219], v19 offset:1536
M a[96:99], a[184:187], a[224:227], a[96:99]
M a[100:103], a[192:195], a[224:227], a[100:103]
buffer_load_dwordx4 v7, s[12:15], s25 offen offset:1024 lds
M a[100:103], a[196:199], a[228:231], a[100:103]
s_waitcnt lgkmcnt(10)
M a[104:107], a[180:183], a[236:239], a[104:107]
ds_read_b128 a[224:227], v12 offset:12288
ds_read_b128 a[228:231], v13 offset:12288
M a[104:107], a[176:179], a[232:235], a[104:107]
M a[108:111], a[184:187], a[232:235], a[108:111]
ds_read_b64_tr_b16 a[204:205], v17 offset:12288
ds_read_b64_tr_b16 a[206:207], v17 offset:13824
M a[108:111], a[188:191], a[236:239], a[108:111]
buffer_load_dwordx4 v8, s[12:15], s25 offen offset:2048 lds
M a[112:115], a[196:199], a[236:239], a[112:115]
M a[112:115], a[192:195], a[232:235], a[112:115]
s_waitcnt lgkmcnt(10)
M a[116:119], a[176:179], a[240:243], a[116:119]
ds_read_b128 a[232:235], v12 offset:14336
ds_read_b128 a[236:239], v13 offset:14336
M a[116:119], a[180:183], a[244:247], a[116:119]
buffer_load_dwordx4 v9, s[12:15], s25 offen offset:3072 lds
M a[120:123], a[188:191], a[244:247], a[120:123]
ds_read_b64_tr_b16 a[212:213], v18 offset:12288
ds_read_b64_tr_b16 a[214:215], v18 offset:13824
M a[120:123], a[184:187], a[240:243], a[120:123]
M a[124:127], a[192:195], a[240:243], a[124:127]
s_add_u32 m0, s30, 69632
s_nop 0
buffer_load_dwordx4 v21, s[12:15], s25 offen offset:0 lds
M a[124:127], a[196:199], a[244:247], a[124:127]
s_waitcnt lgkmcnt(10)
M a[128:131], a[180:183], a[252:255], a[128:131]
ds_read_b128 a[240:243], v12 offset:16384
ds_read_b128 a[244:247], v13 offset:16384
M a[128:131], a[176:179], a[248:251], a[128:131]
M a[132:135], a[184:187], a[248:251], a[132:135]
ds_read_b64_tr_b16 a[220:221], v19 offset:12288
ds_read_b64_tr_b16 a[222:223], v19 offset:13824
M a[132:135], a[188:191], a[252:255], a[132:135]
buffer_load_dwordx4 v22, s[12:15], s25 offen offset:1024 lds
M a[136:139], a[196:199], a[252:255], a[136:139]
M a[136:139], a[192:195], a[248:251], a[136:139]
s_waitcnt lgkmcnt(10)
M a[140:143], a[176:179], a[224:227], a[140:143]
s_sub_u32 s54, s54, 1
s_cmp_eq_u32 s54, 0
s_cselect_b32 s58, s55, s56
s_add_u32 s25, s25, s58
M a[140:143], a[180:183], a[228:231], a[140:143]
M a[144:147], a[188:191], a[228:231], a[144:147]
M a[144:147], a[184:187], a[224:227], a[144:147]
M a[148:151], a[192:195], a[224:227], a[148:151]
s_waitcnt vmcnt(12) lgkmcnt(0)
s_barrier
ds_read_b128 a[248:251], v10 offset:0
ds_read_b128 a[252:255], v11 offset:0
s_cmp_lg_u32 s101, 0
s_cbranch_scc1 Lk1_arr
v_mov_b32 v127, 1
s_and_b32 s41, s2, 128
s_mov_b64 exec, 1
buffer_atomic_add v127, off, s[36:39], s41 sc1
s_mov_b64 exec, -1
Lk1_arr:
M a[148:151], a[196:199], a[228:231], a[148:151]
s_add_u32 m0, s28, 131072
s_nop 0
buffer_load_dword v20, s[8:11], s24 offen lds
M a[152:155], a[180:183], a[236:239], a[152:155]
ds_read_b128 a[224:227], v10 offset:2048
ds_read_b128 a[228:231], v11 offset:2048
M a[152:155], a[176:179], a[232:235], a[152:155]
M a[156:159], a[184:187], a[232:235], a[156:159]
buffer_load_dword v23, s[8:11], s24 offen offset:256 lds
M a[156:159], a[188:191], a[236:239], a[156:159]
M a[160:163], a[196:199], a[236:239], a[160:163]
M a[160:163], a[192:195], a[232:235], a[160:163]
s_add_u32 m0, s29, 133120
s_nop 0
buffer_load_dwordx4 v2, s[8:11], s23 offen offset:0 lds
M a[164:167], a[176:179], a[240:243], a[164:167]
ds_read_b128 a[232:235], v10 offset:4096
ds_read_b128 a[236:239], v11 offset:4096
M a[164:167], a[180:183], a[244:247], a[164:167]
M a[168:171], a[188:191], a[244:247], a[168:171]
M a[168:171], a[184:187], a[240:243], a[168:171]
buffer_load_dwordx4 v3, s[8:11], s23 offen offset:1024 lds
M a[172:175], a[192:195], a[240:243], a[172:175]
M a[172:175], a[196:199], a[244:247], a[172:175]
s_waitcnt lgkmcnt(4)
M a[68:71], a[200:203], a[248:251], a[68:71]
ds_read_b128 a[240:243], v10 offset:6144
ds_read_b128 a[244:247], v11 offset:6144
M a[68:71], a[204:207], a[252:255], a[68:71]
buffer_load_dwordx4 v4, s[8:11], s23 offen offset:2048 lds
M a[72:75], a[212:215], a[252:255], a[72:75]
ds_read_b64_tr_b16 a[176:177], v14 offset:0
ds_read_b64_tr_b16 a[178:179], v14 offset:1536
M a[72:75], a[208:211], a[248:251], a[72:75]
M a[76:79], a[216:219], a[248:251], a[76:79]
buffer_load_dwordx4 v5, s[8:11], s23 offen offset:3072 lds
M a[76:79], a[220:223], a[252:255], a[76:79]
s_waitcnt lgkmcnt(6)
M a[80:83], a[204:207], a[228:231], a[80:83]
ds_read_b128 a[248:251], v10 offset:8192
ds_read_b128 a[252:255], v11 offset:8192
M a[80:83], a[200:203], a[224:227], a[80:83]
M a[84:87], a[208:211], a[224:227], a[84:87]
ds_read_b64_tr_b16 a[184:185], v15 offset:0
ds_read_b64_tr_b16 a[186:187], v15 offset:1536
M a[84:87], a[212:215], a[228:231], a[84:87]
s_sub_u32 s31, s31, 1
s_cmp_eq_u32 s31, 0
s_cselect_b32 s58, -1920, s57
s_add_u32 s23, s23, s58
s_add_u32 s24, s24, s58
M a[88:91], a[220:223], a[228:231], a[88:91]
M a[88:91], a[216:219], a[224:227], a[88:91]
s_waitcnt lgkmcnt(8)
M a[92:95], a[200:203], a[232:235], a[92:95]
ds_read_b128 a[224:227], v10 offset:10240
ds_read_b128 a[228:231], v11 offset:10240
M a[92:95], a[204:207], a[236:239], a[92:95]
s_add_u32 m0, s30, 98304
s_nop 0
buffer_load_dwordx4 v6, s[12:15], s25 offen offset:0 lds
M a[96:99], a[212:215], a[236:239], a[96:99]
ds_read_b64_tr_b16 a[192:193], v16 offset:0
ds_read_b64_tr_b16 a[194:195], v16 offset:1536
M a[96:99], a[208:211], a[232:235], a[96:99]
M a[100:103], a[216:219], a[232:235], a[100:103]
buffer_load_dwordx4 v7, s[12:15], s25 offen offset:1024 lds
M a[100:103], a[220:223], a[236:239], a[100:103]
s_waitcnt lgkmcnt(10)
M a[104:107], a[204:207], a[244:247], a[104:107]
ds_read_b128 a[232:235], v10 offset:12288
ds_read_b128 a[236:239], v11 offset:12288
M a[104:107], a[200:203], a[240:243], a[104:107]
M a[108:111], a[208:211], a[240:243], a[108:111]
ds_read_b64_tr_b16 a[180:181], v14 offset:12288
ds_read_b64_tr_b16 a[182:183], v14 offset:13824
M a[108:111], a[212:215], a[244:247], a[108:111]
buffer_load_dwordx4 v8, s[12:15], s25 offen offset:2048 lds
M a[112:115], a[220:223], a[244:247], a[112:115]
M a[112:115], a[216:219], a[240:243], a[112:115]
s_waitcnt lgkmcnt(10)
M a[116:119], a[200:203], a[248:251], a[116:119]
ds_read_b128 a[240:243], v10 offset:14336
ds_read_b128 a[244:247], v11 offset:14336
M a[116:119], a[204:207], a[252:255], a[116:119]
buffer_load_dwordx4 v9, s[12:15], s25 offen offset:3072 lds
M a[120:123], a[212:215], a[252:255], a[120:123]
ds_read_b64_tr_b16 a[188:189], v15 offset:12288
ds_read_b64_tr_b16 a[190:191], v15 offset:13824
M a[120:123], a[208:211], a[248:251], a[120:123]
M a[124:127], a[216:219], a[248:251], a[124:127]
s_add_u32 m0, s30, 102400
s_nop 0
buffer_load_dwordx4 v21, s[12:15], s25 offen offset:0 lds
M a[124:127], a[220:223], a[252:255], a[124:127]
s_waitcnt lgkmcnt(10)
M a[128:131], a[204:207], a[228:231], a[128:131]
ds_read_b128 a[248:251], v10 offset:16384
ds_read_b128 a[252:255], v11 offset:16384
M a[128:131], a[200:203], a[224:227], a[128:131]
M a[132:135], a[208:211], a[224:227], a[132:135]
ds_read_b64_tr_b16 a[196:197], v16 offset:12288
ds_read_b64_tr_b16 a[198:199], v16 offset:13824
M a[132:135], a[212:215], a[228:231], a[132:135]
buffer_load_dwordx4 v22, s[12:15], s25 offen offset:1024 lds
M a[136:139], a[220:223], a[228:231], a[136:139]
M a[136:139], a[216:219], a[224:227], a[136:139]
s_waitcnt lgkmcnt(10)
M a[140:143], a[200:203], a[232:235], a[140:143]
s_sub_u32 s54, s54, 1
s_cmp_eq_u32 s54, 0
s_cselect_b32 s58, s55, s56
s_add_u32 s25, s25, s58
M a[140:143], a[204:207], a[236:239], a[140:143]
M a[144:147], a[212:215], a[236:239], a[144:147]
M a[144:147], a[208:211], a[232:235], a[144:147]
M a[148:151], a[216:219], a[232:235], a[148:151]
s_waitcnt vmcnt(12) lgkmcnt(0)
s_barrier
ds_read_b128 a[224:227], v10 offset:18432
ds_read_b128 a[228:231], v11 offset:18432
M a[148:151], a[220:223], a[236:239], a[148:151]
s_add_u32 m0, s28, 0
s_nop 0
buffer_load_dword v20, s[8:11], s24 offen lds
M a[152:155], a[204:207], a[244:247], a[152:155]
ds_read_b128 a[232:235], v10 offset:20480
ds_read_b128 a[236:239], v11 offset:20480
M a[152:155], a[200:203], a[240:243], a[152:155]
M a[156:159], a[208:211], a[240:243], a[156:159]
buffer_load_dword v23, s[8:11], s24 offen offset:256 lds
M a[156:159], a[212:215], a[244:247], a[156:159]
M a[160:163], a[220:223], a[244:247], a[160:163]
M a[160:163], a[216:219], a[240:243], a[160:163]
s_add_u32 m0, s29, 2048
s_nop 0
buffer_load_dwordx4 v2, s[8:11], s23 offen offset:0 lds
M a[164:167], a[200:203], a[248:251], a[164:167]
ds_read_b128 a[240:243], v10 offset:22528
ds_read_b128 a[244:247], v11 offset:22528
M a[164:167], a[204:207], a[252:255], a[164:167]
M a[168:171], a[212:215], a[252:255], a[168:171]
M a[168:171], a[208:211], a[248:251], a[168:171]
buffer_load_dwordx4 v3, s[8:11], s23 offen offset:1024 lds
M a[172:175], a[216:219], a[248:251], a[172:175]
M a[172:175], a[220:223], a[252:255], a[172:175]
s_waitcnt lgkmcnt(4)
M a[68:71], a[176:179], a[224:227], a[68:71]
ds_read_b128 a[248:251], v10 offset:24576
ds_read_b128 a[252:255], v11 offset:24576
v_mov_b32 v160, 0
v_mov_b32 v161, 0
M a[68:71], a[180:183], a[228:231], a[68:71]
buffer_load_dwordx4 v4, s[8:11], s23 offen offset:2048 lds
M a[72:75], a[188:191], a[228:231], a[72:75]
ds_read_b64_tr_b16 a[200:201], v14 offset:28672
ds_read_b64_tr_b16 a[202:203], v14 offset:30208
v_mov_b32 v162, 0
v_mov_b32 v163, 0
M a[72:75], a[184:187], a[224:227], a[72:75]
M a[76:79], a[192:195], a[224:227], a[76:79]
buffer_load_dwordx4 v5, s[8:11], s23 offen offset:3072 lds
v_mov_b32 v164, 0
v_mov_b32 v165, 0
M a[76:79], a[196:199], a[228:231], a[76:79]
s_waitcnt lgkmcnt(6)
M a[80:83], a[180:183], a[236:239], a[80:83]
ds_read_b128 a[224:227], v10 offset:26624
ds_read_b128 a[228:231], v11 offset:26624
v_mov_b32 v166, 0
v_mov_b32 v167, 0
M a[80:83], a[176:179], a[232:235], a[80:83]
M a[84:87], a[184:187], a[232:235], a[84:87]
ds_read_b64_tr_b16 a[208:209], v15 offset:28672
ds_read_b64_tr_b16 a[210:211], v15 offset:30208
M a[84:87], a[188:191], a[236:239], a[84:87]
s_sub_u32 s31, s31, 1
s_cmp_eq_u32 s31, 0
s_cselect_b32 s58, -1920, s57
s_add_u32 s23, s23, s58
s_add_u32 s24, s24, s58
v_mov_b32 v168, 0
v_mov_b32 v169, 0
M a[88:91], a[196:199], a[236:239], a[88:91]
M a[88:91], a[192:195], a[232:235], a[88:91]
s_waitcnt lgkmcnt(8)
v_mov_b32 v170, 0
v_mov_b32 v171, 0
M a[92:95], a[176:179], a[240:243], a[92:95]
ds_read_b128 a[232:235], v10 offset:28672
ds_read_b128 a[236:239], v11 offset:28672
M a[92:95], a[180:183], a[244:247], a[92:95]
s_add_u32 m0, s30, 36864
s_nop 0
buffer_load_dwordx4 v6, s[12:15], s25 offen offset:0 lds
v_mov_b32 v172, 0
v_mov_b32 v173, 0
M a[96:99], a[188:191], a[244:247], a[96:99]
ds_read_b64_tr_b16 a[216:217], v16 offset:28672
ds_read_b64_tr_b16 a[218:219], v16 offset:30208
M a[96:99], a[184:187], a[240:243], a[96:99]
v_mov_b32 v174, 0
v_mov_b32 v175, 0
M a[100:103], a[192:195], a[240:243], a[100:103]
buffer_load_dwordx4 v7, s[12:15], s25 offen offset:1024 lds
M a[100:103], a[196:199], a[244:247], a[100:103]
s_waitcnt lgkmcnt(10)
M a[104:107], a[180:183], a[252:255], a[104:107]
ds_read_b128 a[240:243], v10 offset:30720
ds_read_b128 a[244:247], v11 offset:30720
v_mov_b32 v176, 0
v_mov_b32 v177, 0
M a[104:107], a[176:179], a[248:251], a[104:107]
M a[108:111], a[184:187], a[248:251], a[108:111]
ds_read_b64_tr_b16 a[204:205], v14 offset:40960
ds_read_b64_tr_b16 a[206:207], v14 offset:42496
v_mov_b32 v178, 0
v_mov_b32 v179, 0
M a[108:111], a[188:191], a[252:255], a[108:111]
buffer_load_dwordx4 v8, s[12:15], s25 offen offset:2048 lds
M a[112:115], a[196:199], a[252:255], a[112:115]
v_mov_b32 v180, 0
v_mov_b32 v181, 0
M a[112:115], a[192:195], a[248:251], a[112:115]
s_waitcnt lgkmcnt(10)
M a[116:119], a[176:179], a[224:227], a[116:119]
ds_read_b128 a[248:251], v10 offset:32768
ds_read_b128 a[252:255], v11 offset:32768
v_mov_b32 v182, 0
v_mov_b32 v183, 0
M a[116:119], a[180:183], a[228:231], a[116:119]
buffer_load_dwordx4 v9, s[12:15], s25 offen offset:3072 lds
M a[120:123], a[188:191], a[228:231], a[120:123]
ds_read_b64_tr_b16 a[212:213], v15 offset:40960
ds_read_b64_tr_b16 a[214:215], v15 offset:42496
M a[120:123], a[184:187], a[224:227], a[120:123]
v_mov_b32 v184, 0
v_mov_b32 v185, 0
M a[124:127], a[192:195], a[224:227], a[124:127]
s_add_u32 m0, s30, 40960
s_nop 0
buffer_load_dwordx4 v21, s[12:15], s25 offen offset:0 lds
M a[124:127], a[196:199], a[228:231], a[124:127]
s_waitcnt lgkmcnt(10)
v_mov_b32 v186, 0
v_mov_b32 v187, 0
M a[128:131], a[180:183], a[236:239], a[128:131]
ds_read_b128 a[224:227], v10 offset:34816
ds_read_b128 a[228:231], v11 offset:34816
M a[128:131], a[176:179], a[232:235], a[128:131]
v_mov_b32 v188, 0
v_mov_b32 v189, 0
M a[132:135], a[184:187], a[232:235], a[132:135]
ds_read_b64_tr_b16 a[220:221], v16 offset:40960
ds_read_b64_tr_b16 a[222:223], v16 offset:42496
M a[132:135], a[188:191], a[236:239], a[132:135]
buffer_load_dwordx4 v22, s[12:15], s25 offen offset:1024 lds
v_mov_b32 v190, 0
v_mov_b32 v191, 0
M a[136:139], a[196:199], a[236:239], a[136:139]
M a[136:139], a[192:195], a[232:235], a[136:139]
s_waitcnt lgkmcnt(10)
M a[140:143], a[176:179], a[240:243], a[140:143]
s_sub_u32 s54, s54, 1
s_cmp_eq_u32 s54, 0
s_cselect_b32 s58, s55, s56
s_add_u32 s25, s25, s58
v_mov_b32 v192, 0
v_mov_b32 v193, 0
M a[140:143], a[180:183], a[244:247], a[140:143]
M a[144:147], a[188:191], a[244:247], a[144:147]
v_mov_b32 v194, 0
v_mov_b32 v195, 0
M a[144:147], a[184:187], a[240:243], a[144:147]
M a[148:151], a[192:195], a[240:243], a[148:151]
s_waitcnt vmcnt(12) lgkmcnt(0)
s_barrier
ds_read_b128 a[232:235], v12 offset:0
ds_read_b128 a[236:239], v13 offset:0
v_mov_b32 v196, 0
v_mov_b32 v197, 0
M a[148:151], a[196:199], a[244:247], a[148:151]
s_add_u32 m0, s28, 18432
s_nop 0
buffer_load_dword v20, s[8:11], s24 offen lds
M a[152:155], a[180:183], a[252:255], a[152:155]
ds_read_b128 a[240:243], v12 offset:2048
ds_read_b128 a[244:247], v13 offset:2048
v_mov_b32 v198, 0
v_mov_b32 v199, 0
M a[152:155], a[176:179], a[248:251], a[152:155]
M a[156:159], a[184:187], a[248:251], a[156:159]
buffer_load_dword v23, s[8:11], s24 offen offset:256 lds
M a[156:159], a[188:191], a[252:255], a[156:159]
v_mov_b32 v200, 0
v_mov_b32 v201, 0
M a[160:163], a[196:199], a[252:255], a[160:163]
M a[160:163], a[192:195], a[248:251], a[160:163]
s_add_u32 m0, s29, 20480
s_nop 0
buffer_load_dwordx4 v2, s[8:11], s23 offen offset:0 lds
v_mov_b32 v202, 0
v_mov_b32 v203, 0
M a[164:167], a[176:179], a[224:227], a[164:167]
ds_read_b128 a[248:251], v12 offset:4096
ds_read_b128 a[252:255], v13 offset:4096
M a[164:167], a[180:183], a[228:231], a[164:167]
v_mov_b32 v204, 0
v_mov_b32 v205, 0
M a[168:171], a[188:191], a[228:231], a[168:171]
M a[168:171], a[184:187], a[224:227], a[168:171]
buffer_load_dwordx4 v3, s[8:11], s23 offen offset:1024 lds
v_mov_b32 v206, 0
v_mov_b32 v207, 0
M a[172:175], a[192:195], a[224:227], a[172:175]
M a[172:175], a[196:199], a[228:231], a[172:175]
s_waitcnt lgkmcnt(4)
M a[68:71], a[200:203], a[232:235], a[68:71]
ds_read_b128 a[224:227], v12 offset:6144
ds_read_b128 a[228:231], v13 offset:6144
v_and_b32 v128, 15, v0
v_mul_u32_u24 v128, 400, v128
M a[68:71], a[204:207], a[236:239], a[68:71]
buffer_load_dwordx4 v4, s[8:11], s23 offen offset:2048 lds
M a[72:75], a[212:215], a[236:239], a[72:75]
ds_read_b64_tr_b16 a[176:177], v17 offset:0
ds_read_b64_tr_b16 a[178:179], v17 offset:1536
v_lshrrev_b32 v129, 4, v0
v_lshl_add_u32 v128, v129, 3, v128
M a[72:75], a[208:211], a[232:235], a[72:75]
M a[76:79], a[216:219], a[232:235], a[76:79]
buffer_load_dwordx4 v5, s[8:11], s23 offen offset:3072 lds
s_mul_i32 s3, s20, 96
s_add_u32 s3, s3, 98304
M a[76:79], a[220:223], a[236:239], a[76:79]
s_waitcnt lgkmcnt(6)
M a[80:83], a[204:207], a[244:247], a[80:83]
ds_read_b128 a[232:235], v12 offset:8192
ds_read_b128 a[236:239], v13 offset:8192
v_add_u32 v124, s3, v128
v_and_b32 v128, 15, v0
M a[80:83], a[200:203], a[240:243], a[80:83]
M a[84:87], a[208:211], a[240:243], a[84:87]
ds_read_b64_tr_b16 a[184:185], v18 offset:0
ds_read_b64_tr_b16 a[186:187], v18 offset:1536
v_lshrrev_b32 v129, 4, v0
s_add_u32 s3, s21, 16
M a[84:87], a[212:215], a[244:247], a[84:87]
s_sub_u32 s31, s31, 1
s_cmp_eq_u32 s31, 0
s_cselect_b32 s58, -1920, s57
s_add_u32 s23, s23, s58
s_add_u32 s24, s24, s58
M a[88:91], a[220:223], a[244:247], a[88:91]
v_lshl_add_u32 v130, v128, 1, s3
s_lshl_b32 s4, s22, 6
M a[88:91], a[216:219], a[240:243], a[88:91]
s_waitcnt lgkmcnt(8)
M a[92:95], a[200:203], a[248:251], a[92:95]
ds_read_b128 a[240:243], v12 offset:10240
ds_read_b128 a[244:247], v13 offset:10240
s_add_u32 s4, s4, 98304
v_mul_u32_u24 v120, 400, v130
M a[92:95], a[204:207], a[252:255], a[92:95]
s_add_u32 m0, s30, 65536
s_nop 0
buffer_load_dwordx4 v6, s[12:15], s25 offen offset:0 lds
M a[96:99], a[212:215], a[252:255], a[96:99]
ds_read_b64_tr_b16 a[192:193], v19 offset:0
ds_read_b64_tr_b16 a[194:195], v19 offset:1536
M a[96:99], a[208:211], a[248:251], a[96:99]
v_lshl_add_u32 v120, v129, 4, v120
v_add_u32 v120, s4, v120
M a[100:103], a[216:219], a[248:251], a[100:103]
buffer_load_dwordx4 v7, s[12:15], s25 offen offset:1024 lds
M a[100:103], a[220:223], a[252:255], a[100:103]
s_waitcnt lgkmcnt(10)
v_subrev_u32 v130, 32, v130
v_max_i32 v130, 0, v130
M a[104:107], a[204:207], a[228:231], a[104:107]
ds_read_b128 a[248:251], v12 offset:12288
ds_read_b128 a[252:255], v13 offset:12288
M a[104:107], a[200:203], a[224:227], a[104:107]
v_mul_u32_u24 v121, 400, v130
v_lshl_add_u32 v121, v129, 4, v121
M a[108:111], a[208:211], a[224:227], a[108:111]
ds_read_b64_tr_b16 a[180:181], v17 offset:12288
ds_read_b64_tr_b16 a[182:183], v17 offset:13824
M a[108:111], a[212:215], a[228:231], a[108:111]
buffer_load_dwordx4 v8, s[12:15], s25 offen offset:2048 lds
v_add_u32 v121, s4, v121
v_bfe_u32 v131, v0, 2, 2
M a[112:115], a[220:223], a[228:231], a[112:115]
M a[112:115], a[216:219], a[224:227], a[112:115]
s_waitcnt lgkmcnt(10)
v_lshl_add_u32 v131, v129, 2, v131
v_lshl_add_u32 v131, v131, 1, s3
M a[116:119], a[200:203], a[232:235], a[116:119]
ds_read_b128 a[224:227], v12 offset:14336
ds_read_b128 a[228:231], v13 offset:14336
M a[116:119], a[204:207], a[236:239], a[116:119]
buffer_load_dwordx4 v9, s[12:15], s25 offen offset:3072 lds
v_and_b32 v132, 3, v0
v_lshlrev_b32 v132, 3, v132
M a[120:123], a[212:215], a[236:239], a[120:123]
ds_read_b64_tr_b16 a[188:189], v18 offset:12288
ds_read_b64_tr_b16 a[190:191], v18 offset:13824
M a[120:123], a[208:211], a[232:235], a[120:123]
M a[124:127], a[216:219], a[232:235], a[124:127]
s_add_u32 m0, s30, 69632
s_nop 0
buffer_load_dwordx4 v21, s[12:15], s25 offen offset:0 lds
v_add_u32 v132, s4, v132
s_movk_i32 s5, 400
M a[124:127], a[220:223], a[236:239], a[124:127]
s_waitcnt lgkmcnt(10)
M a[128:131], a[204:207], a[244:247], a[128:131]
ds_read_b128 a[232:235], v12 offset:16384
ds_read_b128 a[236:239], v13 offset:16384
v_mad_u32_u24 v122, v131, s5, v132
v_subrev_u32 v131, 32, v131
M a[128:131], a[200:203], a[240:243], a[128:131]
M a[132:135], a[208:211], a[240:243], a[132:135]
ds_read_b64_tr_b16 a[196:197], v19 offset:12288
ds_read_b64_tr_b16 a[198:199], v19 offset:13824
v_max_i32 v131, 0, v131
v_mad_u32_u24 v123, v131, s5, v132
M a[132:135], a[212:215], a[244:247], a[132:135]
buffer_load_dwordx4 v22, s[12:15], s25 offen offset:1024 lds
M a[136:139], a[220:223], a[244:247], a[136:139]
v_lshlrev_b32 v129, 2, v129
v_sub_u32 v128, v128, v129
M a[136:139], a[216:219], a[240:243], a[136:139]
s_waitcnt lgkmcnt(10)
M a[140:143], a[200:203], a[248:251], a[140:143]
s_sub_u32 s54, s54, 1
s_cmp_eq_u32 s54, 0
s_cselect_b32 s58, s55, s56
s_add_u32 s25, s25, s58
v_mov_b32 v129, 0xf149f2ca
s_cmp_eq_u32 s26, 0
s_cselect_b32 s3, 0xf149f2ca, 0
M a[140:143], a[204:207], a[252:255], a[140:143]
M a[144:147], a[212:215], a[252:255], a[144:147]
v_cmp_lt_i32 vcc, -9, v128
s_nop 1
v_cndmask_b32 v144, 0, v129, vcc
M a[144:147], a[208:211], a[248:251], a[144:147]
M a[148:151], a[216:219], a[248:251], a[148:151]
s_waitcnt vmcnt(12) lgkmcnt(0)
s_barrier
ds_read_b128 a[240:243], v10 offset:0
ds_read_b128 a[244:247], v11 offset:0
M a[148:151], a[220:223], a[252:255], a[148:151]
s_add_u32 m0, s28, 131072
s_nop 0
buffer_load_dword v20, s[8:11], s24 offen lds
v_subrev_u32 v130, 0, v128
v_cmp_lt_u32 vcc, 7, v130
s_nop 1
v_cndmask_b32 v148, 0, v129, vcc
M a[152:155], a[204:207], a[228:231], a[152:155]
ds_read_b128 a[248:251], v10 offset:2048
ds_read_b128 a[252:255], v11 offset:2048
M a[152:155], a[200:203], a[224:227], a[152:155]
v_min_f32 v152, s3, v144
v_mov_b32 v156, 0x3f803f80
M a[156:159], a[208:211], a[224:227], a[156:159]
buffer_load_dword v23, s[8:11], s24 offen offset:256 lds
M a[156:159], a[212:215], a[228:231], a[156:159]
v_cmp_lt_i32 vcc, -8, v128
s_nop 1
v_cndmask_b32 v145, 0, v129, vcc
M a[160:163], a[220:223], a[228:231], a[160:163]
M a[160:163], a[216:219], a[224:227], a[160:163]
s_add_u32 m0, s29, 133120
s_nop 0
buffer_load_dwordx4 v2, s[8:11], s23 offen offset:0 lds
v_subrev_u32 v130, 1, v128
v_cmp_lt_u32 vcc, 7, v130
s_nop 1
v_cndmask_b32 v149, 0, v129, vcc
M a[164:167], a[200:203], a[232:235], a[164:167]
ds_read_b128 a[224:227], v10 offset:4096
ds_read_b128 a[228:231], v11 offset:4096
M a[164:167], a[204:207], a[236:239], a[164:167]
v_min_f32 v153, s3, v145
v_mov_b32 v157, 0x3f803f80
M a[168:171], a[212:215], a[236:239], a[168:171]
M a[168:171], a[208:211], a[232:235], a[168:171]
buffer_load_dwordx4 v3, s[8:11], s23 offen offset:1024 lds
v_cmp_lt_i32 vcc, -7, v128
s_nop 1
v_cndmask_b32 v146, 0, v129, vcc
M a[172:175], a[216:219], a[232:235], a[172:175]
M a[172:175], a[220:223], a[236:239], a[172:175]
s_waitcnt lgkmcnt(4)
M a[68:71], a[176:179], a[240:243], a[68:71]
ds_read_b128 a[232:235], v10 offset:6144
ds_read_b128 a[236:239], v11 offset:6144
v_subrev_u32 v130, 2, v128
v_cmp_lt_u32 vcc, 7, v130
s_nop 1
v_cndmask_b32 v150, 0, v129, vcc
M a[68:71], a[180:183], a[244:247], a[68:71]
buffer_load_dwordx4 v4, s[8:11], s23 offen offset:2048 lds
v_min_f32 v154, s3, v146
v_mov_b32 v158, 0x3f803f80
M a[72:75], a[188:191], a[244:247], a[72:75]
ds_read_b64_tr_b16 a[200:201], v14 offset:0
ds_read_b64_tr_b16 a[202:203], v14 offset:1536
M a[72:75], a[184:187], a[240:243], a[72:75]
v_cmp_lt_i32 vcc, -6, v128
s_nop 1
v_cndmask_b32 v147, 0, v129, vcc
M a[76:79], a[192:195], a[240:243], a[76:79]
buffer_load_dwordx4 v5, s[8:11], s23 offen offset:3072 lds
v_subrev_u32 v130, 3, v128
v_cmp_lt_u32 vcc, 7, v130
s_nop 1
v_cndmask_b32 v151, 0, v129, vcc
M a[76:79], a[196:199], a[244:247], a[76:79]
s_waitcnt lgkmcnt(6)
M a[80:83], a[180:183], a[252:255], a[80:83]
ds_read_b128 a[240:243], v10 offset:8192
ds_read_b128 a[244:247], v11 offset:8192
v_min_f32 v155, s3, v147
v_mov_b32 v159, 0x3f803f80
M a[80:83], a[176:179], a[248:251], a[80:83]
s_add_u32 s16, s50, 83886080
s_addc_u32 s17, s51, 0
M a[84:87], a[184:187], a[248:251], a[84:87]
ds_read_b64_tr_b16 a[208:209], v15 offset:0
ds_read_b64_tr_b16 a[210:211], v15 offset:1536
M a[84:87], a[188:191], a[252:255], a[84:87]
s_sub_u32 s31, s31, 1
s_cmp_eq_u32 s31, 0
s_cselect_b32 s58, -1920, s57
s_add_u32 s23, s23, s58
s_add_u32 s24, s24, s58
s_mov_b32 s18, 4194304
s_mov_b32 s19, 0x00020000
M a[88:91], a[196:199], a[252:255], a[88:91]
s_lshl_b32 s3, s26, 18
s_lshl_b32 s4, s27, 14
M a[88:91], a[192:195], a[248:251], a[88:91]
s_waitcnt lgkmcnt(8)
M a[92:95], a[176:179], a[224:227], a[92:95]
ds_read_b128 a[248:251], v10 offset:10240
ds_read_b128 a[252:255], v11 offset:10240
s_add_u32 s3, s3, s4
s_lshl_b32 s4, s21, 13
M a[92:95], a[180:183], a[228:231], a[92:95]
s_add_u32 m0, s30, 98304
s_nop 0
buffer_load_dwordx4 v6, s[12:15], s25 offen offset:0 lds
s_add_u32 s3, s3, s4
s_lshl_b32 s4, s22, 10
M a[96:99], a[188:191], a[228:231], a[96:99]
ds_read_b64_tr_b16 a[216:217], v16 offset:0
ds_read_b64_tr_b16 a[218:219], v16 offset:1536
M a[96:99], a[184:187], a[224:227], a[96:99]
s_add_u32 s6, s3, s4
s_mov_b32 s7, 0x3e8293ee
M a[100:103], a[192:195], a[224:227], a[100:103]
buffer_load_dwordx4 v7, s[12:15], s25 offen offset:1024 lds
s_lshl_b32 s65, s26, 8
s_lshl_b32 s3, s27, 4
M a[100:103], a[196:199], a[228:231], a[100:103]
s_waitcnt lgkmcnt(10)
M a[104:107], a[180:183], a[236:239], a[104:107]
ds_read_b128 a[224:227], v10 offset:12288
ds_read_b128 a[228:231], v11 offset:12288
s_add_u32 s65, s65, s3
s_lshl_b32 s3, s101, 2
M a[104:107], a[176:179], a[232:235], a[104:107]
s_add_u32 s65, s65, s3
s_add_u32 s65, s65, 8400896
M a[108:111], a[184:187], a[232:235], a[108:111]
ds_read_b64_tr_b16 a[204:205], v14 offset:12288
ds_read_b64_tr_b16 a[206:207], v14 offset:13824
M a[108:111], a[188:191], a[236:239], a[108:111]
buffer_load_dwordx4 v8, s[12:15], s25 offen offset:2048 lds
s_mov_b32 s40, 0
v_mov_b32 v119, 0
M a[112:115], a[196:199], a[236:239], a[112:115]
s_mov_b64 s[4:5], s[50:51]
s_and_b32 s20, s2, 7
M a[112:115], a[192:195], a[232:235], a[112:115]
s_waitcnt lgkmcnt(10)
M a[116:119], a[176:179], a[240:243], a[116:119]
ds_read_b128 a[232:235], v10 offset:14336
ds_read_b128 a[236:239], v11 offset:14336
s_lshr_b32 s33, s2, 6
s_lshl_b32 s33, s33, 3
M a[116:119], a[180:183], a[244:247], a[116:119]
buffer_load_dwordx4 v9, s[12:15], s25 offen offset:3072 lds
s_add_u32 s20, s20, s33
s_bfe_u32 s21, s2, 0x30003
M a[120:123], a[188:191], a[244:247], a[120:123]
ds_read_b64_tr_b16 a[212:213], v15 offset:12288
ds_read_b64_tr_b16 a[214:215], v15 offset:13824
M a[120:123], a[184:187], a[240:243], a[120:123]
s_sub_u32 s35, 15, s21
s_cmp_lt_u32 s101, 2
s_cselect_b32 s35, s21, s35
M a[124:127], a[192:195], a[240:243], a[124:127]
s_add_u32 m0, s30, 102400
s_nop 0
buffer_load_dwordx4 v21, s[12:15], s25 offen offset:0 lds
s_lshl_b32 s33, s20, 7
s_lshl_b32 s34, s35, 3
M a[124:127], a[196:199], a[244:247], a[124:127]
s_waitcnt lgkmcnt(10)
M a[128:131], a[180:183], a[252:255], a[128:131]
ds_read_b128 a[240:243], v10 offset:16384
ds_read_b128 a[244:247], v11 offset:16384
s_add_u32 s33, s33, s34
s_and_b32 s34, s101, 1
M a[128:131], a[176:179], a[248:251], a[128:131]
s_lshl_b32 s34, s34, 2
s_add_u32 s33, s33, s34
M a[132:135], a[184:187], a[248:251], a[132:135]
ds_read_b64_tr_b16 a[220:221], v16 offset:12288
ds_read_b64_tr_b16 a[222:223], v16 offset:13824
M a[132:135], a[188:191], a[252:255], a[132:135]
buffer_load_dwordx4 v22, s[12:15], s25 offen offset:1024 lds
s_lshl_b32 s64, s33, 12
s_mov_b32 s44, s4
M a[136:139], a[196:199], a[252:255], a[136:139]
s_mov_b32 s45, s5
s_mov_b32 s46, 16777216
M a[136:139], a[192:195], a[248:251], a[136:139]
s_waitcnt lgkmcnt(10)
M a[140:143], a[176:179], a[224:227], a[140:143]
s_sub_u32 s54, s54, 1
s_cmp_eq_u32 s54, 0
s_cselect_b32 s58, s55, s56
s_add_u32 s25, s25, s58
s_mov_b32 s47, 0x00020000
M a[140:143], a[180:183], a[228:231], a[140:143]
M a[144:147], a[188:191], a[228:231], a[144:147]
M a[144:147], a[184:187], a[224:227], a[144:147]
M a[148:151], a[192:195], a[224:227], a[148:151]
s_waitcnt vmcnt(12) lgkmcnt(0)
s_barrier
ds_read_b128 a[248:251], v10 offset:18432
ds_read_b128 a[252:255], v11 offset:18432
M a[148:151], a[196:199], a[228:231], a[148:151]
s_add_u32 m0, s28, 0
s_nop 0
buffer_load_dword v20, s[8:11], s24 offen lds
M a[152:155], a[180:183], a[236:239], a[152:155]
ds_read_b128 a[224:227], v10 offset:20480
ds_read_b128 a[228:231], v11 offset:20480
M a[152:155], a[176:179], a[232:235], a[152:155]
M a[156:159], a[184:187], a[232:235], a[156:159]
buffer_load_dword v23, s[8:11], s24 offen offset:256 lds
M a[156:159], a[188:191], a[236:239], a[156:159]
M a[160:163], a[196:199], a[236:239], a[160:163]
M a[160:163], a[192:195], a[232:235], a[160:163]
s_add_u32 m0, s29, 2048
s_nop 0
buffer_load_dwordx4 v2, s[8:11], s23 offen offset:0 lds
M a[164:167], a[176:179], a[240:243], a[164:167]
ds_read_b128 a[232:235], v10 offset:22528
ds_read_b128 a[236:239], v11 offset:22528
M a[164:167], a[180:183], a[244:247], a[164:167]
M a[168:171], a[188:191], a[244:247], a[168:171]
M a[168:171], a[184:187], a[240:243], a[168:171]
buffer_load_dwordx4 v3, s[8:11], s23 offen offset:1024 lds
M a[172:175], a[192:195], a[240:243], a[172:175]
M a[172:175], a[196:199], a[244:247], a[172:175]
s_waitcnt lgkmcnt(4)
M a[68:71], a[200:203], a[248:251], a[68:71]
ds_read_b128 a[240:243], v10 offset:24576
ds_read_b128 a[244:247], v11 offset:24576
M a[68:71], a[204:207], a[252:255], a[68:71]
buffer_load_dwordx4 v4, s[8:11], s23 offen offset:2048 lds
M a[72:75], a[212:215], a[252:255], a[72:75]
ds_read_b64_tr_b16 a[176:177], v14 offset:28672
ds_read_b64_tr_b16 a[178:179], v14 offset:30208
M a[72:75], a[208:211], a[248:251], a[72:75]
M a[76:79], a[216:219], a[248:251], a[76:79]
buffer_load_dwordx4 v5, s[8:11], s23 offen offset:3072 lds
M a[76:79], a[220:223], a[252:255], a[76:79]
s_waitcnt lgkmcnt(6)
M a[80:83], a[204:207], a[228:231], a[80:83]
ds_read_b128 a[248:251], v10 offset:26624
ds_read_b128 a[252:255], v11 offset:26624
M a[80:83], a[200:203], a[224:227], a[80:83]
M a[84:87], a[208:211], a[224:227], a[84:87]
ds_read_b64_tr_b16 a[184:185], v15 offset:28672
ds_read_b64_tr_b16 a[186:187], v15 offset:30208
M a[84:87], a[212:215], a[228:231], a[84:87]
s_sub_u32 s31, s31, 1
s_cmp_eq_u32 s31, 0
s_cselect_b32 s58, -1920, s57
s_add_u32 s23, s23, s58
s_add_u32 s24, s24, s58
M a[88:91], a[220:223], a[228:231], a[88:91]
M a[88:91], a[216:219], a[224:227], a[88:91]
s_waitcnt lgkmcnt(8)
M a[92:95], a[200:203], a[232:235], a[92:95]
ds_read_b128 a[224:227], v10 offset:28672
ds_read_b128 a[228:231], v11 offset:28672
M a[92:95], a[204:207], a[236:239], a[92:95]
s_add_u32 m0, s30, 36864
s_nop 0
buffer_load_dwordx4 v6, s[12:15], s25 offen offset:0 lds
M a[96:99], a[212:215], a[236:239], a[96:99]
ds_read_b64_tr_b16 a[192:193], v16 offset:28672
ds_read_b64_tr_b16 a[194:195], v16 offset:30208
M a[96:99], a[208:211], a[232:235], a[96:99]
M a[100:103], a[216:219], a[232:235], a[100:103]
buffer_load_dwordx4 v7, s[12:15], s25 offen offset:1024 lds
M a[100:103], a[220:223], a[236:239], a[100:103]
s_waitcnt lgkmcnt(10)
M a[104:107], a[204:207], a[244:247], a[104:107]
ds_read_b128 a[232:235], v10 offset:30720
ds_read_b128 a[236:239], v11 offset:30720
M a[104:107], a[200:203], a[240:243], a[104:107]
M a[108:111], a[208:211], a[240:243], a[108:111]
ds_read_b64_tr_b16 a[180:181], v14 offset:40960
ds_read_b64_tr_b16 a[182:183], v14 offset:42496
M a[108:111], a[212:215], a[244:247], a[108:111]
buffer_load_dwordx4 v8, s[12:15], s25 offen offset:2048 lds
M a[112:115], a[220:223], a[244:247], a[112:115]
M a[112:115], a[216:219], a[240:243], a[112:115]
s_waitcnt lgkmcnt(10)
M a[116:119], a[200:203], a[248:251], a[116:119]
ds_read_b128 a[240:243], v10 offset:32768
ds_read_b128 a[244:247], v11 offset:32768
M a[116:119], a[204:207], a[252:255], a[116:119]
buffer_load_dwordx4 v9, s[12:15], s25 offen offset:3072 lds
M a[120:123], a[212:215], a[252:255], a[120:123]
ds_read_b64_tr_b16 a[188:189], v15 offset:40960
ds_read_b64_tr_b16 a[190:191], v15 offset:42496
M a[120:123], a[208:211], a[248:251], a[120:123]
M a[124:127], a[216:219], a[248:251], a[124:127]
s_add_u32 m0, s30, 40960
s_nop 0
buffer_load_dwordx4 v21, s[12:15], s25 offen offset:0 lds
M a[124:127], a[220:223], a[252:255], a[124:127]
s_waitcnt lgkmcnt(10)
M a[128:131], a[204:207], a[228:231], a[128:131]
ds_read_b128 a[248:251], v10 offset:34816
ds_read_b128 a[252:255], v11 offset:34816
M a[128:131], a[200:203], a[224:227], a[128:131]
M a[132:135], a[208:211], a[224:227], a[132:135]
ds_read_b64_tr_b16 a[196:197], v16 offset:40960
ds_read_b64_tr_b16 a[198:199], v16 offset:42496
M a[132:135], a[212:215], a[228:231], a[132:135]
buffer_load_dwordx4 v22, s[12:15], s25 offen offset:1024 lds
M a[136:139], a[220:223], a[228:231], a[136:139]
M a[136:139], a[216:219], a[224:227], a[136:139]
s_waitcnt lgkmcnt(10)
M a[140:143], a[200:203], a[232:235], a[140:143]
s_sub_u32 s54, s54, 1
s_cmp_eq_u32 s54, 0
s_cselect_b32 s58, s55, s56
s_add_u32 s25, s25, s58
M a[140:143], a[204:207], a[236:239], a[140:143]
M a[144:147], a[212:215], a[236:239], a[144:147]
M a[144:147], a[208:211], a[232:235], a[144:147]
M a[148:151], a[216:219], a[232:235], a[148:151]
s_waitcnt vmcnt(12) lgkmcnt(0)
s_barrier
ds_read_b128 a[224:227], v12 offset:0
ds_read_b128 a[228:231], v13 offset:0
M a[148:151], a[220:223], a[236:239], a[148:151]
s_add_u32 m0, s28, 18432
s_nop 0
buffer_load_dword v20, s[8:11], s24 offen lds
M a[152:155], a[204:207], a[244:247], a[152:155]
ds_read_b128 a[232:235], v12 offset:2048
ds_read_b128 a[236:239], v13 offset:2048
M a[152:155], a[200:203], a[240:243], a[152:155]
M a[156:159], a[208:211], a[240:243], a[156:159]
buffer_load_dword v23, s[8:11], s24 offen offset:256 lds
M a[156:159], a[212:215], a[244:247], a[156:159]
M a[160:163], a[220:223], a[244:247], a[160:163]
M a[160:163], a[216:219], a[240:243], a[160:163]
s_add_u32 m0, s29, 20480
s_nop 0
buffer_load_dwordx4 v2, s[8:11], s23 offen offset:0 lds
M a[164:167], a[200:203], a[248:251], a[164:167]
ds_read_b128 a[240:243], v12 offset:4096
ds_read_b128 a[244:247], v13 offset:4096
M a[164:167], a[204:207], a[252:255], a[164:167]
M a[168:171], a[212:215], a[252:255], a[168:171]
M a[168:171], a[208:211], a[248:251], a[168:171]
buffer_load_dwordx4 v3, s[8:11], s23 offen offset:1024 lds
M a[172:175], a[216:219], a[248:251], a[172:175]
M a[172:175], a[220:223], a[252:255], a[172:175]
s_waitcnt lgkmcnt(4)
M a[68:71], a[176:179], a[224:227], a[68:71]
ds_read_b128 a[248:251], v12 offset:6144
ds_read_b128 a[252:255], v13 offset:6144
M a[68:71], a[180:183], a[228:231], a[68:71]
buffer_load_dwordx4 v4, s[8:11], s23 offen offset:2048 lds
M a[72:75], a[188:191], a[228:231], a[72:75]
ds_read_b64_tr_b16 a[200:201], v17 offset:0
ds_read_b64_tr_b16 a[202:203], v17 offset:1536
M a[72:75], a[184:187], a[224:227], a[72:75]
M a[76:79], a[192:195], a[224:227], a[76:79]
buffer_load_dwordx4 v5, s[8:11], s23 offen offset:3072 lds
M a[76:79], a[196:199], a[228:231], a[76:79]
s_waitcnt lgkmcnt(6)
M a[80:83], a[180:183], a[236:239], a[80:83]
ds_read_b128 a[224:227], v12 offset:8192
ds_read_b128 a[228:231], v13 offset:8192
M a[80:83], a[176:179], a[232:235], a[80:83]
s_sub_u32 s31, s31, 1
s_cmp_eq_u32 s31, 0
s_cselect_b32 s58, -1920, s57
s_add_u32 s23, s23, s58
s_add_u32 s24, s24, s58
M a[84:87], a[184:187], a[232:235], a[84:87]
ds_read_b64_tr_b16 a[208:209], v18 offset:0
ds_read_b64_tr_b16 a[210:211], v18 offset:1536
M a[84:87], a[188:191], a[236:239], a[84:87]
M a[88:91], a[196:199], a[236:239], a[88:91]
M a[88:91], a[192:195], a[232:235], a[88:91]
s_add_u32 m0, s30, 65536
s_nop 0
buffer_load_dwordx4 v6, s[12:15], s25 offen offset:0 lds
s_waitcnt lgkmcnt(8)
M a[92:95], a[176:179], a[240:243], a[92:95]
ds_read_b128 a[232:235], v12 offset:10240
ds_read_b128 a[236:239], v13 offset:10240
M a[92:95], a[180:183], a[244:247], a[92:95]
M a[96:99], a[188:191], a[244:247], a[96:99]
ds_read_b64_tr_b16 a[216:217], v19 offset:0
ds_read_b64_tr_b16 a[218:219], v19 offset:1536
M a[96:99], a[184:187], a[240:243], a[96:99]
buffer_load_dwordx4 v7, s[12:15], s25 offen offset:1024 lds
M a[100:103], a[192:195], a[240:243], a[100:103]
M a[100:103], a[196:199], a[244:247], a[100:103]
s_waitcnt lgkmcnt(10)
M a[104:107], a[180:183], a[252:255], a[104:107]
ds_read_b128 a[240:243], v12 offset:12288
ds_read_b128 a[244:247], v13 offset:12288
M a[104:107], a[176:179], a[248:251], a[104:107]
buffer_load_dwordx4 v8, s[12:15], s25 offen offset:2048 lds
M a[108:111], a[184:187], a[248:251], a[108:111]
ds_read_b64_tr_b16 a[204:205], v17 offset:12288
ds_read_b64_tr_b16 a[206:207], v17 offset:13824
M a[108:111], a[188:191], a[252:255], a[108:111]
M a[112:115], a[196:199], a[252:255], a[112:115]
buffer_load_dwordx4 v9, s[12:15], s25 offen offset:3072 lds
M a[112:115], a[192:195], a[248:251], a[112:115]
s_waitcnt lgkmcnt(10)
M a[116:119], a[176:179], a[224:227], a[116:119]
ds_read_b128 a[248:251], v12 offset:14336
ds_read_b128 a[252:255], v13 offset:14336
M a[116:119], a[180:183], a[228:231], a[116:119]
M a[120:123], a[188:191], a[228:231], a[120:123]
ds_read_b64_tr_b16 a[212:213], v18 offset:12288
ds_read_b64_tr_b16 a[214:215], v18 offset:13824
M a[120:123], a[184:187], a[224:227], a[120:123]
s_add_u32 m0, s30, 69632
s_nop 0
buffer_load_dwordx4 v21, s[12:15], s25 offen offset:0 lds
M a[124:127], a[192:195], a[224:227], a[124:127]
M a[124:127], a[196:199], a[228:231], a[124:127]
buffer_load_dwordx4 v22, s[12:15], s25 offen offset:1024 lds
s_waitcnt lgkmcnt(10)
M a[128:131], a[180:183], a[236:239], a[128:131]
ds_read_b128 a[224:227], v12 offset:16384
ds_read_b128 a[228:231], v13 offset:16384
M a[128:131], a[176:179], a[232:235], a[128:131]
M a[132:135], a[184:187], a[232:235], a[132:135]
ds_read_b64_tr_b16 a[220:221], v19 offset:12288
ds_read_b64_tr_b16 a[222:223], v19 offset:13824
M a[132:135], a[188:191], a[236:239], a[132:135]
M a[136:139], a[196:199], a[236:239], a[136:139]
s_sub_u32 s54, s54, 1
s_cmp_eq_u32 s54, 0
s_cselect_b32 s58, s55, s56
s_add_u32 s25, s25, s58
M a[136:139], a[192:195], a[232:235], a[136:139]
s_waitcnt lgkmcnt(10)
M a[140:143], a[176:179], a[240:243], a[140:143]
buffer_load_dword v125, v119, s[36:39], 0 offen sc1
M a[140:143], a[180:183], a[244:247], a[140:143]
M a[144:147], a[188:191], a[244:247], a[144:147]
M a[144:147], a[184:187], a[240:243], a[144:147]
M a[148:151], a[192:195], a[240:243], a[148:151]
s_waitcnt vmcnt(13) lgkmcnt(0)
s_barrier
ds_read_b128 a[232:235], v10 offset:0
ds_read_b128 a[236:239], v11 offset:0
s_waitcnt vmcnt(0)
v_cmp_gt_u32 vcc, 0x80, v125
s_nop 0
s_cbranch_vccnz Lk1_spinq
Lk1_gotq:
M a[148:151], a[196:199], a[244:247], a[148:151]
s_add_u32 m0, s28, 131072
s_nop 0
buffer_load_dword v20, s[8:11], s24 offen lds
M a[152:155], a[180:183], a[252:255], a[152:155]
ds_read_b128 a[240:243], v10 offset:2048
ds_read_b128 a[244:247], v11 offset:2048
M a[152:155], a[176:179], a[248:251], a[152:155]
M a[156:159], a[184:187], a[248:251], a[156:159]
buffer_load_dword v23, s[8:11], s24 offen offset:256 lds
M a[156:159], a[188:191], a[252:255], a[156:159]
M a[160:163], a[196:199], a[252:255], a[160:163]
M a[160:163], a[192:195], a[248:251], a[160:163]
s_add_u32 m0, s29, 133120
s_nop 0
buffer_load_dwordx4 v2, s[8:11], s23 offen offset:0 lds
M a[164:167], a[176:179], a[224:227], a[164:167]
ds_read_b128 a[248:251], v10 offset:4096
ds_read_b128 a[252:255], v11 offset:4096
M a[164:167], a[180:183], a[228:231], a[164:167]
M a[168:171], a[188:191], a[228:231], a[168:171]
M a[168:171], a[184:187], a[224:227], a[168:171]
buffer_load_dwordx4 v3, s[8:11], s23 offen offset:1024 lds
M a[172:175], a[192:195], a[224:227], a[172:175]
M a[172:175], a[196:199], a[228:231], a[172:175]
s_waitcnt lgkmcnt(4)
M a[68:71], a[200:203], a[232:235], a[68:71]
ds_read_b128 a[224:227], v10 offset:6144
ds_read_b128 a[228:231], v11 offset:6144
v_mov_b32 v208, 0
v_mov_b32 v209, 0
M a[68:71], a[204:207], a[236:239], a[68:71]
buffer_load_dwordx4 v4, s[8:11], s23 offen offset:2048 lds
M a[72:75], a[212:215], a[236:239], a[72:75]
ds_read_b64_tr_b16 a[176:177], v14 offset:0
ds_read_b64_tr_b16 a[178:179], v14 offset:1536
v_mov_b32 v210, 0
v_mov_b32 v211, 0
M a[72:75], a[208:211], a[232:235], a[72:75]
M a[76:79], a[216:219], a[232:235], a[76:79]
buffer_load_dwordx4 v5, s[8:11], s23 offen offset:3072 lds
v_mov_b32 v212, 0
v_mov_b32 v213, 0
M a[76:79], a[220:223], a[236:239], a[76:79]
s_waitcnt lgkmcnt(6)
M a[80:83], a[204:207], a[244:247], a[80:83]
ds_read_b128 a[232:235], v10 offset:8192
ds_read_b128 a[236:239], v11 offset:8192
v_mov_b32 v214, 0
v_mov_b32 v215, 0
M a[80:83], a[200:203], a[240:243], a[80:83]
s_sub_u32 s31, s31, 1
s_cmp_eq_u32 s31, 0
s_cselect_b32 s58, -1920, s57
s_add_u32 s23, s23, s58
s_add_u32 s24, s24, s58
M a[84:87], a[208:211], a[240:243], a[84:87]
ds_read_b64_tr_b16 a[184:185], v15 offset:0
ds_read_b64_tr_b16 a[186:187], v15 offset:1536
M a[84:87], a[212:215], a[244:247], a[84:87]
v_mov_b32 v216, 0
v_mov_b32 v217, 0
M a[88:91], a[220:223], a[244:247], a[88:91]
M a[88:91], a[216:219], a[240:243], a[88:91]
buffer_load_dwordx4 a[0:3], v1, s[44:47], s64 offen offset:0 sc1
s_waitcnt lgkmcnt(8)
v_mov_b32 v218, 0
v_mov_b32 v219, 0
M a[92:95], a[200:203], a[248:251], a[92:95]
ds_read_b128 a[240:243], v10 offset:10240
ds_read_b128 a[244:247], v11 offset:10240
M a[92:95], a[204:207], a[252:255], a[92:95]
v_mov_b32 v220, 0
v_mov_b32 v221, 0
M a[96:99], a[212:215], a[252:255], a[96:99]
ds_read_b64_tr_b16 a[192:193], v16 offset:0
ds_read_b64_tr_b16 a[194:195], v16 offset:1536
M a[96:99], a[208:211], a[248:251], a[96:99]
buffer_load_dwordx4 a[4:7], v1, s[44:47], s64 offen offset:1024 sc1
v_mov_b32 v222, 0
v_mov_b32 v223, 0
M a[100:103], a[216:219], a[248:251], a[100:103]
M a[100:103], a[220:223], a[252:255], a[100:103]
s_waitcnt lgkmcnt(10)
M a[104:107], a[204:207], a[228:231], a[104:107]
ds_read_b128 a[248:251], v10 offset:12288
ds_read_b128 a[252:255], v11 offset:12288
v_mov_b32 v224, 0
v_mov_b32 v225, 0
M a[104:107], a[200:203], a[224:227], a[104:107]
buffer_load_dwordx4 a[8:11], v1, s[44:47], s64 offen offset:2048 sc1
M a[108:111], a[208:211], a[224:227], a[108:111]
ds_read_b64_tr_b16 a[180:181], v14 offset:12288
ds_read_b64_tr_b16 a[182:183], v14 offset:13824
v_mov_b32 v226, 0
v_mov_b32 v227, 0
M a[108:111], a[212:215], a[228:231], a[108:111]
M a[112:115], a[220:223], a[228:231], a[112:115]
buffer_load_dwordx4 a[12:15], v1, s[44:47], s64 offen offset:3072 sc1
s_add_u32 s64, s64, 4096
v_mov_b32 v228, 0
v_mov_b32 v229, 0
M a[112:115], a[216:219], a[224:227], a[112:115]
s_waitcnt lgkmcnt(10)
M a[116:119], a[200:203], a[232:235], a[116:119]
ds_read_b128 a[224:227], v10 offset:14336
ds_read_b128 a[228:231], v11 offset:14336
v_mov_b32 v230, 0
v_mov_b32 v231, 0
M a[116:119], a[204:207], a[236:239], a[116:119]
M a[120:123], a[212:215], a[236:239], a[120:123]
ds_read_b64_tr_b16 a[188:189], v15 offset:12288
ds_read_b64_tr_b16 a[190:191], v15 offset:13824
M a[120:123], a[208:211], a[232:235], a[120:123]
buffer_load_dwordx4 a[16:19], v1, s[44:47], s64 offen offset:0 sc1
v_mov_b32 v232, 0
v_mov_b32 v233, 0
M a[124:127], a[216:219], a[232:235], a[124:127]
M a[124:127], a[220:223], a[236:239], a[124:127]
buffer_load_dwordx4 a[20:23], v1, s[44:47], s64 offen offset:1024 sc1
s_waitcnt lgkmcnt(10)
v_mov_b32 v234, 0
v_mov_b32 v235, 0
M a[128:131], a[204:207], a[244:247], a[128:131]
ds_read_b128 a[232:235], v10 offset:16384
ds_read_b128 a[236:239], v11 offset:16384
M a[128:131], a[200:203], a[240:243], a[128:131]
v_mov_b32 v236, 0
v_mov_b32 v237, 0
M a[132:135], a[208:211], a[240:243], a[132:135]
ds_read_b64_tr_b16 a[196:197], v16 offset:12288
ds_read_b64_tr_b16 a[198:199], v16 offset:13824
M a[132:135], a[212:215], a[244:247], a[132:135]
v_mov_b32 v238, 0
v_mov_b32 v239, 0
M a[136:139], a[220:223], a[244:247], a[136:139]
buffer_load_dwordx4 a[24:27], v1, s[44:47], s64 offen offset:2048 sc1
M a[136:139], a[216:219], a[240:243], a[136:139]
s_waitcnt lgkmcnt(10)
M a[140:143], a[200:203], a[248:251], a[140:143]
buffer_load_dwordx4 a[28:31], v1, s[44:47], s64 offen offset:3072 sc1
s_add_u32 s64, s64, 4096
v_mov_b32 v240, 0
v_mov_b32 v241, 0
M a[140:143], a[204:207], a[252:255], a[140:143]
M a[144:147], a[212:215], a[252:255], a[144:147]
v_mov_b32 v242, 0
v_mov_b32 v243, 0
M a[144:147], a[208:211], a[248:251], a[144:147]
M a[148:151], a[216:219], a[248:251], a[148:151]
s_waitcnt vmcnt(15) lgkmcnt(0)
s_barrier
ds_read_b128 a[240:243], v10 offset:18432
ds_read_b128 a[244:247], v11 offset:18432
v_mov_b32 v244, 0
v_mov_b32 v245, 0
M a[148:151], a[220:223], a[252:255], a[148:151]
buffer_load_dwordx4 a[32:35], v1, s[44:47], s64 offen offset:0 sc1
M a[152:155], a[204:207], a[228:231], a[152:155]
ds_read_b128 a[248:251], v10 offset:20480
ds_read_b128 a[252:255], v11 offset:20480
v_mov_b32 v246, 0
v_mov_b32 v247, 0
M a[152:155], a[200:203], a[224:227], a[152:155]
M a[156:159], a[208:211], a[224:227], a[156:159]
buffer_load_dwordx4 a[36:39], v1, s[44:47], s64 offen offset:1024 sc1
M a[156:159], a[212:215], a[228:231], a[156:159]
v_mov_b32 v248, 0
v_mov_b32 v249, 0
M a[160:163], a[220:223], a[228:231], a[160:163]
M a[160:163], a[216:219], a[224:227], a[160:163]
buffer_load_dwordx4 a[40:43], v1, s[44:47], s64 offen offset:2048 sc1
v_mov_b32 v250, 0
v_mov_b32 v251, 0
M a[164:167], a[200:203], a[232:235], a[164:167]
ds_read_b128 a[224:227], v10 offset:22528
ds_read_b128 a[228:231], v11 offset:22528
M a[164:167], a[204:207], a[236:239], a[164:167]
v_mov_b32 v252, 0
v_mov_b32 v253, 0
M a[168:171], a[212:215], a[236:239], a[168:171]
M a[168:171], a[208:211], a[232:235], a[168:171]
buffer_load_dwordx4 a[44:47], v1, s[44:47], s64 offen offset:3072 sc1
s_add_u32 s64, s64, 4096
v_mov_b32 v254, 0
v_mov_b32 v255, 0
M a[172:175], a[216:219], a[232:235], a[172:175]
M a[172:175], a[220:223], a[236:239], a[172:175]
s_waitcnt lgkmcnt(4)
M a[68:71], a[176:179], a[240:243], a[68:71]
ds_read_b128 a[232:235], v10 offset:24576
ds_read_b128 a[236:239], v11 offset:24576
s_mov_b32 s22, s101
s_and_b32 s23, s22, 1
M a[68:71], a[180:183], a[244:247], a[68:71]
buffer_load_dwordx4 a[48:51], v1, s[44:47], s64 offen offset:0 sc1
M a[72:75], a[188:191], a[244:247], a[72:75]
ds_read_b64_tr_b16 a[200:201], v14 offset:28672
ds_read_b64_tr_b16 a[202:203], v14 offset:30208
s_lshr_b32 s24, s22, 1
s_lshl_b32 s33, s24, 14
M a[72:75], a[184:187], a[240:243], a[72:75]
M a[76:79], a[192:195], a[240:243], a[76:79]
M a[76:79], a[196:199], a[244:247], a[76:79]
s_waitcnt lgkmcnt(6)
s_lshl_b32 s34, s23, 13
s_add_u32 s29, s33, s34
M a[80:83], a[180:183], a[252:255], a[80:83]
ds_read_b128 a[240:243], v10 offset:26624
ds_read_b128 a[244:247], v11 offset:26624
M a[80:83], a[176:179], a[248:251], a[80:83]
s_lshl_b32 s28, s20, 20
s_add_u32 s28, s28, s34
M a[84:87], a[184:187], a[248:251], a[84:87]
ds_read_b64_tr_b16 a[208:209], v15 offset:28672
ds_read_b64_tr_b16 a[210:211], v15 offset:30208
M a[84:87], a[188:191], a[252:255], a[84:87]
buffer_load_dwordx4 a[52:55], v1, s[44:47], s64 offen offset:1024 sc1
M a[88:91], a[196:199], a[252:255], a[88:91]
s_mov_b32 s25, s28
s_lshl_b32 s33, s21, 16
M a[88:91], a[192:195], a[248:251], a[88:91]
s_waitcnt lgkmcnt(8)
M a[92:95], a[176:179], a[224:227], a[92:95]
ds_read_b128 a[248:251], v10 offset:28672
ds_read_b128 a[252:255], v11 offset:28672
s_add_u32 s34, s28, s33
s_add_u32 s34, s34, 65536
M a[92:95], a[180:183], a[228:231], a[92:95]
M a[96:99], a[188:191], a[228:231], a[96:99]
ds_read_b64_tr_b16 a[216:217], v16 offset:28672
ds_read_b64_tr_b16 a[218:219], v16 offset:30208
M a[96:99], a[184:187], a[224:227], a[96:99]
s_add_u32 s32, s28, 491520
s_sub_u32 s33, s32, s33
M a[100:103], a[192:195], a[224:227], a[100:103]
buffer_load_dwordx4 a[56:59], v1, s[44:47], s64 offen offset:2048 sc1
M a[100:103], a[196:199], a[228:231], a[100:103]
s_waitcnt lgkmcnt(10)
s_add_u32 s33, s33, 491520
s_cmp_eq_u32 s24, 0
s_cselect_b32 s27, s34, s32
s_cselect_b32 s28, s32, s33
M a[104:107], a[180:183], a[236:239], a[104:107]
ds_read_b128 a[224:227], v10 offset:30720
ds_read_b128 a[228:231], v11 offset:30720
M a[104:107], a[176:179], a[232:235], a[104:107]
M a[108:111], a[184:187], a[232:235], a[108:111]
ds_read_b64_tr_b16 a[204:205], v14 offset:40960
ds_read_b64_tr_b16 a[206:207], v14 offset:42496
s_add_u32 s26, s25, 16384
s_add_u32 s62, s27, 16384
M a[108:111], a[188:191], a[236:239], a[108:111]
M a[112:115], a[196:199], a[236:239], a[112:115]
s_add_u32 s63, s28, 16384
s_lshl_b32 s31, s21, 7
M a[112:115], a[192:195], a[232:235], a[112:115]
s_waitcnt lgkmcnt(10)
M a[116:119], a[176:179], a[240:243], a[116:119]
ds_read_b128 a[232:235], v10 offset:32768
ds_read_b128 a[236:239], v11 offset:32768
M a[116:119], a[180:183], a[244:247], a[116:119]
buffer_load_dwordx4 a[60:63], v1, s[44:47], s64 offen offset:3072 sc1
s_cmp_eq_u32 s24, 0
s_cselect_b32 s31, s31, 960
M a[120:123], a[188:191], a[244:247], a[120:123]
ds_read_b64_tr_b16 a[212:213], v15 offset:40960
ds_read_b64_tr_b16 a[214:215], v15 offset:42496
M a[120:123], a[184:187], a[240:243], a[120:123]
s_mov_b32 s60, 0
s_add_u32 s12, s4, 16777216
s_addc_u32 s13, s5, 0
M a[124:127], a[192:195], a[240:243], a[124:127]
M a[124:127], a[196:199], a[244:247], a[124:127]
s_waitcnt lgkmcnt(10)
M a[128:131], a[180:183], a[252:255], a[128:131]
ds_read_b128 a[240:243], v10 offset:34816
ds_read_b128 a[244:247], v11 offset:34816
s_mov_b32 s14, 33554432
s_mov_b32 s15, 0x00020000
M a[128:131], a[176:179], a[248:251], a[128:131]
M a[132:135], a[184:187], a[248:251], a[132:135]
ds_read_b64_tr_b16 a[220:221], v16 offset:40960
ds_read_b64_tr_b16 a[222:223], v16 offset:42496
s_mov_b32 s8, s4
s_mov_b32 s9, s5
M a[132:135], a[188:191], a[252:255], a[132:135]
buffer_load_dword v126, v119, s[36:39], 0 offen offset:128 sc1
M a[136:139], a[196:199], a[252:255], a[136:139]
M a[136:139], a[192:195], a[248:251], a[136:139]
s_waitcnt lgkmcnt(10)
s_mov_b32 s10, 16777216
s_mov_b32 s11, 0x00020000
M a[140:143], a[176:179], a[224:227], a[140:143]
M a[140:143], a[180:183], a[228:231], a[140:143]
M a[144:147], a[188:191], a[228:231], a[144:147]
M a[144:147], a[184:187], a[224:227], a[144:147]
M a[148:151], a[192:195], a[224:227], a[148:151]
s_waitcnt vmcnt(17) lgkmcnt(0)
s_barrier
ds_read_b128 a[248:251], v12 offset:0
ds_read_b128 a[252:255], v13 offset:0
s_waitcnt vmcnt(0)
v_cmp_gt_u32 vcc, 0x80, v126
s_nop 0
s_cbranch_vccnz Lk1_spin
Lk1_got:
M a[148:151], a[196:199], a[228:231], a[148:151]
s_add_u32 m0, s29, 65536
s_add_u32 s32, s25, 4096
buffer_load_dwordx4 v1, s[12:15], s25 offen offset:0 sc1 lds
M a[152:155], a[180:183], a[236:239], a[152:155]
ds_read_b128 a[224:227], v12 offset:2048
ds_read_b128 a[228:231], v13 offset:2048
M a[152:155], a[176:179], a[232:235], a[152:155]
buffer_load_dwordx4 v1, s[12:15], s25 offen offset:1024 sc1 lds
M a[156:159], a[184:187], a[232:235], a[156:159]
M a[156:159], a[188:191], a[236:239], a[156:159]
buffer_load_dwordx4 v1, s[12:15], s25 offen offset:2048 sc1 lds
M a[160:163], a[196:199], a[236:239], a[160:163]
buffer_load_dwordx4 v1, s[12:15], s25 offen offset:3072 sc1 lds
M a[160:163], a[192:195], a[232:235], a[160:163]
M a[164:167], a[176:179], a[240:243], a[164:167]
ds_read_b128 a[232:235], v12 offset:4096
ds_read_b128 a[236:239], v13 offset:4096
M a[164:167], a[180:183], a[244:247], a[164:167]
s_add_u32 m0, s29, 69632
s_nop 0
buffer_load_dwordx4 v1, s[12:15], s32 offen offset:0 sc1 lds
M a[168:171], a[188:191], a[244:247], a[168:171]
buffer_load_dwordx4 v1, s[12:15], s32 offen offset:1024 sc1 lds
M a[168:171], a[184:187], a[240:243], a[168:171]
M a[172:175], a[192:195], a[240:243], a[172:175]
buffer_load_dwordx4 v1, s[12:15], s32 offen offset:2048 sc1 lds
M a[172:175], a[196:199], a[244:247], a[172:175]
s_waitcnt lgkmcnt(4)
M a[68:71], a[200:203], a[248:251], a[68:71]
ds_read_b128 a[240:243], v12 offset:6144
ds_read_b128 a[244:247], v13 offset:6144
M a[68:71], a[204:207], a[252:255], a[68:71]
buffer_load_dwordx4 v1, s[12:15], s32 offen offset:3072 sc1 lds
M a[72:75], a[212:215], a[252:255], a[72:75]
M a[72:75], a[208:211], a[248:251], a[72:75]
M a[76:79], a[216:219], a[248:251], a[76:79]
M a[76:79], a[220:223], a[252:255], a[76:79]
s_waitcnt lgkmcnt(4)
M a[80:83], a[204:207], a[228:231], a[80:83]
ds_read_b128 a[248:251], v12 offset:8192
ds_read_b128 a[252:255], v13 offset:8192
M a[80:83], a[200:203], a[224:227], a[80:83]
M a[84:87], a[208:211], a[224:227], a[84:87]
M a[84:87], a[212:215], a[228:231], a[84:87]
M a[88:91], a[220:223], a[228:231], a[88:91]
M a[88:91], a[216:219], a[224:227], a[88:91]
s_waitcnt lgkmcnt(4)
M a[92:95], a[200:203], a[232:235], a[92:95]
ds_read_b128 a[224:227], v12 offset:10240
ds_read_b128 a[228:231], v13 offset:10240
v_accvgpr_read_b32 v24, a68
v_accvgpr_read_b32 v25, a69
v_accvgpr_read_b32 v26, a70
M a[92:95], a[204:207], a[236:239], a[92:95]
v_accvgpr_read_b32 v27, a71
v_cvt_pk_bf16_f32 v24, v24, v25
v_cvt_pk_bf16_f32 v25, v26, v27
ds_write_b64 v124, v[24:25] offset:0
M a[96:99], a[212:215], a[236:239], a[96:99]
v_accvgpr_read_b32 v28, a72
v_accvgpr_read_b32 v29, a73
v_accvgpr_read_b32 v30, a74
M a[96:99], a[208:211], a[232:235], a[96:99]
v_accvgpr_read_b32 v31, a75
v_cvt_pk_bf16_f32 v28, v28, v29
v_cvt_pk_bf16_f32 v29, v30, v31
ds_write_b64 v124, v[28:29] offset:32
M a[100:103], a[216:219], a[232:235], a[100:103]
v_accvgpr_read_b32 v24, a76
v_accvgpr_read_b32 v25, a77
v_accvgpr_read_b32 v26, a78
M a[100:103], a[220:223], a[236:239], a[100:103]
s_waitcnt lgkmcnt(6)
v_accvgpr_read_b32 v27, a79
v_cvt_pk_bf16_f32 v24, v24, v25
v_cvt_pk_bf16_f32 v25, v26, v27
ds_write_b64 v124, v[24:25] offset:64
M a[104:107], a[204:207], a[244:247], a[104:107]
ds_read_b128 a[232:235], v12 offset:12288
ds_read_b128 a[236:239], v13 offset:12288
v_accvgpr_read_b32 v24, a80
v_accvgpr_read_b32 v25, a81
v_accvgpr_read_b32 v26, a82
M a[104:107], a[200:203], a[240:243], a[104:107]
v_accvgpr_read_b32 v27, a83
v_cvt_pk_bf16_f32 v24, v24, v25
v_cvt_pk_bf16_f32 v25, v26, v27
ds_write_b64 v124, v[24:25] offset:6400
M a[108:111], a[208:211], a[240:243], a[108:111]
v_accvgpr_read_b32 v28, a84
v_accvgpr_read_b32 v29, a85
v_accvgpr_read_b32 v30, a86
M a[108:111], a[212:215], a[244:247], a[108:111]
v_accvgpr_read_b32 v31, a87
v_cvt_pk_bf16_f32 v28, v28, v29
v_cvt_pk_bf16_f32 v29, v30, v31
ds_write_b64 v124, v[28:29] offset:6432
M a[112:115], a[220:223], a[244:247], a[112:115]
v_accvgpr_read_b32 v24, a88
v_accvgpr_read_b32 v25, a89
v_accvgpr_read_b32 v26, a90
M a[112:115], a[216:219], a[240:243], a[112:115]
s_waitcnt lgkmcnt(9)
v_accvgpr_read_b32 v27, a91
v_cvt_pk_bf16_f32 v24, v24, v25
v_cvt_pk_bf16_f32 v25, v26, v27
ds_write_b64 v124, v[24:25] offset:6464
M a[116:119], a[200:203], a[248:251], a[116:119]
ds_read_b128 a[240:243], v12 offset:14336
ds_read_b128 a[244:247], v13 offset:14336
v_accvgpr_read_b32 v24, a92
v_accvgpr_read_b32 v25, a93
v_accvgpr_read_b32 v26, a94
M a[116:119], a[204:207], a[252:255], a[116:119]
v_accvgpr_read_b32 v27, a95
v_cvt_pk_bf16_f32 v24, v24, v25
v_cvt_pk_bf16_f32 v25, v26, v27
ds_write_b64 v124, v[24:25] offset:12800
M a[120:123], a[212:215], a[252:255], a[120:123]
v_accvgpr_read_b32 v28, a96
v_accvgpr_read_b32 v29, a97
v_accvgpr_read_b32 v30, a98
M a[120:123], a[208:211], a[248:251], a[120:123]
v_accvgpr_read_b32 v31, a99
v_cvt_pk_bf16_f32 v28, v28, v29
v_cvt_pk_bf16_f32 v29, v30, v31
ds_write_b64 v124, v[28:29] offset:12832
M a[124:127], a[216:219], a[248:251], a[124:127]
v_accvgpr_read_b32 v24, a100
v_accvgpr_read_b32 v25, a101
v_accvgpr_read_b32 v26, a102
M a[124:127], a[220:223], a[252:255], a[124:127]
s_add_u32 s25, s25, 32768
s_cmp_eq_u32 s25, s27
s_cselect_b32 s25, s28, s25
s_cselect_b32 s27, -1, s27
s_waitcnt lgkmcnt(12)
v_accvgpr_read_b32 v27, a103
v_cvt_pk_bf16_f32 v24, v24, v25
v_cvt_pk_bf16_f32 v25, v26, v27
ds_write_b64 v124, v[24:25] offset:12864
M a[128:131], a[204:207], a[228:231], a[128:131]
ds_read_b128 a[248:251], v12 offset:16384
ds_read_b128 a[252:255], v13 offset:16384
v_accvgpr_read_b32 v24, a104
v_accvgpr_read_b32 v25, a105
v_accvgpr_read_b32 v26, a106
M a[128:131], a[200:203], a[224:227], a[128:131]
v_accvgpr_read_b32 v27, a107
v_cvt_pk_bf16_f32 v24, v24, v25
v_cvt_pk_bf16_f32 v25, v26, v27
ds_write_b64 v124, v[24:25] offset:19200
M a[132:135], a[208:211], a[224:227], a[132:135]
v_accvgpr_read_b32 v28, a108
v_accvgpr_read_b32 v29, a109
v_accvgpr_read_b32 v30, a110
M a[132:135], a[212:215], a[228:231], a[132:135]
v_accvgpr_read_b32 v31, a111
v_cvt_pk_bf16_f32 v28, v28, v29
v_cvt_pk_bf16_f32 v29, v30, v31
ds_write_b64 v124, v[28:29] offset:19232
M a[136:139], a[220:223], a[228:231], a[136:139]
v_accvgpr_read_b32 v24, a112
v_accvgpr_read_b32 v25, a113
v_accvgpr_read_b32 v26, a114
M a[136:139], a[216:219], a[224:227], a[136:139]
s_waitcnt lgkmcnt(12)
v_accvgpr_read_b32 v27, a115
v_cvt_pk_bf16_f32 v24, v24, v25
v_cvt_pk_bf16_f32 v25, v26, v27
ds_write_b64 v124, v[24:25] offset:19264
M a[140:143], a[200:203], a[232:235], a[140:143]
v_accvgpr_read_b32 v24, a116
v_accvgpr_read_b32 v25, a117
v_accvgpr_read_b32 v26, a118
M a[140:143], a[204:207], a[236:239], a[140:143]
v_accvgpr_read_b32 v27, a119
v_cvt_pk_bf16_f32 v24, v24, v25
v_cvt_pk_bf16_f32 v25, v26, v27
ds_write_b64 v124, v[24:25] offset:25600
M a[144:147], a[212:215], a[236:239], a[144:147]
v_accvgpr_read_b32 v28, a120
v_accvgpr_read_b32 v29, a121
v_accvgpr_read_b32 v30, a122
M a[144:147], a[208:211], a[232:235], a[144:147]
v_accvgpr_read_b32 v31, a123
v_cvt_pk_bf16_f32 v28, v28, v29
v_cvt_pk_bf16_f32 v29, v30, v31
ds_write_b64 v124, v[28:29] offset:25632
M a[148:151], a[216:219], a[232:235], a[148:151]
s_waitcnt lgkmcnt(0)
s_barrier
v_accvgpr_read_b32 v24, a124
v_accvgpr_read_b32 v25, a125
v_accvgpr_read_b32 v26, a126
M a[148:151], a[220:223], a[236:239], a[148:151]
v_accvgpr_read_b32 v27, a127
v_cvt_pk_bf16_f32 v24, v24, v25
v_cvt_pk_bf16_f32 v25, v26, v27
ds_write_b64 v124, v[24:25] offset:25664
v_accvgpr_read_b32 v24, a128
v_accvgpr_read_b32 v25, a129
v_accvgpr_read_b32 v26, a130
M a[152:155], a[204:207], a[244:247], a[152:155]
v_accvgpr_read_b32 v27, a131
v_cvt_pk_bf16_f32 v24, v24, v25
v_cvt_pk_bf16_f32 v25, v26, v27
M a[152:155], a[200:203], a[240:243], a[152:155]
ds_write_b64 v124, v[24:25] offset:32000
v_accvgpr_read_b32 v28, a132
v_accvgpr_read_b32 v29, a133
M a[156:159], a[208:211], a[240:243], a[156:159]
v_accvgpr_read_b32 v30, a134
v_accvgpr_read_b32 v31, a135
v_cvt_pk_bf16_f32 v28, v28, v29
M a[156:159], a[212:215], a[244:247], a[156:159]
v_cvt_pk_bf16_f32 v29, v30, v31
ds_write_b64 v124, v[28:29] offset:32032
v_accvgpr_read_b32 v24, a136
M a[160:163], a[220:223], a[244:247], a[160:163]
v_accvgpr_read_b32 v25, a137
v_accvgpr_read_b32 v26, a138
v_accvgpr_read_b32 v27, a139
M a[160:163], a[216:219], a[240:243], a[160:163]
v_cvt_pk_bf16_f32 v24, v24, v25
v_cvt_pk_bf16_f32 v25, v26, v27
ds_write_b64 v124, v[24:25] offset:32064
M a[164:167], a[200:203], a[248:251], a[164:167]
v_accvgpr_read_b32 v24, a140
v_accvgpr_read_b32 v25, a141
v_accvgpr_read_b32 v26, a142
M a[164:167], a[204:207], a[252:255], a[164:167]
v_accvgpr_read_b32 v27, a143
v_cvt_pk_bf16_f32 v24, v24, v25
v_cvt_pk_bf16_f32 v25, v26, v27
ds_write_b64 v124, v[24:25] offset:38400
M a[168:171], a[212:215], a[252:255], a[168:171]
v_accvgpr_read_b32 v28, a144
v_accvgpr_read_b32 v29, a145
v_accvgpr_read_b32 v30, a146
M a[168:171], a[208:211], a[248:251], a[168:171]
v_accvgpr_read_b32 v31, a147
v_cvt_pk_bf16_f32 v28, v28, v29
v_cvt_pk_bf16_f32 v29, v30, v31
ds_write_b64 v124, v[28:29] offset:38432
M a[172:175], a[216:219], a[248:251], a[172:175]
v_accvgpr_read_b32 v24, a148
v_accvgpr_read_b32 v25, a149
v_accvgpr_read_b32 v26, a150
M a[172:175], a[220:223], a[252:255], a[172:175]
v_accvgpr_read_b32 v27, a151
v_cvt_pk_bf16_f32 v24, v24, v25
v_cvt_pk_bf16_f32 v25, v26, v27
ds_write_b64 v124, v[24:25] offset:38464
s_mov_b64 s[44:45], s[42:43]
v_accvgpr_read_b32 v24, a152
v_accvgpr_read_b32 v25, a153
v_accvgpr_read_b32 v26, a154
v_accvgpr_read_b32 v27, a155
v_cvt_pk_bf16_f32 v24, v24, v25
v_cvt_pk_bf16_f32 v25, v26, v27
ds_write_b64 v124, v[24:25] offset:44800
v_accvgpr_read_b32 v28, a156
v_accvgpr_read_b32 v29, a157
v_accvgpr_read_b32 v30, a158
v_accvgpr_read_b32 v31, a159
v_cvt_pk_bf16_f32 v28, v28, v29
v_cvt_pk_bf16_f32 v29, v30, v31
ds_write_b64 v124, v[28:29] offset:44832
v_accvgpr_read_b32 v24, a160
v_accvgpr_read_b32 v25, a161
v_accvgpr_read_b32 v26, a162
v_accvgpr_read_b32 v27, a163
v_cvt_pk_bf16_f32 v24, v24, v25
v_cvt_pk_bf16_f32 v25, v26, v27
ds_write_b64 v124, v[24:25] offset:44864
v_accvgpr_read_b32 v24, a164
v_accvgpr_read_b32 v25, a165
v_accvgpr_read_b32 v26, a166
v_accvgpr_read_b32 v27, a167
v_cvt_pk_bf16_f32 v24, v24, v25
v_cvt_pk_bf16_f32 v25, v26, v27
ds_write_b64 v124, v[24:25] offset:51200
v_accvgpr_read_b32 v28, a168
v_accvgpr_read_b32 v29, a169
v_accvgpr_read_b32 v30, a170
v_accvgpr_read_b32 v31, a171
v_cvt_pk_bf16_f32 v28, v28, v29
v_cvt_pk_bf16_f32 v29, v30, v31
ds_write_b64 v124, v[28:29] offset:51232
v_accvgpr_read_b32 v24, a172
v_accvgpr_read_b32 v25, a173
v_accvgpr_read_b32 v26, a174
v_accvgpr_read_b32 v27, a175
v_cvt_pk_bf16_f32 v24, v24, v25
v_cvt_pk_bf16_f32 v25, v26, v27
ds_write_b64 v124, v[24:25] offset:51264
s_waitcnt lgkmcnt(0)
s_barrier
ds_read_b128 v[48:51], v121 offset:128
ds_read_b128 v[32:35], v120 offset:0
ds_read_b128 v[52:55], v120 offset:128
ds_read_b128 v[36:39], v120 offset:12800
ds_read_b128 v[56:59], v120 offset:12928
ds_read_b128 v[40:43], v120 offset:25600
ds_read_b128 v[60:63], v120 offset:25728
ds_read_b128 v[44:47], v120 offset:38400
ds_read_b128 v[64:67], v120 offset:38528
ds_read_b64_tr_b16 v[68:69], v123 offset:256
ds_read_b64_tr_b16 v[70:71], v122 offset:256
ds_read_b64_tr_b16 v[72:73], v122 offset:13056
ds_read_b64_tr_b16 v[74:75], v122 offset:25856
ds_read_b64_tr_b16 v[76:77], v122 offset:38656
ds_read_b64_tr_b16 v[78:79], v123 offset:288
ds_read_b64_tr_b16 v[80:81], v122 offset:288
ds_read_b64_tr_b16 v[82:83], v122 offset:13088
ds_read_b64_tr_b16 v[84:85], v122 offset:25888
ds_read_b64_tr_b16 v[86:87], v122 offset:38688
v_accvgpr_write_b32 a64, 0
v_accvgpr_write_b32 a65, 0
v_accvgpr_write_b32 a66, 0
v_accvgpr_write_b32 a67, 0
v_accvgpr_write_b32 a68, 0
v_accvgpr_write_b32 a69, 0
v_accvgpr_write_b32 a70, 0
v_accvgpr_write_b32 a71, 0
v_accvgpr_write_b32 a72, 0
v_accvgpr_write_b32 a73, 0
v_accvgpr_write_b32 a74, 0
v_accvgpr_write_b32 a75, 0
s_add_u32 m0, s29, 0
s_add_u32 s32, s25, 4096
buffer_load_dwordx4 v1, s[12:15], s25 offen offset:0 sc1 lds
v_accvgpr_write_b32 a76, 0
v_accvgpr_write_b32 a77, 0
v_accvgpr_write_b32 a78, 0
v_accvgpr_write_b32 a79, 0
v_accvgpr_write_b32 a80, 0
v_accvgpr_write_b32 a81, 0
v_accvgpr_write_b32 a82, 0
v_accvgpr_write_b32 a83, 0
v_accvgpr_write_b32 a84, 0
v_accvgpr_write_b32 a85, 0
v_accvgpr_write_b32 a86, 0
buffer_load_dwordx4 v1, s[12:15], s25 offen offset:1024 sc1 lds
v_accvgpr_write_b32 a87, 0
v_accvgpr_write_b32 a88, 0
v_accvgpr_write_b32 a89, 0
v_accvgpr_write_b32 a90, 0
v_accvgpr_write_b32 a91, 0
v_accvgpr_write_b32 a92, 0
v_accvgpr_write_b32 a93, 0
v_accvgpr_write_b32 a94, 0
v_accvgpr_write_b32 a95, 0
v_accvgpr_write_b32 a96, 0
buffer_load_dwordx4 v1, s[12:15], s25 offen offset:2048 sc1 lds
v_accvgpr_write_b32 a97, 0
v_accvgpr_write_b32 a98, 0
v_accvgpr_write_b32 a99, 0
v_accvgpr_write_b32 a100, 0
v_accvgpr_write_b32 a101, 0
v_accvgpr_write_b32 a102, 0
v_accvgpr_write_b32 a103, 0
v_accvgpr_write_b32 a104, 0
v_accvgpr_write_b32 a105, 0
v_accvgpr_write_b32 a106, 0
v_accvgpr_write_b32 a107, 0
buffer_load_dwordx4 v1, s[12:15], s25 offen offset:3072 sc1 lds
v_accvgpr_write_b32 a108, 0
v_accvgpr_write_b32 a109, 0
v_accvgpr_write_b32 a110, 0
v_accvgpr_write_b32 a111, 0
s_waitcnt lgkmcnt(15)
M v[88:91], v[48:51], v[32:35], v[152:155]
M v[92:95], v[52:55], v[32:35], v[148:151]
M v[96:99], v[52:55], v[36:39], v[144:147]
s_waitcnt lgkmcnt(14)
M v[100:103], v[56:59], v[36:39], v[148:151]
s_waitcnt lgkmcnt(13)
M v[104:107], v[56:59], v[40:43], v[144:147]
s_waitcnt lgkmcnt(12)
M v[108:111], v[60:63], v[40:43], v[148:151]
s_add_u32 m0, s29, 4096
s_nop 0
buffer_load_dwordx4 v1, s[12:15], s32 offen offset:0 sc1 lds
s_waitcnt lgkmcnt(11)
M v[112:115], v[60:63], v[44:47], v[144:147]
s_waitcnt lgkmcnt(10)
M v[116:119], v[64:67], v[44:47], v[148:151]
v_max3_f32 v136, v88, v89, v90
v_max3_f32 v136, v136, v91, v92
v_max3_f32 v136, v136, v93, v94
v_max_f32 v136, v136, v95
v_max3_f32 v137, v96, v97, v98
v_max3_f32 v137, v137, v99, v100
v_max3_f32 v137, v137, v101, v102
v_max_f32 v137, v137, v103
v_max3_f32 v138, v104, v105, v106
buffer_load_dwordx4 v1, s[12:15], s32 offen offset:1024 sc1 lds
v_max3_f32 v138, v138, v107, v108
v_max3_f32 v138, v138, v109, v110
v_max_f32 v138, v138, v111
v_max3_f32 v139, v112, v113, v114
v_max3_f32 v139, v139, v115, v116
v_max3_f32 v139, v139, v117, v118
v_max_f32 v139, v139, v119
v_mov_b32 v140, v136
v_mov_b32 v141, v137
v_mov_b32 v142, v138
buffer_load_dwordx4 v1, s[12:15], s32 offen offset:2048 sc1 lds
v_mov_b32 v143, v139
v_permlane16_swap_b32 v136, v140
v_permlane16_swap_b32 v137, v141
v_permlane16_swap_b32 v138, v142
v_permlane16_swap_b32 v139, v143
v_max_f32 v136, v136, v140
v_max_f32 v137, v137, v141
v_max_f32 v138, v138, v142
v_max_f32 v139, v139, v143
v_mov_b32 v140, v136
v_mov_b32 v141, v137
buffer_load_dwordx4 v1, s[12:15], s32 offen offset:3072 sc1 lds
v_mov_b32 v142, v138
v_mov_b32 v143, v139
v_permlane32_swap_b32 v136, v140
v_permlane32_swap_b32 v137, v141
v_permlane32_swap_b32 v138, v142
v_permlane32_swap_b32 v139, v143
v_max_f32 v136, v136, v140
v_max_f32 v137, v137, v141
v_max_f32 v138, v138, v142
v_max_f32 v139, v139, v143
s_add_u32 s25, s25, 32768
s_cmp_eq_u32 s25, s27
s_cselect_b32 s25, s28, s25
s_cselect_b32 s27, -1, s27
v_mul_f32 v136, s7, v136
v_mul_f32 v137, s7, v137
v_mul_f32 v138, s7, v138
v_mul_f32 v139, s7, v139
v_fma_f32 v88, v88, s7, -v136
v_fma_f32 v89, v89, s7, -v136
v_fma_f32 v90, v90, s7, -v136
v_fma_f32 v91, v91, s7, -v136
v_fma_f32 v92, v92, s7, -v136
v_fma_f32 v93, v93, s7, -v136
v_fma_f32 v94, v94, s7, -v136
s_add_u32 m0, s29, 32768
s_add_u32 s32, s26, 4096
buffer_load_dwordx4 v1, s[12:15], s26 offen offset:0 sc1 lds
v_fma_f32 v95, v95, s7, -v136
v_exp_f32 v88, v88
v_exp_f32 v89, v89
v_exp_f32 v90, v90
v_exp_f32 v91, v91
v_exp_f32 v92, v92
v_exp_f32 v93, v93
v_exp_f32 v94, v94
v_exp_f32 v95, v95
v_fma_f32 v96, v96, s7, -v137
v_fma_f32 v97, v97, s7, -v137
buffer_load_dwordx4 v1, s[12:15], s26 offen offset:1024 sc1 lds
v_fma_f32 v98, v98, s7, -v137
v_fma_f32 v99, v99, s7, -v137
v_fma_f32 v100, v100, s7, -v137
v_fma_f32 v101, v101, s7, -v137
v_fma_f32 v102, v102, s7, -v137
v_fma_f32 v103, v103, s7, -v137
v_exp_f32 v96, v96
v_exp_f32 v97, v97
v_exp_f32 v98, v98
v_exp_f32 v99, v99
buffer_load_dwordx4 v1, s[12:15], s26 offen offset:2048 sc1 lds
v_exp_f32 v100, v100
v_exp_f32 v101, v101
v_exp_f32 v102, v102
v_exp_f32 v103, v103
v_fma_f32 v104, v104, s7, -v138
v_fma_f32 v105, v105, s7, -v138
v_fma_f32 v106, v106, s7, -v138
v_fma_f32 v107, v107, s7, -v138
v_fma_f32 v108, v108, s7, -v138
v_fma_f32 v109, v109, s7, -v138
v_fma_f32 v110, v110, s7, -v138
buffer_load_dwordx4 v1, s[12:15], s26 offen offset:3072 sc1 lds
v_fma_f32 v111, v111, s7, -v138
v_exp_f32 v104, v104
v_exp_f32 v105, v105
v_exp_f32 v106, v106
v_exp_f32 v107, v107
v_exp_f32 v108, v108
v_exp_f32 v109, v109
v_exp_f32 v110, v110
v_exp_f32 v111, v111
v_fma_f32 v112, v112, s7, -v139
s_add_u32 m0, s29, 36864
s_nop 0
buffer_load_dwordx4 v1, s[12:15], s32 offen offset:0 sc1 lds
v_fma_f32 v113, v113, s7, -v139
v_fma_f32 v114, v114, s7, -v139
v_fma_f32 v115, v115, s7, -v139
v_fma_f32 v116, v116, s7, -v139
v_fma_f32 v117, v117, s7, -v139
v_fma_f32 v118, v118, s7, -v139
v_fma_f32 v119, v119, s7, -v139
v_exp_f32 v112, v112
v_exp_f32 v113, v113
v_exp_f32 v114, v114
v_exp_f32 v115, v115
buffer_load_dwordx4 v1, s[12:15], s32 offen offset:1024 sc1 lds
v_exp_f32 v116, v116
v_exp_f32 v117, v117
v_exp_f32 v118, v118
v_exp_f32 v119, v119
v_cvt_pk_bf16_f32 v88, v88, v89
v_cvt_pk_bf16_f32 v89, v90, v91
v_cvt_pk_bf16_f32 v90, v92, v93
v_cvt_pk_bf16_f32 v91, v94, v95
v_cvt_pk_bf16_f32 v96, v96, v97
v_cvt_pk_bf16_f32 v97, v98, v99
buffer_load_dwordx4 v1, s[12:15], s32 offen offset:2048 sc1 lds
v_cvt_pk_bf16_f32 v98, v100, v101
v_cvt_pk_bf16_f32 v99, v102, v103
v_cvt_pk_bf16_f32 v104, v104, v105
v_cvt_pk_bf16_f32 v105, v106, v107
v_cvt_pk_bf16_f32 v106, v108, v109
v_cvt_pk_bf16_f32 v107, v110, v111
v_cvt_pk_bf16_f32 v112, v112, v113
v_cvt_pk_bf16_f32 v113, v114, v115
v_cvt_pk_bf16_f32 v114, v116, v117
v_cvt_pk_bf16_f32 v115, v118, v119
M v[120:123], v[156:159], v[88:91], 0
buffer_load_dwordx4 v1, s[12:15], s32 offen offset:3072 sc1 lds
s_waitcnt lgkmcnt(8)
M v[32:35], v[68:71], v[88:91], 0
s_waitcnt lgkmcnt(3)
M v[36:39], v[78:81], v[88:91], 0
M v[124:127], v[156:159], v[96:99], 0
M v[40:43], v[70:73], v[96:99], 0
s_waitcnt lgkmcnt(2)
M v[44:47], v[80:83], v[96:99], 0
M v[128:131], v[156:159], v[104:107], 0
M v[48:51], v[72:75], v[104:107], 0
s_waitcnt lgkmcnt(1)
M v[52:55], v[82:85], v[104:107], 0
M v[132:135], v[156:159], v[112:115], 0
M v[56:59], v[74:77], v[112:115], 0
s_add_u32 s26, s26, 32768
s_cmp_eq_u32 s26, s62
s_cselect_b32 s26, s63, s26
s_cselect_b32 s62, -1, s62
s_waitcnt lgkmcnt(0)
M v[60:63], v[84:87], v[112:115], 0
v_rcp_f32 v120, v120
v_rcp_f32 v124, v124
v_rcp_f32 v128, v128
v_rcp_f32 v132, v132
v_pk_mul_f32 v[32:33], v[32:33], v[120:121] op_sel_hi:[1,0]
v_pk_mul_f32 v[34:35], v[34:35], v[120:121] op_sel_hi:[1,0]
v_pk_mul_f32 v[36:37], v[36:37], v[120:121] op_sel_hi:[1,0]
v_pk_mul_f32 v[38:39], v[38:39], v[120:121] op_sel_hi:[1,0]
v_cvt_pk_bf16_f32 v32, v32, v33
v_cvt_pk_bf16_f32 v33, v34, v35
v_cvt_pk_bf16_f32 v34, v36, v37
v_cvt_pk_bf16_f32 v35, v38, v39
s_add_u32 s3, s6, 0
buffer_store_dwordx4 v[32:35], v1, s[16:19], s3 offen sc1
v_pk_mul_f32 v[40:41], v[40:41], v[124:125] op_sel_hi:[1,0]
v_pk_mul_f32 v[42:43], v[42:43], v[124:125] op_sel_hi:[1,0]
v_pk_mul_f32 v[44:45], v[44:45], v[124:125] op_sel_hi:[1,0]
v_pk_mul_f32 v[46:47], v[46:47], v[124:125] op_sel_hi:[1,0]
v_cvt_pk_bf16_f32 v40, v40, v41
v_cvt_pk_bf16_f32 v41, v42, v43
v_cvt_pk_bf16_f32 v42, v44, v45
v_cvt_pk_bf16_f32 v43, v46, v47
s_add_u32 s3, s6, 2048
buffer_store_dwordx4 v[40:43], v1, s[16:19], s3 offen sc1
v_pk_mul_f32 v[48:49], v[48:49], v[128:129] op_sel_hi:[1,0]
v_pk_mul_f32 v[50:51], v[50:51], v[128:129] op_sel_hi:[1,0]
v_pk_mul_f32 v[52:53], v[52:53], v[128:129] op_sel_hi:[1,0]
v_pk_mul_f32 v[54:55], v[54:55], v[128:129] op_sel_hi:[1,0]
v_cvt_pk_bf16_f32 v48, v48, v49
v_cvt_pk_bf16_f32 v49, v50, v51
v_cvt_pk_bf16_f32 v50, v52, v53
v_cvt_pk_bf16_f32 v51, v54, v55
s_add_u32 s3, s6, 4096
buffer_store_dwordx4 v[48:51], v1, s[16:19], s3 offen sc1
v_pk_mul_f32 v[56:57], v[56:57], v[132:133] op_sel_hi:[1,0]
v_pk_mul_f32 v[58:59], v[58:59], v[132:133] op_sel_hi:[1,0]
v_pk_mul_f32 v[60:61], v[60:61], v[132:133] op_sel_hi:[1,0]
v_pk_mul_f32 v[62:63], v[62:63], v[132:133] op_sel_hi:[1,0]
v_cvt_pk_bf16_f32 v56, v56, v57
v_cvt_pk_bf16_f32 v57, v58, v59
v_cvt_pk_bf16_f32 v58, v60, v61
v_cvt_pk_bf16_f32 v59, v62, v63
s_add_u32 s3, s6, 6144
buffer_store_dwordx4 v[56:59], v1, s[16:19], s3 offen sc1
Lc2:
s_add_u32 s16, s4, 67108864
s_addc_u32 s17, s5, 0
s_mov_b32 s18, 16777216
s_mov_b32 s19, 0x00020000
s_add_u32 s52, s4, 100663296
s_addc_u32 s53, s5, 0
s_mov_b32 s54, 8404992
s_mov_b32 s55, 0x00020000
s_mov_b32 s46, 8388608
s_mov_b32 s47, 0x00020000
s_mov_b32 s50, 2097152
s_mov_b32 s51, 0x00020000
s_lshl_b32 s33, s24, 14
v_add_u32 v2, s33, v1
v_add_u32 v3, 0x10000, v2
v_and_b32 v8, 15, v0
v_bfe_u32 v9, v0, 4, 2
v_lshlrev_b32 v9, 2, v9
v_sub_u32 v8, v8, v9
v_mov_b32 v4, 0xf149f2ca
v_cmp_gt_i32 vcc, 0, v8
s_nop 1
v_cndmask_b32 v16, 0, v4, vcc
v_cmp_gt_i32 vcc, 1, v8
s_nop 1
v_cndmask_b32 v17, 0, v4, vcc
v_cmp_gt_i32 vcc, 2, v8
s_nop 1
v_cndmask_b32 v18, 0, v4, vcc
v_cmp_gt_i32 vcc, 3, v8
s_nop 1
v_cndmask_b32 v19, 0, v4, vcc
v_mov_b32 v8, 0x3f803f80
v_accvgpr_write_b32 a112, v8
v_accvgpr_write_b32 a113, v8
v_accvgpr_write_b32 a114, v8
v_accvgpr_write_b32 a115, v8
s_lshl_b32 s33, s23, 6
s_add_i32 s33, s33, s31
s_cmp_gt_i32 s33, 0
s_cselect_b32 s34, 0, 0xf149f2ca
s_cmp_lt_i32 s33, 0
s_cselect_b32 s33, 0xf149f2ca, 0
v_mov_b32 v20, s34
v_mov_b32 v21, s34
v_mov_b32 v22, s34
v_mov_b32 v23, s34
v_mov_b32 v28, s33
v_mov_b32 v29, s33
v_mov_b32 v30, s33
v_mov_b32 v31, s33
v_med3_f32 v24, v16, v20, v28
v_med3_f32 v25, v17, v20, v28
v_med3_f32 v26, v18, v20, v28
v_med3_f32 v27, v19, v20, v28
v_mov_b32 v5, 0
v_mov_b32 v6, 1
s_waitcnt vmcnt(20)
s_barrier
ds_read_b128 a[116:119], v3 offset:0
ds_read_b128 a[120:123], v3 offset:1024
ds_read_b128 a[124:127], v3 offset:2048
ds_read_b128 a[128:131], v3 offset:3072
ds_read_b128 a[132:135], v3 offset:4096
ds_read_b128 a[136:139], v3 offset:5120
ds_read_b128 a[140:143], v3 offset:6144
ds_read_b128 a[144:147], v3 offset:7168
s_waitcnt lgkmcnt(4)
M v[32:35], a[116:119], a[0:3], v[24:27]
M v[32:35], a[120:123], a[4:7], v[32:35]
ds_read_b128 a[148:151], v3 offset:8192
ds_read_b128 a[152:155], v3 offset:9216
M v[32:35], a[124:127], a[8:11], v[32:35]
M v[32:35], a[128:131], a[12:15], v[32:35]
M v[36:39], a[128:131], a[28:31], v[28:31]
M v[36:39], a[124:127], a[24:27], v[36:39]
M v[36:39], a[120:123], a[20:23], v[36:39]
M v[36:39], a[116:119], a[16:19], v[36:39]
M v[40:43], a[116:119], a[32:35], v[28:31]
M v[40:43], a[120:123], a[36:39], v[40:43]
ds_read_b128 a[156:159], v3 offset:10240
ds_read_b128 a[160:163], v3 offset:11264
M v[40:43], a[124:127], a[40:43], v[40:43]
M v[40:43], a[128:131], a[44:47], v[40:43]
M v[44:47], a[128:131], a[60:63], v[28:31]
M v[44:47], a[124:127], a[56:59], v[44:47]
M v[44:47], a[120:123], a[52:55], v[44:47]
M v[44:47], a[116:119], a[48:51], v[44:47]
s_waitcnt lgkmcnt(4)
M v[48:51], a[132:135], a[0:3], v[20:23]
M v[48:51], a[136:139], a[4:7], v[48:51]
ds_read_b128 a[164:167], v3 offset:12288
ds_read_b128 a[168:171], v3 offset:13312
M v[48:51], a[140:143], a[8:11], v[48:51]
M v[48:51], a[144:147], a[12:15], v[48:51]
M v[52:55], a[144:147], a[28:31], v[24:27]
M v[52:55], a[140:143], a[24:27], v[52:55]
M v[52:55], a[136:139], a[20:23], v[52:55]
M v[52:55], a[132:135], a[16:19], v[52:55]
M v[56:59], a[132:135], a[32:35], v[28:31]
M v[56:59], a[136:139], a[36:39], v[56:59]
ds_read_b128 a[172:175], v3 offset:14336
ds_read_b128 a[176:179], v3 offset:15360
M v[56:59], a[140:143], a[40:43], v[56:59]
M v[56:59], a[144:147], a[44:47], v[56:59]
M v[60:63], a[144:147], a[60:63], v[28:31]
M v[60:63], a[140:143], a[56:59], v[60:63]
M v[60:63], a[136:139], a[52:55], v[60:63]
M v[60:63], a[132:135], a[48:51], v[60:63]
s_waitcnt lgkmcnt(4)
M v[64:67], a[148:151], a[0:3], v[20:23]
M v[64:67], a[152:155], a[4:7], v[64:67]
M v[64:67], a[156:159], a[8:11], v[64:67]
M v[64:67], a[160:163], a[12:15], v[64:67]
M v[68:71], a[160:163], a[28:31], v[20:23]
M v[68:71], a[156:159], a[24:27], v[68:71]
M v[68:71], a[152:155], a[20:23], v[68:71]
M v[68:71], a[148:151], a[16:19], v[68:71]
M v[72:75], a[148:151], a[32:35], v[24:27]
M v[72:75], a[152:155], a[36:39], v[72:75]
M v[72:75], a[156:159], a[40:43], v[72:75]
M v[72:75], a[160:163], a[44:47], v[72:75]
M v[76:79], a[160:163], a[60:63], v[28:31]
M v[76:79], a[156:159], a[56:59], v[76:79]
s_waitcnt vmcnt(12) lgkmcnt(0)
s_barrier
ds_read_b128 a[116:119], v2 offset:0
ds_read_b128 a[120:123], v2 offset:1024
ds_read_b128 a[124:127], v2 offset:2048
ds_read_b128 a[128:131], v2 offset:3072
M v[76:79], a[152:155], a[52:55], v[76:79]
M v[76:79], a[148:151], a[48:51], v[76:79]
M v[80:83], a[164:167], a[0:3], v[20:23]
M v[80:83], a[168:171], a[4:7], v[80:83]
ds_read_b128 a[132:135], v2 offset:4096
ds_read_b128 a[136:139], v2 offset:5120
M v[80:83], a[172:175], a[8:11], v[80:83]
M v[80:83], a[176:179], a[12:15], v[80:83]
M v[84:87], a[176:179], a[28:31], v[20:23]
M v[84:87], a[172:175], a[24:27], v[84:87]
M v[84:87], a[168:171], a[20:23], v[84:87]
M v[84:87], a[164:167], a[16:19], v[84:87]
M v[88:91], a[164:167], a[32:35], v[20:23]
M v[88:91], a[168:171], a[36:39], v[88:91]
ds_read_b128 a[140:143], v2 offset:6144
ds_read_b128 a[144:147], v2 offset:7168
M v[88:91], a[172:175], a[40:43], v[88:91]
M v[88:91], a[176:179], a[44:47], v[88:91]
M v[92:95], a[176:179], a[60:63], v[24:27]
M v[92:95], a[172:175], a[56:59], v[92:95]
M v[92:95], a[168:171], a[52:55], v[92:95]
M v[92:95], a[164:167], a[48:51], v[92:95]
s_waitcnt vmcnt(0)
s_mov_b64 exec, 1
buffer_store_dword v6, v5, s[52:55], s65 offen sc1
s_mov_b64 exec, -1
s_add_u32 m0, s29, 65536
s_add_u32 s32, s25, 4096
buffer_load_dwordx4 v1, s[12:15], s25 offen offset:0 sc1 lds
buffer_load_dwordx4 v1, s[12:15], s25 offen offset:1024 sc1 lds
buffer_load_dwordx4 v1, s[12:15], s25 offen offset:2048 sc1 lds
buffer_load_dwordx4 v1, s[12:15], s25 offen offset:3072 sc1 lds
s_add_u32 m0, s29, 69632
s_nop 0
buffer_load_dwordx4 v1, s[12:15], s32 offen offset:0 sc1 lds
buffer_load_dwordx4 v1, s[12:15], s32 offen offset:1024 sc1 lds
buffer_load_dwordx4 v1, s[12:15], s32 offen offset:2048 sc1 lds
buffer_load_dwordx4 v1, s[12:15], s32 offen offset:3072 sc1 lds
s_add_u32 s25, s25, 32768
s_cmp_eq_u32 s25, s27
s_cselect_b32 s25, s28, s25
s_cselect_b32 s27, -1, s27
v_exp_f32 v32, v32
v_exp_f32 v33, v33
v_exp_f32 v34, v34
v_exp_f32 v35, v35
v_exp_f32 v48, v48
v_exp_f32 v49, v49
v_exp_f32 v50, v50
v_exp_f32 v51, v51
v_cvt_pk_bf16_f32 v32, v32, v33
v_cvt_pk_bf16_f32 v33, v34, v35
v_exp_f32 v36, v36
v_exp_f32 v37, v37
v_exp_f32 v38, v38
v_exp_f32 v39, v39
v_cvt_pk_bf16_f32 v34, v48, v49
v_cvt_pk_bf16_f32 v35, v50, v51
v_exp_f32 v52, v52
v_exp_f32 v53, v53
v_exp_f32 v54, v54
v_exp_f32 v55, v55
v_cvt_pk_bf16_f32 v36, v36, v37
v_cvt_pk_bf16_f32 v37, v38, v39
v_exp_f32 v40, v40
v_exp_f32 v41, v41
v_exp_f32 v42, v42
v_exp_f32 v43, v43
v_cvt_pk_bf16_f32 v38, v52, v53
v_cvt_pk_bf16_f32 v39, v54, v55
v_exp_f32 v56, v56
v_exp_f32 v57, v57
v_exp_f32 v58, v58
v_exp_f32 v59, v59
v_cvt_pk_bf16_f32 v40, v40, v41
v_cvt_pk_bf16_f32 v41, v42, v43
v_exp_f32 v44, v44
v_exp_f32 v45, v45
v_exp_f32 v46, v46
v_exp_f32 v47, v47
v_cvt_pk_bf16_f32 v42, v56, v57
v_cvt_pk_bf16_f32 v43, v58, v59
v_exp_f32 v60, v60
v_exp_f32 v61, v61
v_exp_f32 v62, v62
v_exp_f32 v63, v63
v_cvt_pk_bf16_f32 v44, v44, v45
v_cvt_pk_bf16_f32 v45, v46, v47
v_cvt_pk_bf16_f32 v46, v60, v61
v_cvt_pk_bf16_f32 v47, v62, v63
s_cmp_eq_u32 s24, 1
s_cbranch_scc1 Lk2_g1
s_mov_b32 s30, s21
s_cmp_eq_u32 s21, 0
s_cbranch_scc1 Lk2_m2
Lk2_l1:
s_waitcnt lgkmcnt(4)
s_add_u32 m0, s29, 98304
M v[96:99], a[116:119], a[0:3], 0
v_exp_f32 v64, v64
M v[96:99], a[120:123], a[4:7], v[96:99]
ds_read_b128 a[148:151], v2 offset:8192
ds_read_b128 a[152:155], v2 offset:9216
M v[96:99], a[124:127], a[8:11], v[96:99]
v_exp_f32 v65, v65
M v[96:99], a[128:131], a[12:15], v[96:99]
buffer_load_dwordx4 v1, s[12:15], s26 offen offset:0 sc1 lds
s_add_u32 s32, s26, 4096
M v[100:103], a[128:131], a[28:31], 0
v_exp_f32 v66, v66
M v[100:103], a[124:127], a[24:27], v[100:103]
v_cvt_pk_bf16_f32 v64, v64, v65
M v[100:103], a[120:123], a[20:23], v[100:103]
v_exp_f32 v67, v67
M v[100:103], a[116:119], a[16:19], v[100:103]
buffer_load_dwordx4 v1, s[12:15], s26 offen offset:1024 sc1 lds
M v[104:107], a[116:119], a[32:35], 0
v_exp_f32 v80, v80
M v[104:107], a[120:123], a[36:39], v[104:107]
ds_read_b128 a[156:159], v2 offset:10240
ds_read_b128 a[160:163], v2 offset:11264
M v[104:107], a[124:127], a[40:43], v[104:107]
v_exp_f32 v81, v81
M v[104:107], a[128:131], a[44:47], v[104:107]
buffer_load_dwordx4 v1, s[12:15], s26 offen offset:2048 sc1 lds
M v[108:111], a[128:131], a[60:63], 0
v_exp_f32 v82, v82
M v[108:111], a[124:127], a[56:59], v[108:111]
v_cvt_pk_bf16_f32 v65, v66, v67
v_cvt_pk_bf16_f32 v66, v80, v81
M v[108:111], a[120:123], a[52:55], v[108:111]
v_exp_f32 v83, v83
M v[108:111], a[116:119], a[48:51], v[108:111]
buffer_load_dwordx4 v1, s[12:15], s26 offen offset:3072 sc1 lds
s_add_u32 m0, s29, 102400
s_waitcnt lgkmcnt(4)
M v[112:115], a[132:135], a[0:3], 0
v_exp_f32 v68, v68
M v[112:115], a[136:139], a[4:7], v[112:115]
ds_read_b128 a[164:167], v2 offset:12288
ds_read_b128 a[168:171], v2 offset:13312
M v[112:115], a[140:143], a[8:11], v[112:115]
v_exp_f32 v69, v69
M v[112:115], a[144:147], a[12:15], v[112:115]
buffer_load_dwordx4 v1, s[12:15], s32 offen offset:0 sc1 lds
M v[116:119], a[144:147], a[28:31], 0
v_exp_f32 v70, v70
M v[116:119], a[140:143], a[24:27], v[116:119]
v_cvt_pk_bf16_f32 v67, v82, v83
v_cvt_pk_bf16_f32 v68, v68, v69
M v[116:119], a[136:139], a[20:23], v[116:119]
v_exp_f32 v71, v71
M v[116:119], a[132:135], a[16:19], v[116:119]
buffer_load_dwordx4 v1, s[12:15], s32 offen offset:1024 sc1 lds
M v[120:123], a[132:135], a[32:35], 0
v_exp_f32 v84, v84
M v[120:123], a[136:139], a[36:39], v[120:123]
ds_read_b128 a[172:175], v2 offset:14336
ds_read_b128 a[176:179], v2 offset:15360
M v[120:123], a[140:143], a[40:43], v[120:123]
v_exp_f32 v85, v85
M v[120:123], a[144:147], a[44:47], v[120:123]
buffer_load_dwordx4 v1, s[12:15], s32 offen offset:2048 sc1 lds
M v[124:127], a[144:147], a[60:63], 0
v_exp_f32 v86, v86
M v[124:127], a[140:143], a[56:59], v[124:127]
v_cvt_pk_bf16_f32 v69, v70, v71
v_cvt_pk_bf16_f32 v70, v84, v85
M v[124:127], a[136:139], a[52:55], v[124:127]
v_exp_f32 v87, v87
M v[124:127], a[132:135], a[48:51], v[124:127]
buffer_load_dwordx4 v1, s[12:15], s32 offen offset:3072 sc1 lds
s_waitcnt lgkmcnt(4)
M v[128:131], a[148:151], a[0:3], 0
v_exp_f32 v72, v72
M v[128:131], a[152:155], a[4:7], v[128:131]
s_add_u32 s26, s26, 32768
s_cmp_eq_u32 s26, s62
s_cselect_b32 s26, s63, s26
s_cselect_b32 s62, -1, s62
M v[128:131], a[156:159], a[8:11], v[128:131]
v_exp_f32 v73, v73
M v[128:131], a[160:163], a[12:15], v[128:131]
v_cvt_pk_bf16_f32 v71, v86, v87
v_cvt_pk_bf16_f32 v72, v72, v73
M v[132:135], a[160:163], a[28:31], 0
v_exp_f32 v74, v74
M v[132:135], a[156:159], a[24:27], v[132:135]
M v[132:135], a[152:155], a[20:23], v[132:135]
v_exp_f32 v75, v75
M v[132:135], a[148:151], a[16:19], v[132:135]
v_cvt_pk_bf16_f32 v73, v74, v75
M v[136:139], a[148:151], a[32:35], 0
v_exp_f32 v88, v88
M v[136:139], a[152:155], a[36:39], v[136:139]
M v[136:139], a[156:159], a[40:43], v[136:139]
v_exp_f32 v89, v89
M v[136:139], a[160:163], a[44:47], v[136:139]
v_cvt_pk_bf16_f32 v74, v88, v89
M v[140:143], a[160:163], a[60:63], 0
v_exp_f32 v90, v90
M v[140:143], a[156:159], a[56:59], v[140:143]
s_waitcnt vmcnt(16) lgkmcnt(0)
s_barrier
ds_read_b128 a[116:119], v2 offset:32768
ds_read_b128 a[120:123], v2 offset:40960
ds_read_b128 a[124:127], v2 offset:33792
ds_read_b128 a[128:131], v2 offset:41984
M v[140:143], a[152:155], a[52:55], v[140:143]
v_exp_f32 v91, v91
M v[140:143], a[148:151], a[48:51], v[140:143]
v_cvt_pk_bf16_f32 v75, v90, v91
M v[144:147], a[164:167], a[0:3], 0
v_exp_f32 v76, v76
M v[144:147], a[168:171], a[4:7], v[144:147]
ds_read_b128 a[132:135], v2 offset:34816
ds_read_b128 a[136:139], v2 offset:43008
M v[144:147], a[172:175], a[8:11], v[144:147]
v_exp_f32 v77, v77
M v[144:147], a[176:179], a[12:15], v[144:147]
v_cvt_pk_bf16_f32 v76, v76, v77
M v[148:151], a[176:179], a[28:31], 0
v_exp_f32 v78, v78
M v[148:151], a[172:175], a[24:27], v[148:151]
M v[148:151], a[168:171], a[20:23], v[148:151]
v_exp_f32 v79, v79
M v[148:151], a[164:167], a[16:19], v[148:151]
v_cvt_pk_bf16_f32 v77, v78, v79
M v[152:155], a[164:167], a[32:35], 0
v_exp_f32 v92, v92
M v[152:155], a[168:171], a[36:39], v[152:155]
ds_read_b128 a[140:143], v2 offset:35840
ds_read_b128 a[144:147], v2 offset:44032
M v[152:155], a[172:175], a[40:43], v[152:155]
v_exp_f32 v93, v93
M v[152:155], a[176:179], a[44:47], v[152:155]
v_cvt_pk_bf16_f32 v78, v92, v93
M v[156:159], a[176:179], a[60:63], 0
v_exp_f32 v94, v94
M v[156:159], a[172:175], a[56:59], v[156:159]
M v[156:159], a[168:171], a[52:55], v[156:159]
v_exp_f32 v95, v95
M v[156:159], a[164:167], a[48:51], v[156:159]
v_cvt_pk_bf16_f32 v79, v94, v95
s_waitcnt lgkmcnt(6)
s_add_u32 m0, s29, 0
M v[160:163], a[116:119], v[32:35], v[160:163]
v_exp_f32 v96, v96
M v[160:163], a[120:123], v[64:67], v[160:163]
ds_read_b128 a[148:151], v2 offset:36864
ds_read_b128 a[152:155], v2 offset:45056
M v[164:167], a[120:123], v[68:71], v[164:167]
v_exp_f32 v97, v97
M v[164:167], a[116:119], v[36:39], v[164:167]
buffer_load_dwordx4 v1, s[12:15], s25 offen offset:0 sc1 lds
s_add_u32 s32, s25, 4096
M v[168:171], a[116:119], v[40:43], v[168:171]
v_exp_f32 v98, v98
M v[168:171], a[120:123], v[72:75], v[168:171]
v_cvt_pk_bf16_f32 v96, v96, v97
M v[172:175], a[120:123], v[76:79], v[172:175]
v_exp_f32 v99, v99
M v[172:175], a[116:119], v[44:47], v[172:175]
buffer_load_dwordx4 v1, s[12:15], s25 offen offset:1024 sc1 lds
s_waitcnt lgkmcnt(6)
M a[96:99], a[112:115], v[32:35], a[96:99]
M a[96:99], a[112:115], v[64:67], a[96:99]
M v[176:179], a[124:127], v[32:35], v[176:179]
v_exp_f32 v112, v112
M v[176:179], a[128:131], v[64:67], v[176:179]
ds_read_b128 a[156:159], v2 offset:37888
ds_read_b128 a[160:163], v2 offset:46080
M v[180:183], a[128:131], v[68:71], v[180:183]
v_exp_f32 v113, v113
M v[180:183], a[124:127], v[36:39], v[180:183]
buffer_load_dwordx4 v1, s[12:15], s25 offen offset:2048 sc1 lds
M v[184:187], a[124:127], v[40:43], v[184:187]
v_exp_f32 v114, v114
M v[184:187], a[128:131], v[72:75], v[184:187]
v_cvt_pk_bf16_f32 v97, v98, v99
v_cvt_pk_bf16_f32 v98, v112, v113
M v[188:191], a[128:131], v[76:79], v[188:191]
v_exp_f32 v115, v115
M v[188:191], a[124:127], v[44:47], v[188:191]
buffer_load_dwordx4 v1, s[12:15], s25 offen offset:3072 sc1 lds
s_add_u32 m0, s29, 4096
s_waitcnt lgkmcnt(6)
M a[100:103], a[112:115], v[36:39], a[100:103]
M a[100:103], a[112:115], v[68:71], a[100:103]
M v[192:195], a[132:135], v[32:35], v[192:195]
v_exp_f32 v100, v100
M v[192:195], a[136:139], v[64:67], v[192:195]
ds_read_b128 a[164:167], v2 offset:38912
ds_read_b128 a[168:171], v2 offset:47104
M v[196:199], a[136:139], v[68:71], v[196:199]
v_exp_f32 v101, v101
M v[196:199], a[132:135], v[36:39], v[196:199]
buffer_load_dwordx4 v1, s[12:15], s32 offen offset:0 sc1 lds
M v[200:203], a[132:135], v[40:43], v[200:203]
v_exp_f32 v102, v102
M v[200:203], a[136:139], v[72:75], v[200:203]
v_cvt_pk_bf16_f32 v99, v114, v115
v_cvt_pk_bf16_f32 v100, v100, v101
M v[204:207], a[136:139], v[76:79], v[204:207]
v_exp_f32 v103, v103
M v[204:207], a[132:135], v[44:47], v[204:207]
buffer_load_dwordx4 v1, s[12:15], s32 offen offset:1024 sc1 lds
s_waitcnt lgkmcnt(6)
M a[104:107], a[112:115], v[40:43], a[104:107]
M a[104:107], a[112:115], v[72:75], a[104:107]
M v[208:211], a[140:143], v[32:35], v[208:211]
v_exp_f32 v116, v116
M v[208:211], a[144:147], v[64:67], v[208:211]
ds_read_b128 a[172:175], v2 offset:39936
ds_read_b128 a[176:179], v2 offset:48128
M v[212:215], a[144:147], v[68:71], v[212:215]
v_exp_f32 v117, v117
M v[212:215], a[140:143], v[36:39], v[212:215]
buffer_load_dwordx4 v1, s[12:15], s32 offen offset:2048 sc1 lds
M v[216:219], a[140:143], v[40:43], v[216:219]
v_exp_f32 v118, v118
M v[216:219], a[144:147], v[72:75], v[216:219]
v_cvt_pk_bf16_f32 v101, v102, v103
v_cvt_pk_bf16_f32 v102, v116, v117
M v[220:223], a[144:147], v[76:79], v[220:223]
v_exp_f32 v119, v119
M v[220:223], a[140:143], v[44:47], v[220:223]
buffer_load_dwordx4 v1, s[12:15], s32 offen offset:3072 sc1 lds
s_waitcnt lgkmcnt(6)
M a[108:111], a[112:115], v[44:47], a[108:111]
M a[108:111], a[112:115], v[76:79], a[108:111]
M v[224:227], a[148:151], v[32:35], v[224:227]
v_exp_f32 v104, v104
M v[224:227], a[152:155], v[64:67], v[224:227]
s_add_u32 s25, s25, 32768
s_cmp_eq_u32 s25, s27
s_cselect_b32 s25, s28, s25
s_cselect_b32 s27, -1, s27
M v[228:231], a[152:155], v[68:71], v[228:231]
v_exp_f32 v105, v105
M v[228:231], a[148:151], v[36:39], v[228:231]
v_cvt_pk_bf16_f32 v103, v118, v119
v_cvt_pk_bf16_f32 v104, v104, v105
M v[232:235], a[148:151], v[40:43], v[232:235]
v_exp_f32 v106, v106
M v[232:235], a[152:155], v[72:75], v[232:235]
M v[236:239], a[152:155], v[76:79], v[236:239]
v_exp_f32 v107, v107
M v[236:239], a[148:151], v[44:47], v[236:239]
v_cvt_pk_bf16_f32 v105, v106, v107
s_waitcnt lgkmcnt(4)
M v[240:243], a[156:159], v[32:35], v[240:243]
v_exp_f32 v120, v120
M v[240:243], a[160:163], v[64:67], v[240:243]
M v[244:247], a[160:163], v[68:71], v[244:247]
v_exp_f32 v121, v121
M v[244:247], a[156:159], v[36:39], v[244:247]
v_cvt_pk_bf16_f32 v106, v120, v121
M v[248:251], a[156:159], v[40:43], v[248:251]
v_exp_f32 v122, v122
M v[248:251], a[160:163], v[72:75], v[248:251]
s_waitcnt vmcnt(16) lgkmcnt(0)
s_barrier
ds_read_b128 a[116:119], v3 offset:0
ds_read_b128 a[120:123], v3 offset:1024
ds_read_b128 a[124:127], v3 offset:2048
ds_read_b128 a[128:131], v3 offset:3072
M v[252:255], a[160:163], v[76:79], v[252:255]
v_exp_f32 v123, v123
M v[252:255], a[156:159], v[44:47], v[252:255]
v_cvt_pk_bf16_f32 v107, v122, v123
M a[64:67], a[164:167], v[32:35], a[64:67]
v_exp_f32 v108, v108
M a[64:67], a[168:171], v[64:67], a[64:67]
ds_read_b128 a[132:135], v3 offset:4096
ds_read_b128 a[136:139], v3 offset:5120
M a[68:71], a[168:171], v[68:71], a[68:71]
v_exp_f32 v109, v109
M a[68:71], a[164:167], v[36:39], a[68:71]
v_cvt_pk_bf16_f32 v108, v108, v109
M a[72:75], a[164:167], v[40:43], a[72:75]
v_exp_f32 v110, v110
M a[72:75], a[168:171], v[72:75], a[72:75]
M a[76:79], a[168:171], v[76:79], a[76:79]
v_exp_f32 v111, v111
M a[76:79], a[164:167], v[44:47], a[76:79]
v_cvt_pk_bf16_f32 v109, v110, v111
M a[80:83], a[172:175], v[32:35], a[80:83]
v_exp_f32 v124, v124
M a[80:83], a[176:179], v[64:67], a[80:83]
ds_read_b128 a[140:143], v3 offset:6144
ds_read_b128 a[144:147], v3 offset:7168
M a[84:87], a[176:179], v[68:71], a[84:87]
v_exp_f32 v125, v125
M a[84:87], a[172:175], v[36:39], a[84:87]
v_cvt_pk_bf16_f32 v110, v124, v125
M a[88:91], a[172:175], v[40:43], a[88:91]
v_exp_f32 v126, v126
M a[88:91], a[176:179], v[72:75], a[88:91]
M a[92:95], a[176:179], v[76:79], a[92:95]
v_exp_f32 v127, v127
M a[92:95], a[172:175], v[44:47], a[92:95]
v_cvt_pk_bf16_f32 v111, v126, v127
s_sub_u32 s30, s30, 1
s_cmp_eq_u32 s30, 0
s_cbranch_scc1 Lk2_m1
s_waitcnt lgkmcnt(4)
s_add_u32 m0, s29, 32768
M v[32:35], a[116:119], a[0:3], 0
v_exp_f32 v128, v128
M v[32:35], a[120:123], a[4:7], v[32:35]
ds_read_b128 a[148:151], v3 offset:8192
ds_read_b128 a[152:155], v3 offset:9216
M v[32:35], a[124:127], a[8:11], v[32:35]
v_exp_f32 v129, v129
M v[32:35], a[128:131], a[12:15], v[32:35]
buffer_load_dwordx4 v1, s[12:15], s26 offen offset:0 sc1 lds
s_add_u32 s32, s26, 4096
M v[36:39], a[128:131], a[28:31], 0
v_exp_f32 v130, v130
M v[36:39], a[124:127], a[24:27], v[36:39]
v_cvt_pk_bf16_f32 v128, v128, v129
M v[36:39], a[120:123], a[20:23], v[36:39]
v_exp_f32 v131, v131
M v[36:39], a[116:119], a[16:19], v[36:39]
buffer_load_dwordx4 v1, s[12:15], s26 offen offset:1024 sc1 lds
M v[40:43], a[116:119], a[32:35], 0
v_exp_f32 v144, v144
M v[40:43], a[120:123], a[36:39], v[40:43]
ds_read_b128 a[156:159], v3 offset:10240
ds_read_b128 a[160:163], v3 offset:11264
M v[40:43], a[124:127], a[40:43], v[40:43]
v_exp_f32 v145, v145
M v[40:43], a[128:131], a[44:47], v[40:43]
buffer_load_dwordx4 v1, s[12:15], s26 offen offset:2048 sc1 lds
M v[44:47], a[128:131], a[60:63], 0
v_exp_f32 v146, v146
M v[44:47], a[124:127], a[56:59], v[44:47]
v_cvt_pk_bf16_f32 v129, v130, v131
v_cvt_pk_bf16_f32 v130, v144, v145
M v[44:47], a[120:123], a[52:55], v[44:47]
v_exp_f32 v147, v147
M v[44:47], a[116:119], a[48:51], v[44:47]
buffer_load_dwordx4 v1, s[12:15], s26 offen offset:3072 sc1 lds
s_add_u32 m0, s29, 36864
s_waitcnt lgkmcnt(4)
M v[48:51], a[132:135], a[0:3], 0
v_exp_f32 v132, v132
M v[48:51], a[136:139], a[4:7], v[48:51]
ds_read_b128 a[164:167], v3 offset:12288
ds_read_b128 a[168:171], v3 offset:13312
M v[48:51], a[140:143], a[8:11], v[48:51]
v_exp_f32 v133, v133
M v[48:51], a[144:147], a[12:15], v[48:51]
buffer_load_dwordx4 v1, s[12:15], s32 offen offset:0 sc1 lds
M v[52:55], a[144:147], a[28:31], 0
v_exp_f32 v134, v134
M v[52:55], a[140:143], a[24:27], v[52:55]
v_cvt_pk_bf16_f32 v131, v146, v147
v_cvt_pk_bf16_f32 v132, v132, v133
M v[52:55], a[136:139], a[20:23], v[52:55]
v_exp_f32 v135, v135
M v[52:55], a[132:135], a[16:19], v[52:55]
buffer_load_dwordx4 v1, s[12:15], s32 offen offset:1024 sc1 lds
M v[56:59], a[132:135], a[32:35], 0
v_exp_f32 v148, v148
M v[56:59], a[136:139], a[36:39], v[56:59]
ds_read_b128 a[172:175], v3 offset:14336
ds_read_b128 a[176:179], v3 offset:15360
M v[56:59], a[140:143], a[40:43], v[56:59]
v_exp_f32 v149, v149
M v[56:59], a[144:147], a[44:47], v[56:59]
buffer_load_dwordx4 v1, s[12:15], s32 offen offset:2048 sc1 lds
M v[60:63], a[144:147], a[60:63], 0
v_exp_f32 v150, v150
M v[60:63], a[140:143], a[56:59], v[60:63]
v_cvt_pk_bf16_f32 v133, v134, v135
v_cvt_pk_bf16_f32 v134, v148, v149
M v[60:63], a[136:139], a[52:55], v[60:63]
v_exp_f32 v151, v151
M v[60:63], a[132:135], a[48:51], v[60:63]
buffer_load_dwordx4 v1, s[12:15], s32 offen offset:3072 sc1 lds
s_waitcnt lgkmcnt(4)
M v[64:67], a[148:151], a[0:3], 0
v_exp_f32 v136, v136
M v[64:67], a[152:155], a[4:7], v[64:67]
s_add_u32 s26, s26, 32768
s_cmp_eq_u32 s26, s62
s_cselect_b32 s26, s63, s26
s_cselect_b32 s62, -1, s62
M v[64:67], a[156:159], a[8:11], v[64:67]
v_exp_f32 v137, v137
M v[64:67], a[160:163], a[12:15], v[64:67]
v_cvt_pk_bf16_f32 v135, v150, v151
v_cvt_pk_bf16_f32 v136, v136, v137
M v[68:71], a[160:163], a[28:31], 0
v_exp_f32 v138, v138
M v[68:71], a[156:159], a[24:27], v[68:71]
M v[68:71], a[152:155], a[20:23], v[68:71]
v_exp_f32 v139, v139
M v[68:71], a[148:151], a[16:19], v[68:71]
v_cvt_pk_bf16_f32 v137, v138, v139
M v[72:75], a[148:151], a[32:35], 0
v_exp_f32 v152, v152
M v[72:75], a[152:155], a[36:39], v[72:75]
M v[72:75], a[156:159], a[40:43], v[72:75]
v_exp_f32 v153, v153
M v[72:75], a[160:163], a[44:47], v[72:75]
v_cvt_pk_bf16_f32 v138, v152, v153
M v[76:79], a[160:163], a[60:63], 0
v_exp_f32 v154, v154
M v[76:79], a[156:159], a[56:59], v[76:79]
s_waitcnt vmcnt(16) lgkmcnt(0)
s_barrier
ds_read_b128 a[116:119], v3 offset:32768
ds_read_b128 a[120:123], v3 offset:40960
ds_read_b128 a[124:127], v3 offset:33792
ds_read_b128 a[128:131], v3 offset:41984
M v[76:79], a[152:155], a[52:55], v[76:79]
v_exp_f32 v155, v155
M v[76:79], a[148:151], a[48:51], v[76:79]
v_cvt_pk_bf16_f32 v139, v154, v155
M v[80:83], a[164:167], a[0:3], 0
v_exp_f32 v140, v140
M v[80:83], a[168:171], a[4:7], v[80:83]
ds_read_b128 a[132:135], v3 offset:34816
ds_read_b128 a[136:139], v3 offset:43008
M v[80:83], a[172:175], a[8:11], v[80:83]
v_exp_f32 v141, v141
M v[80:83], a[176:179], a[12:15], v[80:83]
v_cvt_pk_bf16_f32 v140, v140, v141
M v[84:87], a[176:179], a[28:31], 0
v_exp_f32 v142, v142
M v[84:87], a[172:175], a[24:27], v[84:87]
M v[84:87], a[168:171], a[20:23], v[84:87]
v_exp_f32 v143, v143
M v[84:87], a[164:167], a[16:19], v[84:87]
v_cvt_pk_bf16_f32 v141, v142, v143
M v[88:91], a[164:167], a[32:35], 0
v_exp_f32 v156, v156
M v[88:91], a[168:171], a[36:39], v[88:91]
ds_read_b128 a[140:143], v3 offset:35840
ds_read_b128 a[144:147], v3 offset:44032
M v[88:91], a[172:175], a[40:43], v[88:91]
v_exp_f32 v157, v157
M v[88:91], a[176:179], a[44:47], v[88:91]
v_cvt_pk_bf16_f32 v142, v156, v157
M v[92:95], a[176:179], a[60:63], 0
v_exp_f32 v158, v158
M v[92:95], a[172:175], a[56:59], v[92:95]
M v[92:95], a[168:171], a[52:55], v[92:95]
v_exp_f32 v159, v159
M v[92:95], a[164:167], a[48:51], v[92:95]
v_cvt_pk_bf16_f32 v143, v158, v159
s_waitcnt lgkmcnt(6)
s_add_u32 m0, s29, 65536
M v[160:163], a[116:119], v[96:99], v[160:163]
v_exp_f32 v32, v32
M v[160:163], a[120:123], v[128:131], v[160:163]
ds_read_b128 a[148:151], v3 offset:36864
ds_read_b128 a[152:155], v3 offset:45056
M v[164:167], a[120:123], v[132:135], v[164:167]
v_exp_f32 v33, v33
M v[164:167], a[116:119], v[100:103], v[164:167]
buffer_load_dwordx4 v1, s[12:15], s25 offen offset:0 sc1 lds
s_add_u32 s32, s25, 4096
M v[168:171], a[116:119], v[104:107], v[168:171]
v_exp_f32 v34, v34
M v[168:171], a[120:123], v[136:139], v[168:171]
v_cvt_pk_bf16_f32 v32, v32, v33
M v[172:175], a[120:123], v[140:143], v[172:175]
v_exp_f32 v35, v35
M v[172:175], a[116:119], v[108:111], v[172:175]
buffer_load_dwordx4 v1, s[12:15], s25 offen offset:1024 sc1 lds
s_waitcnt lgkmcnt(6)
M a[96:99], a[112:115], v[96:99], a[96:99]
M a[96:99], a[112:115], v[128:131], a[96:99]
M v[176:179], a[124:127], v[96:99], v[176:179]
v_exp_f32 v48, v48
M v[176:179], a[128:131], v[128:131], v[176:179]
ds_read_b128 a[156:159], v3 offset:37888
ds_read_b128 a[160:163], v3 offset:46080
M v[180:183], a[128:131], v[132:135], v[180:183]
v_exp_f32 v49, v49
M v[180:183], a[124:127], v[100:103], v[180:183]
buffer_load_dwordx4 v1, s[12:15], s25 offen offset:2048 sc1 lds
M v[184:187], a[124:127], v[104:107], v[184:187]
v_exp_f32 v50, v50
M v[184:187], a[128:131], v[136:139], v[184:187]
v_cvt_pk_bf16_f32 v33, v34, v35
v_cvt_pk_bf16_f32 v34, v48, v49
M v[188:191], a[128:131], v[140:143], v[188:191]
v_exp_f32 v51, v51
M v[188:191], a[124:127], v[108:111], v[188:191]
buffer_load_dwordx4 v1, s[12:15], s25 offen offset:3072 sc1 lds
s_add_u32 m0, s29, 69632
s_waitcnt lgkmcnt(6)
M a[100:103], a[112:115], v[100:103], a[100:103]
M a[100:103], a[112:115], v[132:135], a[100:103]
M v[192:195], a[132:135], v[96:99], v[192:195]
v_exp_f32 v36, v36
M v[192:195], a[136:139], v[128:131], v[192:195]
ds_read_b128 a[164:167], v3 offset:38912
ds_read_b128 a[168:171], v3 offset:47104
M v[196:199], a[136:139], v[132:135], v[196:199]
v_exp_f32 v37, v37
M v[196:199], a[132:135], v[100:103], v[196:199]
buffer_load_dwordx4 v1, s[12:15], s32 offen offset:0 sc1 lds
M v[200:203], a[132:135], v[104:107], v[200:203]
v_exp_f32 v38, v38
M v[200:203], a[136:139], v[136:139], v[200:203]
v_cvt_pk_bf16_f32 v35, v50, v51
v_cvt_pk_bf16_f32 v36, v36, v37
M v[204:207], a[136:139], v[140:143], v[204:207]
v_exp_f32 v39, v39
M v[204:207], a[132:135], v[108:111], v[204:207]
buffer_load_dwordx4 v1, s[12:15], s32 offen offset:1024 sc1 lds
s_waitcnt lgkmcnt(6)
M a[104:107], a[112:115], v[104:107], a[104:107]
M a[104:107], a[112:115], v[136:139], a[104:107]
M v[208:211], a[140:143], v[96:99], v[208:211]
v_exp_f32 v52, v52
M v[208:211], a[144:147], v[128:131], v[208:211]
ds_read_b128 a[172:175], v3 offset:39936
ds_read_b128 a[176:179], v3 offset:48128
M v[212:215], a[144:147], v[132:135], v[212:215]
v_exp_f32 v53, v53
M v[212:215], a[140:143], v[100:103], v[212:215]
buffer_load_dwordx4 v1, s[12:15], s32 offen offset:2048 sc1 lds
M v[216:219], a[140:143], v[104:107], v[216:219]
v_exp_f32 v54, v54
M v[216:219], a[144:147], v[136:139], v[216:219]
v_cvt_pk_bf16_f32 v37, v38, v39
v_cvt_pk_bf16_f32 v38, v52, v53
M v[220:223], a[144:147], v[140:143], v[220:223]
v_exp_f32 v55, v55
M v[220:223], a[140:143], v[108:111], v[220:223]
buffer_load_dwordx4 v1, s[12:15], s32 offen offset:3072 sc1 lds
s_waitcnt lgkmcnt(6)
M a[108:111], a[112:115], v[108:111], a[108:111]
M a[108:111], a[112:115], v[140:143], a[108:111]
M v[224:227], a[148:151], v[96:99], v[224:227]
v_exp_f32 v40, v40
M v[224:227], a[152:155], v[128:131], v[224:227]
s_add_u32 s25, s25, 32768
s_cmp_eq_u32 s25, s27
s_cselect_b32 s25, s28, s25
s_cselect_b32 s27, -1, s27
M v[228:231], a[152:155], v[132:135], v[228:231]
v_exp_f32 v41, v41
M v[228:231], a[148:151], v[100:103], v[228:231]
v_cvt_pk_bf16_f32 v39, v54, v55
v_cvt_pk_bf16_f32 v40, v40, v41
M v[232:235], a[148:151], v[104:107], v[232:235]
v_exp_f32 v42, v42
M v[232:235], a[152:155], v[136:139], v[232:235]
M v[236:239], a[152:155], v[140:143], v[236:239]
v_exp_f32 v43, v43
M v[236:239], a[148:151], v[108:111], v[236:239]
v_cvt_pk_bf16_f32 v41, v42, v43
s_waitcnt lgkmcnt(4)
M v[240:243], a[156:159], v[96:99], v[240:243]
v_exp_f32 v56, v56
M v[240:243], a[160:163], v[128:131], v[240:243]
M v[244:247], a[160:163], v[132:135], v[244:247]
v_exp_f32 v57, v57
M v[244:247], a[156:159], v[100:103], v[244:247]
v_cvt_pk_bf16_f32 v42, v56, v57
M v[248:251], a[156:159], v[104:107], v[248:251]
v_exp_f32 v58, v58
M v[248:251], a[160:163], v[136:139], v[248:251]
s_waitcnt vmcnt(16) lgkmcnt(0)
s_barrier
ds_read_b128 a[116:119], v2 offset:0
ds_read_b128 a[120:123], v2 offset:1024
ds_read_b128 a[124:127], v2 offset:2048
ds_read_b128 a[128:131], v2 offset:3072
M v[252:255], a[160:163], v[140:143], v[252:255]
v_exp_f32 v59, v59
M v[252:255], a[156:159], v[108:111], v[252:255]
v_cvt_pk_bf16_f32 v43, v58, v59
M a[64:67], a[164:167], v[96:99], a[64:67]
v_exp_f32 v44, v44
M a[64:67], a[168:171], v[128:131], a[64:67]
ds_read_b128 a[132:135], v2 offset:4096
ds_read_b128 a[136:139], v2 offset:5120
M a[68:71], a[168:171], v[132:135], a[68:71]
v_exp_f32 v45, v45
M a[68:71], a[164:167], v[100:103], a[68:71]
v_cvt_pk_bf16_f32 v44, v44, v45
M a[72:75], a[164:167], v[104:107], a[72:75]
v_exp_f32 v46, v46
M a[72:75], a[168:171], v[136:139], a[72:75]
M a[76:79], a[168:171], v[140:143], a[76:79]
v_exp_f32 v47, v47
M a[76:79], a[164:167], v[108:111], a[76:79]
v_cvt_pk_bf16_f32 v45, v46, v47
M a[80:83], a[172:175], v[96:99], a[80:83]
v_exp_f32 v60, v60
M a[80:83], a[176:179], v[128:131], a[80:83]
ds_read_b128 a[140:143], v2 offset:6144
ds_read_b128 a[144:147], v2 offset:7168
M a[84:87], a[176:179], v[132:135], a[84:87]
v_exp_f32 v61, v61
M a[84:87], a[172:175], v[100:103], a[84:87]
v_cvt_pk_bf16_f32 v46, v60, v61
M a[88:91], a[172:175], v[104:107], a[88:91]
v_exp_f32 v62, v62
M a[88:91], a[176:179], v[136:139], a[88:91]
M a[92:95], a[176:179], v[140:143], a[92:95]
v_exp_f32 v63, v63
M a[92:95], a[172:175], v[108:111], a[92:95]
v_cvt_pk_bf16_f32 v47, v62, v63
s_branch Lk2_l1
Lk2_m1:
s_lshl_b32 s33, s23, 6
s_add_i32 s33, s33, 0
s_cmp_gt_i32 s33, 0
s_cselect_b32 s34, 0, 0xf149f2ca
s_cmp_lt_i32 s33, 0
s_cselect_b32 s33, 0xf149f2ca, 0
v_mov_b32 v20, s34
v_mov_b32 v21, s34
v_mov_b32 v22, s34
v_mov_b32 v23, s34
v_mov_b32 v28, s33
v_mov_b32 v29, s33
v_mov_b32 v30, s33
v_mov_b32 v31, s33
v_med3_f32 v24, v16, v20, v28
v_med3_f32 v25, v17, v20, v28
v_med3_f32 v26, v18, v20, v28
v_med3_f32 v27, v19, v20, v28
s_waitcnt lgkmcnt(4)
s_add_u32 m0, s29, 32768
M v[32:35], a[116:119], a[0:3], v[24:27]
v_exp_f32 v128, v128
M v[32:35], a[120:123], a[4:7], v[32:35]
ds_read_b128 a[148:151], v3 offset:8192
ds_read_b128 a[152:155], v3 offset:9216
M v[32:35], a[124:127], a[8:11], v[32:35]
v_exp_f32 v129, v129
M v[32:35], a[128:131], a[12:15], v[32:35]
buffer_load_dwordx4 v1, s[12:15], s26 offen offset:0 sc1 lds
s_add_u32 s32, s26, 4096
M v[36:39], a[128:131], a[28:31], v[28:31]
v_exp_f32 v130, v130
M v[36:39], a[124:127], a[24:27], v[36:39]
v_cvt_pk_bf16_f32 v128, v128, v129
M v[36:39], a[120:123], a[20:23], v[36:39]
v_exp_f32 v131, v131
M v[36:39], a[116:119], a[16:19], v[36:39]
buffer_load_dwordx4 v1, s[12:15], s26 offen offset:1024 sc1 lds
M v[40:43], a[116:119], a[32:35], v[28:31]
v_exp_f32 v144, v144
M v[40:43], a[120:123], a[36:39], v[40:43]
ds_read_b128 a[156:159], v3 offset:10240
ds_read_b128 a[160:163], v3 offset:11264
M v[40:43], a[124:127], a[40:43], v[40:43]
v_exp_f32 v145, v145
M v[40:43], a[128:131], a[44:47], v[40:43]
buffer_load_dwordx4 v1, s[12:15], s26 offen offset:2048 sc1 lds
M v[44:47], a[128:131], a[60:63], v[28:31]
v_exp_f32 v146, v146
M v[44:47], a[124:127], a[56:59], v[44:47]
v_cvt_pk_bf16_f32 v129, v130, v131
v_cvt_pk_bf16_f32 v130, v144, v145
M v[44:47], a[120:123], a[52:55], v[44:47]
v_exp_f32 v147, v147
M v[44:47], a[116:119], a[48:51], v[44:47]
buffer_load_dwordx4 v1, s[12:15], s26 offen offset:3072 sc1 lds
s_add_u32 m0, s29, 36864
s_waitcnt lgkmcnt(4)
M v[48:51], a[132:135], a[0:3], v[20:23]
v_exp_f32 v132, v132
M v[48:51], a[136:139], a[4:7], v[48:51]
ds_read_b128 a[164:167], v3 offset:12288
ds_read_b128 a[168:171], v3 offset:13312
M v[48:51], a[140:143], a[8:11], v[48:51]
v_exp_f32 v133, v133
M v[48:51], a[144:147], a[12:15], v[48:51]
buffer_load_dwordx4 v1, s[12:15], s32 offen offset:0 sc1 lds
M v[52:55], a[144:147], a[28:31], v[24:27]
v_exp_f32 v134, v134
M v[52:55], a[140:143], a[24:27], v[52:55]
v_cvt_pk_bf16_f32 v131, v146, v147
v_cvt_pk_bf16_f32 v132, v132, v133
M v[52:55], a[136:139], a[20:23], v[52:55]
v_exp_f32 v135, v135
M v[52:55], a[132:135], a[16:19], v[52:55]
buffer_load_dwordx4 v1, s[12:15], s32 offen offset:1024 sc1 lds
M v[56:59], a[132:135], a[32:35], v[28:31]
v_exp_f32 v148, v148
M v[56:59], a[136:139], a[36:39], v[56:59]
ds_read_b128 a[172:175], v3 offset:14336
ds_read_b128 a[176:179], v3 offset:15360
M v[56:59], a[140:143], a[40:43], v[56:59]
v_exp_f32 v149, v149
M v[56:59], a[144:147], a[44:47], v[56:59]
buffer_load_dwordx4 v1, s[12:15], s32 offen offset:2048 sc1 lds
M v[60:63], a[144:147], a[60:63], v[28:31]
v_exp_f32 v150, v150
M v[60:63], a[140:143], a[56:59], v[60:63]
v_cvt_pk_bf16_f32 v133, v134, v135
v_cvt_pk_bf16_f32 v134, v148, v149
M v[60:63], a[136:139], a[52:55], v[60:63]
v_exp_f32 v151, v151
M v[60:63], a[132:135], a[48:51], v[60:63]
buffer_load_dwordx4 v1, s[12:15], s32 offen offset:3072 sc1 lds
s_waitcnt lgkmcnt(4)
M v[64:67], a[148:151], a[0:3], v[20:23]
v_exp_f32 v136, v136
M v[64:67], a[152:155], a[4:7], v[64:67]
s_add_u32 s26, s26, 32768
s_cmp_eq_u32 s26, s62
s_cselect_b32 s26, s63, s26
s_cselect_b32 s62, -1, s62
M v[64:67], a[156:159], a[8:11], v[64:67]
v_exp_f32 v137, v137
M v[64:67], a[160:163], a[12:15], v[64:67]
v_cvt_pk_bf16_f32 v135, v150, v151
v_cvt_pk_bf16_f32 v136, v136, v137
M v[68:71], a[160:163], a[28:31], v[20:23]
v_exp_f32 v138, v138
M v[68:71], a[156:159], a[24:27], v[68:71]
M v[68:71], a[152:155], a[20:23], v[68:71]
v_exp_f32 v139, v139
M v[68:71], a[148:151], a[16:19], v[68:71]
v_cvt_pk_bf16_f32 v137, v138, v139
M v[72:75], a[148:151], a[32:35], v[24:27]
v_exp_f32 v152, v152
M v[72:75], a[152:155], a[36:39], v[72:75]
M v[72:75], a[156:159], a[40:43], v[72:75]
v_exp_f32 v153, v153
M v[72:75], a[160:163], a[44:47], v[72:75]
v_cvt_pk_bf16_f32 v138, v152, v153
M v[76:79], a[160:163], a[60:63], v[28:31]
v_exp_f32 v154, v154
M v[76:79], a[156:159], a[56:59], v[76:79]
s_waitcnt vmcnt(16) lgkmcnt(0)
s_barrier
ds_read_b128 a[116:119], v3 offset:32768
ds_read_b128 a[120:123], v3 offset:40960
ds_read_b128 a[124:127], v3 offset:33792
ds_read_b128 a[128:131], v3 offset:41984
M v[76:79], a[152:155], a[52:55], v[76:79]
v_exp_f32 v155, v155
M v[76:79], a[148:151], a[48:51], v[76:79]
v_cvt_pk_bf16_f32 v139, v154, v155
M v[80:83], a[164:167], a[0:3], v[20:23]
v_exp_f32 v140, v140
M v[80:83], a[168:171], a[4:7], v[80:83]
ds_read_b128 a[132:135], v3 offset:34816
ds_read_b128 a[136:139], v3 offset:43008
M v[80:83], a[172:175], a[8:11], v[80:83]
v_exp_f32 v141, v141
M v[80:83], a[176:179], a[12:15], v[80:83]
v_cvt_pk_bf16_f32 v140, v140, v141
M v[84:87], a[176:179], a[28:31], v[20:23]
v_exp_f32 v142, v142
M v[84:87], a[172:175], a[24:27], v[84:87]
M v[84:87], a[168:171], a[20:23], v[84:87]
v_exp_f32 v143, v143
M v[84:87], a[164:167], a[16:19], v[84:87]
v_cvt_pk_bf16_f32 v141, v142, v143
M v[88:91], a[164:167], a[32:35], v[20:23]
v_exp_f32 v156, v156
M v[88:91], a[168:171], a[36:39], v[88:91]
ds_read_b128 a[140:143], v3 offset:35840
ds_read_b128 a[144:147], v3 offset:44032
M v[88:91], a[172:175], a[40:43], v[88:91]
v_exp_f32 v157, v157
M v[88:91], a[176:179], a[44:47], v[88:91]
v_cvt_pk_bf16_f32 v142, v156, v157
M v[92:95], a[176:179], a[60:63], v[24:27]
v_exp_f32 v158, v158
M v[92:95], a[172:175], a[56:59], v[92:95]
M v[92:95], a[168:171], a[52:55], v[92:95]
v_exp_f32 v159, v159
M v[92:95], a[164:167], a[48:51], v[92:95]
v_cvt_pk_bf16_f32 v143, v158, v159
s_waitcnt lgkmcnt(6)
s_add_u32 m0, s29, 65536
M v[160:163], a[116:119], v[96:99], v[160:163]
v_exp_f32 v32, v32
M v[160:163], a[120:123], v[128:131], v[160:163]
ds_read_b128 a[148:151], v3 offset:36864
ds_read_b128 a[152:155], v3 offset:45056
M v[164:167], a[120:123], v[132:135], v[164:167]
v_exp_f32 v33, v33
M v[164:167], a[116:119], v[100:103], v[164:167]
buffer_load_dwordx4 v1, s[12:15], s25 offen offset:0 sc1 lds
s_add_u32 s32, s25, 4096
M v[168:171], a[116:119], v[104:107], v[168:171]
v_exp_f32 v34, v34
M v[168:171], a[120:123], v[136:139], v[168:171]
v_cvt_pk_bf16_f32 v32, v32, v33
M v[172:175], a[120:123], v[140:143], v[172:175]
v_exp_f32 v35, v35
M v[172:175], a[116:119], v[108:111], v[172:175]
buffer_load_dwordx4 v1, s[12:15], s25 offen offset:1024 sc1 lds
s_waitcnt lgkmcnt(6)
M a[96:99], a[112:115], v[96:99], a[96:99]
M a[96:99], a[112:115], v[128:131], a[96:99]
M v[176:179], a[124:127], v[96:99], v[176:179]
v_exp_f32 v48, v48
M v[176:179], a[128:131], v[128:131], v[176:179]
ds_read_b128 a[156:159], v3 offset:37888
ds_read_b128 a[160:163], v3 offset:46080
M v[180:183], a[128:131], v[132:135], v[180:183]
v_exp_f32 v49, v49
M v[180:183], a[124:127], v[100:103], v[180:183]
buffer_load_dwordx4 v1, s[12:15], s25 offen offset:2048 sc1 lds
M v[184:187], a[124:127], v[104:107], v[184:187]
v_exp_f32 v50, v50
M v[184:187], a[128:131], v[136:139], v[184:187]
v_cvt_pk_bf16_f32 v33, v34, v35
v_cvt_pk_bf16_f32 v34, v48, v49
M v[188:191], a[128:131], v[140:143], v[188:191]
v_exp_f32 v51, v51
M v[188:191], a[124:127], v[108:111], v[188:191]
buffer_load_dwordx4 v1, s[12:15], s25 offen offset:3072 sc1 lds
s_add_u32 m0, s29, 69632
s_waitcnt lgkmcnt(6)
M a[100:103], a[112:115], v[100:103], a[100:103]
M a[100:103], a[112:115], v[132:135], a[100:103]
M v[192:195], a[132:135], v[96:99], v[192:195]
v_exp_f32 v36, v36
M v[192:195], a[136:139], v[128:131], v[192:195]
ds_read_b128 a[164:167], v3 offset:38912
ds_read_b128 a[168:171], v3 offset:47104
M v[196:199], a[136:139], v[132:135], v[196:199]
v_exp_f32 v37, v37
M v[196:199], a[132:135], v[100:103], v[196:199]
buffer_load_dwordx4 v1, s[12:15], s32 offen offset:0 sc1 lds
M v[200:203], a[132:135], v[104:107], v[200:203]
v_exp_f32 v38, v38
M v[200:203], a[136:139], v[136:139], v[200:203]
v_cvt_pk_bf16_f32 v35, v50, v51
v_cvt_pk_bf16_f32 v36, v36, v37
M v[204:207], a[136:139], v[140:143], v[204:207]
v_exp_f32 v39, v39
M v[204:207], a[132:135], v[108:111], v[204:207]
buffer_load_dwordx4 v1, s[12:15], s32 offen offset:1024 sc1 lds
s_waitcnt lgkmcnt(6)
M a[104:107], a[112:115], v[104:107], a[104:107]
M a[104:107], a[112:115], v[136:139], a[104:107]
M v[208:211], a[140:143], v[96:99], v[208:211]
v_exp_f32 v52, v52
M v[208:211], a[144:147], v[128:131], v[208:211]
ds_read_b128 a[172:175], v3 offset:39936
ds_read_b128 a[176:179], v3 offset:48128
M v[212:215], a[144:147], v[132:135], v[212:215]
v_exp_f32 v53, v53
M v[212:215], a[140:143], v[100:103], v[212:215]
buffer_load_dwordx4 v1, s[12:15], s32 offen offset:2048 sc1 lds
M v[216:219], a[140:143], v[104:107], v[216:219]
v_exp_f32 v54, v54
M v[216:219], a[144:147], v[136:139], v[216:219]
v_cvt_pk_bf16_f32 v37, v38, v39
v_cvt_pk_bf16_f32 v38, v52, v53
M v[220:223], a[144:147], v[140:143], v[220:223]
v_exp_f32 v55, v55
M v[220:223], a[140:143], v[108:111], v[220:223]
buffer_load_dwordx4 v1, s[12:15], s32 offen offset:3072 sc1 lds
s_waitcnt lgkmcnt(6)
M a[108:111], a[112:115], v[108:111], a[108:111]
M a[108:111], a[112:115], v[140:143], a[108:111]
M v[224:227], a[148:151], v[96:99], v[224:227]
v_exp_f32 v40, v40
M v[224:227], a[152:155], v[128:131], v[224:227]
s_add_u32 s25, s25, 32768
s_cmp_eq_u32 s25, s27
s_cselect_b32 s25, s28, s25
s_cselect_b32 s27, -1, s27
M v[228:231], a[152:155], v[132:135], v[228:231]
v_exp_f32 v41, v41
M v[228:231], a[148:151], v[100:103], v[228:231]
v_cvt_pk_bf16_f32 v39, v54, v55
v_cvt_pk_bf16_f32 v40, v40, v41
M v[232:235], a[148:151], v[104:107], v[232:235]
v_exp_f32 v42, v42
M v[232:235], a[152:155], v[136:139], v[232:235]
M v[236:239], a[152:155], v[140:143], v[236:239]
v_exp_f32 v43, v43
M v[236:239], a[148:151], v[108:111], v[236:239]
v_cvt_pk_bf16_f32 v41, v42, v43
s_waitcnt lgkmcnt(4)
M v[240:243], a[156:159], v[96:99], v[240:243]
v_exp_f32 v56, v56
M v[240:243], a[160:163], v[128:131], v[240:243]
M v[244:247], a[160:163], v[132:135], v[244:247]
v_exp_f32 v57, v57
M v[244:247], a[156:159], v[100:103], v[244:247]
v_cvt_pk_bf16_f32 v42, v56, v57
M v[248:251], a[156:159], v[104:107], v[248:251]
v_exp_f32 v58, v58
M v[248:251], a[160:163], v[136:139], v[248:251]
s_waitcnt vmcnt(16) lgkmcnt(0)
s_barrier
ds_read_b128 a[116:119], v2 offset:0
ds_read_b128 a[120:123], v2 offset:1024
ds_read_b128 a[124:127], v2 offset:2048
ds_read_b128 a[128:131], v2 offset:3072
M v[252:255], a[160:163], v[140:143], v[252:255]
v_exp_f32 v59, v59
M v[252:255], a[156:159], v[108:111], v[252:255]
v_cvt_pk_bf16_f32 v43, v58, v59
M a[64:67], a[164:167], v[96:99], a[64:67]
v_exp_f32 v44, v44
M a[64:67], a[168:171], v[128:131], a[64:67]
ds_read_b128 a[132:135], v2 offset:4096
ds_read_b128 a[136:139], v2 offset:5120
M a[68:71], a[168:171], v[132:135], a[68:71]
v_exp_f32 v45, v45
M a[68:71], a[164:167], v[100:103], a[68:71]
v_cvt_pk_bf16_f32 v44, v44, v45
M a[72:75], a[164:167], v[104:107], a[72:75]
v_exp_f32 v46, v46
M a[72:75], a[168:171], v[136:139], a[72:75]
M a[76:79], a[168:171], v[140:143], a[76:79]
v_exp_f32 v47, v47
M a[76:79], a[164:167], v[108:111], a[76:79]
v_cvt_pk_bf16_f32 v45, v46, v47
M a[80:83], a[172:175], v[96:99], a[80:83]
v_exp_f32 v60, v60
M a[80:83], a[176:179], v[128:131], a[80:83]
ds_read_b128 a[140:143], v2 offset:6144
ds_read_b128 a[144:147], v2 offset:7168
M a[84:87], a[176:179], v[132:135], a[84:87]
v_exp_f32 v61, v61
M a[84:87], a[172:175], v[100:103], a[84:87]
v_cvt_pk_bf16_f32 v46, v60, v61
M a[88:91], a[172:175], v[104:107], a[88:91]
v_exp_f32 v62, v62
M a[88:91], a[176:179], v[136:139], a[88:91]
M a[92:95], a[176:179], v[140:143], a[92:95]
v_exp_f32 v63, v63
M a[92:95], a[172:175], v[108:111], a[92:95]
v_cvt_pk_bf16_f32 v47, v62, v63
Lk2_m2:
s_sub_u32 s35, 15, s21
s_lshl_b32 s33, s20, 7
s_lshl_b32 s34, s35, 3
s_add_u32 s33, s33, s34
s_lshl_b32 s34, s23, 2
s_add_u32 s33, s33, s34
s_lshl_b32 s33, s33, 12
buffer_load_dwordx4 a[180:183], v1, s[8:11], s33 offen offset:0 sc1
buffer_load_dwordx4 a[184:187], v1, s[8:11], s33 offen offset:1024 sc1
buffer_load_dwordx4 a[188:191], v1, s[8:11], s33 offen offset:2048 sc1
buffer_load_dwordx4 a[192:195], v1, s[8:11], s33 offen offset:3072 sc1
s_add_u32 s33, s33, 4096
buffer_load_dwordx4 a[196:199], v1, s[8:11], s33 offen offset:0 sc1
buffer_load_dwordx4 a[200:203], v1, s[8:11], s33 offen offset:1024 sc1
buffer_load_dwordx4 a[204:207], v1, s[8:11], s33 offen offset:2048 sc1
buffer_load_dwordx4 a[208:211], v1, s[8:11], s33 offen offset:3072 sc1
s_add_u32 s33, s33, 4096
buffer_load_dwordx4 a[212:215], v1, s[8:11], s33 offen offset:0 sc1
buffer_load_dwordx4 a[216:219], v1, s[8:11], s33 offen offset:1024 sc1
buffer_load_dwordx4 a[220:223], v1, s[8:11], s33 offen offset:2048 sc1
buffer_load_dwordx4 a[224:227], v1, s[8:11], s33 offen offset:3072 sc1
s_add_u32 s33, s33, 4096
buffer_load_dwordx4 a[228:231], v1, s[8:11], s33 offen offset:0 sc1
buffer_load_dwordx4 a[232:235], v1, s[8:11], s33 offen offset:1024 sc1
buffer_load_dwordx4 a[236:239], v1, s[8:11], s33 offen offset:2048 sc1
buffer_load_dwordx4 a[240:243], v1, s[8:11], s33 offen offset:3072 sc1
s_lshl_b32 s33, s23, 6
s_add_i32 s33, s33, -64
s_cmp_gt_i32 s33, 0
s_cselect_b32 s34, 0, 0xf149f2ca
s_cmp_lt_i32 s33, 0
s_cselect_b32 s33, 0xf149f2ca, 0
v_mov_b32 v20, s34
v_mov_b32 v21, s34
v_mov_b32 v22, s34
v_mov_b32 v23, s34
v_mov_b32 v28, s33
v_mov_b32 v29, s33
v_mov_b32 v30, s33
v_mov_b32 v31, s33
v_med3_f32 v24, v16, v20, v28
v_med3_f32 v25, v17, v20, v28
v_med3_f32 v26, v18, v20, v28
v_med3_f32 v27, v19, v20, v28
s_waitcnt lgkmcnt(4)
s_add_u32 m0, s29, 98304
M v[96:99], a[116:119], a[0:3], v[24:27]
v_exp_f32 v64, v64
M v[96:99], a[120:123], a[4:7], v[96:99]
ds_read_b128 a[148:151], v2 offset:8192
ds_read_b128 a[152:155], v2 offset:9216
M v[96:99], a[124:127], a[8:11], v[96:99]
v_exp_f32 v65, v65
M v[96:99], a[128:131], a[12:15], v[96:99]
buffer_load_dwordx4 v1, s[12:15], s26 offen offset:0 sc1 lds
s_add_u32 s32, s26, 4096
M v[100:103], a[128:131], a[28:31], v[28:31]
v_exp_f32 v66, v66
M v[100:103], a[124:127], a[24:27], v[100:103]
v_cvt_pk_bf16_f32 v64, v64, v65
M v[100:103], a[120:123], a[20:23], v[100:103]
v_exp_f32 v67, v67
M v[100:103], a[116:119], a[16:19], v[100:103]
buffer_load_dwordx4 v1, s[12:15], s26 offen offset:1024 sc1 lds
M v[104:107], a[116:119], a[32:35], v[28:31]
v_exp_f32 v80, v80
M v[104:107], a[120:123], a[36:39], v[104:107]
ds_read_b128 a[156:159], v2 offset:10240
ds_read_b128 a[160:163], v2 offset:11264
M v[104:107], a[124:127], a[40:43], v[104:107]
v_exp_f32 v81, v81
M v[104:107], a[128:131], a[44:47], v[104:107]
buffer_load_dwordx4 v1, s[12:15], s26 offen offset:2048 sc1 lds
M v[108:111], a[128:131], a[60:63], v[28:31]
v_exp_f32 v82, v82
M v[108:111], a[124:127], a[56:59], v[108:111]
v_cvt_pk_bf16_f32 v65, v66, v67
v_cvt_pk_bf16_f32 v66, v80, v81
M v[108:111], a[120:123], a[52:55], v[108:111]
v_exp_f32 v83, v83
M v[108:111], a[116:119], a[48:51], v[108:111]
buffer_load_dwordx4 v1, s[12:15], s26 offen offset:3072 sc1 lds
s_add_u32 m0, s29, 102400
s_waitcnt lgkmcnt(4)
M v[112:115], a[132:135], a[0:3], v[20:23]
v_exp_f32 v68, v68
M v[112:115], a[136:139], a[4:7], v[112:115]
ds_read_b128 a[164:167], v2 offset:12288
ds_read_b128 a[168:171], v2 offset:13312
M v[112:115], a[140:143], a[8:11], v[112:115]
v_exp_f32 v69, v69
M v[112:115], a[144:147], a[12:15], v[112:115]
buffer_load_dwordx4 v1, s[12:15], s32 offen offset:0 sc1 lds
M v[116:119], a[144:147], a[28:31], v[24:27]
v_exp_f32 v70, v70
M v[116:119], a[140:143], a[24:27], v[116:119]
v_cvt_pk_bf16_f32 v67, v82, v83
v_cvt_pk_bf16_f32 v68, v68, v69
M v[116:119], a[136:139], a[20:23], v[116:119]
v_exp_f32 v71, v71
M v[116:119], a[132:135], a[16:19], v[116:119]
buffer_load_dwordx4 v1, s[12:15], s32 offen offset:1024 sc1 lds
M v[120:123], a[132:135], a[32:35], v[28:31]
v_exp_f32 v84, v84
M v[120:123], a[136:139], a[36:39], v[120:123]
ds_read_b128 a[172:175], v2 offset:14336
ds_read_b128 a[176:179], v2 offset:15360
M v[120:123], a[140:143], a[40:43], v[120:123]
v_exp_f32 v85, v85
M v[120:123], a[144:147], a[44:47], v[120:123]
buffer_load_dwordx4 v1, s[12:15], s32 offen offset:2048 sc1 lds
M v[124:127], a[144:147], a[60:63], v[28:31]
v_exp_f32 v86, v86
M v[124:127], a[140:143], a[56:59], v[124:127]
v_cvt_pk_bf16_f32 v69, v70, v71
v_cvt_pk_bf16_f32 v70, v84, v85
M v[124:127], a[136:139], a[52:55], v[124:127]
v_exp_f32 v87, v87
M v[124:127], a[132:135], a[48:51], v[124:127]
buffer_load_dwordx4 v1, s[12:15], s32 offen offset:3072 sc1 lds
s_waitcnt lgkmcnt(4)
M v[128:131], a[148:151], a[0:3], v[20:23]
v_exp_f32 v72, v72
M v[128:131], a[152:155], a[4:7], v[128:131]
s_add_u32 s26, s26, 32768
s_cmp_eq_u32 s26, s62
s_cselect_b32 s26, s63, s26
s_cselect_b32 s62, -1, s62
M v[128:131], a[156:159], a[8:11], v[128:131]
v_exp_f32 v73, v73
M v[128:131], a[160:163], a[12:15], v[128:131]
v_cvt_pk_bf16_f32 v71, v86, v87
v_cvt_pk_bf16_f32 v72, v72, v73
M v[132:135], a[160:163], a[28:31], v[20:23]
v_exp_f32 v74, v74
M v[132:135], a[156:159], a[24:27], v[132:135]
M v[132:135], a[152:155], a[20:23], v[132:135]
v_exp_f32 v75, v75
M v[132:135], a[148:151], a[16:19], v[132:135]
v_cvt_pk_bf16_f32 v73, v74, v75
M v[136:139], a[148:151], a[32:35], v[24:27]
v_exp_f32 v88, v88
M v[136:139], a[152:155], a[36:39], v[136:139]
M v[136:139], a[156:159], a[40:43], v[136:139]
v_exp_f32 v89, v89
M v[136:139], a[160:163], a[44:47], v[136:139]
v_cvt_pk_bf16_f32 v74, v88, v89
M v[140:143], a[160:163], a[60:63], v[28:31]
v_exp_f32 v90, v90
M v[140:143], a[156:159], a[56:59], v[140:143]
s_waitcnt vmcnt(32) lgkmcnt(0)
s_barrier
ds_read_b128 a[116:119], v2 offset:32768
ds_read_b128 a[120:123], v2 offset:40960
ds_read_b128 a[124:127], v2 offset:33792
ds_read_b128 a[128:131], v2 offset:41984
M v[140:143], a[152:155], a[52:55], v[140:143]
v_exp_f32 v91, v91
M v[140:143], a[148:151], a[48:51], v[140:143]
v_cvt_pk_bf16_f32 v75, v90, v91
M v[144:147], a[164:167], a[0:3], v[20:23]
v_exp_f32 v76, v76
M v[144:147], a[168:171], a[4:7], v[144:147]
ds_read_b128 a[132:135], v2 offset:34816
ds_read_b128 a[136:139], v2 offset:43008
M v[144:147], a[172:175], a[8:11], v[144:147]
v_exp_f32 v77, v77
M v[144:147], a[176:179], a[12:15], v[144:147]
v_cvt_pk_bf16_f32 v76, v76, v77
M v[148:151], a[176:179], a[28:31], v[20:23]
v_exp_f32 v78, v78
M v[148:151], a[172:175], a[24:27], v[148:151]
M v[148:151], a[168:171], a[20:23], v[148:151]
v_exp_f32 v79, v79
M v[148:151], a[164:167], a[16:19], v[148:151]
v_cvt_pk_bf16_f32 v77, v78, v79
M v[152:155], a[164:167], a[32:35], v[20:23]
v_exp_f32 v92, v92
M v[152:155], a[168:171], a[36:39], v[152:155]
ds_read_b128 a[140:143], v2 offset:35840
ds_read_b128 a[144:147], v2 offset:44032
M v[152:155], a[172:175], a[40:43], v[152:155]
v_exp_f32 v93, v93
M v[152:155], a[176:179], a[44:47], v[152:155]
v_cvt_pk_bf16_f32 v78, v92, v93
M v[156:159], a[176:179], a[60:63], v[24:27]
v_exp_f32 v94, v94
M v[156:159], a[172:175], a[56:59], v[156:159]
M v[156:159], a[168:171], a[52:55], v[156:159]
v_exp_f32 v95, v95
M v[156:159], a[164:167], a[48:51], v[156:159]
v_cvt_pk_bf16_f32 v79, v94, v95
s_waitcnt lgkmcnt(6)
s_add_u32 m0, s29, 0
M v[160:163], a[116:119], v[32:35], v[160:163]
v_exp_f32 v96, v96
M v[160:163], a[120:123], v[64:67], v[160:163]
ds_read_b128 a[148:151], v2 offset:36864
ds_read_b128 a[152:155], v2 offset:45056
M v[164:167], a[120:123], v[68:71], v[164:167]
v_exp_f32 v97, v97
M v[164:167], a[116:119], v[36:39], v[164:167]
buffer_load_dwordx4 v1, s[12:15], s25 offen offset:0 sc1 lds
s_add_u32 s32, s25, 4096
M v[168:171], a[116:119], v[40:43], v[168:171]
v_exp_f32 v98, v98
M v[168:171], a[120:123], v[72:75], v[168:171]
v_cvt_pk_bf16_f32 v96, v96, v97
M v[172:175], a[120:123], v[76:79], v[172:175]
v_exp_f32 v99, v99
M v[172:175], a[116:119], v[44:47], v[172:175]
buffer_load_dwordx4 v1, s[12:15], s25 offen offset:1024 sc1 lds
s_waitcnt lgkmcnt(6)
M a[96:99], a[112:115], v[32:35], a[96:99]
M a[96:99], a[112:115], v[64:67], a[96:99]
M v[176:179], a[124:127], v[32:35], v[176:179]
v_exp_f32 v112, v112
M v[176:179], a[128:131], v[64:67], v[176:179]
ds_read_b128 a[156:159], v2 offset:37888
ds_read_b128 a[160:163], v2 offset:46080
M v[180:183], a[128:131], v[68:71], v[180:183]
v_exp_f32 v113, v113
M v[180:183], a[124:127], v[36:39], v[180:183]
buffer_load_dwordx4 v1, s[12:15], s25 offen offset:2048 sc1 lds
M v[184:187], a[124:127], v[40:43], v[184:187]
v_exp_f32 v114, v114
M v[184:187], a[128:131], v[72:75], v[184:187]
v_cvt_pk_bf16_f32 v97, v98, v99
v_cvt_pk_bf16_f32 v98, v112, v113
M v[188:191], a[128:131], v[76:79], v[188:191]
v_exp_f32 v115, v115
M v[188:191], a[124:127], v[44:47], v[188:191]
buffer_load_dwordx4 v1, s[12:15], s25 offen offset:3072 sc1 lds
s_add_u32 m0, s29, 4096
s_waitcnt lgkmcnt(6)
M a[100:103], a[112:115], v[36:39], a[100:103]
M a[100:103], a[112:115], v[68:71], a[100:103]
M v[192:195], a[132:135], v[32:35], v[192:195]
v_exp_f32 v100, v100
M v[192:195], a[136:139], v[64:67], v[192:195]
ds_read_b128 a[164:167], v2 offset:38912
ds_read_b128 a[168:171], v2 offset:47104
M v[196:199], a[136:139], v[68:71], v[196:199]
v_exp_f32 v101, v101
M v[196:199], a[132:135], v[36:39], v[196:199]
buffer_load_dwordx4 v1, s[12:15], s32 offen offset:0 sc1 lds
M v[200:203], a[132:135], v[40:43], v[200:203]
v_exp_f32 v102, v102
M v[200:203], a[136:139], v[72:75], v[200:203]
v_cvt_pk_bf16_f32 v99, v114, v115
v_cvt_pk_bf16_f32 v100, v100, v101
M v[204:207], a[136:139], v[76:79], v[204:207]
v_exp_f32 v103, v103
M v[204:207], a[132:135], v[44:47], v[204:207]
buffer_load_dwordx4 v1, s[12:15], s32 offen offset:1024 sc1 lds
s_waitcnt lgkmcnt(6)
M a[104:107], a[112:115], v[40:43], a[104:107]
M a[104:107], a[112:115], v[72:75], a[104:107]
M v[208:211], a[140:143], v[32:35], v[208:211]
v_exp_f32 v116, v116
M v[208:211], a[144:147], v[64:67], v[208:211]
ds_read_b128 a[172:175], v2 offset:39936
ds_read_b128 a[176:179], v2 offset:48128
M v[212:215], a[144:147], v[68:71], v[212:215]
v_exp_f32 v117, v117
M v[212:215], a[140:143], v[36:39], v[212:215]
buffer_load_dwordx4 v1, s[12:15], s32 offen offset:2048 sc1 lds
M v[216:219], a[140:143], v[40:43], v[216:219]
v_exp_f32 v118, v118
M v[216:219], a[144:147], v[72:75], v[216:219]
v_cvt_pk_bf16_f32 v101, v102, v103
v_cvt_pk_bf16_f32 v102, v116, v117
M v[220:223], a[144:147], v[76:79], v[220:223]
v_exp_f32 v119, v119
M v[220:223], a[140:143], v[44:47], v[220:223]
buffer_load_dwordx4 v1, s[12:15], s32 offen offset:3072 sc1 lds
s_waitcnt lgkmcnt(6)
M a[108:111], a[112:115], v[44:47], a[108:111]
M a[108:111], a[112:115], v[76:79], a[108:111]
M v[224:227], a[148:151], v[32:35], v[224:227]
v_exp_f32 v104, v104
M v[224:227], a[152:155], v[64:67], v[224:227]
s_add_u32 s25, s25, 32768
s_cmp_eq_u32 s25, s27
s_cselect_b32 s25, s28, s25
s_cselect_b32 s27, -1, s27
M v[228:231], a[152:155], v[68:71], v[228:231]
v_exp_f32 v105, v105
M v[228:231], a[148:151], v[36:39], v[228:231]
v_cvt_pk_bf16_f32 v103, v118, v119
v_cvt_pk_bf16_f32 v104, v104, v105
M v[232:235], a[148:151], v[40:43], v[232:235]
v_exp_f32 v106, v106
M v[232:235], a[152:155], v[72:75], v[232:235]
M v[236:239], a[152:155], v[76:79], v[236:239]
v_exp_f32 v107, v107
M v[236:239], a[148:151], v[44:47], v[236:239]
v_cvt_pk_bf16_f32 v105, v106, v107
s_waitcnt lgkmcnt(4)
M v[240:243], a[156:159], v[32:35], v[240:243]
v_exp_f32 v120, v120
M v[240:243], a[160:163], v[64:67], v[240:243]
M v[244:247], a[160:163], v[68:71], v[244:247]
v_exp_f32 v121, v121
M v[244:247], a[156:159], v[36:39], v[244:247]
v_cvt_pk_bf16_f32 v106, v120, v121
M v[248:251], a[156:159], v[40:43], v[248:251]
v_exp_f32 v122, v122
M v[248:251], a[160:163], v[72:75], v[248:251]
s_waitcnt vmcnt(32) lgkmcnt(0)
s_barrier
ds_read_b128 a[116:119], v3 offset:0
ds_read_b128 a[120:123], v3 offset:1024
ds_read_b128 a[124:127], v3 offset:2048
ds_read_b128 a[128:131], v3 offset:3072
M v[252:255], a[160:163], v[76:79], v[252:255]
v_exp_f32 v123, v123
M v[252:255], a[156:159], v[44:47], v[252:255]
v_cvt_pk_bf16_f32 v107, v122, v123
M a[64:67], a[164:167], v[32:35], a[64:67]
v_exp_f32 v108, v108
M a[64:67], a[168:171], v[64:67], a[64:67]
ds_read_b128 a[132:135], v3 offset:4096
ds_read_b128 a[136:139], v3 offset:5120
M a[68:71], a[168:171], v[68:71], a[68:71]
v_exp_f32 v109, v109
M a[68:71], a[164:167], v[36:39], a[68:71]
v_cvt_pk_bf16_f32 v108, v108, v109
M a[72:75], a[164:167], v[40:43], a[72:75]
v_exp_f32 v110, v110
M a[72:75], a[168:171], v[72:75], a[72:75]
M a[76:79], a[168:171], v[76:79], a[76:79]
v_exp_f32 v111, v111
M a[76:79], a[164:167], v[44:47], a[76:79]
v_cvt_pk_bf16_f32 v109, v110, v111
M a[80:83], a[172:175], v[32:35], a[80:83]
v_exp_f32 v124, v124
M a[80:83], a[176:179], v[64:67], a[80:83]
ds_read_b128 a[140:143], v3 offset:6144
ds_read_b128 a[144:147], v3 offset:7168
M a[84:87], a[176:179], v[68:71], a[84:87]
v_exp_f32 v125, v125
M a[84:87], a[172:175], v[36:39], a[84:87]
v_cvt_pk_bf16_f32 v110, v124, v125
M a[88:91], a[172:175], v[40:43], a[88:91]
v_exp_f32 v126, v126
M a[88:91], a[176:179], v[72:75], a[88:91]
M a[92:95], a[176:179], v[76:79], a[92:95]
v_exp_f32 v127, v127
M a[92:95], a[172:175], v[44:47], a[92:95]
v_cvt_pk_bf16_f32 v111, v126, v127
s_waitcnt vmcnt(16)
s_waitcnt lgkmcnt(4)
s_add_u32 m0, s29, 32768
M v[32:35], a[116:119], a[180:183], 0
v_exp_f32 v128, v128
M v[32:35], a[120:123], a[184:187], v[32:35]
ds_read_b128 a[148:151], v3 offset:8192
ds_read_b128 a[152:155], v3 offset:9216
M v[32:35], a[124:127], a[188:191], v[32:35]
v_exp_f32 v129, v129
M v[32:35], a[128:131], a[192:195], v[32:35]
buffer_load_dwordx4 v1, s[12:15], s26 offen offset:0 sc1 lds
s_add_u32 s32, s26, 4096
M v[36:39], a[128:131], a[208:211], 0
v_exp_f32 v130, v130
M v[36:39], a[124:127], a[204:207], v[36:39]
v_cvt_pk_bf16_f32 v128, v128, v129
M v[36:39], a[120:123], a[200:203], v[36:39]
v_exp_f32 v131, v131
M v[36:39], a[116:119], a[196:199], v[36:39]
buffer_load_dwordx4 v1, s[12:15], s26 offen offset:1024 sc1 lds
M v[40:43], a[116:119], a[212:215], 0
v_exp_f32 v144, v144
M v[40:43], a[120:123], a[216:219], v[40:43]
ds_read_b128 a[156:159], v3 offset:10240
ds_read_b128 a[160:163], v3 offset:11264
M v[40:43], a[124:127], a[220:223], v[40:43]
v_exp_f32 v145, v145
M v[40:43], a[128:131], a[224:227], v[40:43]
buffer_load_dwordx4 v1, s[12:15], s26 offen offset:2048 sc1 lds
M v[44:47], a[128:131], a[240:243], 0
v_exp_f32 v146, v146
M v[44:47], a[124:127], a[236:239], v[44:47]
v_cvt_pk_bf16_f32 v129, v130, v131
v_cvt_pk_bf16_f32 v130, v144, v145
M v[44:47], a[120:123], a[232:235], v[44:47]
v_exp_f32 v147, v147
M v[44:47], a[116:119], a[228:231], v[44:47]
buffer_load_dwordx4 v1, s[12:15], s26 offen offset:3072 sc1 lds
s_add_u32 m0, s29, 36864
s_waitcnt lgkmcnt(4)
M v[48:51], a[132:135], a[180:183], 0
v_exp_f32 v132, v132
M v[48:51], a[136:139], a[184:187], v[48:51]
ds_read_b128 a[164:167], v3 offset:12288
ds_read_b128 a[168:171], v3 offset:13312
M v[48:51], a[140:143], a[188:191], v[48:51]
v_exp_f32 v133, v133
M v[48:51], a[144:147], a[192:195], v[48:51]
buffer_load_dwordx4 v1, s[12:15], s32 offen offset:0 sc1 lds
M v[52:55], a[144:147], a[208:211], 0
v_exp_f32 v134, v134
M v[52:55], a[140:143], a[204:207], v[52:55]
v_cvt_pk_bf16_f32 v131, v146, v147
v_cvt_pk_bf16_f32 v132, v132, v133
M v[52:55], a[136:139], a[200:203], v[52:55]
v_exp_f32 v135, v135
M v[52:55], a[132:135], a[196:199], v[52:55]
buffer_load_dwordx4 v1, s[12:15], s32 offen offset:1024 sc1 lds
M v[56:59], a[132:135], a[212:215], 0
v_exp_f32 v148, v148
M v[56:59], a[136:139], a[216:219], v[56:59]
ds_read_b128 a[172:175], v3 offset:14336
ds_read_b128 a[176:179], v3 offset:15360
M v[56:59], a[140:143], a[220:223], v[56:59]
v_exp_f32 v149, v149
M v[56:59], a[144:147], a[224:227], v[56:59]
buffer_load_dwordx4 v1, s[12:15], s32 offen offset:2048 sc1 lds
M v[60:63], a[144:147], a[240:243], 0
v_exp_f32 v150, v150
M v[60:63], a[140:143], a[236:239], v[60:63]
v_cvt_pk_bf16_f32 v133, v134, v135
v_cvt_pk_bf16_f32 v134, v148, v149
M v[60:63], a[136:139], a[232:235], v[60:63]
v_exp_f32 v151, v151
M v[60:63], a[132:135], a[228:231], v[60:63]
buffer_load_dwordx4 v1, s[12:15], s32 offen offset:3072 sc1 lds
s_waitcnt lgkmcnt(4)
M v[64:67], a[148:151], a[180:183], 0
v_exp_f32 v136, v136
M v[64:67], a[152:155], a[184:187], v[64:67]
s_add_u32 s26, s26, 32768
s_cmp_eq_u32 s26, s62
s_cselect_b32 s26, s63, s26
s_cselect_b32 s62, -1, s62
M v[64:67], a[156:159], a[188:191], v[64:67]
v_exp_f32 v137, v137
M v[64:67], a[160:163], a[192:195], v[64:67]
v_cvt_pk_bf16_f32 v135, v150, v151
v_cvt_pk_bf16_f32 v136, v136, v137
M v[68:71], a[160:163], a[208:211], 0
v_exp_f32 v138, v138
M v[68:71], a[156:159], a[204:207], v[68:71]
M v[68:71], a[152:155], a[200:203], v[68:71]
v_exp_f32 v139, v139
M v[68:71], a[148:151], a[196:199], v[68:71]
v_cvt_pk_bf16_f32 v137, v138, v139
M v[72:75], a[148:151], a[212:215], 0
v_exp_f32 v152, v152
M v[72:75], a[152:155], a[216:219], v[72:75]
M v[72:75], a[156:159], a[220:223], v[72:75]
v_exp_f32 v153, v153
M v[72:75], a[160:163], a[224:227], v[72:75]
v_cvt_pk_bf16_f32 v138, v152, v153
M v[76:79], a[160:163], a[240:243], 0
v_exp_f32 v154, v154
M v[76:79], a[156:159], a[236:239], v[76:79]
s_waitcnt vmcnt(16) lgkmcnt(0)
s_barrier
ds_read_b128 a[116:119], v3 offset:32768
ds_read_b128 a[120:123], v3 offset:40960
ds_read_b128 a[124:127], v3 offset:33792
ds_read_b128 a[128:131], v3 offset:41984
M v[76:79], a[152:155], a[232:235], v[76:79]
v_exp_f32 v155, v155
M v[76:79], a[148:151], a[228:231], v[76:79]
v_cvt_pk_bf16_f32 v139, v154, v155
M v[80:83], a[164:167], a[180:183], 0
v_exp_f32 v140, v140
M v[80:83], a[168:171], a[184:187], v[80:83]
ds_read_b128 a[132:135], v3 offset:34816
ds_read_b128 a[136:139], v3 offset:43008
M v[80:83], a[172:175], a[188:191], v[80:83]
v_exp_f32 v141, v141
M v[80:83], a[176:179], a[192:195], v[80:83]
v_cvt_pk_bf16_f32 v140, v140, v141
M v[84:87], a[176:179], a[208:211], 0
v_exp_f32 v142, v142
M v[84:87], a[172:175], a[204:207], v[84:87]
M v[84:87], a[168:171], a[200:203], v[84:87]
v_exp_f32 v143, v143
M v[84:87], a[164:167], a[196:199], v[84:87]
v_cvt_pk_bf16_f32 v141, v142, v143
M v[88:91], a[164:167], a[212:215], 0
v_exp_f32 v156, v156
M v[88:91], a[168:171], a[216:219], v[88:91]
ds_read_b128 a[140:143], v3 offset:35840
ds_read_b128 a[144:147], v3 offset:44032
M v[88:91], a[172:175], a[220:223], v[88:91]
v_exp_f32 v157, v157
M v[88:91], a[176:179], a[224:227], v[88:91]
v_cvt_pk_bf16_f32 v142, v156, v157
M v[92:95], a[176:179], a[240:243], 0
v_exp_f32 v158, v158
M v[92:95], a[172:175], a[236:239], v[92:95]
M v[92:95], a[168:171], a[232:235], v[92:95]
v_exp_f32 v159, v159
M v[92:95], a[164:167], a[228:231], v[92:95]
v_cvt_pk_bf16_f32 v143, v158, v159
s_waitcnt lgkmcnt(6)
s_add_u32 m0, s29, 65536
M v[160:163], a[116:119], v[96:99], v[160:163]
v_exp_f32 v32, v32
M v[160:163], a[120:123], v[128:131], v[160:163]
ds_read_b128 a[148:151], v3 offset:36864
ds_read_b128 a[152:155], v3 offset:45056
M v[164:167], a[120:123], v[132:135], v[164:167]
v_exp_f32 v33, v33
M v[164:167], a[116:119], v[100:103], v[164:167]
buffer_load_dwordx4 v1, s[12:15], s25 offen offset:0 sc1 lds
s_add_u32 s32, s25, 4096
M v[168:171], a[116:119], v[104:107], v[168:171]
v_exp_f32 v34, v34
M v[168:171], a[120:123], v[136:139], v[168:171]
v_cvt_pk_bf16_f32 v32, v32, v33
M v[172:175], a[120:123], v[140:143], v[172:175]
v_exp_f32 v35, v35
M v[172:175], a[116:119], v[108:111], v[172:175]
buffer_load_dwordx4 v1, s[12:15], s25 offen offset:1024 sc1 lds
s_waitcnt lgkmcnt(6)
M a[96:99], a[112:115], v[96:99], a[96:99]
M a[96:99], a[112:115], v[128:131], a[96:99]
M v[176:179], a[124:127], v[96:99], v[176:179]
v_exp_f32 v48, v48
M v[176:179], a[128:131], v[128:131], v[176:179]
ds_read_b128 a[156:159], v3 offset:37888
ds_read_b128 a[160:163], v3 offset:46080
M v[180:183], a[128:131], v[132:135], v[180:183]
v_exp_f32 v49, v49
M v[180:183], a[124:127], v[100:103], v[180:183]
buffer_load_dwordx4 v1, s[12:15], s25 offen offset:2048 sc1 lds
M v[184:187], a[124:127], v[104:107], v[184:187]
v_exp_f32 v50, v50
M v[184:187], a[128:131], v[136:139], v[184:187]
v_cvt_pk_bf16_f32 v33, v34, v35
v_cvt_pk_bf16_f32 v34, v48, v49
M v[188:191], a[128:131], v[140:143], v[188:191]
v_exp_f32 v51, v51
M v[188:191], a[124:127], v[108:111], v[188:191]
buffer_load_dwordx4 v1, s[12:15], s25 offen offset:3072 sc1 lds
s_add_u32 m0, s29, 69632
s_waitcnt lgkmcnt(6)
M a[100:103], a[112:115], v[100:103], a[100:103]
M a[100:103], a[112:115], v[132:135], a[100:103]
M v[192:195], a[132:135], v[96:99], v[192:195]
v_exp_f32 v36, v36
M v[192:195], a[136:139], v[128:131], v[192:195]
ds_read_b128 a[164:167], v3 offset:38912
ds_read_b128 a[168:171], v3 offset:47104
M v[196:199], a[136:139], v[132:135], v[196:199]
v_exp_f32 v37, v37
M v[196:199], a[132:135], v[100:103], v[196:199]
buffer_load_dwordx4 v1, s[12:15], s32 offen offset:0 sc1 lds
M v[200:203], a[132:135], v[104:107], v[200:203]
v_exp_f32 v38, v38
M v[200:203], a[136:139], v[136:139], v[200:203]
v_cvt_pk_bf16_f32 v35, v50, v51
v_cvt_pk_bf16_f32 v36, v36, v37
M v[204:207], a[136:139], v[140:143], v[204:207]
v_exp_f32 v39, v39
M v[204:207], a[132:135], v[108:111], v[204:207]
buffer_load_dwordx4 v1, s[12:15], s32 offen offset:1024 sc1 lds
s_waitcnt lgkmcnt(6)
M a[104:107], a[112:115], v[104:107], a[104:107]
M a[104:107], a[112:115], v[136:139], a[104:107]
M v[208:211], a[140:143], v[96:99], v[208:211]
v_exp_f32 v52, v52
M v[208:211], a[144:147], v[128:131], v[208:211]
ds_read_b128 a[172:175], v3 offset:39936
ds_read_b128 a[176:179], v3 offset:48128
M v[212:215], a[144:147], v[132:135], v[212:215]
v_exp_f32 v53, v53
M v[212:215], a[140:143], v[100:103], v[212:215]
buffer_load_dwordx4 v1, s[12:15], s32 offen offset:2048 sc1 lds
M v[216:219], a[140:143], v[104:107], v[216:219]
v_exp_f32 v54, v54
M v[216:219], a[144:147], v[136:139], v[216:219]
v_cvt_pk_bf16_f32 v37, v38, v39
v_cvt_pk_bf16_f32 v38, v52, v53
M v[220:223], a[144:147], v[140:143], v[220:223]
v_exp_f32 v55, v55
M v[220:223], a[140:143], v[108:111], v[220:223]
buffer_load_dwordx4 v1, s[12:15], s32 offen offset:3072 sc1 lds
s_waitcnt lgkmcnt(6)
M a[108:111], a[112:115], v[108:111], a[108:111]
M a[108:111], a[112:115], v[140:143], a[108:111]
M v[224:227], a[148:151], v[96:99], v[224:227]
v_exp_f32 v40, v40
M v[224:227], a[152:155], v[128:131], v[224:227]
s_add_u32 s25, s25, 32768
s_cmp_eq_u32 s25, s27
s_cselect_b32 s25, s28, s25
s_cselect_b32 s27, -1, s27
M v[228:231], a[152:155], v[132:135], v[228:231]
v_exp_f32 v41, v41
M v[228:231], a[148:151], v[100:103], v[228:231]
v_cvt_pk_bf16_f32 v39, v54, v55
v_cvt_pk_bf16_f32 v40, v40, v41
M v[232:235], a[148:151], v[104:107], v[232:235]
v_exp_f32 v42, v42
M v[232:235], a[152:155], v[136:139], v[232:235]
M v[236:239], a[152:155], v[140:143], v[236:239]
v_exp_f32 v43, v43
M v[236:239], a[148:151], v[108:111], v[236:239]
v_cvt_pk_bf16_f32 v41, v42, v43
s_waitcnt lgkmcnt(4)
M v[240:243], a[156:159], v[96:99], v[240:243]
v_exp_f32 v56, v56
M v[240:243], a[160:163], v[128:131], v[240:243]
M v[244:247], a[160:163], v[132:135], v[244:247]
v_exp_f32 v57, v57
M v[244:247], a[156:159], v[100:103], v[244:247]
v_cvt_pk_bf16_f32 v42, v56, v57
M v[248:251], a[156:159], v[104:107], v[248:251]
v_exp_f32 v58, v58
M v[248:251], a[160:163], v[136:139], v[248:251]
s_waitcnt vmcnt(16) lgkmcnt(0)
s_barrier
ds_read_b128 a[116:119], v2 offset:0
ds_read_b128 a[120:123], v2 offset:1024
ds_read_b128 a[124:127], v2 offset:2048
ds_read_b128 a[128:131], v2 offset:3072
M v[252:255], a[160:163], v[140:143], v[252:255]
v_exp_f32 v59, v59
M v[252:255], a[156:159], v[108:111], v[252:255]
v_cvt_pk_bf16_f32 v43, v58, v59
M a[64:67], a[164:167], v[96:99], a[64:67]
v_exp_f32 v44, v44
M a[64:67], a[168:171], v[128:131], a[64:67]
ds_read_b128 a[132:135], v2 offset:4096
ds_read_b128 a[136:139], v2 offset:5120
M a[68:71], a[168:171], v[132:135], a[68:71]
v_exp_f32 v45, v45
M a[68:71], a[164:167], v[100:103], a[68:71]
v_cvt_pk_bf16_f32 v44, v44, v45
M a[72:75], a[164:167], v[104:107], a[72:75]
v_exp_f32 v46, v46
M a[72:75], a[168:171], v[136:139], a[72:75]
M a[76:79], a[168:171], v[140:143], a[76:79]
v_exp_f32 v47, v47
M a[76:79], a[164:167], v[108:111], a[76:79]
v_cvt_pk_bf16_f32 v45, v46, v47
M a[80:83], a[172:175], v[96:99], a[80:83]
v_exp_f32 v60, v60
M a[80:83], a[176:179], v[128:131], a[80:83]
ds_read_b128 a[140:143], v2 offset:6144
ds_read_b128 a[144:147], v2 offset:7168
M a[84:87], a[176:179], v[132:135], a[84:87]
v_exp_f32 v61, v61
M a[84:87], a[172:175], v[100:103], a[84:87]
v_cvt_pk_bf16_f32 v46, v60, v61
M a[88:91], a[172:175], v[104:107], a[88:91]
v_exp_f32 v62, v62
M a[88:91], a[176:179], v[136:139], a[88:91]
M a[92:95], a[176:179], v[140:143], a[92:95]
v_exp_f32 v63, v63
M a[92:95], a[172:175], v[108:111], a[92:95]
v_cvt_pk_bf16_f32 v47, v62, v63
v_accvgpr_read_b32 v20, a96
v_accvgpr_read_b32 v21, a100
v_accvgpr_read_b32 v22, a104
v_accvgpr_read_b32 v23, a108
v_rcp_f32 v8, v20
v_rcp_f32 v9, v21
v_rcp_f32 v10, v22
v_rcp_f32 v11, v23
v_subrev_u32 v20, 0x21800000, v20
v_subrev_u32 v21, 0x21800000, v21
v_subrev_u32 v22, 0x21800000, v22
v_subrev_u32 v23, 0x21800000, v23
v_max_u32 v12, v20, v21
v_max3_u32 v12, v12, v22, v23
s_mov_b32 s64, 0x207
v_pk_mul_f32 v[160:161], v[160:161], v[8:9] op_sel:[0,0] op_sel_hi:[1,0]
v_pk_mul_f32 v[162:163], v[162:163], v[8:9] op_sel:[0,0] op_sel_hi:[1,0]
v_pk_mul_f32 v[176:177], v[176:177], v[8:9] op_sel:[0,0] op_sel_hi:[1,0]
v_pk_mul_f32 v[178:179], v[178:179], v[8:9] op_sel:[0,0] op_sel_hi:[1,0]
v_cvt_pk_bf16_f32 v160, v160, v161
v_cvt_pk_bf16_f32 v161, v162, v163
v_cvt_pk_bf16_f32 v162, v176, v177
v_cvt_pk_bf16_f32 v163, v178, v179
s_nop 1
M v[24:27], a[112:115], v[160:163], 0
v_pk_mul_f32 v[164:165], v[164:165], v[8:9] op_sel:[0,1] op_sel_hi:[1,1]
v_pk_mul_f32 v[166:167], v[166:167], v[8:9] op_sel:[0,1] op_sel_hi:[1,1]
v_pk_mul_f32 v[180:181], v[180:181], v[8:9] op_sel:[0,1] op_sel_hi:[1,1]
v_pk_mul_f32 v[182:183], v[182:183], v[8:9] op_sel:[0,1] op_sel_hi:[1,1]
v_cvt_pk_bf16_f32 v164, v164, v165
v_cvt_pk_bf16_f32 v165, v166, v167
v_cvt_pk_bf16_f32 v166, v180, v181
v_cvt_pk_bf16_f32 v167, v182, v183
s_nop 1
M v[24:27], a[112:115], v[164:167], v[24:27]
v_pk_mul_f32 v[168:169], v[168:169], v[10:11] op_sel:[0,0] op_sel_hi:[1,0]
v_pk_mul_f32 v[170:171], v[170:171], v[10:11] op_sel:[0,0] op_sel_hi:[1,0]
v_pk_mul_f32 v[184:185], v[184:185], v[10:11] op_sel:[0,0] op_sel_hi:[1,0]
v_pk_mul_f32 v[186:187], v[186:187], v[10:11] op_sel:[0,0] op_sel_hi:[1,0]
v_cvt_pk_bf16_f32 v168, v168, v169
v_cvt_pk_bf16_f32 v169, v170, v171
v_cvt_pk_bf16_f32 v170, v184, v185
v_cvt_pk_bf16_f32 v171, v186, v187
s_nop 1
M v[24:27], a[112:115], v[168:171], v[24:27]
v_pk_mul_f32 v[172:173], v[172:173], v[10:11] op_sel:[0,1] op_sel_hi:[1,1]
v_pk_mul_f32 v[174:175], v[174:175], v[10:11] op_sel:[0,1] op_sel_hi:[1,1]
v_pk_mul_f32 v[188:189], v[188:189], v[10:11] op_sel:[0,1] op_sel_hi:[1,1]
v_pk_mul_f32 v[190:191], v[190:191], v[10:11] op_sel:[0,1] op_sel_hi:[1,1]
v_cvt_pk_bf16_f32 v172, v172, v173
v_cvt_pk_bf16_f32 v173, v174, v175
v_cvt_pk_bf16_f32 v174, v188, v189
v_cvt_pk_bf16_f32 v175, v190, v191
s_nop 1
M v[24:27], a[112:115], v[172:175], v[24:27]
v_pk_mul_f32 v[192:193], v[192:193], v[8:9] op_sel:[0,0] op_sel_hi:[1,0]
v_pk_mul_f32 v[194:195], v[194:195], v[8:9] op_sel:[0,0] op_sel_hi:[1,0]
v_pk_mul_f32 v[208:209], v[208:209], v[8:9] op_sel:[0,0] op_sel_hi:[1,0]
v_pk_mul_f32 v[210:211], v[210:211], v[8:9] op_sel:[0,0] op_sel_hi:[1,0]
v_cvt_pk_bf16_f32 v192, v192, v193
v_cvt_pk_bf16_f32 v193, v194, v195
v_cvt_pk_bf16_f32 v194, v208, v209
v_cvt_pk_bf16_f32 v195, v210, v211
s_nop 1
M v[24:27], a[112:115], v[192:195], v[24:27]
v_pk_mul_f32 v[196:197], v[196:197], v[8:9] op_sel:[0,1] op_sel_hi:[1,1]
v_pk_mul_f32 v[198:199], v[198:199], v[8:9] op_sel:[0,1] op_sel_hi:[1,1]
v_pk_mul_f32 v[212:213], v[212:213], v[8:9] op_sel:[0,1] op_sel_hi:[1,1]
v_pk_mul_f32 v[214:215], v[214:215], v[8:9] op_sel:[0,1] op_sel_hi:[1,1]
v_cvt_pk_bf16_f32 v196, v196, v197
v_cvt_pk_bf16_f32 v197, v198, v199
v_cvt_pk_bf16_f32 v198, v212, v213
v_cvt_pk_bf16_f32 v199, v214, v215
s_nop 1
M v[24:27], a[112:115], v[196:199], v[24:27]
v_pk_mul_f32 v[200:201], v[200:201], v[10:11] op_sel:[0,0] op_sel_hi:[1,0]
v_pk_mul_f32 v[202:203], v[202:203], v[10:11] op_sel:[0,0] op_sel_hi:[1,0]
v_pk_mul_f32 v[216:217], v[216:217], v[10:11] op_sel:[0,0] op_sel_hi:[1,0]
v_pk_mul_f32 v[218:219], v[218:219], v[10:11] op_sel:[0,0] op_sel_hi:[1,0]
v_cvt_pk_bf16_f32 v200, v200, v201
v_cvt_pk_bf16_f32 v201, v202, v203
v_cvt_pk_bf16_f32 v202, v216, v217
v_cvt_pk_bf16_f32 v203, v218, v219
s_nop 1
M v[24:27], a[112:115], v[200:203], v[24:27]
v_pk_mul_f32 v[204:205], v[204:205], v[10:11] op_sel:[0,1] op_sel_hi:[1,1]
v_pk_mul_f32 v[206:207], v[206:207], v[10:11] op_sel:[0,1] op_sel_hi:[1,1]
v_pk_mul_f32 v[220:221], v[220:221], v[10:11] op_sel:[0,1] op_sel_hi:[1,1]
v_pk_mul_f32 v[222:223], v[222:223], v[10:11] op_sel:[0,1] op_sel_hi:[1,1]
v_cvt_pk_bf16_f32 v204, v204, v205
v_cvt_pk_bf16_f32 v205, v206, v207
v_cvt_pk_bf16_f32 v206, v220, v221
v_cvt_pk_bf16_f32 v207, v222, v223
s_nop 1
M v[24:27], a[112:115], v[204:207], v[24:27]
v_pk_mul_f32 v[224:225], v[224:225], v[8:9] op_sel:[0,0] op_sel_hi:[1,0]
v_pk_mul_f32 v[226:227], v[226:227], v[8:9] op_sel:[0,0] op_sel_hi:[1,0]
v_pk_mul_f32 v[240:241], v[240:241], v[8:9] op_sel:[0,0] op_sel_hi:[1,0]
v_pk_mul_f32 v[242:243], v[242:243], v[8:9] op_sel:[0,0] op_sel_hi:[1,0]
v_cvt_pk_bf16_f32 v224, v224, v225
v_cvt_pk_bf16_f32 v225, v226, v227
v_cvt_pk_bf16_f32 v226, v240, v241
v_cvt_pk_bf16_f32 v227, v242, v243
s_nop 1
M v[24:27], a[112:115], v[224:227], v[24:27]
v_pk_mul_f32 v[228:229], v[228:229], v[8:9] op_sel:[0,1] op_sel_hi:[1,1]
v_pk_mul_f32 v[230:231], v[230:231], v[8:9] op_sel:[0,1] op_sel_hi:[1,1]
v_pk_mul_f32 v[244:245], v[244:245], v[8:9] op_sel:[0,1] op_sel_hi:[1,1]
v_pk_mul_f32 v[246:247], v[246:247], v[8:9] op_sel:[0,1] op_sel_hi:[1,1]
v_cvt_pk_bf16_f32 v228, v228, v229
v_cvt_pk_bf16_f32 v229, v230, v231
v_cvt_pk_bf16_f32 v230, v244, v245
v_cvt_pk_bf16_f32 v231, v246, v247
s_nop 1
M v[24:27], a[112:115], v[228:231], v[24:27]
v_pk_mul_f32 v[232:233], v[232:233], v[10:11] op_sel:[0,0] op_sel_hi:[1,0]
v_pk_mul_f32 v[234:235], v[234:235], v[10:11] op_sel:[0,0] op_sel_hi:[1,0]
v_pk_mul_f32 v[248:249], v[248:249], v[10:11] op_sel:[0,0] op_sel_hi:[1,0]
v_pk_mul_f32 v[250:251], v[250:251], v[10:11] op_sel:[0,0] op_sel_hi:[1,0]
v_cvt_pk_bf16_f32 v232, v232, v233
v_cvt_pk_bf16_f32 v233, v234, v235
v_cvt_pk_bf16_f32 v234, v248, v249
v_cvt_pk_bf16_f32 v235, v250, v251
s_nop 1
M v[24:27], a[112:115], v[232:235], v[24:27]
v_pk_mul_f32 v[236:237], v[236:237], v[10:11] op_sel:[0,1] op_sel_hi:[1,1]
v_pk_mul_f32 v[238:239], v[238:239], v[10:11] op_sel:[0,1] op_sel_hi:[1,1]
v_pk_mul_f32 v[252:253], v[252:253], v[10:11] op_sel:[0,1] op_sel_hi:[1,1]
v_pk_mul_f32 v[254:255], v[254:255], v[10:11] op_sel:[0,1] op_sel_hi:[1,1]
v_cvt_pk_bf16_f32 v236, v236, v237
v_cvt_pk_bf16_f32 v237, v238, v239
v_cvt_pk_bf16_f32 v238, v252, v253
v_cvt_pk_bf16_f32 v239, v254, v255
v_accvgpr_read_b32 v176, a64
v_accvgpr_read_b32 v177, a65
v_accvgpr_read_b32 v178, a66
v_accvgpr_read_b32 v179, a67
v_accvgpr_read_b32 v180, a80
v_accvgpr_read_b32 v181, a81
v_accvgpr_read_b32 v182, a82
v_accvgpr_read_b32 v183, a83
M v[24:27], a[112:115], v[236:239], v[24:27]
v_pk_mul_f32 v[176:177], v[176:177], v[8:9] op_sel:[0,0] op_sel_hi:[1,0]
v_pk_mul_f32 v[178:179], v[178:179], v[8:9] op_sel:[0,0] op_sel_hi:[1,0]
v_pk_mul_f32 v[180:181], v[180:181], v[8:9] op_sel:[0,0] op_sel_hi:[1,0]
v_pk_mul_f32 v[182:183], v[182:183], v[8:9] op_sel:[0,0] op_sel_hi:[1,0]
v_cvt_pk_bf16_f32 v176, v176, v177
v_cvt_pk_bf16_f32 v177, v178, v179
v_cvt_pk_bf16_f32 v178, v180, v181
v_cvt_pk_bf16_f32 v179, v182, v183
v_accvgpr_read_b32 v184, a68
v_accvgpr_read_b32 v185, a69
v_accvgpr_read_b32 v186, a70
v_accvgpr_read_b32 v187, a71
v_accvgpr_read_b32 v188, a84
v_accvgpr_read_b32 v189, a85
v_accvgpr_read_b32 v190, a86
v_accvgpr_read_b32 v191, a87
M v[24:27], a[112:115], v[176:179], v[24:27]
v_pk_mul_f32 v[184:185], v[184:185], v[8:9] op_sel:[0,1] op_sel_hi:[1,1]
v_pk_mul_f32 v[186:187], v[186:187], v[8:9] op_sel:[0,1] op_sel_hi:[1,1]
v_pk_mul_f32 v[188:189], v[188:189], v[8:9] op_sel:[0,1] op_sel_hi:[1,1]
v_pk_mul_f32 v[190:191], v[190:191], v[8:9] op_sel:[0,1] op_sel_hi:[1,1]
v_cvt_pk_bf16_f32 v184, v184, v185
v_cvt_pk_bf16_f32 v185, v186, v187
v_cvt_pk_bf16_f32 v186, v188, v189
v_cvt_pk_bf16_f32 v187, v190, v191
v_accvgpr_read_b32 v208, a72
v_accvgpr_read_b32 v209, a73
v_accvgpr_read_b32 v210, a74
v_accvgpr_read_b32 v211, a75
v_accvgpr_read_b32 v212, a88
v_accvgpr_read_b32 v213, a89
v_accvgpr_read_b32 v214, a90
v_accvgpr_read_b32 v215, a91
M v[24:27], a[112:115], v[184:187], v[24:27]
v_pk_mul_f32 v[208:209], v[208:209], v[10:11] op_sel:[0,0] op_sel_hi:[1,0]
v_pk_mul_f32 v[210:211], v[210:211], v[10:11] op_sel:[0,0] op_sel_hi:[1,0]
v_pk_mul_f32 v[212:213], v[212:213], v[10:11] op_sel:[0,0] op_sel_hi:[1,0]
v_pk_mul_f32 v[214:215], v[214:215], v[10:11] op_sel:[0,0] op_sel_hi:[1,0]
v_cvt_pk_bf16_f32 v208, v208, v209
v_cvt_pk_bf16_f32 v209, v210, v211
v_cvt_pk_bf16_f32 v210, v212, v213
v_cvt_pk_bf16_f32 v211, v214, v215
v_accvgpr_read_b32 v216, a76
v_accvgpr_read_b32 v217, a77
v_accvgpr_read_b32 v218, a78
v_accvgpr_read_b32 v219, a79
v_accvgpr_read_b32 v220, a92
v_accvgpr_read_b32 v221, a93
v_accvgpr_read_b32 v222, a94
v_accvgpr_read_b32 v223, a95
M v[24:27], a[112:115], v[208:211], v[24:27]
v_pk_mul_f32 v[216:217], v[216:217], v[10:11] op_sel:[0,1] op_sel_hi:[1,1]
v_pk_mul_f32 v[218:219], v[218:219], v[10:11] op_sel:[0,1] op_sel_hi:[1,1]
v_pk_mul_f32 v[220:221], v[220:221], v[10:11] op_sel:[0,1] op_sel_hi:[1,1]
v_pk_mul_f32 v[222:223], v[222:223], v[10:11] op_sel:[0,1] op_sel_hi:[1,1]
v_cvt_pk_bf16_f32 v216, v216, v217
v_cvt_pk_bf16_f32 v217, v218, v219
v_cvt_pk_bf16_f32 v218, v220, v221
v_cvt_pk_bf16_f32 v219, v222, v223
s_nop 1
M v[24:27], a[112:115], v[216:219], v[24:27]
v_cmp_lt_u32 vcc, 0x3c000000, v12
s_nop 6
v_cmp_class_f32 s[40:41], v24, s64
s_nop 0
s_or_b64 vcc, vcc, s[40:41]
s_cbranch_vccnz Lbad_2
s_lshl_b32 s33, s21, 20
s_lshl_b32 s34, s20, 15
s_add_u32 s33, s33, s34
s_lshl_b32 s34, s23, 13
s_add_u32 s36, s33, s34
s_add_u32 s37, s36, 4096
s_add_u32 s38, s36, 16384
s_add_u32 s39, s36, 20480
buffer_store_dwordx4 v[160:163], v1, s[16:19], s36 offen offset:0 sc1
buffer_store_dwordx4 v[164:167], v1, s[16:19], s36 offen offset:2048 sc1
buffer_store_dwordx4 v[168:171], v1, s[16:19], s37 offen offset:0 sc1
buffer_store_dwordx4 v[172:175], v1, s[16:19], s37 offen offset:2048 sc1
buffer_store_dwordx4 v[192:195], v1, s[16:19], s36 offen offset:1024 sc1
buffer_store_dwordx4 v[196:199], v1, s[16:19], s36 offen offset:3072 sc1
buffer_store_dwordx4 v[200:203], v1, s[16:19], s37 offen offset:1024 sc1
buffer_store_dwordx4 v[204:207], v1, s[16:19], s37 offen offset:3072 sc1
buffer_store_dwordx4 v[224:227], v1, s[16:19], s38 offen offset:0 sc1
buffer_store_dwordx4 v[228:231], v1, s[16:19], s38 offen offset:2048 sc1
buffer_store_dwordx4 v[232:235], v1, s[16:19], s39 offen offset:0 sc1
buffer_store_dwordx4 v[236:239], v1, s[16:19], s39 offen offset:2048 sc1
buffer_store_dwordx4 v[176:179], v1, s[16:19], s38 offen offset:1024 sc1
buffer_store_dwordx4 v[184:187], v1, s[16:19], s38 offen offset:3072 sc1
buffer_store_dwordx4 v[208:211], v1, s[16:19], s39 offen offset:1024 sc1
buffer_store_dwordx4 v[216:219], v1, s[16:19], s39 offen offset:3072 sc1
s_branch Lfd_3
Lbad_2:
s_or_b32 s60, s60, 1
Lfd_3:
s_sub_u32 s30, 7, s21
s_cmp_lg_u32 s30, 0
s_cbranch_scc1 Lk2_b0
s_waitcnt vmcnt(8)
s_waitcnt lgkmcnt(0)
s_barrier
s_and_b32 s3, s2, 3
s_lshl_b32 s3, s3, 2
s_bfe_u32 s27, s2, 0x20003
s_add_u32 s27, s3, s27
s_lshl_b32 s43, s27, 8
s_add_u32 s43, s43, 8400896
v_lshlrev_b32 v15, 2, v0
buffer_load_dword v7, v15, s[52:55], s43 offen sc1
s_lshl_b32 s33, s2, 2
s_add_u32 s33, s33, s22
s_lshl_b32 s34, s33, 11
s_lshl_b32 s33, s33, 13
v_lshlrev_b32 v8, 3, v1
v_lshlrev_b32 v9, 1, v1
buffer_load_dword v5, v8, s[44:47], s33 offen
buffer_load_dword v6, v9, s[48:51], s34 offen
ds_read_b128 a[116:119], v2 offset:32768
ds_read_b128 a[120:123], v2 offset:40960
ds_read_b128 a[124:127], v2 offset:33792
ds_read_b128 a[128:131], v2 offset:41984
ds_read_b128 a[132:135], v2 offset:34816
ds_read_b128 a[136:139], v2 offset:43008
ds_read_b128 a[140:143], v2 offset:35840
ds_read_b128 a[144:147], v2 offset:44032
v_exp_f32 v64, v64
v_exp_f32 v65, v65
v_exp_f32 v66, v66
v_exp_f32 v67, v67
v_exp_f32 v80, v80
v_exp_f32 v81, v81
v_exp_f32 v82, v82
v_exp_f32 v83, v83
v_cvt_pk_bf16_f32 v64, v64, v65
v_cvt_pk_bf16_f32 v65, v66, v67
v_exp_f32 v68, v68
v_exp_f32 v69, v69
v_exp_f32 v70, v70
v_exp_f32 v71, v71
v_cvt_pk_bf16_f32 v66, v80, v81
v_cvt_pk_bf16_f32 v67, v82, v83
v_exp_f32 v84, v84
v_exp_f32 v85, v85
v_exp_f32 v86, v86
v_exp_f32 v87, v87
v_cvt_pk_bf16_f32 v68, v68, v69
v_cvt_pk_bf16_f32 v69, v70, v71
v_exp_f32 v72, v72
v_exp_f32 v73, v73
v_exp_f32 v74, v74
v_exp_f32 v75, v75
v_cvt_pk_bf16_f32 v70, v84, v85
v_cvt_pk_bf16_f32 v71, v86, v87
v_exp_f32 v88, v88
v_exp_f32 v89, v89
v_exp_f32 v90, v90
v_exp_f32 v91, v91
v_cvt_pk_bf16_f32 v72, v72, v73
v_cvt_pk_bf16_f32 v73, v74, v75
v_exp_f32 v76, v76
v_exp_f32 v77, v77
v_exp_f32 v78, v78
v_exp_f32 v79, v79
v_cvt_pk_bf16_f32 v74, v88, v89
v_cvt_pk_bf16_f32 v75, v90, v91
v_exp_f32 v92, v92
v_exp_f32 v93, v93
v_exp_f32 v94, v94
v_exp_f32 v95, v95
v_cvt_pk_bf16_f32 v76, v76, v77
v_cvt_pk_bf16_f32 v77, v78, v79
v_cvt_pk_bf16_f32 v78, v92, v93
v_cvt_pk_bf16_f32 v79, v94, v95
s_waitcnt lgkmcnt(6)
M v[160:163], a[116:119], v[32:35], 0
M v[160:163], a[120:123], v[64:67], v[160:163]
ds_read_b128 a[148:151], v2 offset:36864
ds_read_b128 a[152:155], v2 offset:45056
s_mov_b32 s61, 0
M v[164:167], a[120:123], v[68:71], 0
M v[164:167], a[116:119], v[36:39], v[164:167]
s_bfe_u32 s3, s2, 0x10002
M v[168:171], a[116:119], v[40:43], 0
M v[168:171], a[120:123], v[72:75], v[168:171]
s_lshl_b32 s3, s3, 3
M v[172:175], a[120:123], v[76:79], 0
M v[172:175], a[116:119], v[44:47], v[172:175]
s_waitcnt lgkmcnt(6)
s_lshr_b32 s28, s2, 5
M a[96:99], a[112:115], v[32:35], 0
M a[96:99], a[112:115], v[64:67], a[96:99]
M v[176:179], a[124:127], v[32:35], 0
M v[176:179], a[128:131], v[64:67], v[176:179]
ds_read_b128 a[156:159], v2 offset:37888
ds_read_b128 a[160:163], v2 offset:46080
s_add_u32 s28, s3, s28
M v[180:183], a[128:131], v[68:71], 0
s_lshl_b32 s25, s27, 18
M v[180:183], a[124:127], v[36:39], v[180:183]
M v[184:187], a[124:127], v[40:43], 0
s_lshl_b32 s3, s101, 12
M v[184:187], a[128:131], v[72:75], v[184:187]
M v[188:191], a[128:131], v[76:79], 0
s_add_u32 s25, s25, s3
M v[188:191], a[124:127], v[44:47], v[188:191]
s_waitcnt lgkmcnt(6)
M a[100:103], a[112:115], v[36:39], 0
M a[100:103], a[112:115], v[68:71], a[100:103]
M v[192:195], a[132:135], v[32:35], 0
s_lshl_b32 s26, s28, 7
M v[192:195], a[136:139], v[64:67], v[192:195]
ds_read_b128 a[164:167], v2 offset:38912
ds_read_b128 a[168:171], v2 offset:47104
M v[196:199], a[136:139], v[68:71], 0
s_lshl_b32 s42, s101, 11
M v[196:199], a[132:135], v[36:39], v[196:199]
M v[200:203], a[132:135], v[40:43], 0
s_add_u32 s44, s4, 83886080
s_addc_u32 s45, s5, 0
M v[200:203], a[136:139], v[72:75], v[200:203]
s_mov_b32 s46, 4194304
M v[204:207], a[136:139], v[76:79], 0
M v[204:207], a[132:135], v[44:47], v[204:207]
s_waitcnt lgkmcnt(6)
s_mov_b32 s47, 0x00020000
M a[104:107], a[112:115], v[40:43], 0
M a[104:107], a[112:115], v[72:75], a[104:107]
M v[208:211], a[140:143], v[32:35], 0
M v[208:211], a[144:147], v[64:67], v[208:211]
ds_read_b128 a[172:175], v2 offset:39936
ds_read_b128 a[176:179], v2 offset:48128
s_mov_b32 s50, 2097152
M v[212:215], a[144:147], v[68:71], 0
M v[212:215], a[140:143], v[36:39], v[212:215]
s_mov_b32 s51, 0x00020000
M v[216:219], a[140:143], v[40:43], 0
M v[216:219], a[144:147], v[72:75], v[216:219]
s_lshl_b32 s3, s101, 4
M v[220:223], a[144:147], v[76:79], 0
M v[220:223], a[140:143], v[44:47], v[220:223]
s_waitcnt lgkmcnt(6)
v_lshrrev_b32 v96, 3, v0
M a[108:111], a[112:115], v[44:47], 0
M a[108:111], a[112:115], v[76:79], a[108:111]
M v[224:227], a[148:151], v[32:35], 0
v_and_b32 v97, 6, v96
M v[224:227], a[152:155], v[64:67], v[224:227]
M v[228:231], a[152:155], v[68:71], 0
v_and_b32 v98, 7, v0
M v[228:231], a[148:151], v[36:39], v[228:231]
M v[232:235], a[148:151], v[40:43], 0
v_xor_b32 v97, v97, v98
M v[232:235], a[152:155], v[72:75], v[232:235]
M v[236:239], a[152:155], v[76:79], 0
v_add_u32 v96, s3, v96
M v[236:239], a[148:151], v[44:47], v[236:239]
s_waitcnt lgkmcnt(4)
M v[240:243], a[156:159], v[32:35], 0
v_lshlrev_b32 v96, 11, v96
M v[240:243], a[160:163], v[64:67], v[240:243]
M v[244:247], a[160:163], v[68:71], 0
v_lshl_add_u32 v99, v97, 4, v96
M v[244:247], a[156:159], v[36:39], v[244:247]
v_add_u32 v100, 15360, v99
M v[248:251], a[156:159], v[40:43], 0
M v[248:251], a[160:163], v[72:75], v[248:251]
s_waitcnt vmcnt(2) lgkmcnt(0)
s_barrier
v_cmp_ne_u32 vcc, 1, v7
s_nop 0
s_cbranch_vccnz Lk3_spinb1
Lk3_gotb1:
M v[252:255], a[160:163], v[76:79], 0
s_add_u32 m0, s42, 65536
s_nop 0
buffer_load_dwordx4 v99, s[48:51], s26 offen offset:0 lds
buffer_load_dwordx4 v100, s[48:51], s26 offen offset:1024 lds
M v[252:255], a[156:159], v[44:47], v[252:255]
buffer_load_dwordx4 a[192:195], v1, s[44:47], s25 offen offset:0 sc1
buffer_load_dwordx4 a[196:199], v1, s[44:47], s25 offen offset:1024 sc1
M a[64:67], a[164:167], v[32:35], 0
buffer_load_dwordx4 a[200:203], v1, s[44:47], s25 offen offset:2048 sc1
buffer_load_dwordx4 a[204:207], v1, s[44:47], s25 offen offset:3072 sc1
M a[64:67], a[168:171], v[64:67], a[64:67]
s_add_u32 s25, s25, 16384
s_add_u32 s26, s26, 131072
s_add_u32 m0, s42, 81920
s_nop 0
buffer_load_dwordx4 v99, s[48:51], s26 offen offset:0 lds
M a[68:71], a[168:171], v[68:71], 0
buffer_load_dwordx4 v100, s[48:51], s26 offen offset:1024 lds
buffer_load_dwordx4 a[208:211], v1, s[44:47], s25 offen offset:0 sc1
M a[68:71], a[164:167], v[36:39], a[68:71]
buffer_load_dwordx4 a[212:215], v1, s[44:47], s25 offen offset:1024 sc1
buffer_load_dwordx4 a[216:219], v1, s[44:47], s25 offen offset:2048 sc1
M a[72:75], a[164:167], v[40:43], 0
buffer_load_dwordx4 a[220:223], v1, s[44:47], s25 offen offset:3072 sc1
s_add_u32 s25, s25, 16384
s_add_u32 s26, s26, 131072
M a[72:75], a[168:171], v[72:75], a[72:75]
s_add_u32 m0, s42, 98304
s_nop 0
buffer_load_dwordx4 v99, s[48:51], s26 offen offset:0 lds
buffer_load_dwordx4 v100, s[48:51], s26 offen offset:1024 lds
M a[76:79], a[168:171], v[76:79], 0
buffer_load_dwordx4 a[224:227], v1, s[44:47], s25 offen offset:0 sc1
M a[76:79], a[164:167], v[44:47], a[76:79]
buffer_load_dwordx4 a[228:231], v1, s[44:47], s25 offen offset:1024 sc1
buffer_load_dwordx4 a[232:235], v1, s[44:47], s25 offen offset:2048 sc1
M a[80:83], a[172:175], v[32:35], 0
buffer_load_dwordx4 a[236:239], v1, s[44:47], s25 offen offset:3072 sc1
s_add_u32 s25, s25, 16384
s_add_u32 s26, s26, 131072
M a[80:83], a[176:179], v[64:67], a[80:83]
s_add_u32 m0, s42, 114688
s_nop 0
buffer_load_dwordx4 v99, s[48:51], s26 offen offset:0 lds
buffer_load_dwordx4 v100, s[48:51], s26 offen offset:1024 lds
M a[84:87], a[176:179], v[68:71], 0
buffer_load_dwordx4 a[240:243], v1, s[44:47], s25 offen offset:0 sc1
buffer_load_dwordx4 a[244:247], v1, s[44:47], s25 offen offset:1024 sc1
M a[84:87], a[172:175], v[36:39], a[84:87]
buffer_load_dwordx4 a[248:251], v1, s[44:47], s25 offen offset:2048 sc1
buffer_load_dwordx4 a[252:255], v1, s[44:47], s25 offen offset:3072 sc1
M a[88:91], a[172:175], v[40:43], 0
s_add_u32 s25, s25, 16384
s_add_u32 s26, s26, 131072
s_add_u32 m0, s42, 0
s_nop 0
buffer_load_dwordx4 v99, s[48:51], s26 offen offset:0 lds
M a[88:91], a[176:179], v[72:75], a[88:91]
buffer_load_dwordx4 v100, s[48:51], s26 offen offset:1024 lds
buffer_load_dwordx4 a[128:131], v1, s[44:47], s25 offen offset:0 sc1
M a[92:95], a[176:179], v[76:79], 0
buffer_load_dwordx4 a[132:135], v1, s[44:47], s25 offen offset:1024 sc1
buffer_load_dwordx4 a[136:139], v1, s[44:47], s25 offen offset:2048 sc1
M a[92:95], a[172:175], v[44:47], a[92:95]
buffer_load_dwordx4 a[140:143], v1, s[44:47], s25 offen offset:3072 sc1
s_add_u32 s25, s25, 16384
s_add_u32 s26, s26, 131072
s_branch Lk2_merge
Lk2_b0:
s_waitcnt lgkmcnt(4)
s_add_u32 m0, s29, 98304
M v[96:99], a[116:119], a[180:183], 0
v_exp_f32 v64, v64
M v[96:99], a[120:123], a[184:187], v[96:99]
ds_read_b128 a[148:151], v2 offset:8192
ds_read_b128 a[152:155], v2 offset:9216
M v[96:99], a[124:127], a[188:191], v[96:99]
v_exp_f32 v65, v65
M v[96:99], a[128:131], a[192:195], v[96:99]
buffer_load_dwordx4 v1, s[12:15], s26 offen offset:0 sc1 lds
s_add_u32 s32, s26, 4096
M v[100:103], a[128:131], a[208:211], 0
v_exp_f32 v66, v66
M v[100:103], a[124:127], a[204:207], v[100:103]
v_cvt_pk_bf16_f32 v64, v64, v65
M v[100:103], a[120:123], a[200:203], v[100:103]
v_exp_f32 v67, v67
M v[100:103], a[116:119], a[196:199], v[100:103]
buffer_load_dwordx4 v1, s[12:15], s26 offen offset:1024 sc1 lds
M v[104:107], a[116:119], a[212:215], 0
v_exp_f32 v80, v80
M v[104:107], a[120:123], a[216:219], v[104:107]
ds_read_b128 a[156:159], v2 offset:10240
ds_read_b128 a[160:163], v2 offset:11264
M v[104:107], a[124:127], a[220:223], v[104:107]
v_exp_f32 v81, v81
M v[104:107], a[128:131], a[224:227], v[104:107]
buffer_load_dwordx4 v1, s[12:15], s26 offen offset:2048 sc1 lds
M v[108:111], a[128:131], a[240:243], 0
v_exp_f32 v82, v82
M v[108:111], a[124:127], a[236:239], v[108:111]
v_cvt_pk_bf16_f32 v65, v66, v67
v_cvt_pk_bf16_f32 v66, v80, v81
M v[108:111], a[120:123], a[232:235], v[108:111]
v_exp_f32 v83, v83
M v[108:111], a[116:119], a[228:231], v[108:111]
buffer_load_dwordx4 v1, s[12:15], s26 offen offset:3072 sc1 lds
s_add_u32 m0, s29, 102400
s_waitcnt lgkmcnt(4)
M v[112:115], a[132:135], a[180:183], 0
v_exp_f32 v68, v68
M v[112:115], a[136:139], a[184:187], v[112:115]
ds_read_b128 a[164:167], v2 offset:12288
ds_read_b128 a[168:171], v2 offset:13312
M v[112:115], a[140:143], a[188:191], v[112:115]
v_exp_f32 v69, v69
M v[112:115], a[144:147], a[192:195], v[112:115]
buffer_load_dwordx4 v1, s[12:15], s32 offen offset:0 sc1 lds
M v[116:119], a[144:147], a[208:211], 0
v_exp_f32 v70, v70
M v[116:119], a[140:143], a[204:207], v[116:119]
v_cvt_pk_bf16_f32 v67, v82, v83
v_cvt_pk_bf16_f32 v68, v68, v69
M v[116:119], a[136:139], a[200:203], v[116:119]
v_exp_f32 v71, v71
M v[116:119], a[132:135], a[196:199], v[116:119]
buffer_load_dwordx4 v1, s[12:15], s32 offen offset:1024 sc1 lds
M v[120:123], a[132:135], a[212:215], 0
v_exp_f32 v84, v84
M v[120:123], a[136:139], a[216:219], v[120:123]
ds_read_b128 a[172:175], v2 offset:14336
ds_read_b128 a[176:179], v2 offset:15360
M v[120:123], a[140:143], a[220:223], v[120:123]
v_exp_f32 v85, v85
M v[120:123], a[144:147], a[224:227], v[120:123]
buffer_load_dwordx4 v1, s[12:15], s32 offen offset:2048 sc1 lds
M v[124:127], a[144:147], a[240:243], 0
v_exp_f32 v86, v86
M v[124:127], a[140:143], a[236:239], v[124:127]
v_cvt_pk_bf16_f32 v69, v70, v71
v_cvt_pk_bf16_f32 v70, v84, v85
M v[124:127], a[136:139], a[232:235], v[124:127]
v_exp_f32 v87, v87
M v[124:127], a[132:135], a[228:231], v[124:127]
buffer_load_dwordx4 v1, s[12:15], s32 offen offset:3072 sc1 lds
s_waitcnt lgkmcnt(4)
M v[128:131], a[148:151], a[180:183], 0
v_exp_f32 v72, v72
M v[128:131], a[152:155], a[184:187], v[128:131]
s_add_u32 s26, s26, 32768
s_cmp_eq_u32 s26, s62
s_cselect_b32 s26, s63, s26
s_cselect_b32 s62, -1, s62
M v[128:131], a[156:159], a[188:191], v[128:131]
v_exp_f32 v73, v73
M v[128:131], a[160:163], a[192:195], v[128:131]
v_cvt_pk_bf16_f32 v71, v86, v87
v_cvt_pk_bf16_f32 v72, v72, v73
M v[132:135], a[160:163], a[208:211], 0
v_exp_f32 v74, v74
M v[132:135], a[156:159], a[204:207], v[132:135]
M v[132:135], a[152:155], a[200:203], v[132:135]
v_exp_f32 v75, v75
M v[132:135], a[148:151], a[196:199], v[132:135]
v_cvt_pk_bf16_f32 v73, v74, v75
M v[136:139], a[148:151], a[212:215], 0
v_exp_f32 v88, v88
M v[136:139], a[152:155], a[216:219], v[136:139]
M v[136:139], a[156:159], a[220:223], v[136:139]
v_exp_f32 v89, v89
M v[136:139], a[160:163], a[224:227], v[136:139]
v_cvt_pk_bf16_f32 v74, v88, v89
M v[140:143], a[160:163], a[240:243], 0
v_exp_f32 v90, v90
M v[140:143], a[156:159], a[236:239], v[140:143]
s_waitcnt vmcnt(16) lgkmcnt(0)
s_barrier
ds_read_b128 a[116:119], v2 offset:32768
ds_read_b128 a[120:123], v2 offset:40960
ds_read_b128 a[124:127], v2 offset:33792
ds_read_b128 a[128:131], v2 offset:41984
M v[140:143], a[152:155], a[232:235], v[140:143]
v_exp_f32 v91, v91
M v[140:143], a[148:151], a[228:231], v[140:143]
v_cvt_pk_bf16_f32 v75, v90, v91
M v[144:147], a[164:167], a[180:183], 0
v_exp_f32 v76, v76
M v[144:147], a[168:171], a[184:187], v[144:147]
ds_read_b128 a[132:135], v2 offset:34816
ds_read_b128 a[136:139], v2 offset:43008
M v[144:147], a[172:175], a[188:191], v[144:147]
v_exp_f32 v77, v77
M v[144:147], a[176:179], a[192:195], v[144:147]
v_cvt_pk_bf16_f32 v76, v76, v77
M v[148:151], a[176:179], a[208:211], 0
v_exp_f32 v78, v78
M v[148:151], a[172:175], a[204:207], v[148:151]
M v[148:151], a[168:171], a[200:203], v[148:151]
v_exp_f32 v79, v79
M v[148:151], a[164:167], a[196:199], v[148:151]
v_cvt_pk_bf16_f32 v77, v78, v79
M v[152:155], a[164:167], a[212:215], 0
v_exp_f32 v92, v92
M v[152:155], a[168:171], a[216:219], v[152:155]
ds_read_b128 a[140:143], v2 offset:35840
ds_read_b128 a[144:147], v2 offset:44032
M v[152:155], a[172:175], a[220:223], v[152:155]
v_exp_f32 v93, v93
M v[152:155], a[176:179], a[224:227], v[152:155]
v_cvt_pk_bf16_f32 v78, v92, v93
M v[156:159], a[176:179], a[240:243], 0
v_exp_f32 v94, v94
M v[156:159], a[172:175], a[236:239], v[156:159]
M v[156:159], a[168:171], a[232:235], v[156:159]
v_exp_f32 v95, v95
M v[156:159], a[164:167], a[228:231], v[156:159]
v_cvt_pk_bf16_f32 v79, v94, v95
s_waitcnt lgkmcnt(6)
s_add_u32 m0, s29, 0
M v[160:163], a[116:119], v[32:35], 0
v_exp_f32 v96, v96
M v[160:163], a[120:123], v[64:67], v[160:163]
ds_read_b128 a[148:151], v2 offset:36864
ds_read_b128 a[152:155], v2 offset:45056
M v[164:167], a[120:123], v[68:71], 0
v_exp_f32 v97, v97
M v[164:167], a[116:119], v[36:39], v[164:167]
buffer_load_dwordx4 v1, s[12:15], s25 offen offset:0 sc1 lds
s_add_u32 s32, s25, 4096
M v[168:171], a[116:119], v[40:43], 0
v_exp_f32 v98, v98
M v[168:171], a[120:123], v[72:75], v[168:171]
v_cvt_pk_bf16_f32 v96, v96, v97
M v[172:175], a[120:123], v[76:79], 0
v_exp_f32 v99, v99
M v[172:175], a[116:119], v[44:47], v[172:175]
buffer_load_dwordx4 v1, s[12:15], s25 offen offset:1024 sc1 lds
s_waitcnt lgkmcnt(6)
M a[96:99], a[112:115], v[32:35], 0
M a[96:99], a[112:115], v[64:67], a[96:99]
M v[176:179], a[124:127], v[32:35], 0
v_exp_f32 v112, v112
M v[176:179], a[128:131], v[64:67], v[176:179]
ds_read_b128 a[156:159], v2 offset:37888
ds_read_b128 a[160:163], v2 offset:46080
M v[180:183], a[128:131], v[68:71], 0
v_exp_f32 v113, v113
M v[180:183], a[124:127], v[36:39], v[180:183]
buffer_load_dwordx4 v1, s[12:15], s25 offen offset:2048 sc1 lds
M v[184:187], a[124:127], v[40:43], 0
v_exp_f32 v114, v114
M v[184:187], a[128:131], v[72:75], v[184:187]
v_cvt_pk_bf16_f32 v97, v98, v99
v_cvt_pk_bf16_f32 v98, v112, v113
M v[188:191], a[128:131], v[76:79], 0
v_exp_f32 v115, v115
M v[188:191], a[124:127], v[44:47], v[188:191]
buffer_load_dwordx4 v1, s[12:15], s25 offen offset:3072 sc1 lds
s_add_u32 m0, s29, 4096
s_waitcnt lgkmcnt(6)
M a[100:103], a[112:115], v[36:39], 0
M a[100:103], a[112:115], v[68:71], a[100:103]
M v[192:195], a[132:135], v[32:35], 0
v_exp_f32 v100, v100
M v[192:195], a[136:139], v[64:67], v[192:195]
ds_read_b128 a[164:167], v2 offset:38912
ds_read_b128 a[168:171], v2 offset:47104
M v[196:199], a[136:139], v[68:71], 0
v_exp_f32 v101, v101
M v[196:199], a[132:135], v[36:39], v[196:199]
buffer_load_dwordx4 v1, s[12:15], s32 offen offset:0 sc1 lds
M v[200:203], a[132:135], v[40:43], 0
v_exp_f32 v102, v102
M v[200:203], a[136:139], v[72:75], v[200:203]
v_cvt_pk_bf16_f32 v99, v114, v115
v_cvt_pk_bf16_f32 v100, v100, v101
M v[204:207], a[136:139], v[76:79], 0
v_exp_f32 v103, v103
M v[204:207], a[132:135], v[44:47], v[204:207]
buffer_load_dwordx4 v1, s[12:15], s32 offen offset:1024 sc1 lds
s_waitcnt lgkmcnt(6)
M a[104:107], a[112:115], v[40:43], 0
M a[104:107], a[112:115], v[72:75], a[104:107]
M v[208:211], a[140:143], v[32:35], 0
v_exp_f32 v116, v116
M v[208:211], a[144:147], v[64:67], v[208:211]
ds_read_b128 a[172:175], v2 offset:39936
ds_read_b128 a[176:179], v2 offset:48128
M v[212:215], a[144:147], v[68:71], 0
v_exp_f32 v117, v117
M v[212:215], a[140:143], v[36:39], v[212:215]
buffer_load_dwordx4 v1, s[12:15], s32 offen offset:2048 sc1 lds
M v[216:219], a[140:143], v[40:43], 0
v_exp_f32 v118, v118
M v[216:219], a[144:147], v[72:75], v[216:219]
v_cvt_pk_bf16_f32 v101, v102, v103
v_cvt_pk_bf16_f32 v102, v116, v117
M v[220:223], a[144:147], v[76:79], 0
v_exp_f32 v119, v119
M v[220:223], a[140:143], v[44:47], v[220:223]
buffer_load_dwordx4 v1, s[12:15], s32 offen offset:3072 sc1 lds
s_waitcnt lgkmcnt(6)
M a[108:111], a[112:115], v[44:47], 0
M a[108:111], a[112:115], v[76:79], a[108:111]
M v[224:227], a[148:151], v[32:35], 0
v_exp_f32 v104, v104
M v[224:227], a[152:155], v[64:67], v[224:227]
s_add_u32 s25, s25, 32768
s_cmp_eq_u32 s25, s27
s_cselect_b32 s25, s28, s25
s_cselect_b32 s27, -1, s27
M v[228:231], a[152:155], v[68:71], 0
v_exp_f32 v105, v105
M v[228:231], a[148:151], v[36:39], v[228:231]
v_cvt_pk_bf16_f32 v103, v118, v119
v_cvt_pk_bf16_f32 v104, v104, v105
M v[232:235], a[148:151], v[40:43], 0
v_exp_f32 v106, v106
M v[232:235], a[152:155], v[72:75], v[232:235]
M v[236:239], a[152:155], v[76:79], 0
v_exp_f32 v107, v107
M v[236:239], a[148:151], v[44:47], v[236:239]
v_cvt_pk_bf16_f32 v105, v106, v107
s_waitcnt lgkmcnt(4)
M v[240:243], a[156:159], v[32:35], 0
v_exp_f32 v120, v120
M v[240:243], a[160:163], v[64:67], v[240:243]
M v[244:247], a[160:163], v[68:71], 0
v_exp_f32 v121, v121
M v[244:247], a[156:159], v[36:39], v[244:247]
v_cvt_pk_bf16_f32 v106, v120, v121
M v[248:251], a[156:159], v[40:43], 0
v_exp_f32 v122, v122
M v[248:251], a[160:163], v[72:75], v[248:251]
s_waitcnt vmcnt(16) lgkmcnt(0)
s_barrier
ds_read_b128 a[116:119], v3 offset:0
ds_read_b128 a[120:123], v3 offset:1024
ds_read_b128 a[124:127], v3 offset:2048
ds_read_b128 a[128:131], v3 offset:3072
M v[252:255], a[160:163], v[76:79], 0
v_exp_f32 v123, v123
M v[252:255], a[156:159], v[44:47], v[252:255]
v_cvt_pk_bf16_f32 v107, v122, v123
M a[64:67], a[164:167], v[32:35], 0
v_exp_f32 v108, v108
M a[64:67], a[168:171], v[64:67], a[64:67]
ds_read_b128 a[132:135], v3 offset:4096
ds_read_b128 a[136:139], v3 offset:5120
M a[68:71], a[168:171], v[68:71], 0
v_exp_f32 v109, v109
M a[68:71], a[164:167], v[36:39], a[68:71]
v_cvt_pk_bf16_f32 v108, v108, v109
M a[72:75], a[164:167], v[40:43], 0
v_exp_f32 v110, v110
M a[72:75], a[168:171], v[72:75], a[72:75]
M a[76:79], a[168:171], v[76:79], 0
v_exp_f32 v111, v111
M a[76:79], a[164:167], v[44:47], a[76:79]
v_cvt_pk_bf16_f32 v109, v110, v111
M a[80:83], a[172:175], v[32:35], 0
v_exp_f32 v124, v124
M a[80:83], a[176:179], v[64:67], a[80:83]
ds_read_b128 a[140:143], v3 offset:6144
ds_read_b128 a[144:147], v3 offset:7168
M a[84:87], a[176:179], v[68:71], 0
v_exp_f32 v125, v125
M a[84:87], a[172:175], v[36:39], a[84:87]
v_cvt_pk_bf16_f32 v110, v124, v125
M a[88:91], a[172:175], v[40:43], 0
v_exp_f32 v126, v126
M a[88:91], a[176:179], v[72:75], a[88:91]
M a[92:95], a[176:179], v[76:79], 0
v_exp_f32 v127, v127
M a[92:95], a[172:175], v[44:47], a[92:95]
v_cvt_pk_bf16_f32 v111, v126, v127
s_branch Lk2_l2b
Lk2_l2:
s_waitcnt lgkmcnt(4)
s_add_u32 m0, s29, 98304
M v[96:99], a[116:119], a[180:183], 0
v_exp_f32 v64, v64
M v[96:99], a[120:123], a[184:187], v[96:99]
ds_read_b128 a[148:151], v2 offset:8192
ds_read_b128 a[152:155], v2 offset:9216
M v[96:99], a[124:127], a[188:191], v[96:99]
v_exp_f32 v65, v65
M v[96:99], a[128:131], a[192:195], v[96:99]
buffer_load_dwordx4 v1, s[12:15], s26 offen offset:0 sc1 lds
s_add_u32 s32, s26, 4096
M v[100:103], a[128:131], a[208:211], 0
v_exp_f32 v66, v66
M v[100:103], a[124:127], a[204:207], v[100:103]
v_cvt_pk_bf16_f32 v64, v64, v65
M v[100:103], a[120:123], a[200:203], v[100:103]
v_exp_f32 v67, v67
M v[100:103], a[116:119], a[196:199], v[100:103]
buffer_load_dwordx4 v1, s[12:15], s26 offen offset:1024 sc1 lds
M v[104:107], a[116:119], a[212:215], 0
v_exp_f32 v80, v80
M v[104:107], a[120:123], a[216:219], v[104:107]
ds_read_b128 a[156:159], v2 offset:10240
ds_read_b128 a[160:163], v2 offset:11264
M v[104:107], a[124:127], a[220:223], v[104:107]
v_exp_f32 v81, v81
M v[104:107], a[128:131], a[224:227], v[104:107]
buffer_load_dwordx4 v1, s[12:15], s26 offen offset:2048 sc1 lds
M v[108:111], a[128:131], a[240:243], 0
v_exp_f32 v82, v82
M v[108:111], a[124:127], a[236:239], v[108:111]
v_cvt_pk_bf16_f32 v65, v66, v67
v_cvt_pk_bf16_f32 v66, v80, v81
M v[108:111], a[120:123], a[232:235], v[108:111]
v_exp_f32 v83, v83
M v[108:111], a[116:119], a[228:231], v[108:111]
buffer_load_dwordx4 v1, s[12:15], s26 offen offset:3072 sc1 lds
s_add_u32 m0, s29, 102400
s_waitcnt lgkmcnt(4)
M v[112:115], a[132:135], a[180:183], 0
v_exp_f32 v68, v68
M v[112:115], a[136:139], a[184:187], v[112:115]
ds_read_b128 a[164:167], v2 offset:12288
ds_read_b128 a[168:171], v2 offset:13312
M v[112:115], a[140:143], a[188:191], v[112:115]
v_exp_f32 v69, v69
M v[112:115], a[144:147], a[192:195], v[112:115]
buffer_load_dwordx4 v1, s[12:15], s32 offen offset:0 sc1 lds
M v[116:119], a[144:147], a[208:211], 0
v_exp_f32 v70, v70
M v[116:119], a[140:143], a[204:207], v[116:119]
v_cvt_pk_bf16_f32 v67, v82, v83
v_cvt_pk_bf16_f32 v68, v68, v69
M v[116:119], a[136:139], a[200:203], v[116:119]
v_exp_f32 v71, v71
M v[116:119], a[132:135], a[196:199], v[116:119]
buffer_load_dwordx4 v1, s[12:15], s32 offen offset:1024 sc1 lds
M v[120:123], a[132:135], a[212:215], 0
v_exp_f32 v84, v84
M v[120:123], a[136:139], a[216:219], v[120:123]
ds_read_b128 a[172:175], v2 offset:14336
ds_read_b128 a[176:179], v2 offset:15360
M v[120:123], a[140:143], a[220:223], v[120:123]
v_exp_f32 v85, v85
M v[120:123], a[144:147], a[224:227], v[120:123]
buffer_load_dwordx4 v1, s[12:15], s32 offen offset:2048 sc1 lds
M v[124:127], a[144:147], a[240:243], 0
v_exp_f32 v86, v86
M v[124:127], a[140:143], a[236:239], v[124:127]
v_cvt_pk_bf16_f32 v69, v70, v71
v_cvt_pk_bf16_f32 v70, v84, v85
M v[124:127], a[136:139], a[232:235], v[124:127]
v_exp_f32 v87, v87
M v[124:127], a[132:135], a[228:231], v[124:127]
buffer_load_dwordx4 v1, s[12:15], s32 offen offset:3072 sc1 lds
s_waitcnt lgkmcnt(4)
M v[128:131], a[148:151], a[180:183], 0
v_exp_f32 v72, v72
M v[128:131], a[152:155], a[184:187], v[128:131]
s_add_u32 s26, s26, 32768
s_cmp_eq_u32 s26, s62
s_cselect_b32 s26, s63, s26
s_cselect_b32 s62, -1, s62
M v[128:131], a[156:159], a[188:191], v[128:131]
v_exp_f32 v73, v73
M v[128:131], a[160:163], a[192:195], v[128:131]
v_cvt_pk_bf16_f32 v71, v86, v87
v_cvt_pk_bf16_f32 v72, v72, v73
M v[132:135], a[160:163], a[208:211], 0
v_exp_f32 v74, v74
M v[132:135], a[156:159], a[204:207], v[132:135]
M v[132:135], a[152:155], a[200:203], v[132:135]
v_exp_f32 v75, v75
M v[132:135], a[148:151], a[196:199], v[132:135]
v_cvt_pk_bf16_f32 v73, v74, v75
M v[136:139], a[148:151], a[212:215], 0
v_exp_f32 v88, v88
M v[136:139], a[152:155], a[216:219], v[136:139]
M v[136:139], a[156:159], a[220:223], v[136:139]
v_exp_f32 v89, v89
M v[136:139], a[160:163], a[224:227], v[136:139]
v_cvt_pk_bf16_f32 v74, v88, v89
M v[140:143], a[160:163], a[240:243], 0
v_exp_f32 v90, v90
M v[140:143], a[156:159], a[236:239], v[140:143]
s_waitcnt vmcnt(16) lgkmcnt(0)
s_barrier
ds_read_b128 a[116:119], v2 offset:32768
ds_read_b128 a[120:123], v2 offset:40960
ds_read_b128 a[124:127], v2 offset:33792
ds_read_b128 a[128:131], v2 offset:41984
M v[140:143], a[152:155], a[232:235], v[140:143]
v_exp_f32 v91, v91
M v[140:143], a[148:151], a[228:231], v[140:143]
v_cvt_pk_bf16_f32 v75, v90, v91
M v[144:147], a[164:167], a[180:183], 0
v_exp_f32 v76, v76
M v[144:147], a[168:171], a[184:187], v[144:147]
ds_read_b128 a[132:135], v2 offset:34816
ds_read_b128 a[136:139], v2 offset:43008
M v[144:147], a[172:175], a[188:191], v[144:147]
v_exp_f32 v77, v77
M v[144:147], a[176:179], a[192:195], v[144:147]
v_cvt_pk_bf16_f32 v76, v76, v77
M v[148:151], a[176:179], a[208:211], 0
v_exp_f32 v78, v78
M v[148:151], a[172:175], a[204:207], v[148:151]
M v[148:151], a[168:171], a[200:203], v[148:151]
v_exp_f32 v79, v79
M v[148:151], a[164:167], a[196:199], v[148:151]
v_cvt_pk_bf16_f32 v77, v78, v79
M v[152:155], a[164:167], a[212:215], 0
v_exp_f32 v92, v92
M v[152:155], a[168:171], a[216:219], v[152:155]
ds_read_b128 a[140:143], v2 offset:35840
ds_read_b128 a[144:147], v2 offset:44032
M v[152:155], a[172:175], a[220:223], v[152:155]
v_exp_f32 v93, v93
M v[152:155], a[176:179], a[224:227], v[152:155]
v_cvt_pk_bf16_f32 v78, v92, v93
M v[156:159], a[176:179], a[240:243], 0
v_exp_f32 v94, v94
M v[156:159], a[172:175], a[236:239], v[156:159]
M v[156:159], a[168:171], a[232:235], v[156:159]
v_exp_f32 v95, v95
M v[156:159], a[164:167], a[228:231], v[156:159]
v_cvt_pk_bf16_f32 v79, v94, v95
s_waitcnt lgkmcnt(6)
s_add_u32 m0, s29, 0
M v[160:163], a[116:119], v[32:35], v[160:163]
v_exp_f32 v96, v96
M v[160:163], a[120:123], v[64:67], v[160:163]
ds_read_b128 a[148:151], v2 offset:36864
ds_read_b128 a[152:155], v2 offset:45056
M v[164:167], a[120:123], v[68:71], v[164:167]
v_exp_f32 v97, v97
M v[164:167], a[116:119], v[36:39], v[164:167]
buffer_load_dwordx4 v1, s[12:15], s25 offen offset:0 sc1 lds
s_add_u32 s32, s25, 4096
M v[168:171], a[116:119], v[40:43], v[168:171]
v_exp_f32 v98, v98
M v[168:171], a[120:123], v[72:75], v[168:171]
v_cvt_pk_bf16_f32 v96, v96, v97
M v[172:175], a[120:123], v[76:79], v[172:175]
v_exp_f32 v99, v99
M v[172:175], a[116:119], v[44:47], v[172:175]
buffer_load_dwordx4 v1, s[12:15], s25 offen offset:1024 sc1 lds
s_waitcnt lgkmcnt(6)
M a[96:99], a[112:115], v[32:35], a[96:99]
M a[96:99], a[112:115], v[64:67], a[96:99]
M v[176:179], a[124:127], v[32:35], v[176:179]
v_exp_f32 v112, v112
M v[176:179], a[128:131], v[64:67], v[176:179]
ds_read_b128 a[156:159], v2 offset:37888
ds_read_b128 a[160:163], v2 offset:46080
M v[180:183], a[128:131], v[68:71], v[180:183]
v_exp_f32 v113, v113
M v[180:183], a[124:127], v[36:39], v[180:183]
buffer_load_dwordx4 v1, s[12:15], s25 offen offset:2048 sc1 lds
M v[184:187], a[124:127], v[40:43], v[184:187]
v_exp_f32 v114, v114
M v[184:187], a[128:131], v[72:75], v[184:187]
v_cvt_pk_bf16_f32 v97, v98, v99
v_cvt_pk_bf16_f32 v98, v112, v113
M v[188:191], a[128:131], v[76:79], v[188:191]
v_exp_f32 v115, v115
M v[188:191], a[124:127], v[44:47], v[188:191]
buffer_load_dwordx4 v1, s[12:15], s25 offen offset:3072 sc1 lds
s_add_u32 m0, s29, 4096
s_waitcnt lgkmcnt(6)
M a[100:103], a[112:115], v[36:39], a[100:103]
M a[100:103], a[112:115], v[68:71], a[100:103]
M v[192:195], a[132:135], v[32:35], v[192:195]
v_exp_f32 v100, v100
M v[192:195], a[136:139], v[64:67], v[192:195]
ds_read_b128 a[164:167], v2 offset:38912
ds_read_b128 a[168:171], v2 offset:47104
M v[196:199], a[136:139], v[68:71], v[196:199]
v_exp_f32 v101, v101
M v[196:199], a[132:135], v[36:39], v[196:199]
buffer_load_dwordx4 v1, s[12:15], s32 offen offset:0 sc1 lds
M v[200:203], a[132:135], v[40:43], v[200:203]
v_exp_f32 v102, v102
M v[200:203], a[136:139], v[72:75], v[200:203]
v_cvt_pk_bf16_f32 v99, v114, v115
v_cvt_pk_bf16_f32 v100, v100, v101
M v[204:207], a[136:139], v[76:79], v[204:207]
v_exp_f32 v103, v103
M v[204:207], a[132:135], v[44:47], v[204:207]
buffer_load_dwordx4 v1, s[12:15], s32 offen offset:1024 sc1 lds
s_waitcnt lgkmcnt(6)
M a[104:107], a[112:115], v[40:43], a[104:107]
M a[104:107], a[112:115], v[72:75], a[104:107]
M v[208:211], a[140:143], v[32:35], v[208:211]
v_exp_f32 v116, v116
M v[208:211], a[144:147], v[64:67], v[208:211]
ds_read_b128 a[172:175], v2 offset:39936
ds_read_b128 a[176:179], v2 offset:48128
M v[212:215], a[144:147], v[68:71], v[212:215]
v_exp_f32 v117, v117
M v[212:215], a[140:143], v[36:39], v[212:215]
buffer_load_dwordx4 v1, s[12:15], s32 offen offset:2048 sc1 lds
M v[216:219], a[140:143], v[40:43], v[216:219]
v_exp_f32 v118, v118
M v[216:219], a[144:147], v[72:75], v[216:219]
v_cvt_pk_bf16_f32 v101, v102, v103
v_cvt_pk_bf16_f32 v102, v116, v117
M v[220:223], a[144:147], v[76:79], v[220:223]
v_exp_f32 v119, v119
M v[220:223], a[140:143], v[44:47], v[220:223]
buffer_load_dwordx4 v1, s[12:15], s32 offen offset:3072 sc1 lds
s_waitcnt lgkmcnt(6)
M a[108:111], a[112:115], v[44:47], a[108:111]
M a[108:111], a[112:115], v[76:79], a[108:111]
M v[224:227], a[148:151], v[32:35], v[224:227]
v_exp_f32 v104, v104
M v[224:227], a[152:155], v[64:67], v[224:227]
s_add_u32 s25, s25, 32768
s_cmp_eq_u32 s25, s27
s_cselect_b32 s25, s28, s25
s_cselect_b32 s27, -1, s27
M v[228:231], a[152:155], v[68:71], v[228:231]
v_exp_f32 v105, v105
M v[228:231], a[148:151], v[36:39], v[228:231]
v_cvt_pk_bf16_f32 v103, v118, v119
v_cvt_pk_bf16_f32 v104, v104, v105
M v[232:235], a[148:151], v[40:43], v[232:235]
v_exp_f32 v106, v106
M v[232:235], a[152:155], v[72:75], v[232:235]
M v[236:239], a[152:155], v[76:79], v[236:239]
v_exp_f32 v107, v107
M v[236:239], a[148:151], v[44:47], v[236:239]
v_cvt_pk_bf16_f32 v105, v106, v107
s_waitcnt lgkmcnt(4)
M v[240:243], a[156:159], v[32:35], v[240:243]
v_exp_f32 v120, v120
M v[240:243], a[160:163], v[64:67], v[240:243]
M v[244:247], a[160:163], v[68:71], v[244:247]
v_exp_f32 v121, v121
M v[244:247], a[156:159], v[36:39], v[244:247]
v_cvt_pk_bf16_f32 v106, v120, v121
M v[248:251], a[156:159], v[40:43], v[248:251]
v_exp_f32 v122, v122
M v[248:251], a[160:163], v[72:75], v[248:251]
s_waitcnt vmcnt(16) lgkmcnt(0)
s_barrier
ds_read_b128 a[116:119], v3 offset:0
ds_read_b128 a[120:123], v3 offset:1024
ds_read_b128 a[124:127], v3 offset:2048
ds_read_b128 a[128:131], v3 offset:3072
M v[252:255], a[160:163], v[76:79], v[252:255]
v_exp_f32 v123, v123
M v[252:255], a[156:159], v[44:47], v[252:255]
v_cvt_pk_bf16_f32 v107, v122, v123
M a[64:67], a[164:167], v[32:35], a[64:67]
v_exp_f32 v108, v108
M a[64:67], a[168:171], v[64:67], a[64:67]
ds_read_b128 a[132:135], v3 offset:4096
ds_read_b128 a[136:139], v3 offset:5120
M a[68:71], a[168:171], v[68:71], a[68:71]
v_exp_f32 v109, v109
M a[68:71], a[164:167], v[36:39], a[68:71]
v_cvt_pk_bf16_f32 v108, v108, v109
M a[72:75], a[164:167], v[40:43], a[72:75]
v_exp_f32 v110, v110
M a[72:75], a[168:171], v[72:75], a[72:75]
M a[76:79], a[168:171], v[76:79], a[76:79]
v_exp_f32 v111, v111
M a[76:79], a[164:167], v[44:47], a[76:79]
v_cvt_pk_bf16_f32 v109, v110, v111
M a[80:83], a[172:175], v[32:35], a[80:83]
v_exp_f32 v124, v124
M a[80:83], a[176:179], v[64:67], a[80:83]
ds_read_b128 a[140:143], v3 offset:6144
ds_read_b128 a[144:147], v3 offset:7168
M a[84:87], a[176:179], v[68:71], a[84:87]
v_exp_f32 v125, v125
M a[84:87], a[172:175], v[36:39], a[84:87]
v_cvt_pk_bf16_f32 v110, v124, v125
M a[88:91], a[172:175], v[40:43], a[88:91]
v_exp_f32 v126, v126
M a[88:91], a[176:179], v[72:75], a[88:91]
M a[92:95], a[176:179], v[76:79], a[92:95]
v_exp_f32 v127, v127
M a[92:95], a[172:175], v[44:47], a[92:95]
v_cvt_pk_bf16_f32 v111, v126, v127
Lk2_l2b:
s_waitcnt lgkmcnt(4)
s_add_u32 m0, s29, 32768
M v[32:35], a[116:119], a[180:183], 0
v_exp_f32 v128, v128
M v[32:35], a[120:123], a[184:187], v[32:35]
ds_read_b128 a[148:151], v3 offset:8192
ds_read_b128 a[152:155], v3 offset:9216
M v[32:35], a[124:127], a[188:191], v[32:35]
v_exp_f32 v129, v129
M v[32:35], a[128:131], a[192:195], v[32:35]
buffer_load_dwordx4 v1, s[12:15], s26 offen offset:0 sc1 lds
s_add_u32 s32, s26, 4096
M v[36:39], a[128:131], a[208:211], 0
v_exp_f32 v130, v130
M v[36:39], a[124:127], a[204:207], v[36:39]
v_cvt_pk_bf16_f32 v128, v128, v129
M v[36:39], a[120:123], a[200:203], v[36:39]
v_exp_f32 v131, v131
M v[36:39], a[116:119], a[196:199], v[36:39]
buffer_load_dwordx4 v1, s[12:15], s26 offen offset:1024 sc1 lds
M v[40:43], a[116:119], a[212:215], 0
v_exp_f32 v144, v144
M v[40:43], a[120:123], a[216:219], v[40:43]
ds_read_b128 a[156:159], v3 offset:10240
ds_read_b128 a[160:163], v3 offset:11264
M v[40:43], a[124:127], a[220:223], v[40:43]
v_exp_f32 v145, v145
M v[40:43], a[128:131], a[224:227], v[40:43]
buffer_load_dwordx4 v1, s[12:15], s26 offen offset:2048 sc1 lds
M v[44:47], a[128:131], a[240:243], 0
v_exp_f32 v146, v146
M v[44:47], a[124:127], a[236:239], v[44:47]
v_cvt_pk_bf16_f32 v129, v130, v131
v_cvt_pk_bf16_f32 v130, v144, v145
M v[44:47], a[120:123], a[232:235], v[44:47]
v_exp_f32 v147, v147
M v[44:47], a[116:119], a[228:231], v[44:47]
buffer_load_dwordx4 v1, s[12:15], s26 offen offset:3072 sc1 lds
s_add_u32 m0, s29, 36864
s_waitcnt lgkmcnt(4)
M v[48:51], a[132:135], a[180:183], 0
v_exp_f32 v132, v132
M v[48:51], a[136:139], a[184:187], v[48:51]
ds_read_b128 a[164:167], v3 offset:12288
ds_read_b128 a[168:171], v3 offset:13312
M v[48:51], a[140:143], a[188:191], v[48:51]
v_exp_f32 v133, v133
M v[48:51], a[144:147], a[192:195], v[48:51]
buffer_load_dwordx4 v1, s[12:15], s32 offen offset:0 sc1 lds
M v[52:55], a[144:147], a[208:211], 0
v_exp_f32 v134, v134
M v[52:55], a[140:143], a[204:207], v[52:55]
v_cvt_pk_bf16_f32 v131, v146, v147
v_cvt_pk_bf16_f32 v132, v132, v133
M v[52:55], a[136:139], a[200:203], v[52:55]
v_exp_f32 v135, v135
M v[52:55], a[132:135], a[196:199], v[52:55]
buffer_load_dwordx4 v1, s[12:15], s32 offen offset:1024 sc1 lds
M v[56:59], a[132:135], a[212:215], 0
v_exp_f32 v148, v148
M v[56:59], a[136:139], a[216:219], v[56:59]
ds_read_b128 a[172:175], v3 offset:14336
ds_read_b128 a[176:179], v3 offset:15360
M v[56:59], a[140:143], a[220:223], v[56:59]
v_exp_f32 v149, v149
M v[56:59], a[144:147], a[224:227], v[56:59]
buffer_load_dwordx4 v1, s[12:15], s32 offen offset:2048 sc1 lds
M v[60:63], a[144:147], a[240:243], 0
v_exp_f32 v150, v150
M v[60:63], a[140:143], a[236:239], v[60:63]
v_cvt_pk_bf16_f32 v133, v134, v135
v_cvt_pk_bf16_f32 v134, v148, v149
M v[60:63], a[136:139], a[232:235], v[60:63]
v_exp_f32 v151, v151
M v[60:63], a[132:135], a[228:231], v[60:63]
buffer_load_dwordx4 v1, s[12:15], s32 offen offset:3072 sc1 lds
s_waitcnt lgkmcnt(4)
M v[64:67], a[148:151], a[180:183], 0
v_exp_f32 v136, v136
M v[64:67], a[152:155], a[184:187], v[64:67]
s_add_u32 s26, s26, 32768
s_cmp_eq_u32 s26, s62
s_cselect_b32 s26, s63, s26
s_cselect_b32 s62, -1, s62
M v[64:67], a[156:159], a[188:191], v[64:67]
v_exp_f32 v137, v137
M v[64:67], a[160:163], a[192:195], v[64:67]
v_cvt_pk_bf16_f32 v135, v150, v151
v_cvt_pk_bf16_f32 v136, v136, v137
M v[68:71], a[160:163], a[208:211], 0
v_exp_f32 v138, v138
M v[68:71], a[156:159], a[204:207], v[68:71]
M v[68:71], a[152:155], a[200:203], v[68:71]
v_exp_f32 v139, v139
M v[68:71], a[148:151], a[196:199], v[68:71]
v_cvt_pk_bf16_f32 v137, v138, v139
M v[72:75], a[148:151], a[212:215], 0
v_exp_f32 v152, v152
M v[72:75], a[152:155], a[216:219], v[72:75]
M v[72:75], a[156:159], a[220:223], v[72:75]
v_exp_f32 v153, v153
M v[72:75], a[160:163], a[224:227], v[72:75]
v_cvt_pk_bf16_f32 v138, v152, v153
M v[76:79], a[160:163], a[240:243], 0
v_exp_f32 v154, v154
M v[76:79], a[156:159], a[236:239], v[76:79]
s_waitcnt vmcnt(16) lgkmcnt(0)
s_barrier
ds_read_b128 a[116:119], v3 offset:32768
ds_read_b128 a[120:123], v3 offset:40960
ds_read_b128 a[124:127], v3 offset:33792
ds_read_b128 a[128:131], v3 offset:41984
M v[76:79], a[152:155], a[232:235], v[76:79]
v_exp_f32 v155, v155
M v[76:79], a[148:151], a[228:231], v[76:79]
v_cvt_pk_bf16_f32 v139, v154, v155
M v[80:83], a[164:167], a[180:183], 0
v_exp_f32 v140, v140
M v[80:83], a[168:171], a[184:187], v[80:83]
ds_read_b128 a[132:135], v3 offset:34816
ds_read_b128 a[136:139], v3 offset:43008
M v[80:83], a[172:175], a[188:191], v[80:83]
v_exp_f32 v141, v141
M v[80:83], a[176:179], a[192:195], v[80:83]
v_cvt_pk_bf16_f32 v140, v140, v141
M v[84:87], a[176:179], a[208:211], 0
v_exp_f32 v142, v142
M v[84:87], a[172:175], a[204:207], v[84:87]
M v[84:87], a[168:171], a[200:203], v[84:87]
v_exp_f32 v143, v143
M v[84:87], a[164:167], a[196:199], v[84:87]
v_cvt_pk_bf16_f32 v141, v142, v143
M v[88:91], a[164:167], a[212:215], 0
v_exp_f32 v156, v156
M v[88:91], a[168:171], a[216:219], v[88:91]
ds_read_b128 a[140:143], v3 offset:35840
ds_read_b128 a[144:147], v3 offset:44032
M v[88:91], a[172:175], a[220:223], v[88:91]
v_exp_f32 v157, v157
M v[88:91], a[176:179], a[224:227], v[88:91]
v_cvt_pk_bf16_f32 v142, v156, v157
M v[92:95], a[176:179], a[240:243], 0
v_exp_f32 v158, v158
M v[92:95], a[172:175], a[236:239], v[92:95]
M v[92:95], a[168:171], a[232:235], v[92:95]
v_exp_f32 v159, v159
M v[92:95], a[164:167], a[228:231], v[92:95]
v_cvt_pk_bf16_f32 v143, v158, v159
s_waitcnt lgkmcnt(6)
s_add_u32 m0, s29, 65536
M v[160:163], a[116:119], v[96:99], v[160:163]
v_exp_f32 v32, v32
M v[160:163], a[120:123], v[128:131], v[160:163]
ds_read_b128 a[148:151], v3 offset:36864
ds_read_b128 a[152:155], v3 offset:45056
M v[164:167], a[120:123], v[132:135], v[164:167]
v_exp_f32 v33, v33
M v[164:167], a[116:119], v[100:103], v[164:167]
buffer_load_dwordx4 v1, s[12:15], s25 offen offset:0 sc1 lds
s_add_u32 s32, s25, 4096
M v[168:171], a[116:119], v[104:107], v[168:171]
v_exp_f32 v34, v34
M v[168:171], a[120:123], v[136:139], v[168:171]
v_cvt_pk_bf16_f32 v32, v32, v33
M v[172:175], a[120:123], v[140:143], v[172:175]
v_exp_f32 v35, v35
M v[172:175], a[116:119], v[108:111], v[172:175]
buffer_load_dwordx4 v1, s[12:15], s25 offen offset:1024 sc1 lds
s_waitcnt lgkmcnt(6)
M a[96:99], a[112:115], v[96:99], a[96:99]
M a[96:99], a[112:115], v[128:131], a[96:99]
M v[176:179], a[124:127], v[96:99], v[176:179]
v_exp_f32 v48, v48
M v[176:179], a[128:131], v[128:131], v[176:179]
ds_read_b128 a[156:159], v3 offset:37888
ds_read_b128 a[160:163], v3 offset:46080
M v[180:183], a[128:131], v[132:135], v[180:183]
v_exp_f32 v49, v49
M v[180:183], a[124:127], v[100:103], v[180:183]
buffer_load_dwordx4 v1, s[12:15], s25 offen offset:2048 sc1 lds
M v[184:187], a[124:127], v[104:107], v[184:187]
v_exp_f32 v50, v50
M v[184:187], a[128:131], v[136:139], v[184:187]
v_cvt_pk_bf16_f32 v33, v34, v35
v_cvt_pk_bf16_f32 v34, v48, v49
M v[188:191], a[128:131], v[140:143], v[188:191]
v_exp_f32 v51, v51
M v[188:191], a[124:127], v[108:111], v[188:191]
buffer_load_dwordx4 v1, s[12:15], s25 offen offset:3072 sc1 lds
s_add_u32 m0, s29, 69632
s_waitcnt lgkmcnt(6)
M a[100:103], a[112:115], v[100:103], a[100:103]
M a[100:103], a[112:115], v[132:135], a[100:103]
M v[192:195], a[132:135], v[96:99], v[192:195]
v_exp_f32 v36, v36
M v[192:195], a[136:139], v[128:131], v[192:195]
ds_read_b128 a[164:167], v3 offset:38912
ds_read_b128 a[168:171], v3 offset:47104
M v[196:199], a[136:139], v[132:135], v[196:199]
v_exp_f32 v37, v37
M v[196:199], a[132:135], v[100:103], v[196:199]
buffer_load_dwordx4 v1, s[12:15], s32 offen offset:0 sc1 lds
M v[200:203], a[132:135], v[104:107], v[200:203]
v_exp_f32 v38, v38
M v[200:203], a[136:139], v[136:139], v[200:203]
v_cvt_pk_bf16_f32 v35, v50, v51
v_cvt_pk_bf16_f32 v36, v36, v37
M v[204:207], a[136:139], v[140:143], v[204:207]
v_exp_f32 v39, v39
M v[204:207], a[132:135], v[108:111], v[204:207]
buffer_load_dwordx4 v1, s[12:15], s32 offen offset:1024 sc1 lds
s_waitcnt lgkmcnt(6)
M a[104:107], a[112:115], v[104:107], a[104:107]
M a[104:107], a[112:115], v[136:139], a[104:107]
M v[208:211], a[140:143], v[96:99], v[208:211]
v_exp_f32 v52, v52
M v[208:211], a[144:147], v[128:131], v[208:211]
ds_read_b128 a[172:175], v3 offset:39936
ds_read_b128 a[176:179], v3 offset:48128
M v[212:215], a[144:147], v[132:135], v[212:215]
v_exp_f32 v53, v53
M v[212:215], a[140:143], v[100:103], v[212:215]
buffer_load_dwordx4 v1, s[12:15], s32 offen offset:2048 sc1 lds
M v[216:219], a[140:143], v[104:107], v[216:219]
v_exp_f32 v54, v54
M v[216:219], a[144:147], v[136:139], v[216:219]
v_cvt_pk_bf16_f32 v37, v38, v39
v_cvt_pk_bf16_f32 v38, v52, v53
M v[220:223], a[144:147], v[140:143], v[220:223]
v_exp_f32 v55, v55
M v[220:223], a[140:143], v[108:111], v[220:223]
buffer_load_dwordx4 v1, s[12:15], s32 offen offset:3072 sc1 lds
s_waitcnt lgkmcnt(6)
M a[108:111], a[112:115], v[108:111], a[108:111]
M a[108:111], a[112:115], v[140:143], a[108:111]
M v[224:227], a[148:151], v[96:99], v[224:227]
v_exp_f32 v40, v40
M v[224:227], a[152:155], v[128:131], v[224:227]
s_add_u32 s25, s25, 32768
s_cmp_eq_u32 s25, s27
s_cselect_b32 s25, s28, s25
s_cselect_b32 s27, -1, s27
M v[228:231], a[152:155], v[132:135], v[228:231]
v_exp_f32 v41, v41
M v[228:231], a[148:151], v[100:103], v[228:231]
v_cvt_pk_bf16_f32 v39, v54, v55
v_cvt_pk_bf16_f32 v40, v40, v41
M v[232:235], a[148:151], v[104:107], v[232:235]
v_exp_f32 v42, v42
M v[232:235], a[152:155], v[136:139], v[232:235]
M v[236:239], a[152:155], v[140:143], v[236:239]
v_exp_f32 v43, v43
M v[236:239], a[148:151], v[108:111], v[236:239]
v_cvt_pk_bf16_f32 v41, v42, v43
s_waitcnt lgkmcnt(4)
M v[240:243], a[156:159], v[96:99], v[240:243]
v_exp_f32 v56, v56
M v[240:243], a[160:163], v[128:131], v[240:243]
M v[244:247], a[160:163], v[132:135], v[244:247]
v_exp_f32 v57, v57
M v[244:247], a[156:159], v[100:103], v[244:247]
v_cvt_pk_bf16_f32 v42, v56, v57
M v[248:251], a[156:159], v[104:107], v[248:251]
v_exp_f32 v58, v58
M v[248:251], a[160:163], v[136:139], v[248:251]
s_waitcnt vmcnt(16) lgkmcnt(0)
s_barrier
ds_read_b128 a[116:119], v2 offset:0
ds_read_b128 a[120:123], v2 offset:1024
ds_read_b128 a[124:127], v2 offset:2048
ds_read_b128 a[128:131], v2 offset:3072
M v[252:255], a[160:163], v[140:143], v[252:255]
v_exp_f32 v59, v59
M v[252:255], a[156:159], v[108:111], v[252:255]
v_cvt_pk_bf16_f32 v43, v58, v59
M a[64:67], a[164:167], v[96:99], a[64:67]
v_exp_f32 v44, v44
M a[64:67], a[168:171], v[128:131], a[64:67]
ds_read_b128 a[132:135], v2 offset:4096
ds_read_b128 a[136:139], v2 offset:5120
M a[68:71], a[168:171], v[132:135], a[68:71]
v_exp_f32 v45, v45
M a[68:71], a[164:167], v[100:103], a[68:71]
v_cvt_pk_bf16_f32 v44, v44, v45
M a[72:75], a[164:167], v[104:107], a[72:75]
v_exp_f32 v46, v46
M a[72:75], a[168:171], v[136:139], a[72:75]
M a[76:79], a[168:171], v[140:143], a[76:79]
v_exp_f32 v47, v47
M a[76:79], a[164:167], v[108:111], a[76:79]
v_cvt_pk_bf16_f32 v45, v46, v47
M a[80:83], a[172:175], v[96:99], a[80:83]
v_exp_f32 v60, v60
M a[80:83], a[176:179], v[128:131], a[80:83]
ds_read_b128 a[140:143], v2 offset:6144
ds_read_b128 a[144:147], v2 offset:7168
M a[84:87], a[176:179], v[132:135], a[84:87]
v_exp_f32 v61, v61
M a[84:87], a[172:175], v[100:103], a[84:87]
v_cvt_pk_bf16_f32 v46, v60, v61
M a[88:91], a[172:175], v[104:107], a[88:91]
v_exp_f32 v62, v62
M a[88:91], a[176:179], v[136:139], a[88:91]
M a[92:95], a[176:179], v[140:143], a[92:95]
v_exp_f32 v63, v63
M a[92:95], a[172:175], v[108:111], a[92:95]
v_cvt_pk_bf16_f32 v47, v62, v63
s_sub_u32 s30, s30, 1
s_cmp_lg_u32 s30, 0
s_cbranch_scc1 Lk2_l2
s_branch Lk2_fin
Lk2_g1:
s_mov_b32 s30, 7
Lk2_l3:
s_waitcnt lgkmcnt(4)
s_add_u32 m0, s29, 98304
M v[96:99], a[116:119], a[0:3], 0
v_exp_f32 v64, v64
M v[96:99], a[120:123], a[4:7], v[96:99]
ds_read_b128 a[148:151], v2 offset:8192
ds_read_b128 a[152:155], v2 offset:9216
M v[96:99], a[124:127], a[8:11], v[96:99]
v_exp_f32 v65, v65
M v[96:99], a[128:131], a[12:15], v[96:99]
buffer_load_dwordx4 v1, s[12:15], s26 offen offset:0 sc1 lds
s_add_u32 s32, s26, 4096
M v[100:103], a[128:131], a[28:31], 0
v_exp_f32 v66, v66
M v[100:103], a[124:127], a[24:27], v[100:103]
v_cvt_pk_bf16_f32 v64, v64, v65
M v[100:103], a[120:123], a[20:23], v[100:103]
v_exp_f32 v67, v67
M v[100:103], a[116:119], a[16:19], v[100:103]
buffer_load_dwordx4 v1, s[12:15], s26 offen offset:1024 sc1 lds
M v[104:107], a[116:119], a[32:35], 0
v_exp_f32 v80, v80
M v[104:107], a[120:123], a[36:39], v[104:107]
ds_read_b128 a[156:159], v2 offset:10240
ds_read_b128 a[160:163], v2 offset:11264
M v[104:107], a[124:127], a[40:43], v[104:107]
v_exp_f32 v81, v81
M v[104:107], a[128:131], a[44:47], v[104:107]
buffer_load_dwordx4 v1, s[12:15], s26 offen offset:2048 sc1 lds
M v[108:111], a[128:131], a[60:63], 0
v_exp_f32 v82, v82
M v[108:111], a[124:127], a[56:59], v[108:111]
v_cvt_pk_bf16_f32 v65, v66, v67
v_cvt_pk_bf16_f32 v66, v80, v81
M v[108:111], a[120:123], a[52:55], v[108:111]
v_exp_f32 v83, v83
M v[108:111], a[116:119], a[48:51], v[108:111]
buffer_load_dwordx4 v1, s[12:15], s26 offen offset:3072 sc1 lds
s_add_u32 m0, s29, 102400
s_waitcnt lgkmcnt(4)
M v[112:115], a[132:135], a[0:3], 0
v_exp_f32 v68, v68
M v[112:115], a[136:139], a[4:7], v[112:115]
ds_read_b128 a[164:167], v2 offset:12288
ds_read_b128 a[168:171], v2 offset:13312
M v[112:115], a[140:143], a[8:11], v[112:115]
v_exp_f32 v69, v69
M v[112:115], a[144:147], a[12:15], v[112:115]
buffer_load_dwordx4 v1, s[12:15], s32 offen offset:0 sc1 lds
M v[116:119], a[144:147], a[28:31], 0
v_exp_f32 v70, v70
M v[116:119], a[140:143], a[24:27], v[116:119]
v_cvt_pk_bf16_f32 v67, v82, v83
v_cvt_pk_bf16_f32 v68, v68, v69
M v[116:119], a[136:139], a[20:23], v[116:119]
v_exp_f32 v71, v71
M v[116:119], a[132:135], a[16:19], v[116:119]
buffer_load_dwordx4 v1, s[12:15], s32 offen offset:1024 sc1 lds
M v[120:123], a[132:135], a[32:35], 0
v_exp_f32 v84, v84
M v[120:123], a[136:139], a[36:39], v[120:123]
ds_read_b128 a[172:175], v2 offset:14336
ds_read_b128 a[176:179], v2 offset:15360
M v[120:123], a[140:143], a[40:43], v[120:123]
v_exp_f32 v85, v85
M v[120:123], a[144:147], a[44:47], v[120:123]
buffer_load_dwordx4 v1, s[12:15], s32 offen offset:2048 sc1 lds
M v[124:127], a[144:147], a[60:63], 0
v_exp_f32 v86, v86
M v[124:127], a[140:143], a[56:59], v[124:127]
v_cvt_pk_bf16_f32 v69, v70, v71
v_cvt_pk_bf16_f32 v70, v84, v85
M v[124:127], a[136:139], a[52:55], v[124:127]
v_exp_f32 v87, v87
M v[124:127], a[132:135], a[48:51], v[124:127]
buffer_load_dwordx4 v1, s[12:15], s32 offen offset:3072 sc1 lds
s_waitcnt lgkmcnt(4)
M v[128:131], a[148:151], a[0:3], 0
v_exp_f32 v72, v72
M v[128:131], a[152:155], a[4:7], v[128:131]
s_add_u32 s26, s26, 32768
s_cmp_eq_u32 s26, s62
s_cselect_b32 s26, s63, s26
s_cselect_b32 s62, -1, s62
M v[128:131], a[156:159], a[8:11], v[128:131]
v_exp_f32 v73, v73
M v[128:131], a[160:163], a[12:15], v[128:131]
v_cvt_pk_bf16_f32 v71, v86, v87
v_cvt_pk_bf16_f32 v72, v72, v73
M v[132:135], a[160:163], a[28:31], 0
v_exp_f32 v74, v74
M v[132:135], a[156:159], a[24:27], v[132:135]
M v[132:135], a[152:155], a[20:23], v[132:135]
v_exp_f32 v75, v75
M v[132:135], a[148:151], a[16:19], v[132:135]
v_cvt_pk_bf16_f32 v73, v74, v75
M v[136:139], a[148:151], a[32:35], 0
v_exp_f32 v88, v88
M v[136:139], a[152:155], a[36:39], v[136:139]
M v[136:139], a[156:159], a[40:43], v[136:139]
v_exp_f32 v89, v89
M v[136:139], a[160:163], a[44:47], v[136:139]
v_cvt_pk_bf16_f32 v74, v88, v89
M v[140:143], a[160:163], a[60:63], 0
v_exp_f32 v90, v90
M v[140:143], a[156:159], a[56:59], v[140:143]
s_waitcnt vmcnt(16) lgkmcnt(0)
s_barrier
ds_read_b128 a[116:119], v2 offset:32768
ds_read_b128 a[120:123], v2 offset:40960
ds_read_b128 a[124:127], v2 offset:33792
ds_read_b128 a[128:131], v2 offset:41984
M v[140:143], a[152:155], a[52:55], v[140:143]
v_exp_f32 v91, v91
M v[140:143], a[148:151], a[48:51], v[140:143]
v_cvt_pk_bf16_f32 v75, v90, v91
M v[144:147], a[164:167], a[0:3], 0
v_exp_f32 v76, v76
M v[144:147], a[168:171], a[4:7], v[144:147]
ds_read_b128 a[132:135], v2 offset:34816
ds_read_b128 a[136:139], v2 offset:43008
M v[144:147], a[172:175], a[8:11], v[144:147]
v_exp_f32 v77, v77
M v[144:147], a[176:179], a[12:15], v[144:147]
v_cvt_pk_bf16_f32 v76, v76, v77
M v[148:151], a[176:179], a[28:31], 0
v_exp_f32 v78, v78
M v[148:151], a[172:175], a[24:27], v[148:151]
M v[148:151], a[168:171], a[20:23], v[148:151]
v_exp_f32 v79, v79
M v[148:151], a[164:167], a[16:19], v[148:151]
v_cvt_pk_bf16_f32 v77, v78, v79
M v[152:155], a[164:167], a[32:35], 0
v_exp_f32 v92, v92
M v[152:155], a[168:171], a[36:39], v[152:155]
ds_read_b128 a[140:143], v2 offset:35840
ds_read_b128 a[144:147], v2 offset:44032
M v[152:155], a[172:175], a[40:43], v[152:155]
v_exp_f32 v93, v93
M v[152:155], a[176:179], a[44:47], v[152:155]
v_cvt_pk_bf16_f32 v78, v92, v93
M v[156:159], a[176:179], a[60:63], 0
v_exp_f32 v94, v94
M v[156:159], a[172:175], a[56:59], v[156:159]
M v[156:159], a[168:171], a[52:55], v[156:159]
v_exp_f32 v95, v95
M v[156:159], a[164:167], a[48:51], v[156:159]
v_cvt_pk_bf16_f32 v79, v94, v95
s_waitcnt lgkmcnt(6)
s_add_u32 m0, s29, 0
M v[160:163], a[116:119], v[32:35], v[160:163]
v_exp_f32 v96, v96
M v[160:163], a[120:123], v[64:67], v[160:163]
ds_read_b128 a[148:151], v2 offset:36864
ds_read_b128 a[152:155], v2 offset:45056
M v[164:167], a[120:123], v[68:71], v[164:167]
v_exp_f32 v97, v97
M v[164:167], a[116:119], v[36:39], v[164:167]
buffer_load_dwordx4 v1, s[12:15], s25 offen offset:0 sc1 lds
s_add_u32 s32, s25, 4096
M v[168:171], a[116:119], v[40:43], v[168:171]
v_exp_f32 v98, v98
M v[168:171], a[120:123], v[72:75], v[168:171]
v_cvt_pk_bf16_f32 v96, v96, v97
M v[172:175], a[120:123], v[76:79], v[172:175]
v_exp_f32 v99, v99
M v[172:175], a[116:119], v[44:47], v[172:175]
buffer_load_dwordx4 v1, s[12:15], s25 offen offset:1024 sc1 lds
s_waitcnt lgkmcnt(6)
M a[96:99], a[112:115], v[32:35], a[96:99]
M a[96:99], a[112:115], v[64:67], a[96:99]
M v[176:179], a[124:127], v[32:35], v[176:179]
v_exp_f32 v112, v112
M v[176:179], a[128:131], v[64:67], v[176:179]
ds_read_b128 a[156:159], v2 offset:37888
ds_read_b128 a[160:163], v2 offset:46080
M v[180:183], a[128:131], v[68:71], v[180:183]
v_exp_f32 v113, v113
M v[180:183], a[124:127], v[36:39], v[180:183]
buffer_load_dwordx4 v1, s[12:15], s25 offen offset:2048 sc1 lds
M v[184:187], a[124:127], v[40:43], v[184:187]
v_exp_f32 v114, v114
M v[184:187], a[128:131], v[72:75], v[184:187]
v_cvt_pk_bf16_f32 v97, v98, v99
v_cvt_pk_bf16_f32 v98, v112, v113
M v[188:191], a[128:131], v[76:79], v[188:191]
v_exp_f32 v115, v115
M v[188:191], a[124:127], v[44:47], v[188:191]
buffer_load_dwordx4 v1, s[12:15], s25 offen offset:3072 sc1 lds
s_add_u32 m0, s29, 4096
s_waitcnt lgkmcnt(6)
M a[100:103], a[112:115], v[36:39], a[100:103]
M a[100:103], a[112:115], v[68:71], a[100:103]
M v[192:195], a[132:135], v[32:35], v[192:195]
v_exp_f32 v100, v100
M v[192:195], a[136:139], v[64:67], v[192:195]
ds_read_b128 a[164:167], v2 offset:38912
ds_read_b128 a[168:171], v2 offset:47104
M v[196:199], a[136:139], v[68:71], v[196:199]
v_exp_f32 v101, v101
M v[196:199], a[132:135], v[36:39], v[196:199]
buffer_load_dwordx4 v1, s[12:15], s32 offen offset:0 sc1 lds
M v[200:203], a[132:135], v[40:43], v[200:203]
v_exp_f32 v102, v102
M v[200:203], a[136:139], v[72:75], v[200:203]
v_cvt_pk_bf16_f32 v99, v114, v115
v_cvt_pk_bf16_f32 v100, v100, v101
M v[204:207], a[136:139], v[76:79], v[204:207]
v_exp_f32 v103, v103
M v[204:207], a[132:135], v[44:47], v[204:207]
buffer_load_dwordx4 v1, s[12:15], s32 offen offset:1024 sc1 lds
s_waitcnt lgkmcnt(6)
M a[104:107], a[112:115], v[40:43], a[104:107]
M a[104:107], a[112:115], v[72:75], a[104:107]
M v[208:211], a[140:143], v[32:35], v[208:211]
v_exp_f32 v116, v116
M v[208:211], a[144:147], v[64:67], v[208:211]
ds_read_b128 a[172:175], v2 offset:39936
ds_read_b128 a[176:179], v2 offset:48128
M v[212:215], a[144:147], v[68:71], v[212:215]
v_exp_f32 v117, v117
M v[212:215], a[140:143], v[36:39], v[212:215]
buffer_load_dwordx4 v1, s[12:15], s32 offen offset:2048 sc1 lds
M v[216:219], a[140:143], v[40:43], v[216:219]
v_exp_f32 v118, v118
M v[216:219], a[144:147], v[72:75], v[216:219]
v_cvt_pk_bf16_f32 v101, v102, v103
v_cvt_pk_bf16_f32 v102, v116, v117
M v[220:223], a[144:147], v[76:79], v[220:223]
v_exp_f32 v119, v119
M v[220:223], a[140:143], v[44:47], v[220:223]
buffer_load_dwordx4 v1, s[12:15], s32 offen offset:3072 sc1 lds
s_waitcnt lgkmcnt(6)
M a[108:111], a[112:115], v[44:47], a[108:111]
M a[108:111], a[112:115], v[76:79], a[108:111]
M v[224:227], a[148:151], v[32:35], v[224:227]
v_exp_f32 v104, v104
M v[224:227], a[152:155], v[64:67], v[224:227]
s_add_u32 s25, s25, 32768
s_cmp_eq_u32 s25, s27
s_cselect_b32 s25, s28, s25
s_cselect_b32 s27, -1, s27
M v[228:231], a[152:155], v[68:71], v[228:231]
v_exp_f32 v105, v105
M v[228:231], a[148:151], v[36:39], v[228:231]
v_cvt_pk_bf16_f32 v103, v118, v119
v_cvt_pk_bf16_f32 v104, v104, v105
M v[232:235], a[148:151], v[40:43], v[232:235]
v_exp_f32 v106, v106
M v[232:235], a[152:155], v[72:75], v[232:235]
M v[236:239], a[152:155], v[76:79], v[236:239]
v_exp_f32 v107, v107
M v[236:239], a[148:151], v[44:47], v[236:239]
v_cvt_pk_bf16_f32 v105, v106, v107
s_waitcnt lgkmcnt(4)
M v[240:243], a[156:159], v[32:35], v[240:243]
v_exp_f32 v120, v120
M v[240:243], a[160:163], v[64:67], v[240:243]
M v[244:247], a[160:163], v[68:71], v[244:247]
v_exp_f32 v121, v121
M v[244:247], a[156:159], v[36:39], v[244:247]
v_cvt_pk_bf16_f32 v106, v120, v121
M v[248:251], a[156:159], v[40:43], v[248:251]
v_exp_f32 v122, v122
M v[248:251], a[160:163], v[72:75], v[248:251]
s_waitcnt vmcnt(16) lgkmcnt(0)
s_barrier
ds_read_b128 a[116:119], v3 offset:0
ds_read_b128 a[120:123], v3 offset:1024
ds_read_b128 a[124:127], v3 offset:2048
ds_read_b128 a[128:131], v3 offset:3072
M v[252:255], a[160:163], v[76:79], v[252:255]
v_exp_f32 v123, v123
M v[252:255], a[156:159], v[44:47], v[252:255]
v_cvt_pk_bf16_f32 v107, v122, v123
M a[64:67], a[164:167], v[32:35], a[64:67]
v_exp_f32 v108, v108
M a[64:67], a[168:171], v[64:67], a[64:67]
ds_read_b128 a[132:135], v3 offset:4096
ds_read_b128 a[136:139], v3 offset:5120
M a[68:71], a[168:171], v[68:71], a[68:71]
v_exp_f32 v109, v109
M a[68:71], a[164:167], v[36:39], a[68:71]
v_cvt_pk_bf16_f32 v108, v108, v109
M a[72:75], a[164:167], v[40:43], a[72:75]
v_exp_f32 v110, v110
M a[72:75], a[168:171], v[72:75], a[72:75]
M a[76:79], a[168:171], v[76:79], a[76:79]
v_exp_f32 v111, v111
M a[76:79], a[164:167], v[44:47], a[76:79]
v_cvt_pk_bf16_f32 v109, v110, v111
M a[80:83], a[172:175], v[32:35], a[80:83]
v_exp_f32 v124, v124
M a[80:83], a[176:179], v[64:67], a[80:83]
ds_read_b128 a[140:143], v3 offset:6144
ds_read_b128 a[144:147], v3 offset:7168
M a[84:87], a[176:179], v[68:71], a[84:87]
v_exp_f32 v125, v125
M a[84:87], a[172:175], v[36:39], a[84:87]
v_cvt_pk_bf16_f32 v110, v124, v125
M a[88:91], a[172:175], v[40:43], a[88:91]
v_exp_f32 v126, v126
M a[88:91], a[176:179], v[72:75], a[88:91]
M a[92:95], a[176:179], v[76:79], a[92:95]
v_exp_f32 v127, v127
M a[92:95], a[172:175], v[44:47], a[92:95]
v_cvt_pk_bf16_f32 v111, v126, v127
s_waitcnt lgkmcnt(4)
s_add_u32 m0, s29, 32768
M v[32:35], a[116:119], a[0:3], 0
v_exp_f32 v128, v128
M v[32:35], a[120:123], a[4:7], v[32:35]
ds_read_b128 a[148:151], v3 offset:8192
ds_read_b128 a[152:155], v3 offset:9216
M v[32:35], a[124:127], a[8:11], v[32:35]
v_exp_f32 v129, v129
M v[32:35], a[128:131], a[12:15], v[32:35]
buffer_load_dwordx4 v1, s[12:15], s26 offen offset:0 sc1 lds
s_add_u32 s32, s26, 4096
M v[36:39], a[128:131], a[28:31], 0
v_exp_f32 v130, v130
M v[36:39], a[124:127], a[24:27], v[36:39]
v_cvt_pk_bf16_f32 v128, v128, v129
M v[36:39], a[120:123], a[20:23], v[36:39]
v_exp_f32 v131, v131
M v[36:39], a[116:119], a[16:19], v[36:39]
buffer_load_dwordx4 v1, s[12:15], s26 offen offset:1024 sc1 lds
M v[40:43], a[116:119], a[32:35], 0
v_exp_f32 v144, v144
M v[40:43], a[120:123], a[36:39], v[40:43]
ds_read_b128 a[156:159], v3 offset:10240
ds_read_b128 a[160:163], v3 offset:11264
M v[40:43], a[124:127], a[40:43], v[40:43]
v_exp_f32 v145, v145
M v[40:43], a[128:131], a[44:47], v[40:43]
buffer_load_dwordx4 v1, s[12:15], s26 offen offset:2048 sc1 lds
M v[44:47], a[128:131], a[60:63], 0
v_exp_f32 v146, v146
M v[44:47], a[124:127], a[56:59], v[44:47]
v_cvt_pk_bf16_f32 v129, v130, v131
v_cvt_pk_bf16_f32 v130, v144, v145
M v[44:47], a[120:123], a[52:55], v[44:47]
v_exp_f32 v147, v147
M v[44:47], a[116:119], a[48:51], v[44:47]
buffer_load_dwordx4 v1, s[12:15], s26 offen offset:3072 sc1 lds
s_add_u32 m0, s29, 36864
s_waitcnt lgkmcnt(4)
M v[48:51], a[132:135], a[0:3], 0
v_exp_f32 v132, v132
M v[48:51], a[136:139], a[4:7], v[48:51]
ds_read_b128 a[164:167], v3 offset:12288
ds_read_b128 a[168:171], v3 offset:13312
M v[48:51], a[140:143], a[8:11], v[48:51]
v_exp_f32 v133, v133
M v[48:51], a[144:147], a[12:15], v[48:51]
buffer_load_dwordx4 v1, s[12:15], s32 offen offset:0 sc1 lds
M v[52:55], a[144:147], a[28:31], 0
v_exp_f32 v134, v134
M v[52:55], a[140:143], a[24:27], v[52:55]
v_cvt_pk_bf16_f32 v131, v146, v147
v_cvt_pk_bf16_f32 v132, v132, v133
M v[52:55], a[136:139], a[20:23], v[52:55]
v_exp_f32 v135, v135
M v[52:55], a[132:135], a[16:19], v[52:55]
buffer_load_dwordx4 v1, s[12:15], s32 offen offset:1024 sc1 lds
M v[56:59], a[132:135], a[32:35], 0
v_exp_f32 v148, v148
M v[56:59], a[136:139], a[36:39], v[56:59]
ds_read_b128 a[172:175], v3 offset:14336
ds_read_b128 a[176:179], v3 offset:15360
M v[56:59], a[140:143], a[40:43], v[56:59]
v_exp_f32 v149, v149
M v[56:59], a[144:147], a[44:47], v[56:59]
buffer_load_dwordx4 v1, s[12:15], s32 offen offset:2048 sc1 lds
M v[60:63], a[144:147], a[60:63], 0
v_exp_f32 v150, v150
M v[60:63], a[140:143], a[56:59], v[60:63]
v_cvt_pk_bf16_f32 v133, v134, v135
v_cvt_pk_bf16_f32 v134, v148, v149
M v[60:63], a[136:139], a[52:55], v[60:63]
v_exp_f32 v151, v151
M v[60:63], a[132:135], a[48:51], v[60:63]
buffer_load_dwordx4 v1, s[12:15], s32 offen offset:3072 sc1 lds
s_waitcnt lgkmcnt(4)
M v[64:67], a[148:151], a[0:3], 0
v_exp_f32 v136, v136
M v[64:67], a[152:155], a[4:7], v[64:67]
s_add_u32 s26, s26, 32768
s_cmp_eq_u32 s26, s62
s_cselect_b32 s26, s63, s26
s_cselect_b32 s62, -1, s62
M v[64:67], a[156:159], a[8:11], v[64:67]
v_exp_f32 v137, v137
M v[64:67], a[160:163], a[12:15], v[64:67]
v_cvt_pk_bf16_f32 v135, v150, v151
v_cvt_pk_bf16_f32 v136, v136, v137
M v[68:71], a[160:163], a[28:31], 0
v_exp_f32 v138, v138
M v[68:71], a[156:159], a[24:27], v[68:71]
M v[68:71], a[152:155], a[20:23], v[68:71]
v_exp_f32 v139, v139
M v[68:71], a[148:151], a[16:19], v[68:71]
v_cvt_pk_bf16_f32 v137, v138, v139
M v[72:75], a[148:151], a[32:35], 0
v_exp_f32 v152, v152
M v[72:75], a[152:155], a[36:39], v[72:75]
M v[72:75], a[156:159], a[40:43], v[72:75]
v_exp_f32 v153, v153
M v[72:75], a[160:163], a[44:47], v[72:75]
v_cvt_pk_bf16_f32 v138, v152, v153
M v[76:79], a[160:163], a[60:63], 0
v_exp_f32 v154, v154
M v[76:79], a[156:159], a[56:59], v[76:79]
s_waitcnt vmcnt(16) lgkmcnt(0)
s_barrier
ds_read_b128 a[116:119], v3 offset:32768
ds_read_b128 a[120:123], v3 offset:40960
ds_read_b128 a[124:127], v3 offset:33792
ds_read_b128 a[128:131], v3 offset:41984
M v[76:79], a[152:155], a[52:55], v[76:79]
v_exp_f32 v155, v155
M v[76:79], a[148:151], a[48:51], v[76:79]
v_cvt_pk_bf16_f32 v139, v154, v155
M v[80:83], a[164:167], a[0:3], 0
v_exp_f32 v140, v140
M v[80:83], a[168:171], a[4:7], v[80:83]
ds_read_b128 a[132:135], v3 offset:34816
ds_read_b128 a[136:139], v3 offset:43008
M v[80:83], a[172:175], a[8:11], v[80:83]
v_exp_f32 v141, v141
M v[80:83], a[176:179], a[12:15], v[80:83]
v_cvt_pk_bf16_f32 v140, v140, v141
M v[84:87], a[176:179], a[28:31], 0
v_exp_f32 v142, v142
M v[84:87], a[172:175], a[24:27], v[84:87]
M v[84:87], a[168:171], a[20:23], v[84:87]
v_exp_f32 v143, v143
M v[84:87], a[164:167], a[16:19], v[84:87]
v_cvt_pk_bf16_f32 v141, v142, v143
M v[88:91], a[164:167], a[32:35], 0
v_exp_f32 v156, v156
M v[88:91], a[168:171], a[36:39], v[88:91]
ds_read_b128 a[140:143], v3 offset:35840
ds_read_b128 a[144:147], v3 offset:44032
M v[88:91], a[172:175], a[40:43], v[88:91]
v_exp_f32 v157, v157
M v[88:91], a[176:179], a[44:47], v[88:91]
v_cvt_pk_bf16_f32 v142, v156, v157
M v[92:95], a[176:179], a[60:63], 0
v_exp_f32 v158, v158
M v[92:95], a[172:175], a[56:59], v[92:95]
M v[92:95], a[168:171], a[52:55], v[92:95]
v_exp_f32 v159, v159
M v[92:95], a[164:167], a[48:51], v[92:95]
v_cvt_pk_bf16_f32 v143, v158, v159
s_waitcnt lgkmcnt(6)
s_add_u32 m0, s29, 65536
M v[160:163], a[116:119], v[96:99], v[160:163]
v_exp_f32 v32, v32
M v[160:163], a[120:123], v[128:131], v[160:163]
ds_read_b128 a[148:151], v3 offset:36864
ds_read_b128 a[152:155], v3 offset:45056
M v[164:167], a[120:123], v[132:135], v[164:167]
v_exp_f32 v33, v33
M v[164:167], a[116:119], v[100:103], v[164:167]
buffer_load_dwordx4 v1, s[12:15], s25 offen offset:0 sc1 lds
s_add_u32 s32, s25, 4096
M v[168:171], a[116:119], v[104:107], v[168:171]
v_exp_f32 v34, v34
M v[168:171], a[120:123], v[136:139], v[168:171]
v_cvt_pk_bf16_f32 v32, v32, v33
M v[172:175], a[120:123], v[140:143], v[172:175]
v_exp_f32 v35, v35
M v[172:175], a[116:119], v[108:111], v[172:175]
buffer_load_dwordx4 v1, s[12:15], s25 offen offset:1024 sc1 lds
s_waitcnt lgkmcnt(6)
M a[96:99], a[112:115], v[96:99], a[96:99]
M a[96:99], a[112:115], v[128:131], a[96:99]
M v[176:179], a[124:127], v[96:99], v[176:179]
v_exp_f32 v48, v48
M v[176:179], a[128:131], v[128:131], v[176:179]
ds_read_b128 a[156:159], v3 offset:37888
ds_read_b128 a[160:163], v3 offset:46080
M v[180:183], a[128:131], v[132:135], v[180:183]
v_exp_f32 v49, v49
M v[180:183], a[124:127], v[100:103], v[180:183]
buffer_load_dwordx4 v1, s[12:15], s25 offen offset:2048 sc1 lds
M v[184:187], a[124:127], v[104:107], v[184:187]
v_exp_f32 v50, v50
M v[184:187], a[128:131], v[136:139], v[184:187]
v_cvt_pk_bf16_f32 v33, v34, v35
v_cvt_pk_bf16_f32 v34, v48, v49
M v[188:191], a[128:131], v[140:143], v[188:191]
v_exp_f32 v51, v51
M v[188:191], a[124:127], v[108:111], v[188:191]
buffer_load_dwordx4 v1, s[12:15], s25 offen offset:3072 sc1 lds
s_add_u32 m0, s29, 69632
s_waitcnt lgkmcnt(6)
M a[100:103], a[112:115], v[100:103], a[100:103]
M a[100:103], a[112:115], v[132:135], a[100:103]
M v[192:195], a[132:135], v[96:99], v[192:195]
v_exp_f32 v36, v36
M v[192:195], a[136:139], v[128:131], v[192:195]
ds_read_b128 a[164:167], v3 offset:38912
ds_read_b128 a[168:171], v3 offset:47104
M v[196:199], a[136:139], v[132:135], v[196:199]
v_exp_f32 v37, v37
M v[196:199], a[132:135], v[100:103], v[196:199]
buffer_load_dwordx4 v1, s[12:15], s32 offen offset:0 sc1 lds
M v[200:203], a[132:135], v[104:107], v[200:203]
v_exp_f32 v38, v38
M v[200:203], a[136:139], v[136:139], v[200:203]
v_cvt_pk_bf16_f32 v35, v50, v51
v_cvt_pk_bf16_f32 v36, v36, v37
M v[204:207], a[136:139], v[140:143], v[204:207]
v_exp_f32 v39, v39
M v[204:207], a[132:135], v[108:111], v[204:207]
buffer_load_dwordx4 v1, s[12:15], s32 offen offset:1024 sc1 lds
s_waitcnt lgkmcnt(6)
M a[104:107], a[112:115], v[104:107], a[104:107]
M a[104:107], a[112:115], v[136:139], a[104:107]
M v[208:211], a[140:143], v[96:99], v[208:211]
v_exp_f32 v52, v52
M v[208:211], a[144:147], v[128:131], v[208:211]
ds_read_b128 a[172:175], v3 offset:39936
ds_read_b128 a[176:179], v3 offset:48128
M v[212:215], a[144:147], v[132:135], v[212:215]
v_exp_f32 v53, v53
M v[212:215], a[140:143], v[100:103], v[212:215]
buffer_load_dwordx4 v1, s[12:15], s32 offen offset:2048 sc1 lds
M v[216:219], a[140:143], v[104:107], v[216:219]
v_exp_f32 v54, v54
M v[216:219], a[144:147], v[136:139], v[216:219]
v_cvt_pk_bf16_f32 v37, v38, v39
v_cvt_pk_bf16_f32 v38, v52, v53
M v[220:223], a[144:147], v[140:143], v[220:223]
v_exp_f32 v55, v55
M v[220:223], a[140:143], v[108:111], v[220:223]
buffer_load_dwordx4 v1, s[12:15], s32 offen offset:3072 sc1 lds
s_waitcnt lgkmcnt(6)
M a[108:111], a[112:115], v[108:111], a[108:111]
M a[108:111], a[112:115], v[140:143], a[108:111]
M v[224:227], a[148:151], v[96:99], v[224:227]
v_exp_f32 v40, v40
M v[224:227], a[152:155], v[128:131], v[224:227]
s_add_u32 s25, s25, 32768
s_cmp_eq_u32 s25, s27
s_cselect_b32 s25, s28, s25
s_cselect_b32 s27, -1, s27
M v[228:231], a[152:155], v[132:135], v[228:231]
v_exp_f32 v41, v41
M v[228:231], a[148:151], v[100:103], v[228:231]
v_cvt_pk_bf16_f32 v39, v54, v55
v_cvt_pk_bf16_f32 v40, v40, v41
M v[232:235], a[148:151], v[104:107], v[232:235]
v_exp_f32 v42, v42
M v[232:235], a[152:155], v[136:139], v[232:235]
M v[236:239], a[152:155], v[140:143], v[236:239]
v_exp_f32 v43, v43
M v[236:239], a[148:151], v[108:111], v[236:239]
v_cvt_pk_bf16_f32 v41, v42, v43
s_waitcnt lgkmcnt(4)
M v[240:243], a[156:159], v[96:99], v[240:243]
v_exp_f32 v56, v56
M v[240:243], a[160:163], v[128:131], v[240:243]
M v[244:247], a[160:163], v[132:135], v[244:247]
v_exp_f32 v57, v57
M v[244:247], a[156:159], v[100:103], v[244:247]
v_cvt_pk_bf16_f32 v42, v56, v57
M v[248:251], a[156:159], v[104:107], v[248:251]
v_exp_f32 v58, v58
M v[248:251], a[160:163], v[136:139], v[248:251]
s_waitcnt vmcnt(16) lgkmcnt(0)
s_barrier
ds_read_b128 a[116:119], v2 offset:0
ds_read_b128 a[120:123], v2 offset:1024
ds_read_b128 a[124:127], v2 offset:2048
ds_read_b128 a[128:131], v2 offset:3072
M v[252:255], a[160:163], v[140:143], v[252:255]
v_exp_f32 v59, v59
M v[252:255], a[156:159], v[108:111], v[252:255]
v_cvt_pk_bf16_f32 v43, v58, v59
M a[64:67], a[164:167], v[96:99], a[64:67]
v_exp_f32 v44, v44
M a[64:67], a[168:171], v[128:131], a[64:67]
ds_read_b128 a[132:135], v2 offset:4096
ds_read_b128 a[136:139], v2 offset:5120
M a[68:71], a[168:171], v[132:135], a[68:71]
v_exp_f32 v45, v45
M a[68:71], a[164:167], v[100:103], a[68:71]
v_cvt_pk_bf16_f32 v44, v44, v45
M a[72:75], a[164:167], v[104:107], a[72:75]
v_exp_f32 v46, v46
M a[72:75], a[168:171], v[136:139], a[72:75]
M a[76:79], a[168:171], v[140:143], a[76:79]
v_exp_f32 v47, v47
M a[76:79], a[164:167], v[108:111], a[76:79]
v_cvt_pk_bf16_f32 v45, v46, v47
M a[80:83], a[172:175], v[96:99], a[80:83]
v_exp_f32 v60, v60
M a[80:83], a[176:179], v[128:131], a[80:83]
ds_read_b128 a[140:143], v2 offset:6144
ds_read_b128 a[144:147], v2 offset:7168
M a[84:87], a[176:179], v[132:135], a[84:87]
v_exp_f32 v61, v61
M a[84:87], a[172:175], v[100:103], a[84:87]
v_cvt_pk_bf16_f32 v46, v60, v61
M a[88:91], a[172:175], v[104:107], a[88:91]
v_exp_f32 v62, v62
M a[88:91], a[176:179], v[136:139], a[88:91]
M a[92:95], a[176:179], v[140:143], a[92:95]
v_exp_f32 v63, v63
M a[92:95], a[172:175], v[108:111], a[92:95]
v_cvt_pk_bf16_f32 v47, v62, v63
s_sub_u32 s30, s30, 1
s_cmp_lg_u32 s30, 0
s_cbranch_scc1 Lk2_l3
s_lshl_b32 s33, s23, 6
s_add_i32 s33, s33, 0
s_cmp_gt_i32 s33, 0
s_cselect_b32 s34, 0, 0xf149f2ca
s_cmp_lt_i32 s33, 0
s_cselect_b32 s33, 0xf149f2ca, 0
v_mov_b32 v20, s34
v_mov_b32 v21, s34
v_mov_b32 v22, s34
v_mov_b32 v23, s34
v_mov_b32 v28, s33
v_mov_b32 v29, s33
v_mov_b32 v30, s33
v_mov_b32 v31, s33
v_med3_f32 v24, v16, v20, v28
v_med3_f32 v25, v17, v20, v28
v_med3_f32 v26, v18, v20, v28
v_med3_f32 v27, v19, v20, v28
s_waitcnt lgkmcnt(4)
s_add_u32 m0, s29, 98304
M v[96:99], a[116:119], a[0:3], v[24:27]
v_exp_f32 v64, v64
M v[96:99], a[120:123], a[4:7], v[96:99]
ds_read_b128 a[148:151], v2 offset:8192
ds_read_b128 a[152:155], v2 offset:9216
M v[96:99], a[124:127], a[8:11], v[96:99]
v_exp_f32 v65, v65
M v[96:99], a[128:131], a[12:15], v[96:99]
buffer_load_dwordx4 v1, s[12:15], s26 offen offset:0 sc1 lds
s_add_u32 s32, s26, 4096
M v[100:103], a[128:131], a[28:31], v[28:31]
v_exp_f32 v66, v66
M v[100:103], a[124:127], a[24:27], v[100:103]
v_cvt_pk_bf16_f32 v64, v64, v65
M v[100:103], a[120:123], a[20:23], v[100:103]
v_exp_f32 v67, v67
M v[100:103], a[116:119], a[16:19], v[100:103]
buffer_load_dwordx4 v1, s[12:15], s26 offen offset:1024 sc1 lds
M v[104:107], a[116:119], a[32:35], v[28:31]
v_exp_f32 v80, v80
M v[104:107], a[120:123], a[36:39], v[104:107]
ds_read_b128 a[156:159], v2 offset:10240
ds_read_b128 a[160:163], v2 offset:11264
M v[104:107], a[124:127], a[40:43], v[104:107]
v_exp_f32 v81, v81
M v[104:107], a[128:131], a[44:47], v[104:107]
buffer_load_dwordx4 v1, s[12:15], s26 offen offset:2048 sc1 lds
M v[108:111], a[128:131], a[60:63], v[28:31]
v_exp_f32 v82, v82
M v[108:111], a[124:127], a[56:59], v[108:111]
v_cvt_pk_bf16_f32 v65, v66, v67
v_cvt_pk_bf16_f32 v66, v80, v81
M v[108:111], a[120:123], a[52:55], v[108:111]
v_exp_f32 v83, v83
M v[108:111], a[116:119], a[48:51], v[108:111]
buffer_load_dwordx4 v1, s[12:15], s26 offen offset:3072 sc1 lds
s_add_u32 m0, s29, 102400
s_waitcnt lgkmcnt(4)
M v[112:115], a[132:135], a[0:3], v[20:23]
v_exp_f32 v68, v68
M v[112:115], a[136:139], a[4:7], v[112:115]
ds_read_b128 a[164:167], v2 offset:12288
ds_read_b128 a[168:171], v2 offset:13312
M v[112:115], a[140:143], a[8:11], v[112:115]
v_exp_f32 v69, v69
M v[112:115], a[144:147], a[12:15], v[112:115]
buffer_load_dwordx4 v1, s[12:15], s32 offen offset:0 sc1 lds
M v[116:119], a[144:147], a[28:31], v[24:27]
v_exp_f32 v70, v70
M v[116:119], a[140:143], a[24:27], v[116:119]
v_cvt_pk_bf16_f32 v67, v82, v83
v_cvt_pk_bf16_f32 v68, v68, v69
M v[116:119], a[136:139], a[20:23], v[116:119]
v_exp_f32 v71, v71
M v[116:119], a[132:135], a[16:19], v[116:119]
buffer_load_dwordx4 v1, s[12:15], s32 offen offset:1024 sc1 lds
M v[120:123], a[132:135], a[32:35], v[28:31]
v_exp_f32 v84, v84
M v[120:123], a[136:139], a[36:39], v[120:123]
ds_read_b128 a[172:175], v2 offset:14336
ds_read_b128 a[176:179], v2 offset:15360
M v[120:123], a[140:143], a[40:43], v[120:123]
v_exp_f32 v85, v85
M v[120:123], a[144:147], a[44:47], v[120:123]
buffer_load_dwordx4 v1, s[12:15], s32 offen offset:2048 sc1 lds
M v[124:127], a[144:147], a[60:63], v[28:31]
v_exp_f32 v86, v86
M v[124:127], a[140:143], a[56:59], v[124:127]
v_cvt_pk_bf16_f32 v69, v70, v71
v_cvt_pk_bf16_f32 v70, v84, v85
M v[124:127], a[136:139], a[52:55], v[124:127]
v_exp_f32 v87, v87
M v[124:127], a[132:135], a[48:51], v[124:127]
buffer_load_dwordx4 v1, s[12:15], s32 offen offset:3072 sc1 lds
s_waitcnt lgkmcnt(4)
M v[128:131], a[148:151], a[0:3], v[20:23]
v_exp_f32 v72, v72
M v[128:131], a[152:155], a[4:7], v[128:131]
s_add_u32 s26, s26, 32768
s_cmp_eq_u32 s26, s62
s_cselect_b32 s26, s63, s26
s_cselect_b32 s62, -1, s62
M v[128:131], a[156:159], a[8:11], v[128:131]
v_exp_f32 v73, v73
M v[128:131], a[160:163], a[12:15], v[128:131]
v_cvt_pk_bf16_f32 v71, v86, v87
v_cvt_pk_bf16_f32 v72, v72, v73
M v[132:135], a[160:163], a[28:31], v[20:23]
v_exp_f32 v74, v74
M v[132:135], a[156:159], a[24:27], v[132:135]
M v[132:135], a[152:155], a[20:23], v[132:135]
v_exp_f32 v75, v75
M v[132:135], a[148:151], a[16:19], v[132:135]
v_cvt_pk_bf16_f32 v73, v74, v75
M v[136:139], a[148:151], a[32:35], v[24:27]
v_exp_f32 v88, v88
M v[136:139], a[152:155], a[36:39], v[136:139]
M v[136:139], a[156:159], a[40:43], v[136:139]
v_exp_f32 v89, v89
M v[136:139], a[160:163], a[44:47], v[136:139]
v_cvt_pk_bf16_f32 v74, v88, v89
M v[140:143], a[160:163], a[60:63], v[28:31]
v_exp_f32 v90, v90
M v[140:143], a[156:159], a[56:59], v[140:143]
s_waitcnt vmcnt(16) lgkmcnt(0)
s_barrier
ds_read_b128 a[116:119], v2 offset:32768
ds_read_b128 a[120:123], v2 offset:40960
ds_read_b128 a[124:127], v2 offset:33792
ds_read_b128 a[128:131], v2 offset:41984
M v[140:143], a[152:155], a[52:55], v[140:143]
v_exp_f32 v91, v91
M v[140:143], a[148:151], a[48:51], v[140:143]
v_cvt_pk_bf16_f32 v75, v90, v91
M v[144:147], a[164:167], a[0:3], v[20:23]
v_exp_f32 v76, v76
M v[144:147], a[168:171], a[4:7], v[144:147]
ds_read_b128 a[132:135], v2 offset:34816
ds_read_b128 a[136:139], v2 offset:43008
M v[144:147], a[172:175], a[8:11], v[144:147]
v_exp_f32 v77, v77
M v[144:147], a[176:179], a[12:15], v[144:147]
v_cvt_pk_bf16_f32 v76, v76, v77
M v[148:151], a[176:179], a[28:31], v[20:23]
v_exp_f32 v78, v78
M v[148:151], a[172:175], a[24:27], v[148:151]
M v[148:151], a[168:171], a[20:23], v[148:151]
v_exp_f32 v79, v79
M v[148:151], a[164:167], a[16:19], v[148:151]
v_cvt_pk_bf16_f32 v77, v78, v79
M v[152:155], a[164:167], a[32:35], v[20:23]
v_exp_f32 v92, v92
M v[152:155], a[168:171], a[36:39], v[152:155]
ds_read_b128 a[140:143], v2 offset:35840
ds_read_b128 a[144:147], v2 offset:44032
M v[152:155], a[172:175], a[40:43], v[152:155]
v_exp_f32 v93, v93
M v[152:155], a[176:179], a[44:47], v[152:155]
v_cvt_pk_bf16_f32 v78, v92, v93
M v[156:159], a[176:179], a[60:63], v[24:27]
v_exp_f32 v94, v94
M v[156:159], a[172:175], a[56:59], v[156:159]
M v[156:159], a[168:171], a[52:55], v[156:159]
v_exp_f32 v95, v95
M v[156:159], a[164:167], a[48:51], v[156:159]
v_cvt_pk_bf16_f32 v79, v94, v95
s_waitcnt lgkmcnt(6)
s_add_u32 m0, s29, 0
M v[160:163], a[116:119], v[32:35], v[160:163]
v_exp_f32 v96, v96
M v[160:163], a[120:123], v[64:67], v[160:163]
ds_read_b128 a[148:151], v2 offset:36864
ds_read_b128 a[152:155], v2 offset:45056
M v[164:167], a[120:123], v[68:71], v[164:167]
v_exp_f32 v97, v97
M v[164:167], a[116:119], v[36:39], v[164:167]
buffer_load_dwordx4 v1, s[12:15], s25 offen offset:0 sc1 lds
s_add_u32 s32, s25, 4096
M v[168:171], a[116:119], v[40:43], v[168:171]
v_exp_f32 v98, v98
M v[168:171], a[120:123], v[72:75], v[168:171]
v_cvt_pk_bf16_f32 v96, v96, v97
M v[172:175], a[120:123], v[76:79], v[172:175]
v_exp_f32 v99, v99
M v[172:175], a[116:119], v[44:47], v[172:175]
buffer_load_dwordx4 v1, s[12:15], s25 offen offset:1024 sc1 lds
s_waitcnt lgkmcnt(6)
M a[96:99], a[112:115], v[32:35], a[96:99]
M a[96:99], a[112:115], v[64:67], a[96:99]
M v[176:179], a[124:127], v[32:35], v[176:179]
v_exp_f32 v112, v112
M v[176:179], a[128:131], v[64:67], v[176:179]
ds_read_b128 a[156:159], v2 offset:37888
ds_read_b128 a[160:163], v2 offset:46080
M v[180:183], a[128:131], v[68:71], v[180:183]
v_exp_f32 v113, v113
M v[180:183], a[124:127], v[36:39], v[180:183]
buffer_load_dwordx4 v1, s[12:15], s25 offen offset:2048 sc1 lds
M v[184:187], a[124:127], v[40:43], v[184:187]
v_exp_f32 v114, v114
M v[184:187], a[128:131], v[72:75], v[184:187]
v_cvt_pk_bf16_f32 v97, v98, v99
v_cvt_pk_bf16_f32 v98, v112, v113
M v[188:191], a[128:131], v[76:79], v[188:191]
v_exp_f32 v115, v115
M v[188:191], a[124:127], v[44:47], v[188:191]
buffer_load_dwordx4 v1, s[12:15], s25 offen offset:3072 sc1 lds
s_add_u32 m0, s29, 4096
s_waitcnt lgkmcnt(6)
M a[100:103], a[112:115], v[36:39], a[100:103]
M a[100:103], a[112:115], v[68:71], a[100:103]
M v[192:195], a[132:135], v[32:35], v[192:195]
v_exp_f32 v100, v100
M v[192:195], a[136:139], v[64:67], v[192:195]
ds_read_b128 a[164:167], v2 offset:38912
ds_read_b128 a[168:171], v2 offset:47104
M v[196:199], a[136:139], v[68:71], v[196:199]
v_exp_f32 v101, v101
M v[196:199], a[132:135], v[36:39], v[196:199]
buffer_load_dwordx4 v1, s[12:15], s32 offen offset:0 sc1 lds
M v[200:203], a[132:135], v[40:43], v[200:203]
v_exp_f32 v102, v102
M v[200:203], a[136:139], v[72:75], v[200:203]
v_cvt_pk_bf16_f32 v99, v114, v115
v_cvt_pk_bf16_f32 v100, v100, v101
M v[204:207], a[136:139], v[76:79], v[204:207]
v_exp_f32 v103, v103
M v[204:207], a[132:135], v[44:47], v[204:207]
buffer_load_dwordx4 v1, s[12:15], s32 offen offset:1024 sc1 lds
s_waitcnt lgkmcnt(6)
M a[104:107], a[112:115], v[40:43], a[104:107]
M a[104:107], a[112:115], v[72:75], a[104:107]
M v[208:211], a[140:143], v[32:35], v[208:211]
v_exp_f32 v116, v116
M v[208:211], a[144:147], v[64:67], v[208:211]
ds_read_b128 a[172:175], v2 offset:39936
ds_read_b128 a[176:179], v2 offset:48128
M v[212:215], a[144:147], v[68:71], v[212:215]
v_exp_f32 v117, v117
M v[212:215], a[140:143], v[36:39], v[212:215]
buffer_load_dwordx4 v1, s[12:15], s32 offen offset:2048 sc1 lds
M v[216:219], a[140:143], v[40:43], v[216:219]
v_exp_f32 v118, v118
M v[216:219], a[144:147], v[72:75], v[216:219]
v_cvt_pk_bf16_f32 v101, v102, v103
v_cvt_pk_bf16_f32 v102, v116, v117
M v[220:223], a[144:147], v[76:79], v[220:223]
v_exp_f32 v119, v119
M v[220:223], a[140:143], v[44:47], v[220:223]
buffer_load_dwordx4 v1, s[12:15], s32 offen offset:3072 sc1 lds
s_waitcnt lgkmcnt(6)
M a[108:111], a[112:115], v[44:47], a[108:111]
M a[108:111], a[112:115], v[76:79], a[108:111]
M v[224:227], a[148:151], v[32:35], v[224:227]
v_exp_f32 v104, v104
M v[224:227], a[152:155], v[64:67], v[224:227]
s_add_u32 s25, s25, 32768
s_cmp_eq_u32 s25, s27
s_cselect_b32 s25, s28, s25
s_cselect_b32 s27, -1, s27
M v[228:231], a[152:155], v[68:71], v[228:231]
v_exp_f32 v105, v105
M v[228:231], a[148:151], v[36:39], v[228:231]
v_cvt_pk_bf16_f32 v103, v118, v119
v_cvt_pk_bf16_f32 v104, v104, v105
M v[232:235], a[148:151], v[40:43], v[232:235]
v_exp_f32 v106, v106
M v[232:235], a[152:155], v[72:75], v[232:235]
M v[236:239], a[152:155], v[76:79], v[236:239]
v_exp_f32 v107, v107
M v[236:239], a[148:151], v[44:47], v[236:239]
v_cvt_pk_bf16_f32 v105, v106, v107
s_waitcnt lgkmcnt(4)
M v[240:243], a[156:159], v[32:35], v[240:243]
v_exp_f32 v120, v120
M v[240:243], a[160:163], v[64:67], v[240:243]
M v[244:247], a[160:163], v[68:71], v[244:247]
v_exp_f32 v121, v121
M v[244:247], a[156:159], v[36:39], v[244:247]
v_cvt_pk_bf16_f32 v106, v120, v121
M v[248:251], a[156:159], v[40:43], v[248:251]
v_exp_f32 v122, v122
M v[248:251], a[160:163], v[72:75], v[248:251]
s_waitcnt vmcnt(16) lgkmcnt(0)
s_barrier
ds_read_b128 a[116:119], v3 offset:0
ds_read_b128 a[120:123], v3 offset:1024
ds_read_b128 a[124:127], v3 offset:2048
ds_read_b128 a[128:131], v3 offset:3072
M v[252:255], a[160:163], v[76:79], v[252:255]
v_exp_f32 v123, v123
M v[252:255], a[156:159], v[44:47], v[252:255]
v_cvt_pk_bf16_f32 v107, v122, v123
M a[64:67], a[164:167], v[32:35], a[64:67]
v_exp_f32 v108, v108
M a[64:67], a[168:171], v[64:67], a[64:67]
ds_read_b128 a[132:135], v3 offset:4096
ds_read_b128 a[136:139], v3 offset:5120
M a[68:71], a[168:171], v[68:71], a[68:71]
v_exp_f32 v109, v109
M a[68:71], a[164:167], v[36:39], a[68:71]
v_cvt_pk_bf16_f32 v108, v108, v109
M a[72:75], a[164:167], v[40:43], a[72:75]
v_exp_f32 v110, v110
M a[72:75], a[168:171], v[72:75], a[72:75]
M a[76:79], a[168:171], v[76:79], a[76:79]
v_exp_f32 v111, v111
M a[76:79], a[164:167], v[44:47], a[76:79]
v_cvt_pk_bf16_f32 v109, v110, v111
M a[80:83], a[172:175], v[32:35], a[80:83]
v_exp_f32 v124, v124
M a[80:83], a[176:179], v[64:67], a[80:83]
ds_read_b128 a[140:143], v3 offset:6144
ds_read_b128 a[144:147], v3 offset:7168
M a[84:87], a[176:179], v[68:71], a[84:87]
v_exp_f32 v125, v125
M a[84:87], a[172:175], v[36:39], a[84:87]
v_cvt_pk_bf16_f32 v110, v124, v125
M a[88:91], a[172:175], v[40:43], a[88:91]
v_exp_f32 v126, v126
M a[88:91], a[176:179], v[72:75], a[88:91]
M a[92:95], a[176:179], v[76:79], a[92:95]
v_exp_f32 v127, v127
M a[92:95], a[172:175], v[44:47], a[92:95]
v_cvt_pk_bf16_f32 v111, v126, v127
s_lshl_b32 s33, s23, 6
s_add_i32 s33, s33, -64
s_cmp_gt_i32 s33, 0
s_cselect_b32 s34, 0, 0xf149f2ca
s_cmp_lt_i32 s33, 0
s_cselect_b32 s33, 0xf149f2ca, 0
v_mov_b32 v20, s34
v_mov_b32 v21, s34
v_mov_b32 v22, s34
v_mov_b32 v23, s34
v_mov_b32 v28, s33
v_mov_b32 v29, s33
v_mov_b32 v30, s33
v_mov_b32 v31, s33
v_med3_f32 v24, v16, v20, v28
v_med3_f32 v25, v17, v20, v28
v_med3_f32 v26, v18, v20, v28
v_med3_f32 v27, v19, v20, v28
s_waitcnt lgkmcnt(4)
s_add_u32 m0, s29, 32768
M v[32:35], a[116:119], a[0:3], v[24:27]
v_exp_f32 v128, v128
M v[32:35], a[120:123], a[4:7], v[32:35]
ds_read_b128 a[148:151], v3 offset:8192
ds_read_b128 a[152:155], v3 offset:9216
M v[32:35], a[124:127], a[8:11], v[32:35]
v_exp_f32 v129, v129
M v[32:35], a[128:131], a[12:15], v[32:35]
buffer_load_dwordx4 v1, s[12:15], s26 offen offset:0 sc1 lds
s_add_u32 s32, s26, 4096
M v[36:39], a[128:131], a[28:31], v[28:31]
v_exp_f32 v130, v130
M v[36:39], a[124:127], a[24:27], v[36:39]
v_cvt_pk_bf16_f32 v128, v128, v129
M v[36:39], a[120:123], a[20:23], v[36:39]
v_exp_f32 v131, v131
M v[36:39], a[116:119], a[16:19], v[36:39]
buffer_load_dwordx4 v1, s[12:15], s26 offen offset:1024 sc1 lds
M v[40:43], a[116:119], a[32:35], v[28:31]
v_exp_f32 v144, v144
M v[40:43], a[120:123], a[36:39], v[40:43]
ds_read_b128 a[156:159], v3 offset:10240
ds_read_b128 a[160:163], v3 offset:11264
M v[40:43], a[124:127], a[40:43], v[40:43]
v_exp_f32 v145, v145
M v[40:43], a[128:131], a[44:47], v[40:43]
buffer_load_dwordx4 v1, s[12:15], s26 offen offset:2048 sc1 lds
M v[44:47], a[128:131], a[60:63], v[28:31]
v_exp_f32 v146, v146
M v[44:47], a[124:127], a[56:59], v[44:47]
v_cvt_pk_bf16_f32 v129, v130, v131
v_cvt_pk_bf16_f32 v130, v144, v145
M v[44:47], a[120:123], a[52:55], v[44:47]
v_exp_f32 v147, v147
M v[44:47], a[116:119], a[48:51], v[44:47]
buffer_load_dwordx4 v1, s[12:15], s26 offen offset:3072 sc1 lds
s_add_u32 m0, s29, 36864
s_waitcnt lgkmcnt(4)
M v[48:51], a[132:135], a[0:3], v[20:23]
v_exp_f32 v132, v132
M v[48:51], a[136:139], a[4:7], v[48:51]
ds_read_b128 a[164:167], v3 offset:12288
ds_read_b128 a[168:171], v3 offset:13312
M v[48:51], a[140:143], a[8:11], v[48:51]
v_exp_f32 v133, v133
M v[48:51], a[144:147], a[12:15], v[48:51]
buffer_load_dwordx4 v1, s[12:15], s32 offen offset:0 sc1 lds
M v[52:55], a[144:147], a[28:31], v[24:27]
v_exp_f32 v134, v134
M v[52:55], a[140:143], a[24:27], v[52:55]
v_cvt_pk_bf16_f32 v131, v146, v147
v_cvt_pk_bf16_f32 v132, v132, v133
M v[52:55], a[136:139], a[20:23], v[52:55]
v_exp_f32 v135, v135
M v[52:55], a[132:135], a[16:19], v[52:55]
buffer_load_dwordx4 v1, s[12:15], s32 offen offset:1024 sc1 lds
M v[56:59], a[132:135], a[32:35], v[28:31]
v_exp_f32 v148, v148
M v[56:59], a[136:139], a[36:39], v[56:59]
ds_read_b128 a[172:175], v3 offset:14336
ds_read_b128 a[176:179], v3 offset:15360
M v[56:59], a[140:143], a[40:43], v[56:59]
v_exp_f32 v149, v149
M v[56:59], a[144:147], a[44:47], v[56:59]
buffer_load_dwordx4 v1, s[12:15], s32 offen offset:2048 sc1 lds
M v[60:63], a[144:147], a[60:63], v[28:31]
v_exp_f32 v150, v150
M v[60:63], a[140:143], a[56:59], v[60:63]
v_cvt_pk_bf16_f32 v133, v134, v135
v_cvt_pk_bf16_f32 v134, v148, v149
M v[60:63], a[136:139], a[52:55], v[60:63]
v_exp_f32 v151, v151
M v[60:63], a[132:135], a[48:51], v[60:63]
buffer_load_dwordx4 v1, s[12:15], s32 offen offset:3072 sc1 lds
s_waitcnt lgkmcnt(4)
M v[64:67], a[148:151], a[0:3], v[20:23]
v_exp_f32 v136, v136
M v[64:67], a[152:155], a[4:7], v[64:67]
s_add_u32 s26, s26, 32768
s_cmp_eq_u32 s26, s62
s_cselect_b32 s26, s63, s26
s_cselect_b32 s62, -1, s62
M v[64:67], a[156:159], a[8:11], v[64:67]
v_exp_f32 v137, v137
M v[64:67], a[160:163], a[12:15], v[64:67]
v_cvt_pk_bf16_f32 v135, v150, v151
v_cvt_pk_bf16_f32 v136, v136, v137
M v[68:71], a[160:163], a[28:31], v[20:23]
v_exp_f32 v138, v138
M v[68:71], a[156:159], a[24:27], v[68:71]
M v[68:71], a[152:155], a[20:23], v[68:71]
v_exp_f32 v139, v139
M v[68:71], a[148:151], a[16:19], v[68:71]
v_cvt_pk_bf16_f32 v137, v138, v139
M v[72:75], a[148:151], a[32:35], v[24:27]
v_exp_f32 v152, v152
M v[72:75], a[152:155], a[36:39], v[72:75]
M v[72:75], a[156:159], a[40:43], v[72:75]
v_exp_f32 v153, v153
M v[72:75], a[160:163], a[44:47], v[72:75]
v_cvt_pk_bf16_f32 v138, v152, v153
M v[76:79], a[160:163], a[60:63], v[28:31]
v_exp_f32 v154, v154
M v[76:79], a[156:159], a[56:59], v[76:79]
s_waitcnt vmcnt(16) lgkmcnt(0)
s_barrier
ds_read_b128 a[116:119], v3 offset:32768
ds_read_b128 a[120:123], v3 offset:40960
ds_read_b128 a[124:127], v3 offset:33792
ds_read_b128 a[128:131], v3 offset:41984
M v[76:79], a[152:155], a[52:55], v[76:79]
v_exp_f32 v155, v155
M v[76:79], a[148:151], a[48:51], v[76:79]
v_cvt_pk_bf16_f32 v139, v154, v155
M v[80:83], a[164:167], a[0:3], v[20:23]
v_exp_f32 v140, v140
M v[80:83], a[168:171], a[4:7], v[80:83]
ds_read_b128 a[132:135], v3 offset:34816
ds_read_b128 a[136:139], v3 offset:43008
M v[80:83], a[172:175], a[8:11], v[80:83]
v_exp_f32 v141, v141
M v[80:83], a[176:179], a[12:15], v[80:83]
v_cvt_pk_bf16_f32 v140, v140, v141
M v[84:87], a[176:179], a[28:31], v[20:23]
v_exp_f32 v142, v142
M v[84:87], a[172:175], a[24:27], v[84:87]
M v[84:87], a[168:171], a[20:23], v[84:87]
v_exp_f32 v143, v143
M v[84:87], a[164:167], a[16:19], v[84:87]
v_cvt_pk_bf16_f32 v141, v142, v143
M v[88:91], a[164:167], a[32:35], v[20:23]
v_exp_f32 v156, v156
M v[88:91], a[168:171], a[36:39], v[88:91]
ds_read_b128 a[140:143], v3 offset:35840
ds_read_b128 a[144:147], v3 offset:44032
M v[88:91], a[172:175], a[40:43], v[88:91]
v_exp_f32 v157, v157
M v[88:91], a[176:179], a[44:47], v[88:91]
v_cvt_pk_bf16_f32 v142, v156, v157
M v[92:95], a[176:179], a[60:63], v[24:27]
v_exp_f32 v158, v158
M v[92:95], a[172:175], a[56:59], v[92:95]
M v[92:95], a[168:171], a[52:55], v[92:95]
v_exp_f32 v159, v159
M v[92:95], a[164:167], a[48:51], v[92:95]
v_cvt_pk_bf16_f32 v143, v158, v159
s_waitcnt lgkmcnt(6)
s_add_u32 m0, s29, 65536
M v[160:163], a[116:119], v[96:99], v[160:163]
v_exp_f32 v32, v32
M v[160:163], a[120:123], v[128:131], v[160:163]
ds_read_b128 a[148:151], v3 offset:36864
ds_read_b128 a[152:155], v3 offset:45056
M v[164:167], a[120:123], v[132:135], v[164:167]
v_exp_f32 v33, v33
M v[164:167], a[116:119], v[100:103], v[164:167]
buffer_load_dwordx4 v1, s[12:15], s25 offen offset:0 sc1 lds
s_add_u32 s32, s25, 4096
M v[168:171], a[116:119], v[104:107], v[168:171]
v_exp_f32 v34, v34
M v[168:171], a[120:123], v[136:139], v[168:171]
v_cvt_pk_bf16_f32 v32, v32, v33
M v[172:175], a[120:123], v[140:143], v[172:175]
v_exp_f32 v35, v35
M v[172:175], a[116:119], v[108:111], v[172:175]
buffer_load_dwordx4 v1, s[12:15], s25 offen offset:1024 sc1 lds
s_waitcnt lgkmcnt(6)
M a[96:99], a[112:115], v[96:99], a[96:99]
M a[96:99], a[112:115], v[128:131], a[96:99]
M v[176:179], a[124:127], v[96:99], v[176:179]
v_exp_f32 v48, v48
M v[176:179], a[128:131], v[128:131], v[176:179]
ds_read_b128 a[156:159], v3 offset:37888
ds_read_b128 a[160:163], v3 offset:46080
M v[180:183], a[128:131], v[132:135], v[180:183]
v_exp_f32 v49, v49
M v[180:183], a[124:127], v[100:103], v[180:183]
buffer_load_dwordx4 v1, s[12:15], s25 offen offset:2048 sc1 lds
M v[184:187], a[124:127], v[104:107], v[184:187]
v_exp_f32 v50, v50
M v[184:187], a[128:131], v[136:139], v[184:187]
v_cvt_pk_bf16_f32 v33, v34, v35
v_cvt_pk_bf16_f32 v34, v48, v49
M v[188:191], a[128:131], v[140:143], v[188:191]
v_exp_f32 v51, v51
M v[188:191], a[124:127], v[108:111], v[188:191]
buffer_load_dwordx4 v1, s[12:15], s25 offen offset:3072 sc1 lds
s_add_u32 m0, s29, 69632
s_waitcnt lgkmcnt(6)
M a[100:103], a[112:115], v[100:103], a[100:103]
M a[100:103], a[112:115], v[132:135], a[100:103]
M v[192:195], a[132:135], v[96:99], v[192:195]
v_exp_f32 v36, v36
M v[192:195], a[136:139], v[128:131], v[192:195]
ds_read_b128 a[164:167], v3 offset:38912
ds_read_b128 a[168:171], v3 offset:47104
M v[196:199], a[136:139], v[132:135], v[196:199]
v_exp_f32 v37, v37
M v[196:199], a[132:135], v[100:103], v[196:199]
buffer_load_dwordx4 v1, s[12:15], s32 offen offset:0 sc1 lds
M v[200:203], a[132:135], v[104:107], v[200:203]
v_exp_f32 v38, v38
M v[200:203], a[136:139], v[136:139], v[200:203]
v_cvt_pk_bf16_f32 v35, v50, v51
v_cvt_pk_bf16_f32 v36, v36, v37
M v[204:207], a[136:139], v[140:143], v[204:207]
v_exp_f32 v39, v39
M v[204:207], a[132:135], v[108:111], v[204:207]
buffer_load_dwordx4 v1, s[12:15], s32 offen offset:1024 sc1 lds
s_waitcnt lgkmcnt(6)
M a[104:107], a[112:115], v[104:107], a[104:107]
M a[104:107], a[112:115], v[136:139], a[104:107]
M v[208:211], a[140:143], v[96:99], v[208:211]
v_exp_f32 v52, v52
M v[208:211], a[144:147], v[128:131], v[208:211]
ds_read_b128 a[172:175], v3 offset:39936
ds_read_b128 a[176:179], v3 offset:48128
M v[212:215], a[144:147], v[132:135], v[212:215]
v_exp_f32 v53, v53
M v[212:215], a[140:143], v[100:103], v[212:215]
buffer_load_dwordx4 v1, s[12:15], s32 offen offset:2048 sc1 lds
M v[216:219], a[140:143], v[104:107], v[216:219]
v_exp_f32 v54, v54
M v[216:219], a[144:147], v[136:139], v[216:219]
v_cvt_pk_bf16_f32 v37, v38, v39
v_cvt_pk_bf16_f32 v38, v52, v53
M v[220:223], a[144:147], v[140:143], v[220:223]
v_exp_f32 v55, v55
M v[220:223], a[140:143], v[108:111], v[220:223]
buffer_load_dwordx4 v1, s[12:15], s32 offen offset:3072 sc1 lds
s_waitcnt lgkmcnt(6)
M a[108:111], a[112:115], v[108:111], a[108:111]
M a[108:111], a[112:115], v[140:143], a[108:111]
M v[224:227], a[148:151], v[96:99], v[224:227]
v_exp_f32 v40, v40
M v[224:227], a[152:155], v[128:131], v[224:227]
s_add_u32 s25, s25, 32768
s_cmp_eq_u32 s25, s27
s_cselect_b32 s25, s28, s25
s_cselect_b32 s27, -1, s27
M v[228:231], a[152:155], v[132:135], v[228:231]
v_exp_f32 v41, v41
M v[228:231], a[148:151], v[100:103], v[228:231]
v_cvt_pk_bf16_f32 v39, v54, v55
v_cvt_pk_bf16_f32 v40, v40, v41
M v[232:235], a[148:151], v[104:107], v[232:235]
v_exp_f32 v42, v42
M v[232:235], a[152:155], v[136:139], v[232:235]
M v[236:239], a[152:155], v[140:143], v[236:239]
v_exp_f32 v43, v43
M v[236:239], a[148:151], v[108:111], v[236:239]
v_cvt_pk_bf16_f32 v41, v42, v43
s_waitcnt lgkmcnt(4)
M v[240:243], a[156:159], v[96:99], v[240:243]
v_exp_f32 v56, v56
M v[240:243], a[160:163], v[128:131], v[240:243]
M v[244:247], a[160:163], v[132:135], v[244:247]
v_exp_f32 v57, v57
M v[244:247], a[156:159], v[100:103], v[244:247]
v_cvt_pk_bf16_f32 v42, v56, v57
M v[248:251], a[156:159], v[104:107], v[248:251]
v_exp_f32 v58, v58
M v[248:251], a[160:163], v[136:139], v[248:251]
s_waitcnt vmcnt(16) lgkmcnt(0)
s_barrier
ds_read_b128 a[116:119], v2 offset:0
ds_read_b128 a[120:123], v2 offset:1024
ds_read_b128 a[124:127], v2 offset:2048
ds_read_b128 a[128:131], v2 offset:3072
M v[252:255], a[160:163], v[140:143], v[252:255]
v_exp_f32 v59, v59
M v[252:255], a[156:159], v[108:111], v[252:255]
v_cvt_pk_bf16_f32 v43, v58, v59
M a[64:67], a[164:167], v[96:99], a[64:67]
v_exp_f32 v44, v44
M a[64:67], a[168:171], v[128:131], a[64:67]
ds_read_b128 a[132:135], v2 offset:4096
ds_read_b128 a[136:139], v2 offset:5120
M a[68:71], a[168:171], v[132:135], a[68:71]
v_exp_f32 v45, v45
M a[68:71], a[164:167], v[100:103], a[68:71]
v_cvt_pk_bf16_f32 v44, v44, v45
M a[72:75], a[164:167], v[104:107], a[72:75]
v_exp_f32 v46, v46
M a[72:75], a[168:171], v[136:139], a[72:75]
M a[76:79], a[168:171], v[140:143], a[76:79]
v_exp_f32 v47, v47
M a[76:79], a[164:167], v[108:111], a[76:79]
v_cvt_pk_bf16_f32 v45, v46, v47
M a[80:83], a[172:175], v[96:99], a[80:83]
v_exp_f32 v60, v60
M a[80:83], a[176:179], v[128:131], a[80:83]
ds_read_b128 a[140:143], v2 offset:6144
ds_read_b128 a[144:147], v2 offset:7168
M a[84:87], a[176:179], v[132:135], a[84:87]
v_exp_f32 v61, v61
M a[84:87], a[172:175], v[100:103], a[84:87]
v_cvt_pk_bf16_f32 v46, v60, v61
M a[88:91], a[172:175], v[104:107], a[88:91]
v_exp_f32 v62, v62
M a[88:91], a[176:179], v[136:139], a[88:91]
M a[92:95], a[176:179], v[140:143], a[92:95]
v_exp_f32 v63, v63
M a[92:95], a[172:175], v[108:111], a[92:95]
v_cvt_pk_bf16_f32 v47, v62, v63
s_waitcnt lgkmcnt(0)
Lk2_fin:
s_waitcnt vmcnt(8)
s_barrier
s_and_b32 s3, s2, 3
s_lshl_b32 s3, s3, 2
s_bfe_u32 s27, s2, 0x20003
s_add_u32 s27, s3, s27
s_lshl_b32 s43, s27, 8
s_add_u32 s43, s43, 8400896
v_lshlrev_b32 v15, 2, v0
buffer_load_dword v7, v15, s[52:55], s43 offen sc1
s_lshl_b32 s33, s2, 2
s_add_u32 s33, s33, s22
s_lshl_b32 s34, s33, 11
s_lshl_b32 s33, s33, 13
v_lshlrev_b32 v8, 3, v1
v_lshlrev_b32 v9, 1, v1
buffer_load_dword v5, v8, s[44:47], s33 offen
buffer_load_dword v6, v9, s[48:51], s34 offen
ds_read_b128 a[116:119], v2 offset:32768
ds_read_b128 a[120:123], v2 offset:40960
ds_read_b128 a[124:127], v2 offset:33792
ds_read_b128 a[128:131], v2 offset:41984
ds_read_b128 a[132:135], v2 offset:34816
ds_read_b128 a[136:139], v2 offset:43008
ds_read_b128 a[140:143], v2 offset:35840
ds_read_b128 a[144:147], v2 offset:44032
v_exp_f32 v64, v64
v_exp_f32 v65, v65
v_exp_f32 v66, v66
v_exp_f32 v67, v67
v_exp_f32 v80, v80
v_exp_f32 v81, v81
v_exp_f32 v82, v82
v_exp_f32 v83, v83
v_cvt_pk_bf16_f32 v64, v64, v65
v_cvt_pk_bf16_f32 v65, v66, v67
v_exp_f32 v68, v68
v_exp_f32 v69, v69
v_exp_f32 v70, v70
v_exp_f32 v71, v71
v_cvt_pk_bf16_f32 v66, v80, v81
v_cvt_pk_bf16_f32 v67, v82, v83
v_exp_f32 v84, v84
v_exp_f32 v85, v85
v_exp_f32 v86, v86
v_exp_f32 v87, v87
v_cvt_pk_bf16_f32 v68, v68, v69
v_cvt_pk_bf16_f32 v69, v70, v71
v_exp_f32 v72, v72
v_exp_f32 v73, v73
v_exp_f32 v74, v74
v_exp_f32 v75, v75
v_cvt_pk_bf16_f32 v70, v84, v85
v_cvt_pk_bf16_f32 v71, v86, v87
v_exp_f32 v88, v88
v_exp_f32 v89, v89
v_exp_f32 v90, v90
v_exp_f32 v91, v91
v_cvt_pk_bf16_f32 v72, v72, v73
v_cvt_pk_bf16_f32 v73, v74, v75
v_exp_f32 v76, v76
v_exp_f32 v77, v77
v_exp_f32 v78, v78
v_exp_f32 v79, v79
v_cvt_pk_bf16_f32 v74, v88, v89
v_cvt_pk_bf16_f32 v75, v90, v91
v_exp_f32 v92, v92
v_exp_f32 v93, v93
v_exp_f32 v94, v94
v_exp_f32 v95, v95
v_cvt_pk_bf16_f32 v76, v76, v77
v_cvt_pk_bf16_f32 v77, v78, v79
v_cvt_pk_bf16_f32 v78, v92, v93
v_cvt_pk_bf16_f32 v79, v94, v95
s_waitcnt lgkmcnt(6)
M v[160:163], a[116:119], v[32:35], v[160:163]
M v[160:163], a[120:123], v[64:67], v[160:163]
ds_read_b128 a[148:151], v2 offset:36864
ds_read_b128 a[152:155], v2 offset:45056
s_mov_b32 s61, 0
M v[164:167], a[120:123], v[68:71], v[164:167]
M v[164:167], a[116:119], v[36:39], v[164:167]
s_bfe_u32 s3, s2, 0x10002
M v[168:171], a[116:119], v[40:43], v[168:171]
M v[168:171], a[120:123], v[72:75], v[168:171]
s_lshl_b32 s3, s3, 3
M v[172:175], a[120:123], v[76:79], v[172:175]
M v[172:175], a[116:119], v[44:47], v[172:175]
s_waitcnt lgkmcnt(6)
s_lshr_b32 s28, s2, 5
M a[96:99], a[112:115], v[32:35], a[96:99]
M a[96:99], a[112:115], v[64:67], a[96:99]
M v[176:179], a[124:127], v[32:35], v[176:179]
M v[176:179], a[128:131], v[64:67], v[176:179]
ds_read_b128 a[156:159], v2 offset:37888
ds_read_b128 a[160:163], v2 offset:46080
s_add_u32 s28, s3, s28
M v[180:183], a[128:131], v[68:71], v[180:183]
s_lshl_b32 s25, s27, 18
M v[180:183], a[124:127], v[36:39], v[180:183]
M v[184:187], a[124:127], v[40:43], v[184:187]
s_lshl_b32 s3, s101, 12
M v[184:187], a[128:131], v[72:75], v[184:187]
M v[188:191], a[128:131], v[76:79], v[188:191]
s_add_u32 s25, s25, s3
M v[188:191], a[124:127], v[44:47], v[188:191]
s_waitcnt lgkmcnt(6)
M a[100:103], a[112:115], v[36:39], a[100:103]
M a[100:103], a[112:115], v[68:71], a[100:103]
M v[192:195], a[132:135], v[32:35], v[192:195]
s_lshl_b32 s26, s28, 7
M v[192:195], a[136:139], v[64:67], v[192:195]
ds_read_b128 a[164:167], v2 offset:38912
ds_read_b128 a[168:171], v2 offset:47104
M v[196:199], a[136:139], v[68:71], v[196:199]
s_lshl_b32 s42, s101, 11
M v[196:199], a[132:135], v[36:39], v[196:199]
M v[200:203], a[132:135], v[40:43], v[200:203]
s_add_u32 s44, s4, 83886080
s_addc_u32 s45, s5, 0
M v[200:203], a[136:139], v[72:75], v[200:203]
s_mov_b32 s46, 4194304
M v[204:207], a[136:139], v[76:79], v[204:207]
M v[204:207], a[132:135], v[44:47], v[204:207]
s_waitcnt lgkmcnt(6)
s_mov_b32 s47, 0x00020000
M a[104:107], a[112:115], v[40:43], a[104:107]
M a[104:107], a[112:115], v[72:75], a[104:107]
M v[208:211], a[140:143], v[32:35], v[208:211]
M v[208:211], a[144:147], v[64:67], v[208:211]
ds_read_b128 a[172:175], v2 offset:39936
ds_read_b128 a[176:179], v2 offset:48128
s_mov_b32 s50, 2097152
M v[212:215], a[144:147], v[68:71], v[212:215]
M v[212:215], a[140:143], v[36:39], v[212:215]
s_mov_b32 s51, 0x00020000
M v[216:219], a[140:143], v[40:43], v[216:219]
M v[216:219], a[144:147], v[72:75], v[216:219]
s_lshl_b32 s3, s101, 4
M v[220:223], a[144:147], v[76:79], v[220:223]
M v[220:223], a[140:143], v[44:47], v[220:223]
s_waitcnt lgkmcnt(6)
v_lshrrev_b32 v96, 3, v0
M a[108:111], a[112:115], v[44:47], a[108:111]
M a[108:111], a[112:115], v[76:79], a[108:111]
M v[224:227], a[148:151], v[32:35], v[224:227]
v_and_b32 v97, 6, v96
M v[224:227], a[152:155], v[64:67], v[224:227]
M v[228:231], a[152:155], v[68:71], v[228:231]
v_and_b32 v98, 7, v0
M v[228:231], a[148:151], v[36:39], v[228:231]
M v[232:235], a[148:151], v[40:43], v[232:235]
v_xor_b32 v97, v97, v98
M v[232:235], a[152:155], v[72:75], v[232:235]
M v[236:239], a[152:155], v[76:79], v[236:239]
v_add_u32 v96, s3, v96
M v[236:239], a[148:151], v[44:47], v[236:239]
s_waitcnt lgkmcnt(4)
M v[240:243], a[156:159], v[32:35], v[240:243]
v_lshlrev_b32 v96, 11, v96
M v[240:243], a[160:163], v[64:67], v[240:243]
M v[244:247], a[160:163], v[68:71], v[244:247]
v_lshl_add_u32 v99, v97, 4, v96
M v[244:247], a[156:159], v[36:39], v[244:247]
v_add_u32 v100, 15360, v99
M v[248:251], a[156:159], v[40:43], v[248:251]
M v[248:251], a[160:163], v[72:75], v[248:251]
s_waitcnt vmcnt(2) lgkmcnt(0)
s_barrier
v_cmp_ne_u32 vcc, 1, v7
s_nop 0
s_cbranch_vccnz Lk3_spinb0
Lk3_gotb0:
M v[252:255], a[160:163], v[76:79], v[252:255]
s_add_u32 m0, s42, 65536
s_nop 0
buffer_load_dwordx4 v99, s[48:51], s26 offen offset:0 lds
buffer_load_dwordx4 v100, s[48:51], s26 offen offset:1024 lds
M v[252:255], a[156:159], v[44:47], v[252:255]
buffer_load_dwordx4 a[192:195], v1, s[44:47], s25 offen offset:0 sc1
buffer_load_dwordx4 a[196:199], v1, s[44:47], s25 offen offset:1024 sc1
M a[64:67], a[164:167], v[32:35], a[64:67]
buffer_load_dwordx4 a[200:203], v1, s[44:47], s25 offen offset:2048 sc1
buffer_load_dwordx4 a[204:207], v1, s[44:47], s25 offen offset:3072 sc1
M a[64:67], a[168:171], v[64:67], a[64:67]
s_add_u32 s25, s25, 16384
s_add_u32 s26, s26, 131072
s_add_u32 m0, s42, 81920
s_nop 0
buffer_load_dwordx4 v99, s[48:51], s26 offen offset:0 lds
M a[68:71], a[168:171], v[68:71], a[68:71]
buffer_load_dwordx4 v100, s[48:51], s26 offen offset:1024 lds
buffer_load_dwordx4 a[208:211], v1, s[44:47], s25 offen offset:0 sc1
M a[68:71], a[164:167], v[36:39], a[68:71]
buffer_load_dwordx4 a[212:215], v1, s[44:47], s25 offen offset:1024 sc1
buffer_load_dwordx4 a[216:219], v1, s[44:47], s25 offen offset:2048 sc1
M a[72:75], a[164:167], v[40:43], a[72:75]
buffer_load_dwordx4 a[220:223], v1, s[44:47], s25 offen offset:3072 sc1
s_add_u32 s25, s25, 16384
s_add_u32 s26, s26, 131072
M a[72:75], a[168:171], v[72:75], a[72:75]
s_add_u32 m0, s42, 98304
s_nop 0
buffer_load_dwordx4 v99, s[48:51], s26 offen offset:0 lds
buffer_load_dwordx4 v100, s[48:51], s26 offen offset:1024 lds
M a[76:79], a[168:171], v[76:79], a[76:79]
buffer_load_dwordx4 a[224:227], v1, s[44:47], s25 offen offset:0 sc1
M a[76:79], a[164:167], v[44:47], a[76:79]
buffer_load_dwordx4 a[228:231], v1, s[44:47], s25 offen offset:1024 sc1
buffer_load_dwordx4 a[232:235], v1, s[44:47], s25 offen offset:2048 sc1
M a[80:83], a[172:175], v[32:35], a[80:83]
buffer_load_dwordx4 a[236:239], v1, s[44:47], s25 offen offset:3072 sc1
s_add_u32 s25, s25, 16384
s_add_u32 s26, s26, 131072
M a[80:83], a[176:179], v[64:67], a[80:83]
s_add_u32 m0, s42, 114688
s_nop 0
buffer_load_dwordx4 v99, s[48:51], s26 offen offset:0 lds
buffer_load_dwordx4 v100, s[48:51], s26 offen offset:1024 lds
M a[84:87], a[176:179], v[68:71], a[84:87]
buffer_load_dwordx4 a[240:243], v1, s[44:47], s25 offen offset:0 sc1
buffer_load_dwordx4 a[244:247], v1, s[44:47], s25 offen offset:1024 sc1
M a[84:87], a[172:175], v[36:39], a[84:87]
buffer_load_dwordx4 a[248:251], v1, s[44:47], s25 offen offset:2048 sc1
buffer_load_dwordx4 a[252:255], v1, s[44:47], s25 offen offset:3072 sc1
M a[88:91], a[172:175], v[40:43], a[88:91]
s_add_u32 s25, s25, 16384
s_add_u32 s26, s26, 131072
s_add_u32 m0, s42, 0
s_nop 0
buffer_load_dwordx4 v99, s[48:51], s26 offen offset:0 lds
M a[88:91], a[176:179], v[72:75], a[88:91]
buffer_load_dwordx4 v100, s[48:51], s26 offen offset:1024 lds
buffer_load_dwordx4 a[128:131], v1, s[44:47], s25 offen offset:0 sc1
M a[92:95], a[176:179], v[76:79], a[92:95]
buffer_load_dwordx4 a[132:135], v1, s[44:47], s25 offen offset:1024 sc1
buffer_load_dwordx4 a[136:139], v1, s[44:47], s25 offen offset:2048 sc1
M a[92:95], a[172:175], v[44:47], a[92:95]
buffer_load_dwordx4 a[140:143], v1, s[44:47], s25 offen offset:3072 sc1
s_add_u32 s25, s25, 16384
s_add_u32 s26, s26, 131072
Lk2_merge:
s_lshl_b32 s33, s23, 14
s_add_u32 s34, s33, 131072
s_add_u32 s33, s33, 32768
s_cmp_eq_u32 s24, 0
s_cselect_b32 s35, s34, s33
s_cselect_b32 s36, s33, s34
v_add_u32 v2, s35, v1
v_add_u32 v3, s36, v1
s_lshl_b32 s33, s22, 10
s_add_u32 s33, s33, 28672
s_xor_b32 s34, s33, 2048
v_add_u32 v14, s33, v1
v_add_u32 v15, s34, v1
v_accvgpr_read_b32 v20, a96
v_accvgpr_read_b32 v21, a100
v_accvgpr_read_b32 v22, a104
v_accvgpr_read_b32 v23, a108
ds_write_b128 v14, v[20:23]
s_cmp_eq_u32 s24, 1
s_waitcnt lgkmcnt(0)
s_cbranch_scc1 Lk2_mg1
ds_write_b128 v2, v[224:227] offset:0
ds_write_b128 v2, v[228:231] offset:1024
ds_write_b128 v2, v[232:235] offset:2048
ds_write_b128 v2, v[236:239] offset:3072
ds_write_b128 v2, v[240:243] offset:4096
ds_write_b128 v2, v[244:247] offset:5120
ds_write_b128 v2, v[248:251] offset:6144
ds_write_b128 v2, v[252:255] offset:7168
ds_write_b128 v2, a[64:67] offset:8192
ds_write_b128 v2, a[68:71] offset:9216
ds_write_b128 v2, a[72:75] offset:10240
ds_write_b128 v2, a[76:79] offset:11264
ds_write_b128 v2, a[80:83] offset:12288
ds_write_b128 v2, a[84:87] offset:13312
ds_write_b128 v2, a[88:91] offset:14336
ds_write_b128 v2, a[92:95] offset:15360
s_waitcnt lgkmcnt(0)
s_barrier
ds_read_b128 v[28:31], v15
ds_read_b128 v[32:35], v3 offset:0
ds_read_b128 v[36:39], v3 offset:1024
ds_read_b128 v[40:43], v3 offset:2048
ds_read_b128 v[44:47], v3 offset:3072
ds_read_b128 v[48:51], v3 offset:4096
ds_read_b128 v[52:55], v3 offset:5120
ds_read_b128 v[56:59], v3 offset:6144
ds_read_b128 v[60:63], v3 offset:7168
ds_read_b128 v[64:67], v3 offset:8192
ds_read_b128 v[68:71], v3 offset:9216
ds_read_b128 v[72:75], v3 offset:10240
ds_read_b128 v[76:79], v3 offset:11264
ds_read_b128 v[80:83], v3 offset:12288
ds_read_b128 v[84:87], v3 offset:13312
ds_read_b128 v[88:91], v3 offset:14336
ds_read_b128 v[92:95], v3 offset:15360
s_waitcnt lgkmcnt(15)
v_add_f32 v20, v20, v28
v_add_f32 v21, v21, v29
v_add_f32 v22, v22, v30
v_add_f32 v23, v23, v31
s_sub_u32 s35, 15, s21
v_rcp_f32 v8, v20
v_rcp_f32 v9, v21
v_rcp_f32 v10, v22
v_rcp_f32 v11, v23
v_subrev_u32 v20, 0x21800000, v20
v_subrev_u32 v21, 0x21800000, v21
v_subrev_u32 v22, 0x21800000, v22
v_subrev_u32 v23, 0x21800000, v23
v_max_u32 v12, v20, v21
v_max3_u32 v12, v12, v22, v23
s_mov_b32 s64, 0x207
v_pk_add_f32 v[160:161], v[160:161], v[32:33]
v_pk_add_f32 v[162:163], v[162:163], v[34:35]
s_waitcnt lgkmcnt(11)
v_pk_add_f32 v[176:177], v[176:177], v[48:49]
v_pk_add_f32 v[178:179], v[178:179], v[50:51]
v_pk_mul_f32 v[160:161], v[160:161], v[8:9] op_sel:[0,0] op_sel_hi:[1,0]
v_pk_mul_f32 v[162:163], v[162:163], v[8:9] op_sel:[0,0] op_sel_hi:[1,0]
v_pk_mul_f32 v[176:177], v[176:177], v[8:9] op_sel:[0,0] op_sel_hi:[1,0]
v_pk_mul_f32 v[178:179], v[178:179], v[8:9] op_sel:[0,0] op_sel_hi:[1,0]
v_cvt_pk_bf16_f32 v160, v160, v161
v_cvt_pk_bf16_f32 v161, v162, v163
v_cvt_pk_bf16_f32 v162, v176, v177
v_cvt_pk_bf16_f32 v163, v178, v179
v_pk_add_f32 v[164:165], v[164:165], v[36:37]
v_pk_add_f32 v[166:167], v[166:167], v[38:39]
s_waitcnt lgkmcnt(10)
v_pk_add_f32 v[180:181], v[180:181], v[52:53]
v_pk_add_f32 v[182:183], v[182:183], v[54:55]
M v[24:27], a[112:115], v[160:163], 0
v_pk_mul_f32 v[164:165], v[164:165], v[8:9] op_sel:[0,1] op_sel_hi:[1,1]
v_pk_mul_f32 v[166:167], v[166:167], v[8:9] op_sel:[0,1] op_sel_hi:[1,1]
v_pk_mul_f32 v[180:181], v[180:181], v[8:9] op_sel:[0,1] op_sel_hi:[1,1]
v_pk_mul_f32 v[182:183], v[182:183], v[8:9] op_sel:[0,1] op_sel_hi:[1,1]
v_cvt_pk_bf16_f32 v164, v164, v165
v_cvt_pk_bf16_f32 v165, v166, v167
v_cvt_pk_bf16_f32 v166, v180, v181
v_cvt_pk_bf16_f32 v167, v182, v183
v_pk_add_f32 v[168:169], v[168:169], v[40:41]
v_pk_add_f32 v[170:171], v[170:171], v[42:43]
s_waitcnt lgkmcnt(9)
v_pk_add_f32 v[184:185], v[184:185], v[56:57]
v_pk_add_f32 v[186:187], v[186:187], v[58:59]
M v[24:27], a[112:115], v[164:167], v[24:27]
v_pk_mul_f32 v[168:169], v[168:169], v[10:11] op_sel:[0,0] op_sel_hi:[1,0]
v_pk_mul_f32 v[170:171], v[170:171], v[10:11] op_sel:[0,0] op_sel_hi:[1,0]
v_pk_mul_f32 v[184:185], v[184:185], v[10:11] op_sel:[0,0] op_sel_hi:[1,0]
v_pk_mul_f32 v[186:187], v[186:187], v[10:11] op_sel:[0,0] op_sel_hi:[1,0]
v_cvt_pk_bf16_f32 v168, v168, v169
v_cvt_pk_bf16_f32 v169, v170, v171
v_cvt_pk_bf16_f32 v170, v184, v185
v_cvt_pk_bf16_f32 v171, v186, v187
v_pk_add_f32 v[172:173], v[172:173], v[44:45]
v_pk_add_f32 v[174:175], v[174:175], v[46:47]
s_waitcnt lgkmcnt(8)
v_pk_add_f32 v[188:189], v[188:189], v[60:61]
v_pk_add_f32 v[190:191], v[190:191], v[62:63]
M v[24:27], a[112:115], v[168:171], v[24:27]
v_pk_mul_f32 v[172:173], v[172:173], v[10:11] op_sel:[0,1] op_sel_hi:[1,1]
v_pk_mul_f32 v[174:175], v[174:175], v[10:11] op_sel:[0,1] op_sel_hi:[1,1]
v_pk_mul_f32 v[188:189], v[188:189], v[10:11] op_sel:[0,1] op_sel_hi:[1,1]
v_pk_mul_f32 v[190:191], v[190:191], v[10:11] op_sel:[0,1] op_sel_hi:[1,1]
v_cvt_pk_bf16_f32 v172, v172, v173
v_cvt_pk_bf16_f32 v173, v174, v175
v_cvt_pk_bf16_f32 v174, v188, v189
v_cvt_pk_bf16_f32 v175, v190, v191
s_waitcnt lgkmcnt(7)
v_pk_add_f32 v[192:193], v[192:193], v[64:65]
v_pk_add_f32 v[194:195], v[194:195], v[66:67]
s_waitcnt lgkmcnt(3)
v_pk_add_f32 v[208:209], v[208:209], v[80:81]
v_pk_add_f32 v[210:211], v[210:211], v[82:83]
M v[24:27], a[112:115], v[172:175], v[24:27]
v_pk_mul_f32 v[192:193], v[192:193], v[8:9] op_sel:[0,0] op_sel_hi:[1,0]
v_pk_mul_f32 v[194:195], v[194:195], v[8:9] op_sel:[0,0] op_sel_hi:[1,0]
v_pk_mul_f32 v[208:209], v[208:209], v[8:9] op_sel:[0,0] op_sel_hi:[1,0]
v_pk_mul_f32 v[210:211], v[210:211], v[8:9] op_sel:[0,0] op_sel_hi:[1,0]
v_cvt_pk_bf16_f32 v192, v192, v193
v_cvt_pk_bf16_f32 v193, v194, v195
v_cvt_pk_bf16_f32 v194, v208, v209
v_cvt_pk_bf16_f32 v195, v210, v211
v_pk_add_f32 v[196:197], v[196:197], v[68:69]
v_pk_add_f32 v[198:199], v[198:199], v[70:71]
s_waitcnt lgkmcnt(2)
v_pk_add_f32 v[212:213], v[212:213], v[84:85]
v_pk_add_f32 v[214:215], v[214:215], v[86:87]
M v[24:27], a[112:115], v[192:195], v[24:27]
v_pk_mul_f32 v[196:197], v[196:197], v[8:9] op_sel:[0,1] op_sel_hi:[1,1]
v_pk_mul_f32 v[198:199], v[198:199], v[8:9] op_sel:[0,1] op_sel_hi:[1,1]
v_pk_mul_f32 v[212:213], v[212:213], v[8:9] op_sel:[0,1] op_sel_hi:[1,1]
v_pk_mul_f32 v[214:215], v[214:215], v[8:9] op_sel:[0,1] op_sel_hi:[1,1]
v_cvt_pk_bf16_f32 v196, v196, v197
v_cvt_pk_bf16_f32 v197, v198, v199
v_cvt_pk_bf16_f32 v198, v212, v213
v_cvt_pk_bf16_f32 v199, v214, v215
v_pk_add_f32 v[200:201], v[200:201], v[72:73]
v_pk_add_f32 v[202:203], v[202:203], v[74:75]
s_waitcnt lgkmcnt(1)
v_pk_add_f32 v[216:217], v[216:217], v[88:89]
v_pk_add_f32 v[218:219], v[218:219], v[90:91]
M v[24:27], a[112:115], v[196:199], v[24:27]
v_pk_mul_f32 v[200:201], v[200:201], v[10:11] op_sel:[0,0] op_sel_hi:[1,0]
v_pk_mul_f32 v[202:203], v[202:203], v[10:11] op_sel:[0,0] op_sel_hi:[1,0]
v_pk_mul_f32 v[216:217], v[216:217], v[10:11] op_sel:[0,0] op_sel_hi:[1,0]
v_pk_mul_f32 v[218:219], v[218:219], v[10:11] op_sel:[0,0] op_sel_hi:[1,0]
v_cvt_pk_bf16_f32 v200, v200, v201
v_cvt_pk_bf16_f32 v201, v202, v203
v_cvt_pk_bf16_f32 v202, v216, v217
v_cvt_pk_bf16_f32 v203, v218, v219
v_pk_add_f32 v[204:205], v[204:205], v[76:77]
v_pk_add_f32 v[206:207], v[206:207], v[78:79]
s_waitcnt lgkmcnt(0)
v_pk_add_f32 v[220:221], v[220:221], v[92:93]
v_pk_add_f32 v[222:223], v[222:223], v[94:95]
M v[24:27], a[112:115], v[200:203], v[24:27]
v_pk_mul_f32 v[204:205], v[204:205], v[10:11] op_sel:[0,1] op_sel_hi:[1,1]
v_pk_mul_f32 v[206:207], v[206:207], v[10:11] op_sel:[0,1] op_sel_hi:[1,1]
v_pk_mul_f32 v[220:221], v[220:221], v[10:11] op_sel:[0,1] op_sel_hi:[1,1]
v_pk_mul_f32 v[222:223], v[222:223], v[10:11] op_sel:[0,1] op_sel_hi:[1,1]
v_cvt_pk_bf16_f32 v204, v204, v205
v_cvt_pk_bf16_f32 v205, v206, v207
v_cvt_pk_bf16_f32 v206, v220, v221
v_cvt_pk_bf16_f32 v207, v222, v223
s_nop 1
M v[24:27], a[112:115], v[204:207], v[24:27]
v_cmp_lt_u32 vcc, 0x3c000000, v12
s_nop 6
v_cmp_class_f32 s[40:41], v24, s64
s_nop 0
s_or_b64 vcc, vcc, s[40:41]
s_cbranch_vccnz Lbad_4
s_lshl_b32 s33, s35, 20
s_lshl_b32 s34, s20, 15
s_add_u32 s33, s33, s34
s_lshl_b32 s34, s23, 13
s_add_u32 s36, s33, s34
s_add_u32 s37, s36, 4096
s_add_u32 s38, s36, 16384
s_add_u32 s39, s36, 20480
buffer_store_dwordx4 v[160:163], v1, s[16:19], s36 offen offset:0 sc1
buffer_store_dwordx4 v[164:167], v1, s[16:19], s36 offen offset:2048 sc1
buffer_store_dwordx4 v[168:171], v1, s[16:19], s37 offen offset:0 sc1
buffer_store_dwordx4 v[172:175], v1, s[16:19], s37 offen offset:2048 sc1
buffer_store_dwordx4 v[192:195], v1, s[16:19], s36 offen offset:1024 sc1
buffer_store_dwordx4 v[196:199], v1, s[16:19], s36 offen offset:3072 sc1
buffer_store_dwordx4 v[200:203], v1, s[16:19], s37 offen offset:1024 sc1
buffer_store_dwordx4 v[204:207], v1, s[16:19], s37 offen offset:3072 sc1
s_branch Lfd_5
Lbad_4:
s_or_b32 s60, s60, 2
Lfd_5:
s_branch Lk2_chk
Lk2_mg1:
ds_write_b128 v2, v[160:163] offset:0
ds_write_b128 v2, v[164:167] offset:1024
ds_write_b128 v2, v[168:171] offset:2048
ds_write_b128 v2, v[172:175] offset:3072
ds_write_b128 v2, v[176:179] offset:4096
ds_write_b128 v2, v[180:183] offset:5120
ds_write_b128 v2, v[184:187] offset:6144
ds_write_b128 v2, v[188:191] offset:7168
ds_write_b128 v2, v[192:195] offset:8192
ds_write_b128 v2, v[196:199] offset:9216
ds_write_b128 v2, v[200:203] offset:10240
ds_write_b128 v2, v[204:207] offset:11264
ds_write_b128 v2, v[208:211] offset:12288
ds_write_b128 v2, v[212:215] offset:13312
ds_write_b128 v2, v[216:219] offset:14336
ds_write_b128 v2, v[220:223] offset:15360
s_waitcnt lgkmcnt(0)
s_barrier
ds_read_b128 v[28:31], v15
ds_read_b128 v[32:35], v3 offset:0
ds_read_b128 v[36:39], v3 offset:1024
ds_read_b128 v[40:43], v3 offset:2048
ds_read_b128 v[44:47], v3 offset:3072
ds_read_b128 v[48:51], v3 offset:4096
ds_read_b128 v[52:55], v3 offset:5120
ds_read_b128 v[56:59], v3 offset:6144
ds_read_b128 v[60:63], v3 offset:7168
ds_read_b128 v[64:67], v3 offset:8192
ds_read_b128 v[68:71], v3 offset:9216
ds_read_b128 v[72:75], v3 offset:10240
ds_read_b128 v[76:79], v3 offset:11264
ds_read_b128 v[80:83], v3 offset:12288
ds_read_b128 v[84:87], v3 offset:13312
ds_read_b128 v[88:91], v3 offset:14336
ds_read_b128 v[92:95], v3 offset:15360
s_waitcnt lgkmcnt(15)
v_add_f32 v20, v20, v28
v_add_f32 v21, v21, v29
v_add_f32 v22, v22, v30
v_add_f32 v23, v23, v31
s_sub_u32 s35, 15, s21
v_rcp_f32 v8, v20
v_rcp_f32 v9, v21
v_rcp_f32 v10, v22
v_rcp_f32 v11, v23
v_subrev_u32 v20, 0x21800000, v20
v_subrev_u32 v21, 0x21800000, v21
v_subrev_u32 v22, 0x21800000, v22
v_subrev_u32 v23, 0x21800000, v23
v_max_u32 v12, v20, v21
v_max3_u32 v12, v12, v22, v23
s_mov_b32 s64, 0x207
v_pk_add_f32 v[224:225], v[224:225], v[32:33]
v_pk_add_f32 v[226:227], v[226:227], v[34:35]
s_waitcnt lgkmcnt(11)
v_pk_add_f32 v[240:241], v[240:241], v[48:49]
v_pk_add_f32 v[242:243], v[242:243], v[50:51]
v_pk_mul_f32 v[224:225], v[224:225], v[8:9] op_sel:[0,0] op_sel_hi:[1,0]
v_pk_mul_f32 v[226:227], v[226:227], v[8:9] op_sel:[0,0] op_sel_hi:[1,0]
v_pk_mul_f32 v[240:241], v[240:241], v[8:9] op_sel:[0,0] op_sel_hi:[1,0]
v_pk_mul_f32 v[242:243], v[242:243], v[8:9] op_sel:[0,0] op_sel_hi:[1,0]
v_cvt_pk_bf16_f32 v224, v224, v225
v_cvt_pk_bf16_f32 v225, v226, v227
v_cvt_pk_bf16_f32 v226, v240, v241
v_cvt_pk_bf16_f32 v227, v242, v243
v_pk_add_f32 v[228:229], v[228:229], v[36:37]
v_pk_add_f32 v[230:231], v[230:231], v[38:39]
s_waitcnt lgkmcnt(10)
v_pk_add_f32 v[244:245], v[244:245], v[52:53]
v_pk_add_f32 v[246:247], v[246:247], v[54:55]
M v[24:27], a[112:115], v[224:227], 0
v_pk_mul_f32 v[228:229], v[228:229], v[8:9] op_sel:[0,1] op_sel_hi:[1,1]
v_pk_mul_f32 v[230:231], v[230:231], v[8:9] op_sel:[0,1] op_sel_hi:[1,1]
v_pk_mul_f32 v[244:245], v[244:245], v[8:9] op_sel:[0,1] op_sel_hi:[1,1]
v_pk_mul_f32 v[246:247], v[246:247], v[8:9] op_sel:[0,1] op_sel_hi:[1,1]
v_cvt_pk_bf16_f32 v228, v228, v229
v_cvt_pk_bf16_f32 v229, v230, v231
v_cvt_pk_bf16_f32 v230, v244, v245
v_cvt_pk_bf16_f32 v231, v246, v247
v_pk_add_f32 v[232:233], v[232:233], v[40:41]
v_pk_add_f32 v[234:235], v[234:235], v[42:43]
s_waitcnt lgkmcnt(9)
v_pk_add_f32 v[248:249], v[248:249], v[56:57]
v_pk_add_f32 v[250:251], v[250:251], v[58:59]
M v[24:27], a[112:115], v[228:231], v[24:27]
v_pk_mul_f32 v[232:233], v[232:233], v[10:11] op_sel:[0,0] op_sel_hi:[1,0]
v_pk_mul_f32 v[234:235], v[234:235], v[10:11] op_sel:[0,0] op_sel_hi:[1,0]
v_pk_mul_f32 v[248:249], v[248:249], v[10:11] op_sel:[0,0] op_sel_hi:[1,0]
v_pk_mul_f32 v[250:251], v[250:251], v[10:11] op_sel:[0,0] op_sel_hi:[1,0]
v_cvt_pk_bf16_f32 v232, v232, v233
v_cvt_pk_bf16_f32 v233, v234, v235
v_cvt_pk_bf16_f32 v234, v248, v249
v_cvt_pk_bf16_f32 v235, v250, v251
v_pk_add_f32 v[236:237], v[236:237], v[44:45]
v_pk_add_f32 v[238:239], v[238:239], v[46:47]
s_waitcnt lgkmcnt(8)
v_pk_add_f32 v[252:253], v[252:253], v[60:61]
v_pk_add_f32 v[254:255], v[254:255], v[62:63]
M v[24:27], a[112:115], v[232:235], v[24:27]
v_pk_mul_f32 v[236:237], v[236:237], v[10:11] op_sel:[0,1] op_sel_hi:[1,1]
v_pk_mul_f32 v[238:239], v[238:239], v[10:11] op_sel:[0,1] op_sel_hi:[1,1]
v_pk_mul_f32 v[252:253], v[252:253], v[10:11] op_sel:[0,1] op_sel_hi:[1,1]
v_pk_mul_f32 v[254:255], v[254:255], v[10:11] op_sel:[0,1] op_sel_hi:[1,1]
v_cvt_pk_bf16_f32 v236, v236, v237
v_cvt_pk_bf16_f32 v237, v238, v239
v_cvt_pk_bf16_f32 v238, v252, v253
v_cvt_pk_bf16_f32 v239, v254, v255
v_accvgpr_read_b32 v32, a64
v_accvgpr_read_b32 v33, a65
v_accvgpr_read_b32 v34, a66
v_accvgpr_read_b32 v35, a67
s_waitcnt lgkmcnt(7)
v_pk_add_f32 v[32:33], v[32:33], v[64:65]
v_pk_add_f32 v[34:35], v[34:35], v[66:67]
v_accvgpr_read_b32 v48, a80
v_accvgpr_read_b32 v49, a81
v_accvgpr_read_b32 v50, a82
v_accvgpr_read_b32 v51, a83
s_waitcnt lgkmcnt(3)
v_pk_add_f32 v[48:49], v[48:49], v[80:81]
v_pk_add_f32 v[50:51], v[50:51], v[82:83]
M v[24:27], a[112:115], v[236:239], v[24:27]
v_pk_mul_f32 v[32:33], v[32:33], v[8:9] op_sel:[0,0] op_sel_hi:[1,0]
v_pk_mul_f32 v[34:35], v[34:35], v[8:9] op_sel:[0,0] op_sel_hi:[1,0]
v_pk_mul_f32 v[48:49], v[48:49], v[8:9] op_sel:[0,0] op_sel_hi:[1,0]
v_pk_mul_f32 v[50:51], v[50:51], v[8:9] op_sel:[0,0] op_sel_hi:[1,0]
v_cvt_pk_bf16_f32 v32, v32, v33
v_cvt_pk_bf16_f32 v33, v34, v35
v_cvt_pk_bf16_f32 v34, v48, v49
v_cvt_pk_bf16_f32 v35, v50, v51
v_accvgpr_read_b32 v240, a68
v_accvgpr_read_b32 v241, a69
v_accvgpr_read_b32 v242, a70
v_accvgpr_read_b32 v243, a71
v_pk_add_f32 v[240:241], v[240:241], v[68:69]
v_pk_add_f32 v[242:243], v[242:243], v[70:71]
v_accvgpr_read_b32 v36, a84
v_accvgpr_read_b32 v37, a85
v_accvgpr_read_b32 v38, a86
v_accvgpr_read_b32 v39, a87
s_waitcnt lgkmcnt(2)
v_pk_add_f32 v[36:37], v[36:37], v[84:85]
v_pk_add_f32 v[38:39], v[38:39], v[86:87]
M v[24:27], a[112:115], v[32:35], v[24:27]
v_pk_mul_f32 v[240:241], v[240:241], v[8:9] op_sel:[0,1] op_sel_hi:[1,1]
v_pk_mul_f32 v[242:243], v[242:243], v[8:9] op_sel:[0,1] op_sel_hi:[1,1]
v_pk_mul_f32 v[36:37], v[36:37], v[8:9] op_sel:[0,1] op_sel_hi:[1,1]
v_pk_mul_f32 v[38:39], v[38:39], v[8:9] op_sel:[0,1] op_sel_hi:[1,1]
v_cvt_pk_bf16_f32 v240, v240, v241
v_cvt_pk_bf16_f32 v241, v242, v243
v_cvt_pk_bf16_f32 v242, v36, v37
v_cvt_pk_bf16_f32 v243, v38, v39
v_accvgpr_read_b32 v52, a72
v_accvgpr_read_b32 v53, a73
v_accvgpr_read_b32 v54, a74
v_accvgpr_read_b32 v55, a75
v_pk_add_f32 v[52:53], v[52:53], v[72:73]
v_pk_add_f32 v[54:55], v[54:55], v[74:75]
v_accvgpr_read_b32 v244, a88
v_accvgpr_read_b32 v245, a89
v_accvgpr_read_b32 v246, a90
v_accvgpr_read_b32 v247, a91
s_waitcnt lgkmcnt(1)
v_pk_add_f32 v[244:245], v[244:245], v[88:89]
v_pk_add_f32 v[246:247], v[246:247], v[90:91]
M v[24:27], a[112:115], v[240:243], v[24:27]
v_pk_mul_f32 v[52:53], v[52:53], v[10:11] op_sel:[0,0] op_sel_hi:[1,0]
v_pk_mul_f32 v[54:55], v[54:55], v[10:11] op_sel:[0,0] op_sel_hi:[1,0]
v_pk_mul_f32 v[244:245], v[244:245], v[10:11] op_sel:[0,0] op_sel_hi:[1,0]
v_pk_mul_f32 v[246:247], v[246:247], v[10:11] op_sel:[0,0] op_sel_hi:[1,0]
v_cvt_pk_bf16_f32 v52, v52, v53
v_cvt_pk_bf16_f32 v53, v54, v55
v_cvt_pk_bf16_f32 v54, v244, v245
v_cvt_pk_bf16_f32 v55, v246, v247
v_accvgpr_read_b32 v40, a76
v_accvgpr_read_b32 v41, a77
v_accvgpr_read_b32 v42, a78
v_accvgpr_read_b32 v43, a79
v_pk_add_f32 v[40:41], v[40:41], v[76:77]
v_pk_add_f32 v[42:43], v[42:43], v[78:79]
v_accvgpr_read_b32 v56, a92
v_accvgpr_read_b32 v57, a93
v_accvgpr_read_b32 v58, a94
v_accvgpr_read_b32 v59, a95
s_waitcnt lgkmcnt(0)
v_pk_add_f32 v[56:57], v[56:57], v[92:93]
v_pk_add_f32 v[58:59], v[58:59], v[94:95]
M v[24:27], a[112:115], v[52:55], v[24:27]
v_pk_mul_f32 v[40:41], v[40:41], v[10:11] op_sel:[0,1] op_sel_hi:[1,1]
v_pk_mul_f32 v[42:43], v[42:43], v[10:11] op_sel:[0,1] op_sel_hi:[1,1]
v_pk_mul_f32 v[56:57], v[56:57], v[10:11] op_sel:[0,1] op_sel_hi:[1,1]
v_pk_mul_f32 v[58:59], v[58:59], v[10:11] op_sel:[0,1] op_sel_hi:[1,1]
v_cvt_pk_bf16_f32 v40, v40, v41
v_cvt_pk_bf16_f32 v41, v42, v43
v_cvt_pk_bf16_f32 v42, v56, v57
v_cvt_pk_bf16_f32 v43, v58, v59
s_nop 1
M v[24:27], a[112:115], v[40:43], v[24:27]
v_cmp_lt_u32 vcc, 0x3c000000, v12
s_nop 6
v_cmp_class_f32 s[40:41], v24, s64
s_nop 0
s_or_b64 vcc, vcc, s[40:41]
s_cbranch_vccnz Lbad_6
s_lshl_b32 s33, s35, 20
s_lshl_b32 s34, s20, 15
s_add_u32 s33, s33, s34
s_lshl_b32 s34, s23, 13
s_add_u32 s36, s33, s34
s_add_u32 s37, s36, 4096
s_add_u32 s38, s36, 16384
s_add_u32 s39, s36, 20480
buffer_store_dwordx4 v[224:227], v1, s[16:19], s38 offen offset:0 sc1
buffer_store_dwordx4 v[228:231], v1, s[16:19], s38 offen offset:2048 sc1
buffer_store_dwordx4 v[232:235], v1, s[16:19], s39 offen offset:0 sc1
buffer_store_dwordx4 v[236:239], v1, s[16:19], s39 offen offset:2048 sc1
buffer_store_dwordx4 v[32:35], v1, s[16:19], s38 offen offset:1024 sc1
buffer_store_dwordx4 v[240:243], v1, s[16:19], s38 offen offset:3072 sc1
buffer_store_dwordx4 v[52:55], v1, s[16:19], s39 offen offset:1024 sc1
buffer_store_dwordx4 v[40:43], v1, s[16:19], s39 offen offset:3072 sc1
s_branch Lfd_7
Lbad_6:
s_or_b32 s60, s60, 2
Lfd_7:
Lk2_chk:
s_cmp_eq_u32 s60, 0
s_cbranch_scc1 Lk2_done
s_sub_u32 s56, 15, s21
s_lshl_b32 s33, s24, 1
s_lshl_b32 s61, 3, s33
s_and_b32 s34, s60, 2
s_bitcmp1_b32 s60, 0
s_cselect_b32 s56, s21, s56
s_cselect_b32 s61, 15, s61
s_cselect_b32 s60, s34, 0
s_waitcnt vmcnt(0)
s_lshl_b32 s33, s20, 7
s_lshl_b32 s34, s56, 3
s_add_u32 s33, s33, s34
s_lshl_b32 s34, s23, 2
s_add_u32 s33, s33, s34
s_lshl_b32 s33, s33, 12
buffer_load_dwordx4 a[0:3], v1, s[8:11], s33 offen offset:0 sc1
buffer_load_dwordx4 a[4:7], v1, s[8:11], s33 offen offset:1024 sc1
buffer_load_dwordx4 a[8:11], v1, s[8:11], s33 offen offset:2048 sc1
buffer_load_dwordx4 a[12:15], v1, s[8:11], s33 offen offset:3072 sc1
s_add_u32 s33, s33, 4096
buffer_load_dwordx4 a[16:19], v1, s[8:11], s33 offen offset:0 sc1
buffer_load_dwordx4 a[20:23], v1, s[8:11], s33 offen offset:1024 sc1
buffer_load_dwordx4 a[24:27], v1, s[8:11], s33 offen offset:2048 sc1
buffer_load_dwordx4 a[28:31], v1, s[8:11], s33 offen offset:3072 sc1
s_add_u32 s33, s33, 4096
buffer_load_dwordx4 a[32:35], v1, s[8:11], s33 offen offset:0 sc1
buffer_load_dwordx4 a[36:39], v1, s[8:11], s33 offen offset:1024 sc1
buffer_load_dwordx4 a[40:43], v1, s[8:11], s33 offen offset:2048 sc1
buffer_load_dwordx4 a[44:47], v1, s[8:11], s33 offen offset:3072 sc1
s_add_u32 s33, s33, 4096
buffer_load_dwordx4 a[48:51], v1, s[8:11], s33 offen offset:0 sc1
buffer_load_dwordx4 a[52:55], v1, s[8:11], s33 offen offset:1024 sc1
buffer_load_dwordx4 a[56:59], v1, s[8:11], s33 offen offset:2048 sc1
buffer_load_dwordx4 a[60:63], v1, s[8:11], s33 offen offset:3072 sc1
v_accvgpr_write_b32 a64, 0
v_accvgpr_write_b32 a65, 0
v_accvgpr_write_b32 a66, 0
v_accvgpr_write_b32 a67, 0
v_accvgpr_write_b32 a68, 0
v_accvgpr_write_b32 a69, 0
v_accvgpr_write_b32 a70, 0
v_accvgpr_write_b32 a71, 0
v_accvgpr_write_b32 a72, 0
v_accvgpr_write_b32 a73, 0
v_accvgpr_write_b32 a74, 0
v_accvgpr_write_b32 a75, 0
v_accvgpr_write_b32 a76, 0
v_accvgpr_write_b32 a77, 0
v_accvgpr_write_b32 a78, 0
v_accvgpr_write_b32 a79, 0
v_accvgpr_write_b32 a80, 0
v_accvgpr_write_b32 a81, 0
v_accvgpr_write_b32 a82, 0
v_accvgpr_write_b32 a83, 0
v_accvgpr_write_b32 a84, 0
v_accvgpr_write_b32 a85, 0
v_accvgpr_write_b32 a86, 0
v_accvgpr_write_b32 a87, 0
v_accvgpr_write_b32 a88, 0
v_accvgpr_write_b32 a89, 0
v_accvgpr_write_b32 a90, 0
v_accvgpr_write_b32 a91, 0
v_accvgpr_write_b32 a92, 0
v_accvgpr_write_b32 a93, 0
v_accvgpr_write_b32 a94, 0
v_accvgpr_write_b32 a95, 0
v_accvgpr_write_b32 a96, 0
v_accvgpr_write_b32 a97, 0
v_accvgpr_write_b32 a98, 0
v_accvgpr_write_b32 a99, 0
v_accvgpr_write_b32 a100, 0
v_accvgpr_write_b32 a101, 0
v_accvgpr_write_b32 a102, 0
v_accvgpr_write_b32 a103, 0
v_accvgpr_write_b32 a104, 0
v_accvgpr_write_b32 a105, 0
v_accvgpr_write_b32 a106, 0
v_accvgpr_write_b32 a107, 0
v_accvgpr_write_b32 a108, 0
v_accvgpr_write_b32 a109, 0
v_accvgpr_write_b32 a110, 0
v_accvgpr_write_b32 a111, 0
v_mov_b32 v160, 0
v_mov_b32 v161, 0
v_mov_b32 v162, 0
v_mov_b32 v163, 0
v_mov_b32 v164, 0
v_mov_b32 v165, 0
v_mov_b32 v166, 0
v_mov_b32 v167, 0
v_mov_b32 v168, 0
v_mov_b32 v169, 0
v_mov_b32 v170, 0
v_mov_b32 v171, 0
v_mov_b32 v172, 0
v_mov_b32 v173, 0
v_mov_b32 v174, 0
v_mov_b32 v175, 0
v_mov_b32 v176, 0
v_mov_b32 v177, 0
v_mov_b32 v178, 0
v_mov_b32 v179, 0
v_mov_b32 v180, 0
v_mov_b32 v181, 0
v_mov_b32 v182, 0
v_mov_b32 v183, 0
v_mov_b32 v184, 0
v_mov_b32 v185, 0
v_mov_b32 v186, 0
v_mov_b32 v187, 0
v_mov_b32 v188, 0
v_mov_b32 v189, 0
v_mov_b32 v190, 0
v_mov_b32 v191, 0
v_mov_b32 v192, 0
v_mov_b32 v193, 0
v_mov_b32 v194, 0
v_mov_b32 v195, 0
v_mov_b32 v196, 0
v_mov_b32 v197, 0
v_mov_b32 v198, 0
v_mov_b32 v199, 0
v_mov_b32 v200, 0
v_mov_b32 v201, 0
v_mov_b32 v202, 0
v_mov_b32 v203, 0
v_mov_b32 v204, 0
v_mov_b32 v205, 0
v_mov_b32 v206, 0
v_mov_b32 v207, 0
v_mov_b32 v208, 0
v_mov_b32 v209, 0
v_mov_b32 v210, 0
v_mov_b32 v211, 0
v_mov_b32 v212, 0
v_mov_b32 v213, 0
v_mov_b32 v214, 0
v_mov_b32 v215, 0
v_mov_b32 v216, 0
v_mov_b32 v217, 0
v_mov_b32 v218, 0
v_mov_b32 v219, 0
v_mov_b32 v220, 0
v_mov_b32 v221, 0
v_mov_b32 v222, 0
v_mov_b32 v223, 0
v_mov_b32 v224, 0
v_mov_b32 v225, 0
v_mov_b32 v226, 0
v_mov_b32 v227, 0
v_mov_b32 v228, 0
v_mov_b32 v229, 0
v_mov_b32 v230, 0
v_mov_b32 v231, 0
v_mov_b32 v232, 0
v_mov_b32 v233, 0
v_mov_b32 v234, 0
v_mov_b32 v235, 0
v_mov_b32 v236, 0
v_mov_b32 v237, 0
v_mov_b32 v238, 0
v_mov_b32 v239, 0
v_mov_b32 v240, 0
v_mov_b32 v241, 0
v_mov_b32 v242, 0
v_mov_b32 v243, 0
v_mov_b32 v244, 0
v_mov_b32 v245, 0
v_mov_b32 v246, 0
v_mov_b32 v247, 0
v_mov_b32 v248, 0
v_mov_b32 v249, 0
v_mov_b32 v250, 0
v_mov_b32 v251, 0
v_mov_b32 v252, 0
v_mov_b32 v253, 0
v_mov_b32 v254, 0
v_mov_b32 v255, 0
v_mov_b32 v8, v4
v_mov_b32 v9, v4
v_mov_b32 v10, v4
v_mov_b32 v11, v4
s_lshl_b32 s57, s20, 20
s_lshl_b32 s58, s56, 7
s_lshl_b32 s59, s56, 1
s_add_u32 s59, s59, 2
Lslow_8:
s_add_u32 s35, s57, 0
buffer_load_dwordx4 v[96:99], v1, s[12:15], s35 offen offset:0 sc1
buffer_load_dwordx4 v[100:103], v1, s[12:15], s35 offen offset:1024 sc1
buffer_load_dwordx4 v[104:107], v1, s[12:15], s35 offen offset:2048 sc1
buffer_load_dwordx4 v[108:111], v1, s[12:15], s35 offen offset:3072 sc1
s_add_u32 s35, s57, 4096
buffer_load_dwordx4 v[112:115], v1, s[12:15], s35 offen offset:0 sc1
buffer_load_dwordx4 v[116:119], v1, s[12:15], s35 offen offset:1024 sc1
buffer_load_dwordx4 v[120:123], v1, s[12:15], s35 offen offset:2048 sc1
buffer_load_dwordx4 v[124:127], v1, s[12:15], s35 offen offset:3072 sc1
s_add_u32 s35, s57, 8192
buffer_load_dwordx4 v[128:131], v1, s[12:15], s35 offen offset:0 sc1
buffer_load_dwordx4 v[132:135], v1, s[12:15], s35 offen offset:1024 sc1
buffer_load_dwordx4 v[136:139], v1, s[12:15], s35 offen offset:2048 sc1
buffer_load_dwordx4 v[140:143], v1, s[12:15], s35 offen offset:3072 sc1
s_add_u32 s35, s57, 12288
buffer_load_dwordx4 v[144:147], v1, s[12:15], s35 offen offset:0 sc1
buffer_load_dwordx4 v[148:151], v1, s[12:15], s35 offen offset:1024 sc1
buffer_load_dwordx4 v[152:155], v1, s[12:15], s35 offen offset:2048 sc1
buffer_load_dwordx4 v[156:159], v1, s[12:15], s35 offen offset:3072 sc1
s_lshl_b32 s33, s23, 6
s_add_i32 s33, s33, s58
s_cmp_gt_i32 s33, 0
s_cselect_b32 s34, 0, 0xf149f2ca
s_cmp_lt_i32 s33, 0
s_cselect_b32 s33, 0xf149f2ca, 0
v_mov_b32 v20, s34
v_mov_b32 v21, s34
v_mov_b32 v22, s34
v_mov_b32 v23, s34
v_mov_b32 v28, s33
v_mov_b32 v29, s33
v_mov_b32 v30, s33
v_mov_b32 v31, s33
v_med3_f32 v24, v16, v20, v28
v_med3_f32 v25, v17, v20, v28
v_med3_f32 v26, v18, v20, v28
v_med3_f32 v27, v19, v20, v28
s_waitcnt vmcnt(0)
s_nop 0
M v[32:35], v[96:99], a[0:3], v[24:27]
M v[32:35], v[100:103], a[4:7], v[32:35]
M v[32:35], v[104:107], a[8:11], v[32:35]
M v[32:35], v[108:111], a[12:15], v[32:35]
M v[36:39], v[96:99], a[16:19], v[28:31]
M v[36:39], v[100:103], a[20:23], v[36:39]
M v[36:39], v[104:107], a[24:27], v[36:39]
M v[36:39], v[108:111], a[28:31], v[36:39]
M v[40:43], v[96:99], a[32:35], v[28:31]
M v[40:43], v[100:103], a[36:39], v[40:43]
M v[40:43], v[104:107], a[40:43], v[40:43]
M v[40:43], v[108:111], a[44:47], v[40:43]
M v[44:47], v[96:99], a[48:51], v[28:31]
M v[44:47], v[100:103], a[52:55], v[44:47]
M v[44:47], v[104:107], a[56:59], v[44:47]
M v[44:47], v[108:111], a[60:63], v[44:47]
M v[48:51], v[112:115], a[0:3], v[20:23]
M v[48:51], v[116:119], a[4:7], v[48:51]
M v[48:51], v[120:123], a[8:11], v[48:51]
M v[48:51], v[124:127], a[12:15], v[48:51]
M v[52:55], v[112:115], a[16:19], v[24:27]
M v[52:55], v[116:119], a[20:23], v[52:55]
M v[52:55], v[120:123], a[24:27], v[52:55]
M v[52:55], v[124:127], a[28:31], v[52:55]
M v[56:59], v[112:115], a[32:35], v[28:31]
M v[56:59], v[116:119], a[36:39], v[56:59]
M v[56:59], v[120:123], a[40:43], v[56:59]
M v[56:59], v[124:127], a[44:47], v[56:59]
M v[60:63], v[112:115], a[48:51], v[28:31]
M v[60:63], v[116:119], a[52:55], v[60:63]
M v[60:63], v[120:123], a[56:59], v[60:63]
M v[60:63], v[124:127], a[60:63], v[60:63]
M v[64:67], v[128:131], a[0:3], v[20:23]
M v[64:67], v[132:135], a[4:7], v[64:67]
M v[64:67], v[136:139], a[8:11], v[64:67]
M v[64:67], v[140:143], a[12:15], v[64:67]
M v[68:71], v[128:131], a[16:19], v[20:23]
M v[68:71], v[132:135], a[20:23], v[68:71]
M v[68:71], v[136:139], a[24:27], v[68:71]
M v[68:71], v[140:143], a[28:31], v[68:71]
M v[72:75], v[128:131], a[32:35], v[24:27]
M v[72:75], v[132:135], a[36:39], v[72:75]
M v[72:75], v[136:139], a[40:43], v[72:75]
M v[72:75], v[140:143], a[44:47], v[72:75]
M v[76:79], v[128:131], a[48:51], v[28:31]
M v[76:79], v[132:135], a[52:55], v[76:79]
M v[76:79], v[136:139], a[56:59], v[76:79]
M v[76:79], v[140:143], a[60:63], v[76:79]
M v[80:83], v[144:147], a[0:3], v[20:23]
M v[80:83], v[148:151], a[4:7], v[80:83]
M v[80:83], v[152:155], a[8:11], v[80:83]
M v[80:83], v[156:159], a[12:15], v[80:83]
M v[84:87], v[144:147], a[16:19], v[20:23]
M v[84:87], v[148:151], a[20:23], v[84:87]
M v[84:87], v[152:155], a[24:27], v[84:87]
M v[84:87], v[156:159], a[28:31], v[84:87]
M v[88:91], v[144:147], a[32:35], v[20:23]
M v[88:91], v[148:151], a[36:39], v[88:91]
M v[88:91], v[152:155], a[40:43], v[88:91]
M v[88:91], v[156:159], a[44:47], v[88:91]
M v[92:95], v[144:147], a[48:51], v[24:27]
M v[92:95], v[148:151], a[52:55], v[92:95]
M v[92:95], v[152:155], a[56:59], v[92:95]
M v[92:95], v[156:159], a[60:63], v[92:95]
s_nop 7
s_add_u32 s35, s57, 16384
buffer_load_dwordx4 v[96:99], v1, s[12:15], s35 offen offset:0 sc1
buffer_load_dwordx4 v[100:103], v1, s[12:15], s35 offen offset:1024 sc1
buffer_load_dwordx4 v[104:107], v1, s[12:15], s35 offen offset:2048 sc1
buffer_load_dwordx4 v[108:111], v1, s[12:15], s35 offen offset:3072 sc1
s_add_u32 s35, s57, 20480
buffer_load_dwordx4 v[112:115], v1, s[12:15], s35 offen offset:0 sc1
buffer_load_dwordx4 v[116:119], v1, s[12:15], s35 offen offset:1024 sc1
buffer_load_dwordx4 v[120:123], v1, s[12:15], s35 offen offset:2048 sc1
buffer_load_dwordx4 v[124:127], v1, s[12:15], s35 offen offset:3072 sc1
s_add_u32 s35, s57, 24576
buffer_load_dwordx4 v[128:131], v1, s[12:15], s35 offen offset:0 sc1
buffer_load_dwordx4 v[132:135], v1, s[12:15], s35 offen offset:1024 sc1
buffer_load_dwordx4 v[136:139], v1, s[12:15], s35 offen offset:2048 sc1
buffer_load_dwordx4 v[140:143], v1, s[12:15], s35 offen offset:3072 sc1
s_add_u32 s35, s57, 28672
buffer_load_dwordx4 v[144:147], v1, s[12:15], s35 offen offset:0 sc1
buffer_load_dwordx4 v[148:151], v1, s[12:15], s35 offen offset:1024 sc1
buffer_load_dwordx4 v[152:155], v1, s[12:15], s35 offen offset:2048 sc1
buffer_load_dwordx4 v[156:159], v1, s[12:15], s35 offen offset:3072 sc1
v_max3_f32 v13, v32, v33, v8
v_max3_f32 v13, v13, v34, v35
v_max3_f32 v13, v13, v48, v49
v_max3_f32 v13, v13, v50, v51
v_max3_f32 v13, v13, v64, v65
v_max3_f32 v13, v13, v66, v67
v_max3_f32 v13, v13, v80, v81
v_max3_f32 v13, v13, v82, v83
v_mov_b32 v14, v13
s_nop 1
v_permlane16_swap_b32 v13, v14
v_max_f32 v13, v13, v14
v_mov_b32 v14, v13
s_nop 1
v_permlane32_swap_b32 v13, v14
v_max_f32 v13, v13, v14
v_sub_f32 v12, v8, v13
v_exp_f32 v12, v12
v_mov_b32 v8, v13
v_sub_f32 v32, v32, v13
v_sub_f32 v33, v33, v13
v_sub_f32 v34, v34, v13
v_sub_f32 v35, v35, v13
v_sub_f32 v48, v48, v13
v_sub_f32 v49, v49, v13
v_sub_f32 v50, v50, v13
v_sub_f32 v51, v51, v13
v_sub_f32 v64, v64, v13
v_sub_f32 v65, v65, v13
v_sub_f32 v66, v66, v13
v_sub_f32 v67, v67, v13
v_sub_f32 v80, v80, v13
v_sub_f32 v81, v81, v13
v_sub_f32 v82, v82, v13
v_sub_f32 v83, v83, v13
v_mul_f32 v160, v160, v12
v_mul_f32 v161, v161, v12
v_mul_f32 v162, v162, v12
v_mul_f32 v163, v163, v12
v_mul_f32 v176, v176, v12
v_mul_f32 v177, v177, v12
v_mul_f32 v178, v178, v12
v_mul_f32 v179, v179, v12
v_mul_f32 v192, v192, v12
v_mul_f32 v193, v193, v12
v_mul_f32 v194, v194, v12
v_mul_f32 v195, v195, v12
v_mul_f32 v208, v208, v12
v_mul_f32 v209, v209, v12
v_mul_f32 v210, v210, v12
v_mul_f32 v211, v211, v12
v_mul_f32 v224, v224, v12
v_mul_f32 v225, v225, v12
v_mul_f32 v226, v226, v12
v_mul_f32 v227, v227, v12
v_mul_f32 v240, v240, v12
v_mul_f32 v241, v241, v12
v_mul_f32 v242, v242, v12
v_mul_f32 v243, v243, v12
v_accvgpr_read_b32 v14, a64
v_mul_f32 v14, v14, v12
v_accvgpr_write_b32 a64, v14
v_accvgpr_read_b32 v14, a65
v_mul_f32 v14, v14, v12
v_accvgpr_write_b32 a65, v14
v_accvgpr_read_b32 v14, a66
v_mul_f32 v14, v14, v12
v_accvgpr_write_b32 a66, v14
v_accvgpr_read_b32 v14, a67
v_mul_f32 v14, v14, v12
v_accvgpr_write_b32 a67, v14
v_accvgpr_read_b32 v14, a80
v_mul_f32 v14, v14, v12
v_accvgpr_write_b32 a80, v14
v_accvgpr_read_b32 v14, a81
v_mul_f32 v14, v14, v12
v_accvgpr_write_b32 a81, v14
v_accvgpr_read_b32 v14, a82
v_mul_f32 v14, v14, v12
v_accvgpr_write_b32 a82, v14
v_accvgpr_read_b32 v14, a83
v_mul_f32 v14, v14, v12
v_accvgpr_write_b32 a83, v14
v_accvgpr_read_b32 v14, a96
v_mul_f32 v14, v14, v12
v_accvgpr_write_b32 a96, v14
v_accvgpr_read_b32 v14, a97
v_mul_f32 v14, v14, v12
v_accvgpr_write_b32 a97, v14
v_accvgpr_read_b32 v14, a98
v_mul_f32 v14, v14, v12
v_accvgpr_write_b32 a98, v14
v_accvgpr_read_b32 v14, a99
v_mul_f32 v14, v14, v12
v_accvgpr_write_b32 a99, v14
v_max3_f32 v13, v36, v37, v9
v_max3_f32 v13, v13, v38, v39
v_max3_f32 v13, v13, v52, v53
v_max3_f32 v13, v13, v54, v55
v_max3_f32 v13, v13, v68, v69
v_max3_f32 v13, v13, v70, v71
v_max3_f32 v13, v13, v84, v85
v_max3_f32 v13, v13, v86, v87
v_mov_b32 v14, v13
s_nop 1
v_permlane16_swap_b32 v13, v14
v_max_f32 v13, v13, v14
v_mov_b32 v14, v13
s_nop 1
v_permlane32_swap_b32 v13, v14
v_max_f32 v13, v13, v14
v_sub_f32 v12, v9, v13
v_exp_f32 v12, v12
v_mov_b32 v9, v13
v_sub_f32 v36, v36, v13
v_sub_f32 v37, v37, v13
v_sub_f32 v38, v38, v13
v_sub_f32 v39, v39, v13
v_sub_f32 v52, v52, v13
v_sub_f32 v53, v53, v13
v_sub_f32 v54, v54, v13
v_sub_f32 v55, v55, v13
v_sub_f32 v68, v68, v13
v_sub_f32 v69, v69, v13
v_sub_f32 v70, v70, v13
v_sub_f32 v71, v71, v13
v_sub_f32 v84, v84, v13
v_sub_f32 v85, v85, v13
v_sub_f32 v86, v86, v13
v_sub_f32 v87, v87, v13
v_mul_f32 v164, v164, v12
v_mul_f32 v165, v165, v12
v_mul_f32 v166, v166, v12
v_mul_f32 v167, v167, v12
v_mul_f32 v180, v180, v12
v_mul_f32 v181, v181, v12
v_mul_f32 v182, v182, v12
v_mul_f32 v183, v183, v12
v_mul_f32 v196, v196, v12
v_mul_f32 v197, v197, v12
v_mul_f32 v198, v198, v12
v_mul_f32 v199, v199, v12
v_mul_f32 v212, v212, v12
v_mul_f32 v213, v213, v12
v_mul_f32 v214, v214, v12
v_mul_f32 v215, v215, v12
v_mul_f32 v228, v228, v12
v_mul_f32 v229, v229, v12
v_mul_f32 v230, v230, v12
v_mul_f32 v231, v231, v12
v_mul_f32 v244, v244, v12
v_mul_f32 v245, v245, v12
v_mul_f32 v246, v246, v12
v_mul_f32 v247, v247, v12
v_accvgpr_read_b32 v14, a68
v_mul_f32 v14, v14, v12
v_accvgpr_write_b32 a68, v14
v_accvgpr_read_b32 v14, a69
v_mul_f32 v14, v14, v12
v_accvgpr_write_b32 a69, v14
v_accvgpr_read_b32 v14, a70
v_mul_f32 v14, v14, v12
v_accvgpr_write_b32 a70, v14
v_accvgpr_read_b32 v14, a71
v_mul_f32 v14, v14, v12
v_accvgpr_write_b32 a71, v14
v_accvgpr_read_b32 v14, a84
v_mul_f32 v14, v14, v12
v_accvgpr_write_b32 a84, v14
v_accvgpr_read_b32 v14, a85
v_mul_f32 v14, v14, v12
v_accvgpr_write_b32 a85, v14
v_accvgpr_read_b32 v14, a86
v_mul_f32 v14, v14, v12
v_accvgpr_write_b32 a86, v14
v_accvgpr_read_b32 v14, a87
v_mul_f32 v14, v14, v12
v_accvgpr_write_b32 a87, v14
v_accvgpr_read_b32 v14, a100
v_mul_f32 v14, v14, v12
v_accvgpr_write_b32 a100, v14
v_accvgpr_read_b32 v14, a101
v_mul_f32 v14, v14, v12
v_accvgpr_write_b32 a101, v14
v_accvgpr_read_b32 v14, a102
v_mul_f32 v14, v14, v12
v_accvgpr_write_b32 a102, v14
v_accvgpr_read_b32 v14, a103
v_mul_f32 v14, v14, v12
v_accvgpr_write_b32 a103, v14
v_max3_f32 v13, v40, v41, v10
v_max3_f32 v13, v13, v42, v43
v_max3_f32 v13, v13, v56, v57
v_max3_f32 v13, v13, v58, v59
v_max3_f32 v13, v13, v72, v73
v_max3_f32 v13, v13, v74, v75
v_max3_f32 v13, v13, v88, v89
v_max3_f32 v13, v13, v90, v91
v_mov_b32 v14, v13
s_nop 1
v_permlane16_swap_b32 v13, v14
v_max_f32 v13, v13, v14
v_mov_b32 v14, v13
s_nop 1
v_permlane32_swap_b32 v13, v14
v_max_f32 v13, v13, v14
v_sub_f32 v12, v10, v13
v_exp_f32 v12, v12
v_mov_b32 v10, v13
v_sub_f32 v40, v40, v13
v_sub_f32 v41, v41, v13
v_sub_f32 v42, v42, v13
v_sub_f32 v43, v43, v13
v_sub_f32 v56, v56, v13
v_sub_f32 v57, v57, v13
v_sub_f32 v58, v58, v13
v_sub_f32 v59, v59, v13
v_sub_f32 v72, v72, v13
v_sub_f32 v73, v73, v13
v_sub_f32 v74, v74, v13
v_sub_f32 v75, v75, v13
v_sub_f32 v88, v88, v13
v_sub_f32 v89, v89, v13
v_sub_f32 v90, v90, v13
v_sub_f32 v91, v91, v13
v_mul_f32 v168, v168, v12
v_mul_f32 v169, v169, v12
v_mul_f32 v170, v170, v12
v_mul_f32 v171, v171, v12
v_mul_f32 v184, v184, v12
v_mul_f32 v185, v185, v12
v_mul_f32 v186, v186, v12
v_mul_f32 v187, v187, v12
v_mul_f32 v200, v200, v12
v_mul_f32 v201, v201, v12
v_mul_f32 v202, v202, v12
v_mul_f32 v203, v203, v12
v_mul_f32 v216, v216, v12
v_mul_f32 v217, v217, v12
v_mul_f32 v218, v218, v12
v_mul_f32 v219, v219, v12
v_mul_f32 v232, v232, v12
v_mul_f32 v233, v233, v12
v_mul_f32 v234, v234, v12
v_mul_f32 v235, v235, v12
v_mul_f32 v248, v248, v12
v_mul_f32 v249, v249, v12
v_mul_f32 v250, v250, v12
v_mul_f32 v251, v251, v12
v_accvgpr_read_b32 v14, a72
v_mul_f32 v14, v14, v12
v_accvgpr_write_b32 a72, v14
v_accvgpr_read_b32 v14, a73
v_mul_f32 v14, v14, v12
v_accvgpr_write_b32 a73, v14
v_accvgpr_read_b32 v14, a74
v_mul_f32 v14, v14, v12
v_accvgpr_write_b32 a74, v14
v_accvgpr_read_b32 v14, a75
v_mul_f32 v14, v14, v12
v_accvgpr_write_b32 a75, v14
v_accvgpr_read_b32 v14, a88
v_mul_f32 v14, v14, v12
v_accvgpr_write_b32 a88, v14
v_accvgpr_read_b32 v14, a89
v_mul_f32 v14, v14, v12
v_accvgpr_write_b32 a89, v14
v_accvgpr_read_b32 v14, a90
v_mul_f32 v14, v14, v12
v_accvgpr_write_b32 a90, v14
v_accvgpr_read_b32 v14, a91
v_mul_f32 v14, v14, v12
v_accvgpr_write_b32 a91, v14
v_accvgpr_read_b32 v14, a104
v_mul_f32 v14, v14, v12
v_accvgpr_write_b32 a104, v14
v_accvgpr_read_b32 v14, a105
v_mul_f32 v14, v14, v12
v_accvgpr_write_b32 a105, v14
v_accvgpr_read_b32 v14, a106
v_mul_f32 v14, v14, v12
v_accvgpr_write_b32 a106, v14
v_accvgpr_read_b32 v14, a107
v_mul_f32 v14, v14, v12
v_accvgpr_write_b32 a107, v14
v_max3_f32 v13, v44, v45, v11
v_max3_f32 v13, v13, v46, v47
v_max3_f32 v13, v13, v60, v61
v_max3_f32 v13, v13, v62, v63
v_max3_f32 v13, v13, v76, v77
v_max3_f32 v13, v13, v78, v79
v_max3_f32 v13, v13, v92, v93
v_max3_f32 v13, v13, v94, v95
v_mov_b32 v14, v13
s_nop 1
v_permlane16_swap_b32 v13, v14
v_max_f32 v13, v13, v14
v_mov_b32 v14, v13
s_nop 1
v_permlane32_swap_b32 v13, v14
v_max_f32 v13, v13, v14
v_sub_f32 v12, v11, v13
v_exp_f32 v12, v12
v_mov_b32 v11, v13
v_sub_f32 v44, v44, v13
v_sub_f32 v45, v45, v13
v_sub_f32 v46, v46, v13
v_sub_f32 v47, v47, v13
v_sub_f32 v60, v60, v13
v_sub_f32 v61, v61, v13
v_sub_f32 v62, v62, v13
v_sub_f32 v63, v63, v13
v_sub_f32 v76, v76, v13
v_sub_f32 v77, v77, v13
v_sub_f32 v78, v78, v13
v_sub_f32 v79, v79, v13
v_sub_f32 v92, v92, v13
v_sub_f32 v93, v93, v13
v_sub_f32 v94, v94, v13
v_sub_f32 v95, v95, v13
v_mul_f32 v172, v172, v12
v_mul_f32 v173, v173, v12
v_mul_f32 v174, v174, v12
v_mul_f32 v175, v175, v12
v_mul_f32 v188, v188, v12
v_mul_f32 v189, v189, v12
v_mul_f32 v190, v190, v12
v_mul_f32 v191, v191, v12
v_mul_f32 v204, v204, v12
v_mul_f32 v205, v205, v12
v_mul_f32 v206, v206, v12
v_mul_f32 v207, v207, v12
v_mul_f32 v220, v220, v12
v_mul_f32 v221, v221, v12
v_mul_f32 v222, v222, v12
v_mul_f32 v223, v223, v12
v_mul_f32 v236, v236, v12
v_mul_f32 v237, v237, v12
v_mul_f32 v238, v238, v12
v_mul_f32 v239, v239, v12
v_mul_f32 v252, v252, v12
v_mul_f32 v253, v253, v12
v_mul_f32 v254, v254, v12
v_mul_f32 v255, v255, v12
v_accvgpr_read_b32 v14, a76
v_mul_f32 v14, v14, v12
v_accvgpr_write_b32 a76, v14
v_accvgpr_read_b32 v14, a77
v_mul_f32 v14, v14, v12
v_accvgpr_write_b32 a77, v14
v_accvgpr_read_b32 v14, a78
v_mul_f32 v14, v14, v12
v_accvgpr_write_b32 a78, v14
v_accvgpr_read_b32 v14, a79
v_mul_f32 v14, v14, v12
v_accvgpr_write_b32 a79, v14
v_accvgpr_read_b32 v14, a92
v_mul_f32 v14, v14, v12
v_accvgpr_write_b32 a92, v14
v_accvgpr_read_b32 v14, a93
v_mul_f32 v14, v14, v12
v_accvgpr_write_b32 a93, v14
v_accvgpr_read_b32 v14, a94
v_mul_f32 v14, v14, v12
v_accvgpr_write_b32 a94, v14
v_accvgpr_read_b32 v14, a95
v_mul_f32 v14, v14, v12
v_accvgpr_write_b32 a95, v14
v_accvgpr_read_b32 v14, a108
v_mul_f32 v14, v14, v12
v_accvgpr_write_b32 a108, v14
v_accvgpr_read_b32 v14, a109
v_mul_f32 v14, v14, v12
v_accvgpr_write_b32 a109, v14
v_accvgpr_read_b32 v14, a110
v_mul_f32 v14, v14, v12
v_accvgpr_write_b32 a110, v14
v_accvgpr_read_b32 v14, a111
v_mul_f32 v14, v14, v12
v_accvgpr_write_b32 a111, v14
v_exp_f32 v32, v32
v_exp_f32 v33, v33
v_exp_f32 v34, v34
v_exp_f32 v35, v35
v_exp_f32 v48, v48
v_exp_f32 v49, v49
v_exp_f32 v50, v50
v_exp_f32 v51, v51
v_cvt_pk_bf16_f32 v32, v32, v33
v_cvt_pk_bf16_f32 v33, v34, v35
v_exp_f32 v36, v36
v_exp_f32 v37, v37
v_exp_f32 v38, v38
v_exp_f32 v39, v39
v_cvt_pk_bf16_f32 v34, v48, v49
v_cvt_pk_bf16_f32 v35, v50, v51
v_exp_f32 v52, v52
v_exp_f32 v53, v53
v_exp_f32 v54, v54
v_exp_f32 v55, v55
v_cvt_pk_bf16_f32 v36, v36, v37
v_cvt_pk_bf16_f32 v37, v38, v39
v_exp_f32 v40, v40
v_exp_f32 v41, v41
v_exp_f32 v42, v42
v_exp_f32 v43, v43
v_cvt_pk_bf16_f32 v38, v52, v53
v_cvt_pk_bf16_f32 v39, v54, v55
v_exp_f32 v56, v56
v_exp_f32 v57, v57
v_exp_f32 v58, v58
v_exp_f32 v59, v59
v_cvt_pk_bf16_f32 v40, v40, v41
v_cvt_pk_bf16_f32 v41, v42, v43
v_exp_f32 v44, v44
v_exp_f32 v45, v45
v_exp_f32 v46, v46
v_exp_f32 v47, v47
v_cvt_pk_bf16_f32 v42, v56, v57
v_cvt_pk_bf16_f32 v43, v58, v59
v_exp_f32 v60, v60
v_exp_f32 v61, v61
v_exp_f32 v62, v62
v_exp_f32 v63, v63
v_cvt_pk_bf16_f32 v44, v44, v45
v_cvt_pk_bf16_f32 v45, v46, v47
v_cvt_pk_bf16_f32 v46, v60, v61
v_cvt_pk_bf16_f32 v47, v62, v63
v_exp_f32 v64, v64
v_exp_f32 v65, v65
v_exp_f32 v66, v66
v_exp_f32 v67, v67
v_exp_f32 v80, v80
v_exp_f32 v81, v81
v_exp_f32 v82, v82
v_exp_f32 v83, v83
v_cvt_pk_bf16_f32 v64, v64, v65
v_cvt_pk_bf16_f32 v65, v66, v67
v_exp_f32 v68, v68
v_exp_f32 v69, v69
v_exp_f32 v70, v70
v_exp_f32 v71, v71
v_cvt_pk_bf16_f32 v66, v80, v81
v_cvt_pk_bf16_f32 v67, v82, v83
v_exp_f32 v84, v84
v_exp_f32 v85, v85
v_exp_f32 v86, v86
v_exp_f32 v87, v87
v_cvt_pk_bf16_f32 v68, v68, v69
v_cvt_pk_bf16_f32 v69, v70, v71
v_exp_f32 v72, v72
v_exp_f32 v73, v73
v_exp_f32 v74, v74
v_exp_f32 v75, v75
v_cvt_pk_bf16_f32 v70, v84, v85
v_cvt_pk_bf16_f32 v71, v86, v87
v_exp_f32 v88, v88
v_exp_f32 v89, v89
v_exp_f32 v90, v90
v_exp_f32 v91, v91
v_cvt_pk_bf16_f32 v72, v72, v73
v_cvt_pk_bf16_f32 v73, v74, v75
v_exp_f32 v76, v76
v_exp_f32 v77, v77
v_exp_f32 v78, v78
v_exp_f32 v79, v79
v_cvt_pk_bf16_f32 v74, v88, v89
v_cvt_pk_bf16_f32 v75, v90, v91
v_exp_f32 v92, v92
v_exp_f32 v93, v93
v_exp_f32 v94, v94
v_exp_f32 v95, v95
v_cvt_pk_bf16_f32 v76, v76, v77
v_cvt_pk_bf16_f32 v77, v78, v79
v_cvt_pk_bf16_f32 v78, v92, v93
v_cvt_pk_bf16_f32 v79, v94, v95
s_waitcnt vmcnt(0)
M a[96:99], a[112:115], v[32:35], a[96:99]
M a[100:103], a[112:115], v[36:39], a[100:103]
M a[104:107], a[112:115], v[40:43], a[104:107]
M a[108:111], a[112:115], v[44:47], a[108:111]
M v[160:163], v[96:99], v[32:35], v[160:163]
M v[164:167], v[96:99], v[36:39], v[164:167]
M v[168:171], v[96:99], v[40:43], v[168:171]
M v[172:175], v[96:99], v[44:47], v[172:175]
M v[176:179], v[100:103], v[32:35], v[176:179]
M v[180:183], v[100:103], v[36:39], v[180:183]
M v[184:187], v[100:103], v[40:43], v[184:187]
M v[188:191], v[100:103], v[44:47], v[188:191]
M v[192:195], v[104:107], v[32:35], v[192:195]
M v[196:199], v[104:107], v[36:39], v[196:199]
M v[200:203], v[104:107], v[40:43], v[200:203]
M v[204:207], v[104:107], v[44:47], v[204:207]
M v[208:211], v[108:111], v[32:35], v[208:211]
M v[212:215], v[108:111], v[36:39], v[212:215]
M v[216:219], v[108:111], v[40:43], v[216:219]
M v[220:223], v[108:111], v[44:47], v[220:223]
M v[224:227], v[112:115], v[32:35], v[224:227]
M v[228:231], v[112:115], v[36:39], v[228:231]
M v[232:235], v[112:115], v[40:43], v[232:235]
M v[236:239], v[112:115], v[44:47], v[236:239]
M v[240:243], v[116:119], v[32:35], v[240:243]
M v[244:247], v[116:119], v[36:39], v[244:247]
M v[248:251], v[116:119], v[40:43], v[248:251]
M v[252:255], v[116:119], v[44:47], v[252:255]
M a[64:67], v[120:123], v[32:35], a[64:67]
M a[68:71], v[120:123], v[36:39], a[68:71]
M a[72:75], v[120:123], v[40:43], a[72:75]
M a[76:79], v[120:123], v[44:47], a[76:79]
M a[80:83], v[124:127], v[32:35], a[80:83]
M a[84:87], v[124:127], v[36:39], a[84:87]
M a[88:91], v[124:127], v[40:43], a[88:91]
M a[92:95], v[124:127], v[44:47], a[92:95]
M a[96:99], a[112:115], v[64:67], a[96:99]
M a[100:103], a[112:115], v[68:71], a[100:103]
M a[104:107], a[112:115], v[72:75], a[104:107]
M a[108:111], a[112:115], v[76:79], a[108:111]
M v[160:163], v[128:131], v[64:67], v[160:163]
M v[164:167], v[128:131], v[68:71], v[164:167]
M v[168:171], v[128:131], v[72:75], v[168:171]
M v[172:175], v[128:131], v[76:79], v[172:175]
M v[176:179], v[132:135], v[64:67], v[176:179]
M v[180:183], v[132:135], v[68:71], v[180:183]
M v[184:187], v[132:135], v[72:75], v[184:187]
M v[188:191], v[132:135], v[76:79], v[188:191]
M v[192:195], v[136:139], v[64:67], v[192:195]
M v[196:199], v[136:139], v[68:71], v[196:199]
M v[200:203], v[136:139], v[72:75], v[200:203]
M v[204:207], v[136:139], v[76:79], v[204:207]
M v[208:211], v[140:143], v[64:67], v[208:211]
M v[212:215], v[140:143], v[68:71], v[212:215]
M v[216:219], v[140:143], v[72:75], v[216:219]
M v[220:223], v[140:143], v[76:79], v[220:223]
M v[224:227], v[144:147], v[64:67], v[224:227]
M v[228:231], v[144:147], v[68:71], v[228:231]
M v[232:235], v[144:147], v[72:75], v[232:235]
M v[236:239], v[144:147], v[76:79], v[236:239]
M v[240:243], v[148:151], v[64:67], v[240:243]
M v[244:247], v[148:151], v[68:71], v[244:247]
M v[248:251], v[148:151], v[72:75], v[248:251]
M v[252:255], v[148:151], v[76:79], v[252:255]
M a[64:67], v[152:155], v[64:67], a[64:67]
M a[68:71], v[152:155], v[68:71], a[68:71]
M a[72:75], v[152:155], v[72:75], a[72:75]
M a[76:79], v[152:155], v[76:79], a[76:79]
M a[80:83], v[156:159], v[64:67], a[80:83]
M a[84:87], v[156:159], v[68:71], a[84:87]
M a[88:91], v[156:159], v[72:75], a[88:91]
M a[92:95], v[156:159], v[76:79], a[92:95]
s_nop 7
s_add_u32 s57, s57, 32768
s_sub_u32 s58, s58, 64
s_sub_u32 s59, s59, 1
s_cmp_lg_u32 s59, 0
s_cbranch_scc1 Lslow_8
v_accvgpr_read_b32 v20, a96
v_accvgpr_read_b32 v21, a100
v_accvgpr_read_b32 v22, a104
v_accvgpr_read_b32 v23, a108
v_rcp_f32 v8, v20
v_rcp_f32 v9, v21
v_rcp_f32 v10, v22
v_rcp_f32 v11, v23
v_pk_mul_f32 v[160:161], v[160:161], v[8:9] op_sel:[0,0] op_sel_hi:[1,0]
v_pk_mul_f32 v[162:163], v[162:163], v[8:9] op_sel:[0,0] op_sel_hi:[1,0]
v_pk_mul_f32 v[176:177], v[176:177], v[8:9] op_sel:[0,0] op_sel_hi:[1,0]
v_pk_mul_f32 v[178:179], v[178:179], v[8:9] op_sel:[0,0] op_sel_hi:[1,0]
v_cvt_pk_bf16_f32 v160, v160, v161
v_cvt_pk_bf16_f32 v161, v162, v163
v_cvt_pk_bf16_f32 v162, v176, v177
v_cvt_pk_bf16_f32 v163, v178, v179
v_pk_mul_f32 v[164:165], v[164:165], v[8:9] op_sel:[0,1] op_sel_hi:[1,1]
v_pk_mul_f32 v[166:167], v[166:167], v[8:9] op_sel:[0,1] op_sel_hi:[1,1]
v_pk_mul_f32 v[180:181], v[180:181], v[8:9] op_sel:[0,1] op_sel_hi:[1,1]
v_pk_mul_f32 v[182:183], v[182:183], v[8:9] op_sel:[0,1] op_sel_hi:[1,1]
v_cvt_pk_bf16_f32 v164, v164, v165
v_cvt_pk_bf16_f32 v165, v166, v167
v_cvt_pk_bf16_f32 v166, v180, v181
v_cvt_pk_bf16_f32 v167, v182, v183
v_pk_mul_f32 v[168:169], v[168:169], v[10:11] op_sel:[0,0] op_sel_hi:[1,0]
v_pk_mul_f32 v[170:171], v[170:171], v[10:11] op_sel:[0,0] op_sel_hi:[1,0]
v_pk_mul_f32 v[184:185], v[184:185], v[10:11] op_sel:[0,0] op_sel_hi:[1,0]
v_pk_mul_f32 v[186:187], v[186:187], v[10:11] op_sel:[0,0] op_sel_hi:[1,0]
v_cvt_pk_bf16_f32 v168, v168, v169
v_cvt_pk_bf16_f32 v169, v170, v171
v_cvt_pk_bf16_f32 v170, v184, v185
v_cvt_pk_bf16_f32 v171, v186, v187
v_pk_mul_f32 v[172:173], v[172:173], v[10:11] op_sel:[0,1] op_sel_hi:[1,1]
v_pk_mul_f32 v[174:175], v[174:175], v[10:11] op_sel:[0,1] op_sel_hi:[1,1]
v_pk_mul_f32 v[188:189], v[188:189], v[10:11] op_sel:[0,1] op_sel_hi:[1,1]
v_pk_mul_f32 v[190:191], v[190:191], v[10:11] op_sel:[0,1] op_sel_hi:[1,1]
v_cvt_pk_bf16_f32 v172, v172, v173
v_cvt_pk_bf16_f32 v173, v174, v175
v_cvt_pk_bf16_f32 v174, v188, v189
v_cvt_pk_bf16_f32 v175, v190, v191
v_pk_mul_f32 v[192:193], v[192:193], v[8:9] op_sel:[0,0] op_sel_hi:[1,0]
v_pk_mul_f32 v[194:195], v[194:195], v[8:9] op_sel:[0,0] op_sel_hi:[1,0]
v_pk_mul_f32 v[208:209], v[208:209], v[8:9] op_sel:[0,0] op_sel_hi:[1,0]
v_pk_mul_f32 v[210:211], v[210:211], v[8:9] op_sel:[0,0] op_sel_hi:[1,0]
v_cvt_pk_bf16_f32 v192, v192, v193
v_cvt_pk_bf16_f32 v193, v194, v195
v_cvt_pk_bf16_f32 v194, v208, v209
v_cvt_pk_bf16_f32 v195, v210, v211
v_pk_mul_f32 v[196:197], v[196:197], v[8:9] op_sel:[0,1] op_sel_hi:[1,1]
v_pk_mul_f32 v[198:199], v[198:199], v[8:9] op_sel:[0,1] op_sel_hi:[1,1]
v_pk_mul_f32 v[212:213], v[212:213], v[8:9] op_sel:[0,1] op_sel_hi:[1,1]
v_pk_mul_f32 v[214:215], v[214:215], v[8:9] op_sel:[0,1] op_sel_hi:[1,1]
v_cvt_pk_bf16_f32 v196, v196, v197
v_cvt_pk_bf16_f32 v197, v198, v199
v_cvt_pk_bf16_f32 v198, v212, v213
v_cvt_pk_bf16_f32 v199, v214, v215
v_pk_mul_f32 v[200:201], v[200:201], v[10:11] op_sel:[0,0] op_sel_hi:[1,0]
v_pk_mul_f32 v[202:203], v[202:203], v[10:11] op_sel:[0,0] op_sel_hi:[1,0]
v_pk_mul_f32 v[216:217], v[216:217], v[10:11] op_sel:[0,0] op_sel_hi:[1,0]
v_pk_mul_f32 v[218:219], v[218:219], v[10:11] op_sel:[0,0] op_sel_hi:[1,0]
v_cvt_pk_bf16_f32 v200, v200, v201
v_cvt_pk_bf16_f32 v201, v202, v203
v_cvt_pk_bf16_f32 v202, v216, v217
v_cvt_pk_bf16_f32 v203, v218, v219
v_pk_mul_f32 v[204:205], v[204:205], v[10:11] op_sel:[0,1] op_sel_hi:[1,1]
v_pk_mul_f32 v[206:207], v[206:207], v[10:11] op_sel:[0,1] op_sel_hi:[1,1]
v_pk_mul_f32 v[220:221], v[220:221], v[10:11] op_sel:[0,1] op_sel_hi:[1,1]
v_pk_mul_f32 v[222:223], v[222:223], v[10:11] op_sel:[0,1] op_sel_hi:[1,1]
v_cvt_pk_bf16_f32 v204, v204, v205
v_cvt_pk_bf16_f32 v205, v206, v207
v_cvt_pk_bf16_f32 v206, v220, v221
v_cvt_pk_bf16_f32 v207, v222, v223
v_pk_mul_f32 v[224:225], v[224:225], v[8:9] op_sel:[0,0] op_sel_hi:[1,0]
v_pk_mul_f32 v[226:227], v[226:227], v[8:9] op_sel:[0,0] op_sel_hi:[1,0]
v_pk_mul_f32 v[240:241], v[240:241], v[8:9] op_sel:[0,0] op_sel_hi:[1,0]
v_pk_mul_f32 v[242:243], v[242:243], v[8:9] op_sel:[0,0] op_sel_hi:[1,0]
v_cvt_pk_bf16_f32 v224, v224, v225
v_cvt_pk_bf16_f32 v225, v226, v227
v_cvt_pk_bf16_f32 v226, v240, v241
v_cvt_pk_bf16_f32 v227, v242, v243
v_pk_mul_f32 v[228:229], v[228:229], v[8:9] op_sel:[0,1] op_sel_hi:[1,1]
v_pk_mul_f32 v[230:231], v[230:231], v[8:9] op_sel:[0,1] op_sel_hi:[1,1]
v_pk_mul_f32 v[244:245], v[244:245], v[8:9] op_sel:[0,1] op_sel_hi:[1,1]
v_pk_mul_f32 v[246:247], v[246:247], v[8:9] op_sel:[0,1] op_sel_hi:[1,1]
v_cvt_pk_bf16_f32 v228, v228, v229
v_cvt_pk_bf16_f32 v229, v230, v231
v_cvt_pk_bf16_f32 v230, v244, v245
v_cvt_pk_bf16_f32 v231, v246, v247
v_pk_mul_f32 v[232:233], v[232:233], v[10:11] op_sel:[0,0] op_sel_hi:[1,0]
v_pk_mul_f32 v[234:235], v[234:235], v[10:11] op_sel:[0,0] op_sel_hi:[1,0]
v_pk_mul_f32 v[248:249], v[248:249], v[10:11] op_sel:[0,0] op_sel_hi:[1,0]
v_pk_mul_f32 v[250:251], v[250:251], v[10:11] op_sel:[0,0] op_sel_hi:[1,0]
v_cvt_pk_bf16_f32 v232, v232, v233
v_cvt_pk_bf16_f32 v233, v234, v235
v_cvt_pk_bf16_f32 v234, v248, v249
v_cvt_pk_bf16_f32 v235, v250, v251
v_pk_mul_f32 v[236:237], v[236:237], v[10:11] op_sel:[0,1] op_sel_hi:[1,1]
v_pk_mul_f32 v[238:239], v[238:239], v[10:11] op_sel:[0,1] op_sel_hi:[1,1]
v_pk_mul_f32 v[252:253], v[252:253], v[10:11] op_sel:[0,1] op_sel_hi:[1,1]
v_pk_mul_f32 v[254:255], v[254:255], v[10:11] op_sel:[0,1] op_sel_hi:[1,1]
v_cvt_pk_bf16_f32 v236, v236, v237
v_cvt_pk_bf16_f32 v237, v238, v239
v_cvt_pk_bf16_f32 v238, v252, v253
v_cvt_pk_bf16_f32 v239, v254, v255
v_accvgpr_read_b32 v176, a64
v_accvgpr_read_b32 v177, a65
v_accvgpr_read_b32 v178, a66
v_accvgpr_read_b32 v179, a67
v_accvgpr_read_b32 v180, a80
v_accvgpr_read_b32 v181, a81
v_accvgpr_read_b32 v182, a82
v_accvgpr_read_b32 v183, a83
v_pk_mul_f32 v[176:177], v[176:177], v[8:9] op_sel:[0,0] op_sel_hi:[1,0]
v_pk_mul_f32 v[178:179], v[178:179], v[8:9] op_sel:[0,0] op_sel_hi:[1,0]
v_pk_mul_f32 v[180:181], v[180:181], v[8:9] op_sel:[0,0] op_sel_hi:[1,0]
v_pk_mul_f32 v[182:183], v[182:183], v[8:9] op_sel:[0,0] op_sel_hi:[1,0]
v_cvt_pk_bf16_f32 v176, v176, v177
v_cvt_pk_bf16_f32 v177, v178, v179
v_cvt_pk_bf16_f32 v178, v180, v181
v_cvt_pk_bf16_f32 v179, v182, v183
v_accvgpr_read_b32 v184, a68
v_accvgpr_read_b32 v185, a69
v_accvgpr_read_b32 v186, a70
v_accvgpr_read_b32 v187, a71
v_accvgpr_read_b32 v188, a84
v_accvgpr_read_b32 v189, a85
v_accvgpr_read_b32 v190, a86
v_accvgpr_read_b32 v191, a87
v_pk_mul_f32 v[184:185], v[184:185], v[8:9] op_sel:[0,1] op_sel_hi:[1,1]
v_pk_mul_f32 v[186:187], v[186:187], v[8:9] op_sel:[0,1] op_sel_hi:[1,1]
v_pk_mul_f32 v[188:189], v[188:189], v[8:9] op_sel:[0,1] op_sel_hi:[1,1]
v_pk_mul_f32 v[190:191], v[190:191], v[8:9] op_sel:[0,1] op_sel_hi:[1,1]
v_cvt_pk_bf16_f32 v184, v184, v185
v_cvt_pk_bf16_f32 v185, v186, v187
v_cvt_pk_bf16_f32 v186, v188, v189
v_cvt_pk_bf16_f32 v187, v190, v191
v_accvgpr_read_b32 v208, a72
v_accvgpr_read_b32 v209, a73
v_accvgpr_read_b32 v210, a74
v_accvgpr_read_b32 v211, a75
v_accvgpr_read_b32 v212, a88
v_accvgpr_read_b32 v213, a89
v_accvgpr_read_b32 v214, a90
v_accvgpr_read_b32 v215, a91
v_pk_mul_f32 v[208:209], v[208:209], v[10:11] op_sel:[0,0] op_sel_hi:[1,0]
v_pk_mul_f32 v[210:211], v[210:211], v[10:11] op_sel:[0,0] op_sel_hi:[1,0]
v_pk_mul_f32 v[212:213], v[212:213], v[10:11] op_sel:[0,0] op_sel_hi:[1,0]
v_pk_mul_f32 v[214:215], v[214:215], v[10:11] op_sel:[0,0] op_sel_hi:[1,0]
v_cvt_pk_bf16_f32 v208, v208, v209
v_cvt_pk_bf16_f32 v209, v210, v211
v_cvt_pk_bf16_f32 v210, v212, v213
v_cvt_pk_bf16_f32 v211, v214, v215
v_accvgpr_read_b32 v216, a76
v_accvgpr_read_b32 v217, a77
v_accvgpr_read_b32 v218, a78
v_accvgpr_read_b32 v219, a79
v_accvgpr_read_b32 v220, a92
v_accvgpr_read_b32 v221, a93
v_accvgpr_read_b32 v222, a94
v_accvgpr_read_b32 v223, a95
v_pk_mul_f32 v[216:217], v[216:217], v[10:11] op_sel:[0,1] op_sel_hi:[1,1]
v_pk_mul_f32 v[218:219], v[218:219], v[10:11] op_sel:[0,1] op_sel_hi:[1,1]
v_pk_mul_f32 v[220:221], v[220:221], v[10:11] op_sel:[0,1] op_sel_hi:[1,1]
v_pk_mul_f32 v[222:223], v[222:223], v[10:11] op_sel:[0,1] op_sel_hi:[1,1]
v_cvt_pk_bf16_f32 v216, v216, v217
v_cvt_pk_bf16_f32 v217, v218, v219
v_cvt_pk_bf16_f32 v218, v220, v221
v_cvt_pk_bf16_f32 v219, v222, v223
s_lshl_b32 s33, s56, 20
s_lshl_b32 s34, s20, 15
s_add_u32 s33, s33, s34
s_lshl_b32 s34, s23, 13
s_add_u32 s36, s33, s34
s_add_u32 s37, s36, 4096
s_add_u32 s38, s36, 16384
s_add_u32 s39, s36, 20480
s_bitcmp1_b32 s61, 0
s_cbranch_scc0 Lss_11
buffer_store_dwordx4 v[160:163], v1, s[16:19], s36 offen offset:0 sc1
buffer_store_dwordx4 v[164:167], v1, s[16:19], s36 offen offset:2048 sc1
buffer_store_dwordx4 v[168:171], v1, s[16:19], s37 offen offset:0 sc1
buffer_store_dwordx4 v[172:175], v1, s[16:19], s37 offen offset:2048 sc1
Lss_11:
s_bitcmp1_b32 s61, 1
s_cbranch_scc0 Lss_12
buffer_store_dwordx4 v[192:195], v1, s[16:19], s36 offen offset:1024 sc1
buffer_store_dwordx4 v[196:199], v1, s[16:19], s36 offen offset:3072 sc1
buffer_store_dwordx4 v[200:203], v1, s[16:19], s37 offen offset:1024 sc1
buffer_store_dwordx4 v[204:207], v1, s[16:19], s37 offen offset:3072 sc1
Lss_12:
s_bitcmp1_b32 s61, 2
s_cbranch_scc0 Lss_13
buffer_store_dwordx4 v[224:227], v1, s[16:19], s38 offen offset:0 sc1
buffer_store_dwordx4 v[228:231], v1, s[16:19], s38 offen offset:2048 sc1
buffer_store_dwordx4 v[232:235], v1, s[16:19], s39 offen offset:0 sc1
buffer_store_dwordx4 v[236:239], v1, s[16:19], s39 offen offset:2048 sc1
Lss_13:
s_bitcmp1_b32 s61, 3
s_cbranch_scc0 Lss_14
buffer_store_dwordx4 v[176:179], v1, s[16:19], s38 offen offset:1024 sc1
buffer_store_dwordx4 v[184:187], v1, s[16:19], s38 offen offset:3072 sc1
buffer_store_dwordx4 v[208:211], v1, s[16:19], s39 offen offset:1024 sc1
buffer_store_dwordx4 v[216:219], v1, s[16:19], s39 offen offset:3072 sc1
Lss_14:
s_branch Lk2_chk
Lk2_done:
s_lshl_b32 s33, s20, 4
s_add_u32 s33, s33, 8392704
s_sub_u32 s34, 15, s21
s_lshl_b32 s34, s34, 9
s_add_u32 s92, s33, s34
s_lshl_b32 s34, s22, 2
s_add_u32 s92, s92, s34
s_lshl_b32 s34, s21, 9
s_add_u32 s93, s33, s34
s_lshl_b32 s34, s23, 3
s_add_u32 s93, s93, s34
s_cmp_eq_u32 s24, 0
s_cselect_b32 s93, s93, s92
s_cselect_b32 s94, 4, 0
s_add_u32 s94, s94, s93
s_load_dwordx2 s[10:11], s[0:1], 40
s_load_dwordx2 s[14:15], s[0:1], 72
s_lshl_b32 s21, s27, 7
s_lshl_b32 s22, s28, 6
s_lshl_b32 s3, s101, 4
v_lshrrev_b32 v224, 3, v0
v_and_b32 v225, 6, v224
v_and_b32 v226, 7, v0
v_xor_b32 v225, v225, v226
v_add_u32 v224, s3, v224
v_lshlrev_b32 v224, 11, v224
v_lshl_add_u32 v6, v225, 4, v224
v_add_u32 v7, 15360, v6
v_lshrrev_b32 v224, 2, v0
v_and_b32 v226, 1, v0
v_bfe_u32 v229, v0, 1, 1
v_lshlrev_b32 v225, 7, v224
v_lshl_add_u32 v225, v226, 3, v225
v_and_b32 v228, 6, v224
v_add_u32 v227, 0, v229
v_xor_b32 v227, v227, v228
v_lshl_add_u32 v24, v227, 4, v225
v_add_u32 v28, 0x10000, v24
v_add_u32 v227, 2, v229
v_xor_b32 v227, v227, v228
v_lshl_add_u32 v25, v227, 4, v225
v_add_u32 v29, 0x10000, v25
v_add_u32 v227, 4, v229
v_xor_b32 v227, v227, v228
v_lshl_add_u32 v26, v227, 4, v225
v_add_u32 v30, 0x10000, v26
v_add_u32 v227, 6, v229
v_xor_b32 v227, v227, v228
v_lshl_add_u32 v27, v227, 4, v225
v_add_u32 v31, 0x10000, v27
s_waitcnt vmcnt(32)
s_barrier
ds_read_b64_tr_b16 v[96:97], v28 offset:0
ds_read_b64_tr_b16 v[98:99], v28 offset:2048
ds_read_b64_tr_b16 v[100:101], v28 offset:4096
ds_read_b64_tr_b16 v[102:103], v28 offset:6144
ds_read_b64_tr_b16 v[104:105], v29 offset:0
ds_read_b64_tr_b16 v[106:107], v29 offset:2048
ds_read_b64_tr_b16 v[108:109], v29 offset:4096
ds_read_b64_tr_b16 v[110:111], v29 offset:6144
ds_read_b64_tr_b16 v[112:113], v30 offset:0
ds_read_b64_tr_b16 v[114:115], v30 offset:2048
ds_read_b64_tr_b16 v[116:117], v30 offset:4096
ds_read_b64_tr_b16 v[118:119], v30 offset:6144
ds_read_b64_tr_b16 v[120:121], v31 offset:0
ds_read_b64_tr_b16 v[122:123], v31 offset:2048
ds_read_b64_tr_b16 v[124:125], v31 offset:4096
ds_read_b64_tr_b16 v[126:127], v31 offset:6144
s_and_b32 s40, s2, 1
s_bfe_u32 s3, s2, 0x10001
s_lshl_b32 s3, s3, 3
s_bfe_u32 s36, s2, 0x30003
s_add_u32 s36, s3, s36
s_lshl_b32 s29, s36, 7
s_bfe_u32 s3, s2, 0x10002
s_lshl_b32 s3, s3, 2
s_lshr_b32 s37, s2, 6
s_add_u32 s3, s3, s37
s_lshl_b32 s13, s3, 8
s_lshl_b32 s30, s3, 7
s_lshl_b32 s3, s40, 6
s_add_u32 s30, s30, s3
s_lshl_b32 s41, s101, 12
s_lshl_b32 s12, s36, 20
s_add_u32 s12, s12, s41
s_lshl_b32 s62, s36, 9
s_lshl_b32 s3, s40, 8
s_add_u32 s62, s62, s3
s_add_u32 s62, s62, 8392704
s_lshr_b32 s3, s2, 1
s_lshr_b32 s38, s2, 2
s_xor_b32 s3, s3, s38
s_and_b32 s3, s3, 1
s_lshl_b32 s3, s3, 4
s_sub_u32 s39, 32, s3
s_lshl_b32 s38, s40, 5
s_add_u32 s3, s3, s38
s_lshl_b32 s3, s3, 14
s_add_u32 s12, s12, s3
s_lshl_b32 s3, s3, 3
s_add_u32 s13, s13, s3
s_mov_b32 s64, 4294459392
s_mov_b32 s65, 16384
s_add_u32 s8, s4, 67108864
s_addc_u32 s9, s5, 0
s_lshl_b32 s56, s2, 15
s_lshl_b32 s38, s101, 13
s_add_u32 s56, s56, s38
s_xor_b32 s57, s56, 32768
s_lshl_b32 s58, s2, 2
s_add_u32 s58, s58, 8388608
s_xor_b32 s59, s58, 4
s_mov_b32 s61, 0
s_lshl_b32 s3, s101, 4
v_lshrrev_b32 v232, 4, v0
v_and_b32 v234, 15, v0
v_add_u32 v233, 0, v232
v_lshlrev_b32 v233, 1, v233
v_xor_b32 v233, v233, v234
v_add_u32 v235, s3, v232
v_lshlrev_b32 v235, 11, v235
v_lshl_add_u32 v235, v233, 4, v235
v_add_u32 v2, 0, v235
v_add_u32 v233, 4, v232
v_lshlrev_b32 v233, 1, v233
v_xor_b32 v233, v233, v234
v_add_u32 v235, s3, v232
v_lshlrev_b32 v235, 11, v235
v_lshl_add_u32 v235, v233, 4, v235
v_add_u32 v3, 7168, v235
v_add_u32 v233, 0, v232
v_lshlrev_b32 v233, 1, v233
v_xor_b32 v233, v233, v234
v_add_u32 v235, s3, v232
v_lshlrev_b32 v235, 11, v235
v_lshl_add_u32 v235, v233, 4, v235
v_add_u32 v4, 14336, v235
v_add_u32 v233, 4, v232
v_lshlrev_b32 v233, 1, v233
v_xor_b32 v233, v233, v234
v_add_u32 v235, s3, v232
v_lshlrev_b32 v235, 11, v235
v_lshl_add_u32 v235, v233, 4, v235
v_add_u32 v5, 21504, v235
v_lshlrev_b32 v225, 8, v224
v_lshl_add_u32 v225, v226, 3, v225
v_and_b32 v228, 7, v224
v_lshlrev_b32 v228, 1, v228
s_lshl_b32 s38, s40, 3
v_xor_b32 v228, s38, v228
v_add_u32 v227, 0, v229
v_xor_b32 v227, v227, v228
v_lshl_add_u32 v8, v227, 4, v225
v_add_u32 v16, 0x10000, v8
v_add_u32 v227, 2, v229
v_xor_b32 v227, v227, v228
v_lshl_add_u32 v9, v227, 4, v225
v_add_u32 v17, 0x10000, v9
v_add_u32 v227, 4, v229
v_xor_b32 v227, v227, v228
v_lshl_add_u32 v10, v227, 4, v225
v_add_u32 v18, 0x10000, v10
v_add_u32 v227, 6, v229
v_xor_b32 v227, v227, v228
v_lshl_add_u32 v11, v227, 4, v225
v_add_u32 v19, 0x10000, v11
v_add_u32 v227, 8, v229
v_xor_b32 v227, v227, v228
v_lshl_add_u32 v12, v227, 4, v225
v_add_u32 v20, 0x10000, v12
v_add_u32 v227, 10, v229
v_xor_b32 v227, v227, v228
v_lshl_add_u32 v13, v227, 4, v225
v_add_u32 v21, 0x10000, v13
v_add_u32 v227, 12, v229
v_xor_b32 v227, v227, v228
v_lshl_add_u32 v14, v227, 4, v225
v_add_u32 v22, 0x10000, v14
v_add_u32 v227, 14, v229
v_xor_b32 v227, v227, v228
v_lshl_add_u32 v15, v227, 4, v225
v_add_u32 v23, 0x10000, v15
v_mov_b32 v253, 0
v_mov_b32 v254, 1
v_lshlrev_b32 v255, 2, v0
s_waitcnt lgkmcnt(0)
s_mov_b32 s16, s14
s_mov_b32 s17, s15
s_mov_b32 s18, 8388608
s_mov_b32 s19, 0x00020000
s_waitcnt vmcnt(26) lgkmcnt(0)
s_barrier
M a[0:3], v[96:99], a[192:195], 0
s_add_u32 m0, s42, 16384
s_nop 0
buffer_load_dwordx4 v6, s[48:51], s26 offen offset:0 lds
ds_read_b64_tr_b16 v[160:161], v28 offset:16384
ds_read_b64_tr_b16 v[162:163], v28 offset:18432
M a[0:3], v[100:103], a[196:199], a[0:3]
buffer_load_dwordx4 v7, s[48:51], s26 offen offset:1024 lds
M a[4:7], v[108:111], a[196:199], 0
ds_read_b64_tr_b16 v[164:165], v28 offset:20480
ds_read_b64_tr_b16 v[166:167], v28 offset:22528
M a[4:7], v[104:107], a[192:195], a[4:7]
buffer_load_dwordx4 a[144:147], v1, s[44:47], s25 offen offset:0 sc1
M a[8:11], v[112:115], a[192:195], 0
ds_read_b64_tr_b16 v[168:169], v29 offset:16384
ds_read_b64_tr_b16 v[170:171], v29 offset:18432
M a[8:11], v[116:119], a[196:199], a[8:11]
buffer_load_dwordx4 a[148:151], v1, s[44:47], s25 offen offset:1024 sc1
M a[12:15], v[124:127], a[196:199], 0
ds_read_b64_tr_b16 v[172:173], v29 offset:20480
ds_read_b64_tr_b16 v[174:175], v29 offset:22528
M a[12:15], v[120:123], a[192:195], a[12:15]
buffer_load_dwordx4 a[152:155], v1, s[44:47], s25 offen offset:2048 sc1
M a[16:19], v[96:99], a[200:203], 0
ds_read_b64_tr_b16 v[176:177], v30 offset:16384
ds_read_b64_tr_b16 v[178:179], v30 offset:18432
M a[16:19], v[100:103], a[204:207], a[16:19]
buffer_load_dwordx4 a[156:159], v1, s[44:47], s25 offen offset:3072 sc1
M a[20:23], v[108:111], a[204:207], 0
ds_read_b64_tr_b16 v[180:181], v30 offset:20480
ds_read_b64_tr_b16 v[182:183], v30 offset:22528
M a[20:23], v[104:107], a[200:203], a[20:23]
s_add_u32 s25, s25, 16384
s_add_u32 s26, s26, 131072
M a[24:27], v[112:115], a[200:203], 0
ds_read_b64_tr_b16 v[184:185], v31 offset:16384
ds_read_b64_tr_b16 v[186:187], v31 offset:18432
M a[24:27], v[116:119], a[204:207], a[24:27]
ds_read_b64_tr_b16 v[188:189], v31 offset:20480
ds_read_b64_tr_b16 v[190:191], v31 offset:22528
M a[28:31], v[124:127], a[204:207], 0
M a[28:31], v[120:123], a[200:203], a[28:31]
s_waitcnt vmcnt(6) lgkmcnt(0)
s_barrier
s_mov_b64 exec, 1
buffer_store_dword v254, v253, s[52:55], s92 offen sc1
buffer_store_dword v254, v253, s[52:55], s93 offen sc1
buffer_store_dword v254, v253, s[52:55], s94 offen sc1
s_mov_b64 exec, -1
M a[0:3], v[160:163], a[208:211], a[0:3]
s_add_u32 m0, s42, 32768
s_nop 0
buffer_load_dwordx4 v6, s[48:51], s26 offen offset:0 lds
ds_read_b64_tr_b16 v[96:97], v28 offset:32768
ds_read_b64_tr_b16 v[98:99], v28 offset:34816
M a[0:3], v[164:167], a[212:215], a[0:3]
buffer_load_dwordx4 v7, s[48:51], s26 offen offset:1024 lds
M a[4:7], v[172:175], a[212:215], a[4:7]
ds_read_b64_tr_b16 v[100:101], v28 offset:36864
ds_read_b64_tr_b16 v[102:103], v28 offset:38912
M a[4:7], v[168:171], a[208:211], a[4:7]
buffer_load_dwordx4 a[160:163], v1, s[44:47], s25 offen offset:0 sc1
M a[8:11], v[176:179], a[208:211], a[8:11]
ds_read_b64_tr_b16 v[104:105], v29 offset:32768
ds_read_b64_tr_b16 v[106:107], v29 offset:34816
M a[8:11], v[180:183], a[212:215], a[8:11]
buffer_load_dwordx4 a[164:167], v1, s[44:47], s25 offen offset:1024 sc1
M a[12:15], v[188:191], a[212:215], a[12:15]
ds_read_b64_tr_b16 v[108:109], v29 offset:36864
ds_read_b64_tr_b16 v[110:111], v29 offset:38912
M a[12:15], v[184:187], a[208:211], a[12:15]
buffer_load_dwordx4 a[168:171], v1, s[44:47], s25 offen offset:2048 sc1
M a[16:19], v[160:163], a[216:219], a[16:19]
ds_read_b64_tr_b16 v[112:113], v30 offset:32768
ds_read_b64_tr_b16 v[114:115], v30 offset:34816
M a[16:19], v[164:167], a[220:223], a[16:19]
buffer_load_dwordx4 a[172:175], v1, s[44:47], s25 offen offset:3072 sc1
M a[20:23], v[172:175], a[220:223], a[20:23]
ds_read_b64_tr_b16 v[116:117], v30 offset:36864
ds_read_b64_tr_b16 v[118:119], v30 offset:38912
M a[20:23], v[168:171], a[216:219], a[20:23]
s_add_u32 s25, s25, 16384
s_add_u32 s26, s26, 131072
M a[24:27], v[176:179], a[216:219], a[24:27]
ds_read_b64_tr_b16 v[120:121], v31 offset:32768
ds_read_b64_tr_b16 v[122:123], v31 offset:34816
M a[24:27], v[180:183], a[220:223], a[24:27]
ds_read_b64_tr_b16 v[124:125], v31 offset:36864
ds_read_b64_tr_b16 v[126:127], v31 offset:38912
M a[28:31], v[188:191], a[220:223], a[28:31]
M a[28:31], v[184:187], a[216:219], a[28:31]
s_waitcnt vmcnt(29) lgkmcnt(0)
s_barrier
M a[0:3], v[96:99], a[224:227], a[0:3]
s_add_u32 m0, s42, 49152
s_nop 0
buffer_load_dwordx4 v6, s[48:51], s26 offen offset:0 lds
ds_read_b64_tr_b16 v[160:161], v28 offset:49152
ds_read_b64_tr_b16 v[162:163], v28 offset:51200
M a[0:3], v[100:103], a[228:231], a[0:3]
buffer_load_dwordx4 v7, s[48:51], s26 offen offset:1024 lds
M a[4:7], v[108:111], a[228:231], a[4:7]
ds_read_b64_tr_b16 v[164:165], v28 offset:53248
ds_read_b64_tr_b16 v[166:167], v28 offset:55296
M a[4:7], v[104:107], a[224:227], a[4:7]
buffer_load_dwordx4 a[176:179], v1, s[44:47], s25 offen offset:0 sc1
M a[8:11], v[112:115], a[224:227], a[8:11]
ds_read_b64_tr_b16 v[168:169], v29 offset:49152
ds_read_b64_tr_b16 v[170:171], v29 offset:51200
M a[8:11], v[116:119], a[228:231], a[8:11]
buffer_load_dwordx4 a[180:183], v1, s[44:47], s25 offen offset:1024 sc1
M a[12:15], v[124:127], a[228:231], a[12:15]
ds_read_b64_tr_b16 v[172:173], v29 offset:53248
ds_read_b64_tr_b16 v[174:175], v29 offset:55296
M a[12:15], v[120:123], a[224:227], a[12:15]
buffer_load_dwordx4 a[184:187], v1, s[44:47], s25 offen offset:2048 sc1
ds_read_b64_tr_b16 v[176:177], v30 offset:49152
ds_read_b64_tr_b16 v[178:179], v30 offset:51200
M a[16:19], v[96:99], a[232:235], a[16:19]
buffer_load_dwordx4 a[188:191], v1, s[44:47], s25 offen offset:3072 sc1
M a[16:19], v[100:103], a[236:239], a[16:19]
ds_read_b64_tr_b16 v[180:181], v30 offset:53248
ds_read_b64_tr_b16 v[182:183], v30 offset:55296
M a[20:23], v[108:111], a[236:239], a[20:23]
s_add_u32 s25, s25, 16384
s_add_u32 s26, s26, 131072
M a[20:23], v[104:107], a[232:235], a[20:23]
ds_read_b64_tr_b16 v[184:185], v31 offset:49152
ds_read_b64_tr_b16 v[186:187], v31 offset:51200
M a[24:27], v[112:115], a[232:235], a[24:27]
buffer_load_dword v252, v255, s[52:55], s62 offen sc1
M a[24:27], v[116:119], a[236:239], a[24:27]
ds_read_b64_tr_b16 v[188:189], v31 offset:53248
ds_read_b64_tr_b16 v[190:191], v31 offset:55296
M a[28:31], v[124:127], a[236:239], a[28:31]
M a[28:31], v[120:123], a[232:235], a[28:31]
s_waitcnt vmcnt(30) lgkmcnt(0)
s_barrier
s_waitcnt vmcnt(0)
v_cmp_ne_u32 vcc, 1, v252
s_nop 0
s_cbranch_vccnz Lk3_spinft
Lk3_gotft:
M a[0:3], v[160:163], a[240:243], a[0:3]
s_mov_b32 s32, s25
s_mov_b32 s33, s26
s_mov_b64 s[34:35], s[44:45]
s_mov_b64 s[36:37], s[48:49]
s_mov_b64 s[44:45], s[8:9]
s_mov_b32 s46, 16777216
s_mov_b64 s[48:49], s[10:11]
s_mov_b32 s50, 8388608
s_mov_b32 s25, s12
s_mov_b32 s26, s13
s_add_u32 m0, s41, 65536
s_nop 0
buffer_load_dwordx4 v2, s[48:51], s26 offen offset:0 lds
ds_read_b64_tr_b16 v[96:97], v24 offset:0
ds_read_b64_tr_b16 v[98:99], v24 offset:2048
M a[0:3], v[164:167], a[244:247], a[0:3]
buffer_load_dwordx4 v3, s[48:51], s26 offen offset:1024 lds
M a[4:7], v[172:175], a[244:247], a[4:7]
ds_read_b64_tr_b16 v[100:101], v24 offset:4096
ds_read_b64_tr_b16 v[102:103], v24 offset:6144
M a[4:7], v[168:171], a[240:243], a[4:7]
buffer_load_dwordx4 v4, s[48:51], s26 offen offset:2048 lds
ds_read_b64_tr_b16 v[104:105], v25 offset:0
ds_read_b64_tr_b16 v[106:107], v25 offset:2048
M a[8:11], v[176:179], a[240:243], a[8:11]
buffer_load_dwordx4 v5, s[48:51], s26 offen offset:3072 lds
M a[8:11], v[180:183], a[244:247], a[8:11]
ds_read_b64_tr_b16 v[108:109], v25 offset:4096
ds_read_b64_tr_b16 v[110:111], v25 offset:6144
M a[12:15], v[188:191], a[244:247], a[12:15]
buffer_load_dwordx4 a[192:195], v1, s[44:47], s25 offen offset:0 sc1
M a[12:15], v[184:187], a[240:243], a[12:15]
ds_read_b64_tr_b16 v[112:113], v26 offset:0
ds_read_b64_tr_b16 v[114:115], v26 offset:2048
buffer_load_dwordx4 a[196:199], v1, s[44:47], s25 offen offset:1024 sc1
M a[16:19], v[160:163], a[248:251], a[16:19]
ds_read_b64_tr_b16 v[116:117], v26 offset:4096
ds_read_b64_tr_b16 v[118:119], v26 offset:6144
M a[16:19], v[164:167], a[252:255], a[16:19]
buffer_load_dwordx4 a[200:203], v1, s[44:47], s25 offen offset:2048 sc1
M a[20:23], v[172:175], a[252:255], a[20:23]
ds_read_b64_tr_b16 v[120:121], v27 offset:0
ds_read_b64_tr_b16 v[122:123], v27 offset:2048
buffer_load_dwordx4 a[204:207], v1, s[44:47], s25 offen offset:3072 sc1
M a[20:23], v[168:171], a[248:251], a[20:23]
ds_read_b64_tr_b16 v[124:125], v27 offset:4096
ds_read_b64_tr_b16 v[126:127], v27 offset:6144
M a[24:27], v[176:179], a[248:251], a[24:27]
s_sub_u32 s39, s39, 1
s_cmp_eq_u32 s39, 0
s_cselect_b32 s3, s64, s65
M a[24:27], v[180:183], a[252:255], a[24:27]
s_add_u32 s25, s25, s3
s_lshl_b32 s3, s3, 3
s_add_u32 s26, s26, s3
M a[28:31], v[188:191], a[252:255], a[28:31]
M a[28:31], v[184:187], a[248:251], a[28:31]
s_waitcnt vmcnt(24) lgkmcnt(0)
s_barrier
M a[0:3], v[96:99], a[128:131], a[0:3]
s_add_u32 m0, s41, 81920
s_nop 0
buffer_load_dwordx4 v2, s[48:51], s26 offen offset:0 lds
ds_read_b64_tr_b16 v[160:161], v24 offset:16384
ds_read_b64_tr_b16 v[162:163], v24 offset:18432
M a[0:3], v[100:103], a[132:135], a[0:3]
buffer_load_dwordx4 v3, s[48:51], s26 offen offset:1024 lds
M a[4:7], v[108:111], a[132:135], a[4:7]
ds_read_b64_tr_b16 v[164:165], v24 offset:20480
ds_read_b64_tr_b16 v[166:167], v24 offset:22528
M a[4:7], v[104:107], a[128:131], a[4:7]
buffer_load_dwordx4 v4, s[48:51], s26 offen offset:2048 lds
ds_read_b64_tr_b16 v[168:169], v25 offset:16384
ds_read_b64_tr_b16 v[170:171], v25 offset:18432
M a[8:11], v[112:115], a[128:131], a[8:11]
buffer_load_dwordx4 v5, s[48:51], s26 offen offset:3072 lds
M a[8:11], v[116:119], a[132:135], a[8:11]
ds_read_b64_tr_b16 v[172:173], v25 offset:20480
ds_read_b64_tr_b16 v[174:175], v25 offset:22528
M a[12:15], v[124:127], a[132:135], a[12:15]
buffer_load_dwordx4 a[208:211], v1, s[44:47], s25 offen offset:0 sc1
M a[12:15], v[120:123], a[128:131], a[12:15]
ds_read_b64_tr_b16 v[176:177], v26 offset:16384
ds_read_b64_tr_b16 v[178:179], v26 offset:18432
buffer_load_dwordx4 a[212:215], v1, s[44:47], s25 offen offset:1024 sc1
M a[16:19], v[96:99], a[136:139], a[16:19]
ds_read_b64_tr_b16 v[180:181], v26 offset:20480
ds_read_b64_tr_b16 v[182:183], v26 offset:22528
M a[16:19], v[100:103], a[140:143], a[16:19]
buffer_load_dwordx4 a[216:219], v1, s[44:47], s25 offen offset:2048 sc1
M a[20:23], v[108:111], a[140:143], a[20:23]
ds_read_b64_tr_b16 v[184:185], v27 offset:16384
ds_read_b64_tr_b16 v[186:187], v27 offset:18432
buffer_load_dwordx4 a[220:223], v1, s[44:47], s25 offen offset:3072 sc1
M a[20:23], v[104:107], a[136:139], a[20:23]
ds_read_b64_tr_b16 v[188:189], v27 offset:20480
ds_read_b64_tr_b16 v[190:191], v27 offset:22528
M a[24:27], v[112:115], a[136:139], a[24:27]
s_sub_u32 s39, s39, 1
s_cmp_eq_u32 s39, 0
s_cselect_b32 s3, s64, s65
M a[24:27], v[116:119], a[140:143], a[24:27]
s_add_u32 s25, s25, s3
s_lshl_b32 s3, s3, 3
s_add_u32 s26, s26, s3
M a[28:31], v[124:127], a[140:143], a[28:31]
M a[28:31], v[120:123], a[136:139], a[28:31]
s_waitcnt vmcnt(23) lgkmcnt(0)
s_barrier
M a[0:3], v[160:163], a[144:147], a[0:3]
s_add_u32 m0, s41, 98304
s_nop 0
buffer_load_dwordx4 v2, s[48:51], s26 offen offset:0 lds
ds_read_b64_tr_b16 v[96:97], v24 offset:32768
ds_read_b64_tr_b16 v[98:99], v24 offset:34816
M a[0:3], v[164:167], a[148:151], a[0:3]
buffer_load_dwordx4 v3, s[48:51], s26 offen offset:1024 lds
M a[4:7], v[172:175], a[148:151], a[4:7]
ds_read_b64_tr_b16 v[100:101], v24 offset:36864
ds_read_b64_tr_b16 v[102:103], v24 offset:38912
M a[4:7], v[168:171], a[144:147], a[4:7]
buffer_load_dwordx4 v4, s[48:51], s26 offen offset:2048 lds
ds_read_b64_tr_b16 v[104:105], v25 offset:32768
ds_read_b64_tr_b16 v[106:107], v25 offset:34816
M a[8:11], v[176:179], a[144:147], a[8:11]
buffer_load_dwordx4 v5, s[48:51], s26 offen offset:3072 lds
M a[8:11], v[180:183], a[148:151], a[8:11]
ds_read_b64_tr_b16 v[108:109], v25 offset:36864
ds_read_b64_tr_b16 v[110:111], v25 offset:38912
M a[12:15], v[188:191], a[148:151], a[12:15]
buffer_load_dwordx4 a[224:227], v1, s[44:47], s25 offen offset:0 sc1
M a[12:15], v[184:187], a[144:147], a[12:15]
ds_read_b64_tr_b16 v[112:113], v26 offset:32768
ds_read_b64_tr_b16 v[114:115], v26 offset:34816
buffer_load_dwordx4 a[228:231], v1, s[44:47], s25 offen offset:1024 sc1
M a[16:19], v[160:163], a[152:155], a[16:19]
ds_read_b64_tr_b16 v[116:117], v26 offset:36864
ds_read_b64_tr_b16 v[118:119], v26 offset:38912
M a[16:19], v[164:167], a[156:159], a[16:19]
buffer_load_dwordx4 a[232:235], v1, s[44:47], s25 offen offset:2048 sc1
M a[20:23], v[172:175], a[156:159], a[20:23]
ds_read_b64_tr_b16 v[120:121], v27 offset:32768
ds_read_b64_tr_b16 v[122:123], v27 offset:34816
buffer_load_dwordx4 a[236:239], v1, s[44:47], s25 offen offset:3072 sc1
M a[20:23], v[168:171], a[152:155], a[20:23]
ds_read_b64_tr_b16 v[124:125], v27 offset:36864
ds_read_b64_tr_b16 v[126:127], v27 offset:38912
M a[24:27], v[176:179], a[152:155], a[24:27]
s_sub_u32 s39, s39, 1
s_cmp_eq_u32 s39, 0
s_cselect_b32 s3, s64, s65
M a[24:27], v[180:183], a[156:159], a[24:27]
s_add_u32 s25, s25, s3
s_lshl_b32 s3, s3, 3
s_add_u32 s26, s26, s3
M a[28:31], v[188:191], a[156:159], a[28:31]
M a[28:31], v[184:187], a[152:155], a[28:31]
s_waitcnt vmcnt(25) lgkmcnt(0)
s_barrier
M a[0:3], v[96:99], a[160:163], a[0:3]
s_add_u32 m0, s41, 114688
s_nop 0
buffer_load_dwordx4 v2, s[48:51], s26 offen offset:0 lds
ds_read_b64_tr_b16 v[160:161], v24 offset:49152
ds_read_b64_tr_b16 v[162:163], v24 offset:51200
M a[0:3], v[100:103], a[164:167], a[0:3]
buffer_load_dwordx4 v3, s[48:51], s26 offen offset:1024 lds
M a[4:7], v[108:111], a[164:167], a[4:7]
ds_read_b64_tr_b16 v[164:165], v24 offset:53248
ds_read_b64_tr_b16 v[166:167], v24 offset:55296
M a[4:7], v[104:107], a[160:163], a[4:7]
buffer_load_dwordx4 v4, s[48:51], s26 offen offset:2048 lds
ds_read_b64_tr_b16 v[168:169], v25 offset:49152
ds_read_b64_tr_b16 v[170:171], v25 offset:51200
M a[8:11], v[112:115], a[160:163], a[8:11]
buffer_load_dwordx4 v5, s[48:51], s26 offen offset:3072 lds
M a[8:11], v[116:119], a[164:167], a[8:11]
ds_read_b64_tr_b16 v[172:173], v25 offset:53248
ds_read_b64_tr_b16 v[174:175], v25 offset:55296
M a[12:15], v[124:127], a[164:167], a[12:15]
buffer_load_dwordx4 a[240:243], v1, s[44:47], s25 offen offset:0 sc1
M a[12:15], v[120:123], a[160:163], a[12:15]
ds_read_b64_tr_b16 v[176:177], v26 offset:49152
ds_read_b64_tr_b16 v[178:179], v26 offset:51200
buffer_load_dwordx4 a[244:247], v1, s[44:47], s25 offen offset:1024 sc1
M a[16:19], v[96:99], a[168:171], a[16:19]
ds_read_b64_tr_b16 v[180:181], v26 offset:53248
ds_read_b64_tr_b16 v[182:183], v26 offset:55296
M a[16:19], v[100:103], a[172:175], a[16:19]
buffer_load_dwordx4 a[248:251], v1, s[44:47], s25 offen offset:2048 sc1
M a[20:23], v[108:111], a[172:175], a[20:23]
ds_read_b64_tr_b16 v[184:185], v27 offset:49152
ds_read_b64_tr_b16 v[186:187], v27 offset:51200
buffer_load_dwordx4 a[252:255], v1, s[44:47], s25 offen offset:3072 sc1
M a[20:23], v[104:107], a[168:171], a[20:23]
ds_read_b64_tr_b16 v[188:189], v27 offset:53248
ds_read_b64_tr_b16 v[190:191], v27 offset:55296
M a[24:27], v[112:115], a[168:171], a[24:27]
s_sub_u32 s39, s39, 1
s_cmp_eq_u32 s39, 0
s_cselect_b32 s3, s64, s65
M a[24:27], v[116:119], a[172:175], a[24:27]
s_add_u32 s25, s25, s3
s_lshl_b32 s3, s3, 3
s_add_u32 s26, s26, s3
M a[28:31], v[124:127], a[172:175], a[28:31]
M a[28:31], v[120:123], a[168:171], a[28:31]
s_waitcnt vmcnt(24) lgkmcnt(0)
s_barrier
M a[0:3], v[160:163], a[176:179], a[0:3]
s_add_u32 m0, s41, 0
s_nop 0
buffer_load_dwordx4 v2, s[48:51], s26 offen offset:0 lds
ds_read_b64_tr_b16 v[96:97], v16 offset:0
ds_read_b64_tr_b16 v[98:99], v16 offset:4096
M a[0:3], v[164:167], a[180:183], a[0:3]
buffer_load_dwordx4 v3, s[48:51], s26 offen offset:1024 lds
ds_read_b64_tr_b16 v[100:101], v16 offset:8192
ds_read_b64_tr_b16 v[102:103], v16 offset:12288
M a[4:7], v[172:175], a[180:183], a[4:7]
buffer_load_dwordx4 v4, s[48:51], s26 offen offset:2048 lds
ds_read_b64_tr_b16 v[104:105], v17 offset:0
ds_read_b64_tr_b16 v[106:107], v17 offset:4096
M a[4:7], v[168:171], a[176:179], a[4:7]
buffer_load_dwordx4 v5, s[48:51], s26 offen offset:3072 lds
ds_read_b64_tr_b16 v[108:109], v17 offset:8192
ds_read_b64_tr_b16 v[110:111], v17 offset:12288
M a[8:11], v[176:179], a[176:179], a[8:11]
buffer_load_dwordx4 a[128:131], v1, s[44:47], s25 offen offset:0 sc1
ds_read_b64_tr_b16 v[112:113], v18 offset:0
ds_read_b64_tr_b16 v[114:115], v18 offset:4096
M a[8:11], v[180:183], a[180:183], a[8:11]
buffer_load_dwordx4 a[132:135], v1, s[44:47], s25 offen offset:1024 sc1
ds_read_b64_tr_b16 v[116:117], v18 offset:8192
ds_read_b64_tr_b16 v[118:119], v18 offset:12288
M a[12:15], v[188:191], a[180:183], a[12:15]
buffer_load_dwordx4 a[136:139], v1, s[44:47], s25 offen offset:2048 sc1
M a[12:15], v[184:187], a[176:179], a[12:15]
ds_read_b64_tr_b16 v[120:121], v19 offset:0
ds_read_b64_tr_b16 v[122:123], v19 offset:4096
buffer_load_dwordx4 a[140:143], v1, s[44:47], s25 offen offset:3072 sc1
M a[16:19], v[160:163], a[184:187], a[16:19]
ds_read_b64_tr_b16 v[124:125], v19 offset:8192
ds_read_b64_tr_b16 v[126:127], v19 offset:12288
s_sub_u32 s39, s39, 1
s_cmp_eq_u32 s39, 0
s_cselect_b32 s3, s64, s65
M a[16:19], v[164:167], a[188:191], a[16:19]
ds_read_b64_tr_b16 v[128:129], v20 offset:0
ds_read_b64_tr_b16 v[130:131], v20 offset:4096
s_add_u32 s25, s25, s3
s_lshl_b32 s3, s3, 3
s_add_u32 s26, s26, s3
M a[20:23], v[172:175], a[188:191], a[20:23]
ds_read_b64_tr_b16 v[132:133], v20 offset:8192
ds_read_b64_tr_b16 v[134:135], v20 offset:12288
ds_read_b64_tr_b16 v[136:137], v21 offset:0
ds_read_b64_tr_b16 v[138:139], v21 offset:4096
M a[20:23], v[168:171], a[184:187], a[20:23]
ds_read_b64_tr_b16 v[140:141], v21 offset:8192
ds_read_b64_tr_b16 v[142:143], v21 offset:12288
ds_read_b64_tr_b16 v[144:145], v22 offset:0
ds_read_b64_tr_b16 v[146:147], v22 offset:4096
M a[24:27], v[176:179], a[184:187], a[24:27]
ds_read_b64_tr_b16 v[148:149], v22 offset:8192
ds_read_b64_tr_b16 v[150:151], v22 offset:12288
ds_read_b64_tr_b16 v[152:153], v23 offset:0
ds_read_b64_tr_b16 v[154:155], v23 offset:4096
M a[24:27], v[180:183], a[188:191], a[24:27]
ds_read_b64_tr_b16 v[156:157], v23 offset:8192
ds_read_b64_tr_b16 v[158:159], v23 offset:12288
M a[28:31], v[188:191], a[188:191], a[28:31]
M a[28:31], v[184:187], a[184:187], a[28:31]
s_waitcnt vmcnt(24) lgkmcnt(0)
s_barrier
M v[32:35], v[96:99], a[192:195], 0
s_add_u32 m0, s41, 16384
s_nop 0
buffer_load_dwordx4 v2, s[48:51], s26 offen offset:0 lds
M v[32:35], v[100:103], a[196:199], v[32:35]
ds_read_b64_tr_b16 v[160:161], v16 offset:16384
ds_read_b64_tr_b16 v[162:163], v16 offset:20480
M v[36:39], v[108:111], a[196:199], 0
buffer_load_dwordx4 v3, s[48:51], s26 offen offset:1024 lds
M v[36:39], v[104:107], a[192:195], v[36:39]
ds_read_b64_tr_b16 v[164:165], v16 offset:24576
ds_read_b64_tr_b16 v[166:167], v16 offset:28672
M v[40:43], v[112:115], a[192:195], 0
buffer_load_dwordx4 v4, s[48:51], s26 offen offset:2048 lds
M v[40:43], v[116:119], a[196:199], v[40:43]
ds_read_b64_tr_b16 v[168:169], v17 offset:16384
ds_read_b64_tr_b16 v[170:171], v17 offset:20480
M v[44:47], v[124:127], a[196:199], 0
buffer_load_dwordx4 v5, s[48:51], s26 offen offset:3072 lds
M v[44:47], v[120:123], a[192:195], v[44:47]
M v[48:51], v[128:131], a[192:195], 0
ds_read_b64_tr_b16 v[172:173], v17 offset:24576
ds_read_b64_tr_b16 v[174:175], v17 offset:28672
M v[48:51], v[132:135], a[196:199], v[48:51]
buffer_load_dwordx4 a[144:147], v1, s[44:47], s25 offen offset:0 sc1
M v[52:55], v[140:143], a[196:199], 0
ds_read_b64_tr_b16 v[176:177], v18 offset:16384
ds_read_b64_tr_b16 v[178:179], v18 offset:20480
M v[52:55], v[136:139], a[192:195], v[52:55]
buffer_load_dwordx4 a[148:151], v1, s[44:47], s25 offen offset:1024 sc1
M v[56:59], v[144:147], a[192:195], 0
ds_read_b64_tr_b16 v[180:181], v18 offset:24576
ds_read_b64_tr_b16 v[182:183], v18 offset:28672
M v[56:59], v[148:151], a[196:199], v[56:59]
buffer_load_dwordx4 a[152:155], v1, s[44:47], s25 offen offset:2048 sc1
M v[60:63], v[156:159], a[196:199], 0
M v[60:63], v[152:155], a[192:195], v[60:63]
ds_read_b64_tr_b16 v[184:185], v19 offset:16384
ds_read_b64_tr_b16 v[186:187], v19 offset:20480
M v[64:67], v[96:99], a[200:203], 0
buffer_load_dwordx4 a[156:159], v1, s[44:47], s25 offen offset:3072 sc1
M v[64:67], v[100:103], a[204:207], v[64:67]
ds_read_b64_tr_b16 v[188:189], v19 offset:24576
ds_read_b64_tr_b16 v[190:191], v19 offset:28672
M v[68:71], v[108:111], a[204:207], 0
s_sub_u32 s39, s39, 1
s_cmp_eq_u32 s39, 0
s_cselect_b32 s3, s64, s65
M v[68:71], v[104:107], a[200:203], v[68:71]
ds_read_b64_tr_b16 v[192:193], v20 offset:16384
ds_read_b64_tr_b16 v[194:195], v20 offset:20480
M v[72:75], v[112:115], a[200:203], 0
s_add_u32 s25, s25, s3
s_lshl_b32 s3, s3, 3
s_add_u32 s26, s26, s3
M v[72:75], v[116:119], a[204:207], v[72:75]
ds_read_b64_tr_b16 v[196:197], v20 offset:24576
ds_read_b64_tr_b16 v[198:199], v20 offset:28672
M v[76:79], v[124:127], a[204:207], 0
M v[76:79], v[120:123], a[200:203], v[76:79]
ds_read_b64_tr_b16 v[200:201], v21 offset:16384
ds_read_b64_tr_b16 v[202:203], v21 offset:20480
M v[80:83], v[128:131], a[200:203], 0
ds_read_b64_tr_b16 v[204:205], v21 offset:24576
ds_read_b64_tr_b16 v[206:207], v21 offset:28672
M v[80:83], v[132:135], a[204:207], v[80:83]
ds_read_b64_tr_b16 v[208:209], v22 offset:16384
ds_read_b64_tr_b16 v[210:211], v22 offset:20480
M v[84:87], v[140:143], a[204:207], 0
ds_read_b64_tr_b16 v[212:213], v22 offset:24576
ds_read_b64_tr_b16 v[214:215], v22 offset:28672
M v[84:87], v[136:139], a[200:203], v[84:87]
ds_read_b64_tr_b16 v[216:217], v23 offset:16384
ds_read_b64_tr_b16 v[218:219], v23 offset:20480
M v[88:91], v[144:147], a[200:203], 0
ds_read_b64_tr_b16 v[220:221], v23 offset:24576
ds_read_b64_tr_b16 v[222:223], v23 offset:28672
M v[88:91], v[148:151], a[204:207], v[88:91]
M v[92:95], v[156:159], a[204:207], 0
M v[92:95], v[152:155], a[200:203], v[92:95]
s_mov_b32 s28, 3
Lk3_la:
s_waitcnt vmcnt(24) lgkmcnt(0)
s_barrier
M v[32:35], v[160:163], a[208:211], v[32:35]
s_add_u32 m0, s41, 32768
s_nop 0
buffer_load_dwordx4 v2, s[48:51], s26 offen offset:0 lds
M v[32:35], v[164:167], a[212:215], v[32:35]
ds_read_b64_tr_b16 v[96:97], v16 offset:32768
ds_read_b64_tr_b16 v[98:99], v16 offset:36864
M v[36:39], v[172:175], a[212:215], v[36:39]
buffer_load_dwordx4 v3, s[48:51], s26 offen offset:1024 lds
M v[36:39], v[168:171], a[208:211], v[36:39]
ds_read_b64_tr_b16 v[100:101], v16 offset:40960
ds_read_b64_tr_b16 v[102:103], v16 offset:45056
M v[40:43], v[176:179], a[208:211], v[40:43]
buffer_load_dwordx4 v4, s[48:51], s26 offen offset:2048 lds
M v[40:43], v[180:183], a[212:215], v[40:43]
ds_read_b64_tr_b16 v[104:105], v17 offset:32768
ds_read_b64_tr_b16 v[106:107], v17 offset:36864
M v[44:47], v[188:191], a[212:215], v[44:47]
buffer_load_dwordx4 v5, s[48:51], s26 offen offset:3072 lds
M v[44:47], v[184:187], a[208:211], v[44:47]
M v[48:51], v[192:195], a[208:211], v[48:51]
ds_read_b64_tr_b16 v[108:109], v17 offset:40960
ds_read_b64_tr_b16 v[110:111], v17 offset:45056
M v[48:51], v[196:199], a[212:215], v[48:51]
buffer_load_dwordx4 a[160:163], v1, s[44:47], s25 offen offset:0 sc1
M v[52:55], v[204:207], a[212:215], v[52:55]
ds_read_b64_tr_b16 v[112:113], v18 offset:32768
ds_read_b64_tr_b16 v[114:115], v18 offset:36864
M v[52:55], v[200:203], a[208:211], v[52:55]
buffer_load_dwordx4 a[164:167], v1, s[44:47], s25 offen offset:1024 sc1
M v[56:59], v[208:211], a[208:211], v[56:59]
ds_read_b64_tr_b16 v[116:117], v18 offset:40960
ds_read_b64_tr_b16 v[118:119], v18 offset:45056
M v[56:59], v[212:215], a[212:215], v[56:59]
buffer_load_dwordx4 a[168:171], v1, s[44:47], s25 offen offset:2048 sc1
M v[60:63], v[220:223], a[212:215], v[60:63]
M v[60:63], v[216:219], a[208:211], v[60:63]
ds_read_b64_tr_b16 v[120:121], v19 offset:32768
ds_read_b64_tr_b16 v[122:123], v19 offset:36864
M v[64:67], v[160:163], a[216:219], v[64:67]
buffer_load_dwordx4 a[172:175], v1, s[44:47], s25 offen offset:3072 sc1
M v[64:67], v[164:167], a[220:223], v[64:67]
ds_read_b64_tr_b16 v[124:125], v19 offset:40960
ds_read_b64_tr_b16 v[126:127], v19 offset:45056
M v[68:71], v[172:175], a[220:223], v[68:71]
s_sub_u32 s39, s39, 1
s_cmp_eq_u32 s39, 0
s_cselect_b32 s3, s64, s65
M v[68:71], v[168:171], a[216:219], v[68:71]
ds_read_b64_tr_b16 v[128:129], v20 offset:32768
ds_read_b64_tr_b16 v[130:131], v20 offset:36864
M v[72:75], v[176:179], a[216:219], v[72:75]
s_add_u32 s25, s25, s3
s_lshl_b32 s3, s3, 3
s_add_u32 s26, s26, s3
M v[72:75], v[180:183], a[220:223], v[72:75]
ds_read_b64_tr_b16 v[132:133], v20 offset:40960
ds_read_b64_tr_b16 v[134:135], v20 offset:45056
M v[76:79], v[188:191], a[220:223], v[76:79]
M v[76:79], v[184:187], a[216:219], v[76:79]
ds_read_b64_tr_b16 v[136:137], v21 offset:32768
ds_read_b64_tr_b16 v[138:139], v21 offset:36864
M v[80:83], v[192:195], a[216:219], v[80:83]
ds_read_b64_tr_b16 v[140:141], v21 offset:40960
ds_read_b64_tr_b16 v[142:143], v21 offset:45056
M v[80:83], v[196:199], a[220:223], v[80:83]
ds_read_b64_tr_b16 v[144:145], v22 offset:32768
ds_read_b64_tr_b16 v[146:147], v22 offset:36864
M v[84:87], v[204:207], a[220:223], v[84:87]
ds_read_b64_tr_b16 v[148:149], v22 offset:40960
ds_read_b64_tr_b16 v[150:151], v22 offset:45056
M v[84:87], v[200:203], a[216:219], v[84:87]
ds_read_b64_tr_b16 v[152:153], v23 offset:32768
ds_read_b64_tr_b16 v[154:155], v23 offset:36864
M v[88:91], v[208:211], a[216:219], v[88:91]
ds_read_b64_tr_b16 v[156:157], v23 offset:40960
ds_read_b64_tr_b16 v[158:159], v23 offset:45056
M v[88:91], v[212:215], a[220:223], v[88:91]
M v[92:95], v[220:223], a[220:223], v[92:95]
M v[92:95], v[216:219], a[216:219], v[92:95]
s_waitcnt vmcnt(24) lgkmcnt(0)
s_barrier
M v[32:35], v[96:99], a[224:227], v[32:35]
s_add_u32 m0, s41, 49152
s_nop 0
buffer_load_dwordx4 v2, s[48:51], s26 offen offset:0 lds
M v[32:35], v[100:103], a[228:231], v[32:35]
ds_read_b64_tr_b16 v[160:161], v16 offset:49152
ds_read_b64_tr_b16 v[162:163], v16 offset:53248
M v[36:39], v[108:111], a[228:231], v[36:39]
buffer_load_dwordx4 v3, s[48:51], s26 offen offset:1024 lds
M v[36:39], v[104:107], a[224:227], v[36:39]
ds_read_b64_tr_b16 v[164:165], v16 offset:57344
ds_read_b64_tr_b16 v[166:167], v16 offset:61440
M v[40:43], v[112:115], a[224:227], v[40:43]
buffer_load_dwordx4 v4, s[48:51], s26 offen offset:2048 lds
M v[40:43], v[116:119], a[228:231], v[40:43]
ds_read_b64_tr_b16 v[168:169], v17 offset:49152
ds_read_b64_tr_b16 v[170:171], v17 offset:53248
M v[44:47], v[124:127], a[228:231], v[44:47]
buffer_load_dwordx4 v5, s[48:51], s26 offen offset:3072 lds
M v[44:47], v[120:123], a[224:227], v[44:47]
M v[48:51], v[128:131], a[224:227], v[48:51]
ds_read_b64_tr_b16 v[172:173], v17 offset:57344
ds_read_b64_tr_b16 v[174:175], v17 offset:61440
M v[48:51], v[132:135], a[228:231], v[48:51]
buffer_load_dwordx4 a[176:179], v1, s[44:47], s25 offen offset:0 sc1
M v[52:55], v[140:143], a[228:231], v[52:55]
ds_read_b64_tr_b16 v[176:177], v18 offset:49152
ds_read_b64_tr_b16 v[178:179], v18 offset:53248
M v[52:55], v[136:139], a[224:227], v[52:55]
buffer_load_dwordx4 a[180:183], v1, s[44:47], s25 offen offset:1024 sc1
M v[56:59], v[144:147], a[224:227], v[56:59]
ds_read_b64_tr_b16 v[180:181], v18 offset:57344
ds_read_b64_tr_b16 v[182:183], v18 offset:61440
M v[56:59], v[148:151], a[228:231], v[56:59]
buffer_load_dwordx4 a[184:187], v1, s[44:47], s25 offen offset:2048 sc1
M v[60:63], v[156:159], a[228:231], v[60:63]
M v[60:63], v[152:155], a[224:227], v[60:63]
ds_read_b64_tr_b16 v[184:185], v19 offset:49152
ds_read_b64_tr_b16 v[186:187], v19 offset:53248
M v[64:67], v[96:99], a[232:235], v[64:67]
buffer_load_dwordx4 a[188:191], v1, s[44:47], s25 offen offset:3072 sc1
M v[64:67], v[100:103], a[236:239], v[64:67]
ds_read_b64_tr_b16 v[188:189], v19 offset:57344
ds_read_b64_tr_b16 v[190:191], v19 offset:61440
M v[68:71], v[108:111], a[236:239], v[68:71]
s_sub_u32 s39, s39, 1
s_cmp_eq_u32 s39, 0
s_cselect_b32 s3, s64, s65
M v[68:71], v[104:107], a[232:235], v[68:71]
ds_read_b64_tr_b16 v[192:193], v20 offset:49152
ds_read_b64_tr_b16 v[194:195], v20 offset:53248
M v[72:75], v[112:115], a[232:235], v[72:75]
s_add_u32 s25, s25, s3
s_lshl_b32 s3, s3, 3
s_add_u32 s26, s26, s3
M v[72:75], v[116:119], a[236:239], v[72:75]
ds_read_b64_tr_b16 v[196:197], v20 offset:57344
ds_read_b64_tr_b16 v[198:199], v20 offset:61440
M v[76:79], v[124:127], a[236:239], v[76:79]
M v[76:79], v[120:123], a[232:235], v[76:79]
ds_read_b64_tr_b16 v[200:201], v21 offset:49152
ds_read_b64_tr_b16 v[202:203], v21 offset:53248
M v[80:83], v[128:131], a[232:235], v[80:83]
ds_read_b64_tr_b16 v[204:205], v21 offset:57344
ds_read_b64_tr_b16 v[206:207], v21 offset:61440
M v[80:83], v[132:135], a[236:239], v[80:83]
ds_read_b64_tr_b16 v[208:209], v22 offset:49152
ds_read_b64_tr_b16 v[210:211], v22 offset:53248
M v[84:87], v[140:143], a[236:239], v[84:87]
ds_read_b64_tr_b16 v[212:213], v22 offset:57344
ds_read_b64_tr_b16 v[214:215], v22 offset:61440
M v[84:87], v[136:139], a[232:235], v[84:87]
ds_read_b64_tr_b16 v[216:217], v23 offset:49152
ds_read_b64_tr_b16 v[218:219], v23 offset:53248
M v[88:91], v[144:147], a[232:235], v[88:91]
ds_read_b64_tr_b16 v[220:221], v23 offset:57344
ds_read_b64_tr_b16 v[222:223], v23 offset:61440
M v[88:91], v[148:151], a[236:239], v[88:91]
M v[92:95], v[156:159], a[236:239], v[92:95]
M v[92:95], v[152:155], a[232:235], v[92:95]
s_waitcnt vmcnt(24) lgkmcnt(0)
s_barrier
M v[32:35], v[160:163], a[240:243], v[32:35]
s_add_u32 m0, s41, 65536
s_nop 0
buffer_load_dwordx4 v2, s[48:51], s26 offen offset:0 lds
M v[32:35], v[164:167], a[244:247], v[32:35]
ds_read_b64_tr_b16 v[96:97], v8 offset:0
ds_read_b64_tr_b16 v[98:99], v8 offset:4096
M v[36:39], v[172:175], a[244:247], v[36:39]
buffer_load_dwordx4 v3, s[48:51], s26 offen offset:1024 lds
M v[36:39], v[168:171], a[240:243], v[36:39]
ds_read_b64_tr_b16 v[100:101], v8 offset:8192
ds_read_b64_tr_b16 v[102:103], v8 offset:12288
M v[40:43], v[176:179], a[240:243], v[40:43]
buffer_load_dwordx4 v4, s[48:51], s26 offen offset:2048 lds
M v[40:43], v[180:183], a[244:247], v[40:43]
ds_read_b64_tr_b16 v[104:105], v9 offset:0
ds_read_b64_tr_b16 v[106:107], v9 offset:4096
M v[44:47], v[188:191], a[244:247], v[44:47]
buffer_load_dwordx4 v5, s[48:51], s26 offen offset:3072 lds
M v[44:47], v[184:187], a[240:243], v[44:47]
M v[48:51], v[192:195], a[240:243], v[48:51]
ds_read_b64_tr_b16 v[108:109], v9 offset:8192
ds_read_b64_tr_b16 v[110:111], v9 offset:12288
M v[48:51], v[196:199], a[244:247], v[48:51]
buffer_load_dwordx4 a[192:195], v1, s[44:47], s25 offen offset:0 sc1
M v[52:55], v[204:207], a[244:247], v[52:55]
ds_read_b64_tr_b16 v[112:113], v10 offset:0
ds_read_b64_tr_b16 v[114:115], v10 offset:4096
M v[52:55], v[200:203], a[240:243], v[52:55]
buffer_load_dwordx4 a[196:199], v1, s[44:47], s25 offen offset:1024 sc1
M v[56:59], v[208:211], a[240:243], v[56:59]
ds_read_b64_tr_b16 v[116:117], v10 offset:8192
ds_read_b64_tr_b16 v[118:119], v10 offset:12288
M v[56:59], v[212:215], a[244:247], v[56:59]
buffer_load_dwordx4 a[200:203], v1, s[44:47], s25 offen offset:2048 sc1
M v[60:63], v[220:223], a[244:247], v[60:63]
M v[60:63], v[216:219], a[240:243], v[60:63]
ds_read_b64_tr_b16 v[120:121], v11 offset:0
ds_read_b64_tr_b16 v[122:123], v11 offset:4096
M v[64:67], v[160:163], a[248:251], v[64:67]
buffer_load_dwordx4 a[204:207], v1, s[44:47], s25 offen offset:3072 sc1
M v[64:67], v[164:167], a[252:255], v[64:67]
ds_read_b64_tr_b16 v[124:125], v11 offset:8192
ds_read_b64_tr_b16 v[126:127], v11 offset:12288
M v[68:71], v[172:175], a[252:255], v[68:71]
s_sub_u32 s39, s39, 1
s_cmp_eq_u32 s39, 0
s_cselect_b32 s3, s64, s65
M v[68:71], v[168:171], a[248:251], v[68:71]
ds_read_b64_tr_b16 v[128:129], v12 offset:0
ds_read_b64_tr_b16 v[130:131], v12 offset:4096
M v[72:75], v[176:179], a[248:251], v[72:75]
s_add_u32 s25, s25, s3
s_lshl_b32 s3, s3, 3
s_add_u32 s26, s26, s3
M v[72:75], v[180:183], a[252:255], v[72:75]
ds_read_b64_tr_b16 v[132:133], v12 offset:8192
ds_read_b64_tr_b16 v[134:135], v12 offset:12288
M v[76:79], v[188:191], a[252:255], v[76:79]
M v[76:79], v[184:187], a[248:251], v[76:79]
ds_read_b64_tr_b16 v[136:137], v13 offset:0
ds_read_b64_tr_b16 v[138:139], v13 offset:4096
M v[80:83], v[192:195], a[248:251], v[80:83]
ds_read_b64_tr_b16 v[140:141], v13 offset:8192
ds_read_b64_tr_b16 v[142:143], v13 offset:12288
M v[80:83], v[196:199], a[252:255], v[80:83]
ds_read_b64_tr_b16 v[144:145], v14 offset:0
ds_read_b64_tr_b16 v[146:147], v14 offset:4096
M v[84:87], v[204:207], a[252:255], v[84:87]
ds_read_b64_tr_b16 v[148:149], v14 offset:8192
ds_read_b64_tr_b16 v[150:151], v14 offset:12288
M v[84:87], v[200:203], a[248:251], v[84:87]
ds_read_b64_tr_b16 v[152:153], v15 offset:0
ds_read_b64_tr_b16 v[154:155], v15 offset:4096
M v[88:91], v[208:211], a[248:251], v[88:91]
ds_read_b64_tr_b16 v[156:157], v15 offset:8192
ds_read_b64_tr_b16 v[158:159], v15 offset:12288
M v[88:91], v[212:215], a[252:255], v[88:91]
M v[92:95], v[220:223], a[252:255], v[92:95]
M v[92:95], v[216:219], a[248:251], v[92:95]
s_waitcnt vmcnt(24) lgkmcnt(0)
s_barrier
M v[32:35], v[96:99], a[128:131], v[32:35]
s_add_u32 m0, s41, 81920
s_nop 0
buffer_load_dwordx4 v2, s[48:51], s26 offen offset:0 lds
M v[32:35], v[100:103], a[132:135], v[32:35]
ds_read_b64_tr_b16 v[160:161], v8 offset:16384
ds_read_b64_tr_b16 v[162:163], v8 offset:20480
M v[36:39], v[108:111], a[132:135], v[36:39]
buffer_load_dwordx4 v3, s[48:51], s26 offen offset:1024 lds
M v[36:39], v[104:107], a[128:131], v[36:39]
ds_read_b64_tr_b16 v[164:165], v8 offset:24576
ds_read_b64_tr_b16 v[166:167], v8 offset:28672
M v[40:43], v[112:115], a[128:131], v[40:43]
buffer_load_dwordx4 v4, s[48:51], s26 offen offset:2048 lds
M v[40:43], v[116:119], a[132:135], v[40:43]
ds_read_b64_tr_b16 v[168:169], v9 offset:16384
ds_read_b64_tr_b16 v[170:171], v9 offset:20480
M v[44:47], v[124:127], a[132:135], v[44:47]
buffer_load_dwordx4 v5, s[48:51], s26 offen offset:3072 lds
M v[44:47], v[120:123], a[128:131], v[44:47]
M v[48:51], v[128:131], a[128:131], v[48:51]
ds_read_b64_tr_b16 v[172:173], v9 offset:24576
ds_read_b64_tr_b16 v[174:175], v9 offset:28672
M v[48:51], v[132:135], a[132:135], v[48:51]
buffer_load_dwordx4 a[208:211], v1, s[44:47], s25 offen offset:0 sc1
M v[52:55], v[140:143], a[132:135], v[52:55]
ds_read_b64_tr_b16 v[176:177], v10 offset:16384
ds_read_b64_tr_b16 v[178:179], v10 offset:20480
M v[52:55], v[136:139], a[128:131], v[52:55]
buffer_load_dwordx4 a[212:215], v1, s[44:47], s25 offen offset:1024 sc1
M v[56:59], v[144:147], a[128:131], v[56:59]
ds_read_b64_tr_b16 v[180:181], v10 offset:24576
ds_read_b64_tr_b16 v[182:183], v10 offset:28672
M v[56:59], v[148:151], a[132:135], v[56:59]
buffer_load_dwordx4 a[216:219], v1, s[44:47], s25 offen offset:2048 sc1
M v[60:63], v[156:159], a[132:135], v[60:63]
M v[60:63], v[152:155], a[128:131], v[60:63]
ds_read_b64_tr_b16 v[184:185], v11 offset:16384
ds_read_b64_tr_b16 v[186:187], v11 offset:20480
M v[64:67], v[96:99], a[136:139], v[64:67]
buffer_load_dwordx4 a[220:223], v1, s[44:47], s25 offen offset:3072 sc1
M v[64:67], v[100:103], a[140:143], v[64:67]
ds_read_b64_tr_b16 v[188:189], v11 offset:24576
ds_read_b64_tr_b16 v[190:191], v11 offset:28672
M v[68:71], v[108:111], a[140:143], v[68:71]
s_sub_u32 s39, s39, 1
s_cmp_eq_u32 s39, 0
s_cselect_b32 s3, s64, s65
M v[68:71], v[104:107], a[136:139], v[68:71]
ds_read_b64_tr_b16 v[192:193], v12 offset:16384
ds_read_b64_tr_b16 v[194:195], v12 offset:20480
M v[72:75], v[112:115], a[136:139], v[72:75]
s_add_u32 s25, s25, s3
s_lshl_b32 s3, s3, 3
s_add_u32 s26, s26, s3
M v[72:75], v[116:119], a[140:143], v[72:75]
ds_read_b64_tr_b16 v[196:197], v12 offset:24576
ds_read_b64_tr_b16 v[198:199], v12 offset:28672
M v[76:79], v[124:127], a[140:143], v[76:79]
M v[76:79], v[120:123], a[136:139], v[76:79]
ds_read_b64_tr_b16 v[200:201], v13 offset:16384
ds_read_b64_tr_b16 v[202:203], v13 offset:20480
M v[80:83], v[128:131], a[136:139], v[80:83]
ds_read_b64_tr_b16 v[204:205], v13 offset:24576
ds_read_b64_tr_b16 v[206:207], v13 offset:28672
M v[80:83], v[132:135], a[140:143], v[80:83]
ds_read_b64_tr_b16 v[208:209], v14 offset:16384
ds_read_b64_tr_b16 v[210:211], v14 offset:20480
M v[84:87], v[140:143], a[140:143], v[84:87]
ds_read_b64_tr_b16 v[212:213], v14 offset:24576
ds_read_b64_tr_b16 v[214:215], v14 offset:28672
M v[84:87], v[136:139], a[136:139], v[84:87]
ds_read_b64_tr_b16 v[216:217], v15 offset:16384
ds_read_b64_tr_b16 v[218:219], v15 offset:20480
M v[88:91], v[144:147], a[136:139], v[88:91]
ds_read_b64_tr_b16 v[220:221], v15 offset:24576
ds_read_b64_tr_b16 v[222:223], v15 offset:28672
M v[88:91], v[148:151], a[140:143], v[88:91]
M v[92:95], v[156:159], a[140:143], v[92:95]
M v[92:95], v[152:155], a[136:139], v[92:95]
s_waitcnt vmcnt(24) lgkmcnt(0)
s_barrier
M v[32:35], v[160:163], a[144:147], v[32:35]
s_add_u32 m0, s41, 98304
s_nop 0
buffer_load_dwordx4 v2, s[48:51], s26 offen offset:0 lds
M v[32:35], v[164:167], a[148:151], v[32:35]
ds_read_b64_tr_b16 v[96:97], v8 offset:32768
ds_read_b64_tr_b16 v[98:99], v8 offset:36864
M v[36:39], v[172:175], a[148:151], v[36:39]
buffer_load_dwordx4 v3, s[48:51], s26 offen offset:1024 lds
M v[36:39], v[168:171], a[144:147], v[36:39]
ds_read_b64_tr_b16 v[100:101], v8 offset:40960
ds_read_b64_tr_b16 v[102:103], v8 offset:45056
M v[40:43], v[176:179], a[144:147], v[40:43]
buffer_load_dwordx4 v4, s[48:51], s26 offen offset:2048 lds
M v[40:43], v[180:183], a[148:151], v[40:43]
ds_read_b64_tr_b16 v[104:105], v9 offset:32768
ds_read_b64_tr_b16 v[106:107], v9 offset:36864
M v[44:47], v[188:191], a[148:151], v[44:47]
buffer_load_dwordx4 v5, s[48:51], s26 offen offset:3072 lds
M v[44:47], v[184:187], a[144:147], v[44:47]
M v[48:51], v[192:195], a[144:147], v[48:51]
ds_read_b64_tr_b16 v[108:109], v9 offset:40960
ds_read_b64_tr_b16 v[110:111], v9 offset:45056
M v[48:51], v[196:199], a[148:151], v[48:51]
buffer_load_dwordx4 a[224:227], v1, s[44:47], s25 offen offset:0 sc1
M v[52:55], v[204:207], a[148:151], v[52:55]
ds_read_b64_tr_b16 v[112:113], v10 offset:32768
ds_read_b64_tr_b16 v[114:115], v10 offset:36864
M v[52:55], v[200:203], a[144:147], v[52:55]
buffer_load_dwordx4 a[228:231], v1, s[44:47], s25 offen offset:1024 sc1
M v[56:59], v[208:211], a[144:147], v[56:59]
ds_read_b64_tr_b16 v[116:117], v10 offset:40960
ds_read_b64_tr_b16 v[118:119], v10 offset:45056
M v[56:59], v[212:215], a[148:151], v[56:59]
buffer_load_dwordx4 a[232:235], v1, s[44:47], s25 offen offset:2048 sc1
M v[60:63], v[220:223], a[148:151], v[60:63]
M v[60:63], v[216:219], a[144:147], v[60:63]
ds_read_b64_tr_b16 v[120:121], v11 offset:32768
ds_read_b64_tr_b16 v[122:123], v11 offset:36864
M v[64:67], v[160:163], a[152:155], v[64:67]
buffer_load_dwordx4 a[236:239], v1, s[44:47], s25 offen offset:3072 sc1
M v[64:67], v[164:167], a[156:159], v[64:67]
ds_read_b64_tr_b16 v[124:125], v11 offset:40960
ds_read_b64_tr_b16 v[126:127], v11 offset:45056
M v[68:71], v[172:175], a[156:159], v[68:71]
s_sub_u32 s39, s39, 1
s_cmp_eq_u32 s39, 0
s_cselect_b32 s3, s64, s65
M v[68:71], v[168:171], a[152:155], v[68:71]
ds_read_b64_tr_b16 v[128:129], v12 offset:32768
ds_read_b64_tr_b16 v[130:131], v12 offset:36864
M v[72:75], v[176:179], a[152:155], v[72:75]
s_add_u32 s25, s25, s3
s_lshl_b32 s3, s3, 3
s_add_u32 s26, s26, s3
M v[72:75], v[180:183], a[156:159], v[72:75]
ds_read_b64_tr_b16 v[132:133], v12 offset:40960
ds_read_b64_tr_b16 v[134:135], v12 offset:45056
M v[76:79], v[188:191], a[156:159], v[76:79]
M v[76:79], v[184:187], a[152:155], v[76:79]
ds_read_b64_tr_b16 v[136:137], v13 offset:32768
ds_read_b64_tr_b16 v[138:139], v13 offset:36864
M v[80:83], v[192:195], a[152:155], v[80:83]
ds_read_b64_tr_b16 v[140:141], v13 offset:40960
ds_read_b64_tr_b16 v[142:143], v13 offset:45056
M v[80:83], v[196:199], a[156:159], v[80:83]
ds_read_b64_tr_b16 v[144:145], v14 offset:32768
ds_read_b64_tr_b16 v[146:147], v14 offset:36864
M v[84:87], v[204:207], a[156:159], v[84:87]
ds_read_b64_tr_b16 v[148:149], v14 offset:40960
ds_read_b64_tr_b16 v[150:151], v14 offset:45056
M v[84:87], v[200:203], a[152:155], v[84:87]
ds_read_b64_tr_b16 v[152:153], v15 offset:32768
ds_read_b64_tr_b16 v[154:155], v15 offset:36864
M v[88:91], v[208:211], a[152:155], v[88:91]
ds_read_b64_tr_b16 v[156:157], v15 offset:40960
ds_read_b64_tr_b16 v[158:159], v15 offset:45056
M v[88:91], v[212:215], a[156:159], v[88:91]
M v[92:95], v[220:223], a[156:159], v[92:95]
M v[92:95], v[216:219], a[152:155], v[92:95]
s_waitcnt vmcnt(24) lgkmcnt(0)
s_barrier
M v[32:35], v[96:99], a[160:163], v[32:35]
s_add_u32 m0, s41, 114688
s_nop 0
buffer_load_dwordx4 v2, s[48:51], s26 offen offset:0 lds
M v[32:35], v[100:103], a[164:167], v[32:35]
ds_read_b64_tr_b16 v[160:161], v8 offset:49152
ds_read_b64_tr_b16 v[162:163], v8 offset:53248
M v[36:39], v[108:111], a[164:167], v[36:39]
buffer_load_dwordx4 v3, s[48:51], s26 offen offset:1024 lds
M v[36:39], v[104:107], a[160:163], v[36:39]
ds_read_b64_tr_b16 v[164:165], v8 offset:57344
ds_read_b64_tr_b16 v[166:167], v8 offset:61440
M v[40:43], v[112:115], a[160:163], v[40:43]
buffer_load_dwordx4 v4, s[48:51], s26 offen offset:2048 lds
M v[40:43], v[116:119], a[164:167], v[40:43]
ds_read_b64_tr_b16 v[168:169], v9 offset:49152
ds_read_b64_tr_b16 v[170:171], v9 offset:53248
M v[44:47], v[124:127], a[164:167], v[44:47]
buffer_load_dwordx4 v5, s[48:51], s26 offen offset:3072 lds
M v[44:47], v[120:123], a[160:163], v[44:47]
M v[48:51], v[128:131], a[160:163], v[48:51]
ds_read_b64_tr_b16 v[172:173], v9 offset:57344
ds_read_b64_tr_b16 v[174:175], v9 offset:61440
M v[48:51], v[132:135], a[164:167], v[48:51]
buffer_load_dwordx4 a[240:243], v1, s[44:47], s25 offen offset:0 sc1
M v[52:55], v[140:143], a[164:167], v[52:55]
ds_read_b64_tr_b16 v[176:177], v10 offset:49152
ds_read_b64_tr_b16 v[178:179], v10 offset:53248
M v[52:55], v[136:139], a[160:163], v[52:55]
buffer_load_dwordx4 a[244:247], v1, s[44:47], s25 offen offset:1024 sc1
M v[56:59], v[144:147], a[160:163], v[56:59]
ds_read_b64_tr_b16 v[180:181], v10 offset:57344
ds_read_b64_tr_b16 v[182:183], v10 offset:61440
M v[56:59], v[148:151], a[164:167], v[56:59]
buffer_load_dwordx4 a[248:251], v1, s[44:47], s25 offen offset:2048 sc1
M v[60:63], v[156:159], a[164:167], v[60:63]
M v[60:63], v[152:155], a[160:163], v[60:63]
ds_read_b64_tr_b16 v[184:185], v11 offset:49152
ds_read_b64_tr_b16 v[186:187], v11 offset:53248
M v[64:67], v[96:99], a[168:171], v[64:67]
buffer_load_dwordx4 a[252:255], v1, s[44:47], s25 offen offset:3072 sc1
M v[64:67], v[100:103], a[172:175], v[64:67]
ds_read_b64_tr_b16 v[188:189], v11 offset:57344
ds_read_b64_tr_b16 v[190:191], v11 offset:61440
M v[68:71], v[108:111], a[172:175], v[68:71]
s_sub_u32 s39, s39, 1
s_cmp_eq_u32 s39, 0
s_cselect_b32 s3, s64, s65
M v[68:71], v[104:107], a[168:171], v[68:71]
ds_read_b64_tr_b16 v[192:193], v12 offset:49152
ds_read_b64_tr_b16 v[194:195], v12 offset:53248
M v[72:75], v[112:115], a[168:171], v[72:75]
s_add_u32 s25, s25, s3
s_lshl_b32 s3, s3, 3
s_add_u32 s26, s26, s3
M v[72:75], v[116:119], a[172:175], v[72:75]
ds_read_b64_tr_b16 v[196:197], v12 offset:57344
ds_read_b64_tr_b16 v[198:199], v12 offset:61440
M v[76:79], v[124:127], a[172:175], v[76:79]
M v[76:79], v[120:123], a[168:171], v[76:79]
ds_read_b64_tr_b16 v[200:201], v13 offset:49152
ds_read_b64_tr_b16 v[202:203], v13 offset:53248
M v[80:83], v[128:131], a[168:171], v[80:83]
ds_read_b64_tr_b16 v[204:205], v13 offset:57344
ds_read_b64_tr_b16 v[206:207], v13 offset:61440
M v[80:83], v[132:135], a[172:175], v[80:83]
ds_read_b64_tr_b16 v[208:209], v14 offset:49152
ds_read_b64_tr_b16 v[210:211], v14 offset:53248
M v[84:87], v[140:143], a[172:175], v[84:87]
ds_read_b64_tr_b16 v[212:213], v14 offset:57344
ds_read_b64_tr_b16 v[214:215], v14 offset:61440
M v[84:87], v[136:139], a[168:171], v[84:87]
ds_read_b64_tr_b16 v[216:217], v15 offset:49152
ds_read_b64_tr_b16 v[218:219], v15 offset:53248
M v[88:91], v[144:147], a[168:171], v[88:91]
ds_read_b64_tr_b16 v[220:221], v15 offset:57344
ds_read_b64_tr_b16 v[222:223], v15 offset:61440
M v[88:91], v[148:151], a[172:175], v[88:91]
M v[92:95], v[156:159], a[172:175], v[92:95]
M v[92:95], v[152:155], a[168:171], v[92:95]
s_waitcnt vmcnt(24) lgkmcnt(0)
s_barrier
M v[32:35], v[160:163], a[176:179], v[32:35]
s_add_u32 m0, s41, 0
s_nop 0
buffer_load_dwordx4 v2, s[48:51], s26 offen offset:0 lds
M v[32:35], v[164:167], a[180:183], v[32:35]
ds_read_b64_tr_b16 v[96:97], v16 offset:0
ds_read_b64_tr_b16 v[98:99], v16 offset:4096
M v[36:39], v[172:175], a[180:183], v[36:39]
buffer_load_dwordx4 v3, s[48:51], s26 offen offset:1024 lds
M v[36:39], v[168:171], a[176:179], v[36:39]
ds_read_b64_tr_b16 v[100:101], v16 offset:8192
ds_read_b64_tr_b16 v[102:103], v16 offset:12288
M v[40:43], v[176:179], a[176:179], v[40:43]
buffer_load_dwordx4 v4, s[48:51], s26 offen offset:2048 lds
M v[40:43], v[180:183], a[180:183], v[40:43]
ds_read_b64_tr_b16 v[104:105], v17 offset:0
ds_read_b64_tr_b16 v[106:107], v17 offset:4096
M v[44:47], v[188:191], a[180:183], v[44:47]
buffer_load_dwordx4 v5, s[48:51], s26 offen offset:3072 lds
M v[44:47], v[184:187], a[176:179], v[44:47]
M v[48:51], v[192:195], a[176:179], v[48:51]
ds_read_b64_tr_b16 v[108:109], v17 offset:8192
ds_read_b64_tr_b16 v[110:111], v17 offset:12288
M v[48:51], v[196:199], a[180:183], v[48:51]
buffer_load_dwordx4 a[128:131], v1, s[44:47], s25 offen offset:0 sc1
M v[52:55], v[204:207], a[180:183], v[52:55]
ds_read_b64_tr_b16 v[112:113], v18 offset:0
ds_read_b64_tr_b16 v[114:115], v18 offset:4096
M v[52:55], v[200:203], a[176:179], v[52:55]
buffer_load_dwordx4 a[132:135], v1, s[44:47], s25 offen offset:1024 sc1
M v[56:59], v[208:211], a[176:179], v[56:59]
ds_read_b64_tr_b16 v[116:117], v18 offset:8192
ds_read_b64_tr_b16 v[118:119], v18 offset:12288
M v[56:59], v[212:215], a[180:183], v[56:59]
buffer_load_dwordx4 a[136:139], v1, s[44:47], s25 offen offset:2048 sc1
M v[60:63], v[220:223], a[180:183], v[60:63]
M v[60:63], v[216:219], a[176:179], v[60:63]
ds_read_b64_tr_b16 v[120:121], v19 offset:0
ds_read_b64_tr_b16 v[122:123], v19 offset:4096
M v[64:67], v[160:163], a[184:187], v[64:67]
buffer_load_dwordx4 a[140:143], v1, s[44:47], s25 offen offset:3072 sc1
M v[64:67], v[164:167], a[188:191], v[64:67]
ds_read_b64_tr_b16 v[124:125], v19 offset:8192
ds_read_b64_tr_b16 v[126:127], v19 offset:12288
M v[68:71], v[172:175], a[188:191], v[68:71]
s_sub_u32 s39, s39, 1
s_cmp_eq_u32 s39, 0
s_cselect_b32 s3, s64, s65
M v[68:71], v[168:171], a[184:187], v[68:71]
ds_read_b64_tr_b16 v[128:129], v20 offset:0
ds_read_b64_tr_b16 v[130:131], v20 offset:4096
M v[72:75], v[176:179], a[184:187], v[72:75]
s_add_u32 s25, s25, s3
s_lshl_b32 s3, s3, 3
s_add_u32 s26, s26, s3
M v[72:75], v[180:183], a[188:191], v[72:75]
ds_read_b64_tr_b16 v[132:133], v20 offset:8192
ds_read_b64_tr_b16 v[134:135], v20 offset:12288
M v[76:79], v[188:191], a[188:191], v[76:79]
M v[76:79], v[184:187], a[184:187], v[76:79]
ds_read_b64_tr_b16 v[136:137], v21 offset:0
ds_read_b64_tr_b16 v[138:139], v21 offset:4096
M v[80:83], v[192:195], a[184:187], v[80:83]
ds_read_b64_tr_b16 v[140:141], v21 offset:8192
ds_read_b64_tr_b16 v[142:143], v21 offset:12288
M v[80:83], v[196:199], a[188:191], v[80:83]
ds_read_b64_tr_b16 v[144:145], v22 offset:0
ds_read_b64_tr_b16 v[146:147], v22 offset:4096
M v[84:87], v[204:207], a[188:191], v[84:87]
ds_read_b64_tr_b16 v[148:149], v22 offset:8192
ds_read_b64_tr_b16 v[150:151], v22 offset:12288
M v[84:87], v[200:203], a[184:187], v[84:87]
ds_read_b64_tr_b16 v[152:153], v23 offset:0
ds_read_b64_tr_b16 v[154:155], v23 offset:4096
M v[88:91], v[208:211], a[184:187], v[88:91]
ds_read_b64_tr_b16 v[156:157], v23 offset:8192
ds_read_b64_tr_b16 v[158:159], v23 offset:12288
M v[88:91], v[212:215], a[188:191], v[88:91]
M v[92:95], v[220:223], a[188:191], v[92:95]
M v[92:95], v[216:219], a[184:187], v[92:95]
s_waitcnt vmcnt(24) lgkmcnt(0)
s_barrier
M v[32:35], v[96:99], a[192:195], v[32:35]
s_add_u32 m0, s41, 16384
s_nop 0
buffer_load_dwordx4 v2, s[48:51], s26 offen offset:0 lds
M v[32:35], v[100:103], a[196:199], v[32:35]
ds_read_b64_tr_b16 v[160:161], v16 offset:16384
ds_read_b64_tr_b16 v[162:163], v16 offset:20480
M v[36:39], v[108:111], a[196:199], v[36:39]
buffer_load_dwordx4 v3, s[48:51], s26 offen offset:1024 lds
M v[36:39], v[104:107], a[192:195], v[36:39]
ds_read_b64_tr_b16 v[164:165], v16 offset:24576
ds_read_b64_tr_b16 v[166:167], v16 offset:28672
M v[40:43], v[112:115], a[192:195], v[40:43]
buffer_load_dwordx4 v4, s[48:51], s26 offen offset:2048 lds
M v[40:43], v[116:119], a[196:199], v[40:43]
ds_read_b64_tr_b16 v[168:169], v17 offset:16384
ds_read_b64_tr_b16 v[170:171], v17 offset:20480
M v[44:47], v[124:127], a[196:199], v[44:47]
buffer_load_dwordx4 v5, s[48:51], s26 offen offset:3072 lds
M v[44:47], v[120:123], a[192:195], v[44:47]
M v[48:51], v[128:131], a[192:195], v[48:51]
ds_read_b64_tr_b16 v[172:173], v17 offset:24576
ds_read_b64_tr_b16 v[174:175], v17 offset:28672
M v[48:51], v[132:135], a[196:199], v[48:51]
buffer_load_dwordx4 a[144:147], v1, s[44:47], s25 offen offset:0 sc1
M v[52:55], v[140:143], a[196:199], v[52:55]
ds_read_b64_tr_b16 v[176:177], v18 offset:16384
ds_read_b64_tr_b16 v[178:179], v18 offset:20480
M v[52:55], v[136:139], a[192:195], v[52:55]
buffer_load_dwordx4 a[148:151], v1, s[44:47], s25 offen offset:1024 sc1
M v[56:59], v[144:147], a[192:195], v[56:59]
ds_read_b64_tr_b16 v[180:181], v18 offset:24576
ds_read_b64_tr_b16 v[182:183], v18 offset:28672
M v[56:59], v[148:151], a[196:199], v[56:59]
buffer_load_dwordx4 a[152:155], v1, s[44:47], s25 offen offset:2048 sc1
M v[60:63], v[156:159], a[196:199], v[60:63]
M v[60:63], v[152:155], a[192:195], v[60:63]
ds_read_b64_tr_b16 v[184:185], v19 offset:16384
ds_read_b64_tr_b16 v[186:187], v19 offset:20480
M v[64:67], v[96:99], a[200:203], v[64:67]
buffer_load_dwordx4 a[156:159], v1, s[44:47], s25 offen offset:3072 sc1
M v[64:67], v[100:103], a[204:207], v[64:67]
ds_read_b64_tr_b16 v[188:189], v19 offset:24576
ds_read_b64_tr_b16 v[190:191], v19 offset:28672
M v[68:71], v[108:111], a[204:207], v[68:71]
s_sub_u32 s39, s39, 1
s_cmp_eq_u32 s39, 0
s_cselect_b32 s3, s64, s65
M v[68:71], v[104:107], a[200:203], v[68:71]
ds_read_b64_tr_b16 v[192:193], v20 offset:16384
ds_read_b64_tr_b16 v[194:195], v20 offset:20480
M v[72:75], v[112:115], a[200:203], v[72:75]
s_add_u32 s25, s25, s3
s_lshl_b32 s3, s3, 3
s_add_u32 s26, s26, s3
M v[72:75], v[116:119], a[204:207], v[72:75]
ds_read_b64_tr_b16 v[196:197], v20 offset:24576
ds_read_b64_tr_b16 v[198:199], v20 offset:28672
M v[76:79], v[124:127], a[204:207], v[76:79]
M v[76:79], v[120:123], a[200:203], v[76:79]
ds_read_b64_tr_b16 v[200:201], v21 offset:16384
ds_read_b64_tr_b16 v[202:203], v21 offset:20480
M v[80:83], v[128:131], a[200:203], v[80:83]
ds_read_b64_tr_b16 v[204:205], v21 offset:24576
ds_read_b64_tr_b16 v[206:207], v21 offset:28672
M v[80:83], v[132:135], a[204:207], v[80:83]
ds_read_b64_tr_b16 v[208:209], v22 offset:16384
ds_read_b64_tr_b16 v[210:211], v22 offset:20480
M v[84:87], v[140:143], a[204:207], v[84:87]
ds_read_b64_tr_b16 v[212:213], v22 offset:24576
ds_read_b64_tr_b16 v[214:215], v22 offset:28672
M v[84:87], v[136:139], a[200:203], v[84:87]
ds_read_b64_tr_b16 v[216:217], v23 offset:16384
ds_read_b64_tr_b16 v[218:219], v23 offset:20480
M v[88:91], v[144:147], a[200:203], v[88:91]
ds_read_b64_tr_b16 v[220:221], v23 offset:24576
ds_read_b64_tr_b16 v[222:223], v23 offset:28672
M v[88:91], v[148:151], a[204:207], v[88:91]
M v[92:95], v[156:159], a[204:207], v[92:95]
M v[92:95], v[152:155], a[200:203], v[92:95]
s_sub_u32 s28, s28, 1
s_cmp_lg_u32 s28, 0
s_cbranch_scc1 Lk3_la
s_waitcnt vmcnt(24) lgkmcnt(0)
s_barrier
M v[32:35], v[160:163], a[208:211], v[32:35]
s_add_u32 m0, s41, 32768
s_nop 0
buffer_load_dwordx4 v2, s[48:51], s26 offen offset:0 lds
M v[32:35], v[164:167], a[212:215], v[32:35]
ds_read_b64_tr_b16 v[96:97], v16 offset:32768
ds_read_b64_tr_b16 v[98:99], v16 offset:36864
M v[36:39], v[172:175], a[212:215], v[36:39]
buffer_load_dwordx4 v3, s[48:51], s26 offen offset:1024 lds
M v[36:39], v[168:171], a[208:211], v[36:39]
ds_read_b64_tr_b16 v[100:101], v16 offset:40960
ds_read_b64_tr_b16 v[102:103], v16 offset:45056
M v[40:43], v[176:179], a[208:211], v[40:43]
buffer_load_dwordx4 v4, s[48:51], s26 offen offset:2048 lds
M v[40:43], v[180:183], a[212:215], v[40:43]
ds_read_b64_tr_b16 v[104:105], v17 offset:32768
ds_read_b64_tr_b16 v[106:107], v17 offset:36864
M v[44:47], v[188:191], a[212:215], v[44:47]
buffer_load_dwordx4 v5, s[48:51], s26 offen offset:3072 lds
M v[44:47], v[184:187], a[208:211], v[44:47]
M v[48:51], v[192:195], a[208:211], v[48:51]
ds_read_b64_tr_b16 v[108:109], v17 offset:40960
ds_read_b64_tr_b16 v[110:111], v17 offset:45056
M v[48:51], v[196:199], a[212:215], v[48:51]
buffer_load_dwordx4 a[160:163], v1, s[44:47], s25 offen offset:0 sc1
M v[52:55], v[204:207], a[212:215], v[52:55]
ds_read_b64_tr_b16 v[112:113], v18 offset:32768
ds_read_b64_tr_b16 v[114:115], v18 offset:36864
M v[52:55], v[200:203], a[208:211], v[52:55]
buffer_load_dwordx4 a[164:167], v1, s[44:47], s25 offen offset:1024 sc1
M v[56:59], v[208:211], a[208:211], v[56:59]
ds_read_b64_tr_b16 v[116:117], v18 offset:40960
ds_read_b64_tr_b16 v[118:119], v18 offset:45056
M v[56:59], v[212:215], a[212:215], v[56:59]
buffer_load_dwordx4 a[168:171], v1, s[44:47], s25 offen offset:2048 sc1
M v[60:63], v[220:223], a[212:215], v[60:63]
M v[60:63], v[216:219], a[208:211], v[60:63]
ds_read_b64_tr_b16 v[120:121], v19 offset:32768
ds_read_b64_tr_b16 v[122:123], v19 offset:36864
M v[64:67], v[160:163], a[216:219], v[64:67]
buffer_load_dwordx4 a[172:175], v1, s[44:47], s25 offen offset:3072 sc1
M v[64:67], v[164:167], a[220:223], v[64:67]
ds_read_b64_tr_b16 v[124:125], v19 offset:40960
ds_read_b64_tr_b16 v[126:127], v19 offset:45056
M v[68:71], v[172:175], a[220:223], v[68:71]
s_sub_u32 s39, s39, 1
s_cmp_eq_u32 s39, 0
s_cselect_b32 s3, s64, s65
M v[68:71], v[168:171], a[216:219], v[68:71]
ds_read_b64_tr_b16 v[128:129], v20 offset:32768
ds_read_b64_tr_b16 v[130:131], v20 offset:36864
M v[72:75], v[176:179], a[216:219], v[72:75]
s_add_u32 s25, s25, s3
s_lshl_b32 s3, s3, 3
s_add_u32 s26, s26, s3
M v[72:75], v[180:183], a[220:223], v[72:75]
ds_read_b64_tr_b16 v[132:133], v20 offset:40960
ds_read_b64_tr_b16 v[134:135], v20 offset:45056
M v[76:79], v[188:191], a[220:223], v[76:79]
M v[76:79], v[184:187], a[216:219], v[76:79]
ds_read_b64_tr_b16 v[136:137], v21 offset:32768
ds_read_b64_tr_b16 v[138:139], v21 offset:36864
M v[80:83], v[192:195], a[216:219], v[80:83]
ds_read_b64_tr_b16 v[140:141], v21 offset:40960
ds_read_b64_tr_b16 v[142:143], v21 offset:45056
M v[80:83], v[196:199], a[220:223], v[80:83]
ds_read_b64_tr_b16 v[144:145], v22 offset:32768
ds_read_b64_tr_b16 v[146:147], v22 offset:36864
M v[84:87], v[204:207], a[220:223], v[84:87]
ds_read_b64_tr_b16 v[148:149], v22 offset:40960
ds_read_b64_tr_b16 v[150:151], v22 offset:45056
M v[84:87], v[200:203], a[216:219], v[84:87]
ds_read_b64_tr_b16 v[152:153], v23 offset:32768
ds_read_b64_tr_b16 v[154:155], v23 offset:36864
M v[88:91], v[208:211], a[216:219], v[88:91]
ds_read_b64_tr_b16 v[156:157], v23 offset:40960
ds_read_b64_tr_b16 v[158:159], v23 offset:45056
M v[88:91], v[212:215], a[220:223], v[88:91]
M v[92:95], v[220:223], a[220:223], v[92:95]
M v[92:95], v[216:219], a[216:219], v[92:95]
s_waitcnt vmcnt(24) lgkmcnt(0)
s_barrier
M v[32:35], v[96:99], a[224:227], v[32:35]
s_add_u32 m0, s41, 49152
s_nop 0
buffer_load_dwordx4 v2, s[48:51], s26 offen offset:0 lds
M v[32:35], v[100:103], a[228:231], v[32:35]
ds_read_b64_tr_b16 v[160:161], v16 offset:49152
ds_read_b64_tr_b16 v[162:163], v16 offset:53248
M v[36:39], v[108:111], a[228:231], v[36:39]
buffer_load_dwordx4 v3, s[48:51], s26 offen offset:1024 lds
M v[36:39], v[104:107], a[224:227], v[36:39]
ds_read_b64_tr_b16 v[164:165], v16 offset:57344
ds_read_b64_tr_b16 v[166:167], v16 offset:61440
M v[40:43], v[112:115], a[224:227], v[40:43]
buffer_load_dwordx4 v4, s[48:51], s26 offen offset:2048 lds
M v[40:43], v[116:119], a[228:231], v[40:43]
ds_read_b64_tr_b16 v[168:169], v17 offset:49152
ds_read_b64_tr_b16 v[170:171], v17 offset:53248
M v[44:47], v[124:127], a[228:231], v[44:47]
buffer_load_dwordx4 v5, s[48:51], s26 offen offset:3072 lds
M v[44:47], v[120:123], a[224:227], v[44:47]
M v[48:51], v[128:131], a[224:227], v[48:51]
ds_read_b64_tr_b16 v[172:173], v17 offset:57344
ds_read_b64_tr_b16 v[174:175], v17 offset:61440
M v[48:51], v[132:135], a[228:231], v[48:51]
buffer_load_dwordx4 a[176:179], v1, s[44:47], s25 offen offset:0 sc1
M v[52:55], v[140:143], a[228:231], v[52:55]
ds_read_b64_tr_b16 v[176:177], v18 offset:49152
ds_read_b64_tr_b16 v[178:179], v18 offset:53248
M v[52:55], v[136:139], a[224:227], v[52:55]
buffer_load_dwordx4 a[180:183], v1, s[44:47], s25 offen offset:1024 sc1
M v[56:59], v[144:147], a[224:227], v[56:59]
ds_read_b64_tr_b16 v[180:181], v18 offset:57344
ds_read_b64_tr_b16 v[182:183], v18 offset:61440
M v[56:59], v[148:151], a[228:231], v[56:59]
buffer_load_dwordx4 a[184:187], v1, s[44:47], s25 offen offset:2048 sc1
M v[60:63], v[156:159], a[228:231], v[60:63]
M v[60:63], v[152:155], a[224:227], v[60:63]
ds_read_b64_tr_b16 v[184:185], v19 offset:49152
ds_read_b64_tr_b16 v[186:187], v19 offset:53248
M v[64:67], v[96:99], a[232:235], v[64:67]
buffer_load_dwordx4 a[188:191], v1, s[44:47], s25 offen offset:3072 sc1
M v[64:67], v[100:103], a[236:239], v[64:67]
ds_read_b64_tr_b16 v[188:189], v19 offset:57344
ds_read_b64_tr_b16 v[190:191], v19 offset:61440
M v[68:71], v[108:111], a[236:239], v[68:71]
s_sub_u32 s39, s39, 1
s_cmp_eq_u32 s39, 0
s_cselect_b32 s3, s64, s65
M v[68:71], v[104:107], a[232:235], v[68:71]
ds_read_b64_tr_b16 v[192:193], v20 offset:49152
ds_read_b64_tr_b16 v[194:195], v20 offset:53248
M v[72:75], v[112:115], a[232:235], v[72:75]
s_add_u32 s25, s25, s3
s_lshl_b32 s3, s3, 3
s_add_u32 s26, s26, s3
M v[72:75], v[116:119], a[236:239], v[72:75]
ds_read_b64_tr_b16 v[196:197], v20 offset:57344
ds_read_b64_tr_b16 v[198:199], v20 offset:61440
M v[76:79], v[124:127], a[236:239], v[76:79]
M v[76:79], v[120:123], a[232:235], v[76:79]
ds_read_b64_tr_b16 v[200:201], v21 offset:49152
ds_read_b64_tr_b16 v[202:203], v21 offset:53248
M v[80:83], v[128:131], a[232:235], v[80:83]
ds_read_b64_tr_b16 v[204:205], v21 offset:57344
ds_read_b64_tr_b16 v[206:207], v21 offset:61440
M v[80:83], v[132:135], a[236:239], v[80:83]
ds_read_b64_tr_b16 v[208:209], v22 offset:49152
ds_read_b64_tr_b16 v[210:211], v22 offset:53248
M v[84:87], v[140:143], a[236:239], v[84:87]
ds_read_b64_tr_b16 v[212:213], v22 offset:57344
ds_read_b64_tr_b16 v[214:215], v22 offset:61440
M v[84:87], v[136:139], a[232:235], v[84:87]
ds_read_b64_tr_b16 v[216:217], v23 offset:49152
ds_read_b64_tr_b16 v[218:219], v23 offset:53248
M v[88:91], v[144:147], a[232:235], v[88:91]
ds_read_b64_tr_b16 v[220:221], v23 offset:57344
ds_read_b64_tr_b16 v[222:223], v23 offset:61440
M v[88:91], v[148:151], a[236:239], v[88:91]
M v[92:95], v[156:159], a[236:239], v[92:95]
M v[92:95], v[152:155], a[232:235], v[92:95]
s_waitcnt vmcnt(24) lgkmcnt(0)
s_barrier
M v[32:35], v[160:163], a[240:243], v[32:35]
s_mov_b64 s[44:45], s[34:35]
s_mov_b32 s46, 4194304
s_mov_b64 s[48:49], s[36:37]
s_mov_b32 s50, 2097152
s_mov_b32 s25, s32
s_mov_b32 s26, s33
s_add_u32 m0, s42, 65536
s_nop 0
buffer_load_dwordx4 v6, s[48:51], s26 offen offset:0 lds
M v[32:35], v[164:167], a[244:247], v[32:35]
ds_read_b64_tr_b16 v[96:97], v8 offset:0
ds_read_b64_tr_b16 v[98:99], v8 offset:4096
M v[36:39], v[172:175], a[244:247], v[36:39]
buffer_load_dwordx4 v7, s[48:51], s26 offen offset:1024 lds
M v[36:39], v[168:171], a[240:243], v[36:39]
ds_read_b64_tr_b16 v[100:101], v8 offset:8192
ds_read_b64_tr_b16 v[102:103], v8 offset:12288
M v[40:43], v[176:179], a[240:243], v[40:43]
M v[40:43], v[180:183], a[244:247], v[40:43]
buffer_load_dwordx4 a[192:195], v1, s[44:47], s25 offen offset:0 sc1
M v[44:47], v[188:191], a[244:247], v[44:47]
ds_read_b64_tr_b16 v[104:105], v9 offset:0
ds_read_b64_tr_b16 v[106:107], v9 offset:4096
M v[44:47], v[184:187], a[240:243], v[44:47]
buffer_load_dwordx4 a[196:199], v1, s[44:47], s25 offen offset:1024 sc1
M v[48:51], v[192:195], a[240:243], v[48:51]
M v[48:51], v[196:199], a[244:247], v[48:51]
ds_read_b64_tr_b16 v[108:109], v9 offset:8192
ds_read_b64_tr_b16 v[110:111], v9 offset:12288
M v[52:55], v[204:207], a[244:247], v[52:55]
buffer_load_dwordx4 a[200:203], v1, s[44:47], s25 offen offset:2048 sc1
M v[52:55], v[200:203], a[240:243], v[52:55]
ds_read_b64_tr_b16 v[112:113], v10 offset:0
ds_read_b64_tr_b16 v[114:115], v10 offset:4096
M v[56:59], v[208:211], a[240:243], v[56:59]
M v[56:59], v[212:215], a[244:247], v[56:59]
buffer_load_dwordx4 a[204:207], v1, s[44:47], s25 offen offset:3072 sc1
M v[60:63], v[220:223], a[244:247], v[60:63]
ds_read_b64_tr_b16 v[116:117], v10 offset:8192
ds_read_b64_tr_b16 v[118:119], v10 offset:12288
M v[60:63], v[216:219], a[240:243], v[60:63]
s_add_u32 s25, s25, 16384
s_add_u32 s26, s26, 131072
M v[64:67], v[160:163], a[248:251], v[64:67]
ds_read_b64_tr_b16 v[120:121], v11 offset:0
ds_read_b64_tr_b16 v[122:123], v11 offset:4096
M v[64:67], v[164:167], a[252:255], v[64:67]
M v[68:71], v[172:175], a[252:255], v[68:71]
ds_read_b64_tr_b16 v[124:125], v11 offset:8192
ds_read_b64_tr_b16 v[126:127], v11 offset:12288
M v[68:71], v[168:171], a[248:251], v[68:71]
ds_read_b64_tr_b16 v[128:129], v12 offset:0
ds_read_b64_tr_b16 v[130:131], v12 offset:4096
M v[72:75], v[176:179], a[248:251], v[72:75]
ds_read_b64_tr_b16 v[132:133], v12 offset:8192
ds_read_b64_tr_b16 v[134:135], v12 offset:12288
M v[72:75], v[180:183], a[252:255], v[72:75]
M v[76:79], v[188:191], a[252:255], v[76:79]
ds_read_b64_tr_b16 v[136:137], v13 offset:0
ds_read_b64_tr_b16 v[138:139], v13 offset:4096
M v[76:79], v[184:187], a[248:251], v[76:79]
ds_read_b64_tr_b16 v[140:141], v13 offset:8192
ds_read_b64_tr_b16 v[142:143], v13 offset:12288
M v[80:83], v[192:195], a[248:251], v[80:83]
ds_read_b64_tr_b16 v[144:145], v14 offset:0
ds_read_b64_tr_b16 v[146:147], v14 offset:4096
M v[80:83], v[196:199], a[252:255], v[80:83]
M v[84:87], v[204:207], a[252:255], v[84:87]
ds_read_b64_tr_b16 v[148:149], v14 offset:8192
ds_read_b64_tr_b16 v[150:151], v14 offset:12288
M v[84:87], v[200:203], a[248:251], v[84:87]
ds_read_b64_tr_b16 v[152:153], v15 offset:0
ds_read_b64_tr_b16 v[154:155], v15 offset:4096
M v[88:91], v[208:211], a[248:251], v[88:91]
ds_read_b64_tr_b16 v[156:157], v15 offset:8192
ds_read_b64_tr_b16 v[158:159], v15 offset:12288
M v[88:91], v[212:215], a[252:255], v[88:91]
M v[92:95], v[220:223], a[252:255], v[92:95]
M v[92:95], v[216:219], a[248:251], v[92:95]
s_waitcnt vmcnt(22) lgkmcnt(0)
s_barrier
M v[32:35], v[96:99], a[128:131], v[32:35]
s_add_u32 m0, s42, 81920
s_nop 0
buffer_load_dwordx4 v6, s[48:51], s26 offen offset:0 lds
M v[32:35], v[100:103], a[132:135], v[32:35]
ds_read_b64_tr_b16 v[160:161], v8 offset:16384
ds_read_b64_tr_b16 v[162:163], v8 offset:20480
M v[36:39], v[108:111], a[132:135], v[36:39]
buffer_load_dwordx4 v7, s[48:51], s26 offen offset:1024 lds
M v[36:39], v[104:107], a[128:131], v[36:39]
ds_read_b64_tr_b16 v[164:165], v8 offset:24576
ds_read_b64_tr_b16 v[166:167], v8 offset:28672
M v[40:43], v[112:115], a[128:131], v[40:43]
M v[40:43], v[116:119], a[132:135], v[40:43]
buffer_load_dwordx4 a[208:211], v1, s[44:47], s25 offen offset:0 sc1
M v[44:47], v[124:127], a[132:135], v[44:47]
ds_read_b64_tr_b16 v[168:169], v9 offset:16384
ds_read_b64_tr_b16 v[170:171], v9 offset:20480
M v[44:47], v[120:123], a[128:131], v[44:47]
buffer_load_dwordx4 a[212:215], v1, s[44:47], s25 offen offset:1024 sc1
M v[48:51], v[128:131], a[128:131], v[48:51]
M v[48:51], v[132:135], a[132:135], v[48:51]
ds_read_b64_tr_b16 v[172:173], v9 offset:24576
ds_read_b64_tr_b16 v[174:175], v9 offset:28672
M v[52:55], v[140:143], a[132:135], v[52:55]
buffer_load_dwordx4 a[216:219], v1, s[44:47], s25 offen offset:2048 sc1
M v[52:55], v[136:139], a[128:131], v[52:55]
ds_read_b64_tr_b16 v[176:177], v10 offset:16384
ds_read_b64_tr_b16 v[178:179], v10 offset:20480
M v[56:59], v[144:147], a[128:131], v[56:59]
M v[56:59], v[148:151], a[132:135], v[56:59]
buffer_load_dwordx4 a[220:223], v1, s[44:47], s25 offen offset:3072 sc1
M v[60:63], v[156:159], a[132:135], v[60:63]
ds_read_b64_tr_b16 v[180:181], v10 offset:24576
ds_read_b64_tr_b16 v[182:183], v10 offset:28672
M v[60:63], v[152:155], a[128:131], v[60:63]
s_add_u32 s25, s25, 16384
s_add_u32 s26, s26, 131072
M v[64:67], v[96:99], a[136:139], v[64:67]
ds_read_b64_tr_b16 v[184:185], v11 offset:16384
ds_read_b64_tr_b16 v[186:187], v11 offset:20480
M v[64:67], v[100:103], a[140:143], v[64:67]
M v[68:71], v[108:111], a[140:143], v[68:71]
ds_read_b64_tr_b16 v[188:189], v11 offset:24576
ds_read_b64_tr_b16 v[190:191], v11 offset:28672
M v[68:71], v[104:107], a[136:139], v[68:71]
ds_read_b64_tr_b16 v[192:193], v12 offset:16384
ds_read_b64_tr_b16 v[194:195], v12 offset:20480
M v[72:75], v[112:115], a[136:139], v[72:75]
ds_read_b64_tr_b16 v[196:197], v12 offset:24576
ds_read_b64_tr_b16 v[198:199], v12 offset:28672
M v[72:75], v[116:119], a[140:143], v[72:75]
M v[76:79], v[124:127], a[140:143], v[76:79]
ds_read_b64_tr_b16 v[200:201], v13 offset:16384
ds_read_b64_tr_b16 v[202:203], v13 offset:20480
M v[76:79], v[120:123], a[136:139], v[76:79]
ds_read_b64_tr_b16 v[204:205], v13 offset:24576
ds_read_b64_tr_b16 v[206:207], v13 offset:28672
M v[80:83], v[128:131], a[136:139], v[80:83]
ds_read_b64_tr_b16 v[208:209], v14 offset:16384
ds_read_b64_tr_b16 v[210:211], v14 offset:20480
M v[80:83], v[132:135], a[140:143], v[80:83]
M v[84:87], v[140:143], a[140:143], v[84:87]
ds_read_b64_tr_b16 v[212:213], v14 offset:24576
ds_read_b64_tr_b16 v[214:215], v14 offset:28672
M v[84:87], v[136:139], a[136:139], v[84:87]
ds_read_b64_tr_b16 v[216:217], v15 offset:16384
ds_read_b64_tr_b16 v[218:219], v15 offset:20480
M v[88:91], v[144:147], a[136:139], v[88:91]
ds_read_b64_tr_b16 v[220:221], v15 offset:24576
ds_read_b64_tr_b16 v[222:223], v15 offset:28672
M v[88:91], v[148:151], a[140:143], v[88:91]
M v[92:95], v[156:159], a[140:143], v[92:95]
M v[92:95], v[152:155], a[136:139], v[92:95]
s_waitcnt vmcnt(20) lgkmcnt(0)
s_barrier
M v[32:35], v[160:163], a[144:147], v[32:35]
s_add_u32 m0, s42, 98304
s_nop 0
buffer_load_dwordx4 v6, s[48:51], s26 offen offset:0 lds
M v[32:35], v[164:167], a[148:151], v[32:35]
ds_read_b64_tr_b16 v[96:97], v8 offset:32768
ds_read_b64_tr_b16 v[98:99], v8 offset:36864
M v[36:39], v[172:175], a[148:151], v[36:39]
buffer_load_dwordx4 v7, s[48:51], s26 offen offset:1024 lds
M v[36:39], v[168:171], a[144:147], v[36:39]
ds_read_b64_tr_b16 v[100:101], v8 offset:40960
ds_read_b64_tr_b16 v[102:103], v8 offset:45056
M v[40:43], v[176:179], a[144:147], v[40:43]
M v[40:43], v[180:183], a[148:151], v[40:43]
buffer_load_dwordx4 a[224:227], v1, s[44:47], s25 offen offset:0 sc1
M v[44:47], v[188:191], a[148:151], v[44:47]
ds_read_b64_tr_b16 v[104:105], v9 offset:32768
ds_read_b64_tr_b16 v[106:107], v9 offset:36864
M v[44:47], v[184:187], a[144:147], v[44:47]
buffer_load_dwordx4 a[228:231], v1, s[44:47], s25 offen offset:1024 sc1
M v[48:51], v[192:195], a[144:147], v[48:51]
M v[48:51], v[196:199], a[148:151], v[48:51]
ds_read_b64_tr_b16 v[108:109], v9 offset:40960
ds_read_b64_tr_b16 v[110:111], v9 offset:45056
M v[52:55], v[204:207], a[148:151], v[52:55]
buffer_load_dwordx4 a[232:235], v1, s[44:47], s25 offen offset:2048 sc1
M v[52:55], v[200:203], a[144:147], v[52:55]
ds_read_b64_tr_b16 v[112:113], v10 offset:32768
ds_read_b64_tr_b16 v[114:115], v10 offset:36864
M v[56:59], v[208:211], a[144:147], v[56:59]
M v[56:59], v[212:215], a[148:151], v[56:59]
buffer_load_dwordx4 a[236:239], v1, s[44:47], s25 offen offset:3072 sc1
M v[60:63], v[220:223], a[148:151], v[60:63]
ds_read_b64_tr_b16 v[116:117], v10 offset:40960
ds_read_b64_tr_b16 v[118:119], v10 offset:45056
M v[60:63], v[216:219], a[144:147], v[60:63]
s_add_u32 s25, s25, 16384
s_add_u32 s26, s26, 131072
M v[64:67], v[160:163], a[152:155], v[64:67]
ds_read_b64_tr_b16 v[120:121], v11 offset:32768
ds_read_b64_tr_b16 v[122:123], v11 offset:36864
M v[64:67], v[164:167], a[156:159], v[64:67]
M v[68:71], v[172:175], a[156:159], v[68:71]
ds_read_b64_tr_b16 v[124:125], v11 offset:40960
ds_read_b64_tr_b16 v[126:127], v11 offset:45056
M v[68:71], v[168:171], a[152:155], v[68:71]
ds_read_b64_tr_b16 v[128:129], v12 offset:32768
ds_read_b64_tr_b16 v[130:131], v12 offset:36864
M v[72:75], v[176:179], a[152:155], v[72:75]
ds_read_b64_tr_b16 v[132:133], v12 offset:40960
ds_read_b64_tr_b16 v[134:135], v12 offset:45056
M v[72:75], v[180:183], a[156:159], v[72:75]
M v[76:79], v[188:191], a[156:159], v[76:79]
ds_read_b64_tr_b16 v[136:137], v13 offset:32768
ds_read_b64_tr_b16 v[138:139], v13 offset:36864
M v[76:79], v[184:187], a[152:155], v[76:79]
ds_read_b64_tr_b16 v[140:141], v13 offset:40960
ds_read_b64_tr_b16 v[142:143], v13 offset:45056
M v[80:83], v[192:195], a[152:155], v[80:83]
ds_read_b64_tr_b16 v[144:145], v14 offset:32768
ds_read_b64_tr_b16 v[146:147], v14 offset:36864
M v[80:83], v[196:199], a[156:159], v[80:83]
M v[84:87], v[204:207], a[156:159], v[84:87]
ds_read_b64_tr_b16 v[148:149], v14 offset:40960
ds_read_b64_tr_b16 v[150:151], v14 offset:45056
M v[84:87], v[200:203], a[152:155], v[84:87]
ds_read_b64_tr_b16 v[152:153], v15 offset:32768
ds_read_b64_tr_b16 v[154:155], v15 offset:36864
M v[88:91], v[208:211], a[152:155], v[88:91]
ds_read_b64_tr_b16 v[156:157], v15 offset:40960
ds_read_b64_tr_b16 v[158:159], v15 offset:45056
M v[88:91], v[212:215], a[156:159], v[88:91]
M v[92:95], v[220:223], a[156:159], v[92:95]
M v[92:95], v[216:219], a[152:155], v[92:95]
s_waitcnt vmcnt(18) lgkmcnt(0)
s_barrier
M v[32:35], v[96:99], a[160:163], v[32:35]
s_add_u32 m0, s42, 114688
s_nop 0
buffer_load_dwordx4 v6, s[48:51], s26 offen offset:0 lds
M v[32:35], v[100:103], a[164:167], v[32:35]
ds_read_b64_tr_b16 v[160:161], v8 offset:49152
ds_read_b64_tr_b16 v[162:163], v8 offset:53248
M v[36:39], v[108:111], a[164:167], v[36:39]
buffer_load_dwordx4 v7, s[48:51], s26 offen offset:1024 lds
M v[36:39], v[104:107], a[160:163], v[36:39]
ds_read_b64_tr_b16 v[164:165], v8 offset:57344
ds_read_b64_tr_b16 v[166:167], v8 offset:61440
M v[40:43], v[112:115], a[160:163], v[40:43]
M v[40:43], v[116:119], a[164:167], v[40:43]
buffer_load_dwordx4 a[240:243], v1, s[44:47], s25 offen offset:0 sc1
M v[44:47], v[124:127], a[164:167], v[44:47]
ds_read_b64_tr_b16 v[168:169], v9 offset:49152
ds_read_b64_tr_b16 v[170:171], v9 offset:53248
M v[44:47], v[120:123], a[160:163], v[44:47]
buffer_load_dwordx4 a[244:247], v1, s[44:47], s25 offen offset:1024 sc1
M v[48:51], v[128:131], a[160:163], v[48:51]
M v[48:51], v[132:135], a[164:167], v[48:51]
ds_read_b64_tr_b16 v[172:173], v9 offset:57344
ds_read_b64_tr_b16 v[174:175], v9 offset:61440
M v[52:55], v[140:143], a[164:167], v[52:55]
buffer_load_dwordx4 a[248:251], v1, s[44:47], s25 offen offset:2048 sc1
M v[52:55], v[136:139], a[160:163], v[52:55]
ds_read_b64_tr_b16 v[176:177], v10 offset:49152
ds_read_b64_tr_b16 v[178:179], v10 offset:53248
M v[56:59], v[144:147], a[160:163], v[56:59]
M v[56:59], v[148:151], a[164:167], v[56:59]
buffer_load_dwordx4 a[252:255], v1, s[44:47], s25 offen offset:3072 sc1
M v[60:63], v[156:159], a[164:167], v[60:63]
ds_read_b64_tr_b16 v[180:181], v10 offset:57344
ds_read_b64_tr_b16 v[182:183], v10 offset:61440
M v[60:63], v[152:155], a[160:163], v[60:63]
s_add_u32 s25, s25, 16384
s_add_u32 s26, s26, 131072
M v[64:67], v[96:99], a[168:171], v[64:67]
ds_read_b64_tr_b16 v[184:185], v11 offset:49152
ds_read_b64_tr_b16 v[186:187], v11 offset:53248
M v[64:67], v[100:103], a[172:175], v[64:67]
M v[68:71], v[108:111], a[172:175], v[68:71]
ds_read_b64_tr_b16 v[188:189], v11 offset:57344
ds_read_b64_tr_b16 v[190:191], v11 offset:61440
M v[68:71], v[104:107], a[168:171], v[68:71]
ds_read_b64_tr_b16 v[192:193], v12 offset:49152
ds_read_b64_tr_b16 v[194:195], v12 offset:53248
M v[72:75], v[112:115], a[168:171], v[72:75]
ds_read_b64_tr_b16 v[196:197], v12 offset:57344
ds_read_b64_tr_b16 v[198:199], v12 offset:61440
M v[72:75], v[116:119], a[172:175], v[72:75]
M v[76:79], v[124:127], a[172:175], v[76:79]
ds_read_b64_tr_b16 v[200:201], v13 offset:49152
ds_read_b64_tr_b16 v[202:203], v13 offset:53248
M v[76:79], v[120:123], a[168:171], v[76:79]
ds_read_b64_tr_b16 v[204:205], v13 offset:57344
ds_read_b64_tr_b16 v[206:207], v13 offset:61440
M v[80:83], v[128:131], a[168:171], v[80:83]
ds_read_b64_tr_b16 v[208:209], v14 offset:49152
ds_read_b64_tr_b16 v[210:211], v14 offset:53248
M v[80:83], v[132:135], a[172:175], v[80:83]
M v[84:87], v[140:143], a[172:175], v[84:87]
ds_read_b64_tr_b16 v[212:213], v14 offset:57344
ds_read_b64_tr_b16 v[214:215], v14 offset:61440
M v[84:87], v[136:139], a[168:171], v[84:87]
ds_read_b64_tr_b16 v[216:217], v15 offset:49152
ds_read_b64_tr_b16 v[218:219], v15 offset:53248
M v[88:91], v[144:147], a[168:171], v[88:91]
ds_read_b64_tr_b16 v[220:221], v15 offset:57344
ds_read_b64_tr_b16 v[222:223], v15 offset:61440
M v[88:91], v[148:151], a[172:175], v[88:91]
M v[92:95], v[156:159], a[172:175], v[92:95]
M v[92:95], v[152:155], a[168:171], v[92:95]
s_waitcnt vmcnt(18) lgkmcnt(0)
s_barrier
M v[32:35], v[160:163], a[176:179], v[32:35]
s_add_u32 m0, s42, 0
s_nop 0
buffer_load_dwordx4 v6, s[48:51], s26 offen offset:0 lds
M v[32:35], v[164:167], a[180:183], v[32:35]
M v[36:39], v[172:175], a[180:183], v[36:39]
ds_read_b64_tr_b16 v[96:97], v28 offset:0
ds_read_b64_tr_b16 v[98:99], v28 offset:2048
M v[36:39], v[168:171], a[176:179], v[36:39]
M v[40:43], v[176:179], a[176:179], v[40:43]
buffer_load_dwordx4 v7, s[48:51], s26 offen offset:1024 lds
M v[40:43], v[180:183], a[180:183], v[40:43]
M v[44:47], v[188:191], a[180:183], v[44:47]
ds_read_b64_tr_b16 v[100:101], v28 offset:4096
ds_read_b64_tr_b16 v[102:103], v28 offset:6144
M v[44:47], v[184:187], a[176:179], v[44:47]
M v[48:51], v[192:195], a[176:179], v[48:51]
buffer_load_dwordx4 a[128:131], v1, s[44:47], s25 offen offset:0 sc1
M v[48:51], v[196:199], a[180:183], v[48:51]
M v[52:55], v[204:207], a[180:183], v[52:55]
ds_read_b64_tr_b16 v[104:105], v29 offset:0
ds_read_b64_tr_b16 v[106:107], v29 offset:2048
M v[52:55], v[200:203], a[176:179], v[52:55]
M v[56:59], v[208:211], a[176:179], v[56:59]
buffer_load_dwordx4 a[132:135], v1, s[44:47], s25 offen offset:1024 sc1
M v[56:59], v[212:215], a[180:183], v[56:59]
M v[60:63], v[220:223], a[180:183], v[60:63]
ds_read_b64_tr_b16 v[108:109], v29 offset:4096
ds_read_b64_tr_b16 v[110:111], v29 offset:6144
M v[60:63], v[216:219], a[176:179], v[60:63]
M v[64:67], v[160:163], a[184:187], v[64:67]
buffer_load_dwordx4 a[136:139], v1, s[44:47], s25 offen offset:2048 sc1
M v[64:67], v[164:167], a[188:191], v[64:67]
M v[68:71], v[172:175], a[188:191], v[68:71]
ds_read_b64_tr_b16 v[112:113], v30 offset:0
ds_read_b64_tr_b16 v[114:115], v30 offset:2048
M v[68:71], v[168:171], a[184:187], v[68:71]
M v[72:75], v[176:179], a[184:187], v[72:75]
buffer_load_dwordx4 a[140:143], v1, s[44:47], s25 offen offset:3072 sc1
M v[72:75], v[180:183], a[188:191], v[72:75]
M v[76:79], v[188:191], a[188:191], v[76:79]
ds_read_b64_tr_b16 v[116:117], v30 offset:4096
ds_read_b64_tr_b16 v[118:119], v30 offset:6144
M v[76:79], v[184:187], a[184:187], v[76:79]
M v[80:83], v[192:195], a[184:187], v[80:83]
s_add_u32 s25, s25, 16384
s_add_u32 s26, s26, 131072
M v[80:83], v[196:199], a[188:191], v[80:83]
M v[84:87], v[204:207], a[188:191], v[84:87]
ds_read_b64_tr_b16 v[120:121], v31 offset:0
ds_read_b64_tr_b16 v[122:123], v31 offset:2048
M v[84:87], v[200:203], a[184:187], v[84:87]
M v[88:91], v[208:211], a[184:187], v[88:91]
ds_read_b64_tr_b16 v[124:125], v31 offset:4096
ds_read_b64_tr_b16 v[126:127], v31 offset:6144
M v[88:91], v[212:215], a[188:191], v[88:91]
M v[92:95], v[220:223], a[188:191], v[92:95]
M v[92:95], v[216:219], a[184:187], v[92:95]
s_waitcnt vmcnt(18) lgkmcnt(0)
s_barrier
M a[0:3], v[96:99], a[192:195], a[0:3]
s_add_u32 m0, s42, 16384
s_nop 0
buffer_load_dwordx4 v6, s[48:51], s26 offen offset:0 lds
ds_read_b64_tr_b16 v[160:161], v28 offset:16384
ds_read_b64_tr_b16 v[162:163], v28 offset:18432
M a[0:3], v[100:103], a[196:199], a[0:3]
buffer_load_dwordx4 v7, s[48:51], s26 offen offset:1024 lds
ds_read_b64_tr_b16 v[164:165], v28 offset:20480
ds_read_b64_tr_b16 v[166:167], v28 offset:22528
M a[4:7], v[108:111], a[196:199], a[4:7]
buffer_load_dwordx4 a[144:147], v1, s[44:47], s25 offen offset:0 sc1
ds_read_b64_tr_b16 v[168:169], v29 offset:16384
ds_read_b64_tr_b16 v[170:171], v29 offset:18432
M a[4:7], v[104:107], a[192:195], a[4:7]
buffer_load_dwordx4 a[148:151], v1, s[44:47], s25 offen offset:1024 sc1
M a[8:11], v[112:115], a[192:195], a[8:11]
ds_read_b64_tr_b16 v[172:173], v29 offset:20480
ds_read_b64_tr_b16 v[174:175], v29 offset:22528
buffer_load_dwordx4 a[152:155], v1, s[44:47], s25 offen offset:2048 sc1
M a[8:11], v[116:119], a[196:199], a[8:11]
ds_read_b64_tr_b16 v[176:177], v30 offset:16384
ds_read_b64_tr_b16 v[178:179], v30 offset:18432
buffer_load_dwordx4 a[156:159], v1, s[44:47], s25 offen offset:3072 sc1
M a[12:15], v[124:127], a[196:199], a[12:15]
ds_read_b64_tr_b16 v[180:181], v30 offset:20480
ds_read_b64_tr_b16 v[182:183], v30 offset:22528
M a[12:15], v[120:123], a[192:195], a[12:15]
s_add_u32 s25, s25, 16384
s_add_u32 s26, s26, 131072
ds_read_b64_tr_b16 v[184:185], v31 offset:16384
ds_read_b64_tr_b16 v[186:187], v31 offset:18432
M a[16:19], v[96:99], a[200:203], a[16:19]
s_add_u32 s60, s56, 0
buffer_store_dwordx4 v[48:51], v1, s[52:55], s60 offen offset:0 sc1
ds_read_b64_tr_b16 v[188:189], v31 offset:20480
ds_read_b64_tr_b16 v[190:191], v31 offset:22528
M a[16:19], v[100:103], a[204:207], a[16:19]
buffer_store_dwordx4 v[52:55], v1, s[52:55], s60 offen offset:1024 sc1
buffer_store_dwordx4 v[56:59], v1, s[52:55], s60 offen offset:2048 sc1
M a[20:23], v[108:111], a[204:207], a[20:23]
buffer_store_dwordx4 v[60:63], v1, s[52:55], s60 offen offset:3072 sc1
M a[20:23], v[104:107], a[200:203], a[20:23]
s_add_u32 s60, s56, 4096
buffer_store_dwordx4 v[80:83], v1, s[52:55], s60 offen offset:0 sc1
buffer_store_dwordx4 v[84:87], v1, s[52:55], s60 offen offset:1024 sc1
M a[24:27], v[112:115], a[200:203], a[24:27]
buffer_store_dwordx4 v[88:91], v1, s[52:55], s60 offen offset:2048 sc1
buffer_store_dwordx4 v[92:95], v1, s[52:55], s60 offen offset:3072 sc1
M a[24:27], v[116:119], a[204:207], a[24:27]
v_mov_b32 v11, 0
M a[28:31], v[124:127], a[204:207], a[28:31]
M a[28:31], v[120:123], a[200:203], a[28:31]
s_waitcnt vmcnt(26) lgkmcnt(0)
s_barrier
M a[0:3], v[160:163], a[208:211], a[0:3]
s_add_u32 m0, s42, 32768
s_nop 0
buffer_load_dwordx4 v6, s[48:51], s26 offen offset:0 lds
ds_read_b64_tr_b16 v[96:97], v28 offset:32768
ds_read_b64_tr_b16 v[98:99], v28 offset:34816
M a[0:3], v[164:167], a[212:215], a[0:3]
buffer_load_dwordx4 v7, s[48:51], s26 offen offset:1024 lds
M a[4:7], v[172:175], a[212:215], a[4:7]
ds_read_b64_tr_b16 v[100:101], v28 offset:36864
ds_read_b64_tr_b16 v[102:103], v28 offset:38912
M a[4:7], v[168:171], a[208:211], a[4:7]
buffer_load_dwordx4 a[160:163], v1, s[44:47], s25 offen offset:0 sc1
M a[8:11], v[176:179], a[208:211], a[8:11]
ds_read_b64_tr_b16 v[104:105], v29 offset:32768
ds_read_b64_tr_b16 v[106:107], v29 offset:34816
M a[8:11], v[180:183], a[212:215], a[8:11]
buffer_load_dwordx4 a[164:167], v1, s[44:47], s25 offen offset:1024 sc1
M a[12:15], v[188:191], a[212:215], a[12:15]
ds_read_b64_tr_b16 v[108:109], v29 offset:36864
ds_read_b64_tr_b16 v[110:111], v29 offset:38912
M a[12:15], v[184:187], a[208:211], a[12:15]
buffer_load_dwordx4 a[168:171], v1, s[44:47], s25 offen offset:2048 sc1
M a[16:19], v[160:163], a[216:219], a[16:19]
ds_read_b64_tr_b16 v[112:113], v30 offset:32768
ds_read_b64_tr_b16 v[114:115], v30 offset:34816
M a[16:19], v[164:167], a[220:223], a[16:19]
buffer_load_dwordx4 a[172:175], v1, s[44:47], s25 offen offset:3072 sc1
M a[20:23], v[172:175], a[220:223], a[20:23]
ds_read_b64_tr_b16 v[116:117], v30 offset:36864
ds_read_b64_tr_b16 v[118:119], v30 offset:38912
M a[20:23], v[168:171], a[216:219], a[20:23]
s_add_u32 s25, s25, 16384
s_add_u32 s26, s26, 131072
M a[24:27], v[176:179], a[216:219], a[24:27]
ds_read_b64_tr_b16 v[120:121], v31 offset:32768
ds_read_b64_tr_b16 v[122:123], v31 offset:34816
M a[24:27], v[180:183], a[220:223], a[24:27]
ds_read_b64_tr_b16 v[124:125], v31 offset:36864
ds_read_b64_tr_b16 v[126:127], v31 offset:38912
M a[28:31], v[188:191], a[220:223], a[28:31]
M a[28:31], v[184:187], a[216:219], a[28:31]
s_waitcnt vmcnt(6) lgkmcnt(0)
s_barrier
s_cmp_lg_u32 s101, 0
s_cbranch_scc1 Lk3f_15
v_mov_b32 v9, 1
s_mov_b64 exec, 1
buffer_store_dword v9, v11, s[52:55], s58 offen sc1
s_mov_b64 exec, -1
Lk3f_15:
M a[0:3], v[96:99], a[224:227], a[0:3]
s_add_u32 m0, s42, 49152
s_nop 0
buffer_load_dwordx4 v6, s[48:51], s26 offen offset:0 lds
ds_read_b64_tr_b16 v[160:161], v28 offset:49152
ds_read_b64_tr_b16 v[162:163], v28 offset:51200
M a[0:3], v[100:103], a[228:231], a[0:3]
buffer_load_dwordx4 v7, s[48:51], s26 offen offset:1024 lds
M a[4:7], v[108:111], a[228:231], a[4:7]
ds_read_b64_tr_b16 v[164:165], v28 offset:53248
ds_read_b64_tr_b16 v[166:167], v28 offset:55296
M a[4:7], v[104:107], a[224:227], a[4:7]
buffer_load_dwordx4 a[176:179], v1, s[44:47], s25 offen offset:0 sc1
M a[8:11], v[112:115], a[224:227], a[8:11]
ds_read_b64_tr_b16 v[168:169], v29 offset:49152
ds_read_b64_tr_b16 v[170:171], v29 offset:51200
M a[8:11], v[116:119], a[228:231], a[8:11]
buffer_load_dwordx4 a[180:183], v1, s[44:47], s25 offen offset:1024 sc1
M a[12:15], v[124:127], a[228:231], a[12:15]
ds_read_b64_tr_b16 v[172:173], v29 offset:53248
ds_read_b64_tr_b16 v[174:175], v29 offset:55296
M a[12:15], v[120:123], a[224:227], a[12:15]
buffer_load_dwordx4 a[184:187], v1, s[44:47], s25 offen offset:2048 sc1
M a[16:19], v[96:99], a[232:235], a[16:19]
ds_read_b64_tr_b16 v[176:177], v30 offset:49152
ds_read_b64_tr_b16 v[178:179], v30 offset:51200
M a[16:19], v[100:103], a[236:239], a[16:19]
buffer_load_dwordx4 a[188:191], v1, s[44:47], s25 offen offset:3072 sc1
M a[20:23], v[108:111], a[236:239], a[20:23]
ds_read_b64_tr_b16 v[180:181], v30 offset:53248
ds_read_b64_tr_b16 v[182:183], v30 offset:55296
M a[20:23], v[104:107], a[232:235], a[20:23]
s_add_u32 s25, s25, 16384
s_add_u32 s26, s26, 131072
M a[24:27], v[112:115], a[232:235], a[24:27]
ds_read_b64_tr_b16 v[184:185], v31 offset:49152
ds_read_b64_tr_b16 v[186:187], v31 offset:51200
M a[24:27], v[116:119], a[236:239], a[24:27]
ds_read_b64_tr_b16 v[188:189], v31 offset:53248
ds_read_b64_tr_b16 v[190:191], v31 offset:55296
M a[28:31], v[124:127], a[236:239], a[28:31]
M a[28:31], v[120:123], a[232:235], a[28:31]
s_waitcnt vmcnt(26) lgkmcnt(0)
s_barrier
M a[0:3], v[160:163], a[240:243], a[0:3]
ds_read_b64_tr_b16 v[96:97], v24 offset:0
ds_read_b64_tr_b16 v[98:99], v24 offset:2048
M a[0:3], v[164:167], a[244:247], a[0:3]
ds_read_b64_tr_b16 v[100:101], v24 offset:4096
ds_read_b64_tr_b16 v[102:103], v24 offset:6144
M a[4:7], v[172:175], a[244:247], a[4:7]
M a[4:7], v[168:171], a[240:243], a[4:7]
ds_read_b64_tr_b16 v[104:105], v25 offset:0
ds_read_b64_tr_b16 v[106:107], v25 offset:2048
M a[8:11], v[176:179], a[240:243], a[8:11]
M a[8:11], v[180:183], a[244:247], a[8:11]
ds_read_b64_tr_b16 v[108:109], v25 offset:4096
ds_read_b64_tr_b16 v[110:111], v25 offset:6144
M a[12:15], v[188:191], a[244:247], a[12:15]
M a[12:15], v[184:187], a[240:243], a[12:15]
ds_read_b64_tr_b16 v[112:113], v26 offset:0
ds_read_b64_tr_b16 v[114:115], v26 offset:2048
M a[16:19], v[160:163], a[248:251], a[16:19]
ds_read_b64_tr_b16 v[116:117], v26 offset:4096
ds_read_b64_tr_b16 v[118:119], v26 offset:6144
M a[16:19], v[164:167], a[252:255], a[16:19]
M a[20:23], v[172:175], a[252:255], a[20:23]
ds_read_b64_tr_b16 v[120:121], v27 offset:0
ds_read_b64_tr_b16 v[122:123], v27 offset:2048
M a[20:23], v[168:171], a[248:251], a[20:23]
M a[24:27], v[176:179], a[248:251], a[24:27]
ds_read_b64_tr_b16 v[124:125], v27 offset:4096
ds_read_b64_tr_b16 v[126:127], v27 offset:6144
M a[24:27], v[180:183], a[252:255], a[24:27]
M a[28:31], v[188:191], a[252:255], a[28:31]
M a[28:31], v[184:187], a[248:251], a[28:31]
s_waitcnt vmcnt(20) lgkmcnt(0)
s_barrier
M a[0:3], v[96:99], a[128:131], a[0:3]
ds_read_b64_tr_b16 v[160:161], v24 offset:16384
ds_read_b64_tr_b16 v[162:163], v24 offset:18432
M a[0:3], v[100:103], a[132:135], a[0:3]
ds_read_b64_tr_b16 v[164:165], v24 offset:20480
ds_read_b64_tr_b16 v[166:167], v24 offset:22528
M a[4:7], v[108:111], a[132:135], a[4:7]
M a[4:7], v[104:107], a[128:131], a[4:7]
ds_read_b64_tr_b16 v[168:169], v25 offset:16384
ds_read_b64_tr_b16 v[170:171], v25 offset:18432
M a[8:11], v[112:115], a[128:131], a[8:11]
M a[8:11], v[116:119], a[132:135], a[8:11]
ds_read_b64_tr_b16 v[172:173], v25 offset:20480
ds_read_b64_tr_b16 v[174:175], v25 offset:22528
M a[12:15], v[124:127], a[132:135], a[12:15]
M a[12:15], v[120:123], a[128:131], a[12:15]
ds_read_b64_tr_b16 v[176:177], v26 offset:16384
ds_read_b64_tr_b16 v[178:179], v26 offset:18432
M a[16:19], v[96:99], a[136:139], a[16:19]
ds_read_b64_tr_b16 v[180:181], v26 offset:20480
ds_read_b64_tr_b16 v[182:183], v26 offset:22528
M a[16:19], v[100:103], a[140:143], a[16:19]
M a[20:23], v[108:111], a[140:143], a[20:23]
ds_read_b64_tr_b16 v[184:185], v27 offset:16384
ds_read_b64_tr_b16 v[186:187], v27 offset:18432
M a[20:23], v[104:107], a[136:139], a[20:23]
M a[24:27], v[112:115], a[136:139], a[24:27]
ds_read_b64_tr_b16 v[188:189], v27 offset:20480
ds_read_b64_tr_b16 v[190:191], v27 offset:22528
M a[24:27], v[116:119], a[140:143], a[24:27]
M a[28:31], v[124:127], a[140:143], a[28:31]
M a[28:31], v[120:123], a[136:139], a[28:31]
s_waitcnt vmcnt(6) lgkmcnt(0)
s_barrier
M a[0:3], v[160:163], a[144:147], a[0:3]
buffer_load_dword v8, v11, s[52:55], s59 offen sc1
M a[0:3], v[164:167], a[148:151], a[0:3]
ds_read_b64_tr_b16 v[96:97], v24 offset:32768
ds_read_b64_tr_b16 v[98:99], v24 offset:34816
M a[4:7], v[172:175], a[148:151], a[4:7]
M a[4:7], v[168:171], a[144:147], a[4:7]
ds_read_b64_tr_b16 v[100:101], v24 offset:36864
ds_read_b64_tr_b16 v[102:103], v24 offset:38912
M a[8:11], v[176:179], a[144:147], a[8:11]
ds_read_b64_tr_b16 v[104:105], v25 offset:32768
ds_read_b64_tr_b16 v[106:107], v25 offset:34816
M a[8:11], v[180:183], a[148:151], a[8:11]
M a[12:15], v[188:191], a[148:151], a[12:15]
ds_read_b64_tr_b16 v[108:109], v25 offset:36864
ds_read_b64_tr_b16 v[110:111], v25 offset:38912
M a[12:15], v[184:187], a[144:147], a[12:15]
ds_read_b64_tr_b16 v[112:113], v26 offset:32768
ds_read_b64_tr_b16 v[114:115], v26 offset:34816
M a[16:19], v[160:163], a[152:155], a[16:19]
M a[16:19], v[164:167], a[156:159], a[16:19]
ds_read_b64_tr_b16 v[116:117], v26 offset:36864
ds_read_b64_tr_b16 v[118:119], v26 offset:38912
M a[20:23], v[172:175], a[156:159], a[20:23]
ds_read_b64_tr_b16 v[120:121], v27 offset:32768
ds_read_b64_tr_b16 v[122:123], v27 offset:34816
M a[20:23], v[168:171], a[152:155], a[20:23]
M a[24:27], v[176:179], a[152:155], a[24:27]
ds_read_b64_tr_b16 v[124:125], v27 offset:36864
ds_read_b64_tr_b16 v[126:127], v27 offset:38912
M a[24:27], v[180:183], a[156:159], a[24:27]
M a[28:31], v[188:191], a[156:159], a[28:31]
M a[28:31], v[184:187], a[152:155], a[28:31]
s_waitcnt vmcnt(1) lgkmcnt(0)
s_barrier
s_waitcnt vmcnt(0)
v_cmp_ne_u32 vcc, 1, v8
s_nop 0
s_cbranch_vccnz Lk3_spinfl
Lk3_gotfl:
M a[0:3], v[96:99], a[160:163], a[0:3]
s_add_u32 s60, s57, 0
buffer_load_dwordx4 v[224:227], v1, s[52:55], s60 offen offset:0 sc1
ds_read_b64_tr_b16 v[160:161], v24 offset:49152
ds_read_b64_tr_b16 v[162:163], v24 offset:51200
M a[0:3], v[100:103], a[164:167], a[0:3]
buffer_load_dwordx4 v[228:231], v1, s[52:55], s60 offen offset:1024 sc1
M a[4:7], v[108:111], a[164:167], a[4:7]
ds_read_b64_tr_b16 v[164:165], v24 offset:53248
ds_read_b64_tr_b16 v[166:167], v24 offset:55296
M a[4:7], v[104:107], a[160:163], a[4:7]
buffer_load_dwordx4 v[232:235], v1, s[52:55], s60 offen offset:2048 sc1
M a[8:11], v[112:115], a[160:163], a[8:11]
ds_read_b64_tr_b16 v[168:169], v25 offset:49152
ds_read_b64_tr_b16 v[170:171], v25 offset:51200
M a[8:11], v[116:119], a[164:167], a[8:11]
buffer_load_dwordx4 v[236:239], v1, s[52:55], s60 offen offset:3072 sc1
M a[12:15], v[124:127], a[164:167], a[12:15]
ds_read_b64_tr_b16 v[172:173], v25 offset:53248
ds_read_b64_tr_b16 v[174:175], v25 offset:55296
M a[12:15], v[120:123], a[160:163], a[12:15]
s_add_u32 s60, s57, 4096
buffer_load_dwordx4 v[240:243], v1, s[52:55], s60 offen offset:0 sc1
ds_read_b64_tr_b16 v[176:177], v26 offset:49152
ds_read_b64_tr_b16 v[178:179], v26 offset:51200
M a[16:19], v[96:99], a[168:171], a[16:19]
buffer_load_dwordx4 v[244:247], v1, s[52:55], s60 offen offset:1024 sc1
M a[16:19], v[100:103], a[172:175], a[16:19]
ds_read_b64_tr_b16 v[180:181], v26 offset:53248
ds_read_b64_tr_b16 v[182:183], v26 offset:55296
M a[20:23], v[108:111], a[172:175], a[20:23]
buffer_load_dwordx4 v[248:251], v1, s[52:55], s60 offen offset:2048 sc1
M a[20:23], v[104:107], a[168:171], a[20:23]
ds_read_b64_tr_b16 v[184:185], v27 offset:49152
ds_read_b64_tr_b16 v[186:187], v27 offset:51200
M a[24:27], v[112:115], a[168:171], a[24:27]
buffer_load_dwordx4 v[252:255], v1, s[52:55], s60 offen offset:3072 sc1
M a[24:27], v[116:119], a[172:175], a[24:27]
ds_read_b64_tr_b16 v[188:189], v27 offset:53248
ds_read_b64_tr_b16 v[190:191], v27 offset:55296
M a[28:31], v[124:127], a[172:175], a[28:31]
M a[28:31], v[120:123], a[168:171], a[28:31]
s_waitcnt lgkmcnt(0)
M a[0:3], v[160:163], a[176:179], a[0:3]
M a[0:3], v[164:167], a[180:183], a[0:3]
M a[4:7], v[172:175], a[180:183], a[4:7]
M a[4:7], v[168:171], a[176:179], a[4:7]
M a[8:11], v[176:179], a[176:179], a[8:11]
M a[8:11], v[180:183], a[180:183], a[8:11]
M a[12:15], v[188:191], a[180:183], a[12:15]
M a[12:15], v[184:187], a[176:179], a[12:15]
M a[16:19], v[160:163], a[184:187], a[16:19]
M a[16:19], v[164:167], a[188:191], a[16:19]
M a[20:23], v[172:175], a[188:191], a[20:23]
M a[20:23], v[168:171], a[184:187], a[20:23]
M a[24:27], v[176:179], a[184:187], a[24:27]
M a[24:27], v[180:183], a[188:191], a[24:27]
M a[28:31], v[188:191], a[188:191], a[28:31]
M a[28:31], v[184:187], a[184:187], a[28:31]
v_bfe_u32 v96, v0, 4, 1
v_lshrrev_b32 v97, 5, v0
v_lshl_or_b32 v96, v96, 1, v97
v_and_b32 v97, 15, v0
v_lshlrev_b32 v97, 13, v97
v_lshl_add_u32 v96, v96, 4, v97
s_and_b32 s3, s101, 1
s_lshl_b32 s3, s3, 6
s_lshr_b32 s6, s101, 1
s_add_u32 s3, s3, s6
s_add_u32 s3, s3, s21
s_lshl_b32 s3, s3, 12
s_lshl_b32 s6, s22, 1
s_add_u32 s3, s3, s6
s_add_u32 s3, s3, 2048
v_accvgpr_read_b32 v108, a0
v_accvgpr_read_b32 v109, a1
v_accvgpr_read_b32 v110, a2
v_accvgpr_read_b32 v111, a3
v_accvgpr_read_b32 v112, a4
v_accvgpr_read_b32 v113, a5
v_accvgpr_read_b32 v114, a6
v_accvgpr_read_b32 v115, a7
v_cvt_pk_bf16_f32 v100, v108, v109
v_cvt_pk_bf16_f32 v101, v110, v111
v_cvt_pk_bf16_f32 v102, v112, v113
v_cvt_pk_bf16_f32 v103, v114, v115
s_nop 0
v_permlane16_swap_b32 v100, v102
v_permlane16_swap_b32 v101, v103
buffer_store_dwordx4 v[100:103], v96, s[16:19], s3 offen offset:0
v_accvgpr_read_b32 v108, a8
v_accvgpr_read_b32 v109, a9
v_accvgpr_read_b32 v110, a10
v_accvgpr_read_b32 v111, a11
v_accvgpr_read_b32 v112, a12
v_accvgpr_read_b32 v113, a13
v_accvgpr_read_b32 v114, a14
v_accvgpr_read_b32 v115, a15
v_cvt_pk_bf16_f32 v104, v108, v109
v_cvt_pk_bf16_f32 v105, v110, v111
v_cvt_pk_bf16_f32 v106, v112, v113
v_cvt_pk_bf16_f32 v107, v114, v115
s_nop 0
v_permlane16_swap_b32 v104, v106
v_permlane16_swap_b32 v105, v107
buffer_store_dwordx4 v[104:107], v96, s[16:19], s3 offen offset:64
s_add_u32 s3, s3, 131072
v_accvgpr_read_b32 v108, a16
v_accvgpr_read_b32 v109, a17
v_accvgpr_read_b32 v110, a18
v_accvgpr_read_b32 v111, a19
v_accvgpr_read_b32 v112, a20
v_accvgpr_read_b32 v113, a21
v_accvgpr_read_b32 v114, a22
v_accvgpr_read_b32 v115, a23
v_cvt_pk_bf16_f32 v100, v108, v109
v_cvt_pk_bf16_f32 v101, v110, v111
v_cvt_pk_bf16_f32 v102, v112, v113
v_cvt_pk_bf16_f32 v103, v114, v115
s_nop 0
v_permlane16_swap_b32 v100, v102
v_permlane16_swap_b32 v101, v103
buffer_store_dwordx4 v[100:103], v96, s[16:19], s3 offen offset:0
v_accvgpr_read_b32 v108, a24
v_accvgpr_read_b32 v109, a25
v_accvgpr_read_b32 v110, a26
v_accvgpr_read_b32 v111, a27
v_accvgpr_read_b32 v112, a28
v_accvgpr_read_b32 v113, a29
v_accvgpr_read_b32 v114, a30
v_accvgpr_read_b32 v115, a31
v_cvt_pk_bf16_f32 v104, v108, v109
v_cvt_pk_bf16_f32 v105, v110, v111
v_cvt_pk_bf16_f32 v106, v112, v113
v_cvt_pk_bf16_f32 v107, v114, v115
s_nop 0
v_permlane16_swap_b32 v104, v106
v_permlane16_swap_b32 v105, v107
buffer_store_dwordx4 v[104:107], v96, s[16:19], s3 offen offset:64
v_bfe_u32 v128, v0, 4, 1
v_lshrrev_b32 v129, 5, v0
v_lshl_or_b32 v128, v128, 1, v129
v_and_b32 v129, 15, v0
v_lshlrev_b32 v129, 12, v129
v_lshl_add_u32 v128, v128, 4, v129
s_lshl_b32 s3, s101, 5
s_add_u32 s3, s3, s29
s_lshl_b32 s3, s3, 12
s_lshl_b32 s6, s30, 1
s_add_u32 s3, s3, s6
s_waitcnt vmcnt(4)
v_pk_add_f32 v[32:33], v[32:33], v[224:225]
v_pk_add_f32 v[34:35], v[34:35], v[226:227]
v_pk_add_f32 v[36:37], v[36:37], v[228:229]
v_pk_add_f32 v[38:39], v[38:39], v[230:231]
v_cvt_pk_bf16_f32 v132, v32, v33
v_cvt_pk_bf16_f32 v133, v34, v35
v_cvt_pk_bf16_f32 v134, v36, v37
v_cvt_pk_bf16_f32 v135, v38, v39
s_nop 0
v_permlane16_swap_b32 v132, v134
v_permlane16_swap_b32 v133, v135
buffer_store_dwordx4 v[132:135], v128, s[16:19], s3 offen offset:0
v_pk_add_f32 v[40:41], v[40:41], v[232:233]
v_pk_add_f32 v[42:43], v[42:43], v[234:235]
v_pk_add_f32 v[44:45], v[44:45], v[236:237]
v_pk_add_f32 v[46:47], v[46:47], v[238:239]
v_cvt_pk_bf16_f32 v136, v40, v41
v_cvt_pk_bf16_f32 v137, v42, v43
v_cvt_pk_bf16_f32 v138, v44, v45
v_cvt_pk_bf16_f32 v139, v46, v47
s_nop 0
v_permlane16_swap_b32 v136, v138
v_permlane16_swap_b32 v137, v139
buffer_store_dwordx4 v[136:139], v128, s[16:19], s3 offen offset:64
s_add_u32 s3, s3, 65536
v_pk_add_f32 v[64:65], v[64:65], v[240:241]
v_pk_add_f32 v[66:67], v[66:67], v[242:243]
v_pk_add_f32 v[68:69], v[68:69], v[244:245]
v_pk_add_f32 v[70:71], v[70:71], v[246:247]
v_cvt_pk_bf16_f32 v132, v64, v65
v_cvt_pk_bf16_f32 v133, v66, v67
v_cvt_pk_bf16_f32 v134, v68, v69
v_cvt_pk_bf16_f32 v135, v70, v71
s_nop 0
v_permlane16_swap_b32 v132, v134
v_permlane16_swap_b32 v133, v135
buffer_store_dwordx4 v[132:135], v128, s[16:19], s3 offen offset:0
v_pk_add_f32 v[72:73], v[72:73], v[248:249]
v_pk_add_f32 v[74:75], v[74:75], v[250:251]
v_pk_add_f32 v[76:77], v[76:77], v[252:253]
v_pk_add_f32 v[78:79], v[78:79], v[254:255]
v_cvt_pk_bf16_f32 v136, v72, v73
v_cvt_pk_bf16_f32 v137, v74, v75
v_cvt_pk_bf16_f32 v138, v76, v77
v_cvt_pk_bf16_f32 v139, v78, v79
s_nop 0
v_permlane16_swap_b32 v136, v138
v_permlane16_swap_b32 v137, v139
buffer_store_dwordx4 v[136:139], v128, s[16:19], s3 offen offset:64
s_endpgm
Lk3_spinb0:
Lk3_spinb0_:
s_add_u32 s61, s61, 1
s_cmp_gt_u32 s61, 1048576
s_cbranch_scc1 Lk3_gotb0
s_sleep 2
buffer_load_dword v7, v15, s[52:55], s43 offen sc1
s_waitcnt vmcnt(0)
v_cmp_ne_u32 vcc, 1, v7
s_nop 0
s_cbranch_vccnz Lk3_spinb0_
s_branch Lk3_gotb0
Lk3_spinb1:
Lk3_spinb1_:
s_add_u32 s61, s61, 1
s_cmp_gt_u32 s61, 1048576
s_cbranch_scc1 Lk3_gotb1
s_sleep 2
buffer_load_dword v7, v15, s[52:55], s43 offen sc1
s_waitcnt vmcnt(0)
v_cmp_ne_u32 vcc, 1, v7
s_nop 0
s_cbranch_vccnz Lk3_spinb1_
s_branch Lk3_gotb1
Lk3_spinft:
s_add_u32 s61, s61, 1
s_cmp_gt_u32 s61, 1048576
s_cbranch_scc1 Lk3_gotft
s_sleep 2
buffer_load_dword v252, v255, s[52:55], s62 offen sc1
s_waitcnt vmcnt(0)
v_cmp_ne_u32 vcc, 1, v252
s_nop 0
s_cbranch_vccnz Lk3_spinft
s_branch Lk3_gotft
Lk3_spinfl:
s_add_u32 s61, s61, 1
s_cmp_gt_u32 s61, 1048576
s_cbranch_scc1 Lk3_gotfl
s_sleep 2
buffer_load_dword v8, v11, s[52:55], s59 offen sc1
s_waitcnt vmcnt(0)
v_cmp_ne_u32 vcc, 1, v8
s_nop 0
s_cbranch_vccnz Lk3_spinfl
s_branch Lk3_gotfl
Lc3:
.section .rodata,"a"
.p2align 6
.amdhsa_kernel concat_heads__compressed_kv_cla__sliding_local_dilated__prompt_kernel
  .amdhsa_next_free_vgpr 512
  .amdhsa_next_free_sgpr 102
  .amdhsa_accum_offset 256
  .amdhsa_group_segment_fixed_size 0
  .amdhsa_kernarg_size 96
  .amdhsa_user_sgpr_count 2
  .amdhsa_user_sgpr_kernarg_segment_ptr 1
  .amdhsa_system_sgpr_workgroup_id_x 1
.end_amdhsa_kernel
```

```asm
; @launch grid=(256,1,1) block=(256,1,1) lds=163840
.amdgcn_target "amdgcn-amd-amdhsa--gfx950"
.text
.macro M d, a, b, c
v_mfma_f32_16x16x32_bf16 \d, \a, \b, \c
.endm
.globl concat_heads__compressed_kv_cla__sliding_local_dilated__prompt_kernel
.p2align 8
.type concat_heads__compressed_kv_cla__sliding_local_dilated__prompt_kernel,@function
concat_heads__compressed_kv_cla__sliding_local_dilated__prompt_kernel:
s_cmp_lt_u32 s2, 256
s_cbranch_scc1 Lk1_go
s_endpgm
Lk1_go:
s_load_dwordx16 s[32:47], s[0:1], 0
s_load_dwordx2 s[48:49], s[0:1], 64
s_load_dwordx2 s[50:51], s[0:1], 88
s_load_dwordx2 s[90:91], s[0:1], 80
v_lshrrev_b32 v24, 6, v0
s_nop 0
v_readfirstlane_b32 s20, v24
v_and_b32 v0, 63, v0
v_lshlrev_b32 v1, 4, v0
s_mov_b32 s101, s20
s_lshr_b32 s21, s20, 1
s_and_b32 s22, s20, 1
s_lshl_b32 s29, s20, 12
s_and_b32 s3, s2, 1
s_lshl_b32 s3, s3, 2
s_bfe_u32 s6, s2, 0x20003
s_add_u32 s3, s3, s6
s_lshl_b32 s52, s3, 8
s_bfe_u32 s3, s2, 0x20001
s_lshl_b32 s3, s3, 2
s_bfe_u32 s7, s2, 0x20005
s_add_u32 s3, s3, s7
s_lshl_b32 s53, s3, 8
s_cmp_lt_u32 s2, 128
s_cselect_b32 s5, 11, 10
s_lshl_b32 s3, s21, 7
s_lshl_b32 s4, s22, 5
s_add_u32 s3, s3, s4
v_lshrrev_b32 v24, 3, v0
v_add_u32 v24, s3, v24
v_and_b32 v25, 7, v0
v_add_u32 v26, 0, v24
v_bfe_u32 v27, v26, 1, 3
v_xor_b32 v27, v27, v25
v_lshlrev_b32 v26, s5, v26
v_lshl_add_u32 v26, v27, 4, v26
v_subrev_u32 v2, 0, v26
v_add_u32 v26, 8, v24
v_bfe_u32 v27, v26, 1, 3
v_xor_b32 v27, v27, v25
v_lshlrev_b32 v26, s5, v26
v_lshl_add_u32 v26, v27, 4, v26
v_subrev_u32 v3, 1024, v26
v_add_u32 v26, 16, v24
v_bfe_u32 v27, v26, 1, 3
v_xor_b32 v27, v27, v25
v_lshlrev_b32 v26, s5, v26
v_lshl_add_u32 v26, v27, 4, v26
v_subrev_u32 v4, 2048, v26
v_add_u32 v26, 24, v24
v_bfe_u32 v27, v26, 1, 3
v_xor_b32 v27, v27, v25
v_lshlrev_b32 v26, s5, v26
v_lshl_add_u32 v26, v27, 4, v26
v_subrev_u32 v5, 3072, v26
s_lshl_b32 s3, s20, 3
v_lshrrev_b32 v24, 5, v0
v_add_u32 v24, s3, v24
v_and_b32 v25, 31, v0
v_add_u32 v26, 0, v24
v_and_b32 v27, 3, v26
v_lshlrev_b32 v27, 1, v27
v_and_or_b32 v27, v26, 8, v27
v_xor_b32 v27, v27, v25
v_lshlrev_b32 v26, 13, v26
v_lshl_add_u32 v26, v27, 4, v26
v_subrev_u32 v6, 0, v26
v_add_u32 v26, 2, v24
v_and_b32 v27, 3, v26
v_lshlrev_b32 v27, 1, v27
v_and_or_b32 v27, v26, 8, v27
v_xor_b32 v27, v27, v25
v_lshlrev_b32 v26, 13, v26
v_lshl_add_u32 v26, v27, 4, v26
v_subrev_u32 v7, 1024, v26
v_add_u32 v26, 4, v24
v_and_b32 v27, 3, v26
v_lshlrev_b32 v27, 1, v27
v_and_or_b32 v27, v26, 8, v27
v_xor_b32 v27, v27, v25
v_lshlrev_b32 v26, 13, v26
v_lshl_add_u32 v26, v27, 4, v26
v_subrev_u32 v8, 2048, v26
v_add_u32 v26, 6, v24
v_and_b32 v27, 3, v26
v_lshlrev_b32 v27, 1, v27
v_and_or_b32 v27, v26, 8, v27
v_xor_b32 v27, v27, v25
v_lshlrev_b32 v26, 13, v26
v_lshl_add_u32 v26, v27, 4, v26
v_subrev_u32 v9, 3072, v26
s_lshl_b32 s23, s52, s5
s_lshl_b32 s31, 64, s5
s_mov_b32 s26, s23
s_lshl_b32 s24, s53, 1
s_mov_b32 s28, s24
s_lshl_b32 s3, 1, s5
s_add_u32 s25, s23, s3
s_lshl_b32 s3, s3, 12
s_add_u32 s27, s24, s3
s_bfe_u32 s3, s2, 0x20001
s_and_b32 s4, s2, 1
s_lshl_b32 s4, s4, 1
s_add_u32 s3, s3, s4
s_and_b32 s3, s3, 3
s_sub_u32 s4, s5, 2
s_lshl_b32 s3, s3, s4
s_add_u32 s23, s23, s3
s_lshl_b32 s3, s3, 12
s_add_u32 s24, s24, s3
s_mov_b32 s95, s6
s_cmp_lt_u32 s2, 128
s_cselect_b32 s6, -1, 8
s_waitcnt lgkmcnt(0)
s_cmp_lt_u32 s2, 128
s_cselect_b64 s[8:9], s[32:33], s[34:35]
s_mov_b32 s10, 2097152
s_cselect_b32 s10, 4194304, s10
s_mov_b32 s11, 0x00020000
s_cselect_b64 s[12:13], s[36:37], s[38:39]
s_mov_b32 s14, 4194304
s_cselect_b32 s14, 8388608, s14
s_mov_b32 s15, 0x00020000
s_mov_b64 s[64:65], s[40:41]
s_add_u32 m0, s29, 65536
s_nop 0
buffer_load_dwordx4 v6, s[12:15], s24 offen offset:0 lds
buffer_load_dwordx4 v7, s[12:15], s24 offen offset:1024 lds
buffer_load_dwordx4 v8, s[12:15], s24 offen offset:2048 lds
buffer_load_dwordx4 v9, s[12:15], s24 offen offset:3072 lds
s_add_u32 s24, s24, 262144
s_add_u32 m0, s29, 0
s_nop 0
buffer_load_dwordx4 v2, s[8:11], s23 offen offset:0 lds
buffer_load_dwordx4 v3, s[8:11], s23 offen offset:1024 lds
buffer_load_dwordx4 v4, s[8:11], s23 offen offset:2048 lds
buffer_load_dwordx4 v5, s[8:11], s23 offen offset:3072 lds
s_add_u32 m0, s29, 81920
s_nop 0
buffer_load_dwordx4 v6, s[12:15], s24 offen offset:0 lds
buffer_load_dwordx4 v7, s[12:15], s24 offen offset:1024 lds
buffer_load_dwordx4 v8, s[12:15], s24 offen offset:2048 lds
buffer_load_dwordx4 v9, s[12:15], s24 offen offset:3072 lds
s_add_u32 s24, s24, 262144
s_cmp_eq_u32 s24, s27
s_cselect_b32 s24, s28, s24
s_sub_u32 s6, s6, 1
s_cmp_eq_u32 s6, 0
s_cselect_b64 s[12:13], s[64:65], s[12:13]
s_add_u32 m0, s29, 98304
s_nop 0
buffer_load_dwordx4 v6, s[12:15], s24 offen offset:0 lds
buffer_load_dwordx4 v7, s[12:15], s24 offen offset:1024 lds
buffer_load_dwordx4 v8, s[12:15], s24 offen offset:2048 lds
buffer_load_dwordx4 v9, s[12:15], s24 offen offset:3072 lds
s_add_u32 s24, s24, 262144
s_add_u32 m0, s29, 16384
s_add_u32 s3, s23, s31
s_nop 0
buffer_load_dwordx4 v2, s[8:11], s3 offen offset:0 lds
buffer_load_dwordx4 v3, s[8:11], s3 offen offset:1024 lds
buffer_load_dwordx4 v4, s[8:11], s3 offen offset:2048 lds
buffer_load_dwordx4 v5, s[8:11], s3 offen offset:3072 lds
s_add_u32 s23, s23, 128
s_cmp_eq_u32 s23, s25
s_cselect_b32 s23, s26, s23
s_add_u32 m0, s29, 114688
s_nop 0
buffer_load_dwordx4 v6, s[12:15], s24 offen offset:0 lds
buffer_load_dwordx4 v7, s[12:15], s24 offen offset:1024 lds
buffer_load_dwordx4 v8, s[12:15], s24 offen offset:2048 lds
buffer_load_dwordx4 v9, s[12:15], s24 offen offset:3072 lds
s_add_u32 s24, s24, 262144
s_cmp_eq_u32 s24, s27
s_cselect_b32 s24, s28, s24
s_sub_u32 s6, s6, 1
s_cmp_eq_u32 s6, 0
s_cselect_b64 s[12:13], s[64:65], s[12:13]
s_add_u32 s16, s50, 109051904
s_addc_u32 s17, s51, 0
s_mov_b32 s18, 16384
s_mov_b32 s19, 0x00020000
v_mov_b32 v24, 0
v_mov_b32 v25, 0
v_mov_b32 v26, 0
v_mov_b32 v27, 0
s_lshl_b32 s3, s2, 2
buffer_store_dword v24, v24, s[16:19], s3 offen sc1
s_and_b32 s3, s2, 7
s_lshr_b32 s4, s2, 6
s_lshl_b32 s4, s4, 3
s_add_u32 s3, s3, s4
s_lshl_b32 s3, s3, 4
s_add_u32 s3, s3, 4096
s_bfe_u32 s4, s2, 0x30003
s_lshl_b32 s4, s4, 9
s_add_u32 s92, s3, s4
s_sub_u32 s4, 7680, s4
s_add_u32 s93, s3, s4
buffer_store_dwordx4 v[24:27], v24, s[16:19], s92 offen sc1
buffer_store_dwordx4 v[24:27], v24, s[16:19], s93 offen sc1
s_and_b32 s3, s2, 1
s_lshl_b32 s3, s3, 3
s_bfe_u32 s4, s2, 0x30003
s_add_u32 s92, s3, s4
s_bfe_u32 s3, s2, 0x20001
s_lshl_b32 s3, s3, 2
s_lshr_b32 s4, s2, 6
s_xor_b32 s4, s4, 2
s_add_u32 s93, s3, s4
s_lshl_b32 s92, s92, 8
s_lshl_b32 s93, s93, 4
s_add_u32 s92, s92, s93
s_add_u32 s92, s92, 12288
buffer_store_dwordx4 v[24:27], v24, s[16:19], s92 offen sc1
v_lshlrev_b32 v20, 7, v0
s_lshl_b32 s54, s2, 13
s_mov_b64 s[60:61], s[40:41]
s_mov_b32 s62, 0
s_cmp_eq_u32 s20, 1
s_cselect_b64 s[60:61], s[46:47], s[60:61]
s_cselect_b32 s62, 6291456, s62
s_cmp_eq_u32 s20, 2
s_cselect_b64 s[60:61], s[44:45], s[60:61]
s_cselect_b32 s62, 4194304, s62
s_cmp_eq_u32 s20, 3
s_cselect_b32 s62, 0, s62
s_mov_b32 s63, 0x00020000
s_mov_b32 s3, 0
s_cmp_eq_u32 s20, 1
s_cselect_b32 s3, 6291456, s3
s_cmp_eq_u32 s20, 2
s_cselect_b32 s3, 6291456, s3
s_sub_u32 s54, s54, s3
Lc0:
s_getpc_b64 s[92:93]
Lpc_1:
s_add_u32 s92, s92, Lc1-Lpc_1
s_addc_u32 s93, s93, 0
s_lshr_b32 s94, s2, 3
s_mul_i32 s94, s94, ((Lc3-Lc1)/32+127)&~127
v_lshlrev_b32 v24, 7, v0
v_add_u32 v24, s94, v24
v_min_u32 v24, Lc3-Lc1-4, v24
global_load_dword v21, v24, s[92:93]
s_add_u32 m0, s29, 32768
s_nop 0
buffer_load_dwordx4 v2, s[8:11], s23 offen offset:0 lds
buffer_load_dwordx4 v3, s[8:11], s23 offen offset:1024 lds
buffer_load_dwordx4 v4, s[8:11], s23 offen offset:2048 lds
buffer_load_dwordx4 v5, s[8:11], s23 offen offset:3072 lds
s_lshl_b32 s4, s21, 13
v_and_b32 v24, 15, v0
v_lshlrev_b32 v24, 7, v24
v_add_u32 v24, s4, v24
v_bfe_u32 v25, v0, 1, 3
v_lshrrev_b32 v26, 4, v0
v_xor_b32 v25, v25, v26
v_lshl_add_u32 v10, v25, 4, v24
v_xor_b32 v11, 64, v10
v_bfe_u32 v24, v0, 2, 2
v_lshl_add_u32 v29, v26, 3, v24
v_lshlrev_b32 v25, 9, v29
v_and_b32 v27, 1, v0
v_lshl_add_u32 v25, v27, 3, v25
v_add_u32 v25, 65536, v25
v_lshlrev_b32 v24, 1, v24
v_and_or_b32 v24, v29, 8, v24
v_bfe_u32 v26, v0, 1, 1
s_lshl_b32 s4, s22, 4
s_add_u32 s3, s4, 0
v_add_u32 v27, s3, v26
v_xor_b32 v27, v27, v24
v_lshl_add_u32 v12, v27, 4, v25
s_add_u32 s3, s4, 2
v_add_u32 v27, s3, v26
v_xor_b32 v27, v27, v24
v_lshl_add_u32 v13, v27, 4, v25
s_add_u32 s3, s4, 4
v_add_u32 v27, s3, v26
v_xor_b32 v27, v27, v24
v_lshl_add_u32 v14, v27, 4, v25
s_add_u32 s3, s4, 6
v_add_u32 v27, s3, v26
v_xor_b32 v27, v27, v24
v_lshl_add_u32 v15, v27, 4, v25
s_add_u32 s3, s4, 8
v_add_u32 v27, s3, v26
v_xor_b32 v27, v27, v24
v_lshl_add_u32 v16, v27, 4, v25
s_add_u32 s3, s4, 10
v_add_u32 v27, s3, v26
v_xor_b32 v27, v27, v24
v_lshl_add_u32 v17, v27, 4, v25
s_add_u32 s3, s4, 12
v_add_u32 v27, s3, v26
v_xor_b32 v27, v27, v24
v_lshl_add_u32 v18, v27, 4, v25
s_add_u32 s3, s4, 14
v_add_u32 v27, s3, v26
v_xor_b32 v27, v27, v24
v_lshl_add_u32 v19, v27, 4, v25
s_waitcnt vmcnt(21)
s_barrier
ds_read_b64_tr_b16 a[32:33], v12 offset:0
ds_read_b64_tr_b16 a[34:35], v12 offset:2048
ds_read_b64_tr_b16 a[40:41], v13 offset:0
ds_read_b64_tr_b16 a[42:43], v13 offset:2048
ds_read_b64_tr_b16 a[48:49], v14 offset:0
ds_read_b64_tr_b16 a[50:51], v14 offset:2048
ds_read_b64_tr_b16 a[56:57], v15 offset:0
ds_read_b64_tr_b16 a[58:59], v15 offset:2048
ds_read_b64_tr_b16 a[64:65], v16 offset:0
ds_read_b64_tr_b16 a[66:67], v16 offset:2048
ds_read_b64_tr_b16 a[72:73], v17 offset:0
ds_read_b64_tr_b16 a[74:75], v17 offset:2048
ds_read_b64_tr_b16 a[80:81], v18 offset:0
ds_read_b64_tr_b16 a[82:83], v18 offset:2048
ds_read_b64_tr_b16 a[88:89], v19 offset:0
ds_read_b64_tr_b16 a[90:91], v19 offset:2048
ds_read_b64_tr_b16 a[36:37], v12 offset:16384
ds_read_b64_tr_b16 a[38:39], v12 offset:18432
ds_read_b64_tr_b16 a[44:45], v13 offset:16384
ds_read_b64_tr_b16 a[46:47], v13 offset:18432
ds_read_b64_tr_b16 a[52:53], v14 offset:16384
ds_read_b64_tr_b16 a[54:55], v14 offset:18432
ds_read_b64_tr_b16 a[60:61], v15 offset:16384
ds_read_b64_tr_b16 a[62:63], v15 offset:18432
ds_read_b64_tr_b16 a[68:69], v16 offset:16384
ds_read_b64_tr_b16 a[70:71], v16 offset:18432
ds_read_b64_tr_b16 a[76:77], v17 offset:16384
ds_read_b64_tr_b16 a[78:79], v17 offset:18432
ds_read_b64_tr_b16 a[84:85], v18 offset:16384
ds_read_b64_tr_b16 a[86:87], v18 offset:18432
ds_read_b64_tr_b16 a[92:93], v19 offset:16384
ds_read_b64_tr_b16 a[94:95], v19 offset:18432
ds_read_b128 a[160:163], v10 offset:0
ds_read_b128 a[164:167], v11 offset:0
ds_read_b128 a[168:171], v10 offset:2048
ds_read_b128 a[172:175], v11 offset:2048
s_waitcnt vmcnt(17) lgkmcnt(0)
s_barrier
s_add_u32 m0, s29, 65536
s_nop 0
buffer_load_dwordx4 v6, s[12:15], s24 offen offset:0 lds
buffer_load_dwordx4 v7, s[12:15], s24 offen offset:1024 lds
buffer_load_dwordx4 v8, s[12:15], s24 offen offset:2048 lds
buffer_load_dwordx4 v9, s[12:15], s24 offen offset:3072 lds
s_add_u32 s24, s24, 262144
s_add_u32 m0, s29, 49152
s_add_u32 s3, s23, s31
s_nop 0
buffer_load_dwordx4 v2, s[8:11], s3 offen offset:0 lds
buffer_load_dwordx4 v3, s[8:11], s3 offen offset:1024 lds
buffer_load_dwordx4 v4, s[8:11], s3 offen offset:2048 lds
buffer_load_dwordx4 v5, s[8:11], s3 offen offset:3072 lds
Lc1:
s_cmp_lt_u32 s2, 128
s_cbranch_scc0 Lk1_kv
M v[32:35], a[32:35], a[160:163], 0
s_add_u32 s23, s23, 128
s_cmp_eq_u32 s23, s25
s_cselect_b32 s23, s26, s23
M v[32:35], a[36:39], a[164:167], v[32:35]
ds_read_b128 a[176:179], v10 offset:4096
ds_read_b128 a[180:183], v11 offset:4096
M v[36:39], a[44:47], a[164:167], 0
M v[36:39], a[40:43], a[160:163], v[36:39]
ds_read_b64_tr_b16 a[96:97], v12 offset:32768
ds_read_b64_tr_b16 a[98:99], v12 offset:34816
M v[40:43], a[48:51], a[160:163], 0
M v[40:43], a[52:55], a[164:167], v[40:43]
M v[44:47], a[60:63], a[164:167], 0
s_add_u32 m0, s29, 81920
s_nop 0
buffer_load_dwordx4 v6, s[12:15], s24 offen offset:0 lds
M v[44:47], a[56:59], a[160:163], v[44:47]
ds_read_b64_tr_b16 a[104:105], v13 offset:32768
ds_read_b64_tr_b16 a[106:107], v13 offset:34816
M v[48:51], a[64:67], a[160:163], 0
M v[48:51], a[68:71], a[164:167], v[48:51]
M v[52:55], a[76:79], a[164:167], 0
M v[52:55], a[72:75], a[160:163], v[52:55]
ds_read_b64_tr_b16 a[112:113], v14 offset:32768
ds_read_b64_tr_b16 a[114:115], v14 offset:34816
M v[56:59], a[80:83], a[160:163], 0
M v[56:59], a[84:87], a[164:167], v[56:59]
buffer_load_dwordx4 v7, s[12:15], s24 offen offset:1024 lds
M v[60:63], a[92:95], a[164:167], 0
M v[60:63], a[88:91], a[160:163], v[60:63]
ds_read_b64_tr_b16 a[120:121], v15 offset:32768
ds_read_b64_tr_b16 a[122:123], v15 offset:34816
M v[64:67], a[32:35], a[168:171], 0
M v[64:67], a[36:39], a[172:175], v[64:67]
ds_read_b128 a[184:187], v10 offset:6144
ds_read_b128 a[188:191], v11 offset:6144
M v[68:71], a[44:47], a[172:175], 0
M v[68:71], a[40:43], a[168:171], v[68:71]
ds_read_b64_tr_b16 a[128:129], v16 offset:32768
ds_read_b64_tr_b16 a[130:131], v16 offset:34816
M v[72:75], a[48:51], a[168:171], 0
buffer_load_dwordx4 v8, s[12:15], s24 offen offset:2048 lds
M v[72:75], a[52:55], a[172:175], v[72:75]
M v[76:79], a[60:63], a[172:175], 0
M v[76:79], a[56:59], a[168:171], v[76:79]
ds_read_b64_tr_b16 a[136:137], v17 offset:32768
ds_read_b64_tr_b16 a[138:139], v17 offset:34816
M v[80:83], a[64:67], a[168:171], 0
M v[80:83], a[68:71], a[172:175], v[80:83]
M v[84:87], a[76:79], a[172:175], 0
buffer_load_dwordx4 v9, s[12:15], s24 offen offset:3072 lds
M v[84:87], a[72:75], a[168:171], v[84:87]
ds_read_b64_tr_b16 a[144:145], v18 offset:32768
ds_read_b64_tr_b16 a[146:147], v18 offset:34816
M v[88:91], a[80:83], a[168:171], 0
M v[88:91], a[84:87], a[172:175], v[88:91]
M v[92:95], a[92:95], a[172:175], 0
M v[92:95], a[88:91], a[168:171], v[92:95]
s_waitcnt lgkmcnt(15)
ds_read_b64_tr_b16 a[152:153], v19 offset:32768
ds_read_b64_tr_b16 a[154:155], v19 offset:34816
M v[96:99], a[32:35], a[176:179], 0
s_add_u32 s24, s24, 262144
s_cmp_eq_u32 s24, s27
s_cselect_b32 s24, s28, s24
s_sub_u32 s6, s6, 1
s_cmp_eq_u32 s6, 0
s_cselect_b64 s[12:13], s[64:65], s[12:13]
M v[96:99], a[36:39], a[180:183], v[96:99]
M v[100:103], a[44:47], a[180:183], 0
M v[100:103], a[40:43], a[176:179], v[100:103]
M v[104:107], a[48:51], a[176:179], 0
M v[104:107], a[52:55], a[180:183], v[104:107]
M v[108:111], a[60:63], a[180:183], 0
M v[108:111], a[56:59], a[176:179], v[108:111]
s_waitcnt vmcnt(21) lgkmcnt(0)
s_barrier
ds_read_b128 a[160:163], v10 offset:16384
ds_read_b128 a[164:167], v11 offset:16384
M v[112:115], a[64:67], a[176:179], 0
s_add_u32 m0, s29, 0
s_nop 0
buffer_load_dwordx4 v2, s[8:11], s23 offen offset:0 lds
M v[112:115], a[68:71], a[180:183], v[112:115]
M v[116:119], a[76:79], a[180:183], 0
M v[116:119], a[72:75], a[176:179], v[116:119]
ds_read_b64_tr_b16 a[100:101], v12 offset:49152
ds_read_b64_tr_b16 a[102:103], v12 offset:51200
M v[120:123], a[80:83], a[176:179], 0
M v[120:123], a[84:87], a[180:183], v[120:123]
buffer_load_dwordx4 v3, s[8:11], s23 offen offset:1024 lds
M v[124:127], a[92:95], a[180:183], 0
M v[124:127], a[88:91], a[176:179], v[124:127]
M v[128:131], a[32:35], a[184:187], 0
M v[128:131], a[36:39], a[188:191], v[128:131]
ds_read_b128 a[168:171], v10 offset:18432
ds_read_b128 a[172:175], v11 offset:18432
ds_read_b64_tr_b16 a[108:109], v13 offset:49152
ds_read_b64_tr_b16 a[110:111], v13 offset:51200
M v[132:135], a[44:47], a[188:191], 0
M v[132:135], a[40:43], a[184:187], v[132:135]
M v[136:139], a[48:51], a[184:187], 0
buffer_load_dwordx4 v4, s[8:11], s23 offen offset:2048 lds
M v[136:139], a[52:55], a[188:191], v[136:139]
M v[140:143], a[60:63], a[188:191], 0
M v[140:143], a[56:59], a[184:187], v[140:143]
ds_read_b64_tr_b16 a[116:117], v14 offset:49152
ds_read_b64_tr_b16 a[118:119], v14 offset:51200
M v[144:147], a[64:67], a[184:187], 0
M v[144:147], a[68:71], a[188:191], v[144:147]
M v[148:151], a[76:79], a[188:191], 0
buffer_load_dwordx4 v5, s[8:11], s23 offen offset:3072 lds
M v[148:151], a[72:75], a[184:187], v[148:151]
M v[152:155], a[80:83], a[184:187], 0
M v[152:155], a[84:87], a[188:191], v[152:155]
ds_read_b64_tr_b16 a[124:125], v15 offset:49152
ds_read_b64_tr_b16 a[126:127], v15 offset:51200
M v[156:159], a[92:95], a[188:191], 0
M v[156:159], a[88:91], a[184:187], v[156:159]
s_waitcnt lgkmcnt(10)
M v[160:163], a[32:35], a[160:163], 0
M v[160:163], a[36:39], a[164:167], v[160:163]
ds_read_b128 a[176:179], v10 offset:20480
ds_read_b128 a[180:183], v11 offset:20480
M v[164:167], a[44:47], a[164:167], 0
s_add_u32 m0, s29, 98304
s_nop 0
buffer_load_dwordx4 v6, s[12:15], s24 offen offset:0 lds
M v[164:167], a[40:43], a[160:163], v[164:167]
ds_read_b64_tr_b16 a[132:133], v16 offset:49152
ds_read_b64_tr_b16 a[134:135], v16 offset:51200
M v[168:171], a[48:51], a[160:163], 0
M v[168:171], a[52:55], a[164:167], v[168:171]
M v[172:175], a[60:63], a[164:167], 0
M v[172:175], a[56:59], a[160:163], v[172:175]
M v[176:179], a[64:67], a[160:163], 0
buffer_load_dwordx4 v7, s[12:15], s24 offen offset:1024 lds
M v[176:179], a[68:71], a[164:167], v[176:179]
ds_read_b64_tr_b16 a[140:141], v17 offset:49152
ds_read_b64_tr_b16 a[142:143], v17 offset:51200
M v[180:183], a[76:79], a[164:167], 0
M v[180:183], a[72:75], a[160:163], v[180:183]
M v[184:187], a[80:83], a[160:163], 0
M v[184:187], a[84:87], a[164:167], v[184:187]
buffer_load_dwordx4 v8, s[12:15], s24 offen offset:2048 lds
M v[188:191], a[92:95], a[164:167], 0
M v[188:191], a[88:91], a[160:163], v[188:191]
s_waitcnt lgkmcnt(12)
ds_read_b64_tr_b16 a[148:149], v18 offset:49152
ds_read_b64_tr_b16 a[150:151], v18 offset:51200
M v[192:195], a[32:35], a[168:171], 0
M v[192:195], a[36:39], a[172:175], v[192:195]
ds_read_b128 a[184:187], v10 offset:22528
ds_read_b128 a[188:191], v11 offset:22528
M v[196:199], a[44:47], a[172:175], 0
M v[196:199], a[40:43], a[168:171], v[196:199]
M v[200:203], a[48:51], a[168:171], 0
buffer_load_dwordx4 v9, s[12:15], s24 offen offset:3072 lds
M v[200:203], a[52:55], a[172:175], v[200:203]
ds_read_b64_tr_b16 a[156:157], v19 offset:49152
ds_read_b64_tr_b16 a[158:159], v19 offset:51200
M v[204:207], a[60:63], a[172:175], 0
M v[204:207], a[56:59], a[168:171], v[204:207]
M v[208:211], a[64:67], a[168:171], 0
M v[208:211], a[68:71], a[172:175], v[208:211]
M v[212:215], a[76:79], a[172:175], 0
s_add_u32 s24, s24, 262144
M v[212:215], a[72:75], a[168:171], v[212:215]
M v[216:219], a[80:83], a[168:171], 0
M v[216:219], a[84:87], a[172:175], v[216:219]
M v[220:223], a[92:95], a[172:175], 0
M v[220:223], a[88:91], a[168:171], v[220:223]
s_waitcnt lgkmcnt(10)
M v[224:227], a[32:35], a[176:179], 0
buffer_load_dword v21, v20, s[60:63], s54 offen
s_add_u32 s54, s54, 1048576
M v[224:227], a[36:39], a[180:183], v[224:227]
M v[228:231], a[44:47], a[180:183], 0
M v[228:231], a[40:43], a[176:179], v[228:231]
M v[232:235], a[48:51], a[176:179], 0
M v[232:235], a[52:55], a[180:183], v[232:235]
M v[236:239], a[60:63], a[180:183], 0
M v[236:239], a[56:59], a[176:179], v[236:239]
s_waitcnt vmcnt(17) lgkmcnt(0)
s_barrier
ds_read_b128 a[160:163], v10 offset:32768
ds_read_b128 a[164:167], v11 offset:32768
M v[240:243], a[64:67], a[176:179], 0
s_add_u32 m0, s29, 16384
s_add_u32 s3, s23, s31
buffer_load_dwordx4 v2, s[8:11], s3 offen offset:0 lds
M v[240:243], a[68:71], a[180:183], v[240:243]
M v[244:247], a[76:79], a[180:183], 0
M v[244:247], a[72:75], a[176:179], v[244:247]
M v[248:251], a[80:83], a[176:179], 0
M v[248:251], a[84:87], a[180:183], v[248:251]
buffer_load_dwordx4 v3, s[8:11], s3 offen offset:1024 lds
M v[252:255], a[92:95], a[180:183], 0
M v[252:255], a[88:91], a[176:179], v[252:255]
M a[0:3], a[32:35], a[184:187], 0
M a[0:3], a[36:39], a[188:191], a[0:3]
ds_read_b128 a[168:171], v10 offset:34816
ds_read_b128 a[172:175], v11 offset:34816
M a[4:7], a[44:47], a[188:191], 0
M a[4:7], a[40:43], a[184:187], a[4:7]
M a[8:11], a[48:51], a[184:187], 0
buffer_load_dwordx4 v4, s[8:11], s3 offen offset:2048 lds
M a[8:11], a[52:55], a[188:191], a[8:11]
M a[12:15], a[60:63], a[188:191], 0
M a[12:15], a[56:59], a[184:187], a[12:15]
M a[16:19], a[64:67], a[184:187], 0
M a[16:19], a[68:71], a[188:191], a[16:19]
buffer_load_dwordx4 v5, s[8:11], s3 offen offset:3072 lds
M a[20:23], a[76:79], a[188:191], 0
M a[20:23], a[72:75], a[184:187], a[20:23]
M a[24:27], a[80:83], a[184:187], 0
M a[24:27], a[84:87], a[188:191], a[24:27]
M a[28:31], a[92:95], a[188:191], 0
M a[28:31], a[88:91], a[184:187], a[28:31]
s_waitcnt lgkmcnt(2)
M v[32:35], a[96:99], a[160:163], v[32:35]
s_add_u32 s23, s23, 128
s_cmp_eq_u32 s23, s25
s_cselect_b32 s23, s26, s23
M v[32:35], a[100:103], a[164:167], v[32:35]
ds_read_b128 a[176:179], v10 offset:36864
ds_read_b128 a[180:183], v11 offset:36864
M v[36:39], a[108:111], a[164:167], v[36:39]
M v[36:39], a[104:107], a[160:163], v[36:39]
ds_read_b64_tr_b16 a[32:33], v12 offset:0
ds_read_b64_tr_b16 a[34:35], v12 offset:2048
M v[40:43], a[112:115], a[160:163], v[40:43]
M v[40:43], a[116:119], a[164:167], v[40:43]
M v[44:47], a[124:127], a[164:167], v[44:47]
s_add_u32 m0, s29, 114688
s_nop 0
buffer_load_dwordx4 v6, s[12:15], s24 offen offset:0 lds
M v[44:47], a[120:123], a[160:163], v[44:47]
ds_read_b64_tr_b16 a[40:41], v13 offset:0
ds_read_b64_tr_b16 a[42:43], v13 offset:2048
M v[48:51], a[128:131], a[160:163], v[48:51]
M v[48:51], a[132:135], a[164:167], v[48:51]
M v[52:55], a[140:143], a[164:167], v[52:55]
M v[52:55], a[136:139], a[160:163], v[52:55]
ds_read_b64_tr_b16 a[48:49], v14 offset:0
ds_read_b64_tr_b16 a[50:51], v14 offset:2048
M v[56:59], a[144:147], a[160:163], v[56:59]
M v[56:59], a[148:151], a[164:167], v[56:59]
buffer_load_dwordx4 v7, s[12:15], s24 offen offset:1024 lds
M v[60:63], a[156:159], a[164:167], v[60:63]
M v[60:63], a[152:155], a[160:163], v[60:63]
s_waitcnt lgkmcnt(8)
ds_read_b64_tr_b16 a[56:57], v15 offset:0
ds_read_b64_tr_b16 a[58:59], v15 offset:2048
M v[64:67], a[96:99], a[168:171], v[64:67]
M v[64:67], a[100:103], a[172:175], v[64:67]
ds_read_b128 a[184:187], v10 offset:38912
ds_read_b128 a[188:191], v11 offset:38912
M v[68:71], a[108:111], a[172:175], v[68:71]
M v[68:71], a[104:107], a[168:171], v[68:71]
ds_read_b64_tr_b16 a[64:65], v16 offset:0
ds_read_b64_tr_b16 a[66:67], v16 offset:2048
M v[72:75], a[112:115], a[168:171], v[72:75]
buffer_load_dwordx4 v8, s[12:15], s24 offen offset:2048 lds
M v[72:75], a[116:119], a[172:175], v[72:75]
M v[76:79], a[124:127], a[172:175], v[76:79]
M v[76:79], a[120:123], a[168:171], v[76:79]
ds_read_b64_tr_b16 a[72:73], v17 offset:0
ds_read_b64_tr_b16 a[74:75], v17 offset:2048
M v[80:83], a[128:131], a[168:171], v[80:83]
M v[80:83], a[132:135], a[172:175], v[80:83]
M v[84:87], a[140:143], a[172:175], v[84:87]
buffer_load_dwordx4 v9, s[12:15], s24 offen offset:3072 lds
M v[84:87], a[136:139], a[168:171], v[84:87]
ds_read_b64_tr_b16 a[80:81], v18 offset:0
ds_read_b64_tr_b16 a[82:83], v18 offset:2048
M v[88:91], a[144:147], a[168:171], v[88:91]
M v[88:91], a[148:151], a[172:175], v[88:91]
M v[92:95], a[156:159], a[172:175], v[92:95]
M v[92:95], a[152:155], a[168:171], v[92:95]
s_waitcnt lgkmcnt(15)
ds_read_b64_tr_b16 a[88:89], v19 offset:0
ds_read_b64_tr_b16 a[90:91], v19 offset:2048
M v[96:99], a[96:99], a[176:179], v[96:99]
s_add_u32 s24, s24, 262144
s_cmp_eq_u32 s24, s27
s_cselect_b32 s24, s28, s24
s_sub_u32 s6, s6, 1
s_cmp_eq_u32 s6, 0
s_cselect_b64 s[12:13], s[64:65], s[12:13]
M v[96:99], a[100:103], a[180:183], v[96:99]
M v[100:103], a[108:111], a[180:183], v[100:103]
M v[100:103], a[104:107], a[176:179], v[100:103]
M v[104:107], a[112:115], a[176:179], v[104:107]
M v[104:107], a[116:119], a[180:183], v[104:107]
M v[108:111], a[124:127], a[180:183], v[108:111]
M v[108:111], a[120:123], a[176:179], v[108:111]
s_waitcnt vmcnt(17) lgkmcnt(0)
s_barrier
ds_read_b128 a[160:163], v10 offset:49152
ds_read_b128 a[164:167], v11 offset:49152
M v[112:115], a[128:131], a[176:179], v[112:115]
s_add_u32 m0, s29, 32768
s_nop 0
buffer_load_dwordx4 v2, s[8:11], s23 offen offset:0 lds
M v[112:115], a[132:135], a[180:183], v[112:115]
M v[116:119], a[140:143], a[180:183], v[116:119]
M v[116:119], a[136:139], a[176:179], v[116:119]
ds_read_b64_tr_b16 a[36:37], v12 offset:16384
ds_read_b64_tr_b16 a[38:39], v12 offset:18432
M v[120:123], a[144:147], a[176:179], v[120:123]
M v[120:123], a[148:151], a[180:183], v[120:123]
buffer_load_dwordx4 v3, s[8:11], s23 offen offset:1024 lds
M v[124:127], a[156:159], a[180:183], v[124:127]
M v[124:127], a[152:155], a[176:179], v[124:127]
M v[128:131], a[96:99], a[184:187], v[128:131]
M v[128:131], a[100:103], a[188:191], v[128:131]
ds_read_b128 a[168:171], v10 offset:51200
ds_read_b128 a[172:175], v11 offset:51200
ds_read_b64_tr_b16 a[44:45], v13 offset:16384
ds_read_b64_tr_b16 a[46:47], v13 offset:18432
M v[132:135], a[108:111], a[188:191], v[132:135]
M v[132:135], a[104:107], a[184:187], v[132:135]
M v[136:139], a[112:115], a[184:187], v[136:139]
buffer_load_dwordx4 v4, s[8:11], s23 offen offset:2048 lds
M v[136:139], a[116:119], a[188:191], v[136:139]
M v[140:143], a[124:127], a[188:191], v[140:143]
M v[140:143], a[120:123], a[184:187], v[140:143]
ds_read_b64_tr_b16 a[52:53], v14 offset:16384
ds_read_b64_tr_b16 a[54:55], v14 offset:18432
M v[144:147], a[128:131], a[184:187], v[144:147]
M v[144:147], a[132:135], a[188:191], v[144:147]
M v[148:151], a[140:143], a[188:191], v[148:151]
buffer_load_dwordx4 v5, s[8:11], s23 offen offset:3072 lds
M v[148:151], a[136:139], a[184:187], v[148:151]
M v[152:155], a[144:147], a[184:187], v[152:155]
M v[152:155], a[148:151], a[188:191], v[152:155]
ds_read_b64_tr_b16 a[60:61], v15 offset:16384
ds_read_b64_tr_b16 a[62:63], v15 offset:18432
M v[156:159], a[156:159], a[188:191], v[156:159]
M v[156:159], a[152:155], a[184:187], v[156:159]
s_waitcnt lgkmcnt(10)
M v[160:163], a[96:99], a[160:163], v[160:163]
M v[160:163], a[100:103], a[164:167], v[160:163]
ds_read_b128 a[176:179], v10 offset:53248
ds_read_b128 a[180:183], v11 offset:53248
M v[164:167], a[108:111], a[164:167], v[164:167]
s_add_u32 m0, s29, 65536
s_nop 0
buffer_load_dwordx4 v6, s[12:15], s24 offen offset:0 lds
M v[164:167], a[104:107], a[160:163], v[164:167]
ds_read_b64_tr_b16 a[68:69], v16 offset:16384
ds_read_b64_tr_b16 a[70:71], v16 offset:18432
M v[168:171], a[112:115], a[160:163], v[168:171]
M v[168:171], a[116:119], a[164:167], v[168:171]
M v[172:175], a[124:127], a[164:167], v[172:175]
M v[172:175], a[120:123], a[160:163], v[172:175]
M v[176:179], a[128:131], a[160:163], v[176:179]
buffer_load_dwordx4 v7, s[12:15], s24 offen offset:1024 lds
M v[176:179], a[132:135], a[164:167], v[176:179]
ds_read_b64_tr_b16 a[76:77], v17 offset:16384
ds_read_b64_tr_b16 a[78:79], v17 offset:18432
M v[180:183], a[140:143], a[164:167], v[180:183]
M v[180:183], a[136:139], a[160:163], v[180:183]
M v[184:187], a[144:147], a[160:163], v[184:187]
M v[184:187], a[148:151], a[164:167], v[184:187]
buffer_load_dwordx4 v8, s[12:15], s24 offen offset:2048 lds
M v[188:191], a[156:159], a[164:167], v[188:191]
M v[188:191], a[152:155], a[160:163], v[188:191]
s_waitcnt lgkmcnt(12)
ds_read_b64_tr_b16 a[84:85], v18 offset:16384
ds_read_b64_tr_b16 a[86:87], v18 offset:18432
M v[192:195], a[96:99], a[168:171], v[192:195]
M v[192:195], a[100:103], a[172:175], v[192:195]
ds_read_b128 a[184:187], v10 offset:55296
ds_read_b128 a[188:191], v11 offset:55296
M v[196:199], a[108:111], a[172:175], v[196:199]
M v[196:199], a[104:107], a[168:171], v[196:199]
M v[200:203], a[112:115], a[168:171], v[200:203]
buffer_load_dwordx4 v9, s[12:15], s24 offen offset:3072 lds
M v[200:203], a[116:119], a[172:175], v[200:203]
ds_read_b64_tr_b16 a[92:93], v19 offset:16384
ds_read_b64_tr_b16 a[94:95], v19 offset:18432
M v[204:207], a[124:127], a[172:175], v[204:207]
M v[204:207], a[120:123], a[168:171], v[204:207]
M v[208:211], a[128:131], a[168:171], v[208:211]
M v[208:211], a[132:135], a[172:175], v[208:211]
M v[212:215], a[140:143], a[172:175], v[212:215]
s_add_u32 s24, s24, 262144
M v[212:215], a[136:139], a[168:171], v[212:215]
M v[216:219], a[144:147], a[168:171], v[216:219]
M v[216:219], a[148:151], a[172:175], v[216:219]
M v[220:223], a[156:159], a[172:175], v[220:223]
M v[220:223], a[152:155], a[168:171], v[220:223]
s_waitcnt lgkmcnt(10)
M v[224:227], a[96:99], a[176:179], v[224:227]
buffer_load_dword v21, v20, s[60:63], s54 offen
s_add_u32 s54, s54, 1048576
M v[224:227], a[100:103], a[180:183], v[224:227]
M v[228:231], a[108:111], a[180:183], v[228:231]
M v[228:231], a[104:107], a[176:179], v[228:231]
M v[232:235], a[112:115], a[176:179], v[232:235]
M v[232:235], a[116:119], a[180:183], v[232:235]
M v[236:239], a[124:127], a[180:183], v[236:239]
M v[236:239], a[120:123], a[176:179], v[236:239]
s_waitcnt vmcnt(18) lgkmcnt(0)
s_barrier
ds_read_b128 a[160:163], v10 offset:0
ds_read_b128 a[164:167], v11 offset:0
M v[240:243], a[128:131], a[176:179], v[240:243]
s_add_u32 m0, s29, 49152
s_add_u32 s3, s23, s31
buffer_load_dwordx4 v2, s[8:11], s3 offen offset:0 lds
M v[240:243], a[132:135], a[180:183], v[240:243]
M v[244:247], a[140:143], a[180:183], v[244:247]
M v[244:247], a[136:139], a[176:179], v[244:247]
M v[248:251], a[144:147], a[176:179], v[248:251]
M v[248:251], a[148:151], a[180:183], v[248:251]
buffer_load_dwordx4 v3, s[8:11], s3 offen offset:1024 lds
M v[252:255], a[156:159], a[180:183], v[252:255]
M v[252:255], a[152:155], a[176:179], v[252:255]
M a[0:3], a[96:99], a[184:187], a[0:3]
M a[0:3], a[100:103], a[188:191], a[0:3]
ds_read_b128 a[168:171], v10 offset:2048
ds_read_b128 a[172:175], v11 offset:2048
M a[4:7], a[108:111], a[188:191], a[4:7]
M a[4:7], a[104:107], a[184:187], a[4:7]
M a[8:11], a[112:115], a[184:187], a[8:11]
buffer_load_dwordx4 v4, s[8:11], s3 offen offset:2048 lds
M a[8:11], a[116:119], a[188:191], a[8:11]
M a[12:15], a[124:127], a[188:191], a[12:15]
M a[12:15], a[120:123], a[184:187], a[12:15]
M a[16:19], a[128:131], a[184:187], a[16:19]
M a[16:19], a[132:135], a[188:191], a[16:19]
buffer_load_dwordx4 v5, s[8:11], s3 offen offset:3072 lds
M a[20:23], a[140:143], a[188:191], a[20:23]
M a[20:23], a[136:139], a[184:187], a[20:23]
M a[24:27], a[144:147], a[184:187], a[24:27]
M a[24:27], a[148:151], a[188:191], a[24:27]
M a[28:31], a[156:159], a[188:191], a[28:31]
M a[28:31], a[152:155], a[184:187], a[28:31]
s_waitcnt lgkmcnt(2)
s_mov_b32 s30, 5
Lk1_ql:
M v[32:35], a[32:35], a[160:163], v[32:35]
s_add_u32 s23, s23, 128
s_cmp_eq_u32 s23, s25
s_cselect_b32 s23, s26, s23
M v[32:35], a[36:39], a[164:167], v[32:35]
ds_read_b128 a[176:179], v10 offset:4096
ds_read_b128 a[180:183], v11 offset:4096
M v[36:39], a[44:47], a[164:167], v[36:39]
M v[36:39], a[40:43], a[160:163], v[36:39]
ds_read_b64_tr_b16 a[96:97], v12 offset:32768
ds_read_b64_tr_b16 a[98:99], v12 offset:34816
M v[40:43], a[48:51], a[160:163], v[40:43]
M v[40:43], a[52:55], a[164:167], v[40:43]
M v[44:47], a[60:63], a[164:167], v[44:47]
s_add_u32 m0, s29, 81920
s_nop 0
buffer_load_dwordx4 v6, s[12:15], s24 offen offset:0 lds
M v[44:47], a[56:59], a[160:163], v[44:47]
ds_read_b64_tr_b16 a[104:105], v13 offset:32768
ds_read_b64_tr_b16 a[106:107], v13 offset:34816
M v[48:51], a[64:67], a[160:163], v[48:51]
M v[48:51], a[68:71], a[164:167], v[48:51]
M v[52:55], a[76:79], a[164:167], v[52:55]
M v[52:55], a[72:75], a[160:163], v[52:55]
ds_read_b64_tr_b16 a[112:113], v14 offset:32768
ds_read_b64_tr_b16 a[114:115], v14 offset:34816
M v[56:59], a[80:83], a[160:163], v[56:59]
M v[56:59], a[84:87], a[164:167], v[56:59]
buffer_load_dwordx4 v7, s[12:15], s24 offen offset:1024 lds
M v[60:63], a[92:95], a[164:167], v[60:63]
M v[60:63], a[88:91], a[160:163], v[60:63]
s_waitcnt lgkmcnt(8)
ds_read_b64_tr_b16 a[120:121], v15 offset:32768
ds_read_b64_tr_b16 a[122:123], v15 offset:34816
M v[64:67], a[32:35], a[168:171], v[64:67]
M v[64:67], a[36:39], a[172:175], v[64:67]
ds_read_b128 a[184:187], v10 offset:6144
ds_read_b128 a[188:191], v11 offset:6144
M v[68:71], a[44:47], a[172:175], v[68:71]
M v[68:71], a[40:43], a[168:171], v[68:71]
ds_read_b64_tr_b16 a[128:129], v16 offset:32768
ds_read_b64_tr_b16 a[130:131], v16 offset:34816
M v[72:75], a[48:51], a[168:171], v[72:75]
buffer_load_dwordx4 v8, s[12:15], s24 offen offset:2048 lds
M v[72:75], a[52:55], a[172:175], v[72:75]
M v[76:79], a[60:63], a[172:175], v[76:79]
M v[76:79], a[56:59], a[168:171], v[76:79]
ds_read_b64_tr_b16 a[136:137], v17 offset:32768
ds_read_b64_tr_b16 a[138:139], v17 offset:34816
M v[80:83], a[64:67], a[168:171], v[80:83]
M v[80:83], a[68:71], a[172:175], v[80:83]
M v[84:87], a[76:79], a[172:175], v[84:87]
buffer_load_dwordx4 v9, s[12:15], s24 offen offset:3072 lds
M v[84:87], a[72:75], a[168:171], v[84:87]
ds_read_b64_tr_b16 a[144:145], v18 offset:32768
ds_read_b64_tr_b16 a[146:147], v18 offset:34816
M v[88:91], a[80:83], a[168:171], v[88:91]
M v[88:91], a[84:87], a[172:175], v[88:91]
M v[92:95], a[92:95], a[172:175], v[92:95]
M v[92:95], a[88:91], a[168:171], v[92:95]
s_waitcnt lgkmcnt(15)
ds_read_b64_tr_b16 a[152:153], v19 offset:32768
ds_read_b64_tr_b16 a[154:155], v19 offset:34816
M v[96:99], a[32:35], a[176:179], v[96:99]
s_add_u32 s24, s24, 262144
s_cmp_eq_u32 s24, s27
s_cselect_b32 s24, s28, s24
s_sub_u32 s6, s6, 1
s_cmp_eq_u32 s6, 0
s_cselect_b64 s[12:13], s[64:65], s[12:13]
M v[96:99], a[36:39], a[180:183], v[96:99]
M v[100:103], a[44:47], a[180:183], v[100:103]
M v[100:103], a[40:43], a[176:179], v[100:103]
M v[104:107], a[48:51], a[176:179], v[104:107]
M v[104:107], a[52:55], a[180:183], v[104:107]
M v[108:111], a[60:63], a[180:183], v[108:111]
M v[108:111], a[56:59], a[176:179], v[108:111]
s_waitcnt vmcnt(17) lgkmcnt(0)
s_barrier
ds_read_b128 a[160:163], v10 offset:16384
ds_read_b128 a[164:167], v11 offset:16384
M v[112:115], a[64:67], a[176:179], v[112:115]
s_add_u32 m0, s29, 0
s_nop 0
buffer_load_dwordx4 v2, s[8:11], s23 offen offset:0 lds
M v[112:115], a[68:71], a[180:183], v[112:115]
M v[116:119], a[76:79], a[180:183], v[116:119]
M v[116:119], a[72:75], a[176:179], v[116:119]
ds_read_b64_tr_b16 a[100:101], v12 offset:49152
ds_read_b64_tr_b16 a[102:103], v12 offset:51200
M v[120:123], a[80:83], a[176:179], v[120:123]
M v[120:123], a[84:87], a[180:183], v[120:123]
buffer_load_dwordx4 v3, s[8:11], s23 offen offset:1024 lds
M v[124:127], a[92:95], a[180:183], v[124:127]
M v[124:127], a[88:91], a[176:179], v[124:127]
M v[128:131], a[32:35], a[184:187], v[128:131]
M v[128:131], a[36:39], a[188:191], v[128:131]
ds_read_b128 a[168:171], v10 offset:18432
ds_read_b128 a[172:175], v11 offset:18432
ds_read_b64_tr_b16 a[108:109], v13 offset:49152
ds_read_b64_tr_b16 a[110:111], v13 offset:51200
M v[132:135], a[44:47], a[188:191], v[132:135]
M v[132:135], a[40:43], a[184:187], v[132:135]
M v[136:139], a[48:51], a[184:187], v[136:139]
buffer_load_dwordx4 v4, s[8:11], s23 offen offset:2048 lds
M v[136:139], a[52:55], a[188:191], v[136:139]
M v[140:143], a[60:63], a[188:191], v[140:143]
M v[140:143], a[56:59], a[184:187], v[140:143]
ds_read_b64_tr_b16 a[116:117], v14 offset:49152
ds_read_b64_tr_b16 a[118:119], v14 offset:51200
M v[144:147], a[64:67], a[184:187], v[144:147]
M v[144:147], a[68:71], a[188:191], v[144:147]
M v[148:151], a[76:79], a[188:191], v[148:151]
buffer_load_dwordx4 v5, s[8:11], s23 offen offset:3072 lds
M v[148:151], a[72:75], a[184:187], v[148:151]
M v[152:155], a[80:83], a[184:187], v[152:155]
M v[152:155], a[84:87], a[188:191], v[152:155]
ds_read_b64_tr_b16 a[124:125], v15 offset:49152
ds_read_b64_tr_b16 a[126:127], v15 offset:51200
M v[156:159], a[92:95], a[188:191], v[156:159]
M v[156:159], a[88:91], a[184:187], v[156:159]
s_waitcnt lgkmcnt(10)
M v[160:163], a[32:35], a[160:163], v[160:163]
M v[160:163], a[36:39], a[164:167], v[160:163]
ds_read_b128 a[176:179], v10 offset:20480
ds_read_b128 a[180:183], v11 offset:20480
M v[164:167], a[44:47], a[164:167], v[164:167]
s_add_u32 m0, s29, 98304
s_nop 0
buffer_load_dwordx4 v6, s[12:15], s24 offen offset:0 lds
M v[164:167], a[40:43], a[160:163], v[164:167]
ds_read_b64_tr_b16 a[132:133], v16 offset:49152
ds_read_b64_tr_b16 a[134:135], v16 offset:51200
M v[168:171], a[48:51], a[160:163], v[168:171]
M v[168:171], a[52:55], a[164:167], v[168:171]
M v[172:175], a[60:63], a[164:167], v[172:175]
M v[172:175], a[56:59], a[160:163], v[172:175]
M v[176:179], a[64:67], a[160:163], v[176:179]
buffer_load_dwordx4 v7, s[12:15], s24 offen offset:1024 lds
M v[176:179], a[68:71], a[164:167], v[176:179]
ds_read_b64_tr_b16 a[140:141], v17 offset:49152
ds_read_b64_tr_b16 a[142:143], v17 offset:51200
M v[180:183], a[76:79], a[164:167], v[180:183]
M v[180:183], a[72:75], a[160:163], v[180:183]
M v[184:187], a[80:83], a[160:163], v[184:187]
M v[184:187], a[84:87], a[164:167], v[184:187]
buffer_load_dwordx4 v8, s[12:15], s24 offen offset:2048 lds
M v[188:191], a[92:95], a[164:167], v[188:191]
M v[188:191], a[88:91], a[160:163], v[188:191]
s_waitcnt lgkmcnt(12)
ds_read_b64_tr_b16 a[148:149], v18 offset:49152
ds_read_b64_tr_b16 a[150:151], v18 offset:51200
M v[192:195], a[32:35], a[168:171], v[192:195]
M v[192:195], a[36:39], a[172:175], v[192:195]
ds_read_b128 a[184:187], v10 offset:22528
ds_read_b128 a[188:191], v11 offset:22528
M v[196:199], a[44:47], a[172:175], v[196:199]
M v[196:199], a[40:43], a[168:171], v[196:199]
M v[200:203], a[48:51], a[168:171], v[200:203]
buffer_load_dwordx4 v9, s[12:15], s24 offen offset:3072 lds
M v[200:203], a[52:55], a[172:175], v[200:203]
ds_read_b64_tr_b16 a[156:157], v19 offset:49152
ds_read_b64_tr_b16 a[158:159], v19 offset:51200
M v[204:207], a[60:63], a[172:175], v[204:207]
M v[204:207], a[56:59], a[168:171], v[204:207]
M v[208:211], a[64:67], a[168:171], v[208:211]
M v[208:211], a[68:71], a[172:175], v[208:211]
M v[212:215], a[76:79], a[172:175], v[212:215]
s_add_u32 s24, s24, 262144
M v[212:215], a[72:75], a[168:171], v[212:215]
M v[216:219], a[80:83], a[168:171], v[216:219]
M v[216:219], a[84:87], a[172:175], v[216:219]
M v[220:223], a[92:95], a[172:175], v[220:223]
M v[220:223], a[88:91], a[168:171], v[220:223]
s_waitcnt lgkmcnt(10)
M v[224:227], a[32:35], a[176:179], v[224:227]
buffer_load_dword v21, v20, s[60:63], s54 offen
s_add_u32 s54, s54, 1048576
M v[224:227], a[36:39], a[180:183], v[224:227]
M v[228:231], a[44:47], a[180:183], v[228:231]
M v[228:231], a[40:43], a[176:179], v[228:231]
M v[232:235], a[48:51], a[176:179], v[232:235]
M v[232:235], a[52:55], a[180:183], v[232:235]
M v[236:239], a[60:63], a[180:183], v[236:239]
M v[236:239], a[56:59], a[176:179], v[236:239]
s_waitcnt vmcnt(18) lgkmcnt(0)
s_barrier
ds_read_b128 a[160:163], v10 offset:32768
ds_read_b128 a[164:167], v11 offset:32768
M v[240:243], a[64:67], a[176:179], v[240:243]
s_add_u32 m0, s29, 16384
s_add_u32 s3, s23, s31
buffer_load_dwordx4 v2, s[8:11], s3 offen offset:0 lds
M v[240:243], a[68:71], a[180:183], v[240:243]
M v[244:247], a[76:79], a[180:183], v[244:247]
M v[244:247], a[72:75], a[176:179], v[244:247]
M v[248:251], a[80:83], a[176:179], v[248:251]
M v[248:251], a[84:87], a[180:183], v[248:251]
buffer_load_dwordx4 v3, s[8:11], s3 offen offset:1024 lds
M v[252:255], a[92:95], a[180:183], v[252:255]
M v[252:255], a[88:91], a[176:179], v[252:255]
M a[0:3], a[32:35], a[184:187], a[0:3]
M a[0:3], a[36:39], a[188:191], a[0:3]
ds_read_b128 a[168:171], v10 offset:34816
ds_read_b128 a[172:175], v11 offset:34816
M a[4:7], a[44:47], a[188:191], a[4:7]
M a[4:7], a[40:43], a[184:187], a[4:7]
M a[8:11], a[48:51], a[184:187], a[8:11]
buffer_load_dwordx4 v4, s[8:11], s3 offen offset:2048 lds
M a[8:11], a[52:55], a[188:191], a[8:11]
M a[12:15], a[60:63], a[188:191], a[12:15]
M a[12:15], a[56:59], a[184:187], a[12:15]
M a[16:19], a[64:67], a[184:187], a[16:19]
M a[16:19], a[68:71], a[188:191], a[16:19]
buffer_load_dwordx4 v5, s[8:11], s3 offen offset:3072 lds
M a[20:23], a[76:79], a[188:191], a[20:23]
M a[20:23], a[72:75], a[184:187], a[20:23]
M a[24:27], a[80:83], a[184:187], a[24:27]
M a[24:27], a[84:87], a[188:191], a[24:27]
M a[28:31], a[92:95], a[188:191], a[28:31]
M a[28:31], a[88:91], a[184:187], a[28:31]
s_waitcnt lgkmcnt(2)
M v[32:35], a[96:99], a[160:163], v[32:35]
s_add_u32 s23, s23, 128
s_cmp_eq_u32 s23, s25
s_cselect_b32 s23, s26, s23
M v[32:35], a[100:103], a[164:167], v[32:35]
ds_read_b128 a[176:179], v10 offset:36864
ds_read_b128 a[180:183], v11 offset:36864
M v[36:39], a[108:111], a[164:167], v[36:39]
M v[36:39], a[104:107], a[160:163], v[36:39]
ds_read_b64_tr_b16 a[32:33], v12 offset:0
ds_read_b64_tr_b16 a[34:35], v12 offset:2048
M v[40:43], a[112:115], a[160:163], v[40:43]
M v[40:43], a[116:119], a[164:167], v[40:43]
M v[44:47], a[124:127], a[164:167], v[44:47]
s_add_u32 m0, s29, 114688
s_nop 0
buffer_load_dwordx4 v6, s[12:15], s24 offen offset:0 lds
M v[44:47], a[120:123], a[160:163], v[44:47]
ds_read_b64_tr_b16 a[40:41], v13 offset:0
ds_read_b64_tr_b16 a[42:43], v13 offset:2048
M v[48:51], a[128:131], a[160:163], v[48:51]
M v[48:51], a[132:135], a[164:167], v[48:51]
M v[52:55], a[140:143], a[164:167], v[52:55]
M v[52:55], a[136:139], a[160:163], v[52:55]
ds_read_b64_tr_b16 a[48:49], v14 offset:0
ds_read_b64_tr_b16 a[50:51], v14 offset:2048
M v[56:59], a[144:147], a[160:163], v[56:59]
M v[56:59], a[148:151], a[164:167], v[56:59]
buffer_load_dwordx4 v7, s[12:15], s24 offen offset:1024 lds
M v[60:63], a[156:159], a[164:167], v[60:63]
M v[60:63], a[152:155], a[160:163], v[60:63]
s_waitcnt lgkmcnt(8)
ds_read_b64_tr_b16 a[56:57], v15 offset:0
ds_read_b64_tr_b16 a[58:59], v15 offset:2048
M v[64:67], a[96:99], a[168:171], v[64:67]
M v[64:67], a[100:103], a[172:175], v[64:67]
ds_read_b128 a[184:187], v10 offset:38912
ds_read_b128 a[188:191], v11 offset:38912
M v[68:71], a[108:111], a[172:175], v[68:71]
M v[68:71], a[104:107], a[168:171], v[68:71]
ds_read_b64_tr_b16 a[64:65], v16 offset:0
ds_read_b64_tr_b16 a[66:67], v16 offset:2048
M v[72:75], a[112:115], a[168:171], v[72:75]
buffer_load_dwordx4 v8, s[12:15], s24 offen offset:2048 lds
M v[72:75], a[116:119], a[172:175], v[72:75]
M v[76:79], a[124:127], a[172:175], v[76:79]
M v[76:79], a[120:123], a[168:171], v[76:79]
ds_read_b64_tr_b16 a[72:73], v17 offset:0
ds_read_b64_tr_b16 a[74:75], v17 offset:2048
M v[80:83], a[128:131], a[168:171], v[80:83]
M v[80:83], a[132:135], a[172:175], v[80:83]
M v[84:87], a[140:143], a[172:175], v[84:87]
buffer_load_dwordx4 v9, s[12:15], s24 offen offset:3072 lds
M v[84:87], a[136:139], a[168:171], v[84:87]
ds_read_b64_tr_b16 a[80:81], v18 offset:0
ds_read_b64_tr_b16 a[82:83], v18 offset:2048
M v[88:91], a[144:147], a[168:171], v[88:91]
M v[88:91], a[148:151], a[172:175], v[88:91]
M v[92:95], a[156:159], a[172:175], v[92:95]
M v[92:95], a[152:155], a[168:171], v[92:95]
s_waitcnt lgkmcnt(15)
ds_read_b64_tr_b16 a[88:89], v19 offset:0
ds_read_b64_tr_b16 a[90:91], v19 offset:2048
M v[96:99], a[96:99], a[176:179], v[96:99]
s_add_u32 s24, s24, 262144
s_cmp_eq_u32 s24, s27
s_cselect_b32 s24, s28, s24
s_sub_u32 s6, s6, 1
s_cmp_eq_u32 s6, 0
s_cselect_b64 s[12:13], s[64:65], s[12:13]
M v[96:99], a[100:103], a[180:183], v[96:99]
M v[100:103], a[108:111], a[180:183], v[100:103]
M v[100:103], a[104:107], a[176:179], v[100:103]
M v[104:107], a[112:115], a[176:179], v[104:107]
M v[104:107], a[116:119], a[180:183], v[104:107]
M v[108:111], a[124:127], a[180:183], v[108:111]
M v[108:111], a[120:123], a[176:179], v[108:111]
s_waitcnt vmcnt(17) lgkmcnt(0)
s_barrier
ds_read_b128 a[160:163], v10 offset:49152
ds_read_b128 a[164:167], v11 offset:49152
M v[112:115], a[128:131], a[176:179], v[112:115]
s_add_u32 m0, s29, 32768
s_nop 0
buffer_load_dwordx4 v2, s[8:11], s23 offen offset:0 lds
M v[112:115], a[132:135], a[180:183], v[112:115]
M v[116:119], a[140:143], a[180:183], v[116:119]
M v[116:119], a[136:139], a[176:179], v[116:119]
ds_read_b64_tr_b16 a[36:37], v12 offset:16384
ds_read_b64_tr_b16 a[38:39], v12 offset:18432
M v[120:123], a[144:147], a[176:179], v[120:123]
M v[120:123], a[148:151], a[180:183], v[120:123]
buffer_load_dwordx4 v3, s[8:11], s23 offen offset:1024 lds
M v[124:127], a[156:159], a[180:183], v[124:127]
M v[124:127], a[152:155], a[176:179], v[124:127]
M v[128:131], a[96:99], a[184:187], v[128:131]
M v[128:131], a[100:103], a[188:191], v[128:131]
ds_read_b128 a[168:171], v10 offset:51200
ds_read_b128 a[172:175], v11 offset:51200
ds_read_b64_tr_b16 a[44:45], v13 offset:16384
ds_read_b64_tr_b16 a[46:47], v13 offset:18432
M v[132:135], a[108:111], a[188:191], v[132:135]
M v[132:135], a[104:107], a[184:187], v[132:135]
M v[136:139], a[112:115], a[184:187], v[136:139]
buffer_load_dwordx4 v4, s[8:11], s23 offen offset:2048 lds
M v[136:139], a[116:119], a[188:191], v[136:139]
M v[140:143], a[124:127], a[188:191], v[140:143]
M v[140:143], a[120:123], a[184:187], v[140:143]
ds_read_b64_tr_b16 a[52:53], v14 offset:16384
ds_read_b64_tr_b16 a[54:55], v14 offset:18432
M v[144:147], a[128:131], a[184:187], v[144:147]
M v[144:147], a[132:135], a[188:191], v[144:147]
M v[148:151], a[140:143], a[188:191], v[148:151]
buffer_load_dwordx4 v5, s[8:11], s23 offen offset:3072 lds
M v[148:151], a[136:139], a[184:187], v[148:151]
M v[152:155], a[144:147], a[184:187], v[152:155]
M v[152:155], a[148:151], a[188:191], v[152:155]
ds_read_b64_tr_b16 a[60:61], v15 offset:16384
ds_read_b64_tr_b16 a[62:63], v15 offset:18432
M v[156:159], a[156:159], a[188:191], v[156:159]
M v[156:159], a[152:155], a[184:187], v[156:159]
s_waitcnt lgkmcnt(10)
M v[160:163], a[96:99], a[160:163], v[160:163]
M v[160:163], a[100:103], a[164:167], v[160:163]
ds_read_b128 a[176:179], v10 offset:53248
ds_read_b128 a[180:183], v11 offset:53248
M v[164:167], a[108:111], a[164:167], v[164:167]
s_add_u32 m0, s29, 65536
s_nop 0
buffer_load_dwordx4 v6, s[12:15], s24 offen offset:0 lds
M v[164:167], a[104:107], a[160:163], v[164:167]
ds_read_b64_tr_b16 a[68:69], v16 offset:16384
ds_read_b64_tr_b16 a[70:71], v16 offset:18432
M v[168:171], a[112:115], a[160:163], v[168:171]
M v[168:171], a[116:119], a[164:167], v[168:171]
M v[172:175], a[124:127], a[164:167], v[172:175]
M v[172:175], a[120:123], a[160:163], v[172:175]
M v[176:179], a[128:131], a[160:163], v[176:179]
buffer_load_dwordx4 v7, s[12:15], s24 offen offset:1024 lds
M v[176:179], a[132:135], a[164:167], v[176:179]
ds_read_b64_tr_b16 a[76:77], v17 offset:16384
ds_read_b64_tr_b16 a[78:79], v17 offset:18432
M v[180:183], a[140:143], a[164:167], v[180:183]
M v[180:183], a[136:139], a[160:163], v[180:183]
M v[184:187], a[144:147], a[160:163], v[184:187]
M v[184:187], a[148:151], a[164:167], v[184:187]
buffer_load_dwordx4 v8, s[12:15], s24 offen offset:2048 lds
M v[188:191], a[156:159], a[164:167], v[188:191]
M v[188:191], a[152:155], a[160:163], v[188:191]
s_waitcnt lgkmcnt(12)
ds_read_b64_tr_b16 a[84:85], v18 offset:16384
ds_read_b64_tr_b16 a[86:87], v18 offset:18432
M v[192:195], a[96:99], a[168:171], v[192:195]
M v[192:195], a[100:103], a[172:175], v[192:195]
ds_read_b128 a[184:187], v10 offset:55296
ds_read_b128 a[188:191], v11 offset:55296
M v[196:199], a[108:111], a[172:175], v[196:199]
M v[196:199], a[104:107], a[168:171], v[196:199]
M v[200:203], a[112:115], a[168:171], v[200:203]
buffer_load_dwordx4 v9, s[12:15], s24 offen offset:3072 lds
M v[200:203], a[116:119], a[172:175], v[200:203]
ds_read_b64_tr_b16 a[92:93], v19 offset:16384
ds_read_b64_tr_b16 a[94:95], v19 offset:18432
M v[204:207], a[124:127], a[172:175], v[204:207]
M v[204:207], a[120:123], a[168:171], v[204:207]
M v[208:211], a[128:131], a[168:171], v[208:211]
M v[208:211], a[132:135], a[172:175], v[208:211]
M v[212:215], a[140:143], a[172:175], v[212:215]
s_add_u32 s24, s24, 262144
M v[212:215], a[136:139], a[168:171], v[212:215]
M v[216:219], a[144:147], a[168:171], v[216:219]
M v[216:219], a[148:151], a[172:175], v[216:219]
M v[220:223], a[156:159], a[172:175], v[220:223]
M v[220:223], a[152:155], a[168:171], v[220:223]
s_waitcnt lgkmcnt(10)
M v[224:227], a[96:99], a[176:179], v[224:227]
buffer_load_dword v21, v20, s[60:63], s54 offen
s_add_u32 s54, s54, 1048576
M v[224:227], a[100:103], a[180:183], v[224:227]
M v[228:231], a[108:111], a[180:183], v[228:231]
M v[228:231], a[104:107], a[176:179], v[228:231]
M v[232:235], a[112:115], a[176:179], v[232:235]
M v[232:235], a[116:119], a[180:183], v[232:235]
M v[236:239], a[124:127], a[180:183], v[236:239]
M v[236:239], a[120:123], a[176:179], v[236:239]
s_waitcnt vmcnt(18) lgkmcnt(0)
s_barrier
ds_read_b128 a[160:163], v10 offset:0
ds_read_b128 a[164:167], v11 offset:0
M v[240:243], a[128:131], a[176:179], v[240:243]
s_add_u32 m0, s29, 49152
s_add_u32 s3, s23, s31
buffer_load_dwordx4 v2, s[8:11], s3 offen offset:0 lds
M v[240:243], a[132:135], a[180:183], v[240:243]
M v[244:247], a[140:143], a[180:183], v[244:247]
M v[244:247], a[136:139], a[176:179], v[244:247]
M v[248:251], a[144:147], a[176:179], v[248:251]
M v[248:251], a[148:151], a[180:183], v[248:251]
buffer_load_dwordx4 v3, s[8:11], s3 offen offset:1024 lds
M v[252:255], a[156:159], a[180:183], v[252:255]
M v[252:255], a[152:155], a[176:179], v[252:255]
M a[0:3], a[96:99], a[184:187], a[0:3]
M a[0:3], a[100:103], a[188:191], a[0:3]
ds_read_b128 a[168:171], v10 offset:2048
ds_read_b128 a[172:175], v11 offset:2048
M a[4:7], a[108:111], a[188:191], a[4:7]
M a[4:7], a[104:107], a[184:187], a[4:7]
M a[8:11], a[112:115], a[184:187], a[8:11]
buffer_load_dwordx4 v4, s[8:11], s3 offen offset:2048 lds
M a[8:11], a[116:119], a[188:191], a[8:11]
M a[12:15], a[124:127], a[188:191], a[12:15]
M a[12:15], a[120:123], a[184:187], a[12:15]
M a[16:19], a[128:131], a[184:187], a[16:19]
M a[16:19], a[132:135], a[188:191], a[16:19]
buffer_load_dwordx4 v5, s[8:11], s3 offen offset:3072 lds
M a[20:23], a[140:143], a[188:191], a[20:23]
M a[20:23], a[136:139], a[184:187], a[20:23]
M a[24:27], a[144:147], a[184:187], a[24:27]
M a[24:27], a[148:151], a[188:191], a[24:27]
M a[28:31], a[156:159], a[188:191], a[28:31]
M a[28:31], a[152:155], a[184:187], a[28:31]
s_waitcnt lgkmcnt(2)
s_sub_u32 s30, s30, 1
s_cmp_lg_u32 s30, 0
s_cbranch_scc1 Lk1_ql
M v[32:35], a[32:35], a[160:163], v[32:35]
s_add_u32 s23, s23, 128
s_cmp_eq_u32 s23, s25
s_cselect_b32 s23, s26, s23
M v[32:35], a[36:39], a[164:167], v[32:35]
ds_read_b128 a[176:179], v10 offset:4096
ds_read_b128 a[180:183], v11 offset:4096
M v[36:39], a[44:47], a[164:167], v[36:39]
M v[36:39], a[40:43], a[160:163], v[36:39]
ds_read_b64_tr_b16 a[96:97], v12 offset:32768
ds_read_b64_tr_b16 a[98:99], v12 offset:34816
M v[40:43], a[48:51], a[160:163], v[40:43]
M v[40:43], a[52:55], a[164:167], v[40:43]
M v[44:47], a[60:63], a[164:167], v[44:47]
s_add_u32 m0, s29, 81920
s_nop 0
buffer_load_dwordx4 v6, s[12:15], s24 offen offset:0 lds
M v[44:47], a[56:59], a[160:163], v[44:47]
ds_read_b64_tr_b16 a[104:105], v13 offset:32768
ds_read_b64_tr_b16 a[106:107], v13 offset:34816
M v[48:51], a[64:67], a[160:163], v[48:51]
M v[48:51], a[68:71], a[164:167], v[48:51]
M v[52:55], a[76:79], a[164:167], v[52:55]
M v[52:55], a[72:75], a[160:163], v[52:55]
ds_read_b64_tr_b16 a[112:113], v14 offset:32768
ds_read_b64_tr_b16 a[114:115], v14 offset:34816
M v[56:59], a[80:83], a[160:163], v[56:59]
M v[56:59], a[84:87], a[164:167], v[56:59]
buffer_load_dwordx4 v7, s[12:15], s24 offen offset:1024 lds
M v[60:63], a[92:95], a[164:167], v[60:63]
M v[60:63], a[88:91], a[160:163], v[60:63]
s_waitcnt lgkmcnt(8)
ds_read_b64_tr_b16 a[120:121], v15 offset:32768
ds_read_b64_tr_b16 a[122:123], v15 offset:34816
M v[64:67], a[32:35], a[168:171], v[64:67]
M v[64:67], a[36:39], a[172:175], v[64:67]
ds_read_b128 a[184:187], v10 offset:6144
ds_read_b128 a[188:191], v11 offset:6144
M v[68:71], a[44:47], a[172:175], v[68:71]
M v[68:71], a[40:43], a[168:171], v[68:71]
ds_read_b64_tr_b16 a[128:129], v16 offset:32768
ds_read_b64_tr_b16 a[130:131], v16 offset:34816
M v[72:75], a[48:51], a[168:171], v[72:75]
buffer_load_dwordx4 v8, s[12:15], s24 offen offset:2048 lds
M v[72:75], a[52:55], a[172:175], v[72:75]
M v[76:79], a[60:63], a[172:175], v[76:79]
M v[76:79], a[56:59], a[168:171], v[76:79]
ds_read_b64_tr_b16 a[136:137], v17 offset:32768
ds_read_b64_tr_b16 a[138:139], v17 offset:34816
M v[80:83], a[64:67], a[168:171], v[80:83]
M v[80:83], a[68:71], a[172:175], v[80:83]
M v[84:87], a[76:79], a[172:175], v[84:87]
buffer_load_dwordx4 v9, s[12:15], s24 offen offset:3072 lds
M v[84:87], a[72:75], a[168:171], v[84:87]
ds_read_b64_tr_b16 a[144:145], v18 offset:32768
ds_read_b64_tr_b16 a[146:147], v18 offset:34816
M v[88:91], a[80:83], a[168:171], v[88:91]
M v[88:91], a[84:87], a[172:175], v[88:91]
M v[92:95], a[92:95], a[172:175], v[92:95]
M v[92:95], a[88:91], a[168:171], v[92:95]
s_waitcnt lgkmcnt(15)
ds_read_b64_tr_b16 a[152:153], v19 offset:32768
ds_read_b64_tr_b16 a[154:155], v19 offset:34816
M v[96:99], a[32:35], a[176:179], v[96:99]
s_add_u32 s24, s24, 262144
s_cmp_eq_u32 s24, s27
s_cselect_b32 s24, s28, s24
s_sub_u32 s6, s6, 1
s_cmp_eq_u32 s6, 0
s_cselect_b64 s[12:13], s[64:65], s[12:13]
M v[96:99], a[36:39], a[180:183], v[96:99]
M v[100:103], a[44:47], a[180:183], v[100:103]
M v[100:103], a[40:43], a[176:179], v[100:103]
M v[104:107], a[48:51], a[176:179], v[104:107]
M v[104:107], a[52:55], a[180:183], v[104:107]
M v[108:111], a[60:63], a[180:183], v[108:111]
M v[108:111], a[56:59], a[176:179], v[108:111]
s_waitcnt vmcnt(17) lgkmcnt(0)
s_barrier
ds_read_b128 a[160:163], v10 offset:16384
ds_read_b128 a[164:167], v11 offset:16384
M v[112:115], a[64:67], a[176:179], v[112:115]
s_add_u32 m0, s29, 0
s_nop 0
buffer_load_dwordx4 v2, s[8:11], s23 offen offset:0 lds
M v[112:115], a[68:71], a[180:183], v[112:115]
M v[116:119], a[76:79], a[180:183], v[116:119]
M v[116:119], a[72:75], a[176:179], v[116:119]
ds_read_b64_tr_b16 a[100:101], v12 offset:49152
ds_read_b64_tr_b16 a[102:103], v12 offset:51200
M v[120:123], a[80:83], a[176:179], v[120:123]
M v[120:123], a[84:87], a[180:183], v[120:123]
M v[124:127], a[92:95], a[180:183], v[124:127]
buffer_load_dwordx4 v3, s[8:11], s23 offen offset:1024 lds
M v[124:127], a[88:91], a[176:179], v[124:127]
M v[128:131], a[32:35], a[184:187], v[128:131]
M v[128:131], a[36:39], a[188:191], v[128:131]
ds_read_b128 a[168:171], v10 offset:18432
ds_read_b128 a[172:175], v11 offset:18432
ds_read_b64_tr_b16 a[108:109], v13 offset:49152
ds_read_b64_tr_b16 a[110:111], v13 offset:51200
M v[132:135], a[44:47], a[188:191], v[132:135]
M v[132:135], a[40:43], a[184:187], v[132:135]
M v[136:139], a[48:51], a[184:187], v[136:139]
M v[136:139], a[52:55], a[188:191], v[136:139]
buffer_load_dwordx4 v4, s[8:11], s23 offen offset:2048 lds
M v[140:143], a[60:63], a[188:191], v[140:143]
M v[140:143], a[56:59], a[184:187], v[140:143]
ds_read_b64_tr_b16 a[116:117], v14 offset:49152
ds_read_b64_tr_b16 a[118:119], v14 offset:51200
M v[144:147], a[64:67], a[184:187], v[144:147]
M v[144:147], a[68:71], a[188:191], v[144:147]
M v[148:151], a[76:79], a[188:191], v[148:151]
M v[148:151], a[72:75], a[184:187], v[148:151]
M v[152:155], a[80:83], a[184:187], v[152:155]
buffer_load_dwordx4 v5, s[8:11], s23 offen offset:3072 lds
M v[152:155], a[84:87], a[188:191], v[152:155]
ds_read_b64_tr_b16 a[124:125], v15 offset:49152
ds_read_b64_tr_b16 a[126:127], v15 offset:51200
M v[156:159], a[92:95], a[188:191], v[156:159]
M v[156:159], a[88:91], a[184:187], v[156:159]
s_waitcnt lgkmcnt(10)
M v[160:163], a[32:35], a[160:163], v[160:163]
M v[160:163], a[36:39], a[164:167], v[160:163]
ds_read_b128 a[176:179], v10 offset:20480
ds_read_b128 a[180:183], v11 offset:20480
M v[164:167], a[44:47], a[164:167], v[164:167]
M v[164:167], a[40:43], a[160:163], v[164:167]
ds_read_b64_tr_b16 a[132:133], v16 offset:49152
ds_read_b64_tr_b16 a[134:135], v16 offset:51200
M v[168:171], a[48:51], a[160:163], v[168:171]
M v[168:171], a[52:55], a[164:167], v[168:171]
s_add_u32 m0, s29, 98304
s_nop 0
buffer_load_dwordx4 v6, s[12:15], s24 offen offset:0 lds
M v[172:175], a[60:63], a[164:167], v[172:175]
M v[172:175], a[56:59], a[160:163], v[172:175]
M v[176:179], a[64:67], a[160:163], v[176:179]
M v[176:179], a[68:71], a[164:167], v[176:179]
ds_read_b64_tr_b16 a[140:141], v17 offset:49152
ds_read_b64_tr_b16 a[142:143], v17 offset:51200
M v[180:183], a[76:79], a[164:167], v[180:183]
M v[180:183], a[72:75], a[160:163], v[180:183]
buffer_load_dwordx4 v7, s[12:15], s24 offen offset:1024 lds
M v[184:187], a[80:83], a[160:163], v[184:187]
M v[184:187], a[84:87], a[164:167], v[184:187]
M v[188:191], a[92:95], a[164:167], v[188:191]
M v[188:191], a[88:91], a[160:163], v[188:191]
s_waitcnt lgkmcnt(12)
ds_read_b64_tr_b16 a[148:149], v18 offset:49152
ds_read_b64_tr_b16 a[150:151], v18 offset:51200
M v[192:195], a[32:35], a[168:171], v[192:195]
M v[192:195], a[36:39], a[172:175], v[192:195]
ds_read_b128 a[184:187], v10 offset:22528
ds_read_b128 a[188:191], v11 offset:22528
M v[196:199], a[44:47], a[172:175], v[196:199]
M v[196:199], a[40:43], a[168:171], v[196:199]
buffer_load_dwordx4 v8, s[12:15], s24 offen offset:2048 lds
M v[200:203], a[48:51], a[168:171], v[200:203]
M v[200:203], a[52:55], a[172:175], v[200:203]
ds_read_b64_tr_b16 a[156:157], v19 offset:49152
ds_read_b64_tr_b16 a[158:159], v19 offset:51200
M v[204:207], a[60:63], a[172:175], v[204:207]
M v[204:207], a[56:59], a[168:171], v[204:207]
M v[208:211], a[64:67], a[168:171], v[208:211]
M v[208:211], a[68:71], a[172:175], v[208:211]
buffer_load_dwordx4 v9, s[12:15], s24 offen offset:3072 lds
M v[212:215], a[76:79], a[172:175], v[212:215]
M v[212:215], a[72:75], a[168:171], v[212:215]
M v[216:219], a[80:83], a[168:171], v[216:219]
M v[216:219], a[84:87], a[172:175], v[216:219]
M v[220:223], a[92:95], a[172:175], v[220:223]
s_add_u32 s24, s24, 262144
M v[220:223], a[88:91], a[168:171], v[220:223]
s_waitcnt lgkmcnt(10)
M v[224:227], a[32:35], a[176:179], v[224:227]
M v[224:227], a[36:39], a[180:183], v[224:227]
M v[228:231], a[44:47], a[180:183], v[228:231]
M v[228:231], a[40:43], a[176:179], v[228:231]
M v[232:235], a[48:51], a[176:179], v[232:235]
M v[232:235], a[52:55], a[180:183], v[232:235]
M v[236:239], a[60:63], a[180:183], v[236:239]
M v[236:239], a[56:59], a[176:179], v[236:239]
s_waitcnt vmcnt(17) lgkmcnt(0)
s_barrier
ds_read_b128 a[160:163], v10 offset:32768
ds_read_b128 a[164:167], v11 offset:32768
M v[240:243], a[64:67], a[176:179], v[240:243]
s_add_u32 m0, s29, 16384
s_add_u32 s3, s23, s31
buffer_load_dwordx4 v2, s[8:11], s3 offen offset:0 lds
M v[240:243], a[68:71], a[180:183], v[240:243]
M v[244:247], a[76:79], a[180:183], v[244:247]
M v[244:247], a[72:75], a[176:179], v[244:247]
M v[248:251], a[80:83], a[176:179], v[248:251]
M v[248:251], a[84:87], a[180:183], v[248:251]
buffer_load_dwordx4 v3, s[8:11], s3 offen offset:1024 lds
M v[252:255], a[92:95], a[180:183], v[252:255]
M v[252:255], a[88:91], a[176:179], v[252:255]
M a[0:3], a[32:35], a[184:187], a[0:3]
M a[0:3], a[36:39], a[188:191], a[0:3]
ds_read_b128 a[168:171], v10 offset:34816
ds_read_b128 a[172:175], v11 offset:34816
M a[4:7], a[44:47], a[188:191], a[4:7]
M a[4:7], a[40:43], a[184:187], a[4:7]
M a[8:11], a[48:51], a[184:187], a[8:11]
buffer_load_dwordx4 v4, s[8:11], s3 offen offset:2048 lds
M a[8:11], a[52:55], a[188:191], a[8:11]
M a[12:15], a[60:63], a[188:191], a[12:15]
M a[12:15], a[56:59], a[184:187], a[12:15]
M a[16:19], a[64:67], a[184:187], a[16:19]
M a[16:19], a[68:71], a[188:191], a[16:19]
buffer_load_dwordx4 v5, s[8:11], s3 offen offset:3072 lds
M a[20:23], a[76:79], a[188:191], a[20:23]
M a[20:23], a[72:75], a[184:187], a[20:23]
M a[24:27], a[80:83], a[184:187], a[24:27]
M a[24:27], a[84:87], a[188:191], a[24:27]
M a[28:31], a[92:95], a[188:191], a[28:31]
M a[28:31], a[88:91], a[184:187], a[28:31]
s_waitcnt lgkmcnt(2)
M v[32:35], a[96:99], a[160:163], v[32:35]
s_add_u32 s23, s23, 128
s_cmp_eq_u32 s23, s25
s_cselect_b32 s23, s26, s23
M v[32:35], a[100:103], a[164:167], v[32:35]
ds_read_b128 a[176:179], v10 offset:36864
ds_read_b128 a[180:183], v11 offset:36864
M v[36:39], a[108:111], a[164:167], v[36:39]
M v[36:39], a[104:107], a[160:163], v[36:39]
ds_read_b64_tr_b16 a[32:33], v12 offset:0
ds_read_b64_tr_b16 a[34:35], v12 offset:2048
M v[40:43], a[112:115], a[160:163], v[40:43]
M v[40:43], a[116:119], a[164:167], v[40:43]
M v[44:47], a[124:127], a[164:167], v[44:47]
s_add_u32 m0, s29, 114688
s_nop 0
buffer_load_dwordx4 v6, s[12:15], s24 offen offset:0 lds
M v[44:47], a[120:123], a[160:163], v[44:47]
ds_read_b64_tr_b16 a[40:41], v13 offset:0
ds_read_b64_tr_b16 a[42:43], v13 offset:2048
M v[48:51], a[128:131], a[160:163], v[48:51]
M v[48:51], a[132:135], a[164:167], v[48:51]
M v[52:55], a[140:143], a[164:167], v[52:55]
M v[52:55], a[136:139], a[160:163], v[52:55]
ds_read_b64_tr_b16 a[48:49], v14 offset:0
ds_read_b64_tr_b16 a[50:51], v14 offset:2048
M v[56:59], a[144:147], a[160:163], v[56:59]
M v[56:59], a[148:151], a[164:167], v[56:59]
buffer_load_dwordx4 v7, s[12:15], s24 offen offset:1024 lds
M v[60:63], a[156:159], a[164:167], v[60:63]
M v[60:63], a[152:155], a[160:163], v[60:63]
s_waitcnt lgkmcnt(8)
ds_read_b64_tr_b16 a[56:57], v15 offset:0
ds_read_b64_tr_b16 a[58:59], v15 offset:2048
M v[64:67], a[96:99], a[168:171], v[64:67]
M v[64:67], a[100:103], a[172:175], v[64:67]
ds_read_b128 a[184:187], v10 offset:38912
ds_read_b128 a[188:191], v11 offset:38912
M v[68:71], a[108:111], a[172:175], v[68:71]
M v[68:71], a[104:107], a[168:171], v[68:71]
ds_read_b64_tr_b16 a[64:65], v16 offset:0
ds_read_b64_tr_b16 a[66:67], v16 offset:2048
M v[72:75], a[112:115], a[168:171], v[72:75]
buffer_load_dwordx4 v8, s[12:15], s24 offen offset:2048 lds
M v[72:75], a[116:119], a[172:175], v[72:75]
M v[76:79], a[124:127], a[172:175], v[76:79]
M v[76:79], a[120:123], a[168:171], v[76:79]
ds_read_b64_tr_b16 a[72:73], v17 offset:0
ds_read_b64_tr_b16 a[74:75], v17 offset:2048
M v[80:83], a[128:131], a[168:171], v[80:83]
M v[80:83], a[132:135], a[172:175], v[80:83]
M v[84:87], a[140:143], a[172:175], v[84:87]
buffer_load_dwordx4 v9, s[12:15], s24 offen offset:3072 lds
M v[84:87], a[136:139], a[168:171], v[84:87]
ds_read_b64_tr_b16 a[80:81], v18 offset:0
ds_read_b64_tr_b16 a[82:83], v18 offset:2048
M v[88:91], a[144:147], a[168:171], v[88:91]
M v[88:91], a[148:151], a[172:175], v[88:91]
M v[92:95], a[156:159], a[172:175], v[92:95]
M v[92:95], a[152:155], a[168:171], v[92:95]
s_waitcnt lgkmcnt(15)
ds_read_b64_tr_b16 a[88:89], v19 offset:0
ds_read_b64_tr_b16 a[90:91], v19 offset:2048
M v[96:99], a[96:99], a[176:179], v[96:99]
s_add_u32 s24, s24, 262144
s_cmp_eq_u32 s24, s27
s_cselect_b32 s24, s28, s24
s_sub_u32 s6, s6, 1
s_cmp_eq_u32 s6, 0
s_cselect_b64 s[12:13], s[64:65], s[12:13]
M v[96:99], a[100:103], a[180:183], v[96:99]
M v[100:103], a[108:111], a[180:183], v[100:103]
M v[100:103], a[104:107], a[176:179], v[100:103]
M v[104:107], a[112:115], a[176:179], v[104:107]
M v[104:107], a[116:119], a[180:183], v[104:107]
M v[108:111], a[124:127], a[180:183], v[108:111]
M v[108:111], a[120:123], a[176:179], v[108:111]
s_waitcnt vmcnt(16) lgkmcnt(0)
s_barrier
ds_read_b128 a[160:163], v10 offset:49152
ds_read_b128 a[164:167], v11 offset:49152
M v[112:115], a[128:131], a[176:179], v[112:115]
s_add_u32 m0, s29, 32768
s_nop 0
buffer_load_dwordx4 v2, s[8:11], s23 offen offset:0 lds
M v[112:115], a[132:135], a[180:183], v[112:115]
M v[116:119], a[140:143], a[180:183], v[116:119]
M v[116:119], a[136:139], a[176:179], v[116:119]
ds_read_b64_tr_b16 a[36:37], v12 offset:16384
ds_read_b64_tr_b16 a[38:39], v12 offset:18432
M v[120:123], a[144:147], a[176:179], v[120:123]
M v[120:123], a[148:151], a[180:183], v[120:123]
M v[124:127], a[156:159], a[180:183], v[124:127]
M v[124:127], a[152:155], a[176:179], v[124:127]
M v[128:131], a[96:99], a[184:187], v[128:131]
M v[128:131], a[100:103], a[188:191], v[128:131]
ds_read_b128 a[168:171], v10 offset:51200
ds_read_b128 a[172:175], v11 offset:51200
ds_read_b64_tr_b16 a[44:45], v13 offset:16384
ds_read_b64_tr_b16 a[46:47], v13 offset:18432
M v[132:135], a[108:111], a[188:191], v[132:135]
M v[132:135], a[104:107], a[184:187], v[132:135]
M v[136:139], a[112:115], a[184:187], v[136:139]
M v[136:139], a[116:119], a[188:191], v[136:139]
M v[140:143], a[124:127], a[188:191], v[140:143]
M v[140:143], a[120:123], a[184:187], v[140:143]
ds_read_b64_tr_b16 a[52:53], v14 offset:16384
ds_read_b64_tr_b16 a[54:55], v14 offset:18432
M v[144:147], a[128:131], a[184:187], v[144:147]
buffer_load_dwordx4 v3, s[8:11], s23 offen offset:1024 lds
M v[144:147], a[132:135], a[188:191], v[144:147]
M v[148:151], a[140:143], a[188:191], v[148:151]
M v[148:151], a[136:139], a[184:187], v[148:151]
M v[152:155], a[144:147], a[184:187], v[152:155]
M v[152:155], a[148:151], a[188:191], v[152:155]
ds_read_b64_tr_b16 a[60:61], v15 offset:16384
ds_read_b64_tr_b16 a[62:63], v15 offset:18432
M v[156:159], a[156:159], a[188:191], v[156:159]
M v[156:159], a[152:155], a[184:187], v[156:159]
s_waitcnt lgkmcnt(10)
M v[160:163], a[96:99], a[160:163], v[160:163]
M v[160:163], a[100:103], a[164:167], v[160:163]
ds_read_b128 a[176:179], v10 offset:53248
ds_read_b128 a[180:183], v11 offset:53248
M v[164:167], a[108:111], a[164:167], v[164:167]
M v[164:167], a[104:107], a[160:163], v[164:167]
ds_read_b64_tr_b16 a[68:69], v16 offset:16384
ds_read_b64_tr_b16 a[70:71], v16 offset:18432
M v[168:171], a[112:115], a[160:163], v[168:171]
M v[168:171], a[116:119], a[164:167], v[168:171]
M v[172:175], a[124:127], a[164:167], v[172:175]
M v[172:175], a[120:123], a[160:163], v[172:175]
M v[176:179], a[128:131], a[160:163], v[176:179]
buffer_load_dwordx4 v4, s[8:11], s23 offen offset:2048 lds
M v[176:179], a[132:135], a[164:167], v[176:179]
ds_read_b64_tr_b16 a[76:77], v17 offset:16384
ds_read_b64_tr_b16 a[78:79], v17 offset:18432
M v[180:183], a[140:143], a[164:167], v[180:183]
M v[180:183], a[136:139], a[160:163], v[180:183]
M v[184:187], a[144:147], a[160:163], v[184:187]
M v[184:187], a[148:151], a[164:167], v[184:187]
M v[188:191], a[156:159], a[164:167], v[188:191]
M v[188:191], a[152:155], a[160:163], v[188:191]
s_waitcnt lgkmcnt(12)
ds_read_b64_tr_b16 a[84:85], v18 offset:16384
ds_read_b64_tr_b16 a[86:87], v18 offset:18432
M v[192:195], a[96:99], a[168:171], v[192:195]
M v[192:195], a[100:103], a[172:175], v[192:195]
ds_read_b128 a[184:187], v10 offset:55296
ds_read_b128 a[188:191], v11 offset:55296
M v[196:199], a[108:111], a[172:175], v[196:199]
M v[196:199], a[104:107], a[168:171], v[196:199]
M v[200:203], a[112:115], a[168:171], v[200:203]
M v[200:203], a[116:119], a[172:175], v[200:203]
ds_read_b64_tr_b16 a[92:93], v19 offset:16384
ds_read_b64_tr_b16 a[94:95], v19 offset:18432
M v[204:207], a[124:127], a[172:175], v[204:207]
M v[204:207], a[120:123], a[168:171], v[204:207]
M v[208:211], a[128:131], a[168:171], v[208:211]
buffer_load_dwordx4 v5, s[8:11], s23 offen offset:3072 lds
M v[208:211], a[132:135], a[172:175], v[208:211]
M v[212:215], a[140:143], a[172:175], v[212:215]
M v[212:215], a[136:139], a[168:171], v[212:215]
M v[216:219], a[144:147], a[168:171], v[216:219]
M v[216:219], a[148:151], a[172:175], v[216:219]
M v[220:223], a[156:159], a[172:175], v[220:223]
M v[220:223], a[152:155], a[168:171], v[220:223]
s_waitcnt lgkmcnt(10)
M v[224:227], a[96:99], a[176:179], v[224:227]
M v[224:227], a[100:103], a[180:183], v[224:227]
M v[228:231], a[108:111], a[180:183], v[228:231]
M v[228:231], a[104:107], a[176:179], v[228:231]
M v[232:235], a[112:115], a[176:179], v[232:235]
M v[232:235], a[116:119], a[180:183], v[232:235]
M v[236:239], a[124:127], a[180:183], v[236:239]
M v[236:239], a[120:123], a[176:179], v[236:239]
s_waitcnt vmcnt(12) lgkmcnt(0)
s_barrier
ds_read_b128 a[160:163], v10 offset:0
ds_read_b128 a[164:167], v11 offset:0
M v[240:243], a[128:131], a[176:179], v[240:243]
s_add_u32 m0, s29, 49152
s_add_u32 s3, s23, s31
buffer_load_dwordx4 v2, s[8:11], s3 offen offset:0 lds
M v[240:243], a[132:135], a[180:183], v[240:243]
M v[244:247], a[140:143], a[180:183], v[244:247]
M v[244:247], a[136:139], a[176:179], v[244:247]
M v[248:251], a[144:147], a[176:179], v[248:251]
M v[248:251], a[148:151], a[180:183], v[248:251]
M v[252:255], a[156:159], a[180:183], v[252:255]
M v[252:255], a[152:155], a[176:179], v[252:255]
M a[0:3], a[96:99], a[184:187], a[0:3]
M a[0:3], a[100:103], a[188:191], a[0:3]
ds_read_b128 a[168:171], v10 offset:2048
ds_read_b128 a[172:175], v11 offset:2048
M a[4:7], a[108:111], a[188:191], a[4:7]
M a[4:7], a[104:107], a[184:187], a[4:7]
M a[8:11], a[112:115], a[184:187], a[8:11]
buffer_load_dwordx4 v3, s[8:11], s3 offen offset:1024 lds
M a[8:11], a[116:119], a[188:191], a[8:11]
M a[12:15], a[124:127], a[188:191], a[12:15]
M a[12:15], a[120:123], a[184:187], a[12:15]
M a[16:19], a[128:131], a[184:187], a[16:19]
M a[16:19], a[132:135], a[188:191], a[16:19]
M a[20:23], a[140:143], a[188:191], a[20:23]
M a[20:23], a[136:139], a[184:187], a[20:23]
M a[24:27], a[144:147], a[184:187], a[24:27]
M a[24:27], a[148:151], a[188:191], a[24:27]
M a[28:31], a[156:159], a[188:191], a[28:31]
M a[28:31], a[152:155], a[184:187], a[28:31]
s_waitcnt lgkmcnt(2)
M v[32:35], a[32:35], a[160:163], v[32:35]
buffer_load_dwordx4 v4, s[8:11], s3 offen offset:2048 lds
M v[32:35], a[36:39], a[164:167], v[32:35]
ds_read_b128 a[176:179], v10 offset:4096
ds_read_b128 a[180:183], v11 offset:4096
M v[36:39], a[44:47], a[164:167], v[36:39]
M v[36:39], a[40:43], a[160:163], v[36:39]
ds_read_b64_tr_b16 a[96:97], v12 offset:32768
ds_read_b64_tr_b16 a[98:99], v12 offset:34816
M v[40:43], a[48:51], a[160:163], v[40:43]
M v[40:43], a[52:55], a[164:167], v[40:43]
M v[44:47], a[60:63], a[164:167], v[44:47]
M v[44:47], a[56:59], a[160:163], v[44:47]
ds_read_b64_tr_b16 a[104:105], v13 offset:32768
ds_read_b64_tr_b16 a[106:107], v13 offset:34816
M v[48:51], a[64:67], a[160:163], v[48:51]
M v[48:51], a[68:71], a[164:167], v[48:51]
M v[52:55], a[76:79], a[164:167], v[52:55]
M v[52:55], a[72:75], a[160:163], v[52:55]
ds_read_b64_tr_b16 a[112:113], v14 offset:32768
ds_read_b64_tr_b16 a[114:115], v14 offset:34816
M v[56:59], a[80:83], a[160:163], v[56:59]
M v[56:59], a[84:87], a[164:167], v[56:59]
buffer_load_dwordx4 v5, s[8:11], s3 offen offset:3072 lds
M v[60:63], a[92:95], a[164:167], v[60:63]
M v[60:63], a[88:91], a[160:163], v[60:63]
s_waitcnt lgkmcnt(8)
ds_read_b64_tr_b16 a[120:121], v15 offset:32768
ds_read_b64_tr_b16 a[122:123], v15 offset:34816
M v[64:67], a[32:35], a[168:171], v[64:67]
M v[64:67], a[36:39], a[172:175], v[64:67]
ds_read_b128 a[184:187], v10 offset:6144
ds_read_b128 a[188:191], v11 offset:6144
M v[68:71], a[44:47], a[172:175], v[68:71]
M v[68:71], a[40:43], a[168:171], v[68:71]
ds_read_b64_tr_b16 a[128:129], v16 offset:32768
ds_read_b64_tr_b16 a[130:131], v16 offset:34816
M v[72:75], a[48:51], a[168:171], v[72:75]
M v[72:75], a[52:55], a[172:175], v[72:75]
M v[76:79], a[60:63], a[172:175], v[76:79]
M v[76:79], a[56:59], a[168:171], v[76:79]
ds_read_b64_tr_b16 a[136:137], v17 offset:32768
ds_read_b64_tr_b16 a[138:139], v17 offset:34816
M v[80:83], a[64:67], a[168:171], v[80:83]
M v[80:83], a[68:71], a[172:175], v[80:83]
M v[84:87], a[76:79], a[172:175], v[84:87]
s_add_u32 s23, s23, 128
s_cmp_eq_u32 s23, s25
s_cselect_b32 s23, s26, s23
M v[84:87], a[72:75], a[168:171], v[84:87]
ds_read_b64_tr_b16 a[144:145], v18 offset:32768
ds_read_b64_tr_b16 a[146:147], v18 offset:34816
M v[88:91], a[80:83], a[168:171], v[88:91]
M v[88:91], a[84:87], a[172:175], v[88:91]
M v[92:95], a[92:95], a[172:175], v[92:95]
M v[92:95], a[88:91], a[168:171], v[92:95]
s_waitcnt lgkmcnt(15)
ds_read_b64_tr_b16 a[152:153], v19 offset:32768
ds_read_b64_tr_b16 a[154:155], v19 offset:34816
M v[96:99], a[32:35], a[176:179], v[96:99]
M v[96:99], a[36:39], a[180:183], v[96:99]
M v[100:103], a[44:47], a[180:183], v[100:103]
M v[100:103], a[40:43], a[176:179], v[100:103]
M v[104:107], a[48:51], a[176:179], v[104:107]
M v[104:107], a[52:55], a[180:183], v[104:107]
M v[108:111], a[60:63], a[180:183], v[108:111]
M v[108:111], a[56:59], a[176:179], v[108:111]
s_waitcnt vmcnt(8) lgkmcnt(0)
s_barrier
ds_read_b128 a[160:163], v10 offset:16384
ds_read_b128 a[164:167], v11 offset:16384
M v[112:115], a[64:67], a[176:179], v[112:115]
M v[112:115], a[68:71], a[180:183], v[112:115]
s_and_b32 s3, s2, 1
s_lshl_b32 s3, s3, 3
s_bfe_u32 s4, s2, 0x30003
M v[116:119], a[76:79], a[180:183], v[116:119]
s_add_u32 s26, s3, s4
s_bfe_u32 s3, s2, 0x20001
s_lshl_b32 s3, s3, 2
M v[116:119], a[72:75], a[176:179], v[116:119]
ds_read_b64_tr_b16 a[100:101], v12 offset:49152
ds_read_b64_tr_b16 a[102:103], v12 offset:51200
s_lshr_b32 s4, s2, 6
s_xor_b32 s4, s4, 2
s_add_u32 s27, s3, s4
M v[120:123], a[80:83], a[176:179], v[120:123]
s_lshl_b32 s23, s26, 18
s_sub_u32 s24, s23, 32768
M v[120:123], a[84:87], a[180:183], v[120:123]
s_max_i32 s24, s24, 0
s_lshl_b32 s25, s27, 7
s_xor_b32 s3, s26, s27
M v[124:127], a[92:95], a[180:183], v[124:127]
s_and_b32 s3, s3, 0
s_lshl_b32 s3, s3, 3
s_sub_u32 s31, 16, s3
M v[124:127], a[88:91], a[176:179], v[124:127]
s_mov_b32 s54, s31
s_movk_i32 s57, 128
s_mov_b32 s55, 4289069056
M v[128:131], a[32:35], a[184:187], v[128:131]
s_mov_b32 s56, 393216
s_lshl_b32 s4, s3, 7
M v[128:131], a[36:39], a[188:191], v[128:131]
ds_read_b128 a[168:171], v10 offset:18432
ds_read_b128 a[172:175], v11 offset:18432
ds_read_b64_tr_b16 a[108:109], v13 offset:49152
ds_read_b64_tr_b16 a[110:111], v13 offset:51200
s_add_u32 s23, s23, s4
s_add_u32 s24, s24, s4
s_mul_i32 s4, s3, 393216
M v[132:135], a[44:47], a[188:191], v[132:135]
s_add_u32 s25, s25, s4
s_mov_b64 s[8:9], s[44:45]
s_mov_b32 s10, 4194304
M v[132:135], a[40:43], a[184:187], v[132:135]
s_mov_b64 s[12:13], s[46:47]
s_mov_b32 s14, 6291456
M v[136:139], a[48:51], a[184:187], v[136:139]
s_mov_b64 s[36:37], s[90:91]
s_mov_b32 s38, 256
s_mov_b32 s39, 0x00020000
M v[136:139], a[52:55], a[188:191], v[136:139]
s_lshl_b32 s28, s20, 9
s_mul_i32 s30, s20, 6144
s_lshl_b32 s3, s20, 5
M v[140:143], a[60:63], a[188:191], v[140:143]
v_lshrrev_b32 v24, 3, v0
v_and_b32 v25, 7, v0
v_add_u32 v28, s3, v24
M v[140:143], a[56:59], a[184:187], v[140:143]
ds_read_b64_tr_b16 a[116:117], v14 offset:49152
ds_read_b64_tr_b16 a[118:119], v14 offset:51200
v_add_u32 v26, 0, v28
v_bfe_u32 v27, v26, 1, 3
M v[144:147], a[64:67], a[184:187], v[144:147]
v_xor_b32 v27, v27, v25
v_lshlrev_b32 v26, 11, v26
v_lshl_add_u32 v26, v27, 4, v26
M v[144:147], a[68:71], a[188:191], v[144:147]
v_subrev_u32 v2, 0, v26
v_add_u32 v26, 8, v28
v_bfe_u32 v27, v26, 1, 3
M v[148:151], a[76:79], a[188:191], v[148:151]
v_xor_b32 v27, v27, v25
v_lshlrev_b32 v26, 11, v26
v_lshl_add_u32 v26, v27, 4, v26
M v[148:151], a[72:75], a[184:187], v[148:151]
v_subrev_u32 v3, 1024, v26
v_add_u32 v26, 16, v28
M v[152:155], a[80:83], a[184:187], v[152:155]
v_bfe_u32 v27, v26, 1, 3
v_xor_b32 v27, v27, v25
v_lshlrev_b32 v26, 11, v26
M v[152:155], a[84:87], a[188:191], v[152:155]
ds_read_b64_tr_b16 a[124:125], v15 offset:49152
ds_read_b64_tr_b16 a[126:127], v15 offset:51200
v_lshl_add_u32 v26, v27, 4, v26
v_subrev_u32 v4, 2048, v26
v_add_u32 v26, 24, v28
M v[156:159], a[92:95], a[188:191], v[156:159]
v_bfe_u32 v27, v26, 1, 3
v_xor_b32 v27, v27, v25
M v[156:159], a[88:91], a[184:187], v[156:159]
s_waitcnt lgkmcnt(10)
v_lshlrev_b32 v26, 11, v26
v_lshl_add_u32 v26, v27, 4, v26
v_subrev_u32 v5, 3072, v26
M v[160:163], a[32:35], a[160:163], v[160:163]
s_lshl_b32 s3, s20, 2
v_lshrrev_b32 v26, 5, v0
v_add_u32 v26, s3, v26
M v[160:163], a[36:39], a[164:167], v[160:163]
ds_read_b128 a[176:179], v10 offset:20480
ds_read_b128 a[180:183], v11 offset:20480
v_bfe_u32 v29, v0, 2, 3
v_bfe_u32 v27, v26, 1, 3
v_xor_b32 v27, v27, v29
M v[164:167], a[44:47], a[164:167], v[164:167]
v_lshlrev_b32 v27, 4, v27
v_and_b32 v30, 3, v0
M v[164:167], a[40:43], a[160:163], v[164:167]
ds_read_b64_tr_b16 a[132:133], v16 offset:49152
ds_read_b64_tr_b16 a[134:135], v16 offset:51200
v_lshl_add_u32 v27, v30, 2, v27
v_lshl_add_u32 v20, v26, 11, v27
v_add_u32 v26, 2, v26
M v[168:171], a[48:51], a[160:163], v[168:171]
v_bfe_u32 v27, v26, 1, 3
v_xor_b32 v27, v27, v29
v_lshlrev_b32 v27, 4, v27
M v[168:171], a[52:55], a[164:167], v[168:171]
v_and_b32 v30, 3, v0
v_lshl_add_u32 v27, v30, 2, v27
M v[172:175], a[60:63], a[164:167], v[172:175]
v_lshl_add_u32 v23, v26, 11, v27
v_subrev_u32 v23, 256, v23
s_mul_i32 s3, s20, 48
M v[172:175], a[56:59], a[160:163], v[172:175]
v_add_u32 v28, s3, v24
v_add_u32 v26, 0, v28
v_mul_u32_u24 v27, 0xaaab, v26
M v[176:179], a[64:67], a[160:163], v[176:179]
v_lshrrev_b32 v27, 17, v27
v_lshrrev_b32 v29, 1, v27
v_and_b32 v29, 4, v29
M v[176:179], a[68:71], a[164:167], v[176:179]
ds_read_b64_tr_b16 a[140:141], v17 offset:49152
ds_read_b64_tr_b16 a[142:143], v17 offset:51200
v_and_or_b32 v27, v27, 2, v29
v_xor_b32 v27, v27, v25
M v[180:183], a[76:79], a[164:167], v[180:183]
v_lshlrev_b32 v26, 11, v26
v_lshl_add_u32 v26, v27, 4, v26
v_subrev_u32 v6, 0, v26
M v[180:183], a[72:75], a[160:163], v[180:183]
v_add_u32 v26, 8, v28
v_mul_u32_u24 v27, 0xaaab, v26
v_lshrrev_b32 v27, 17, v27
M v[184:187], a[80:83], a[160:163], v[184:187]
v_lshrrev_b32 v29, 1, v27
v_and_b32 v29, 4, v29
v_and_or_b32 v27, v27, 2, v29
M v[184:187], a[84:87], a[164:167], v[184:187]
v_xor_b32 v27, v27, v25
v_lshlrev_b32 v26, 11, v26
M v[188:191], a[92:95], a[164:167], v[188:191]
v_lshl_add_u32 v26, v27, 4, v26
v_subrev_u32 v7, 1024, v26
v_add_u32 v26, 16, v28
M v[188:191], a[88:91], a[160:163], v[188:191]
s_waitcnt lgkmcnt(12)
ds_read_b64_tr_b16 a[148:149], v18 offset:49152
ds_read_b64_tr_b16 a[150:151], v18 offset:51200
v_mul_u32_u24 v27, 0xaaab, v26
v_lshrrev_b32 v27, 17, v27
v_lshrrev_b32 v29, 1, v27
M v[192:195], a[32:35], a[168:171], v[192:195]
v_and_b32 v29, 4, v29
v_and_or_b32 v27, v27, 2, v29
M v[192:195], a[36:39], a[172:175], v[192:195]
ds_read_b128 a[184:187], v10 offset:22528
ds_read_b128 a[188:191], v11 offset:22528
v_xor_b32 v27, v27, v25
v_lshlrev_b32 v26, 11, v26
v_lshl_add_u32 v26, v27, 4, v26
M v[196:199], a[44:47], a[172:175], v[196:199]
v_subrev_u32 v8, 2048, v26
v_add_u32 v26, 24, v28
v_mul_u32_u24 v27, 0xaaab, v26
M v[196:199], a[40:43], a[168:171], v[196:199]
v_lshrrev_b32 v27, 17, v27
v_lshrrev_b32 v29, 1, v27
v_and_b32 v29, 4, v29
M v[200:203], a[48:51], a[168:171], v[200:203]
v_and_or_b32 v27, v27, 2, v29
v_xor_b32 v27, v27, v25
M v[200:203], a[52:55], a[172:175], v[200:203]
ds_read_b64_tr_b16 a[156:157], v19 offset:49152
ds_read_b64_tr_b16 a[158:159], v19 offset:51200
v_lshlrev_b32 v26, 11, v26
v_lshl_add_u32 v26, v27, 4, v26
v_subrev_u32 v9, 3072, v26
M v[204:207], a[60:63], a[172:175], v[204:207]
v_add_u32 v26, 32, v28
v_mul_u32_u24 v27, 0xaaab, v26
v_lshrrev_b32 v27, 17, v27
M v[204:207], a[56:59], a[168:171], v[204:207]
v_lshrrev_b32 v29, 1, v27
v_and_b32 v29, 4, v29
v_and_or_b32 v27, v27, 2, v29
M v[208:211], a[64:67], a[168:171], v[208:211]
v_xor_b32 v27, v27, v25
v_lshlrev_b32 v26, 11, v26
M v[208:211], a[68:71], a[172:175], v[208:211]
v_lshl_add_u32 v26, v27, 4, v26
v_subrev_u32 v21, 0, v26
v_add_u32 v26, 40, v28
M v[212:215], a[76:79], a[172:175], v[212:215]
v_mul_u32_u24 v27, 0xaaab, v26
v_lshrrev_b32 v27, 17, v27
v_lshrrev_b32 v29, 1, v27
M v[212:215], a[72:75], a[168:171], v[212:215]
v_and_b32 v29, 4, v29
v_and_or_b32 v27, v27, 2, v29
M v[216:219], a[80:83], a[168:171], v[216:219]
v_xor_b32 v27, v27, v25
v_lshlrev_b32 v26, 11, v26
v_lshl_add_u32 v26, v27, 4, v26
M v[216:219], a[84:87], a[172:175], v[216:219]
v_subrev_u32 v22, 1024, v26
s_lshr_b32 s3, s53, 7
s_add_u32 s3, s3, s22
M v[220:223], a[92:95], a[172:175], v[220:223]
s_lshl_b32 s3, s3, 5
s_lshr_b32 s19, s52, 6
s_add_u32 s3, s3, s19
M v[220:223], a[88:91], a[168:171], v[220:223]
s_waitcnt lgkmcnt(10)
s_lshl_b32 s19, s21, 1
s_add_u32 s3, s3, s19
M v[224:227], a[32:35], a[176:179], v[224:227]
s_lshl_b32 s92, s3, 14
s_add_u32 s93, s92, 16384
s_add_u32 s16, s50, 0
M v[224:227], a[36:39], a[180:183], v[224:227]
s_addc_u32 s17, s51, 0
s_mov_b32 s18, 16777216
s_mov_b32 s19, 0x00020000
M v[228:231], a[44:47], a[180:183], v[228:231]
s_mov_b32 s4, 0x3e0293ee
s_mov_b32 s5, 0x3e0293ee
M v[228:231], a[40:43], a[176:179], v[228:231]
M v[232:235], a[48:51], a[176:179], v[232:235]
M v[232:235], a[52:55], a[180:183], v[232:235]
M v[236:239], a[60:63], a[180:183], v[236:239]
M v[236:239], a[56:59], a[176:179], v[236:239]
s_waitcnt vmcnt(4) lgkmcnt(0)
s_barrier
ds_read_b128 a[160:163], v10 offset:32768
ds_read_b128 a[164:167], v11 offset:32768
M v[240:243], a[64:67], a[176:179], v[240:243]
s_add_u32 m0, s28, 131072
s_nop 0
buffer_load_dword v20, s[8:11], s24 offen lds
M v[240:243], a[68:71], a[180:183], v[240:243]
M v[244:247], a[76:79], a[180:183], v[244:247]
M v[244:247], a[72:75], a[176:179], v[244:247]
buffer_load_dword v23, s[8:11], s24 offen offset:256 lds
M v[248:251], a[80:83], a[176:179], v[248:251]
M v[248:251], a[84:87], a[180:183], v[248:251]
M v[252:255], a[92:95], a[180:183], v[252:255]
M v[252:255], a[88:91], a[176:179], v[252:255]
M a[0:3], a[32:35], a[184:187], a[0:3]
s_add_u32 m0, s29, 133120
s_nop 0
buffer_load_dwordx4 v2, s[8:11], s23 offen offset:0 lds
M a[0:3], a[36:39], a[188:191], a[0:3]
ds_read_b128 a[168:171], v10 offset:34816
ds_read_b128 a[172:175], v11 offset:34816
M a[4:7], a[44:47], a[188:191], a[4:7]
M a[4:7], a[40:43], a[184:187], a[4:7]
M a[8:11], a[48:51], a[184:187], a[8:11]
buffer_load_dwordx4 v3, s[8:11], s23 offen offset:1024 lds
M a[8:11], a[52:55], a[188:191], a[8:11]
M a[12:15], a[60:63], a[188:191], a[12:15]
M a[12:15], a[56:59], a[184:187], a[12:15]
M a[16:19], a[64:67], a[184:187], a[16:19]
buffer_load_dwordx4 v4, s[8:11], s23 offen offset:2048 lds
M a[16:19], a[68:71], a[188:191], a[16:19]
M a[20:23], a[76:79], a[188:191], a[20:23]
M a[20:23], a[72:75], a[184:187], a[20:23]
buffer_load_dwordx4 v5, s[8:11], s23 offen offset:3072 lds
M a[24:27], a[80:83], a[184:187], a[24:27]
M a[24:27], a[84:87], a[188:191], a[24:27]
M a[28:31], a[92:95], a[188:191], a[28:31]
M a[28:31], a[88:91], a[184:187], a[28:31]
s_waitcnt lgkmcnt(2)
M v[32:35], a[96:99], a[160:163], v[32:35]
s_sub_u32 s31, s31, 1
s_cmp_eq_u32 s31, 0
s_cselect_b32 s58, -1920, s57
s_add_u32 s23, s23, s58
s_add_u32 s24, s24, s58
M v[32:35], a[100:103], a[164:167], v[32:35]
ds_read_b128 a[176:179], v10 offset:36864
ds_read_b128 a[180:183], v11 offset:36864
M v[36:39], a[108:111], a[164:167], v[36:39]
M v[36:39], a[104:107], a[160:163], v[36:39]
M v[40:43], a[112:115], a[160:163], v[40:43]
M v[40:43], a[116:119], a[164:167], v[40:43]
s_add_u32 m0, s30, 65536
s_nop 0
buffer_load_dwordx4 v6, s[12:15], s25 offen offset:0 lds
M v[44:47], a[124:127], a[164:167], v[44:47]
M v[44:47], a[120:123], a[160:163], v[44:47]
M v[48:51], a[128:131], a[160:163], v[48:51]
M v[48:51], a[132:135], a[164:167], v[48:51]
buffer_load_dwordx4 v7, s[12:15], s25 offen offset:1024 lds
M v[52:55], a[140:143], a[164:167], v[52:55]
M v[52:55], a[136:139], a[160:163], v[52:55]
M v[56:59], a[144:147], a[160:163], v[56:59]
M v[56:59], a[148:151], a[164:167], v[56:59]
buffer_load_dwordx4 v8, s[12:15], s25 offen offset:2048 lds
M v[60:63], a[156:159], a[164:167], v[60:63]
M v[60:63], a[152:155], a[160:163], v[60:63]
s_waitcnt lgkmcnt(2)
M v[64:67], a[96:99], a[168:171], v[64:67]
M v[64:67], a[100:103], a[172:175], v[64:67]
ds_read_b128 a[184:187], v10 offset:38912
ds_read_b128 a[188:191], v11 offset:38912
M v[68:71], a[108:111], a[172:175], v[68:71]
M v[68:71], a[104:107], a[168:171], v[68:71]
buffer_load_dwordx4 v9, s[12:15], s25 offen offset:3072 lds
v_pk_mul_f32 v[32:33], v[32:33], s[4:5]
v_pk_mul_f32 v[34:35], v[34:35], s[4:5]
v_pk_mul_f32 v[36:37], v[36:37], s[4:5]
M v[72:75], a[112:115], a[168:171], v[72:75]
v_pk_mul_f32 v[38:39], v[38:39], s[4:5]
v_cvt_pk_bf16_f32 v32, v32, v33
M v[72:75], a[116:119], a[172:175], v[72:75]
v_cvt_pk_bf16_f32 v33, v34, v35
v_cvt_pk_bf16_f32 v34, v36, v37
M v[76:79], a[124:127], a[172:175], v[76:79]
v_cvt_pk_bf16_f32 v35, v38, v39
v_pk_mul_f32 v[40:41], v[40:41], s[4:5]
v_pk_mul_f32 v[42:43], v[42:43], s[4:5]
M v[76:79], a[120:123], a[168:171], v[76:79]
s_add_u32 m0, s30, 69632
s_nop 0
buffer_load_dwordx4 v21, s[12:15], s25 offen offset:0 lds
v_pk_mul_f32 v[44:45], v[44:45], s[4:5]
v_pk_mul_f32 v[46:47], v[46:47], s[4:5]
M v[80:83], a[128:131], a[168:171], v[80:83]
v_cvt_pk_bf16_f32 v40, v40, v41
v_cvt_pk_bf16_f32 v41, v42, v43
M v[80:83], a[132:135], a[172:175], v[80:83]
v_cvt_pk_bf16_f32 v42, v44, v45
v_cvt_pk_bf16_f32 v43, v46, v47
M v[84:87], a[140:143], a[172:175], v[84:87]
v_pk_mul_f32 v[48:49], v[48:49], s[4:5]
v_pk_mul_f32 v[50:51], v[50:51], s[4:5]
v_pk_mul_f32 v[52:53], v[52:53], s[4:5]
M v[84:87], a[136:139], a[168:171], v[84:87]
buffer_load_dwordx4 v22, s[12:15], s25 offen offset:1024 lds
v_pk_mul_f32 v[54:55], v[54:55], s[4:5]
v_cvt_pk_bf16_f32 v48, v48, v49
M v[88:91], a[144:147], a[168:171], v[88:91]
v_cvt_pk_bf16_f32 v49, v50, v51
v_cvt_pk_bf16_f32 v50, v52, v53
M v[88:91], a[148:151], a[172:175], v[88:91]
v_cvt_pk_bf16_f32 v51, v54, v55
v_pk_mul_f32 v[56:57], v[56:57], s[4:5]
v_pk_mul_f32 v[58:59], v[58:59], s[4:5]
M v[92:95], a[156:159], a[172:175], v[92:95]
v_pk_mul_f32 v[60:61], v[60:61], s[4:5]
v_pk_mul_f32 v[62:63], v[62:63], s[4:5]
M v[92:95], a[152:155], a[168:171], v[92:95]
s_waitcnt lgkmcnt(2)
v_cvt_pk_bf16_f32 v56, v56, v57
v_cvt_pk_bf16_f32 v57, v58, v59
M v[96:99], a[96:99], a[176:179], v[96:99]
s_sub_u32 s54, s54, 1
s_cmp_eq_u32 s54, 0
s_cselect_b32 s58, s55, s56
s_add_u32 s25, s25, s58
v_cvt_pk_bf16_f32 v58, v60, v61
v_cvt_pk_bf16_f32 v59, v62, v63
M v[96:99], a[100:103], a[180:183], v[96:99]
M v[100:103], a[108:111], a[180:183], v[100:103]
M v[100:103], a[104:107], a[176:179], v[100:103]
v_pk_mul_f32 v[64:65], v[64:65], s[4:5]
v_pk_mul_f32 v[66:67], v[66:67], s[4:5]
v_pk_mul_f32 v[68:69], v[68:69], s[4:5]
M v[104:107], a[112:115], a[176:179], v[104:107]
s_add_u32 s94, s92, 0
buffer_store_dwordx4 v[32:35], v1, s[16:19], s94 offen offset:0 sc1
v_pk_mul_f32 v[70:71], v[70:71], s[4:5]
v_cvt_pk_bf16_f32 v64, v64, v65
M v[104:107], a[116:119], a[180:183], v[104:107]
v_cvt_pk_bf16_f32 v65, v66, v67
v_cvt_pk_bf16_f32 v66, v68, v69
M v[108:111], a[124:127], a[180:183], v[108:111]
v_cvt_pk_bf16_f32 v67, v70, v71
v_pk_mul_f32 v[72:73], v[72:73], s[4:5]
v_pk_mul_f32 v[74:75], v[74:75], s[4:5]
M v[108:111], a[120:123], a[176:179], v[108:111]
s_waitcnt vmcnt(13) lgkmcnt(0)
s_barrier
ds_read_b128 a[160:163], v10 offset:49152
ds_read_b128 a[164:167], v11 offset:49152
v_pk_mul_f32 v[76:77], v[76:77], s[4:5]
v_pk_mul_f32 v[78:79], v[78:79], s[4:5]
M v[112:115], a[128:131], a[176:179], v[112:115]
s_add_u32 m0, s28, 0
s_nop 0
buffer_load_dword v20, s[8:11], s24 offen lds
v_cvt_pk_bf16_f32 v72, v72, v73
v_cvt_pk_bf16_f32 v73, v74, v75
M v[112:115], a[132:135], a[180:183], v[112:115]
v_cvt_pk_bf16_f32 v74, v76, v77
v_cvt_pk_bf16_f32 v75, v78, v79
M v[116:119], a[140:143], a[180:183], v[116:119]
s_add_u32 s94, s92, 0
buffer_store_dwordx4 v[40:43], v1, s[16:19], s94 offen offset:1024 sc1
v_pk_mul_f32 v[80:81], v[80:81], s[4:5]
v_pk_mul_f32 v[82:83], v[82:83], s[4:5]
v_pk_mul_f32 v[84:85], v[84:85], s[4:5]
M v[116:119], a[136:139], a[176:179], v[116:119]
v_pk_mul_f32 v[86:87], v[86:87], s[4:5]
v_cvt_pk_bf16_f32 v80, v80, v81
M v[120:123], a[144:147], a[176:179], v[120:123]
buffer_load_dword v23, s[8:11], s24 offen offset:256 lds
v_cvt_pk_bf16_f32 v81, v82, v83
v_cvt_pk_bf16_f32 v82, v84, v85
M v[120:123], a[148:151], a[180:183], v[120:123]
v_cvt_pk_bf16_f32 v83, v86, v87
v_pk_mul_f32 v[88:89], v[88:89], s[4:5]
v_pk_mul_f32 v[90:91], v[90:91], s[4:5]
M v[124:127], a[156:159], a[180:183], v[124:127]
v_pk_mul_f32 v[92:93], v[92:93], s[4:5]
v_pk_mul_f32 v[94:95], v[94:95], s[4:5]
M v[124:127], a[152:155], a[176:179], v[124:127]
v_cvt_pk_bf16_f32 v88, v88, v89
v_cvt_pk_bf16_f32 v89, v90, v91
M v[128:131], a[96:99], a[184:187], v[128:131]
s_add_u32 m0, s29, 2048
s_nop 0
buffer_load_dwordx4 v2, s[8:11], s23 offen offset:0 lds
v_cvt_pk_bf16_f32 v90, v92, v93
v_cvt_pk_bf16_f32 v91, v94, v95
M v[128:131], a[100:103], a[188:191], v[128:131]
ds_read_b128 a[168:171], v10 offset:51200
ds_read_b128 a[172:175], v11 offset:51200
M v[132:135], a[108:111], a[188:191], v[132:135]
s_add_u32 s94, s92, 0
buffer_store_dwordx4 v[48:51], v1, s[16:19], s94 offen offset:2048 sc1
M v[132:135], a[104:107], a[184:187], v[132:135]
v_pk_mul_f32 v[96:97], v[96:97], s[4:5]
v_pk_mul_f32 v[98:99], v[98:99], s[4:5]
v_pk_mul_f32 v[100:101], v[100:101], s[4:5]
M v[136:139], a[112:115], a[184:187], v[136:139]
v_pk_mul_f32 v[102:103], v[102:103], s[4:5]
v_cvt_pk_bf16_f32 v96, v96, v97
M v[136:139], a[116:119], a[188:191], v[136:139]
buffer_load_dwordx4 v3, s[8:11], s23 offen offset:1024 lds
v_cvt_pk_bf16_f32 v97, v98, v99
v_cvt_pk_bf16_f32 v98, v100, v101
M v[140:143], a[124:127], a[188:191], v[140:143]
v_cvt_pk_bf16_f32 v99, v102, v103
v_pk_mul_f32 v[104:105], v[104:105], s[4:5]
v_pk_mul_f32 v[106:107], v[106:107], s[4:5]
M v[140:143], a[120:123], a[184:187], v[140:143]
v_pk_mul_f32 v[108:109], v[108:109], s[4:5]
v_pk_mul_f32 v[110:111], v[110:111], s[4:5]
M v[144:147], a[128:131], a[184:187], v[144:147]
s_add_u32 s94, s92, 0
buffer_store_dwordx4 v[56:59], v1, s[16:19], s94 offen offset:3072 sc1
v_cvt_pk_bf16_f32 v104, v104, v105
v_cvt_pk_bf16_f32 v105, v106, v107
M v[144:147], a[132:135], a[188:191], v[144:147]
v_cvt_pk_bf16_f32 v106, v108, v109
v_cvt_pk_bf16_f32 v107, v110, v111
M v[148:151], a[140:143], a[188:191], v[148:151]
buffer_load_dwordx4 v4, s[8:11], s23 offen offset:2048 lds
v_pk_mul_f32 v[112:113], v[112:113], s[4:5]
v_pk_mul_f32 v[114:115], v[114:115], s[4:5]
v_pk_mul_f32 v[116:117], v[116:117], s[4:5]
M v[148:151], a[136:139], a[184:187], v[148:151]
v_pk_mul_f32 v[118:119], v[118:119], s[4:5]
v_cvt_pk_bf16_f32 v112, v112, v113
M v[152:155], a[144:147], a[184:187], v[152:155]
v_cvt_pk_bf16_f32 v113, v114, v115
v_cvt_pk_bf16_f32 v114, v116, v117
M v[152:155], a[148:151], a[188:191], v[152:155]
buffer_load_dwordx4 v5, s[8:11], s23 offen offset:3072 lds
v_cvt_pk_bf16_f32 v115, v118, v119
v_pk_mul_f32 v[120:121], v[120:121], s[4:5]
v_pk_mul_f32 v[122:123], v[122:123], s[4:5]
M v[156:159], a[156:159], a[188:191], v[156:159]
v_pk_mul_f32 v[124:125], v[124:125], s[4:5]
v_pk_mul_f32 v[126:127], v[126:127], s[4:5]
M v[156:159], a[152:155], a[184:187], v[156:159]
s_add_u32 s94, s92, 4096
buffer_store_dwordx4 v[64:67], v1, s[16:19], s94 offen offset:0 sc1
s_waitcnt lgkmcnt(2)
v_cvt_pk_bf16_f32 v120, v120, v121
v_cvt_pk_bf16_f32 v121, v122, v123
M v[160:163], a[96:99], a[160:163], v[160:163]
v_cvt_pk_bf16_f32 v122, v124, v125
v_cvt_pk_bf16_f32 v123, v126, v127
M v[160:163], a[100:103], a[164:167], v[160:163]
ds_read_b128 a[176:179], v10 offset:53248
ds_read_b128 a[180:183], v11 offset:53248
M v[164:167], a[108:111], a[164:167], v[164:167]
s_sub_u32 s31, s31, 1
s_cmp_eq_u32 s31, 0
s_cselect_b32 s58, -1920, s57
s_add_u32 s23, s23, s58
s_add_u32 s24, s24, s58
M v[164:167], a[104:107], a[160:163], v[164:167]
v_pk_mul_f32 v[128:129], v[128:129], s[4:5]
v_pk_mul_f32 v[130:131], v[130:131], s[4:5]
v_pk_mul_f32 v[132:133], v[132:133], s[4:5]
M v[168:171], a[112:115], a[160:163], v[168:171]
v_pk_mul_f32 v[134:135], v[134:135], s[4:5]
v_cvt_pk_bf16_f32 v128, v128, v129
M v[168:171], a[116:119], a[164:167], v[168:171]
s_add_u32 s94, s92, 4096
buffer_store_dwordx4 v[72:75], v1, s[16:19], s94 offen offset:1024 sc1
v_cvt_pk_bf16_f32 v129, v130, v131
v_cvt_pk_bf16_f32 v130, v132, v133
M v[172:175], a[124:127], a[164:167], v[172:175]
v_cvt_pk_bf16_f32 v131, v134, v135
v_pk_mul_f32 v[136:137], v[136:137], s[4:5]
v_pk_mul_f32 v[138:139], v[138:139], s[4:5]
M v[172:175], a[120:123], a[160:163], v[172:175]
s_add_u32 m0, s30, 98304
s_nop 0
buffer_load_dwordx4 v6, s[12:15], s25 offen offset:0 lds
v_pk_mul_f32 v[140:141], v[140:141], s[4:5]
v_pk_mul_f32 v[142:143], v[142:143], s[4:5]
M v[176:179], a[128:131], a[160:163], v[176:179]
v_cvt_pk_bf16_f32 v136, v136, v137
v_cvt_pk_bf16_f32 v137, v138, v139
M v[176:179], a[132:135], a[164:167], v[176:179]
v_cvt_pk_bf16_f32 v138, v140, v141
v_cvt_pk_bf16_f32 v139, v142, v143
M v[180:183], a[140:143], a[164:167], v[180:183]
buffer_load_dwordx4 v7, s[12:15], s25 offen offset:1024 lds
v_pk_mul_f32 v[144:145], v[144:145], s[4:5]
v_pk_mul_f32 v[146:147], v[146:147], s[4:5]
v_pk_mul_f32 v[148:149], v[148:149], s[4:5]
M v[180:183], a[136:139], a[160:163], v[180:183]
v_pk_mul_f32 v[150:151], v[150:151], s[4:5]
v_cvt_pk_bf16_f32 v144, v144, v145
M v[184:187], a[144:147], a[160:163], v[184:187]
s_add_u32 s94, s92, 4096
buffer_store_dwordx4 v[80:83], v1, s[16:19], s94 offen offset:2048 sc1
v_cvt_pk_bf16_f32 v145, v146, v147
v_cvt_pk_bf16_f32 v146, v148, v149
M v[184:187], a[148:151], a[164:167], v[184:187]
v_cvt_pk_bf16_f32 v147, v150, v151
v_pk_mul_f32 v[152:153], v[152:153], s[4:5]
v_pk_mul_f32 v[154:155], v[154:155], s[4:5]
M v[188:191], a[156:159], a[164:167], v[188:191]
buffer_load_dwordx4 v8, s[12:15], s25 offen offset:2048 lds
v_pk_mul_f32 v[156:157], v[156:157], s[4:5]
v_pk_mul_f32 v[158:159], v[158:159], s[4:5]
M v[188:191], a[152:155], a[160:163], v[188:191]
s_waitcnt lgkmcnt(2)
v_cvt_pk_bf16_f32 v152, v152, v153
v_cvt_pk_bf16_f32 v153, v154, v155
M v[192:195], a[96:99], a[168:171], v[192:195]
v_cvt_pk_bf16_f32 v154, v156, v157
v_cvt_pk_bf16_f32 v155, v158, v159
M v[192:195], a[100:103], a[172:175], v[192:195]
ds_read_b128 a[184:187], v10 offset:55296
ds_read_b128 a[188:191], v11 offset:55296
M v[196:199], a[108:111], a[172:175], v[196:199]
M v[196:199], a[104:107], a[168:171], v[196:199]
s_add_u32 s94, s92, 4096
buffer_store_dwordx4 v[88:91], v1, s[16:19], s94 offen offset:3072 sc1
v_pk_mul_f32 v[160:161], v[160:161], s[4:5]
v_pk_mul_f32 v[162:163], v[162:163], s[4:5]
v_pk_mul_f32 v[164:165], v[164:165], s[4:5]
M v[200:203], a[112:115], a[168:171], v[200:203]
buffer_load_dwordx4 v9, s[12:15], s25 offen offset:3072 lds
v_pk_mul_f32 v[166:167], v[166:167], s[4:5]
v_cvt_pk_bf16_f32 v160, v160, v161
M v[200:203], a[116:119], a[172:175], v[200:203]
v_cvt_pk_bf16_f32 v161, v162, v163
v_cvt_pk_bf16_f32 v162, v164, v165
M v[204:207], a[124:127], a[172:175], v[204:207]
v_cvt_pk_bf16_f32 v163, v166, v167
v_pk_mul_f32 v[168:169], v[168:169], s[4:5]
v_pk_mul_f32 v[170:171], v[170:171], s[4:5]
M v[204:207], a[120:123], a[168:171], v[204:207]
v_pk_mul_f32 v[172:173], v[172:173], s[4:5]
v_pk_mul_f32 v[174:175], v[174:175], s[4:5]
M v[208:211], a[128:131], a[168:171], v[208:211]
s_add_u32 m0, s30, 102400
s_nop 0
buffer_load_dwordx4 v21, s[12:15], s25 offen offset:0 lds
v_cvt_pk_bf16_f32 v168, v168, v169
v_cvt_pk_bf16_f32 v169, v170, v171
M v[208:211], a[132:135], a[172:175], v[208:211]
v_cvt_pk_bf16_f32 v170, v172, v173
v_cvt_pk_bf16_f32 v171, v174, v175
M v[212:215], a[140:143], a[172:175], v[212:215]
s_add_u32 s94, s92, 8192
buffer_store_dwordx4 v[96:99], v1, s[16:19], s94 offen offset:0 sc1
v_pk_mul_f32 v[176:177], v[176:177], s[4:5]
v_pk_mul_f32 v[178:179], v[178:179], s[4:5]
v_pk_mul_f32 v[180:181], v[180:181], s[4:5]
M v[212:215], a[136:139], a[168:171], v[212:215]
v_pk_mul_f32 v[182:183], v[182:183], s[4:5]
v_cvt_pk_bf16_f32 v176, v176, v177
M v[216:219], a[144:147], a[168:171], v[216:219]
buffer_load_dwordx4 v22, s[12:15], s25 offen offset:1024 lds
v_cvt_pk_bf16_f32 v177, v178, v179
v_cvt_pk_bf16_f32 v178, v180, v181
M v[216:219], a[148:151], a[172:175], v[216:219]
v_cvt_pk_bf16_f32 v179, v182, v183
v_pk_mul_f32 v[184:185], v[184:185], s[4:5]
v_pk_mul_f32 v[186:187], v[186:187], s[4:5]
M v[220:223], a[156:159], a[172:175], v[220:223]
v_pk_mul_f32 v[188:189], v[188:189], s[4:5]
v_pk_mul_f32 v[190:191], v[190:191], s[4:5]
M v[220:223], a[152:155], a[168:171], v[220:223]
s_waitcnt lgkmcnt(2)
v_cvt_pk_bf16_f32 v184, v184, v185
v_cvt_pk_bf16_f32 v185, v186, v187
M v[224:227], a[96:99], a[176:179], v[224:227]
s_add_u32 s94, s92, 8192
buffer_store_dwordx4 v[104:107], v1, s[16:19], s94 offen offset:1024 sc1
v_cvt_pk_bf16_f32 v186, v188, v189
v_cvt_pk_bf16_f32 v187, v190, v191
M v[224:227], a[100:103], a[180:183], v[224:227]
s_sub_u32 s54, s54, 1
s_cmp_eq_u32 s54, 0
s_cselect_b32 s58, s55, s56
s_add_u32 s25, s25, s58
M v[228:231], a[108:111], a[180:183], v[228:231]
M v[228:231], a[104:107], a[176:179], v[228:231]
v_pk_mul_f32 v[192:193], v[192:193], s[4:5]
v_pk_mul_f32 v[194:195], v[194:195], s[4:5]
v_pk_mul_f32 v[196:197], v[196:197], s[4:5]
M v[232:235], a[112:115], a[176:179], v[232:235]
v_pk_mul_f32 v[198:199], v[198:199], s[4:5]
v_cvt_pk_bf16_f32 v192, v192, v193
M v[232:235], a[116:119], a[180:183], v[232:235]
v_cvt_pk_bf16_f32 v193, v194, v195
v_cvt_pk_bf16_f32 v194, v196, v197
M v[236:239], a[124:127], a[180:183], v[236:239]
v_cvt_pk_bf16_f32 v195, v198, v199
v_pk_mul_f32 v[200:201], v[200:201], s[4:5]
v_pk_mul_f32 v[202:203], v[202:203], s[4:5]
M v[236:239], a[120:123], a[176:179], v[236:239]
s_waitcnt vmcnt(63) lgkmcnt(0)
s_barrier
v_pk_mul_f32 v[204:205], v[204:205], s[4:5]
v_pk_mul_f32 v[206:207], v[206:207], s[4:5]
M v[240:243], a[128:131], a[176:179], v[240:243]
s_add_u32 s94, s92, 8192
buffer_store_dwordx4 v[112:115], v1, s[16:19], s94 offen offset:2048 sc1
v_cvt_pk_bf16_f32 v200, v200, v201
v_cvt_pk_bf16_f32 v201, v202, v203
M v[240:243], a[132:135], a[180:183], v[240:243]
s_add_u32 m0, s28, 18432
s_nop 0
buffer_load_dword v20, s[8:11], s24 offen lds
v_cvt_pk_bf16_f32 v202, v204, v205
v_cvt_pk_bf16_f32 v203, v206, v207
M v[244:247], a[140:143], a[180:183], v[244:247]
v_pk_mul_f32 v[208:209], v[208:209], s[4:5]
v_pk_mul_f32 v[210:211], v[210:211], s[4:5]
v_pk_mul_f32 v[212:213], v[212:213], s[4:5]
M v[244:247], a[136:139], a[176:179], v[244:247]
v_pk_mul_f32 v[214:215], v[214:215], s[4:5]
v_cvt_pk_bf16_f32 v208, v208, v209
M v[248:251], a[144:147], a[176:179], v[248:251]
buffer_load_dword v23, s[8:11], s24 offen offset:256 lds
v_cvt_pk_bf16_f32 v209, v210, v211
v_cvt_pk_bf16_f32 v210, v212, v213
M v[248:251], a[148:151], a[180:183], v[248:251]
v_cvt_pk_bf16_f32 v211, v214, v215
v_pk_mul_f32 v[216:217], v[216:217], s[4:5]
v_pk_mul_f32 v[218:219], v[218:219], s[4:5]
M v[252:255], a[156:159], a[180:183], v[252:255]
s_add_u32 s94, s92, 8192
buffer_store_dwordx4 v[120:123], v1, s[16:19], s94 offen offset:3072 sc1
v_pk_mul_f32 v[220:221], v[220:221], s[4:5]
v_pk_mul_f32 v[222:223], v[222:223], s[4:5]
M v[252:255], a[152:155], a[176:179], v[252:255]
v_cvt_pk_bf16_f32 v216, v216, v217
v_cvt_pk_bf16_f32 v217, v218, v219
M a[0:3], a[96:99], a[184:187], a[0:3]
v_cvt_pk_bf16_f32 v218, v220, v221
v_cvt_pk_bf16_f32 v219, v222, v223
M a[0:3], a[100:103], a[188:191], a[0:3]
s_add_u32 m0, s29, 20480
s_nop 0
buffer_load_dwordx4 v2, s[8:11], s23 offen offset:0 lds
M a[4:7], a[108:111], a[188:191], a[4:7]
M a[4:7], a[104:107], a[184:187], a[4:7]
v_pk_mul_f32 v[224:225], v[224:225], s[4:5]
v_pk_mul_f32 v[226:227], v[226:227], s[4:5]
v_pk_mul_f32 v[228:229], v[228:229], s[4:5]
M a[8:11], a[112:115], a[184:187], a[8:11]
buffer_load_dwordx4 v3, s[8:11], s23 offen offset:1024 lds
v_pk_mul_f32 v[230:231], v[230:231], s[4:5]
v_cvt_pk_bf16_f32 v224, v224, v225
M a[8:11], a[116:119], a[188:191], a[8:11]
s_add_u32 s94, s92, 12288
buffer_store_dwordx4 v[128:131], v1, s[16:19], s94 offen offset:0 sc1
v_cvt_pk_bf16_f32 v225, v226, v227
v_cvt_pk_bf16_f32 v226, v228, v229
M a[12:15], a[124:127], a[188:191], a[12:15]
v_cvt_pk_bf16_f32 v227, v230, v231
v_pk_mul_f32 v[232:233], v[232:233], s[4:5]
v_pk_mul_f32 v[234:235], v[234:235], s[4:5]
M a[12:15], a[120:123], a[184:187], a[12:15]
v_pk_mul_f32 v[236:237], v[236:237], s[4:5]
v_pk_mul_f32 v[238:239], v[238:239], s[4:5]
M a[16:19], a[128:131], a[184:187], a[16:19]
buffer_load_dwordx4 v4, s[8:11], s23 offen offset:2048 lds
v_cvt_pk_bf16_f32 v232, v232, v233
v_cvt_pk_bf16_f32 v233, v234, v235
M a[16:19], a[132:135], a[188:191], a[16:19]
v_cvt_pk_bf16_f32 v234, v236, v237
v_cvt_pk_bf16_f32 v235, v238, v239
M a[20:23], a[140:143], a[188:191], a[20:23]
v_pk_mul_f32 v[240:241], v[240:241], s[4:5]
v_pk_mul_f32 v[242:243], v[242:243], s[4:5]
v_pk_mul_f32 v[244:245], v[244:245], s[4:5]
M a[20:23], a[136:139], a[184:187], a[20:23]
buffer_load_dwordx4 v5, s[8:11], s23 offen offset:3072 lds
v_pk_mul_f32 v[246:247], v[246:247], s[4:5]
v_cvt_pk_bf16_f32 v240, v240, v241
M a[24:27], a[144:147], a[184:187], a[24:27]
s_add_u32 s94, s92, 12288
buffer_store_dwordx4 v[136:139], v1, s[16:19], s94 offen offset:1024 sc1
v_cvt_pk_bf16_f32 v241, v242, v243
v_cvt_pk_bf16_f32 v242, v244, v245
M a[24:27], a[148:151], a[188:191], a[24:27]
v_cvt_pk_bf16_f32 v243, v246, v247
v_pk_mul_f32 v[248:249], v[248:249], s[4:5]
v_pk_mul_f32 v[250:251], v[250:251], s[4:5]
M a[28:31], a[156:159], a[188:191], a[28:31]
v_pk_mul_f32 v[252:253], v[252:253], s[4:5]
v_pk_mul_f32 v[254:255], v[254:255], s[4:5]
M a[28:31], a[152:155], a[184:187], a[28:31]
v_cvt_pk_bf16_f32 v248, v248, v249
v_cvt_pk_bf16_f32 v249, v250, v251
v_cvt_pk_bf16_f32 v250, v252, v253
v_cvt_pk_bf16_f32 v251, v254, v255
v_accvgpr_read_b32 v24, a0
v_accvgpr_read_b32 v25, a1
v_accvgpr_read_b32 v26, a2
v_accvgpr_read_b32 v27, a3
v_accvgpr_read_b32 v28, a4
v_accvgpr_read_b32 v29, a5
v_accvgpr_read_b32 v30, a6
v_accvgpr_read_b32 v31, a7
v_pk_mul_f32 v[24:25], v[24:25], s[4:5]
v_pk_mul_f32 v[26:27], v[26:27], s[4:5]
v_pk_mul_f32 v[28:29], v[28:29], s[4:5]
v_pk_mul_f32 v[30:31], v[30:31], s[4:5]
v_cvt_pk_bf16_f32 v36, v24, v25
v_cvt_pk_bf16_f32 v37, v26, v27
v_cvt_pk_bf16_f32 v38, v28, v29
v_cvt_pk_bf16_f32 v39, v30, v31
v_accvgpr_read_b32 v24, a8
v_accvgpr_read_b32 v25, a9
v_accvgpr_read_b32 v26, a10
v_accvgpr_read_b32 v27, a11
v_accvgpr_read_b32 v28, a12
v_accvgpr_read_b32 v29, a13
v_accvgpr_read_b32 v30, a14
v_accvgpr_read_b32 v31, a15
v_pk_mul_f32 v[24:25], v[24:25], s[4:5]
v_pk_mul_f32 v[26:27], v[26:27], s[4:5]
v_pk_mul_f32 v[28:29], v[28:29], s[4:5]
v_pk_mul_f32 v[30:31], v[30:31], s[4:5]
v_cvt_pk_bf16_f32 v44, v24, v25
v_cvt_pk_bf16_f32 v45, v26, v27
v_cvt_pk_bf16_f32 v46, v28, v29
v_cvt_pk_bf16_f32 v47, v30, v31
v_accvgpr_read_b32 v24, a16
v_accvgpr_read_b32 v25, a17
v_accvgpr_read_b32 v26, a18
v_accvgpr_read_b32 v27, a19
v_accvgpr_read_b32 v28, a20
v_accvgpr_read_b32 v29, a21
v_accvgpr_read_b32 v30, a22
v_accvgpr_read_b32 v31, a23
v_pk_mul_f32 v[24:25], v[24:25], s[4:5]
v_pk_mul_f32 v[26:27], v[26:27], s[4:5]
v_pk_mul_f32 v[28:29], v[28:29], s[4:5]
v_pk_mul_f32 v[30:31], v[30:31], s[4:5]
v_cvt_pk_bf16_f32 v52, v24, v25
v_cvt_pk_bf16_f32 v53, v26, v27
v_cvt_pk_bf16_f32 v54, v28, v29
v_cvt_pk_bf16_f32 v55, v30, v31
v_accvgpr_read_b32 v24, a24
v_accvgpr_read_b32 v25, a25
v_accvgpr_read_b32 v26, a26
v_accvgpr_read_b32 v27, a27
v_accvgpr_read_b32 v28, a28
v_accvgpr_read_b32 v29, a29
v_accvgpr_read_b32 v30, a30
v_accvgpr_read_b32 v31, a31
v_pk_mul_f32 v[24:25], v[24:25], s[4:5]
v_pk_mul_f32 v[26:27], v[26:27], s[4:5]
v_pk_mul_f32 v[28:29], v[28:29], s[4:5]
v_pk_mul_f32 v[30:31], v[30:31], s[4:5]
v_cvt_pk_bf16_f32 v60, v24, v25
v_cvt_pk_bf16_f32 v61, v26, v27
v_cvt_pk_bf16_f32 v62, v28, v29
v_cvt_pk_bf16_f32 v63, v30, v31
s_branch Lk1_b
Lk1_spin:
s_add_u32 s40, s40, 1
s_cmp_gt_u32 s40, 1048576
s_cbranch_scc1 Lk1_got
s_sleep 2
buffer_load_dword v126, v119, s[36:39], 0 offen offset:128 sc1
s_waitcnt vmcnt(0)
v_cmp_gt_u32 vcc, 0x80, v126
s_nop 0
s_cbranch_vccnz Lk1_spin
s_branch Lk1_got
Lk1_spinq:
s_add_u32 s40, s40, 1
s_cmp_gt_u32 s40, 1048576
s_cbranch_scc1 Lk1_gotq
s_sleep 2
buffer_load_dword v125, v119, s[36:39], 0 offen offset:0 sc1
s_waitcnt vmcnt(0)
v_cmp_gt_u32 vcc, 0x80, v125
s_nop 0
s_cbranch_vccnz Lk1_spinq
s_branch Lk1_gotq
Lk1_kv:
M v[32:35], a[32:35], a[160:163], 0
s_add_u32 s23, s23, 128
s_cmp_eq_u32 s23, s25
s_cselect_b32 s23, s26, s23
M v[32:35], a[36:39], a[164:167], v[32:35]
ds_read_b128 a[176:179], v10 offset:4096
ds_read_b128 a[180:183], v11 offset:4096
M v[36:39], a[44:47], a[164:167], 0
M v[36:39], a[40:43], a[160:163], v[36:39]
ds_read_b64_tr_b16 a[96:97], v12 offset:32768
ds_read_b64_tr_b16 a[98:99], v12 offset:34816
M v[40:43], a[48:51], a[160:163], 0
M v[40:43], a[52:55], a[164:167], v[40:43]
M v[44:47], a[60:63], a[164:167], 0
s_add_u32 m0, s29, 81920
s_nop 0
buffer_load_dwordx4 v6, s[12:15], s24 offen offset:0 lds
M v[44:47], a[56:59], a[160:163], v[44:47]
ds_read_b64_tr_b16 a[104:105], v13 offset:32768
ds_read_b64_tr_b16 a[106:107], v13 offset:34816
M v[48:51], a[64:67], a[160:163], 0
M v[48:51], a[68:71], a[164:167], v[48:51]
M v[52:55], a[76:79], a[164:167], 0
M v[52:55], a[72:75], a[160:163], v[52:55]
ds_read_b64_tr_b16 a[112:113], v14 offset:32768
ds_read_b64_tr_b16 a[114:115], v14 offset:34816
M v[56:59], a[80:83], a[160:163], 0
M v[56:59], a[84:87], a[164:167], v[56:59]
buffer_load_dwordx4 v7, s[12:15], s24 offen offset:1024 lds
M v[60:63], a[92:95], a[164:167], 0
M v[60:63], a[88:91], a[160:163], v[60:63]
ds_read_b64_tr_b16 a[120:121], v15 offset:32768
ds_read_b64_tr_b16 a[122:123], v15 offset:34816
M v[64:67], a[32:35], a[168:171], 0
M v[64:67], a[36:39], a[172:175], v[64:67]
ds_read_b128 a[184:187], v10 offset:6144
ds_read_b128 a[188:191], v11 offset:6144
M v[68:71], a[44:47], a[172:175], 0
M v[68:71], a[40:43], a[168:171], v[68:71]
ds_read_b64_tr_b16 a[128:129], v16 offset:32768
ds_read_b64_tr_b16 a[130:131], v16 offset:34816
M v[72:75], a[48:51], a[168:171], 0
buffer_load_dwordx4 v8, s[12:15], s24 offen offset:2048 lds
M v[72:75], a[52:55], a[172:175], v[72:75]
M v[76:79], a[60:63], a[172:175], 0
M v[76:79], a[56:59], a[168:171], v[76:79]
ds_read_b64_tr_b16 a[136:137], v17 offset:32768
ds_read_b64_tr_b16 a[138:139], v17 offset:34816
M v[80:83], a[64:67], a[168:171], 0
M v[80:83], a[68:71], a[172:175], v[80:83]
M v[84:87], a[76:79], a[172:175], 0
buffer_load_dwordx4 v9, s[12:15], s24 offen offset:3072 lds
M v[84:87], a[72:75], a[168:171], v[84:87]
ds_read_b64_tr_b16 a[144:145], v18 offset:32768
ds_read_b64_tr_b16 a[146:147], v18 offset:34816
M v[88:91], a[80:83], a[168:171], 0
M v[88:91], a[84:87], a[172:175], v[88:91]
M v[92:95], a[92:95], a[172:175], 0
M v[92:95], a[88:91], a[168:171], v[92:95]
s_waitcnt lgkmcnt(15)
ds_read_b64_tr_b16 a[152:153], v19 offset:32768
ds_read_b64_tr_b16 a[154:155], v19 offset:34816
M v[96:99], a[32:35], a[176:179], 0
s_add_u32 s24, s24, 262144
s_cmp_eq_u32 s24, s27
s_cselect_b32 s24, s28, s24
s_sub_u32 s6, s6, 1
s_cmp_eq_u32 s6, 0
s_cselect_b64 s[12:13], s[64:65], s[12:13]
M v[96:99], a[36:39], a[180:183], v[96:99]
M v[100:103], a[44:47], a[180:183], 0
M v[100:103], a[40:43], a[176:179], v[100:103]
M v[104:107], a[48:51], a[176:179], 0
M v[104:107], a[52:55], a[180:183], v[104:107]
M v[108:111], a[60:63], a[180:183], 0
M v[108:111], a[56:59], a[176:179], v[108:111]
s_waitcnt vmcnt(21) lgkmcnt(0)
s_barrier
ds_read_b128 a[160:163], v10 offset:16384
ds_read_b128 a[164:167], v11 offset:16384
M v[112:115], a[64:67], a[176:179], 0
s_add_u32 m0, s29, 0
s_nop 0
buffer_load_dwordx4 v2, s[8:11], s23 offen offset:0 lds
M v[112:115], a[68:71], a[180:183], v[112:115]
M v[116:119], a[76:79], a[180:183], 0
M v[116:119], a[72:75], a[176:179], v[116:119]
ds_read_b64_tr_b16 a[100:101], v12 offset:49152
ds_read_b64_tr_b16 a[102:103], v12 offset:51200
M v[120:123], a[80:83], a[176:179], 0
M v[120:123], a[84:87], a[180:183], v[120:123]
M v[124:127], a[92:95], a[180:183], 0
buffer_load_dwordx4 v3, s[8:11], s23 offen offset:1024 lds
M v[124:127], a[88:91], a[176:179], v[124:127]
M v[128:131], a[32:35], a[184:187], 0
M v[128:131], a[36:39], a[188:191], v[128:131]
ds_read_b128 a[168:171], v10 offset:18432
ds_read_b128 a[172:175], v11 offset:18432
ds_read_b64_tr_b16 a[108:109], v13 offset:49152
ds_read_b64_tr_b16 a[110:111], v13 offset:51200
M v[132:135], a[44:47], a[188:191], 0
M v[132:135], a[40:43], a[184:187], v[132:135]
M v[136:139], a[48:51], a[184:187], 0
M v[136:139], a[52:55], a[188:191], v[136:139]
buffer_load_dwordx4 v4, s[8:11], s23 offen offset:2048 lds
M v[140:143], a[60:63], a[188:191], 0
M v[140:143], a[56:59], a[184:187], v[140:143]
ds_read_b64_tr_b16 a[116:117], v14 offset:49152
ds_read_b64_tr_b16 a[118:119], v14 offset:51200
M v[144:147], a[64:67], a[184:187], 0
M v[144:147], a[68:71], a[188:191], v[144:147]
M v[148:151], a[76:79], a[188:191], 0
M v[148:151], a[72:75], a[184:187], v[148:151]
M v[152:155], a[80:83], a[184:187], 0
buffer_load_dwordx4 v5, s[8:11], s23 offen offset:3072 lds
M v[152:155], a[84:87], a[188:191], v[152:155]
ds_read_b64_tr_b16 a[124:125], v15 offset:49152
ds_read_b64_tr_b16 a[126:127], v15 offset:51200
M v[156:159], a[92:95], a[188:191], 0
M v[156:159], a[88:91], a[184:187], v[156:159]
s_waitcnt lgkmcnt(10)
M v[160:163], a[32:35], a[160:163], 0
M v[160:163], a[36:39], a[164:167], v[160:163]
ds_read_b128 a[176:179], v10 offset:20480
ds_read_b128 a[180:183], v11 offset:20480
M v[164:167], a[44:47], a[164:167], 0
M v[164:167], a[40:43], a[160:163], v[164:167]
ds_read_b64_tr_b16 a[132:133], v16 offset:49152
ds_read_b64_tr_b16 a[134:135], v16 offset:51200
M v[168:171], a[48:51], a[160:163], 0
M v[168:171], a[52:55], a[164:167], v[168:171]
s_add_u32 m0, s29, 98304
s_nop 0
buffer_load_dwordx4 v6, s[12:15], s24 offen offset:0 lds
M v[172:175], a[60:63], a[164:167], 0
M v[172:175], a[56:59], a[160:163], v[172:175]
M v[176:179], a[64:67], a[160:163], 0
M v[176:179], a[68:71], a[164:167], v[176:179]
ds_read_b64_tr_b16 a[140:141], v17 offset:49152
ds_read_b64_tr_b16 a[142:143], v17 offset:51200
M v[180:183], a[76:79], a[164:167], 0
M v[180:183], a[72:75], a[160:163], v[180:183]
buffer_load_dwordx4 v7, s[12:15], s24 offen offset:1024 lds
M v[184:187], a[80:83], a[160:163], 0
M v[184:187], a[84:87], a[164:167], v[184:187]
M v[188:191], a[92:95], a[164:167], 0
M v[188:191], a[88:91], a[160:163], v[188:191]
s_waitcnt lgkmcnt(12)
ds_read_b64_tr_b16 a[148:149], v18 offset:49152
ds_read_b64_tr_b16 a[150:151], v18 offset:51200
M v[192:195], a[32:35], a[168:171], 0
M v[192:195], a[36:39], a[172:175], v[192:195]
ds_read_b128 a[184:187], v10 offset:22528
ds_read_b128 a[188:191], v11 offset:22528
M v[196:199], a[44:47], a[172:175], 0
M v[196:199], a[40:43], a[168:171], v[196:199]
buffer_load_dwordx4 v8, s[12:15], s24 offen offset:2048 lds
M v[200:203], a[48:51], a[168:171], 0
M v[200:203], a[52:55], a[172:175], v[200:203]
ds_read_b64_tr_b16 a[156:157], v19 offset:49152
ds_read_b64_tr_b16 a[158:159], v19 offset:51200
M v[204:207], a[60:63], a[172:175], 0
M v[204:207], a[56:59], a[168:171], v[204:207]
M v[208:211], a[64:67], a[168:171], 0
M v[208:211], a[68:71], a[172:175], v[208:211]
buffer_load_dwordx4 v9, s[12:15], s24 offen offset:3072 lds
M v[212:215], a[76:79], a[172:175], 0
M v[212:215], a[72:75], a[168:171], v[212:215]
M v[216:219], a[80:83], a[168:171], 0
M v[216:219], a[84:87], a[172:175], v[216:219]
M v[220:223], a[92:95], a[172:175], 0
s_add_u32 s24, s24, 262144
M v[220:223], a[88:91], a[168:171], v[220:223]
s_waitcnt lgkmcnt(10)
M v[224:227], a[32:35], a[176:179], 0
M v[224:227], a[36:39], a[180:183], v[224:227]
M v[228:231], a[44:47], a[180:183], 0
M v[228:231], a[40:43], a[176:179], v[228:231]
M v[232:235], a[48:51], a[176:179], 0
M v[232:235], a[52:55], a[180:183], v[232:235]
M v[236:239], a[60:63], a[180:183], 0
M v[236:239], a[56:59], a[176:179], v[236:239]
s_waitcnt vmcnt(16) lgkmcnt(0)
s_barrier
ds_read_b128 a[160:163], v10 offset:32768
ds_read_b128 a[164:167], v11 offset:32768
M v[240:243], a[64:67], a[176:179], 0
s_add_u32 m0, s29, 16384
s_add_u32 s3, s23, s31
buffer_load_dwordx4 v2, s[8:11], s3 offen offset:0 lds
M v[240:243], a[68:71], a[180:183], v[240:243]
M v[244:247], a[76:79], a[180:183], 0
M v[244:247], a[72:75], a[176:179], v[244:247]
M v[248:251], a[80:83], a[176:179], 0
M v[248:251], a[84:87], a[180:183], v[248:251]
buffer_load_dwordx4 v3, s[8:11], s3 offen offset:1024 lds
M v[252:255], a[92:95], a[180:183], 0
M v[252:255], a[88:91], a[176:179], v[252:255]
M a[0:3], a[32:35], a[184:187], 0
M a[0:3], a[36:39], a[188:191], a[0:3]
ds_read_b128 a[168:171], v10 offset:34816
ds_read_b128 a[172:175], v11 offset:34816
M a[4:7], a[44:47], a[188:191], 0
M a[4:7], a[40:43], a[184:187], a[4:7]
M a[8:11], a[48:51], a[184:187], 0
buffer_load_dwordx4 v4, s[8:11], s3 offen offset:2048 lds
M a[8:11], a[52:55], a[188:191], a[8:11]
M a[12:15], a[60:63], a[188:191], 0
M a[12:15], a[56:59], a[184:187], a[12:15]
M a[16:19], a[64:67], a[184:187], 0
M a[16:19], a[68:71], a[188:191], a[16:19]
buffer_load_dwordx4 v5, s[8:11], s3 offen offset:3072 lds
M a[20:23], a[76:79], a[188:191], 0
M a[20:23], a[72:75], a[184:187], a[20:23]
M a[24:27], a[80:83], a[184:187], 0
M a[24:27], a[84:87], a[188:191], a[24:27]
M a[28:31], a[92:95], a[188:191], 0
M a[28:31], a[88:91], a[184:187], a[28:31]
s_waitcnt lgkmcnt(2)
M v[32:35], a[96:99], a[160:163], v[32:35]
s_add_u32 s23, s23, 128
s_cmp_eq_u32 s23, s25
s_cselect_b32 s23, s26, s23
M v[32:35], a[100:103], a[164:167], v[32:35]
ds_read_b128 a[176:179], v10 offset:36864
ds_read_b128 a[180:183], v11 offset:36864
M v[36:39], a[108:111], a[164:167], v[36:39]
M v[36:39], a[104:107], a[160:163], v[36:39]
ds_read_b64_tr_b16 a[32:33], v12 offset:0
ds_read_b64_tr_b16 a[34:35], v12 offset:2048
M v[40:43], a[112:115], a[160:163], v[40:43]
M v[40:43], a[116:119], a[164:167], v[40:43]
M v[44:47], a[124:127], a[164:167], v[44:47]
s_add_u32 m0, s29, 114688
s_nop 0
buffer_load_dwordx4 v6, s[12:15], s24 offen offset:0 lds
M v[44:47], a[120:123], a[160:163], v[44:47]
ds_read_b64_tr_b16 a[40:41], v13 offset:0
ds_read_b64_tr_b16 a[42:43], v13 offset:2048
M v[48:51], a[128:131], a[160:163], v[48:51]
M v[48:51], a[132:135], a[164:167], v[48:51]
M v[52:55], a[140:143], a[164:167], v[52:55]
M v[52:55], a[136:139], a[160:163], v[52:55]
ds_read_b64_tr_b16 a[48:49], v14 offset:0
ds_read_b64_tr_b16 a[50:51], v14 offset:2048
M v[56:59], a[144:147], a[160:163], v[56:59]
M v[56:59], a[148:151], a[164:167], v[56:59]
buffer_load_dwordx4 v7, s[12:15], s24 offen offset:1024 lds
M v[60:63], a[156:159], a[164:167], v[60:63]
M v[60:63], a[152:155], a[160:163], v[60:63]
s_waitcnt lgkmcnt(8)
ds_read_b64_tr_b16 a[56:57], v15 offset:0
ds_read_b64_tr_b16 a[58:59], v15 offset:2048
M v[64:67], a[96:99], a[168:171], v[64:67]
M v[64:67], a[100:103], a[172:175], v[64:67]
ds_read_b128 a[184:187], v10 offset:38912
ds_read_b128 a[188:191], v11 offset:38912
M v[68:71], a[108:111], a[172:175], v[68:71]
M v[68:71], a[104:107], a[168:171], v[68:71]
ds_read_b64_tr_b16 a[64:65], v16 offset:0
ds_read_b64_tr_b16 a[66:67], v16 offset:2048
M v[72:75], a[112:115], a[168:171], v[72:75]
buffer_load_dwordx4 v8, s[12:15], s24 offen offset:2048 lds
M v[72:75], a[116:119], a[172:175], v[72:75]
M v[76:79], a[124:127], a[172:175], v[76:79]
M v[76:79], a[120:123], a[168:171], v[76:79]
ds_read_b64_tr_b16 a[72:73], v17 offset:0
ds_read_b64_tr_b16 a[74:75], v17 offset:2048
M v[80:83], a[128:131], a[168:171], v[80:83]
M v[80:83], a[132:135], a[172:175], v[80:83]
M v[84:87], a[140:143], a[172:175], v[84:87]
buffer_load_dwordx4 v9, s[12:15], s24 offen offset:3072 lds
M v[84:87], a[136:139], a[168:171], v[84:87]
ds_read_b64_tr_b16 a[80:81], v18 offset:0
ds_read_b64_tr_b16 a[82:83], v18 offset:2048
M v[88:91], a[144:147], a[168:171], v[88:91]
M v[88:91], a[148:151], a[172:175], v[88:91]
M v[92:95], a[156:159], a[172:175], v[92:95]
M v[92:95], a[152:155], a[168:171], v[92:95]
s_waitcnt lgkmcnt(15)
ds_read_b64_tr_b16 a[88:89], v19 offset:0
ds_read_b64_tr_b16 a[90:91], v19 offset:2048
M v[96:99], a[96:99], a[176:179], v[96:99]
s_add_u32 s24, s24, 262144
s_cmp_eq_u32 s24, s27
s_cselect_b32 s24, s28, s24
s_sub_u32 s6, s6, 1
s_cmp_eq_u32 s6, 0
s_cselect_b64 s[12:13], s[64:65], s[12:13]
M v[96:99], a[100:103], a[180:183], v[96:99]
M v[100:103], a[108:111], a[180:183], v[100:103]
M v[100:103], a[104:107], a[176:179], v[100:103]
M v[104:107], a[112:115], a[176:179], v[104:107]
M v[104:107], a[116:119], a[180:183], v[104:107]
M v[108:111], a[124:127], a[180:183], v[108:111]
M v[108:111], a[120:123], a[176:179], v[108:111]
s_waitcnt vmcnt(16) lgkmcnt(0)
s_barrier
ds_read_b128 a[160:163], v10 offset:49152
ds_read_b128 a[164:167], v11 offset:49152
M v[112:115], a[128:131], a[176:179], v[112:115]
s_add_u32 m0, s29, 32768
s_nop 0
buffer_load_dwordx4 v2, s[8:11], s23 offen offset:0 lds
M v[112:115], a[132:135], a[180:183], v[112:115]
M v[116:119], a[140:143], a[180:183], v[116:119]
M v[116:119], a[136:139], a[176:179], v[116:119]
ds_read_b64_tr_b16 a[36:37], v12 offset:16384
ds_read_b64_tr_b16 a[38:39], v12 offset:18432
M v[120:123], a[144:147], a[176:179], v[120:123]
M v[120:123], a[148:151], a[180:183], v[120:123]
M v[124:127], a[156:159], a[180:183], v[124:127]
buffer_load_dwordx4 v3, s[8:11], s23 offen offset:1024 lds
M v[124:127], a[152:155], a[176:179], v[124:127]
M v[128:131], a[96:99], a[184:187], v[128:131]
M v[128:131], a[100:103], a[188:191], v[128:131]
ds_read_b128 a[168:171], v10 offset:51200
ds_read_b128 a[172:175], v11 offset:51200
ds_read_b64_tr_b16 a[44:45], v13 offset:16384
ds_read_b64_tr_b16 a[46:47], v13 offset:18432
M v[132:135], a[108:111], a[188:191], v[132:135]
M v[132:135], a[104:107], a[184:187], v[132:135]
M v[136:139], a[112:115], a[184:187], v[136:139]
M v[136:139], a[116:119], a[188:191], v[136:139]
buffer_load_dwordx4 v4, s[8:11], s23 offen offset:2048 lds
M v[140:143], a[124:127], a[188:191], v[140:143]
M v[140:143], a[120:123], a[184:187], v[140:143]
ds_read_b64_tr_b16 a[52:53], v14 offset:16384
ds_read_b64_tr_b16 a[54:55], v14 offset:18432
M v[144:147], a[128:131], a[184:187], v[144:147]
M v[144:147], a[132:135], a[188:191], v[144:147]
M v[148:151], a[140:143], a[188:191], v[148:151]
M v[148:151], a[136:139], a[184:187], v[148:151]
M v[152:155], a[144:147], a[184:187], v[152:155]
buffer_load_dwordx4 v5, s[8:11], s23 offen offset:3072 lds
M v[152:155], a[148:151], a[188:191], v[152:155]
ds_read_b64_tr_b16 a[60:61], v15 offset:16384
ds_read_b64_tr_b16 a[62:63], v15 offset:18432
M v[156:159], a[156:159], a[188:191], v[156:159]
M v[156:159], a[152:155], a[184:187], v[156:159]
s_waitcnt lgkmcnt(10)
M v[160:163], a[96:99], a[160:163], v[160:163]
M v[160:163], a[100:103], a[164:167], v[160:163]
ds_read_b128 a[176:179], v10 offset:53248
ds_read_b128 a[180:183], v11 offset:53248
M v[164:167], a[108:111], a[164:167], v[164:167]
M v[164:167], a[104:107], a[160:163], v[164:167]
ds_read_b64_tr_b16 a[68:69], v16 offset:16384
ds_read_b64_tr_b16 a[70:71], v16 offset:18432
M v[168:171], a[112:115], a[160:163], v[168:171]
M v[168:171], a[116:119], a[164:167], v[168:171]
s_add_u32 m0, s29, 65536
s_nop 0
buffer_load_dwordx4 v6, s[12:15], s24 offen offset:0 lds
M v[172:175], a[124:127], a[164:167], v[172:175]
M v[172:175], a[120:123], a[160:163], v[172:175]
M v[176:179], a[128:131], a[160:163], v[176:179]
M v[176:179], a[132:135], a[164:167], v[176:179]
ds_read_b64_tr_b16 a[76:77], v17 offset:16384
ds_read_b64_tr_b16 a[78:79], v17 offset:18432
M v[180:183], a[140:143], a[164:167], v[180:183]
M v[180:183], a[136:139], a[160:163], v[180:183]
buffer_load_dwordx4 v7, s[12:15], s24 offen offset:1024 lds
M v[184:187], a[144:147], a[160:163], v[184:187]
M v[184:187], a[148:151], a[164:167], v[184:187]
M v[188:191], a[156:159], a[164:167], v[188:191]
M v[188:191], a[152:155], a[160:163], v[188:191]
s_waitcnt lgkmcnt(12)
ds_read_b64_tr_b16 a[84:85], v18 offset:16384
ds_read_b64_tr_b16 a[86:87], v18 offset:18432
M v[192:195], a[96:99], a[168:171], v[192:195]
M v[192:195], a[100:103], a[172:175], v[192:195]
ds_read_b128 a[184:187], v10 offset:55296
ds_read_b128 a[188:191], v11 offset:55296
M v[196:199], a[108:111], a[172:175], v[196:199]
M v[196:199], a[104:107], a[168:171], v[196:199]
buffer_load_dwordx4 v8, s[12:15], s24 offen offset:2048 lds
M v[200:203], a[112:115], a[168:171], v[200:203]
M v[200:203], a[116:119], a[172:175], v[200:203]
ds_read_b64_tr_b16 a[92:93], v19 offset:16384
ds_read_b64_tr_b16 a[94:95], v19 offset:18432
M v[204:207], a[124:127], a[172:175], v[204:207]
M v[204:207], a[120:123], a[168:171], v[204:207]
M v[208:211], a[128:131], a[168:171], v[208:211]
M v[208:211], a[132:135], a[172:175], v[208:211]
buffer_load_dwordx4 v9, s[12:15], s24 offen offset:3072 lds
M v[212:215], a[140:143], a[172:175], v[212:215]
M v[212:215], a[136:139], a[168:171], v[212:215]
M v[216:219], a[144:147], a[168:171], v[216:219]
M v[216:219], a[148:151], a[172:175], v[216:219]
M v[220:223], a[156:159], a[172:175], v[220:223]
s_add_u32 s24, s24, 262144
M v[220:223], a[152:155], a[168:171], v[220:223]
s_waitcnt lgkmcnt(10)
M v[224:227], a[96:99], a[176:179], v[224:227]
M v[224:227], a[100:103], a[180:183], v[224:227]
M v[228:231], a[108:111], a[180:183], v[228:231]
M v[228:231], a[104:107], a[176:179], v[228:231]
M v[232:235], a[112:115], a[176:179], v[232:235]
M v[232:235], a[116:119], a[180:183], v[232:235]
M v[236:239], a[124:127], a[180:183], v[236:239]
M v[236:239], a[120:123], a[176:179], v[236:239]
s_waitcnt vmcnt(16) lgkmcnt(0)
s_barrier
ds_read_b128 a[160:163], v10 offset:0
ds_read_b128 a[164:167], v11 offset:0
M v[240:243], a[128:131], a[176:179], v[240:243]
s_add_u32 m0, s29, 49152
s_add_u32 s3, s23, s31
buffer_load_dwordx4 v2, s[8:11], s3 offen offset:0 lds
M v[240:243], a[132:135], a[180:183], v[240:243]
M v[244:247], a[140:143], a[180:183], v[244:247]
M v[244:247], a[136:139], a[176:179], v[244:247]
M v[248:251], a[144:147], a[176:179], v[248:251]
M v[248:251], a[148:151], a[180:183], v[248:251]
buffer_load_dwordx4 v3, s[8:11], s3 offen offset:1024 lds
M v[252:255], a[156:159], a[180:183], v[252:255]
M v[252:255], a[152:155], a[176:179], v[252:255]
M a[0:3], a[96:99], a[184:187], a[0:3]
M a[0:3], a[100:103], a[188:191], a[0:3]
ds_read_b128 a[168:171], v10 offset:2048
ds_read_b128 a[172:175], v11 offset:2048
M a[4:7], a[108:111], a[188:191], a[4:7]
M a[4:7], a[104:107], a[184:187], a[4:7]
M a[8:11], a[112:115], a[184:187], a[8:11]
buffer_load_dwordx4 v4, s[8:11], s3 offen offset:2048 lds
M a[8:11], a[116:119], a[188:191], a[8:11]
M a[12:15], a[124:127], a[188:191], a[12:15]
M a[12:15], a[120:123], a[184:187], a[12:15]
M a[16:19], a[128:131], a[184:187], a[16:19]
M a[16:19], a[132:135], a[188:191], a[16:19]
buffer_load_dwordx4 v5, s[8:11], s3 offen offset:3072 lds
M a[20:23], a[140:143], a[188:191], a[20:23]
M a[20:23], a[136:139], a[184:187], a[20:23]
M a[24:27], a[144:147], a[184:187], a[24:27]
M a[24:27], a[148:151], a[188:191], a[24:27]
M a[28:31], a[156:159], a[188:191], a[28:31]
M a[28:31], a[152:155], a[184:187], a[28:31]
s_waitcnt lgkmcnt(2)
s_mov_b32 s30, 2
Lk1_kl:
M v[32:35], a[32:35], a[160:163], v[32:35]
s_add_u32 s23, s23, 128
s_cmp_eq_u32 s23, s25
s_cselect_b32 s23, s26, s23
M v[32:35], a[36:39], a[164:167], v[32:35]
ds_read_b128 a[176:179], v10 offset:4096
ds_read_b128 a[180:183], v11 offset:4096
M v[36:39], a[44:47], a[164:167], v[36:39]
M v[36:39], a[40:43], a[160:163], v[36:39]
ds_read_b64_tr_b16 a[96:97], v12 offset:32768
ds_read_b64_tr_b16 a[98:99], v12 offset:34816
M v[40:43], a[48:51], a[160:163], v[40:43]
M v[40:43], a[52:55], a[164:167], v[40:43]
M v[44:47], a[60:63], a[164:167], v[44:47]
s_add_u32 m0, s29, 81920
s_nop 0
buffer_load_dwordx4 v6, s[12:15], s24 offen offset:0 lds
M v[44:47], a[56:59], a[160:163], v[44:47]
ds_read_b64_tr_b16 a[104:105], v13 offset:32768
ds_read_b64_tr_b16 a[106:107], v13 offset:34816
M v[48:51], a[64:67], a[160:163], v[48:51]
M v[48:51], a[68:71], a[164:167], v[48:51]
M v[52:55], a[76:79], a[164:167], v[52:55]
M v[52:55], a[72:75], a[160:163], v[52:55]
ds_read_b64_tr_b16 a[112:113], v14 offset:32768
ds_read_b64_tr_b16 a[114:115], v14 offset:34816
M v[56:59], a[80:83], a[160:163], v[56:59]
M v[56:59], a[84:87], a[164:167], v[56:59]
buffer_load_dwordx4 v7, s[12:15], s24 offen offset:1024 lds
M v[60:63], a[92:95], a[164:167], v[60:63]
M v[60:63], a[88:91], a[160:163], v[60:63]
s_waitcnt lgkmcnt(8)
ds_read_b64_tr_b16 a[120:121], v15 offset:32768
ds_read_b64_tr_b16 a[122:123], v15 offset:34816
M v[64:67], a[32:35], a[168:171], v[64:67]
M v[64:67], a[36:39], a[172:175], v[64:67]
ds_read_b128 a[184:187], v10 offset:6144
ds_read_b128 a[188:191], v11 offset:6144
M v[68:71], a[44:47], a[172:175], v[68:71]
M v[68:71], a[40:43], a[168:171], v[68:71]
ds_read_b64_tr_b16 a[128:129], v16 offset:32768
ds_read_b64_tr_b16 a[130:131], v16 offset:34816
M v[72:75], a[48:51], a[168:171], v[72:75]
buffer_load_dwordx4 v8, s[12:15], s24 offen offset:2048 lds
M v[72:75], a[52:55], a[172:175], v[72:75]
M v[76:79], a[60:63], a[172:175], v[76:79]
M v[76:79], a[56:59], a[168:171], v[76:79]
ds_read_b64_tr_b16 a[136:137], v17 offset:32768
ds_read_b64_tr_b16 a[138:139], v17 offset:34816
M v[80:83], a[64:67], a[168:171], v[80:83]
M v[80:83], a[68:71], a[172:175], v[80:83]
M v[84:87], a[76:79], a[172:175], v[84:87]
buffer_load_dwordx4 v9, s[12:15], s24 offen offset:3072 lds
M v[84:87], a[72:75], a[168:171], v[84:87]
ds_read_b64_tr_b16 a[144:145], v18 offset:32768
ds_read_b64_tr_b16 a[146:147], v18 offset:34816
M v[88:91], a[80:83], a[168:171], v[88:91]
M v[88:91], a[84:87], a[172:175], v[88:91]
M v[92:95], a[92:95], a[172:175], v[92:95]
M v[92:95], a[88:91], a[168:171], v[92:95]
s_waitcnt lgkmcnt(15)
ds_read_b64_tr_b16 a[152:153], v19 offset:32768
ds_read_b64_tr_b16 a[154:155], v19 offset:34816
M v[96:99], a[32:35], a[176:179], v[96:99]
s_add_u32 s24, s24, 262144
s_cmp_eq_u32 s24, s27
s_cselect_b32 s24, s28, s24
s_sub_u32 s6, s6, 1
s_cmp_eq_u32 s6, 0
s_cselect_b64 s[12:13], s[64:65], s[12:13]
M v[96:99], a[36:39], a[180:183], v[96:99]
M v[100:103], a[44:47], a[180:183], v[100:103]
M v[100:103], a[40:43], a[176:179], v[100:103]
M v[104:107], a[48:51], a[176:179], v[104:107]
M v[104:107], a[52:55], a[180:183], v[104:107]
M v[108:111], a[60:63], a[180:183], v[108:111]
M v[108:111], a[56:59], a[176:179], v[108:111]
s_waitcnt vmcnt(16) lgkmcnt(0)
s_barrier
ds_read_b128 a[160:163], v10 offset:16384
ds_read_b128 a[164:167], v11 offset:16384
M v[112:115], a[64:67], a[176:179], v[112:115]
s_add_u32 m0, s29, 0
s_nop 0
buffer_load_dwordx4 v2, s[8:11], s23 offen offset:0 lds
M v[112:115], a[68:71], a[180:183], v[112:115]
M v[116:119], a[76:79], a[180:183], v[116:119]
M v[116:119], a[72:75], a[176:179], v[116:119]
ds_read_b64_tr_b16 a[100:101], v12 offset:49152
ds_read_b64_tr_b16 a[102:103], v12 offset:51200
M v[120:123], a[80:83], a[176:179], v[120:123]
M v[120:123], a[84:87], a[180:183], v[120:123]
M v[124:127], a[92:95], a[180:183], v[124:127]
buffer_load_dwordx4 v3, s[8:11], s23 offen offset:1024 lds
M v[124:127], a[88:91], a[176:179], v[124:127]
M v[128:131], a[32:35], a[184:187], v[128:131]
M v[128:131], a[36:39], a[188:191], v[128:131]
ds_read_b128 a[168:171], v10 offset:18432
ds_read_b128 a[172:175], v11 offset:18432
ds_read_b64_tr_b16 a[108:109], v13 offset:49152
ds_read_b64_tr_b16 a[110:111], v13 offset:51200
M v[132:135], a[44:47], a[188:191], v[132:135]
M v[132:135], a[40:43], a[184:187], v[132:135]
M v[136:139], a[48:51], a[184:187], v[136:139]
M v[136:139], a[52:55], a[188:191], v[136:139]
buffer_load_dwordx4 v4, s[8:11], s23 offen offset:2048 lds
M v[140:143], a[60:63], a[188:191], v[140:143]
M v[140:143], a[56:59], a[184:187], v[140:143]
ds_read_b64_tr_b16 a[116:117], v14 offset:49152
ds_read_b64_tr_b16 a[118:119], v14 offset:51200
M v[144:147], a[64:67], a[184:187], v[144:147]
M v[144:147], a[68:71], a[188:191], v[144:147]
M v[148:151], a[76:79], a[188:191], v[148:151]
M v[148:151], a[72:75], a[184:187], v[148:151]
M v[152:155], a[80:83], a[184:187], v[152:155]
buffer_load_dwordx4 v5, s[8:11], s23 offen offset:3072 lds
M v[152:155], a[84:87], a[188:191], v[152:155]
ds_read_b64_tr_b16 a[124:125], v15 offset:49152
ds_read_b64_tr_b16 a[126:127], v15 offset:51200
M v[156:159], a[92:95], a[188:191], v[156:159]
M v[156:159], a[88:91], a[184:187], v[156:159]
s_waitcnt lgkmcnt(10)
M v[160:163], a[32:35], a[160:163], v[160:163]
M v[160:163], a[36:39], a[164:167], v[160:163]
ds_read_b128 a[176:179], v10 offset:20480
ds_read_b128 a[180:183], v11 offset:20480
M v[164:167], a[44:47], a[164:167], v[164:167]
M v[164:167], a[40:43], a[160:163], v[164:167]
ds_read_b64_tr_b16 a[132:133], v16 offset:49152
ds_read_b64_tr_b16 a[134:135], v16 offset:51200
M v[168:171], a[48:51], a[160:163], v[168:171]
M v[168:171], a[52:55], a[164:167], v[168:171]
s_add_u32 m0, s29, 98304
s_nop 0
buffer_load_dwordx4 v6, s[12:15], s24 offen offset:0 lds
M v[172:175], a[60:63], a[164:167], v[172:175]
M v[172:175], a[56:59], a[160:163], v[172:175]
M v[176:179], a[64:67], a[160:163], v[176:179]
M v[176:179], a[68:71], a[164:167], v[176:179]
ds_read_b64_tr_b16 a[140:141], v17 offset:49152
ds_read_b64_tr_b16 a[142:143], v17 offset:51200
M v[180:183], a[76:79], a[164:167], v[180:183]
M v[180:183], a[72:75], a[160:163], v[180:183]
buffer_load_dwordx4 v7, s[12:15], s24 offen offset:1024 lds
M v[184:187], a[80:83], a[160:163], v[184:187]
M v[184:187], a[84:87], a[164:167], v[184:187]
M v[188:191], a[92:95], a[164:167], v[188:191]
M v[188:191], a[88:91], a[160:163], v[188:191]
s_waitcnt lgkmcnt(12)
ds_read_b64_tr_b16 a[148:149], v18 offset:49152
ds_read_b64_tr_b16 a[150:151], v18 offset:51200
M v[192:195], a[32:35], a[168:171], v[192:195]
M v[192:195], a[36:39], a[172:175], v[192:195]
ds_read_b128 a[184:187], v10 offset:22528
ds_read_b128 a[188:191], v11 offset:22528
M v[196:199], a[44:47], a[172:175], v[196:199]
M v[196:199], a[40:43], a[168:171], v[196:199]
buffer_load_dwordx4 v8, s[12:15], s24 offen offset:2048 lds
M v[200:203], a[48:51], a[168:171], v[200:203]
M v[200:203], a[52:55], a[172:175], v[200:203]
ds_read_b64_tr_b16 a[156:157], v19 offset:49152
ds_read_b64_tr_b16 a[158:159], v19 offset:51200
M v[204:207], a[60:63], a[172:175], v[204:207]
M v[204:207], a[56:59], a[168:171], v[204:207]
M v[208:211], a[64:67], a[168:171], v[208:211]
M v[208:211], a[68:71], a[172:175], v[208:211]
buffer_load_dwordx4 v9, s[12:15], s24 offen offset:3072 lds
M v[212:215], a[76:79], a[172:175], v[212:215]
M v[212:215], a[72:75], a[168:171], v[212:215]
M v[216:219], a[80:83], a[168:171], v[216:219]
M v[216:219], a[84:87], a[172:175], v[216:219]
M v[220:223], a[92:95], a[172:175], v[220:223]
s_add_u32 s24, s24, 262144
M v[220:223], a[88:91], a[168:171], v[220:223]
s_waitcnt lgkmcnt(10)
M v[224:227], a[32:35], a[176:179], v[224:227]
M v[224:227], a[36:39], a[180:183], v[224:227]
M v[228:231], a[44:47], a[180:183], v[228:231]
M v[228:231], a[40:43], a[176:179], v[228:231]
M v[232:235], a[48:51], a[176:179], v[232:235]
M v[232:235], a[52:55], a[180:183], v[232:235]
M v[236:239], a[60:63], a[180:183], v[236:239]
M v[236:239], a[56:59], a[176:179], v[236:239]
s_waitcnt vmcnt(16) lgkmcnt(0)
s_barrier
ds_read_b128 a[160:163], v10 offset:32768
ds_read_b128 a[164:167], v11 offset:32768
M v[240:243], a[64:67], a[176:179], v[240:243]
s_add_u32 m0, s29, 16384
s_add_u32 s3, s23, s31
buffer_load_dwordx4 v2, s[8:11], s3 offen offset:0 lds
M v[240:243], a[68:71], a[180:183], v[240:243]
M v[244:247], a[76:79], a[180:183], v[244:247]
M v[244:247], a[72:75], a[176:179], v[244:247]
M v[248:251], a[80:83], a[176:179], v[248:251]
M v[248:251], a[84:87], a[180:183], v[248:251]
buffer_load_dwordx4 v3, s[8:11], s3 offen offset:1024 lds
M v[252:255], a[92:95], a[180:183], v[252:255]
M v[252:255], a[88:91], a[176:179], v[252:255]
M a[0:3], a[32:35], a[184:187], a[0:3]
M a[0:3], a[36:39], a[188:191], a[0:3]
ds_read_b128 a[168:171], v10 offset:34816
ds_read_b128 a[172:175], v11 offset:34816
M a[4:7], a[44:47], a[188:191], a[4:7]
M a[4:7], a[40:43], a[184:187], a[4:7]
M a[8:11], a[48:51], a[184:187], a[8:11]
buffer_load_dwordx4 v4, s[8:11], s3 offen offset:2048 lds
M a[8:11], a[52:55], a[188:191], a[8:11]
M a[12:15], a[60:63], a[188:191], a[12:15]
M a[12:15], a[56:59], a[184:187], a[12:15]
M a[16:19], a[64:67], a[184:187], a[16:19]
M a[16:19], a[68:71], a[188:191], a[16:19]
buffer_load_dwordx4 v5, s[8:11], s3 offen offset:3072 lds
M a[20:23], a[76:79], a[188:191], a[20:23]
M a[20:23], a[72:75], a[184:187], a[20:23]
M a[24:27], a[80:83], a[184:187], a[24:27]
M a[24:27], a[84:87], a[188:191], a[24:27]
M a[28:31], a[92:95], a[188:191], a[28:31]
M a[28:31], a[88:91], a[184:187], a[28:31]
s_waitcnt lgkmcnt(2)
M v[32:35], a[96:99], a[160:163], v[32:35]
s_add_u32 s23, s23, 128
s_cmp_eq_u32 s23, s25
s_cselect_b32 s23, s26, s23
M v[32:35], a[100:103], a[164:167], v[32:35]
ds_read_b128 a[176:179], v10 offset:36864
ds_read_b128 a[180:183], v11 offset:36864
M v[36:39], a[108:111], a[164:167], v[36:39]
M v[36:39], a[104:107], a[160:163], v[36:39]
ds_read_b64_tr_b16 a[32:33], v12 offset:0
ds_read_b64_tr_b16 a[34:35], v12 offset:2048
M v[40:43], a[112:115], a[160:163], v[40:43]
M v[40:43], a[116:119], a[164:167], v[40:43]
M v[44:47], a[124:127], a[164:167], v[44:47]
s_add_u32 m0, s29, 114688
s_nop 0
buffer_load_dwordx4 v6, s[12:15], s24 offen offset:0 lds
M v[44:47], a[120:123], a[160:163], v[44:47]
ds_read_b64_tr_b16 a[40:41], v13 offset:0
ds_read_b64_tr_b16 a[42:43], v13 offset:2048
M v[48:51], a[128:131], a[160:163], v[48:51]
M v[48:51], a[132:135], a[164:167], v[48:51]
M v[52:55], a[140:143], a[164:167], v[52:55]
M v[52:55], a[136:139], a[160:163], v[52:55]
ds_read_b64_tr_b16 a[48:49], v14 offset:0
ds_read_b64_tr_b16 a[50:51], v14 offset:2048
M v[56:59], a[144:147], a[160:163], v[56:59]
M v[56:59], a[148:151], a[164:167], v[56:59]
buffer_load_dwordx4 v7, s[12:15], s24 offen offset:1024 lds
M v[60:63], a[156:159], a[164:167], v[60:63]
M v[60:63], a[152:155], a[160:163], v[60:63]
s_waitcnt lgkmcnt(8)
ds_read_b64_tr_b16 a[56:57], v15 offset:0
ds_read_b64_tr_b16 a[58:59], v15 offset:2048
M v[64:67], a[96:99], a[168:171], v[64:67]
M v[64:67], a[100:103], a[172:175], v[64:67]
ds_read_b128 a[184:187], v10 offset:38912
ds_read_b128 a[188:191], v11 offset:38912
M v[68:71], a[108:111], a[172:175], v[68:71]
M v[68:71], a[104:107], a[168:171], v[68:71]
ds_read_b64_tr_b16 a[64:65], v16 offset:0
ds_read_b64_tr_b16 a[66:67], v16 offset:2048
M v[72:75], a[112:115], a[168:171], v[72:75]
buffer_load_dwordx4 v8, s[12:15], s24 offen offset:2048 lds
M v[72:75], a[116:119], a[172:175], v[72:75]
M v[76:79], a[124:127], a[172:175], v[76:79]
M v[76:79], a[120:123], a[168:171], v[76:79]
ds_read_b64_tr_b16 a[72:73], v17 offset:0
ds_read_b64_tr_b16 a[74:75], v17 offset:2048
M v[80:83], a[128:131], a[168:171], v[80:83]
M v[80:83], a[132:135], a[172:175], v[80:83]
M v[84:87], a[140:143], a[172:175], v[84:87]
buffer_load_dwordx4 v9, s[12:15], s24 offen offset:3072 lds
M v[84:87], a[136:139], a[168:171], v[84:87]
ds_read_b64_tr_b16 a[80:81], v18 offset:0
ds_read_b64_tr_b16 a[82:83], v18 offset:2048
M v[88:91], a[144:147], a[168:171], v[88:91]
M v[88:91], a[148:151], a[172:175], v[88:91]
M v[92:95], a[156:159], a[172:175], v[92:95]
M v[92:95], a[152:155], a[168:171], v[92:95]
s_waitcnt lgkmcnt(15)
ds_read_b64_tr_b16 a[88:89], v19 offset:0
ds_read_b64_tr_b16 a[90:91], v19 offset:2048
M v[96:99], a[96:99], a[176:179], v[96:99]
s_add_u32 s24, s24, 262144
s_cmp_eq_u32 s24, s27
s_cselect_b32 s24, s28, s24
s_sub_u32 s6, s6, 1
s_cmp_eq_u32 s6, 0
s_cselect_b64 s[12:13], s[64:65], s[12:13]
M v[96:99], a[100:103], a[180:183], v[96:99]
M v[100:103], a[108:111], a[180:183], v[100:103]
M v[100:103], a[104:107], a[176:179], v[100:103]
M v[104:107], a[112:115], a[176:179], v[104:107]
M v[104:107], a[116:119], a[180:183], v[104:107]
M v[108:111], a[124:127], a[180:183], v[108:111]
M v[108:111], a[120:123], a[176:179], v[108:111]
s_waitcnt vmcnt(16) lgkmcnt(0)
s_barrier
ds_read_b128 a[160:163], v10 offset:49152
ds_read_b128 a[164:167], v11 offset:49152
M v[112:115], a[128:131], a[176:179], v[112:115]
s_add_u32 m0, s29, 32768
s_nop 0
buffer_load_dwordx4 v2, s[8:11], s23 offen offset:0 lds
M v[112:115], a[132:135], a[180:183], v[112:115]
M v[116:119], a[140:143], a[180:183], v[116:119]
M v[116:119], a[136:139], a[176:179], v[116:119]
ds_read_b64_tr_b16 a[36:37], v12 offset:16384
ds_read_b64_tr_b16 a[38:39], v12 offset:18432
M v[120:123], a[144:147], a[176:179], v[120:123]
M v[120:123], a[148:151], a[180:183], v[120:123]
M v[124:127], a[156:159], a[180:183], v[124:127]
buffer_load_dwordx4 v3, s[8:11], s23 offen offset:1024 lds
M v[124:127], a[152:155], a[176:179], v[124:127]
M v[128:131], a[96:99], a[184:187], v[128:131]
M v[128:131], a[100:103], a[188:191], v[128:131]
ds_read_b128 a[168:171], v10 offset:51200
ds_read_b128 a[172:175], v11 offset:51200
ds_read_b64_tr_b16 a[44:45], v13 offset:16384
ds_read_b64_tr_b16 a[46:47], v13 offset:18432
M v[132:135], a[108:111], a[188:191], v[132:135]
M v[132:135], a[104:107], a[184:187], v[132:135]
M v[136:139], a[112:115], a[184:187], v[136:139]
M v[136:139], a[116:119], a[188:191], v[136:139]
buffer_load_dwordx4 v4, s[8:11], s23 offen offset:2048 lds
M v[140:143], a[124:127], a[188:191], v[140:143]
M v[140:143], a[120:123], a[184:187], v[140:143]
ds_read_b64_tr_b16 a[52:53], v14 offset:16384
ds_read_b64_tr_b16 a[54:55], v14 offset:18432
M v[144:147], a[128:131], a[184:187], v[144:147]
M v[144:147], a[132:135], a[188:191], v[144:147]
M v[148:151], a[140:143], a[188:191], v[148:151]
M v[148:151], a[136:139], a[184:187], v[148:151]
M v[152:155], a[144:147], a[184:187], v[152:155]
buffer_load_dwordx4 v5, s[8:11], s23 offen offset:3072 lds
M v[152:155], a[148:151], a[188:191], v[152:155]
ds_read_b64_tr_b16 a[60:61], v15 offset:16384
ds_read_b64_tr_b16 a[62:63], v15 offset:18432
M v[156:159], a[156:159], a[188:191], v[156:159]
M v[156:159], a[152:155], a[184:187], v[156:159]
s_waitcnt lgkmcnt(10)
M v[160:163], a[96:99], a[160:163], v[160:163]
M v[160:163], a[100:103], a[164:167], v[160:163]
ds_read_b128 a[176:179], v10 offset:53248
ds_read_b128 a[180:183], v11 offset:53248
M v[164:167], a[108:111], a[164:167], v[164:167]
M v[164:167], a[104:107], a[160:163], v[164:167]
ds_read_b64_tr_b16 a[68:69], v16 offset:16384
ds_read_b64_tr_b16 a[70:71], v16 offset:18432
M v[168:171], a[112:115], a[160:163], v[168:171]
M v[168:171], a[116:119], a[164:167], v[168:171]
s_add_u32 m0, s29, 65536
s_nop 0
buffer_load_dwordx4 v6, s[12:15], s24 offen offset:0 lds
M v[172:175], a[124:127], a[164:167], v[172:175]
M v[172:175], a[120:123], a[160:163], v[172:175]
M v[176:179], a[128:131], a[160:163], v[176:179]
M v[176:179], a[132:135], a[164:167], v[176:179]
ds_read_b64_tr_b16 a[76:77], v17 offset:16384
ds_read_b64_tr_b16 a[78:79], v17 offset:18432
M v[180:183], a[140:143], a[164:167], v[180:183]
M v[180:183], a[136:139], a[160:163], v[180:183]
buffer_load_dwordx4 v7, s[12:15], s24 offen offset:1024 lds
M v[184:187], a[144:147], a[160:163], v[184:187]
M v[184:187], a[148:151], a[164:167], v[184:187]
M v[188:191], a[156:159], a[164:167], v[188:191]
M v[188:191], a[152:155], a[160:163], v[188:191]
s_waitcnt lgkmcnt(12)
ds_read_b64_tr_b16 a[84:85], v18 offset:16384
ds_read_b64_tr_b16 a[86:87], v18 offset:18432
M v[192:195], a[96:99], a[168:171], v[192:195]
M v[192:195], a[100:103], a[172:175], v[192:195]
ds_read_b128 a[184:187], v10 offset:55296
ds_read_b128 a[188:191], v11 offset:55296
M v[196:199], a[108:111], a[172:175], v[196:199]
M v[196:199], a[104:107], a[168:171], v[196:199]
buffer_load_dwordx4 v8, s[12:15], s24 offen offset:2048 lds
M v[200:203], a[112:115], a[168:171], v[200:203]
M v[200:203], a[116:119], a[172:175], v[200:203]
ds_read_b64_tr_b16 a[92:93], v19 offset:16384
ds_read_b64_tr_b16 a[94:95], v19 offset:18432
M v[204:207], a[124:127], a[172:175], v[204:207]
M v[204:207], a[120:123], a[168:171], v[204:207]
M v[208:211], a[128:131], a[168:171], v[208:211]
M v[208:211], a[132:135], a[172:175], v[208:211]
buffer_load_dwordx4 v9, s[12:15], s24 offen offset:3072 lds
M v[212:215], a[140:143], a[172:175], v[212:215]
M v[212:215], a[136:139], a[168:171], v[212:215]
M v[216:219], a[144:147], a[168:171], v[216:219]
M v[216:219], a[148:151], a[172:175], v[216:219]
M v[220:223], a[156:159], a[172:175], v[220:223]
s_add_u32 s24, s24, 262144
M v[220:223], a[152:155], a[168:171], v[220:223]
s_waitcnt lgkmcnt(10)
M v[224:227], a[96:99], a[176:179], v[224:227]
M v[224:227], a[100:103], a[180:183], v[224:227]
M v[228:231], a[108:111], a[180:183], v[228:231]
M v[228:231], a[104:107], a[176:179], v[228:231]
M v[232:235], a[112:115], a[176:179], v[232:235]
M v[232:235], a[116:119], a[180:183], v[232:235]
M v[236:239], a[124:127], a[180:183], v[236:239]
M v[236:239], a[120:123], a[176:179], v[236:239]
s_waitcnt vmcnt(16) lgkmcnt(0)
s_barrier
ds_read_b128 a[160:163], v10 offset:0
ds_read_b128 a[164:167], v11 offset:0
M v[240:243], a[128:131], a[176:179], v[240:243]
s_add_u32 m0, s29, 49152
s_add_u32 s3, s23, s31
buffer_load_dwordx4 v2, s[8:11], s3 offen offset:0 lds
M v[240:243], a[132:135], a[180:183], v[240:243]
M v[244:247], a[140:143], a[180:183], v[244:247]
M v[244:247], a[136:139], a[176:179], v[244:247]
M v[248:251], a[144:147], a[176:179], v[248:251]
M v[248:251], a[148:151], a[180:183], v[248:251]
buffer_load_dwordx4 v3, s[8:11], s3 offen offset:1024 lds
M v[252:255], a[156:159], a[180:183], v[252:255]
M v[252:255], a[152:155], a[176:179], v[252:255]
M a[0:3], a[96:99], a[184:187], a[0:3]
M a[0:3], a[100:103], a[188:191], a[0:3]
ds_read_b128 a[168:171], v10 offset:2048
ds_read_b128 a[172:175], v11 offset:2048
M a[4:7], a[108:111], a[188:191], a[4:7]
M a[4:7], a[104:107], a[184:187], a[4:7]
M a[8:11], a[112:115], a[184:187], a[8:11]
buffer_load_dwordx4 v4, s[8:11], s3 offen offset:2048 lds
M a[8:11], a[116:119], a[188:191], a[8:11]
M a[12:15], a[124:127], a[188:191], a[12:15]
M a[12:15], a[120:123], a[184:187], a[12:15]
M a[16:19], a[128:131], a[184:187], a[16:19]
M a[16:19], a[132:135], a[188:191], a[16:19]
buffer_load_dwordx4 v5, s[8:11], s3 offen offset:3072 lds
M a[20:23], a[140:143], a[188:191], a[20:23]
M a[20:23], a[136:139], a[184:187], a[20:23]
M a[24:27], a[144:147], a[184:187], a[24:27]
M a[24:27], a[148:151], a[188:191], a[24:27]
M a[28:31], a[156:159], a[188:191], a[28:31]
M a[28:31], a[152:155], a[184:187], a[28:31]
s_waitcnt lgkmcnt(2)
s_sub_u32 s30, s30, 1
s_cmp_lg_u32 s30, 0
s_cbranch_scc1 Lk1_kl
M v[32:35], a[32:35], a[160:163], v[32:35]
s_add_u32 s23, s23, 128
s_cmp_eq_u32 s23, s25
s_cselect_b32 s23, s26, s23
M v[32:35], a[36:39], a[164:167], v[32:35]
ds_read_b128 a[176:179], v10 offset:4096
ds_read_b128 a[180:183], v11 offset:4096
M v[36:39], a[44:47], a[164:167], v[36:39]
M v[36:39], a[40:43], a[160:163], v[36:39]
ds_read_b64_tr_b16 a[96:97], v12 offset:32768
ds_read_b64_tr_b16 a[98:99], v12 offset:34816
M v[40:43], a[48:51], a[160:163], v[40:43]
M v[40:43], a[52:55], a[164:167], v[40:43]
M v[44:47], a[60:63], a[164:167], v[44:47]
s_add_u32 m0, s29, 81920
s_nop 0
buffer_load_dwordx4 v6, s[12:15], s24 offen offset:0 lds
M v[44:47], a[56:59], a[160:163], v[44:47]
ds_read_b64_tr_b16 a[104:105], v13 offset:32768
ds_read_b64_tr_b16 a[106:107], v13 offset:34816
M v[48:51], a[64:67], a[160:163], v[48:51]
M v[48:51], a[68:71], a[164:167], v[48:51]
M v[52:55], a[76:79], a[164:167], v[52:55]
M v[52:55], a[72:75], a[160:163], v[52:55]
ds_read_b64_tr_b16 a[112:113], v14 offset:32768
ds_read_b64_tr_b16 a[114:115], v14 offset:34816
M v[56:59], a[80:83], a[160:163], v[56:59]
M v[56:59], a[84:87], a[164:167], v[56:59]
buffer_load_dwordx4 v7, s[12:15], s24 offen offset:1024 lds
M v[60:63], a[92:95], a[164:167], v[60:63]
M v[60:63], a[88:91], a[160:163], v[60:63]
s_waitcnt lgkmcnt(8)
ds_read_b64_tr_b16 a[120:121], v15 offset:32768
ds_read_b64_tr_b16 a[122:123], v15 offset:34816
M v[64:67], a[32:35], a[168:171], v[64:67]
M v[64:67], a[36:39], a[172:175], v[64:67]
ds_read_b128 a[184:187], v10 offset:6144
ds_read_b128 a[188:191], v11 offset:6144
M v[68:71], a[44:47], a[172:175], v[68:71]
M v[68:71], a[40:43], a[168:171], v[68:71]
ds_read_b64_tr_b16 a[128:129], v16 offset:32768
ds_read_b64_tr_b16 a[130:131], v16 offset:34816
M v[72:75], a[48:51], a[168:171], v[72:75]
buffer_load_dwordx4 v8, s[12:15], s24 offen offset:2048 lds
M v[72:75], a[52:55], a[172:175], v[72:75]
M v[76:79], a[60:63], a[172:175], v[76:79]
M v[76:79], a[56:59], a[168:171], v[76:79]
ds_read_b64_tr_b16 a[136:137], v17 offset:32768
ds_read_b64_tr_b16 a[138:139], v17 offset:34816
M v[80:83], a[64:67], a[168:171], v[80:83]
M v[80:83], a[68:71], a[172:175], v[80:83]
M v[84:87], a[76:79], a[172:175], v[84:87]
buffer_load_dwordx4 v9, s[12:15], s24 offen offset:3072 lds
M v[84:87], a[72:75], a[168:171], v[84:87]
ds_read_b64_tr_b16 a[144:145], v18 offset:32768
ds_read_b64_tr_b16 a[146:147], v18 offset:34816
M v[88:91], a[80:83], a[168:171], v[88:91]
M v[88:91], a[84:87], a[172:175], v[88:91]
M v[92:95], a[92:95], a[172:175], v[92:95]
M v[92:95], a[88:91], a[168:171], v[92:95]
s_waitcnt lgkmcnt(15)
ds_read_b64_tr_b16 a[152:153], v19 offset:32768
ds_read_b64_tr_b16 a[154:155], v19 offset:34816
M v[96:99], a[32:35], a[176:179], v[96:99]
s_add_u32 s24, s24, 262144
s_cmp_eq_u32 s24, s27
s_cselect_b32 s24, s28, s24
s_sub_u32 s6, s6, 1
s_cmp_eq_u32 s6, 0
s_cselect_b64 s[12:13], s[64:65], s[12:13]
M v[96:99], a[36:39], a[180:183], v[96:99]
M v[100:103], a[44:47], a[180:183], v[100:103]
M v[100:103], a[40:43], a[176:179], v[100:103]
M v[104:107], a[48:51], a[176:179], v[104:107]
M v[104:107], a[52:55], a[180:183], v[104:107]
M v[108:111], a[60:63], a[180:183], v[108:111]
M v[108:111], a[56:59], a[176:179], v[108:111]
s_waitcnt vmcnt(16) lgkmcnt(0)
s_barrier
ds_read_b128 a[160:163], v10 offset:16384
ds_read_b128 a[164:167], v11 offset:16384
M v[112:115], a[64:67], a[176:179], v[112:115]
s_add_u32 m0, s29, 0
s_nop 0
buffer_load_dwordx4 v2, s[8:11], s23 offen offset:0 lds
M v[112:115], a[68:71], a[180:183], v[112:115]
M v[116:119], a[76:79], a[180:183], v[116:119]
M v[116:119], a[72:75], a[176:179], v[116:119]
ds_read_b64_tr_b16 a[100:101], v12 offset:49152
ds_read_b64_tr_b16 a[102:103], v12 offset:51200
M v[120:123], a[80:83], a[176:179], v[120:123]
M v[120:123], a[84:87], a[180:183], v[120:123]
M v[124:127], a[92:95], a[180:183], v[124:127]
buffer_load_dwordx4 v3, s[8:11], s23 offen offset:1024 lds
M v[124:127], a[88:91], a[176:179], v[124:127]
M v[128:131], a[32:35], a[184:187], v[128:131]
M v[128:131], a[36:39], a[188:191], v[128:131]
ds_read_b128 a[168:171], v10 offset:18432
ds_read_b128 a[172:175], v11 offset:18432
ds_read_b64_tr_b16 a[108:109], v13 offset:49152
ds_read_b64_tr_b16 a[110:111], v13 offset:51200
M v[132:135], a[44:47], a[188:191], v[132:135]
M v[132:135], a[40:43], a[184:187], v[132:135]
M v[136:139], a[48:51], a[184:187], v[136:139]
M v[136:139], a[52:55], a[188:191], v[136:139]
buffer_load_dwordx4 v4, s[8:11], s23 offen offset:2048 lds
M v[140:143], a[60:63], a[188:191], v[140:143]
M v[140:143], a[56:59], a[184:187], v[140:143]
ds_read_b64_tr_b16 a[116:117], v14 offset:49152
ds_read_b64_tr_b16 a[118:119], v14 offset:51200
M v[144:147], a[64:67], a[184:187], v[144:147]
M v[144:147], a[68:71], a[188:191], v[144:147]
M v[148:151], a[76:79], a[188:191], v[148:151]
M v[148:151], a[72:75], a[184:187], v[148:151]
M v[152:155], a[80:83], a[184:187], v[152:155]
buffer_load_dwordx4 v5, s[8:11], s23 offen offset:3072 lds
s_lshr_b32 s3, s53, 7
s_add_u32 s3, s3, s22
M v[152:155], a[84:87], a[188:191], v[152:155]
ds_read_b64_tr_b16 a[124:125], v15 offset:49152
ds_read_b64_tr_b16 a[126:127], v15 offset:51200
s_lshl_b32 s3, s3, 5
s_lshr_b32 s19, s52, 6
M v[156:159], a[92:95], a[188:191], v[156:159]
s_add_u32 s3, s3, s19
s_lshl_b32 s19, s21, 1
M v[156:159], a[88:91], a[184:187], v[156:159]
s_waitcnt lgkmcnt(10)
s_add_u32 s3, s3, s19
s_lshl_b32 s92, s3, 15
M v[160:163], a[32:35], a[160:163], v[160:163]
s_add_u32 s93, s92, 32768
s_add_u32 s16, s50, 16777216
M v[160:163], a[36:39], a[164:167], v[160:163]
ds_read_b128 a[176:179], v10 offset:20480
ds_read_b128 a[180:183], v11 offset:20480
s_addc_u32 s17, s51, 0
s_mov_b32 s18, 33554432
M v[164:167], a[44:47], a[164:167], v[164:167]
s_mov_b32 s19, 0x00020000
M v[164:167], a[40:43], a[160:163], v[164:167]
ds_read_b64_tr_b16 a[132:133], v16 offset:49152
ds_read_b64_tr_b16 a[134:135], v16 offset:51200
M v[168:171], a[48:51], a[160:163], v[168:171]
M v[168:171], a[52:55], a[164:167], v[168:171]
s_add_u32 m0, s29, 98304
s_nop 0
buffer_load_dwordx4 v6, s[12:15], s24 offen offset:0 lds
M v[172:175], a[60:63], a[164:167], v[172:175]
M v[172:175], a[56:59], a[160:163], v[172:175]
M v[176:179], a[64:67], a[160:163], v[176:179]
M v[176:179], a[68:71], a[164:167], v[176:179]
ds_read_b64_tr_b16 a[140:141], v17 offset:49152
ds_read_b64_tr_b16 a[142:143], v17 offset:51200
M v[180:183], a[76:79], a[164:167], v[180:183]
M v[180:183], a[72:75], a[160:163], v[180:183]
buffer_load_dwordx4 v7, s[12:15], s24 offen offset:1024 lds
M v[184:187], a[80:83], a[160:163], v[184:187]
M v[184:187], a[84:87], a[164:167], v[184:187]
M v[188:191], a[92:95], a[164:167], v[188:191]
M v[188:191], a[88:91], a[160:163], v[188:191]
s_waitcnt lgkmcnt(12)
ds_read_b64_tr_b16 a[148:149], v18 offset:49152
ds_read_b64_tr_b16 a[150:151], v18 offset:51200
M v[192:195], a[32:35], a[168:171], v[192:195]
M v[192:195], a[36:39], a[172:175], v[192:195]
ds_read_b128 a[184:187], v10 offset:22528
ds_read_b128 a[188:191], v11 offset:22528
M v[196:199], a[44:47], a[172:175], v[196:199]
M v[196:199], a[40:43], a[168:171], v[196:199]
buffer_load_dwordx4 v8, s[12:15], s24 offen offset:2048 lds
M v[200:203], a[48:51], a[168:171], v[200:203]
M v[200:203], a[52:55], a[172:175], v[200:203]
ds_read_b64_tr_b16 a[156:157], v19 offset:49152
ds_read_b64_tr_b16 a[158:159], v19 offset:51200
M v[204:207], a[60:63], a[172:175], v[204:207]
M v[204:207], a[56:59], a[168:171], v[204:207]
M v[208:211], a[64:67], a[168:171], v[208:211]
M v[208:211], a[68:71], a[172:175], v[208:211]
buffer_load_dwordx4 v9, s[12:15], s24 offen offset:3072 lds
M v[212:215], a[76:79], a[172:175], v[212:215]
M v[212:215], a[72:75], a[168:171], v[212:215]
M v[216:219], a[80:83], a[168:171], v[216:219]
M v[216:219], a[84:87], a[172:175], v[216:219]
M v[220:223], a[92:95], a[172:175], v[220:223]
s_add_u32 s24, s24, 262144
M v[220:223], a[88:91], a[168:171], v[220:223]
s_waitcnt lgkmcnt(10)
M v[224:227], a[32:35], a[176:179], v[224:227]
M v[224:227], a[36:39], a[180:183], v[224:227]
M v[228:231], a[44:47], a[180:183], v[228:231]
M v[228:231], a[40:43], a[176:179], v[228:231]
M v[232:235], a[48:51], a[176:179], v[232:235]
M v[232:235], a[52:55], a[180:183], v[232:235]
M v[236:239], a[60:63], a[180:183], v[236:239]
M v[236:239], a[56:59], a[176:179], v[236:239]
s_waitcnt vmcnt(16) lgkmcnt(0)
s_barrier
ds_read_b128 a[160:163], v10 offset:32768
ds_read_b128 a[164:167], v11 offset:32768
M v[240:243], a[64:67], a[176:179], v[240:243]
s_add_u32 m0, s29, 16384
s_add_u32 s3, s23, s31
buffer_load_dwordx4 v2, s[8:11], s3 offen offset:0 lds
M v[240:243], a[68:71], a[180:183], v[240:243]
M v[244:247], a[76:79], a[180:183], v[244:247]
M v[244:247], a[72:75], a[176:179], v[244:247]
M v[248:251], a[80:83], a[176:179], v[248:251]
M v[248:251], a[84:87], a[180:183], v[248:251]
buffer_load_dwordx4 v3, s[8:11], s3 offen offset:1024 lds
M v[252:255], a[92:95], a[180:183], v[252:255]
M v[252:255], a[88:91], a[176:179], v[252:255]
M a[0:3], a[32:35], a[184:187], a[0:3]
M a[0:3], a[36:39], a[188:191], a[0:3]
ds_read_b128 a[168:171], v10 offset:34816
ds_read_b128 a[172:175], v11 offset:34816
M a[4:7], a[44:47], a[188:191], a[4:7]
M a[4:7], a[40:43], a[184:187], a[4:7]
M a[8:11], a[48:51], a[184:187], a[8:11]
buffer_load_dwordx4 v4, s[8:11], s3 offen offset:2048 lds
M a[8:11], a[52:55], a[188:191], a[8:11]
M a[12:15], a[60:63], a[188:191], a[12:15]
M a[12:15], a[56:59], a[184:187], a[12:15]
M a[16:19], a[64:67], a[184:187], a[16:19]
M a[16:19], a[68:71], a[188:191], a[16:19]
buffer_load_dwordx4 v5, s[8:11], s3 offen offset:3072 lds
M a[20:23], a[76:79], a[188:191], a[20:23]
M a[20:23], a[72:75], a[184:187], a[20:23]
M a[24:27], a[80:83], a[184:187], a[24:27]
M a[24:27], a[84:87], a[188:191], a[24:27]
M a[28:31], a[92:95], a[188:191], a[28:31]
M a[28:31], a[88:91], a[184:187], a[28:31]
s_waitcnt lgkmcnt(2)
M v[32:35], a[96:99], a[160:163], v[32:35]
s_add_u32 s23, s23, 128
s_cmp_eq_u32 s23, s25
s_cselect_b32 s23, s26, s23
M v[32:35], a[100:103], a[164:167], v[32:35]
ds_read_b128 a[176:179], v10 offset:36864
ds_read_b128 a[180:183], v11 offset:36864
M v[36:39], a[108:111], a[164:167], v[36:39]
M v[36:39], a[104:107], a[160:163], v[36:39]
ds_read_b64_tr_b16 a[32:33], v12 offset:0
ds_read_b64_tr_b16 a[34:35], v12 offset:2048
M v[40:43], a[112:115], a[160:163], v[40:43]
M v[40:43], a[116:119], a[164:167], v[40:43]
M v[44:47], a[124:127], a[164:167], v[44:47]
s_add_u32 m0, s29, 114688
s_nop 0
buffer_load_dwordx4 v6, s[12:15], s24 offen offset:0 lds
M v[44:47], a[120:123], a[160:163], v[44:47]
ds_read_b64_tr_b16 a[40:41], v13 offset:0
ds_read_b64_tr_b16 a[42:43], v13 offset:2048
M v[48:51], a[128:131], a[160:163], v[48:51]
M v[48:51], a[132:135], a[164:167], v[48:51]
M v[52:55], a[140:143], a[164:167], v[52:55]
M v[52:55], a[136:139], a[160:163], v[52:55]
ds_read_b64_tr_b16 a[48:49], v14 offset:0
ds_read_b64_tr_b16 a[50:51], v14 offset:2048
M v[56:59], a[144:147], a[160:163], v[56:59]
buffer_load_dwordx4 v7, s[12:15], s24 offen offset:1024 lds
M v[56:59], a[148:151], a[164:167], v[56:59]
M v[60:63], a[156:159], a[164:167], v[60:63]
M v[60:63], a[152:155], a[160:163], v[60:63]
s_waitcnt lgkmcnt(8)
ds_read_b64_tr_b16 a[56:57], v15 offset:0
ds_read_b64_tr_b16 a[58:59], v15 offset:2048
M v[64:67], a[96:99], a[168:171], v[64:67]
M v[64:67], a[100:103], a[172:175], v[64:67]
ds_read_b128 a[184:187], v10 offset:38912
ds_read_b128 a[188:191], v11 offset:38912
M v[68:71], a[108:111], a[172:175], v[68:71]
M v[68:71], a[104:107], a[168:171], v[68:71]
ds_read_b64_tr_b16 a[64:65], v16 offset:0
ds_read_b64_tr_b16 a[66:67], v16 offset:2048
v_cvt_pk_bf16_f32 v32, v32, v33
v_cvt_pk_bf16_f32 v33, v34, v35
M v[72:75], a[112:115], a[168:171], v[72:75]
buffer_load_dwordx4 v8, s[12:15], s24 offen offset:2048 lds
v_cvt_pk_bf16_f32 v34, v36, v37
v_cvt_pk_bf16_f32 v35, v38, v39
M v[72:75], a[116:119], a[172:175], v[72:75]
v_cvt_pk_bf16_f32 v40, v40, v41
v_cvt_pk_bf16_f32 v41, v42, v43
M v[76:79], a[124:127], a[172:175], v[76:79]
v_cvt_pk_bf16_f32 v42, v44, v45
v_cvt_pk_bf16_f32 v43, v46, v47
M v[76:79], a[120:123], a[168:171], v[76:79]
ds_read_b64_tr_b16 a[72:73], v17 offset:0
ds_read_b64_tr_b16 a[74:75], v17 offset:2048
v_cvt_pk_bf16_f32 v48, v48, v49
v_cvt_pk_bf16_f32 v49, v50, v51
M v[80:83], a[128:131], a[168:171], v[80:83]
v_cvt_pk_bf16_f32 v50, v52, v53
v_cvt_pk_bf16_f32 v51, v54, v55
M v[80:83], a[132:135], a[172:175], v[80:83]
buffer_load_dwordx4 v9, s[12:15], s24 offen offset:3072 lds
v_cvt_pk_bf16_f32 v56, v56, v57
v_cvt_pk_bf16_f32 v57, v58, v59
M v[84:87], a[140:143], a[172:175], v[84:87]
v_cvt_pk_bf16_f32 v58, v60, v61
v_cvt_pk_bf16_f32 v59, v62, v63
M v[84:87], a[136:139], a[168:171], v[84:87]
ds_read_b64_tr_b16 a[80:81], v18 offset:0
ds_read_b64_tr_b16 a[82:83], v18 offset:2048
M v[88:91], a[144:147], a[168:171], v[88:91]
M v[88:91], a[148:151], a[172:175], v[88:91]
M v[92:95], a[156:159], a[172:175], v[92:95]
s_add_u32 s94, s92, 0
buffer_store_dwordx4 v[32:35], v1, s[16:19], s94 offen offset:0 sc1
M v[92:95], a[152:155], a[168:171], v[92:95]
s_waitcnt lgkmcnt(15)
ds_read_b64_tr_b16 a[88:89], v19 offset:0
ds_read_b64_tr_b16 a[90:91], v19 offset:2048
M v[96:99], a[96:99], a[176:179], v[96:99]
s_add_u32 s24, s24, 262144
s_cmp_eq_u32 s24, s27
s_cselect_b32 s24, s28, s24
s_sub_u32 s6, s6, 1
s_cmp_eq_u32 s6, 0
s_cselect_b64 s[12:13], s[64:65], s[12:13]
M v[96:99], a[100:103], a[180:183], v[96:99]
M v[100:103], a[108:111], a[180:183], v[100:103]
M v[100:103], a[104:107], a[176:179], v[100:103]
v_cvt_pk_bf16_f32 v64, v64, v65
v_cvt_pk_bf16_f32 v65, v66, v67
M v[104:107], a[112:115], a[176:179], v[104:107]
v_cvt_pk_bf16_f32 v66, v68, v69
v_cvt_pk_bf16_f32 v67, v70, v71
M v[104:107], a[116:119], a[180:183], v[104:107]
s_add_u32 s94, s92, 0
buffer_store_dwordx4 v[40:43], v1, s[16:19], s94 offen offset:1024 sc1
v_cvt_pk_bf16_f32 v72, v72, v73
v_cvt_pk_bf16_f32 v73, v74, v75
M v[108:111], a[124:127], a[180:183], v[108:111]
v_cvt_pk_bf16_f32 v74, v76, v77
v_cvt_pk_bf16_f32 v75, v78, v79
M v[108:111], a[120:123], a[176:179], v[108:111]
s_waitcnt vmcnt(18) lgkmcnt(0)
s_barrier
ds_read_b128 a[160:163], v10 offset:49152
ds_read_b128 a[164:167], v11 offset:49152
v_cvt_pk_bf16_f32 v80, v80, v81
v_cvt_pk_bf16_f32 v81, v82, v83
M v[112:115], a[128:131], a[176:179], v[112:115]
s_add_u32 m0, s29, 32768
s_nop 0
buffer_load_dwordx4 v2, s[8:11], s23 offen offset:0 lds
v_cvt_pk_bf16_f32 v82, v84, v85
v_cvt_pk_bf16_f32 v83, v86, v87
M v[112:115], a[132:135], a[180:183], v[112:115]
v_cvt_pk_bf16_f32 v88, v88, v89
v_cvt_pk_bf16_f32 v89, v90, v91
M v[116:119], a[140:143], a[180:183], v[116:119]
v_cvt_pk_bf16_f32 v90, v92, v93
v_cvt_pk_bf16_f32 v91, v94, v95
M v[116:119], a[136:139], a[176:179], v[116:119]
ds_read_b64_tr_b16 a[36:37], v12 offset:16384
ds_read_b64_tr_b16 a[38:39], v12 offset:18432
M v[120:123], a[144:147], a[176:179], v[120:123]
s_add_u32 s94, s92, 0
buffer_store_dwordx4 v[48:51], v1, s[16:19], s94 offen offset:2048 sc1
M v[120:123], a[148:151], a[180:183], v[120:123]
M v[124:127], a[156:159], a[180:183], v[124:127]
buffer_load_dwordx4 v3, s[8:11], s23 offen offset:1024 lds
M v[124:127], a[152:155], a[176:179], v[124:127]
M v[128:131], a[96:99], a[184:187], v[128:131]
M v[128:131], a[100:103], a[188:191], v[128:131]
ds_read_b128 a[168:171], v10 offset:51200
ds_read_b128 a[172:175], v11 offset:51200
ds_read_b64_tr_b16 a[44:45], v13 offset:16384
ds_read_b64_tr_b16 a[46:47], v13 offset:18432
M v[132:135], a[108:111], a[188:191], v[132:135]
M v[132:135], a[104:107], a[184:187], v[132:135]
s_add_u32 s94, s92, 0
buffer_store_dwordx4 v[56:59], v1, s[16:19], s94 offen offset:3072 sc1
v_cvt_pk_bf16_f32 v96, v96, v97
v_cvt_pk_bf16_f32 v97, v98, v99
M v[136:139], a[112:115], a[184:187], v[136:139]
v_cvt_pk_bf16_f32 v98, v100, v101
v_cvt_pk_bf16_f32 v99, v102, v103
M v[136:139], a[116:119], a[188:191], v[136:139]
buffer_load_dwordx4 v4, s[8:11], s23 offen offset:2048 lds
v_cvt_pk_bf16_f32 v104, v104, v105
v_cvt_pk_bf16_f32 v105, v106, v107
M v[140:143], a[124:127], a[188:191], v[140:143]
v_cvt_pk_bf16_f32 v106, v108, v109
v_cvt_pk_bf16_f32 v107, v110, v111
M v[140:143], a[120:123], a[184:187], v[140:143]
ds_read_b64_tr_b16 a[52:53], v14 offset:16384
ds_read_b64_tr_b16 a[54:55], v14 offset:18432
v_cvt_pk_bf16_f32 v112, v112, v113
v_cvt_pk_bf16_f32 v113, v114, v115
M v[144:147], a[128:131], a[184:187], v[144:147]
v_cvt_pk_bf16_f32 v114, v116, v117
v_cvt_pk_bf16_f32 v115, v118, v119
M v[144:147], a[132:135], a[188:191], v[144:147]
v_cvt_pk_bf16_f32 v120, v120, v121
v_cvt_pk_bf16_f32 v121, v122, v123
M v[148:151], a[140:143], a[188:191], v[148:151]
s_add_u32 s94, s92, 4096
buffer_store_dwordx4 v[64:67], v1, s[16:19], s94 offen offset:0 sc1
v_cvt_pk_bf16_f32 v122, v124, v125
v_cvt_pk_bf16_f32 v123, v126, v127
M v[148:151], a[136:139], a[184:187], v[148:151]
M v[152:155], a[144:147], a[184:187], v[152:155]
buffer_load_dwordx4 v5, s[8:11], s23 offen offset:3072 lds
M v[152:155], a[148:151], a[188:191], v[152:155]
ds_read_b64_tr_b16 a[60:61], v15 offset:16384
ds_read_b64_tr_b16 a[62:63], v15 offset:18432
M v[156:159], a[156:159], a[188:191], v[156:159]
M v[156:159], a[152:155], a[184:187], v[156:159]
s_waitcnt lgkmcnt(10)
M v[160:163], a[96:99], a[160:163], v[160:163]
M v[160:163], a[100:103], a[164:167], v[160:163]
ds_read_b128 a[176:179], v10 offset:53248
ds_read_b128 a[180:183], v11 offset:53248
M v[164:167], a[108:111], a[164:167], v[164:167]
s_add_u32 s94, s92, 4096
buffer_store_dwordx4 v[72:75], v1, s[16:19], s94 offen offset:1024 sc1
M v[164:167], a[104:107], a[160:163], v[164:167]
ds_read_b64_tr_b16 a[68:69], v16 offset:16384
ds_read_b64_tr_b16 a[70:71], v16 offset:18432
v_cvt_pk_bf16_f32 v128, v128, v129
v_cvt_pk_bf16_f32 v129, v130, v131
M v[168:171], a[112:115], a[160:163], v[168:171]
v_cvt_pk_bf16_f32 v130, v132, v133
v_cvt_pk_bf16_f32 v131, v134, v135
M v[168:171], a[116:119], a[164:167], v[168:171]
s_add_u32 m0, s29, 65536
s_nop 0
buffer_load_dwordx4 v6, s[12:15], s24 offen offset:0 lds
v_cvt_pk_bf16_f32 v136, v136, v137
v_cvt_pk_bf16_f32 v137, v138, v139
M v[172:175], a[124:127], a[164:167], v[172:175]
v_cvt_pk_bf16_f32 v138, v140, v141
v_cvt_pk_bf16_f32 v139, v142, v143
M v[172:175], a[120:123], a[160:163], v[172:175]
v_cvt_pk_bf16_f32 v144, v144, v145
v_cvt_pk_bf16_f32 v145, v146, v147
M v[176:179], a[128:131], a[160:163], v[176:179]
s_add_u32 s94, s92, 4096
buffer_store_dwordx4 v[80:83], v1, s[16:19], s94 offen offset:2048 sc1
v_cvt_pk_bf16_f32 v146, v148, v149
v_cvt_pk_bf16_f32 v147, v150, v151
M v[176:179], a[132:135], a[164:167], v[176:179]
ds_read_b64_tr_b16 a[76:77], v17 offset:16384
ds_read_b64_tr_b16 a[78:79], v17 offset:18432
v_cvt_pk_bf16_f32 v152, v152, v153
v_cvt_pk_bf16_f32 v153, v154, v155
M v[180:183], a[140:143], a[164:167], v[180:183]
v_cvt_pk_bf16_f32 v154, v156, v157
v_cvt_pk_bf16_f32 v155, v158, v159
M v[180:183], a[136:139], a[160:163], v[180:183]
buffer_load_dwordx4 v7, s[12:15], s24 offen offset:1024 lds
M v[184:187], a[144:147], a[160:163], v[184:187]
M v[184:187], a[148:151], a[164:167], v[184:187]
M v[188:191], a[156:159], a[164:167], v[188:191]
M v[188:191], a[152:155], a[160:163], v[188:191]
s_waitcnt lgkmcnt(12)
ds_read_b64_tr_b16 a[84:85], v18 offset:16384
ds_read_b64_tr_b16 a[86:87], v18 offset:18432
M v[192:195], a[96:99], a[168:171], v[192:195]
s_add_u32 s94, s92, 4096
buffer_store_dwordx4 v[88:91], v1, s[16:19], s94 offen offset:3072 sc1
M v[192:195], a[100:103], a[172:175], v[192:195]
ds_read_b128 a[184:187], v10 offset:55296
ds_read_b128 a[188:191], v11 offset:55296
M v[196:199], a[108:111], a[172:175], v[196:199]
M v[196:199], a[104:107], a[168:171], v[196:199]
buffer_load_dwordx4 v8, s[12:15], s24 offen offset:2048 lds
v_cvt_pk_bf16_f32 v160, v160, v161
v_cvt_pk_bf16_f32 v161, v162, v163
M v[200:203], a[112:115], a[168:171], v[200:203]
v_cvt_pk_bf16_f32 v162, v164, v165
v_cvt_pk_bf16_f32 v163, v166, v167
M v[200:203], a[116:119], a[172:175], v[200:203]
ds_read_b64_tr_b16 a[92:93], v19 offset:16384
ds_read_b64_tr_b16 a[94:95], v19 offset:18432
v_cvt_pk_bf16_f32 v168, v168, v169
v_cvt_pk_bf16_f32 v169, v170, v171
M v[204:207], a[124:127], a[172:175], v[204:207]
s_add_u32 s94, s92, 8192
buffer_store_dwordx4 v[96:99], v1, s[16:19], s94 offen offset:0 sc1
v_cvt_pk_bf16_f32 v170, v172, v173
v_cvt_pk_bf16_f32 v171, v174, v175
M v[204:207], a[120:123], a[168:171], v[204:207]
v_cvt_pk_bf16_f32 v176, v176, v177
v_cvt_pk_bf16_f32 v177, v178, v179
M v[208:211], a[128:131], a[168:171], v[208:211]
v_cvt_pk_bf16_f32 v178, v180, v181
v_cvt_pk_bf16_f32 v179, v182, v183
M v[208:211], a[132:135], a[172:175], v[208:211]
buffer_load_dwordx4 v9, s[12:15], s24 offen offset:3072 lds
v_cvt_pk_bf16_f32 v184, v184, v185
v_cvt_pk_bf16_f32 v185, v186, v187
M v[212:215], a[140:143], a[172:175], v[212:215]
v_cvt_pk_bf16_f32 v186, v188, v189
v_cvt_pk_bf16_f32 v187, v190, v191
M v[212:215], a[136:139], a[168:171], v[212:215]
M v[216:219], a[144:147], a[168:171], v[216:219]
M v[216:219], a[148:151], a[172:175], v[216:219]
s_add_u32 s94, s92, 8192
buffer_store_dwordx4 v[104:107], v1, s[16:19], s94 offen offset:1024 sc1
M v[220:223], a[156:159], a[172:175], v[220:223]
s_add_u32 s24, s24, 262144
M v[220:223], a[152:155], a[168:171], v[220:223]
s_waitcnt lgkmcnt(10)
M v[224:227], a[96:99], a[176:179], v[224:227]
M v[224:227], a[100:103], a[180:183], v[224:227]
M v[228:231], a[108:111], a[180:183], v[228:231]
M v[228:231], a[104:107], a[176:179], v[228:231]
v_cvt_pk_bf16_f32 v192, v192, v193
v_cvt_pk_bf16_f32 v193, v194, v195
M v[232:235], a[112:115], a[176:179], v[232:235]
s_add_u32 s94, s92, 8192
buffer_store_dwordx4 v[112:115], v1, s[16:19], s94 offen offset:2048 sc1
v_cvt_pk_bf16_f32 v194, v196, v197
v_cvt_pk_bf16_f32 v195, v198, v199
M v[232:235], a[116:119], a[180:183], v[232:235]
v_cvt_pk_bf16_f32 v200, v200, v201
v_cvt_pk_bf16_f32 v201, v202, v203
M v[236:239], a[124:127], a[180:183], v[236:239]
v_cvt_pk_bf16_f32 v202, v204, v205
v_cvt_pk_bf16_f32 v203, v206, v207
M v[236:239], a[120:123], a[176:179], v[236:239]
s_waitcnt vmcnt(27) lgkmcnt(0)
s_barrier
ds_read_b128 a[160:163], v10 offset:0
ds_read_b128 a[164:167], v11 offset:0
v_cvt_pk_bf16_f32 v208, v208, v209
v_cvt_pk_bf16_f32 v209, v210, v211
M v[240:243], a[128:131], a[176:179], v[240:243]
s_add_u32 m0, s29, 49152
s_add_u32 s3, s23, s31
buffer_load_dwordx4 v2, s[8:11], s3 offen offset:0 lds
v_cvt_pk_bf16_f32 v210, v212, v213
v_cvt_pk_bf16_f32 v211, v214, v215
M v[240:243], a[132:135], a[180:183], v[240:243]
v_cvt_pk_bf16_f32 v216, v216, v217
v_cvt_pk_bf16_f32 v217, v218, v219
M v[244:247], a[140:143], a[180:183], v[244:247]
v_cvt_pk_bf16_f32 v218, v220, v221
v_cvt_pk_bf16_f32 v219, v222, v223
M v[244:247], a[136:139], a[176:179], v[244:247]
s_add_u32 s94, s92, 8192
buffer_store_dwordx4 v[120:123], v1, s[16:19], s94 offen offset:3072 sc1
M v[248:251], a[144:147], a[176:179], v[248:251]
M v[248:251], a[148:151], a[180:183], v[248:251]
buffer_load_dwordx4 v3, s[8:11], s3 offen offset:1024 lds
M v[252:255], a[156:159], a[180:183], v[252:255]
M v[252:255], a[152:155], a[176:179], v[252:255]
M a[0:3], a[96:99], a[184:187], a[0:3]
M a[0:3], a[100:103], a[188:191], a[0:3]
ds_read_b128 a[168:171], v10 offset:2048
ds_read_b128 a[172:175], v11 offset:2048
M a[4:7], a[108:111], a[188:191], a[4:7]
s_add_u32 s94, s92, 12288
buffer_store_dwordx4 v[128:131], v1, s[16:19], s94 offen offset:0 sc1
M a[4:7], a[104:107], a[184:187], a[4:7]
v_cvt_pk_bf16_f32 v224, v224, v225
v_cvt_pk_bf16_f32 v225, v226, v227
M a[8:11], a[112:115], a[184:187], a[8:11]
v_cvt_pk_bf16_f32 v226, v228, v229
v_cvt_pk_bf16_f32 v227, v230, v231
M a[8:11], a[116:119], a[188:191], a[8:11]
buffer_load_dwordx4 v4, s[8:11], s3 offen offset:2048 lds
v_cvt_pk_bf16_f32 v232, v232, v233
v_cvt_pk_bf16_f32 v233, v234, v235
M a[12:15], a[124:127], a[188:191], a[12:15]
v_cvt_pk_bf16_f32 v234, v236, v237
v_cvt_pk_bf16_f32 v235, v238, v239
M a[12:15], a[120:123], a[184:187], a[12:15]
v_cvt_pk_bf16_f32 v240, v240, v241
v_cvt_pk_bf16_f32 v241, v242, v243
M a[16:19], a[128:131], a[184:187], a[16:19]
v_cvt_pk_bf16_f32 v242, v244, v245
v_cvt_pk_bf16_f32 v243, v246, v247
M a[16:19], a[132:135], a[188:191], a[16:19]
s_add_u32 s94, s92, 12288
buffer_store_dwordx4 v[136:139], v1, s[16:19], s94 offen offset:1024 sc1
v_cvt_pk_bf16_f32 v248, v248, v249
v_cvt_pk_bf16_f32 v249, v250, v251
M a[20:23], a[140:143], a[188:191], a[20:23]
buffer_load_dwordx4 v5, s[8:11], s3 offen offset:3072 lds
v_cvt_pk_bf16_f32 v250, v252, v253
v_cvt_pk_bf16_f32 v251, v254, v255
M a[20:23], a[136:139], a[184:187], a[20:23]
M a[24:27], a[144:147], a[184:187], a[24:27]
M a[24:27], a[148:151], a[188:191], a[24:27]
M a[28:31], a[156:159], a[188:191], a[28:31]
M a[28:31], a[152:155], a[184:187], a[28:31]
s_waitcnt lgkmcnt(2)
M v[32:35], a[160:163], a[32:35], 0
s_add_u32 s94, s92, 12288
buffer_store_dwordx4 v[144:147], v1, s[16:19], s94 offen offset:2048 sc1
M v[32:35], a[164:167], a[36:39], v[32:35]
ds_read_b128 a[176:179], v10 offset:4096
ds_read_b128 a[180:183], v11 offset:4096
M v[36:39], a[164:167], a[44:47], 0
s_add_u32 s23, s23, 128
s_cmp_eq_u32 s23, s25
s_cselect_b32 s23, s26, s23
M v[36:39], a[160:163], a[40:43], v[36:39]
ds_read_b64_tr_b16 a[96:97], v12 offset:32768
ds_read_b64_tr_b16 a[98:99], v12 offset:34816
M v[40:43], a[160:163], a[48:51], 0
M v[40:43], a[164:167], a[52:55], v[40:43]
M v[44:47], a[164:167], a[60:63], 0
s_add_u32 m0, s29, 81920
s_nop 0
buffer_load_dwordx4 v6, s[12:15], s24 offen offset:0 lds
v_accvgpr_read_b32 v24, a0
v_accvgpr_read_b32 v25, a1
M v[44:47], a[160:163], a[56:59], v[44:47]
ds_read_b64_tr_b16 a[104:105], v13 offset:32768
ds_read_b64_tr_b16 a[106:107], v13 offset:34816
v_accvgpr_read_b32 v26, a2
v_accvgpr_read_b32 v27, a3
M v[48:51], a[160:163], a[64:67], 0
s_add_u32 s94, s92, 12288
buffer_store_dwordx4 v[152:155], v1, s[16:19], s94 offen offset:3072 sc1
v_accvgpr_read_b32 v28, a4
v_accvgpr_read_b32 v29, a5
M v[48:51], a[164:167], a[68:71], v[48:51]
v_accvgpr_read_b32 v30, a6
v_accvgpr_read_b32 v31, a7
M v[52:55], a[164:167], a[76:79], 0
v_cvt_pk_bf16_f32 v24, v24, v25
v_cvt_pk_bf16_f32 v25, v26, v27
M v[52:55], a[160:163], a[72:75], v[52:55]
ds_read_b64_tr_b16 a[112:113], v14 offset:32768
ds_read_b64_tr_b16 a[114:115], v14 offset:34816
v_cvt_pk_bf16_f32 v26, v28, v29
v_cvt_pk_bf16_f32 v27, v30, v31
M v[56:59], a[160:163], a[80:83], 0
buffer_load_dwordx4 v7, s[12:15], s24 offen offset:1024 lds
M v[56:59], a[164:167], a[84:87], v[56:59]
M v[60:63], a[164:167], a[92:95], 0
s_add_u32 s94, s93, 0
buffer_store_dwordx4 v[160:163], v1, s[16:19], s94 offen offset:0 sc1
M v[60:63], a[160:163], a[88:91], v[60:63]
s_waitcnt lgkmcnt(8)
ds_read_b64_tr_b16 a[120:121], v15 offset:32768
ds_read_b64_tr_b16 a[122:123], v15 offset:34816
M v[64:67], a[168:171], a[32:35], 0
s_add_u32 s94, s93, 12288
buffer_store_dwordx4 v[24:27], v1, s[16:19], s94 offen offset:0 sc1
M v[64:67], a[172:175], a[36:39], v[64:67]
ds_read_b128 a[184:187], v10 offset:6144
ds_read_b128 a[188:191], v11 offset:6144
M v[68:71], a[172:175], a[44:47], 0
M v[68:71], a[168:171], a[40:43], v[68:71]
ds_read_b64_tr_b16 a[128:129], v16 offset:32768
ds_read_b64_tr_b16 a[130:131], v16 offset:34816
M v[72:75], a[168:171], a[48:51], 0
M v[72:75], a[172:175], a[52:55], v[72:75]
s_add_u32 s94, s93, 0
buffer_store_dwordx4 v[168:171], v1, s[16:19], s94 offen offset:1024 sc1
M v[76:79], a[172:175], a[60:63], 0
buffer_load_dwordx4 v8, s[12:15], s24 offen offset:2048 lds
M v[76:79], a[168:171], a[56:59], v[76:79]
ds_read_b64_tr_b16 a[136:137], v17 offset:32768
ds_read_b64_tr_b16 a[138:139], v17 offset:34816
M v[80:83], a[168:171], a[64:67], 0
M v[80:83], a[172:175], a[68:71], v[80:83]
M v[84:87], a[172:175], a[76:79], 0
buffer_load_dwordx4 v9, s[12:15], s24 offen offset:3072 lds
M v[84:87], a[168:171], a[72:75], v[84:87]
ds_read_b64_tr_b16 a[144:145], v18 offset:32768
ds_read_b64_tr_b16 a[146:147], v18 offset:34816
M v[88:91], a[168:171], a[80:83], 0
s_add_u32 s94, s93, 0
buffer_store_dwordx4 v[176:179], v1, s[16:19], s94 offen offset:2048 sc1
M v[88:91], a[172:175], a[84:87], v[88:91]
M v[92:95], a[172:175], a[92:95], 0
M v[92:95], a[168:171], a[88:91], v[92:95]
s_waitcnt lgkmcnt(15)
ds_read_b64_tr_b16 a[152:153], v19 offset:32768
ds_read_b64_tr_b16 a[154:155], v19 offset:34816
M v[96:99], a[176:179], a[32:35], 0
s_add_u32 s24, s24, 262144
s_cmp_eq_u32 s24, s27
s_cselect_b32 s24, s28, s24
s_sub_u32 s6, s6, 1
s_cmp_eq_u32 s6, 0
s_cselect_b64 s[12:13], s[64:65], s[12:13]
v_accvgpr_read_b32 v24, a8
v_accvgpr_read_b32 v25, a9
M v[96:99], a[180:183], a[36:39], v[96:99]
v_accvgpr_read_b32 v26, a10
v_accvgpr_read_b32 v27, a11
M v[100:103], a[180:183], a[44:47], 0
v_accvgpr_read_b32 v28, a12
v_accvgpr_read_b32 v29, a13
M v[100:103], a[176:179], a[40:43], v[100:103]
s_add_u32 s94, s93, 0
buffer_store_dwordx4 v[184:187], v1, s[16:19], s94 offen offset:3072 sc1
v_accvgpr_read_b32 v30, a14
v_accvgpr_read_b32 v31, a15
M v[104:107], a[176:179], a[48:51], 0
v_cvt_pk_bf16_f32 v24, v24, v25
v_cvt_pk_bf16_f32 v25, v26, v27
M v[104:107], a[180:183], a[52:55], v[104:107]
v_cvt_pk_bf16_f32 v26, v28, v29
v_cvt_pk_bf16_f32 v27, v30, v31
M v[108:111], a[180:183], a[60:63], 0
M v[108:111], a[176:179], a[56:59], v[108:111]
s_waitcnt vmcnt(37) lgkmcnt(0)
s_barrier
ds_read_b128 a[160:163], v10 offset:16384
ds_read_b128 a[164:167], v11 offset:16384
M v[112:115], a[176:179], a[64:67], 0
s_add_u32 m0, s29, 0
s_nop 0
buffer_load_dwordx4 v2, s[8:11], s23 offen offset:0 lds
M v[112:115], a[180:183], a[68:71], v[112:115]
s_add_u32 s94, s93, 12288
buffer_store_dwordx4 v[24:27], v1, s[16:19], s94 offen offset:1024 sc1
M v[116:119], a[180:183], a[76:79], 0
s_add_u32 s94, s93, 4096
buffer_store_dwordx4 v[192:195], v1, s[16:19], s94 offen offset:0 sc1
M v[116:119], a[176:179], a[72:75], v[116:119]
ds_read_b64_tr_b16 a[100:101], v12 offset:49152
ds_read_b64_tr_b16 a[102:103], v12 offset:51200
M v[120:123], a[176:179], a[80:83], 0
M v[120:123], a[180:183], a[84:87], v[120:123]
M v[124:127], a[180:183], a[92:95], 0
M v[124:127], a[176:179], a[88:91], v[124:127]
M v[128:131], a[184:187], a[32:35], 0
buffer_load_dwordx4 v3, s[8:11], s23 offen offset:1024 lds
M v[128:131], a[188:191], a[36:39], v[128:131]
ds_read_b128 a[168:171], v10 offset:18432
ds_read_b128 a[172:175], v11 offset:18432
ds_read_b64_tr_b16 a[108:109], v13 offset:49152
ds_read_b64_tr_b16 a[110:111], v13 offset:51200
M v[132:135], a[188:191], a[44:47], 0
s_add_u32 s94, s93, 4096
buffer_store_dwordx4 v[200:203], v1, s[16:19], s94 offen offset:1024 sc1
M v[132:135], a[184:187], a[40:43], v[132:135]
M v[136:139], a[184:187], a[48:51], 0
M v[136:139], a[188:191], a[52:55], v[136:139]
M v[140:143], a[188:191], a[60:63], 0
buffer_load_dwordx4 v4, s[8:11], s23 offen offset:2048 lds
M v[140:143], a[184:187], a[56:59], v[140:143]
ds_read_b64_tr_b16 a[116:117], v14 offset:49152
ds_read_b64_tr_b16 a[118:119], v14 offset:51200
M v[144:147], a[184:187], a[64:67], 0
s_add_u32 s94, s93, 4096
buffer_store_dwordx4 v[208:211], v1, s[16:19], s94 offen offset:2048 sc1
M v[144:147], a[188:191], a[68:71], v[144:147]
M v[148:151], a[188:191], a[76:79], 0
v_accvgpr_read_b32 v24, a16
v_accvgpr_read_b32 v25, a17
M v[148:151], a[184:187], a[72:75], v[148:151]
v_accvgpr_read_b32 v26, a18
v_accvgpr_read_b32 v27, a19
M v[152:155], a[184:187], a[80:83], 0
buffer_load_dwordx4 v5, s[8:11], s23 offen offset:3072 lds
v_accvgpr_read_b32 v28, a20
v_accvgpr_read_b32 v29, a21
M v[152:155], a[188:191], a[84:87], v[152:155]
ds_read_b64_tr_b16 a[124:125], v15 offset:49152
ds_read_b64_tr_b16 a[126:127], v15 offset:51200
v_accvgpr_read_b32 v30, a22
v_accvgpr_read_b32 v31, a23
M v[156:159], a[188:191], a[92:95], 0
v_cvt_pk_bf16_f32 v24, v24, v25
v_cvt_pk_bf16_f32 v25, v26, v27
M v[156:159], a[184:187], a[88:91], v[156:159]
s_add_u32 s94, s93, 4096
buffer_store_dwordx4 v[216:219], v1, s[16:19], s94 offen offset:3072 sc1
s_waitcnt lgkmcnt(10)
v_cvt_pk_bf16_f32 v26, v28, v29
v_cvt_pk_bf16_f32 v27, v30, v31
M v[160:163], a[160:163], a[32:35], 0
M v[160:163], a[164:167], a[36:39], v[160:163]
ds_read_b128 a[176:179], v10 offset:20480
ds_read_b128 a[180:183], v11 offset:20480
M v[164:167], a[164:167], a[44:47], 0
M v[164:167], a[160:163], a[40:43], v[164:167]
ds_read_b64_tr_b16 a[132:133], v16 offset:49152
ds_read_b64_tr_b16 a[134:135], v16 offset:51200
M v[168:171], a[160:163], a[48:51], 0
s_add_u32 s94, s93, 12288
buffer_store_dwordx4 v[24:27], v1, s[16:19], s94 offen offset:2048 sc1
M v[168:171], a[164:167], a[52:55], v[168:171]
s_add_u32 m0, s29, 98304
s_nop 0
buffer_load_dwordx4 v6, s[12:15], s24 offen offset:0 lds
M v[172:175], a[164:167], a[60:63], 0
s_add_u32 s94, s93, 8192
buffer_store_dwordx4 v[224:227], v1, s[16:19], s94 offen offset:0 sc1
M v[172:175], a[160:163], a[56:59], v[172:175]
M v[176:179], a[160:163], a[64:67], 0
M v[176:179], a[164:167], a[68:71], v[176:179]
ds_read_b64_tr_b16 a[140:141], v17 offset:49152
ds_read_b64_tr_b16 a[142:143], v17 offset:51200
M v[180:183], a[164:167], a[76:79], 0
M v[180:183], a[160:163], a[72:75], v[180:183]
M v[184:187], a[160:163], a[80:83], 0
buffer_load_dwordx4 v7, s[12:15], s24 offen offset:1024 lds
M v[184:187], a[164:167], a[84:87], v[184:187]
s_add_u32 s94, s93, 8192
buffer_store_dwordx4 v[232:235], v1, s[16:19], s94 offen offset:1024 sc1
M v[188:191], a[164:167], a[92:95], 0
M v[188:191], a[160:163], a[88:91], v[188:191]
s_waitcnt lgkmcnt(12)
ds_read_b64_tr_b16 a[148:149], v18 offset:49152
ds_read_b64_tr_b16 a[150:151], v18 offset:51200
M v[192:195], a[168:171], a[32:35], 0
M v[192:195], a[172:175], a[36:39], v[192:195]
ds_read_b128 a[184:187], v10 offset:22528
ds_read_b128 a[188:191], v11 offset:22528
M v[196:199], a[172:175], a[44:47], 0
M v[196:199], a[168:171], a[40:43], v[196:199]
buffer_load_dwordx4 v8, s[12:15], s24 offen offset:2048 lds
M v[200:203], a[168:171], a[48:51], 0
s_add_u32 s94, s93, 8192
buffer_store_dwordx4 v[240:243], v1, s[16:19], s94 offen offset:2048 sc1
v_accvgpr_read_b32 v24, a24
v_accvgpr_read_b32 v25, a25
M v[200:203], a[172:175], a[52:55], v[200:203]
ds_read_b64_tr_b16 a[156:157], v19 offset:49152
ds_read_b64_tr_b16 a[158:159], v19 offset:51200
v_accvgpr_read_b32 v26, a26
v_accvgpr_read_b32 v27, a27
M v[204:207], a[172:175], a[60:63], 0
v_accvgpr_read_b32 v28, a28
v_accvgpr_read_b32 v29, a29
M v[204:207], a[168:171], a[56:59], v[204:207]
v_accvgpr_read_b32 v30, a30
v_accvgpr_read_b32 v31, a31
M v[208:211], a[168:171], a[64:67], 0
v_cvt_pk_bf16_f32 v24, v24, v25
v_cvt_pk_bf16_f32 v25, v26, v27
M v[208:211], a[172:175], a[68:71], v[208:211]
buffer_load_dwordx4 v9, s[12:15], s24 offen offset:3072 lds
v_cvt_pk_bf16_f32 v26, v28, v29
v_cvt_pk_bf16_f32 v27, v30, v31
M v[212:215], a[172:175], a[76:79], 0
M v[212:215], a[168:171], a[72:75], v[212:215]
s_add_u32 s94, s93, 8192
buffer_store_dwordx4 v[248:251], v1, s[16:19], s94 offen offset:3072 sc1
M v[216:219], a[168:171], a[80:83], 0
M v[216:219], a[172:175], a[84:87], v[216:219]
s_add_u32 s94, s93, 12288
buffer_store_dwordx4 v[24:27], v1, s[16:19], s94 offen offset:3072 sc1
M v[220:223], a[172:175], a[92:95], 0
M v[220:223], a[168:171], a[88:91], v[220:223]
s_waitcnt lgkmcnt(10)
M v[224:227], a[176:179], a[32:35], 0
s_add_u32 s24, s24, 262144
M v[224:227], a[180:183], a[36:39], v[224:227]
M v[228:231], a[180:183], a[44:47], 0
M v[228:231], a[176:179], a[40:43], v[228:231]
M v[232:235], a[176:179], a[48:51], 0
M v[232:235], a[180:183], a[52:55], v[232:235]
M v[236:239], a[180:183], a[60:63], 0
M v[236:239], a[176:179], a[56:59], v[236:239]
s_waitcnt vmcnt(39) lgkmcnt(0)
s_barrier
ds_read_b128 a[160:163], v10 offset:32768
ds_read_b128 a[164:167], v11 offset:32768
M v[240:243], a[176:179], a[64:67], 0
s_add_u32 m0, s29, 16384
s_add_u32 s3, s23, s31
buffer_load_dwordx4 v2, s[8:11], s3 offen offset:0 lds
M v[240:243], a[180:183], a[68:71], v[240:243]
M v[244:247], a[180:183], a[76:79], 0
M v[244:247], a[176:179], a[72:75], v[244:247]
M v[248:251], a[176:179], a[80:83], 0
M v[248:251], a[180:183], a[84:87], v[248:251]
buffer_load_dwordx4 v3, s[8:11], s3 offen offset:1024 lds
M v[252:255], a[180:183], a[92:95], 0
M v[252:255], a[176:179], a[88:91], v[252:255]
M a[0:3], a[184:187], a[32:35], 0
M a[0:3], a[188:191], a[36:39], a[0:3]
ds_read_b128 a[168:171], v10 offset:34816
ds_read_b128 a[172:175], v11 offset:34816
M a[4:7], a[188:191], a[44:47], 0
M a[4:7], a[184:187], a[40:43], a[4:7]
M a[8:11], a[184:187], a[48:51], 0
buffer_load_dwordx4 v4, s[8:11], s3 offen offset:2048 lds
M a[8:11], a[188:191], a[52:55], a[8:11]
M a[12:15], a[188:191], a[60:63], 0
M a[12:15], a[184:187], a[56:59], a[12:15]
M a[16:19], a[184:187], a[64:67], 0
M a[16:19], a[188:191], a[68:71], a[16:19]
buffer_load_dwordx4 v5, s[8:11], s3 offen offset:3072 lds
M a[20:23], a[188:191], a[76:79], 0
M a[20:23], a[184:187], a[72:75], a[20:23]
M a[24:27], a[184:187], a[80:83], 0
M a[24:27], a[188:191], a[84:87], a[24:27]
M a[28:31], a[188:191], a[92:95], 0
M a[28:31], a[184:187], a[88:91], a[28:31]
s_waitcnt lgkmcnt(2)
M v[32:35], a[160:163], a[96:99], v[32:35]
s_add_u32 s23, s23, 128
s_cmp_eq_u32 s23, s25
s_cselect_b32 s23, s26, s23
M v[32:35], a[164:167], a[100:103], v[32:35]
ds_read_b128 a[176:179], v10 offset:36864
ds_read_b128 a[180:183], v11 offset:36864
M v[36:39], a[164:167], a[108:111], v[36:39]
M v[36:39], a[160:163], a[104:107], v[36:39]
ds_read_b64_tr_b16 a[32:33], v12 offset:0
ds_read_b64_tr_b16 a[34:35], v12 offset:2048
M v[40:43], a[160:163], a[112:115], v[40:43]
M v[40:43], a[164:167], a[116:119], v[40:43]
M v[44:47], a[164:167], a[124:127], v[44:47]
s_add_u32 m0, s29, 114688
s_nop 0
buffer_load_dwordx4 v6, s[12:15], s24 offen offset:0 lds
M v[44:47], a[160:163], a[120:123], v[44:47]
ds_read_b64_tr_b16 a[40:41], v13 offset:0
ds_read_b64_tr_b16 a[42:43], v13 offset:2048
M v[48:51], a[160:163], a[128:131], v[48:51]
M v[48:51], a[164:167], a[132:135], v[48:51]
M v[52:55], a[164:167], a[140:143], v[52:55]
M v[52:55], a[160:163], a[136:139], v[52:55]
ds_read_b64_tr_b16 a[48:49], v14 offset:0
ds_read_b64_tr_b16 a[50:51], v14 offset:2048
M v[56:59], a[160:163], a[144:147], v[56:59]
M v[56:59], a[164:167], a[148:151], v[56:59]
buffer_load_dwordx4 v7, s[12:15], s24 offen offset:1024 lds
M v[60:63], a[164:167], a[156:159], v[60:63]
M v[60:63], a[160:163], a[152:155], v[60:63]
s_waitcnt lgkmcnt(8)
ds_read_b64_tr_b16 a[56:57], v15 offset:0
ds_read_b64_tr_b16 a[58:59], v15 offset:2048
M v[64:67], a[168:171], a[96:99], v[64:67]
M v[64:67], a[172:175], a[100:103], v[64:67]
ds_read_b128 a[184:187], v10 offset:38912
ds_read_b128 a[188:191], v11 offset:38912
M v[68:71], a[172:175], a[108:111], v[68:71]
M v[68:71], a[168:171], a[104:107], v[68:71]
ds_read_b64_tr_b16 a[64:65], v16 offset:0
ds_read_b64_tr_b16 a[66:67], v16 offset:2048
M v[72:75], a[168:171], a[112:115], v[72:75]
buffer_load_dwordx4 v8, s[12:15], s24 offen offset:2048 lds
M v[72:75], a[172:175], a[116:119], v[72:75]
M v[76:79], a[172:175], a[124:127], v[76:79]
M v[76:79], a[168:171], a[120:123], v[76:79]
ds_read_b64_tr_b16 a[72:73], v17 offset:0
ds_read_b64_tr_b16 a[74:75], v17 offset:2048
M v[80:83], a[168:171], a[128:131], v[80:83]
M v[80:83], a[172:175], a[132:135], v[80:83]
M v[84:87], a[172:175], a[140:143], v[84:87]
buffer_load_dwordx4 v9, s[12:15], s24 offen offset:3072 lds
M v[84:87], a[168:171], a[136:139], v[84:87]
ds_read_b64_tr_b16 a[80:81], v18 offset:0
ds_read_b64_tr_b16 a[82:83], v18 offset:2048
M v[88:91], a[168:171], a[144:147], v[88:91]
M v[88:91], a[172:175], a[148:151], v[88:91]
M v[92:95], a[172:175], a[156:159], v[92:95]
M v[92:95], a[168:171], a[152:155], v[92:95]
s_waitcnt lgkmcnt(15)
ds_read_b64_tr_b16 a[88:89], v19 offset:0
ds_read_b64_tr_b16 a[90:91], v19 offset:2048
M v[96:99], a[176:179], a[96:99], v[96:99]
s_add_u32 s24, s24, 262144
s_cmp_eq_u32 s24, s27
s_cselect_b32 s24, s28, s24
s_sub_u32 s6, s6, 1
s_cmp_eq_u32 s6, 0
s_cselect_b64 s[12:13], s[64:65], s[12:13]
M v[96:99], a[180:183], a[100:103], v[96:99]
M v[100:103], a[180:183], a[108:111], v[100:103]
M v[100:103], a[176:179], a[104:107], v[100:103]
M v[104:107], a[176:179], a[112:115], v[104:107]
M v[104:107], a[180:183], a[116:119], v[104:107]
M v[108:111], a[180:183], a[124:127], v[108:111]
M v[108:111], a[176:179], a[120:123], v[108:111]
s_waitcnt vmcnt(29) lgkmcnt(0)
s_barrier
ds_read_b128 a[160:163], v10 offset:49152
ds_read_b128 a[164:167], v11 offset:49152
M v[112:115], a[176:179], a[128:131], v[112:115]
s_add_u32 m0, s29, 32768
s_nop 0
buffer_load_dwordx4 v2, s[8:11], s23 offen offset:0 lds
M v[112:115], a[180:183], a[132:135], v[112:115]
M v[116:119], a[180:183], a[140:143], v[116:119]
M v[116:119], a[176:179], a[136:139], v[116:119]
ds_read_b64_tr_b16 a[36:37], v12 offset:16384
ds_read_b64_tr_b16 a[38:39], v12 offset:18432
M v[120:123], a[176:179], a[144:147], v[120:123]
M v[120:123], a[180:183], a[148:151], v[120:123]
M v[124:127], a[180:183], a[156:159], v[124:127]
buffer_load_dwordx4 v3, s[8:11], s23 offen offset:1024 lds
M v[124:127], a[176:179], a[152:155], v[124:127]
M v[128:131], a[184:187], a[96:99], v[128:131]
M v[128:131], a[188:191], a[100:103], v[128:131]
ds_read_b128 a[168:171], v10 offset:51200
ds_read_b128 a[172:175], v11 offset:51200
ds_read_b64_tr_b16 a[44:45], v13 offset:16384
ds_read_b64_tr_b16 a[46:47], v13 offset:18432
M v[132:135], a[188:191], a[108:111], v[132:135]
M v[132:135], a[184:187], a[104:107], v[132:135]
M v[136:139], a[184:187], a[112:115], v[136:139]
M v[136:139], a[188:191], a[116:119], v[136:139]
buffer_load_dwordx4 v4, s[8:11], s23 offen offset:2048 lds
M v[140:143], a[188:191], a[124:127], v[140:143]
M v[140:143], a[184:187], a[120:123], v[140:143]
ds_read_b64_tr_b16 a[52:53], v14 offset:16384
ds_read_b64_tr_b16 a[54:55], v14 offset:18432
M v[144:147], a[184:187], a[128:131], v[144:147]
M v[144:147], a[188:191], a[132:135], v[144:147]
M v[148:151], a[188:191], a[140:143], v[148:151]
M v[148:151], a[184:187], a[136:139], v[148:151]
M v[152:155], a[184:187], a[144:147], v[152:155]
buffer_load_dwordx4 v5, s[8:11], s23 offen offset:3072 lds
M v[152:155], a[188:191], a[148:151], v[152:155]
ds_read_b64_tr_b16 a[60:61], v15 offset:16384
ds_read_b64_tr_b16 a[62:63], v15 offset:18432
M v[156:159], a[188:191], a[156:159], v[156:159]
M v[156:159], a[184:187], a[152:155], v[156:159]
s_waitcnt lgkmcnt(10)
M v[160:163], a[160:163], a[96:99], v[160:163]
M v[160:163], a[164:167], a[100:103], v[160:163]
ds_read_b128 a[176:179], v10 offset:53248
ds_read_b128 a[180:183], v11 offset:53248
M v[164:167], a[164:167], a[108:111], v[164:167]
M v[164:167], a[160:163], a[104:107], v[164:167]
ds_read_b64_tr_b16 a[68:69], v16 offset:16384
ds_read_b64_tr_b16 a[70:71], v16 offset:18432
M v[168:171], a[160:163], a[112:115], v[168:171]
M v[168:171], a[164:167], a[116:119], v[168:171]
s_add_u32 m0, s29, 65536
s_nop 0
buffer_load_dwordx4 v6, s[12:15], s24 offen offset:0 lds
M v[172:175], a[164:167], a[124:127], v[172:175]
M v[172:175], a[160:163], a[120:123], v[172:175]
M v[176:179], a[160:163], a[128:131], v[176:179]
M v[176:179], a[164:167], a[132:135], v[176:179]
ds_read_b64_tr_b16 a[76:77], v17 offset:16384
ds_read_b64_tr_b16 a[78:79], v17 offset:18432
M v[180:183], a[164:167], a[140:143], v[180:183]
M v[180:183], a[160:163], a[136:139], v[180:183]
buffer_load_dwordx4 v7, s[12:15], s24 offen offset:1024 lds
M v[184:187], a[160:163], a[144:147], v[184:187]
M v[184:187], a[164:167], a[148:151], v[184:187]
M v[188:191], a[164:167], a[156:159], v[188:191]
M v[188:191], a[160:163], a[152:155], v[188:191]
s_waitcnt lgkmcnt(12)
ds_read_b64_tr_b16 a[84:85], v18 offset:16384
ds_read_b64_tr_b16 a[86:87], v18 offset:18432
M v[192:195], a[168:171], a[96:99], v[192:195]
M v[192:195], a[172:175], a[100:103], v[192:195]
ds_read_b128 a[184:187], v10 offset:55296
ds_read_b128 a[188:191], v11 offset:55296
M v[196:199], a[172:175], a[108:111], v[196:199]
M v[196:199], a[168:171], a[104:107], v[196:199]
buffer_load_dwordx4 v8, s[12:15], s24 offen offset:2048 lds
M v[200:203], a[168:171], a[112:115], v[200:203]
M v[200:203], a[172:175], a[116:119], v[200:203]
ds_read_b64_tr_b16 a[92:93], v19 offset:16384
ds_read_b64_tr_b16 a[94:95], v19 offset:18432
M v[204:207], a[172:175], a[124:127], v[204:207]
M v[204:207], a[168:171], a[120:123], v[204:207]
M v[208:211], a[168:171], a[128:131], v[208:211]
M v[208:211], a[172:175], a[132:135], v[208:211]
buffer_load_dwordx4 v9, s[12:15], s24 offen offset:3072 lds
M v[212:215], a[172:175], a[140:143], v[212:215]
M v[212:215], a[168:171], a[136:139], v[212:215]
M v[216:219], a[168:171], a[144:147], v[216:219]
M v[216:219], a[172:175], a[148:151], v[216:219]
M v[220:223], a[172:175], a[156:159], v[220:223]
s_add_u32 s24, s24, 262144
M v[220:223], a[168:171], a[152:155], v[220:223]
s_waitcnt lgkmcnt(10)
M v[224:227], a[176:179], a[96:99], v[224:227]
M v[224:227], a[180:183], a[100:103], v[224:227]
M v[228:231], a[180:183], a[108:111], v[228:231]
M v[228:231], a[176:179], a[104:107], v[228:231]
M v[232:235], a[176:179], a[112:115], v[232:235]
M v[232:235], a[180:183], a[116:119], v[232:235]
M v[236:239], a[180:183], a[124:127], v[236:239]
M v[236:239], a[176:179], a[120:123], v[236:239]
s_waitcnt vmcnt(18) lgkmcnt(0)
s_barrier
ds_read_b128 a[160:163], v10 offset:0
ds_read_b128 a[164:167], v11 offset:0
M v[240:243], a[176:179], a[128:131], v[240:243]
s_add_u32 m0, s29, 49152
s_add_u32 s3, s23, s31
buffer_load_dwordx4 v2, s[8:11], s3 offen offset:0 lds
M v[240:243], a[180:183], a[132:135], v[240:243]
M v[244:247], a[180:183], a[140:143], v[244:247]
M v[244:247], a[176:179], a[136:139], v[244:247]
M v[248:251], a[176:179], a[144:147], v[248:251]
M v[248:251], a[180:183], a[148:151], v[248:251]
buffer_load_dwordx4 v3, s[8:11], s3 offen offset:1024 lds
M v[252:255], a[180:183], a[156:159], v[252:255]
M v[252:255], a[176:179], a[152:155], v[252:255]
M a[0:3], a[184:187], a[96:99], a[0:3]
M a[0:3], a[188:191], a[100:103], a[0:3]
ds_read_b128 a[168:171], v10 offset:2048
ds_read_b128 a[172:175], v11 offset:2048
M a[4:7], a[188:191], a[108:111], a[4:7]
M a[4:7], a[184:187], a[104:107], a[4:7]
M a[8:11], a[184:187], a[112:115], a[8:11]
buffer_load_dwordx4 v4, s[8:11], s3 offen offset:2048 lds
M a[8:11], a[188:191], a[116:119], a[8:11]
M a[12:15], a[188:191], a[124:127], a[12:15]
M a[12:15], a[184:187], a[120:123], a[12:15]
M a[16:19], a[184:187], a[128:131], a[16:19]
M a[16:19], a[188:191], a[132:135], a[16:19]
buffer_load_dwordx4 v5, s[8:11], s3 offen offset:3072 lds
M a[20:23], a[188:191], a[140:143], a[20:23]
M a[20:23], a[184:187], a[136:139], a[20:23]
M a[24:27], a[184:187], a[144:147], a[24:27]
M a[24:27], a[188:191], a[148:151], a[24:27]
M a[28:31], a[188:191], a[156:159], a[28:31]
M a[28:31], a[184:187], a[152:155], a[28:31]
s_waitcnt lgkmcnt(2)
M v[32:35], a[160:163], a[32:35], v[32:35]
s_add_u32 s23, s23, 128
s_cmp_eq_u32 s23, s25
s_cselect_b32 s23, s26, s23
M v[32:35], a[164:167], a[36:39], v[32:35]
ds_read_b128 a[176:179], v10 offset:4096
ds_read_b128 a[180:183], v11 offset:4096
M v[36:39], a[164:167], a[44:47], v[36:39]
M v[36:39], a[160:163], a[40:43], v[36:39]
ds_read_b64_tr_b16 a[96:97], v12 offset:32768
ds_read_b64_tr_b16 a[98:99], v12 offset:34816
M v[40:43], a[160:163], a[48:51], v[40:43]
M v[40:43], a[164:167], a[52:55], v[40:43]
M v[44:47], a[164:167], a[60:63], v[44:47]
s_add_u32 m0, s29, 81920
s_nop 0
buffer_load_dwordx4 v6, s[12:15], s24 offen offset:0 lds
M v[44:47], a[160:163], a[56:59], v[44:47]
ds_read_b64_tr_b16 a[104:105], v13 offset:32768
ds_read_b64_tr_b16 a[106:107], v13 offset:34816
M v[48:51], a[160:163], a[64:67], v[48:51]
M v[48:51], a[164:167], a[68:71], v[48:51]
M v[52:55], a[164:167], a[76:79], v[52:55]
M v[52:55], a[160:163], a[72:75], v[52:55]
ds_read_b64_tr_b16 a[112:113], v14 offset:32768
ds_read_b64_tr_b16 a[114:115], v14 offset:34816
M v[56:59], a[160:163], a[80:83], v[56:59]
M v[56:59], a[164:167], a[84:87], v[56:59]
buffer_load_dwordx4 v7, s[12:15], s24 offen offset:1024 lds
M v[60:63], a[164:167], a[92:95], v[60:63]
M v[60:63], a[160:163], a[88:91], v[60:63]
s_waitcnt lgkmcnt(8)
ds_read_b64_tr_b16 a[120:121], v15 offset:32768
ds_read_b64_tr_b16 a[122:123], v15 offset:34816
M v[64:67], a[168:171], a[32:35], v[64:67]
M v[64:67], a[172:175], a[36:39], v[64:67]
ds_read_b128 a[184:187], v10 offset:6144
ds_read_b128 a[188:191], v11 offset:6144
M v[68:71], a[172:175], a[44:47], v[68:71]
M v[68:71], a[168:171], a[40:43], v[68:71]
ds_read_b64_tr_b16 a[128:129], v16 offset:32768
ds_read_b64_tr_b16 a[130:131], v16 offset:34816
M v[72:75], a[168:171], a[48:51], v[72:75]
buffer_load_dwordx4 v8, s[12:15], s24 offen offset:2048 lds
M v[72:75], a[172:175], a[52:55], v[72:75]
M v[76:79], a[172:175], a[60:63], v[76:79]
M v[76:79], a[168:171], a[56:59], v[76:79]
ds_read_b64_tr_b16 a[136:137], v17 offset:32768
ds_read_b64_tr_b16 a[138:139], v17 offset:34816
M v[80:83], a[168:171], a[64:67], v[80:83]
M v[80:83], a[172:175], a[68:71], v[80:83]
M v[84:87], a[172:175], a[76:79], v[84:87]
buffer_load_dwordx4 v9, s[12:15], s24 offen offset:3072 lds
M v[84:87], a[168:171], a[72:75], v[84:87]
ds_read_b64_tr_b16 a[144:145], v18 offset:32768
ds_read_b64_tr_b16 a[146:147], v18 offset:34816
M v[88:91], a[168:171], a[80:83], v[88:91]
M v[88:91], a[172:175], a[84:87], v[88:91]
M v[92:95], a[172:175], a[92:95], v[92:95]
M v[92:95], a[168:171], a[88:91], v[92:95]
s_waitcnt lgkmcnt(15)
ds_read_b64_tr_b16 a[152:153], v19 offset:32768
ds_read_b64_tr_b16 a[154:155], v19 offset:34816
M v[96:99], a[176:179], a[32:35], v[96:99]
s_add_u32 s24, s24, 262144
s_cmp_eq_u32 s24, s27
s_cselect_b32 s24, s28, s24
s_sub_u32 s6, s6, 1
s_cmp_eq_u32 s6, 0
s_cselect_b64 s[12:13], s[64:65], s[12:13]
M v[96:99], a[180:183], a[36:39], v[96:99]
M v[100:103], a[180:183], a[44:47], v[100:103]
M v[100:103], a[176:179], a[40:43], v[100:103]
M v[104:107], a[176:179], a[48:51], v[104:107]
M v[104:107], a[180:183], a[52:55], v[104:107]
M v[108:111], a[180:183], a[60:63], v[108:111]
M v[108:111], a[176:179], a[56:59], v[108:111]
s_waitcnt vmcnt(16) lgkmcnt(0)
s_barrier
ds_read_b128 a[160:163], v10 offset:16384
ds_read_b128 a[164:167], v11 offset:16384
M v[112:115], a[176:179], a[64:67], v[112:115]
s_add_u32 m0, s29, 0
s_nop 0
buffer_load_dwordx4 v2, s[8:11], s23 offen offset:0 lds
M v[112:115], a[180:183], a[68:71], v[112:115]
M v[116:119], a[180:183], a[76:79], v[116:119]
M v[116:119], a[176:179], a[72:75], v[116:119]
ds_read_b64_tr_b16 a[100:101], v12 offset:49152
ds_read_b64_tr_b16 a[102:103], v12 offset:51200
M v[120:123], a[176:179], a[80:83], v[120:123]
M v[120:123], a[180:183], a[84:87], v[120:123]
M v[124:127], a[180:183], a[92:95], v[124:127]
buffer_load_dwordx4 v3, s[8:11], s23 offen offset:1024 lds
M v[124:127], a[176:179], a[88:91], v[124:127]
M v[128:131], a[184:187], a[32:35], v[128:131]
M v[128:131], a[188:191], a[36:39], v[128:131]
ds_read_b128 a[168:171], v10 offset:18432
ds_read_b128 a[172:175], v11 offset:18432
ds_read_b64_tr_b16 a[108:109], v13 offset:49152
ds_read_b64_tr_b16 a[110:111], v13 offset:51200
M v[132:135], a[188:191], a[44:47], v[132:135]
M v[132:135], a[184:187], a[40:43], v[132:135]
M v[136:139], a[184:187], a[48:51], v[136:139]
M v[136:139], a[188:191], a[52:55], v[136:139]
buffer_load_dwordx4 v4, s[8:11], s23 offen offset:2048 lds
M v[140:143], a[188:191], a[60:63], v[140:143]
M v[140:143], a[184:187], a[56:59], v[140:143]
ds_read_b64_tr_b16 a[116:117], v14 offset:49152
ds_read_b64_tr_b16 a[118:119], v14 offset:51200
M v[144:147], a[184:187], a[64:67], v[144:147]
M v[144:147], a[188:191], a[68:71], v[144:147]
M v[148:151], a[188:191], a[76:79], v[148:151]
M v[148:151], a[184:187], a[72:75], v[148:151]
M v[152:155], a[184:187], a[80:83], v[152:155]
buffer_load_dwordx4 v5, s[8:11], s23 offen offset:3072 lds
M v[152:155], a[188:191], a[84:87], v[152:155]
ds_read_b64_tr_b16 a[124:125], v15 offset:49152
ds_read_b64_tr_b16 a[126:127], v15 offset:51200
M v[156:159], a[188:191], a[92:95], v[156:159]
M v[156:159], a[184:187], a[88:91], v[156:159]
s_waitcnt lgkmcnt(10)
M v[160:163], a[160:163], a[32:35], v[160:163]
M v[160:163], a[164:167], a[36:39], v[160:163]
ds_read_b128 a[176:179], v10 offset:20480
ds_read_b128 a[180:183], v11 offset:20480
M v[164:167], a[164:167], a[44:47], v[164:167]
M v[164:167], a[160:163], a[40:43], v[164:167]
ds_read_b64_tr_b16 a[132:133], v16 offset:49152
ds_read_b64_tr_b16 a[134:135], v16 offset:51200
M v[168:171], a[160:163], a[48:51], v[168:171]
M v[168:171], a[164:167], a[52:55], v[168:171]
s_add_u32 m0, s29, 98304
s_nop 0
buffer_load_dwordx4 v6, s[12:15], s24 offen offset:0 lds
M v[172:175], a[164:167], a[60:63], v[172:175]
M v[172:175], a[160:163], a[56:59], v[172:175]
M v[176:179], a[160:163], a[64:67], v[176:179]
M v[176:179], a[164:167], a[68:71], v[176:179]
ds_read_b64_tr_b16 a[140:141], v17 offset:49152
ds_read_b64_tr_b16 a[142:143], v17 offset:51200
M v[180:183], a[164:167], a[76:79], v[180:183]
M v[180:183], a[160:163], a[72:75], v[180:183]
buffer_load_dwordx4 v7, s[12:15], s24 offen offset:1024 lds
M v[184:187], a[160:163], a[80:83], v[184:187]
M v[184:187], a[164:167], a[84:87], v[184:187]
M v[188:191], a[164:167], a[92:95], v[188:191]
M v[188:191], a[160:163], a[88:91], v[188:191]
s_waitcnt lgkmcnt(12)
ds_read_b64_tr_b16 a[148:149], v18 offset:49152
ds_read_b64_tr_b16 a[150:151], v18 offset:51200
M v[192:195], a[168:171], a[32:35], v[192:195]
M v[192:195], a[172:175], a[36:39], v[192:195]
ds_read_b128 a[184:187], v10 offset:22528
ds_read_b128 a[188:191], v11 offset:22528
M v[196:199], a[172:175], a[44:47], v[196:199]
M v[196:199], a[168:171], a[40:43], v[196:199]
buffer_load_dwordx4 v8, s[12:15], s24 offen offset:2048 lds
M v[200:203], a[168:171], a[48:51], v[200:203]
M v[200:203], a[172:175], a[52:55], v[200:203]
ds_read_b64_tr_b16 a[156:157], v19 offset:49152
ds_read_b64_tr_b16 a[158:159], v19 offset:51200
M v[204:207], a[172:175], a[60:63], v[204:207]
M v[204:207], a[168:171], a[56:59], v[204:207]
M v[208:211], a[168:171], a[64:67], v[208:211]
M v[208:211], a[172:175], a[68:71], v[208:211]
buffer_load_dwordx4 v9, s[12:15], s24 offen offset:3072 lds
M v[212:215], a[172:175], a[76:79], v[212:215]
M v[212:215], a[168:171], a[72:75], v[212:215]
M v[216:219], a[168:171], a[80:83], v[216:219]
M v[216:219], a[172:175], a[84:87], v[216:219]
M v[220:223], a[172:175], a[92:95], v[220:223]
s_add_u32 s24, s24, 262144
M v[220:223], a[168:171], a[88:91], v[220:223]
s_waitcnt lgkmcnt(10)
M v[224:227], a[176:179], a[32:35], v[224:227]
M v[224:227], a[180:183], a[36:39], v[224:227]
M v[228:231], a[180:183], a[44:47], v[228:231]
M v[228:231], a[176:179], a[40:43], v[228:231]
M v[232:235], a[176:179], a[48:51], v[232:235]
M v[232:235], a[180:183], a[52:55], v[232:235]
M v[236:239], a[180:183], a[60:63], v[236:239]
M v[236:239], a[176:179], a[56:59], v[236:239]
s_waitcnt vmcnt(16) lgkmcnt(0)
s_barrier
ds_read_b128 a[160:163], v10 offset:32768
ds_read_b128 a[164:167], v11 offset:32768
M v[240:243], a[176:179], a[64:67], v[240:243]
s_add_u32 m0, s29, 16384
s_add_u32 s3, s23, s31
buffer_load_dwordx4 v2, s[8:11], s3 offen offset:0 lds
M v[240:243], a[180:183], a[68:71], v[240:243]
M v[244:247], a[180:183], a[76:79], v[244:247]
M v[244:247], a[176:179], a[72:75], v[244:247]
M v[248:251], a[176:179], a[80:83], v[248:251]
M v[248:251], a[180:183], a[84:87], v[248:251]
buffer_load_dwordx4 v3, s[8:11], s3 offen offset:1024 lds
M v[252:255], a[180:183], a[92:95], v[252:255]
M v[252:255], a[176:179], a[88:91], v[252:255]
M a[0:3], a[184:187], a[32:35], a[0:3]
M a[0:3], a[188:191], a[36:39], a[0:3]
ds_read_b128 a[168:171], v10 offset:34816
ds_read_b128 a[172:175], v11 offset:34816
M a[4:7], a[188:191], a[44:47], a[4:7]
M a[4:7], a[184:187], a[40:43], a[4:7]
M a[8:11], a[184:187], a[48:51], a[8:11]
buffer_load_dwordx4 v4, s[8:11], s3 offen offset:2048 lds
M a[8:11], a[188:191], a[52:55], a[8:11]
M a[12:15], a[188:191], a[60:63], a[12:15]
M a[12:15], a[184:187], a[56:59], a[12:15]
M a[16:19], a[184:187], a[64:67], a[16:19]
M a[16:19], a[188:191], a[68:71], a[16:19]
buffer_load_dwordx4 v5, s[8:11], s3 offen offset:3072 lds
M a[20:23], a[188:191], a[76:79], a[20:23]
M a[20:23], a[184:187], a[72:75], a[20:23]
M a[24:27], a[184:187], a[80:83], a[24:27]
M a[24:27], a[188:191], a[84:87], a[24:27]
M a[28:31], a[188:191], a[92:95], a[28:31]
M a[28:31], a[184:187], a[88:91], a[28:31]
s_waitcnt lgkmcnt(2)
M v[32:35], a[160:163], a[96:99], v[32:35]
s_add_u32 s23, s23, 128
s_cmp_eq_u32 s23, s25
s_cselect_b32 s23, s26, s23
M v[32:35], a[164:167], a[100:103], v[32:35]
ds_read_b128 a[176:179], v10 offset:36864
ds_read_b128 a[180:183], v11 offset:36864
M v[36:39], a[164:167], a[108:111], v[36:39]
M v[36:39], a[160:163], a[104:107], v[36:39]
ds_read_b64_tr_b16 a[32:33], v12 offset:0
ds_read_b64_tr_b16 a[34:35], v12 offset:2048
M v[40:43], a[160:163], a[112:115], v[40:43]
M v[40:43], a[164:167], a[116:119], v[40:43]
M v[44:47], a[164:167], a[124:127], v[44:47]
s_add_u32 m0, s29, 114688
s_nop 0
buffer_load_dwordx4 v6, s[12:15], s24 offen offset:0 lds
M v[44:47], a[160:163], a[120:123], v[44:47]
ds_read_b64_tr_b16 a[40:41], v13 offset:0
ds_read_b64_tr_b16 a[42:43], v13 offset:2048
M v[48:51], a[160:163], a[128:131], v[48:51]
M v[48:51], a[164:167], a[132:135], v[48:51]
M v[52:55], a[164:167], a[140:143], v[52:55]
M v[52:55], a[160:163], a[136:139], v[52:55]
ds_read_b64_tr_b16 a[48:49], v14 offset:0
ds_read_b64_tr_b16 a[50:51], v14 offset:2048
M v[56:59], a[160:163], a[144:147], v[56:59]
M v[56:59], a[164:167], a[148:151], v[56:59]
buffer_load_dwordx4 v7, s[12:15], s24 offen offset:1024 lds
M v[60:63], a[164:167], a[156:159], v[60:63]
M v[60:63], a[160:163], a[152:155], v[60:63]
s_waitcnt lgkmcnt(8)
ds_read_b64_tr_b16 a[56:57], v15 offset:0
ds_read_b64_tr_b16 a[58:59], v15 offset:2048
M v[64:67], a[168:171], a[96:99], v[64:67]
M v[64:67], a[172:175], a[100:103], v[64:67]
ds_read_b128 a[184:187], v10 offset:38912
ds_read_b128 a[188:191], v11 offset:38912
M v[68:71], a[172:175], a[108:111], v[68:71]
M v[68:71], a[168:171], a[104:107], v[68:71]
ds_read_b64_tr_b16 a[64:65], v16 offset:0
ds_read_b64_tr_b16 a[66:67], v16 offset:2048
M v[72:75], a[168:171], a[112:115], v[72:75]
buffer_load_dwordx4 v8, s[12:15], s24 offen offset:2048 lds
M v[72:75], a[172:175], a[116:119], v[72:75]
M v[76:79], a[172:175], a[124:127], v[76:79]
M v[76:79], a[168:171], a[120:123], v[76:79]
ds_read_b64_tr_b16 a[72:73], v17 offset:0
ds_read_b64_tr_b16 a[74:75], v17 offset:2048
M v[80:83], a[168:171], a[128:131], v[80:83]
M v[80:83], a[172:175], a[132:135], v[80:83]
M v[84:87], a[172:175], a[140:143], v[84:87]
buffer_load_dwordx4 v9, s[12:15], s24 offen offset:3072 lds
M v[84:87], a[168:171], a[136:139], v[84:87]
ds_read_b64_tr_b16 a[80:81], v18 offset:0
ds_read_b64_tr_b16 a[82:83], v18 offset:2048
M v[88:91], a[168:171], a[144:147], v[88:91]
M v[88:91], a[172:175], a[148:151], v[88:91]
M v[92:95], a[172:175], a[156:159], v[92:95]
M v[92:95], a[168:171], a[152:155], v[92:95]
s_waitcnt lgkmcnt(15)
ds_read_b64_tr_b16 a[88:89], v19 offset:0
ds_read_b64_tr_b16 a[90:91], v19 offset:2048
M v[96:99], a[176:179], a[96:99], v[96:99]
s_add_u32 s24, s24, 262144
s_cmp_eq_u32 s24, s27
s_cselect_b32 s24, s28, s24
s_sub_u32 s6, s6, 1
s_cmp_eq_u32 s6, 0
s_cselect_b64 s[12:13], s[64:65], s[12:13]
M v[96:99], a[180:183], a[100:103], v[96:99]
M v[100:103], a[180:183], a[108:111], v[100:103]
M v[100:103], a[176:179], a[104:107], v[100:103]
M v[104:107], a[176:179], a[112:115], v[104:107]
M v[104:107], a[180:183], a[116:119], v[104:107]
M v[108:111], a[180:183], a[124:127], v[108:111]
M v[108:111], a[176:179], a[120:123], v[108:111]
s_waitcnt vmcnt(16) lgkmcnt(0)
s_barrier
ds_read_b128 a[160:163], v10 offset:49152
ds_read_b128 a[164:167], v11 offset:49152
M v[112:115], a[176:179], a[128:131], v[112:115]
s_add_u32 m0, s29, 32768
s_nop 0
buffer_load_dwordx4 v2, s[8:11], s23 offen offset:0 lds
M v[112:115], a[180:183], a[132:135], v[112:115]
M v[116:119], a[180:183], a[140:143], v[116:119]
M v[116:119], a[176:179], a[136:139], v[116:119]
ds_read_b64_tr_b16 a[36:37], v12 offset:16384
ds_read_b64_tr_b16 a[38:39], v12 offset:18432
M v[120:123], a[176:179], a[144:147], v[120:123]
M v[120:123], a[180:183], a[148:151], v[120:123]
M v[124:127], a[180:183], a[156:159], v[124:127]
buffer_load_dwordx4 v3, s[8:11], s23 offen offset:1024 lds
M v[124:127], a[176:179], a[152:155], v[124:127]
M v[128:131], a[184:187], a[96:99], v[128:131]
M v[128:131], a[188:191], a[100:103], v[128:131]
ds_read_b128 a[168:171], v10 offset:51200
ds_read_b128 a[172:175], v11 offset:51200
ds_read_b64_tr_b16 a[44:45], v13 offset:16384
ds_read_b64_tr_b16 a[46:47], v13 offset:18432
M v[132:135], a[188:191], a[108:111], v[132:135]
M v[132:135], a[184:187], a[104:107], v[132:135]
M v[136:139], a[184:187], a[112:115], v[136:139]
M v[136:139], a[188:191], a[116:119], v[136:139]
buffer_load_dwordx4 v4, s[8:11], s23 offen offset:2048 lds
M v[140:143], a[188:191], a[124:127], v[140:143]
M v[140:143], a[184:187], a[120:123], v[140:143]
ds_read_b64_tr_b16 a[52:53], v14 offset:16384
ds_read_b64_tr_b16 a[54:55], v14 offset:18432
M v[144:147], a[184:187], a[128:131], v[144:147]
M v[144:147], a[188:191], a[132:135], v[144:147]
M v[148:151], a[188:191], a[140:143], v[148:151]
M v[148:151], a[184:187], a[136:139], v[148:151]
M v[152:155], a[184:187], a[144:147], v[152:155]
buffer_load_dwordx4 v5, s[8:11], s23 offen offset:3072 lds
M v[152:155], a[188:191], a[148:151], v[152:155]
ds_read_b64_tr_b16 a[60:61], v15 offset:16384
ds_read_b64_tr_b16 a[62:63], v15 offset:18432
M v[156:159], a[188:191], a[156:159], v[156:159]
M v[156:159], a[184:187], a[152:155], v[156:159]
s_waitcnt lgkmcnt(10)
M v[160:163], a[160:163], a[96:99], v[160:163]
M v[160:163], a[164:167], a[100:103], v[160:163]
ds_read_b128 a[176:179], v10 offset:53248
ds_read_b128 a[180:183], v11 offset:53248
M v[164:167], a[164:167], a[108:111], v[164:167]
M v[164:167], a[160:163], a[104:107], v[164:167]
ds_read_b64_tr_b16 a[68:69], v16 offset:16384
ds_read_b64_tr_b16 a[70:71], v16 offset:18432
M v[168:171], a[160:163], a[112:115], v[168:171]
M v[168:171], a[164:167], a[116:119], v[168:171]
s_add_u32 m0, s29, 65536
s_nop 0
buffer_load_dwordx4 v6, s[12:15], s24 offen offset:0 lds
M v[172:175], a[164:167], a[124:127], v[172:175]
M v[172:175], a[160:163], a[120:123], v[172:175]
M v[176:179], a[160:163], a[128:131], v[176:179]
M v[176:179], a[164:167], a[132:135], v[176:179]
ds_read_b64_tr_b16 a[76:77], v17 offset:16384
ds_read_b64_tr_b16 a[78:79], v17 offset:18432
M v[180:183], a[164:167], a[140:143], v[180:183]
M v[180:183], a[160:163], a[136:139], v[180:183]
buffer_load_dwordx4 v7, s[12:15], s24 offen offset:1024 lds
M v[184:187], a[160:163], a[144:147], v[184:187]
M v[184:187], a[164:167], a[148:151], v[184:187]
M v[188:191], a[164:167], a[156:159], v[188:191]
M v[188:191], a[160:163], a[152:155], v[188:191]
s_waitcnt lgkmcnt(12)
ds_read_b64_tr_b16 a[84:85], v18 offset:16384
ds_read_b64_tr_b16 a[86:87], v18 offset:18432
M v[192:195], a[168:171], a[96:99], v[192:195]
M v[192:195], a[172:175], a[100:103], v[192:195]
ds_read_b128 a[184:187], v10 offset:55296
ds_read_b128 a[188:191], v11 offset:55296
M v[196:199], a[172:175], a[108:111], v[196:199]
M v[196:199], a[168:171], a[104:107], v[196:199]
buffer_load_dwordx4 v8, s[12:15], s24 offen offset:2048 lds
M v[200:203], a[168:171], a[112:115], v[200:203]
M v[200:203], a[172:175], a[116:119], v[200:203]
ds_read_b64_tr_b16 a[92:93], v19 offset:16384
ds_read_b64_tr_b16 a[94:95], v19 offset:18432
M v[204:207], a[172:175], a[124:127], v[204:207]
M v[204:207], a[168:171], a[120:123], v[204:207]
M v[208:211], a[168:171], a[128:131], v[208:211]
M v[208:211], a[172:175], a[132:135], v[208:211]
buffer_load_dwordx4 v9, s[12:15], s24 offen offset:3072 lds
M v[212:215], a[172:175], a[140:143], v[212:215]
M v[212:215], a[168:171], a[136:139], v[212:215]
M v[216:219], a[168:171], a[144:147], v[216:219]
M v[216:219], a[172:175], a[148:151], v[216:219]
M v[220:223], a[172:175], a[156:159], v[220:223]
s_add_u32 s24, s24, 262144
M v[220:223], a[168:171], a[152:155], v[220:223]
s_waitcnt lgkmcnt(10)
M v[224:227], a[176:179], a[96:99], v[224:227]
M v[224:227], a[180:183], a[100:103], v[224:227]
M v[228:231], a[180:183], a[108:111], v[228:231]
M v[228:231], a[176:179], a[104:107], v[228:231]
M v[232:235], a[176:179], a[112:115], v[232:235]
M v[232:235], a[180:183], a[116:119], v[232:235]
M v[236:239], a[180:183], a[124:127], v[236:239]
M v[236:239], a[176:179], a[120:123], v[236:239]
s_waitcnt vmcnt(16) lgkmcnt(0)
s_barrier
ds_read_b128 a[160:163], v10 offset:0
ds_read_b128 a[164:167], v11 offset:0
M v[240:243], a[176:179], a[128:131], v[240:243]
s_add_u32 m0, s29, 49152
s_add_u32 s3, s23, s31
buffer_load_dwordx4 v2, s[8:11], s3 offen offset:0 lds
M v[240:243], a[180:183], a[132:135], v[240:243]
M v[244:247], a[180:183], a[140:143], v[244:247]
M v[244:247], a[176:179], a[136:139], v[244:247]
M v[248:251], a[176:179], a[144:147], v[248:251]
M v[248:251], a[180:183], a[148:151], v[248:251]
buffer_load_dwordx4 v3, s[8:11], s3 offen offset:1024 lds
M v[252:255], a[180:183], a[156:159], v[252:255]
M v[252:255], a[176:179], a[152:155], v[252:255]
M a[0:3], a[184:187], a[96:99], a[0:3]
M a[0:3], a[188:191], a[100:103], a[0:3]
ds_read_b128 a[168:171], v10 offset:2048
ds_read_b128 a[172:175], v11 offset:2048
M a[4:7], a[188:191], a[108:111], a[4:7]
M a[4:7], a[184:187], a[104:107], a[4:7]
M a[8:11], a[184:187], a[112:115], a[8:11]
buffer_load_dwordx4 v4, s[8:11], s3 offen offset:2048 lds
M a[8:11], a[188:191], a[116:119], a[8:11]
M a[12:15], a[188:191], a[124:127], a[12:15]
M a[12:15], a[184:187], a[120:123], a[12:15]
M a[16:19], a[184:187], a[128:131], a[16:19]
M a[16:19], a[188:191], a[132:135], a[16:19]
buffer_load_dwordx4 v5, s[8:11], s3 offen offset:3072 lds
M a[20:23], a[188:191], a[140:143], a[20:23]
M a[20:23], a[184:187], a[136:139], a[20:23]
M a[24:27], a[184:187], a[144:147], a[24:27]
M a[24:27], a[188:191], a[148:151], a[24:27]
M a[28:31], a[188:191], a[156:159], a[28:31]
M a[28:31], a[184:187], a[152:155], a[28:31]
s_waitcnt lgkmcnt(2)
M v[32:35], a[160:163], a[32:35], v[32:35]
s_add_u32 s23, s23, 128
s_cmp_eq_u32 s23, s25
s_cselect_b32 s23, s26, s23
M v[32:35], a[164:167], a[36:39], v[32:35]
ds_read_b128 a[176:179], v10 offset:4096
ds_read_b128 a[180:183], v11 offset:4096
M v[36:39], a[164:167], a[44:47], v[36:39]
M v[36:39], a[160:163], a[40:43], v[36:39]
ds_read_b64_tr_b16 a[96:97], v12 offset:32768
ds_read_b64_tr_b16 a[98:99], v12 offset:34816
M v[40:43], a[160:163], a[48:51], v[40:43]
M v[40:43], a[164:167], a[52:55], v[40:43]
M v[44:47], a[164:167], a[60:63], v[44:47]
s_add_u32 m0, s29, 81920
s_nop 0
buffer_load_dwordx4 v6, s[12:15], s24 offen offset:0 lds
M v[44:47], a[160:163], a[56:59], v[44:47]
ds_read_b64_tr_b16 a[104:105], v13 offset:32768
ds_read_b64_tr_b16 a[106:107], v13 offset:34816
M v[48:51], a[160:163], a[64:67], v[48:51]
M v[48:51], a[164:167], a[68:71], v[48:51]
M v[52:55], a[164:167], a[76:79], v[52:55]
M v[52:55], a[160:163], a[72:75], v[52:55]
ds_read_b64_tr_b16 a[112:113], v14 offset:32768
ds_read_b64_tr_b16 a[114:115], v14 offset:34816
M v[56:59], a[160:163], a[80:83], v[56:59]
M v[56:59], a[164:167], a[84:87], v[56:59]
buffer_load_dwordx4 v7, s[12:15], s24 offen offset:1024 lds
M v[60:63], a[164:167], a[92:95], v[60:63]
M v[60:63], a[160:163], a[88:91], v[60:63]
s_waitcnt lgkmcnt(8)
ds_read_b64_tr_b16 a[120:121], v15 offset:32768
ds_read_b64_tr_b16 a[122:123], v15 offset:34816
M v[64:67], a[168:171], a[32:35], v[64:67]
M v[64:67], a[172:175], a[36:39], v[64:67]
ds_read_b128 a[184:187], v10 offset:6144
ds_read_b128 a[188:191], v11 offset:6144
M v[68:71], a[172:175], a[44:47], v[68:71]
M v[68:71], a[168:171], a[40:43], v[68:71]
ds_read_b64_tr_b16 a[128:129], v16 offset:32768
ds_read_b64_tr_b16 a[130:131], v16 offset:34816
M v[72:75], a[168:171], a[48:51], v[72:75]
buffer_load_dwordx4 v8, s[12:15], s24 offen offset:2048 lds
M v[72:75], a[172:175], a[52:55], v[72:75]
M v[76:79], a[172:175], a[60:63], v[76:79]
M v[76:79], a[168:171], a[56:59], v[76:79]
ds_read_b64_tr_b16 a[136:137], v17 offset:32768
ds_read_b64_tr_b16 a[138:139], v17 offset:34816
M v[80:83], a[168:171], a[64:67], v[80:83]
M v[80:83], a[172:175], a[68:71], v[80:83]
M v[84:87], a[172:175], a[76:79], v[84:87]
buffer_load_dwordx4 v9, s[12:15], s24 offen offset:3072 lds
M v[84:87], a[168:171], a[72:75], v[84:87]
ds_read_b64_tr_b16 a[144:145], v18 offset:32768
ds_read_b64_tr_b16 a[146:147], v18 offset:34816
M v[88:91], a[168:171], a[80:83], v[88:91]
M v[88:91], a[172:175], a[84:87], v[88:91]
M v[92:95], a[172:175], a[92:95], v[92:95]
M v[92:95], a[168:171], a[88:91], v[92:95]
s_waitcnt lgkmcnt(15)
ds_read_b64_tr_b16 a[152:153], v19 offset:32768
ds_read_b64_tr_b16 a[154:155], v19 offset:34816
M v[96:99], a[176:179], a[32:35], v[96:99]
s_add_u32 s24, s24, 262144
s_cmp_eq_u32 s24, s27
s_cselect_b32 s24, s28, s24
s_sub_u32 s6, s6, 1
s_cmp_eq_u32 s6, 0
s_cselect_b64 s[12:13], s[64:65], s[12:13]
M v[96:99], a[180:183], a[36:39], v[96:99]
M v[100:103], a[180:183], a[44:47], v[100:103]
M v[100:103], a[176:179], a[40:43], v[100:103]
M v[104:107], a[176:179], a[48:51], v[104:107]
M v[104:107], a[180:183], a[52:55], v[104:107]
M v[108:111], a[180:183], a[60:63], v[108:111]
M v[108:111], a[176:179], a[56:59], v[108:111]
s_waitcnt vmcnt(16) lgkmcnt(0)
s_barrier
ds_read_b128 a[160:163], v10 offset:16384
ds_read_b128 a[164:167], v11 offset:16384
M v[112:115], a[176:179], a[64:67], v[112:115]
s_add_u32 m0, s29, 0
s_nop 0
buffer_load_dwordx4 v2, s[8:11], s23 offen offset:0 lds
M v[112:115], a[180:183], a[68:71], v[112:115]
M v[116:119], a[180:183], a[76:79], v[116:119]
M v[116:119], a[176:179], a[72:75], v[116:119]
ds_read_b64_tr_b16 a[100:101], v12 offset:49152
ds_read_b64_tr_b16 a[102:103], v12 offset:51200
M v[120:123], a[176:179], a[80:83], v[120:123]
M v[120:123], a[180:183], a[84:87], v[120:123]
M v[124:127], a[180:183], a[92:95], v[124:127]
buffer_load_dwordx4 v3, s[8:11], s23 offen offset:1024 lds
M v[124:127], a[176:179], a[88:91], v[124:127]
M v[128:131], a[184:187], a[32:35], v[128:131]
M v[128:131], a[188:191], a[36:39], v[128:131]
ds_read_b128 a[168:171], v10 offset:18432
ds_read_b128 a[172:175], v11 offset:18432
ds_read_b64_tr_b16 a[108:109], v13 offset:49152
ds_read_b64_tr_b16 a[110:111], v13 offset:51200
M v[132:135], a[188:191], a[44:47], v[132:135]
M v[132:135], a[184:187], a[40:43], v[132:135]
M v[136:139], a[184:187], a[48:51], v[136:139]
M v[136:139], a[188:191], a[52:55], v[136:139]
buffer_load_dwordx4 v4, s[8:11], s23 offen offset:2048 lds
M v[140:143], a[188:191], a[60:63], v[140:143]
M v[140:143], a[184:187], a[56:59], v[140:143]
ds_read_b64_tr_b16 a[116:117], v14 offset:49152
ds_read_b64_tr_b16 a[118:119], v14 offset:51200
M v[144:147], a[184:187], a[64:67], v[144:147]
M v[144:147], a[188:191], a[68:71], v[144:147]
M v[148:151], a[188:191], a[76:79], v[148:151]
M v[148:151], a[184:187], a[72:75], v[148:151]
M v[152:155], a[184:187], a[80:83], v[152:155]
buffer_load_dwordx4 v5, s[8:11], s23 offen offset:3072 lds
M v[152:155], a[188:191], a[84:87], v[152:155]
ds_read_b64_tr_b16 a[124:125], v15 offset:49152
ds_read_b64_tr_b16 a[126:127], v15 offset:51200
M v[156:159], a[188:191], a[92:95], v[156:159]
M v[156:159], a[184:187], a[88:91], v[156:159]
s_waitcnt lgkmcnt(10)
M v[160:163], a[160:163], a[32:35], v[160:163]
M v[160:163], a[164:167], a[36:39], v[160:163]
ds_read_b128 a[176:179], v10 offset:20480
ds_read_b128 a[180:183], v11 offset:20480
M v[164:167], a[164:167], a[44:47], v[164:167]
M v[164:167], a[160:163], a[40:43], v[164:167]
ds_read_b64_tr_b16 a[132:133], v16 offset:49152
ds_read_b64_tr_b16 a[134:135], v16 offset:51200
M v[168:171], a[160:163], a[48:51], v[168:171]
M v[168:171], a[164:167], a[52:55], v[168:171]
s_add_u32 m0, s29, 98304
s_nop 0
buffer_load_dwordx4 v6, s[12:15], s24 offen offset:0 lds
M v[172:175], a[164:167], a[60:63], v[172:175]
M v[172:175], a[160:163], a[56:59], v[172:175]
M v[176:179], a[160:163], a[64:67], v[176:179]
M v[176:179], a[164:167], a[68:71], v[176:179]
ds_read_b64_tr_b16 a[140:141], v17 offset:49152
ds_read_b64_tr_b16 a[142:143], v17 offset:51200
M v[180:183], a[164:167], a[76:79], v[180:183]
M v[180:183], a[160:163], a[72:75], v[180:183]
buffer_load_dwordx4 v7, s[12:15], s24 offen offset:1024 lds
M v[184:187], a[160:163], a[80:83], v[184:187]
M v[184:187], a[164:167], a[84:87], v[184:187]
M v[188:191], a[164:167], a[92:95], v[188:191]
M v[188:191], a[160:163], a[88:91], v[188:191]
s_waitcnt lgkmcnt(12)
ds_read_b64_tr_b16 a[148:149], v18 offset:49152
ds_read_b64_tr_b16 a[150:151], v18 offset:51200
M v[192:195], a[168:171], a[32:35], v[192:195]
M v[192:195], a[172:175], a[36:39], v[192:195]
ds_read_b128 a[184:187], v10 offset:22528
ds_read_b128 a[188:191], v11 offset:22528
M v[196:199], a[172:175], a[44:47], v[196:199]
M v[196:199], a[168:171], a[40:43], v[196:199]
buffer_load_dwordx4 v8, s[12:15], s24 offen offset:2048 lds
M v[200:203], a[168:171], a[48:51], v[200:203]
M v[200:203], a[172:175], a[52:55], v[200:203]
ds_read_b64_tr_b16 a[156:157], v19 offset:49152
ds_read_b64_tr_b16 a[158:159], v19 offset:51200
M v[204:207], a[172:175], a[60:63], v[204:207]
M v[204:207], a[168:171], a[56:59], v[204:207]
M v[208:211], a[168:171], a[64:67], v[208:211]
M v[208:211], a[172:175], a[68:71], v[208:211]
buffer_load_dwordx4 v9, s[12:15], s24 offen offset:3072 lds
M v[212:215], a[172:175], a[76:79], v[212:215]
M v[212:215], a[168:171], a[72:75], v[212:215]
M v[216:219], a[168:171], a[80:83], v[216:219]
M v[216:219], a[172:175], a[84:87], v[216:219]
M v[220:223], a[172:175], a[92:95], v[220:223]
s_add_u32 s24, s24, 262144
M v[220:223], a[168:171], a[88:91], v[220:223]
s_waitcnt lgkmcnt(10)
M v[224:227], a[176:179], a[32:35], v[224:227]
M v[224:227], a[180:183], a[36:39], v[224:227]
M v[228:231], a[180:183], a[44:47], v[228:231]
M v[228:231], a[176:179], a[40:43], v[228:231]
M v[232:235], a[176:179], a[48:51], v[232:235]
M v[232:235], a[180:183], a[52:55], v[232:235]
M v[236:239], a[180:183], a[60:63], v[236:239]
M v[236:239], a[176:179], a[56:59], v[236:239]
s_waitcnt vmcnt(16) lgkmcnt(0)
s_barrier
ds_read_b128 a[160:163], v10 offset:32768
ds_read_b128 a[164:167], v11 offset:32768
M v[240:243], a[176:179], a[64:67], v[240:243]
s_add_u32 m0, s29, 16384
s_add_u32 s3, s23, s31
buffer_load_dwordx4 v2, s[8:11], s3 offen offset:0 lds
M v[240:243], a[180:183], a[68:71], v[240:243]
M v[244:247], a[180:183], a[76:79], v[244:247]
M v[244:247], a[176:179], a[72:75], v[244:247]
M v[248:251], a[176:179], a[80:83], v[248:251]
M v[248:251], a[180:183], a[84:87], v[248:251]
buffer_load_dwordx4 v3, s[8:11], s3 offen offset:1024 lds
M v[252:255], a[180:183], a[92:95], v[252:255]
M v[252:255], a[176:179], a[88:91], v[252:255]
M a[0:3], a[184:187], a[32:35], a[0:3]
M a[0:3], a[188:191], a[36:39], a[0:3]
ds_read_b128 a[168:171], v10 offset:34816
ds_read_b128 a[172:175], v11 offset:34816
M a[4:7], a[188:191], a[44:47], a[4:7]
M a[4:7], a[184:187], a[40:43], a[4:7]
M a[8:11], a[184:187], a[48:51], a[8:11]
buffer_load_dwordx4 v4, s[8:11], s3 offen offset:2048 lds
M a[8:11], a[188:191], a[52:55], a[8:11]
M a[12:15], a[188:191], a[60:63], a[12:15]
M a[12:15], a[184:187], a[56:59], a[12:15]
M a[16:19], a[184:187], a[64:67], a[16:19]
M a[16:19], a[188:191], a[68:71], a[16:19]
buffer_load_dwordx4 v5, s[8:11], s3 offen offset:3072 lds
M a[20:23], a[188:191], a[76:79], a[20:23]
M a[20:23], a[184:187], a[72:75], a[20:23]
M a[24:27], a[184:187], a[80:83], a[24:27]
M a[24:27], a[188:191], a[84:87], a[24:27]
M a[28:31], a[188:191], a[92:95], a[28:31]
M a[28:31], a[184:187], a[88:91], a[28:31]
s_waitcnt lgkmcnt(2)
M v[32:35], a[160:163], a[96:99], v[32:35]
s_add_u32 s23, s23, 128
s_cmp_eq_u32 s23, s25
s_cselect_b32 s23, s26, s23
M v[32:35], a[164:167], a[100:103], v[32:35]
ds_read_b128 a[176:179], v10 offset:36864
ds_read_b128 a[180:183], v11 offset:36864
M v[36:39], a[164:167], a[108:111], v[36:39]
M v[36:39], a[160:163], a[104:107], v[36:39]
ds_read_b64_tr_b16 a[32:33], v12 offset:0
ds_read_b64_tr_b16 a[34:35], v12 offset:2048
M v[40:43], a[160:163], a[112:115], v[40:43]
M v[40:43], a[164:167], a[116:119], v[40:43]
M v[44:47], a[164:167], a[124:127], v[44:47]
s_add_u32 m0, s29, 114688
s_nop 0
buffer_load_dwordx4 v6, s[12:15], s24 offen offset:0 lds
M v[44:47], a[160:163], a[120:123], v[44:47]
ds_read_b64_tr_b16 a[40:41], v13 offset:0
ds_read_b64_tr_b16 a[42:43], v13 offset:2048
M v[48:51], a[160:163], a[128:131], v[48:51]
M v[48:51], a[164:167], a[132:135], v[48:51]
M v[52:55], a[164:167], a[140:143], v[52:55]
M v[52:55], a[160:163], a[136:139], v[52:55]
ds_read_b64_tr_b16 a[48:49], v14 offset:0
ds_read_b64_tr_b16 a[50:51], v14 offset:2048
M v[56:59], a[160:163], a[144:147], v[56:59]
M v[56:59], a[164:167], a[148:151], v[56:59]
buffer_load_dwordx4 v7, s[12:15], s24 offen offset:1024 lds
M v[60:63], a[164:167], a[156:159], v[60:63]
M v[60:63], a[160:163], a[152:155], v[60:63]
s_waitcnt lgkmcnt(8)
ds_read_b64_tr_b16 a[56:57], v15 offset:0
ds_read_b64_tr_b16 a[58:59], v15 offset:2048
M v[64:67], a[168:171], a[96:99], v[64:67]
M v[64:67], a[172:175], a[100:103], v[64:67]
ds_read_b128 a[184:187], v10 offset:38912
ds_read_b128 a[188:191], v11 offset:38912
M v[68:71], a[172:175], a[108:111], v[68:71]
M v[68:71], a[168:171], a[104:107], v[68:71]
ds_read_b64_tr_b16 a[64:65], v16 offset:0
ds_read_b64_tr_b16 a[66:67], v16 offset:2048
M v[72:75], a[168:171], a[112:115], v[72:75]
buffer_load_dwordx4 v8, s[12:15], s24 offen offset:2048 lds
M v[72:75], a[172:175], a[116:119], v[72:75]
M v[76:79], a[172:175], a[124:127], v[76:79]
M v[76:79], a[168:171], a[120:123], v[76:79]
ds_read_b64_tr_b16 a[72:73], v17 offset:0
ds_read_b64_tr_b16 a[74:75], v17 offset:2048
M v[80:83], a[168:171], a[128:131], v[80:83]
M v[80:83], a[172:175], a[132:135], v[80:83]
M v[84:87], a[172:175], a[140:143], v[84:87]
buffer_load_dwordx4 v9, s[12:15], s24 offen offset:3072 lds
M v[84:87], a[168:171], a[136:139], v[84:87]
ds_read_b64_tr_b16 a[80:81], v18 offset:0
ds_read_b64_tr_b16 a[82:83], v18 offset:2048
M v[88:91], a[168:171], a[144:147], v[88:91]
M v[88:91], a[172:175], a[148:151], v[88:91]
M v[92:95], a[172:175], a[156:159], v[92:95]
M v[92:95], a[168:171], a[152:155], v[92:95]
s_waitcnt lgkmcnt(15)
ds_read_b64_tr_b16 a[88:89], v19 offset:0
ds_read_b64_tr_b16 a[90:91], v19 offset:2048
M v[96:99], a[176:179], a[96:99], v[96:99]
s_add_u32 s24, s24, 262144
s_cmp_eq_u32 s24, s27
s_cselect_b32 s24, s28, s24
s_sub_u32 s6, s6, 1
s_cmp_eq_u32 s6, 0
s_cselect_b64 s[12:13], s[64:65], s[12:13]
M v[96:99], a[180:183], a[100:103], v[96:99]
M v[100:103], a[180:183], a[108:111], v[100:103]
M v[100:103], a[176:179], a[104:107], v[100:103]
M v[104:107], a[176:179], a[112:115], v[104:107]
M v[104:107], a[180:183], a[116:119], v[104:107]
M v[108:111], a[180:183], a[124:127], v[108:111]
M v[108:111], a[176:179], a[120:123], v[108:111]
s_waitcnt vmcnt(16) lgkmcnt(0)
s_barrier
ds_read_b128 a[160:163], v10 offset:49152
ds_read_b128 a[164:167], v11 offset:49152
M v[112:115], a[176:179], a[128:131], v[112:115]
s_add_u32 m0, s29, 32768
s_nop 0
buffer_load_dwordx4 v2, s[8:11], s23 offen offset:0 lds
M v[112:115], a[180:183], a[132:135], v[112:115]
M v[116:119], a[180:183], a[140:143], v[116:119]
M v[116:119], a[176:179], a[136:139], v[116:119]
ds_read_b64_tr_b16 a[36:37], v12 offset:16384
ds_read_b64_tr_b16 a[38:39], v12 offset:18432
M v[120:123], a[176:179], a[144:147], v[120:123]
M v[120:123], a[180:183], a[148:151], v[120:123]
M v[124:127], a[180:183], a[156:159], v[124:127]
M v[124:127], a[176:179], a[152:155], v[124:127]
M v[128:131], a[184:187], a[96:99], v[128:131]
M v[128:131], a[188:191], a[100:103], v[128:131]
ds_read_b128 a[168:171], v10 offset:51200
ds_read_b128 a[172:175], v11 offset:51200
ds_read_b64_tr_b16 a[44:45], v13 offset:16384
ds_read_b64_tr_b16 a[46:47], v13 offset:18432
M v[132:135], a[188:191], a[108:111], v[132:135]
M v[132:135], a[184:187], a[104:107], v[132:135]
M v[136:139], a[184:187], a[112:115], v[136:139]
M v[136:139], a[188:191], a[116:119], v[136:139]
M v[140:143], a[188:191], a[124:127], v[140:143]
M v[140:143], a[184:187], a[120:123], v[140:143]
ds_read_b64_tr_b16 a[52:53], v14 offset:16384
ds_read_b64_tr_b16 a[54:55], v14 offset:18432
M v[144:147], a[184:187], a[128:131], v[144:147]
buffer_load_dwordx4 v3, s[8:11], s23 offen offset:1024 lds
M v[144:147], a[188:191], a[132:135], v[144:147]
M v[148:151], a[188:191], a[140:143], v[148:151]
M v[148:151], a[184:187], a[136:139], v[148:151]
M v[152:155], a[184:187], a[144:147], v[152:155]
M v[152:155], a[188:191], a[148:151], v[152:155]
ds_read_b64_tr_b16 a[60:61], v15 offset:16384
ds_read_b64_tr_b16 a[62:63], v15 offset:18432
M v[156:159], a[188:191], a[156:159], v[156:159]
M v[156:159], a[184:187], a[152:155], v[156:159]
s_waitcnt lgkmcnt(10)
M v[160:163], a[160:163], a[96:99], v[160:163]
M v[160:163], a[164:167], a[100:103], v[160:163]
ds_read_b128 a[176:179], v10 offset:53248
ds_read_b128 a[180:183], v11 offset:53248
M v[164:167], a[164:167], a[108:111], v[164:167]
M v[164:167], a[160:163], a[104:107], v[164:167]
ds_read_b64_tr_b16 a[68:69], v16 offset:16384
ds_read_b64_tr_b16 a[70:71], v16 offset:18432
M v[168:171], a[160:163], a[112:115], v[168:171]
M v[168:171], a[164:167], a[116:119], v[168:171]
M v[172:175], a[164:167], a[124:127], v[172:175]
M v[172:175], a[160:163], a[120:123], v[172:175]
M v[176:179], a[160:163], a[128:131], v[176:179]
buffer_load_dwordx4 v4, s[8:11], s23 offen offset:2048 lds
M v[176:179], a[164:167], a[132:135], v[176:179]
ds_read_b64_tr_b16 a[76:77], v17 offset:16384
ds_read_b64_tr_b16 a[78:79], v17 offset:18432
M v[180:183], a[164:167], a[140:143], v[180:183]
M v[180:183], a[160:163], a[136:139], v[180:183]
M v[184:187], a[160:163], a[144:147], v[184:187]
M v[184:187], a[164:167], a[148:151], v[184:187]
M v[188:191], a[164:167], a[156:159], v[188:191]
M v[188:191], a[160:163], a[152:155], v[188:191]
s_waitcnt lgkmcnt(12)
ds_read_b64_tr_b16 a[84:85], v18 offset:16384
ds_read_b64_tr_b16 a[86:87], v18 offset:18432
M v[192:195], a[168:171], a[96:99], v[192:195]
M v[192:195], a[172:175], a[100:103], v[192:195]
ds_read_b128 a[184:187], v10 offset:55296
ds_read_b128 a[188:191], v11 offset:55296
M v[196:199], a[172:175], a[108:111], v[196:199]
M v[196:199], a[168:171], a[104:107], v[196:199]
M v[200:203], a[168:171], a[112:115], v[200:203]
M v[200:203], a[172:175], a[116:119], v[200:203]
ds_read_b64_tr_b16 a[92:93], v19 offset:16384
ds_read_b64_tr_b16 a[94:95], v19 offset:18432
M v[204:207], a[172:175], a[124:127], v[204:207]
M v[204:207], a[168:171], a[120:123], v[204:207]
M v[208:211], a[168:171], a[128:131], v[208:211]
buffer_load_dwordx4 v5, s[8:11], s23 offen offset:3072 lds
M v[208:211], a[172:175], a[132:135], v[208:211]
M v[212:215], a[172:175], a[140:143], v[212:215]
M v[212:215], a[168:171], a[136:139], v[212:215]
M v[216:219], a[168:171], a[144:147], v[216:219]
M v[216:219], a[172:175], a[148:151], v[216:219]
M v[220:223], a[172:175], a[156:159], v[220:223]
M v[220:223], a[168:171], a[152:155], v[220:223]
s_waitcnt lgkmcnt(10)
M v[224:227], a[176:179], a[96:99], v[224:227]
M v[224:227], a[180:183], a[100:103], v[224:227]
M v[228:231], a[180:183], a[108:111], v[228:231]
M v[228:231], a[176:179], a[104:107], v[228:231]
M v[232:235], a[176:179], a[112:115], v[232:235]
M v[232:235], a[180:183], a[116:119], v[232:235]
M v[236:239], a[180:183], a[124:127], v[236:239]
M v[236:239], a[176:179], a[120:123], v[236:239]
s_waitcnt vmcnt(12) lgkmcnt(0)
s_barrier
ds_read_b128 a[160:163], v10 offset:0
ds_read_b128 a[164:167], v11 offset:0
M v[240:243], a[176:179], a[128:131], v[240:243]
s_add_u32 m0, s29, 49152
s_add_u32 s3, s23, s31
buffer_load_dwordx4 v2, s[8:11], s3 offen offset:0 lds
M v[240:243], a[180:183], a[132:135], v[240:243]
M v[244:247], a[180:183], a[140:143], v[244:247]
M v[244:247], a[176:179], a[136:139], v[244:247]
M v[248:251], a[176:179], a[144:147], v[248:251]
M v[248:251], a[180:183], a[148:151], v[248:251]
M v[252:255], a[180:183], a[156:159], v[252:255]
M v[252:255], a[176:179], a[152:155], v[252:255]
M a[0:3], a[184:187], a[96:99], a[0:3]
M a[0:3], a[188:191], a[100:103], a[0:3]
ds_read_b128 a[168:171], v10 offset:2048
ds_read_b128 a[172:175], v11 offset:2048
M a[4:7], a[188:191], a[108:111], a[4:7]
M a[4:7], a[184:187], a[104:107], a[4:7]
M a[8:11], a[184:187], a[112:115], a[8:11]
buffer_load_dwordx4 v3, s[8:11], s3 offen offset:1024 lds
M a[8:11], a[188:191], a[116:119], a[8:11]
M a[12:15], a[188:191], a[124:127], a[12:15]
M a[12:15], a[184:187], a[120:123], a[12:15]
M a[16:19], a[184:187], a[128:131], a[16:19]
M a[16:19], a[188:191], a[132:135], a[16:19]
M a[20:23], a[188:191], a[140:143], a[20:23]
M a[20:23], a[184:187], a[136:139], a[20:23]
M a[24:27], a[184:187], a[144:147], a[24:27]
M a[24:27], a[188:191], a[148:151], a[24:27]
M a[28:31], a[188:191], a[156:159], a[28:31]
M a[28:31], a[184:187], a[152:155], a[28:31]
s_waitcnt lgkmcnt(2)
M v[32:35], a[160:163], a[32:35], v[32:35]
buffer_load_dwordx4 v4, s[8:11], s3 offen offset:2048 lds
M v[32:35], a[164:167], a[36:39], v[32:35]
ds_read_b128 a[176:179], v10 offset:4096
ds_read_b128 a[180:183], v11 offset:4096
M v[36:39], a[164:167], a[44:47], v[36:39]
M v[36:39], a[160:163], a[40:43], v[36:39]
ds_read_b64_tr_b16 a[96:97], v12 offset:32768
ds_read_b64_tr_b16 a[98:99], v12 offset:34816
M v[40:43], a[160:163], a[48:51], v[40:43]
M v[40:43], a[164:167], a[52:55], v[40:43]
M v[44:47], a[164:167], a[60:63], v[44:47]
M v[44:47], a[160:163], a[56:59], v[44:47]
ds_read_b64_tr_b16 a[104:105], v13 offset:32768
ds_read_b64_tr_b16 a[106:107], v13 offset:34816
M v[48:51], a[160:163], a[64:67], v[48:51]
M v[48:51], a[164:167], a[68:71], v[48:51]
M v[52:55], a[164:167], a[76:79], v[52:55]
M v[52:55], a[160:163], a[72:75], v[52:55]
ds_read_b64_tr_b16 a[112:113], v14 offset:32768
ds_read_b64_tr_b16 a[114:115], v14 offset:34816
M v[56:59], a[160:163], a[80:83], v[56:59]
M v[56:59], a[164:167], a[84:87], v[56:59]
buffer_load_dwordx4 v5, s[8:11], s3 offen offset:3072 lds
M v[60:63], a[164:167], a[92:95], v[60:63]
M v[60:63], a[160:163], a[88:91], v[60:63]
s_waitcnt lgkmcnt(8)
ds_read_b64_tr_b16 a[120:121], v15 offset:32768
ds_read_b64_tr_b16 a[122:123], v15 offset:34816
M v[64:67], a[168:171], a[32:35], v[64:67]
M v[64:67], a[172:175], a[36:39], v[64:67]
ds_read_b128 a[184:187], v10 offset:6144
ds_read_b128 a[188:191], v11 offset:6144
M v[68:71], a[172:175], a[44:47], v[68:71]
M v[68:71], a[168:171], a[40:43], v[68:71]
ds_read_b64_tr_b16 a[128:129], v16 offset:32768
ds_read_b64_tr_b16 a[130:131], v16 offset:34816
M v[72:75], a[168:171], a[48:51], v[72:75]
M v[72:75], a[172:175], a[52:55], v[72:75]
M v[76:79], a[172:175], a[60:63], v[76:79]
M v[76:79], a[168:171], a[56:59], v[76:79]
ds_read_b64_tr_b16 a[136:137], v17 offset:32768
ds_read_b64_tr_b16 a[138:139], v17 offset:34816
M v[80:83], a[168:171], a[64:67], v[80:83]
M v[80:83], a[172:175], a[68:71], v[80:83]
M v[84:87], a[172:175], a[76:79], v[84:87]
s_add_u32 s23, s23, 128
s_cmp_eq_u32 s23, s25
s_cselect_b32 s23, s26, s23
M v[84:87], a[168:171], a[72:75], v[84:87]
ds_read_b64_tr_b16 a[144:145], v18 offset:32768
ds_read_b64_tr_b16 a[146:147], v18 offset:34816
M v[88:91], a[168:171], a[80:83], v[88:91]
M v[88:91], a[172:175], a[84:87], v[88:91]
M v[92:95], a[172:175], a[92:95], v[92:95]
M v[92:95], a[168:171], a[88:91], v[92:95]
s_waitcnt lgkmcnt(15)
ds_read_b64_tr_b16 a[152:153], v19 offset:32768
ds_read_b64_tr_b16 a[154:155], v19 offset:34816
M v[96:99], a[176:179], a[32:35], v[96:99]
M v[96:99], a[180:183], a[36:39], v[96:99]
M v[100:103], a[180:183], a[44:47], v[100:103]
M v[100:103], a[176:179], a[40:43], v[100:103]
M v[104:107], a[176:179], a[48:51], v[104:107]
M v[104:107], a[180:183], a[52:55], v[104:107]
M v[108:111], a[180:183], a[60:63], v[108:111]
M v[108:111], a[176:179], a[56:59], v[108:111]
s_waitcnt vmcnt(8) lgkmcnt(0)
s_barrier
ds_read_b128 a[160:163], v10 offset:16384
ds_read_b128 a[164:167], v11 offset:16384
M v[112:115], a[176:179], a[64:67], v[112:115]
M v[112:115], a[180:183], a[68:71], v[112:115]
s_and_b32 s3, s2, 1
s_lshl_b32 s3, s3, 3
s_bfe_u32 s4, s2, 0x30003
M v[116:119], a[180:183], a[76:79], v[116:119]
s_add_u32 s26, s3, s4
s_bfe_u32 s3, s2, 0x20001
s_lshl_b32 s3, s3, 2
M v[116:119], a[176:179], a[72:75], v[116:119]
ds_read_b64_tr_b16 a[100:101], v12 offset:49152
ds_read_b64_tr_b16 a[102:103], v12 offset:51200
s_lshr_b32 s4, s2, 6
s_xor_b32 s4, s4, 2
s_add_u32 s27, s3, s4
M v[120:123], a[176:179], a[80:83], v[120:123]
s_lshl_b32 s23, s26, 18
s_sub_u32 s24, s23, 32768
M v[120:123], a[180:183], a[84:87], v[120:123]
s_max_i32 s24, s24, 0
s_lshl_b32 s25, s27, 7
s_xor_b32 s3, s26, s27
M v[124:127], a[180:183], a[92:95], v[124:127]
s_and_b32 s3, s3, 0
s_lshl_b32 s3, s3, 3
s_sub_u32 s31, 16, s3
M v[124:127], a[176:179], a[88:91], v[124:127]
s_mov_b32 s54, s31
s_movk_i32 s57, 128
M v[128:131], a[184:187], a[32:35], v[128:131]
s_mov_b32 s55, 4289069056
s_mov_b32 s56, 393216
s_lshl_b32 s4, s3, 7
M v[128:131], a[188:191], a[36:39], v[128:131]
ds_read_b128 a[168:171], v10 offset:18432
ds_read_b128 a[172:175], v11 offset:18432
ds_read_b64_tr_b16 a[108:109], v13 offset:49152
ds_read_b64_tr_b16 a[110:111], v13 offset:51200
s_add_u32 s23, s23, s4
s_add_u32 s24, s24, s4
s_mul_i32 s4, s3, 393216
M v[132:135], a[188:191], a[44:47], v[132:135]
s_add_u32 s25, s25, s4
s_mov_b64 s[8:9], s[44:45]
s_mov_b32 s10, 4194304
M v[132:135], a[184:187], a[40:43], v[132:135]
s_mov_b64 s[12:13], s[46:47]
s_mov_b32 s14, 6291456
M v[136:139], a[184:187], a[48:51], v[136:139]
s_mov_b64 s[36:37], s[90:91]
s_mov_b32 s38, 256
s_mov_b32 s39, 0x00020000
M v[136:139], a[188:191], a[52:55], v[136:139]
s_lshl_b32 s28, s20, 9
s_mul_i32 s30, s20, 6144
s_lshl_b32 s3, s20, 5
M v[140:143], a[188:191], a[60:63], v[140:143]
v_lshrrev_b32 v24, 3, v0
v_and_b32 v25, 7, v0
M v[140:143], a[184:187], a[56:59], v[140:143]
ds_read_b64_tr_b16 a[116:117], v14 offset:49152
ds_read_b64_tr_b16 a[118:119], v14 offset:51200
v_add_u32 v28, s3, v24
v_add_u32 v26, 0, v28
v_bfe_u32 v27, v26, 1, 3
M v[144:147], a[184:187], a[64:67], v[144:147]
v_xor_b32 v27, v27, v25
v_lshlrev_b32 v26, 11, v26
v_lshl_add_u32 v26, v27, 4, v26
M v[144:147], a[188:191], a[68:71], v[144:147]
v_subrev_u32 v2, 0, v26
v_add_u32 v26, 8, v28
v_bfe_u32 v27, v26, 1, 3
M v[148:151], a[188:191], a[76:79], v[148:151]
v_xor_b32 v27, v27, v25
v_lshlrev_b32 v26, 11, v26
M v[148:151], a[184:187], a[72:75], v[148:151]
v_lshl_add_u32 v26, v27, 4, v26
v_subrev_u32 v3, 1024, v26
v_add_u32 v26, 16, v28
M v[152:155], a[184:187], a[80:83], v[152:155]
v_bfe_u32 v27, v26, 1, 3
v_xor_b32 v27, v27, v25
v_lshlrev_b32 v26, 11, v26
M v[152:155], a[188:191], a[84:87], v[152:155]
ds_read_b64_tr_b16 a[124:125], v15 offset:49152
ds_read_b64_tr_b16 a[126:127], v15 offset:51200
v_lshl_add_u32 v26, v27, 4, v26
v_subrev_u32 v4, 2048, v26
M v[156:159], a[188:191], a[92:95], v[156:159]
v_add_u32 v26, 24, v28
v_bfe_u32 v27, v26, 1, 3
v_xor_b32 v27, v27, v25
M v[156:159], a[184:187], a[88:91], v[156:159]
s_waitcnt lgkmcnt(10)
v_lshlrev_b32 v26, 11, v26
v_lshl_add_u32 v26, v27, 4, v26
v_subrev_u32 v5, 3072, v26
M v[160:163], a[160:163], a[32:35], v[160:163]
s_lshl_b32 s3, s20, 2
v_lshrrev_b32 v26, 5, v0
M v[160:163], a[164:167], a[36:39], v[160:163]
ds_read_b128 a[176:179], v10 offset:20480
ds_read_b128 a[180:183], v11 offset:20480
v_add_u32 v26, s3, v26
v_bfe_u32 v29, v0, 2, 3
v_bfe_u32 v27, v26, 1, 3
M v[164:167], a[164:167], a[44:47], v[164:167]
v_xor_b32 v27, v27, v29
v_lshlrev_b32 v27, 4, v27
v_and_b32 v30, 3, v0
M v[164:167], a[160:163], a[40:43], v[164:167]
ds_read_b64_tr_b16 a[132:133], v16 offset:49152
ds_read_b64_tr_b16 a[134:135], v16 offset:51200
v_lshl_add_u32 v27, v30, 2, v27
v_lshl_add_u32 v20, v26, 11, v27
v_add_u32 v26, 2, v26
M v[168:171], a[160:163], a[48:51], v[168:171]
v_bfe_u32 v27, v26, 1, 3
v_xor_b32 v27, v27, v29
M v[168:171], a[164:167], a[52:55], v[168:171]
v_lshlrev_b32 v27, 4, v27
v_and_b32 v30, 3, v0
v_lshl_add_u32 v27, v30, 2, v27
M v[172:175], a[164:167], a[60:63], v[172:175]
v_lshl_add_u32 v23, v26, 11, v27
v_subrev_u32 v23, 256, v23
s_mul_i32 s3, s20, 48
M v[172:175], a[160:163], a[56:59], v[172:175]
v_add_u32 v28, s3, v24
v_add_u32 v26, 0, v28
M v[176:179], a[160:163], a[64:67], v[176:179]
v_mul_u32_u24 v27, 0xaaab, v26
v_lshrrev_b32 v27, 17, v27
v_lshrrev_b32 v29, 1, v27
M v[176:179], a[164:167], a[68:71], v[176:179]
ds_read_b64_tr_b16 a[140:141], v17 offset:49152
ds_read_b64_tr_b16 a[142:143], v17 offset:51200
v_and_b32 v29, 4, v29
v_and_or_b32 v27, v27, 2, v29
v_xor_b32 v27, v27, v25
M v[180:183], a[164:167], a[76:79], v[180:183]
v_lshlrev_b32 v26, 11, v26
v_lshl_add_u32 v26, v27, 4, v26
v_subrev_u32 v6, 0, v26
M v[180:183], a[160:163], a[72:75], v[180:183]
v_add_u32 v26, 8, v28
v_mul_u32_u24 v27, 0xaaab, v26
M v[184:187], a[160:163], a[80:83], v[184:187]
v_lshrrev_b32 v27, 17, v27
v_lshrrev_b32 v29, 1, v27
v_and_b32 v29, 4, v29
M v[184:187], a[164:167], a[84:87], v[184:187]
v_and_or_b32 v27, v27, 2, v29
v_xor_b32 v27, v27, v25
v_lshlrev_b32 v26, 11, v26
M v[188:191], a[164:167], a[92:95], v[188:191]
v_lshl_add_u32 v26, v27, 4, v26
v_subrev_u32 v7, 1024, v26
M v[188:191], a[160:163], a[88:91], v[188:191]
s_waitcnt lgkmcnt(12)
ds_read_b64_tr_b16 a[148:149], v18 offset:49152
ds_read_b64_tr_b16 a[150:151], v18 offset:51200
v_add_u32 v26, 16, v28
v_mul_u32_u24 v27, 0xaaab, v26
v_lshrrev_b32 v27, 17, v27
M v[192:195], a[168:171], a[32:35], v[192:195]
v_lshrrev_b32 v29, 1, v27
v_and_b32 v29, 4, v29
v_and_or_b32 v27, v27, 2, v29
M v[192:195], a[172:175], a[36:39], v[192:195]
ds_read_b128 a[184:187], v10 offset:22528
ds_read_b128 a[188:191], v11 offset:22528
v_xor_b32 v27, v27, v25
v_lshlrev_b32 v26, 11, v26
M v[196:199], a[172:175], a[44:47], v[196:199]
v_lshl_add_u32 v26, v27, 4, v26
v_subrev_u32 v8, 2048, v26
v_add_u32 v26, 24, v28
M v[196:199], a[168:171], a[40:43], v[196:199]
v_mul_u32_u24 v27, 0xaaab, v26
v_lshrrev_b32 v27, 17, v27
v_lshrrev_b32 v29, 1, v27
M v[200:203], a[168:171], a[48:51], v[200:203]
v_and_b32 v29, 4, v29
v_and_or_b32 v27, v27, 2, v29
v_xor_b32 v27, v27, v25
M v[200:203], a[172:175], a[52:55], v[200:203]
ds_read_b64_tr_b16 a[156:157], v19 offset:49152
ds_read_b64_tr_b16 a[158:159], v19 offset:51200
v_lshlrev_b32 v26, 11, v26
v_lshl_add_u32 v26, v27, 4, v26
M v[204:207], a[172:175], a[60:63], v[204:207]
v_subrev_u32 v9, 3072, v26
v_add_u32 v26, 32, v28
v_mul_u32_u24 v27, 0xaaab, v26
M v[204:207], a[168:171], a[56:59], v[204:207]
v_lshrrev_b32 v27, 17, v27
v_lshrrev_b32 v29, 1, v27
v_and_b32 v29, 4, v29
M v[208:211], a[168:171], a[64:67], v[208:211]
v_and_or_b32 v27, v27, 2, v29
v_xor_b32 v27, v27, v25
M v[208:211], a[172:175], a[68:71], v[208:211]
v_lshlrev_b32 v26, 11, v26
v_lshl_add_u32 v26, v27, 4, v26
v_subrev_u32 v21, 0, v26
M v[212:215], a[172:175], a[76:79], v[212:215]
v_add_u32 v26, 40, v28
v_mul_u32_u24 v27, 0xaaab, v26
v_lshrrev_b32 v27, 17, v27
M v[212:215], a[168:171], a[72:75], v[212:215]
v_lshrrev_b32 v29, 1, v27
v_and_b32 v29, 4, v29
v_and_or_b32 v27, v27, 2, v29
M v[216:219], a[168:171], a[80:83], v[216:219]
v_xor_b32 v27, v27, v25
v_lshlrev_b32 v26, 11, v26
M v[216:219], a[172:175], a[84:87], v[216:219]
v_lshl_add_u32 v26, v27, 4, v26
v_subrev_u32 v22, 1024, v26
s_lshr_b32 s3, s53, 7
M v[220:223], a[172:175], a[92:95], v[220:223]
s_add_u32 s3, s3, s22
s_lshl_b32 s3, s3, 5
s_lshr_b32 s19, s52, 6
M v[220:223], a[168:171], a[88:91], v[220:223]
s_waitcnt lgkmcnt(10)
s_add_u32 s3, s3, s19
s_lshl_b32 s19, s21, 1
M v[224:227], a[176:179], a[32:35], v[224:227]
s_add_u32 s3, s3, s19
s_lshl_b32 s92, s3, 15
s_add_u32 s92, s92, 16384
M v[224:227], a[180:183], a[36:39], v[224:227]
s_add_u32 s93, s92, 32768
s_add_u32 s16, s50, 16777216
s_addc_u32 s17, s51, 0
M v[228:231], a[180:183], a[44:47], v[228:231]
s_mov_b32 s18, 33554432
s_mov_b32 s19, 0x00020000
M v[228:231], a[176:179], a[40:43], v[228:231]
M v[232:235], a[176:179], a[48:51], v[232:235]
M v[232:235], a[180:183], a[52:55], v[232:235]
M v[236:239], a[180:183], a[60:63], v[236:239]
M v[236:239], a[176:179], a[56:59], v[236:239]
s_waitcnt vmcnt(4) lgkmcnt(0)
s_barrier
ds_read_b128 a[160:163], v10 offset:32768
ds_read_b128 a[164:167], v11 offset:32768
M v[240:243], a[176:179], a[64:67], v[240:243]
s_add_u32 m0, s28, 131072
s_nop 0
buffer_load_dword v20, s[8:11], s24 offen lds
M v[240:243], a[180:183], a[68:71], v[240:243]
M v[244:247], a[180:183], a[76:79], v[244:247]
M v[244:247], a[176:179], a[72:75], v[244:247]
buffer_load_dword v23, s[8:11], s24 offen offset:256 lds
M v[248:251], a[176:179], a[80:83], v[248:251]
M v[248:251], a[180:183], a[84:87], v[248:251]
M v[252:255], a[180:183], a[92:95], v[252:255]
M v[252:255], a[176:179], a[88:91], v[252:255]
M a[0:3], a[184:187], a[32:35], a[0:3]
s_add_u32 m0, s29, 133120
s_nop 0
buffer_load_dwordx4 v2, s[8:11], s23 offen offset:0 lds
M a[0:3], a[188:191], a[36:39], a[0:3]
ds_read_b128 a[168:171], v10 offset:34816
ds_read_b128 a[172:175], v11 offset:34816
M a[4:7], a[188:191], a[44:47], a[4:7]
M a[4:7], a[184:187], a[40:43], a[4:7]
M a[8:11], a[184:187], a[48:51], a[8:11]
buffer_load_dwordx4 v3, s[8:11], s23 offen offset:1024 lds
M a[8:11], a[188:191], a[52:55], a[8:11]
M a[12:15], a[188:191], a[60:63], a[12:15]
M a[12:15], a[184:187], a[56:59], a[12:15]
M a[16:19], a[184:187], a[64:67], a[16:19]
buffer_load_dwordx4 v4, s[8:11], s23 offen offset:2048 lds
M a[16:19], a[188:191], a[68:71], a[16:19]
M a[20:23], a[188:191], a[76:79], a[20:23]
M a[20:23], a[184:187], a[72:75], a[20:23]
buffer_load_dwordx4 v5, s[8:11], s23 offen offset:3072 lds
M a[24:27], a[184:187], a[80:83], a[24:27]
M a[24:27], a[188:191], a[84:87], a[24:27]
M a[28:31], a[188:191], a[92:95], a[28:31]
M a[28:31], a[184:187], a[88:91], a[28:31]
s_waitcnt lgkmcnt(2)
M v[32:35], a[160:163], a[96:99], v[32:35]
s_sub_u32 s31, s31, 1
s_cmp_eq_u32 s31, 0
s_cselect_b32 s58, -1920, s57
s_add_u32 s23, s23, s58
s_add_u32 s24, s24, s58
M v[32:35], a[164:167], a[100:103], v[32:35]
ds_read_b128 a[176:179], v10 offset:36864
ds_read_b128 a[180:183], v11 offset:36864
M v[36:39], a[164:167], a[108:111], v[36:39]
M v[36:39], a[160:163], a[104:107], v[36:39]
M v[40:43], a[160:163], a[112:115], v[40:43]
M v[40:43], a[164:167], a[116:119], v[40:43]
s_add_u32 m0, s30, 65536
s_nop 0
buffer_load_dwordx4 v6, s[12:15], s25 offen offset:0 lds
M v[44:47], a[164:167], a[124:127], v[44:47]
M v[44:47], a[160:163], a[120:123], v[44:47]
M v[48:51], a[160:163], a[128:131], v[48:51]
M v[48:51], a[164:167], a[132:135], v[48:51]
buffer_load_dwordx4 v7, s[12:15], s25 offen offset:1024 lds
M v[52:55], a[164:167], a[140:143], v[52:55]
M v[52:55], a[160:163], a[136:139], v[52:55]
M v[56:59], a[160:163], a[144:147], v[56:59]
M v[56:59], a[164:167], a[148:151], v[56:59]
buffer_load_dwordx4 v8, s[12:15], s25 offen offset:2048 lds
M v[60:63], a[164:167], a[156:159], v[60:63]
M v[60:63], a[160:163], a[152:155], v[60:63]
s_waitcnt lgkmcnt(2)
M v[64:67], a[168:171], a[96:99], v[64:67]
M v[64:67], a[172:175], a[100:103], v[64:67]
ds_read_b128 a[184:187], v10 offset:38912
ds_read_b128 a[188:191], v11 offset:38912
M v[68:71], a[172:175], a[108:111], v[68:71]
M v[68:71], a[168:171], a[104:107], v[68:71]
buffer_load_dwordx4 v9, s[12:15], s25 offen offset:3072 lds
M v[72:75], a[168:171], a[112:115], v[72:75]
M v[72:75], a[172:175], a[116:119], v[72:75]
M v[76:79], a[172:175], a[124:127], v[76:79]
M v[76:79], a[168:171], a[120:123], v[76:79]
s_add_u32 m0, s30, 69632
s_nop 0
buffer_load_dwordx4 v21, s[12:15], s25 offen offset:0 lds
M v[80:83], a[168:171], a[128:131], v[80:83]
M v[80:83], a[172:175], a[132:135], v[80:83]
M v[84:87], a[172:175], a[140:143], v[84:87]
M v[84:87], a[168:171], a[136:139], v[84:87]
buffer_load_dwordx4 v22, s[12:15], s25 offen offset:1024 lds
M v[88:91], a[168:171], a[144:147], v[88:91]
M v[88:91], a[172:175], a[148:151], v[88:91]
M v[92:95], a[172:175], a[156:159], v[92:95]
M v[92:95], a[168:171], a[152:155], v[92:95]
s_waitcnt lgkmcnt(2)
M v[96:99], a[176:179], a[96:99], v[96:99]
s_sub_u32 s54, s54, 1
s_cmp_eq_u32 s54, 0
s_cselect_b32 s58, s55, s56
s_add_u32 s25, s25, s58
M v[96:99], a[180:183], a[100:103], v[96:99]
M v[100:103], a[180:183], a[108:111], v[100:103]
M v[100:103], a[176:179], a[104:107], v[100:103]
v_cvt_pk_bf16_f32 v32, v32, v33
v_cvt_pk_bf16_f32 v33, v34, v35
M v[104:107], a[176:179], a[112:115], v[104:107]
v_cvt_pk_bf16_f32 v34, v64, v65
v_cvt_pk_bf16_f32 v35, v66, v67
M v[104:107], a[180:183], a[116:119], v[104:107]
v_cvt_pk_bf16_f32 v64, v48, v49
M v[108:111], a[180:183], a[124:127], v[108:111]
v_cvt_pk_bf16_f32 v65, v50, v51
v_cvt_pk_bf16_f32 v66, v80, v81
M v[108:111], a[176:179], a[120:123], v[108:111]
s_waitcnt vmcnt(12) lgkmcnt(0)
s_barrier
ds_read_b128 a[160:163], v10 offset:49152
ds_read_b128 a[164:167], v11 offset:49152
v_cvt_pk_bf16_f32 v67, v82, v83
M v[112:115], a[176:179], a[128:131], v[112:115]
s_add_u32 m0, s28, 0
s_nop 0
buffer_load_dword v20, s[8:11], s24 offen lds
v_cvt_pk_bf16_f32 v48, v40, v41
v_cvt_pk_bf16_f32 v49, v42, v43
M v[112:115], a[180:183], a[132:135], v[112:115]
v_cvt_pk_bf16_f32 v50, v72, v73
v_cvt_pk_bf16_f32 v51, v74, v75
M v[116:119], a[180:183], a[140:143], v[116:119]
v_cvt_pk_bf16_f32 v80, v56, v57
M v[116:119], a[176:179], a[136:139], v[116:119]
buffer_load_dword v23, s[8:11], s24 offen offset:256 lds
v_cvt_pk_bf16_f32 v81, v58, v59
v_cvt_pk_bf16_f32 v82, v88, v89
M v[120:123], a[176:179], a[144:147], v[120:123]
v_cvt_pk_bf16_f32 v83, v90, v91
M v[120:123], a[180:183], a[148:151], v[120:123]
v_cvt_pk_bf16_f32 v40, v36, v37
v_cvt_pk_bf16_f32 v41, v38, v39
M v[124:127], a[180:183], a[156:159], v[124:127]
s_add_u32 m0, s29, 2048
s_nop 0
buffer_load_dwordx4 v2, s[8:11], s23 offen offset:0 lds
v_cvt_pk_bf16_f32 v42, v68, v69
v_cvt_pk_bf16_f32 v43, v70, v71
M v[124:127], a[176:179], a[152:155], v[124:127]
v_cvt_pk_bf16_f32 v72, v52, v53
M v[128:131], a[184:187], a[96:99], v[128:131]
v_cvt_pk_bf16_f32 v73, v54, v55
v_cvt_pk_bf16_f32 v74, v84, v85
M v[128:131], a[188:191], a[100:103], v[128:131]
ds_read_b128 a[168:171], v10 offset:51200
ds_read_b128 a[172:175], v11 offset:51200
v_cvt_pk_bf16_f32 v75, v86, v87
M v[132:135], a[188:191], a[108:111], v[132:135]
v_cvt_pk_bf16_f32 v56, v44, v45
v_cvt_pk_bf16_f32 v57, v46, v47
M v[132:135], a[184:187], a[104:107], v[132:135]
buffer_load_dwordx4 v3, s[8:11], s23 offen offset:1024 lds
v_cvt_pk_bf16_f32 v58, v76, v77
v_cvt_pk_bf16_f32 v59, v78, v79
M v[136:139], a[184:187], a[112:115], v[136:139]
v_cvt_pk_bf16_f32 v88, v60, v61
M v[136:139], a[188:191], a[116:119], v[136:139]
v_cvt_pk_bf16_f32 v89, v62, v63
v_cvt_pk_bf16_f32 v90, v92, v93
M v[140:143], a[188:191], a[124:127], v[140:143]
buffer_load_dwordx4 v4, s[8:11], s23 offen offset:2048 lds
v_cvt_pk_bf16_f32 v91, v94, v95
M v[140:143], a[184:187], a[120:123], v[140:143]
M v[144:147], a[184:187], a[128:131], v[144:147]
M v[144:147], a[188:191], a[132:135], v[144:147]
buffer_load_dwordx4 v5, s[8:11], s23 offen offset:3072 lds
M v[148:151], a[188:191], a[140:143], v[148:151]
s_add_u32 s94, s92, 0
buffer_store_dwordx4 v[32:35], v1, s[16:19], s94 offen offset:0 sc1
M v[148:151], a[184:187], a[136:139], v[148:151]
M v[152:155], a[184:187], a[144:147], v[152:155]
M v[152:155], a[188:191], a[148:151], v[152:155]
s_sub_u32 s31, s31, 1
s_cmp_eq_u32 s31, 0
s_cselect_b32 s58, -1920, s57
s_add_u32 s23, s23, s58
s_add_u32 s24, s24, s58
M v[156:159], a[188:191], a[156:159], v[156:159]
s_add_u32 s94, s92, 0
buffer_store_dwordx4 v[40:43], v1, s[16:19], s94 offen offset:1024 sc1
M v[156:159], a[184:187], a[152:155], v[156:159]
s_waitcnt lgkmcnt(2)
M v[160:163], a[160:163], a[96:99], v[160:163]
M v[160:163], a[164:167], a[100:103], v[160:163]
ds_read_b128 a[176:179], v10 offset:53248
ds_read_b128 a[180:183], v11 offset:53248
M v[164:167], a[164:167], a[108:111], v[164:167]
s_add_u32 s94, s92, 0
buffer_store_dwordx4 v[48:51], v1, s[16:19], s94 offen offset:2048 sc1
M v[164:167], a[160:163], a[104:107], v[164:167]
v_cvt_pk_bf16_f32 v96, v96, v97
v_cvt_pk_bf16_f32 v97, v98, v99
M v[168:171], a[160:163], a[112:115], v[168:171]
v_cvt_pk_bf16_f32 v98, v128, v129
v_cvt_pk_bf16_f32 v99, v130, v131
M v[168:171], a[164:167], a[116:119], v[168:171]
s_add_u32 m0, s30, 98304
s_nop 0
buffer_load_dwordx4 v6, s[12:15], s25 offen offset:0 lds
v_cvt_pk_bf16_f32 v128, v112, v113
M v[172:175], a[164:167], a[124:127], v[172:175]
s_add_u32 s94, s92, 0
buffer_store_dwordx4 v[56:59], v1, s[16:19], s94 offen offset:3072 sc1
v_cvt_pk_bf16_f32 v129, v114, v115
v_cvt_pk_bf16_f32 v130, v144, v145
M v[172:175], a[160:163], a[120:123], v[172:175]
v_cvt_pk_bf16_f32 v131, v146, v147
M v[176:179], a[160:163], a[128:131], v[176:179]
v_cvt_pk_bf16_f32 v112, v104, v105
v_cvt_pk_bf16_f32 v113, v106, v107
M v[176:179], a[164:167], a[132:135], v[176:179]
buffer_load_dwordx4 v7, s[12:15], s25 offen offset:1024 lds
v_cvt_pk_bf16_f32 v114, v136, v137
v_cvt_pk_bf16_f32 v115, v138, v139
M v[180:183], a[164:167], a[140:143], v[180:183]
s_add_u32 s94, s92, 4096
buffer_store_dwordx4 v[64:67], v1, s[16:19], s94 offen offset:0 sc1
v_cvt_pk_bf16_f32 v144, v120, v121
M v[180:183], a[160:163], a[136:139], v[180:183]
v_cvt_pk_bf16_f32 v145, v122, v123
v_cvt_pk_bf16_f32 v146, v152, v153
M v[184:187], a[160:163], a[144:147], v[184:187]
v_cvt_pk_bf16_f32 v147, v154, v155
M v[184:187], a[164:167], a[148:151], v[184:187]
buffer_load_dwordx4 v8, s[12:15], s25 offen offset:2048 lds
v_cvt_pk_bf16_f32 v104, v100, v101
v_cvt_pk_bf16_f32 v105, v102, v103
M v[188:191], a[164:167], a[156:159], v[188:191]
s_add_u32 s94, s92, 4096
buffer_store_dwordx4 v[72:75], v1, s[16:19], s94 offen offset:1024 sc1
v_cvt_pk_bf16_f32 v106, v132, v133
v_cvt_pk_bf16_f32 v107, v134, v135
M v[188:191], a[160:163], a[152:155], v[188:191]
s_waitcnt lgkmcnt(2)
v_cvt_pk_bf16_f32 v136, v116, v117
M v[192:195], a[168:171], a[96:99], v[192:195]
v_cvt_pk_bf16_f32 v137, v118, v119
v_cvt_pk_bf16_f32 v138, v148, v149
M v[192:195], a[172:175], a[100:103], v[192:195]
ds_read_b128 a[184:187], v10 offset:55296
ds_read_b128 a[188:191], v11 offset:55296
v_cvt_pk_bf16_f32 v139, v150, v151
M v[196:199], a[172:175], a[108:111], v[196:199]
s_add_u32 s94, s92, 4096
buffer_store_dwordx4 v[80:83], v1, s[16:19], s94 offen offset:2048 sc1
v_cvt_pk_bf16_f32 v120, v108, v109
v_cvt_pk_bf16_f32 v121, v110, v111
M v[196:199], a[168:171], a[104:107], v[196:199]
v_cvt_pk_bf16_f32 v122, v140, v141
v_cvt_pk_bf16_f32 v123, v142, v143
M v[200:203], a[168:171], a[112:115], v[200:203]
buffer_load_dwordx4 v9, s[12:15], s25 offen offset:3072 lds
v_cvt_pk_bf16_f32 v152, v124, v125
M v[200:203], a[172:175], a[116:119], v[200:203]
v_cvt_pk_bf16_f32 v153, v126, v127
v_cvt_pk_bf16_f32 v154, v156, v157
M v[204:207], a[172:175], a[124:127], v[204:207]
s_add_u32 s94, s92, 4096
buffer_store_dwordx4 v[88:91], v1, s[16:19], s94 offen offset:3072 sc1
v_cvt_pk_bf16_f32 v155, v158, v159
M v[204:207], a[168:171], a[120:123], v[204:207]
M v[208:211], a[168:171], a[128:131], v[208:211]
s_add_u32 m0, s30, 102400
s_nop 0
buffer_load_dwordx4 v21, s[12:15], s25 offen offset:0 lds
M v[208:211], a[172:175], a[132:135], v[208:211]
M v[212:215], a[172:175], a[140:143], v[212:215]
M v[212:215], a[168:171], a[136:139], v[212:215]
buffer_load_dwordx4 v22, s[12:15], s25 offen offset:1024 lds
M v[216:219], a[168:171], a[144:147], v[216:219]
s_add_u32 s94, s92, 8192
buffer_store_dwordx4 v[96:99], v1, s[16:19], s94 offen offset:0 sc1
M v[216:219], a[172:175], a[148:151], v[216:219]
M v[220:223], a[172:175], a[156:159], v[220:223]
M v[220:223], a[168:171], a[152:155], v[220:223]
s_waitcnt lgkmcnt(2)
M v[224:227], a[176:179], a[96:99], v[224:227]
s_sub_u32 s54, s54, 1
s_cmp_eq_u32 s54, 0
s_cselect_b32 s58, s55, s56
s_add_u32 s25, s25, s58
M v[224:227], a[180:183], a[100:103], v[224:227]
M v[228:231], a[180:183], a[108:111], v[228:231]
s_add_u32 s94, s92, 8192
buffer_store_dwordx4 v[104:107], v1, s[16:19], s94 offen offset:1024 sc1
M v[228:231], a[176:179], a[104:107], v[228:231]
v_cvt_pk_bf16_f32 v160, v160, v161
v_cvt_pk_bf16_f32 v161, v162, v163
M v[232:235], a[176:179], a[112:115], v[232:235]
v_cvt_pk_bf16_f32 v162, v192, v193
v_cvt_pk_bf16_f32 v163, v194, v195
M v[232:235], a[180:183], a[116:119], v[232:235]
v_cvt_pk_bf16_f32 v192, v176, v177
M v[236:239], a[180:183], a[124:127], v[236:239]
v_cvt_pk_bf16_f32 v193, v178, v179
v_cvt_pk_bf16_f32 v194, v208, v209
M v[236:239], a[176:179], a[120:123], v[236:239]
s_waitcnt vmcnt(63) lgkmcnt(0)
s_barrier
v_cvt_pk_bf16_f32 v195, v210, v211
M v[240:243], a[176:179], a[128:131], v[240:243]
s_add_u32 s94, s92, 8192
buffer_store_dwordx4 v[112:115], v1, s[16:19], s94 offen offset:2048 sc1
v_cvt_pk_bf16_f32 v176, v168, v169
v_cvt_pk_bf16_f32 v177, v170, v171
M v[240:243], a[180:183], a[132:135], v[240:243]
s_add_u32 m0, s28, 18432
s_nop 0
buffer_load_dword v20, s[8:11], s24 offen lds
v_cvt_pk_bf16_f32 v178, v200, v201
v_cvt_pk_bf16_f32 v179, v202, v203
M v[244:247], a[180:183], a[140:143], v[244:247]
v_cvt_pk_bf16_f32 v208, v184, v185
M v[244:247], a[176:179], a[136:139], v[244:247]
v_cvt_pk_bf16_f32 v209, v186, v187
v_cvt_pk_bf16_f32 v210, v216, v217
M v[248:251], a[176:179], a[144:147], v[248:251]
buffer_load_dword v23, s[8:11], s24 offen offset:256 lds
v_cvt_pk_bf16_f32 v211, v218, v219
M v[248:251], a[180:183], a[148:151], v[248:251]
v_cvt_pk_bf16_f32 v168, v164, v165
v_cvt_pk_bf16_f32 v169, v166, v167
M v[252:255], a[180:183], a[156:159], v[252:255]
s_add_u32 s94, s92, 8192
buffer_store_dwordx4 v[120:123], v1, s[16:19], s94 offen offset:3072 sc1
v_cvt_pk_bf16_f32 v170, v196, v197
v_cvt_pk_bf16_f32 v171, v198, v199
M v[252:255], a[176:179], a[152:155], v[252:255]
v_cvt_pk_bf16_f32 v200, v180, v181
M a[0:3], a[184:187], a[96:99], a[0:3]
v_cvt_pk_bf16_f32 v201, v182, v183
v_cvt_pk_bf16_f32 v202, v212, v213
M a[0:3], a[188:191], a[100:103], a[0:3]
s_add_u32 m0, s29, 20480
s_nop 0
buffer_load_dwordx4 v2, s[8:11], s23 offen offset:0 lds
v_cvt_pk_bf16_f32 v203, v214, v215
M a[4:7], a[188:191], a[108:111], a[4:7]
v_cvt_pk_bf16_f32 v184, v172, v173
v_cvt_pk_bf16_f32 v185, v174, v175
M a[4:7], a[184:187], a[104:107], a[4:7]
v_cvt_pk_bf16_f32 v186, v204, v205
v_cvt_pk_bf16_f32 v187, v206, v207
M a[8:11], a[184:187], a[112:115], a[8:11]
s_add_u32 s94, s92, 12288
buffer_store_dwordx4 v[128:131], v1, s[16:19], s94 offen offset:0 sc1
v_cvt_pk_bf16_f32 v216, v188, v189
M a[8:11], a[188:191], a[116:119], a[8:11]
buffer_load_dwordx4 v3, s[8:11], s23 offen offset:1024 lds
v_cvt_pk_bf16_f32 v217, v190, v191
v_cvt_pk_bf16_f32 v218, v220, v221
M a[12:15], a[188:191], a[124:127], a[12:15]
v_cvt_pk_bf16_f32 v219, v222, v223
M a[12:15], a[184:187], a[120:123], a[12:15]
M a[16:19], a[184:187], a[128:131], a[16:19]
buffer_load_dwordx4 v4, s[8:11], s23 offen offset:2048 lds
M a[16:19], a[188:191], a[132:135], a[16:19]
M a[20:23], a[188:191], a[140:143], a[20:23]
s_add_u32 s94, s92, 12288
buffer_store_dwordx4 v[136:139], v1, s[16:19], s94 offen offset:1024 sc1
M a[20:23], a[184:187], a[136:139], a[20:23]
M a[24:27], a[184:187], a[144:147], a[24:27]
buffer_load_dwordx4 v5, s[8:11], s23 offen offset:3072 lds
M a[24:27], a[188:191], a[148:151], a[24:27]
M a[28:31], a[188:191], a[156:159], a[28:31]
M a[28:31], a[184:187], a[152:155], a[28:31]
v_accvgpr_read_b32 v24, a0
v_accvgpr_read_b32 v25, a1
v_accvgpr_read_b32 v26, a2
v_accvgpr_read_b32 v27, a3
v_cvt_pk_bf16_f32 v224, v224, v225
v_cvt_pk_bf16_f32 v225, v226, v227
v_cvt_pk_bf16_f32 v226, v24, v25
v_cvt_pk_bf16_f32 v227, v26, v27
v_accvgpr_read_b32 v24, a16
v_accvgpr_read_b32 v25, a17
v_accvgpr_read_b32 v26, a18
v_accvgpr_read_b32 v27, a19
v_cvt_pk_bf16_f32 v36, v240, v241
v_cvt_pk_bf16_f32 v37, v242, v243
v_cvt_pk_bf16_f32 v38, v24, v25
v_cvt_pk_bf16_f32 v39, v26, v27
v_accvgpr_read_b32 v24, a24
v_accvgpr_read_b32 v25, a25
v_accvgpr_read_b32 v26, a26
v_accvgpr_read_b32 v27, a27
v_cvt_pk_bf16_f32 v52, v248, v249
v_cvt_pk_bf16_f32 v53, v250, v251
v_cvt_pk_bf16_f32 v54, v24, v25
v_cvt_pk_bf16_f32 v55, v26, v27
v_accvgpr_read_b32 v24, a8
v_accvgpr_read_b32 v25, a9
v_accvgpr_read_b32 v26, a10
v_accvgpr_read_b32 v27, a11
v_cvt_pk_bf16_f32 v240, v232, v233
v_cvt_pk_bf16_f32 v241, v234, v235
v_cvt_pk_bf16_f32 v242, v24, v25
v_cvt_pk_bf16_f32 v243, v26, v27
v_accvgpr_read_b32 v28, a4
v_accvgpr_read_b32 v29, a5
v_accvgpr_read_b32 v30, a6
v_accvgpr_read_b32 v31, a7
v_cvt_pk_bf16_f32 v232, v228, v229
v_cvt_pk_bf16_f32 v233, v230, v231
v_cvt_pk_bf16_f32 v234, v28, v29
v_cvt_pk_bf16_f32 v235, v30, v31
v_accvgpr_read_b32 v28, a12
v_accvgpr_read_b32 v29, a13
v_accvgpr_read_b32 v30, a14
v_accvgpr_read_b32 v31, a15
v_cvt_pk_bf16_f32 v248, v236, v237
v_cvt_pk_bf16_f32 v249, v238, v239
v_cvt_pk_bf16_f32 v250, v28, v29
v_cvt_pk_bf16_f32 v251, v30, v31
v_accvgpr_read_b32 v28, a20
v_accvgpr_read_b32 v29, a21
v_accvgpr_read_b32 v30, a22
v_accvgpr_read_b32 v31, a23
v_cvt_pk_bf16_f32 v44, v244, v245
v_cvt_pk_bf16_f32 v45, v246, v247
v_cvt_pk_bf16_f32 v46, v28, v29
v_cvt_pk_bf16_f32 v47, v30, v31
v_accvgpr_read_b32 v28, a28
v_accvgpr_read_b32 v29, a29
v_accvgpr_read_b32 v30, a30
v_accvgpr_read_b32 v31, a31
v_cvt_pk_bf16_f32 v60, v252, v253
v_cvt_pk_bf16_f32 v61, v254, v255
v_cvt_pk_bf16_f32 v62, v28, v29
v_cvt_pk_bf16_f32 v63, v30, v31
Lk1_b:
v_and_b32 v24, 15, v0
v_lshlrev_b32 v24, 7, v24
v_bfe_u32 v25, v0, 1, 3
v_lshrrev_b32 v26, 4, v0
v_xor_b32 v25, v25, v26
v_lshl_add_u32 v10, v25, 4, v24
v_xor_b32 v11, 64, v10
v_add_u32 v12, 131072, v10
v_add_u32 v13, 131072, v11
v_bfe_u32 v24, v0, 2, 2
v_lshl_add_u32 v29, v26, 3, v24
v_mul_u32_u24 v25, 384, v29
v_and_b32 v27, 1, v0
v_lshl_add_u32 v25, v27, 3, v25
v_add_u32 v25, 36864, v25
v_lshrrev_b32 v24, 1, v29
v_and_b32 v24, 4, v24
v_and_or_b32 v24, v29, 2, v24
v_bfe_u32 v26, v0, 1, 1
s_mul_i32 s4, s20, 3
s_add_u32 s3, s4, 0
s_and_b32 s5, s3, 3
s_lshl_b32 s5, s5, 1
s_lshr_b32 s3, s3, 2
s_lshl_b32 s3, s3, 7
v_add_u32 v27, s5, v26
v_xor_b32 v27, v27, v24
v_lshl_add_u32 v27, v27, 4, v25
v_add_u32 v14, s3, v27
v_add_u32 v17, 61440, v14
s_add_u32 s3, s4, 1
s_and_b32 s5, s3, 3
s_lshl_b32 s5, s5, 1
s_lshr_b32 s3, s3, 2
s_lshl_b32 s3, s3, 7
v_add_u32 v27, s5, v26
v_xor_b32 v27, v27, v24
v_lshl_add_u32 v27, v27, 4, v25
v_add_u32 v15, s3, v27
v_add_u32 v18, 61440, v15
s_add_u32 s3, s4, 2
s_and_b32 s5, s3, 3
s_lshl_b32 s5, s5, 1
s_lshr_b32 s3, s3, 2
s_lshl_b32 s3, s3, 7
v_add_u32 v27, s5, v26
v_xor_b32 v27, v27, v24
v_lshl_add_u32 v27, v27, 4, v25
v_add_u32 v16, s3, v27
v_add_u32 v19, 61440, v16
s_waitcnt vmcnt(11)
s_barrier
ds_read_b64_tr_b16 a[176:177], v14 offset:28672
ds_read_b64_tr_b16 a[178:179], v14 offset:30208
ds_read_b64_tr_b16 a[184:185], v15 offset:28672
ds_read_b64_tr_b16 a[186:187], v15 offset:30208
ds_read_b64_tr_b16 a[192:193], v16 offset:28672
ds_read_b64_tr_b16 a[194:195], v16 offset:30208
ds_read_b64_tr_b16 a[180:181], v14 offset:40960
ds_read_b64_tr_b16 a[182:183], v14 offset:42496
ds_read_b64_tr_b16 a[188:189], v15 offset:40960
ds_read_b64_tr_b16 a[190:191], v15 offset:42496
ds_read_b64_tr_b16 a[196:197], v16 offset:40960
ds_read_b64_tr_b16 a[198:199], v16 offset:42496
ds_read_b128 a[224:227], v12 offset:0
ds_read_b128 a[228:231], v13 offset:0
ds_read_b128 a[232:235], v12 offset:2048
ds_read_b128 a[236:239], v13 offset:2048
ds_read_b128 a[240:243], v12 offset:4096
ds_read_b128 a[244:247], v13 offset:4096
s_waitcnt lgkmcnt(0)
s_barrier
M a[68:71], a[176:179], a[224:227], 0
ds_read_b128 a[248:251], v12 offset:6144
ds_read_b128 a[252:255], v13 offset:6144
M a[68:71], a[180:183], a[228:231], a[68:71]
s_sub_u32 s31, s31, 1
s_cmp_eq_u32 s31, 0
s_cselect_b32 s58, -1920, s57
s_add_u32 s23, s23, s58
s_add_u32 s24, s24, s58
M a[72:75], a[188:191], a[228:231], 0
ds_read_b64_tr_b16 a[200:201], v17 offset:0
ds_read_b64_tr_b16 a[202:203], v17 offset:1536
M a[72:75], a[184:187], a[224:227], a[72:75]
s_add_u32 m0, s30, 36864
s_nop 0
buffer_load_dwordx4 v6, s[12:15], s25 offen offset:0 lds
M a[76:79], a[192:195], a[224:227], 0
M a[76:79], a[196:199], a[228:231], a[76:79]
buffer_load_dwordx4 v7, s[12:15], s25 offen offset:1024 lds
M a[80:83], a[180:183], a[236:239], 0
ds_read_b128 a[224:227], v12 offset:8192
ds_read_b128 a[228:231], v13 offset:8192
M a[80:83], a[176:179], a[232:235], a[80:83]
M a[84:87], a[184:187], a[232:235], 0
ds_read_b64_tr_b16 a[208:209], v18 offset:0
ds_read_b64_tr_b16 a[210:211], v18 offset:1536
M a[84:87], a[188:191], a[236:239], a[84:87]
buffer_load_dwordx4 v8, s[12:15], s25 offen offset:2048 lds
M a[88:91], a[196:199], a[236:239], 0
M a[88:91], a[192:195], a[232:235], a[88:91]
buffer_load_dwordx4 v9, s[12:15], s25 offen offset:3072 lds
M a[92:95], a[176:179], a[240:243], 0
ds_read_b128 a[232:235], v12 offset:10240
ds_read_b128 a[236:239], v13 offset:10240
M a[92:95], a[180:183], a[244:247], a[92:95]
M a[96:99], a[188:191], a[244:247], 0
ds_read_b64_tr_b16 a[216:217], v19 offset:0
ds_read_b64_tr_b16 a[218:219], v19 offset:1536
M a[96:99], a[184:187], a[240:243], a[96:99]
s_add_u32 m0, s30, 40960
s_nop 0
buffer_load_dwordx4 v21, s[12:15], s25 offen offset:0 lds
M a[100:103], a[192:195], a[240:243], 0
buffer_load_dwordx4 v22, s[12:15], s25 offen offset:1024 lds
M a[100:103], a[196:199], a[244:247], a[100:103]
s_waitcnt lgkmcnt(10)
M a[104:107], a[180:183], a[252:255], 0
ds_read_b128 a[240:243], v12 offset:12288
ds_read_b128 a[244:247], v13 offset:12288
M a[104:107], a[176:179], a[248:251], a[104:107]
s_sub_u32 s54, s54, 1
s_cmp_eq_u32 s54, 0
s_cselect_b32 s58, s55, s56
s_add_u32 s25, s25, s58
M a[108:111], a[184:187], a[248:251], 0
ds_read_b64_tr_b16 a[204:205], v17 offset:12288
ds_read_b64_tr_b16 a[206:207], v17 offset:13824
M a[108:111], a[188:191], a[252:255], a[108:111]
M a[112:115], a[196:199], a[252:255], 0
s_add_u32 m0, s30, 65536
s_nop 0
buffer_load_dwordx4 v6, s[12:15], s25 offen offset:0 lds
M a[112:115], a[192:195], a[248:251], a[112:115]
s_waitcnt lgkmcnt(10)
M a[116:119], a[176:179], a[224:227], 0
ds_read_b128 a[248:251], v12 offset:14336
ds_read_b128 a[252:255], v13 offset:14336
M a[116:119], a[180:183], a[228:231], a[116:119]
buffer_load_dwordx4 v7, s[12:15], s25 offen offset:1024 lds
M a[120:123], a[188:191], a[228:231], 0
ds_read_b64_tr_b16 a[212:213], v18 offset:12288
ds_read_b64_tr_b16 a[214:215], v18 offset:13824
M a[120:123], a[184:187], a[224:227], a[120:123]
M a[124:127], a[192:195], a[224:227], 0
buffer_load_dwordx4 v8, s[12:15], s25 offen offset:2048 lds
M a[124:127], a[196:199], a[228:231], a[124:127]
buffer_load_dwordx4 v9, s[12:15], s25 offen offset:3072 lds
s_waitcnt lgkmcnt(10)
M a[128:131], a[180:183], a[236:239], 0
ds_read_b128 a[224:227], v12 offset:16384
ds_read_b128 a[228:231], v13 offset:16384
M a[128:131], a[176:179], a[232:235], a[128:131]
M a[132:135], a[184:187], a[232:235], 0
ds_read_b64_tr_b16 a[220:221], v19 offset:12288
ds_read_b64_tr_b16 a[222:223], v19 offset:13824
M a[132:135], a[188:191], a[236:239], a[132:135]
s_add_u32 m0, s30, 69632
s_nop 0
buffer_load_dwordx4 v21, s[12:15], s25 offen offset:0 lds
M a[136:139], a[196:199], a[236:239], 0
M a[136:139], a[192:195], a[232:235], a[136:139]
buffer_load_dwordx4 v22, s[12:15], s25 offen offset:1024 lds
s_waitcnt lgkmcnt(10)
M a[140:143], a[176:179], a[240:243], 0
M a[140:143], a[180:183], a[244:247], a[140:143]
s_sub_u32 s54, s54, 1
s_cmp_eq_u32 s54, 0
s_cselect_b32 s58, s55, s56
s_add_u32 s25, s25, s58
M a[144:147], a[188:191], a[244:247], 0
M a[144:147], a[184:187], a[240:243], a[144:147]
M a[148:151], a[192:195], a[240:243], 0
s_waitcnt vmcnt(6) lgkmcnt(0)
s_barrier
ds_read_b128 a[232:235], v10 offset:0
ds_read_b128 a[236:239], v11 offset:0
M a[148:151], a[196:199], a[244:247], a[148:151]
s_add_u32 m0, s28, 131072
s_nop 0
buffer_load_dword v20, s[8:11], s24 offen lds
M a[152:155], a[180:183], a[252:255], 0
ds_read_b128 a[240:243], v10 offset:2048
ds_read_b128 a[244:247], v11 offset:2048
M a[152:155], a[176:179], a[248:251], a[152:155]
M a[156:159], a[184:187], a[248:251], 0
buffer_load_dword v23, s[8:11], s24 offen offset:256 lds
M a[156:159], a[188:191], a[252:255], a[156:159]
M a[160:163], a[196:199], a[252:255], 0
M a[160:163], a[192:195], a[248:251], a[160:163]
s_add_u32 m0, s29, 133120
s_nop 0
buffer_load_dwordx4 v2, s[8:11], s23 offen offset:0 lds
M a[164:167], a[176:179], a[224:227], 0
ds_read_b128 a[248:251], v10 offset:4096
ds_read_b128 a[252:255], v11 offset:4096
M a[164:167], a[180:183], a[228:231], a[164:167]
M a[168:171], a[188:191], a[228:231], 0
M a[168:171], a[184:187], a[224:227], a[168:171]
buffer_load_dwordx4 v3, s[8:11], s23 offen offset:1024 lds
M a[172:175], a[192:195], a[224:227], 0
M a[172:175], a[196:199], a[228:231], a[172:175]
s_waitcnt lgkmcnt(4)
M a[68:71], a[200:203], a[232:235], a[68:71]
ds_read_b128 a[224:227], v10 offset:6144
ds_read_b128 a[228:231], v11 offset:6144
M a[68:71], a[204:207], a[236:239], a[68:71]
buffer_load_dwordx4 v4, s[8:11], s23 offen offset:2048 lds
M a[72:75], a[212:215], a[236:239], a[72:75]
ds_read_b64_tr_b16 a[176:177], v14 offset:0
ds_read_b64_tr_b16 a[178:179], v14 offset:1536
M a[72:75], a[208:211], a[232:235], a[72:75]
buffer_load_dwordx4 v5, s[8:11], s23 offen offset:3072 lds
M a[76:79], a[216:219], a[232:235], a[76:79]
M a[76:79], a[220:223], a[236:239], a[76:79]
s_sub_u32 s31, s31, 1
s_cmp_eq_u32 s31, 0
s_cselect_b32 s58, -1920, s57
s_add_u32 s23, s23, s58
s_add_u32 s24, s24, s58
s_waitcnt lgkmcnt(6)
M a[80:83], a[204:207], a[244:247], a[80:83]
ds_read_b128 a[232:235], v10 offset:8192
ds_read_b128 a[236:239], v11 offset:8192
M a[80:83], a[200:203], a[240:243], a[80:83]
M a[84:87], a[208:211], a[240:243], a[84:87]
ds_read_b64_tr_b16 a[184:185], v15 offset:0
ds_read_b64_tr_b16 a[186:187], v15 offset:1536
M a[84:87], a[212:215], a[244:247], a[84:87]
s_add_u32 m0, s30, 98304
s_nop 0
buffer_load_dwordx4 v6, s[12:15], s25 offen offset:0 lds
M a[88:91], a[220:223], a[244:247], a[88:91]
M a[88:91], a[216:219], a[240:243], a[88:91]
buffer_load_dwordx4 v7, s[12:15], s25 offen offset:1024 lds
s_waitcnt lgkmcnt(8)
M a[92:95], a[200:203], a[248:251], a[92:95]
ds_read_b128 a[240:243], v10 offset:10240
ds_read_b128 a[244:247], v11 offset:10240
M a[92:95], a[204:207], a[252:255], a[92:95]
M a[96:99], a[212:215], a[252:255], a[96:99]
ds_read_b64_tr_b16 a[192:193], v16 offset:0
ds_read_b64_tr_b16 a[194:195], v16 offset:1536
M a[96:99], a[208:211], a[248:251], a[96:99]
buffer_load_dwordx4 v8, s[12:15], s25 offen offset:2048 lds
M a[100:103], a[216:219], a[248:251], a[100:103]
M a[100:103], a[220:223], a[252:255], a[100:103]
buffer_load_dwordx4 v9, s[12:15], s25 offen offset:3072 lds
s_waitcnt lgkmcnt(10)
M a[104:107], a[204:207], a[228:231], a[104:107]
ds_read_b128 a[248:251], v10 offset:12288
ds_read_b128 a[252:255], v11 offset:12288
M a[104:107], a[200:203], a[224:227], a[104:107]
M a[108:111], a[208:211], a[224:227], a[108:111]
ds_read_b64_tr_b16 a[180:181], v14 offset:12288
ds_read_b64_tr_b16 a[182:183], v14 offset:13824
M a[108:111], a[212:215], a[228:231], a[108:111]
s_add_u32 m0, s30, 102400
s_nop 0
buffer_load_dwordx4 v21, s[12:15], s25 offen offset:0 lds
M a[112:115], a[220:223], a[228:231], a[112:115]
M a[112:115], a[216:219], a[224:227], a[112:115]
buffer_load_dwordx4 v22, s[12:15], s25 offen offset:1024 lds
s_waitcnt lgkmcnt(10)
M a[116:119], a[200:203], a[232:235], a[116:119]
ds_read_b128 a[224:227], v10 offset:14336
ds_read_b128 a[228:231], v11 offset:14336
M a[116:119], a[204:207], a[236:239], a[116:119]
M a[120:123], a[212:215], a[236:239], a[120:123]
ds_read_b64_tr_b16 a[188:189], v15 offset:12288
ds_read_b64_tr_b16 a[190:191], v15 offset:13824
M a[120:123], a[208:211], a[232:235], a[120:123]
s_sub_u32 s54, s54, 1
s_cmp_eq_u32 s54, 0
s_cselect_b32 s58, s55, s56
s_add_u32 s25, s25, s58
M a[124:127], a[216:219], a[232:235], a[124:127]
M a[124:127], a[220:223], a[236:239], a[124:127]
s_add_u32 s94, s92, 12288
buffer_store_dwordx4 v[144:147], v1, s[16:19], s94 offen offset:2048 sc1
s_waitcnt lgkmcnt(10)
M a[128:131], a[204:207], a[244:247], a[128:131]
ds_read_b128 a[232:235], v10 offset:16384
ds_read_b128 a[236:239], v11 offset:16384
M a[128:131], a[200:203], a[240:243], a[128:131]
M a[132:135], a[208:211], a[240:243], a[132:135]
ds_read_b64_tr_b16 a[196:197], v16 offset:12288
ds_read_b64_tr_b16 a[198:199], v16 offset:13824
M a[132:135], a[212:215], a[244:247], a[132:135]
s_add_u32 s94, s92, 12288
buffer_store_dwordx4 v[152:155], v1, s[16:19], s94 offen offset:3072 sc1
M a[136:139], a[220:223], a[244:247], a[136:139]
M a[136:139], a[216:219], a[240:243], a[136:139]
s_add_u32 s94, s93, 0
buffer_store_dwordx4 v[160:163], v1, s[16:19], s94 offen offset:0 sc1
s_waitcnt lgkmcnt(10)
M a[140:143], a[200:203], a[248:251], a[140:143]
M a[140:143], a[204:207], a[252:255], a[140:143]
s_add_u32 s94, s93, 0
buffer_store_dwordx4 v[168:171], v1, s[16:19], s94 offen offset:1024 sc1
M a[144:147], a[212:215], a[252:255], a[144:147]
M a[144:147], a[208:211], a[248:251], a[144:147]
M a[148:151], a[216:219], a[248:251], a[148:151]
s_waitcnt vmcnt(16) lgkmcnt(0)
s_barrier
ds_read_b128 a[240:243], v10 offset:18432
ds_read_b128 a[244:247], v11 offset:18432
M a[148:151], a[220:223], a[252:255], a[148:151]
s_add_u32 m0, s28, 0
s_nop 0
buffer_load_dword v20, s[8:11], s24 offen lds
M a[152:155], a[204:207], a[228:231], a[152:155]
ds_read_b128 a[248:251], v10 offset:20480
ds_read_b128 a[252:255], v11 offset:20480
M a[152:155], a[200:203], a[224:227], a[152:155]
M a[156:159], a[208:211], a[224:227], a[156:159]
buffer_load_dword v23, s[8:11], s24 offen offset:256 lds
M a[156:159], a[212:215], a[228:231], a[156:159]
M a[160:163], a[220:223], a[228:231], a[160:163]
M a[160:163], a[216:219], a[224:227], a[160:163]
s_add_u32 m0, s29, 2048
s_nop 0
buffer_load_dwordx4 v2, s[8:11], s23 offen offset:0 lds
M a[164:167], a[200:203], a[232:235], a[164:167]
ds_read_b128 a[224:227], v10 offset:22528
ds_read_b128 a[228:231], v11 offset:22528
M a[164:167], a[204:207], a[236:239], a[164:167]
M a[168:171], a[212:215], a[236:239], a[168:171]
M a[168:171], a[208:211], a[232:235], a[168:171]
buffer_load_dwordx4 v3, s[8:11], s23 offen offset:1024 lds
M a[172:175], a[216:219], a[232:235], a[172:175]
M a[172:175], a[220:223], a[236:239], a[172:175]
s_waitcnt lgkmcnt(4)
M a[68:71], a[176:179], a[240:243], a[68:71]
ds_read_b128 a[232:235], v10 offset:24576
ds_read_b128 a[236:239], v11 offset:24576
M a[68:71], a[180:183], a[244:247], a[68:71]
buffer_load_dwordx4 v4, s[8:11], s23 offen offset:2048 lds
M a[72:75], a[188:191], a[244:247], a[72:75]
ds_read_b64_tr_b16 a[200:201], v14 offset:28672
ds_read_b64_tr_b16 a[202:203], v14 offset:30208
M a[72:75], a[184:187], a[240:243], a[72:75]
buffer_load_dwordx4 v5, s[8:11], s23 offen offset:3072 lds
M a[76:79], a[192:195], a[240:243], a[76:79]
M a[76:79], a[196:199], a[244:247], a[76:79]
s_sub_u32 s31, s31, 1
s_cmp_eq_u32 s31, 0
s_cselect_b32 s58, -1920, s57
s_add_u32 s23, s23, s58
s_add_u32 s24, s24, s58
s_waitcnt lgkmcnt(6)
M a[80:83], a[180:183], a[252:255], a[80:83]
ds_read_b128 a[240:243], v10 offset:26624
ds_read_b128 a[244:247], v11 offset:26624
M a[80:83], a[176:179], a[248:251], a[80:83]
M a[84:87], a[184:187], a[248:251], a[84:87]
ds_read_b64_tr_b16 a[208:209], v15 offset:28672
ds_read_b64_tr_b16 a[210:211], v15 offset:30208
M a[84:87], a[188:191], a[252:255], a[84:87]
s_add_u32 m0, s30, 36864
s_nop 0
buffer_load_dwordx4 v6, s[12:15], s25 offen offset:0 lds
M a[88:91], a[196:199], a[252:255], a[88:91]
M a[88:91], a[192:195], a[248:251], a[88:91]
buffer_load_dwordx4 v7, s[12:15], s25 offen offset:1024 lds
s_waitcnt lgkmcnt(8)
M a[92:95], a[176:179], a[224:227], a[92:95]
ds_read_b128 a[248:251], v10 offset:28672
ds_read_b128 a[252:255], v11 offset:28672
M a[92:95], a[180:183], a[228:231], a[92:95]
M a[96:99], a[188:191], a[228:231], a[96:99]
ds_read_b64_tr_b16 a[216:217], v16 offset:28672
ds_read_b64_tr_b16 a[218:219], v16 offset:30208
M a[96:99], a[184:187], a[224:227], a[96:99]
buffer_load_dwordx4 v8, s[12:15], s25 offen offset:2048 lds
M a[100:103], a[192:195], a[224:227], a[100:103]
M a[100:103], a[196:199], a[228:231], a[100:103]
buffer_load_dwordx4 v9, s[12:15], s25 offen offset:3072 lds
s_waitcnt lgkmcnt(10)
M a[104:107], a[180:183], a[236:239], a[104:107]
ds_read_b128 a[224:227], v10 offset:30720
ds_read_b128 a[228:231], v11 offset:30720
M a[104:107], a[176:179], a[232:235], a[104:107]
M a[108:111], a[184:187], a[232:235], a[108:111]
ds_read_b64_tr_b16 a[204:205], v14 offset:40960
ds_read_b64_tr_b16 a[206:207], v14 offset:42496
M a[108:111], a[188:191], a[236:239], a[108:111]
s_add_u32 m0, s30, 40960
s_nop 0
buffer_load_dwordx4 v21, s[12:15], s25 offen offset:0 lds
M a[112:115], a[196:199], a[236:239], a[112:115]
M a[112:115], a[192:195], a[232:235], a[112:115]
buffer_load_dwordx4 v22, s[12:15], s25 offen offset:1024 lds
s_waitcnt lgkmcnt(10)
M a[116:119], a[176:179], a[240:243], a[116:119]
ds_read_b128 a[232:235], v10 offset:32768
ds_read_b128 a[236:239], v11 offset:32768
M a[116:119], a[180:183], a[244:247], a[116:119]
M a[120:123], a[188:191], a[244:247], a[120:123]
ds_read_b64_tr_b16 a[212:213], v15 offset:40960
ds_read_b64_tr_b16 a[214:215], v15 offset:42496
M a[120:123], a[184:187], a[240:243], a[120:123]
s_sub_u32 s54, s54, 1
s_cmp_eq_u32 s54, 0
s_cselect_b32 s58, s55, s56
s_add_u32 s25, s25, s58
M a[124:127], a[192:195], a[240:243], a[124:127]
M a[124:127], a[196:199], a[244:247], a[124:127]
s_add_u32 s94, s93, 0
buffer_store_dwordx4 v[176:179], v1, s[16:19], s94 offen offset:2048 sc1
s_waitcnt lgkmcnt(10)
M a[128:131], a[180:183], a[252:255], a[128:131]
ds_read_b128 a[240:243], v10 offset:34816
ds_read_b128 a[244:247], v11 offset:34816
M a[128:131], a[176:179], a[248:251], a[128:131]
M a[132:135], a[184:187], a[248:251], a[132:135]
ds_read_b64_tr_b16 a[220:221], v16 offset:40960
ds_read_b64_tr_b16 a[222:223], v16 offset:42496
M a[132:135], a[188:191], a[252:255], a[132:135]
s_add_u32 s94, s93, 0
buffer_store_dwordx4 v[184:187], v1, s[16:19], s94 offen offset:3072 sc1
M a[136:139], a[196:199], a[252:255], a[136:139]
M a[136:139], a[192:195], a[248:251], a[136:139]
s_add_u32 s94, s93, 4096
buffer_store_dwordx4 v[192:195], v1, s[16:19], s94 offen offset:0 sc1
s_waitcnt lgkmcnt(10)
M a[140:143], a[176:179], a[224:227], a[140:143]
M a[140:143], a[180:183], a[228:231], a[140:143]
s_add_u32 s94, s93, 4096
buffer_store_dwordx4 v[200:203], v1, s[16:19], s94 offen offset:1024 sc1
M a[144:147], a[188:191], a[228:231], a[144:147]
M a[144:147], a[184:187], a[224:227], a[144:147]
M a[148:151], a[192:195], a[224:227], a[148:151]
s_waitcnt vmcnt(20) lgkmcnt(0)
s_barrier
ds_read_b128 a[248:251], v12 offset:0
ds_read_b128 a[252:255], v13 offset:0
M a[148:151], a[196:199], a[228:231], a[148:151]
s_add_u32 m0, s28, 18432
s_nop 0
buffer_load_dword v20, s[8:11], s24 offen lds
M a[152:155], a[180:183], a[236:239], a[152:155]
ds_read_b128 a[224:227], v12 offset:2048
ds_read_b128 a[228:231], v13 offset:2048
M a[152:155], a[176:179], a[232:235], a[152:155]
M a[156:159], a[184:187], a[232:235], a[156:159]
buffer_load_dword v23, s[8:11], s24 offen offset:256 lds
M a[156:159], a[188:191], a[236:239], a[156:159]
M a[160:163], a[196:199], a[236:239], a[160:163]
M a[160:163], a[192:195], a[232:235], a[160:163]
s_add_u32 m0, s29, 20480
s_nop 0
buffer_load_dwordx4 v2, s[8:11], s23 offen offset:0 lds
M a[164:167], a[176:179], a[240:243], a[164:167]
ds_read_b128 a[232:235], v12 offset:4096
ds_read_b128 a[236:239], v13 offset:4096
M a[164:167], a[180:183], a[244:247], a[164:167]
M a[168:171], a[188:191], a[244:247], a[168:171]
M a[168:171], a[184:187], a[240:243], a[168:171]
buffer_load_dwordx4 v3, s[8:11], s23 offen offset:1024 lds
M a[172:175], a[192:195], a[240:243], a[172:175]
M a[172:175], a[196:199], a[244:247], a[172:175]
s_waitcnt lgkmcnt(4)
M a[68:71], a[200:203], a[248:251], a[68:71]
ds_read_b128 a[240:243], v12 offset:6144
ds_read_b128 a[244:247], v13 offset:6144
M a[68:71], a[204:207], a[252:255], a[68:71]
buffer_load_dwordx4 v4, s[8:11], s23 offen offset:2048 lds
M a[72:75], a[212:215], a[252:255], a[72:75]
ds_read_b64_tr_b16 a[176:177], v17 offset:0
ds_read_b64_tr_b16 a[178:179], v17 offset:1536
M a[72:75], a[208:211], a[248:251], a[72:75]
buffer_load_dwordx4 v5, s[8:11], s23 offen offset:3072 lds
M a[76:79], a[216:219], a[248:251], a[76:79]
M a[76:79], a[220:223], a[252:255], a[76:79]
s_sub_u32 s31, s31, 1
s_cmp_eq_u32 s31, 0
s_cselect_b32 s58, -1920, s57
s_add_u32 s23, s23, s58
s_add_u32 s24, s24, s58
s_waitcnt lgkmcnt(6)
M a[80:83], a[204:207], a[228:231], a[80:83]
ds_read_b128 a[248:251], v12 offset:8192
ds_read_b128 a[252:255], v13 offset:8192
M a[80:83], a[200:203], a[224:227], a[80:83]
M a[84:87], a[208:211], a[224:227], a[84:87]
ds_read_b64_tr_b16 a[184:185], v18 offset:0
ds_read_b64_tr_b16 a[186:187], v18 offset:1536
M a[84:87], a[212:215], a[228:231], a[84:87]
s_add_u32 m0, s30, 65536
s_nop 0
buffer_load_dwordx4 v6, s[12:15], s25 offen offset:0 lds
M a[88:91], a[220:223], a[228:231], a[88:91]
M a[88:91], a[216:219], a[224:227], a[88:91]
buffer_load_dwordx4 v7, s[12:15], s25 offen offset:1024 lds
s_waitcnt lgkmcnt(8)
M a[92:95], a[200:203], a[232:235], a[92:95]
ds_read_b128 a[224:227], v12 offset:10240
ds_read_b128 a[228:231], v13 offset:10240
M a[92:95], a[204:207], a[236:239], a[92:95]
M a[96:99], a[212:215], a[236:239], a[96:99]
ds_read_b64_tr_b16 a[192:193], v19 offset:0
ds_read_b64_tr_b16 a[194:195], v19 offset:1536
M a[96:99], a[208:211], a[232:235], a[96:99]
buffer_load_dwordx4 v8, s[12:15], s25 offen offset:2048 lds
M a[100:103], a[216:219], a[232:235], a[100:103]
M a[100:103], a[220:223], a[236:239], a[100:103]
buffer_load_dwordx4 v9, s[12:15], s25 offen offset:3072 lds
s_waitcnt lgkmcnt(10)
M a[104:107], a[204:207], a[244:247], a[104:107]
ds_read_b128 a[232:235], v12 offset:12288
ds_read_b128 a[236:239], v13 offset:12288
M a[104:107], a[200:203], a[240:243], a[104:107]
M a[108:111], a[208:211], a[240:243], a[108:111]
ds_read_b64_tr_b16 a[180:181], v17 offset:12288
ds_read_b64_tr_b16 a[182:183], v17 offset:13824
M a[108:111], a[212:215], a[244:247], a[108:111]
s_add_u32 m0, s30, 69632
s_nop 0
buffer_load_dwordx4 v21, s[12:15], s25 offen offset:0 lds
M a[112:115], a[220:223], a[244:247], a[112:115]
M a[112:115], a[216:219], a[240:243], a[112:115]
buffer_load_dwordx4 v22, s[12:15], s25 offen offset:1024 lds
s_waitcnt lgkmcnt(10)
M a[116:119], a[200:203], a[248:251], a[116:119]
ds_read_b128 a[240:243], v12 offset:14336
ds_read_b128 a[244:247], v13 offset:14336
M a[116:119], a[204:207], a[252:255], a[116:119]
M a[120:123], a[212:215], a[252:255], a[120:123]
ds_read_b64_tr_b16 a[188:189], v18 offset:12288
ds_read_b64_tr_b16 a[190:191], v18 offset:13824
M a[120:123], a[208:211], a[248:251], a[120:123]
s_sub_u32 s54, s54, 1
s_cmp_eq_u32 s54, 0
s_cselect_b32 s58, s55, s56
s_add_u32 s25, s25, s58
M a[124:127], a[216:219], a[248:251], a[124:127]
M a[124:127], a[220:223], a[252:255], a[124:127]
s_add_u32 s94, s93, 4096
buffer_store_dwordx4 v[208:211], v1, s[16:19], s94 offen offset:2048 sc1
s_waitcnt lgkmcnt(10)
M a[128:131], a[204:207], a[228:231], a[128:131]
ds_read_b128 a[248:251], v12 offset:16384
ds_read_b128 a[252:255], v13 offset:16384
M a[128:131], a[200:203], a[224:227], a[128:131]
M a[132:135], a[208:211], a[224:227], a[132:135]
ds_read_b64_tr_b16 a[196:197], v19 offset:12288
ds_read_b64_tr_b16 a[198:199], v19 offset:13824
M a[132:135], a[212:215], a[228:231], a[132:135]
s_add_u32 s94, s93, 4096
buffer_store_dwordx4 v[216:219], v1, s[16:19], s94 offen offset:3072 sc1
M a[136:139], a[220:223], a[228:231], a[136:139]
M a[136:139], a[216:219], a[224:227], a[136:139]
s_add_u32 s94, s93, 8192
buffer_store_dwordx4 v[224:227], v1, s[16:19], s94 offen offset:0 sc1
s_waitcnt lgkmcnt(10)
M a[140:143], a[200:203], a[232:235], a[140:143]
M a[140:143], a[204:207], a[236:239], a[140:143]
s_add_u32 s94, s93, 8192
buffer_store_dwordx4 v[232:235], v1, s[16:19], s94 offen offset:1024 sc1
M a[144:147], a[212:215], a[236:239], a[144:147]
M a[144:147], a[208:211], a[232:235], a[144:147]
M a[148:151], a[216:219], a[232:235], a[148:151]
s_waitcnt vmcnt(20) lgkmcnt(0)
s_barrier
ds_read_b128 a[224:227], v10 offset:0
ds_read_b128 a[228:231], v11 offset:0
M a[148:151], a[220:223], a[236:239], a[148:151]
s_add_u32 m0, s28, 131072
s_nop 0
buffer_load_dword v20, s[8:11], s24 offen lds
M a[152:155], a[204:207], a[244:247], a[152:155]
ds_read_b128 a[232:235], v10 offset:2048
ds_read_b128 a[236:239], v11 offset:2048
M a[152:155], a[200:203], a[240:243], a[152:155]
M a[156:159], a[208:211], a[240:243], a[156:159]
buffer_load_dword v23, s[8:11], s24 offen offset:256 lds
M a[156:159], a[212:215], a[244:247], a[156:159]
M a[160:163], a[220:223], a[244:247], a[160:163]
M a[160:163], a[216:219], a[240:243], a[160:163]
s_add_u32 m0, s29, 133120
s_nop 0
buffer_load_dwordx4 v2, s[8:11], s23 offen offset:0 lds
M a[164:167], a[200:203], a[248:251], a[164:167]
ds_read_b128 a[240:243], v10 offset:4096
ds_read_b128 a[244:247], v11 offset:4096
M a[164:167], a[204:207], a[252:255], a[164:167]
M a[168:171], a[212:215], a[252:255], a[168:171]
M a[168:171], a[208:211], a[248:251], a[168:171]
buffer_load_dwordx4 v3, s[8:11], s23 offen offset:1024 lds
M a[172:175], a[216:219], a[248:251], a[172:175]
M a[172:175], a[220:223], a[252:255], a[172:175]
s_waitcnt lgkmcnt(4)
M a[68:71], a[176:179], a[224:227], a[68:71]
ds_read_b128 a[248:251], v10 offset:6144
ds_read_b128 a[252:255], v11 offset:6144
M a[68:71], a[180:183], a[228:231], a[68:71]
buffer_load_dwordx4 v4, s[8:11], s23 offen offset:2048 lds
M a[72:75], a[188:191], a[228:231], a[72:75]
ds_read_b64_tr_b16 a[200:201], v14 offset:0
ds_read_b64_tr_b16 a[202:203], v14 offset:1536
M a[72:75], a[184:187], a[224:227], a[72:75]
buffer_load_dwordx4 v5, s[8:11], s23 offen offset:3072 lds
M a[76:79], a[192:195], a[224:227], a[76:79]
M a[76:79], a[196:199], a[228:231], a[76:79]
s_sub_u32 s31, s31, 1
s_cmp_eq_u32 s31, 0
s_cselect_b32 s58, -1920, s57
s_add_u32 s23, s23, s58
s_add_u32 s24, s24, s58
s_waitcnt lgkmcnt(6)
M a[80:83], a[180:183], a[236:239], a[80:83]
ds_read_b128 a[224:227], v10 offset:8192
ds_read_b128 a[228:231], v11 offset:8192
M a[80:83], a[176:179], a[232:235], a[80:83]
M a[84:87], a[184:187], a[232:235], a[84:87]
ds_read_b64_tr_b16 a[208:209], v15 offset:0
ds_read_b64_tr_b16 a[210:211], v15 offset:1536
M a[84:87], a[188:191], a[236:239], a[84:87]
s_add_u32 m0, s30, 98304
s_nop 0
buffer_load_dwordx4 v6, s[12:15], s25 offen offset:0 lds
M a[88:91], a[196:199], a[236:239], a[88:91]
M a[88:91], a[192:195], a[232:235], a[88:91]
buffer_load_dwordx4 v7, s[12:15], s25 offen offset:1024 lds
s_waitcnt lgkmcnt(8)
M a[92:95], a[176:179], a[240:243], a[92:95]
ds_read_b128 a[232:235], v10 offset:10240
ds_read_b128 a[236:239], v11 offset:10240
M a[92:95], a[180:183], a[244:247], a[92:95]
M a[96:99], a[188:191], a[244:247], a[96:99]
ds_read_b64_tr_b16 a[216:217], v16 offset:0
ds_read_b64_tr_b16 a[218:219], v16 offset:1536
M a[96:99], a[184:187], a[240:243], a[96:99]
buffer_load_dwordx4 v8, s[12:15], s25 offen offset:2048 lds
M a[100:103], a[192:195], a[240:243], a[100:103]
M a[100:103], a[196:199], a[244:247], a[100:103]
buffer_load_dwordx4 v9, s[12:15], s25 offen offset:3072 lds
s_waitcnt lgkmcnt(10)
M a[104:107], a[180:183], a[252:255], a[104:107]
ds_read_b128 a[240:243], v10 offset:12288
ds_read_b128 a[244:247], v11 offset:12288
M a[104:107], a[176:179], a[248:251], a[104:107]
M a[108:111], a[184:187], a[248:251], a[108:111]
ds_read_b64_tr_b16 a[204:205], v14 offset:12288
ds_read_b64_tr_b16 a[206:207], v14 offset:13824
M a[108:111], a[188:191], a[252:255], a[108:111]
s_add_u32 m0, s30, 102400
s_nop 0
buffer_load_dwordx4 v21, s[12:15], s25 offen offset:0 lds
M a[112:115], a[196:199], a[252:255], a[112:115]
M a[112:115], a[192:195], a[248:251], a[112:115]
buffer_load_dwordx4 v22, s[12:15], s25 offen offset:1024 lds
s_waitcnt lgkmcnt(10)
M a[116:119], a[176:179], a[224:227], a[116:119]
ds_read_b128 a[248:251], v10 offset:14336
ds_read_b128 a[252:255], v11 offset:14336
M a[116:119], a[180:183], a[228:231], a[116:119]
M a[120:123], a[188:191], a[228:231], a[120:123]
ds_read_b64_tr_b16 a[212:213], v15 offset:12288
ds_read_b64_tr_b16 a[214:215], v15 offset:13824
M a[120:123], a[184:187], a[224:227], a[120:123]
s_sub_u32 s54, s54, 1
s_cmp_eq_u32 s54, 0
s_cselect_b32 s58, s55, s56
s_add_u32 s25, s25, s58
M a[124:127], a[192:195], a[224:227], a[124:127]
M a[124:127], a[196:199], a[228:231], a[124:127]
s_add_u32 s94, s93, 8192
buffer_store_dwordx4 v[240:243], v1, s[16:19], s94 offen offset:2048 sc1
s_waitcnt lgkmcnt(10)
M a[128:131], a[180:183], a[236:239], a[128:131]
ds_read_b128 a[224:227], v10 offset:16384
ds_read_b128 a[228:231], v11 offset:16384
M a[128:131], a[176:179], a[232:235], a[128:131]
M a[132:135], a[184:187], a[232:235], a[132:135]
ds_read_b64_tr_b16 a[220:221], v16 offset:12288
ds_read_b64_tr_b16 a[222:223], v16 offset:13824
M a[132:135], a[188:191], a[236:239], a[132:135]
s_add_u32 s94, s93, 8192
buffer_store_dwordx4 v[248:251], v1, s[16:19], s94 offen offset:3072 sc1
M a[136:139], a[196:199], a[236:239], a[136:139]
M a[136:139], a[192:195], a[232:235], a[136:139]
s_add_u32 s94, s93, 12288
buffer_store_dwordx4 v[36:39], v1, s[16:19], s94 offen offset:0 sc1
s_waitcnt lgkmcnt(10)
M a[140:143], a[176:179], a[240:243], a[140:143]
M a[140:143], a[180:183], a[244:247], a[140:143]
s_add_u32 s94, s93, 12288
buffer_store_dwordx4 v[44:47], v1, s[16:19], s94 offen offset:1024 sc1
M a[144:147], a[188:191], a[244:247], a[144:147]
M a[144:147], a[184:187], a[240:243], a[144:147]
M a[148:151], a[192:195], a[240:243], a[148:151]
s_waitcnt vmcnt(20) lgkmcnt(0)
s_barrier
ds_read_b128 a[232:235], v10 offset:18432
ds_read_b128 a[236:239], v11 offset:18432
M a[148:151], a[196:199], a[244:247], a[148:151]
s_add_u32 m0, s28, 0
s_nop 0
buffer_load_dword v20, s[8:11], s24 offen lds
M a[152:155], a[180:183], a[252:255], a[152:155]
ds_read_b128 a[240:243], v10 offset:20480
ds_read_b128 a[244:247], v11 offset:20480
M a[152:155], a[176:179], a[248:251], a[152:155]
M a[156:159], a[184:187], a[248:251], a[156:159]
buffer_load_dword v23, s[8:11], s24 offen offset:256 lds
M a[156:159], a[188:191], a[252:255], a[156:159]
M a[160:163], a[196:199], a[252:255], a[160:163]
M a[160:163], a[192:195], a[248:251], a[160:163]
s_add_u32 m0, s29, 2048
s_nop 0
buffer_load_dwordx4 v2, s[8:11], s23 offen offset:0 lds
M a[164:167], a[176:179], a[224:227], a[164:167]
ds_read_b128 a[248:251], v10 offset:22528
ds_read_b128 a[252:255], v11 offset:22528
M a[164:167], a[180:183], a[228:231], a[164:167]
M a[168:171], a[188:191], a[228:231], a[168:171]
M a[168:171], a[184:187], a[224:227], a[168:171]
buffer_load_dwordx4 v3, s[8:11], s23 offen offset:1024 lds
M a[172:175], a[192:195], a[224:227], a[172:175]
M a[172:175], a[196:199], a[228:231], a[172:175]
s_waitcnt lgkmcnt(4)
M a[68:71], a[200:203], a[232:235], a[68:71]
ds_read_b128 a[224:227], v10 offset:24576
ds_read_b128 a[228:231], v11 offset:24576
M a[68:71], a[204:207], a[236:239], a[68:71]
buffer_load_dwordx4 v4, s[8:11], s23 offen offset:2048 lds
M a[72:75], a[212:215], a[236:239], a[72:75]
ds_read_b64_tr_b16 a[176:177], v14 offset:28672
ds_read_b64_tr_b16 a[178:179], v14 offset:30208
M a[72:75], a[208:211], a[232:235], a[72:75]
M a[76:79], a[216:219], a[232:235], a[76:79]
buffer_load_dwordx4 v5, s[8:11], s23 offen offset:3072 lds
M a[76:79], a[220:223], a[236:239], a[76:79]
s_waitcnt lgkmcnt(6)
M a[80:83], a[204:207], a[244:247], a[80:83]
ds_read_b128 a[232:235], v10 offset:26624
ds_read_b128 a[236:239], v11 offset:26624
M a[80:83], a[200:203], a[240:243], a[80:83]
s_sub_u32 s31, s31, 1
s_cmp_eq_u32 s31, 0
s_cselect_b32 s58, -1920, s57
s_add_u32 s23, s23, s58
s_add_u32 s24, s24, s58
M a[84:87], a[208:211], a[240:243], a[84:87]
ds_read_b64_tr_b16 a[184:185], v15 offset:28672
ds_read_b64_tr_b16 a[186:187], v15 offset:30208
M a[84:87], a[212:215], a[244:247], a[84:87]
M a[88:91], a[220:223], a[244:247], a[88:91]
s_add_u32 m0, s30, 36864
s_nop 0
buffer_load_dwordx4 v6, s[12:15], s25 offen offset:0 lds
M a[88:91], a[216:219], a[240:243], a[88:91]
s_waitcnt lgkmcnt(8)
M a[92:95], a[200:203], a[248:251], a[92:95]
ds_read_b128 a[240:243], v10 offset:28672
ds_read_b128 a[244:247], v11 offset:28672
M a[92:95], a[204:207], a[252:255], a[92:95]
M a[96:99], a[212:215], a[252:255], a[96:99]
ds_read_b64_tr_b16 a[192:193], v16 offset:28672
ds_read_b64_tr_b16 a[194:195], v16 offset:30208
M a[96:99], a[208:211], a[248:251], a[96:99]
buffer_load_dwordx4 v7, s[12:15], s25 offen offset:1024 lds
M a[100:103], a[216:219], a[248:251], a[100:103]
M a[100:103], a[220:223], a[252:255], a[100:103]
buffer_load_dwordx4 v8, s[12:15], s25 offen offset:2048 lds
s_waitcnt lgkmcnt(10)
M a[104:107], a[204:207], a[228:231], a[104:107]
ds_read_b128 a[248:251], v10 offset:30720
ds_read_b128 a[252:255], v11 offset:30720
M a[104:107], a[200:203], a[224:227], a[104:107]
M a[108:111], a[208:211], a[224:227], a[108:111]
ds_read_b64_tr_b16 a[180:181], v14 offset:40960
ds_read_b64_tr_b16 a[182:183], v14 offset:42496
M a[108:111], a[212:215], a[228:231], a[108:111]
buffer_load_dwordx4 v9, s[12:15], s25 offen offset:3072 lds
M a[112:115], a[220:223], a[228:231], a[112:115]
M a[112:115], a[216:219], a[224:227], a[112:115]
s_add_u32 m0, s30, 40960
s_nop 0
buffer_load_dwordx4 v21, s[12:15], s25 offen offset:0 lds
s_waitcnt lgkmcnt(10)
M a[116:119], a[200:203], a[232:235], a[116:119]
ds_read_b128 a[224:227], v10 offset:32768
ds_read_b128 a[228:231], v11 offset:32768
M a[116:119], a[204:207], a[236:239], a[116:119]
M a[120:123], a[212:215], a[236:239], a[120:123]
ds_read_b64_tr_b16 a[188:189], v15 offset:40960
ds_read_b64_tr_b16 a[190:191], v15 offset:42496
M a[120:123], a[208:211], a[232:235], a[120:123]
M a[124:127], a[216:219], a[232:235], a[124:127]
buffer_load_dwordx4 v22, s[12:15], s25 offen offset:1024 lds
M a[124:127], a[220:223], a[236:239], a[124:127]
s_waitcnt lgkmcnt(10)
M a[128:131], a[204:207], a[244:247], a[128:131]
ds_read_b128 a[232:235], v10 offset:34816
ds_read_b128 a[236:239], v11 offset:34816
M a[128:131], a[200:203], a[240:243], a[128:131]
s_sub_u32 s54, s54, 1
s_cmp_eq_u32 s54, 0
s_cselect_b32 s58, s55, s56
s_add_u32 s25, s25, s58
M a[132:135], a[208:211], a[240:243], a[132:135]
ds_read_b64_tr_b16 a[196:197], v16 offset:40960
ds_read_b64_tr_b16 a[198:199], v16 offset:42496
M a[132:135], a[212:215], a[244:247], a[132:135]
M a[136:139], a[220:223], a[244:247], a[136:139]
s_add_u32 s94, s93, 12288
buffer_store_dwordx4 v[52:55], v1, s[16:19], s94 offen offset:2048 sc1
M a[136:139], a[216:219], a[240:243], a[136:139]
s_waitcnt lgkmcnt(10)
M a[140:143], a[200:203], a[248:251], a[140:143]
s_add_u32 s94, s93, 12288
buffer_store_dwordx4 v[60:63], v1, s[16:19], s94 offen offset:3072 sc1
M a[140:143], a[204:207], a[252:255], a[140:143]
M a[144:147], a[212:215], a[252:255], a[144:147]
M a[144:147], a[208:211], a[248:251], a[144:147]
M a[148:151], a[216:219], a[248:251], a[148:151]
s_waitcnt vmcnt(18) lgkmcnt(0)
s_barrier
ds_read_b128 a[240:243], v12 offset:0
ds_read_b128 a[244:247], v13 offset:0
M a[148:151], a[220:223], a[252:255], a[148:151]
s_add_u32 m0, s28, 18432
s_nop 0
buffer_load_dword v20, s[8:11], s24 offen lds
M a[152:155], a[204:207], a[228:231], a[152:155]
ds_read_b128 a[248:251], v12 offset:2048
ds_read_b128 a[252:255], v13 offset:2048
M a[152:155], a[200:203], a[224:227], a[152:155]
M a[156:159], a[208:211], a[224:227], a[156:159]
buffer_load_dword v23, s[8:11], s24 offen offset:256 lds
M a[156:159], a[212:215], a[228:231], a[156:159]
M a[160:163], a[220:223], a[228:231], a[160:163]
M a[160:163], a[216:219], a[224:227], a[160:163]
s_add_u32 m0, s29, 20480
s_nop 0
buffer_load_dwordx4 v2, s[8:11], s23 offen offset:0 lds
M a[164:167], a[200:203], a[232:235], a[164:167]
ds_read_b128 a[224:227], v12 offset:4096
ds_read_b128 a[228:231], v13 offset:4096
M a[164:167], a[204:207], a[236:239], a[164:167]
M a[168:171], a[212:215], a[236:239], a[168:171]
M a[168:171], a[208:211], a[232:235], a[168:171]
buffer_load_dwordx4 v3, s[8:11], s23 offen offset:1024 lds
M a[172:175], a[216:219], a[232:235], a[172:175]
M a[172:175], a[220:223], a[236:239], a[172:175]
s_waitcnt lgkmcnt(4)
M a[68:71], a[176:179], a[240:243], a[68:71]
ds_read_b128 a[232:235], v12 offset:6144
ds_read_b128 a[236:239], v13 offset:6144
M a[68:71], a[180:183], a[244:247], a[68:71]
buffer_load_dwordx4 v4, s[8:11], s23 offen offset:2048 lds
M a[72:75], a[188:191], a[244:247], a[72:75]
ds_read_b64_tr_b16 a[200:201], v17 offset:0
ds_read_b64_tr_b16 a[202:203], v17 offset:1536
M a[72:75], a[184:187], a[240:243], a[72:75]
M a[76:79], a[192:195], a[240:243], a[76:79]
buffer_load_dwordx4 v5, s[8:11], s23 offen offset:3072 lds
M a[76:79], a[196:199], a[244:247], a[76:79]
s_waitcnt lgkmcnt(6)
M a[80:83], a[180:183], a[252:255], a[80:83]
ds_read_b128 a[240:243], v12 offset:8192
ds_read_b128 a[244:247], v13 offset:8192
M a[80:83], a[176:179], a[248:251], a[80:83]
M a[84:87], a[184:187], a[248:251], a[84:87]
ds_read_b64_tr_b16 a[208:209], v18 offset:0
ds_read_b64_tr_b16 a[210:211], v18 offset:1536
M a[84:87], a[188:191], a[252:255], a[84:87]
s_sub_u32 s31, s31, 1
s_cmp_eq_u32 s31, 0
s_cselect_b32 s58, -1920, s57
s_add_u32 s23, s23, s58
s_add_u32 s24, s24, s58
M a[88:91], a[196:199], a[252:255], a[88:91]
M a[88:91], a[192:195], a[248:251], a[88:91]
s_waitcnt lgkmcnt(8)
M a[92:95], a[176:179], a[224:227], a[92:95]
ds_read_b128 a[248:251], v12 offset:10240
ds_read_b128 a[252:255], v13 offset:10240
M a[92:95], a[180:183], a[228:231], a[92:95]
s_add_u32 m0, s30, 65536
s_nop 0
buffer_load_dwordx4 v6, s[12:15], s25 offen offset:0 lds
M a[96:99], a[188:191], a[228:231], a[96:99]
ds_read_b64_tr_b16 a[216:217], v19 offset:0
ds_read_b64_tr_b16 a[218:219], v19 offset:1536
M a[96:99], a[184:187], a[224:227], a[96:99]
M a[100:103], a[192:195], a[224:227], a[100:103]
buffer_load_dwordx4 v7, s[12:15], s25 offen offset:1024 lds
M a[100:103], a[196:199], a[228:231], a[100:103]
s_waitcnt lgkmcnt(10)
M a[104:107], a[180:183], a[236:239], a[104:107]
ds_read_b128 a[224:227], v12 offset:12288
ds_read_b128 a[228:231], v13 offset:12288
M a[104:107], a[176:179], a[232:235], a[104:107]
M a[108:111], a[184:187], a[232:235], a[108:111]
ds_read_b64_tr_b16 a[204:205], v17 offset:12288
ds_read_b64_tr_b16 a[206:207], v17 offset:13824
M a[108:111], a[188:191], a[236:239], a[108:111]
buffer_load_dwordx4 v8, s[12:15], s25 offen offset:2048 lds
M a[112:115], a[196:199], a[236:239], a[112:115]
M a[112:115], a[192:195], a[232:235], a[112:115]
s_waitcnt lgkmcnt(10)
M a[116:119], a[176:179], a[240:243], a[116:119]
ds_read_b128 a[232:235], v12 offset:14336
ds_read_b128 a[236:239], v13 offset:14336
M a[116:119], a[180:183], a[244:247], a[116:119]
buffer_load_dwordx4 v9, s[12:15], s25 offen offset:3072 lds
M a[120:123], a[188:191], a[244:247], a[120:123]
ds_read_b64_tr_b16 a[212:213], v18 offset:12288
ds_read_b64_tr_b16 a[214:215], v18 offset:13824
M a[120:123], a[184:187], a[240:243], a[120:123]
M a[124:127], a[192:195], a[240:243], a[124:127]
s_add_u32 m0, s30, 69632
s_nop 0
buffer_load_dwordx4 v21, s[12:15], s25 offen offset:0 lds
M a[124:127], a[196:199], a[244:247], a[124:127]
s_waitcnt lgkmcnt(10)
M a[128:131], a[180:183], a[252:255], a[128:131]
ds_read_b128 a[240:243], v12 offset:16384
ds_read_b128 a[244:247], v13 offset:16384
M a[128:131], a[176:179], a[248:251], a[128:131]
M a[132:135], a[184:187], a[248:251], a[132:135]
ds_read_b64_tr_b16 a[220:221], v19 offset:12288
ds_read_b64_tr_b16 a[222:223], v19 offset:13824
M a[132:135], a[188:191], a[252:255], a[132:135]
buffer_load_dwordx4 v22, s[12:15], s25 offen offset:1024 lds
M a[136:139], a[196:199], a[252:255], a[136:139]
M a[136:139], a[192:195], a[248:251], a[136:139]
s_waitcnt lgkmcnt(10)
M a[140:143], a[176:179], a[224:227], a[140:143]
s_sub_u32 s54, s54, 1
s_cmp_eq_u32 s54, 0
s_cselect_b32 s58, s55, s56
s_add_u32 s25, s25, s58
M a[140:143], a[180:183], a[228:231], a[140:143]
M a[144:147], a[188:191], a[228:231], a[144:147]
M a[144:147], a[184:187], a[224:227], a[144:147]
M a[148:151], a[192:195], a[224:227], a[148:151]
s_waitcnt vmcnt(12) lgkmcnt(0)
s_barrier
ds_read_b128 a[248:251], v10 offset:0
ds_read_b128 a[252:255], v11 offset:0
s_cmp_lg_u32 s101, 0
s_cbranch_scc1 Lk1_arr
v_mov_b32 v127, 1
s_and_b32 s41, s2, 128
s_mov_b64 exec, 1
buffer_atomic_add v127, off, s[36:39], s41 sc1
s_mov_b64 exec, -1
Lk1_arr:
M a[148:151], a[196:199], a[228:231], a[148:151]
s_add_u32 m0, s28, 131072
s_nop 0
buffer_load_dword v20, s[8:11], s24 offen lds
M a[152:155], a[180:183], a[236:239], a[152:155]
ds_read_b128 a[224:227], v10 offset:2048
ds_read_b128 a[228:231], v11 offset:2048
M a[152:155], a[176:179], a[232:235], a[152:155]
M a[156:159], a[184:187], a[232:235], a[156:159]
buffer_load_dword v23, s[8:11], s24 offen offset:256 lds
M a[156:159], a[188:191], a[236:239], a[156:159]
M a[160:163], a[196:199], a[236:239], a[160:163]
M a[160:163], a[192:195], a[232:235], a[160:163]
s_add_u32 m0, s29, 133120
s_nop 0
buffer_load_dwordx4 v2, s[8:11], s23 offen offset:0 lds
M a[164:167], a[176:179], a[240:243], a[164:167]
ds_read_b128 a[232:235], v10 offset:4096
ds_read_b128 a[236:239], v11 offset:4096
M a[164:167], a[180:183], a[244:247], a[164:167]
M a[168:171], a[188:191], a[244:247], a[168:171]
M a[168:171], a[184:187], a[240:243], a[168:171]
buffer_load_dwordx4 v3, s[8:11], s23 offen offset:1024 lds
M a[172:175], a[192:195], a[240:243], a[172:175]
M a[172:175], a[196:199], a[244:247], a[172:175]
s_waitcnt lgkmcnt(4)
M a[68:71], a[200:203], a[248:251], a[68:71]
ds_read_b128 a[240:243], v10 offset:6144
ds_read_b128 a[244:247], v11 offset:6144
M a[68:71], a[204:207], a[252:255], a[68:71]
buffer_load_dwordx4 v4, s[8:11], s23 offen offset:2048 lds
M a[72:75], a[212:215], a[252:255], a[72:75]
ds_read_b64_tr_b16 a[176:177], v14 offset:0
ds_read_b64_tr_b16 a[178:179], v14 offset:1536
M a[72:75], a[208:211], a[248:251], a[72:75]
M a[76:79], a[216:219], a[248:251], a[76:79]
buffer_load_dwordx4 v5, s[8:11], s23 offen offset:3072 lds
M a[76:79], a[220:223], a[252:255], a[76:79]
s_waitcnt lgkmcnt(6)
M a[80:83], a[204:207], a[228:231], a[80:83]
ds_read_b128 a[248:251], v10 offset:8192
ds_read_b128 a[252:255], v11 offset:8192
M a[80:83], a[200:203], a[224:227], a[80:83]
M a[84:87], a[208:211], a[224:227], a[84:87]
ds_read_b64_tr_b16 a[184:185], v15 offset:0
ds_read_b64_tr_b16 a[186:187], v15 offset:1536
M a[84:87], a[212:215], a[228:231], a[84:87]
s_sub_u32 s31, s31, 1
s_cmp_eq_u32 s31, 0
s_cselect_b32 s58, -1920, s57
s_add_u32 s23, s23, s58
s_add_u32 s24, s24, s58
M a[88:91], a[220:223], a[228:231], a[88:91]
M a[88:91], a[216:219], a[224:227], a[88:91]
s_waitcnt lgkmcnt(8)
M a[92:95], a[200:203], a[232:235], a[92:95]
ds_read_b128 a[224:227], v10 offset:10240
ds_read_b128 a[228:231], v11 offset:10240
M a[92:95], a[204:207], a[236:239], a[92:95]
s_add_u32 m0, s30, 98304
s_nop 0
buffer_load_dwordx4 v6, s[12:15], s25 offen offset:0 lds
M a[96:99], a[212:215], a[236:239], a[96:99]
ds_read_b64_tr_b16 a[192:193], v16 offset:0
ds_read_b64_tr_b16 a[194:195], v16 offset:1536
M a[96:99], a[208:211], a[232:235], a[96:99]
M a[100:103], a[216:219], a[232:235], a[100:103]
buffer_load_dwordx4 v7, s[12:15], s25 offen offset:1024 lds
M a[100:103], a[220:223], a[236:239], a[100:103]
s_waitcnt lgkmcnt(10)
M a[104:107], a[204:207], a[244:247], a[104:107]
ds_read_b128 a[232:235], v10 offset:12288
ds_read_b128 a[236:239], v11 offset:12288
M a[104:107], a[200:203], a[240:243], a[104:107]
M a[108:111], a[208:211], a[240:243], a[108:111]
ds_read_b64_tr_b16 a[180:181], v14 offset:12288
ds_read_b64_tr_b16 a[182:183], v14 offset:13824
M a[108:111], a[212:215], a[244:247], a[108:111]
buffer_load_dwordx4 v8, s[12:15], s25 offen offset:2048 lds
M a[112:115], a[220:223], a[244:247], a[112:115]
M a[112:115], a[216:219], a[240:243], a[112:115]
s_waitcnt lgkmcnt(10)
M a[116:119], a[200:203], a[248:251], a[116:119]
ds_read_b128 a[240:243], v10 offset:14336
ds_read_b128 a[244:247], v11 offset:14336
M a[116:119], a[204:207], a[252:255], a[116:119]
buffer_load_dwordx4 v9, s[12:15], s25 offen offset:3072 lds
M a[120:123], a[212:215], a[252:255], a[120:123]
ds_read_b64_tr_b16 a[188:189], v15 offset:12288
ds_read_b64_tr_b16 a[190:191], v15 offset:13824
M a[120:123], a[208:211], a[248:251], a[120:123]
M a[124:127], a[216:219], a[248:251], a[124:127]
s_add_u32 m0, s30, 102400
s_nop 0
buffer_load_dwordx4 v21, s[12:15], s25 offen offset:0 lds
M a[124:127], a[220:223], a[252:255], a[124:127]
s_waitcnt lgkmcnt(10)
M a[128:131], a[204:207], a[228:231], a[128:131]
ds_read_b128 a[248:251], v10 offset:16384
ds_read_b128 a[252:255], v11 offset:16384
M a[128:131], a[200:203], a[224:227], a[128:131]
M a[132:135], a[208:211], a[224:227], a[132:135]
ds_read_b64_tr_b16 a[196:197], v16 offset:12288
ds_read_b64_tr_b16 a[198:199], v16 offset:13824
M a[132:135], a[212:215], a[228:231], a[132:135]
buffer_load_dwordx4 v22, s[12:15], s25 offen offset:1024 lds
M a[136:139], a[220:223], a[228:231], a[136:139]
M a[136:139], a[216:219], a[224:227], a[136:139]
s_waitcnt lgkmcnt(10)
M a[140:143], a[200:203], a[232:235], a[140:143]
s_sub_u32 s54, s54, 1
s_cmp_eq_u32 s54, 0
s_cselect_b32 s58, s55, s56
s_add_u32 s25, s25, s58
M a[140:143], a[204:207], a[236:239], a[140:143]
M a[144:147], a[212:215], a[236:239], a[144:147]
M a[144:147], a[208:211], a[232:235], a[144:147]
M a[148:151], a[216:219], a[232:235], a[148:151]
s_waitcnt vmcnt(12) lgkmcnt(0)
s_barrier
ds_read_b128 a[224:227], v10 offset:18432
ds_read_b128 a[228:231], v11 offset:18432
M a[148:151], a[220:223], a[236:239], a[148:151]
s_add_u32 m0, s28, 0
s_nop 0
buffer_load_dword v20, s[8:11], s24 offen lds
M a[152:155], a[204:207], a[244:247], a[152:155]
ds_read_b128 a[232:235], v10 offset:20480
ds_read_b128 a[236:239], v11 offset:20480
M a[152:155], a[200:203], a[240:243], a[152:155]
M a[156:159], a[208:211], a[240:243], a[156:159]
buffer_load_dword v23, s[8:11], s24 offen offset:256 lds
M a[156:159], a[212:215], a[244:247], a[156:159]
M a[160:163], a[220:223], a[244:247], a[160:163]
M a[160:163], a[216:219], a[240:243], a[160:163]
s_add_u32 m0, s29, 2048
s_nop 0
buffer_load_dwordx4 v2, s[8:11], s23 offen offset:0 lds
M a[164:167], a[200:203], a[248:251], a[164:167]
ds_read_b128 a[240:243], v10 offset:22528
ds_read_b128 a[244:247], v11 offset:22528
M a[164:167], a[204:207], a[252:255], a[164:167]
M a[168:171], a[212:215], a[252:255], a[168:171]
M a[168:171], a[208:211], a[248:251], a[168:171]
buffer_load_dwordx4 v3, s[8:11], s23 offen offset:1024 lds
M a[172:175], a[216:219], a[248:251], a[172:175]
M a[172:175], a[220:223], a[252:255], a[172:175]
s_waitcnt lgkmcnt(4)
M a[68:71], a[176:179], a[224:227], a[68:71]
ds_read_b128 a[248:251], v10 offset:24576
ds_read_b128 a[252:255], v11 offset:24576
v_mov_b32 v160, 0
v_mov_b32 v161, 0
M a[68:71], a[180:183], a[228:231], a[68:71]
buffer_load_dwordx4 v4, s[8:11], s23 offen offset:2048 lds
M a[72:75], a[188:191], a[228:231], a[72:75]
ds_read_b64_tr_b16 a[200:201], v14 offset:28672
ds_read_b64_tr_b16 a[202:203], v14 offset:30208
v_mov_b32 v162, 0
v_mov_b32 v163, 0
M a[72:75], a[184:187], a[224:227], a[72:75]
M a[76:79], a[192:195], a[224:227], a[76:79]
buffer_load_dwordx4 v5, s[8:11], s23 offen offset:3072 lds
v_mov_b32 v164, 0
v_mov_b32 v165, 0
M a[76:79], a[196:199], a[228:231], a[76:79]
s_waitcnt lgkmcnt(6)
M a[80:83], a[180:183], a[236:239], a[80:83]
ds_read_b128 a[224:227], v10 offset:26624
ds_read_b128 a[228:231], v11 offset:26624
v_mov_b32 v166, 0
v_mov_b32 v167, 0
M a[80:83], a[176:179], a[232:235], a[80:83]
M a[84:87], a[184:187], a[232:235], a[84:87]
ds_read_b64_tr_b16 a[208:209], v15 offset:28672
ds_read_b64_tr_b16 a[210:211], v15 offset:30208
M a[84:87], a[188:191], a[236:239], a[84:87]
s_sub_u32 s31, s31, 1
s_cmp_eq_u32 s31, 0
s_cselect_b32 s58, -1920, s57
s_add_u32 s23, s23, s58
s_add_u32 s24, s24, s58
v_mov_b32 v168, 0
v_mov_b32 v169, 0
M a[88:91], a[196:199], a[236:239], a[88:91]
M a[88:91], a[192:195], a[232:235], a[88:91]
s_waitcnt lgkmcnt(8)
v_mov_b32 v170, 0
v_mov_b32 v171, 0
M a[92:95], a[176:179], a[240:243], a[92:95]
ds_read_b128 a[232:235], v10 offset:28672
ds_read_b128 a[236:239], v11 offset:28672
M a[92:95], a[180:183], a[244:247], a[92:95]
s_add_u32 m0, s30, 36864
s_nop 0
buffer_load_dwordx4 v6, s[12:15], s25 offen offset:0 lds
v_mov_b32 v172, 0
v_mov_b32 v173, 0
M a[96:99], a[188:191], a[244:247], a[96:99]
ds_read_b64_tr_b16 a[216:217], v16 offset:28672
ds_read_b64_tr_b16 a[218:219], v16 offset:30208
M a[96:99], a[184:187], a[240:243], a[96:99]
v_mov_b32 v174, 0
v_mov_b32 v175, 0
M a[100:103], a[192:195], a[240:243], a[100:103]
buffer_load_dwordx4 v7, s[12:15], s25 offen offset:1024 lds
M a[100:103], a[196:199], a[244:247], a[100:103]
s_waitcnt lgkmcnt(10)
M a[104:107], a[180:183], a[252:255], a[104:107]
ds_read_b128 a[240:243], v10 offset:30720
ds_read_b128 a[244:247], v11 offset:30720
v_mov_b32 v176, 0
v_mov_b32 v177, 0
M a[104:107], a[176:179], a[248:251], a[104:107]
M a[108:111], a[184:187], a[248:251], a[108:111]
ds_read_b64_tr_b16 a[204:205], v14 offset:40960
ds_read_b64_tr_b16 a[206:207], v14 offset:42496
v_mov_b32 v178, 0
v_mov_b32 v179, 0
M a[108:111], a[188:191], a[252:255], a[108:111]
buffer_load_dwordx4 v8, s[12:15], s25 offen offset:2048 lds
M a[112:115], a[196:199], a[252:255], a[112:115]
v_mov_b32 v180, 0
v_mov_b32 v181, 0
M a[112:115], a[192:195], a[248:251], a[112:115]
s_waitcnt lgkmcnt(10)
M a[116:119], a[176:179], a[224:227], a[116:119]
ds_read_b128 a[248:251], v10 offset:32768
ds_read_b128 a[252:255], v11 offset:32768
v_mov_b32 v182, 0
v_mov_b32 v183, 0
M a[116:119], a[180:183], a[228:231], a[116:119]
buffer_load_dwordx4 v9, s[12:15], s25 offen offset:3072 lds
M a[120:123], a[188:191], a[228:231], a[120:123]
ds_read_b64_tr_b16 a[212:213], v15 offset:40960
ds_read_b64_tr_b16 a[214:215], v15 offset:42496
M a[120:123], a[184:187], a[224:227], a[120:123]
v_mov_b32 v184, 0
v_mov_b32 v185, 0
M a[124:127], a[192:195], a[224:227], a[124:127]
s_add_u32 m0, s30, 40960
s_nop 0
buffer_load_dwordx4 v21, s[12:15], s25 offen offset:0 lds
M a[124:127], a[196:199], a[228:231], a[124:127]
s_waitcnt lgkmcnt(10)
v_mov_b32 v186, 0
v_mov_b32 v187, 0
M a[128:131], a[180:183], a[236:239], a[128:131]
ds_read_b128 a[224:227], v10 offset:34816
ds_read_b128 a[228:231], v11 offset:34816
M a[128:131], a[176:179], a[232:235], a[128:131]
v_mov_b32 v188, 0
v_mov_b32 v189, 0
M a[132:135], a[184:187], a[232:235], a[132:135]
ds_read_b64_tr_b16 a[220:221], v16 offset:40960
ds_read_b64_tr_b16 a[222:223], v16 offset:42496
M a[132:135], a[188:191], a[236:239], a[132:135]
buffer_load_dwordx4 v22, s[12:15], s25 offen offset:1024 lds
v_mov_b32 v190, 0
v_mov_b32 v191, 0
M a[136:139], a[196:199], a[236:239], a[136:139]
M a[136:139], a[192:195], a[232:235], a[136:139]
s_waitcnt lgkmcnt(10)
M a[140:143], a[176:179], a[240:243], a[140:143]
s_sub_u32 s54, s54, 1
s_cmp_eq_u32 s54, 0
s_cselect_b32 s58, s55, s56
s_add_u32 s25, s25, s58
v_mov_b32 v192, 0
v_mov_b32 v193, 0
M a[140:143], a[180:183], a[244:247], a[140:143]
M a[144:147], a[188:191], a[244:247], a[144:147]
v_mov_b32 v194, 0
v_mov_b32 v195, 0
M a[144:147], a[184:187], a[240:243], a[144:147]
M a[148:151], a[192:195], a[240:243], a[148:151]
s_waitcnt vmcnt(12) lgkmcnt(0)
s_barrier
ds_read_b128 a[232:235], v12 offset:0
ds_read_b128 a[236:239], v13 offset:0
v_mov_b32 v196, 0
v_mov_b32 v197, 0
M a[148:151], a[196:199], a[244:247], a[148:151]
s_add_u32 m0, s28, 18432
s_nop 0
buffer_load_dword v20, s[8:11], s24 offen lds
M a[152:155], a[180:183], a[252:255], a[152:155]
ds_read_b128 a[240:243], v12 offset:2048
ds_read_b128 a[244:247], v13 offset:2048
v_mov_b32 v198, 0
v_mov_b32 v199, 0
M a[152:155], a[176:179], a[248:251], a[152:155]
M a[156:159], a[184:187], a[248:251], a[156:159]
buffer_load_dword v23, s[8:11], s24 offen offset:256 lds
M a[156:159], a[188:191], a[252:255], a[156:159]
v_mov_b32 v200, 0
v_mov_b32 v201, 0
M a[160:163], a[196:199], a[252:255], a[160:163]
M a[160:163], a[192:195], a[248:251], a[160:163]
s_add_u32 m0, s29, 20480
s_nop 0
buffer_load_dwordx4 v2, s[8:11], s23 offen offset:0 lds
v_mov_b32 v202, 0
v_mov_b32 v203, 0
M a[164:167], a[176:179], a[224:227], a[164:167]
ds_read_b128 a[248:251], v12 offset:4096
ds_read_b128 a[252:255], v13 offset:4096
M a[164:167], a[180:183], a[228:231], a[164:167]
v_mov_b32 v204, 0
v_mov_b32 v205, 0
M a[168:171], a[188:191], a[228:231], a[168:171]
M a[168:171], a[184:187], a[224:227], a[168:171]
buffer_load_dwordx4 v3, s[8:11], s23 offen offset:1024 lds
v_mov_b32 v206, 0
v_mov_b32 v207, 0
M a[172:175], a[192:195], a[224:227], a[172:175]
M a[172:175], a[196:199], a[228:231], a[172:175]
s_waitcnt lgkmcnt(4)
M a[68:71], a[200:203], a[232:235], a[68:71]
ds_read_b128 a[224:227], v12 offset:6144
ds_read_b128 a[228:231], v13 offset:6144
v_and_b32 v128, 15, v0
v_mul_u32_u24 v128, 400, v128
M a[68:71], a[204:207], a[236:239], a[68:71]
buffer_load_dwordx4 v4, s[8:11], s23 offen offset:2048 lds
M a[72:75], a[212:215], a[236:239], a[72:75]
ds_read_b64_tr_b16 a[176:177], v17 offset:0
ds_read_b64_tr_b16 a[178:179], v17 offset:1536
v_lshrrev_b32 v129, 4, v0
v_lshl_add_u32 v128, v129, 3, v128
M a[72:75], a[208:211], a[232:235], a[72:75]
M a[76:79], a[216:219], a[232:235], a[76:79]
buffer_load_dwordx4 v5, s[8:11], s23 offen offset:3072 lds
s_mul_i32 s3, s20, 96
s_add_u32 s3, s3, 98304
M a[76:79], a[220:223], a[236:239], a[76:79]
s_waitcnt lgkmcnt(6)
M a[80:83], a[204:207], a[244:247], a[80:83]
ds_read_b128 a[232:235], v12 offset:8192
ds_read_b128 a[236:239], v13 offset:8192
v_add_u32 v124, s3, v128
v_and_b32 v128, 15, v0
M a[80:83], a[200:203], a[240:243], a[80:83]
M a[84:87], a[208:211], a[240:243], a[84:87]
ds_read_b64_tr_b16 a[184:185], v18 offset:0
ds_read_b64_tr_b16 a[186:187], v18 offset:1536
v_lshrrev_b32 v129, 4, v0
s_add_u32 s3, s21, 16
M a[84:87], a[212:215], a[244:247], a[84:87]
s_sub_u32 s31, s31, 1
s_cmp_eq_u32 s31, 0
s_cselect_b32 s58, -1920, s57
s_add_u32 s23, s23, s58
s_add_u32 s24, s24, s58
M a[88:91], a[220:223], a[244:247], a[88:91]
v_lshl_add_u32 v130, v128, 1, s3
s_lshl_b32 s4, s22, 6
M a[88:91], a[216:219], a[240:243], a[88:91]
s_waitcnt lgkmcnt(8)
M a[92:95], a[200:203], a[248:251], a[92:95]
ds_read_b128 a[240:243], v12 offset:10240
ds_read_b128 a[244:247], v13 offset:10240
s_add_u32 s4, s4, 98304
v_mul_u32_u24 v120, 400, v130
M a[92:95], a[204:207], a[252:255], a[92:95]
s_add_u32 m0, s30, 65536
s_nop 0
buffer_load_dwordx4 v6, s[12:15], s25 offen offset:0 lds
M a[96:99], a[212:215], a[252:255], a[96:99]
ds_read_b64_tr_b16 a[192:193], v19 offset:0
ds_read_b64_tr_b16 a[194:195], v19 offset:1536
M a[96:99], a[208:211], a[248:251], a[96:99]
v_lshl_add_u32 v120, v129, 4, v120
v_add_u32 v120, s4, v120
M a[100:103], a[216:219], a[248:251], a[100:103]
buffer_load_dwordx4 v7, s[12:15], s25 offen offset:1024 lds
M a[100:103], a[220:223], a[252:255], a[100:103]
s_waitcnt lgkmcnt(10)
v_subrev_u32 v130, 32, v130
v_max_i32 v130, 0, v130
M a[104:107], a[204:207], a[228:231], a[104:107]
ds_read_b128 a[248:251], v12 offset:12288
ds_read_b128 a[252:255], v13 offset:12288
M a[104:107], a[200:203], a[224:227], a[104:107]
v_mul_u32_u24 v121, 400, v130
v_lshl_add_u32 v121, v129, 4, v121
M a[108:111], a[208:211], a[224:227], a[108:111]
ds_read_b64_tr_b16 a[180:181], v17 offset:12288
ds_read_b64_tr_b16 a[182:183], v17 offset:13824
M a[108:111], a[212:215], a[228:231], a[108:111]
buffer_load_dwordx4 v8, s[12:15], s25 offen offset:2048 lds
v_add_u32 v121, s4, v121
v_bfe_u32 v131, v0, 2, 2
M a[112:115], a[220:223], a[228:231], a[112:115]
M a[112:115], a[216:219], a[224:227], a[112:115]
s_waitcnt lgkmcnt(10)
v_lshl_add_u32 v131, v129, 2, v131
v_lshl_add_u32 v131, v131, 1, s3
M a[116:119], a[200:203], a[232:235], a[116:119]
ds_read_b128 a[224:227], v12 offset:14336
ds_read_b128 a[228:231], v13 offset:14336
M a[116:119], a[204:207], a[236:239], a[116:119]
buffer_load_dwordx4 v9, s[12:15], s25 offen offset:3072 lds
v_and_b32 v132, 3, v0
v_lshlrev_b32 v132, 3, v132
M a[120:123], a[212:215], a[236:239], a[120:123]
ds_read_b64_tr_b16 a[188:189], v18 offset:12288
ds_read_b64_tr_b16 a[190:191], v18 offset:13824
M a[120:123], a[208:211], a[232:235], a[120:123]
M a[124:127], a[216:219], a[232:235], a[124:127]
s_add_u32 m0, s30, 69632
s_nop 0
buffer_load_dwordx4 v21, s[12:15], s25 offen offset:0 lds
v_add_u32 v132, s4, v132
s_movk_i32 s5, 400
M a[124:127], a[220:223], a[236:239], a[124:127]
s_waitcnt lgkmcnt(10)
M a[128:131], a[204:207], a[244:247], a[128:131]
ds_read_b128 a[232:235], v12 offset:16384
ds_read_b128 a[236:239], v13 offset:16384
v_mad_u32_u24 v122, v131, s5, v132
v_subrev_u32 v131, 32, v131
M a[128:131], a[200:203], a[240:243], a[128:131]
M a[132:135], a[208:211], a[240:243], a[132:135]
ds_read_b64_tr_b16 a[196:197], v19 offset:12288
ds_read_b64_tr_b16 a[198:199], v19 offset:13824
v_max_i32 v131, 0, v131
v_mad_u32_u24 v123, v131, s5, v132
M a[132:135], a[212:215], a[244:247], a[132:135]
buffer_load_dwordx4 v22, s[12:15], s25 offen offset:1024 lds
M a[136:139], a[220:223], a[244:247], a[136:139]
v_lshlrev_b32 v129, 2, v129
v_sub_u32 v128, v128, v129
M a[136:139], a[216:219], a[240:243], a[136:139]
s_waitcnt lgkmcnt(10)
M a[140:143], a[200:203], a[248:251], a[140:143]
s_sub_u32 s54, s54, 1
s_cmp_eq_u32 s54, 0
s_cselect_b32 s58, s55, s56
s_add_u32 s25, s25, s58
v_mov_b32 v129, 0xf149f2ca
s_cmp_eq_u32 s26, 0
s_cselect_b32 s3, 0xf149f2ca, 0
M a[140:143], a[204:207], a[252:255], a[140:143]
M a[144:147], a[212:215], a[252:255], a[144:147]
v_cmp_lt_i32 vcc, -9, v128
s_nop 1
v_cndmask_b32 v144, 0, v129, vcc
M a[144:147], a[208:211], a[248:251], a[144:147]
M a[148:151], a[216:219], a[248:251], a[148:151]
s_waitcnt vmcnt(12) lgkmcnt(0)
s_barrier
ds_read_b128 a[240:243], v10 offset:0
ds_read_b128 a[244:247], v11 offset:0
M a[148:151], a[220:223], a[252:255], a[148:151]
s_add_u32 m0, s28, 131072
s_nop 0
buffer_load_dword v20, s[8:11], s24 offen lds
v_subrev_u32 v130, 0, v128
v_cmp_lt_u32 vcc, 7, v130
s_nop 1
v_cndmask_b32 v148, 0, v129, vcc
M a[152:155], a[204:207], a[228:231], a[152:155]
ds_read_b128 a[248:251], v10 offset:2048
ds_read_b128 a[252:255], v11 offset:2048
M a[152:155], a[200:203], a[224:227], a[152:155]
v_min_f32 v152, s3, v144
v_mov_b32 v156, 0x3f803f80
M a[156:159], a[208:211], a[224:227], a[156:159]
buffer_load_dword v23, s[8:11], s24 offen offset:256 lds
M a[156:159], a[212:215], a[228:231], a[156:159]
v_cmp_lt_i32 vcc, -8, v128
s_nop 1
v_cndmask_b32 v145, 0, v129, vcc
M a[160:163], a[220:223], a[228:231], a[160:163]
M a[160:163], a[216:219], a[224:227], a[160:163]
s_add_u32 m0, s29, 133120
s_nop 0
buffer_load_dwordx4 v2, s[8:11], s23 offen offset:0 lds
v_subrev_u32 v130, 1, v128
v_cmp_lt_u32 vcc, 7, v130
s_nop 1
v_cndmask_b32 v149, 0, v129, vcc
M a[164:167], a[200:203], a[232:235], a[164:167]
ds_read_b128 a[224:227], v10 offset:4096
ds_read_b128 a[228:231], v11 offset:4096
M a[164:167], a[204:207], a[236:239], a[164:167]
v_min_f32 v153, s3, v145
v_mov_b32 v157, 0x3f803f80
M a[168:171], a[212:215], a[236:239], a[168:171]
M a[168:171], a[208:211], a[232:235], a[168:171]
buffer_load_dwordx4 v3, s[8:11], s23 offen offset:1024 lds
v_cmp_lt_i32 vcc, -7, v128
s_nop 1
v_cndmask_b32 v146, 0, v129, vcc
M a[172:175], a[216:219], a[232:235], a[172:175]
M a[172:175], a[220:223], a[236:239], a[172:175]
s_waitcnt lgkmcnt(4)
M a[68:71], a[176:179], a[240:243], a[68:71]
ds_read_b128 a[232:235], v10 offset:6144
ds_read_b128 a[236:239], v11 offset:6144
v_subrev_u32 v130, 2, v128
v_cmp_lt_u32 vcc, 7, v130
s_nop 1
v_cndmask_b32 v150, 0, v129, vcc
M a[68:71], a[180:183], a[244:247], a[68:71]
buffer_load_dwordx4 v4, s[8:11], s23 offen offset:2048 lds
v_min_f32 v154, s3, v146
v_mov_b32 v158, 0x3f803f80
M a[72:75], a[188:191], a[244:247], a[72:75]
ds_read_b64_tr_b16 a[200:201], v14 offset:0
ds_read_b64_tr_b16 a[202:203], v14 offset:1536
M a[72:75], a[184:187], a[240:243], a[72:75]
v_cmp_lt_i32 vcc, -6, v128
s_nop 1
v_cndmask_b32 v147, 0, v129, vcc
M a[76:79], a[192:195], a[240:243], a[76:79]
buffer_load_dwordx4 v5, s[8:11], s23 offen offset:3072 lds
v_subrev_u32 v130, 3, v128
v_cmp_lt_u32 vcc, 7, v130
s_nop 1
v_cndmask_b32 v151, 0, v129, vcc
M a[76:79], a[196:199], a[244:247], a[76:79]
s_waitcnt lgkmcnt(6)
M a[80:83], a[180:183], a[252:255], a[80:83]
ds_read_b128 a[240:243], v10 offset:8192
ds_read_b128 a[244:247], v11 offset:8192
v_min_f32 v155, s3, v147
v_mov_b32 v159, 0x3f803f80
M a[80:83], a[176:179], a[248:251], a[80:83]
s_add_u32 s16, s50, 83886080
s_addc_u32 s17, s51, 0
M a[84:87], a[184:187], a[248:251], a[84:87]
ds_read_b64_tr_b16 a[208:209], v15 offset:0
ds_read_b64_tr_b16 a[210:211], v15 offset:1536
M a[84:87], a[188:191], a[252:255], a[84:87]
s_sub_u32 s31, s31, 1
s_cmp_eq_u32 s31, 0
s_cselect_b32 s58, -1920, s57
s_add_u32 s23, s23, s58
s_add_u32 s24, s24, s58
s_mov_b32 s18, 4194304
s_mov_b32 s19, 0x00020000
M a[88:91], a[196:199], a[252:255], a[88:91]
s_lshl_b32 s3, s26, 18
s_lshl_b32 s4, s27, 14
M a[88:91], a[192:195], a[248:251], a[88:91]
s_waitcnt lgkmcnt(8)
M a[92:95], a[176:179], a[224:227], a[92:95]
ds_read_b128 a[248:251], v10 offset:10240
ds_read_b128 a[252:255], v11 offset:10240
s_add_u32 s3, s3, s4
s_lshl_b32 s4, s21, 13
M a[92:95], a[180:183], a[228:231], a[92:95]
s_add_u32 m0, s30, 98304
s_nop 0
buffer_load_dwordx4 v6, s[12:15], s25 offen offset:0 lds
s_add_u32 s3, s3, s4
s_lshl_b32 s4, s22, 10
M a[96:99], a[188:191], a[228:231], a[96:99]
ds_read_b64_tr_b16 a[216:217], v16 offset:0
ds_read_b64_tr_b16 a[218:219], v16 offset:1536
M a[96:99], a[184:187], a[224:227], a[96:99]
s_add_u32 s6, s3, s4
s_mov_b32 s7, 0x3e8293ee
M a[100:103], a[192:195], a[224:227], a[100:103]
buffer_load_dwordx4 v7, s[12:15], s25 offen offset:1024 lds
s_lshl_b32 s65, s26, 8
s_lshl_b32 s3, s27, 4
M a[100:103], a[196:199], a[228:231], a[100:103]
s_waitcnt lgkmcnt(10)
M a[104:107], a[180:183], a[236:239], a[104:107]
ds_read_b128 a[224:227], v10 offset:12288
ds_read_b128 a[228:231], v11 offset:12288
s_add_u32 s65, s65, s3
s_lshl_b32 s3, s101, 2
M a[104:107], a[176:179], a[232:235], a[104:107]
s_add_u32 s65, s65, s3
s_add_u32 s65, s65, 8400896
M a[108:111], a[184:187], a[232:235], a[108:111]
ds_read_b64_tr_b16 a[204:205], v14 offset:12288
ds_read_b64_tr_b16 a[206:207], v14 offset:13824
M a[108:111], a[188:191], a[236:239], a[108:111]
buffer_load_dwordx4 v8, s[12:15], s25 offen offset:2048 lds
s_mov_b32 s40, 0
v_mov_b32 v119, 0
M a[112:115], a[196:199], a[236:239], a[112:115]
s_mov_b64 s[4:5], s[50:51]
s_and_b32 s20, s2, 7
M a[112:115], a[192:195], a[232:235], a[112:115]
s_waitcnt lgkmcnt(10)
M a[116:119], a[176:179], a[240:243], a[116:119]
ds_read_b128 a[232:235], v10 offset:14336
ds_read_b128 a[236:239], v11 offset:14336
s_lshr_b32 s33, s2, 6
s_lshl_b32 s33, s33, 3
M a[116:119], a[180:183], a[244:247], a[116:119]
buffer_load_dwordx4 v9, s[12:15], s25 offen offset:3072 lds
s_add_u32 s20, s20, s33
s_bfe_u32 s21, s2, 0x30003
M a[120:123], a[188:191], a[244:247], a[120:123]
ds_read_b64_tr_b16 a[212:213], v15 offset:12288
ds_read_b64_tr_b16 a[214:215], v15 offset:13824
M a[120:123], a[184:187], a[240:243], a[120:123]
s_sub_u32 s35, 15, s21
s_cmp_lt_u32 s101, 2
s_cselect_b32 s35, s21, s35
M a[124:127], a[192:195], a[240:243], a[124:127]
s_add_u32 m0, s30, 102400
s_nop 0
buffer_load_dwordx4 v21, s[12:15], s25 offen offset:0 lds
s_lshl_b32 s33, s20, 7
s_lshl_b32 s34, s35, 3
M a[124:127], a[196:199], a[244:247], a[124:127]
s_waitcnt lgkmcnt(10)
M a[128:131], a[180:183], a[252:255], a[128:131]
ds_read_b128 a[240:243], v10 offset:16384
ds_read_b128 a[244:247], v11 offset:16384
s_add_u32 s33, s33, s34
s_and_b32 s34, s101, 1
M a[128:131], a[176:179], a[248:251], a[128:131]
s_lshl_b32 s34, s34, 2
s_add_u32 s33, s33, s34
M a[132:135], a[184:187], a[248:251], a[132:135]
ds_read_b64_tr_b16 a[220:221], v16 offset:12288
ds_read_b64_tr_b16 a[222:223], v16 offset:13824
M a[132:135], a[188:191], a[252:255], a[132:135]
buffer_load_dwordx4 v22, s[12:15], s25 offen offset:1024 lds
s_lshl_b32 s64, s33, 12
s_mov_b32 s44, s4
M a[136:139], a[196:199], a[252:255], a[136:139]
s_mov_b32 s45, s5
s_mov_b32 s46, 16777216
M a[136:139], a[192:195], a[248:251], a[136:139]
s_waitcnt lgkmcnt(10)
M a[140:143], a[176:179], a[224:227], a[140:143]
s_sub_u32 s54, s54, 1
s_cmp_eq_u32 s54, 0
s_cselect_b32 s58, s55, s56
s_add_u32 s25, s25, s58
s_mov_b32 s47, 0x00020000
M a[140:143], a[180:183], a[228:231], a[140:143]
M a[144:147], a[188:191], a[228:231], a[144:147]
M a[144:147], a[184:187], a[224:227], a[144:147]
M a[148:151], a[192:195], a[224:227], a[148:151]
s_waitcnt vmcnt(12) lgkmcnt(0)
s_barrier
ds_read_b128 a[248:251], v10 offset:18432
ds_read_b128 a[252:255], v11 offset:18432
M a[148:151], a[196:199], a[228:231], a[148:151]
s_add_u32 m0, s28, 0
s_nop 0
buffer_load_dword v20, s[8:11], s24 offen lds
M a[152:155], a[180:183], a[236:239], a[152:155]
ds_read_b128 a[224:227], v10 offset:20480
ds_read_b128 a[228:231], v11 offset:20480
M a[152:155], a[176:179], a[232:235], a[152:155]
M a[156:159], a[184:187], a[232:235], a[156:159]
buffer_load_dword v23, s[8:11], s24 offen offset:256 lds
M a[156:159], a[188:191], a[236:239], a[156:159]
M a[160:163], a[196:199], a[236:239], a[160:163]
M a[160:163], a[192:195], a[232:235], a[160:163]
s_add_u32 m0, s29, 2048
s_nop 0
buffer_load_dwordx4 v2, s[8:11], s23 offen offset:0 lds
M a[164:167], a[176:179], a[240:243], a[164:167]
ds_read_b128 a[232:235], v10 offset:22528
ds_read_b128 a[236:239], v11 offset:22528
M a[164:167], a[180:183], a[244:247], a[164:167]
M a[168:171], a[188:191], a[244:247], a[168:171]
M a[168:171], a[184:187], a[240:243], a[168:171]
buffer_load_dwordx4 v3, s[8:11], s23 offen offset:1024 lds
M a[172:175], a[192:195], a[240:243], a[172:175]
M a[172:175], a[196:199], a[244:247], a[172:175]
s_waitcnt lgkmcnt(4)
M a[68:71], a[200:203], a[248:251], a[68:71]
ds_read_b128 a[240:243], v10 offset:24576
ds_read_b128 a[244:247], v11 offset:24576
M a[68:71], a[204:207], a[252:255], a[68:71]
buffer_load_dwordx4 v4, s[8:11], s23 offen offset:2048 lds
M a[72:75], a[212:215], a[252:255], a[72:75]
ds_read_b64_tr_b16 a[176:177], v14 offset:28672
ds_read_b64_tr_b16 a[178:179], v14 offset:30208
M a[72:75], a[208:211], a[248:251], a[72:75]
M a[76:79], a[216:219], a[248:251], a[76:79]
buffer_load_dwordx4 v5, s[8:11], s23 offen offset:3072 lds
M a[76:79], a[220:223], a[252:255], a[76:79]
s_waitcnt lgkmcnt(6)
M a[80:83], a[204:207], a[228:231], a[80:83]
ds_read_b128 a[248:251], v10 offset:26624
ds_read_b128 a[252:255], v11 offset:26624
M a[80:83], a[200:203], a[224:227], a[80:83]
M a[84:87], a[208:211], a[224:227], a[84:87]
ds_read_b64_tr_b16 a[184:185], v15 offset:28672
ds_read_b64_tr_b16 a[186:187], v15 offset:30208
M a[84:87], a[212:215], a[228:231], a[84:87]
s_sub_u32 s31, s31, 1
s_cmp_eq_u32 s31, 0
s_cselect_b32 s58, -1920, s57
s_add_u32 s23, s23, s58
s_add_u32 s24, s24, s58
M a[88:91], a[220:223], a[228:231], a[88:91]
M a[88:91], a[216:219], a[224:227], a[88:91]
s_waitcnt lgkmcnt(8)
M a[92:95], a[200:203], a[232:235], a[92:95]
ds_read_b128 a[224:227], v10 offset:28672
ds_read_b128 a[228:231], v11 offset:28672
M a[92:95], a[204:207], a[236:239], a[92:95]
s_add_u32 m0, s30, 36864
s_nop 0
buffer_load_dwordx4 v6, s[12:15], s25 offen offset:0 lds
M a[96:99], a[212:215], a[236:239], a[96:99]
ds_read_b64_tr_b16 a[192:193], v16 offset:28672
ds_read_b64_tr_b16 a[194:195], v16 offset:30208
M a[96:99], a[208:211], a[232:235], a[96:99]
M a[100:103], a[216:219], a[232:235], a[100:103]
buffer_load_dwordx4 v7, s[12:15], s25 offen offset:1024 lds
M a[100:103], a[220:223], a[236:239], a[100:103]
s_waitcnt lgkmcnt(10)
M a[104:107], a[204:207], a[244:247], a[104:107]
ds_read_b128 a[232:235], v10 offset:30720
ds_read_b128 a[236:239], v11 offset:30720
M a[104:107], a[200:203], a[240:243], a[104:107]
M a[108:111], a[208:211], a[240:243], a[108:111]
ds_read_b64_tr_b16 a[180:181], v14 offset:40960
ds_read_b64_tr_b16 a[182:183], v14 offset:42496
M a[108:111], a[212:215], a[244:247], a[108:111]
buffer_load_dwordx4 v8, s[12:15], s25 offen offset:2048 lds
M a[112:115], a[220:223], a[244:247], a[112:115]
M a[112:115], a[216:219], a[240:243], a[112:115]
s_waitcnt lgkmcnt(10)
M a[116:119], a[200:203], a[248:251], a[116:119]
ds_read_b128 a[240:243], v10 offset:32768
ds_read_b128 a[244:247], v11 offset:32768
M a[116:119], a[204:207], a[252:255], a[116:119]
buffer_load_dwordx4 v9, s[12:15], s25 offen offset:3072 lds
M a[120:123], a[212:215], a[252:255], a[120:123]
ds_read_b64_tr_b16 a[188:189], v15 offset:40960
ds_read_b64_tr_b16 a[190:191], v15 offset:42496
M a[120:123], a[208:211], a[248:251], a[120:123]
M a[124:127], a[216:219], a[248:251], a[124:127]
s_add_u32 m0, s30, 40960
s_nop 0
buffer_load_dwordx4 v21, s[12:15], s25 offen offset:0 lds
M a[124:127], a[220:223], a[252:255], a[124:127]
s_waitcnt lgkmcnt(10)
M a[128:131], a[204:207], a[228:231], a[128:131]
ds_read_b128 a[248:251], v10 offset:34816
ds_read_b128 a[252:255], v11 offset:34816
M a[128:131], a[200:203], a[224:227], a[128:131]
M a[132:135], a[208:211], a[224:227], a[132:135]
ds_read_b64_tr_b16 a[196:197], v16 offset:40960
ds_read_b64_tr_b16 a[198:199], v16 offset:42496
M a[132:135], a[212:215], a[228:231], a[132:135]
buffer_load_dwordx4 v22, s[12:15], s25 offen offset:1024 lds
M a[136:139], a[220:223], a[228:231], a[136:139]
M a[136:139], a[216:219], a[224:227], a[136:139]
s_waitcnt lgkmcnt(10)
M a[140:143], a[200:203], a[232:235], a[140:143]
s_sub_u32 s54, s54, 1
s_cmp_eq_u32 s54, 0
s_cselect_b32 s58, s55, s56
s_add_u32 s25, s25, s58
M a[140:143], a[204:207], a[236:239], a[140:143]
M a[144:147], a[212:215], a[236:239], a[144:147]
M a[144:147], a[208:211], a[232:235], a[144:147]
M a[148:151], a[216:219], a[232:235], a[148:151]
s_waitcnt vmcnt(12) lgkmcnt(0)
s_barrier
ds_read_b128 a[224:227], v12 offset:0
ds_read_b128 a[228:231], v13 offset:0
M a[148:151], a[220:223], a[236:239], a[148:151]
s_add_u32 m0, s28, 18432
s_nop 0
buffer_load_dword v20, s[8:11], s24 offen lds
M a[152:155], a[204:207], a[244:247], a[152:155]
ds_read_b128 a[232:235], v12 offset:2048
ds_read_b128 a[236:239], v13 offset:2048
M a[152:155], a[200:203], a[240:243], a[152:155]
M a[156:159], a[208:211], a[240:243], a[156:159]
buffer_load_dword v23, s[8:11], s24 offen offset:256 lds
M a[156:159], a[212:215], a[244:247], a[156:159]
M a[160:163], a[220:223], a[244:247], a[160:163]
M a[160:163], a[216:219], a[240:243], a[160:163]
s_add_u32 m0, s29, 20480
s_nop 0
buffer_load_dwordx4 v2, s[8:11], s23 offen offset:0 lds
M a[164:167], a[200:203], a[248:251], a[164:167]
ds_read_b128 a[240:243], v12 offset:4096
ds_read_b128 a[244:247], v13 offset:4096
M a[164:167], a[204:207], a[252:255], a[164:167]
M a[168:171], a[212:215], a[252:255], a[168:171]
M a[168:171], a[208:211], a[248:251], a[168:171]
buffer_load_dwordx4 v3, s[8:11], s23 offen offset:1024 lds
M a[172:175], a[216:219], a[248:251], a[172:175]
M a[172:175], a[220:223], a[252:255], a[172:175]
s_waitcnt lgkmcnt(4)
M a[68:71], a[176:179], a[224:227], a[68:71]
ds_read_b128 a[248:251], v12 offset:6144
ds_read_b128 a[252:255], v13 offset:6144
M a[68:71], a[180:183], a[228:231], a[68:71]
buffer_load_dwordx4 v4, s[8:11], s23 offen offset:2048 lds
M a[72:75], a[188:191], a[228:231], a[72:75]
ds_read_b64_tr_b16 a[200:201], v17 offset:0
ds_read_b64_tr_b16 a[202:203], v17 offset:1536
M a[72:75], a[184:187], a[224:227], a[72:75]
M a[76:79], a[192:195], a[224:227], a[76:79]
buffer_load_dwordx4 v5, s[8:11], s23 offen offset:3072 lds
M a[76:79], a[196:199], a[228:231], a[76:79]
s_waitcnt lgkmcnt(6)
M a[80:83], a[180:183], a[236:239], a[80:83]
ds_read_b128 a[224:227], v12 offset:8192
ds_read_b128 a[228:231], v13 offset:8192
M a[80:83], a[176:179], a[232:235], a[80:83]
s_sub_u32 s31, s31, 1
s_cmp_eq_u32 s31, 0
s_cselect_b32 s58, -1920, s57
s_add_u32 s23, s23, s58
s_add_u32 s24, s24, s58
M a[84:87], a[184:187], a[232:235], a[84:87]
ds_read_b64_tr_b16 a[208:209], v18 offset:0
ds_read_b64_tr_b16 a[210:211], v18 offset:1536
M a[84:87], a[188:191], a[236:239], a[84:87]
M a[88:91], a[196:199], a[236:239], a[88:91]
M a[88:91], a[192:195], a[232:235], a[88:91]
s_add_u32 m0, s30, 65536
s_nop 0
buffer_load_dwordx4 v6, s[12:15], s25 offen offset:0 lds
s_waitcnt lgkmcnt(8)
M a[92:95], a[176:179], a[240:243], a[92:95]
ds_read_b128 a[232:235], v12 offset:10240
ds_read_b128 a[236:239], v13 offset:10240
M a[92:95], a[180:183], a[244:247], a[92:95]
M a[96:99], a[188:191], a[244:247], a[96:99]
ds_read_b64_tr_b16 a[216:217], v19 offset:0
ds_read_b64_tr_b16 a[218:219], v19 offset:1536
M a[96:99], a[184:187], a[240:243], a[96:99]
buffer_load_dwordx4 v7, s[12:15], s25 offen offset:1024 lds
M a[100:103], a[192:195], a[240:243], a[100:103]
M a[100:103], a[196:199], a[244:247], a[100:103]
s_waitcnt lgkmcnt(10)
M a[104:107], a[180:183], a[252:255], a[104:107]
ds_read_b128 a[240:243], v12 offset:12288
ds_read_b128 a[244:247], v13 offset:12288
M a[104:107], a[176:179], a[248:251], a[104:107]
buffer_load_dwordx4 v8, s[12:15], s25 offen offset:2048 lds
M a[108:111], a[184:187], a[248:251], a[108:111]
ds_read_b64_tr_b16 a[204:205], v17 offset:12288
ds_read_b64_tr_b16 a[206:207], v17 offset:13824
M a[108:111], a[188:191], a[252:255], a[108:111]
M a[112:115], a[196:199], a[252:255], a[112:115]
buffer_load_dwordx4 v9, s[12:15], s25 offen offset:3072 lds
M a[112:115], a[192:195], a[248:251], a[112:115]
s_waitcnt lgkmcnt(10)
M a[116:119], a[176:179], a[224:227], a[116:119]
ds_read_b128 a[248:251], v12 offset:14336
ds_read_b128 a[252:255], v13 offset:14336
M a[116:119], a[180:183], a[228:231], a[116:119]
M a[120:123], a[188:191], a[228:231], a[120:123]
ds_read_b64_tr_b16 a[212:213], v18 offset:12288
ds_read_b64_tr_b16 a[214:215], v18 offset:13824
M a[120:123], a[184:187], a[224:227], a[120:123]
s_add_u32 m0, s30, 69632
s_nop 0
buffer_load_dwordx4 v21, s[12:15], s25 offen offset:0 lds
M a[124:127], a[192:195], a[224:227], a[124:127]
M a[124:127], a[196:199], a[228:231], a[124:127]
buffer_load_dwordx4 v22, s[12:15], s25 offen offset:1024 lds
s_waitcnt lgkmcnt(10)
M a[128:131], a[180:183], a[236:239], a[128:131]
ds_read_b128 a[224:227], v12 offset:16384
ds_read_b128 a[228:231], v13 offset:16384
M a[128:131], a[176:179], a[232:235], a[128:131]
M a[132:135], a[184:187], a[232:235], a[132:135]
ds_read_b64_tr_b16 a[220:221], v19 offset:12288
ds_read_b64_tr_b16 a[222:223], v19 offset:13824
M a[132:135], a[188:191], a[236:239], a[132:135]
M a[136:139], a[196:199], a[236:239], a[136:139]
s_sub_u32 s54, s54, 1
s_cmp_eq_u32 s54, 0
s_cselect_b32 s58, s55, s56
s_add_u32 s25, s25, s58
M a[136:139], a[192:195], a[232:235], a[136:139]
s_waitcnt lgkmcnt(10)
M a[140:143], a[176:179], a[240:243], a[140:143]
buffer_load_dword v125, v119, s[36:39], 0 offen sc1
M a[140:143], a[180:183], a[244:247], a[140:143]
M a[144:147], a[188:191], a[244:247], a[144:147]
M a[144:147], a[184:187], a[240:243], a[144:147]
M a[148:151], a[192:195], a[240:243], a[148:151]
s_waitcnt vmcnt(13) lgkmcnt(0)
s_barrier
ds_read_b128 a[232:235], v10 offset:0
ds_read_b128 a[236:239], v11 offset:0
s_waitcnt vmcnt(0)
v_cmp_gt_u32 vcc, 0x80, v125
s_nop 0
s_cbranch_vccnz Lk1_spinq
Lk1_gotq:
M a[148:151], a[196:199], a[244:247], a[148:151]
s_add_u32 m0, s28, 131072
s_nop 0
buffer_load_dword v20, s[8:11], s24 offen lds
M a[152:155], a[180:183], a[252:255], a[152:155]
ds_read_b128 a[240:243], v10 offset:2048
ds_read_b128 a[244:247], v11 offset:2048
M a[152:155], a[176:179], a[248:251], a[152:155]
M a[156:159], a[184:187], a[248:251], a[156:159]
buffer_load_dword v23, s[8:11], s24 offen offset:256 lds
M a[156:159], a[188:191], a[252:255], a[156:159]
M a[160:163], a[196:199], a[252:255], a[160:163]
M a[160:163], a[192:195], a[248:251], a[160:163]
s_add_u32 m0, s29, 133120
s_nop 0
buffer_load_dwordx4 v2, s[8:11], s23 offen offset:0 lds
M a[164:167], a[176:179], a[224:227], a[164:167]
ds_read_b128 a[248:251], v10 offset:4096
ds_read_b128 a[252:255], v11 offset:4096
M a[164:167], a[180:183], a[228:231], a[164:167]
M a[168:171], a[188:191], a[228:231], a[168:171]
M a[168:171], a[184:187], a[224:227], a[168:171]
buffer_load_dwordx4 v3, s[8:11], s23 offen offset:1024 lds
M a[172:175], a[192:195], a[224:227], a[172:175]
M a[172:175], a[196:199], a[228:231], a[172:175]
s_waitcnt lgkmcnt(4)
M a[68:71], a[200:203], a[232:235], a[68:71]
ds_read_b128 a[224:227], v10 offset:6144
ds_read_b128 a[228:231], v11 offset:6144
v_mov_b32 v208, 0
v_mov_b32 v209, 0
M a[68:71], a[204:207], a[236:239], a[68:71]
buffer_load_dwordx4 v4, s[8:11], s23 offen offset:2048 lds
M a[72:75], a[212:215], a[236:239], a[72:75]
ds_read_b64_tr_b16 a[176:177], v14 offset:0
ds_read_b64_tr_b16 a[178:179], v14 offset:1536
v_mov_b32 v210, 0
v_mov_b32 v211, 0
M a[72:75], a[208:211], a[232:235], a[72:75]
M a[76:79], a[216:219], a[232:235], a[76:79]
buffer_load_dwordx4 v5, s[8:11], s23 offen offset:3072 lds
v_mov_b32 v212, 0
v_mov_b32 v213, 0
M a[76:79], a[220:223], a[236:239], a[76:79]
s_waitcnt lgkmcnt(6)
M a[80:83], a[204:207], a[244:247], a[80:83]
ds_read_b128 a[232:235], v10 offset:8192
ds_read_b128 a[236:239], v11 offset:8192
v_mov_b32 v214, 0
v_mov_b32 v215, 0
M a[80:83], a[200:203], a[240:243], a[80:83]
s_sub_u32 s31, s31, 1
s_cmp_eq_u32 s31, 0
s_cselect_b32 s58, -1920, s57
s_add_u32 s23, s23, s58
s_add_u32 s24, s24, s58
M a[84:87], a[208:211], a[240:243], a[84:87]
ds_read_b64_tr_b16 a[184:185], v15 offset:0
ds_read_b64_tr_b16 a[186:187], v15 offset:1536
M a[84:87], a[212:215], a[244:247], a[84:87]
v_mov_b32 v216, 0
v_mov_b32 v217, 0
M a[88:91], a[220:223], a[244:247], a[88:91]
M a[88:91], a[216:219], a[240:243], a[88:91]
buffer_load_dwordx4 a[0:3], v1, s[44:47], s64 offen offset:0 sc1
s_waitcnt lgkmcnt(8)
v_mov_b32 v218, 0
v_mov_b32 v219, 0
M a[92:95], a[200:203], a[248:251], a[92:95]
ds_read_b128 a[240:243], v10 offset:10240
ds_read_b128 a[244:247], v11 offset:10240
M a[92:95], a[204:207], a[252:255], a[92:95]
v_mov_b32 v220, 0
v_mov_b32 v221, 0
M a[96:99], a[212:215], a[252:255], a[96:99]
ds_read_b64_tr_b16 a[192:193], v16 offset:0
ds_read_b64_tr_b16 a[194:195], v16 offset:1536
M a[96:99], a[208:211], a[248:251], a[96:99]
buffer_load_dwordx4 a[4:7], v1, s[44:47], s64 offen offset:1024 sc1
v_mov_b32 v222, 0
v_mov_b32 v223, 0
M a[100:103], a[216:219], a[248:251], a[100:103]
M a[100:103], a[220:223], a[252:255], a[100:103]
s_waitcnt lgkmcnt(10)
M a[104:107], a[204:207], a[228:231], a[104:107]
ds_read_b128 a[248:251], v10 offset:12288
ds_read_b128 a[252:255], v11 offset:12288
v_mov_b32 v224, 0
v_mov_b32 v225, 0
M a[104:107], a[200:203], a[224:227], a[104:107]
buffer_load_dwordx4 a[8:11], v1, s[44:47], s64 offen offset:2048 sc1
M a[108:111], a[208:211], a[224:227], a[108:111]
ds_read_b64_tr_b16 a[180:181], v14 offset:12288
ds_read_b64_tr_b16 a[182:183], v14 offset:13824
v_mov_b32 v226, 0
v_mov_b32 v227, 0
M a[108:111], a[212:215], a[228:231], a[108:111]
M a[112:115], a[220:223], a[228:231], a[112:115]
buffer_load_dwordx4 a[12:15], v1, s[44:47], s64 offen offset:3072 sc1
s_add_u32 s64, s64, 4096
v_mov_b32 v228, 0
v_mov_b32 v229, 0
M a[112:115], a[216:219], a[224:227], a[112:115]
s_waitcnt lgkmcnt(10)
M a[116:119], a[200:203], a[232:235], a[116:119]
ds_read_b128 a[224:227], v10 offset:14336
ds_read_b128 a[228:231], v11 offset:14336
v_mov_b32 v230, 0
v_mov_b32 v231, 0
M a[116:119], a[204:207], a[236:239], a[116:119]
M a[120:123], a[212:215], a[236:239], a[120:123]
ds_read_b64_tr_b16 a[188:189], v15 offset:12288
ds_read_b64_tr_b16 a[190:191], v15 offset:13824
M a[120:123], a[208:211], a[232:235], a[120:123]
buffer_load_dwordx4 a[16:19], v1, s[44:47], s64 offen offset:0 sc1
v_mov_b32 v232, 0
v_mov_b32 v233, 0
M a[124:127], a[216:219], a[232:235], a[124:127]
M a[124:127], a[220:223], a[236:239], a[124:127]
buffer_load_dwordx4 a[20:23], v1, s[44:47], s64 offen offset:1024 sc1
s_waitcnt lgkmcnt(10)
v_mov_b32 v234, 0
v_mov_b32 v235, 0
M a[128:131], a[204:207], a[244:247], a[128:131]
ds_read_b128 a[232:235], v10 offset:16384
ds_read_b128 a[236:239], v11 offset:16384
M a[128:131], a[200:203], a[240:243], a[128:131]
v_mov_b32 v236, 0
v_mov_b32 v237, 0
M a[132:135], a[208:211], a[240:243], a[132:135]
ds_read_b64_tr_b16 a[196:197], v16 offset:12288
ds_read_b64_tr_b16 a[198:199], v16 offset:13824
M a[132:135], a[212:215], a[244:247], a[132:135]
v_mov_b32 v238, 0
v_mov_b32 v239, 0
M a[136:139], a[220:223], a[244:247], a[136:139]
buffer_load_dwordx4 a[24:27], v1, s[44:47], s64 offen offset:2048 sc1
M a[136:139], a[216:219], a[240:243], a[136:139]
s_waitcnt lgkmcnt(10)
M a[140:143], a[200:203], a[248:251], a[140:143]
buffer_load_dwordx4 a[28:31], v1, s[44:47], s64 offen offset:3072 sc1
s_add_u32 s64, s64, 4096
v_mov_b32 v240, 0
v_mov_b32 v241, 0
M a[140:143], a[204:207], a[252:255], a[140:143]
M a[144:147], a[212:215], a[252:255], a[144:147]
v_mov_b32 v242, 0
v_mov_b32 v243, 0
M a[144:147], a[208:211], a[248:251], a[144:147]
M a[148:151], a[216:219], a[248:251], a[148:151]
s_waitcnt vmcnt(15) lgkmcnt(0)
s_barrier
ds_read_b128 a[240:243], v10 offset:18432
ds_read_b128 a[244:247], v11 offset:18432
v_mov_b32 v244, 0
v_mov_b32 v245, 0
M a[148:151], a[220:223], a[252:255], a[148:151]
buffer_load_dwordx4 a[32:35], v1, s[44:47], s64 offen offset:0 sc1
M a[152:155], a[204:207], a[228:231], a[152:155]
ds_read_b128 a[248:251], v10 offset:20480
ds_read_b128 a[252:255], v11 offset:20480
v_mov_b32 v246, 0
v_mov_b32 v247, 0
M a[152:155], a[200:203], a[224:227], a[152:155]
M a[156:159], a[208:211], a[224:227], a[156:159]
buffer_load_dwordx4 a[36:39], v1, s[44:47], s64 offen offset:1024 sc1
M a[156:159], a[212:215], a[228:231], a[156:159]
v_mov_b32 v248, 0
v_mov_b32 v249, 0
M a[160:163], a[220:223], a[228:231], a[160:163]
M a[160:163], a[216:219], a[224:227], a[160:163]
buffer_load_dwordx4 a[40:43], v1, s[44:47], s64 offen offset:2048 sc1
v_mov_b32 v250, 0
v_mov_b32 v251, 0
M a[164:167], a[200:203], a[232:235], a[164:167]
ds_read_b128 a[224:227], v10 offset:22528
ds_read_b128 a[228:231], v11 offset:22528
M a[164:167], a[204:207], a[236:239], a[164:167]
v_mov_b32 v252, 0
v_mov_b32 v253, 0
M a[168:171], a[212:215], a[236:239], a[168:171]
M a[168:171], a[208:211], a[232:235], a[168:171]
buffer_load_dwordx4 a[44:47], v1, s[44:47], s64 offen offset:3072 sc1
s_add_u32 s64, s64, 4096
v_mov_b32 v254, 0
v_mov_b32 v255, 0
M a[172:175], a[216:219], a[232:235], a[172:175]
M a[172:175], a[220:223], a[236:239], a[172:175]
s_waitcnt lgkmcnt(4)
M a[68:71], a[176:179], a[240:243], a[68:71]
ds_read_b128 a[232:235], v10 offset:24576
ds_read_b128 a[236:239], v11 offset:24576
s_mov_b32 s22, s101
s_and_b32 s23, s22, 1
M a[68:71], a[180:183], a[244:247], a[68:71]
buffer_load_dwordx4 a[48:51], v1, s[44:47], s64 offen offset:0 sc1
M a[72:75], a[188:191], a[244:247], a[72:75]
ds_read_b64_tr_b16 a[200:201], v14 offset:28672
ds_read_b64_tr_b16 a[202:203], v14 offset:30208
s_lshr_b32 s24, s22, 1
s_lshl_b32 s33, s24, 14
M a[72:75], a[184:187], a[240:243], a[72:75]
M a[76:79], a[192:195], a[240:243], a[76:79]
M a[76:79], a[196:199], a[244:247], a[76:79]
s_waitcnt lgkmcnt(6)
s_lshl_b32 s34, s23, 13
s_add_u32 s29, s33, s34
M a[80:83], a[180:183], a[252:255], a[80:83]
ds_read_b128 a[240:243], v10 offset:26624
ds_read_b128 a[244:247], v11 offset:26624
M a[80:83], a[176:179], a[248:251], a[80:83]
s_lshl_b32 s28, s20, 20
s_add_u32 s28, s28, s34
M a[84:87], a[184:187], a[248:251], a[84:87]
ds_read_b64_tr_b16 a[208:209], v15 offset:28672
ds_read_b64_tr_b16 a[210:211], v15 offset:30208
M a[84:87], a[188:191], a[252:255], a[84:87]
buffer_load_dwordx4 a[52:55], v1, s[44:47], s64 offen offset:1024 sc1
M a[88:91], a[196:199], a[252:255], a[88:91]
s_mov_b32 s25, s28
s_lshl_b32 s33, s21, 16
M a[88:91], a[192:195], a[248:251], a[88:91]
s_waitcnt lgkmcnt(8)
M a[92:95], a[176:179], a[224:227], a[92:95]
ds_read_b128 a[248:251], v10 offset:28672
ds_read_b128 a[252:255], v11 offset:28672
s_add_u32 s34, s28, s33
s_add_u32 s34, s34, 65536
M a[92:95], a[180:183], a[228:231], a[92:95]
M a[96:99], a[188:191], a[228:231], a[96:99]
ds_read_b64_tr_b16 a[216:217], v16 offset:28672
ds_read_b64_tr_b16 a[218:219], v16 offset:30208
M a[96:99], a[184:187], a[224:227], a[96:99]
s_add_u32 s32, s28, 491520
s_sub_u32 s33, s32, s33
M a[100:103], a[192:195], a[224:227], a[100:103]
buffer_load_dwordx4 a[56:59], v1, s[44:47], s64 offen offset:2048 sc1
M a[100:103], a[196:199], a[228:231], a[100:103]
s_waitcnt lgkmcnt(10)
s_add_u32 s33, s33, 491520
s_cmp_eq_u32 s24, 0
s_cselect_b32 s27, s34, s32
s_cselect_b32 s28, s32, s33
M a[104:107], a[180:183], a[236:239], a[104:107]
ds_read_b128 a[224:227], v10 offset:30720
ds_read_b128 a[228:231], v11 offset:30720
M a[104:107], a[176:179], a[232:235], a[104:107]
M a[108:111], a[184:187], a[232:235], a[108:111]
ds_read_b64_tr_b16 a[204:205], v14 offset:40960
ds_read_b64_tr_b16 a[206:207], v14 offset:42496
s_add_u32 s26, s25, 16384
s_add_u32 s62, s27, 16384
M a[108:111], a[188:191], a[236:239], a[108:111]
M a[112:115], a[196:199], a[236:239], a[112:115]
s_add_u32 s63, s28, 16384
s_lshl_b32 s31, s21, 7
M a[112:115], a[192:195], a[232:235], a[112:115]
s_waitcnt lgkmcnt(10)
M a[116:119], a[176:179], a[240:243], a[116:119]
ds_read_b128 a[232:235], v10 offset:32768
ds_read_b128 a[236:239], v11 offset:32768
M a[116:119], a[180:183], a[244:247], a[116:119]
buffer_load_dwordx4 a[60:63], v1, s[44:47], s64 offen offset:3072 sc1
s_cmp_eq_u32 s24, 0
s_cselect_b32 s31, s31, 960
M a[120:123], a[188:191], a[244:247], a[120:123]
ds_read_b64_tr_b16 a[212:213], v15 offset:40960
ds_read_b64_tr_b16 a[214:215], v15 offset:42496
M a[120:123], a[184:187], a[240:243], a[120:123]
s_mov_b32 s60, 0
s_add_u32 s12, s4, 16777216
s_addc_u32 s13, s5, 0
M a[124:127], a[192:195], a[240:243], a[124:127]
M a[124:127], a[196:199], a[244:247], a[124:127]
s_waitcnt lgkmcnt(10)
M a[128:131], a[180:183], a[252:255], a[128:131]
ds_read_b128 a[240:243], v10 offset:34816
ds_read_b128 a[244:247], v11 offset:34816
s_mov_b32 s14, 33554432
s_mov_b32 s15, 0x00020000
M a[128:131], a[176:179], a[248:251], a[128:131]
M a[132:135], a[184:187], a[248:251], a[132:135]
ds_read_b64_tr_b16 a[220:221], v16 offset:40960
ds_read_b64_tr_b16 a[222:223], v16 offset:42496
s_mov_b32 s8, s4
s_mov_b32 s9, s5
M a[132:135], a[188:191], a[252:255], a[132:135]
buffer_load_dword v126, v119, s[36:39], 0 offen offset:128 sc1
M a[136:139], a[196:199], a[252:255], a[136:139]
M a[136:139], a[192:195], a[248:251], a[136:139]
s_waitcnt lgkmcnt(10)
s_mov_b32 s10, 16777216
s_mov_b32 s11, 0x00020000
M a[140:143], a[176:179], a[224:227], a[140:143]
M a[140:143], a[180:183], a[228:231], a[140:143]
M a[144:147], a[188:191], a[228:231], a[144:147]
M a[144:147], a[184:187], a[224:227], a[144:147]
M a[148:151], a[192:195], a[224:227], a[148:151]
s_waitcnt vmcnt(17) lgkmcnt(0)
s_barrier
ds_read_b128 a[248:251], v12 offset:0
ds_read_b128 a[252:255], v13 offset:0
s_waitcnt vmcnt(0)
v_cmp_gt_u32 vcc, 0x80, v126
s_nop 0
s_cbranch_vccnz Lk1_spin
Lk1_got:
M a[148:151], a[196:199], a[228:231], a[148:151]
s_add_u32 m0, s29, 65536
s_add_u32 s32, s25, 4096
buffer_load_dwordx4 v1, s[12:15], s25 offen offset:0 sc1 lds
M a[152:155], a[180:183], a[236:239], a[152:155]
ds_read_b128 a[224:227], v12 offset:2048
ds_read_b128 a[228:231], v13 offset:2048
M a[152:155], a[176:179], a[232:235], a[152:155]
buffer_load_dwordx4 v1, s[12:15], s25 offen offset:1024 sc1 lds
M a[156:159], a[184:187], a[232:235], a[156:159]
M a[156:159], a[188:191], a[236:239], a[156:159]
buffer_load_dwordx4 v1, s[12:15], s25 offen offset:2048 sc1 lds
M a[160:163], a[196:199], a[236:239], a[160:163]
buffer_load_dwordx4 v1, s[12:15], s25 offen offset:3072 sc1 lds
M a[160:163], a[192:195], a[232:235], a[160:163]
M a[164:167], a[176:179], a[240:243], a[164:167]
ds_read_b128 a[232:235], v12 offset:4096
ds_read_b128 a[236:239], v13 offset:4096
M a[164:167], a[180:183], a[244:247], a[164:167]
s_add_u32 m0, s29, 69632
s_nop 0
buffer_load_dwordx4 v1, s[12:15], s32 offen offset:0 sc1 lds
M a[168:171], a[188:191], a[244:247], a[168:171]
buffer_load_dwordx4 v1, s[12:15], s32 offen offset:1024 sc1 lds
M a[168:171], a[184:187], a[240:243], a[168:171]
M a[172:175], a[192:195], a[240:243], a[172:175]
buffer_load_dwordx4 v1, s[12:15], s32 offen offset:2048 sc1 lds
M a[172:175], a[196:199], a[244:247], a[172:175]
s_waitcnt lgkmcnt(4)
M a[68:71], a[200:203], a[248:251], a[68:71]
ds_read_b128 a[240:243], v12 offset:6144
ds_read_b128 a[244:247], v13 offset:6144
M a[68:71], a[204:207], a[252:255], a[68:71]
buffer_load_dwordx4 v1, s[12:15], s32 offen offset:3072 sc1 lds
M a[72:75], a[212:215], a[252:255], a[72:75]
M a[72:75], a[208:211], a[248:251], a[72:75]
M a[76:79], a[216:219], a[248:251], a[76:79]
M a[76:79], a[220:223], a[252:255], a[76:79]
s_waitcnt lgkmcnt(4)
M a[80:83], a[204:207], a[228:231], a[80:83]
ds_read_b128 a[248:251], v12 offset:8192
ds_read_b128 a[252:255], v13 offset:8192
M a[80:83], a[200:203], a[224:227], a[80:83]
M a[84:87], a[208:211], a[224:227], a[84:87]
M a[84:87], a[212:215], a[228:231], a[84:87]
M a[88:91], a[220:223], a[228:231], a[88:91]
M a[88:91], a[216:219], a[224:227], a[88:91]
s_waitcnt lgkmcnt(4)
M a[92:95], a[200:203], a[232:235], a[92:95]
ds_read_b128 a[224:227], v12 offset:10240
ds_read_b128 a[228:231], v13 offset:10240
v_accvgpr_read_b32 v24, a68
v_accvgpr_read_b32 v25, a69
v_accvgpr_read_b32 v26, a70
M a[92:95], a[204:207], a[236:239], a[92:95]
v_accvgpr_read_b32 v27, a71
v_cvt_pk_bf16_f32 v24, v24, v25
v_cvt_pk_bf16_f32 v25, v26, v27
ds_write_b64 v124, v[24:25] offset:0
M a[96:99], a[212:215], a[236:239], a[96:99]
v_accvgpr_read_b32 v28, a72
v_accvgpr_read_b32 v29, a73
v_accvgpr_read_b32 v30, a74
M a[96:99], a[208:211], a[232:235], a[96:99]
v_accvgpr_read_b32 v31, a75
v_cvt_pk_bf16_f32 v28, v28, v29
v_cvt_pk_bf16_f32 v29, v30, v31
ds_write_b64 v124, v[28:29] offset:32
M a[100:103], a[216:219], a[232:235], a[100:103]
v_accvgpr_read_b32 v24, a76
v_accvgpr_read_b32 v25, a77
v_accvgpr_read_b32 v26, a78
M a[100:103], a[220:223], a[236:239], a[100:103]
s_waitcnt lgkmcnt(6)
v_accvgpr_read_b32 v27, a79
v_cvt_pk_bf16_f32 v24, v24, v25
v_cvt_pk_bf16_f32 v25, v26, v27
ds_write_b64 v124, v[24:25] offset:64
M a[104:107], a[204:207], a[244:247], a[104:107]
ds_read_b128 a[232:235], v12 offset:12288
ds_read_b128 a[236:239], v13 offset:12288
v_accvgpr_read_b32 v24, a80
v_accvgpr_read_b32 v25, a81
v_accvgpr_read_b32 v26, a82
M a[104:107], a[200:203], a[240:243], a[104:107]
v_accvgpr_read_b32 v27, a83
v_cvt_pk_bf16_f32 v24, v24, v25
v_cvt_pk_bf16_f32 v25, v26, v27
ds_write_b64 v124, v[24:25] offset:6400
M a[108:111], a[208:211], a[240:243], a[108:111]
v_accvgpr_read_b32 v28, a84
v_accvgpr_read_b32 v29, a85
v_accvgpr_read_b32 v30, a86
M a[108:111], a[212:215], a[244:247], a[108:111]
v_accvgpr_read_b32 v31, a87
v_cvt_pk_bf16_f32 v28, v28, v29
v_cvt_pk_bf16_f32 v29, v30, v31
ds_write_b64 v124, v[28:29] offset:6432
M a[112:115], a[220:223], a[244:247], a[112:115]
v_accvgpr_read_b32 v24, a88
v_accvgpr_read_b32 v25, a89
v_accvgpr_read_b32 v26, a90
M a[112:115], a[216:219], a[240:243], a[112:115]
s_waitcnt lgkmcnt(9)
v_accvgpr_read_b32 v27, a91
v_cvt_pk_bf16_f32 v24, v24, v25
v_cvt_pk_bf16_f32 v25, v26, v27
ds_write_b64 v124, v[24:25] offset:6464
M a[116:119], a[200:203], a[248:251], a[116:119]
ds_read_b128 a[240:243], v12 offset:14336
ds_read_b128 a[244:247], v13 offset:14336
v_accvgpr_read_b32 v24, a92
v_accvgpr_read_b32 v25, a93
v_accvgpr_read_b32 v26, a94
M a[116:119], a[204:207], a[252:255], a[116:119]
v_accvgpr_read_b32 v27, a95
v_cvt_pk_bf16_f32 v24, v24, v25
v_cvt_pk_bf16_f32 v25, v26, v27
ds_write_b64 v124, v[24:25] offset:12800
M a[120:123], a[212:215], a[252:255], a[120:123]
v_accvgpr_read_b32 v28, a96
v_accvgpr_read_b32 v29, a97
v_accvgpr_read_b32 v30, a98
M a[120:123], a[208:211], a[248:251], a[120:123]
v_accvgpr_read_b32 v31, a99
v_cvt_pk_bf16_f32 v28, v28, v29
v_cvt_pk_bf16_f32 v29, v30, v31
ds_write_b64 v124, v[28:29] offset:12832
M a[124:127], a[216:219], a[248:251], a[124:127]
v_accvgpr_read_b32 v24, a100
v_accvgpr_read_b32 v25, a101
v_accvgpr_read_b32 v26, a102
M a[124:127], a[220:223], a[252:255], a[124:127]
s_add_u32 s25, s25, 32768
s_cmp_eq_u32 s25, s27
s_cselect_b32 s25, s28, s25
s_cselect_b32 s27, -1, s27
s_waitcnt lgkmcnt(12)
v_accvgpr_read_b32 v27, a103
v_cvt_pk_bf16_f32 v24, v24, v25
v_cvt_pk_bf16_f32 v25, v26, v27
ds_write_b64 v124, v[24:25] offset:12864
M a[128:131], a[204:207], a[228:231], a[128:131]
ds_read_b128 a[248:251], v12 offset:16384
ds_read_b128 a[252:255], v13 offset:16384
v_accvgpr_read_b32 v24, a104
v_accvgpr_read_b32 v25, a105
v_accvgpr_read_b32 v26, a106
M a[128:131], a[200:203], a[224:227], a[128:131]
v_accvgpr_read_b32 v27, a107
v_cvt_pk_bf16_f32 v24, v24, v25
v_cvt_pk_bf16_f32 v25, v26, v27
ds_write_b64 v124, v[24:25] offset:19200
M a[132:135], a[208:211], a[224:227], a[132:135]
v_accvgpr_read_b32 v28, a108
v_accvgpr_read_b32 v29, a109
v_accvgpr_read_b32 v30, a110
M a[132:135], a[212:215], a[228:231], a[132:135]
v_accvgpr_read_b32 v31, a111
v_cvt_pk_bf16_f32 v28, v28, v29
v_cvt_pk_bf16_f32 v29, v30, v31
ds_write_b64 v124, v[28:29] offset:19232
M a[136:139], a[220:223], a[228:231], a[136:139]
v_accvgpr_read_b32 v24, a112
v_accvgpr_read_b32 v25, a113
v_accvgpr_read_b32 v26, a114
M a[136:139], a[216:219], a[224:227], a[136:139]
s_waitcnt lgkmcnt(12)
v_accvgpr_read_b32 v27, a115
v_cvt_pk_bf16_f32 v24, v24, v25
v_cvt_pk_bf16_f32 v25, v26, v27
ds_write_b64 v124, v[24:25] offset:19264
M a[140:143], a[200:203], a[232:235], a[140:143]
v_accvgpr_read_b32 v24, a116
v_accvgpr_read_b32 v25, a117
v_accvgpr_read_b32 v26, a118
M a[140:143], a[204:207], a[236:239], a[140:143]
v_accvgpr_read_b32 v27, a119
v_cvt_pk_bf16_f32 v24, v24, v25
v_cvt_pk_bf16_f32 v25, v26, v27
ds_write_b64 v124, v[24:25] offset:25600
M a[144:147], a[212:215], a[236:239], a[144:147]
v_accvgpr_read_b32 v28, a120
v_accvgpr_read_b32 v29, a121
v_accvgpr_read_b32 v30, a122
M a[144:147], a[208:211], a[232:235], a[144:147]
v_accvgpr_read_b32 v31, a123
v_cvt_pk_bf16_f32 v28, v28, v29
v_cvt_pk_bf16_f32 v29, v30, v31
ds_write_b64 v124, v[28:29] offset:25632
M a[148:151], a[216:219], a[232:235], a[148:151]
s_waitcnt lgkmcnt(0)
s_barrier
v_accvgpr_read_b32 v24, a124
v_accvgpr_read_b32 v25, a125
v_accvgpr_read_b32 v26, a126
M a[148:151], a[220:223], a[236:239], a[148:151]
v_accvgpr_read_b32 v27, a127
v_cvt_pk_bf16_f32 v24, v24, v25
v_cvt_pk_bf16_f32 v25, v26, v27
ds_write_b64 v124, v[24:25] offset:25664
v_accvgpr_read_b32 v24, a128
v_accvgpr_read_b32 v25, a129
v_accvgpr_read_b32 v26, a130
M a[152:155], a[204:207], a[244:247], a[152:155]
v_accvgpr_read_b32 v27, a131
v_cvt_pk_bf16_f32 v24, v24, v25
v_cvt_pk_bf16_f32 v25, v26, v27
M a[152:155], a[200:203], a[240:243], a[152:155]
ds_write_b64 v124, v[24:25] offset:32000
v_accvgpr_read_b32 v28, a132
v_accvgpr_read_b32 v29, a133
M a[156:159], a[208:211], a[240:243], a[156:159]
v_accvgpr_read_b32 v30, a134
v_accvgpr_read_b32 v31, a135
v_cvt_pk_bf16_f32 v28, v28, v29
M a[156:159], a[212:215], a[244:247], a[156:159]
v_cvt_pk_bf16_f32 v29, v30, v31
ds_write_b64 v124, v[28:29] offset:32032
v_accvgpr_read_b32 v24, a136
M a[160:163], a[220:223], a[244:247], a[160:163]
v_accvgpr_read_b32 v25, a137
v_accvgpr_read_b32 v26, a138
v_accvgpr_read_b32 v27, a139
M a[160:163], a[216:219], a[240:243], a[160:163]
v_cvt_pk_bf16_f32 v24, v24, v25
v_cvt_pk_bf16_f32 v25, v26, v27
ds_write_b64 v124, v[24:25] offset:32064
M a[164:167], a[200:203], a[248:251], a[164:167]
v_accvgpr_read_b32 v24, a140
v_accvgpr_read_b32 v25, a141
v_accvgpr_read_b32 v26, a142
M a[164:167], a[204:207], a[252:255], a[164:167]
v_accvgpr_read_b32 v27, a143
v_cvt_pk_bf16_f32 v24, v24, v25
v_cvt_pk_bf16_f32 v25, v26, v27
ds_write_b64 v124, v[24:25] offset:38400
M a[168:171], a[212:215], a[252:255], a[168:171]
v_accvgpr_read_b32 v28, a144
v_accvgpr_read_b32 v29, a145
v_accvgpr_read_b32 v30, a146
M a[168:171], a[208:211], a[248:251], a[168:171]
v_accvgpr_read_b32 v31, a147
v_cvt_pk_bf16_f32 v28, v28, v29
v_cvt_pk_bf16_f32 v29, v30, v31
ds_write_b64 v124, v[28:29] offset:38432
M a[172:175], a[216:219], a[248:251], a[172:175]
v_accvgpr_read_b32 v24, a148
v_accvgpr_read_b32 v25, a149
v_accvgpr_read_b32 v26, a150
M a[172:175], a[220:223], a[252:255], a[172:175]
v_accvgpr_read_b32 v27, a151
v_cvt_pk_bf16_f32 v24, v24, v25
v_cvt_pk_bf16_f32 v25, v26, v27
ds_write_b64 v124, v[24:25] offset:38464
s_mov_b64 s[44:45], s[42:43]
v_accvgpr_read_b32 v24, a152
v_accvgpr_read_b32 v25, a153
v_accvgpr_read_b32 v26, a154
v_accvgpr_read_b32 v27, a155
v_cvt_pk_bf16_f32 v24, v24, v25
v_cvt_pk_bf16_f32 v25, v26, v27
ds_write_b64 v124, v[24:25] offset:44800
v_accvgpr_read_b32 v28, a156
v_accvgpr_read_b32 v29, a157
v_accvgpr_read_b32 v30, a158
v_accvgpr_read_b32 v31, a159
v_cvt_pk_bf16_f32 v28, v28, v29
v_cvt_pk_bf16_f32 v29, v30, v31
ds_write_b64 v124, v[28:29] offset:44832
v_accvgpr_read_b32 v24, a160
v_accvgpr_read_b32 v25, a161
v_accvgpr_read_b32 v26, a162
v_accvgpr_read_b32 v27, a163
v_cvt_pk_bf16_f32 v24, v24, v25
v_cvt_pk_bf16_f32 v25, v26, v27
ds_write_b64 v124, v[24:25] offset:44864
v_accvgpr_read_b32 v24, a164
v_accvgpr_read_b32 v25, a165
v_accvgpr_read_b32 v26, a166
v_accvgpr_read_b32 v27, a167
v_cvt_pk_bf16_f32 v24, v24, v25
v_cvt_pk_bf16_f32 v25, v26, v27
ds_write_b64 v124, v[24:25] offset:51200
v_accvgpr_read_b32 v28, a168
v_accvgpr_read_b32 v29, a169
v_accvgpr_read_b32 v30, a170
v_accvgpr_read_b32 v31, a171
v_cvt_pk_bf16_f32 v28, v28, v29
v_cvt_pk_bf16_f32 v29, v30, v31
ds_write_b64 v124, v[28:29] offset:51232
v_accvgpr_read_b32 v24, a172
v_accvgpr_read_b32 v25, a173
v_accvgpr_read_b32 v26, a174
v_accvgpr_read_b32 v27, a175
v_cvt_pk_bf16_f32 v24, v24, v25
v_cvt_pk_bf16_f32 v25, v26, v27
ds_write_b64 v124, v[24:25] offset:51264
s_waitcnt lgkmcnt(0)
s_barrier
ds_read_b128 v[48:51], v121 offset:128
ds_read_b128 v[32:35], v120 offset:0
ds_read_b128 v[52:55], v120 offset:128
ds_read_b128 v[36:39], v120 offset:12800
ds_read_b128 v[56:59], v120 offset:12928
ds_read_b128 v[40:43], v120 offset:25600
ds_read_b128 v[60:63], v120 offset:25728
ds_read_b128 v[44:47], v120 offset:38400
ds_read_b128 v[64:67], v120 offset:38528
ds_read_b64_tr_b16 v[68:69], v123 offset:256
ds_read_b64_tr_b16 v[70:71], v122 offset:256
ds_read_b64_tr_b16 v[72:73], v122 offset:13056
ds_read_b64_tr_b16 v[74:75], v122 offset:25856
ds_read_b64_tr_b16 v[76:77], v122 offset:38656
ds_read_b64_tr_b16 v[78:79], v123 offset:288
ds_read_b64_tr_b16 v[80:81], v122 offset:288
ds_read_b64_tr_b16 v[82:83], v122 offset:13088
ds_read_b64_tr_b16 v[84:85], v122 offset:25888
ds_read_b64_tr_b16 v[86:87], v122 offset:38688
v_accvgpr_write_b32 a64, 0
v_accvgpr_write_b32 a65, 0
v_accvgpr_write_b32 a66, 0
v_accvgpr_write_b32 a67, 0
v_accvgpr_write_b32 a68, 0
v_accvgpr_write_b32 a69, 0
v_accvgpr_write_b32 a70, 0
v_accvgpr_write_b32 a71, 0
v_accvgpr_write_b32 a72, 0
v_accvgpr_write_b32 a73, 0
v_accvgpr_write_b32 a74, 0
v_accvgpr_write_b32 a75, 0
s_add_u32 m0, s29, 0
s_add_u32 s32, s25, 4096
buffer_load_dwordx4 v1, s[12:15], s25 offen offset:0 sc1 lds
v_accvgpr_write_b32 a76, 0
v_accvgpr_write_b32 a77, 0
v_accvgpr_write_b32 a78, 0
v_accvgpr_write_b32 a79, 0
v_accvgpr_write_b32 a80, 0
v_accvgpr_write_b32 a81, 0
v_accvgpr_write_b32 a82, 0
v_accvgpr_write_b32 a83, 0
v_accvgpr_write_b32 a84, 0
v_accvgpr_write_b32 a85, 0
v_accvgpr_write_b32 a86, 0
buffer_load_dwordx4 v1, s[12:15], s25 offen offset:1024 sc1 lds
v_accvgpr_write_b32 a87, 0
v_accvgpr_write_b32 a88, 0
v_accvgpr_write_b32 a89, 0
v_accvgpr_write_b32 a90, 0
v_accvgpr_write_b32 a91, 0
v_accvgpr_write_b32 a92, 0
v_accvgpr_write_b32 a93, 0
v_accvgpr_write_b32 a94, 0
v_accvgpr_write_b32 a95, 0
v_accvgpr_write_b32 a96, 0
buffer_load_dwordx4 v1, s[12:15], s25 offen offset:2048 sc1 lds
v_accvgpr_write_b32 a97, 0
v_accvgpr_write_b32 a98, 0
v_accvgpr_write_b32 a99, 0
v_accvgpr_write_b32 a100, 0
v_accvgpr_write_b32 a101, 0
v_accvgpr_write_b32 a102, 0
v_accvgpr_write_b32 a103, 0
v_accvgpr_write_b32 a104, 0
v_accvgpr_write_b32 a105, 0
v_accvgpr_write_b32 a106, 0
v_accvgpr_write_b32 a107, 0
buffer_load_dwordx4 v1, s[12:15], s25 offen offset:3072 sc1 lds
v_accvgpr_write_b32 a108, 0
v_accvgpr_write_b32 a109, 0
v_accvgpr_write_b32 a110, 0
v_accvgpr_write_b32 a111, 0
s_waitcnt lgkmcnt(15)
M v[88:91], v[48:51], v[32:35], v[152:155]
M v[92:95], v[52:55], v[32:35], v[148:151]
M v[96:99], v[52:55], v[36:39], v[144:147]
s_waitcnt lgkmcnt(14)
M v[100:103], v[56:59], v[36:39], v[148:151]
s_waitcnt lgkmcnt(13)
M v[104:107], v[56:59], v[40:43], v[144:147]
s_waitcnt lgkmcnt(12)
M v[108:111], v[60:63], v[40:43], v[148:151]
s_add_u32 m0, s29, 4096
s_nop 0
buffer_load_dwordx4 v1, s[12:15], s32 offen offset:0 sc1 lds
s_waitcnt lgkmcnt(11)
M v[112:115], v[60:63], v[44:47], v[144:147]
s_waitcnt lgkmcnt(10)
M v[116:119], v[64:67], v[44:47], v[148:151]
v_max3_f32 v136, v88, v89, v90
v_max3_f32 v136, v136, v91, v92
v_max3_f32 v136, v136, v93, v94
v_max_f32 v136, v136, v95
v_max3_f32 v137, v96, v97, v98
v_max3_f32 v137, v137, v99, v100
v_max3_f32 v137, v137, v101, v102
v_max_f32 v137, v137, v103
v_max3_f32 v138, v104, v105, v106
buffer_load_dwordx4 v1, s[12:15], s32 offen offset:1024 sc1 lds
v_max3_f32 v138, v138, v107, v108
v_max3_f32 v138, v138, v109, v110
v_max_f32 v138, v138, v111
v_max3_f32 v139, v112, v113, v114
v_max3_f32 v139, v139, v115, v116
v_max3_f32 v139, v139, v117, v118
v_max_f32 v139, v139, v119
v_mov_b32 v140, v136
v_mov_b32 v141, v137
v_mov_b32 v142, v138
buffer_load_dwordx4 v1, s[12:15], s32 offen offset:2048 sc1 lds
v_mov_b32 v143, v139
v_permlane16_swap_b32 v136, v140
v_permlane16_swap_b32 v137, v141
v_permlane16_swap_b32 v138, v142
v_permlane16_swap_b32 v139, v143
v_max_f32 v136, v136, v140
v_max_f32 v137, v137, v141
v_max_f32 v138, v138, v142
v_max_f32 v139, v139, v143
v_mov_b32 v140, v136
v_mov_b32 v141, v137
buffer_load_dwordx4 v1, s[12:15], s32 offen offset:3072 sc1 lds
v_mov_b32 v142, v138
v_mov_b32 v143, v139
v_permlane32_swap_b32 v136, v140
v_permlane32_swap_b32 v137, v141
v_permlane32_swap_b32 v138, v142
v_permlane32_swap_b32 v139, v143
v_max_f32 v136, v136, v140
v_max_f32 v137, v137, v141
v_max_f32 v138, v138, v142
v_max_f32 v139, v139, v143
s_add_u32 s25, s25, 32768
s_cmp_eq_u32 s25, s27
s_cselect_b32 s25, s28, s25
s_cselect_b32 s27, -1, s27
v_mul_f32 v136, s7, v136
v_mul_f32 v137, s7, v137
v_mul_f32 v138, s7, v138
v_mul_f32 v139, s7, v139
v_fma_f32 v88, v88, s7, -v136
v_fma_f32 v89, v89, s7, -v136
v_fma_f32 v90, v90, s7, -v136
v_fma_f32 v91, v91, s7, -v136
v_fma_f32 v92, v92, s7, -v136
v_fma_f32 v93, v93, s7, -v136
v_fma_f32 v94, v94, s7, -v136
s_add_u32 m0, s29, 32768
s_add_u32 s32, s26, 4096
buffer_load_dwordx4 v1, s[12:15], s26 offen offset:0 sc1 lds
v_fma_f32 v95, v95, s7, -v136
v_exp_f32 v88, v88
v_exp_f32 v89, v89
v_exp_f32 v90, v90
v_exp_f32 v91, v91
v_exp_f32 v92, v92
v_exp_f32 v93, v93
v_exp_f32 v94, v94
v_exp_f32 v95, v95
v_fma_f32 v96, v96, s7, -v137
v_fma_f32 v97, v97, s7, -v137
buffer_load_dwordx4 v1, s[12:15], s26 offen offset:1024 sc1 lds
v_fma_f32 v98, v98, s7, -v137
v_fma_f32 v99, v99, s7, -v137
v_fma_f32 v100, v100, s7, -v137
v_fma_f32 v101, v101, s7, -v137
v_fma_f32 v102, v102, s7, -v137
v_fma_f32 v103, v103, s7, -v137
v_exp_f32 v96, v96
v_exp_f32 v97, v97
v_exp_f32 v98, v98
v_exp_f32 v99, v99
buffer_load_dwordx4 v1, s[12:15], s26 offen offset:2048 sc1 lds
v_exp_f32 v100, v100
v_exp_f32 v101, v101
v_exp_f32 v102, v102
v_exp_f32 v103, v103
v_fma_f32 v104, v104, s7, -v138
v_fma_f32 v105, v105, s7, -v138
v_fma_f32 v106, v106, s7, -v138
v_fma_f32 v107, v107, s7, -v138
v_fma_f32 v108, v108, s7, -v138
v_fma_f32 v109, v109, s7, -v138
v_fma_f32 v110, v110, s7, -v138
buffer_load_dwordx4 v1, s[12:15], s26 offen offset:3072 sc1 lds
v_fma_f32 v111, v111, s7, -v138
v_exp_f32 v104, v104
v_exp_f32 v105, v105
v_exp_f32 v106, v106
v_exp_f32 v107, v107
v_exp_f32 v108, v108
v_exp_f32 v109, v109
v_exp_f32 v110, v110
v_exp_f32 v111, v111
v_fma_f32 v112, v112, s7, -v139
s_add_u32 m0, s29, 36864
s_nop 0
buffer_load_dwordx4 v1, s[12:15], s32 offen offset:0 sc1 lds
v_fma_f32 v113, v113, s7, -v139
v_fma_f32 v114, v114, s7, -v139
v_fma_f32 v115, v115, s7, -v139
v_fma_f32 v116, v116, s7, -v139
v_fma_f32 v117, v117, s7, -v139
v_fma_f32 v118, v118, s7, -v139
v_fma_f32 v119, v119, s7, -v139
v_exp_f32 v112, v112
v_exp_f32 v113, v113
v_exp_f32 v114, v114
v_exp_f32 v115, v115
buffer_load_dwordx4 v1, s[12:15], s32 offen offset:1024 sc1 lds
v_exp_f32 v116, v116
v_exp_f32 v117, v117
v_exp_f32 v118, v118
v_exp_f32 v119, v119
v_cvt_pk_bf16_f32 v88, v88, v89
v_cvt_pk_bf16_f32 v89, v90, v91
v_cvt_pk_bf16_f32 v90, v92, v93
v_cvt_pk_bf16_f32 v91, v94, v95
v_cvt_pk_bf16_f32 v96, v96, v97
v_cvt_pk_bf16_f32 v97, v98, v99
buffer_load_dwordx4 v1, s[12:15], s32 offen offset:2048 sc1 lds
v_cvt_pk_bf16_f32 v98, v100, v101
v_cvt_pk_bf16_f32 v99, v102, v103
v_cvt_pk_bf16_f32 v104, v104, v105
v_cvt_pk_bf16_f32 v105, v106, v107
v_cvt_pk_bf16_f32 v106, v108, v109
v_cvt_pk_bf16_f32 v107, v110, v111
v_cvt_pk_bf16_f32 v112, v112, v113
v_cvt_pk_bf16_f32 v113, v114, v115
v_cvt_pk_bf16_f32 v114, v116, v117
v_cvt_pk_bf16_f32 v115, v118, v119
M v[120:123], v[156:159], v[88:91], 0
buffer_load_dwordx4 v1, s[12:15], s32 offen offset:3072 sc1 lds
s_waitcnt lgkmcnt(8)
M v[32:35], v[68:71], v[88:91], 0
s_waitcnt lgkmcnt(3)
M v[36:39], v[78:81], v[88:91], 0
M v[124:127], v[156:159], v[96:99], 0
M v[40:43], v[70:73], v[96:99], 0
s_waitcnt lgkmcnt(2)
M v[44:47], v[80:83], v[96:99], 0
M v[128:131], v[156:159], v[104:107], 0
M v[48:51], v[72:75], v[104:107], 0
s_waitcnt lgkmcnt(1)
M v[52:55], v[82:85], v[104:107], 0
M v[132:135], v[156:159], v[112:115], 0
M v[56:59], v[74:77], v[112:115], 0
s_add_u32 s26, s26, 32768
s_cmp_eq_u32 s26, s62
s_cselect_b32 s26, s63, s26
s_cselect_b32 s62, -1, s62
s_waitcnt lgkmcnt(0)
M v[60:63], v[84:87], v[112:115], 0
v_rcp_f32 v120, v120
v_rcp_f32 v124, v124
v_rcp_f32 v128, v128
v_rcp_f32 v132, v132
v_pk_mul_f32 v[32:33], v[32:33], v[120:121] op_sel_hi:[1,0]
v_pk_mul_f32 v[34:35], v[34:35], v[120:121] op_sel_hi:[1,0]
v_pk_mul_f32 v[36:37], v[36:37], v[120:121] op_sel_hi:[1,0]
v_pk_mul_f32 v[38:39], v[38:39], v[120:121] op_sel_hi:[1,0]
v_cvt_pk_bf16_f32 v32, v32, v33
v_cvt_pk_bf16_f32 v33, v34, v35
v_cvt_pk_bf16_f32 v34, v36, v37
v_cvt_pk_bf16_f32 v35, v38, v39
s_add_u32 s3, s6, 0
buffer_store_dwordx4 v[32:35], v1, s[16:19], s3 offen sc1
v_pk_mul_f32 v[40:41], v[40:41], v[124:125] op_sel_hi:[1,0]
v_pk_mul_f32 v[42:43], v[42:43], v[124:125] op_sel_hi:[1,0]
v_pk_mul_f32 v[44:45], v[44:45], v[124:125] op_sel_hi:[1,0]
v_pk_mul_f32 v[46:47], v[46:47], v[124:125] op_sel_hi:[1,0]
v_cvt_pk_bf16_f32 v40, v40, v41
v_cvt_pk_bf16_f32 v41, v42, v43
v_cvt_pk_bf16_f32 v42, v44, v45
v_cvt_pk_bf16_f32 v43, v46, v47
s_add_u32 s3, s6, 2048
buffer_store_dwordx4 v[40:43], v1, s[16:19], s3 offen sc1
v_pk_mul_f32 v[48:49], v[48:49], v[128:129] op_sel_hi:[1,0]
v_pk_mul_f32 v[50:51], v[50:51], v[128:129] op_sel_hi:[1,0]
v_pk_mul_f32 v[52:53], v[52:53], v[128:129] op_sel_hi:[1,0]
v_pk_mul_f32 v[54:55], v[54:55], v[128:129] op_sel_hi:[1,0]
v_cvt_pk_bf16_f32 v48, v48, v49
v_cvt_pk_bf16_f32 v49, v50, v51
v_cvt_pk_bf16_f32 v50, v52, v53
v_cvt_pk_bf16_f32 v51, v54, v55
s_add_u32 s3, s6, 4096
buffer_store_dwordx4 v[48:51], v1, s[16:19], s3 offen sc1
v_pk_mul_f32 v[56:57], v[56:57], v[132:133] op_sel_hi:[1,0]
v_pk_mul_f32 v[58:59], v[58:59], v[132:133] op_sel_hi:[1,0]
v_pk_mul_f32 v[60:61], v[60:61], v[132:133] op_sel_hi:[1,0]
v_pk_mul_f32 v[62:63], v[62:63], v[132:133] op_sel_hi:[1,0]
v_cvt_pk_bf16_f32 v56, v56, v57
v_cvt_pk_bf16_f32 v57, v58, v59
v_cvt_pk_bf16_f32 v58, v60, v61
v_cvt_pk_bf16_f32 v59, v62, v63
s_add_u32 s3, s6, 6144
buffer_store_dwordx4 v[56:59], v1, s[16:19], s3 offen sc1
Lc2:
s_add_u32 s16, s4, 67108864
s_addc_u32 s17, s5, 0
s_mov_b32 s18, 16777216
s_mov_b32 s19, 0x00020000
s_add_u32 s52, s4, 100663296
s_addc_u32 s53, s5, 0
s_mov_b32 s54, 8404992
s_mov_b32 s55, 0x00020000
s_mov_b32 s46, 8388608
s_mov_b32 s47, 0x00020000
s_mov_b32 s50, 2097152
s_mov_b32 s51, 0x00020000
s_lshl_b32 s33, s24, 14
v_add_u32 v2, s33, v1
v_add_u32 v3, 0x10000, v2
v_and_b32 v8, 15, v0
v_bfe_u32 v9, v0, 4, 2
v_lshlrev_b32 v9, 2, v9
v_sub_u32 v8, v8, v9
v_mov_b32 v4, 0xf149f2ca
v_cmp_gt_i32 vcc, 0, v8
s_nop 1
v_cndmask_b32 v16, 0, v4, vcc
v_cmp_gt_i32 vcc, 1, v8
s_nop 1
v_cndmask_b32 v17, 0, v4, vcc
v_cmp_gt_i32 vcc, 2, v8
s_nop 1
v_cndmask_b32 v18, 0, v4, vcc
v_cmp_gt_i32 vcc, 3, v8
s_nop 1
v_cndmask_b32 v19, 0, v4, vcc
v_mov_b32 v8, 0x3f803f80
v_accvgpr_write_b32 a112, v8
v_accvgpr_write_b32 a113, v8
v_accvgpr_write_b32 a114, v8
v_accvgpr_write_b32 a115, v8
s_lshl_b32 s33, s23, 6
s_add_i32 s33, s33, s31
s_cmp_gt_i32 s33, 0
s_cselect_b32 s34, 0, 0xf149f2ca
s_cmp_lt_i32 s33, 0
s_cselect_b32 s33, 0xf149f2ca, 0
v_mov_b32 v20, s34
v_mov_b32 v21, s34
v_mov_b32 v22, s34
v_mov_b32 v23, s34
v_mov_b32 v28, s33
v_mov_b32 v29, s33
v_mov_b32 v30, s33
v_mov_b32 v31, s33
v_med3_f32 v24, v16, v20, v28
v_med3_f32 v25, v17, v20, v28
v_med3_f32 v26, v18, v20, v28
v_med3_f32 v27, v19, v20, v28
v_mov_b32 v5, 0
v_mov_b32 v6, 1
s_waitcnt vmcnt(20)
s_barrier
ds_read_b128 a[116:119], v3 offset:0
ds_read_b128 a[120:123], v3 offset:1024
ds_read_b128 a[124:127], v3 offset:2048
ds_read_b128 a[128:131], v3 offset:3072
ds_read_b128 a[132:135], v3 offset:4096
ds_read_b128 a[136:139], v3 offset:5120
ds_read_b128 a[140:143], v3 offset:6144
ds_read_b128 a[144:147], v3 offset:7168
s_waitcnt lgkmcnt(4)
M v[32:35], a[116:119], a[0:3], v[24:27]
M v[32:35], a[120:123], a[4:7], v[32:35]
ds_read_b128 a[148:151], v3 offset:8192
ds_read_b128 a[152:155], v3 offset:9216
M v[32:35], a[124:127], a[8:11], v[32:35]
M v[32:35], a[128:131], a[12:15], v[32:35]
M v[36:39], a[128:131], a[28:31], v[28:31]
M v[36:39], a[124:127], a[24:27], v[36:39]
M v[36:39], a[120:123], a[20:23], v[36:39]
M v[36:39], a[116:119], a[16:19], v[36:39]
M v[40:43], a[116:119], a[32:35], v[28:31]
M v[40:43], a[120:123], a[36:39], v[40:43]
ds_read_b128 a[156:159], v3 offset:10240
ds_read_b128 a[160:163], v3 offset:11264
M v[40:43], a[124:127], a[40:43], v[40:43]
M v[40:43], a[128:131], a[44:47], v[40:43]
M v[44:47], a[128:131], a[60:63], v[28:31]
M v[44:47], a[124:127], a[56:59], v[44:47]
M v[44:47], a[120:123], a[52:55], v[44:47]
M v[44:47], a[116:119], a[48:51], v[44:47]
s_waitcnt lgkmcnt(4)
M v[48:51], a[132:135], a[0:3], v[20:23]
M v[48:51], a[136:139], a[4:7], v[48:51]
ds_read_b128 a[164:167], v3 offset:12288
ds_read_b128 a[168:171], v3 offset:13312
M v[48:51], a[140:143], a[8:11], v[48:51]
M v[48:51], a[144:147], a[12:15], v[48:51]
M v[52:55], a[144:147], a[28:31], v[24:27]
M v[52:55], a[140:143], a[24:27], v[52:55]
M v[52:55], a[136:139], a[20:23], v[52:55]
M v[52:55], a[132:135], a[16:19], v[52:55]
M v[56:59], a[132:135], a[32:35], v[28:31]
M v[56:59], a[136:139], a[36:39], v[56:59]
ds_read_b128 a[172:175], v3 offset:14336
ds_read_b128 a[176:179], v3 offset:15360
M v[56:59], a[140:143], a[40:43], v[56:59]
M v[56:59], a[144:147], a[44:47], v[56:59]
M v[60:63], a[144:147], a[60:63], v[28:31]
M v[60:63], a[140:143], a[56:59], v[60:63]
M v[60:63], a[136:139], a[52:55], v[60:63]
M v[60:63], a[132:135], a[48:51], v[60:63]
s_waitcnt lgkmcnt(4)
M v[64:67], a[148:151], a[0:3], v[20:23]
M v[64:67], a[152:155], a[4:7], v[64:67]
M v[64:67], a[156:159], a[8:11], v[64:67]
M v[64:67], a[160:163], a[12:15], v[64:67]
M v[68:71], a[160:163], a[28:31], v[20:23]
M v[68:71], a[156:159], a[24:27], v[68:71]
M v[68:71], a[152:155], a[20:23], v[68:71]
M v[68:71], a[148:151], a[16:19], v[68:71]
M v[72:75], a[148:151], a[32:35], v[24:27]
M v[72:75], a[152:155], a[36:39], v[72:75]
M v[72:75], a[156:159], a[40:43], v[72:75]
M v[72:75], a[160:163], a[44:47], v[72:75]
M v[76:79], a[160:163], a[60:63], v[28:31]
M v[76:79], a[156:159], a[56:59], v[76:79]
s_waitcnt vmcnt(12) lgkmcnt(0)
s_barrier
ds_read_b128 a[116:119], v2 offset:0
ds_read_b128 a[120:123], v2 offset:1024
ds_read_b128 a[124:127], v2 offset:2048
ds_read_b128 a[128:131], v2 offset:3072
M v[76:79], a[152:155], a[52:55], v[76:79]
M v[76:79], a[148:151], a[48:51], v[76:79]
M v[80:83], a[164:167], a[0:3], v[20:23]
M v[80:83], a[168:171], a[4:7], v[80:83]
ds_read_b128 a[132:135], v2 offset:4096
ds_read_b128 a[136:139], v2 offset:5120
M v[80:83], a[172:175], a[8:11], v[80:83]
M v[80:83], a[176:179], a[12:15], v[80:83]
M v[84:87], a[176:179], a[28:31], v[20:23]
M v[84:87], a[172:175], a[24:27], v[84:87]
M v[84:87], a[168:171], a[20:23], v[84:87]
M v[84:87], a[164:167], a[16:19], v[84:87]
M v[88:91], a[164:167], a[32:35], v[20:23]
M v[88:91], a[168:171], a[36:39], v[88:91]
ds_read_b128 a[140:143], v2 offset:6144
ds_read_b128 a[144:147], v2 offset:7168
M v[88:91], a[172:175], a[40:43], v[88:91]
M v[88:91], a[176:179], a[44:47], v[88:91]
M v[92:95], a[176:179], a[60:63], v[24:27]
M v[92:95], a[172:175], a[56:59], v[92:95]
M v[92:95], a[168:171], a[52:55], v[92:95]
M v[92:95], a[164:167], a[48:51], v[92:95]
s_waitcnt vmcnt(0)
s_mov_b64 exec, 1
buffer_store_dword v6, v5, s[52:55], s65 offen sc1
s_mov_b64 exec, -1
s_add_u32 m0, s29, 65536
s_add_u32 s32, s25, 4096
buffer_load_dwordx4 v1, s[12:15], s25 offen offset:0 sc1 lds
buffer_load_dwordx4 v1, s[12:15], s25 offen offset:1024 sc1 lds
buffer_load_dwordx4 v1, s[12:15], s25 offen offset:2048 sc1 lds
buffer_load_dwordx4 v1, s[12:15], s25 offen offset:3072 sc1 lds
s_add_u32 m0, s29, 69632
s_nop 0
buffer_load_dwordx4 v1, s[12:15], s32 offen offset:0 sc1 lds
buffer_load_dwordx4 v1, s[12:15], s32 offen offset:1024 sc1 lds
buffer_load_dwordx4 v1, s[12:15], s32 offen offset:2048 sc1 lds
buffer_load_dwordx4 v1, s[12:15], s32 offen offset:3072 sc1 lds
s_add_u32 s25, s25, 32768
s_cmp_eq_u32 s25, s27
s_cselect_b32 s25, s28, s25
s_cselect_b32 s27, -1, s27
v_exp_f32 v32, v32
v_exp_f32 v33, v33
v_exp_f32 v34, v34
v_exp_f32 v35, v35
v_exp_f32 v48, v48
v_exp_f32 v49, v49
v_exp_f32 v50, v50
v_exp_f32 v51, v51
v_cvt_pk_bf16_f32 v32, v32, v33
v_cvt_pk_bf16_f32 v33, v34, v35
v_exp_f32 v36, v36
v_exp_f32 v37, v37
v_exp_f32 v38, v38
v_exp_f32 v39, v39
v_cvt_pk_bf16_f32 v34, v48, v49
v_cvt_pk_bf16_f32 v35, v50, v51
v_exp_f32 v52, v52
v_exp_f32 v53, v53
v_exp_f32 v54, v54
v_exp_f32 v55, v55
v_cvt_pk_bf16_f32 v36, v36, v37
v_cvt_pk_bf16_f32 v37, v38, v39
v_exp_f32 v40, v40
v_exp_f32 v41, v41
v_exp_f32 v42, v42
v_exp_f32 v43, v43
v_cvt_pk_bf16_f32 v38, v52, v53
v_cvt_pk_bf16_f32 v39, v54, v55
v_exp_f32 v56, v56
v_exp_f32 v57, v57
v_exp_f32 v58, v58
v_exp_f32 v59, v59
v_cvt_pk_bf16_f32 v40, v40, v41
v_cvt_pk_bf16_f32 v41, v42, v43
v_exp_f32 v44, v44
v_exp_f32 v45, v45
v_exp_f32 v46, v46
v_exp_f32 v47, v47
v_cvt_pk_bf16_f32 v42, v56, v57
v_cvt_pk_bf16_f32 v43, v58, v59
v_exp_f32 v60, v60
v_exp_f32 v61, v61
v_exp_f32 v62, v62
v_exp_f32 v63, v63
v_cvt_pk_bf16_f32 v44, v44, v45
v_cvt_pk_bf16_f32 v45, v46, v47
v_cvt_pk_bf16_f32 v46, v60, v61
v_cvt_pk_bf16_f32 v47, v62, v63
s_cmp_eq_u32 s24, 1
s_cbranch_scc1 Lk2_g1
s_mov_b32 s30, s21
s_cmp_eq_u32 s21, 0
s_cbranch_scc1 Lk2_m2
Lk2_l1:
s_waitcnt lgkmcnt(4)
s_add_u32 m0, s29, 98304
M v[96:99], a[116:119], a[0:3], 0
v_exp_f32 v64, v64
M v[96:99], a[120:123], a[4:7], v[96:99]
ds_read_b128 a[148:151], v2 offset:8192
ds_read_b128 a[152:155], v2 offset:9216
M v[96:99], a[124:127], a[8:11], v[96:99]
v_exp_f32 v65, v65
M v[96:99], a[128:131], a[12:15], v[96:99]
buffer_load_dwordx4 v1, s[12:15], s26 offen offset:0 sc1 lds
s_add_u32 s32, s26, 4096
M v[100:103], a[128:131], a[28:31], 0
v_exp_f32 v66, v66
M v[100:103], a[124:127], a[24:27], v[100:103]
v_cvt_pk_bf16_f32 v64, v64, v65
M v[100:103], a[120:123], a[20:23], v[100:103]
v_exp_f32 v67, v67
M v[100:103], a[116:119], a[16:19], v[100:103]
buffer_load_dwordx4 v1, s[12:15], s26 offen offset:1024 sc1 lds
M v[104:107], a[116:119], a[32:35], 0
v_exp_f32 v80, v80
M v[104:107], a[120:123], a[36:39], v[104:107]
ds_read_b128 a[156:159], v2 offset:10240
ds_read_b128 a[160:163], v2 offset:11264
M v[104:107], a[124:127], a[40:43], v[104:107]
v_exp_f32 v81, v81
M v[104:107], a[128:131], a[44:47], v[104:107]
buffer_load_dwordx4 v1, s[12:15], s26 offen offset:2048 sc1 lds
M v[108:111], a[128:131], a[60:63], 0
v_exp_f32 v82, v82
M v[108:111], a[124:127], a[56:59], v[108:111]
v_cvt_pk_bf16_f32 v65, v66, v67
v_cvt_pk_bf16_f32 v66, v80, v81
M v[108:111], a[120:123], a[52:55], v[108:111]
v_exp_f32 v83, v83
M v[108:111], a[116:119], a[48:51], v[108:111]
buffer_load_dwordx4 v1, s[12:15], s26 offen offset:3072 sc1 lds
s_add_u32 m0, s29, 102400
s_waitcnt lgkmcnt(4)
M v[112:115], a[132:135], a[0:3], 0
v_exp_f32 v68, v68
M v[112:115], a[136:139], a[4:7], v[112:115]
ds_read_b128 a[164:167], v2 offset:12288
ds_read_b128 a[168:171], v2 offset:13312
M v[112:115], a[140:143], a[8:11], v[112:115]
v_exp_f32 v69, v69
M v[112:115], a[144:147], a[12:15], v[112:115]
buffer_load_dwordx4 v1, s[12:15], s32 offen offset:0 sc1 lds
M v[116:119], a[144:147], a[28:31], 0
v_exp_f32 v70, v70
M v[116:119], a[140:143], a[24:27], v[116:119]
v_cvt_pk_bf16_f32 v67, v82, v83
v_cvt_pk_bf16_f32 v68, v68, v69
M v[116:119], a[136:139], a[20:23], v[116:119]
v_exp_f32 v71, v71
M v[116:119], a[132:135], a[16:19], v[116:119]
buffer_load_dwordx4 v1, s[12:15], s32 offen offset:1024 sc1 lds
M v[120:123], a[132:135], a[32:35], 0
v_exp_f32 v84, v84
M v[120:123], a[136:139], a[36:39], v[120:123]
ds_read_b128 a[172:175], v2 offset:14336
ds_read_b128 a[176:179], v2 offset:15360
M v[120:123], a[140:143], a[40:43], v[120:123]
v_exp_f32 v85, v85
M v[120:123], a[144:147], a[44:47], v[120:123]
buffer_load_dwordx4 v1, s[12:15], s32 offen offset:2048 sc1 lds
M v[124:127], a[144:147], a[60:63], 0
v_exp_f32 v86, v86
M v[124:127], a[140:143], a[56:59], v[124:127]
v_cvt_pk_bf16_f32 v69, v70, v71
v_cvt_pk_bf16_f32 v70, v84, v85
M v[124:127], a[136:139], a[52:55], v[124:127]
v_exp_f32 v87, v87
M v[124:127], a[132:135], a[48:51], v[124:127]
buffer_load_dwordx4 v1, s[12:15], s32 offen offset:3072 sc1 lds
s_waitcnt lgkmcnt(4)
M v[128:131], a[148:151], a[0:3], 0
v_exp_f32 v72, v72
M v[128:131], a[152:155], a[4:7], v[128:131]
s_add_u32 s26, s26, 32768
s_cmp_eq_u32 s26, s62
s_cselect_b32 s26, s63, s26
s_cselect_b32 s62, -1, s62
M v[128:131], a[156:159], a[8:11], v[128:131]
v_exp_f32 v73, v73
M v[128:131], a[160:163], a[12:15], v[128:131]
v_cvt_pk_bf16_f32 v71, v86, v87
v_cvt_pk_bf16_f32 v72, v72, v73
M v[132:135], a[160:163], a[28:31], 0
v_exp_f32 v74, v74
M v[132:135], a[156:159], a[24:27], v[132:135]
M v[132:135], a[152:155], a[20:23], v[132:135]
v_exp_f32 v75, v75
M v[132:135], a[148:151], a[16:19], v[132:135]
v_cvt_pk_bf16_f32 v73, v74, v75
M v[136:139], a[148:151], a[32:35], 0
v_exp_f32 v88, v88
M v[136:139], a[152:155], a[36:39], v[136:139]
M v[136:139], a[156:159], a[40:43], v[136:139]
v_exp_f32 v89, v89
M v[136:139], a[160:163], a[44:47], v[136:139]
v_cvt_pk_bf16_f32 v74, v88, v89
M v[140:143], a[160:163], a[60:63], 0
v_exp_f32 v90, v90
M v[140:143], a[156:159], a[56:59], v[140:143]
s_waitcnt vmcnt(16) lgkmcnt(0)
s_barrier
ds_read_b128 a[116:119], v2 offset:32768
ds_read_b128 a[120:123], v2 offset:40960
ds_read_b128 a[124:127], v2 offset:33792
ds_read_b128 a[128:131], v2 offset:41984
M v[140:143], a[152:155], a[52:55], v[140:143]
v_exp_f32 v91, v91
M v[140:143], a[148:151], a[48:51], v[140:143]
v_cvt_pk_bf16_f32 v75, v90, v91
M v[144:147], a[164:167], a[0:3], 0
v_exp_f32 v76, v76
M v[144:147], a[168:171], a[4:7], v[144:147]
ds_read_b128 a[132:135], v2 offset:34816
ds_read_b128 a[136:139], v2 offset:43008
M v[144:147], a[172:175], a[8:11], v[144:147]
v_exp_f32 v77, v77
M v[144:147], a[176:179], a[12:15], v[144:147]
v_cvt_pk_bf16_f32 v76, v76, v77
M v[148:151], a[176:179], a[28:31], 0
v_exp_f32 v78, v78
M v[148:151], a[172:175], a[24:27], v[148:151]
M v[148:151], a[168:171], a[20:23], v[148:151]
v_exp_f32 v79, v79
M v[148:151], a[164:167], a[16:19], v[148:151]
v_cvt_pk_bf16_f32 v77, v78, v79
M v[152:155], a[164:167], a[32:35], 0
v_exp_f32 v92, v92
M v[152:155], a[168:171], a[36:39], v[152:155]
ds_read_b128 a[140:143], v2 offset:35840
ds_read_b128 a[144:147], v2 offset:44032
M v[152:155], a[172:175], a[40:43], v[152:155]
v_exp_f32 v93, v93
M v[152:155], a[176:179], a[44:47], v[152:155]
v_cvt_pk_bf16_f32 v78, v92, v93
M v[156:159], a[176:179], a[60:63], 0
v_exp_f32 v94, v94
M v[156:159], a[172:175], a[56:59], v[156:159]
M v[156:159], a[168:171], a[52:55], v[156:159]
v_exp_f32 v95, v95
M v[156:159], a[164:167], a[48:51], v[156:159]
v_cvt_pk_bf16_f32 v79, v94, v95
s_waitcnt lgkmcnt(6)
s_add_u32 m0, s29, 0
M v[160:163], a[116:119], v[32:35], v[160:163]
v_exp_f32 v96, v96
M v[160:163], a[120:123], v[64:67], v[160:163]
ds_read_b128 a[148:151], v2 offset:36864
ds_read_b128 a[152:155], v2 offset:45056
M v[164:167], a[120:123], v[68:71], v[164:167]
v_exp_f32 v97, v97
M v[164:167], a[116:119], v[36:39], v[164:167]
buffer_load_dwordx4 v1, s[12:15], s25 offen offset:0 sc1 lds
s_add_u32 s32, s25, 4096
M v[168:171], a[116:119], v[40:43], v[168:171]
v_exp_f32 v98, v98
M v[168:171], a[120:123], v[72:75], v[168:171]
v_cvt_pk_bf16_f32 v96, v96, v97
M v[172:175], a[120:123], v[76:79], v[172:175]
v_exp_f32 v99, v99
M v[172:175], a[116:119], v[44:47], v[172:175]
buffer_load_dwordx4 v1, s[12:15], s25 offen offset:1024 sc1 lds
s_waitcnt lgkmcnt(6)
M a[96:99], a[112:115], v[32:35], a[96:99]
M a[96:99], a[112:115], v[64:67], a[96:99]
M v[176:179], a[124:127], v[32:35], v[176:179]
v_exp_f32 v112, v112
M v[176:179], a[128:131], v[64:67], v[176:179]
ds_read_b128 a[156:159], v2 offset:37888
ds_read_b128 a[160:163], v2 offset:46080
M v[180:183], a[128:131], v[68:71], v[180:183]
v_exp_f32 v113, v113
M v[180:183], a[124:127], v[36:39], v[180:183]
buffer_load_dwordx4 v1, s[12:15], s25 offen offset:2048 sc1 lds
M v[184:187], a[124:127], v[40:43], v[184:187]
v_exp_f32 v114, v114
M v[184:187], a[128:131], v[72:75], v[184:187]
v_cvt_pk_bf16_f32 v97, v98, v99
v_cvt_pk_bf16_f32 v98, v112, v113
M v[188:191], a[128:131], v[76:79], v[188:191]
v_exp_f32 v115, v115
M v[188:191], a[124:127], v[44:47], v[188:191]
buffer_load_dwordx4 v1, s[12:15], s25 offen offset:3072 sc1 lds
s_add_u32 m0, s29, 4096
s_waitcnt lgkmcnt(6)
M a[100:103], a[112:115], v[36:39], a[100:103]
M a[100:103], a[112:115], v[68:71], a[100:103]
M v[192:195], a[132:135], v[32:35], v[192:195]
v_exp_f32 v100, v100
M v[192:195], a[136:139], v[64:67], v[192:195]
ds_read_b128 a[164:167], v2 offset:38912
ds_read_b128 a[168:171], v2 offset:47104
M v[196:199], a[136:139], v[68:71], v[196:199]
v_exp_f32 v101, v101
M v[196:199], a[132:135], v[36:39], v[196:199]
buffer_load_dwordx4 v1, s[12:15], s32 offen offset:0 sc1 lds
M v[200:203], a[132:135], v[40:43], v[200:203]
v_exp_f32 v102, v102
M v[200:203], a[136:139], v[72:75], v[200:203]
v_cvt_pk_bf16_f32 v99, v114, v115
v_cvt_pk_bf16_f32 v100, v100, v101
M v[204:207], a[136:139], v[76:79], v[204:207]
v_exp_f32 v103, v103
M v[204:207], a[132:135], v[44:47], v[204:207]
buffer_load_dwordx4 v1, s[12:15], s32 offen offset:1024 sc1 lds
s_waitcnt lgkmcnt(6)
M a[104:107], a[112:115], v[40:43], a[104:107]
M a[104:107], a[112:115], v[72:75], a[104:107]
M v[208:211], a[140:143], v[32:35], v[208:211]
v_exp_f32 v116, v116
M v[208:211], a[144:147], v[64:67], v[208:211]
ds_read_b128 a[172:175], v2 offset:39936
ds_read_b128 a[176:179], v2 offset:48128
M v[212:215], a[144:147], v[68:71], v[212:215]
v_exp_f32 v117, v117
M v[212:215], a[140:143], v[36:39], v[212:215]
buffer_load_dwordx4 v1, s[12:15], s32 offen offset:2048 sc1 lds
M v[216:219], a[140:143], v[40:43], v[216:219]
v_exp_f32 v118, v118
M v[216:219], a[144:147], v[72:75], v[216:219]
v_cvt_pk_bf16_f32 v101, v102, v103
v_cvt_pk_bf16_f32 v102, v116, v117
M v[220:223], a[144:147], v[76:79], v[220:223]
v_exp_f32 v119, v119
M v[220:223], a[140:143], v[44:47], v[220:223]
buffer_load_dwordx4 v1, s[12:15], s32 offen offset:3072 sc1 lds
s_waitcnt lgkmcnt(6)
M a[108:111], a[112:115], v[44:47], a[108:111]
M a[108:111], a[112:115], v[76:79], a[108:111]
M v[224:227], a[148:151], v[32:35], v[224:227]
v_exp_f32 v104, v104
M v[224:227], a[152:155], v[64:67], v[224:227]
s_add_u32 s25, s25, 32768
s_cmp_eq_u32 s25, s27
s_cselect_b32 s25, s28, s25
s_cselect_b32 s27, -1, s27
M v[228:231], a[152:155], v[68:71], v[228:231]
v_exp_f32 v105, v105
M v[228:231], a[148:151], v[36:39], v[228:231]
v_cvt_pk_bf16_f32 v103, v118, v119
v_cvt_pk_bf16_f32 v104, v104, v105
M v[232:235], a[148:151], v[40:43], v[232:235]
v_exp_f32 v106, v106
M v[232:235], a[152:155], v[72:75], v[232:235]
M v[236:239], a[152:155], v[76:79], v[236:239]
v_exp_f32 v107, v107
M v[236:239], a[148:151], v[44:47], v[236:239]
v_cvt_pk_bf16_f32 v105, v106, v107
s_waitcnt lgkmcnt(4)
M v[240:243], a[156:159], v[32:35], v[240:243]
v_exp_f32 v120, v120
M v[240:243], a[160:163], v[64:67], v[240:243]
M v[244:247], a[160:163], v[68:71], v[244:247]
v_exp_f32 v121, v121
M v[244:247], a[156:159], v[36:39], v[244:247]
v_cvt_pk_bf16_f32 v106, v120, v121
M v[248:251], a[156:159], v[40:43], v[248:251]
v_exp_f32 v122, v122
M v[248:251], a[160:163], v[72:75], v[248:251]
s_waitcnt vmcnt(16) lgkmcnt(0)
s_barrier
ds_read_b128 a[116:119], v3 offset:0
ds_read_b128 a[120:123], v3 offset:1024
ds_read_b128 a[124:127], v3 offset:2048
ds_read_b128 a[128:131], v3 offset:3072
M v[252:255], a[160:163], v[76:79], v[252:255]
v_exp_f32 v123, v123
M v[252:255], a[156:159], v[44:47], v[252:255]
v_cvt_pk_bf16_f32 v107, v122, v123
M a[64:67], a[164:167], v[32:35], a[64:67]
v_exp_f32 v108, v108
M a[64:67], a[168:171], v[64:67], a[64:67]
ds_read_b128 a[132:135], v3 offset:4096
ds_read_b128 a[136:139], v3 offset:5120
M a[68:71], a[168:171], v[68:71], a[68:71]
v_exp_f32 v109, v109
M a[68:71], a[164:167], v[36:39], a[68:71]
v_cvt_pk_bf16_f32 v108, v108, v109
M a[72:75], a[164:167], v[40:43], a[72:75]
v_exp_f32 v110, v110
M a[72:75], a[168:171], v[72:75], a[72:75]
M a[76:79], a[168:171], v[76:79], a[76:79]
v_exp_f32 v111, v111
M a[76:79], a[164:167], v[44:47], a[76:79]
v_cvt_pk_bf16_f32 v109, v110, v111
M a[80:83], a[172:175], v[32:35], a[80:83]
v_exp_f32 v124, v124
M a[80:83], a[176:179], v[64:67], a[80:83]
ds_read_b128 a[140:143], v3 offset:6144
ds_read_b128 a[144:147], v3 offset:7168
M a[84:87], a[176:179], v[68:71], a[84:87]
v_exp_f32 v125, v125
M a[84:87], a[172:175], v[36:39], a[84:87]
v_cvt_pk_bf16_f32 v110, v124, v125
M a[88:91], a[172:175], v[40:43], a[88:91]
v_exp_f32 v126, v126
M a[88:91], a[176:179], v[72:75], a[88:91]
M a[92:95], a[176:179], v[76:79], a[92:95]
v_exp_f32 v127, v127
M a[92:95], a[172:175], v[44:47], a[92:95]
v_cvt_pk_bf16_f32 v111, v126, v127
s_sub_u32 s30, s30, 1
s_cmp_eq_u32 s30, 0
s_cbranch_scc1 Lk2_m1
s_waitcnt lgkmcnt(4)
s_add_u32 m0, s29, 32768
M v[32:35], a[116:119], a[0:3], 0
v_exp_f32 v128, v128
M v[32:35], a[120:123], a[4:7], v[32:35]
ds_read_b128 a[148:151], v3 offset:8192
ds_read_b128 a[152:155], v3 offset:9216
M v[32:35], a[124:127], a[8:11], v[32:35]
v_exp_f32 v129, v129
M v[32:35], a[128:131], a[12:15], v[32:35]
buffer_load_dwordx4 v1, s[12:15], s26 offen offset:0 sc1 lds
s_add_u32 s32, s26, 4096
M v[36:39], a[128:131], a[28:31], 0
v_exp_f32 v130, v130
M v[36:39], a[124:127], a[24:27], v[36:39]
v_cvt_pk_bf16_f32 v128, v128, v129
M v[36:39], a[120:123], a[20:23], v[36:39]
v_exp_f32 v131, v131
M v[36:39], a[116:119], a[16:19], v[36:39]
buffer_load_dwordx4 v1, s[12:15], s26 offen offset:1024 sc1 lds
M v[40:43], a[116:119], a[32:35], 0
v_exp_f32 v144, v144
M v[40:43], a[120:123], a[36:39], v[40:43]
ds_read_b128 a[156:159], v3 offset:10240
ds_read_b128 a[160:163], v3 offset:11264
M v[40:43], a[124:127], a[40:43], v[40:43]
v_exp_f32 v145, v145
M v[40:43], a[128:131], a[44:47], v[40:43]
buffer_load_dwordx4 v1, s[12:15], s26 offen offset:2048 sc1 lds
M v[44:47], a[128:131], a[60:63], 0
v_exp_f32 v146, v146
M v[44:47], a[124:127], a[56:59], v[44:47]
v_cvt_pk_bf16_f32 v129, v130, v131
v_cvt_pk_bf16_f32 v130, v144, v145
M v[44:47], a[120:123], a[52:55], v[44:47]
v_exp_f32 v147, v147
M v[44:47], a[116:119], a[48:51], v[44:47]
buffer_load_dwordx4 v1, s[12:15], s26 offen offset:3072 sc1 lds
s_add_u32 m0, s29, 36864
s_waitcnt lgkmcnt(4)
M v[48:51], a[132:135], a[0:3], 0
v_exp_f32 v132, v132
M v[48:51], a[136:139], a[4:7], v[48:51]
ds_read_b128 a[164:167], v3 offset:12288
ds_read_b128 a[168:171], v3 offset:13312
M v[48:51], a[140:143], a[8:11], v[48:51]
v_exp_f32 v133, v133
M v[48:51], a[144:147], a[12:15], v[48:51]
buffer_load_dwordx4 v1, s[12:15], s32 offen offset:0 sc1 lds
M v[52:55], a[144:147], a[28:31], 0
v_exp_f32 v134, v134
M v[52:55], a[140:143], a[24:27], v[52:55]
v_cvt_pk_bf16_f32 v131, v146, v147
v_cvt_pk_bf16_f32 v132, v132, v133
M v[52:55], a[136:139], a[20:23], v[52:55]
v_exp_f32 v135, v135
M v[52:55], a[132:135], a[16:19], v[52:55]
buffer_load_dwordx4 v1, s[12:15], s32 offen offset:1024 sc1 lds
M v[56:59], a[132:135], a[32:35], 0
v_exp_f32 v148, v148
M v[56:59], a[136:139], a[36:39], v[56:59]
ds_read_b128 a[172:175], v3 offset:14336
ds_read_b128 a[176:179], v3 offset:15360
M v[56:59], a[140:143], a[40:43], v[56:59]
v_exp_f32 v149, v149
M v[56:59], a[144:147], a[44:47], v[56:59]
buffer_load_dwordx4 v1, s[12:15], s32 offen offset:2048 sc1 lds
M v[60:63], a[144:147], a[60:63], 0
v_exp_f32 v150, v150
M v[60:63], a[140:143], a[56:59], v[60:63]
v_cvt_pk_bf16_f32 v133, v134, v135
v_cvt_pk_bf16_f32 v134, v148, v149
M v[60:63], a[136:139], a[52:55], v[60:63]
v_exp_f32 v151, v151
M v[60:63], a[132:135], a[48:51], v[60:63]
buffer_load_dwordx4 v1, s[12:15], s32 offen offset:3072 sc1 lds
s_waitcnt lgkmcnt(4)
M v[64:67], a[148:151], a[0:3], 0
v_exp_f32 v136, v136
M v[64:67], a[152:155], a[4:7], v[64:67]
s_add_u32 s26, s26, 32768
s_cmp_eq_u32 s26, s62
s_cselect_b32 s26, s63, s26
s_cselect_b32 s62, -1, s62
M v[64:67], a[156:159], a[8:11], v[64:67]
v_exp_f32 v137, v137
M v[64:67], a[160:163], a[12:15], v[64:67]
v_cvt_pk_bf16_f32 v135, v150, v151
v_cvt_pk_bf16_f32 v136, v136, v137
M v[68:71], a[160:163], a[28:31], 0
v_exp_f32 v138, v138
M v[68:71], a[156:159], a[24:27], v[68:71]
M v[68:71], a[152:155], a[20:23], v[68:71]
v_exp_f32 v139, v139
M v[68:71], a[148:151], a[16:19], v[68:71]
v_cvt_pk_bf16_f32 v137, v138, v139
M v[72:75], a[148:151], a[32:35], 0
v_exp_f32 v152, v152
M v[72:75], a[152:155], a[36:39], v[72:75]
M v[72:75], a[156:159], a[40:43], v[72:75]
v_exp_f32 v153, v153
M v[72:75], a[160:163], a[44:47], v[72:75]
v_cvt_pk_bf16_f32 v138, v152, v153
M v[76:79], a[160:163], a[60:63], 0
v_exp_f32 v154, v154
M v[76:79], a[156:159], a[56:59], v[76:79]
s_waitcnt vmcnt(16) lgkmcnt(0)
s_barrier
ds_read_b128 a[116:119], v3 offset:32768
ds_read_b128 a[120:123], v3 offset:40960
ds_read_b128 a[124:127], v3 offset:33792
ds_read_b128 a[128:131], v3 offset:41984
M v[76:79], a[152:155], a[52:55], v[76:79]
v_exp_f32 v155, v155
M v[76:79], a[148:151], a[48:51], v[76:79]
v_cvt_pk_bf16_f32 v139, v154, v155
M v[80:83], a[164:167], a[0:3], 0
v_exp_f32 v140, v140
M v[80:83], a[168:171], a[4:7], v[80:83]
ds_read_b128 a[132:135], v3 offset:34816
ds_read_b128 a[136:139], v3 offset:43008
M v[80:83], a[172:175], a[8:11], v[80:83]
v_exp_f32 v141, v141
M v[80:83], a[176:179], a[12:15], v[80:83]
v_cvt_pk_bf16_f32 v140, v140, v141
M v[84:87], a[176:179], a[28:31], 0
v_exp_f32 v142, v142
M v[84:87], a[172:175], a[24:27], v[84:87]
M v[84:87], a[168:171], a[20:23], v[84:87]
v_exp_f32 v143, v143
M v[84:87], a[164:167], a[16:19], v[84:87]
v_cvt_pk_bf16_f32 v141, v142, v143
M v[88:91], a[164:167], a[32:35], 0
v_exp_f32 v156, v156
M v[88:91], a[168:171], a[36:39], v[88:91]
ds_read_b128 a[140:143], v3 offset:35840
ds_read_b128 a[144:147], v3 offset:44032
M v[88:91], a[172:175], a[40:43], v[88:91]
v_exp_f32 v157, v157
M v[88:91], a[176:179], a[44:47], v[88:91]
v_cvt_pk_bf16_f32 v142, v156, v157
M v[92:95], a[176:179], a[60:63], 0
v_exp_f32 v158, v158
M v[92:95], a[172:175], a[56:59], v[92:95]
M v[92:95], a[168:171], a[52:55], v[92:95]
v_exp_f32 v159, v159
M v[92:95], a[164:167], a[48:51], v[92:95]
v_cvt_pk_bf16_f32 v143, v158, v159
s_waitcnt lgkmcnt(6)
s_add_u32 m0, s29, 65536
M v[160:163], a[116:119], v[96:99], v[160:163]
v_exp_f32 v32, v32
M v[160:163], a[120:123], v[128:131], v[160:163]
ds_read_b128 a[148:151], v3 offset:36864
ds_read_b128 a[152:155], v3 offset:45056
M v[164:167], a[120:123], v[132:135], v[164:167]
v_exp_f32 v33, v33
M v[164:167], a[116:119], v[100:103], v[164:167]
buffer_load_dwordx4 v1, s[12:15], s25 offen offset:0 sc1 lds
s_add_u32 s32, s25, 4096
M v[168:171], a[116:119], v[104:107], v[168:171]
v_exp_f32 v34, v34
M v[168:171], a[120:123], v[136:139], v[168:171]
v_cvt_pk_bf16_f32 v32, v32, v33
M v[172:175], a[120:123], v[140:143], v[172:175]
v_exp_f32 v35, v35
M v[172:175], a[116:119], v[108:111], v[172:175]
buffer_load_dwordx4 v1, s[12:15], s25 offen offset:1024 sc1 lds
s_waitcnt lgkmcnt(6)
M a[96:99], a[112:115], v[96:99], a[96:99]
M a[96:99], a[112:115], v[128:131], a[96:99]
M v[176:179], a[124:127], v[96:99], v[176:179]
v_exp_f32 v48, v48
M v[176:179], a[128:131], v[128:131], v[176:179]
ds_read_b128 a[156:159], v3 offset:37888
ds_read_b128 a[160:163], v3 offset:46080
M v[180:183], a[128:131], v[132:135], v[180:183]
v_exp_f32 v49, v49
M v[180:183], a[124:127], v[100:103], v[180:183]
buffer_load_dwordx4 v1, s[12:15], s25 offen offset:2048 sc1 lds
M v[184:187], a[124:127], v[104:107], v[184:187]
v_exp_f32 v50, v50
M v[184:187], a[128:131], v[136:139], v[184:187]
v_cvt_pk_bf16_f32 v33, v34, v35
v_cvt_pk_bf16_f32 v34, v48, v49
M v[188:191], a[128:131], v[140:143], v[188:191]
v_exp_f32 v51, v51
M v[188:191], a[124:127], v[108:111], v[188:191]
buffer_load_dwordx4 v1, s[12:15], s25 offen offset:3072 sc1 lds
s_add_u32 m0, s29, 69632
s_waitcnt lgkmcnt(6)
M a[100:103], a[112:115], v[100:103], a[100:103]
M a[100:103], a[112:115], v[132:135], a[100:103]
M v[192:195], a[132:135], v[96:99], v[192:195]
v_exp_f32 v36, v36
M v[192:195], a[136:139], v[128:131], v[192:195]
ds_read_b128 a[164:167], v3 offset:38912
ds_read_b128 a[168:171], v3 offset:47104
M v[196:199], a[136:139], v[132:135], v[196:199]
v_exp_f32 v37, v37
M v[196:199], a[132:135], v[100:103], v[196:199]
buffer_load_dwordx4 v1, s[12:15], s32 offen offset:0 sc1 lds
M v[200:203], a[132:135], v[104:107], v[200:203]
v_exp_f32 v38, v38
M v[200:203], a[136:139], v[136:139], v[200:203]
v_cvt_pk_bf16_f32 v35, v50, v51
v_cvt_pk_bf16_f32 v36, v36, v37
M v[204:207], a[136:139], v[140:143], v[204:207]
v_exp_f32 v39, v39
M v[204:207], a[132:135], v[108:111], v[204:207]
buffer_load_dwordx4 v1, s[12:15], s32 offen offset:1024 sc1 lds
s_waitcnt lgkmcnt(6)
M a[104:107], a[112:115], v[104:107], a[104:107]
M a[104:107], a[112:115], v[136:139], a[104:107]
M v[208:211], a[140:143], v[96:99], v[208:211]
v_exp_f32 v52, v52
M v[208:211], a[144:147], v[128:131], v[208:211]
ds_read_b128 a[172:175], v3 offset:39936
ds_read_b128 a[176:179], v3 offset:48128
M v[212:215], a[144:147], v[132:135], v[212:215]
v_exp_f32 v53, v53
M v[212:215], a[140:143], v[100:103], v[212:215]
buffer_load_dwordx4 v1, s[12:15], s32 offen offset:2048 sc1 lds
M v[216:219], a[140:143], v[104:107], v[216:219]
v_exp_f32 v54, v54
M v[216:219], a[144:147], v[136:139], v[216:219]
v_cvt_pk_bf16_f32 v37, v38, v39
v_cvt_pk_bf16_f32 v38, v52, v53
M v[220:223], a[144:147], v[140:143], v[220:223]
v_exp_f32 v55, v55
M v[220:223], a[140:143], v[108:111], v[220:223]
buffer_load_dwordx4 v1, s[12:15], s32 offen offset:3072 sc1 lds
s_waitcnt lgkmcnt(6)
M a[108:111], a[112:115], v[108:111], a[108:111]
M a[108:111], a[112:115], v[140:143], a[108:111]
M v[224:227], a[148:151], v[96:99], v[224:227]
v_exp_f32 v40, v40
M v[224:227], a[152:155], v[128:131], v[224:227]
s_add_u32 s25, s25, 32768
s_cmp_eq_u32 s25, s27
s_cselect_b32 s25, s28, s25
s_cselect_b32 s27, -1, s27
M v[228:231], a[152:155], v[132:135], v[228:231]
v_exp_f32 v41, v41
M v[228:231], a[148:151], v[100:103], v[228:231]
v_cvt_pk_bf16_f32 v39, v54, v55
v_cvt_pk_bf16_f32 v40, v40, v41
M v[232:235], a[148:151], v[104:107], v[232:235]
v_exp_f32 v42, v42
M v[232:235], a[152:155], v[136:139], v[232:235]
M v[236:239], a[152:155], v[140:143], v[236:239]
v_exp_f32 v43, v43
M v[236:239], a[148:151], v[108:111], v[236:239]
v_cvt_pk_bf16_f32 v41, v42, v43
s_waitcnt lgkmcnt(4)
M v[240:243], a[156:159], v[96:99], v[240:243]
v_exp_f32 v56, v56
M v[240:243], a[160:163], v[128:131], v[240:243]
M v[244:247], a[160:163], v[132:135], v[244:247]
v_exp_f32 v57, v57
M v[244:247], a[156:159], v[100:103], v[244:247]
v_cvt_pk_bf16_f32 v42, v56, v57
M v[248:251], a[156:159], v[104:107], v[248:251]
v_exp_f32 v58, v58
M v[248:251], a[160:163], v[136:139], v[248:251]
s_waitcnt vmcnt(16) lgkmcnt(0)
s_barrier
ds_read_b128 a[116:119], v2 offset:0
ds_read_b128 a[120:123], v2 offset:1024
ds_read_b128 a[124:127], v2 offset:2048
ds_read_b128 a[128:131], v2 offset:3072
M v[252:255], a[160:163], v[140:143], v[252:255]
v_exp_f32 v59, v59
M v[252:255], a[156:159], v[108:111], v[252:255]
v_cvt_pk_bf16_f32 v43, v58, v59
M a[64:67], a[164:167], v[96:99], a[64:67]
v_exp_f32 v44, v44
M a[64:67], a[168:171], v[128:131], a[64:67]
ds_read_b128 a[132:135], v2 offset:4096
ds_read_b128 a[136:139], v2 offset:5120
M a[68:71], a[168:171], v[132:135], a[68:71]
v_exp_f32 v45, v45
M a[68:71], a[164:167], v[100:103], a[68:71]
v_cvt_pk_bf16_f32 v44, v44, v45
M a[72:75], a[164:167], v[104:107], a[72:75]
v_exp_f32 v46, v46
M a[72:75], a[168:171], v[136:139], a[72:75]
M a[76:79], a[168:171], v[140:143], a[76:79]
v_exp_f32 v47, v47
M a[76:79], a[164:167], v[108:111], a[76:79]
v_cvt_pk_bf16_f32 v45, v46, v47
M a[80:83], a[172:175], v[96:99], a[80:83]
v_exp_f32 v60, v60
M a[80:83], a[176:179], v[128:131], a[80:83]
ds_read_b128 a[140:143], v2 offset:6144
ds_read_b128 a[144:147], v2 offset:7168
M a[84:87], a[176:179], v[132:135], a[84:87]
v_exp_f32 v61, v61
M a[84:87], a[172:175], v[100:103], a[84:87]
v_cvt_pk_bf16_f32 v46, v60, v61
M a[88:91], a[172:175], v[104:107], a[88:91]
v_exp_f32 v62, v62
M a[88:91], a[176:179], v[136:139], a[88:91]
M a[92:95], a[176:179], v[140:143], a[92:95]
v_exp_f32 v63, v63
M a[92:95], a[172:175], v[108:111], a[92:95]
v_cvt_pk_bf16_f32 v47, v62, v63
s_branch Lk2_l1
Lk2_m1:
s_lshl_b32 s33, s23, 6
s_add_i32 s33, s33, 0
s_cmp_gt_i32 s33, 0
s_cselect_b32 s34, 0, 0xf149f2ca
s_cmp_lt_i32 s33, 0
s_cselect_b32 s33, 0xf149f2ca, 0
v_mov_b32 v20, s34
v_mov_b32 v21, s34
v_mov_b32 v22, s34
v_mov_b32 v23, s34
v_mov_b32 v28, s33
v_mov_b32 v29, s33
v_mov_b32 v30, s33
v_mov_b32 v31, s33
v_med3_f32 v24, v16, v20, v28
v_med3_f32 v25, v17, v20, v28
v_med3_f32 v26, v18, v20, v28
v_med3_f32 v27, v19, v20, v28
s_waitcnt lgkmcnt(4)
s_add_u32 m0, s29, 32768
M v[32:35], a[116:119], a[0:3], v[24:27]
v_exp_f32 v128, v128
M v[32:35], a[120:123], a[4:7], v[32:35]
ds_read_b128 a[148:151], v3 offset:8192
ds_read_b128 a[152:155], v3 offset:9216
M v[32:35], a[124:127], a[8:11], v[32:35]
v_exp_f32 v129, v129
M v[32:35], a[128:131], a[12:15], v[32:35]
buffer_load_dwordx4 v1, s[12:15], s26 offen offset:0 sc1 lds
s_add_u32 s32, s26, 4096
M v[36:39], a[128:131], a[28:31], v[28:31]
v_exp_f32 v130, v130
M v[36:39], a[124:127], a[24:27], v[36:39]
v_cvt_pk_bf16_f32 v128, v128, v129
M v[36:39], a[120:123], a[20:23], v[36:39]
v_exp_f32 v131, v131
M v[36:39], a[116:119], a[16:19], v[36:39]
buffer_load_dwordx4 v1, s[12:15], s26 offen offset:1024 sc1 lds
M v[40:43], a[116:119], a[32:35], v[28:31]
v_exp_f32 v144, v144
M v[40:43], a[120:123], a[36:39], v[40:43]
ds_read_b128 a[156:159], v3 offset:10240
ds_read_b128 a[160:163], v3 offset:11264
M v[40:43], a[124:127], a[40:43], v[40:43]
v_exp_f32 v145, v145
M v[40:43], a[128:131], a[44:47], v[40:43]
buffer_load_dwordx4 v1, s[12:15], s26 offen offset:2048 sc1 lds
M v[44:47], a[128:131], a[60:63], v[28:31]
v_exp_f32 v146, v146
M v[44:47], a[124:127], a[56:59], v[44:47]
v_cvt_pk_bf16_f32 v129, v130, v131
v_cvt_pk_bf16_f32 v130, v144, v145
M v[44:47], a[120:123], a[52:55], v[44:47]
v_exp_f32 v147, v147
M v[44:47], a[116:119], a[48:51], v[44:47]
buffer_load_dwordx4 v1, s[12:15], s26 offen offset:3072 sc1 lds
s_add_u32 m0, s29, 36864
s_waitcnt lgkmcnt(4)
M v[48:51], a[132:135], a[0:3], v[20:23]
v_exp_f32 v132, v132
M v[48:51], a[136:139], a[4:7], v[48:51]
ds_read_b128 a[164:167], v3 offset:12288
ds_read_b128 a[168:171], v3 offset:13312
M v[48:51], a[140:143], a[8:11], v[48:51]
v_exp_f32 v133, v133
M v[48:51], a[144:147], a[12:15], v[48:51]
buffer_load_dwordx4 v1, s[12:15], s32 offen offset:0 sc1 lds
M v[52:55], a[144:147], a[28:31], v[24:27]
v_exp_f32 v134, v134
M v[52:55], a[140:143], a[24:27], v[52:55]
v_cvt_pk_bf16_f32 v131, v146, v147
v_cvt_pk_bf16_f32 v132, v132, v133
M v[52:55], a[136:139], a[20:23], v[52:55]
v_exp_f32 v135, v135
M v[52:55], a[132:135], a[16:19], v[52:55]
buffer_load_dwordx4 v1, s[12:15], s32 offen offset:1024 sc1 lds
M v[56:59], a[132:135], a[32:35], v[28:31]
v_exp_f32 v148, v148
M v[56:59], a[136:139], a[36:39], v[56:59]
ds_read_b128 a[172:175], v3 offset:14336
ds_read_b128 a[176:179], v3 offset:15360
M v[56:59], a[140:143], a[40:43], v[56:59]
v_exp_f32 v149, v149
M v[56:59], a[144:147], a[44:47], v[56:59]
buffer_load_dwordx4 v1, s[12:15], s32 offen offset:2048 sc1 lds
M v[60:63], a[144:147], a[60:63], v[28:31]
v_exp_f32 v150, v150
M v[60:63], a[140:143], a[56:59], v[60:63]
v_cvt_pk_bf16_f32 v133, v134, v135
v_cvt_pk_bf16_f32 v134, v148, v149
M v[60:63], a[136:139], a[52:55], v[60:63]
v_exp_f32 v151, v151
M v[60:63], a[132:135], a[48:51], v[60:63]
buffer_load_dwordx4 v1, s[12:15], s32 offen offset:3072 sc1 lds
s_waitcnt lgkmcnt(4)
M v[64:67], a[148:151], a[0:3], v[20:23]
v_exp_f32 v136, v136
M v[64:67], a[152:155], a[4:7], v[64:67]
s_add_u32 s26, s26, 32768
s_cmp_eq_u32 s26, s62
s_cselect_b32 s26, s63, s26
s_cselect_b32 s62, -1, s62
M v[64:67], a[156:159], a[8:11], v[64:67]
v_exp_f32 v137, v137
M v[64:67], a[160:163], a[12:15], v[64:67]
v_cvt_pk_bf16_f32 v135, v150, v151
v_cvt_pk_bf16_f32 v136, v136, v137
M v[68:71], a[160:163], a[28:31], v[20:23]
v_exp_f32 v138, v138
M v[68:71], a[156:159], a[24:27], v[68:71]
M v[68:71], a[152:155], a[20:23], v[68:71]
v_exp_f32 v139, v139
M v[68:71], a[148:151], a[16:19], v[68:71]
v_cvt_pk_bf16_f32 v137, v138, v139
M v[72:75], a[148:151], a[32:35], v[24:27]
v_exp_f32 v152, v152
M v[72:75], a[152:155], a[36:39], v[72:75]
M v[72:75], a[156:159], a[40:43], v[72:75]
v_exp_f32 v153, v153
M v[72:75], a[160:163], a[44:47], v[72:75]
v_cvt_pk_bf16_f32 v138, v152, v153
M v[76:79], a[160:163], a[60:63], v[28:31]
v_exp_f32 v154, v154
M v[76:79], a[156:159], a[56:59], v[76:79]
s_waitcnt vmcnt(16) lgkmcnt(0)
s_barrier
ds_read_b128 a[116:119], v3 offset:32768
ds_read_b128 a[120:123], v3 offset:40960
ds_read_b128 a[124:127], v3 offset:33792
ds_read_b128 a[128:131], v3 offset:41984
M v[76:79], a[152:155], a[52:55], v[76:79]
v_exp_f32 v155, v155
M v[76:79], a[148:151], a[48:51], v[76:79]
v_cvt_pk_bf16_f32 v139, v154, v155
M v[80:83], a[164:167], a[0:3], v[20:23]
v_exp_f32 v140, v140
M v[80:83], a[168:171], a[4:7], v[80:83]
ds_read_b128 a[132:135], v3 offset:34816
ds_read_b128 a[136:139], v3 offset:43008
M v[80:83], a[172:175], a[8:11], v[80:83]
v_exp_f32 v141, v141
M v[80:83], a[176:179], a[12:15], v[80:83]
v_cvt_pk_bf16_f32 v140, v140, v141
M v[84:87], a[176:179], a[28:31], v[20:23]
v_exp_f32 v142, v142
M v[84:87], a[172:175], a[24:27], v[84:87]
M v[84:87], a[168:171], a[20:23], v[84:87]
v_exp_f32 v143, v143
M v[84:87], a[164:167], a[16:19], v[84:87]
v_cvt_pk_bf16_f32 v141, v142, v143
M v[88:91], a[164:167], a[32:35], v[20:23]
v_exp_f32 v156, v156
M v[88:91], a[168:171], a[36:39], v[88:91]
ds_read_b128 a[140:143], v3 offset:35840
ds_read_b128 a[144:147], v3 offset:44032
M v[88:91], a[172:175], a[40:43], v[88:91]
v_exp_f32 v157, v157
M v[88:91], a[176:179], a[44:47], v[88:91]
v_cvt_pk_bf16_f32 v142, v156, v157
M v[92:95], a[176:179], a[60:63], v[24:27]
v_exp_f32 v158, v158
M v[92:95], a[172:175], a[56:59], v[92:95]
M v[92:95], a[168:171], a[52:55], v[92:95]
v_exp_f32 v159, v159
M v[92:95], a[164:167], a[48:51], v[92:95]
v_cvt_pk_bf16_f32 v143, v158, v159
s_waitcnt lgkmcnt(6)
s_add_u32 m0, s29, 65536
M v[160:163], a[116:119], v[96:99], v[160:163]
v_exp_f32 v32, v32
M v[160:163], a[120:123], v[128:131], v[160:163]
ds_read_b128 a[148:151], v3 offset:36864
ds_read_b128 a[152:155], v3 offset:45056
M v[164:167], a[120:123], v[132:135], v[164:167]
v_exp_f32 v33, v33
M v[164:167], a[116:119], v[100:103], v[164:167]
buffer_load_dwordx4 v1, s[12:15], s25 offen offset:0 sc1 lds
s_add_u32 s32, s25, 4096
M v[168:171], a[116:119], v[104:107], v[168:171]
v_exp_f32 v34, v34
M v[168:171], a[120:123], v[136:139], v[168:171]
v_cvt_pk_bf16_f32 v32, v32, v33
M v[172:175], a[120:123], v[140:143], v[172:175]
v_exp_f32 v35, v35
M v[172:175], a[116:119], v[108:111], v[172:175]
buffer_load_dwordx4 v1, s[12:15], s25 offen offset:1024 sc1 lds
s_waitcnt lgkmcnt(6)
M a[96:99], a[112:115], v[96:99], a[96:99]
M a[96:99], a[112:115], v[128:131], a[96:99]
M v[176:179], a[124:127], v[96:99], v[176:179]
v_exp_f32 v48, v48
M v[176:179], a[128:131], v[128:131], v[176:179]
ds_read_b128 a[156:159], v3 offset:37888
ds_read_b128 a[160:163], v3 offset:46080
M v[180:183], a[128:131], v[132:135], v[180:183]
v_exp_f32 v49, v49
M v[180:183], a[124:127], v[100:103], v[180:183]
buffer_load_dwordx4 v1, s[12:15], s25 offen offset:2048 sc1 lds
M v[184:187], a[124:127], v[104:107], v[184:187]
v_exp_f32 v50, v50
M v[184:187], a[128:131], v[136:139], v[184:187]
v_cvt_pk_bf16_f32 v33, v34, v35
v_cvt_pk_bf16_f32 v34, v48, v49
M v[188:191], a[128:131], v[140:143], v[188:191]
v_exp_f32 v51, v51
M v[188:191], a[124:127], v[108:111], v[188:191]
buffer_load_dwordx4 v1, s[12:15], s25 offen offset:3072 sc1 lds
s_add_u32 m0, s29, 69632
s_waitcnt lgkmcnt(6)
M a[100:103], a[112:115], v[100:103], a[100:103]
M a[100:103], a[112:115], v[132:135], a[100:103]
M v[192:195], a[132:135], v[96:99], v[192:195]
v_exp_f32 v36, v36
M v[192:195], a[136:139], v[128:131], v[192:195]
ds_read_b128 a[164:167], v3 offset:38912
ds_read_b128 a[168:171], v3 offset:47104
M v[196:199], a[136:139], v[132:135], v[196:199]
v_exp_f32 v37, v37
M v[196:199], a[132:135], v[100:103], v[196:199]
buffer_load_dwordx4 v1, s[12:15], s32 offen offset:0 sc1 lds
M v[200:203], a[132:135], v[104:107], v[200:203]
v_exp_f32 v38, v38
M v[200:203], a[136:139], v[136:139], v[200:203]
v_cvt_pk_bf16_f32 v35, v50, v51
v_cvt_pk_bf16_f32 v36, v36, v37
M v[204:207], a[136:139], v[140:143], v[204:207]
v_exp_f32 v39, v39
M v[204:207], a[132:135], v[108:111], v[204:207]
buffer_load_dwordx4 v1, s[12:15], s32 offen offset:1024 sc1 lds
s_waitcnt lgkmcnt(6)
M a[104:107], a[112:115], v[104:107], a[104:107]
M a[104:107], a[112:115], v[136:139], a[104:107]
M v[208:211], a[140:143], v[96:99], v[208:211]
v_exp_f32 v52, v52
M v[208:211], a[144:147], v[128:131], v[208:211]
ds_read_b128 a[172:175], v3 offset:39936
ds_read_b128 a[176:179], v3 offset:48128
M v[212:215], a[144:147], v[132:135], v[212:215]
v_exp_f32 v53, v53
M v[212:215], a[140:143], v[100:103], v[212:215]
buffer_load_dwordx4 v1, s[12:15], s32 offen offset:2048 sc1 lds
M v[216:219], a[140:143], v[104:107], v[216:219]
v_exp_f32 v54, v54
M v[216:219], a[144:147], v[136:139], v[216:219]
v_cvt_pk_bf16_f32 v37, v38, v39
v_cvt_pk_bf16_f32 v38, v52, v53
M v[220:223], a[144:147], v[140:143], v[220:223]
v_exp_f32 v55, v55
M v[220:223], a[140:143], v[108:111], v[220:223]
buffer_load_dwordx4 v1, s[12:15], s32 offen offset:3072 sc1 lds
s_waitcnt lgkmcnt(6)
M a[108:111], a[112:115], v[108:111], a[108:111]
M a[108:111], a[112:115], v[140:143], a[108:111]
M v[224:227], a[148:151], v[96:99], v[224:227]
v_exp_f32 v40, v40
M v[224:227], a[152:155], v[128:131], v[224:227]
s_add_u32 s25, s25, 32768
s_cmp_eq_u32 s25, s27
s_cselect_b32 s25, s28, s25
s_cselect_b32 s27, -1, s27
M v[228:231], a[152:155], v[132:135], v[228:231]
v_exp_f32 v41, v41
M v[228:231], a[148:151], v[100:103], v[228:231]
v_cvt_pk_bf16_f32 v39, v54, v55
v_cvt_pk_bf16_f32 v40, v40, v41
M v[232:235], a[148:151], v[104:107], v[232:235]
v_exp_f32 v42, v42
M v[232:235], a[152:155], v[136:139], v[232:235]
M v[236:239], a[152:155], v[140:143], v[236:239]
v_exp_f32 v43, v43
M v[236:239], a[148:151], v[108:111], v[236:239]
v_cvt_pk_bf16_f32 v41, v42, v43
s_waitcnt lgkmcnt(4)
M v[240:243], a[156:159], v[96:99], v[240:243]
v_exp_f32 v56, v56
M v[240:243], a[160:163], v[128:131], v[240:243]
M v[244:247], a[160:163], v[132:135], v[244:247]
v_exp_f32 v57, v57
M v[244:247], a[156:159], v[100:103], v[244:247]
v_cvt_pk_bf16_f32 v42, v56, v57
M v[248:251], a[156:159], v[104:107], v[248:251]
v_exp_f32 v58, v58
M v[248:251], a[160:163], v[136:139], v[248:251]
s_waitcnt vmcnt(16) lgkmcnt(0)
s_barrier
ds_read_b128 a[116:119], v2 offset:0
ds_read_b128 a[120:123], v2 offset:1024
ds_read_b128 a[124:127], v2 offset:2048
ds_read_b128 a[128:131], v2 offset:3072
M v[252:255], a[160:163], v[140:143], v[252:255]
v_exp_f32 v59, v59
M v[252:255], a[156:159], v[108:111], v[252:255]
v_cvt_pk_bf16_f32 v43, v58, v59
M a[64:67], a[164:167], v[96:99], a[64:67]
v_exp_f32 v44, v44
M a[64:67], a[168:171], v[128:131], a[64:67]
ds_read_b128 a[132:135], v2 offset:4096
ds_read_b128 a[136:139], v2 offset:5120
M a[68:71], a[168:171], v[132:135], a[68:71]
v_exp_f32 v45, v45
M a[68:71], a[164:167], v[100:103], a[68:71]
v_cvt_pk_bf16_f32 v44, v44, v45
M a[72:75], a[164:167], v[104:107], a[72:75]
v_exp_f32 v46, v46
M a[72:75], a[168:171], v[136:139], a[72:75]
M a[76:79], a[168:171], v[140:143], a[76:79]
v_exp_f32 v47, v47
M a[76:79], a[164:167], v[108:111], a[76:79]
v_cvt_pk_bf16_f32 v45, v46, v47
M a[80:83], a[172:175], v[96:99], a[80:83]
v_exp_f32 v60, v60
M a[80:83], a[176:179], v[128:131], a[80:83]
ds_read_b128 a[140:143], v2 offset:6144
ds_read_b128 a[144:147], v2 offset:7168
M a[84:87], a[176:179], v[132:135], a[84:87]
v_exp_f32 v61, v61
M a[84:87], a[172:175], v[100:103], a[84:87]
v_cvt_pk_bf16_f32 v46, v60, v61
M a[88:91], a[172:175], v[104:107], a[88:91]
v_exp_f32 v62, v62
M a[88:91], a[176:179], v[136:139], a[88:91]
M a[92:95], a[176:179], v[140:143], a[92:95]
v_exp_f32 v63, v63
M a[92:95], a[172:175], v[108:111], a[92:95]
v_cvt_pk_bf16_f32 v47, v62, v63
Lk2_m2:
s_sub_u32 s35, 15, s21
s_lshl_b32 s33, s20, 7
s_lshl_b32 s34, s35, 3
s_add_u32 s33, s33, s34
s_lshl_b32 s34, s23, 2
s_add_u32 s33, s33, s34
s_lshl_b32 s33, s33, 12
buffer_load_dwordx4 a[180:183], v1, s[8:11], s33 offen offset:0 sc1
buffer_load_dwordx4 a[184:187], v1, s[8:11], s33 offen offset:1024 sc1
buffer_load_dwordx4 a[188:191], v1, s[8:11], s33 offen offset:2048 sc1
buffer_load_dwordx4 a[192:195], v1, s[8:11], s33 offen offset:3072 sc1
s_add_u32 s33, s33, 4096
buffer_load_dwordx4 a[196:199], v1, s[8:11], s33 offen offset:0 sc1
buffer_load_dwordx4 a[200:203], v1, s[8:11], s33 offen offset:1024 sc1
buffer_load_dwordx4 a[204:207], v1, s[8:11], s33 offen offset:2048 sc1
buffer_load_dwordx4 a[208:211], v1, s[8:11], s33 offen offset:3072 sc1
s_add_u32 s33, s33, 4096
buffer_load_dwordx4 a[212:215], v1, s[8:11], s33 offen offset:0 sc1
buffer_load_dwordx4 a[216:219], v1, s[8:11], s33 offen offset:1024 sc1
buffer_load_dwordx4 a[220:223], v1, s[8:11], s33 offen offset:2048 sc1
buffer_load_dwordx4 a[224:227], v1, s[8:11], s33 offen offset:3072 sc1
s_add_u32 s33, s33, 4096
buffer_load_dwordx4 a[228:231], v1, s[8:11], s33 offen offset:0 sc1
buffer_load_dwordx4 a[232:235], v1, s[8:11], s33 offen offset:1024 sc1
buffer_load_dwordx4 a[236:239], v1, s[8:11], s33 offen offset:2048 sc1
buffer_load_dwordx4 a[240:243], v1, s[8:11], s33 offen offset:3072 sc1
s_lshl_b32 s33, s23, 6
s_add_i32 s33, s33, -64
s_cmp_gt_i32 s33, 0
s_cselect_b32 s34, 0, 0xf149f2ca
s_cmp_lt_i32 s33, 0
s_cselect_b32 s33, 0xf149f2ca, 0
v_mov_b32 v20, s34
v_mov_b32 v21, s34
v_mov_b32 v22, s34
v_mov_b32 v23, s34
v_mov_b32 v28, s33
v_mov_b32 v29, s33
v_mov_b32 v30, s33
v_mov_b32 v31, s33
v_med3_f32 v24, v16, v20, v28
v_med3_f32 v25, v17, v20, v28
v_med3_f32 v26, v18, v20, v28
v_med3_f32 v27, v19, v20, v28
s_waitcnt lgkmcnt(4)
s_add_u32 m0, s29, 98304
M v[96:99], a[116:119], a[0:3], v[24:27]
v_exp_f32 v64, v64
M v[96:99], a[120:123], a[4:7], v[96:99]
ds_read_b128 a[148:151], v2 offset:8192
ds_read_b128 a[152:155], v2 offset:9216
M v[96:99], a[124:127], a[8:11], v[96:99]
v_exp_f32 v65, v65
M v[96:99], a[128:131], a[12:15], v[96:99]
buffer_load_dwordx4 v1, s[12:15], s26 offen offset:0 sc1 lds
s_add_u32 s32, s26, 4096
M v[100:103], a[128:131], a[28:31], v[28:31]
v_exp_f32 v66, v66
M v[100:103], a[124:127], a[24:27], v[100:103]
v_cvt_pk_bf16_f32 v64, v64, v65
M v[100:103], a[120:123], a[20:23], v[100:103]
v_exp_f32 v67, v67
M v[100:103], a[116:119], a[16:19], v[100:103]
buffer_load_dwordx4 v1, s[12:15], s26 offen offset:1024 sc1 lds
M v[104:107], a[116:119], a[32:35], v[28:31]
v_exp_f32 v80, v80
M v[104:107], a[120:123], a[36:39], v[104:107]
ds_read_b128 a[156:159], v2 offset:10240
ds_read_b128 a[160:163], v2 offset:11264
M v[104:107], a[124:127], a[40:43], v[104:107]
v_exp_f32 v81, v81
M v[104:107], a[128:131], a[44:47], v[104:107]
buffer_load_dwordx4 v1, s[12:15], s26 offen offset:2048 sc1 lds
M v[108:111], a[128:131], a[60:63], v[28:31]
v_exp_f32 v82, v82
M v[108:111], a[124:127], a[56:59], v[108:111]
v_cvt_pk_bf16_f32 v65, v66, v67
v_cvt_pk_bf16_f32 v66, v80, v81
M v[108:111], a[120:123], a[52:55], v[108:111]
v_exp_f32 v83, v83
M v[108:111], a[116:119], a[48:51], v[108:111]
buffer_load_dwordx4 v1, s[12:15], s26 offen offset:3072 sc1 lds
s_add_u32 m0, s29, 102400
s_waitcnt lgkmcnt(4)
M v[112:115], a[132:135], a[0:3], v[20:23]
v_exp_f32 v68, v68
M v[112:115], a[136:139], a[4:7], v[112:115]
ds_read_b128 a[164:167], v2 offset:12288
ds_read_b128 a[168:171], v2 offset:13312
M v[112:115], a[140:143], a[8:11], v[112:115]
v_exp_f32 v69, v69
M v[112:115], a[144:147], a[12:15], v[112:115]
buffer_load_dwordx4 v1, s[12:15], s32 offen offset:0 sc1 lds
M v[116:119], a[144:147], a[28:31], v[24:27]
v_exp_f32 v70, v70
M v[116:119], a[140:143], a[24:27], v[116:119]
v_cvt_pk_bf16_f32 v67, v82, v83
v_cvt_pk_bf16_f32 v68, v68, v69
M v[116:119], a[136:139], a[20:23], v[116:119]
v_exp_f32 v71, v71
M v[116:119], a[132:135], a[16:19], v[116:119]
buffer_load_dwordx4 v1, s[12:15], s32 offen offset:1024 sc1 lds
M v[120:123], a[132:135], a[32:35], v[28:31]
v_exp_f32 v84, v84
M v[120:123], a[136:139], a[36:39], v[120:123]
ds_read_b128 a[172:175], v2 offset:14336
ds_read_b128 a[176:179], v2 offset:15360
M v[120:123], a[140:143], a[40:43], v[120:123]
v_exp_f32 v85, v85
M v[120:123], a[144:147], a[44:47], v[120:123]
buffer_load_dwordx4 v1, s[12:15], s32 offen offset:2048 sc1 lds
M v[124:127], a[144:147], a[60:63], v[28:31]
v_exp_f32 v86, v86
M v[124:127], a[140:143], a[56:59], v[124:127]
v_cvt_pk_bf16_f32 v69, v70, v71
v_cvt_pk_bf16_f32 v70, v84, v85
M v[124:127], a[136:139], a[52:55], v[124:127]
v_exp_f32 v87, v87
M v[124:127], a[132:135], a[48:51], v[124:127]
buffer_load_dwordx4 v1, s[12:15], s32 offen offset:3072 sc1 lds
s_waitcnt lgkmcnt(4)
M v[128:131], a[148:151], a[0:3], v[20:23]
v_exp_f32 v72, v72
M v[128:131], a[152:155], a[4:7], v[128:131]
s_add_u32 s26, s26, 32768
s_cmp_eq_u32 s26, s62
s_cselect_b32 s26, s63, s26
s_cselect_b32 s62, -1, s62
M v[128:131], a[156:159], a[8:11], v[128:131]
v_exp_f32 v73, v73
M v[128:131], a[160:163], a[12:15], v[128:131]
v_cvt_pk_bf16_f32 v71, v86, v87
v_cvt_pk_bf16_f32 v72, v72, v73
M v[132:135], a[160:163], a[28:31], v[20:23]
v_exp_f32 v74, v74
M v[132:135], a[156:159], a[24:27], v[132:135]
M v[132:135], a[152:155], a[20:23], v[132:135]
v_exp_f32 v75, v75
M v[132:135], a[148:151], a[16:19], v[132:135]
v_cvt_pk_bf16_f32 v73, v74, v75
M v[136:139], a[148:151], a[32:35], v[24:27]
v_exp_f32 v88, v88
M v[136:139], a[152:155], a[36:39], v[136:139]
M v[136:139], a[156:159], a[40:43], v[136:139]
v_exp_f32 v89, v89
M v[136:139], a[160:163], a[44:47], v[136:139]
v_cvt_pk_bf16_f32 v74, v88, v89
M v[140:143], a[160:163], a[60:63], v[28:31]
v_exp_f32 v90, v90
M v[140:143], a[156:159], a[56:59], v[140:143]
s_waitcnt vmcnt(32) lgkmcnt(0)
s_barrier
ds_read_b128 a[116:119], v2 offset:32768
ds_read_b128 a[120:123], v2 offset:40960
ds_read_b128 a[124:127], v2 offset:33792
ds_read_b128 a[128:131], v2 offset:41984
M v[140:143], a[152:155], a[52:55], v[140:143]
v_exp_f32 v91, v91
M v[140:143], a[148:151], a[48:51], v[140:143]
v_cvt_pk_bf16_f32 v75, v90, v91
M v[144:147], a[164:167], a[0:3], v[20:23]
v_exp_f32 v76, v76
M v[144:147], a[168:171], a[4:7], v[144:147]
ds_read_b128 a[132:135], v2 offset:34816
ds_read_b128 a[136:139], v2 offset:43008
M v[144:147], a[172:175], a[8:11], v[144:147]
v_exp_f32 v77, v77
M v[144:147], a[176:179], a[12:15], v[144:147]
v_cvt_pk_bf16_f32 v76, v76, v77
M v[148:151], a[176:179], a[28:31], v[20:23]
v_exp_f32 v78, v78
M v[148:151], a[172:175], a[24:27], v[148:151]
M v[148:151], a[168:171], a[20:23], v[148:151]
v_exp_f32 v79, v79
M v[148:151], a[164:167], a[16:19], v[148:151]
v_cvt_pk_bf16_f32 v77, v78, v79
M v[152:155], a[164:167], a[32:35], v[20:23]
v_exp_f32 v92, v92
M v[152:155], a[168:171], a[36:39], v[152:155]
ds_read_b128 a[140:143], v2 offset:35840
ds_read_b128 a[144:147], v2 offset:44032
M v[152:155], a[172:175], a[40:43], v[152:155]
v_exp_f32 v93, v93
M v[152:155], a[176:179], a[44:47], v[152:155]
v_cvt_pk_bf16_f32 v78, v92, v93
M v[156:159], a[176:179], a[60:63], v[24:27]
v_exp_f32 v94, v94
M v[156:159], a[172:175], a[56:59], v[156:159]
M v[156:159], a[168:171], a[52:55], v[156:159]
v_exp_f32 v95, v95
M v[156:159], a[164:167], a[48:51], v[156:159]
v_cvt_pk_bf16_f32 v79, v94, v95
s_waitcnt lgkmcnt(6)
s_add_u32 m0, s29, 0
M v[160:163], a[116:119], v[32:35], v[160:163]
v_exp_f32 v96, v96
M v[160:163], a[120:123], v[64:67], v[160:163]
ds_read_b128 a[148:151], v2 offset:36864
ds_read_b128 a[152:155], v2 offset:45056
M v[164:167], a[120:123], v[68:71], v[164:167]
v_exp_f32 v97, v97
M v[164:167], a[116:119], v[36:39], v[164:167]
buffer_load_dwordx4 v1, s[12:15], s25 offen offset:0 sc1 lds
s_add_u32 s32, s25, 4096
M v[168:171], a[116:119], v[40:43], v[168:171]
v_exp_f32 v98, v98
M v[168:171], a[120:123], v[72:75], v[168:171]
v_cvt_pk_bf16_f32 v96, v96, v97
M v[172:175], a[120:123], v[76:79], v[172:175]
v_exp_f32 v99, v99
M v[172:175], a[116:119], v[44:47], v[172:175]
buffer_load_dwordx4 v1, s[12:15], s25 offen offset:1024 sc1 lds
s_waitcnt lgkmcnt(6)
M a[96:99], a[112:115], v[32:35], a[96:99]
M a[96:99], a[112:115], v[64:67], a[96:99]
M v[176:179], a[124:127], v[32:35], v[176:179]
v_exp_f32 v112, v112
M v[176:179], a[128:131], v[64:67], v[176:179]
ds_read_b128 a[156:159], v2 offset:37888
ds_read_b128 a[160:163], v2 offset:46080
M v[180:183], a[128:131], v[68:71], v[180:183]
v_exp_f32 v113, v113
M v[180:183], a[124:127], v[36:39], v[180:183]
buffer_load_dwordx4 v1, s[12:15], s25 offen offset:2048 sc1 lds
M v[184:187], a[124:127], v[40:43], v[184:187]
v_exp_f32 v114, v114
M v[184:187], a[128:131], v[72:75], v[184:187]
v_cvt_pk_bf16_f32 v97, v98, v99
v_cvt_pk_bf16_f32 v98, v112, v113
M v[188:191], a[128:131], v[76:79], v[188:191]
v_exp_f32 v115, v115
M v[188:191], a[124:127], v[44:47], v[188:191]
buffer_load_dwordx4 v1, s[12:15], s25 offen offset:3072 sc1 lds
s_add_u32 m0, s29, 4096
s_waitcnt lgkmcnt(6)
M a[100:103], a[112:115], v[36:39], a[100:103]
M a[100:103], a[112:115], v[68:71], a[100:103]
M v[192:195], a[132:135], v[32:35], v[192:195]
v_exp_f32 v100, v100
M v[192:195], a[136:139], v[64:67], v[192:195]
ds_read_b128 a[164:167], v2 offset:38912
ds_read_b128 a[168:171], v2 offset:47104
M v[196:199], a[136:139], v[68:71], v[196:199]
v_exp_f32 v101, v101
M v[196:199], a[132:135], v[36:39], v[196:199]
buffer_load_dwordx4 v1, s[12:15], s32 offen offset:0 sc1 lds
M v[200:203], a[132:135], v[40:43], v[200:203]
v_exp_f32 v102, v102
M v[200:203], a[136:139], v[72:75], v[200:203]
v_cvt_pk_bf16_f32 v99, v114, v115
v_cvt_pk_bf16_f32 v100, v100, v101
M v[204:207], a[136:139], v[76:79], v[204:207]
v_exp_f32 v103, v103
M v[204:207], a[132:135], v[44:47], v[204:207]
buffer_load_dwordx4 v1, s[12:15], s32 offen offset:1024 sc1 lds
s_waitcnt lgkmcnt(6)
M a[104:107], a[112:115], v[40:43], a[104:107]
M a[104:107], a[112:115], v[72:75], a[104:107]
M v[208:211], a[140:143], v[32:35], v[208:211]
v_exp_f32 v116, v116
M v[208:211], a[144:147], v[64:67], v[208:211]
ds_read_b128 a[172:175], v2 offset:39936
ds_read_b128 a[176:179], v2 offset:48128
M v[212:215], a[144:147], v[68:71], v[212:215]
v_exp_f32 v117, v117
M v[212:215], a[140:143], v[36:39], v[212:215]
buffer_load_dwordx4 v1, s[12:15], s32 offen offset:2048 sc1 lds
M v[216:219], a[140:143], v[40:43], v[216:219]
v_exp_f32 v118, v118
M v[216:219], a[144:147], v[72:75], v[216:219]
v_cvt_pk_bf16_f32 v101, v102, v103
v_cvt_pk_bf16_f32 v102, v116, v117
M v[220:223], a[144:147], v[76:79], v[220:223]
v_exp_f32 v119, v119
M v[220:223], a[140:143], v[44:47], v[220:223]
buffer_load_dwordx4 v1, s[12:15], s32 offen offset:3072 sc1 lds
s_waitcnt lgkmcnt(6)
M a[108:111], a[112:115], v[44:47], a[108:111]
M a[108:111], a[112:115], v[76:79], a[108:111]
M v[224:227], a[148:151], v[32:35], v[224:227]
v_exp_f32 v104, v104
M v[224:227], a[152:155], v[64:67], v[224:227]
s_add_u32 s25, s25, 32768
s_cmp_eq_u32 s25, s27
s_cselect_b32 s25, s28, s25
s_cselect_b32 s27, -1, s27
M v[228:231], a[152:155], v[68:71], v[228:231]
v_exp_f32 v105, v105
M v[228:231], a[148:151], v[36:39], v[228:231]
v_cvt_pk_bf16_f32 v103, v118, v119
v_cvt_pk_bf16_f32 v104, v104, v105
M v[232:235], a[148:151], v[40:43], v[232:235]
v_exp_f32 v106, v106
M v[232:235], a[152:155], v[72:75], v[232:235]
M v[236:239], a[152:155], v[76:79], v[236:239]
v_exp_f32 v107, v107
M v[236:239], a[148:151], v[44:47], v[236:239]
v_cvt_pk_bf16_f32 v105, v106, v107
s_waitcnt lgkmcnt(4)
M v[240:243], a[156:159], v[32:35], v[240:243]
v_exp_f32 v120, v120
M v[240:243], a[160:163], v[64:67], v[240:243]
M v[244:247], a[160:163], v[68:71], v[244:247]
v_exp_f32 v121, v121
M v[244:247], a[156:159], v[36:39], v[244:247]
v_cvt_pk_bf16_f32 v106, v120, v121
M v[248:251], a[156:159], v[40:43], v[248:251]
v_exp_f32 v122, v122
M v[248:251], a[160:163], v[72:75], v[248:251]
s_waitcnt vmcnt(32) lgkmcnt(0)
s_barrier
ds_read_b128 a[116:119], v3 offset:0
ds_read_b128 a[120:123], v3 offset:1024
ds_read_b128 a[124:127], v3 offset:2048
ds_read_b128 a[128:131], v3 offset:3072
M v[252:255], a[160:163], v[76:79], v[252:255]
v_exp_f32 v123, v123
M v[252:255], a[156:159], v[44:47], v[252:255]
v_cvt_pk_bf16_f32 v107, v122, v123
M a[64:67], a[164:167], v[32:35], a[64:67]
v_exp_f32 v108, v108
M a[64:67], a[168:171], v[64:67], a[64:67]
ds_read_b128 a[132:135], v3 offset:4096
ds_read_b128 a[136:139], v3 offset:5120
M a[68:71], a[168:171], v[68:71], a[68:71]
v_exp_f32 v109, v109
M a[68:71], a[164:167], v[36:39], a[68:71]
v_cvt_pk_bf16_f32 v108, v108, v109
M a[72:75], a[164:167], v[40:43], a[72:75]
v_exp_f32 v110, v110
M a[72:75], a[168:171], v[72:75], a[72:75]
M a[76:79], a[168:171], v[76:79], a[76:79]
v_exp_f32 v111, v111
M a[76:79], a[164:167], v[44:47], a[76:79]
v_cvt_pk_bf16_f32 v109, v110, v111
M a[80:83], a[172:175], v[32:35], a[80:83]
v_exp_f32 v124, v124
M a[80:83], a[176:179], v[64:67], a[80:83]
ds_read_b128 a[140:143], v3 offset:6144
ds_read_b128 a[144:147], v3 offset:7168
M a[84:87], a[176:179], v[68:71], a[84:87]
v_exp_f32 v125, v125
M a[84:87], a[172:175], v[36:39], a[84:87]
v_cvt_pk_bf16_f32 v110, v124, v125
M a[88:91], a[172:175], v[40:43], a[88:91]
v_exp_f32 v126, v126
M a[88:91], a[176:179], v[72:75], a[88:91]
M a[92:95], a[176:179], v[76:79], a[92:95]
v_exp_f32 v127, v127
M a[92:95], a[172:175], v[44:47], a[92:95]
v_cvt_pk_bf16_f32 v111, v126, v127
s_waitcnt vmcnt(16)
s_waitcnt lgkmcnt(4)
s_add_u32 m0, s29, 32768
M v[32:35], a[116:119], a[180:183], 0
v_exp_f32 v128, v128
M v[32:35], a[120:123], a[184:187], v[32:35]
ds_read_b128 a[148:151], v3 offset:8192
ds_read_b128 a[152:155], v3 offset:9216
M v[32:35], a[124:127], a[188:191], v[32:35]
v_exp_f32 v129, v129
M v[32:35], a[128:131], a[192:195], v[32:35]
buffer_load_dwordx4 v1, s[12:15], s26 offen offset:0 sc1 lds
s_add_u32 s32, s26, 4096
M v[36:39], a[128:131], a[208:211], 0
v_exp_f32 v130, v130
M v[36:39], a[124:127], a[204:207], v[36:39]
v_cvt_pk_bf16_f32 v128, v128, v129
M v[36:39], a[120:123], a[200:203], v[36:39]
v_exp_f32 v131, v131
M v[36:39], a[116:119], a[196:199], v[36:39]
buffer_load_dwordx4 v1, s[12:15], s26 offen offset:1024 sc1 lds
M v[40:43], a[116:119], a[212:215], 0
v_exp_f32 v144, v144
M v[40:43], a[120:123], a[216:219], v[40:43]
ds_read_b128 a[156:159], v3 offset:10240
ds_read_b128 a[160:163], v3 offset:11264
M v[40:43], a[124:127], a[220:223], v[40:43]
v_exp_f32 v145, v145
M v[40:43], a[128:131], a[224:227], v[40:43]
buffer_load_dwordx4 v1, s[12:15], s26 offen offset:2048 sc1 lds
M v[44:47], a[128:131], a[240:243], 0
v_exp_f32 v146, v146
M v[44:47], a[124:127], a[236:239], v[44:47]
v_cvt_pk_bf16_f32 v129, v130, v131
v_cvt_pk_bf16_f32 v130, v144, v145
M v[44:47], a[120:123], a[232:235], v[44:47]
v_exp_f32 v147, v147
M v[44:47], a[116:119], a[228:231], v[44:47]
buffer_load_dwordx4 v1, s[12:15], s26 offen offset:3072 sc1 lds
s_add_u32 m0, s29, 36864
s_waitcnt lgkmcnt(4)
M v[48:51], a[132:135], a[180:183], 0
v_exp_f32 v132, v132
M v[48:51], a[136:139], a[184:187], v[48:51]
ds_read_b128 a[164:167], v3 offset:12288
ds_read_b128 a[168:171], v3 offset:13312
M v[48:51], a[140:143], a[188:191], v[48:51]
v_exp_f32 v133, v133
M v[48:51], a[144:147], a[192:195], v[48:51]
buffer_load_dwordx4 v1, s[12:15], s32 offen offset:0 sc1 lds
M v[52:55], a[144:147], a[208:211], 0
v_exp_f32 v134, v134
M v[52:55], a[140:143], a[204:207], v[52:55]
v_cvt_pk_bf16_f32 v131, v146, v147
v_cvt_pk_bf16_f32 v132, v132, v133
M v[52:55], a[136:139], a[200:203], v[52:55]
v_exp_f32 v135, v135
M v[52:55], a[132:135], a[196:199], v[52:55]
buffer_load_dwordx4 v1, s[12:15], s32 offen offset:1024 sc1 lds
M v[56:59], a[132:135], a[212:215], 0
v_exp_f32 v148, v148
M v[56:59], a[136:139], a[216:219], v[56:59]
ds_read_b128 a[172:175], v3 offset:14336
ds_read_b128 a[176:179], v3 offset:15360
M v[56:59], a[140:143], a[220:223], v[56:59]
v_exp_f32 v149, v149
M v[56:59], a[144:147], a[224:227], v[56:59]
buffer_load_dwordx4 v1, s[12:15], s32 offen offset:2048 sc1 lds
M v[60:63], a[144:147], a[240:243], 0
v_exp_f32 v150, v150
M v[60:63], a[140:143], a[236:239], v[60:63]
v_cvt_pk_bf16_f32 v133, v134, v135
v_cvt_pk_bf16_f32 v134, v148, v149
M v[60:63], a[136:139], a[232:235], v[60:63]
v_exp_f32 v151, v151
M v[60:63], a[132:135], a[228:231], v[60:63]
buffer_load_dwordx4 v1, s[12:15], s32 offen offset:3072 sc1 lds
s_waitcnt lgkmcnt(4)
M v[64:67], a[148:151], a[180:183], 0
v_exp_f32 v136, v136
M v[64:67], a[152:155], a[184:187], v[64:67]
s_add_u32 s26, s26, 32768
s_cmp_eq_u32 s26, s62
s_cselect_b32 s26, s63, s26
s_cselect_b32 s62, -1, s62
M v[64:67], a[156:159], a[188:191], v[64:67]
v_exp_f32 v137, v137
M v[64:67], a[160:163], a[192:195], v[64:67]
v_cvt_pk_bf16_f32 v135, v150, v151
v_cvt_pk_bf16_f32 v136, v136, v137
M v[68:71], a[160:163], a[208:211], 0
v_exp_f32 v138, v138
M v[68:71], a[156:159], a[204:207], v[68:71]
M v[68:71], a[152:155], a[200:203], v[68:71]
v_exp_f32 v139, v139
M v[68:71], a[148:151], a[196:199], v[68:71]
v_cvt_pk_bf16_f32 v137, v138, v139
M v[72:75], a[148:151], a[212:215], 0
v_exp_f32 v152, v152
M v[72:75], a[152:155], a[216:219], v[72:75]
M v[72:75], a[156:159], a[220:223], v[72:75]
v_exp_f32 v153, v153
M v[72:75], a[160:163], a[224:227], v[72:75]
v_cvt_pk_bf16_f32 v138, v152, v153
M v[76:79], a[160:163], a[240:243], 0
v_exp_f32 v154, v154
M v[76:79], a[156:159], a[236:239], v[76:79]
s_waitcnt vmcnt(16) lgkmcnt(0)
s_barrier
ds_read_b128 a[116:119], v3 offset:32768
ds_read_b128 a[120:123], v3 offset:40960
ds_read_b128 a[124:127], v3 offset:33792
ds_read_b128 a[128:131], v3 offset:41984
M v[76:79], a[152:155], a[232:235], v[76:79]
v_exp_f32 v155, v155
M v[76:79], a[148:151], a[228:231], v[76:79]
v_cvt_pk_bf16_f32 v139, v154, v155
M v[80:83], a[164:167], a[180:183], 0
v_exp_f32 v140, v140
M v[80:83], a[168:171], a[184:187], v[80:83]
ds_read_b128 a[132:135], v3 offset:34816
ds_read_b128 a[136:139], v3 offset:43008
M v[80:83], a[172:175], a[188:191], v[80:83]
v_exp_f32 v141, v141
M v[80:83], a[176:179], a[192:195], v[80:83]
v_cvt_pk_bf16_f32 v140, v140, v141
M v[84:87], a[176:179], a[208:211], 0
v_exp_f32 v142, v142
M v[84:87], a[172:175], a[204:207], v[84:87]
M v[84:87], a[168:171], a[200:203], v[84:87]
v_exp_f32 v143, v143
M v[84:87], a[164:167], a[196:199], v[84:87]
v_cvt_pk_bf16_f32 v141, v142, v143
M v[88:91], a[164:167], a[212:215], 0
v_exp_f32 v156, v156
M v[88:91], a[168:171], a[216:219], v[88:91]
ds_read_b128 a[140:143], v3 offset:35840
ds_read_b128 a[144:147], v3 offset:44032
M v[88:91], a[172:175], a[220:223], v[88:91]
v_exp_f32 v157, v157
M v[88:91], a[176:179], a[224:227], v[88:91]
v_cvt_pk_bf16_f32 v142, v156, v157
M v[92:95], a[176:179], a[240:243], 0
v_exp_f32 v158, v158
M v[92:95], a[172:175], a[236:239], v[92:95]
M v[92:95], a[168:171], a[232:235], v[92:95]
v_exp_f32 v159, v159
M v[92:95], a[164:167], a[228:231], v[92:95]
v_cvt_pk_bf16_f32 v143, v158, v159
s_waitcnt lgkmcnt(6)
s_add_u32 m0, s29, 65536
M v[160:163], a[116:119], v[96:99], v[160:163]
v_exp_f32 v32, v32
M v[160:163], a[120:123], v[128:131], v[160:163]
ds_read_b128 a[148:151], v3 offset:36864
ds_read_b128 a[152:155], v3 offset:45056
M v[164:167], a[120:123], v[132:135], v[164:167]
v_exp_f32 v33, v33
M v[164:167], a[116:119], v[100:103], v[164:167]
buffer_load_dwordx4 v1, s[12:15], s25 offen offset:0 sc1 lds
s_add_u32 s32, s25, 4096
M v[168:171], a[116:119], v[104:107], v[168:171]
v_exp_f32 v34, v34
M v[168:171], a[120:123], v[136:139], v[168:171]
v_cvt_pk_bf16_f32 v32, v32, v33
M v[172:175], a[120:123], v[140:143], v[172:175]
v_exp_f32 v35, v35
M v[172:175], a[116:119], v[108:111], v[172:175]
buffer_load_dwordx4 v1, s[12:15], s25 offen offset:1024 sc1 lds
s_waitcnt lgkmcnt(6)
M a[96:99], a[112:115], v[96:99], a[96:99]
M a[96:99], a[112:115], v[128:131], a[96:99]
M v[176:179], a[124:127], v[96:99], v[176:179]
v_exp_f32 v48, v48
M v[176:179], a[128:131], v[128:131], v[176:179]
ds_read_b128 a[156:159], v3 offset:37888
ds_read_b128 a[160:163], v3 offset:46080
M v[180:183], a[128:131], v[132:135], v[180:183]
v_exp_f32 v49, v49
M v[180:183], a[124:127], v[100:103], v[180:183]
buffer_load_dwordx4 v1, s[12:15], s25 offen offset:2048 sc1 lds
M v[184:187], a[124:127], v[104:107], v[184:187]
v_exp_f32 v50, v50
M v[184:187], a[128:131], v[136:139], v[184:187]
v_cvt_pk_bf16_f32 v33, v34, v35
v_cvt_pk_bf16_f32 v34, v48, v49
M v[188:191], a[128:131], v[140:143], v[188:191]
v_exp_f32 v51, v51
M v[188:191], a[124:127], v[108:111], v[188:191]
buffer_load_dwordx4 v1, s[12:15], s25 offen offset:3072 sc1 lds
s_add_u32 m0, s29, 69632
s_waitcnt lgkmcnt(6)
M a[100:103], a[112:115], v[100:103], a[100:103]
M a[100:103], a[112:115], v[132:135], a[100:103]
M v[192:195], a[132:135], v[96:99], v[192:195]
v_exp_f32 v36, v36
M v[192:195], a[136:139], v[128:131], v[192:195]
ds_read_b128 a[164:167], v3 offset:38912
ds_read_b128 a[168:171], v3 offset:47104
M v[196:199], a[136:139], v[132:135], v[196:199]
v_exp_f32 v37, v37
M v[196:199], a[132:135], v[100:103], v[196:199]
buffer_load_dwordx4 v1, s[12:15], s32 offen offset:0 sc1 lds
M v[200:203], a[132:135], v[104:107], v[200:203]
v_exp_f32 v38, v38
M v[200:203], a[136:139], v[136:139], v[200:203]
v_cvt_pk_bf16_f32 v35, v50, v51
v_cvt_pk_bf16_f32 v36, v36, v37
M v[204:207], a[136:139], v[140:143], v[204:207]
v_exp_f32 v39, v39
M v[204:207], a[132:135], v[108:111], v[204:207]
buffer_load_dwordx4 v1, s[12:15], s32 offen offset:1024 sc1 lds
s_waitcnt lgkmcnt(6)
M a[104:107], a[112:115], v[104:107], a[104:107]
M a[104:107], a[112:115], v[136:139], a[104:107]
M v[208:211], a[140:143], v[96:99], v[208:211]
v_exp_f32 v52, v52
M v[208:211], a[144:147], v[128:131], v[208:211]
ds_read_b128 a[172:175], v3 offset:39936
ds_read_b128 a[176:179], v3 offset:48128
M v[212:215], a[144:147], v[132:135], v[212:215]
v_exp_f32 v53, v53
M v[212:215], a[140:143], v[100:103], v[212:215]
buffer_load_dwordx4 v1, s[12:15], s32 offen offset:2048 sc1 lds
M v[216:219], a[140:143], v[104:107], v[216:219]
v_exp_f32 v54, v54
M v[216:219], a[144:147], v[136:139], v[216:219]
v_cvt_pk_bf16_f32 v37, v38, v39
v_cvt_pk_bf16_f32 v38, v52, v53
M v[220:223], a[144:147], v[140:143], v[220:223]
v_exp_f32 v55, v55
M v[220:223], a[140:143], v[108:111], v[220:223]
buffer_load_dwordx4 v1, s[12:15], s32 offen offset:3072 sc1 lds
s_waitcnt lgkmcnt(6)
M a[108:111], a[112:115], v[108:111], a[108:111]
M a[108:111], a[112:115], v[140:143], a[108:111]
M v[224:227], a[148:151], v[96:99], v[224:227]
v_exp_f32 v40, v40
M v[224:227], a[152:155], v[128:131], v[224:227]
s_add_u32 s25, s25, 32768
s_cmp_eq_u32 s25, s27
s_cselect_b32 s25, s28, s25
s_cselect_b32 s27, -1, s27
M v[228:231], a[152:155], v[132:135], v[228:231]
v_exp_f32 v41, v41
M v[228:231], a[148:151], v[100:103], v[228:231]
v_cvt_pk_bf16_f32 v39, v54, v55
v_cvt_pk_bf16_f32 v40, v40, v41
M v[232:235], a[148:151], v[104:107], v[232:235]
v_exp_f32 v42, v42
M v[232:235], a[152:155], v[136:139], v[232:235]
M v[236:239], a[152:155], v[140:143], v[236:239]
v_exp_f32 v43, v43
M v[236:239], a[148:151], v[108:111], v[236:239]
v_cvt_pk_bf16_f32 v41, v42, v43
s_waitcnt lgkmcnt(4)
M v[240:243], a[156:159], v[96:99], v[240:243]
v_exp_f32 v56, v56
M v[240:243], a[160:163], v[128:131], v[240:243]
M v[244:247], a[160:163], v[132:135], v[244:247]
v_exp_f32 v57, v57
M v[244:247], a[156:159], v[100:103], v[244:247]
v_cvt_pk_bf16_f32 v42, v56, v57
M v[248:251], a[156:159], v[104:107], v[248:251]
v_exp_f32 v58, v58
M v[248:251], a[160:163], v[136:139], v[248:251]
s_waitcnt vmcnt(16) lgkmcnt(0)
s_barrier
ds_read_b128 a[116:119], v2 offset:0
ds_read_b128 a[120:123], v2 offset:1024
ds_read_b128 a[124:127], v2 offset:2048
ds_read_b128 a[128:131], v2 offset:3072
M v[252:255], a[160:163], v[140:143], v[252:255]
v_exp_f32 v59, v59
M v[252:255], a[156:159], v[108:111], v[252:255]
v_cvt_pk_bf16_f32 v43, v58, v59
M a[64:67], a[164:167], v[96:99], a[64:67]
v_exp_f32 v44, v44
M a[64:67], a[168:171], v[128:131], a[64:67]
ds_read_b128 a[132:135], v2 offset:4096
ds_read_b128 a[136:139], v2 offset:5120
M a[68:71], a[168:171], v[132:135], a[68:71]
v_exp_f32 v45, v45
M a[68:71], a[164:167], v[100:103], a[68:71]
v_cvt_pk_bf16_f32 v44, v44, v45
M a[72:75], a[164:167], v[104:107], a[72:75]
v_exp_f32 v46, v46
M a[72:75], a[168:171], v[136:139], a[72:75]
M a[76:79], a[168:171], v[140:143], a[76:79]
v_exp_f32 v47, v47
M a[76:79], a[164:167], v[108:111], a[76:79]
v_cvt_pk_bf16_f32 v45, v46, v47
M a[80:83], a[172:175], v[96:99], a[80:83]
v_exp_f32 v60, v60
M a[80:83], a[176:179], v[128:131], a[80:83]
ds_read_b128 a[140:143], v2 offset:6144
ds_read_b128 a[144:147], v2 offset:7168
M a[84:87], a[176:179], v[132:135], a[84:87]
v_exp_f32 v61, v61
M a[84:87], a[172:175], v[100:103], a[84:87]
v_cvt_pk_bf16_f32 v46, v60, v61
M a[88:91], a[172:175], v[104:107], a[88:91]
v_exp_f32 v62, v62
M a[88:91], a[176:179], v[136:139], a[88:91]
M a[92:95], a[176:179], v[140:143], a[92:95]
v_exp_f32 v63, v63
M a[92:95], a[172:175], v[108:111], a[92:95]
v_cvt_pk_bf16_f32 v47, v62, v63
v_accvgpr_read_b32 v20, a96
v_accvgpr_read_b32 v21, a100
v_accvgpr_read_b32 v22, a104
v_accvgpr_read_b32 v23, a108
v_rcp_f32 v8, v20
v_rcp_f32 v9, v21
v_rcp_f32 v10, v22
v_rcp_f32 v11, v23
v_subrev_u32 v20, 0x21800000, v20
v_subrev_u32 v21, 0x21800000, v21
v_subrev_u32 v22, 0x21800000, v22
v_subrev_u32 v23, 0x21800000, v23
v_max_u32 v12, v20, v21
v_max3_u32 v12, v12, v22, v23
s_mov_b32 s64, 0x207
v_pk_mul_f32 v[160:161], v[160:161], v[8:9] op_sel:[0,0] op_sel_hi:[1,0]
v_pk_mul_f32 v[162:163], v[162:163], v[8:9] op_sel:[0,0] op_sel_hi:[1,0]
v_pk_mul_f32 v[176:177], v[176:177], v[8:9] op_sel:[0,0] op_sel_hi:[1,0]
v_pk_mul_f32 v[178:179], v[178:179], v[8:9] op_sel:[0,0] op_sel_hi:[1,0]
v_cvt_pk_bf16_f32 v160, v160, v161
v_cvt_pk_bf16_f32 v161, v162, v163
v_cvt_pk_bf16_f32 v162, v176, v177
v_cvt_pk_bf16_f32 v163, v178, v179
s_nop 1
M v[24:27], a[112:115], v[160:163], 0
v_pk_mul_f32 v[164:165], v[164:165], v[8:9] op_sel:[0,1] op_sel_hi:[1,1]
v_pk_mul_f32 v[166:167], v[166:167], v[8:9] op_sel:[0,1] op_sel_hi:[1,1]
v_pk_mul_f32 v[180:181], v[180:181], v[8:9] op_sel:[0,1] op_sel_hi:[1,1]
v_pk_mul_f32 v[182:183], v[182:183], v[8:9] op_sel:[0,1] op_sel_hi:[1,1]
v_cvt_pk_bf16_f32 v164, v164, v165
v_cvt_pk_bf16_f32 v165, v166, v167
v_cvt_pk_bf16_f32 v166, v180, v181
v_cvt_pk_bf16_f32 v167, v182, v183
s_nop 1
M v[24:27], a[112:115], v[164:167], v[24:27]
v_pk_mul_f32 v[168:169], v[168:169], v[10:11] op_sel:[0,0] op_sel_hi:[1,0]
v_pk_mul_f32 v[170:171], v[170:171], v[10:11] op_sel:[0,0] op_sel_hi:[1,0]
v_pk_mul_f32 v[184:185], v[184:185], v[10:11] op_sel:[0,0] op_sel_hi:[1,0]
v_pk_mul_f32 v[186:187], v[186:187], v[10:11] op_sel:[0,0] op_sel_hi:[1,0]
v_cvt_pk_bf16_f32 v168, v168, v169
v_cvt_pk_bf16_f32 v169, v170, v171
v_cvt_pk_bf16_f32 v170, v184, v185
v_cvt_pk_bf16_f32 v171, v186, v187
s_nop 1
M v[24:27], a[112:115], v[168:171], v[24:27]
v_pk_mul_f32 v[172:173], v[172:173], v[10:11] op_sel:[0,1] op_sel_hi:[1,1]
v_pk_mul_f32 v[174:175], v[174:175], v[10:11] op_sel:[0,1] op_sel_hi:[1,1]
v_pk_mul_f32 v[188:189], v[188:189], v[10:11] op_sel:[0,1] op_sel_hi:[1,1]
v_pk_mul_f32 v[190:191], v[190:191], v[10:11] op_sel:[0,1] op_sel_hi:[1,1]
v_cvt_pk_bf16_f32 v172, v172, v173
v_cvt_pk_bf16_f32 v173, v174, v175
v_cvt_pk_bf16_f32 v174, v188, v189
v_cvt_pk_bf16_f32 v175, v190, v191
s_nop 1
M v[24:27], a[112:115], v[172:175], v[24:27]
v_pk_mul_f32 v[192:193], v[192:193], v[8:9] op_sel:[0,0] op_sel_hi:[1,0]
v_pk_mul_f32 v[194:195], v[194:195], v[8:9] op_sel:[0,0] op_sel_hi:[1,0]
v_pk_mul_f32 v[208:209], v[208:209], v[8:9] op_sel:[0,0] op_sel_hi:[1,0]
v_pk_mul_f32 v[210:211], v[210:211], v[8:9] op_sel:[0,0] op_sel_hi:[1,0]
v_cvt_pk_bf16_f32 v192, v192, v193
v_cvt_pk_bf16_f32 v193, v194, v195
v_cvt_pk_bf16_f32 v194, v208, v209
v_cvt_pk_bf16_f32 v195, v210, v211
s_nop 1
M v[24:27], a[112:115], v[192:195], v[24:27]
v_pk_mul_f32 v[196:197], v[196:197], v[8:9] op_sel:[0,1] op_sel_hi:[1,1]
v_pk_mul_f32 v[198:199], v[198:199], v[8:9] op_sel:[0,1] op_sel_hi:[1,1]
v_pk_mul_f32 v[212:213], v[212:213], v[8:9] op_sel:[0,1] op_sel_hi:[1,1]
v_pk_mul_f32 v[214:215], v[214:215], v[8:9] op_sel:[0,1] op_sel_hi:[1,1]
v_cvt_pk_bf16_f32 v196, v196, v197
v_cvt_pk_bf16_f32 v197, v198, v199
v_cvt_pk_bf16_f32 v198, v212, v213
v_cvt_pk_bf16_f32 v199, v214, v215
s_nop 1
M v[24:27], a[112:115], v[196:199], v[24:27]
v_pk_mul_f32 v[200:201], v[200:201], v[10:11] op_sel:[0,0] op_sel_hi:[1,0]
v_pk_mul_f32 v[202:203], v[202:203], v[10:11] op_sel:[0,0] op_sel_hi:[1,0]
v_pk_mul_f32 v[216:217], v[216:217], v[10:11] op_sel:[0,0] op_sel_hi:[1,0]
v_pk_mul_f32 v[218:219], v[218:219], v[10:11] op_sel:[0,0] op_sel_hi:[1,0]
v_cvt_pk_bf16_f32 v200, v200, v201
v_cvt_pk_bf16_f32 v201, v202, v203
v_cvt_pk_bf16_f32 v202, v216, v217
v_cvt_pk_bf16_f32 v203, v218, v219
s_nop 1
M v[24:27], a[112:115], v[200:203], v[24:27]
v_pk_mul_f32 v[204:205], v[204:205], v[10:11] op_sel:[0,1] op_sel_hi:[1,1]
v_pk_mul_f32 v[206:207], v[206:207], v[10:11] op_sel:[0,1] op_sel_hi:[1,1]
v_pk_mul_f32 v[220:221], v[220:221], v[10:11] op_sel:[0,1] op_sel_hi:[1,1]
v_pk_mul_f32 v[222:223], v[222:223], v[10:11] op_sel:[0,1] op_sel_hi:[1,1]
v_cvt_pk_bf16_f32 v204, v204, v205
v_cvt_pk_bf16_f32 v205, v206, v207
v_cvt_pk_bf16_f32 v206, v220, v221
v_cvt_pk_bf16_f32 v207, v222, v223
s_nop 1
M v[24:27], a[112:115], v[204:207], v[24:27]
v_pk_mul_f32 v[224:225], v[224:225], v[8:9] op_sel:[0,0] op_sel_hi:[1,0]
v_pk_mul_f32 v[226:227], v[226:227], v[8:9] op_sel:[0,0] op_sel_hi:[1,0]
v_pk_mul_f32 v[240:241], v[240:241], v[8:9] op_sel:[0,0] op_sel_hi:[1,0]
v_pk_mul_f32 v[242:243], v[242:243], v[8:9] op_sel:[0,0] op_sel_hi:[1,0]
v_cvt_pk_bf16_f32 v224, v224, v225
v_cvt_pk_bf16_f32 v225, v226, v227
v_cvt_pk_bf16_f32 v226, v240, v241
v_cvt_pk_bf16_f32 v227, v242, v243
s_nop 1
M v[24:27], a[112:115], v[224:227], v[24:27]
v_pk_mul_f32 v[228:229], v[228:229], v[8:9] op_sel:[0,1] op_sel_hi:[1,1]
v_pk_mul_f32 v[230:231], v[230:231], v[8:9] op_sel:[0,1] op_sel_hi:[1,1]
v_pk_mul_f32 v[244:245], v[244:245], v[8:9] op_sel:[0,1] op_sel_hi:[1,1]
v_pk_mul_f32 v[246:247], v[246:247], v[8:9] op_sel:[0,1] op_sel_hi:[1,1]
v_cvt_pk_bf16_f32 v228, v228, v229
v_cvt_pk_bf16_f32 v229, v230, v231
v_cvt_pk_bf16_f32 v230, v244, v245
v_cvt_pk_bf16_f32 v231, v246, v247
s_nop 1
M v[24:27], a[112:115], v[228:231], v[24:27]
v_pk_mul_f32 v[232:233], v[232:233], v[10:11] op_sel:[0,0] op_sel_hi:[1,0]
v_pk_mul_f32 v[234:235], v[234:235], v[10:11] op_sel:[0,0] op_sel_hi:[1,0]
v_pk_mul_f32 v[248:249], v[248:249], v[10:11] op_sel:[0,0] op_sel_hi:[1,0]
v_pk_mul_f32 v[250:251], v[250:251], v[10:11] op_sel:[0,0] op_sel_hi:[1,0]
v_cvt_pk_bf16_f32 v232, v232, v233
v_cvt_pk_bf16_f32 v233, v234, v235
v_cvt_pk_bf16_f32 v234, v248, v249
v_cvt_pk_bf16_f32 v235, v250, v251
s_nop 1
M v[24:27], a[112:115], v[232:235], v[24:27]
v_pk_mul_f32 v[236:237], v[236:237], v[10:11] op_sel:[0,1] op_sel_hi:[1,1]
v_pk_mul_f32 v[238:239], v[238:239], v[10:11] op_sel:[0,1] op_sel_hi:[1,1]
v_pk_mul_f32 v[252:253], v[252:253], v[10:11] op_sel:[0,1] op_sel_hi:[1,1]
v_pk_mul_f32 v[254:255], v[254:255], v[10:11] op_sel:[0,1] op_sel_hi:[1,1]
v_cvt_pk_bf16_f32 v236, v236, v237
v_cvt_pk_bf16_f32 v237, v238, v239
v_cvt_pk_bf16_f32 v238, v252, v253
v_cvt_pk_bf16_f32 v239, v254, v255
v_accvgpr_read_b32 v176, a64
v_accvgpr_read_b32 v177, a65
v_accvgpr_read_b32 v178, a66
v_accvgpr_read_b32 v179, a67
v_accvgpr_read_b32 v180, a80
v_accvgpr_read_b32 v181, a81
v_accvgpr_read_b32 v182, a82
v_accvgpr_read_b32 v183, a83
M v[24:27], a[112:115], v[236:239], v[24:27]
v_pk_mul_f32 v[176:177], v[176:177], v[8:9] op_sel:[0,0] op_sel_hi:[1,0]
v_pk_mul_f32 v[178:179], v[178:179], v[8:9] op_sel:[0,0] op_sel_hi:[1,0]
v_pk_mul_f32 v[180:181], v[180:181], v[8:9] op_sel:[0,0] op_sel_hi:[1,0]
v_pk_mul_f32 v[182:183], v[182:183], v[8:9] op_sel:[0,0] op_sel_hi:[1,0]
v_cvt_pk_bf16_f32 v176, v176, v177
v_cvt_pk_bf16_f32 v177, v178, v179
v_cvt_pk_bf16_f32 v178, v180, v181
v_cvt_pk_bf16_f32 v179, v182, v183
v_accvgpr_read_b32 v184, a68
v_accvgpr_read_b32 v185, a69
v_accvgpr_read_b32 v186, a70
v_accvgpr_read_b32 v187, a71
v_accvgpr_read_b32 v188, a84
v_accvgpr_read_b32 v189, a85
v_accvgpr_read_b32 v190, a86
v_accvgpr_read_b32 v191, a87
M v[24:27], a[112:115], v[176:179], v[24:27]
v_pk_mul_f32 v[184:185], v[184:185], v[8:9] op_sel:[0,1] op_sel_hi:[1,1]
v_pk_mul_f32 v[186:187], v[186:187], v[8:9] op_sel:[0,1] op_sel_hi:[1,1]
v_pk_mul_f32 v[188:189], v[188:189], v[8:9] op_sel:[0,1] op_sel_hi:[1,1]
v_pk_mul_f32 v[190:191], v[190:191], v[8:9] op_sel:[0,1] op_sel_hi:[1,1]
v_cvt_pk_bf16_f32 v184, v184, v185
v_cvt_pk_bf16_f32 v185, v186, v187
v_cvt_pk_bf16_f32 v186, v188, v189
v_cvt_pk_bf16_f32 v187, v190, v191
v_accvgpr_read_b32 v208, a72
v_accvgpr_read_b32 v209, a73
v_accvgpr_read_b32 v210, a74
v_accvgpr_read_b32 v211, a75
v_accvgpr_read_b32 v212, a88
v_accvgpr_read_b32 v213, a89
v_accvgpr_read_b32 v214, a90
v_accvgpr_read_b32 v215, a91
M v[24:27], a[112:115], v[184:187], v[24:27]
v_pk_mul_f32 v[208:209], v[208:209], v[10:11] op_sel:[0,0] op_sel_hi:[1,0]
v_pk_mul_f32 v[210:211], v[210:211], v[10:11] op_sel:[0,0] op_sel_hi:[1,0]
v_pk_mul_f32 v[212:213], v[212:213], v[10:11] op_sel:[0,0] op_sel_hi:[1,0]
v_pk_mul_f32 v[214:215], v[214:215], v[10:11] op_sel:[0,0] op_sel_hi:[1,0]
v_cvt_pk_bf16_f32 v208, v208, v209
v_cvt_pk_bf16_f32 v209, v210, v211
v_cvt_pk_bf16_f32 v210, v212, v213
v_cvt_pk_bf16_f32 v211, v214, v215
v_accvgpr_read_b32 v216, a76
v_accvgpr_read_b32 v217, a77
v_accvgpr_read_b32 v218, a78
v_accvgpr_read_b32 v219, a79
v_accvgpr_read_b32 v220, a92
v_accvgpr_read_b32 v221, a93
v_accvgpr_read_b32 v222, a94
v_accvgpr_read_b32 v223, a95
M v[24:27], a[112:115], v[208:211], v[24:27]
v_pk_mul_f32 v[216:217], v[216:217], v[10:11] op_sel:[0,1] op_sel_hi:[1,1]
v_pk_mul_f32 v[218:219], v[218:219], v[10:11] op_sel:[0,1] op_sel_hi:[1,1]
v_pk_mul_f32 v[220:221], v[220:221], v[10:11] op_sel:[0,1] op_sel_hi:[1,1]
v_pk_mul_f32 v[222:223], v[222:223], v[10:11] op_sel:[0,1] op_sel_hi:[1,1]
v_cvt_pk_bf16_f32 v216, v216, v217
v_cvt_pk_bf16_f32 v217, v218, v219
v_cvt_pk_bf16_f32 v218, v220, v221
v_cvt_pk_bf16_f32 v219, v222, v223
s_nop 1
M v[24:27], a[112:115], v[216:219], v[24:27]
v_cmp_lt_u32 vcc, 0x3c000000, v12
s_nop 6
v_cmp_class_f32 s[40:41], v24, s64
s_nop 0
s_or_b64 vcc, vcc, s[40:41]
s_cbranch_vccnz Lbad_2
s_lshl_b32 s33, s21, 20
s_lshl_b32 s34, s20, 15
s_add_u32 s33, s33, s34
s_lshl_b32 s34, s23, 13
s_add_u32 s36, s33, s34
s_add_u32 s37, s36, 4096
s_add_u32 s38, s36, 16384
s_add_u32 s39, s36, 20480
buffer_store_dwordx4 v[160:163], v1, s[16:19], s36 offen offset:0 sc1
buffer_store_dwordx4 v[164:167], v1, s[16:19], s36 offen offset:2048 sc1
buffer_store_dwordx4 v[168:171], v1, s[16:19], s37 offen offset:0 sc1
buffer_store_dwordx4 v[172:175], v1, s[16:19], s37 offen offset:2048 sc1
buffer_store_dwordx4 v[192:195], v1, s[16:19], s36 offen offset:1024 sc1
buffer_store_dwordx4 v[196:199], v1, s[16:19], s36 offen offset:3072 sc1
buffer_store_dwordx4 v[200:203], v1, s[16:19], s37 offen offset:1024 sc1
buffer_store_dwordx4 v[204:207], v1, s[16:19], s37 offen offset:3072 sc1
buffer_store_dwordx4 v[224:227], v1, s[16:19], s38 offen offset:0 sc1
buffer_store_dwordx4 v[228:231], v1, s[16:19], s38 offen offset:2048 sc1
buffer_store_dwordx4 v[232:235], v1, s[16:19], s39 offen offset:0 sc1
buffer_store_dwordx4 v[236:239], v1, s[16:19], s39 offen offset:2048 sc1
buffer_store_dwordx4 v[176:179], v1, s[16:19], s38 offen offset:1024 sc1
buffer_store_dwordx4 v[184:187], v1, s[16:19], s38 offen offset:3072 sc1
buffer_store_dwordx4 v[208:211], v1, s[16:19], s39 offen offset:1024 sc1
buffer_store_dwordx4 v[216:219], v1, s[16:19], s39 offen offset:3072 sc1
s_branch Lfd_3
Lbad_2:
s_or_b32 s60, s60, 1
Lfd_3:
s_sub_u32 s30, 7, s21
s_cmp_lg_u32 s30, 0
s_cbranch_scc1 Lk2_b0
s_waitcnt vmcnt(8)
s_waitcnt lgkmcnt(0)
s_barrier
s_and_b32 s3, s2, 3
s_lshl_b32 s3, s3, 2
s_bfe_u32 s27, s2, 0x20003
s_add_u32 s27, s3, s27
s_lshl_b32 s43, s27, 8
s_add_u32 s43, s43, 8400896
v_lshlrev_b32 v15, 2, v0
buffer_load_dword v7, v15, s[52:55], s43 offen sc1
s_lshl_b32 s33, s2, 2
s_add_u32 s33, s33, s22
s_lshl_b32 s34, s33, 11
s_lshl_b32 s33, s33, 13
v_lshlrev_b32 v8, 3, v1
v_lshlrev_b32 v9, 1, v1
buffer_load_dword v5, v8, s[44:47], s33 offen
buffer_load_dword v6, v9, s[48:51], s34 offen
ds_read_b128 a[116:119], v2 offset:32768
ds_read_b128 a[120:123], v2 offset:40960
ds_read_b128 a[124:127], v2 offset:33792
ds_read_b128 a[128:131], v2 offset:41984
ds_read_b128 a[132:135], v2 offset:34816
ds_read_b128 a[136:139], v2 offset:43008
ds_read_b128 a[140:143], v2 offset:35840
ds_read_b128 a[144:147], v2 offset:44032
v_exp_f32 v64, v64
v_exp_f32 v65, v65
v_exp_f32 v66, v66
v_exp_f32 v67, v67
v_exp_f32 v80, v80
v_exp_f32 v81, v81
v_exp_f32 v82, v82
v_exp_f32 v83, v83
v_cvt_pk_bf16_f32 v64, v64, v65
v_cvt_pk_bf16_f32 v65, v66, v67
v_exp_f32 v68, v68
v_exp_f32 v69, v69
v_exp_f32 v70, v70
v_exp_f32 v71, v71
v_cvt_pk_bf16_f32 v66, v80, v81
v_cvt_pk_bf16_f32 v67, v82, v83
v_exp_f32 v84, v84
v_exp_f32 v85, v85
v_exp_f32 v86, v86
v_exp_f32 v87, v87
v_cvt_pk_bf16_f32 v68, v68, v69
v_cvt_pk_bf16_f32 v69, v70, v71
v_exp_f32 v72, v72
v_exp_f32 v73, v73
v_exp_f32 v74, v74
v_exp_f32 v75, v75
v_cvt_pk_bf16_f32 v70, v84, v85
v_cvt_pk_bf16_f32 v71, v86, v87
v_exp_f32 v88, v88
v_exp_f32 v89, v89
v_exp_f32 v90, v90
v_exp_f32 v91, v91
v_cvt_pk_bf16_f32 v72, v72, v73
v_cvt_pk_bf16_f32 v73, v74, v75
v_exp_f32 v76, v76
v_exp_f32 v77, v77
v_exp_f32 v78, v78
v_exp_f32 v79, v79
v_cvt_pk_bf16_f32 v74, v88, v89
v_cvt_pk_bf16_f32 v75, v90, v91
v_exp_f32 v92, v92
v_exp_f32 v93, v93
v_exp_f32 v94, v94
v_exp_f32 v95, v95
v_cvt_pk_bf16_f32 v76, v76, v77
v_cvt_pk_bf16_f32 v77, v78, v79
v_cvt_pk_bf16_f32 v78, v92, v93
v_cvt_pk_bf16_f32 v79, v94, v95
s_waitcnt lgkmcnt(6)
M v[160:163], a[116:119], v[32:35], 0
M v[160:163], a[120:123], v[64:67], v[160:163]
ds_read_b128 a[148:151], v2 offset:36864
ds_read_b128 a[152:155], v2 offset:45056
s_mov_b32 s61, 0
M v[164:167], a[120:123], v[68:71], 0
M v[164:167], a[116:119], v[36:39], v[164:167]
s_bfe_u32 s3, s2, 0x10002
M v[168:171], a[116:119], v[40:43], 0
M v[168:171], a[120:123], v[72:75], v[168:171]
s_lshl_b32 s3, s3, 3
M v[172:175], a[120:123], v[76:79], 0
M v[172:175], a[116:119], v[44:47], v[172:175]
s_waitcnt lgkmcnt(6)
s_lshr_b32 s28, s2, 5
M a[96:99], a[112:115], v[32:35], 0
M a[96:99], a[112:115], v[64:67], a[96:99]
M v[176:179], a[124:127], v[32:35], 0
M v[176:179], a[128:131], v[64:67], v[176:179]
ds_read_b128 a[156:159], v2 offset:37888
ds_read_b128 a[160:163], v2 offset:46080
s_add_u32 s28, s3, s28
M v[180:183], a[128:131], v[68:71], 0
s_lshl_b32 s25, s27, 18
M v[180:183], a[124:127], v[36:39], v[180:183]
M v[184:187], a[124:127], v[40:43], 0
s_lshl_b32 s3, s101, 12
M v[184:187], a[128:131], v[72:75], v[184:187]
M v[188:191], a[128:131], v[76:79], 0
s_add_u32 s25, s25, s3
M v[188:191], a[124:127], v[44:47], v[188:191]
s_waitcnt lgkmcnt(6)
M a[100:103], a[112:115], v[36:39], 0
M a[100:103], a[112:115], v[68:71], a[100:103]
M v[192:195], a[132:135], v[32:35], 0
s_lshl_b32 s26, s28, 7
M v[192:195], a[136:139], v[64:67], v[192:195]
ds_read_b128 a[164:167], v2 offset:38912
ds_read_b128 a[168:171], v2 offset:47104
M v[196:199], a[136:139], v[68:71], 0
s_lshl_b32 s42, s101, 11
M v[196:199], a[132:135], v[36:39], v[196:199]
M v[200:203], a[132:135], v[40:43], 0
s_add_u32 s44, s4, 83886080
s_addc_u32 s45, s5, 0
M v[200:203], a[136:139], v[72:75], v[200:203]
s_mov_b32 s46, 4194304
M v[204:207], a[136:139], v[76:79], 0
M v[204:207], a[132:135], v[44:47], v[204:207]
s_waitcnt lgkmcnt(6)
s_mov_b32 s47, 0x00020000
M a[104:107], a[112:115], v[40:43], 0
M a[104:107], a[112:115], v[72:75], a[104:107]
M v[208:211], a[140:143], v[32:35], 0
M v[208:211], a[144:147], v[64:67], v[208:211]
ds_read_b128 a[172:175], v2 offset:39936
ds_read_b128 a[176:179], v2 offset:48128
s_mov_b32 s50, 2097152
M v[212:215], a[144:147], v[68:71], 0
M v[212:215], a[140:143], v[36:39], v[212:215]
s_mov_b32 s51, 0x00020000
M v[216:219], a[140:143], v[40:43], 0
M v[216:219], a[144:147], v[72:75], v[216:219]
s_lshl_b32 s3, s101, 4
M v[220:223], a[144:147], v[76:79], 0
M v[220:223], a[140:143], v[44:47], v[220:223]
s_waitcnt lgkmcnt(6)
v_lshrrev_b32 v96, 3, v0
M a[108:111], a[112:115], v[44:47], 0
M a[108:111], a[112:115], v[76:79], a[108:111]
M v[224:227], a[148:151], v[32:35], 0
v_and_b32 v97, 6, v96
M v[224:227], a[152:155], v[64:67], v[224:227]
M v[228:231], a[152:155], v[68:71], 0
v_and_b32 v98, 7, v0
M v[228:231], a[148:151], v[36:39], v[228:231]
M v[232:235], a[148:151], v[40:43], 0
v_xor_b32 v97, v97, v98
M v[232:235], a[152:155], v[72:75], v[232:235]
M v[236:239], a[152:155], v[76:79], 0
v_add_u32 v96, s3, v96
M v[236:239], a[148:151], v[44:47], v[236:239]
s_waitcnt lgkmcnt(4)
M v[240:243], a[156:159], v[32:35], 0
v_lshlrev_b32 v96, 11, v96
M v[240:243], a[160:163], v[64:67], v[240:243]
M v[244:247], a[160:163], v[68:71], 0
v_lshl_add_u32 v99, v97, 4, v96
M v[244:247], a[156:159], v[36:39], v[244:247]
v_add_u32 v100, 15360, v99
M v[248:251], a[156:159], v[40:43], 0
M v[248:251], a[160:163], v[72:75], v[248:251]
s_waitcnt vmcnt(2) lgkmcnt(0)
s_barrier
v_cmp_ne_u32 vcc, 1, v7
s_nop 0
s_cbranch_vccnz Lk3_spinb1
Lk3_gotb1:
M v[252:255], a[160:163], v[76:79], 0
s_add_u32 m0, s42, 65536
s_nop 0
buffer_load_dwordx4 v99, s[48:51], s26 offen offset:0 lds
buffer_load_dwordx4 v100, s[48:51], s26 offen offset:1024 lds
M v[252:255], a[156:159], v[44:47], v[252:255]
buffer_load_dwordx4 a[192:195], v1, s[44:47], s25 offen offset:0 sc1
buffer_load_dwordx4 a[196:199], v1, s[44:47], s25 offen offset:1024 sc1
M a[64:67], a[164:167], v[32:35], 0
buffer_load_dwordx4 a[200:203], v1, s[44:47], s25 offen offset:2048 sc1
buffer_load_dwordx4 a[204:207], v1, s[44:47], s25 offen offset:3072 sc1
M a[64:67], a[168:171], v[64:67], a[64:67]
s_add_u32 s25, s25, 16384
s_add_u32 s26, s26, 131072
s_add_u32 m0, s42, 81920
s_nop 0
buffer_load_dwordx4 v99, s[48:51], s26 offen offset:0 lds
M a[68:71], a[168:171], v[68:71], 0
buffer_load_dwordx4 v100, s[48:51], s26 offen offset:1024 lds
buffer_load_dwordx4 a[208:211], v1, s[44:47], s25 offen offset:0 sc1
M a[68:71], a[164:167], v[36:39], a[68:71]
buffer_load_dwordx4 a[212:215], v1, s[44:47], s25 offen offset:1024 sc1
buffer_load_dwordx4 a[216:219], v1, s[44:47], s25 offen offset:2048 sc1
M a[72:75], a[164:167], v[40:43], 0
buffer_load_dwordx4 a[220:223], v1, s[44:47], s25 offen offset:3072 sc1
s_add_u32 s25, s25, 16384
s_add_u32 s26, s26, 131072
M a[72:75], a[168:171], v[72:75], a[72:75]
s_add_u32 m0, s42, 98304
s_nop 0
buffer_load_dwordx4 v99, s[48:51], s26 offen offset:0 lds
buffer_load_dwordx4 v100, s[48:51], s26 offen offset:1024 lds
M a[76:79], a[168:171], v[76:79], 0
buffer_load_dwordx4 a[224:227], v1, s[44:47], s25 offen offset:0 sc1
M a[76:79], a[164:167], v[44:47], a[76:79]
buffer_load_dwordx4 a[228:231], v1, s[44:47], s25 offen offset:1024 sc1
buffer_load_dwordx4 a[232:235], v1, s[44:47], s25 offen offset:2048 sc1
M a[80:83], a[172:175], v[32:35], 0
buffer_load_dwordx4 a[236:239], v1, s[44:47], s25 offen offset:3072 sc1
s_add_u32 s25, s25, 16384
s_add_u32 s26, s26, 131072
M a[80:83], a[176:179], v[64:67], a[80:83]
s_add_u32 m0, s42, 114688
s_nop 0
buffer_load_dwordx4 v99, s[48:51], s26 offen offset:0 lds
buffer_load_dwordx4 v100, s[48:51], s26 offen offset:1024 lds
M a[84:87], a[176:179], v[68:71], 0
buffer_load_dwordx4 a[240:243], v1, s[44:47], s25 offen offset:0 sc1
buffer_load_dwordx4 a[244:247], v1, s[44:47], s25 offen offset:1024 sc1
M a[84:87], a[172:175], v[36:39], a[84:87]
buffer_load_dwordx4 a[248:251], v1, s[44:47], s25 offen offset:2048 sc1
buffer_load_dwordx4 a[252:255], v1, s[44:47], s25 offen offset:3072 sc1
M a[88:91], a[172:175], v[40:43], 0
s_add_u32 s25, s25, 16384
s_add_u32 s26, s26, 131072
s_add_u32 m0, s42, 0
s_nop 0
buffer_load_dwordx4 v99, s[48:51], s26 offen offset:0 lds
M a[88:91], a[176:179], v[72:75], a[88:91]
buffer_load_dwordx4 v100, s[48:51], s26 offen offset:1024 lds
buffer_load_dwordx4 a[128:131], v1, s[44:47], s25 offen offset:0 sc1
M a[92:95], a[176:179], v[76:79], 0
buffer_load_dwordx4 a[132:135], v1, s[44:47], s25 offen offset:1024 sc1
buffer_load_dwordx4 a[136:139], v1, s[44:47], s25 offen offset:2048 sc1
M a[92:95], a[172:175], v[44:47], a[92:95]
buffer_load_dwordx4 a[140:143], v1, s[44:47], s25 offen offset:3072 sc1
s_add_u32 s25, s25, 16384
s_add_u32 s26, s26, 131072
s_branch Lk2_merge
Lk2_b0:
s_waitcnt lgkmcnt(4)
s_add_u32 m0, s29, 98304
M v[96:99], a[116:119], a[180:183], 0
v_exp_f32 v64, v64
M v[96:99], a[120:123], a[184:187], v[96:99]
ds_read_b128 a[148:151], v2 offset:8192
ds_read_b128 a[152:155], v2 offset:9216
M v[96:99], a[124:127], a[188:191], v[96:99]
v_exp_f32 v65, v65
M v[96:99], a[128:131], a[192:195], v[96:99]
buffer_load_dwordx4 v1, s[12:15], s26 offen offset:0 sc1 lds
s_add_u32 s32, s26, 4096
M v[100:103], a[128:131], a[208:211], 0
v_exp_f32 v66, v66
M v[100:103], a[124:127], a[204:207], v[100:103]
v_cvt_pk_bf16_f32 v64, v64, v65
M v[100:103], a[120:123], a[200:203], v[100:103]
v_exp_f32 v67, v67
M v[100:103], a[116:119], a[196:199], v[100:103]
buffer_load_dwordx4 v1, s[12:15], s26 offen offset:1024 sc1 lds
M v[104:107], a[116:119], a[212:215], 0
v_exp_f32 v80, v80
M v[104:107], a[120:123], a[216:219], v[104:107]
ds_read_b128 a[156:159], v2 offset:10240
ds_read_b128 a[160:163], v2 offset:11264
M v[104:107], a[124:127], a[220:223], v[104:107]
v_exp_f32 v81, v81
M v[104:107], a[128:131], a[224:227], v[104:107]
buffer_load_dwordx4 v1, s[12:15], s26 offen offset:2048 sc1 lds
M v[108:111], a[128:131], a[240:243], 0
v_exp_f32 v82, v82
M v[108:111], a[124:127], a[236:239], v[108:111]
v_cvt_pk_bf16_f32 v65, v66, v67
v_cvt_pk_bf16_f32 v66, v80, v81
M v[108:111], a[120:123], a[232:235], v[108:111]
v_exp_f32 v83, v83
M v[108:111], a[116:119], a[228:231], v[108:111]
buffer_load_dwordx4 v1, s[12:15], s26 offen offset:3072 sc1 lds
s_add_u32 m0, s29, 102400
s_waitcnt lgkmcnt(4)
M v[112:115], a[132:135], a[180:183], 0
v_exp_f32 v68, v68
M v[112:115], a[136:139], a[184:187], v[112:115]
ds_read_b128 a[164:167], v2 offset:12288
ds_read_b128 a[168:171], v2 offset:13312
M v[112:115], a[140:143], a[188:191], v[112:115]
v_exp_f32 v69, v69
M v[112:115], a[144:147], a[192:195], v[112:115]
buffer_load_dwordx4 v1, s[12:15], s32 offen offset:0 sc1 lds
M v[116:119], a[144:147], a[208:211], 0
v_exp_f32 v70, v70
M v[116:119], a[140:143], a[204:207], v[116:119]
v_cvt_pk_bf16_f32 v67, v82, v83
v_cvt_pk_bf16_f32 v68, v68, v69
M v[116:119], a[136:139], a[200:203], v[116:119]
v_exp_f32 v71, v71
M v[116:119], a[132:135], a[196:199], v[116:119]
buffer_load_dwordx4 v1, s[12:15], s32 offen offset:1024 sc1 lds
M v[120:123], a[132:135], a[212:215], 0
v_exp_f32 v84, v84
M v[120:123], a[136:139], a[216:219], v[120:123]
ds_read_b128 a[172:175], v2 offset:14336
ds_read_b128 a[176:179], v2 offset:15360
M v[120:123], a[140:143], a[220:223], v[120:123]
v_exp_f32 v85, v85
M v[120:123], a[144:147], a[224:227], v[120:123]
buffer_load_dwordx4 v1, s[12:15], s32 offen offset:2048 sc1 lds
M v[124:127], a[144:147], a[240:243], 0
v_exp_f32 v86, v86
M v[124:127], a[140:143], a[236:239], v[124:127]
v_cvt_pk_bf16_f32 v69, v70, v71
v_cvt_pk_bf16_f32 v70, v84, v85
M v[124:127], a[136:139], a[232:235], v[124:127]
v_exp_f32 v87, v87
M v[124:127], a[132:135], a[228:231], v[124:127]
buffer_load_dwordx4 v1, s[12:15], s32 offen offset:3072 sc1 lds
s_waitcnt lgkmcnt(4)
M v[128:131], a[148:151], a[180:183], 0
v_exp_f32 v72, v72
M v[128:131], a[152:155], a[184:187], v[128:131]
s_add_u32 s26, s26, 32768
s_cmp_eq_u32 s26, s62
s_cselect_b32 s26, s63, s26
s_cselect_b32 s62, -1, s62
M v[128:131], a[156:159], a[188:191], v[128:131]
v_exp_f32 v73, v73
M v[128:131], a[160:163], a[192:195], v[128:131]
v_cvt_pk_bf16_f32 v71, v86, v87
v_cvt_pk_bf16_f32 v72, v72, v73
M v[132:135], a[160:163], a[208:211], 0
v_exp_f32 v74, v74
M v[132:135], a[156:159], a[204:207], v[132:135]
M v[132:135], a[152:155], a[200:203], v[132:135]
v_exp_f32 v75, v75
M v[132:135], a[148:151], a[196:199], v[132:135]
v_cvt_pk_bf16_f32 v73, v74, v75
M v[136:139], a[148:151], a[212:215], 0
v_exp_f32 v88, v88
M v[136:139], a[152:155], a[216:219], v[136:139]
M v[136:139], a[156:159], a[220:223], v[136:139]
v_exp_f32 v89, v89
M v[136:139], a[160:163], a[224:227], v[136:139]
v_cvt_pk_bf16_f32 v74, v88, v89
M v[140:143], a[160:163], a[240:243], 0
v_exp_f32 v90, v90
M v[140:143], a[156:159], a[236:239], v[140:143]
s_waitcnt vmcnt(16) lgkmcnt(0)
s_barrier
ds_read_b128 a[116:119], v2 offset:32768
ds_read_b128 a[120:123], v2 offset:40960
ds_read_b128 a[124:127], v2 offset:33792
ds_read_b128 a[128:131], v2 offset:41984
M v[140:143], a[152:155], a[232:235], v[140:143]
v_exp_f32 v91, v91
M v[140:143], a[148:151], a[228:231], v[140:143]
v_cvt_pk_bf16_f32 v75, v90, v91
M v[144:147], a[164:167], a[180:183], 0
v_exp_f32 v76, v76
M v[144:147], a[168:171], a[184:187], v[144:147]
ds_read_b128 a[132:135], v2 offset:34816
ds_read_b128 a[136:139], v2 offset:43008
M v[144:147], a[172:175], a[188:191], v[144:147]
v_exp_f32 v77, v77
M v[144:147], a[176:179], a[192:195], v[144:147]
v_cvt_pk_bf16_f32 v76, v76, v77
M v[148:151], a[176:179], a[208:211], 0
v_exp_f32 v78, v78
M v[148:151], a[172:175], a[204:207], v[148:151]
M v[148:151], a[168:171], a[200:203], v[148:151]
v_exp_f32 v79, v79
M v[148:151], a[164:167], a[196:199], v[148:151]
v_cvt_pk_bf16_f32 v77, v78, v79
M v[152:155], a[164:167], a[212:215], 0
v_exp_f32 v92, v92
M v[152:155], a[168:171], a[216:219], v[152:155]
ds_read_b128 a[140:143], v2 offset:35840
ds_read_b128 a[144:147], v2 offset:44032
M v[152:155], a[172:175], a[220:223], v[152:155]
v_exp_f32 v93, v93
M v[152:155], a[176:179], a[224:227], v[152:155]
v_cvt_pk_bf16_f32 v78, v92, v93
M v[156:159], a[176:179], a[240:243], 0
v_exp_f32 v94, v94
M v[156:159], a[172:175], a[236:239], v[156:159]
M v[156:159], a[168:171], a[232:235], v[156:159]
v_exp_f32 v95, v95
M v[156:159], a[164:167], a[228:231], v[156:159]
v_cvt_pk_bf16_f32 v79, v94, v95
s_waitcnt lgkmcnt(6)
s_add_u32 m0, s29, 0
M v[160:163], a[116:119], v[32:35], 0
v_exp_f32 v96, v96
M v[160:163], a[120:123], v[64:67], v[160:163]
ds_read_b128 a[148:151], v2 offset:36864
ds_read_b128 a[152:155], v2 offset:45056
M v[164:167], a[120:123], v[68:71], 0
v_exp_f32 v97, v97
M v[164:167], a[116:119], v[36:39], v[164:167]
buffer_load_dwordx4 v1, s[12:15], s25 offen offset:0 sc1 lds
s_add_u32 s32, s25, 4096
M v[168:171], a[116:119], v[40:43], 0
v_exp_f32 v98, v98
M v[168:171], a[120:123], v[72:75], v[168:171]
v_cvt_pk_bf16_f32 v96, v96, v97
M v[172:175], a[120:123], v[76:79], 0
v_exp_f32 v99, v99
M v[172:175], a[116:119], v[44:47], v[172:175]
buffer_load_dwordx4 v1, s[12:15], s25 offen offset:1024 sc1 lds
s_waitcnt lgkmcnt(6)
M a[96:99], a[112:115], v[32:35], 0
M a[96:99], a[112:115], v[64:67], a[96:99]
M v[176:179], a[124:127], v[32:35], 0
v_exp_f32 v112, v112
M v[176:179], a[128:131], v[64:67], v[176:179]
ds_read_b128 a[156:159], v2 offset:37888
ds_read_b128 a[160:163], v2 offset:46080
M v[180:183], a[128:131], v[68:71], 0
v_exp_f32 v113, v113
M v[180:183], a[124:127], v[36:39], v[180:183]
buffer_load_dwordx4 v1, s[12:15], s25 offen offset:2048 sc1 lds
M v[184:187], a[124:127], v[40:43], 0
v_exp_f32 v114, v114
M v[184:187], a[128:131], v[72:75], v[184:187]
v_cvt_pk_bf16_f32 v97, v98, v99
v_cvt_pk_bf16_f32 v98, v112, v113
M v[188:191], a[128:131], v[76:79], 0
v_exp_f32 v115, v115
M v[188:191], a[124:127], v[44:47], v[188:191]
buffer_load_dwordx4 v1, s[12:15], s25 offen offset:3072 sc1 lds
s_add_u32 m0, s29, 4096
s_waitcnt lgkmcnt(6)
M a[100:103], a[112:115], v[36:39], 0
M a[100:103], a[112:115], v[68:71], a[100:103]
M v[192:195], a[132:135], v[32:35], 0
v_exp_f32 v100, v100
M v[192:195], a[136:139], v[64:67], v[192:195]
ds_read_b128 a[164:167], v2 offset:38912
ds_read_b128 a[168:171], v2 offset:47104
M v[196:199], a[136:139], v[68:71], 0
v_exp_f32 v101, v101
M v[196:199], a[132:135], v[36:39], v[196:199]
buffer_load_dwordx4 v1, s[12:15], s32 offen offset:0 sc1 lds
M v[200:203], a[132:135], v[40:43], 0
v_exp_f32 v102, v102
M v[200:203], a[136:139], v[72:75], v[200:203]
v_cvt_pk_bf16_f32 v99, v114, v115
v_cvt_pk_bf16_f32 v100, v100, v101
M v[204:207], a[136:139], v[76:79], 0
v_exp_f32 v103, v103
M v[204:207], a[132:135], v[44:47], v[204:207]
buffer_load_dwordx4 v1, s[12:15], s32 offen offset:1024 sc1 lds
s_waitcnt lgkmcnt(6)
M a[104:107], a[112:115], v[40:43], 0
M a[104:107], a[112:115], v[72:75], a[104:107]
M v[208:211], a[140:143], v[32:35], 0
v_exp_f32 v116, v116
M v[208:211], a[144:147], v[64:67], v[208:211]
ds_read_b128 a[172:175], v2 offset:39936
ds_read_b128 a[176:179], v2 offset:48128
M v[212:215], a[144:147], v[68:71], 0
v_exp_f32 v117, v117
M v[212:215], a[140:143], v[36:39], v[212:215]
buffer_load_dwordx4 v1, s[12:15], s32 offen offset:2048 sc1 lds
M v[216:219], a[140:143], v[40:43], 0
v_exp_f32 v118, v118
M v[216:219], a[144:147], v[72:75], v[216:219]
v_cvt_pk_bf16_f32 v101, v102, v103
v_cvt_pk_bf16_f32 v102, v116, v117
M v[220:223], a[144:147], v[76:79], 0
v_exp_f32 v119, v119
M v[220:223], a[140:143], v[44:47], v[220:223]
buffer_load_dwordx4 v1, s[12:15], s32 offen offset:3072 sc1 lds
s_waitcnt lgkmcnt(6)
M a[108:111], a[112:115], v[44:47], 0
M a[108:111], a[112:115], v[76:79], a[108:111]
M v[224:227], a[148:151], v[32:35], 0
v_exp_f32 v104, v104
M v[224:227], a[152:155], v[64:67], v[224:227]
s_add_u32 s25, s25, 32768
s_cmp_eq_u32 s25, s27
s_cselect_b32 s25, s28, s25
s_cselect_b32 s27, -1, s27
M v[228:231], a[152:155], v[68:71], 0
v_exp_f32 v105, v105
M v[228:231], a[148:151], v[36:39], v[228:231]
v_cvt_pk_bf16_f32 v103, v118, v119
v_cvt_pk_bf16_f32 v104, v104, v105
M v[232:235], a[148:151], v[40:43], 0
v_exp_f32 v106, v106
M v[232:235], a[152:155], v[72:75], v[232:235]
M v[236:239], a[152:155], v[76:79], 0
v_exp_f32 v107, v107
M v[236:239], a[148:151], v[44:47], v[236:239]
v_cvt_pk_bf16_f32 v105, v106, v107
s_waitcnt lgkmcnt(4)
M v[240:243], a[156:159], v[32:35], 0
v_exp_f32 v120, v120
M v[240:243], a[160:163], v[64:67], v[240:243]
M v[244:247], a[160:163], v[68:71], 0
v_exp_f32 v121, v121
M v[244:247], a[156:159], v[36:39], v[244:247]
v_cvt_pk_bf16_f32 v106, v120, v121
M v[248:251], a[156:159], v[40:43], 0
v_exp_f32 v122, v122
M v[248:251], a[160:163], v[72:75], v[248:251]
s_waitcnt vmcnt(16) lgkmcnt(0)
s_barrier
ds_read_b128 a[116:119], v3 offset:0
ds_read_b128 a[120:123], v3 offset:1024
ds_read_b128 a[124:127], v3 offset:2048
ds_read_b128 a[128:131], v3 offset:3072
M v[252:255], a[160:163], v[76:79], 0
v_exp_f32 v123, v123
M v[252:255], a[156:159], v[44:47], v[252:255]
v_cvt_pk_bf16_f32 v107, v122, v123
M a[64:67], a[164:167], v[32:35], 0
v_exp_f32 v108, v108
M a[64:67], a[168:171], v[64:67], a[64:67]
ds_read_b128 a[132:135], v3 offset:4096
ds_read_b128 a[136:139], v3 offset:5120
M a[68:71], a[168:171], v[68:71], 0
v_exp_f32 v109, v109
M a[68:71], a[164:167], v[36:39], a[68:71]
v_cvt_pk_bf16_f32 v108, v108, v109
M a[72:75], a[164:167], v[40:43], 0
v_exp_f32 v110, v110
M a[72:75], a[168:171], v[72:75], a[72:75]
M a[76:79], a[168:171], v[76:79], 0
v_exp_f32 v111, v111
M a[76:79], a[164:167], v[44:47], a[76:79]
v_cvt_pk_bf16_f32 v109, v110, v111
M a[80:83], a[172:175], v[32:35], 0
v_exp_f32 v124, v124
M a[80:83], a[176:179], v[64:67], a[80:83]
ds_read_b128 a[140:143], v3 offset:6144
ds_read_b128 a[144:147], v3 offset:7168
M a[84:87], a[176:179], v[68:71], 0
v_exp_f32 v125, v125
M a[84:87], a[172:175], v[36:39], a[84:87]
v_cvt_pk_bf16_f32 v110, v124, v125
M a[88:91], a[172:175], v[40:43], 0
v_exp_f32 v126, v126
M a[88:91], a[176:179], v[72:75], a[88:91]
M a[92:95], a[176:179], v[76:79], 0
v_exp_f32 v127, v127
M a[92:95], a[172:175], v[44:47], a[92:95]
v_cvt_pk_bf16_f32 v111, v126, v127
s_branch Lk2_l2b
Lk2_l2:
s_waitcnt lgkmcnt(4)
s_add_u32 m0, s29, 98304
M v[96:99], a[116:119], a[180:183], 0
v_exp_f32 v64, v64
M v[96:99], a[120:123], a[184:187], v[96:99]
ds_read_b128 a[148:151], v2 offset:8192
ds_read_b128 a[152:155], v2 offset:9216
M v[96:99], a[124:127], a[188:191], v[96:99]
v_exp_f32 v65, v65
M v[96:99], a[128:131], a[192:195], v[96:99]
buffer_load_dwordx4 v1, s[12:15], s26 offen offset:0 sc1 lds
s_add_u32 s32, s26, 4096
M v[100:103], a[128:131], a[208:211], 0
v_exp_f32 v66, v66
M v[100:103], a[124:127], a[204:207], v[100:103]
v_cvt_pk_bf16_f32 v64, v64, v65
M v[100:103], a[120:123], a[200:203], v[100:103]
v_exp_f32 v67, v67
M v[100:103], a[116:119], a[196:199], v[100:103]
buffer_load_dwordx4 v1, s[12:15], s26 offen offset:1024 sc1 lds
M v[104:107], a[116:119], a[212:215], 0
v_exp_f32 v80, v80
M v[104:107], a[120:123], a[216:219], v[104:107]
ds_read_b128 a[156:159], v2 offset:10240
ds_read_b128 a[160:163], v2 offset:11264
M v[104:107], a[124:127], a[220:223], v[104:107]
v_exp_f32 v81, v81
M v[104:107], a[128:131], a[224:227], v[104:107]
buffer_load_dwordx4 v1, s[12:15], s26 offen offset:2048 sc1 lds
M v[108:111], a[128:131], a[240:243], 0
v_exp_f32 v82, v82
M v[108:111], a[124:127], a[236:239], v[108:111]
v_cvt_pk_bf16_f32 v65, v66, v67
v_cvt_pk_bf16_f32 v66, v80, v81
M v[108:111], a[120:123], a[232:235], v[108:111]
v_exp_f32 v83, v83
M v[108:111], a[116:119], a[228:231], v[108:111]
buffer_load_dwordx4 v1, s[12:15], s26 offen offset:3072 sc1 lds
s_add_u32 m0, s29, 102400
s_waitcnt lgkmcnt(4)
M v[112:115], a[132:135], a[180:183], 0
v_exp_f32 v68, v68
M v[112:115], a[136:139], a[184:187], v[112:115]
ds_read_b128 a[164:167], v2 offset:12288
ds_read_b128 a[168:171], v2 offset:13312
M v[112:115], a[140:143], a[188:191], v[112:115]
v_exp_f32 v69, v69
M v[112:115], a[144:147], a[192:195], v[112:115]
buffer_load_dwordx4 v1, s[12:15], s32 offen offset:0 sc1 lds
M v[116:119], a[144:147], a[208:211], 0
v_exp_f32 v70, v70
M v[116:119], a[140:143], a[204:207], v[116:119]
v_cvt_pk_bf16_f32 v67, v82, v83
v_cvt_pk_bf16_f32 v68, v68, v69
M v[116:119], a[136:139], a[200:203], v[116:119]
v_exp_f32 v71, v71
M v[116:119], a[132:135], a[196:199], v[116:119]
buffer_load_dwordx4 v1, s[12:15], s32 offen offset:1024 sc1 lds
M v[120:123], a[132:135], a[212:215], 0
v_exp_f32 v84, v84
M v[120:123], a[136:139], a[216:219], v[120:123]
ds_read_b128 a[172:175], v2 offset:14336
ds_read_b128 a[176:179], v2 offset:15360
M v[120:123], a[140:143], a[220:223], v[120:123]
v_exp_f32 v85, v85
M v[120:123], a[144:147], a[224:227], v[120:123]
buffer_load_dwordx4 v1, s[12:15], s32 offen offset:2048 sc1 lds
M v[124:127], a[144:147], a[240:243], 0
v_exp_f32 v86, v86
M v[124:127], a[140:143], a[236:239], v[124:127]
v_cvt_pk_bf16_f32 v69, v70, v71
v_cvt_pk_bf16_f32 v70, v84, v85
M v[124:127], a[136:139], a[232:235], v[124:127]
v_exp_f32 v87, v87
M v[124:127], a[132:135], a[228:231], v[124:127]
buffer_load_dwordx4 v1, s[12:15], s32 offen offset:3072 sc1 lds
s_waitcnt lgkmcnt(4)
M v[128:131], a[148:151], a[180:183], 0
v_exp_f32 v72, v72
M v[128:131], a[152:155], a[184:187], v[128:131]
s_add_u32 s26, s26, 32768
s_cmp_eq_u32 s26, s62
s_cselect_b32 s26, s63, s26
s_cselect_b32 s62, -1, s62
M v[128:131], a[156:159], a[188:191], v[128:131]
v_exp_f32 v73, v73
M v[128:131], a[160:163], a[192:195], v[128:131]
v_cvt_pk_bf16_f32 v71, v86, v87
v_cvt_pk_bf16_f32 v72, v72, v73
M v[132:135], a[160:163], a[208:211], 0
v_exp_f32 v74, v74
M v[132:135], a[156:159], a[204:207], v[132:135]
M v[132:135], a[152:155], a[200:203], v[132:135]
v_exp_f32 v75, v75
M v[132:135], a[148:151], a[196:199], v[132:135]
v_cvt_pk_bf16_f32 v73, v74, v75
M v[136:139], a[148:151], a[212:215], 0
v_exp_f32 v88, v88
M v[136:139], a[152:155], a[216:219], v[136:139]
M v[136:139], a[156:159], a[220:223], v[136:139]
v_exp_f32 v89, v89
M v[136:139], a[160:163], a[224:227], v[136:139]
v_cvt_pk_bf16_f32 v74, v88, v89
M v[140:143], a[160:163], a[240:243], 0
v_exp_f32 v90, v90
M v[140:143], a[156:159], a[236:239], v[140:143]
s_waitcnt vmcnt(16) lgkmcnt(0)
s_barrier
ds_read_b128 a[116:119], v2 offset:32768
ds_read_b128 a[120:123], v2 offset:40960
ds_read_b128 a[124:127], v2 offset:33792
ds_read_b128 a[128:131], v2 offset:41984
M v[140:143], a[152:155], a[232:235], v[140:143]
v_exp_f32 v91, v91
M v[140:143], a[148:151], a[228:231], v[140:143]
v_cvt_pk_bf16_f32 v75, v90, v91
M v[144:147], a[164:167], a[180:183], 0
v_exp_f32 v76, v76
M v[144:147], a[168:171], a[184:187], v[144:147]
ds_read_b128 a[132:135], v2 offset:34816
ds_read_b128 a[136:139], v2 offset:43008
M v[144:147], a[172:175], a[188:191], v[144:147]
v_exp_f32 v77, v77
M v[144:147], a[176:179], a[192:195], v[144:147]
v_cvt_pk_bf16_f32 v76, v76, v77
M v[148:151], a[176:179], a[208:211], 0
v_exp_f32 v78, v78
M v[148:151], a[172:175], a[204:207], v[148:151]
M v[148:151], a[168:171], a[200:203], v[148:151]
v_exp_f32 v79, v79
M v[148:151], a[164:167], a[196:199], v[148:151]
v_cvt_pk_bf16_f32 v77, v78, v79
M v[152:155], a[164:167], a[212:215], 0
v_exp_f32 v92, v92
M v[152:155], a[168:171], a[216:219], v[152:155]
ds_read_b128 a[140:143], v2 offset:35840
ds_read_b128 a[144:147], v2 offset:44032
M v[152:155], a[172:175], a[220:223], v[152:155]
v_exp_f32 v93, v93
M v[152:155], a[176:179], a[224:227], v[152:155]
v_cvt_pk_bf16_f32 v78, v92, v93
M v[156:159], a[176:179], a[240:243], 0
v_exp_f32 v94, v94
M v[156:159], a[172:175], a[236:239], v[156:159]
M v[156:159], a[168:171], a[232:235], v[156:159]
v_exp_f32 v95, v95
M v[156:159], a[164:167], a[228:231], v[156:159]
v_cvt_pk_bf16_f32 v79, v94, v95
s_waitcnt lgkmcnt(6)
s_add_u32 m0, s29, 0
M v[160:163], a[116:119], v[32:35], v[160:163]
v_exp_f32 v96, v96
M v[160:163], a[120:123], v[64:67], v[160:163]
ds_read_b128 a[148:151], v2 offset:36864
ds_read_b128 a[152:155], v2 offset:45056
M v[164:167], a[120:123], v[68:71], v[164:167]
v_exp_f32 v97, v97
M v[164:167], a[116:119], v[36:39], v[164:167]
buffer_load_dwordx4 v1, s[12:15], s25 offen offset:0 sc1 lds
s_add_u32 s32, s25, 4096
M v[168:171], a[116:119], v[40:43], v[168:171]
v_exp_f32 v98, v98
M v[168:171], a[120:123], v[72:75], v[168:171]
v_cvt_pk_bf16_f32 v96, v96, v97
M v[172:175], a[120:123], v[76:79], v[172:175]
v_exp_f32 v99, v99
M v[172:175], a[116:119], v[44:47], v[172:175]
buffer_load_dwordx4 v1, s[12:15], s25 offen offset:1024 sc1 lds
s_waitcnt lgkmcnt(6)
M a[96:99], a[112:115], v[32:35], a[96:99]
M a[96:99], a[112:115], v[64:67], a[96:99]
M v[176:179], a[124:127], v[32:35], v[176:179]
v_exp_f32 v112, v112
M v[176:179], a[128:131], v[64:67], v[176:179]
ds_read_b128 a[156:159], v2 offset:37888
ds_read_b128 a[160:163], v2 offset:46080
M v[180:183], a[128:131], v[68:71], v[180:183]
v_exp_f32 v113, v113
M v[180:183], a[124:127], v[36:39], v[180:183]
buffer_load_dwordx4 v1, s[12:15], s25 offen offset:2048 sc1 lds
M v[184:187], a[124:127], v[40:43], v[184:187]
v_exp_f32 v114, v114
M v[184:187], a[128:131], v[72:75], v[184:187]
v_cvt_pk_bf16_f32 v97, v98, v99
v_cvt_pk_bf16_f32 v98, v112, v113
M v[188:191], a[128:131], v[76:79], v[188:191]
v_exp_f32 v115, v115
M v[188:191], a[124:127], v[44:47], v[188:191]
buffer_load_dwordx4 v1, s[12:15], s25 offen offset:3072 sc1 lds
s_add_u32 m0, s29, 4096
s_waitcnt lgkmcnt(6)
M a[100:103], a[112:115], v[36:39], a[100:103]
M a[100:103], a[112:115], v[68:71], a[100:103]
M v[192:195], a[132:135], v[32:35], v[192:195]
v_exp_f32 v100, v100
M v[192:195], a[136:139], v[64:67], v[192:195]
ds_read_b128 a[164:167], v2 offset:38912
ds_read_b128 a[168:171], v2 offset:47104
M v[196:199], a[136:139], v[68:71], v[196:199]
v_exp_f32 v101, v101
M v[196:199], a[132:135], v[36:39], v[196:199]
buffer_load_dwordx4 v1, s[12:15], s32 offen offset:0 sc1 lds
M v[200:203], a[132:135], v[40:43], v[200:203]
v_exp_f32 v102, v102
M v[200:203], a[136:139], v[72:75], v[200:203]
v_cvt_pk_bf16_f32 v99, v114, v115
v_cvt_pk_bf16_f32 v100, v100, v101
M v[204:207], a[136:139], v[76:79], v[204:207]
v_exp_f32 v103, v103
M v[204:207], a[132:135], v[44:47], v[204:207]
buffer_load_dwordx4 v1, s[12:15], s32 offen offset:1024 sc1 lds
s_waitcnt lgkmcnt(6)
M a[104:107], a[112:115], v[40:43], a[104:107]
M a[104:107], a[112:115], v[72:75], a[104:107]
M v[208:211], a[140:143], v[32:35], v[208:211]
v_exp_f32 v116, v116
M v[208:211], a[144:147], v[64:67], v[208:211]
ds_read_b128 a[172:175], v2 offset:39936
ds_read_b128 a[176:179], v2 offset:48128
M v[212:215], a[144:147], v[68:71], v[212:215]
v_exp_f32 v117, v117
M v[212:215], a[140:143], v[36:39], v[212:215]
buffer_load_dwordx4 v1, s[12:15], s32 offen offset:2048 sc1 lds
M v[216:219], a[140:143], v[40:43], v[216:219]
v_exp_f32 v118, v118
M v[216:219], a[144:147], v[72:75], v[216:219]
v_cvt_pk_bf16_f32 v101, v102, v103
v_cvt_pk_bf16_f32 v102, v116, v117
M v[220:223], a[144:147], v[76:79], v[220:223]
v_exp_f32 v119, v119
M v[220:223], a[140:143], v[44:47], v[220:223]
buffer_load_dwordx4 v1, s[12:15], s32 offen offset:3072 sc1 lds
s_waitcnt lgkmcnt(6)
M a[108:111], a[112:115], v[44:47], a[108:111]
M a[108:111], a[112:115], v[76:79], a[108:111]
M v[224:227], a[148:151], v[32:35], v[224:227]
v_exp_f32 v104, v104
M v[224:227], a[152:155], v[64:67], v[224:227]
s_add_u32 s25, s25, 32768
s_cmp_eq_u32 s25, s27
s_cselect_b32 s25, s28, s25
s_cselect_b32 s27, -1, s27
M v[228:231], a[152:155], v[68:71], v[228:231]
v_exp_f32 v105, v105
M v[228:231], a[148:151], v[36:39], v[228:231]
v_cvt_pk_bf16_f32 v103, v118, v119
v_cvt_pk_bf16_f32 v104, v104, v105
M v[232:235], a[148:151], v[40:43], v[232:235]
v_exp_f32 v106, v106
M v[232:235], a[152:155], v[72:75], v[232:235]
M v[236:239], a[152:155], v[76:79], v[236:239]
v_exp_f32 v107, v107
M v[236:239], a[148:151], v[44:47], v[236:239]
v_cvt_pk_bf16_f32 v105, v106, v107
s_waitcnt lgkmcnt(4)
M v[240:243], a[156:159], v[32:35], v[240:243]
v_exp_f32 v120, v120
M v[240:243], a[160:163], v[64:67], v[240:243]
M v[244:247], a[160:163], v[68:71], v[244:247]
v_exp_f32 v121, v121
M v[244:247], a[156:159], v[36:39], v[244:247]
v_cvt_pk_bf16_f32 v106, v120, v121
M v[248:251], a[156:159], v[40:43], v[248:251]
v_exp_f32 v122, v122
M v[248:251], a[160:163], v[72:75], v[248:251]
s_waitcnt vmcnt(16) lgkmcnt(0)
s_barrier
ds_read_b128 a[116:119], v3 offset:0
ds_read_b128 a[120:123], v3 offset:1024
ds_read_b128 a[124:127], v3 offset:2048
ds_read_b128 a[128:131], v3 offset:3072
M v[252:255], a[160:163], v[76:79], v[252:255]
v_exp_f32 v123, v123
M v[252:255], a[156:159], v[44:47], v[252:255]
v_cvt_pk_bf16_f32 v107, v122, v123
M a[64:67], a[164:167], v[32:35], a[64:67]
v_exp_f32 v108, v108
M a[64:67], a[168:171], v[64:67], a[64:67]
ds_read_b128 a[132:135], v3 offset:4096
ds_read_b128 a[136:139], v3 offset:5120
M a[68:71], a[168:171], v[68:71], a[68:71]
v_exp_f32 v109, v109
M a[68:71], a[164:167], v[36:39], a[68:71]
v_cvt_pk_bf16_f32 v108, v108, v109
M a[72:75], a[164:167], v[40:43], a[72:75]
v_exp_f32 v110, v110
M a[72:75], a[168:171], v[72:75], a[72:75]
M a[76:79], a[168:171], v[76:79], a[76:79]
v_exp_f32 v111, v111
M a[76:79], a[164:167], v[44:47], a[76:79]
v_cvt_pk_bf16_f32 v109, v110, v111
M a[80:83], a[172:175], v[32:35], a[80:83]
v_exp_f32 v124, v124
M a[80:83], a[176:179], v[64:67], a[80:83]
ds_read_b128 a[140:143], v3 offset:6144
ds_read_b128 a[144:147], v3 offset:7168
M a[84:87], a[176:179], v[68:71], a[84:87]
v_exp_f32 v125, v125
M a[84:87], a[172:175], v[36:39], a[84:87]
v_cvt_pk_bf16_f32 v110, v124, v125
M a[88:91], a[172:175], v[40:43], a[88:91]
v_exp_f32 v126, v126
M a[88:91], a[176:179], v[72:75], a[88:91]
M a[92:95], a[176:179], v[76:79], a[92:95]
v_exp_f32 v127, v127
M a[92:95], a[172:175], v[44:47], a[92:95]
v_cvt_pk_bf16_f32 v111, v126, v127
Lk2_l2b:
s_waitcnt lgkmcnt(4)
s_add_u32 m0, s29, 32768
M v[32:35], a[116:119], a[180:183], 0
v_exp_f32 v128, v128
M v[32:35], a[120:123], a[184:187], v[32:35]
ds_read_b128 a[148:151], v3 offset:8192
ds_read_b128 a[152:155], v3 offset:9216
M v[32:35], a[124:127], a[188:191], v[32:35]
v_exp_f32 v129, v129
M v[32:35], a[128:131], a[192:195], v[32:35]
buffer_load_dwordx4 v1, s[12:15], s26 offen offset:0 sc1 lds
s_add_u32 s32, s26, 4096
M v[36:39], a[128:131], a[208:211], 0
v_exp_f32 v130, v130
M v[36:39], a[124:127], a[204:207], v[36:39]
v_cvt_pk_bf16_f32 v128, v128, v129
M v[36:39], a[120:123], a[200:203], v[36:39]
v_exp_f32 v131, v131
M v[36:39], a[116:119], a[196:199], v[36:39]
buffer_load_dwordx4 v1, s[12:15], s26 offen offset:1024 sc1 lds
M v[40:43], a[116:119], a[212:215], 0
v_exp_f32 v144, v144
M v[40:43], a[120:123], a[216:219], v[40:43]
ds_read_b128 a[156:159], v3 offset:10240
ds_read_b128 a[160:163], v3 offset:11264
M v[40:43], a[124:127], a[220:223], v[40:43]
v_exp_f32 v145, v145
M v[40:43], a[128:131], a[224:227], v[40:43]
buffer_load_dwordx4 v1, s[12:15], s26 offen offset:2048 sc1 lds
M v[44:47], a[128:131], a[240:243], 0
v_exp_f32 v146, v146
M v[44:47], a[124:127], a[236:239], v[44:47]
v_cvt_pk_bf16_f32 v129, v130, v131
v_cvt_pk_bf16_f32 v130, v144, v145
M v[44:47], a[120:123], a[232:235], v[44:47]
v_exp_f32 v147, v147
M v[44:47], a[116:119], a[228:231], v[44:47]
buffer_load_dwordx4 v1, s[12:15], s26 offen offset:3072 sc1 lds
s_add_u32 m0, s29, 36864
s_waitcnt lgkmcnt(4)
M v[48:51], a[132:135], a[180:183], 0
v_exp_f32 v132, v132
M v[48:51], a[136:139], a[184:187], v[48:51]
ds_read_b128 a[164:167], v3 offset:12288
ds_read_b128 a[168:171], v3 offset:13312
M v[48:51], a[140:143], a[188:191], v[48:51]
v_exp_f32 v133, v133
M v[48:51], a[144:147], a[192:195], v[48:51]
buffer_load_dwordx4 v1, s[12:15], s32 offen offset:0 sc1 lds
M v[52:55], a[144:147], a[208:211], 0
v_exp_f32 v134, v134
M v[52:55], a[140:143], a[204:207], v[52:55]
v_cvt_pk_bf16_f32 v131, v146, v147
v_cvt_pk_bf16_f32 v132, v132, v133
M v[52:55], a[136:139], a[200:203], v[52:55]
v_exp_f32 v135, v135
M v[52:55], a[132:135], a[196:199], v[52:55]
buffer_load_dwordx4 v1, s[12:15], s32 offen offset:1024 sc1 lds
M v[56:59], a[132:135], a[212:215], 0
v_exp_f32 v148, v148
M v[56:59], a[136:139], a[216:219], v[56:59]
ds_read_b128 a[172:175], v3 offset:14336
ds_read_b128 a[176:179], v3 offset:15360
M v[56:59], a[140:143], a[220:223], v[56:59]
v_exp_f32 v149, v149
M v[56:59], a[144:147], a[224:227], v[56:59]
buffer_load_dwordx4 v1, s[12:15], s32 offen offset:2048 sc1 lds
M v[60:63], a[144:147], a[240:243], 0
v_exp_f32 v150, v150
M v[60:63], a[140:143], a[236:239], v[60:63]
v_cvt_pk_bf16_f32 v133, v134, v135
v_cvt_pk_bf16_f32 v134, v148, v149
M v[60:63], a[136:139], a[232:235], v[60:63]
v_exp_f32 v151, v151
M v[60:63], a[132:135], a[228:231], v[60:63]
buffer_load_dwordx4 v1, s[12:15], s32 offen offset:3072 sc1 lds
s_waitcnt lgkmcnt(4)
M v[64:67], a[148:151], a[180:183], 0
v_exp_f32 v136, v136
M v[64:67], a[152:155], a[184:187], v[64:67]
s_add_u32 s26, s26, 32768
s_cmp_eq_u32 s26, s62
s_cselect_b32 s26, s63, s26
s_cselect_b32 s62, -1, s62
M v[64:67], a[156:159], a[188:191], v[64:67]
v_exp_f32 v137, v137
M v[64:67], a[160:163], a[192:195], v[64:67]
v_cvt_pk_bf16_f32 v135, v150, v151
v_cvt_pk_bf16_f32 v136, v136, v137
M v[68:71], a[160:163], a[208:211], 0
v_exp_f32 v138, v138
M v[68:71], a[156:159], a[204:207], v[68:71]
M v[68:71], a[152:155], a[200:203], v[68:71]
v_exp_f32 v139, v139
M v[68:71], a[148:151], a[196:199], v[68:71]
v_cvt_pk_bf16_f32 v137, v138, v139
M v[72:75], a[148:151], a[212:215], 0
v_exp_f32 v152, v152
M v[72:75], a[152:155], a[216:219], v[72:75]
M v[72:75], a[156:159], a[220:223], v[72:75]
v_exp_f32 v153, v153
M v[72:75], a[160:163], a[224:227], v[72:75]
v_cvt_pk_bf16_f32 v138, v152, v153
M v[76:79], a[160:163], a[240:243], 0
v_exp_f32 v154, v154
M v[76:79], a[156:159], a[236:239], v[76:79]
s_waitcnt vmcnt(16) lgkmcnt(0)
s_barrier
ds_read_b128 a[116:119], v3 offset:32768
ds_read_b128 a[120:123], v3 offset:40960
ds_read_b128 a[124:127], v3 offset:33792
ds_read_b128 a[128:131], v3 offset:41984
M v[76:79], a[152:155], a[232:235], v[76:79]
v_exp_f32 v155, v155
M v[76:79], a[148:151], a[228:231], v[76:79]
v_cvt_pk_bf16_f32 v139, v154, v155
M v[80:83], a[164:167], a[180:183], 0
v_exp_f32 v140, v140
M v[80:83], a[168:171], a[184:187], v[80:83]
ds_read_b128 a[132:135], v3 offset:34816
ds_read_b128 a[136:139], v3 offset:43008
M v[80:83], a[172:175], a[188:191], v[80:83]
v_exp_f32 v141, v141
M v[80:83], a[176:179], a[192:195], v[80:83]
v_cvt_pk_bf16_f32 v140, v140, v141
M v[84:87], a[176:179], a[208:211], 0
v_exp_f32 v142, v142
M v[84:87], a[172:175], a[204:207], v[84:87]
M v[84:87], a[168:171], a[200:203], v[84:87]
v_exp_f32 v143, v143
M v[84:87], a[164:167], a[196:199], v[84:87]
v_cvt_pk_bf16_f32 v141, v142, v143
M v[88:91], a[164:167], a[212:215], 0
v_exp_f32 v156, v156
M v[88:91], a[168:171], a[216:219], v[88:91]
ds_read_b128 a[140:143], v3 offset:35840
ds_read_b128 a[144:147], v3 offset:44032
M v[88:91], a[172:175], a[220:223], v[88:91]
v_exp_f32 v157, v157
M v[88:91], a[176:179], a[224:227], v[88:91]
v_cvt_pk_bf16_f32 v142, v156, v157
M v[92:95], a[176:179], a[240:243], 0
v_exp_f32 v158, v158
M v[92:95], a[172:175], a[236:239], v[92:95]
M v[92:95], a[168:171], a[232:235], v[92:95]
v_exp_f32 v159, v159
M v[92:95], a[164:167], a[228:231], v[92:95]
v_cvt_pk_bf16_f32 v143, v158, v159
s_waitcnt lgkmcnt(6)
s_add_u32 m0, s29, 65536
M v[160:163], a[116:119], v[96:99], v[160:163]
v_exp_f32 v32, v32
M v[160:163], a[120:123], v[128:131], v[160:163]
ds_read_b128 a[148:151], v3 offset:36864
ds_read_b128 a[152:155], v3 offset:45056
M v[164:167], a[120:123], v[132:135], v[164:167]
v_exp_f32 v33, v33
M v[164:167], a[116:119], v[100:103], v[164:167]
buffer_load_dwordx4 v1, s[12:15], s25 offen offset:0 sc1 lds
s_add_u32 s32, s25, 4096
M v[168:171], a[116:119], v[104:107], v[168:171]
v_exp_f32 v34, v34
M v[168:171], a[120:123], v[136:139], v[168:171]
v_cvt_pk_bf16_f32 v32, v32, v33
M v[172:175], a[120:123], v[140:143], v[172:175]
v_exp_f32 v35, v35
M v[172:175], a[116:119], v[108:111], v[172:175]
buffer_load_dwordx4 v1, s[12:15], s25 offen offset:1024 sc1 lds
s_waitcnt lgkmcnt(6)
M a[96:99], a[112:115], v[96:99], a[96:99]
M a[96:99], a[112:115], v[128:131], a[96:99]
M v[176:179], a[124:127], v[96:99], v[176:179]
v_exp_f32 v48, v48
M v[176:179], a[128:131], v[128:131], v[176:179]
ds_read_b128 a[156:159], v3 offset:37888
ds_read_b128 a[160:163], v3 offset:46080
M v[180:183], a[128:131], v[132:135], v[180:183]
v_exp_f32 v49, v49
M v[180:183], a[124:127], v[100:103], v[180:183]
buffer_load_dwordx4 v1, s[12:15], s25 offen offset:2048 sc1 lds
M v[184:187], a[124:127], v[104:107], v[184:187]
v_exp_f32 v50, v50
M v[184:187], a[128:131], v[136:139], v[184:187]
v_cvt_pk_bf16_f32 v33, v34, v35
v_cvt_pk_bf16_f32 v34, v48, v49
M v[188:191], a[128:131], v[140:143], v[188:191]
v_exp_f32 v51, v51
M v[188:191], a[124:127], v[108:111], v[188:191]
buffer_load_dwordx4 v1, s[12:15], s25 offen offset:3072 sc1 lds
s_add_u32 m0, s29, 69632
s_waitcnt lgkmcnt(6)
M a[100:103], a[112:115], v[100:103], a[100:103]
M a[100:103], a[112:115], v[132:135], a[100:103]
M v[192:195], a[132:135], v[96:99], v[192:195]
v_exp_f32 v36, v36
M v[192:195], a[136:139], v[128:131], v[192:195]
ds_read_b128 a[164:167], v3 offset:38912
ds_read_b128 a[168:171], v3 offset:47104
M v[196:199], a[136:139], v[132:135], v[196:199]
v_exp_f32 v37, v37
M v[196:199], a[132:135], v[100:103], v[196:199]
buffer_load_dwordx4 v1, s[12:15], s32 offen offset:0 sc1 lds
M v[200:203], a[132:135], v[104:107], v[200:203]
v_exp_f32 v38, v38
M v[200:203], a[136:139], v[136:139], v[200:203]
v_cvt_pk_bf16_f32 v35, v50, v51
v_cvt_pk_bf16_f32 v36, v36, v37
M v[204:207], a[136:139], v[140:143], v[204:207]
v_exp_f32 v39, v39
M v[204:207], a[132:135], v[108:111], v[204:207]
buffer_load_dwordx4 v1, s[12:15], s32 offen offset:1024 sc1 lds
s_waitcnt lgkmcnt(6)
M a[104:107], a[112:115], v[104:107], a[104:107]
M a[104:107], a[112:115], v[136:139], a[104:107]
M v[208:211], a[140:143], v[96:99], v[208:211]
v_exp_f32 v52, v52
M v[208:211], a[144:147], v[128:131], v[208:211]
ds_read_b128 a[172:175], v3 offset:39936
ds_read_b128 a[176:179], v3 offset:48128
M v[212:215], a[144:147], v[132:135], v[212:215]
v_exp_f32 v53, v53
M v[212:215], a[140:143], v[100:103], v[212:215]
buffer_load_dwordx4 v1, s[12:15], s32 offen offset:2048 sc1 lds
M v[216:219], a[140:143], v[104:107], v[216:219]
v_exp_f32 v54, v54
M v[216:219], a[144:147], v[136:139], v[216:219]
v_cvt_pk_bf16_f32 v37, v38, v39
v_cvt_pk_bf16_f32 v38, v52, v53
M v[220:223], a[144:147], v[140:143], v[220:223]
v_exp_f32 v55, v55
M v[220:223], a[140:143], v[108:111], v[220:223]
buffer_load_dwordx4 v1, s[12:15], s32 offen offset:3072 sc1 lds
s_waitcnt lgkmcnt(6)
M a[108:111], a[112:115], v[108:111], a[108:111]
M a[108:111], a[112:115], v[140:143], a[108:111]
M v[224:227], a[148:151], v[96:99], v[224:227]
v_exp_f32 v40, v40
M v[224:227], a[152:155], v[128:131], v[224:227]
s_add_u32 s25, s25, 32768
s_cmp_eq_u32 s25, s27
s_cselect_b32 s25, s28, s25
s_cselect_b32 s27, -1, s27
M v[228:231], a[152:155], v[132:135], v[228:231]
v_exp_f32 v41, v41
M v[228:231], a[148:151], v[100:103], v[228:231]
v_cvt_pk_bf16_f32 v39, v54, v55
v_cvt_pk_bf16_f32 v40, v40, v41
M v[232:235], a[148:151], v[104:107], v[232:235]
v_exp_f32 v42, v42
M v[232:235], a[152:155], v[136:139], v[232:235]
M v[236:239], a[152:155], v[140:143], v[236:239]
v_exp_f32 v43, v43
M v[236:239], a[148:151], v[108:111], v[236:239]
v_cvt_pk_bf16_f32 v41, v42, v43
s_waitcnt lgkmcnt(4)
M v[240:243], a[156:159], v[96:99], v[240:243]
v_exp_f32 v56, v56
M v[240:243], a[160:163], v[128:131], v[240:243]
M v[244:247], a[160:163], v[132:135], v[244:247]
v_exp_f32 v57, v57
M v[244:247], a[156:159], v[100:103], v[244:247]
v_cvt_pk_bf16_f32 v42, v56, v57
M v[248:251], a[156:159], v[104:107], v[248:251]
v_exp_f32 v58, v58
M v[248:251], a[160:163], v[136:139], v[248:251]
s_waitcnt vmcnt(16) lgkmcnt(0)
s_barrier
ds_read_b128 a[116:119], v2 offset:0
ds_read_b128 a[120:123], v2 offset:1024
ds_read_b128 a[124:127], v2 offset:2048
ds_read_b128 a[128:131], v2 offset:3072
M v[252:255], a[160:163], v[140:143], v[252:255]
v_exp_f32 v59, v59
M v[252:255], a[156:159], v[108:111], v[252:255]
v_cvt_pk_bf16_f32 v43, v58, v59
M a[64:67], a[164:167], v[96:99], a[64:67]
v_exp_f32 v44, v44
M a[64:67], a[168:171], v[128:131], a[64:67]
ds_read_b128 a[132:135], v2 offset:4096
ds_read_b128 a[136:139], v2 offset:5120
M a[68:71], a[168:171], v[132:135], a[68:71]
v_exp_f32 v45, v45
M a[68:71], a[164:167], v[100:103], a[68:71]
v_cvt_pk_bf16_f32 v44, v44, v45
M a[72:75], a[164:167], v[104:107], a[72:75]
v_exp_f32 v46, v46
M a[72:75], a[168:171], v[136:139], a[72:75]
M a[76:79], a[168:171], v[140:143], a[76:79]
v_exp_f32 v47, v47
M a[76:79], a[164:167], v[108:111], a[76:79]
v_cvt_pk_bf16_f32 v45, v46, v47
M a[80:83], a[172:175], v[96:99], a[80:83]
v_exp_f32 v60, v60
M a[80:83], a[176:179], v[128:131], a[80:83]
ds_read_b128 a[140:143], v2 offset:6144
ds_read_b128 a[144:147], v2 offset:7168
M a[84:87], a[176:179], v[132:135], a[84:87]
v_exp_f32 v61, v61
M a[84:87], a[172:175], v[100:103], a[84:87]
v_cvt_pk_bf16_f32 v46, v60, v61
M a[88:91], a[172:175], v[104:107], a[88:91]
v_exp_f32 v62, v62
M a[88:91], a[176:179], v[136:139], a[88:91]
M a[92:95], a[176:179], v[140:143], a[92:95]
v_exp_f32 v63, v63
M a[92:95], a[172:175], v[108:111], a[92:95]
v_cvt_pk_bf16_f32 v47, v62, v63
s_sub_u32 s30, s30, 1
s_cmp_lg_u32 s30, 0
s_cbranch_scc1 Lk2_l2
s_branch Lk2_fin
Lk2_g1:
s_mov_b32 s30, 7
Lk2_l3:
s_waitcnt lgkmcnt(4)
s_add_u32 m0, s29, 98304
M v[96:99], a[116:119], a[0:3], 0
v_exp_f32 v64, v64
M v[96:99], a[120:123], a[4:7], v[96:99]
ds_read_b128 a[148:151], v2 offset:8192
ds_read_b128 a[152:155], v2 offset:9216
M v[96:99], a[124:127], a[8:11], v[96:99]
v_exp_f32 v65, v65
M v[96:99], a[128:131], a[12:15], v[96:99]
buffer_load_dwordx4 v1, s[12:15], s26 offen offset:0 sc1 lds
s_add_u32 s32, s26, 4096
M v[100:103], a[128:131], a[28:31], 0
v_exp_f32 v66, v66
M v[100:103], a[124:127], a[24:27], v[100:103]
v_cvt_pk_bf16_f32 v64, v64, v65
M v[100:103], a[120:123], a[20:23], v[100:103]
v_exp_f32 v67, v67
M v[100:103], a[116:119], a[16:19], v[100:103]
buffer_load_dwordx4 v1, s[12:15], s26 offen offset:1024 sc1 lds
M v[104:107], a[116:119], a[32:35], 0
v_exp_f32 v80, v80
M v[104:107], a[120:123], a[36:39], v[104:107]
ds_read_b128 a[156:159], v2 offset:10240
ds_read_b128 a[160:163], v2 offset:11264
M v[104:107], a[124:127], a[40:43], v[104:107]
v_exp_f32 v81, v81
M v[104:107], a[128:131], a[44:47], v[104:107]
buffer_load_dwordx4 v1, s[12:15], s26 offen offset:2048 sc1 lds
M v[108:111], a[128:131], a[60:63], 0
v_exp_f32 v82, v82
M v[108:111], a[124:127], a[56:59], v[108:111]
v_cvt_pk_bf16_f32 v65, v66, v67
v_cvt_pk_bf16_f32 v66, v80, v81
M v[108:111], a[120:123], a[52:55], v[108:111]
v_exp_f32 v83, v83
M v[108:111], a[116:119], a[48:51], v[108:111]
buffer_load_dwordx4 v1, s[12:15], s26 offen offset:3072 sc1 lds
s_add_u32 m0, s29, 102400
s_waitcnt lgkmcnt(4)
M v[112:115], a[132:135], a[0:3], 0
v_exp_f32 v68, v68
M v[112:115], a[136:139], a[4:7], v[112:115]
ds_read_b128 a[164:167], v2 offset:12288
ds_read_b128 a[168:171], v2 offset:13312
M v[112:115], a[140:143], a[8:11], v[112:115]
v_exp_f32 v69, v69
M v[112:115], a[144:147], a[12:15], v[112:115]
buffer_load_dwordx4 v1, s[12:15], s32 offen offset:0 sc1 lds
M v[116:119], a[144:147], a[28:31], 0
v_exp_f32 v70, v70
M v[116:119], a[140:143], a[24:27], v[116:119]
v_cvt_pk_bf16_f32 v67, v82, v83
v_cvt_pk_bf16_f32 v68, v68, v69
M v[116:119], a[136:139], a[20:23], v[116:119]
v_exp_f32 v71, v71
M v[116:119], a[132:135], a[16:19], v[116:119]
buffer_load_dwordx4 v1, s[12:15], s32 offen offset:1024 sc1 lds
M v[120:123], a[132:135], a[32:35], 0
v_exp_f32 v84, v84
M v[120:123], a[136:139], a[36:39], v[120:123]
ds_read_b128 a[172:175], v2 offset:14336
ds_read_b128 a[176:179], v2 offset:15360
M v[120:123], a[140:143], a[40:43], v[120:123]
v_exp_f32 v85, v85
M v[120:123], a[144:147], a[44:47], v[120:123]
buffer_load_dwordx4 v1, s[12:15], s32 offen offset:2048 sc1 lds
M v[124:127], a[144:147], a[60:63], 0
v_exp_f32 v86, v86
M v[124:127], a[140:143], a[56:59], v[124:127]
v_cvt_pk_bf16_f32 v69, v70, v71
v_cvt_pk_bf16_f32 v70, v84, v85
M v[124:127], a[136:139], a[52:55], v[124:127]
v_exp_f32 v87, v87
M v[124:127], a[132:135], a[48:51], v[124:127]
buffer_load_dwordx4 v1, s[12:15], s32 offen offset:3072 sc1 lds
s_waitcnt lgkmcnt(4)
M v[128:131], a[148:151], a[0:3], 0
v_exp_f32 v72, v72
M v[128:131], a[152:155], a[4:7], v[128:131]
s_add_u32 s26, s26, 32768
s_cmp_eq_u32 s26, s62
s_cselect_b32 s26, s63, s26
s_cselect_b32 s62, -1, s62
M v[128:131], a[156:159], a[8:11], v[128:131]
v_exp_f32 v73, v73
M v[128:131], a[160:163], a[12:15], v[128:131]
v_cvt_pk_bf16_f32 v71, v86, v87
v_cvt_pk_bf16_f32 v72, v72, v73
M v[132:135], a[160:163], a[28:31], 0
v_exp_f32 v74, v74
M v[132:135], a[156:159], a[24:27], v[132:135]
M v[132:135], a[152:155], a[20:23], v[132:135]
v_exp_f32 v75, v75
M v[132:135], a[148:151], a[16:19], v[132:135]
v_cvt_pk_bf16_f32 v73, v74, v75
M v[136:139], a[148:151], a[32:35], 0
v_exp_f32 v88, v88
M v[136:139], a[152:155], a[36:39], v[136:139]
M v[136:139], a[156:159], a[40:43], v[136:139]
v_exp_f32 v89, v89
M v[136:139], a[160:163], a[44:47], v[136:139]
v_cvt_pk_bf16_f32 v74, v88, v89
M v[140:143], a[160:163], a[60:63], 0
v_exp_f32 v90, v90
M v[140:143], a[156:159], a[56:59], v[140:143]
s_waitcnt vmcnt(16) lgkmcnt(0)
s_barrier
ds_read_b128 a[116:119], v2 offset:32768
ds_read_b128 a[120:123], v2 offset:40960
ds_read_b128 a[124:127], v2 offset:33792
ds_read_b128 a[128:131], v2 offset:41984
M v[140:143], a[152:155], a[52:55], v[140:143]
v_exp_f32 v91, v91
M v[140:143], a[148:151], a[48:51], v[140:143]
v_cvt_pk_bf16_f32 v75, v90, v91
M v[144:147], a[164:167], a[0:3], 0
v_exp_f32 v76, v76
M v[144:147], a[168:171], a[4:7], v[144:147]
ds_read_b128 a[132:135], v2 offset:34816
ds_read_b128 a[136:139], v2 offset:43008
M v[144:147], a[172:175], a[8:11], v[144:147]
v_exp_f32 v77, v77
M v[144:147], a[176:179], a[12:15], v[144:147]
v_cvt_pk_bf16_f32 v76, v76, v77
M v[148:151], a[176:179], a[28:31], 0
v_exp_f32 v78, v78
M v[148:151], a[172:175], a[24:27], v[148:151]
M v[148:151], a[168:171], a[20:23], v[148:151]
v_exp_f32 v79, v79
M v[148:151], a[164:167], a[16:19], v[148:151]
v_cvt_pk_bf16_f32 v77, v78, v79
M v[152:155], a[164:167], a[32:35], 0
v_exp_f32 v92, v92
M v[152:155], a[168:171], a[36:39], v[152:155]
ds_read_b128 a[140:143], v2 offset:35840
ds_read_b128 a[144:147], v2 offset:44032
M v[152:155], a[172:175], a[40:43], v[152:155]
v_exp_f32 v93, v93
M v[152:155], a[176:179], a[44:47], v[152:155]
v_cvt_pk_bf16_f32 v78, v92, v93
M v[156:159], a[176:179], a[60:63], 0
v_exp_f32 v94, v94
M v[156:159], a[172:175], a[56:59], v[156:159]
M v[156:159], a[168:171], a[52:55], v[156:159]
v_exp_f32 v95, v95
M v[156:159], a[164:167], a[48:51], v[156:159]
v_cvt_pk_bf16_f32 v79, v94, v95
s_waitcnt lgkmcnt(6)
s_add_u32 m0, s29, 0
M v[160:163], a[116:119], v[32:35], v[160:163]
v_exp_f32 v96, v96
M v[160:163], a[120:123], v[64:67], v[160:163]
ds_read_b128 a[148:151], v2 offset:36864
ds_read_b128 a[152:155], v2 offset:45056
M v[164:167], a[120:123], v[68:71], v[164:167]
v_exp_f32 v97, v97
M v[164:167], a[116:119], v[36:39], v[164:167]
buffer_load_dwordx4 v1, s[12:15], s25 offen offset:0 sc1 lds
s_add_u32 s32, s25, 4096
M v[168:171], a[116:119], v[40:43], v[168:171]
v_exp_f32 v98, v98
M v[168:171], a[120:123], v[72:75], v[168:171]
v_cvt_pk_bf16_f32 v96, v96, v97
M v[172:175], a[120:123], v[76:79], v[172:175]
v_exp_f32 v99, v99
M v[172:175], a[116:119], v[44:47], v[172:175]
buffer_load_dwordx4 v1, s[12:15], s25 offen offset:1024 sc1 lds
s_waitcnt lgkmcnt(6)
M a[96:99], a[112:115], v[32:35], a[96:99]
M a[96:99], a[112:115], v[64:67], a[96:99]
M v[176:179], a[124:127], v[32:35], v[176:179]
v_exp_f32 v112, v112
M v[176:179], a[128:131], v[64:67], v[176:179]
ds_read_b128 a[156:159], v2 offset:37888
ds_read_b128 a[160:163], v2 offset:46080
M v[180:183], a[128:131], v[68:71], v[180:183]
v_exp_f32 v113, v113
M v[180:183], a[124:127], v[36:39], v[180:183]
buffer_load_dwordx4 v1, s[12:15], s25 offen offset:2048 sc1 lds
M v[184:187], a[124:127], v[40:43], v[184:187]
v_exp_f32 v114, v114
M v[184:187], a[128:131], v[72:75], v[184:187]
v_cvt_pk_bf16_f32 v97, v98, v99
v_cvt_pk_bf16_f32 v98, v112, v113
M v[188:191], a[128:131], v[76:79], v[188:191]
v_exp_f32 v115, v115
M v[188:191], a[124:127], v[44:47], v[188:191]
buffer_load_dwordx4 v1, s[12:15], s25 offen offset:3072 sc1 lds
s_add_u32 m0, s29, 4096
s_waitcnt lgkmcnt(6)
M a[100:103], a[112:115], v[36:39], a[100:103]
M a[100:103], a[112:115], v[68:71], a[100:103]
M v[192:195], a[132:135], v[32:35], v[192:195]
v_exp_f32 v100, v100
M v[192:195], a[136:139], v[64:67], v[192:195]
ds_read_b128 a[164:167], v2 offset:38912
ds_read_b128 a[168:171], v2 offset:47104
M v[196:199], a[136:139], v[68:71], v[196:199]
v_exp_f32 v101, v101
M v[196:199], a[132:135], v[36:39], v[196:199]
buffer_load_dwordx4 v1, s[12:15], s32 offen offset:0 sc1 lds
M v[200:203], a[132:135], v[40:43], v[200:203]
v_exp_f32 v102, v102
M v[200:203], a[136:139], v[72:75], v[200:203]
v_cvt_pk_bf16_f32 v99, v114, v115
v_cvt_pk_bf16_f32 v100, v100, v101
M v[204:207], a[136:139], v[76:79], v[204:207]
v_exp_f32 v103, v103
M v[204:207], a[132:135], v[44:47], v[204:207]
buffer_load_dwordx4 v1, s[12:15], s32 offen offset:1024 sc1 lds
s_waitcnt lgkmcnt(6)
M a[104:107], a[112:115], v[40:43], a[104:107]
M a[104:107], a[112:115], v[72:75], a[104:107]
M v[208:211], a[140:143], v[32:35], v[208:211]
v_exp_f32 v116, v116
M v[208:211], a[144:147], v[64:67], v[208:211]
ds_read_b128 a[172:175], v2 offset:39936
ds_read_b128 a[176:179], v2 offset:48128
M v[212:215], a[144:147], v[68:71], v[212:215]
v_exp_f32 v117, v117
M v[212:215], a[140:143], v[36:39], v[212:215]
buffer_load_dwordx4 v1, s[12:15], s32 offen offset:2048 sc1 lds
M v[216:219], a[140:143], v[40:43], v[216:219]
v_exp_f32 v118, v118
M v[216:219], a[144:147], v[72:75], v[216:219]
v_cvt_pk_bf16_f32 v101, v102, v103
v_cvt_pk_bf16_f32 v102, v116, v117
M v[220:223], a[144:147], v[76:79], v[220:223]
v_exp_f32 v119, v119
M v[220:223], a[140:143], v[44:47], v[220:223]
buffer_load_dwordx4 v1, s[12:15], s32 offen offset:3072 sc1 lds
s_waitcnt lgkmcnt(6)
M a[108:111], a[112:115], v[44:47], a[108:111]
M a[108:111], a[112:115], v[76:79], a[108:111]
M v[224:227], a[148:151], v[32:35], v[224:227]
v_exp_f32 v104, v104
M v[224:227], a[152:155], v[64:67], v[224:227]
s_add_u32 s25, s25, 32768
s_cmp_eq_u32 s25, s27
s_cselect_b32 s25, s28, s25
s_cselect_b32 s27, -1, s27
M v[228:231], a[152:155], v[68:71], v[228:231]
v_exp_f32 v105, v105
M v[228:231], a[148:151], v[36:39], v[228:231]
v_cvt_pk_bf16_f32 v103, v118, v119
v_cvt_pk_bf16_f32 v104, v104, v105
M v[232:235], a[148:151], v[40:43], v[232:235]
v_exp_f32 v106, v106
M v[232:235], a[152:155], v[72:75], v[232:235]
M v[236:239], a[152:155], v[76:79], v[236:239]
v_exp_f32 v107, v107
M v[236:239], a[148:151], v[44:47], v[236:239]
v_cvt_pk_bf16_f32 v105, v106, v107
s_waitcnt lgkmcnt(4)
M v[240:243], a[156:159], v[32:35], v[240:243]
v_exp_f32 v120, v120
M v[240:243], a[160:163], v[64:67], v[240:243]
M v[244:247], a[160:163], v[68:71], v[244:247]
v_exp_f32 v121, v121
M v[244:247], a[156:159], v[36:39], v[244:247]
v_cvt_pk_bf16_f32 v106, v120, v121
M v[248:251], a[156:159], v[40:43], v[248:251]
v_exp_f32 v122, v122
M v[248:251], a[160:163], v[72:75], v[248:251]
s_waitcnt vmcnt(16) lgkmcnt(0)
s_barrier
ds_read_b128 a[116:119], v3 offset:0
ds_read_b128 a[120:123], v3 offset:1024
ds_read_b128 a[124:127], v3 offset:2048
ds_read_b128 a[128:131], v3 offset:3072
M v[252:255], a[160:163], v[76:79], v[252:255]
v_exp_f32 v123, v123
M v[252:255], a[156:159], v[44:47], v[252:255]
v_cvt_pk_bf16_f32 v107, v122, v123
M a[64:67], a[164:167], v[32:35], a[64:67]
v_exp_f32 v108, v108
M a[64:67], a[168:171], v[64:67], a[64:67]
ds_read_b128 a[132:135], v3 offset:4096
ds_read_b128 a[136:139], v3 offset:5120
M a[68:71], a[168:171], v[68:71], a[68:71]
v_exp_f32 v109, v109
M a[68:71], a[164:167], v[36:39], a[68:71]
v_cvt_pk_bf16_f32 v108, v108, v109
M a[72:75], a[164:167], v[40:43], a[72:75]
v_exp_f32 v110, v110
M a[72:75], a[168:171], v[72:75], a[72:75]
M a[76:79], a[168:171], v[76:79], a[76:79]
v_exp_f32 v111, v111
M a[76:79], a[164:167], v[44:47], a[76:79]
v_cvt_pk_bf16_f32 v109, v110, v111
M a[80:83], a[172:175], v[32:35], a[80:83]
v_exp_f32 v124, v124
M a[80:83], a[176:179], v[64:67], a[80:83]
ds_read_b128 a[140:143], v3 offset:6144
ds_read_b128 a[144:147], v3 offset:7168
M a[84:87], a[176:179], v[68:71], a[84:87]
v_exp_f32 v125, v125
M a[84:87], a[172:175], v[36:39], a[84:87]
v_cvt_pk_bf16_f32 v110, v124, v125
M a[88:91], a[172:175], v[40:43], a[88:91]
v_exp_f32 v126, v126
M a[88:91], a[176:179], v[72:75], a[88:91]
M a[92:95], a[176:179], v[76:79], a[92:95]
v_exp_f32 v127, v127
M a[92:95], a[172:175], v[44:47], a[92:95]
v_cvt_pk_bf16_f32 v111, v126, v127
s_waitcnt lgkmcnt(4)
s_add_u32 m0, s29, 32768
M v[32:35], a[116:119], a[0:3], 0
v_exp_f32 v128, v128
M v[32:35], a[120:123], a[4:7], v[32:35]
ds_read_b128 a[148:151], v3 offset:8192
ds_read_b128 a[152:155], v3 offset:9216
M v[32:35], a[124:127], a[8:11], v[32:35]
v_exp_f32 v129, v129
M v[32:35], a[128:131], a[12:15], v[32:35]
buffer_load_dwordx4 v1, s[12:15], s26 offen offset:0 sc1 lds
s_add_u32 s32, s26, 4096
M v[36:39], a[128:131], a[28:31], 0
v_exp_f32 v130, v130
M v[36:39], a[124:127], a[24:27], v[36:39]
v_cvt_pk_bf16_f32 v128, v128, v129
M v[36:39], a[120:123], a[20:23], v[36:39]
v_exp_f32 v131, v131
M v[36:39], a[116:119], a[16:19], v[36:39]
buffer_load_dwordx4 v1, s[12:15], s26 offen offset:1024 sc1 lds
M v[40:43], a[116:119], a[32:35], 0
v_exp_f32 v144, v144
M v[40:43], a[120:123], a[36:39], v[40:43]
ds_read_b128 a[156:159], v3 offset:10240
ds_read_b128 a[160:163], v3 offset:11264
M v[40:43], a[124:127], a[40:43], v[40:43]
v_exp_f32 v145, v145
M v[40:43], a[128:131], a[44:47], v[40:43]
buffer_load_dwordx4 v1, s[12:15], s26 offen offset:2048 sc1 lds
M v[44:47], a[128:131], a[60:63], 0
v_exp_f32 v146, v146
M v[44:47], a[124:127], a[56:59], v[44:47]
v_cvt_pk_bf16_f32 v129, v130, v131
v_cvt_pk_bf16_f32 v130, v144, v145
M v[44:47], a[120:123], a[52:55], v[44:47]
v_exp_f32 v147, v147
M v[44:47], a[116:119], a[48:51], v[44:47]
buffer_load_dwordx4 v1, s[12:15], s26 offen offset:3072 sc1 lds
s_add_u32 m0, s29, 36864
s_waitcnt lgkmcnt(4)
M v[48:51], a[132:135], a[0:3], 0
v_exp_f32 v132, v132
M v[48:51], a[136:139], a[4:7], v[48:51]
ds_read_b128 a[164:167], v3 offset:12288
ds_read_b128 a[168:171], v3 offset:13312
M v[48:51], a[140:143], a[8:11], v[48:51]
v_exp_f32 v133, v133
M v[48:51], a[144:147], a[12:15], v[48:51]
buffer_load_dwordx4 v1, s[12:15], s32 offen offset:0 sc1 lds
M v[52:55], a[144:147], a[28:31], 0
v_exp_f32 v134, v134
M v[52:55], a[140:143], a[24:27], v[52:55]
v_cvt_pk_bf16_f32 v131, v146, v147
v_cvt_pk_bf16_f32 v132, v132, v133
M v[52:55], a[136:139], a[20:23], v[52:55]
v_exp_f32 v135, v135
M v[52:55], a[132:135], a[16:19], v[52:55]
buffer_load_dwordx4 v1, s[12:15], s32 offen offset:1024 sc1 lds
M v[56:59], a[132:135], a[32:35], 0
v_exp_f32 v148, v148
M v[56:59], a[136:139], a[36:39], v[56:59]
ds_read_b128 a[172:175], v3 offset:14336
ds_read_b128 a[176:179], v3 offset:15360
M v[56:59], a[140:143], a[40:43], v[56:59]
v_exp_f32 v149, v149
M v[56:59], a[144:147], a[44:47], v[56:59]
buffer_load_dwordx4 v1, s[12:15], s32 offen offset:2048 sc1 lds
M v[60:63], a[144:147], a[60:63], 0
v_exp_f32 v150, v150
M v[60:63], a[140:143], a[56:59], v[60:63]
v_cvt_pk_bf16_f32 v133, v134, v135
v_cvt_pk_bf16_f32 v134, v148, v149
M v[60:63], a[136:139], a[52:55], v[60:63]
v_exp_f32 v151, v151
M v[60:63], a[132:135], a[48:51], v[60:63]
buffer_load_dwordx4 v1, s[12:15], s32 offen offset:3072 sc1 lds
s_waitcnt lgkmcnt(4)
M v[64:67], a[148:151], a[0:3], 0
v_exp_f32 v136, v136
M v[64:67], a[152:155], a[4:7], v[64:67]
s_add_u32 s26, s26, 32768
s_cmp_eq_u32 s26, s62
s_cselect_b32 s26, s63, s26
s_cselect_b32 s62, -1, s62
M v[64:67], a[156:159], a[8:11], v[64:67]
v_exp_f32 v137, v137
M v[64:67], a[160:163], a[12:15], v[64:67]
v_cvt_pk_bf16_f32 v135, v150, v151
v_cvt_pk_bf16_f32 v136, v136, v137
M v[68:71], a[160:163], a[28:31], 0
v_exp_f32 v138, v138
M v[68:71], a[156:159], a[24:27], v[68:71]
M v[68:71], a[152:155], a[20:23], v[68:71]
v_exp_f32 v139, v139
M v[68:71], a[148:151], a[16:19], v[68:71]
v_cvt_pk_bf16_f32 v137, v138, v139
M v[72:75], a[148:151], a[32:35], 0
v_exp_f32 v152, v152
M v[72:75], a[152:155], a[36:39], v[72:75]
M v[72:75], a[156:159], a[40:43], v[72:75]
v_exp_f32 v153, v153
M v[72:75], a[160:163], a[44:47], v[72:75]
v_cvt_pk_bf16_f32 v138, v152, v153
M v[76:79], a[160:163], a[60:63], 0
v_exp_f32 v154, v154
M v[76:79], a[156:159], a[56:59], v[76:79]
s_waitcnt vmcnt(16) lgkmcnt(0)
s_barrier
ds_read_b128 a[116:119], v3 offset:32768
ds_read_b128 a[120:123], v3 offset:40960
ds_read_b128 a[124:127], v3 offset:33792
ds_read_b128 a[128:131], v3 offset:41984
M v[76:79], a[152:155], a[52:55], v[76:79]
v_exp_f32 v155, v155
M v[76:79], a[148:151], a[48:51], v[76:79]
v_cvt_pk_bf16_f32 v139, v154, v155
M v[80:83], a[164:167], a[0:3], 0
v_exp_f32 v140, v140
M v[80:83], a[168:171], a[4:7], v[80:83]
ds_read_b128 a[132:135], v3 offset:34816
ds_read_b128 a[136:139], v3 offset:43008
M v[80:83], a[172:175], a[8:11], v[80:83]
v_exp_f32 v141, v141
M v[80:83], a[176:179], a[12:15], v[80:83]
v_cvt_pk_bf16_f32 v140, v140, v141
M v[84:87], a[176:179], a[28:31], 0
v_exp_f32 v142, v142
M v[84:87], a[172:175], a[24:27], v[84:87]
M v[84:87], a[168:171], a[20:23], v[84:87]
v_exp_f32 v143, v143
M v[84:87], a[164:167], a[16:19], v[84:87]
v_cvt_pk_bf16_f32 v141, v142, v143
M v[88:91], a[164:167], a[32:35], 0
v_exp_f32 v156, v156
M v[88:91], a[168:171], a[36:39], v[88:91]
ds_read_b128 a[140:143], v3 offset:35840
ds_read_b128 a[144:147], v3 offset:44032
M v[88:91], a[172:175], a[40:43], v[88:91]
v_exp_f32 v157, v157
M v[88:91], a[176:179], a[44:47], v[88:91]
v_cvt_pk_bf16_f32 v142, v156, v157
M v[92:95], a[176:179], a[60:63], 0
v_exp_f32 v158, v158
M v[92:95], a[172:175], a[56:59], v[92:95]
M v[92:95], a[168:171], a[52:55], v[92:95]
v_exp_f32 v159, v159
M v[92:95], a[164:167], a[48:51], v[92:95]
v_cvt_pk_bf16_f32 v143, v158, v159
s_waitcnt lgkmcnt(6)
s_add_u32 m0, s29, 65536
M v[160:163], a[116:119], v[96:99], v[160:163]
v_exp_f32 v32, v32
M v[160:163], a[120:123], v[128:131], v[160:163]
ds_read_b128 a[148:151], v3 offset:36864
ds_read_b128 a[152:155], v3 offset:45056
M v[164:167], a[120:123], v[132:135], v[164:167]
v_exp_f32 v33, v33
M v[164:167], a[116:119], v[100:103], v[164:167]
buffer_load_dwordx4 v1, s[12:15], s25 offen offset:0 sc1 lds
s_add_u32 s32, s25, 4096
M v[168:171], a[116:119], v[104:107], v[168:171]
v_exp_f32 v34, v34
M v[168:171], a[120:123], v[136:139], v[168:171]
v_cvt_pk_bf16_f32 v32, v32, v33
M v[172:175], a[120:123], v[140:143], v[172:175]
v_exp_f32 v35, v35
M v[172:175], a[116:119], v[108:111], v[172:175]
buffer_load_dwordx4 v1, s[12:15], s25 offen offset:1024 sc1 lds
s_waitcnt lgkmcnt(6)
M a[96:99], a[112:115], v[96:99], a[96:99]
M a[96:99], a[112:115], v[128:131], a[96:99]
M v[176:179], a[124:127], v[96:99], v[176:179]
v_exp_f32 v48, v48
M v[176:179], a[128:131], v[128:131], v[176:179]
ds_read_b128 a[156:159], v3 offset:37888
ds_read_b128 a[160:163], v3 offset:46080
M v[180:183], a[128:131], v[132:135], v[180:183]
v_exp_f32 v49, v49
M v[180:183], a[124:127], v[100:103], v[180:183]
buffer_load_dwordx4 v1, s[12:15], s25 offen offset:2048 sc1 lds
M v[184:187], a[124:127], v[104:107], v[184:187]
v_exp_f32 v50, v50
M v[184:187], a[128:131], v[136:139], v[184:187]
v_cvt_pk_bf16_f32 v33, v34, v35
v_cvt_pk_bf16_f32 v34, v48, v49
M v[188:191], a[128:131], v[140:143], v[188:191]
v_exp_f32 v51, v51
M v[188:191], a[124:127], v[108:111], v[188:191]
buffer_load_dwordx4 v1, s[12:15], s25 offen offset:3072 sc1 lds
s_add_u32 m0, s29, 69632
s_waitcnt lgkmcnt(6)
M a[100:103], a[112:115], v[100:103], a[100:103]
M a[100:103], a[112:115], v[132:135], a[100:103]
M v[192:195], a[132:135], v[96:99], v[192:195]
v_exp_f32 v36, v36
M v[192:195], a[136:139], v[128:131], v[192:195]
ds_read_b128 a[164:167], v3 offset:38912
ds_read_b128 a[168:171], v3 offset:47104
M v[196:199], a[136:139], v[132:135], v[196:199]
v_exp_f32 v37, v37
M v[196:199], a[132:135], v[100:103], v[196:199]
buffer_load_dwordx4 v1, s[12:15], s32 offen offset:0 sc1 lds
M v[200:203], a[132:135], v[104:107], v[200:203]
v_exp_f32 v38, v38
M v[200:203], a[136:139], v[136:139], v[200:203]
v_cvt_pk_bf16_f32 v35, v50, v51
v_cvt_pk_bf16_f32 v36, v36, v37
M v[204:207], a[136:139], v[140:143], v[204:207]
v_exp_f32 v39, v39
M v[204:207], a[132:135], v[108:111], v[204:207]
buffer_load_dwordx4 v1, s[12:15], s32 offen offset:1024 sc1 lds
s_waitcnt lgkmcnt(6)
M a[104:107], a[112:115], v[104:107], a[104:107]
M a[104:107], a[112:115], v[136:139], a[104:107]
M v[208:211], a[140:143], v[96:99], v[208:211]
v_exp_f32 v52, v52
M v[208:211], a[144:147], v[128:131], v[208:211]
ds_read_b128 a[172:175], v3 offset:39936
ds_read_b128 a[176:179], v3 offset:48128
M v[212:215], a[144:147], v[132:135], v[212:215]
v_exp_f32 v53, v53
M v[212:215], a[140:143], v[100:103], v[212:215]
buffer_load_dwordx4 v1, s[12:15], s32 offen offset:2048 sc1 lds
M v[216:219], a[140:143], v[104:107], v[216:219]
v_exp_f32 v54, v54
M v[216:219], a[144:147], v[136:139], v[216:219]
v_cvt_pk_bf16_f32 v37, v38, v39
v_cvt_pk_bf16_f32 v38, v52, v53
M v[220:223], a[144:147], v[140:143], v[220:223]
v_exp_f32 v55, v55
M v[220:223], a[140:143], v[108:111], v[220:223]
buffer_load_dwordx4 v1, s[12:15], s32 offen offset:3072 sc1 lds
s_waitcnt lgkmcnt(6)
M a[108:111], a[112:115], v[108:111], a[108:111]
M a[108:111], a[112:115], v[140:143], a[108:111]
M v[224:227], a[148:151], v[96:99], v[224:227]
v_exp_f32 v40, v40
M v[224:227], a[152:155], v[128:131], v[224:227]
s_add_u32 s25, s25, 32768
s_cmp_eq_u32 s25, s27
s_cselect_b32 s25, s28, s25
s_cselect_b32 s27, -1, s27
M v[228:231], a[152:155], v[132:135], v[228:231]
v_exp_f32 v41, v41
M v[228:231], a[148:151], v[100:103], v[228:231]
v_cvt_pk_bf16_f32 v39, v54, v55
v_cvt_pk_bf16_f32 v40, v40, v41
M v[232:235], a[148:151], v[104:107], v[232:235]
v_exp_f32 v42, v42
M v[232:235], a[152:155], v[136:139], v[232:235]
M v[236:239], a[152:155], v[140:143], v[236:239]
v_exp_f32 v43, v43
M v[236:239], a[148:151], v[108:111], v[236:239]
v_cvt_pk_bf16_f32 v41, v42, v43
s_waitcnt lgkmcnt(4)
M v[240:243], a[156:159], v[96:99], v[240:243]
v_exp_f32 v56, v56
M v[240:243], a[160:163], v[128:131], v[240:243]
M v[244:247], a[160:163], v[132:135], v[244:247]
v_exp_f32 v57, v57
M v[244:247], a[156:159], v[100:103], v[244:247]
v_cvt_pk_bf16_f32 v42, v56, v57
M v[248:251], a[156:159], v[104:107], v[248:251]
v_exp_f32 v58, v58
M v[248:251], a[160:163], v[136:139], v[248:251]
s_waitcnt vmcnt(16) lgkmcnt(0)
s_barrier
ds_read_b128 a[116:119], v2 offset:0
ds_read_b128 a[120:123], v2 offset:1024
ds_read_b128 a[124:127], v2 offset:2048
ds_read_b128 a[128:131], v2 offset:3072
M v[252:255], a[160:163], v[140:143], v[252:255]
v_exp_f32 v59, v59
M v[252:255], a[156:159], v[108:111], v[252:255]
v_cvt_pk_bf16_f32 v43, v58, v59
M a[64:67], a[164:167], v[96:99], a[64:67]
v_exp_f32 v44, v44
M a[64:67], a[168:171], v[128:131], a[64:67]
ds_read_b128 a[132:135], v2 offset:4096
ds_read_b128 a[136:139], v2 offset:5120
M a[68:71], a[168:171], v[132:135], a[68:71]
v_exp_f32 v45, v45
M a[68:71], a[164:167], v[100:103], a[68:71]
v_cvt_pk_bf16_f32 v44, v44, v45
M a[72:75], a[164:167], v[104:107], a[72:75]
v_exp_f32 v46, v46
M a[72:75], a[168:171], v[136:139], a[72:75]
M a[76:79], a[168:171], v[140:143], a[76:79]
v_exp_f32 v47, v47
M a[76:79], a[164:167], v[108:111], a[76:79]
v_cvt_pk_bf16_f32 v45, v46, v47
M a[80:83], a[172:175], v[96:99], a[80:83]
v_exp_f32 v60, v60
M a[80:83], a[176:179], v[128:131], a[80:83]
ds_read_b128 a[140:143], v2 offset:6144
ds_read_b128 a[144:147], v2 offset:7168
M a[84:87], a[176:179], v[132:135], a[84:87]
v_exp_f32 v61, v61
M a[84:87], a[172:175], v[100:103], a[84:87]
v_cvt_pk_bf16_f32 v46, v60, v61
M a[88:91], a[172:175], v[104:107], a[88:91]
v_exp_f32 v62, v62
M a[88:91], a[176:179], v[136:139], a[88:91]
M a[92:95], a[176:179], v[140:143], a[92:95]
v_exp_f32 v63, v63
M a[92:95], a[172:175], v[108:111], a[92:95]
v_cvt_pk_bf16_f32 v47, v62, v63
s_sub_u32 s30, s30, 1
s_cmp_lg_u32 s30, 0
s_cbranch_scc1 Lk2_l3
s_lshl_b32 s33, s23, 6
s_add_i32 s33, s33, 0
s_cmp_gt_i32 s33, 0
s_cselect_b32 s34, 0, 0xf149f2ca
s_cmp_lt_i32 s33, 0
s_cselect_b32 s33, 0xf149f2ca, 0
v_mov_b32 v20, s34
v_mov_b32 v21, s34
v_mov_b32 v22, s34
v_mov_b32 v23, s34
v_mov_b32 v28, s33
v_mov_b32 v29, s33
v_mov_b32 v30, s33
v_mov_b32 v31, s33
v_med3_f32 v24, v16, v20, v28
v_med3_f32 v25, v17, v20, v28
v_med3_f32 v26, v18, v20, v28
v_med3_f32 v27, v19, v20, v28
s_waitcnt lgkmcnt(4)
s_add_u32 m0, s29, 98304
M v[96:99], a[116:119], a[0:3], v[24:27]
v_exp_f32 v64, v64
M v[96:99], a[120:123], a[4:7], v[96:99]
ds_read_b128 a[148:151], v2 offset:8192
ds_read_b128 a[152:155], v2 offset:9216
M v[96:99], a[124:127], a[8:11], v[96:99]
v_exp_f32 v65, v65
M v[96:99], a[128:131], a[12:15], v[96:99]
buffer_load_dwordx4 v1, s[12:15], s26 offen offset:0 sc1 lds
s_add_u32 s32, s26, 4096
M v[100:103], a[128:131], a[28:31], v[28:31]
v_exp_f32 v66, v66
M v[100:103], a[124:127], a[24:27], v[100:103]
v_cvt_pk_bf16_f32 v64, v64, v65
M v[100:103], a[120:123], a[20:23], v[100:103]
v_exp_f32 v67, v67
M v[100:103], a[116:119], a[16:19], v[100:103]
buffer_load_dwordx4 v1, s[12:15], s26 offen offset:1024 sc1 lds
M v[104:107], a[116:119], a[32:35], v[28:31]
v_exp_f32 v80, v80
M v[104:107], a[120:123], a[36:39], v[104:107]
ds_read_b128 a[156:159], v2 offset:10240
ds_read_b128 a[160:163], v2 offset:11264
M v[104:107], a[124:127], a[40:43], v[104:107]
v_exp_f32 v81, v81
M v[104:107], a[128:131], a[44:47], v[104:107]
buffer_load_dwordx4 v1, s[12:15], s26 offen offset:2048 sc1 lds
M v[108:111], a[128:131], a[60:63], v[28:31]
v_exp_f32 v82, v82
M v[108:111], a[124:127], a[56:59], v[108:111]
v_cvt_pk_bf16_f32 v65, v66, v67
v_cvt_pk_bf16_f32 v66, v80, v81
M v[108:111], a[120:123], a[52:55], v[108:111]
v_exp_f32 v83, v83
M v[108:111], a[116:119], a[48:51], v[108:111]
buffer_load_dwordx4 v1, s[12:15], s26 offen offset:3072 sc1 lds
s_add_u32 m0, s29, 102400
s_waitcnt lgkmcnt(4)
M v[112:115], a[132:135], a[0:3], v[20:23]
v_exp_f32 v68, v68
M v[112:115], a[136:139], a[4:7], v[112:115]
ds_read_b128 a[164:167], v2 offset:12288
ds_read_b128 a[168:171], v2 offset:13312
M v[112:115], a[140:143], a[8:11], v[112:115]
v_exp_f32 v69, v69
M v[112:115], a[144:147], a[12:15], v[112:115]
buffer_load_dwordx4 v1, s[12:15], s32 offen offset:0 sc1 lds
M v[116:119], a[144:147], a[28:31], v[24:27]
v_exp_f32 v70, v70
M v[116:119], a[140:143], a[24:27], v[116:119]
v_cvt_pk_bf16_f32 v67, v82, v83
v_cvt_pk_bf16_f32 v68, v68, v69
M v[116:119], a[136:139], a[20:23], v[116:119]
v_exp_f32 v71, v71
M v[116:119], a[132:135], a[16:19], v[116:119]
buffer_load_dwordx4 v1, s[12:15], s32 offen offset:1024 sc1 lds
M v[120:123], a[132:135], a[32:35], v[28:31]
v_exp_f32 v84, v84
M v[120:123], a[136:139], a[36:39], v[120:123]
ds_read_b128 a[172:175], v2 offset:14336
ds_read_b128 a[176:179], v2 offset:15360
M v[120:123], a[140:143], a[40:43], v[120:123]
v_exp_f32 v85, v85
M v[120:123], a[144:147], a[44:47], v[120:123]
buffer_load_dwordx4 v1, s[12:15], s32 offen offset:2048 sc1 lds
M v[124:127], a[144:147], a[60:63], v[28:31]
v_exp_f32 v86, v86
M v[124:127], a[140:143], a[56:59], v[124:127]
v_cvt_pk_bf16_f32 v69, v70, v71
v_cvt_pk_bf16_f32 v70, v84, v85
M v[124:127], a[136:139], a[52:55], v[124:127]
v_exp_f32 v87, v87
M v[124:127], a[132:135], a[48:51], v[124:127]
buffer_load_dwordx4 v1, s[12:15], s32 offen offset:3072 sc1 lds
s_waitcnt lgkmcnt(4)
M v[128:131], a[148:151], a[0:3], v[20:23]
v_exp_f32 v72, v72
M v[128:131], a[152:155], a[4:7], v[128:131]
s_add_u32 s26, s26, 32768
s_cmp_eq_u32 s26, s62
s_cselect_b32 s26, s63, s26
s_cselect_b32 s62, -1, s62
M v[128:131], a[156:159], a[8:11], v[128:131]
v_exp_f32 v73, v73
M v[128:131], a[160:163], a[12:15], v[128:131]
v_cvt_pk_bf16_f32 v71, v86, v87
v_cvt_pk_bf16_f32 v72, v72, v73
M v[132:135], a[160:163], a[28:31], v[20:23]
v_exp_f32 v74, v74
M v[132:135], a[156:159], a[24:27], v[132:135]
M v[132:135], a[152:155], a[20:23], v[132:135]
v_exp_f32 v75, v75
M v[132:135], a[148:151], a[16:19], v[132:135]
v_cvt_pk_bf16_f32 v73, v74, v75
M v[136:139], a[148:151], a[32:35], v[24:27]
v_exp_f32 v88, v88
M v[136:139], a[152:155], a[36:39], v[136:139]
M v[136:139], a[156:159], a[40:43], v[136:139]
v_exp_f32 v89, v89
M v[136:139], a[160:163], a[44:47], v[136:139]
v_cvt_pk_bf16_f32 v74, v88, v89
M v[140:143], a[160:163], a[60:63], v[28:31]
v_exp_f32 v90, v90
M v[140:143], a[156:159], a[56:59], v[140:143]
s_waitcnt vmcnt(16) lgkmcnt(0)
s_barrier
ds_read_b128 a[116:119], v2 offset:32768
ds_read_b128 a[120:123], v2 offset:40960
ds_read_b128 a[124:127], v2 offset:33792
ds_read_b128 a[128:131], v2 offset:41984
M v[140:143], a[152:155], a[52:55], v[140:143]
v_exp_f32 v91, v91
M v[140:143], a[148:151], a[48:51], v[140:143]
v_cvt_pk_bf16_f32 v75, v90, v91
M v[144:147], a[164:167], a[0:3], v[20:23]
v_exp_f32 v76, v76
M v[144:147], a[168:171], a[4:7], v[144:147]
ds_read_b128 a[132:135], v2 offset:34816
ds_read_b128 a[136:139], v2 offset:43008
M v[144:147], a[172:175], a[8:11], v[144:147]
v_exp_f32 v77, v77
M v[144:147], a[176:179], a[12:15], v[144:147]
v_cvt_pk_bf16_f32 v76, v76, v77
M v[148:151], a[176:179], a[28:31], v[20:23]
v_exp_f32 v78, v78
M v[148:151], a[172:175], a[24:27], v[148:151]
M v[148:151], a[168:171], a[20:23], v[148:151]
v_exp_f32 v79, v79
M v[148:151], a[164:167], a[16:19], v[148:151]
v_cvt_pk_bf16_f32 v77, v78, v79
M v[152:155], a[164:167], a[32:35], v[20:23]
v_exp_f32 v92, v92
M v[152:155], a[168:171], a[36:39], v[152:155]
ds_read_b128 a[140:143], v2 offset:35840
ds_read_b128 a[144:147], v2 offset:44032
M v[152:155], a[172:175], a[40:43], v[152:155]
v_exp_f32 v93, v93
M v[152:155], a[176:179], a[44:47], v[152:155]
v_cvt_pk_bf16_f32 v78, v92, v93
M v[156:159], a[176:179], a[60:63], v[24:27]
v_exp_f32 v94, v94
M v[156:159], a[172:175], a[56:59], v[156:159]
M v[156:159], a[168:171], a[52:55], v[156:159]
v_exp_f32 v95, v95
M v[156:159], a[164:167], a[48:51], v[156:159]
v_cvt_pk_bf16_f32 v79, v94, v95
s_waitcnt lgkmcnt(6)
s_add_u32 m0, s29, 0
M v[160:163], a[116:119], v[32:35], v[160:163]
v_exp_f32 v96, v96
M v[160:163], a[120:123], v[64:67], v[160:163]
ds_read_b128 a[148:151], v2 offset:36864
ds_read_b128 a[152:155], v2 offset:45056
M v[164:167], a[120:123], v[68:71], v[164:167]
v_exp_f32 v97, v97
M v[164:167], a[116:119], v[36:39], v[164:167]
buffer_load_dwordx4 v1, s[12:15], s25 offen offset:0 sc1 lds
s_add_u32 s32, s25, 4096
M v[168:171], a[116:119], v[40:43], v[168:171]
v_exp_f32 v98, v98
M v[168:171], a[120:123], v[72:75], v[168:171]
v_cvt_pk_bf16_f32 v96, v96, v97
M v[172:175], a[120:123], v[76:79], v[172:175]
v_exp_f32 v99, v99
M v[172:175], a[116:119], v[44:47], v[172:175]
buffer_load_dwordx4 v1, s[12:15], s25 offen offset:1024 sc1 lds
s_waitcnt lgkmcnt(6)
M a[96:99], a[112:115], v[32:35], a[96:99]
M a[96:99], a[112:115], v[64:67], a[96:99]
M v[176:179], a[124:127], v[32:35], v[176:179]
v_exp_f32 v112, v112
M v[176:179], a[128:131], v[64:67], v[176:179]
ds_read_b128 a[156:159], v2 offset:37888
ds_read_b128 a[160:163], v2 offset:46080
M v[180:183], a[128:131], v[68:71], v[180:183]
v_exp_f32 v113, v113
M v[180:183], a[124:127], v[36:39], v[180:183]
buffer_load_dwordx4 v1, s[12:15], s25 offen offset:2048 sc1 lds
M v[184:187], a[124:127], v[40:43], v[184:187]
v_exp_f32 v114, v114
M v[184:187], a[128:131], v[72:75], v[184:187]
v_cvt_pk_bf16_f32 v97, v98, v99
v_cvt_pk_bf16_f32 v98, v112, v113
M v[188:191], a[128:131], v[76:79], v[188:191]
v_exp_f32 v115, v115
M v[188:191], a[124:127], v[44:47], v[188:191]
buffer_load_dwordx4 v1, s[12:15], s25 offen offset:3072 sc1 lds
s_add_u32 m0, s29, 4096
s_waitcnt lgkmcnt(6)
M a[100:103], a[112:115], v[36:39], a[100:103]
M a[100:103], a[112:115], v[68:71], a[100:103]
M v[192:195], a[132:135], v[32:35], v[192:195]
v_exp_f32 v100, v100
M v[192:195], a[136:139], v[64:67], v[192:195]
ds_read_b128 a[164:167], v2 offset:38912
ds_read_b128 a[168:171], v2 offset:47104
M v[196:199], a[136:139], v[68:71], v[196:199]
v_exp_f32 v101, v101
M v[196:199], a[132:135], v[36:39], v[196:199]
buffer_load_dwordx4 v1, s[12:15], s32 offen offset:0 sc1 lds
M v[200:203], a[132:135], v[40:43], v[200:203]
v_exp_f32 v102, v102
M v[200:203], a[136:139], v[72:75], v[200:203]
v_cvt_pk_bf16_f32 v99, v114, v115
v_cvt_pk_bf16_f32 v100, v100, v101
M v[204:207], a[136:139], v[76:79], v[204:207]
v_exp_f32 v103, v103
M v[204:207], a[132:135], v[44:47], v[204:207]
buffer_load_dwordx4 v1, s[12:15], s32 offen offset:1024 sc1 lds
s_waitcnt lgkmcnt(6)
M a[104:107], a[112:115], v[40:43], a[104:107]
M a[104:107], a[112:115], v[72:75], a[104:107]
M v[208:211], a[140:143], v[32:35], v[208:211]
v_exp_f32 v116, v116
M v[208:211], a[144:147], v[64:67], v[208:211]
ds_read_b128 a[172:175], v2 offset:39936
ds_read_b128 a[176:179], v2 offset:48128
M v[212:215], a[144:147], v[68:71], v[212:215]
v_exp_f32 v117, v117
M v[212:215], a[140:143], v[36:39], v[212:215]
buffer_load_dwordx4 v1, s[12:15], s32 offen offset:2048 sc1 lds
M v[216:219], a[140:143], v[40:43], v[216:219]
v_exp_f32 v118, v118
M v[216:219], a[144:147], v[72:75], v[216:219]
v_cvt_pk_bf16_f32 v101, v102, v103
v_cvt_pk_bf16_f32 v102, v116, v117
M v[220:223], a[144:147], v[76:79], v[220:223]
v_exp_f32 v119, v119
M v[220:223], a[140:143], v[44:47], v[220:223]
buffer_load_dwordx4 v1, s[12:15], s32 offen offset:3072 sc1 lds
s_waitcnt lgkmcnt(6)
M a[108:111], a[112:115], v[44:47], a[108:111]
M a[108:111], a[112:115], v[76:79], a[108:111]
M v[224:227], a[148:151], v[32:35], v[224:227]
v_exp_f32 v104, v104
M v[224:227], a[152:155], v[64:67], v[224:227]
s_add_u32 s25, s25, 32768
s_cmp_eq_u32 s25, s27
s_cselect_b32 s25, s28, s25
s_cselect_b32 s27, -1, s27
M v[228:231], a[152:155], v[68:71], v[228:231]
v_exp_f32 v105, v105
M v[228:231], a[148:151], v[36:39], v[228:231]
v_cvt_pk_bf16_f32 v103, v118, v119
v_cvt_pk_bf16_f32 v104, v104, v105
M v[232:235], a[148:151], v[40:43], v[232:235]
v_exp_f32 v106, v106
M v[232:235], a[152:155], v[72:75], v[232:235]
M v[236:239], a[152:155], v[76:79], v[236:239]
v_exp_f32 v107, v107
M v[236:239], a[148:151], v[44:47], v[236:239]
v_cvt_pk_bf16_f32 v105, v106, v107
s_waitcnt lgkmcnt(4)
M v[240:243], a[156:159], v[32:35], v[240:243]
v_exp_f32 v120, v120
M v[240:243], a[160:163], v[64:67], v[240:243]
M v[244:247], a[160:163], v[68:71], v[244:247]
v_exp_f32 v121, v121
M v[244:247], a[156:159], v[36:39], v[244:247]
v_cvt_pk_bf16_f32 v106, v120, v121
M v[248:251], a[156:159], v[40:43], v[248:251]
v_exp_f32 v122, v122
M v[248:251], a[160:163], v[72:75], v[248:251]
s_waitcnt vmcnt(16) lgkmcnt(0)
s_barrier
ds_read_b128 a[116:119], v3 offset:0
ds_read_b128 a[120:123], v3 offset:1024
ds_read_b128 a[124:127], v3 offset:2048
ds_read_b128 a[128:131], v3 offset:3072
M v[252:255], a[160:163], v[76:79], v[252:255]
v_exp_f32 v123, v123
M v[252:255], a[156:159], v[44:47], v[252:255]
v_cvt_pk_bf16_f32 v107, v122, v123
M a[64:67], a[164:167], v[32:35], a[64:67]
v_exp_f32 v108, v108
M a[64:67], a[168:171], v[64:67], a[64:67]
ds_read_b128 a[132:135], v3 offset:4096
ds_read_b128 a[136:139], v3 offset:5120
M a[68:71], a[168:171], v[68:71], a[68:71]
v_exp_f32 v109, v109
M a[68:71], a[164:167], v[36:39], a[68:71]
v_cvt_pk_bf16_f32 v108, v108, v109
M a[72:75], a[164:167], v[40:43], a[72:75]
v_exp_f32 v110, v110
M a[72:75], a[168:171], v[72:75], a[72:75]
M a[76:79], a[168:171], v[76:79], a[76:79]
v_exp_f32 v111, v111
M a[76:79], a[164:167], v[44:47], a[76:79]
v_cvt_pk_bf16_f32 v109, v110, v111
M a[80:83], a[172:175], v[32:35], a[80:83]
v_exp_f32 v124, v124
M a[80:83], a[176:179], v[64:67], a[80:83]
ds_read_b128 a[140:143], v3 offset:6144
ds_read_b128 a[144:147], v3 offset:7168
M a[84:87], a[176:179], v[68:71], a[84:87]
v_exp_f32 v125, v125
M a[84:87], a[172:175], v[36:39], a[84:87]
v_cvt_pk_bf16_f32 v110, v124, v125
M a[88:91], a[172:175], v[40:43], a[88:91]
v_exp_f32 v126, v126
M a[88:91], a[176:179], v[72:75], a[88:91]
M a[92:95], a[176:179], v[76:79], a[92:95]
v_exp_f32 v127, v127
M a[92:95], a[172:175], v[44:47], a[92:95]
v_cvt_pk_bf16_f32 v111, v126, v127
s_lshl_b32 s33, s23, 6
s_add_i32 s33, s33, -64
s_cmp_gt_i32 s33, 0
s_cselect_b32 s34, 0, 0xf149f2ca
s_cmp_lt_i32 s33, 0
s_cselect_b32 s33, 0xf149f2ca, 0
v_mov_b32 v20, s34
v_mov_b32 v21, s34
v_mov_b32 v22, s34
v_mov_b32 v23, s34
v_mov_b32 v28, s33
v_mov_b32 v29, s33
v_mov_b32 v30, s33
v_mov_b32 v31, s33
v_med3_f32 v24, v16, v20, v28
v_med3_f32 v25, v17, v20, v28
v_med3_f32 v26, v18, v20, v28
v_med3_f32 v27, v19, v20, v28
s_waitcnt lgkmcnt(4)
s_add_u32 m0, s29, 32768
M v[32:35], a[116:119], a[0:3], v[24:27]
v_exp_f32 v128, v128
M v[32:35], a[120:123], a[4:7], v[32:35]
ds_read_b128 a[148:151], v3 offset:8192
ds_read_b128 a[152:155], v3 offset:9216
M v[32:35], a[124:127], a[8:11], v[32:35]
v_exp_f32 v129, v129
M v[32:35], a[128:131], a[12:15], v[32:35]
buffer_load_dwordx4 v1, s[12:15], s26 offen offset:0 sc1 lds
s_add_u32 s32, s26, 4096
M v[36:39], a[128:131], a[28:31], v[28:31]
v_exp_f32 v130, v130
M v[36:39], a[124:127], a[24:27], v[36:39]
v_cvt_pk_bf16_f32 v128, v128, v129
M v[36:39], a[120:123], a[20:23], v[36:39]
v_exp_f32 v131, v131
M v[36:39], a[116:119], a[16:19], v[36:39]
buffer_load_dwordx4 v1, s[12:15], s26 offen offset:1024 sc1 lds
M v[40:43], a[116:119], a[32:35], v[28:31]
v_exp_f32 v144, v144
M v[40:43], a[120:123], a[36:39], v[40:43]
ds_read_b128 a[156:159], v3 offset:10240
ds_read_b128 a[160:163], v3 offset:11264
M v[40:43], a[124:127], a[40:43], v[40:43]
v_exp_f32 v145, v145
M v[40:43], a[128:131], a[44:47], v[40:43]
buffer_load_dwordx4 v1, s[12:15], s26 offen offset:2048 sc1 lds
M v[44:47], a[128:131], a[60:63], v[28:31]
v_exp_f32 v146, v146
M v[44:47], a[124:127], a[56:59], v[44:47]
v_cvt_pk_bf16_f32 v129, v130, v131
v_cvt_pk_bf16_f32 v130, v144, v145
M v[44:47], a[120:123], a[52:55], v[44:47]
v_exp_f32 v147, v147
M v[44:47], a[116:119], a[48:51], v[44:47]
buffer_load_dwordx4 v1, s[12:15], s26 offen offset:3072 sc1 lds
s_add_u32 m0, s29, 36864
s_waitcnt lgkmcnt(4)
M v[48:51], a[132:135], a[0:3], v[20:23]
v_exp_f32 v132, v132
M v[48:51], a[136:139], a[4:7], v[48:51]
ds_read_b128 a[164:167], v3 offset:12288
ds_read_b128 a[168:171], v3 offset:13312
M v[48:51], a[140:143], a[8:11], v[48:51]
v_exp_f32 v133, v133
M v[48:51], a[144:147], a[12:15], v[48:51]
buffer_load_dwordx4 v1, s[12:15], s32 offen offset:0 sc1 lds
M v[52:55], a[144:147], a[28:31], v[24:27]
v_exp_f32 v134, v134
M v[52:55], a[140:143], a[24:27], v[52:55]
v_cvt_pk_bf16_f32 v131, v146, v147
v_cvt_pk_bf16_f32 v132, v132, v133
M v[52:55], a[136:139], a[20:23], v[52:55]
v_exp_f32 v135, v135
M v[52:55], a[132:135], a[16:19], v[52:55]
buffer_load_dwordx4 v1, s[12:15], s32 offen offset:1024 sc1 lds
M v[56:59], a[132:135], a[32:35], v[28:31]
v_exp_f32 v148, v148
M v[56:59], a[136:139], a[36:39], v[56:59]
ds_read_b128 a[172:175], v3 offset:14336
ds_read_b128 a[176:179], v3 offset:15360
M v[56:59], a[140:143], a[40:43], v[56:59]
v_exp_f32 v149, v149
M v[56:59], a[144:147], a[44:47], v[56:59]
buffer_load_dwordx4 v1, s[12:15], s32 offen offset:2048 sc1 lds
M v[60:63], a[144:147], a[60:63], v[28:31]
v_exp_f32 v150, v150
M v[60:63], a[140:143], a[56:59], v[60:63]
v_cvt_pk_bf16_f32 v133, v134, v135
v_cvt_pk_bf16_f32 v134, v148, v149
M v[60:63], a[136:139], a[52:55], v[60:63]
v_exp_f32 v151, v151
M v[60:63], a[132:135], a[48:51], v[60:63]
buffer_load_dwordx4 v1, s[12:15], s32 offen offset:3072 sc1 lds
s_waitcnt lgkmcnt(4)
M v[64:67], a[148:151], a[0:3], v[20:23]
v_exp_f32 v136, v136
M v[64:67], a[152:155], a[4:7], v[64:67]
s_add_u32 s26, s26, 32768
s_cmp_eq_u32 s26, s62
s_cselect_b32 s26, s63, s26
s_cselect_b32 s62, -1, s62
M v[64:67], a[156:159], a[8:11], v[64:67]
v_exp_f32 v137, v137
M v[64:67], a[160:163], a[12:15], v[64:67]
v_cvt_pk_bf16_f32 v135, v150, v151
v_cvt_pk_bf16_f32 v136, v136, v137
M v[68:71], a[160:163], a[28:31], v[20:23]
v_exp_f32 v138, v138
M v[68:71], a[156:159], a[24:27], v[68:71]
M v[68:71], a[152:155], a[20:23], v[68:71]
v_exp_f32 v139, v139
M v[68:71], a[148:151], a[16:19], v[68:71]
v_cvt_pk_bf16_f32 v137, v138, v139
M v[72:75], a[148:151], a[32:35], v[24:27]
v_exp_f32 v152, v152
M v[72:75], a[152:155], a[36:39], v[72:75]
M v[72:75], a[156:159], a[40:43], v[72:75]
v_exp_f32 v153, v153
M v[72:75], a[160:163], a[44:47], v[72:75]
v_cvt_pk_bf16_f32 v138, v152, v153
M v[76:79], a[160:163], a[60:63], v[28:31]
v_exp_f32 v154, v154
M v[76:79], a[156:159], a[56:59], v[76:79]
s_waitcnt vmcnt(16) lgkmcnt(0)
s_barrier
ds_read_b128 a[116:119], v3 offset:32768
ds_read_b128 a[120:123], v3 offset:40960
ds_read_b128 a[124:127], v3 offset:33792
ds_read_b128 a[128:131], v3 offset:41984
M v[76:79], a[152:155], a[52:55], v[76:79]
v_exp_f32 v155, v155
M v[76:79], a[148:151], a[48:51], v[76:79]
v_cvt_pk_bf16_f32 v139, v154, v155
M v[80:83], a[164:167], a[0:3], v[20:23]
v_exp_f32 v140, v140
M v[80:83], a[168:171], a[4:7], v[80:83]
ds_read_b128 a[132:135], v3 offset:34816
ds_read_b128 a[136:139], v3 offset:43008
M v[80:83], a[172:175], a[8:11], v[80:83]
v_exp_f32 v141, v141
M v[80:83], a[176:179], a[12:15], v[80:83]
v_cvt_pk_bf16_f32 v140, v140, v141
M v[84:87], a[176:179], a[28:31], v[20:23]
v_exp_f32 v142, v142
M v[84:87], a[172:175], a[24:27], v[84:87]
M v[84:87], a[168:171], a[20:23], v[84:87]
v_exp_f32 v143, v143
M v[84:87], a[164:167], a[16:19], v[84:87]
v_cvt_pk_bf16_f32 v141, v142, v143
M v[88:91], a[164:167], a[32:35], v[20:23]
v_exp_f32 v156, v156
M v[88:91], a[168:171], a[36:39], v[88:91]
ds_read_b128 a[140:143], v3 offset:35840
ds_read_b128 a[144:147], v3 offset:44032
M v[88:91], a[172:175], a[40:43], v[88:91]
v_exp_f32 v157, v157
M v[88:91], a[176:179], a[44:47], v[88:91]
v_cvt_pk_bf16_f32 v142, v156, v157
M v[92:95], a[176:179], a[60:63], v[24:27]
v_exp_f32 v158, v158
M v[92:95], a[172:175], a[56:59], v[92:95]
M v[92:95], a[168:171], a[52:55], v[92:95]
v_exp_f32 v159, v159
M v[92:95], a[164:167], a[48:51], v[92:95]
v_cvt_pk_bf16_f32 v143, v158, v159
s_waitcnt lgkmcnt(6)
s_add_u32 m0, s29, 65536
M v[160:163], a[116:119], v[96:99], v[160:163]
v_exp_f32 v32, v32
M v[160:163], a[120:123], v[128:131], v[160:163]
ds_read_b128 a[148:151], v3 offset:36864
ds_read_b128 a[152:155], v3 offset:45056
M v[164:167], a[120:123], v[132:135], v[164:167]
v_exp_f32 v33, v33
M v[164:167], a[116:119], v[100:103], v[164:167]
buffer_load_dwordx4 v1, s[12:15], s25 offen offset:0 sc1 lds
s_add_u32 s32, s25, 4096
M v[168:171], a[116:119], v[104:107], v[168:171]
v_exp_f32 v34, v34
M v[168:171], a[120:123], v[136:139], v[168:171]
v_cvt_pk_bf16_f32 v32, v32, v33
M v[172:175], a[120:123], v[140:143], v[172:175]
v_exp_f32 v35, v35
M v[172:175], a[116:119], v[108:111], v[172:175]
buffer_load_dwordx4 v1, s[12:15], s25 offen offset:1024 sc1 lds
s_waitcnt lgkmcnt(6)
M a[96:99], a[112:115], v[96:99], a[96:99]
M a[96:99], a[112:115], v[128:131], a[96:99]
M v[176:179], a[124:127], v[96:99], v[176:179]
v_exp_f32 v48, v48
M v[176:179], a[128:131], v[128:131], v[176:179]
ds_read_b128 a[156:159], v3 offset:37888
ds_read_b128 a[160:163], v3 offset:46080
M v[180:183], a[128:131], v[132:135], v[180:183]
v_exp_f32 v49, v49
M v[180:183], a[124:127], v[100:103], v[180:183]
buffer_load_dwordx4 v1, s[12:15], s25 offen offset:2048 sc1 lds
M v[184:187], a[124:127], v[104:107], v[184:187]
v_exp_f32 v50, v50
M v[184:187], a[128:131], v[136:139], v[184:187]
v_cvt_pk_bf16_f32 v33, v34, v35
v_cvt_pk_bf16_f32 v34, v48, v49
M v[188:191], a[128:131], v[140:143], v[188:191]
v_exp_f32 v51, v51
M v[188:191], a[124:127], v[108:111], v[188:191]
buffer_load_dwordx4 v1, s[12:15], s25 offen offset:3072 sc1 lds
s_add_u32 m0, s29, 69632
s_waitcnt lgkmcnt(6)
M a[100:103], a[112:115], v[100:103], a[100:103]
M a[100:103], a[112:115], v[132:135], a[100:103]
M v[192:195], a[132:135], v[96:99], v[192:195]
v_exp_f32 v36, v36
M v[192:195], a[136:139], v[128:131], v[192:195]
ds_read_b128 a[164:167], v3 offset:38912
ds_read_b128 a[168:171], v3 offset:47104
M v[196:199], a[136:139], v[132:135], v[196:199]
v_exp_f32 v37, v37
M v[196:199], a[132:135], v[100:103], v[196:199]
buffer_load_dwordx4 v1, s[12:15], s32 offen offset:0 sc1 lds
M v[200:203], a[132:135], v[104:107], v[200:203]
v_exp_f32 v38, v38
M v[200:203], a[136:139], v[136:139], v[200:203]
v_cvt_pk_bf16_f32 v35, v50, v51
v_cvt_pk_bf16_f32 v36, v36, v37
M v[204:207], a[136:139], v[140:143], v[204:207]
v_exp_f32 v39, v39
M v[204:207], a[132:135], v[108:111], v[204:207]
buffer_load_dwordx4 v1, s[12:15], s32 offen offset:1024 sc1 lds
s_waitcnt lgkmcnt(6)
M a[104:107], a[112:115], v[104:107], a[104:107]
M a[104:107], a[112:115], v[136:139], a[104:107]
M v[208:211], a[140:143], v[96:99], v[208:211]
v_exp_f32 v52, v52
M v[208:211], a[144:147], v[128:131], v[208:211]
ds_read_b128 a[172:175], v3 offset:39936
ds_read_b128 a[176:179], v3 offset:48128
M v[212:215], a[144:147], v[132:135], v[212:215]
v_exp_f32 v53, v53
M v[212:215], a[140:143], v[100:103], v[212:215]
buffer_load_dwordx4 v1, s[12:15], s32 offen offset:2048 sc1 lds
M v[216:219], a[140:143], v[104:107], v[216:219]
v_exp_f32 v54, v54
M v[216:219], a[144:147], v[136:139], v[216:219]
v_cvt_pk_bf16_f32 v37, v38, v39
v_cvt_pk_bf16_f32 v38, v52, v53
M v[220:223], a[144:147], v[140:143], v[220:223]
v_exp_f32 v55, v55
M v[220:223], a[140:143], v[108:111], v[220:223]
buffer_load_dwordx4 v1, s[12:15], s32 offen offset:3072 sc1 lds
s_waitcnt lgkmcnt(6)
M a[108:111], a[112:115], v[108:111], a[108:111]
M a[108:111], a[112:115], v[140:143], a[108:111]
M v[224:227], a[148:151], v[96:99], v[224:227]
v_exp_f32 v40, v40
M v[224:227], a[152:155], v[128:131], v[224:227]
s_add_u32 s25, s25, 32768
s_cmp_eq_u32 s25, s27
s_cselect_b32 s25, s28, s25
s_cselect_b32 s27, -1, s27
M v[228:231], a[152:155], v[132:135], v[228:231]
v_exp_f32 v41, v41
M v[228:231], a[148:151], v[100:103], v[228:231]
v_cvt_pk_bf16_f32 v39, v54, v55
v_cvt_pk_bf16_f32 v40, v40, v41
M v[232:235], a[148:151], v[104:107], v[232:235]
v_exp_f32 v42, v42
M v[232:235], a[152:155], v[136:139], v[232:235]
M v[236:239], a[152:155], v[140:143], v[236:239]
v_exp_f32 v43, v43
M v[236:239], a[148:151], v[108:111], v[236:239]
v_cvt_pk_bf16_f32 v41, v42, v43
s_waitcnt lgkmcnt(4)
M v[240:243], a[156:159], v[96:99], v[240:243]
v_exp_f32 v56, v56
M v[240:243], a[160:163], v[128:131], v[240:243]
M v[244:247], a[160:163], v[132:135], v[244:247]
v_exp_f32 v57, v57
M v[244:247], a[156:159], v[100:103], v[244:247]
v_cvt_pk_bf16_f32 v42, v56, v57
M v[248:251], a[156:159], v[104:107], v[248:251]
v_exp_f32 v58, v58
M v[248:251], a[160:163], v[136:139], v[248:251]
s_waitcnt vmcnt(16) lgkmcnt(0)
s_barrier
ds_read_b128 a[116:119], v2 offset:0
ds_read_b128 a[120:123], v2 offset:1024
ds_read_b128 a[124:127], v2 offset:2048
ds_read_b128 a[128:131], v2 offset:3072
M v[252:255], a[160:163], v[140:143], v[252:255]
v_exp_f32 v59, v59
M v[252:255], a[156:159], v[108:111], v[252:255]
v_cvt_pk_bf16_f32 v43, v58, v59
M a[64:67], a[164:167], v[96:99], a[64:67]
v_exp_f32 v44, v44
M a[64:67], a[168:171], v[128:131], a[64:67]
ds_read_b128 a[132:135], v2 offset:4096
ds_read_b128 a[136:139], v2 offset:5120
M a[68:71], a[168:171], v[132:135], a[68:71]
v_exp_f32 v45, v45
M a[68:71], a[164:167], v[100:103], a[68:71]
v_cvt_pk_bf16_f32 v44, v44, v45
M a[72:75], a[164:167], v[104:107], a[72:75]
v_exp_f32 v46, v46
M a[72:75], a[168:171], v[136:139], a[72:75]
M a[76:79], a[168:171], v[140:143], a[76:79]
v_exp_f32 v47, v47
M a[76:79], a[164:167], v[108:111], a[76:79]
v_cvt_pk_bf16_f32 v45, v46, v47
M a[80:83], a[172:175], v[96:99], a[80:83]
v_exp_f32 v60, v60
M a[80:83], a[176:179], v[128:131], a[80:83]
ds_read_b128 a[140:143], v2 offset:6144
ds_read_b128 a[144:147], v2 offset:7168
M a[84:87], a[176:179], v[132:135], a[84:87]
v_exp_f32 v61, v61
M a[84:87], a[172:175], v[100:103], a[84:87]
v_cvt_pk_bf16_f32 v46, v60, v61
M a[88:91], a[172:175], v[104:107], a[88:91]
v_exp_f32 v62, v62
M a[88:91], a[176:179], v[136:139], a[88:91]
M a[92:95], a[176:179], v[140:143], a[92:95]
v_exp_f32 v63, v63
M a[92:95], a[172:175], v[108:111], a[92:95]
v_cvt_pk_bf16_f32 v47, v62, v63
s_waitcnt lgkmcnt(0)
Lk2_fin:
s_waitcnt vmcnt(8)
s_barrier
s_and_b32 s3, s2, 3
s_lshl_b32 s3, s3, 2
s_bfe_u32 s27, s2, 0x20003
s_add_u32 s27, s3, s27
s_lshl_b32 s43, s27, 8
s_add_u32 s43, s43, 8400896
v_lshlrev_b32 v15, 2, v0
buffer_load_dword v7, v15, s[52:55], s43 offen sc1
s_lshl_b32 s33, s2, 2
s_add_u32 s33, s33, s22
s_lshl_b32 s34, s33, 11
s_lshl_b32 s33, s33, 13
v_lshlrev_b32 v8, 3, v1
v_lshlrev_b32 v9, 1, v1
buffer_load_dword v5, v8, s[44:47], s33 offen
buffer_load_dword v6, v9, s[48:51], s34 offen
ds_read_b128 a[116:119], v2 offset:32768
ds_read_b128 a[120:123], v2 offset:40960
ds_read_b128 a[124:127], v2 offset:33792
ds_read_b128 a[128:131], v2 offset:41984
ds_read_b128 a[132:135], v2 offset:34816
ds_read_b128 a[136:139], v2 offset:43008
ds_read_b128 a[140:143], v2 offset:35840
ds_read_b128 a[144:147], v2 offset:44032
v_exp_f32 v64, v64
v_exp_f32 v65, v65
v_exp_f32 v66, v66
v_exp_f32 v67, v67
v_exp_f32 v80, v80
v_exp_f32 v81, v81
v_exp_f32 v82, v82
v_exp_f32 v83, v83
v_cvt_pk_bf16_f32 v64, v64, v65
v_cvt_pk_bf16_f32 v65, v66, v67
v_exp_f32 v68, v68
v_exp_f32 v69, v69
v_exp_f32 v70, v70
v_exp_f32 v71, v71
v_cvt_pk_bf16_f32 v66, v80, v81
v_cvt_pk_bf16_f32 v67, v82, v83
v_exp_f32 v84, v84
v_exp_f32 v85, v85
v_exp_f32 v86, v86
v_exp_f32 v87, v87
v_cvt_pk_bf16_f32 v68, v68, v69
v_cvt_pk_bf16_f32 v69, v70, v71
v_exp_f32 v72, v72
v_exp_f32 v73, v73
v_exp_f32 v74, v74
v_exp_f32 v75, v75
v_cvt_pk_bf16_f32 v70, v84, v85
v_cvt_pk_bf16_f32 v71, v86, v87
v_exp_f32 v88, v88
v_exp_f32 v89, v89
v_exp_f32 v90, v90
v_exp_f32 v91, v91
v_cvt_pk_bf16_f32 v72, v72, v73
v_cvt_pk_bf16_f32 v73, v74, v75
v_exp_f32 v76, v76
v_exp_f32 v77, v77
v_exp_f32 v78, v78
v_exp_f32 v79, v79
v_cvt_pk_bf16_f32 v74, v88, v89
v_cvt_pk_bf16_f32 v75, v90, v91
v_exp_f32 v92, v92
v_exp_f32 v93, v93
v_exp_f32 v94, v94
v_exp_f32 v95, v95
v_cvt_pk_bf16_f32 v76, v76, v77
v_cvt_pk_bf16_f32 v77, v78, v79
v_cvt_pk_bf16_f32 v78, v92, v93
v_cvt_pk_bf16_f32 v79, v94, v95
s_waitcnt lgkmcnt(6)
M v[160:163], a[116:119], v[32:35], v[160:163]
M v[160:163], a[120:123], v[64:67], v[160:163]
ds_read_b128 a[148:151], v2 offset:36864
ds_read_b128 a[152:155], v2 offset:45056
s_mov_b32 s61, 0
M v[164:167], a[120:123], v[68:71], v[164:167]
M v[164:167], a[116:119], v[36:39], v[164:167]
s_bfe_u32 s3, s2, 0x10002
M v[168:171], a[116:119], v[40:43], v[168:171]
M v[168:171], a[120:123], v[72:75], v[168:171]
s_lshl_b32 s3, s3, 3
M v[172:175], a[120:123], v[76:79], v[172:175]
M v[172:175], a[116:119], v[44:47], v[172:175]
s_waitcnt lgkmcnt(6)
s_lshr_b32 s28, s2, 5
M a[96:99], a[112:115], v[32:35], a[96:99]
M a[96:99], a[112:115], v[64:67], a[96:99]
M v[176:179], a[124:127], v[32:35], v[176:179]
M v[176:179], a[128:131], v[64:67], v[176:179]
ds_read_b128 a[156:159], v2 offset:37888
ds_read_b128 a[160:163], v2 offset:46080
s_add_u32 s28, s3, s28
M v[180:183], a[128:131], v[68:71], v[180:183]
s_lshl_b32 s25, s27, 18
M v[180:183], a[124:127], v[36:39], v[180:183]
M v[184:187], a[124:127], v[40:43], v[184:187]
s_lshl_b32 s3, s101, 12
M v[184:187], a[128:131], v[72:75], v[184:187]
M v[188:191], a[128:131], v[76:79], v[188:191]
s_add_u32 s25, s25, s3
M v[188:191], a[124:127], v[44:47], v[188:191]
s_waitcnt lgkmcnt(6)
M a[100:103], a[112:115], v[36:39], a[100:103]
M a[100:103], a[112:115], v[68:71], a[100:103]
M v[192:195], a[132:135], v[32:35], v[192:195]
s_lshl_b32 s26, s28, 7
M v[192:195], a[136:139], v[64:67], v[192:195]
ds_read_b128 a[164:167], v2 offset:38912
ds_read_b128 a[168:171], v2 offset:47104
M v[196:199], a[136:139], v[68:71], v[196:199]
s_lshl_b32 s42, s101, 11
M v[196:199], a[132:135], v[36:39], v[196:199]
M v[200:203], a[132:135], v[40:43], v[200:203]
s_add_u32 s44, s4, 83886080
s_addc_u32 s45, s5, 0
M v[200:203], a[136:139], v[72:75], v[200:203]
s_mov_b32 s46, 4194304
M v[204:207], a[136:139], v[76:79], v[204:207]
M v[204:207], a[132:135], v[44:47], v[204:207]
s_waitcnt lgkmcnt(6)
s_mov_b32 s47, 0x00020000
M a[104:107], a[112:115], v[40:43], a[104:107]
M a[104:107], a[112:115], v[72:75], a[104:107]
M v[208:211], a[140:143], v[32:35], v[208:211]
M v[208:211], a[144:147], v[64:67], v[208:211]
ds_read_b128 a[172:175], v2 offset:39936
ds_read_b128 a[176:179], v2 offset:48128
s_mov_b32 s50, 2097152
M v[212:215], a[144:147], v[68:71], v[212:215]
M v[212:215], a[140:143], v[36:39], v[212:215]
s_mov_b32 s51, 0x00020000
M v[216:219], a[140:143], v[40:43], v[216:219]
M v[216:219], a[144:147], v[72:75], v[216:219]
s_lshl_b32 s3, s101, 4
M v[220:223], a[144:147], v[76:79], v[220:223]
M v[220:223], a[140:143], v[44:47], v[220:223]
s_waitcnt lgkmcnt(6)
v_lshrrev_b32 v96, 3, v0
M a[108:111], a[112:115], v[44:47], a[108:111]
M a[108:111], a[112:115], v[76:79], a[108:111]
M v[224:227], a[148:151], v[32:35], v[224:227]
v_and_b32 v97, 6, v96
M v[224:227], a[152:155], v[64:67], v[224:227]
M v[228:231], a[152:155], v[68:71], v[228:231]
v_and_b32 v98, 7, v0
M v[228:231], a[148:151], v[36:39], v[228:231]
M v[232:235], a[148:151], v[40:43], v[232:235]
v_xor_b32 v97, v97, v98
M v[232:235], a[152:155], v[72:75], v[232:235]
M v[236:239], a[152:155], v[76:79], v[236:239]
v_add_u32 v96, s3, v96
M v[236:239], a[148:151], v[44:47], v[236:239]
s_waitcnt lgkmcnt(4)
M v[240:243], a[156:159], v[32:35], v[240:243]
v_lshlrev_b32 v96, 11, v96
M v[240:243], a[160:163], v[64:67], v[240:243]
M v[244:247], a[160:163], v[68:71], v[244:247]
v_lshl_add_u32 v99, v97, 4, v96
M v[244:247], a[156:159], v[36:39], v[244:247]
v_add_u32 v100, 15360, v99
M v[248:251], a[156:159], v[40:43], v[248:251]
M v[248:251], a[160:163], v[72:75], v[248:251]
s_waitcnt vmcnt(2) lgkmcnt(0)
s_barrier
v_cmp_ne_u32 vcc, 1, v7
s_nop 0
s_cbranch_vccnz Lk3_spinb0
Lk3_gotb0:
M v[252:255], a[160:163], v[76:79], v[252:255]
s_add_u32 m0, s42, 65536
s_nop 0
buffer_load_dwordx4 v99, s[48:51], s26 offen offset:0 lds
buffer_load_dwordx4 v100, s[48:51], s26 offen offset:1024 lds
M v[252:255], a[156:159], v[44:47], v[252:255]
buffer_load_dwordx4 a[192:195], v1, s[44:47], s25 offen offset:0 sc1
buffer_load_dwordx4 a[196:199], v1, s[44:47], s25 offen offset:1024 sc1
M a[64:67], a[164:167], v[32:35], a[64:67]
buffer_load_dwordx4 a[200:203], v1, s[44:47], s25 offen offset:2048 sc1
buffer_load_dwordx4 a[204:207], v1, s[44:47], s25 offen offset:3072 sc1
M a[64:67], a[168:171], v[64:67], a[64:67]
s_add_u32 s25, s25, 16384
s_add_u32 s26, s26, 131072
s_add_u32 m0, s42, 81920
s_nop 0
buffer_load_dwordx4 v99, s[48:51], s26 offen offset:0 lds
M a[68:71], a[168:171], v[68:71], a[68:71]
buffer_load_dwordx4 v100, s[48:51], s26 offen offset:1024 lds
buffer_load_dwordx4 a[208:211], v1, s[44:47], s25 offen offset:0 sc1
M a[68:71], a[164:167], v[36:39], a[68:71]
buffer_load_dwordx4 a[212:215], v1, s[44:47], s25 offen offset:1024 sc1
buffer_load_dwordx4 a[216:219], v1, s[44:47], s25 offen offset:2048 sc1
M a[72:75], a[164:167], v[40:43], a[72:75]
buffer_load_dwordx4 a[220:223], v1, s[44:47], s25 offen offset:3072 sc1
s_add_u32 s25, s25, 16384
s_add_u32 s26, s26, 131072
M a[72:75], a[168:171], v[72:75], a[72:75]
s_add_u32 m0, s42, 98304
s_nop 0
buffer_load_dwordx4 v99, s[48:51], s26 offen offset:0 lds
buffer_load_dwordx4 v100, s[48:51], s26 offen offset:1024 lds
M a[76:79], a[168:171], v[76:79], a[76:79]
buffer_load_dwordx4 a[224:227], v1, s[44:47], s25 offen offset:0 sc1
M a[76:79], a[164:167], v[44:47], a[76:79]
buffer_load_dwordx4 a[228:231], v1, s[44:47], s25 offen offset:1024 sc1
buffer_load_dwordx4 a[232:235], v1, s[44:47], s25 offen offset:2048 sc1
M a[80:83], a[172:175], v[32:35], a[80:83]
buffer_load_dwordx4 a[236:239], v1, s[44:47], s25 offen offset:3072 sc1
s_add_u32 s25, s25, 16384
s_add_u32 s26, s26, 131072
M a[80:83], a[176:179], v[64:67], a[80:83]
s_add_u32 m0, s42, 114688
s_nop 0
buffer_load_dwordx4 v99, s[48:51], s26 offen offset:0 lds
buffer_load_dwordx4 v100, s[48:51], s26 offen offset:1024 lds
M a[84:87], a[176:179], v[68:71], a[84:87]
buffer_load_dwordx4 a[240:243], v1, s[44:47], s25 offen offset:0 sc1
buffer_load_dwordx4 a[244:247], v1, s[44:47], s25 offen offset:1024 sc1
M a[84:87], a[172:175], v[36:39], a[84:87]
buffer_load_dwordx4 a[248:251], v1, s[44:47], s25 offen offset:2048 sc1
buffer_load_dwordx4 a[252:255], v1, s[44:47], s25 offen offset:3072 sc1
M a[88:91], a[172:175], v[40:43], a[88:91]
s_add_u32 s25, s25, 16384
s_add_u32 s26, s26, 131072
s_add_u32 m0, s42, 0
s_nop 0
buffer_load_dwordx4 v99, s[48:51], s26 offen offset:0 lds
M a[88:91], a[176:179], v[72:75], a[88:91]
buffer_load_dwordx4 v100, s[48:51], s26 offen offset:1024 lds
buffer_load_dwordx4 a[128:131], v1, s[44:47], s25 offen offset:0 sc1
M a[92:95], a[176:179], v[76:79], a[92:95]
buffer_load_dwordx4 a[132:135], v1, s[44:47], s25 offen offset:1024 sc1
buffer_load_dwordx4 a[136:139], v1, s[44:47], s25 offen offset:2048 sc1
M a[92:95], a[172:175], v[44:47], a[92:95]
buffer_load_dwordx4 a[140:143], v1, s[44:47], s25 offen offset:3072 sc1
s_add_u32 s25, s25, 16384
s_add_u32 s26, s26, 131072
Lk2_merge:
s_lshl_b32 s33, s23, 14
s_add_u32 s34, s33, 131072
s_add_u32 s33, s33, 32768
s_cmp_eq_u32 s24, 0
s_cselect_b32 s35, s34, s33
s_cselect_b32 s36, s33, s34
v_add_u32 v2, s35, v1
v_add_u32 v3, s36, v1
s_lshl_b32 s33, s22, 10
s_add_u32 s33, s33, 28672
s_xor_b32 s34, s33, 2048
v_add_u32 v14, s33, v1
v_add_u32 v15, s34, v1
v_accvgpr_read_b32 v20, a96
v_accvgpr_read_b32 v21, a100
v_accvgpr_read_b32 v22, a104
v_accvgpr_read_b32 v23, a108
ds_write_b128 v14, v[20:23]
s_cmp_eq_u32 s24, 1
s_waitcnt lgkmcnt(0)
s_cbranch_scc1 Lk2_mg1
ds_write_b128 v2, v[224:227] offset:0
ds_write_b128 v2, v[228:231] offset:1024
ds_write_b128 v2, v[232:235] offset:2048
ds_write_b128 v2, v[236:239] offset:3072
ds_write_b128 v2, v[240:243] offset:4096
ds_write_b128 v2, v[244:247] offset:5120
ds_write_b128 v2, v[248:251] offset:6144
ds_write_b128 v2, v[252:255] offset:7168
ds_write_b128 v2, a[64:67] offset:8192
ds_write_b128 v2, a[68:71] offset:9216
ds_write_b128 v2, a[72:75] offset:10240
ds_write_b128 v2, a[76:79] offset:11264
ds_write_b128 v2, a[80:83] offset:12288
ds_write_b128 v2, a[84:87] offset:13312
ds_write_b128 v2, a[88:91] offset:14336
ds_write_b128 v2, a[92:95] offset:15360
s_waitcnt lgkmcnt(0)
s_barrier
ds_read_b128 v[28:31], v15
ds_read_b128 v[32:35], v3 offset:0
ds_read_b128 v[36:39], v3 offset:1024
ds_read_b128 v[40:43], v3 offset:2048
ds_read_b128 v[44:47], v3 offset:3072
ds_read_b128 v[48:51], v3 offset:4096
ds_read_b128 v[52:55], v3 offset:5120
ds_read_b128 v[56:59], v3 offset:6144
ds_read_b128 v[60:63], v3 offset:7168
ds_read_b128 v[64:67], v3 offset:8192
ds_read_b128 v[68:71], v3 offset:9216
ds_read_b128 v[72:75], v3 offset:10240
ds_read_b128 v[76:79], v3 offset:11264
ds_read_b128 v[80:83], v3 offset:12288
ds_read_b128 v[84:87], v3 offset:13312
ds_read_b128 v[88:91], v3 offset:14336
ds_read_b128 v[92:95], v3 offset:15360
s_waitcnt lgkmcnt(15)
v_add_f32 v20, v20, v28
v_add_f32 v21, v21, v29
v_add_f32 v22, v22, v30
v_add_f32 v23, v23, v31
s_sub_u32 s35, 15, s21
v_rcp_f32 v8, v20
v_rcp_f32 v9, v21
v_rcp_f32 v10, v22
v_rcp_f32 v11, v23
v_subrev_u32 v20, 0x21800000, v20
v_subrev_u32 v21, 0x21800000, v21
v_subrev_u32 v22, 0x21800000, v22
v_subrev_u32 v23, 0x21800000, v23
v_max_u32 v12, v20, v21
v_max3_u32 v12, v12, v22, v23
s_mov_b32 s64, 0x207
v_pk_add_f32 v[160:161], v[160:161], v[32:33]
v_pk_add_f32 v[162:163], v[162:163], v[34:35]
s_waitcnt lgkmcnt(11)
v_pk_add_f32 v[176:177], v[176:177], v[48:49]
v_pk_add_f32 v[178:179], v[178:179], v[50:51]
v_pk_mul_f32 v[160:161], v[160:161], v[8:9] op_sel:[0,0] op_sel_hi:[1,0]
v_pk_mul_f32 v[162:163], v[162:163], v[8:9] op_sel:[0,0] op_sel_hi:[1,0]
v_pk_mul_f32 v[176:177], v[176:177], v[8:9] op_sel:[0,0] op_sel_hi:[1,0]
v_pk_mul_f32 v[178:179], v[178:179], v[8:9] op_sel:[0,0] op_sel_hi:[1,0]
v_cvt_pk_bf16_f32 v160, v160, v161
v_cvt_pk_bf16_f32 v161, v162, v163
v_cvt_pk_bf16_f32 v162, v176, v177
v_cvt_pk_bf16_f32 v163, v178, v179
v_pk_add_f32 v[164:165], v[164:165], v[36:37]
v_pk_add_f32 v[166:167], v[166:167], v[38:39]
s_waitcnt lgkmcnt(10)
v_pk_add_f32 v[180:181], v[180:181], v[52:53]
v_pk_add_f32 v[182:183], v[182:183], v[54:55]
M v[24:27], a[112:115], v[160:163], 0
v_pk_mul_f32 v[164:165], v[164:165], v[8:9] op_sel:[0,1] op_sel_hi:[1,1]
v_pk_mul_f32 v[166:167], v[166:167], v[8:9] op_sel:[0,1] op_sel_hi:[1,1]
v_pk_mul_f32 v[180:181], v[180:181], v[8:9] op_sel:[0,1] op_sel_hi:[1,1]
v_pk_mul_f32 v[182:183], v[182:183], v[8:9] op_sel:[0,1] op_sel_hi:[1,1]
v_cvt_pk_bf16_f32 v164, v164, v165
v_cvt_pk_bf16_f32 v165, v166, v167
v_cvt_pk_bf16_f32 v166, v180, v181
v_cvt_pk_bf16_f32 v167, v182, v183
v_pk_add_f32 v[168:169], v[168:169], v[40:41]
v_pk_add_f32 v[170:171], v[170:171], v[42:43]
s_waitcnt lgkmcnt(9)
v_pk_add_f32 v[184:185], v[184:185], v[56:57]
v_pk_add_f32 v[186:187], v[186:187], v[58:59]
M v[24:27], a[112:115], v[164:167], v[24:27]
v_pk_mul_f32 v[168:169], v[168:169], v[10:11] op_sel:[0,0] op_sel_hi:[1,0]
v_pk_mul_f32 v[170:171], v[170:171], v[10:11] op_sel:[0,0] op_sel_hi:[1,0]
v_pk_mul_f32 v[184:185], v[184:185], v[10:11] op_sel:[0,0] op_sel_hi:[1,0]
v_pk_mul_f32 v[186:187], v[186:187], v[10:11] op_sel:[0,0] op_sel_hi:[1,0]
v_cvt_pk_bf16_f32 v168, v168, v169
v_cvt_pk_bf16_f32 v169, v170, v171
v_cvt_pk_bf16_f32 v170, v184, v185
v_cvt_pk_bf16_f32 v171, v186, v187
v_pk_add_f32 v[172:173], v[172:173], v[44:45]
v_pk_add_f32 v[174:175], v[174:175], v[46:47]
s_waitcnt lgkmcnt(8)
v_pk_add_f32 v[188:189], v[188:189], v[60:61]
v_pk_add_f32 v[190:191], v[190:191], v[62:63]
M v[24:27], a[112:115], v[168:171], v[24:27]
v_pk_mul_f32 v[172:173], v[172:173], v[10:11] op_sel:[0,1] op_sel_hi:[1,1]
v_pk_mul_f32 v[174:175], v[174:175], v[10:11] op_sel:[0,1] op_sel_hi:[1,1]
v_pk_mul_f32 v[188:189], v[188:189], v[10:11] op_sel:[0,1] op_sel_hi:[1,1]
v_pk_mul_f32 v[190:191], v[190:191], v[10:11] op_sel:[0,1] op_sel_hi:[1,1]
v_cvt_pk_bf16_f32 v172, v172, v173
v_cvt_pk_bf16_f32 v173, v174, v175
v_cvt_pk_bf16_f32 v174, v188, v189
v_cvt_pk_bf16_f32 v175, v190, v191
s_waitcnt lgkmcnt(7)
v_pk_add_f32 v[192:193], v[192:193], v[64:65]
v_pk_add_f32 v[194:195], v[194:195], v[66:67]
s_waitcnt lgkmcnt(3)
v_pk_add_f32 v[208:209], v[208:209], v[80:81]
v_pk_add_f32 v[210:211], v[210:211], v[82:83]
M v[24:27], a[112:115], v[172:175], v[24:27]
v_pk_mul_f32 v[192:193], v[192:193], v[8:9] op_sel:[0,0] op_sel_hi:[1,0]
v_pk_mul_f32 v[194:195], v[194:195], v[8:9] op_sel:[0,0] op_sel_hi:[1,0]
v_pk_mul_f32 v[208:209], v[208:209], v[8:9] op_sel:[0,0] op_sel_hi:[1,0]
v_pk_mul_f32 v[210:211], v[210:211], v[8:9] op_sel:[0,0] op_sel_hi:[1,0]
v_cvt_pk_bf16_f32 v192, v192, v193
v_cvt_pk_bf16_f32 v193, v194, v195
v_cvt_pk_bf16_f32 v194, v208, v209
v_cvt_pk_bf16_f32 v195, v210, v211
v_pk_add_f32 v[196:197], v[196:197], v[68:69]
v_pk_add_f32 v[198:199], v[198:199], v[70:71]
s_waitcnt lgkmcnt(2)
v_pk_add_f32 v[212:213], v[212:213], v[84:85]
v_pk_add_f32 v[214:215], v[214:215], v[86:87]
M v[24:27], a[112:115], v[192:195], v[24:27]
v_pk_mul_f32 v[196:197], v[196:197], v[8:9] op_sel:[0,1] op_sel_hi:[1,1]
v_pk_mul_f32 v[198:199], v[198:199], v[8:9] op_sel:[0,1] op_sel_hi:[1,1]
v_pk_mul_f32 v[212:213], v[212:213], v[8:9] op_sel:[0,1] op_sel_hi:[1,1]
v_pk_mul_f32 v[214:215], v[214:215], v[8:9] op_sel:[0,1] op_sel_hi:[1,1]
v_cvt_pk_bf16_f32 v196, v196, v197
v_cvt_pk_bf16_f32 v197, v198, v199
v_cvt_pk_bf16_f32 v198, v212, v213
v_cvt_pk_bf16_f32 v199, v214, v215
v_pk_add_f32 v[200:201], v[200:201], v[72:73]
v_pk_add_f32 v[202:203], v[202:203], v[74:75]
s_waitcnt lgkmcnt(1)
v_pk_add_f32 v[216:217], v[216:217], v[88:89]
v_pk_add_f32 v[218:219], v[218:219], v[90:91]
M v[24:27], a[112:115], v[196:199], v[24:27]
v_pk_mul_f32 v[200:201], v[200:201], v[10:11] op_sel:[0,0] op_sel_hi:[1,0]
v_pk_mul_f32 v[202:203], v[202:203], v[10:11] op_sel:[0,0] op_sel_hi:[1,0]
v_pk_mul_f32 v[216:217], v[216:217], v[10:11] op_sel:[0,0] op_sel_hi:[1,0]
v_pk_mul_f32 v[218:219], v[218:219], v[10:11] op_sel:[0,0] op_sel_hi:[1,0]
v_cvt_pk_bf16_f32 v200, v200, v201
v_cvt_pk_bf16_f32 v201, v202, v203
v_cvt_pk_bf16_f32 v202, v216, v217
v_cvt_pk_bf16_f32 v203, v218, v219
v_pk_add_f32 v[204:205], v[204:205], v[76:77]
v_pk_add_f32 v[206:207], v[206:207], v[78:79]
s_waitcnt lgkmcnt(0)
v_pk_add_f32 v[220:221], v[220:221], v[92:93]
v_pk_add_f32 v[222:223], v[222:223], v[94:95]
M v[24:27], a[112:115], v[200:203], v[24:27]
v_pk_mul_f32 v[204:205], v[204:205], v[10:11] op_sel:[0,1] op_sel_hi:[1,1]
v_pk_mul_f32 v[206:207], v[206:207], v[10:11] op_sel:[0,1] op_sel_hi:[1,1]
v_pk_mul_f32 v[220:221], v[220:221], v[10:11] op_sel:[0,1] op_sel_hi:[1,1]
v_pk_mul_f32 v[222:223], v[222:223], v[10:11] op_sel:[0,1] op_sel_hi:[1,1]
v_cvt_pk_bf16_f32 v204, v204, v205
v_cvt_pk_bf16_f32 v205, v206, v207
v_cvt_pk_bf16_f32 v206, v220, v221
v_cvt_pk_bf16_f32 v207, v222, v223
s_nop 1
M v[24:27], a[112:115], v[204:207], v[24:27]
v_cmp_lt_u32 vcc, 0x3c000000, v12
s_nop 6
v_cmp_class_f32 s[40:41], v24, s64
s_nop 0
s_or_b64 vcc, vcc, s[40:41]
s_cbranch_vccnz Lbad_4
s_lshl_b32 s33, s35, 20
s_lshl_b32 s34, s20, 15
s_add_u32 s33, s33, s34
s_lshl_b32 s34, s23, 13
s_add_u32 s36, s33, s34
s_add_u32 s37, s36, 4096
s_add_u32 s38, s36, 16384
s_add_u32 s39, s36, 20480
buffer_store_dwordx4 v[160:163], v1, s[16:19], s36 offen offset:0 sc1
buffer_store_dwordx4 v[164:167], v1, s[16:19], s36 offen offset:2048 sc1
buffer_store_dwordx4 v[168:171], v1, s[16:19], s37 offen offset:0 sc1
buffer_store_dwordx4 v[172:175], v1, s[16:19], s37 offen offset:2048 sc1
buffer_store_dwordx4 v[192:195], v1, s[16:19], s36 offen offset:1024 sc1
buffer_store_dwordx4 v[196:199], v1, s[16:19], s36 offen offset:3072 sc1
buffer_store_dwordx4 v[200:203], v1, s[16:19], s37 offen offset:1024 sc1
buffer_store_dwordx4 v[204:207], v1, s[16:19], s37 offen offset:3072 sc1
s_branch Lfd_5
Lbad_4:
s_or_b32 s60, s60, 2
Lfd_5:
s_branch Lk2_chk
Lk2_mg1:
ds_write_b128 v2, v[160:163] offset:0
ds_write_b128 v2, v[164:167] offset:1024
ds_write_b128 v2, v[168:171] offset:2048
ds_write_b128 v2, v[172:175] offset:3072
ds_write_b128 v2, v[176:179] offset:4096
ds_write_b128 v2, v[180:183] offset:5120
ds_write_b128 v2, v[184:187] offset:6144
ds_write_b128 v2, v[188:191] offset:7168
ds_write_b128 v2, v[192:195] offset:8192
ds_write_b128 v2, v[196:199] offset:9216
ds_write_b128 v2, v[200:203] offset:10240
ds_write_b128 v2, v[204:207] offset:11264
ds_write_b128 v2, v[208:211] offset:12288
ds_write_b128 v2, v[212:215] offset:13312
ds_write_b128 v2, v[216:219] offset:14336
ds_write_b128 v2, v[220:223] offset:15360
s_waitcnt lgkmcnt(0)
s_barrier
ds_read_b128 v[28:31], v15
ds_read_b128 v[32:35], v3 offset:0
ds_read_b128 v[36:39], v3 offset:1024
ds_read_b128 v[40:43], v3 offset:2048
ds_read_b128 v[44:47], v3 offset:3072
ds_read_b128 v[48:51], v3 offset:4096
ds_read_b128 v[52:55], v3 offset:5120
ds_read_b128 v[56:59], v3 offset:6144
ds_read_b128 v[60:63], v3 offset:7168
ds_read_b128 v[64:67], v3 offset:8192
ds_read_b128 v[68:71], v3 offset:9216
ds_read_b128 v[72:75], v3 offset:10240
ds_read_b128 v[76:79], v3 offset:11264
ds_read_b128 v[80:83], v3 offset:12288
ds_read_b128 v[84:87], v3 offset:13312
ds_read_b128 v[88:91], v3 offset:14336
ds_read_b128 v[92:95], v3 offset:15360
s_waitcnt lgkmcnt(15)
v_add_f32 v20, v20, v28
v_add_f32 v21, v21, v29
v_add_f32 v22, v22, v30
v_add_f32 v23, v23, v31
s_sub_u32 s35, 15, s21
v_rcp_f32 v8, v20
v_rcp_f32 v9, v21
v_rcp_f32 v10, v22
v_rcp_f32 v11, v23
v_subrev_u32 v20, 0x21800000, v20
v_subrev_u32 v21, 0x21800000, v21
v_subrev_u32 v22, 0x21800000, v22
v_subrev_u32 v23, 0x21800000, v23
v_max_u32 v12, v20, v21
v_max3_u32 v12, v12, v22, v23
s_mov_b32 s64, 0x207
v_pk_add_f32 v[224:225], v[224:225], v[32:33]
v_pk_add_f32 v[226:227], v[226:227], v[34:35]
s_waitcnt lgkmcnt(11)
v_pk_add_f32 v[240:241], v[240:241], v[48:49]
v_pk_add_f32 v[242:243], v[242:243], v[50:51]
v_pk_mul_f32 v[224:225], v[224:225], v[8:9] op_sel:[0,0] op_sel_hi:[1,0]
v_pk_mul_f32 v[226:227], v[226:227], v[8:9] op_sel:[0,0] op_sel_hi:[1,0]
v_pk_mul_f32 v[240:241], v[240:241], v[8:9] op_sel:[0,0] op_sel_hi:[1,0]
v_pk_mul_f32 v[242:243], v[242:243], v[8:9] op_sel:[0,0] op_sel_hi:[1,0]
v_cvt_pk_bf16_f32 v224, v224, v225
v_cvt_pk_bf16_f32 v225, v226, v227
v_cvt_pk_bf16_f32 v226, v240, v241
v_cvt_pk_bf16_f32 v227, v242, v243
v_pk_add_f32 v[228:229], v[228:229], v[36:37]
v_pk_add_f32 v[230:231], v[230:231], v[38:39]
s_waitcnt lgkmcnt(10)
v_pk_add_f32 v[244:245], v[244:245], v[52:53]
v_pk_add_f32 v[246:247], v[246:247], v[54:55]
M v[24:27], a[112:115], v[224:227], 0
v_pk_mul_f32 v[228:229], v[228:229], v[8:9] op_sel:[0,1] op_sel_hi:[1,1]
v_pk_mul_f32 v[230:231], v[230:231], v[8:9] op_sel:[0,1] op_sel_hi:[1,1]
v_pk_mul_f32 v[244:245], v[244:245], v[8:9] op_sel:[0,1] op_sel_hi:[1,1]
v_pk_mul_f32 v[246:247], v[246:247], v[8:9] op_sel:[0,1] op_sel_hi:[1,1]
v_cvt_pk_bf16_f32 v228, v228, v229
v_cvt_pk_bf16_f32 v229, v230, v231
v_cvt_pk_bf16_f32 v230, v244, v245
v_cvt_pk_bf16_f32 v231, v246, v247
v_pk_add_f32 v[232:233], v[232:233], v[40:41]
v_pk_add_f32 v[234:235], v[234:235], v[42:43]
s_waitcnt lgkmcnt(9)
v_pk_add_f32 v[248:249], v[248:249], v[56:57]
v_pk_add_f32 v[250:251], v[250:251], v[58:59]
M v[24:27], a[112:115], v[228:231], v[24:27]
v_pk_mul_f32 v[232:233], v[232:233], v[10:11] op_sel:[0,0] op_sel_hi:[1,0]
v_pk_mul_f32 v[234:235], v[234:235], v[10:11] op_sel:[0,0] op_sel_hi:[1,0]
v_pk_mul_f32 v[248:249], v[248:249], v[10:11] op_sel:[0,0] op_sel_hi:[1,0]
v_pk_mul_f32 v[250:251], v[250:251], v[10:11] op_sel:[0,0] op_sel_hi:[1,0]
v_cvt_pk_bf16_f32 v232, v232, v233
v_cvt_pk_bf16_f32 v233, v234, v235
v_cvt_pk_bf16_f32 v234, v248, v249
v_cvt_pk_bf16_f32 v235, v250, v251
v_pk_add_f32 v[236:237], v[236:237], v[44:45]
v_pk_add_f32 v[238:239], v[238:239], v[46:47]
s_waitcnt lgkmcnt(8)
v_pk_add_f32 v[252:253], v[252:253], v[60:61]
v_pk_add_f32 v[254:255], v[254:255], v[62:63]
M v[24:27], a[112:115], v[232:235], v[24:27]
v_pk_mul_f32 v[236:237], v[236:237], v[10:11] op_sel:[0,1] op_sel_hi:[1,1]
v_pk_mul_f32 v[238:239], v[238:239], v[10:11] op_sel:[0,1] op_sel_hi:[1,1]
v_pk_mul_f32 v[252:253], v[252:253], v[10:11] op_sel:[0,1] op_sel_hi:[1,1]
v_pk_mul_f32 v[254:255], v[254:255], v[10:11] op_sel:[0,1] op_sel_hi:[1,1]
v_cvt_pk_bf16_f32 v236, v236, v237
v_cvt_pk_bf16_f32 v237, v238, v239
v_cvt_pk_bf16_f32 v238, v252, v253
v_cvt_pk_bf16_f32 v239, v254, v255
v_accvgpr_read_b32 v32, a64
v_accvgpr_read_b32 v33, a65
v_accvgpr_read_b32 v34, a66
v_accvgpr_read_b32 v35, a67
s_waitcnt lgkmcnt(7)
v_pk_add_f32 v[32:33], v[32:33], v[64:65]
v_pk_add_f32 v[34:35], v[34:35], v[66:67]
v_accvgpr_read_b32 v48, a80
v_accvgpr_read_b32 v49, a81
v_accvgpr_read_b32 v50, a82
v_accvgpr_read_b32 v51, a83
s_waitcnt lgkmcnt(3)
v_pk_add_f32 v[48:49], v[48:49], v[80:81]
v_pk_add_f32 v[50:51], v[50:51], v[82:83]
M v[24:27], a[112:115], v[236:239], v[24:27]
v_pk_mul_f32 v[32:33], v[32:33], v[8:9] op_sel:[0,0] op_sel_hi:[1,0]
v_pk_mul_f32 v[34:35], v[34:35], v[8:9] op_sel:[0,0] op_sel_hi:[1,0]
v_pk_mul_f32 v[48:49], v[48:49], v[8:9] op_sel:[0,0] op_sel_hi:[1,0]
v_pk_mul_f32 v[50:51], v[50:51], v[8:9] op_sel:[0,0] op_sel_hi:[1,0]
v_cvt_pk_bf16_f32 v32, v32, v33
v_cvt_pk_bf16_f32 v33, v34, v35
v_cvt_pk_bf16_f32 v34, v48, v49
v_cvt_pk_bf16_f32 v35, v50, v51
v_accvgpr_read_b32 v240, a68
v_accvgpr_read_b32 v241, a69
v_accvgpr_read_b32 v242, a70
v_accvgpr_read_b32 v243, a71
v_pk_add_f32 v[240:241], v[240:241], v[68:69]
v_pk_add_f32 v[242:243], v[242:243], v[70:71]
v_accvgpr_read_b32 v36, a84
v_accvgpr_read_b32 v37, a85
v_accvgpr_read_b32 v38, a86
v_accvgpr_read_b32 v39, a87
s_waitcnt lgkmcnt(2)
v_pk_add_f32 v[36:37], v[36:37], v[84:85]
v_pk_add_f32 v[38:39], v[38:39], v[86:87]
M v[24:27], a[112:115], v[32:35], v[24:27]
v_pk_mul_f32 v[240:241], v[240:241], v[8:9] op_sel:[0,1] op_sel_hi:[1,1]
v_pk_mul_f32 v[242:243], v[242:243], v[8:9] op_sel:[0,1] op_sel_hi:[1,1]
v_pk_mul_f32 v[36:37], v[36:37], v[8:9] op_sel:[0,1] op_sel_hi:[1,1]
v_pk_mul_f32 v[38:39], v[38:39], v[8:9] op_sel:[0,1] op_sel_hi:[1,1]
v_cvt_pk_bf16_f32 v240, v240, v241
v_cvt_pk_bf16_f32 v241, v242, v243
v_cvt_pk_bf16_f32 v242, v36, v37
v_cvt_pk_bf16_f32 v243, v38, v39
v_accvgpr_read_b32 v52, a72
v_accvgpr_read_b32 v53, a73
v_accvgpr_read_b32 v54, a74
v_accvgpr_read_b32 v55, a75
v_pk_add_f32 v[52:53], v[52:53], v[72:73]
v_pk_add_f32 v[54:55], v[54:55], v[74:75]
v_accvgpr_read_b32 v244, a88
v_accvgpr_read_b32 v245, a89
v_accvgpr_read_b32 v246, a90
v_accvgpr_read_b32 v247, a91
s_waitcnt lgkmcnt(1)
v_pk_add_f32 v[244:245], v[244:245], v[88:89]
v_pk_add_f32 v[246:247], v[246:247], v[90:91]
M v[24:27], a[112:115], v[240:243], v[24:27]
v_pk_mul_f32 v[52:53], v[52:53], v[10:11] op_sel:[0,0] op_sel_hi:[1,0]
v_pk_mul_f32 v[54:55], v[54:55], v[10:11] op_sel:[0,0] op_sel_hi:[1,0]
v_pk_mul_f32 v[244:245], v[244:245], v[10:11] op_sel:[0,0] op_sel_hi:[1,0]
v_pk_mul_f32 v[246:247], v[246:247], v[10:11] op_sel:[0,0] op_sel_hi:[1,0]
v_cvt_pk_bf16_f32 v52, v52, v53
v_cvt_pk_bf16_f32 v53, v54, v55
v_cvt_pk_bf16_f32 v54, v244, v245
v_cvt_pk_bf16_f32 v55, v246, v247
v_accvgpr_read_b32 v40, a76
v_accvgpr_read_b32 v41, a77
v_accvgpr_read_b32 v42, a78
v_accvgpr_read_b32 v43, a79
v_pk_add_f32 v[40:41], v[40:41], v[76:77]
v_pk_add_f32 v[42:43], v[42:43], v[78:79]
v_accvgpr_read_b32 v56, a92
v_accvgpr_read_b32 v57, a93
v_accvgpr_read_b32 v58, a94
v_accvgpr_read_b32 v59, a95
s_waitcnt lgkmcnt(0)
v_pk_add_f32 v[56:57], v[56:57], v[92:93]
v_pk_add_f32 v[58:59], v[58:59], v[94:95]
M v[24:27], a[112:115], v[52:55], v[24:27]
v_pk_mul_f32 v[40:41], v[40:41], v[10:11] op_sel:[0,1] op_sel_hi:[1,1]
v_pk_mul_f32 v[42:43], v[42:43], v[10:11] op_sel:[0,1] op_sel_hi:[1,1]
v_pk_mul_f32 v[56:57], v[56:57], v[10:11] op_sel:[0,1] op_sel_hi:[1,1]
v_pk_mul_f32 v[58:59], v[58:59], v[10:11] op_sel:[0,1] op_sel_hi:[1,1]
v_cvt_pk_bf16_f32 v40, v40, v41
v_cvt_pk_bf16_f32 v41, v42, v43
v_cvt_pk_bf16_f32 v42, v56, v57
v_cvt_pk_bf16_f32 v43, v58, v59
s_nop 1
M v[24:27], a[112:115], v[40:43], v[24:27]
v_cmp_lt_u32 vcc, 0x3c000000, v12
s_nop 6
v_cmp_class_f32 s[40:41], v24, s64
s_nop 0
s_or_b64 vcc, vcc, s[40:41]
s_cbranch_vccnz Lbad_6
s_lshl_b32 s33, s35, 20
s_lshl_b32 s34, s20, 15
s_add_u32 s33, s33, s34
s_lshl_b32 s34, s23, 13
s_add_u32 s36, s33, s34
s_add_u32 s37, s36, 4096
s_add_u32 s38, s36, 16384
s_add_u32 s39, s36, 20480
buffer_store_dwordx4 v[224:227], v1, s[16:19], s38 offen offset:0 sc1
buffer_store_dwordx4 v[228:231], v1, s[16:19], s38 offen offset:2048 sc1
buffer_store_dwordx4 v[232:235], v1, s[16:19], s39 offen offset:0 sc1
buffer_store_dwordx4 v[236:239], v1, s[16:19], s39 offen offset:2048 sc1
buffer_store_dwordx4 v[32:35], v1, s[16:19], s38 offen offset:1024 sc1
buffer_store_dwordx4 v[240:243], v1, s[16:19], s38 offen offset:3072 sc1
buffer_store_dwordx4 v[52:55], v1, s[16:19], s39 offen offset:1024 sc1
buffer_store_dwordx4 v[40:43], v1, s[16:19], s39 offen offset:3072 sc1
s_branch Lfd_7
Lbad_6:
s_or_b32 s60, s60, 2
Lfd_7:
Lk2_chk:
s_cmp_eq_u32 s60, 0
s_cbranch_scc1 Lk2_done
s_sub_u32 s56, 15, s21
s_lshl_b32 s33, s24, 1
s_lshl_b32 s61, 3, s33
s_and_b32 s34, s60, 2
s_bitcmp1_b32 s60, 0
s_cselect_b32 s56, s21, s56
s_cselect_b32 s61, 15, s61
s_cselect_b32 s60, s34, 0
s_waitcnt vmcnt(0)
s_lshl_b32 s33, s20, 7
s_lshl_b32 s34, s56, 3
s_add_u32 s33, s33, s34
s_lshl_b32 s34, s23, 2
s_add_u32 s33, s33, s34
s_lshl_b32 s33, s33, 12
buffer_load_dwordx4 a[0:3], v1, s[8:11], s33 offen offset:0 sc1
buffer_load_dwordx4 a[4:7], v1, s[8:11], s33 offen offset:1024 sc1
buffer_load_dwordx4 a[8:11], v1, s[8:11], s33 offen offset:2048 sc1
buffer_load_dwordx4 a[12:15], v1, s[8:11], s33 offen offset:3072 sc1
s_add_u32 s33, s33, 4096
buffer_load_dwordx4 a[16:19], v1, s[8:11], s33 offen offset:0 sc1
buffer_load_dwordx4 a[20:23], v1, s[8:11], s33 offen offset:1024 sc1
buffer_load_dwordx4 a[24:27], v1, s[8:11], s33 offen offset:2048 sc1
buffer_load_dwordx4 a[28:31], v1, s[8:11], s33 offen offset:3072 sc1
s_add_u32 s33, s33, 4096
buffer_load_dwordx4 a[32:35], v1, s[8:11], s33 offen offset:0 sc1
buffer_load_dwordx4 a[36:39], v1, s[8:11], s33 offen offset:1024 sc1
buffer_load_dwordx4 a[40:43], v1, s[8:11], s33 offen offset:2048 sc1
buffer_load_dwordx4 a[44:47], v1, s[8:11], s33 offen offset:3072 sc1
s_add_u32 s33, s33, 4096
buffer_load_dwordx4 a[48:51], v1, s[8:11], s33 offen offset:0 sc1
buffer_load_dwordx4 a[52:55], v1, s[8:11], s33 offen offset:1024 sc1
buffer_load_dwordx4 a[56:59], v1, s[8:11], s33 offen offset:2048 sc1
buffer_load_dwordx4 a[60:63], v1, s[8:11], s33 offen offset:3072 sc1
v_accvgpr_write_b32 a64, 0
v_accvgpr_write_b32 a65, 0
v_accvgpr_write_b32 a66, 0
v_accvgpr_write_b32 a67, 0
v_accvgpr_write_b32 a68, 0
v_accvgpr_write_b32 a69, 0
v_accvgpr_write_b32 a70, 0
v_accvgpr_write_b32 a71, 0
v_accvgpr_write_b32 a72, 0
v_accvgpr_write_b32 a73, 0
v_accvgpr_write_b32 a74, 0
v_accvgpr_write_b32 a75, 0
v_accvgpr_write_b32 a76, 0
v_accvgpr_write_b32 a77, 0
v_accvgpr_write_b32 a78, 0
v_accvgpr_write_b32 a79, 0
v_accvgpr_write_b32 a80, 0
v_accvgpr_write_b32 a81, 0
v_accvgpr_write_b32 a82, 0
v_accvgpr_write_b32 a83, 0
v_accvgpr_write_b32 a84, 0
v_accvgpr_write_b32 a85, 0
v_accvgpr_write_b32 a86, 0
v_accvgpr_write_b32 a87, 0
v_accvgpr_write_b32 a88, 0
v_accvgpr_write_b32 a89, 0
v_accvgpr_write_b32 a90, 0
v_accvgpr_write_b32 a91, 0
v_accvgpr_write_b32 a92, 0
v_accvgpr_write_b32 a93, 0
v_accvgpr_write_b32 a94, 0
v_accvgpr_write_b32 a95, 0
v_accvgpr_write_b32 a96, 0
v_accvgpr_write_b32 a97, 0
v_accvgpr_write_b32 a98, 0
v_accvgpr_write_b32 a99, 0
v_accvgpr_write_b32 a100, 0
v_accvgpr_write_b32 a101, 0
v_accvgpr_write_b32 a102, 0
v_accvgpr_write_b32 a103, 0
v_accvgpr_write_b32 a104, 0
v_accvgpr_write_b32 a105, 0
v_accvgpr_write_b32 a106, 0
v_accvgpr_write_b32 a107, 0
v_accvgpr_write_b32 a108, 0
v_accvgpr_write_b32 a109, 0
v_accvgpr_write_b32 a110, 0
v_accvgpr_write_b32 a111, 0
v_mov_b32 v160, 0
v_mov_b32 v161, 0
v_mov_b32 v162, 0
v_mov_b32 v163, 0
v_mov_b32 v164, 0
v_mov_b32 v165, 0
v_mov_b32 v166, 0
v_mov_b32 v167, 0
v_mov_b32 v168, 0
v_mov_b32 v169, 0
v_mov_b32 v170, 0
v_mov_b32 v171, 0
v_mov_b32 v172, 0
v_mov_b32 v173, 0
v_mov_b32 v174, 0
v_mov_b32 v175, 0
v_mov_b32 v176, 0
v_mov_b32 v177, 0
v_mov_b32 v178, 0
v_mov_b32 v179, 0
v_mov_b32 v180, 0
v_mov_b32 v181, 0
v_mov_b32 v182, 0
v_mov_b32 v183, 0
v_mov_b32 v184, 0
v_mov_b32 v185, 0
v_mov_b32 v186, 0
v_mov_b32 v187, 0
v_mov_b32 v188, 0
v_mov_b32 v189, 0
v_mov_b32 v190, 0
v_mov_b32 v191, 0
v_mov_b32 v192, 0
v_mov_b32 v193, 0
v_mov_b32 v194, 0
v_mov_b32 v195, 0
v_mov_b32 v196, 0
v_mov_b32 v197, 0
v_mov_b32 v198, 0
v_mov_b32 v199, 0
v_mov_b32 v200, 0
v_mov_b32 v201, 0
v_mov_b32 v202, 0
v_mov_b32 v203, 0
v_mov_b32 v204, 0
v_mov_b32 v205, 0
v_mov_b32 v206, 0
v_mov_b32 v207, 0
v_mov_b32 v208, 0
v_mov_b32 v209, 0
v_mov_b32 v210, 0
v_mov_b32 v211, 0
v_mov_b32 v212, 0
v_mov_b32 v213, 0
v_mov_b32 v214, 0
v_mov_b32 v215, 0
v_mov_b32 v216, 0
v_mov_b32 v217, 0
v_mov_b32 v218, 0
v_mov_b32 v219, 0
v_mov_b32 v220, 0
v_mov_b32 v221, 0
v_mov_b32 v222, 0
v_mov_b32 v223, 0
v_mov_b32 v224, 0
v_mov_b32 v225, 0
v_mov_b32 v226, 0
v_mov_b32 v227, 0
v_mov_b32 v228, 0
v_mov_b32 v229, 0
v_mov_b32 v230, 0
v_mov_b32 v231, 0
v_mov_b32 v232, 0
v_mov_b32 v233, 0
v_mov_b32 v234, 0
v_mov_b32 v235, 0
v_mov_b32 v236, 0
v_mov_b32 v237, 0
v_mov_b32 v238, 0
v_mov_b32 v239, 0
v_mov_b32 v240, 0
v_mov_b32 v241, 0
v_mov_b32 v242, 0
v_mov_b32 v243, 0
v_mov_b32 v244, 0
v_mov_b32 v245, 0
v_mov_b32 v246, 0
v_mov_b32 v247, 0
v_mov_b32 v248, 0
v_mov_b32 v249, 0
v_mov_b32 v250, 0
v_mov_b32 v251, 0
v_mov_b32 v252, 0
v_mov_b32 v253, 0
v_mov_b32 v254, 0
v_mov_b32 v255, 0
v_mov_b32 v8, v4
v_mov_b32 v9, v4
v_mov_b32 v10, v4
v_mov_b32 v11, v4
s_lshl_b32 s57, s20, 20
s_lshl_b32 s58, s56, 7
s_lshl_b32 s59, s56, 1
s_add_u32 s59, s59, 2
Lslow_8:
s_add_u32 s35, s57, 0
buffer_load_dwordx4 v[96:99], v1, s[12:15], s35 offen offset:0 sc1
buffer_load_dwordx4 v[100:103], v1, s[12:15], s35 offen offset:1024 sc1
buffer_load_dwordx4 v[104:107], v1, s[12:15], s35 offen offset:2048 sc1
buffer_load_dwordx4 v[108:111], v1, s[12:15], s35 offen offset:3072 sc1
s_add_u32 s35, s57, 4096
buffer_load_dwordx4 v[112:115], v1, s[12:15], s35 offen offset:0 sc1
buffer_load_dwordx4 v[116:119], v1, s[12:15], s35 offen offset:1024 sc1
buffer_load_dwordx4 v[120:123], v1, s[12:15], s35 offen offset:2048 sc1
buffer_load_dwordx4 v[124:127], v1, s[12:15], s35 offen offset:3072 sc1
s_add_u32 s35, s57, 8192
buffer_load_dwordx4 v[128:131], v1, s[12:15], s35 offen offset:0 sc1
buffer_load_dwordx4 v[132:135], v1, s[12:15], s35 offen offset:1024 sc1
buffer_load_dwordx4 v[136:139], v1, s[12:15], s35 offen offset:2048 sc1
buffer_load_dwordx4 v[140:143], v1, s[12:15], s35 offen offset:3072 sc1
s_add_u32 s35, s57, 12288
buffer_load_dwordx4 v[144:147], v1, s[12:15], s35 offen offset:0 sc1
buffer_load_dwordx4 v[148:151], v1, s[12:15], s35 offen offset:1024 sc1
buffer_load_dwordx4 v[152:155], v1, s[12:15], s35 offen offset:2048 sc1
buffer_load_dwordx4 v[156:159], v1, s[12:15], s35 offen offset:3072 sc1
s_lshl_b32 s33, s23, 6
s_add_i32 s33, s33, s58
s_cmp_gt_i32 s33, 0
s_cselect_b32 s34, 0, 0xf149f2ca
s_cmp_lt_i32 s33, 0
s_cselect_b32 s33, 0xf149f2ca, 0
v_mov_b32 v20, s34
v_mov_b32 v21, s34
v_mov_b32 v22, s34
v_mov_b32 v23, s34
v_mov_b32 v28, s33
v_mov_b32 v29, s33
v_mov_b32 v30, s33
v_mov_b32 v31, s33
v_med3_f32 v24, v16, v20, v28
v_med3_f32 v25, v17, v20, v28
v_med3_f32 v26, v18, v20, v28
v_med3_f32 v27, v19, v20, v28
s_waitcnt vmcnt(0)
s_nop 0
M v[32:35], v[96:99], a[0:3], v[24:27]
M v[32:35], v[100:103], a[4:7], v[32:35]
M v[32:35], v[104:107], a[8:11], v[32:35]
M v[32:35], v[108:111], a[12:15], v[32:35]
M v[36:39], v[96:99], a[16:19], v[28:31]
M v[36:39], v[100:103], a[20:23], v[36:39]
M v[36:39], v[104:107], a[24:27], v[36:39]
M v[36:39], v[108:111], a[28:31], v[36:39]
M v[40:43], v[96:99], a[32:35], v[28:31]
M v[40:43], v[100:103], a[36:39], v[40:43]
M v[40:43], v[104:107], a[40:43], v[40:43]
M v[40:43], v[108:111], a[44:47], v[40:43]
M v[44:47], v[96:99], a[48:51], v[28:31]
M v[44:47], v[100:103], a[52:55], v[44:47]
M v[44:47], v[104:107], a[56:59], v[44:47]
M v[44:47], v[108:111], a[60:63], v[44:47]
M v[48:51], v[112:115], a[0:3], v[20:23]
M v[48:51], v[116:119], a[4:7], v[48:51]
M v[48:51], v[120:123], a[8:11], v[48:51]
M v[48:51], v[124:127], a[12:15], v[48:51]
M v[52:55], v[112:115], a[16:19], v[24:27]
M v[52:55], v[116:119], a[20:23], v[52:55]
M v[52:55], v[120:123], a[24:27], v[52:55]
M v[52:55], v[124:127], a[28:31], v[52:55]
M v[56:59], v[112:115], a[32:35], v[28:31]
M v[56:59], v[116:119], a[36:39], v[56:59]
M v[56:59], v[120:123], a[40:43], v[56:59]
M v[56:59], v[124:127], a[44:47], v[56:59]
M v[60:63], v[112:115], a[48:51], v[28:31]
M v[60:63], v[116:119], a[52:55], v[60:63]
M v[60:63], v[120:123], a[56:59], v[60:63]
M v[60:63], v[124:127], a[60:63], v[60:63]
M v[64:67], v[128:131], a[0:3], v[20:23]
M v[64:67], v[132:135], a[4:7], v[64:67]
M v[64:67], v[136:139], a[8:11], v[64:67]
M v[64:67], v[140:143], a[12:15], v[64:67]
M v[68:71], v[128:131], a[16:19], v[20:23]
M v[68:71], v[132:135], a[20:23], v[68:71]
M v[68:71], v[136:139], a[24:27], v[68:71]
M v[68:71], v[140:143], a[28:31], v[68:71]
M v[72:75], v[128:131], a[32:35], v[24:27]
M v[72:75], v[132:135], a[36:39], v[72:75]
M v[72:75], v[136:139], a[40:43], v[72:75]
M v[72:75], v[140:143], a[44:47], v[72:75]
M v[76:79], v[128:131], a[48:51], v[28:31]
M v[76:79], v[132:135], a[52:55], v[76:79]
M v[76:79], v[136:139], a[56:59], v[76:79]
M v[76:79], v[140:143], a[60:63], v[76:79]
M v[80:83], v[144:147], a[0:3], v[20:23]
M v[80:83], v[148:151], a[4:7], v[80:83]
M v[80:83], v[152:155], a[8:11], v[80:83]
M v[80:83], v[156:159], a[12:15], v[80:83]
M v[84:87], v[144:147], a[16:19], v[20:23]
M v[84:87], v[148:151], a[20:23], v[84:87]
M v[84:87], v[152:155], a[24:27], v[84:87]
M v[84:87], v[156:159], a[28:31], v[84:87]
M v[88:91], v[144:147], a[32:35], v[20:23]
M v[88:91], v[148:151], a[36:39], v[88:91]
M v[88:91], v[152:155], a[40:43], v[88:91]
M v[88:91], v[156:159], a[44:47], v[88:91]
M v[92:95], v[144:147], a[48:51], v[24:27]
M v[92:95], v[148:151], a[52:55], v[92:95]
M v[92:95], v[152:155], a[56:59], v[92:95]
M v[92:95], v[156:159], a[60:63], v[92:95]
s_nop 7
s_add_u32 s35, s57, 16384
buffer_load_dwordx4 v[96:99], v1, s[12:15], s35 offen offset:0 sc1
buffer_load_dwordx4 v[100:103], v1, s[12:15], s35 offen offset:1024 sc1
buffer_load_dwordx4 v[104:107], v1, s[12:15], s35 offen offset:2048 sc1
buffer_load_dwordx4 v[108:111], v1, s[12:15], s35 offen offset:3072 sc1
s_add_u32 s35, s57, 20480
buffer_load_dwordx4 v[112:115], v1, s[12:15], s35 offen offset:0 sc1
buffer_load_dwordx4 v[116:119], v1, s[12:15], s35 offen offset:1024 sc1
buffer_load_dwordx4 v[120:123], v1, s[12:15], s35 offen offset:2048 sc1
buffer_load_dwordx4 v[124:127], v1, s[12:15], s35 offen offset:3072 sc1
s_add_u32 s35, s57, 24576
buffer_load_dwordx4 v[128:131], v1, s[12:15], s35 offen offset:0 sc1
buffer_load_dwordx4 v[132:135], v1, s[12:15], s35 offen offset:1024 sc1
buffer_load_dwordx4 v[136:139], v1, s[12:15], s35 offen offset:2048 sc1
buffer_load_dwordx4 v[140:143], v1, s[12:15], s35 offen offset:3072 sc1
s_add_u32 s35, s57, 28672
buffer_load_dwordx4 v[144:147], v1, s[12:15], s35 offen offset:0 sc1
buffer_load_dwordx4 v[148:151], v1, s[12:15], s35 offen offset:1024 sc1
buffer_load_dwordx4 v[152:155], v1, s[12:15], s35 offen offset:2048 sc1
buffer_load_dwordx4 v[156:159], v1, s[12:15], s35 offen offset:3072 sc1
v_max3_f32 v13, v32, v33, v8
v_max3_f32 v13, v13, v34, v35
v_max3_f32 v13, v13, v48, v49
v_max3_f32 v13, v13, v50, v51
v_max3_f32 v13, v13, v64, v65
v_max3_f32 v13, v13, v66, v67
v_max3_f32 v13, v13, v80, v81
v_max3_f32 v13, v13, v82, v83
v_mov_b32 v14, v13
s_nop 1
v_permlane16_swap_b32 v13, v14
v_max_f32 v13, v13, v14
v_mov_b32 v14, v13
s_nop 1
v_permlane32_swap_b32 v13, v14
v_max_f32 v13, v13, v14
v_sub_f32 v12, v8, v13
v_exp_f32 v12, v12
v_mov_b32 v8, v13
v_sub_f32 v32, v32, v13
v_sub_f32 v33, v33, v13
v_sub_f32 v34, v34, v13
v_sub_f32 v35, v35, v13
v_sub_f32 v48, v48, v13
v_sub_f32 v49, v49, v13
v_sub_f32 v50, v50, v13
v_sub_f32 v51, v51, v13
v_sub_f32 v64, v64, v13
v_sub_f32 v65, v65, v13
v_sub_f32 v66, v66, v13
v_sub_f32 v67, v67, v13
v_sub_f32 v80, v80, v13
v_sub_f32 v81, v81, v13
v_sub_f32 v82, v82, v13
v_sub_f32 v83, v83, v13
v_mul_f32 v160, v160, v12
v_mul_f32 v161, v161, v12
v_mul_f32 v162, v162, v12
v_mul_f32 v163, v163, v12
v_mul_f32 v176, v176, v12
v_mul_f32 v177, v177, v12
v_mul_f32 v178, v178, v12
v_mul_f32 v179, v179, v12
v_mul_f32 v192, v192, v12
v_mul_f32 v193, v193, v12
v_mul_f32 v194, v194, v12
v_mul_f32 v195, v195, v12
v_mul_f32 v208, v208, v12
v_mul_f32 v209, v209, v12
v_mul_f32 v210, v210, v12
v_mul_f32 v211, v211, v12
v_mul_f32 v224, v224, v12
v_mul_f32 v225, v225, v12
v_mul_f32 v226, v226, v12
v_mul_f32 v227, v227, v12
v_mul_f32 v240, v240, v12
v_mul_f32 v241, v241, v12
v_mul_f32 v242, v242, v12
v_mul_f32 v243, v243, v12
v_accvgpr_read_b32 v14, a64
v_mul_f32 v14, v14, v12
v_accvgpr_write_b32 a64, v14
v_accvgpr_read_b32 v14, a65
v_mul_f32 v14, v14, v12
v_accvgpr_write_b32 a65, v14
v_accvgpr_read_b32 v14, a66
v_mul_f32 v14, v14, v12
v_accvgpr_write_b32 a66, v14
v_accvgpr_read_b32 v14, a67
v_mul_f32 v14, v14, v12
v_accvgpr_write_b32 a67, v14
v_accvgpr_read_b32 v14, a80
v_mul_f32 v14, v14, v12
v_accvgpr_write_b32 a80, v14
v_accvgpr_read_b32 v14, a81
v_mul_f32 v14, v14, v12
v_accvgpr_write_b32 a81, v14
v_accvgpr_read_b32 v14, a82
v_mul_f32 v14, v14, v12
v_accvgpr_write_b32 a82, v14
v_accvgpr_read_b32 v14, a83
v_mul_f32 v14, v14, v12
v_accvgpr_write_b32 a83, v14
v_accvgpr_read_b32 v14, a96
v_mul_f32 v14, v14, v12
v_accvgpr_write_b32 a96, v14
v_accvgpr_read_b32 v14, a97
v_mul_f32 v14, v14, v12
v_accvgpr_write_b32 a97, v14
v_accvgpr_read_b32 v14, a98
v_mul_f32 v14, v14, v12
v_accvgpr_write_b32 a98, v14
v_accvgpr_read_b32 v14, a99
v_mul_f32 v14, v14, v12
v_accvgpr_write_b32 a99, v14
v_max3_f32 v13, v36, v37, v9
v_max3_f32 v13, v13, v38, v39
v_max3_f32 v13, v13, v52, v53
v_max3_f32 v13, v13, v54, v55
v_max3_f32 v13, v13, v68, v69
v_max3_f32 v13, v13, v70, v71
v_max3_f32 v13, v13, v84, v85
v_max3_f32 v13, v13, v86, v87
v_mov_b32 v14, v13
s_nop 1
v_permlane16_swap_b32 v13, v14
v_max_f32 v13, v13, v14
v_mov_b32 v14, v13
s_nop 1
v_permlane32_swap_b32 v13, v14
v_max_f32 v13, v13, v14
v_sub_f32 v12, v9, v13
v_exp_f32 v12, v12
v_mov_b32 v9, v13
v_sub_f32 v36, v36, v13
v_sub_f32 v37, v37, v13
v_sub_f32 v38, v38, v13
v_sub_f32 v39, v39, v13
v_sub_f32 v52, v52, v13
v_sub_f32 v53, v53, v13
v_sub_f32 v54, v54, v13
v_sub_f32 v55, v55, v13
v_sub_f32 v68, v68, v13
v_sub_f32 v69, v69, v13
v_sub_f32 v70, v70, v13
v_sub_f32 v71, v71, v13
v_sub_f32 v84, v84, v13
v_sub_f32 v85, v85, v13
v_sub_f32 v86, v86, v13
v_sub_f32 v87, v87, v13
v_mul_f32 v164, v164, v12
v_mul_f32 v165, v165, v12
v_mul_f32 v166, v166, v12
v_mul_f32 v167, v167, v12
v_mul_f32 v180, v180, v12
v_mul_f32 v181, v181, v12
v_mul_f32 v182, v182, v12
v_mul_f32 v183, v183, v12
v_mul_f32 v196, v196, v12
v_mul_f32 v197, v197, v12
v_mul_f32 v198, v198, v12
v_mul_f32 v199, v199, v12
v_mul_f32 v212, v212, v12
v_mul_f32 v213, v213, v12
v_mul_f32 v214, v214, v12
v_mul_f32 v215, v215, v12
v_mul_f32 v228, v228, v12
v_mul_f32 v229, v229, v12
v_mul_f32 v230, v230, v12
v_mul_f32 v231, v231, v12
v_mul_f32 v244, v244, v12
v_mul_f32 v245, v245, v12
v_mul_f32 v246, v246, v12
v_mul_f32 v247, v247, v12
v_accvgpr_read_b32 v14, a68
v_mul_f32 v14, v14, v12
v_accvgpr_write_b32 a68, v14
v_accvgpr_read_b32 v14, a69
v_mul_f32 v14, v14, v12
v_accvgpr_write_b32 a69, v14
v_accvgpr_read_b32 v14, a70
v_mul_f32 v14, v14, v12
v_accvgpr_write_b32 a70, v14
v_accvgpr_read_b32 v14, a71
v_mul_f32 v14, v14, v12
v_accvgpr_write_b32 a71, v14
v_accvgpr_read_b32 v14, a84
v_mul_f32 v14, v14, v12
v_accvgpr_write_b32 a84, v14
v_accvgpr_read_b32 v14, a85
v_mul_f32 v14, v14, v12
v_accvgpr_write_b32 a85, v14
v_accvgpr_read_b32 v14, a86
v_mul_f32 v14, v14, v12
v_accvgpr_write_b32 a86, v14
v_accvgpr_read_b32 v14, a87
v_mul_f32 v14, v14, v12
v_accvgpr_write_b32 a87, v14
v_accvgpr_read_b32 v14, a100
v_mul_f32 v14, v14, v12
v_accvgpr_write_b32 a100, v14
v_accvgpr_read_b32 v14, a101
v_mul_f32 v14, v14, v12
v_accvgpr_write_b32 a101, v14
v_accvgpr_read_b32 v14, a102
v_mul_f32 v14, v14, v12
v_accvgpr_write_b32 a102, v14
v_accvgpr_read_b32 v14, a103
v_mul_f32 v14, v14, v12
v_accvgpr_write_b32 a103, v14
v_max3_f32 v13, v40, v41, v10
v_max3_f32 v13, v13, v42, v43
v_max3_f32 v13, v13, v56, v57
v_max3_f32 v13, v13, v58, v59
v_max3_f32 v13, v13, v72, v73
v_max3_f32 v13, v13, v74, v75
v_max3_f32 v13, v13, v88, v89
v_max3_f32 v13, v13, v90, v91
v_mov_b32 v14, v13
s_nop 1
v_permlane16_swap_b32 v13, v14
v_max_f32 v13, v13, v14
v_mov_b32 v14, v13
s_nop 1
v_permlane32_swap_b32 v13, v14
v_max_f32 v13, v13, v14
v_sub_f32 v12, v10, v13
v_exp_f32 v12, v12
v_mov_b32 v10, v13
v_sub_f32 v40, v40, v13
v_sub_f32 v41, v41, v13
v_sub_f32 v42, v42, v13
v_sub_f32 v43, v43, v13
v_sub_f32 v56, v56, v13
v_sub_f32 v57, v57, v13
v_sub_f32 v58, v58, v13
v_sub_f32 v59, v59, v13
v_sub_f32 v72, v72, v13
v_sub_f32 v73, v73, v13
v_sub_f32 v74, v74, v13
v_sub_f32 v75, v75, v13
v_sub_f32 v88, v88, v13
v_sub_f32 v89, v89, v13
v_sub_f32 v90, v90, v13
v_sub_f32 v91, v91, v13
v_mul_f32 v168, v168, v12
v_mul_f32 v169, v169, v12
v_mul_f32 v170, v170, v12
v_mul_f32 v171, v171, v12
v_mul_f32 v184, v184, v12
v_mul_f32 v185, v185, v12
v_mul_f32 v186, v186, v12
v_mul_f32 v187, v187, v12
v_mul_f32 v200, v200, v12
v_mul_f32 v201, v201, v12
v_mul_f32 v202, v202, v12
v_mul_f32 v203, v203, v12
v_mul_f32 v216, v216, v12
v_mul_f32 v217, v217, v12
v_mul_f32 v218, v218, v12
v_mul_f32 v219, v219, v12
v_mul_f32 v232, v232, v12
v_mul_f32 v233, v233, v12
v_mul_f32 v234, v234, v12
v_mul_f32 v235, v235, v12
v_mul_f32 v248, v248, v12
v_mul_f32 v249, v249, v12
v_mul_f32 v250, v250, v12
v_mul_f32 v251, v251, v12
v_accvgpr_read_b32 v14, a72
v_mul_f32 v14, v14, v12
v_accvgpr_write_b32 a72, v14
v_accvgpr_read_b32 v14, a73
v_mul_f32 v14, v14, v12
v_accvgpr_write_b32 a73, v14
v_accvgpr_read_b32 v14, a74
v_mul_f32 v14, v14, v12
v_accvgpr_write_b32 a74, v14
v_accvgpr_read_b32 v14, a75
v_mul_f32 v14, v14, v12
v_accvgpr_write_b32 a75, v14
v_accvgpr_read_b32 v14, a88
v_mul_f32 v14, v14, v12
v_accvgpr_write_b32 a88, v14
v_accvgpr_read_b32 v14, a89
v_mul_f32 v14, v14, v12
v_accvgpr_write_b32 a89, v14
v_accvgpr_read_b32 v14, a90
v_mul_f32 v14, v14, v12
v_accvgpr_write_b32 a90, v14
v_accvgpr_read_b32 v14, a91
v_mul_f32 v14, v14, v12
v_accvgpr_write_b32 a91, v14
v_accvgpr_read_b32 v14, a104
v_mul_f32 v14, v14, v12
v_accvgpr_write_b32 a104, v14
v_accvgpr_read_b32 v14, a105
v_mul_f32 v14, v14, v12
v_accvgpr_write_b32 a105, v14
v_accvgpr_read_b32 v14, a106
v_mul_f32 v14, v14, v12
v_accvgpr_write_b32 a106, v14
v_accvgpr_read_b32 v14, a107
v_mul_f32 v14, v14, v12
v_accvgpr_write_b32 a107, v14
v_max3_f32 v13, v44, v45, v11
v_max3_f32 v13, v13, v46, v47
v_max3_f32 v13, v13, v60, v61
v_max3_f32 v13, v13, v62, v63
v_max3_f32 v13, v13, v76, v77
v_max3_f32 v13, v13, v78, v79
v_max3_f32 v13, v13, v92, v93
v_max3_f32 v13, v13, v94, v95
v_mov_b32 v14, v13
s_nop 1
v_permlane16_swap_b32 v13, v14
v_max_f32 v13, v13, v14
v_mov_b32 v14, v13
s_nop 1
v_permlane32_swap_b32 v13, v14
v_max_f32 v13, v13, v14
v_sub_f32 v12, v11, v13
v_exp_f32 v12, v12
v_mov_b32 v11, v13
v_sub_f32 v44, v44, v13
v_sub_f32 v45, v45, v13
v_sub_f32 v46, v46, v13
v_sub_f32 v47, v47, v13
v_sub_f32 v60, v60, v13
v_sub_f32 v61, v61, v13
v_sub_f32 v62, v62, v13
v_sub_f32 v63, v63, v13
v_sub_f32 v76, v76, v13
v_sub_f32 v77, v77, v13
v_sub_f32 v78, v78, v13
v_sub_f32 v79, v79, v13
v_sub_f32 v92, v92, v13
v_sub_f32 v93, v93, v13
v_sub_f32 v94, v94, v13
v_sub_f32 v95, v95, v13
v_mul_f32 v172, v172, v12
v_mul_f32 v173, v173, v12
v_mul_f32 v174, v174, v12
v_mul_f32 v175, v175, v12
v_mul_f32 v188, v188, v12
v_mul_f32 v189, v189, v12
v_mul_f32 v190, v190, v12
v_mul_f32 v191, v191, v12
v_mul_f32 v204, v204, v12
v_mul_f32 v205, v205, v12
v_mul_f32 v206, v206, v12
v_mul_f32 v207, v207, v12
v_mul_f32 v220, v220, v12
v_mul_f32 v221, v221, v12
v_mul_f32 v222, v222, v12
v_mul_f32 v223, v223, v12
v_mul_f32 v236, v236, v12
v_mul_f32 v237, v237, v12
v_mul_f32 v238, v238, v12
v_mul_f32 v239, v239, v12
v_mul_f32 v252, v252, v12
v_mul_f32 v253, v253, v12
v_mul_f32 v254, v254, v12
v_mul_f32 v255, v255, v12
v_accvgpr_read_b32 v14, a76
v_mul_f32 v14, v14, v12
v_accvgpr_write_b32 a76, v14
v_accvgpr_read_b32 v14, a77
v_mul_f32 v14, v14, v12
v_accvgpr_write_b32 a77, v14
v_accvgpr_read_b32 v14, a78
v_mul_f32 v14, v14, v12
v_accvgpr_write_b32 a78, v14
v_accvgpr_read_b32 v14, a79
v_mul_f32 v14, v14, v12
v_accvgpr_write_b32 a79, v14
v_accvgpr_read_b32 v14, a92
v_mul_f32 v14, v14, v12
v_accvgpr_write_b32 a92, v14
v_accvgpr_read_b32 v14, a93
v_mul_f32 v14, v14, v12
v_accvgpr_write_b32 a93, v14
v_accvgpr_read_b32 v14, a94
v_mul_f32 v14, v14, v12
v_accvgpr_write_b32 a94, v14
v_accvgpr_read_b32 v14, a95
v_mul_f32 v14, v14, v12
v_accvgpr_write_b32 a95, v14
v_accvgpr_read_b32 v14, a108
v_mul_f32 v14, v14, v12
v_accvgpr_write_b32 a108, v14
v_accvgpr_read_b32 v14, a109
v_mul_f32 v14, v14, v12
v_accvgpr_write_b32 a109, v14
v_accvgpr_read_b32 v14, a110
v_mul_f32 v14, v14, v12
v_accvgpr_write_b32 a110, v14
v_accvgpr_read_b32 v14, a111
v_mul_f32 v14, v14, v12
v_accvgpr_write_b32 a111, v14
v_exp_f32 v32, v32
v_exp_f32 v33, v33
v_exp_f32 v34, v34
v_exp_f32 v35, v35
v_exp_f32 v48, v48
v_exp_f32 v49, v49
v_exp_f32 v50, v50
v_exp_f32 v51, v51
v_cvt_pk_bf16_f32 v32, v32, v33
v_cvt_pk_bf16_f32 v33, v34, v35
v_exp_f32 v36, v36
v_exp_f32 v37, v37
v_exp_f32 v38, v38
v_exp_f32 v39, v39
v_cvt_pk_bf16_f32 v34, v48, v49
v_cvt_pk_bf16_f32 v35, v50, v51
v_exp_f32 v52, v52
v_exp_f32 v53, v53
v_exp_f32 v54, v54
v_exp_f32 v55, v55
v_cvt_pk_bf16_f32 v36, v36, v37
v_cvt_pk_bf16_f32 v37, v38, v39
v_exp_f32 v40, v40
v_exp_f32 v41, v41
v_exp_f32 v42, v42
v_exp_f32 v43, v43
v_cvt_pk_bf16_f32 v38, v52, v53
v_cvt_pk_bf16_f32 v39, v54, v55
v_exp_f32 v56, v56
v_exp_f32 v57, v57
v_exp_f32 v58, v58
v_exp_f32 v59, v59
v_cvt_pk_bf16_f32 v40, v40, v41
v_cvt_pk_bf16_f32 v41, v42, v43
v_exp_f32 v44, v44
v_exp_f32 v45, v45
v_exp_f32 v46, v46
v_exp_f32 v47, v47
v_cvt_pk_bf16_f32 v42, v56, v57
v_cvt_pk_bf16_f32 v43, v58, v59
v_exp_f32 v60, v60
v_exp_f32 v61, v61
v_exp_f32 v62, v62
v_exp_f32 v63, v63
v_cvt_pk_bf16_f32 v44, v44, v45
v_cvt_pk_bf16_f32 v45, v46, v47
v_cvt_pk_bf16_f32 v46, v60, v61
v_cvt_pk_bf16_f32 v47, v62, v63
v_exp_f32 v64, v64
v_exp_f32 v65, v65
v_exp_f32 v66, v66
v_exp_f32 v67, v67
v_exp_f32 v80, v80
v_exp_f32 v81, v81
v_exp_f32 v82, v82
v_exp_f32 v83, v83
v_cvt_pk_bf16_f32 v64, v64, v65
v_cvt_pk_bf16_f32 v65, v66, v67
v_exp_f32 v68, v68
v_exp_f32 v69, v69
v_exp_f32 v70, v70
v_exp_f32 v71, v71
v_cvt_pk_bf16_f32 v66, v80, v81
v_cvt_pk_bf16_f32 v67, v82, v83
v_exp_f32 v84, v84
v_exp_f32 v85, v85
v_exp_f32 v86, v86
v_exp_f32 v87, v87
v_cvt_pk_bf16_f32 v68, v68, v69
v_cvt_pk_bf16_f32 v69, v70, v71
v_exp_f32 v72, v72
v_exp_f32 v73, v73
v_exp_f32 v74, v74
v_exp_f32 v75, v75
v_cvt_pk_bf16_f32 v70, v84, v85
v_cvt_pk_bf16_f32 v71, v86, v87
v_exp_f32 v88, v88
v_exp_f32 v89, v89
v_exp_f32 v90, v90
v_exp_f32 v91, v91
v_cvt_pk_bf16_f32 v72, v72, v73
v_cvt_pk_bf16_f32 v73, v74, v75
v_exp_f32 v76, v76
v_exp_f32 v77, v77
v_exp_f32 v78, v78
v_exp_f32 v79, v79
v_cvt_pk_bf16_f32 v74, v88, v89
v_cvt_pk_bf16_f32 v75, v90, v91
v_exp_f32 v92, v92
v_exp_f32 v93, v93
v_exp_f32 v94, v94
v_exp_f32 v95, v95
v_cvt_pk_bf16_f32 v76, v76, v77
v_cvt_pk_bf16_f32 v77, v78, v79
v_cvt_pk_bf16_f32 v78, v92, v93
v_cvt_pk_bf16_f32 v79, v94, v95
s_waitcnt vmcnt(0)
M a[96:99], a[112:115], v[32:35], a[96:99]
M a[100:103], a[112:115], v[36:39], a[100:103]
M a[104:107], a[112:115], v[40:43], a[104:107]
M a[108:111], a[112:115], v[44:47], a[108:111]
M v[160:163], v[96:99], v[32:35], v[160:163]
M v[164:167], v[96:99], v[36:39], v[164:167]
M v[168:171], v[96:99], v[40:43], v[168:171]
M v[172:175], v[96:99], v[44:47], v[172:175]
M v[176:179], v[100:103], v[32:35], v[176:179]
M v[180:183], v[100:103], v[36:39], v[180:183]
M v[184:187], v[100:103], v[40:43], v[184:187]
M v[188:191], v[100:103], v[44:47], v[188:191]
M v[192:195], v[104:107], v[32:35], v[192:195]
M v[196:199], v[104:107], v[36:39], v[196:199]
M v[200:203], v[104:107], v[40:43], v[200:203]
M v[204:207], v[104:107], v[44:47], v[204:207]
M v[208:211], v[108:111], v[32:35], v[208:211]
M v[212:215], v[108:111], v[36:39], v[212:215]
M v[216:219], v[108:111], v[40:43], v[216:219]
M v[220:223], v[108:111], v[44:47], v[220:223]
M v[224:227], v[112:115], v[32:35], v[224:227]
M v[228:231], v[112:115], v[36:39], v[228:231]
M v[232:235], v[112:115], v[40:43], v[232:235]
M v[236:239], v[112:115], v[44:47], v[236:239]
M v[240:243], v[116:119], v[32:35], v[240:243]
M v[244:247], v[116:119], v[36:39], v[244:247]
M v[248:251], v[116:119], v[40:43], v[248:251]
M v[252:255], v[116:119], v[44:47], v[252:255]
M a[64:67], v[120:123], v[32:35], a[64:67]
M a[68:71], v[120:123], v[36:39], a[68:71]
M a[72:75], v[120:123], v[40:43], a[72:75]
M a[76:79], v[120:123], v[44:47], a[76:79]
M a[80:83], v[124:127], v[32:35], a[80:83]
M a[84:87], v[124:127], v[36:39], a[84:87]
M a[88:91], v[124:127], v[40:43], a[88:91]
M a[92:95], v[124:127], v[44:47], a[92:95]
M a[96:99], a[112:115], v[64:67], a[96:99]
M a[100:103], a[112:115], v[68:71], a[100:103]
M a[104:107], a[112:115], v[72:75], a[104:107]
M a[108:111], a[112:115], v[76:79], a[108:111]
M v[160:163], v[128:131], v[64:67], v[160:163]
M v[164:167], v[128:131], v[68:71], v[164:167]
M v[168:171], v[128:131], v[72:75], v[168:171]
M v[172:175], v[128:131], v[76:79], v[172:175]
M v[176:179], v[132:135], v[64:67], v[176:179]
M v[180:183], v[132:135], v[68:71], v[180:183]
M v[184:187], v[132:135], v[72:75], v[184:187]
M v[188:191], v[132:135], v[76:79], v[188:191]
M v[192:195], v[136:139], v[64:67], v[192:195]
M v[196:199], v[136:139], v[68:71], v[196:199]
M v[200:203], v[136:139], v[72:75], v[200:203]
M v[204:207], v[136:139], v[76:79], v[204:207]
M v[208:211], v[140:143], v[64:67], v[208:211]
M v[212:215], v[140:143], v[68:71], v[212:215]
M v[216:219], v[140:143], v[72:75], v[216:219]
M v[220:223], v[140:143], v[76:79], v[220:223]
M v[224:227], v[144:147], v[64:67], v[224:227]
M v[228:231], v[144:147], v[68:71], v[228:231]
M v[232:235], v[144:147], v[72:75], v[232:235]
M v[236:239], v[144:147], v[76:79], v[236:239]
M v[240:243], v[148:151], v[64:67], v[240:243]
M v[244:247], v[148:151], v[68:71], v[244:247]
M v[248:251], v[148:151], v[72:75], v[248:251]
M v[252:255], v[148:151], v[76:79], v[252:255]
M a[64:67], v[152:155], v[64:67], a[64:67]
M a[68:71], v[152:155], v[68:71], a[68:71]
M a[72:75], v[152:155], v[72:75], a[72:75]
M a[76:79], v[152:155], v[76:79], a[76:79]
M a[80:83], v[156:159], v[64:67], a[80:83]
M a[84:87], v[156:159], v[68:71], a[84:87]
M a[88:91], v[156:159], v[72:75], a[88:91]
M a[92:95], v[156:159], v[76:79], a[92:95]
s_nop 7
s_add_u32 s57, s57, 32768
s_sub_u32 s58, s58, 64
s_sub_u32 s59, s59, 1
s_cmp_lg_u32 s59, 0
s_cbranch_scc1 Lslow_8
v_accvgpr_read_b32 v20, a96
v_accvgpr_read_b32 v21, a100
v_accvgpr_read_b32 v22, a104
v_accvgpr_read_b32 v23, a108
v_rcp_f32 v8, v20
v_rcp_f32 v9, v21
v_rcp_f32 v10, v22
v_rcp_f32 v11, v23
v_pk_mul_f32 v[160:161], v[160:161], v[8:9] op_sel:[0,0] op_sel_hi:[1,0]
v_pk_mul_f32 v[162:163], v[162:163], v[8:9] op_sel:[0,0] op_sel_hi:[1,0]
v_pk_mul_f32 v[176:177], v[176:177], v[8:9] op_sel:[0,0] op_sel_hi:[1,0]
v_pk_mul_f32 v[178:179], v[178:179], v[8:9] op_sel:[0,0] op_sel_hi:[1,0]
v_cvt_pk_bf16_f32 v160, v160, v161
v_cvt_pk_bf16_f32 v161, v162, v163
v_cvt_pk_bf16_f32 v162, v176, v177
v_cvt_pk_bf16_f32 v163, v178, v179
v_pk_mul_f32 v[164:165], v[164:165], v[8:9] op_sel:[0,1] op_sel_hi:[1,1]
v_pk_mul_f32 v[166:167], v[166:167], v[8:9] op_sel:[0,1] op_sel_hi:[1,1]
v_pk_mul_f32 v[180:181], v[180:181], v[8:9] op_sel:[0,1] op_sel_hi:[1,1]
v_pk_mul_f32 v[182:183], v[182:183], v[8:9] op_sel:[0,1] op_sel_hi:[1,1]
v_cvt_pk_bf16_f32 v164, v164, v165
v_cvt_pk_bf16_f32 v165, v166, v167
v_cvt_pk_bf16_f32 v166, v180, v181
v_cvt_pk_bf16_f32 v167, v182, v183
v_pk_mul_f32 v[168:169], v[168:169], v[10:11] op_sel:[0,0] op_sel_hi:[1,0]
v_pk_mul_f32 v[170:171], v[170:171], v[10:11] op_sel:[0,0] op_sel_hi:[1,0]
v_pk_mul_f32 v[184:185], v[184:185], v[10:11] op_sel:[0,0] op_sel_hi:[1,0]
v_pk_mul_f32 v[186:187], v[186:187], v[10:11] op_sel:[0,0] op_sel_hi:[1,0]
v_cvt_pk_bf16_f32 v168, v168, v169
v_cvt_pk_bf16_f32 v169, v170, v171
v_cvt_pk_bf16_f32 v170, v184, v185
v_cvt_pk_bf16_f32 v171, v186, v187
v_pk_mul_f32 v[172:173], v[172:173], v[10:11] op_sel:[0,1] op_sel_hi:[1,1]
v_pk_mul_f32 v[174:175], v[174:175], v[10:11] op_sel:[0,1] op_sel_hi:[1,1]
v_pk_mul_f32 v[188:189], v[188:189], v[10:11] op_sel:[0,1] op_sel_hi:[1,1]
v_pk_mul_f32 v[190:191], v[190:191], v[10:11] op_sel:[0,1] op_sel_hi:[1,1]
v_cvt_pk_bf16_f32 v172, v172, v173
v_cvt_pk_bf16_f32 v173, v174, v175
v_cvt_pk_bf16_f32 v174, v188, v189
v_cvt_pk_bf16_f32 v175, v190, v191
v_pk_mul_f32 v[192:193], v[192:193], v[8:9] op_sel:[0,0] op_sel_hi:[1,0]
v_pk_mul_f32 v[194:195], v[194:195], v[8:9] op_sel:[0,0] op_sel_hi:[1,0]
v_pk_mul_f32 v[208:209], v[208:209], v[8:9] op_sel:[0,0] op_sel_hi:[1,0]
v_pk_mul_f32 v[210:211], v[210:211], v[8:9] op_sel:[0,0] op_sel_hi:[1,0]
v_cvt_pk_bf16_f32 v192, v192, v193
v_cvt_pk_bf16_f32 v193, v194, v195
v_cvt_pk_bf16_f32 v194, v208, v209
v_cvt_pk_bf16_f32 v195, v210, v211
v_pk_mul_f32 v[196:197], v[196:197], v[8:9] op_sel:[0,1] op_sel_hi:[1,1]
v_pk_mul_f32 v[198:199], v[198:199], v[8:9] op_sel:[0,1] op_sel_hi:[1,1]
v_pk_mul_f32 v[212:213], v[212:213], v[8:9] op_sel:[0,1] op_sel_hi:[1,1]
v_pk_mul_f32 v[214:215], v[214:215], v[8:9] op_sel:[0,1] op_sel_hi:[1,1]
v_cvt_pk_bf16_f32 v196, v196, v197
v_cvt_pk_bf16_f32 v197, v198, v199
v_cvt_pk_bf16_f32 v198, v212, v213
v_cvt_pk_bf16_f32 v199, v214, v215
v_pk_mul_f32 v[200:201], v[200:201], v[10:11] op_sel:[0,0] op_sel_hi:[1,0]
v_pk_mul_f32 v[202:203], v[202:203], v[10:11] op_sel:[0,0] op_sel_hi:[1,0]
v_pk_mul_f32 v[216:217], v[216:217], v[10:11] op_sel:[0,0] op_sel_hi:[1,0]
v_pk_mul_f32 v[218:219], v[218:219], v[10:11] op_sel:[0,0] op_sel_hi:[1,0]
v_cvt_pk_bf16_f32 v200, v200, v201
v_cvt_pk_bf16_f32 v201, v202, v203
v_cvt_pk_bf16_f32 v202, v216, v217
v_cvt_pk_bf16_f32 v203, v218, v219
v_pk_mul_f32 v[204:205], v[204:205], v[10:11] op_sel:[0,1] op_sel_hi:[1,1]
v_pk_mul_f32 v[206:207], v[206:207], v[10:11] op_sel:[0,1] op_sel_hi:[1,1]
v_pk_mul_f32 v[220:221], v[220:221], v[10:11] op_sel:[0,1] op_sel_hi:[1,1]
v_pk_mul_f32 v[222:223], v[222:223], v[10:11] op_sel:[0,1] op_sel_hi:[1,1]
v_cvt_pk_bf16_f32 v204, v204, v205
v_cvt_pk_bf16_f32 v205, v206, v207
v_cvt_pk_bf16_f32 v206, v220, v221
v_cvt_pk_bf16_f32 v207, v222, v223
v_pk_mul_f32 v[224:225], v[224:225], v[8:9] op_sel:[0,0] op_sel_hi:[1,0]
v_pk_mul_f32 v[226:227], v[226:227], v[8:9] op_sel:[0,0] op_sel_hi:[1,0]
v_pk_mul_f32 v[240:241], v[240:241], v[8:9] op_sel:[0,0] op_sel_hi:[1,0]
v_pk_mul_f32 v[242:243], v[242:243], v[8:9] op_sel:[0,0] op_sel_hi:[1,0]
v_cvt_pk_bf16_f32 v224, v224, v225
v_cvt_pk_bf16_f32 v225, v226, v227
v_cvt_pk_bf16_f32 v226, v240, v241
v_cvt_pk_bf16_f32 v227, v242, v243
v_pk_mul_f32 v[228:229], v[228:229], v[8:9] op_sel:[0,1] op_sel_hi:[1,1]
v_pk_mul_f32 v[230:231], v[230:231], v[8:9] op_sel:[0,1] op_sel_hi:[1,1]
v_pk_mul_f32 v[244:245], v[244:245], v[8:9] op_sel:[0,1] op_sel_hi:[1,1]
v_pk_mul_f32 v[246:247], v[246:247], v[8:9] op_sel:[0,1] op_sel_hi:[1,1]
v_cvt_pk_bf16_f32 v228, v228, v229
v_cvt_pk_bf16_f32 v229, v230, v231
v_cvt_pk_bf16_f32 v230, v244, v245
v_cvt_pk_bf16_f32 v231, v246, v247
v_pk_mul_f32 v[232:233], v[232:233], v[10:11] op_sel:[0,0] op_sel_hi:[1,0]
v_pk_mul_f32 v[234:235], v[234:235], v[10:11] op_sel:[0,0] op_sel_hi:[1,0]
v_pk_mul_f32 v[248:249], v[248:249], v[10:11] op_sel:[0,0] op_sel_hi:[1,0]
v_pk_mul_f32 v[250:251], v[250:251], v[10:11] op_sel:[0,0] op_sel_hi:[1,0]
v_cvt_pk_bf16_f32 v232, v232, v233
v_cvt_pk_bf16_f32 v233, v234, v235
v_cvt_pk_bf16_f32 v234, v248, v249
v_cvt_pk_bf16_f32 v235, v250, v251
v_pk_mul_f32 v[236:237], v[236:237], v[10:11] op_sel:[0,1] op_sel_hi:[1,1]
v_pk_mul_f32 v[238:239], v[238:239], v[10:11] op_sel:[0,1] op_sel_hi:[1,1]
v_pk_mul_f32 v[252:253], v[252:253], v[10:11] op_sel:[0,1] op_sel_hi:[1,1]
v_pk_mul_f32 v[254:255], v[254:255], v[10:11] op_sel:[0,1] op_sel_hi:[1,1]
v_cvt_pk_bf16_f32 v236, v236, v237
v_cvt_pk_bf16_f32 v237, v238, v239
v_cvt_pk_bf16_f32 v238, v252, v253
v_cvt_pk_bf16_f32 v239, v254, v255
v_accvgpr_read_b32 v176, a64
v_accvgpr_read_b32 v177, a65
v_accvgpr_read_b32 v178, a66
v_accvgpr_read_b32 v179, a67
v_accvgpr_read_b32 v180, a80
v_accvgpr_read_b32 v181, a81
v_accvgpr_read_b32 v182, a82
v_accvgpr_read_b32 v183, a83
v_pk_mul_f32 v[176:177], v[176:177], v[8:9] op_sel:[0,0] op_sel_hi:[1,0]
v_pk_mul_f32 v[178:179], v[178:179], v[8:9] op_sel:[0,0] op_sel_hi:[1,0]
v_pk_mul_f32 v[180:181], v[180:181], v[8:9] op_sel:[0,0] op_sel_hi:[1,0]
v_pk_mul_f32 v[182:183], v[182:183], v[8:9] op_sel:[0,0] op_sel_hi:[1,0]
v_cvt_pk_bf16_f32 v176, v176, v177
v_cvt_pk_bf16_f32 v177, v178, v179
v_cvt_pk_bf16_f32 v178, v180, v181
v_cvt_pk_bf16_f32 v179, v182, v183
v_accvgpr_read_b32 v184, a68
v_accvgpr_read_b32 v185, a69
v_accvgpr_read_b32 v186, a70
v_accvgpr_read_b32 v187, a71
v_accvgpr_read_b32 v188, a84
v_accvgpr_read_b32 v189, a85
v_accvgpr_read_b32 v190, a86
v_accvgpr_read_b32 v191, a87
v_pk_mul_f32 v[184:185], v[184:185], v[8:9] op_sel:[0,1] op_sel_hi:[1,1]
v_pk_mul_f32 v[186:187], v[186:187], v[8:9] op_sel:[0,1] op_sel_hi:[1,1]
v_pk_mul_f32 v[188:189], v[188:189], v[8:9] op_sel:[0,1] op_sel_hi:[1,1]
v_pk_mul_f32 v[190:191], v[190:191], v[8:9] op_sel:[0,1] op_sel_hi:[1,1]
v_cvt_pk_bf16_f32 v184, v184, v185
v_cvt_pk_bf16_f32 v185, v186, v187
v_cvt_pk_bf16_f32 v186, v188, v189
v_cvt_pk_bf16_f32 v187, v190, v191
v_accvgpr_read_b32 v208, a72
v_accvgpr_read_b32 v209, a73
v_accvgpr_read_b32 v210, a74
v_accvgpr_read_b32 v211, a75
v_accvgpr_read_b32 v212, a88
v_accvgpr_read_b32 v213, a89
v_accvgpr_read_b32 v214, a90
v_accvgpr_read_b32 v215, a91
v_pk_mul_f32 v[208:209], v[208:209], v[10:11] op_sel:[0,0] op_sel_hi:[1,0]
v_pk_mul_f32 v[210:211], v[210:211], v[10:11] op_sel:[0,0] op_sel_hi:[1,0]
v_pk_mul_f32 v[212:213], v[212:213], v[10:11] op_sel:[0,0] op_sel_hi:[1,0]
v_pk_mul_f32 v[214:215], v[214:215], v[10:11] op_sel:[0,0] op_sel_hi:[1,0]
v_cvt_pk_bf16_f32 v208, v208, v209
v_cvt_pk_bf16_f32 v209, v210, v211
v_cvt_pk_bf16_f32 v210, v212, v213
v_cvt_pk_bf16_f32 v211, v214, v215
v_accvgpr_read_b32 v216, a76
v_accvgpr_read_b32 v217, a77
v_accvgpr_read_b32 v218, a78
v_accvgpr_read_b32 v219, a79
v_accvgpr_read_b32 v220, a92
v_accvgpr_read_b32 v221, a93
v_accvgpr_read_b32 v222, a94
v_accvgpr_read_b32 v223, a95
v_pk_mul_f32 v[216:217], v[216:217], v[10:11] op_sel:[0,1] op_sel_hi:[1,1]
v_pk_mul_f32 v[218:219], v[218:219], v[10:11] op_sel:[0,1] op_sel_hi:[1,1]
v_pk_mul_f32 v[220:221], v[220:221], v[10:11] op_sel:[0,1] op_sel_hi:[1,1]
v_pk_mul_f32 v[222:223], v[222:223], v[10:11] op_sel:[0,1] op_sel_hi:[1,1]
v_cvt_pk_bf16_f32 v216, v216, v217
v_cvt_pk_bf16_f32 v217, v218, v219
v_cvt_pk_bf16_f32 v218, v220, v221
v_cvt_pk_bf16_f32 v219, v222, v223
s_lshl_b32 s33, s56, 20
s_lshl_b32 s34, s20, 15
s_add_u32 s33, s33, s34
s_lshl_b32 s34, s23, 13
s_add_u32 s36, s33, s34
s_add_u32 s37, s36, 4096
s_add_u32 s38, s36, 16384
s_add_u32 s39, s36, 20480
s_bitcmp1_b32 s61, 0
s_cbranch_scc0 Lss_11
buffer_store_dwordx4 v[160:163], v1, s[16:19], s36 offen offset:0 sc1
buffer_store_dwordx4 v[164:167], v1, s[16:19], s36 offen offset:2048 sc1
buffer_store_dwordx4 v[168:171], v1, s[16:19], s37 offen offset:0 sc1
buffer_store_dwordx4 v[172:175], v1, s[16:19], s37 offen offset:2048 sc1
Lss_11:
s_bitcmp1_b32 s61, 1
s_cbranch_scc0 Lss_12
buffer_store_dwordx4 v[192:195], v1, s[16:19], s36 offen offset:1024 sc1
buffer_store_dwordx4 v[196:199], v1, s[16:19], s36 offen offset:3072 sc1
buffer_store_dwordx4 v[200:203], v1, s[16:19], s37 offen offset:1024 sc1
buffer_store_dwordx4 v[204:207], v1, s[16:19], s37 offen offset:3072 sc1
Lss_12:
s_bitcmp1_b32 s61, 2
s_cbranch_scc0 Lss_13
buffer_store_dwordx4 v[224:227], v1, s[16:19], s38 offen offset:0 sc1
buffer_store_dwordx4 v[228:231], v1, s[16:19], s38 offen offset:2048 sc1
buffer_store_dwordx4 v[232:235], v1, s[16:19], s39 offen offset:0 sc1
buffer_store_dwordx4 v[236:239], v1, s[16:19], s39 offen offset:2048 sc1
Lss_13:
s_bitcmp1_b32 s61, 3
s_cbranch_scc0 Lss_14
buffer_store_dwordx4 v[176:179], v1, s[16:19], s38 offen offset:1024 sc1
buffer_store_dwordx4 v[184:187], v1, s[16:19], s38 offen offset:3072 sc1
buffer_store_dwordx4 v[208:211], v1, s[16:19], s39 offen offset:1024 sc1
buffer_store_dwordx4 v[216:219], v1, s[16:19], s39 offen offset:3072 sc1
Lss_14:
s_branch Lk2_chk
Lk2_done:
s_lshl_b32 s33, s20, 4
s_add_u32 s33, s33, 8392704
s_sub_u32 s34, 15, s21
s_lshl_b32 s34, s34, 9
s_add_u32 s92, s33, s34
s_lshl_b32 s34, s22, 2
s_add_u32 s92, s92, s34
s_lshl_b32 s34, s21, 9
s_add_u32 s93, s33, s34
s_lshl_b32 s34, s23, 3
s_add_u32 s93, s93, s34
s_cmp_eq_u32 s24, 0
s_cselect_b32 s93, s93, s92
s_cselect_b32 s94, 4, 0
s_add_u32 s94, s94, s93
s_load_dwordx2 s[10:11], s[0:1], 40
s_load_dwordx2 s[14:15], s[0:1], 72
s_lshl_b32 s21, s27, 7
s_lshl_b32 s22, s28, 6
s_lshl_b32 s3, s101, 4
v_lshrrev_b32 v224, 3, v0
v_and_b32 v225, 6, v224
v_and_b32 v226, 7, v0
v_xor_b32 v225, v225, v226
v_add_u32 v224, s3, v224
v_lshlrev_b32 v224, 11, v224
v_lshl_add_u32 v6, v225, 4, v224
v_add_u32 v7, 15360, v6
v_lshrrev_b32 v224, 2, v0
v_and_b32 v226, 1, v0
v_bfe_u32 v229, v0, 1, 1
v_lshlrev_b32 v225, 7, v224
v_lshl_add_u32 v225, v226, 3, v225
v_and_b32 v228, 6, v224
v_add_u32 v227, 0, v229
v_xor_b32 v227, v227, v228
v_lshl_add_u32 v24, v227, 4, v225
v_add_u32 v28, 0x10000, v24
v_add_u32 v227, 2, v229
v_xor_b32 v227, v227, v228
v_lshl_add_u32 v25, v227, 4, v225
v_add_u32 v29, 0x10000, v25
v_add_u32 v227, 4, v229
v_xor_b32 v227, v227, v228
v_lshl_add_u32 v26, v227, 4, v225
v_add_u32 v30, 0x10000, v26
v_add_u32 v227, 6, v229
v_xor_b32 v227, v227, v228
v_lshl_add_u32 v27, v227, 4, v225
v_add_u32 v31, 0x10000, v27
s_waitcnt vmcnt(32)
s_barrier
ds_read_b64_tr_b16 v[96:97], v28 offset:0
ds_read_b64_tr_b16 v[98:99], v28 offset:2048
ds_read_b64_tr_b16 v[100:101], v28 offset:4096
ds_read_b64_tr_b16 v[102:103], v28 offset:6144
ds_read_b64_tr_b16 v[104:105], v29 offset:0
ds_read_b64_tr_b16 v[106:107], v29 offset:2048
ds_read_b64_tr_b16 v[108:109], v29 offset:4096
ds_read_b64_tr_b16 v[110:111], v29 offset:6144
ds_read_b64_tr_b16 v[112:113], v30 offset:0
ds_read_b64_tr_b16 v[114:115], v30 offset:2048
ds_read_b64_tr_b16 v[116:117], v30 offset:4096
ds_read_b64_tr_b16 v[118:119], v30 offset:6144
ds_read_b64_tr_b16 v[120:121], v31 offset:0
ds_read_b64_tr_b16 v[122:123], v31 offset:2048
ds_read_b64_tr_b16 v[124:125], v31 offset:4096
ds_read_b64_tr_b16 v[126:127], v31 offset:6144
s_and_b32 s40, s2, 1
s_bfe_u32 s3, s2, 0x10001
s_lshl_b32 s3, s3, 3
s_bfe_u32 s36, s2, 0x30003
s_add_u32 s36, s3, s36
s_lshl_b32 s29, s36, 7
s_bfe_u32 s3, s2, 0x10002
s_lshl_b32 s3, s3, 2
s_lshr_b32 s37, s2, 6
s_add_u32 s3, s3, s37
s_lshl_b32 s13, s3, 8
s_lshl_b32 s30, s3, 7
s_lshl_b32 s3, s40, 6
s_add_u32 s30, s30, s3
s_lshl_b32 s41, s101, 12
s_lshl_b32 s12, s36, 20
s_add_u32 s12, s12, s41
s_lshl_b32 s62, s36, 9
s_lshl_b32 s3, s40, 8
s_add_u32 s62, s62, s3
s_add_u32 s62, s62, 8392704
s_lshr_b32 s3, s2, 1
s_lshr_b32 s38, s2, 2
s_xor_b32 s3, s3, s38
s_and_b32 s3, s3, 1
s_lshl_b32 s3, s3, 4
s_sub_u32 s39, 32, s3
s_lshl_b32 s38, s40, 5
s_add_u32 s3, s3, s38
s_lshl_b32 s3, s3, 14
s_add_u32 s12, s12, s3
s_lshl_b32 s3, s3, 3
s_add_u32 s13, s13, s3
s_mov_b32 s64, 4294459392
s_mov_b32 s65, 16384
s_add_u32 s8, s4, 67108864
s_addc_u32 s9, s5, 0
s_lshl_b32 s56, s2, 15
s_lshl_b32 s38, s101, 13
s_add_u32 s56, s56, s38
s_xor_b32 s57, s56, 32768
s_lshl_b32 s58, s2, 2
s_add_u32 s58, s58, 8388608
s_xor_b32 s59, s58, 4
s_mov_b32 s61, 0
s_lshl_b32 s3, s101, 4
v_lshrrev_b32 v232, 4, v0
v_and_b32 v234, 15, v0
v_add_u32 v233, 0, v232
v_lshlrev_b32 v233, 1, v233
v_xor_b32 v233, v233, v234
v_add_u32 v235, s3, v232
v_lshlrev_b32 v235, 11, v235
v_lshl_add_u32 v235, v233, 4, v235
v_add_u32 v2, 0, v235
v_add_u32 v233, 4, v232
v_lshlrev_b32 v233, 1, v233
v_xor_b32 v233, v233, v234
v_add_u32 v235, s3, v232
v_lshlrev_b32 v235, 11, v235
v_lshl_add_u32 v235, v233, 4, v235
v_add_u32 v3, 7168, v235
v_add_u32 v233, 0, v232
v_lshlrev_b32 v233, 1, v233
v_xor_b32 v233, v233, v234
v_add_u32 v235, s3, v232
v_lshlrev_b32 v235, 11, v235
v_lshl_add_u32 v235, v233, 4, v235
v_add_u32 v4, 14336, v235
v_add_u32 v233, 4, v232
v_lshlrev_b32 v233, 1, v233
v_xor_b32 v233, v233, v234
v_add_u32 v235, s3, v232
v_lshlrev_b32 v235, 11, v235
v_lshl_add_u32 v235, v233, 4, v235
v_add_u32 v5, 21504, v235
v_lshlrev_b32 v225, 8, v224
v_lshl_add_u32 v225, v226, 3, v225
v_and_b32 v228, 7, v224
v_lshlrev_b32 v228, 1, v228
s_lshl_b32 s38, s40, 3
v_xor_b32 v228, s38, v228
v_add_u32 v227, 0, v229
v_xor_b32 v227, v227, v228
v_lshl_add_u32 v8, v227, 4, v225
v_add_u32 v16, 0x10000, v8
v_add_u32 v227, 2, v229
v_xor_b32 v227, v227, v228
v_lshl_add_u32 v9, v227, 4, v225
v_add_u32 v17, 0x10000, v9
v_add_u32 v227, 4, v229
v_xor_b32 v227, v227, v228
v_lshl_add_u32 v10, v227, 4, v225
v_add_u32 v18, 0x10000, v10
v_add_u32 v227, 6, v229
v_xor_b32 v227, v227, v228
v_lshl_add_u32 v11, v227, 4, v225
v_add_u32 v19, 0x10000, v11
v_add_u32 v227, 8, v229
v_xor_b32 v227, v227, v228
v_lshl_add_u32 v12, v227, 4, v225
v_add_u32 v20, 0x10000, v12
v_add_u32 v227, 10, v229
v_xor_b32 v227, v227, v228
v_lshl_add_u32 v13, v227, 4, v225
v_add_u32 v21, 0x10000, v13
v_add_u32 v227, 12, v229
v_xor_b32 v227, v227, v228
v_lshl_add_u32 v14, v227, 4, v225
v_add_u32 v22, 0x10000, v14
v_add_u32 v227, 14, v229
v_xor_b32 v227, v227, v228
v_lshl_add_u32 v15, v227, 4, v225
v_add_u32 v23, 0x10000, v15
v_mov_b32 v253, 0
v_mov_b32 v254, 1
v_lshlrev_b32 v255, 2, v0
s_waitcnt lgkmcnt(0)
s_mov_b32 s16, s14
s_mov_b32 s17, s15
s_mov_b32 s18, 8388608
s_mov_b32 s19, 0x00020000
s_waitcnt vmcnt(26) lgkmcnt(0)
s_barrier
M a[0:3], v[96:99], a[192:195], 0
s_add_u32 m0, s42, 16384
s_nop 0
buffer_load_dwordx4 v6, s[48:51], s26 offen offset:0 lds
ds_read_b64_tr_b16 v[160:161], v28 offset:16384
ds_read_b64_tr_b16 v[162:163], v28 offset:18432
M a[0:3], v[100:103], a[196:199], a[0:3]
buffer_load_dwordx4 v7, s[48:51], s26 offen offset:1024 lds
M a[4:7], v[108:111], a[196:199], 0
ds_read_b64_tr_b16 v[164:165], v28 offset:20480
ds_read_b64_tr_b16 v[166:167], v28 offset:22528
M a[4:7], v[104:107], a[192:195], a[4:7]
buffer_load_dwordx4 a[144:147], v1, s[44:47], s25 offen offset:0 sc1
M a[8:11], v[112:115], a[192:195], 0
ds_read_b64_tr_b16 v[168:169], v29 offset:16384
ds_read_b64_tr_b16 v[170:171], v29 offset:18432
M a[8:11], v[116:119], a[196:199], a[8:11]
buffer_load_dwordx4 a[148:151], v1, s[44:47], s25 offen offset:1024 sc1
M a[12:15], v[124:127], a[196:199], 0
ds_read_b64_tr_b16 v[172:173], v29 offset:20480
ds_read_b64_tr_b16 v[174:175], v29 offset:22528
M a[12:15], v[120:123], a[192:195], a[12:15]
buffer_load_dwordx4 a[152:155], v1, s[44:47], s25 offen offset:2048 sc1
M a[16:19], v[96:99], a[200:203], 0
ds_read_b64_tr_b16 v[176:177], v30 offset:16384
ds_read_b64_tr_b16 v[178:179], v30 offset:18432
M a[16:19], v[100:103], a[204:207], a[16:19]
buffer_load_dwordx4 a[156:159], v1, s[44:47], s25 offen offset:3072 sc1
M a[20:23], v[108:111], a[204:207], 0
ds_read_b64_tr_b16 v[180:181], v30 offset:20480
ds_read_b64_tr_b16 v[182:183], v30 offset:22528
M a[20:23], v[104:107], a[200:203], a[20:23]
s_add_u32 s25, s25, 16384
s_add_u32 s26, s26, 131072
M a[24:27], v[112:115], a[200:203], 0
ds_read_b64_tr_b16 v[184:185], v31 offset:16384
ds_read_b64_tr_b16 v[186:187], v31 offset:18432
M a[24:27], v[116:119], a[204:207], a[24:27]
ds_read_b64_tr_b16 v[188:189], v31 offset:20480
ds_read_b64_tr_b16 v[190:191], v31 offset:22528
M a[28:31], v[124:127], a[204:207], 0
M a[28:31], v[120:123], a[200:203], a[28:31]
s_waitcnt vmcnt(6) lgkmcnt(0)
s_barrier
s_mov_b64 exec, 1
buffer_store_dword v254, v253, s[52:55], s92 offen sc1
buffer_store_dword v254, v253, s[52:55], s93 offen sc1
buffer_store_dword v254, v253, s[52:55], s94 offen sc1
s_mov_b64 exec, -1
M a[0:3], v[160:163], a[208:211], a[0:3]
s_add_u32 m0, s42, 32768
s_nop 0
buffer_load_dwordx4 v6, s[48:51], s26 offen offset:0 lds
ds_read_b64_tr_b16 v[96:97], v28 offset:32768
ds_read_b64_tr_b16 v[98:99], v28 offset:34816
M a[0:3], v[164:167], a[212:215], a[0:3]
buffer_load_dwordx4 v7, s[48:51], s26 offen offset:1024 lds
M a[4:7], v[172:175], a[212:215], a[4:7]
ds_read_b64_tr_b16 v[100:101], v28 offset:36864
ds_read_b64_tr_b16 v[102:103], v28 offset:38912
M a[4:7], v[168:171], a[208:211], a[4:7]
buffer_load_dwordx4 a[160:163], v1, s[44:47], s25 offen offset:0 sc1
M a[8:11], v[176:179], a[208:211], a[8:11]
ds_read_b64_tr_b16 v[104:105], v29 offset:32768
ds_read_b64_tr_b16 v[106:107], v29 offset:34816
M a[8:11], v[180:183], a[212:215], a[8:11]
buffer_load_dwordx4 a[164:167], v1, s[44:47], s25 offen offset:1024 sc1
M a[12:15], v[188:191], a[212:215], a[12:15]
ds_read_b64_tr_b16 v[108:109], v29 offset:36864
ds_read_b64_tr_b16 v[110:111], v29 offset:38912
M a[12:15], v[184:187], a[208:211], a[12:15]
buffer_load_dwordx4 a[168:171], v1, s[44:47], s25 offen offset:2048 sc1
M a[16:19], v[160:163], a[216:219], a[16:19]
ds_read_b64_tr_b16 v[112:113], v30 offset:32768
ds_read_b64_tr_b16 v[114:115], v30 offset:34816
M a[16:19], v[164:167], a[220:223], a[16:19]
buffer_load_dwordx4 a[172:175], v1, s[44:47], s25 offen offset:3072 sc1
M a[20:23], v[172:175], a[220:223], a[20:23]
ds_read_b64_tr_b16 v[116:117], v30 offset:36864
ds_read_b64_tr_b16 v[118:119], v30 offset:38912
M a[20:23], v[168:171], a[216:219], a[20:23]
s_add_u32 s25, s25, 16384
s_add_u32 s26, s26, 131072
M a[24:27], v[176:179], a[216:219], a[24:27]
ds_read_b64_tr_b16 v[120:121], v31 offset:32768
ds_read_b64_tr_b16 v[122:123], v31 offset:34816
M a[24:27], v[180:183], a[220:223], a[24:27]
ds_read_b64_tr_b16 v[124:125], v31 offset:36864
ds_read_b64_tr_b16 v[126:127], v31 offset:38912
M a[28:31], v[188:191], a[220:223], a[28:31]
M a[28:31], v[184:187], a[216:219], a[28:31]
s_waitcnt vmcnt(29) lgkmcnt(0)
s_barrier
M a[0:3], v[96:99], a[224:227], a[0:3]
s_add_u32 m0, s42, 49152
s_nop 0
buffer_load_dwordx4 v6, s[48:51], s26 offen offset:0 lds
ds_read_b64_tr_b16 v[160:161], v28 offset:49152
ds_read_b64_tr_b16 v[162:163], v28 offset:51200
M a[0:3], v[100:103], a[228:231], a[0:3]
buffer_load_dwordx4 v7, s[48:51], s26 offen offset:1024 lds
M a[4:7], v[108:111], a[228:231], a[4:7]
ds_read_b64_tr_b16 v[164:165], v28 offset:53248
ds_read_b64_tr_b16 v[166:167], v28 offset:55296
M a[4:7], v[104:107], a[224:227], a[4:7]
buffer_load_dwordx4 a[176:179], v1, s[44:47], s25 offen offset:0 sc1
M a[8:11], v[112:115], a[224:227], a[8:11]
ds_read_b64_tr_b16 v[168:169], v29 offset:49152
ds_read_b64_tr_b16 v[170:171], v29 offset:51200
M a[8:11], v[116:119], a[228:231], a[8:11]
buffer_load_dwordx4 a[180:183], v1, s[44:47], s25 offen offset:1024 sc1
M a[12:15], v[124:127], a[228:231], a[12:15]
ds_read_b64_tr_b16 v[172:173], v29 offset:53248
ds_read_b64_tr_b16 v[174:175], v29 offset:55296
M a[12:15], v[120:123], a[224:227], a[12:15]
buffer_load_dwordx4 a[184:187], v1, s[44:47], s25 offen offset:2048 sc1
ds_read_b64_tr_b16 v[176:177], v30 offset:49152
ds_read_b64_tr_b16 v[178:179], v30 offset:51200
M a[16:19], v[96:99], a[232:235], a[16:19]
buffer_load_dwordx4 a[188:191], v1, s[44:47], s25 offen offset:3072 sc1
M a[16:19], v[100:103], a[236:239], a[16:19]
ds_read_b64_tr_b16 v[180:181], v30 offset:53248
ds_read_b64_tr_b16 v[182:183], v30 offset:55296
M a[20:23], v[108:111], a[236:239], a[20:23]
s_add_u32 s25, s25, 16384
s_add_u32 s26, s26, 131072
M a[20:23], v[104:107], a[232:235], a[20:23]
ds_read_b64_tr_b16 v[184:185], v31 offset:49152
ds_read_b64_tr_b16 v[186:187], v31 offset:51200
M a[24:27], v[112:115], a[232:235], a[24:27]
buffer_load_dword v252, v255, s[52:55], s62 offen sc1
M a[24:27], v[116:119], a[236:239], a[24:27]
ds_read_b64_tr_b16 v[188:189], v31 offset:53248
ds_read_b64_tr_b16 v[190:191], v31 offset:55296
M a[28:31], v[124:127], a[236:239], a[28:31]
M a[28:31], v[120:123], a[232:235], a[28:31]
s_waitcnt vmcnt(30) lgkmcnt(0)
s_barrier
s_waitcnt vmcnt(0)
v_cmp_ne_u32 vcc, 1, v252
s_nop 0
s_cbranch_vccnz Lk3_spinft
Lk3_gotft:
M a[0:3], v[160:163], a[240:243], a[0:3]
s_mov_b32 s32, s25
s_mov_b32 s33, s26
s_mov_b64 s[34:35], s[44:45]
s_mov_b64 s[36:37], s[48:49]
s_mov_b64 s[44:45], s[8:9]
s_mov_b32 s46, 16777216
s_mov_b64 s[48:49], s[10:11]
s_mov_b32 s50, 8388608
s_mov_b32 s25, s12
s_mov_b32 s26, s13
s_add_u32 m0, s41, 65536
s_nop 0
buffer_load_dwordx4 v2, s[48:51], s26 offen offset:0 lds
ds_read_b64_tr_b16 v[96:97], v24 offset:0
ds_read_b64_tr_b16 v[98:99], v24 offset:2048
M a[0:3], v[164:167], a[244:247], a[0:3]
buffer_load_dwordx4 v3, s[48:51], s26 offen offset:1024 lds
M a[4:7], v[172:175], a[244:247], a[4:7]
ds_read_b64_tr_b16 v[100:101], v24 offset:4096
ds_read_b64_tr_b16 v[102:103], v24 offset:6144
M a[4:7], v[168:171], a[240:243], a[4:7]
buffer_load_dwordx4 v4, s[48:51], s26 offen offset:2048 lds
ds_read_b64_tr_b16 v[104:105], v25 offset:0
ds_read_b64_tr_b16 v[106:107], v25 offset:2048
M a[8:11], v[176:179], a[240:243], a[8:11]
buffer_load_dwordx4 v5, s[48:51], s26 offen offset:3072 lds
M a[8:11], v[180:183], a[244:247], a[8:11]
ds_read_b64_tr_b16 v[108:109], v25 offset:4096
ds_read_b64_tr_b16 v[110:111], v25 offset:6144
M a[12:15], v[188:191], a[244:247], a[12:15]
buffer_load_dwordx4 a[192:195], v1, s[44:47], s25 offen offset:0 sc1
M a[12:15], v[184:187], a[240:243], a[12:15]
ds_read_b64_tr_b16 v[112:113], v26 offset:0
ds_read_b64_tr_b16 v[114:115], v26 offset:2048
buffer_load_dwordx4 a[196:199], v1, s[44:47], s25 offen offset:1024 sc1
M a[16:19], v[160:163], a[248:251], a[16:19]
ds_read_b64_tr_b16 v[116:117], v26 offset:4096
ds_read_b64_tr_b16 v[118:119], v26 offset:6144
M a[16:19], v[164:167], a[252:255], a[16:19]
buffer_load_dwordx4 a[200:203], v1, s[44:47], s25 offen offset:2048 sc1
M a[20:23], v[172:175], a[252:255], a[20:23]
ds_read_b64_tr_b16 v[120:121], v27 offset:0
ds_read_b64_tr_b16 v[122:123], v27 offset:2048
buffer_load_dwordx4 a[204:207], v1, s[44:47], s25 offen offset:3072 sc1
M a[20:23], v[168:171], a[248:251], a[20:23]
ds_read_b64_tr_b16 v[124:125], v27 offset:4096
ds_read_b64_tr_b16 v[126:127], v27 offset:6144
M a[24:27], v[176:179], a[248:251], a[24:27]
s_sub_u32 s39, s39, 1
s_cmp_eq_u32 s39, 0
s_cselect_b32 s3, s64, s65
M a[24:27], v[180:183], a[252:255], a[24:27]
s_add_u32 s25, s25, s3
s_lshl_b32 s3, s3, 3
s_add_u32 s26, s26, s3
M a[28:31], v[188:191], a[252:255], a[28:31]
M a[28:31], v[184:187], a[248:251], a[28:31]
s_waitcnt vmcnt(24) lgkmcnt(0)
s_barrier
M a[0:3], v[96:99], a[128:131], a[0:3]
s_add_u32 m0, s41, 81920
s_nop 0
buffer_load_dwordx4 v2, s[48:51], s26 offen offset:0 lds
ds_read_b64_tr_b16 v[160:161], v24 offset:16384
ds_read_b64_tr_b16 v[162:163], v24 offset:18432
M a[0:3], v[100:103], a[132:135], a[0:3]
buffer_load_dwordx4 v3, s[48:51], s26 offen offset:1024 lds
M a[4:7], v[108:111], a[132:135], a[4:7]
ds_read_b64_tr_b16 v[164:165], v24 offset:20480
ds_read_b64_tr_b16 v[166:167], v24 offset:22528
M a[4:7], v[104:107], a[128:131], a[4:7]
buffer_load_dwordx4 v4, s[48:51], s26 offen offset:2048 lds
ds_read_b64_tr_b16 v[168:169], v25 offset:16384
ds_read_b64_tr_b16 v[170:171], v25 offset:18432
M a[8:11], v[112:115], a[128:131], a[8:11]
buffer_load_dwordx4 v5, s[48:51], s26 offen offset:3072 lds
M a[8:11], v[116:119], a[132:135], a[8:11]
ds_read_b64_tr_b16 v[172:173], v25 offset:20480
ds_read_b64_tr_b16 v[174:175], v25 offset:22528
M a[12:15], v[124:127], a[132:135], a[12:15]
buffer_load_dwordx4 a[208:211], v1, s[44:47], s25 offen offset:0 sc1
M a[12:15], v[120:123], a[128:131], a[12:15]
ds_read_b64_tr_b16 v[176:177], v26 offset:16384
ds_read_b64_tr_b16 v[178:179], v26 offset:18432
buffer_load_dwordx4 a[212:215], v1, s[44:47], s25 offen offset:1024 sc1
M a[16:19], v[96:99], a[136:139], a[16:19]
ds_read_b64_tr_b16 v[180:181], v26 offset:20480
ds_read_b64_tr_b16 v[182:183], v26 offset:22528
M a[16:19], v[100:103], a[140:143], a[16:19]
buffer_load_dwordx4 a[216:219], v1, s[44:47], s25 offen offset:2048 sc1
M a[20:23], v[108:111], a[140:143], a[20:23]
ds_read_b64_tr_b16 v[184:185], v27 offset:16384
ds_read_b64_tr_b16 v[186:187], v27 offset:18432
buffer_load_dwordx4 a[220:223], v1, s[44:47], s25 offen offset:3072 sc1
M a[20:23], v[104:107], a[136:139], a[20:23]
ds_read_b64_tr_b16 v[188:189], v27 offset:20480
ds_read_b64_tr_b16 v[190:191], v27 offset:22528
M a[24:27], v[112:115], a[136:139], a[24:27]
s_sub_u32 s39, s39, 1
s_cmp_eq_u32 s39, 0
s_cselect_b32 s3, s64, s65
M a[24:27], v[116:119], a[140:143], a[24:27]
s_add_u32 s25, s25, s3
s_lshl_b32 s3, s3, 3
s_add_u32 s26, s26, s3
M a[28:31], v[124:127], a[140:143], a[28:31]
M a[28:31], v[120:123], a[136:139], a[28:31]
s_waitcnt vmcnt(23) lgkmcnt(0)
s_barrier
M a[0:3], v[160:163], a[144:147], a[0:3]
s_add_u32 m0, s41, 98304
s_nop 0
buffer_load_dwordx4 v2, s[48:51], s26 offen offset:0 lds
ds_read_b64_tr_b16 v[96:97], v24 offset:32768
ds_read_b64_tr_b16 v[98:99], v24 offset:34816
M a[0:3], v[164:167], a[148:151], a[0:3]
buffer_load_dwordx4 v3, s[48:51], s26 offen offset:1024 lds
M a[4:7], v[172:175], a[148:151], a[4:7]
ds_read_b64_tr_b16 v[100:101], v24 offset:36864
ds_read_b64_tr_b16 v[102:103], v24 offset:38912
M a[4:7], v[168:171], a[144:147], a[4:7]
buffer_load_dwordx4 v4, s[48:51], s26 offen offset:2048 lds
ds_read_b64_tr_b16 v[104:105], v25 offset:32768
ds_read_b64_tr_b16 v[106:107], v25 offset:34816
M a[8:11], v[176:179], a[144:147], a[8:11]
buffer_load_dwordx4 v5, s[48:51], s26 offen offset:3072 lds
M a[8:11], v[180:183], a[148:151], a[8:11]
ds_read_b64_tr_b16 v[108:109], v25 offset:36864
ds_read_b64_tr_b16 v[110:111], v25 offset:38912
M a[12:15], v[188:191], a[148:151], a[12:15]
buffer_load_dwordx4 a[224:227], v1, s[44:47], s25 offen offset:0 sc1
M a[12:15], v[184:187], a[144:147], a[12:15]
ds_read_b64_tr_b16 v[112:113], v26 offset:32768
ds_read_b64_tr_b16 v[114:115], v26 offset:34816
buffer_load_dwordx4 a[228:231], v1, s[44:47], s25 offen offset:1024 sc1
M a[16:19], v[160:163], a[152:155], a[16:19]
ds_read_b64_tr_b16 v[116:117], v26 offset:36864
ds_read_b64_tr_b16 v[118:119], v26 offset:38912
M a[16:19], v[164:167], a[156:159], a[16:19]
buffer_load_dwordx4 a[232:235], v1, s[44:47], s25 offen offset:2048 sc1
M a[20:23], v[172:175], a[156:159], a[20:23]
ds_read_b64_tr_b16 v[120:121], v27 offset:32768
ds_read_b64_tr_b16 v[122:123], v27 offset:34816
buffer_load_dwordx4 a[236:239], v1, s[44:47], s25 offen offset:3072 sc1
M a[20:23], v[168:171], a[152:155], a[20:23]
ds_read_b64_tr_b16 v[124:125], v27 offset:36864
ds_read_b64_tr_b16 v[126:127], v27 offset:38912
M a[24:27], v[176:179], a[152:155], a[24:27]
s_sub_u32 s39, s39, 1
s_cmp_eq_u32 s39, 0
s_cselect_b32 s3, s64, s65
M a[24:27], v[180:183], a[156:159], a[24:27]
s_add_u32 s25, s25, s3
s_lshl_b32 s3, s3, 3
s_add_u32 s26, s26, s3
M a[28:31], v[188:191], a[156:159], a[28:31]
M a[28:31], v[184:187], a[152:155], a[28:31]
s_waitcnt vmcnt(25) lgkmcnt(0)
s_barrier
M a[0:3], v[96:99], a[160:163], a[0:3]
s_add_u32 m0, s41, 114688
s_nop 0
buffer_load_dwordx4 v2, s[48:51], s26 offen offset:0 lds
ds_read_b64_tr_b16 v[160:161], v24 offset:49152
ds_read_b64_tr_b16 v[162:163], v24 offset:51200
M a[0:3], v[100:103], a[164:167], a[0:3]
buffer_load_dwordx4 v3, s[48:51], s26 offen offset:1024 lds
M a[4:7], v[108:111], a[164:167], a[4:7]
ds_read_b64_tr_b16 v[164:165], v24 offset:53248
ds_read_b64_tr_b16 v[166:167], v24 offset:55296
M a[4:7], v[104:107], a[160:163], a[4:7]
buffer_load_dwordx4 v4, s[48:51], s26 offen offset:2048 lds
ds_read_b64_tr_b16 v[168:169], v25 offset:49152
ds_read_b64_tr_b16 v[170:171], v25 offset:51200
M a[8:11], v[112:115], a[160:163], a[8:11]
buffer_load_dwordx4 v5, s[48:51], s26 offen offset:3072 lds
M a[8:11], v[116:119], a[164:167], a[8:11]
ds_read_b64_tr_b16 v[172:173], v25 offset:53248
ds_read_b64_tr_b16 v[174:175], v25 offset:55296
M a[12:15], v[124:127], a[164:167], a[12:15]
buffer_load_dwordx4 a[240:243], v1, s[44:47], s25 offen offset:0 sc1
M a[12:15], v[120:123], a[160:163], a[12:15]
ds_read_b64_tr_b16 v[176:177], v26 offset:49152
ds_read_b64_tr_b16 v[178:179], v26 offset:51200
buffer_load_dwordx4 a[244:247], v1, s[44:47], s25 offen offset:1024 sc1
M a[16:19], v[96:99], a[168:171], a[16:19]
ds_read_b64_tr_b16 v[180:181], v26 offset:53248
ds_read_b64_tr_b16 v[182:183], v26 offset:55296
M a[16:19], v[100:103], a[172:175], a[16:19]
buffer_load_dwordx4 a[248:251], v1, s[44:47], s25 offen offset:2048 sc1
M a[20:23], v[108:111], a[172:175], a[20:23]
ds_read_b64_tr_b16 v[184:185], v27 offset:49152
ds_read_b64_tr_b16 v[186:187], v27 offset:51200
buffer_load_dwordx4 a[252:255], v1, s[44:47], s25 offen offset:3072 sc1
M a[20:23], v[104:107], a[168:171], a[20:23]
ds_read_b64_tr_b16 v[188:189], v27 offset:53248
ds_read_b64_tr_b16 v[190:191], v27 offset:55296
M a[24:27], v[112:115], a[168:171], a[24:27]
s_sub_u32 s39, s39, 1
s_cmp_eq_u32 s39, 0
s_cselect_b32 s3, s64, s65
M a[24:27], v[116:119], a[172:175], a[24:27]
s_add_u32 s25, s25, s3
s_lshl_b32 s3, s3, 3
s_add_u32 s26, s26, s3
M a[28:31], v[124:127], a[172:175], a[28:31]
M a[28:31], v[120:123], a[168:171], a[28:31]
s_waitcnt vmcnt(24) lgkmcnt(0)
s_barrier
M a[0:3], v[160:163], a[176:179], a[0:3]
s_add_u32 m0, s41, 0
s_nop 0
buffer_load_dwordx4 v2, s[48:51], s26 offen offset:0 lds
ds_read_b64_tr_b16 v[96:97], v16 offset:0
ds_read_b64_tr_b16 v[98:99], v16 offset:4096
M a[0:3], v[164:167], a[180:183], a[0:3]
buffer_load_dwordx4 v3, s[48:51], s26 offen offset:1024 lds
ds_read_b64_tr_b16 v[100:101], v16 offset:8192
ds_read_b64_tr_b16 v[102:103], v16 offset:12288
M a[4:7], v[172:175], a[180:183], a[4:7]
buffer_load_dwordx4 v4, s[48:51], s26 offen offset:2048 lds
ds_read_b64_tr_b16 v[104:105], v17 offset:0
ds_read_b64_tr_b16 v[106:107], v17 offset:4096
M a[4:7], v[168:171], a[176:179], a[4:7]
buffer_load_dwordx4 v5, s[48:51], s26 offen offset:3072 lds
ds_read_b64_tr_b16 v[108:109], v17 offset:8192
ds_read_b64_tr_b16 v[110:111], v17 offset:12288
M a[8:11], v[176:179], a[176:179], a[8:11]
buffer_load_dwordx4 a[128:131], v1, s[44:47], s25 offen offset:0 sc1
ds_read_b64_tr_b16 v[112:113], v18 offset:0
ds_read_b64_tr_b16 v[114:115], v18 offset:4096
M a[8:11], v[180:183], a[180:183], a[8:11]
buffer_load_dwordx4 a[132:135], v1, s[44:47], s25 offen offset:1024 sc1
ds_read_b64_tr_b16 v[116:117], v18 offset:8192
ds_read_b64_tr_b16 v[118:119], v18 offset:12288
M a[12:15], v[188:191], a[180:183], a[12:15]
buffer_load_dwordx4 a[136:139], v1, s[44:47], s25 offen offset:2048 sc1
M a[12:15], v[184:187], a[176:179], a[12:15]
ds_read_b64_tr_b16 v[120:121], v19 offset:0
ds_read_b64_tr_b16 v[122:123], v19 offset:4096
buffer_load_dwordx4 a[140:143], v1, s[44:47], s25 offen offset:3072 sc1
M a[16:19], v[160:163], a[184:187], a[16:19]
ds_read_b64_tr_b16 v[124:125], v19 offset:8192
ds_read_b64_tr_b16 v[126:127], v19 offset:12288
s_sub_u32 s39, s39, 1
s_cmp_eq_u32 s39, 0
s_cselect_b32 s3, s64, s65
M a[16:19], v[164:167], a[188:191], a[16:19]
ds_read_b64_tr_b16 v[128:129], v20 offset:0
ds_read_b64_tr_b16 v[130:131], v20 offset:4096
s_add_u32 s25, s25, s3
s_lshl_b32 s3, s3, 3
s_add_u32 s26, s26, s3
M a[20:23], v[172:175], a[188:191], a[20:23]
ds_read_b64_tr_b16 v[132:133], v20 offset:8192
ds_read_b64_tr_b16 v[134:135], v20 offset:12288
ds_read_b64_tr_b16 v[136:137], v21 offset:0
ds_read_b64_tr_b16 v[138:139], v21 offset:4096
M a[20:23], v[168:171], a[184:187], a[20:23]
ds_read_b64_tr_b16 v[140:141], v21 offset:8192
ds_read_b64_tr_b16 v[142:143], v21 offset:12288
ds_read_b64_tr_b16 v[144:145], v22 offset:0
ds_read_b64_tr_b16 v[146:147], v22 offset:4096
M a[24:27], v[176:179], a[184:187], a[24:27]
ds_read_b64_tr_b16 v[148:149], v22 offset:8192
ds_read_b64_tr_b16 v[150:151], v22 offset:12288
ds_read_b64_tr_b16 v[152:153], v23 offset:0
ds_read_b64_tr_b16 v[154:155], v23 offset:4096
M a[24:27], v[180:183], a[188:191], a[24:27]
ds_read_b64_tr_b16 v[156:157], v23 offset:8192
ds_read_b64_tr_b16 v[158:159], v23 offset:12288
M a[28:31], v[188:191], a[188:191], a[28:31]
M a[28:31], v[184:187], a[184:187], a[28:31]
s_waitcnt vmcnt(24) lgkmcnt(0)
s_barrier
M v[32:35], v[96:99], a[192:195], 0
s_add_u32 m0, s41, 16384
s_nop 0
buffer_load_dwordx4 v2, s[48:51], s26 offen offset:0 lds
M v[32:35], v[100:103], a[196:199], v[32:35]
ds_read_b64_tr_b16 v[160:161], v16 offset:16384
ds_read_b64_tr_b16 v[162:163], v16 offset:20480
M v[36:39], v[108:111], a[196:199], 0
buffer_load_dwordx4 v3, s[48:51], s26 offen offset:1024 lds
M v[36:39], v[104:107], a[192:195], v[36:39]
ds_read_b64_tr_b16 v[164:165], v16 offset:24576
ds_read_b64_tr_b16 v[166:167], v16 offset:28672
M v[40:43], v[112:115], a[192:195], 0
buffer_load_dwordx4 v4, s[48:51], s26 offen offset:2048 lds
M v[40:43], v[116:119], a[196:199], v[40:43]
ds_read_b64_tr_b16 v[168:169], v17 offset:16384
ds_read_b64_tr_b16 v[170:171], v17 offset:20480
M v[44:47], v[124:127], a[196:199], 0
buffer_load_dwordx4 v5, s[48:51], s26 offen offset:3072 lds
M v[44:47], v[120:123], a[192:195], v[44:47]
M v[48:51], v[128:131], a[192:195], 0
ds_read_b64_tr_b16 v[172:173], v17 offset:24576
ds_read_b64_tr_b16 v[174:175], v17 offset:28672
M v[48:51], v[132:135], a[196:199], v[48:51]
buffer_load_dwordx4 a[144:147], v1, s[44:47], s25 offen offset:0 sc1
M v[52:55], v[140:143], a[196:199], 0
ds_read_b64_tr_b16 v[176:177], v18 offset:16384
ds_read_b64_tr_b16 v[178:179], v18 offset:20480
M v[52:55], v[136:139], a[192:195], v[52:55]
buffer_load_dwordx4 a[148:151], v1, s[44:47], s25 offen offset:1024 sc1
M v[56:59], v[144:147], a[192:195], 0
ds_read_b64_tr_b16 v[180:181], v18 offset:24576
ds_read_b64_tr_b16 v[182:183], v18 offset:28672
M v[56:59], v[148:151], a[196:199], v[56:59]
buffer_load_dwordx4 a[152:155], v1, s[44:47], s25 offen offset:2048 sc1
M v[60:63], v[156:159], a[196:199], 0
M v[60:63], v[152:155], a[192:195], v[60:63]
ds_read_b64_tr_b16 v[184:185], v19 offset:16384
ds_read_b64_tr_b16 v[186:187], v19 offset:20480
M v[64:67], v[96:99], a[200:203], 0
buffer_load_dwordx4 a[156:159], v1, s[44:47], s25 offen offset:3072 sc1
M v[64:67], v[100:103], a[204:207], v[64:67]
ds_read_b64_tr_b16 v[188:189], v19 offset:24576
ds_read_b64_tr_b16 v[190:191], v19 offset:28672
M v[68:71], v[108:111], a[204:207], 0
s_sub_u32 s39, s39, 1
s_cmp_eq_u32 s39, 0
s_cselect_b32 s3, s64, s65
M v[68:71], v[104:107], a[200:203], v[68:71]
ds_read_b64_tr_b16 v[192:193], v20 offset:16384
ds_read_b64_tr_b16 v[194:195], v20 offset:20480
M v[72:75], v[112:115], a[200:203], 0
s_add_u32 s25, s25, s3
s_lshl_b32 s3, s3, 3
s_add_u32 s26, s26, s3
M v[72:75], v[116:119], a[204:207], v[72:75]
ds_read_b64_tr_b16 v[196:197], v20 offset:24576
ds_read_b64_tr_b16 v[198:199], v20 offset:28672
M v[76:79], v[124:127], a[204:207], 0
M v[76:79], v[120:123], a[200:203], v[76:79]
ds_read_b64_tr_b16 v[200:201], v21 offset:16384
ds_read_b64_tr_b16 v[202:203], v21 offset:20480
M v[80:83], v[128:131], a[200:203], 0
ds_read_b64_tr_b16 v[204:205], v21 offset:24576
ds_read_b64_tr_b16 v[206:207], v21 offset:28672
M v[80:83], v[132:135], a[204:207], v[80:83]
ds_read_b64_tr_b16 v[208:209], v22 offset:16384
ds_read_b64_tr_b16 v[210:211], v22 offset:20480
M v[84:87], v[140:143], a[204:207], 0
ds_read_b64_tr_b16 v[212:213], v22 offset:24576
ds_read_b64_tr_b16 v[214:215], v22 offset:28672
M v[84:87], v[136:139], a[200:203], v[84:87]
ds_read_b64_tr_b16 v[216:217], v23 offset:16384
ds_read_b64_tr_b16 v[218:219], v23 offset:20480
M v[88:91], v[144:147], a[200:203], 0
ds_read_b64_tr_b16 v[220:221], v23 offset:24576
ds_read_b64_tr_b16 v[222:223], v23 offset:28672
M v[88:91], v[148:151], a[204:207], v[88:91]
M v[92:95], v[156:159], a[204:207], 0
M v[92:95], v[152:155], a[200:203], v[92:95]
s_mov_b32 s28, 3
Lk3_la:
s_waitcnt vmcnt(24) lgkmcnt(0)
s_barrier
M v[32:35], v[160:163], a[208:211], v[32:35]
s_add_u32 m0, s41, 32768
s_nop 0
buffer_load_dwordx4 v2, s[48:51], s26 offen offset:0 lds
M v[32:35], v[164:167], a[212:215], v[32:35]
ds_read_b64_tr_b16 v[96:97], v16 offset:32768
ds_read_b64_tr_b16 v[98:99], v16 offset:36864
M v[36:39], v[172:175], a[212:215], v[36:39]
buffer_load_dwordx4 v3, s[48:51], s26 offen offset:1024 lds
M v[36:39], v[168:171], a[208:211], v[36:39]
ds_read_b64_tr_b16 v[100:101], v16 offset:40960
ds_read_b64_tr_b16 v[102:103], v16 offset:45056
M v[40:43], v[176:179], a[208:211], v[40:43]
buffer_load_dwordx4 v4, s[48:51], s26 offen offset:2048 lds
M v[40:43], v[180:183], a[212:215], v[40:43]
ds_read_b64_tr_b16 v[104:105], v17 offset:32768
ds_read_b64_tr_b16 v[106:107], v17 offset:36864
M v[44:47], v[188:191], a[212:215], v[44:47]
buffer_load_dwordx4 v5, s[48:51], s26 offen offset:3072 lds
M v[44:47], v[184:187], a[208:211], v[44:47]
M v[48:51], v[192:195], a[208:211], v[48:51]
ds_read_b64_tr_b16 v[108:109], v17 offset:40960
ds_read_b64_tr_b16 v[110:111], v17 offset:45056
M v[48:51], v[196:199], a[212:215], v[48:51]
buffer_load_dwordx4 a[160:163], v1, s[44:47], s25 offen offset:0 sc1
M v[52:55], v[204:207], a[212:215], v[52:55]
ds_read_b64_tr_b16 v[112:113], v18 offset:32768
ds_read_b64_tr_b16 v[114:115], v18 offset:36864
M v[52:55], v[200:203], a[208:211], v[52:55]
buffer_load_dwordx4 a[164:167], v1, s[44:47], s25 offen offset:1024 sc1
M v[56:59], v[208:211], a[208:211], v[56:59]
ds_read_b64_tr_b16 v[116:117], v18 offset:40960
ds_read_b64_tr_b16 v[118:119], v18 offset:45056
M v[56:59], v[212:215], a[212:215], v[56:59]
buffer_load_dwordx4 a[168:171], v1, s[44:47], s25 offen offset:2048 sc1
M v[60:63], v[220:223], a[212:215], v[60:63]
M v[60:63], v[216:219], a[208:211], v[60:63]
ds_read_b64_tr_b16 v[120:121], v19 offset:32768
ds_read_b64_tr_b16 v[122:123], v19 offset:36864
M v[64:67], v[160:163], a[216:219], v[64:67]
buffer_load_dwordx4 a[172:175], v1, s[44:47], s25 offen offset:3072 sc1
M v[64:67], v[164:167], a[220:223], v[64:67]
ds_read_b64_tr_b16 v[124:125], v19 offset:40960
ds_read_b64_tr_b16 v[126:127], v19 offset:45056
M v[68:71], v[172:175], a[220:223], v[68:71]
s_sub_u32 s39, s39, 1
s_cmp_eq_u32 s39, 0
s_cselect_b32 s3, s64, s65
M v[68:71], v[168:171], a[216:219], v[68:71]
ds_read_b64_tr_b16 v[128:129], v20 offset:32768
ds_read_b64_tr_b16 v[130:131], v20 offset:36864
M v[72:75], v[176:179], a[216:219], v[72:75]
s_add_u32 s25, s25, s3
s_lshl_b32 s3, s3, 3
s_add_u32 s26, s26, s3
M v[72:75], v[180:183], a[220:223], v[72:75]
ds_read_b64_tr_b16 v[132:133], v20 offset:40960
ds_read_b64_tr_b16 v[134:135], v20 offset:45056
M v[76:79], v[188:191], a[220:223], v[76:79]
M v[76:79], v[184:187], a[216:219], v[76:79]
ds_read_b64_tr_b16 v[136:137], v21 offset:32768
ds_read_b64_tr_b16 v[138:139], v21 offset:36864
M v[80:83], v[192:195], a[216:219], v[80:83]
ds_read_b64_tr_b16 v[140:141], v21 offset:40960
ds_read_b64_tr_b16 v[142:143], v21 offset:45056
M v[80:83], v[196:199], a[220:223], v[80:83]
ds_read_b64_tr_b16 v[144:145], v22 offset:32768
ds_read_b64_tr_b16 v[146:147], v22 offset:36864
M v[84:87], v[204:207], a[220:223], v[84:87]
ds_read_b64_tr_b16 v[148:149], v22 offset:40960
ds_read_b64_tr_b16 v[150:151], v22 offset:45056
M v[84:87], v[200:203], a[216:219], v[84:87]
ds_read_b64_tr_b16 v[152:153], v23 offset:32768
ds_read_b64_tr_b16 v[154:155], v23 offset:36864
M v[88:91], v[208:211], a[216:219], v[88:91]
ds_read_b64_tr_b16 v[156:157], v23 offset:40960
ds_read_b64_tr_b16 v[158:159], v23 offset:45056
M v[88:91], v[212:215], a[220:223], v[88:91]
M v[92:95], v[220:223], a[220:223], v[92:95]
M v[92:95], v[216:219], a[216:219], v[92:95]
s_waitcnt vmcnt(24) lgkmcnt(0)
s_barrier
M v[32:35], v[96:99], a[224:227], v[32:35]
s_add_u32 m0, s41, 49152
s_nop 0
buffer_load_dwordx4 v2, s[48:51], s26 offen offset:0 lds
M v[32:35], v[100:103], a[228:231], v[32:35]
ds_read_b64_tr_b16 v[160:161], v16 offset:49152
ds_read_b64_tr_b16 v[162:163], v16 offset:53248
M v[36:39], v[108:111], a[228:231], v[36:39]
buffer_load_dwordx4 v3, s[48:51], s26 offen offset:1024 lds
M v[36:39], v[104:107], a[224:227], v[36:39]
ds_read_b64_tr_b16 v[164:165], v16 offset:57344
ds_read_b64_tr_b16 v[166:167], v16 offset:61440
M v[40:43], v[112:115], a[224:227], v[40:43]
buffer_load_dwordx4 v4, s[48:51], s26 offen offset:2048 lds
M v[40:43], v[116:119], a[228:231], v[40:43]
ds_read_b64_tr_b16 v[168:169], v17 offset:49152
ds_read_b64_tr_b16 v[170:171], v17 offset:53248
M v[44:47], v[124:127], a[228:231], v[44:47]
buffer_load_dwordx4 v5, s[48:51], s26 offen offset:3072 lds
M v[44:47], v[120:123], a[224:227], v[44:47]
M v[48:51], v[128:131], a[224:227], v[48:51]
ds_read_b64_tr_b16 v[172:173], v17 offset:57344
ds_read_b64_tr_b16 v[174:175], v17 offset:61440
M v[48:51], v[132:135], a[228:231], v[48:51]
buffer_load_dwordx4 a[176:179], v1, s[44:47], s25 offen offset:0 sc1
M v[52:55], v[140:143], a[228:231], v[52:55]
ds_read_b64_tr_b16 v[176:177], v18 offset:49152
ds_read_b64_tr_b16 v[178:179], v18 offset:53248
M v[52:55], v[136:139], a[224:227], v[52:55]
buffer_load_dwordx4 a[180:183], v1, s[44:47], s25 offen offset:1024 sc1
M v[56:59], v[144:147], a[224:227], v[56:59]
ds_read_b64_tr_b16 v[180:181], v18 offset:57344
ds_read_b64_tr_b16 v[182:183], v18 offset:61440
M v[56:59], v[148:151], a[228:231], v[56:59]
buffer_load_dwordx4 a[184:187], v1, s[44:47], s25 offen offset:2048 sc1
M v[60:63], v[156:159], a[228:231], v[60:63]
M v[60:63], v[152:155], a[224:227], v[60:63]
ds_read_b64_tr_b16 v[184:185], v19 offset:49152
ds_read_b64_tr_b16 v[186:187], v19 offset:53248
M v[64:67], v[96:99], a[232:235], v[64:67]
buffer_load_dwordx4 a[188:191], v1, s[44:47], s25 offen offset:3072 sc1
M v[64:67], v[100:103], a[236:239], v[64:67]
ds_read_b64_tr_b16 v[188:189], v19 offset:57344
ds_read_b64_tr_b16 v[190:191], v19 offset:61440
M v[68:71], v[108:111], a[236:239], v[68:71]
s_sub_u32 s39, s39, 1
s_cmp_eq_u32 s39, 0
s_cselect_b32 s3, s64, s65
M v[68:71], v[104:107], a[232:235], v[68:71]
ds_read_b64_tr_b16 v[192:193], v20 offset:49152
ds_read_b64_tr_b16 v[194:195], v20 offset:53248
M v[72:75], v[112:115], a[232:235], v[72:75]
s_add_u32 s25, s25, s3
s_lshl_b32 s3, s3, 3
s_add_u32 s26, s26, s3
M v[72:75], v[116:119], a[236:239], v[72:75]
ds_read_b64_tr_b16 v[196:197], v20 offset:57344
ds_read_b64_tr_b16 v[198:199], v20 offset:61440
M v[76:79], v[124:127], a[236:239], v[76:79]
M v[76:79], v[120:123], a[232:235], v[76:79]
ds_read_b64_tr_b16 v[200:201], v21 offset:49152
ds_read_b64_tr_b16 v[202:203], v21 offset:53248
M v[80:83], v[128:131], a[232:235], v[80:83]
ds_read_b64_tr_b16 v[204:205], v21 offset:57344
ds_read_b64_tr_b16 v[206:207], v21 offset:61440
M v[80:83], v[132:135], a[236:239], v[80:83]
ds_read_b64_tr_b16 v[208:209], v22 offset:49152
ds_read_b64_tr_b16 v[210:211], v22 offset:53248
M v[84:87], v[140:143], a[236:239], v[84:87]
ds_read_b64_tr_b16 v[212:213], v22 offset:57344
ds_read_b64_tr_b16 v[214:215], v22 offset:61440
M v[84:87], v[136:139], a[232:235], v[84:87]
ds_read_b64_tr_b16 v[216:217], v23 offset:49152
ds_read_b64_tr_b16 v[218:219], v23 offset:53248
M v[88:91], v[144:147], a[232:235], v[88:91]
ds_read_b64_tr_b16 v[220:221], v23 offset:57344
ds_read_b64_tr_b16 v[222:223], v23 offset:61440
M v[88:91], v[148:151], a[236:239], v[88:91]
M v[92:95], v[156:159], a[236:239], v[92:95]
M v[92:95], v[152:155], a[232:235], v[92:95]
s_waitcnt vmcnt(24) lgkmcnt(0)
s_barrier
M v[32:35], v[160:163], a[240:243], v[32:35]
s_add_u32 m0, s41, 65536
s_nop 0
buffer_load_dwordx4 v2, s[48:51], s26 offen offset:0 lds
M v[32:35], v[164:167], a[244:247], v[32:35]
ds_read_b64_tr_b16 v[96:97], v8 offset:0
ds_read_b64_tr_b16 v[98:99], v8 offset:4096
M v[36:39], v[172:175], a[244:247], v[36:39]
buffer_load_dwordx4 v3, s[48:51], s26 offen offset:1024 lds
M v[36:39], v[168:171], a[240:243], v[36:39]
ds_read_b64_tr_b16 v[100:101], v8 offset:8192
ds_read_b64_tr_b16 v[102:103], v8 offset:12288
M v[40:43], v[176:179], a[240:243], v[40:43]
buffer_load_dwordx4 v4, s[48:51], s26 offen offset:2048 lds
M v[40:43], v[180:183], a[244:247], v[40:43]
ds_read_b64_tr_b16 v[104:105], v9 offset:0
ds_read_b64_tr_b16 v[106:107], v9 offset:4096
M v[44:47], v[188:191], a[244:247], v[44:47]
buffer_load_dwordx4 v5, s[48:51], s26 offen offset:3072 lds
M v[44:47], v[184:187], a[240:243], v[44:47]
M v[48:51], v[192:195], a[240:243], v[48:51]
ds_read_b64_tr_b16 v[108:109], v9 offset:8192
ds_read_b64_tr_b16 v[110:111], v9 offset:12288
M v[48:51], v[196:199], a[244:247], v[48:51]
buffer_load_dwordx4 a[192:195], v1, s[44:47], s25 offen offset:0 sc1
M v[52:55], v[204:207], a[244:247], v[52:55]
ds_read_b64_tr_b16 v[112:113], v10 offset:0
ds_read_b64_tr_b16 v[114:115], v10 offset:4096
M v[52:55], v[200:203], a[240:243], v[52:55]
buffer_load_dwordx4 a[196:199], v1, s[44:47], s25 offen offset:1024 sc1
M v[56:59], v[208:211], a[240:243], v[56:59]
ds_read_b64_tr_b16 v[116:117], v10 offset:8192
ds_read_b64_tr_b16 v[118:119], v10 offset:12288
M v[56:59], v[212:215], a[244:247], v[56:59]
buffer_load_dwordx4 a[200:203], v1, s[44:47], s25 offen offset:2048 sc1
M v[60:63], v[220:223], a[244:247], v[60:63]
M v[60:63], v[216:219], a[240:243], v[60:63]
ds_read_b64_tr_b16 v[120:121], v11 offset:0
ds_read_b64_tr_b16 v[122:123], v11 offset:4096
M v[64:67], v[160:163], a[248:251], v[64:67]
buffer_load_dwordx4 a[204:207], v1, s[44:47], s25 offen offset:3072 sc1
M v[64:67], v[164:167], a[252:255], v[64:67]
ds_read_b64_tr_b16 v[124:125], v11 offset:8192
ds_read_b64_tr_b16 v[126:127], v11 offset:12288
M v[68:71], v[172:175], a[252:255], v[68:71]
s_sub_u32 s39, s39, 1
s_cmp_eq_u32 s39, 0
s_cselect_b32 s3, s64, s65
M v[68:71], v[168:171], a[248:251], v[68:71]
ds_read_b64_tr_b16 v[128:129], v12 offset:0
ds_read_b64_tr_b16 v[130:131], v12 offset:4096
M v[72:75], v[176:179], a[248:251], v[72:75]
s_add_u32 s25, s25, s3
s_lshl_b32 s3, s3, 3
s_add_u32 s26, s26, s3
M v[72:75], v[180:183], a[252:255], v[72:75]
ds_read_b64_tr_b16 v[132:133], v12 offset:8192
ds_read_b64_tr_b16 v[134:135], v12 offset:12288
M v[76:79], v[188:191], a[252:255], v[76:79]
M v[76:79], v[184:187], a[248:251], v[76:79]
ds_read_b64_tr_b16 v[136:137], v13 offset:0
ds_read_b64_tr_b16 v[138:139], v13 offset:4096
M v[80:83], v[192:195], a[248:251], v[80:83]
ds_read_b64_tr_b16 v[140:141], v13 offset:8192
ds_read_b64_tr_b16 v[142:143], v13 offset:12288
M v[80:83], v[196:199], a[252:255], v[80:83]
ds_read_b64_tr_b16 v[144:145], v14 offset:0
ds_read_b64_tr_b16 v[146:147], v14 offset:4096
M v[84:87], v[204:207], a[252:255], v[84:87]
ds_read_b64_tr_b16 v[148:149], v14 offset:8192
ds_read_b64_tr_b16 v[150:151], v14 offset:12288
M v[84:87], v[200:203], a[248:251], v[84:87]
ds_read_b64_tr_b16 v[152:153], v15 offset:0
ds_read_b64_tr_b16 v[154:155], v15 offset:4096
M v[88:91], v[208:211], a[248:251], v[88:91]
ds_read_b64_tr_b16 v[156:157], v15 offset:8192
ds_read_b64_tr_b16 v[158:159], v15 offset:12288
M v[88:91], v[212:215], a[252:255], v[88:91]
M v[92:95], v[220:223], a[252:255], v[92:95]
M v[92:95], v[216:219], a[248:251], v[92:95]
s_waitcnt vmcnt(24) lgkmcnt(0)
s_barrier
M v[32:35], v[96:99], a[128:131], v[32:35]
s_add_u32 m0, s41, 81920
s_nop 0
buffer_load_dwordx4 v2, s[48:51], s26 offen offset:0 lds
M v[32:35], v[100:103], a[132:135], v[32:35]
ds_read_b64_tr_b16 v[160:161], v8 offset:16384
ds_read_b64_tr_b16 v[162:163], v8 offset:20480
M v[36:39], v[108:111], a[132:135], v[36:39]
buffer_load_dwordx4 v3, s[48:51], s26 offen offset:1024 lds
M v[36:39], v[104:107], a[128:131], v[36:39]
ds_read_b64_tr_b16 v[164:165], v8 offset:24576
ds_read_b64_tr_b16 v[166:167], v8 offset:28672
M v[40:43], v[112:115], a[128:131], v[40:43]
buffer_load_dwordx4 v4, s[48:51], s26 offen offset:2048 lds
M v[40:43], v[116:119], a[132:135], v[40:43]
ds_read_b64_tr_b16 v[168:169], v9 offset:16384
ds_read_b64_tr_b16 v[170:171], v9 offset:20480
M v[44:47], v[124:127], a[132:135], v[44:47]
buffer_load_dwordx4 v5, s[48:51], s26 offen offset:3072 lds
M v[44:47], v[120:123], a[128:131], v[44:47]
M v[48:51], v[128:131], a[128:131], v[48:51]
ds_read_b64_tr_b16 v[172:173], v9 offset:24576
ds_read_b64_tr_b16 v[174:175], v9 offset:28672
M v[48:51], v[132:135], a[132:135], v[48:51]
buffer_load_dwordx4 a[208:211], v1, s[44:47], s25 offen offset:0 sc1
M v[52:55], v[140:143], a[132:135], v[52:55]
ds_read_b64_tr_b16 v[176:177], v10 offset:16384
ds_read_b64_tr_b16 v[178:179], v10 offset:20480
M v[52:55], v[136:139], a[128:131], v[52:55]
buffer_load_dwordx4 a[212:215], v1, s[44:47], s25 offen offset:1024 sc1
M v[56:59], v[144:147], a[128:131], v[56:59]
ds_read_b64_tr_b16 v[180:181], v10 offset:24576
ds_read_b64_tr_b16 v[182:183], v10 offset:28672
M v[56:59], v[148:151], a[132:135], v[56:59]
buffer_load_dwordx4 a[216:219], v1, s[44:47], s25 offen offset:2048 sc1
M v[60:63], v[156:159], a[132:135], v[60:63]
M v[60:63], v[152:155], a[128:131], v[60:63]
ds_read_b64_tr_b16 v[184:185], v11 offset:16384
ds_read_b64_tr_b16 v[186:187], v11 offset:20480
M v[64:67], v[96:99], a[136:139], v[64:67]
buffer_load_dwordx4 a[220:223], v1, s[44:47], s25 offen offset:3072 sc1
M v[64:67], v[100:103], a[140:143], v[64:67]
ds_read_b64_tr_b16 v[188:189], v11 offset:24576
ds_read_b64_tr_b16 v[190:191], v11 offset:28672
M v[68:71], v[108:111], a[140:143], v[68:71]
s_sub_u32 s39, s39, 1
s_cmp_eq_u32 s39, 0
s_cselect_b32 s3, s64, s65
M v[68:71], v[104:107], a[136:139], v[68:71]
ds_read_b64_tr_b16 v[192:193], v12 offset:16384
ds_read_b64_tr_b16 v[194:195], v12 offset:20480
M v[72:75], v[112:115], a[136:139], v[72:75]
s_add_u32 s25, s25, s3
s_lshl_b32 s3, s3, 3
s_add_u32 s26, s26, s3
M v[72:75], v[116:119], a[140:143], v[72:75]
ds_read_b64_tr_b16 v[196:197], v12 offset:24576
ds_read_b64_tr_b16 v[198:199], v12 offset:28672
M v[76:79], v[124:127], a[140:143], v[76:79]
M v[76:79], v[120:123], a[136:139], v[76:79]
ds_read_b64_tr_b16 v[200:201], v13 offset:16384
ds_read_b64_tr_b16 v[202:203], v13 offset:20480
M v[80:83], v[128:131], a[136:139], v[80:83]
ds_read_b64_tr_b16 v[204:205], v13 offset:24576
ds_read_b64_tr_b16 v[206:207], v13 offset:28672
M v[80:83], v[132:135], a[140:143], v[80:83]
ds_read_b64_tr_b16 v[208:209], v14 offset:16384
ds_read_b64_tr_b16 v[210:211], v14 offset:20480
M v[84:87], v[140:143], a[140:143], v[84:87]
ds_read_b64_tr_b16 v[212:213], v14 offset:24576
ds_read_b64_tr_b16 v[214:215], v14 offset:28672
M v[84:87], v[136:139], a[136:139], v[84:87]
ds_read_b64_tr_b16 v[216:217], v15 offset:16384
ds_read_b64_tr_b16 v[218:219], v15 offset:20480
M v[88:91], v[144:147], a[136:139], v[88:91]
ds_read_b64_tr_b16 v[220:221], v15 offset:24576
ds_read_b64_tr_b16 v[222:223], v15 offset:28672
M v[88:91], v[148:151], a[140:143], v[88:91]
M v[92:95], v[156:159], a[140:143], v[92:95]
M v[92:95], v[152:155], a[136:139], v[92:95]
s_waitcnt vmcnt(24) lgkmcnt(0)
s_barrier
M v[32:35], v[160:163], a[144:147], v[32:35]
s_add_u32 m0, s41, 98304
s_nop 0
buffer_load_dwordx4 v2, s[48:51], s26 offen offset:0 lds
M v[32:35], v[164:167], a[148:151], v[32:35]
ds_read_b64_tr_b16 v[96:97], v8 offset:32768
ds_read_b64_tr_b16 v[98:99], v8 offset:36864
M v[36:39], v[172:175], a[148:151], v[36:39]
buffer_load_dwordx4 v3, s[48:51], s26 offen offset:1024 lds
M v[36:39], v[168:171], a[144:147], v[36:39]
ds_read_b64_tr_b16 v[100:101], v8 offset:40960
ds_read_b64_tr_b16 v[102:103], v8 offset:45056
M v[40:43], v[176:179], a[144:147], v[40:43]
buffer_load_dwordx4 v4, s[48:51], s26 offen offset:2048 lds
M v[40:43], v[180:183], a[148:151], v[40:43]
ds_read_b64_tr_b16 v[104:105], v9 offset:32768
ds_read_b64_tr_b16 v[106:107], v9 offset:36864
M v[44:47], v[188:191], a[148:151], v[44:47]
buffer_load_dwordx4 v5, s[48:51], s26 offen offset:3072 lds
M v[44:47], v[184:187], a[144:147], v[44:47]
M v[48:51], v[192:195], a[144:147], v[48:51]
ds_read_b64_tr_b16 v[108:109], v9 offset:40960
ds_read_b64_tr_b16 v[110:111], v9 offset:45056
M v[48:51], v[196:199], a[148:151], v[48:51]
buffer_load_dwordx4 a[224:227], v1, s[44:47], s25 offen offset:0 sc1
M v[52:55], v[204:207], a[148:151], v[52:55]
ds_read_b64_tr_b16 v[112:113], v10 offset:32768
ds_read_b64_tr_b16 v[114:115], v10 offset:36864
M v[52:55], v[200:203], a[144:147], v[52:55]
buffer_load_dwordx4 a[228:231], v1, s[44:47], s25 offen offset:1024 sc1
M v[56:59], v[208:211], a[144:147], v[56:59]
ds_read_b64_tr_b16 v[116:117], v10 offset:40960
ds_read_b64_tr_b16 v[118:119], v10 offset:45056
M v[56:59], v[212:215], a[148:151], v[56:59]
buffer_load_dwordx4 a[232:235], v1, s[44:47], s25 offen offset:2048 sc1
M v[60:63], v[220:223], a[148:151], v[60:63]
M v[60:63], v[216:219], a[144:147], v[60:63]
ds_read_b64_tr_b16 v[120:121], v11 offset:32768
ds_read_b64_tr_b16 v[122:123], v11 offset:36864
M v[64:67], v[160:163], a[152:155], v[64:67]
buffer_load_dwordx4 a[236:239], v1, s[44:47], s25 offen offset:3072 sc1
M v[64:67], v[164:167], a[156:159], v[64:67]
ds_read_b64_tr_b16 v[124:125], v11 offset:40960
ds_read_b64_tr_b16 v[126:127], v11 offset:45056
M v[68:71], v[172:175], a[156:159], v[68:71]
s_sub_u32 s39, s39, 1
s_cmp_eq_u32 s39, 0
s_cselect_b32 s3, s64, s65
M v[68:71], v[168:171], a[152:155], v[68:71]
ds_read_b64_tr_b16 v[128:129], v12 offset:32768
ds_read_b64_tr_b16 v[130:131], v12 offset:36864
M v[72:75], v[176:179], a[152:155], v[72:75]
s_add_u32 s25, s25, s3
s_lshl_b32 s3, s3, 3
s_add_u32 s26, s26, s3
M v[72:75], v[180:183], a[156:159], v[72:75]
ds_read_b64_tr_b16 v[132:133], v12 offset:40960
ds_read_b64_tr_b16 v[134:135], v12 offset:45056
M v[76:79], v[188:191], a[156:159], v[76:79]
M v[76:79], v[184:187], a[152:155], v[76:79]
ds_read_b64_tr_b16 v[136:137], v13 offset:32768
ds_read_b64_tr_b16 v[138:139], v13 offset:36864
M v[80:83], v[192:195], a[152:155], v[80:83]
ds_read_b64_tr_b16 v[140:141], v13 offset:40960
ds_read_b64_tr_b16 v[142:143], v13 offset:45056
M v[80:83], v[196:199], a[156:159], v[80:83]
ds_read_b64_tr_b16 v[144:145], v14 offset:32768
ds_read_b64_tr_b16 v[146:147], v14 offset:36864
M v[84:87], v[204:207], a[156:159], v[84:87]
ds_read_b64_tr_b16 v[148:149], v14 offset:40960
ds_read_b64_tr_b16 v[150:151], v14 offset:45056
M v[84:87], v[200:203], a[152:155], v[84:87]
ds_read_b64_tr_b16 v[152:153], v15 offset:32768
ds_read_b64_tr_b16 v[154:155], v15 offset:36864
M v[88:91], v[208:211], a[152:155], v[88:91]
ds_read_b64_tr_b16 v[156:157], v15 offset:40960
ds_read_b64_tr_b16 v[158:159], v15 offset:45056
M v[88:91], v[212:215], a[156:159], v[88:91]
M v[92:95], v[220:223], a[156:159], v[92:95]
M v[92:95], v[216:219], a[152:155], v[92:95]
s_waitcnt vmcnt(24) lgkmcnt(0)
s_barrier
M v[32:35], v[96:99], a[160:163], v[32:35]
s_add_u32 m0, s41, 114688
s_nop 0
buffer_load_dwordx4 v2, s[48:51], s26 offen offset:0 lds
M v[32:35], v[100:103], a[164:167], v[32:35]
ds_read_b64_tr_b16 v[160:161], v8 offset:49152
ds_read_b64_tr_b16 v[162:163], v8 offset:53248
M v[36:39], v[108:111], a[164:167], v[36:39]
buffer_load_dwordx4 v3, s[48:51], s26 offen offset:1024 lds
M v[36:39], v[104:107], a[160:163], v[36:39]
ds_read_b64_tr_b16 v[164:165], v8 offset:57344
ds_read_b64_tr_b16 v[166:167], v8 offset:61440
M v[40:43], v[112:115], a[160:163], v[40:43]
buffer_load_dwordx4 v4, s[48:51], s26 offen offset:2048 lds
M v[40:43], v[116:119], a[164:167], v[40:43]
ds_read_b64_tr_b16 v[168:169], v9 offset:49152
ds_read_b64_tr_b16 v[170:171], v9 offset:53248
M v[44:47], v[124:127], a[164:167], v[44:47]
buffer_load_dwordx4 v5, s[48:51], s26 offen offset:3072 lds
M v[44:47], v[120:123], a[160:163], v[44:47]
M v[48:51], v[128:131], a[160:163], v[48:51]
ds_read_b64_tr_b16 v[172:173], v9 offset:57344
ds_read_b64_tr_b16 v[174:175], v9 offset:61440
M v[48:51], v[132:135], a[164:167], v[48:51]
buffer_load_dwordx4 a[240:243], v1, s[44:47], s25 offen offset:0 sc1
M v[52:55], v[140:143], a[164:167], v[52:55]
ds_read_b64_tr_b16 v[176:177], v10 offset:49152
ds_read_b64_tr_b16 v[178:179], v10 offset:53248
M v[52:55], v[136:139], a[160:163], v[52:55]
buffer_load_dwordx4 a[244:247], v1, s[44:47], s25 offen offset:1024 sc1
M v[56:59], v[144:147], a[160:163], v[56:59]
ds_read_b64_tr_b16 v[180:181], v10 offset:57344
ds_read_b64_tr_b16 v[182:183], v10 offset:61440
M v[56:59], v[148:151], a[164:167], v[56:59]
buffer_load_dwordx4 a[248:251], v1, s[44:47], s25 offen offset:2048 sc1
M v[60:63], v[156:159], a[164:167], v[60:63]
M v[60:63], v[152:155], a[160:163], v[60:63]
ds_read_b64_tr_b16 v[184:185], v11 offset:49152
ds_read_b64_tr_b16 v[186:187], v11 offset:53248
M v[64:67], v[96:99], a[168:171], v[64:67]
buffer_load_dwordx4 a[252:255], v1, s[44:47], s25 offen offset:3072 sc1
M v[64:67], v[100:103], a[172:175], v[64:67]
ds_read_b64_tr_b16 v[188:189], v11 offset:57344
ds_read_b64_tr_b16 v[190:191], v11 offset:61440
M v[68:71], v[108:111], a[172:175], v[68:71]
s_sub_u32 s39, s39, 1
s_cmp_eq_u32 s39, 0
s_cselect_b32 s3, s64, s65
M v[68:71], v[104:107], a[168:171], v[68:71]
ds_read_b64_tr_b16 v[192:193], v12 offset:49152
ds_read_b64_tr_b16 v[194:195], v12 offset:53248
M v[72:75], v[112:115], a[168:171], v[72:75]
s_add_u32 s25, s25, s3
s_lshl_b32 s3, s3, 3
s_add_u32 s26, s26, s3
M v[72:75], v[116:119], a[172:175], v[72:75]
ds_read_b64_tr_b16 v[196:197], v12 offset:57344
ds_read_b64_tr_b16 v[198:199], v12 offset:61440
M v[76:79], v[124:127], a[172:175], v[76:79]
M v[76:79], v[120:123], a[168:171], v[76:79]
ds_read_b64_tr_b16 v[200:201], v13 offset:49152
ds_read_b64_tr_b16 v[202:203], v13 offset:53248
M v[80:83], v[128:131], a[168:171], v[80:83]
ds_read_b64_tr_b16 v[204:205], v13 offset:57344
ds_read_b64_tr_b16 v[206:207], v13 offset:61440
M v[80:83], v[132:135], a[172:175], v[80:83]
ds_read_b64_tr_b16 v[208:209], v14 offset:49152
ds_read_b64_tr_b16 v[210:211], v14 offset:53248
M v[84:87], v[140:143], a[172:175], v[84:87]
ds_read_b64_tr_b16 v[212:213], v14 offset:57344
ds_read_b64_tr_b16 v[214:215], v14 offset:61440
M v[84:87], v[136:139], a[168:171], v[84:87]
ds_read_b64_tr_b16 v[216:217], v15 offset:49152
ds_read_b64_tr_b16 v[218:219], v15 offset:53248
M v[88:91], v[144:147], a[168:171], v[88:91]
ds_read_b64_tr_b16 v[220:221], v15 offset:57344
ds_read_b64_tr_b16 v[222:223], v15 offset:61440
M v[88:91], v[148:151], a[172:175], v[88:91]
M v[92:95], v[156:159], a[172:175], v[92:95]
M v[92:95], v[152:155], a[168:171], v[92:95]
s_waitcnt vmcnt(24) lgkmcnt(0)
s_barrier
M v[32:35], v[160:163], a[176:179], v[32:35]
s_add_u32 m0, s41, 0
s_nop 0
buffer_load_dwordx4 v2, s[48:51], s26 offen offset:0 lds
M v[32:35], v[164:167], a[180:183], v[32:35]
ds_read_b64_tr_b16 v[96:97], v16 offset:0
ds_read_b64_tr_b16 v[98:99], v16 offset:4096
M v[36:39], v[172:175], a[180:183], v[36:39]
buffer_load_dwordx4 v3, s[48:51], s26 offen offset:1024 lds
M v[36:39], v[168:171], a[176:179], v[36:39]
ds_read_b64_tr_b16 v[100:101], v16 offset:8192
ds_read_b64_tr_b16 v[102:103], v16 offset:12288
M v[40:43], v[176:179], a[176:179], v[40:43]
buffer_load_dwordx4 v4, s[48:51], s26 offen offset:2048 lds
M v[40:43], v[180:183], a[180:183], v[40:43]
ds_read_b64_tr_b16 v[104:105], v17 offset:0
ds_read_b64_tr_b16 v[106:107], v17 offset:4096
M v[44:47], v[188:191], a[180:183], v[44:47]
buffer_load_dwordx4 v5, s[48:51], s26 offen offset:3072 lds
M v[44:47], v[184:187], a[176:179], v[44:47]
M v[48:51], v[192:195], a[176:179], v[48:51]
ds_read_b64_tr_b16 v[108:109], v17 offset:8192
ds_read_b64_tr_b16 v[110:111], v17 offset:12288
M v[48:51], v[196:199], a[180:183], v[48:51]
buffer_load_dwordx4 a[128:131], v1, s[44:47], s25 offen offset:0 sc1
M v[52:55], v[204:207], a[180:183], v[52:55]
ds_read_b64_tr_b16 v[112:113], v18 offset:0
ds_read_b64_tr_b16 v[114:115], v18 offset:4096
M v[52:55], v[200:203], a[176:179], v[52:55]
buffer_load_dwordx4 a[132:135], v1, s[44:47], s25 offen offset:1024 sc1
M v[56:59], v[208:211], a[176:179], v[56:59]
ds_read_b64_tr_b16 v[116:117], v18 offset:8192
ds_read_b64_tr_b16 v[118:119], v18 offset:12288
M v[56:59], v[212:215], a[180:183], v[56:59]
buffer_load_dwordx4 a[136:139], v1, s[44:47], s25 offen offset:2048 sc1
M v[60:63], v[220:223], a[180:183], v[60:63]
M v[60:63], v[216:219], a[176:179], v[60:63]
ds_read_b64_tr_b16 v[120:121], v19 offset:0
ds_read_b64_tr_b16 v[122:123], v19 offset:4096
M v[64:67], v[160:163], a[184:187], v[64:67]
buffer_load_dwordx4 a[140:143], v1, s[44:47], s25 offen offset:3072 sc1
M v[64:67], v[164:167], a[188:191], v[64:67]
ds_read_b64_tr_b16 v[124:125], v19 offset:8192
ds_read_b64_tr_b16 v[126:127], v19 offset:12288
M v[68:71], v[172:175], a[188:191], v[68:71]
s_sub_u32 s39, s39, 1
s_cmp_eq_u32 s39, 0
s_cselect_b32 s3, s64, s65
M v[68:71], v[168:171], a[184:187], v[68:71]
ds_read_b64_tr_b16 v[128:129], v20 offset:0
ds_read_b64_tr_b16 v[130:131], v20 offset:4096
M v[72:75], v[176:179], a[184:187], v[72:75]
s_add_u32 s25, s25, s3
s_lshl_b32 s3, s3, 3
s_add_u32 s26, s26, s3
M v[72:75], v[180:183], a[188:191], v[72:75]
ds_read_b64_tr_b16 v[132:133], v20 offset:8192
ds_read_b64_tr_b16 v[134:135], v20 offset:12288
M v[76:79], v[188:191], a[188:191], v[76:79]
M v[76:79], v[184:187], a[184:187], v[76:79]
ds_read_b64_tr_b16 v[136:137], v21 offset:0
ds_read_b64_tr_b16 v[138:139], v21 offset:4096
M v[80:83], v[192:195], a[184:187], v[80:83]
ds_read_b64_tr_b16 v[140:141], v21 offset:8192
ds_read_b64_tr_b16 v[142:143], v21 offset:12288
M v[80:83], v[196:199], a[188:191], v[80:83]
ds_read_b64_tr_b16 v[144:145], v22 offset:0
ds_read_b64_tr_b16 v[146:147], v22 offset:4096
M v[84:87], v[204:207], a[188:191], v[84:87]
ds_read_b64_tr_b16 v[148:149], v22 offset:8192
ds_read_b64_tr_b16 v[150:151], v22 offset:12288
M v[84:87], v[200:203], a[184:187], v[84:87]
ds_read_b64_tr_b16 v[152:153], v23 offset:0
ds_read_b64_tr_b16 v[154:155], v23 offset:4096
M v[88:91], v[208:211], a[184:187], v[88:91]
ds_read_b64_tr_b16 v[156:157], v23 offset:8192
ds_read_b64_tr_b16 v[158:159], v23 offset:12288
M v[88:91], v[212:215], a[188:191], v[88:91]
M v[92:95], v[220:223], a[188:191], v[92:95]
M v[92:95], v[216:219], a[184:187], v[92:95]
s_waitcnt vmcnt(24) lgkmcnt(0)
s_barrier
M v[32:35], v[96:99], a[192:195], v[32:35]
s_add_u32 m0, s41, 16384
s_nop 0
buffer_load_dwordx4 v2, s[48:51], s26 offen offset:0 lds
M v[32:35], v[100:103], a[196:199], v[32:35]
ds_read_b64_tr_b16 v[160:161], v16 offset:16384
ds_read_b64_tr_b16 v[162:163], v16 offset:20480
M v[36:39], v[108:111], a[196:199], v[36:39]
buffer_load_dwordx4 v3, s[48:51], s26 offen offset:1024 lds
M v[36:39], v[104:107], a[192:195], v[36:39]
ds_read_b64_tr_b16 v[164:165], v16 offset:24576
ds_read_b64_tr_b16 v[166:167], v16 offset:28672
M v[40:43], v[112:115], a[192:195], v[40:43]
buffer_load_dwordx4 v4, s[48:51], s26 offen offset:2048 lds
M v[40:43], v[116:119], a[196:199], v[40:43]
ds_read_b64_tr_b16 v[168:169], v17 offset:16384
ds_read_b64_tr_b16 v[170:171], v17 offset:20480
M v[44:47], v[124:127], a[196:199], v[44:47]
buffer_load_dwordx4 v5, s[48:51], s26 offen offset:3072 lds
M v[44:47], v[120:123], a[192:195], v[44:47]
M v[48:51], v[128:131], a[192:195], v[48:51]
ds_read_b64_tr_b16 v[172:173], v17 offset:24576
ds_read_b64_tr_b16 v[174:175], v17 offset:28672
M v[48:51], v[132:135], a[196:199], v[48:51]
buffer_load_dwordx4 a[144:147], v1, s[44:47], s25 offen offset:0 sc1
M v[52:55], v[140:143], a[196:199], v[52:55]
ds_read_b64_tr_b16 v[176:177], v18 offset:16384
ds_read_b64_tr_b16 v[178:179], v18 offset:20480
M v[52:55], v[136:139], a[192:195], v[52:55]
buffer_load_dwordx4 a[148:151], v1, s[44:47], s25 offen offset:1024 sc1
M v[56:59], v[144:147], a[192:195], v[56:59]
ds_read_b64_tr_b16 v[180:181], v18 offset:24576
ds_read_b64_tr_b16 v[182:183], v18 offset:28672
M v[56:59], v[148:151], a[196:199], v[56:59]
buffer_load_dwordx4 a[152:155], v1, s[44:47], s25 offen offset:2048 sc1
M v[60:63], v[156:159], a[196:199], v[60:63]
M v[60:63], v[152:155], a[192:195], v[60:63]
ds_read_b64_tr_b16 v[184:185], v19 offset:16384
ds_read_b64_tr_b16 v[186:187], v19 offset:20480
M v[64:67], v[96:99], a[200:203], v[64:67]
buffer_load_dwordx4 a[156:159], v1, s[44:47], s25 offen offset:3072 sc1
M v[64:67], v[100:103], a[204:207], v[64:67]
ds_read_b64_tr_b16 v[188:189], v19 offset:24576
ds_read_b64_tr_b16 v[190:191], v19 offset:28672
M v[68:71], v[108:111], a[204:207], v[68:71]
s_sub_u32 s39, s39, 1
s_cmp_eq_u32 s39, 0
s_cselect_b32 s3, s64, s65
M v[68:71], v[104:107], a[200:203], v[68:71]
ds_read_b64_tr_b16 v[192:193], v20 offset:16384
ds_read_b64_tr_b16 v[194:195], v20 offset:20480
M v[72:75], v[112:115], a[200:203], v[72:75]
s_add_u32 s25, s25, s3
s_lshl_b32 s3, s3, 3
s_add_u32 s26, s26, s3
M v[72:75], v[116:119], a[204:207], v[72:75]
ds_read_b64_tr_b16 v[196:197], v20 offset:24576
ds_read_b64_tr_b16 v[198:199], v20 offset:28672
M v[76:79], v[124:127], a[204:207], v[76:79]
M v[76:79], v[120:123], a[200:203], v[76:79]
ds_read_b64_tr_b16 v[200:201], v21 offset:16384
ds_read_b64_tr_b16 v[202:203], v21 offset:20480
M v[80:83], v[128:131], a[200:203], v[80:83]
ds_read_b64_tr_b16 v[204:205], v21 offset:24576
ds_read_b64_tr_b16 v[206:207], v21 offset:28672
M v[80:83], v[132:135], a[204:207], v[80:83]
ds_read_b64_tr_b16 v[208:209], v22 offset:16384
ds_read_b64_tr_b16 v[210:211], v22 offset:20480
M v[84:87], v[140:143], a[204:207], v[84:87]
ds_read_b64_tr_b16 v[212:213], v22 offset:24576
ds_read_b64_tr_b16 v[214:215], v22 offset:28672
M v[84:87], v[136:139], a[200:203], v[84:87]
ds_read_b64_tr_b16 v[216:217], v23 offset:16384
ds_read_b64_tr_b16 v[218:219], v23 offset:20480
M v[88:91], v[144:147], a[200:203], v[88:91]
ds_read_b64_tr_b16 v[220:221], v23 offset:24576
ds_read_b64_tr_b16 v[222:223], v23 offset:28672
M v[88:91], v[148:151], a[204:207], v[88:91]
M v[92:95], v[156:159], a[204:207], v[92:95]
M v[92:95], v[152:155], a[200:203], v[92:95]
s_sub_u32 s28, s28, 1
s_cmp_lg_u32 s28, 0
s_cbranch_scc1 Lk3_la
s_waitcnt vmcnt(24) lgkmcnt(0)
s_barrier
M v[32:35], v[160:163], a[208:211], v[32:35]
s_add_u32 m0, s41, 32768
s_nop 0
buffer_load_dwordx4 v2, s[48:51], s26 offen offset:0 lds
M v[32:35], v[164:167], a[212:215], v[32:35]
ds_read_b64_tr_b16 v[96:97], v16 offset:32768
ds_read_b64_tr_b16 v[98:99], v16 offset:36864
M v[36:39], v[172:175], a[212:215], v[36:39]
buffer_load_dwordx4 v3, s[48:51], s26 offen offset:1024 lds
M v[36:39], v[168:171], a[208:211], v[36:39]
ds_read_b64_tr_b16 v[100:101], v16 offset:40960
ds_read_b64_tr_b16 v[102:103], v16 offset:45056
M v[40:43], v[176:179], a[208:211], v[40:43]
buffer_load_dwordx4 v4, s[48:51], s26 offen offset:2048 lds
M v[40:43], v[180:183], a[212:215], v[40:43]
ds_read_b64_tr_b16 v[104:105], v17 offset:32768
ds_read_b64_tr_b16 v[106:107], v17 offset:36864
M v[44:47], v[188:191], a[212:215], v[44:47]
buffer_load_dwordx4 v5, s[48:51], s26 offen offset:3072 lds
M v[44:47], v[184:187], a[208:211], v[44:47]
M v[48:51], v[192:195], a[208:211], v[48:51]
ds_read_b64_tr_b16 v[108:109], v17 offset:40960
ds_read_b64_tr_b16 v[110:111], v17 offset:45056
M v[48:51], v[196:199], a[212:215], v[48:51]
buffer_load_dwordx4 a[160:163], v1, s[44:47], s25 offen offset:0 sc1
M v[52:55], v[204:207], a[212:215], v[52:55]
ds_read_b64_tr_b16 v[112:113], v18 offset:32768
ds_read_b64_tr_b16 v[114:115], v18 offset:36864
M v[52:55], v[200:203], a[208:211], v[52:55]
buffer_load_dwordx4 a[164:167], v1, s[44:47], s25 offen offset:1024 sc1
M v[56:59], v[208:211], a[208:211], v[56:59]
ds_read_b64_tr_b16 v[116:117], v18 offset:40960
ds_read_b64_tr_b16 v[118:119], v18 offset:45056
M v[56:59], v[212:215], a[212:215], v[56:59]
buffer_load_dwordx4 a[168:171], v1, s[44:47], s25 offen offset:2048 sc1
M v[60:63], v[220:223], a[212:215], v[60:63]
M v[60:63], v[216:219], a[208:211], v[60:63]
ds_read_b64_tr_b16 v[120:121], v19 offset:32768
ds_read_b64_tr_b16 v[122:123], v19 offset:36864
M v[64:67], v[160:163], a[216:219], v[64:67]
buffer_load_dwordx4 a[172:175], v1, s[44:47], s25 offen offset:3072 sc1
M v[64:67], v[164:167], a[220:223], v[64:67]
ds_read_b64_tr_b16 v[124:125], v19 offset:40960
ds_read_b64_tr_b16 v[126:127], v19 offset:45056
M v[68:71], v[172:175], a[220:223], v[68:71]
s_sub_u32 s39, s39, 1
s_cmp_eq_u32 s39, 0
s_cselect_b32 s3, s64, s65
M v[68:71], v[168:171], a[216:219], v[68:71]
ds_read_b64_tr_b16 v[128:129], v20 offset:32768
ds_read_b64_tr_b16 v[130:131], v20 offset:36864
M v[72:75], v[176:179], a[216:219], v[72:75]
s_add_u32 s25, s25, s3
s_lshl_b32 s3, s3, 3
s_add_u32 s26, s26, s3
M v[72:75], v[180:183], a[220:223], v[72:75]
ds_read_b64_tr_b16 v[132:133], v20 offset:40960
ds_read_b64_tr_b16 v[134:135], v20 offset:45056
M v[76:79], v[188:191], a[220:223], v[76:79]
M v[76:79], v[184:187], a[216:219], v[76:79]
ds_read_b64_tr_b16 v[136:137], v21 offset:32768
ds_read_b64_tr_b16 v[138:139], v21 offset:36864
M v[80:83], v[192:195], a[216:219], v[80:83]
ds_read_b64_tr_b16 v[140:141], v21 offset:40960
ds_read_b64_tr_b16 v[142:143], v21 offset:45056
M v[80:83], v[196:199], a[220:223], v[80:83]
ds_read_b64_tr_b16 v[144:145], v22 offset:32768
ds_read_b64_tr_b16 v[146:147], v22 offset:36864
M v[84:87], v[204:207], a[220:223], v[84:87]
ds_read_b64_tr_b16 v[148:149], v22 offset:40960
ds_read_b64_tr_b16 v[150:151], v22 offset:45056
M v[84:87], v[200:203], a[216:219], v[84:87]
ds_read_b64_tr_b16 v[152:153], v23 offset:32768
ds_read_b64_tr_b16 v[154:155], v23 offset:36864
M v[88:91], v[208:211], a[216:219], v[88:91]
ds_read_b64_tr_b16 v[156:157], v23 offset:40960
ds_read_b64_tr_b16 v[158:159], v23 offset:45056
M v[88:91], v[212:215], a[220:223], v[88:91]
M v[92:95], v[220:223], a[220:223], v[92:95]
M v[92:95], v[216:219], a[216:219], v[92:95]
s_waitcnt vmcnt(24) lgkmcnt(0)
s_barrier
M v[32:35], v[96:99], a[224:227], v[32:35]
s_add_u32 m0, s41, 49152
s_nop 0
buffer_load_dwordx4 v2, s[48:51], s26 offen offset:0 lds
M v[32:35], v[100:103], a[228:231], v[32:35]
ds_read_b64_tr_b16 v[160:161], v16 offset:49152
ds_read_b64_tr_b16 v[162:163], v16 offset:53248
M v[36:39], v[108:111], a[228:231], v[36:39]
buffer_load_dwordx4 v3, s[48:51], s26 offen offset:1024 lds
M v[36:39], v[104:107], a[224:227], v[36:39]
ds_read_b64_tr_b16 v[164:165], v16 offset:57344
ds_read_b64_tr_b16 v[166:167], v16 offset:61440
M v[40:43], v[112:115], a[224:227], v[40:43]
buffer_load_dwordx4 v4, s[48:51], s26 offen offset:2048 lds
M v[40:43], v[116:119], a[228:231], v[40:43]
ds_read_b64_tr_b16 v[168:169], v17 offset:49152
ds_read_b64_tr_b16 v[170:171], v17 offset:53248
M v[44:47], v[124:127], a[228:231], v[44:47]
buffer_load_dwordx4 v5, s[48:51], s26 offen offset:3072 lds
M v[44:47], v[120:123], a[224:227], v[44:47]
M v[48:51], v[128:131], a[224:227], v[48:51]
ds_read_b64_tr_b16 v[172:173], v17 offset:57344
ds_read_b64_tr_b16 v[174:175], v17 offset:61440
M v[48:51], v[132:135], a[228:231], v[48:51]
buffer_load_dwordx4 a[176:179], v1, s[44:47], s25 offen offset:0 sc1
M v[52:55], v[140:143], a[228:231], v[52:55]
ds_read_b64_tr_b16 v[176:177], v18 offset:49152
ds_read_b64_tr_b16 v[178:179], v18 offset:53248
M v[52:55], v[136:139], a[224:227], v[52:55]
buffer_load_dwordx4 a[180:183], v1, s[44:47], s25 offen offset:1024 sc1
M v[56:59], v[144:147], a[224:227], v[56:59]
ds_read_b64_tr_b16 v[180:181], v18 offset:57344
ds_read_b64_tr_b16 v[182:183], v18 offset:61440
M v[56:59], v[148:151], a[228:231], v[56:59]
buffer_load_dwordx4 a[184:187], v1, s[44:47], s25 offen offset:2048 sc1
M v[60:63], v[156:159], a[228:231], v[60:63]
M v[60:63], v[152:155], a[224:227], v[60:63]
ds_read_b64_tr_b16 v[184:185], v19 offset:49152
ds_read_b64_tr_b16 v[186:187], v19 offset:53248
M v[64:67], v[96:99], a[232:235], v[64:67]
buffer_load_dwordx4 a[188:191], v1, s[44:47], s25 offen offset:3072 sc1
M v[64:67], v[100:103], a[236:239], v[64:67]
ds_read_b64_tr_b16 v[188:189], v19 offset:57344
ds_read_b64_tr_b16 v[190:191], v19 offset:61440
M v[68:71], v[108:111], a[236:239], v[68:71]
s_sub_u32 s39, s39, 1
s_cmp_eq_u32 s39, 0
s_cselect_b32 s3, s64, s65
M v[68:71], v[104:107], a[232:235], v[68:71]
ds_read_b64_tr_b16 v[192:193], v20 offset:49152
ds_read_b64_tr_b16 v[194:195], v20 offset:53248
M v[72:75], v[112:115], a[232:235], v[72:75]
s_add_u32 s25, s25, s3
s_lshl_b32 s3, s3, 3
s_add_u32 s26, s26, s3
M v[72:75], v[116:119], a[236:239], v[72:75]
ds_read_b64_tr_b16 v[196:197], v20 offset:57344
ds_read_b64_tr_b16 v[198:199], v20 offset:61440
M v[76:79], v[124:127], a[236:239], v[76:79]
M v[76:79], v[120:123], a[232:235], v[76:79]
ds_read_b64_tr_b16 v[200:201], v21 offset:49152
ds_read_b64_tr_b16 v[202:203], v21 offset:53248
M v[80:83], v[128:131], a[232:235], v[80:83]
ds_read_b64_tr_b16 v[204:205], v21 offset:57344
ds_read_b64_tr_b16 v[206:207], v21 offset:61440
M v[80:83], v[132:135], a[236:239], v[80:83]
ds_read_b64_tr_b16 v[208:209], v22 offset:49152
ds_read_b64_tr_b16 v[210:211], v22 offset:53248
M v[84:87], v[140:143], a[236:239], v[84:87]
ds_read_b64_tr_b16 v[212:213], v22 offset:57344
ds_read_b64_tr_b16 v[214:215], v22 offset:61440
M v[84:87], v[136:139], a[232:235], v[84:87]
ds_read_b64_tr_b16 v[216:217], v23 offset:49152
ds_read_b64_tr_b16 v[218:219], v23 offset:53248
M v[88:91], v[144:147], a[232:235], v[88:91]
ds_read_b64_tr_b16 v[220:221], v23 offset:57344
ds_read_b64_tr_b16 v[222:223], v23 offset:61440
M v[88:91], v[148:151], a[236:239], v[88:91]
M v[92:95], v[156:159], a[236:239], v[92:95]
M v[92:95], v[152:155], a[232:235], v[92:95]
s_waitcnt vmcnt(24) lgkmcnt(0)
s_barrier
M v[32:35], v[160:163], a[240:243], v[32:35]
s_mov_b64 s[44:45], s[34:35]
s_mov_b32 s46, 4194304
s_mov_b64 s[48:49], s[36:37]
s_mov_b32 s50, 2097152
s_mov_b32 s25, s32
s_mov_b32 s26, s33
s_add_u32 m0, s42, 65536
s_nop 0
buffer_load_dwordx4 v6, s[48:51], s26 offen offset:0 lds
M v[32:35], v[164:167], a[244:247], v[32:35]
ds_read_b64_tr_b16 v[96:97], v8 offset:0
ds_read_b64_tr_b16 v[98:99], v8 offset:4096
M v[36:39], v[172:175], a[244:247], v[36:39]
buffer_load_dwordx4 v7, s[48:51], s26 offen offset:1024 lds
M v[36:39], v[168:171], a[240:243], v[36:39]
ds_read_b64_tr_b16 v[100:101], v8 offset:8192
ds_read_b64_tr_b16 v[102:103], v8 offset:12288
M v[40:43], v[176:179], a[240:243], v[40:43]
M v[40:43], v[180:183], a[244:247], v[40:43]
buffer_load_dwordx4 a[192:195], v1, s[44:47], s25 offen offset:0 sc1
M v[44:47], v[188:191], a[244:247], v[44:47]
ds_read_b64_tr_b16 v[104:105], v9 offset:0
ds_read_b64_tr_b16 v[106:107], v9 offset:4096
M v[44:47], v[184:187], a[240:243], v[44:47]
buffer_load_dwordx4 a[196:199], v1, s[44:47], s25 offen offset:1024 sc1
M v[48:51], v[192:195], a[240:243], v[48:51]
M v[48:51], v[196:199], a[244:247], v[48:51]
ds_read_b64_tr_b16 v[108:109], v9 offset:8192
ds_read_b64_tr_b16 v[110:111], v9 offset:12288
M v[52:55], v[204:207], a[244:247], v[52:55]
buffer_load_dwordx4 a[200:203], v1, s[44:47], s25 offen offset:2048 sc1
M v[52:55], v[200:203], a[240:243], v[52:55]
ds_read_b64_tr_b16 v[112:113], v10 offset:0
ds_read_b64_tr_b16 v[114:115], v10 offset:4096
M v[56:59], v[208:211], a[240:243], v[56:59]
M v[56:59], v[212:215], a[244:247], v[56:59]
buffer_load_dwordx4 a[204:207], v1, s[44:47], s25 offen offset:3072 sc1
M v[60:63], v[220:223], a[244:247], v[60:63]
ds_read_b64_tr_b16 v[116:117], v10 offset:8192
ds_read_b64_tr_b16 v[118:119], v10 offset:12288
M v[60:63], v[216:219], a[240:243], v[60:63]
s_add_u32 s25, s25, 16384
s_add_u32 s26, s26, 131072
M v[64:67], v[160:163], a[248:251], v[64:67]
ds_read_b64_tr_b16 v[120:121], v11 offset:0
ds_read_b64_tr_b16 v[122:123], v11 offset:4096
M v[64:67], v[164:167], a[252:255], v[64:67]
M v[68:71], v[172:175], a[252:255], v[68:71]
ds_read_b64_tr_b16 v[124:125], v11 offset:8192
ds_read_b64_tr_b16 v[126:127], v11 offset:12288
M v[68:71], v[168:171], a[248:251], v[68:71]
ds_read_b64_tr_b16 v[128:129], v12 offset:0
ds_read_b64_tr_b16 v[130:131], v12 offset:4096
M v[72:75], v[176:179], a[248:251], v[72:75]
ds_read_b64_tr_b16 v[132:133], v12 offset:8192
ds_read_b64_tr_b16 v[134:135], v12 offset:12288
M v[72:75], v[180:183], a[252:255], v[72:75]
M v[76:79], v[188:191], a[252:255], v[76:79]
ds_read_b64_tr_b16 v[136:137], v13 offset:0
ds_read_b64_tr_b16 v[138:139], v13 offset:4096
M v[76:79], v[184:187], a[248:251], v[76:79]
ds_read_b64_tr_b16 v[140:141], v13 offset:8192
ds_read_b64_tr_b16 v[142:143], v13 offset:12288
M v[80:83], v[192:195], a[248:251], v[80:83]
ds_read_b64_tr_b16 v[144:145], v14 offset:0
ds_read_b64_tr_b16 v[146:147], v14 offset:4096
M v[80:83], v[196:199], a[252:255], v[80:83]
M v[84:87], v[204:207], a[252:255], v[84:87]
ds_read_b64_tr_b16 v[148:149], v14 offset:8192
ds_read_b64_tr_b16 v[150:151], v14 offset:12288
M v[84:87], v[200:203], a[248:251], v[84:87]
ds_read_b64_tr_b16 v[152:153], v15 offset:0
ds_read_b64_tr_b16 v[154:155], v15 offset:4096
M v[88:91], v[208:211], a[248:251], v[88:91]
ds_read_b64_tr_b16 v[156:157], v15 offset:8192
ds_read_b64_tr_b16 v[158:159], v15 offset:12288
M v[88:91], v[212:215], a[252:255], v[88:91]
M v[92:95], v[220:223], a[252:255], v[92:95]
M v[92:95], v[216:219], a[248:251], v[92:95]
s_waitcnt vmcnt(22) lgkmcnt(0)
s_barrier
M v[32:35], v[96:99], a[128:131], v[32:35]
s_add_u32 m0, s42, 81920
s_nop 0
buffer_load_dwordx4 v6, s[48:51], s26 offen offset:0 lds
M v[32:35], v[100:103], a[132:135], v[32:35]
ds_read_b64_tr_b16 v[160:161], v8 offset:16384
ds_read_b64_tr_b16 v[162:163], v8 offset:20480
M v[36:39], v[108:111], a[132:135], v[36:39]
buffer_load_dwordx4 v7, s[48:51], s26 offen offset:1024 lds
M v[36:39], v[104:107], a[128:131], v[36:39]
ds_read_b64_tr_b16 v[164:165], v8 offset:24576
ds_read_b64_tr_b16 v[166:167], v8 offset:28672
M v[40:43], v[112:115], a[128:131], v[40:43]
M v[40:43], v[116:119], a[132:135], v[40:43]
buffer_load_dwordx4 a[208:211], v1, s[44:47], s25 offen offset:0 sc1
M v[44:47], v[124:127], a[132:135], v[44:47]
ds_read_b64_tr_b16 v[168:169], v9 offset:16384
ds_read_b64_tr_b16 v[170:171], v9 offset:20480
M v[44:47], v[120:123], a[128:131], v[44:47]
buffer_load_dwordx4 a[212:215], v1, s[44:47], s25 offen offset:1024 sc1
M v[48:51], v[128:131], a[128:131], v[48:51]
M v[48:51], v[132:135], a[132:135], v[48:51]
ds_read_b64_tr_b16 v[172:173], v9 offset:24576
ds_read_b64_tr_b16 v[174:175], v9 offset:28672
M v[52:55], v[140:143], a[132:135], v[52:55]
buffer_load_dwordx4 a[216:219], v1, s[44:47], s25 offen offset:2048 sc1
M v[52:55], v[136:139], a[128:131], v[52:55]
ds_read_b64_tr_b16 v[176:177], v10 offset:16384
ds_read_b64_tr_b16 v[178:179], v10 offset:20480
M v[56:59], v[144:147], a[128:131], v[56:59]
M v[56:59], v[148:151], a[132:135], v[56:59]
buffer_load_dwordx4 a[220:223], v1, s[44:47], s25 offen offset:3072 sc1
M v[60:63], v[156:159], a[132:135], v[60:63]
ds_read_b64_tr_b16 v[180:181], v10 offset:24576
ds_read_b64_tr_b16 v[182:183], v10 offset:28672
M v[60:63], v[152:155], a[128:131], v[60:63]
s_add_u32 s25, s25, 16384
s_add_u32 s26, s26, 131072
M v[64:67], v[96:99], a[136:139], v[64:67]
ds_read_b64_tr_b16 v[184:185], v11 offset:16384
ds_read_b64_tr_b16 v[186:187], v11 offset:20480
M v[64:67], v[100:103], a[140:143], v[64:67]
M v[68:71], v[108:111], a[140:143], v[68:71]
ds_read_b64_tr_b16 v[188:189], v11 offset:24576
ds_read_b64_tr_b16 v[190:191], v11 offset:28672
M v[68:71], v[104:107], a[136:139], v[68:71]
ds_read_b64_tr_b16 v[192:193], v12 offset:16384
ds_read_b64_tr_b16 v[194:195], v12 offset:20480
M v[72:75], v[112:115], a[136:139], v[72:75]
ds_read_b64_tr_b16 v[196:197], v12 offset:24576
ds_read_b64_tr_b16 v[198:199], v12 offset:28672
M v[72:75], v[116:119], a[140:143], v[72:75]
M v[76:79], v[124:127], a[140:143], v[76:79]
ds_read_b64_tr_b16 v[200:201], v13 offset:16384
ds_read_b64_tr_b16 v[202:203], v13 offset:20480
M v[76:79], v[120:123], a[136:139], v[76:79]
ds_read_b64_tr_b16 v[204:205], v13 offset:24576
ds_read_b64_tr_b16 v[206:207], v13 offset:28672
M v[80:83], v[128:131], a[136:139], v[80:83]
ds_read_b64_tr_b16 v[208:209], v14 offset:16384
ds_read_b64_tr_b16 v[210:211], v14 offset:20480
M v[80:83], v[132:135], a[140:143], v[80:83]
M v[84:87], v[140:143], a[140:143], v[84:87]
ds_read_b64_tr_b16 v[212:213], v14 offset:24576
ds_read_b64_tr_b16 v[214:215], v14 offset:28672
M v[84:87], v[136:139], a[136:139], v[84:87]
ds_read_b64_tr_b16 v[216:217], v15 offset:16384
ds_read_b64_tr_b16 v[218:219], v15 offset:20480
M v[88:91], v[144:147], a[136:139], v[88:91]
ds_read_b64_tr_b16 v[220:221], v15 offset:24576
ds_read_b64_tr_b16 v[222:223], v15 offset:28672
M v[88:91], v[148:151], a[140:143], v[88:91]
M v[92:95], v[156:159], a[140:143], v[92:95]
M v[92:95], v[152:155], a[136:139], v[92:95]
s_waitcnt vmcnt(20) lgkmcnt(0)
s_barrier
M v[32:35], v[160:163], a[144:147], v[32:35]
s_add_u32 m0, s42, 98304
s_nop 0
buffer_load_dwordx4 v6, s[48:51], s26 offen offset:0 lds
M v[32:35], v[164:167], a[148:151], v[32:35]
ds_read_b64_tr_b16 v[96:97], v8 offset:32768
ds_read_b64_tr_b16 v[98:99], v8 offset:36864
M v[36:39], v[172:175], a[148:151], v[36:39]
buffer_load_dwordx4 v7, s[48:51], s26 offen offset:1024 lds
M v[36:39], v[168:171], a[144:147], v[36:39]
ds_read_b64_tr_b16 v[100:101], v8 offset:40960
ds_read_b64_tr_b16 v[102:103], v8 offset:45056
M v[40:43], v[176:179], a[144:147], v[40:43]
M v[40:43], v[180:183], a[148:151], v[40:43]
buffer_load_dwordx4 a[224:227], v1, s[44:47], s25 offen offset:0 sc1
M v[44:47], v[188:191], a[148:151], v[44:47]
ds_read_b64_tr_b16 v[104:105], v9 offset:32768
ds_read_b64_tr_b16 v[106:107], v9 offset:36864
M v[44:47], v[184:187], a[144:147], v[44:47]
buffer_load_dwordx4 a[228:231], v1, s[44:47], s25 offen offset:1024 sc1
M v[48:51], v[192:195], a[144:147], v[48:51]
M v[48:51], v[196:199], a[148:151], v[48:51]
ds_read_b64_tr_b16 v[108:109], v9 offset:40960
ds_read_b64_tr_b16 v[110:111], v9 offset:45056
M v[52:55], v[204:207], a[148:151], v[52:55]
buffer_load_dwordx4 a[232:235], v1, s[44:47], s25 offen offset:2048 sc1
M v[52:55], v[200:203], a[144:147], v[52:55]
ds_read_b64_tr_b16 v[112:113], v10 offset:32768
ds_read_b64_tr_b16 v[114:115], v10 offset:36864
M v[56:59], v[208:211], a[144:147], v[56:59]
M v[56:59], v[212:215], a[148:151], v[56:59]
buffer_load_dwordx4 a[236:239], v1, s[44:47], s25 offen offset:3072 sc1
M v[60:63], v[220:223], a[148:151], v[60:63]
ds_read_b64_tr_b16 v[116:117], v10 offset:40960
ds_read_b64_tr_b16 v[118:119], v10 offset:45056
M v[60:63], v[216:219], a[144:147], v[60:63]
s_add_u32 s25, s25, 16384
s_add_u32 s26, s26, 131072
M v[64:67], v[160:163], a[152:155], v[64:67]
ds_read_b64_tr_b16 v[120:121], v11 offset:32768
ds_read_b64_tr_b16 v[122:123], v11 offset:36864
M v[64:67], v[164:167], a[156:159], v[64:67]
M v[68:71], v[172:175], a[156:159], v[68:71]
ds_read_b64_tr_b16 v[124:125], v11 offset:40960
ds_read_b64_tr_b16 v[126:127], v11 offset:45056
M v[68:71], v[168:171], a[152:155], v[68:71]
ds_read_b64_tr_b16 v[128:129], v12 offset:32768
ds_read_b64_tr_b16 v[130:131], v12 offset:36864
M v[72:75], v[176:179], a[152:155], v[72:75]
ds_read_b64_tr_b16 v[132:133], v12 offset:40960
ds_read_b64_tr_b16 v[134:135], v12 offset:45056
M v[72:75], v[180:183], a[156:159], v[72:75]
M v[76:79], v[188:191], a[156:159], v[76:79]
ds_read_b64_tr_b16 v[136:137], v13 offset:32768
ds_read_b64_tr_b16 v[138:139], v13 offset:36864
M v[76:79], v[184:187], a[152:155], v[76:79]
ds_read_b64_tr_b16 v[140:141], v13 offset:40960
ds_read_b64_tr_b16 v[142:143], v13 offset:45056
M v[80:83], v[192:195], a[152:155], v[80:83]
ds_read_b64_tr_b16 v[144:145], v14 offset:32768
ds_read_b64_tr_b16 v[146:147], v14 offset:36864
M v[80:83], v[196:199], a[156:159], v[80:83]
M v[84:87], v[204:207], a[156:159], v[84:87]
ds_read_b64_tr_b16 v[148:149], v14 offset:40960
ds_read_b64_tr_b16 v[150:151], v14 offset:45056
M v[84:87], v[200:203], a[152:155], v[84:87]
ds_read_b64_tr_b16 v[152:153], v15 offset:32768
ds_read_b64_tr_b16 v[154:155], v15 offset:36864
M v[88:91], v[208:211], a[152:155], v[88:91]
ds_read_b64_tr_b16 v[156:157], v15 offset:40960
ds_read_b64_tr_b16 v[158:159], v15 offset:45056
M v[88:91], v[212:215], a[156:159], v[88:91]
M v[92:95], v[220:223], a[156:159], v[92:95]
M v[92:95], v[216:219], a[152:155], v[92:95]
s_waitcnt vmcnt(18) lgkmcnt(0)
s_barrier
M v[32:35], v[96:99], a[160:163], v[32:35]
s_add_u32 m0, s42, 114688
s_nop 0
buffer_load_dwordx4 v6, s[48:51], s26 offen offset:0 lds
M v[32:35], v[100:103], a[164:167], v[32:35]
ds_read_b64_tr_b16 v[160:161], v8 offset:49152
ds_read_b64_tr_b16 v[162:163], v8 offset:53248
M v[36:39], v[108:111], a[164:167], v[36:39]
buffer_load_dwordx4 v7, s[48:51], s26 offen offset:1024 lds
M v[36:39], v[104:107], a[160:163], v[36:39]
ds_read_b64_tr_b16 v[164:165], v8 offset:57344
ds_read_b64_tr_b16 v[166:167], v8 offset:61440
M v[40:43], v[112:115], a[160:163], v[40:43]
M v[40:43], v[116:119], a[164:167], v[40:43]
buffer_load_dwordx4 a[240:243], v1, s[44:47], s25 offen offset:0 sc1
M v[44:47], v[124:127], a[164:167], v[44:47]
ds_read_b64_tr_b16 v[168:169], v9 offset:49152
ds_read_b64_tr_b16 v[170:171], v9 offset:53248
M v[44:47], v[120:123], a[160:163], v[44:47]
buffer_load_dwordx4 a[244:247], v1, s[44:47], s25 offen offset:1024 sc1
M v[48:51], v[128:131], a[160:163], v[48:51]
M v[48:51], v[132:135], a[164:167], v[48:51]
ds_read_b64_tr_b16 v[172:173], v9 offset:57344
ds_read_b64_tr_b16 v[174:175], v9 offset:61440
M v[52:55], v[140:143], a[164:167], v[52:55]
buffer_load_dwordx4 a[248:251], v1, s[44:47], s25 offen offset:2048 sc1
M v[52:55], v[136:139], a[160:163], v[52:55]
ds_read_b64_tr_b16 v[176:177], v10 offset:49152
ds_read_b64_tr_b16 v[178:179], v10 offset:53248
M v[56:59], v[144:147], a[160:163], v[56:59]
M v[56:59], v[148:151], a[164:167], v[56:59]
buffer_load_dwordx4 a[252:255], v1, s[44:47], s25 offen offset:3072 sc1
M v[60:63], v[156:159], a[164:167], v[60:63]
ds_read_b64_tr_b16 v[180:181], v10 offset:57344
ds_read_b64_tr_b16 v[182:183], v10 offset:61440
M v[60:63], v[152:155], a[160:163], v[60:63]
s_add_u32 s25, s25, 16384
s_add_u32 s26, s26, 131072
M v[64:67], v[96:99], a[168:171], v[64:67]
ds_read_b64_tr_b16 v[184:185], v11 offset:49152
ds_read_b64_tr_b16 v[186:187], v11 offset:53248
M v[64:67], v[100:103], a[172:175], v[64:67]
M v[68:71], v[108:111], a[172:175], v[68:71]
ds_read_b64_tr_b16 v[188:189], v11 offset:57344
ds_read_b64_tr_b16 v[190:191], v11 offset:61440
M v[68:71], v[104:107], a[168:171], v[68:71]
ds_read_b64_tr_b16 v[192:193], v12 offset:49152
ds_read_b64_tr_b16 v[194:195], v12 offset:53248
M v[72:75], v[112:115], a[168:171], v[72:75]
ds_read_b64_tr_b16 v[196:197], v12 offset:57344
ds_read_b64_tr_b16 v[198:199], v12 offset:61440
M v[72:75], v[116:119], a[172:175], v[72:75]
M v[76:79], v[124:127], a[172:175], v[76:79]
ds_read_b64_tr_b16 v[200:201], v13 offset:49152
ds_read_b64_tr_b16 v[202:203], v13 offset:53248
M v[76:79], v[120:123], a[168:171], v[76:79]
ds_read_b64_tr_b16 v[204:205], v13 offset:57344
ds_read_b64_tr_b16 v[206:207], v13 offset:61440
M v[80:83], v[128:131], a[168:171], v[80:83]
ds_read_b64_tr_b16 v[208:209], v14 offset:49152
ds_read_b64_tr_b16 v[210:211], v14 offset:53248
M v[80:83], v[132:135], a[172:175], v[80:83]
M v[84:87], v[140:143], a[172:175], v[84:87]
ds_read_b64_tr_b16 v[212:213], v14 offset:57344
ds_read_b64_tr_b16 v[214:215], v14 offset:61440
M v[84:87], v[136:139], a[168:171], v[84:87]
ds_read_b64_tr_b16 v[216:217], v15 offset:49152
ds_read_b64_tr_b16 v[218:219], v15 offset:53248
M v[88:91], v[144:147], a[168:171], v[88:91]
ds_read_b64_tr_b16 v[220:221], v15 offset:57344
ds_read_b64_tr_b16 v[222:223], v15 offset:61440
M v[88:91], v[148:151], a[172:175], v[88:91]
M v[92:95], v[156:159], a[172:175], v[92:95]
M v[92:95], v[152:155], a[168:171], v[92:95]
s_waitcnt vmcnt(18) lgkmcnt(0)
s_barrier
M v[32:35], v[160:163], a[176:179], v[32:35]
s_add_u32 m0, s42, 0
s_nop 0
buffer_load_dwordx4 v6, s[48:51], s26 offen offset:0 lds
M v[32:35], v[164:167], a[180:183], v[32:35]
M v[36:39], v[172:175], a[180:183], v[36:39]
ds_read_b64_tr_b16 v[96:97], v28 offset:0
ds_read_b64_tr_b16 v[98:99], v28 offset:2048
M v[36:39], v[168:171], a[176:179], v[36:39]
M v[40:43], v[176:179], a[176:179], v[40:43]
buffer_load_dwordx4 v7, s[48:51], s26 offen offset:1024 lds
M v[40:43], v[180:183], a[180:183], v[40:43]
M v[44:47], v[188:191], a[180:183], v[44:47]
ds_read_b64_tr_b16 v[100:101], v28 offset:4096
ds_read_b64_tr_b16 v[102:103], v28 offset:6144
M v[44:47], v[184:187], a[176:179], v[44:47]
M v[48:51], v[192:195], a[176:179], v[48:51]
buffer_load_dwordx4 a[128:131], v1, s[44:47], s25 offen offset:0 sc1
M v[48:51], v[196:199], a[180:183], v[48:51]
M v[52:55], v[204:207], a[180:183], v[52:55]
ds_read_b64_tr_b16 v[104:105], v29 offset:0
ds_read_b64_tr_b16 v[106:107], v29 offset:2048
M v[52:55], v[200:203], a[176:179], v[52:55]
M v[56:59], v[208:211], a[176:179], v[56:59]
buffer_load_dwordx4 a[132:135], v1, s[44:47], s25 offen offset:1024 sc1
M v[56:59], v[212:215], a[180:183], v[56:59]
M v[60:63], v[220:223], a[180:183], v[60:63]
ds_read_b64_tr_b16 v[108:109], v29 offset:4096
ds_read_b64_tr_b16 v[110:111], v29 offset:6144
M v[60:63], v[216:219], a[176:179], v[60:63]
M v[64:67], v[160:163], a[184:187], v[64:67]
buffer_load_dwordx4 a[136:139], v1, s[44:47], s25 offen offset:2048 sc1
M v[64:67], v[164:167], a[188:191], v[64:67]
M v[68:71], v[172:175], a[188:191], v[68:71]
ds_read_b64_tr_b16 v[112:113], v30 offset:0
ds_read_b64_tr_b16 v[114:115], v30 offset:2048
M v[68:71], v[168:171], a[184:187], v[68:71]
M v[72:75], v[176:179], a[184:187], v[72:75]
buffer_load_dwordx4 a[140:143], v1, s[44:47], s25 offen offset:3072 sc1
M v[72:75], v[180:183], a[188:191], v[72:75]
M v[76:79], v[188:191], a[188:191], v[76:79]
ds_read_b64_tr_b16 v[116:117], v30 offset:4096
ds_read_b64_tr_b16 v[118:119], v30 offset:6144
M v[76:79], v[184:187], a[184:187], v[76:79]
M v[80:83], v[192:195], a[184:187], v[80:83]
s_add_u32 s25, s25, 16384
s_add_u32 s26, s26, 131072
M v[80:83], v[196:199], a[188:191], v[80:83]
M v[84:87], v[204:207], a[188:191], v[84:87]
ds_read_b64_tr_b16 v[120:121], v31 offset:0
ds_read_b64_tr_b16 v[122:123], v31 offset:2048
M v[84:87], v[200:203], a[184:187], v[84:87]
M v[88:91], v[208:211], a[184:187], v[88:91]
ds_read_b64_tr_b16 v[124:125], v31 offset:4096
ds_read_b64_tr_b16 v[126:127], v31 offset:6144
M v[88:91], v[212:215], a[188:191], v[88:91]
M v[92:95], v[220:223], a[188:191], v[92:95]
M v[92:95], v[216:219], a[184:187], v[92:95]
s_waitcnt vmcnt(18) lgkmcnt(0)
s_barrier
M a[0:3], v[96:99], a[192:195], a[0:3]
s_add_u32 m0, s42, 16384
s_nop 0
buffer_load_dwordx4 v6, s[48:51], s26 offen offset:0 lds
ds_read_b64_tr_b16 v[160:161], v28 offset:16384
ds_read_b64_tr_b16 v[162:163], v28 offset:18432
M a[0:3], v[100:103], a[196:199], a[0:3]
buffer_load_dwordx4 v7, s[48:51], s26 offen offset:1024 lds
ds_read_b64_tr_b16 v[164:165], v28 offset:20480
ds_read_b64_tr_b16 v[166:167], v28 offset:22528
M a[4:7], v[108:111], a[196:199], a[4:7]
buffer_load_dwordx4 a[144:147], v1, s[44:47], s25 offen offset:0 sc1
ds_read_b64_tr_b16 v[168:169], v29 offset:16384
ds_read_b64_tr_b16 v[170:171], v29 offset:18432
M a[4:7], v[104:107], a[192:195], a[4:7]
buffer_load_dwordx4 a[148:151], v1, s[44:47], s25 offen offset:1024 sc1
M a[8:11], v[112:115], a[192:195], a[8:11]
ds_read_b64_tr_b16 v[172:173], v29 offset:20480
ds_read_b64_tr_b16 v[174:175], v29 offset:22528
buffer_load_dwordx4 a[152:155], v1, s[44:47], s25 offen offset:2048 sc1
M a[8:11], v[116:119], a[196:199], a[8:11]
ds_read_b64_tr_b16 v[176:177], v30 offset:16384
ds_read_b64_tr_b16 v[178:179], v30 offset:18432
buffer_load_dwordx4 a[156:159], v1, s[44:47], s25 offen offset:3072 sc1
M a[12:15], v[124:127], a[196:199], a[12:15]
ds_read_b64_tr_b16 v[180:181], v30 offset:20480
ds_read_b64_tr_b16 v[182:183], v30 offset:22528
M a[12:15], v[120:123], a[192:195], a[12:15]
s_add_u32 s25, s25, 16384
s_add_u32 s26, s26, 131072
ds_read_b64_tr_b16 v[184:185], v31 offset:16384
ds_read_b64_tr_b16 v[186:187], v31 offset:18432
M a[16:19], v[96:99], a[200:203], a[16:19]
s_add_u32 s60, s56, 0
buffer_store_dwordx4 v[48:51], v1, s[52:55], s60 offen offset:0 sc1
ds_read_b64_tr_b16 v[188:189], v31 offset:20480
ds_read_b64_tr_b16 v[190:191], v31 offset:22528
M a[16:19], v[100:103], a[204:207], a[16:19]
buffer_store_dwordx4 v[52:55], v1, s[52:55], s60 offen offset:1024 sc1
buffer_store_dwordx4 v[56:59], v1, s[52:55], s60 offen offset:2048 sc1
M a[20:23], v[108:111], a[204:207], a[20:23]
buffer_store_dwordx4 v[60:63], v1, s[52:55], s60 offen offset:3072 sc1
M a[20:23], v[104:107], a[200:203], a[20:23]
s_add_u32 s60, s56, 4096
buffer_store_dwordx4 v[80:83], v1, s[52:55], s60 offen offset:0 sc1
buffer_store_dwordx4 v[84:87], v1, s[52:55], s60 offen offset:1024 sc1
M a[24:27], v[112:115], a[200:203], a[24:27]
buffer_store_dwordx4 v[88:91], v1, s[52:55], s60 offen offset:2048 sc1
buffer_store_dwordx4 v[92:95], v1, s[52:55], s60 offen offset:3072 sc1
M a[24:27], v[116:119], a[204:207], a[24:27]
v_mov_b32 v11, 0
M a[28:31], v[124:127], a[204:207], a[28:31]
M a[28:31], v[120:123], a[200:203], a[28:31]
s_waitcnt vmcnt(26) lgkmcnt(0)
s_barrier
M a[0:3], v[160:163], a[208:211], a[0:3]
s_add_u32 m0, s42, 32768
s_nop 0
buffer_load_dwordx4 v6, s[48:51], s26 offen offset:0 lds
ds_read_b64_tr_b16 v[96:97], v28 offset:32768
ds_read_b64_tr_b16 v[98:99], v28 offset:34816
M a[0:3], v[164:167], a[212:215], a[0:3]
buffer_load_dwordx4 v7, s[48:51], s26 offen offset:1024 lds
M a[4:7], v[172:175], a[212:215], a[4:7]
ds_read_b64_tr_b16 v[100:101], v28 offset:36864
ds_read_b64_tr_b16 v[102:103], v28 offset:38912
M a[4:7], v[168:171], a[208:211], a[4:7]
buffer_load_dwordx4 a[160:163], v1, s[44:47], s25 offen offset:0 sc1
M a[8:11], v[176:179], a[208:211], a[8:11]
ds_read_b64_tr_b16 v[104:105], v29 offset:32768
ds_read_b64_tr_b16 v[106:107], v29 offset:34816
M a[8:11], v[180:183], a[212:215], a[8:11]
buffer_load_dwordx4 a[164:167], v1, s[44:47], s25 offen offset:1024 sc1
M a[12:15], v[188:191], a[212:215], a[12:15]
ds_read_b64_tr_b16 v[108:109], v29 offset:36864
ds_read_b64_tr_b16 v[110:111], v29 offset:38912
M a[12:15], v[184:187], a[208:211], a[12:15]
buffer_load_dwordx4 a[168:171], v1, s[44:47], s25 offen offset:2048 sc1
M a[16:19], v[160:163], a[216:219], a[16:19]
ds_read_b64_tr_b16 v[112:113], v30 offset:32768
ds_read_b64_tr_b16 v[114:115], v30 offset:34816
M a[16:19], v[164:167], a[220:223], a[16:19]
buffer_load_dwordx4 a[172:175], v1, s[44:47], s25 offen offset:3072 sc1
M a[20:23], v[172:175], a[220:223], a[20:23]
ds_read_b64_tr_b16 v[116:117], v30 offset:36864
ds_read_b64_tr_b16 v[118:119], v30 offset:38912
M a[20:23], v[168:171], a[216:219], a[20:23]
s_add_u32 s25, s25, 16384
s_add_u32 s26, s26, 131072
M a[24:27], v[176:179], a[216:219], a[24:27]
ds_read_b64_tr_b16 v[120:121], v31 offset:32768
ds_read_b64_tr_b16 v[122:123], v31 offset:34816
M a[24:27], v[180:183], a[220:223], a[24:27]
ds_read_b64_tr_b16 v[124:125], v31 offset:36864
ds_read_b64_tr_b16 v[126:127], v31 offset:38912
M a[28:31], v[188:191], a[220:223], a[28:31]
M a[28:31], v[184:187], a[216:219], a[28:31]
s_waitcnt vmcnt(6) lgkmcnt(0)
s_barrier
s_cmp_lg_u32 s101, 0
s_cbranch_scc1 Lk3f_15
v_mov_b32 v9, 1
s_mov_b64 exec, 1
buffer_store_dword v9, v11, s[52:55], s58 offen sc1
s_mov_b64 exec, -1
Lk3f_15:
M a[0:3], v[96:99], a[224:227], a[0:3]
s_add_u32 m0, s42, 49152
s_nop 0
buffer_load_dwordx4 v6, s[48:51], s26 offen offset:0 lds
ds_read_b64_tr_b16 v[160:161], v28 offset:49152
ds_read_b64_tr_b16 v[162:163], v28 offset:51200
M a[0:3], v[100:103], a[228:231], a[0:3]
buffer_load_dwordx4 v7, s[48:51], s26 offen offset:1024 lds
M a[4:7], v[108:111], a[228:231], a[4:7]
ds_read_b64_tr_b16 v[164:165], v28 offset:53248
ds_read_b64_tr_b16 v[166:167], v28 offset:55296
M a[4:7], v[104:107], a[224:227], a[4:7]
buffer_load_dwordx4 a[176:179], v1, s[44:47], s25 offen offset:0 sc1
M a[8:11], v[112:115], a[224:227], a[8:11]
ds_read_b64_tr_b16 v[168:169], v29 offset:49152
ds_read_b64_tr_b16 v[170:171], v29 offset:51200
M a[8:11], v[116:119], a[228:231], a[8:11]
buffer_load_dwordx4 a[180:183], v1, s[44:47], s25 offen offset:1024 sc1
M a[12:15], v[124:127], a[228:231], a[12:15]
ds_read_b64_tr_b16 v[172:173], v29 offset:53248
ds_read_b64_tr_b16 v[174:175], v29 offset:55296
M a[12:15], v[120:123], a[224:227], a[12:15]
buffer_load_dwordx4 a[184:187], v1, s[44:47], s25 offen offset:2048 sc1
M a[16:19], v[96:99], a[232:235], a[16:19]
ds_read_b64_tr_b16 v[176:177], v30 offset:49152
ds_read_b64_tr_b16 v[178:179], v30 offset:51200
M a[16:19], v[100:103], a[236:239], a[16:19]
buffer_load_dwordx4 a[188:191], v1, s[44:47], s25 offen offset:3072 sc1
M a[20:23], v[108:111], a[236:239], a[20:23]
ds_read_b64_tr_b16 v[180:181], v30 offset:53248
ds_read_b64_tr_b16 v[182:183], v30 offset:55296
M a[20:23], v[104:107], a[232:235], a[20:23]
s_add_u32 s25, s25, 16384
s_add_u32 s26, s26, 131072
M a[24:27], v[112:115], a[232:235], a[24:27]
ds_read_b64_tr_b16 v[184:185], v31 offset:49152
ds_read_b64_tr_b16 v[186:187], v31 offset:51200
M a[24:27], v[116:119], a[236:239], a[24:27]
ds_read_b64_tr_b16 v[188:189], v31 offset:53248
ds_read_b64_tr_b16 v[190:191], v31 offset:55296
M a[28:31], v[124:127], a[236:239], a[28:31]
M a[28:31], v[120:123], a[232:235], a[28:31]
s_waitcnt vmcnt(26) lgkmcnt(0)
s_barrier
M a[0:3], v[160:163], a[240:243], a[0:3]
ds_read_b64_tr_b16 v[96:97], v24 offset:0
ds_read_b64_tr_b16 v[98:99], v24 offset:2048
M a[0:3], v[164:167], a[244:247], a[0:3]
ds_read_b64_tr_b16 v[100:101], v24 offset:4096
ds_read_b64_tr_b16 v[102:103], v24 offset:6144
M a[4:7], v[172:175], a[244:247], a[4:7]
M a[4:7], v[168:171], a[240:243], a[4:7]
ds_read_b64_tr_b16 v[104:105], v25 offset:0
ds_read_b64_tr_b16 v[106:107], v25 offset:2048
M a[8:11], v[176:179], a[240:243], a[8:11]
M a[8:11], v[180:183], a[244:247], a[8:11]
ds_read_b64_tr_b16 v[108:109], v25 offset:4096
ds_read_b64_tr_b16 v[110:111], v25 offset:6144
M a[12:15], v[188:191], a[244:247], a[12:15]
M a[12:15], v[184:187], a[240:243], a[12:15]
ds_read_b64_tr_b16 v[112:113], v26 offset:0
ds_read_b64_tr_b16 v[114:115], v26 offset:2048
M a[16:19], v[160:163], a[248:251], a[16:19]
ds_read_b64_tr_b16 v[116:117], v26 offset:4096
ds_read_b64_tr_b16 v[118:119], v26 offset:6144
M a[16:19], v[164:167], a[252:255], a[16:19]
M a[20:23], v[172:175], a[252:255], a[20:23]
ds_read_b64_tr_b16 v[120:121], v27 offset:0
ds_read_b64_tr_b16 v[122:123], v27 offset:2048
M a[20:23], v[168:171], a[248:251], a[20:23]
M a[24:27], v[176:179], a[248:251], a[24:27]
ds_read_b64_tr_b16 v[124:125], v27 offset:4096
ds_read_b64_tr_b16 v[126:127], v27 offset:6144
M a[24:27], v[180:183], a[252:255], a[24:27]
M a[28:31], v[188:191], a[252:255], a[28:31]
M a[28:31], v[184:187], a[248:251], a[28:31]
s_waitcnt vmcnt(20) lgkmcnt(0)
s_barrier
M a[0:3], v[96:99], a[128:131], a[0:3]
ds_read_b64_tr_b16 v[160:161], v24 offset:16384
ds_read_b64_tr_b16 v[162:163], v24 offset:18432
M a[0:3], v[100:103], a[132:135], a[0:3]
ds_read_b64_tr_b16 v[164:165], v24 offset:20480
ds_read_b64_tr_b16 v[166:167], v24 offset:22528
M a[4:7], v[108:111], a[132:135], a[4:7]
M a[4:7], v[104:107], a[128:131], a[4:7]
ds_read_b64_tr_b16 v[168:169], v25 offset:16384
ds_read_b64_tr_b16 v[170:171], v25 offset:18432
M a[8:11], v[112:115], a[128:131], a[8:11]
M a[8:11], v[116:119], a[132:135], a[8:11]
ds_read_b64_tr_b16 v[172:173], v25 offset:20480
ds_read_b64_tr_b16 v[174:175], v25 offset:22528
M a[12:15], v[124:127], a[132:135], a[12:15]
M a[12:15], v[120:123], a[128:131], a[12:15]
ds_read_b64_tr_b16 v[176:177], v26 offset:16384
ds_read_b64_tr_b16 v[178:179], v26 offset:18432
M a[16:19], v[96:99], a[136:139], a[16:19]
ds_read_b64_tr_b16 v[180:181], v26 offset:20480
ds_read_b64_tr_b16 v[182:183], v26 offset:22528
M a[16:19], v[100:103], a[140:143], a[16:19]
M a[20:23], v[108:111], a[140:143], a[20:23]
ds_read_b64_tr_b16 v[184:185], v27 offset:16384
ds_read_b64_tr_b16 v[186:187], v27 offset:18432
M a[20:23], v[104:107], a[136:139], a[20:23]
M a[24:27], v[112:115], a[136:139], a[24:27]
ds_read_b64_tr_b16 v[188:189], v27 offset:20480
ds_read_b64_tr_b16 v[190:191], v27 offset:22528
M a[24:27], v[116:119], a[140:143], a[24:27]
M a[28:31], v[124:127], a[140:143], a[28:31]
M a[28:31], v[120:123], a[136:139], a[28:31]
s_waitcnt vmcnt(6) lgkmcnt(0)
s_barrier
M a[0:3], v[160:163], a[144:147], a[0:3]
buffer_load_dword v8, v11, s[52:55], s59 offen sc1
M a[0:3], v[164:167], a[148:151], a[0:3]
ds_read_b64_tr_b16 v[96:97], v24 offset:32768
ds_read_b64_tr_b16 v[98:99], v24 offset:34816
M a[4:7], v[172:175], a[148:151], a[4:7]
M a[4:7], v[168:171], a[144:147], a[4:7]
ds_read_b64_tr_b16 v[100:101], v24 offset:36864
ds_read_b64_tr_b16 v[102:103], v24 offset:38912
M a[8:11], v[176:179], a[144:147], a[8:11]
ds_read_b64_tr_b16 v[104:105], v25 offset:32768
ds_read_b64_tr_b16 v[106:107], v25 offset:34816
M a[8:11], v[180:183], a[148:151], a[8:11]
M a[12:15], v[188:191], a[148:151], a[12:15]
ds_read_b64_tr_b16 v[108:109], v25 offset:36864
ds_read_b64_tr_b16 v[110:111], v25 offset:38912
M a[12:15], v[184:187], a[144:147], a[12:15]
ds_read_b64_tr_b16 v[112:113], v26 offset:32768
ds_read_b64_tr_b16 v[114:115], v26 offset:34816
M a[16:19], v[160:163], a[152:155], a[16:19]
M a[16:19], v[164:167], a[156:159], a[16:19]
ds_read_b64_tr_b16 v[116:117], v26 offset:36864
ds_read_b64_tr_b16 v[118:119], v26 offset:38912
M a[20:23], v[172:175], a[156:159], a[20:23]
ds_read_b64_tr_b16 v[120:121], v27 offset:32768
ds_read_b64_tr_b16 v[122:123], v27 offset:34816
M a[20:23], v[168:171], a[152:155], a[20:23]
M a[24:27], v[176:179], a[152:155], a[24:27]
ds_read_b64_tr_b16 v[124:125], v27 offset:36864
ds_read_b64_tr_b16 v[126:127], v27 offset:38912
M a[24:27], v[180:183], a[156:159], a[24:27]
M a[28:31], v[188:191], a[156:159], a[28:31]
M a[28:31], v[184:187], a[152:155], a[28:31]
s_waitcnt vmcnt(1) lgkmcnt(0)
s_barrier
s_waitcnt vmcnt(0)
v_cmp_ne_u32 vcc, 1, v8
s_nop 0
s_cbranch_vccnz Lk3_spinfl
Lk3_gotfl:
M a[0:3], v[96:99], a[160:163], a[0:3]
s_add_u32 s60, s57, 0
buffer_load_dwordx4 v[224:227], v1, s[52:55], s60 offen offset:0 sc1
ds_read_b64_tr_b16 v[160:161], v24 offset:49152
ds_read_b64_tr_b16 v[162:163], v24 offset:51200
M a[0:3], v[100:103], a[164:167], a[0:3]
buffer_load_dwordx4 v[228:231], v1, s[52:55], s60 offen offset:1024 sc1
M a[4:7], v[108:111], a[164:167], a[4:7]
ds_read_b64_tr_b16 v[164:165], v24 offset:53248
ds_read_b64_tr_b16 v[166:167], v24 offset:55296
M a[4:7], v[104:107], a[160:163], a[4:7]
buffer_load_dwordx4 v[232:235], v1, s[52:55], s60 offen offset:2048 sc1
M a[8:11], v[112:115], a[160:163], a[8:11]
ds_read_b64_tr_b16 v[168:169], v25 offset:49152
ds_read_b64_tr_b16 v[170:171], v25 offset:51200
M a[8:11], v[116:119], a[164:167], a[8:11]
buffer_load_dwordx4 v[236:239], v1, s[52:55], s60 offen offset:3072 sc1
M a[12:15], v[124:127], a[164:167], a[12:15]
ds_read_b64_tr_b16 v[172:173], v25 offset:53248
ds_read_b64_tr_b16 v[174:175], v25 offset:55296
M a[12:15], v[120:123], a[160:163], a[12:15]
s_add_u32 s60, s57, 4096
buffer_load_dwordx4 v[240:243], v1, s[52:55], s60 offen offset:0 sc1
ds_read_b64_tr_b16 v[176:177], v26 offset:49152
ds_read_b64_tr_b16 v[178:179], v26 offset:51200
M a[16:19], v[96:99], a[168:171], a[16:19]
buffer_load_dwordx4 v[244:247], v1, s[52:55], s60 offen offset:1024 sc1
M a[16:19], v[100:103], a[172:175], a[16:19]
ds_read_b64_tr_b16 v[180:181], v26 offset:53248
ds_read_b64_tr_b16 v[182:183], v26 offset:55296
M a[20:23], v[108:111], a[172:175], a[20:23]
buffer_load_dwordx4 v[248:251], v1, s[52:55], s60 offen offset:2048 sc1
M a[20:23], v[104:107], a[168:171], a[20:23]
ds_read_b64_tr_b16 v[184:185], v27 offset:49152
ds_read_b64_tr_b16 v[186:187], v27 offset:51200
M a[24:27], v[112:115], a[168:171], a[24:27]
buffer_load_dwordx4 v[252:255], v1, s[52:55], s60 offen offset:3072 sc1
M a[24:27], v[116:119], a[172:175], a[24:27]
ds_read_b64_tr_b16 v[188:189], v27 offset:53248
ds_read_b64_tr_b16 v[190:191], v27 offset:55296
M a[28:31], v[124:127], a[172:175], a[28:31]
M a[28:31], v[120:123], a[168:171], a[28:31]
s_waitcnt lgkmcnt(0)
M a[0:3], v[160:163], a[176:179], a[0:3]
M a[0:3], v[164:167], a[180:183], a[0:3]
M a[4:7], v[172:175], a[180:183], a[4:7]
M a[4:7], v[168:171], a[176:179], a[4:7]
M a[8:11], v[176:179], a[176:179], a[8:11]
M a[8:11], v[180:183], a[180:183], a[8:11]
M a[12:15], v[188:191], a[180:183], a[12:15]
M a[12:15], v[184:187], a[176:179], a[12:15]
M a[16:19], v[160:163], a[184:187], a[16:19]
M a[16:19], v[164:167], a[188:191], a[16:19]
M a[20:23], v[172:175], a[188:191], a[20:23]
M a[20:23], v[168:171], a[184:187], a[20:23]
M a[24:27], v[176:179], a[184:187], a[24:27]
M a[24:27], v[180:183], a[188:191], a[24:27]
M a[28:31], v[188:191], a[188:191], a[28:31]
M a[28:31], v[184:187], a[184:187], a[28:31]
v_bfe_u32 v96, v0, 4, 1
v_lshrrev_b32 v97, 5, v0
v_lshl_or_b32 v96, v96, 1, v97
v_and_b32 v97, 15, v0
v_lshlrev_b32 v97, 13, v97
v_lshl_add_u32 v96, v96, 4, v97
s_and_b32 s3, s101, 1
s_lshl_b32 s3, s3, 6
s_lshr_b32 s6, s101, 1
s_add_u32 s3, s3, s6
s_add_u32 s3, s3, s21
s_lshl_b32 s3, s3, 12
s_lshl_b32 s6, s22, 1
s_add_u32 s3, s3, s6
s_add_u32 s3, s3, 2048
v_accvgpr_read_b32 v108, a0
v_accvgpr_read_b32 v109, a1
v_accvgpr_read_b32 v110, a2
v_accvgpr_read_b32 v111, a3
v_accvgpr_read_b32 v112, a4
v_accvgpr_read_b32 v113, a5
v_accvgpr_read_b32 v114, a6
v_accvgpr_read_b32 v115, a7
v_cvt_pk_bf16_f32 v100, v108, v109
v_cvt_pk_bf16_f32 v101, v110, v111
v_cvt_pk_bf16_f32 v102, v112, v113
v_cvt_pk_bf16_f32 v103, v114, v115
s_nop 0
v_permlane16_swap_b32 v100, v102
v_permlane16_swap_b32 v101, v103
buffer_store_dwordx4 v[100:103], v96, s[16:19], s3 offen offset:0
v_accvgpr_read_b32 v108, a8
v_accvgpr_read_b32 v109, a9
v_accvgpr_read_b32 v110, a10
v_accvgpr_read_b32 v111, a11
v_accvgpr_read_b32 v112, a12
v_accvgpr_read_b32 v113, a13
v_accvgpr_read_b32 v114, a14
v_accvgpr_read_b32 v115, a15
v_cvt_pk_bf16_f32 v104, v108, v109
v_cvt_pk_bf16_f32 v105, v110, v111
v_cvt_pk_bf16_f32 v106, v112, v113
v_cvt_pk_bf16_f32 v107, v114, v115
s_nop 0
v_permlane16_swap_b32 v104, v106
v_permlane16_swap_b32 v105, v107
buffer_store_dwordx4 v[104:107], v96, s[16:19], s3 offen offset:64
s_add_u32 s3, s3, 131072
v_accvgpr_read_b32 v108, a16
v_accvgpr_read_b32 v109, a17
v_accvgpr_read_b32 v110, a18
v_accvgpr_read_b32 v111, a19
v_accvgpr_read_b32 v112, a20
v_accvgpr_read_b32 v113, a21
v_accvgpr_read_b32 v114, a22
v_accvgpr_read_b32 v115, a23
v_cvt_pk_bf16_f32 v100, v108, v109
v_cvt_pk_bf16_f32 v101, v110, v111
v_cvt_pk_bf16_f32 v102, v112, v113
v_cvt_pk_bf16_f32 v103, v114, v115
s_nop 0
v_permlane16_swap_b32 v100, v102
v_permlane16_swap_b32 v101, v103
buffer_store_dwordx4 v[100:103], v96, s[16:19], s3 offen offset:0
v_accvgpr_read_b32 v108, a24
v_accvgpr_read_b32 v109, a25
v_accvgpr_read_b32 v110, a26
v_accvgpr_read_b32 v111, a27
v_accvgpr_read_b32 v112, a28
v_accvgpr_read_b32 v113, a29
v_accvgpr_read_b32 v114, a30
v_accvgpr_read_b32 v115, a31
v_cvt_pk_bf16_f32 v104, v108, v109
v_cvt_pk_bf16_f32 v105, v110, v111
v_cvt_pk_bf16_f32 v106, v112, v113
v_cvt_pk_bf16_f32 v107, v114, v115
s_nop 0
v_permlane16_swap_b32 v104, v106
v_permlane16_swap_b32 v105, v107
buffer_store_dwordx4 v[104:107], v96, s[16:19], s3 offen offset:64
v_bfe_u32 v128, v0, 4, 1
v_lshrrev_b32 v129, 5, v0
v_lshl_or_b32 v128, v128, 1, v129
v_and_b32 v129, 15, v0
v_lshlrev_b32 v129, 12, v129
v_lshl_add_u32 v128, v128, 4, v129
s_lshl_b32 s3, s101, 5
s_add_u32 s3, s3, s29
s_lshl_b32 s3, s3, 12
s_lshl_b32 s6, s30, 1
s_add_u32 s3, s3, s6
s_waitcnt vmcnt(4)
v_pk_add_f32 v[32:33], v[32:33], v[224:225]
v_pk_add_f32 v[34:35], v[34:35], v[226:227]
v_pk_add_f32 v[36:37], v[36:37], v[228:229]
v_pk_add_f32 v[38:39], v[38:39], v[230:231]
v_cvt_pk_bf16_f32 v132, v32, v33
v_cvt_pk_bf16_f32 v133, v34, v35
v_cvt_pk_bf16_f32 v134, v36, v37
v_cvt_pk_bf16_f32 v135, v38, v39
s_nop 0
v_permlane16_swap_b32 v132, v134
v_permlane16_swap_b32 v133, v135
buffer_store_dwordx4 v[132:135], v128, s[16:19], s3 offen offset:0
v_pk_add_f32 v[40:41], v[40:41], v[232:233]
v_pk_add_f32 v[42:43], v[42:43], v[234:235]
v_pk_add_f32 v[44:45], v[44:45], v[236:237]
v_pk_add_f32 v[46:47], v[46:47], v[238:239]
v_cvt_pk_bf16_f32 v136, v40, v41
v_cvt_pk_bf16_f32 v137, v42, v43
v_cvt_pk_bf16_f32 v138, v44, v45
v_cvt_pk_bf16_f32 v139, v46, v47
s_nop 0
v_permlane16_swap_b32 v136, v138
v_permlane16_swap_b32 v137, v139
buffer_store_dwordx4 v[136:139], v128, s[16:19], s3 offen offset:64
s_add_u32 s3, s3, 65536
v_pk_add_f32 v[64:65], v[64:65], v[240:241]
v_pk_add_f32 v[66:67], v[66:67], v[242:243]
v_pk_add_f32 v[68:69], v[68:69], v[244:245]
v_pk_add_f32 v[70:71], v[70:71], v[246:247]
v_cvt_pk_bf16_f32 v132, v64, v65
v_cvt_pk_bf16_f32 v133, v66, v67
v_cvt_pk_bf16_f32 v134, v68, v69
v_cvt_pk_bf16_f32 v135, v70, v71
s_nop 0
v_permlane16_swap_b32 v132, v134
v_permlane16_swap_b32 v133, v135
buffer_store_dwordx4 v[132:135], v128, s[16:19], s3 offen offset:0
v_pk_add_f32 v[72:73], v[72:73], v[248:249]
v_pk_add_f32 v[74:75], v[74:75], v[250:251]
v_pk_add_f32 v[76:77], v[76:77], v[252:253]
v_pk_add_f32 v[78:79], v[78:79], v[254:255]
v_cvt_pk_bf16_f32 v136, v72, v73
v_cvt_pk_bf16_f32 v137, v74, v75
v_cvt_pk_bf16_f32 v138, v76, v77
v_cvt_pk_bf16_f32 v139, v78, v79
s_nop 0
v_permlane16_swap_b32 v136, v138
v_permlane16_swap_b32 v137, v139
buffer_store_dwordx4 v[136:139], v128, s[16:19], s3 offen offset:64
s_endpgm
Lk3_spinb0:
Lk3_spinb0_:
s_add_u32 s61, s61, 1
s_cmp_gt_u32 s61, 1048576
s_cbranch_scc1 Lk3_gotb0
s_sleep 2
buffer_load_dword v7, v15, s[52:55], s43 offen sc1
s_waitcnt vmcnt(0)
v_cmp_ne_u32 vcc, 1, v7
s_nop 0
s_cbranch_vccnz Lk3_spinb0_
s_branch Lk3_gotb0
Lk3_spinb1:
Lk3_spinb1_:
s_add_u32 s61, s61, 1
s_cmp_gt_u32 s61, 1048576
s_cbranch_scc1 Lk3_gotb1
s_sleep 2
buffer_load_dword v7, v15, s[52:55], s43 offen sc1
s_waitcnt vmcnt(0)
v_cmp_ne_u32 vcc, 1, v7
s_nop 0
s_cbranch_vccnz Lk3_spinb1_
s_branch Lk3_gotb1
Lk3_spinft:
s_add_u32 s61, s61, 1
s_cmp_gt_u32 s61, 1048576
s_cbranch_scc1 Lk3_gotft
s_sleep 2
buffer_load_dword v252, v255, s[52:55], s62 offen sc1
s_waitcnt vmcnt(0)
v_cmp_ne_u32 vcc, 1, v252
s_nop 0
s_cbranch_vccnz Lk3_spinft
s_branch Lk3_gotft
Lk3_spinfl:
s_add_u32 s61, s61, 1
s_cmp_gt_u32 s61, 1048576
s_cbranch_scc1 Lk3_gotfl
s_sleep 2
buffer_load_dword v8, v11, s[52:55], s59 offen sc1
s_waitcnt vmcnt(0)
v_cmp_ne_u32 vcc, 1, v8
s_nop 0
s_cbranch_vccnz Lk3_spinfl
s_branch Lk3_gotfl
Lc3:
.section .rodata,"a"
.p2align 6
.amdhsa_kernel concat_heads__compressed_kv_cla__sliding_local_dilated__prompt_kernel
  .amdhsa_next_free_vgpr 512
  .amdhsa_next_free_sgpr 102
  .amdhsa_accum_offset 256
  .amdhsa_group_segment_fixed_size 0
  .amdhsa_kernarg_size 96
  .amdhsa_user_sgpr_count 2
  .amdhsa_user_sgpr_kernarg_segment_ptr 1
  .amdhsa_system_sgpr_workgroup_id_x 1
.end_amdhsa_kernel
```

```asm
; @launch grid=(256,1,1) block=(256,1,1) lds=163840
.amdgcn_target "amdgcn-amd-amdhsa--gfx950"
.text
.macro M d, a, b, c
v_mfma_f32_16x16x32_bf16 \d, \a, \b, \c
.endm
.globl concat_heads__compressed_kv_cla__sliding_local_dilated__prompt_kernel
.p2align 8
.type concat_heads__compressed_kv_cla__sliding_local_dilated__prompt_kernel,@function
concat_heads__compressed_kv_cla__sliding_local_dilated__prompt_kernel:
s_cmp_lt_u32 s2, 256
s_cbranch_scc1 Lk1_go
s_endpgm
Lk1_go:
s_load_dwordx16 s[32:47], s[0:1], 0
s_load_dwordx2 s[48:49], s[0:1], 64
s_load_dwordx2 s[50:51], s[0:1], 88
s_load_dwordx2 s[90:91], s[0:1], 80
v_lshrrev_b32 v24, 6, v0
s_nop 0
v_readfirstlane_b32 s20, v24
v_and_b32 v0, 63, v0
v_lshlrev_b32 v1, 4, v0
s_mov_b32 s101, s20
s_lshr_b32 s21, s20, 1
s_and_b32 s22, s20, 1
s_lshl_b32 s29, s20, 12
s_and_b32 s3, s2, 1
s_lshl_b32 s3, s3, 2
s_bfe_u32 s6, s2, 0x20003
s_add_u32 s3, s3, s6
s_lshl_b32 s52, s3, 8
s_bfe_u32 s3, s2, 0x20001
s_lshl_b32 s3, s3, 2
s_bfe_u32 s7, s2, 0x20005
s_add_u32 s3, s3, s7
s_lshl_b32 s53, s3, 8
s_cmp_lt_u32 s2, 128
s_cselect_b32 s5, 11, 10
s_lshl_b32 s3, s21, 7
s_lshl_b32 s4, s22, 5
s_add_u32 s3, s3, s4
v_lshrrev_b32 v24, 3, v0
v_add_u32 v24, s3, v24
v_and_b32 v25, 7, v0
v_add_u32 v26, 0, v24
v_bfe_u32 v27, v26, 1, 3
v_xor_b32 v27, v27, v25
v_lshlrev_b32 v26, s5, v26
v_lshl_add_u32 v26, v27, 4, v26
v_subrev_u32 v2, 0, v26
v_add_u32 v26, 8, v24
v_bfe_u32 v27, v26, 1, 3
v_xor_b32 v27, v27, v25
v_lshlrev_b32 v26, s5, v26
v_lshl_add_u32 v26, v27, 4, v26
v_subrev_u32 v3, 1024, v26
v_add_u32 v26, 16, v24
v_bfe_u32 v27, v26, 1, 3
v_xor_b32 v27, v27, v25
v_lshlrev_b32 v26, s5, v26
v_lshl_add_u32 v26, v27, 4, v26
v_subrev_u32 v4, 2048, v26
v_add_u32 v26, 24, v24
v_bfe_u32 v27, v26, 1, 3
v_xor_b32 v27, v27, v25
v_lshlrev_b32 v26, s5, v26
v_lshl_add_u32 v26, v27, 4, v26
v_subrev_u32 v5, 3072, v26
s_lshl_b32 s3, s20, 3
v_lshrrev_b32 v24, 5, v0
v_add_u32 v24, s3, v24
v_and_b32 v25, 31, v0
v_add_u32 v26, 0, v24
v_and_b32 v27, 3, v26
v_lshlrev_b32 v27, 1, v27
v_and_or_b32 v27, v26, 8, v27
v_xor_b32 v27, v27, v25
v_lshlrev_b32 v26, 13, v26
v_lshl_add_u32 v26, v27, 4, v26
v_subrev_u32 v6, 0, v26
v_add_u32 v26, 2, v24
v_and_b32 v27, 3, v26
v_lshlrev_b32 v27, 1, v27
v_and_or_b32 v27, v26, 8, v27
v_xor_b32 v27, v27, v25
v_lshlrev_b32 v26, 13, v26
v_lshl_add_u32 v26, v27, 4, v26
v_subrev_u32 v7, 1024, v26
v_add_u32 v26, 4, v24
v_and_b32 v27, 3, v26
v_lshlrev_b32 v27, 1, v27
v_and_or_b32 v27, v26, 8, v27
v_xor_b32 v27, v27, v25
v_lshlrev_b32 v26, 13, v26
v_lshl_add_u32 v26, v27, 4, v26
v_subrev_u32 v8, 2048, v26
v_add_u32 v26, 6, v24
v_and_b32 v27, 3, v26
v_lshlrev_b32 v27, 1, v27
v_and_or_b32 v27, v26, 8, v27
v_xor_b32 v27, v27, v25
v_lshlrev_b32 v26, 13, v26
v_lshl_add_u32 v26, v27, 4, v26
v_subrev_u32 v9, 3072, v26
s_lshl_b32 s23, s52, s5
s_lshl_b32 s31, 64, s5
s_mov_b32 s26, s23
s_lshl_b32 s24, s53, 1
s_mov_b32 s28, s24
s_lshl_b32 s3, 1, s5
s_add_u32 s25, s23, s3
s_lshl_b32 s3, s3, 12
s_add_u32 s27, s24, s3
s_bfe_u32 s3, s2, 0x20001
s_and_b32 s4, s2, 1
s_lshl_b32 s4, s4, 1
s_add_u32 s3, s3, s4
s_and_b32 s3, s3, 3
s_sub_u32 s4, s5, 2
s_lshl_b32 s3, s3, s4
s_add_u32 s23, s23, s3
s_lshl_b32 s3, s3, 12
s_add_u32 s24, s24, s3
s_mov_b32 s95, s6
s_cmp_lt_u32 s2, 128
s_cselect_b32 s6, -1, 8
s_waitcnt lgkmcnt(0)
s_cmp_lt_u32 s2, 128
s_cselect_b64 s[8:9], s[32:33], s[34:35]
s_mov_b32 s10, 2097152
s_cselect_b32 s10, 4194304, s10
s_mov_b32 s11, 0x00020000
s_cselect_b64 s[12:13], s[36:37], s[38:39]
s_mov_b32 s14, 4194304
s_cselect_b32 s14, 8388608, s14
s_mov_b32 s15, 0x00020000
s_mov_b64 s[64:65], s[40:41]
s_add_u32 m0, s29, 65536
s_nop 0
buffer_load_dwordx4 v6, s[12:15], s24 offen offset:0 lds
buffer_load_dwordx4 v7, s[12:15], s24 offen offset:1024 lds
buffer_load_dwordx4 v8, s[12:15], s24 offen offset:2048 lds
buffer_load_dwordx4 v9, s[12:15], s24 offen offset:3072 lds
s_add_u32 s24, s24, 262144
s_add_u32 m0, s29, 0
s_nop 0
buffer_load_dwordx4 v2, s[8:11], s23 offen offset:0 lds
buffer_load_dwordx4 v3, s[8:11], s23 offen offset:1024 lds
buffer_load_dwordx4 v4, s[8:11], s23 offen offset:2048 lds
buffer_load_dwordx4 v5, s[8:11], s23 offen offset:3072 lds
s_add_u32 m0, s29, 81920
s_nop 0
buffer_load_dwordx4 v6, s[12:15], s24 offen offset:0 lds
buffer_load_dwordx4 v7, s[12:15], s24 offen offset:1024 lds
buffer_load_dwordx4 v8, s[12:15], s24 offen offset:2048 lds
buffer_load_dwordx4 v9, s[12:15], s24 offen offset:3072 lds
s_add_u32 s24, s24, 262144
s_cmp_eq_u32 s24, s27
s_cselect_b32 s24, s28, s24
s_sub_u32 s6, s6, 1
s_cmp_eq_u32 s6, 0
s_cselect_b64 s[12:13], s[64:65], s[12:13]
s_add_u32 m0, s29, 98304
s_nop 0
buffer_load_dwordx4 v6, s[12:15], s24 offen offset:0 lds
buffer_load_dwordx4 v7, s[12:15], s24 offen offset:1024 lds
buffer_load_dwordx4 v8, s[12:15], s24 offen offset:2048 lds
buffer_load_dwordx4 v9, s[12:15], s24 offen offset:3072 lds
s_add_u32 s24, s24, 262144
s_add_u32 m0, s29, 16384
s_add_u32 s3, s23, s31
s_nop 0
buffer_load_dwordx4 v2, s[8:11], s3 offen offset:0 lds
buffer_load_dwordx4 v3, s[8:11], s3 offen offset:1024 lds
buffer_load_dwordx4 v4, s[8:11], s3 offen offset:2048 lds
buffer_load_dwordx4 v5, s[8:11], s3 offen offset:3072 lds
s_add_u32 s23, s23, 128
s_cmp_eq_u32 s23, s25
s_cselect_b32 s23, s26, s23
s_add_u32 m0, s29, 114688
s_nop 0
buffer_load_dwordx4 v6, s[12:15], s24 offen offset:0 lds
buffer_load_dwordx4 v7, s[12:15], s24 offen offset:1024 lds
buffer_load_dwordx4 v8, s[12:15], s24 offen offset:2048 lds
buffer_load_dwordx4 v9, s[12:15], s24 offen offset:3072 lds
s_add_u32 s24, s24, 262144
s_cmp_eq_u32 s24, s27
s_cselect_b32 s24, s28, s24
s_sub_u32 s6, s6, 1
s_cmp_eq_u32 s6, 0
s_cselect_b64 s[12:13], s[64:65], s[12:13]
s_add_u32 s16, s50, 109051904
s_addc_u32 s17, s51, 0
s_mov_b32 s18, 16384
s_mov_b32 s19, 0x00020000
v_mov_b32 v24, 0
v_mov_b32 v25, 0
v_mov_b32 v26, 0
v_mov_b32 v27, 0
s_lshl_b32 s3, s2, 2
buffer_store_dword v24, v24, s[16:19], s3 offen sc1
s_and_b32 s3, s2, 7
s_lshr_b32 s4, s2, 6
s_lshl_b32 s4, s4, 3
s_add_u32 s3, s3, s4
s_lshl_b32 s3, s3, 4
s_add_u32 s3, s3, 4096
s_bfe_u32 s4, s2, 0x30003
s_lshl_b32 s4, s4, 9
s_add_u32 s92, s3, s4
s_sub_u32 s4, 7680, s4
s_add_u32 s93, s3, s4
buffer_store_dwordx4 v[24:27], v24, s[16:19], s92 offen sc1
buffer_store_dwordx4 v[24:27], v24, s[16:19], s93 offen sc1
s_and_b32 s3, s2, 1
s_lshl_b32 s3, s3, 3
s_bfe_u32 s4, s2, 0x30003
s_add_u32 s92, s3, s4
s_bfe_u32 s3, s2, 0x20001
s_lshl_b32 s3, s3, 2
s_lshr_b32 s4, s2, 6
s_xor_b32 s4, s4, 2
s_add_u32 s93, s3, s4
s_lshl_b32 s92, s92, 8
s_lshl_b32 s93, s93, 4
s_add_u32 s92, s92, s93
s_add_u32 s92, s92, 12288
buffer_store_dwordx4 v[24:27], v24, s[16:19], s92 offen sc1
v_lshlrev_b32 v20, 7, v0
s_lshl_b32 s54, s2, 13
s_mov_b64 s[60:61], s[40:41]
s_mov_b32 s62, 0
s_cmp_eq_u32 s20, 1
s_cselect_b64 s[60:61], s[46:47], s[60:61]
s_cselect_b32 s62, 6291456, s62
s_cmp_eq_u32 s20, 2
s_cselect_b64 s[60:61], s[44:45], s[60:61]
s_cselect_b32 s62, 4194304, s62
s_cmp_eq_u32 s20, 3
s_cselect_b32 s62, 0, s62
s_mov_b32 s63, 0x00020000
s_mov_b32 s3, 0
s_cmp_eq_u32 s20, 1
s_cselect_b32 s3, 6291456, s3
s_cmp_eq_u32 s20, 2
s_cselect_b32 s3, 6291456, s3
s_sub_u32 s54, s54, s3
Lc0:
s_getpc_b64 s[92:93]
Lpc_1:
s_add_u32 s92, s92, Lc1-Lpc_1
s_addc_u32 s93, s93, 0
s_lshr_b32 s94, s2, 3
s_mul_i32 s94, s94, ((Lc3-Lc1)/32+127)&~127
v_lshlrev_b32 v24, 7, v0
v_add_u32 v24, s94, v24
v_min_u32 v24, Lc3-Lc1-4, v24
global_load_dword v21, v24, s[92:93]
s_add_u32 m0, s29, 32768
s_nop 0
buffer_load_dwordx4 v2, s[8:11], s23 offen offset:0 lds
buffer_load_dwordx4 v3, s[8:11], s23 offen offset:1024 lds
buffer_load_dwordx4 v4, s[8:11], s23 offen offset:2048 lds
buffer_load_dwordx4 v5, s[8:11], s23 offen offset:3072 lds
s_lshl_b32 s4, s21, 13
v_and_b32 v24, 15, v0
v_lshlrev_b32 v24, 7, v24
v_add_u32 v24, s4, v24
v_bfe_u32 v25, v0, 1, 3
v_lshrrev_b32 v26, 4, v0
v_xor_b32 v25, v25, v26
v_lshl_add_u32 v10, v25, 4, v24
v_xor_b32 v11, 64, v10
v_bfe_u32 v24, v0, 2, 2
v_lshl_add_u32 v29, v26, 3, v24
v_lshlrev_b32 v25, 9, v29
v_and_b32 v27, 1, v0
v_lshl_add_u32 v25, v27, 3, v25
v_add_u32 v25, 65536, v25
v_lshlrev_b32 v24, 1, v24
v_and_or_b32 v24, v29, 8, v24
v_bfe_u32 v26, v0, 1, 1
s_lshl_b32 s4, s22, 4
s_add_u32 s3, s4, 0
v_add_u32 v27, s3, v26
v_xor_b32 v27, v27, v24
v_lshl_add_u32 v12, v27, 4, v25
s_add_u32 s3, s4, 2
v_add_u32 v27, s3, v26
v_xor_b32 v27, v27, v24
v_lshl_add_u32 v13, v27, 4, v25
s_add_u32 s3, s4, 4
v_add_u32 v27, s3, v26
v_xor_b32 v27, v27, v24
v_lshl_add_u32 v14, v27, 4, v25
s_add_u32 s3, s4, 6
v_add_u32 v27, s3, v26
v_xor_b32 v27, v27, v24
v_lshl_add_u32 v15, v27, 4, v25
s_add_u32 s3, s4, 8
v_add_u32 v27, s3, v26
v_xor_b32 v27, v27, v24
v_lshl_add_u32 v16, v27, 4, v25
s_add_u32 s3, s4, 10
v_add_u32 v27, s3, v26
v_xor_b32 v27, v27, v24
v_lshl_add_u32 v17, v27, 4, v25
s_add_u32 s3, s4, 12
v_add_u32 v27, s3, v26
v_xor_b32 v27, v27, v24
v_lshl_add_u32 v18, v27, 4, v25
s_add_u32 s3, s4, 14
v_add_u32 v27, s3, v26
v_xor_b32 v27, v27, v24
v_lshl_add_u32 v19, v27, 4, v25
s_waitcnt vmcnt(21)
s_barrier
ds_read_b64_tr_b16 a[32:33], v12 offset:0
ds_read_b64_tr_b16 a[34:35], v12 offset:2048
ds_read_b64_tr_b16 a[40:41], v13 offset:0
ds_read_b64_tr_b16 a[42:43], v13 offset:2048
ds_read_b64_tr_b16 a[48:49], v14 offset:0
ds_read_b64_tr_b16 a[50:51], v14 offset:2048
ds_read_b64_tr_b16 a[56:57], v15 offset:0
ds_read_b64_tr_b16 a[58:59], v15 offset:2048
ds_read_b64_tr_b16 a[64:65], v16 offset:0
ds_read_b64_tr_b16 a[66:67], v16 offset:2048
ds_read_b64_tr_b16 a[72:73], v17 offset:0
ds_read_b64_tr_b16 a[74:75], v17 offset:2048
ds_read_b64_tr_b16 a[80:81], v18 offset:0
ds_read_b64_tr_b16 a[82:83], v18 offset:2048
ds_read_b64_tr_b16 a[88:89], v19 offset:0
ds_read_b64_tr_b16 a[90:91], v19 offset:2048
ds_read_b64_tr_b16 a[36:37], v12 offset:16384
ds_read_b64_tr_b16 a[38:39], v12 offset:18432
ds_read_b64_tr_b16 a[44:45], v13 offset:16384
ds_read_b64_tr_b16 a[46:47], v13 offset:18432
ds_read_b64_tr_b16 a[52:53], v14 offset:16384
ds_read_b64_tr_b16 a[54:55], v14 offset:18432
ds_read_b64_tr_b16 a[60:61], v15 offset:16384
ds_read_b64_tr_b16 a[62:63], v15 offset:18432
ds_read_b64_tr_b16 a[68:69], v16 offset:16384
ds_read_b64_tr_b16 a[70:71], v16 offset:18432
ds_read_b64_tr_b16 a[76:77], v17 offset:16384
ds_read_b64_tr_b16 a[78:79], v17 offset:18432
ds_read_b64_tr_b16 a[84:85], v18 offset:16384
ds_read_b64_tr_b16 a[86:87], v18 offset:18432
ds_read_b64_tr_b16 a[92:93], v19 offset:16384
ds_read_b64_tr_b16 a[94:95], v19 offset:18432
ds_read_b128 a[160:163], v10 offset:0
ds_read_b128 a[164:167], v11 offset:0
ds_read_b128 a[168:171], v10 offset:2048
ds_read_b128 a[172:175], v11 offset:2048
s_waitcnt vmcnt(17) lgkmcnt(0)
s_barrier
s_add_u32 m0, s29, 65536
s_nop 0
buffer_load_dwordx4 v6, s[12:15], s24 offen offset:0 lds
buffer_load_dwordx4 v7, s[12:15], s24 offen offset:1024 lds
buffer_load_dwordx4 v8, s[12:15], s24 offen offset:2048 lds
buffer_load_dwordx4 v9, s[12:15], s24 offen offset:3072 lds
s_add_u32 s24, s24, 262144
s_add_u32 m0, s29, 49152
s_add_u32 s3, s23, s31
s_nop 0
buffer_load_dwordx4 v2, s[8:11], s3 offen offset:0 lds
buffer_load_dwordx4 v3, s[8:11], s3 offen offset:1024 lds
buffer_load_dwordx4 v4, s[8:11], s3 offen offset:2048 lds
buffer_load_dwordx4 v5, s[8:11], s3 offen offset:3072 lds
Lc1:
s_cmp_lt_u32 s2, 128
s_cbranch_scc0 Lk1_kv
M v[32:35], a[32:35], a[160:163], 0
s_add_u32 s23, s23, 128
s_cmp_eq_u32 s23, s25
s_cselect_b32 s23, s26, s23
M v[32:35], a[36:39], a[164:167], v[32:35]
ds_read_b128 a[176:179], v10 offset:4096
ds_read_b128 a[180:183], v11 offset:4096
M v[36:39], a[44:47], a[164:167], 0
M v[36:39], a[40:43], a[160:163], v[36:39]
ds_read_b64_tr_b16 a[96:97], v12 offset:32768
ds_read_b64_tr_b16 a[98:99], v12 offset:34816
M v[40:43], a[48:51], a[160:163], 0
M v[40:43], a[52:55], a[164:167], v[40:43]
M v[44:47], a[60:63], a[164:167], 0
s_add_u32 m0, s29, 81920
s_nop 0
buffer_load_dwordx4 v6, s[12:15], s24 offen offset:0 lds
M v[44:47], a[56:59], a[160:163], v[44:47]
ds_read_b64_tr_b16 a[104:105], v13 offset:32768
ds_read_b64_tr_b16 a[106:107], v13 offset:34816
M v[48:51], a[64:67], a[160:163], 0
M v[48:51], a[68:71], a[164:167], v[48:51]
M v[52:55], a[76:79], a[164:167], 0
M v[52:55], a[72:75], a[160:163], v[52:55]
ds_read_b64_tr_b16 a[112:113], v14 offset:32768
ds_read_b64_tr_b16 a[114:115], v14 offset:34816
M v[56:59], a[80:83], a[160:163], 0
M v[56:59], a[84:87], a[164:167], v[56:59]
buffer_load_dwordx4 v7, s[12:15], s24 offen offset:1024 lds
M v[60:63], a[92:95], a[164:167], 0
M v[60:63], a[88:91], a[160:163], v[60:63]
ds_read_b64_tr_b16 a[120:121], v15 offset:32768
ds_read_b64_tr_b16 a[122:123], v15 offset:34816
M v[64:67], a[32:35], a[168:171], 0
M v[64:67], a[36:39], a[172:175], v[64:67]
ds_read_b128 a[184:187], v10 offset:6144
ds_read_b128 a[188:191], v11 offset:6144
M v[68:71], a[44:47], a[172:175], 0
M v[68:71], a[40:43], a[168:171], v[68:71]
ds_read_b64_tr_b16 a[128:129], v16 offset:32768
ds_read_b64_tr_b16 a[130:131], v16 offset:34816
M v[72:75], a[48:51], a[168:171], 0
buffer_load_dwordx4 v8, s[12:15], s24 offen offset:2048 lds
M v[72:75], a[52:55], a[172:175], v[72:75]
M v[76:79], a[60:63], a[172:175], 0
M v[76:79], a[56:59], a[168:171], v[76:79]
ds_read_b64_tr_b16 a[136:137], v17 offset:32768
ds_read_b64_tr_b16 a[138:139], v17 offset:34816
M v[80:83], a[64:67], a[168:171], 0
M v[80:83], a[68:71], a[172:175], v[80:83]
M v[84:87], a[76:79], a[172:175], 0
buffer_load_dwordx4 v9, s[12:15], s24 offen offset:3072 lds
M v[84:87], a[72:75], a[168:171], v[84:87]
ds_read_b64_tr_b16 a[144:145], v18 offset:32768
ds_read_b64_tr_b16 a[146:147], v18 offset:34816
M v[88:91], a[80:83], a[168:171], 0
M v[88:91], a[84:87], a[172:175], v[88:91]
M v[92:95], a[92:95], a[172:175], 0
M v[92:95], a[88:91], a[168:171], v[92:95]
s_waitcnt lgkmcnt(15)
ds_read_b64_tr_b16 a[152:153], v19 offset:32768
ds_read_b64_tr_b16 a[154:155], v19 offset:34816
M v[96:99], a[32:35], a[176:179], 0
s_add_u32 s24, s24, 262144
s_cmp_eq_u32 s24, s27
s_cselect_b32 s24, s28, s24
s_sub_u32 s6, s6, 1
s_cmp_eq_u32 s6, 0
s_cselect_b64 s[12:13], s[64:65], s[12:13]
M v[96:99], a[36:39], a[180:183], v[96:99]
M v[100:103], a[44:47], a[180:183], 0
M v[100:103], a[40:43], a[176:179], v[100:103]
M v[104:107], a[48:51], a[176:179], 0
M v[104:107], a[52:55], a[180:183], v[104:107]
M v[108:111], a[60:63], a[180:183], 0
M v[108:111], a[56:59], a[176:179], v[108:111]
s_waitcnt vmcnt(21) lgkmcnt(0)
s_barrier
ds_read_b128 a[160:163], v10 offset:16384
ds_read_b128 a[164:167], v11 offset:16384
M v[112:115], a[64:67], a[176:179], 0
s_add_u32 m0, s29, 0
s_nop 0
buffer_load_dwordx4 v2, s[8:11], s23 offen offset:0 lds
M v[112:115], a[68:71], a[180:183], v[112:115]
M v[116:119], a[76:79], a[180:183], 0
M v[116:119], a[72:75], a[176:179], v[116:119]
ds_read_b64_tr_b16 a[100:101], v12 offset:49152
ds_read_b64_tr_b16 a[102:103], v12 offset:51200
M v[120:123], a[80:83], a[176:179], 0
M v[120:123], a[84:87], a[180:183], v[120:123]
buffer_load_dwordx4 v3, s[8:11], s23 offen offset:1024 lds
M v[124:127], a[92:95], a[180:183], 0
M v[124:127], a[88:91], a[176:179], v[124:127]
M v[128:131], a[32:35], a[184:187], 0
M v[128:131], a[36:39], a[188:191], v[128:131]
ds_read_b128 a[168:171], v10 offset:18432
ds_read_b128 a[172:175], v11 offset:18432
ds_read_b64_tr_b16 a[108:109], v13 offset:49152
ds_read_b64_tr_b16 a[110:111], v13 offset:51200
M v[132:135], a[44:47], a[188:191], 0
M v[132:135], a[40:43], a[184:187], v[132:135]
M v[136:139], a[48:51], a[184:187], 0
buffer_load_dwordx4 v4, s[8:11], s23 offen offset:2048 lds
M v[136:139], a[52:55], a[188:191], v[136:139]
M v[140:143], a[60:63], a[188:191], 0
M v[140:143], a[56:59], a[184:187], v[140:143]
ds_read_b64_tr_b16 a[116:117], v14 offset:49152
ds_read_b64_tr_b16 a[118:119], v14 offset:51200
M v[144:147], a[64:67], a[184:187], 0
M v[144:147], a[68:71], a[188:191], v[144:147]
M v[148:151], a[76:79], a[188:191], 0
buffer_load_dwordx4 v5, s[8:11], s23 offen offset:3072 lds
M v[148:151], a[72:75], a[184:187], v[148:151]
M v[152:155], a[80:83], a[184:187], 0
M v[152:155], a[84:87], a[188:191], v[152:155]
ds_read_b64_tr_b16 a[124:125], v15 offset:49152
ds_read_b64_tr_b16 a[126:127], v15 offset:51200
M v[156:159], a[92:95], a[188:191], 0
M v[156:159], a[88:91], a[184:187], v[156:159]
s_waitcnt lgkmcnt(10)
M v[160:163], a[32:35], a[160:163], 0
M v[160:163], a[36:39], a[164:167], v[160:163]
ds_read_b128 a[176:179], v10 offset:20480
ds_read_b128 a[180:183], v11 offset:20480
M v[164:167], a[44:47], a[164:167], 0
s_add_u32 m0, s29, 98304
s_nop 0
buffer_load_dwordx4 v6, s[12:15], s24 offen offset:0 lds
M v[164:167], a[40:43], a[160:163], v[164:167]
ds_read_b64_tr_b16 a[132:133], v16 offset:49152
ds_read_b64_tr_b16 a[134:135], v16 offset:51200
M v[168:171], a[48:51], a[160:163], 0
M v[168:171], a[52:55], a[164:167], v[168:171]
M v[172:175], a[60:63], a[164:167], 0
M v[172:175], a[56:59], a[160:163], v[172:175]
M v[176:179], a[64:67], a[160:163], 0
buffer_load_dwordx4 v7, s[12:15], s24 offen offset:1024 lds
M v[176:179], a[68:71], a[164:167], v[176:179]
ds_read_b64_tr_b16 a[140:141], v17 offset:49152
ds_read_b64_tr_b16 a[142:143], v17 offset:51200
M v[180:183], a[76:79], a[164:167], 0
M v[180:183], a[72:75], a[160:163], v[180:183]
M v[184:187], a[80:83], a[160:163], 0
M v[184:187], a[84:87], a[164:167], v[184:187]
buffer_load_dwordx4 v8, s[12:15], s24 offen offset:2048 lds
M v[188:191], a[92:95], a[164:167], 0
M v[188:191], a[88:91], a[160:163], v[188:191]
s_waitcnt lgkmcnt(12)
ds_read_b64_tr_b16 a[148:149], v18 offset:49152
ds_read_b64_tr_b16 a[150:151], v18 offset:51200
M v[192:195], a[32:35], a[168:171], 0
M v[192:195], a[36:39], a[172:175], v[192:195]
ds_read_b128 a[184:187], v10 offset:22528
ds_read_b128 a[188:191], v11 offset:22528
M v[196:199], a[44:47], a[172:175], 0
M v[196:199], a[40:43], a[168:171], v[196:199]
M v[200:203], a[48:51], a[168:171], 0
buffer_load_dwordx4 v9, s[12:15], s24 offen offset:3072 lds
M v[200:203], a[52:55], a[172:175], v[200:203]
ds_read_b64_tr_b16 a[156:157], v19 offset:49152
ds_read_b64_tr_b16 a[158:159], v19 offset:51200
M v[204:207], a[60:63], a[172:175], 0
M v[204:207], a[56:59], a[168:171], v[204:207]
M v[208:211], a[64:67], a[168:171], 0
M v[208:211], a[68:71], a[172:175], v[208:211]
M v[212:215], a[76:79], a[172:175], 0
s_add_u32 s24, s24, 262144
M v[212:215], a[72:75], a[168:171], v[212:215]
M v[216:219], a[80:83], a[168:171], 0
M v[216:219], a[84:87], a[172:175], v[216:219]
M v[220:223], a[92:95], a[172:175], 0
M v[220:223], a[88:91], a[168:171], v[220:223]
s_waitcnt lgkmcnt(10)
M v[224:227], a[32:35], a[176:179], 0
buffer_load_dword v21, v20, s[60:63], s54 offen
s_add_u32 s54, s54, 1048576
M v[224:227], a[36:39], a[180:183], v[224:227]
M v[228:231], a[44:47], a[180:183], 0
M v[228:231], a[40:43], a[176:179], v[228:231]
M v[232:235], a[48:51], a[176:179], 0
M v[232:235], a[52:55], a[180:183], v[232:235]
M v[236:239], a[60:63], a[180:183], 0
M v[236:239], a[56:59], a[176:179], v[236:239]
s_waitcnt vmcnt(17) lgkmcnt(0)
s_barrier
ds_read_b128 a[160:163], v10 offset:32768
ds_read_b128 a[164:167], v11 offset:32768
M v[240:243], a[64:67], a[176:179], 0
s_add_u32 m0, s29, 16384
s_add_u32 s3, s23, s31
buffer_load_dwordx4 v2, s[8:11], s3 offen offset:0 lds
M v[240:243], a[68:71], a[180:183], v[240:243]
M v[244:247], a[76:79], a[180:183], 0
M v[244:247], a[72:75], a[176:179], v[244:247]
M v[248:251], a[80:83], a[176:179], 0
M v[248:251], a[84:87], a[180:183], v[248:251]
buffer_load_dwordx4 v3, s[8:11], s3 offen offset:1024 lds
M v[252:255], a[92:95], a[180:183], 0
M v[252:255], a[88:91], a[176:179], v[252:255]
M a[0:3], a[32:35], a[184:187], 0
M a[0:3], a[36:39], a[188:191], a[0:3]
ds_read_b128 a[168:171], v10 offset:34816
ds_read_b128 a[172:175], v11 offset:34816
M a[4:7], a[44:47], a[188:191], 0
M a[4:7], a[40:43], a[184:187], a[4:7]
M a[8:11], a[48:51], a[184:187], 0
buffer_load_dwordx4 v4, s[8:11], s3 offen offset:2048 lds
M a[8:11], a[52:55], a[188:191], a[8:11]
M a[12:15], a[60:63], a[188:191], 0
M a[12:15], a[56:59], a[184:187], a[12:15]
M a[16:19], a[64:67], a[184:187], 0
M a[16:19], a[68:71], a[188:191], a[16:19]
buffer_load_dwordx4 v5, s[8:11], s3 offen offset:3072 lds
M a[20:23], a[76:79], a[188:191], 0
M a[20:23], a[72:75], a[184:187], a[20:23]
M a[24:27], a[80:83], a[184:187], 0
M a[24:27], a[84:87], a[188:191], a[24:27]
M a[28:31], a[92:95], a[188:191], 0
M a[28:31], a[88:91], a[184:187], a[28:31]
s_waitcnt lgkmcnt(2)
M v[32:35], a[96:99], a[160:163], v[32:35]
s_add_u32 s23, s23, 128
s_cmp_eq_u32 s23, s25
s_cselect_b32 s23, s26, s23
M v[32:35], a[100:103], a[164:167], v[32:35]
ds_read_b128 a[176:179], v10 offset:36864
ds_read_b128 a[180:183], v11 offset:36864
M v[36:39], a[108:111], a[164:167], v[36:39]
M v[36:39], a[104:107], a[160:163], v[36:39]
ds_read_b64_tr_b16 a[32:33], v12 offset:0
ds_read_b64_tr_b16 a[34:35], v12 offset:2048
M v[40:43], a[112:115], a[160:163], v[40:43]
M v[40:43], a[116:119], a[164:167], v[40:43]
M v[44:47], a[124:127], a[164:167], v[44:47]
s_add_u32 m0, s29, 114688
s_nop 0
buffer_load_dwordx4 v6, s[12:15], s24 offen offset:0 lds
M v[44:47], a[120:123], a[160:163], v[44:47]
ds_read_b64_tr_b16 a[40:41], v13 offset:0
ds_read_b64_tr_b16 a[42:43], v13 offset:2048
M v[48:51], a[128:131], a[160:163], v[48:51]
M v[48:51], a[132:135], a[164:167], v[48:51]
M v[52:55], a[140:143], a[164:167], v[52:55]
M v[52:55], a[136:139], a[160:163], v[52:55]
ds_read_b64_tr_b16 a[48:49], v14 offset:0
ds_read_b64_tr_b16 a[50:51], v14 offset:2048
M v[56:59], a[144:147], a[160:163], v[56:59]
M v[56:59], a[148:151], a[164:167], v[56:59]
buffer_load_dwordx4 v7, s[12:15], s24 offen offset:1024 lds
M v[60:63], a[156:159], a[164:167], v[60:63]
M v[60:63], a[152:155], a[160:163], v[60:63]
s_waitcnt lgkmcnt(8)
ds_read_b64_tr_b16 a[56:57], v15 offset:0
ds_read_b64_tr_b16 a[58:59], v15 offset:2048
M v[64:67], a[96:99], a[168:171], v[64:67]
M v[64:67], a[100:103], a[172:175], v[64:67]
ds_read_b128 a[184:187], v10 offset:38912
ds_read_b128 a[188:191], v11 offset:38912
M v[68:71], a[108:111], a[172:175], v[68:71]
M v[68:71], a[104:107], a[168:171], v[68:71]
ds_read_b64_tr_b16 a[64:65], v16 offset:0
ds_read_b64_tr_b16 a[66:67], v16 offset:2048
M v[72:75], a[112:115], a[168:171], v[72:75]
buffer_load_dwordx4 v8, s[12:15], s24 offen offset:2048 lds
M v[72:75], a[116:119], a[172:175], v[72:75]
M v[76:79], a[124:127], a[172:175], v[76:79]
M v[76:79], a[120:123], a[168:171], v[76:79]
ds_read_b64_tr_b16 a[72:73], v17 offset:0
ds_read_b64_tr_b16 a[74:75], v17 offset:2048
M v[80:83], a[128:131], a[168:171], v[80:83]
M v[80:83], a[132:135], a[172:175], v[80:83]
M v[84:87], a[140:143], a[172:175], v[84:87]
buffer_load_dwordx4 v9, s[12:15], s24 offen offset:3072 lds
M v[84:87], a[136:139], a[168:171], v[84:87]
ds_read_b64_tr_b16 a[80:81], v18 offset:0
ds_read_b64_tr_b16 a[82:83], v18 offset:2048
M v[88:91], a[144:147], a[168:171], v[88:91]
M v[88:91], a[148:151], a[172:175], v[88:91]
M v[92:95], a[156:159], a[172:175], v[92:95]
M v[92:95], a[152:155], a[168:171], v[92:95]
s_waitcnt lgkmcnt(15)
ds_read_b64_tr_b16 a[88:89], v19 offset:0
ds_read_b64_tr_b16 a[90:91], v19 offset:2048
M v[96:99], a[96:99], a[176:179], v[96:99]
s_add_u32 s24, s24, 262144
s_cmp_eq_u32 s24, s27
s_cselect_b32 s24, s28, s24
s_sub_u32 s6, s6, 1
s_cmp_eq_u32 s6, 0
s_cselect_b64 s[12:13], s[64:65], s[12:13]
M v[96:99], a[100:103], a[180:183], v[96:99]
M v[100:103], a[108:111], a[180:183], v[100:103]
M v[100:103], a[104:107], a[176:179], v[100:103]
M v[104:107], a[112:115], a[176:179], v[104:107]
M v[104:107], a[116:119], a[180:183], v[104:107]
M v[108:111], a[124:127], a[180:183], v[108:111]
M v[108:111], a[120:123], a[176:179], v[108:111]
s_waitcnt vmcnt(17) lgkmcnt(0)
s_barrier
ds_read_b128 a[160:163], v10 offset:49152
ds_read_b128 a[164:167], v11 offset:49152
M v[112:115], a[128:131], a[176:179], v[112:115]
s_add_u32 m0, s29, 32768
s_nop 0
buffer_load_dwordx4 v2, s[8:11], s23 offen offset:0 lds
M v[112:115], a[132:135], a[180:183], v[112:115]
M v[116:119], a[140:143], a[180:183], v[116:119]
M v[116:119], a[136:139], a[176:179], v[116:119]
ds_read_b64_tr_b16 a[36:37], v12 offset:16384
ds_read_b64_tr_b16 a[38:39], v12 offset:18432
M v[120:123], a[144:147], a[176:179], v[120:123]
M v[120:123], a[148:151], a[180:183], v[120:123]
buffer_load_dwordx4 v3, s[8:11], s23 offen offset:1024 lds
M v[124:127], a[156:159], a[180:183], v[124:127]
M v[124:127], a[152:155], a[176:179], v[124:127]
M v[128:131], a[96:99], a[184:187], v[128:131]
M v[128:131], a[100:103], a[188:191], v[128:131]
ds_read_b128 a[168:171], v10 offset:51200
ds_read_b128 a[172:175], v11 offset:51200
ds_read_b64_tr_b16 a[44:45], v13 offset:16384
ds_read_b64_tr_b16 a[46:47], v13 offset:18432
M v[132:135], a[108:111], a[188:191], v[132:135]
M v[132:135], a[104:107], a[184:187], v[132:135]
M v[136:139], a[112:115], a[184:187], v[136:139]
buffer_load_dwordx4 v4, s[8:11], s23 offen offset:2048 lds
M v[136:139], a[116:119], a[188:191], v[136:139]
M v[140:143], a[124:127], a[188:191], v[140:143]
M v[140:143], a[120:123], a[184:187], v[140:143]
ds_read_b64_tr_b16 a[52:53], v14 offset:16384
ds_read_b64_tr_b16 a[54:55], v14 offset:18432
M v[144:147], a[128:131], a[184:187], v[144:147]
M v[144:147], a[132:135], a[188:191], v[144:147]
M v[148:151], a[140:143], a[188:191], v[148:151]
buffer_load_dwordx4 v5, s[8:11], s23 offen offset:3072 lds
M v[148:151], a[136:139], a[184:187], v[148:151]
M v[152:155], a[144:147], a[184:187], v[152:155]
M v[152:155], a[148:151], a[188:191], v[152:155]
ds_read_b64_tr_b16 a[60:61], v15 offset:16384
ds_read_b64_tr_b16 a[62:63], v15 offset:18432
M v[156:159], a[156:159], a[188:191], v[156:159]
M v[156:159], a[152:155], a[184:187], v[156:159]
s_waitcnt lgkmcnt(10)
M v[160:163], a[96:99], a[160:163], v[160:163]
M v[160:163], a[100:103], a[164:167], v[160:163]
ds_read_b128 a[176:179], v10 offset:53248
ds_read_b128 a[180:183], v11 offset:53248
M v[164:167], a[108:111], a[164:167], v[164:167]
s_add_u32 m0, s29, 65536
s_nop 0
buffer_load_dwordx4 v6, s[12:15], s24 offen offset:0 lds
M v[164:167], a[104:107], a[160:163], v[164:167]
ds_read_b64_tr_b16 a[68:69], v16 offset:16384
ds_read_b64_tr_b16 a[70:71], v16 offset:18432
M v[168:171], a[112:115], a[160:163], v[168:171]
M v[168:171], a[116:119], a[164:167], v[168:171]
M v[172:175], a[124:127], a[164:167], v[172:175]
M v[172:175], a[120:123], a[160:163], v[172:175]
M v[176:179], a[128:131], a[160:163], v[176:179]
buffer_load_dwordx4 v7, s[12:15], s24 offen offset:1024 lds
M v[176:179], a[132:135], a[164:167], v[176:179]
ds_read_b64_tr_b16 a[76:77], v17 offset:16384
ds_read_b64_tr_b16 a[78:79], v17 offset:18432
M v[180:183], a[140:143], a[164:167], v[180:183]
M v[180:183], a[136:139], a[160:163], v[180:183]
M v[184:187], a[144:147], a[160:163], v[184:187]
M v[184:187], a[148:151], a[164:167], v[184:187]
buffer_load_dwordx4 v8, s[12:15], s24 offen offset:2048 lds
M v[188:191], a[156:159], a[164:167], v[188:191]
M v[188:191], a[152:155], a[160:163], v[188:191]
s_waitcnt lgkmcnt(12)
ds_read_b64_tr_b16 a[84:85], v18 offset:16384
ds_read_b64_tr_b16 a[86:87], v18 offset:18432
M v[192:195], a[96:99], a[168:171], v[192:195]
M v[192:195], a[100:103], a[172:175], v[192:195]
ds_read_b128 a[184:187], v10 offset:55296
ds_read_b128 a[188:191], v11 offset:55296
M v[196:199], a[108:111], a[172:175], v[196:199]
M v[196:199], a[104:107], a[168:171], v[196:199]
M v[200:203], a[112:115], a[168:171], v[200:203]
buffer_load_dwordx4 v9, s[12:15], s24 offen offset:3072 lds
M v[200:203], a[116:119], a[172:175], v[200:203]
ds_read_b64_tr_b16 a[92:93], v19 offset:16384
ds_read_b64_tr_b16 a[94:95], v19 offset:18432
M v[204:207], a[124:127], a[172:175], v[204:207]
M v[204:207], a[120:123], a[168:171], v[204:207]
M v[208:211], a[128:131], a[168:171], v[208:211]
M v[208:211], a[132:135], a[172:175], v[208:211]
M v[212:215], a[140:143], a[172:175], v[212:215]
s_add_u32 s24, s24, 262144
M v[212:215], a[136:139], a[168:171], v[212:215]
M v[216:219], a[144:147], a[168:171], v[216:219]
M v[216:219], a[148:151], a[172:175], v[216:219]
M v[220:223], a[156:159], a[172:175], v[220:223]
M v[220:223], a[152:155], a[168:171], v[220:223]
s_waitcnt lgkmcnt(10)
M v[224:227], a[96:99], a[176:179], v[224:227]
buffer_load_dword v21, v20, s[60:63], s54 offen
s_add_u32 s54, s54, 1048576
M v[224:227], a[100:103], a[180:183], v[224:227]
M v[228:231], a[108:111], a[180:183], v[228:231]
M v[228:231], a[104:107], a[176:179], v[228:231]
M v[232:235], a[112:115], a[176:179], v[232:235]
M v[232:235], a[116:119], a[180:183], v[232:235]
M v[236:239], a[124:127], a[180:183], v[236:239]
M v[236:239], a[120:123], a[176:179], v[236:239]
s_waitcnt vmcnt(18) lgkmcnt(0)
s_barrier
ds_read_b128 a[160:163], v10 offset:0
ds_read_b128 a[164:167], v11 offset:0
M v[240:243], a[128:131], a[176:179], v[240:243]
s_add_u32 m0, s29, 49152
s_add_u32 s3, s23, s31
buffer_load_dwordx4 v2, s[8:11], s3 offen offset:0 lds
M v[240:243], a[132:135], a[180:183], v[240:243]
M v[244:247], a[140:143], a[180:183], v[244:247]
M v[244:247], a[136:139], a[176:179], v[244:247]
M v[248:251], a[144:147], a[176:179], v[248:251]
M v[248:251], a[148:151], a[180:183], v[248:251]
buffer_load_dwordx4 v3, s[8:11], s3 offen offset:1024 lds
M v[252:255], a[156:159], a[180:183], v[252:255]
M v[252:255], a[152:155], a[176:179], v[252:255]
M a[0:3], a[96:99], a[184:187], a[0:3]
M a[0:3], a[100:103], a[188:191], a[0:3]
ds_read_b128 a[168:171], v10 offset:2048
ds_read_b128 a[172:175], v11 offset:2048
M a[4:7], a[108:111], a[188:191], a[4:7]
M a[4:7], a[104:107], a[184:187], a[4:7]
M a[8:11], a[112:115], a[184:187], a[8:11]
buffer_load_dwordx4 v4, s[8:11], s3 offen offset:2048 lds
M a[8:11], a[116:119], a[188:191], a[8:11]
M a[12:15], a[124:127], a[188:191], a[12:15]
M a[12:15], a[120:123], a[184:187], a[12:15]
M a[16:19], a[128:131], a[184:187], a[16:19]
M a[16:19], a[132:135], a[188:191], a[16:19]
buffer_load_dwordx4 v5, s[8:11], s3 offen offset:3072 lds
M a[20:23], a[140:143], a[188:191], a[20:23]
M a[20:23], a[136:139], a[184:187], a[20:23]
M a[24:27], a[144:147], a[184:187], a[24:27]
M a[24:27], a[148:151], a[188:191], a[24:27]
M a[28:31], a[156:159], a[188:191], a[28:31]
M a[28:31], a[152:155], a[184:187], a[28:31]
s_waitcnt lgkmcnt(2)
s_mov_b32 s30, 5
Lk1_ql:
M v[32:35], a[32:35], a[160:163], v[32:35]
s_add_u32 s23, s23, 128
s_cmp_eq_u32 s23, s25
s_cselect_b32 s23, s26, s23
M v[32:35], a[36:39], a[164:167], v[32:35]
ds_read_b128 a[176:179], v10 offset:4096
ds_read_b128 a[180:183], v11 offset:4096
M v[36:39], a[44:47], a[164:167], v[36:39]
M v[36:39], a[40:43], a[160:163], v[36:39]
ds_read_b64_tr_b16 a[96:97], v12 offset:32768
ds_read_b64_tr_b16 a[98:99], v12 offset:34816
M v[40:43], a[48:51], a[160:163], v[40:43]
M v[40:43], a[52:55], a[164:167], v[40:43]
M v[44:47], a[60:63], a[164:167], v[44:47]
s_add_u32 m0, s29, 81920
s_nop 0
buffer_load_dwordx4 v6, s[12:15], s24 offen offset:0 lds
M v[44:47], a[56:59], a[160:163], v[44:47]
ds_read_b64_tr_b16 a[104:105], v13 offset:32768
ds_read_b64_tr_b16 a[106:107], v13 offset:34816
M v[48:51], a[64:67], a[160:163], v[48:51]
M v[48:51], a[68:71], a[164:167], v[48:51]
M v[52:55], a[76:79], a[164:167], v[52:55]
M v[52:55], a[72:75], a[160:163], v[52:55]
ds_read_b64_tr_b16 a[112:113], v14 offset:32768
ds_read_b64_tr_b16 a[114:115], v14 offset:34816
M v[56:59], a[80:83], a[160:163], v[56:59]
M v[56:59], a[84:87], a[164:167], v[56:59]
buffer_load_dwordx4 v7, s[12:15], s24 offen offset:1024 lds
M v[60:63], a[92:95], a[164:167], v[60:63]
M v[60:63], a[88:91], a[160:163], v[60:63]
s_waitcnt lgkmcnt(8)
ds_read_b64_tr_b16 a[120:121], v15 offset:32768
ds_read_b64_tr_b16 a[122:123], v15 offset:34816
M v[64:67], a[32:35], a[168:171], v[64:67]
M v[64:67], a[36:39], a[172:175], v[64:67]
ds_read_b128 a[184:187], v10 offset:6144
ds_read_b128 a[188:191], v11 offset:6144
M v[68:71], a[44:47], a[172:175], v[68:71]
M v[68:71], a[40:43], a[168:171], v[68:71]
ds_read_b64_tr_b16 a[128:129], v16 offset:32768
ds_read_b64_tr_b16 a[130:131], v16 offset:34816
M v[72:75], a[48:51], a[168:171], v[72:75]
buffer_load_dwordx4 v8, s[12:15], s24 offen offset:2048 lds
M v[72:75], a[52:55], a[172:175], v[72:75]
M v[76:79], a[60:63], a[172:175], v[76:79]
M v[76:79], a[56:59], a[168:171], v[76:79]
ds_read_b64_tr_b16 a[136:137], v17 offset:32768
ds_read_b64_tr_b16 a[138:139], v17 offset:34816
M v[80:83], a[64:67], a[168:171], v[80:83]
M v[80:83], a[68:71], a[172:175], v[80:83]
M v[84:87], a[76:79], a[172:175], v[84:87]
buffer_load_dwordx4 v9, s[12:15], s24 offen offset:3072 lds
M v[84:87], a[72:75], a[168:171], v[84:87]
ds_read_b64_tr_b16 a[144:145], v18 offset:32768
ds_read_b64_tr_b16 a[146:147], v18 offset:34816
M v[88:91], a[80:83], a[168:171], v[88:91]
M v[88:91], a[84:87], a[172:175], v[88:91]
M v[92:95], a[92:95], a[172:175], v[92:95]
M v[92:95], a[88:91], a[168:171], v[92:95]
s_waitcnt lgkmcnt(15)
ds_read_b64_tr_b16 a[152:153], v19 offset:32768
ds_read_b64_tr_b16 a[154:155], v19 offset:34816
M v[96:99], a[32:35], a[176:179], v[96:99]
s_add_u32 s24, s24, 262144
s_cmp_eq_u32 s24, s27
s_cselect_b32 s24, s28, s24
s_sub_u32 s6, s6, 1
s_cmp_eq_u32 s6, 0
s_cselect_b64 s[12:13], s[64:65], s[12:13]
M v[96:99], a[36:39], a[180:183], v[96:99]
M v[100:103], a[44:47], a[180:183], v[100:103]
M v[100:103], a[40:43], a[176:179], v[100:103]
M v[104:107], a[48:51], a[176:179], v[104:107]
M v[104:107], a[52:55], a[180:183], v[104:107]
M v[108:111], a[60:63], a[180:183], v[108:111]
M v[108:111], a[56:59], a[176:179], v[108:111]
s_waitcnt vmcnt(17) lgkmcnt(0)
s_barrier
ds_read_b128 a[160:163], v10 offset:16384
ds_read_b128 a[164:167], v11 offset:16384
M v[112:115], a[64:67], a[176:179], v[112:115]
s_add_u32 m0, s29, 0
s_nop 0
buffer_load_dwordx4 v2, s[8:11], s23 offen offset:0 lds
M v[112:115], a[68:71], a[180:183], v[112:115]
M v[116:119], a[76:79], a[180:183], v[116:119]
M v[116:119], a[72:75], a[176:179], v[116:119]
ds_read_b64_tr_b16 a[100:101], v12 offset:49152
ds_read_b64_tr_b16 a[102:103], v12 offset:51200
M v[120:123], a[80:83], a[176:179], v[120:123]
M v[120:123], a[84:87], a[180:183], v[120:123]
buffer_load_dwordx4 v3, s[8:11], s23 offen offset:1024 lds
M v[124:127], a[92:95], a[180:183], v[124:127]
M v[124:127], a[88:91], a[176:179], v[124:127]
M v[128:131], a[32:35], a[184:187], v[128:131]
M v[128:131], a[36:39], a[188:191], v[128:131]
ds_read_b128 a[168:171], v10 offset:18432
ds_read_b128 a[172:175], v11 offset:18432
ds_read_b64_tr_b16 a[108:109], v13 offset:49152
ds_read_b64_tr_b16 a[110:111], v13 offset:51200
M v[132:135], a[44:47], a[188:191], v[132:135]
M v[132:135], a[40:43], a[184:187], v[132:135]
M v[136:139], a[48:51], a[184:187], v[136:139]
buffer_load_dwordx4 v4, s[8:11], s23 offen offset:2048 lds
M v[136:139], a[52:55], a[188:191], v[136:139]
M v[140:143], a[60:63], a[188:191], v[140:143]
M v[140:143], a[56:59], a[184:187], v[140:143]
ds_read_b64_tr_b16 a[116:117], v14 offset:49152
ds_read_b64_tr_b16 a[118:119], v14 offset:51200
M v[144:147], a[64:67], a[184:187], v[144:147]
M v[144:147], a[68:71], a[188:191], v[144:147]
M v[148:151], a[76:79], a[188:191], v[148:151]
buffer_load_dwordx4 v5, s[8:11], s23 offen offset:3072 lds
M v[148:151], a[72:75], a[184:187], v[148:151]
M v[152:155], a[80:83], a[184:187], v[152:155]
M v[152:155], a[84:87], a[188:191], v[152:155]
ds_read_b64_tr_b16 a[124:125], v15 offset:49152
ds_read_b64_tr_b16 a[126:127], v15 offset:51200
M v[156:159], a[92:95], a[188:191], v[156:159]
M v[156:159], a[88:91], a[184:187], v[156:159]
s_waitcnt lgkmcnt(10)
M v[160:163], a[32:35], a[160:163], v[160:163]
M v[160:163], a[36:39], a[164:167], v[160:163]
ds_read_b128 a[176:179], v10 offset:20480
ds_read_b128 a[180:183], v11 offset:20480
M v[164:167], a[44:47], a[164:167], v[164:167]
s_add_u32 m0, s29, 98304
s_nop 0
buffer_load_dwordx4 v6, s[12:15], s24 offen offset:0 lds
M v[164:167], a[40:43], a[160:163], v[164:167]
ds_read_b64_tr_b16 a[132:133], v16 offset:49152
ds_read_b64_tr_b16 a[134:135], v16 offset:51200
M v[168:171], a[48:51], a[160:163], v[168:171]
M v[168:171], a[52:55], a[164:167], v[168:171]
M v[172:175], a[60:63], a[164:167], v[172:175]
M v[172:175], a[56:59], a[160:163], v[172:175]
M v[176:179], a[64:67], a[160:163], v[176:179]
buffer_load_dwordx4 v7, s[12:15], s24 offen offset:1024 lds
M v[176:179], a[68:71], a[164:167], v[176:179]
ds_read_b64_tr_b16 a[140:141], v17 offset:49152
ds_read_b64_tr_b16 a[142:143], v17 offset:51200
M v[180:183], a[76:79], a[164:167], v[180:183]
M v[180:183], a[72:75], a[160:163], v[180:183]
M v[184:187], a[80:83], a[160:163], v[184:187]
M v[184:187], a[84:87], a[164:167], v[184:187]
buffer_load_dwordx4 v8, s[12:15], s24 offen offset:2048 lds
M v[188:191], a[92:95], a[164:167], v[188:191]
M v[188:191], a[88:91], a[160:163], v[188:191]
s_waitcnt lgkmcnt(12)
ds_read_b64_tr_b16 a[148:149], v18 offset:49152
ds_read_b64_tr_b16 a[150:151], v18 offset:51200
M v[192:195], a[32:35], a[168:171], v[192:195]
M v[192:195], a[36:39], a[172:175], v[192:195]
ds_read_b128 a[184:187], v10 offset:22528
ds_read_b128 a[188:191], v11 offset:22528
M v[196:199], a[44:47], a[172:175], v[196:199]
M v[196:199], a[40:43], a[168:171], v[196:199]
M v[200:203], a[48:51], a[168:171], v[200:203]
buffer_load_dwordx4 v9, s[12:15], s24 offen offset:3072 lds
M v[200:203], a[52:55], a[172:175], v[200:203]
ds_read_b64_tr_b16 a[156:157], v19 offset:49152
ds_read_b64_tr_b16 a[158:159], v19 offset:51200
M v[204:207], a[60:63], a[172:175], v[204:207]
M v[204:207], a[56:59], a[168:171], v[204:207]
M v[208:211], a[64:67], a[168:171], v[208:211]
M v[208:211], a[68:71], a[172:175], v[208:211]
M v[212:215], a[76:79], a[172:175], v[212:215]
s_add_u32 s24, s24, 262144
M v[212:215], a[72:75], a[168:171], v[212:215]
M v[216:219], a[80:83], a[168:171], v[216:219]
M v[216:219], a[84:87], a[172:175], v[216:219]
M v[220:223], a[92:95], a[172:175], v[220:223]
M v[220:223], a[88:91], a[168:171], v[220:223]
s_waitcnt lgkmcnt(10)
M v[224:227], a[32:35], a[176:179], v[224:227]
buffer_load_dword v21, v20, s[60:63], s54 offen
s_add_u32 s54, s54, 1048576
M v[224:227], a[36:39], a[180:183], v[224:227]
M v[228:231], a[44:47], a[180:183], v[228:231]
M v[228:231], a[40:43], a[176:179], v[228:231]
M v[232:235], a[48:51], a[176:179], v[232:235]
M v[232:235], a[52:55], a[180:183], v[232:235]
M v[236:239], a[60:63], a[180:183], v[236:239]
M v[236:239], a[56:59], a[176:179], v[236:239]
s_waitcnt vmcnt(18) lgkmcnt(0)
s_barrier
ds_read_b128 a[160:163], v10 offset:32768
ds_read_b128 a[164:167], v11 offset:32768
M v[240:243], a[64:67], a[176:179], v[240:243]
s_add_u32 m0, s29, 16384
s_add_u32 s3, s23, s31
buffer_load_dwordx4 v2, s[8:11], s3 offen offset:0 lds
M v[240:243], a[68:71], a[180:183], v[240:243]
M v[244:247], a[76:79], a[180:183], v[244:247]
M v[244:247], a[72:75], a[176:179], v[244:247]
M v[248:251], a[80:83], a[176:179], v[248:251]
M v[248:251], a[84:87], a[180:183], v[248:251]
buffer_load_dwordx4 v3, s[8:11], s3 offen offset:1024 lds
M v[252:255], a[92:95], a[180:183], v[252:255]
M v[252:255], a[88:91], a[176:179], v[252:255]
M a[0:3], a[32:35], a[184:187], a[0:3]
M a[0:3], a[36:39], a[188:191], a[0:3]
ds_read_b128 a[168:171], v10 offset:34816
ds_read_b128 a[172:175], v11 offset:34816
M a[4:7], a[44:47], a[188:191], a[4:7]
M a[4:7], a[40:43], a[184:187], a[4:7]
M a[8:11], a[48:51], a[184:187], a[8:11]
buffer_load_dwordx4 v4, s[8:11], s3 offen offset:2048 lds
M a[8:11], a[52:55], a[188:191], a[8:11]
M a[12:15], a[60:63], a[188:191], a[12:15]
M a[12:15], a[56:59], a[184:187], a[12:15]
M a[16:19], a[64:67], a[184:187], a[16:19]
M a[16:19], a[68:71], a[188:191], a[16:19]
buffer_load_dwordx4 v5, s[8:11], s3 offen offset:3072 lds
M a[20:23], a[76:79], a[188:191], a[20:23]
M a[20:23], a[72:75], a[184:187], a[20:23]
M a[24:27], a[80:83], a[184:187], a[24:27]
M a[24:27], a[84:87], a[188:191], a[24:27]
M a[28:31], a[92:95], a[188:191], a[28:31]
M a[28:31], a[88:91], a[184:187], a[28:31]
s_waitcnt lgkmcnt(2)
M v[32:35], a[96:99], a[160:163], v[32:35]
s_add_u32 s23, s23, 128
s_cmp_eq_u32 s23, s25
s_cselect_b32 s23, s26, s23
M v[32:35], a[100:103], a[164:167], v[32:35]
ds_read_b128 a[176:179], v10 offset:36864
ds_read_b128 a[180:183], v11 offset:36864
M v[36:39], a[108:111], a[164:167], v[36:39]
M v[36:39], a[104:107], a[160:163], v[36:39]
ds_read_b64_tr_b16 a[32:33], v12 offset:0
ds_read_b64_tr_b16 a[34:35], v12 offset:2048
M v[40:43], a[112:115], a[160:163], v[40:43]
M v[40:43], a[116:119], a[164:167], v[40:43]
M v[44:47], a[124:127], a[164:167], v[44:47]
s_add_u32 m0, s29, 114688
s_nop 0
buffer_load_dwordx4 v6, s[12:15], s24 offen offset:0 lds
M v[44:47], a[120:123], a[160:163], v[44:47]
ds_read_b64_tr_b16 a[40:41], v13 offset:0
ds_read_b64_tr_b16 a[42:43], v13 offset:2048
M v[48:51], a[128:131], a[160:163], v[48:51]
M v[48:51], a[132:135], a[164:167], v[48:51]
M v[52:55], a[140:143], a[164:167], v[52:55]
M v[52:55], a[136:139], a[160:163], v[52:55]
ds_read_b64_tr_b16 a[48:49], v14 offset:0
ds_read_b64_tr_b16 a[50:51], v14 offset:2048
M v[56:59], a[144:147], a[160:163], v[56:59]
M v[56:59], a[148:151], a[164:167], v[56:59]
buffer_load_dwordx4 v7, s[12:15], s24 offen offset:1024 lds
M v[60:63], a[156:159], a[164:167], v[60:63]
M v[60:63], a[152:155], a[160:163], v[60:63]
s_waitcnt lgkmcnt(8)
ds_read_b64_tr_b16 a[56:57], v15 offset:0
ds_read_b64_tr_b16 a[58:59], v15 offset:2048
M v[64:67], a[96:99], a[168:171], v[64:67]
M v[64:67], a[100:103], a[172:175], v[64:67]
ds_read_b128 a[184:187], v10 offset:38912
ds_read_b128 a[188:191], v11 offset:38912
M v[68:71], a[108:111], a[172:175], v[68:71]
M v[68:71], a[104:107], a[168:171], v[68:71]
ds_read_b64_tr_b16 a[64:65], v16 offset:0
ds_read_b64_tr_b16 a[66:67], v16 offset:2048
M v[72:75], a[112:115], a[168:171], v[72:75]
buffer_load_dwordx4 v8, s[12:15], s24 offen offset:2048 lds
M v[72:75], a[116:119], a[172:175], v[72:75]
M v[76:79], a[124:127], a[172:175], v[76:79]
M v[76:79], a[120:123], a[168:171], v[76:79]
ds_read_b64_tr_b16 a[72:73], v17 offset:0
ds_read_b64_tr_b16 a[74:75], v17 offset:2048
M v[80:83], a[128:131], a[168:171], v[80:83]
M v[80:83], a[132:135], a[172:175], v[80:83]
M v[84:87], a[140:143], a[172:175], v[84:87]
buffer_load_dwordx4 v9, s[12:15], s24 offen offset:3072 lds
M v[84:87], a[136:139], a[168:171], v[84:87]
ds_read_b64_tr_b16 a[80:81], v18 offset:0
ds_read_b64_tr_b16 a[82:83], v18 offset:2048
M v[88:91], a[144:147], a[168:171], v[88:91]
M v[88:91], a[148:151], a[172:175], v[88:91]
M v[92:95], a[156:159], a[172:175], v[92:95]
M v[92:95], a[152:155], a[168:171], v[92:95]
s_waitcnt lgkmcnt(15)
ds_read_b64_tr_b16 a[88:89], v19 offset:0
ds_read_b64_tr_b16 a[90:91], v19 offset:2048
M v[96:99], a[96:99], a[176:179], v[96:99]
s_add_u32 s24, s24, 262144
s_cmp_eq_u32 s24, s27
s_cselect_b32 s24, s28, s24
s_sub_u32 s6, s6, 1
s_cmp_eq_u32 s6, 0
s_cselect_b64 s[12:13], s[64:65], s[12:13]
M v[96:99], a[100:103], a[180:183], v[96:99]
M v[100:103], a[108:111], a[180:183], v[100:103]
M v[100:103], a[104:107], a[176:179], v[100:103]
M v[104:107], a[112:115], a[176:179], v[104:107]
M v[104:107], a[116:119], a[180:183], v[104:107]
M v[108:111], a[124:127], a[180:183], v[108:111]
M v[108:111], a[120:123], a[176:179], v[108:111]
s_waitcnt vmcnt(17) lgkmcnt(0)
s_barrier
ds_read_b128 a[160:163], v10 offset:49152
ds_read_b128 a[164:167], v11 offset:49152
M v[112:115], a[128:131], a[176:179], v[112:115]
s_add_u32 m0, s29, 32768
s_nop 0
buffer_load_dwordx4 v2, s[8:11], s23 offen offset:0 lds
M v[112:115], a[132:135], a[180:183], v[112:115]
M v[116:119], a[140:143], a[180:183], v[116:119]
M v[116:119], a[136:139], a[176:179], v[116:119]
ds_read_b64_tr_b16 a[36:37], v12 offset:16384
ds_read_b64_tr_b16 a[38:39], v12 offset:18432
M v[120:123], a[144:147], a[176:179], v[120:123]
M v[120:123], a[148:151], a[180:183], v[120:123]
buffer_load_dwordx4 v3, s[8:11], s23 offen offset:1024 lds
M v[124:127], a[156:159], a[180:183], v[124:127]
M v[124:127], a[152:155], a[176:179], v[124:127]
M v[128:131], a[96:99], a[184:187], v[128:131]
M v[128:131], a[100:103], a[188:191], v[128:131]
ds_read_b128 a[168:171], v10 offset:51200
ds_read_b128 a[172:175], v11 offset:51200
ds_read_b64_tr_b16 a[44:45], v13 offset:16384
ds_read_b64_tr_b16 a[46:47], v13 offset:18432
M v[132:135], a[108:111], a[188:191], v[132:135]
M v[132:135], a[104:107], a[184:187], v[132:135]
M v[136:139], a[112:115], a[184:187], v[136:139]
buffer_load_dwordx4 v4, s[8:11], s23 offen offset:2048 lds
M v[136:139], a[116:119], a[188:191], v[136:139]
M v[140:143], a[124:127], a[188:191], v[140:143]
M v[140:143], a[120:123], a[184:187], v[140:143]
ds_read_b64_tr_b16 a[52:53], v14 offset:16384
ds_read_b64_tr_b16 a[54:55], v14 offset:18432
M v[144:147], a[128:131], a[184:187], v[144:147]
M v[144:147], a[132:135], a[188:191], v[144:147]
M v[148:151], a[140:143], a[188:191], v[148:151]
buffer_load_dwordx4 v5, s[8:11], s23 offen offset:3072 lds
M v[148:151], a[136:139], a[184:187], v[148:151]
M v[152:155], a[144:147], a[184:187], v[152:155]
M v[152:155], a[148:151], a[188:191], v[152:155]
ds_read_b64_tr_b16 a[60:61], v15 offset:16384
ds_read_b64_tr_b16 a[62:63], v15 offset:18432
M v[156:159], a[156:159], a[188:191], v[156:159]
M v[156:159], a[152:155], a[184:187], v[156:159]
s_waitcnt lgkmcnt(10)
M v[160:163], a[96:99], a[160:163], v[160:163]
M v[160:163], a[100:103], a[164:167], v[160:163]
ds_read_b128 a[176:179], v10 offset:53248
ds_read_b128 a[180:183], v11 offset:53248
M v[164:167], a[108:111], a[164:167], v[164:167]
s_add_u32 m0, s29, 65536
s_nop 0
buffer_load_dwordx4 v6, s[12:15], s24 offen offset:0 lds
M v[164:167], a[104:107], a[160:163], v[164:167]
ds_read_b64_tr_b16 a[68:69], v16 offset:16384
ds_read_b64_tr_b16 a[70:71], v16 offset:18432
M v[168:171], a[112:115], a[160:163], v[168:171]
M v[168:171], a[116:119], a[164:167], v[168:171]
M v[172:175], a[124:127], a[164:167], v[172:175]
M v[172:175], a[120:123], a[160:163], v[172:175]
M v[176:179], a[128:131], a[160:163], v[176:179]
buffer_load_dwordx4 v7, s[12:15], s24 offen offset:1024 lds
M v[176:179], a[132:135], a[164:167], v[176:179]
ds_read_b64_tr_b16 a[76:77], v17 offset:16384
ds_read_b64_tr_b16 a[78:79], v17 offset:18432
M v[180:183], a[140:143], a[164:167], v[180:183]
M v[180:183], a[136:139], a[160:163], v[180:183]
M v[184:187], a[144:147], a[160:163], v[184:187]
M v[184:187], a[148:151], a[164:167], v[184:187]
buffer_load_dwordx4 v8, s[12:15], s24 offen offset:2048 lds
M v[188:191], a[156:159], a[164:167], v[188:191]
M v[188:191], a[152:155], a[160:163], v[188:191]
s_waitcnt lgkmcnt(12)
ds_read_b64_tr_b16 a[84:85], v18 offset:16384
ds_read_b64_tr_b16 a[86:87], v18 offset:18432
M v[192:195], a[96:99], a[168:171], v[192:195]
M v[192:195], a[100:103], a[172:175], v[192:195]
ds_read_b128 a[184:187], v10 offset:55296
ds_read_b128 a[188:191], v11 offset:55296
M v[196:199], a[108:111], a[172:175], v[196:199]
M v[196:199], a[104:107], a[168:171], v[196:199]
M v[200:203], a[112:115], a[168:171], v[200:203]
buffer_load_dwordx4 v9, s[12:15], s24 offen offset:3072 lds
M v[200:203], a[116:119], a[172:175], v[200:203]
ds_read_b64_tr_b16 a[92:93], v19 offset:16384
ds_read_b64_tr_b16 a[94:95], v19 offset:18432
M v[204:207], a[124:127], a[172:175], v[204:207]
M v[204:207], a[120:123], a[168:171], v[204:207]
M v[208:211], a[128:131], a[168:171], v[208:211]
M v[208:211], a[132:135], a[172:175], v[208:211]
M v[212:215], a[140:143], a[172:175], v[212:215]
s_add_u32 s24, s24, 262144
M v[212:215], a[136:139], a[168:171], v[212:215]
M v[216:219], a[144:147], a[168:171], v[216:219]
M v[216:219], a[148:151], a[172:175], v[216:219]
M v[220:223], a[156:159], a[172:175], v[220:223]
M v[220:223], a[152:155], a[168:171], v[220:223]
s_waitcnt lgkmcnt(10)
M v[224:227], a[96:99], a[176:179], v[224:227]
buffer_load_dword v21, v20, s[60:63], s54 offen
s_add_u32 s54, s54, 1048576
M v[224:227], a[100:103], a[180:183], v[224:227]
M v[228:231], a[108:111], a[180:183], v[228:231]
M v[228:231], a[104:107], a[176:179], v[228:231]
M v[232:235], a[112:115], a[176:179], v[232:235]
M v[232:235], a[116:119], a[180:183], v[232:235]
M v[236:239], a[124:127], a[180:183], v[236:239]
M v[236:239], a[120:123], a[176:179], v[236:239]
s_waitcnt vmcnt(18) lgkmcnt(0)
s_barrier
ds_read_b128 a[160:163], v10 offset:0
ds_read_b128 a[164:167], v11 offset:0
M v[240:243], a[128:131], a[176:179], v[240:243]
s_add_u32 m0, s29, 49152
s_add_u32 s3, s23, s31
buffer_load_dwordx4 v2, s[8:11], s3 offen offset:0 lds
M v[240:243], a[132:135], a[180:183], v[240:243]
M v[244:247], a[140:143], a[180:183], v[244:247]
M v[244:247], a[136:139], a[176:179], v[244:247]
M v[248:251], a[144:147], a[176:179], v[248:251]
M v[248:251], a[148:151], a[180:183], v[248:251]
buffer_load_dwordx4 v3, s[8:11], s3 offen offset:1024 lds
M v[252:255], a[156:159], a[180:183], v[252:255]
M v[252:255], a[152:155], a[176:179], v[252:255]
M a[0:3], a[96:99], a[184:187], a[0:3]
M a[0:3], a[100:103], a[188:191], a[0:3]
ds_read_b128 a[168:171], v10 offset:2048
ds_read_b128 a[172:175], v11 offset:2048
M a[4:7], a[108:111], a[188:191], a[4:7]
M a[4:7], a[104:107], a[184:187], a[4:7]
M a[8:11], a[112:115], a[184:187], a[8:11]
buffer_load_dwordx4 v4, s[8:11], s3 offen offset:2048 lds
M a[8:11], a[116:119], a[188:191], a[8:11]
M a[12:15], a[124:127], a[188:191], a[12:15]
M a[12:15], a[120:123], a[184:187], a[12:15]
M a[16:19], a[128:131], a[184:187], a[16:19]
M a[16:19], a[132:135], a[188:191], a[16:19]
buffer_load_dwordx4 v5, s[8:11], s3 offen offset:3072 lds
M a[20:23], a[140:143], a[188:191], a[20:23]
M a[20:23], a[136:139], a[184:187], a[20:23]
M a[24:27], a[144:147], a[184:187], a[24:27]
M a[24:27], a[148:151], a[188:191], a[24:27]
M a[28:31], a[156:159], a[188:191], a[28:31]
M a[28:31], a[152:155], a[184:187], a[28:31]
s_waitcnt lgkmcnt(2)
s_sub_u32 s30, s30, 1
s_cmp_lg_u32 s30, 0
s_cbranch_scc1 Lk1_ql
M v[32:35], a[32:35], a[160:163], v[32:35]
s_add_u32 s23, s23, 128
s_cmp_eq_u32 s23, s25
s_cselect_b32 s23, s26, s23
M v[32:35], a[36:39], a[164:167], v[32:35]
ds_read_b128 a[176:179], v10 offset:4096
ds_read_b128 a[180:183], v11 offset:4096
M v[36:39], a[44:47], a[164:167], v[36:39]
M v[36:39], a[40:43], a[160:163], v[36:39]
ds_read_b64_tr_b16 a[96:97], v12 offset:32768
ds_read_b64_tr_b16 a[98:99], v12 offset:34816
M v[40:43], a[48:51], a[160:163], v[40:43]
M v[40:43], a[52:55], a[164:167], v[40:43]
M v[44:47], a[60:63], a[164:167], v[44:47]
s_add_u32 m0, s29, 81920
s_nop 0
buffer_load_dwordx4 v6, s[12:15], s24 offen offset:0 lds
M v[44:47], a[56:59], a[160:163], v[44:47]
ds_read_b64_tr_b16 a[104:105], v13 offset:32768
ds_read_b64_tr_b16 a[106:107], v13 offset:34816
M v[48:51], a[64:67], a[160:163], v[48:51]
M v[48:51], a[68:71], a[164:167], v[48:51]
M v[52:55], a[76:79], a[164:167], v[52:55]
M v[52:55], a[72:75], a[160:163], v[52:55]
ds_read_b64_tr_b16 a[112:113], v14 offset:32768
ds_read_b64_tr_b16 a[114:115], v14 offset:34816
M v[56:59], a[80:83], a[160:163], v[56:59]
M v[56:59], a[84:87], a[164:167], v[56:59]
buffer_load_dwordx4 v7, s[12:15], s24 offen offset:1024 lds
M v[60:63], a[92:95], a[164:167], v[60:63]
M v[60:63], a[88:91], a[160:163], v[60:63]
s_waitcnt lgkmcnt(8)
ds_read_b64_tr_b16 a[120:121], v15 offset:32768
ds_read_b64_tr_b16 a[122:123], v15 offset:34816
M v[64:67], a[32:35], a[168:171], v[64:67]
M v[64:67], a[36:39], a[172:175], v[64:67]
ds_read_b128 a[184:187], v10 offset:6144
ds_read_b128 a[188:191], v11 offset:6144
M v[68:71], a[44:47], a[172:175], v[68:71]
M v[68:71], a[40:43], a[168:171], v[68:71]
ds_read_b64_tr_b16 a[128:129], v16 offset:32768
ds_read_b64_tr_b16 a[130:131], v16 offset:34816
M v[72:75], a[48:51], a[168:171], v[72:75]
buffer_load_dwordx4 v8, s[12:15], s24 offen offset:2048 lds
M v[72:75], a[52:55], a[172:175], v[72:75]
M v[76:79], a[60:63], a[172:175], v[76:79]
M v[76:79], a[56:59], a[168:171], v[76:79]
ds_read_b64_tr_b16 a[136:137], v17 offset:32768
ds_read_b64_tr_b16 a[138:139], v17 offset:34816
M v[80:83], a[64:67], a[168:171], v[80:83]
M v[80:83], a[68:71], a[172:175], v[80:83]
M v[84:87], a[76:79], a[172:175], v[84:87]
buffer_load_dwordx4 v9, s[12:15], s24 offen offset:3072 lds
M v[84:87], a[72:75], a[168:171], v[84:87]
ds_read_b64_tr_b16 a[144:145], v18 offset:32768
ds_read_b64_tr_b16 a[146:147], v18 offset:34816
M v[88:91], a[80:83], a[168:171], v[88:91]
M v[88:91], a[84:87], a[172:175], v[88:91]
M v[92:95], a[92:95], a[172:175], v[92:95]
M v[92:95], a[88:91], a[168:171], v[92:95]
s_waitcnt lgkmcnt(15)
ds_read_b64_tr_b16 a[152:153], v19 offset:32768
ds_read_b64_tr_b16 a[154:155], v19 offset:34816
M v[96:99], a[32:35], a[176:179], v[96:99]
s_add_u32 s24, s24, 262144
s_cmp_eq_u32 s24, s27
s_cselect_b32 s24, s28, s24
s_sub_u32 s6, s6, 1
s_cmp_eq_u32 s6, 0
s_cselect_b64 s[12:13], s[64:65], s[12:13]
M v[96:99], a[36:39], a[180:183], v[96:99]
M v[100:103], a[44:47], a[180:183], v[100:103]
M v[100:103], a[40:43], a[176:179], v[100:103]
M v[104:107], a[48:51], a[176:179], v[104:107]
M v[104:107], a[52:55], a[180:183], v[104:107]
M v[108:111], a[60:63], a[180:183], v[108:111]
M v[108:111], a[56:59], a[176:179], v[108:111]
s_waitcnt vmcnt(17) lgkmcnt(0)
s_barrier
ds_read_b128 a[160:163], v10 offset:16384
ds_read_b128 a[164:167], v11 offset:16384
M v[112:115], a[64:67], a[176:179], v[112:115]
s_add_u32 m0, s29, 0
s_nop 0
buffer_load_dwordx4 v2, s[8:11], s23 offen offset:0 lds
M v[112:115], a[68:71], a[180:183], v[112:115]
M v[116:119], a[76:79], a[180:183], v[116:119]
M v[116:119], a[72:75], a[176:179], v[116:119]
ds_read_b64_tr_b16 a[100:101], v12 offset:49152
ds_read_b64_tr_b16 a[102:103], v12 offset:51200
M v[120:123], a[80:83], a[176:179], v[120:123]
M v[120:123], a[84:87], a[180:183], v[120:123]
M v[124:127], a[92:95], a[180:183], v[124:127]
buffer_load_dwordx4 v3, s[8:11], s23 offen offset:1024 lds
M v[124:127], a[88:91], a[176:179], v[124:127]
M v[128:131], a[32:35], a[184:187], v[128:131]
M v[128:131], a[36:39], a[188:191], v[128:131]
ds_read_b128 a[168:171], v10 offset:18432
ds_read_b128 a[172:175], v11 offset:18432
ds_read_b64_tr_b16 a[108:109], v13 offset:49152
ds_read_b64_tr_b16 a[110:111], v13 offset:51200
M v[132:135], a[44:47], a[188:191], v[132:135]
M v[132:135], a[40:43], a[184:187], v[132:135]
M v[136:139], a[48:51], a[184:187], v[136:139]
M v[136:139], a[52:55], a[188:191], v[136:139]
buffer_load_dwordx4 v4, s[8:11], s23 offen offset:2048 lds
M v[140:143], a[60:63], a[188:191], v[140:143]
M v[140:143], a[56:59], a[184:187], v[140:143]
ds_read_b64_tr_b16 a[116:117], v14 offset:49152
ds_read_b64_tr_b16 a[118:119], v14 offset:51200
M v[144:147], a[64:67], a[184:187], v[144:147]
M v[144:147], a[68:71], a[188:191], v[144:147]
M v[148:151], a[76:79], a[188:191], v[148:151]
M v[148:151], a[72:75], a[184:187], v[148:151]
M v[152:155], a[80:83], a[184:187], v[152:155]
buffer_load_dwordx4 v5, s[8:11], s23 offen offset:3072 lds
M v[152:155], a[84:87], a[188:191], v[152:155]
ds_read_b64_tr_b16 a[124:125], v15 offset:49152
ds_read_b64_tr_b16 a[126:127], v15 offset:51200
M v[156:159], a[92:95], a[188:191], v[156:159]
M v[156:159], a[88:91], a[184:187], v[156:159]
s_waitcnt lgkmcnt(10)
M v[160:163], a[32:35], a[160:163], v[160:163]
M v[160:163], a[36:39], a[164:167], v[160:163]
ds_read_b128 a[176:179], v10 offset:20480
ds_read_b128 a[180:183], v11 offset:20480
M v[164:167], a[44:47], a[164:167], v[164:167]
M v[164:167], a[40:43], a[160:163], v[164:167]
ds_read_b64_tr_b16 a[132:133], v16 offset:49152
ds_read_b64_tr_b16 a[134:135], v16 offset:51200
M v[168:171], a[48:51], a[160:163], v[168:171]
M v[168:171], a[52:55], a[164:167], v[168:171]
s_add_u32 m0, s29, 98304
s_nop 0
buffer_load_dwordx4 v6, s[12:15], s24 offen offset:0 lds
M v[172:175], a[60:63], a[164:167], v[172:175]
M v[172:175], a[56:59], a[160:163], v[172:175]
M v[176:179], a[64:67], a[160:163], v[176:179]
M v[176:179], a[68:71], a[164:167], v[176:179]
ds_read_b64_tr_b16 a[140:141], v17 offset:49152
ds_read_b64_tr_b16 a[142:143], v17 offset:51200
M v[180:183], a[76:79], a[164:167], v[180:183]
M v[180:183], a[72:75], a[160:163], v[180:183]
buffer_load_dwordx4 v7, s[12:15], s24 offen offset:1024 lds
M v[184:187], a[80:83], a[160:163], v[184:187]
M v[184:187], a[84:87], a[164:167], v[184:187]
M v[188:191], a[92:95], a[164:167], v[188:191]
M v[188:191], a[88:91], a[160:163], v[188:191]
s_waitcnt lgkmcnt(12)
ds_read_b64_tr_b16 a[148:149], v18 offset:49152
ds_read_b64_tr_b16 a[150:151], v18 offset:51200
M v[192:195], a[32:35], a[168:171], v[192:195]
M v[192:195], a[36:39], a[172:175], v[192:195]
ds_read_b128 a[184:187], v10 offset:22528
ds_read_b128 a[188:191], v11 offset:22528
M v[196:199], a[44:47], a[172:175], v[196:199]
M v[196:199], a[40:43], a[168:171], v[196:199]
buffer_load_dwordx4 v8, s[12:15], s24 offen offset:2048 lds
M v[200:203], a[48:51], a[168:171], v[200:203]
M v[200:203], a[52:55], a[172:175], v[200:203]
ds_read_b64_tr_b16 a[156:157], v19 offset:49152
ds_read_b64_tr_b16 a[158:159], v19 offset:51200
M v[204:207], a[60:63], a[172:175], v[204:207]
M v[204:207], a[56:59], a[168:171], v[204:207]
M v[208:211], a[64:67], a[168:171], v[208:211]
M v[208:211], a[68:71], a[172:175], v[208:211]
buffer_load_dwordx4 v9, s[12:15], s24 offen offset:3072 lds
M v[212:215], a[76:79], a[172:175], v[212:215]
M v[212:215], a[72:75], a[168:171], v[212:215]
M v[216:219], a[80:83], a[168:171], v[216:219]
M v[216:219], a[84:87], a[172:175], v[216:219]
M v[220:223], a[92:95], a[172:175], v[220:223]
s_add_u32 s24, s24, 262144
M v[220:223], a[88:91], a[168:171], v[220:223]
s_waitcnt lgkmcnt(10)
M v[224:227], a[32:35], a[176:179], v[224:227]
M v[224:227], a[36:39], a[180:183], v[224:227]
M v[228:231], a[44:47], a[180:183], v[228:231]
M v[228:231], a[40:43], a[176:179], v[228:231]
M v[232:235], a[48:51], a[176:179], v[232:235]
M v[232:235], a[52:55], a[180:183], v[232:235]
M v[236:239], a[60:63], a[180:183], v[236:239]
M v[236:239], a[56:59], a[176:179], v[236:239]
s_waitcnt vmcnt(17) lgkmcnt(0)
s_barrier
ds_read_b128 a[160:163], v10 offset:32768
ds_read_b128 a[164:167], v11 offset:32768
M v[240:243], a[64:67], a[176:179], v[240:243]
s_add_u32 m0, s29, 16384
s_add_u32 s3, s23, s31
buffer_load_dwordx4 v2, s[8:11], s3 offen offset:0 lds
M v[240:243], a[68:71], a[180:183], v[240:243]
M v[244:247], a[76:79], a[180:183], v[244:247]
M v[244:247], a[72:75], a[176:179], v[244:247]
M v[248:251], a[80:83], a[176:179], v[248:251]
M v[248:251], a[84:87], a[180:183], v[248:251]
buffer_load_dwordx4 v3, s[8:11], s3 offen offset:1024 lds
M v[252:255], a[92:95], a[180:183], v[252:255]
M v[252:255], a[88:91], a[176:179], v[252:255]
M a[0:3], a[32:35], a[184:187], a[0:3]
M a[0:3], a[36:39], a[188:191], a[0:3]
ds_read_b128 a[168:171], v10 offset:34816
ds_read_b128 a[172:175], v11 offset:34816
M a[4:7], a[44:47], a[188:191], a[4:7]
M a[4:7], a[40:43], a[184:187], a[4:7]
M a[8:11], a[48:51], a[184:187], a[8:11]
buffer_load_dwordx4 v4, s[8:11], s3 offen offset:2048 lds
M a[8:11], a[52:55], a[188:191], a[8:11]
M a[12:15], a[60:63], a[188:191], a[12:15]
M a[12:15], a[56:59], a[184:187], a[12:15]
M a[16:19], a[64:67], a[184:187], a[16:19]
M a[16:19], a[68:71], a[188:191], a[16:19]
buffer_load_dwordx4 v5, s[8:11], s3 offen offset:3072 lds
M a[20:23], a[76:79], a[188:191], a[20:23]
M a[20:23], a[72:75], a[184:187], a[20:23]
M a[24:27], a[80:83], a[184:187], a[24:27]
M a[24:27], a[84:87], a[188:191], a[24:27]
M a[28:31], a[92:95], a[188:191], a[28:31]
M a[28:31], a[88:91], a[184:187], a[28:31]
s_waitcnt lgkmcnt(2)
M v[32:35], a[96:99], a[160:163], v[32:35]
s_add_u32 s23, s23, 128
s_cmp_eq_u32 s23, s25
s_cselect_b32 s23, s26, s23
M v[32:35], a[100:103], a[164:167], v[32:35]
ds_read_b128 a[176:179], v10 offset:36864
ds_read_b128 a[180:183], v11 offset:36864
M v[36:39], a[108:111], a[164:167], v[36:39]
M v[36:39], a[104:107], a[160:163], v[36:39]
ds_read_b64_tr_b16 a[32:33], v12 offset:0
ds_read_b64_tr_b16 a[34:35], v12 offset:2048
M v[40:43], a[112:115], a[160:163], v[40:43]
M v[40:43], a[116:119], a[164:167], v[40:43]
M v[44:47], a[124:127], a[164:167], v[44:47]
s_add_u32 m0, s29, 114688
s_nop 0
buffer_load_dwordx4 v6, s[12:15], s24 offen offset:0 lds
M v[44:47], a[120:123], a[160:163], v[44:47]
ds_read_b64_tr_b16 a[40:41], v13 offset:0
ds_read_b64_tr_b16 a[42:43], v13 offset:2048
M v[48:51], a[128:131], a[160:163], v[48:51]
M v[48:51], a[132:135], a[164:167], v[48:51]
M v[52:55], a[140:143], a[164:167], v[52:55]
M v[52:55], a[136:139], a[160:163], v[52:55]
ds_read_b64_tr_b16 a[48:49], v14 offset:0
ds_read_b64_tr_b16 a[50:51], v14 offset:2048
M v[56:59], a[144:147], a[160:163], v[56:59]
M v[56:59], a[148:151], a[164:167], v[56:59]
buffer_load_dwordx4 v7, s[12:15], s24 offen offset:1024 lds
M v[60:63], a[156:159], a[164:167], v[60:63]
M v[60:63], a[152:155], a[160:163], v[60:63]
s_waitcnt lgkmcnt(8)
ds_read_b64_tr_b16 a[56:57], v15 offset:0
ds_read_b64_tr_b16 a[58:59], v15 offset:2048
M v[64:67], a[96:99], a[168:171], v[64:67]
M v[64:67], a[100:103], a[172:175], v[64:67]
ds_read_b128 a[184:187], v10 offset:38912
ds_read_b128 a[188:191], v11 offset:38912
M v[68:71], a[108:111], a[172:175], v[68:71]
M v[68:71], a[104:107], a[168:171], v[68:71]
ds_read_b64_tr_b16 a[64:65], v16 offset:0
ds_read_b64_tr_b16 a[66:67], v16 offset:2048
M v[72:75], a[112:115], a[168:171], v[72:75]
buffer_load_dwordx4 v8, s[12:15], s24 offen offset:2048 lds
M v[72:75], a[116:119], a[172:175], v[72:75]
M v[76:79], a[124:127], a[172:175], v[76:79]
M v[76:79], a[120:123], a[168:171], v[76:79]
ds_read_b64_tr_b16 a[72:73], v17 offset:0
ds_read_b64_tr_b16 a[74:75], v17 offset:2048
M v[80:83], a[128:131], a[168:171], v[80:83]
M v[80:83], a[132:135], a[172:175], v[80:83]
M v[84:87], a[140:143], a[172:175], v[84:87]
buffer_load_dwordx4 v9, s[12:15], s24 offen offset:3072 lds
M v[84:87], a[136:139], a[168:171], v[84:87]
ds_read_b64_tr_b16 a[80:81], v18 offset:0
ds_read_b64_tr_b16 a[82:83], v18 offset:2048
M v[88:91], a[144:147], a[168:171], v[88:91]
M v[88:91], a[148:151], a[172:175], v[88:91]
M v[92:95], a[156:159], a[172:175], v[92:95]
M v[92:95], a[152:155], a[168:171], v[92:95]
s_waitcnt lgkmcnt(15)
ds_read_b64_tr_b16 a[88:89], v19 offset:0
ds_read_b64_tr_b16 a[90:91], v19 offset:2048
M v[96:99], a[96:99], a[176:179], v[96:99]
s_add_u32 s24, s24, 262144
s_cmp_eq_u32 s24, s27
s_cselect_b32 s24, s28, s24
s_sub_u32 s6, s6, 1
s_cmp_eq_u32 s6, 0
s_cselect_b64 s[12:13], s[64:65], s[12:13]
M v[96:99], a[100:103], a[180:183], v[96:99]
M v[100:103], a[108:111], a[180:183], v[100:103]
M v[100:103], a[104:107], a[176:179], v[100:103]
M v[104:107], a[112:115], a[176:179], v[104:107]
M v[104:107], a[116:119], a[180:183], v[104:107]
M v[108:111], a[124:127], a[180:183], v[108:111]
M v[108:111], a[120:123], a[176:179], v[108:111]
s_waitcnt vmcnt(16) lgkmcnt(0)
s_barrier
ds_read_b128 a[160:163], v10 offset:49152
ds_read_b128 a[164:167], v11 offset:49152
M v[112:115], a[128:131], a[176:179], v[112:115]
s_add_u32 m0, s29, 32768
s_nop 0
buffer_load_dwordx4 v2, s[8:11], s23 offen offset:0 lds
M v[112:115], a[132:135], a[180:183], v[112:115]
M v[116:119], a[140:143], a[180:183], v[116:119]
M v[116:119], a[136:139], a[176:179], v[116:119]
ds_read_b64_tr_b16 a[36:37], v12 offset:16384
ds_read_b64_tr_b16 a[38:39], v12 offset:18432
M v[120:123], a[144:147], a[176:179], v[120:123]
M v[120:123], a[148:151], a[180:183], v[120:123]
M v[124:127], a[156:159], a[180:183], v[124:127]
M v[124:127], a[152:155], a[176:179], v[124:127]
M v[128:131], a[96:99], a[184:187], v[128:131]
M v[128:131], a[100:103], a[188:191], v[128:131]
ds_read_b128 a[168:171], v10 offset:51200
ds_read_b128 a[172:175], v11 offset:51200
ds_read_b64_tr_b16 a[44:45], v13 offset:16384
ds_read_b64_tr_b16 a[46:47], v13 offset:18432
M v[132:135], a[108:111], a[188:191], v[132:135]
M v[132:135], a[104:107], a[184:187], v[132:135]
M v[136:139], a[112:115], a[184:187], v[136:139]
M v[136:139], a[116:119], a[188:191], v[136:139]
M v[140:143], a[124:127], a[188:191], v[140:143]
M v[140:143], a[120:123], a[184:187], v[140:143]
ds_read_b64_tr_b16 a[52:53], v14 offset:16384
ds_read_b64_tr_b16 a[54:55], v14 offset:18432
M v[144:147], a[128:131], a[184:187], v[144:147]
buffer_load_dwordx4 v3, s[8:11], s23 offen offset:1024 lds
M v[144:147], a[132:135], a[188:191], v[144:147]
M v[148:151], a[140:143], a[188:191], v[148:151]
M v[148:151], a[136:139], a[184:187], v[148:151]
M v[152:155], a[144:147], a[184:187], v[152:155]
M v[152:155], a[148:151], a[188:191], v[152:155]
ds_read_b64_tr_b16 a[60:61], v15 offset:16384
ds_read_b64_tr_b16 a[62:63], v15 offset:18432
M v[156:159], a[156:159], a[188:191], v[156:159]
M v[156:159], a[152:155], a[184:187], v[156:159]
s_waitcnt lgkmcnt(10)
M v[160:163], a[96:99], a[160:163], v[160:163]
M v[160:163], a[100:103], a[164:167], v[160:163]
ds_read_b128 a[176:179], v10 offset:53248
ds_read_b128 a[180:183], v11 offset:53248
M v[164:167], a[108:111], a[164:167], v[164:167]
M v[164:167], a[104:107], a[160:163], v[164:167]
ds_read_b64_tr_b16 a[68:69], v16 offset:16384
ds_read_b64_tr_b16 a[70:71], v16 offset:18432
M v[168:171], a[112:115], a[160:163], v[168:171]
M v[168:171], a[116:119], a[164:167], v[168:171]
M v[172:175], a[124:127], a[164:167], v[172:175]
M v[172:175], a[120:123], a[160:163], v[172:175]
M v[176:179], a[128:131], a[160:163], v[176:179]
buffer_load_dwordx4 v4, s[8:11], s23 offen offset:2048 lds
M v[176:179], a[132:135], a[164:167], v[176:179]
ds_read_b64_tr_b16 a[76:77], v17 offset:16384
ds_read_b64_tr_b16 a[78:79], v17 offset:18432
M v[180:183], a[140:143], a[164:167], v[180:183]
M v[180:183], a[136:139], a[160:163], v[180:183]
M v[184:187], a[144:147], a[160:163], v[184:187]
M v[184:187], a[148:151], a[164:167], v[184:187]
M v[188:191], a[156:159], a[164:167], v[188:191]
M v[188:191], a[152:155], a[160:163], v[188:191]
s_waitcnt lgkmcnt(12)
ds_read_b64_tr_b16 a[84:85], v18 offset:16384
ds_read_b64_tr_b16 a[86:87], v18 offset:18432
M v[192:195], a[96:99], a[168:171], v[192:195]
M v[192:195], a[100:103], a[172:175], v[192:195]
ds_read_b128 a[184:187], v10 offset:55296
ds_read_b128 a[188:191], v11 offset:55296
M v[196:199], a[108:111], a[172:175], v[196:199]
M v[196:199], a[104:107], a[168:171], v[196:199]
M v[200:203], a[112:115], a[168:171], v[200:203]
M v[200:203], a[116:119], a[172:175], v[200:203]
ds_read_b64_tr_b16 a[92:93], v19 offset:16384
ds_read_b64_tr_b16 a[94:95], v19 offset:18432
M v[204:207], a[124:127], a[172:175], v[204:207]
M v[204:207], a[120:123], a[168:171], v[204:207]
M v[208:211], a[128:131], a[168:171], v[208:211]
buffer_load_dwordx4 v5, s[8:11], s23 offen offset:3072 lds
M v[208:211], a[132:135], a[172:175], v[208:211]
M v[212:215], a[140:143], a[172:175], v[212:215]
M v[212:215], a[136:139], a[168:171], v[212:215]
M v[216:219], a[144:147], a[168:171], v[216:219]
M v[216:219], a[148:151], a[172:175], v[216:219]
M v[220:223], a[156:159], a[172:175], v[220:223]
M v[220:223], a[152:155], a[168:171], v[220:223]
s_waitcnt lgkmcnt(10)
M v[224:227], a[96:99], a[176:179], v[224:227]
M v[224:227], a[100:103], a[180:183], v[224:227]
M v[228:231], a[108:111], a[180:183], v[228:231]
M v[228:231], a[104:107], a[176:179], v[228:231]
M v[232:235], a[112:115], a[176:179], v[232:235]
M v[232:235], a[116:119], a[180:183], v[232:235]
M v[236:239], a[124:127], a[180:183], v[236:239]
M v[236:239], a[120:123], a[176:179], v[236:239]
s_waitcnt vmcnt(12) lgkmcnt(0)
s_barrier
ds_read_b128 a[160:163], v10 offset:0
ds_read_b128 a[164:167], v11 offset:0
M v[240:243], a[128:131], a[176:179], v[240:243]
s_add_u32 m0, s29, 49152
s_add_u32 s3, s23, s31
buffer_load_dwordx4 v2, s[8:11], s3 offen offset:0 lds
M v[240:243], a[132:135], a[180:183], v[240:243]
M v[244:247], a[140:143], a[180:183], v[244:247]
M v[244:247], a[136:139], a[176:179], v[244:247]
M v[248:251], a[144:147], a[176:179], v[248:251]
M v[248:251], a[148:151], a[180:183], v[248:251]
M v[252:255], a[156:159], a[180:183], v[252:255]
M v[252:255], a[152:155], a[176:179], v[252:255]
M a[0:3], a[96:99], a[184:187], a[0:3]
M a[0:3], a[100:103], a[188:191], a[0:3]
ds_read_b128 a[168:171], v10 offset:2048
ds_read_b128 a[172:175], v11 offset:2048
M a[4:7], a[108:111], a[188:191], a[4:7]
M a[4:7], a[104:107], a[184:187], a[4:7]
M a[8:11], a[112:115], a[184:187], a[8:11]
buffer_load_dwordx4 v3, s[8:11], s3 offen offset:1024 lds
M a[8:11], a[116:119], a[188:191], a[8:11]
M a[12:15], a[124:127], a[188:191], a[12:15]
M a[12:15], a[120:123], a[184:187], a[12:15]
M a[16:19], a[128:131], a[184:187], a[16:19]
M a[16:19], a[132:135], a[188:191], a[16:19]
M a[20:23], a[140:143], a[188:191], a[20:23]
M a[20:23], a[136:139], a[184:187], a[20:23]
M a[24:27], a[144:147], a[184:187], a[24:27]
M a[24:27], a[148:151], a[188:191], a[24:27]
M a[28:31], a[156:159], a[188:191], a[28:31]
M a[28:31], a[152:155], a[184:187], a[28:31]
s_waitcnt lgkmcnt(2)
M v[32:35], a[32:35], a[160:163], v[32:35]
buffer_load_dwordx4 v4, s[8:11], s3 offen offset:2048 lds
M v[32:35], a[36:39], a[164:167], v[32:35]
ds_read_b128 a[176:179], v10 offset:4096
ds_read_b128 a[180:183], v11 offset:4096
M v[36:39], a[44:47], a[164:167], v[36:39]
M v[36:39], a[40:43], a[160:163], v[36:39]
ds_read_b64_tr_b16 a[96:97], v12 offset:32768
ds_read_b64_tr_b16 a[98:99], v12 offset:34816
M v[40:43], a[48:51], a[160:163], v[40:43]
M v[40:43], a[52:55], a[164:167], v[40:43]
M v[44:47], a[60:63], a[164:167], v[44:47]
M v[44:47], a[56:59], a[160:163], v[44:47]
ds_read_b64_tr_b16 a[104:105], v13 offset:32768
ds_read_b64_tr_b16 a[106:107], v13 offset:34816
M v[48:51], a[64:67], a[160:163], v[48:51]
M v[48:51], a[68:71], a[164:167], v[48:51]
M v[52:55], a[76:79], a[164:167], v[52:55]
M v[52:55], a[72:75], a[160:163], v[52:55]
ds_read_b64_tr_b16 a[112:113], v14 offset:32768
ds_read_b64_tr_b16 a[114:115], v14 offset:34816
M v[56:59], a[80:83], a[160:163], v[56:59]
M v[56:59], a[84:87], a[164:167], v[56:59]
buffer_load_dwordx4 v5, s[8:11], s3 offen offset:3072 lds
M v[60:63], a[92:95], a[164:167], v[60:63]
M v[60:63], a[88:91], a[160:163], v[60:63]
s_waitcnt lgkmcnt(8)
ds_read_b64_tr_b16 a[120:121], v15 offset:32768
ds_read_b64_tr_b16 a[122:123], v15 offset:34816
M v[64:67], a[32:35], a[168:171], v[64:67]
M v[64:67], a[36:39], a[172:175], v[64:67]
ds_read_b128 a[184:187], v10 offset:6144
ds_read_b128 a[188:191], v11 offset:6144
M v[68:71], a[44:47], a[172:175], v[68:71]
M v[68:71], a[40:43], a[168:171], v[68:71]
ds_read_b64_tr_b16 a[128:129], v16 offset:32768
ds_read_b64_tr_b16 a[130:131], v16 offset:34816
M v[72:75], a[48:51], a[168:171], v[72:75]
M v[72:75], a[52:55], a[172:175], v[72:75]
M v[76:79], a[60:63], a[172:175], v[76:79]
M v[76:79], a[56:59], a[168:171], v[76:79]
ds_read_b64_tr_b16 a[136:137], v17 offset:32768
ds_read_b64_tr_b16 a[138:139], v17 offset:34816
M v[80:83], a[64:67], a[168:171], v[80:83]
M v[80:83], a[68:71], a[172:175], v[80:83]
M v[84:87], a[76:79], a[172:175], v[84:87]
s_add_u32 s23, s23, 128
s_cmp_eq_u32 s23, s25
s_cselect_b32 s23, s26, s23
M v[84:87], a[72:75], a[168:171], v[84:87]
ds_read_b64_tr_b16 a[144:145], v18 offset:32768
ds_read_b64_tr_b16 a[146:147], v18 offset:34816
M v[88:91], a[80:83], a[168:171], v[88:91]
M v[88:91], a[84:87], a[172:175], v[88:91]
M v[92:95], a[92:95], a[172:175], v[92:95]
M v[92:95], a[88:91], a[168:171], v[92:95]
s_waitcnt lgkmcnt(15)
ds_read_b64_tr_b16 a[152:153], v19 offset:32768
ds_read_b64_tr_b16 a[154:155], v19 offset:34816
M v[96:99], a[32:35], a[176:179], v[96:99]
M v[96:99], a[36:39], a[180:183], v[96:99]
M v[100:103], a[44:47], a[180:183], v[100:103]
M v[100:103], a[40:43], a[176:179], v[100:103]
M v[104:107], a[48:51], a[176:179], v[104:107]
M v[104:107], a[52:55], a[180:183], v[104:107]
M v[108:111], a[60:63], a[180:183], v[108:111]
M v[108:111], a[56:59], a[176:179], v[108:111]
s_waitcnt vmcnt(8) lgkmcnt(0)
s_barrier
ds_read_b128 a[160:163], v10 offset:16384
ds_read_b128 a[164:167], v11 offset:16384
M v[112:115], a[64:67], a[176:179], v[112:115]
M v[112:115], a[68:71], a[180:183], v[112:115]
s_and_b32 s3, s2, 1
s_lshl_b32 s3, s3, 3
s_bfe_u32 s4, s2, 0x30003
M v[116:119], a[76:79], a[180:183], v[116:119]
s_add_u32 s26, s3, s4
s_bfe_u32 s3, s2, 0x20001
s_lshl_b32 s3, s3, 2
M v[116:119], a[72:75], a[176:179], v[116:119]
ds_read_b64_tr_b16 a[100:101], v12 offset:49152
ds_read_b64_tr_b16 a[102:103], v12 offset:51200
s_lshr_b32 s4, s2, 6
s_xor_b32 s4, s4, 2
s_add_u32 s27, s3, s4
M v[120:123], a[80:83], a[176:179], v[120:123]
s_lshl_b32 s23, s26, 18
s_sub_u32 s24, s23, 32768
M v[120:123], a[84:87], a[180:183], v[120:123]
s_max_i32 s24, s24, 0
s_lshl_b32 s25, s27, 7
s_xor_b32 s3, s26, s27
M v[124:127], a[92:95], a[180:183], v[124:127]
s_and_b32 s3, s3, 0
s_lshl_b32 s3, s3, 3
s_sub_u32 s31, 16, s3
M v[124:127], a[88:91], a[176:179], v[124:127]
s_mov_b32 s54, s31
s_movk_i32 s57, 128
s_mov_b32 s55, 4289069056
M v[128:131], a[32:35], a[184:187], v[128:131]
s_mov_b32 s56, 393216
s_lshl_b32 s4, s3, 7
M v[128:131], a[36:39], a[188:191], v[128:131]
ds_read_b128 a[168:171], v10 offset:18432
ds_read_b128 a[172:175], v11 offset:18432
ds_read_b64_tr_b16 a[108:109], v13 offset:49152
ds_read_b64_tr_b16 a[110:111], v13 offset:51200
s_add_u32 s23, s23, s4
s_add_u32 s24, s24, s4
s_mul_i32 s4, s3, 393216
M v[132:135], a[44:47], a[188:191], v[132:135]
s_add_u32 s25, s25, s4
s_mov_b64 s[8:9], s[44:45]
s_mov_b32 s10, 4194304
M v[132:135], a[40:43], a[184:187], v[132:135]
s_mov_b64 s[12:13], s[46:47]
s_mov_b32 s14, 6291456
M v[136:139], a[48:51], a[184:187], v[136:139]
s_mov_b64 s[36:37], s[90:91]
s_mov_b32 s38, 256
s_mov_b32 s39, 0x00020000
M v[136:139], a[52:55], a[188:191], v[136:139]
s_lshl_b32 s28, s20, 9
s_mul_i32 s30, s20, 6144
s_lshl_b32 s3, s20, 5
M v[140:143], a[60:63], a[188:191], v[140:143]
v_lshrrev_b32 v24, 3, v0
v_and_b32 v25, 7, v0
v_add_u32 v28, s3, v24
M v[140:143], a[56:59], a[184:187], v[140:143]
ds_read_b64_tr_b16 a[116:117], v14 offset:49152
ds_read_b64_tr_b16 a[118:119], v14 offset:51200
v_add_u32 v26, 0, v28
v_bfe_u32 v27, v26, 1, 3
M v[144:147], a[64:67], a[184:187], v[144:147]
v_xor_b32 v27, v27, v25
v_lshlrev_b32 v26, 11, v26
v_lshl_add_u32 v26, v27, 4, v26
M v[144:147], a[68:71], a[188:191], v[144:147]
v_subrev_u32 v2, 0, v26
v_add_u32 v26, 8, v28
v_bfe_u32 v27, v26, 1, 3
M v[148:151], a[76:79], a[188:191], v[148:151]
v_xor_b32 v27, v27, v25
v_lshlrev_b32 v26, 11, v26
v_lshl_add_u32 v26, v27, 4, v26
M v[148:151], a[72:75], a[184:187], v[148:151]
v_subrev_u32 v3, 1024, v26
v_add_u32 v26, 16, v28
M v[152:155], a[80:83], a[184:187], v[152:155]
v_bfe_u32 v27, v26, 1, 3
v_xor_b32 v27, v27, v25
v_lshlrev_b32 v26, 11, v26
M v[152:155], a[84:87], a[188:191], v[152:155]
ds_read_b64_tr_b16 a[124:125], v15 offset:49152
ds_read_b64_tr_b16 a[126:127], v15 offset:51200
v_lshl_add_u32 v26, v27, 4, v26
v_subrev_u32 v4, 2048, v26
v_add_u32 v26, 24, v28
M v[156:159], a[92:95], a[188:191], v[156:159]
v_bfe_u32 v27, v26, 1, 3
v_xor_b32 v27, v27, v25
M v[156:159], a[88:91], a[184:187], v[156:159]
s_waitcnt lgkmcnt(10)
v_lshlrev_b32 v26, 11, v26
v_lshl_add_u32 v26, v27, 4, v26
v_subrev_u32 v5, 3072, v26
M v[160:163], a[32:35], a[160:163], v[160:163]
s_lshl_b32 s3, s20, 2
v_lshrrev_b32 v26, 5, v0
v_add_u32 v26, s3, v26
M v[160:163], a[36:39], a[164:167], v[160:163]
ds_read_b128 a[176:179], v10 offset:20480
ds_read_b128 a[180:183], v11 offset:20480
v_bfe_u32 v29, v0, 2, 3
v_bfe_u32 v27, v26, 1, 3
v_xor_b32 v27, v27, v29
M v[164:167], a[44:47], a[164:167], v[164:167]
v_lshlrev_b32 v27, 4, v27
v_and_b32 v30, 3, v0
M v[164:167], a[40:43], a[160:163], v[164:167]
ds_read_b64_tr_b16 a[132:133], v16 offset:49152
ds_read_b64_tr_b16 a[134:135], v16 offset:51200
v_lshl_add_u32 v27, v30, 2, v27
v_lshl_add_u32 v20, v26, 11, v27
v_add_u32 v26, 2, v26
M v[168:171], a[48:51], a[160:163], v[168:171]
v_bfe_u32 v27, v26, 1, 3
v_xor_b32 v27, v27, v29
v_lshlrev_b32 v27, 4, v27
M v[168:171], a[52:55], a[164:167], v[168:171]
v_and_b32 v30, 3, v0
v_lshl_add_u32 v27, v30, 2, v27
M v[172:175], a[60:63], a[164:167], v[172:175]
v_lshl_add_u32 v23, v26, 11, v27
v_subrev_u32 v23, 256, v23
s_mul_i32 s3, s20, 48
M v[172:175], a[56:59], a[160:163], v[172:175]
v_add_u32 v28, s3, v24
v_add_u32 v26, 0, v28
v_mul_u32_u24 v27, 0xaaab, v26
M v[176:179], a[64:67], a[160:163], v[176:179]
v_lshrrev_b32 v27, 17, v27
v_lshrrev_b32 v29, 1, v27
v_and_b32 v29, 4, v29
M v[176:179], a[68:71], a[164:167], v[176:179]
ds_read_b64_tr_b16 a[140:141], v17 offset:49152
ds_read_b64_tr_b16 a[142:143], v17 offset:51200
v_and_or_b32 v27, v27, 2, v29
v_xor_b32 v27, v27, v25
M v[180:183], a[76:79], a[164:167], v[180:183]
v_lshlrev_b32 v26, 11, v26
v_lshl_add_u32 v26, v27, 4, v26
v_subrev_u32 v6, 0, v26
M v[180:183], a[72:75], a[160:163], v[180:183]
v_add_u32 v26, 8, v28
v_mul_u32_u24 v27, 0xaaab, v26
v_lshrrev_b32 v27, 17, v27
M v[184:187], a[80:83], a[160:163], v[184:187]
v_lshrrev_b32 v29, 1, v27
v_and_b32 v29, 4, v29
v_and_or_b32 v27, v27, 2, v29
M v[184:187], a[84:87], a[164:167], v[184:187]
v_xor_b32 v27, v27, v25
v_lshlrev_b32 v26, 11, v26
M v[188:191], a[92:95], a[164:167], v[188:191]
v_lshl_add_u32 v26, v27, 4, v26
v_subrev_u32 v7, 1024, v26
v_add_u32 v26, 16, v28
M v[188:191], a[88:91], a[160:163], v[188:191]
s_waitcnt lgkmcnt(12)
ds_read_b64_tr_b16 a[148:149], v18 offset:49152
ds_read_b64_tr_b16 a[150:151], v18 offset:51200
v_mul_u32_u24 v27, 0xaaab, v26
v_lshrrev_b32 v27, 17, v27
v_lshrrev_b32 v29, 1, v27
M v[192:195], a[32:35], a[168:171], v[192:195]
v_and_b32 v29, 4, v29
v_and_or_b32 v27, v27, 2, v29
M v[192:195], a[36:39], a[172:175], v[192:195]
ds_read_b128 a[184:187], v10 offset:22528
ds_read_b128 a[188:191], v11 offset:22528
v_xor_b32 v27, v27, v25
v_lshlrev_b32 v26, 11, v26
v_lshl_add_u32 v26, v27, 4, v26
M v[196:199], a[44:47], a[172:175], v[196:199]
v_subrev_u32 v8, 2048, v26
v_add_u32 v26, 24, v28
v_mul_u32_u24 v27, 0xaaab, v26
M v[196:199], a[40:43], a[168:171], v[196:199]
v_lshrrev_b32 v27, 17, v27
v_lshrrev_b32 v29, 1, v27
v_and_b32 v29, 4, v29
M v[200:203], a[48:51], a[168:171], v[200:203]
v_and_or_b32 v27, v27, 2, v29
v_xor_b32 v27, v27, v25
M v[200:203], a[52:55], a[172:175], v[200:203]
ds_read_b64_tr_b16 a[156:157], v19 offset:49152
ds_read_b64_tr_b16 a[158:159], v19 offset:51200
v_lshlrev_b32 v26, 11, v26
v_lshl_add_u32 v26, v27, 4, v26
v_subrev_u32 v9, 3072, v26
M v[204:207], a[60:63], a[172:175], v[204:207]
v_add_u32 v26, 32, v28
v_mul_u32_u24 v27, 0xaaab, v26
v_lshrrev_b32 v27, 17, v27
M v[204:207], a[56:59], a[168:171], v[204:207]
v_lshrrev_b32 v29, 1, v27
v_and_b32 v29, 4, v29
v_and_or_b32 v27, v27, 2, v29
M v[208:211], a[64:67], a[168:171], v[208:211]
v_xor_b32 v27, v27, v25
v_lshlrev_b32 v26, 11, v26
M v[208:211], a[68:71], a[172:175], v[208:211]
v_lshl_add_u32 v26, v27, 4, v26
v_subrev_u32 v21, 0, v26
v_add_u32 v26, 40, v28
M v[212:215], a[76:79], a[172:175], v[212:215]
v_mul_u32_u24 v27, 0xaaab, v26
v_lshrrev_b32 v27, 17, v27
v_lshrrev_b32 v29, 1, v27
M v[212:215], a[72:75], a[168:171], v[212:215]
v_and_b32 v29, 4, v29
v_and_or_b32 v27, v27, 2, v29
M v[216:219], a[80:83], a[168:171], v[216:219]
v_xor_b32 v27, v27, v25
v_lshlrev_b32 v26, 11, v26
v_lshl_add_u32 v26, v27, 4, v26
M v[216:219], a[84:87], a[172:175], v[216:219]
v_subrev_u32 v22, 1024, v26
s_lshr_b32 s3, s53, 7
s_add_u32 s3, s3, s22
M v[220:223], a[92:95], a[172:175], v[220:223]
s_lshl_b32 s3, s3, 5
s_lshr_b32 s19, s52, 6
s_add_u32 s3, s3, s19
M v[220:223], a[88:91], a[168:171], v[220:223]
s_waitcnt lgkmcnt(10)
s_lshl_b32 s19, s21, 1
s_add_u32 s3, s3, s19
M v[224:227], a[32:35], a[176:179], v[224:227]
s_lshl_b32 s92, s3, 14
s_add_u32 s93, s92, 16384
s_add_u32 s16, s50, 0
M v[224:227], a[36:39], a[180:183], v[224:227]
s_addc_u32 s17, s51, 0
s_mov_b32 s18, 16777216
s_mov_b32 s19, 0x00020000
M v[228:231], a[44:47], a[180:183], v[228:231]
s_mov_b32 s4, 0x3e0293ee
s_mov_b32 s5, 0x3e0293ee
M v[228:231], a[40:43], a[176:179], v[228:231]
M v[232:235], a[48:51], a[176:179], v[232:235]
M v[232:235], a[52:55], a[180:183], v[232:235]
M v[236:239], a[60:63], a[180:183], v[236:239]
M v[236:239], a[56:59], a[176:179], v[236:239]
s_waitcnt vmcnt(4) lgkmcnt(0)
s_barrier
ds_read_b128 a[160:163], v10 offset:32768
ds_read_b128 a[164:167], v11 offset:32768
M v[240:243], a[64:67], a[176:179], v[240:243]
s_add_u32 m0, s28, 131072
s_nop 0
buffer_load_dword v20, s[8:11], s24 offen lds
M v[240:243], a[68:71], a[180:183], v[240:243]
M v[244:247], a[76:79], a[180:183], v[244:247]
M v[244:247], a[72:75], a[176:179], v[244:247]
buffer_load_dword v23, s[8:11], s24 offen offset:256 lds
M v[248:251], a[80:83], a[176:179], v[248:251]
M v[248:251], a[84:87], a[180:183], v[248:251]
M v[252:255], a[92:95], a[180:183], v[252:255]
M v[252:255], a[88:91], a[176:179], v[252:255]
M a[0:3], a[32:35], a[184:187], a[0:3]
s_add_u32 m0, s29, 133120
s_nop 0
buffer_load_dwordx4 v2, s[8:11], s23 offen offset:0 lds
M a[0:3], a[36:39], a[188:191], a[0:3]
ds_read_b128 a[168:171], v10 offset:34816
ds_read_b128 a[172:175], v11 offset:34816
M a[4:7], a[44:47], a[188:191], a[4:7]
M a[4:7], a[40:43], a[184:187], a[4:7]
M a[8:11], a[48:51], a[184:187], a[8:11]
buffer_load_dwordx4 v3, s[8:11], s23 offen offset:1024 lds
M a[8:11], a[52:55], a[188:191], a[8:11]
M a[12:15], a[60:63], a[188:191], a[12:15]
M a[12:15], a[56:59], a[184:187], a[12:15]
M a[16:19], a[64:67], a[184:187], a[16:19]
buffer_load_dwordx4 v4, s[8:11], s23 offen offset:2048 lds
M a[16:19], a[68:71], a[188:191], a[16:19]
M a[20:23], a[76:79], a[188:191], a[20:23]
M a[20:23], a[72:75], a[184:187], a[20:23]
buffer_load_dwordx4 v5, s[8:11], s23 offen offset:3072 lds
M a[24:27], a[80:83], a[184:187], a[24:27]
M a[24:27], a[84:87], a[188:191], a[24:27]
M a[28:31], a[92:95], a[188:191], a[28:31]
M a[28:31], a[88:91], a[184:187], a[28:31]
s_waitcnt lgkmcnt(2)
M v[32:35], a[96:99], a[160:163], v[32:35]
s_sub_u32 s31, s31, 1
s_cmp_eq_u32 s31, 0
s_cselect_b32 s58, -1920, s57
s_add_u32 s23, s23, s58
s_add_u32 s24, s24, s58
M v[32:35], a[100:103], a[164:167], v[32:35]
ds_read_b128 a[176:179], v10 offset:36864
ds_read_b128 a[180:183], v11 offset:36864
M v[36:39], a[108:111], a[164:167], v[36:39]
M v[36:39], a[104:107], a[160:163], v[36:39]
M v[40:43], a[112:115], a[160:163], v[40:43]
M v[40:43], a[116:119], a[164:167], v[40:43]
s_add_u32 m0, s30, 65536
s_nop 0
buffer_load_dwordx4 v6, s[12:15], s25 offen offset:0 lds
M v[44:47], a[124:127], a[164:167], v[44:47]
M v[44:47], a[120:123], a[160:163], v[44:47]
M v[48:51], a[128:131], a[160:163], v[48:51]
M v[48:51], a[132:135], a[164:167], v[48:51]
buffer_load_dwordx4 v7, s[12:15], s25 offen offset:1024 lds
M v[52:55], a[140:143], a[164:167], v[52:55]
M v[52:55], a[136:139], a[160:163], v[52:55]
M v[56:59], a[144:147], a[160:163], v[56:59]
M v[56:59], a[148:151], a[164:167], v[56:59]
buffer_load_dwordx4 v8, s[12:15], s25 offen offset:2048 lds
M v[60:63], a[156:159], a[164:167], v[60:63]
M v[60:63], a[152:155], a[160:163], v[60:63]
s_waitcnt lgkmcnt(2)
M v[64:67], a[96:99], a[168:171], v[64:67]
M v[64:67], a[100:103], a[172:175], v[64:67]
ds_read_b128 a[184:187], v10 offset:38912
ds_read_b128 a[188:191], v11 offset:38912
M v[68:71], a[108:111], a[172:175], v[68:71]
M v[68:71], a[104:107], a[168:171], v[68:71]
buffer_load_dwordx4 v9, s[12:15], s25 offen offset:3072 lds
v_pk_mul_f32 v[32:33], v[32:33], s[4:5]
v_pk_mul_f32 v[34:35], v[34:35], s[4:5]
v_pk_mul_f32 v[36:37], v[36:37], s[4:5]
M v[72:75], a[112:115], a[168:171], v[72:75]
v_pk_mul_f32 v[38:39], v[38:39], s[4:5]
v_cvt_pk_bf16_f32 v32, v32, v33
M v[72:75], a[116:119], a[172:175], v[72:75]
v_cvt_pk_bf16_f32 v33, v34, v35
v_cvt_pk_bf16_f32 v34, v36, v37
M v[76:79], a[124:127], a[172:175], v[76:79]
v_cvt_pk_bf16_f32 v35, v38, v39
v_pk_mul_f32 v[40:41], v[40:41], s[4:5]
v_pk_mul_f32 v[42:43], v[42:43], s[4:5]
M v[76:79], a[120:123], a[168:171], v[76:79]
s_add_u32 m0, s30, 69632
s_nop 0
buffer_load_dwordx4 v21, s[12:15], s25 offen offset:0 lds
v_pk_mul_f32 v[44:45], v[44:45], s[4:5]
v_pk_mul_f32 v[46:47], v[46:47], s[4:5]
M v[80:83], a[128:131], a[168:171], v[80:83]
v_cvt_pk_bf16_f32 v40, v40, v41
v_cvt_pk_bf16_f32 v41, v42, v43
M v[80:83], a[132:135], a[172:175], v[80:83]
v_cvt_pk_bf16_f32 v42, v44, v45
v_cvt_pk_bf16_f32 v43, v46, v47
M v[84:87], a[140:143], a[172:175], v[84:87]
v_pk_mul_f32 v[48:49], v[48:49], s[4:5]
v_pk_mul_f32 v[50:51], v[50:51], s[4:5]
v_pk_mul_f32 v[52:53], v[52:53], s[4:5]
M v[84:87], a[136:139], a[168:171], v[84:87]
buffer_load_dwordx4 v22, s[12:15], s25 offen offset:1024 lds
v_pk_mul_f32 v[54:55], v[54:55], s[4:5]
v_cvt_pk_bf16_f32 v48, v48, v49
M v[88:91], a[144:147], a[168:171], v[88:91]
v_cvt_pk_bf16_f32 v49, v50, v51
v_cvt_pk_bf16_f32 v50, v52, v53
M v[88:91], a[148:151], a[172:175], v[88:91]
v_cvt_pk_bf16_f32 v51, v54, v55
v_pk_mul_f32 v[56:57], v[56:57], s[4:5]
v_pk_mul_f32 v[58:59], v[58:59], s[4:5]
M v[92:95], a[156:159], a[172:175], v[92:95]
v_pk_mul_f32 v[60:61], v[60:61], s[4:5]
v_pk_mul_f32 v[62:63], v[62:63], s[4:5]
M v[92:95], a[152:155], a[168:171], v[92:95]
s_waitcnt lgkmcnt(2)
v_cvt_pk_bf16_f32 v56, v56, v57
v_cvt_pk_bf16_f32 v57, v58, v59
M v[96:99], a[96:99], a[176:179], v[96:99]
s_sub_u32 s54, s54, 1
s_cmp_eq_u32 s54, 0
s_cselect_b32 s58, s55, s56
s_add_u32 s25, s25, s58
v_cvt_pk_bf16_f32 v58, v60, v61
v_cvt_pk_bf16_f32 v59, v62, v63
M v[96:99], a[100:103], a[180:183], v[96:99]
M v[100:103], a[108:111], a[180:183], v[100:103]
M v[100:103], a[104:107], a[176:179], v[100:103]
v_pk_mul_f32 v[64:65], v[64:65], s[4:5]
v_pk_mul_f32 v[66:67], v[66:67], s[4:5]
v_pk_mul_f32 v[68:69], v[68:69], s[4:5]
M v[104:107], a[112:115], a[176:179], v[104:107]
s_add_u32 s94, s92, 0
buffer_store_dwordx4 v[32:35], v1, s[16:19], s94 offen offset:0 sc1
v_pk_mul_f32 v[70:71], v[70:71], s[4:5]
v_cvt_pk_bf16_f32 v64, v64, v65
M v[104:107], a[116:119], a[180:183], v[104:107]
v_cvt_pk_bf16_f32 v65, v66, v67
v_cvt_pk_bf16_f32 v66, v68, v69
M v[108:111], a[124:127], a[180:183], v[108:111]
v_cvt_pk_bf16_f32 v67, v70, v71
v_pk_mul_f32 v[72:73], v[72:73], s[4:5]
v_pk_mul_f32 v[74:75], v[74:75], s[4:5]
M v[108:111], a[120:123], a[176:179], v[108:111]
s_waitcnt vmcnt(13) lgkmcnt(0)
s_barrier
ds_read_b128 a[160:163], v10 offset:49152
ds_read_b128 a[164:167], v11 offset:49152
v_pk_mul_f32 v[76:77], v[76:77], s[4:5]
v_pk_mul_f32 v[78:79], v[78:79], s[4:5]
M v[112:115], a[128:131], a[176:179], v[112:115]
s_add_u32 m0, s28, 0
s_nop 0
buffer_load_dword v20, s[8:11], s24 offen lds
v_cvt_pk_bf16_f32 v72, v72, v73
v_cvt_pk_bf16_f32 v73, v74, v75
M v[112:115], a[132:135], a[180:183], v[112:115]
v_cvt_pk_bf16_f32 v74, v76, v77
v_cvt_pk_bf16_f32 v75, v78, v79
M v[116:119], a[140:143], a[180:183], v[116:119]
s_add_u32 s94, s92, 0
buffer_store_dwordx4 v[40:43], v1, s[16:19], s94 offen offset:1024 sc1
v_pk_mul_f32 v[80:81], v[80:81], s[4:5]
v_pk_mul_f32 v[82:83], v[82:83], s[4:5]
v_pk_mul_f32 v[84:85], v[84:85], s[4:5]
M v[116:119], a[136:139], a[176:179], v[116:119]
v_pk_mul_f32 v[86:87], v[86:87], s[4:5]
v_cvt_pk_bf16_f32 v80, v80, v81
M v[120:123], a[144:147], a[176:179], v[120:123]
buffer_load_dword v23, s[8:11], s24 offen offset:256 lds
v_cvt_pk_bf16_f32 v81, v82, v83
v_cvt_pk_bf16_f32 v82, v84, v85
M v[120:123], a[148:151], a[180:183], v[120:123]
v_cvt_pk_bf16_f32 v83, v86, v87
v_pk_mul_f32 v[88:89], v[88:89], s[4:5]
v_pk_mul_f32 v[90:91], v[90:91], s[4:5]
M v[124:127], a[156:159], a[180:183], v[124:127]
v_pk_mul_f32 v[92:93], v[92:93], s[4:5]
v_pk_mul_f32 v[94:95], v[94:95], s[4:5]
M v[124:127], a[152:155], a[176:179], v[124:127]
v_cvt_pk_bf16_f32 v88, v88, v89
v_cvt_pk_bf16_f32 v89, v90, v91
M v[128:131], a[96:99], a[184:187], v[128:131]
s_add_u32 m0, s29, 2048
s_nop 0
buffer_load_dwordx4 v2, s[8:11], s23 offen offset:0 lds
v_cvt_pk_bf16_f32 v90, v92, v93
v_cvt_pk_bf16_f32 v91, v94, v95
M v[128:131], a[100:103], a[188:191], v[128:131]
ds_read_b128 a[168:171], v10 offset:51200
ds_read_b128 a[172:175], v11 offset:51200
M v[132:135], a[108:111], a[188:191], v[132:135]
s_add_u32 s94, s92, 0
buffer_store_dwordx4 v[48:51], v1, s[16:19], s94 offen offset:2048 sc1
M v[132:135], a[104:107], a[184:187], v[132:135]
v_pk_mul_f32 v[96:97], v[96:97], s[4:5]
v_pk_mul_f32 v[98:99], v[98:99], s[4:5]
v_pk_mul_f32 v[100:101], v[100:101], s[4:5]
M v[136:139], a[112:115], a[184:187], v[136:139]
v_pk_mul_f32 v[102:103], v[102:103], s[4:5]
v_cvt_pk_bf16_f32 v96, v96, v97
M v[136:139], a[116:119], a[188:191], v[136:139]
buffer_load_dwordx4 v3, s[8:11], s23 offen offset:1024 lds
v_cvt_pk_bf16_f32 v97, v98, v99
v_cvt_pk_bf16_f32 v98, v100, v101
M v[140:143], a[124:127], a[188:191], v[140:143]
v_cvt_pk_bf16_f32 v99, v102, v103
v_pk_mul_f32 v[104:105], v[104:105], s[4:5]
v_pk_mul_f32 v[106:107], v[106:107], s[4:5]
M v[140:143], a[120:123], a[184:187], v[140:143]
v_pk_mul_f32 v[108:109], v[108:109], s[4:5]
v_pk_mul_f32 v[110:111], v[110:111], s[4:5]
M v[144:147], a[128:131], a[184:187], v[144:147]
s_add_u32 s94, s92, 0
buffer_store_dwordx4 v[56:59], v1, s[16:19], s94 offen offset:3072 sc1
v_cvt_pk_bf16_f32 v104, v104, v105
v_cvt_pk_bf16_f32 v105, v106, v107
M v[144:147], a[132:135], a[188:191], v[144:147]
v_cvt_pk_bf16_f32 v106, v108, v109
v_cvt_pk_bf16_f32 v107, v110, v111
M v[148:151], a[140:143], a[188:191], v[148:151]
buffer_load_dwordx4 v4, s[8:11], s23 offen offset:2048 lds
v_pk_mul_f32 v[112:113], v[112:113], s[4:5]
v_pk_mul_f32 v[114:115], v[114:115], s[4:5]
v_pk_mul_f32 v[116:117], v[116:117], s[4:5]
M v[148:151], a[136:139], a[184:187], v[148:151]
v_pk_mul_f32 v[118:119], v[118:119], s[4:5]
v_cvt_pk_bf16_f32 v112, v112, v113
M v[152:155], a[144:147], a[184:187], v[152:155]
v_cvt_pk_bf16_f32 v113, v114, v115
v_cvt_pk_bf16_f32 v114, v116, v117
M v[152:155], a[148:151], a[188:191], v[152:155]
buffer_load_dwordx4 v5, s[8:11], s23 offen offset:3072 lds
v_cvt_pk_bf16_f32 v115, v118, v119
v_pk_mul_f32 v[120:121], v[120:121], s[4:5]
v_pk_mul_f32 v[122:123], v[122:123], s[4:5]
M v[156:159], a[156:159], a[188:191], v[156:159]
v_pk_mul_f32 v[124:125], v[124:125], s[4:5]
v_pk_mul_f32 v[126:127], v[126:127], s[4:5]
M v[156:159], a[152:155], a[184:187], v[156:159]
s_add_u32 s94, s92, 4096
buffer_store_dwordx4 v[64:67], v1, s[16:19], s94 offen offset:0 sc1
s_waitcnt lgkmcnt(2)
v_cvt_pk_bf16_f32 v120, v120, v121
v_cvt_pk_bf16_f32 v121, v122, v123
M v[160:163], a[96:99], a[160:163], v[160:163]
v_cvt_pk_bf16_f32 v122, v124, v125
v_cvt_pk_bf16_f32 v123, v126, v127
M v[160:163], a[100:103], a[164:167], v[160:163]
ds_read_b128 a[176:179], v10 offset:53248
ds_read_b128 a[180:183], v11 offset:53248
M v[164:167], a[108:111], a[164:167], v[164:167]
s_sub_u32 s31, s31, 1
s_cmp_eq_u32 s31, 0
s_cselect_b32 s58, -1920, s57
s_add_u32 s23, s23, s58
s_add_u32 s24, s24, s58
M v[164:167], a[104:107], a[160:163], v[164:167]
v_pk_mul_f32 v[128:129], v[128:129], s[4:5]
v_pk_mul_f32 v[130:131], v[130:131], s[4:5]
v_pk_mul_f32 v[132:133], v[132:133], s[4:5]
M v[168:171], a[112:115], a[160:163], v[168:171]
v_pk_mul_f32 v[134:135], v[134:135], s[4:5]
v_cvt_pk_bf16_f32 v128, v128, v129
M v[168:171], a[116:119], a[164:167], v[168:171]
s_add_u32 s94, s92, 4096
buffer_store_dwordx4 v[72:75], v1, s[16:19], s94 offen offset:1024 sc1
v_cvt_pk_bf16_f32 v129, v130, v131
v_cvt_pk_bf16_f32 v130, v132, v133
M v[172:175], a[124:127], a[164:167], v[172:175]
v_cvt_pk_bf16_f32 v131, v134, v135
v_pk_mul_f32 v[136:137], v[136:137], s[4:5]
v_pk_mul_f32 v[138:139], v[138:139], s[4:5]
M v[172:175], a[120:123], a[160:163], v[172:175]
s_add_u32 m0, s30, 98304
s_nop 0
buffer_load_dwordx4 v6, s[12:15], s25 offen offset:0 lds
v_pk_mul_f32 v[140:141], v[140:141], s[4:5]
v_pk_mul_f32 v[142:143], v[142:143], s[4:5]
M v[176:179], a[128:131], a[160:163], v[176:179]
v_cvt_pk_bf16_f32 v136, v136, v137
v_cvt_pk_bf16_f32 v137, v138, v139
M v[176:179], a[132:135], a[164:167], v[176:179]
v_cvt_pk_bf16_f32 v138, v140, v141
v_cvt_pk_bf16_f32 v139, v142, v143
M v[180:183], a[140:143], a[164:167], v[180:183]
buffer_load_dwordx4 v7, s[12:15], s25 offen offset:1024 lds
v_pk_mul_f32 v[144:145], v[144:145], s[4:5]
v_pk_mul_f32 v[146:147], v[146:147], s[4:5]
v_pk_mul_f32 v[148:149], v[148:149], s[4:5]
M v[180:183], a[136:139], a[160:163], v[180:183]
v_pk_mul_f32 v[150:151], v[150:151], s[4:5]
v_cvt_pk_bf16_f32 v144, v144, v145
M v[184:187], a[144:147], a[160:163], v[184:187]
s_add_u32 s94, s92, 4096
buffer_store_dwordx4 v[80:83], v1, s[16:19], s94 offen offset:2048 sc1
v_cvt_pk_bf16_f32 v145, v146, v147
v_cvt_pk_bf16_f32 v146, v148, v149
M v[184:187], a[148:151], a[164:167], v[184:187]
v_cvt_pk_bf16_f32 v147, v150, v151
v_pk_mul_f32 v[152:153], v[152:153], s[4:5]
v_pk_mul_f32 v[154:155], v[154:155], s[4:5]
M v[188:191], a[156:159], a[164:167], v[188:191]
buffer_load_dwordx4 v8, s[12:15], s25 offen offset:2048 lds
v_pk_mul_f32 v[156:157], v[156:157], s[4:5]
v_pk_mul_f32 v[158:159], v[158:159], s[4:5]
M v[188:191], a[152:155], a[160:163], v[188:191]
s_waitcnt lgkmcnt(2)
v_cvt_pk_bf16_f32 v152, v152, v153
v_cvt_pk_bf16_f32 v153, v154, v155
M v[192:195], a[96:99], a[168:171], v[192:195]
v_cvt_pk_bf16_f32 v154, v156, v157
v_cvt_pk_bf16_f32 v155, v158, v159
M v[192:195], a[100:103], a[172:175], v[192:195]
ds_read_b128 a[184:187], v10 offset:55296
ds_read_b128 a[188:191], v11 offset:55296
M v[196:199], a[108:111], a[172:175], v[196:199]
M v[196:199], a[104:107], a[168:171], v[196:199]
s_add_u32 s94, s92, 4096
buffer_store_dwordx4 v[88:91], v1, s[16:19], s94 offen offset:3072 sc1
v_pk_mul_f32 v[160:161], v[160:161], s[4:5]
v_pk_mul_f32 v[162:163], v[162:163], s[4:5]
v_pk_mul_f32 v[164:165], v[164:165], s[4:5]
M v[200:203], a[112:115], a[168:171], v[200:203]
buffer_load_dwordx4 v9, s[12:15], s25 offen offset:3072 lds
v_pk_mul_f32 v[166:167], v[166:167], s[4:5]
v_cvt_pk_bf16_f32 v160, v160, v161
M v[200:203], a[116:119], a[172:175], v[200:203]
v_cvt_pk_bf16_f32 v161, v162, v163
v_cvt_pk_bf16_f32 v162, v164, v165
M v[204:207], a[124:127], a[172:175], v[204:207]
v_cvt_pk_bf16_f32 v163, v166, v167
v_pk_mul_f32 v[168:169], v[168:169], s[4:5]
v_pk_mul_f32 v[170:171], v[170:171], s[4:5]
M v[204:207], a[120:123], a[168:171], v[204:207]
v_pk_mul_f32 v[172:173], v[172:173], s[4:5]
v_pk_mul_f32 v[174:175], v[174:175], s[4:5]
M v[208:211], a[128:131], a[168:171], v[208:211]
s_add_u32 m0, s30, 102400
s_nop 0
buffer_load_dwordx4 v21, s[12:15], s25 offen offset:0 lds
v_cvt_pk_bf16_f32 v168, v168, v169
v_cvt_pk_bf16_f32 v169, v170, v171
M v[208:211], a[132:135], a[172:175], v[208:211]
v_cvt_pk_bf16_f32 v170, v172, v173
v_cvt_pk_bf16_f32 v171, v174, v175
M v[212:215], a[140:143], a[172:175], v[212:215]
s_add_u32 s94, s92, 8192
buffer_store_dwordx4 v[96:99], v1, s[16:19], s94 offen offset:0 sc1
v_pk_mul_f32 v[176:177], v[176:177], s[4:5]
v_pk_mul_f32 v[178:179], v[178:179], s[4:5]
v_pk_mul_f32 v[180:181], v[180:181], s[4:5]
M v[212:215], a[136:139], a[168:171], v[212:215]
v_pk_mul_f32 v[182:183], v[182:183], s[4:5]
v_cvt_pk_bf16_f32 v176, v176, v177
M v[216:219], a[144:147], a[168:171], v[216:219]
buffer_load_dwordx4 v22, s[12:15], s25 offen offset:1024 lds
v_cvt_pk_bf16_f32 v177, v178, v179
v_cvt_pk_bf16_f32 v178, v180, v181
M v[216:219], a[148:151], a[172:175], v[216:219]
v_cvt_pk_bf16_f32 v179, v182, v183
v_pk_mul_f32 v[184:185], v[184:185], s[4:5]
v_pk_mul_f32 v[186:187], v[186:187], s[4:5]
M v[220:223], a[156:159], a[172:175], v[220:223]
v_pk_mul_f32 v[188:189], v[188:189], s[4:5]
v_pk_mul_f32 v[190:191], v[190:191], s[4:5]
M v[220:223], a[152:155], a[168:171], v[220:223]
s_waitcnt lgkmcnt(2)
v_cvt_pk_bf16_f32 v184, v184, v185
v_cvt_pk_bf16_f32 v185, v186, v187
M v[224:227], a[96:99], a[176:179], v[224:227]
s_add_u32 s94, s92, 8192
buffer_store_dwordx4 v[104:107], v1, s[16:19], s94 offen offset:1024 sc1
v_cvt_pk_bf16_f32 v186, v188, v189
v_cvt_pk_bf16_f32 v187, v190, v191
M v[224:227], a[100:103], a[180:183], v[224:227]
s_sub_u32 s54, s54, 1
s_cmp_eq_u32 s54, 0
s_cselect_b32 s58, s55, s56
s_add_u32 s25, s25, s58
M v[228:231], a[108:111], a[180:183], v[228:231]
M v[228:231], a[104:107], a[176:179], v[228:231]
v_pk_mul_f32 v[192:193], v[192:193], s[4:5]
v_pk_mul_f32 v[194:195], v[194:195], s[4:5]
v_pk_mul_f32 v[196:197], v[196:197], s[4:5]
M v[232:235], a[112:115], a[176:179], v[232:235]
v_pk_mul_f32 v[198:199], v[198:199], s[4:5]
v_cvt_pk_bf16_f32 v192, v192, v193
M v[232:235], a[116:119], a[180:183], v[232:235]
v_cvt_pk_bf16_f32 v193, v194, v195
v_cvt_pk_bf16_f32 v194, v196, v197
M v[236:239], a[124:127], a[180:183], v[236:239]
v_cvt_pk_bf16_f32 v195, v198, v199
v_pk_mul_f32 v[200:201], v[200:201], s[4:5]
v_pk_mul_f32 v[202:203], v[202:203], s[4:5]
M v[236:239], a[120:123], a[176:179], v[236:239]
s_waitcnt vmcnt(63) lgkmcnt(0)
s_barrier
v_pk_mul_f32 v[204:205], v[204:205], s[4:5]
v_pk_mul_f32 v[206:207], v[206:207], s[4:5]
M v[240:243], a[128:131], a[176:179], v[240:243]
s_add_u32 s94, s92, 8192
buffer_store_dwordx4 v[112:115], v1, s[16:19], s94 offen offset:2048 sc1
v_cvt_pk_bf16_f32 v200, v200, v201
v_cvt_pk_bf16_f32 v201, v202, v203
M v[240:243], a[132:135], a[180:183], v[240:243]
s_add_u32 m0, s28, 18432
s_nop 0
buffer_load_dword v20, s[8:11], s24 offen lds
v_cvt_pk_bf16_f32 v202, v204, v205
v_cvt_pk_bf16_f32 v203, v206, v207
M v[244:247], a[140:143], a[180:183], v[244:247]
v_pk_mul_f32 v[208:209], v[208:209], s[4:5]
v_pk_mul_f32 v[210:211], v[210:211], s[4:5]
v_pk_mul_f32 v[212:213], v[212:213], s[4:5]
M v[244:247], a[136:139], a[176:179], v[244:247]
v_pk_mul_f32 v[214:215], v[214:215], s[4:5]
v_cvt_pk_bf16_f32 v208, v208, v209
M v[248:251], a[144:147], a[176:179], v[248:251]
buffer_load_dword v23, s[8:11], s24 offen offset:256 lds
v_cvt_pk_bf16_f32 v209, v210, v211
v_cvt_pk_bf16_f32 v210, v212, v213
M v[248:251], a[148:151], a[180:183], v[248:251]
v_cvt_pk_bf16_f32 v211, v214, v215
v_pk_mul_f32 v[216:217], v[216:217], s[4:5]
v_pk_mul_f32 v[218:219], v[218:219], s[4:5]
M v[252:255], a[156:159], a[180:183], v[252:255]
s_add_u32 s94, s92, 8192
buffer_store_dwordx4 v[120:123], v1, s[16:19], s94 offen offset:3072 sc1
v_pk_mul_f32 v[220:221], v[220:221], s[4:5]
v_pk_mul_f32 v[222:223], v[222:223], s[4:5]
M v[252:255], a[152:155], a[176:179], v[252:255]
v_cvt_pk_bf16_f32 v216, v216, v217
v_cvt_pk_bf16_f32 v217, v218, v219
M a[0:3], a[96:99], a[184:187], a[0:3]
v_cvt_pk_bf16_f32 v218, v220, v221
v_cvt_pk_bf16_f32 v219, v222, v223
M a[0:3], a[100:103], a[188:191], a[0:3]
s_add_u32 m0, s29, 20480
s_nop 0
buffer_load_dwordx4 v2, s[8:11], s23 offen offset:0 lds
M a[4:7], a[108:111], a[188:191], a[4:7]
M a[4:7], a[104:107], a[184:187], a[4:7]
v_pk_mul_f32 v[224:225], v[224:225], s[4:5]
v_pk_mul_f32 v[226:227], v[226:227], s[4:5]
v_pk_mul_f32 v[228:229], v[228:229], s[4:5]
M a[8:11], a[112:115], a[184:187], a[8:11]
buffer_load_dwordx4 v3, s[8:11], s23 offen offset:1024 lds
v_pk_mul_f32 v[230:231], v[230:231], s[4:5]
v_cvt_pk_bf16_f32 v224, v224, v225
M a[8:11], a[116:119], a[188:191], a[8:11]
s_add_u32 s94, s92, 12288
buffer_store_dwordx4 v[128:131], v1, s[16:19], s94 offen offset:0 sc1
v_cvt_pk_bf16_f32 v225, v226, v227
v_cvt_pk_bf16_f32 v226, v228, v229
M a[12:15], a[124:127], a[188:191], a[12:15]
v_cvt_pk_bf16_f32 v227, v230, v231
v_pk_mul_f32 v[232:233], v[232:233], s[4:5]
v_pk_mul_f32 v[234:235], v[234:235], s[4:5]
M a[12:15], a[120:123], a[184:187], a[12:15]
v_pk_mul_f32 v[236:237], v[236:237], s[4:5]
v_pk_mul_f32 v[238:239], v[238:239], s[4:5]
M a[16:19], a[128:131], a[184:187], a[16:19]
buffer_load_dwordx4 v4, s[8:11], s23 offen offset:2048 lds
v_cvt_pk_bf16_f32 v232, v232, v233
v_cvt_pk_bf16_f32 v233, v234, v235
M a[16:19], a[132:135], a[188:191], a[16:19]
v_cvt_pk_bf16_f32 v234, v236, v237
v_cvt_pk_bf16_f32 v235, v238, v239
M a[20:23], a[140:143], a[188:191], a[20:23]
v_pk_mul_f32 v[240:241], v[240:241], s[4:5]
v_pk_mul_f32 v[242:243], v[242:243], s[4:5]
v_pk_mul_f32 v[244:245], v[244:245], s[4:5]
M a[20:23], a[136:139], a[184:187], a[20:23]
buffer_load_dwordx4 v5, s[8:11], s23 offen offset:3072 lds
v_pk_mul_f32 v[246:247], v[246:247], s[4:5]
v_cvt_pk_bf16_f32 v240, v240, v241
M a[24:27], a[144:147], a[184:187], a[24:27]
s_add_u32 s94, s92, 12288
buffer_store_dwordx4 v[136:139], v1, s[16:19], s94 offen offset:1024 sc1
v_cvt_pk_bf16_f32 v241, v242, v243
v_cvt_pk_bf16_f32 v242, v244, v245
M a[24:27], a[148:151], a[188:191], a[24:27]
v_cvt_pk_bf16_f32 v243, v246, v247
v_pk_mul_f32 v[248:249], v[248:249], s[4:5]
v_pk_mul_f32 v[250:251], v[250:251], s[4:5]
M a[28:31], a[156:159], a[188:191], a[28:31]
v_pk_mul_f32 v[252:253], v[252:253], s[4:5]
v_pk_mul_f32 v[254:255], v[254:255], s[4:5]
M a[28:31], a[152:155], a[184:187], a[28:31]
v_cvt_pk_bf16_f32 v248, v248, v249
v_cvt_pk_bf16_f32 v249, v250, v251
v_cvt_pk_bf16_f32 v250, v252, v253
v_cvt_pk_bf16_f32 v251, v254, v255
v_accvgpr_read_b32 v24, a0
v_accvgpr_read_b32 v25, a1
v_accvgpr_read_b32 v26, a2
v_accvgpr_read_b32 v27, a3
v_accvgpr_read_b32 v28, a4
v_accvgpr_read_b32 v29, a5
v_accvgpr_read_b32 v30, a6
v_accvgpr_read_b32 v31, a7
v_pk_mul_f32 v[24:25], v[24:25], s[4:5]
v_pk_mul_f32 v[26:27], v[26:27], s[4:5]
v_pk_mul_f32 v[28:29], v[28:29], s[4:5]
v_pk_mul_f32 v[30:31], v[30:31], s[4:5]
v_cvt_pk_bf16_f32 v36, v24, v25
v_cvt_pk_bf16_f32 v37, v26, v27
v_cvt_pk_bf16_f32 v38, v28, v29
v_cvt_pk_bf16_f32 v39, v30, v31
v_accvgpr_read_b32 v24, a8
v_accvgpr_read_b32 v25, a9
v_accvgpr_read_b32 v26, a10
v_accvgpr_read_b32 v27, a11
v_accvgpr_read_b32 v28, a12
v_accvgpr_read_b32 v29, a13
v_accvgpr_read_b32 v30, a14
v_accvgpr_read_b32 v31, a15
v_pk_mul_f32 v[24:25], v[24:25], s[4:5]
v_pk_mul_f32 v[26:27], v[26:27], s[4:5]
v_pk_mul_f32 v[28:29], v[28:29], s[4:5]
v_pk_mul_f32 v[30:31], v[30:31], s[4:5]
v_cvt_pk_bf16_f32 v44, v24, v25
v_cvt_pk_bf16_f32 v45, v26, v27
v_cvt_pk_bf16_f32 v46, v28, v29
v_cvt_pk_bf16_f32 v47, v30, v31
v_accvgpr_read_b32 v24, a16
v_accvgpr_read_b32 v25, a17
v_accvgpr_read_b32 v26, a18
v_accvgpr_read_b32 v27, a19
v_accvgpr_read_b32 v28, a20
v_accvgpr_read_b32 v29, a21
v_accvgpr_read_b32 v30, a22
v_accvgpr_read_b32 v31, a23
v_pk_mul_f32 v[24:25], v[24:25], s[4:5]
v_pk_mul_f32 v[26:27], v[26:27], s[4:5]
v_pk_mul_f32 v[28:29], v[28:29], s[4:5]
v_pk_mul_f32 v[30:31], v[30:31], s[4:5]
v_cvt_pk_bf16_f32 v52, v24, v25
v_cvt_pk_bf16_f32 v53, v26, v27
v_cvt_pk_bf16_f32 v54, v28, v29
v_cvt_pk_bf16_f32 v55, v30, v31
v_accvgpr_read_b32 v24, a24
v_accvgpr_read_b32 v25, a25
v_accvgpr_read_b32 v26, a26
v_accvgpr_read_b32 v27, a27
v_accvgpr_read_b32 v28, a28
v_accvgpr_read_b32 v29, a29
v_accvgpr_read_b32 v30, a30
v_accvgpr_read_b32 v31, a31
v_pk_mul_f32 v[24:25], v[24:25], s[4:5]
v_pk_mul_f32 v[26:27], v[26:27], s[4:5]
v_pk_mul_f32 v[28:29], v[28:29], s[4:5]
v_pk_mul_f32 v[30:31], v[30:31], s[4:5]
v_cvt_pk_bf16_f32 v60, v24, v25
v_cvt_pk_bf16_f32 v61, v26, v27
v_cvt_pk_bf16_f32 v62, v28, v29
v_cvt_pk_bf16_f32 v63, v30, v31
s_branch Lk1_b
Lk1_spin:
s_add_u32 s40, s40, 1
s_cmp_gt_u32 s40, 1048576
s_cbranch_scc1 Lk1_got
s_sleep 2
buffer_load_dword v126, v119, s[36:39], 0 offen offset:128 sc1
s_waitcnt vmcnt(0)
v_cmp_gt_u32 vcc, 0x80, v126
s_nop 0
s_cbranch_vccnz Lk1_spin
s_branch Lk1_got
Lk1_spinq:
s_add_u32 s40, s40, 1
s_cmp_gt_u32 s40, 1048576
s_cbranch_scc1 Lk1_gotq
s_sleep 2
buffer_load_dword v125, v119, s[36:39], 0 offen offset:0 sc1
s_waitcnt vmcnt(0)
v_cmp_gt_u32 vcc, 0x80, v125
s_nop 0
s_cbranch_vccnz Lk1_spinq
s_branch Lk1_gotq
Lk1_kv:
M v[32:35], a[32:35], a[160:163], 0
s_add_u32 s23, s23, 128
s_cmp_eq_u32 s23, s25
s_cselect_b32 s23, s26, s23
M v[32:35], a[36:39], a[164:167], v[32:35]
ds_read_b128 a[176:179], v10 offset:4096
ds_read_b128 a[180:183], v11 offset:4096
M v[36:39], a[44:47], a[164:167], 0
M v[36:39], a[40:43], a[160:163], v[36:39]
ds_read_b64_tr_b16 a[96:97], v12 offset:32768
ds_read_b64_tr_b16 a[98:99], v12 offset:34816
M v[40:43], a[48:51], a[160:163], 0
M v[40:43], a[52:55], a[164:167], v[40:43]
M v[44:47], a[60:63], a[164:167], 0
s_add_u32 m0, s29, 81920
s_nop 0
buffer_load_dwordx4 v6, s[12:15], s24 offen offset:0 lds
M v[44:47], a[56:59], a[160:163], v[44:47]
ds_read_b64_tr_b16 a[104:105], v13 offset:32768
ds_read_b64_tr_b16 a[106:107], v13 offset:34816
M v[48:51], a[64:67], a[160:163], 0
M v[48:51], a[68:71], a[164:167], v[48:51]
M v[52:55], a[76:79], a[164:167], 0
M v[52:55], a[72:75], a[160:163], v[52:55]
ds_read_b64_tr_b16 a[112:113], v14 offset:32768
ds_read_b64_tr_b16 a[114:115], v14 offset:34816
M v[56:59], a[80:83], a[160:163], 0
M v[56:59], a[84:87], a[164:167], v[56:59]
buffer_load_dwordx4 v7, s[12:15], s24 offen offset:1024 lds
M v[60:63], a[92:95], a[164:167], 0
M v[60:63], a[88:91], a[160:163], v[60:63]
ds_read_b64_tr_b16 a[120:121], v15 offset:32768
ds_read_b64_tr_b16 a[122:123], v15 offset:34816
M v[64:67], a[32:35], a[168:171], 0
M v[64:67], a[36:39], a[172:175], v[64:67]
ds_read_b128 a[184:187], v10 offset:6144
ds_read_b128 a[188:191], v11 offset:6144
M v[68:71], a[44:47], a[172:175], 0
M v[68:71], a[40:43], a[168:171], v[68:71]
ds_read_b64_tr_b16 a[128:129], v16 offset:32768
ds_read_b64_tr_b16 a[130:131], v16 offset:34816
M v[72:75], a[48:51], a[168:171], 0
buffer_load_dwordx4 v8, s[12:15], s24 offen offset:2048 lds
M v[72:75], a[52:55], a[172:175], v[72:75]
M v[76:79], a[60:63], a[172:175], 0
M v[76:79], a[56:59], a[168:171], v[76:79]
ds_read_b64_tr_b16 a[136:137], v17 offset:32768
ds_read_b64_tr_b16 a[138:139], v17 offset:34816
M v[80:83], a[64:67], a[168:171], 0
M v[80:83], a[68:71], a[172:175], v[80:83]
M v[84:87], a[76:79], a[172:175], 0
buffer_load_dwordx4 v9, s[12:15], s24 offen offset:3072 lds
M v[84:87], a[72:75], a[168:171], v[84:87]
ds_read_b64_tr_b16 a[144:145], v18 offset:32768
ds_read_b64_tr_b16 a[146:147], v18 offset:34816
M v[88:91], a[80:83], a[168:171], 0
M v[88:91], a[84:87], a[172:175], v[88:91]
M v[92:95], a[92:95], a[172:175], 0
M v[92:95], a[88:91], a[168:171], v[92:95]
s_waitcnt lgkmcnt(15)
ds_read_b64_tr_b16 a[152:153], v19 offset:32768
ds_read_b64_tr_b16 a[154:155], v19 offset:34816
M v[96:99], a[32:35], a[176:179], 0
s_add_u32 s24, s24, 262144
s_cmp_eq_u32 s24, s27
s_cselect_b32 s24, s28, s24
s_sub_u32 s6, s6, 1
s_cmp_eq_u32 s6, 0
s_cselect_b64 s[12:13], s[64:65], s[12:13]
M v[96:99], a[36:39], a[180:183], v[96:99]
M v[100:103], a[44:47], a[180:183], 0
M v[100:103], a[40:43], a[176:179], v[100:103]
M v[104:107], a[48:51], a[176:179], 0
M v[104:107], a[52:55], a[180:183], v[104:107]
M v[108:111], a[60:63], a[180:183], 0
M v[108:111], a[56:59], a[176:179], v[108:111]
s_waitcnt vmcnt(21) lgkmcnt(0)
s_barrier
ds_read_b128 a[160:163], v10 offset:16384
ds_read_b128 a[164:167], v11 offset:16384
M v[112:115], a[64:67], a[176:179], 0
s_add_u32 m0, s29, 0
s_nop 0
buffer_load_dwordx4 v2, s[8:11], s23 offen offset:0 lds
M v[112:115], a[68:71], a[180:183], v[112:115]
M v[116:119], a[76:79], a[180:183], 0
M v[116:119], a[72:75], a[176:179], v[116:119]
ds_read_b64_tr_b16 a[100:101], v12 offset:49152
ds_read_b64_tr_b16 a[102:103], v12 offset:51200
M v[120:123], a[80:83], a[176:179], 0
M v[120:123], a[84:87], a[180:183], v[120:123]
M v[124:127], a[92:95], a[180:183], 0
buffer_load_dwordx4 v3, s[8:11], s23 offen offset:1024 lds
M v[124:127], a[88:91], a[176:179], v[124:127]
M v[128:131], a[32:35], a[184:187], 0
M v[128:131], a[36:39], a[188:191], v[128:131]
ds_read_b128 a[168:171], v10 offset:18432
ds_read_b128 a[172:175], v11 offset:18432
ds_read_b64_tr_b16 a[108:109], v13 offset:49152
ds_read_b64_tr_b16 a[110:111], v13 offset:51200
M v[132:135], a[44:47], a[188:191], 0
M v[132:135], a[40:43], a[184:187], v[132:135]
M v[136:139], a[48:51], a[184:187], 0
M v[136:139], a[52:55], a[188:191], v[136:139]
buffer_load_dwordx4 v4, s[8:11], s23 offen offset:2048 lds
M v[140:143], a[60:63], a[188:191], 0
M v[140:143], a[56:59], a[184:187], v[140:143]
ds_read_b64_tr_b16 a[116:117], v14 offset:49152
ds_read_b64_tr_b16 a[118:119], v14 offset:51200
M v[144:147], a[64:67], a[184:187], 0
M v[144:147], a[68:71], a[188:191], v[144:147]
M v[148:151], a[76:79], a[188:191], 0
M v[148:151], a[72:75], a[184:187], v[148:151]
M v[152:155], a[80:83], a[184:187], 0
buffer_load_dwordx4 v5, s[8:11], s23 offen offset:3072 lds
M v[152:155], a[84:87], a[188:191], v[152:155]
ds_read_b64_tr_b16 a[124:125], v15 offset:49152
ds_read_b64_tr_b16 a[126:127], v15 offset:51200
M v[156:159], a[92:95], a[188:191], 0
M v[156:159], a[88:91], a[184:187], v[156:159]
s_waitcnt lgkmcnt(10)
M v[160:163], a[32:35], a[160:163], 0
M v[160:163], a[36:39], a[164:167], v[160:163]
ds_read_b128 a[176:179], v10 offset:20480
ds_read_b128 a[180:183], v11 offset:20480
M v[164:167], a[44:47], a[164:167], 0
M v[164:167], a[40:43], a[160:163], v[164:167]
ds_read_b64_tr_b16 a[132:133], v16 offset:49152
ds_read_b64_tr_b16 a[134:135], v16 offset:51200
M v[168:171], a[48:51], a[160:163], 0
M v[168:171], a[52:55], a[164:167], v[168:171]
s_add_u32 m0, s29, 98304
s_nop 0
buffer_load_dwordx4 v6, s[12:15], s24 offen offset:0 lds
M v[172:175], a[60:63], a[164:167], 0
M v[172:175], a[56:59], a[160:163], v[172:175]
M v[176:179], a[64:67], a[160:163], 0
M v[176:179], a[68:71], a[164:167], v[176:179]
ds_read_b64_tr_b16 a[140:141], v17 offset:49152
ds_read_b64_tr_b16 a[142:143], v17 offset:51200
M v[180:183], a[76:79], a[164:167], 0
M v[180:183], a[72:75], a[160:163], v[180:183]
buffer_load_dwordx4 v7, s[12:15], s24 offen offset:1024 lds
M v[184:187], a[80:83], a[160:163], 0
M v[184:187], a[84:87], a[164:167], v[184:187]
M v[188:191], a[92:95], a[164:167], 0
M v[188:191], a[88:91], a[160:163], v[188:191]
s_waitcnt lgkmcnt(12)
ds_read_b64_tr_b16 a[148:149], v18 offset:49152
ds_read_b64_tr_b16 a[150:151], v18 offset:51200
M v[192:195], a[32:35], a[168:171], 0
M v[192:195], a[36:39], a[172:175], v[192:195]
ds_read_b128 a[184:187], v10 offset:22528
ds_read_b128 a[188:191], v11 offset:22528
M v[196:199], a[44:47], a[172:175], 0
M v[196:199], a[40:43], a[168:171], v[196:199]
buffer_load_dwordx4 v8, s[12:15], s24 offen offset:2048 lds
M v[200:203], a[48:51], a[168:171], 0
M v[200:203], a[52:55], a[172:175], v[200:203]
ds_read_b64_tr_b16 a[156:157], v19 offset:49152
ds_read_b64_tr_b16 a[158:159], v19 offset:51200
M v[204:207], a[60:63], a[172:175], 0
M v[204:207], a[56:59], a[168:171], v[204:207]
M v[208:211], a[64:67], a[168:171], 0
M v[208:211], a[68:71], a[172:175], v[208:211]
buffer_load_dwordx4 v9, s[12:15], s24 offen offset:3072 lds
M v[212:215], a[76:79], a[172:175], 0
M v[212:215], a[72:75], a[168:171], v[212:215]
M v[216:219], a[80:83], a[168:171], 0
M v[216:219], a[84:87], a[172:175], v[216:219]
M v[220:223], a[92:95], a[172:175], 0
s_add_u32 s24, s24, 262144
M v[220:223], a[88:91], a[168:171], v[220:223]
s_waitcnt lgkmcnt(10)
M v[224:227], a[32:35], a[176:179], 0
M v[224:227], a[36:39], a[180:183], v[224:227]
M v[228:231], a[44:47], a[180:183], 0
M v[228:231], a[40:43], a[176:179], v[228:231]
M v[232:235], a[48:51], a[176:179], 0
M v[232:235], a[52:55], a[180:183], v[232:235]
M v[236:239], a[60:63], a[180:183], 0
M v[236:239], a[56:59], a[176:179], v[236:239]
s_waitcnt vmcnt(16) lgkmcnt(0)
s_barrier
ds_read_b128 a[160:163], v10 offset:32768
ds_read_b128 a[164:167], v11 offset:32768
M v[240:243], a[64:67], a[176:179], 0
s_add_u32 m0, s29, 16384
s_add_u32 s3, s23, s31
buffer_load_dwordx4 v2, s[8:11], s3 offen offset:0 lds
M v[240:243], a[68:71], a[180:183], v[240:243]
M v[244:247], a[76:79], a[180:183], 0
M v[244:247], a[72:75], a[176:179], v[244:247]
M v[248:251], a[80:83], a[176:179], 0
M v[248:251], a[84:87], a[180:183], v[248:251]
buffer_load_dwordx4 v3, s[8:11], s3 offen offset:1024 lds
M v[252:255], a[92:95], a[180:183], 0
M v[252:255], a[88:91], a[176:179], v[252:255]
M a[0:3], a[32:35], a[184:187], 0
M a[0:3], a[36:39], a[188:191], a[0:3]
ds_read_b128 a[168:171], v10 offset:34816
ds_read_b128 a[172:175], v11 offset:34816
M a[4:7], a[44:47], a[188:191], 0
M a[4:7], a[40:43], a[184:187], a[4:7]
M a[8:11], a[48:51], a[184:187], 0
buffer_load_dwordx4 v4, s[8:11], s3 offen offset:2048 lds
M a[8:11], a[52:55], a[188:191], a[8:11]
M a[12:15], a[60:63], a[188:191], 0
M a[12:15], a[56:59], a[184:187], a[12:15]
M a[16:19], a[64:67], a[184:187], 0
M a[16:19], a[68:71], a[188:191], a[16:19]
buffer_load_dwordx4 v5, s[8:11], s3 offen offset:3072 lds
M a[20:23], a[76:79], a[188:191], 0
M a[20:23], a[72:75], a[184:187], a[20:23]
M a[24:27], a[80:83], a[184:187], 0
M a[24:27], a[84:87], a[188:191], a[24:27]
M a[28:31], a[92:95], a[188:191], 0
M a[28:31], a[88:91], a[184:187], a[28:31]
s_waitcnt lgkmcnt(2)
M v[32:35], a[96:99], a[160:163], v[32:35]
s_add_u32 s23, s23, 128
s_cmp_eq_u32 s23, s25
s_cselect_b32 s23, s26, s23
M v[32:35], a[100:103], a[164:167], v[32:35]
ds_read_b128 a[176:179], v10 offset:36864
ds_read_b128 a[180:183], v11 offset:36864
M v[36:39], a[108:111], a[164:167], v[36:39]
M v[36:39], a[104:107], a[160:163], v[36:39]
ds_read_b64_tr_b16 a[32:33], v12 offset:0
ds_read_b64_tr_b16 a[34:35], v12 offset:2048
M v[40:43], a[112:115], a[160:163], v[40:43]
M v[40:43], a[116:119], a[164:167], v[40:43]
M v[44:47], a[124:127], a[164:167], v[44:47]
s_add_u32 m0, s29, 114688
s_nop 0
buffer_load_dwordx4 v6, s[12:15], s24 offen offset:0 lds
M v[44:47], a[120:123], a[160:163], v[44:47]
ds_read_b64_tr_b16 a[40:41], v13 offset:0
ds_read_b64_tr_b16 a[42:43], v13 offset:2048
M v[48:51], a[128:131], a[160:163], v[48:51]
M v[48:51], a[132:135], a[164:167], v[48:51]
M v[52:55], a[140:143], a[164:167], v[52:55]
M v[52:55], a[136:139], a[160:163], v[52:55]
ds_read_b64_tr_b16 a[48:49], v14 offset:0
ds_read_b64_tr_b16 a[50:51], v14 offset:2048
M v[56:59], a[144:147], a[160:163], v[56:59]
M v[56:59], a[148:151], a[164:167], v[56:59]
buffer_load_dwordx4 v7, s[12:15], s24 offen offset:1024 lds
M v[60:63], a[156:159], a[164:167], v[60:63]
M v[60:63], a[152:155], a[160:163], v[60:63]
s_waitcnt lgkmcnt(8)
ds_read_b64_tr_b16 a[56:57], v15 offset:0
ds_read_b64_tr_b16 a[58:59], v15 offset:2048
M v[64:67], a[96:99], a[168:171], v[64:67]
M v[64:67], a[100:103], a[172:175], v[64:67]
ds_read_b128 a[184:187], v10 offset:38912
ds_read_b128 a[188:191], v11 offset:38912
M v[68:71], a[108:111], a[172:175], v[68:71]
M v[68:71], a[104:107], a[168:171], v[68:71]
ds_read_b64_tr_b16 a[64:65], v16 offset:0
ds_read_b64_tr_b16 a[66:67], v16 offset:2048
M v[72:75], a[112:115], a[168:171], v[72:75]
buffer_load_dwordx4 v8, s[12:15], s24 offen offset:2048 lds
M v[72:75], a[116:119], a[172:175], v[72:75]
M v[76:79], a[124:127], a[172:175], v[76:79]
M v[76:79], a[120:123], a[168:171], v[76:79]
ds_read_b64_tr_b16 a[72:73], v17 offset:0
ds_read_b64_tr_b16 a[74:75], v17 offset:2048
M v[80:83], a[128:131], a[168:171], v[80:83]
M v[80:83], a[132:135], a[172:175], v[80:83]
M v[84:87], a[140:143], a[172:175], v[84:87]
buffer_load_dwordx4 v9, s[12:15], s24 offen offset:3072 lds
M v[84:87], a[136:139], a[168:171], v[84:87]
ds_read_b64_tr_b16 a[80:81], v18 offset:0
ds_read_b64_tr_b16 a[82:83], v18 offset:2048
M v[88:91], a[144:147], a[168:171], v[88:91]
M v[88:91], a[148:151], a[172:175], v[88:91]
M v[92:95], a[156:159], a[172:175], v[92:95]
M v[92:95], a[152:155], a[168:171], v[92:95]
s_waitcnt lgkmcnt(15)
ds_read_b64_tr_b16 a[88:89], v19 offset:0
ds_read_b64_tr_b16 a[90:91], v19 offset:2048
M v[96:99], a[96:99], a[176:179], v[96:99]
s_add_u32 s24, s24, 262144
s_cmp_eq_u32 s24, s27
s_cselect_b32 s24, s28, s24
s_sub_u32 s6, s6, 1
s_cmp_eq_u32 s6, 0
s_cselect_b64 s[12:13], s[64:65], s[12:13]
M v[96:99], a[100:103], a[180:183], v[96:99]
M v[100:103], a[108:111], a[180:183], v[100:103]
M v[100:103], a[104:107], a[176:179], v[100:103]
M v[104:107], a[112:115], a[176:179], v[104:107]
M v[104:107], a[116:119], a[180:183], v[104:107]
M v[108:111], a[124:127], a[180:183], v[108:111]
M v[108:111], a[120:123], a[176:179], v[108:111]
s_waitcnt vmcnt(16) lgkmcnt(0)
s_barrier
ds_read_b128 a[160:163], v10 offset:49152
ds_read_b128 a[164:167], v11 offset:49152
M v[112:115], a[128:131], a[176:179], v[112:115]
s_add_u32 m0, s29, 32768
s_nop 0
buffer_load_dwordx4 v2, s[8:11], s23 offen offset:0 lds
M v[112:115], a[132:135], a[180:183], v[112:115]
M v[116:119], a[140:143], a[180:183], v[116:119]
M v[116:119], a[136:139], a[176:179], v[116:119]
ds_read_b64_tr_b16 a[36:37], v12 offset:16384
ds_read_b64_tr_b16 a[38:39], v12 offset:18432
M v[120:123], a[144:147], a[176:179], v[120:123]
M v[120:123], a[148:151], a[180:183], v[120:123]
M v[124:127], a[156:159], a[180:183], v[124:127]
buffer_load_dwordx4 v3, s[8:11], s23 offen offset:1024 lds
M v[124:127], a[152:155], a[176:179], v[124:127]
M v[128:131], a[96:99], a[184:187], v[128:131]
M v[128:131], a[100:103], a[188:191], v[128:131]
ds_read_b128 a[168:171], v10 offset:51200
ds_read_b128 a[172:175], v11 offset:51200
ds_read_b64_tr_b16 a[44:45], v13 offset:16384
ds_read_b64_tr_b16 a[46:47], v13 offset:18432
M v[132:135], a[108:111], a[188:191], v[132:135]
M v[132:135], a[104:107], a[184:187], v[132:135]
M v[136:139], a[112:115], a[184:187], v[136:139]
M v[136:139], a[116:119], a[188:191], v[136:139]
buffer_load_dwordx4 v4, s[8:11], s23 offen offset:2048 lds
M v[140:143], a[124:127], a[188:191], v[140:143]
M v[140:143], a[120:123], a[184:187], v[140:143]
ds_read_b64_tr_b16 a[52:53], v14 offset:16384
ds_read_b64_tr_b16 a[54:55], v14 offset:18432
M v[144:147], a[128:131], a[184:187], v[144:147]
M v[144:147], a[132:135], a[188:191], v[144:147]
M v[148:151], a[140:143], a[188:191], v[148:151]
M v[148:151], a[136:139], a[184:187], v[148:151]
M v[152:155], a[144:147], a[184:187], v[152:155]
buffer_load_dwordx4 v5, s[8:11], s23 offen offset:3072 lds
M v[152:155], a[148:151], a[188:191], v[152:155]
ds_read_b64_tr_b16 a[60:61], v15 offset:16384
ds_read_b64_tr_b16 a[62:63], v15 offset:18432
M v[156:159], a[156:159], a[188:191], v[156:159]
M v[156:159], a[152:155], a[184:187], v[156:159]
s_waitcnt lgkmcnt(10)
M v[160:163], a[96:99], a[160:163], v[160:163]
M v[160:163], a[100:103], a[164:167], v[160:163]
ds_read_b128 a[176:179], v10 offset:53248
ds_read_b128 a[180:183], v11 offset:53248
M v[164:167], a[108:111], a[164:167], v[164:167]
M v[164:167], a[104:107], a[160:163], v[164:167]
ds_read_b64_tr_b16 a[68:69], v16 offset:16384
ds_read_b64_tr_b16 a[70:71], v16 offset:18432
M v[168:171], a[112:115], a[160:163], v[168:171]
M v[168:171], a[116:119], a[164:167], v[168:171]
s_add_u32 m0, s29, 65536
s_nop 0
buffer_load_dwordx4 v6, s[12:15], s24 offen offset:0 lds
M v[172:175], a[124:127], a[164:167], v[172:175]
M v[172:175], a[120:123], a[160:163], v[172:175]
M v[176:179], a[128:131], a[160:163], v[176:179]
M v[176:179], a[132:135], a[164:167], v[176:179]
ds_read_b64_tr_b16 a[76:77], v17 offset:16384
ds_read_b64_tr_b16 a[78:79], v17 offset:18432
M v[180:183], a[140:143], a[164:167], v[180:183]
M v[180:183], a[136:139], a[160:163], v[180:183]
buffer_load_dwordx4 v7, s[12:15], s24 offen offset:1024 lds
M v[184:187], a[144:147], a[160:163], v[184:187]
M v[184:187], a[148:151], a[164:167], v[184:187]
M v[188:191], a[156:159], a[164:167], v[188:191]
M v[188:191], a[152:155], a[160:163], v[188:191]
s_waitcnt lgkmcnt(12)
ds_read_b64_tr_b16 a[84:85], v18 offset:16384
ds_read_b64_tr_b16 a[86:87], v18 offset:18432
M v[192:195], a[96:99], a[168:171], v[192:195]
M v[192:195], a[100:103], a[172:175], v[192:195]
ds_read_b128 a[184:187], v10 offset:55296
ds_read_b128 a[188:191], v11 offset:55296
M v[196:199], a[108:111], a[172:175], v[196:199]
M v[196:199], a[104:107], a[168:171], v[196:199]
buffer_load_dwordx4 v8, s[12:15], s24 offen offset:2048 lds
M v[200:203], a[112:115], a[168:171], v[200:203]
M v[200:203], a[116:119], a[172:175], v[200:203]
ds_read_b64_tr_b16 a[92:93], v19 offset:16384
ds_read_b64_tr_b16 a[94:95], v19 offset:18432
M v[204:207], a[124:127], a[172:175], v[204:207]
M v[204:207], a[120:123], a[168:171], v[204:207]
M v[208:211], a[128:131], a[168:171], v[208:211]
M v[208:211], a[132:135], a[172:175], v[208:211]
buffer_load_dwordx4 v9, s[12:15], s24 offen offset:3072 lds
M v[212:215], a[140:143], a[172:175], v[212:215]
M v[212:215], a[136:139], a[168:171], v[212:215]
M v[216:219], a[144:147], a[168:171], v[216:219]
M v[216:219], a[148:151], a[172:175], v[216:219]
M v[220:223], a[156:159], a[172:175], v[220:223]
s_add_u32 s24, s24, 262144
M v[220:223], a[152:155], a[168:171], v[220:223]
s_waitcnt lgkmcnt(10)
M v[224:227], a[96:99], a[176:179], v[224:227]
M v[224:227], a[100:103], a[180:183], v[224:227]
M v[228:231], a[108:111], a[180:183], v[228:231]
M v[228:231], a[104:107], a[176:179], v[228:231]
M v[232:235], a[112:115], a[176:179], v[232:235]
M v[232:235], a[116:119], a[180:183], v[232:235]
M v[236:239], a[124:127], a[180:183], v[236:239]
M v[236:239], a[120:123], a[176:179], v[236:239]
s_waitcnt vmcnt(16) lgkmcnt(0)
s_barrier
ds_read_b128 a[160:163], v10 offset:0
ds_read_b128 a[164:167], v11 offset:0
M v[240:243], a[128:131], a[176:179], v[240:243]
s_add_u32 m0, s29, 49152
s_add_u32 s3, s23, s31
buffer_load_dwordx4 v2, s[8:11], s3 offen offset:0 lds
M v[240:243], a[132:135], a[180:183], v[240:243]
M v[244:247], a[140:143], a[180:183], v[244:247]
M v[244:247], a[136:139], a[176:179], v[244:247]
M v[248:251], a[144:147], a[176:179], v[248:251]
M v[248:251], a[148:151], a[180:183], v[248:251]
buffer_load_dwordx4 v3, s[8:11], s3 offen offset:1024 lds
M v[252:255], a[156:159], a[180:183], v[252:255]
M v[252:255], a[152:155], a[176:179], v[252:255]
M a[0:3], a[96:99], a[184:187], a[0:3]
M a[0:3], a[100:103], a[188:191], a[0:3]
ds_read_b128 a[168:171], v10 offset:2048
ds_read_b128 a[172:175], v11 offset:2048
M a[4:7], a[108:111], a[188:191], a[4:7]
M a[4:7], a[104:107], a[184:187], a[4:7]
M a[8:11], a[112:115], a[184:187], a[8:11]
buffer_load_dwordx4 v4, s[8:11], s3 offen offset:2048 lds
M a[8:11], a[116:119], a[188:191], a[8:11]
M a[12:15], a[124:127], a[188:191], a[12:15]
M a[12:15], a[120:123], a[184:187], a[12:15]
M a[16:19], a[128:131], a[184:187], a[16:19]
M a[16:19], a[132:135], a[188:191], a[16:19]
buffer_load_dwordx4 v5, s[8:11], s3 offen offset:3072 lds
M a[20:23], a[140:143], a[188:191], a[20:23]
M a[20:23], a[136:139], a[184:187], a[20:23]
M a[24:27], a[144:147], a[184:187], a[24:27]
M a[24:27], a[148:151], a[188:191], a[24:27]
M a[28:31], a[156:159], a[188:191], a[28:31]
M a[28:31], a[152:155], a[184:187], a[28:31]
s_waitcnt lgkmcnt(2)
s_mov_b32 s30, 2
Lk1_kl:
M v[32:35], a[32:35], a[160:163], v[32:35]
s_add_u32 s23, s23, 128
s_cmp_eq_u32 s23, s25
s_cselect_b32 s23, s26, s23
M v[32:35], a[36:39], a[164:167], v[32:35]
ds_read_b128 a[176:179], v10 offset:4096
ds_read_b128 a[180:183], v11 offset:4096
M v[36:39], a[44:47], a[164:167], v[36:39]
M v[36:39], a[40:43], a[160:163], v[36:39]
ds_read_b64_tr_b16 a[96:97], v12 offset:32768
ds_read_b64_tr_b16 a[98:99], v12 offset:34816
M v[40:43], a[48:51], a[160:163], v[40:43]
M v[40:43], a[52:55], a[164:167], v[40:43]
M v[44:47], a[60:63], a[164:167], v[44:47]
s_add_u32 m0, s29, 81920
s_nop 0
buffer_load_dwordx4 v6, s[12:15], s24 offen offset:0 lds
M v[44:47], a[56:59], a[160:163], v[44:47]
ds_read_b64_tr_b16 a[104:105], v13 offset:32768
ds_read_b64_tr_b16 a[106:107], v13 offset:34816
M v[48:51], a[64:67], a[160:163], v[48:51]
M v[48:51], a[68:71], a[164:167], v[48:51]
M v[52:55], a[76:79], a[164:167], v[52:55]
M v[52:55], a[72:75], a[160:163], v[52:55]
ds_read_b64_tr_b16 a[112:113], v14 offset:32768
ds_read_b64_tr_b16 a[114:115], v14 offset:34816
M v[56:59], a[80:83], a[160:163], v[56:59]
M v[56:59], a[84:87], a[164:167], v[56:59]
buffer_load_dwordx4 v7, s[12:15], s24 offen offset:1024 lds
M v[60:63], a[92:95], a[164:167], v[60:63]
M v[60:63], a[88:91], a[160:163], v[60:63]
s_waitcnt lgkmcnt(8)
ds_read_b64_tr_b16 a[120:121], v15 offset:32768
ds_read_b64_tr_b16 a[122:123], v15 offset:34816
M v[64:67], a[32:35], a[168:171], v[64:67]
M v[64:67], a[36:39], a[172:175], v[64:67]
ds_read_b128 a[184:187], v10 offset:6144
ds_read_b128 a[188:191], v11 offset:6144
M v[68:71], a[44:47], a[172:175], v[68:71]
M v[68:71], a[40:43], a[168:171], v[68:71]
ds_read_b64_tr_b16 a[128:129], v16 offset:32768
ds_read_b64_tr_b16 a[130:131], v16 offset:34816
M v[72:75], a[48:51], a[168:171], v[72:75]
buffer_load_dwordx4 v8, s[12:15], s24 offen offset:2048 lds
M v[72:75], a[52:55], a[172:175], v[72:75]
M v[76:79], a[60:63], a[172:175], v[76:79]
M v[76:79], a[56:59], a[168:171], v[76:79]
ds_read_b64_tr_b16 a[136:137], v17 offset:32768
ds_read_b64_tr_b16 a[138:139], v17 offset:34816
M v[80:83], a[64:67], a[168:171], v[80:83]
M v[80:83], a[68:71], a[172:175], v[80:83]
M v[84:87], a[76:79], a[172:175], v[84:87]
buffer_load_dwordx4 v9, s[12:15], s24 offen offset:3072 lds
M v[84:87], a[72:75], a[168:171], v[84:87]
ds_read_b64_tr_b16 a[144:145], v18 offset:32768
ds_read_b64_tr_b16 a[146:147], v18 offset:34816
M v[88:91], a[80:83], a[168:171], v[88:91]
M v[88:91], a[84:87], a[172:175], v[88:91]
M v[92:95], a[92:95], a[172:175], v[92:95]
M v[92:95], a[88:91], a[168:171], v[92:95]
s_waitcnt lgkmcnt(15)
ds_read_b64_tr_b16 a[152:153], v19 offset:32768
ds_read_b64_tr_b16 a[154:155], v19 offset:34816
M v[96:99], a[32:35], a[176:179], v[96:99]
s_add_u32 s24, s24, 262144
s_cmp_eq_u32 s24, s27
s_cselect_b32 s24, s28, s24
s_sub_u32 s6, s6, 1
s_cmp_eq_u32 s6, 0
s_cselect_b64 s[12:13], s[64:65], s[12:13]
M v[96:99], a[36:39], a[180:183], v[96:99]
M v[100:103], a[44:47], a[180:183], v[100:103]
M v[100:103], a[40:43], a[176:179], v[100:103]
M v[104:107], a[48:51], a[176:179], v[104:107]
M v[104:107], a[52:55], a[180:183], v[104:107]
M v[108:111], a[60:63], a[180:183], v[108:111]
M v[108:111], a[56:59], a[176:179], v[108:111]
s_waitcnt vmcnt(16) lgkmcnt(0)
s_barrier
ds_read_b128 a[160:163], v10 offset:16384
ds_read_b128 a[164:167], v11 offset:16384
M v[112:115], a[64:67], a[176:179], v[112:115]
s_add_u32 m0, s29, 0
s_nop 0
buffer_load_dwordx4 v2, s[8:11], s23 offen offset:0 lds
M v[112:115], a[68:71], a[180:183], v[112:115]
M v[116:119], a[76:79], a[180:183], v[116:119]
M v[116:119], a[72:75], a[176:179], v[116:119]
ds_read_b64_tr_b16 a[100:101], v12 offset:49152
ds_read_b64_tr_b16 a[102:103], v12 offset:51200
M v[120:123], a[80:83], a[176:179], v[120:123]
M v[120:123], a[84:87], a[180:183], v[120:123]
M v[124:127], a[92:95], a[180:183], v[124:127]
buffer_load_dwordx4 v3, s[8:11], s23 offen offset:1024 lds
M v[124:127], a[88:91], a[176:179], v[124:127]
M v[128:131], a[32:35], a[184:187], v[128:131]
M v[128:131], a[36:39], a[188:191], v[128:131]
ds_read_b128 a[168:171], v10 offset:18432
ds_read_b128 a[172:175], v11 offset:18432
ds_read_b64_tr_b16 a[108:109], v13 offset:49152
ds_read_b64_tr_b16 a[110:111], v13 offset:51200
M v[132:135], a[44:47], a[188:191], v[132:135]
M v[132:135], a[40:43], a[184:187], v[132:135]
M v[136:139], a[48:51], a[184:187], v[136:139]
M v[136:139], a[52:55], a[188:191], v[136:139]
buffer_load_dwordx4 v4, s[8:11], s23 offen offset:2048 lds
M v[140:143], a[60:63], a[188:191], v[140:143]
M v[140:143], a[56:59], a[184:187], v[140:143]
ds_read_b64_tr_b16 a[116:117], v14 offset:49152
ds_read_b64_tr_b16 a[118:119], v14 offset:51200
M v[144:147], a[64:67], a[184:187], v[144:147]
M v[144:147], a[68:71], a[188:191], v[144:147]
M v[148:151], a[76:79], a[188:191], v[148:151]
M v[148:151], a[72:75], a[184:187], v[148:151]
M v[152:155], a[80:83], a[184:187], v[152:155]
buffer_load_dwordx4 v5, s[8:11], s23 offen offset:3072 lds
M v[152:155], a[84:87], a[188:191], v[152:155]
ds_read_b64_tr_b16 a[124:125], v15 offset:49152
ds_read_b64_tr_b16 a[126:127], v15 offset:51200
M v[156:159], a[92:95], a[188:191], v[156:159]
M v[156:159], a[88:91], a[184:187], v[156:159]
s_waitcnt lgkmcnt(10)
M v[160:163], a[32:35], a[160:163], v[160:163]
M v[160:163], a[36:39], a[164:167], v[160:163]
ds_read_b128 a[176:179], v10 offset:20480
ds_read_b128 a[180:183], v11 offset:20480
M v[164:167], a[44:47], a[164:167], v[164:167]
M v[164:167], a[40:43], a[160:163], v[164:167]
ds_read_b64_tr_b16 a[132:133], v16 offset:49152
ds_read_b64_tr_b16 a[134:135], v16 offset:51200
M v[168:171], a[48:51], a[160:163], v[168:171]
M v[168:171], a[52:55], a[164:167], v[168:171]
s_add_u32 m0, s29, 98304
s_nop 0
buffer_load_dwordx4 v6, s[12:15], s24 offen offset:0 lds
M v[172:175], a[60:63], a[164:167], v[172:175]
M v[172:175], a[56:59], a[160:163], v[172:175]
M v[176:179], a[64:67], a[160:163], v[176:179]
M v[176:179], a[68:71], a[164:167], v[176:179]
ds_read_b64_tr_b16 a[140:141], v17 offset:49152
ds_read_b64_tr_b16 a[142:143], v17 offset:51200
M v[180:183], a[76:79], a[164:167], v[180:183]
M v[180:183], a[72:75], a[160:163], v[180:183]
buffer_load_dwordx4 v7, s[12:15], s24 offen offset:1024 lds
M v[184:187], a[80:83], a[160:163], v[184:187]
M v[184:187], a[84:87], a[164:167], v[184:187]
M v[188:191], a[92:95], a[164:167], v[188:191]
M v[188:191], a[88:91], a[160:163], v[188:191]
s_waitcnt lgkmcnt(12)
ds_read_b64_tr_b16 a[148:149], v18 offset:49152
ds_read_b64_tr_b16 a[150:151], v18 offset:51200
M v[192:195], a[32:35], a[168:171], v[192:195]
M v[192:195], a[36:39], a[172:175], v[192:195]
ds_read_b128 a[184:187], v10 offset:22528
ds_read_b128 a[188:191], v11 offset:22528
M v[196:199], a[44:47], a[172:175], v[196:199]
M v[196:199], a[40:43], a[168:171], v[196:199]
buffer_load_dwordx4 v8, s[12:15], s24 offen offset:2048 lds
M v[200:203], a[48:51], a[168:171], v[200:203]
M v[200:203], a[52:55], a[172:175], v[200:203]
ds_read_b64_tr_b16 a[156:157], v19 offset:49152
ds_read_b64_tr_b16 a[158:159], v19 offset:51200
M v[204:207], a[60:63], a[172:175], v[204:207]
M v[204:207], a[56:59], a[168:171], v[204:207]
M v[208:211], a[64:67], a[168:171], v[208:211]
M v[208:211], a[68:71], a[172:175], v[208:211]
buffer_load_dwordx4 v9, s[12:15], s24 offen offset:3072 lds
M v[212:215], a[76:79], a[172:175], v[212:215]
M v[212:215], a[72:75], a[168:171], v[212:215]
M v[216:219], a[80:83], a[168:171], v[216:219]
M v[216:219], a[84:87], a[172:175], v[216:219]
M v[220:223], a[92:95], a[172:175], v[220:223]
s_add_u32 s24, s24, 262144
M v[220:223], a[88:91], a[168:171], v[220:223]
s_waitcnt lgkmcnt(10)
M v[224:227], a[32:35], a[176:179], v[224:227]
M v[224:227], a[36:39], a[180:183], v[224:227]
M v[228:231], a[44:47], a[180:183], v[228:231]
M v[228:231], a[40:43], a[176:179], v[228:231]
M v[232:235], a[48:51], a[176:179], v[232:235]
M v[232:235], a[52:55], a[180:183], v[232:235]
M v[236:239], a[60:63], a[180:183], v[236:239]
M v[236:239], a[56:59], a[176:179], v[236:239]
s_waitcnt vmcnt(16) lgkmcnt(0)
s_barrier
ds_read_b128 a[160:163], v10 offset:32768
ds_read_b128 a[164:167], v11 offset:32768
M v[240:243], a[64:67], a[176:179], v[240:243]
s_add_u32 m0, s29, 16384
s_add_u32 s3, s23, s31
buffer_load_dwordx4 v2, s[8:11], s3 offen offset:0 lds
M v[240:243], a[68:71], a[180:183], v[240:243]
M v[244:247], a[76:79], a[180:183], v[244:247]
M v[244:247], a[72:75], a[176:179], v[244:247]
M v[248:251], a[80:83], a[176:179], v[248:251]
M v[248:251], a[84:87], a[180:183], v[248:251]
buffer_load_dwordx4 v3, s[8:11], s3 offen offset:1024 lds
M v[252:255], a[92:95], a[180:183], v[252:255]
M v[252:255], a[88:91], a[176:179], v[252:255]
M a[0:3], a[32:35], a[184:187], a[0:3]
M a[0:3], a[36:39], a[188:191], a[0:3]
ds_read_b128 a[168:171], v10 offset:34816
ds_read_b128 a[172:175], v11 offset:34816
M a[4:7], a[44:47], a[188:191], a[4:7]
M a[4:7], a[40:43], a[184:187], a[4:7]
M a[8:11], a[48:51], a[184:187], a[8:11]
buffer_load_dwordx4 v4, s[8:11], s3 offen offset:2048 lds
M a[8:11], a[52:55], a[188:191], a[8:11]
M a[12:15], a[60:63], a[188:191], a[12:15]
M a[12:15], a[56:59], a[184:187], a[12:15]
M a[16:19], a[64:67], a[184:187], a[16:19]
M a[16:19], a[68:71], a[188:191], a[16:19]
buffer_load_dwordx4 v5, s[8:11], s3 offen offset:3072 lds
M a[20:23], a[76:79], a[188:191], a[20:23]
M a[20:23], a[72:75], a[184:187], a[20:23]
M a[24:27], a[80:83], a[184:187], a[24:27]
M a[24:27], a[84:87], a[188:191], a[24:27]
M a[28:31], a[92:95], a[188:191], a[28:31]
M a[28:31], a[88:91], a[184:187], a[28:31]
s_waitcnt lgkmcnt(2)
M v[32:35], a[96:99], a[160:163], v[32:35]
s_add_u32 s23, s23, 128
s_cmp_eq_u32 s23, s25
s_cselect_b32 s23, s26, s23
M v[32:35], a[100:103], a[164:167], v[32:35]
ds_read_b128 a[176:179], v10 offset:36864
ds_read_b128 a[180:183], v11 offset:36864
M v[36:39], a[108:111], a[164:167], v[36:39]
M v[36:39], a[104:107], a[160:163], v[36:39]
ds_read_b64_tr_b16 a[32:33], v12 offset:0
ds_read_b64_tr_b16 a[34:35], v12 offset:2048
M v[40:43], a[112:115], a[160:163], v[40:43]
M v[40:43], a[116:119], a[164:167], v[40:43]
M v[44:47], a[124:127], a[164:167], v[44:47]
s_add_u32 m0, s29, 114688
s_nop 0
buffer_load_dwordx4 v6, s[12:15], s24 offen offset:0 lds
M v[44:47], a[120:123], a[160:163], v[44:47]
ds_read_b64_tr_b16 a[40:41], v13 offset:0
ds_read_b64_tr_b16 a[42:43], v13 offset:2048
M v[48:51], a[128:131], a[160:163], v[48:51]
M v[48:51], a[132:135], a[164:167], v[48:51]
M v[52:55], a[140:143], a[164:167], v[52:55]
M v[52:55], a[136:139], a[160:163], v[52:55]
ds_read_b64_tr_b16 a[48:49], v14 offset:0
ds_read_b64_tr_b16 a[50:51], v14 offset:2048
M v[56:59], a[144:147], a[160:163], v[56:59]
M v[56:59], a[148:151], a[164:167], v[56:59]
buffer_load_dwordx4 v7, s[12:15], s24 offen offset:1024 lds
M v[60:63], a[156:159], a[164:167], v[60:63]
M v[60:63], a[152:155], a[160:163], v[60:63]
s_waitcnt lgkmcnt(8)
ds_read_b64_tr_b16 a[56:57], v15 offset:0
ds_read_b64_tr_b16 a[58:59], v15 offset:2048
M v[64:67], a[96:99], a[168:171], v[64:67]
M v[64:67], a[100:103], a[172:175], v[64:67]
ds_read_b128 a[184:187], v10 offset:38912
ds_read_b128 a[188:191], v11 offset:38912
M v[68:71], a[108:111], a[172:175], v[68:71]
M v[68:71], a[104:107], a[168:171], v[68:71]
ds_read_b64_tr_b16 a[64:65], v16 offset:0
ds_read_b64_tr_b16 a[66:67], v16 offset:2048
M v[72:75], a[112:115], a[168:171], v[72:75]
buffer_load_dwordx4 v8, s[12:15], s24 offen offset:2048 lds
M v[72:75], a[116:119], a[172:175], v[72:75]
M v[76:79], a[124:127], a[172:175], v[76:79]
M v[76:79], a[120:123], a[168:171], v[76:79]
ds_read_b64_tr_b16 a[72:73], v17 offset:0
ds_read_b64_tr_b16 a[74:75], v17 offset:2048
M v[80:83], a[128:131], a[168:171], v[80:83]
M v[80:83], a[132:135], a[172:175], v[80:83]
M v[84:87], a[140:143], a[172:175], v[84:87]
buffer_load_dwordx4 v9, s[12:15], s24 offen offset:3072 lds
M v[84:87], a[136:139], a[168:171], v[84:87]
ds_read_b64_tr_b16 a[80:81], v18 offset:0
ds_read_b64_tr_b16 a[82:83], v18 offset:2048
M v[88:91], a[144:147], a[168:171], v[88:91]
M v[88:91], a[148:151], a[172:175], v[88:91]
M v[92:95], a[156:159], a[172:175], v[92:95]
M v[92:95], a[152:155], a[168:171], v[92:95]
s_waitcnt lgkmcnt(15)
ds_read_b64_tr_b16 a[88:89], v19 offset:0
ds_read_b64_tr_b16 a[90:91], v19 offset:2048
M v[96:99], a[96:99], a[176:179], v[96:99]
s_add_u32 s24, s24, 262144
s_cmp_eq_u32 s24, s27
s_cselect_b32 s24, s28, s24
s_sub_u32 s6, s6, 1
s_cmp_eq_u32 s6, 0
s_cselect_b64 s[12:13], s[64:65], s[12:13]
M v[96:99], a[100:103], a[180:183], v[96:99]
M v[100:103], a[108:111], a[180:183], v[100:103]
M v[100:103], a[104:107], a[176:179], v[100:103]
M v[104:107], a[112:115], a[176:179], v[104:107]
M v[104:107], a[116:119], a[180:183], v[104:107]
M v[108:111], a[124:127], a[180:183], v[108:111]
M v[108:111], a[120:123], a[176:179], v[108:111]
s_waitcnt vmcnt(16) lgkmcnt(0)
s_barrier
ds_read_b128 a[160:163], v10 offset:49152
ds_read_b128 a[164:167], v11 offset:49152
M v[112:115], a[128:131], a[176:179], v[112:115]
s_add_u32 m0, s29, 32768
s_nop 0
buffer_load_dwordx4 v2, s[8:11], s23 offen offset:0 lds
M v[112:115], a[132:135], a[180:183], v[112:115]
M v[116:119], a[140:143], a[180:183], v[116:119]
M v[116:119], a[136:139], a[176:179], v[116:119]
ds_read_b64_tr_b16 a[36:37], v12 offset:16384
ds_read_b64_tr_b16 a[38:39], v12 offset:18432
M v[120:123], a[144:147], a[176:179], v[120:123]
M v[120:123], a[148:151], a[180:183], v[120:123]
M v[124:127], a[156:159], a[180:183], v[124:127]
buffer_load_dwordx4 v3, s[8:11], s23 offen offset:1024 lds
M v[124:127], a[152:155], a[176:179], v[124:127]
M v[128:131], a[96:99], a[184:187], v[128:131]
M v[128:131], a[100:103], a[188:191], v[128:131]
ds_read_b128 a[168:171], v10 offset:51200
ds_read_b128 a[172:175], v11 offset:51200
ds_read_b64_tr_b16 a[44:45], v13 offset:16384
ds_read_b64_tr_b16 a[46:47], v13 offset:18432
M v[132:135], a[108:111], a[188:191], v[132:135]
M v[132:135], a[104:107], a[184:187], v[132:135]
M v[136:139], a[112:115], a[184:187], v[136:139]
M v[136:139], a[116:119], a[188:191], v[136:139]
buffer_load_dwordx4 v4, s[8:11], s23 offen offset:2048 lds
M v[140:143], a[124:127], a[188:191], v[140:143]
M v[140:143], a[120:123], a[184:187], v[140:143]
ds_read_b64_tr_b16 a[52:53], v14 offset:16384
ds_read_b64_tr_b16 a[54:55], v14 offset:18432
M v[144:147], a[128:131], a[184:187], v[144:147]
M v[144:147], a[132:135], a[188:191], v[144:147]
M v[148:151], a[140:143], a[188:191], v[148:151]
M v[148:151], a[136:139], a[184:187], v[148:151]
M v[152:155], a[144:147], a[184:187], v[152:155]
buffer_load_dwordx4 v5, s[8:11], s23 offen offset:3072 lds
M v[152:155], a[148:151], a[188:191], v[152:155]
ds_read_b64_tr_b16 a[60:61], v15 offset:16384
ds_read_b64_tr_b16 a[62:63], v15 offset:18432
M v[156:159], a[156:159], a[188:191], v[156:159]
M v[156:159], a[152:155], a[184:187], v[156:159]
s_waitcnt lgkmcnt(10)
M v[160:163], a[96:99], a[160:163], v[160:163]
M v[160:163], a[100:103], a[164:167], v[160:163]
ds_read_b128 a[176:179], v10 offset:53248
ds_read_b128 a[180:183], v11 offset:53248
M v[164:167], a[108:111], a[164:167], v[164:167]
M v[164:167], a[104:107], a[160:163], v[164:167]
ds_read_b64_tr_b16 a[68:69], v16 offset:16384
ds_read_b64_tr_b16 a[70:71], v16 offset:18432
M v[168:171], a[112:115], a[160:163], v[168:171]
M v[168:171], a[116:119], a[164:167], v[168:171]
s_add_u32 m0, s29, 65536
s_nop 0
buffer_load_dwordx4 v6, s[12:15], s24 offen offset:0 lds
M v[172:175], a[124:127], a[164:167], v[172:175]
M v[172:175], a[120:123], a[160:163], v[172:175]
M v[176:179], a[128:131], a[160:163], v[176:179]
M v[176:179], a[132:135], a[164:167], v[176:179]
ds_read_b64_tr_b16 a[76:77], v17 offset:16384
ds_read_b64_tr_b16 a[78:79], v17 offset:18432
M v[180:183], a[140:143], a[164:167], v[180:183]
M v[180:183], a[136:139], a[160:163], v[180:183]
buffer_load_dwordx4 v7, s[12:15], s24 offen offset:1024 lds
M v[184:187], a[144:147], a[160:163], v[184:187]
M v[184:187], a[148:151], a[164:167], v[184:187]
M v[188:191], a[156:159], a[164:167], v[188:191]
M v[188:191], a[152:155], a[160:163], v[188:191]
s_waitcnt lgkmcnt(12)
ds_read_b64_tr_b16 a[84:85], v18 offset:16384
ds_read_b64_tr_b16 a[86:87], v18 offset:18432
M v[192:195], a[96:99], a[168:171], v[192:195]
M v[192:195], a[100:103], a[172:175], v[192:195]
ds_read_b128 a[184:187], v10 offset:55296
ds_read_b128 a[188:191], v11 offset:55296
M v[196:199], a[108:111], a[172:175], v[196:199]
M v[196:199], a[104:107], a[168:171], v[196:199]
buffer_load_dwordx4 v8, s[12:15], s24 offen offset:2048 lds
M v[200:203], a[112:115], a[168:171], v[200:203]
M v[200:203], a[116:119], a[172:175], v[200:203]
ds_read_b64_tr_b16 a[92:93], v19 offset:16384
ds_read_b64_tr_b16 a[94:95], v19 offset:18432
M v[204:207], a[124:127], a[172:175], v[204:207]
M v[204:207], a[120:123], a[168:171], v[204:207]
M v[208:211], a[128:131], a[168:171], v[208:211]
M v[208:211], a[132:135], a[172:175], v[208:211]
buffer_load_dwordx4 v9, s[12:15], s24 offen offset:3072 lds
M v[212:215], a[140:143], a[172:175], v[212:215]
M v[212:215], a[136:139], a[168:171], v[212:215]
M v[216:219], a[144:147], a[168:171], v[216:219]
M v[216:219], a[148:151], a[172:175], v[216:219]
M v[220:223], a[156:159], a[172:175], v[220:223]
s_add_u32 s24, s24, 262144
M v[220:223], a[152:155], a[168:171], v[220:223]
s_waitcnt lgkmcnt(10)
M v[224:227], a[96:99], a[176:179], v[224:227]
M v[224:227], a[100:103], a[180:183], v[224:227]
M v[228:231], a[108:111], a[180:183], v[228:231]
M v[228:231], a[104:107], a[176:179], v[228:231]
M v[232:235], a[112:115], a[176:179], v[232:235]
M v[232:235], a[116:119], a[180:183], v[232:235]
M v[236:239], a[124:127], a[180:183], v[236:239]
M v[236:239], a[120:123], a[176:179], v[236:239]
s_waitcnt vmcnt(16) lgkmcnt(0)
s_barrier
ds_read_b128 a[160:163], v10 offset:0
ds_read_b128 a[164:167], v11 offset:0
M v[240:243], a[128:131], a[176:179], v[240:243]
s_add_u32 m0, s29, 49152
s_add_u32 s3, s23, s31
buffer_load_dwordx4 v2, s[8:11], s3 offen offset:0 lds
M v[240:243], a[132:135], a[180:183], v[240:243]
M v[244:247], a[140:143], a[180:183], v[244:247]
M v[244:247], a[136:139], a[176:179], v[244:247]
M v[248:251], a[144:147], a[176:179], v[248:251]
M v[248:251], a[148:151], a[180:183], v[248:251]
buffer_load_dwordx4 v3, s[8:11], s3 offen offset:1024 lds
M v[252:255], a[156:159], a[180:183], v[252:255]
M v[252:255], a[152:155], a[176:179], v[252:255]
M a[0:3], a[96:99], a[184:187], a[0:3]
M a[0:3], a[100:103], a[188:191], a[0:3]
ds_read_b128 a[168:171], v10 offset:2048
ds_read_b128 a[172:175], v11 offset:2048
M a[4:7], a[108:111], a[188:191], a[4:7]
M a[4:7], a[104:107], a[184:187], a[4:7]
M a[8:11], a[112:115], a[184:187], a[8:11]
buffer_load_dwordx4 v4, s[8:11], s3 offen offset:2048 lds
M a[8:11], a[116:119], a[188:191], a[8:11]
M a[12:15], a[124:127], a[188:191], a[12:15]
M a[12:15], a[120:123], a[184:187], a[12:15]
M a[16:19], a[128:131], a[184:187], a[16:19]
M a[16:19], a[132:135], a[188:191], a[16:19]
buffer_load_dwordx4 v5, s[8:11], s3 offen offset:3072 lds
M a[20:23], a[140:143], a[188:191], a[20:23]
M a[20:23], a[136:139], a[184:187], a[20:23]
M a[24:27], a[144:147], a[184:187], a[24:27]
M a[24:27], a[148:151], a[188:191], a[24:27]
M a[28:31], a[156:159], a[188:191], a[28:31]
M a[28:31], a[152:155], a[184:187], a[28:31]
s_waitcnt lgkmcnt(2)
s_sub_u32 s30, s30, 1
s_cmp_lg_u32 s30, 0
s_cbranch_scc1 Lk1_kl
M v[32:35], a[32:35], a[160:163], v[32:35]
s_add_u32 s23, s23, 128
s_cmp_eq_u32 s23, s25
s_cselect_b32 s23, s26, s23
M v[32:35], a[36:39], a[164:167], v[32:35]
ds_read_b128 a[176:179], v10 offset:4096
ds_read_b128 a[180:183], v11 offset:4096
M v[36:39], a[44:47], a[164:167], v[36:39]
M v[36:39], a[40:43], a[160:163], v[36:39]
ds_read_b64_tr_b16 a[96:97], v12 offset:32768
ds_read_b64_tr_b16 a[98:99], v12 offset:34816
M v[40:43], a[48:51], a[160:163], v[40:43]
M v[40:43], a[52:55], a[164:167], v[40:43]
M v[44:47], a[60:63], a[164:167], v[44:47]
s_add_u32 m0, s29, 81920
s_nop 0
buffer_load_dwordx4 v6, s[12:15], s24 offen offset:0 lds
M v[44:47], a[56:59], a[160:163], v[44:47]
ds_read_b64_tr_b16 a[104:105], v13 offset:32768
ds_read_b64_tr_b16 a[106:107], v13 offset:34816
M v[48:51], a[64:67], a[160:163], v[48:51]
M v[48:51], a[68:71], a[164:167], v[48:51]
M v[52:55], a[76:79], a[164:167], v[52:55]
M v[52:55], a[72:75], a[160:163], v[52:55]
ds_read_b64_tr_b16 a[112:113], v14 offset:32768
ds_read_b64_tr_b16 a[114:115], v14 offset:34816
M v[56:59], a[80:83], a[160:163], v[56:59]
M v[56:59], a[84:87], a[164:167], v[56:59]
buffer_load_dwordx4 v7, s[12:15], s24 offen offset:1024 lds
M v[60:63], a[92:95], a[164:167], v[60:63]
M v[60:63], a[88:91], a[160:163], v[60:63]
s_waitcnt lgkmcnt(8)
ds_read_b64_tr_b16 a[120:121], v15 offset:32768
ds_read_b64_tr_b16 a[122:123], v15 offset:34816
M v[64:67], a[32:35], a[168:171], v[64:67]
M v[64:67], a[36:39], a[172:175], v[64:67]
ds_read_b128 a[184:187], v10 offset:6144
ds_read_b128 a[188:191], v11 offset:6144
M v[68:71], a[44:47], a[172:175], v[68:71]
M v[68:71], a[40:43], a[168:171], v[68:71]
ds_read_b64_tr_b16 a[128:129], v16 offset:32768
ds_read_b64_tr_b16 a[130:131], v16 offset:34816
M v[72:75], a[48:51], a[168:171], v[72:75]
buffer_load_dwordx4 v8, s[12:15], s24 offen offset:2048 lds
M v[72:75], a[52:55], a[172:175], v[72:75]
M v[76:79], a[60:63], a[172:175], v[76:79]
M v[76:79], a[56:59], a[168:171], v[76:79]
ds_read_b64_tr_b16 a[136:137], v17 offset:32768
ds_read_b64_tr_b16 a[138:139], v17 offset:34816
M v[80:83], a[64:67], a[168:171], v[80:83]
M v[80:83], a[68:71], a[172:175], v[80:83]
M v[84:87], a[76:79], a[172:175], v[84:87]
buffer_load_dwordx4 v9, s[12:15], s24 offen offset:3072 lds
M v[84:87], a[72:75], a[168:171], v[84:87]
ds_read_b64_tr_b16 a[144:145], v18 offset:32768
ds_read_b64_tr_b16 a[146:147], v18 offset:34816
M v[88:91], a[80:83], a[168:171], v[88:91]
M v[88:91], a[84:87], a[172:175], v[88:91]
M v[92:95], a[92:95], a[172:175], v[92:95]
M v[92:95], a[88:91], a[168:171], v[92:95]
s_waitcnt lgkmcnt(15)
ds_read_b64_tr_b16 a[152:153], v19 offset:32768
ds_read_b64_tr_b16 a[154:155], v19 offset:34816
M v[96:99], a[32:35], a[176:179], v[96:99]
s_add_u32 s24, s24, 262144
s_cmp_eq_u32 s24, s27
s_cselect_b32 s24, s28, s24
s_sub_u32 s6, s6, 1
s_cmp_eq_u32 s6, 0
s_cselect_b64 s[12:13], s[64:65], s[12:13]
M v[96:99], a[36:39], a[180:183], v[96:99]
M v[100:103], a[44:47], a[180:183], v[100:103]
M v[100:103], a[40:43], a[176:179], v[100:103]
M v[104:107], a[48:51], a[176:179], v[104:107]
M v[104:107], a[52:55], a[180:183], v[104:107]
M v[108:111], a[60:63], a[180:183], v[108:111]
M v[108:111], a[56:59], a[176:179], v[108:111]
s_waitcnt vmcnt(16) lgkmcnt(0)
s_barrier
ds_read_b128 a[160:163], v10 offset:16384
ds_read_b128 a[164:167], v11 offset:16384
M v[112:115], a[64:67], a[176:179], v[112:115]
s_add_u32 m0, s29, 0
s_nop 0
buffer_load_dwordx4 v2, s[8:11], s23 offen offset:0 lds
M v[112:115], a[68:71], a[180:183], v[112:115]
M v[116:119], a[76:79], a[180:183], v[116:119]
M v[116:119], a[72:75], a[176:179], v[116:119]
ds_read_b64_tr_b16 a[100:101], v12 offset:49152
ds_read_b64_tr_b16 a[102:103], v12 offset:51200
M v[120:123], a[80:83], a[176:179], v[120:123]
M v[120:123], a[84:87], a[180:183], v[120:123]
M v[124:127], a[92:95], a[180:183], v[124:127]
buffer_load_dwordx4 v3, s[8:11], s23 offen offset:1024 lds
M v[124:127], a[88:91], a[176:179], v[124:127]
M v[128:131], a[32:35], a[184:187], v[128:131]
M v[128:131], a[36:39], a[188:191], v[128:131]
ds_read_b128 a[168:171], v10 offset:18432
ds_read_b128 a[172:175], v11 offset:18432
ds_read_b64_tr_b16 a[108:109], v13 offset:49152
ds_read_b64_tr_b16 a[110:111], v13 offset:51200
M v[132:135], a[44:47], a[188:191], v[132:135]
M v[132:135], a[40:43], a[184:187], v[132:135]
M v[136:139], a[48:51], a[184:187], v[136:139]
M v[136:139], a[52:55], a[188:191], v[136:139]
buffer_load_dwordx4 v4, s[8:11], s23 offen offset:2048 lds
M v[140:143], a[60:63], a[188:191], v[140:143]
M v[140:143], a[56:59], a[184:187], v[140:143]
ds_read_b64_tr_b16 a[116:117], v14 offset:49152
ds_read_b64_tr_b16 a[118:119], v14 offset:51200
M v[144:147], a[64:67], a[184:187], v[144:147]
M v[144:147], a[68:71], a[188:191], v[144:147]
M v[148:151], a[76:79], a[188:191], v[148:151]
M v[148:151], a[72:75], a[184:187], v[148:151]
M v[152:155], a[80:83], a[184:187], v[152:155]
buffer_load_dwordx4 v5, s[8:11], s23 offen offset:3072 lds
s_lshr_b32 s3, s53, 7
s_add_u32 s3, s3, s22
M v[152:155], a[84:87], a[188:191], v[152:155]
ds_read_b64_tr_b16 a[124:125], v15 offset:49152
ds_read_b64_tr_b16 a[126:127], v15 offset:51200
s_lshl_b32 s3, s3, 5
s_lshr_b32 s19, s52, 6
M v[156:159], a[92:95], a[188:191], v[156:159]
s_add_u32 s3, s3, s19
s_lshl_b32 s19, s21, 1
M v[156:159], a[88:91], a[184:187], v[156:159]
s_waitcnt lgkmcnt(10)
s_add_u32 s3, s3, s19
s_lshl_b32 s92, s3, 15
M v[160:163], a[32:35], a[160:163], v[160:163]
s_add_u32 s93, s92, 32768
s_add_u32 s16, s50, 16777216
M v[160:163], a[36:39], a[164:167], v[160:163]
ds_read_b128 a[176:179], v10 offset:20480
ds_read_b128 a[180:183], v11 offset:20480
s_addc_u32 s17, s51, 0
s_mov_b32 s18, 33554432
M v[164:167], a[44:47], a[164:167], v[164:167]
s_mov_b32 s19, 0x00020000
M v[164:167], a[40:43], a[160:163], v[164:167]
ds_read_b64_tr_b16 a[132:133], v16 offset:49152
ds_read_b64_tr_b16 a[134:135], v16 offset:51200
M v[168:171], a[48:51], a[160:163], v[168:171]
M v[168:171], a[52:55], a[164:167], v[168:171]
s_add_u32 m0, s29, 98304
s_nop 0
buffer_load_dwordx4 v6, s[12:15], s24 offen offset:0 lds
M v[172:175], a[60:63], a[164:167], v[172:175]
M v[172:175], a[56:59], a[160:163], v[172:175]
M v[176:179], a[64:67], a[160:163], v[176:179]
M v[176:179], a[68:71], a[164:167], v[176:179]
ds_read_b64_tr_b16 a[140:141], v17 offset:49152
ds_read_b64_tr_b16 a[142:143], v17 offset:51200
M v[180:183], a[76:79], a[164:167], v[180:183]
M v[180:183], a[72:75], a[160:163], v[180:183]
buffer_load_dwordx4 v7, s[12:15], s24 offen offset:1024 lds
M v[184:187], a[80:83], a[160:163], v[184:187]
M v[184:187], a[84:87], a[164:167], v[184:187]
M v[188:191], a[92:95], a[164:167], v[188:191]
M v[188:191], a[88:91], a[160:163], v[188:191]
s_waitcnt lgkmcnt(12)
ds_read_b64_tr_b16 a[148:149], v18 offset:49152
ds_read_b64_tr_b16 a[150:151], v18 offset:51200
M v[192:195], a[32:35], a[168:171], v[192:195]
M v[192:195], a[36:39], a[172:175], v[192:195]
ds_read_b128 a[184:187], v10 offset:22528
ds_read_b128 a[188:191], v11 offset:22528
M v[196:199], a[44:47], a[172:175], v[196:199]
M v[196:199], a[40:43], a[168:171], v[196:199]
buffer_load_dwordx4 v8, s[12:15], s24 offen offset:2048 lds
M v[200:203], a[48:51], a[168:171], v[200:203]
M v[200:203], a[52:55], a[172:175], v[200:203]
ds_read_b64_tr_b16 a[156:157], v19 offset:49152
ds_read_b64_tr_b16 a[158:159], v19 offset:51200
M v[204:207], a[60:63], a[172:175], v[204:207]
M v[204:207], a[56:59], a[168:171], v[204:207]
M v[208:211], a[64:67], a[168:171], v[208:211]
M v[208:211], a[68:71], a[172:175], v[208:211]
buffer_load_dwordx4 v9, s[12:15], s24 offen offset:3072 lds
M v[212:215], a[76:79], a[172:175], v[212:215]
M v[212:215], a[72:75], a[168:171], v[212:215]
M v[216:219], a[80:83], a[168:171], v[216:219]
M v[216:219], a[84:87], a[172:175], v[216:219]
M v[220:223], a[92:95], a[172:175], v[220:223]
s_add_u32 s24, s24, 262144
M v[220:223], a[88:91], a[168:171], v[220:223]
s_waitcnt lgkmcnt(10)
M v[224:227], a[32:35], a[176:179], v[224:227]
M v[224:227], a[36:39], a[180:183], v[224:227]
M v[228:231], a[44:47], a[180:183], v[228:231]
M v[228:231], a[40:43], a[176:179], v[228:231]
M v[232:235], a[48:51], a[176:179], v[232:235]
M v[232:235], a[52:55], a[180:183], v[232:235]
M v[236:239], a[60:63], a[180:183], v[236:239]
M v[236:239], a[56:59], a[176:179], v[236:239]
s_waitcnt vmcnt(16) lgkmcnt(0)
s_barrier
ds_read_b128 a[160:163], v10 offset:32768
ds_read_b128 a[164:167], v11 offset:32768
M v[240:243], a[64:67], a[176:179], v[240:243]
s_add_u32 m0, s29, 16384
s_add_u32 s3, s23, s31
buffer_load_dwordx4 v2, s[8:11], s3 offen offset:0 lds
M v[240:243], a[68:71], a[180:183], v[240:243]
M v[244:247], a[76:79], a[180:183], v[244:247]
M v[244:247], a[72:75], a[176:179], v[244:247]
M v[248:251], a[80:83], a[176:179], v[248:251]
M v[248:251], a[84:87], a[180:183], v[248:251]
buffer_load_dwordx4 v3, s[8:11], s3 offen offset:1024 lds
M v[252:255], a[92:95], a[180:183], v[252:255]
M v[252:255], a[88:91], a[176:179], v[252:255]
M a[0:3], a[32:35], a[184:187], a[0:3]
M a[0:3], a[36:39], a[188:191], a[0:3]
ds_read_b128 a[168:171], v10 offset:34816
ds_read_b128 a[172:175], v11 offset:34816
M a[4:7], a[44:47], a[188:191], a[4:7]
M a[4:7], a[40:43], a[184:187], a[4:7]
M a[8:11], a[48:51], a[184:187], a[8:11]
buffer_load_dwordx4 v4, s[8:11], s3 offen offset:2048 lds
M a[8:11], a[52:55], a[188:191], a[8:11]
M a[12:15], a[60:63], a[188:191], a[12:15]
M a[12:15], a[56:59], a[184:187], a[12:15]
M a[16:19], a[64:67], a[184:187], a[16:19]
M a[16:19], a[68:71], a[188:191], a[16:19]
buffer_load_dwordx4 v5, s[8:11], s3 offen offset:3072 lds
M a[20:23], a[76:79], a[188:191], a[20:23]
M a[20:23], a[72:75], a[184:187], a[20:23]
M a[24:27], a[80:83], a[184:187], a[24:27]
M a[24:27], a[84:87], a[188:191], a[24:27]
M a[28:31], a[92:95], a[188:191], a[28:31]
M a[28:31], a[88:91], a[184:187], a[28:31]
s_waitcnt lgkmcnt(2)
M v[32:35], a[96:99], a[160:163], v[32:35]
s_add_u32 s23, s23, 128
s_cmp_eq_u32 s23, s25
s_cselect_b32 s23, s26, s23
M v[32:35], a[100:103], a[164:167], v[32:35]
ds_read_b128 a[176:179], v10 offset:36864
ds_read_b128 a[180:183], v11 offset:36864
M v[36:39], a[108:111], a[164:167], v[36:39]
M v[36:39], a[104:107], a[160:163], v[36:39]
ds_read_b64_tr_b16 a[32:33], v12 offset:0
ds_read_b64_tr_b16 a[34:35], v12 offset:2048
M v[40:43], a[112:115], a[160:163], v[40:43]
M v[40:43], a[116:119], a[164:167], v[40:43]
M v[44:47], a[124:127], a[164:167], v[44:47]
s_add_u32 m0, s29, 114688
s_nop 0
buffer_load_dwordx4 v6, s[12:15], s24 offen offset:0 lds
M v[44:47], a[120:123], a[160:163], v[44:47]
ds_read_b64_tr_b16 a[40:41], v13 offset:0
ds_read_b64_tr_b16 a[42:43], v13 offset:2048
M v[48:51], a[128:131], a[160:163], v[48:51]
M v[48:51], a[132:135], a[164:167], v[48:51]
M v[52:55], a[140:143], a[164:167], v[52:55]
M v[52:55], a[136:139], a[160:163], v[52:55]
ds_read_b64_tr_b16 a[48:49], v14 offset:0
ds_read_b64_tr_b16 a[50:51], v14 offset:2048
M v[56:59], a[144:147], a[160:163], v[56:59]
buffer_load_dwordx4 v7, s[12:15], s24 offen offset:1024 lds
M v[56:59], a[148:151], a[164:167], v[56:59]
M v[60:63], a[156:159], a[164:167], v[60:63]
M v[60:63], a[152:155], a[160:163], v[60:63]
s_waitcnt lgkmcnt(8)
ds_read_b64_tr_b16 a[56:57], v15 offset:0
ds_read_b64_tr_b16 a[58:59], v15 offset:2048
M v[64:67], a[96:99], a[168:171], v[64:67]
M v[64:67], a[100:103], a[172:175], v[64:67]
ds_read_b128 a[184:187], v10 offset:38912
ds_read_b128 a[188:191], v11 offset:38912
M v[68:71], a[108:111], a[172:175], v[68:71]
M v[68:71], a[104:107], a[168:171], v[68:71]
ds_read_b64_tr_b16 a[64:65], v16 offset:0
ds_read_b64_tr_b16 a[66:67], v16 offset:2048
v_cvt_pk_bf16_f32 v32, v32, v33
v_cvt_pk_bf16_f32 v33, v34, v35
M v[72:75], a[112:115], a[168:171], v[72:75]
buffer_load_dwordx4 v8, s[12:15], s24 offen offset:2048 lds
v_cvt_pk_bf16_f32 v34, v36, v37
v_cvt_pk_bf16_f32 v35, v38, v39
M v[72:75], a[116:119], a[172:175], v[72:75]
v_cvt_pk_bf16_f32 v40, v40, v41
v_cvt_pk_bf16_f32 v41, v42, v43
M v[76:79], a[124:127], a[172:175], v[76:79]
v_cvt_pk_bf16_f32 v42, v44, v45
v_cvt_pk_bf16_f32 v43, v46, v47
M v[76:79], a[120:123], a[168:171], v[76:79]
ds_read_b64_tr_b16 a[72:73], v17 offset:0
ds_read_b64_tr_b16 a[74:75], v17 offset:2048
v_cvt_pk_bf16_f32 v48, v48, v49
v_cvt_pk_bf16_f32 v49, v50, v51
M v[80:83], a[128:131], a[168:171], v[80:83]
v_cvt_pk_bf16_f32 v50, v52, v53
v_cvt_pk_bf16_f32 v51, v54, v55
M v[80:83], a[132:135], a[172:175], v[80:83]
buffer_load_dwordx4 v9, s[12:15], s24 offen offset:3072 lds
v_cvt_pk_bf16_f32 v56, v56, v57
v_cvt_pk_bf16_f32 v57, v58, v59
M v[84:87], a[140:143], a[172:175], v[84:87]
v_cvt_pk_bf16_f32 v58, v60, v61
v_cvt_pk_bf16_f32 v59, v62, v63
M v[84:87], a[136:139], a[168:171], v[84:87]
ds_read_b64_tr_b16 a[80:81], v18 offset:0
ds_read_b64_tr_b16 a[82:83], v18 offset:2048
M v[88:91], a[144:147], a[168:171], v[88:91]
M v[88:91], a[148:151], a[172:175], v[88:91]
M v[92:95], a[156:159], a[172:175], v[92:95]
s_add_u32 s94, s92, 0
buffer_store_dwordx4 v[32:35], v1, s[16:19], s94 offen offset:0 sc1
M v[92:95], a[152:155], a[168:171], v[92:95]
s_waitcnt lgkmcnt(15)
ds_read_b64_tr_b16 a[88:89], v19 offset:0
ds_read_b64_tr_b16 a[90:91], v19 offset:2048
M v[96:99], a[96:99], a[176:179], v[96:99]
s_add_u32 s24, s24, 262144
s_cmp_eq_u32 s24, s27
s_cselect_b32 s24, s28, s24
s_sub_u32 s6, s6, 1
s_cmp_eq_u32 s6, 0
s_cselect_b64 s[12:13], s[64:65], s[12:13]
M v[96:99], a[100:103], a[180:183], v[96:99]
M v[100:103], a[108:111], a[180:183], v[100:103]
M v[100:103], a[104:107], a[176:179], v[100:103]
v_cvt_pk_bf16_f32 v64, v64, v65
v_cvt_pk_bf16_f32 v65, v66, v67
M v[104:107], a[112:115], a[176:179], v[104:107]
v_cvt_pk_bf16_f32 v66, v68, v69
v_cvt_pk_bf16_f32 v67, v70, v71
M v[104:107], a[116:119], a[180:183], v[104:107]
v_cvt_pk_bf16_f32 v72, v72, v73
v_cvt_pk_bf16_f32 v73, v74, v75
M v[108:111], a[124:127], a[180:183], v[108:111]
v_cvt_pk_bf16_f32 v74, v76, v77
v_cvt_pk_bf16_f32 v75, v78, v79
M v[108:111], a[120:123], a[176:179], v[108:111]
s_waitcnt vmcnt(17) lgkmcnt(0)
s_barrier
ds_read_b128 a[160:163], v10 offset:49152
ds_read_b128 a[164:167], v11 offset:49152
v_cvt_pk_bf16_f32 v80, v80, v81
v_cvt_pk_bf16_f32 v81, v82, v83
M v[112:115], a[128:131], a[176:179], v[112:115]
s_add_u32 s94, s92, 0
buffer_store_dwordx4 v[40:43], v1, s[16:19], s94 offen offset:1024 sc1
v_cvt_pk_bf16_f32 v82, v84, v85
v_cvt_pk_bf16_f32 v83, v86, v87
M v[112:115], a[132:135], a[180:183], v[112:115]
s_add_u32 m0, s29, 32768
s_nop 0
buffer_load_dwordx4 v2, s[8:11], s23 offen offset:0 lds
v_cvt_pk_bf16_f32 v88, v88, v89
v_cvt_pk_bf16_f32 v89, v90, v91
M v[116:119], a[140:143], a[180:183], v[116:119]
v_cvt_pk_bf16_f32 v90, v92, v93
v_cvt_pk_bf16_f32 v91, v94, v95
M v[116:119], a[136:139], a[176:179], v[116:119]
ds_read_b64_tr_b16 a[36:37], v12 offset:16384
ds_read_b64_tr_b16 a[38:39], v12 offset:18432
M v[120:123], a[144:147], a[176:179], v[120:123]
M v[120:123], a[148:151], a[180:183], v[120:123]
M v[124:127], a[156:159], a[180:183], v[124:127]
buffer_load_dwordx4 v3, s[8:11], s23 offen offset:1024 lds
M v[124:127], a[152:155], a[176:179], v[124:127]
M v[128:131], a[96:99], a[184:187], v[128:131]
M v[128:131], a[100:103], a[188:191], v[128:131]
ds_read_b128 a[168:171], v10 offset:51200
ds_read_b128 a[172:175], v11 offset:51200
ds_read_b64_tr_b16 a[44:45], v13 offset:16384
ds_read_b64_tr_b16 a[46:47], v13 offset:18432
M v[132:135], a[108:111], a[188:191], v[132:135]
M v[132:135], a[104:107], a[184:187], v[132:135]
s_add_u32 s94, s92, 0
buffer_store_dwordx4 v[48:51], v1, s[16:19], s94 offen offset:2048 sc1
v_cvt_pk_bf16_f32 v96, v96, v97
v_cvt_pk_bf16_f32 v97, v98, v99
M v[136:139], a[112:115], a[184:187], v[136:139]
v_cvt_pk_bf16_f32 v98, v100, v101
v_cvt_pk_bf16_f32 v99, v102, v103
M v[136:139], a[116:119], a[188:191], v[136:139]
v_cvt_pk_bf16_f32 v104, v104, v105
v_cvt_pk_bf16_f32 v105, v106, v107
M v[140:143], a[124:127], a[188:191], v[140:143]
buffer_load_dwordx4 v4, s[8:11], s23 offen offset:2048 lds
v_cvt_pk_bf16_f32 v106, v108, v109
v_cvt_pk_bf16_f32 v107, v110, v111
M v[140:143], a[120:123], a[184:187], v[140:143]
ds_read_b64_tr_b16 a[52:53], v14 offset:16384
ds_read_b64_tr_b16 a[54:55], v14 offset:18432
v_cvt_pk_bf16_f32 v112, v112, v113
v_cvt_pk_bf16_f32 v113, v114, v115
M v[144:147], a[128:131], a[184:187], v[144:147]
v_cvt_pk_bf16_f32 v114, v116, v117
v_cvt_pk_bf16_f32 v115, v118, v119
M v[144:147], a[132:135], a[188:191], v[144:147]
v_cvt_pk_bf16_f32 v120, v120, v121
v_cvt_pk_bf16_f32 v121, v122, v123
M v[148:151], a[140:143], a[188:191], v[148:151]
v_cvt_pk_bf16_f32 v122, v124, v125
v_cvt_pk_bf16_f32 v123, v126, v127
M v[148:151], a[136:139], a[184:187], v[148:151]
M v[152:155], a[144:147], a[184:187], v[152:155]
buffer_load_dwordx4 v5, s[8:11], s23 offen offset:3072 lds
M v[152:155], a[148:151], a[188:191], v[152:155]
ds_read_b64_tr_b16 a[60:61], v15 offset:16384
ds_read_b64_tr_b16 a[62:63], v15 offset:18432
M v[156:159], a[156:159], a[188:191], v[156:159]
s_add_u32 s94, s92, 0
buffer_store_dwordx4 v[56:59], v1, s[16:19], s94 offen offset:3072 sc1
M v[156:159], a[152:155], a[184:187], v[156:159]
s_waitcnt lgkmcnt(10)
M v[160:163], a[96:99], a[160:163], v[160:163]
M v[160:163], a[100:103], a[164:167], v[160:163]
ds_read_b128 a[176:179], v10 offset:53248
ds_read_b128 a[180:183], v11 offset:53248
M v[164:167], a[108:111], a[164:167], v[164:167]
M v[164:167], a[104:107], a[160:163], v[164:167]
ds_read_b64_tr_b16 a[68:69], v16 offset:16384
ds_read_b64_tr_b16 a[70:71], v16 offset:18432
v_cvt_pk_bf16_f32 v128, v128, v129
v_cvt_pk_bf16_f32 v129, v130, v131
M v[168:171], a[112:115], a[160:163], v[168:171]
v_cvt_pk_bf16_f32 v130, v132, v133
v_cvt_pk_bf16_f32 v131, v134, v135
M v[168:171], a[116:119], a[164:167], v[168:171]
s_add_u32 m0, s29, 65536
s_nop 0
buffer_load_dwordx4 v6, s[12:15], s24 offen offset:0 lds
v_cvt_pk_bf16_f32 v136, v136, v137
v_cvt_pk_bf16_f32 v137, v138, v139
M v[172:175], a[124:127], a[164:167], v[172:175]
v_cvt_pk_bf16_f32 v138, v140, v141
v_cvt_pk_bf16_f32 v139, v142, v143
M v[172:175], a[120:123], a[160:163], v[172:175]
v_cvt_pk_bf16_f32 v144, v144, v145
v_cvt_pk_bf16_f32 v145, v146, v147
M v[176:179], a[128:131], a[160:163], v[176:179]
s_add_u32 s94, s92, 4096
buffer_store_dwordx4 v[64:67], v1, s[16:19], s94 offen offset:0 sc1
v_cvt_pk_bf16_f32 v146, v148, v149
v_cvt_pk_bf16_f32 v147, v150, v151
M v[176:179], a[132:135], a[164:167], v[176:179]
ds_read_b64_tr_b16 a[76:77], v17 offset:16384
ds_read_b64_tr_b16 a[78:79], v17 offset:18432
v_cvt_pk_bf16_f32 v152, v152, v153
v_cvt_pk_bf16_f32 v153, v154, v155
M v[180:183], a[140:143], a[164:167], v[180:183]
v_cvt_pk_bf16_f32 v154, v156, v157
v_cvt_pk_bf16_f32 v155, v158, v159
M v[180:183], a[136:139], a[160:163], v[180:183]
M v[184:187], a[144:147], a[160:163], v[184:187]
buffer_load_dwordx4 v7, s[12:15], s24 offen offset:1024 lds
v_accvgpr_write_b32 a192, v128
v_accvgpr_write_b32 a193, v129
v_accvgpr_write_b32 a194, v130
v_accvgpr_write_b32 a195, v131
M v[184:187], a[148:151], a[164:167], v[184:187]
v_accvgpr_write_b32 a196, v136
v_accvgpr_write_b32 a197, v137
v_accvgpr_write_b32 a198, v138
v_accvgpr_write_b32 a199, v139
M v[188:191], a[156:159], a[164:167], v[188:191]
v_accvgpr_write_b32 a200, v144
v_accvgpr_write_b32 a201, v145
v_accvgpr_write_b32 a202, v146
v_accvgpr_write_b32 a203, v147
M v[188:191], a[152:155], a[160:163], v[188:191]
s_waitcnt lgkmcnt(12)
ds_read_b64_tr_b16 a[84:85], v18 offset:16384
ds_read_b64_tr_b16 a[86:87], v18 offset:18432
v_accvgpr_write_b32 a204, v152
v_accvgpr_write_b32 a205, v153
v_accvgpr_write_b32 a206, v154
v_accvgpr_write_b32 a207, v155
M v[192:195], a[96:99], a[168:171], v[192:195]
M v[192:195], a[100:103], a[172:175], v[192:195]
ds_read_b128 a[184:187], v10 offset:55296
ds_read_b128 a[188:191], v11 offset:55296
M v[196:199], a[108:111], a[172:175], v[196:199]
s_add_u32 s94, s92, 4096
buffer_store_dwordx4 v[72:75], v1, s[16:19], s94 offen offset:1024 sc1
M v[196:199], a[104:107], a[168:171], v[196:199]
v_cvt_pk_bf16_f32 v160, v160, v161
v_cvt_pk_bf16_f32 v161, v162, v163
M v[200:203], a[112:115], a[168:171], v[200:203]
buffer_load_dwordx4 v8, s[12:15], s24 offen offset:2048 lds
v_cvt_pk_bf16_f32 v162, v164, v165
v_cvt_pk_bf16_f32 v163, v166, v167
M v[200:203], a[116:119], a[172:175], v[200:203]
ds_read_b64_tr_b16 a[92:93], v19 offset:16384
ds_read_b64_tr_b16 a[94:95], v19 offset:18432
v_cvt_pk_bf16_f32 v168, v168, v169
v_cvt_pk_bf16_f32 v169, v170, v171
M v[204:207], a[124:127], a[172:175], v[204:207]
v_cvt_pk_bf16_f32 v170, v172, v173
v_cvt_pk_bf16_f32 v171, v174, v175
M v[204:207], a[120:123], a[168:171], v[204:207]
v_cvt_pk_bf16_f32 v176, v176, v177
v_cvt_pk_bf16_f32 v177, v178, v179
M v[208:211], a[128:131], a[168:171], v[208:211]
v_cvt_pk_bf16_f32 v178, v180, v181
v_cvt_pk_bf16_f32 v179, v182, v183
M v[208:211], a[132:135], a[172:175], v[208:211]
buffer_load_dwordx4 v9, s[12:15], s24 offen offset:3072 lds
v_cvt_pk_bf16_f32 v184, v184, v185
v_cvt_pk_bf16_f32 v185, v186, v187
M v[212:215], a[140:143], a[172:175], v[212:215]
v_cvt_pk_bf16_f32 v186, v188, v189
v_cvt_pk_bf16_f32 v187, v190, v191
M v[212:215], a[136:139], a[168:171], v[212:215]
M v[216:219], a[144:147], a[168:171], v[216:219]
v_accvgpr_write_b32 a208, v160
v_accvgpr_write_b32 a209, v161
v_accvgpr_write_b32 a210, v162
v_accvgpr_write_b32 a211, v163
M v[216:219], a[148:151], a[172:175], v[216:219]
s_add_u32 s94, s92, 4096
buffer_store_dwordx4 v[80:83], v1, s[16:19], s94 offen offset:2048 sc1
v_accvgpr_write_b32 a212, v168
v_accvgpr_write_b32 a213, v169
v_accvgpr_write_b32 a214, v170
v_accvgpr_write_b32 a215, v171
M v[220:223], a[156:159], a[172:175], v[220:223]
v_accvgpr_write_b32 a216, v176
v_accvgpr_write_b32 a217, v177
v_accvgpr_write_b32 a218, v178
v_accvgpr_write_b32 a219, v179
M v[220:223], a[152:155], a[168:171], v[220:223]
s_waitcnt lgkmcnt(10)
v_accvgpr_write_b32 a220, v184
v_accvgpr_write_b32 a221, v185
v_accvgpr_write_b32 a222, v186
v_accvgpr_write_b32 a223, v187
M v[224:227], a[96:99], a[176:179], v[224:227]
s_add_u32 s24, s24, 262144
M v[224:227], a[100:103], a[180:183], v[224:227]
M v[228:231], a[108:111], a[180:183], v[228:231]
M v[228:231], a[104:107], a[176:179], v[228:231]
v_cvt_pk_bf16_f32 v192, v192, v193
v_cvt_pk_bf16_f32 v193, v194, v195
M v[232:235], a[112:115], a[176:179], v[232:235]
v_cvt_pk_bf16_f32 v194, v196, v197
v_cvt_pk_bf16_f32 v195, v198, v199
M v[232:235], a[116:119], a[180:183], v[232:235]
v_cvt_pk_bf16_f32 v200, v200, v201
v_cvt_pk_bf16_f32 v201, v202, v203
M v[236:239], a[124:127], a[180:183], v[236:239]
v_cvt_pk_bf16_f32 v202, v204, v205
v_cvt_pk_bf16_f32 v203, v206, v207
M v[236:239], a[120:123], a[176:179], v[236:239]
s_waitcnt vmcnt(23) lgkmcnt(0)
s_barrier
ds_read_b128 a[160:163], v10 offset:0
ds_read_b128 a[164:167], v11 offset:0
v_cvt_pk_bf16_f32 v208, v208, v209
v_cvt_pk_bf16_f32 v209, v210, v211
M v[240:243], a[128:131], a[176:179], v[240:243]
s_add_u32 s94, s92, 4096
buffer_store_dwordx4 v[88:91], v1, s[16:19], s94 offen offset:3072 sc1
v_cvt_pk_bf16_f32 v210, v212, v213
v_cvt_pk_bf16_f32 v211, v214, v215
M v[240:243], a[132:135], a[180:183], v[240:243]
s_add_u32 m0, s29, 49152
s_add_u32 s3, s23, s31
buffer_load_dwordx4 v2, s[8:11], s3 offen offset:0 lds
v_cvt_pk_bf16_f32 v216, v216, v217
v_cvt_pk_bf16_f32 v217, v218, v219
M v[244:247], a[140:143], a[180:183], v[244:247]
v_cvt_pk_bf16_f32 v218, v220, v221
v_cvt_pk_bf16_f32 v219, v222, v223
M v[244:247], a[136:139], a[176:179], v[244:247]
M v[248:251], a[144:147], a[176:179], v[248:251]
v_accvgpr_write_b32 a224, v192
v_accvgpr_write_b32 a225, v193
v_accvgpr_write_b32 a226, v194
v_accvgpr_write_b32 a227, v195
M v[248:251], a[148:151], a[180:183], v[248:251]
buffer_load_dwordx4 v3, s[8:11], s3 offen offset:1024 lds
v_accvgpr_write_b32 a228, v200
v_accvgpr_write_b32 a229, v201
v_accvgpr_write_b32 a230, v202
v_accvgpr_write_b32 a231, v203
M v[252:255], a[156:159], a[180:183], v[252:255]
v_accvgpr_write_b32 a232, v208
v_accvgpr_write_b32 a233, v209
v_accvgpr_write_b32 a234, v210
v_accvgpr_write_b32 a235, v211
M v[252:255], a[152:155], a[176:179], v[252:255]
v_accvgpr_write_b32 a236, v216
v_accvgpr_write_b32 a237, v217
v_accvgpr_write_b32 a238, v218
v_accvgpr_write_b32 a239, v219
M a[0:3], a[96:99], a[184:187], a[0:3]
M a[0:3], a[100:103], a[188:191], a[0:3]
ds_read_b128 a[168:171], v10 offset:2048
ds_read_b128 a[172:175], v11 offset:2048
M a[4:7], a[108:111], a[188:191], a[4:7]
s_add_u32 s94, s92, 8192
buffer_store_dwordx4 v[96:99], v1, s[16:19], s94 offen offset:0 sc1
M a[4:7], a[104:107], a[184:187], a[4:7]
v_cvt_pk_bf16_f32 v224, v224, v225
v_cvt_pk_bf16_f32 v225, v226, v227
M a[8:11], a[112:115], a[184:187], a[8:11]
v_cvt_pk_bf16_f32 v226, v228, v229
v_cvt_pk_bf16_f32 v227, v230, v231
M a[8:11], a[116:119], a[188:191], a[8:11]
buffer_load_dwordx4 v4, s[8:11], s3 offen offset:2048 lds
v_cvt_pk_bf16_f32 v232, v232, v233
v_cvt_pk_bf16_f32 v233, v234, v235
M a[12:15], a[124:127], a[188:191], a[12:15]
v_cvt_pk_bf16_f32 v234, v236, v237
v_cvt_pk_bf16_f32 v235, v238, v239
M a[12:15], a[120:123], a[184:187], a[12:15]
v_cvt_pk_bf16_f32 v240, v240, v241
v_cvt_pk_bf16_f32 v241, v242, v243
M a[16:19], a[128:131], a[184:187], a[16:19]
v_cvt_pk_bf16_f32 v242, v244, v245
v_cvt_pk_bf16_f32 v243, v246, v247
M a[16:19], a[132:135], a[188:191], a[16:19]
buffer_load_dwordx4 v5, s[8:11], s3 offen offset:3072 lds
v_cvt_pk_bf16_f32 v248, v248, v249
v_cvt_pk_bf16_f32 v249, v250, v251
M a[20:23], a[140:143], a[188:191], a[20:23]
v_cvt_pk_bf16_f32 v250, v252, v253
v_cvt_pk_bf16_f32 v251, v254, v255
M a[20:23], a[136:139], a[184:187], a[20:23]
M a[24:27], a[144:147], a[184:187], a[24:27]
s_add_u32 s94, s92, 8192
buffer_store_dwordx4 v[104:107], v1, s[16:19], s94 offen offset:1024 sc1
v_accvgpr_write_b32 a240, v224
v_accvgpr_write_b32 a241, v225
v_accvgpr_write_b32 a242, v226
v_accvgpr_write_b32 a243, v227
M a[24:27], a[148:151], a[188:191], a[24:27]
v_accvgpr_write_b32 a244, v232
v_accvgpr_write_b32 a245, v233
v_accvgpr_write_b32 a246, v234
v_accvgpr_write_b32 a247, v235
M a[28:31], a[156:159], a[188:191], a[28:31]
v_accvgpr_write_b32 a248, v240
v_accvgpr_write_b32 a249, v241
v_accvgpr_write_b32 a250, v242
v_accvgpr_write_b32 a251, v243
M a[28:31], a[152:155], a[184:187], a[28:31]
s_waitcnt lgkmcnt(2)
v_accvgpr_write_b32 a252, v248
v_accvgpr_write_b32 a253, v249
v_accvgpr_write_b32 a254, v250
v_accvgpr_write_b32 a255, v251
M v[32:35], a[160:163], a[32:35], 0
s_add_u32 s23, s23, 128
s_cmp_eq_u32 s23, s25
s_cselect_b32 s23, s26, s23
M v[32:35], a[164:167], a[36:39], v[32:35]
ds_read_b128 a[176:179], v10 offset:4096
ds_read_b128 a[180:183], v11 offset:4096
M v[36:39], a[164:167], a[44:47], 0
M v[36:39], a[160:163], a[40:43], v[36:39]
ds_read_b64_tr_b16 a[96:97], v12 offset:32768
ds_read_b64_tr_b16 a[98:99], v12 offset:34816
M v[40:43], a[160:163], a[48:51], 0
M v[40:43], a[164:167], a[52:55], v[40:43]
M v[44:47], a[164:167], a[60:63], 0
s_add_u32 m0, s29, 81920
s_nop 0
buffer_load_dwordx4 v6, s[12:15], s24 offen offset:0 lds
M v[44:47], a[160:163], a[56:59], v[44:47]
ds_read_b64_tr_b16 a[104:105], v13 offset:32768
ds_read_b64_tr_b16 a[106:107], v13 offset:34816
M v[48:51], a[160:163], a[64:67], 0
s_add_u32 s94, s92, 8192
buffer_store_dwordx4 v[112:115], v1, s[16:19], s94 offen offset:2048 sc1
M v[48:51], a[164:167], a[68:71], v[48:51]
M v[52:55], a[164:167], a[76:79], 0
M v[52:55], a[160:163], a[72:75], v[52:55]
ds_read_b64_tr_b16 a[112:113], v14 offset:32768
ds_read_b64_tr_b16 a[114:115], v14 offset:34816
M v[56:59], a[160:163], a[80:83], 0
M v[56:59], a[164:167], a[84:87], v[56:59]
buffer_load_dwordx4 v7, s[12:15], s24 offen offset:1024 lds
M v[60:63], a[164:167], a[92:95], 0
M v[60:63], a[160:163], a[88:91], v[60:63]
s_waitcnt lgkmcnt(8)
ds_read_b64_tr_b16 a[120:121], v15 offset:32768
ds_read_b64_tr_b16 a[122:123], v15 offset:34816
M v[64:67], a[168:171], a[32:35], 0
M v[64:67], a[172:175], a[36:39], v[64:67]
ds_read_b128 a[184:187], v10 offset:6144
ds_read_b128 a[188:191], v11 offset:6144
M v[68:71], a[172:175], a[44:47], 0
s_add_u32 s94, s92, 8192
buffer_store_dwordx4 v[120:123], v1, s[16:19], s94 offen offset:3072 sc1
M v[68:71], a[168:171], a[40:43], v[68:71]
ds_read_b64_tr_b16 a[128:129], v16 offset:32768
ds_read_b64_tr_b16 a[130:131], v16 offset:34816
M v[72:75], a[168:171], a[48:51], 0
v_accvgpr_read_b32 v24, a0
v_accvgpr_read_b32 v25, a1
M v[72:75], a[172:175], a[52:55], v[72:75]
buffer_load_dwordx4 v8, s[12:15], s24 offen offset:2048 lds
v_accvgpr_read_b32 v26, a2
v_accvgpr_read_b32 v27, a3
M v[76:79], a[172:175], a[60:63], 0
v_accvgpr_read_b32 v28, a4
v_accvgpr_read_b32 v29, a5
M v[76:79], a[168:171], a[56:59], v[76:79]
ds_read_b64_tr_b16 a[136:137], v17 offset:32768
ds_read_b64_tr_b16 a[138:139], v17 offset:34816
v_accvgpr_read_b32 v30, a6
v_accvgpr_read_b32 v31, a7
M v[80:83], a[168:171], a[64:67], 0
v_cvt_pk_bf16_f32 v24, v24, v25
v_cvt_pk_bf16_f32 v25, v26, v27
M v[80:83], a[172:175], a[68:71], v[80:83]
v_cvt_pk_bf16_f32 v26, v28, v29
v_cvt_pk_bf16_f32 v27, v30, v31
M v[84:87], a[172:175], a[76:79], 0
buffer_load_dwordx4 v9, s[12:15], s24 offen offset:3072 lds
M v[84:87], a[168:171], a[72:75], v[84:87]
ds_read_b64_tr_b16 a[144:145], v18 offset:32768
ds_read_b64_tr_b16 a[146:147], v18 offset:34816
M v[88:91], a[168:171], a[80:83], 0
M v[88:91], a[172:175], a[84:87], v[88:91]
s_add_u32 s94, s93, 12288
buffer_store_dwordx4 v[24:27], v1, s[16:19], s94 offen offset:0 sc1
M v[92:95], a[172:175], a[92:95], 0
M v[92:95], a[168:171], a[88:91], v[92:95]
s_waitcnt lgkmcnt(15)
ds_read_b64_tr_b16 a[152:153], v19 offset:32768
ds_read_b64_tr_b16 a[154:155], v19 offset:34816
M v[96:99], a[176:179], a[32:35], 0
M v[96:99], a[180:183], a[36:39], v[96:99]
s_add_u32 s24, s24, 262144
s_cmp_eq_u32 s24, s27
s_cselect_b32 s24, s28, s24
s_sub_u32 s6, s6, 1
s_cmp_eq_u32 s6, 0
s_cselect_b64 s[12:13], s[64:65], s[12:13]
M v[100:103], a[180:183], a[44:47], 0
M v[100:103], a[176:179], a[40:43], v[100:103]
M v[104:107], a[176:179], a[48:51], 0
M v[104:107], a[180:183], a[52:55], v[104:107]
M v[108:111], a[180:183], a[60:63], 0
M v[108:111], a[176:179], a[56:59], v[108:111]
s_waitcnt vmcnt(29) lgkmcnt(0)
s_barrier
ds_read_b128 a[160:163], v10 offset:16384
ds_read_b128 a[164:167], v11 offset:16384
M v[112:115], a[176:179], a[64:67], 0
s_add_u32 m0, s29, 0
s_nop 0
buffer_load_dwordx4 v2, s[8:11], s23 offen offset:0 lds
M v[112:115], a[180:183], a[68:71], v[112:115]
M v[116:119], a[180:183], a[76:79], 0
M v[116:119], a[176:179], a[72:75], v[116:119]
ds_read_b64_tr_b16 a[100:101], v12 offset:49152
ds_read_b64_tr_b16 a[102:103], v12 offset:51200
M v[120:123], a[176:179], a[80:83], 0
v_accvgpr_read_b32 v24, a8
v_accvgpr_read_b32 v25, a9
M v[120:123], a[180:183], a[84:87], v[120:123]
v_accvgpr_read_b32 v26, a10
v_accvgpr_read_b32 v27, a11
M v[124:127], a[180:183], a[92:95], 0
buffer_load_dwordx4 v3, s[8:11], s23 offen offset:1024 lds
v_accvgpr_read_b32 v28, a12
v_accvgpr_read_b32 v29, a13
M v[124:127], a[176:179], a[88:91], v[124:127]
v_accvgpr_read_b32 v30, a14
v_accvgpr_read_b32 v31, a15
M v[128:131], a[184:187], a[32:35], 0
v_cvt_pk_bf16_f32 v24, v24, v25
v_cvt_pk_bf16_f32 v25, v26, v27
M v[128:131], a[188:191], a[36:39], v[128:131]
ds_read_b128 a[168:171], v10 offset:18432
ds_read_b128 a[172:175], v11 offset:18432
ds_read_b64_tr_b16 a[108:109], v13 offset:49152
ds_read_b64_tr_b16 a[110:111], v13 offset:51200
v_cvt_pk_bf16_f32 v26, v28, v29
v_cvt_pk_bf16_f32 v27, v30, v31
M v[132:135], a[188:191], a[44:47], 0
M v[132:135], a[184:187], a[40:43], v[132:135]
M v[136:139], a[184:187], a[48:51], 0
M v[136:139], a[188:191], a[52:55], v[136:139]
s_add_u32 s94, s93, 12288
buffer_store_dwordx4 v[24:27], v1, s[16:19], s94 offen offset:1024 sc1
M v[140:143], a[188:191], a[60:63], 0
buffer_load_dwordx4 v4, s[8:11], s23 offen offset:2048 lds
M v[140:143], a[184:187], a[56:59], v[140:143]
ds_read_b64_tr_b16 a[116:117], v14 offset:49152
ds_read_b64_tr_b16 a[118:119], v14 offset:51200
M v[144:147], a[184:187], a[64:67], 0
M v[144:147], a[188:191], a[68:71], v[144:147]
M v[148:151], a[188:191], a[76:79], 0
M v[148:151], a[184:187], a[72:75], v[148:151]
M v[152:155], a[184:187], a[80:83], 0
buffer_load_dwordx4 v5, s[8:11], s23 offen offset:3072 lds
M v[152:155], a[188:191], a[84:87], v[152:155]
ds_read_b64_tr_b16 a[124:125], v15 offset:49152
ds_read_b64_tr_b16 a[126:127], v15 offset:51200
M v[156:159], a[188:191], a[92:95], 0
M v[156:159], a[184:187], a[88:91], v[156:159]
s_waitcnt lgkmcnt(10)
M v[160:163], a[160:163], a[32:35], 0
M v[160:163], a[164:167], a[36:39], v[160:163]
ds_read_b128 a[176:179], v10 offset:20480
ds_read_b128 a[180:183], v11 offset:20480
M v[164:167], a[164:167], a[44:47], 0
M v[164:167], a[160:163], a[40:43], v[164:167]
ds_read_b64_tr_b16 a[132:133], v16 offset:49152
ds_read_b64_tr_b16 a[134:135], v16 offset:51200
M v[168:171], a[160:163], a[48:51], 0
v_accvgpr_read_b32 v24, a16
v_accvgpr_read_b32 v25, a17
M v[168:171], a[164:167], a[52:55], v[168:171]
s_add_u32 m0, s29, 98304
s_nop 0
buffer_load_dwordx4 v6, s[12:15], s24 offen offset:0 lds
v_accvgpr_read_b32 v26, a18
v_accvgpr_read_b32 v27, a19
M v[172:175], a[164:167], a[60:63], 0
v_accvgpr_read_b32 v28, a20
v_accvgpr_read_b32 v29, a21
M v[172:175], a[160:163], a[56:59], v[172:175]
v_accvgpr_read_b32 v30, a22
v_accvgpr_read_b32 v31, a23
M v[176:179], a[160:163], a[64:67], 0
v_cvt_pk_bf16_f32 v24, v24, v25
v_cvt_pk_bf16_f32 v25, v26, v27
M v[176:179], a[164:167], a[68:71], v[176:179]
ds_read_b64_tr_b16 a[140:141], v17 offset:49152
ds_read_b64_tr_b16 a[142:143], v17 offset:51200
v_cvt_pk_bf16_f32 v26, v28, v29
v_cvt_pk_bf16_f32 v27, v30, v31
M v[180:183], a[164:167], a[76:79], 0
M v[180:183], a[160:163], a[72:75], v[180:183]
buffer_load_dwordx4 v7, s[12:15], s24 offen offset:1024 lds
M v[184:187], a[160:163], a[80:83], 0
M v[184:187], a[164:167], a[84:87], v[184:187]
s_add_u32 s94, s93, 12288
buffer_store_dwordx4 v[24:27], v1, s[16:19], s94 offen offset:2048 sc1
M v[188:191], a[164:167], a[92:95], 0
M v[188:191], a[160:163], a[88:91], v[188:191]
s_waitcnt lgkmcnt(12)
ds_read_b64_tr_b16 a[148:149], v18 offset:49152
ds_read_b64_tr_b16 a[150:151], v18 offset:51200
M v[192:195], a[168:171], a[32:35], 0
M v[192:195], a[172:175], a[36:39], v[192:195]
ds_read_b128 a[184:187], v10 offset:22528
ds_read_b128 a[188:191], v11 offset:22528
M v[196:199], a[172:175], a[44:47], 0
M v[196:199], a[168:171], a[40:43], v[196:199]
buffer_load_dwordx4 v8, s[12:15], s24 offen offset:2048 lds
M v[200:203], a[168:171], a[48:51], 0
M v[200:203], a[172:175], a[52:55], v[200:203]
ds_read_b64_tr_b16 a[156:157], v19 offset:49152
ds_read_b64_tr_b16 a[158:159], v19 offset:51200
M v[204:207], a[172:175], a[60:63], 0
M v[204:207], a[168:171], a[56:59], v[204:207]
M v[208:211], a[168:171], a[64:67], 0
M v[208:211], a[172:175], a[68:71], v[208:211]
buffer_load_dwordx4 v9, s[12:15], s24 offen offset:3072 lds
M v[212:215], a[172:175], a[76:79], 0
M v[212:215], a[168:171], a[72:75], v[212:215]
M v[216:219], a[168:171], a[80:83], 0
v_accvgpr_read_b32 v24, a24
v_accvgpr_read_b32 v25, a25
M v[216:219], a[172:175], a[84:87], v[216:219]
v_accvgpr_read_b32 v26, a26
v_accvgpr_read_b32 v27, a27
M v[220:223], a[172:175], a[92:95], 0
s_add_u32 s24, s24, 262144
v_accvgpr_read_b32 v28, a28
v_accvgpr_read_b32 v29, a29
M v[220:223], a[168:171], a[88:91], v[220:223]
s_waitcnt lgkmcnt(10)
v_accvgpr_read_b32 v30, a30
v_accvgpr_read_b32 v31, a31
M v[224:227], a[176:179], a[32:35], 0
v_cvt_pk_bf16_f32 v24, v24, v25
v_cvt_pk_bf16_f32 v25, v26, v27
M v[224:227], a[180:183], a[36:39], v[224:227]
v_cvt_pk_bf16_f32 v26, v28, v29
v_cvt_pk_bf16_f32 v27, v30, v31
M v[228:231], a[180:183], a[44:47], 0
M v[228:231], a[176:179], a[40:43], v[228:231]
M v[232:235], a[176:179], a[48:51], 0
M v[232:235], a[180:183], a[52:55], v[232:235]
s_add_u32 s94, s93, 12288
buffer_store_dwordx4 v[24:27], v1, s[16:19], s94 offen offset:3072 sc1
M v[236:239], a[180:183], a[60:63], 0
M v[236:239], a[176:179], a[56:59], v[236:239]
s_waitcnt vmcnt(26) lgkmcnt(0)
s_barrier
ds_read_b128 a[160:163], v10 offset:32768
ds_read_b128 a[164:167], v11 offset:32768
M v[240:243], a[176:179], a[64:67], 0
s_add_u32 m0, s29, 16384
s_add_u32 s3, s23, s31
buffer_load_dwordx4 v2, s[8:11], s3 offen offset:0 lds
M v[240:243], a[180:183], a[68:71], v[240:243]
M v[244:247], a[180:183], a[76:79], 0
M v[244:247], a[176:179], a[72:75], v[244:247]
M v[248:251], a[176:179], a[80:83], 0
M v[248:251], a[180:183], a[84:87], v[248:251]
buffer_load_dwordx4 v3, s[8:11], s3 offen offset:1024 lds
M v[252:255], a[180:183], a[92:95], 0
M v[252:255], a[176:179], a[88:91], v[252:255]
M a[0:3], a[184:187], a[32:35], 0
M a[0:3], a[188:191], a[36:39], a[0:3]
ds_read_b128 a[168:171], v10 offset:34816
ds_read_b128 a[172:175], v11 offset:34816
M a[4:7], a[188:191], a[44:47], 0
M a[4:7], a[184:187], a[40:43], a[4:7]
M a[8:11], a[184:187], a[48:51], 0
buffer_load_dwordx4 v4, s[8:11], s3 offen offset:2048 lds
M a[8:11], a[188:191], a[52:55], a[8:11]
M a[12:15], a[188:191], a[60:63], 0
M a[12:15], a[184:187], a[56:59], a[12:15]
M a[16:19], a[184:187], a[64:67], 0
M a[16:19], a[188:191], a[68:71], a[16:19]
buffer_load_dwordx4 v5, s[8:11], s3 offen offset:3072 lds
M a[20:23], a[188:191], a[76:79], 0
M a[20:23], a[184:187], a[72:75], a[20:23]
M a[24:27], a[184:187], a[80:83], 0
M a[24:27], a[188:191], a[84:87], a[24:27]
M a[28:31], a[188:191], a[92:95], 0
M a[28:31], a[184:187], a[88:91], a[28:31]
s_waitcnt lgkmcnt(2)
M v[32:35], a[160:163], a[96:99], v[32:35]
s_add_u32 s23, s23, 128
s_cmp_eq_u32 s23, s25
s_cselect_b32 s23, s26, s23
M v[32:35], a[164:167], a[100:103], v[32:35]
ds_read_b128 a[176:179], v10 offset:36864
ds_read_b128 a[180:183], v11 offset:36864
M v[36:39], a[164:167], a[108:111], v[36:39]
M v[36:39], a[160:163], a[104:107], v[36:39]
ds_read_b64_tr_b16 a[32:33], v12 offset:0
ds_read_b64_tr_b16 a[34:35], v12 offset:2048
M v[40:43], a[160:163], a[112:115], v[40:43]
M v[40:43], a[164:167], a[116:119], v[40:43]
M v[44:47], a[164:167], a[124:127], v[44:47]
s_add_u32 m0, s29, 114688
s_nop 0
buffer_load_dwordx4 v6, s[12:15], s24 offen offset:0 lds
M v[44:47], a[160:163], a[120:123], v[44:47]
ds_read_b64_tr_b16 a[40:41], v13 offset:0
ds_read_b64_tr_b16 a[42:43], v13 offset:2048
M v[48:51], a[160:163], a[128:131], v[48:51]
s_add_u32 s94, s92, 12288
buffer_store_dwordx4 a[192:195], v1, s[16:19], s94 offen offset:0 sc1
M v[48:51], a[164:167], a[132:135], v[48:51]
M v[52:55], a[164:167], a[140:143], v[52:55]
M v[52:55], a[160:163], a[136:139], v[52:55]
ds_read_b64_tr_b16 a[48:49], v14 offset:0
ds_read_b64_tr_b16 a[50:51], v14 offset:2048
M v[56:59], a[160:163], a[144:147], v[56:59]
M v[56:59], a[164:167], a[148:151], v[56:59]
buffer_load_dwordx4 v7, s[12:15], s24 offen offset:1024 lds
M v[60:63], a[164:167], a[156:159], v[60:63]
M v[60:63], a[160:163], a[152:155], v[60:63]
s_waitcnt lgkmcnt(8)
ds_read_b64_tr_b16 a[56:57], v15 offset:0
ds_read_b64_tr_b16 a[58:59], v15 offset:2048
M v[64:67], a[168:171], a[96:99], v[64:67]
M v[64:67], a[172:175], a[100:103], v[64:67]
ds_read_b128 a[184:187], v10 offset:38912
ds_read_b128 a[188:191], v11 offset:38912
M v[68:71], a[172:175], a[108:111], v[68:71]
M v[68:71], a[168:171], a[104:107], v[68:71]
ds_read_b64_tr_b16 a[64:65], v16 offset:0
ds_read_b64_tr_b16 a[66:67], v16 offset:2048
M v[72:75], a[168:171], a[112:115], v[72:75]
buffer_load_dwordx4 v8, s[12:15], s24 offen offset:2048 lds
M v[72:75], a[172:175], a[116:119], v[72:75]
M v[76:79], a[172:175], a[124:127], v[76:79]
M v[76:79], a[168:171], a[120:123], v[76:79]
ds_read_b64_tr_b16 a[72:73], v17 offset:0
ds_read_b64_tr_b16 a[74:75], v17 offset:2048
M v[80:83], a[168:171], a[128:131], v[80:83]
M v[80:83], a[172:175], a[132:135], v[80:83]
buffer_load_dwordx4 v9, s[12:15], s24 offen offset:3072 lds
M v[84:87], a[172:175], a[140:143], v[84:87]
M v[84:87], a[168:171], a[136:139], v[84:87]
ds_read_b64_tr_b16 a[80:81], v18 offset:0
ds_read_b64_tr_b16 a[82:83], v18 offset:2048
M v[88:91], a[168:171], a[144:147], v[88:91]
M v[88:91], a[172:175], a[148:151], v[88:91]
M v[92:95], a[172:175], a[156:159], v[92:95]
s_add_u32 s24, s24, 262144
s_cmp_eq_u32 s24, s27
s_cselect_b32 s24, s28, s24
s_sub_u32 s6, s6, 1
s_cmp_eq_u32 s6, 0
s_cselect_b64 s[12:13], s[64:65], s[12:13]
M v[92:95], a[168:171], a[152:155], v[92:95]
s_waitcnt lgkmcnt(15)
ds_read_b64_tr_b16 a[88:89], v19 offset:0
ds_read_b64_tr_b16 a[90:91], v19 offset:2048
M v[96:99], a[176:179], a[96:99], v[96:99]
M v[96:99], a[180:183], a[100:103], v[96:99]
M v[100:103], a[180:183], a[108:111], v[100:103]
M v[100:103], a[176:179], a[104:107], v[100:103]
M v[104:107], a[176:179], a[112:115], v[104:107]
s_add_u32 s94, s92, 12288
buffer_store_dwordx4 a[196:199], v1, s[16:19], s94 offen offset:1024 sc1
M v[104:107], a[180:183], a[116:119], v[104:107]
M v[108:111], a[180:183], a[124:127], v[108:111]
M v[108:111], a[176:179], a[120:123], v[108:111]
s_waitcnt vmcnt(22) lgkmcnt(0)
s_barrier
ds_read_b128 a[160:163], v10 offset:49152
ds_read_b128 a[164:167], v11 offset:49152
M v[112:115], a[176:179], a[128:131], v[112:115]
s_add_u32 m0, s29, 32768
s_nop 0
buffer_load_dwordx4 v2, s[8:11], s23 offen offset:0 lds
M v[112:115], a[180:183], a[132:135], v[112:115]
M v[116:119], a[180:183], a[140:143], v[116:119]
M v[116:119], a[176:179], a[136:139], v[116:119]
ds_read_b64_tr_b16 a[36:37], v12 offset:16384
ds_read_b64_tr_b16 a[38:39], v12 offset:18432
M v[120:123], a[176:179], a[144:147], v[120:123]
M v[120:123], a[180:183], a[148:151], v[120:123]
M v[124:127], a[180:183], a[156:159], v[124:127]
buffer_load_dwordx4 v3, s[8:11], s23 offen offset:1024 lds
M v[124:127], a[176:179], a[152:155], v[124:127]
M v[128:131], a[184:187], a[96:99], v[128:131]
M v[128:131], a[188:191], a[100:103], v[128:131]
ds_read_b128 a[168:171], v10 offset:51200
ds_read_b128 a[172:175], v11 offset:51200
ds_read_b64_tr_b16 a[44:45], v13 offset:16384
ds_read_b64_tr_b16 a[46:47], v13 offset:18432
M v[132:135], a[188:191], a[108:111], v[132:135]
M v[132:135], a[184:187], a[104:107], v[132:135]
M v[136:139], a[184:187], a[112:115], v[136:139]
M v[136:139], a[188:191], a[116:119], v[136:139]
buffer_load_dwordx4 v4, s[8:11], s23 offen offset:2048 lds
M v[140:143], a[188:191], a[124:127], v[140:143]
M v[140:143], a[184:187], a[120:123], v[140:143]
ds_read_b64_tr_b16 a[52:53], v14 offset:16384
ds_read_b64_tr_b16 a[54:55], v14 offset:18432
M v[144:147], a[184:187], a[128:131], v[144:147]
M v[144:147], a[188:191], a[132:135], v[144:147]
M v[148:151], a[188:191], a[140:143], v[148:151]
M v[148:151], a[184:187], a[136:139], v[148:151]
buffer_load_dwordx4 v5, s[8:11], s23 offen offset:3072 lds
M v[152:155], a[184:187], a[144:147], v[152:155]
M v[152:155], a[188:191], a[148:151], v[152:155]
ds_read_b64_tr_b16 a[60:61], v15 offset:16384
ds_read_b64_tr_b16 a[62:63], v15 offset:18432
M v[156:159], a[188:191], a[156:159], v[156:159]
M v[156:159], a[184:187], a[152:155], v[156:159]
s_waitcnt lgkmcnt(10)
M v[160:163], a[160:163], a[96:99], v[160:163]
s_add_u32 s94, s92, 12288
buffer_store_dwordx4 a[200:203], v1, s[16:19], s94 offen offset:2048 sc1
M v[160:163], a[164:167], a[100:103], v[160:163]
ds_read_b128 a[176:179], v10 offset:53248
ds_read_b128 a[180:183], v11 offset:53248
M v[164:167], a[164:167], a[108:111], v[164:167]
M v[164:167], a[160:163], a[104:107], v[164:167]
ds_read_b64_tr_b16 a[68:69], v16 offset:16384
ds_read_b64_tr_b16 a[70:71], v16 offset:18432
M v[168:171], a[160:163], a[112:115], v[168:171]
M v[168:171], a[164:167], a[116:119], v[168:171]
s_add_u32 m0, s29, 65536
s_nop 0
buffer_load_dwordx4 v6, s[12:15], s24 offen offset:0 lds
M v[172:175], a[164:167], a[124:127], v[172:175]
M v[172:175], a[160:163], a[120:123], v[172:175]
M v[176:179], a[160:163], a[128:131], v[176:179]
M v[176:179], a[164:167], a[132:135], v[176:179]
ds_read_b64_tr_b16 a[76:77], v17 offset:16384
ds_read_b64_tr_b16 a[78:79], v17 offset:18432
M v[180:183], a[164:167], a[140:143], v[180:183]
M v[180:183], a[160:163], a[136:139], v[180:183]
buffer_load_dwordx4 v7, s[12:15], s24 offen offset:1024 lds
M v[184:187], a[160:163], a[144:147], v[184:187]
M v[184:187], a[164:167], a[148:151], v[184:187]
M v[188:191], a[164:167], a[156:159], v[188:191]
M v[188:191], a[160:163], a[152:155], v[188:191]
s_waitcnt lgkmcnt(12)
ds_read_b64_tr_b16 a[84:85], v18 offset:16384
ds_read_b64_tr_b16 a[86:87], v18 offset:18432
M v[192:195], a[168:171], a[96:99], v[192:195]
M v[192:195], a[172:175], a[100:103], v[192:195]
ds_read_b128 a[184:187], v10 offset:55296
ds_read_b128 a[188:191], v11 offset:55296
M v[196:199], a[172:175], a[108:111], v[196:199]
buffer_load_dwordx4 v8, s[12:15], s24 offen offset:2048 lds
M v[196:199], a[168:171], a[104:107], v[196:199]
M v[200:203], a[168:171], a[112:115], v[200:203]
M v[200:203], a[172:175], a[116:119], v[200:203]
ds_read_b64_tr_b16 a[92:93], v19 offset:16384
ds_read_b64_tr_b16 a[94:95], v19 offset:18432
M v[204:207], a[172:175], a[124:127], v[204:207]
M v[204:207], a[168:171], a[120:123], v[204:207]
M v[208:211], a[168:171], a[128:131], v[208:211]
buffer_load_dwordx4 v9, s[12:15], s24 offen offset:3072 lds
M v[208:211], a[172:175], a[132:135], v[208:211]
M v[212:215], a[172:175], a[140:143], v[212:215]
M v[212:215], a[168:171], a[136:139], v[212:215]
M v[216:219], a[168:171], a[144:147], v[216:219]
s_add_u32 s94, s92, 12288
buffer_store_dwordx4 a[204:207], v1, s[16:19], s94 offen offset:3072 sc1
M v[216:219], a[172:175], a[148:151], v[216:219]
M v[220:223], a[172:175], a[156:159], v[220:223]
s_add_u32 s24, s24, 262144
M v[220:223], a[168:171], a[152:155], v[220:223]
s_waitcnt lgkmcnt(10)
M v[224:227], a[176:179], a[96:99], v[224:227]
M v[224:227], a[180:183], a[100:103], v[224:227]
M v[228:231], a[180:183], a[108:111], v[228:231]
M v[228:231], a[176:179], a[104:107], v[228:231]
M v[232:235], a[176:179], a[112:115], v[232:235]
M v[232:235], a[180:183], a[116:119], v[232:235]
M v[236:239], a[180:183], a[124:127], v[236:239]
M v[236:239], a[176:179], a[120:123], v[236:239]
s_waitcnt vmcnt(21) lgkmcnt(0)
s_barrier
ds_read_b128 a[160:163], v10 offset:0
ds_read_b128 a[164:167], v11 offset:0
M v[240:243], a[176:179], a[128:131], v[240:243]
s_add_u32 m0, s29, 49152
s_add_u32 s3, s23, s31
buffer_load_dwordx4 v2, s[8:11], s3 offen offset:0 lds
M v[240:243], a[180:183], a[132:135], v[240:243]
M v[244:247], a[180:183], a[140:143], v[244:247]
M v[244:247], a[176:179], a[136:139], v[244:247]
M v[248:251], a[176:179], a[144:147], v[248:251]
M v[248:251], a[180:183], a[148:151], v[248:251]
buffer_load_dwordx4 v3, s[8:11], s3 offen offset:1024 lds
M v[252:255], a[180:183], a[156:159], v[252:255]
M v[252:255], a[176:179], a[152:155], v[252:255]
M a[0:3], a[184:187], a[96:99], a[0:3]
M a[0:3], a[188:191], a[100:103], a[0:3]
ds_read_b128 a[168:171], v10 offset:2048
ds_read_b128 a[172:175], v11 offset:2048
M a[4:7], a[188:191], a[108:111], a[4:7]
M a[4:7], a[184:187], a[104:107], a[4:7]
M a[8:11], a[184:187], a[112:115], a[8:11]
buffer_load_dwordx4 v4, s[8:11], s3 offen offset:2048 lds
M a[8:11], a[188:191], a[116:119], a[8:11]
M a[12:15], a[188:191], a[124:127], a[12:15]
M a[12:15], a[184:187], a[120:123], a[12:15]
M a[16:19], a[184:187], a[128:131], a[16:19]
M a[16:19], a[188:191], a[132:135], a[16:19]
buffer_load_dwordx4 v5, s[8:11], s3 offen offset:3072 lds
M a[20:23], a[188:191], a[140:143], a[20:23]
M a[20:23], a[184:187], a[136:139], a[20:23]
M a[24:27], a[184:187], a[144:147], a[24:27]
M a[24:27], a[188:191], a[148:151], a[24:27]
M a[28:31], a[188:191], a[156:159], a[28:31]
M a[28:31], a[184:187], a[152:155], a[28:31]
s_waitcnt lgkmcnt(2)
M v[32:35], a[160:163], a[32:35], v[32:35]
s_add_u32 s23, s23, 128
s_cmp_eq_u32 s23, s25
s_cselect_b32 s23, s26, s23
M v[32:35], a[164:167], a[36:39], v[32:35]
ds_read_b128 a[176:179], v10 offset:4096
ds_read_b128 a[180:183], v11 offset:4096
M v[36:39], a[164:167], a[44:47], v[36:39]
M v[36:39], a[160:163], a[40:43], v[36:39]
ds_read_b64_tr_b16 a[96:97], v12 offset:32768
ds_read_b64_tr_b16 a[98:99], v12 offset:34816
M v[40:43], a[160:163], a[48:51], v[40:43]
M v[40:43], a[164:167], a[52:55], v[40:43]
M v[44:47], a[164:167], a[60:63], v[44:47]
s_add_u32 m0, s29, 81920
s_nop 0
buffer_load_dwordx4 v6, s[12:15], s24 offen offset:0 lds
M v[44:47], a[160:163], a[56:59], v[44:47]
ds_read_b64_tr_b16 a[104:105], v13 offset:32768
ds_read_b64_tr_b16 a[106:107], v13 offset:34816
M v[48:51], a[160:163], a[64:67], v[48:51]
s_add_u32 s94, s93, 0
buffer_store_dwordx4 a[208:211], v1, s[16:19], s94 offen offset:0 sc1
M v[48:51], a[164:167], a[68:71], v[48:51]
M v[52:55], a[164:167], a[76:79], v[52:55]
M v[52:55], a[160:163], a[72:75], v[52:55]
ds_read_b64_tr_b16 a[112:113], v14 offset:32768
ds_read_b64_tr_b16 a[114:115], v14 offset:34816
M v[56:59], a[160:163], a[80:83], v[56:59]
M v[56:59], a[164:167], a[84:87], v[56:59]
buffer_load_dwordx4 v7, s[12:15], s24 offen offset:1024 lds
M v[60:63], a[164:167], a[92:95], v[60:63]
M v[60:63], a[160:163], a[88:91], v[60:63]
s_waitcnt lgkmcnt(8)
ds_read_b64_tr_b16 a[120:121], v15 offset:32768
ds_read_b64_tr_b16 a[122:123], v15 offset:34816
M v[64:67], a[168:171], a[32:35], v[64:67]
M v[64:67], a[172:175], a[36:39], v[64:67]
ds_read_b128 a[184:187], v10 offset:6144
ds_read_b128 a[188:191], v11 offset:6144
M v[68:71], a[172:175], a[44:47], v[68:71]
M v[68:71], a[168:171], a[40:43], v[68:71]
ds_read_b64_tr_b16 a[128:129], v16 offset:32768
ds_read_b64_tr_b16 a[130:131], v16 offset:34816
M v[72:75], a[168:171], a[48:51], v[72:75]
buffer_load_dwordx4 v8, s[12:15], s24 offen offset:2048 lds
M v[72:75], a[172:175], a[52:55], v[72:75]
M v[76:79], a[172:175], a[60:63], v[76:79]
M v[76:79], a[168:171], a[56:59], v[76:79]
ds_read_b64_tr_b16 a[136:137], v17 offset:32768
ds_read_b64_tr_b16 a[138:139], v17 offset:34816
M v[80:83], a[168:171], a[64:67], v[80:83]
M v[80:83], a[172:175], a[68:71], v[80:83]
buffer_load_dwordx4 v9, s[12:15], s24 offen offset:3072 lds
M v[84:87], a[172:175], a[76:79], v[84:87]
M v[84:87], a[168:171], a[72:75], v[84:87]
ds_read_b64_tr_b16 a[144:145], v18 offset:32768
ds_read_b64_tr_b16 a[146:147], v18 offset:34816
M v[88:91], a[168:171], a[80:83], v[88:91]
M v[88:91], a[172:175], a[84:87], v[88:91]
M v[92:95], a[172:175], a[92:95], v[92:95]
s_add_u32 s24, s24, 262144
s_cmp_eq_u32 s24, s27
s_cselect_b32 s24, s28, s24
s_sub_u32 s6, s6, 1
s_cmp_eq_u32 s6, 0
s_cselect_b64 s[12:13], s[64:65], s[12:13]
M v[92:95], a[168:171], a[88:91], v[92:95]
s_waitcnt lgkmcnt(15)
ds_read_b64_tr_b16 a[152:153], v19 offset:32768
ds_read_b64_tr_b16 a[154:155], v19 offset:34816
M v[96:99], a[176:179], a[32:35], v[96:99]
M v[96:99], a[180:183], a[36:39], v[96:99]
M v[100:103], a[180:183], a[44:47], v[100:103]
M v[100:103], a[176:179], a[40:43], v[100:103]
M v[104:107], a[176:179], a[48:51], v[104:107]
s_add_u32 s94, s93, 0
buffer_store_dwordx4 a[212:215], v1, s[16:19], s94 offen offset:1024 sc1
M v[104:107], a[180:183], a[52:55], v[104:107]
M v[108:111], a[180:183], a[60:63], v[108:111]
M v[108:111], a[176:179], a[56:59], v[108:111]
s_waitcnt vmcnt(21) lgkmcnt(0)
s_barrier
ds_read_b128 a[160:163], v10 offset:16384
ds_read_b128 a[164:167], v11 offset:16384
M v[112:115], a[176:179], a[64:67], v[112:115]
s_add_u32 m0, s29, 0
s_nop 0
buffer_load_dwordx4 v2, s[8:11], s23 offen offset:0 lds
M v[112:115], a[180:183], a[68:71], v[112:115]
M v[116:119], a[180:183], a[76:79], v[116:119]
M v[116:119], a[176:179], a[72:75], v[116:119]
ds_read_b64_tr_b16 a[100:101], v12 offset:49152
ds_read_b64_tr_b16 a[102:103], v12 offset:51200
M v[120:123], a[176:179], a[80:83], v[120:123]
M v[120:123], a[180:183], a[84:87], v[120:123]
M v[124:127], a[180:183], a[92:95], v[124:127]
buffer_load_dwordx4 v3, s[8:11], s23 offen offset:1024 lds
M v[124:127], a[176:179], a[88:91], v[124:127]
M v[128:131], a[184:187], a[32:35], v[128:131]
M v[128:131], a[188:191], a[36:39], v[128:131]
ds_read_b128 a[168:171], v10 offset:18432
ds_read_b128 a[172:175], v11 offset:18432
ds_read_b64_tr_b16 a[108:109], v13 offset:49152
ds_read_b64_tr_b16 a[110:111], v13 offset:51200
M v[132:135], a[188:191], a[44:47], v[132:135]
M v[132:135], a[184:187], a[40:43], v[132:135]
M v[136:139], a[184:187], a[48:51], v[136:139]
M v[136:139], a[188:191], a[52:55], v[136:139]
buffer_load_dwordx4 v4, s[8:11], s23 offen offset:2048 lds
M v[140:143], a[188:191], a[60:63], v[140:143]
M v[140:143], a[184:187], a[56:59], v[140:143]
ds_read_b64_tr_b16 a[116:117], v14 offset:49152
ds_read_b64_tr_b16 a[118:119], v14 offset:51200
M v[144:147], a[184:187], a[64:67], v[144:147]
M v[144:147], a[188:191], a[68:71], v[144:147]
M v[148:151], a[188:191], a[76:79], v[148:151]
M v[148:151], a[184:187], a[72:75], v[148:151]
buffer_load_dwordx4 v5, s[8:11], s23 offen offset:3072 lds
M v[152:155], a[184:187], a[80:83], v[152:155]
M v[152:155], a[188:191], a[84:87], v[152:155]
ds_read_b64_tr_b16 a[124:125], v15 offset:49152
ds_read_b64_tr_b16 a[126:127], v15 offset:51200
M v[156:159], a[188:191], a[92:95], v[156:159]
M v[156:159], a[184:187], a[88:91], v[156:159]
s_waitcnt lgkmcnt(10)
M v[160:163], a[160:163], a[32:35], v[160:163]
s_add_u32 s94, s93, 0
buffer_store_dwordx4 a[216:219], v1, s[16:19], s94 offen offset:2048 sc1
M v[160:163], a[164:167], a[36:39], v[160:163]
ds_read_b128 a[176:179], v10 offset:20480
ds_read_b128 a[180:183], v11 offset:20480
M v[164:167], a[164:167], a[44:47], v[164:167]
M v[164:167], a[160:163], a[40:43], v[164:167]
ds_read_b64_tr_b16 a[132:133], v16 offset:49152
ds_read_b64_tr_b16 a[134:135], v16 offset:51200
M v[168:171], a[160:163], a[48:51], v[168:171]
M v[168:171], a[164:167], a[52:55], v[168:171]
s_add_u32 m0, s29, 98304
s_nop 0
buffer_load_dwordx4 v6, s[12:15], s24 offen offset:0 lds
M v[172:175], a[164:167], a[60:63], v[172:175]
M v[172:175], a[160:163], a[56:59], v[172:175]
M v[176:179], a[160:163], a[64:67], v[176:179]
M v[176:179], a[164:167], a[68:71], v[176:179]
ds_read_b64_tr_b16 a[140:141], v17 offset:49152
ds_read_b64_tr_b16 a[142:143], v17 offset:51200
M v[180:183], a[164:167], a[76:79], v[180:183]
M v[180:183], a[160:163], a[72:75], v[180:183]
buffer_load_dwordx4 v7, s[12:15], s24 offen offset:1024 lds
M v[184:187], a[160:163], a[80:83], v[184:187]
M v[184:187], a[164:167], a[84:87], v[184:187]
M v[188:191], a[164:167], a[92:95], v[188:191]
M v[188:191], a[160:163], a[88:91], v[188:191]
s_waitcnt lgkmcnt(12)
ds_read_b64_tr_b16 a[148:149], v18 offset:49152
ds_read_b64_tr_b16 a[150:151], v18 offset:51200
M v[192:195], a[168:171], a[32:35], v[192:195]
M v[192:195], a[172:175], a[36:39], v[192:195]
ds_read_b128 a[184:187], v10 offset:22528
ds_read_b128 a[188:191], v11 offset:22528
M v[196:199], a[172:175], a[44:47], v[196:199]
buffer_load_dwordx4 v8, s[12:15], s24 offen offset:2048 lds
M v[196:199], a[168:171], a[40:43], v[196:199]
M v[200:203], a[168:171], a[48:51], v[200:203]
M v[200:203], a[172:175], a[52:55], v[200:203]
ds_read_b64_tr_b16 a[156:157], v19 offset:49152
ds_read_b64_tr_b16 a[158:159], v19 offset:51200
M v[204:207], a[172:175], a[60:63], v[204:207]
M v[204:207], a[168:171], a[56:59], v[204:207]
M v[208:211], a[168:171], a[64:67], v[208:211]
buffer_load_dwordx4 v9, s[12:15], s24 offen offset:3072 lds
M v[208:211], a[172:175], a[68:71], v[208:211]
M v[212:215], a[172:175], a[76:79], v[212:215]
M v[212:215], a[168:171], a[72:75], v[212:215]
M v[216:219], a[168:171], a[80:83], v[216:219]
s_add_u32 s94, s93, 0
buffer_store_dwordx4 a[220:223], v1, s[16:19], s94 offen offset:3072 sc1
M v[216:219], a[172:175], a[84:87], v[216:219]
M v[220:223], a[172:175], a[92:95], v[220:223]
s_add_u32 s24, s24, 262144
M v[220:223], a[168:171], a[88:91], v[220:223]
s_waitcnt lgkmcnt(10)
M v[224:227], a[176:179], a[32:35], v[224:227]
M v[224:227], a[180:183], a[36:39], v[224:227]
M v[228:231], a[180:183], a[44:47], v[228:231]
M v[228:231], a[176:179], a[40:43], v[228:231]
M v[232:235], a[176:179], a[48:51], v[232:235]
M v[232:235], a[180:183], a[52:55], v[232:235]
M v[236:239], a[180:183], a[60:63], v[236:239]
M v[236:239], a[176:179], a[56:59], v[236:239]
s_waitcnt vmcnt(21) lgkmcnt(0)
s_barrier
ds_read_b128 a[160:163], v10 offset:32768
ds_read_b128 a[164:167], v11 offset:32768
M v[240:243], a[176:179], a[64:67], v[240:243]
s_add_u32 m0, s29, 16384
s_add_u32 s3, s23, s31
buffer_load_dwordx4 v2, s[8:11], s3 offen offset:0 lds
M v[240:243], a[180:183], a[68:71], v[240:243]
M v[244:247], a[180:183], a[76:79], v[244:247]
M v[244:247], a[176:179], a[72:75], v[244:247]
M v[248:251], a[176:179], a[80:83], v[248:251]
M v[248:251], a[180:183], a[84:87], v[248:251]
buffer_load_dwordx4 v3, s[8:11], s3 offen offset:1024 lds
M v[252:255], a[180:183], a[92:95], v[252:255]
M v[252:255], a[176:179], a[88:91], v[252:255]
M a[0:3], a[184:187], a[32:35], a[0:3]
M a[0:3], a[188:191], a[36:39], a[0:3]
ds_read_b128 a[168:171], v10 offset:34816
ds_read_b128 a[172:175], v11 offset:34816
M a[4:7], a[188:191], a[44:47], a[4:7]
M a[4:7], a[184:187], a[40:43], a[4:7]
M a[8:11], a[184:187], a[48:51], a[8:11]
buffer_load_dwordx4 v4, s[8:11], s3 offen offset:2048 lds
M a[8:11], a[188:191], a[52:55], a[8:11]
M a[12:15], a[188:191], a[60:63], a[12:15]
M a[12:15], a[184:187], a[56:59], a[12:15]
M a[16:19], a[184:187], a[64:67], a[16:19]
M a[16:19], a[188:191], a[68:71], a[16:19]
buffer_load_dwordx4 v5, s[8:11], s3 offen offset:3072 lds
M a[20:23], a[188:191], a[76:79], a[20:23]
M a[20:23], a[184:187], a[72:75], a[20:23]
M a[24:27], a[184:187], a[80:83], a[24:27]
M a[24:27], a[188:191], a[84:87], a[24:27]
M a[28:31], a[188:191], a[92:95], a[28:31]
M a[28:31], a[184:187], a[88:91], a[28:31]
s_waitcnt lgkmcnt(2)
M v[32:35], a[160:163], a[96:99], v[32:35]
s_add_u32 s23, s23, 128
s_cmp_eq_u32 s23, s25
s_cselect_b32 s23, s26, s23
M v[32:35], a[164:167], a[100:103], v[32:35]
ds_read_b128 a[176:179], v10 offset:36864
ds_read_b128 a[180:183], v11 offset:36864
M v[36:39], a[164:167], a[108:111], v[36:39]
M v[36:39], a[160:163], a[104:107], v[36:39]
ds_read_b64_tr_b16 a[32:33], v12 offset:0
ds_read_b64_tr_b16 a[34:35], v12 offset:2048
M v[40:43], a[160:163], a[112:115], v[40:43]
M v[40:43], a[164:167], a[116:119], v[40:43]
M v[44:47], a[164:167], a[124:127], v[44:47]
s_add_u32 m0, s29, 114688
s_nop 0
buffer_load_dwordx4 v6, s[12:15], s24 offen offset:0 lds
M v[44:47], a[160:163], a[120:123], v[44:47]
ds_read_b64_tr_b16 a[40:41], v13 offset:0
ds_read_b64_tr_b16 a[42:43], v13 offset:2048
M v[48:51], a[160:163], a[128:131], v[48:51]
s_add_u32 s94, s93, 4096
buffer_store_dwordx4 a[224:227], v1, s[16:19], s94 offen offset:0 sc1
M v[48:51], a[164:167], a[132:135], v[48:51]
M v[52:55], a[164:167], a[140:143], v[52:55]
M v[52:55], a[160:163], a[136:139], v[52:55]
ds_read_b64_tr_b16 a[48:49], v14 offset:0
ds_read_b64_tr_b16 a[50:51], v14 offset:2048
M v[56:59], a[160:163], a[144:147], v[56:59]
M v[56:59], a[164:167], a[148:151], v[56:59]
buffer_load_dwordx4 v7, s[12:15], s24 offen offset:1024 lds
M v[60:63], a[164:167], a[156:159], v[60:63]
M v[60:63], a[160:163], a[152:155], v[60:63]
s_waitcnt lgkmcnt(8)
ds_read_b64_tr_b16 a[56:57], v15 offset:0
ds_read_b64_tr_b16 a[58:59], v15 offset:2048
M v[64:67], a[168:171], a[96:99], v[64:67]
M v[64:67], a[172:175], a[100:103], v[64:67]
ds_read_b128 a[184:187], v10 offset:38912
ds_read_b128 a[188:191], v11 offset:38912
M v[68:71], a[172:175], a[108:111], v[68:71]
M v[68:71], a[168:171], a[104:107], v[68:71]
ds_read_b64_tr_b16 a[64:65], v16 offset:0
ds_read_b64_tr_b16 a[66:67], v16 offset:2048
M v[72:75], a[168:171], a[112:115], v[72:75]
buffer_load_dwordx4 v8, s[12:15], s24 offen offset:2048 lds
M v[72:75], a[172:175], a[116:119], v[72:75]
M v[76:79], a[172:175], a[124:127], v[76:79]
M v[76:79], a[168:171], a[120:123], v[76:79]
ds_read_b64_tr_b16 a[72:73], v17 offset:0
ds_read_b64_tr_b16 a[74:75], v17 offset:2048
M v[80:83], a[168:171], a[128:131], v[80:83]
M v[80:83], a[172:175], a[132:135], v[80:83]
buffer_load_dwordx4 v9, s[12:15], s24 offen offset:3072 lds
M v[84:87], a[172:175], a[140:143], v[84:87]
M v[84:87], a[168:171], a[136:139], v[84:87]
ds_read_b64_tr_b16 a[80:81], v18 offset:0
ds_read_b64_tr_b16 a[82:83], v18 offset:2048
M v[88:91], a[168:171], a[144:147], v[88:91]
M v[88:91], a[172:175], a[148:151], v[88:91]
M v[92:95], a[172:175], a[156:159], v[92:95]
s_add_u32 s24, s24, 262144
s_cmp_eq_u32 s24, s27
s_cselect_b32 s24, s28, s24
s_sub_u32 s6, s6, 1
s_cmp_eq_u32 s6, 0
s_cselect_b64 s[12:13], s[64:65], s[12:13]
M v[92:95], a[168:171], a[152:155], v[92:95]
s_waitcnt lgkmcnt(15)
ds_read_b64_tr_b16 a[88:89], v19 offset:0
ds_read_b64_tr_b16 a[90:91], v19 offset:2048
M v[96:99], a[176:179], a[96:99], v[96:99]
M v[96:99], a[180:183], a[100:103], v[96:99]
M v[100:103], a[180:183], a[108:111], v[100:103]
M v[100:103], a[176:179], a[104:107], v[100:103]
M v[104:107], a[176:179], a[112:115], v[104:107]
s_add_u32 s94, s93, 4096
buffer_store_dwordx4 a[228:231], v1, s[16:19], s94 offen offset:1024 sc1
M v[104:107], a[180:183], a[116:119], v[104:107]
M v[108:111], a[180:183], a[124:127], v[108:111]
M v[108:111], a[176:179], a[120:123], v[108:111]
s_waitcnt vmcnt(21) lgkmcnt(0)
s_barrier
ds_read_b128 a[160:163], v10 offset:49152
ds_read_b128 a[164:167], v11 offset:49152
M v[112:115], a[176:179], a[128:131], v[112:115]
s_add_u32 m0, s29, 32768
s_nop 0
buffer_load_dwordx4 v2, s[8:11], s23 offen offset:0 lds
M v[112:115], a[180:183], a[132:135], v[112:115]
M v[116:119], a[180:183], a[140:143], v[116:119]
M v[116:119], a[176:179], a[136:139], v[116:119]
ds_read_b64_tr_b16 a[36:37], v12 offset:16384
ds_read_b64_tr_b16 a[38:39], v12 offset:18432
M v[120:123], a[176:179], a[144:147], v[120:123]
M v[120:123], a[180:183], a[148:151], v[120:123]
M v[124:127], a[180:183], a[156:159], v[124:127]
buffer_load_dwordx4 v3, s[8:11], s23 offen offset:1024 lds
M v[124:127], a[176:179], a[152:155], v[124:127]
M v[128:131], a[184:187], a[96:99], v[128:131]
M v[128:131], a[188:191], a[100:103], v[128:131]
ds_read_b128 a[168:171], v10 offset:51200
ds_read_b128 a[172:175], v11 offset:51200
ds_read_b64_tr_b16 a[44:45], v13 offset:16384
ds_read_b64_tr_b16 a[46:47], v13 offset:18432
M v[132:135], a[188:191], a[108:111], v[132:135]
M v[132:135], a[184:187], a[104:107], v[132:135]
M v[136:139], a[184:187], a[112:115], v[136:139]
M v[136:139], a[188:191], a[116:119], v[136:139]
buffer_load_dwordx4 v4, s[8:11], s23 offen offset:2048 lds
M v[140:143], a[188:191], a[124:127], v[140:143]
M v[140:143], a[184:187], a[120:123], v[140:143]
ds_read_b64_tr_b16 a[52:53], v14 offset:16384
ds_read_b64_tr_b16 a[54:55], v14 offset:18432
M v[144:147], a[184:187], a[128:131], v[144:147]
M v[144:147], a[188:191], a[132:135], v[144:147]
M v[148:151], a[188:191], a[140:143], v[148:151]
M v[148:151], a[184:187], a[136:139], v[148:151]
buffer_load_dwordx4 v5, s[8:11], s23 offen offset:3072 lds
M v[152:155], a[184:187], a[144:147], v[152:155]
M v[152:155], a[188:191], a[148:151], v[152:155]
ds_read_b64_tr_b16 a[60:61], v15 offset:16384
ds_read_b64_tr_b16 a[62:63], v15 offset:18432
M v[156:159], a[188:191], a[156:159], v[156:159]
M v[156:159], a[184:187], a[152:155], v[156:159]
s_waitcnt lgkmcnt(10)
M v[160:163], a[160:163], a[96:99], v[160:163]
s_add_u32 s94, s93, 4096
buffer_store_dwordx4 a[232:235], v1, s[16:19], s94 offen offset:2048 sc1
M v[160:163], a[164:167], a[100:103], v[160:163]
ds_read_b128 a[176:179], v10 offset:53248
ds_read_b128 a[180:183], v11 offset:53248
M v[164:167], a[164:167], a[108:111], v[164:167]
M v[164:167], a[160:163], a[104:107], v[164:167]
ds_read_b64_tr_b16 a[68:69], v16 offset:16384
ds_read_b64_tr_b16 a[70:71], v16 offset:18432
M v[168:171], a[160:163], a[112:115], v[168:171]
M v[168:171], a[164:167], a[116:119], v[168:171]
s_add_u32 m0, s29, 65536
s_nop 0
buffer_load_dwordx4 v6, s[12:15], s24 offen offset:0 lds
M v[172:175], a[164:167], a[124:127], v[172:175]
M v[172:175], a[160:163], a[120:123], v[172:175]
M v[176:179], a[160:163], a[128:131], v[176:179]
M v[176:179], a[164:167], a[132:135], v[176:179]
ds_read_b64_tr_b16 a[76:77], v17 offset:16384
ds_read_b64_tr_b16 a[78:79], v17 offset:18432
M v[180:183], a[164:167], a[140:143], v[180:183]
M v[180:183], a[160:163], a[136:139], v[180:183]
buffer_load_dwordx4 v7, s[12:15], s24 offen offset:1024 lds
M v[184:187], a[160:163], a[144:147], v[184:187]
M v[184:187], a[164:167], a[148:151], v[184:187]
M v[188:191], a[164:167], a[156:159], v[188:191]
M v[188:191], a[160:163], a[152:155], v[188:191]
s_waitcnt lgkmcnt(12)
ds_read_b64_tr_b16 a[84:85], v18 offset:16384
ds_read_b64_tr_b16 a[86:87], v18 offset:18432
M v[192:195], a[168:171], a[96:99], v[192:195]
M v[192:195], a[172:175], a[100:103], v[192:195]
ds_read_b128 a[184:187], v10 offset:55296
ds_read_b128 a[188:191], v11 offset:55296
M v[196:199], a[172:175], a[108:111], v[196:199]
buffer_load_dwordx4 v8, s[12:15], s24 offen offset:2048 lds
M v[196:199], a[168:171], a[104:107], v[196:199]
M v[200:203], a[168:171], a[112:115], v[200:203]
M v[200:203], a[172:175], a[116:119], v[200:203]
ds_read_b64_tr_b16 a[92:93], v19 offset:16384
ds_read_b64_tr_b16 a[94:95], v19 offset:18432
M v[204:207], a[172:175], a[124:127], v[204:207]
M v[204:207], a[168:171], a[120:123], v[204:207]
M v[208:211], a[168:171], a[128:131], v[208:211]
buffer_load_dwordx4 v9, s[12:15], s24 offen offset:3072 lds
M v[208:211], a[172:175], a[132:135], v[208:211]
M v[212:215], a[172:175], a[140:143], v[212:215]
M v[212:215], a[168:171], a[136:139], v[212:215]
M v[216:219], a[168:171], a[144:147], v[216:219]
s_add_u32 s94, s93, 4096
buffer_store_dwordx4 a[236:239], v1, s[16:19], s94 offen offset:3072 sc1
M v[216:219], a[172:175], a[148:151], v[216:219]
M v[220:223], a[172:175], a[156:159], v[220:223]
s_add_u32 s24, s24, 262144
M v[220:223], a[168:171], a[152:155], v[220:223]
s_waitcnt lgkmcnt(10)
M v[224:227], a[176:179], a[96:99], v[224:227]
M v[224:227], a[180:183], a[100:103], v[224:227]
M v[228:231], a[180:183], a[108:111], v[228:231]
M v[228:231], a[176:179], a[104:107], v[228:231]
M v[232:235], a[176:179], a[112:115], v[232:235]
M v[232:235], a[180:183], a[116:119], v[232:235]
M v[236:239], a[180:183], a[124:127], v[236:239]
M v[236:239], a[176:179], a[120:123], v[236:239]
s_waitcnt vmcnt(21) lgkmcnt(0)
s_barrier
ds_read_b128 a[160:163], v10 offset:0
ds_read_b128 a[164:167], v11 offset:0
M v[240:243], a[176:179], a[128:131], v[240:243]
s_add_u32 m0, s29, 49152
s_add_u32 s3, s23, s31
buffer_load_dwordx4 v2, s[8:11], s3 offen offset:0 lds
M v[240:243], a[180:183], a[132:135], v[240:243]
M v[244:247], a[180:183], a[140:143], v[244:247]
M v[244:247], a[176:179], a[136:139], v[244:247]
M v[248:251], a[176:179], a[144:147], v[248:251]
M v[248:251], a[180:183], a[148:151], v[248:251]
buffer_load_dwordx4 v3, s[8:11], s3 offen offset:1024 lds
M v[252:255], a[180:183], a[156:159], v[252:255]
M v[252:255], a[176:179], a[152:155], v[252:255]
M a[0:3], a[184:187], a[96:99], a[0:3]
M a[0:3], a[188:191], a[100:103], a[0:3]
ds_read_b128 a[168:171], v10 offset:2048
ds_read_b128 a[172:175], v11 offset:2048
M a[4:7], a[188:191], a[108:111], a[4:7]
M a[4:7], a[184:187], a[104:107], a[4:7]
M a[8:11], a[184:187], a[112:115], a[8:11]
buffer_load_dwordx4 v4, s[8:11], s3 offen offset:2048 lds
M a[8:11], a[188:191], a[116:119], a[8:11]
M a[12:15], a[188:191], a[124:127], a[12:15]
M a[12:15], a[184:187], a[120:123], a[12:15]
M a[16:19], a[184:187], a[128:131], a[16:19]
M a[16:19], a[188:191], a[132:135], a[16:19]
buffer_load_dwordx4 v5, s[8:11], s3 offen offset:3072 lds
M a[20:23], a[188:191], a[140:143], a[20:23]
M a[20:23], a[184:187], a[136:139], a[20:23]
M a[24:27], a[184:187], a[144:147], a[24:27]
M a[24:27], a[188:191], a[148:151], a[24:27]
M a[28:31], a[188:191], a[156:159], a[28:31]
M a[28:31], a[184:187], a[152:155], a[28:31]
s_waitcnt lgkmcnt(2)
M v[32:35], a[160:163], a[32:35], v[32:35]
s_add_u32 s23, s23, 128
s_cmp_eq_u32 s23, s25
s_cselect_b32 s23, s26, s23
M v[32:35], a[164:167], a[36:39], v[32:35]
ds_read_b128 a[176:179], v10 offset:4096
ds_read_b128 a[180:183], v11 offset:4096
M v[36:39], a[164:167], a[44:47], v[36:39]
M v[36:39], a[160:163], a[40:43], v[36:39]
ds_read_b64_tr_b16 a[96:97], v12 offset:32768
ds_read_b64_tr_b16 a[98:99], v12 offset:34816
M v[40:43], a[160:163], a[48:51], v[40:43]
M v[40:43], a[164:167], a[52:55], v[40:43]
M v[44:47], a[164:167], a[60:63], v[44:47]
s_add_u32 m0, s29, 81920
s_nop 0
buffer_load_dwordx4 v6, s[12:15], s24 offen offset:0 lds
M v[44:47], a[160:163], a[56:59], v[44:47]
ds_read_b64_tr_b16 a[104:105], v13 offset:32768
ds_read_b64_tr_b16 a[106:107], v13 offset:34816
M v[48:51], a[160:163], a[64:67], v[48:51]
s_add_u32 s94, s93, 8192
buffer_store_dwordx4 a[240:243], v1, s[16:19], s94 offen offset:0 sc1
M v[48:51], a[164:167], a[68:71], v[48:51]
M v[52:55], a[164:167], a[76:79], v[52:55]
M v[52:55], a[160:163], a[72:75], v[52:55]
ds_read_b64_tr_b16 a[112:113], v14 offset:32768
ds_read_b64_tr_b16 a[114:115], v14 offset:34816
M v[56:59], a[160:163], a[80:83], v[56:59]
M v[56:59], a[164:167], a[84:87], v[56:59]
buffer_load_dwordx4 v7, s[12:15], s24 offen offset:1024 lds
M v[60:63], a[164:167], a[92:95], v[60:63]
M v[60:63], a[160:163], a[88:91], v[60:63]
s_waitcnt lgkmcnt(8)
ds_read_b64_tr_b16 a[120:121], v15 offset:32768
ds_read_b64_tr_b16 a[122:123], v15 offset:34816
M v[64:67], a[168:171], a[32:35], v[64:67]
M v[64:67], a[172:175], a[36:39], v[64:67]
ds_read_b128 a[184:187], v10 offset:6144
ds_read_b128 a[188:191], v11 offset:6144
M v[68:71], a[172:175], a[44:47], v[68:71]
M v[68:71], a[168:171], a[40:43], v[68:71]
ds_read_b64_tr_b16 a[128:129], v16 offset:32768
ds_read_b64_tr_b16 a[130:131], v16 offset:34816
M v[72:75], a[168:171], a[48:51], v[72:75]
buffer_load_dwordx4 v8, s[12:15], s24 offen offset:2048 lds
M v[72:75], a[172:175], a[52:55], v[72:75]
M v[76:79], a[172:175], a[60:63], v[76:79]
M v[76:79], a[168:171], a[56:59], v[76:79]
ds_read_b64_tr_b16 a[136:137], v17 offset:32768
ds_read_b64_tr_b16 a[138:139], v17 offset:34816
M v[80:83], a[168:171], a[64:67], v[80:83]
M v[80:83], a[172:175], a[68:71], v[80:83]
buffer_load_dwordx4 v9, s[12:15], s24 offen offset:3072 lds
M v[84:87], a[172:175], a[76:79], v[84:87]
M v[84:87], a[168:171], a[72:75], v[84:87]
ds_read_b64_tr_b16 a[144:145], v18 offset:32768
ds_read_b64_tr_b16 a[146:147], v18 offset:34816
M v[88:91], a[168:171], a[80:83], v[88:91]
M v[88:91], a[172:175], a[84:87], v[88:91]
M v[92:95], a[172:175], a[92:95], v[92:95]
s_add_u32 s24, s24, 262144
s_cmp_eq_u32 s24, s27
s_cselect_b32 s24, s28, s24
s_sub_u32 s6, s6, 1
s_cmp_eq_u32 s6, 0
s_cselect_b64 s[12:13], s[64:65], s[12:13]
M v[92:95], a[168:171], a[88:91], v[92:95]
s_waitcnt lgkmcnt(15)
ds_read_b64_tr_b16 a[152:153], v19 offset:32768
ds_read_b64_tr_b16 a[154:155], v19 offset:34816
M v[96:99], a[176:179], a[32:35], v[96:99]
M v[96:99], a[180:183], a[36:39], v[96:99]
M v[100:103], a[180:183], a[44:47], v[100:103]
M v[100:103], a[176:179], a[40:43], v[100:103]
M v[104:107], a[176:179], a[48:51], v[104:107]
s_add_u32 s94, s93, 8192
buffer_store_dwordx4 a[244:247], v1, s[16:19], s94 offen offset:1024 sc1
M v[104:107], a[180:183], a[52:55], v[104:107]
M v[108:111], a[180:183], a[60:63], v[108:111]
M v[108:111], a[176:179], a[56:59], v[108:111]
s_waitcnt vmcnt(21) lgkmcnt(0)
s_barrier
ds_read_b128 a[160:163], v10 offset:16384
ds_read_b128 a[164:167], v11 offset:16384
M v[112:115], a[176:179], a[64:67], v[112:115]
s_add_u32 m0, s29, 0
s_nop 0
buffer_load_dwordx4 v2, s[8:11], s23 offen offset:0 lds
M v[112:115], a[180:183], a[68:71], v[112:115]
M v[116:119], a[180:183], a[76:79], v[116:119]
M v[116:119], a[176:179], a[72:75], v[116:119]
ds_read_b64_tr_b16 a[100:101], v12 offset:49152
ds_read_b64_tr_b16 a[102:103], v12 offset:51200
M v[120:123], a[176:179], a[80:83], v[120:123]
M v[120:123], a[180:183], a[84:87], v[120:123]
M v[124:127], a[180:183], a[92:95], v[124:127]
buffer_load_dwordx4 v3, s[8:11], s23 offen offset:1024 lds
M v[124:127], a[176:179], a[88:91], v[124:127]
M v[128:131], a[184:187], a[32:35], v[128:131]
M v[128:131], a[188:191], a[36:39], v[128:131]
ds_read_b128 a[168:171], v10 offset:18432
ds_read_b128 a[172:175], v11 offset:18432
ds_read_b64_tr_b16 a[108:109], v13 offset:49152
ds_read_b64_tr_b16 a[110:111], v13 offset:51200
M v[132:135], a[188:191], a[44:47], v[132:135]
M v[132:135], a[184:187], a[40:43], v[132:135]
M v[136:139], a[184:187], a[48:51], v[136:139]
M v[136:139], a[188:191], a[52:55], v[136:139]
buffer_load_dwordx4 v4, s[8:11], s23 offen offset:2048 lds
M v[140:143], a[188:191], a[60:63], v[140:143]
M v[140:143], a[184:187], a[56:59], v[140:143]
ds_read_b64_tr_b16 a[116:117], v14 offset:49152
ds_read_b64_tr_b16 a[118:119], v14 offset:51200
M v[144:147], a[184:187], a[64:67], v[144:147]
M v[144:147], a[188:191], a[68:71], v[144:147]
M v[148:151], a[188:191], a[76:79], v[148:151]
M v[148:151], a[184:187], a[72:75], v[148:151]
buffer_load_dwordx4 v5, s[8:11], s23 offen offset:3072 lds
M v[152:155], a[184:187], a[80:83], v[152:155]
M v[152:155], a[188:191], a[84:87], v[152:155]
ds_read_b64_tr_b16 a[124:125], v15 offset:49152
ds_read_b64_tr_b16 a[126:127], v15 offset:51200
M v[156:159], a[188:191], a[92:95], v[156:159]
M v[156:159], a[184:187], a[88:91], v[156:159]
s_waitcnt lgkmcnt(10)
M v[160:163], a[160:163], a[32:35], v[160:163]
s_add_u32 s94, s93, 8192
buffer_store_dwordx4 a[248:251], v1, s[16:19], s94 offen offset:2048 sc1
M v[160:163], a[164:167], a[36:39], v[160:163]
ds_read_b128 a[176:179], v10 offset:20480
ds_read_b128 a[180:183], v11 offset:20480
M v[164:167], a[164:167], a[44:47], v[164:167]
M v[164:167], a[160:163], a[40:43], v[164:167]
ds_read_b64_tr_b16 a[132:133], v16 offset:49152
ds_read_b64_tr_b16 a[134:135], v16 offset:51200
M v[168:171], a[160:163], a[48:51], v[168:171]
M v[168:171], a[164:167], a[52:55], v[168:171]
s_add_u32 m0, s29, 98304
s_nop 0
buffer_load_dwordx4 v6, s[12:15], s24 offen offset:0 lds
M v[172:175], a[164:167], a[60:63], v[172:175]
M v[172:175], a[160:163], a[56:59], v[172:175]
M v[176:179], a[160:163], a[64:67], v[176:179]
M v[176:179], a[164:167], a[68:71], v[176:179]
ds_read_b64_tr_b16 a[140:141], v17 offset:49152
ds_read_b64_tr_b16 a[142:143], v17 offset:51200
M v[180:183], a[164:167], a[76:79], v[180:183]
M v[180:183], a[160:163], a[72:75], v[180:183]
buffer_load_dwordx4 v7, s[12:15], s24 offen offset:1024 lds
M v[184:187], a[160:163], a[80:83], v[184:187]
M v[184:187], a[164:167], a[84:87], v[184:187]
M v[188:191], a[164:167], a[92:95], v[188:191]
M v[188:191], a[160:163], a[88:91], v[188:191]
s_waitcnt lgkmcnt(12)
ds_read_b64_tr_b16 a[148:149], v18 offset:49152
ds_read_b64_tr_b16 a[150:151], v18 offset:51200
M v[192:195], a[168:171], a[32:35], v[192:195]
M v[192:195], a[172:175], a[36:39], v[192:195]
ds_read_b128 a[184:187], v10 offset:22528
ds_read_b128 a[188:191], v11 offset:22528
M v[196:199], a[172:175], a[44:47], v[196:199]
buffer_load_dwordx4 v8, s[12:15], s24 offen offset:2048 lds
M v[196:199], a[168:171], a[40:43], v[196:199]
M v[200:203], a[168:171], a[48:51], v[200:203]
M v[200:203], a[172:175], a[52:55], v[200:203]
ds_read_b64_tr_b16 a[156:157], v19 offset:49152
ds_read_b64_tr_b16 a[158:159], v19 offset:51200
M v[204:207], a[172:175], a[60:63], v[204:207]
M v[204:207], a[168:171], a[56:59], v[204:207]
M v[208:211], a[168:171], a[64:67], v[208:211]
buffer_load_dwordx4 v9, s[12:15], s24 offen offset:3072 lds
M v[208:211], a[172:175], a[68:71], v[208:211]
M v[212:215], a[172:175], a[76:79], v[212:215]
M v[212:215], a[168:171], a[72:75], v[212:215]
M v[216:219], a[168:171], a[80:83], v[216:219]
s_add_u32 s94, s93, 8192
buffer_store_dwordx4 a[252:255], v1, s[16:19], s94 offen offset:3072 sc1
M v[216:219], a[172:175], a[84:87], v[216:219]
M v[220:223], a[172:175], a[92:95], v[220:223]
s_add_u32 s24, s24, 262144
M v[220:223], a[168:171], a[88:91], v[220:223]
s_waitcnt lgkmcnt(10)
M v[224:227], a[176:179], a[32:35], v[224:227]
M v[224:227], a[180:183], a[36:39], v[224:227]
M v[228:231], a[180:183], a[44:47], v[228:231]
M v[228:231], a[176:179], a[40:43], v[228:231]
M v[232:235], a[176:179], a[48:51], v[232:235]
M v[232:235], a[180:183], a[52:55], v[232:235]
M v[236:239], a[180:183], a[60:63], v[236:239]
M v[236:239], a[176:179], a[56:59], v[236:239]
s_waitcnt vmcnt(21) lgkmcnt(0)
s_barrier
ds_read_b128 a[160:163], v10 offset:32768
ds_read_b128 a[164:167], v11 offset:32768
M v[240:243], a[176:179], a[64:67], v[240:243]
s_add_u32 m0, s29, 16384
s_add_u32 s3, s23, s31
buffer_load_dwordx4 v2, s[8:11], s3 offen offset:0 lds
M v[240:243], a[180:183], a[68:71], v[240:243]
M v[244:247], a[180:183], a[76:79], v[244:247]
M v[244:247], a[176:179], a[72:75], v[244:247]
M v[248:251], a[176:179], a[80:83], v[248:251]
M v[248:251], a[180:183], a[84:87], v[248:251]
buffer_load_dwordx4 v3, s[8:11], s3 offen offset:1024 lds
M v[252:255], a[180:183], a[92:95], v[252:255]
M v[252:255], a[176:179], a[88:91], v[252:255]
M a[0:3], a[184:187], a[32:35], a[0:3]
M a[0:3], a[188:191], a[36:39], a[0:3]
ds_read_b128 a[168:171], v10 offset:34816
ds_read_b128 a[172:175], v11 offset:34816
M a[4:7], a[188:191], a[44:47], a[4:7]
M a[4:7], a[184:187], a[40:43], a[4:7]
M a[8:11], a[184:187], a[48:51], a[8:11]
buffer_load_dwordx4 v4, s[8:11], s3 offen offset:2048 lds
M a[8:11], a[188:191], a[52:55], a[8:11]
M a[12:15], a[188:191], a[60:63], a[12:15]
M a[12:15], a[184:187], a[56:59], a[12:15]
M a[16:19], a[184:187], a[64:67], a[16:19]
M a[16:19], a[188:191], a[68:71], a[16:19]
buffer_load_dwordx4 v5, s[8:11], s3 offen offset:3072 lds
M a[20:23], a[188:191], a[76:79], a[20:23]
M a[20:23], a[184:187], a[72:75], a[20:23]
M a[24:27], a[184:187], a[80:83], a[24:27]
M a[24:27], a[188:191], a[84:87], a[24:27]
M a[28:31], a[188:191], a[92:95], a[28:31]
M a[28:31], a[184:187], a[88:91], a[28:31]
s_waitcnt lgkmcnt(2)
M v[32:35], a[160:163], a[96:99], v[32:35]
s_add_u32 s23, s23, 128
s_cmp_eq_u32 s23, s25
s_cselect_b32 s23, s26, s23
M v[32:35], a[164:167], a[100:103], v[32:35]
ds_read_b128 a[176:179], v10 offset:36864
ds_read_b128 a[180:183], v11 offset:36864
M v[36:39], a[164:167], a[108:111], v[36:39]
M v[36:39], a[160:163], a[104:107], v[36:39]
ds_read_b64_tr_b16 a[32:33], v12 offset:0
ds_read_b64_tr_b16 a[34:35], v12 offset:2048
M v[40:43], a[160:163], a[112:115], v[40:43]
M v[40:43], a[164:167], a[116:119], v[40:43]
M v[44:47], a[164:167], a[124:127], v[44:47]
s_add_u32 m0, s29, 114688
s_nop 0
buffer_load_dwordx4 v6, s[12:15], s24 offen offset:0 lds
M v[44:47], a[160:163], a[120:123], v[44:47]
ds_read_b64_tr_b16 a[40:41], v13 offset:0
ds_read_b64_tr_b16 a[42:43], v13 offset:2048
M v[48:51], a[160:163], a[128:131], v[48:51]
M v[48:51], a[164:167], a[132:135], v[48:51]
M v[52:55], a[164:167], a[140:143], v[52:55]
M v[52:55], a[160:163], a[136:139], v[52:55]
ds_read_b64_tr_b16 a[48:49], v14 offset:0
ds_read_b64_tr_b16 a[50:51], v14 offset:2048
M v[56:59], a[160:163], a[144:147], v[56:59]
M v[56:59], a[164:167], a[148:151], v[56:59]
buffer_load_dwordx4 v7, s[12:15], s24 offen offset:1024 lds
M v[60:63], a[164:167], a[156:159], v[60:63]
M v[60:63], a[160:163], a[152:155], v[60:63]
s_waitcnt lgkmcnt(8)
ds_read_b64_tr_b16 a[56:57], v15 offset:0
ds_read_b64_tr_b16 a[58:59], v15 offset:2048
M v[64:67], a[168:171], a[96:99], v[64:67]
M v[64:67], a[172:175], a[100:103], v[64:67]
ds_read_b128 a[184:187], v10 offset:38912
ds_read_b128 a[188:191], v11 offset:38912
M v[68:71], a[172:175], a[108:111], v[68:71]
M v[68:71], a[168:171], a[104:107], v[68:71]
ds_read_b64_tr_b16 a[64:65], v16 offset:0
ds_read_b64_tr_b16 a[66:67], v16 offset:2048
M v[72:75], a[168:171], a[112:115], v[72:75]
buffer_load_dwordx4 v8, s[12:15], s24 offen offset:2048 lds
M v[72:75], a[172:175], a[116:119], v[72:75]
M v[76:79], a[172:175], a[124:127], v[76:79]
M v[76:79], a[168:171], a[120:123], v[76:79]
ds_read_b64_tr_b16 a[72:73], v17 offset:0
ds_read_b64_tr_b16 a[74:75], v17 offset:2048
M v[80:83], a[168:171], a[128:131], v[80:83]
M v[80:83], a[172:175], a[132:135], v[80:83]
M v[84:87], a[172:175], a[140:143], v[84:87]
buffer_load_dwordx4 v9, s[12:15], s24 offen offset:3072 lds
M v[84:87], a[168:171], a[136:139], v[84:87]
ds_read_b64_tr_b16 a[80:81], v18 offset:0
ds_read_b64_tr_b16 a[82:83], v18 offset:2048
M v[88:91], a[168:171], a[144:147], v[88:91]
M v[88:91], a[172:175], a[148:151], v[88:91]
M v[92:95], a[172:175], a[156:159], v[92:95]
M v[92:95], a[168:171], a[152:155], v[92:95]
s_waitcnt lgkmcnt(15)
ds_read_b64_tr_b16 a[88:89], v19 offset:0
ds_read_b64_tr_b16 a[90:91], v19 offset:2048
M v[96:99], a[176:179], a[96:99], v[96:99]
s_add_u32 s24, s24, 262144
s_cmp_eq_u32 s24, s27
s_cselect_b32 s24, s28, s24
s_sub_u32 s6, s6, 1
s_cmp_eq_u32 s6, 0
s_cselect_b64 s[12:13], s[64:65], s[12:13]
M v[96:99], a[180:183], a[100:103], v[96:99]
M v[100:103], a[180:183], a[108:111], v[100:103]
M v[100:103], a[176:179], a[104:107], v[100:103]
M v[104:107], a[176:179], a[112:115], v[104:107]
M v[104:107], a[180:183], a[116:119], v[104:107]
M v[108:111], a[180:183], a[124:127], v[108:111]
M v[108:111], a[176:179], a[120:123], v[108:111]
s_waitcnt vmcnt(19) lgkmcnt(0)
s_barrier
ds_read_b128 a[160:163], v10 offset:49152
ds_read_b128 a[164:167], v11 offset:49152
M v[112:115], a[176:179], a[128:131], v[112:115]
s_add_u32 m0, s29, 32768
s_nop 0
buffer_load_dwordx4 v2, s[8:11], s23 offen offset:0 lds
M v[112:115], a[180:183], a[132:135], v[112:115]
M v[116:119], a[180:183], a[140:143], v[116:119]
M v[116:119], a[176:179], a[136:139], v[116:119]
ds_read_b64_tr_b16 a[36:37], v12 offset:16384
ds_read_b64_tr_b16 a[38:39], v12 offset:18432
M v[120:123], a[176:179], a[144:147], v[120:123]
M v[120:123], a[180:183], a[148:151], v[120:123]
M v[124:127], a[180:183], a[156:159], v[124:127]
M v[124:127], a[176:179], a[152:155], v[124:127]
M v[128:131], a[184:187], a[96:99], v[128:131]
M v[128:131], a[188:191], a[100:103], v[128:131]
ds_read_b128 a[168:171], v10 offset:51200
ds_read_b128 a[172:175], v11 offset:51200
ds_read_b64_tr_b16 a[44:45], v13 offset:16384
ds_read_b64_tr_b16 a[46:47], v13 offset:18432
M v[132:135], a[188:191], a[108:111], v[132:135]
M v[132:135], a[184:187], a[104:107], v[132:135]
M v[136:139], a[184:187], a[112:115], v[136:139]
M v[136:139], a[188:191], a[116:119], v[136:139]
M v[140:143], a[188:191], a[124:127], v[140:143]
M v[140:143], a[184:187], a[120:123], v[140:143]
ds_read_b64_tr_b16 a[52:53], v14 offset:16384
ds_read_b64_tr_b16 a[54:55], v14 offset:18432
M v[144:147], a[184:187], a[128:131], v[144:147]
buffer_load_dwordx4 v3, s[8:11], s23 offen offset:1024 lds
M v[144:147], a[188:191], a[132:135], v[144:147]
M v[148:151], a[188:191], a[140:143], v[148:151]
M v[148:151], a[184:187], a[136:139], v[148:151]
M v[152:155], a[184:187], a[144:147], v[152:155]
M v[152:155], a[188:191], a[148:151], v[152:155]
ds_read_b64_tr_b16 a[60:61], v15 offset:16384
ds_read_b64_tr_b16 a[62:63], v15 offset:18432
M v[156:159], a[188:191], a[156:159], v[156:159]
M v[156:159], a[184:187], a[152:155], v[156:159]
s_waitcnt lgkmcnt(10)
M v[160:163], a[160:163], a[96:99], v[160:163]
M v[160:163], a[164:167], a[100:103], v[160:163]
ds_read_b128 a[176:179], v10 offset:53248
ds_read_b128 a[180:183], v11 offset:53248
M v[164:167], a[164:167], a[108:111], v[164:167]
M v[164:167], a[160:163], a[104:107], v[164:167]
ds_read_b64_tr_b16 a[68:69], v16 offset:16384
ds_read_b64_tr_b16 a[70:71], v16 offset:18432
M v[168:171], a[160:163], a[112:115], v[168:171]
M v[168:171], a[164:167], a[116:119], v[168:171]
M v[172:175], a[164:167], a[124:127], v[172:175]
M v[172:175], a[160:163], a[120:123], v[172:175]
M v[176:179], a[160:163], a[128:131], v[176:179]
buffer_load_dwordx4 v4, s[8:11], s23 offen offset:2048 lds
M v[176:179], a[164:167], a[132:135], v[176:179]
ds_read_b64_tr_b16 a[76:77], v17 offset:16384
ds_read_b64_tr_b16 a[78:79], v17 offset:18432
M v[180:183], a[164:167], a[140:143], v[180:183]
M v[180:183], a[160:163], a[136:139], v[180:183]
M v[184:187], a[160:163], a[144:147], v[184:187]
M v[184:187], a[164:167], a[148:151], v[184:187]
M v[188:191], a[164:167], a[156:159], v[188:191]
M v[188:191], a[160:163], a[152:155], v[188:191]
s_waitcnt lgkmcnt(12)
ds_read_b64_tr_b16 a[84:85], v18 offset:16384
ds_read_b64_tr_b16 a[86:87], v18 offset:18432
M v[192:195], a[168:171], a[96:99], v[192:195]
M v[192:195], a[172:175], a[100:103], v[192:195]
ds_read_b128 a[184:187], v10 offset:55296
ds_read_b128 a[188:191], v11 offset:55296
M v[196:199], a[172:175], a[108:111], v[196:199]
M v[196:199], a[168:171], a[104:107], v[196:199]
M v[200:203], a[168:171], a[112:115], v[200:203]
M v[200:203], a[172:175], a[116:119], v[200:203]
ds_read_b64_tr_b16 a[92:93], v19 offset:16384
ds_read_b64_tr_b16 a[94:95], v19 offset:18432
M v[204:207], a[172:175], a[124:127], v[204:207]
M v[204:207], a[168:171], a[120:123], v[204:207]
M v[208:211], a[168:171], a[128:131], v[208:211]
buffer_load_dwordx4 v5, s[8:11], s23 offen offset:3072 lds
M v[208:211], a[172:175], a[132:135], v[208:211]
M v[212:215], a[172:175], a[140:143], v[212:215]
M v[212:215], a[168:171], a[136:139], v[212:215]
M v[216:219], a[168:171], a[144:147], v[216:219]
M v[216:219], a[172:175], a[148:151], v[216:219]
M v[220:223], a[172:175], a[156:159], v[220:223]
M v[220:223], a[168:171], a[152:155], v[220:223]
s_waitcnt lgkmcnt(10)
M v[224:227], a[176:179], a[96:99], v[224:227]
M v[224:227], a[180:183], a[100:103], v[224:227]
M v[228:231], a[180:183], a[108:111], v[228:231]
M v[228:231], a[176:179], a[104:107], v[228:231]
M v[232:235], a[176:179], a[112:115], v[232:235]
M v[232:235], a[180:183], a[116:119], v[232:235]
M v[236:239], a[180:183], a[124:127], v[236:239]
M v[236:239], a[176:179], a[120:123], v[236:239]
s_waitcnt vmcnt(13) lgkmcnt(0)
s_barrier
ds_read_b128 a[160:163], v10 offset:0
ds_read_b128 a[164:167], v11 offset:0
M v[240:243], a[176:179], a[128:131], v[240:243]
s_add_u32 m0, s29, 49152
s_add_u32 s3, s23, s31
buffer_load_dwordx4 v2, s[8:11], s3 offen offset:0 lds
M v[240:243], a[180:183], a[132:135], v[240:243]
M v[244:247], a[180:183], a[140:143], v[244:247]
M v[244:247], a[176:179], a[136:139], v[244:247]
M v[248:251], a[176:179], a[144:147], v[248:251]
M v[248:251], a[180:183], a[148:151], v[248:251]
M v[252:255], a[180:183], a[156:159], v[252:255]
M v[252:255], a[176:179], a[152:155], v[252:255]
M a[0:3], a[184:187], a[96:99], a[0:3]
M a[0:3], a[188:191], a[100:103], a[0:3]
ds_read_b128 a[168:171], v10 offset:2048
ds_read_b128 a[172:175], v11 offset:2048
M a[4:7], a[188:191], a[108:111], a[4:7]
M a[4:7], a[184:187], a[104:107], a[4:7]
M a[8:11], a[184:187], a[112:115], a[8:11]
buffer_load_dwordx4 v3, s[8:11], s3 offen offset:1024 lds
M a[8:11], a[188:191], a[116:119], a[8:11]
M a[12:15], a[188:191], a[124:127], a[12:15]
M a[12:15], a[184:187], a[120:123], a[12:15]
M a[16:19], a[184:187], a[128:131], a[16:19]
M a[16:19], a[188:191], a[132:135], a[16:19]
M a[20:23], a[188:191], a[140:143], a[20:23]
M a[20:23], a[184:187], a[136:139], a[20:23]
M a[24:27], a[184:187], a[144:147], a[24:27]
M a[24:27], a[188:191], a[148:151], a[24:27]
M a[28:31], a[188:191], a[156:159], a[28:31]
M a[28:31], a[184:187], a[152:155], a[28:31]
s_waitcnt lgkmcnt(2)
M v[32:35], a[160:163], a[32:35], v[32:35]
buffer_load_dwordx4 v4, s[8:11], s3 offen offset:2048 lds
M v[32:35], a[164:167], a[36:39], v[32:35]
ds_read_b128 a[176:179], v10 offset:4096
ds_read_b128 a[180:183], v11 offset:4096
M v[36:39], a[164:167], a[44:47], v[36:39]
M v[36:39], a[160:163], a[40:43], v[36:39]
ds_read_b64_tr_b16 a[96:97], v12 offset:32768
ds_read_b64_tr_b16 a[98:99], v12 offset:34816
M v[40:43], a[160:163], a[48:51], v[40:43]
M v[40:43], a[164:167], a[52:55], v[40:43]
M v[44:47], a[164:167], a[60:63], v[44:47]
M v[44:47], a[160:163], a[56:59], v[44:47]
ds_read_b64_tr_b16 a[104:105], v13 offset:32768
ds_read_b64_tr_b16 a[106:107], v13 offset:34816
M v[48:51], a[160:163], a[64:67], v[48:51]
M v[48:51], a[164:167], a[68:71], v[48:51]
M v[52:55], a[164:167], a[76:79], v[52:55]
M v[52:55], a[160:163], a[72:75], v[52:55]
ds_read_b64_tr_b16 a[112:113], v14 offset:32768
ds_read_b64_tr_b16 a[114:115], v14 offset:34816
M v[56:59], a[160:163], a[80:83], v[56:59]
M v[56:59], a[164:167], a[84:87], v[56:59]
buffer_load_dwordx4 v5, s[8:11], s3 offen offset:3072 lds
M v[60:63], a[164:167], a[92:95], v[60:63]
M v[60:63], a[160:163], a[88:91], v[60:63]
s_waitcnt lgkmcnt(8)
ds_read_b64_tr_b16 a[120:121], v15 offset:32768
ds_read_b64_tr_b16 a[122:123], v15 offset:34816
M v[64:67], a[168:171], a[32:35], v[64:67]
M v[64:67], a[172:175], a[36:39], v[64:67]
ds_read_b128 a[184:187], v10 offset:6144
ds_read_b128 a[188:191], v11 offset:6144
M v[68:71], a[172:175], a[44:47], v[68:71]
M v[68:71], a[168:171], a[40:43], v[68:71]
ds_read_b64_tr_b16 a[128:129], v16 offset:32768
ds_read_b64_tr_b16 a[130:131], v16 offset:34816
M v[72:75], a[168:171], a[48:51], v[72:75]
M v[72:75], a[172:175], a[52:55], v[72:75]
M v[76:79], a[172:175], a[60:63], v[76:79]
M v[76:79], a[168:171], a[56:59], v[76:79]
ds_read_b64_tr_b16 a[136:137], v17 offset:32768
ds_read_b64_tr_b16 a[138:139], v17 offset:34816
M v[80:83], a[168:171], a[64:67], v[80:83]
M v[80:83], a[172:175], a[68:71], v[80:83]
M v[84:87], a[172:175], a[76:79], v[84:87]
s_add_u32 s23, s23, 128
s_cmp_eq_u32 s23, s25
s_cselect_b32 s23, s26, s23
M v[84:87], a[168:171], a[72:75], v[84:87]
ds_read_b64_tr_b16 a[144:145], v18 offset:32768
ds_read_b64_tr_b16 a[146:147], v18 offset:34816
M v[88:91], a[168:171], a[80:83], v[88:91]
M v[88:91], a[172:175], a[84:87], v[88:91]
M v[92:95], a[172:175], a[92:95], v[92:95]
M v[92:95], a[168:171], a[88:91], v[92:95]
s_waitcnt lgkmcnt(15)
ds_read_b64_tr_b16 a[152:153], v19 offset:32768
ds_read_b64_tr_b16 a[154:155], v19 offset:34816
M v[96:99], a[176:179], a[32:35], v[96:99]
M v[96:99], a[180:183], a[36:39], v[96:99]
M v[100:103], a[180:183], a[44:47], v[100:103]
M v[100:103], a[176:179], a[40:43], v[100:103]
M v[104:107], a[176:179], a[48:51], v[104:107]
M v[104:107], a[180:183], a[52:55], v[104:107]
M v[108:111], a[180:183], a[60:63], v[108:111]
M v[108:111], a[176:179], a[56:59], v[108:111]
s_waitcnt vmcnt(8) lgkmcnt(0)
s_barrier
ds_read_b128 a[160:163], v10 offset:16384
ds_read_b128 a[164:167], v11 offset:16384
M v[112:115], a[176:179], a[64:67], v[112:115]
M v[112:115], a[180:183], a[68:71], v[112:115]
s_and_b32 s3, s2, 1
s_lshl_b32 s3, s3, 3
s_bfe_u32 s4, s2, 0x30003
M v[116:119], a[180:183], a[76:79], v[116:119]
s_add_u32 s26, s3, s4
s_bfe_u32 s3, s2, 0x20001
s_lshl_b32 s3, s3, 2
M v[116:119], a[176:179], a[72:75], v[116:119]
ds_read_b64_tr_b16 a[100:101], v12 offset:49152
ds_read_b64_tr_b16 a[102:103], v12 offset:51200
s_lshr_b32 s4, s2, 6
s_xor_b32 s4, s4, 2
s_add_u32 s27, s3, s4
M v[120:123], a[176:179], a[80:83], v[120:123]
s_lshl_b32 s23, s26, 18
s_sub_u32 s24, s23, 32768
M v[120:123], a[180:183], a[84:87], v[120:123]
s_max_i32 s24, s24, 0
s_lshl_b32 s25, s27, 7
s_xor_b32 s3, s26, s27
M v[124:127], a[180:183], a[92:95], v[124:127]
s_and_b32 s3, s3, 0
s_lshl_b32 s3, s3, 3
s_sub_u32 s31, 16, s3
M v[124:127], a[176:179], a[88:91], v[124:127]
s_mov_b32 s54, s31
s_movk_i32 s57, 128
M v[128:131], a[184:187], a[32:35], v[128:131]
s_mov_b32 s55, 4289069056
s_mov_b32 s56, 393216
s_lshl_b32 s4, s3, 7
M v[128:131], a[188:191], a[36:39], v[128:131]
ds_read_b128 a[168:171], v10 offset:18432
ds_read_b128 a[172:175], v11 offset:18432
ds_read_b64_tr_b16 a[108:109], v13 offset:49152
ds_read_b64_tr_b16 a[110:111], v13 offset:51200
s_add_u32 s23, s23, s4
s_add_u32 s24, s24, s4
s_mul_i32 s4, s3, 393216
M v[132:135], a[188:191], a[44:47], v[132:135]
s_add_u32 s25, s25, s4
s_mov_b64 s[8:9], s[44:45]
s_mov_b32 s10, 4194304
M v[132:135], a[184:187], a[40:43], v[132:135]
s_mov_b64 s[12:13], s[46:47]
s_mov_b32 s14, 6291456
M v[136:139], a[184:187], a[48:51], v[136:139]
s_mov_b64 s[36:37], s[90:91]
s_mov_b32 s38, 256
s_mov_b32 s39, 0x00020000
M v[136:139], a[188:191], a[52:55], v[136:139]
s_lshl_b32 s28, s20, 9
s_mul_i32 s30, s20, 6144
s_lshl_b32 s3, s20, 5
M v[140:143], a[188:191], a[60:63], v[140:143]
v_lshrrev_b32 v24, 3, v0
v_and_b32 v25, 7, v0
M v[140:143], a[184:187], a[56:59], v[140:143]
ds_read_b64_tr_b16 a[116:117], v14 offset:49152
ds_read_b64_tr_b16 a[118:119], v14 offset:51200
v_add_u32 v28, s3, v24
v_add_u32 v26, 0, v28
v_bfe_u32 v27, v26, 1, 3
M v[144:147], a[184:187], a[64:67], v[144:147]
v_xor_b32 v27, v27, v25
v_lshlrev_b32 v26, 11, v26
v_lshl_add_u32 v26, v27, 4, v26
M v[144:147], a[188:191], a[68:71], v[144:147]
v_subrev_u32 v2, 0, v26
v_add_u32 v26, 8, v28
v_bfe_u32 v27, v26, 1, 3
M v[148:151], a[188:191], a[76:79], v[148:151]
v_xor_b32 v27, v27, v25
v_lshlrev_b32 v26, 11, v26
M v[148:151], a[184:187], a[72:75], v[148:151]
v_lshl_add_u32 v26, v27, 4, v26
v_subrev_u32 v3, 1024, v26
v_add_u32 v26, 16, v28
M v[152:155], a[184:187], a[80:83], v[152:155]
v_bfe_u32 v27, v26, 1, 3
v_xor_b32 v27, v27, v25
v_lshlrev_b32 v26, 11, v26
M v[152:155], a[188:191], a[84:87], v[152:155]
ds_read_b64_tr_b16 a[124:125], v15 offset:49152
ds_read_b64_tr_b16 a[126:127], v15 offset:51200
v_lshl_add_u32 v26, v27, 4, v26
v_subrev_u32 v4, 2048, v26
M v[156:159], a[188:191], a[92:95], v[156:159]
v_add_u32 v26, 24, v28
v_bfe_u32 v27, v26, 1, 3
v_xor_b32 v27, v27, v25
M v[156:159], a[184:187], a[88:91], v[156:159]
s_waitcnt lgkmcnt(10)
v_lshlrev_b32 v26, 11, v26
v_lshl_add_u32 v26, v27, 4, v26
v_subrev_u32 v5, 3072, v26
M v[160:163], a[160:163], a[32:35], v[160:163]
s_lshl_b32 s3, s20, 2
v_lshrrev_b32 v26, 5, v0
M v[160:163], a[164:167], a[36:39], v[160:163]
ds_read_b128 a[176:179], v10 offset:20480
ds_read_b128 a[180:183], v11 offset:20480
v_add_u32 v26, s3, v26
v_bfe_u32 v29, v0, 2, 3
v_bfe_u32 v27, v26, 1, 3
M v[164:167], a[164:167], a[44:47], v[164:167]
v_xor_b32 v27, v27, v29
v_lshlrev_b32 v27, 4, v27
v_and_b32 v30, 3, v0
M v[164:167], a[160:163], a[40:43], v[164:167]
ds_read_b64_tr_b16 a[132:133], v16 offset:49152
ds_read_b64_tr_b16 a[134:135], v16 offset:51200
v_lshl_add_u32 v27, v30, 2, v27
v_lshl_add_u32 v20, v26, 11, v27
v_add_u32 v26, 2, v26
M v[168:171], a[160:163], a[48:51], v[168:171]
v_bfe_u32 v27, v26, 1, 3
v_xor_b32 v27, v27, v29
M v[168:171], a[164:167], a[52:55], v[168:171]
v_lshlrev_b32 v27, 4, v27
v_and_b32 v30, 3, v0
v_lshl_add_u32 v27, v30, 2, v27
M v[172:175], a[164:167], a[60:63], v[172:175]
v_lshl_add_u32 v23, v26, 11, v27
v_subrev_u32 v23, 256, v23
s_mul_i32 s3, s20, 48
M v[172:175], a[160:163], a[56:59], v[172:175]
v_add_u32 v28, s3, v24
v_add_u32 v26, 0, v28
M v[176:179], a[160:163], a[64:67], v[176:179]
v_mul_u32_u24 v27, 0xaaab, v26
v_lshrrev_b32 v27, 17, v27
v_lshrrev_b32 v29, 1, v27
M v[176:179], a[164:167], a[68:71], v[176:179]
ds_read_b64_tr_b16 a[140:141], v17 offset:49152
ds_read_b64_tr_b16 a[142:143], v17 offset:51200
v_and_b32 v29, 4, v29
v_and_or_b32 v27, v27, 2, v29
v_xor_b32 v27, v27, v25
M v[180:183], a[164:167], a[76:79], v[180:183]
v_lshlrev_b32 v26, 11, v26
v_lshl_add_u32 v26, v27, 4, v26
v_subrev_u32 v6, 0, v26
M v[180:183], a[160:163], a[72:75], v[180:183]
v_add_u32 v26, 8, v28
v_mul_u32_u24 v27, 0xaaab, v26
M v[184:187], a[160:163], a[80:83], v[184:187]
v_lshrrev_b32 v27, 17, v27
v_lshrrev_b32 v29, 1, v27
v_and_b32 v29, 4, v29
M v[184:187], a[164:167], a[84:87], v[184:187]
v_and_or_b32 v27, v27, 2, v29
v_xor_b32 v27, v27, v25
v_lshlrev_b32 v26, 11, v26
M v[188:191], a[164:167], a[92:95], v[188:191]
v_lshl_add_u32 v26, v27, 4, v26
v_subrev_u32 v7, 1024, v26
M v[188:191], a[160:163], a[88:91], v[188:191]
s_waitcnt lgkmcnt(12)
ds_read_b64_tr_b16 a[148:149], v18 offset:49152
ds_read_b64_tr_b16 a[150:151], v18 offset:51200
v_add_u32 v26, 16, v28
v_mul_u32_u24 v27, 0xaaab, v26
v_lshrrev_b32 v27, 17, v27
M v[192:195], a[168:171], a[32:35], v[192:195]
v_lshrrev_b32 v29, 1, v27
v_and_b32 v29, 4, v29
v_and_or_b32 v27, v27, 2, v29
M v[192:195], a[172:175], a[36:39], v[192:195]
ds_read_b128 a[184:187], v10 offset:22528
ds_read_b128 a[188:191], v11 offset:22528
v_xor_b32 v27, v27, v25
v_lshlrev_b32 v26, 11, v26
M v[196:199], a[172:175], a[44:47], v[196:199]
v_lshl_add_u32 v26, v27, 4, v26
v_subrev_u32 v8, 2048, v26
v_add_u32 v26, 24, v28
M v[196:199], a[168:171], a[40:43], v[196:199]
v_mul_u32_u24 v27, 0xaaab, v26
v_lshrrev_b32 v27, 17, v27
v_lshrrev_b32 v29, 1, v27
M v[200:203], a[168:171], a[48:51], v[200:203]
v_and_b32 v29, 4, v29
v_and_or_b32 v27, v27, 2, v29
v_xor_b32 v27, v27, v25
M v[200:203], a[172:175], a[52:55], v[200:203]
ds_read_b64_tr_b16 a[156:157], v19 offset:49152
ds_read_b64_tr_b16 a[158:159], v19 offset:51200
v_lshlrev_b32 v26, 11, v26
v_lshl_add_u32 v26, v27, 4, v26
M v[204:207], a[172:175], a[60:63], v[204:207]
v_subrev_u32 v9, 3072, v26
v_add_u32 v26, 32, v28
v_mul_u32_u24 v27, 0xaaab, v26
M v[204:207], a[168:171], a[56:59], v[204:207]
v_lshrrev_b32 v27, 17, v27
v_lshrrev_b32 v29, 1, v27
v_and_b32 v29, 4, v29
M v[208:211], a[168:171], a[64:67], v[208:211]
v_and_or_b32 v27, v27, 2, v29
v_xor_b32 v27, v27, v25
M v[208:211], a[172:175], a[68:71], v[208:211]
v_lshlrev_b32 v26, 11, v26
v_lshl_add_u32 v26, v27, 4, v26
v_subrev_u32 v21, 0, v26
M v[212:215], a[172:175], a[76:79], v[212:215]
v_add_u32 v26, 40, v28
v_mul_u32_u24 v27, 0xaaab, v26
v_lshrrev_b32 v27, 17, v27
M v[212:215], a[168:171], a[72:75], v[212:215]
v_lshrrev_b32 v29, 1, v27
v_and_b32 v29, 4, v29
v_and_or_b32 v27, v27, 2, v29
M v[216:219], a[168:171], a[80:83], v[216:219]
v_xor_b32 v27, v27, v25
v_lshlrev_b32 v26, 11, v26
M v[216:219], a[172:175], a[84:87], v[216:219]
v_lshl_add_u32 v26, v27, 4, v26
v_subrev_u32 v22, 1024, v26
s_lshr_b32 s3, s53, 7
M v[220:223], a[172:175], a[92:95], v[220:223]
s_add_u32 s3, s3, s22
s_lshl_b32 s3, s3, 5
s_lshr_b32 s19, s52, 6
M v[220:223], a[168:171], a[88:91], v[220:223]
s_waitcnt lgkmcnt(10)
s_add_u32 s3, s3, s19
s_lshl_b32 s19, s21, 1
M v[224:227], a[176:179], a[32:35], v[224:227]
s_add_u32 s3, s3, s19
s_lshl_b32 s92, s3, 15
s_add_u32 s92, s92, 16384
M v[224:227], a[180:183], a[36:39], v[224:227]
s_add_u32 s93, s92, 32768
s_add_u32 s16, s50, 16777216
s_addc_u32 s17, s51, 0
M v[228:231], a[180:183], a[44:47], v[228:231]
s_mov_b32 s18, 33554432
s_mov_b32 s19, 0x00020000
M v[228:231], a[176:179], a[40:43], v[228:231]
M v[232:235], a[176:179], a[48:51], v[232:235]
M v[232:235], a[180:183], a[52:55], v[232:235]
M v[236:239], a[180:183], a[60:63], v[236:239]
M v[236:239], a[176:179], a[56:59], v[236:239]
s_waitcnt vmcnt(4) lgkmcnt(0)
s_barrier
ds_read_b128 a[160:163], v10 offset:32768
ds_read_b128 a[164:167], v11 offset:32768
M v[240:243], a[176:179], a[64:67], v[240:243]
s_add_u32 m0, s28, 131072
s_nop 0
buffer_load_dword v20, s[8:11], s24 offen lds
M v[240:243], a[180:183], a[68:71], v[240:243]
M v[244:247], a[180:183], a[76:79], v[244:247]
M v[244:247], a[176:179], a[72:75], v[244:247]
buffer_load_dword v23, s[8:11], s24 offen offset:256 lds
M v[248:251], a[176:179], a[80:83], v[248:251]
M v[248:251], a[180:183], a[84:87], v[248:251]
M v[252:255], a[180:183], a[92:95], v[252:255]
M v[252:255], a[176:179], a[88:91], v[252:255]
M a[0:3], a[184:187], a[32:35], a[0:3]
s_add_u32 m0, s29, 133120
s_nop 0
buffer_load_dwordx4 v2, s[8:11], s23 offen offset:0 lds
M a[0:3], a[188:191], a[36:39], a[0:3]
ds_read_b128 a[168:171], v10 offset:34816
ds_read_b128 a[172:175], v11 offset:34816
M a[4:7], a[188:191], a[44:47], a[4:7]
M a[4:7], a[184:187], a[40:43], a[4:7]
M a[8:11], a[184:187], a[48:51], a[8:11]
buffer_load_dwordx4 v3, s[8:11], s23 offen offset:1024 lds
M a[8:11], a[188:191], a[52:55], a[8:11]
M a[12:15], a[188:191], a[60:63], a[12:15]
M a[12:15], a[184:187], a[56:59], a[12:15]
M a[16:19], a[184:187], a[64:67], a[16:19]
buffer_load_dwordx4 v4, s[8:11], s23 offen offset:2048 lds
M a[16:19], a[188:191], a[68:71], a[16:19]
M a[20:23], a[188:191], a[76:79], a[20:23]
M a[20:23], a[184:187], a[72:75], a[20:23]
buffer_load_dwordx4 v5, s[8:11], s23 offen offset:3072 lds
M a[24:27], a[184:187], a[80:83], a[24:27]
M a[24:27], a[188:191], a[84:87], a[24:27]
M a[28:31], a[188:191], a[92:95], a[28:31]
M a[28:31], a[184:187], a[88:91], a[28:31]
s_waitcnt lgkmcnt(2)
M v[32:35], a[160:163], a[96:99], v[32:35]
s_sub_u32 s31, s31, 1
s_cmp_eq_u32 s31, 0
s_cselect_b32 s58, -1920, s57
s_add_u32 s23, s23, s58
s_add_u32 s24, s24, s58
M v[32:35], a[164:167], a[100:103], v[32:35]
ds_read_b128 a[176:179], v10 offset:36864
ds_read_b128 a[180:183], v11 offset:36864
M v[36:39], a[164:167], a[108:111], v[36:39]
M v[36:39], a[160:163], a[104:107], v[36:39]
M v[40:43], a[160:163], a[112:115], v[40:43]
M v[40:43], a[164:167], a[116:119], v[40:43]
s_add_u32 m0, s30, 65536
s_nop 0
buffer_load_dwordx4 v6, s[12:15], s25 offen offset:0 lds
M v[44:47], a[164:167], a[124:127], v[44:47]
M v[44:47], a[160:163], a[120:123], v[44:47]
M v[48:51], a[160:163], a[128:131], v[48:51]
M v[48:51], a[164:167], a[132:135], v[48:51]
buffer_load_dwordx4 v7, s[12:15], s25 offen offset:1024 lds
M v[52:55], a[164:167], a[140:143], v[52:55]
M v[52:55], a[160:163], a[136:139], v[52:55]
M v[56:59], a[160:163], a[144:147], v[56:59]
M v[56:59], a[164:167], a[148:151], v[56:59]
buffer_load_dwordx4 v8, s[12:15], s25 offen offset:2048 lds
M v[60:63], a[164:167], a[156:159], v[60:63]
M v[60:63], a[160:163], a[152:155], v[60:63]
s_waitcnt lgkmcnt(2)
M v[64:67], a[168:171], a[96:99], v[64:67]
M v[64:67], a[172:175], a[100:103], v[64:67]
ds_read_b128 a[184:187], v10 offset:38912
ds_read_b128 a[188:191], v11 offset:38912
M v[68:71], a[172:175], a[108:111], v[68:71]
M v[68:71], a[168:171], a[104:107], v[68:71]
buffer_load_dwordx4 v9, s[12:15], s25 offen offset:3072 lds
M v[72:75], a[168:171], a[112:115], v[72:75]
M v[72:75], a[172:175], a[116:119], v[72:75]
M v[76:79], a[172:175], a[124:127], v[76:79]
M v[76:79], a[168:171], a[120:123], v[76:79]
s_add_u32 m0, s30, 69632
s_nop 0
buffer_load_dwordx4 v21, s[12:15], s25 offen offset:0 lds
M v[80:83], a[168:171], a[128:131], v[80:83]
M v[80:83], a[172:175], a[132:135], v[80:83]
M v[84:87], a[172:175], a[140:143], v[84:87]
M v[84:87], a[168:171], a[136:139], v[84:87]
buffer_load_dwordx4 v22, s[12:15], s25 offen offset:1024 lds
M v[88:91], a[168:171], a[144:147], v[88:91]
M v[88:91], a[172:175], a[148:151], v[88:91]
M v[92:95], a[172:175], a[156:159], v[92:95]
M v[92:95], a[168:171], a[152:155], v[92:95]
s_waitcnt lgkmcnt(2)
M v[96:99], a[176:179], a[96:99], v[96:99]
s_sub_u32 s54, s54, 1
s_cmp_eq_u32 s54, 0
s_cselect_b32 s58, s55, s56
s_add_u32 s25, s25, s58
M v[96:99], a[180:183], a[100:103], v[96:99]
M v[100:103], a[180:183], a[108:111], v[100:103]
M v[100:103], a[176:179], a[104:107], v[100:103]
v_cvt_pk_bf16_f32 v32, v32, v33
v_cvt_pk_bf16_f32 v33, v34, v35
M v[104:107], a[176:179], a[112:115], v[104:107]
v_cvt_pk_bf16_f32 v34, v64, v65
v_cvt_pk_bf16_f32 v35, v66, v67
M v[104:107], a[180:183], a[116:119], v[104:107]
v_cvt_pk_bf16_f32 v64, v48, v49
M v[108:111], a[180:183], a[124:127], v[108:111]
v_cvt_pk_bf16_f32 v65, v50, v51
v_cvt_pk_bf16_f32 v66, v80, v81
M v[108:111], a[176:179], a[120:123], v[108:111]
s_waitcnt vmcnt(12) lgkmcnt(0)
s_barrier
ds_read_b128 a[160:163], v10 offset:49152
ds_read_b128 a[164:167], v11 offset:49152
v_cvt_pk_bf16_f32 v67, v82, v83
M v[112:115], a[176:179], a[128:131], v[112:115]
s_add_u32 m0, s28, 0
s_nop 0
buffer_load_dword v20, s[8:11], s24 offen lds
v_cvt_pk_bf16_f32 v48, v40, v41
v_cvt_pk_bf16_f32 v49, v42, v43
M v[112:115], a[180:183], a[132:135], v[112:115]
v_cvt_pk_bf16_f32 v50, v72, v73
v_cvt_pk_bf16_f32 v51, v74, v75
M v[116:119], a[180:183], a[140:143], v[116:119]
v_cvt_pk_bf16_f32 v80, v56, v57
M v[116:119], a[176:179], a[136:139], v[116:119]
buffer_load_dword v23, s[8:11], s24 offen offset:256 lds
v_cvt_pk_bf16_f32 v81, v58, v59
v_cvt_pk_bf16_f32 v82, v88, v89
M v[120:123], a[176:179], a[144:147], v[120:123]
v_cvt_pk_bf16_f32 v83, v90, v91
M v[120:123], a[180:183], a[148:151], v[120:123]
v_cvt_pk_bf16_f32 v40, v36, v37
v_cvt_pk_bf16_f32 v41, v38, v39
M v[124:127], a[180:183], a[156:159], v[124:127]
s_add_u32 m0, s29, 2048
s_nop 0
buffer_load_dwordx4 v2, s[8:11], s23 offen offset:0 lds
v_cvt_pk_bf16_f32 v42, v68, v69
v_cvt_pk_bf16_f32 v43, v70, v71
M v[124:127], a[176:179], a[152:155], v[124:127]
v_cvt_pk_bf16_f32 v72, v52, v53
M v[128:131], a[184:187], a[96:99], v[128:131]
v_cvt_pk_bf16_f32 v73, v54, v55
v_cvt_pk_bf16_f32 v74, v84, v85
M v[128:131], a[188:191], a[100:103], v[128:131]
ds_read_b128 a[168:171], v10 offset:51200
ds_read_b128 a[172:175], v11 offset:51200
v_cvt_pk_bf16_f32 v75, v86, v87
M v[132:135], a[188:191], a[108:111], v[132:135]
v_cvt_pk_bf16_f32 v56, v44, v45
v_cvt_pk_bf16_f32 v57, v46, v47
M v[132:135], a[184:187], a[104:107], v[132:135]
buffer_load_dwordx4 v3, s[8:11], s23 offen offset:1024 lds
v_cvt_pk_bf16_f32 v58, v76, v77
v_cvt_pk_bf16_f32 v59, v78, v79
M v[136:139], a[184:187], a[112:115], v[136:139]
v_cvt_pk_bf16_f32 v88, v60, v61
M v[136:139], a[188:191], a[116:119], v[136:139]
v_cvt_pk_bf16_f32 v89, v62, v63
v_cvt_pk_bf16_f32 v90, v92, v93
M v[140:143], a[188:191], a[124:127], v[140:143]
buffer_load_dwordx4 v4, s[8:11], s23 offen offset:2048 lds
v_cvt_pk_bf16_f32 v91, v94, v95
M v[140:143], a[184:187], a[120:123], v[140:143]
M v[144:147], a[184:187], a[128:131], v[144:147]
M v[144:147], a[188:191], a[132:135], v[144:147]
buffer_load_dwordx4 v5, s[8:11], s23 offen offset:3072 lds
M v[148:151], a[188:191], a[140:143], v[148:151]
s_add_u32 s94, s92, 0
buffer_store_dwordx4 v[32:35], v1, s[16:19], s94 offen offset:0 sc1
M v[148:151], a[184:187], a[136:139], v[148:151]
M v[152:155], a[184:187], a[144:147], v[152:155]
M v[152:155], a[188:191], a[148:151], v[152:155]
s_sub_u32 s31, s31, 1
s_cmp_eq_u32 s31, 0
s_cselect_b32 s58, -1920, s57
s_add_u32 s23, s23, s58
s_add_u32 s24, s24, s58
M v[156:159], a[188:191], a[156:159], v[156:159]
s_add_u32 s94, s92, 0
buffer_store_dwordx4 v[40:43], v1, s[16:19], s94 offen offset:1024 sc1
M v[156:159], a[184:187], a[152:155], v[156:159]
s_waitcnt lgkmcnt(2)
M v[160:163], a[160:163], a[96:99], v[160:163]
M v[160:163], a[164:167], a[100:103], v[160:163]
ds_read_b128 a[176:179], v10 offset:53248
ds_read_b128 a[180:183], v11 offset:53248
M v[164:167], a[164:167], a[108:111], v[164:167]
s_add_u32 s94, s92, 0
buffer_store_dwordx4 v[48:51], v1, s[16:19], s94 offen offset:2048 sc1
M v[164:167], a[160:163], a[104:107], v[164:167]
v_cvt_pk_bf16_f32 v96, v96, v97
v_cvt_pk_bf16_f32 v97, v98, v99
M v[168:171], a[160:163], a[112:115], v[168:171]
v_cvt_pk_bf16_f32 v98, v128, v129
v_cvt_pk_bf16_f32 v99, v130, v131
M v[168:171], a[164:167], a[116:119], v[168:171]
s_add_u32 m0, s30, 98304
s_nop 0
buffer_load_dwordx4 v6, s[12:15], s25 offen offset:0 lds
v_cvt_pk_bf16_f32 v128, v112, v113
M v[172:175], a[164:167], a[124:127], v[172:175]
s_add_u32 s94, s92, 0
buffer_store_dwordx4 v[56:59], v1, s[16:19], s94 offen offset:3072 sc1
v_cvt_pk_bf16_f32 v129, v114, v115
v_cvt_pk_bf16_f32 v130, v144, v145
M v[172:175], a[160:163], a[120:123], v[172:175]
v_cvt_pk_bf16_f32 v131, v146, v147
M v[176:179], a[160:163], a[128:131], v[176:179]
v_cvt_pk_bf16_f32 v112, v104, v105
v_cvt_pk_bf16_f32 v113, v106, v107
M v[176:179], a[164:167], a[132:135], v[176:179]
buffer_load_dwordx4 v7, s[12:15], s25 offen offset:1024 lds
v_cvt_pk_bf16_f32 v114, v136, v137
v_cvt_pk_bf16_f32 v115, v138, v139
M v[180:183], a[164:167], a[140:143], v[180:183]
s_add_u32 s94, s92, 4096
buffer_store_dwordx4 v[64:67], v1, s[16:19], s94 offen offset:0 sc1
v_cvt_pk_bf16_f32 v144, v120, v121
M v[180:183], a[160:163], a[136:139], v[180:183]
v_cvt_pk_bf16_f32 v145, v122, v123
v_cvt_pk_bf16_f32 v146, v152, v153
M v[184:187], a[160:163], a[144:147], v[184:187]
v_cvt_pk_bf16_f32 v147, v154, v155
M v[184:187], a[164:167], a[148:151], v[184:187]
buffer_load_dwordx4 v8, s[12:15], s25 offen offset:2048 lds
v_cvt_pk_bf16_f32 v104, v100, v101
v_cvt_pk_bf16_f32 v105, v102, v103
M v[188:191], a[164:167], a[156:159], v[188:191]
s_add_u32 s94, s92, 4096
buffer_store_dwordx4 v[72:75], v1, s[16:19], s94 offen offset:1024 sc1
v_cvt_pk_bf16_f32 v106, v132, v133
v_cvt_pk_bf16_f32 v107, v134, v135
M v[188:191], a[160:163], a[152:155], v[188:191]
s_waitcnt lgkmcnt(2)
v_cvt_pk_bf16_f32 v136, v116, v117
M v[192:195], a[168:171], a[96:99], v[192:195]
v_cvt_pk_bf16_f32 v137, v118, v119
v_cvt_pk_bf16_f32 v138, v148, v149
M v[192:195], a[172:175], a[100:103], v[192:195]
ds_read_b128 a[184:187], v10 offset:55296
ds_read_b128 a[188:191], v11 offset:55296
v_cvt_pk_bf16_f32 v139, v150, v151
M v[196:199], a[172:175], a[108:111], v[196:199]
s_add_u32 s94, s92, 4096
buffer_store_dwordx4 v[80:83], v1, s[16:19], s94 offen offset:2048 sc1
v_cvt_pk_bf16_f32 v120, v108, v109
v_cvt_pk_bf16_f32 v121, v110, v111
M v[196:199], a[168:171], a[104:107], v[196:199]
v_cvt_pk_bf16_f32 v122, v140, v141
v_cvt_pk_bf16_f32 v123, v142, v143
M v[200:203], a[168:171], a[112:115], v[200:203]
buffer_load_dwordx4 v9, s[12:15], s25 offen offset:3072 lds
v_cvt_pk_bf16_f32 v152, v124, v125
M v[200:203], a[172:175], a[116:119], v[200:203]
v_cvt_pk_bf16_f32 v153, v126, v127
v_cvt_pk_bf16_f32 v154, v156, v157
M v[204:207], a[172:175], a[124:127], v[204:207]
s_add_u32 s94, s92, 4096
buffer_store_dwordx4 v[88:91], v1, s[16:19], s94 offen offset:3072 sc1
v_cvt_pk_bf16_f32 v155, v158, v159
M v[204:207], a[168:171], a[120:123], v[204:207]
M v[208:211], a[168:171], a[128:131], v[208:211]
s_add_u32 m0, s30, 102400
s_nop 0
buffer_load_dwordx4 v21, s[12:15], s25 offen offset:0 lds
M v[208:211], a[172:175], a[132:135], v[208:211]
M v[212:215], a[172:175], a[140:143], v[212:215]
M v[212:215], a[168:171], a[136:139], v[212:215]
buffer_load_dwordx4 v22, s[12:15], s25 offen offset:1024 lds
M v[216:219], a[168:171], a[144:147], v[216:219]
s_add_u32 s94, s92, 8192
buffer_store_dwordx4 v[96:99], v1, s[16:19], s94 offen offset:0 sc1
M v[216:219], a[172:175], a[148:151], v[216:219]
M v[220:223], a[172:175], a[156:159], v[220:223]
M v[220:223], a[168:171], a[152:155], v[220:223]
s_waitcnt lgkmcnt(2)
M v[224:227], a[176:179], a[96:99], v[224:227]
s_sub_u32 s54, s54, 1
s_cmp_eq_u32 s54, 0
s_cselect_b32 s58, s55, s56
s_add_u32 s25, s25, s58
M v[224:227], a[180:183], a[100:103], v[224:227]
M v[228:231], a[180:183], a[108:111], v[228:231]
s_add_u32 s94, s92, 8192
buffer_store_dwordx4 v[104:107], v1, s[16:19], s94 offen offset:1024 sc1
M v[228:231], a[176:179], a[104:107], v[228:231]
v_cvt_pk_bf16_f32 v160, v160, v161
v_cvt_pk_bf16_f32 v161, v162, v163
M v[232:235], a[176:179], a[112:115], v[232:235]
v_cvt_pk_bf16_f32 v162, v192, v193
v_cvt_pk_bf16_f32 v163, v194, v195
M v[232:235], a[180:183], a[116:119], v[232:235]
v_cvt_pk_bf16_f32 v192, v176, v177
M v[236:239], a[180:183], a[124:127], v[236:239]
v_cvt_pk_bf16_f32 v193, v178, v179
v_cvt_pk_bf16_f32 v194, v208, v209
M v[236:239], a[176:179], a[120:123], v[236:239]
s_waitcnt vmcnt(63) lgkmcnt(0)
s_barrier
v_cvt_pk_bf16_f32 v195, v210, v211
M v[240:243], a[176:179], a[128:131], v[240:243]
s_add_u32 s94, s92, 8192
buffer_store_dwordx4 v[112:115], v1, s[16:19], s94 offen offset:2048 sc1
v_cvt_pk_bf16_f32 v176, v168, v169
v_cvt_pk_bf16_f32 v177, v170, v171
M v[240:243], a[180:183], a[132:135], v[240:243]
s_add_u32 m0, s28, 18432
s_nop 0
buffer_load_dword v20, s[8:11], s24 offen lds
v_cvt_pk_bf16_f32 v178, v200, v201
v_cvt_pk_bf16_f32 v179, v202, v203
M v[244:247], a[180:183], a[140:143], v[244:247]
v_cvt_pk_bf16_f32 v208, v184, v185
M v[244:247], a[176:179], a[136:139], v[244:247]
v_cvt_pk_bf16_f32 v209, v186, v187
v_cvt_pk_bf16_f32 v210, v216, v217
M v[248:251], a[176:179], a[144:147], v[248:251]
buffer_load_dword v23, s[8:11], s24 offen offset:256 lds
v_cvt_pk_bf16_f32 v211, v218, v219
M v[248:251], a[180:183], a[148:151], v[248:251]
v_cvt_pk_bf16_f32 v168, v164, v165
v_cvt_pk_bf16_f32 v169, v166, v167
M v[252:255], a[180:183], a[156:159], v[252:255]
s_add_u32 s94, s92, 8192
buffer_store_dwordx4 v[120:123], v1, s[16:19], s94 offen offset:3072 sc1
v_cvt_pk_bf16_f32 v170, v196, v197
v_cvt_pk_bf16_f32 v171, v198, v199
M v[252:255], a[176:179], a[152:155], v[252:255]
v_cvt_pk_bf16_f32 v200, v180, v181
M a[0:3], a[184:187], a[96:99], a[0:3]
v_cvt_pk_bf16_f32 v201, v182, v183
v_cvt_pk_bf16_f32 v202, v212, v213
M a[0:3], a[188:191], a[100:103], a[0:3]
s_add_u32 m0, s29, 20480
s_nop 0
buffer_load_dwordx4 v2, s[8:11], s23 offen offset:0 lds
v_cvt_pk_bf16_f32 v203, v214, v215
M a[4:7], a[188:191], a[108:111], a[4:7]
v_cvt_pk_bf16_f32 v184, v172, v173
v_cvt_pk_bf16_f32 v185, v174, v175
M a[4:7], a[184:187], a[104:107], a[4:7]
v_cvt_pk_bf16_f32 v186, v204, v205
v_cvt_pk_bf16_f32 v187, v206, v207
M a[8:11], a[184:187], a[112:115], a[8:11]
s_add_u32 s94, s92, 12288
buffer_store_dwordx4 v[128:131], v1, s[16:19], s94 offen offset:0 sc1
v_cvt_pk_bf16_f32 v216, v188, v189
M a[8:11], a[188:191], a[116:119], a[8:11]
buffer_load_dwordx4 v3, s[8:11], s23 offen offset:1024 lds
v_cvt_pk_bf16_f32 v217, v190, v191
v_cvt_pk_bf16_f32 v218, v220, v221
M a[12:15], a[188:191], a[124:127], a[12:15]
v_cvt_pk_bf16_f32 v219, v222, v223
M a[12:15], a[184:187], a[120:123], a[12:15]
M a[16:19], a[184:187], a[128:131], a[16:19]
buffer_load_dwordx4 v4, s[8:11], s23 offen offset:2048 lds
M a[16:19], a[188:191], a[132:135], a[16:19]
M a[20:23], a[188:191], a[140:143], a[20:23]
s_add_u32 s94, s92, 12288
buffer_store_dwordx4 v[136:139], v1, s[16:19], s94 offen offset:1024 sc1
M a[20:23], a[184:187], a[136:139], a[20:23]
M a[24:27], a[184:187], a[144:147], a[24:27]
buffer_load_dwordx4 v5, s[8:11], s23 offen offset:3072 lds
M a[24:27], a[188:191], a[148:151], a[24:27]
M a[28:31], a[188:191], a[156:159], a[28:31]
M a[28:31], a[184:187], a[152:155], a[28:31]
v_accvgpr_read_b32 v24, a0
v_accvgpr_read_b32 v25, a1
v_accvgpr_read_b32 v26, a2
v_accvgpr_read_b32 v27, a3
v_cvt_pk_bf16_f32 v224, v224, v225
v_cvt_pk_bf16_f32 v225, v226, v227
v_cvt_pk_bf16_f32 v226, v24, v25
v_cvt_pk_bf16_f32 v227, v26, v27
v_accvgpr_read_b32 v24, a16
v_accvgpr_read_b32 v25, a17
v_accvgpr_read_b32 v26, a18
v_accvgpr_read_b32 v27, a19
v_cvt_pk_bf16_f32 v36, v240, v241
v_cvt_pk_bf16_f32 v37, v242, v243
v_cvt_pk_bf16_f32 v38, v24, v25
v_cvt_pk_bf16_f32 v39, v26, v27
v_accvgpr_read_b32 v24, a24
v_accvgpr_read_b32 v25, a25
v_accvgpr_read_b32 v26, a26
v_accvgpr_read_b32 v27, a27
v_cvt_pk_bf16_f32 v52, v248, v249
v_cvt_pk_bf16_f32 v53, v250, v251
v_cvt_pk_bf16_f32 v54, v24, v25
v_cvt_pk_bf16_f32 v55, v26, v27
v_accvgpr_read_b32 v24, a8
v_accvgpr_read_b32 v25, a9
v_accvgpr_read_b32 v26, a10
v_accvgpr_read_b32 v27, a11
v_cvt_pk_bf16_f32 v240, v232, v233
v_cvt_pk_bf16_f32 v241, v234, v235
v_cvt_pk_bf16_f32 v242, v24, v25
v_cvt_pk_bf16_f32 v243, v26, v27
v_accvgpr_read_b32 v28, a4
v_accvgpr_read_b32 v29, a5
v_accvgpr_read_b32 v30, a6
v_accvgpr_read_b32 v31, a7
v_cvt_pk_bf16_f32 v232, v228, v229
v_cvt_pk_bf16_f32 v233, v230, v231
v_cvt_pk_bf16_f32 v234, v28, v29
v_cvt_pk_bf16_f32 v235, v30, v31
v_accvgpr_read_b32 v28, a12
v_accvgpr_read_b32 v29, a13
v_accvgpr_read_b32 v30, a14
v_accvgpr_read_b32 v31, a15
v_cvt_pk_bf16_f32 v248, v236, v237
v_cvt_pk_bf16_f32 v249, v238, v239
v_cvt_pk_bf16_f32 v250, v28, v29
v_cvt_pk_bf16_f32 v251, v30, v31
v_accvgpr_read_b32 v28, a20
v_accvgpr_read_b32 v29, a21
v_accvgpr_read_b32 v30, a22
v_accvgpr_read_b32 v31, a23
v_cvt_pk_bf16_f32 v44, v244, v245
v_cvt_pk_bf16_f32 v45, v246, v247
v_cvt_pk_bf16_f32 v46, v28, v29
v_cvt_pk_bf16_f32 v47, v30, v31
v_accvgpr_read_b32 v28, a28
v_accvgpr_read_b32 v29, a29
v_accvgpr_read_b32 v30, a30
v_accvgpr_read_b32 v31, a31
v_cvt_pk_bf16_f32 v60, v252, v253
v_cvt_pk_bf16_f32 v61, v254, v255
v_cvt_pk_bf16_f32 v62, v28, v29
v_cvt_pk_bf16_f32 v63, v30, v31
Lk1_b:
v_and_b32 v24, 15, v0
v_lshlrev_b32 v24, 7, v24
v_bfe_u32 v25, v0, 1, 3
v_lshrrev_b32 v26, 4, v0
v_xor_b32 v25, v25, v26
v_lshl_add_u32 v10, v25, 4, v24
v_xor_b32 v11, 64, v10
v_add_u32 v12, 131072, v10
v_add_u32 v13, 131072, v11
v_bfe_u32 v24, v0, 2, 2
v_lshl_add_u32 v29, v26, 3, v24
v_mul_u32_u24 v25, 384, v29
v_and_b32 v27, 1, v0
v_lshl_add_u32 v25, v27, 3, v25
v_add_u32 v25, 36864, v25
v_lshrrev_b32 v24, 1, v29
v_and_b32 v24, 4, v24
v_and_or_b32 v24, v29, 2, v24
v_bfe_u32 v26, v0, 1, 1
s_mul_i32 s4, s20, 3
s_add_u32 s3, s4, 0
s_and_b32 s5, s3, 3
s_lshl_b32 s5, s5, 1
s_lshr_b32 s3, s3, 2
s_lshl_b32 s3, s3, 7
v_add_u32 v27, s5, v26
v_xor_b32 v27, v27, v24
v_lshl_add_u32 v27, v27, 4, v25
v_add_u32 v14, s3, v27
v_add_u32 v17, 61440, v14
s_add_u32 s3, s4, 1
s_and_b32 s5, s3, 3
s_lshl_b32 s5, s5, 1
s_lshr_b32 s3, s3, 2
s_lshl_b32 s3, s3, 7
v_add_u32 v27, s5, v26
v_xor_b32 v27, v27, v24
v_lshl_add_u32 v27, v27, 4, v25
v_add_u32 v15, s3, v27
v_add_u32 v18, 61440, v15
s_add_u32 s3, s4, 2
s_and_b32 s5, s3, 3
s_lshl_b32 s5, s5, 1
s_lshr_b32 s3, s3, 2
s_lshl_b32 s3, s3, 7
v_add_u32 v27, s5, v26
v_xor_b32 v27, v27, v24
v_lshl_add_u32 v27, v27, 4, v25
v_add_u32 v16, s3, v27
v_add_u32 v19, 61440, v16
s_waitcnt vmcnt(11)
s_barrier
ds_read_b64_tr_b16 a[176:177], v14 offset:28672
ds_read_b64_tr_b16 a[178:179], v14 offset:30208
ds_read_b64_tr_b16 a[184:185], v15 offset:28672
ds_read_b64_tr_b16 a[186:187], v15 offset:30208
ds_read_b64_tr_b16 a[192:193], v16 offset:28672
ds_read_b64_tr_b16 a[194:195], v16 offset:30208
ds_read_b64_tr_b16 a[180:181], v14 offset:40960
ds_read_b64_tr_b16 a[182:183], v14 offset:42496
ds_read_b64_tr_b16 a[188:189], v15 offset:40960
ds_read_b64_tr_b16 a[190:191], v15 offset:42496
ds_read_b64_tr_b16 a[196:197], v16 offset:40960
ds_read_b64_tr_b16 a[198:199], v16 offset:42496
ds_read_b128 a[224:227], v12 offset:0
ds_read_b128 a[228:231], v13 offset:0
ds_read_b128 a[232:235], v12 offset:2048
ds_read_b128 a[236:239], v13 offset:2048
ds_read_b128 a[240:243], v12 offset:4096
ds_read_b128 a[244:247], v13 offset:4096
s_waitcnt lgkmcnt(0)
s_barrier
M a[68:71], a[176:179], a[224:227], 0
ds_read_b128 a[248:251], v12 offset:6144
ds_read_b128 a[252:255], v13 offset:6144
M a[68:71], a[180:183], a[228:231], a[68:71]
s_sub_u32 s31, s31, 1
s_cmp_eq_u32 s31, 0
s_cselect_b32 s58, -1920, s57
s_add_u32 s23, s23, s58
s_add_u32 s24, s24, s58
M a[72:75], a[188:191], a[228:231], 0
ds_read_b64_tr_b16 a[200:201], v17 offset:0
ds_read_b64_tr_b16 a[202:203], v17 offset:1536
M a[72:75], a[184:187], a[224:227], a[72:75]
s_add_u32 m0, s30, 36864
s_nop 0
buffer_load_dwordx4 v6, s[12:15], s25 offen offset:0 lds
M a[76:79], a[192:195], a[224:227], 0
M a[76:79], a[196:199], a[228:231], a[76:79]
buffer_load_dwordx4 v7, s[12:15], s25 offen offset:1024 lds
M a[80:83], a[180:183], a[236:239], 0
ds_read_b128 a[224:227], v12 offset:8192
ds_read_b128 a[228:231], v13 offset:8192
M a[80:83], a[176:179], a[232:235], a[80:83]
M a[84:87], a[184:187], a[232:235], 0
ds_read_b64_tr_b16 a[208:209], v18 offset:0
ds_read_b64_tr_b16 a[210:211], v18 offset:1536
M a[84:87], a[188:191], a[236:239], a[84:87]
buffer_load_dwordx4 v8, s[12:15], s25 offen offset:2048 lds
M a[88:91], a[196:199], a[236:239], 0
M a[88:91], a[192:195], a[232:235], a[88:91]
buffer_load_dwordx4 v9, s[12:15], s25 offen offset:3072 lds
M a[92:95], a[176:179], a[240:243], 0
ds_read_b128 a[232:235], v12 offset:10240
ds_read_b128 a[236:239], v13 offset:10240
M a[92:95], a[180:183], a[244:247], a[92:95]
M a[96:99], a[188:191], a[244:247], 0
ds_read_b64_tr_b16 a[216:217], v19 offset:0
ds_read_b64_tr_b16 a[218:219], v19 offset:1536
M a[96:99], a[184:187], a[240:243], a[96:99]
s_add_u32 m0, s30, 40960
s_nop 0
buffer_load_dwordx4 v21, s[12:15], s25 offen offset:0 lds
M a[100:103], a[192:195], a[240:243], 0
buffer_load_dwordx4 v22, s[12:15], s25 offen offset:1024 lds
M a[100:103], a[196:199], a[244:247], a[100:103]
s_waitcnt lgkmcnt(10)
M a[104:107], a[180:183], a[252:255], 0
ds_read_b128 a[240:243], v12 offset:12288
ds_read_b128 a[244:247], v13 offset:12288
M a[104:107], a[176:179], a[248:251], a[104:107]
s_sub_u32 s54, s54, 1
s_cmp_eq_u32 s54, 0
s_cselect_b32 s58, s55, s56
s_add_u32 s25, s25, s58
M a[108:111], a[184:187], a[248:251], 0
ds_read_b64_tr_b16 a[204:205], v17 offset:12288
ds_read_b64_tr_b16 a[206:207], v17 offset:13824
M a[108:111], a[188:191], a[252:255], a[108:111]
M a[112:115], a[196:199], a[252:255], 0
s_add_u32 m0, s30, 65536
s_nop 0
buffer_load_dwordx4 v6, s[12:15], s25 offen offset:0 lds
M a[112:115], a[192:195], a[248:251], a[112:115]
s_waitcnt lgkmcnt(10)
M a[116:119], a[176:179], a[224:227], 0
ds_read_b128 a[248:251], v12 offset:14336
ds_read_b128 a[252:255], v13 offset:14336
M a[116:119], a[180:183], a[228:231], a[116:119]
buffer_load_dwordx4 v7, s[12:15], s25 offen offset:1024 lds
M a[120:123], a[188:191], a[228:231], 0
ds_read_b64_tr_b16 a[212:213], v18 offset:12288
ds_read_b64_tr_b16 a[214:215], v18 offset:13824
M a[120:123], a[184:187], a[224:227], a[120:123]
M a[124:127], a[192:195], a[224:227], 0
buffer_load_dwordx4 v8, s[12:15], s25 offen offset:2048 lds
M a[124:127], a[196:199], a[228:231], a[124:127]
buffer_load_dwordx4 v9, s[12:15], s25 offen offset:3072 lds
s_waitcnt lgkmcnt(10)
M a[128:131], a[180:183], a[236:239], 0
ds_read_b128 a[224:227], v12 offset:16384
ds_read_b128 a[228:231], v13 offset:16384
M a[128:131], a[176:179], a[232:235], a[128:131]
M a[132:135], a[184:187], a[232:235], 0
ds_read_b64_tr_b16 a[220:221], v19 offset:12288
ds_read_b64_tr_b16 a[222:223], v19 offset:13824
M a[132:135], a[188:191], a[236:239], a[132:135]
s_add_u32 m0, s30, 69632
s_nop 0
buffer_load_dwordx4 v21, s[12:15], s25 offen offset:0 lds
M a[136:139], a[196:199], a[236:239], 0
M a[136:139], a[192:195], a[232:235], a[136:139]
buffer_load_dwordx4 v22, s[12:15], s25 offen offset:1024 lds
s_waitcnt lgkmcnt(10)
M a[140:143], a[176:179], a[240:243], 0
M a[140:143], a[180:183], a[244:247], a[140:143]
s_sub_u32 s54, s54, 1
s_cmp_eq_u32 s54, 0
s_cselect_b32 s58, s55, s56
s_add_u32 s25, s25, s58
M a[144:147], a[188:191], a[244:247], 0
M a[144:147], a[184:187], a[240:243], a[144:147]
M a[148:151], a[192:195], a[240:243], 0
s_waitcnt vmcnt(6) lgkmcnt(0)
s_barrier
ds_read_b128 a[232:235], v10 offset:0
ds_read_b128 a[236:239], v11 offset:0
M a[148:151], a[196:199], a[244:247], a[148:151]
s_add_u32 m0, s28, 131072
s_nop 0
buffer_load_dword v20, s[8:11], s24 offen lds
M a[152:155], a[180:183], a[252:255], 0
ds_read_b128 a[240:243], v10 offset:2048
ds_read_b128 a[244:247], v11 offset:2048
M a[152:155], a[176:179], a[248:251], a[152:155]
M a[156:159], a[184:187], a[248:251], 0
buffer_load_dword v23, s[8:11], s24 offen offset:256 lds
M a[156:159], a[188:191], a[252:255], a[156:159]
M a[160:163], a[196:199], a[252:255], 0
M a[160:163], a[192:195], a[248:251], a[160:163]
s_add_u32 m0, s29, 133120
s_nop 0
buffer_load_dwordx4 v2, s[8:11], s23 offen offset:0 lds
M a[164:167], a[176:179], a[224:227], 0
ds_read_b128 a[248:251], v10 offset:4096
ds_read_b128 a[252:255], v11 offset:4096
M a[164:167], a[180:183], a[228:231], a[164:167]
M a[168:171], a[188:191], a[228:231], 0
M a[168:171], a[184:187], a[224:227], a[168:171]
buffer_load_dwordx4 v3, s[8:11], s23 offen offset:1024 lds
M a[172:175], a[192:195], a[224:227], 0
M a[172:175], a[196:199], a[228:231], a[172:175]
s_waitcnt lgkmcnt(4)
M a[68:71], a[200:203], a[232:235], a[68:71]
ds_read_b128 a[224:227], v10 offset:6144
ds_read_b128 a[228:231], v11 offset:6144
M a[68:71], a[204:207], a[236:239], a[68:71]
buffer_load_dwordx4 v4, s[8:11], s23 offen offset:2048 lds
M a[72:75], a[212:215], a[236:239], a[72:75]
ds_read_b64_tr_b16 a[176:177], v14 offset:0
ds_read_b64_tr_b16 a[178:179], v14 offset:1536
M a[72:75], a[208:211], a[232:235], a[72:75]
buffer_load_dwordx4 v5, s[8:11], s23 offen offset:3072 lds
M a[76:79], a[216:219], a[232:235], a[76:79]
M a[76:79], a[220:223], a[236:239], a[76:79]
s_sub_u32 s31, s31, 1
s_cmp_eq_u32 s31, 0
s_cselect_b32 s58, -1920, s57
s_add_u32 s23, s23, s58
s_add_u32 s24, s24, s58
s_waitcnt lgkmcnt(6)
M a[80:83], a[204:207], a[244:247], a[80:83]
ds_read_b128 a[232:235], v10 offset:8192
ds_read_b128 a[236:239], v11 offset:8192
M a[80:83], a[200:203], a[240:243], a[80:83]
M a[84:87], a[208:211], a[240:243], a[84:87]
ds_read_b64_tr_b16 a[184:185], v15 offset:0
ds_read_b64_tr_b16 a[186:187], v15 offset:1536
M a[84:87], a[212:215], a[244:247], a[84:87]
s_add_u32 m0, s30, 98304
s_nop 0
buffer_load_dwordx4 v6, s[12:15], s25 offen offset:0 lds
M a[88:91], a[220:223], a[244:247], a[88:91]
M a[88:91], a[216:219], a[240:243], a[88:91]
buffer_load_dwordx4 v7, s[12:15], s25 offen offset:1024 lds
s_waitcnt lgkmcnt(8)
M a[92:95], a[200:203], a[248:251], a[92:95]
ds_read_b128 a[240:243], v10 offset:10240
ds_read_b128 a[244:247], v11 offset:10240
M a[92:95], a[204:207], a[252:255], a[92:95]
M a[96:99], a[212:215], a[252:255], a[96:99]
ds_read_b64_tr_b16 a[192:193], v16 offset:0
ds_read_b64_tr_b16 a[194:195], v16 offset:1536
M a[96:99], a[208:211], a[248:251], a[96:99]
buffer_load_dwordx4 v8, s[12:15], s25 offen offset:2048 lds
M a[100:103], a[216:219], a[248:251], a[100:103]
M a[100:103], a[220:223], a[252:255], a[100:103]
buffer_load_dwordx4 v9, s[12:15], s25 offen offset:3072 lds
s_waitcnt lgkmcnt(10)
M a[104:107], a[204:207], a[228:231], a[104:107]
ds_read_b128 a[248:251], v10 offset:12288
ds_read_b128 a[252:255], v11 offset:12288
M a[104:107], a[200:203], a[224:227], a[104:107]
M a[108:111], a[208:211], a[224:227], a[108:111]
ds_read_b64_tr_b16 a[180:181], v14 offset:12288
ds_read_b64_tr_b16 a[182:183], v14 offset:13824
M a[108:111], a[212:215], a[228:231], a[108:111]
s_add_u32 m0, s30, 102400
s_nop 0
buffer_load_dwordx4 v21, s[12:15], s25 offen offset:0 lds
M a[112:115], a[220:223], a[228:231], a[112:115]
M a[112:115], a[216:219], a[224:227], a[112:115]
buffer_load_dwordx4 v22, s[12:15], s25 offen offset:1024 lds
s_waitcnt lgkmcnt(10)
M a[116:119], a[200:203], a[232:235], a[116:119]
ds_read_b128 a[224:227], v10 offset:14336
ds_read_b128 a[228:231], v11 offset:14336
M a[116:119], a[204:207], a[236:239], a[116:119]
M a[120:123], a[212:215], a[236:239], a[120:123]
ds_read_b64_tr_b16 a[188:189], v15 offset:12288
ds_read_b64_tr_b16 a[190:191], v15 offset:13824
M a[120:123], a[208:211], a[232:235], a[120:123]
s_sub_u32 s54, s54, 1
s_cmp_eq_u32 s54, 0
s_cselect_b32 s58, s55, s56
s_add_u32 s25, s25, s58
M a[124:127], a[216:219], a[232:235], a[124:127]
M a[124:127], a[220:223], a[236:239], a[124:127]
s_add_u32 s94, s92, 12288
buffer_store_dwordx4 v[144:147], v1, s[16:19], s94 offen offset:2048 sc1
s_waitcnt lgkmcnt(10)
M a[128:131], a[204:207], a[244:247], a[128:131]
ds_read_b128 a[232:235], v10 offset:16384
ds_read_b128 a[236:239], v11 offset:16384
M a[128:131], a[200:203], a[240:243], a[128:131]
M a[132:135], a[208:211], a[240:243], a[132:135]
ds_read_b64_tr_b16 a[196:197], v16 offset:12288
ds_read_b64_tr_b16 a[198:199], v16 offset:13824
M a[132:135], a[212:215], a[244:247], a[132:135]
s_add_u32 s94, s92, 12288
buffer_store_dwordx4 v[152:155], v1, s[16:19], s94 offen offset:3072 sc1
M a[136:139], a[220:223], a[244:247], a[136:139]
M a[136:139], a[216:219], a[240:243], a[136:139]
s_add_u32 s94, s93, 0
buffer_store_dwordx4 v[160:163], v1, s[16:19], s94 offen offset:0 sc1
s_waitcnt lgkmcnt(10)
M a[140:143], a[200:203], a[248:251], a[140:143]
M a[140:143], a[204:207], a[252:255], a[140:143]
s_add_u32 s94, s93, 0
buffer_store_dwordx4 v[168:171], v1, s[16:19], s94 offen offset:1024 sc1
M a[144:147], a[212:215], a[252:255], a[144:147]
M a[144:147], a[208:211], a[248:251], a[144:147]
M a[148:151], a[216:219], a[248:251], a[148:151]
s_waitcnt vmcnt(16) lgkmcnt(0)
s_barrier
ds_read_b128 a[240:243], v10 offset:18432
ds_read_b128 a[244:247], v11 offset:18432
M a[148:151], a[220:223], a[252:255], a[148:151]
s_add_u32 m0, s28, 0
s_nop 0
buffer_load_dword v20, s[8:11], s24 offen lds
M a[152:155], a[204:207], a[228:231], a[152:155]
ds_read_b128 a[248:251], v10 offset:20480
ds_read_b128 a[252:255], v11 offset:20480
M a[152:155], a[200:203], a[224:227], a[152:155]
M a[156:159], a[208:211], a[224:227], a[156:159]
buffer_load_dword v23, s[8:11], s24 offen offset:256 lds
M a[156:159], a[212:215], a[228:231], a[156:159]
M a[160:163], a[220:223], a[228:231], a[160:163]
M a[160:163], a[216:219], a[224:227], a[160:163]
s_add_u32 m0, s29, 2048
s_nop 0
buffer_load_dwordx4 v2, s[8:11], s23 offen offset:0 lds
M a[164:167], a[200:203], a[232:235], a[164:167]
ds_read_b128 a[224:227], v10 offset:22528
ds_read_b128 a[228:231], v11 offset:22528
M a[164:167], a[204:207], a[236:239], a[164:167]
M a[168:171], a[212:215], a[236:239], a[168:171]
M a[168:171], a[208:211], a[232:235], a[168:171]
buffer_load_dwordx4 v3, s[8:11], s23 offen offset:1024 lds
M a[172:175], a[216:219], a[232:235], a[172:175]
M a[172:175], a[220:223], a[236:239], a[172:175]
s_waitcnt lgkmcnt(4)
M a[68:71], a[176:179], a[240:243], a[68:71]
ds_read_b128 a[232:235], v10 offset:24576
ds_read_b128 a[236:239], v11 offset:24576
M a[68:71], a[180:183], a[244:247], a[68:71]
buffer_load_dwordx4 v4, s[8:11], s23 offen offset:2048 lds
M a[72:75], a[188:191], a[244:247], a[72:75]
ds_read_b64_tr_b16 a[200:201], v14 offset:28672
ds_read_b64_tr_b16 a[202:203], v14 offset:30208
M a[72:75], a[184:187], a[240:243], a[72:75]
buffer_load_dwordx4 v5, s[8:11], s23 offen offset:3072 lds
M a[76:79], a[192:195], a[240:243], a[76:79]
M a[76:79], a[196:199], a[244:247], a[76:79]
s_sub_u32 s31, s31, 1
s_cmp_eq_u32 s31, 0
s_cselect_b32 s58, -1920, s57
s_add_u32 s23, s23, s58
s_add_u32 s24, s24, s58
s_waitcnt lgkmcnt(6)
M a[80:83], a[180:183], a[252:255], a[80:83]
ds_read_b128 a[240:243], v10 offset:26624
ds_read_b128 a[244:247], v11 offset:26624
M a[80:83], a[176:179], a[248:251], a[80:83]
M a[84:87], a[184:187], a[248:251], a[84:87]
ds_read_b64_tr_b16 a[208:209], v15 offset:28672
ds_read_b64_tr_b16 a[210:211], v15 offset:30208
M a[84:87], a[188:191], a[252:255], a[84:87]
s_add_u32 m0, s30, 36864
s_nop 0
buffer_load_dwordx4 v6, s[12:15], s25 offen offset:0 lds
M a[88:91], a[196:199], a[252:255], a[88:91]
M a[88:91], a[192:195], a[248:251], a[88:91]
buffer_load_dwordx4 v7, s[12:15], s25 offen offset:1024 lds
s_waitcnt lgkmcnt(8)
M a[92:95], a[176:179], a[224:227], a[92:95]
ds_read_b128 a[248:251], v10 offset:28672
ds_read_b128 a[252:255], v11 offset:28672
M a[92:95], a[180:183], a[228:231], a[92:95]
M a[96:99], a[188:191], a[228:231], a[96:99]
ds_read_b64_tr_b16 a[216:217], v16 offset:28672
ds_read_b64_tr_b16 a[218:219], v16 offset:30208
M a[96:99], a[184:187], a[224:227], a[96:99]
buffer_load_dwordx4 v8, s[12:15], s25 offen offset:2048 lds
M a[100:103], a[192:195], a[224:227], a[100:103]
M a[100:103], a[196:199], a[228:231], a[100:103]
buffer_load_dwordx4 v9, s[12:15], s25 offen offset:3072 lds
s_waitcnt lgkmcnt(10)
M a[104:107], a[180:183], a[236:239], a[104:107]
ds_read_b128 a[224:227], v10 offset:30720
ds_read_b128 a[228:231], v11 offset:30720
M a[104:107], a[176:179], a[232:235], a[104:107]
M a[108:111], a[184:187], a[232:235], a[108:111]
ds_read_b64_tr_b16 a[204:205], v14 offset:40960
ds_read_b64_tr_b16 a[206:207], v14 offset:42496
M a[108:111], a[188:191], a[236:239], a[108:111]
s_add_u32 m0, s30, 40960
s_nop 0
buffer_load_dwordx4 v21, s[12:15], s25 offen offset:0 lds
M a[112:115], a[196:199], a[236:239], a[112:115]
M a[112:115], a[192:195], a[232:235], a[112:115]
buffer_load_dwordx4 v22, s[12:15], s25 offen offset:1024 lds
s_waitcnt lgkmcnt(10)
M a[116:119], a[176:179], a[240:243], a[116:119]
ds_read_b128 a[232:235], v10 offset:32768
ds_read_b128 a[236:239], v11 offset:32768
M a[116:119], a[180:183], a[244:247], a[116:119]
M a[120:123], a[188:191], a[244:247], a[120:123]
ds_read_b64_tr_b16 a[212:213], v15 offset:40960
ds_read_b64_tr_b16 a[214:215], v15 offset:42496
M a[120:123], a[184:187], a[240:243], a[120:123]
s_sub_u32 s54, s54, 1
s_cmp_eq_u32 s54, 0
s_cselect_b32 s58, s55, s56
s_add_u32 s25, s25, s58
M a[124:127], a[192:195], a[240:243], a[124:127]
M a[124:127], a[196:199], a[244:247], a[124:127]
s_add_u32 s94, s93, 0
buffer_store_dwordx4 v[176:179], v1, s[16:19], s94 offen offset:2048 sc1
s_waitcnt lgkmcnt(10)
M a[128:131], a[180:183], a[252:255], a[128:131]
ds_read_b128 a[240:243], v10 offset:34816
ds_read_b128 a[244:247], v11 offset:34816
M a[128:131], a[176:179], a[248:251], a[128:131]
M a[132:135], a[184:187], a[248:251], a[132:135]
ds_read_b64_tr_b16 a[220:221], v16 offset:40960
ds_read_b64_tr_b16 a[222:223], v16 offset:42496
M a[132:135], a[188:191], a[252:255], a[132:135]
s_add_u32 s94, s93, 0
buffer_store_dwordx4 v[184:187], v1, s[16:19], s94 offen offset:3072 sc1
M a[136:139], a[196:199], a[252:255], a[136:139]
M a[136:139], a[192:195], a[248:251], a[136:139]
s_add_u32 s94, s93, 4096
buffer_store_dwordx4 v[192:195], v1, s[16:19], s94 offen offset:0 sc1
s_waitcnt lgkmcnt(10)
M a[140:143], a[176:179], a[224:227], a[140:143]
M a[140:143], a[180:183], a[228:231], a[140:143]
s_add_u32 s94, s93, 4096
buffer_store_dwordx4 v[200:203], v1, s[16:19], s94 offen offset:1024 sc1
M a[144:147], a[188:191], a[228:231], a[144:147]
M a[144:147], a[184:187], a[224:227], a[144:147]
M a[148:151], a[192:195], a[224:227], a[148:151]
s_waitcnt vmcnt(20) lgkmcnt(0)
s_barrier
ds_read_b128 a[248:251], v12 offset:0
ds_read_b128 a[252:255], v13 offset:0
M a[148:151], a[196:199], a[228:231], a[148:151]
s_add_u32 m0, s28, 18432
s_nop 0
buffer_load_dword v20, s[8:11], s24 offen lds
M a[152:155], a[180:183], a[236:239], a[152:155]
ds_read_b128 a[224:227], v12 offset:2048
ds_read_b128 a[228:231], v13 offset:2048
M a[152:155], a[176:179], a[232:235], a[152:155]
M a[156:159], a[184:187], a[232:235], a[156:159]
buffer_load_dword v23, s[8:11], s24 offen offset:256 lds
M a[156:159], a[188:191], a[236:239], a[156:159]
M a[160:163], a[196:199], a[236:239], a[160:163]
M a[160:163], a[192:195], a[232:235], a[160:163]
s_add_u32 m0, s29, 20480
s_nop 0
buffer_load_dwordx4 v2, s[8:11], s23 offen offset:0 lds
M a[164:167], a[176:179], a[240:243], a[164:167]
ds_read_b128 a[232:235], v12 offset:4096
ds_read_b128 a[236:239], v13 offset:4096
M a[164:167], a[180:183], a[244:247], a[164:167]
M a[168:171], a[188:191], a[244:247], a[168:171]
M a[168:171], a[184:187], a[240:243], a[168:171]
buffer_load_dwordx4 v3, s[8:11], s23 offen offset:1024 lds
M a[172:175], a[192:195], a[240:243], a[172:175]
M a[172:175], a[196:199], a[244:247], a[172:175]
s_waitcnt lgkmcnt(4)
M a[68:71], a[200:203], a[248:251], a[68:71]
ds_read_b128 a[240:243], v12 offset:6144
ds_read_b128 a[244:247], v13 offset:6144
M a[68:71], a[204:207], a[252:255], a[68:71]
buffer_load_dwordx4 v4, s[8:11], s23 offen offset:2048 lds
M a[72:75], a[212:215], a[252:255], a[72:75]
ds_read_b64_tr_b16 a[176:177], v17 offset:0
ds_read_b64_tr_b16 a[178:179], v17 offset:1536
M a[72:75], a[208:211], a[248:251], a[72:75]
buffer_load_dwordx4 v5, s[8:11], s23 offen offset:3072 lds
M a[76:79], a[216:219], a[248:251], a[76:79]
M a[76:79], a[220:223], a[252:255], a[76:79]
s_sub_u32 s31, s31, 1
s_cmp_eq_u32 s31, 0
s_cselect_b32 s58, -1920, s57
s_add_u32 s23, s23, s58
s_add_u32 s24, s24, s58
s_waitcnt lgkmcnt(6)
M a[80:83], a[204:207], a[228:231], a[80:83]
ds_read_b128 a[248:251], v12 offset:8192
ds_read_b128 a[252:255], v13 offset:8192
M a[80:83], a[200:203], a[224:227], a[80:83]
M a[84:87], a[208:211], a[224:227], a[84:87]
ds_read_b64_tr_b16 a[184:185], v18 offset:0
ds_read_b64_tr_b16 a[186:187], v18 offset:1536
M a[84:87], a[212:215], a[228:231], a[84:87]
s_add_u32 m0, s30, 65536
s_nop 0
buffer_load_dwordx4 v6, s[12:15], s25 offen offset:0 lds
M a[88:91], a[220:223], a[228:231], a[88:91]
M a[88:91], a[216:219], a[224:227], a[88:91]
buffer_load_dwordx4 v7, s[12:15], s25 offen offset:1024 lds
s_waitcnt lgkmcnt(8)
M a[92:95], a[200:203], a[232:235], a[92:95]
ds_read_b128 a[224:227], v12 offset:10240
ds_read_b128 a[228:231], v13 offset:10240
M a[92:95], a[204:207], a[236:239], a[92:95]
M a[96:99], a[212:215], a[236:239], a[96:99]
ds_read_b64_tr_b16 a[192:193], v19 offset:0
ds_read_b64_tr_b16 a[194:195], v19 offset:1536
M a[96:99], a[208:211], a[232:235], a[96:99]
buffer_load_dwordx4 v8, s[12:15], s25 offen offset:2048 lds
M a[100:103], a[216:219], a[232:235], a[100:103]
M a[100:103], a[220:223], a[236:239], a[100:103]
buffer_load_dwordx4 v9, s[12:15], s25 offen offset:3072 lds
s_waitcnt lgkmcnt(10)
M a[104:107], a[204:207], a[244:247], a[104:107]
ds_read_b128 a[232:235], v12 offset:12288
ds_read_b128 a[236:239], v13 offset:12288
M a[104:107], a[200:203], a[240:243], a[104:107]
M a[108:111], a[208:211], a[240:243], a[108:111]
ds_read_b64_tr_b16 a[180:181], v17 offset:12288
ds_read_b64_tr_b16 a[182:183], v17 offset:13824
M a[108:111], a[212:215], a[244:247], a[108:111]
s_add_u32 m0, s30, 69632
s_nop 0
buffer_load_dwordx4 v21, s[12:15], s25 offen offset:0 lds
M a[112:115], a[220:223], a[244:247], a[112:115]
M a[112:115], a[216:219], a[240:243], a[112:115]
buffer_load_dwordx4 v22, s[12:15], s25 offen offset:1024 lds
s_waitcnt lgkmcnt(10)
M a[116:119], a[200:203], a[248:251], a[116:119]
ds_read_b128 a[240:243], v12 offset:14336
ds_read_b128 a[244:247], v13 offset:14336
M a[116:119], a[204:207], a[252:255], a[116:119]
M a[120:123], a[212:215], a[252:255], a[120:123]
ds_read_b64_tr_b16 a[188:189], v18 offset:12288
ds_read_b64_tr_b16 a[190:191], v18 offset:13824
M a[120:123], a[208:211], a[248:251], a[120:123]
s_sub_u32 s54, s54, 1
s_cmp_eq_u32 s54, 0
s_cselect_b32 s58, s55, s56
s_add_u32 s25, s25, s58
M a[124:127], a[216:219], a[248:251], a[124:127]
M a[124:127], a[220:223], a[252:255], a[124:127]
s_add_u32 s94, s93, 4096
buffer_store_dwordx4 v[208:211], v1, s[16:19], s94 offen offset:2048 sc1
s_waitcnt lgkmcnt(10)
M a[128:131], a[204:207], a[228:231], a[128:131]
ds_read_b128 a[248:251], v12 offset:16384
ds_read_b128 a[252:255], v13 offset:16384
M a[128:131], a[200:203], a[224:227], a[128:131]
M a[132:135], a[208:211], a[224:227], a[132:135]
ds_read_b64_tr_b16 a[196:197], v19 offset:12288
ds_read_b64_tr_b16 a[198:199], v19 offset:13824
M a[132:135], a[212:215], a[228:231], a[132:135]
s_add_u32 s94, s93, 4096
buffer_store_dwordx4 v[216:219], v1, s[16:19], s94 offen offset:3072 sc1
M a[136:139], a[220:223], a[228:231], a[136:139]
M a[136:139], a[216:219], a[224:227], a[136:139]
s_add_u32 s94, s93, 8192
buffer_store_dwordx4 v[224:227], v1, s[16:19], s94 offen offset:0 sc1
s_waitcnt lgkmcnt(10)
M a[140:143], a[200:203], a[232:235], a[140:143]
M a[140:143], a[204:207], a[236:239], a[140:143]
s_add_u32 s94, s93, 8192
buffer_store_dwordx4 v[232:235], v1, s[16:19], s94 offen offset:1024 sc1
M a[144:147], a[212:215], a[236:239], a[144:147]
M a[144:147], a[208:211], a[232:235], a[144:147]
M a[148:151], a[216:219], a[232:235], a[148:151]
s_waitcnt vmcnt(20) lgkmcnt(0)
s_barrier
ds_read_b128 a[224:227], v10 offset:0
ds_read_b128 a[228:231], v11 offset:0
M a[148:151], a[220:223], a[236:239], a[148:151]
s_add_u32 m0, s28, 131072
s_nop 0
buffer_load_dword v20, s[8:11], s24 offen lds
M a[152:155], a[204:207], a[244:247], a[152:155]
ds_read_b128 a[232:235], v10 offset:2048
ds_read_b128 a[236:239], v11 offset:2048
M a[152:155], a[200:203], a[240:243], a[152:155]
M a[156:159], a[208:211], a[240:243], a[156:159]
buffer_load_dword v23, s[8:11], s24 offen offset:256 lds
M a[156:159], a[212:215], a[244:247], a[156:159]
M a[160:163], a[220:223], a[244:247], a[160:163]
M a[160:163], a[216:219], a[240:243], a[160:163]
s_add_u32 m0, s29, 133120
s_nop 0
buffer_load_dwordx4 v2, s[8:11], s23 offen offset:0 lds
M a[164:167], a[200:203], a[248:251], a[164:167]
ds_read_b128 a[240:243], v10 offset:4096
ds_read_b128 a[244:247], v11 offset:4096
M a[164:167], a[204:207], a[252:255], a[164:167]
M a[168:171], a[212:215], a[252:255], a[168:171]
M a[168:171], a[208:211], a[248:251], a[168:171]
buffer_load_dwordx4 v3, s[8:11], s23 offen offset:1024 lds
M a[172:175], a[216:219], a[248:251], a[172:175]
M a[172:175], a[220:223], a[252:255], a[172:175]
s_waitcnt lgkmcnt(4)
M a[68:71], a[176:179], a[224:227], a[68:71]
ds_read_b128 a[248:251], v10 offset:6144
ds_read_b128 a[252:255], v11 offset:6144
M a[68:71], a[180:183], a[228:231], a[68:71]
buffer_load_dwordx4 v4, s[8:11], s23 offen offset:2048 lds
M a[72:75], a[188:191], a[228:231], a[72:75]
ds_read_b64_tr_b16 a[200:201], v14 offset:0
ds_read_b64_tr_b16 a[202:203], v14 offset:1536
M a[72:75], a[184:187], a[224:227], a[72:75]
buffer_load_dwordx4 v5, s[8:11], s23 offen offset:3072 lds
M a[76:79], a[192:195], a[224:227], a[76:79]
M a[76:79], a[196:199], a[228:231], a[76:79]
s_sub_u32 s31, s31, 1
s_cmp_eq_u32 s31, 0
s_cselect_b32 s58, -1920, s57
s_add_u32 s23, s23, s58
s_add_u32 s24, s24, s58
s_waitcnt lgkmcnt(6)
M a[80:83], a[180:183], a[236:239], a[80:83]
ds_read_b128 a[224:227], v10 offset:8192
ds_read_b128 a[228:231], v11 offset:8192
M a[80:83], a[176:179], a[232:235], a[80:83]
M a[84:87], a[184:187], a[232:235], a[84:87]
ds_read_b64_tr_b16 a[208:209], v15 offset:0
ds_read_b64_tr_b16 a[210:211], v15 offset:1536
M a[84:87], a[188:191], a[236:239], a[84:87]
s_add_u32 m0, s30, 98304
s_nop 0
buffer_load_dwordx4 v6, s[12:15], s25 offen offset:0 lds
M a[88:91], a[196:199], a[236:239], a[88:91]
M a[88:91], a[192:195], a[232:235], a[88:91]
buffer_load_dwordx4 v7, s[12:15], s25 offen offset:1024 lds
s_waitcnt lgkmcnt(8)
M a[92:95], a[176:179], a[240:243], a[92:95]
ds_read_b128 a[232:235], v10 offset:10240
ds_read_b128 a[236:239], v11 offset:10240
M a[92:95], a[180:183], a[244:247], a[92:95]
M a[96:99], a[188:191], a[244:247], a[96:99]
ds_read_b64_tr_b16 a[216:217], v16 offset:0
ds_read_b64_tr_b16 a[218:219], v16 offset:1536
M a[96:99], a[184:187], a[240:243], a[96:99]
buffer_load_dwordx4 v8, s[12:15], s25 offen offset:2048 lds
M a[100:103], a[192:195], a[240:243], a[100:103]
M a[100:103], a[196:199], a[244:247], a[100:103]
buffer_load_dwordx4 v9, s[12:15], s25 offen offset:3072 lds
s_waitcnt lgkmcnt(10)
M a[104:107], a[180:183], a[252:255], a[104:107]
ds_read_b128 a[240:243], v10 offset:12288
ds_read_b128 a[244:247], v11 offset:12288
M a[104:107], a[176:179], a[248:251], a[104:107]
M a[108:111], a[184:187], a[248:251], a[108:111]
ds_read_b64_tr_b16 a[204:205], v14 offset:12288
ds_read_b64_tr_b16 a[206:207], v14 offset:13824
M a[108:111], a[188:191], a[252:255], a[108:111]
s_add_u32 m0, s30, 102400
s_nop 0
buffer_load_dwordx4 v21, s[12:15], s25 offen offset:0 lds
M a[112:115], a[196:199], a[252:255], a[112:115]
M a[112:115], a[192:195], a[248:251], a[112:115]
buffer_load_dwordx4 v22, s[12:15], s25 offen offset:1024 lds
s_waitcnt lgkmcnt(10)
M a[116:119], a[176:179], a[224:227], a[116:119]
ds_read_b128 a[248:251], v10 offset:14336
ds_read_b128 a[252:255], v11 offset:14336
M a[116:119], a[180:183], a[228:231], a[116:119]
M a[120:123], a[188:191], a[228:231], a[120:123]
ds_read_b64_tr_b16 a[212:213], v15 offset:12288
ds_read_b64_tr_b16 a[214:215], v15 offset:13824
M a[120:123], a[184:187], a[224:227], a[120:123]
s_sub_u32 s54, s54, 1
s_cmp_eq_u32 s54, 0
s_cselect_b32 s58, s55, s56
s_add_u32 s25, s25, s58
M a[124:127], a[192:195], a[224:227], a[124:127]
M a[124:127], a[196:199], a[228:231], a[124:127]
s_add_u32 s94, s93, 8192
buffer_store_dwordx4 v[240:243], v1, s[16:19], s94 offen offset:2048 sc1
s_waitcnt lgkmcnt(10)
M a[128:131], a[180:183], a[236:239], a[128:131]
ds_read_b128 a[224:227], v10 offset:16384
ds_read_b128 a[228:231], v11 offset:16384
M a[128:131], a[176:179], a[232:235], a[128:131]
M a[132:135], a[184:187], a[232:235], a[132:135]
ds_read_b64_tr_b16 a[220:221], v16 offset:12288
ds_read_b64_tr_b16 a[222:223], v16 offset:13824
M a[132:135], a[188:191], a[236:239], a[132:135]
s_add_u32 s94, s93, 8192
buffer_store_dwordx4 v[248:251], v1, s[16:19], s94 offen offset:3072 sc1
M a[136:139], a[196:199], a[236:239], a[136:139]
M a[136:139], a[192:195], a[232:235], a[136:139]
s_add_u32 s94, s93, 12288
buffer_store_dwordx4 v[36:39], v1, s[16:19], s94 offen offset:0 sc1
s_waitcnt lgkmcnt(10)
M a[140:143], a[176:179], a[240:243], a[140:143]
M a[140:143], a[180:183], a[244:247], a[140:143]
s_add_u32 s94, s93, 12288
buffer_store_dwordx4 v[44:47], v1, s[16:19], s94 offen offset:1024 sc1
M a[144:147], a[188:191], a[244:247], a[144:147]
M a[144:147], a[184:187], a[240:243], a[144:147]
M a[148:151], a[192:195], a[240:243], a[148:151]
s_waitcnt vmcnt(20) lgkmcnt(0)
s_barrier
ds_read_b128 a[232:235], v10 offset:18432
ds_read_b128 a[236:239], v11 offset:18432
M a[148:151], a[196:199], a[244:247], a[148:151]
s_add_u32 m0, s28, 0
s_nop 0
buffer_load_dword v20, s[8:11], s24 offen lds
M a[152:155], a[180:183], a[252:255], a[152:155]
ds_read_b128 a[240:243], v10 offset:20480
ds_read_b128 a[244:247], v11 offset:20480
M a[152:155], a[176:179], a[248:251], a[152:155]
M a[156:159], a[184:187], a[248:251], a[156:159]
buffer_load_dword v23, s[8:11], s24 offen offset:256 lds
M a[156:159], a[188:191], a[252:255], a[156:159]
M a[160:163], a[196:199], a[252:255], a[160:163]
M a[160:163], a[192:195], a[248:251], a[160:163]
s_add_u32 m0, s29, 2048
s_nop 0
buffer_load_dwordx4 v2, s[8:11], s23 offen offset:0 lds
M a[164:167], a[176:179], a[224:227], a[164:167]
ds_read_b128 a[248:251], v10 offset:22528
ds_read_b128 a[252:255], v11 offset:22528
M a[164:167], a[180:183], a[228:231], a[164:167]
M a[168:171], a[188:191], a[228:231], a[168:171]
M a[168:171], a[184:187], a[224:227], a[168:171]
buffer_load_dwordx4 v3, s[8:11], s23 offen offset:1024 lds
M a[172:175], a[192:195], a[224:227], a[172:175]
M a[172:175], a[196:199], a[228:231], a[172:175]
s_waitcnt lgkmcnt(4)
M a[68:71], a[200:203], a[232:235], a[68:71]
ds_read_b128 a[224:227], v10 offset:24576
ds_read_b128 a[228:231], v11 offset:24576
M a[68:71], a[204:207], a[236:239], a[68:71]
buffer_load_dwordx4 v4, s[8:11], s23 offen offset:2048 lds
M a[72:75], a[212:215], a[236:239], a[72:75]
ds_read_b64_tr_b16 a[176:177], v14 offset:28672
ds_read_b64_tr_b16 a[178:179], v14 offset:30208
M a[72:75], a[208:211], a[232:235], a[72:75]
M a[76:79], a[216:219], a[232:235], a[76:79]
buffer_load_dwordx4 v5, s[8:11], s23 offen offset:3072 lds
M a[76:79], a[220:223], a[236:239], a[76:79]
s_waitcnt lgkmcnt(6)
M a[80:83], a[204:207], a[244:247], a[80:83]
ds_read_b128 a[232:235], v10 offset:26624
ds_read_b128 a[236:239], v11 offset:26624
M a[80:83], a[200:203], a[240:243], a[80:83]
s_sub_u32 s31, s31, 1
s_cmp_eq_u32 s31, 0
s_cselect_b32 s58, -1920, s57
s_add_u32 s23, s23, s58
s_add_u32 s24, s24, s58
M a[84:87], a[208:211], a[240:243], a[84:87]
ds_read_b64_tr_b16 a[184:185], v15 offset:28672
ds_read_b64_tr_b16 a[186:187], v15 offset:30208
M a[84:87], a[212:215], a[244:247], a[84:87]
M a[88:91], a[220:223], a[244:247], a[88:91]
s_add_u32 m0, s30, 36864
s_nop 0
buffer_load_dwordx4 v6, s[12:15], s25 offen offset:0 lds
M a[88:91], a[216:219], a[240:243], a[88:91]
s_waitcnt lgkmcnt(8)
M a[92:95], a[200:203], a[248:251], a[92:95]
ds_read_b128 a[240:243], v10 offset:28672
ds_read_b128 a[244:247], v11 offset:28672
M a[92:95], a[204:207], a[252:255], a[92:95]
M a[96:99], a[212:215], a[252:255], a[96:99]
ds_read_b64_tr_b16 a[192:193], v16 offset:28672
ds_read_b64_tr_b16 a[194:195], v16 offset:30208
M a[96:99], a[208:211], a[248:251], a[96:99]
buffer_load_dwordx4 v7, s[12:15], s25 offen offset:1024 lds
M a[100:103], a[216:219], a[248:251], a[100:103]
M a[100:103], a[220:223], a[252:255], a[100:103]
buffer_load_dwordx4 v8, s[12:15], s25 offen offset:2048 lds
s_waitcnt lgkmcnt(10)
M a[104:107], a[204:207], a[228:231], a[104:107]
ds_read_b128 a[248:251], v10 offset:30720
ds_read_b128 a[252:255], v11 offset:30720
M a[104:107], a[200:203], a[224:227], a[104:107]
M a[108:111], a[208:211], a[224:227], a[108:111]
ds_read_b64_tr_b16 a[180:181], v14 offset:40960
ds_read_b64_tr_b16 a[182:183], v14 offset:42496
M a[108:111], a[212:215], a[228:231], a[108:111]
buffer_load_dwordx4 v9, s[12:15], s25 offen offset:3072 lds
M a[112:115], a[220:223], a[228:231], a[112:115]
M a[112:115], a[216:219], a[224:227], a[112:115]
s_add_u32 m0, s30, 40960
s_nop 0
buffer_load_dwordx4 v21, s[12:15], s25 offen offset:0 lds
s_waitcnt lgkmcnt(10)
M a[116:119], a[200:203], a[232:235], a[116:119]
ds_read_b128 a[224:227], v10 offset:32768
ds_read_b128 a[228:231], v11 offset:32768
M a[116:119], a[204:207], a[236:239], a[116:119]
M a[120:123], a[212:215], a[236:239], a[120:123]
ds_read_b64_tr_b16 a[188:189], v15 offset:40960
ds_read_b64_tr_b16 a[190:191], v15 offset:42496
M a[120:123], a[208:211], a[232:235], a[120:123]
M a[124:127], a[216:219], a[232:235], a[124:127]
buffer_load_dwordx4 v22, s[12:15], s25 offen offset:1024 lds
M a[124:127], a[220:223], a[236:239], a[124:127]
s_waitcnt lgkmcnt(10)
M a[128:131], a[204:207], a[244:247], a[128:131]
ds_read_b128 a[232:235], v10 offset:34816
ds_read_b128 a[236:239], v11 offset:34816
M a[128:131], a[200:203], a[240:243], a[128:131]
s_sub_u32 s54, s54, 1
s_cmp_eq_u32 s54, 0
s_cselect_b32 s58, s55, s56
s_add_u32 s25, s25, s58
M a[132:135], a[208:211], a[240:243], a[132:135]
ds_read_b64_tr_b16 a[196:197], v16 offset:40960
ds_read_b64_tr_b16 a[198:199], v16 offset:42496
M a[132:135], a[212:215], a[244:247], a[132:135]
M a[136:139], a[220:223], a[244:247], a[136:139]
s_add_u32 s94, s93, 12288
buffer_store_dwordx4 v[52:55], v1, s[16:19], s94 offen offset:2048 sc1
M a[136:139], a[216:219], a[240:243], a[136:139]
s_waitcnt lgkmcnt(10)
M a[140:143], a[200:203], a[248:251], a[140:143]
s_add_u32 s94, s93, 12288
buffer_store_dwordx4 v[60:63], v1, s[16:19], s94 offen offset:3072 sc1
M a[140:143], a[204:207], a[252:255], a[140:143]
M a[144:147], a[212:215], a[252:255], a[144:147]
M a[144:147], a[208:211], a[248:251], a[144:147]
M a[148:151], a[216:219], a[248:251], a[148:151]
s_waitcnt vmcnt(18) lgkmcnt(0)
s_barrier
ds_read_b128 a[240:243], v12 offset:0
ds_read_b128 a[244:247], v13 offset:0
M a[148:151], a[220:223], a[252:255], a[148:151]
s_add_u32 m0, s28, 18432
s_nop 0
buffer_load_dword v20, s[8:11], s24 offen lds
M a[152:155], a[204:207], a[228:231], a[152:155]
ds_read_b128 a[248:251], v12 offset:2048
ds_read_b128 a[252:255], v13 offset:2048
M a[152:155], a[200:203], a[224:227], a[152:155]
M a[156:159], a[208:211], a[224:227], a[156:159]
buffer_load_dword v23, s[8:11], s24 offen offset:256 lds
M a[156:159], a[212:215], a[228:231], a[156:159]
M a[160:163], a[220:223], a[228:231], a[160:163]
M a[160:163], a[216:219], a[224:227], a[160:163]
s_add_u32 m0, s29, 20480
s_nop 0
buffer_load_dwordx4 v2, s[8:11], s23 offen offset:0 lds
M a[164:167], a[200:203], a[232:235], a[164:167]
ds_read_b128 a[224:227], v12 offset:4096
ds_read_b128 a[228:231], v13 offset:4096
M a[164:167], a[204:207], a[236:239], a[164:167]
M a[168:171], a[212:215], a[236:239], a[168:171]
M a[168:171], a[208:211], a[232:235], a[168:171]
buffer_load_dwordx4 v3, s[8:11], s23 offen offset:1024 lds
M a[172:175], a[216:219], a[232:235], a[172:175]
M a[172:175], a[220:223], a[236:239], a[172:175]
s_waitcnt lgkmcnt(4)
M a[68:71], a[176:179], a[240:243], a[68:71]
ds_read_b128 a[232:235], v12 offset:6144
ds_read_b128 a[236:239], v13 offset:6144
M a[68:71], a[180:183], a[244:247], a[68:71]
buffer_load_dwordx4 v4, s[8:11], s23 offen offset:2048 lds
M a[72:75], a[188:191], a[244:247], a[72:75]
ds_read_b64_tr_b16 a[200:201], v17 offset:0
ds_read_b64_tr_b16 a[202:203], v17 offset:1536
M a[72:75], a[184:187], a[240:243], a[72:75]
M a[76:79], a[192:195], a[240:243], a[76:79]
buffer_load_dwordx4 v5, s[8:11], s23 offen offset:3072 lds
M a[76:79], a[196:199], a[244:247], a[76:79]
s_waitcnt lgkmcnt(6)
M a[80:83], a[180:183], a[252:255], a[80:83]
ds_read_b128 a[240:243], v12 offset:8192
ds_read_b128 a[244:247], v13 offset:8192
M a[80:83], a[176:179], a[248:251], a[80:83]
M a[84:87], a[184:187], a[248:251], a[84:87]
ds_read_b64_tr_b16 a[208:209], v18 offset:0
ds_read_b64_tr_b16 a[210:211], v18 offset:1536
M a[84:87], a[188:191], a[252:255], a[84:87]
s_sub_u32 s31, s31, 1
s_cmp_eq_u32 s31, 0
s_cselect_b32 s58, -1920, s57
s_add_u32 s23, s23, s58
s_add_u32 s24, s24, s58
M a[88:91], a[196:199], a[252:255], a[88:91]
M a[88:91], a[192:195], a[248:251], a[88:91]
s_waitcnt lgkmcnt(8)
M a[92:95], a[176:179], a[224:227], a[92:95]
ds_read_b128 a[248:251], v12 offset:10240
ds_read_b128 a[252:255], v13 offset:10240
M a[92:95], a[180:183], a[228:231], a[92:95]
s_add_u32 m0, s30, 65536
s_nop 0
buffer_load_dwordx4 v6, s[12:15], s25 offen offset:0 lds
M a[96:99], a[188:191], a[228:231], a[96:99]
ds_read_b64_tr_b16 a[216:217], v19 offset:0
ds_read_b64_tr_b16 a[218:219], v19 offset:1536
M a[96:99], a[184:187], a[224:227], a[96:99]
M a[100:103], a[192:195], a[224:227], a[100:103]
buffer_load_dwordx4 v7, s[12:15], s25 offen offset:1024 lds
M a[100:103], a[196:199], a[228:231], a[100:103]
s_waitcnt lgkmcnt(10)
M a[104:107], a[180:183], a[236:239], a[104:107]
ds_read_b128 a[224:227], v12 offset:12288
ds_read_b128 a[228:231], v13 offset:12288
M a[104:107], a[176:179], a[232:235], a[104:107]
M a[108:111], a[184:187], a[232:235], a[108:111]
ds_read_b64_tr_b16 a[204:205], v17 offset:12288
ds_read_b64_tr_b16 a[206:207], v17 offset:13824
M a[108:111], a[188:191], a[236:239], a[108:111]
buffer_load_dwordx4 v8, s[12:15], s25 offen offset:2048 lds
M a[112:115], a[196:199], a[236:239], a[112:115]
M a[112:115], a[192:195], a[232:235], a[112:115]
s_waitcnt lgkmcnt(10)
M a[116:119], a[176:179], a[240:243], a[116:119]
ds_read_b128 a[232:235], v12 offset:14336
ds_read_b128 a[236:239], v13 offset:14336
M a[116:119], a[180:183], a[244:247], a[116:119]
buffer_load_dwordx4 v9, s[12:15], s25 offen offset:3072 lds
M a[120:123], a[188:191], a[244:247], a[120:123]
ds_read_b64_tr_b16 a[212:213], v18 offset:12288
ds_read_b64_tr_b16 a[214:215], v18 offset:13824
M a[120:123], a[184:187], a[240:243], a[120:123]
M a[124:127], a[192:195], a[240:243], a[124:127]
s_add_u32 m0, s30, 69632
s_nop 0
buffer_load_dwordx4 v21, s[12:15], s25 offen offset:0 lds
M a[124:127], a[196:199], a[244:247], a[124:127]
s_waitcnt lgkmcnt(10)
M a[128:131], a[180:183], a[252:255], a[128:131]
ds_read_b128 a[240:243], v12 offset:16384
ds_read_b128 a[244:247], v13 offset:16384
M a[128:131], a[176:179], a[248:251], a[128:131]
M a[132:135], a[184:187], a[248:251], a[132:135]
ds_read_b64_tr_b16 a[220:221], v19 offset:12288
ds_read_b64_tr_b16 a[222:223], v19 offset:13824
M a[132:135], a[188:191], a[252:255], a[132:135]
buffer_load_dwordx4 v22, s[12:15], s25 offen offset:1024 lds
M a[136:139], a[196:199], a[252:255], a[136:139]
M a[136:139], a[192:195], a[248:251], a[136:139]
s_waitcnt lgkmcnt(10)
M a[140:143], a[176:179], a[224:227], a[140:143]
s_sub_u32 s54, s54, 1
s_cmp_eq_u32 s54, 0
s_cselect_b32 s58, s55, s56
s_add_u32 s25, s25, s58
M a[140:143], a[180:183], a[228:231], a[140:143]
M a[144:147], a[188:191], a[228:231], a[144:147]
M a[144:147], a[184:187], a[224:227], a[144:147]
M a[148:151], a[192:195], a[224:227], a[148:151]
s_waitcnt vmcnt(12) lgkmcnt(0)
s_barrier
ds_read_b128 a[248:251], v10 offset:0
ds_read_b128 a[252:255], v11 offset:0
s_cmp_lg_u32 s101, 0
s_cbranch_scc1 Lk1_arr
v_mov_b32 v127, 1
s_and_b32 s41, s2, 128
s_mov_b64 exec, 1
buffer_atomic_add v127, off, s[36:39], s41 sc1
s_mov_b64 exec, -1
Lk1_arr:
M a[148:151], a[196:199], a[228:231], a[148:151]
s_add_u32 m0, s28, 131072
s_nop 0
buffer_load_dword v20, s[8:11], s24 offen lds
M a[152:155], a[180:183], a[236:239], a[152:155]
ds_read_b128 a[224:227], v10 offset:2048
ds_read_b128 a[228:231], v11 offset:2048
M a[152:155], a[176:179], a[232:235], a[152:155]
M a[156:159], a[184:187], a[232:235], a[156:159]
buffer_load_dword v23, s[8:11], s24 offen offset:256 lds
M a[156:159], a[188:191], a[236:239], a[156:159]
M a[160:163], a[196:199], a[236:239], a[160:163]
M a[160:163], a[192:195], a[232:235], a[160:163]
s_add_u32 m0, s29, 133120
s_nop 0
buffer_load_dwordx4 v2, s[8:11], s23 offen offset:0 lds
M a[164:167], a[176:179], a[240:243], a[164:167]
ds_read_b128 a[232:235], v10 offset:4096
ds_read_b128 a[236:239], v11 offset:4096
M a[164:167], a[180:183], a[244:247], a[164:167]
M a[168:171], a[188:191], a[244:247], a[168:171]
M a[168:171], a[184:187], a[240:243], a[168:171]
buffer_load_dwordx4 v3, s[8:11], s23 offen offset:1024 lds
M a[172:175], a[192:195], a[240:243], a[172:175]
M a[172:175], a[196:199], a[244:247], a[172:175]
s_waitcnt lgkmcnt(4)
M a[68:71], a[200:203], a[248:251], a[68:71]
ds_read_b128 a[240:243], v10 offset:6144
ds_read_b128 a[244:247], v11 offset:6144
M a[68:71], a[204:207], a[252:255], a[68:71]
buffer_load_dwordx4 v4, s[8:11], s23 offen offset:2048 lds
M a[72:75], a[212:215], a[252:255], a[72:75]
ds_read_b64_tr_b16 a[176:177], v14 offset:0
ds_read_b64_tr_b16 a[178:179], v14 offset:1536
M a[72:75], a[208:211], a[248:251], a[72:75]
M a[76:79], a[216:219], a[248:251], a[76:79]
buffer_load_dwordx4 v5, s[8:11], s23 offen offset:3072 lds
M a[76:79], a[220:223], a[252:255], a[76:79]
s_waitcnt lgkmcnt(6)
M a[80:83], a[204:207], a[228:231], a[80:83]
ds_read_b128 a[248:251], v10 offset:8192
ds_read_b128 a[252:255], v11 offset:8192
M a[80:83], a[200:203], a[224:227], a[80:83]
M a[84:87], a[208:211], a[224:227], a[84:87]
ds_read_b64_tr_b16 a[184:185], v15 offset:0
ds_read_b64_tr_b16 a[186:187], v15 offset:1536
M a[84:87], a[212:215], a[228:231], a[84:87]
s_sub_u32 s31, s31, 1
s_cmp_eq_u32 s31, 0
s_cselect_b32 s58, -1920, s57
s_add_u32 s23, s23, s58
s_add_u32 s24, s24, s58
M a[88:91], a[220:223], a[228:231], a[88:91]
M a[88:91], a[216:219], a[224:227], a[88:91]
s_waitcnt lgkmcnt(8)
M a[92:95], a[200:203], a[232:235], a[92:95]
ds_read_b128 a[224:227], v10 offset:10240
ds_read_b128 a[228:231], v11 offset:10240
M a[92:95], a[204:207], a[236:239], a[92:95]
s_add_u32 m0, s30, 98304
s_nop 0
buffer_load_dwordx4 v6, s[12:15], s25 offen offset:0 lds
M a[96:99], a[212:215], a[236:239], a[96:99]
ds_read_b64_tr_b16 a[192:193], v16 offset:0
ds_read_b64_tr_b16 a[194:195], v16 offset:1536
M a[96:99], a[208:211], a[232:235], a[96:99]
M a[100:103], a[216:219], a[232:235], a[100:103]
buffer_load_dwordx4 v7, s[12:15], s25 offen offset:1024 lds
M a[100:103], a[220:223], a[236:239], a[100:103]
s_waitcnt lgkmcnt(10)
M a[104:107], a[204:207], a[244:247], a[104:107]
ds_read_b128 a[232:235], v10 offset:12288
ds_read_b128 a[236:239], v11 offset:12288
M a[104:107], a[200:203], a[240:243], a[104:107]
M a[108:111], a[208:211], a[240:243], a[108:111]
ds_read_b64_tr_b16 a[180:181], v14 offset:12288
ds_read_b64_tr_b16 a[182:183], v14 offset:13824
M a[108:111], a[212:215], a[244:247], a[108:111]
buffer_load_dwordx4 v8, s[12:15], s25 offen offset:2048 lds
M a[112:115], a[220:223], a[244:247], a[112:115]
M a[112:115], a[216:219], a[240:243], a[112:115]
s_waitcnt lgkmcnt(10)
M a[116:119], a[200:203], a[248:251], a[116:119]
ds_read_b128 a[240:243], v10 offset:14336
ds_read_b128 a[244:247], v11 offset:14336
M a[116:119], a[204:207], a[252:255], a[116:119]
buffer_load_dwordx4 v9, s[12:15], s25 offen offset:3072 lds
M a[120:123], a[212:215], a[252:255], a[120:123]
ds_read_b64_tr_b16 a[188:189], v15 offset:12288
ds_read_b64_tr_b16 a[190:191], v15 offset:13824
M a[120:123], a[208:211], a[248:251], a[120:123]
M a[124:127], a[216:219], a[248:251], a[124:127]
s_add_u32 m0, s30, 102400
s_nop 0
buffer_load_dwordx4 v21, s[12:15], s25 offen offset:0 lds
M a[124:127], a[220:223], a[252:255], a[124:127]
s_waitcnt lgkmcnt(10)
M a[128:131], a[204:207], a[228:231], a[128:131]
ds_read_b128 a[248:251], v10 offset:16384
ds_read_b128 a[252:255], v11 offset:16384
M a[128:131], a[200:203], a[224:227], a[128:131]
M a[132:135], a[208:211], a[224:227], a[132:135]
ds_read_b64_tr_b16 a[196:197], v16 offset:12288
ds_read_b64_tr_b16 a[198:199], v16 offset:13824
M a[132:135], a[212:215], a[228:231], a[132:135]
buffer_load_dwordx4 v22, s[12:15], s25 offen offset:1024 lds
M a[136:139], a[220:223], a[228:231], a[136:139]
M a[136:139], a[216:219], a[224:227], a[136:139]
s_waitcnt lgkmcnt(10)
M a[140:143], a[200:203], a[232:235], a[140:143]
s_sub_u32 s54, s54, 1
s_cmp_eq_u32 s54, 0
s_cselect_b32 s58, s55, s56
s_add_u32 s25, s25, s58
M a[140:143], a[204:207], a[236:239], a[140:143]
M a[144:147], a[212:215], a[236:239], a[144:147]
M a[144:147], a[208:211], a[232:235], a[144:147]
M a[148:151], a[216:219], a[232:235], a[148:151]
s_waitcnt vmcnt(12) lgkmcnt(0)
s_barrier
ds_read_b128 a[224:227], v10 offset:18432
ds_read_b128 a[228:231], v11 offset:18432
M a[148:151], a[220:223], a[236:239], a[148:151]
s_add_u32 m0, s28, 0
s_nop 0
buffer_load_dword v20, s[8:11], s24 offen lds
M a[152:155], a[204:207], a[244:247], a[152:155]
ds_read_b128 a[232:235], v10 offset:20480
ds_read_b128 a[236:239], v11 offset:20480
M a[152:155], a[200:203], a[240:243], a[152:155]
M a[156:159], a[208:211], a[240:243], a[156:159]
buffer_load_dword v23, s[8:11], s24 offen offset:256 lds
M a[156:159], a[212:215], a[244:247], a[156:159]
M a[160:163], a[220:223], a[244:247], a[160:163]
M a[160:163], a[216:219], a[240:243], a[160:163]
s_add_u32 m0, s29, 2048
s_nop 0
buffer_load_dwordx4 v2, s[8:11], s23 offen offset:0 lds
M a[164:167], a[200:203], a[248:251], a[164:167]
ds_read_b128 a[240:243], v10 offset:22528
ds_read_b128 a[244:247], v11 offset:22528
M a[164:167], a[204:207], a[252:255], a[164:167]
M a[168:171], a[212:215], a[252:255], a[168:171]
M a[168:171], a[208:211], a[248:251], a[168:171]
buffer_load_dwordx4 v3, s[8:11], s23 offen offset:1024 lds
M a[172:175], a[216:219], a[248:251], a[172:175]
M a[172:175], a[220:223], a[252:255], a[172:175]
s_waitcnt lgkmcnt(4)
M a[68:71], a[176:179], a[224:227], a[68:71]
ds_read_b128 a[248:251], v10 offset:24576
ds_read_b128 a[252:255], v11 offset:24576
v_mov_b32 v160, 0
v_mov_b32 v161, 0
M a[68:71], a[180:183], a[228:231], a[68:71]
buffer_load_dwordx4 v4, s[8:11], s23 offen offset:2048 lds
M a[72:75], a[188:191], a[228:231], a[72:75]
ds_read_b64_tr_b16 a[200:201], v14 offset:28672
ds_read_b64_tr_b16 a[202:203], v14 offset:30208
v_mov_b32 v162, 0
v_mov_b32 v163, 0
M a[72:75], a[184:187], a[224:227], a[72:75]
M a[76:79], a[192:195], a[224:227], a[76:79]
buffer_load_dwordx4 v5, s[8:11], s23 offen offset:3072 lds
v_mov_b32 v164, 0
v_mov_b32 v165, 0
M a[76:79], a[196:199], a[228:231], a[76:79]
s_waitcnt lgkmcnt(6)
M a[80:83], a[180:183], a[236:239], a[80:83]
ds_read_b128 a[224:227], v10 offset:26624
ds_read_b128 a[228:231], v11 offset:26624
v_mov_b32 v166, 0
v_mov_b32 v167, 0
M a[80:83], a[176:179], a[232:235], a[80:83]
M a[84:87], a[184:187], a[232:235], a[84:87]
ds_read_b64_tr_b16 a[208:209], v15 offset:28672
ds_read_b64_tr_b16 a[210:211], v15 offset:30208
M a[84:87], a[188:191], a[236:239], a[84:87]
s_sub_u32 s31, s31, 1
s_cmp_eq_u32 s31, 0
s_cselect_b32 s58, -1920, s57
s_add_u32 s23, s23, s58
s_add_u32 s24, s24, s58
v_mov_b32 v168, 0
v_mov_b32 v169, 0
M a[88:91], a[196:199], a[236:239], a[88:91]
M a[88:91], a[192:195], a[232:235], a[88:91]
s_waitcnt lgkmcnt(8)
v_mov_b32 v170, 0
v_mov_b32 v171, 0
M a[92:95], a[176:179], a[240:243], a[92:95]
ds_read_b128 a[232:235], v10 offset:28672
ds_read_b128 a[236:239], v11 offset:28672
M a[92:95], a[180:183], a[244:247], a[92:95]
s_add_u32 m0, s30, 36864
s_nop 0
buffer_load_dwordx4 v6, s[12:15], s25 offen offset:0 lds
v_mov_b32 v172, 0
v_mov_b32 v173, 0
M a[96:99], a[188:191], a[244:247], a[96:99]
ds_read_b64_tr_b16 a[216:217], v16 offset:28672
ds_read_b64_tr_b16 a[218:219], v16 offset:30208
M a[96:99], a[184:187], a[240:243], a[96:99]
v_mov_b32 v174, 0
v_mov_b32 v175, 0
M a[100:103], a[192:195], a[240:243], a[100:103]
buffer_load_dwordx4 v7, s[12:15], s25 offen offset:1024 lds
M a[100:103], a[196:199], a[244:247], a[100:103]
s_waitcnt lgkmcnt(10)
M a[104:107], a[180:183], a[252:255], a[104:107]
ds_read_b128 a[240:243], v10 offset:30720
ds_read_b128 a[244:247], v11 offset:30720
v_mov_b32 v176, 0
v_mov_b32 v177, 0
M a[104:107], a[176:179], a[248:251], a[104:107]
M a[108:111], a[184:187], a[248:251], a[108:111]
ds_read_b64_tr_b16 a[204:205], v14 offset:40960
ds_read_b64_tr_b16 a[206:207], v14 offset:42496
v_mov_b32 v178, 0
v_mov_b32 v179, 0
M a[108:111], a[188:191], a[252:255], a[108:111]
buffer_load_dwordx4 v8, s[12:15], s25 offen offset:2048 lds
M a[112:115], a[196:199], a[252:255], a[112:115]
v_mov_b32 v180, 0
v_mov_b32 v181, 0
M a[112:115], a[192:195], a[248:251], a[112:115]
s_waitcnt lgkmcnt(10)
M a[116:119], a[176:179], a[224:227], a[116:119]
ds_read_b128 a[248:251], v10 offset:32768
ds_read_b128 a[252:255], v11 offset:32768
v_mov_b32 v182, 0
v_mov_b32 v183, 0
M a[116:119], a[180:183], a[228:231], a[116:119]
buffer_load_dwordx4 v9, s[12:15], s25 offen offset:3072 lds
M a[120:123], a[188:191], a[228:231], a[120:123]
ds_read_b64_tr_b16 a[212:213], v15 offset:40960
ds_read_b64_tr_b16 a[214:215], v15 offset:42496
M a[120:123], a[184:187], a[224:227], a[120:123]
v_mov_b32 v184, 0
v_mov_b32 v185, 0
M a[124:127], a[192:195], a[224:227], a[124:127]
s_add_u32 m0, s30, 40960
s_nop 0
buffer_load_dwordx4 v21, s[12:15], s25 offen offset:0 lds
M a[124:127], a[196:199], a[228:231], a[124:127]
s_waitcnt lgkmcnt(10)
v_mov_b32 v186, 0
v_mov_b32 v187, 0
M a[128:131], a[180:183], a[236:239], a[128:131]
ds_read_b128 a[224:227], v10 offset:34816
ds_read_b128 a[228:231], v11 offset:34816
M a[128:131], a[176:179], a[232:235], a[128:131]
v_mov_b32 v188, 0
v_mov_b32 v189, 0
M a[132:135], a[184:187], a[232:235], a[132:135]
ds_read_b64_tr_b16 a[220:221], v16 offset:40960
ds_read_b64_tr_b16 a[222:223], v16 offset:42496
M a[132:135], a[188:191], a[236:239], a[132:135]
buffer_load_dwordx4 v22, s[12:15], s25 offen offset:1024 lds
v_mov_b32 v190, 0
v_mov_b32 v191, 0
M a[136:139], a[196:199], a[236:239], a[136:139]
M a[136:139], a[192:195], a[232:235], a[136:139]
s_waitcnt lgkmcnt(10)
M a[140:143], a[176:179], a[240:243], a[140:143]
s_sub_u32 s54, s54, 1
s_cmp_eq_u32 s54, 0
s_cselect_b32 s58, s55, s56
s_add_u32 s25, s25, s58
v_mov_b32 v192, 0
v_mov_b32 v193, 0
M a[140:143], a[180:183], a[244:247], a[140:143]
M a[144:147], a[188:191], a[244:247], a[144:147]
v_mov_b32 v194, 0
v_mov_b32 v195, 0
M a[144:147], a[184:187], a[240:243], a[144:147]
M a[148:151], a[192:195], a[240:243], a[148:151]
s_waitcnt vmcnt(12) lgkmcnt(0)
s_barrier
ds_read_b128 a[232:235], v12 offset:0
ds_read_b128 a[236:239], v13 offset:0
v_mov_b32 v196, 0
v_mov_b32 v197, 0
M a[148:151], a[196:199], a[244:247], a[148:151]
s_add_u32 m0, s28, 18432
s_nop 0
buffer_load_dword v20, s[8:11], s24 offen lds
M a[152:155], a[180:183], a[252:255], a[152:155]
ds_read_b128 a[240:243], v12 offset:2048
ds_read_b128 a[244:247], v13 offset:2048
v_mov_b32 v198, 0
v_mov_b32 v199, 0
M a[152:155], a[176:179], a[248:251], a[152:155]
M a[156:159], a[184:187], a[248:251], a[156:159]
buffer_load_dword v23, s[8:11], s24 offen offset:256 lds
M a[156:159], a[188:191], a[252:255], a[156:159]
v_mov_b32 v200, 0
v_mov_b32 v201, 0
M a[160:163], a[196:199], a[252:255], a[160:163]
M a[160:163], a[192:195], a[248:251], a[160:163]
s_add_u32 m0, s29, 20480
s_nop 0
buffer_load_dwordx4 v2, s[8:11], s23 offen offset:0 lds
v_mov_b32 v202, 0
v_mov_b32 v203, 0
M a[164:167], a[176:179], a[224:227], a[164:167]
ds_read_b128 a[248:251], v12 offset:4096
ds_read_b128 a[252:255], v13 offset:4096
M a[164:167], a[180:183], a[228:231], a[164:167]
v_mov_b32 v204, 0
v_mov_b32 v205, 0
M a[168:171], a[188:191], a[228:231], a[168:171]
M a[168:171], a[184:187], a[224:227], a[168:171]
buffer_load_dwordx4 v3, s[8:11], s23 offen offset:1024 lds
v_mov_b32 v206, 0
v_mov_b32 v207, 0
M a[172:175], a[192:195], a[224:227], a[172:175]
M a[172:175], a[196:199], a[228:231], a[172:175]
s_waitcnt lgkmcnt(4)
M a[68:71], a[200:203], a[232:235], a[68:71]
ds_read_b128 a[224:227], v12 offset:6144
ds_read_b128 a[228:231], v13 offset:6144
v_and_b32 v128, 15, v0
v_mul_u32_u24 v128, 400, v128
M a[68:71], a[204:207], a[236:239], a[68:71]
buffer_load_dwordx4 v4, s[8:11], s23 offen offset:2048 lds
M a[72:75], a[212:215], a[236:239], a[72:75]
ds_read_b64_tr_b16 a[176:177], v17 offset:0
ds_read_b64_tr_b16 a[178:179], v17 offset:1536
v_lshrrev_b32 v129, 4, v0
v_lshl_add_u32 v128, v129, 3, v128
M a[72:75], a[208:211], a[232:235], a[72:75]
M a[76:79], a[216:219], a[232:235], a[76:79]
buffer_load_dwordx4 v5, s[8:11], s23 offen offset:3072 lds
s_mul_i32 s3, s20, 96
s_add_u32 s3, s3, 98304
M a[76:79], a[220:223], a[236:239], a[76:79]
s_waitcnt lgkmcnt(6)
M a[80:83], a[204:207], a[244:247], a[80:83]
ds_read_b128 a[232:235], v12 offset:8192
ds_read_b128 a[236:239], v13 offset:8192
v_add_u32 v124, s3, v128
v_and_b32 v128, 15, v0
M a[80:83], a[200:203], a[240:243], a[80:83]
M a[84:87], a[208:211], a[240:243], a[84:87]
ds_read_b64_tr_b16 a[184:185], v18 offset:0
ds_read_b64_tr_b16 a[186:187], v18 offset:1536
v_lshrrev_b32 v129, 4, v0
s_add_u32 s3, s21, 16
M a[84:87], a[212:215], a[244:247], a[84:87]
s_sub_u32 s31, s31, 1
s_cmp_eq_u32 s31, 0
s_cselect_b32 s58, -1920, s57
s_add_u32 s23, s23, s58
s_add_u32 s24, s24, s58
M a[88:91], a[220:223], a[244:247], a[88:91]
v_lshl_add_u32 v130, v128, 1, s3
s_lshl_b32 s4, s22, 6
M a[88:91], a[216:219], a[240:243], a[88:91]
s_waitcnt lgkmcnt(8)
M a[92:95], a[200:203], a[248:251], a[92:95]
ds_read_b128 a[240:243], v12 offset:10240
ds_read_b128 a[244:247], v13 offset:10240
s_add_u32 s4, s4, 98304
v_mul_u32_u24 v120, 400, v130
M a[92:95], a[204:207], a[252:255], a[92:95]
s_add_u32 m0, s30, 65536
s_nop 0
buffer_load_dwordx4 v6, s[12:15], s25 offen offset:0 lds
M a[96:99], a[212:215], a[252:255], a[96:99]
ds_read_b64_tr_b16 a[192:193], v19 offset:0
ds_read_b64_tr_b16 a[194:195], v19 offset:1536
M a[96:99], a[208:211], a[248:251], a[96:99]
v_lshl_add_u32 v120, v129, 4, v120
v_add_u32 v120, s4, v120
M a[100:103], a[216:219], a[248:251], a[100:103]
buffer_load_dwordx4 v7, s[12:15], s25 offen offset:1024 lds
M a[100:103], a[220:223], a[252:255], a[100:103]
s_waitcnt lgkmcnt(10)
v_subrev_u32 v130, 32, v130
v_max_i32 v130, 0, v130
M a[104:107], a[204:207], a[228:231], a[104:107]
ds_read_b128 a[248:251], v12 offset:12288
ds_read_b128 a[252:255], v13 offset:12288
M a[104:107], a[200:203], a[224:227], a[104:107]
v_mul_u32_u24 v121, 400, v130
v_lshl_add_u32 v121, v129, 4, v121
M a[108:111], a[208:211], a[224:227], a[108:111]
ds_read_b64_tr_b16 a[180:181], v17 offset:12288
ds_read_b64_tr_b16 a[182:183], v17 offset:13824
M a[108:111], a[212:215], a[228:231], a[108:111]
buffer_load_dwordx4 v8, s[12:15], s25 offen offset:2048 lds
v_add_u32 v121, s4, v121
v_bfe_u32 v131, v0, 2, 2
M a[112:115], a[220:223], a[228:231], a[112:115]
M a[112:115], a[216:219], a[224:227], a[112:115]
s_waitcnt lgkmcnt(10)
v_lshl_add_u32 v131, v129, 2, v131
v_lshl_add_u32 v131, v131, 1, s3
M a[116:119], a[200:203], a[232:235], a[116:119]
ds_read_b128 a[224:227], v12 offset:14336
ds_read_b128 a[228:231], v13 offset:14336
M a[116:119], a[204:207], a[236:239], a[116:119]
buffer_load_dwordx4 v9, s[12:15], s25 offen offset:3072 lds
v_and_b32 v132, 3, v0
v_lshlrev_b32 v132, 3, v132
M a[120:123], a[212:215], a[236:239], a[120:123]
ds_read_b64_tr_b16 a[188:189], v18 offset:12288
ds_read_b64_tr_b16 a[190:191], v18 offset:13824
M a[120:123], a[208:211], a[232:235], a[120:123]
M a[124:127], a[216:219], a[232:235], a[124:127]
s_add_u32 m0, s30, 69632
s_nop 0
buffer_load_dwordx4 v21, s[12:15], s25 offen offset:0 lds
v_add_u32 v132, s4, v132
s_movk_i32 s5, 400
M a[124:127], a[220:223], a[236:239], a[124:127]
s_waitcnt lgkmcnt(10)
M a[128:131], a[204:207], a[244:247], a[128:131]
ds_read_b128 a[232:235], v12 offset:16384
ds_read_b128 a[236:239], v13 offset:16384
v_mad_u32_u24 v122, v131, s5, v132
v_subrev_u32 v131, 32, v131
M a[128:131], a[200:203], a[240:243], a[128:131]
M a[132:135], a[208:211], a[240:243], a[132:135]
ds_read_b64_tr_b16 a[196:197], v19 offset:12288
ds_read_b64_tr_b16 a[198:199], v19 offset:13824
v_max_i32 v131, 0, v131
v_mad_u32_u24 v123, v131, s5, v132
M a[132:135], a[212:215], a[244:247], a[132:135]
buffer_load_dwordx4 v22, s[12:15], s25 offen offset:1024 lds
M a[136:139], a[220:223], a[244:247], a[136:139]
v_lshlrev_b32 v129, 2, v129
v_sub_u32 v128, v128, v129
M a[136:139], a[216:219], a[240:243], a[136:139]
s_waitcnt lgkmcnt(10)
M a[140:143], a[200:203], a[248:251], a[140:143]
s_sub_u32 s54, s54, 1
s_cmp_eq_u32 s54, 0
s_cselect_b32 s58, s55, s56
s_add_u32 s25, s25, s58
v_mov_b32 v129, 0xf149f2ca
s_cmp_eq_u32 s26, 0
s_cselect_b32 s3, 0xf149f2ca, 0
M a[140:143], a[204:207], a[252:255], a[140:143]
M a[144:147], a[212:215], a[252:255], a[144:147]
v_cmp_lt_i32 vcc, -9, v128
s_nop 1
v_cndmask_b32 v144, 0, v129, vcc
M a[144:147], a[208:211], a[248:251], a[144:147]
M a[148:151], a[216:219], a[248:251], a[148:151]
s_waitcnt vmcnt(12) lgkmcnt(0)
s_barrier
ds_read_b128 a[240:243], v10 offset:0
ds_read_b128 a[244:247], v11 offset:0
M a[148:151], a[220:223], a[252:255], a[148:151]
s_add_u32 m0, s28, 131072
s_nop 0
buffer_load_dword v20, s[8:11], s24 offen lds
v_subrev_u32 v130, 0, v128
v_cmp_lt_u32 vcc, 7, v130
s_nop 1
v_cndmask_b32 v148, 0, v129, vcc
M a[152:155], a[204:207], a[228:231], a[152:155]
ds_read_b128 a[248:251], v10 offset:2048
ds_read_b128 a[252:255], v11 offset:2048
M a[152:155], a[200:203], a[224:227], a[152:155]
v_min_f32 v152, s3, v144
v_mov_b32 v156, 0x3f803f80
M a[156:159], a[208:211], a[224:227], a[156:159]
buffer_load_dword v23, s[8:11], s24 offen offset:256 lds
M a[156:159], a[212:215], a[228:231], a[156:159]
v_cmp_lt_i32 vcc, -8, v128
s_nop 1
v_cndmask_b32 v145, 0, v129, vcc
M a[160:163], a[220:223], a[228:231], a[160:163]
M a[160:163], a[216:219], a[224:227], a[160:163]
s_add_u32 m0, s29, 133120
s_nop 0
buffer_load_dwordx4 v2, s[8:11], s23 offen offset:0 lds
v_subrev_u32 v130, 1, v128
v_cmp_lt_u32 vcc, 7, v130
s_nop 1
v_cndmask_b32 v149, 0, v129, vcc
M a[164:167], a[200:203], a[232:235], a[164:167]
ds_read_b128 a[224:227], v10 offset:4096
ds_read_b128 a[228:231], v11 offset:4096
M a[164:167], a[204:207], a[236:239], a[164:167]
v_min_f32 v153, s3, v145
v_mov_b32 v157, 0x3f803f80
M a[168:171], a[212:215], a[236:239], a[168:171]
M a[168:171], a[208:211], a[232:235], a[168:171]
buffer_load_dwordx4 v3, s[8:11], s23 offen offset:1024 lds
v_cmp_lt_i32 vcc, -7, v128
s_nop 1
v_cndmask_b32 v146, 0, v129, vcc
M a[172:175], a[216:219], a[232:235], a[172:175]
M a[172:175], a[220:223], a[236:239], a[172:175]
s_waitcnt lgkmcnt(4)
M a[68:71], a[176:179], a[240:243], a[68:71]
ds_read_b128 a[232:235], v10 offset:6144
ds_read_b128 a[236:239], v11 offset:6144
v_subrev_u32 v130, 2, v128
v_cmp_lt_u32 vcc, 7, v130
s_nop 1
v_cndmask_b32 v150, 0, v129, vcc
M a[68:71], a[180:183], a[244:247], a[68:71]
buffer_load_dwordx4 v4, s[8:11], s23 offen offset:2048 lds
v_min_f32 v154, s3, v146
v_mov_b32 v158, 0x3f803f80
M a[72:75], a[188:191], a[244:247], a[72:75]
ds_read_b64_tr_b16 a[200:201], v14 offset:0
ds_read_b64_tr_b16 a[202:203], v14 offset:1536
M a[72:75], a[184:187], a[240:243], a[72:75]
v_cmp_lt_i32 vcc, -6, v128
s_nop 1
v_cndmask_b32 v147, 0, v129, vcc
M a[76:79], a[192:195], a[240:243], a[76:79]
buffer_load_dwordx4 v5, s[8:11], s23 offen offset:3072 lds
v_subrev_u32 v130, 3, v128
v_cmp_lt_u32 vcc, 7, v130
s_nop 1
v_cndmask_b32 v151, 0, v129, vcc
M a[76:79], a[196:199], a[244:247], a[76:79]
s_waitcnt lgkmcnt(6)
M a[80:83], a[180:183], a[252:255], a[80:83]
ds_read_b128 a[240:243], v10 offset:8192
ds_read_b128 a[244:247], v11 offset:8192
v_min_f32 v155, s3, v147
v_mov_b32 v159, 0x3f803f80
M a[80:83], a[176:179], a[248:251], a[80:83]
s_add_u32 s16, s50, 83886080
s_addc_u32 s17, s51, 0
M a[84:87], a[184:187], a[248:251], a[84:87]
ds_read_b64_tr_b16 a[208:209], v15 offset:0
ds_read_b64_tr_b16 a[210:211], v15 offset:1536
M a[84:87], a[188:191], a[252:255], a[84:87]
s_sub_u32 s31, s31, 1
s_cmp_eq_u32 s31, 0
s_cselect_b32 s58, -1920, s57
s_add_u32 s23, s23, s58
s_add_u32 s24, s24, s58
s_mov_b32 s18, 4194304
s_mov_b32 s19, 0x00020000
M a[88:91], a[196:199], a[252:255], a[88:91]
s_lshl_b32 s3, s26, 18
s_lshl_b32 s4, s27, 14
M a[88:91], a[192:195], a[248:251], a[88:91]
s_waitcnt lgkmcnt(8)
M a[92:95], a[176:179], a[224:227], a[92:95]
ds_read_b128 a[248:251], v10 offset:10240
ds_read_b128 a[252:255], v11 offset:10240
s_add_u32 s3, s3, s4
s_lshl_b32 s4, s21, 13
M a[92:95], a[180:183], a[228:231], a[92:95]
s_add_u32 m0, s30, 98304
s_nop 0
buffer_load_dwordx4 v6, s[12:15], s25 offen offset:0 lds
s_add_u32 s3, s3, s4
s_lshl_b32 s4, s22, 10
M a[96:99], a[188:191], a[228:231], a[96:99]
ds_read_b64_tr_b16 a[216:217], v16 offset:0
ds_read_b64_tr_b16 a[218:219], v16 offset:1536
M a[96:99], a[184:187], a[224:227], a[96:99]
s_add_u32 s6, s3, s4
s_mov_b32 s7, 0x3e8293ee
M a[100:103], a[192:195], a[224:227], a[100:103]
buffer_load_dwordx4 v7, s[12:15], s25 offen offset:1024 lds
s_lshl_b32 s65, s26, 8
s_lshl_b32 s3, s27, 4
M a[100:103], a[196:199], a[228:231], a[100:103]
s_waitcnt lgkmcnt(10)
M a[104:107], a[180:183], a[236:239], a[104:107]
ds_read_b128 a[224:227], v10 offset:12288
ds_read_b128 a[228:231], v11 offset:12288
s_add_u32 s65, s65, s3
s_lshl_b32 s3, s101, 2
M a[104:107], a[176:179], a[232:235], a[104:107]
s_add_u32 s65, s65, s3
s_add_u32 s65, s65, 8400896
M a[108:111], a[184:187], a[232:235], a[108:111]
ds_read_b64_tr_b16 a[204:205], v14 offset:12288
ds_read_b64_tr_b16 a[206:207], v14 offset:13824
M a[108:111], a[188:191], a[236:239], a[108:111]
buffer_load_dwordx4 v8, s[12:15], s25 offen offset:2048 lds
s_mov_b32 s40, 0
v_mov_b32 v119, 0
M a[112:115], a[196:199], a[236:239], a[112:115]
s_mov_b64 s[4:5], s[50:51]
s_and_b32 s20, s2, 7
M a[112:115], a[192:195], a[232:235], a[112:115]
s_waitcnt lgkmcnt(10)
M a[116:119], a[176:179], a[240:243], a[116:119]
ds_read_b128 a[232:235], v10 offset:14336
ds_read_b128 a[236:239], v11 offset:14336
s_lshr_b32 s33, s2, 6
s_lshl_b32 s33, s33, 3
M a[116:119], a[180:183], a[244:247], a[116:119]
buffer_load_dwordx4 v9, s[12:15], s25 offen offset:3072 lds
s_add_u32 s20, s20, s33
s_bfe_u32 s21, s2, 0x30003
M a[120:123], a[188:191], a[244:247], a[120:123]
ds_read_b64_tr_b16 a[212:213], v15 offset:12288
ds_read_b64_tr_b16 a[214:215], v15 offset:13824
M a[120:123], a[184:187], a[240:243], a[120:123]
s_sub_u32 s35, 15, s21
s_cmp_lt_u32 s101, 2
s_cselect_b32 s35, s21, s35
M a[124:127], a[192:195], a[240:243], a[124:127]
s_add_u32 m0, s30, 102400
s_nop 0
buffer_load_dwordx4 v21, s[12:15], s25 offen offset:0 lds
s_lshl_b32 s33, s20, 7
s_lshl_b32 s34, s35, 3
M a[124:127], a[196:199], a[244:247], a[124:127]
s_waitcnt lgkmcnt(10)
M a[128:131], a[180:183], a[252:255], a[128:131]
ds_read_b128 a[240:243], v10 offset:16384
ds_read_b128 a[244:247], v11 offset:16384
s_add_u32 s33, s33, s34
s_and_b32 s34, s101, 1
M a[128:131], a[176:179], a[248:251], a[128:131]
s_lshl_b32 s34, s34, 2
s_add_u32 s33, s33, s34
M a[132:135], a[184:187], a[248:251], a[132:135]
ds_read_b64_tr_b16 a[220:221], v16 offset:12288
ds_read_b64_tr_b16 a[222:223], v16 offset:13824
M a[132:135], a[188:191], a[252:255], a[132:135]
buffer_load_dwordx4 v22, s[12:15], s25 offen offset:1024 lds
s_lshl_b32 s64, s33, 12
s_mov_b32 s44, s4
M a[136:139], a[196:199], a[252:255], a[136:139]
s_mov_b32 s45, s5
s_mov_b32 s46, 16777216
M a[136:139], a[192:195], a[248:251], a[136:139]
s_waitcnt lgkmcnt(10)
M a[140:143], a[176:179], a[224:227], a[140:143]
s_sub_u32 s54, s54, 1
s_cmp_eq_u32 s54, 0
s_cselect_b32 s58, s55, s56
s_add_u32 s25, s25, s58
s_mov_b32 s47, 0x00020000
M a[140:143], a[180:183], a[228:231], a[140:143]
M a[144:147], a[188:191], a[228:231], a[144:147]
M a[144:147], a[184:187], a[224:227], a[144:147]
M a[148:151], a[192:195], a[224:227], a[148:151]
s_waitcnt vmcnt(12) lgkmcnt(0)
s_barrier
ds_read_b128 a[248:251], v10 offset:18432
ds_read_b128 a[252:255], v11 offset:18432
M a[148:151], a[196:199], a[228:231], a[148:151]
s_add_u32 m0, s28, 0
s_nop 0
buffer_load_dword v20, s[8:11], s24 offen lds
M a[152:155], a[180:183], a[236:239], a[152:155]
ds_read_b128 a[224:227], v10 offset:20480
ds_read_b128 a[228:231], v11 offset:20480
M a[152:155], a[176:179], a[232:235], a[152:155]
M a[156:159], a[184:187], a[232:235], a[156:159]
buffer_load_dword v23, s[8:11], s24 offen offset:256 lds
M a[156:159], a[188:191], a[236:239], a[156:159]
M a[160:163], a[196:199], a[236:239], a[160:163]
M a[160:163], a[192:195], a[232:235], a[160:163]
s_add_u32 m0, s29, 2048
s_nop 0
buffer_load_dwordx4 v2, s[8:11], s23 offen offset:0 lds
M a[164:167], a[176:179], a[240:243], a[164:167]
ds_read_b128 a[232:235], v10 offset:22528
ds_read_b128 a[236:239], v11 offset:22528
M a[164:167], a[180:183], a[244:247], a[164:167]
M a[168:171], a[188:191], a[244:247], a[168:171]
M a[168:171], a[184:187], a[240:243], a[168:171]
buffer_load_dwordx4 v3, s[8:11], s23 offen offset:1024 lds
M a[172:175], a[192:195], a[240:243], a[172:175]
M a[172:175], a[196:199], a[244:247], a[172:175]
s_waitcnt lgkmcnt(4)
M a[68:71], a[200:203], a[248:251], a[68:71]
ds_read_b128 a[240:243], v10 offset:24576
ds_read_b128 a[244:247], v11 offset:24576
M a[68:71], a[204:207], a[252:255], a[68:71]
buffer_load_dwordx4 v4, s[8:11], s23 offen offset:2048 lds
M a[72:75], a[212:215], a[252:255], a[72:75]
ds_read_b64_tr_b16 a[176:177], v14 offset:28672
ds_read_b64_tr_b16 a[178:179], v14 offset:30208
M a[72:75], a[208:211], a[248:251], a[72:75]
M a[76:79], a[216:219], a[248:251], a[76:79]
buffer_load_dwordx4 v5, s[8:11], s23 offen offset:3072 lds
M a[76:79], a[220:223], a[252:255], a[76:79]
s_waitcnt lgkmcnt(6)
M a[80:83], a[204:207], a[228:231], a[80:83]
ds_read_b128 a[248:251], v10 offset:26624
ds_read_b128 a[252:255], v11 offset:26624
M a[80:83], a[200:203], a[224:227], a[80:83]
M a[84:87], a[208:211], a[224:227], a[84:87]
ds_read_b64_tr_b16 a[184:185], v15 offset:28672
ds_read_b64_tr_b16 a[186:187], v15 offset:30208
M a[84:87], a[212:215], a[228:231], a[84:87]
s_sub_u32 s31, s31, 1
s_cmp_eq_u32 s31, 0
s_cselect_b32 s58, -1920, s57
s_add_u32 s23, s23, s58
s_add_u32 s24, s24, s58
M a[88:91], a[220:223], a[228:231], a[88:91]
M a[88:91], a[216:219], a[224:227], a[88:91]
s_waitcnt lgkmcnt(8)
M a[92:95], a[200:203], a[232:235], a[92:95]
ds_read_b128 a[224:227], v10 offset:28672
ds_read_b128 a[228:231], v11 offset:28672
M a[92:95], a[204:207], a[236:239], a[92:95]
s_add_u32 m0, s30, 36864
s_nop 0
buffer_load_dwordx4 v6, s[12:15], s25 offen offset:0 lds
M a[96:99], a[212:215], a[236:239], a[96:99]
ds_read_b64_tr_b16 a[192:193], v16 offset:28672
ds_read_b64_tr_b16 a[194:195], v16 offset:30208
M a[96:99], a[208:211], a[232:235], a[96:99]
M a[100:103], a[216:219], a[232:235], a[100:103]
buffer_load_dwordx4 v7, s[12:15], s25 offen offset:1024 lds
M a[100:103], a[220:223], a[236:239], a[100:103]
s_waitcnt lgkmcnt(10)
M a[104:107], a[204:207], a[244:247], a[104:107]
ds_read_b128 a[232:235], v10 offset:30720
ds_read_b128 a[236:239], v11 offset:30720
M a[104:107], a[200:203], a[240:243], a[104:107]
M a[108:111], a[208:211], a[240:243], a[108:111]
ds_read_b64_tr_b16 a[180:181], v14 offset:40960
ds_read_b64_tr_b16 a[182:183], v14 offset:42496
M a[108:111], a[212:215], a[244:247], a[108:111]
buffer_load_dwordx4 v8, s[12:15], s25 offen offset:2048 lds
M a[112:115], a[220:223], a[244:247], a[112:115]
M a[112:115], a[216:219], a[240:243], a[112:115]
s_waitcnt lgkmcnt(10)
M a[116:119], a[200:203], a[248:251], a[116:119]
ds_read_b128 a[240:243], v10 offset:32768
ds_read_b128 a[244:247], v11 offset:32768
M a[116:119], a[204:207], a[252:255], a[116:119]
buffer_load_dwordx4 v9, s[12:15], s25 offen offset:3072 lds
M a[120:123], a[212:215], a[252:255], a[120:123]
ds_read_b64_tr_b16 a[188:189], v15 offset:40960
ds_read_b64_tr_b16 a[190:191], v15 offset:42496
M a[120:123], a[208:211], a[248:251], a[120:123]
M a[124:127], a[216:219], a[248:251], a[124:127]
s_add_u32 m0, s30, 40960
s_nop 0
buffer_load_dwordx4 v21, s[12:15], s25 offen offset:0 lds
M a[124:127], a[220:223], a[252:255], a[124:127]
s_waitcnt lgkmcnt(10)
M a[128:131], a[204:207], a[228:231], a[128:131]
ds_read_b128 a[248:251], v10 offset:34816
ds_read_b128 a[252:255], v11 offset:34816
M a[128:131], a[200:203], a[224:227], a[128:131]
M a[132:135], a[208:211], a[224:227], a[132:135]
ds_read_b64_tr_b16 a[196:197], v16 offset:40960
ds_read_b64_tr_b16 a[198:199], v16 offset:42496
M a[132:135], a[212:215], a[228:231], a[132:135]
buffer_load_dwordx4 v22, s[12:15], s25 offen offset:1024 lds
M a[136:139], a[220:223], a[228:231], a[136:139]
M a[136:139], a[216:219], a[224:227], a[136:139]
s_waitcnt lgkmcnt(10)
M a[140:143], a[200:203], a[232:235], a[140:143]
s_sub_u32 s54, s54, 1
s_cmp_eq_u32 s54, 0
s_cselect_b32 s58, s55, s56
s_add_u32 s25, s25, s58
M a[140:143], a[204:207], a[236:239], a[140:143]
M a[144:147], a[212:215], a[236:239], a[144:147]
M a[144:147], a[208:211], a[232:235], a[144:147]
M a[148:151], a[216:219], a[232:235], a[148:151]
s_waitcnt vmcnt(12) lgkmcnt(0)
s_barrier
ds_read_b128 a[224:227], v12 offset:0
ds_read_b128 a[228:231], v13 offset:0
M a[148:151], a[220:223], a[236:239], a[148:151]
s_add_u32 m0, s28, 18432
s_nop 0
buffer_load_dword v20, s[8:11], s24 offen lds
M a[152:155], a[204:207], a[244:247], a[152:155]
ds_read_b128 a[232:235], v12 offset:2048
ds_read_b128 a[236:239], v13 offset:2048
M a[152:155], a[200:203], a[240:243], a[152:155]
M a[156:159], a[208:211], a[240:243], a[156:159]
buffer_load_dword v23, s[8:11], s24 offen offset:256 lds
M a[156:159], a[212:215], a[244:247], a[156:159]
M a[160:163], a[220:223], a[244:247], a[160:163]
M a[160:163], a[216:219], a[240:243], a[160:163]
s_add_u32 m0, s29, 20480
s_nop 0
buffer_load_dwordx4 v2, s[8:11], s23 offen offset:0 lds
M a[164:167], a[200:203], a[248:251], a[164:167]
ds_read_b128 a[240:243], v12 offset:4096
ds_read_b128 a[244:247], v13 offset:4096
M a[164:167], a[204:207], a[252:255], a[164:167]
M a[168:171], a[212:215], a[252:255], a[168:171]
M a[168:171], a[208:211], a[248:251], a[168:171]
buffer_load_dwordx4 v3, s[8:11], s23 offen offset:1024 lds
M a[172:175], a[216:219], a[248:251], a[172:175]
M a[172:175], a[220:223], a[252:255], a[172:175]
s_waitcnt lgkmcnt(4)
M a[68:71], a[176:179], a[224:227], a[68:71]
ds_read_b128 a[248:251], v12 offset:6144
ds_read_b128 a[252:255], v13 offset:6144
M a[68:71], a[180:183], a[228:231], a[68:71]
buffer_load_dwordx4 v4, s[8:11], s23 offen offset:2048 lds
M a[72:75], a[188:191], a[228:231], a[72:75]
ds_read_b64_tr_b16 a[200:201], v17 offset:0
ds_read_b64_tr_b16 a[202:203], v17 offset:1536
M a[72:75], a[184:187], a[224:227], a[72:75]
M a[76:79], a[192:195], a[224:227], a[76:79]
buffer_load_dwordx4 v5, s[8:11], s23 offen offset:3072 lds
M a[76:79], a[196:199], a[228:231], a[76:79]
s_waitcnt lgkmcnt(6)
M a[80:83], a[180:183], a[236:239], a[80:83]
ds_read_b128 a[224:227], v12 offset:8192
ds_read_b128 a[228:231], v13 offset:8192
M a[80:83], a[176:179], a[232:235], a[80:83]
s_sub_u32 s31, s31, 1
s_cmp_eq_u32 s31, 0
s_cselect_b32 s58, -1920, s57
s_add_u32 s23, s23, s58
s_add_u32 s24, s24, s58
M a[84:87], a[184:187], a[232:235], a[84:87]
ds_read_b64_tr_b16 a[208:209], v18 offset:0
ds_read_b64_tr_b16 a[210:211], v18 offset:1536
M a[84:87], a[188:191], a[236:239], a[84:87]
M a[88:91], a[196:199], a[236:239], a[88:91]
M a[88:91], a[192:195], a[232:235], a[88:91]
s_add_u32 m0, s30, 65536
s_nop 0
buffer_load_dwordx4 v6, s[12:15], s25 offen offset:0 lds
s_waitcnt lgkmcnt(8)
M a[92:95], a[176:179], a[240:243], a[92:95]
ds_read_b128 a[232:235], v12 offset:10240
ds_read_b128 a[236:239], v13 offset:10240
M a[92:95], a[180:183], a[244:247], a[92:95]
M a[96:99], a[188:191], a[244:247], a[96:99]
ds_read_b64_tr_b16 a[216:217], v19 offset:0
ds_read_b64_tr_b16 a[218:219], v19 offset:1536
M a[96:99], a[184:187], a[240:243], a[96:99]
buffer_load_dwordx4 v7, s[12:15], s25 offen offset:1024 lds
M a[100:103], a[192:195], a[240:243], a[100:103]
M a[100:103], a[196:199], a[244:247], a[100:103]
s_waitcnt lgkmcnt(10)
M a[104:107], a[180:183], a[252:255], a[104:107]
ds_read_b128 a[240:243], v12 offset:12288
ds_read_b128 a[244:247], v13 offset:12288
M a[104:107], a[176:179], a[248:251], a[104:107]
buffer_load_dwordx4 v8, s[12:15], s25 offen offset:2048 lds
M a[108:111], a[184:187], a[248:251], a[108:111]
ds_read_b64_tr_b16 a[204:205], v17 offset:12288
ds_read_b64_tr_b16 a[206:207], v17 offset:13824
M a[108:111], a[188:191], a[252:255], a[108:111]
M a[112:115], a[196:199], a[252:255], a[112:115]
buffer_load_dwordx4 v9, s[12:15], s25 offen offset:3072 lds
M a[112:115], a[192:195], a[248:251], a[112:115]
s_waitcnt lgkmcnt(10)
M a[116:119], a[176:179], a[224:227], a[116:119]
ds_read_b128 a[248:251], v12 offset:14336
ds_read_b128 a[252:255], v13 offset:14336
M a[116:119], a[180:183], a[228:231], a[116:119]
M a[120:123], a[188:191], a[228:231], a[120:123]
ds_read_b64_tr_b16 a[212:213], v18 offset:12288
ds_read_b64_tr_b16 a[214:215], v18 offset:13824
M a[120:123], a[184:187], a[224:227], a[120:123]
s_add_u32 m0, s30, 69632
s_nop 0
buffer_load_dwordx4 v21, s[12:15], s25 offen offset:0 lds
M a[124:127], a[192:195], a[224:227], a[124:127]
M a[124:127], a[196:199], a[228:231], a[124:127]
buffer_load_dwordx4 v22, s[12:15], s25 offen offset:1024 lds
s_waitcnt lgkmcnt(10)
M a[128:131], a[180:183], a[236:239], a[128:131]
ds_read_b128 a[224:227], v12 offset:16384
ds_read_b128 a[228:231], v13 offset:16384
M a[128:131], a[176:179], a[232:235], a[128:131]
M a[132:135], a[184:187], a[232:235], a[132:135]
ds_read_b64_tr_b16 a[220:221], v19 offset:12288
ds_read_b64_tr_b16 a[222:223], v19 offset:13824
M a[132:135], a[188:191], a[236:239], a[132:135]
M a[136:139], a[196:199], a[236:239], a[136:139]
s_sub_u32 s54, s54, 1
s_cmp_eq_u32 s54, 0
s_cselect_b32 s58, s55, s56
s_add_u32 s25, s25, s58
M a[136:139], a[192:195], a[232:235], a[136:139]
s_waitcnt lgkmcnt(10)
M a[140:143], a[176:179], a[240:243], a[140:143]
buffer_load_dword v125, v119, s[36:39], 0 offen sc1
M a[140:143], a[180:183], a[244:247], a[140:143]
M a[144:147], a[188:191], a[244:247], a[144:147]
M a[144:147], a[184:187], a[240:243], a[144:147]
M a[148:151], a[192:195], a[240:243], a[148:151]
s_waitcnt vmcnt(13) lgkmcnt(0)
s_barrier
ds_read_b128 a[232:235], v10 offset:0
ds_read_b128 a[236:239], v11 offset:0
s_waitcnt vmcnt(0)
v_cmp_gt_u32 vcc, 0x80, v125
s_nop 0
s_cbranch_vccnz Lk1_spinq
Lk1_gotq:
M a[148:151], a[196:199], a[244:247], a[148:151]
s_add_u32 m0, s28, 131072
s_nop 0
buffer_load_dword v20, s[8:11], s24 offen lds
M a[152:155], a[180:183], a[252:255], a[152:155]
ds_read_b128 a[240:243], v10 offset:2048
ds_read_b128 a[244:247], v11 offset:2048
M a[152:155], a[176:179], a[248:251], a[152:155]
M a[156:159], a[184:187], a[248:251], a[156:159]
buffer_load_dword v23, s[8:11], s24 offen offset:256 lds
M a[156:159], a[188:191], a[252:255], a[156:159]
M a[160:163], a[196:199], a[252:255], a[160:163]
M a[160:163], a[192:195], a[248:251], a[160:163]
s_add_u32 m0, s29, 133120
s_nop 0
buffer_load_dwordx4 v2, s[8:11], s23 offen offset:0 lds
M a[164:167], a[176:179], a[224:227], a[164:167]
ds_read_b128 a[248:251], v10 offset:4096
ds_read_b128 a[252:255], v11 offset:4096
M a[164:167], a[180:183], a[228:231], a[164:167]
M a[168:171], a[188:191], a[228:231], a[168:171]
M a[168:171], a[184:187], a[224:227], a[168:171]
buffer_load_dwordx4 v3, s[8:11], s23 offen offset:1024 lds
M a[172:175], a[192:195], a[224:227], a[172:175]
M a[172:175], a[196:199], a[228:231], a[172:175]
s_waitcnt lgkmcnt(4)
M a[68:71], a[200:203], a[232:235], a[68:71]
ds_read_b128 a[224:227], v10 offset:6144
ds_read_b128 a[228:231], v11 offset:6144
v_mov_b32 v208, 0
v_mov_b32 v209, 0
M a[68:71], a[204:207], a[236:239], a[68:71]
buffer_load_dwordx4 v4, s[8:11], s23 offen offset:2048 lds
M a[72:75], a[212:215], a[236:239], a[72:75]
ds_read_b64_tr_b16 a[176:177], v14 offset:0
ds_read_b64_tr_b16 a[178:179], v14 offset:1536
v_mov_b32 v210, 0
v_mov_b32 v211, 0
M a[72:75], a[208:211], a[232:235], a[72:75]
M a[76:79], a[216:219], a[232:235], a[76:79]
buffer_load_dwordx4 v5, s[8:11], s23 offen offset:3072 lds
v_mov_b32 v212, 0
v_mov_b32 v213, 0
M a[76:79], a[220:223], a[236:239], a[76:79]
s_waitcnt lgkmcnt(6)
M a[80:83], a[204:207], a[244:247], a[80:83]
ds_read_b128 a[232:235], v10 offset:8192
ds_read_b128 a[236:239], v11 offset:8192
v_mov_b32 v214, 0
v_mov_b32 v215, 0
M a[80:83], a[200:203], a[240:243], a[80:83]
s_sub_u32 s31, s31, 1
s_cmp_eq_u32 s31, 0
s_cselect_b32 s58, -1920, s57
s_add_u32 s23, s23, s58
s_add_u32 s24, s24, s58
M a[84:87], a[208:211], a[240:243], a[84:87]
ds_read_b64_tr_b16 a[184:185], v15 offset:0
ds_read_b64_tr_b16 a[186:187], v15 offset:1536
M a[84:87], a[212:215], a[244:247], a[84:87]
v_mov_b32 v216, 0
v_mov_b32 v217, 0
M a[88:91], a[220:223], a[244:247], a[88:91]
M a[88:91], a[216:219], a[240:243], a[88:91]
buffer_load_dwordx4 a[0:3], v1, s[44:47], s64 offen offset:0 sc1
s_waitcnt lgkmcnt(8)
v_mov_b32 v218, 0
v_mov_b32 v219, 0
M a[92:95], a[200:203], a[248:251], a[92:95]
ds_read_b128 a[240:243], v10 offset:10240
ds_read_b128 a[244:247], v11 offset:10240
M a[92:95], a[204:207], a[252:255], a[92:95]
v_mov_b32 v220, 0
v_mov_b32 v221, 0
M a[96:99], a[212:215], a[252:255], a[96:99]
ds_read_b64_tr_b16 a[192:193], v16 offset:0
ds_read_b64_tr_b16 a[194:195], v16 offset:1536
M a[96:99], a[208:211], a[248:251], a[96:99]
buffer_load_dwordx4 a[4:7], v1, s[44:47], s64 offen offset:1024 sc1
v_mov_b32 v222, 0
v_mov_b32 v223, 0
M a[100:103], a[216:219], a[248:251], a[100:103]
M a[100:103], a[220:223], a[252:255], a[100:103]
s_waitcnt lgkmcnt(10)
M a[104:107], a[204:207], a[228:231], a[104:107]
ds_read_b128 a[248:251], v10 offset:12288
ds_read_b128 a[252:255], v11 offset:12288
v_mov_b32 v224, 0
v_mov_b32 v225, 0
M a[104:107], a[200:203], a[224:227], a[104:107]
buffer_load_dwordx4 a[8:11], v1, s[44:47], s64 offen offset:2048 sc1
M a[108:111], a[208:211], a[224:227], a[108:111]
ds_read_b64_tr_b16 a[180:181], v14 offset:12288
ds_read_b64_tr_b16 a[182:183], v14 offset:13824
v_mov_b32 v226, 0
v_mov_b32 v227, 0
M a[108:111], a[212:215], a[228:231], a[108:111]
M a[112:115], a[220:223], a[228:231], a[112:115]
buffer_load_dwordx4 a[12:15], v1, s[44:47], s64 offen offset:3072 sc1
s_add_u32 s64, s64, 4096
v_mov_b32 v228, 0
v_mov_b32 v229, 0
M a[112:115], a[216:219], a[224:227], a[112:115]
s_waitcnt lgkmcnt(10)
M a[116:119], a[200:203], a[232:235], a[116:119]
ds_read_b128 a[224:227], v10 offset:14336
ds_read_b128 a[228:231], v11 offset:14336
v_mov_b32 v230, 0
v_mov_b32 v231, 0
M a[116:119], a[204:207], a[236:239], a[116:119]
M a[120:123], a[212:215], a[236:239], a[120:123]
ds_read_b64_tr_b16 a[188:189], v15 offset:12288
ds_read_b64_tr_b16 a[190:191], v15 offset:13824
M a[120:123], a[208:211], a[232:235], a[120:123]
buffer_load_dwordx4 a[16:19], v1, s[44:47], s64 offen offset:0 sc1
v_mov_b32 v232, 0
v_mov_b32 v233, 0
M a[124:127], a[216:219], a[232:235], a[124:127]
M a[124:127], a[220:223], a[236:239], a[124:127]
buffer_load_dwordx4 a[20:23], v1, s[44:47], s64 offen offset:1024 sc1
s_waitcnt lgkmcnt(10)
v_mov_b32 v234, 0
v_mov_b32 v235, 0
M a[128:131], a[204:207], a[244:247], a[128:131]
ds_read_b128 a[232:235], v10 offset:16384
ds_read_b128 a[236:239], v11 offset:16384
M a[128:131], a[200:203], a[240:243], a[128:131]
v_mov_b32 v236, 0
v_mov_b32 v237, 0
M a[132:135], a[208:211], a[240:243], a[132:135]
ds_read_b64_tr_b16 a[196:197], v16 offset:12288
ds_read_b64_tr_b16 a[198:199], v16 offset:13824
M a[132:135], a[212:215], a[244:247], a[132:135]
v_mov_b32 v238, 0
v_mov_b32 v239, 0
M a[136:139], a[220:223], a[244:247], a[136:139]
buffer_load_dwordx4 a[24:27], v1, s[44:47], s64 offen offset:2048 sc1
M a[136:139], a[216:219], a[240:243], a[136:139]
s_waitcnt lgkmcnt(10)
M a[140:143], a[200:203], a[248:251], a[140:143]
buffer_load_dwordx4 a[28:31], v1, s[44:47], s64 offen offset:3072 sc1
s_add_u32 s64, s64, 4096
v_mov_b32 v240, 0
v_mov_b32 v241, 0
M a[140:143], a[204:207], a[252:255], a[140:143]
M a[144:147], a[212:215], a[252:255], a[144:147]
v_mov_b32 v242, 0
v_mov_b32 v243, 0
M a[144:147], a[208:211], a[248:251], a[144:147]
M a[148:151], a[216:219], a[248:251], a[148:151]
s_waitcnt vmcnt(15) lgkmcnt(0)
s_barrier
ds_read_b128 a[240:243], v10 offset:18432
ds_read_b128 a[244:247], v11 offset:18432
v_mov_b32 v244, 0
v_mov_b32 v245, 0
M a[148:151], a[220:223], a[252:255], a[148:151]
buffer_load_dwordx4 a[32:35], v1, s[44:47], s64 offen offset:0 sc1
M a[152:155], a[204:207], a[228:231], a[152:155]
ds_read_b128 a[248:251], v10 offset:20480
ds_read_b128 a[252:255], v11 offset:20480
v_mov_b32 v246, 0
v_mov_b32 v247, 0
M a[152:155], a[200:203], a[224:227], a[152:155]
M a[156:159], a[208:211], a[224:227], a[156:159]
buffer_load_dwordx4 a[36:39], v1, s[44:47], s64 offen offset:1024 sc1
M a[156:159], a[212:215], a[228:231], a[156:159]
v_mov_b32 v248, 0
v_mov_b32 v249, 0
M a[160:163], a[220:223], a[228:231], a[160:163]
M a[160:163], a[216:219], a[224:227], a[160:163]
buffer_load_dwordx4 a[40:43], v1, s[44:47], s64 offen offset:2048 sc1
v_mov_b32 v250, 0
v_mov_b32 v251, 0
M a[164:167], a[200:203], a[232:235], a[164:167]
ds_read_b128 a[224:227], v10 offset:22528
ds_read_b128 a[228:231], v11 offset:22528
M a[164:167], a[204:207], a[236:239], a[164:167]
v_mov_b32 v252, 0
v_mov_b32 v253, 0
M a[168:171], a[212:215], a[236:239], a[168:171]
M a[168:171], a[208:211], a[232:235], a[168:171]
buffer_load_dwordx4 a[44:47], v1, s[44:47], s64 offen offset:3072 sc1
s_add_u32 s64, s64, 4096
v_mov_b32 v254, 0
v_mov_b32 v255, 0
M a[172:175], a[216:219], a[232:235], a[172:175]
M a[172:175], a[220:223], a[236:239], a[172:175]
s_waitcnt lgkmcnt(4)
M a[68:71], a[176:179], a[240:243], a[68:71]
ds_read_b128 a[232:235], v10 offset:24576
ds_read_b128 a[236:239], v11 offset:24576
s_mov_b32 s22, s101
s_and_b32 s23, s22, 1
M a[68:71], a[180:183], a[244:247], a[68:71]
buffer_load_dwordx4 a[48:51], v1, s[44:47], s64 offen offset:0 sc1
M a[72:75], a[188:191], a[244:247], a[72:75]
ds_read_b64_tr_b16 a[200:201], v14 offset:28672
ds_read_b64_tr_b16 a[202:203], v14 offset:30208
s_lshr_b32 s24, s22, 1
s_lshl_b32 s33, s24, 14
M a[72:75], a[184:187], a[240:243], a[72:75]
M a[76:79], a[192:195], a[240:243], a[76:79]
M a[76:79], a[196:199], a[244:247], a[76:79]
s_waitcnt lgkmcnt(6)
s_lshl_b32 s34, s23, 13
s_add_u32 s29, s33, s34
M a[80:83], a[180:183], a[252:255], a[80:83]
ds_read_b128 a[240:243], v10 offset:26624
ds_read_b128 a[244:247], v11 offset:26624
M a[80:83], a[176:179], a[248:251], a[80:83]
s_lshl_b32 s28, s20, 20
s_add_u32 s28, s28, s34
M a[84:87], a[184:187], a[248:251], a[84:87]
ds_read_b64_tr_b16 a[208:209], v15 offset:28672
ds_read_b64_tr_b16 a[210:211], v15 offset:30208
M a[84:87], a[188:191], a[252:255], a[84:87]
buffer_load_dwordx4 a[52:55], v1, s[44:47], s64 offen offset:1024 sc1
M a[88:91], a[196:199], a[252:255], a[88:91]
s_mov_b32 s25, s28
s_lshl_b32 s33, s21, 16
M a[88:91], a[192:195], a[248:251], a[88:91]
s_waitcnt lgkmcnt(8)
M a[92:95], a[176:179], a[224:227], a[92:95]
ds_read_b128 a[248:251], v10 offset:28672
ds_read_b128 a[252:255], v11 offset:28672
s_add_u32 s34, s28, s33
s_add_u32 s34, s34, 65536
M a[92:95], a[180:183], a[228:231], a[92:95]
M a[96:99], a[188:191], a[228:231], a[96:99]
ds_read_b64_tr_b16 a[216:217], v16 offset:28672
ds_read_b64_tr_b16 a[218:219], v16 offset:30208
M a[96:99], a[184:187], a[224:227], a[96:99]
s_add_u32 s32, s28, 491520
s_sub_u32 s33, s32, s33
M a[100:103], a[192:195], a[224:227], a[100:103]
buffer_load_dwordx4 a[56:59], v1, s[44:47], s64 offen offset:2048 sc1
M a[100:103], a[196:199], a[228:231], a[100:103]
s_waitcnt lgkmcnt(10)
s_add_u32 s33, s33, 491520
s_cmp_eq_u32 s24, 0
s_cselect_b32 s27, s34, s32
s_cselect_b32 s28, s32, s33
M a[104:107], a[180:183], a[236:239], a[104:107]
ds_read_b128 a[224:227], v10 offset:30720
ds_read_b128 a[228:231], v11 offset:30720
M a[104:107], a[176:179], a[232:235], a[104:107]
M a[108:111], a[184:187], a[232:235], a[108:111]
ds_read_b64_tr_b16 a[204:205], v14 offset:40960
ds_read_b64_tr_b16 a[206:207], v14 offset:42496
s_add_u32 s26, s25, 16384
s_add_u32 s62, s27, 16384
M a[108:111], a[188:191], a[236:239], a[108:111]
M a[112:115], a[196:199], a[236:239], a[112:115]
s_add_u32 s63, s28, 16384
s_lshl_b32 s31, s21, 7
M a[112:115], a[192:195], a[232:235], a[112:115]
s_waitcnt lgkmcnt(10)
M a[116:119], a[176:179], a[240:243], a[116:119]
ds_read_b128 a[232:235], v10 offset:32768
ds_read_b128 a[236:239], v11 offset:32768
M a[116:119], a[180:183], a[244:247], a[116:119]
buffer_load_dwordx4 a[60:63], v1, s[44:47], s64 offen offset:3072 sc1
s_cmp_eq_u32 s24, 0
s_cselect_b32 s31, s31, 960
M a[120:123], a[188:191], a[244:247], a[120:123]
ds_read_b64_tr_b16 a[212:213], v15 offset:40960
ds_read_b64_tr_b16 a[214:215], v15 offset:42496
M a[120:123], a[184:187], a[240:243], a[120:123]
s_mov_b32 s60, 0
s_add_u32 s12, s4, 16777216
s_addc_u32 s13, s5, 0
M a[124:127], a[192:195], a[240:243], a[124:127]
M a[124:127], a[196:199], a[244:247], a[124:127]
s_waitcnt lgkmcnt(10)
M a[128:131], a[180:183], a[252:255], a[128:131]
ds_read_b128 a[240:243], v10 offset:34816
ds_read_b128 a[244:247], v11 offset:34816
s_mov_b32 s14, 33554432
s_mov_b32 s15, 0x00020000
M a[128:131], a[176:179], a[248:251], a[128:131]
M a[132:135], a[184:187], a[248:251], a[132:135]
ds_read_b64_tr_b16 a[220:221], v16 offset:40960
ds_read_b64_tr_b16 a[222:223], v16 offset:42496
s_mov_b32 s8, s4
s_mov_b32 s9, s5
M a[132:135], a[188:191], a[252:255], a[132:135]
buffer_load_dword v126, v119, s[36:39], 0 offen offset:128 sc1
M a[136:139], a[196:199], a[252:255], a[136:139]
M a[136:139], a[192:195], a[248:251], a[136:139]
s_waitcnt lgkmcnt(10)
s_mov_b32 s10, 16777216
s_mov_b32 s11, 0x00020000
M a[140:143], a[176:179], a[224:227], a[140:143]
M a[140:143], a[180:183], a[228:231], a[140:143]
M a[144:147], a[188:191], a[228:231], a[144:147]
M a[144:147], a[184:187], a[224:227], a[144:147]
M a[148:151], a[192:195], a[224:227], a[148:151]
s_waitcnt vmcnt(17) lgkmcnt(0)
s_barrier
ds_read_b128 a[248:251], v12 offset:0
ds_read_b128 a[252:255], v13 offset:0
s_waitcnt vmcnt(0)
v_cmp_gt_u32 vcc, 0x80, v126
s_nop 0
s_cbranch_vccnz Lk1_spin
Lk1_got:
M a[148:151], a[196:199], a[228:231], a[148:151]
s_add_u32 m0, s29, 65536
s_add_u32 s32, s25, 4096
buffer_load_dwordx4 v1, s[12:15], s25 offen offset:0 sc1 lds
M a[152:155], a[180:183], a[236:239], a[152:155]
ds_read_b128 a[224:227], v12 offset:2048
ds_read_b128 a[228:231], v13 offset:2048
M a[152:155], a[176:179], a[232:235], a[152:155]
buffer_load_dwordx4 v1, s[12:15], s25 offen offset:1024 sc1 lds
M a[156:159], a[184:187], a[232:235], a[156:159]
M a[156:159], a[188:191], a[236:239], a[156:159]
buffer_load_dwordx4 v1, s[12:15], s25 offen offset:2048 sc1 lds
M a[160:163], a[196:199], a[236:239], a[160:163]
buffer_load_dwordx4 v1, s[12:15], s25 offen offset:3072 sc1 lds
M a[160:163], a[192:195], a[232:235], a[160:163]
M a[164:167], a[176:179], a[240:243], a[164:167]
ds_read_b128 a[232:235], v12 offset:4096
ds_read_b128 a[236:239], v13 offset:4096
M a[164:167], a[180:183], a[244:247], a[164:167]
s_add_u32 m0, s29, 69632
s_nop 0
buffer_load_dwordx4 v1, s[12:15], s32 offen offset:0 sc1 lds
M a[168:171], a[188:191], a[244:247], a[168:171]
buffer_load_dwordx4 v1, s[12:15], s32 offen offset:1024 sc1 lds
M a[168:171], a[184:187], a[240:243], a[168:171]
M a[172:175], a[192:195], a[240:243], a[172:175]
buffer_load_dwordx4 v1, s[12:15], s32 offen offset:2048 sc1 lds
M a[172:175], a[196:199], a[244:247], a[172:175]
s_waitcnt lgkmcnt(4)
M a[68:71], a[200:203], a[248:251], a[68:71]
ds_read_b128 a[240:243], v12 offset:6144
ds_read_b128 a[244:247], v13 offset:6144
M a[68:71], a[204:207], a[252:255], a[68:71]
buffer_load_dwordx4 v1, s[12:15], s32 offen offset:3072 sc1 lds
M a[72:75], a[212:215], a[252:255], a[72:75]
M a[72:75], a[208:211], a[248:251], a[72:75]
M a[76:79], a[216:219], a[248:251], a[76:79]
M a[76:79], a[220:223], a[252:255], a[76:79]
s_waitcnt lgkmcnt(4)
M a[80:83], a[204:207], a[228:231], a[80:83]
ds_read_b128 a[248:251], v12 offset:8192
ds_read_b128 a[252:255], v13 offset:8192
M a[80:83], a[200:203], a[224:227], a[80:83]
M a[84:87], a[208:211], a[224:227], a[84:87]
M a[84:87], a[212:215], a[228:231], a[84:87]
M a[88:91], a[220:223], a[228:231], a[88:91]
M a[88:91], a[216:219], a[224:227], a[88:91]
s_waitcnt lgkmcnt(4)
M a[92:95], a[200:203], a[232:235], a[92:95]
ds_read_b128 a[224:227], v12 offset:10240
ds_read_b128 a[228:231], v13 offset:10240
v_accvgpr_read_b32 v24, a68
v_accvgpr_read_b32 v25, a69
v_accvgpr_read_b32 v26, a70
M a[92:95], a[204:207], a[236:239], a[92:95]
v_accvgpr_read_b32 v27, a71
v_cvt_pk_bf16_f32 v24, v24, v25
v_cvt_pk_bf16_f32 v25, v26, v27
ds_write_b64 v124, v[24:25] offset:0
M a[96:99], a[212:215], a[236:239], a[96:99]
v_accvgpr_read_b32 v28, a72
v_accvgpr_read_b32 v29, a73
v_accvgpr_read_b32 v30, a74
M a[96:99], a[208:211], a[232:235], a[96:99]
v_accvgpr_read_b32 v31, a75
v_cvt_pk_bf16_f32 v28, v28, v29
v_cvt_pk_bf16_f32 v29, v30, v31
ds_write_b64 v124, v[28:29] offset:32
M a[100:103], a[216:219], a[232:235], a[100:103]
v_accvgpr_read_b32 v24, a76
v_accvgpr_read_b32 v25, a77
v_accvgpr_read_b32 v26, a78
M a[100:103], a[220:223], a[236:239], a[100:103]
s_waitcnt lgkmcnt(6)
v_accvgpr_read_b32 v27, a79
v_cvt_pk_bf16_f32 v24, v24, v25
v_cvt_pk_bf16_f32 v25, v26, v27
ds_write_b64 v124, v[24:25] offset:64
M a[104:107], a[204:207], a[244:247], a[104:107]
ds_read_b128 a[232:235], v12 offset:12288
ds_read_b128 a[236:239], v13 offset:12288
v_accvgpr_read_b32 v24, a80
v_accvgpr_read_b32 v25, a81
v_accvgpr_read_b32 v26, a82
M a[104:107], a[200:203], a[240:243], a[104:107]
v_accvgpr_read_b32 v27, a83
v_cvt_pk_bf16_f32 v24, v24, v25
v_cvt_pk_bf16_f32 v25, v26, v27
ds_write_b64 v124, v[24:25] offset:6400
M a[108:111], a[208:211], a[240:243], a[108:111]
v_accvgpr_read_b32 v28, a84
v_accvgpr_read_b32 v29, a85
v_accvgpr_read_b32 v30, a86
M a[108:111], a[212:215], a[244:247], a[108:111]
v_accvgpr_read_b32 v31, a87
v_cvt_pk_bf16_f32 v28, v28, v29
v_cvt_pk_bf16_f32 v29, v30, v31
ds_write_b64 v124, v[28:29] offset:6432
M a[112:115], a[220:223], a[244:247], a[112:115]
v_accvgpr_read_b32 v24, a88
v_accvgpr_read_b32 v25, a89
v_accvgpr_read_b32 v26, a90
M a[112:115], a[216:219], a[240:243], a[112:115]
s_waitcnt lgkmcnt(9)
v_accvgpr_read_b32 v27, a91
v_cvt_pk_bf16_f32 v24, v24, v25
v_cvt_pk_bf16_f32 v25, v26, v27
ds_write_b64 v124, v[24:25] offset:6464
M a[116:119], a[200:203], a[248:251], a[116:119]
ds_read_b128 a[240:243], v12 offset:14336
ds_read_b128 a[244:247], v13 offset:14336
v_accvgpr_read_b32 v24, a92
v_accvgpr_read_b32 v25, a93
v_accvgpr_read_b32 v26, a94
M a[116:119], a[204:207], a[252:255], a[116:119]
v_accvgpr_read_b32 v27, a95
v_cvt_pk_bf16_f32 v24, v24, v25
v_cvt_pk_bf16_f32 v25, v26, v27
ds_write_b64 v124, v[24:25] offset:12800
M a[120:123], a[212:215], a[252:255], a[120:123]
v_accvgpr_read_b32 v28, a96
v_accvgpr_read_b32 v29, a97
v_accvgpr_read_b32 v30, a98
M a[120:123], a[208:211], a[248:251], a[120:123]
v_accvgpr_read_b32 v31, a99
v_cvt_pk_bf16_f32 v28, v28, v29
v_cvt_pk_bf16_f32 v29, v30, v31
ds_write_b64 v124, v[28:29] offset:12832
M a[124:127], a[216:219], a[248:251], a[124:127]
v_accvgpr_read_b32 v24, a100
v_accvgpr_read_b32 v25, a101
v_accvgpr_read_b32 v26, a102
M a[124:127], a[220:223], a[252:255], a[124:127]
s_add_u32 s25, s25, 32768
s_cmp_eq_u32 s25, s27
s_cselect_b32 s25, s28, s25
s_cselect_b32 s27, -1, s27
s_waitcnt lgkmcnt(12)
v_accvgpr_read_b32 v27, a103
v_cvt_pk_bf16_f32 v24, v24, v25
v_cvt_pk_bf16_f32 v25, v26, v27
ds_write_b64 v124, v[24:25] offset:12864
M a[128:131], a[204:207], a[228:231], a[128:131]
ds_read_b128 a[248:251], v12 offset:16384
ds_read_b128 a[252:255], v13 offset:16384
v_accvgpr_read_b32 v24, a104
v_accvgpr_read_b32 v25, a105
v_accvgpr_read_b32 v26, a106
M a[128:131], a[200:203], a[224:227], a[128:131]
v_accvgpr_read_b32 v27, a107
v_cvt_pk_bf16_f32 v24, v24, v25
v_cvt_pk_bf16_f32 v25, v26, v27
ds_write_b64 v124, v[24:25] offset:19200
M a[132:135], a[208:211], a[224:227], a[132:135]
v_accvgpr_read_b32 v28, a108
v_accvgpr_read_b32 v29, a109
v_accvgpr_read_b32 v30, a110
M a[132:135], a[212:215], a[228:231], a[132:135]
v_accvgpr_read_b32 v31, a111
v_cvt_pk_bf16_f32 v28, v28, v29
v_cvt_pk_bf16_f32 v29, v30, v31
ds_write_b64 v124, v[28:29] offset:19232
M a[136:139], a[220:223], a[228:231], a[136:139]
v_accvgpr_read_b32 v24, a112
v_accvgpr_read_b32 v25, a113
v_accvgpr_read_b32 v26, a114
M a[136:139], a[216:219], a[224:227], a[136:139]
s_waitcnt lgkmcnt(12)
v_accvgpr_read_b32 v27, a115
v_cvt_pk_bf16_f32 v24, v24, v25
v_cvt_pk_bf16_f32 v25, v26, v27
ds_write_b64 v124, v[24:25] offset:19264
M a[140:143], a[200:203], a[232:235], a[140:143]
v_accvgpr_read_b32 v24, a116
v_accvgpr_read_b32 v25, a117
v_accvgpr_read_b32 v26, a118
M a[140:143], a[204:207], a[236:239], a[140:143]
v_accvgpr_read_b32 v27, a119
v_cvt_pk_bf16_f32 v24, v24, v25
v_cvt_pk_bf16_f32 v25, v26, v27
ds_write_b64 v124, v[24:25] offset:25600
M a[144:147], a[212:215], a[236:239], a[144:147]
v_accvgpr_read_b32 v28, a120
v_accvgpr_read_b32 v29, a121
v_accvgpr_read_b32 v30, a122
M a[144:147], a[208:211], a[232:235], a[144:147]
v_accvgpr_read_b32 v31, a123
v_cvt_pk_bf16_f32 v28, v28, v29
v_cvt_pk_bf16_f32 v29, v30, v31
ds_write_b64 v124, v[28:29] offset:25632
M a[148:151], a[216:219], a[232:235], a[148:151]
s_waitcnt lgkmcnt(0)
s_barrier
v_accvgpr_read_b32 v24, a124
v_accvgpr_read_b32 v25, a125
v_accvgpr_read_b32 v26, a126
M a[148:151], a[220:223], a[236:239], a[148:151]
v_accvgpr_read_b32 v27, a127
v_cvt_pk_bf16_f32 v24, v24, v25
v_cvt_pk_bf16_f32 v25, v26, v27
ds_write_b64 v124, v[24:25] offset:25664
v_accvgpr_read_b32 v24, a128
v_accvgpr_read_b32 v25, a129
v_accvgpr_read_b32 v26, a130
M a[152:155], a[204:207], a[244:247], a[152:155]
v_accvgpr_read_b32 v27, a131
v_cvt_pk_bf16_f32 v24, v24, v25
v_cvt_pk_bf16_f32 v25, v26, v27
M a[152:155], a[200:203], a[240:243], a[152:155]
ds_write_b64 v124, v[24:25] offset:32000
v_accvgpr_read_b32 v28, a132
v_accvgpr_read_b32 v29, a133
M a[156:159], a[208:211], a[240:243], a[156:159]
v_accvgpr_read_b32 v30, a134
v_accvgpr_read_b32 v31, a135
v_cvt_pk_bf16_f32 v28, v28, v29
M a[156:159], a[212:215], a[244:247], a[156:159]
v_cvt_pk_bf16_f32 v29, v30, v31
ds_write_b64 v124, v[28:29] offset:32032
v_accvgpr_read_b32 v24, a136
M a[160:163], a[220:223], a[244:247], a[160:163]
v_accvgpr_read_b32 v25, a137
v_accvgpr_read_b32 v26, a138
v_accvgpr_read_b32 v27, a139
M a[160:163], a[216:219], a[240:243], a[160:163]
v_cvt_pk_bf16_f32 v24, v24, v25
v_cvt_pk_bf16_f32 v25, v26, v27
ds_write_b64 v124, v[24:25] offset:32064
M a[164:167], a[200:203], a[248:251], a[164:167]
v_accvgpr_read_b32 v24, a140
v_accvgpr_read_b32 v25, a141
v_accvgpr_read_b32 v26, a142
M a[164:167], a[204:207], a[252:255], a[164:167]
v_accvgpr_read_b32 v27, a143
v_cvt_pk_bf16_f32 v24, v24, v25
v_cvt_pk_bf16_f32 v25, v26, v27
ds_write_b64 v124, v[24:25] offset:38400
M a[168:171], a[212:215], a[252:255], a[168:171]
v_accvgpr_read_b32 v28, a144
v_accvgpr_read_b32 v29, a145
v_accvgpr_read_b32 v30, a146
M a[168:171], a[208:211], a[248:251], a[168:171]
v_accvgpr_read_b32 v31, a147
v_cvt_pk_bf16_f32 v28, v28, v29
v_cvt_pk_bf16_f32 v29, v30, v31
ds_write_b64 v124, v[28:29] offset:38432
M a[172:175], a[216:219], a[248:251], a[172:175]
v_accvgpr_read_b32 v24, a148
v_accvgpr_read_b32 v25, a149
v_accvgpr_read_b32 v26, a150
M a[172:175], a[220:223], a[252:255], a[172:175]
v_accvgpr_read_b32 v27, a151
v_cvt_pk_bf16_f32 v24, v24, v25
v_cvt_pk_bf16_f32 v25, v26, v27
ds_write_b64 v124, v[24:25] offset:38464
s_mov_b64 s[44:45], s[42:43]
v_accvgpr_read_b32 v24, a152
v_accvgpr_read_b32 v25, a153
v_accvgpr_read_b32 v26, a154
v_accvgpr_read_b32 v27, a155
v_cvt_pk_bf16_f32 v24, v24, v25
v_cvt_pk_bf16_f32 v25, v26, v27
ds_write_b64 v124, v[24:25] offset:44800
v_accvgpr_read_b32 v28, a156
v_accvgpr_read_b32 v29, a157
v_accvgpr_read_b32 v30, a158
v_accvgpr_read_b32 v31, a159
v_cvt_pk_bf16_f32 v28, v28, v29
v_cvt_pk_bf16_f32 v29, v30, v31
ds_write_b64 v124, v[28:29] offset:44832
v_accvgpr_read_b32 v24, a160
v_accvgpr_read_b32 v25, a161
v_accvgpr_read_b32 v26, a162
v_accvgpr_read_b32 v27, a163
v_cvt_pk_bf16_f32 v24, v24, v25
v_cvt_pk_bf16_f32 v25, v26, v27
ds_write_b64 v124, v[24:25] offset:44864
v_accvgpr_read_b32 v24, a164
v_accvgpr_read_b32 v25, a165
v_accvgpr_read_b32 v26, a166
v_accvgpr_read_b32 v27, a167
v_cvt_pk_bf16_f32 v24, v24, v25
v_cvt_pk_bf16_f32 v25, v26, v27
ds_write_b64 v124, v[24:25] offset:51200
v_accvgpr_read_b32 v28, a168
v_accvgpr_read_b32 v29, a169
v_accvgpr_read_b32 v30, a170
v_accvgpr_read_b32 v31, a171
v_cvt_pk_bf16_f32 v28, v28, v29
v_cvt_pk_bf16_f32 v29, v30, v31
ds_write_b64 v124, v[28:29] offset:51232
v_accvgpr_read_b32 v24, a172
v_accvgpr_read_b32 v25, a173
v_accvgpr_read_b32 v26, a174
v_accvgpr_read_b32 v27, a175
v_cvt_pk_bf16_f32 v24, v24, v25
v_cvt_pk_bf16_f32 v25, v26, v27
ds_write_b64 v124, v[24:25] offset:51264
s_waitcnt lgkmcnt(0)
s_barrier
ds_read_b128 v[48:51], v121 offset:128
ds_read_b128 v[32:35], v120 offset:0
ds_read_b128 v[52:55], v120 offset:128
ds_read_b128 v[36:39], v120 offset:12800
ds_read_b128 v[56:59], v120 offset:12928
ds_read_b128 v[40:43], v120 offset:25600
ds_read_b128 v[60:63], v120 offset:25728
ds_read_b128 v[44:47], v120 offset:38400
ds_read_b128 v[64:67], v120 offset:38528
ds_read_b64_tr_b16 v[68:69], v123 offset:256
ds_read_b64_tr_b16 v[70:71], v122 offset:256
ds_read_b64_tr_b16 v[72:73], v122 offset:13056
ds_read_b64_tr_b16 v[74:75], v122 offset:25856
ds_read_b64_tr_b16 v[76:77], v122 offset:38656
ds_read_b64_tr_b16 v[78:79], v123 offset:288
ds_read_b64_tr_b16 v[80:81], v122 offset:288
ds_read_b64_tr_b16 v[82:83], v122 offset:13088
ds_read_b64_tr_b16 v[84:85], v122 offset:25888
ds_read_b64_tr_b16 v[86:87], v122 offset:38688
v_accvgpr_write_b32 a64, 0
v_accvgpr_write_b32 a65, 0
v_accvgpr_write_b32 a66, 0
v_accvgpr_write_b32 a67, 0
v_accvgpr_write_b32 a68, 0
v_accvgpr_write_b32 a69, 0
v_accvgpr_write_b32 a70, 0
v_accvgpr_write_b32 a71, 0
v_accvgpr_write_b32 a72, 0
v_accvgpr_write_b32 a73, 0
v_accvgpr_write_b32 a74, 0
v_accvgpr_write_b32 a75, 0
s_add_u32 m0, s29, 0
s_add_u32 s32, s25, 4096
buffer_load_dwordx4 v1, s[12:15], s25 offen offset:0 sc1 lds
v_accvgpr_write_b32 a76, 0
v_accvgpr_write_b32 a77, 0
v_accvgpr_write_b32 a78, 0
v_accvgpr_write_b32 a79, 0
v_accvgpr_write_b32 a80, 0
v_accvgpr_write_b32 a81, 0
v_accvgpr_write_b32 a82, 0
v_accvgpr_write_b32 a83, 0
v_accvgpr_write_b32 a84, 0
v_accvgpr_write_b32 a85, 0
v_accvgpr_write_b32 a86, 0
buffer_load_dwordx4 v1, s[12:15], s25 offen offset:1024 sc1 lds
v_accvgpr_write_b32 a87, 0
v_accvgpr_write_b32 a88, 0
v_accvgpr_write_b32 a89, 0
v_accvgpr_write_b32 a90, 0
v_accvgpr_write_b32 a91, 0
v_accvgpr_write_b32 a92, 0
v_accvgpr_write_b32 a93, 0
v_accvgpr_write_b32 a94, 0
v_accvgpr_write_b32 a95, 0
v_accvgpr_write_b32 a96, 0
buffer_load_dwordx4 v1, s[12:15], s25 offen offset:2048 sc1 lds
v_accvgpr_write_b32 a97, 0
v_accvgpr_write_b32 a98, 0
v_accvgpr_write_b32 a99, 0
v_accvgpr_write_b32 a100, 0
v_accvgpr_write_b32 a101, 0
v_accvgpr_write_b32 a102, 0
v_accvgpr_write_b32 a103, 0
v_accvgpr_write_b32 a104, 0
v_accvgpr_write_b32 a105, 0
v_accvgpr_write_b32 a106, 0
v_accvgpr_write_b32 a107, 0
buffer_load_dwordx4 v1, s[12:15], s25 offen offset:3072 sc1 lds
v_accvgpr_write_b32 a108, 0
v_accvgpr_write_b32 a109, 0
v_accvgpr_write_b32 a110, 0
v_accvgpr_write_b32 a111, 0
s_waitcnt lgkmcnt(15)
M v[88:91], v[48:51], v[32:35], v[152:155]
M v[92:95], v[52:55], v[32:35], v[148:151]
M v[96:99], v[52:55], v[36:39], v[144:147]
s_waitcnt lgkmcnt(14)
M v[100:103], v[56:59], v[36:39], v[148:151]
s_waitcnt lgkmcnt(13)
M v[104:107], v[56:59], v[40:43], v[144:147]
s_waitcnt lgkmcnt(12)
M v[108:111], v[60:63], v[40:43], v[148:151]
s_add_u32 m0, s29, 4096
s_nop 0
buffer_load_dwordx4 v1, s[12:15], s32 offen offset:0 sc1 lds
s_waitcnt lgkmcnt(11)
M v[112:115], v[60:63], v[44:47], v[144:147]
s_waitcnt lgkmcnt(10)
M v[116:119], v[64:67], v[44:47], v[148:151]
v_max3_f32 v136, v88, v89, v90
v_max3_f32 v136, v136, v91, v92
v_max3_f32 v136, v136, v93, v94
v_max_f32 v136, v136, v95
v_max3_f32 v137, v96, v97, v98
v_max3_f32 v137, v137, v99, v100
v_max3_f32 v137, v137, v101, v102
v_max_f32 v137, v137, v103
v_max3_f32 v138, v104, v105, v106
buffer_load_dwordx4 v1, s[12:15], s32 offen offset:1024 sc1 lds
v_max3_f32 v138, v138, v107, v108
v_max3_f32 v138, v138, v109, v110
v_max_f32 v138, v138, v111
v_max3_f32 v139, v112, v113, v114
v_max3_f32 v139, v139, v115, v116
v_max3_f32 v139, v139, v117, v118
v_max_f32 v139, v139, v119
v_mov_b32 v140, v136
v_mov_b32 v141, v137
v_mov_b32 v142, v138
buffer_load_dwordx4 v1, s[12:15], s32 offen offset:2048 sc1 lds
v_mov_b32 v143, v139
v_permlane16_swap_b32 v136, v140
v_permlane16_swap_b32 v137, v141
v_permlane16_swap_b32 v138, v142
v_permlane16_swap_b32 v139, v143
v_max_f32 v136, v136, v140
v_max_f32 v137, v137, v141
v_max_f32 v138, v138, v142
v_max_f32 v139, v139, v143
v_mov_b32 v140, v136
v_mov_b32 v141, v137
buffer_load_dwordx4 v1, s[12:15], s32 offen offset:3072 sc1 lds
v_mov_b32 v142, v138
v_mov_b32 v143, v139
v_permlane32_swap_b32 v136, v140
v_permlane32_swap_b32 v137, v141
v_permlane32_swap_b32 v138, v142
v_permlane32_swap_b32 v139, v143
v_max_f32 v136, v136, v140
v_max_f32 v137, v137, v141
v_max_f32 v138, v138, v142
v_max_f32 v139, v139, v143
s_add_u32 s25, s25, 32768
s_cmp_eq_u32 s25, s27
s_cselect_b32 s25, s28, s25
s_cselect_b32 s27, -1, s27
v_mul_f32 v136, s7, v136
v_mul_f32 v137, s7, v137
v_mul_f32 v138, s7, v138
v_mul_f32 v139, s7, v139
v_fma_f32 v88, v88, s7, -v136
v_fma_f32 v89, v89, s7, -v136
v_fma_f32 v90, v90, s7, -v136
v_fma_f32 v91, v91, s7, -v136
v_fma_f32 v92, v92, s7, -v136
v_fma_f32 v93, v93, s7, -v136
v_fma_f32 v94, v94, s7, -v136
s_add_u32 m0, s29, 32768
s_add_u32 s32, s26, 4096
buffer_load_dwordx4 v1, s[12:15], s26 offen offset:0 sc1 lds
v_fma_f32 v95, v95, s7, -v136
v_exp_f32 v88, v88
v_exp_f32 v89, v89
v_exp_f32 v90, v90
v_exp_f32 v91, v91
v_exp_f32 v92, v92
v_exp_f32 v93, v93
v_exp_f32 v94, v94
v_exp_f32 v95, v95
v_fma_f32 v96, v96, s7, -v137
v_fma_f32 v97, v97, s7, -v137
buffer_load_dwordx4 v1, s[12:15], s26 offen offset:1024 sc1 lds
v_fma_f32 v98, v98, s7, -v137
v_fma_f32 v99, v99, s7, -v137
v_fma_f32 v100, v100, s7, -v137
v_fma_f32 v101, v101, s7, -v137
v_fma_f32 v102, v102, s7, -v137
v_fma_f32 v103, v103, s7, -v137
v_exp_f32 v96, v96
v_exp_f32 v97, v97
v_exp_f32 v98, v98
v_exp_f32 v99, v99
buffer_load_dwordx4 v1, s[12:15], s26 offen offset:2048 sc1 lds
v_exp_f32 v100, v100
v_exp_f32 v101, v101
v_exp_f32 v102, v102
v_exp_f32 v103, v103
v_fma_f32 v104, v104, s7, -v138
v_fma_f32 v105, v105, s7, -v138
v_fma_f32 v106, v106, s7, -v138
v_fma_f32 v107, v107, s7, -v138
v_fma_f32 v108, v108, s7, -v138
v_fma_f32 v109, v109, s7, -v138
v_fma_f32 v110, v110, s7, -v138
buffer_load_dwordx4 v1, s[12:15], s26 offen offset:3072 sc1 lds
v_fma_f32 v111, v111, s7, -v138
v_exp_f32 v104, v104
v_exp_f32 v105, v105
v_exp_f32 v106, v106
v_exp_f32 v107, v107
v_exp_f32 v108, v108
v_exp_f32 v109, v109
v_exp_f32 v110, v110
v_exp_f32 v111, v111
v_fma_f32 v112, v112, s7, -v139
s_add_u32 m0, s29, 36864
s_nop 0
buffer_load_dwordx4 v1, s[12:15], s32 offen offset:0 sc1 lds
v_fma_f32 v113, v113, s7, -v139
v_fma_f32 v114, v114, s7, -v139
v_fma_f32 v115, v115, s7, -v139
v_fma_f32 v116, v116, s7, -v139
v_fma_f32 v117, v117, s7, -v139
v_fma_f32 v118, v118, s7, -v139
v_fma_f32 v119, v119, s7, -v139
v_exp_f32 v112, v112
v_exp_f32 v113, v113
v_exp_f32 v114, v114
v_exp_f32 v115, v115
buffer_load_dwordx4 v1, s[12:15], s32 offen offset:1024 sc1 lds
v_exp_f32 v116, v116
v_exp_f32 v117, v117
v_exp_f32 v118, v118
v_exp_f32 v119, v119
v_cvt_pk_bf16_f32 v88, v88, v89
v_cvt_pk_bf16_f32 v89, v90, v91
v_cvt_pk_bf16_f32 v90, v92, v93
v_cvt_pk_bf16_f32 v91, v94, v95
v_cvt_pk_bf16_f32 v96, v96, v97
v_cvt_pk_bf16_f32 v97, v98, v99
buffer_load_dwordx4 v1, s[12:15], s32 offen offset:2048 sc1 lds
v_cvt_pk_bf16_f32 v98, v100, v101
v_cvt_pk_bf16_f32 v99, v102, v103
v_cvt_pk_bf16_f32 v104, v104, v105
v_cvt_pk_bf16_f32 v105, v106, v107
v_cvt_pk_bf16_f32 v106, v108, v109
v_cvt_pk_bf16_f32 v107, v110, v111
v_cvt_pk_bf16_f32 v112, v112, v113
v_cvt_pk_bf16_f32 v113, v114, v115
v_cvt_pk_bf16_f32 v114, v116, v117
v_cvt_pk_bf16_f32 v115, v118, v119
M v[120:123], v[156:159], v[88:91], 0
buffer_load_dwordx4 v1, s[12:15], s32 offen offset:3072 sc1 lds
s_waitcnt lgkmcnt(8)
M v[32:35], v[68:71], v[88:91], 0
s_waitcnt lgkmcnt(3)
M v[36:39], v[78:81], v[88:91], 0
M v[124:127], v[156:159], v[96:99], 0
M v[40:43], v[70:73], v[96:99], 0
s_waitcnt lgkmcnt(2)
M v[44:47], v[80:83], v[96:99], 0
M v[128:131], v[156:159], v[104:107], 0
M v[48:51], v[72:75], v[104:107], 0
s_waitcnt lgkmcnt(1)
M v[52:55], v[82:85], v[104:107], 0
M v[132:135], v[156:159], v[112:115], 0
M v[56:59], v[74:77], v[112:115], 0
s_add_u32 s26, s26, 32768
s_cmp_eq_u32 s26, s62
s_cselect_b32 s26, s63, s26
s_cselect_b32 s62, -1, s62
s_waitcnt lgkmcnt(0)
M v[60:63], v[84:87], v[112:115], 0
v_rcp_f32 v120, v120
v_rcp_f32 v124, v124
v_rcp_f32 v128, v128
v_rcp_f32 v132, v132
v_pk_mul_f32 v[32:33], v[32:33], v[120:121] op_sel_hi:[1,0]
v_pk_mul_f32 v[34:35], v[34:35], v[120:121] op_sel_hi:[1,0]
v_pk_mul_f32 v[36:37], v[36:37], v[120:121] op_sel_hi:[1,0]
v_pk_mul_f32 v[38:39], v[38:39], v[120:121] op_sel_hi:[1,0]
v_cvt_pk_bf16_f32 v32, v32, v33
v_cvt_pk_bf16_f32 v33, v34, v35
v_cvt_pk_bf16_f32 v34, v36, v37
v_cvt_pk_bf16_f32 v35, v38, v39
s_add_u32 s3, s6, 0
buffer_store_dwordx4 v[32:35], v1, s[16:19], s3 offen sc1
v_pk_mul_f32 v[40:41], v[40:41], v[124:125] op_sel_hi:[1,0]
v_pk_mul_f32 v[42:43], v[42:43], v[124:125] op_sel_hi:[1,0]
v_pk_mul_f32 v[44:45], v[44:45], v[124:125] op_sel_hi:[1,0]
v_pk_mul_f32 v[46:47], v[46:47], v[124:125] op_sel_hi:[1,0]
v_cvt_pk_bf16_f32 v40, v40, v41
v_cvt_pk_bf16_f32 v41, v42, v43
v_cvt_pk_bf16_f32 v42, v44, v45
v_cvt_pk_bf16_f32 v43, v46, v47
s_add_u32 s3, s6, 2048
buffer_store_dwordx4 v[40:43], v1, s[16:19], s3 offen sc1
v_pk_mul_f32 v[48:49], v[48:49], v[128:129] op_sel_hi:[1,0]
v_pk_mul_f32 v[50:51], v[50:51], v[128:129] op_sel_hi:[1,0]
v_pk_mul_f32 v[52:53], v[52:53], v[128:129] op_sel_hi:[1,0]
v_pk_mul_f32 v[54:55], v[54:55], v[128:129] op_sel_hi:[1,0]
v_cvt_pk_bf16_f32 v48, v48, v49
v_cvt_pk_bf16_f32 v49, v50, v51
v_cvt_pk_bf16_f32 v50, v52, v53
v_cvt_pk_bf16_f32 v51, v54, v55
s_add_u32 s3, s6, 4096
buffer_store_dwordx4 v[48:51], v1, s[16:19], s3 offen sc1
v_pk_mul_f32 v[56:57], v[56:57], v[132:133] op_sel_hi:[1,0]
v_pk_mul_f32 v[58:59], v[58:59], v[132:133] op_sel_hi:[1,0]
v_pk_mul_f32 v[60:61], v[60:61], v[132:133] op_sel_hi:[1,0]
v_pk_mul_f32 v[62:63], v[62:63], v[132:133] op_sel_hi:[1,0]
v_cvt_pk_bf16_f32 v56, v56, v57
v_cvt_pk_bf16_f32 v57, v58, v59
v_cvt_pk_bf16_f32 v58, v60, v61
v_cvt_pk_bf16_f32 v59, v62, v63
s_add_u32 s3, s6, 6144
buffer_store_dwordx4 v[56:59], v1, s[16:19], s3 offen sc1
Lc2:
s_add_u32 s16, s4, 67108864
s_addc_u32 s17, s5, 0
s_mov_b32 s18, 16777216
s_mov_b32 s19, 0x00020000
s_add_u32 s52, s4, 100663296
s_addc_u32 s53, s5, 0
s_mov_b32 s54, 8404992
s_mov_b32 s55, 0x00020000
s_mov_b32 s46, 8388608
s_mov_b32 s47, 0x00020000
s_mov_b32 s50, 2097152
s_mov_b32 s51, 0x00020000
s_lshl_b32 s33, s24, 14
v_add_u32 v2, s33, v1
v_add_u32 v3, 0x10000, v2
v_and_b32 v8, 15, v0
v_bfe_u32 v9, v0, 4, 2
v_lshlrev_b32 v9, 2, v9
v_sub_u32 v8, v8, v9
v_mov_b32 v4, 0xf149f2ca
v_cmp_gt_i32 vcc, 0, v8
s_nop 1
v_cndmask_b32 v16, 0, v4, vcc
v_cmp_gt_i32 vcc, 1, v8
s_nop 1
v_cndmask_b32 v17, 0, v4, vcc
v_cmp_gt_i32 vcc, 2, v8
s_nop 1
v_cndmask_b32 v18, 0, v4, vcc
v_cmp_gt_i32 vcc, 3, v8
s_nop 1
v_cndmask_b32 v19, 0, v4, vcc
v_mov_b32 v8, 0x3f803f80
v_accvgpr_write_b32 a112, v8
v_accvgpr_write_b32 a113, v8
v_accvgpr_write_b32 a114, v8
v_accvgpr_write_b32 a115, v8
s_lshl_b32 s33, s23, 6
s_add_i32 s33, s33, s31
s_cmp_gt_i32 s33, 0
s_cselect_b32 s34, 0, 0xf149f2ca
s_cmp_lt_i32 s33, 0
s_cselect_b32 s33, 0xf149f2ca, 0
v_mov_b32 v20, s34
v_mov_b32 v21, s34
v_mov_b32 v22, s34
v_mov_b32 v23, s34
v_mov_b32 v28, s33
v_mov_b32 v29, s33
v_mov_b32 v30, s33
v_mov_b32 v31, s33
v_med3_f32 v24, v16, v20, v28
v_med3_f32 v25, v17, v20, v28
v_med3_f32 v26, v18, v20, v28
v_med3_f32 v27, v19, v20, v28
v_mov_b32 v5, 0
v_mov_b32 v6, 1
s_waitcnt vmcnt(20)
s_barrier
ds_read_b128 a[116:119], v3 offset:0
ds_read_b128 a[120:123], v3 offset:1024
ds_read_b128 a[124:127], v3 offset:2048
ds_read_b128 a[128:131], v3 offset:3072
ds_read_b128 a[132:135], v3 offset:4096
ds_read_b128 a[136:139], v3 offset:5120
ds_read_b128 a[140:143], v3 offset:6144
ds_read_b128 a[144:147], v3 offset:7168
s_waitcnt lgkmcnt(4)
M v[32:35], a[116:119], a[0:3], v[24:27]
M v[32:35], a[120:123], a[4:7], v[32:35]
ds_read_b128 a[148:151], v3 offset:8192
ds_read_b128 a[152:155], v3 offset:9216
M v[32:35], a[124:127], a[8:11], v[32:35]
M v[32:35], a[128:131], a[12:15], v[32:35]
M v[36:39], a[128:131], a[28:31], v[28:31]
M v[36:39], a[124:127], a[24:27], v[36:39]
M v[36:39], a[120:123], a[20:23], v[36:39]
M v[36:39], a[116:119], a[16:19], v[36:39]
M v[40:43], a[116:119], a[32:35], v[28:31]
M v[40:43], a[120:123], a[36:39], v[40:43]
ds_read_b128 a[156:159], v3 offset:10240
ds_read_b128 a[160:163], v3 offset:11264
M v[40:43], a[124:127], a[40:43], v[40:43]
M v[40:43], a[128:131], a[44:47], v[40:43]
M v[44:47], a[128:131], a[60:63], v[28:31]
M v[44:47], a[124:127], a[56:59], v[44:47]
M v[44:47], a[120:123], a[52:55], v[44:47]
M v[44:47], a[116:119], a[48:51], v[44:47]
s_waitcnt lgkmcnt(4)
M v[48:51], a[132:135], a[0:3], v[20:23]
M v[48:51], a[136:139], a[4:7], v[48:51]
ds_read_b128 a[164:167], v3 offset:12288
ds_read_b128 a[168:171], v3 offset:13312
M v[48:51], a[140:143], a[8:11], v[48:51]
M v[48:51], a[144:147], a[12:15], v[48:51]
M v[52:55], a[144:147], a[28:31], v[24:27]
M v[52:55], a[140:143], a[24:27], v[52:55]
M v[52:55], a[136:139], a[20:23], v[52:55]
M v[52:55], a[132:135], a[16:19], v[52:55]
M v[56:59], a[132:135], a[32:35], v[28:31]
M v[56:59], a[136:139], a[36:39], v[56:59]
ds_read_b128 a[172:175], v3 offset:14336
ds_read_b128 a[176:179], v3 offset:15360
M v[56:59], a[140:143], a[40:43], v[56:59]
M v[56:59], a[144:147], a[44:47], v[56:59]
M v[60:63], a[144:147], a[60:63], v[28:31]
M v[60:63], a[140:143], a[56:59], v[60:63]
M v[60:63], a[136:139], a[52:55], v[60:63]
M v[60:63], a[132:135], a[48:51], v[60:63]
s_waitcnt lgkmcnt(4)
M v[64:67], a[148:151], a[0:3], v[20:23]
M v[64:67], a[152:155], a[4:7], v[64:67]
M v[64:67], a[156:159], a[8:11], v[64:67]
M v[64:67], a[160:163], a[12:15], v[64:67]
M v[68:71], a[160:163], a[28:31], v[20:23]
M v[68:71], a[156:159], a[24:27], v[68:71]
M v[68:71], a[152:155], a[20:23], v[68:71]
M v[68:71], a[148:151], a[16:19], v[68:71]
M v[72:75], a[148:151], a[32:35], v[24:27]
M v[72:75], a[152:155], a[36:39], v[72:75]
M v[72:75], a[156:159], a[40:43], v[72:75]
M v[72:75], a[160:163], a[44:47], v[72:75]
M v[76:79], a[160:163], a[60:63], v[28:31]
M v[76:79], a[156:159], a[56:59], v[76:79]
s_waitcnt vmcnt(12) lgkmcnt(0)
s_barrier
ds_read_b128 a[116:119], v2 offset:0
ds_read_b128 a[120:123], v2 offset:1024
ds_read_b128 a[124:127], v2 offset:2048
ds_read_b128 a[128:131], v2 offset:3072
M v[76:79], a[152:155], a[52:55], v[76:79]
M v[76:79], a[148:151], a[48:51], v[76:79]
M v[80:83], a[164:167], a[0:3], v[20:23]
M v[80:83], a[168:171], a[4:7], v[80:83]
ds_read_b128 a[132:135], v2 offset:4096
ds_read_b128 a[136:139], v2 offset:5120
M v[80:83], a[172:175], a[8:11], v[80:83]
M v[80:83], a[176:179], a[12:15], v[80:83]
M v[84:87], a[176:179], a[28:31], v[20:23]
M v[84:87], a[172:175], a[24:27], v[84:87]
M v[84:87], a[168:171], a[20:23], v[84:87]
M v[84:87], a[164:167], a[16:19], v[84:87]
M v[88:91], a[164:167], a[32:35], v[20:23]
M v[88:91], a[168:171], a[36:39], v[88:91]
ds_read_b128 a[140:143], v2 offset:6144
ds_read_b128 a[144:147], v2 offset:7168
M v[88:91], a[172:175], a[40:43], v[88:91]
M v[88:91], a[176:179], a[44:47], v[88:91]
M v[92:95], a[176:179], a[60:63], v[24:27]
M v[92:95], a[172:175], a[56:59], v[92:95]
M v[92:95], a[168:171], a[52:55], v[92:95]
M v[92:95], a[164:167], a[48:51], v[92:95]
s_waitcnt vmcnt(0)
s_mov_b64 exec, 1
buffer_store_dword v6, v5, s[52:55], s65 offen sc1
s_mov_b64 exec, -1
s_add_u32 m0, s29, 65536
s_add_u32 s32, s25, 4096
buffer_load_dwordx4 v1, s[12:15], s25 offen offset:0 sc1 lds
buffer_load_dwordx4 v1, s[12:15], s25 offen offset:1024 sc1 lds
buffer_load_dwordx4 v1, s[12:15], s25 offen offset:2048 sc1 lds
buffer_load_dwordx4 v1, s[12:15], s25 offen offset:3072 sc1 lds
s_add_u32 m0, s29, 69632
s_nop 0
buffer_load_dwordx4 v1, s[12:15], s32 offen offset:0 sc1 lds
buffer_load_dwordx4 v1, s[12:15], s32 offen offset:1024 sc1 lds
buffer_load_dwordx4 v1, s[12:15], s32 offen offset:2048 sc1 lds
buffer_load_dwordx4 v1, s[12:15], s32 offen offset:3072 sc1 lds
s_add_u32 s25, s25, 32768
s_cmp_eq_u32 s25, s27
s_cselect_b32 s25, s28, s25
s_cselect_b32 s27, -1, s27
v_exp_f32 v32, v32
v_exp_f32 v33, v33
v_exp_f32 v34, v34
v_exp_f32 v35, v35
v_exp_f32 v48, v48
v_exp_f32 v49, v49
v_exp_f32 v50, v50
v_exp_f32 v51, v51
v_cvt_pk_bf16_f32 v32, v32, v33
v_cvt_pk_bf16_f32 v33, v34, v35
v_exp_f32 v36, v36
v_exp_f32 v37, v37
v_exp_f32 v38, v38
v_exp_f32 v39, v39
v_cvt_pk_bf16_f32 v34, v48, v49
v_cvt_pk_bf16_f32 v35, v50, v51
v_exp_f32 v52, v52
v_exp_f32 v53, v53
v_exp_f32 v54, v54
v_exp_f32 v55, v55
v_cvt_pk_bf16_f32 v36, v36, v37
v_cvt_pk_bf16_f32 v37, v38, v39
v_exp_f32 v40, v40
v_exp_f32 v41, v41
v_exp_f32 v42, v42
v_exp_f32 v43, v43
v_cvt_pk_bf16_f32 v38, v52, v53
v_cvt_pk_bf16_f32 v39, v54, v55
v_exp_f32 v56, v56
v_exp_f32 v57, v57
v_exp_f32 v58, v58
v_exp_f32 v59, v59
v_cvt_pk_bf16_f32 v40, v40, v41
v_cvt_pk_bf16_f32 v41, v42, v43
v_exp_f32 v44, v44
v_exp_f32 v45, v45
v_exp_f32 v46, v46
v_exp_f32 v47, v47
v_cvt_pk_bf16_f32 v42, v56, v57
v_cvt_pk_bf16_f32 v43, v58, v59
v_exp_f32 v60, v60
v_exp_f32 v61, v61
v_exp_f32 v62, v62
v_exp_f32 v63, v63
v_cvt_pk_bf16_f32 v44, v44, v45
v_cvt_pk_bf16_f32 v45, v46, v47
v_cvt_pk_bf16_f32 v46, v60, v61
v_cvt_pk_bf16_f32 v47, v62, v63
s_cmp_eq_u32 s24, 1
s_cbranch_scc1 Lk2_g1
s_mov_b32 s30, s21
s_cmp_eq_u32 s21, 0
s_cbranch_scc1 Lk2_m2
Lk2_l1:
s_waitcnt lgkmcnt(4)
s_add_u32 m0, s29, 98304
M v[96:99], a[116:119], a[0:3], 0
v_exp_f32 v64, v64
M v[96:99], a[120:123], a[4:7], v[96:99]
ds_read_b128 a[148:151], v2 offset:8192
ds_read_b128 a[152:155], v2 offset:9216
M v[96:99], a[124:127], a[8:11], v[96:99]
v_exp_f32 v65, v65
M v[96:99], a[128:131], a[12:15], v[96:99]
buffer_load_dwordx4 v1, s[12:15], s26 offen offset:0 sc1 lds
s_add_u32 s32, s26, 4096
M v[100:103], a[128:131], a[28:31], 0
v_exp_f32 v66, v66
M v[100:103], a[124:127], a[24:27], v[100:103]
v_cvt_pk_bf16_f32 v64, v64, v65
M v[100:103], a[120:123], a[20:23], v[100:103]
v_exp_f32 v67, v67
M v[100:103], a[116:119], a[16:19], v[100:103]
buffer_load_dwordx4 v1, s[12:15], s26 offen offset:1024 sc1 lds
M v[104:107], a[116:119], a[32:35], 0
v_exp_f32 v80, v80
M v[104:107], a[120:123], a[36:39], v[104:107]
ds_read_b128 a[156:159], v2 offset:10240
ds_read_b128 a[160:163], v2 offset:11264
M v[104:107], a[124:127], a[40:43], v[104:107]
v_exp_f32 v81, v81
M v[104:107], a[128:131], a[44:47], v[104:107]
buffer_load_dwordx4 v1, s[12:15], s26 offen offset:2048 sc1 lds
M v[108:111], a[128:131], a[60:63], 0
v_exp_f32 v82, v82
M v[108:111], a[124:127], a[56:59], v[108:111]
v_cvt_pk_bf16_f32 v65, v66, v67
v_cvt_pk_bf16_f32 v66, v80, v81
M v[108:111], a[120:123], a[52:55], v[108:111]
v_exp_f32 v83, v83
M v[108:111], a[116:119], a[48:51], v[108:111]
buffer_load_dwordx4 v1, s[12:15], s26 offen offset:3072 sc1 lds
s_add_u32 m0, s29, 102400
s_waitcnt lgkmcnt(4)
M v[112:115], a[132:135], a[0:3], 0
v_exp_f32 v68, v68
M v[112:115], a[136:139], a[4:7], v[112:115]
ds_read_b128 a[164:167], v2 offset:12288
ds_read_b128 a[168:171], v2 offset:13312
M v[112:115], a[140:143], a[8:11], v[112:115]
v_exp_f32 v69, v69
M v[112:115], a[144:147], a[12:15], v[112:115]
buffer_load_dwordx4 v1, s[12:15], s32 offen offset:0 sc1 lds
M v[116:119], a[144:147], a[28:31], 0
v_exp_f32 v70, v70
M v[116:119], a[140:143], a[24:27], v[116:119]
v_cvt_pk_bf16_f32 v67, v82, v83
v_cvt_pk_bf16_f32 v68, v68, v69
M v[116:119], a[136:139], a[20:23], v[116:119]
v_exp_f32 v71, v71
M v[116:119], a[132:135], a[16:19], v[116:119]
buffer_load_dwordx4 v1, s[12:15], s32 offen offset:1024 sc1 lds
M v[120:123], a[132:135], a[32:35], 0
v_exp_f32 v84, v84
M v[120:123], a[136:139], a[36:39], v[120:123]
ds_read_b128 a[172:175], v2 offset:14336
ds_read_b128 a[176:179], v2 offset:15360
M v[120:123], a[140:143], a[40:43], v[120:123]
v_exp_f32 v85, v85
M v[120:123], a[144:147], a[44:47], v[120:123]
buffer_load_dwordx4 v1, s[12:15], s32 offen offset:2048 sc1 lds
M v[124:127], a[144:147], a[60:63], 0
v_exp_f32 v86, v86
M v[124:127], a[140:143], a[56:59], v[124:127]
v_cvt_pk_bf16_f32 v69, v70, v71
v_cvt_pk_bf16_f32 v70, v84, v85
M v[124:127], a[136:139], a[52:55], v[124:127]
v_exp_f32 v87, v87
M v[124:127], a[132:135], a[48:51], v[124:127]
buffer_load_dwordx4 v1, s[12:15], s32 offen offset:3072 sc1 lds
s_waitcnt lgkmcnt(4)
M v[128:131], a[148:151], a[0:3], 0
v_exp_f32 v72, v72
M v[128:131], a[152:155], a[4:7], v[128:131]
s_add_u32 s26, s26, 32768
s_cmp_eq_u32 s26, s62
s_cselect_b32 s26, s63, s26
s_cselect_b32 s62, -1, s62
M v[128:131], a[156:159], a[8:11], v[128:131]
v_exp_f32 v73, v73
M v[128:131], a[160:163], a[12:15], v[128:131]
v_cvt_pk_bf16_f32 v71, v86, v87
v_cvt_pk_bf16_f32 v72, v72, v73
M v[132:135], a[160:163], a[28:31], 0
v_exp_f32 v74, v74
M v[132:135], a[156:159], a[24:27], v[132:135]
M v[132:135], a[152:155], a[20:23], v[132:135]
v_exp_f32 v75, v75
M v[132:135], a[148:151], a[16:19], v[132:135]
v_cvt_pk_bf16_f32 v73, v74, v75
M v[136:139], a[148:151], a[32:35], 0
v_exp_f32 v88, v88
M v[136:139], a[152:155], a[36:39], v[136:139]
M v[136:139], a[156:159], a[40:43], v[136:139]
v_exp_f32 v89, v89
M v[136:139], a[160:163], a[44:47], v[136:139]
v_cvt_pk_bf16_f32 v74, v88, v89
M v[140:143], a[160:163], a[60:63], 0
v_exp_f32 v90, v90
M v[140:143], a[156:159], a[56:59], v[140:143]
s_waitcnt vmcnt(16) lgkmcnt(0)
s_barrier
ds_read_b128 a[116:119], v2 offset:32768
ds_read_b128 a[120:123], v2 offset:40960
ds_read_b128 a[124:127], v2 offset:33792
ds_read_b128 a[128:131], v2 offset:41984
M v[140:143], a[152:155], a[52:55], v[140:143]
v_exp_f32 v91, v91
M v[140:143], a[148:151], a[48:51], v[140:143]
v_cvt_pk_bf16_f32 v75, v90, v91
M v[144:147], a[164:167], a[0:3], 0
v_exp_f32 v76, v76
M v[144:147], a[168:171], a[4:7], v[144:147]
ds_read_b128 a[132:135], v2 offset:34816
ds_read_b128 a[136:139], v2 offset:43008
M v[144:147], a[172:175], a[8:11], v[144:147]
v_exp_f32 v77, v77
M v[144:147], a[176:179], a[12:15], v[144:147]
v_cvt_pk_bf16_f32 v76, v76, v77
M v[148:151], a[176:179], a[28:31], 0
v_exp_f32 v78, v78
M v[148:151], a[172:175], a[24:27], v[148:151]
M v[148:151], a[168:171], a[20:23], v[148:151]
v_exp_f32 v79, v79
M v[148:151], a[164:167], a[16:19], v[148:151]
v_cvt_pk_bf16_f32 v77, v78, v79
M v[152:155], a[164:167], a[32:35], 0
v_exp_f32 v92, v92
M v[152:155], a[168:171], a[36:39], v[152:155]
ds_read_b128 a[140:143], v2 offset:35840
ds_read_b128 a[144:147], v2 offset:44032
M v[152:155], a[172:175], a[40:43], v[152:155]
v_exp_f32 v93, v93
M v[152:155], a[176:179], a[44:47], v[152:155]
v_cvt_pk_bf16_f32 v78, v92, v93
M v[156:159], a[176:179], a[60:63], 0
v_exp_f32 v94, v94
M v[156:159], a[172:175], a[56:59], v[156:159]
M v[156:159], a[168:171], a[52:55], v[156:159]
v_exp_f32 v95, v95
M v[156:159], a[164:167], a[48:51], v[156:159]
v_cvt_pk_bf16_f32 v79, v94, v95
s_waitcnt lgkmcnt(6)
s_add_u32 m0, s29, 0
M v[160:163], a[116:119], v[32:35], v[160:163]
v_exp_f32 v96, v96
M v[160:163], a[120:123], v[64:67], v[160:163]
ds_read_b128 a[148:151], v2 offset:36864
ds_read_b128 a[152:155], v2 offset:45056
M v[164:167], a[120:123], v[68:71], v[164:167]
v_exp_f32 v97, v97
M v[164:167], a[116:119], v[36:39], v[164:167]
buffer_load_dwordx4 v1, s[12:15], s25 offen offset:0 sc1 lds
s_add_u32 s32, s25, 4096
M v[168:171], a[116:119], v[40:43], v[168:171]
v_exp_f32 v98, v98
M v[168:171], a[120:123], v[72:75], v[168:171]
v_cvt_pk_bf16_f32 v96, v96, v97
M v[172:175], a[120:123], v[76:79], v[172:175]
v_exp_f32 v99, v99
M v[172:175], a[116:119], v[44:47], v[172:175]
buffer_load_dwordx4 v1, s[12:15], s25 offen offset:1024 sc1 lds
s_waitcnt lgkmcnt(6)
M a[96:99], a[112:115], v[32:35], a[96:99]
M a[96:99], a[112:115], v[64:67], a[96:99]
M v[176:179], a[124:127], v[32:35], v[176:179]
v_exp_f32 v112, v112
M v[176:179], a[128:131], v[64:67], v[176:179]
ds_read_b128 a[156:159], v2 offset:37888
ds_read_b128 a[160:163], v2 offset:46080
M v[180:183], a[128:131], v[68:71], v[180:183]
v_exp_f32 v113, v113
M v[180:183], a[124:127], v[36:39], v[180:183]
buffer_load_dwordx4 v1, s[12:15], s25 offen offset:2048 sc1 lds
M v[184:187], a[124:127], v[40:43], v[184:187]
v_exp_f32 v114, v114
M v[184:187], a[128:131], v[72:75], v[184:187]
v_cvt_pk_bf16_f32 v97, v98, v99
v_cvt_pk_bf16_f32 v98, v112, v113
M v[188:191], a[128:131], v[76:79], v[188:191]
v_exp_f32 v115, v115
M v[188:191], a[124:127], v[44:47], v[188:191]
buffer_load_dwordx4 v1, s[12:15], s25 offen offset:3072 sc1 lds
s_add_u32 m0, s29, 4096
s_waitcnt lgkmcnt(6)
M a[100:103], a[112:115], v[36:39], a[100:103]
M a[100:103], a[112:115], v[68:71], a[100:103]
M v[192:195], a[132:135], v[32:35], v[192:195]
v_exp_f32 v100, v100
M v[192:195], a[136:139], v[64:67], v[192:195]
ds_read_b128 a[164:167], v2 offset:38912
ds_read_b128 a[168:171], v2 offset:47104
M v[196:199], a[136:139], v[68:71], v[196:199]
v_exp_f32 v101, v101
M v[196:199], a[132:135], v[36:39], v[196:199]
buffer_load_dwordx4 v1, s[12:15], s32 offen offset:0 sc1 lds
M v[200:203], a[132:135], v[40:43], v[200:203]
v_exp_f32 v102, v102
M v[200:203], a[136:139], v[72:75], v[200:203]
v_cvt_pk_bf16_f32 v99, v114, v115
v_cvt_pk_bf16_f32 v100, v100, v101
M v[204:207], a[136:139], v[76:79], v[204:207]
v_exp_f32 v103, v103
M v[204:207], a[132:135], v[44:47], v[204:207]
buffer_load_dwordx4 v1, s[12:15], s32 offen offset:1024 sc1 lds
s_waitcnt lgkmcnt(6)
M a[104:107], a[112:115], v[40:43], a[104:107]
M a[104:107], a[112:115], v[72:75], a[104:107]
M v[208:211], a[140:143], v[32:35], v[208:211]
v_exp_f32 v116, v116
M v[208:211], a[144:147], v[64:67], v[208:211]
ds_read_b128 a[172:175], v2 offset:39936
ds_read_b128 a[176:179], v2 offset:48128
M v[212:215], a[144:147], v[68:71], v[212:215]
v_exp_f32 v117, v117
M v[212:215], a[140:143], v[36:39], v[212:215]
buffer_load_dwordx4 v1, s[12:15], s32 offen offset:2048 sc1 lds
M v[216:219], a[140:143], v[40:43], v[216:219]
v_exp_f32 v118, v118
M v[216:219], a[144:147], v[72:75], v[216:219]
v_cvt_pk_bf16_f32 v101, v102, v103
v_cvt_pk_bf16_f32 v102, v116, v117
M v[220:223], a[144:147], v[76:79], v[220:223]
v_exp_f32 v119, v119
M v[220:223], a[140:143], v[44:47], v[220:223]
buffer_load_dwordx4 v1, s[12:15], s32 offen offset:3072 sc1 lds
s_waitcnt lgkmcnt(6)
M a[108:111], a[112:115], v[44:47], a[108:111]
M a[108:111], a[112:115], v[76:79], a[108:111]
M v[224:227], a[148:151], v[32:35], v[224:227]
v_exp_f32 v104, v104
M v[224:227], a[152:155], v[64:67], v[224:227]
s_add_u32 s25, s25, 32768
s_cmp_eq_u32 s25, s27
s_cselect_b32 s25, s28, s25
s_cselect_b32 s27, -1, s27
M v[228:231], a[152:155], v[68:71], v[228:231]
v_exp_f32 v105, v105
M v[228:231], a[148:151], v[36:39], v[228:231]
v_cvt_pk_bf16_f32 v103, v118, v119
v_cvt_pk_bf16_f32 v104, v104, v105
M v[232:235], a[148:151], v[40:43], v[232:235]
v_exp_f32 v106, v106
M v[232:235], a[152:155], v[72:75], v[232:235]
M v[236:239], a[152:155], v[76:79], v[236:239]
v_exp_f32 v107, v107
M v[236:239], a[148:151], v[44:47], v[236:239]
v_cvt_pk_bf16_f32 v105, v106, v107
s_waitcnt lgkmcnt(4)
M v[240:243], a[156:159], v[32:35], v[240:243]
v_exp_f32 v120, v120
M v[240:243], a[160:163], v[64:67], v[240:243]
M v[244:247], a[160:163], v[68:71], v[244:247]
v_exp_f32 v121, v121
M v[244:247], a[156:159], v[36:39], v[244:247]
v_cvt_pk_bf16_f32 v106, v120, v121
M v[248:251], a[156:159], v[40:43], v[248:251]
v_exp_f32 v122, v122
M v[248:251], a[160:163], v[72:75], v[248:251]
s_waitcnt vmcnt(16) lgkmcnt(0)
s_barrier
ds_read_b128 a[116:119], v3 offset:0
ds_read_b128 a[120:123], v3 offset:1024
ds_read_b128 a[124:127], v3 offset:2048
ds_read_b128 a[128:131], v3 offset:3072
M v[252:255], a[160:163], v[76:79], v[252:255]
v_exp_f32 v123, v123
M v[252:255], a[156:159], v[44:47], v[252:255]
v_cvt_pk_bf16_f32 v107, v122, v123
M a[64:67], a[164:167], v[32:35], a[64:67]
v_exp_f32 v108, v108
M a[64:67], a[168:171], v[64:67], a[64:67]
ds_read_b128 a[132:135], v3 offset:4096
ds_read_b128 a[136:139], v3 offset:5120
M a[68:71], a[168:171], v[68:71], a[68:71]
v_exp_f32 v109, v109
M a[68:71], a[164:167], v[36:39], a[68:71]
v_cvt_pk_bf16_f32 v108, v108, v109
M a[72:75], a[164:167], v[40:43], a[72:75]
v_exp_f32 v110, v110
M a[72:75], a[168:171], v[72:75], a[72:75]
M a[76:79], a[168:171], v[76:79], a[76:79]
v_exp_f32 v111, v111
M a[76:79], a[164:167], v[44:47], a[76:79]
v_cvt_pk_bf16_f32 v109, v110, v111
M a[80:83], a[172:175], v[32:35], a[80:83]
v_exp_f32 v124, v124
M a[80:83], a[176:179], v[64:67], a[80:83]
ds_read_b128 a[140:143], v3 offset:6144
ds_read_b128 a[144:147], v3 offset:7168
M a[84:87], a[176:179], v[68:71], a[84:87]
v_exp_f32 v125, v125
M a[84:87], a[172:175], v[36:39], a[84:87]
v_cvt_pk_bf16_f32 v110, v124, v125
M a[88:91], a[172:175], v[40:43], a[88:91]
v_exp_f32 v126, v126
M a[88:91], a[176:179], v[72:75], a[88:91]
M a[92:95], a[176:179], v[76:79], a[92:95]
v_exp_f32 v127, v127
M a[92:95], a[172:175], v[44:47], a[92:95]
v_cvt_pk_bf16_f32 v111, v126, v127
s_sub_u32 s30, s30, 1
s_cmp_eq_u32 s30, 0
s_cbranch_scc1 Lk2_m1
s_waitcnt lgkmcnt(4)
s_add_u32 m0, s29, 32768
M v[32:35], a[116:119], a[0:3], 0
v_exp_f32 v128, v128
M v[32:35], a[120:123], a[4:7], v[32:35]
ds_read_b128 a[148:151], v3 offset:8192
ds_read_b128 a[152:155], v3 offset:9216
M v[32:35], a[124:127], a[8:11], v[32:35]
v_exp_f32 v129, v129
M v[32:35], a[128:131], a[12:15], v[32:35]
buffer_load_dwordx4 v1, s[12:15], s26 offen offset:0 sc1 lds
s_add_u32 s32, s26, 4096
M v[36:39], a[128:131], a[28:31], 0
v_exp_f32 v130, v130
M v[36:39], a[124:127], a[24:27], v[36:39]
v_cvt_pk_bf16_f32 v128, v128, v129
M v[36:39], a[120:123], a[20:23], v[36:39]
v_exp_f32 v131, v131
M v[36:39], a[116:119], a[16:19], v[36:39]
buffer_load_dwordx4 v1, s[12:15], s26 offen offset:1024 sc1 lds
M v[40:43], a[116:119], a[32:35], 0
v_exp_f32 v144, v144
M v[40:43], a[120:123], a[36:39], v[40:43]
ds_read_b128 a[156:159], v3 offset:10240
ds_read_b128 a[160:163], v3 offset:11264
M v[40:43], a[124:127], a[40:43], v[40:43]
v_exp_f32 v145, v145
M v[40:43], a[128:131], a[44:47], v[40:43]
buffer_load_dwordx4 v1, s[12:15], s26 offen offset:2048 sc1 lds
M v[44:47], a[128:131], a[60:63], 0
v_exp_f32 v146, v146
M v[44:47], a[124:127], a[56:59], v[44:47]
v_cvt_pk_bf16_f32 v129, v130, v131
v_cvt_pk_bf16_f32 v130, v144, v145
M v[44:47], a[120:123], a[52:55], v[44:47]
v_exp_f32 v147, v147
M v[44:47], a[116:119], a[48:51], v[44:47]
buffer_load_dwordx4 v1, s[12:15], s26 offen offset:3072 sc1 lds
s_add_u32 m0, s29, 36864
s_waitcnt lgkmcnt(4)
M v[48:51], a[132:135], a[0:3], 0
v_exp_f32 v132, v132
M v[48:51], a[136:139], a[4:7], v[48:51]
ds_read_b128 a[164:167], v3 offset:12288
ds_read_b128 a[168:171], v3 offset:13312
M v[48:51], a[140:143], a[8:11], v[48:51]
v_exp_f32 v133, v133
M v[48:51], a[144:147], a[12:15], v[48:51]
buffer_load_dwordx4 v1, s[12:15], s32 offen offset:0 sc1 lds
M v[52:55], a[144:147], a[28:31], 0
v_exp_f32 v134, v134
M v[52:55], a[140:143], a[24:27], v[52:55]
v_cvt_pk_bf16_f32 v131, v146, v147
v_cvt_pk_bf16_f32 v132, v132, v133
M v[52:55], a[136:139], a[20:23], v[52:55]
v_exp_f32 v135, v135
M v[52:55], a[132:135], a[16:19], v[52:55]
buffer_load_dwordx4 v1, s[12:15], s32 offen offset:1024 sc1 lds
M v[56:59], a[132:135], a[32:35], 0
v_exp_f32 v148, v148
M v[56:59], a[136:139], a[36:39], v[56:59]
ds_read_b128 a[172:175], v3 offset:14336
ds_read_b128 a[176:179], v3 offset:15360
M v[56:59], a[140:143], a[40:43], v[56:59]
v_exp_f32 v149, v149
M v[56:59], a[144:147], a[44:47], v[56:59]
buffer_load_dwordx4 v1, s[12:15], s32 offen offset:2048 sc1 lds
M v[60:63], a[144:147], a[60:63], 0
v_exp_f32 v150, v150
M v[60:63], a[140:143], a[56:59], v[60:63]
v_cvt_pk_bf16_f32 v133, v134, v135
v_cvt_pk_bf16_f32 v134, v148, v149
M v[60:63], a[136:139], a[52:55], v[60:63]
v_exp_f32 v151, v151
M v[60:63], a[132:135], a[48:51], v[60:63]
buffer_load_dwordx4 v1, s[12:15], s32 offen offset:3072 sc1 lds
s_waitcnt lgkmcnt(4)
M v[64:67], a[148:151], a[0:3], 0
v_exp_f32 v136, v136
M v[64:67], a[152:155], a[4:7], v[64:67]
s_add_u32 s26, s26, 32768
s_cmp_eq_u32 s26, s62
s_cselect_b32 s26, s63, s26
s_cselect_b32 s62, -1, s62
M v[64:67], a[156:159], a[8:11], v[64:67]
v_exp_f32 v137, v137
M v[64:67], a[160:163], a[12:15], v[64:67]
v_cvt_pk_bf16_f32 v135, v150, v151
v_cvt_pk_bf16_f32 v136, v136, v137
M v[68:71], a[160:163], a[28:31], 0
v_exp_f32 v138, v138
M v[68:71], a[156:159], a[24:27], v[68:71]
M v[68:71], a[152:155], a[20:23], v[68:71]
v_exp_f32 v139, v139
M v[68:71], a[148:151], a[16:19], v[68:71]
v_cvt_pk_bf16_f32 v137, v138, v139
M v[72:75], a[148:151], a[32:35], 0
v_exp_f32 v152, v152
M v[72:75], a[152:155], a[36:39], v[72:75]
M v[72:75], a[156:159], a[40:43], v[72:75]
v_exp_f32 v153, v153
M v[72:75], a[160:163], a[44:47], v[72:75]
v_cvt_pk_bf16_f32 v138, v152, v153
M v[76:79], a[160:163], a[60:63], 0
v_exp_f32 v154, v154
M v[76:79], a[156:159], a[56:59], v[76:79]
s_waitcnt vmcnt(16) lgkmcnt(0)
s_barrier
ds_read_b128 a[116:119], v3 offset:32768
ds_read_b128 a[120:123], v3 offset:40960
ds_read_b128 a[124:127], v3 offset:33792
ds_read_b128 a[128:131], v3 offset:41984
M v[76:79], a[152:155], a[52:55], v[76:79]
v_exp_f32 v155, v155
M v[76:79], a[148:151], a[48:51], v[76:79]
v_cvt_pk_bf16_f32 v139, v154, v155
M v[80:83], a[164:167], a[0:3], 0
v_exp_f32 v140, v140
M v[80:83], a[168:171], a[4:7], v[80:83]
ds_read_b128 a[132:135], v3 offset:34816
ds_read_b128 a[136:139], v3 offset:43008
M v[80:83], a[172:175], a[8:11], v[80:83]
v_exp_f32 v141, v141
M v[80:83], a[176:179], a[12:15], v[80:83]
v_cvt_pk_bf16_f32 v140, v140, v141
M v[84:87], a[176:179], a[28:31], 0
v_exp_f32 v142, v142
M v[84:87], a[172:175], a[24:27], v[84:87]
M v[84:87], a[168:171], a[20:23], v[84:87]
v_exp_f32 v143, v143
M v[84:87], a[164:167], a[16:19], v[84:87]
v_cvt_pk_bf16_f32 v141, v142, v143
M v[88:91], a[164:167], a[32:35], 0
v_exp_f32 v156, v156
M v[88:91], a[168:171], a[36:39], v[88:91]
ds_read_b128 a[140:143], v3 offset:35840
ds_read_b128 a[144:147], v3 offset:44032
M v[88:91], a[172:175], a[40:43], v[88:91]
v_exp_f32 v157, v157
M v[88:91], a[176:179], a[44:47], v[88:91]
v_cvt_pk_bf16_f32 v142, v156, v157
M v[92:95], a[176:179], a[60:63], 0
v_exp_f32 v158, v158
M v[92:95], a[172:175], a[56:59], v[92:95]
M v[92:95], a[168:171], a[52:55], v[92:95]
v_exp_f32 v159, v159
M v[92:95], a[164:167], a[48:51], v[92:95]
v_cvt_pk_bf16_f32 v143, v158, v159
s_waitcnt lgkmcnt(6)
s_add_u32 m0, s29, 65536
M v[160:163], a[116:119], v[96:99], v[160:163]
v_exp_f32 v32, v32
M v[160:163], a[120:123], v[128:131], v[160:163]
ds_read_b128 a[148:151], v3 offset:36864
ds_read_b128 a[152:155], v3 offset:45056
M v[164:167], a[120:123], v[132:135], v[164:167]
v_exp_f32 v33, v33
M v[164:167], a[116:119], v[100:103], v[164:167]
buffer_load_dwordx4 v1, s[12:15], s25 offen offset:0 sc1 lds
s_add_u32 s32, s25, 4096
M v[168:171], a[116:119], v[104:107], v[168:171]
v_exp_f32 v34, v34
M v[168:171], a[120:123], v[136:139], v[168:171]
v_cvt_pk_bf16_f32 v32, v32, v33
M v[172:175], a[120:123], v[140:143], v[172:175]
v_exp_f32 v35, v35
M v[172:175], a[116:119], v[108:111], v[172:175]
buffer_load_dwordx4 v1, s[12:15], s25 offen offset:1024 sc1 lds
s_waitcnt lgkmcnt(6)
M a[96:99], a[112:115], v[96:99], a[96:99]
M a[96:99], a[112:115], v[128:131], a[96:99]
M v[176:179], a[124:127], v[96:99], v[176:179]
v_exp_f32 v48, v48
M v[176:179], a[128:131], v[128:131], v[176:179]
ds_read_b128 a[156:159], v3 offset:37888
ds_read_b128 a[160:163], v3 offset:46080
M v[180:183], a[128:131], v[132:135], v[180:183]
v_exp_f32 v49, v49
M v[180:183], a[124:127], v[100:103], v[180:183]
buffer_load_dwordx4 v1, s[12:15], s25 offen offset:2048 sc1 lds
M v[184:187], a[124:127], v[104:107], v[184:187]
v_exp_f32 v50, v50
M v[184:187], a[128:131], v[136:139], v[184:187]
v_cvt_pk_bf16_f32 v33, v34, v35
v_cvt_pk_bf16_f32 v34, v48, v49
M v[188:191], a[128:131], v[140:143], v[188:191]
v_exp_f32 v51, v51
M v[188:191], a[124:127], v[108:111], v[188:191]
buffer_load_dwordx4 v1, s[12:15], s25 offen offset:3072 sc1 lds
s_add_u32 m0, s29, 69632
s_waitcnt lgkmcnt(6)
M a[100:103], a[112:115], v[100:103], a[100:103]
M a[100:103], a[112:115], v[132:135], a[100:103]
M v[192:195], a[132:135], v[96:99], v[192:195]
v_exp_f32 v36, v36
M v[192:195], a[136:139], v[128:131], v[192:195]
ds_read_b128 a[164:167], v3 offset:38912
ds_read_b128 a[168:171], v3 offset:47104
M v[196:199], a[136:139], v[132:135], v[196:199]
v_exp_f32 v37, v37
M v[196:199], a[132:135], v[100:103], v[196:199]
buffer_load_dwordx4 v1, s[12:15], s32 offen offset:0 sc1 lds
M v[200:203], a[132:135], v[104:107], v[200:203]
v_exp_f32 v38, v38
M v[200:203], a[136:139], v[136:139], v[200:203]
v_cvt_pk_bf16_f32 v35, v50, v51
v_cvt_pk_bf16_f32 v36, v36, v37
M v[204:207], a[136:139], v[140:143], v[204:207]
v_exp_f32 v39, v39
M v[204:207], a[132:135], v[108:111], v[204:207]
buffer_load_dwordx4 v1, s[12:15], s32 offen offset:1024 sc1 lds
s_waitcnt lgkmcnt(6)
M a[104:107], a[112:115], v[104:107], a[104:107]
M a[104:107], a[112:115], v[136:139], a[104:107]
M v[208:211], a[140:143], v[96:99], v[208:211]
v_exp_f32 v52, v52
M v[208:211], a[144:147], v[128:131], v[208:211]
ds_read_b128 a[172:175], v3 offset:39936
ds_read_b128 a[176:179], v3 offset:48128
M v[212:215], a[144:147], v[132:135], v[212:215]
v_exp_f32 v53, v53
M v[212:215], a[140:143], v[100:103], v[212:215]
buffer_load_dwordx4 v1, s[12:15], s32 offen offset:2048 sc1 lds
M v[216:219], a[140:143], v[104:107], v[216:219]
v_exp_f32 v54, v54
M v[216:219], a[144:147], v[136:139], v[216:219]
v_cvt_pk_bf16_f32 v37, v38, v39
v_cvt_pk_bf16_f32 v38, v52, v53
M v[220:223], a[144:147], v[140:143], v[220:223]
v_exp_f32 v55, v55
M v[220:223], a[140:143], v[108:111], v[220:223]
buffer_load_dwordx4 v1, s[12:15], s32 offen offset:3072 sc1 lds
s_waitcnt lgkmcnt(6)
M a[108:111], a[112:115], v[108:111], a[108:111]
M a[108:111], a[112:115], v[140:143], a[108:111]
M v[224:227], a[148:151], v[96:99], v[224:227]
v_exp_f32 v40, v40
M v[224:227], a[152:155], v[128:131], v[224:227]
s_add_u32 s25, s25, 32768
s_cmp_eq_u32 s25, s27
s_cselect_b32 s25, s28, s25
s_cselect_b32 s27, -1, s27
M v[228:231], a[152:155], v[132:135], v[228:231]
v_exp_f32 v41, v41
M v[228:231], a[148:151], v[100:103], v[228:231]
v_cvt_pk_bf16_f32 v39, v54, v55
v_cvt_pk_bf16_f32 v40, v40, v41
M v[232:235], a[148:151], v[104:107], v[232:235]
v_exp_f32 v42, v42
M v[232:235], a[152:155], v[136:139], v[232:235]
M v[236:239], a[152:155], v[140:143], v[236:239]
v_exp_f32 v43, v43
M v[236:239], a[148:151], v[108:111], v[236:239]
v_cvt_pk_bf16_f32 v41, v42, v43
s_waitcnt lgkmcnt(4)
M v[240:243], a[156:159], v[96:99], v[240:243]
v_exp_f32 v56, v56
M v[240:243], a[160:163], v[128:131], v[240:243]
M v[244:247], a[160:163], v[132:135], v[244:247]
v_exp_f32 v57, v57
M v[244:247], a[156:159], v[100:103], v[244:247]
v_cvt_pk_bf16_f32 v42, v56, v57
M v[248:251], a[156:159], v[104:107], v[248:251]
v_exp_f32 v58, v58
M v[248:251], a[160:163], v[136:139], v[248:251]
s_waitcnt vmcnt(16) lgkmcnt(0)
s_barrier
ds_read_b128 a[116:119], v2 offset:0
ds_read_b128 a[120:123], v2 offset:1024
ds_read_b128 a[124:127], v2 offset:2048
ds_read_b128 a[128:131], v2 offset:3072
M v[252:255], a[160:163], v[140:143], v[252:255]
v_exp_f32 v59, v59
M v[252:255], a[156:159], v[108:111], v[252:255]
v_cvt_pk_bf16_f32 v43, v58, v59
M a[64:67], a[164:167], v[96:99], a[64:67]
v_exp_f32 v44, v44
M a[64:67], a[168:171], v[128:131], a[64:67]
ds_read_b128 a[132:135], v2 offset:4096
ds_read_b128 a[136:139], v2 offset:5120
M a[68:71], a[168:171], v[132:135], a[68:71]
v_exp_f32 v45, v45
M a[68:71], a[164:167], v[100:103], a[68:71]
v_cvt_pk_bf16_f32 v44, v44, v45
M a[72:75], a[164:167], v[104:107], a[72:75]
v_exp_f32 v46, v46
M a[72:75], a[168:171], v[136:139], a[72:75]
M a[76:79], a[168:171], v[140:143], a[76:79]
v_exp_f32 v47, v47
M a[76:79], a[164:167], v[108:111], a[76:79]
v_cvt_pk_bf16_f32 v45, v46, v47
M a[80:83], a[172:175], v[96:99], a[80:83]
v_exp_f32 v60, v60
M a[80:83], a[176:179], v[128:131], a[80:83]
ds_read_b128 a[140:143], v2 offset:6144
ds_read_b128 a[144:147], v2 offset:7168
M a[84:87], a[176:179], v[132:135], a[84:87]
v_exp_f32 v61, v61
M a[84:87], a[172:175], v[100:103], a[84:87]
v_cvt_pk_bf16_f32 v46, v60, v61
M a[88:91], a[172:175], v[104:107], a[88:91]
v_exp_f32 v62, v62
M a[88:91], a[176:179], v[136:139], a[88:91]
M a[92:95], a[176:179], v[140:143], a[92:95]
v_exp_f32 v63, v63
M a[92:95], a[172:175], v[108:111], a[92:95]
v_cvt_pk_bf16_f32 v47, v62, v63
s_branch Lk2_l1
Lk2_m1:
s_lshl_b32 s33, s23, 6
s_add_i32 s33, s33, 0
s_cmp_gt_i32 s33, 0
s_cselect_b32 s34, 0, 0xf149f2ca
s_cmp_lt_i32 s33, 0
s_cselect_b32 s33, 0xf149f2ca, 0
v_mov_b32 v20, s34
v_mov_b32 v21, s34
v_mov_b32 v22, s34
v_mov_b32 v23, s34
v_mov_b32 v28, s33
v_mov_b32 v29, s33
v_mov_b32 v30, s33
v_mov_b32 v31, s33
v_med3_f32 v24, v16, v20, v28
v_med3_f32 v25, v17, v20, v28
v_med3_f32 v26, v18, v20, v28
v_med3_f32 v27, v19, v20, v28
s_waitcnt lgkmcnt(4)
s_add_u32 m0, s29, 32768
M v[32:35], a[116:119], a[0:3], v[24:27]
v_exp_f32 v128, v128
M v[32:35], a[120:123], a[4:7], v[32:35]
ds_read_b128 a[148:151], v3 offset:8192
ds_read_b128 a[152:155], v3 offset:9216
M v[32:35], a[124:127], a[8:11], v[32:35]
v_exp_f32 v129, v129
M v[32:35], a[128:131], a[12:15], v[32:35]
buffer_load_dwordx4 v1, s[12:15], s26 offen offset:0 sc1 lds
s_add_u32 s32, s26, 4096
M v[36:39], a[128:131], a[28:31], v[28:31]
v_exp_f32 v130, v130
M v[36:39], a[124:127], a[24:27], v[36:39]
v_cvt_pk_bf16_f32 v128, v128, v129
M v[36:39], a[120:123], a[20:23], v[36:39]
v_exp_f32 v131, v131
M v[36:39], a[116:119], a[16:19], v[36:39]
buffer_load_dwordx4 v1, s[12:15], s26 offen offset:1024 sc1 lds
M v[40:43], a[116:119], a[32:35], v[28:31]
v_exp_f32 v144, v144
M v[40:43], a[120:123], a[36:39], v[40:43]
ds_read_b128 a[156:159], v3 offset:10240
ds_read_b128 a[160:163], v3 offset:11264
M v[40:43], a[124:127], a[40:43], v[40:43]
v_exp_f32 v145, v145
M v[40:43], a[128:131], a[44:47], v[40:43]
buffer_load_dwordx4 v1, s[12:15], s26 offen offset:2048 sc1 lds
M v[44:47], a[128:131], a[60:63], v[28:31]
v_exp_f32 v146, v146
M v[44:47], a[124:127], a[56:59], v[44:47]
v_cvt_pk_bf16_f32 v129, v130, v131
v_cvt_pk_bf16_f32 v130, v144, v145
M v[44:47], a[120:123], a[52:55], v[44:47]
v_exp_f32 v147, v147
M v[44:47], a[116:119], a[48:51], v[44:47]
buffer_load_dwordx4 v1, s[12:15], s26 offen offset:3072 sc1 lds
s_add_u32 m0, s29, 36864
s_waitcnt lgkmcnt(4)
M v[48:51], a[132:135], a[0:3], v[20:23]
v_exp_f32 v132, v132
M v[48:51], a[136:139], a[4:7], v[48:51]
ds_read_b128 a[164:167], v3 offset:12288
ds_read_b128 a[168:171], v3 offset:13312
M v[48:51], a[140:143], a[8:11], v[48:51]
v_exp_f32 v133, v133
M v[48:51], a[144:147], a[12:15], v[48:51]
buffer_load_dwordx4 v1, s[12:15], s32 offen offset:0 sc1 lds
M v[52:55], a[144:147], a[28:31], v[24:27]
v_exp_f32 v134, v134
M v[52:55], a[140:143], a[24:27], v[52:55]
v_cvt_pk_bf16_f32 v131, v146, v147
v_cvt_pk_bf16_f32 v132, v132, v133
M v[52:55], a[136:139], a[20:23], v[52:55]
v_exp_f32 v135, v135
M v[52:55], a[132:135], a[16:19], v[52:55]
buffer_load_dwordx4 v1, s[12:15], s32 offen offset:1024 sc1 lds
M v[56:59], a[132:135], a[32:35], v[28:31]
v_exp_f32 v148, v148
M v[56:59], a[136:139], a[36:39], v[56:59]
ds_read_b128 a[172:175], v3 offset:14336
ds_read_b128 a[176:179], v3 offset:15360
M v[56:59], a[140:143], a[40:43], v[56:59]
v_exp_f32 v149, v149
M v[56:59], a[144:147], a[44:47], v[56:59]
buffer_load_dwordx4 v1, s[12:15], s32 offen offset:2048 sc1 lds
M v[60:63], a[144:147], a[60:63], v[28:31]
v_exp_f32 v150, v150
M v[60:63], a[140:143], a[56:59], v[60:63]
v_cvt_pk_bf16_f32 v133, v134, v135
v_cvt_pk_bf16_f32 v134, v148, v149
M v[60:63], a[136:139], a[52:55], v[60:63]
v_exp_f32 v151, v151
M v[60:63], a[132:135], a[48:51], v[60:63]
buffer_load_dwordx4 v1, s[12:15], s32 offen offset:3072 sc1 lds
s_waitcnt lgkmcnt(4)
M v[64:67], a[148:151], a[0:3], v[20:23]
v_exp_f32 v136, v136
M v[64:67], a[152:155], a[4:7], v[64:67]
s_add_u32 s26, s26, 32768
s_cmp_eq_u32 s26, s62
s_cselect_b32 s26, s63, s26
s_cselect_b32 s62, -1, s62
M v[64:67], a[156:159], a[8:11], v[64:67]
v_exp_f32 v137, v137
M v[64:67], a[160:163], a[12:15], v[64:67]
v_cvt_pk_bf16_f32 v135, v150, v151
v_cvt_pk_bf16_f32 v136, v136, v137
M v[68:71], a[160:163], a[28:31], v[20:23]
v_exp_f32 v138, v138
M v[68:71], a[156:159], a[24:27], v[68:71]
M v[68:71], a[152:155], a[20:23], v[68:71]
v_exp_f32 v139, v139
M v[68:71], a[148:151], a[16:19], v[68:71]
v_cvt_pk_bf16_f32 v137, v138, v139
M v[72:75], a[148:151], a[32:35], v[24:27]
v_exp_f32 v152, v152
M v[72:75], a[152:155], a[36:39], v[72:75]
M v[72:75], a[156:159], a[40:43], v[72:75]
v_exp_f32 v153, v153
M v[72:75], a[160:163], a[44:47], v[72:75]
v_cvt_pk_bf16_f32 v138, v152, v153
M v[76:79], a[160:163], a[60:63], v[28:31]
v_exp_f32 v154, v154
M v[76:79], a[156:159], a[56:59], v[76:79]
s_waitcnt vmcnt(16) lgkmcnt(0)
s_barrier
ds_read_b128 a[116:119], v3 offset:32768
ds_read_b128 a[120:123], v3 offset:40960
ds_read_b128 a[124:127], v3 offset:33792
ds_read_b128 a[128:131], v3 offset:41984
M v[76:79], a[152:155], a[52:55], v[76:79]
v_exp_f32 v155, v155
M v[76:79], a[148:151], a[48:51], v[76:79]
v_cvt_pk_bf16_f32 v139, v154, v155
M v[80:83], a[164:167], a[0:3], v[20:23]
v_exp_f32 v140, v140
M v[80:83], a[168:171], a[4:7], v[80:83]
ds_read_b128 a[132:135], v3 offset:34816
ds_read_b128 a[136:139], v3 offset:43008
M v[80:83], a[172:175], a[8:11], v[80:83]
v_exp_f32 v141, v141
M v[80:83], a[176:179], a[12:15], v[80:83]
v_cvt_pk_bf16_f32 v140, v140, v141
M v[84:87], a[176:179], a[28:31], v[20:23]
v_exp_f32 v142, v142
M v[84:87], a[172:175], a[24:27], v[84:87]
M v[84:87], a[168:171], a[20:23], v[84:87]
v_exp_f32 v143, v143
M v[84:87], a[164:167], a[16:19], v[84:87]
v_cvt_pk_bf16_f32 v141, v142, v143
M v[88:91], a[164:167], a[32:35], v[20:23]
v_exp_f32 v156, v156
M v[88:91], a[168:171], a[36:39], v[88:91]
ds_read_b128 a[140:143], v3 offset:35840
ds_read_b128 a[144:147], v3 offset:44032
M v[88:91], a[172:175], a[40:43], v[88:91]
v_exp_f32 v157, v157
M v[88:91], a[176:179], a[44:47], v[88:91]
v_cvt_pk_bf16_f32 v142, v156, v157
M v[92:95], a[176:179], a[60:63], v[24:27]
v_exp_f32 v158, v158
M v[92:95], a[172:175], a[56:59], v[92:95]
M v[92:95], a[168:171], a[52:55], v[92:95]
v_exp_f32 v159, v159
M v[92:95], a[164:167], a[48:51], v[92:95]
v_cvt_pk_bf16_f32 v143, v158, v159
s_waitcnt lgkmcnt(6)
s_add_u32 m0, s29, 65536
M v[160:163], a[116:119], v[96:99], v[160:163]
v_exp_f32 v32, v32
M v[160:163], a[120:123], v[128:131], v[160:163]
ds_read_b128 a[148:151], v3 offset:36864
ds_read_b128 a[152:155], v3 offset:45056
M v[164:167], a[120:123], v[132:135], v[164:167]
v_exp_f32 v33, v33
M v[164:167], a[116:119], v[100:103], v[164:167]
buffer_load_dwordx4 v1, s[12:15], s25 offen offset:0 sc1 lds
s_add_u32 s32, s25, 4096
M v[168:171], a[116:119], v[104:107], v[168:171]
v_exp_f32 v34, v34
M v[168:171], a[120:123], v[136:139], v[168:171]
v_cvt_pk_bf16_f32 v32, v32, v33
M v[172:175], a[120:123], v[140:143], v[172:175]
v_exp_f32 v35, v35
M v[172:175], a[116:119], v[108:111], v[172:175]
buffer_load_dwordx4 v1, s[12:15], s25 offen offset:1024 sc1 lds
s_waitcnt lgkmcnt(6)
M a[96:99], a[112:115], v[96:99], a[96:99]
M a[96:99], a[112:115], v[128:131], a[96:99]
M v[176:179], a[124:127], v[96:99], v[176:179]
v_exp_f32 v48, v48
M v[176:179], a[128:131], v[128:131], v[176:179]
ds_read_b128 a[156:159], v3 offset:37888
ds_read_b128 a[160:163], v3 offset:46080
M v[180:183], a[128:131], v[132:135], v[180:183]
v_exp_f32 v49, v49
M v[180:183], a[124:127], v[100:103], v[180:183]
buffer_load_dwordx4 v1, s[12:15], s25 offen offset:2048 sc1 lds
M v[184:187], a[124:127], v[104:107], v[184:187]
v_exp_f32 v50, v50
M v[184:187], a[128:131], v[136:139], v[184:187]
v_cvt_pk_bf16_f32 v33, v34, v35
v_cvt_pk_bf16_f32 v34, v48, v49
M v[188:191], a[128:131], v[140:143], v[188:191]
v_exp_f32 v51, v51
M v[188:191], a[124:127], v[108:111], v[188:191]
buffer_load_dwordx4 v1, s[12:15], s25 offen offset:3072 sc1 lds
s_add_u32 m0, s29, 69632
s_waitcnt lgkmcnt(6)
M a[100:103], a[112:115], v[100:103], a[100:103]
M a[100:103], a[112:115], v[132:135], a[100:103]
M v[192:195], a[132:135], v[96:99], v[192:195]
v_exp_f32 v36, v36
M v[192:195], a[136:139], v[128:131], v[192:195]
ds_read_b128 a[164:167], v3 offset:38912
ds_read_b128 a[168:171], v3 offset:47104
M v[196:199], a[136:139], v[132:135], v[196:199]
v_exp_f32 v37, v37
M v[196:199], a[132:135], v[100:103], v[196:199]
buffer_load_dwordx4 v1, s[12:15], s32 offen offset:0 sc1 lds
M v[200:203], a[132:135], v[104:107], v[200:203]
v_exp_f32 v38, v38
M v[200:203], a[136:139], v[136:139], v[200:203]
v_cvt_pk_bf16_f32 v35, v50, v51
v_cvt_pk_bf16_f32 v36, v36, v37
M v[204:207], a[136:139], v[140:143], v[204:207]
v_exp_f32 v39, v39
M v[204:207], a[132:135], v[108:111], v[204:207]
buffer_load_dwordx4 v1, s[12:15], s32 offen offset:1024 sc1 lds
s_waitcnt lgkmcnt(6)
M a[104:107], a[112:115], v[104:107], a[104:107]
M a[104:107], a[112:115], v[136:139], a[104:107]
M v[208:211], a[140:143], v[96:99], v[208:211]
v_exp_f32 v52, v52
M v[208:211], a[144:147], v[128:131], v[208:211]
ds_read_b128 a[172:175], v3 offset:39936
ds_read_b128 a[176:179], v3 offset:48128
M v[212:215], a[144:147], v[132:135], v[212:215]
v_exp_f32 v53, v53
M v[212:215], a[140:143], v[100:103], v[212:215]
buffer_load_dwordx4 v1, s[12:15], s32 offen offset:2048 sc1 lds
M v[216:219], a[140:143], v[104:107], v[216:219]
v_exp_f32 v54, v54
M v[216:219], a[144:147], v[136:139], v[216:219]
v_cvt_pk_bf16_f32 v37, v38, v39
v_cvt_pk_bf16_f32 v38, v52, v53
M v[220:223], a[144:147], v[140:143], v[220:223]
v_exp_f32 v55, v55
M v[220:223], a[140:143], v[108:111], v[220:223]
buffer_load_dwordx4 v1, s[12:15], s32 offen offset:3072 sc1 lds
s_waitcnt lgkmcnt(6)
M a[108:111], a[112:115], v[108:111], a[108:111]
M a[108:111], a[112:115], v[140:143], a[108:111]
M v[224:227], a[148:151], v[96:99], v[224:227]
v_exp_f32 v40, v40
M v[224:227], a[152:155], v[128:131], v[224:227]
s_add_u32 s25, s25, 32768
s_cmp_eq_u32 s25, s27
s_cselect_b32 s25, s28, s25
s_cselect_b32 s27, -1, s27
M v[228:231], a[152:155], v[132:135], v[228:231]
v_exp_f32 v41, v41
M v[228:231], a[148:151], v[100:103], v[228:231]
v_cvt_pk_bf16_f32 v39, v54, v55
v_cvt_pk_bf16_f32 v40, v40, v41
M v[232:235], a[148:151], v[104:107], v[232:235]
v_exp_f32 v42, v42
M v[232:235], a[152:155], v[136:139], v[232:235]
M v[236:239], a[152:155], v[140:143], v[236:239]
v_exp_f32 v43, v43
M v[236:239], a[148:151], v[108:111], v[236:239]
v_cvt_pk_bf16_f32 v41, v42, v43
s_waitcnt lgkmcnt(4)
M v[240:243], a[156:159], v[96:99], v[240:243]
v_exp_f32 v56, v56
M v[240:243], a[160:163], v[128:131], v[240:243]
M v[244:247], a[160:163], v[132:135], v[244:247]
v_exp_f32 v57, v57
M v[244:247], a[156:159], v[100:103], v[244:247]
v_cvt_pk_bf16_f32 v42, v56, v57
M v[248:251], a[156:159], v[104:107], v[248:251]
v_exp_f32 v58, v58
M v[248:251], a[160:163], v[136:139], v[248:251]
s_waitcnt vmcnt(16) lgkmcnt(0)
s_barrier
ds_read_b128 a[116:119], v2 offset:0
ds_read_b128 a[120:123], v2 offset:1024
ds_read_b128 a[124:127], v2 offset:2048
ds_read_b128 a[128:131], v2 offset:3072
M v[252:255], a[160:163], v[140:143], v[252:255]
v_exp_f32 v59, v59
M v[252:255], a[156:159], v[108:111], v[252:255]
v_cvt_pk_bf16_f32 v43, v58, v59
M a[64:67], a[164:167], v[96:99], a[64:67]
v_exp_f32 v44, v44
M a[64:67], a[168:171], v[128:131], a[64:67]
ds_read_b128 a[132:135], v2 offset:4096
ds_read_b128 a[136:139], v2 offset:5120
M a[68:71], a[168:171], v[132:135], a[68:71]
v_exp_f32 v45, v45
M a[68:71], a[164:167], v[100:103], a[68:71]
v_cvt_pk_bf16_f32 v44, v44, v45
M a[72:75], a[164:167], v[104:107], a[72:75]
v_exp_f32 v46, v46
M a[72:75], a[168:171], v[136:139], a[72:75]
M a[76:79], a[168:171], v[140:143], a[76:79]
v_exp_f32 v47, v47
M a[76:79], a[164:167], v[108:111], a[76:79]
v_cvt_pk_bf16_f32 v45, v46, v47
M a[80:83], a[172:175], v[96:99], a[80:83]
v_exp_f32 v60, v60
M a[80:83], a[176:179], v[128:131], a[80:83]
ds_read_b128 a[140:143], v2 offset:6144
ds_read_b128 a[144:147], v2 offset:7168
M a[84:87], a[176:179], v[132:135], a[84:87]
v_exp_f32 v61, v61
M a[84:87], a[172:175], v[100:103], a[84:87]
v_cvt_pk_bf16_f32 v46, v60, v61
M a[88:91], a[172:175], v[104:107], a[88:91]
v_exp_f32 v62, v62
M a[88:91], a[176:179], v[136:139], a[88:91]
M a[92:95], a[176:179], v[140:143], a[92:95]
v_exp_f32 v63, v63
M a[92:95], a[172:175], v[108:111], a[92:95]
v_cvt_pk_bf16_f32 v47, v62, v63
Lk2_m2:
s_sub_u32 s35, 15, s21
s_lshl_b32 s33, s20, 7
s_lshl_b32 s34, s35, 3
s_add_u32 s33, s33, s34
s_lshl_b32 s34, s23, 2
s_add_u32 s33, s33, s34
s_lshl_b32 s33, s33, 12
buffer_load_dwordx4 a[180:183], v1, s[8:11], s33 offen offset:0 sc1
buffer_load_dwordx4 a[184:187], v1, s[8:11], s33 offen offset:1024 sc1
buffer_load_dwordx4 a[188:191], v1, s[8:11], s33 offen offset:2048 sc1
buffer_load_dwordx4 a[192:195], v1, s[8:11], s33 offen offset:3072 sc1
s_add_u32 s33, s33, 4096
buffer_load_dwordx4 a[196:199], v1, s[8:11], s33 offen offset:0 sc1
buffer_load_dwordx4 a[200:203], v1, s[8:11], s33 offen offset:1024 sc1
buffer_load_dwordx4 a[204:207], v1, s[8:11], s33 offen offset:2048 sc1
buffer_load_dwordx4 a[208:211], v1, s[8:11], s33 offen offset:3072 sc1
s_add_u32 s33, s33, 4096
buffer_load_dwordx4 a[212:215], v1, s[8:11], s33 offen offset:0 sc1
buffer_load_dwordx4 a[216:219], v1, s[8:11], s33 offen offset:1024 sc1
buffer_load_dwordx4 a[220:223], v1, s[8:11], s33 offen offset:2048 sc1
buffer_load_dwordx4 a[224:227], v1, s[8:11], s33 offen offset:3072 sc1
s_add_u32 s33, s33, 4096
buffer_load_dwordx4 a[228:231], v1, s[8:11], s33 offen offset:0 sc1
buffer_load_dwordx4 a[232:235], v1, s[8:11], s33 offen offset:1024 sc1
buffer_load_dwordx4 a[236:239], v1, s[8:11], s33 offen offset:2048 sc1
buffer_load_dwordx4 a[240:243], v1, s[8:11], s33 offen offset:3072 sc1
s_lshl_b32 s33, s23, 6
s_add_i32 s33, s33, -64
s_cmp_gt_i32 s33, 0
s_cselect_b32 s34, 0, 0xf149f2ca
s_cmp_lt_i32 s33, 0
s_cselect_b32 s33, 0xf149f2ca, 0
v_mov_b32 v20, s34
v_mov_b32 v21, s34
v_mov_b32 v22, s34
v_mov_b32 v23, s34
v_mov_b32 v28, s33
v_mov_b32 v29, s33
v_mov_b32 v30, s33
v_mov_b32 v31, s33
v_med3_f32 v24, v16, v20, v28
v_med3_f32 v25, v17, v20, v28
v_med3_f32 v26, v18, v20, v28
v_med3_f32 v27, v19, v20, v28
s_waitcnt lgkmcnt(4)
s_add_u32 m0, s29, 98304
M v[96:99], a[116:119], a[0:3], v[24:27]
v_exp_f32 v64, v64
M v[96:99], a[120:123], a[4:7], v[96:99]
ds_read_b128 a[148:151], v2 offset:8192
ds_read_b128 a[152:155], v2 offset:9216
M v[96:99], a[124:127], a[8:11], v[96:99]
v_exp_f32 v65, v65
M v[96:99], a[128:131], a[12:15], v[96:99]
buffer_load_dwordx4 v1, s[12:15], s26 offen offset:0 sc1 lds
s_add_u32 s32, s26, 4096
M v[100:103], a[128:131], a[28:31], v[28:31]
v_exp_f32 v66, v66
M v[100:103], a[124:127], a[24:27], v[100:103]
v_cvt_pk_bf16_f32 v64, v64, v65
M v[100:103], a[120:123], a[20:23], v[100:103]
v_exp_f32 v67, v67
M v[100:103], a[116:119], a[16:19], v[100:103]
buffer_load_dwordx4 v1, s[12:15], s26 offen offset:1024 sc1 lds
M v[104:107], a[116:119], a[32:35], v[28:31]
v_exp_f32 v80, v80
M v[104:107], a[120:123], a[36:39], v[104:107]
ds_read_b128 a[156:159], v2 offset:10240
ds_read_b128 a[160:163], v2 offset:11264
M v[104:107], a[124:127], a[40:43], v[104:107]
v_exp_f32 v81, v81
M v[104:107], a[128:131], a[44:47], v[104:107]
buffer_load_dwordx4 v1, s[12:15], s26 offen offset:2048 sc1 lds
M v[108:111], a[128:131], a[60:63], v[28:31]
v_exp_f32 v82, v82
M v[108:111], a[124:127], a[56:59], v[108:111]
v_cvt_pk_bf16_f32 v65, v66, v67
v_cvt_pk_bf16_f32 v66, v80, v81
M v[108:111], a[120:123], a[52:55], v[108:111]
v_exp_f32 v83, v83
M v[108:111], a[116:119], a[48:51], v[108:111]
buffer_load_dwordx4 v1, s[12:15], s26 offen offset:3072 sc1 lds
s_add_u32 m0, s29, 102400
s_waitcnt lgkmcnt(4)
M v[112:115], a[132:135], a[0:3], v[20:23]
v_exp_f32 v68, v68
M v[112:115], a[136:139], a[4:7], v[112:115]
ds_read_b128 a[164:167], v2 offset:12288
ds_read_b128 a[168:171], v2 offset:13312
M v[112:115], a[140:143], a[8:11], v[112:115]
v_exp_f32 v69, v69
M v[112:115], a[144:147], a[12:15], v[112:115]
buffer_load_dwordx4 v1, s[12:15], s32 offen offset:0 sc1 lds
M v[116:119], a[144:147], a[28:31], v[24:27]
v_exp_f32 v70, v70
M v[116:119], a[140:143], a[24:27], v[116:119]
v_cvt_pk_bf16_f32 v67, v82, v83
v_cvt_pk_bf16_f32 v68, v68, v69
M v[116:119], a[136:139], a[20:23], v[116:119]
v_exp_f32 v71, v71
M v[116:119], a[132:135], a[16:19], v[116:119]
buffer_load_dwordx4 v1, s[12:15], s32 offen offset:1024 sc1 lds
M v[120:123], a[132:135], a[32:35], v[28:31]
v_exp_f32 v84, v84
M v[120:123], a[136:139], a[36:39], v[120:123]
ds_read_b128 a[172:175], v2 offset:14336
ds_read_b128 a[176:179], v2 offset:15360
M v[120:123], a[140:143], a[40:43], v[120:123]
v_exp_f32 v85, v85
M v[120:123], a[144:147], a[44:47], v[120:123]
buffer_load_dwordx4 v1, s[12:15], s32 offen offset:2048 sc1 lds
M v[124:127], a[144:147], a[60:63], v[28:31]
v_exp_f32 v86, v86
M v[124:127], a[140:143], a[56:59], v[124:127]
v_cvt_pk_bf16_f32 v69, v70, v71
v_cvt_pk_bf16_f32 v70, v84, v85
M v[124:127], a[136:139], a[52:55], v[124:127]
v_exp_f32 v87, v87
M v[124:127], a[132:135], a[48:51], v[124:127]
buffer_load_dwordx4 v1, s[12:15], s32 offen offset:3072 sc1 lds
s_waitcnt lgkmcnt(4)
M v[128:131], a[148:151], a[0:3], v[20:23]
v_exp_f32 v72, v72
M v[128:131], a[152:155], a[4:7], v[128:131]
s_add_u32 s26, s26, 32768
s_cmp_eq_u32 s26, s62
s_cselect_b32 s26, s63, s26
s_cselect_b32 s62, -1, s62
M v[128:131], a[156:159], a[8:11], v[128:131]
v_exp_f32 v73, v73
M v[128:131], a[160:163], a[12:15], v[128:131]
v_cvt_pk_bf16_f32 v71, v86, v87
v_cvt_pk_bf16_f32 v72, v72, v73
M v[132:135], a[160:163], a[28:31], v[20:23]
v_exp_f32 v74, v74
M v[132:135], a[156:159], a[24:27], v[132:135]
M v[132:135], a[152:155], a[20:23], v[132:135]
v_exp_f32 v75, v75
M v[132:135], a[148:151], a[16:19], v[132:135]
v_cvt_pk_bf16_f32 v73, v74, v75
M v[136:139], a[148:151], a[32:35], v[24:27]
v_exp_f32 v88, v88
M v[136:139], a[152:155], a[36:39], v[136:139]
M v[136:139], a[156:159], a[40:43], v[136:139]
v_exp_f32 v89, v89
M v[136:139], a[160:163], a[44:47], v[136:139]
v_cvt_pk_bf16_f32 v74, v88, v89
M v[140:143], a[160:163], a[60:63], v[28:31]
v_exp_f32 v90, v90
M v[140:143], a[156:159], a[56:59], v[140:143]
s_waitcnt vmcnt(32) lgkmcnt(0)
s_barrier
ds_read_b128 a[116:119], v2 offset:32768
ds_read_b128 a[120:123], v2 offset:40960
ds_read_b128 a[124:127], v2 offset:33792
ds_read_b128 a[128:131], v2 offset:41984
M v[140:143], a[152:155], a[52:55], v[140:143]
v_exp_f32 v91, v91
M v[140:143], a[148:151], a[48:51], v[140:143]
v_cvt_pk_bf16_f32 v75, v90, v91
M v[144:147], a[164:167], a[0:3], v[20:23]
v_exp_f32 v76, v76
M v[144:147], a[168:171], a[4:7], v[144:147]
ds_read_b128 a[132:135], v2 offset:34816
ds_read_b128 a[136:139], v2 offset:43008
M v[144:147], a[172:175], a[8:11], v[144:147]
v_exp_f32 v77, v77
M v[144:147], a[176:179], a[12:15], v[144:147]
v_cvt_pk_bf16_f32 v76, v76, v77
M v[148:151], a[176:179], a[28:31], v[20:23]
v_exp_f32 v78, v78
M v[148:151], a[172:175], a[24:27], v[148:151]
M v[148:151], a[168:171], a[20:23], v[148:151]
v_exp_f32 v79, v79
M v[148:151], a[164:167], a[16:19], v[148:151]
v_cvt_pk_bf16_f32 v77, v78, v79
M v[152:155], a[164:167], a[32:35], v[20:23]
v_exp_f32 v92, v92
M v[152:155], a[168:171], a[36:39], v[152:155]
ds_read_b128 a[140:143], v2 offset:35840
ds_read_b128 a[144:147], v2 offset:44032
M v[152:155], a[172:175], a[40:43], v[152:155]
v_exp_f32 v93, v93
M v[152:155], a[176:179], a[44:47], v[152:155]
v_cvt_pk_bf16_f32 v78, v92, v93
M v[156:159], a[176:179], a[60:63], v[24:27]
v_exp_f32 v94, v94
M v[156:159], a[172:175], a[56:59], v[156:159]
M v[156:159], a[168:171], a[52:55], v[156:159]
v_exp_f32 v95, v95
M v[156:159], a[164:167], a[48:51], v[156:159]
v_cvt_pk_bf16_f32 v79, v94, v95
s_waitcnt lgkmcnt(6)
s_add_u32 m0, s29, 0
M v[160:163], a[116:119], v[32:35], v[160:163]
v_exp_f32 v96, v96
M v[160:163], a[120:123], v[64:67], v[160:163]
ds_read_b128 a[148:151], v2 offset:36864
ds_read_b128 a[152:155], v2 offset:45056
M v[164:167], a[120:123], v[68:71], v[164:167]
v_exp_f32 v97, v97
M v[164:167], a[116:119], v[36:39], v[164:167]
buffer_load_dwordx4 v1, s[12:15], s25 offen offset:0 sc1 lds
s_add_u32 s32, s25, 4096
M v[168:171], a[116:119], v[40:43], v[168:171]
v_exp_f32 v98, v98
M v[168:171], a[120:123], v[72:75], v[168:171]
v_cvt_pk_bf16_f32 v96, v96, v97
M v[172:175], a[120:123], v[76:79], v[172:175]
v_exp_f32 v99, v99
M v[172:175], a[116:119], v[44:47], v[172:175]
buffer_load_dwordx4 v1, s[12:15], s25 offen offset:1024 sc1 lds
s_waitcnt lgkmcnt(6)
M a[96:99], a[112:115], v[32:35], a[96:99]
M a[96:99], a[112:115], v[64:67], a[96:99]
M v[176:179], a[124:127], v[32:35], v[176:179]
v_exp_f32 v112, v112
M v[176:179], a[128:131], v[64:67], v[176:179]
ds_read_b128 a[156:159], v2 offset:37888
ds_read_b128 a[160:163], v2 offset:46080
M v[180:183], a[128:131], v[68:71], v[180:183]
v_exp_f32 v113, v113
M v[180:183], a[124:127], v[36:39], v[180:183]
buffer_load_dwordx4 v1, s[12:15], s25 offen offset:2048 sc1 lds
M v[184:187], a[124:127], v[40:43], v[184:187]
v_exp_f32 v114, v114
M v[184:187], a[128:131], v[72:75], v[184:187]
v_cvt_pk_bf16_f32 v97, v98, v99
v_cvt_pk_bf16_f32 v98, v112, v113
M v[188:191], a[128:131], v[76:79], v[188:191]
v_exp_f32 v115, v115
M v[188:191], a[124:127], v[44:47], v[188:191]
buffer_load_dwordx4 v1, s[12:15], s25 offen offset:3072 sc1 lds
s_add_u32 m0, s29, 4096
s_waitcnt lgkmcnt(6)
M a[100:103], a[112:115], v[36:39], a[100:103]
M a[100:103], a[112:115], v[68:71], a[100:103]
M v[192:195], a[132:135], v[32:35], v[192:195]
v_exp_f32 v100, v100
M v[192:195], a[136:139], v[64:67], v[192:195]
ds_read_b128 a[164:167], v2 offset:38912
ds_read_b128 a[168:171], v2 offset:47104
M v[196:199], a[136:139], v[68:71], v[196:199]
v_exp_f32 v101, v101
M v[196:199], a[132:135], v[36:39], v[196:199]
buffer_load_dwordx4 v1, s[12:15], s32 offen offset:0 sc1 lds
M v[200:203], a[132:135], v[40:43], v[200:203]
v_exp_f32 v102, v102
M v[200:203], a[136:139], v[72:75], v[200:203]
v_cvt_pk_bf16_f32 v99, v114, v115
v_cvt_pk_bf16_f32 v100, v100, v101
M v[204:207], a[136:139], v[76:79], v[204:207]
v_exp_f32 v103, v103
M v[204:207], a[132:135], v[44:47], v[204:207]
buffer_load_dwordx4 v1, s[12:15], s32 offen offset:1024 sc1 lds
s_waitcnt lgkmcnt(6)
M a[104:107], a[112:115], v[40:43], a[104:107]
M a[104:107], a[112:115], v[72:75], a[104:107]
M v[208:211], a[140:143], v[32:35], v[208:211]
v_exp_f32 v116, v116
M v[208:211], a[144:147], v[64:67], v[208:211]
ds_read_b128 a[172:175], v2 offset:39936
ds_read_b128 a[176:179], v2 offset:48128
M v[212:215], a[144:147], v[68:71], v[212:215]
v_exp_f32 v117, v117
M v[212:215], a[140:143], v[36:39], v[212:215]
buffer_load_dwordx4 v1, s[12:15], s32 offen offset:2048 sc1 lds
M v[216:219], a[140:143], v[40:43], v[216:219]
v_exp_f32 v118, v118
M v[216:219], a[144:147], v[72:75], v[216:219]
v_cvt_pk_bf16_f32 v101, v102, v103
v_cvt_pk_bf16_f32 v102, v116, v117
M v[220:223], a[144:147], v[76:79], v[220:223]
v_exp_f32 v119, v119
M v[220:223], a[140:143], v[44:47], v[220:223]
buffer_load_dwordx4 v1, s[12:15], s32 offen offset:3072 sc1 lds
s_waitcnt lgkmcnt(6)
M a[108:111], a[112:115], v[44:47], a[108:111]
M a[108:111], a[112:115], v[76:79], a[108:111]
M v[224:227], a[148:151], v[32:35], v[224:227]
v_exp_f32 v104, v104
M v[224:227], a[152:155], v[64:67], v[224:227]
s_add_u32 s25, s25, 32768
s_cmp_eq_u32 s25, s27
s_cselect_b32 s25, s28, s25
s_cselect_b32 s27, -1, s27
M v[228:231], a[152:155], v[68:71], v[228:231]
v_exp_f32 v105, v105
M v[228:231], a[148:151], v[36:39], v[228:231]
v_cvt_pk_bf16_f32 v103, v118, v119
v_cvt_pk_bf16_f32 v104, v104, v105
M v[232:235], a[148:151], v[40:43], v[232:235]
v_exp_f32 v106, v106
M v[232:235], a[152:155], v[72:75], v[232:235]
M v[236:239], a[152:155], v[76:79], v[236:239]
v_exp_f32 v107, v107
M v[236:239], a[148:151], v[44:47], v[236:239]
v_cvt_pk_bf16_f32 v105, v106, v107
s_waitcnt lgkmcnt(4)
M v[240:243], a[156:159], v[32:35], v[240:243]
v_exp_f32 v120, v120
M v[240:243], a[160:163], v[64:67], v[240:243]
M v[244:247], a[160:163], v[68:71], v[244:247]
v_exp_f32 v121, v121
M v[244:247], a[156:159], v[36:39], v[244:247]
v_cvt_pk_bf16_f32 v106, v120, v121
M v[248:251], a[156:159], v[40:43], v[248:251]
v_exp_f32 v122, v122
M v[248:251], a[160:163], v[72:75], v[248:251]
s_waitcnt vmcnt(32) lgkmcnt(0)
s_barrier
ds_read_b128 a[116:119], v3 offset:0
ds_read_b128 a[120:123], v3 offset:1024
ds_read_b128 a[124:127], v3 offset:2048
ds_read_b128 a[128:131], v3 offset:3072
M v[252:255], a[160:163], v[76:79], v[252:255]
v_exp_f32 v123, v123
M v[252:255], a[156:159], v[44:47], v[252:255]
v_cvt_pk_bf16_f32 v107, v122, v123
M a[64:67], a[164:167], v[32:35], a[64:67]
v_exp_f32 v108, v108
M a[64:67], a[168:171], v[64:67], a[64:67]
ds_read_b128 a[132:135], v3 offset:4096
ds_read_b128 a[136:139], v3 offset:5120
M a[68:71], a[168:171], v[68:71], a[68:71]
v_exp_f32 v109, v109
M a[68:71], a[164:167], v[36:39], a[68:71]
v_cvt_pk_bf16_f32 v108, v108, v109
M a[72:75], a[164:167], v[40:43], a[72:75]
v_exp_f32 v110, v110
M a[72:75], a[168:171], v[72:75], a[72:75]
M a[76:79], a[168:171], v[76:79], a[76:79]
v_exp_f32 v111, v111
M a[76:79], a[164:167], v[44:47], a[76:79]
v_cvt_pk_bf16_f32 v109, v110, v111
M a[80:83], a[172:175], v[32:35], a[80:83]
v_exp_f32 v124, v124
M a[80:83], a[176:179], v[64:67], a[80:83]
ds_read_b128 a[140:143], v3 offset:6144
ds_read_b128 a[144:147], v3 offset:7168
M a[84:87], a[176:179], v[68:71], a[84:87]
v_exp_f32 v125, v125
M a[84:87], a[172:175], v[36:39], a[84:87]
v_cvt_pk_bf16_f32 v110, v124, v125
M a[88:91], a[172:175], v[40:43], a[88:91]
v_exp_f32 v126, v126
M a[88:91], a[176:179], v[72:75], a[88:91]
M a[92:95], a[176:179], v[76:79], a[92:95]
v_exp_f32 v127, v127
M a[92:95], a[172:175], v[44:47], a[92:95]
v_cvt_pk_bf16_f32 v111, v126, v127
s_waitcnt vmcnt(16)
s_waitcnt lgkmcnt(4)
s_add_u32 m0, s29, 32768
M v[32:35], a[116:119], a[180:183], 0
v_exp_f32 v128, v128
M v[32:35], a[120:123], a[184:187], v[32:35]
ds_read_b128 a[148:151], v3 offset:8192
ds_read_b128 a[152:155], v3 offset:9216
M v[32:35], a[124:127], a[188:191], v[32:35]
v_exp_f32 v129, v129
M v[32:35], a[128:131], a[192:195], v[32:35]
buffer_load_dwordx4 v1, s[12:15], s26 offen offset:0 sc1 lds
s_add_u32 s32, s26, 4096
M v[36:39], a[128:131], a[208:211], 0
v_exp_f32 v130, v130
M v[36:39], a[124:127], a[204:207], v[36:39]
v_cvt_pk_bf16_f32 v128, v128, v129
M v[36:39], a[120:123], a[200:203], v[36:39]
v_exp_f32 v131, v131
M v[36:39], a[116:119], a[196:199], v[36:39]
buffer_load_dwordx4 v1, s[12:15], s26 offen offset:1024 sc1 lds
M v[40:43], a[116:119], a[212:215], 0
v_exp_f32 v144, v144
M v[40:43], a[120:123], a[216:219], v[40:43]
ds_read_b128 a[156:159], v3 offset:10240
ds_read_b128 a[160:163], v3 offset:11264
M v[40:43], a[124:127], a[220:223], v[40:43]
v_exp_f32 v145, v145
M v[40:43], a[128:131], a[224:227], v[40:43]
buffer_load_dwordx4 v1, s[12:15], s26 offen offset:2048 sc1 lds
M v[44:47], a[128:131], a[240:243], 0
v_exp_f32 v146, v146
M v[44:47], a[124:127], a[236:239], v[44:47]
v_cvt_pk_bf16_f32 v129, v130, v131
v_cvt_pk_bf16_f32 v130, v144, v145
M v[44:47], a[120:123], a[232:235], v[44:47]
v_exp_f32 v147, v147
M v[44:47], a[116:119], a[228:231], v[44:47]
buffer_load_dwordx4 v1, s[12:15], s26 offen offset:3072 sc1 lds
s_add_u32 m0, s29, 36864
s_waitcnt lgkmcnt(4)
M v[48:51], a[132:135], a[180:183], 0
v_exp_f32 v132, v132
M v[48:51], a[136:139], a[184:187], v[48:51]
ds_read_b128 a[164:167], v3 offset:12288
ds_read_b128 a[168:171], v3 offset:13312
M v[48:51], a[140:143], a[188:191], v[48:51]
v_exp_f32 v133, v133
M v[48:51], a[144:147], a[192:195], v[48:51]
buffer_load_dwordx4 v1, s[12:15], s32 offen offset:0 sc1 lds
M v[52:55], a[144:147], a[208:211], 0
v_exp_f32 v134, v134
M v[52:55], a[140:143], a[204:207], v[52:55]
v_cvt_pk_bf16_f32 v131, v146, v147
v_cvt_pk_bf16_f32 v132, v132, v133
M v[52:55], a[136:139], a[200:203], v[52:55]
v_exp_f32 v135, v135
M v[52:55], a[132:135], a[196:199], v[52:55]
buffer_load_dwordx4 v1, s[12:15], s32 offen offset:1024 sc1 lds
M v[56:59], a[132:135], a[212:215], 0
v_exp_f32 v148, v148
M v[56:59], a[136:139], a[216:219], v[56:59]
ds_read_b128 a[172:175], v3 offset:14336
ds_read_b128 a[176:179], v3 offset:15360
M v[56:59], a[140:143], a[220:223], v[56:59]
v_exp_f32 v149, v149
M v[56:59], a[144:147], a[224:227], v[56:59]
buffer_load_dwordx4 v1, s[12:15], s32 offen offset:2048 sc1 lds
M v[60:63], a[144:147], a[240:243], 0
v_exp_f32 v150, v150
M v[60:63], a[140:143], a[236:239], v[60:63]
v_cvt_pk_bf16_f32 v133, v134, v135
v_cvt_pk_bf16_f32 v134, v148, v149
M v[60:63], a[136:139], a[232:235], v[60:63]
v_exp_f32 v151, v151
M v[60:63], a[132:135], a[228:231], v[60:63]
buffer_load_dwordx4 v1, s[12:15], s32 offen offset:3072 sc1 lds
s_waitcnt lgkmcnt(4)
M v[64:67], a[148:151], a[180:183], 0
v_exp_f32 v136, v136
M v[64:67], a[152:155], a[184:187], v[64:67]
s_add_u32 s26, s26, 32768
s_cmp_eq_u32 s26, s62
s_cselect_b32 s26, s63, s26
s_cselect_b32 s62, -1, s62
M v[64:67], a[156:159], a[188:191], v[64:67]
v_exp_f32 v137, v137
M v[64:67], a[160:163], a[192:195], v[64:67]
v_cvt_pk_bf16_f32 v135, v150, v151
v_cvt_pk_bf16_f32 v136, v136, v137
M v[68:71], a[160:163], a[208:211], 0
v_exp_f32 v138, v138
M v[68:71], a[156:159], a[204:207], v[68:71]
M v[68:71], a[152:155], a[200:203], v[68:71]
v_exp_f32 v139, v139
M v[68:71], a[148:151], a[196:199], v[68:71]
v_cvt_pk_bf16_f32 v137, v138, v139
M v[72:75], a[148:151], a[212:215], 0
v_exp_f32 v152, v152
M v[72:75], a[152:155], a[216:219], v[72:75]
M v[72:75], a[156:159], a[220:223], v[72:75]
v_exp_f32 v153, v153
M v[72:75], a[160:163], a[224:227], v[72:75]
v_cvt_pk_bf16_f32 v138, v152, v153
M v[76:79], a[160:163], a[240:243], 0
v_exp_f32 v154, v154
M v[76:79], a[156:159], a[236:239], v[76:79]
s_waitcnt vmcnt(16) lgkmcnt(0)
s_barrier
ds_read_b128 a[116:119], v3 offset:32768
ds_read_b128 a[120:123], v3 offset:40960
ds_read_b128 a[124:127], v3 offset:33792
ds_read_b128 a[128:131], v3 offset:41984
M v[76:79], a[152:155], a[232:235], v[76:79]
v_exp_f32 v155, v155
M v[76:79], a[148:151], a[228:231], v[76:79]
v_cvt_pk_bf16_f32 v139, v154, v155
M v[80:83], a[164:167], a[180:183], 0
v_exp_f32 v140, v140
M v[80:83], a[168:171], a[184:187], v[80:83]
ds_read_b128 a[132:135], v3 offset:34816
ds_read_b128 a[136:139], v3 offset:43008
M v[80:83], a[172:175], a[188:191], v[80:83]
v_exp_f32 v141, v141
M v[80:83], a[176:179], a[192:195], v[80:83]
v_cvt_pk_bf16_f32 v140, v140, v141
M v[84:87], a[176:179], a[208:211], 0
v_exp_f32 v142, v142
M v[84:87], a[172:175], a[204:207], v[84:87]
M v[84:87], a[168:171], a[200:203], v[84:87]
v_exp_f32 v143, v143
M v[84:87], a[164:167], a[196:199], v[84:87]
v_cvt_pk_bf16_f32 v141, v142, v143
M v[88:91], a[164:167], a[212:215], 0
v_exp_f32 v156, v156
M v[88:91], a[168:171], a[216:219], v[88:91]
ds_read_b128 a[140:143], v3 offset:35840
ds_read_b128 a[144:147], v3 offset:44032
M v[88:91], a[172:175], a[220:223], v[88:91]
v_exp_f32 v157, v157
M v[88:91], a[176:179], a[224:227], v[88:91]
v_cvt_pk_bf16_f32 v142, v156, v157
M v[92:95], a[176:179], a[240:243], 0
v_exp_f32 v158, v158
M v[92:95], a[172:175], a[236:239], v[92:95]
M v[92:95], a[168:171], a[232:235], v[92:95]
v_exp_f32 v159, v159
M v[92:95], a[164:167], a[228:231], v[92:95]
v_cvt_pk_bf16_f32 v143, v158, v159
s_waitcnt lgkmcnt(6)
s_add_u32 m0, s29, 65536
M v[160:163], a[116:119], v[96:99], v[160:163]
v_exp_f32 v32, v32
M v[160:163], a[120:123], v[128:131], v[160:163]
ds_read_b128 a[148:151], v3 offset:36864
ds_read_b128 a[152:155], v3 offset:45056
M v[164:167], a[120:123], v[132:135], v[164:167]
v_exp_f32 v33, v33
M v[164:167], a[116:119], v[100:103], v[164:167]
buffer_load_dwordx4 v1, s[12:15], s25 offen offset:0 sc1 lds
s_add_u32 s32, s25, 4096
M v[168:171], a[116:119], v[104:107], v[168:171]
v_exp_f32 v34, v34
M v[168:171], a[120:123], v[136:139], v[168:171]
v_cvt_pk_bf16_f32 v32, v32, v33
M v[172:175], a[120:123], v[140:143], v[172:175]
v_exp_f32 v35, v35
M v[172:175], a[116:119], v[108:111], v[172:175]
buffer_load_dwordx4 v1, s[12:15], s25 offen offset:1024 sc1 lds
s_waitcnt lgkmcnt(6)
M a[96:99], a[112:115], v[96:99], a[96:99]
M a[96:99], a[112:115], v[128:131], a[96:99]
M v[176:179], a[124:127], v[96:99], v[176:179]
v_exp_f32 v48, v48
M v[176:179], a[128:131], v[128:131], v[176:179]
ds_read_b128 a[156:159], v3 offset:37888
ds_read_b128 a[160:163], v3 offset:46080
M v[180:183], a[128:131], v[132:135], v[180:183]
v_exp_f32 v49, v49
M v[180:183], a[124:127], v[100:103], v[180:183]
buffer_load_dwordx4 v1, s[12:15], s25 offen offset:2048 sc1 lds
M v[184:187], a[124:127], v[104:107], v[184:187]
v_exp_f32 v50, v50
M v[184:187], a[128:131], v[136:139], v[184:187]
v_cvt_pk_bf16_f32 v33, v34, v35
v_cvt_pk_bf16_f32 v34, v48, v49
M v[188:191], a[128:131], v[140:143], v[188:191]
v_exp_f32 v51, v51
M v[188:191], a[124:127], v[108:111], v[188:191]
buffer_load_dwordx4 v1, s[12:15], s25 offen offset:3072 sc1 lds
s_add_u32 m0, s29, 69632
s_waitcnt lgkmcnt(6)
M a[100:103], a[112:115], v[100:103], a[100:103]
M a[100:103], a[112:115], v[132:135], a[100:103]
M v[192:195], a[132:135], v[96:99], v[192:195]
v_exp_f32 v36, v36
M v[192:195], a[136:139], v[128:131], v[192:195]
ds_read_b128 a[164:167], v3 offset:38912
ds_read_b128 a[168:171], v3 offset:47104
M v[196:199], a[136:139], v[132:135], v[196:199]
v_exp_f32 v37, v37
M v[196:199], a[132:135], v[100:103], v[196:199]
buffer_load_dwordx4 v1, s[12:15], s32 offen offset:0 sc1 lds
M v[200:203], a[132:135], v[104:107], v[200:203]
v_exp_f32 v38, v38
M v[200:203], a[136:139], v[136:139], v[200:203]
v_cvt_pk_bf16_f32 v35, v50, v51
v_cvt_pk_bf16_f32 v36, v36, v37
M v[204:207], a[136:139], v[140:143], v[204:207]
v_exp_f32 v39, v39
M v[204:207], a[132:135], v[108:111], v[204:207]
buffer_load_dwordx4 v1, s[12:15], s32 offen offset:1024 sc1 lds
s_waitcnt lgkmcnt(6)
M a[104:107], a[112:115], v[104:107], a[104:107]
M a[104:107], a[112:115], v[136:139], a[104:107]
M v[208:211], a[140:143], v[96:99], v[208:211]
v_exp_f32 v52, v52
M v[208:211], a[144:147], v[128:131], v[208:211]
ds_read_b128 a[172:175], v3 offset:39936
ds_read_b128 a[176:179], v3 offset:48128
M v[212:215], a[144:147], v[132:135], v[212:215]
v_exp_f32 v53, v53
M v[212:215], a[140:143], v[100:103], v[212:215]
buffer_load_dwordx4 v1, s[12:15], s32 offen offset:2048 sc1 lds
M v[216:219], a[140:143], v[104:107], v[216:219]
v_exp_f32 v54, v54
M v[216:219], a[144:147], v[136:139], v[216:219]
v_cvt_pk_bf16_f32 v37, v38, v39
v_cvt_pk_bf16_f32 v38, v52, v53
M v[220:223], a[144:147], v[140:143], v[220:223]
v_exp_f32 v55, v55
M v[220:223], a[140:143], v[108:111], v[220:223]
buffer_load_dwordx4 v1, s[12:15], s32 offen offset:3072 sc1 lds
s_waitcnt lgkmcnt(6)
M a[108:111], a[112:115], v[108:111], a[108:111]
M a[108:111], a[112:115], v[140:143], a[108:111]
M v[224:227], a[148:151], v[96:99], v[224:227]
v_exp_f32 v40, v40
M v[224:227], a[152:155], v[128:131], v[224:227]
s_add_u32 s25, s25, 32768
s_cmp_eq_u32 s25, s27
s_cselect_b32 s25, s28, s25
s_cselect_b32 s27, -1, s27
M v[228:231], a[152:155], v[132:135], v[228:231]
v_exp_f32 v41, v41
M v[228:231], a[148:151], v[100:103], v[228:231]
v_cvt_pk_bf16_f32 v39, v54, v55
v_cvt_pk_bf16_f32 v40, v40, v41
M v[232:235], a[148:151], v[104:107], v[232:235]
v_exp_f32 v42, v42
M v[232:235], a[152:155], v[136:139], v[232:235]
M v[236:239], a[152:155], v[140:143], v[236:239]
v_exp_f32 v43, v43
M v[236:239], a[148:151], v[108:111], v[236:239]
v_cvt_pk_bf16_f32 v41, v42, v43
s_waitcnt lgkmcnt(4)
M v[240:243], a[156:159], v[96:99], v[240:243]
v_exp_f32 v56, v56
M v[240:243], a[160:163], v[128:131], v[240:243]
M v[244:247], a[160:163], v[132:135], v[244:247]
v_exp_f32 v57, v57
M v[244:247], a[156:159], v[100:103], v[244:247]
v_cvt_pk_bf16_f32 v42, v56, v57
M v[248:251], a[156:159], v[104:107], v[248:251]
v_exp_f32 v58, v58
M v[248:251], a[160:163], v[136:139], v[248:251]
s_waitcnt vmcnt(16) lgkmcnt(0)
s_barrier
ds_read_b128 a[116:119], v2 offset:0
ds_read_b128 a[120:123], v2 offset:1024
ds_read_b128 a[124:127], v2 offset:2048
ds_read_b128 a[128:131], v2 offset:3072
M v[252:255], a[160:163], v[140:143], v[252:255]
v_exp_f32 v59, v59
M v[252:255], a[156:159], v[108:111], v[252:255]
v_cvt_pk_bf16_f32 v43, v58, v59
M a[64:67], a[164:167], v[96:99], a[64:67]
v_exp_f32 v44, v44
M a[64:67], a[168:171], v[128:131], a[64:67]
ds_read_b128 a[132:135], v2 offset:4096
ds_read_b128 a[136:139], v2 offset:5120
M a[68:71], a[168:171], v[132:135], a[68:71]
v_exp_f32 v45, v45
M a[68:71], a[164:167], v[100:103], a[68:71]
v_cvt_pk_bf16_f32 v44, v44, v45
M a[72:75], a[164:167], v[104:107], a[72:75]
v_exp_f32 v46, v46
M a[72:75], a[168:171], v[136:139], a[72:75]
M a[76:79], a[168:171], v[140:143], a[76:79]
v_exp_f32 v47, v47
M a[76:79], a[164:167], v[108:111], a[76:79]
v_cvt_pk_bf16_f32 v45, v46, v47
M a[80:83], a[172:175], v[96:99], a[80:83]
v_exp_f32 v60, v60
M a[80:83], a[176:179], v[128:131], a[80:83]
ds_read_b128 a[140:143], v2 offset:6144
ds_read_b128 a[144:147], v2 offset:7168
M a[84:87], a[176:179], v[132:135], a[84:87]
v_exp_f32 v61, v61
M a[84:87], a[172:175], v[100:103], a[84:87]
v_cvt_pk_bf16_f32 v46, v60, v61
M a[88:91], a[172:175], v[104:107], a[88:91]
v_exp_f32 v62, v62
M a[88:91], a[176:179], v[136:139], a[88:91]
M a[92:95], a[176:179], v[140:143], a[92:95]
v_exp_f32 v63, v63
M a[92:95], a[172:175], v[108:111], a[92:95]
v_cvt_pk_bf16_f32 v47, v62, v63
v_accvgpr_read_b32 v20, a96
v_accvgpr_read_b32 v21, a100
v_accvgpr_read_b32 v22, a104
v_accvgpr_read_b32 v23, a108
v_rcp_f32 v8, v20
v_rcp_f32 v9, v21
v_rcp_f32 v10, v22
v_rcp_f32 v11, v23
v_subrev_u32 v20, 0x21800000, v20
v_subrev_u32 v21, 0x21800000, v21
v_subrev_u32 v22, 0x21800000, v22
v_subrev_u32 v23, 0x21800000, v23
v_max_u32 v12, v20, v21
v_max3_u32 v12, v12, v22, v23
s_mov_b32 s64, 0x207
v_pk_mul_f32 v[160:161], v[160:161], v[8:9] op_sel:[0,0] op_sel_hi:[1,0]
v_pk_mul_f32 v[162:163], v[162:163], v[8:9] op_sel:[0,0] op_sel_hi:[1,0]
v_pk_mul_f32 v[176:177], v[176:177], v[8:9] op_sel:[0,0] op_sel_hi:[1,0]
v_pk_mul_f32 v[178:179], v[178:179], v[8:9] op_sel:[0,0] op_sel_hi:[1,0]
v_cvt_pk_bf16_f32 v160, v160, v161
v_cvt_pk_bf16_f32 v161, v162, v163
v_cvt_pk_bf16_f32 v162, v176, v177
v_cvt_pk_bf16_f32 v163, v178, v179
s_nop 1
M v[24:27], a[112:115], v[160:163], 0
v_pk_mul_f32 v[164:165], v[164:165], v[8:9] op_sel:[0,1] op_sel_hi:[1,1]
v_pk_mul_f32 v[166:167], v[166:167], v[8:9] op_sel:[0,1] op_sel_hi:[1,1]
v_pk_mul_f32 v[180:181], v[180:181], v[8:9] op_sel:[0,1] op_sel_hi:[1,1]
v_pk_mul_f32 v[182:183], v[182:183], v[8:9] op_sel:[0,1] op_sel_hi:[1,1]
v_cvt_pk_bf16_f32 v164, v164, v165
v_cvt_pk_bf16_f32 v165, v166, v167
v_cvt_pk_bf16_f32 v166, v180, v181
v_cvt_pk_bf16_f32 v167, v182, v183
s_nop 1
M v[24:27], a[112:115], v[164:167], v[24:27]
v_pk_mul_f32 v[168:169], v[168:169], v[10:11] op_sel:[0,0] op_sel_hi:[1,0]
v_pk_mul_f32 v[170:171], v[170:171], v[10:11] op_sel:[0,0] op_sel_hi:[1,0]
v_pk_mul_f32 v[184:185], v[184:185], v[10:11] op_sel:[0,0] op_sel_hi:[1,0]
v_pk_mul_f32 v[186:187], v[186:187], v[10:11] op_sel:[0,0] op_sel_hi:[1,0]
v_cvt_pk_bf16_f32 v168, v168, v169
v_cvt_pk_bf16_f32 v169, v170, v171
v_cvt_pk_bf16_f32 v170, v184, v185
v_cvt_pk_bf16_f32 v171, v186, v187
s_nop 1
M v[24:27], a[112:115], v[168:171], v[24:27]
v_pk_mul_f32 v[172:173], v[172:173], v[10:11] op_sel:[0,1] op_sel_hi:[1,1]
v_pk_mul_f32 v[174:175], v[174:175], v[10:11] op_sel:[0,1] op_sel_hi:[1,1]
v_pk_mul_f32 v[188:189], v[188:189], v[10:11] op_sel:[0,1] op_sel_hi:[1,1]
v_pk_mul_f32 v[190:191], v[190:191], v[10:11] op_sel:[0,1] op_sel_hi:[1,1]
v_cvt_pk_bf16_f32 v172, v172, v173
v_cvt_pk_bf16_f32 v173, v174, v175
v_cvt_pk_bf16_f32 v174, v188, v189
v_cvt_pk_bf16_f32 v175, v190, v191
s_nop 1
M v[24:27], a[112:115], v[172:175], v[24:27]
v_pk_mul_f32 v[192:193], v[192:193], v[8:9] op_sel:[0,0] op_sel_hi:[1,0]
v_pk_mul_f32 v[194:195], v[194:195], v[8:9] op_sel:[0,0] op_sel_hi:[1,0]
v_pk_mul_f32 v[208:209], v[208:209], v[8:9] op_sel:[0,0] op_sel_hi:[1,0]
v_pk_mul_f32 v[210:211], v[210:211], v[8:9] op_sel:[0,0] op_sel_hi:[1,0]
v_cvt_pk_bf16_f32 v192, v192, v193
v_cvt_pk_bf16_f32 v193, v194, v195
v_cvt_pk_bf16_f32 v194, v208, v209
v_cvt_pk_bf16_f32 v195, v210, v211
s_nop 1
M v[24:27], a[112:115], v[192:195], v[24:27]
v_pk_mul_f32 v[196:197], v[196:197], v[8:9] op_sel:[0,1] op_sel_hi:[1,1]
v_pk_mul_f32 v[198:199], v[198:199], v[8:9] op_sel:[0,1] op_sel_hi:[1,1]
v_pk_mul_f32 v[212:213], v[212:213], v[8:9] op_sel:[0,1] op_sel_hi:[1,1]
v_pk_mul_f32 v[214:215], v[214:215], v[8:9] op_sel:[0,1] op_sel_hi:[1,1]
v_cvt_pk_bf16_f32 v196, v196, v197
v_cvt_pk_bf16_f32 v197, v198, v199
v_cvt_pk_bf16_f32 v198, v212, v213
v_cvt_pk_bf16_f32 v199, v214, v215
s_nop 1
M v[24:27], a[112:115], v[196:199], v[24:27]
v_pk_mul_f32 v[200:201], v[200:201], v[10:11] op_sel:[0,0] op_sel_hi:[1,0]
v_pk_mul_f32 v[202:203], v[202:203], v[10:11] op_sel:[0,0] op_sel_hi:[1,0]
v_pk_mul_f32 v[216:217], v[216:217], v[10:11] op_sel:[0,0] op_sel_hi:[1,0]
v_pk_mul_f32 v[218:219], v[218:219], v[10:11] op_sel:[0,0] op_sel_hi:[1,0]
v_cvt_pk_bf16_f32 v200, v200, v201
v_cvt_pk_bf16_f32 v201, v202, v203
v_cvt_pk_bf16_f32 v202, v216, v217
v_cvt_pk_bf16_f32 v203, v218, v219
s_nop 1
M v[24:27], a[112:115], v[200:203], v[24:27]
v_pk_mul_f32 v[204:205], v[204:205], v[10:11] op_sel:[0,1] op_sel_hi:[1,1]
v_pk_mul_f32 v[206:207], v[206:207], v[10:11] op_sel:[0,1] op_sel_hi:[1,1]
v_pk_mul_f32 v[220:221], v[220:221], v[10:11] op_sel:[0,1] op_sel_hi:[1,1]
v_pk_mul_f32 v[222:223], v[222:223], v[10:11] op_sel:[0,1] op_sel_hi:[1,1]
v_cvt_pk_bf16_f32 v204, v204, v205
v_cvt_pk_bf16_f32 v205, v206, v207
v_cvt_pk_bf16_f32 v206, v220, v221
v_cvt_pk_bf16_f32 v207, v222, v223
s_nop 1
M v[24:27], a[112:115], v[204:207], v[24:27]
v_pk_mul_f32 v[224:225], v[224:225], v[8:9] op_sel:[0,0] op_sel_hi:[1,0]
v_pk_mul_f32 v[226:227], v[226:227], v[8:9] op_sel:[0,0] op_sel_hi:[1,0]
v_pk_mul_f32 v[240:241], v[240:241], v[8:9] op_sel:[0,0] op_sel_hi:[1,0]
v_pk_mul_f32 v[242:243], v[242:243], v[8:9] op_sel:[0,0] op_sel_hi:[1,0]
v_cvt_pk_bf16_f32 v224, v224, v225
v_cvt_pk_bf16_f32 v225, v226, v227
v_cvt_pk_bf16_f32 v226, v240, v241
v_cvt_pk_bf16_f32 v227, v242, v243
s_nop 1
M v[24:27], a[112:115], v[224:227], v[24:27]
v_pk_mul_f32 v[228:229], v[228:229], v[8:9] op_sel:[0,1] op_sel_hi:[1,1]
v_pk_mul_f32 v[230:231], v[230:231], v[8:9] op_sel:[0,1] op_sel_hi:[1,1]
v_pk_mul_f32 v[244:245], v[244:245], v[8:9] op_sel:[0,1] op_sel_hi:[1,1]
v_pk_mul_f32 v[246:247], v[246:247], v[8:9] op_sel:[0,1] op_sel_hi:[1,1]
v_cvt_pk_bf16_f32 v228, v228, v229
v_cvt_pk_bf16_f32 v229, v230, v231
v_cvt_pk_bf16_f32 v230, v244, v245
v_cvt_pk_bf16_f32 v231, v246, v247
s_nop 1
M v[24:27], a[112:115], v[228:231], v[24:27]
v_pk_mul_f32 v[232:233], v[232:233], v[10:11] op_sel:[0,0] op_sel_hi:[1,0]
v_pk_mul_f32 v[234:235], v[234:235], v[10:11] op_sel:[0,0] op_sel_hi:[1,0]
v_pk_mul_f32 v[248:249], v[248:249], v[10:11] op_sel:[0,0] op_sel_hi:[1,0]
v_pk_mul_f32 v[250:251], v[250:251], v[10:11] op_sel:[0,0] op_sel_hi:[1,0]
v_cvt_pk_bf16_f32 v232, v232, v233
v_cvt_pk_bf16_f32 v233, v234, v235
v_cvt_pk_bf16_f32 v234, v248, v249
v_cvt_pk_bf16_f32 v235, v250, v251
s_nop 1
M v[24:27], a[112:115], v[232:235], v[24:27]
v_pk_mul_f32 v[236:237], v[236:237], v[10:11] op_sel:[0,1] op_sel_hi:[1,1]
v_pk_mul_f32 v[238:239], v[238:239], v[10:11] op_sel:[0,1] op_sel_hi:[1,1]
v_pk_mul_f32 v[252:253], v[252:253], v[10:11] op_sel:[0,1] op_sel_hi:[1,1]
v_pk_mul_f32 v[254:255], v[254:255], v[10:11] op_sel:[0,1] op_sel_hi:[1,1]
v_cvt_pk_bf16_f32 v236, v236, v237
v_cvt_pk_bf16_f32 v237, v238, v239
v_cvt_pk_bf16_f32 v238, v252, v253
v_cvt_pk_bf16_f32 v239, v254, v255
v_accvgpr_read_b32 v176, a64
v_accvgpr_read_b32 v177, a65
v_accvgpr_read_b32 v178, a66
v_accvgpr_read_b32 v179, a67
v_accvgpr_read_b32 v180, a80
v_accvgpr_read_b32 v181, a81
v_accvgpr_read_b32 v182, a82
v_accvgpr_read_b32 v183, a83
M v[24:27], a[112:115], v[236:239], v[24:27]
v_pk_mul_f32 v[176:177], v[176:177], v[8:9] op_sel:[0,0] op_sel_hi:[1,0]
v_pk_mul_f32 v[178:179], v[178:179], v[8:9] op_sel:[0,0] op_sel_hi:[1,0]
v_pk_mul_f32 v[180:181], v[180:181], v[8:9] op_sel:[0,0] op_sel_hi:[1,0]
v_pk_mul_f32 v[182:183], v[182:183], v[8:9] op_sel:[0,0] op_sel_hi:[1,0]
v_cvt_pk_bf16_f32 v176, v176, v177
v_cvt_pk_bf16_f32 v177, v178, v179
v_cvt_pk_bf16_f32 v178, v180, v181
v_cvt_pk_bf16_f32 v179, v182, v183
v_accvgpr_read_b32 v184, a68
v_accvgpr_read_b32 v185, a69
v_accvgpr_read_b32 v186, a70
v_accvgpr_read_b32 v187, a71
v_accvgpr_read_b32 v188, a84
v_accvgpr_read_b32 v189, a85
v_accvgpr_read_b32 v190, a86
v_accvgpr_read_b32 v191, a87
M v[24:27], a[112:115], v[176:179], v[24:27]
v_pk_mul_f32 v[184:185], v[184:185], v[8:9] op_sel:[0,1] op_sel_hi:[1,1]
v_pk_mul_f32 v[186:187], v[186:187], v[8:9] op_sel:[0,1] op_sel_hi:[1,1]
v_pk_mul_f32 v[188:189], v[188:189], v[8:9] op_sel:[0,1] op_sel_hi:[1,1]
v_pk_mul_f32 v[190:191], v[190:191], v[8:9] op_sel:[0,1] op_sel_hi:[1,1]
v_cvt_pk_bf16_f32 v184, v184, v185
v_cvt_pk_bf16_f32 v185, v186, v187
v_cvt_pk_bf16_f32 v186, v188, v189
v_cvt_pk_bf16_f32 v187, v190, v191
v_accvgpr_read_b32 v208, a72
v_accvgpr_read_b32 v209, a73
v_accvgpr_read_b32 v210, a74
v_accvgpr_read_b32 v211, a75
v_accvgpr_read_b32 v212, a88
v_accvgpr_read_b32 v213, a89
v_accvgpr_read_b32 v214, a90
v_accvgpr_read_b32 v215, a91
M v[24:27], a[112:115], v[184:187], v[24:27]
v_pk_mul_f32 v[208:209], v[208:209], v[10:11] op_sel:[0,0] op_sel_hi:[1,0]
v_pk_mul_f32 v[210:211], v[210:211], v[10:11] op_sel:[0,0] op_sel_hi:[1,0]
v_pk_mul_f32 v[212:213], v[212:213], v[10:11] op_sel:[0,0] op_sel_hi:[1,0]
v_pk_mul_f32 v[214:215], v[214:215], v[10:11] op_sel:[0,0] op_sel_hi:[1,0]
v_cvt_pk_bf16_f32 v208, v208, v209
v_cvt_pk_bf16_f32 v209, v210, v211
v_cvt_pk_bf16_f32 v210, v212, v213
v_cvt_pk_bf16_f32 v211, v214, v215
v_accvgpr_read_b32 v216, a76
v_accvgpr_read_b32 v217, a77
v_accvgpr_read_b32 v218, a78
v_accvgpr_read_b32 v219, a79
v_accvgpr_read_b32 v220, a92
v_accvgpr_read_b32 v221, a93
v_accvgpr_read_b32 v222, a94
v_accvgpr_read_b32 v223, a95
M v[24:27], a[112:115], v[208:211], v[24:27]
v_pk_mul_f32 v[216:217], v[216:217], v[10:11] op_sel:[0,1] op_sel_hi:[1,1]
v_pk_mul_f32 v[218:219], v[218:219], v[10:11] op_sel:[0,1] op_sel_hi:[1,1]
v_pk_mul_f32 v[220:221], v[220:221], v[10:11] op_sel:[0,1] op_sel_hi:[1,1]
v_pk_mul_f32 v[222:223], v[222:223], v[10:11] op_sel:[0,1] op_sel_hi:[1,1]
v_cvt_pk_bf16_f32 v216, v216, v217
v_cvt_pk_bf16_f32 v217, v218, v219
v_cvt_pk_bf16_f32 v218, v220, v221
v_cvt_pk_bf16_f32 v219, v222, v223
s_nop 1
M v[24:27], a[112:115], v[216:219], v[24:27]
v_cmp_lt_u32 vcc, 0x3c000000, v12
s_nop 6
v_cmp_class_f32 s[40:41], v24, s64
s_nop 0
s_or_b64 vcc, vcc, s[40:41]
s_cbranch_vccnz Lbad_2
s_lshl_b32 s33, s21, 20
s_lshl_b32 s34, s20, 15
s_add_u32 s33, s33, s34
s_lshl_b32 s34, s23, 13
s_add_u32 s36, s33, s34
s_add_u32 s37, s36, 4096
s_add_u32 s38, s36, 16384
s_add_u32 s39, s36, 20480
buffer_store_dwordx4 v[160:163], v1, s[16:19], s36 offen offset:0 sc1
buffer_store_dwordx4 v[164:167], v1, s[16:19], s36 offen offset:2048 sc1
buffer_store_dwordx4 v[168:171], v1, s[16:19], s37 offen offset:0 sc1
buffer_store_dwordx4 v[172:175], v1, s[16:19], s37 offen offset:2048 sc1
buffer_store_dwordx4 v[192:195], v1, s[16:19], s36 offen offset:1024 sc1
buffer_store_dwordx4 v[196:199], v1, s[16:19], s36 offen offset:3072 sc1
buffer_store_dwordx4 v[200:203], v1, s[16:19], s37 offen offset:1024 sc1
buffer_store_dwordx4 v[204:207], v1, s[16:19], s37 offen offset:3072 sc1
buffer_store_dwordx4 v[224:227], v1, s[16:19], s38 offen offset:0 sc1
buffer_store_dwordx4 v[228:231], v1, s[16:19], s38 offen offset:2048 sc1
buffer_store_dwordx4 v[232:235], v1, s[16:19], s39 offen offset:0 sc1
buffer_store_dwordx4 v[236:239], v1, s[16:19], s39 offen offset:2048 sc1
buffer_store_dwordx4 v[176:179], v1, s[16:19], s38 offen offset:1024 sc1
buffer_store_dwordx4 v[184:187], v1, s[16:19], s38 offen offset:3072 sc1
buffer_store_dwordx4 v[208:211], v1, s[16:19], s39 offen offset:1024 sc1
buffer_store_dwordx4 v[216:219], v1, s[16:19], s39 offen offset:3072 sc1
s_branch Lfd_3
Lbad_2:
s_or_b32 s60, s60, 1
Lfd_3:
s_sub_u32 s30, 7, s21
s_cmp_lg_u32 s30, 0
s_cbranch_scc1 Lk2_b0
s_waitcnt vmcnt(8)
s_waitcnt lgkmcnt(0)
s_barrier
s_and_b32 s3, s2, 3
s_lshl_b32 s3, s3, 2
s_bfe_u32 s27, s2, 0x20003
s_add_u32 s27, s3, s27
s_lshl_b32 s43, s27, 8
s_add_u32 s43, s43, 8400896
v_lshlrev_b32 v15, 2, v0
buffer_load_dword v7, v15, s[52:55], s43 offen sc1
ds_read_b128 a[116:119], v2 offset:32768
ds_read_b128 a[120:123], v2 offset:40960
ds_read_b128 a[124:127], v2 offset:33792
ds_read_b128 a[128:131], v2 offset:41984
ds_read_b128 a[132:135], v2 offset:34816
ds_read_b128 a[136:139], v2 offset:43008
ds_read_b128 a[140:143], v2 offset:35840
ds_read_b128 a[144:147], v2 offset:44032
v_exp_f32 v64, v64
v_exp_f32 v65, v65
v_exp_f32 v66, v66
v_exp_f32 v67, v67
v_exp_f32 v80, v80
v_exp_f32 v81, v81
v_exp_f32 v82, v82
v_exp_f32 v83, v83
v_cvt_pk_bf16_f32 v64, v64, v65
v_cvt_pk_bf16_f32 v65, v66, v67
v_exp_f32 v68, v68
v_exp_f32 v69, v69
v_exp_f32 v70, v70
v_exp_f32 v71, v71
v_cvt_pk_bf16_f32 v66, v80, v81
v_cvt_pk_bf16_f32 v67, v82, v83
v_exp_f32 v84, v84
v_exp_f32 v85, v85
v_exp_f32 v86, v86
v_exp_f32 v87, v87
v_cvt_pk_bf16_f32 v68, v68, v69
v_cvt_pk_bf16_f32 v69, v70, v71
v_exp_f32 v72, v72
v_exp_f32 v73, v73
v_exp_f32 v74, v74
v_exp_f32 v75, v75
v_cvt_pk_bf16_f32 v70, v84, v85
v_cvt_pk_bf16_f32 v71, v86, v87
v_exp_f32 v88, v88
v_exp_f32 v89, v89
v_exp_f32 v90, v90
v_exp_f32 v91, v91
v_cvt_pk_bf16_f32 v72, v72, v73
v_cvt_pk_bf16_f32 v73, v74, v75
v_exp_f32 v76, v76
v_exp_f32 v77, v77
v_exp_f32 v78, v78
v_exp_f32 v79, v79
v_cvt_pk_bf16_f32 v74, v88, v89
v_cvt_pk_bf16_f32 v75, v90, v91
v_exp_f32 v92, v92
v_exp_f32 v93, v93
v_exp_f32 v94, v94
v_exp_f32 v95, v95
v_cvt_pk_bf16_f32 v76, v76, v77
v_cvt_pk_bf16_f32 v77, v78, v79
v_cvt_pk_bf16_f32 v78, v92, v93
v_cvt_pk_bf16_f32 v79, v94, v95
s_waitcnt lgkmcnt(6)
M v[160:163], a[116:119], v[32:35], 0
M v[160:163], a[120:123], v[64:67], v[160:163]
ds_read_b128 a[148:151], v2 offset:36864
ds_read_b128 a[152:155], v2 offset:45056
s_mov_b32 s61, 0
M v[164:167], a[120:123], v[68:71], 0
M v[164:167], a[116:119], v[36:39], v[164:167]
s_bfe_u32 s3, s2, 0x10002
M v[168:171], a[116:119], v[40:43], 0
M v[168:171], a[120:123], v[72:75], v[168:171]
s_lshl_b32 s3, s3, 3
M v[172:175], a[120:123], v[76:79], 0
M v[172:175], a[116:119], v[44:47], v[172:175]
s_waitcnt lgkmcnt(6)
s_lshr_b32 s28, s2, 5
M a[96:99], a[112:115], v[32:35], 0
M a[96:99], a[112:115], v[64:67], a[96:99]
M v[176:179], a[124:127], v[32:35], 0
M v[176:179], a[128:131], v[64:67], v[176:179]
ds_read_b128 a[156:159], v2 offset:37888
ds_read_b128 a[160:163], v2 offset:46080
s_add_u32 s28, s3, s28
M v[180:183], a[128:131], v[68:71], 0
s_lshl_b32 s25, s27, 18
M v[180:183], a[124:127], v[36:39], v[180:183]
M v[184:187], a[124:127], v[40:43], 0
s_lshl_b32 s3, s101, 12
M v[184:187], a[128:131], v[72:75], v[184:187]
M v[188:191], a[128:131], v[76:79], 0
s_add_u32 s25, s25, s3
M v[188:191], a[124:127], v[44:47], v[188:191]
s_waitcnt lgkmcnt(6)
M a[100:103], a[112:115], v[36:39], 0
M a[100:103], a[112:115], v[68:71], a[100:103]
M v[192:195], a[132:135], v[32:35], 0
s_lshl_b32 s26, s28, 7
M v[192:195], a[136:139], v[64:67], v[192:195]
ds_read_b128 a[164:167], v2 offset:38912
ds_read_b128 a[168:171], v2 offset:47104
M v[196:199], a[136:139], v[68:71], 0
s_lshl_b32 s42, s101, 11
M v[196:199], a[132:135], v[36:39], v[196:199]
M v[200:203], a[132:135], v[40:43], 0
s_add_u32 s44, s4, 83886080
s_addc_u32 s45, s5, 0
M v[200:203], a[136:139], v[72:75], v[200:203]
s_mov_b32 s46, 4194304
M v[204:207], a[136:139], v[76:79], 0
M v[204:207], a[132:135], v[44:47], v[204:207]
s_waitcnt lgkmcnt(6)
s_mov_b32 s47, 0x00020000
M a[104:107], a[112:115], v[40:43], 0
M a[104:107], a[112:115], v[72:75], a[104:107]
M v[208:211], a[140:143], v[32:35], 0
M v[208:211], a[144:147], v[64:67], v[208:211]
ds_read_b128 a[172:175], v2 offset:39936
ds_read_b128 a[176:179], v2 offset:48128
s_mov_b32 s50, 2097152
M v[212:215], a[144:147], v[68:71], 0
M v[212:215], a[140:143], v[36:39], v[212:215]
s_mov_b32 s51, 0x00020000
M v[216:219], a[140:143], v[40:43], 0
M v[216:219], a[144:147], v[72:75], v[216:219]
s_lshl_b32 s3, s101, 4
M v[220:223], a[144:147], v[76:79], 0
M v[220:223], a[140:143], v[44:47], v[220:223]
s_waitcnt lgkmcnt(6)
v_lshrrev_b32 v96, 3, v0
M a[108:111], a[112:115], v[44:47], 0
M a[108:111], a[112:115], v[76:79], a[108:111]
M v[224:227], a[148:151], v[32:35], 0
v_and_b32 v97, 6, v96
M v[224:227], a[152:155], v[64:67], v[224:227]
M v[228:231], a[152:155], v[68:71], 0
v_and_b32 v98, 7, v0
M v[228:231], a[148:151], v[36:39], v[228:231]
M v[232:235], a[148:151], v[40:43], 0
v_xor_b32 v97, v97, v98
M v[232:235], a[152:155], v[72:75], v[232:235]
M v[236:239], a[152:155], v[76:79], 0
v_add_u32 v96, s3, v96
M v[236:239], a[148:151], v[44:47], v[236:239]
s_waitcnt lgkmcnt(4)
M v[240:243], a[156:159], v[32:35], 0
v_lshlrev_b32 v96, 11, v96
M v[240:243], a[160:163], v[64:67], v[240:243]
M v[244:247], a[160:163], v[68:71], 0
v_lshl_add_u32 v99, v97, 4, v96
M v[244:247], a[156:159], v[36:39], v[244:247]
v_add_u32 v100, 15360, v99
M v[248:251], a[156:159], v[40:43], 0
M v[248:251], a[160:163], v[72:75], v[248:251]
s_waitcnt vmcnt(0) lgkmcnt(0)
s_barrier
v_cmp_ne_u32 vcc, 1, v7
s_nop 0
s_cbranch_vccnz Lk3_spinb1
Lk3_gotb1:
M v[252:255], a[160:163], v[76:79], 0
s_add_u32 m0, s42, 65536
s_nop 0
buffer_load_dwordx4 v99, s[48:51], s26 offen offset:0 lds
buffer_load_dwordx4 v100, s[48:51], s26 offen offset:1024 lds
M v[252:255], a[156:159], v[44:47], v[252:255]
buffer_load_dwordx4 a[192:195], v1, s[44:47], s25 offen offset:0 sc1
buffer_load_dwordx4 a[196:199], v1, s[44:47], s25 offen offset:1024 sc1
M a[64:67], a[164:167], v[32:35], 0
buffer_load_dwordx4 a[200:203], v1, s[44:47], s25 offen offset:2048 sc1
buffer_load_dwordx4 a[204:207], v1, s[44:47], s25 offen offset:3072 sc1
M a[64:67], a[168:171], v[64:67], a[64:67]
s_add_u32 s25, s25, 16384
s_add_u32 s26, s26, 131072
s_add_u32 m0, s42, 81920
s_nop 0
buffer_load_dwordx4 v99, s[48:51], s26 offen offset:0 lds
M a[68:71], a[168:171], v[68:71], 0
buffer_load_dwordx4 v100, s[48:51], s26 offen offset:1024 lds
buffer_load_dwordx4 a[208:211], v1, s[44:47], s25 offen offset:0 sc1
M a[68:71], a[164:167], v[36:39], a[68:71]
buffer_load_dwordx4 a[212:215], v1, s[44:47], s25 offen offset:1024 sc1
buffer_load_dwordx4 a[216:219], v1, s[44:47], s25 offen offset:2048 sc1
M a[72:75], a[164:167], v[40:43], 0
buffer_load_dwordx4 a[220:223], v1, s[44:47], s25 offen offset:3072 sc1
s_add_u32 s25, s25, 16384
s_add_u32 s26, s26, 131072
M a[72:75], a[168:171], v[72:75], a[72:75]
s_add_u32 m0, s42, 98304
s_nop 0
buffer_load_dwordx4 v99, s[48:51], s26 offen offset:0 lds
buffer_load_dwordx4 v100, s[48:51], s26 offen offset:1024 lds
M a[76:79], a[168:171], v[76:79], 0
buffer_load_dwordx4 a[224:227], v1, s[44:47], s25 offen offset:0 sc1
M a[76:79], a[164:167], v[44:47], a[76:79]
buffer_load_dwordx4 a[228:231], v1, s[44:47], s25 offen offset:1024 sc1
buffer_load_dwordx4 a[232:235], v1, s[44:47], s25 offen offset:2048 sc1
M a[80:83], a[172:175], v[32:35], 0
buffer_load_dwordx4 a[236:239], v1, s[44:47], s25 offen offset:3072 sc1
s_add_u32 s25, s25, 16384
s_add_u32 s26, s26, 131072
M a[80:83], a[176:179], v[64:67], a[80:83]
s_add_u32 m0, s42, 114688
s_nop 0
buffer_load_dwordx4 v99, s[48:51], s26 offen offset:0 lds
buffer_load_dwordx4 v100, s[48:51], s26 offen offset:1024 lds
M a[84:87], a[176:179], v[68:71], 0
buffer_load_dwordx4 a[240:243], v1, s[44:47], s25 offen offset:0 sc1
buffer_load_dwordx4 a[244:247], v1, s[44:47], s25 offen offset:1024 sc1
M a[84:87], a[172:175], v[36:39], a[84:87]
buffer_load_dwordx4 a[248:251], v1, s[44:47], s25 offen offset:2048 sc1
buffer_load_dwordx4 a[252:255], v1, s[44:47], s25 offen offset:3072 sc1
M a[88:91], a[172:175], v[40:43], 0
s_add_u32 s25, s25, 16384
s_add_u32 s26, s26, 131072
s_add_u32 m0, s42, 0
s_nop 0
buffer_load_dwordx4 v99, s[48:51], s26 offen offset:0 lds
M a[88:91], a[176:179], v[72:75], a[88:91]
buffer_load_dwordx4 v100, s[48:51], s26 offen offset:1024 lds
buffer_load_dwordx4 a[128:131], v1, s[44:47], s25 offen offset:0 sc1
M a[92:95], a[176:179], v[76:79], 0
buffer_load_dwordx4 a[132:135], v1, s[44:47], s25 offen offset:1024 sc1
buffer_load_dwordx4 a[136:139], v1, s[44:47], s25 offen offset:2048 sc1
M a[92:95], a[172:175], v[44:47], a[92:95]
buffer_load_dwordx4 a[140:143], v1, s[44:47], s25 offen offset:3072 sc1
s_add_u32 s25, s25, 16384
s_add_u32 s26, s26, 131072
s_branch Lk2_merge
Lk2_b0:
s_waitcnt lgkmcnt(4)
s_add_u32 m0, s29, 98304
M v[96:99], a[116:119], a[180:183], 0
v_exp_f32 v64, v64
M v[96:99], a[120:123], a[184:187], v[96:99]
ds_read_b128 a[148:151], v2 offset:8192
ds_read_b128 a[152:155], v2 offset:9216
M v[96:99], a[124:127], a[188:191], v[96:99]
v_exp_f32 v65, v65
M v[96:99], a[128:131], a[192:195], v[96:99]
buffer_load_dwordx4 v1, s[12:15], s26 offen offset:0 sc1 lds
s_add_u32 s32, s26, 4096
M v[100:103], a[128:131], a[208:211], 0
v_exp_f32 v66, v66
M v[100:103], a[124:127], a[204:207], v[100:103]
v_cvt_pk_bf16_f32 v64, v64, v65
M v[100:103], a[120:123], a[200:203], v[100:103]
v_exp_f32 v67, v67
M v[100:103], a[116:119], a[196:199], v[100:103]
buffer_load_dwordx4 v1, s[12:15], s26 offen offset:1024 sc1 lds
M v[104:107], a[116:119], a[212:215], 0
v_exp_f32 v80, v80
M v[104:107], a[120:123], a[216:219], v[104:107]
ds_read_b128 a[156:159], v2 offset:10240
ds_read_b128 a[160:163], v2 offset:11264
M v[104:107], a[124:127], a[220:223], v[104:107]
v_exp_f32 v81, v81
M v[104:107], a[128:131], a[224:227], v[104:107]
buffer_load_dwordx4 v1, s[12:15], s26 offen offset:2048 sc1 lds
M v[108:111], a[128:131], a[240:243], 0
v_exp_f32 v82, v82
M v[108:111], a[124:127], a[236:239], v[108:111]
v_cvt_pk_bf16_f32 v65, v66, v67
v_cvt_pk_bf16_f32 v66, v80, v81
M v[108:111], a[120:123], a[232:235], v[108:111]
v_exp_f32 v83, v83
M v[108:111], a[116:119], a[228:231], v[108:111]
buffer_load_dwordx4 v1, s[12:15], s26 offen offset:3072 sc1 lds
s_add_u32 m0, s29, 102400
s_waitcnt lgkmcnt(4)
M v[112:115], a[132:135], a[180:183], 0
v_exp_f32 v68, v68
M v[112:115], a[136:139], a[184:187], v[112:115]
ds_read_b128 a[164:167], v2 offset:12288
ds_read_b128 a[168:171], v2 offset:13312
M v[112:115], a[140:143], a[188:191], v[112:115]
v_exp_f32 v69, v69
M v[112:115], a[144:147], a[192:195], v[112:115]
buffer_load_dwordx4 v1, s[12:15], s32 offen offset:0 sc1 lds
M v[116:119], a[144:147], a[208:211], 0
v_exp_f32 v70, v70
M v[116:119], a[140:143], a[204:207], v[116:119]
v_cvt_pk_bf16_f32 v67, v82, v83
v_cvt_pk_bf16_f32 v68, v68, v69
M v[116:119], a[136:139], a[200:203], v[116:119]
v_exp_f32 v71, v71
M v[116:119], a[132:135], a[196:199], v[116:119]
buffer_load_dwordx4 v1, s[12:15], s32 offen offset:1024 sc1 lds
M v[120:123], a[132:135], a[212:215], 0
v_exp_f32 v84, v84
M v[120:123], a[136:139], a[216:219], v[120:123]
ds_read_b128 a[172:175], v2 offset:14336
ds_read_b128 a[176:179], v2 offset:15360
M v[120:123], a[140:143], a[220:223], v[120:123]
v_exp_f32 v85, v85
M v[120:123], a[144:147], a[224:227], v[120:123]
buffer_load_dwordx4 v1, s[12:15], s32 offen offset:2048 sc1 lds
M v[124:127], a[144:147], a[240:243], 0
v_exp_f32 v86, v86
M v[124:127], a[140:143], a[236:239], v[124:127]
v_cvt_pk_bf16_f32 v69, v70, v71
v_cvt_pk_bf16_f32 v70, v84, v85
M v[124:127], a[136:139], a[232:235], v[124:127]
v_exp_f32 v87, v87
M v[124:127], a[132:135], a[228:231], v[124:127]
buffer_load_dwordx4 v1, s[12:15], s32 offen offset:3072 sc1 lds
s_waitcnt lgkmcnt(4)
M v[128:131], a[148:151], a[180:183], 0
v_exp_f32 v72, v72
M v[128:131], a[152:155], a[184:187], v[128:131]
s_add_u32 s26, s26, 32768
s_cmp_eq_u32 s26, s62
s_cselect_b32 s26, s63, s26
s_cselect_b32 s62, -1, s62
M v[128:131], a[156:159], a[188:191], v[128:131]
v_exp_f32 v73, v73
M v[128:131], a[160:163], a[192:195], v[128:131]
v_cvt_pk_bf16_f32 v71, v86, v87
v_cvt_pk_bf16_f32 v72, v72, v73
M v[132:135], a[160:163], a[208:211], 0
v_exp_f32 v74, v74
M v[132:135], a[156:159], a[204:207], v[132:135]
M v[132:135], a[152:155], a[200:203], v[132:135]
v_exp_f32 v75, v75
M v[132:135], a[148:151], a[196:199], v[132:135]
v_cvt_pk_bf16_f32 v73, v74, v75
M v[136:139], a[148:151], a[212:215], 0
v_exp_f32 v88, v88
M v[136:139], a[152:155], a[216:219], v[136:139]
M v[136:139], a[156:159], a[220:223], v[136:139]
v_exp_f32 v89, v89
M v[136:139], a[160:163], a[224:227], v[136:139]
v_cvt_pk_bf16_f32 v74, v88, v89
M v[140:143], a[160:163], a[240:243], 0
v_exp_f32 v90, v90
M v[140:143], a[156:159], a[236:239], v[140:143]
s_waitcnt vmcnt(16) lgkmcnt(0)
s_barrier
ds_read_b128 a[116:119], v2 offset:32768
ds_read_b128 a[120:123], v2 offset:40960
ds_read_b128 a[124:127], v2 offset:33792
ds_read_b128 a[128:131], v2 offset:41984
M v[140:143], a[152:155], a[232:235], v[140:143]
v_exp_f32 v91, v91
M v[140:143], a[148:151], a[228:231], v[140:143]
v_cvt_pk_bf16_f32 v75, v90, v91
M v[144:147], a[164:167], a[180:183], 0
v_exp_f32 v76, v76
M v[144:147], a[168:171], a[184:187], v[144:147]
ds_read_b128 a[132:135], v2 offset:34816
ds_read_b128 a[136:139], v2 offset:43008
M v[144:147], a[172:175], a[188:191], v[144:147]
v_exp_f32 v77, v77
M v[144:147], a[176:179], a[192:195], v[144:147]
v_cvt_pk_bf16_f32 v76, v76, v77
M v[148:151], a[176:179], a[208:211], 0
v_exp_f32 v78, v78
M v[148:151], a[172:175], a[204:207], v[148:151]
M v[148:151], a[168:171], a[200:203], v[148:151]
v_exp_f32 v79, v79
M v[148:151], a[164:167], a[196:199], v[148:151]
v_cvt_pk_bf16_f32 v77, v78, v79
M v[152:155], a[164:167], a[212:215], 0
v_exp_f32 v92, v92
M v[152:155], a[168:171], a[216:219], v[152:155]
ds_read_b128 a[140:143], v2 offset:35840
ds_read_b128 a[144:147], v2 offset:44032
M v[152:155], a[172:175], a[220:223], v[152:155]
v_exp_f32 v93, v93
M v[152:155], a[176:179], a[224:227], v[152:155]
v_cvt_pk_bf16_f32 v78, v92, v93
M v[156:159], a[176:179], a[240:243], 0
v_exp_f32 v94, v94
M v[156:159], a[172:175], a[236:239], v[156:159]
M v[156:159], a[168:171], a[232:235], v[156:159]
v_exp_f32 v95, v95
M v[156:159], a[164:167], a[228:231], v[156:159]
v_cvt_pk_bf16_f32 v79, v94, v95
s_waitcnt lgkmcnt(6)
s_add_u32 m0, s29, 0
M v[160:163], a[116:119], v[32:35], 0
v_exp_f32 v96, v96
M v[160:163], a[120:123], v[64:67], v[160:163]
ds_read_b128 a[148:151], v2 offset:36864
ds_read_b128 a[152:155], v2 offset:45056
M v[164:167], a[120:123], v[68:71], 0
v_exp_f32 v97, v97
M v[164:167], a[116:119], v[36:39], v[164:167]
buffer_load_dwordx4 v1, s[12:15], s25 offen offset:0 sc1 lds
s_add_u32 s32, s25, 4096
M v[168:171], a[116:119], v[40:43], 0
v_exp_f32 v98, v98
M v[168:171], a[120:123], v[72:75], v[168:171]
v_cvt_pk_bf16_f32 v96, v96, v97
M v[172:175], a[120:123], v[76:79], 0
v_exp_f32 v99, v99
M v[172:175], a[116:119], v[44:47], v[172:175]
buffer_load_dwordx4 v1, s[12:15], s25 offen offset:1024 sc1 lds
s_waitcnt lgkmcnt(6)
M a[96:99], a[112:115], v[32:35], 0
M a[96:99], a[112:115], v[64:67], a[96:99]
M v[176:179], a[124:127], v[32:35], 0
v_exp_f32 v112, v112
M v[176:179], a[128:131], v[64:67], v[176:179]
ds_read_b128 a[156:159], v2 offset:37888
ds_read_b128 a[160:163], v2 offset:46080
M v[180:183], a[128:131], v[68:71], 0
v_exp_f32 v113, v113
M v[180:183], a[124:127], v[36:39], v[180:183]
buffer_load_dwordx4 v1, s[12:15], s25 offen offset:2048 sc1 lds
M v[184:187], a[124:127], v[40:43], 0
v_exp_f32 v114, v114
M v[184:187], a[128:131], v[72:75], v[184:187]
v_cvt_pk_bf16_f32 v97, v98, v99
v_cvt_pk_bf16_f32 v98, v112, v113
M v[188:191], a[128:131], v[76:79], 0
v_exp_f32 v115, v115
M v[188:191], a[124:127], v[44:47], v[188:191]
buffer_load_dwordx4 v1, s[12:15], s25 offen offset:3072 sc1 lds
s_add_u32 m0, s29, 4096
s_waitcnt lgkmcnt(6)
M a[100:103], a[112:115], v[36:39], 0
M a[100:103], a[112:115], v[68:71], a[100:103]
M v[192:195], a[132:135], v[32:35], 0
v_exp_f32 v100, v100
M v[192:195], a[136:139], v[64:67], v[192:195]
ds_read_b128 a[164:167], v2 offset:38912
ds_read_b128 a[168:171], v2 offset:47104
M v[196:199], a[136:139], v[68:71], 0
v_exp_f32 v101, v101
M v[196:199], a[132:135], v[36:39], v[196:199]
buffer_load_dwordx4 v1, s[12:15], s32 offen offset:0 sc1 lds
M v[200:203], a[132:135], v[40:43], 0
v_exp_f32 v102, v102
M v[200:203], a[136:139], v[72:75], v[200:203]
v_cvt_pk_bf16_f32 v99, v114, v115
v_cvt_pk_bf16_f32 v100, v100, v101
M v[204:207], a[136:139], v[76:79], 0
v_exp_f32 v103, v103
M v[204:207], a[132:135], v[44:47], v[204:207]
buffer_load_dwordx4 v1, s[12:15], s32 offen offset:1024 sc1 lds
s_waitcnt lgkmcnt(6)
M a[104:107], a[112:115], v[40:43], 0
M a[104:107], a[112:115], v[72:75], a[104:107]
M v[208:211], a[140:143], v[32:35], 0
v_exp_f32 v116, v116
M v[208:211], a[144:147], v[64:67], v[208:211]
ds_read_b128 a[172:175], v2 offset:39936
ds_read_b128 a[176:179], v2 offset:48128
M v[212:215], a[144:147], v[68:71], 0
v_exp_f32 v117, v117
M v[212:215], a[140:143], v[36:39], v[212:215]
buffer_load_dwordx4 v1, s[12:15], s32 offen offset:2048 sc1 lds
M v[216:219], a[140:143], v[40:43], 0
v_exp_f32 v118, v118
M v[216:219], a[144:147], v[72:75], v[216:219]
v_cvt_pk_bf16_f32 v101, v102, v103
v_cvt_pk_bf16_f32 v102, v116, v117
M v[220:223], a[144:147], v[76:79], 0
v_exp_f32 v119, v119
M v[220:223], a[140:143], v[44:47], v[220:223]
buffer_load_dwordx4 v1, s[12:15], s32 offen offset:3072 sc1 lds
s_waitcnt lgkmcnt(6)
M a[108:111], a[112:115], v[44:47], 0
M a[108:111], a[112:115], v[76:79], a[108:111]
M v[224:227], a[148:151], v[32:35], 0
v_exp_f32 v104, v104
M v[224:227], a[152:155], v[64:67], v[224:227]
s_add_u32 s25, s25, 32768
s_cmp_eq_u32 s25, s27
s_cselect_b32 s25, s28, s25
s_cselect_b32 s27, -1, s27
M v[228:231], a[152:155], v[68:71], 0
v_exp_f32 v105, v105
M v[228:231], a[148:151], v[36:39], v[228:231]
v_cvt_pk_bf16_f32 v103, v118, v119
v_cvt_pk_bf16_f32 v104, v104, v105
M v[232:235], a[148:151], v[40:43], 0
v_exp_f32 v106, v106
M v[232:235], a[152:155], v[72:75], v[232:235]
M v[236:239], a[152:155], v[76:79], 0
v_exp_f32 v107, v107
M v[236:239], a[148:151], v[44:47], v[236:239]
v_cvt_pk_bf16_f32 v105, v106, v107
s_waitcnt lgkmcnt(4)
M v[240:243], a[156:159], v[32:35], 0
v_exp_f32 v120, v120
M v[240:243], a[160:163], v[64:67], v[240:243]
M v[244:247], a[160:163], v[68:71], 0
v_exp_f32 v121, v121
M v[244:247], a[156:159], v[36:39], v[244:247]
v_cvt_pk_bf16_f32 v106, v120, v121
M v[248:251], a[156:159], v[40:43], 0
v_exp_f32 v122, v122
M v[248:251], a[160:163], v[72:75], v[248:251]
s_waitcnt vmcnt(16) lgkmcnt(0)
s_barrier
ds_read_b128 a[116:119], v3 offset:0
ds_read_b128 a[120:123], v3 offset:1024
ds_read_b128 a[124:127], v3 offset:2048
ds_read_b128 a[128:131], v3 offset:3072
M v[252:255], a[160:163], v[76:79], 0
v_exp_f32 v123, v123
M v[252:255], a[156:159], v[44:47], v[252:255]
v_cvt_pk_bf16_f32 v107, v122, v123
M a[64:67], a[164:167], v[32:35], 0
v_exp_f32 v108, v108
M a[64:67], a[168:171], v[64:67], a[64:67]
ds_read_b128 a[132:135], v3 offset:4096
ds_read_b128 a[136:139], v3 offset:5120
M a[68:71], a[168:171], v[68:71], 0
v_exp_f32 v109, v109
M a[68:71], a[164:167], v[36:39], a[68:71]
v_cvt_pk_bf16_f32 v108, v108, v109
M a[72:75], a[164:167], v[40:43], 0
v_exp_f32 v110, v110
M a[72:75], a[168:171], v[72:75], a[72:75]
M a[76:79], a[168:171], v[76:79], 0
v_exp_f32 v111, v111
M a[76:79], a[164:167], v[44:47], a[76:79]
v_cvt_pk_bf16_f32 v109, v110, v111
M a[80:83], a[172:175], v[32:35], 0
v_exp_f32 v124, v124
M a[80:83], a[176:179], v[64:67], a[80:83]
ds_read_b128 a[140:143], v3 offset:6144
ds_read_b128 a[144:147], v3 offset:7168
M a[84:87], a[176:179], v[68:71], 0
v_exp_f32 v125, v125
M a[84:87], a[172:175], v[36:39], a[84:87]
v_cvt_pk_bf16_f32 v110, v124, v125
M a[88:91], a[172:175], v[40:43], 0
v_exp_f32 v126, v126
M a[88:91], a[176:179], v[72:75], a[88:91]
M a[92:95], a[176:179], v[76:79], 0
v_exp_f32 v127, v127
M a[92:95], a[172:175], v[44:47], a[92:95]
v_cvt_pk_bf16_f32 v111, v126, v127
s_branch Lk2_l2b
Lk2_l2:
s_waitcnt lgkmcnt(4)
s_add_u32 m0, s29, 98304
M v[96:99], a[116:119], a[180:183], 0
v_exp_f32 v64, v64
M v[96:99], a[120:123], a[184:187], v[96:99]
ds_read_b128 a[148:151], v2 offset:8192
ds_read_b128 a[152:155], v2 offset:9216
M v[96:99], a[124:127], a[188:191], v[96:99]
v_exp_f32 v65, v65
M v[96:99], a[128:131], a[192:195], v[96:99]
buffer_load_dwordx4 v1, s[12:15], s26 offen offset:0 sc1 lds
s_add_u32 s32, s26, 4096
M v[100:103], a[128:131], a[208:211], 0
v_exp_f32 v66, v66
M v[100:103], a[124:127], a[204:207], v[100:103]
v_cvt_pk_bf16_f32 v64, v64, v65
M v[100:103], a[120:123], a[200:203], v[100:103]
v_exp_f32 v67, v67
M v[100:103], a[116:119], a[196:199], v[100:103]
buffer_load_dwordx4 v1, s[12:15], s26 offen offset:1024 sc1 lds
M v[104:107], a[116:119], a[212:215], 0
v_exp_f32 v80, v80
M v[104:107], a[120:123], a[216:219], v[104:107]
ds_read_b128 a[156:159], v2 offset:10240
ds_read_b128 a[160:163], v2 offset:11264
M v[104:107], a[124:127], a[220:223], v[104:107]
v_exp_f32 v81, v81
M v[104:107], a[128:131], a[224:227], v[104:107]
buffer_load_dwordx4 v1, s[12:15], s26 offen offset:2048 sc1 lds
M v[108:111], a[128:131], a[240:243], 0
v_exp_f32 v82, v82
M v[108:111], a[124:127], a[236:239], v[108:111]
v_cvt_pk_bf16_f32 v65, v66, v67
v_cvt_pk_bf16_f32 v66, v80, v81
M v[108:111], a[120:123], a[232:235], v[108:111]
v_exp_f32 v83, v83
M v[108:111], a[116:119], a[228:231], v[108:111]
buffer_load_dwordx4 v1, s[12:15], s26 offen offset:3072 sc1 lds
s_add_u32 m0, s29, 102400
s_waitcnt lgkmcnt(4)
M v[112:115], a[132:135], a[180:183], 0
v_exp_f32 v68, v68
M v[112:115], a[136:139], a[184:187], v[112:115]
ds_read_b128 a[164:167], v2 offset:12288
ds_read_b128 a[168:171], v2 offset:13312
M v[112:115], a[140:143], a[188:191], v[112:115]
v_exp_f32 v69, v69
M v[112:115], a[144:147], a[192:195], v[112:115]
buffer_load_dwordx4 v1, s[12:15], s32 offen offset:0 sc1 lds
M v[116:119], a[144:147], a[208:211], 0
v_exp_f32 v70, v70
M v[116:119], a[140:143], a[204:207], v[116:119]
v_cvt_pk_bf16_f32 v67, v82, v83
v_cvt_pk_bf16_f32 v68, v68, v69
M v[116:119], a[136:139], a[200:203], v[116:119]
v_exp_f32 v71, v71
M v[116:119], a[132:135], a[196:199], v[116:119]
buffer_load_dwordx4 v1, s[12:15], s32 offen offset:1024 sc1 lds
M v[120:123], a[132:135], a[212:215], 0
v_exp_f32 v84, v84
M v[120:123], a[136:139], a[216:219], v[120:123]
ds_read_b128 a[172:175], v2 offset:14336
ds_read_b128 a[176:179], v2 offset:15360
M v[120:123], a[140:143], a[220:223], v[120:123]
v_exp_f32 v85, v85
M v[120:123], a[144:147], a[224:227], v[120:123]
buffer_load_dwordx4 v1, s[12:15], s32 offen offset:2048 sc1 lds
M v[124:127], a[144:147], a[240:243], 0
v_exp_f32 v86, v86
M v[124:127], a[140:143], a[236:239], v[124:127]
v_cvt_pk_bf16_f32 v69, v70, v71
v_cvt_pk_bf16_f32 v70, v84, v85
M v[124:127], a[136:139], a[232:235], v[124:127]
v_exp_f32 v87, v87
M v[124:127], a[132:135], a[228:231], v[124:127]
buffer_load_dwordx4 v1, s[12:15], s32 offen offset:3072 sc1 lds
s_waitcnt lgkmcnt(4)
M v[128:131], a[148:151], a[180:183], 0
v_exp_f32 v72, v72
M v[128:131], a[152:155], a[184:187], v[128:131]
s_add_u32 s26, s26, 32768
s_cmp_eq_u32 s26, s62
s_cselect_b32 s26, s63, s26
s_cselect_b32 s62, -1, s62
M v[128:131], a[156:159], a[188:191], v[128:131]
v_exp_f32 v73, v73
M v[128:131], a[160:163], a[192:195], v[128:131]
v_cvt_pk_bf16_f32 v71, v86, v87
v_cvt_pk_bf16_f32 v72, v72, v73
M v[132:135], a[160:163], a[208:211], 0
v_exp_f32 v74, v74
M v[132:135], a[156:159], a[204:207], v[132:135]
M v[132:135], a[152:155], a[200:203], v[132:135]
v_exp_f32 v75, v75
M v[132:135], a[148:151], a[196:199], v[132:135]
v_cvt_pk_bf16_f32 v73, v74, v75
M v[136:139], a[148:151], a[212:215], 0
v_exp_f32 v88, v88
M v[136:139], a[152:155], a[216:219], v[136:139]
M v[136:139], a[156:159], a[220:223], v[136:139]
v_exp_f32 v89, v89
M v[136:139], a[160:163], a[224:227], v[136:139]
v_cvt_pk_bf16_f32 v74, v88, v89
M v[140:143], a[160:163], a[240:243], 0
v_exp_f32 v90, v90
M v[140:143], a[156:159], a[236:239], v[140:143]
s_waitcnt vmcnt(16) lgkmcnt(0)
s_barrier
ds_read_b128 a[116:119], v2 offset:32768
ds_read_b128 a[120:123], v2 offset:40960
ds_read_b128 a[124:127], v2 offset:33792
ds_read_b128 a[128:131], v2 offset:41984
M v[140:143], a[152:155], a[232:235], v[140:143]
v_exp_f32 v91, v91
M v[140:143], a[148:151], a[228:231], v[140:143]
v_cvt_pk_bf16_f32 v75, v90, v91
M v[144:147], a[164:167], a[180:183], 0
v_exp_f32 v76, v76
M v[144:147], a[168:171], a[184:187], v[144:147]
ds_read_b128 a[132:135], v2 offset:34816
ds_read_b128 a[136:139], v2 offset:43008
M v[144:147], a[172:175], a[188:191], v[144:147]
v_exp_f32 v77, v77
M v[144:147], a[176:179], a[192:195], v[144:147]
v_cvt_pk_bf16_f32 v76, v76, v77
M v[148:151], a[176:179], a[208:211], 0
v_exp_f32 v78, v78
M v[148:151], a[172:175], a[204:207], v[148:151]
M v[148:151], a[168:171], a[200:203], v[148:151]
v_exp_f32 v79, v79
M v[148:151], a[164:167], a[196:199], v[148:151]
v_cvt_pk_bf16_f32 v77, v78, v79
M v[152:155], a[164:167], a[212:215], 0
v_exp_f32 v92, v92
M v[152:155], a[168:171], a[216:219], v[152:155]
ds_read_b128 a[140:143], v2 offset:35840
ds_read_b128 a[144:147], v2 offset:44032
M v[152:155], a[172:175], a[220:223], v[152:155]
v_exp_f32 v93, v93
M v[152:155], a[176:179], a[224:227], v[152:155]
v_cvt_pk_bf16_f32 v78, v92, v93
M v[156:159], a[176:179], a[240:243], 0
v_exp_f32 v94, v94
M v[156:159], a[172:175], a[236:239], v[156:159]
M v[156:159], a[168:171], a[232:235], v[156:159]
v_exp_f32 v95, v95
M v[156:159], a[164:167], a[228:231], v[156:159]
v_cvt_pk_bf16_f32 v79, v94, v95
s_waitcnt lgkmcnt(6)
s_add_u32 m0, s29, 0
M v[160:163], a[116:119], v[32:35], v[160:163]
v_exp_f32 v96, v96
M v[160:163], a[120:123], v[64:67], v[160:163]
ds_read_b128 a[148:151], v2 offset:36864
ds_read_b128 a[152:155], v2 offset:45056
M v[164:167], a[120:123], v[68:71], v[164:167]
v_exp_f32 v97, v97
M v[164:167], a[116:119], v[36:39], v[164:167]
buffer_load_dwordx4 v1, s[12:15], s25 offen offset:0 sc1 lds
s_add_u32 s32, s25, 4096
M v[168:171], a[116:119], v[40:43], v[168:171]
v_exp_f32 v98, v98
M v[168:171], a[120:123], v[72:75], v[168:171]
v_cvt_pk_bf16_f32 v96, v96, v97
M v[172:175], a[120:123], v[76:79], v[172:175]
v_exp_f32 v99, v99
M v[172:175], a[116:119], v[44:47], v[172:175]
buffer_load_dwordx4 v1, s[12:15], s25 offen offset:1024 sc1 lds
s_waitcnt lgkmcnt(6)
M a[96:99], a[112:115], v[32:35], a[96:99]
M a[96:99], a[112:115], v[64:67], a[96:99]
M v[176:179], a[124:127], v[32:35], v[176:179]
v_exp_f32 v112, v112
M v[176:179], a[128:131], v[64:67], v[176:179]
ds_read_b128 a[156:159], v2 offset:37888
ds_read_b128 a[160:163], v2 offset:46080
M v[180:183], a[128:131], v[68:71], v[180:183]
v_exp_f32 v113, v113
M v[180:183], a[124:127], v[36:39], v[180:183]
buffer_load_dwordx4 v1, s[12:15], s25 offen offset:2048 sc1 lds
M v[184:187], a[124:127], v[40:43], v[184:187]
v_exp_f32 v114, v114
M v[184:187], a[128:131], v[72:75], v[184:187]
v_cvt_pk_bf16_f32 v97, v98, v99
v_cvt_pk_bf16_f32 v98, v112, v113
M v[188:191], a[128:131], v[76:79], v[188:191]
v_exp_f32 v115, v115
M v[188:191], a[124:127], v[44:47], v[188:191]
buffer_load_dwordx4 v1, s[12:15], s25 offen offset:3072 sc1 lds
s_add_u32 m0, s29, 4096
s_waitcnt lgkmcnt(6)
M a[100:103], a[112:115], v[36:39], a[100:103]
M a[100:103], a[112:115], v[68:71], a[100:103]
M v[192:195], a[132:135], v[32:35], v[192:195]
v_exp_f32 v100, v100
M v[192:195], a[136:139], v[64:67], v[192:195]
ds_read_b128 a[164:167], v2 offset:38912
ds_read_b128 a[168:171], v2 offset:47104
M v[196:199], a[136:139], v[68:71], v[196:199]
v_exp_f32 v101, v101
M v[196:199], a[132:135], v[36:39], v[196:199]
buffer_load_dwordx4 v1, s[12:15], s32 offen offset:0 sc1 lds
M v[200:203], a[132:135], v[40:43], v[200:203]
v_exp_f32 v102, v102
M v[200:203], a[136:139], v[72:75], v[200:203]
v_cvt_pk_bf16_f32 v99, v114, v115
v_cvt_pk_bf16_f32 v100, v100, v101
M v[204:207], a[136:139], v[76:79], v[204:207]
v_exp_f32 v103, v103
M v[204:207], a[132:135], v[44:47], v[204:207]
buffer_load_dwordx4 v1, s[12:15], s32 offen offset:1024 sc1 lds
s_waitcnt lgkmcnt(6)
M a[104:107], a[112:115], v[40:43], a[104:107]
M a[104:107], a[112:115], v[72:75], a[104:107]
M v[208:211], a[140:143], v[32:35], v[208:211]
v_exp_f32 v116, v116
M v[208:211], a[144:147], v[64:67], v[208:211]
ds_read_b128 a[172:175], v2 offset:39936
ds_read_b128 a[176:179], v2 offset:48128
M v[212:215], a[144:147], v[68:71], v[212:215]
v_exp_f32 v117, v117
M v[212:215], a[140:143], v[36:39], v[212:215]
buffer_load_dwordx4 v1, s[12:15], s32 offen offset:2048 sc1 lds
M v[216:219], a[140:143], v[40:43], v[216:219]
v_exp_f32 v118, v118
M v[216:219], a[144:147], v[72:75], v[216:219]
v_cvt_pk_bf16_f32 v101, v102, v103
v_cvt_pk_bf16_f32 v102, v116, v117
M v[220:223], a[144:147], v[76:79], v[220:223]
v_exp_f32 v119, v119
M v[220:223], a[140:143], v[44:47], v[220:223]
buffer_load_dwordx4 v1, s[12:15], s32 offen offset:3072 sc1 lds
s_waitcnt lgkmcnt(6)
M a[108:111], a[112:115], v[44:47], a[108:111]
M a[108:111], a[112:115], v[76:79], a[108:111]
M v[224:227], a[148:151], v[32:35], v[224:227]
v_exp_f32 v104, v104
M v[224:227], a[152:155], v[64:67], v[224:227]
s_add_u32 s25, s25, 32768
s_cmp_eq_u32 s25, s27
s_cselect_b32 s25, s28, s25
s_cselect_b32 s27, -1, s27
M v[228:231], a[152:155], v[68:71], v[228:231]
v_exp_f32 v105, v105
M v[228:231], a[148:151], v[36:39], v[228:231]
v_cvt_pk_bf16_f32 v103, v118, v119
v_cvt_pk_bf16_f32 v104, v104, v105
M v[232:235], a[148:151], v[40:43], v[232:235]
v_exp_f32 v106, v106
M v[232:235], a[152:155], v[72:75], v[232:235]
M v[236:239], a[152:155], v[76:79], v[236:239]
v_exp_f32 v107, v107
M v[236:239], a[148:151], v[44:47], v[236:239]
v_cvt_pk_bf16_f32 v105, v106, v107
s_waitcnt lgkmcnt(4)
M v[240:243], a[156:159], v[32:35], v[240:243]
v_exp_f32 v120, v120
M v[240:243], a[160:163], v[64:67], v[240:243]
M v[244:247], a[160:163], v[68:71], v[244:247]
v_exp_f32 v121, v121
M v[244:247], a[156:159], v[36:39], v[244:247]
v_cvt_pk_bf16_f32 v106, v120, v121
M v[248:251], a[156:159], v[40:43], v[248:251]
v_exp_f32 v122, v122
M v[248:251], a[160:163], v[72:75], v[248:251]
s_waitcnt vmcnt(16) lgkmcnt(0)
s_barrier
ds_read_b128 a[116:119], v3 offset:0
ds_read_b128 a[120:123], v3 offset:1024
ds_read_b128 a[124:127], v3 offset:2048
ds_read_b128 a[128:131], v3 offset:3072
M v[252:255], a[160:163], v[76:79], v[252:255]
v_exp_f32 v123, v123
M v[252:255], a[156:159], v[44:47], v[252:255]
v_cvt_pk_bf16_f32 v107, v122, v123
M a[64:67], a[164:167], v[32:35], a[64:67]
v_exp_f32 v108, v108
M a[64:67], a[168:171], v[64:67], a[64:67]
ds_read_b128 a[132:135], v3 offset:4096
ds_read_b128 a[136:139], v3 offset:5120
M a[68:71], a[168:171], v[68:71], a[68:71]
v_exp_f32 v109, v109
M a[68:71], a[164:167], v[36:39], a[68:71]
v_cvt_pk_bf16_f32 v108, v108, v109
M a[72:75], a[164:167], v[40:43], a[72:75]
v_exp_f32 v110, v110
M a[72:75], a[168:171], v[72:75], a[72:75]
M a[76:79], a[168:171], v[76:79], a[76:79]
v_exp_f32 v111, v111
M a[76:79], a[164:167], v[44:47], a[76:79]
v_cvt_pk_bf16_f32 v109, v110, v111
M a[80:83], a[172:175], v[32:35], a[80:83]
v_exp_f32 v124, v124
M a[80:83], a[176:179], v[64:67], a[80:83]
ds_read_b128 a[140:143], v3 offset:6144
ds_read_b128 a[144:147], v3 offset:7168
M a[84:87], a[176:179], v[68:71], a[84:87]
v_exp_f32 v125, v125
M a[84:87], a[172:175], v[36:39], a[84:87]
v_cvt_pk_bf16_f32 v110, v124, v125
M a[88:91], a[172:175], v[40:43], a[88:91]
v_exp_f32 v126, v126
M a[88:91], a[176:179], v[72:75], a[88:91]
M a[92:95], a[176:179], v[76:79], a[92:95]
v_exp_f32 v127, v127
M a[92:95], a[172:175], v[44:47], a[92:95]
v_cvt_pk_bf16_f32 v111, v126, v127
Lk2_l2b:
s_waitcnt lgkmcnt(4)
s_add_u32 m0, s29, 32768
M v[32:35], a[116:119], a[180:183], 0
v_exp_f32 v128, v128
M v[32:35], a[120:123], a[184:187], v[32:35]
ds_read_b128 a[148:151], v3 offset:8192
ds_read_b128 a[152:155], v3 offset:9216
M v[32:35], a[124:127], a[188:191], v[32:35]
v_exp_f32 v129, v129
M v[32:35], a[128:131], a[192:195], v[32:35]
buffer_load_dwordx4 v1, s[12:15], s26 offen offset:0 sc1 lds
s_add_u32 s32, s26, 4096
M v[36:39], a[128:131], a[208:211], 0
v_exp_f32 v130, v130
M v[36:39], a[124:127], a[204:207], v[36:39]
v_cvt_pk_bf16_f32 v128, v128, v129
M v[36:39], a[120:123], a[200:203], v[36:39]
v_exp_f32 v131, v131
M v[36:39], a[116:119], a[196:199], v[36:39]
buffer_load_dwordx4 v1, s[12:15], s26 offen offset:1024 sc1 lds
M v[40:43], a[116:119], a[212:215], 0
v_exp_f32 v144, v144
M v[40:43], a[120:123], a[216:219], v[40:43]
ds_read_b128 a[156:159], v3 offset:10240
ds_read_b128 a[160:163], v3 offset:11264
M v[40:43], a[124:127], a[220:223], v[40:43]
v_exp_f32 v145, v145
M v[40:43], a[128:131], a[224:227], v[40:43]
buffer_load_dwordx4 v1, s[12:15], s26 offen offset:2048 sc1 lds
M v[44:47], a[128:131], a[240:243], 0
v_exp_f32 v146, v146
M v[44:47], a[124:127], a[236:239], v[44:47]
v_cvt_pk_bf16_f32 v129, v130, v131
v_cvt_pk_bf16_f32 v130, v144, v145
M v[44:47], a[120:123], a[232:235], v[44:47]
v_exp_f32 v147, v147
M v[44:47], a[116:119], a[228:231], v[44:47]
buffer_load_dwordx4 v1, s[12:15], s26 offen offset:3072 sc1 lds
s_add_u32 m0, s29, 36864
s_waitcnt lgkmcnt(4)
M v[48:51], a[132:135], a[180:183], 0
v_exp_f32 v132, v132
M v[48:51], a[136:139], a[184:187], v[48:51]
ds_read_b128 a[164:167], v3 offset:12288
ds_read_b128 a[168:171], v3 offset:13312
M v[48:51], a[140:143], a[188:191], v[48:51]
v_exp_f32 v133, v133
M v[48:51], a[144:147], a[192:195], v[48:51]
buffer_load_dwordx4 v1, s[12:15], s32 offen offset:0 sc1 lds
M v[52:55], a[144:147], a[208:211], 0
v_exp_f32 v134, v134
M v[52:55], a[140:143], a[204:207], v[52:55]
v_cvt_pk_bf16_f32 v131, v146, v147
v_cvt_pk_bf16_f32 v132, v132, v133
M v[52:55], a[136:139], a[200:203], v[52:55]
v_exp_f32 v135, v135
M v[52:55], a[132:135], a[196:199], v[52:55]
buffer_load_dwordx4 v1, s[12:15], s32 offen offset:1024 sc1 lds
M v[56:59], a[132:135], a[212:215], 0
v_exp_f32 v148, v148
M v[56:59], a[136:139], a[216:219], v[56:59]
ds_read_b128 a[172:175], v3 offset:14336
ds_read_b128 a[176:179], v3 offset:15360
M v[56:59], a[140:143], a[220:223], v[56:59]
v_exp_f32 v149, v149
M v[56:59], a[144:147], a[224:227], v[56:59]
buffer_load_dwordx4 v1, s[12:15], s32 offen offset:2048 sc1 lds
M v[60:63], a[144:147], a[240:243], 0
v_exp_f32 v150, v150
M v[60:63], a[140:143], a[236:239], v[60:63]
v_cvt_pk_bf16_f32 v133, v134, v135
v_cvt_pk_bf16_f32 v134, v148, v149
M v[60:63], a[136:139], a[232:235], v[60:63]
v_exp_f32 v151, v151
M v[60:63], a[132:135], a[228:231], v[60:63]
buffer_load_dwordx4 v1, s[12:15], s32 offen offset:3072 sc1 lds
s_waitcnt lgkmcnt(4)
M v[64:67], a[148:151], a[180:183], 0
v_exp_f32 v136, v136
M v[64:67], a[152:155], a[184:187], v[64:67]
s_add_u32 s26, s26, 32768
s_cmp_eq_u32 s26, s62
s_cselect_b32 s26, s63, s26
s_cselect_b32 s62, -1, s62
M v[64:67], a[156:159], a[188:191], v[64:67]
v_exp_f32 v137, v137
M v[64:67], a[160:163], a[192:195], v[64:67]
v_cvt_pk_bf16_f32 v135, v150, v151
v_cvt_pk_bf16_f32 v136, v136, v137
M v[68:71], a[160:163], a[208:211], 0
v_exp_f32 v138, v138
M v[68:71], a[156:159], a[204:207], v[68:71]
M v[68:71], a[152:155], a[200:203], v[68:71]
v_exp_f32 v139, v139
M v[68:71], a[148:151], a[196:199], v[68:71]
v_cvt_pk_bf16_f32 v137, v138, v139
M v[72:75], a[148:151], a[212:215], 0
v_exp_f32 v152, v152
M v[72:75], a[152:155], a[216:219], v[72:75]
M v[72:75], a[156:159], a[220:223], v[72:75]
v_exp_f32 v153, v153
M v[72:75], a[160:163], a[224:227], v[72:75]
v_cvt_pk_bf16_f32 v138, v152, v153
M v[76:79], a[160:163], a[240:243], 0
v_exp_f32 v154, v154
M v[76:79], a[156:159], a[236:239], v[76:79]
s_waitcnt vmcnt(16) lgkmcnt(0)
s_barrier
ds_read_b128 a[116:119], v3 offset:32768
ds_read_b128 a[120:123], v3 offset:40960
ds_read_b128 a[124:127], v3 offset:33792
ds_read_b128 a[128:131], v3 offset:41984
M v[76:79], a[152:155], a[232:235], v[76:79]
v_exp_f32 v155, v155
M v[76:79], a[148:151], a[228:231], v[76:79]
v_cvt_pk_bf16_f32 v139, v154, v155
M v[80:83], a[164:167], a[180:183], 0
v_exp_f32 v140, v140
M v[80:83], a[168:171], a[184:187], v[80:83]
ds_read_b128 a[132:135], v3 offset:34816
ds_read_b128 a[136:139], v3 offset:43008
M v[80:83], a[172:175], a[188:191], v[80:83]
v_exp_f32 v141, v141
M v[80:83], a[176:179], a[192:195], v[80:83]
v_cvt_pk_bf16_f32 v140, v140, v141
M v[84:87], a[176:179], a[208:211], 0
v_exp_f32 v142, v142
M v[84:87], a[172:175], a[204:207], v[84:87]
M v[84:87], a[168:171], a[200:203], v[84:87]
v_exp_f32 v143, v143
M v[84:87], a[164:167], a[196:199], v[84:87]
v_cvt_pk_bf16_f32 v141, v142, v143
M v[88:91], a[164:167], a[212:215], 0
v_exp_f32 v156, v156
M v[88:91], a[168:171], a[216:219], v[88:91]
ds_read_b128 a[140:143], v3 offset:35840
ds_read_b128 a[144:147], v3 offset:44032
M v[88:91], a[172:175], a[220:223], v[88:91]
v_exp_f32 v157, v157
M v[88:91], a[176:179], a[224:227], v[88:91]
v_cvt_pk_bf16_f32 v142, v156, v157
M v[92:95], a[176:179], a[240:243], 0
v_exp_f32 v158, v158
M v[92:95], a[172:175], a[236:239], v[92:95]
M v[92:95], a[168:171], a[232:235], v[92:95]
v_exp_f32 v159, v159
M v[92:95], a[164:167], a[228:231], v[92:95]
v_cvt_pk_bf16_f32 v143, v158, v159
s_waitcnt lgkmcnt(6)
s_add_u32 m0, s29, 65536
M v[160:163], a[116:119], v[96:99], v[160:163]
v_exp_f32 v32, v32
M v[160:163], a[120:123], v[128:131], v[160:163]
ds_read_b128 a[148:151], v3 offset:36864
ds_read_b128 a[152:155], v3 offset:45056
M v[164:167], a[120:123], v[132:135], v[164:167]
v_exp_f32 v33, v33
M v[164:167], a[116:119], v[100:103], v[164:167]
buffer_load_dwordx4 v1, s[12:15], s25 offen offset:0 sc1 lds
s_add_u32 s32, s25, 4096
M v[168:171], a[116:119], v[104:107], v[168:171]
v_exp_f32 v34, v34
M v[168:171], a[120:123], v[136:139], v[168:171]
v_cvt_pk_bf16_f32 v32, v32, v33
M v[172:175], a[120:123], v[140:143], v[172:175]
v_exp_f32 v35, v35
M v[172:175], a[116:119], v[108:111], v[172:175]
buffer_load_dwordx4 v1, s[12:15], s25 offen offset:1024 sc1 lds
s_waitcnt lgkmcnt(6)
M a[96:99], a[112:115], v[96:99], a[96:99]
M a[96:99], a[112:115], v[128:131], a[96:99]
M v[176:179], a[124:127], v[96:99], v[176:179]
v_exp_f32 v48, v48
M v[176:179], a[128:131], v[128:131], v[176:179]
ds_read_b128 a[156:159], v3 offset:37888
ds_read_b128 a[160:163], v3 offset:46080
M v[180:183], a[128:131], v[132:135], v[180:183]
v_exp_f32 v49, v49
M v[180:183], a[124:127], v[100:103], v[180:183]
buffer_load_dwordx4 v1, s[12:15], s25 offen offset:2048 sc1 lds
M v[184:187], a[124:127], v[104:107], v[184:187]
v_exp_f32 v50, v50
M v[184:187], a[128:131], v[136:139], v[184:187]
v_cvt_pk_bf16_f32 v33, v34, v35
v_cvt_pk_bf16_f32 v34, v48, v49
M v[188:191], a[128:131], v[140:143], v[188:191]
v_exp_f32 v51, v51
M v[188:191], a[124:127], v[108:111], v[188:191]
buffer_load_dwordx4 v1, s[12:15], s25 offen offset:3072 sc1 lds
s_add_u32 m0, s29, 69632
s_waitcnt lgkmcnt(6)
M a[100:103], a[112:115], v[100:103], a[100:103]
M a[100:103], a[112:115], v[132:135], a[100:103]
M v[192:195], a[132:135], v[96:99], v[192:195]
v_exp_f32 v36, v36
M v[192:195], a[136:139], v[128:131], v[192:195]
ds_read_b128 a[164:167], v3 offset:38912
ds_read_b128 a[168:171], v3 offset:47104
M v[196:199], a[136:139], v[132:135], v[196:199]
v_exp_f32 v37, v37
M v[196:199], a[132:135], v[100:103], v[196:199]
buffer_load_dwordx4 v1, s[12:15], s32 offen offset:0 sc1 lds
M v[200:203], a[132:135], v[104:107], v[200:203]
v_exp_f32 v38, v38
M v[200:203], a[136:139], v[136:139], v[200:203]
v_cvt_pk_bf16_f32 v35, v50, v51
v_cvt_pk_bf16_f32 v36, v36, v37
M v[204:207], a[136:139], v[140:143], v[204:207]
v_exp_f32 v39, v39
M v[204:207], a[132:135], v[108:111], v[204:207]
buffer_load_dwordx4 v1, s[12:15], s32 offen offset:1024 sc1 lds
s_waitcnt lgkmcnt(6)
M a[104:107], a[112:115], v[104:107], a[104:107]
M a[104:107], a[112:115], v[136:139], a[104:107]
M v[208:211], a[140:143], v[96:99], v[208:211]
v_exp_f32 v52, v52
M v[208:211], a[144:147], v[128:131], v[208:211]
ds_read_b128 a[172:175], v3 offset:39936
ds_read_b128 a[176:179], v3 offset:48128
M v[212:215], a[144:147], v[132:135], v[212:215]
v_exp_f32 v53, v53
M v[212:215], a[140:143], v[100:103], v[212:215]
buffer_load_dwordx4 v1, s[12:15], s32 offen offset:2048 sc1 lds
M v[216:219], a[140:143], v[104:107], v[216:219]
v_exp_f32 v54, v54
M v[216:219], a[144:147], v[136:139], v[216:219]
v_cvt_pk_bf16_f32 v37, v38, v39
v_cvt_pk_bf16_f32 v38, v52, v53
M v[220:223], a[144:147], v[140:143], v[220:223]
v_exp_f32 v55, v55
M v[220:223], a[140:143], v[108:111], v[220:223]
buffer_load_dwordx4 v1, s[12:15], s32 offen offset:3072 sc1 lds
s_waitcnt lgkmcnt(6)
M a[108:111], a[112:115], v[108:111], a[108:111]
M a[108:111], a[112:115], v[140:143], a[108:111]
M v[224:227], a[148:151], v[96:99], v[224:227]
v_exp_f32 v40, v40
M v[224:227], a[152:155], v[128:131], v[224:227]
s_add_u32 s25, s25, 32768
s_cmp_eq_u32 s25, s27
s_cselect_b32 s25, s28, s25
s_cselect_b32 s27, -1, s27
M v[228:231], a[152:155], v[132:135], v[228:231]
v_exp_f32 v41, v41
M v[228:231], a[148:151], v[100:103], v[228:231]
v_cvt_pk_bf16_f32 v39, v54, v55
v_cvt_pk_bf16_f32 v40, v40, v41
M v[232:235], a[148:151], v[104:107], v[232:235]
v_exp_f32 v42, v42
M v[232:235], a[152:155], v[136:139], v[232:235]
M v[236:239], a[152:155], v[140:143], v[236:239]
v_exp_f32 v43, v43
M v[236:239], a[148:151], v[108:111], v[236:239]
v_cvt_pk_bf16_f32 v41, v42, v43
s_waitcnt lgkmcnt(4)
M v[240:243], a[156:159], v[96:99], v[240:243]
v_exp_f32 v56, v56
M v[240:243], a[160:163], v[128:131], v[240:243]
M v[244:247], a[160:163], v[132:135], v[244:247]
v_exp_f32 v57, v57
M v[244:247], a[156:159], v[100:103], v[244:247]
v_cvt_pk_bf16_f32 v42, v56, v57
M v[248:251], a[156:159], v[104:107], v[248:251]
v_exp_f32 v58, v58
M v[248:251], a[160:163], v[136:139], v[248:251]
s_waitcnt vmcnt(16) lgkmcnt(0)
s_barrier
ds_read_b128 a[116:119], v2 offset:0
ds_read_b128 a[120:123], v2 offset:1024
ds_read_b128 a[124:127], v2 offset:2048
ds_read_b128 a[128:131], v2 offset:3072
M v[252:255], a[160:163], v[140:143], v[252:255]
v_exp_f32 v59, v59
M v[252:255], a[156:159], v[108:111], v[252:255]
v_cvt_pk_bf16_f32 v43, v58, v59
M a[64:67], a[164:167], v[96:99], a[64:67]
v_exp_f32 v44, v44
M a[64:67], a[168:171], v[128:131], a[64:67]
ds_read_b128 a[132:135], v2 offset:4096
ds_read_b128 a[136:139], v2 offset:5120
M a[68:71], a[168:171], v[132:135], a[68:71]
v_exp_f32 v45, v45
M a[68:71], a[164:167], v[100:103], a[68:71]
v_cvt_pk_bf16_f32 v44, v44, v45
M a[72:75], a[164:167], v[104:107], a[72:75]
v_exp_f32 v46, v46
M a[72:75], a[168:171], v[136:139], a[72:75]
M a[76:79], a[168:171], v[140:143], a[76:79]
v_exp_f32 v47, v47
M a[76:79], a[164:167], v[108:111], a[76:79]
v_cvt_pk_bf16_f32 v45, v46, v47
M a[80:83], a[172:175], v[96:99], a[80:83]
v_exp_f32 v60, v60
M a[80:83], a[176:179], v[128:131], a[80:83]
ds_read_b128 a[140:143], v2 offset:6144
ds_read_b128 a[144:147], v2 offset:7168
M a[84:87], a[176:179], v[132:135], a[84:87]
v_exp_f32 v61, v61
M a[84:87], a[172:175], v[100:103], a[84:87]
v_cvt_pk_bf16_f32 v46, v60, v61
M a[88:91], a[172:175], v[104:107], a[88:91]
v_exp_f32 v62, v62
M a[88:91], a[176:179], v[136:139], a[88:91]
M a[92:95], a[176:179], v[140:143], a[92:95]
v_exp_f32 v63, v63
M a[92:95], a[172:175], v[108:111], a[92:95]
v_cvt_pk_bf16_f32 v47, v62, v63
s_sub_u32 s30, s30, 1
s_cmp_lg_u32 s30, 0
s_cbranch_scc1 Lk2_l2
s_branch Lk2_fin
s_waitcnt lgkmcnt(0)
Lk2_wm:
s_lshl_b32 s33, s2, 1
s_add_u32 s33, s33, s23
s_lshl_b32 s34, s33, 12
s_lshl_b32 s33, s33, 14
v_lshlrev_b32 v8, 3, v1
v_lshlrev_b32 v9, 2, v1
buffer_load_dword a244, v8, s[44:47], s33 offen
s_add_u32 s33, s33, 8192
buffer_load_dword a245, v8, s[44:47], s33 offen
buffer_load_dword a246, v9, s[48:51], s34 offen
s_branch Lk2_l3b
Lk2_g1:
s_mov_b32 s30, 7
s_bfe_u32 s42, s2, 0x20003
s_add_u32 s42, s42, 2
Lk2_l3:
s_cmp_eq_u32 s30, s42
s_cbranch_scc1 Lk2_wm
Lk2_l3b:
s_waitcnt lgkmcnt(4)
s_add_u32 m0, s29, 98304
M v[96:99], a[116:119], a[0:3], 0
v_exp_f32 v64, v64
M v[96:99], a[120:123], a[4:7], v[96:99]
ds_read_b128 a[148:151], v2 offset:8192
ds_read_b128 a[152:155], v2 offset:9216
M v[96:99], a[124:127], a[8:11], v[96:99]
v_exp_f32 v65, v65
M v[96:99], a[128:131], a[12:15], v[96:99]
buffer_load_dwordx4 v1, s[12:15], s26 offen offset:0 sc1 lds
s_add_u32 s32, s26, 4096
M v[100:103], a[128:131], a[28:31], 0
v_exp_f32 v66, v66
M v[100:103], a[124:127], a[24:27], v[100:103]
v_cvt_pk_bf16_f32 v64, v64, v65
M v[100:103], a[120:123], a[20:23], v[100:103]
v_exp_f32 v67, v67
M v[100:103], a[116:119], a[16:19], v[100:103]
buffer_load_dwordx4 v1, s[12:15], s26 offen offset:1024 sc1 lds
M v[104:107], a[116:119], a[32:35], 0
v_exp_f32 v80, v80
M v[104:107], a[120:123], a[36:39], v[104:107]
ds_read_b128 a[156:159], v2 offset:10240
ds_read_b128 a[160:163], v2 offset:11264
M v[104:107], a[124:127], a[40:43], v[104:107]
v_exp_f32 v81, v81
M v[104:107], a[128:131], a[44:47], v[104:107]
buffer_load_dwordx4 v1, s[12:15], s26 offen offset:2048 sc1 lds
M v[108:111], a[128:131], a[60:63], 0
v_exp_f32 v82, v82
M v[108:111], a[124:127], a[56:59], v[108:111]
v_cvt_pk_bf16_f32 v65, v66, v67
v_cvt_pk_bf16_f32 v66, v80, v81
M v[108:111], a[120:123], a[52:55], v[108:111]
v_exp_f32 v83, v83
M v[108:111], a[116:119], a[48:51], v[108:111]
buffer_load_dwordx4 v1, s[12:15], s26 offen offset:3072 sc1 lds
s_add_u32 m0, s29, 102400
s_waitcnt lgkmcnt(4)
M v[112:115], a[132:135], a[0:3], 0
v_exp_f32 v68, v68
M v[112:115], a[136:139], a[4:7], v[112:115]
ds_read_b128 a[164:167], v2 offset:12288
ds_read_b128 a[168:171], v2 offset:13312
M v[112:115], a[140:143], a[8:11], v[112:115]
v_exp_f32 v69, v69
M v[112:115], a[144:147], a[12:15], v[112:115]
buffer_load_dwordx4 v1, s[12:15], s32 offen offset:0 sc1 lds
M v[116:119], a[144:147], a[28:31], 0
v_exp_f32 v70, v70
M v[116:119], a[140:143], a[24:27], v[116:119]
v_cvt_pk_bf16_f32 v67, v82, v83
v_cvt_pk_bf16_f32 v68, v68, v69
M v[116:119], a[136:139], a[20:23], v[116:119]
v_exp_f32 v71, v71
M v[116:119], a[132:135], a[16:19], v[116:119]
buffer_load_dwordx4 v1, s[12:15], s32 offen offset:1024 sc1 lds
M v[120:123], a[132:135], a[32:35], 0
v_exp_f32 v84, v84
M v[120:123], a[136:139], a[36:39], v[120:123]
ds_read_b128 a[172:175], v2 offset:14336
ds_read_b128 a[176:179], v2 offset:15360
M v[120:123], a[140:143], a[40:43], v[120:123]
v_exp_f32 v85, v85
M v[120:123], a[144:147], a[44:47], v[120:123]
buffer_load_dwordx4 v1, s[12:15], s32 offen offset:2048 sc1 lds
M v[124:127], a[144:147], a[60:63], 0
v_exp_f32 v86, v86
M v[124:127], a[140:143], a[56:59], v[124:127]
v_cvt_pk_bf16_f32 v69, v70, v71
v_cvt_pk_bf16_f32 v70, v84, v85
M v[124:127], a[136:139], a[52:55], v[124:127]
v_exp_f32 v87, v87
M v[124:127], a[132:135], a[48:51], v[124:127]
buffer_load_dwordx4 v1, s[12:15], s32 offen offset:3072 sc1 lds
s_waitcnt lgkmcnt(4)
M v[128:131], a[148:151], a[0:3], 0
v_exp_f32 v72, v72
M v[128:131], a[152:155], a[4:7], v[128:131]
s_add_u32 s26, s26, 32768
s_cmp_eq_u32 s26, s62
s_cselect_b32 s26, s63, s26
s_cselect_b32 s62, -1, s62
M v[128:131], a[156:159], a[8:11], v[128:131]
v_exp_f32 v73, v73
M v[128:131], a[160:163], a[12:15], v[128:131]
v_cvt_pk_bf16_f32 v71, v86, v87
v_cvt_pk_bf16_f32 v72, v72, v73
M v[132:135], a[160:163], a[28:31], 0
v_exp_f32 v74, v74
M v[132:135], a[156:159], a[24:27], v[132:135]
M v[132:135], a[152:155], a[20:23], v[132:135]
v_exp_f32 v75, v75
M v[132:135], a[148:151], a[16:19], v[132:135]
v_cvt_pk_bf16_f32 v73, v74, v75
M v[136:139], a[148:151], a[32:35], 0
v_exp_f32 v88, v88
M v[136:139], a[152:155], a[36:39], v[136:139]
M v[136:139], a[156:159], a[40:43], v[136:139]
v_exp_f32 v89, v89
M v[136:139], a[160:163], a[44:47], v[136:139]
v_cvt_pk_bf16_f32 v74, v88, v89
M v[140:143], a[160:163], a[60:63], 0
v_exp_f32 v90, v90
M v[140:143], a[156:159], a[56:59], v[140:143]
s_waitcnt vmcnt(16) lgkmcnt(0)
s_barrier
ds_read_b128 a[116:119], v2 offset:32768
ds_read_b128 a[120:123], v2 offset:40960
ds_read_b128 a[124:127], v2 offset:33792
ds_read_b128 a[128:131], v2 offset:41984
M v[140:143], a[152:155], a[52:55], v[140:143]
v_exp_f32 v91, v91
M v[140:143], a[148:151], a[48:51], v[140:143]
v_cvt_pk_bf16_f32 v75, v90, v91
M v[144:147], a[164:167], a[0:3], 0
v_exp_f32 v76, v76
M v[144:147], a[168:171], a[4:7], v[144:147]
ds_read_b128 a[132:135], v2 offset:34816
ds_read_b128 a[136:139], v2 offset:43008
M v[144:147], a[172:175], a[8:11], v[144:147]
v_exp_f32 v77, v77
M v[144:147], a[176:179], a[12:15], v[144:147]
v_cvt_pk_bf16_f32 v76, v76, v77
M v[148:151], a[176:179], a[28:31], 0
v_exp_f32 v78, v78
M v[148:151], a[172:175], a[24:27], v[148:151]
M v[148:151], a[168:171], a[20:23], v[148:151]
v_exp_f32 v79, v79
M v[148:151], a[164:167], a[16:19], v[148:151]
v_cvt_pk_bf16_f32 v77, v78, v79
M v[152:155], a[164:167], a[32:35], 0
v_exp_f32 v92, v92
M v[152:155], a[168:171], a[36:39], v[152:155]
ds_read_b128 a[140:143], v2 offset:35840
ds_read_b128 a[144:147], v2 offset:44032
M v[152:155], a[172:175], a[40:43], v[152:155]
v_exp_f32 v93, v93
M v[152:155], a[176:179], a[44:47], v[152:155]
v_cvt_pk_bf16_f32 v78, v92, v93
M v[156:159], a[176:179], a[60:63], 0
v_exp_f32 v94, v94
M v[156:159], a[172:175], a[56:59], v[156:159]
M v[156:159], a[168:171], a[52:55], v[156:159]
v_exp_f32 v95, v95
M v[156:159], a[164:167], a[48:51], v[156:159]
v_cvt_pk_bf16_f32 v79, v94, v95
s_waitcnt lgkmcnt(6)
s_add_u32 m0, s29, 0
M v[160:163], a[116:119], v[32:35], v[160:163]
v_exp_f32 v96, v96
M v[160:163], a[120:123], v[64:67], v[160:163]
ds_read_b128 a[148:151], v2 offset:36864
ds_read_b128 a[152:155], v2 offset:45056
M v[164:167], a[120:123], v[68:71], v[164:167]
v_exp_f32 v97, v97
M v[164:167], a[116:119], v[36:39], v[164:167]
buffer_load_dwordx4 v1, s[12:15], s25 offen offset:0 sc1 lds
s_add_u32 s32, s25, 4096
M v[168:171], a[116:119], v[40:43], v[168:171]
v_exp_f32 v98, v98
M v[168:171], a[120:123], v[72:75], v[168:171]
v_cvt_pk_bf16_f32 v96, v96, v97
M v[172:175], a[120:123], v[76:79], v[172:175]
v_exp_f32 v99, v99
M v[172:175], a[116:119], v[44:47], v[172:175]
buffer_load_dwordx4 v1, s[12:15], s25 offen offset:1024 sc1 lds
s_waitcnt lgkmcnt(6)
M a[96:99], a[112:115], v[32:35], a[96:99]
M a[96:99], a[112:115], v[64:67], a[96:99]
M v[176:179], a[124:127], v[32:35], v[176:179]
v_exp_f32 v112, v112
M v[176:179], a[128:131], v[64:67], v[176:179]
ds_read_b128 a[156:159], v2 offset:37888
ds_read_b128 a[160:163], v2 offset:46080
M v[180:183], a[128:131], v[68:71], v[180:183]
v_exp_f32 v113, v113
M v[180:183], a[124:127], v[36:39], v[180:183]
buffer_load_dwordx4 v1, s[12:15], s25 offen offset:2048 sc1 lds
M v[184:187], a[124:127], v[40:43], v[184:187]
v_exp_f32 v114, v114
M v[184:187], a[128:131], v[72:75], v[184:187]
v_cvt_pk_bf16_f32 v97, v98, v99
v_cvt_pk_bf16_f32 v98, v112, v113
M v[188:191], a[128:131], v[76:79], v[188:191]
v_exp_f32 v115, v115
M v[188:191], a[124:127], v[44:47], v[188:191]
buffer_load_dwordx4 v1, s[12:15], s25 offen offset:3072 sc1 lds
s_add_u32 m0, s29, 4096
s_waitcnt lgkmcnt(6)
M a[100:103], a[112:115], v[36:39], a[100:103]
M a[100:103], a[112:115], v[68:71], a[100:103]
M v[192:195], a[132:135], v[32:35], v[192:195]
v_exp_f32 v100, v100
M v[192:195], a[136:139], v[64:67], v[192:195]
ds_read_b128 a[164:167], v2 offset:38912
ds_read_b128 a[168:171], v2 offset:47104
M v[196:199], a[136:139], v[68:71], v[196:199]
v_exp_f32 v101, v101
M v[196:199], a[132:135], v[36:39], v[196:199]
buffer_load_dwordx4 v1, s[12:15], s32 offen offset:0 sc1 lds
M v[200:203], a[132:135], v[40:43], v[200:203]
v_exp_f32 v102, v102
M v[200:203], a[136:139], v[72:75], v[200:203]
v_cvt_pk_bf16_f32 v99, v114, v115
v_cvt_pk_bf16_f32 v100, v100, v101
M v[204:207], a[136:139], v[76:79], v[204:207]
v_exp_f32 v103, v103
M v[204:207], a[132:135], v[44:47], v[204:207]
buffer_load_dwordx4 v1, s[12:15], s32 offen offset:1024 sc1 lds
s_waitcnt lgkmcnt(6)
M a[104:107], a[112:115], v[40:43], a[104:107]
M a[104:107], a[112:115], v[72:75], a[104:107]
M v[208:211], a[140:143], v[32:35], v[208:211]
v_exp_f32 v116, v116
M v[208:211], a[144:147], v[64:67], v[208:211]
ds_read_b128 a[172:175], v2 offset:39936
ds_read_b128 a[176:179], v2 offset:48128
M v[212:215], a[144:147], v[68:71], v[212:215]
v_exp_f32 v117, v117
M v[212:215], a[140:143], v[36:39], v[212:215]
buffer_load_dwordx4 v1, s[12:15], s32 offen offset:2048 sc1 lds
M v[216:219], a[140:143], v[40:43], v[216:219]
v_exp_f32 v118, v118
M v[216:219], a[144:147], v[72:75], v[216:219]
v_cvt_pk_bf16_f32 v101, v102, v103
v_cvt_pk_bf16_f32 v102, v116, v117
M v[220:223], a[144:147], v[76:79], v[220:223]
v_exp_f32 v119, v119
M v[220:223], a[140:143], v[44:47], v[220:223]
buffer_load_dwordx4 v1, s[12:15], s32 offen offset:3072 sc1 lds
s_waitcnt lgkmcnt(6)
M a[108:111], a[112:115], v[44:47], a[108:111]
M a[108:111], a[112:115], v[76:79], a[108:111]
M v[224:227], a[148:151], v[32:35], v[224:227]
v_exp_f32 v104, v104
M v[224:227], a[152:155], v[64:67], v[224:227]
s_add_u32 s25, s25, 32768
s_cmp_eq_u32 s25, s27
s_cselect_b32 s25, s28, s25
s_cselect_b32 s27, -1, s27
M v[228:231], a[152:155], v[68:71], v[228:231]
v_exp_f32 v105, v105
M v[228:231], a[148:151], v[36:39], v[228:231]
v_cvt_pk_bf16_f32 v103, v118, v119
v_cvt_pk_bf16_f32 v104, v104, v105
M v[232:235], a[148:151], v[40:43], v[232:235]
v_exp_f32 v106, v106
M v[232:235], a[152:155], v[72:75], v[232:235]
M v[236:239], a[152:155], v[76:79], v[236:239]
v_exp_f32 v107, v107
M v[236:239], a[148:151], v[44:47], v[236:239]
v_cvt_pk_bf16_f32 v105, v106, v107
s_waitcnt lgkmcnt(4)
M v[240:243], a[156:159], v[32:35], v[240:243]
v_exp_f32 v120, v120
M v[240:243], a[160:163], v[64:67], v[240:243]
M v[244:247], a[160:163], v[68:71], v[244:247]
v_exp_f32 v121, v121
M v[244:247], a[156:159], v[36:39], v[244:247]
v_cvt_pk_bf16_f32 v106, v120, v121
M v[248:251], a[156:159], v[40:43], v[248:251]
v_exp_f32 v122, v122
M v[248:251], a[160:163], v[72:75], v[248:251]
s_waitcnt vmcnt(16) lgkmcnt(0)
s_barrier
ds_read_b128 a[116:119], v3 offset:0
ds_read_b128 a[120:123], v3 offset:1024
ds_read_b128 a[124:127], v3 offset:2048
ds_read_b128 a[128:131], v3 offset:3072
M v[252:255], a[160:163], v[76:79], v[252:255]
v_exp_f32 v123, v123
M v[252:255], a[156:159], v[44:47], v[252:255]
v_cvt_pk_bf16_f32 v107, v122, v123
M a[64:67], a[164:167], v[32:35], a[64:67]
v_exp_f32 v108, v108
M a[64:67], a[168:171], v[64:67], a[64:67]
ds_read_b128 a[132:135], v3 offset:4096
ds_read_b128 a[136:139], v3 offset:5120
M a[68:71], a[168:171], v[68:71], a[68:71]
v_exp_f32 v109, v109
M a[68:71], a[164:167], v[36:39], a[68:71]
v_cvt_pk_bf16_f32 v108, v108, v109
M a[72:75], a[164:167], v[40:43], a[72:75]
v_exp_f32 v110, v110
M a[72:75], a[168:171], v[72:75], a[72:75]
M a[76:79], a[168:171], v[76:79], a[76:79]
v_exp_f32 v111, v111
M a[76:79], a[164:167], v[44:47], a[76:79]
v_cvt_pk_bf16_f32 v109, v110, v111
M a[80:83], a[172:175], v[32:35], a[80:83]
v_exp_f32 v124, v124
M a[80:83], a[176:179], v[64:67], a[80:83]
ds_read_b128 a[140:143], v3 offset:6144
ds_read_b128 a[144:147], v3 offset:7168
M a[84:87], a[176:179], v[68:71], a[84:87]
v_exp_f32 v125, v125
M a[84:87], a[172:175], v[36:39], a[84:87]
v_cvt_pk_bf16_f32 v110, v124, v125
M a[88:91], a[172:175], v[40:43], a[88:91]
v_exp_f32 v126, v126
M a[88:91], a[176:179], v[72:75], a[88:91]
M a[92:95], a[176:179], v[76:79], a[92:95]
v_exp_f32 v127, v127
M a[92:95], a[172:175], v[44:47], a[92:95]
v_cvt_pk_bf16_f32 v111, v126, v127
s_waitcnt lgkmcnt(4)
s_add_u32 m0, s29, 32768
M v[32:35], a[116:119], a[0:3], 0
v_exp_f32 v128, v128
M v[32:35], a[120:123], a[4:7], v[32:35]
ds_read_b128 a[148:151], v3 offset:8192
ds_read_b128 a[152:155], v3 offset:9216
M v[32:35], a[124:127], a[8:11], v[32:35]
v_exp_f32 v129, v129
M v[32:35], a[128:131], a[12:15], v[32:35]
buffer_load_dwordx4 v1, s[12:15], s26 offen offset:0 sc1 lds
s_add_u32 s32, s26, 4096
M v[36:39], a[128:131], a[28:31], 0
v_exp_f32 v130, v130
M v[36:39], a[124:127], a[24:27], v[36:39]
v_cvt_pk_bf16_f32 v128, v128, v129
M v[36:39], a[120:123], a[20:23], v[36:39]
v_exp_f32 v131, v131
M v[36:39], a[116:119], a[16:19], v[36:39]
buffer_load_dwordx4 v1, s[12:15], s26 offen offset:1024 sc1 lds
M v[40:43], a[116:119], a[32:35], 0
v_exp_f32 v144, v144
M v[40:43], a[120:123], a[36:39], v[40:43]
ds_read_b128 a[156:159], v3 offset:10240
ds_read_b128 a[160:163], v3 offset:11264
M v[40:43], a[124:127], a[40:43], v[40:43]
v_exp_f32 v145, v145
M v[40:43], a[128:131], a[44:47], v[40:43]
buffer_load_dwordx4 v1, s[12:15], s26 offen offset:2048 sc1 lds
M v[44:47], a[128:131], a[60:63], 0
v_exp_f32 v146, v146
M v[44:47], a[124:127], a[56:59], v[44:47]
v_cvt_pk_bf16_f32 v129, v130, v131
v_cvt_pk_bf16_f32 v130, v144, v145
M v[44:47], a[120:123], a[52:55], v[44:47]
v_exp_f32 v147, v147
M v[44:47], a[116:119], a[48:51], v[44:47]
buffer_load_dwordx4 v1, s[12:15], s26 offen offset:3072 sc1 lds
s_add_u32 m0, s29, 36864
s_waitcnt lgkmcnt(4)
M v[48:51], a[132:135], a[0:3], 0
v_exp_f32 v132, v132
M v[48:51], a[136:139], a[4:7], v[48:51]
ds_read_b128 a[164:167], v3 offset:12288
ds_read_b128 a[168:171], v3 offset:13312
M v[48:51], a[140:143], a[8:11], v[48:51]
v_exp_f32 v133, v133
M v[48:51], a[144:147], a[12:15], v[48:51]
buffer_load_dwordx4 v1, s[12:15], s32 offen offset:0 sc1 lds
M v[52:55], a[144:147], a[28:31], 0
v_exp_f32 v134, v134
M v[52:55], a[140:143], a[24:27], v[52:55]
v_cvt_pk_bf16_f32 v131, v146, v147
v_cvt_pk_bf16_f32 v132, v132, v133
M v[52:55], a[136:139], a[20:23], v[52:55]
v_exp_f32 v135, v135
M v[52:55], a[132:135], a[16:19], v[52:55]
buffer_load_dwordx4 v1, s[12:15], s32 offen offset:1024 sc1 lds
M v[56:59], a[132:135], a[32:35], 0
v_exp_f32 v148, v148
M v[56:59], a[136:139], a[36:39], v[56:59]
ds_read_b128 a[172:175], v3 offset:14336
ds_read_b128 a[176:179], v3 offset:15360
M v[56:59], a[140:143], a[40:43], v[56:59]
v_exp_f32 v149, v149
M v[56:59], a[144:147], a[44:47], v[56:59]
buffer_load_dwordx4 v1, s[12:15], s32 offen offset:2048 sc1 lds
M v[60:63], a[144:147], a[60:63], 0
v_exp_f32 v150, v150
M v[60:63], a[140:143], a[56:59], v[60:63]
v_cvt_pk_bf16_f32 v133, v134, v135
v_cvt_pk_bf16_f32 v134, v148, v149
M v[60:63], a[136:139], a[52:55], v[60:63]
v_exp_f32 v151, v151
M v[60:63], a[132:135], a[48:51], v[60:63]
buffer_load_dwordx4 v1, s[12:15], s32 offen offset:3072 sc1 lds
s_waitcnt lgkmcnt(4)
M v[64:67], a[148:151], a[0:3], 0
v_exp_f32 v136, v136
M v[64:67], a[152:155], a[4:7], v[64:67]
s_add_u32 s26, s26, 32768
s_cmp_eq_u32 s26, s62
s_cselect_b32 s26, s63, s26
s_cselect_b32 s62, -1, s62
M v[64:67], a[156:159], a[8:11], v[64:67]
v_exp_f32 v137, v137
M v[64:67], a[160:163], a[12:15], v[64:67]
v_cvt_pk_bf16_f32 v135, v150, v151
v_cvt_pk_bf16_f32 v136, v136, v137
M v[68:71], a[160:163], a[28:31], 0
v_exp_f32 v138, v138
M v[68:71], a[156:159], a[24:27], v[68:71]
M v[68:71], a[152:155], a[20:23], v[68:71]
v_exp_f32 v139, v139
M v[68:71], a[148:151], a[16:19], v[68:71]
v_cvt_pk_bf16_f32 v137, v138, v139
M v[72:75], a[148:151], a[32:35], 0
v_exp_f32 v152, v152
M v[72:75], a[152:155], a[36:39], v[72:75]
M v[72:75], a[156:159], a[40:43], v[72:75]
v_exp_f32 v153, v153
M v[72:75], a[160:163], a[44:47], v[72:75]
v_cvt_pk_bf16_f32 v138, v152, v153
M v[76:79], a[160:163], a[60:63], 0
v_exp_f32 v154, v154
M v[76:79], a[156:159], a[56:59], v[76:79]
s_waitcnt vmcnt(16) lgkmcnt(0)
s_barrier
ds_read_b128 a[116:119], v3 offset:32768
ds_read_b128 a[120:123], v3 offset:40960
ds_read_b128 a[124:127], v3 offset:33792
ds_read_b128 a[128:131], v3 offset:41984
M v[76:79], a[152:155], a[52:55], v[76:79]
v_exp_f32 v155, v155
M v[76:79], a[148:151], a[48:51], v[76:79]
v_cvt_pk_bf16_f32 v139, v154, v155
M v[80:83], a[164:167], a[0:3], 0
v_exp_f32 v140, v140
M v[80:83], a[168:171], a[4:7], v[80:83]
ds_read_b128 a[132:135], v3 offset:34816
ds_read_b128 a[136:139], v3 offset:43008
M v[80:83], a[172:175], a[8:11], v[80:83]
v_exp_f32 v141, v141
M v[80:83], a[176:179], a[12:15], v[80:83]
v_cvt_pk_bf16_f32 v140, v140, v141
M v[84:87], a[176:179], a[28:31], 0
v_exp_f32 v142, v142
M v[84:87], a[172:175], a[24:27], v[84:87]
M v[84:87], a[168:171], a[20:23], v[84:87]
v_exp_f32 v143, v143
M v[84:87], a[164:167], a[16:19], v[84:87]
v_cvt_pk_bf16_f32 v141, v142, v143
M v[88:91], a[164:167], a[32:35], 0
v_exp_f32 v156, v156
M v[88:91], a[168:171], a[36:39], v[88:91]
ds_read_b128 a[140:143], v3 offset:35840
ds_read_b128 a[144:147], v3 offset:44032
M v[88:91], a[172:175], a[40:43], v[88:91]
v_exp_f32 v157, v157
M v[88:91], a[176:179], a[44:47], v[88:91]
v_cvt_pk_bf16_f32 v142, v156, v157
M v[92:95], a[176:179], a[60:63], 0
v_exp_f32 v158, v158
M v[92:95], a[172:175], a[56:59], v[92:95]
M v[92:95], a[168:171], a[52:55], v[92:95]
v_exp_f32 v159, v159
M v[92:95], a[164:167], a[48:51], v[92:95]
v_cvt_pk_bf16_f32 v143, v158, v159
s_waitcnt lgkmcnt(6)
s_add_u32 m0, s29, 65536
M v[160:163], a[116:119], v[96:99], v[160:163]
v_exp_f32 v32, v32
M v[160:163], a[120:123], v[128:131], v[160:163]
ds_read_b128 a[148:151], v3 offset:36864
ds_read_b128 a[152:155], v3 offset:45056
M v[164:167], a[120:123], v[132:135], v[164:167]
v_exp_f32 v33, v33
M v[164:167], a[116:119], v[100:103], v[164:167]
buffer_load_dwordx4 v1, s[12:15], s25 offen offset:0 sc1 lds
s_add_u32 s32, s25, 4096
M v[168:171], a[116:119], v[104:107], v[168:171]
v_exp_f32 v34, v34
M v[168:171], a[120:123], v[136:139], v[168:171]
v_cvt_pk_bf16_f32 v32, v32, v33
M v[172:175], a[120:123], v[140:143], v[172:175]
v_exp_f32 v35, v35
M v[172:175], a[116:119], v[108:111], v[172:175]
buffer_load_dwordx4 v1, s[12:15], s25 offen offset:1024 sc1 lds
s_waitcnt lgkmcnt(6)
M a[96:99], a[112:115], v[96:99], a[96:99]
M a[96:99], a[112:115], v[128:131], a[96:99]
M v[176:179], a[124:127], v[96:99], v[176:179]
v_exp_f32 v48, v48
M v[176:179], a[128:131], v[128:131], v[176:179]
ds_read_b128 a[156:159], v3 offset:37888
ds_read_b128 a[160:163], v3 offset:46080
M v[180:183], a[128:131], v[132:135], v[180:183]
v_exp_f32 v49, v49
M v[180:183], a[124:127], v[100:103], v[180:183]
buffer_load_dwordx4 v1, s[12:15], s25 offen offset:2048 sc1 lds
M v[184:187], a[124:127], v[104:107], v[184:187]
v_exp_f32 v50, v50
M v[184:187], a[128:131], v[136:139], v[184:187]
v_cvt_pk_bf16_f32 v33, v34, v35
v_cvt_pk_bf16_f32 v34, v48, v49
M v[188:191], a[128:131], v[140:143], v[188:191]
v_exp_f32 v51, v51
M v[188:191], a[124:127], v[108:111], v[188:191]
buffer_load_dwordx4 v1, s[12:15], s25 offen offset:3072 sc1 lds
s_add_u32 m0, s29, 69632
s_waitcnt lgkmcnt(6)
M a[100:103], a[112:115], v[100:103], a[100:103]
M a[100:103], a[112:115], v[132:135], a[100:103]
M v[192:195], a[132:135], v[96:99], v[192:195]
v_exp_f32 v36, v36
M v[192:195], a[136:139], v[128:131], v[192:195]
ds_read_b128 a[164:167], v3 offset:38912
ds_read_b128 a[168:171], v3 offset:47104
M v[196:199], a[136:139], v[132:135], v[196:199]
v_exp_f32 v37, v37
M v[196:199], a[132:135], v[100:103], v[196:199]
buffer_load_dwordx4 v1, s[12:15], s32 offen offset:0 sc1 lds
M v[200:203], a[132:135], v[104:107], v[200:203]
v_exp_f32 v38, v38
M v[200:203], a[136:139], v[136:139], v[200:203]
v_cvt_pk_bf16_f32 v35, v50, v51
v_cvt_pk_bf16_f32 v36, v36, v37
M v[204:207], a[136:139], v[140:143], v[204:207]
v_exp_f32 v39, v39
M v[204:207], a[132:135], v[108:111], v[204:207]
buffer_load_dwordx4 v1, s[12:15], s32 offen offset:1024 sc1 lds
s_waitcnt lgkmcnt(6)
M a[104:107], a[112:115], v[104:107], a[104:107]
M a[104:107], a[112:115], v[136:139], a[104:107]
M v[208:211], a[140:143], v[96:99], v[208:211]
v_exp_f32 v52, v52
M v[208:211], a[144:147], v[128:131], v[208:211]
ds_read_b128 a[172:175], v3 offset:39936
ds_read_b128 a[176:179], v3 offset:48128
M v[212:215], a[144:147], v[132:135], v[212:215]
v_exp_f32 v53, v53
M v[212:215], a[140:143], v[100:103], v[212:215]
buffer_load_dwordx4 v1, s[12:15], s32 offen offset:2048 sc1 lds
M v[216:219], a[140:143], v[104:107], v[216:219]
v_exp_f32 v54, v54
M v[216:219], a[144:147], v[136:139], v[216:219]
v_cvt_pk_bf16_f32 v37, v38, v39
v_cvt_pk_bf16_f32 v38, v52, v53
M v[220:223], a[144:147], v[140:143], v[220:223]
v_exp_f32 v55, v55
M v[220:223], a[140:143], v[108:111], v[220:223]
buffer_load_dwordx4 v1, s[12:15], s32 offen offset:3072 sc1 lds
s_waitcnt lgkmcnt(6)
M a[108:111], a[112:115], v[108:111], a[108:111]
M a[108:111], a[112:115], v[140:143], a[108:111]
M v[224:227], a[148:151], v[96:99], v[224:227]
v_exp_f32 v40, v40
M v[224:227], a[152:155], v[128:131], v[224:227]
s_add_u32 s25, s25, 32768
s_cmp_eq_u32 s25, s27
s_cselect_b32 s25, s28, s25
s_cselect_b32 s27, -1, s27
M v[228:231], a[152:155], v[132:135], v[228:231]
v_exp_f32 v41, v41
M v[228:231], a[148:151], v[100:103], v[228:231]
v_cvt_pk_bf16_f32 v39, v54, v55
v_cvt_pk_bf16_f32 v40, v40, v41
M v[232:235], a[148:151], v[104:107], v[232:235]
v_exp_f32 v42, v42
M v[232:235], a[152:155], v[136:139], v[232:235]
M v[236:239], a[152:155], v[140:143], v[236:239]
v_exp_f32 v43, v43
M v[236:239], a[148:151], v[108:111], v[236:239]
v_cvt_pk_bf16_f32 v41, v42, v43
s_waitcnt lgkmcnt(4)
M v[240:243], a[156:159], v[96:99], v[240:243]
v_exp_f32 v56, v56
M v[240:243], a[160:163], v[128:131], v[240:243]
M v[244:247], a[160:163], v[132:135], v[244:247]
v_exp_f32 v57, v57
M v[244:247], a[156:159], v[100:103], v[244:247]
v_cvt_pk_bf16_f32 v42, v56, v57
M v[248:251], a[156:159], v[104:107], v[248:251]
v_exp_f32 v58, v58
M v[248:251], a[160:163], v[136:139], v[248:251]
s_waitcnt vmcnt(16) lgkmcnt(0)
s_barrier
ds_read_b128 a[116:119], v2 offset:0
ds_read_b128 a[120:123], v2 offset:1024
ds_read_b128 a[124:127], v2 offset:2048
ds_read_b128 a[128:131], v2 offset:3072
M v[252:255], a[160:163], v[140:143], v[252:255]
v_exp_f32 v59, v59
M v[252:255], a[156:159], v[108:111], v[252:255]
v_cvt_pk_bf16_f32 v43, v58, v59
M a[64:67], a[164:167], v[96:99], a[64:67]
v_exp_f32 v44, v44
M a[64:67], a[168:171], v[128:131], a[64:67]
ds_read_b128 a[132:135], v2 offset:4096
ds_read_b128 a[136:139], v2 offset:5120
M a[68:71], a[168:171], v[132:135], a[68:71]
v_exp_f32 v45, v45
M a[68:71], a[164:167], v[100:103], a[68:71]
v_cvt_pk_bf16_f32 v44, v44, v45
M a[72:75], a[164:167], v[104:107], a[72:75]
v_exp_f32 v46, v46
M a[72:75], a[168:171], v[136:139], a[72:75]
M a[76:79], a[168:171], v[140:143], a[76:79]
v_exp_f32 v47, v47
M a[76:79], a[164:167], v[108:111], a[76:79]
v_cvt_pk_bf16_f32 v45, v46, v47
M a[80:83], a[172:175], v[96:99], a[80:83]
v_exp_f32 v60, v60
M a[80:83], a[176:179], v[128:131], a[80:83]
ds_read_b128 a[140:143], v2 offset:6144
ds_read_b128 a[144:147], v2 offset:7168
M a[84:87], a[176:179], v[132:135], a[84:87]
v_exp_f32 v61, v61
M a[84:87], a[172:175], v[100:103], a[84:87]
v_cvt_pk_bf16_f32 v46, v60, v61
M a[88:91], a[172:175], v[104:107], a[88:91]
v_exp_f32 v62, v62
M a[88:91], a[176:179], v[136:139], a[88:91]
M a[92:95], a[176:179], v[140:143], a[92:95]
v_exp_f32 v63, v63
M a[92:95], a[172:175], v[108:111], a[92:95]
v_cvt_pk_bf16_f32 v47, v62, v63
s_sub_u32 s30, s30, 1
s_cmp_lg_u32 s30, 0
s_cbranch_scc1 Lk2_l3
s_lshl_b32 s33, s23, 6
s_add_i32 s33, s33, 0
s_cmp_gt_i32 s33, 0
s_cselect_b32 s34, 0, 0xf149f2ca
s_cmp_lt_i32 s33, 0
s_cselect_b32 s33, 0xf149f2ca, 0
v_mov_b32 v20, s34
v_mov_b32 v21, s34
v_mov_b32 v22, s34
v_mov_b32 v23, s34
v_mov_b32 v28, s33
v_mov_b32 v29, s33
v_mov_b32 v30, s33
v_mov_b32 v31, s33
v_med3_f32 v24, v16, v20, v28
v_med3_f32 v25, v17, v20, v28
v_med3_f32 v26, v18, v20, v28
v_med3_f32 v27, v19, v20, v28
s_waitcnt lgkmcnt(4)
s_add_u32 m0, s29, 98304
M v[96:99], a[116:119], a[0:3], v[24:27]
v_exp_f32 v64, v64
M v[96:99], a[120:123], a[4:7], v[96:99]
ds_read_b128 a[148:151], v2 offset:8192
ds_read_b128 a[152:155], v2 offset:9216
M v[96:99], a[124:127], a[8:11], v[96:99]
v_exp_f32 v65, v65
M v[96:99], a[128:131], a[12:15], v[96:99]
buffer_load_dwordx4 v1, s[12:15], s26 offen offset:0 sc1 lds
s_add_u32 s32, s26, 4096
M v[100:103], a[128:131], a[28:31], v[28:31]
v_exp_f32 v66, v66
M v[100:103], a[124:127], a[24:27], v[100:103]
v_cvt_pk_bf16_f32 v64, v64, v65
M v[100:103], a[120:123], a[20:23], v[100:103]
v_exp_f32 v67, v67
M v[100:103], a[116:119], a[16:19], v[100:103]
buffer_load_dwordx4 v1, s[12:15], s26 offen offset:1024 sc1 lds
M v[104:107], a[116:119], a[32:35], v[28:31]
v_exp_f32 v80, v80
M v[104:107], a[120:123], a[36:39], v[104:107]
ds_read_b128 a[156:159], v2 offset:10240
ds_read_b128 a[160:163], v2 offset:11264
M v[104:107], a[124:127], a[40:43], v[104:107]
v_exp_f32 v81, v81
M v[104:107], a[128:131], a[44:47], v[104:107]
buffer_load_dwordx4 v1, s[12:15], s26 offen offset:2048 sc1 lds
M v[108:111], a[128:131], a[60:63], v[28:31]
v_exp_f32 v82, v82
M v[108:111], a[124:127], a[56:59], v[108:111]
v_cvt_pk_bf16_f32 v65, v66, v67
v_cvt_pk_bf16_f32 v66, v80, v81
M v[108:111], a[120:123], a[52:55], v[108:111]
v_exp_f32 v83, v83
M v[108:111], a[116:119], a[48:51], v[108:111]
buffer_load_dwordx4 v1, s[12:15], s26 offen offset:3072 sc1 lds
s_add_u32 m0, s29, 102400
s_waitcnt lgkmcnt(4)
M v[112:115], a[132:135], a[0:3], v[20:23]
v_exp_f32 v68, v68
M v[112:115], a[136:139], a[4:7], v[112:115]
ds_read_b128 a[164:167], v2 offset:12288
ds_read_b128 a[168:171], v2 offset:13312
M v[112:115], a[140:143], a[8:11], v[112:115]
v_exp_f32 v69, v69
M v[112:115], a[144:147], a[12:15], v[112:115]
buffer_load_dwordx4 v1, s[12:15], s32 offen offset:0 sc1 lds
M v[116:119], a[144:147], a[28:31], v[24:27]
v_exp_f32 v70, v70
M v[116:119], a[140:143], a[24:27], v[116:119]
v_cvt_pk_bf16_f32 v67, v82, v83
v_cvt_pk_bf16_f32 v68, v68, v69
M v[116:119], a[136:139], a[20:23], v[116:119]
v_exp_f32 v71, v71
M v[116:119], a[132:135], a[16:19], v[116:119]
buffer_load_dwordx4 v1, s[12:15], s32 offen offset:1024 sc1 lds
M v[120:123], a[132:135], a[32:35], v[28:31]
v_exp_f32 v84, v84
M v[120:123], a[136:139], a[36:39], v[120:123]
ds_read_b128 a[172:175], v2 offset:14336
ds_read_b128 a[176:179], v2 offset:15360
M v[120:123], a[140:143], a[40:43], v[120:123]
v_exp_f32 v85, v85
M v[120:123], a[144:147], a[44:47], v[120:123]
buffer_load_dwordx4 v1, s[12:15], s32 offen offset:2048 sc1 lds
M v[124:127], a[144:147], a[60:63], v[28:31]
v_exp_f32 v86, v86
M v[124:127], a[140:143], a[56:59], v[124:127]
v_cvt_pk_bf16_f32 v69, v70, v71
v_cvt_pk_bf16_f32 v70, v84, v85
M v[124:127], a[136:139], a[52:55], v[124:127]
v_exp_f32 v87, v87
M v[124:127], a[132:135], a[48:51], v[124:127]
buffer_load_dwordx4 v1, s[12:15], s32 offen offset:3072 sc1 lds
s_waitcnt lgkmcnt(4)
M v[128:131], a[148:151], a[0:3], v[20:23]
v_exp_f32 v72, v72
M v[128:131], a[152:155], a[4:7], v[128:131]
s_add_u32 s26, s26, 32768
s_cmp_eq_u32 s26, s62
s_cselect_b32 s26, s63, s26
s_cselect_b32 s62, -1, s62
M v[128:131], a[156:159], a[8:11], v[128:131]
v_exp_f32 v73, v73
M v[128:131], a[160:163], a[12:15], v[128:131]
v_cvt_pk_bf16_f32 v71, v86, v87
v_cvt_pk_bf16_f32 v72, v72, v73
M v[132:135], a[160:163], a[28:31], v[20:23]
v_exp_f32 v74, v74
M v[132:135], a[156:159], a[24:27], v[132:135]
M v[132:135], a[152:155], a[20:23], v[132:135]
v_exp_f32 v75, v75
M v[132:135], a[148:151], a[16:19], v[132:135]
v_cvt_pk_bf16_f32 v73, v74, v75
M v[136:139], a[148:151], a[32:35], v[24:27]
v_exp_f32 v88, v88
M v[136:139], a[152:155], a[36:39], v[136:139]
M v[136:139], a[156:159], a[40:43], v[136:139]
v_exp_f32 v89, v89
M v[136:139], a[160:163], a[44:47], v[136:139]
v_cvt_pk_bf16_f32 v74, v88, v89
M v[140:143], a[160:163], a[60:63], v[28:31]
v_exp_f32 v90, v90
M v[140:143], a[156:159], a[56:59], v[140:143]
s_waitcnt vmcnt(16) lgkmcnt(0)
s_barrier
ds_read_b128 a[116:119], v2 offset:32768
ds_read_b128 a[120:123], v2 offset:40960
ds_read_b128 a[124:127], v2 offset:33792
ds_read_b128 a[128:131], v2 offset:41984
M v[140:143], a[152:155], a[52:55], v[140:143]
v_exp_f32 v91, v91
M v[140:143], a[148:151], a[48:51], v[140:143]
v_cvt_pk_bf16_f32 v75, v90, v91
M v[144:147], a[164:167], a[0:3], v[20:23]
v_exp_f32 v76, v76
M v[144:147], a[168:171], a[4:7], v[144:147]
ds_read_b128 a[132:135], v2 offset:34816
ds_read_b128 a[136:139], v2 offset:43008
M v[144:147], a[172:175], a[8:11], v[144:147]
v_exp_f32 v77, v77
M v[144:147], a[176:179], a[12:15], v[144:147]
v_cvt_pk_bf16_f32 v76, v76, v77
M v[148:151], a[176:179], a[28:31], v[20:23]
v_exp_f32 v78, v78
M v[148:151], a[172:175], a[24:27], v[148:151]
M v[148:151], a[168:171], a[20:23], v[148:151]
v_exp_f32 v79, v79
M v[148:151], a[164:167], a[16:19], v[148:151]
v_cvt_pk_bf16_f32 v77, v78, v79
M v[152:155], a[164:167], a[32:35], v[20:23]
v_exp_f32 v92, v92
M v[152:155], a[168:171], a[36:39], v[152:155]
ds_read_b128 a[140:143], v2 offset:35840
ds_read_b128 a[144:147], v2 offset:44032
M v[152:155], a[172:175], a[40:43], v[152:155]
v_exp_f32 v93, v93
M v[152:155], a[176:179], a[44:47], v[152:155]
v_cvt_pk_bf16_f32 v78, v92, v93
M v[156:159], a[176:179], a[60:63], v[24:27]
v_exp_f32 v94, v94
M v[156:159], a[172:175], a[56:59], v[156:159]
M v[156:159], a[168:171], a[52:55], v[156:159]
v_exp_f32 v95, v95
M v[156:159], a[164:167], a[48:51], v[156:159]
v_cvt_pk_bf16_f32 v79, v94, v95
s_waitcnt lgkmcnt(6)
s_add_u32 m0, s29, 0
M v[160:163], a[116:119], v[32:35], v[160:163]
v_exp_f32 v96, v96
M v[160:163], a[120:123], v[64:67], v[160:163]
ds_read_b128 a[148:151], v2 offset:36864
ds_read_b128 a[152:155], v2 offset:45056
M v[164:167], a[120:123], v[68:71], v[164:167]
v_exp_f32 v97, v97
M v[164:167], a[116:119], v[36:39], v[164:167]
buffer_load_dwordx4 v1, s[12:15], s25 offen offset:0 sc1 lds
s_add_u32 s32, s25, 4096
M v[168:171], a[116:119], v[40:43], v[168:171]
v_exp_f32 v98, v98
M v[168:171], a[120:123], v[72:75], v[168:171]
v_cvt_pk_bf16_f32 v96, v96, v97
M v[172:175], a[120:123], v[76:79], v[172:175]
v_exp_f32 v99, v99
M v[172:175], a[116:119], v[44:47], v[172:175]
buffer_load_dwordx4 v1, s[12:15], s25 offen offset:1024 sc1 lds
s_waitcnt lgkmcnt(6)
M a[96:99], a[112:115], v[32:35], a[96:99]
M a[96:99], a[112:115], v[64:67], a[96:99]
M v[176:179], a[124:127], v[32:35], v[176:179]
v_exp_f32 v112, v112
M v[176:179], a[128:131], v[64:67], v[176:179]
ds_read_b128 a[156:159], v2 offset:37888
ds_read_b128 a[160:163], v2 offset:46080
M v[180:183], a[128:131], v[68:71], v[180:183]
v_exp_f32 v113, v113
M v[180:183], a[124:127], v[36:39], v[180:183]
buffer_load_dwordx4 v1, s[12:15], s25 offen offset:2048 sc1 lds
M v[184:187], a[124:127], v[40:43], v[184:187]
v_exp_f32 v114, v114
M v[184:187], a[128:131], v[72:75], v[184:187]
v_cvt_pk_bf16_f32 v97, v98, v99
v_cvt_pk_bf16_f32 v98, v112, v113
M v[188:191], a[128:131], v[76:79], v[188:191]
v_exp_f32 v115, v115
M v[188:191], a[124:127], v[44:47], v[188:191]
buffer_load_dwordx4 v1, s[12:15], s25 offen offset:3072 sc1 lds
s_add_u32 m0, s29, 4096
s_waitcnt lgkmcnt(6)
M a[100:103], a[112:115], v[36:39], a[100:103]
M a[100:103], a[112:115], v[68:71], a[100:103]
M v[192:195], a[132:135], v[32:35], v[192:195]
v_exp_f32 v100, v100
M v[192:195], a[136:139], v[64:67], v[192:195]
ds_read_b128 a[164:167], v2 offset:38912
ds_read_b128 a[168:171], v2 offset:47104
M v[196:199], a[136:139], v[68:71], v[196:199]
v_exp_f32 v101, v101
M v[196:199], a[132:135], v[36:39], v[196:199]
buffer_load_dwordx4 v1, s[12:15], s32 offen offset:0 sc1 lds
M v[200:203], a[132:135], v[40:43], v[200:203]
v_exp_f32 v102, v102
M v[200:203], a[136:139], v[72:75], v[200:203]
v_cvt_pk_bf16_f32 v99, v114, v115
v_cvt_pk_bf16_f32 v100, v100, v101
M v[204:207], a[136:139], v[76:79], v[204:207]
v_exp_f32 v103, v103
M v[204:207], a[132:135], v[44:47], v[204:207]
buffer_load_dwordx4 v1, s[12:15], s32 offen offset:1024 sc1 lds
s_waitcnt lgkmcnt(6)
M a[104:107], a[112:115], v[40:43], a[104:107]
M a[104:107], a[112:115], v[72:75], a[104:107]
M v[208:211], a[140:143], v[32:35], v[208:211]
v_exp_f32 v116, v116
M v[208:211], a[144:147], v[64:67], v[208:211]
ds_read_b128 a[172:175], v2 offset:39936
ds_read_b128 a[176:179], v2 offset:48128
M v[212:215], a[144:147], v[68:71], v[212:215]
v_exp_f32 v117, v117
M v[212:215], a[140:143], v[36:39], v[212:215]
buffer_load_dwordx4 v1, s[12:15], s32 offen offset:2048 sc1 lds
M v[216:219], a[140:143], v[40:43], v[216:219]
v_exp_f32 v118, v118
M v[216:219], a[144:147], v[72:75], v[216:219]
v_cvt_pk_bf16_f32 v101, v102, v103
v_cvt_pk_bf16_f32 v102, v116, v117
M v[220:223], a[144:147], v[76:79], v[220:223]
v_exp_f32 v119, v119
M v[220:223], a[140:143], v[44:47], v[220:223]
buffer_load_dwordx4 v1, s[12:15], s32 offen offset:3072 sc1 lds
s_waitcnt lgkmcnt(6)
M a[108:111], a[112:115], v[44:47], a[108:111]
M a[108:111], a[112:115], v[76:79], a[108:111]
M v[224:227], a[148:151], v[32:35], v[224:227]
v_exp_f32 v104, v104
M v[224:227], a[152:155], v[64:67], v[224:227]
s_add_u32 s25, s25, 32768
s_cmp_eq_u32 s25, s27
s_cselect_b32 s25, s28, s25
s_cselect_b32 s27, -1, s27
M v[228:231], a[152:155], v[68:71], v[228:231]
v_exp_f32 v105, v105
M v[228:231], a[148:151], v[36:39], v[228:231]
v_cvt_pk_bf16_f32 v103, v118, v119
v_cvt_pk_bf16_f32 v104, v104, v105
M v[232:235], a[148:151], v[40:43], v[232:235]
v_exp_f32 v106, v106
M v[232:235], a[152:155], v[72:75], v[232:235]
M v[236:239], a[152:155], v[76:79], v[236:239]
v_exp_f32 v107, v107
M v[236:239], a[148:151], v[44:47], v[236:239]
v_cvt_pk_bf16_f32 v105, v106, v107
s_waitcnt lgkmcnt(4)
M v[240:243], a[156:159], v[32:35], v[240:243]
v_exp_f32 v120, v120
M v[240:243], a[160:163], v[64:67], v[240:243]
M v[244:247], a[160:163], v[68:71], v[244:247]
v_exp_f32 v121, v121
M v[244:247], a[156:159], v[36:39], v[244:247]
v_cvt_pk_bf16_f32 v106, v120, v121
M v[248:251], a[156:159], v[40:43], v[248:251]
v_exp_f32 v122, v122
M v[248:251], a[160:163], v[72:75], v[248:251]
s_waitcnt vmcnt(16) lgkmcnt(0)
s_barrier
ds_read_b128 a[116:119], v3 offset:0
ds_read_b128 a[120:123], v3 offset:1024
ds_read_b128 a[124:127], v3 offset:2048
ds_read_b128 a[128:131], v3 offset:3072
M v[252:255], a[160:163], v[76:79], v[252:255]
v_exp_f32 v123, v123
M v[252:255], a[156:159], v[44:47], v[252:255]
v_cvt_pk_bf16_f32 v107, v122, v123
M a[64:67], a[164:167], v[32:35], a[64:67]
v_exp_f32 v108, v108
M a[64:67], a[168:171], v[64:67], a[64:67]
ds_read_b128 a[132:135], v3 offset:4096
ds_read_b128 a[136:139], v3 offset:5120
M a[68:71], a[168:171], v[68:71], a[68:71]
v_exp_f32 v109, v109
M a[68:71], a[164:167], v[36:39], a[68:71]
v_cvt_pk_bf16_f32 v108, v108, v109
M a[72:75], a[164:167], v[40:43], a[72:75]
v_exp_f32 v110, v110
M a[72:75], a[168:171], v[72:75], a[72:75]
M a[76:79], a[168:171], v[76:79], a[76:79]
v_exp_f32 v111, v111
M a[76:79], a[164:167], v[44:47], a[76:79]
v_cvt_pk_bf16_f32 v109, v110, v111
M a[80:83], a[172:175], v[32:35], a[80:83]
v_exp_f32 v124, v124
M a[80:83], a[176:179], v[64:67], a[80:83]
ds_read_b128 a[140:143], v3 offset:6144
ds_read_b128 a[144:147], v3 offset:7168
M a[84:87], a[176:179], v[68:71], a[84:87]
v_exp_f32 v125, v125
M a[84:87], a[172:175], v[36:39], a[84:87]
v_cvt_pk_bf16_f32 v110, v124, v125
M a[88:91], a[172:175], v[40:43], a[88:91]
v_exp_f32 v126, v126
M a[88:91], a[176:179], v[72:75], a[88:91]
M a[92:95], a[176:179], v[76:79], a[92:95]
v_exp_f32 v127, v127
M a[92:95], a[172:175], v[44:47], a[92:95]
v_cvt_pk_bf16_f32 v111, v126, v127
s_lshl_b32 s33, s23, 6
s_add_i32 s33, s33, -64
s_cmp_gt_i32 s33, 0
s_cselect_b32 s34, 0, 0xf149f2ca
s_cmp_lt_i32 s33, 0
s_cselect_b32 s33, 0xf149f2ca, 0
v_mov_b32 v20, s34
v_mov_b32 v21, s34
v_mov_b32 v22, s34
v_mov_b32 v23, s34
v_mov_b32 v28, s33
v_mov_b32 v29, s33
v_mov_b32 v30, s33
v_mov_b32 v31, s33
v_med3_f32 v24, v16, v20, v28
v_med3_f32 v25, v17, v20, v28
v_med3_f32 v26, v18, v20, v28
v_med3_f32 v27, v19, v20, v28
s_waitcnt lgkmcnt(4)
s_add_u32 m0, s29, 32768
M v[32:35], a[116:119], a[0:3], v[24:27]
v_exp_f32 v128, v128
M v[32:35], a[120:123], a[4:7], v[32:35]
ds_read_b128 a[148:151], v3 offset:8192
ds_read_b128 a[152:155], v3 offset:9216
M v[32:35], a[124:127], a[8:11], v[32:35]
v_exp_f32 v129, v129
M v[32:35], a[128:131], a[12:15], v[32:35]
buffer_load_dwordx4 v1, s[12:15], s26 offen offset:0 sc1 lds
s_add_u32 s32, s26, 4096
M v[36:39], a[128:131], a[28:31], v[28:31]
v_exp_f32 v130, v130
M v[36:39], a[124:127], a[24:27], v[36:39]
v_cvt_pk_bf16_f32 v128, v128, v129
M v[36:39], a[120:123], a[20:23], v[36:39]
v_exp_f32 v131, v131
M v[36:39], a[116:119], a[16:19], v[36:39]
buffer_load_dwordx4 v1, s[12:15], s26 offen offset:1024 sc1 lds
M v[40:43], a[116:119], a[32:35], v[28:31]
v_exp_f32 v144, v144
M v[40:43], a[120:123], a[36:39], v[40:43]
ds_read_b128 a[156:159], v3 offset:10240
ds_read_b128 a[160:163], v3 offset:11264
M v[40:43], a[124:127], a[40:43], v[40:43]
v_exp_f32 v145, v145
M v[40:43], a[128:131], a[44:47], v[40:43]
buffer_load_dwordx4 v1, s[12:15], s26 offen offset:2048 sc1 lds
M v[44:47], a[128:131], a[60:63], v[28:31]
v_exp_f32 v146, v146
M v[44:47], a[124:127], a[56:59], v[44:47]
v_cvt_pk_bf16_f32 v129, v130, v131
v_cvt_pk_bf16_f32 v130, v144, v145
M v[44:47], a[120:123], a[52:55], v[44:47]
v_exp_f32 v147, v147
M v[44:47], a[116:119], a[48:51], v[44:47]
buffer_load_dwordx4 v1, s[12:15], s26 offen offset:3072 sc1 lds
s_add_u32 m0, s29, 36864
s_waitcnt lgkmcnt(4)
M v[48:51], a[132:135], a[0:3], v[20:23]
v_exp_f32 v132, v132
M v[48:51], a[136:139], a[4:7], v[48:51]
ds_read_b128 a[164:167], v3 offset:12288
ds_read_b128 a[168:171], v3 offset:13312
M v[48:51], a[140:143], a[8:11], v[48:51]
v_exp_f32 v133, v133
M v[48:51], a[144:147], a[12:15], v[48:51]
buffer_load_dwordx4 v1, s[12:15], s32 offen offset:0 sc1 lds
M v[52:55], a[144:147], a[28:31], v[24:27]
v_exp_f32 v134, v134
M v[52:55], a[140:143], a[24:27], v[52:55]
v_cvt_pk_bf16_f32 v131, v146, v147
v_cvt_pk_bf16_f32 v132, v132, v133
M v[52:55], a[136:139], a[20:23], v[52:55]
v_exp_f32 v135, v135
M v[52:55], a[132:135], a[16:19], v[52:55]
buffer_load_dwordx4 v1, s[12:15], s32 offen offset:1024 sc1 lds
M v[56:59], a[132:135], a[32:35], v[28:31]
v_exp_f32 v148, v148
M v[56:59], a[136:139], a[36:39], v[56:59]
ds_read_b128 a[172:175], v3 offset:14336
ds_read_b128 a[176:179], v3 offset:15360
M v[56:59], a[140:143], a[40:43], v[56:59]
v_exp_f32 v149, v149
M v[56:59], a[144:147], a[44:47], v[56:59]
buffer_load_dwordx4 v1, s[12:15], s32 offen offset:2048 sc1 lds
M v[60:63], a[144:147], a[60:63], v[28:31]
v_exp_f32 v150, v150
M v[60:63], a[140:143], a[56:59], v[60:63]
v_cvt_pk_bf16_f32 v133, v134, v135
v_cvt_pk_bf16_f32 v134, v148, v149
M v[60:63], a[136:139], a[52:55], v[60:63]
v_exp_f32 v151, v151
M v[60:63], a[132:135], a[48:51], v[60:63]
buffer_load_dwordx4 v1, s[12:15], s32 offen offset:3072 sc1 lds
s_waitcnt lgkmcnt(4)
M v[64:67], a[148:151], a[0:3], v[20:23]
v_exp_f32 v136, v136
M v[64:67], a[152:155], a[4:7], v[64:67]
s_add_u32 s26, s26, 32768
s_cmp_eq_u32 s26, s62
s_cselect_b32 s26, s63, s26
s_cselect_b32 s62, -1, s62
M v[64:67], a[156:159], a[8:11], v[64:67]
v_exp_f32 v137, v137
M v[64:67], a[160:163], a[12:15], v[64:67]
v_cvt_pk_bf16_f32 v135, v150, v151
v_cvt_pk_bf16_f32 v136, v136, v137
M v[68:71], a[160:163], a[28:31], v[20:23]
v_exp_f32 v138, v138
M v[68:71], a[156:159], a[24:27], v[68:71]
M v[68:71], a[152:155], a[20:23], v[68:71]
v_exp_f32 v139, v139
M v[68:71], a[148:151], a[16:19], v[68:71]
v_cvt_pk_bf16_f32 v137, v138, v139
M v[72:75], a[148:151], a[32:35], v[24:27]
v_exp_f32 v152, v152
M v[72:75], a[152:155], a[36:39], v[72:75]
M v[72:75], a[156:159], a[40:43], v[72:75]
v_exp_f32 v153, v153
M v[72:75], a[160:163], a[44:47], v[72:75]
v_cvt_pk_bf16_f32 v138, v152, v153
M v[76:79], a[160:163], a[60:63], v[28:31]
v_exp_f32 v154, v154
M v[76:79], a[156:159], a[56:59], v[76:79]
s_waitcnt vmcnt(16) lgkmcnt(0)
s_barrier
ds_read_b128 a[116:119], v3 offset:32768
ds_read_b128 a[120:123], v3 offset:40960
ds_read_b128 a[124:127], v3 offset:33792
ds_read_b128 a[128:131], v3 offset:41984
M v[76:79], a[152:155], a[52:55], v[76:79]
v_exp_f32 v155, v155
M v[76:79], a[148:151], a[48:51], v[76:79]
v_cvt_pk_bf16_f32 v139, v154, v155
M v[80:83], a[164:167], a[0:3], v[20:23]
v_exp_f32 v140, v140
M v[80:83], a[168:171], a[4:7], v[80:83]
ds_read_b128 a[132:135], v3 offset:34816
ds_read_b128 a[136:139], v3 offset:43008
M v[80:83], a[172:175], a[8:11], v[80:83]
v_exp_f32 v141, v141
M v[80:83], a[176:179], a[12:15], v[80:83]
v_cvt_pk_bf16_f32 v140, v140, v141
M v[84:87], a[176:179], a[28:31], v[20:23]
v_exp_f32 v142, v142
M v[84:87], a[172:175], a[24:27], v[84:87]
M v[84:87], a[168:171], a[20:23], v[84:87]
v_exp_f32 v143, v143
M v[84:87], a[164:167], a[16:19], v[84:87]
v_cvt_pk_bf16_f32 v141, v142, v143
M v[88:91], a[164:167], a[32:35], v[20:23]
v_exp_f32 v156, v156
M v[88:91], a[168:171], a[36:39], v[88:91]
ds_read_b128 a[140:143], v3 offset:35840
ds_read_b128 a[144:147], v3 offset:44032
M v[88:91], a[172:175], a[40:43], v[88:91]
v_exp_f32 v157, v157
M v[88:91], a[176:179], a[44:47], v[88:91]
v_cvt_pk_bf16_f32 v142, v156, v157
M v[92:95], a[176:179], a[60:63], v[24:27]
v_exp_f32 v158, v158
M v[92:95], a[172:175], a[56:59], v[92:95]
M v[92:95], a[168:171], a[52:55], v[92:95]
v_exp_f32 v159, v159
M v[92:95], a[164:167], a[48:51], v[92:95]
v_cvt_pk_bf16_f32 v143, v158, v159
s_waitcnt lgkmcnt(6)
s_add_u32 m0, s29, 65536
M v[160:163], a[116:119], v[96:99], v[160:163]
v_exp_f32 v32, v32
M v[160:163], a[120:123], v[128:131], v[160:163]
ds_read_b128 a[148:151], v3 offset:36864
ds_read_b128 a[152:155], v3 offset:45056
M v[164:167], a[120:123], v[132:135], v[164:167]
v_exp_f32 v33, v33
M v[164:167], a[116:119], v[100:103], v[164:167]
buffer_load_dwordx4 v1, s[12:15], s25 offen offset:0 sc1 lds
s_add_u32 s32, s25, 4096
M v[168:171], a[116:119], v[104:107], v[168:171]
v_exp_f32 v34, v34
M v[168:171], a[120:123], v[136:139], v[168:171]
v_cvt_pk_bf16_f32 v32, v32, v33
M v[172:175], a[120:123], v[140:143], v[172:175]
v_exp_f32 v35, v35
M v[172:175], a[116:119], v[108:111], v[172:175]
buffer_load_dwordx4 v1, s[12:15], s25 offen offset:1024 sc1 lds
s_waitcnt lgkmcnt(6)
M a[96:99], a[112:115], v[96:99], a[96:99]
M a[96:99], a[112:115], v[128:131], a[96:99]
M v[176:179], a[124:127], v[96:99], v[176:179]
v_exp_f32 v48, v48
M v[176:179], a[128:131], v[128:131], v[176:179]
ds_read_b128 a[156:159], v3 offset:37888
ds_read_b128 a[160:163], v3 offset:46080
M v[180:183], a[128:131], v[132:135], v[180:183]
v_exp_f32 v49, v49
M v[180:183], a[124:127], v[100:103], v[180:183]
buffer_load_dwordx4 v1, s[12:15], s25 offen offset:2048 sc1 lds
M v[184:187], a[124:127], v[104:107], v[184:187]
v_exp_f32 v50, v50
M v[184:187], a[128:131], v[136:139], v[184:187]
v_cvt_pk_bf16_f32 v33, v34, v35
v_cvt_pk_bf16_f32 v34, v48, v49
M v[188:191], a[128:131], v[140:143], v[188:191]
v_exp_f32 v51, v51
M v[188:191], a[124:127], v[108:111], v[188:191]
buffer_load_dwordx4 v1, s[12:15], s25 offen offset:3072 sc1 lds
s_add_u32 m0, s29, 69632
s_waitcnt lgkmcnt(6)
M a[100:103], a[112:115], v[100:103], a[100:103]
M a[100:103], a[112:115], v[132:135], a[100:103]
M v[192:195], a[132:135], v[96:99], v[192:195]
v_exp_f32 v36, v36
M v[192:195], a[136:139], v[128:131], v[192:195]
ds_read_b128 a[164:167], v3 offset:38912
ds_read_b128 a[168:171], v3 offset:47104
M v[196:199], a[136:139], v[132:135], v[196:199]
v_exp_f32 v37, v37
M v[196:199], a[132:135], v[100:103], v[196:199]
buffer_load_dwordx4 v1, s[12:15], s32 offen offset:0 sc1 lds
M v[200:203], a[132:135], v[104:107], v[200:203]
v_exp_f32 v38, v38
M v[200:203], a[136:139], v[136:139], v[200:203]
v_cvt_pk_bf16_f32 v35, v50, v51
v_cvt_pk_bf16_f32 v36, v36, v37
M v[204:207], a[136:139], v[140:143], v[204:207]
v_exp_f32 v39, v39
M v[204:207], a[132:135], v[108:111], v[204:207]
buffer_load_dwordx4 v1, s[12:15], s32 offen offset:1024 sc1 lds
s_waitcnt lgkmcnt(6)
M a[104:107], a[112:115], v[104:107], a[104:107]
M a[104:107], a[112:115], v[136:139], a[104:107]
M v[208:211], a[140:143], v[96:99], v[208:211]
v_exp_f32 v52, v52
M v[208:211], a[144:147], v[128:131], v[208:211]
ds_read_b128 a[172:175], v3 offset:39936
ds_read_b128 a[176:179], v3 offset:48128
M v[212:215], a[144:147], v[132:135], v[212:215]
v_exp_f32 v53, v53
M v[212:215], a[140:143], v[100:103], v[212:215]
buffer_load_dwordx4 v1, s[12:15], s32 offen offset:2048 sc1 lds
M v[216:219], a[140:143], v[104:107], v[216:219]
v_exp_f32 v54, v54
M v[216:219], a[144:147], v[136:139], v[216:219]
v_cvt_pk_bf16_f32 v37, v38, v39
v_cvt_pk_bf16_f32 v38, v52, v53
M v[220:223], a[144:147], v[140:143], v[220:223]
v_exp_f32 v55, v55
M v[220:223], a[140:143], v[108:111], v[220:223]
buffer_load_dwordx4 v1, s[12:15], s32 offen offset:3072 sc1 lds
s_waitcnt lgkmcnt(6)
M a[108:111], a[112:115], v[108:111], a[108:111]
M a[108:111], a[112:115], v[140:143], a[108:111]
M v[224:227], a[148:151], v[96:99], v[224:227]
v_exp_f32 v40, v40
M v[224:227], a[152:155], v[128:131], v[224:227]
s_add_u32 s25, s25, 32768
s_cmp_eq_u32 s25, s27
s_cselect_b32 s25, s28, s25
s_cselect_b32 s27, -1, s27
M v[228:231], a[152:155], v[132:135], v[228:231]
v_exp_f32 v41, v41
M v[228:231], a[148:151], v[100:103], v[228:231]
v_cvt_pk_bf16_f32 v39, v54, v55
v_cvt_pk_bf16_f32 v40, v40, v41
M v[232:235], a[148:151], v[104:107], v[232:235]
v_exp_f32 v42, v42
M v[232:235], a[152:155], v[136:139], v[232:235]
M v[236:239], a[152:155], v[140:143], v[236:239]
v_exp_f32 v43, v43
M v[236:239], a[148:151], v[108:111], v[236:239]
v_cvt_pk_bf16_f32 v41, v42, v43
s_waitcnt lgkmcnt(4)
M v[240:243], a[156:159], v[96:99], v[240:243]
v_exp_f32 v56, v56
M v[240:243], a[160:163], v[128:131], v[240:243]
M v[244:247], a[160:163], v[132:135], v[244:247]
v_exp_f32 v57, v57
M v[244:247], a[156:159], v[100:103], v[244:247]
v_cvt_pk_bf16_f32 v42, v56, v57
M v[248:251], a[156:159], v[104:107], v[248:251]
v_exp_f32 v58, v58
M v[248:251], a[160:163], v[136:139], v[248:251]
s_waitcnt vmcnt(16) lgkmcnt(0)
s_barrier
ds_read_b128 a[116:119], v2 offset:0
ds_read_b128 a[120:123], v2 offset:1024
ds_read_b128 a[124:127], v2 offset:2048
ds_read_b128 a[128:131], v2 offset:3072
M v[252:255], a[160:163], v[140:143], v[252:255]
v_exp_f32 v59, v59
M v[252:255], a[156:159], v[108:111], v[252:255]
v_cvt_pk_bf16_f32 v43, v58, v59
M a[64:67], a[164:167], v[96:99], a[64:67]
v_exp_f32 v44, v44
M a[64:67], a[168:171], v[128:131], a[64:67]
ds_read_b128 a[132:135], v2 offset:4096
ds_read_b128 a[136:139], v2 offset:5120
M a[68:71], a[168:171], v[132:135], a[68:71]
v_exp_f32 v45, v45
M a[68:71], a[164:167], v[100:103], a[68:71]
v_cvt_pk_bf16_f32 v44, v44, v45
M a[72:75], a[164:167], v[104:107], a[72:75]
v_exp_f32 v46, v46
M a[72:75], a[168:171], v[136:139], a[72:75]
M a[76:79], a[168:171], v[140:143], a[76:79]
v_exp_f32 v47, v47
M a[76:79], a[164:167], v[108:111], a[76:79]
v_cvt_pk_bf16_f32 v45, v46, v47
M a[80:83], a[172:175], v[96:99], a[80:83]
v_exp_f32 v60, v60
M a[80:83], a[176:179], v[128:131], a[80:83]
ds_read_b128 a[140:143], v2 offset:6144
ds_read_b128 a[144:147], v2 offset:7168
M a[84:87], a[176:179], v[132:135], a[84:87]
v_exp_f32 v61, v61
M a[84:87], a[172:175], v[100:103], a[84:87]
v_cvt_pk_bf16_f32 v46, v60, v61
M a[88:91], a[172:175], v[104:107], a[88:91]
v_exp_f32 v62, v62
M a[88:91], a[176:179], v[136:139], a[88:91]
M a[92:95], a[176:179], v[140:143], a[92:95]
v_exp_f32 v63, v63
M a[92:95], a[172:175], v[108:111], a[92:95]
v_cvt_pk_bf16_f32 v47, v62, v63
s_waitcnt lgkmcnt(0)
Lk2_fin:
s_waitcnt vmcnt(8)
s_barrier
s_and_b32 s3, s2, 3
s_lshl_b32 s3, s3, 2
s_bfe_u32 s27, s2, 0x20003
s_add_u32 s27, s3, s27
s_lshl_b32 s43, s27, 8
s_add_u32 s43, s43, 8400896
v_lshlrev_b32 v15, 2, v0
buffer_load_dword v7, v15, s[52:55], s43 offen sc1
ds_read_b128 a[116:119], v2 offset:32768
ds_read_b128 a[120:123], v2 offset:40960
ds_read_b128 a[124:127], v2 offset:33792
ds_read_b128 a[128:131], v2 offset:41984
ds_read_b128 a[132:135], v2 offset:34816
ds_read_b128 a[136:139], v2 offset:43008
ds_read_b128 a[140:143], v2 offset:35840
ds_read_b128 a[144:147], v2 offset:44032
v_exp_f32 v64, v64
v_exp_f32 v65, v65
v_exp_f32 v66, v66
v_exp_f32 v67, v67
v_exp_f32 v80, v80
v_exp_f32 v81, v81
v_exp_f32 v82, v82
v_exp_f32 v83, v83
v_cvt_pk_bf16_f32 v64, v64, v65
v_cvt_pk_bf16_f32 v65, v66, v67
v_exp_f32 v68, v68
v_exp_f32 v69, v69
v_exp_f32 v70, v70
v_exp_f32 v71, v71
v_cvt_pk_bf16_f32 v66, v80, v81
v_cvt_pk_bf16_f32 v67, v82, v83
v_exp_f32 v84, v84
v_exp_f32 v85, v85
v_exp_f32 v86, v86
v_exp_f32 v87, v87
v_cvt_pk_bf16_f32 v68, v68, v69
v_cvt_pk_bf16_f32 v69, v70, v71
v_exp_f32 v72, v72
v_exp_f32 v73, v73
v_exp_f32 v74, v74
v_exp_f32 v75, v75
v_cvt_pk_bf16_f32 v70, v84, v85
v_cvt_pk_bf16_f32 v71, v86, v87
v_exp_f32 v88, v88
v_exp_f32 v89, v89
v_exp_f32 v90, v90
v_exp_f32 v91, v91
v_cvt_pk_bf16_f32 v72, v72, v73
v_cvt_pk_bf16_f32 v73, v74, v75
v_exp_f32 v76, v76
v_exp_f32 v77, v77
v_exp_f32 v78, v78
v_exp_f32 v79, v79
v_cvt_pk_bf16_f32 v74, v88, v89
v_cvt_pk_bf16_f32 v75, v90, v91
v_exp_f32 v92, v92
v_exp_f32 v93, v93
v_exp_f32 v94, v94
v_exp_f32 v95, v95
v_cvt_pk_bf16_f32 v76, v76, v77
v_cvt_pk_bf16_f32 v77, v78, v79
v_cvt_pk_bf16_f32 v78, v92, v93
v_cvt_pk_bf16_f32 v79, v94, v95
s_waitcnt lgkmcnt(6)
M v[160:163], a[116:119], v[32:35], v[160:163]
M v[160:163], a[120:123], v[64:67], v[160:163]
ds_read_b128 a[148:151], v2 offset:36864
ds_read_b128 a[152:155], v2 offset:45056
s_mov_b32 s61, 0
M v[164:167], a[120:123], v[68:71], v[164:167]
M v[164:167], a[116:119], v[36:39], v[164:167]
s_bfe_u32 s3, s2, 0x10002
M v[168:171], a[116:119], v[40:43], v[168:171]
M v[168:171], a[120:123], v[72:75], v[168:171]
s_lshl_b32 s3, s3, 3
M v[172:175], a[120:123], v[76:79], v[172:175]
M v[172:175], a[116:119], v[44:47], v[172:175]
s_waitcnt lgkmcnt(6)
s_lshr_b32 s28, s2, 5
M a[96:99], a[112:115], v[32:35], a[96:99]
M a[96:99], a[112:115], v[64:67], a[96:99]
M v[176:179], a[124:127], v[32:35], v[176:179]
M v[176:179], a[128:131], v[64:67], v[176:179]
ds_read_b128 a[156:159], v2 offset:37888
ds_read_b128 a[160:163], v2 offset:46080
s_add_u32 s28, s3, s28
M v[180:183], a[128:131], v[68:71], v[180:183]
s_lshl_b32 s25, s27, 18
M v[180:183], a[124:127], v[36:39], v[180:183]
M v[184:187], a[124:127], v[40:43], v[184:187]
s_lshl_b32 s3, s101, 12
M v[184:187], a[128:131], v[72:75], v[184:187]
M v[188:191], a[128:131], v[76:79], v[188:191]
s_add_u32 s25, s25, s3
M v[188:191], a[124:127], v[44:47], v[188:191]
s_waitcnt lgkmcnt(6)
M a[100:103], a[112:115], v[36:39], a[100:103]
M a[100:103], a[112:115], v[68:71], a[100:103]
M v[192:195], a[132:135], v[32:35], v[192:195]
s_lshl_b32 s26, s28, 7
M v[192:195], a[136:139], v[64:67], v[192:195]
ds_read_b128 a[164:167], v2 offset:38912
ds_read_b128 a[168:171], v2 offset:47104
M v[196:199], a[136:139], v[68:71], v[196:199]
s_lshl_b32 s42, s101, 11
M v[196:199], a[132:135], v[36:39], v[196:199]
M v[200:203], a[132:135], v[40:43], v[200:203]
s_add_u32 s44, s4, 83886080
s_addc_u32 s45, s5, 0
M v[200:203], a[136:139], v[72:75], v[200:203]
s_mov_b32 s46, 4194304
M v[204:207], a[136:139], v[76:79], v[204:207]
M v[204:207], a[132:135], v[44:47], v[204:207]
s_waitcnt lgkmcnt(6)
s_mov_b32 s47, 0x00020000
M a[104:107], a[112:115], v[40:43], a[104:107]
M a[104:107], a[112:115], v[72:75], a[104:107]
M v[208:211], a[140:143], v[32:35], v[208:211]
M v[208:211], a[144:147], v[64:67], v[208:211]
ds_read_b128 a[172:175], v2 offset:39936
ds_read_b128 a[176:179], v2 offset:48128
s_mov_b32 s50, 2097152
M v[212:215], a[144:147], v[68:71], v[212:215]
M v[212:215], a[140:143], v[36:39], v[212:215]
s_mov_b32 s51, 0x00020000
M v[216:219], a[140:143], v[40:43], v[216:219]
M v[216:219], a[144:147], v[72:75], v[216:219]
s_lshl_b32 s3, s101, 4
M v[220:223], a[144:147], v[76:79], v[220:223]
M v[220:223], a[140:143], v[44:47], v[220:223]
s_waitcnt lgkmcnt(6)
v_lshrrev_b32 v96, 3, v0
M a[108:111], a[112:115], v[44:47], a[108:111]
M a[108:111], a[112:115], v[76:79], a[108:111]
M v[224:227], a[148:151], v[32:35], v[224:227]
v_and_b32 v97, 6, v96
M v[224:227], a[152:155], v[64:67], v[224:227]
M v[228:231], a[152:155], v[68:71], v[228:231]
v_and_b32 v98, 7, v0
M v[228:231], a[148:151], v[36:39], v[228:231]
M v[232:235], a[148:151], v[40:43], v[232:235]
v_xor_b32 v97, v97, v98
M v[232:235], a[152:155], v[72:75], v[232:235]
M v[236:239], a[152:155], v[76:79], v[236:239]
v_add_u32 v96, s3, v96
M v[236:239], a[148:151], v[44:47], v[236:239]
s_waitcnt lgkmcnt(4)
M v[240:243], a[156:159], v[32:35], v[240:243]
v_lshlrev_b32 v96, 11, v96
M v[240:243], a[160:163], v[64:67], v[240:243]
M v[244:247], a[160:163], v[68:71], v[244:247]
v_lshl_add_u32 v99, v97, 4, v96
M v[244:247], a[156:159], v[36:39], v[244:247]
v_add_u32 v100, 15360, v99
M v[248:251], a[156:159], v[40:43], v[248:251]
M v[248:251], a[160:163], v[72:75], v[248:251]
s_waitcnt vmcnt(0) lgkmcnt(0)
s_barrier
v_cmp_ne_u32 vcc, 1, v7
s_nop 0
s_cbranch_vccnz Lk3_spinb0
Lk3_gotb0:
M v[252:255], a[160:163], v[76:79], v[252:255]
s_add_u32 m0, s42, 65536
s_nop 0
buffer_load_dwordx4 v99, s[48:51], s26 offen offset:0 lds
buffer_load_dwordx4 v100, s[48:51], s26 offen offset:1024 lds
M v[252:255], a[156:159], v[44:47], v[252:255]
buffer_load_dwordx4 a[192:195], v1, s[44:47], s25 offen offset:0 sc1
buffer_load_dwordx4 a[196:199], v1, s[44:47], s25 offen offset:1024 sc1
M a[64:67], a[164:167], v[32:35], a[64:67]
buffer_load_dwordx4 a[200:203], v1, s[44:47], s25 offen offset:2048 sc1
buffer_load_dwordx4 a[204:207], v1, s[44:47], s25 offen offset:3072 sc1
M a[64:67], a[168:171], v[64:67], a[64:67]
s_add_u32 s25, s25, 16384
s_add_u32 s26, s26, 131072
s_add_u32 m0, s42, 81920
s_nop 0
buffer_load_dwordx4 v99, s[48:51], s26 offen offset:0 lds
M a[68:71], a[168:171], v[68:71], a[68:71]
buffer_load_dwordx4 v100, s[48:51], s26 offen offset:1024 lds
buffer_load_dwordx4 a[208:211], v1, s[44:47], s25 offen offset:0 sc1
M a[68:71], a[164:167], v[36:39], a[68:71]
buffer_load_dwordx4 a[212:215], v1, s[44:47], s25 offen offset:1024 sc1
buffer_load_dwordx4 a[216:219], v1, s[44:47], s25 offen offset:2048 sc1
M a[72:75], a[164:167], v[40:43], a[72:75]
buffer_load_dwordx4 a[220:223], v1, s[44:47], s25 offen offset:3072 sc1
s_add_u32 s25, s25, 16384
s_add_u32 s26, s26, 131072
M a[72:75], a[168:171], v[72:75], a[72:75]
s_add_u32 m0, s42, 98304
s_nop 0
buffer_load_dwordx4 v99, s[48:51], s26 offen offset:0 lds
buffer_load_dwordx4 v100, s[48:51], s26 offen offset:1024 lds
M a[76:79], a[168:171], v[76:79], a[76:79]
buffer_load_dwordx4 a[224:227], v1, s[44:47], s25 offen offset:0 sc1
M a[76:79], a[164:167], v[44:47], a[76:79]
buffer_load_dwordx4 a[228:231], v1, s[44:47], s25 offen offset:1024 sc1
buffer_load_dwordx4 a[232:235], v1, s[44:47], s25 offen offset:2048 sc1
M a[80:83], a[172:175], v[32:35], a[80:83]
buffer_load_dwordx4 a[236:239], v1, s[44:47], s25 offen offset:3072 sc1
s_add_u32 s25, s25, 16384
s_add_u32 s26, s26, 131072
M a[80:83], a[176:179], v[64:67], a[80:83]
s_add_u32 m0, s42, 114688
s_nop 0
buffer_load_dwordx4 v99, s[48:51], s26 offen offset:0 lds
buffer_load_dwordx4 v100, s[48:51], s26 offen offset:1024 lds
M a[84:87], a[176:179], v[68:71], a[84:87]
buffer_load_dwordx4 a[240:243], v1, s[44:47], s25 offen offset:0 sc1
buffer_load_dwordx4 a[244:247], v1, s[44:47], s25 offen offset:1024 sc1
M a[84:87], a[172:175], v[36:39], a[84:87]
buffer_load_dwordx4 a[248:251], v1, s[44:47], s25 offen offset:2048 sc1
buffer_load_dwordx4 a[252:255], v1, s[44:47], s25 offen offset:3072 sc1
M a[88:91], a[172:175], v[40:43], a[88:91]
s_add_u32 s25, s25, 16384
s_add_u32 s26, s26, 131072
s_add_u32 m0, s42, 0
s_nop 0
buffer_load_dwordx4 v99, s[48:51], s26 offen offset:0 lds
M a[88:91], a[176:179], v[72:75], a[88:91]
buffer_load_dwordx4 v100, s[48:51], s26 offen offset:1024 lds
buffer_load_dwordx4 a[128:131], v1, s[44:47], s25 offen offset:0 sc1
M a[92:95], a[176:179], v[76:79], a[92:95]
buffer_load_dwordx4 a[132:135], v1, s[44:47], s25 offen offset:1024 sc1
buffer_load_dwordx4 a[136:139], v1, s[44:47], s25 offen offset:2048 sc1
M a[92:95], a[172:175], v[44:47], a[92:95]
buffer_load_dwordx4 a[140:143], v1, s[44:47], s25 offen offset:3072 sc1
s_add_u32 s25, s25, 16384
s_add_u32 s26, s26, 131072
Lk2_merge:
s_lshl_b32 s33, s23, 14
s_add_u32 s34, s33, 131072
s_add_u32 s33, s33, 32768
s_cmp_eq_u32 s24, 0
s_cselect_b32 s35, s34, s33
s_cselect_b32 s36, s33, s34
v_add_u32 v2, s35, v1
v_add_u32 v3, s36, v1
s_lshl_b32 s33, s22, 10
s_add_u32 s33, s33, 28672
s_xor_b32 s34, s33, 2048
v_add_u32 v14, s33, v1
v_add_u32 v15, s34, v1
v_accvgpr_read_b32 v20, a96
v_accvgpr_read_b32 v21, a100
v_accvgpr_read_b32 v22, a104
v_accvgpr_read_b32 v23, a108
ds_write_b128 v14, v[20:23]
s_cmp_eq_u32 s24, 1
s_waitcnt lgkmcnt(0)
s_cbranch_scc1 Lk2_mg1
ds_write_b128 v2, v[224:227] offset:0
ds_write_b128 v2, v[228:231] offset:1024
ds_write_b128 v2, v[232:235] offset:2048
ds_write_b128 v2, v[236:239] offset:3072
ds_write_b128 v2, v[240:243] offset:4096
ds_write_b128 v2, v[244:247] offset:5120
ds_write_b128 v2, v[248:251] offset:6144
ds_write_b128 v2, v[252:255] offset:7168
ds_write_b128 v2, a[64:67] offset:8192
ds_write_b128 v2, a[68:71] offset:9216
ds_write_b128 v2, a[72:75] offset:10240
ds_write_b128 v2, a[76:79] offset:11264
ds_write_b128 v2, a[80:83] offset:12288
ds_write_b128 v2, a[84:87] offset:13312
ds_write_b128 v2, a[88:91] offset:14336
ds_write_b128 v2, a[92:95] offset:15360
s_waitcnt lgkmcnt(0)
s_barrier
ds_read_b128 v[28:31], v15
ds_read_b128 v[32:35], v3 offset:0
ds_read_b128 v[36:39], v3 offset:1024
ds_read_b128 v[40:43], v3 offset:2048
ds_read_b128 v[44:47], v3 offset:3072
ds_read_b128 v[48:51], v3 offset:4096
ds_read_b128 v[52:55], v3 offset:5120
ds_read_b128 v[56:59], v3 offset:6144
ds_read_b128 v[60:63], v3 offset:7168
ds_read_b128 v[64:67], v3 offset:8192
ds_read_b128 v[68:71], v3 offset:9216
ds_read_b128 v[72:75], v3 offset:10240
ds_read_b128 v[76:79], v3 offset:11264
ds_read_b128 v[80:83], v3 offset:12288
ds_read_b128 v[84:87], v3 offset:13312
ds_read_b128 v[88:91], v3 offset:14336
ds_read_b128 v[92:95], v3 offset:15360
s_waitcnt lgkmcnt(15)
v_add_f32 v20, v20, v28
v_add_f32 v21, v21, v29
v_add_f32 v22, v22, v30
v_add_f32 v23, v23, v31
s_sub_u32 s35, 15, s21
v_rcp_f32 v8, v20
v_rcp_f32 v9, v21
v_rcp_f32 v10, v22
v_rcp_f32 v11, v23
v_subrev_u32 v20, 0x21800000, v20
v_subrev_u32 v21, 0x21800000, v21
v_subrev_u32 v22, 0x21800000, v22
v_subrev_u32 v23, 0x21800000, v23
v_max_u32 v12, v20, v21
v_max3_u32 v12, v12, v22, v23
s_mov_b32 s64, 0x207
v_pk_add_f32 v[160:161], v[160:161], v[32:33]
v_pk_add_f32 v[162:163], v[162:163], v[34:35]
s_waitcnt lgkmcnt(11)
v_pk_add_f32 v[176:177], v[176:177], v[48:49]
v_pk_add_f32 v[178:179], v[178:179], v[50:51]
v_pk_mul_f32 v[160:161], v[160:161], v[8:9] op_sel:[0,0] op_sel_hi:[1,0]
v_pk_mul_f32 v[162:163], v[162:163], v[8:9] op_sel:[0,0] op_sel_hi:[1,0]
v_pk_mul_f32 v[176:177], v[176:177], v[8:9] op_sel:[0,0] op_sel_hi:[1,0]
v_pk_mul_f32 v[178:179], v[178:179], v[8:9] op_sel:[0,0] op_sel_hi:[1,0]
v_cvt_pk_bf16_f32 v160, v160, v161
v_cvt_pk_bf16_f32 v161, v162, v163
v_cvt_pk_bf16_f32 v162, v176, v177
v_cvt_pk_bf16_f32 v163, v178, v179
v_pk_add_f32 v[164:165], v[164:165], v[36:37]
v_pk_add_f32 v[166:167], v[166:167], v[38:39]
s_waitcnt lgkmcnt(10)
v_pk_add_f32 v[180:181], v[180:181], v[52:53]
v_pk_add_f32 v[182:183], v[182:183], v[54:55]
M v[24:27], a[112:115], v[160:163], 0
v_pk_mul_f32 v[164:165], v[164:165], v[8:9] op_sel:[0,1] op_sel_hi:[1,1]
v_pk_mul_f32 v[166:167], v[166:167], v[8:9] op_sel:[0,1] op_sel_hi:[1,1]
v_pk_mul_f32 v[180:181], v[180:181], v[8:9] op_sel:[0,1] op_sel_hi:[1,1]
v_pk_mul_f32 v[182:183], v[182:183], v[8:9] op_sel:[0,1] op_sel_hi:[1,1]
v_cvt_pk_bf16_f32 v164, v164, v165
v_cvt_pk_bf16_f32 v165, v166, v167
v_cvt_pk_bf16_f32 v166, v180, v181
v_cvt_pk_bf16_f32 v167, v182, v183
v_pk_add_f32 v[168:169], v[168:169], v[40:41]
v_pk_add_f32 v[170:171], v[170:171], v[42:43]
s_waitcnt lgkmcnt(9)
v_pk_add_f32 v[184:185], v[184:185], v[56:57]
v_pk_add_f32 v[186:187], v[186:187], v[58:59]
M v[24:27], a[112:115], v[164:167], v[24:27]
v_pk_mul_f32 v[168:169], v[168:169], v[10:11] op_sel:[0,0] op_sel_hi:[1,0]
v_pk_mul_f32 v[170:171], v[170:171], v[10:11] op_sel:[0,0] op_sel_hi:[1,0]
v_pk_mul_f32 v[184:185], v[184:185], v[10:11] op_sel:[0,0] op_sel_hi:[1,0]
v_pk_mul_f32 v[186:187], v[186:187], v[10:11] op_sel:[0,0] op_sel_hi:[1,0]
v_cvt_pk_bf16_f32 v168, v168, v169
v_cvt_pk_bf16_f32 v169, v170, v171
v_cvt_pk_bf16_f32 v170, v184, v185
v_cvt_pk_bf16_f32 v171, v186, v187
v_pk_add_f32 v[172:173], v[172:173], v[44:45]
v_pk_add_f32 v[174:175], v[174:175], v[46:47]
s_waitcnt lgkmcnt(8)
v_pk_add_f32 v[188:189], v[188:189], v[60:61]
v_pk_add_f32 v[190:191], v[190:191], v[62:63]
M v[24:27], a[112:115], v[168:171], v[24:27]
v_pk_mul_f32 v[172:173], v[172:173], v[10:11] op_sel:[0,1] op_sel_hi:[1,1]
v_pk_mul_f32 v[174:175], v[174:175], v[10:11] op_sel:[0,1] op_sel_hi:[1,1]
v_pk_mul_f32 v[188:189], v[188:189], v[10:11] op_sel:[0,1] op_sel_hi:[1,1]
v_pk_mul_f32 v[190:191], v[190:191], v[10:11] op_sel:[0,1] op_sel_hi:[1,1]
v_cvt_pk_bf16_f32 v172, v172, v173
v_cvt_pk_bf16_f32 v173, v174, v175
v_cvt_pk_bf16_f32 v174, v188, v189
v_cvt_pk_bf16_f32 v175, v190, v191
s_waitcnt lgkmcnt(7)
v_pk_add_f32 v[192:193], v[192:193], v[64:65]
v_pk_add_f32 v[194:195], v[194:195], v[66:67]
s_waitcnt lgkmcnt(3)
v_pk_add_f32 v[208:209], v[208:209], v[80:81]
v_pk_add_f32 v[210:211], v[210:211], v[82:83]
M v[24:27], a[112:115], v[172:175], v[24:27]
v_pk_mul_f32 v[192:193], v[192:193], v[8:9] op_sel:[0,0] op_sel_hi:[1,0]
v_pk_mul_f32 v[194:195], v[194:195], v[8:9] op_sel:[0,0] op_sel_hi:[1,0]
v_pk_mul_f32 v[208:209], v[208:209], v[8:9] op_sel:[0,0] op_sel_hi:[1,0]
v_pk_mul_f32 v[210:211], v[210:211], v[8:9] op_sel:[0,0] op_sel_hi:[1,0]
v_cvt_pk_bf16_f32 v192, v192, v193
v_cvt_pk_bf16_f32 v193, v194, v195
v_cvt_pk_bf16_f32 v194, v208, v209
v_cvt_pk_bf16_f32 v195, v210, v211
v_pk_add_f32 v[196:197], v[196:197], v[68:69]
v_pk_add_f32 v[198:199], v[198:199], v[70:71]
s_waitcnt lgkmcnt(2)
v_pk_add_f32 v[212:213], v[212:213], v[84:85]
v_pk_add_f32 v[214:215], v[214:215], v[86:87]
M v[24:27], a[112:115], v[192:195], v[24:27]
v_pk_mul_f32 v[196:197], v[196:197], v[8:9] op_sel:[0,1] op_sel_hi:[1,1]
v_pk_mul_f32 v[198:199], v[198:199], v[8:9] op_sel:[0,1] op_sel_hi:[1,1]
v_pk_mul_f32 v[212:213], v[212:213], v[8:9] op_sel:[0,1] op_sel_hi:[1,1]
v_pk_mul_f32 v[214:215], v[214:215], v[8:9] op_sel:[0,1] op_sel_hi:[1,1]
v_cvt_pk_bf16_f32 v196, v196, v197
v_cvt_pk_bf16_f32 v197, v198, v199
v_cvt_pk_bf16_f32 v198, v212, v213
v_cvt_pk_bf16_f32 v199, v214, v215
v_pk_add_f32 v[200:201], v[200:201], v[72:73]
v_pk_add_f32 v[202:203], v[202:203], v[74:75]
s_waitcnt lgkmcnt(1)
v_pk_add_f32 v[216:217], v[216:217], v[88:89]
v_pk_add_f32 v[218:219], v[218:219], v[90:91]
M v[24:27], a[112:115], v[196:199], v[24:27]
v_pk_mul_f32 v[200:201], v[200:201], v[10:11] op_sel:[0,0] op_sel_hi:[1,0]
v_pk_mul_f32 v[202:203], v[202:203], v[10:11] op_sel:[0,0] op_sel_hi:[1,0]
v_pk_mul_f32 v[216:217], v[216:217], v[10:11] op_sel:[0,0] op_sel_hi:[1,0]
v_pk_mul_f32 v[218:219], v[218:219], v[10:11] op_sel:[0,0] op_sel_hi:[1,0]
v_cvt_pk_bf16_f32 v200, v200, v201
v_cvt_pk_bf16_f32 v201, v202, v203
v_cvt_pk_bf16_f32 v202, v216, v217
v_cvt_pk_bf16_f32 v203, v218, v219
v_pk_add_f32 v[204:205], v[204:205], v[76:77]
v_pk_add_f32 v[206:207], v[206:207], v[78:79]
s_waitcnt lgkmcnt(0)
v_pk_add_f32 v[220:221], v[220:221], v[92:93]
v_pk_add_f32 v[222:223], v[222:223], v[94:95]
M v[24:27], a[112:115], v[200:203], v[24:27]
v_pk_mul_f32 v[204:205], v[204:205], v[10:11] op_sel:[0,1] op_sel_hi:[1,1]
v_pk_mul_f32 v[206:207], v[206:207], v[10:11] op_sel:[0,1] op_sel_hi:[1,1]
v_pk_mul_f32 v[220:221], v[220:221], v[10:11] op_sel:[0,1] op_sel_hi:[1,1]
v_pk_mul_f32 v[222:223], v[222:223], v[10:11] op_sel:[0,1] op_sel_hi:[1,1]
v_cvt_pk_bf16_f32 v204, v204, v205
v_cvt_pk_bf16_f32 v205, v206, v207
v_cvt_pk_bf16_f32 v206, v220, v221
v_cvt_pk_bf16_f32 v207, v222, v223
s_nop 1
M v[24:27], a[112:115], v[204:207], v[24:27]
v_cmp_lt_u32 vcc, 0x3c000000, v12
s_nop 6
v_cmp_class_f32 s[40:41], v24, s64
s_nop 0
s_or_b64 vcc, vcc, s[40:41]
s_cbranch_vccnz Lbad_4
s_lshl_b32 s33, s35, 20
s_lshl_b32 s34, s20, 15
s_add_u32 s33, s33, s34
s_lshl_b32 s34, s23, 13
s_add_u32 s36, s33, s34
s_add_u32 s37, s36, 4096
s_add_u32 s38, s36, 16384
s_add_u32 s39, s36, 20480
buffer_store_dwordx4 v[160:163], v1, s[16:19], s36 offen offset:0 sc1
buffer_store_dwordx4 v[164:167], v1, s[16:19], s36 offen offset:2048 sc1
buffer_store_dwordx4 v[168:171], v1, s[16:19], s37 offen offset:0 sc1
buffer_store_dwordx4 v[172:175], v1, s[16:19], s37 offen offset:2048 sc1
buffer_store_dwordx4 v[192:195], v1, s[16:19], s36 offen offset:1024 sc1
buffer_store_dwordx4 v[196:199], v1, s[16:19], s36 offen offset:3072 sc1
buffer_store_dwordx4 v[200:203], v1, s[16:19], s37 offen offset:1024 sc1
buffer_store_dwordx4 v[204:207], v1, s[16:19], s37 offen offset:3072 sc1
s_branch Lfd_5
Lbad_4:
s_or_b32 s60, s60, 2
Lfd_5:
s_branch Lk2_chk
Lk2_mg1:
ds_write_b128 v2, v[160:163] offset:0
ds_write_b128 v2, v[164:167] offset:1024
ds_write_b128 v2, v[168:171] offset:2048
ds_write_b128 v2, v[172:175] offset:3072
ds_write_b128 v2, v[176:179] offset:4096
ds_write_b128 v2, v[180:183] offset:5120
ds_write_b128 v2, v[184:187] offset:6144
ds_write_b128 v2, v[188:191] offset:7168
ds_write_b128 v2, v[192:195] offset:8192
ds_write_b128 v2, v[196:199] offset:9216
ds_write_b128 v2, v[200:203] offset:10240
ds_write_b128 v2, v[204:207] offset:11264
ds_write_b128 v2, v[208:211] offset:12288
ds_write_b128 v2, v[212:215] offset:13312
ds_write_b128 v2, v[216:219] offset:14336
ds_write_b128 v2, v[220:223] offset:15360
s_waitcnt lgkmcnt(0)
s_barrier
ds_read_b128 v[28:31], v15
ds_read_b128 v[32:35], v3 offset:0
ds_read_b128 v[36:39], v3 offset:1024
ds_read_b128 v[40:43], v3 offset:2048
ds_read_b128 v[44:47], v3 offset:3072
ds_read_b128 v[48:51], v3 offset:4096
ds_read_b128 v[52:55], v3 offset:5120
ds_read_b128 v[56:59], v3 offset:6144
ds_read_b128 v[60:63], v3 offset:7168
ds_read_b128 v[64:67], v3 offset:8192
ds_read_b128 v[68:71], v3 offset:9216
ds_read_b128 v[72:75], v3 offset:10240
ds_read_b128 v[76:79], v3 offset:11264
ds_read_b128 v[80:83], v3 offset:12288
ds_read_b128 v[84:87], v3 offset:13312
ds_read_b128 v[88:91], v3 offset:14336
ds_read_b128 v[92:95], v3 offset:15360
s_waitcnt lgkmcnt(15)
v_add_f32 v20, v20, v28
v_add_f32 v21, v21, v29
v_add_f32 v22, v22, v30
v_add_f32 v23, v23, v31
s_sub_u32 s35, 15, s21
v_rcp_f32 v8, v20
v_rcp_f32 v9, v21
v_rcp_f32 v10, v22
v_rcp_f32 v11, v23
v_subrev_u32 v20, 0x21800000, v20
v_subrev_u32 v21, 0x21800000, v21
v_subrev_u32 v22, 0x21800000, v22
v_subrev_u32 v23, 0x21800000, v23
v_max_u32 v12, v20, v21
v_max3_u32 v12, v12, v22, v23
s_mov_b32 s64, 0x207
v_pk_add_f32 v[224:225], v[224:225], v[32:33]
v_pk_add_f32 v[226:227], v[226:227], v[34:35]
s_waitcnt lgkmcnt(11)
v_pk_add_f32 v[240:241], v[240:241], v[48:49]
v_pk_add_f32 v[242:243], v[242:243], v[50:51]
v_pk_mul_f32 v[224:225], v[224:225], v[8:9] op_sel:[0,0] op_sel_hi:[1,0]
v_pk_mul_f32 v[226:227], v[226:227], v[8:9] op_sel:[0,0] op_sel_hi:[1,0]
v_pk_mul_f32 v[240:241], v[240:241], v[8:9] op_sel:[0,0] op_sel_hi:[1,0]
v_pk_mul_f32 v[242:243], v[242:243], v[8:9] op_sel:[0,0] op_sel_hi:[1,0]
v_cvt_pk_bf16_f32 v224, v224, v225
v_cvt_pk_bf16_f32 v225, v226, v227
v_cvt_pk_bf16_f32 v226, v240, v241
v_cvt_pk_bf16_f32 v227, v242, v243
v_pk_add_f32 v[228:229], v[228:229], v[36:37]
v_pk_add_f32 v[230:231], v[230:231], v[38:39]
s_waitcnt lgkmcnt(10)
v_pk_add_f32 v[244:245], v[244:245], v[52:53]
v_pk_add_f32 v[246:247], v[246:247], v[54:55]
M v[24:27], a[112:115], v[224:227], 0
v_pk_mul_f32 v[228:229], v[228:229], v[8:9] op_sel:[0,1] op_sel_hi:[1,1]
v_pk_mul_f32 v[230:231], v[230:231], v[8:9] op_sel:[0,1] op_sel_hi:[1,1]
v_pk_mul_f32 v[244:245], v[244:245], v[8:9] op_sel:[0,1] op_sel_hi:[1,1]
v_pk_mul_f32 v[246:247], v[246:247], v[8:9] op_sel:[0,1] op_sel_hi:[1,1]
v_cvt_pk_bf16_f32 v228, v228, v229
v_cvt_pk_bf16_f32 v229, v230, v231
v_cvt_pk_bf16_f32 v230, v244, v245
v_cvt_pk_bf16_f32 v231, v246, v247
v_pk_add_f32 v[232:233], v[232:233], v[40:41]
v_pk_add_f32 v[234:235], v[234:235], v[42:43]
s_waitcnt lgkmcnt(9)
v_pk_add_f32 v[248:249], v[248:249], v[56:57]
v_pk_add_f32 v[250:251], v[250:251], v[58:59]
M v[24:27], a[112:115], v[228:231], v[24:27]
v_pk_mul_f32 v[232:233], v[232:233], v[10:11] op_sel:[0,0] op_sel_hi:[1,0]
v_pk_mul_f32 v[234:235], v[234:235], v[10:11] op_sel:[0,0] op_sel_hi:[1,0]
v_pk_mul_f32 v[248:249], v[248:249], v[10:11] op_sel:[0,0] op_sel_hi:[1,0]
v_pk_mul_f32 v[250:251], v[250:251], v[10:11] op_sel:[0,0] op_sel_hi:[1,0]
v_cvt_pk_bf16_f32 v232, v232, v233
v_cvt_pk_bf16_f32 v233, v234, v235
v_cvt_pk_bf16_f32 v234, v248, v249
v_cvt_pk_bf16_f32 v235, v250, v251
v_pk_add_f32 v[236:237], v[236:237], v[44:45]
v_pk_add_f32 v[238:239], v[238:239], v[46:47]
s_waitcnt lgkmcnt(8)
v_pk_add_f32 v[252:253], v[252:253], v[60:61]
v_pk_add_f32 v[254:255], v[254:255], v[62:63]
M v[24:27], a[112:115], v[232:235], v[24:27]
v_pk_mul_f32 v[236:237], v[236:237], v[10:11] op_sel:[0,1] op_sel_hi:[1,1]
v_pk_mul_f32 v[238:239], v[238:239], v[10:11] op_sel:[0,1] op_sel_hi:[1,1]
v_pk_mul_f32 v[252:253], v[252:253], v[10:11] op_sel:[0,1] op_sel_hi:[1,1]
v_pk_mul_f32 v[254:255], v[254:255], v[10:11] op_sel:[0,1] op_sel_hi:[1,1]
v_cvt_pk_bf16_f32 v236, v236, v237
v_cvt_pk_bf16_f32 v237, v238, v239
v_cvt_pk_bf16_f32 v238, v252, v253
v_cvt_pk_bf16_f32 v239, v254, v255
v_accvgpr_read_b32 v32, a64
v_accvgpr_read_b32 v33, a65
v_accvgpr_read_b32 v34, a66
v_accvgpr_read_b32 v35, a67
s_waitcnt lgkmcnt(7)
v_pk_add_f32 v[32:33], v[32:33], v[64:65]
v_pk_add_f32 v[34:35], v[34:35], v[66:67]
v_accvgpr_read_b32 v48, a80
v_accvgpr_read_b32 v49, a81
v_accvgpr_read_b32 v50, a82
v_accvgpr_read_b32 v51, a83
s_waitcnt lgkmcnt(3)
v_pk_add_f32 v[48:49], v[48:49], v[80:81]
v_pk_add_f32 v[50:51], v[50:51], v[82:83]
M v[24:27], a[112:115], v[236:239], v[24:27]
v_pk_mul_f32 v[32:33], v[32:33], v[8:9] op_sel:[0,0] op_sel_hi:[1,0]
v_pk_mul_f32 v[34:35], v[34:35], v[8:9] op_sel:[0,0] op_sel_hi:[1,0]
v_pk_mul_f32 v[48:49], v[48:49], v[8:9] op_sel:[0,0] op_sel_hi:[1,0]
v_pk_mul_f32 v[50:51], v[50:51], v[8:9] op_sel:[0,0] op_sel_hi:[1,0]
v_cvt_pk_bf16_f32 v32, v32, v33
v_cvt_pk_bf16_f32 v33, v34, v35
v_cvt_pk_bf16_f32 v34, v48, v49
v_cvt_pk_bf16_f32 v35, v50, v51
v_accvgpr_read_b32 v240, a68
v_accvgpr_read_b32 v241, a69
v_accvgpr_read_b32 v242, a70
v_accvgpr_read_b32 v243, a71
v_pk_add_f32 v[240:241], v[240:241], v[68:69]
v_pk_add_f32 v[242:243], v[242:243], v[70:71]
v_accvgpr_read_b32 v36, a84
v_accvgpr_read_b32 v37, a85
v_accvgpr_read_b32 v38, a86
v_accvgpr_read_b32 v39, a87
s_waitcnt lgkmcnt(2)
v_pk_add_f32 v[36:37], v[36:37], v[84:85]
v_pk_add_f32 v[38:39], v[38:39], v[86:87]
M v[24:27], a[112:115], v[32:35], v[24:27]
v_pk_mul_f32 v[240:241], v[240:241], v[8:9] op_sel:[0,1] op_sel_hi:[1,1]
v_pk_mul_f32 v[242:243], v[242:243], v[8:9] op_sel:[0,1] op_sel_hi:[1,1]
v_pk_mul_f32 v[36:37], v[36:37], v[8:9] op_sel:[0,1] op_sel_hi:[1,1]
v_pk_mul_f32 v[38:39], v[38:39], v[8:9] op_sel:[0,1] op_sel_hi:[1,1]
v_cvt_pk_bf16_f32 v240, v240, v241
v_cvt_pk_bf16_f32 v241, v242, v243
v_cvt_pk_bf16_f32 v242, v36, v37
v_cvt_pk_bf16_f32 v243, v38, v39
v_accvgpr_read_b32 v52, a72
v_accvgpr_read_b32 v53, a73
v_accvgpr_read_b32 v54, a74
v_accvgpr_read_b32 v55, a75
v_pk_add_f32 v[52:53], v[52:53], v[72:73]
v_pk_add_f32 v[54:55], v[54:55], v[74:75]
v_accvgpr_read_b32 v244, a88
v_accvgpr_read_b32 v245, a89
v_accvgpr_read_b32 v246, a90
v_accvgpr_read_b32 v247, a91
s_waitcnt lgkmcnt(1)
v_pk_add_f32 v[244:245], v[244:245], v[88:89]
v_pk_add_f32 v[246:247], v[246:247], v[90:91]
M v[24:27], a[112:115], v[240:243], v[24:27]
v_pk_mul_f32 v[52:53], v[52:53], v[10:11] op_sel:[0,0] op_sel_hi:[1,0]
v_pk_mul_f32 v[54:55], v[54:55], v[10:11] op_sel:[0,0] op_sel_hi:[1,0]
v_pk_mul_f32 v[244:245], v[244:245], v[10:11] op_sel:[0,0] op_sel_hi:[1,0]
v_pk_mul_f32 v[246:247], v[246:247], v[10:11] op_sel:[0,0] op_sel_hi:[1,0]
v_cvt_pk_bf16_f32 v52, v52, v53
v_cvt_pk_bf16_f32 v53, v54, v55
v_cvt_pk_bf16_f32 v54, v244, v245
v_cvt_pk_bf16_f32 v55, v246, v247
v_accvgpr_read_b32 v40, a76
v_accvgpr_read_b32 v41, a77
v_accvgpr_read_b32 v42, a78
v_accvgpr_read_b32 v43, a79
v_pk_add_f32 v[40:41], v[40:41], v[76:77]
v_pk_add_f32 v[42:43], v[42:43], v[78:79]
v_accvgpr_read_b32 v56, a92
v_accvgpr_read_b32 v57, a93
v_accvgpr_read_b32 v58, a94
v_accvgpr_read_b32 v59, a95
s_waitcnt lgkmcnt(0)
v_pk_add_f32 v[56:57], v[56:57], v[92:93]
v_pk_add_f32 v[58:59], v[58:59], v[94:95]
M v[24:27], a[112:115], v[52:55], v[24:27]
v_pk_mul_f32 v[40:41], v[40:41], v[10:11] op_sel:[0,1] op_sel_hi:[1,1]
v_pk_mul_f32 v[42:43], v[42:43], v[10:11] op_sel:[0,1] op_sel_hi:[1,1]
v_pk_mul_f32 v[56:57], v[56:57], v[10:11] op_sel:[0,1] op_sel_hi:[1,1]
v_pk_mul_f32 v[58:59], v[58:59], v[10:11] op_sel:[0,1] op_sel_hi:[1,1]
v_cvt_pk_bf16_f32 v40, v40, v41
v_cvt_pk_bf16_f32 v41, v42, v43
v_cvt_pk_bf16_f32 v42, v56, v57
v_cvt_pk_bf16_f32 v43, v58, v59
s_nop 1
M v[24:27], a[112:115], v[40:43], v[24:27]
v_cmp_lt_u32 vcc, 0x3c000000, v12
s_nop 6
v_cmp_class_f32 s[40:41], v24, s64
s_nop 0
s_or_b64 vcc, vcc, s[40:41]
s_cbranch_vccnz Lbad_6
s_lshl_b32 s33, s35, 20
s_lshl_b32 s34, s20, 15
s_add_u32 s33, s33, s34
s_lshl_b32 s34, s23, 13
s_add_u32 s36, s33, s34
s_add_u32 s37, s36, 4096
s_add_u32 s38, s36, 16384
s_add_u32 s39, s36, 20480
buffer_store_dwordx4 v[224:227], v1, s[16:19], s38 offen offset:0 sc1
buffer_store_dwordx4 v[228:231], v1, s[16:19], s38 offen offset:2048 sc1
buffer_store_dwordx4 v[232:235], v1, s[16:19], s39 offen offset:0 sc1
buffer_store_dwordx4 v[236:239], v1, s[16:19], s39 offen offset:2048 sc1
buffer_store_dwordx4 v[32:35], v1, s[16:19], s38 offen offset:1024 sc1
buffer_store_dwordx4 v[240:243], v1, s[16:19], s38 offen offset:3072 sc1
buffer_store_dwordx4 v[52:55], v1, s[16:19], s39 offen offset:1024 sc1
buffer_store_dwordx4 v[40:43], v1, s[16:19], s39 offen offset:3072 sc1
s_branch Lfd_7
Lbad_6:
s_or_b32 s60, s60, 2
Lfd_7:
Lk2_chk:
s_cmp_eq_u32 s60, 0
s_cbranch_scc1 Lk2_done
s_sub_u32 s56, 15, s21
s_lshl_b32 s33, s24, 1
s_lshl_b32 s61, 3, s33
s_and_b32 s34, s60, 2
s_bitcmp1_b32 s60, 0
s_cselect_b32 s56, s21, s56
s_cselect_b32 s61, 15, s61
s_cselect_b32 s60, s34, 0
s_waitcnt vmcnt(0)
s_lshl_b32 s33, s20, 7
s_lshl_b32 s34, s56, 3
s_add_u32 s33, s33, s34
s_lshl_b32 s34, s23, 2
s_add_u32 s33, s33, s34
s_lshl_b32 s33, s33, 12
buffer_load_dwordx4 a[0:3], v1, s[8:11], s33 offen offset:0 sc1
buffer_load_dwordx4 a[4:7], v1, s[8:11], s33 offen offset:1024 sc1
buffer_load_dwordx4 a[8:11], v1, s[8:11], s33 offen offset:2048 sc1
buffer_load_dwordx4 a[12:15], v1, s[8:11], s33 offen offset:3072 sc1
s_add_u32 s33, s33, 4096
buffer_load_dwordx4 a[16:19], v1, s[8:11], s33 offen offset:0 sc1
buffer_load_dwordx4 a[20:23], v1, s[8:11], s33 offen offset:1024 sc1
buffer_load_dwordx4 a[24:27], v1, s[8:11], s33 offen offset:2048 sc1
buffer_load_dwordx4 a[28:31], v1, s[8:11], s33 offen offset:3072 sc1
s_add_u32 s33, s33, 4096
buffer_load_dwordx4 a[32:35], v1, s[8:11], s33 offen offset:0 sc1
buffer_load_dwordx4 a[36:39], v1, s[8:11], s33 offen offset:1024 sc1
buffer_load_dwordx4 a[40:43], v1, s[8:11], s33 offen offset:2048 sc1
buffer_load_dwordx4 a[44:47], v1, s[8:11], s33 offen offset:3072 sc1
s_add_u32 s33, s33, 4096
buffer_load_dwordx4 a[48:51], v1, s[8:11], s33 offen offset:0 sc1
buffer_load_dwordx4 a[52:55], v1, s[8:11], s33 offen offset:1024 sc1
buffer_load_dwordx4 a[56:59], v1, s[8:11], s33 offen offset:2048 sc1
buffer_load_dwordx4 a[60:63], v1, s[8:11], s33 offen offset:3072 sc1
v_accvgpr_write_b32 a64, 0
v_accvgpr_write_b32 a65, 0
v_accvgpr_write_b32 a66, 0
v_accvgpr_write_b32 a67, 0
v_accvgpr_write_b32 a68, 0
v_accvgpr_write_b32 a69, 0
v_accvgpr_write_b32 a70, 0
v_accvgpr_write_b32 a71, 0
v_accvgpr_write_b32 a72, 0
v_accvgpr_write_b32 a73, 0
v_accvgpr_write_b32 a74, 0
v_accvgpr_write_b32 a75, 0
v_accvgpr_write_b32 a76, 0
v_accvgpr_write_b32 a77, 0
v_accvgpr_write_b32 a78, 0
v_accvgpr_write_b32 a79, 0
v_accvgpr_write_b32 a80, 0
v_accvgpr_write_b32 a81, 0
v_accvgpr_write_b32 a82, 0
v_accvgpr_write_b32 a83, 0
v_accvgpr_write_b32 a84, 0
v_accvgpr_write_b32 a85, 0
v_accvgpr_write_b32 a86, 0
v_accvgpr_write_b32 a87, 0
v_accvgpr_write_b32 a88, 0
v_accvgpr_write_b32 a89, 0
v_accvgpr_write_b32 a90, 0
v_accvgpr_write_b32 a91, 0
v_accvgpr_write_b32 a92, 0
v_accvgpr_write_b32 a93, 0
v_accvgpr_write_b32 a94, 0
v_accvgpr_write_b32 a95, 0
v_accvgpr_write_b32 a96, 0
v_accvgpr_write_b32 a97, 0
v_accvgpr_write_b32 a98, 0
v_accvgpr_write_b32 a99, 0
v_accvgpr_write_b32 a100, 0
v_accvgpr_write_b32 a101, 0
v_accvgpr_write_b32 a102, 0
v_accvgpr_write_b32 a103, 0
v_accvgpr_write_b32 a104, 0
v_accvgpr_write_b32 a105, 0
v_accvgpr_write_b32 a106, 0
v_accvgpr_write_b32 a107, 0
v_accvgpr_write_b32 a108, 0
v_accvgpr_write_b32 a109, 0
v_accvgpr_write_b32 a110, 0
v_accvgpr_write_b32 a111, 0
v_mov_b32 v160, 0
v_mov_b32 v161, 0
v_mov_b32 v162, 0
v_mov_b32 v163, 0
v_mov_b32 v164, 0
v_mov_b32 v165, 0
v_mov_b32 v166, 0
v_mov_b32 v167, 0
v_mov_b32 v168, 0
v_mov_b32 v169, 0
v_mov_b32 v170, 0
v_mov_b32 v171, 0
v_mov_b32 v172, 0
v_mov_b32 v173, 0
v_mov_b32 v174, 0
v_mov_b32 v175, 0
v_mov_b32 v176, 0
v_mov_b32 v177, 0
v_mov_b32 v178, 0
v_mov_b32 v179, 0
v_mov_b32 v180, 0
v_mov_b32 v181, 0
v_mov_b32 v182, 0
v_mov_b32 v183, 0
v_mov_b32 v184, 0
v_mov_b32 v185, 0
v_mov_b32 v186, 0
v_mov_b32 v187, 0
v_mov_b32 v188, 0
v_mov_b32 v189, 0
v_mov_b32 v190, 0
v_mov_b32 v191, 0
v_mov_b32 v192, 0
v_mov_b32 v193, 0
v_mov_b32 v194, 0
v_mov_b32 v195, 0
v_mov_b32 v196, 0
v_mov_b32 v197, 0
v_mov_b32 v198, 0
v_mov_b32 v199, 0
v_mov_b32 v200, 0
v_mov_b32 v201, 0
v_mov_b32 v202, 0
v_mov_b32 v203, 0
v_mov_b32 v204, 0
v_mov_b32 v205, 0
v_mov_b32 v206, 0
v_mov_b32 v207, 0
v_mov_b32 v208, 0
v_mov_b32 v209, 0
v_mov_b32 v210, 0
v_mov_b32 v211, 0
v_mov_b32 v212, 0
v_mov_b32 v213, 0
v_mov_b32 v214, 0
v_mov_b32 v215, 0
v_mov_b32 v216, 0
v_mov_b32 v217, 0
v_mov_b32 v218, 0
v_mov_b32 v219, 0
v_mov_b32 v220, 0
v_mov_b32 v221, 0
v_mov_b32 v222, 0
v_mov_b32 v223, 0
v_mov_b32 v224, 0
v_mov_b32 v225, 0
v_mov_b32 v226, 0
v_mov_b32 v227, 0
v_mov_b32 v228, 0
v_mov_b32 v229, 0
v_mov_b32 v230, 0
v_mov_b32 v231, 0
v_mov_b32 v232, 0
v_mov_b32 v233, 0
v_mov_b32 v234, 0
v_mov_b32 v235, 0
v_mov_b32 v236, 0
v_mov_b32 v237, 0
v_mov_b32 v238, 0
v_mov_b32 v239, 0
v_mov_b32 v240, 0
v_mov_b32 v241, 0
v_mov_b32 v242, 0
v_mov_b32 v243, 0
v_mov_b32 v244, 0
v_mov_b32 v245, 0
v_mov_b32 v246, 0
v_mov_b32 v247, 0
v_mov_b32 v248, 0
v_mov_b32 v249, 0
v_mov_b32 v250, 0
v_mov_b32 v251, 0
v_mov_b32 v252, 0
v_mov_b32 v253, 0
v_mov_b32 v254, 0
v_mov_b32 v255, 0
v_mov_b32 v8, v4
v_mov_b32 v9, v4
v_mov_b32 v10, v4
v_mov_b32 v11, v4
s_lshl_b32 s57, s20, 20
s_lshl_b32 s58, s56, 7
s_lshl_b32 s59, s56, 1
s_add_u32 s59, s59, 2
Lslow_8:
s_add_u32 s35, s57, 0
buffer_load_dwordx4 v[96:99], v1, s[12:15], s35 offen offset:0 sc1
buffer_load_dwordx4 v[100:103], v1, s[12:15], s35 offen offset:1024 sc1
buffer_load_dwordx4 v[104:107], v1, s[12:15], s35 offen offset:2048 sc1
buffer_load_dwordx4 v[108:111], v1, s[12:15], s35 offen offset:3072 sc1
s_add_u32 s35, s57, 4096
buffer_load_dwordx4 v[112:115], v1, s[12:15], s35 offen offset:0 sc1
buffer_load_dwordx4 v[116:119], v1, s[12:15], s35 offen offset:1024 sc1
buffer_load_dwordx4 v[120:123], v1, s[12:15], s35 offen offset:2048 sc1
buffer_load_dwordx4 v[124:127], v1, s[12:15], s35 offen offset:3072 sc1
s_add_u32 s35, s57, 8192
buffer_load_dwordx4 v[128:131], v1, s[12:15], s35 offen offset:0 sc1
buffer_load_dwordx4 v[132:135], v1, s[12:15], s35 offen offset:1024 sc1
buffer_load_dwordx4 v[136:139], v1, s[12:15], s35 offen offset:2048 sc1
buffer_load_dwordx4 v[140:143], v1, s[12:15], s35 offen offset:3072 sc1
s_add_u32 s35, s57, 12288
buffer_load_dwordx4 v[144:147], v1, s[12:15], s35 offen offset:0 sc1
buffer_load_dwordx4 v[148:151], v1, s[12:15], s35 offen offset:1024 sc1
buffer_load_dwordx4 v[152:155], v1, s[12:15], s35 offen offset:2048 sc1
buffer_load_dwordx4 v[156:159], v1, s[12:15], s35 offen offset:3072 sc1
s_lshl_b32 s33, s23, 6
s_add_i32 s33, s33, s58
s_cmp_gt_i32 s33, 0
s_cselect_b32 s34, 0, 0xf149f2ca
s_cmp_lt_i32 s33, 0
s_cselect_b32 s33, 0xf149f2ca, 0
v_mov_b32 v20, s34
v_mov_b32 v21, s34
v_mov_b32 v22, s34
v_mov_b32 v23, s34
v_mov_b32 v28, s33
v_mov_b32 v29, s33
v_mov_b32 v30, s33
v_mov_b32 v31, s33
v_med3_f32 v24, v16, v20, v28
v_med3_f32 v25, v17, v20, v28
v_med3_f32 v26, v18, v20, v28
v_med3_f32 v27, v19, v20, v28
s_waitcnt vmcnt(0)
s_nop 0
M v[32:35], v[96:99], a[0:3], v[24:27]
M v[32:35], v[100:103], a[4:7], v[32:35]
M v[32:35], v[104:107], a[8:11], v[32:35]
M v[32:35], v[108:111], a[12:15], v[32:35]
M v[36:39], v[96:99], a[16:19], v[28:31]
M v[36:39], v[100:103], a[20:23], v[36:39]
M v[36:39], v[104:107], a[24:27], v[36:39]
M v[36:39], v[108:111], a[28:31], v[36:39]
M v[40:43], v[96:99], a[32:35], v[28:31]
M v[40:43], v[100:103], a[36:39], v[40:43]
M v[40:43], v[104:107], a[40:43], v[40:43]
M v[40:43], v[108:111], a[44:47], v[40:43]
M v[44:47], v[96:99], a[48:51], v[28:31]
M v[44:47], v[100:103], a[52:55], v[44:47]
M v[44:47], v[104:107], a[56:59], v[44:47]
M v[44:47], v[108:111], a[60:63], v[44:47]
M v[48:51], v[112:115], a[0:3], v[20:23]
M v[48:51], v[116:119], a[4:7], v[48:51]
M v[48:51], v[120:123], a[8:11], v[48:51]
M v[48:51], v[124:127], a[12:15], v[48:51]
M v[52:55], v[112:115], a[16:19], v[24:27]
M v[52:55], v[116:119], a[20:23], v[52:55]
M v[52:55], v[120:123], a[24:27], v[52:55]
M v[52:55], v[124:127], a[28:31], v[52:55]
M v[56:59], v[112:115], a[32:35], v[28:31]
M v[56:59], v[116:119], a[36:39], v[56:59]
M v[56:59], v[120:123], a[40:43], v[56:59]
M v[56:59], v[124:127], a[44:47], v[56:59]
M v[60:63], v[112:115], a[48:51], v[28:31]
M v[60:63], v[116:119], a[52:55], v[60:63]
M v[60:63], v[120:123], a[56:59], v[60:63]
M v[60:63], v[124:127], a[60:63], v[60:63]
M v[64:67], v[128:131], a[0:3], v[20:23]
M v[64:67], v[132:135], a[4:7], v[64:67]
M v[64:67], v[136:139], a[8:11], v[64:67]
M v[64:67], v[140:143], a[12:15], v[64:67]
M v[68:71], v[128:131], a[16:19], v[20:23]
M v[68:71], v[132:135], a[20:23], v[68:71]
M v[68:71], v[136:139], a[24:27], v[68:71]
M v[68:71], v[140:143], a[28:31], v[68:71]
M v[72:75], v[128:131], a[32:35], v[24:27]
M v[72:75], v[132:135], a[36:39], v[72:75]
M v[72:75], v[136:139], a[40:43], v[72:75]
M v[72:75], v[140:143], a[44:47], v[72:75]
M v[76:79], v[128:131], a[48:51], v[28:31]
M v[76:79], v[132:135], a[52:55], v[76:79]
M v[76:79], v[136:139], a[56:59], v[76:79]
M v[76:79], v[140:143], a[60:63], v[76:79]
M v[80:83], v[144:147], a[0:3], v[20:23]
M v[80:83], v[148:151], a[4:7], v[80:83]
M v[80:83], v[152:155], a[8:11], v[80:83]
M v[80:83], v[156:159], a[12:15], v[80:83]
M v[84:87], v[144:147], a[16:19], v[20:23]
M v[84:87], v[148:151], a[20:23], v[84:87]
M v[84:87], v[152:155], a[24:27], v[84:87]
M v[84:87], v[156:159], a[28:31], v[84:87]
M v[88:91], v[144:147], a[32:35], v[20:23]
M v[88:91], v[148:151], a[36:39], v[88:91]
M v[88:91], v[152:155], a[40:43], v[88:91]
M v[88:91], v[156:159], a[44:47], v[88:91]
M v[92:95], v[144:147], a[48:51], v[24:27]
M v[92:95], v[148:151], a[52:55], v[92:95]
M v[92:95], v[152:155], a[56:59], v[92:95]
M v[92:95], v[156:159], a[60:63], v[92:95]
s_nop 7
s_add_u32 s35, s57, 16384
buffer_load_dwordx4 v[96:99], v1, s[12:15], s35 offen offset:0 sc1
buffer_load_dwordx4 v[100:103], v1, s[12:15], s35 offen offset:1024 sc1
buffer_load_dwordx4 v[104:107], v1, s[12:15], s35 offen offset:2048 sc1
buffer_load_dwordx4 v[108:111], v1, s[12:15], s35 offen offset:3072 sc1
s_add_u32 s35, s57, 20480
buffer_load_dwordx4 v[112:115], v1, s[12:15], s35 offen offset:0 sc1
buffer_load_dwordx4 v[116:119], v1, s[12:15], s35 offen offset:1024 sc1
buffer_load_dwordx4 v[120:123], v1, s[12:15], s35 offen offset:2048 sc1
buffer_load_dwordx4 v[124:127], v1, s[12:15], s35 offen offset:3072 sc1
s_add_u32 s35, s57, 24576
buffer_load_dwordx4 v[128:131], v1, s[12:15], s35 offen offset:0 sc1
buffer_load_dwordx4 v[132:135], v1, s[12:15], s35 offen offset:1024 sc1
buffer_load_dwordx4 v[136:139], v1, s[12:15], s35 offen offset:2048 sc1
buffer_load_dwordx4 v[140:143], v1, s[12:15], s35 offen offset:3072 sc1
s_add_u32 s35, s57, 28672
buffer_load_dwordx4 v[144:147], v1, s[12:15], s35 offen offset:0 sc1
buffer_load_dwordx4 v[148:151], v1, s[12:15], s35 offen offset:1024 sc1
buffer_load_dwordx4 v[152:155], v1, s[12:15], s35 offen offset:2048 sc1
buffer_load_dwordx4 v[156:159], v1, s[12:15], s35 offen offset:3072 sc1
v_max3_f32 v13, v32, v33, v8
v_max3_f32 v13, v13, v34, v35
v_max3_f32 v13, v13, v48, v49
v_max3_f32 v13, v13, v50, v51
v_max3_f32 v13, v13, v64, v65
v_max3_f32 v13, v13, v66, v67
v_max3_f32 v13, v13, v80, v81
v_max3_f32 v13, v13, v82, v83
v_mov_b32 v14, v13
s_nop 1
v_permlane16_swap_b32 v13, v14
v_max_f32 v13, v13, v14
v_mov_b32 v14, v13
s_nop 1
v_permlane32_swap_b32 v13, v14
v_max_f32 v13, v13, v14
v_sub_f32 v12, v8, v13
v_exp_f32 v12, v12
v_mov_b32 v8, v13
v_sub_f32 v32, v32, v13
v_sub_f32 v33, v33, v13
v_sub_f32 v34, v34, v13
v_sub_f32 v35, v35, v13
v_sub_f32 v48, v48, v13
v_sub_f32 v49, v49, v13
v_sub_f32 v50, v50, v13
v_sub_f32 v51, v51, v13
v_sub_f32 v64, v64, v13
v_sub_f32 v65, v65, v13
v_sub_f32 v66, v66, v13
v_sub_f32 v67, v67, v13
v_sub_f32 v80, v80, v13
v_sub_f32 v81, v81, v13
v_sub_f32 v82, v82, v13
v_sub_f32 v83, v83, v13
v_mul_f32 v160, v160, v12
v_mul_f32 v161, v161, v12
v_mul_f32 v162, v162, v12
v_mul_f32 v163, v163, v12
v_mul_f32 v176, v176, v12
v_mul_f32 v177, v177, v12
v_mul_f32 v178, v178, v12
v_mul_f32 v179, v179, v12
v_mul_f32 v192, v192, v12
v_mul_f32 v193, v193, v12
v_mul_f32 v194, v194, v12
v_mul_f32 v195, v195, v12
v_mul_f32 v208, v208, v12
v_mul_f32 v209, v209, v12
v_mul_f32 v210, v210, v12
v_mul_f32 v211, v211, v12
v_mul_f32 v224, v224, v12
v_mul_f32 v225, v225, v12
v_mul_f32 v226, v226, v12
v_mul_f32 v227, v227, v12
v_mul_f32 v240, v240, v12
v_mul_f32 v241, v241, v12
v_mul_f32 v242, v242, v12
v_mul_f32 v243, v243, v12
v_accvgpr_read_b32 v14, a64
v_mul_f32 v14, v14, v12
v_accvgpr_write_b32 a64, v14
v_accvgpr_read_b32 v14, a65
v_mul_f32 v14, v14, v12
v_accvgpr_write_b32 a65, v14
v_accvgpr_read_b32 v14, a66
v_mul_f32 v14, v14, v12
v_accvgpr_write_b32 a66, v14
v_accvgpr_read_b32 v14, a67
v_mul_f32 v14, v14, v12
v_accvgpr_write_b32 a67, v14
v_accvgpr_read_b32 v14, a80
v_mul_f32 v14, v14, v12
v_accvgpr_write_b32 a80, v14
v_accvgpr_read_b32 v14, a81
v_mul_f32 v14, v14, v12
v_accvgpr_write_b32 a81, v14
v_accvgpr_read_b32 v14, a82
v_mul_f32 v14, v14, v12
v_accvgpr_write_b32 a82, v14
v_accvgpr_read_b32 v14, a83
v_mul_f32 v14, v14, v12
v_accvgpr_write_b32 a83, v14
v_accvgpr_read_b32 v14, a96
v_mul_f32 v14, v14, v12
v_accvgpr_write_b32 a96, v14
v_accvgpr_read_b32 v14, a97
v_mul_f32 v14, v14, v12
v_accvgpr_write_b32 a97, v14
v_accvgpr_read_b32 v14, a98
v_mul_f32 v14, v14, v12
v_accvgpr_write_b32 a98, v14
v_accvgpr_read_b32 v14, a99
v_mul_f32 v14, v14, v12
v_accvgpr_write_b32 a99, v14
v_max3_f32 v13, v36, v37, v9
v_max3_f32 v13, v13, v38, v39
v_max3_f32 v13, v13, v52, v53
v_max3_f32 v13, v13, v54, v55
v_max3_f32 v13, v13, v68, v69
v_max3_f32 v13, v13, v70, v71
v_max3_f32 v13, v13, v84, v85
v_max3_f32 v13, v13, v86, v87
v_mov_b32 v14, v13
s_nop 1
v_permlane16_swap_b32 v13, v14
v_max_f32 v13, v13, v14
v_mov_b32 v14, v13
s_nop 1
v_permlane32_swap_b32 v13, v14
v_max_f32 v13, v13, v14
v_sub_f32 v12, v9, v13
v_exp_f32 v12, v12
v_mov_b32 v9, v13
v_sub_f32 v36, v36, v13
v_sub_f32 v37, v37, v13
v_sub_f32 v38, v38, v13
v_sub_f32 v39, v39, v13
v_sub_f32 v52, v52, v13
v_sub_f32 v53, v53, v13
v_sub_f32 v54, v54, v13
v_sub_f32 v55, v55, v13
v_sub_f32 v68, v68, v13
v_sub_f32 v69, v69, v13
v_sub_f32 v70, v70, v13
v_sub_f32 v71, v71, v13
v_sub_f32 v84, v84, v13
v_sub_f32 v85, v85, v13
v_sub_f32 v86, v86, v13
v_sub_f32 v87, v87, v13
v_mul_f32 v164, v164, v12
v_mul_f32 v165, v165, v12
v_mul_f32 v166, v166, v12
v_mul_f32 v167, v167, v12
v_mul_f32 v180, v180, v12
v_mul_f32 v181, v181, v12
v_mul_f32 v182, v182, v12
v_mul_f32 v183, v183, v12
v_mul_f32 v196, v196, v12
v_mul_f32 v197, v197, v12
v_mul_f32 v198, v198, v12
v_mul_f32 v199, v199, v12
v_mul_f32 v212, v212, v12
v_mul_f32 v213, v213, v12
v_mul_f32 v214, v214, v12
v_mul_f32 v215, v215, v12
v_mul_f32 v228, v228, v12
v_mul_f32 v229, v229, v12
v_mul_f32 v230, v230, v12
v_mul_f32 v231, v231, v12
v_mul_f32 v244, v244, v12
v_mul_f32 v245, v245, v12
v_mul_f32 v246, v246, v12
v_mul_f32 v247, v247, v12
v_accvgpr_read_b32 v14, a68
v_mul_f32 v14, v14, v12
v_accvgpr_write_b32 a68, v14
v_accvgpr_read_b32 v14, a69
v_mul_f32 v14, v14, v12
v_accvgpr_write_b32 a69, v14
v_accvgpr_read_b32 v14, a70
v_mul_f32 v14, v14, v12
v_accvgpr_write_b32 a70, v14
v_accvgpr_read_b32 v14, a71
v_mul_f32 v14, v14, v12
v_accvgpr_write_b32 a71, v14
v_accvgpr_read_b32 v14, a84
v_mul_f32 v14, v14, v12
v_accvgpr_write_b32 a84, v14
v_accvgpr_read_b32 v14, a85
v_mul_f32 v14, v14, v12
v_accvgpr_write_b32 a85, v14
v_accvgpr_read_b32 v14, a86
v_mul_f32 v14, v14, v12
v_accvgpr_write_b32 a86, v14
v_accvgpr_read_b32 v14, a87
v_mul_f32 v14, v14, v12
v_accvgpr_write_b32 a87, v14
v_accvgpr_read_b32 v14, a100
v_mul_f32 v14, v14, v12
v_accvgpr_write_b32 a100, v14
v_accvgpr_read_b32 v14, a101
v_mul_f32 v14, v14, v12
v_accvgpr_write_b32 a101, v14
v_accvgpr_read_b32 v14, a102
v_mul_f32 v14, v14, v12
v_accvgpr_write_b32 a102, v14
v_accvgpr_read_b32 v14, a103
v_mul_f32 v14, v14, v12
v_accvgpr_write_b32 a103, v14
v_max3_f32 v13, v40, v41, v10
v_max3_f32 v13, v13, v42, v43
v_max3_f32 v13, v13, v56, v57
v_max3_f32 v13, v13, v58, v59
v_max3_f32 v13, v13, v72, v73
v_max3_f32 v13, v13, v74, v75
v_max3_f32 v13, v13, v88, v89
v_max3_f32 v13, v13, v90, v91
v_mov_b32 v14, v13
s_nop 1
v_permlane16_swap_b32 v13, v14
v_max_f32 v13, v13, v14
v_mov_b32 v14, v13
s_nop 1
v_permlane32_swap_b32 v13, v14
v_max_f32 v13, v13, v14
v_sub_f32 v12, v10, v13
v_exp_f32 v12, v12
v_mov_b32 v10, v13
v_sub_f32 v40, v40, v13
v_sub_f32 v41, v41, v13
v_sub_f32 v42, v42, v13
v_sub_f32 v43, v43, v13
v_sub_f32 v56, v56, v13
v_sub_f32 v57, v57, v13
v_sub_f32 v58, v58, v13
v_sub_f32 v59, v59, v13
v_sub_f32 v72, v72, v13
v_sub_f32 v73, v73, v13
v_sub_f32 v74, v74, v13
v_sub_f32 v75, v75, v13
v_sub_f32 v88, v88, v13
v_sub_f32 v89, v89, v13
v_sub_f32 v90, v90, v13
v_sub_f32 v91, v91, v13
v_mul_f32 v168, v168, v12
v_mul_f32 v169, v169, v12
v_mul_f32 v170, v170, v12
v_mul_f32 v171, v171, v12
v_mul_f32 v184, v184, v12
v_mul_f32 v185, v185, v12
v_mul_f32 v186, v186, v12
v_mul_f32 v187, v187, v12
v_mul_f32 v200, v200, v12
v_mul_f32 v201, v201, v12
v_mul_f32 v202, v202, v12
v_mul_f32 v203, v203, v12
v_mul_f32 v216, v216, v12
v_mul_f32 v217, v217, v12
v_mul_f32 v218, v218, v12
v_mul_f32 v219, v219, v12
v_mul_f32 v232, v232, v12
v_mul_f32 v233, v233, v12
v_mul_f32 v234, v234, v12
v_mul_f32 v235, v235, v12
v_mul_f32 v248, v248, v12
v_mul_f32 v249, v249, v12
v_mul_f32 v250, v250, v12
v_mul_f32 v251, v251, v12
v_accvgpr_read_b32 v14, a72
v_mul_f32 v14, v14, v12
v_accvgpr_write_b32 a72, v14
v_accvgpr_read_b32 v14, a73
v_mul_f32 v14, v14, v12
v_accvgpr_write_b32 a73, v14
v_accvgpr_read_b32 v14, a74
v_mul_f32 v14, v14, v12
v_accvgpr_write_b32 a74, v14
v_accvgpr_read_b32 v14, a75
v_mul_f32 v14, v14, v12
v_accvgpr_write_b32 a75, v14
v_accvgpr_read_b32 v14, a88
v_mul_f32 v14, v14, v12
v_accvgpr_write_b32 a88, v14
v_accvgpr_read_b32 v14, a89
v_mul_f32 v14, v14, v12
v_accvgpr_write_b32 a89, v14
v_accvgpr_read_b32 v14, a90
v_mul_f32 v14, v14, v12
v_accvgpr_write_b32 a90, v14
v_accvgpr_read_b32 v14, a91
v_mul_f32 v14, v14, v12
v_accvgpr_write_b32 a91, v14
v_accvgpr_read_b32 v14, a104
v_mul_f32 v14, v14, v12
v_accvgpr_write_b32 a104, v14
v_accvgpr_read_b32 v14, a105
v_mul_f32 v14, v14, v12
v_accvgpr_write_b32 a105, v14
v_accvgpr_read_b32 v14, a106
v_mul_f32 v14, v14, v12
v_accvgpr_write_b32 a106, v14
v_accvgpr_read_b32 v14, a107
v_mul_f32 v14, v14, v12
v_accvgpr_write_b32 a107, v14
v_max3_f32 v13, v44, v45, v11
v_max3_f32 v13, v13, v46, v47
v_max3_f32 v13, v13, v60, v61
v_max3_f32 v13, v13, v62, v63
v_max3_f32 v13, v13, v76, v77
v_max3_f32 v13, v13, v78, v79
v_max3_f32 v13, v13, v92, v93
v_max3_f32 v13, v13, v94, v95
v_mov_b32 v14, v13
s_nop 1
v_permlane16_swap_b32 v13, v14
v_max_f32 v13, v13, v14
v_mov_b32 v14, v13
s_nop 1
v_permlane32_swap_b32 v13, v14
v_max_f32 v13, v13, v14
v_sub_f32 v12, v11, v13
v_exp_f32 v12, v12
v_mov_b32 v11, v13
v_sub_f32 v44, v44, v13
v_sub_f32 v45, v45, v13
v_sub_f32 v46, v46, v13
v_sub_f32 v47, v47, v13
v_sub_f32 v60, v60, v13
v_sub_f32 v61, v61, v13
v_sub_f32 v62, v62, v13
v_sub_f32 v63, v63, v13
v_sub_f32 v76, v76, v13
v_sub_f32 v77, v77, v13
v_sub_f32 v78, v78, v13
v_sub_f32 v79, v79, v13
v_sub_f32 v92, v92, v13
v_sub_f32 v93, v93, v13
v_sub_f32 v94, v94, v13
v_sub_f32 v95, v95, v13
v_mul_f32 v172, v172, v12
v_mul_f32 v173, v173, v12
v_mul_f32 v174, v174, v12
v_mul_f32 v175, v175, v12
v_mul_f32 v188, v188, v12
v_mul_f32 v189, v189, v12
v_mul_f32 v190, v190, v12
v_mul_f32 v191, v191, v12
v_mul_f32 v204, v204, v12
v_mul_f32 v205, v205, v12
v_mul_f32 v206, v206, v12
v_mul_f32 v207, v207, v12
v_mul_f32 v220, v220, v12
v_mul_f32 v221, v221, v12
v_mul_f32 v222, v222, v12
v_mul_f32 v223, v223, v12
v_mul_f32 v236, v236, v12
v_mul_f32 v237, v237, v12
v_mul_f32 v238, v238, v12
v_mul_f32 v239, v239, v12
v_mul_f32 v252, v252, v12
v_mul_f32 v253, v253, v12
v_mul_f32 v254, v254, v12
v_mul_f32 v255, v255, v12
v_accvgpr_read_b32 v14, a76
v_mul_f32 v14, v14, v12
v_accvgpr_write_b32 a76, v14
v_accvgpr_read_b32 v14, a77
v_mul_f32 v14, v14, v12
v_accvgpr_write_b32 a77, v14
v_accvgpr_read_b32 v14, a78
v_mul_f32 v14, v14, v12
v_accvgpr_write_b32 a78, v14
v_accvgpr_read_b32 v14, a79
v_mul_f32 v14, v14, v12
v_accvgpr_write_b32 a79, v14
v_accvgpr_read_b32 v14, a92
v_mul_f32 v14, v14, v12
v_accvgpr_write_b32 a92, v14
v_accvgpr_read_b32 v14, a93
v_mul_f32 v14, v14, v12
v_accvgpr_write_b32 a93, v14
v_accvgpr_read_b32 v14, a94
v_mul_f32 v14, v14, v12
v_accvgpr_write_b32 a94, v14
v_accvgpr_read_b32 v14, a95
v_mul_f32 v14, v14, v12
v_accvgpr_write_b32 a95, v14
v_accvgpr_read_b32 v14, a108
v_mul_f32 v14, v14, v12
v_accvgpr_write_b32 a108, v14
v_accvgpr_read_b32 v14, a109
v_mul_f32 v14, v14, v12
v_accvgpr_write_b32 a109, v14
v_accvgpr_read_b32 v14, a110
v_mul_f32 v14, v14, v12
v_accvgpr_write_b32 a110, v14
v_accvgpr_read_b32 v14, a111
v_mul_f32 v14, v14, v12
v_accvgpr_write_b32 a111, v14
v_exp_f32 v32, v32
v_exp_f32 v33, v33
v_exp_f32 v34, v34
v_exp_f32 v35, v35
v_exp_f32 v48, v48
v_exp_f32 v49, v49
v_exp_f32 v50, v50
v_exp_f32 v51, v51
v_cvt_pk_bf16_f32 v32, v32, v33
v_cvt_pk_bf16_f32 v33, v34, v35
v_exp_f32 v36, v36
v_exp_f32 v37, v37
v_exp_f32 v38, v38
v_exp_f32 v39, v39
v_cvt_pk_bf16_f32 v34, v48, v49
v_cvt_pk_bf16_f32 v35, v50, v51
v_exp_f32 v52, v52
v_exp_f32 v53, v53
v_exp_f32 v54, v54
v_exp_f32 v55, v55
v_cvt_pk_bf16_f32 v36, v36, v37
v_cvt_pk_bf16_f32 v37, v38, v39
v_exp_f32 v40, v40
v_exp_f32 v41, v41
v_exp_f32 v42, v42
v_exp_f32 v43, v43
v_cvt_pk_bf16_f32 v38, v52, v53
v_cvt_pk_bf16_f32 v39, v54, v55
v_exp_f32 v56, v56
v_exp_f32 v57, v57
v_exp_f32 v58, v58
v_exp_f32 v59, v59
v_cvt_pk_bf16_f32 v40, v40, v41
v_cvt_pk_bf16_f32 v41, v42, v43
v_exp_f32 v44, v44
v_exp_f32 v45, v45
v_exp_f32 v46, v46
v_exp_f32 v47, v47
v_cvt_pk_bf16_f32 v42, v56, v57
v_cvt_pk_bf16_f32 v43, v58, v59
v_exp_f32 v60, v60
v_exp_f32 v61, v61
v_exp_f32 v62, v62
v_exp_f32 v63, v63
v_cvt_pk_bf16_f32 v44, v44, v45
v_cvt_pk_bf16_f32 v45, v46, v47
v_cvt_pk_bf16_f32 v46, v60, v61
v_cvt_pk_bf16_f32 v47, v62, v63
v_exp_f32 v64, v64
v_exp_f32 v65, v65
v_exp_f32 v66, v66
v_exp_f32 v67, v67
v_exp_f32 v80, v80
v_exp_f32 v81, v81
v_exp_f32 v82, v82
v_exp_f32 v83, v83
v_cvt_pk_bf16_f32 v64, v64, v65
v_cvt_pk_bf16_f32 v65, v66, v67
v_exp_f32 v68, v68
v_exp_f32 v69, v69
v_exp_f32 v70, v70
v_exp_f32 v71, v71
v_cvt_pk_bf16_f32 v66, v80, v81
v_cvt_pk_bf16_f32 v67, v82, v83
v_exp_f32 v84, v84
v_exp_f32 v85, v85
v_exp_f32 v86, v86
v_exp_f32 v87, v87
v_cvt_pk_bf16_f32 v68, v68, v69
v_cvt_pk_bf16_f32 v69, v70, v71
v_exp_f32 v72, v72
v_exp_f32 v73, v73
v_exp_f32 v74, v74
v_exp_f32 v75, v75
v_cvt_pk_bf16_f32 v70, v84, v85
v_cvt_pk_bf16_f32 v71, v86, v87
v_exp_f32 v88, v88
v_exp_f32 v89, v89
v_exp_f32 v90, v90
v_exp_f32 v91, v91
v_cvt_pk_bf16_f32 v72, v72, v73
v_cvt_pk_bf16_f32 v73, v74, v75
v_exp_f32 v76, v76
v_exp_f32 v77, v77
v_exp_f32 v78, v78
v_exp_f32 v79, v79
v_cvt_pk_bf16_f32 v74, v88, v89
v_cvt_pk_bf16_f32 v75, v90, v91
v_exp_f32 v92, v92
v_exp_f32 v93, v93
v_exp_f32 v94, v94
v_exp_f32 v95, v95
v_cvt_pk_bf16_f32 v76, v76, v77
v_cvt_pk_bf16_f32 v77, v78, v79
v_cvt_pk_bf16_f32 v78, v92, v93
v_cvt_pk_bf16_f32 v79, v94, v95
s_waitcnt vmcnt(0)
M a[96:99], a[112:115], v[32:35], a[96:99]
M a[100:103], a[112:115], v[36:39], a[100:103]
M a[104:107], a[112:115], v[40:43], a[104:107]
M a[108:111], a[112:115], v[44:47], a[108:111]
M v[160:163], v[96:99], v[32:35], v[160:163]
M v[164:167], v[96:99], v[36:39], v[164:167]
M v[168:171], v[96:99], v[40:43], v[168:171]
M v[172:175], v[96:99], v[44:47], v[172:175]
M v[176:179], v[100:103], v[32:35], v[176:179]
M v[180:183], v[100:103], v[36:39], v[180:183]
M v[184:187], v[100:103], v[40:43], v[184:187]
M v[188:191], v[100:103], v[44:47], v[188:191]
M v[192:195], v[104:107], v[32:35], v[192:195]
M v[196:199], v[104:107], v[36:39], v[196:199]
M v[200:203], v[104:107], v[40:43], v[200:203]
M v[204:207], v[104:107], v[44:47], v[204:207]
M v[208:211], v[108:111], v[32:35], v[208:211]
M v[212:215], v[108:111], v[36:39], v[212:215]
M v[216:219], v[108:111], v[40:43], v[216:219]
M v[220:223], v[108:111], v[44:47], v[220:223]
M v[224:227], v[112:115], v[32:35], v[224:227]
M v[228:231], v[112:115], v[36:39], v[228:231]
M v[232:235], v[112:115], v[40:43], v[232:235]
M v[236:239], v[112:115], v[44:47], v[236:239]
M v[240:243], v[116:119], v[32:35], v[240:243]
M v[244:247], v[116:119], v[36:39], v[244:247]
M v[248:251], v[116:119], v[40:43], v[248:251]
M v[252:255], v[116:119], v[44:47], v[252:255]
M a[64:67], v[120:123], v[32:35], a[64:67]
M a[68:71], v[120:123], v[36:39], a[68:71]
M a[72:75], v[120:123], v[40:43], a[72:75]
M a[76:79], v[120:123], v[44:47], a[76:79]
M a[80:83], v[124:127], v[32:35], a[80:83]
M a[84:87], v[124:127], v[36:39], a[84:87]
M a[88:91], v[124:127], v[40:43], a[88:91]
M a[92:95], v[124:127], v[44:47], a[92:95]
M a[96:99], a[112:115], v[64:67], a[96:99]
M a[100:103], a[112:115], v[68:71], a[100:103]
M a[104:107], a[112:115], v[72:75], a[104:107]
M a[108:111], a[112:115], v[76:79], a[108:111]
M v[160:163], v[128:131], v[64:67], v[160:163]
M v[164:167], v[128:131], v[68:71], v[164:167]
M v[168:171], v[128:131], v[72:75], v[168:171]
M v[172:175], v[128:131], v[76:79], v[172:175]
M v[176:179], v[132:135], v[64:67], v[176:179]
M v[180:183], v[132:135], v[68:71], v[180:183]
M v[184:187], v[132:135], v[72:75], v[184:187]
M v[188:191], v[132:135], v[76:79], v[188:191]
M v[192:195], v[136:139], v[64:67], v[192:195]
M v[196:199], v[136:139], v[68:71], v[196:199]
M v[200:203], v[136:139], v[72:75], v[200:203]
M v[204:207], v[136:139], v[76:79], v[204:207]
M v[208:211], v[140:143], v[64:67], v[208:211]
M v[212:215], v[140:143], v[68:71], v[212:215]
M v[216:219], v[140:143], v[72:75], v[216:219]
M v[220:223], v[140:143], v[76:79], v[220:223]
M v[224:227], v[144:147], v[64:67], v[224:227]
M v[228:231], v[144:147], v[68:71], v[228:231]
M v[232:235], v[144:147], v[72:75], v[232:235]
M v[236:239], v[144:147], v[76:79], v[236:239]
M v[240:243], v[148:151], v[64:67], v[240:243]
M v[244:247], v[148:151], v[68:71], v[244:247]
M v[248:251], v[148:151], v[72:75], v[248:251]
M v[252:255], v[148:151], v[76:79], v[252:255]
M a[64:67], v[152:155], v[64:67], a[64:67]
M a[68:71], v[152:155], v[68:71], a[68:71]
M a[72:75], v[152:155], v[72:75], a[72:75]
M a[76:79], v[152:155], v[76:79], a[76:79]
M a[80:83], v[156:159], v[64:67], a[80:83]
M a[84:87], v[156:159], v[68:71], a[84:87]
M a[88:91], v[156:159], v[72:75], a[88:91]
M a[92:95], v[156:159], v[76:79], a[92:95]
s_nop 7
s_add_u32 s57, s57, 32768
s_sub_u32 s58, s58, 64
s_sub_u32 s59, s59, 1
s_cmp_lg_u32 s59, 0
s_cbranch_scc1 Lslow_8
v_accvgpr_read_b32 v20, a96
v_accvgpr_read_b32 v21, a100
v_accvgpr_read_b32 v22, a104
v_accvgpr_read_b32 v23, a108
v_rcp_f32 v8, v20
v_rcp_f32 v9, v21
v_rcp_f32 v10, v22
v_rcp_f32 v11, v23
v_pk_mul_f32 v[160:161], v[160:161], v[8:9] op_sel:[0,0] op_sel_hi:[1,0]
v_pk_mul_f32 v[162:163], v[162:163], v[8:9] op_sel:[0,0] op_sel_hi:[1,0]
v_pk_mul_f32 v[176:177], v[176:177], v[8:9] op_sel:[0,0] op_sel_hi:[1,0]
v_pk_mul_f32 v[178:179], v[178:179], v[8:9] op_sel:[0,0] op_sel_hi:[1,0]
v_cvt_pk_bf16_f32 v160, v160, v161
v_cvt_pk_bf16_f32 v161, v162, v163
v_cvt_pk_bf16_f32 v162, v176, v177
v_cvt_pk_bf16_f32 v163, v178, v179
v_pk_mul_f32 v[164:165], v[164:165], v[8:9] op_sel:[0,1] op_sel_hi:[1,1]
v_pk_mul_f32 v[166:167], v[166:167], v[8:9] op_sel:[0,1] op_sel_hi:[1,1]
v_pk_mul_f32 v[180:181], v[180:181], v[8:9] op_sel:[0,1] op_sel_hi:[1,1]
v_pk_mul_f32 v[182:183], v[182:183], v[8:9] op_sel:[0,1] op_sel_hi:[1,1]
v_cvt_pk_bf16_f32 v164, v164, v165
v_cvt_pk_bf16_f32 v165, v166, v167
v_cvt_pk_bf16_f32 v166, v180, v181
v_cvt_pk_bf16_f32 v167, v182, v183
v_pk_mul_f32 v[168:169], v[168:169], v[10:11] op_sel:[0,0] op_sel_hi:[1,0]
v_pk_mul_f32 v[170:171], v[170:171], v[10:11] op_sel:[0,0] op_sel_hi:[1,0]
v_pk_mul_f32 v[184:185], v[184:185], v[10:11] op_sel:[0,0] op_sel_hi:[1,0]
v_pk_mul_f32 v[186:187], v[186:187], v[10:11] op_sel:[0,0] op_sel_hi:[1,0]
v_cvt_pk_bf16_f32 v168, v168, v169
v_cvt_pk_bf16_f32 v169, v170, v171
v_cvt_pk_bf16_f32 v170, v184, v185
v_cvt_pk_bf16_f32 v171, v186, v187
v_pk_mul_f32 v[172:173], v[172:173], v[10:11] op_sel:[0,1] op_sel_hi:[1,1]
v_pk_mul_f32 v[174:175], v[174:175], v[10:11] op_sel:[0,1] op_sel_hi:[1,1]
v_pk_mul_f32 v[188:189], v[188:189], v[10:11] op_sel:[0,1] op_sel_hi:[1,1]
v_pk_mul_f32 v[190:191], v[190:191], v[10:11] op_sel:[0,1] op_sel_hi:[1,1]
v_cvt_pk_bf16_f32 v172, v172, v173
v_cvt_pk_bf16_f32 v173, v174, v175
v_cvt_pk_bf16_f32 v174, v188, v189
v_cvt_pk_bf16_f32 v175, v190, v191
v_pk_mul_f32 v[192:193], v[192:193], v[8:9] op_sel:[0,0] op_sel_hi:[1,0]
v_pk_mul_f32 v[194:195], v[194:195], v[8:9] op_sel:[0,0] op_sel_hi:[1,0]
v_pk_mul_f32 v[208:209], v[208:209], v[8:9] op_sel:[0,0] op_sel_hi:[1,0]
v_pk_mul_f32 v[210:211], v[210:211], v[8:9] op_sel:[0,0] op_sel_hi:[1,0]
v_cvt_pk_bf16_f32 v192, v192, v193
v_cvt_pk_bf16_f32 v193, v194, v195
v_cvt_pk_bf16_f32 v194, v208, v209
v_cvt_pk_bf16_f32 v195, v210, v211
v_pk_mul_f32 v[196:197], v[196:197], v[8:9] op_sel:[0,1] op_sel_hi:[1,1]
v_pk_mul_f32 v[198:199], v[198:199], v[8:9] op_sel:[0,1] op_sel_hi:[1,1]
v_pk_mul_f32 v[212:213], v[212:213], v[8:9] op_sel:[0,1] op_sel_hi:[1,1]
v_pk_mul_f32 v[214:215], v[214:215], v[8:9] op_sel:[0,1] op_sel_hi:[1,1]
v_cvt_pk_bf16_f32 v196, v196, v197
v_cvt_pk_bf16_f32 v197, v198, v199
v_cvt_pk_bf16_f32 v198, v212, v213
v_cvt_pk_bf16_f32 v199, v214, v215
v_pk_mul_f32 v[200:201], v[200:201], v[10:11] op_sel:[0,0] op_sel_hi:[1,0]
v_pk_mul_f32 v[202:203], v[202:203], v[10:11] op_sel:[0,0] op_sel_hi:[1,0]
v_pk_mul_f32 v[216:217], v[216:217], v[10:11] op_sel:[0,0] op_sel_hi:[1,0]
v_pk_mul_f32 v[218:219], v[218:219], v[10:11] op_sel:[0,0] op_sel_hi:[1,0]
v_cvt_pk_bf16_f32 v200, v200, v201
v_cvt_pk_bf16_f32 v201, v202, v203
v_cvt_pk_bf16_f32 v202, v216, v217
v_cvt_pk_bf16_f32 v203, v218, v219
v_pk_mul_f32 v[204:205], v[204:205], v[10:11] op_sel:[0,1] op_sel_hi:[1,1]
v_pk_mul_f32 v[206:207], v[206:207], v[10:11] op_sel:[0,1] op_sel_hi:[1,1]
v_pk_mul_f32 v[220:221], v[220:221], v[10:11] op_sel:[0,1] op_sel_hi:[1,1]
v_pk_mul_f32 v[222:223], v[222:223], v[10:11] op_sel:[0,1] op_sel_hi:[1,1]
v_cvt_pk_bf16_f32 v204, v204, v205
v_cvt_pk_bf16_f32 v205, v206, v207
v_cvt_pk_bf16_f32 v206, v220, v221
v_cvt_pk_bf16_f32 v207, v222, v223
v_pk_mul_f32 v[224:225], v[224:225], v[8:9] op_sel:[0,0] op_sel_hi:[1,0]
v_pk_mul_f32 v[226:227], v[226:227], v[8:9] op_sel:[0,0] op_sel_hi:[1,0]
v_pk_mul_f32 v[240:241], v[240:241], v[8:9] op_sel:[0,0] op_sel_hi:[1,0]
v_pk_mul_f32 v[242:243], v[242:243], v[8:9] op_sel:[0,0] op_sel_hi:[1,0]
v_cvt_pk_bf16_f32 v224, v224, v225
v_cvt_pk_bf16_f32 v225, v226, v227
v_cvt_pk_bf16_f32 v226, v240, v241
v_cvt_pk_bf16_f32 v227, v242, v243
v_pk_mul_f32 v[228:229], v[228:229], v[8:9] op_sel:[0,1] op_sel_hi:[1,1]
v_pk_mul_f32 v[230:231], v[230:231], v[8:9] op_sel:[0,1] op_sel_hi:[1,1]
v_pk_mul_f32 v[244:245], v[244:245], v[8:9] op_sel:[0,1] op_sel_hi:[1,1]
v_pk_mul_f32 v[246:247], v[246:247], v[8:9] op_sel:[0,1] op_sel_hi:[1,1]
v_cvt_pk_bf16_f32 v228, v228, v229
v_cvt_pk_bf16_f32 v229, v230, v231
v_cvt_pk_bf16_f32 v230, v244, v245
v_cvt_pk_bf16_f32 v231, v246, v247
v_pk_mul_f32 v[232:233], v[232:233], v[10:11] op_sel:[0,0] op_sel_hi:[1,0]
v_pk_mul_f32 v[234:235], v[234:235], v[10:11] op_sel:[0,0] op_sel_hi:[1,0]
v_pk_mul_f32 v[248:249], v[248:249], v[10:11] op_sel:[0,0] op_sel_hi:[1,0]
v_pk_mul_f32 v[250:251], v[250:251], v[10:11] op_sel:[0,0] op_sel_hi:[1,0]
v_cvt_pk_bf16_f32 v232, v232, v233
v_cvt_pk_bf16_f32 v233, v234, v235
v_cvt_pk_bf16_f32 v234, v248, v249
v_cvt_pk_bf16_f32 v235, v250, v251
v_pk_mul_f32 v[236:237], v[236:237], v[10:11] op_sel:[0,1] op_sel_hi:[1,1]
v_pk_mul_f32 v[238:239], v[238:239], v[10:11] op_sel:[0,1] op_sel_hi:[1,1]
v_pk_mul_f32 v[252:253], v[252:253], v[10:11] op_sel:[0,1] op_sel_hi:[1,1]
v_pk_mul_f32 v[254:255], v[254:255], v[10:11] op_sel:[0,1] op_sel_hi:[1,1]
v_cvt_pk_bf16_f32 v236, v236, v237
v_cvt_pk_bf16_f32 v237, v238, v239
v_cvt_pk_bf16_f32 v238, v252, v253
v_cvt_pk_bf16_f32 v239, v254, v255
v_accvgpr_read_b32 v176, a64
v_accvgpr_read_b32 v177, a65
v_accvgpr_read_b32 v178, a66
v_accvgpr_read_b32 v179, a67
v_accvgpr_read_b32 v180, a80
v_accvgpr_read_b32 v181, a81
v_accvgpr_read_b32 v182, a82
v_accvgpr_read_b32 v183, a83
v_pk_mul_f32 v[176:177], v[176:177], v[8:9] op_sel:[0,0] op_sel_hi:[1,0]
v_pk_mul_f32 v[178:179], v[178:179], v[8:9] op_sel:[0,0] op_sel_hi:[1,0]
v_pk_mul_f32 v[180:181], v[180:181], v[8:9] op_sel:[0,0] op_sel_hi:[1,0]
v_pk_mul_f32 v[182:183], v[182:183], v[8:9] op_sel:[0,0] op_sel_hi:[1,0]
v_cvt_pk_bf16_f32 v176, v176, v177
v_cvt_pk_bf16_f32 v177, v178, v179
v_cvt_pk_bf16_f32 v178, v180, v181
v_cvt_pk_bf16_f32 v179, v182, v183
v_accvgpr_read_b32 v184, a68
v_accvgpr_read_b32 v185, a69
v_accvgpr_read_b32 v186, a70
v_accvgpr_read_b32 v187, a71
v_accvgpr_read_b32 v188, a84
v_accvgpr_read_b32 v189, a85
v_accvgpr_read_b32 v190, a86
v_accvgpr_read_b32 v191, a87
v_pk_mul_f32 v[184:185], v[184:185], v[8:9] op_sel:[0,1] op_sel_hi:[1,1]
v_pk_mul_f32 v[186:187], v[186:187], v[8:9] op_sel:[0,1] op_sel_hi:[1,1]
v_pk_mul_f32 v[188:189], v[188:189], v[8:9] op_sel:[0,1] op_sel_hi:[1,1]
v_pk_mul_f32 v[190:191], v[190:191], v[8:9] op_sel:[0,1] op_sel_hi:[1,1]
v_cvt_pk_bf16_f32 v184, v184, v185
v_cvt_pk_bf16_f32 v185, v186, v187
v_cvt_pk_bf16_f32 v186, v188, v189
v_cvt_pk_bf16_f32 v187, v190, v191
v_accvgpr_read_b32 v208, a72
v_accvgpr_read_b32 v209, a73
v_accvgpr_read_b32 v210, a74
v_accvgpr_read_b32 v211, a75
v_accvgpr_read_b32 v212, a88
v_accvgpr_read_b32 v213, a89
v_accvgpr_read_b32 v214, a90
v_accvgpr_read_b32 v215, a91
v_pk_mul_f32 v[208:209], v[208:209], v[10:11] op_sel:[0,0] op_sel_hi:[1,0]
v_pk_mul_f32 v[210:211], v[210:211], v[10:11] op_sel:[0,0] op_sel_hi:[1,0]
v_pk_mul_f32 v[212:213], v[212:213], v[10:11] op_sel:[0,0] op_sel_hi:[1,0]
v_pk_mul_f32 v[214:215], v[214:215], v[10:11] op_sel:[0,0] op_sel_hi:[1,0]
v_cvt_pk_bf16_f32 v208, v208, v209
v_cvt_pk_bf16_f32 v209, v210, v211
v_cvt_pk_bf16_f32 v210, v212, v213
v_cvt_pk_bf16_f32 v211, v214, v215
v_accvgpr_read_b32 v216, a76
v_accvgpr_read_b32 v217, a77
v_accvgpr_read_b32 v218, a78
v_accvgpr_read_b32 v219, a79
v_accvgpr_read_b32 v220, a92
v_accvgpr_read_b32 v221, a93
v_accvgpr_read_b32 v222, a94
v_accvgpr_read_b32 v223, a95
v_pk_mul_f32 v[216:217], v[216:217], v[10:11] op_sel:[0,1] op_sel_hi:[1,1]
v_pk_mul_f32 v[218:219], v[218:219], v[10:11] op_sel:[0,1] op_sel_hi:[1,1]
v_pk_mul_f32 v[220:221], v[220:221], v[10:11] op_sel:[0,1] op_sel_hi:[1,1]
v_pk_mul_f32 v[222:223], v[222:223], v[10:11] op_sel:[0,1] op_sel_hi:[1,1]
v_cvt_pk_bf16_f32 v216, v216, v217
v_cvt_pk_bf16_f32 v217, v218, v219
v_cvt_pk_bf16_f32 v218, v220, v221
v_cvt_pk_bf16_f32 v219, v222, v223
s_lshl_b32 s33, s56, 20
s_lshl_b32 s34, s20, 15
s_add_u32 s33, s33, s34
s_lshl_b32 s34, s23, 13
s_add_u32 s36, s33, s34
s_add_u32 s37, s36, 4096
s_add_u32 s38, s36, 16384
s_add_u32 s39, s36, 20480
s_bitcmp1_b32 s61, 0
s_cbranch_scc0 Lss_11
buffer_store_dwordx4 v[160:163], v1, s[16:19], s36 offen offset:0 sc1
buffer_store_dwordx4 v[164:167], v1, s[16:19], s36 offen offset:2048 sc1
buffer_store_dwordx4 v[168:171], v1, s[16:19], s37 offen offset:0 sc1
buffer_store_dwordx4 v[172:175], v1, s[16:19], s37 offen offset:2048 sc1
Lss_11:
s_bitcmp1_b32 s61, 1
s_cbranch_scc0 Lss_12
buffer_store_dwordx4 v[192:195], v1, s[16:19], s36 offen offset:1024 sc1
buffer_store_dwordx4 v[196:199], v1, s[16:19], s36 offen offset:3072 sc1
buffer_store_dwordx4 v[200:203], v1, s[16:19], s37 offen offset:1024 sc1
buffer_store_dwordx4 v[204:207], v1, s[16:19], s37 offen offset:3072 sc1
Lss_12:
s_bitcmp1_b32 s61, 2
s_cbranch_scc0 Lss_13
buffer_store_dwordx4 v[224:227], v1, s[16:19], s38 offen offset:0 sc1
buffer_store_dwordx4 v[228:231], v1, s[16:19], s38 offen offset:2048 sc1
buffer_store_dwordx4 v[232:235], v1, s[16:19], s39 offen offset:0 sc1
buffer_store_dwordx4 v[236:239], v1, s[16:19], s39 offen offset:2048 sc1
Lss_13:
s_bitcmp1_b32 s61, 3
s_cbranch_scc0 Lss_14
buffer_store_dwordx4 v[176:179], v1, s[16:19], s38 offen offset:1024 sc1
buffer_store_dwordx4 v[184:187], v1, s[16:19], s38 offen offset:3072 sc1
buffer_store_dwordx4 v[208:211], v1, s[16:19], s39 offen offset:1024 sc1
buffer_store_dwordx4 v[216:219], v1, s[16:19], s39 offen offset:3072 sc1
Lss_14:
s_branch Lk2_chk
Lk2_done:
s_lshl_b32 s33, s20, 4
s_add_u32 s33, s33, 8392704
s_sub_u32 s34, 15, s21
s_lshl_b32 s34, s34, 9
s_add_u32 s92, s33, s34
s_lshl_b32 s34, s22, 2
s_add_u32 s92, s92, s34
s_lshl_b32 s34, s21, 9
s_add_u32 s93, s33, s34
s_lshl_b32 s34, s23, 3
s_add_u32 s93, s93, s34
s_cmp_eq_u32 s24, 0
s_cselect_b32 s93, s93, s92
s_cselect_b32 s94, 4, 0
s_add_u32 s94, s94, s93
s_load_dwordx2 s[10:11], s[0:1], 40
s_load_dwordx2 s[14:15], s[0:1], 72
s_lshl_b32 s21, s27, 7
s_lshl_b32 s22, s28, 6
s_lshl_b32 s3, s101, 4
v_lshrrev_b32 v224, 3, v0
v_and_b32 v225, 6, v224
v_and_b32 v226, 7, v0
v_xor_b32 v225, v225, v226
v_add_u32 v224, s3, v224
v_lshlrev_b32 v224, 11, v224
v_lshl_add_u32 v6, v225, 4, v224
v_add_u32 v7, 15360, v6
v_lshrrev_b32 v224, 2, v0
v_and_b32 v226, 1, v0
v_bfe_u32 v229, v0, 1, 1
v_lshlrev_b32 v225, 7, v224
v_lshl_add_u32 v225, v226, 3, v225
v_and_b32 v228, 6, v224
v_add_u32 v227, 0, v229
v_xor_b32 v227, v227, v228
v_lshl_add_u32 v24, v227, 4, v225
v_add_u32 v28, 0x10000, v24
v_add_u32 v227, 2, v229
v_xor_b32 v227, v227, v228
v_lshl_add_u32 v25, v227, 4, v225
v_add_u32 v29, 0x10000, v25
v_add_u32 v227, 4, v229
v_xor_b32 v227, v227, v228
v_lshl_add_u32 v26, v227, 4, v225
v_add_u32 v30, 0x10000, v26
v_add_u32 v227, 6, v229
v_xor_b32 v227, v227, v228
v_lshl_add_u32 v27, v227, 4, v225
v_add_u32 v31, 0x10000, v27
s_waitcnt vmcnt(32)
s_barrier
ds_read_b64_tr_b16 v[96:97], v28 offset:0
ds_read_b64_tr_b16 v[98:99], v28 offset:2048
ds_read_b64_tr_b16 v[100:101], v28 offset:4096
ds_read_b64_tr_b16 v[102:103], v28 offset:6144
ds_read_b64_tr_b16 v[104:105], v29 offset:0
ds_read_b64_tr_b16 v[106:107], v29 offset:2048
ds_read_b64_tr_b16 v[108:109], v29 offset:4096
ds_read_b64_tr_b16 v[110:111], v29 offset:6144
ds_read_b64_tr_b16 v[112:113], v30 offset:0
ds_read_b64_tr_b16 v[114:115], v30 offset:2048
ds_read_b64_tr_b16 v[116:117], v30 offset:4096
ds_read_b64_tr_b16 v[118:119], v30 offset:6144
ds_read_b64_tr_b16 v[120:121], v31 offset:0
ds_read_b64_tr_b16 v[122:123], v31 offset:2048
ds_read_b64_tr_b16 v[124:125], v31 offset:4096
ds_read_b64_tr_b16 v[126:127], v31 offset:6144
s_and_b32 s40, s2, 1
s_bfe_u32 s3, s2, 0x10001
s_lshl_b32 s3, s3, 3
s_bfe_u32 s36, s2, 0x30003
s_add_u32 s36, s3, s36
s_lshl_b32 s29, s36, 7
s_bfe_u32 s3, s2, 0x10002
s_lshl_b32 s3, s3, 2
s_lshr_b32 s37, s2, 6
s_add_u32 s3, s3, s37
s_lshl_b32 s13, s3, 8
s_lshl_b32 s30, s3, 7
s_lshl_b32 s3, s40, 6
s_add_u32 s30, s30, s3
s_lshl_b32 s41, s101, 12
s_lshl_b32 s12, s36, 20
s_add_u32 s12, s12, s41
s_lshl_b32 s62, s36, 9
s_lshl_b32 s3, s40, 8
s_add_u32 s62, s62, s3
s_add_u32 s62, s62, 8392704
s_lshr_b32 s3, s2, 1
s_lshr_b32 s38, s2, 2
s_xor_b32 s3, s3, s38
s_and_b32 s3, s3, 1
s_lshl_b32 s3, s3, 4
s_sub_u32 s39, 32, s3
s_lshl_b32 s38, s40, 5
s_add_u32 s3, s3, s38
s_lshl_b32 s3, s3, 14
s_add_u32 s12, s12, s3
s_lshl_b32 s3, s3, 3
s_add_u32 s13, s13, s3
s_mov_b32 s64, 4294459392
s_mov_b32 s65, 16384
s_add_u32 s8, s4, 67108864
s_addc_u32 s9, s5, 0
s_lshl_b32 s56, s2, 15
s_lshl_b32 s38, s101, 13
s_add_u32 s56, s56, s38
s_xor_b32 s57, s56, 32768
s_lshl_b32 s58, s2, 2
s_add_u32 s58, s58, 8388608
s_xor_b32 s59, s58, 4
s_mov_b32 s61, 0
s_lshl_b32 s3, s101, 4
v_lshrrev_b32 v232, 4, v0
v_and_b32 v234, 15, v0
v_add_u32 v233, 0, v232
v_lshlrev_b32 v233, 1, v233
v_xor_b32 v233, v233, v234
v_add_u32 v235, s3, v232
v_lshlrev_b32 v235, 11, v235
v_lshl_add_u32 v235, v233, 4, v235
v_add_u32 v2, 0, v235
v_add_u32 v233, 4, v232
v_lshlrev_b32 v233, 1, v233
v_xor_b32 v233, v233, v234
v_add_u32 v235, s3, v232
v_lshlrev_b32 v235, 11, v235
v_lshl_add_u32 v235, v233, 4, v235
v_add_u32 v3, 7168, v235
v_add_u32 v233, 0, v232
v_lshlrev_b32 v233, 1, v233
v_xor_b32 v233, v233, v234
v_add_u32 v235, s3, v232
v_lshlrev_b32 v235, 11, v235
v_lshl_add_u32 v235, v233, 4, v235
v_add_u32 v4, 14336, v235
v_add_u32 v233, 4, v232
v_lshlrev_b32 v233, 1, v233
v_xor_b32 v233, v233, v234
v_add_u32 v235, s3, v232
v_lshlrev_b32 v235, 11, v235
v_lshl_add_u32 v235, v233, 4, v235
v_add_u32 v5, 21504, v235
v_lshlrev_b32 v225, 8, v224
v_lshl_add_u32 v225, v226, 3, v225
v_and_b32 v228, 7, v224
v_lshlrev_b32 v228, 1, v228
s_lshl_b32 s38, s40, 3
v_xor_b32 v228, s38, v228
v_add_u32 v227, 0, v229
v_xor_b32 v227, v227, v228
v_lshl_add_u32 v8, v227, 4, v225
v_add_u32 v16, 0x10000, v8
v_add_u32 v227, 2, v229
v_xor_b32 v227, v227, v228
v_lshl_add_u32 v9, v227, 4, v225
v_add_u32 v17, 0x10000, v9
v_add_u32 v227, 4, v229
v_xor_b32 v227, v227, v228
v_lshl_add_u32 v10, v227, 4, v225
v_add_u32 v18, 0x10000, v10
v_add_u32 v227, 6, v229
v_xor_b32 v227, v227, v228
v_lshl_add_u32 v11, v227, 4, v225
v_add_u32 v19, 0x10000, v11
v_add_u32 v227, 8, v229
v_xor_b32 v227, v227, v228
v_lshl_add_u32 v12, v227, 4, v225
v_add_u32 v20, 0x10000, v12
v_add_u32 v227, 10, v229
v_xor_b32 v227, v227, v228
v_lshl_add_u32 v13, v227, 4, v225
v_add_u32 v21, 0x10000, v13
v_add_u32 v227, 12, v229
v_xor_b32 v227, v227, v228
v_lshl_add_u32 v14, v227, 4, v225
v_add_u32 v22, 0x10000, v14
v_add_u32 v227, 14, v229
v_xor_b32 v227, v227, v228
v_lshl_add_u32 v15, v227, 4, v225
v_add_u32 v23, 0x10000, v15
v_mov_b32 v253, 0
v_mov_b32 v254, 1
v_lshlrev_b32 v255, 2, v0
s_waitcnt lgkmcnt(0)
s_mov_b32 s16, s14
s_mov_b32 s17, s15
s_mov_b32 s18, 8388608
s_mov_b32 s19, 0x00020000
s_waitcnt vmcnt(26) lgkmcnt(0)
s_barrier
M a[0:3], v[96:99], a[192:195], 0
s_add_u32 m0, s42, 16384
s_nop 0
buffer_load_dwordx4 v6, s[48:51], s26 offen offset:0 lds
ds_read_b64_tr_b16 v[160:161], v28 offset:16384
ds_read_b64_tr_b16 v[162:163], v28 offset:18432
M a[0:3], v[100:103], a[196:199], a[0:3]
buffer_load_dwordx4 v7, s[48:51], s26 offen offset:1024 lds
M a[4:7], v[108:111], a[196:199], 0
ds_read_b64_tr_b16 v[164:165], v28 offset:20480
ds_read_b64_tr_b16 v[166:167], v28 offset:22528
M a[4:7], v[104:107], a[192:195], a[4:7]
buffer_load_dwordx4 a[144:147], v1, s[44:47], s25 offen offset:0 sc1
M a[8:11], v[112:115], a[192:195], 0
ds_read_b64_tr_b16 v[168:169], v29 offset:16384
ds_read_b64_tr_b16 v[170:171], v29 offset:18432
M a[8:11], v[116:119], a[196:199], a[8:11]
buffer_load_dwordx4 a[148:151], v1, s[44:47], s25 offen offset:1024 sc1
M a[12:15], v[124:127], a[196:199], 0
ds_read_b64_tr_b16 v[172:173], v29 offset:20480
ds_read_b64_tr_b16 v[174:175], v29 offset:22528
M a[12:15], v[120:123], a[192:195], a[12:15]
buffer_load_dwordx4 a[152:155], v1, s[44:47], s25 offen offset:2048 sc1
M a[16:19], v[96:99], a[200:203], 0
ds_read_b64_tr_b16 v[176:177], v30 offset:16384
ds_read_b64_tr_b16 v[178:179], v30 offset:18432
M a[16:19], v[100:103], a[204:207], a[16:19]
buffer_load_dwordx4 a[156:159], v1, s[44:47], s25 offen offset:3072 sc1
M a[20:23], v[108:111], a[204:207], 0
ds_read_b64_tr_b16 v[180:181], v30 offset:20480
ds_read_b64_tr_b16 v[182:183], v30 offset:22528
M a[20:23], v[104:107], a[200:203], a[20:23]
s_add_u32 s25, s25, 16384
s_add_u32 s26, s26, 131072
M a[24:27], v[112:115], a[200:203], 0
ds_read_b64_tr_b16 v[184:185], v31 offset:16384
ds_read_b64_tr_b16 v[186:187], v31 offset:18432
M a[24:27], v[116:119], a[204:207], a[24:27]
ds_read_b64_tr_b16 v[188:189], v31 offset:20480
ds_read_b64_tr_b16 v[190:191], v31 offset:22528
M a[28:31], v[124:127], a[204:207], 0
M a[28:31], v[120:123], a[200:203], a[28:31]
s_waitcnt vmcnt(6) lgkmcnt(0)
s_barrier
s_mov_b64 exec, 1
buffer_store_dword v254, v253, s[52:55], s92 offen sc1
buffer_store_dword v254, v253, s[52:55], s93 offen sc1
buffer_store_dword v254, v253, s[52:55], s94 offen sc1
s_mov_b64 exec, -1
M a[0:3], v[160:163], a[208:211], a[0:3]
s_add_u32 m0, s42, 32768
s_nop 0
buffer_load_dwordx4 v6, s[48:51], s26 offen offset:0 lds
ds_read_b64_tr_b16 v[96:97], v28 offset:32768
ds_read_b64_tr_b16 v[98:99], v28 offset:34816
M a[0:3], v[164:167], a[212:215], a[0:3]
buffer_load_dwordx4 v7, s[48:51], s26 offen offset:1024 lds
M a[4:7], v[172:175], a[212:215], a[4:7]
ds_read_b64_tr_b16 v[100:101], v28 offset:36864
ds_read_b64_tr_b16 v[102:103], v28 offset:38912
M a[4:7], v[168:171], a[208:211], a[4:7]
buffer_load_dwordx4 a[160:163], v1, s[44:47], s25 offen offset:0 sc1
M a[8:11], v[176:179], a[208:211], a[8:11]
ds_read_b64_tr_b16 v[104:105], v29 offset:32768
ds_read_b64_tr_b16 v[106:107], v29 offset:34816
M a[8:11], v[180:183], a[212:215], a[8:11]
buffer_load_dwordx4 a[164:167], v1, s[44:47], s25 offen offset:1024 sc1
M a[12:15], v[188:191], a[212:215], a[12:15]
ds_read_b64_tr_b16 v[108:109], v29 offset:36864
ds_read_b64_tr_b16 v[110:111], v29 offset:38912
M a[12:15], v[184:187], a[208:211], a[12:15]
buffer_load_dwordx4 a[168:171], v1, s[44:47], s25 offen offset:2048 sc1
M a[16:19], v[160:163], a[216:219], a[16:19]
ds_read_b64_tr_b16 v[112:113], v30 offset:32768
ds_read_b64_tr_b16 v[114:115], v30 offset:34816
M a[16:19], v[164:167], a[220:223], a[16:19]
buffer_load_dwordx4 a[172:175], v1, s[44:47], s25 offen offset:3072 sc1
M a[20:23], v[172:175], a[220:223], a[20:23]
ds_read_b64_tr_b16 v[116:117], v30 offset:36864
ds_read_b64_tr_b16 v[118:119], v30 offset:38912
M a[20:23], v[168:171], a[216:219], a[20:23]
s_add_u32 s25, s25, 16384
s_add_u32 s26, s26, 131072
M a[24:27], v[176:179], a[216:219], a[24:27]
ds_read_b64_tr_b16 v[120:121], v31 offset:32768
ds_read_b64_tr_b16 v[122:123], v31 offset:34816
M a[24:27], v[180:183], a[220:223], a[24:27]
ds_read_b64_tr_b16 v[124:125], v31 offset:36864
ds_read_b64_tr_b16 v[126:127], v31 offset:38912
M a[28:31], v[188:191], a[220:223], a[28:31]
M a[28:31], v[184:187], a[216:219], a[28:31]
s_waitcnt vmcnt(29) lgkmcnt(0)
s_barrier
M a[0:3], v[96:99], a[224:227], a[0:3]
s_add_u32 m0, s42, 49152
s_nop 0
buffer_load_dwordx4 v6, s[48:51], s26 offen offset:0 lds
ds_read_b64_tr_b16 v[160:161], v28 offset:49152
ds_read_b64_tr_b16 v[162:163], v28 offset:51200
M a[0:3], v[100:103], a[228:231], a[0:3]
buffer_load_dwordx4 v7, s[48:51], s26 offen offset:1024 lds
M a[4:7], v[108:111], a[228:231], a[4:7]
ds_read_b64_tr_b16 v[164:165], v28 offset:53248
ds_read_b64_tr_b16 v[166:167], v28 offset:55296
M a[4:7], v[104:107], a[224:227], a[4:7]
buffer_load_dwordx4 a[176:179], v1, s[44:47], s25 offen offset:0 sc1
M a[8:11], v[112:115], a[224:227], a[8:11]
ds_read_b64_tr_b16 v[168:169], v29 offset:49152
ds_read_b64_tr_b16 v[170:171], v29 offset:51200
M a[8:11], v[116:119], a[228:231], a[8:11]
buffer_load_dwordx4 a[180:183], v1, s[44:47], s25 offen offset:1024 sc1
M a[12:15], v[124:127], a[228:231], a[12:15]
ds_read_b64_tr_b16 v[172:173], v29 offset:53248
ds_read_b64_tr_b16 v[174:175], v29 offset:55296
M a[12:15], v[120:123], a[224:227], a[12:15]
buffer_load_dwordx4 a[184:187], v1, s[44:47], s25 offen offset:2048 sc1
ds_read_b64_tr_b16 v[176:177], v30 offset:49152
ds_read_b64_tr_b16 v[178:179], v30 offset:51200
M a[16:19], v[96:99], a[232:235], a[16:19]
buffer_load_dwordx4 a[188:191], v1, s[44:47], s25 offen offset:3072 sc1
M a[16:19], v[100:103], a[236:239], a[16:19]
ds_read_b64_tr_b16 v[180:181], v30 offset:53248
ds_read_b64_tr_b16 v[182:183], v30 offset:55296
M a[20:23], v[108:111], a[236:239], a[20:23]
s_add_u32 s25, s25, 16384
s_add_u32 s26, s26, 131072
M a[20:23], v[104:107], a[232:235], a[20:23]
ds_read_b64_tr_b16 v[184:185], v31 offset:49152
ds_read_b64_tr_b16 v[186:187], v31 offset:51200
M a[24:27], v[112:115], a[232:235], a[24:27]
buffer_load_dword v252, v255, s[52:55], s62 offen sc1
M a[24:27], v[116:119], a[236:239], a[24:27]
ds_read_b64_tr_b16 v[188:189], v31 offset:53248
ds_read_b64_tr_b16 v[190:191], v31 offset:55296
M a[28:31], v[124:127], a[236:239], a[28:31]
M a[28:31], v[120:123], a[232:235], a[28:31]
s_waitcnt vmcnt(30) lgkmcnt(0)
s_barrier
s_waitcnt vmcnt(0)
v_cmp_ne_u32 vcc, 1, v252
s_nop 0
s_cbranch_vccnz Lk3_spinft
Lk3_gotft:
M a[0:3], v[160:163], a[240:243], a[0:3]
s_mov_b32 s32, s25
s_mov_b32 s33, s26
s_mov_b64 s[34:35], s[44:45]
s_mov_b64 s[36:37], s[48:49]
s_mov_b64 s[44:45], s[8:9]
s_mov_b32 s46, 16777216
s_mov_b64 s[48:49], s[10:11]
s_mov_b32 s50, 8388608
s_mov_b32 s25, s12
s_mov_b32 s26, s13
s_add_u32 m0, s41, 65536
s_nop 0
buffer_load_dwordx4 v2, s[48:51], s26 offen offset:0 lds
ds_read_b64_tr_b16 v[96:97], v24 offset:0
ds_read_b64_tr_b16 v[98:99], v24 offset:2048
M a[0:3], v[164:167], a[244:247], a[0:3]
buffer_load_dwordx4 v3, s[48:51], s26 offen offset:1024 lds
M a[4:7], v[172:175], a[244:247], a[4:7]
ds_read_b64_tr_b16 v[100:101], v24 offset:4096
ds_read_b64_tr_b16 v[102:103], v24 offset:6144
M a[4:7], v[168:171], a[240:243], a[4:7]
buffer_load_dwordx4 v4, s[48:51], s26 offen offset:2048 lds
ds_read_b64_tr_b16 v[104:105], v25 offset:0
ds_read_b64_tr_b16 v[106:107], v25 offset:2048
M a[8:11], v[176:179], a[240:243], a[8:11]
buffer_load_dwordx4 v5, s[48:51], s26 offen offset:3072 lds
M a[8:11], v[180:183], a[244:247], a[8:11]
ds_read_b64_tr_b16 v[108:109], v25 offset:4096
ds_read_b64_tr_b16 v[110:111], v25 offset:6144
M a[12:15], v[188:191], a[244:247], a[12:15]
buffer_load_dwordx4 a[192:195], v1, s[44:47], s25 offen offset:0 sc1
M a[12:15], v[184:187], a[240:243], a[12:15]
ds_read_b64_tr_b16 v[112:113], v26 offset:0
ds_read_b64_tr_b16 v[114:115], v26 offset:2048
buffer_load_dwordx4 a[196:199], v1, s[44:47], s25 offen offset:1024 sc1
M a[16:19], v[160:163], a[248:251], a[16:19]
ds_read_b64_tr_b16 v[116:117], v26 offset:4096
ds_read_b64_tr_b16 v[118:119], v26 offset:6144
M a[16:19], v[164:167], a[252:255], a[16:19]
buffer_load_dwordx4 a[200:203], v1, s[44:47], s25 offen offset:2048 sc1
M a[20:23], v[172:175], a[252:255], a[20:23]
ds_read_b64_tr_b16 v[120:121], v27 offset:0
ds_read_b64_tr_b16 v[122:123], v27 offset:2048
buffer_load_dwordx4 a[204:207], v1, s[44:47], s25 offen offset:3072 sc1
M a[20:23], v[168:171], a[248:251], a[20:23]
ds_read_b64_tr_b16 v[124:125], v27 offset:4096
ds_read_b64_tr_b16 v[126:127], v27 offset:6144
M a[24:27], v[176:179], a[248:251], a[24:27]
s_sub_u32 s39, s39, 1
s_cmp_eq_u32 s39, 0
s_cselect_b32 s3, s64, s65
M a[24:27], v[180:183], a[252:255], a[24:27]
s_add_u32 s25, s25, s3
s_lshl_b32 s3, s3, 3
s_add_u32 s26, s26, s3
M a[28:31], v[188:191], a[252:255], a[28:31]
M a[28:31], v[184:187], a[248:251], a[28:31]
s_waitcnt vmcnt(24) lgkmcnt(0)
s_barrier
M a[0:3], v[96:99], a[128:131], a[0:3]
s_add_u32 m0, s41, 81920
s_nop 0
buffer_load_dwordx4 v2, s[48:51], s26 offen offset:0 lds
ds_read_b64_tr_b16 v[160:161], v24 offset:16384
ds_read_b64_tr_b16 v[162:163], v24 offset:18432
M a[0:3], v[100:103], a[132:135], a[0:3]
buffer_load_dwordx4 v3, s[48:51], s26 offen offset:1024 lds
M a[4:7], v[108:111], a[132:135], a[4:7]
ds_read_b64_tr_b16 v[164:165], v24 offset:20480
ds_read_b64_tr_b16 v[166:167], v24 offset:22528
M a[4:7], v[104:107], a[128:131], a[4:7]
buffer_load_dwordx4 v4, s[48:51], s26 offen offset:2048 lds
ds_read_b64_tr_b16 v[168:169], v25 offset:16384
ds_read_b64_tr_b16 v[170:171], v25 offset:18432
M a[8:11], v[112:115], a[128:131], a[8:11]
buffer_load_dwordx4 v5, s[48:51], s26 offen offset:3072 lds
M a[8:11], v[116:119], a[132:135], a[8:11]
ds_read_b64_tr_b16 v[172:173], v25 offset:20480
ds_read_b64_tr_b16 v[174:175], v25 offset:22528
M a[12:15], v[124:127], a[132:135], a[12:15]
buffer_load_dwordx4 a[208:211], v1, s[44:47], s25 offen offset:0 sc1
M a[12:15], v[120:123], a[128:131], a[12:15]
ds_read_b64_tr_b16 v[176:177], v26 offset:16384
ds_read_b64_tr_b16 v[178:179], v26 offset:18432
buffer_load_dwordx4 a[212:215], v1, s[44:47], s25 offen offset:1024 sc1
M a[16:19], v[96:99], a[136:139], a[16:19]
ds_read_b64_tr_b16 v[180:181], v26 offset:20480
ds_read_b64_tr_b16 v[182:183], v26 offset:22528
M a[16:19], v[100:103], a[140:143], a[16:19]
buffer_load_dwordx4 a[216:219], v1, s[44:47], s25 offen offset:2048 sc1
M a[20:23], v[108:111], a[140:143], a[20:23]
ds_read_b64_tr_b16 v[184:185], v27 offset:16384
ds_read_b64_tr_b16 v[186:187], v27 offset:18432
buffer_load_dwordx4 a[220:223], v1, s[44:47], s25 offen offset:3072 sc1
M a[20:23], v[104:107], a[136:139], a[20:23]
ds_read_b64_tr_b16 v[188:189], v27 offset:20480
ds_read_b64_tr_b16 v[190:191], v27 offset:22528
M a[24:27], v[112:115], a[136:139], a[24:27]
s_sub_u32 s39, s39, 1
s_cmp_eq_u32 s39, 0
s_cselect_b32 s3, s64, s65
M a[24:27], v[116:119], a[140:143], a[24:27]
s_add_u32 s25, s25, s3
s_lshl_b32 s3, s3, 3
s_add_u32 s26, s26, s3
M a[28:31], v[124:127], a[140:143], a[28:31]
M a[28:31], v[120:123], a[136:139], a[28:31]
s_waitcnt vmcnt(23) lgkmcnt(0)
s_barrier
M a[0:3], v[160:163], a[144:147], a[0:3]
s_add_u32 m0, s41, 98304
s_nop 0
buffer_load_dwordx4 v2, s[48:51], s26 offen offset:0 lds
ds_read_b64_tr_b16 v[96:97], v24 offset:32768
ds_read_b64_tr_b16 v[98:99], v24 offset:34816
M a[0:3], v[164:167], a[148:151], a[0:3]
buffer_load_dwordx4 v3, s[48:51], s26 offen offset:1024 lds
M a[4:7], v[172:175], a[148:151], a[4:7]
ds_read_b64_tr_b16 v[100:101], v24 offset:36864
ds_read_b64_tr_b16 v[102:103], v24 offset:38912
M a[4:7], v[168:171], a[144:147], a[4:7]
buffer_load_dwordx4 v4, s[48:51], s26 offen offset:2048 lds
ds_read_b64_tr_b16 v[104:105], v25 offset:32768
ds_read_b64_tr_b16 v[106:107], v25 offset:34816
M a[8:11], v[176:179], a[144:147], a[8:11]
buffer_load_dwordx4 v5, s[48:51], s26 offen offset:3072 lds
M a[8:11], v[180:183], a[148:151], a[8:11]
ds_read_b64_tr_b16 v[108:109], v25 offset:36864
ds_read_b64_tr_b16 v[110:111], v25 offset:38912
M a[12:15], v[188:191], a[148:151], a[12:15]
buffer_load_dwordx4 a[224:227], v1, s[44:47], s25 offen offset:0 sc1
M a[12:15], v[184:187], a[144:147], a[12:15]
ds_read_b64_tr_b16 v[112:113], v26 offset:32768
ds_read_b64_tr_b16 v[114:115], v26 offset:34816
buffer_load_dwordx4 a[228:231], v1, s[44:47], s25 offen offset:1024 sc1
M a[16:19], v[160:163], a[152:155], a[16:19]
ds_read_b64_tr_b16 v[116:117], v26 offset:36864
ds_read_b64_tr_b16 v[118:119], v26 offset:38912
M a[16:19], v[164:167], a[156:159], a[16:19]
buffer_load_dwordx4 a[232:235], v1, s[44:47], s25 offen offset:2048 sc1
M a[20:23], v[172:175], a[156:159], a[20:23]
ds_read_b64_tr_b16 v[120:121], v27 offset:32768
ds_read_b64_tr_b16 v[122:123], v27 offset:34816
buffer_load_dwordx4 a[236:239], v1, s[44:47], s25 offen offset:3072 sc1
M a[20:23], v[168:171], a[152:155], a[20:23]
ds_read_b64_tr_b16 v[124:125], v27 offset:36864
ds_read_b64_tr_b16 v[126:127], v27 offset:38912
M a[24:27], v[176:179], a[152:155], a[24:27]
s_sub_u32 s39, s39, 1
s_cmp_eq_u32 s39, 0
s_cselect_b32 s3, s64, s65
M a[24:27], v[180:183], a[156:159], a[24:27]
s_add_u32 s25, s25, s3
s_lshl_b32 s3, s3, 3
s_add_u32 s26, s26, s3
M a[28:31], v[188:191], a[156:159], a[28:31]
M a[28:31], v[184:187], a[152:155], a[28:31]
s_waitcnt vmcnt(25) lgkmcnt(0)
s_barrier
M a[0:3], v[96:99], a[160:163], a[0:3]
s_add_u32 m0, s41, 114688
s_nop 0
buffer_load_dwordx4 v2, s[48:51], s26 offen offset:0 lds
ds_read_b64_tr_b16 v[160:161], v24 offset:49152
ds_read_b64_tr_b16 v[162:163], v24 offset:51200
M a[0:3], v[100:103], a[164:167], a[0:3]
buffer_load_dwordx4 v3, s[48:51], s26 offen offset:1024 lds
M a[4:7], v[108:111], a[164:167], a[4:7]
ds_read_b64_tr_b16 v[164:165], v24 offset:53248
ds_read_b64_tr_b16 v[166:167], v24 offset:55296
M a[4:7], v[104:107], a[160:163], a[4:7]
buffer_load_dwordx4 v4, s[48:51], s26 offen offset:2048 lds
ds_read_b64_tr_b16 v[168:169], v25 offset:49152
ds_read_b64_tr_b16 v[170:171], v25 offset:51200
M a[8:11], v[112:115], a[160:163], a[8:11]
buffer_load_dwordx4 v5, s[48:51], s26 offen offset:3072 lds
M a[8:11], v[116:119], a[164:167], a[8:11]
ds_read_b64_tr_b16 v[172:173], v25 offset:53248
ds_read_b64_tr_b16 v[174:175], v25 offset:55296
M a[12:15], v[124:127], a[164:167], a[12:15]
buffer_load_dwordx4 a[240:243], v1, s[44:47], s25 offen offset:0 sc1
M a[12:15], v[120:123], a[160:163], a[12:15]
ds_read_b64_tr_b16 v[176:177], v26 offset:49152
ds_read_b64_tr_b16 v[178:179], v26 offset:51200
buffer_load_dwordx4 a[244:247], v1, s[44:47], s25 offen offset:1024 sc1
M a[16:19], v[96:99], a[168:171], a[16:19]
ds_read_b64_tr_b16 v[180:181], v26 offset:53248
ds_read_b64_tr_b16 v[182:183], v26 offset:55296
M a[16:19], v[100:103], a[172:175], a[16:19]
buffer_load_dwordx4 a[248:251], v1, s[44:47], s25 offen offset:2048 sc1
M a[20:23], v[108:111], a[172:175], a[20:23]
ds_read_b64_tr_b16 v[184:185], v27 offset:49152
ds_read_b64_tr_b16 v[186:187], v27 offset:51200
buffer_load_dwordx4 a[252:255], v1, s[44:47], s25 offen offset:3072 sc1
M a[20:23], v[104:107], a[168:171], a[20:23]
ds_read_b64_tr_b16 v[188:189], v27 offset:53248
ds_read_b64_tr_b16 v[190:191], v27 offset:55296
M a[24:27], v[112:115], a[168:171], a[24:27]
s_sub_u32 s39, s39, 1
s_cmp_eq_u32 s39, 0
s_cselect_b32 s3, s64, s65
M a[24:27], v[116:119], a[172:175], a[24:27]
s_add_u32 s25, s25, s3
s_lshl_b32 s3, s3, 3
s_add_u32 s26, s26, s3
M a[28:31], v[124:127], a[172:175], a[28:31]
M a[28:31], v[120:123], a[168:171], a[28:31]
s_waitcnt vmcnt(24) lgkmcnt(0)
s_barrier
M a[0:3], v[160:163], a[176:179], a[0:3]
s_add_u32 m0, s41, 0
s_nop 0
buffer_load_dwordx4 v2, s[48:51], s26 offen offset:0 lds
ds_read_b64_tr_b16 v[96:97], v16 offset:0
ds_read_b64_tr_b16 v[98:99], v16 offset:4096
M a[0:3], v[164:167], a[180:183], a[0:3]
buffer_load_dwordx4 v3, s[48:51], s26 offen offset:1024 lds
ds_read_b64_tr_b16 v[100:101], v16 offset:8192
ds_read_b64_tr_b16 v[102:103], v16 offset:12288
M a[4:7], v[172:175], a[180:183], a[4:7]
buffer_load_dwordx4 v4, s[48:51], s26 offen offset:2048 lds
ds_read_b64_tr_b16 v[104:105], v17 offset:0
ds_read_b64_tr_b16 v[106:107], v17 offset:4096
M a[4:7], v[168:171], a[176:179], a[4:7]
buffer_load_dwordx4 v5, s[48:51], s26 offen offset:3072 lds
ds_read_b64_tr_b16 v[108:109], v17 offset:8192
ds_read_b64_tr_b16 v[110:111], v17 offset:12288
M a[8:11], v[176:179], a[176:179], a[8:11]
buffer_load_dwordx4 a[128:131], v1, s[44:47], s25 offen offset:0 sc1
ds_read_b64_tr_b16 v[112:113], v18 offset:0
ds_read_b64_tr_b16 v[114:115], v18 offset:4096
M a[8:11], v[180:183], a[180:183], a[8:11]
buffer_load_dwordx4 a[132:135], v1, s[44:47], s25 offen offset:1024 sc1
ds_read_b64_tr_b16 v[116:117], v18 offset:8192
ds_read_b64_tr_b16 v[118:119], v18 offset:12288
M a[12:15], v[188:191], a[180:183], a[12:15]
buffer_load_dwordx4 a[136:139], v1, s[44:47], s25 offen offset:2048 sc1
M a[12:15], v[184:187], a[176:179], a[12:15]
ds_read_b64_tr_b16 v[120:121], v19 offset:0
ds_read_b64_tr_b16 v[122:123], v19 offset:4096
buffer_load_dwordx4 a[140:143], v1, s[44:47], s25 offen offset:3072 sc1
M a[16:19], v[160:163], a[184:187], a[16:19]
ds_read_b64_tr_b16 v[124:125], v19 offset:8192
ds_read_b64_tr_b16 v[126:127], v19 offset:12288
s_sub_u32 s39, s39, 1
s_cmp_eq_u32 s39, 0
s_cselect_b32 s3, s64, s65
M a[16:19], v[164:167], a[188:191], a[16:19]
ds_read_b64_tr_b16 v[128:129], v20 offset:0
ds_read_b64_tr_b16 v[130:131], v20 offset:4096
s_add_u32 s25, s25, s3
s_lshl_b32 s3, s3, 3
s_add_u32 s26, s26, s3
M a[20:23], v[172:175], a[188:191], a[20:23]
ds_read_b64_tr_b16 v[132:133], v20 offset:8192
ds_read_b64_tr_b16 v[134:135], v20 offset:12288
ds_read_b64_tr_b16 v[136:137], v21 offset:0
ds_read_b64_tr_b16 v[138:139], v21 offset:4096
M a[20:23], v[168:171], a[184:187], a[20:23]
ds_read_b64_tr_b16 v[140:141], v21 offset:8192
ds_read_b64_tr_b16 v[142:143], v21 offset:12288
ds_read_b64_tr_b16 v[144:145], v22 offset:0
ds_read_b64_tr_b16 v[146:147], v22 offset:4096
M a[24:27], v[176:179], a[184:187], a[24:27]
ds_read_b64_tr_b16 v[148:149], v22 offset:8192
ds_read_b64_tr_b16 v[150:151], v22 offset:12288
ds_read_b64_tr_b16 v[152:153], v23 offset:0
ds_read_b64_tr_b16 v[154:155], v23 offset:4096
M a[24:27], v[180:183], a[188:191], a[24:27]
ds_read_b64_tr_b16 v[156:157], v23 offset:8192
ds_read_b64_tr_b16 v[158:159], v23 offset:12288
M a[28:31], v[188:191], a[188:191], a[28:31]
M a[28:31], v[184:187], a[184:187], a[28:31]
s_waitcnt vmcnt(24) lgkmcnt(0)
s_barrier
M v[32:35], v[96:99], a[192:195], 0
s_add_u32 m0, s41, 16384
s_nop 0
buffer_load_dwordx4 v2, s[48:51], s26 offen offset:0 lds
M v[32:35], v[100:103], a[196:199], v[32:35]
ds_read_b64_tr_b16 v[160:161], v16 offset:16384
ds_read_b64_tr_b16 v[162:163], v16 offset:20480
M v[36:39], v[108:111], a[196:199], 0
buffer_load_dwordx4 v3, s[48:51], s26 offen offset:1024 lds
M v[36:39], v[104:107], a[192:195], v[36:39]
ds_read_b64_tr_b16 v[164:165], v16 offset:24576
ds_read_b64_tr_b16 v[166:167], v16 offset:28672
M v[40:43], v[112:115], a[192:195], 0
buffer_load_dwordx4 v4, s[48:51], s26 offen offset:2048 lds
M v[40:43], v[116:119], a[196:199], v[40:43]
ds_read_b64_tr_b16 v[168:169], v17 offset:16384
ds_read_b64_tr_b16 v[170:171], v17 offset:20480
M v[44:47], v[124:127], a[196:199], 0
buffer_load_dwordx4 v5, s[48:51], s26 offen offset:3072 lds
M v[44:47], v[120:123], a[192:195], v[44:47]
M v[48:51], v[128:131], a[192:195], 0
ds_read_b64_tr_b16 v[172:173], v17 offset:24576
ds_read_b64_tr_b16 v[174:175], v17 offset:28672
M v[48:51], v[132:135], a[196:199], v[48:51]
buffer_load_dwordx4 a[144:147], v1, s[44:47], s25 offen offset:0 sc1
M v[52:55], v[140:143], a[196:199], 0
ds_read_b64_tr_b16 v[176:177], v18 offset:16384
ds_read_b64_tr_b16 v[178:179], v18 offset:20480
M v[52:55], v[136:139], a[192:195], v[52:55]
buffer_load_dwordx4 a[148:151], v1, s[44:47], s25 offen offset:1024 sc1
M v[56:59], v[144:147], a[192:195], 0
ds_read_b64_tr_b16 v[180:181], v18 offset:24576
ds_read_b64_tr_b16 v[182:183], v18 offset:28672
M v[56:59], v[148:151], a[196:199], v[56:59]
buffer_load_dwordx4 a[152:155], v1, s[44:47], s25 offen offset:2048 sc1
M v[60:63], v[156:159], a[196:199], 0
M v[60:63], v[152:155], a[192:195], v[60:63]
ds_read_b64_tr_b16 v[184:185], v19 offset:16384
ds_read_b64_tr_b16 v[186:187], v19 offset:20480
M v[64:67], v[96:99], a[200:203], 0
buffer_load_dwordx4 a[156:159], v1, s[44:47], s25 offen offset:3072 sc1
M v[64:67], v[100:103], a[204:207], v[64:67]
ds_read_b64_tr_b16 v[188:189], v19 offset:24576
ds_read_b64_tr_b16 v[190:191], v19 offset:28672
M v[68:71], v[108:111], a[204:207], 0
s_sub_u32 s39, s39, 1
s_cmp_eq_u32 s39, 0
s_cselect_b32 s3, s64, s65
M v[68:71], v[104:107], a[200:203], v[68:71]
ds_read_b64_tr_b16 v[192:193], v20 offset:16384
ds_read_b64_tr_b16 v[194:195], v20 offset:20480
M v[72:75], v[112:115], a[200:203], 0
s_add_u32 s25, s25, s3
s_lshl_b32 s3, s3, 3
s_add_u32 s26, s26, s3
M v[72:75], v[116:119], a[204:207], v[72:75]
ds_read_b64_tr_b16 v[196:197], v20 offset:24576
ds_read_b64_tr_b16 v[198:199], v20 offset:28672
M v[76:79], v[124:127], a[204:207], 0
M v[76:79], v[120:123], a[200:203], v[76:79]
ds_read_b64_tr_b16 v[200:201], v21 offset:16384
ds_read_b64_tr_b16 v[202:203], v21 offset:20480
M v[80:83], v[128:131], a[200:203], 0
ds_read_b64_tr_b16 v[204:205], v21 offset:24576
ds_read_b64_tr_b16 v[206:207], v21 offset:28672
M v[80:83], v[132:135], a[204:207], v[80:83]
ds_read_b64_tr_b16 v[208:209], v22 offset:16384
ds_read_b64_tr_b16 v[210:211], v22 offset:20480
M v[84:87], v[140:143], a[204:207], 0
ds_read_b64_tr_b16 v[212:213], v22 offset:24576
ds_read_b64_tr_b16 v[214:215], v22 offset:28672
M v[84:87], v[136:139], a[200:203], v[84:87]
ds_read_b64_tr_b16 v[216:217], v23 offset:16384
ds_read_b64_tr_b16 v[218:219], v23 offset:20480
M v[88:91], v[144:147], a[200:203], 0
ds_read_b64_tr_b16 v[220:221], v23 offset:24576
ds_read_b64_tr_b16 v[222:223], v23 offset:28672
M v[88:91], v[148:151], a[204:207], v[88:91]
M v[92:95], v[156:159], a[204:207], 0
M v[92:95], v[152:155], a[200:203], v[92:95]
s_mov_b32 s28, 3
Lk3_la:
s_waitcnt vmcnt(24) lgkmcnt(0)
s_barrier
M v[32:35], v[160:163], a[208:211], v[32:35]
s_add_u32 m0, s41, 32768
s_nop 0
buffer_load_dwordx4 v2, s[48:51], s26 offen offset:0 lds
M v[32:35], v[164:167], a[212:215], v[32:35]
ds_read_b64_tr_b16 v[96:97], v16 offset:32768
ds_read_b64_tr_b16 v[98:99], v16 offset:36864
M v[36:39], v[172:175], a[212:215], v[36:39]
buffer_load_dwordx4 v3, s[48:51], s26 offen offset:1024 lds
M v[36:39], v[168:171], a[208:211], v[36:39]
ds_read_b64_tr_b16 v[100:101], v16 offset:40960
ds_read_b64_tr_b16 v[102:103], v16 offset:45056
M v[40:43], v[176:179], a[208:211], v[40:43]
buffer_load_dwordx4 v4, s[48:51], s26 offen offset:2048 lds
M v[40:43], v[180:183], a[212:215], v[40:43]
ds_read_b64_tr_b16 v[104:105], v17 offset:32768
ds_read_b64_tr_b16 v[106:107], v17 offset:36864
M v[44:47], v[188:191], a[212:215], v[44:47]
buffer_load_dwordx4 v5, s[48:51], s26 offen offset:3072 lds
M v[44:47], v[184:187], a[208:211], v[44:47]
M v[48:51], v[192:195], a[208:211], v[48:51]
ds_read_b64_tr_b16 v[108:109], v17 offset:40960
ds_read_b64_tr_b16 v[110:111], v17 offset:45056
M v[48:51], v[196:199], a[212:215], v[48:51]
buffer_load_dwordx4 a[160:163], v1, s[44:47], s25 offen offset:0 sc1
M v[52:55], v[204:207], a[212:215], v[52:55]
ds_read_b64_tr_b16 v[112:113], v18 offset:32768
ds_read_b64_tr_b16 v[114:115], v18 offset:36864
M v[52:55], v[200:203], a[208:211], v[52:55]
buffer_load_dwordx4 a[164:167], v1, s[44:47], s25 offen offset:1024 sc1
M v[56:59], v[208:211], a[208:211], v[56:59]
ds_read_b64_tr_b16 v[116:117], v18 offset:40960
ds_read_b64_tr_b16 v[118:119], v18 offset:45056
M v[56:59], v[212:215], a[212:215], v[56:59]
buffer_load_dwordx4 a[168:171], v1, s[44:47], s25 offen offset:2048 sc1
M v[60:63], v[220:223], a[212:215], v[60:63]
M v[60:63], v[216:219], a[208:211], v[60:63]
ds_read_b64_tr_b16 v[120:121], v19 offset:32768
ds_read_b64_tr_b16 v[122:123], v19 offset:36864
M v[64:67], v[160:163], a[216:219], v[64:67]
buffer_load_dwordx4 a[172:175], v1, s[44:47], s25 offen offset:3072 sc1
M v[64:67], v[164:167], a[220:223], v[64:67]
ds_read_b64_tr_b16 v[124:125], v19 offset:40960
ds_read_b64_tr_b16 v[126:127], v19 offset:45056
M v[68:71], v[172:175], a[220:223], v[68:71]
s_sub_u32 s39, s39, 1
s_cmp_eq_u32 s39, 0
s_cselect_b32 s3, s64, s65
M v[68:71], v[168:171], a[216:219], v[68:71]
ds_read_b64_tr_b16 v[128:129], v20 offset:32768
ds_read_b64_tr_b16 v[130:131], v20 offset:36864
M v[72:75], v[176:179], a[216:219], v[72:75]
s_add_u32 s25, s25, s3
s_lshl_b32 s3, s3, 3
s_add_u32 s26, s26, s3
M v[72:75], v[180:183], a[220:223], v[72:75]
ds_read_b64_tr_b16 v[132:133], v20 offset:40960
ds_read_b64_tr_b16 v[134:135], v20 offset:45056
M v[76:79], v[188:191], a[220:223], v[76:79]
M v[76:79], v[184:187], a[216:219], v[76:79]
ds_read_b64_tr_b16 v[136:137], v21 offset:32768
ds_read_b64_tr_b16 v[138:139], v21 offset:36864
M v[80:83], v[192:195], a[216:219], v[80:83]
ds_read_b64_tr_b16 v[140:141], v21 offset:40960
ds_read_b64_tr_b16 v[142:143], v21 offset:45056
M v[80:83], v[196:199], a[220:223], v[80:83]
ds_read_b64_tr_b16 v[144:145], v22 offset:32768
ds_read_b64_tr_b16 v[146:147], v22 offset:36864
M v[84:87], v[204:207], a[220:223], v[84:87]
ds_read_b64_tr_b16 v[148:149], v22 offset:40960
ds_read_b64_tr_b16 v[150:151], v22 offset:45056
M v[84:87], v[200:203], a[216:219], v[84:87]
ds_read_b64_tr_b16 v[152:153], v23 offset:32768
ds_read_b64_tr_b16 v[154:155], v23 offset:36864
M v[88:91], v[208:211], a[216:219], v[88:91]
ds_read_b64_tr_b16 v[156:157], v23 offset:40960
ds_read_b64_tr_b16 v[158:159], v23 offset:45056
M v[88:91], v[212:215], a[220:223], v[88:91]
M v[92:95], v[220:223], a[220:223], v[92:95]
M v[92:95], v[216:219], a[216:219], v[92:95]
s_waitcnt vmcnt(24) lgkmcnt(0)
s_barrier
M v[32:35], v[96:99], a[224:227], v[32:35]
s_add_u32 m0, s41, 49152
s_nop 0
buffer_load_dwordx4 v2, s[48:51], s26 offen offset:0 lds
M v[32:35], v[100:103], a[228:231], v[32:35]
ds_read_b64_tr_b16 v[160:161], v16 offset:49152
ds_read_b64_tr_b16 v[162:163], v16 offset:53248
M v[36:39], v[108:111], a[228:231], v[36:39]
buffer_load_dwordx4 v3, s[48:51], s26 offen offset:1024 lds
M v[36:39], v[104:107], a[224:227], v[36:39]
ds_read_b64_tr_b16 v[164:165], v16 offset:57344
ds_read_b64_tr_b16 v[166:167], v16 offset:61440
M v[40:43], v[112:115], a[224:227], v[40:43]
buffer_load_dwordx4 v4, s[48:51], s26 offen offset:2048 lds
M v[40:43], v[116:119], a[228:231], v[40:43]
ds_read_b64_tr_b16 v[168:169], v17 offset:49152
ds_read_b64_tr_b16 v[170:171], v17 offset:53248
M v[44:47], v[124:127], a[228:231], v[44:47]
buffer_load_dwordx4 v5, s[48:51], s26 offen offset:3072 lds
M v[44:47], v[120:123], a[224:227], v[44:47]
M v[48:51], v[128:131], a[224:227], v[48:51]
ds_read_b64_tr_b16 v[172:173], v17 offset:57344
ds_read_b64_tr_b16 v[174:175], v17 offset:61440
M v[48:51], v[132:135], a[228:231], v[48:51]
buffer_load_dwordx4 a[176:179], v1, s[44:47], s25 offen offset:0 sc1
M v[52:55], v[140:143], a[228:231], v[52:55]
ds_read_b64_tr_b16 v[176:177], v18 offset:49152
ds_read_b64_tr_b16 v[178:179], v18 offset:53248
M v[52:55], v[136:139], a[224:227], v[52:55]
buffer_load_dwordx4 a[180:183], v1, s[44:47], s25 offen offset:1024 sc1
M v[56:59], v[144:147], a[224:227], v[56:59]
ds_read_b64_tr_b16 v[180:181], v18 offset:57344
ds_read_b64_tr_b16 v[182:183], v18 offset:61440
M v[56:59], v[148:151], a[228:231], v[56:59]
buffer_load_dwordx4 a[184:187], v1, s[44:47], s25 offen offset:2048 sc1
M v[60:63], v[156:159], a[228:231], v[60:63]
M v[60:63], v[152:155], a[224:227], v[60:63]
ds_read_b64_tr_b16 v[184:185], v19 offset:49152
ds_read_b64_tr_b16 v[186:187], v19 offset:53248
M v[64:67], v[96:99], a[232:235], v[64:67]
buffer_load_dwordx4 a[188:191], v1, s[44:47], s25 offen offset:3072 sc1
M v[64:67], v[100:103], a[236:239], v[64:67]
ds_read_b64_tr_b16 v[188:189], v19 offset:57344
ds_read_b64_tr_b16 v[190:191], v19 offset:61440
M v[68:71], v[108:111], a[236:239], v[68:71]
s_sub_u32 s39, s39, 1
s_cmp_eq_u32 s39, 0
s_cselect_b32 s3, s64, s65
M v[68:71], v[104:107], a[232:235], v[68:71]
ds_read_b64_tr_b16 v[192:193], v20 offset:49152
ds_read_b64_tr_b16 v[194:195], v20 offset:53248
M v[72:75], v[112:115], a[232:235], v[72:75]
s_add_u32 s25, s25, s3
s_lshl_b32 s3, s3, 3
s_add_u32 s26, s26, s3
M v[72:75], v[116:119], a[236:239], v[72:75]
ds_read_b64_tr_b16 v[196:197], v20 offset:57344
ds_read_b64_tr_b16 v[198:199], v20 offset:61440
M v[76:79], v[124:127], a[236:239], v[76:79]
M v[76:79], v[120:123], a[232:235], v[76:79]
ds_read_b64_tr_b16 v[200:201], v21 offset:49152
ds_read_b64_tr_b16 v[202:203], v21 offset:53248
M v[80:83], v[128:131], a[232:235], v[80:83]
ds_read_b64_tr_b16 v[204:205], v21 offset:57344
ds_read_b64_tr_b16 v[206:207], v21 offset:61440
M v[80:83], v[132:135], a[236:239], v[80:83]
ds_read_b64_tr_b16 v[208:209], v22 offset:49152
ds_read_b64_tr_b16 v[210:211], v22 offset:53248
M v[84:87], v[140:143], a[236:239], v[84:87]
ds_read_b64_tr_b16 v[212:213], v22 offset:57344
ds_read_b64_tr_b16 v[214:215], v22 offset:61440
M v[84:87], v[136:139], a[232:235], v[84:87]
ds_read_b64_tr_b16 v[216:217], v23 offset:49152
ds_read_b64_tr_b16 v[218:219], v23 offset:53248
M v[88:91], v[144:147], a[232:235], v[88:91]
ds_read_b64_tr_b16 v[220:221], v23 offset:57344
ds_read_b64_tr_b16 v[222:223], v23 offset:61440
M v[88:91], v[148:151], a[236:239], v[88:91]
M v[92:95], v[156:159], a[236:239], v[92:95]
M v[92:95], v[152:155], a[232:235], v[92:95]
s_waitcnt vmcnt(24) lgkmcnt(0)
s_barrier
M v[32:35], v[160:163], a[240:243], v[32:35]
s_add_u32 m0, s41, 65536
s_nop 0
buffer_load_dwordx4 v2, s[48:51], s26 offen offset:0 lds
M v[32:35], v[164:167], a[244:247], v[32:35]
ds_read_b64_tr_b16 v[96:97], v8 offset:0
ds_read_b64_tr_b16 v[98:99], v8 offset:4096
M v[36:39], v[172:175], a[244:247], v[36:39]
buffer_load_dwordx4 v3, s[48:51], s26 offen offset:1024 lds
M v[36:39], v[168:171], a[240:243], v[36:39]
ds_read_b64_tr_b16 v[100:101], v8 offset:8192
ds_read_b64_tr_b16 v[102:103], v8 offset:12288
M v[40:43], v[176:179], a[240:243], v[40:43]
buffer_load_dwordx4 v4, s[48:51], s26 offen offset:2048 lds
M v[40:43], v[180:183], a[244:247], v[40:43]
ds_read_b64_tr_b16 v[104:105], v9 offset:0
ds_read_b64_tr_b16 v[106:107], v9 offset:4096
M v[44:47], v[188:191], a[244:247], v[44:47]
buffer_load_dwordx4 v5, s[48:51], s26 offen offset:3072 lds
M v[44:47], v[184:187], a[240:243], v[44:47]
M v[48:51], v[192:195], a[240:243], v[48:51]
ds_read_b64_tr_b16 v[108:109], v9 offset:8192
ds_read_b64_tr_b16 v[110:111], v9 offset:12288
M v[48:51], v[196:199], a[244:247], v[48:51]
buffer_load_dwordx4 a[192:195], v1, s[44:47], s25 offen offset:0 sc1
M v[52:55], v[204:207], a[244:247], v[52:55]
ds_read_b64_tr_b16 v[112:113], v10 offset:0
ds_read_b64_tr_b16 v[114:115], v10 offset:4096
M v[52:55], v[200:203], a[240:243], v[52:55]
buffer_load_dwordx4 a[196:199], v1, s[44:47], s25 offen offset:1024 sc1
M v[56:59], v[208:211], a[240:243], v[56:59]
ds_read_b64_tr_b16 v[116:117], v10 offset:8192
ds_read_b64_tr_b16 v[118:119], v10 offset:12288
M v[56:59], v[212:215], a[244:247], v[56:59]
buffer_load_dwordx4 a[200:203], v1, s[44:47], s25 offen offset:2048 sc1
M v[60:63], v[220:223], a[244:247], v[60:63]
M v[60:63], v[216:219], a[240:243], v[60:63]
ds_read_b64_tr_b16 v[120:121], v11 offset:0
ds_read_b64_tr_b16 v[122:123], v11 offset:4096
M v[64:67], v[160:163], a[248:251], v[64:67]
buffer_load_dwordx4 a[204:207], v1, s[44:47], s25 offen offset:3072 sc1
M v[64:67], v[164:167], a[252:255], v[64:67]
ds_read_b64_tr_b16 v[124:125], v11 offset:8192
ds_read_b64_tr_b16 v[126:127], v11 offset:12288
M v[68:71], v[172:175], a[252:255], v[68:71]
s_sub_u32 s39, s39, 1
s_cmp_eq_u32 s39, 0
s_cselect_b32 s3, s64, s65
M v[68:71], v[168:171], a[248:251], v[68:71]
ds_read_b64_tr_b16 v[128:129], v12 offset:0
ds_read_b64_tr_b16 v[130:131], v12 offset:4096
M v[72:75], v[176:179], a[248:251], v[72:75]
s_add_u32 s25, s25, s3
s_lshl_b32 s3, s3, 3
s_add_u32 s26, s26, s3
M v[72:75], v[180:183], a[252:255], v[72:75]
ds_read_b64_tr_b16 v[132:133], v12 offset:8192
ds_read_b64_tr_b16 v[134:135], v12 offset:12288
M v[76:79], v[188:191], a[252:255], v[76:79]
M v[76:79], v[184:187], a[248:251], v[76:79]
ds_read_b64_tr_b16 v[136:137], v13 offset:0
ds_read_b64_tr_b16 v[138:139], v13 offset:4096
M v[80:83], v[192:195], a[248:251], v[80:83]
ds_read_b64_tr_b16 v[140:141], v13 offset:8192
ds_read_b64_tr_b16 v[142:143], v13 offset:12288
M v[80:83], v[196:199], a[252:255], v[80:83]
ds_read_b64_tr_b16 v[144:145], v14 offset:0
ds_read_b64_tr_b16 v[146:147], v14 offset:4096
M v[84:87], v[204:207], a[252:255], v[84:87]
ds_read_b64_tr_b16 v[148:149], v14 offset:8192
ds_read_b64_tr_b16 v[150:151], v14 offset:12288
M v[84:87], v[200:203], a[248:251], v[84:87]
ds_read_b64_tr_b16 v[152:153], v15 offset:0
ds_read_b64_tr_b16 v[154:155], v15 offset:4096
M v[88:91], v[208:211], a[248:251], v[88:91]
ds_read_b64_tr_b16 v[156:157], v15 offset:8192
ds_read_b64_tr_b16 v[158:159], v15 offset:12288
M v[88:91], v[212:215], a[252:255], v[88:91]
M v[92:95], v[220:223], a[252:255], v[92:95]
M v[92:95], v[216:219], a[248:251], v[92:95]
s_waitcnt vmcnt(24) lgkmcnt(0)
s_barrier
M v[32:35], v[96:99], a[128:131], v[32:35]
s_add_u32 m0, s41, 81920
s_nop 0
buffer_load_dwordx4 v2, s[48:51], s26 offen offset:0 lds
M v[32:35], v[100:103], a[132:135], v[32:35]
ds_read_b64_tr_b16 v[160:161], v8 offset:16384
ds_read_b64_tr_b16 v[162:163], v8 offset:20480
M v[36:39], v[108:111], a[132:135], v[36:39]
buffer_load_dwordx4 v3, s[48:51], s26 offen offset:1024 lds
M v[36:39], v[104:107], a[128:131], v[36:39]
ds_read_b64_tr_b16 v[164:165], v8 offset:24576
ds_read_b64_tr_b16 v[166:167], v8 offset:28672
M v[40:43], v[112:115], a[128:131], v[40:43]
buffer_load_dwordx4 v4, s[48:51], s26 offen offset:2048 lds
M v[40:43], v[116:119], a[132:135], v[40:43]
ds_read_b64_tr_b16 v[168:169], v9 offset:16384
ds_read_b64_tr_b16 v[170:171], v9 offset:20480
M v[44:47], v[124:127], a[132:135], v[44:47]
buffer_load_dwordx4 v5, s[48:51], s26 offen offset:3072 lds
M v[44:47], v[120:123], a[128:131], v[44:47]
M v[48:51], v[128:131], a[128:131], v[48:51]
ds_read_b64_tr_b16 v[172:173], v9 offset:24576
ds_read_b64_tr_b16 v[174:175], v9 offset:28672
M v[48:51], v[132:135], a[132:135], v[48:51]
buffer_load_dwordx4 a[208:211], v1, s[44:47], s25 offen offset:0 sc1
M v[52:55], v[140:143], a[132:135], v[52:55]
ds_read_b64_tr_b16 v[176:177], v10 offset:16384
ds_read_b64_tr_b16 v[178:179], v10 offset:20480
M v[52:55], v[136:139], a[128:131], v[52:55]
buffer_load_dwordx4 a[212:215], v1, s[44:47], s25 offen offset:1024 sc1
M v[56:59], v[144:147], a[128:131], v[56:59]
ds_read_b64_tr_b16 v[180:181], v10 offset:24576
ds_read_b64_tr_b16 v[182:183], v10 offset:28672
M v[56:59], v[148:151], a[132:135], v[56:59]
buffer_load_dwordx4 a[216:219], v1, s[44:47], s25 offen offset:2048 sc1
M v[60:63], v[156:159], a[132:135], v[60:63]
M v[60:63], v[152:155], a[128:131], v[60:63]
ds_read_b64_tr_b16 v[184:185], v11 offset:16384
ds_read_b64_tr_b16 v[186:187], v11 offset:20480
M v[64:67], v[96:99], a[136:139], v[64:67]
buffer_load_dwordx4 a[220:223], v1, s[44:47], s25 offen offset:3072 sc1
M v[64:67], v[100:103], a[140:143], v[64:67]
ds_read_b64_tr_b16 v[188:189], v11 offset:24576
ds_read_b64_tr_b16 v[190:191], v11 offset:28672
M v[68:71], v[108:111], a[140:143], v[68:71]
s_sub_u32 s39, s39, 1
s_cmp_eq_u32 s39, 0
s_cselect_b32 s3, s64, s65
M v[68:71], v[104:107], a[136:139], v[68:71]
ds_read_b64_tr_b16 v[192:193], v12 offset:16384
ds_read_b64_tr_b16 v[194:195], v12 offset:20480
M v[72:75], v[112:115], a[136:139], v[72:75]
s_add_u32 s25, s25, s3
s_lshl_b32 s3, s3, 3
s_add_u32 s26, s26, s3
M v[72:75], v[116:119], a[140:143], v[72:75]
ds_read_b64_tr_b16 v[196:197], v12 offset:24576
ds_read_b64_tr_b16 v[198:199], v12 offset:28672
M v[76:79], v[124:127], a[140:143], v[76:79]
M v[76:79], v[120:123], a[136:139], v[76:79]
ds_read_b64_tr_b16 v[200:201], v13 offset:16384
ds_read_b64_tr_b16 v[202:203], v13 offset:20480
M v[80:83], v[128:131], a[136:139], v[80:83]
ds_read_b64_tr_b16 v[204:205], v13 offset:24576
ds_read_b64_tr_b16 v[206:207], v13 offset:28672
M v[80:83], v[132:135], a[140:143], v[80:83]
ds_read_b64_tr_b16 v[208:209], v14 offset:16384
ds_read_b64_tr_b16 v[210:211], v14 offset:20480
M v[84:87], v[140:143], a[140:143], v[84:87]
ds_read_b64_tr_b16 v[212:213], v14 offset:24576
ds_read_b64_tr_b16 v[214:215], v14 offset:28672
M v[84:87], v[136:139], a[136:139], v[84:87]
ds_read_b64_tr_b16 v[216:217], v15 offset:16384
ds_read_b64_tr_b16 v[218:219], v15 offset:20480
M v[88:91], v[144:147], a[136:139], v[88:91]
ds_read_b64_tr_b16 v[220:221], v15 offset:24576
ds_read_b64_tr_b16 v[222:223], v15 offset:28672
M v[88:91], v[148:151], a[140:143], v[88:91]
M v[92:95], v[156:159], a[140:143], v[92:95]
M v[92:95], v[152:155], a[136:139], v[92:95]
s_waitcnt vmcnt(24) lgkmcnt(0)
s_barrier
M v[32:35], v[160:163], a[144:147], v[32:35]
s_add_u32 m0, s41, 98304
s_nop 0
buffer_load_dwordx4 v2, s[48:51], s26 offen offset:0 lds
M v[32:35], v[164:167], a[148:151], v[32:35]
ds_read_b64_tr_b16 v[96:97], v8 offset:32768
ds_read_b64_tr_b16 v[98:99], v8 offset:36864
M v[36:39], v[172:175], a[148:151], v[36:39]
buffer_load_dwordx4 v3, s[48:51], s26 offen offset:1024 lds
M v[36:39], v[168:171], a[144:147], v[36:39]
ds_read_b64_tr_b16 v[100:101], v8 offset:40960
ds_read_b64_tr_b16 v[102:103], v8 offset:45056
M v[40:43], v[176:179], a[144:147], v[40:43]
buffer_load_dwordx4 v4, s[48:51], s26 offen offset:2048 lds
M v[40:43], v[180:183], a[148:151], v[40:43]
ds_read_b64_tr_b16 v[104:105], v9 offset:32768
ds_read_b64_tr_b16 v[106:107], v9 offset:36864
M v[44:47], v[188:191], a[148:151], v[44:47]
buffer_load_dwordx4 v5, s[48:51], s26 offen offset:3072 lds
M v[44:47], v[184:187], a[144:147], v[44:47]
M v[48:51], v[192:195], a[144:147], v[48:51]
ds_read_b64_tr_b16 v[108:109], v9 offset:40960
ds_read_b64_tr_b16 v[110:111], v9 offset:45056
M v[48:51], v[196:199], a[148:151], v[48:51]
buffer_load_dwordx4 a[224:227], v1, s[44:47], s25 offen offset:0 sc1
M v[52:55], v[204:207], a[148:151], v[52:55]
ds_read_b64_tr_b16 v[112:113], v10 offset:32768
ds_read_b64_tr_b16 v[114:115], v10 offset:36864
M v[52:55], v[200:203], a[144:147], v[52:55]
buffer_load_dwordx4 a[228:231], v1, s[44:47], s25 offen offset:1024 sc1
M v[56:59], v[208:211], a[144:147], v[56:59]
ds_read_b64_tr_b16 v[116:117], v10 offset:40960
ds_read_b64_tr_b16 v[118:119], v10 offset:45056
M v[56:59], v[212:215], a[148:151], v[56:59]
buffer_load_dwordx4 a[232:235], v1, s[44:47], s25 offen offset:2048 sc1
M v[60:63], v[220:223], a[148:151], v[60:63]
M v[60:63], v[216:219], a[144:147], v[60:63]
ds_read_b64_tr_b16 v[120:121], v11 offset:32768
ds_read_b64_tr_b16 v[122:123], v11 offset:36864
M v[64:67], v[160:163], a[152:155], v[64:67]
buffer_load_dwordx4 a[236:239], v1, s[44:47], s25 offen offset:3072 sc1
M v[64:67], v[164:167], a[156:159], v[64:67]
ds_read_b64_tr_b16 v[124:125], v11 offset:40960
ds_read_b64_tr_b16 v[126:127], v11 offset:45056
M v[68:71], v[172:175], a[156:159], v[68:71]
s_sub_u32 s39, s39, 1
s_cmp_eq_u32 s39, 0
s_cselect_b32 s3, s64, s65
M v[68:71], v[168:171], a[152:155], v[68:71]
ds_read_b64_tr_b16 v[128:129], v12 offset:32768
ds_read_b64_tr_b16 v[130:131], v12 offset:36864
M v[72:75], v[176:179], a[152:155], v[72:75]
s_add_u32 s25, s25, s3
s_lshl_b32 s3, s3, 3
s_add_u32 s26, s26, s3
M v[72:75], v[180:183], a[156:159], v[72:75]
ds_read_b64_tr_b16 v[132:133], v12 offset:40960
ds_read_b64_tr_b16 v[134:135], v12 offset:45056
M v[76:79], v[188:191], a[156:159], v[76:79]
M v[76:79], v[184:187], a[152:155], v[76:79]
ds_read_b64_tr_b16 v[136:137], v13 offset:32768
ds_read_b64_tr_b16 v[138:139], v13 offset:36864
M v[80:83], v[192:195], a[152:155], v[80:83]
ds_read_b64_tr_b16 v[140:141], v13 offset:40960
ds_read_b64_tr_b16 v[142:143], v13 offset:45056
M v[80:83], v[196:199], a[156:159], v[80:83]
ds_read_b64_tr_b16 v[144:145], v14 offset:32768
ds_read_b64_tr_b16 v[146:147], v14 offset:36864
M v[84:87], v[204:207], a[156:159], v[84:87]
ds_read_b64_tr_b16 v[148:149], v14 offset:40960
ds_read_b64_tr_b16 v[150:151], v14 offset:45056
M v[84:87], v[200:203], a[152:155], v[84:87]
ds_read_b64_tr_b16 v[152:153], v15 offset:32768
ds_read_b64_tr_b16 v[154:155], v15 offset:36864
M v[88:91], v[208:211], a[152:155], v[88:91]
ds_read_b64_tr_b16 v[156:157], v15 offset:40960
ds_read_b64_tr_b16 v[158:159], v15 offset:45056
M v[88:91], v[212:215], a[156:159], v[88:91]
M v[92:95], v[220:223], a[156:159], v[92:95]
M v[92:95], v[216:219], a[152:155], v[92:95]
s_waitcnt vmcnt(24) lgkmcnt(0)
s_barrier
M v[32:35], v[96:99], a[160:163], v[32:35]
s_add_u32 m0, s41, 114688
s_nop 0
buffer_load_dwordx4 v2, s[48:51], s26 offen offset:0 lds
M v[32:35], v[100:103], a[164:167], v[32:35]
ds_read_b64_tr_b16 v[160:161], v8 offset:49152
ds_read_b64_tr_b16 v[162:163], v8 offset:53248
M v[36:39], v[108:111], a[164:167], v[36:39]
buffer_load_dwordx4 v3, s[48:51], s26 offen offset:1024 lds
M v[36:39], v[104:107], a[160:163], v[36:39]
ds_read_b64_tr_b16 v[164:165], v8 offset:57344
ds_read_b64_tr_b16 v[166:167], v8 offset:61440
M v[40:43], v[112:115], a[160:163], v[40:43]
buffer_load_dwordx4 v4, s[48:51], s26 offen offset:2048 lds
M v[40:43], v[116:119], a[164:167], v[40:43]
ds_read_b64_tr_b16 v[168:169], v9 offset:49152
ds_read_b64_tr_b16 v[170:171], v9 offset:53248
M v[44:47], v[124:127], a[164:167], v[44:47]
buffer_load_dwordx4 v5, s[48:51], s26 offen offset:3072 lds
M v[44:47], v[120:123], a[160:163], v[44:47]
M v[48:51], v[128:131], a[160:163], v[48:51]
ds_read_b64_tr_b16 v[172:173], v9 offset:57344
ds_read_b64_tr_b16 v[174:175], v9 offset:61440
M v[48:51], v[132:135], a[164:167], v[48:51]
buffer_load_dwordx4 a[240:243], v1, s[44:47], s25 offen offset:0 sc1
M v[52:55], v[140:143], a[164:167], v[52:55]
ds_read_b64_tr_b16 v[176:177], v10 offset:49152
ds_read_b64_tr_b16 v[178:179], v10 offset:53248
M v[52:55], v[136:139], a[160:163], v[52:55]
buffer_load_dwordx4 a[244:247], v1, s[44:47], s25 offen offset:1024 sc1
M v[56:59], v[144:147], a[160:163], v[56:59]
ds_read_b64_tr_b16 v[180:181], v10 offset:57344
ds_read_b64_tr_b16 v[182:183], v10 offset:61440
M v[56:59], v[148:151], a[164:167], v[56:59]
buffer_load_dwordx4 a[248:251], v1, s[44:47], s25 offen offset:2048 sc1
M v[60:63], v[156:159], a[164:167], v[60:63]
M v[60:63], v[152:155], a[160:163], v[60:63]
ds_read_b64_tr_b16 v[184:185], v11 offset:49152
ds_read_b64_tr_b16 v[186:187], v11 offset:53248
M v[64:67], v[96:99], a[168:171], v[64:67]
buffer_load_dwordx4 a[252:255], v1, s[44:47], s25 offen offset:3072 sc1
M v[64:67], v[100:103], a[172:175], v[64:67]
ds_read_b64_tr_b16 v[188:189], v11 offset:57344
ds_read_b64_tr_b16 v[190:191], v11 offset:61440
M v[68:71], v[108:111], a[172:175], v[68:71]
s_sub_u32 s39, s39, 1
s_cmp_eq_u32 s39, 0
s_cselect_b32 s3, s64, s65
M v[68:71], v[104:107], a[168:171], v[68:71]
ds_read_b64_tr_b16 v[192:193], v12 offset:49152
ds_read_b64_tr_b16 v[194:195], v12 offset:53248
M v[72:75], v[112:115], a[168:171], v[72:75]
s_add_u32 s25, s25, s3
s_lshl_b32 s3, s3, 3
s_add_u32 s26, s26, s3
M v[72:75], v[116:119], a[172:175], v[72:75]
ds_read_b64_tr_b16 v[196:197], v12 offset:57344
ds_read_b64_tr_b16 v[198:199], v12 offset:61440
M v[76:79], v[124:127], a[172:175], v[76:79]
M v[76:79], v[120:123], a[168:171], v[76:79]
ds_read_b64_tr_b16 v[200:201], v13 offset:49152
ds_read_b64_tr_b16 v[202:203], v13 offset:53248
M v[80:83], v[128:131], a[168:171], v[80:83]
ds_read_b64_tr_b16 v[204:205], v13 offset:57344
ds_read_b64_tr_b16 v[206:207], v13 offset:61440
M v[80:83], v[132:135], a[172:175], v[80:83]
ds_read_b64_tr_b16 v[208:209], v14 offset:49152
ds_read_b64_tr_b16 v[210:211], v14 offset:53248
M v[84:87], v[140:143], a[172:175], v[84:87]
ds_read_b64_tr_b16 v[212:213], v14 offset:57344
ds_read_b64_tr_b16 v[214:215], v14 offset:61440
M v[84:87], v[136:139], a[168:171], v[84:87]
ds_read_b64_tr_b16 v[216:217], v15 offset:49152
ds_read_b64_tr_b16 v[218:219], v15 offset:53248
M v[88:91], v[144:147], a[168:171], v[88:91]
ds_read_b64_tr_b16 v[220:221], v15 offset:57344
ds_read_b64_tr_b16 v[222:223], v15 offset:61440
M v[88:91], v[148:151], a[172:175], v[88:91]
M v[92:95], v[156:159], a[172:175], v[92:95]
M v[92:95], v[152:155], a[168:171], v[92:95]
s_waitcnt vmcnt(24) lgkmcnt(0)
s_barrier
M v[32:35], v[160:163], a[176:179], v[32:35]
s_add_u32 m0, s41, 0
s_nop 0
buffer_load_dwordx4 v2, s[48:51], s26 offen offset:0 lds
M v[32:35], v[164:167], a[180:183], v[32:35]
ds_read_b64_tr_b16 v[96:97], v16 offset:0
ds_read_b64_tr_b16 v[98:99], v16 offset:4096
M v[36:39], v[172:175], a[180:183], v[36:39]
buffer_load_dwordx4 v3, s[48:51], s26 offen offset:1024 lds
M v[36:39], v[168:171], a[176:179], v[36:39]
ds_read_b64_tr_b16 v[100:101], v16 offset:8192
ds_read_b64_tr_b16 v[102:103], v16 offset:12288
M v[40:43], v[176:179], a[176:179], v[40:43]
buffer_load_dwordx4 v4, s[48:51], s26 offen offset:2048 lds
M v[40:43], v[180:183], a[180:183], v[40:43]
ds_read_b64_tr_b16 v[104:105], v17 offset:0
ds_read_b64_tr_b16 v[106:107], v17 offset:4096
M v[44:47], v[188:191], a[180:183], v[44:47]
buffer_load_dwordx4 v5, s[48:51], s26 offen offset:3072 lds
M v[44:47], v[184:187], a[176:179], v[44:47]
M v[48:51], v[192:195], a[176:179], v[48:51]
ds_read_b64_tr_b16 v[108:109], v17 offset:8192
ds_read_b64_tr_b16 v[110:111], v17 offset:12288
M v[48:51], v[196:199], a[180:183], v[48:51]
buffer_load_dwordx4 a[128:131], v1, s[44:47], s25 offen offset:0 sc1
M v[52:55], v[204:207], a[180:183], v[52:55]
ds_read_b64_tr_b16 v[112:113], v18 offset:0
ds_read_b64_tr_b16 v[114:115], v18 offset:4096
M v[52:55], v[200:203], a[176:179], v[52:55]
buffer_load_dwordx4 a[132:135], v1, s[44:47], s25 offen offset:1024 sc1
M v[56:59], v[208:211], a[176:179], v[56:59]
ds_read_b64_tr_b16 v[116:117], v18 offset:8192
ds_read_b64_tr_b16 v[118:119], v18 offset:12288
M v[56:59], v[212:215], a[180:183], v[56:59]
buffer_load_dwordx4 a[136:139], v1, s[44:47], s25 offen offset:2048 sc1
M v[60:63], v[220:223], a[180:183], v[60:63]
M v[60:63], v[216:219], a[176:179], v[60:63]
ds_read_b64_tr_b16 v[120:121], v19 offset:0
ds_read_b64_tr_b16 v[122:123], v19 offset:4096
M v[64:67], v[160:163], a[184:187], v[64:67]
buffer_load_dwordx4 a[140:143], v1, s[44:47], s25 offen offset:3072 sc1
M v[64:67], v[164:167], a[188:191], v[64:67]
ds_read_b64_tr_b16 v[124:125], v19 offset:8192
ds_read_b64_tr_b16 v[126:127], v19 offset:12288
M v[68:71], v[172:175], a[188:191], v[68:71]
s_sub_u32 s39, s39, 1
s_cmp_eq_u32 s39, 0
s_cselect_b32 s3, s64, s65
M v[68:71], v[168:171], a[184:187], v[68:71]
ds_read_b64_tr_b16 v[128:129], v20 offset:0
ds_read_b64_tr_b16 v[130:131], v20 offset:4096
M v[72:75], v[176:179], a[184:187], v[72:75]
s_add_u32 s25, s25, s3
s_lshl_b32 s3, s3, 3
s_add_u32 s26, s26, s3
M v[72:75], v[180:183], a[188:191], v[72:75]
ds_read_b64_tr_b16 v[132:133], v20 offset:8192
ds_read_b64_tr_b16 v[134:135], v20 offset:12288
M v[76:79], v[188:191], a[188:191], v[76:79]
M v[76:79], v[184:187], a[184:187], v[76:79]
ds_read_b64_tr_b16 v[136:137], v21 offset:0
ds_read_b64_tr_b16 v[138:139], v21 offset:4096
M v[80:83], v[192:195], a[184:187], v[80:83]
ds_read_b64_tr_b16 v[140:141], v21 offset:8192
ds_read_b64_tr_b16 v[142:143], v21 offset:12288
M v[80:83], v[196:199], a[188:191], v[80:83]
ds_read_b64_tr_b16 v[144:145], v22 offset:0
ds_read_b64_tr_b16 v[146:147], v22 offset:4096
M v[84:87], v[204:207], a[188:191], v[84:87]
ds_read_b64_tr_b16 v[148:149], v22 offset:8192
ds_read_b64_tr_b16 v[150:151], v22 offset:12288
M v[84:87], v[200:203], a[184:187], v[84:87]
ds_read_b64_tr_b16 v[152:153], v23 offset:0
ds_read_b64_tr_b16 v[154:155], v23 offset:4096
M v[88:91], v[208:211], a[184:187], v[88:91]
ds_read_b64_tr_b16 v[156:157], v23 offset:8192
ds_read_b64_tr_b16 v[158:159], v23 offset:12288
M v[88:91], v[212:215], a[188:191], v[88:91]
M v[92:95], v[220:223], a[188:191], v[92:95]
M v[92:95], v[216:219], a[184:187], v[92:95]
s_waitcnt vmcnt(24) lgkmcnt(0)
s_barrier
M v[32:35], v[96:99], a[192:195], v[32:35]
s_add_u32 m0, s41, 16384
s_nop 0
buffer_load_dwordx4 v2, s[48:51], s26 offen offset:0 lds
M v[32:35], v[100:103], a[196:199], v[32:35]
ds_read_b64_tr_b16 v[160:161], v16 offset:16384
ds_read_b64_tr_b16 v[162:163], v16 offset:20480
M v[36:39], v[108:111], a[196:199], v[36:39]
buffer_load_dwordx4 v3, s[48:51], s26 offen offset:1024 lds
M v[36:39], v[104:107], a[192:195], v[36:39]
ds_read_b64_tr_b16 v[164:165], v16 offset:24576
ds_read_b64_tr_b16 v[166:167], v16 offset:28672
M v[40:43], v[112:115], a[192:195], v[40:43]
buffer_load_dwordx4 v4, s[48:51], s26 offen offset:2048 lds
M v[40:43], v[116:119], a[196:199], v[40:43]
ds_read_b64_tr_b16 v[168:169], v17 offset:16384
ds_read_b64_tr_b16 v[170:171], v17 offset:20480
M v[44:47], v[124:127], a[196:199], v[44:47]
buffer_load_dwordx4 v5, s[48:51], s26 offen offset:3072 lds
M v[44:47], v[120:123], a[192:195], v[44:47]
M v[48:51], v[128:131], a[192:195], v[48:51]
ds_read_b64_tr_b16 v[172:173], v17 offset:24576
ds_read_b64_tr_b16 v[174:175], v17 offset:28672
M v[48:51], v[132:135], a[196:199], v[48:51]
buffer_load_dwordx4 a[144:147], v1, s[44:47], s25 offen offset:0 sc1
M v[52:55], v[140:143], a[196:199], v[52:55]
ds_read_b64_tr_b16 v[176:177], v18 offset:16384
ds_read_b64_tr_b16 v[178:179], v18 offset:20480
M v[52:55], v[136:139], a[192:195], v[52:55]
buffer_load_dwordx4 a[148:151], v1, s[44:47], s25 offen offset:1024 sc1
M v[56:59], v[144:147], a[192:195], v[56:59]
ds_read_b64_tr_b16 v[180:181], v18 offset:24576
ds_read_b64_tr_b16 v[182:183], v18 offset:28672
M v[56:59], v[148:151], a[196:199], v[56:59]
buffer_load_dwordx4 a[152:155], v1, s[44:47], s25 offen offset:2048 sc1
M v[60:63], v[156:159], a[196:199], v[60:63]
M v[60:63], v[152:155], a[192:195], v[60:63]
ds_read_b64_tr_b16 v[184:185], v19 offset:16384
ds_read_b64_tr_b16 v[186:187], v19 offset:20480
M v[64:67], v[96:99], a[200:203], v[64:67]
buffer_load_dwordx4 a[156:159], v1, s[44:47], s25 offen offset:3072 sc1
M v[64:67], v[100:103], a[204:207], v[64:67]
ds_read_b64_tr_b16 v[188:189], v19 offset:24576
ds_read_b64_tr_b16 v[190:191], v19 offset:28672
M v[68:71], v[108:111], a[204:207], v[68:71]
s_sub_u32 s39, s39, 1
s_cmp_eq_u32 s39, 0
s_cselect_b32 s3, s64, s65
M v[68:71], v[104:107], a[200:203], v[68:71]
ds_read_b64_tr_b16 v[192:193], v20 offset:16384
ds_read_b64_tr_b16 v[194:195], v20 offset:20480
M v[72:75], v[112:115], a[200:203], v[72:75]
s_add_u32 s25, s25, s3
s_lshl_b32 s3, s3, 3
s_add_u32 s26, s26, s3
M v[72:75], v[116:119], a[204:207], v[72:75]
ds_read_b64_tr_b16 v[196:197], v20 offset:24576
ds_read_b64_tr_b16 v[198:199], v20 offset:28672
M v[76:79], v[124:127], a[204:207], v[76:79]
M v[76:79], v[120:123], a[200:203], v[76:79]
ds_read_b64_tr_b16 v[200:201], v21 offset:16384
ds_read_b64_tr_b16 v[202:203], v21 offset:20480
M v[80:83], v[128:131], a[200:203], v[80:83]
ds_read_b64_tr_b16 v[204:205], v21 offset:24576
ds_read_b64_tr_b16 v[206:207], v21 offset:28672
M v[80:83], v[132:135], a[204:207], v[80:83]
ds_read_b64_tr_b16 v[208:209], v22 offset:16384
ds_read_b64_tr_b16 v[210:211], v22 offset:20480
M v[84:87], v[140:143], a[204:207], v[84:87]
ds_read_b64_tr_b16 v[212:213], v22 offset:24576
ds_read_b64_tr_b16 v[214:215], v22 offset:28672
M v[84:87], v[136:139], a[200:203], v[84:87]
ds_read_b64_tr_b16 v[216:217], v23 offset:16384
ds_read_b64_tr_b16 v[218:219], v23 offset:20480
M v[88:91], v[144:147], a[200:203], v[88:91]
ds_read_b64_tr_b16 v[220:221], v23 offset:24576
ds_read_b64_tr_b16 v[222:223], v23 offset:28672
M v[88:91], v[148:151], a[204:207], v[88:91]
M v[92:95], v[156:159], a[204:207], v[92:95]
M v[92:95], v[152:155], a[200:203], v[92:95]
s_sub_u32 s28, s28, 1
s_cmp_lg_u32 s28, 0
s_cbranch_scc1 Lk3_la
s_waitcnt vmcnt(24) lgkmcnt(0)
s_barrier
M v[32:35], v[160:163], a[208:211], v[32:35]
s_add_u32 m0, s41, 32768
s_nop 0
buffer_load_dwordx4 v2, s[48:51], s26 offen offset:0 lds
M v[32:35], v[164:167], a[212:215], v[32:35]
ds_read_b64_tr_b16 v[96:97], v16 offset:32768
ds_read_b64_tr_b16 v[98:99], v16 offset:36864
M v[36:39], v[172:175], a[212:215], v[36:39]
buffer_load_dwordx4 v3, s[48:51], s26 offen offset:1024 lds
M v[36:39], v[168:171], a[208:211], v[36:39]
ds_read_b64_tr_b16 v[100:101], v16 offset:40960
ds_read_b64_tr_b16 v[102:103], v16 offset:45056
M v[40:43], v[176:179], a[208:211], v[40:43]
buffer_load_dwordx4 v4, s[48:51], s26 offen offset:2048 lds
M v[40:43], v[180:183], a[212:215], v[40:43]
ds_read_b64_tr_b16 v[104:105], v17 offset:32768
ds_read_b64_tr_b16 v[106:107], v17 offset:36864
M v[44:47], v[188:191], a[212:215], v[44:47]
buffer_load_dwordx4 v5, s[48:51], s26 offen offset:3072 lds
M v[44:47], v[184:187], a[208:211], v[44:47]
M v[48:51], v[192:195], a[208:211], v[48:51]
ds_read_b64_tr_b16 v[108:109], v17 offset:40960
ds_read_b64_tr_b16 v[110:111], v17 offset:45056
M v[48:51], v[196:199], a[212:215], v[48:51]
buffer_load_dwordx4 a[160:163], v1, s[44:47], s25 offen offset:0 sc1
M v[52:55], v[204:207], a[212:215], v[52:55]
ds_read_b64_tr_b16 v[112:113], v18 offset:32768
ds_read_b64_tr_b16 v[114:115], v18 offset:36864
M v[52:55], v[200:203], a[208:211], v[52:55]
buffer_load_dwordx4 a[164:167], v1, s[44:47], s25 offen offset:1024 sc1
M v[56:59], v[208:211], a[208:211], v[56:59]
ds_read_b64_tr_b16 v[116:117], v18 offset:40960
ds_read_b64_tr_b16 v[118:119], v18 offset:45056
M v[56:59], v[212:215], a[212:215], v[56:59]
buffer_load_dwordx4 a[168:171], v1, s[44:47], s25 offen offset:2048 sc1
M v[60:63], v[220:223], a[212:215], v[60:63]
M v[60:63], v[216:219], a[208:211], v[60:63]
ds_read_b64_tr_b16 v[120:121], v19 offset:32768
ds_read_b64_tr_b16 v[122:123], v19 offset:36864
M v[64:67], v[160:163], a[216:219], v[64:67]
buffer_load_dwordx4 a[172:175], v1, s[44:47], s25 offen offset:3072 sc1
M v[64:67], v[164:167], a[220:223], v[64:67]
ds_read_b64_tr_b16 v[124:125], v19 offset:40960
ds_read_b64_tr_b16 v[126:127], v19 offset:45056
M v[68:71], v[172:175], a[220:223], v[68:71]
s_sub_u32 s39, s39, 1
s_cmp_eq_u32 s39, 0
s_cselect_b32 s3, s64, s65
M v[68:71], v[168:171], a[216:219], v[68:71]
ds_read_b64_tr_b16 v[128:129], v20 offset:32768
ds_read_b64_tr_b16 v[130:131], v20 offset:36864
M v[72:75], v[176:179], a[216:219], v[72:75]
s_add_u32 s25, s25, s3
s_lshl_b32 s3, s3, 3
s_add_u32 s26, s26, s3
M v[72:75], v[180:183], a[220:223], v[72:75]
ds_read_b64_tr_b16 v[132:133], v20 offset:40960
ds_read_b64_tr_b16 v[134:135], v20 offset:45056
M v[76:79], v[188:191], a[220:223], v[76:79]
M v[76:79], v[184:187], a[216:219], v[76:79]
ds_read_b64_tr_b16 v[136:137], v21 offset:32768
ds_read_b64_tr_b16 v[138:139], v21 offset:36864
M v[80:83], v[192:195], a[216:219], v[80:83]
ds_read_b64_tr_b16 v[140:141], v21 offset:40960
ds_read_b64_tr_b16 v[142:143], v21 offset:45056
M v[80:83], v[196:199], a[220:223], v[80:83]
ds_read_b64_tr_b16 v[144:145], v22 offset:32768
ds_read_b64_tr_b16 v[146:147], v22 offset:36864
M v[84:87], v[204:207], a[220:223], v[84:87]
ds_read_b64_tr_b16 v[148:149], v22 offset:40960
ds_read_b64_tr_b16 v[150:151], v22 offset:45056
M v[84:87], v[200:203], a[216:219], v[84:87]
ds_read_b64_tr_b16 v[152:153], v23 offset:32768
ds_read_b64_tr_b16 v[154:155], v23 offset:36864
M v[88:91], v[208:211], a[216:219], v[88:91]
ds_read_b64_tr_b16 v[156:157], v23 offset:40960
ds_read_b64_tr_b16 v[158:159], v23 offset:45056
M v[88:91], v[212:215], a[220:223], v[88:91]
M v[92:95], v[220:223], a[220:223], v[92:95]
M v[92:95], v[216:219], a[216:219], v[92:95]
s_waitcnt vmcnt(24) lgkmcnt(0)
s_barrier
M v[32:35], v[96:99], a[224:227], v[32:35]
s_add_u32 m0, s41, 49152
s_nop 0
buffer_load_dwordx4 v2, s[48:51], s26 offen offset:0 lds
M v[32:35], v[100:103], a[228:231], v[32:35]
ds_read_b64_tr_b16 v[160:161], v16 offset:49152
ds_read_b64_tr_b16 v[162:163], v16 offset:53248
M v[36:39], v[108:111], a[228:231], v[36:39]
buffer_load_dwordx4 v3, s[48:51], s26 offen offset:1024 lds
M v[36:39], v[104:107], a[224:227], v[36:39]
ds_read_b64_tr_b16 v[164:165], v16 offset:57344
ds_read_b64_tr_b16 v[166:167], v16 offset:61440
M v[40:43], v[112:115], a[224:227], v[40:43]
buffer_load_dwordx4 v4, s[48:51], s26 offen offset:2048 lds
M v[40:43], v[116:119], a[228:231], v[40:43]
ds_read_b64_tr_b16 v[168:169], v17 offset:49152
ds_read_b64_tr_b16 v[170:171], v17 offset:53248
M v[44:47], v[124:127], a[228:231], v[44:47]
buffer_load_dwordx4 v5, s[48:51], s26 offen offset:3072 lds
M v[44:47], v[120:123], a[224:227], v[44:47]
M v[48:51], v[128:131], a[224:227], v[48:51]
ds_read_b64_tr_b16 v[172:173], v17 offset:57344
ds_read_b64_tr_b16 v[174:175], v17 offset:61440
M v[48:51], v[132:135], a[228:231], v[48:51]
buffer_load_dwordx4 a[176:179], v1, s[44:47], s25 offen offset:0 sc1
M v[52:55], v[140:143], a[228:231], v[52:55]
ds_read_b64_tr_b16 v[176:177], v18 offset:49152
ds_read_b64_tr_b16 v[178:179], v18 offset:53248
M v[52:55], v[136:139], a[224:227], v[52:55]
buffer_load_dwordx4 a[180:183], v1, s[44:47], s25 offen offset:1024 sc1
M v[56:59], v[144:147], a[224:227], v[56:59]
ds_read_b64_tr_b16 v[180:181], v18 offset:57344
ds_read_b64_tr_b16 v[182:183], v18 offset:61440
M v[56:59], v[148:151], a[228:231], v[56:59]
buffer_load_dwordx4 a[184:187], v1, s[44:47], s25 offen offset:2048 sc1
M v[60:63], v[156:159], a[228:231], v[60:63]
M v[60:63], v[152:155], a[224:227], v[60:63]
ds_read_b64_tr_b16 v[184:185], v19 offset:49152
ds_read_b64_tr_b16 v[186:187], v19 offset:53248
M v[64:67], v[96:99], a[232:235], v[64:67]
buffer_load_dwordx4 a[188:191], v1, s[44:47], s25 offen offset:3072 sc1
M v[64:67], v[100:103], a[236:239], v[64:67]
ds_read_b64_tr_b16 v[188:189], v19 offset:57344
ds_read_b64_tr_b16 v[190:191], v19 offset:61440
M v[68:71], v[108:111], a[236:239], v[68:71]
s_sub_u32 s39, s39, 1
s_cmp_eq_u32 s39, 0
s_cselect_b32 s3, s64, s65
M v[68:71], v[104:107], a[232:235], v[68:71]
ds_read_b64_tr_b16 v[192:193], v20 offset:49152
ds_read_b64_tr_b16 v[194:195], v20 offset:53248
M v[72:75], v[112:115], a[232:235], v[72:75]
s_add_u32 s25, s25, s3
s_lshl_b32 s3, s3, 3
s_add_u32 s26, s26, s3
M v[72:75], v[116:119], a[236:239], v[72:75]
ds_read_b64_tr_b16 v[196:197], v20 offset:57344
ds_read_b64_tr_b16 v[198:199], v20 offset:61440
M v[76:79], v[124:127], a[236:239], v[76:79]
M v[76:79], v[120:123], a[232:235], v[76:79]
ds_read_b64_tr_b16 v[200:201], v21 offset:49152
ds_read_b64_tr_b16 v[202:203], v21 offset:53248
M v[80:83], v[128:131], a[232:235], v[80:83]
ds_read_b64_tr_b16 v[204:205], v21 offset:57344
ds_read_b64_tr_b16 v[206:207], v21 offset:61440
M v[80:83], v[132:135], a[236:239], v[80:83]
ds_read_b64_tr_b16 v[208:209], v22 offset:49152
ds_read_b64_tr_b16 v[210:211], v22 offset:53248
M v[84:87], v[140:143], a[236:239], v[84:87]
ds_read_b64_tr_b16 v[212:213], v22 offset:57344
ds_read_b64_tr_b16 v[214:215], v22 offset:61440
M v[84:87], v[136:139], a[232:235], v[84:87]
ds_read_b64_tr_b16 v[216:217], v23 offset:49152
ds_read_b64_tr_b16 v[218:219], v23 offset:53248
M v[88:91], v[144:147], a[232:235], v[88:91]
ds_read_b64_tr_b16 v[220:221], v23 offset:57344
ds_read_b64_tr_b16 v[222:223], v23 offset:61440
M v[88:91], v[148:151], a[236:239], v[88:91]
M v[92:95], v[156:159], a[236:239], v[92:95]
M v[92:95], v[152:155], a[232:235], v[92:95]
s_waitcnt vmcnt(24) lgkmcnt(0)
s_barrier
M v[32:35], v[160:163], a[240:243], v[32:35]
s_mov_b64 s[44:45], s[34:35]
s_mov_b32 s46, 4194304
s_mov_b64 s[48:49], s[36:37]
s_mov_b32 s50, 2097152
s_mov_b32 s25, s32
s_mov_b32 s26, s33
s_add_u32 m0, s42, 65536
s_nop 0
buffer_load_dwordx4 v6, s[48:51], s26 offen offset:0 lds
M v[32:35], v[164:167], a[244:247], v[32:35]
ds_read_b64_tr_b16 v[96:97], v8 offset:0
ds_read_b64_tr_b16 v[98:99], v8 offset:4096
M v[36:39], v[172:175], a[244:247], v[36:39]
buffer_load_dwordx4 v7, s[48:51], s26 offen offset:1024 lds
M v[36:39], v[168:171], a[240:243], v[36:39]
ds_read_b64_tr_b16 v[100:101], v8 offset:8192
ds_read_b64_tr_b16 v[102:103], v8 offset:12288
M v[40:43], v[176:179], a[240:243], v[40:43]
M v[40:43], v[180:183], a[244:247], v[40:43]
buffer_load_dwordx4 a[192:195], v1, s[44:47], s25 offen offset:0 sc1
M v[44:47], v[188:191], a[244:247], v[44:47]
ds_read_b64_tr_b16 v[104:105], v9 offset:0
ds_read_b64_tr_b16 v[106:107], v9 offset:4096
M v[44:47], v[184:187], a[240:243], v[44:47]
buffer_load_dwordx4 a[196:199], v1, s[44:47], s25 offen offset:1024 sc1
M v[48:51], v[192:195], a[240:243], v[48:51]
M v[48:51], v[196:199], a[244:247], v[48:51]
ds_read_b64_tr_b16 v[108:109], v9 offset:8192
ds_read_b64_tr_b16 v[110:111], v9 offset:12288
M v[52:55], v[204:207], a[244:247], v[52:55]
buffer_load_dwordx4 a[200:203], v1, s[44:47], s25 offen offset:2048 sc1
M v[52:55], v[200:203], a[240:243], v[52:55]
ds_read_b64_tr_b16 v[112:113], v10 offset:0
ds_read_b64_tr_b16 v[114:115], v10 offset:4096
M v[56:59], v[208:211], a[240:243], v[56:59]
M v[56:59], v[212:215], a[244:247], v[56:59]
buffer_load_dwordx4 a[204:207], v1, s[44:47], s25 offen offset:3072 sc1
M v[60:63], v[220:223], a[244:247], v[60:63]
ds_read_b64_tr_b16 v[116:117], v10 offset:8192
ds_read_b64_tr_b16 v[118:119], v10 offset:12288
M v[60:63], v[216:219], a[240:243], v[60:63]
s_add_u32 s25, s25, 16384
s_add_u32 s26, s26, 131072
M v[64:67], v[160:163], a[248:251], v[64:67]
ds_read_b64_tr_b16 v[120:121], v11 offset:0
ds_read_b64_tr_b16 v[122:123], v11 offset:4096
M v[64:67], v[164:167], a[252:255], v[64:67]
M v[68:71], v[172:175], a[252:255], v[68:71]
ds_read_b64_tr_b16 v[124:125], v11 offset:8192
ds_read_b64_tr_b16 v[126:127], v11 offset:12288
M v[68:71], v[168:171], a[248:251], v[68:71]
ds_read_b64_tr_b16 v[128:129], v12 offset:0
ds_read_b64_tr_b16 v[130:131], v12 offset:4096
M v[72:75], v[176:179], a[248:251], v[72:75]
ds_read_b64_tr_b16 v[132:133], v12 offset:8192
ds_read_b64_tr_b16 v[134:135], v12 offset:12288
M v[72:75], v[180:183], a[252:255], v[72:75]
M v[76:79], v[188:191], a[252:255], v[76:79]
ds_read_b64_tr_b16 v[136:137], v13 offset:0
ds_read_b64_tr_b16 v[138:139], v13 offset:4096
M v[76:79], v[184:187], a[248:251], v[76:79]
ds_read_b64_tr_b16 v[140:141], v13 offset:8192
ds_read_b64_tr_b16 v[142:143], v13 offset:12288
M v[80:83], v[192:195], a[248:251], v[80:83]
ds_read_b64_tr_b16 v[144:145], v14 offset:0
ds_read_b64_tr_b16 v[146:147], v14 offset:4096
M v[80:83], v[196:199], a[252:255], v[80:83]
M v[84:87], v[204:207], a[252:255], v[84:87]
ds_read_b64_tr_b16 v[148:149], v14 offset:8192
ds_read_b64_tr_b16 v[150:151], v14 offset:12288
M v[84:87], v[200:203], a[248:251], v[84:87]
ds_read_b64_tr_b16 v[152:153], v15 offset:0
ds_read_b64_tr_b16 v[154:155], v15 offset:4096
M v[88:91], v[208:211], a[248:251], v[88:91]
ds_read_b64_tr_b16 v[156:157], v15 offset:8192
ds_read_b64_tr_b16 v[158:159], v15 offset:12288
M v[88:91], v[212:215], a[252:255], v[88:91]
M v[92:95], v[220:223], a[252:255], v[92:95]
M v[92:95], v[216:219], a[248:251], v[92:95]
s_waitcnt vmcnt(22) lgkmcnt(0)
s_barrier
M v[32:35], v[96:99], a[128:131], v[32:35]
s_add_u32 m0, s42, 81920
s_nop 0
buffer_load_dwordx4 v6, s[48:51], s26 offen offset:0 lds
M v[32:35], v[100:103], a[132:135], v[32:35]
ds_read_b64_tr_b16 v[160:161], v8 offset:16384
ds_read_b64_tr_b16 v[162:163], v8 offset:20480
M v[36:39], v[108:111], a[132:135], v[36:39]
buffer_load_dwordx4 v7, s[48:51], s26 offen offset:1024 lds
M v[36:39], v[104:107], a[128:131], v[36:39]
ds_read_b64_tr_b16 v[164:165], v8 offset:24576
ds_read_b64_tr_b16 v[166:167], v8 offset:28672
M v[40:43], v[112:115], a[128:131], v[40:43]
M v[40:43], v[116:119], a[132:135], v[40:43]
buffer_load_dwordx4 a[208:211], v1, s[44:47], s25 offen offset:0 sc1
M v[44:47], v[124:127], a[132:135], v[44:47]
ds_read_b64_tr_b16 v[168:169], v9 offset:16384
ds_read_b64_tr_b16 v[170:171], v9 offset:20480
M v[44:47], v[120:123], a[128:131], v[44:47]
buffer_load_dwordx4 a[212:215], v1, s[44:47], s25 offen offset:1024 sc1
M v[48:51], v[128:131], a[128:131], v[48:51]
M v[48:51], v[132:135], a[132:135], v[48:51]
ds_read_b64_tr_b16 v[172:173], v9 offset:24576
ds_read_b64_tr_b16 v[174:175], v9 offset:28672
M v[52:55], v[140:143], a[132:135], v[52:55]
buffer_load_dwordx4 a[216:219], v1, s[44:47], s25 offen offset:2048 sc1
M v[52:55], v[136:139], a[128:131], v[52:55]
ds_read_b64_tr_b16 v[176:177], v10 offset:16384
ds_read_b64_tr_b16 v[178:179], v10 offset:20480
M v[56:59], v[144:147], a[128:131], v[56:59]
M v[56:59], v[148:151], a[132:135], v[56:59]
buffer_load_dwordx4 a[220:223], v1, s[44:47], s25 offen offset:3072 sc1
M v[60:63], v[156:159], a[132:135], v[60:63]
ds_read_b64_tr_b16 v[180:181], v10 offset:24576
ds_read_b64_tr_b16 v[182:183], v10 offset:28672
M v[60:63], v[152:155], a[128:131], v[60:63]
s_add_u32 s25, s25, 16384
s_add_u32 s26, s26, 131072
M v[64:67], v[96:99], a[136:139], v[64:67]
ds_read_b64_tr_b16 v[184:185], v11 offset:16384
ds_read_b64_tr_b16 v[186:187], v11 offset:20480
M v[64:67], v[100:103], a[140:143], v[64:67]
M v[68:71], v[108:111], a[140:143], v[68:71]
ds_read_b64_tr_b16 v[188:189], v11 offset:24576
ds_read_b64_tr_b16 v[190:191], v11 offset:28672
M v[68:71], v[104:107], a[136:139], v[68:71]
ds_read_b64_tr_b16 v[192:193], v12 offset:16384
ds_read_b64_tr_b16 v[194:195], v12 offset:20480
M v[72:75], v[112:115], a[136:139], v[72:75]
ds_read_b64_tr_b16 v[196:197], v12 offset:24576
ds_read_b64_tr_b16 v[198:199], v12 offset:28672
M v[72:75], v[116:119], a[140:143], v[72:75]
M v[76:79], v[124:127], a[140:143], v[76:79]
ds_read_b64_tr_b16 v[200:201], v13 offset:16384
ds_read_b64_tr_b16 v[202:203], v13 offset:20480
M v[76:79], v[120:123], a[136:139], v[76:79]
ds_read_b64_tr_b16 v[204:205], v13 offset:24576
ds_read_b64_tr_b16 v[206:207], v13 offset:28672
M v[80:83], v[128:131], a[136:139], v[80:83]
ds_read_b64_tr_b16 v[208:209], v14 offset:16384
ds_read_b64_tr_b16 v[210:211], v14 offset:20480
M v[80:83], v[132:135], a[140:143], v[80:83]
M v[84:87], v[140:143], a[140:143], v[84:87]
ds_read_b64_tr_b16 v[212:213], v14 offset:24576
ds_read_b64_tr_b16 v[214:215], v14 offset:28672
M v[84:87], v[136:139], a[136:139], v[84:87]
ds_read_b64_tr_b16 v[216:217], v15 offset:16384
ds_read_b64_tr_b16 v[218:219], v15 offset:20480
M v[88:91], v[144:147], a[136:139], v[88:91]
ds_read_b64_tr_b16 v[220:221], v15 offset:24576
ds_read_b64_tr_b16 v[222:223], v15 offset:28672
M v[88:91], v[148:151], a[140:143], v[88:91]
M v[92:95], v[156:159], a[140:143], v[92:95]
M v[92:95], v[152:155], a[136:139], v[92:95]
s_waitcnt vmcnt(20) lgkmcnt(0)
s_barrier
M v[32:35], v[160:163], a[144:147], v[32:35]
s_add_u32 m0, s42, 98304
s_nop 0
buffer_load_dwordx4 v6, s[48:51], s26 offen offset:0 lds
M v[32:35], v[164:167], a[148:151], v[32:35]
ds_read_b64_tr_b16 v[96:97], v8 offset:32768
ds_read_b64_tr_b16 v[98:99], v8 offset:36864
M v[36:39], v[172:175], a[148:151], v[36:39]
buffer_load_dwordx4 v7, s[48:51], s26 offen offset:1024 lds
M v[36:39], v[168:171], a[144:147], v[36:39]
ds_read_b64_tr_b16 v[100:101], v8 offset:40960
ds_read_b64_tr_b16 v[102:103], v8 offset:45056
M v[40:43], v[176:179], a[144:147], v[40:43]
M v[40:43], v[180:183], a[148:151], v[40:43]
buffer_load_dwordx4 a[224:227], v1, s[44:47], s25 offen offset:0 sc1
M v[44:47], v[188:191], a[148:151], v[44:47]
ds_read_b64_tr_b16 v[104:105], v9 offset:32768
ds_read_b64_tr_b16 v[106:107], v9 offset:36864
M v[44:47], v[184:187], a[144:147], v[44:47]
buffer_load_dwordx4 a[228:231], v1, s[44:47], s25 offen offset:1024 sc1
M v[48:51], v[192:195], a[144:147], v[48:51]
M v[48:51], v[196:199], a[148:151], v[48:51]
ds_read_b64_tr_b16 v[108:109], v9 offset:40960
ds_read_b64_tr_b16 v[110:111], v9 offset:45056
M v[52:55], v[204:207], a[148:151], v[52:55]
buffer_load_dwordx4 a[232:235], v1, s[44:47], s25 offen offset:2048 sc1
M v[52:55], v[200:203], a[144:147], v[52:55]
ds_read_b64_tr_b16 v[112:113], v10 offset:32768
ds_read_b64_tr_b16 v[114:115], v10 offset:36864
M v[56:59], v[208:211], a[144:147], v[56:59]
M v[56:59], v[212:215], a[148:151], v[56:59]
buffer_load_dwordx4 a[236:239], v1, s[44:47], s25 offen offset:3072 sc1
M v[60:63], v[220:223], a[148:151], v[60:63]
ds_read_b64_tr_b16 v[116:117], v10 offset:40960
ds_read_b64_tr_b16 v[118:119], v10 offset:45056
M v[60:63], v[216:219], a[144:147], v[60:63]
s_add_u32 s25, s25, 16384
s_add_u32 s26, s26, 131072
M v[64:67], v[160:163], a[152:155], v[64:67]
ds_read_b64_tr_b16 v[120:121], v11 offset:32768
ds_read_b64_tr_b16 v[122:123], v11 offset:36864
M v[64:67], v[164:167], a[156:159], v[64:67]
M v[68:71], v[172:175], a[156:159], v[68:71]
ds_read_b64_tr_b16 v[124:125], v11 offset:40960
ds_read_b64_tr_b16 v[126:127], v11 offset:45056
M v[68:71], v[168:171], a[152:155], v[68:71]
ds_read_b64_tr_b16 v[128:129], v12 offset:32768
ds_read_b64_tr_b16 v[130:131], v12 offset:36864
M v[72:75], v[176:179], a[152:155], v[72:75]
ds_read_b64_tr_b16 v[132:133], v12 offset:40960
ds_read_b64_tr_b16 v[134:135], v12 offset:45056
M v[72:75], v[180:183], a[156:159], v[72:75]
M v[76:79], v[188:191], a[156:159], v[76:79]
ds_read_b64_tr_b16 v[136:137], v13 offset:32768
ds_read_b64_tr_b16 v[138:139], v13 offset:36864
M v[76:79], v[184:187], a[152:155], v[76:79]
ds_read_b64_tr_b16 v[140:141], v13 offset:40960
ds_read_b64_tr_b16 v[142:143], v13 offset:45056
M v[80:83], v[192:195], a[152:155], v[80:83]
ds_read_b64_tr_b16 v[144:145], v14 offset:32768
ds_read_b64_tr_b16 v[146:147], v14 offset:36864
M v[80:83], v[196:199], a[156:159], v[80:83]
M v[84:87], v[204:207], a[156:159], v[84:87]
ds_read_b64_tr_b16 v[148:149], v14 offset:40960
ds_read_b64_tr_b16 v[150:151], v14 offset:45056
M v[84:87], v[200:203], a[152:155], v[84:87]
ds_read_b64_tr_b16 v[152:153], v15 offset:32768
ds_read_b64_tr_b16 v[154:155], v15 offset:36864
M v[88:91], v[208:211], a[152:155], v[88:91]
ds_read_b64_tr_b16 v[156:157], v15 offset:40960
ds_read_b64_tr_b16 v[158:159], v15 offset:45056
M v[88:91], v[212:215], a[156:159], v[88:91]
M v[92:95], v[220:223], a[156:159], v[92:95]
M v[92:95], v[216:219], a[152:155], v[92:95]
s_waitcnt vmcnt(18) lgkmcnt(0)
s_barrier
M v[32:35], v[96:99], a[160:163], v[32:35]
s_add_u32 m0, s42, 114688
s_nop 0
buffer_load_dwordx4 v6, s[48:51], s26 offen offset:0 lds
M v[32:35], v[100:103], a[164:167], v[32:35]
ds_read_b64_tr_b16 v[160:161], v8 offset:49152
ds_read_b64_tr_b16 v[162:163], v8 offset:53248
M v[36:39], v[108:111], a[164:167], v[36:39]
buffer_load_dwordx4 v7, s[48:51], s26 offen offset:1024 lds
M v[36:39], v[104:107], a[160:163], v[36:39]
ds_read_b64_tr_b16 v[164:165], v8 offset:57344
ds_read_b64_tr_b16 v[166:167], v8 offset:61440
M v[40:43], v[112:115], a[160:163], v[40:43]
M v[40:43], v[116:119], a[164:167], v[40:43]
buffer_load_dwordx4 a[240:243], v1, s[44:47], s25 offen offset:0 sc1
M v[44:47], v[124:127], a[164:167], v[44:47]
ds_read_b64_tr_b16 v[168:169], v9 offset:49152
ds_read_b64_tr_b16 v[170:171], v9 offset:53248
M v[44:47], v[120:123], a[160:163], v[44:47]
buffer_load_dwordx4 a[244:247], v1, s[44:47], s25 offen offset:1024 sc1
M v[48:51], v[128:131], a[160:163], v[48:51]
M v[48:51], v[132:135], a[164:167], v[48:51]
ds_read_b64_tr_b16 v[172:173], v9 offset:57344
ds_read_b64_tr_b16 v[174:175], v9 offset:61440
M v[52:55], v[140:143], a[164:167], v[52:55]
buffer_load_dwordx4 a[248:251], v1, s[44:47], s25 offen offset:2048 sc1
M v[52:55], v[136:139], a[160:163], v[52:55]
ds_read_b64_tr_b16 v[176:177], v10 offset:49152
ds_read_b64_tr_b16 v[178:179], v10 offset:53248
M v[56:59], v[144:147], a[160:163], v[56:59]
M v[56:59], v[148:151], a[164:167], v[56:59]
buffer_load_dwordx4 a[252:255], v1, s[44:47], s25 offen offset:3072 sc1
M v[60:63], v[156:159], a[164:167], v[60:63]
ds_read_b64_tr_b16 v[180:181], v10 offset:57344
ds_read_b64_tr_b16 v[182:183], v10 offset:61440
M v[60:63], v[152:155], a[160:163], v[60:63]
s_add_u32 s25, s25, 16384
s_add_u32 s26, s26, 131072
M v[64:67], v[96:99], a[168:171], v[64:67]
ds_read_b64_tr_b16 v[184:185], v11 offset:49152
ds_read_b64_tr_b16 v[186:187], v11 offset:53248
M v[64:67], v[100:103], a[172:175], v[64:67]
M v[68:71], v[108:111], a[172:175], v[68:71]
ds_read_b64_tr_b16 v[188:189], v11 offset:57344
ds_read_b64_tr_b16 v[190:191], v11 offset:61440
M v[68:71], v[104:107], a[168:171], v[68:71]
ds_read_b64_tr_b16 v[192:193], v12 offset:49152
ds_read_b64_tr_b16 v[194:195], v12 offset:53248
M v[72:75], v[112:115], a[168:171], v[72:75]
ds_read_b64_tr_b16 v[196:197], v12 offset:57344
ds_read_b64_tr_b16 v[198:199], v12 offset:61440
M v[72:75], v[116:119], a[172:175], v[72:75]
M v[76:79], v[124:127], a[172:175], v[76:79]
ds_read_b64_tr_b16 v[200:201], v13 offset:49152
ds_read_b64_tr_b16 v[202:203], v13 offset:53248
M v[76:79], v[120:123], a[168:171], v[76:79]
ds_read_b64_tr_b16 v[204:205], v13 offset:57344
ds_read_b64_tr_b16 v[206:207], v13 offset:61440
M v[80:83], v[128:131], a[168:171], v[80:83]
ds_read_b64_tr_b16 v[208:209], v14 offset:49152
ds_read_b64_tr_b16 v[210:211], v14 offset:53248
M v[80:83], v[132:135], a[172:175], v[80:83]
M v[84:87], v[140:143], a[172:175], v[84:87]
ds_read_b64_tr_b16 v[212:213], v14 offset:57344
ds_read_b64_tr_b16 v[214:215], v14 offset:61440
M v[84:87], v[136:139], a[168:171], v[84:87]
ds_read_b64_tr_b16 v[216:217], v15 offset:49152
ds_read_b64_tr_b16 v[218:219], v15 offset:53248
M v[88:91], v[144:147], a[168:171], v[88:91]
ds_read_b64_tr_b16 v[220:221], v15 offset:57344
ds_read_b64_tr_b16 v[222:223], v15 offset:61440
M v[88:91], v[148:151], a[172:175], v[88:91]
M v[92:95], v[156:159], a[172:175], v[92:95]
M v[92:95], v[152:155], a[168:171], v[92:95]
s_waitcnt vmcnt(18) lgkmcnt(0)
s_barrier
M v[32:35], v[160:163], a[176:179], v[32:35]
s_add_u32 m0, s42, 0
s_nop 0
buffer_load_dwordx4 v6, s[48:51], s26 offen offset:0 lds
M v[32:35], v[164:167], a[180:183], v[32:35]
M v[36:39], v[172:175], a[180:183], v[36:39]
ds_read_b64_tr_b16 v[96:97], v28 offset:0
ds_read_b64_tr_b16 v[98:99], v28 offset:2048
M v[36:39], v[168:171], a[176:179], v[36:39]
M v[40:43], v[176:179], a[176:179], v[40:43]
buffer_load_dwordx4 v7, s[48:51], s26 offen offset:1024 lds
M v[40:43], v[180:183], a[180:183], v[40:43]
M v[44:47], v[188:191], a[180:183], v[44:47]
ds_read_b64_tr_b16 v[100:101], v28 offset:4096
ds_read_b64_tr_b16 v[102:103], v28 offset:6144
M v[44:47], v[184:187], a[176:179], v[44:47]
M v[48:51], v[192:195], a[176:179], v[48:51]
buffer_load_dwordx4 a[128:131], v1, s[44:47], s25 offen offset:0 sc1
M v[48:51], v[196:199], a[180:183], v[48:51]
M v[52:55], v[204:207], a[180:183], v[52:55]
ds_read_b64_tr_b16 v[104:105], v29 offset:0
ds_read_b64_tr_b16 v[106:107], v29 offset:2048
M v[52:55], v[200:203], a[176:179], v[52:55]
M v[56:59], v[208:211], a[176:179], v[56:59]
buffer_load_dwordx4 a[132:135], v1, s[44:47], s25 offen offset:1024 sc1
M v[56:59], v[212:215], a[180:183], v[56:59]
M v[60:63], v[220:223], a[180:183], v[60:63]
ds_read_b64_tr_b16 v[108:109], v29 offset:4096
ds_read_b64_tr_b16 v[110:111], v29 offset:6144
M v[60:63], v[216:219], a[176:179], v[60:63]
M v[64:67], v[160:163], a[184:187], v[64:67]
buffer_load_dwordx4 a[136:139], v1, s[44:47], s25 offen offset:2048 sc1
M v[64:67], v[164:167], a[188:191], v[64:67]
M v[68:71], v[172:175], a[188:191], v[68:71]
ds_read_b64_tr_b16 v[112:113], v30 offset:0
ds_read_b64_tr_b16 v[114:115], v30 offset:2048
M v[68:71], v[168:171], a[184:187], v[68:71]
M v[72:75], v[176:179], a[184:187], v[72:75]
buffer_load_dwordx4 a[140:143], v1, s[44:47], s25 offen offset:3072 sc1
M v[72:75], v[180:183], a[188:191], v[72:75]
M v[76:79], v[188:191], a[188:191], v[76:79]
ds_read_b64_tr_b16 v[116:117], v30 offset:4096
ds_read_b64_tr_b16 v[118:119], v30 offset:6144
M v[76:79], v[184:187], a[184:187], v[76:79]
M v[80:83], v[192:195], a[184:187], v[80:83]
s_add_u32 s25, s25, 16384
s_add_u32 s26, s26, 131072
M v[80:83], v[196:199], a[188:191], v[80:83]
M v[84:87], v[204:207], a[188:191], v[84:87]
ds_read_b64_tr_b16 v[120:121], v31 offset:0
ds_read_b64_tr_b16 v[122:123], v31 offset:2048
M v[84:87], v[200:203], a[184:187], v[84:87]
M v[88:91], v[208:211], a[184:187], v[88:91]
ds_read_b64_tr_b16 v[124:125], v31 offset:4096
ds_read_b64_tr_b16 v[126:127], v31 offset:6144
M v[88:91], v[212:215], a[188:191], v[88:91]
M v[92:95], v[220:223], a[188:191], v[92:95]
M v[92:95], v[216:219], a[184:187], v[92:95]
s_waitcnt vmcnt(18) lgkmcnt(0)
s_barrier
M a[0:3], v[96:99], a[192:195], a[0:3]
s_add_u32 m0, s42, 16384
s_nop 0
buffer_load_dwordx4 v6, s[48:51], s26 offen offset:0 lds
ds_read_b64_tr_b16 v[160:161], v28 offset:16384
ds_read_b64_tr_b16 v[162:163], v28 offset:18432
M a[0:3], v[100:103], a[196:199], a[0:3]
buffer_load_dwordx4 v7, s[48:51], s26 offen offset:1024 lds
ds_read_b64_tr_b16 v[164:165], v28 offset:20480
ds_read_b64_tr_b16 v[166:167], v28 offset:22528
M a[4:7], v[108:111], a[196:199], a[4:7]
buffer_load_dwordx4 a[144:147], v1, s[44:47], s25 offen offset:0 sc1
ds_read_b64_tr_b16 v[168:169], v29 offset:16384
ds_read_b64_tr_b16 v[170:171], v29 offset:18432
M a[4:7], v[104:107], a[192:195], a[4:7]
buffer_load_dwordx4 a[148:151], v1, s[44:47], s25 offen offset:1024 sc1
M a[8:11], v[112:115], a[192:195], a[8:11]
ds_read_b64_tr_b16 v[172:173], v29 offset:20480
ds_read_b64_tr_b16 v[174:175], v29 offset:22528
buffer_load_dwordx4 a[152:155], v1, s[44:47], s25 offen offset:2048 sc1
M a[8:11], v[116:119], a[196:199], a[8:11]
ds_read_b64_tr_b16 v[176:177], v30 offset:16384
ds_read_b64_tr_b16 v[178:179], v30 offset:18432
buffer_load_dwordx4 a[156:159], v1, s[44:47], s25 offen offset:3072 sc1
M a[12:15], v[124:127], a[196:199], a[12:15]
ds_read_b64_tr_b16 v[180:181], v30 offset:20480
ds_read_b64_tr_b16 v[182:183], v30 offset:22528
M a[12:15], v[120:123], a[192:195], a[12:15]
s_add_u32 s25, s25, 16384
s_add_u32 s26, s26, 131072
ds_read_b64_tr_b16 v[184:185], v31 offset:16384
ds_read_b64_tr_b16 v[186:187], v31 offset:18432
M a[16:19], v[96:99], a[200:203], a[16:19]
s_add_u32 s60, s56, 0
buffer_store_dwordx4 v[48:51], v1, s[52:55], s60 offen offset:0 sc1
ds_read_b64_tr_b16 v[188:189], v31 offset:20480
ds_read_b64_tr_b16 v[190:191], v31 offset:22528
M a[16:19], v[100:103], a[204:207], a[16:19]
buffer_store_dwordx4 v[52:55], v1, s[52:55], s60 offen offset:1024 sc1
buffer_store_dwordx4 v[56:59], v1, s[52:55], s60 offen offset:2048 sc1
M a[20:23], v[108:111], a[204:207], a[20:23]
buffer_store_dwordx4 v[60:63], v1, s[52:55], s60 offen offset:3072 sc1
M a[20:23], v[104:107], a[200:203], a[20:23]
s_add_u32 s60, s56, 4096
buffer_store_dwordx4 v[80:83], v1, s[52:55], s60 offen offset:0 sc1
buffer_store_dwordx4 v[84:87], v1, s[52:55], s60 offen offset:1024 sc1
M a[24:27], v[112:115], a[200:203], a[24:27]
buffer_store_dwordx4 v[88:91], v1, s[52:55], s60 offen offset:2048 sc1
buffer_store_dwordx4 v[92:95], v1, s[52:55], s60 offen offset:3072 sc1
M a[24:27], v[116:119], a[204:207], a[24:27]
v_mov_b32 v11, 0
M a[28:31], v[124:127], a[204:207], a[28:31]
M a[28:31], v[120:123], a[200:203], a[28:31]
s_waitcnt vmcnt(26) lgkmcnt(0)
s_barrier
M a[0:3], v[160:163], a[208:211], a[0:3]
s_add_u32 m0, s42, 32768
s_nop 0
buffer_load_dwordx4 v6, s[48:51], s26 offen offset:0 lds
ds_read_b64_tr_b16 v[96:97], v28 offset:32768
ds_read_b64_tr_b16 v[98:99], v28 offset:34816
M a[0:3], v[164:167], a[212:215], a[0:3]
buffer_load_dwordx4 v7, s[48:51], s26 offen offset:1024 lds
M a[4:7], v[172:175], a[212:215], a[4:7]
ds_read_b64_tr_b16 v[100:101], v28 offset:36864
ds_read_b64_tr_b16 v[102:103], v28 offset:38912
M a[4:7], v[168:171], a[208:211], a[4:7]
buffer_load_dwordx4 a[160:163], v1, s[44:47], s25 offen offset:0 sc1
M a[8:11], v[176:179], a[208:211], a[8:11]
ds_read_b64_tr_b16 v[104:105], v29 offset:32768
ds_read_b64_tr_b16 v[106:107], v29 offset:34816
M a[8:11], v[180:183], a[212:215], a[8:11]
buffer_load_dwordx4 a[164:167], v1, s[44:47], s25 offen offset:1024 sc1
M a[12:15], v[188:191], a[212:215], a[12:15]
ds_read_b64_tr_b16 v[108:109], v29 offset:36864
ds_read_b64_tr_b16 v[110:111], v29 offset:38912
M a[12:15], v[184:187], a[208:211], a[12:15]
buffer_load_dwordx4 a[168:171], v1, s[44:47], s25 offen offset:2048 sc1
M a[16:19], v[160:163], a[216:219], a[16:19]
ds_read_b64_tr_b16 v[112:113], v30 offset:32768
ds_read_b64_tr_b16 v[114:115], v30 offset:34816
M a[16:19], v[164:167], a[220:223], a[16:19]
buffer_load_dwordx4 a[172:175], v1, s[44:47], s25 offen offset:3072 sc1
M a[20:23], v[172:175], a[220:223], a[20:23]
ds_read_b64_tr_b16 v[116:117], v30 offset:36864
ds_read_b64_tr_b16 v[118:119], v30 offset:38912
M a[20:23], v[168:171], a[216:219], a[20:23]
s_add_u32 s25, s25, 16384
s_add_u32 s26, s26, 131072
M a[24:27], v[176:179], a[216:219], a[24:27]
ds_read_b64_tr_b16 v[120:121], v31 offset:32768
ds_read_b64_tr_b16 v[122:123], v31 offset:34816
M a[24:27], v[180:183], a[220:223], a[24:27]
ds_read_b64_tr_b16 v[124:125], v31 offset:36864
ds_read_b64_tr_b16 v[126:127], v31 offset:38912
M a[28:31], v[188:191], a[220:223], a[28:31]
M a[28:31], v[184:187], a[216:219], a[28:31]
s_waitcnt vmcnt(6) lgkmcnt(0)
s_barrier
s_cmp_lg_u32 s101, 0
s_cbranch_scc1 Lk3f_15
v_mov_b32 v9, 1
s_mov_b64 exec, 1
buffer_store_dword v9, v11, s[52:55], s58 offen sc1
s_mov_b64 exec, -1
Lk3f_15:
M a[0:3], v[96:99], a[224:227], a[0:3]
s_add_u32 m0, s42, 49152
s_nop 0
buffer_load_dwordx4 v6, s[48:51], s26 offen offset:0 lds
ds_read_b64_tr_b16 v[160:161], v28 offset:49152
ds_read_b64_tr_b16 v[162:163], v28 offset:51200
M a[0:3], v[100:103], a[228:231], a[0:3]
buffer_load_dwordx4 v7, s[48:51], s26 offen offset:1024 lds
M a[4:7], v[108:111], a[228:231], a[4:7]
ds_read_b64_tr_b16 v[164:165], v28 offset:53248
ds_read_b64_tr_b16 v[166:167], v28 offset:55296
M a[4:7], v[104:107], a[224:227], a[4:7]
buffer_load_dwordx4 a[176:179], v1, s[44:47], s25 offen offset:0 sc1
M a[8:11], v[112:115], a[224:227], a[8:11]
ds_read_b64_tr_b16 v[168:169], v29 offset:49152
ds_read_b64_tr_b16 v[170:171], v29 offset:51200
M a[8:11], v[116:119], a[228:231], a[8:11]
buffer_load_dwordx4 a[180:183], v1, s[44:47], s25 offen offset:1024 sc1
M a[12:15], v[124:127], a[228:231], a[12:15]
ds_read_b64_tr_b16 v[172:173], v29 offset:53248
ds_read_b64_tr_b16 v[174:175], v29 offset:55296
M a[12:15], v[120:123], a[224:227], a[12:15]
buffer_load_dwordx4 a[184:187], v1, s[44:47], s25 offen offset:2048 sc1
M a[16:19], v[96:99], a[232:235], a[16:19]
ds_read_b64_tr_b16 v[176:177], v30 offset:49152
ds_read_b64_tr_b16 v[178:179], v30 offset:51200
M a[16:19], v[100:103], a[236:239], a[16:19]
buffer_load_dwordx4 a[188:191], v1, s[44:47], s25 offen offset:3072 sc1
M a[20:23], v[108:111], a[236:239], a[20:23]
ds_read_b64_tr_b16 v[180:181], v30 offset:53248
ds_read_b64_tr_b16 v[182:183], v30 offset:55296
M a[20:23], v[104:107], a[232:235], a[20:23]
s_add_u32 s25, s25, 16384
s_add_u32 s26, s26, 131072
M a[24:27], v[112:115], a[232:235], a[24:27]
ds_read_b64_tr_b16 v[184:185], v31 offset:49152
ds_read_b64_tr_b16 v[186:187], v31 offset:51200
M a[24:27], v[116:119], a[236:239], a[24:27]
ds_read_b64_tr_b16 v[188:189], v31 offset:53248
ds_read_b64_tr_b16 v[190:191], v31 offset:55296
M a[28:31], v[124:127], a[236:239], a[28:31]
M a[28:31], v[120:123], a[232:235], a[28:31]
s_waitcnt vmcnt(26) lgkmcnt(0)
s_barrier
M a[0:3], v[160:163], a[240:243], a[0:3]
ds_read_b64_tr_b16 v[96:97], v24 offset:0
ds_read_b64_tr_b16 v[98:99], v24 offset:2048
M a[0:3], v[164:167], a[244:247], a[0:3]
ds_read_b64_tr_b16 v[100:101], v24 offset:4096
ds_read_b64_tr_b16 v[102:103], v24 offset:6144
M a[4:7], v[172:175], a[244:247], a[4:7]
M a[4:7], v[168:171], a[240:243], a[4:7]
ds_read_b64_tr_b16 v[104:105], v25 offset:0
ds_read_b64_tr_b16 v[106:107], v25 offset:2048
M a[8:11], v[176:179], a[240:243], a[8:11]
M a[8:11], v[180:183], a[244:247], a[8:11]
ds_read_b64_tr_b16 v[108:109], v25 offset:4096
ds_read_b64_tr_b16 v[110:111], v25 offset:6144
M a[12:15], v[188:191], a[244:247], a[12:15]
M a[12:15], v[184:187], a[240:243], a[12:15]
ds_read_b64_tr_b16 v[112:113], v26 offset:0
ds_read_b64_tr_b16 v[114:115], v26 offset:2048
M a[16:19], v[160:163], a[248:251], a[16:19]
ds_read_b64_tr_b16 v[116:117], v26 offset:4096
ds_read_b64_tr_b16 v[118:119], v26 offset:6144
M a[16:19], v[164:167], a[252:255], a[16:19]
M a[20:23], v[172:175], a[252:255], a[20:23]
ds_read_b64_tr_b16 v[120:121], v27 offset:0
ds_read_b64_tr_b16 v[122:123], v27 offset:2048
M a[20:23], v[168:171], a[248:251], a[20:23]
M a[24:27], v[176:179], a[248:251], a[24:27]
ds_read_b64_tr_b16 v[124:125], v27 offset:4096
ds_read_b64_tr_b16 v[126:127], v27 offset:6144
M a[24:27], v[180:183], a[252:255], a[24:27]
M a[28:31], v[188:191], a[252:255], a[28:31]
M a[28:31], v[184:187], a[248:251], a[28:31]
s_waitcnt vmcnt(20) lgkmcnt(0)
s_barrier
M a[0:3], v[96:99], a[128:131], a[0:3]
ds_read_b64_tr_b16 v[160:161], v24 offset:16384
ds_read_b64_tr_b16 v[162:163], v24 offset:18432
M a[0:3], v[100:103], a[132:135], a[0:3]
ds_read_b64_tr_b16 v[164:165], v24 offset:20480
ds_read_b64_tr_b16 v[166:167], v24 offset:22528
M a[4:7], v[108:111], a[132:135], a[4:7]
M a[4:7], v[104:107], a[128:131], a[4:7]
ds_read_b64_tr_b16 v[168:169], v25 offset:16384
ds_read_b64_tr_b16 v[170:171], v25 offset:18432
M a[8:11], v[112:115], a[128:131], a[8:11]
M a[8:11], v[116:119], a[132:135], a[8:11]
ds_read_b64_tr_b16 v[172:173], v25 offset:20480
ds_read_b64_tr_b16 v[174:175], v25 offset:22528
M a[12:15], v[124:127], a[132:135], a[12:15]
M a[12:15], v[120:123], a[128:131], a[12:15]
ds_read_b64_tr_b16 v[176:177], v26 offset:16384
ds_read_b64_tr_b16 v[178:179], v26 offset:18432
M a[16:19], v[96:99], a[136:139], a[16:19]
ds_read_b64_tr_b16 v[180:181], v26 offset:20480
ds_read_b64_tr_b16 v[182:183], v26 offset:22528
M a[16:19], v[100:103], a[140:143], a[16:19]
M a[20:23], v[108:111], a[140:143], a[20:23]
ds_read_b64_tr_b16 v[184:185], v27 offset:16384
ds_read_b64_tr_b16 v[186:187], v27 offset:18432
M a[20:23], v[104:107], a[136:139], a[20:23]
M a[24:27], v[112:115], a[136:139], a[24:27]
ds_read_b64_tr_b16 v[188:189], v27 offset:20480
ds_read_b64_tr_b16 v[190:191], v27 offset:22528
M a[24:27], v[116:119], a[140:143], a[24:27]
M a[28:31], v[124:127], a[140:143], a[28:31]
M a[28:31], v[120:123], a[136:139], a[28:31]
s_waitcnt vmcnt(6) lgkmcnt(0)
s_barrier
M a[0:3], v[160:163], a[144:147], a[0:3]
buffer_load_dword v8, v11, s[52:55], s59 offen sc1
M a[0:3], v[164:167], a[148:151], a[0:3]
ds_read_b64_tr_b16 v[96:97], v24 offset:32768
ds_read_b64_tr_b16 v[98:99], v24 offset:34816
M a[4:7], v[172:175], a[148:151], a[4:7]
M a[4:7], v[168:171], a[144:147], a[4:7]
ds_read_b64_tr_b16 v[100:101], v24 offset:36864
ds_read_b64_tr_b16 v[102:103], v24 offset:38912
M a[8:11], v[176:179], a[144:147], a[8:11]
ds_read_b64_tr_b16 v[104:105], v25 offset:32768
ds_read_b64_tr_b16 v[106:107], v25 offset:34816
M a[8:11], v[180:183], a[148:151], a[8:11]
M a[12:15], v[188:191], a[148:151], a[12:15]
ds_read_b64_tr_b16 v[108:109], v25 offset:36864
ds_read_b64_tr_b16 v[110:111], v25 offset:38912
M a[12:15], v[184:187], a[144:147], a[12:15]
ds_read_b64_tr_b16 v[112:113], v26 offset:32768
ds_read_b64_tr_b16 v[114:115], v26 offset:34816
M a[16:19], v[160:163], a[152:155], a[16:19]
M a[16:19], v[164:167], a[156:159], a[16:19]
ds_read_b64_tr_b16 v[116:117], v26 offset:36864
ds_read_b64_tr_b16 v[118:119], v26 offset:38912
M a[20:23], v[172:175], a[156:159], a[20:23]
ds_read_b64_tr_b16 v[120:121], v27 offset:32768
ds_read_b64_tr_b16 v[122:123], v27 offset:34816
M a[20:23], v[168:171], a[152:155], a[20:23]
M a[24:27], v[176:179], a[152:155], a[24:27]
ds_read_b64_tr_b16 v[124:125], v27 offset:36864
ds_read_b64_tr_b16 v[126:127], v27 offset:38912
M a[24:27], v[180:183], a[156:159], a[24:27]
M a[28:31], v[188:191], a[156:159], a[28:31]
M a[28:31], v[184:187], a[152:155], a[28:31]
s_waitcnt vmcnt(1) lgkmcnt(0)
s_barrier
s_waitcnt vmcnt(0)
v_cmp_ne_u32 vcc, 1, v8
s_nop 0
s_cbranch_vccnz Lk3_spinfl
Lk3_gotfl:
M a[0:3], v[96:99], a[160:163], a[0:3]
s_add_u32 s60, s57, 0
buffer_load_dwordx4 v[224:227], v1, s[52:55], s60 offen offset:0 sc1
ds_read_b64_tr_b16 v[160:161], v24 offset:49152
ds_read_b64_tr_b16 v[162:163], v24 offset:51200
M a[0:3], v[100:103], a[164:167], a[0:3]
buffer_load_dwordx4 v[228:231], v1, s[52:55], s60 offen offset:1024 sc1
M a[4:7], v[108:111], a[164:167], a[4:7]
ds_read_b64_tr_b16 v[164:165], v24 offset:53248
ds_read_b64_tr_b16 v[166:167], v24 offset:55296
M a[4:7], v[104:107], a[160:163], a[4:7]
buffer_load_dwordx4 v[232:235], v1, s[52:55], s60 offen offset:2048 sc1
M a[8:11], v[112:115], a[160:163], a[8:11]
ds_read_b64_tr_b16 v[168:169], v25 offset:49152
ds_read_b64_tr_b16 v[170:171], v25 offset:51200
M a[8:11], v[116:119], a[164:167], a[8:11]
buffer_load_dwordx4 v[236:239], v1, s[52:55], s60 offen offset:3072 sc1
M a[12:15], v[124:127], a[164:167], a[12:15]
ds_read_b64_tr_b16 v[172:173], v25 offset:53248
ds_read_b64_tr_b16 v[174:175], v25 offset:55296
M a[12:15], v[120:123], a[160:163], a[12:15]
s_add_u32 s60, s57, 4096
buffer_load_dwordx4 v[240:243], v1, s[52:55], s60 offen offset:0 sc1
ds_read_b64_tr_b16 v[176:177], v26 offset:49152
ds_read_b64_tr_b16 v[178:179], v26 offset:51200
M a[16:19], v[96:99], a[168:171], a[16:19]
buffer_load_dwordx4 v[244:247], v1, s[52:55], s60 offen offset:1024 sc1
M a[16:19], v[100:103], a[172:175], a[16:19]
ds_read_b64_tr_b16 v[180:181], v26 offset:53248
ds_read_b64_tr_b16 v[182:183], v26 offset:55296
M a[20:23], v[108:111], a[172:175], a[20:23]
buffer_load_dwordx4 v[248:251], v1, s[52:55], s60 offen offset:2048 sc1
M a[20:23], v[104:107], a[168:171], a[20:23]
ds_read_b64_tr_b16 v[184:185], v27 offset:49152
ds_read_b64_tr_b16 v[186:187], v27 offset:51200
M a[24:27], v[112:115], a[168:171], a[24:27]
buffer_load_dwordx4 v[252:255], v1, s[52:55], s60 offen offset:3072 sc1
M a[24:27], v[116:119], a[172:175], a[24:27]
ds_read_b64_tr_b16 v[188:189], v27 offset:53248
ds_read_b64_tr_b16 v[190:191], v27 offset:55296
M a[28:31], v[124:127], a[172:175], a[28:31]
M a[28:31], v[120:123], a[168:171], a[28:31]
s_waitcnt lgkmcnt(0)
M a[0:3], v[160:163], a[176:179], a[0:3]
M a[0:3], v[164:167], a[180:183], a[0:3]
M a[4:7], v[172:175], a[180:183], a[4:7]
M a[4:7], v[168:171], a[176:179], a[4:7]
M a[8:11], v[176:179], a[176:179], a[8:11]
M a[8:11], v[180:183], a[180:183], a[8:11]
M a[12:15], v[188:191], a[180:183], a[12:15]
M a[12:15], v[184:187], a[176:179], a[12:15]
M a[16:19], v[160:163], a[184:187], a[16:19]
M a[16:19], v[164:167], a[188:191], a[16:19]
M a[20:23], v[172:175], a[188:191], a[20:23]
M a[20:23], v[168:171], a[184:187], a[20:23]
M a[24:27], v[176:179], a[184:187], a[24:27]
M a[24:27], v[180:183], a[188:191], a[24:27]
M a[28:31], v[188:191], a[188:191], a[28:31]
M a[28:31], v[184:187], a[184:187], a[28:31]
v_bfe_u32 v96, v0, 4, 1
v_lshrrev_b32 v97, 5, v0
v_lshl_or_b32 v96, v96, 1, v97
v_and_b32 v97, 15, v0
v_lshlrev_b32 v97, 13, v97
v_lshl_add_u32 v96, v96, 4, v97
s_and_b32 s3, s101, 1
s_lshl_b32 s3, s3, 6
s_lshr_b32 s6, s101, 1
s_add_u32 s3, s3, s6
s_add_u32 s3, s3, s21
s_lshl_b32 s3, s3, 12
s_lshl_b32 s6, s22, 1
s_add_u32 s3, s3, s6
s_add_u32 s3, s3, 2048
v_accvgpr_read_b32 v108, a0
v_accvgpr_read_b32 v109, a1
v_accvgpr_read_b32 v110, a2
v_accvgpr_read_b32 v111, a3
v_accvgpr_read_b32 v112, a4
v_accvgpr_read_b32 v113, a5
v_accvgpr_read_b32 v114, a6
v_accvgpr_read_b32 v115, a7
v_cvt_pk_bf16_f32 v100, v108, v109
v_cvt_pk_bf16_f32 v101, v110, v111
v_cvt_pk_bf16_f32 v102, v112, v113
v_cvt_pk_bf16_f32 v103, v114, v115
s_nop 0
v_permlane16_swap_b32 v100, v102
v_permlane16_swap_b32 v101, v103
buffer_store_dwordx4 v[100:103], v96, s[16:19], s3 offen offset:0
v_accvgpr_read_b32 v108, a8
v_accvgpr_read_b32 v109, a9
v_accvgpr_read_b32 v110, a10
v_accvgpr_read_b32 v111, a11
v_accvgpr_read_b32 v112, a12
v_accvgpr_read_b32 v113, a13
v_accvgpr_read_b32 v114, a14
v_accvgpr_read_b32 v115, a15
v_cvt_pk_bf16_f32 v104, v108, v109
v_cvt_pk_bf16_f32 v105, v110, v111
v_cvt_pk_bf16_f32 v106, v112, v113
v_cvt_pk_bf16_f32 v107, v114, v115
s_nop 0
v_permlane16_swap_b32 v104, v106
v_permlane16_swap_b32 v105, v107
buffer_store_dwordx4 v[104:107], v96, s[16:19], s3 offen offset:64
s_add_u32 s3, s3, 131072
v_accvgpr_read_b32 v108, a16
v_accvgpr_read_b32 v109, a17
v_accvgpr_read_b32 v110, a18
v_accvgpr_read_b32 v111, a19
v_accvgpr_read_b32 v112, a20
v_accvgpr_read_b32 v113, a21
v_accvgpr_read_b32 v114, a22
v_accvgpr_read_b32 v115, a23
v_cvt_pk_bf16_f32 v100, v108, v109
v_cvt_pk_bf16_f32 v101, v110, v111
v_cvt_pk_bf16_f32 v102, v112, v113
v_cvt_pk_bf16_f32 v103, v114, v115
s_nop 0
v_permlane16_swap_b32 v100, v102
v_permlane16_swap_b32 v101, v103
buffer_store_dwordx4 v[100:103], v96, s[16:19], s3 offen offset:0
v_accvgpr_read_b32 v108, a24
v_accvgpr_read_b32 v109, a25
v_accvgpr_read_b32 v110, a26
v_accvgpr_read_b32 v111, a27
v_accvgpr_read_b32 v112, a28
v_accvgpr_read_b32 v113, a29
v_accvgpr_read_b32 v114, a30
v_accvgpr_read_b32 v115, a31
v_cvt_pk_bf16_f32 v104, v108, v109
v_cvt_pk_bf16_f32 v105, v110, v111
v_cvt_pk_bf16_f32 v106, v112, v113
v_cvt_pk_bf16_f32 v107, v114, v115
s_nop 0
v_permlane16_swap_b32 v104, v106
v_permlane16_swap_b32 v105, v107
buffer_store_dwordx4 v[104:107], v96, s[16:19], s3 offen offset:64
v_bfe_u32 v128, v0, 4, 1
v_lshrrev_b32 v129, 5, v0
v_lshl_or_b32 v128, v128, 1, v129
v_and_b32 v129, 15, v0
v_lshlrev_b32 v129, 12, v129
v_lshl_add_u32 v128, v128, 4, v129
s_lshl_b32 s3, s101, 5
s_add_u32 s3, s3, s29
s_lshl_b32 s3, s3, 12
s_lshl_b32 s6, s30, 1
s_add_u32 s3, s3, s6
s_waitcnt vmcnt(4)
v_pk_add_f32 v[32:33], v[32:33], v[224:225]
v_pk_add_f32 v[34:35], v[34:35], v[226:227]
v_pk_add_f32 v[36:37], v[36:37], v[228:229]
v_pk_add_f32 v[38:39], v[38:39], v[230:231]
v_cvt_pk_bf16_f32 v132, v32, v33
v_cvt_pk_bf16_f32 v133, v34, v35
v_cvt_pk_bf16_f32 v134, v36, v37
v_cvt_pk_bf16_f32 v135, v38, v39
s_nop 0
v_permlane16_swap_b32 v132, v134
v_permlane16_swap_b32 v133, v135
buffer_store_dwordx4 v[132:135], v128, s[16:19], s3 offen offset:0
v_pk_add_f32 v[40:41], v[40:41], v[232:233]
v_pk_add_f32 v[42:43], v[42:43], v[234:235]
v_pk_add_f32 v[44:45], v[44:45], v[236:237]
v_pk_add_f32 v[46:47], v[46:47], v[238:239]
v_cvt_pk_bf16_f32 v136, v40, v41
v_cvt_pk_bf16_f32 v137, v42, v43
v_cvt_pk_bf16_f32 v138, v44, v45
v_cvt_pk_bf16_f32 v139, v46, v47
s_nop 0
v_permlane16_swap_b32 v136, v138
v_permlane16_swap_b32 v137, v139
buffer_store_dwordx4 v[136:139], v128, s[16:19], s3 offen offset:64
s_add_u32 s3, s3, 65536
v_pk_add_f32 v[64:65], v[64:65], v[240:241]
v_pk_add_f32 v[66:67], v[66:67], v[242:243]
v_pk_add_f32 v[68:69], v[68:69], v[244:245]
v_pk_add_f32 v[70:71], v[70:71], v[246:247]
v_cvt_pk_bf16_f32 v132, v64, v65
v_cvt_pk_bf16_f32 v133, v66, v67
v_cvt_pk_bf16_f32 v134, v68, v69
v_cvt_pk_bf16_f32 v135, v70, v71
s_nop 0
v_permlane16_swap_b32 v132, v134
v_permlane16_swap_b32 v133, v135
buffer_store_dwordx4 v[132:135], v128, s[16:19], s3 offen offset:0
v_pk_add_f32 v[72:73], v[72:73], v[248:249]
v_pk_add_f32 v[74:75], v[74:75], v[250:251]
v_pk_add_f32 v[76:77], v[76:77], v[252:253]
v_pk_add_f32 v[78:79], v[78:79], v[254:255]
v_cvt_pk_bf16_f32 v136, v72, v73
v_cvt_pk_bf16_f32 v137, v74, v75
v_cvt_pk_bf16_f32 v138, v76, v77
v_cvt_pk_bf16_f32 v139, v78, v79
s_nop 0
v_permlane16_swap_b32 v136, v138
v_permlane16_swap_b32 v137, v139
buffer_store_dwordx4 v[136:139], v128, s[16:19], s3 offen offset:64
s_endpgm
Lk3_spinb0:
Lk3_spinb0_:
s_add_u32 s61, s61, 1
s_cmp_gt_u32 s61, 1048576
s_cbranch_scc1 Lk3_gotb0
s_sleep 2
buffer_load_dword v7, v15, s[52:55], s43 offen sc1
s_waitcnt vmcnt(0)
v_cmp_ne_u32 vcc, 1, v7
s_nop 0
s_cbranch_vccnz Lk3_spinb0_
s_branch Lk3_gotb0
Lk3_spinb1:
Lk3_spinb1_:
s_add_u32 s61, s61, 1
s_cmp_gt_u32 s61, 1048576
s_cbranch_scc1 Lk3_gotb1
s_sleep 2
buffer_load_dword v7, v15, s[52:55], s43 offen sc1
s_waitcnt vmcnt(0)
v_cmp_ne_u32 vcc, 1, v7
s_nop 0
s_cbranch_vccnz Lk3_spinb1_
s_branch Lk3_gotb1
Lk3_spinft:
s_add_u32 s61, s61, 1
s_cmp_gt_u32 s61, 1048576
s_cbranch_scc1 Lk3_gotft
s_sleep 2
buffer_load_dword v252, v255, s[52:55], s62 offen sc1
s_waitcnt vmcnt(0)
v_cmp_ne_u32 vcc, 1, v252
s_nop 0
s_cbranch_vccnz Lk3_spinft
s_branch Lk3_gotft
Lk3_spinfl:
s_add_u32 s61, s61, 1
s_cmp_gt_u32 s61, 1048576
s_cbranch_scc1 Lk3_gotfl
s_sleep 2
buffer_load_dword v8, v11, s[52:55], s59 offen sc1
s_waitcnt vmcnt(0)
v_cmp_ne_u32 vcc, 1, v8
s_nop 0
s_cbranch_vccnz Lk3_spinfl
s_branch Lk3_gotfl
Lc3:
.section .rodata,"a"
.p2align 6
.amdhsa_kernel concat_heads__compressed_kv_cla__sliding_local_dilated__prompt_kernel
  .amdhsa_next_free_vgpr 512
  .amdhsa_next_free_sgpr 102
  .amdhsa_accum_offset 256
  .amdhsa_group_segment_fixed_size 0
  .amdhsa_kernarg_size 96
  .amdhsa_user_sgpr_count 2
  .amdhsa_user_sgpr_kernarg_segment_ptr 1
  .amdhsa_system_sgpr_workgroup_id_x 1
.end_amdhsa_kernel
```

```asm
; @launch grid=(256,1,1) block=(256,1,1) lds=163840
.amdgcn_target "amdgcn-amd-amdhsa--gfx950"
.text
.macro M d, a, b, c
v_mfma_f32_16x16x32_bf16 \d, \a, \b, \c
.endm
.globl concat_heads__compressed_kv_cla__sliding_local_dilated__prompt_kernel
.p2align 8
.type concat_heads__compressed_kv_cla__sliding_local_dilated__prompt_kernel,@function
concat_heads__compressed_kv_cla__sliding_local_dilated__prompt_kernel:
s_cmp_lt_u32 s2, 256
s_cbranch_scc1 Lk1_go
s_endpgm
Lk1_go:
s_load_dwordx16 s[32:47], s[0:1], 0
s_load_dwordx2 s[48:49], s[0:1], 64
s_load_dwordx2 s[50:51], s[0:1], 88
s_load_dwordx2 s[90:91], s[0:1], 80
v_lshrrev_b32 v24, 6, v0
s_nop 0
v_readfirstlane_b32 s20, v24
v_and_b32 v0, 63, v0
v_lshlrev_b32 v1, 4, v0
s_mov_b32 s101, s20
s_lshr_b32 s21, s20, 1
s_and_b32 s22, s20, 1
s_lshl_b32 s29, s20, 12
s_and_b32 s3, s2, 1
s_lshl_b32 s3, s3, 2
s_bfe_u32 s6, s2, 0x20003
s_add_u32 s3, s3, s6
s_lshl_b32 s52, s3, 8
s_bfe_u32 s3, s2, 0x20001
s_lshl_b32 s3, s3, 2
s_bfe_u32 s7, s2, 0x20005
s_add_u32 s3, s3, s7
s_lshl_b32 s53, s3, 8
s_cmp_lt_u32 s2, 128
s_cselect_b32 s5, 11, 10
s_lshl_b32 s3, s21, 7
s_lshl_b32 s4, s22, 5
s_add_u32 s3, s3, s4
v_lshrrev_b32 v24, 3, v0
v_add_u32 v24, s3, v24
v_and_b32 v25, 7, v0
v_add_u32 v26, 0, v24
v_bfe_u32 v27, v26, 1, 3
v_xor_b32 v27, v27, v25
v_lshlrev_b32 v26, s5, v26
v_lshl_add_u32 v26, v27, 4, v26
v_subrev_u32 v2, 0, v26
v_add_u32 v26, 8, v24
v_bfe_u32 v27, v26, 1, 3
v_xor_b32 v27, v27, v25
v_lshlrev_b32 v26, s5, v26
v_lshl_add_u32 v26, v27, 4, v26
v_subrev_u32 v3, 1024, v26
v_add_u32 v26, 16, v24
v_bfe_u32 v27, v26, 1, 3
v_xor_b32 v27, v27, v25
v_lshlrev_b32 v26, s5, v26
v_lshl_add_u32 v26, v27, 4, v26
v_subrev_u32 v4, 2048, v26
v_add_u32 v26, 24, v24
v_bfe_u32 v27, v26, 1, 3
v_xor_b32 v27, v27, v25
v_lshlrev_b32 v26, s5, v26
v_lshl_add_u32 v26, v27, 4, v26
v_subrev_u32 v5, 3072, v26
s_lshl_b32 s3, s20, 3
v_lshrrev_b32 v24, 5, v0
v_add_u32 v24, s3, v24
v_and_b32 v25, 31, v0
v_add_u32 v26, 0, v24
v_and_b32 v27, 3, v26
v_lshlrev_b32 v27, 1, v27
v_and_or_b32 v27, v26, 8, v27
v_xor_b32 v27, v27, v25
v_lshlrev_b32 v26, 13, v26
v_lshl_add_u32 v26, v27, 4, v26
v_subrev_u32 v6, 0, v26
v_add_u32 v26, 2, v24
v_and_b32 v27, 3, v26
v_lshlrev_b32 v27, 1, v27
v_and_or_b32 v27, v26, 8, v27
v_xor_b32 v27, v27, v25
v_lshlrev_b32 v26, 13, v26
v_lshl_add_u32 v26, v27, 4, v26
v_subrev_u32 v7, 1024, v26
v_add_u32 v26, 4, v24
v_and_b32 v27, 3, v26
v_lshlrev_b32 v27, 1, v27
v_and_or_b32 v27, v26, 8, v27
v_xor_b32 v27, v27, v25
v_lshlrev_b32 v26, 13, v26
v_lshl_add_u32 v26, v27, 4, v26
v_subrev_u32 v8, 2048, v26
v_add_u32 v26, 6, v24
v_and_b32 v27, 3, v26
v_lshlrev_b32 v27, 1, v27
v_and_or_b32 v27, v26, 8, v27
v_xor_b32 v27, v27, v25
v_lshlrev_b32 v26, 13, v26
v_lshl_add_u32 v26, v27, 4, v26
v_subrev_u32 v9, 3072, v26
s_lshl_b32 s23, s52, s5
s_lshl_b32 s31, 64, s5
s_mov_b32 s26, s23
s_lshl_b32 s24, s53, 1
s_mov_b32 s28, s24
s_lshl_b32 s3, 1, s5
s_add_u32 s25, s23, s3
s_lshl_b32 s3, s3, 12
s_add_u32 s27, s24, s3
s_bfe_u32 s3, s2, 0x20001
s_and_b32 s4, s2, 1
s_lshl_b32 s4, s4, 1
s_add_u32 s3, s3, s4
s_and_b32 s3, s3, 3
s_sub_u32 s4, s5, 2
s_lshl_b32 s3, s3, s4
s_add_u32 s23, s23, s3
s_lshl_b32 s3, s3, 12
s_add_u32 s24, s24, s3
s_mov_b32 s95, s6
s_cmp_lt_u32 s2, 128
s_cselect_b32 s6, -1, 8
s_waitcnt lgkmcnt(0)
s_cmp_lt_u32 s2, 128
s_cselect_b64 s[8:9], s[32:33], s[34:35]
s_mov_b32 s10, 2097152
s_cselect_b32 s10, 4194304, s10
s_mov_b32 s11, 0x00020000
s_cselect_b64 s[12:13], s[36:37], s[38:39]
s_mov_b32 s14, 4194304
s_cselect_b32 s14, 8388608, s14
s_mov_b32 s15, 0x00020000
s_mov_b64 s[64:65], s[40:41]
s_add_u32 m0, s29, 65536
s_nop 0
buffer_load_dwordx4 v6, s[12:15], s24 offen offset:0 lds
buffer_load_dwordx4 v7, s[12:15], s24 offen offset:1024 lds
buffer_load_dwordx4 v8, s[12:15], s24 offen offset:2048 lds
buffer_load_dwordx4 v9, s[12:15], s24 offen offset:3072 lds
s_add_u32 s24, s24, 262144
s_add_u32 m0, s29, 0
s_nop 0
buffer_load_dwordx4 v2, s[8:11], s23 offen offset:0 lds
buffer_load_dwordx4 v3, s[8:11], s23 offen offset:1024 lds
buffer_load_dwordx4 v4, s[8:11], s23 offen offset:2048 lds
buffer_load_dwordx4 v5, s[8:11], s23 offen offset:3072 lds
s_add_u32 m0, s29, 81920
s_nop 0
buffer_load_dwordx4 v6, s[12:15], s24 offen offset:0 lds
buffer_load_dwordx4 v7, s[12:15], s24 offen offset:1024 lds
buffer_load_dwordx4 v8, s[12:15], s24 offen offset:2048 lds
buffer_load_dwordx4 v9, s[12:15], s24 offen offset:3072 lds
s_add_u32 s24, s24, 262144
s_cmp_eq_u32 s24, s27
s_cselect_b32 s24, s28, s24
s_sub_u32 s6, s6, 1
s_cmp_eq_u32 s6, 0
s_cselect_b64 s[12:13], s[64:65], s[12:13]
s_add_u32 m0, s29, 98304
s_nop 0
buffer_load_dwordx4 v6, s[12:15], s24 offen offset:0 lds
buffer_load_dwordx4 v7, s[12:15], s24 offen offset:1024 lds
buffer_load_dwordx4 v8, s[12:15], s24 offen offset:2048 lds
buffer_load_dwordx4 v9, s[12:15], s24 offen offset:3072 lds
s_add_u32 s24, s24, 262144
s_add_u32 m0, s29, 16384
s_add_u32 s3, s23, s31
s_nop 0
buffer_load_dwordx4 v2, s[8:11], s3 offen offset:0 lds
buffer_load_dwordx4 v3, s[8:11], s3 offen offset:1024 lds
buffer_load_dwordx4 v4, s[8:11], s3 offen offset:2048 lds
buffer_load_dwordx4 v5, s[8:11], s3 offen offset:3072 lds
s_add_u32 s23, s23, 128
s_cmp_eq_u32 s23, s25
s_cselect_b32 s23, s26, s23
s_add_u32 m0, s29, 114688
s_nop 0
buffer_load_dwordx4 v6, s[12:15], s24 offen offset:0 lds
buffer_load_dwordx4 v7, s[12:15], s24 offen offset:1024 lds
buffer_load_dwordx4 v8, s[12:15], s24 offen offset:2048 lds
buffer_load_dwordx4 v9, s[12:15], s24 offen offset:3072 lds
s_add_u32 s24, s24, 262144
s_cmp_eq_u32 s24, s27
s_cselect_b32 s24, s28, s24
s_sub_u32 s6, s6, 1
s_cmp_eq_u32 s6, 0
s_cselect_b64 s[12:13], s[64:65], s[12:13]
s_add_u32 s16, s50, 109051904
s_addc_u32 s17, s51, 0
s_mov_b32 s18, 16384
s_mov_b32 s19, 0x00020000
v_mov_b32 v24, 0
v_mov_b32 v25, 0
v_mov_b32 v26, 0
v_mov_b32 v27, 0
s_lshl_b32 s3, s2, 2
buffer_store_dword v24, v24, s[16:19], s3 offen sc1
s_and_b32 s3, s2, 7
s_lshr_b32 s4, s2, 6
s_lshl_b32 s4, s4, 3
s_add_u32 s3, s3, s4
s_lshl_b32 s3, s3, 4
s_add_u32 s3, s3, 4096
s_bfe_u32 s4, s2, 0x30003
s_lshl_b32 s4, s4, 9
s_add_u32 s92, s3, s4
s_sub_u32 s4, 7680, s4
s_add_u32 s93, s3, s4
buffer_store_dwordx4 v[24:27], v24, s[16:19], s92 offen sc1
buffer_store_dwordx4 v[24:27], v24, s[16:19], s93 offen sc1
s_and_b32 s3, s2, 1
s_lshl_b32 s3, s3, 3
s_bfe_u32 s4, s2, 0x30003
s_add_u32 s92, s3, s4
s_bfe_u32 s3, s2, 0x20001
s_lshl_b32 s3, s3, 2
s_lshr_b32 s4, s2, 6
s_xor_b32 s4, s4, 2
s_add_u32 s93, s3, s4
s_lshl_b32 s92, s92, 8
s_lshl_b32 s93, s93, 4
s_add_u32 s92, s92, s93
s_add_u32 s92, s92, 12288
buffer_store_dwordx4 v[24:27], v24, s[16:19], s92 offen sc1
v_lshlrev_b32 v20, 7, v0
s_lshl_b32 s54, s2, 13
s_mov_b64 s[60:61], s[40:41]
s_mov_b32 s62, 0
s_cmp_eq_u32 s20, 1
s_cselect_b64 s[60:61], s[46:47], s[60:61]
s_cselect_b32 s62, 6291456, s62
s_cmp_eq_u32 s20, 2
s_cselect_b64 s[60:61], s[44:45], s[60:61]
s_cselect_b32 s62, 4194304, s62
s_cmp_eq_u32 s20, 3
s_cselect_b32 s62, 0, s62
s_mov_b32 s63, 0x00020000
s_mov_b32 s3, 0
s_cmp_eq_u32 s20, 1
s_cselect_b32 s3, 6291456, s3
s_cmp_eq_u32 s20, 2
s_cselect_b32 s3, 6291456, s3
s_sub_u32 s54, s54, s3
Lc0:
s_getpc_b64 s[92:93]
Lpc_1:
s_add_u32 s92, s92, Lc1-Lpc_1
s_addc_u32 s93, s93, 0
s_lshr_b32 s94, s2, 3
s_mul_i32 s94, s94, ((Lc3-Lc1)/32+127)&~127
v_lshlrev_b32 v24, 7, v0
v_add_u32 v24, s94, v24
v_min_u32 v24, Lc3-Lc1-4, v24
global_load_dword v21, v24, s[92:93]
s_add_u32 m0, s29, 32768
s_nop 0
buffer_load_dwordx4 v2, s[8:11], s23 offen offset:0 lds
buffer_load_dwordx4 v3, s[8:11], s23 offen offset:1024 lds
buffer_load_dwordx4 v4, s[8:11], s23 offen offset:2048 lds
buffer_load_dwordx4 v5, s[8:11], s23 offen offset:3072 lds
s_lshl_b32 s4, s21, 13
v_and_b32 v24, 15, v0
v_lshlrev_b32 v24, 7, v24
v_add_u32 v24, s4, v24
v_bfe_u32 v25, v0, 1, 3
v_lshrrev_b32 v26, 4, v0
v_xor_b32 v25, v25, v26
v_lshl_add_u32 v10, v25, 4, v24
v_xor_b32 v11, 64, v10
v_bfe_u32 v24, v0, 2, 2
v_lshl_add_u32 v29, v26, 3, v24
v_lshlrev_b32 v25, 9, v29
v_and_b32 v27, 1, v0
v_lshl_add_u32 v25, v27, 3, v25
v_add_u32 v25, 65536, v25
v_lshlrev_b32 v24, 1, v24
v_and_or_b32 v24, v29, 8, v24
v_bfe_u32 v26, v0, 1, 1
s_lshl_b32 s4, s22, 4
s_add_u32 s3, s4, 0
v_add_u32 v27, s3, v26
v_xor_b32 v27, v27, v24
v_lshl_add_u32 v12, v27, 4, v25
s_add_u32 s3, s4, 2
v_add_u32 v27, s3, v26
v_xor_b32 v27, v27, v24
v_lshl_add_u32 v13, v27, 4, v25
s_add_u32 s3, s4, 4
v_add_u32 v27, s3, v26
v_xor_b32 v27, v27, v24
v_lshl_add_u32 v14, v27, 4, v25
s_add_u32 s3, s4, 6
v_add_u32 v27, s3, v26
v_xor_b32 v27, v27, v24
v_lshl_add_u32 v15, v27, 4, v25
s_add_u32 s3, s4, 8
v_add_u32 v27, s3, v26
v_xor_b32 v27, v27, v24
v_lshl_add_u32 v16, v27, 4, v25
s_add_u32 s3, s4, 10
v_add_u32 v27, s3, v26
v_xor_b32 v27, v27, v24
v_lshl_add_u32 v17, v27, 4, v25
s_add_u32 s3, s4, 12
v_add_u32 v27, s3, v26
v_xor_b32 v27, v27, v24
v_lshl_add_u32 v18, v27, 4, v25
s_add_u32 s3, s4, 14
v_add_u32 v27, s3, v26
v_xor_b32 v27, v27, v24
v_lshl_add_u32 v19, v27, 4, v25
s_waitcnt vmcnt(21)
s_barrier
ds_read_b64_tr_b16 a[32:33], v12 offset:0
ds_read_b64_tr_b16 a[34:35], v12 offset:2048
ds_read_b64_tr_b16 a[40:41], v13 offset:0
ds_read_b64_tr_b16 a[42:43], v13 offset:2048
ds_read_b64_tr_b16 a[48:49], v14 offset:0
ds_read_b64_tr_b16 a[50:51], v14 offset:2048
ds_read_b64_tr_b16 a[56:57], v15 offset:0
ds_read_b64_tr_b16 a[58:59], v15 offset:2048
ds_read_b64_tr_b16 a[64:65], v16 offset:0
ds_read_b64_tr_b16 a[66:67], v16 offset:2048
ds_read_b64_tr_b16 a[72:73], v17 offset:0
ds_read_b64_tr_b16 a[74:75], v17 offset:2048
ds_read_b64_tr_b16 a[80:81], v18 offset:0
ds_read_b64_tr_b16 a[82:83], v18 offset:2048
ds_read_b64_tr_b16 a[88:89], v19 offset:0
ds_read_b64_tr_b16 a[90:91], v19 offset:2048
ds_read_b64_tr_b16 a[36:37], v12 offset:16384
ds_read_b64_tr_b16 a[38:39], v12 offset:18432
ds_read_b64_tr_b16 a[44:45], v13 offset:16384
ds_read_b64_tr_b16 a[46:47], v13 offset:18432
ds_read_b64_tr_b16 a[52:53], v14 offset:16384
ds_read_b64_tr_b16 a[54:55], v14 offset:18432
ds_read_b64_tr_b16 a[60:61], v15 offset:16384
ds_read_b64_tr_b16 a[62:63], v15 offset:18432
ds_read_b64_tr_b16 a[68:69], v16 offset:16384
ds_read_b64_tr_b16 a[70:71], v16 offset:18432
ds_read_b64_tr_b16 a[76:77], v17 offset:16384
ds_read_b64_tr_b16 a[78:79], v17 offset:18432
ds_read_b64_tr_b16 a[84:85], v18 offset:16384
ds_read_b64_tr_b16 a[86:87], v18 offset:18432
ds_read_b64_tr_b16 a[92:93], v19 offset:16384
ds_read_b64_tr_b16 a[94:95], v19 offset:18432
ds_read_b128 a[160:163], v10 offset:0
ds_read_b128 a[164:167], v11 offset:0
ds_read_b128 a[168:171], v10 offset:2048
ds_read_b128 a[172:175], v11 offset:2048
s_waitcnt vmcnt(17) lgkmcnt(0)
s_barrier
s_add_u32 m0, s29, 65536
s_nop 0
buffer_load_dwordx4 v6, s[12:15], s24 offen offset:0 lds
buffer_load_dwordx4 v7, s[12:15], s24 offen offset:1024 lds
buffer_load_dwordx4 v8, s[12:15], s24 offen offset:2048 lds
buffer_load_dwordx4 v9, s[12:15], s24 offen offset:3072 lds
s_add_u32 s24, s24, 262144
s_add_u32 m0, s29, 49152
s_add_u32 s3, s23, s31
s_nop 0
buffer_load_dwordx4 v2, s[8:11], s3 offen offset:0 lds
buffer_load_dwordx4 v3, s[8:11], s3 offen offset:1024 lds
buffer_load_dwordx4 v4, s[8:11], s3 offen offset:2048 lds
buffer_load_dwordx4 v5, s[8:11], s3 offen offset:3072 lds
Lc1:
s_cmp_lt_u32 s2, 128
s_cbranch_scc0 Lk1_kv
M v[32:35], a[32:35], a[160:163], 0
s_add_u32 s23, s23, 128
s_cmp_eq_u32 s23, s25
s_cselect_b32 s23, s26, s23
M v[32:35], a[36:39], a[164:167], v[32:35]
ds_read_b128 a[176:179], v10 offset:4096
ds_read_b128 a[180:183], v11 offset:4096
M v[36:39], a[44:47], a[164:167], 0
M v[36:39], a[40:43], a[160:163], v[36:39]
ds_read_b64_tr_b16 a[96:97], v12 offset:32768
ds_read_b64_tr_b16 a[98:99], v12 offset:34816
M v[40:43], a[48:51], a[160:163], 0
M v[40:43], a[52:55], a[164:167], v[40:43]
M v[44:47], a[60:63], a[164:167], 0
s_add_u32 m0, s29, 81920
s_nop 0
buffer_load_dwordx4 v6, s[12:15], s24 offen offset:0 lds
M v[44:47], a[56:59], a[160:163], v[44:47]
ds_read_b64_tr_b16 a[104:105], v13 offset:32768
ds_read_b64_tr_b16 a[106:107], v13 offset:34816
M v[48:51], a[64:67], a[160:163], 0
M v[48:51], a[68:71], a[164:167], v[48:51]
M v[52:55], a[76:79], a[164:167], 0
M v[52:55], a[72:75], a[160:163], v[52:55]
ds_read_b64_tr_b16 a[112:113], v14 offset:32768
ds_read_b64_tr_b16 a[114:115], v14 offset:34816
M v[56:59], a[80:83], a[160:163], 0
M v[56:59], a[84:87], a[164:167], v[56:59]
buffer_load_dwordx4 v7, s[12:15], s24 offen offset:1024 lds
M v[60:63], a[92:95], a[164:167], 0
M v[60:63], a[88:91], a[160:163], v[60:63]
ds_read_b64_tr_b16 a[120:121], v15 offset:32768
ds_read_b64_tr_b16 a[122:123], v15 offset:34816
M v[64:67], a[32:35], a[168:171], 0
M v[64:67], a[36:39], a[172:175], v[64:67]
ds_read_b128 a[184:187], v10 offset:6144
ds_read_b128 a[188:191], v11 offset:6144
M v[68:71], a[44:47], a[172:175], 0
M v[68:71], a[40:43], a[168:171], v[68:71]
ds_read_b64_tr_b16 a[128:129], v16 offset:32768
ds_read_b64_tr_b16 a[130:131], v16 offset:34816
M v[72:75], a[48:51], a[168:171], 0
buffer_load_dwordx4 v8, s[12:15], s24 offen offset:2048 lds
M v[72:75], a[52:55], a[172:175], v[72:75]
M v[76:79], a[60:63], a[172:175], 0
M v[76:79], a[56:59], a[168:171], v[76:79]
ds_read_b64_tr_b16 a[136:137], v17 offset:32768
ds_read_b64_tr_b16 a[138:139], v17 offset:34816
M v[80:83], a[64:67], a[168:171], 0
M v[80:83], a[68:71], a[172:175], v[80:83]
M v[84:87], a[76:79], a[172:175], 0
buffer_load_dwordx4 v9, s[12:15], s24 offen offset:3072 lds
M v[84:87], a[72:75], a[168:171], v[84:87]
ds_read_b64_tr_b16 a[144:145], v18 offset:32768
ds_read_b64_tr_b16 a[146:147], v18 offset:34816
M v[88:91], a[80:83], a[168:171], 0
M v[88:91], a[84:87], a[172:175], v[88:91]
M v[92:95], a[92:95], a[172:175], 0
M v[92:95], a[88:91], a[168:171], v[92:95]
s_waitcnt lgkmcnt(15)
ds_read_b64_tr_b16 a[152:153], v19 offset:32768
ds_read_b64_tr_b16 a[154:155], v19 offset:34816
M v[96:99], a[32:35], a[176:179], 0
s_add_u32 s24, s24, 262144
s_cmp_eq_u32 s24, s27
s_cselect_b32 s24, s28, s24
s_sub_u32 s6, s6, 1
s_cmp_eq_u32 s6, 0
s_cselect_b64 s[12:13], s[64:65], s[12:13]
M v[96:99], a[36:39], a[180:183], v[96:99]
M v[100:103], a[44:47], a[180:183], 0
M v[100:103], a[40:43], a[176:179], v[100:103]
M v[104:107], a[48:51], a[176:179], 0
M v[104:107], a[52:55], a[180:183], v[104:107]
M v[108:111], a[60:63], a[180:183], 0
M v[108:111], a[56:59], a[176:179], v[108:111]
s_waitcnt vmcnt(21) lgkmcnt(0)
s_barrier
ds_read_b128 a[160:163], v10 offset:16384
ds_read_b128 a[164:167], v11 offset:16384
M v[112:115], a[64:67], a[176:179], 0
s_add_u32 m0, s29, 0
s_nop 0
buffer_load_dwordx4 v2, s[8:11], s23 offen offset:0 lds
M v[112:115], a[68:71], a[180:183], v[112:115]
M v[116:119], a[76:79], a[180:183], 0
M v[116:119], a[72:75], a[176:179], v[116:119]
ds_read_b64_tr_b16 a[100:101], v12 offset:49152
ds_read_b64_tr_b16 a[102:103], v12 offset:51200
M v[120:123], a[80:83], a[176:179], 0
M v[120:123], a[84:87], a[180:183], v[120:123]
buffer_load_dwordx4 v3, s[8:11], s23 offen offset:1024 lds
M v[124:127], a[92:95], a[180:183], 0
M v[124:127], a[88:91], a[176:179], v[124:127]
M v[128:131], a[32:35], a[184:187], 0
M v[128:131], a[36:39], a[188:191], v[128:131]
ds_read_b128 a[168:171], v10 offset:18432
ds_read_b128 a[172:175], v11 offset:18432
ds_read_b64_tr_b16 a[108:109], v13 offset:49152
ds_read_b64_tr_b16 a[110:111], v13 offset:51200
M v[132:135], a[44:47], a[188:191], 0
M v[132:135], a[40:43], a[184:187], v[132:135]
M v[136:139], a[48:51], a[184:187], 0
buffer_load_dwordx4 v4, s[8:11], s23 offen offset:2048 lds
M v[136:139], a[52:55], a[188:191], v[136:139]
M v[140:143], a[60:63], a[188:191], 0
M v[140:143], a[56:59], a[184:187], v[140:143]
ds_read_b64_tr_b16 a[116:117], v14 offset:49152
ds_read_b64_tr_b16 a[118:119], v14 offset:51200
M v[144:147], a[64:67], a[184:187], 0
M v[144:147], a[68:71], a[188:191], v[144:147]
M v[148:151], a[76:79], a[188:191], 0
buffer_load_dwordx4 v5, s[8:11], s23 offen offset:3072 lds
M v[148:151], a[72:75], a[184:187], v[148:151]
M v[152:155], a[80:83], a[184:187], 0
M v[152:155], a[84:87], a[188:191], v[152:155]
ds_read_b64_tr_b16 a[124:125], v15 offset:49152
ds_read_b64_tr_b16 a[126:127], v15 offset:51200
M v[156:159], a[92:95], a[188:191], 0
M v[156:159], a[88:91], a[184:187], v[156:159]
s_waitcnt lgkmcnt(10)
M v[160:163], a[32:35], a[160:163], 0
M v[160:163], a[36:39], a[164:167], v[160:163]
ds_read_b128 a[176:179], v10 offset:20480
ds_read_b128 a[180:183], v11 offset:20480
M v[164:167], a[44:47], a[164:167], 0
s_add_u32 m0, s29, 98304
s_nop 0
buffer_load_dwordx4 v6, s[12:15], s24 offen offset:0 lds
M v[164:167], a[40:43], a[160:163], v[164:167]
ds_read_b64_tr_b16 a[132:133], v16 offset:49152
ds_read_b64_tr_b16 a[134:135], v16 offset:51200
M v[168:171], a[48:51], a[160:163], 0
M v[168:171], a[52:55], a[164:167], v[168:171]
M v[172:175], a[60:63], a[164:167], 0
M v[172:175], a[56:59], a[160:163], v[172:175]
M v[176:179], a[64:67], a[160:163], 0
buffer_load_dwordx4 v7, s[12:15], s24 offen offset:1024 lds
M v[176:179], a[68:71], a[164:167], v[176:179]
ds_read_b64_tr_b16 a[140:141], v17 offset:49152
ds_read_b64_tr_b16 a[142:143], v17 offset:51200
M v[180:183], a[76:79], a[164:167], 0
M v[180:183], a[72:75], a[160:163], v[180:183]
M v[184:187], a[80:83], a[160:163], 0
M v[184:187], a[84:87], a[164:167], v[184:187]
buffer_load_dwordx4 v8, s[12:15], s24 offen offset:2048 lds
M v[188:191], a[92:95], a[164:167], 0
M v[188:191], a[88:91], a[160:163], v[188:191]
s_waitcnt lgkmcnt(12)
ds_read_b64_tr_b16 a[148:149], v18 offset:49152
ds_read_b64_tr_b16 a[150:151], v18 offset:51200
M v[192:195], a[32:35], a[168:171], 0
M v[192:195], a[36:39], a[172:175], v[192:195]
ds_read_b128 a[184:187], v10 offset:22528
ds_read_b128 a[188:191], v11 offset:22528
M v[196:199], a[44:47], a[172:175], 0
M v[196:199], a[40:43], a[168:171], v[196:199]
M v[200:203], a[48:51], a[168:171], 0
buffer_load_dwordx4 v9, s[12:15], s24 offen offset:3072 lds
M v[200:203], a[52:55], a[172:175], v[200:203]
ds_read_b64_tr_b16 a[156:157], v19 offset:49152
ds_read_b64_tr_b16 a[158:159], v19 offset:51200
M v[204:207], a[60:63], a[172:175], 0
M v[204:207], a[56:59], a[168:171], v[204:207]
M v[208:211], a[64:67], a[168:171], 0
M v[208:211], a[68:71], a[172:175], v[208:211]
M v[212:215], a[76:79], a[172:175], 0
s_add_u32 s24, s24, 262144
M v[212:215], a[72:75], a[168:171], v[212:215]
M v[216:219], a[80:83], a[168:171], 0
M v[216:219], a[84:87], a[172:175], v[216:219]
M v[220:223], a[92:95], a[172:175], 0
M v[220:223], a[88:91], a[168:171], v[220:223]
s_waitcnt lgkmcnt(10)
M v[224:227], a[32:35], a[176:179], 0
buffer_load_dword v21, v20, s[60:63], s54 offen
s_add_u32 s54, s54, 1048576
M v[224:227], a[36:39], a[180:183], v[224:227]
M v[228:231], a[44:47], a[180:183], 0
M v[228:231], a[40:43], a[176:179], v[228:231]
M v[232:235], a[48:51], a[176:179], 0
M v[232:235], a[52:55], a[180:183], v[232:235]
M v[236:239], a[60:63], a[180:183], 0
M v[236:239], a[56:59], a[176:179], v[236:239]
s_waitcnt vmcnt(17) lgkmcnt(0)
s_barrier
ds_read_b128 a[160:163], v10 offset:32768
ds_read_b128 a[164:167], v11 offset:32768
M v[240:243], a[64:67], a[176:179], 0
s_add_u32 m0, s29, 16384
s_add_u32 s3, s23, s31
buffer_load_dwordx4 v2, s[8:11], s3 offen offset:0 lds
M v[240:243], a[68:71], a[180:183], v[240:243]
M v[244:247], a[76:79], a[180:183], 0
M v[244:247], a[72:75], a[176:179], v[244:247]
M v[248:251], a[80:83], a[176:179], 0
M v[248:251], a[84:87], a[180:183], v[248:251]
buffer_load_dwordx4 v3, s[8:11], s3 offen offset:1024 lds
M v[252:255], a[92:95], a[180:183], 0
M v[252:255], a[88:91], a[176:179], v[252:255]
M a[0:3], a[32:35], a[184:187], 0
M a[0:3], a[36:39], a[188:191], a[0:3]
ds_read_b128 a[168:171], v10 offset:34816
ds_read_b128 a[172:175], v11 offset:34816
M a[4:7], a[44:47], a[188:191], 0
M a[4:7], a[40:43], a[184:187], a[4:7]
M a[8:11], a[48:51], a[184:187], 0
buffer_load_dwordx4 v4, s[8:11], s3 offen offset:2048 lds
M a[8:11], a[52:55], a[188:191], a[8:11]
M a[12:15], a[60:63], a[188:191], 0
M a[12:15], a[56:59], a[184:187], a[12:15]
M a[16:19], a[64:67], a[184:187], 0
M a[16:19], a[68:71], a[188:191], a[16:19]
buffer_load_dwordx4 v5, s[8:11], s3 offen offset:3072 lds
M a[20:23], a[76:79], a[188:191], 0
M a[20:23], a[72:75], a[184:187], a[20:23]
M a[24:27], a[80:83], a[184:187], 0
M a[24:27], a[84:87], a[188:191], a[24:27]
M a[28:31], a[92:95], a[188:191], 0
M a[28:31], a[88:91], a[184:187], a[28:31]
s_waitcnt lgkmcnt(2)
M v[32:35], a[96:99], a[160:163], v[32:35]
s_add_u32 s23, s23, 128
s_cmp_eq_u32 s23, s25
s_cselect_b32 s23, s26, s23
M v[32:35], a[100:103], a[164:167], v[32:35]
ds_read_b128 a[176:179], v10 offset:36864
ds_read_b128 a[180:183], v11 offset:36864
M v[36:39], a[108:111], a[164:167], v[36:39]
M v[36:39], a[104:107], a[160:163], v[36:39]
ds_read_b64_tr_b16 a[32:33], v12 offset:0
ds_read_b64_tr_b16 a[34:35], v12 offset:2048
M v[40:43], a[112:115], a[160:163], v[40:43]
M v[40:43], a[116:119], a[164:167], v[40:43]
M v[44:47], a[124:127], a[164:167], v[44:47]
s_add_u32 m0, s29, 114688
s_nop 0
buffer_load_dwordx4 v6, s[12:15], s24 offen offset:0 lds
M v[44:47], a[120:123], a[160:163], v[44:47]
ds_read_b64_tr_b16 a[40:41], v13 offset:0
ds_read_b64_tr_b16 a[42:43], v13 offset:2048
M v[48:51], a[128:131], a[160:163], v[48:51]
M v[48:51], a[132:135], a[164:167], v[48:51]
M v[52:55], a[140:143], a[164:167], v[52:55]
M v[52:55], a[136:139], a[160:163], v[52:55]
ds_read_b64_tr_b16 a[48:49], v14 offset:0
ds_read_b64_tr_b16 a[50:51], v14 offset:2048
M v[56:59], a[144:147], a[160:163], v[56:59]
M v[56:59], a[148:151], a[164:167], v[56:59]
buffer_load_dwordx4 v7, s[12:15], s24 offen offset:1024 lds
M v[60:63], a[156:159], a[164:167], v[60:63]
M v[60:63], a[152:155], a[160:163], v[60:63]
s_waitcnt lgkmcnt(8)
ds_read_b64_tr_b16 a[56:57], v15 offset:0
ds_read_b64_tr_b16 a[58:59], v15 offset:2048
M v[64:67], a[96:99], a[168:171], v[64:67]
M v[64:67], a[100:103], a[172:175], v[64:67]
ds_read_b128 a[184:187], v10 offset:38912
ds_read_b128 a[188:191], v11 offset:38912
M v[68:71], a[108:111], a[172:175], v[68:71]
M v[68:71], a[104:107], a[168:171], v[68:71]
ds_read_b64_tr_b16 a[64:65], v16 offset:0
ds_read_b64_tr_b16 a[66:67], v16 offset:2048
M v[72:75], a[112:115], a[168:171], v[72:75]
buffer_load_dwordx4 v8, s[12:15], s24 offen offset:2048 lds
M v[72:75], a[116:119], a[172:175], v[72:75]
M v[76:79], a[124:127], a[172:175], v[76:79]
M v[76:79], a[120:123], a[168:171], v[76:79]
ds_read_b64_tr_b16 a[72:73], v17 offset:0
ds_read_b64_tr_b16 a[74:75], v17 offset:2048
M v[80:83], a[128:131], a[168:171], v[80:83]
M v[80:83], a[132:135], a[172:175], v[80:83]
M v[84:87], a[140:143], a[172:175], v[84:87]
buffer_load_dwordx4 v9, s[12:15], s24 offen offset:3072 lds
M v[84:87], a[136:139], a[168:171], v[84:87]
ds_read_b64_tr_b16 a[80:81], v18 offset:0
ds_read_b64_tr_b16 a[82:83], v18 offset:2048
M v[88:91], a[144:147], a[168:171], v[88:91]
M v[88:91], a[148:151], a[172:175], v[88:91]
M v[92:95], a[156:159], a[172:175], v[92:95]
M v[92:95], a[152:155], a[168:171], v[92:95]
s_waitcnt lgkmcnt(15)
ds_read_b64_tr_b16 a[88:89], v19 offset:0
ds_read_b64_tr_b16 a[90:91], v19 offset:2048
M v[96:99], a[96:99], a[176:179], v[96:99]
s_add_u32 s24, s24, 262144
s_cmp_eq_u32 s24, s27
s_cselect_b32 s24, s28, s24
s_sub_u32 s6, s6, 1
s_cmp_eq_u32 s6, 0
s_cselect_b64 s[12:13], s[64:65], s[12:13]
M v[96:99], a[100:103], a[180:183], v[96:99]
M v[100:103], a[108:111], a[180:183], v[100:103]
M v[100:103], a[104:107], a[176:179], v[100:103]
M v[104:107], a[112:115], a[176:179], v[104:107]
M v[104:107], a[116:119], a[180:183], v[104:107]
M v[108:111], a[124:127], a[180:183], v[108:111]
M v[108:111], a[120:123], a[176:179], v[108:111]
s_waitcnt vmcnt(17) lgkmcnt(0)
s_barrier
ds_read_b128 a[160:163], v10 offset:49152
ds_read_b128 a[164:167], v11 offset:49152
M v[112:115], a[128:131], a[176:179], v[112:115]
s_add_u32 m0, s29, 32768
s_nop 0
buffer_load_dwordx4 v2, s[8:11], s23 offen offset:0 lds
M v[112:115], a[132:135], a[180:183], v[112:115]
M v[116:119], a[140:143], a[180:183], v[116:119]
M v[116:119], a[136:139], a[176:179], v[116:119]
ds_read_b64_tr_b16 a[36:37], v12 offset:16384
ds_read_b64_tr_b16 a[38:39], v12 offset:18432
M v[120:123], a[144:147], a[176:179], v[120:123]
M v[120:123], a[148:151], a[180:183], v[120:123]
buffer_load_dwordx4 v3, s[8:11], s23 offen offset:1024 lds
M v[124:127], a[156:159], a[180:183], v[124:127]
M v[124:127], a[152:155], a[176:179], v[124:127]
M v[128:131], a[96:99], a[184:187], v[128:131]
M v[128:131], a[100:103], a[188:191], v[128:131]
ds_read_b128 a[168:171], v10 offset:51200
ds_read_b128 a[172:175], v11 offset:51200
ds_read_b64_tr_b16 a[44:45], v13 offset:16384
ds_read_b64_tr_b16 a[46:47], v13 offset:18432
M v[132:135], a[108:111], a[188:191], v[132:135]
M v[132:135], a[104:107], a[184:187], v[132:135]
M v[136:139], a[112:115], a[184:187], v[136:139]
buffer_load_dwordx4 v4, s[8:11], s23 offen offset:2048 lds
M v[136:139], a[116:119], a[188:191], v[136:139]
M v[140:143], a[124:127], a[188:191], v[140:143]
M v[140:143], a[120:123], a[184:187], v[140:143]
ds_read_b64_tr_b16 a[52:53], v14 offset:16384
ds_read_b64_tr_b16 a[54:55], v14 offset:18432
M v[144:147], a[128:131], a[184:187], v[144:147]
M v[144:147], a[132:135], a[188:191], v[144:147]
M v[148:151], a[140:143], a[188:191], v[148:151]
buffer_load_dwordx4 v5, s[8:11], s23 offen offset:3072 lds
M v[148:151], a[136:139], a[184:187], v[148:151]
M v[152:155], a[144:147], a[184:187], v[152:155]
M v[152:155], a[148:151], a[188:191], v[152:155]
ds_read_b64_tr_b16 a[60:61], v15 offset:16384
ds_read_b64_tr_b16 a[62:63], v15 offset:18432
M v[156:159], a[156:159], a[188:191], v[156:159]
M v[156:159], a[152:155], a[184:187], v[156:159]
s_waitcnt lgkmcnt(10)
M v[160:163], a[96:99], a[160:163], v[160:163]
M v[160:163], a[100:103], a[164:167], v[160:163]
ds_read_b128 a[176:179], v10 offset:53248
ds_read_b128 a[180:183], v11 offset:53248
M v[164:167], a[108:111], a[164:167], v[164:167]
s_add_u32 m0, s29, 65536
s_nop 0
buffer_load_dwordx4 v6, s[12:15], s24 offen offset:0 lds
M v[164:167], a[104:107], a[160:163], v[164:167]
ds_read_b64_tr_b16 a[68:69], v16 offset:16384
ds_read_b64_tr_b16 a[70:71], v16 offset:18432
M v[168:171], a[112:115], a[160:163], v[168:171]
M v[168:171], a[116:119], a[164:167], v[168:171]
M v[172:175], a[124:127], a[164:167], v[172:175]
M v[172:175], a[120:123], a[160:163], v[172:175]
M v[176:179], a[128:131], a[160:163], v[176:179]
buffer_load_dwordx4 v7, s[12:15], s24 offen offset:1024 lds
M v[176:179], a[132:135], a[164:167], v[176:179]
ds_read_b64_tr_b16 a[76:77], v17 offset:16384
ds_read_b64_tr_b16 a[78:79], v17 offset:18432
M v[180:183], a[140:143], a[164:167], v[180:183]
M v[180:183], a[136:139], a[160:163], v[180:183]
M v[184:187], a[144:147], a[160:163], v[184:187]
M v[184:187], a[148:151], a[164:167], v[184:187]
buffer_load_dwordx4 v8, s[12:15], s24 offen offset:2048 lds
M v[188:191], a[156:159], a[164:167], v[188:191]
M v[188:191], a[152:155], a[160:163], v[188:191]
s_waitcnt lgkmcnt(12)
ds_read_b64_tr_b16 a[84:85], v18 offset:16384
ds_read_b64_tr_b16 a[86:87], v18 offset:18432
M v[192:195], a[96:99], a[168:171], v[192:195]
M v[192:195], a[100:103], a[172:175], v[192:195]
ds_read_b128 a[184:187], v10 offset:55296
ds_read_b128 a[188:191], v11 offset:55296
M v[196:199], a[108:111], a[172:175], v[196:199]
M v[196:199], a[104:107], a[168:171], v[196:199]
M v[200:203], a[112:115], a[168:171], v[200:203]
buffer_load_dwordx4 v9, s[12:15], s24 offen offset:3072 lds
M v[200:203], a[116:119], a[172:175], v[200:203]
ds_read_b64_tr_b16 a[92:93], v19 offset:16384
ds_read_b64_tr_b16 a[94:95], v19 offset:18432
M v[204:207], a[124:127], a[172:175], v[204:207]
M v[204:207], a[120:123], a[168:171], v[204:207]
M v[208:211], a[128:131], a[168:171], v[208:211]
M v[208:211], a[132:135], a[172:175], v[208:211]
M v[212:215], a[140:143], a[172:175], v[212:215]
s_add_u32 s24, s24, 262144
M v[212:215], a[136:139], a[168:171], v[212:215]
M v[216:219], a[144:147], a[168:171], v[216:219]
M v[216:219], a[148:151], a[172:175], v[216:219]
M v[220:223], a[156:159], a[172:175], v[220:223]
M v[220:223], a[152:155], a[168:171], v[220:223]
s_waitcnt lgkmcnt(10)
M v[224:227], a[96:99], a[176:179], v[224:227]
buffer_load_dword v21, v20, s[60:63], s54 offen
s_add_u32 s54, s54, 1048576
M v[224:227], a[100:103], a[180:183], v[224:227]
M v[228:231], a[108:111], a[180:183], v[228:231]
M v[228:231], a[104:107], a[176:179], v[228:231]
M v[232:235], a[112:115], a[176:179], v[232:235]
M v[232:235], a[116:119], a[180:183], v[232:235]
M v[236:239], a[124:127], a[180:183], v[236:239]
M v[236:239], a[120:123], a[176:179], v[236:239]
s_waitcnt vmcnt(18) lgkmcnt(0)
s_barrier
ds_read_b128 a[160:163], v10 offset:0
ds_read_b128 a[164:167], v11 offset:0
M v[240:243], a[128:131], a[176:179], v[240:243]
s_add_u32 m0, s29, 49152
s_add_u32 s3, s23, s31
buffer_load_dwordx4 v2, s[8:11], s3 offen offset:0 lds
M v[240:243], a[132:135], a[180:183], v[240:243]
M v[244:247], a[140:143], a[180:183], v[244:247]
M v[244:247], a[136:139], a[176:179], v[244:247]
M v[248:251], a[144:147], a[176:179], v[248:251]
M v[248:251], a[148:151], a[180:183], v[248:251]
buffer_load_dwordx4 v3, s[8:11], s3 offen offset:1024 lds
M v[252:255], a[156:159], a[180:183], v[252:255]
M v[252:255], a[152:155], a[176:179], v[252:255]
M a[0:3], a[96:99], a[184:187], a[0:3]
M a[0:3], a[100:103], a[188:191], a[0:3]
ds_read_b128 a[168:171], v10 offset:2048
ds_read_b128 a[172:175], v11 offset:2048
M a[4:7], a[108:111], a[188:191], a[4:7]
M a[4:7], a[104:107], a[184:187], a[4:7]
M a[8:11], a[112:115], a[184:187], a[8:11]
buffer_load_dwordx4 v4, s[8:11], s3 offen offset:2048 lds
M a[8:11], a[116:119], a[188:191], a[8:11]
M a[12:15], a[124:127], a[188:191], a[12:15]
M a[12:15], a[120:123], a[184:187], a[12:15]
M a[16:19], a[128:131], a[184:187], a[16:19]
M a[16:19], a[132:135], a[188:191], a[16:19]
buffer_load_dwordx4 v5, s[8:11], s3 offen offset:3072 lds
M a[20:23], a[140:143], a[188:191], a[20:23]
M a[20:23], a[136:139], a[184:187], a[20:23]
M a[24:27], a[144:147], a[184:187], a[24:27]
M a[24:27], a[148:151], a[188:191], a[24:27]
M a[28:31], a[156:159], a[188:191], a[28:31]
M a[28:31], a[152:155], a[184:187], a[28:31]
s_waitcnt lgkmcnt(2)
s_mov_b32 s30, 5
Lk1_ql:
M v[32:35], a[32:35], a[160:163], v[32:35]
s_add_u32 s23, s23, 128
s_cmp_eq_u32 s23, s25
s_cselect_b32 s23, s26, s23
M v[32:35], a[36:39], a[164:167], v[32:35]
ds_read_b128 a[176:179], v10 offset:4096
ds_read_b128 a[180:183], v11 offset:4096
M v[36:39], a[44:47], a[164:167], v[36:39]
M v[36:39], a[40:43], a[160:163], v[36:39]
ds_read_b64_tr_b16 a[96:97], v12 offset:32768
ds_read_b64_tr_b16 a[98:99], v12 offset:34816
M v[40:43], a[48:51], a[160:163], v[40:43]
M v[40:43], a[52:55], a[164:167], v[40:43]
M v[44:47], a[60:63], a[164:167], v[44:47]
s_add_u32 m0, s29, 81920
s_nop 0
buffer_load_dwordx4 v6, s[12:15], s24 offen offset:0 lds
M v[44:47], a[56:59], a[160:163], v[44:47]
ds_read_b64_tr_b16 a[104:105], v13 offset:32768
ds_read_b64_tr_b16 a[106:107], v13 offset:34816
M v[48:51], a[64:67], a[160:163], v[48:51]
M v[48:51], a[68:71], a[164:167], v[48:51]
M v[52:55], a[76:79], a[164:167], v[52:55]
M v[52:55], a[72:75], a[160:163], v[52:55]
ds_read_b64_tr_b16 a[112:113], v14 offset:32768
ds_read_b64_tr_b16 a[114:115], v14 offset:34816
M v[56:59], a[80:83], a[160:163], v[56:59]
M v[56:59], a[84:87], a[164:167], v[56:59]
buffer_load_dwordx4 v7, s[12:15], s24 offen offset:1024 lds
M v[60:63], a[92:95], a[164:167], v[60:63]
M v[60:63], a[88:91], a[160:163], v[60:63]
s_waitcnt lgkmcnt(8)
ds_read_b64_tr_b16 a[120:121], v15 offset:32768
ds_read_b64_tr_b16 a[122:123], v15 offset:34816
M v[64:67], a[32:35], a[168:171], v[64:67]
M v[64:67], a[36:39], a[172:175], v[64:67]
ds_read_b128 a[184:187], v10 offset:6144
ds_read_b128 a[188:191], v11 offset:6144
M v[68:71], a[44:47], a[172:175], v[68:71]
M v[68:71], a[40:43], a[168:171], v[68:71]
ds_read_b64_tr_b16 a[128:129], v16 offset:32768
ds_read_b64_tr_b16 a[130:131], v16 offset:34816
M v[72:75], a[48:51], a[168:171], v[72:75]
buffer_load_dwordx4 v8, s[12:15], s24 offen offset:2048 lds
M v[72:75], a[52:55], a[172:175], v[72:75]
M v[76:79], a[60:63], a[172:175], v[76:79]
M v[76:79], a[56:59], a[168:171], v[76:79]
ds_read_b64_tr_b16 a[136:137], v17 offset:32768
ds_read_b64_tr_b16 a[138:139], v17 offset:34816
M v[80:83], a[64:67], a[168:171], v[80:83]
M v[80:83], a[68:71], a[172:175], v[80:83]
M v[84:87], a[76:79], a[172:175], v[84:87]
buffer_load_dwordx4 v9, s[12:15], s24 offen offset:3072 lds
M v[84:87], a[72:75], a[168:171], v[84:87]
ds_read_b64_tr_b16 a[144:145], v18 offset:32768
ds_read_b64_tr_b16 a[146:147], v18 offset:34816
M v[88:91], a[80:83], a[168:171], v[88:91]
M v[88:91], a[84:87], a[172:175], v[88:91]
M v[92:95], a[92:95], a[172:175], v[92:95]
M v[92:95], a[88:91], a[168:171], v[92:95]
s_waitcnt lgkmcnt(15)
ds_read_b64_tr_b16 a[152:153], v19 offset:32768
ds_read_b64_tr_b16 a[154:155], v19 offset:34816
M v[96:99], a[32:35], a[176:179], v[96:99]
s_add_u32 s24, s24, 262144
s_cmp_eq_u32 s24, s27
s_cselect_b32 s24, s28, s24
s_sub_u32 s6, s6, 1
s_cmp_eq_u32 s6, 0
s_cselect_b64 s[12:13], s[64:65], s[12:13]
M v[96:99], a[36:39], a[180:183], v[96:99]
M v[100:103], a[44:47], a[180:183], v[100:103]
M v[100:103], a[40:43], a[176:179], v[100:103]
M v[104:107], a[48:51], a[176:179], v[104:107]
M v[104:107], a[52:55], a[180:183], v[104:107]
M v[108:111], a[60:63], a[180:183], v[108:111]
M v[108:111], a[56:59], a[176:179], v[108:111]
s_waitcnt vmcnt(17) lgkmcnt(0)
s_barrier
ds_read_b128 a[160:163], v10 offset:16384
ds_read_b128 a[164:167], v11 offset:16384
M v[112:115], a[64:67], a[176:179], v[112:115]
s_add_u32 m0, s29, 0
s_nop 0
buffer_load_dwordx4 v2, s[8:11], s23 offen offset:0 lds
M v[112:115], a[68:71], a[180:183], v[112:115]
M v[116:119], a[76:79], a[180:183], v[116:119]
M v[116:119], a[72:75], a[176:179], v[116:119]
ds_read_b64_tr_b16 a[100:101], v12 offset:49152
ds_read_b64_tr_b16 a[102:103], v12 offset:51200
M v[120:123], a[80:83], a[176:179], v[120:123]
M v[120:123], a[84:87], a[180:183], v[120:123]
buffer_load_dwordx4 v3, s[8:11], s23 offen offset:1024 lds
M v[124:127], a[92:95], a[180:183], v[124:127]
M v[124:127], a[88:91], a[176:179], v[124:127]
M v[128:131], a[32:35], a[184:187], v[128:131]
M v[128:131], a[36:39], a[188:191], v[128:131]
ds_read_b128 a[168:171], v10 offset:18432
ds_read_b128 a[172:175], v11 offset:18432
ds_read_b64_tr_b16 a[108:109], v13 offset:49152
ds_read_b64_tr_b16 a[110:111], v13 offset:51200
M v[132:135], a[44:47], a[188:191], v[132:135]
M v[132:135], a[40:43], a[184:187], v[132:135]
M v[136:139], a[48:51], a[184:187], v[136:139]
buffer_load_dwordx4 v4, s[8:11], s23 offen offset:2048 lds
M v[136:139], a[52:55], a[188:191], v[136:139]
M v[140:143], a[60:63], a[188:191], v[140:143]
M v[140:143], a[56:59], a[184:187], v[140:143]
ds_read_b64_tr_b16 a[116:117], v14 offset:49152
ds_read_b64_tr_b16 a[118:119], v14 offset:51200
M v[144:147], a[64:67], a[184:187], v[144:147]
M v[144:147], a[68:71], a[188:191], v[144:147]
M v[148:151], a[76:79], a[188:191], v[148:151]
buffer_load_dwordx4 v5, s[8:11], s23 offen offset:3072 lds
M v[148:151], a[72:75], a[184:187], v[148:151]
M v[152:155], a[80:83], a[184:187], v[152:155]
M v[152:155], a[84:87], a[188:191], v[152:155]
ds_read_b64_tr_b16 a[124:125], v15 offset:49152
ds_read_b64_tr_b16 a[126:127], v15 offset:51200
M v[156:159], a[92:95], a[188:191], v[156:159]
M v[156:159], a[88:91], a[184:187], v[156:159]
s_waitcnt lgkmcnt(10)
M v[160:163], a[32:35], a[160:163], v[160:163]
M v[160:163], a[36:39], a[164:167], v[160:163]
ds_read_b128 a[176:179], v10 offset:20480
ds_read_b128 a[180:183], v11 offset:20480
M v[164:167], a[44:47], a[164:167], v[164:167]
s_add_u32 m0, s29, 98304
s_nop 0
buffer_load_dwordx4 v6, s[12:15], s24 offen offset:0 lds
M v[164:167], a[40:43], a[160:163], v[164:167]
ds_read_b64_tr_b16 a[132:133], v16 offset:49152
ds_read_b64_tr_b16 a[134:135], v16 offset:51200
M v[168:171], a[48:51], a[160:163], v[168:171]
M v[168:171], a[52:55], a[164:167], v[168:171]
M v[172:175], a[60:63], a[164:167], v[172:175]
M v[172:175], a[56:59], a[160:163], v[172:175]
M v[176:179], a[64:67], a[160:163], v[176:179]
buffer_load_dwordx4 v7, s[12:15], s24 offen offset:1024 lds
M v[176:179], a[68:71], a[164:167], v[176:179]
ds_read_b64_tr_b16 a[140:141], v17 offset:49152
ds_read_b64_tr_b16 a[142:143], v17 offset:51200
M v[180:183], a[76:79], a[164:167], v[180:183]
M v[180:183], a[72:75], a[160:163], v[180:183]
M v[184:187], a[80:83], a[160:163], v[184:187]
M v[184:187], a[84:87], a[164:167], v[184:187]
buffer_load_dwordx4 v8, s[12:15], s24 offen offset:2048 lds
M v[188:191], a[92:95], a[164:167], v[188:191]
M v[188:191], a[88:91], a[160:163], v[188:191]
s_waitcnt lgkmcnt(12)
ds_read_b64_tr_b16 a[148:149], v18 offset:49152
ds_read_b64_tr_b16 a[150:151], v18 offset:51200
M v[192:195], a[32:35], a[168:171], v[192:195]
M v[192:195], a[36:39], a[172:175], v[192:195]
ds_read_b128 a[184:187], v10 offset:22528
ds_read_b128 a[188:191], v11 offset:22528
M v[196:199], a[44:47], a[172:175], v[196:199]
M v[196:199], a[40:43], a[168:171], v[196:199]
M v[200:203], a[48:51], a[168:171], v[200:203]
buffer_load_dwordx4 v9, s[12:15], s24 offen offset:3072 lds
M v[200:203], a[52:55], a[172:175], v[200:203]
ds_read_b64_tr_b16 a[156:157], v19 offset:49152
ds_read_b64_tr_b16 a[158:159], v19 offset:51200
M v[204:207], a[60:63], a[172:175], v[204:207]
M v[204:207], a[56:59], a[168:171], v[204:207]
M v[208:211], a[64:67], a[168:171], v[208:211]
M v[208:211], a[68:71], a[172:175], v[208:211]
M v[212:215], a[76:79], a[172:175], v[212:215]
s_add_u32 s24, s24, 262144
M v[212:215], a[72:75], a[168:171], v[212:215]
M v[216:219], a[80:83], a[168:171], v[216:219]
M v[216:219], a[84:87], a[172:175], v[216:219]
M v[220:223], a[92:95], a[172:175], v[220:223]
M v[220:223], a[88:91], a[168:171], v[220:223]
s_waitcnt lgkmcnt(10)
M v[224:227], a[32:35], a[176:179], v[224:227]
buffer_load_dword v21, v20, s[60:63], s54 offen
s_add_u32 s54, s54, 1048576
M v[224:227], a[36:39], a[180:183], v[224:227]
M v[228:231], a[44:47], a[180:183], v[228:231]
M v[228:231], a[40:43], a[176:179], v[228:231]
M v[232:235], a[48:51], a[176:179], v[232:235]
M v[232:235], a[52:55], a[180:183], v[232:235]
M v[236:239], a[60:63], a[180:183], v[236:239]
M v[236:239], a[56:59], a[176:179], v[236:239]
s_waitcnt vmcnt(18) lgkmcnt(0)
s_barrier
ds_read_b128 a[160:163], v10 offset:32768
ds_read_b128 a[164:167], v11 offset:32768
M v[240:243], a[64:67], a[176:179], v[240:243]
s_add_u32 m0, s29, 16384
s_add_u32 s3, s23, s31
buffer_load_dwordx4 v2, s[8:11], s3 offen offset:0 lds
M v[240:243], a[68:71], a[180:183], v[240:243]
M v[244:247], a[76:79], a[180:183], v[244:247]
M v[244:247], a[72:75], a[176:179], v[244:247]
M v[248:251], a[80:83], a[176:179], v[248:251]
M v[248:251], a[84:87], a[180:183], v[248:251]
buffer_load_dwordx4 v3, s[8:11], s3 offen offset:1024 lds
M v[252:255], a[92:95], a[180:183], v[252:255]
M v[252:255], a[88:91], a[176:179], v[252:255]
M a[0:3], a[32:35], a[184:187], a[0:3]
M a[0:3], a[36:39], a[188:191], a[0:3]
ds_read_b128 a[168:171], v10 offset:34816
ds_read_b128 a[172:175], v11 offset:34816
M a[4:7], a[44:47], a[188:191], a[4:7]
M a[4:7], a[40:43], a[184:187], a[4:7]
M a[8:11], a[48:51], a[184:187], a[8:11]
buffer_load_dwordx4 v4, s[8:11], s3 offen offset:2048 lds
M a[8:11], a[52:55], a[188:191], a[8:11]
M a[12:15], a[60:63], a[188:191], a[12:15]
M a[12:15], a[56:59], a[184:187], a[12:15]
M a[16:19], a[64:67], a[184:187], a[16:19]
M a[16:19], a[68:71], a[188:191], a[16:19]
buffer_load_dwordx4 v5, s[8:11], s3 offen offset:3072 lds
M a[20:23], a[76:79], a[188:191], a[20:23]
M a[20:23], a[72:75], a[184:187], a[20:23]
M a[24:27], a[80:83], a[184:187], a[24:27]
M a[24:27], a[84:87], a[188:191], a[24:27]
M a[28:31], a[92:95], a[188:191], a[28:31]
M a[28:31], a[88:91], a[184:187], a[28:31]
s_waitcnt lgkmcnt(2)
M v[32:35], a[96:99], a[160:163], v[32:35]
s_add_u32 s23, s23, 128
s_cmp_eq_u32 s23, s25
s_cselect_b32 s23, s26, s23
M v[32:35], a[100:103], a[164:167], v[32:35]
ds_read_b128 a[176:179], v10 offset:36864
ds_read_b128 a[180:183], v11 offset:36864
M v[36:39], a[108:111], a[164:167], v[36:39]
M v[36:39], a[104:107], a[160:163], v[36:39]
ds_read_b64_tr_b16 a[32:33], v12 offset:0
ds_read_b64_tr_b16 a[34:35], v12 offset:2048
M v[40:43], a[112:115], a[160:163], v[40:43]
M v[40:43], a[116:119], a[164:167], v[40:43]
M v[44:47], a[124:127], a[164:167], v[44:47]
s_add_u32 m0, s29, 114688
s_nop 0
buffer_load_dwordx4 v6, s[12:15], s24 offen offset:0 lds
M v[44:47], a[120:123], a[160:163], v[44:47]
ds_read_b64_tr_b16 a[40:41], v13 offset:0
ds_read_b64_tr_b16 a[42:43], v13 offset:2048
M v[48:51], a[128:131], a[160:163], v[48:51]
M v[48:51], a[132:135], a[164:167], v[48:51]
M v[52:55], a[140:143], a[164:167], v[52:55]
M v[52:55], a[136:139], a[160:163], v[52:55]
ds_read_b64_tr_b16 a[48:49], v14 offset:0
ds_read_b64_tr_b16 a[50:51], v14 offset:2048
M v[56:59], a[144:147], a[160:163], v[56:59]
M v[56:59], a[148:151], a[164:167], v[56:59]
buffer_load_dwordx4 v7, s[12:15], s24 offen offset:1024 lds
M v[60:63], a[156:159], a[164:167], v[60:63]
M v[60:63], a[152:155], a[160:163], v[60:63]
s_waitcnt lgkmcnt(8)
ds_read_b64_tr_b16 a[56:57], v15 offset:0
ds_read_b64_tr_b16 a[58:59], v15 offset:2048
M v[64:67], a[96:99], a[168:171], v[64:67]
M v[64:67], a[100:103], a[172:175], v[64:67]
ds_read_b128 a[184:187], v10 offset:38912
ds_read_b128 a[188:191], v11 offset:38912
M v[68:71], a[108:111], a[172:175], v[68:71]
M v[68:71], a[104:107], a[168:171], v[68:71]
ds_read_b64_tr_b16 a[64:65], v16 offset:0
ds_read_b64_tr_b16 a[66:67], v16 offset:2048
M v[72:75], a[112:115], a[168:171], v[72:75]
buffer_load_dwordx4 v8, s[12:15], s24 offen offset:2048 lds
M v[72:75], a[116:119], a[172:175], v[72:75]
M v[76:79], a[124:127], a[172:175], v[76:79]
M v[76:79], a[120:123], a[168:171], v[76:79]
ds_read_b64_tr_b16 a[72:73], v17 offset:0
ds_read_b64_tr_b16 a[74:75], v17 offset:2048
M v[80:83], a[128:131], a[168:171], v[80:83]
M v[80:83], a[132:135], a[172:175], v[80:83]
M v[84:87], a[140:143], a[172:175], v[84:87]
buffer_load_dwordx4 v9, s[12:15], s24 offen offset:3072 lds
M v[84:87], a[136:139], a[168:171], v[84:87]
ds_read_b64_tr_b16 a[80:81], v18 offset:0
ds_read_b64_tr_b16 a[82:83], v18 offset:2048
M v[88:91], a[144:147], a[168:171], v[88:91]
M v[88:91], a[148:151], a[172:175], v[88:91]
M v[92:95], a[156:159], a[172:175], v[92:95]
M v[92:95], a[152:155], a[168:171], v[92:95]
s_waitcnt lgkmcnt(15)
ds_read_b64_tr_b16 a[88:89], v19 offset:0
ds_read_b64_tr_b16 a[90:91], v19 offset:2048
M v[96:99], a[96:99], a[176:179], v[96:99]
s_add_u32 s24, s24, 262144
s_cmp_eq_u32 s24, s27
s_cselect_b32 s24, s28, s24
s_sub_u32 s6, s6, 1
s_cmp_eq_u32 s6, 0
s_cselect_b64 s[12:13], s[64:65], s[12:13]
M v[96:99], a[100:103], a[180:183], v[96:99]
M v[100:103], a[108:111], a[180:183], v[100:103]
M v[100:103], a[104:107], a[176:179], v[100:103]
M v[104:107], a[112:115], a[176:179], v[104:107]
M v[104:107], a[116:119], a[180:183], v[104:107]
M v[108:111], a[124:127], a[180:183], v[108:111]
M v[108:111], a[120:123], a[176:179], v[108:111]
s_waitcnt vmcnt(17) lgkmcnt(0)
s_barrier
ds_read_b128 a[160:163], v10 offset:49152
ds_read_b128 a[164:167], v11 offset:49152
M v[112:115], a[128:131], a[176:179], v[112:115]
s_add_u32 m0, s29, 32768
s_nop 0
buffer_load_dwordx4 v2, s[8:11], s23 offen offset:0 lds
M v[112:115], a[132:135], a[180:183], v[112:115]
M v[116:119], a[140:143], a[180:183], v[116:119]
M v[116:119], a[136:139], a[176:179], v[116:119]
ds_read_b64_tr_b16 a[36:37], v12 offset:16384
ds_read_b64_tr_b16 a[38:39], v12 offset:18432
M v[120:123], a[144:147], a[176:179], v[120:123]
M v[120:123], a[148:151], a[180:183], v[120:123]
buffer_load_dwordx4 v3, s[8:11], s23 offen offset:1024 lds
M v[124:127], a[156:159], a[180:183], v[124:127]
M v[124:127], a[152:155], a[176:179], v[124:127]
M v[128:131], a[96:99], a[184:187], v[128:131]
M v[128:131], a[100:103], a[188:191], v[128:131]
ds_read_b128 a[168:171], v10 offset:51200
ds_read_b128 a[172:175], v11 offset:51200
ds_read_b64_tr_b16 a[44:45], v13 offset:16384
ds_read_b64_tr_b16 a[46:47], v13 offset:18432
M v[132:135], a[108:111], a[188:191], v[132:135]
M v[132:135], a[104:107], a[184:187], v[132:135]
M v[136:139], a[112:115], a[184:187], v[136:139]
buffer_load_dwordx4 v4, s[8:11], s23 offen offset:2048 lds
M v[136:139], a[116:119], a[188:191], v[136:139]
M v[140:143], a[124:127], a[188:191], v[140:143]
M v[140:143], a[120:123], a[184:187], v[140:143]
ds_read_b64_tr_b16 a[52:53], v14 offset:16384
ds_read_b64_tr_b16 a[54:55], v14 offset:18432
M v[144:147], a[128:131], a[184:187], v[144:147]
M v[144:147], a[132:135], a[188:191], v[144:147]
M v[148:151], a[140:143], a[188:191], v[148:151]
buffer_load_dwordx4 v5, s[8:11], s23 offen offset:3072 lds
M v[148:151], a[136:139], a[184:187], v[148:151]
M v[152:155], a[144:147], a[184:187], v[152:155]
M v[152:155], a[148:151], a[188:191], v[152:155]
ds_read_b64_tr_b16 a[60:61], v15 offset:16384
ds_read_b64_tr_b16 a[62:63], v15 offset:18432
M v[156:159], a[156:159], a[188:191], v[156:159]
M v[156:159], a[152:155], a[184:187], v[156:159]
s_waitcnt lgkmcnt(10)
M v[160:163], a[96:99], a[160:163], v[160:163]
M v[160:163], a[100:103], a[164:167], v[160:163]
ds_read_b128 a[176:179], v10 offset:53248
ds_read_b128 a[180:183], v11 offset:53248
M v[164:167], a[108:111], a[164:167], v[164:167]
s_add_u32 m0, s29, 65536
s_nop 0
buffer_load_dwordx4 v6, s[12:15], s24 offen offset:0 lds
M v[164:167], a[104:107], a[160:163], v[164:167]
ds_read_b64_tr_b16 a[68:69], v16 offset:16384
ds_read_b64_tr_b16 a[70:71], v16 offset:18432
M v[168:171], a[112:115], a[160:163], v[168:171]
M v[168:171], a[116:119], a[164:167], v[168:171]
M v[172:175], a[124:127], a[164:167], v[172:175]
M v[172:175], a[120:123], a[160:163], v[172:175]
M v[176:179], a[128:131], a[160:163], v[176:179]
buffer_load_dwordx4 v7, s[12:15], s24 offen offset:1024 lds
M v[176:179], a[132:135], a[164:167], v[176:179]
ds_read_b64_tr_b16 a[76:77], v17 offset:16384
ds_read_b64_tr_b16 a[78:79], v17 offset:18432
M v[180:183], a[140:143], a[164:167], v[180:183]
M v[180:183], a[136:139], a[160:163], v[180:183]
M v[184:187], a[144:147], a[160:163], v[184:187]
M v[184:187], a[148:151], a[164:167], v[184:187]
buffer_load_dwordx4 v8, s[12:15], s24 offen offset:2048 lds
M v[188:191], a[156:159], a[164:167], v[188:191]
M v[188:191], a[152:155], a[160:163], v[188:191]
s_waitcnt lgkmcnt(12)
ds_read_b64_tr_b16 a[84:85], v18 offset:16384
ds_read_b64_tr_b16 a[86:87], v18 offset:18432
M v[192:195], a[96:99], a[168:171], v[192:195]
M v[192:195], a[100:103], a[172:175], v[192:195]
ds_read_b128 a[184:187], v10 offset:55296
ds_read_b128 a[188:191], v11 offset:55296
M v[196:199], a[108:111], a[172:175], v[196:199]
M v[196:199], a[104:107], a[168:171], v[196:199]
M v[200:203], a[112:115], a[168:171], v[200:203]
buffer_load_dwordx4 v9, s[12:15], s24 offen offset:3072 lds
M v[200:203], a[116:119], a[172:175], v[200:203]
ds_read_b64_tr_b16 a[92:93], v19 offset:16384
ds_read_b64_tr_b16 a[94:95], v19 offset:18432
M v[204:207], a[124:127], a[172:175], v[204:207]
M v[204:207], a[120:123], a[168:171], v[204:207]
M v[208:211], a[128:131], a[168:171], v[208:211]
M v[208:211], a[132:135], a[172:175], v[208:211]
M v[212:215], a[140:143], a[172:175], v[212:215]
s_add_u32 s24, s24, 262144
M v[212:215], a[136:139], a[168:171], v[212:215]
M v[216:219], a[144:147], a[168:171], v[216:219]
M v[216:219], a[148:151], a[172:175], v[216:219]
M v[220:223], a[156:159], a[172:175], v[220:223]
M v[220:223], a[152:155], a[168:171], v[220:223]
s_waitcnt lgkmcnt(10)
M v[224:227], a[96:99], a[176:179], v[224:227]
buffer_load_dword v21, v20, s[60:63], s54 offen
s_add_u32 s54, s54, 1048576
M v[224:227], a[100:103], a[180:183], v[224:227]
M v[228:231], a[108:111], a[180:183], v[228:231]
M v[228:231], a[104:107], a[176:179], v[228:231]
M v[232:235], a[112:115], a[176:179], v[232:235]
M v[232:235], a[116:119], a[180:183], v[232:235]
M v[236:239], a[124:127], a[180:183], v[236:239]
M v[236:239], a[120:123], a[176:179], v[236:239]
s_waitcnt vmcnt(18) lgkmcnt(0)
s_barrier
ds_read_b128 a[160:163], v10 offset:0
ds_read_b128 a[164:167], v11 offset:0
M v[240:243], a[128:131], a[176:179], v[240:243]
s_add_u32 m0, s29, 49152
s_add_u32 s3, s23, s31
buffer_load_dwordx4 v2, s[8:11], s3 offen offset:0 lds
M v[240:243], a[132:135], a[180:183], v[240:243]
M v[244:247], a[140:143], a[180:183], v[244:247]
M v[244:247], a[136:139], a[176:179], v[244:247]
M v[248:251], a[144:147], a[176:179], v[248:251]
M v[248:251], a[148:151], a[180:183], v[248:251]
buffer_load_dwordx4 v3, s[8:11], s3 offen offset:1024 lds
M v[252:255], a[156:159], a[180:183], v[252:255]
M v[252:255], a[152:155], a[176:179], v[252:255]
M a[0:3], a[96:99], a[184:187], a[0:3]
M a[0:3], a[100:103], a[188:191], a[0:3]
ds_read_b128 a[168:171], v10 offset:2048
ds_read_b128 a[172:175], v11 offset:2048
M a[4:7], a[108:111], a[188:191], a[4:7]
M a[4:7], a[104:107], a[184:187], a[4:7]
M a[8:11], a[112:115], a[184:187], a[8:11]
buffer_load_dwordx4 v4, s[8:11], s3 offen offset:2048 lds
M a[8:11], a[116:119], a[188:191], a[8:11]
M a[12:15], a[124:127], a[188:191], a[12:15]
M a[12:15], a[120:123], a[184:187], a[12:15]
M a[16:19], a[128:131], a[184:187], a[16:19]
M a[16:19], a[132:135], a[188:191], a[16:19]
buffer_load_dwordx4 v5, s[8:11], s3 offen offset:3072 lds
M a[20:23], a[140:143], a[188:191], a[20:23]
M a[20:23], a[136:139], a[184:187], a[20:23]
M a[24:27], a[144:147], a[184:187], a[24:27]
M a[24:27], a[148:151], a[188:191], a[24:27]
M a[28:31], a[156:159], a[188:191], a[28:31]
M a[28:31], a[152:155], a[184:187], a[28:31]
s_waitcnt lgkmcnt(2)
s_sub_u32 s30, s30, 1
s_cmp_lg_u32 s30, 0
s_cbranch_scc1 Lk1_ql
M v[32:35], a[32:35], a[160:163], v[32:35]
s_add_u32 s23, s23, 128
s_cmp_eq_u32 s23, s25
s_cselect_b32 s23, s26, s23
M v[32:35], a[36:39], a[164:167], v[32:35]
ds_read_b128 a[176:179], v10 offset:4096
ds_read_b128 a[180:183], v11 offset:4096
M v[36:39], a[44:47], a[164:167], v[36:39]
M v[36:39], a[40:43], a[160:163], v[36:39]
ds_read_b64_tr_b16 a[96:97], v12 offset:32768
ds_read_b64_tr_b16 a[98:99], v12 offset:34816
M v[40:43], a[48:51], a[160:163], v[40:43]
M v[40:43], a[52:55], a[164:167], v[40:43]
M v[44:47], a[60:63], a[164:167], v[44:47]
s_add_u32 m0, s29, 81920
s_nop 0
buffer_load_dwordx4 v6, s[12:15], s24 offen offset:0 lds
M v[44:47], a[56:59], a[160:163], v[44:47]
ds_read_b64_tr_b16 a[104:105], v13 offset:32768
ds_read_b64_tr_b16 a[106:107], v13 offset:34816
M v[48:51], a[64:67], a[160:163], v[48:51]
M v[48:51], a[68:71], a[164:167], v[48:51]
M v[52:55], a[76:79], a[164:167], v[52:55]
M v[52:55], a[72:75], a[160:163], v[52:55]
ds_read_b64_tr_b16 a[112:113], v14 offset:32768
ds_read_b64_tr_b16 a[114:115], v14 offset:34816
M v[56:59], a[80:83], a[160:163], v[56:59]
M v[56:59], a[84:87], a[164:167], v[56:59]
buffer_load_dwordx4 v7, s[12:15], s24 offen offset:1024 lds
M v[60:63], a[92:95], a[164:167], v[60:63]
M v[60:63], a[88:91], a[160:163], v[60:63]
s_waitcnt lgkmcnt(8)
ds_read_b64_tr_b16 a[120:121], v15 offset:32768
ds_read_b64_tr_b16 a[122:123], v15 offset:34816
M v[64:67], a[32:35], a[168:171], v[64:67]
M v[64:67], a[36:39], a[172:175], v[64:67]
ds_read_b128 a[184:187], v10 offset:6144
ds_read_b128 a[188:191], v11 offset:6144
M v[68:71], a[44:47], a[172:175], v[68:71]
M v[68:71], a[40:43], a[168:171], v[68:71]
ds_read_b64_tr_b16 a[128:129], v16 offset:32768
ds_read_b64_tr_b16 a[130:131], v16 offset:34816
M v[72:75], a[48:51], a[168:171], v[72:75]
buffer_load_dwordx4 v8, s[12:15], s24 offen offset:2048 lds
M v[72:75], a[52:55], a[172:175], v[72:75]
M v[76:79], a[60:63], a[172:175], v[76:79]
M v[76:79], a[56:59], a[168:171], v[76:79]
ds_read_b64_tr_b16 a[136:137], v17 offset:32768
ds_read_b64_tr_b16 a[138:139], v17 offset:34816
M v[80:83], a[64:67], a[168:171], v[80:83]
M v[80:83], a[68:71], a[172:175], v[80:83]
M v[84:87], a[76:79], a[172:175], v[84:87]
buffer_load_dwordx4 v9, s[12:15], s24 offen offset:3072 lds
M v[84:87], a[72:75], a[168:171], v[84:87]
ds_read_b64_tr_b16 a[144:145], v18 offset:32768
ds_read_b64_tr_b16 a[146:147], v18 offset:34816
M v[88:91], a[80:83], a[168:171], v[88:91]
M v[88:91], a[84:87], a[172:175], v[88:91]
M v[92:95], a[92:95], a[172:175], v[92:95]
M v[92:95], a[88:91], a[168:171], v[92:95]
s_waitcnt lgkmcnt(15)
ds_read_b64_tr_b16 a[152:153], v19 offset:32768
ds_read_b64_tr_b16 a[154:155], v19 offset:34816
M v[96:99], a[32:35], a[176:179], v[96:99]
s_add_u32 s24, s24, 262144
s_cmp_eq_u32 s24, s27
s_cselect_b32 s24, s28, s24
s_sub_u32 s6, s6, 1
s_cmp_eq_u32 s6, 0
s_cselect_b64 s[12:13], s[64:65], s[12:13]
M v[96:99], a[36:39], a[180:183], v[96:99]
M v[100:103], a[44:47], a[180:183], v[100:103]
M v[100:103], a[40:43], a[176:179], v[100:103]
M v[104:107], a[48:51], a[176:179], v[104:107]
M v[104:107], a[52:55], a[180:183], v[104:107]
M v[108:111], a[60:63], a[180:183], v[108:111]
M v[108:111], a[56:59], a[176:179], v[108:111]
s_waitcnt vmcnt(17) lgkmcnt(0)
s_barrier
ds_read_b128 a[160:163], v10 offset:16384
ds_read_b128 a[164:167], v11 offset:16384
M v[112:115], a[64:67], a[176:179], v[112:115]
s_add_u32 m0, s29, 0
s_nop 0
buffer_load_dwordx4 v2, s[8:11], s23 offen offset:0 lds
M v[112:115], a[68:71], a[180:183], v[112:115]
M v[116:119], a[76:79], a[180:183], v[116:119]
M v[116:119], a[72:75], a[176:179], v[116:119]
ds_read_b64_tr_b16 a[100:101], v12 offset:49152
ds_read_b64_tr_b16 a[102:103], v12 offset:51200
M v[120:123], a[80:83], a[176:179], v[120:123]
M v[120:123], a[84:87], a[180:183], v[120:123]
M v[124:127], a[92:95], a[180:183], v[124:127]
buffer_load_dwordx4 v3, s[8:11], s23 offen offset:1024 lds
M v[124:127], a[88:91], a[176:179], v[124:127]
M v[128:131], a[32:35], a[184:187], v[128:131]
M v[128:131], a[36:39], a[188:191], v[128:131]
ds_read_b128 a[168:171], v10 offset:18432
ds_read_b128 a[172:175], v11 offset:18432
ds_read_b64_tr_b16 a[108:109], v13 offset:49152
ds_read_b64_tr_b16 a[110:111], v13 offset:51200
M v[132:135], a[44:47], a[188:191], v[132:135]
M v[132:135], a[40:43], a[184:187], v[132:135]
M v[136:139], a[48:51], a[184:187], v[136:139]
M v[136:139], a[52:55], a[188:191], v[136:139]
buffer_load_dwordx4 v4, s[8:11], s23 offen offset:2048 lds
M v[140:143], a[60:63], a[188:191], v[140:143]
M v[140:143], a[56:59], a[184:187], v[140:143]
ds_read_b64_tr_b16 a[116:117], v14 offset:49152
ds_read_b64_tr_b16 a[118:119], v14 offset:51200
M v[144:147], a[64:67], a[184:187], v[144:147]
M v[144:147], a[68:71], a[188:191], v[144:147]
M v[148:151], a[76:79], a[188:191], v[148:151]
M v[148:151], a[72:75], a[184:187], v[148:151]
M v[152:155], a[80:83], a[184:187], v[152:155]
buffer_load_dwordx4 v5, s[8:11], s23 offen offset:3072 lds
M v[152:155], a[84:87], a[188:191], v[152:155]
ds_read_b64_tr_b16 a[124:125], v15 offset:49152
ds_read_b64_tr_b16 a[126:127], v15 offset:51200
M v[156:159], a[92:95], a[188:191], v[156:159]
M v[156:159], a[88:91], a[184:187], v[156:159]
s_waitcnt lgkmcnt(10)
M v[160:163], a[32:35], a[160:163], v[160:163]
M v[160:163], a[36:39], a[164:167], v[160:163]
ds_read_b128 a[176:179], v10 offset:20480
ds_read_b128 a[180:183], v11 offset:20480
M v[164:167], a[44:47], a[164:167], v[164:167]
M v[164:167], a[40:43], a[160:163], v[164:167]
ds_read_b64_tr_b16 a[132:133], v16 offset:49152
ds_read_b64_tr_b16 a[134:135], v16 offset:51200
M v[168:171], a[48:51], a[160:163], v[168:171]
M v[168:171], a[52:55], a[164:167], v[168:171]
s_add_u32 m0, s29, 98304
s_nop 0
buffer_load_dwordx4 v6, s[12:15], s24 offen offset:0 lds
M v[172:175], a[60:63], a[164:167], v[172:175]
M v[172:175], a[56:59], a[160:163], v[172:175]
M v[176:179], a[64:67], a[160:163], v[176:179]
M v[176:179], a[68:71], a[164:167], v[176:179]
ds_read_b64_tr_b16 a[140:141], v17 offset:49152
ds_read_b64_tr_b16 a[142:143], v17 offset:51200
M v[180:183], a[76:79], a[164:167], v[180:183]
M v[180:183], a[72:75], a[160:163], v[180:183]
buffer_load_dwordx4 v7, s[12:15], s24 offen offset:1024 lds
M v[184:187], a[80:83], a[160:163], v[184:187]
M v[184:187], a[84:87], a[164:167], v[184:187]
M v[188:191], a[92:95], a[164:167], v[188:191]
M v[188:191], a[88:91], a[160:163], v[188:191]
s_waitcnt lgkmcnt(12)
ds_read_b64_tr_b16 a[148:149], v18 offset:49152
ds_read_b64_tr_b16 a[150:151], v18 offset:51200
M v[192:195], a[32:35], a[168:171], v[192:195]
M v[192:195], a[36:39], a[172:175], v[192:195]
ds_read_b128 a[184:187], v10 offset:22528
ds_read_b128 a[188:191], v11 offset:22528
M v[196:199], a[44:47], a[172:175], v[196:199]
M v[196:199], a[40:43], a[168:171], v[196:199]
buffer_load_dwordx4 v8, s[12:15], s24 offen offset:2048 lds
M v[200:203], a[48:51], a[168:171], v[200:203]
M v[200:203], a[52:55], a[172:175], v[200:203]
ds_read_b64_tr_b16 a[156:157], v19 offset:49152
ds_read_b64_tr_b16 a[158:159], v19 offset:51200
M v[204:207], a[60:63], a[172:175], v[204:207]
M v[204:207], a[56:59], a[168:171], v[204:207]
M v[208:211], a[64:67], a[168:171], v[208:211]
M v[208:211], a[68:71], a[172:175], v[208:211]
buffer_load_dwordx4 v9, s[12:15], s24 offen offset:3072 lds
M v[212:215], a[76:79], a[172:175], v[212:215]
M v[212:215], a[72:75], a[168:171], v[212:215]
M v[216:219], a[80:83], a[168:171], v[216:219]
M v[216:219], a[84:87], a[172:175], v[216:219]
M v[220:223], a[92:95], a[172:175], v[220:223]
s_add_u32 s24, s24, 262144
M v[220:223], a[88:91], a[168:171], v[220:223]
s_waitcnt lgkmcnt(10)
M v[224:227], a[32:35], a[176:179], v[224:227]
M v[224:227], a[36:39], a[180:183], v[224:227]
M v[228:231], a[44:47], a[180:183], v[228:231]
M v[228:231], a[40:43], a[176:179], v[228:231]
M v[232:235], a[48:51], a[176:179], v[232:235]
M v[232:235], a[52:55], a[180:183], v[232:235]
M v[236:239], a[60:63], a[180:183], v[236:239]
M v[236:239], a[56:59], a[176:179], v[236:239]
s_waitcnt vmcnt(17) lgkmcnt(0)
s_barrier
ds_read_b128 a[160:163], v10 offset:32768
ds_read_b128 a[164:167], v11 offset:32768
M v[240:243], a[64:67], a[176:179], v[240:243]
s_add_u32 m0, s29, 16384
s_add_u32 s3, s23, s31
buffer_load_dwordx4 v2, s[8:11], s3 offen offset:0 lds
M v[240:243], a[68:71], a[180:183], v[240:243]
M v[244:247], a[76:79], a[180:183], v[244:247]
M v[244:247], a[72:75], a[176:179], v[244:247]
M v[248:251], a[80:83], a[176:179], v[248:251]
M v[248:251], a[84:87], a[180:183], v[248:251]
buffer_load_dwordx4 v3, s[8:11], s3 offen offset:1024 lds
M v[252:255], a[92:95], a[180:183], v[252:255]
M v[252:255], a[88:91], a[176:179], v[252:255]
M a[0:3], a[32:35], a[184:187], a[0:3]
M a[0:3], a[36:39], a[188:191], a[0:3]
ds_read_b128 a[168:171], v10 offset:34816
ds_read_b128 a[172:175], v11 offset:34816
M a[4:7], a[44:47], a[188:191], a[4:7]
M a[4:7], a[40:43], a[184:187], a[4:7]
M a[8:11], a[48:51], a[184:187], a[8:11]
buffer_load_dwordx4 v4, s[8:11], s3 offen offset:2048 lds
M a[8:11], a[52:55], a[188:191], a[8:11]
M a[12:15], a[60:63], a[188:191], a[12:15]
M a[12:15], a[56:59], a[184:187], a[12:15]
M a[16:19], a[64:67], a[184:187], a[16:19]
M a[16:19], a[68:71], a[188:191], a[16:19]
buffer_load_dwordx4 v5, s[8:11], s3 offen offset:3072 lds
M a[20:23], a[76:79], a[188:191], a[20:23]
M a[20:23], a[72:75], a[184:187], a[20:23]
M a[24:27], a[80:83], a[184:187], a[24:27]
M a[24:27], a[84:87], a[188:191], a[24:27]
M a[28:31], a[92:95], a[188:191], a[28:31]
M a[28:31], a[88:91], a[184:187], a[28:31]
s_waitcnt lgkmcnt(2)
M v[32:35], a[96:99], a[160:163], v[32:35]
s_add_u32 s23, s23, 128
s_cmp_eq_u32 s23, s25
s_cselect_b32 s23, s26, s23
M v[32:35], a[100:103], a[164:167], v[32:35]
ds_read_b128 a[176:179], v10 offset:36864
ds_read_b128 a[180:183], v11 offset:36864
M v[36:39], a[108:111], a[164:167], v[36:39]
M v[36:39], a[104:107], a[160:163], v[36:39]
ds_read_b64_tr_b16 a[32:33], v12 offset:0
ds_read_b64_tr_b16 a[34:35], v12 offset:2048
M v[40:43], a[112:115], a[160:163], v[40:43]
M v[40:43], a[116:119], a[164:167], v[40:43]
M v[44:47], a[124:127], a[164:167], v[44:47]
s_add_u32 m0, s29, 114688
s_nop 0
buffer_load_dwordx4 v6, s[12:15], s24 offen offset:0 lds
M v[44:47], a[120:123], a[160:163], v[44:47]
ds_read_b64_tr_b16 a[40:41], v13 offset:0
ds_read_b64_tr_b16 a[42:43], v13 offset:2048
M v[48:51], a[128:131], a[160:163], v[48:51]
M v[48:51], a[132:135], a[164:167], v[48:51]
M v[52:55], a[140:143], a[164:167], v[52:55]
M v[52:55], a[136:139], a[160:163], v[52:55]
ds_read_b64_tr_b16 a[48:49], v14 offset:0
ds_read_b64_tr_b16 a[50:51], v14 offset:2048
M v[56:59], a[144:147], a[160:163], v[56:59]
M v[56:59], a[148:151], a[164:167], v[56:59]
buffer_load_dwordx4 v7, s[12:15], s24 offen offset:1024 lds
M v[60:63], a[156:159], a[164:167], v[60:63]
M v[60:63], a[152:155], a[160:163], v[60:63]
s_waitcnt lgkmcnt(8)
ds_read_b64_tr_b16 a[56:57], v15 offset:0
ds_read_b64_tr_b16 a[58:59], v15 offset:2048
M v[64:67], a[96:99], a[168:171], v[64:67]
M v[64:67], a[100:103], a[172:175], v[64:67]
ds_read_b128 a[184:187], v10 offset:38912
ds_read_b128 a[188:191], v11 offset:38912
M v[68:71], a[108:111], a[172:175], v[68:71]
M v[68:71], a[104:107], a[168:171], v[68:71]
ds_read_b64_tr_b16 a[64:65], v16 offset:0
ds_read_b64_tr_b16 a[66:67], v16 offset:2048
M v[72:75], a[112:115], a[168:171], v[72:75]
buffer_load_dwordx4 v8, s[12:15], s24 offen offset:2048 lds
M v[72:75], a[116:119], a[172:175], v[72:75]
M v[76:79], a[124:127], a[172:175], v[76:79]
M v[76:79], a[120:123], a[168:171], v[76:79]
ds_read_b64_tr_b16 a[72:73], v17 offset:0
ds_read_b64_tr_b16 a[74:75], v17 offset:2048
M v[80:83], a[128:131], a[168:171], v[80:83]
M v[80:83], a[132:135], a[172:175], v[80:83]
M v[84:87], a[140:143], a[172:175], v[84:87]
buffer_load_dwordx4 v9, s[12:15], s24 offen offset:3072 lds
M v[84:87], a[136:139], a[168:171], v[84:87]
ds_read_b64_tr_b16 a[80:81], v18 offset:0
ds_read_b64_tr_b16 a[82:83], v18 offset:2048
M v[88:91], a[144:147], a[168:171], v[88:91]
M v[88:91], a[148:151], a[172:175], v[88:91]
M v[92:95], a[156:159], a[172:175], v[92:95]
M v[92:95], a[152:155], a[168:171], v[92:95]
s_waitcnt lgkmcnt(15)
ds_read_b64_tr_b16 a[88:89], v19 offset:0
ds_read_b64_tr_b16 a[90:91], v19 offset:2048
M v[96:99], a[96:99], a[176:179], v[96:99]
s_add_u32 s24, s24, 262144
s_cmp_eq_u32 s24, s27
s_cselect_b32 s24, s28, s24
s_sub_u32 s6, s6, 1
s_cmp_eq_u32 s6, 0
s_cselect_b64 s[12:13], s[64:65], s[12:13]
M v[96:99], a[100:103], a[180:183], v[96:99]
M v[100:103], a[108:111], a[180:183], v[100:103]
M v[100:103], a[104:107], a[176:179], v[100:103]
M v[104:107], a[112:115], a[176:179], v[104:107]
M v[104:107], a[116:119], a[180:183], v[104:107]
M v[108:111], a[124:127], a[180:183], v[108:111]
M v[108:111], a[120:123], a[176:179], v[108:111]
s_waitcnt vmcnt(16) lgkmcnt(0)
s_barrier
ds_read_b128 a[160:163], v10 offset:49152
ds_read_b128 a[164:167], v11 offset:49152
M v[112:115], a[128:131], a[176:179], v[112:115]
s_add_u32 m0, s29, 32768
s_nop 0
buffer_load_dwordx4 v2, s[8:11], s23 offen offset:0 lds
M v[112:115], a[132:135], a[180:183], v[112:115]
M v[116:119], a[140:143], a[180:183], v[116:119]
M v[116:119], a[136:139], a[176:179], v[116:119]
ds_read_b64_tr_b16 a[36:37], v12 offset:16384
ds_read_b64_tr_b16 a[38:39], v12 offset:18432
M v[120:123], a[144:147], a[176:179], v[120:123]
M v[120:123], a[148:151], a[180:183], v[120:123]
M v[124:127], a[156:159], a[180:183], v[124:127]
M v[124:127], a[152:155], a[176:179], v[124:127]
M v[128:131], a[96:99], a[184:187], v[128:131]
M v[128:131], a[100:103], a[188:191], v[128:131]
ds_read_b128 a[168:171], v10 offset:51200
ds_read_b128 a[172:175], v11 offset:51200
ds_read_b64_tr_b16 a[44:45], v13 offset:16384
ds_read_b64_tr_b16 a[46:47], v13 offset:18432
M v[132:135], a[108:111], a[188:191], v[132:135]
M v[132:135], a[104:107], a[184:187], v[132:135]
M v[136:139], a[112:115], a[184:187], v[136:139]
M v[136:139], a[116:119], a[188:191], v[136:139]
M v[140:143], a[124:127], a[188:191], v[140:143]
M v[140:143], a[120:123], a[184:187], v[140:143]
ds_read_b64_tr_b16 a[52:53], v14 offset:16384
ds_read_b64_tr_b16 a[54:55], v14 offset:18432
M v[144:147], a[128:131], a[184:187], v[144:147]
buffer_load_dwordx4 v3, s[8:11], s23 offen offset:1024 lds
M v[144:147], a[132:135], a[188:191], v[144:147]
M v[148:151], a[140:143], a[188:191], v[148:151]
M v[148:151], a[136:139], a[184:187], v[148:151]
M v[152:155], a[144:147], a[184:187], v[152:155]
M v[152:155], a[148:151], a[188:191], v[152:155]
ds_read_b64_tr_b16 a[60:61], v15 offset:16384
ds_read_b64_tr_b16 a[62:63], v15 offset:18432
M v[156:159], a[156:159], a[188:191], v[156:159]
M v[156:159], a[152:155], a[184:187], v[156:159]
s_waitcnt lgkmcnt(10)
M v[160:163], a[96:99], a[160:163], v[160:163]
M v[160:163], a[100:103], a[164:167], v[160:163]
ds_read_b128 a[176:179], v10 offset:53248
ds_read_b128 a[180:183], v11 offset:53248
M v[164:167], a[108:111], a[164:167], v[164:167]
M v[164:167], a[104:107], a[160:163], v[164:167]
ds_read_b64_tr_b16 a[68:69], v16 offset:16384
ds_read_b64_tr_b16 a[70:71], v16 offset:18432
M v[168:171], a[112:115], a[160:163], v[168:171]
M v[168:171], a[116:119], a[164:167], v[168:171]
M v[172:175], a[124:127], a[164:167], v[172:175]
M v[172:175], a[120:123], a[160:163], v[172:175]
M v[176:179], a[128:131], a[160:163], v[176:179]
buffer_load_dwordx4 v4, s[8:11], s23 offen offset:2048 lds
M v[176:179], a[132:135], a[164:167], v[176:179]
ds_read_b64_tr_b16 a[76:77], v17 offset:16384
ds_read_b64_tr_b16 a[78:79], v17 offset:18432
M v[180:183], a[140:143], a[164:167], v[180:183]
M v[180:183], a[136:139], a[160:163], v[180:183]
M v[184:187], a[144:147], a[160:163], v[184:187]
M v[184:187], a[148:151], a[164:167], v[184:187]
M v[188:191], a[156:159], a[164:167], v[188:191]
M v[188:191], a[152:155], a[160:163], v[188:191]
s_waitcnt lgkmcnt(12)
ds_read_b64_tr_b16 a[84:85], v18 offset:16384
ds_read_b64_tr_b16 a[86:87], v18 offset:18432
M v[192:195], a[96:99], a[168:171], v[192:195]
M v[192:195], a[100:103], a[172:175], v[192:195]
ds_read_b128 a[184:187], v10 offset:55296
ds_read_b128 a[188:191], v11 offset:55296
M v[196:199], a[108:111], a[172:175], v[196:199]
M v[196:199], a[104:107], a[168:171], v[196:199]
M v[200:203], a[112:115], a[168:171], v[200:203]
M v[200:203], a[116:119], a[172:175], v[200:203]
ds_read_b64_tr_b16 a[92:93], v19 offset:16384
ds_read_b64_tr_b16 a[94:95], v19 offset:18432
M v[204:207], a[124:127], a[172:175], v[204:207]
M v[204:207], a[120:123], a[168:171], v[204:207]
M v[208:211], a[128:131], a[168:171], v[208:211]
buffer_load_dwordx4 v5, s[8:11], s23 offen offset:3072 lds
M v[208:211], a[132:135], a[172:175], v[208:211]
M v[212:215], a[140:143], a[172:175], v[212:215]
M v[212:215], a[136:139], a[168:171], v[212:215]
M v[216:219], a[144:147], a[168:171], v[216:219]
M v[216:219], a[148:151], a[172:175], v[216:219]
M v[220:223], a[156:159], a[172:175], v[220:223]
M v[220:223], a[152:155], a[168:171], v[220:223]
s_waitcnt lgkmcnt(10)
M v[224:227], a[96:99], a[176:179], v[224:227]
M v[224:227], a[100:103], a[180:183], v[224:227]
M v[228:231], a[108:111], a[180:183], v[228:231]
M v[228:231], a[104:107], a[176:179], v[228:231]
M v[232:235], a[112:115], a[176:179], v[232:235]
M v[232:235], a[116:119], a[180:183], v[232:235]
M v[236:239], a[124:127], a[180:183], v[236:239]
M v[236:239], a[120:123], a[176:179], v[236:239]
s_waitcnt vmcnt(12) lgkmcnt(0)
s_barrier
ds_read_b128 a[160:163], v10 offset:0
ds_read_b128 a[164:167], v11 offset:0
M v[240:243], a[128:131], a[176:179], v[240:243]
s_add_u32 m0, s29, 49152
s_add_u32 s3, s23, s31
buffer_load_dwordx4 v2, s[8:11], s3 offen offset:0 lds
M v[240:243], a[132:135], a[180:183], v[240:243]
M v[244:247], a[140:143], a[180:183], v[244:247]
M v[244:247], a[136:139], a[176:179], v[244:247]
M v[248:251], a[144:147], a[176:179], v[248:251]
M v[248:251], a[148:151], a[180:183], v[248:251]
M v[252:255], a[156:159], a[180:183], v[252:255]
M v[252:255], a[152:155], a[176:179], v[252:255]
M a[0:3], a[96:99], a[184:187], a[0:3]
M a[0:3], a[100:103], a[188:191], a[0:3]
ds_read_b128 a[168:171], v10 offset:2048
ds_read_b128 a[172:175], v11 offset:2048
M a[4:7], a[108:111], a[188:191], a[4:7]
M a[4:7], a[104:107], a[184:187], a[4:7]
M a[8:11], a[112:115], a[184:187], a[8:11]
buffer_load_dwordx4 v3, s[8:11], s3 offen offset:1024 lds
M a[8:11], a[116:119], a[188:191], a[8:11]
M a[12:15], a[124:127], a[188:191], a[12:15]
M a[12:15], a[120:123], a[184:187], a[12:15]
M a[16:19], a[128:131], a[184:187], a[16:19]
M a[16:19], a[132:135], a[188:191], a[16:19]
M a[20:23], a[140:143], a[188:191], a[20:23]
M a[20:23], a[136:139], a[184:187], a[20:23]
M a[24:27], a[144:147], a[184:187], a[24:27]
M a[24:27], a[148:151], a[188:191], a[24:27]
M a[28:31], a[156:159], a[188:191], a[28:31]
M a[28:31], a[152:155], a[184:187], a[28:31]
s_waitcnt lgkmcnt(2)
M v[32:35], a[32:35], a[160:163], v[32:35]
buffer_load_dwordx4 v4, s[8:11], s3 offen offset:2048 lds
M v[32:35], a[36:39], a[164:167], v[32:35]
ds_read_b128 a[176:179], v10 offset:4096
ds_read_b128 a[180:183], v11 offset:4096
M v[36:39], a[44:47], a[164:167], v[36:39]
M v[36:39], a[40:43], a[160:163], v[36:39]
ds_read_b64_tr_b16 a[96:97], v12 offset:32768
ds_read_b64_tr_b16 a[98:99], v12 offset:34816
M v[40:43], a[48:51], a[160:163], v[40:43]
M v[40:43], a[52:55], a[164:167], v[40:43]
M v[44:47], a[60:63], a[164:167], v[44:47]
M v[44:47], a[56:59], a[160:163], v[44:47]
ds_read_b64_tr_b16 a[104:105], v13 offset:32768
ds_read_b64_tr_b16 a[106:107], v13 offset:34816
M v[48:51], a[64:67], a[160:163], v[48:51]
M v[48:51], a[68:71], a[164:167], v[48:51]
M v[52:55], a[76:79], a[164:167], v[52:55]
M v[52:55], a[72:75], a[160:163], v[52:55]
ds_read_b64_tr_b16 a[112:113], v14 offset:32768
ds_read_b64_tr_b16 a[114:115], v14 offset:34816
M v[56:59], a[80:83], a[160:163], v[56:59]
M v[56:59], a[84:87], a[164:167], v[56:59]
buffer_load_dwordx4 v5, s[8:11], s3 offen offset:3072 lds
M v[60:63], a[92:95], a[164:167], v[60:63]
M v[60:63], a[88:91], a[160:163], v[60:63]
s_waitcnt lgkmcnt(8)
ds_read_b64_tr_b16 a[120:121], v15 offset:32768
ds_read_b64_tr_b16 a[122:123], v15 offset:34816
M v[64:67], a[32:35], a[168:171], v[64:67]
M v[64:67], a[36:39], a[172:175], v[64:67]
ds_read_b128 a[184:187], v10 offset:6144
ds_read_b128 a[188:191], v11 offset:6144
M v[68:71], a[44:47], a[172:175], v[68:71]
M v[68:71], a[40:43], a[168:171], v[68:71]
ds_read_b64_tr_b16 a[128:129], v16 offset:32768
ds_read_b64_tr_b16 a[130:131], v16 offset:34816
M v[72:75], a[48:51], a[168:171], v[72:75]
M v[72:75], a[52:55], a[172:175], v[72:75]
M v[76:79], a[60:63], a[172:175], v[76:79]
M v[76:79], a[56:59], a[168:171], v[76:79]
ds_read_b64_tr_b16 a[136:137], v17 offset:32768
ds_read_b64_tr_b16 a[138:139], v17 offset:34816
M v[80:83], a[64:67], a[168:171], v[80:83]
M v[80:83], a[68:71], a[172:175], v[80:83]
M v[84:87], a[76:79], a[172:175], v[84:87]
s_add_u32 s23, s23, 128
s_cmp_eq_u32 s23, s25
s_cselect_b32 s23, s26, s23
M v[84:87], a[72:75], a[168:171], v[84:87]
ds_read_b64_tr_b16 a[144:145], v18 offset:32768
ds_read_b64_tr_b16 a[146:147], v18 offset:34816
M v[88:91], a[80:83], a[168:171], v[88:91]
M v[88:91], a[84:87], a[172:175], v[88:91]
M v[92:95], a[92:95], a[172:175], v[92:95]
M v[92:95], a[88:91], a[168:171], v[92:95]
s_waitcnt lgkmcnt(15)
ds_read_b64_tr_b16 a[152:153], v19 offset:32768
ds_read_b64_tr_b16 a[154:155], v19 offset:34816
M v[96:99], a[32:35], a[176:179], v[96:99]
M v[96:99], a[36:39], a[180:183], v[96:99]
M v[100:103], a[44:47], a[180:183], v[100:103]
M v[100:103], a[40:43], a[176:179], v[100:103]
M v[104:107], a[48:51], a[176:179], v[104:107]
M v[104:107], a[52:55], a[180:183], v[104:107]
M v[108:111], a[60:63], a[180:183], v[108:111]
M v[108:111], a[56:59], a[176:179], v[108:111]
s_waitcnt vmcnt(8) lgkmcnt(0)
s_barrier
ds_read_b128 a[160:163], v10 offset:16384
ds_read_b128 a[164:167], v11 offset:16384
M v[112:115], a[64:67], a[176:179], v[112:115]
M v[112:115], a[68:71], a[180:183], v[112:115]
s_and_b32 s3, s2, 1
s_lshl_b32 s3, s3, 3
s_bfe_u32 s4, s2, 0x30003
M v[116:119], a[76:79], a[180:183], v[116:119]
s_add_u32 s26, s3, s4
s_bfe_u32 s3, s2, 0x20001
s_lshl_b32 s3, s3, 2
M v[116:119], a[72:75], a[176:179], v[116:119]
ds_read_b64_tr_b16 a[100:101], v12 offset:49152
ds_read_b64_tr_b16 a[102:103], v12 offset:51200
s_lshr_b32 s4, s2, 6
s_xor_b32 s4, s4, 2
s_add_u32 s27, s3, s4
M v[120:123], a[80:83], a[176:179], v[120:123]
s_lshl_b32 s23, s26, 18
s_sub_u32 s24, s23, 32768
M v[120:123], a[84:87], a[180:183], v[120:123]
s_max_i32 s24, s24, 0
s_lshl_b32 s25, s27, 7
s_xor_b32 s3, s26, s27
M v[124:127], a[92:95], a[180:183], v[124:127]
s_and_b32 s3, s3, 0
s_lshl_b32 s3, s3, 3
s_sub_u32 s31, 16, s3
M v[124:127], a[88:91], a[176:179], v[124:127]
s_mov_b32 s54, s31
s_movk_i32 s57, 128
s_mov_b32 s55, 4289069056
M v[128:131], a[32:35], a[184:187], v[128:131]
s_mov_b32 s56, 393216
s_lshl_b32 s4, s3, 7
M v[128:131], a[36:39], a[188:191], v[128:131]
ds_read_b128 a[168:171], v10 offset:18432
ds_read_b128 a[172:175], v11 offset:18432
ds_read_b64_tr_b16 a[108:109], v13 offset:49152
ds_read_b64_tr_b16 a[110:111], v13 offset:51200
s_add_u32 s23, s23, s4
s_add_u32 s24, s24, s4
s_mul_i32 s4, s3, 393216
M v[132:135], a[44:47], a[188:191], v[132:135]
s_add_u32 s25, s25, s4
s_mov_b64 s[8:9], s[44:45]
s_mov_b32 s10, 4194304
M v[132:135], a[40:43], a[184:187], v[132:135]
s_mov_b64 s[12:13], s[46:47]
s_mov_b32 s14, 6291456
M v[136:139], a[48:51], a[184:187], v[136:139]
s_mov_b64 s[36:37], s[90:91]
s_mov_b32 s38, 256
s_mov_b32 s39, 0x00020000
M v[136:139], a[52:55], a[188:191], v[136:139]
s_lshl_b32 s28, s20, 9
s_mul_i32 s30, s20, 6144
s_lshl_b32 s3, s20, 5
M v[140:143], a[60:63], a[188:191], v[140:143]
v_lshrrev_b32 v24, 3, v0
v_and_b32 v25, 7, v0
v_add_u32 v28, s3, v24
M v[140:143], a[56:59], a[184:187], v[140:143]
ds_read_b64_tr_b16 a[116:117], v14 offset:49152
ds_read_b64_tr_b16 a[118:119], v14 offset:51200
v_add_u32 v26, 0, v28
v_bfe_u32 v27, v26, 1, 3
M v[144:147], a[64:67], a[184:187], v[144:147]
v_xor_b32 v27, v27, v25
v_lshlrev_b32 v26, 11, v26
v_lshl_add_u32 v26, v27, 4, v26
M v[144:147], a[68:71], a[188:191], v[144:147]
v_subrev_u32 v2, 0, v26
v_add_u32 v26, 8, v28
v_bfe_u32 v27, v26, 1, 3
M v[148:151], a[76:79], a[188:191], v[148:151]
v_xor_b32 v27, v27, v25
v_lshlrev_b32 v26, 11, v26
v_lshl_add_u32 v26, v27, 4, v26
M v[148:151], a[72:75], a[184:187], v[148:151]
v_subrev_u32 v3, 1024, v26
v_add_u32 v26, 16, v28
M v[152:155], a[80:83], a[184:187], v[152:155]
v_bfe_u32 v27, v26, 1, 3
v_xor_b32 v27, v27, v25
v_lshlrev_b32 v26, 11, v26
M v[152:155], a[84:87], a[188:191], v[152:155]
ds_read_b64_tr_b16 a[124:125], v15 offset:49152
ds_read_b64_tr_b16 a[126:127], v15 offset:51200
v_lshl_add_u32 v26, v27, 4, v26
v_subrev_u32 v4, 2048, v26
v_add_u32 v26, 24, v28
M v[156:159], a[92:95], a[188:191], v[156:159]
v_bfe_u32 v27, v26, 1, 3
v_xor_b32 v27, v27, v25
M v[156:159], a[88:91], a[184:187], v[156:159]
s_waitcnt lgkmcnt(10)
v_lshlrev_b32 v26, 11, v26
v_lshl_add_u32 v26, v27, 4, v26
v_subrev_u32 v5, 3072, v26
M v[160:163], a[32:35], a[160:163], v[160:163]
s_lshl_b32 s3, s20, 2
v_lshrrev_b32 v26, 5, v0
v_add_u32 v26, s3, v26
M v[160:163], a[36:39], a[164:167], v[160:163]
ds_read_b128 a[176:179], v10 offset:20480
ds_read_b128 a[180:183], v11 offset:20480
v_bfe_u32 v29, v0, 2, 3
v_bfe_u32 v27, v26, 1, 3
v_xor_b32 v27, v27, v29
M v[164:167], a[44:47], a[164:167], v[164:167]
v_lshlrev_b32 v27, 4, v27
v_and_b32 v30, 3, v0
M v[164:167], a[40:43], a[160:163], v[164:167]
ds_read_b64_tr_b16 a[132:133], v16 offset:49152
ds_read_b64_tr_b16 a[134:135], v16 offset:51200
v_lshl_add_u32 v27, v30, 2, v27
v_lshl_add_u32 v20, v26, 11, v27
v_add_u32 v26, 2, v26
M v[168:171], a[48:51], a[160:163], v[168:171]
v_bfe_u32 v27, v26, 1, 3
v_xor_b32 v27, v27, v29
v_lshlrev_b32 v27, 4, v27
M v[168:171], a[52:55], a[164:167], v[168:171]
v_and_b32 v30, 3, v0
v_lshl_add_u32 v27, v30, 2, v27
M v[172:175], a[60:63], a[164:167], v[172:175]
v_lshl_add_u32 v23, v26, 11, v27
v_subrev_u32 v23, 256, v23
s_mul_i32 s3, s20, 48
M v[172:175], a[56:59], a[160:163], v[172:175]
v_add_u32 v28, s3, v24
v_add_u32 v26, 0, v28
v_mul_u32_u24 v27, 0xaaab, v26
M v[176:179], a[64:67], a[160:163], v[176:179]
v_lshrrev_b32 v27, 17, v27
v_lshrrev_b32 v29, 1, v27
v_and_b32 v29, 4, v29
M v[176:179], a[68:71], a[164:167], v[176:179]
ds_read_b64_tr_b16 a[140:141], v17 offset:49152
ds_read_b64_tr_b16 a[142:143], v17 offset:51200
v_and_or_b32 v27, v27, 2, v29
v_xor_b32 v27, v27, v25
M v[180:183], a[76:79], a[164:167], v[180:183]
v_lshlrev_b32 v26, 11, v26
v_lshl_add_u32 v26, v27, 4, v26
v_subrev_u32 v6, 0, v26
M v[180:183], a[72:75], a[160:163], v[180:183]
v_add_u32 v26, 8, v28
v_mul_u32_u24 v27, 0xaaab, v26
v_lshrrev_b32 v27, 17, v27
M v[184:187], a[80:83], a[160:163], v[184:187]
v_lshrrev_b32 v29, 1, v27
v_and_b32 v29, 4, v29
v_and_or_b32 v27, v27, 2, v29
M v[184:187], a[84:87], a[164:167], v[184:187]
v_xor_b32 v27, v27, v25
v_lshlrev_b32 v26, 11, v26
M v[188:191], a[92:95], a[164:167], v[188:191]
v_lshl_add_u32 v26, v27, 4, v26
v_subrev_u32 v7, 1024, v26
v_add_u32 v26, 16, v28
M v[188:191], a[88:91], a[160:163], v[188:191]
s_waitcnt lgkmcnt(12)
ds_read_b64_tr_b16 a[148:149], v18 offset:49152
ds_read_b64_tr_b16 a[150:151], v18 offset:51200
v_mul_u32_u24 v27, 0xaaab, v26
v_lshrrev_b32 v27, 17, v27
v_lshrrev_b32 v29, 1, v27
M v[192:195], a[32:35], a[168:171], v[192:195]
v_and_b32 v29, 4, v29
v_and_or_b32 v27, v27, 2, v29
M v[192:195], a[36:39], a[172:175], v[192:195]
ds_read_b128 a[184:187], v10 offset:22528
ds_read_b128 a[188:191], v11 offset:22528
v_xor_b32 v27, v27, v25
v_lshlrev_b32 v26, 11, v26
v_lshl_add_u32 v26, v27, 4, v26
M v[196:199], a[44:47], a[172:175], v[196:199]
v_subrev_u32 v8, 2048, v26
v_add_u32 v26, 24, v28
v_mul_u32_u24 v27, 0xaaab, v26
M v[196:199], a[40:43], a[168:171], v[196:199]
v_lshrrev_b32 v27, 17, v27
v_lshrrev_b32 v29, 1, v27
v_and_b32 v29, 4, v29
M v[200:203], a[48:51], a[168:171], v[200:203]
v_and_or_b32 v27, v27, 2, v29
v_xor_b32 v27, v27, v25
M v[200:203], a[52:55], a[172:175], v[200:203]
ds_read_b64_tr_b16 a[156:157], v19 offset:49152
ds_read_b64_tr_b16 a[158:159], v19 offset:51200
v_lshlrev_b32 v26, 11, v26
v_lshl_add_u32 v26, v27, 4, v26
v_subrev_u32 v9, 3072, v26
M v[204:207], a[60:63], a[172:175], v[204:207]
v_add_u32 v26, 32, v28
v_mul_u32_u24 v27, 0xaaab, v26
v_lshrrev_b32 v27, 17, v27
M v[204:207], a[56:59], a[168:171], v[204:207]
v_lshrrev_b32 v29, 1, v27
v_and_b32 v29, 4, v29
v_and_or_b32 v27, v27, 2, v29
M v[208:211], a[64:67], a[168:171], v[208:211]
v_xor_b32 v27, v27, v25
v_lshlrev_b32 v26, 11, v26
M v[208:211], a[68:71], a[172:175], v[208:211]
v_lshl_add_u32 v26, v27, 4, v26
v_subrev_u32 v21, 0, v26
v_add_u32 v26, 40, v28
M v[212:215], a[76:79], a[172:175], v[212:215]
v_mul_u32_u24 v27, 0xaaab, v26
v_lshrrev_b32 v27, 17, v27
v_lshrrev_b32 v29, 1, v27
M v[212:215], a[72:75], a[168:171], v[212:215]
v_and_b32 v29, 4, v29
v_and_or_b32 v27, v27, 2, v29
M v[216:219], a[80:83], a[168:171], v[216:219]
v_xor_b32 v27, v27, v25
v_lshlrev_b32 v26, 11, v26
v_lshl_add_u32 v26, v27, 4, v26
M v[216:219], a[84:87], a[172:175], v[216:219]
v_subrev_u32 v22, 1024, v26
s_lshr_b32 s3, s53, 7
s_add_u32 s3, s3, s22
M v[220:223], a[92:95], a[172:175], v[220:223]
s_lshl_b32 s3, s3, 5
s_lshr_b32 s19, s52, 6
s_add_u32 s3, s3, s19
M v[220:223], a[88:91], a[168:171], v[220:223]
s_waitcnt lgkmcnt(10)
s_lshl_b32 s19, s21, 1
s_add_u32 s3, s3, s19
M v[224:227], a[32:35], a[176:179], v[224:227]
s_lshl_b32 s92, s3, 14
s_add_u32 s93, s92, 16384
s_add_u32 s16, s50, 0
M v[224:227], a[36:39], a[180:183], v[224:227]
s_addc_u32 s17, s51, 0
s_mov_b32 s18, 16777216
s_mov_b32 s19, 0x00020000
M v[228:231], a[44:47], a[180:183], v[228:231]
s_mov_b32 s4, 0x3e0293ee
s_mov_b32 s5, 0x3e0293ee
M v[228:231], a[40:43], a[176:179], v[228:231]
M v[232:235], a[48:51], a[176:179], v[232:235]
M v[232:235], a[52:55], a[180:183], v[232:235]
M v[236:239], a[60:63], a[180:183], v[236:239]
M v[236:239], a[56:59], a[176:179], v[236:239]
s_waitcnt vmcnt(4) lgkmcnt(0)
s_barrier
ds_read_b128 a[160:163], v10 offset:32768
ds_read_b128 a[164:167], v11 offset:32768
M v[240:243], a[64:67], a[176:179], v[240:243]
s_add_u32 m0, s28, 131072
s_nop 0
buffer_load_dword v20, s[8:11], s24 offen lds
M v[240:243], a[68:71], a[180:183], v[240:243]
M v[244:247], a[76:79], a[180:183], v[244:247]
M v[244:247], a[72:75], a[176:179], v[244:247]
buffer_load_dword v23, s[8:11], s24 offen offset:256 lds
M v[248:251], a[80:83], a[176:179], v[248:251]
M v[248:251], a[84:87], a[180:183], v[248:251]
M v[252:255], a[92:95], a[180:183], v[252:255]
M v[252:255], a[88:91], a[176:179], v[252:255]
M a[0:3], a[32:35], a[184:187], a[0:3]
s_add_u32 m0, s29, 133120
s_nop 0
buffer_load_dwordx4 v2, s[8:11], s23 offen offset:0 lds
M a[0:3], a[36:39], a[188:191], a[0:3]
ds_read_b128 a[168:171], v10 offset:34816
ds_read_b128 a[172:175], v11 offset:34816
M a[4:7], a[44:47], a[188:191], a[4:7]
M a[4:7], a[40:43], a[184:187], a[4:7]
M a[8:11], a[48:51], a[184:187], a[8:11]
buffer_load_dwordx4 v3, s[8:11], s23 offen offset:1024 lds
M a[8:11], a[52:55], a[188:191], a[8:11]
M a[12:15], a[60:63], a[188:191], a[12:15]
M a[12:15], a[56:59], a[184:187], a[12:15]
M a[16:19], a[64:67], a[184:187], a[16:19]
buffer_load_dwordx4 v4, s[8:11], s23 offen offset:2048 lds
M a[16:19], a[68:71], a[188:191], a[16:19]
M a[20:23], a[76:79], a[188:191], a[20:23]
M a[20:23], a[72:75], a[184:187], a[20:23]
buffer_load_dwordx4 v5, s[8:11], s23 offen offset:3072 lds
M a[24:27], a[80:83], a[184:187], a[24:27]
M a[24:27], a[84:87], a[188:191], a[24:27]
M a[28:31], a[92:95], a[188:191], a[28:31]
M a[28:31], a[88:91], a[184:187], a[28:31]
s_waitcnt lgkmcnt(2)
M v[32:35], a[96:99], a[160:163], v[32:35]
s_sub_u32 s31, s31, 1
s_cmp_eq_u32 s31, 0
s_cselect_b32 s58, -1920, s57
s_add_u32 s23, s23, s58
s_add_u32 s24, s24, s58
M v[32:35], a[100:103], a[164:167], v[32:35]
ds_read_b128 a[176:179], v10 offset:36864
ds_read_b128 a[180:183], v11 offset:36864
M v[36:39], a[108:111], a[164:167], v[36:39]
M v[36:39], a[104:107], a[160:163], v[36:39]
M v[40:43], a[112:115], a[160:163], v[40:43]
M v[40:43], a[116:119], a[164:167], v[40:43]
s_add_u32 m0, s30, 65536
s_nop 0
buffer_load_dwordx4 v6, s[12:15], s25 offen offset:0 lds
M v[44:47], a[124:127], a[164:167], v[44:47]
M v[44:47], a[120:123], a[160:163], v[44:47]
M v[48:51], a[128:131], a[160:163], v[48:51]
M v[48:51], a[132:135], a[164:167], v[48:51]
buffer_load_dwordx4 v7, s[12:15], s25 offen offset:1024 lds
M v[52:55], a[140:143], a[164:167], v[52:55]
M v[52:55], a[136:139], a[160:163], v[52:55]
M v[56:59], a[144:147], a[160:163], v[56:59]
M v[56:59], a[148:151], a[164:167], v[56:59]
buffer_load_dwordx4 v8, s[12:15], s25 offen offset:2048 lds
M v[60:63], a[156:159], a[164:167], v[60:63]
M v[60:63], a[152:155], a[160:163], v[60:63]
s_waitcnt lgkmcnt(2)
M v[64:67], a[96:99], a[168:171], v[64:67]
M v[64:67], a[100:103], a[172:175], v[64:67]
ds_read_b128 a[184:187], v10 offset:38912
ds_read_b128 a[188:191], v11 offset:38912
M v[68:71], a[108:111], a[172:175], v[68:71]
M v[68:71], a[104:107], a[168:171], v[68:71]
buffer_load_dwordx4 v9, s[12:15], s25 offen offset:3072 lds
v_pk_mul_f32 v[32:33], v[32:33], s[4:5]
v_pk_mul_f32 v[34:35], v[34:35], s[4:5]
v_pk_mul_f32 v[36:37], v[36:37], s[4:5]
M v[72:75], a[112:115], a[168:171], v[72:75]
v_pk_mul_f32 v[38:39], v[38:39], s[4:5]
v_cvt_pk_bf16_f32 v32, v32, v33
M v[72:75], a[116:119], a[172:175], v[72:75]
v_cvt_pk_bf16_f32 v33, v34, v35
v_cvt_pk_bf16_f32 v34, v36, v37
M v[76:79], a[124:127], a[172:175], v[76:79]
v_cvt_pk_bf16_f32 v35, v38, v39
v_pk_mul_f32 v[40:41], v[40:41], s[4:5]
v_pk_mul_f32 v[42:43], v[42:43], s[4:5]
M v[76:79], a[120:123], a[168:171], v[76:79]
s_add_u32 m0, s30, 69632
s_nop 0
buffer_load_dwordx4 v21, s[12:15], s25 offen offset:0 lds
v_pk_mul_f32 v[44:45], v[44:45], s[4:5]
v_pk_mul_f32 v[46:47], v[46:47], s[4:5]
M v[80:83], a[128:131], a[168:171], v[80:83]
v_cvt_pk_bf16_f32 v40, v40, v41
v_cvt_pk_bf16_f32 v41, v42, v43
M v[80:83], a[132:135], a[172:175], v[80:83]
v_cvt_pk_bf16_f32 v42, v44, v45
v_cvt_pk_bf16_f32 v43, v46, v47
M v[84:87], a[140:143], a[172:175], v[84:87]
v_pk_mul_f32 v[48:49], v[48:49], s[4:5]
v_pk_mul_f32 v[50:51], v[50:51], s[4:5]
v_pk_mul_f32 v[52:53], v[52:53], s[4:5]
M v[84:87], a[136:139], a[168:171], v[84:87]
buffer_load_dwordx4 v22, s[12:15], s25 offen offset:1024 lds
v_pk_mul_f32 v[54:55], v[54:55], s[4:5]
v_cvt_pk_bf16_f32 v48, v48, v49
M v[88:91], a[144:147], a[168:171], v[88:91]
v_cvt_pk_bf16_f32 v49, v50, v51
v_cvt_pk_bf16_f32 v50, v52, v53
M v[88:91], a[148:151], a[172:175], v[88:91]
v_cvt_pk_bf16_f32 v51, v54, v55
v_pk_mul_f32 v[56:57], v[56:57], s[4:5]
v_pk_mul_f32 v[58:59], v[58:59], s[4:5]
M v[92:95], a[156:159], a[172:175], v[92:95]
v_pk_mul_f32 v[60:61], v[60:61], s[4:5]
v_pk_mul_f32 v[62:63], v[62:63], s[4:5]
M v[92:95], a[152:155], a[168:171], v[92:95]
s_waitcnt lgkmcnt(2)
v_cvt_pk_bf16_f32 v56, v56, v57
v_cvt_pk_bf16_f32 v57, v58, v59
M v[96:99], a[96:99], a[176:179], v[96:99]
s_sub_u32 s54, s54, 1
s_cmp_eq_u32 s54, 0
s_cselect_b32 s58, s55, s56
s_add_u32 s25, s25, s58
v_cvt_pk_bf16_f32 v58, v60, v61
v_cvt_pk_bf16_f32 v59, v62, v63
M v[96:99], a[100:103], a[180:183], v[96:99]
M v[100:103], a[108:111], a[180:183], v[100:103]
M v[100:103], a[104:107], a[176:179], v[100:103]
v_pk_mul_f32 v[64:65], v[64:65], s[4:5]
v_pk_mul_f32 v[66:67], v[66:67], s[4:5]
v_pk_mul_f32 v[68:69], v[68:69], s[4:5]
M v[104:107], a[112:115], a[176:179], v[104:107]
s_add_u32 s94, s92, 0
buffer_store_dwordx4 v[32:35], v1, s[16:19], s94 offen offset:0 sc1
v_pk_mul_f32 v[70:71], v[70:71], s[4:5]
v_cvt_pk_bf16_f32 v64, v64, v65
M v[104:107], a[116:119], a[180:183], v[104:107]
v_cvt_pk_bf16_f32 v65, v66, v67
v_cvt_pk_bf16_f32 v66, v68, v69
M v[108:111], a[124:127], a[180:183], v[108:111]
v_cvt_pk_bf16_f32 v67, v70, v71
v_pk_mul_f32 v[72:73], v[72:73], s[4:5]
v_pk_mul_f32 v[74:75], v[74:75], s[4:5]
M v[108:111], a[120:123], a[176:179], v[108:111]
s_waitcnt vmcnt(13) lgkmcnt(0)
s_barrier
ds_read_b128 a[160:163], v10 offset:49152
ds_read_b128 a[164:167], v11 offset:49152
v_pk_mul_f32 v[76:77], v[76:77], s[4:5]
v_pk_mul_f32 v[78:79], v[78:79], s[4:5]
M v[112:115], a[128:131], a[176:179], v[112:115]
s_add_u32 m0, s28, 0
s_nop 0
buffer_load_dword v20, s[8:11], s24 offen lds
v_cvt_pk_bf16_f32 v72, v72, v73
v_cvt_pk_bf16_f32 v73, v74, v75
M v[112:115], a[132:135], a[180:183], v[112:115]
v_cvt_pk_bf16_f32 v74, v76, v77
v_cvt_pk_bf16_f32 v75, v78, v79
M v[116:119], a[140:143], a[180:183], v[116:119]
s_add_u32 s94, s92, 0
buffer_store_dwordx4 v[40:43], v1, s[16:19], s94 offen offset:1024 sc1
v_pk_mul_f32 v[80:81], v[80:81], s[4:5]
v_pk_mul_f32 v[82:83], v[82:83], s[4:5]
v_pk_mul_f32 v[84:85], v[84:85], s[4:5]
M v[116:119], a[136:139], a[176:179], v[116:119]
v_pk_mul_f32 v[86:87], v[86:87], s[4:5]
v_cvt_pk_bf16_f32 v80, v80, v81
M v[120:123], a[144:147], a[176:179], v[120:123]
buffer_load_dword v23, s[8:11], s24 offen offset:256 lds
v_cvt_pk_bf16_f32 v81, v82, v83
v_cvt_pk_bf16_f32 v82, v84, v85
M v[120:123], a[148:151], a[180:183], v[120:123]
v_cvt_pk_bf16_f32 v83, v86, v87
v_pk_mul_f32 v[88:89], v[88:89], s[4:5]
v_pk_mul_f32 v[90:91], v[90:91], s[4:5]
M v[124:127], a[156:159], a[180:183], v[124:127]
v_pk_mul_f32 v[92:93], v[92:93], s[4:5]
v_pk_mul_f32 v[94:95], v[94:95], s[4:5]
M v[124:127], a[152:155], a[176:179], v[124:127]
v_cvt_pk_bf16_f32 v88, v88, v89
v_cvt_pk_bf16_f32 v89, v90, v91
M v[128:131], a[96:99], a[184:187], v[128:131]
s_add_u32 m0, s29, 2048
s_nop 0
buffer_load_dwordx4 v2, s[8:11], s23 offen offset:0 lds
v_cvt_pk_bf16_f32 v90, v92, v93
v_cvt_pk_bf16_f32 v91, v94, v95
M v[128:131], a[100:103], a[188:191], v[128:131]
ds_read_b128 a[168:171], v10 offset:51200
ds_read_b128 a[172:175], v11 offset:51200
M v[132:135], a[108:111], a[188:191], v[132:135]
s_add_u32 s94, s92, 0
buffer_store_dwordx4 v[48:51], v1, s[16:19], s94 offen offset:2048 sc1
M v[132:135], a[104:107], a[184:187], v[132:135]
v_pk_mul_f32 v[96:97], v[96:97], s[4:5]
v_pk_mul_f32 v[98:99], v[98:99], s[4:5]
v_pk_mul_f32 v[100:101], v[100:101], s[4:5]
M v[136:139], a[112:115], a[184:187], v[136:139]
v_pk_mul_f32 v[102:103], v[102:103], s[4:5]
v_cvt_pk_bf16_f32 v96, v96, v97
M v[136:139], a[116:119], a[188:191], v[136:139]
buffer_load_dwordx4 v3, s[8:11], s23 offen offset:1024 lds
v_cvt_pk_bf16_f32 v97, v98, v99
v_cvt_pk_bf16_f32 v98, v100, v101
M v[140:143], a[124:127], a[188:191], v[140:143]
v_cvt_pk_bf16_f32 v99, v102, v103
v_pk_mul_f32 v[104:105], v[104:105], s[4:5]
v_pk_mul_f32 v[106:107], v[106:107], s[4:5]
M v[140:143], a[120:123], a[184:187], v[140:143]
v_pk_mul_f32 v[108:109], v[108:109], s[4:5]
v_pk_mul_f32 v[110:111], v[110:111], s[4:5]
M v[144:147], a[128:131], a[184:187], v[144:147]
s_add_u32 s94, s92, 0
buffer_store_dwordx4 v[56:59], v1, s[16:19], s94 offen offset:3072 sc1
v_cvt_pk_bf16_f32 v104, v104, v105
v_cvt_pk_bf16_f32 v105, v106, v107
M v[144:147], a[132:135], a[188:191], v[144:147]
v_cvt_pk_bf16_f32 v106, v108, v109
v_cvt_pk_bf16_f32 v107, v110, v111
M v[148:151], a[140:143], a[188:191], v[148:151]
buffer_load_dwordx4 v4, s[8:11], s23 offen offset:2048 lds
v_pk_mul_f32 v[112:113], v[112:113], s[4:5]
v_pk_mul_f32 v[114:115], v[114:115], s[4:5]
v_pk_mul_f32 v[116:117], v[116:117], s[4:5]
M v[148:151], a[136:139], a[184:187], v[148:151]
v_pk_mul_f32 v[118:119], v[118:119], s[4:5]
v_cvt_pk_bf16_f32 v112, v112, v113
M v[152:155], a[144:147], a[184:187], v[152:155]
v_cvt_pk_bf16_f32 v113, v114, v115
v_cvt_pk_bf16_f32 v114, v116, v117
M v[152:155], a[148:151], a[188:191], v[152:155]
buffer_load_dwordx4 v5, s[8:11], s23 offen offset:3072 lds
v_cvt_pk_bf16_f32 v115, v118, v119
v_pk_mul_f32 v[120:121], v[120:121], s[4:5]
v_pk_mul_f32 v[122:123], v[122:123], s[4:5]
M v[156:159], a[156:159], a[188:191], v[156:159]
v_pk_mul_f32 v[124:125], v[124:125], s[4:5]
v_pk_mul_f32 v[126:127], v[126:127], s[4:5]
M v[156:159], a[152:155], a[184:187], v[156:159]
s_add_u32 s94, s92, 4096
buffer_store_dwordx4 v[64:67], v1, s[16:19], s94 offen offset:0 sc1
s_waitcnt lgkmcnt(2)
v_cvt_pk_bf16_f32 v120, v120, v121
v_cvt_pk_bf16_f32 v121, v122, v123
M v[160:163], a[96:99], a[160:163], v[160:163]
v_cvt_pk_bf16_f32 v122, v124, v125
v_cvt_pk_bf16_f32 v123, v126, v127
M v[160:163], a[100:103], a[164:167], v[160:163]
ds_read_b128 a[176:179], v10 offset:53248
ds_read_b128 a[180:183], v11 offset:53248
M v[164:167], a[108:111], a[164:167], v[164:167]
s_sub_u32 s31, s31, 1
s_cmp_eq_u32 s31, 0
s_cselect_b32 s58, -1920, s57
s_add_u32 s23, s23, s58
s_add_u32 s24, s24, s58
M v[164:167], a[104:107], a[160:163], v[164:167]
v_pk_mul_f32 v[128:129], v[128:129], s[4:5]
v_pk_mul_f32 v[130:131], v[130:131], s[4:5]
v_pk_mul_f32 v[132:133], v[132:133], s[4:5]
M v[168:171], a[112:115], a[160:163], v[168:171]
v_pk_mul_f32 v[134:135], v[134:135], s[4:5]
v_cvt_pk_bf16_f32 v128, v128, v129
M v[168:171], a[116:119], a[164:167], v[168:171]
s_add_u32 s94, s92, 4096
buffer_store_dwordx4 v[72:75], v1, s[16:19], s94 offen offset:1024 sc1
v_cvt_pk_bf16_f32 v129, v130, v131
v_cvt_pk_bf16_f32 v130, v132, v133
M v[172:175], a[124:127], a[164:167], v[172:175]
v_cvt_pk_bf16_f32 v131, v134, v135
v_pk_mul_f32 v[136:137], v[136:137], s[4:5]
v_pk_mul_f32 v[138:139], v[138:139], s[4:5]
M v[172:175], a[120:123], a[160:163], v[172:175]
s_add_u32 m0, s30, 98304
s_nop 0
buffer_load_dwordx4 v6, s[12:15], s25 offen offset:0 lds
v_pk_mul_f32 v[140:141], v[140:141], s[4:5]
v_pk_mul_f32 v[142:143], v[142:143], s[4:5]
M v[176:179], a[128:131], a[160:163], v[176:179]
v_cvt_pk_bf16_f32 v136, v136, v137
v_cvt_pk_bf16_f32 v137, v138, v139
M v[176:179], a[132:135], a[164:167], v[176:179]
v_cvt_pk_bf16_f32 v138, v140, v141
v_cvt_pk_bf16_f32 v139, v142, v143
M v[180:183], a[140:143], a[164:167], v[180:183]
buffer_load_dwordx4 v7, s[12:15], s25 offen offset:1024 lds
v_pk_mul_f32 v[144:145], v[144:145], s[4:5]
v_pk_mul_f32 v[146:147], v[146:147], s[4:5]
v_pk_mul_f32 v[148:149], v[148:149], s[4:5]
M v[180:183], a[136:139], a[160:163], v[180:183]
v_pk_mul_f32 v[150:151], v[150:151], s[4:5]
v_cvt_pk_bf16_f32 v144, v144, v145
M v[184:187], a[144:147], a[160:163], v[184:187]
s_add_u32 s94, s92, 4096
buffer_store_dwordx4 v[80:83], v1, s[16:19], s94 offen offset:2048 sc1
v_cvt_pk_bf16_f32 v145, v146, v147
v_cvt_pk_bf16_f32 v146, v148, v149
M v[184:187], a[148:151], a[164:167], v[184:187]
v_cvt_pk_bf16_f32 v147, v150, v151
v_pk_mul_f32 v[152:153], v[152:153], s[4:5]
v_pk_mul_f32 v[154:155], v[154:155], s[4:5]
M v[188:191], a[156:159], a[164:167], v[188:191]
buffer_load_dwordx4 v8, s[12:15], s25 offen offset:2048 lds
v_pk_mul_f32 v[156:157], v[156:157], s[4:5]
v_pk_mul_f32 v[158:159], v[158:159], s[4:5]
M v[188:191], a[152:155], a[160:163], v[188:191]
s_waitcnt lgkmcnt(2)
v_cvt_pk_bf16_f32 v152, v152, v153
v_cvt_pk_bf16_f32 v153, v154, v155
M v[192:195], a[96:99], a[168:171], v[192:195]
v_cvt_pk_bf16_f32 v154, v156, v157
v_cvt_pk_bf16_f32 v155, v158, v159
M v[192:195], a[100:103], a[172:175], v[192:195]
ds_read_b128 a[184:187], v10 offset:55296
ds_read_b128 a[188:191], v11 offset:55296
M v[196:199], a[108:111], a[172:175], v[196:199]
M v[196:199], a[104:107], a[168:171], v[196:199]
s_add_u32 s94, s92, 4096
buffer_store_dwordx4 v[88:91], v1, s[16:19], s94 offen offset:3072 sc1
v_pk_mul_f32 v[160:161], v[160:161], s[4:5]
v_pk_mul_f32 v[162:163], v[162:163], s[4:5]
v_pk_mul_f32 v[164:165], v[164:165], s[4:5]
M v[200:203], a[112:115], a[168:171], v[200:203]
buffer_load_dwordx4 v9, s[12:15], s25 offen offset:3072 lds
v_pk_mul_f32 v[166:167], v[166:167], s[4:5]
v_cvt_pk_bf16_f32 v160, v160, v161
M v[200:203], a[116:119], a[172:175], v[200:203]
v_cvt_pk_bf16_f32 v161, v162, v163
v_cvt_pk_bf16_f32 v162, v164, v165
M v[204:207], a[124:127], a[172:175], v[204:207]
v_cvt_pk_bf16_f32 v163, v166, v167
v_pk_mul_f32 v[168:169], v[168:169], s[4:5]
v_pk_mul_f32 v[170:171], v[170:171], s[4:5]
M v[204:207], a[120:123], a[168:171], v[204:207]
v_pk_mul_f32 v[172:173], v[172:173], s[4:5]
v_pk_mul_f32 v[174:175], v[174:175], s[4:5]
M v[208:211], a[128:131], a[168:171], v[208:211]
s_add_u32 m0, s30, 102400
s_nop 0
buffer_load_dwordx4 v21, s[12:15], s25 offen offset:0 lds
v_cvt_pk_bf16_f32 v168, v168, v169
v_cvt_pk_bf16_f32 v169, v170, v171
M v[208:211], a[132:135], a[172:175], v[208:211]
v_cvt_pk_bf16_f32 v170, v172, v173
v_cvt_pk_bf16_f32 v171, v174, v175
M v[212:215], a[140:143], a[172:175], v[212:215]
s_add_u32 s94, s92, 8192
buffer_store_dwordx4 v[96:99], v1, s[16:19], s94 offen offset:0 sc1
v_pk_mul_f32 v[176:177], v[176:177], s[4:5]
v_pk_mul_f32 v[178:179], v[178:179], s[4:5]
v_pk_mul_f32 v[180:181], v[180:181], s[4:5]
M v[212:215], a[136:139], a[168:171], v[212:215]
v_pk_mul_f32 v[182:183], v[182:183], s[4:5]
v_cvt_pk_bf16_f32 v176, v176, v177
M v[216:219], a[144:147], a[168:171], v[216:219]
buffer_load_dwordx4 v22, s[12:15], s25 offen offset:1024 lds
v_cvt_pk_bf16_f32 v177, v178, v179
v_cvt_pk_bf16_f32 v178, v180, v181
M v[216:219], a[148:151], a[172:175], v[216:219]
v_cvt_pk_bf16_f32 v179, v182, v183
v_pk_mul_f32 v[184:185], v[184:185], s[4:5]
v_pk_mul_f32 v[186:187], v[186:187], s[4:5]
M v[220:223], a[156:159], a[172:175], v[220:223]
v_pk_mul_f32 v[188:189], v[188:189], s[4:5]
v_pk_mul_f32 v[190:191], v[190:191], s[4:5]
M v[220:223], a[152:155], a[168:171], v[220:223]
s_waitcnt lgkmcnt(2)
v_cvt_pk_bf16_f32 v184, v184, v185
v_cvt_pk_bf16_f32 v185, v186, v187
M v[224:227], a[96:99], a[176:179], v[224:227]
s_add_u32 s94, s92, 8192
buffer_store_dwordx4 v[104:107], v1, s[16:19], s94 offen offset:1024 sc1
v_cvt_pk_bf16_f32 v186, v188, v189
v_cvt_pk_bf16_f32 v187, v190, v191
M v[224:227], a[100:103], a[180:183], v[224:227]
s_sub_u32 s54, s54, 1
s_cmp_eq_u32 s54, 0
s_cselect_b32 s58, s55, s56
s_add_u32 s25, s25, s58
M v[228:231], a[108:111], a[180:183], v[228:231]
M v[228:231], a[104:107], a[176:179], v[228:231]
v_pk_mul_f32 v[192:193], v[192:193], s[4:5]
v_pk_mul_f32 v[194:195], v[194:195], s[4:5]
v_pk_mul_f32 v[196:197], v[196:197], s[4:5]
M v[232:235], a[112:115], a[176:179], v[232:235]
v_pk_mul_f32 v[198:199], v[198:199], s[4:5]
v_cvt_pk_bf16_f32 v192, v192, v193
M v[232:235], a[116:119], a[180:183], v[232:235]
v_cvt_pk_bf16_f32 v193, v194, v195
v_cvt_pk_bf16_f32 v194, v196, v197
M v[236:239], a[124:127], a[180:183], v[236:239]
v_cvt_pk_bf16_f32 v195, v198, v199
v_pk_mul_f32 v[200:201], v[200:201], s[4:5]
v_pk_mul_f32 v[202:203], v[202:203], s[4:5]
M v[236:239], a[120:123], a[176:179], v[236:239]
s_waitcnt vmcnt(63) lgkmcnt(0)
s_barrier
v_pk_mul_f32 v[204:205], v[204:205], s[4:5]
v_pk_mul_f32 v[206:207], v[206:207], s[4:5]
M v[240:243], a[128:131], a[176:179], v[240:243]
s_add_u32 s94, s92, 8192
buffer_store_dwordx4 v[112:115], v1, s[16:19], s94 offen offset:2048 sc1
v_cvt_pk_bf16_f32 v200, v200, v201
v_cvt_pk_bf16_f32 v201, v202, v203
M v[240:243], a[132:135], a[180:183], v[240:243]
s_add_u32 m0, s28, 18432
s_nop 0
buffer_load_dword v20, s[8:11], s24 offen lds
v_cvt_pk_bf16_f32 v202, v204, v205
v_cvt_pk_bf16_f32 v203, v206, v207
M v[244:247], a[140:143], a[180:183], v[244:247]
v_pk_mul_f32 v[208:209], v[208:209], s[4:5]
v_pk_mul_f32 v[210:211], v[210:211], s[4:5]
v_pk_mul_f32 v[212:213], v[212:213], s[4:5]
M v[244:247], a[136:139], a[176:179], v[244:247]
v_pk_mul_f32 v[214:215], v[214:215], s[4:5]
v_cvt_pk_bf16_f32 v208, v208, v209
M v[248:251], a[144:147], a[176:179], v[248:251]
buffer_load_dword v23, s[8:11], s24 offen offset:256 lds
v_cvt_pk_bf16_f32 v209, v210, v211
v_cvt_pk_bf16_f32 v210, v212, v213
M v[248:251], a[148:151], a[180:183], v[248:251]
v_cvt_pk_bf16_f32 v211, v214, v215
v_pk_mul_f32 v[216:217], v[216:217], s[4:5]
v_pk_mul_f32 v[218:219], v[218:219], s[4:5]
M v[252:255], a[156:159], a[180:183], v[252:255]
s_add_u32 s94, s92, 8192
buffer_store_dwordx4 v[120:123], v1, s[16:19], s94 offen offset:3072 sc1
v_pk_mul_f32 v[220:221], v[220:221], s[4:5]
v_pk_mul_f32 v[222:223], v[222:223], s[4:5]
M v[252:255], a[152:155], a[176:179], v[252:255]
v_cvt_pk_bf16_f32 v216, v216, v217
v_cvt_pk_bf16_f32 v217, v218, v219
M a[0:3], a[96:99], a[184:187], a[0:3]
v_cvt_pk_bf16_f32 v218, v220, v221
v_cvt_pk_bf16_f32 v219, v222, v223
M a[0:3], a[100:103], a[188:191], a[0:3]
s_add_u32 m0, s29, 20480
s_nop 0
buffer_load_dwordx4 v2, s[8:11], s23 offen offset:0 lds
M a[4:7], a[108:111], a[188:191], a[4:7]
M a[4:7], a[104:107], a[184:187], a[4:7]
v_pk_mul_f32 v[224:225], v[224:225], s[4:5]
v_pk_mul_f32 v[226:227], v[226:227], s[4:5]
v_pk_mul_f32 v[228:229], v[228:229], s[4:5]
M a[8:11], a[112:115], a[184:187], a[8:11]
buffer_load_dwordx4 v3, s[8:11], s23 offen offset:1024 lds
v_pk_mul_f32 v[230:231], v[230:231], s[4:5]
v_cvt_pk_bf16_f32 v224, v224, v225
M a[8:11], a[116:119], a[188:191], a[8:11]
s_add_u32 s94, s92, 12288
buffer_store_dwordx4 v[128:131], v1, s[16:19], s94 offen offset:0 sc1
v_cvt_pk_bf16_f32 v225, v226, v227
v_cvt_pk_bf16_f32 v226, v228, v229
M a[12:15], a[124:127], a[188:191], a[12:15]
v_cvt_pk_bf16_f32 v227, v230, v231
v_pk_mul_f32 v[232:233], v[232:233], s[4:5]
v_pk_mul_f32 v[234:235], v[234:235], s[4:5]
M a[12:15], a[120:123], a[184:187], a[12:15]
v_pk_mul_f32 v[236:237], v[236:237], s[4:5]
v_pk_mul_f32 v[238:239], v[238:239], s[4:5]
M a[16:19], a[128:131], a[184:187], a[16:19]
buffer_load_dwordx4 v4, s[8:11], s23 offen offset:2048 lds
v_cvt_pk_bf16_f32 v232, v232, v233
v_cvt_pk_bf16_f32 v233, v234, v235
M a[16:19], a[132:135], a[188:191], a[16:19]
v_cvt_pk_bf16_f32 v234, v236, v237
v_cvt_pk_bf16_f32 v235, v238, v239
M a[20:23], a[140:143], a[188:191], a[20:23]
v_pk_mul_f32 v[240:241], v[240:241], s[4:5]
v_pk_mul_f32 v[242:243], v[242:243], s[4:5]
v_pk_mul_f32 v[244:245], v[244:245], s[4:5]
M a[20:23], a[136:139], a[184:187], a[20:23]
buffer_load_dwordx4 v5, s[8:11], s23 offen offset:3072 lds
v_pk_mul_f32 v[246:247], v[246:247], s[4:5]
v_cvt_pk_bf16_f32 v240, v240, v241
M a[24:27], a[144:147], a[184:187], a[24:27]
s_add_u32 s94, s92, 12288
buffer_store_dwordx4 v[136:139], v1, s[16:19], s94 offen offset:1024 sc1
v_cvt_pk_bf16_f32 v241, v242, v243
v_cvt_pk_bf16_f32 v242, v244, v245
M a[24:27], a[148:151], a[188:191], a[24:27]
v_cvt_pk_bf16_f32 v243, v246, v247
v_pk_mul_f32 v[248:249], v[248:249], s[4:5]
v_pk_mul_f32 v[250:251], v[250:251], s[4:5]
M a[28:31], a[156:159], a[188:191], a[28:31]
v_pk_mul_f32 v[252:253], v[252:253], s[4:5]
v_pk_mul_f32 v[254:255], v[254:255], s[4:5]
M a[28:31], a[152:155], a[184:187], a[28:31]
v_cvt_pk_bf16_f32 v248, v248, v249
v_cvt_pk_bf16_f32 v249, v250, v251
v_cvt_pk_bf16_f32 v250, v252, v253
v_cvt_pk_bf16_f32 v251, v254, v255
v_accvgpr_read_b32 v24, a0
v_accvgpr_read_b32 v25, a1
v_accvgpr_read_b32 v26, a2
v_accvgpr_read_b32 v27, a3
v_accvgpr_read_b32 v28, a4
v_accvgpr_read_b32 v29, a5
v_accvgpr_read_b32 v30, a6
v_accvgpr_read_b32 v31, a7
v_pk_mul_f32 v[24:25], v[24:25], s[4:5]
v_pk_mul_f32 v[26:27], v[26:27], s[4:5]
v_pk_mul_f32 v[28:29], v[28:29], s[4:5]
v_pk_mul_f32 v[30:31], v[30:31], s[4:5]
v_cvt_pk_bf16_f32 v36, v24, v25
v_cvt_pk_bf16_f32 v37, v26, v27
v_cvt_pk_bf16_f32 v38, v28, v29
v_cvt_pk_bf16_f32 v39, v30, v31
v_accvgpr_read_b32 v24, a8
v_accvgpr_read_b32 v25, a9
v_accvgpr_read_b32 v26, a10
v_accvgpr_read_b32 v27, a11
v_accvgpr_read_b32 v28, a12
v_accvgpr_read_b32 v29, a13
v_accvgpr_read_b32 v30, a14
v_accvgpr_read_b32 v31, a15
v_pk_mul_f32 v[24:25], v[24:25], s[4:5]
v_pk_mul_f32 v[26:27], v[26:27], s[4:5]
v_pk_mul_f32 v[28:29], v[28:29], s[4:5]
v_pk_mul_f32 v[30:31], v[30:31], s[4:5]
v_cvt_pk_bf16_f32 v44, v24, v25
v_cvt_pk_bf16_f32 v45, v26, v27
v_cvt_pk_bf16_f32 v46, v28, v29
v_cvt_pk_bf16_f32 v47, v30, v31
v_accvgpr_read_b32 v24, a16
v_accvgpr_read_b32 v25, a17
v_accvgpr_read_b32 v26, a18
v_accvgpr_read_b32 v27, a19
v_accvgpr_read_b32 v28, a20
v_accvgpr_read_b32 v29, a21
v_accvgpr_read_b32 v30, a22
v_accvgpr_read_b32 v31, a23
v_pk_mul_f32 v[24:25], v[24:25], s[4:5]
v_pk_mul_f32 v[26:27], v[26:27], s[4:5]
v_pk_mul_f32 v[28:29], v[28:29], s[4:5]
v_pk_mul_f32 v[30:31], v[30:31], s[4:5]
v_cvt_pk_bf16_f32 v52, v24, v25
v_cvt_pk_bf16_f32 v53, v26, v27
v_cvt_pk_bf16_f32 v54, v28, v29
v_cvt_pk_bf16_f32 v55, v30, v31
v_accvgpr_read_b32 v24, a24
v_accvgpr_read_b32 v25, a25
v_accvgpr_read_b32 v26, a26
v_accvgpr_read_b32 v27, a27
v_accvgpr_read_b32 v28, a28
v_accvgpr_read_b32 v29, a29
v_accvgpr_read_b32 v30, a30
v_accvgpr_read_b32 v31, a31
v_pk_mul_f32 v[24:25], v[24:25], s[4:5]
v_pk_mul_f32 v[26:27], v[26:27], s[4:5]
v_pk_mul_f32 v[28:29], v[28:29], s[4:5]
v_pk_mul_f32 v[30:31], v[30:31], s[4:5]
v_cvt_pk_bf16_f32 v60, v24, v25
v_cvt_pk_bf16_f32 v61, v26, v27
v_cvt_pk_bf16_f32 v62, v28, v29
v_cvt_pk_bf16_f32 v63, v30, v31
s_branch Lk1_b
Lk1_spin:
s_add_u32 s40, s40, 1
s_cmp_gt_u32 s40, 1048576
s_cbranch_scc1 Lk1_got
s_sleep 2
buffer_load_dword v126, v119, s[36:39], 0 offen offset:128 sc1
s_waitcnt vmcnt(0)
v_cmp_gt_u32 vcc, 0x80, v126
s_nop 0
s_cbranch_vccnz Lk1_spin
s_branch Lk1_got
Lk1_spinq:
s_add_u32 s40, s40, 1
s_cmp_gt_u32 s40, 1048576
s_cbranch_scc1 Lk1_gotq
s_sleep 2
buffer_load_dword v125, v119, s[36:39], 0 offen offset:0 sc1
s_waitcnt vmcnt(0)
v_cmp_gt_u32 vcc, 0x80, v125
s_nop 0
s_cbranch_vccnz Lk1_spinq
s_branch Lk1_gotq
Lk1_kv:
M v[32:35], a[32:35], a[160:163], 0
s_add_u32 s23, s23, 128
s_cmp_eq_u32 s23, s25
s_cselect_b32 s23, s26, s23
M v[32:35], a[36:39], a[164:167], v[32:35]
ds_read_b128 a[176:179], v10 offset:4096
ds_read_b128 a[180:183], v11 offset:4096
M v[36:39], a[44:47], a[164:167], 0
M v[36:39], a[40:43], a[160:163], v[36:39]
ds_read_b64_tr_b16 a[96:97], v12 offset:32768
ds_read_b64_tr_b16 a[98:99], v12 offset:34816
M v[40:43], a[48:51], a[160:163], 0
M v[40:43], a[52:55], a[164:167], v[40:43]
M v[44:47], a[60:63], a[164:167], 0
s_add_u32 m0, s29, 81920
s_nop 0
buffer_load_dwordx4 v6, s[12:15], s24 offen offset:0 lds
M v[44:47], a[56:59], a[160:163], v[44:47]
ds_read_b64_tr_b16 a[104:105], v13 offset:32768
ds_read_b64_tr_b16 a[106:107], v13 offset:34816
M v[48:51], a[64:67], a[160:163], 0
M v[48:51], a[68:71], a[164:167], v[48:51]
M v[52:55], a[76:79], a[164:167], 0
M v[52:55], a[72:75], a[160:163], v[52:55]
ds_read_b64_tr_b16 a[112:113], v14 offset:32768
ds_read_b64_tr_b16 a[114:115], v14 offset:34816
M v[56:59], a[80:83], a[160:163], 0
M v[56:59], a[84:87], a[164:167], v[56:59]
buffer_load_dwordx4 v7, s[12:15], s24 offen offset:1024 lds
M v[60:63], a[92:95], a[164:167], 0
M v[60:63], a[88:91], a[160:163], v[60:63]
ds_read_b64_tr_b16 a[120:121], v15 offset:32768
ds_read_b64_tr_b16 a[122:123], v15 offset:34816
M v[64:67], a[32:35], a[168:171], 0
M v[64:67], a[36:39], a[172:175], v[64:67]
ds_read_b128 a[184:187], v10 offset:6144
ds_read_b128 a[188:191], v11 offset:6144
M v[68:71], a[44:47], a[172:175], 0
M v[68:71], a[40:43], a[168:171], v[68:71]
ds_read_b64_tr_b16 a[128:129], v16 offset:32768
ds_read_b64_tr_b16 a[130:131], v16 offset:34816
M v[72:75], a[48:51], a[168:171], 0
buffer_load_dwordx4 v8, s[12:15], s24 offen offset:2048 lds
M v[72:75], a[52:55], a[172:175], v[72:75]
M v[76:79], a[60:63], a[172:175], 0
M v[76:79], a[56:59], a[168:171], v[76:79]
ds_read_b64_tr_b16 a[136:137], v17 offset:32768
ds_read_b64_tr_b16 a[138:139], v17 offset:34816
M v[80:83], a[64:67], a[168:171], 0
M v[80:83], a[68:71], a[172:175], v[80:83]
M v[84:87], a[76:79], a[172:175], 0
buffer_load_dwordx4 v9, s[12:15], s24 offen offset:3072 lds
M v[84:87], a[72:75], a[168:171], v[84:87]
ds_read_b64_tr_b16 a[144:145], v18 offset:32768
ds_read_b64_tr_b16 a[146:147], v18 offset:34816
M v[88:91], a[80:83], a[168:171], 0
M v[88:91], a[84:87], a[172:175], v[88:91]
M v[92:95], a[92:95], a[172:175], 0
M v[92:95], a[88:91], a[168:171], v[92:95]
s_waitcnt lgkmcnt(15)
ds_read_b64_tr_b16 a[152:153], v19 offset:32768
ds_read_b64_tr_b16 a[154:155], v19 offset:34816
M v[96:99], a[32:35], a[176:179], 0
s_add_u32 s24, s24, 262144
s_cmp_eq_u32 s24, s27
s_cselect_b32 s24, s28, s24
s_sub_u32 s6, s6, 1
s_cmp_eq_u32 s6, 0
s_cselect_b64 s[12:13], s[64:65], s[12:13]
M v[96:99], a[36:39], a[180:183], v[96:99]
M v[100:103], a[44:47], a[180:183], 0
M v[100:103], a[40:43], a[176:179], v[100:103]
M v[104:107], a[48:51], a[176:179], 0
M v[104:107], a[52:55], a[180:183], v[104:107]
M v[108:111], a[60:63], a[180:183], 0
M v[108:111], a[56:59], a[176:179], v[108:111]
s_waitcnt vmcnt(21) lgkmcnt(0)
s_barrier
ds_read_b128 a[160:163], v10 offset:16384
ds_read_b128 a[164:167], v11 offset:16384
M v[112:115], a[64:67], a[176:179], 0
s_add_u32 m0, s29, 0
s_nop 0
buffer_load_dwordx4 v2, s[8:11], s23 offen offset:0 lds
M v[112:115], a[68:71], a[180:183], v[112:115]
M v[116:119], a[76:79], a[180:183], 0
M v[116:119], a[72:75], a[176:179], v[116:119]
ds_read_b64_tr_b16 a[100:101], v12 offset:49152
ds_read_b64_tr_b16 a[102:103], v12 offset:51200
M v[120:123], a[80:83], a[176:179], 0
M v[120:123], a[84:87], a[180:183], v[120:123]
M v[124:127], a[92:95], a[180:183], 0
buffer_load_dwordx4 v3, s[8:11], s23 offen offset:1024 lds
M v[124:127], a[88:91], a[176:179], v[124:127]
M v[128:131], a[32:35], a[184:187], 0
M v[128:131], a[36:39], a[188:191], v[128:131]
ds_read_b128 a[168:171], v10 offset:18432
ds_read_b128 a[172:175], v11 offset:18432
ds_read_b64_tr_b16 a[108:109], v13 offset:49152
ds_read_b64_tr_b16 a[110:111], v13 offset:51200
M v[132:135], a[44:47], a[188:191], 0
M v[132:135], a[40:43], a[184:187], v[132:135]
M v[136:139], a[48:51], a[184:187], 0
M v[136:139], a[52:55], a[188:191], v[136:139]
buffer_load_dwordx4 v4, s[8:11], s23 offen offset:2048 lds
M v[140:143], a[60:63], a[188:191], 0
M v[140:143], a[56:59], a[184:187], v[140:143]
ds_read_b64_tr_b16 a[116:117], v14 offset:49152
ds_read_b64_tr_b16 a[118:119], v14 offset:51200
M v[144:147], a[64:67], a[184:187], 0
M v[144:147], a[68:71], a[188:191], v[144:147]
M v[148:151], a[76:79], a[188:191], 0
M v[148:151], a[72:75], a[184:187], v[148:151]
M v[152:155], a[80:83], a[184:187], 0
buffer_load_dwordx4 v5, s[8:11], s23 offen offset:3072 lds
M v[152:155], a[84:87], a[188:191], v[152:155]
ds_read_b64_tr_b16 a[124:125], v15 offset:49152
ds_read_b64_tr_b16 a[126:127], v15 offset:51200
M v[156:159], a[92:95], a[188:191], 0
M v[156:159], a[88:91], a[184:187], v[156:159]
s_waitcnt lgkmcnt(10)
M v[160:163], a[32:35], a[160:163], 0
M v[160:163], a[36:39], a[164:167], v[160:163]
ds_read_b128 a[176:179], v10 offset:20480
ds_read_b128 a[180:183], v11 offset:20480
M v[164:167], a[44:47], a[164:167], 0
M v[164:167], a[40:43], a[160:163], v[164:167]
ds_read_b64_tr_b16 a[132:133], v16 offset:49152
ds_read_b64_tr_b16 a[134:135], v16 offset:51200
M v[168:171], a[48:51], a[160:163], 0
M v[168:171], a[52:55], a[164:167], v[168:171]
s_add_u32 m0, s29, 98304
s_nop 0
buffer_load_dwordx4 v6, s[12:15], s24 offen offset:0 lds
M v[172:175], a[60:63], a[164:167], 0
M v[172:175], a[56:59], a[160:163], v[172:175]
M v[176:179], a[64:67], a[160:163], 0
M v[176:179], a[68:71], a[164:167], v[176:179]
ds_read_b64_tr_b16 a[140:141], v17 offset:49152
ds_read_b64_tr_b16 a[142:143], v17 offset:51200
M v[180:183], a[76:79], a[164:167], 0
M v[180:183], a[72:75], a[160:163], v[180:183]
buffer_load_dwordx4 v7, s[12:15], s24 offen offset:1024 lds
M v[184:187], a[80:83], a[160:163], 0
M v[184:187], a[84:87], a[164:167], v[184:187]
M v[188:191], a[92:95], a[164:167], 0
M v[188:191], a[88:91], a[160:163], v[188:191]
s_waitcnt lgkmcnt(12)
ds_read_b64_tr_b16 a[148:149], v18 offset:49152
ds_read_b64_tr_b16 a[150:151], v18 offset:51200
M v[192:195], a[32:35], a[168:171], 0
M v[192:195], a[36:39], a[172:175], v[192:195]
ds_read_b128 a[184:187], v10 offset:22528
ds_read_b128 a[188:191], v11 offset:22528
M v[196:199], a[44:47], a[172:175], 0
M v[196:199], a[40:43], a[168:171], v[196:199]
buffer_load_dwordx4 v8, s[12:15], s24 offen offset:2048 lds
M v[200:203], a[48:51], a[168:171], 0
M v[200:203], a[52:55], a[172:175], v[200:203]
ds_read_b64_tr_b16 a[156:157], v19 offset:49152
ds_read_b64_tr_b16 a[158:159], v19 offset:51200
M v[204:207], a[60:63], a[172:175], 0
M v[204:207], a[56:59], a[168:171], v[204:207]
M v[208:211], a[64:67], a[168:171], 0
M v[208:211], a[68:71], a[172:175], v[208:211]
buffer_load_dwordx4 v9, s[12:15], s24 offen offset:3072 lds
M v[212:215], a[76:79], a[172:175], 0
M v[212:215], a[72:75], a[168:171], v[212:215]
M v[216:219], a[80:83], a[168:171], 0
M v[216:219], a[84:87], a[172:175], v[216:219]
M v[220:223], a[92:95], a[172:175], 0
s_add_u32 s24, s24, 262144
M v[220:223], a[88:91], a[168:171], v[220:223]
s_waitcnt lgkmcnt(10)
M v[224:227], a[32:35], a[176:179], 0
M v[224:227], a[36:39], a[180:183], v[224:227]
M v[228:231], a[44:47], a[180:183], 0
M v[228:231], a[40:43], a[176:179], v[228:231]
M v[232:235], a[48:51], a[176:179], 0
M v[232:235], a[52:55], a[180:183], v[232:235]
M v[236:239], a[60:63], a[180:183], 0
M v[236:239], a[56:59], a[176:179], v[236:239]
s_waitcnt vmcnt(16) lgkmcnt(0)
s_barrier
ds_read_b128 a[160:163], v10 offset:32768
ds_read_b128 a[164:167], v11 offset:32768
M v[240:243], a[64:67], a[176:179], 0
s_add_u32 m0, s29, 16384
s_add_u32 s3, s23, s31
buffer_load_dwordx4 v2, s[8:11], s3 offen offset:0 lds
M v[240:243], a[68:71], a[180:183], v[240:243]
M v[244:247], a[76:79], a[180:183], 0
M v[244:247], a[72:75], a[176:179], v[244:247]
M v[248:251], a[80:83], a[176:179], 0
M v[248:251], a[84:87], a[180:183], v[248:251]
buffer_load_dwordx4 v3, s[8:11], s3 offen offset:1024 lds
M v[252:255], a[92:95], a[180:183], 0
M v[252:255], a[88:91], a[176:179], v[252:255]
M a[0:3], a[32:35], a[184:187], 0
M a[0:3], a[36:39], a[188:191], a[0:3]
ds_read_b128 a[168:171], v10 offset:34816
ds_read_b128 a[172:175], v11 offset:34816
M a[4:7], a[44:47], a[188:191], 0
M a[4:7], a[40:43], a[184:187], a[4:7]
M a[8:11], a[48:51], a[184:187], 0
buffer_load_dwordx4 v4, s[8:11], s3 offen offset:2048 lds
M a[8:11], a[52:55], a[188:191], a[8:11]
M a[12:15], a[60:63], a[188:191], 0
M a[12:15], a[56:59], a[184:187], a[12:15]
M a[16:19], a[64:67], a[184:187], 0
M a[16:19], a[68:71], a[188:191], a[16:19]
buffer_load_dwordx4 v5, s[8:11], s3 offen offset:3072 lds
M a[20:23], a[76:79], a[188:191], 0
M a[20:23], a[72:75], a[184:187], a[20:23]
M a[24:27], a[80:83], a[184:187], 0
M a[24:27], a[84:87], a[188:191], a[24:27]
M a[28:31], a[92:95], a[188:191], 0
M a[28:31], a[88:91], a[184:187], a[28:31]
s_waitcnt lgkmcnt(2)
M v[32:35], a[96:99], a[160:163], v[32:35]
s_add_u32 s23, s23, 128
s_cmp_eq_u32 s23, s25
s_cselect_b32 s23, s26, s23
M v[32:35], a[100:103], a[164:167], v[32:35]
ds_read_b128 a[176:179], v10 offset:36864
ds_read_b128 a[180:183], v11 offset:36864
M v[36:39], a[108:111], a[164:167], v[36:39]
M v[36:39], a[104:107], a[160:163], v[36:39]
ds_read_b64_tr_b16 a[32:33], v12 offset:0
ds_read_b64_tr_b16 a[34:35], v12 offset:2048
M v[40:43], a[112:115], a[160:163], v[40:43]
M v[40:43], a[116:119], a[164:167], v[40:43]
M v[44:47], a[124:127], a[164:167], v[44:47]
s_add_u32 m0, s29, 114688
s_nop 0
buffer_load_dwordx4 v6, s[12:15], s24 offen offset:0 lds
M v[44:47], a[120:123], a[160:163], v[44:47]
ds_read_b64_tr_b16 a[40:41], v13 offset:0
ds_read_b64_tr_b16 a[42:43], v13 offset:2048
M v[48:51], a[128:131], a[160:163], v[48:51]
M v[48:51], a[132:135], a[164:167], v[48:51]
M v[52:55], a[140:143], a[164:167], v[52:55]
M v[52:55], a[136:139], a[160:163], v[52:55]
ds_read_b64_tr_b16 a[48:49], v14 offset:0
ds_read_b64_tr_b16 a[50:51], v14 offset:2048
M v[56:59], a[144:147], a[160:163], v[56:59]
M v[56:59], a[148:151], a[164:167], v[56:59]
buffer_load_dwordx4 v7, s[12:15], s24 offen offset:1024 lds
M v[60:63], a[156:159], a[164:167], v[60:63]
M v[60:63], a[152:155], a[160:163], v[60:63]
s_waitcnt lgkmcnt(8)
ds_read_b64_tr_b16 a[56:57], v15 offset:0
ds_read_b64_tr_b16 a[58:59], v15 offset:2048
M v[64:67], a[96:99], a[168:171], v[64:67]
M v[64:67], a[100:103], a[172:175], v[64:67]
ds_read_b128 a[184:187], v10 offset:38912
ds_read_b128 a[188:191], v11 offset:38912
M v[68:71], a[108:111], a[172:175], v[68:71]
M v[68:71], a[104:107], a[168:171], v[68:71]
ds_read_b64_tr_b16 a[64:65], v16 offset:0
ds_read_b64_tr_b16 a[66:67], v16 offset:2048
M v[72:75], a[112:115], a[168:171], v[72:75]
buffer_load_dwordx4 v8, s[12:15], s24 offen offset:2048 lds
M v[72:75], a[116:119], a[172:175], v[72:75]
M v[76:79], a[124:127], a[172:175], v[76:79]
M v[76:79], a[120:123], a[168:171], v[76:79]
ds_read_b64_tr_b16 a[72:73], v17 offset:0
ds_read_b64_tr_b16 a[74:75], v17 offset:2048
M v[80:83], a[128:131], a[168:171], v[80:83]
M v[80:83], a[132:135], a[172:175], v[80:83]
M v[84:87], a[140:143], a[172:175], v[84:87]
buffer_load_dwordx4 v9, s[12:15], s24 offen offset:3072 lds
M v[84:87], a[136:139], a[168:171], v[84:87]
ds_read_b64_tr_b16 a[80:81], v18 offset:0
ds_read_b64_tr_b16 a[82:83], v18 offset:2048
M v[88:91], a[144:147], a[168:171], v[88:91]
M v[88:91], a[148:151], a[172:175], v[88:91]
M v[92:95], a[156:159], a[172:175], v[92:95]
M v[92:95], a[152:155], a[168:171], v[92:95]
s_waitcnt lgkmcnt(15)
ds_read_b64_tr_b16 a[88:89], v19 offset:0
ds_read_b64_tr_b16 a[90:91], v19 offset:2048
M v[96:99], a[96:99], a[176:179], v[96:99]
s_add_u32 s24, s24, 262144
s_cmp_eq_u32 s24, s27
s_cselect_b32 s24, s28, s24
s_sub_u32 s6, s6, 1
s_cmp_eq_u32 s6, 0
s_cselect_b64 s[12:13], s[64:65], s[12:13]
M v[96:99], a[100:103], a[180:183], v[96:99]
M v[100:103], a[108:111], a[180:183], v[100:103]
M v[100:103], a[104:107], a[176:179], v[100:103]
M v[104:107], a[112:115], a[176:179], v[104:107]
M v[104:107], a[116:119], a[180:183], v[104:107]
M v[108:111], a[124:127], a[180:183], v[108:111]
M v[108:111], a[120:123], a[176:179], v[108:111]
s_waitcnt vmcnt(16) lgkmcnt(0)
s_barrier
ds_read_b128 a[160:163], v10 offset:49152
ds_read_b128 a[164:167], v11 offset:49152
M v[112:115], a[128:131], a[176:179], v[112:115]
s_add_u32 m0, s29, 32768
s_nop 0
buffer_load_dwordx4 v2, s[8:11], s23 offen offset:0 lds
M v[112:115], a[132:135], a[180:183], v[112:115]
M v[116:119], a[140:143], a[180:183], v[116:119]
M v[116:119], a[136:139], a[176:179], v[116:119]
ds_read_b64_tr_b16 a[36:37], v12 offset:16384
ds_read_b64_tr_b16 a[38:39], v12 offset:18432
M v[120:123], a[144:147], a[176:179], v[120:123]
M v[120:123], a[148:151], a[180:183], v[120:123]
M v[124:127], a[156:159], a[180:183], v[124:127]
buffer_load_dwordx4 v3, s[8:11], s23 offen offset:1024 lds
M v[124:127], a[152:155], a[176:179], v[124:127]
M v[128:131], a[96:99], a[184:187], v[128:131]
M v[128:131], a[100:103], a[188:191], v[128:131]
ds_read_b128 a[168:171], v10 offset:51200
ds_read_b128 a[172:175], v11 offset:51200
ds_read_b64_tr_b16 a[44:45], v13 offset:16384
ds_read_b64_tr_b16 a[46:47], v13 offset:18432
M v[132:135], a[108:111], a[188:191], v[132:135]
M v[132:135], a[104:107], a[184:187], v[132:135]
M v[136:139], a[112:115], a[184:187], v[136:139]
M v[136:139], a[116:119], a[188:191], v[136:139]
buffer_load_dwordx4 v4, s[8:11], s23 offen offset:2048 lds
M v[140:143], a[124:127], a[188:191], v[140:143]
M v[140:143], a[120:123], a[184:187], v[140:143]
ds_read_b64_tr_b16 a[52:53], v14 offset:16384
ds_read_b64_tr_b16 a[54:55], v14 offset:18432
M v[144:147], a[128:131], a[184:187], v[144:147]
M v[144:147], a[132:135], a[188:191], v[144:147]
M v[148:151], a[140:143], a[188:191], v[148:151]
M v[148:151], a[136:139], a[184:187], v[148:151]
M v[152:155], a[144:147], a[184:187], v[152:155]
buffer_load_dwordx4 v5, s[8:11], s23 offen offset:3072 lds
M v[152:155], a[148:151], a[188:191], v[152:155]
ds_read_b64_tr_b16 a[60:61], v15 offset:16384
ds_read_b64_tr_b16 a[62:63], v15 offset:18432
M v[156:159], a[156:159], a[188:191], v[156:159]
M v[156:159], a[152:155], a[184:187], v[156:159]
s_waitcnt lgkmcnt(10)
M v[160:163], a[96:99], a[160:163], v[160:163]
M v[160:163], a[100:103], a[164:167], v[160:163]
ds_read_b128 a[176:179], v10 offset:53248
ds_read_b128 a[180:183], v11 offset:53248
M v[164:167], a[108:111], a[164:167], v[164:167]
M v[164:167], a[104:107], a[160:163], v[164:167]
ds_read_b64_tr_b16 a[68:69], v16 offset:16384
ds_read_b64_tr_b16 a[70:71], v16 offset:18432
M v[168:171], a[112:115], a[160:163], v[168:171]
M v[168:171], a[116:119], a[164:167], v[168:171]
s_add_u32 m0, s29, 65536
s_nop 0
buffer_load_dwordx4 v6, s[12:15], s24 offen offset:0 lds
M v[172:175], a[124:127], a[164:167], v[172:175]
M v[172:175], a[120:123], a[160:163], v[172:175]
M v[176:179], a[128:131], a[160:163], v[176:179]
M v[176:179], a[132:135], a[164:167], v[176:179]
ds_read_b64_tr_b16 a[76:77], v17 offset:16384
ds_read_b64_tr_b16 a[78:79], v17 offset:18432
M v[180:183], a[140:143], a[164:167], v[180:183]
M v[180:183], a[136:139], a[160:163], v[180:183]
buffer_load_dwordx4 v7, s[12:15], s24 offen offset:1024 lds
M v[184:187], a[144:147], a[160:163], v[184:187]
M v[184:187], a[148:151], a[164:167], v[184:187]
M v[188:191], a[156:159], a[164:167], v[188:191]
M v[188:191], a[152:155], a[160:163], v[188:191]
s_waitcnt lgkmcnt(12)
ds_read_b64_tr_b16 a[84:85], v18 offset:16384
ds_read_b64_tr_b16 a[86:87], v18 offset:18432
M v[192:195], a[96:99], a[168:171], v[192:195]
M v[192:195], a[100:103], a[172:175], v[192:195]
ds_read_b128 a[184:187], v10 offset:55296
ds_read_b128 a[188:191], v11 offset:55296
M v[196:199], a[108:111], a[172:175], v[196:199]
M v[196:199], a[104:107], a[168:171], v[196:199]
buffer_load_dwordx4 v8, s[12:15], s24 offen offset:2048 lds
M v[200:203], a[112:115], a[168:171], v[200:203]
M v[200:203], a[116:119], a[172:175], v[200:203]
ds_read_b64_tr_b16 a[92:93], v19 offset:16384
ds_read_b64_tr_b16 a[94:95], v19 offset:18432
M v[204:207], a[124:127], a[172:175], v[204:207]
M v[204:207], a[120:123], a[168:171], v[204:207]
M v[208:211], a[128:131], a[168:171], v[208:211]
M v[208:211], a[132:135], a[172:175], v[208:211]
buffer_load_dwordx4 v9, s[12:15], s24 offen offset:3072 lds
M v[212:215], a[140:143], a[172:175], v[212:215]
M v[212:215], a[136:139], a[168:171], v[212:215]
M v[216:219], a[144:147], a[168:171], v[216:219]
M v[216:219], a[148:151], a[172:175], v[216:219]
M v[220:223], a[156:159], a[172:175], v[220:223]
s_add_u32 s24, s24, 262144
M v[220:223], a[152:155], a[168:171], v[220:223]
s_waitcnt lgkmcnt(10)
M v[224:227], a[96:99], a[176:179], v[224:227]
M v[224:227], a[100:103], a[180:183], v[224:227]
M v[228:231], a[108:111], a[180:183], v[228:231]
M v[228:231], a[104:107], a[176:179], v[228:231]
M v[232:235], a[112:115], a[176:179], v[232:235]
M v[232:235], a[116:119], a[180:183], v[232:235]
M v[236:239], a[124:127], a[180:183], v[236:239]
M v[236:239], a[120:123], a[176:179], v[236:239]
s_waitcnt vmcnt(16) lgkmcnt(0)
s_barrier
ds_read_b128 a[160:163], v10 offset:0
ds_read_b128 a[164:167], v11 offset:0
M v[240:243], a[128:131], a[176:179], v[240:243]
s_add_u32 m0, s29, 49152
s_add_u32 s3, s23, s31
buffer_load_dwordx4 v2, s[8:11], s3 offen offset:0 lds
M v[240:243], a[132:135], a[180:183], v[240:243]
M v[244:247], a[140:143], a[180:183], v[244:247]
M v[244:247], a[136:139], a[176:179], v[244:247]
M v[248:251], a[144:147], a[176:179], v[248:251]
M v[248:251], a[148:151], a[180:183], v[248:251]
buffer_load_dwordx4 v3, s[8:11], s3 offen offset:1024 lds
M v[252:255], a[156:159], a[180:183], v[252:255]
M v[252:255], a[152:155], a[176:179], v[252:255]
M a[0:3], a[96:99], a[184:187], a[0:3]
M a[0:3], a[100:103], a[188:191], a[0:3]
ds_read_b128 a[168:171], v10 offset:2048
ds_read_b128 a[172:175], v11 offset:2048
M a[4:7], a[108:111], a[188:191], a[4:7]
M a[4:7], a[104:107], a[184:187], a[4:7]
M a[8:11], a[112:115], a[184:187], a[8:11]
buffer_load_dwordx4 v4, s[8:11], s3 offen offset:2048 lds
M a[8:11], a[116:119], a[188:191], a[8:11]
M a[12:15], a[124:127], a[188:191], a[12:15]
M a[12:15], a[120:123], a[184:187], a[12:15]
M a[16:19], a[128:131], a[184:187], a[16:19]
M a[16:19], a[132:135], a[188:191], a[16:19]
buffer_load_dwordx4 v5, s[8:11], s3 offen offset:3072 lds
M a[20:23], a[140:143], a[188:191], a[20:23]
M a[20:23], a[136:139], a[184:187], a[20:23]
M a[24:27], a[144:147], a[184:187], a[24:27]
M a[24:27], a[148:151], a[188:191], a[24:27]
M a[28:31], a[156:159], a[188:191], a[28:31]
M a[28:31], a[152:155], a[184:187], a[28:31]
s_waitcnt lgkmcnt(2)
s_mov_b32 s30, 2
Lk1_kl:
M v[32:35], a[32:35], a[160:163], v[32:35]
s_add_u32 s23, s23, 128
s_cmp_eq_u32 s23, s25
s_cselect_b32 s23, s26, s23
M v[32:35], a[36:39], a[164:167], v[32:35]
ds_read_b128 a[176:179], v10 offset:4096
ds_read_b128 a[180:183], v11 offset:4096
M v[36:39], a[44:47], a[164:167], v[36:39]
M v[36:39], a[40:43], a[160:163], v[36:39]
ds_read_b64_tr_b16 a[96:97], v12 offset:32768
ds_read_b64_tr_b16 a[98:99], v12 offset:34816
M v[40:43], a[48:51], a[160:163], v[40:43]
M v[40:43], a[52:55], a[164:167], v[40:43]
M v[44:47], a[60:63], a[164:167], v[44:47]
s_add_u32 m0, s29, 81920
s_nop 0
buffer_load_dwordx4 v6, s[12:15], s24 offen offset:0 lds
M v[44:47], a[56:59], a[160:163], v[44:47]
ds_read_b64_tr_b16 a[104:105], v13 offset:32768
ds_read_b64_tr_b16 a[106:107], v13 offset:34816
M v[48:51], a[64:67], a[160:163], v[48:51]
M v[48:51], a[68:71], a[164:167], v[48:51]
M v[52:55], a[76:79], a[164:167], v[52:55]
M v[52:55], a[72:75], a[160:163], v[52:55]
ds_read_b64_tr_b16 a[112:113], v14 offset:32768
ds_read_b64_tr_b16 a[114:115], v14 offset:34816
M v[56:59], a[80:83], a[160:163], v[56:59]
M v[56:59], a[84:87], a[164:167], v[56:59]
buffer_load_dwordx4 v7, s[12:15], s24 offen offset:1024 lds
M v[60:63], a[92:95], a[164:167], v[60:63]
M v[60:63], a[88:91], a[160:163], v[60:63]
s_waitcnt lgkmcnt(8)
ds_read_b64_tr_b16 a[120:121], v15 offset:32768
ds_read_b64_tr_b16 a[122:123], v15 offset:34816
M v[64:67], a[32:35], a[168:171], v[64:67]
M v[64:67], a[36:39], a[172:175], v[64:67]
ds_read_b128 a[184:187], v10 offset:6144
ds_read_b128 a[188:191], v11 offset:6144
M v[68:71], a[44:47], a[172:175], v[68:71]
M v[68:71], a[40:43], a[168:171], v[68:71]
ds_read_b64_tr_b16 a[128:129], v16 offset:32768
ds_read_b64_tr_b16 a[130:131], v16 offset:34816
M v[72:75], a[48:51], a[168:171], v[72:75]
buffer_load_dwordx4 v8, s[12:15], s24 offen offset:2048 lds
M v[72:75], a[52:55], a[172:175], v[72:75]
M v[76:79], a[60:63], a[172:175], v[76:79]
M v[76:79], a[56:59], a[168:171], v[76:79]
ds_read_b64_tr_b16 a[136:137], v17 offset:32768
ds_read_b64_tr_b16 a[138:139], v17 offset:34816
M v[80:83], a[64:67], a[168:171], v[80:83]
M v[80:83], a[68:71], a[172:175], v[80:83]
M v[84:87], a[76:79], a[172:175], v[84:87]
buffer_load_dwordx4 v9, s[12:15], s24 offen offset:3072 lds
M v[84:87], a[72:75], a[168:171], v[84:87]
ds_read_b64_tr_b16 a[144:145], v18 offset:32768
ds_read_b64_tr_b16 a[146:147], v18 offset:34816
M v[88:91], a[80:83], a[168:171], v[88:91]
M v[88:91], a[84:87], a[172:175], v[88:91]
M v[92:95], a[92:95], a[172:175], v[92:95]
M v[92:95], a[88:91], a[168:171], v[92:95]
s_waitcnt lgkmcnt(15)
ds_read_b64_tr_b16 a[152:153], v19 offset:32768
ds_read_b64_tr_b16 a[154:155], v19 offset:34816
M v[96:99], a[32:35], a[176:179], v[96:99]
s_add_u32 s24, s24, 262144
s_cmp_eq_u32 s24, s27
s_cselect_b32 s24, s28, s24
s_sub_u32 s6, s6, 1
s_cmp_eq_u32 s6, 0
s_cselect_b64 s[12:13], s[64:65], s[12:13]
M v[96:99], a[36:39], a[180:183], v[96:99]
M v[100:103], a[44:47], a[180:183], v[100:103]
M v[100:103], a[40:43], a[176:179], v[100:103]
M v[104:107], a[48:51], a[176:179], v[104:107]
M v[104:107], a[52:55], a[180:183], v[104:107]
M v[108:111], a[60:63], a[180:183], v[108:111]
M v[108:111], a[56:59], a[176:179], v[108:111]
s_waitcnt vmcnt(16) lgkmcnt(0)
s_barrier
ds_read_b128 a[160:163], v10 offset:16384
ds_read_b128 a[164:167], v11 offset:16384
M v[112:115], a[64:67], a[176:179], v[112:115]
s_add_u32 m0, s29, 0
s_nop 0
buffer_load_dwordx4 v2, s[8:11], s23 offen offset:0 lds
M v[112:115], a[68:71], a[180:183], v[112:115]
M v[116:119], a[76:79], a[180:183], v[116:119]
M v[116:119], a[72:75], a[176:179], v[116:119]
ds_read_b64_tr_b16 a[100:101], v12 offset:49152
ds_read_b64_tr_b16 a[102:103], v12 offset:51200
M v[120:123], a[80:83], a[176:179], v[120:123]
M v[120:123], a[84:87], a[180:183], v[120:123]
M v[124:127], a[92:95], a[180:183], v[124:127]
buffer_load_dwordx4 v3, s[8:11], s23 offen offset:1024 lds
M v[124:127], a[88:91], a[176:179], v[124:127]
M v[128:131], a[32:35], a[184:187], v[128:131]
M v[128:131], a[36:39], a[188:191], v[128:131]
ds_read_b128 a[168:171], v10 offset:18432
ds_read_b128 a[172:175], v11 offset:18432
ds_read_b64_tr_b16 a[108:109], v13 offset:49152
ds_read_b64_tr_b16 a[110:111], v13 offset:51200
M v[132:135], a[44:47], a[188:191], v[132:135]
M v[132:135], a[40:43], a[184:187], v[132:135]
M v[136:139], a[48:51], a[184:187], v[136:139]
M v[136:139], a[52:55], a[188:191], v[136:139]
buffer_load_dwordx4 v4, s[8:11], s23 offen offset:2048 lds
M v[140:143], a[60:63], a[188:191], v[140:143]
M v[140:143], a[56:59], a[184:187], v[140:143]
ds_read_b64_tr_b16 a[116:117], v14 offset:49152
ds_read_b64_tr_b16 a[118:119], v14 offset:51200
M v[144:147], a[64:67], a[184:187], v[144:147]
M v[144:147], a[68:71], a[188:191], v[144:147]
M v[148:151], a[76:79], a[188:191], v[148:151]
M v[148:151], a[72:75], a[184:187], v[148:151]
M v[152:155], a[80:83], a[184:187], v[152:155]
buffer_load_dwordx4 v5, s[8:11], s23 offen offset:3072 lds
M v[152:155], a[84:87], a[188:191], v[152:155]
ds_read_b64_tr_b16 a[124:125], v15 offset:49152
ds_read_b64_tr_b16 a[126:127], v15 offset:51200
M v[156:159], a[92:95], a[188:191], v[156:159]
M v[156:159], a[88:91], a[184:187], v[156:159]
s_waitcnt lgkmcnt(10)
M v[160:163], a[32:35], a[160:163], v[160:163]
M v[160:163], a[36:39], a[164:167], v[160:163]
ds_read_b128 a[176:179], v10 offset:20480
ds_read_b128 a[180:183], v11 offset:20480
M v[164:167], a[44:47], a[164:167], v[164:167]
M v[164:167], a[40:43], a[160:163], v[164:167]
ds_read_b64_tr_b16 a[132:133], v16 offset:49152
ds_read_b64_tr_b16 a[134:135], v16 offset:51200
M v[168:171], a[48:51], a[160:163], v[168:171]
M v[168:171], a[52:55], a[164:167], v[168:171]
s_add_u32 m0, s29, 98304
s_nop 0
buffer_load_dwordx4 v6, s[12:15], s24 offen offset:0 lds
M v[172:175], a[60:63], a[164:167], v[172:175]
M v[172:175], a[56:59], a[160:163], v[172:175]
M v[176:179], a[64:67], a[160:163], v[176:179]
M v[176:179], a[68:71], a[164:167], v[176:179]
ds_read_b64_tr_b16 a[140:141], v17 offset:49152
ds_read_b64_tr_b16 a[142:143], v17 offset:51200
M v[180:183], a[76:79], a[164:167], v[180:183]
M v[180:183], a[72:75], a[160:163], v[180:183]
buffer_load_dwordx4 v7, s[12:15], s24 offen offset:1024 lds
M v[184:187], a[80:83], a[160:163], v[184:187]
M v[184:187], a[84:87], a[164:167], v[184:187]
M v[188:191], a[92:95], a[164:167], v[188:191]
M v[188:191], a[88:91], a[160:163], v[188:191]
s_waitcnt lgkmcnt(12)
ds_read_b64_tr_b16 a[148:149], v18 offset:49152
ds_read_b64_tr_b16 a[150:151], v18 offset:51200
M v[192:195], a[32:35], a[168:171], v[192:195]
M v[192:195], a[36:39], a[172:175], v[192:195]
ds_read_b128 a[184:187], v10 offset:22528
ds_read_b128 a[188:191], v11 offset:22528
M v[196:199], a[44:47], a[172:175], v[196:199]
M v[196:199], a[40:43], a[168:171], v[196:199]
buffer_load_dwordx4 v8, s[12:15], s24 offen offset:2048 lds
M v[200:203], a[48:51], a[168:171], v[200:203]
M v[200:203], a[52:55], a[172:175], v[200:203]
ds_read_b64_tr_b16 a[156:157], v19 offset:49152
ds_read_b64_tr_b16 a[158:159], v19 offset:51200
M v[204:207], a[60:63], a[172:175], v[204:207]
M v[204:207], a[56:59], a[168:171], v[204:207]
M v[208:211], a[64:67], a[168:171], v[208:211]
M v[208:211], a[68:71], a[172:175], v[208:211]
buffer_load_dwordx4 v9, s[12:15], s24 offen offset:3072 lds
M v[212:215], a[76:79], a[172:175], v[212:215]
M v[212:215], a[72:75], a[168:171], v[212:215]
M v[216:219], a[80:83], a[168:171], v[216:219]
M v[216:219], a[84:87], a[172:175], v[216:219]
M v[220:223], a[92:95], a[172:175], v[220:223]
s_add_u32 s24, s24, 262144
M v[220:223], a[88:91], a[168:171], v[220:223]
s_waitcnt lgkmcnt(10)
M v[224:227], a[32:35], a[176:179], v[224:227]
M v[224:227], a[36:39], a[180:183], v[224:227]
M v[228:231], a[44:47], a[180:183], v[228:231]
M v[228:231], a[40:43], a[176:179], v[228:231]
M v[232:235], a[48:51], a[176:179], v[232:235]
M v[232:235], a[52:55], a[180:183], v[232:235]
M v[236:239], a[60:63], a[180:183], v[236:239]
M v[236:239], a[56:59], a[176:179], v[236:239]
s_waitcnt vmcnt(16) lgkmcnt(0)
s_barrier
ds_read_b128 a[160:163], v10 offset:32768
ds_read_b128 a[164:167], v11 offset:32768
M v[240:243], a[64:67], a[176:179], v[240:243]
s_add_u32 m0, s29, 16384
s_add_u32 s3, s23, s31
buffer_load_dwordx4 v2, s[8:11], s3 offen offset:0 lds
M v[240:243], a[68:71], a[180:183], v[240:243]
M v[244:247], a[76:79], a[180:183], v[244:247]
M v[244:247], a[72:75], a[176:179], v[244:247]
M v[248:251], a[80:83], a[176:179], v[248:251]
M v[248:251], a[84:87], a[180:183], v[248:251]
buffer_load_dwordx4 v3, s[8:11], s3 offen offset:1024 lds
M v[252:255], a[92:95], a[180:183], v[252:255]
M v[252:255], a[88:91], a[176:179], v[252:255]
M a[0:3], a[32:35], a[184:187], a[0:3]
M a[0:3], a[36:39], a[188:191], a[0:3]
ds_read_b128 a[168:171], v10 offset:34816
ds_read_b128 a[172:175], v11 offset:34816
M a[4:7], a[44:47], a[188:191], a[4:7]
M a[4:7], a[40:43], a[184:187], a[4:7]
M a[8:11], a[48:51], a[184:187], a[8:11]
buffer_load_dwordx4 v4, s[8:11], s3 offen offset:2048 lds
M a[8:11], a[52:55], a[188:191], a[8:11]
M a[12:15], a[60:63], a[188:191], a[12:15]
M a[12:15], a[56:59], a[184:187], a[12:15]
M a[16:19], a[64:67], a[184:187], a[16:19]
M a[16:19], a[68:71], a[188:191], a[16:19]
buffer_load_dwordx4 v5, s[8:11], s3 offen offset:3072 lds
M a[20:23], a[76:79], a[188:191], a[20:23]
M a[20:23], a[72:75], a[184:187], a[20:23]
M a[24:27], a[80:83], a[184:187], a[24:27]
M a[24:27], a[84:87], a[188:191], a[24:27]
M a[28:31], a[92:95], a[188:191], a[28:31]
M a[28:31], a[88:91], a[184:187], a[28:31]
s_waitcnt lgkmcnt(2)
M v[32:35], a[96:99], a[160:163], v[32:35]
s_add_u32 s23, s23, 128
s_cmp_eq_u32 s23, s25
s_cselect_b32 s23, s26, s23
M v[32:35], a[100:103], a[164:167], v[32:35]
ds_read_b128 a[176:179], v10 offset:36864
ds_read_b128 a[180:183], v11 offset:36864
M v[36:39], a[108:111], a[164:167], v[36:39]
M v[36:39], a[104:107], a[160:163], v[36:39]
ds_read_b64_tr_b16 a[32:33], v12 offset:0
ds_read_b64_tr_b16 a[34:35], v12 offset:2048
M v[40:43], a[112:115], a[160:163], v[40:43]
M v[40:43], a[116:119], a[164:167], v[40:43]
M v[44:47], a[124:127], a[164:167], v[44:47]
s_add_u32 m0, s29, 114688
s_nop 0
buffer_load_dwordx4 v6, s[12:15], s24 offen offset:0 lds
M v[44:47], a[120:123], a[160:163], v[44:47]
ds_read_b64_tr_b16 a[40:41], v13 offset:0
ds_read_b64_tr_b16 a[42:43], v13 offset:2048
M v[48:51], a[128:131], a[160:163], v[48:51]
M v[48:51], a[132:135], a[164:167], v[48:51]
M v[52:55], a[140:143], a[164:167], v[52:55]
M v[52:55], a[136:139], a[160:163], v[52:55]
ds_read_b64_tr_b16 a[48:49], v14 offset:0
ds_read_b64_tr_b16 a[50:51], v14 offset:2048
M v[56:59], a[144:147], a[160:163], v[56:59]
M v[56:59], a[148:151], a[164:167], v[56:59]
buffer_load_dwordx4 v7, s[12:15], s24 offen offset:1024 lds
M v[60:63], a[156:159], a[164:167], v[60:63]
M v[60:63], a[152:155], a[160:163], v[60:63]
s_waitcnt lgkmcnt(8)
ds_read_b64_tr_b16 a[56:57], v15 offset:0
ds_read_b64_tr_b16 a[58:59], v15 offset:2048
M v[64:67], a[96:99], a[168:171], v[64:67]
M v[64:67], a[100:103], a[172:175], v[64:67]
ds_read_b128 a[184:187], v10 offset:38912
ds_read_b128 a[188:191], v11 offset:38912
M v[68:71], a[108:111], a[172:175], v[68:71]
M v[68:71], a[104:107], a[168:171], v[68:71]
ds_read_b64_tr_b16 a[64:65], v16 offset:0
ds_read_b64_tr_b16 a[66:67], v16 offset:2048
M v[72:75], a[112:115], a[168:171], v[72:75]
buffer_load_dwordx4 v8, s[12:15], s24 offen offset:2048 lds
M v[72:75], a[116:119], a[172:175], v[72:75]
M v[76:79], a[124:127], a[172:175], v[76:79]
M v[76:79], a[120:123], a[168:171], v[76:79]
ds_read_b64_tr_b16 a[72:73], v17 offset:0
ds_read_b64_tr_b16 a[74:75], v17 offset:2048
M v[80:83], a[128:131], a[168:171], v[80:83]
M v[80:83], a[132:135], a[172:175], v[80:83]
M v[84:87], a[140:143], a[172:175], v[84:87]
buffer_load_dwordx4 v9, s[12:15], s24 offen offset:3072 lds
M v[84:87], a[136:139], a[168:171], v[84:87]
ds_read_b64_tr_b16 a[80:81], v18 offset:0
ds_read_b64_tr_b16 a[82:83], v18 offset:2048
M v[88:91], a[144:147], a[168:171], v[88:91]
M v[88:91], a[148:151], a[172:175], v[88:91]
M v[92:95], a[156:159], a[172:175], v[92:95]
M v[92:95], a[152:155], a[168:171], v[92:95]
s_waitcnt lgkmcnt(15)
ds_read_b64_tr_b16 a[88:89], v19 offset:0
ds_read_b64_tr_b16 a[90:91], v19 offset:2048
M v[96:99], a[96:99], a[176:179], v[96:99]
s_add_u32 s24, s24, 262144
s_cmp_eq_u32 s24, s27
s_cselect_b32 s24, s28, s24
s_sub_u32 s6, s6, 1
s_cmp_eq_u32 s6, 0
s_cselect_b64 s[12:13], s[64:65], s[12:13]
M v[96:99], a[100:103], a[180:183], v[96:99]
M v[100:103], a[108:111], a[180:183], v[100:103]
M v[100:103], a[104:107], a[176:179], v[100:103]
M v[104:107], a[112:115], a[176:179], v[104:107]
M v[104:107], a[116:119], a[180:183], v[104:107]
M v[108:111], a[124:127], a[180:183], v[108:111]
M v[108:111], a[120:123], a[176:179], v[108:111]
s_waitcnt vmcnt(16) lgkmcnt(0)
s_barrier
ds_read_b128 a[160:163], v10 offset:49152
ds_read_b128 a[164:167], v11 offset:49152
M v[112:115], a[128:131], a[176:179], v[112:115]
s_add_u32 m0, s29, 32768
s_nop 0
buffer_load_dwordx4 v2, s[8:11], s23 offen offset:0 lds
M v[112:115], a[132:135], a[180:183], v[112:115]
M v[116:119], a[140:143], a[180:183], v[116:119]
M v[116:119], a[136:139], a[176:179], v[116:119]
ds_read_b64_tr_b16 a[36:37], v12 offset:16384
ds_read_b64_tr_b16 a[38:39], v12 offset:18432
M v[120:123], a[144:147], a[176:179], v[120:123]
M v[120:123], a[148:151], a[180:183], v[120:123]
M v[124:127], a[156:159], a[180:183], v[124:127]
buffer_load_dwordx4 v3, s[8:11], s23 offen offset:1024 lds
M v[124:127], a[152:155], a[176:179], v[124:127]
M v[128:131], a[96:99], a[184:187], v[128:131]
M v[128:131], a[100:103], a[188:191], v[128:131]
ds_read_b128 a[168:171], v10 offset:51200
ds_read_b128 a[172:175], v11 offset:51200
ds_read_b64_tr_b16 a[44:45], v13 offset:16384
ds_read_b64_tr_b16 a[46:47], v13 offset:18432
M v[132:135], a[108:111], a[188:191], v[132:135]
M v[132:135], a[104:107], a[184:187], v[132:135]
M v[136:139], a[112:115], a[184:187], v[136:139]
M v[136:139], a[116:119], a[188:191], v[136:139]
buffer_load_dwordx4 v4, s[8:11], s23 offen offset:2048 lds
M v[140:143], a[124:127], a[188:191], v[140:143]
M v[140:143], a[120:123], a[184:187], v[140:143]
ds_read_b64_tr_b16 a[52:53], v14 offset:16384
ds_read_b64_tr_b16 a[54:55], v14 offset:18432
M v[144:147], a[128:131], a[184:187], v[144:147]
M v[144:147], a[132:135], a[188:191], v[144:147]
M v[148:151], a[140:143], a[188:191], v[148:151]
M v[148:151], a[136:139], a[184:187], v[148:151]
M v[152:155], a[144:147], a[184:187], v[152:155]
buffer_load_dwordx4 v5, s[8:11], s23 offen offset:3072 lds
M v[152:155], a[148:151], a[188:191], v[152:155]
ds_read_b64_tr_b16 a[60:61], v15 offset:16384
ds_read_b64_tr_b16 a[62:63], v15 offset:18432
M v[156:159], a[156:159], a[188:191], v[156:159]
M v[156:159], a[152:155], a[184:187], v[156:159]
s_waitcnt lgkmcnt(10)
M v[160:163], a[96:99], a[160:163], v[160:163]
M v[160:163], a[100:103], a[164:167], v[160:163]
ds_read_b128 a[176:179], v10 offset:53248
ds_read_b128 a[180:183], v11 offset:53248
M v[164:167], a[108:111], a[164:167], v[164:167]
M v[164:167], a[104:107], a[160:163], v[164:167]
ds_read_b64_tr_b16 a[68:69], v16 offset:16384
ds_read_b64_tr_b16 a[70:71], v16 offset:18432
M v[168:171], a[112:115], a[160:163], v[168:171]
M v[168:171], a[116:119], a[164:167], v[168:171]
s_add_u32 m0, s29, 65536
s_nop 0
buffer_load_dwordx4 v6, s[12:15], s24 offen offset:0 lds
M v[172:175], a[124:127], a[164:167], v[172:175]
M v[172:175], a[120:123], a[160:163], v[172:175]
M v[176:179], a[128:131], a[160:163], v[176:179]
M v[176:179], a[132:135], a[164:167], v[176:179]
ds_read_b64_tr_b16 a[76:77], v17 offset:16384
ds_read_b64_tr_b16 a[78:79], v17 offset:18432
M v[180:183], a[140:143], a[164:167], v[180:183]
M v[180:183], a[136:139], a[160:163], v[180:183]
buffer_load_dwordx4 v7, s[12:15], s24 offen offset:1024 lds
M v[184:187], a[144:147], a[160:163], v[184:187]
M v[184:187], a[148:151], a[164:167], v[184:187]
M v[188:191], a[156:159], a[164:167], v[188:191]
M v[188:191], a[152:155], a[160:163], v[188:191]
s_waitcnt lgkmcnt(12)
ds_read_b64_tr_b16 a[84:85], v18 offset:16384
ds_read_b64_tr_b16 a[86:87], v18 offset:18432
M v[192:195], a[96:99], a[168:171], v[192:195]
M v[192:195], a[100:103], a[172:175], v[192:195]
ds_read_b128 a[184:187], v10 offset:55296
ds_read_b128 a[188:191], v11 offset:55296
M v[196:199], a[108:111], a[172:175], v[196:199]
M v[196:199], a[104:107], a[168:171], v[196:199]
buffer_load_dwordx4 v8, s[12:15], s24 offen offset:2048 lds
M v[200:203], a[112:115], a[168:171], v[200:203]
M v[200:203], a[116:119], a[172:175], v[200:203]
ds_read_b64_tr_b16 a[92:93], v19 offset:16384
ds_read_b64_tr_b16 a[94:95], v19 offset:18432
M v[204:207], a[124:127], a[172:175], v[204:207]
M v[204:207], a[120:123], a[168:171], v[204:207]
M v[208:211], a[128:131], a[168:171], v[208:211]
M v[208:211], a[132:135], a[172:175], v[208:211]
buffer_load_dwordx4 v9, s[12:15], s24 offen offset:3072 lds
M v[212:215], a[140:143], a[172:175], v[212:215]
M v[212:215], a[136:139], a[168:171], v[212:215]
M v[216:219], a[144:147], a[168:171], v[216:219]
M v[216:219], a[148:151], a[172:175], v[216:219]
M v[220:223], a[156:159], a[172:175], v[220:223]
s_add_u32 s24, s24, 262144
M v[220:223], a[152:155], a[168:171], v[220:223]
s_waitcnt lgkmcnt(10)
M v[224:227], a[96:99], a[176:179], v[224:227]
M v[224:227], a[100:103], a[180:183], v[224:227]
M v[228:231], a[108:111], a[180:183], v[228:231]
M v[228:231], a[104:107], a[176:179], v[228:231]
M v[232:235], a[112:115], a[176:179], v[232:235]
M v[232:235], a[116:119], a[180:183], v[232:235]
M v[236:239], a[124:127], a[180:183], v[236:239]
M v[236:239], a[120:123], a[176:179], v[236:239]
s_waitcnt vmcnt(16) lgkmcnt(0)
s_barrier
ds_read_b128 a[160:163], v10 offset:0
ds_read_b128 a[164:167], v11 offset:0
M v[240:243], a[128:131], a[176:179], v[240:243]
s_add_u32 m0, s29, 49152
s_add_u32 s3, s23, s31
buffer_load_dwordx4 v2, s[8:11], s3 offen offset:0 lds
M v[240:243], a[132:135], a[180:183], v[240:243]
M v[244:247], a[140:143], a[180:183], v[244:247]
M v[244:247], a[136:139], a[176:179], v[244:247]
M v[248:251], a[144:147], a[176:179], v[248:251]
M v[248:251], a[148:151], a[180:183], v[248:251]
buffer_load_dwordx4 v3, s[8:11], s3 offen offset:1024 lds
M v[252:255], a[156:159], a[180:183], v[252:255]
M v[252:255], a[152:155], a[176:179], v[252:255]
M a[0:3], a[96:99], a[184:187], a[0:3]
M a[0:3], a[100:103], a[188:191], a[0:3]
ds_read_b128 a[168:171], v10 offset:2048
ds_read_b128 a[172:175], v11 offset:2048
M a[4:7], a[108:111], a[188:191], a[4:7]
M a[4:7], a[104:107], a[184:187], a[4:7]
M a[8:11], a[112:115], a[184:187], a[8:11]
buffer_load_dwordx4 v4, s[8:11], s3 offen offset:2048 lds
M a[8:11], a[116:119], a[188:191], a[8:11]
M a[12:15], a[124:127], a[188:191], a[12:15]
M a[12:15], a[120:123], a[184:187], a[12:15]
M a[16:19], a[128:131], a[184:187], a[16:19]
M a[16:19], a[132:135], a[188:191], a[16:19]
buffer_load_dwordx4 v5, s[8:11], s3 offen offset:3072 lds
M a[20:23], a[140:143], a[188:191], a[20:23]
M a[20:23], a[136:139], a[184:187], a[20:23]
M a[24:27], a[144:147], a[184:187], a[24:27]
M a[24:27], a[148:151], a[188:191], a[24:27]
M a[28:31], a[156:159], a[188:191], a[28:31]
M a[28:31], a[152:155], a[184:187], a[28:31]
s_waitcnt lgkmcnt(2)
s_sub_u32 s30, s30, 1
s_cmp_lg_u32 s30, 0
s_cbranch_scc1 Lk1_kl
M v[32:35], a[32:35], a[160:163], v[32:35]
s_add_u32 s23, s23, 128
s_cmp_eq_u32 s23, s25
s_cselect_b32 s23, s26, s23
M v[32:35], a[36:39], a[164:167], v[32:35]
ds_read_b128 a[176:179], v10 offset:4096
ds_read_b128 a[180:183], v11 offset:4096
M v[36:39], a[44:47], a[164:167], v[36:39]
M v[36:39], a[40:43], a[160:163], v[36:39]
ds_read_b64_tr_b16 a[96:97], v12 offset:32768
ds_read_b64_tr_b16 a[98:99], v12 offset:34816
M v[40:43], a[48:51], a[160:163], v[40:43]
M v[40:43], a[52:55], a[164:167], v[40:43]
M v[44:47], a[60:63], a[164:167], v[44:47]
s_add_u32 m0, s29, 81920
s_nop 0
buffer_load_dwordx4 v6, s[12:15], s24 offen offset:0 lds
M v[44:47], a[56:59], a[160:163], v[44:47]
ds_read_b64_tr_b16 a[104:105], v13 offset:32768
ds_read_b64_tr_b16 a[106:107], v13 offset:34816
M v[48:51], a[64:67], a[160:163], v[48:51]
M v[48:51], a[68:71], a[164:167], v[48:51]
M v[52:55], a[76:79], a[164:167], v[52:55]
M v[52:55], a[72:75], a[160:163], v[52:55]
ds_read_b64_tr_b16 a[112:113], v14 offset:32768
ds_read_b64_tr_b16 a[114:115], v14 offset:34816
M v[56:59], a[80:83], a[160:163], v[56:59]
M v[56:59], a[84:87], a[164:167], v[56:59]
buffer_load_dwordx4 v7, s[12:15], s24 offen offset:1024 lds
M v[60:63], a[92:95], a[164:167], v[60:63]
M v[60:63], a[88:91], a[160:163], v[60:63]
s_waitcnt lgkmcnt(8)
ds_read_b64_tr_b16 a[120:121], v15 offset:32768
ds_read_b64_tr_b16 a[122:123], v15 offset:34816
M v[64:67], a[32:35], a[168:171], v[64:67]
M v[64:67], a[36:39], a[172:175], v[64:67]
ds_read_b128 a[184:187], v10 offset:6144
ds_read_b128 a[188:191], v11 offset:6144
M v[68:71], a[44:47], a[172:175], v[68:71]
M v[68:71], a[40:43], a[168:171], v[68:71]
ds_read_b64_tr_b16 a[128:129], v16 offset:32768
ds_read_b64_tr_b16 a[130:131], v16 offset:34816
M v[72:75], a[48:51], a[168:171], v[72:75]
buffer_load_dwordx4 v8, s[12:15], s24 offen offset:2048 lds
M v[72:75], a[52:55], a[172:175], v[72:75]
M v[76:79], a[60:63], a[172:175], v[76:79]
M v[76:79], a[56:59], a[168:171], v[76:79]
ds_read_b64_tr_b16 a[136:137], v17 offset:32768
ds_read_b64_tr_b16 a[138:139], v17 offset:34816
M v[80:83], a[64:67], a[168:171], v[80:83]
M v[80:83], a[68:71], a[172:175], v[80:83]
M v[84:87], a[76:79], a[172:175], v[84:87]
buffer_load_dwordx4 v9, s[12:15], s24 offen offset:3072 lds
M v[84:87], a[72:75], a[168:171], v[84:87]
ds_read_b64_tr_b16 a[144:145], v18 offset:32768
ds_read_b64_tr_b16 a[146:147], v18 offset:34816
M v[88:91], a[80:83], a[168:171], v[88:91]
M v[88:91], a[84:87], a[172:175], v[88:91]
M v[92:95], a[92:95], a[172:175], v[92:95]
M v[92:95], a[88:91], a[168:171], v[92:95]
s_waitcnt lgkmcnt(15)
ds_read_b64_tr_b16 a[152:153], v19 offset:32768
ds_read_b64_tr_b16 a[154:155], v19 offset:34816
M v[96:99], a[32:35], a[176:179], v[96:99]
s_add_u32 s24, s24, 262144
s_cmp_eq_u32 s24, s27
s_cselect_b32 s24, s28, s24
s_sub_u32 s6, s6, 1
s_cmp_eq_u32 s6, 0
s_cselect_b64 s[12:13], s[64:65], s[12:13]
M v[96:99], a[36:39], a[180:183], v[96:99]
M v[100:103], a[44:47], a[180:183], v[100:103]
M v[100:103], a[40:43], a[176:179], v[100:103]
M v[104:107], a[48:51], a[176:179], v[104:107]
M v[104:107], a[52:55], a[180:183], v[104:107]
M v[108:111], a[60:63], a[180:183], v[108:111]
M v[108:111], a[56:59], a[176:179], v[108:111]
s_waitcnt vmcnt(16) lgkmcnt(0)
s_barrier
ds_read_b128 a[160:163], v10 offset:16384
ds_read_b128 a[164:167], v11 offset:16384
M v[112:115], a[64:67], a[176:179], v[112:115]
s_add_u32 m0, s29, 0
s_nop 0
buffer_load_dwordx4 v2, s[8:11], s23 offen offset:0 lds
M v[112:115], a[68:71], a[180:183], v[112:115]
M v[116:119], a[76:79], a[180:183], v[116:119]
M v[116:119], a[72:75], a[176:179], v[116:119]
ds_read_b64_tr_b16 a[100:101], v12 offset:49152
ds_read_b64_tr_b16 a[102:103], v12 offset:51200
M v[120:123], a[80:83], a[176:179], v[120:123]
M v[120:123], a[84:87], a[180:183], v[120:123]
M v[124:127], a[92:95], a[180:183], v[124:127]
buffer_load_dwordx4 v3, s[8:11], s23 offen offset:1024 lds
M v[124:127], a[88:91], a[176:179], v[124:127]
M v[128:131], a[32:35], a[184:187], v[128:131]
M v[128:131], a[36:39], a[188:191], v[128:131]
ds_read_b128 a[168:171], v10 offset:18432
ds_read_b128 a[172:175], v11 offset:18432
ds_read_b64_tr_b16 a[108:109], v13 offset:49152
ds_read_b64_tr_b16 a[110:111], v13 offset:51200
M v[132:135], a[44:47], a[188:191], v[132:135]
M v[132:135], a[40:43], a[184:187], v[132:135]
M v[136:139], a[48:51], a[184:187], v[136:139]
M v[136:139], a[52:55], a[188:191], v[136:139]
buffer_load_dwordx4 v4, s[8:11], s23 offen offset:2048 lds
M v[140:143], a[60:63], a[188:191], v[140:143]
M v[140:143], a[56:59], a[184:187], v[140:143]
ds_read_b64_tr_b16 a[116:117], v14 offset:49152
ds_read_b64_tr_b16 a[118:119], v14 offset:51200
M v[144:147], a[64:67], a[184:187], v[144:147]
M v[144:147], a[68:71], a[188:191], v[144:147]
M v[148:151], a[76:79], a[188:191], v[148:151]
M v[148:151], a[72:75], a[184:187], v[148:151]
M v[152:155], a[80:83], a[184:187], v[152:155]
buffer_load_dwordx4 v5, s[8:11], s23 offen offset:3072 lds
s_lshr_b32 s3, s53, 7
s_add_u32 s3, s3, s22
M v[152:155], a[84:87], a[188:191], v[152:155]
ds_read_b64_tr_b16 a[124:125], v15 offset:49152
ds_read_b64_tr_b16 a[126:127], v15 offset:51200
s_lshl_b32 s3, s3, 5
s_lshr_b32 s19, s52, 6
M v[156:159], a[92:95], a[188:191], v[156:159]
s_add_u32 s3, s3, s19
s_lshl_b32 s19, s21, 1
M v[156:159], a[88:91], a[184:187], v[156:159]
s_waitcnt lgkmcnt(10)
s_add_u32 s3, s3, s19
s_lshl_b32 s92, s3, 15
M v[160:163], a[32:35], a[160:163], v[160:163]
s_add_u32 s93, s92, 32768
s_add_u32 s16, s50, 16777216
M v[160:163], a[36:39], a[164:167], v[160:163]
ds_read_b128 a[176:179], v10 offset:20480
ds_read_b128 a[180:183], v11 offset:20480
s_addc_u32 s17, s51, 0
s_mov_b32 s18, 33554432
M v[164:167], a[44:47], a[164:167], v[164:167]
s_mov_b32 s19, 0x00020000
M v[164:167], a[40:43], a[160:163], v[164:167]
ds_read_b64_tr_b16 a[132:133], v16 offset:49152
ds_read_b64_tr_b16 a[134:135], v16 offset:51200
M v[168:171], a[48:51], a[160:163], v[168:171]
M v[168:171], a[52:55], a[164:167], v[168:171]
s_add_u32 m0, s29, 98304
s_nop 0
buffer_load_dwordx4 v6, s[12:15], s24 offen offset:0 lds
M v[172:175], a[60:63], a[164:167], v[172:175]
M v[172:175], a[56:59], a[160:163], v[172:175]
M v[176:179], a[64:67], a[160:163], v[176:179]
M v[176:179], a[68:71], a[164:167], v[176:179]
ds_read_b64_tr_b16 a[140:141], v17 offset:49152
ds_read_b64_tr_b16 a[142:143], v17 offset:51200
M v[180:183], a[76:79], a[164:167], v[180:183]
M v[180:183], a[72:75], a[160:163], v[180:183]
buffer_load_dwordx4 v7, s[12:15], s24 offen offset:1024 lds
M v[184:187], a[80:83], a[160:163], v[184:187]
M v[184:187], a[84:87], a[164:167], v[184:187]
M v[188:191], a[92:95], a[164:167], v[188:191]
M v[188:191], a[88:91], a[160:163], v[188:191]
s_waitcnt lgkmcnt(12)
ds_read_b64_tr_b16 a[148:149], v18 offset:49152
ds_read_b64_tr_b16 a[150:151], v18 offset:51200
M v[192:195], a[32:35], a[168:171], v[192:195]
M v[192:195], a[36:39], a[172:175], v[192:195]
ds_read_b128 a[184:187], v10 offset:22528
ds_read_b128 a[188:191], v11 offset:22528
M v[196:199], a[44:47], a[172:175], v[196:199]
M v[196:199], a[40:43], a[168:171], v[196:199]
buffer_load_dwordx4 v8, s[12:15], s24 offen offset:2048 lds
M v[200:203], a[48:51], a[168:171], v[200:203]
M v[200:203], a[52:55], a[172:175], v[200:203]
ds_read_b64_tr_b16 a[156:157], v19 offset:49152
ds_read_b64_tr_b16 a[158:159], v19 offset:51200
M v[204:207], a[60:63], a[172:175], v[204:207]
M v[204:207], a[56:59], a[168:171], v[204:207]
M v[208:211], a[64:67], a[168:171], v[208:211]
M v[208:211], a[68:71], a[172:175], v[208:211]
buffer_load_dwordx4 v9, s[12:15], s24 offen offset:3072 lds
M v[212:215], a[76:79], a[172:175], v[212:215]
M v[212:215], a[72:75], a[168:171], v[212:215]
M v[216:219], a[80:83], a[168:171], v[216:219]
M v[216:219], a[84:87], a[172:175], v[216:219]
M v[220:223], a[92:95], a[172:175], v[220:223]
s_add_u32 s24, s24, 262144
M v[220:223], a[88:91], a[168:171], v[220:223]
s_waitcnt lgkmcnt(10)
M v[224:227], a[32:35], a[176:179], v[224:227]
M v[224:227], a[36:39], a[180:183], v[224:227]
M v[228:231], a[44:47], a[180:183], v[228:231]
M v[228:231], a[40:43], a[176:179], v[228:231]
M v[232:235], a[48:51], a[176:179], v[232:235]
M v[232:235], a[52:55], a[180:183], v[232:235]
M v[236:239], a[60:63], a[180:183], v[236:239]
M v[236:239], a[56:59], a[176:179], v[236:239]
s_waitcnt vmcnt(16) lgkmcnt(0)
s_barrier
ds_read_b128 a[160:163], v10 offset:32768
ds_read_b128 a[164:167], v11 offset:32768
M v[240:243], a[64:67], a[176:179], v[240:243]
s_add_u32 m0, s29, 16384
s_add_u32 s3, s23, s31
buffer_load_dwordx4 v2, s[8:11], s3 offen offset:0 lds
M v[240:243], a[68:71], a[180:183], v[240:243]
M v[244:247], a[76:79], a[180:183], v[244:247]
M v[244:247], a[72:75], a[176:179], v[244:247]
M v[248:251], a[80:83], a[176:179], v[248:251]
M v[248:251], a[84:87], a[180:183], v[248:251]
buffer_load_dwordx4 v3, s[8:11], s3 offen offset:1024 lds
M v[252:255], a[92:95], a[180:183], v[252:255]
M v[252:255], a[88:91], a[176:179], v[252:255]
M a[0:3], a[32:35], a[184:187], a[0:3]
M a[0:3], a[36:39], a[188:191], a[0:3]
ds_read_b128 a[168:171], v10 offset:34816
ds_read_b128 a[172:175], v11 offset:34816
M a[4:7], a[44:47], a[188:191], a[4:7]
M a[4:7], a[40:43], a[184:187], a[4:7]
M a[8:11], a[48:51], a[184:187], a[8:11]
buffer_load_dwordx4 v4, s[8:11], s3 offen offset:2048 lds
M a[8:11], a[52:55], a[188:191], a[8:11]
M a[12:15], a[60:63], a[188:191], a[12:15]
M a[12:15], a[56:59], a[184:187], a[12:15]
M a[16:19], a[64:67], a[184:187], a[16:19]
M a[16:19], a[68:71], a[188:191], a[16:19]
buffer_load_dwordx4 v5, s[8:11], s3 offen offset:3072 lds
M a[20:23], a[76:79], a[188:191], a[20:23]
M a[20:23], a[72:75], a[184:187], a[20:23]
M a[24:27], a[80:83], a[184:187], a[24:27]
M a[24:27], a[84:87], a[188:191], a[24:27]
M a[28:31], a[92:95], a[188:191], a[28:31]
M a[28:31], a[88:91], a[184:187], a[28:31]
s_waitcnt lgkmcnt(2)
M v[32:35], a[96:99], a[160:163], v[32:35]
s_add_u32 s23, s23, 128
s_cmp_eq_u32 s23, s25
s_cselect_b32 s23, s26, s23
M v[32:35], a[100:103], a[164:167], v[32:35]
ds_read_b128 a[176:179], v10 offset:36864
ds_read_b128 a[180:183], v11 offset:36864
M v[36:39], a[108:111], a[164:167], v[36:39]
M v[36:39], a[104:107], a[160:163], v[36:39]
ds_read_b64_tr_b16 a[32:33], v12 offset:0
ds_read_b64_tr_b16 a[34:35], v12 offset:2048
M v[40:43], a[112:115], a[160:163], v[40:43]
M v[40:43], a[116:119], a[164:167], v[40:43]
M v[44:47], a[124:127], a[164:167], v[44:47]
s_add_u32 m0, s29, 114688
s_nop 0
buffer_load_dwordx4 v6, s[12:15], s24 offen offset:0 lds
M v[44:47], a[120:123], a[160:163], v[44:47]
ds_read_b64_tr_b16 a[40:41], v13 offset:0
ds_read_b64_tr_b16 a[42:43], v13 offset:2048
M v[48:51], a[128:131], a[160:163], v[48:51]
M v[48:51], a[132:135], a[164:167], v[48:51]
M v[52:55], a[140:143], a[164:167], v[52:55]
M v[52:55], a[136:139], a[160:163], v[52:55]
ds_read_b64_tr_b16 a[48:49], v14 offset:0
ds_read_b64_tr_b16 a[50:51], v14 offset:2048
M v[56:59], a[144:147], a[160:163], v[56:59]
buffer_load_dwordx4 v7, s[12:15], s24 offen offset:1024 lds
M v[56:59], a[148:151], a[164:167], v[56:59]
M v[60:63], a[156:159], a[164:167], v[60:63]
M v[60:63], a[152:155], a[160:163], v[60:63]
s_waitcnt lgkmcnt(8)
ds_read_b64_tr_b16 a[56:57], v15 offset:0
ds_read_b64_tr_b16 a[58:59], v15 offset:2048
M v[64:67], a[96:99], a[168:171], v[64:67]
M v[64:67], a[100:103], a[172:175], v[64:67]
ds_read_b128 a[184:187], v10 offset:38912
ds_read_b128 a[188:191], v11 offset:38912
M v[68:71], a[108:111], a[172:175], v[68:71]
M v[68:71], a[104:107], a[168:171], v[68:71]
ds_read_b64_tr_b16 a[64:65], v16 offset:0
ds_read_b64_tr_b16 a[66:67], v16 offset:2048
v_cvt_pk_bf16_f32 v32, v32, v33
v_cvt_pk_bf16_f32 v33, v34, v35
M v[72:75], a[112:115], a[168:171], v[72:75]
buffer_load_dwordx4 v8, s[12:15], s24 offen offset:2048 lds
v_cvt_pk_bf16_f32 v34, v36, v37
v_cvt_pk_bf16_f32 v35, v38, v39
M v[72:75], a[116:119], a[172:175], v[72:75]
v_cvt_pk_bf16_f32 v40, v40, v41
v_cvt_pk_bf16_f32 v41, v42, v43
M v[76:79], a[124:127], a[172:175], v[76:79]
v_cvt_pk_bf16_f32 v42, v44, v45
v_cvt_pk_bf16_f32 v43, v46, v47
M v[76:79], a[120:123], a[168:171], v[76:79]
ds_read_b64_tr_b16 a[72:73], v17 offset:0
ds_read_b64_tr_b16 a[74:75], v17 offset:2048
v_cvt_pk_bf16_f32 v48, v48, v49
v_cvt_pk_bf16_f32 v49, v50, v51
M v[80:83], a[128:131], a[168:171], v[80:83]
v_cvt_pk_bf16_f32 v50, v52, v53
v_cvt_pk_bf16_f32 v51, v54, v55
M v[80:83], a[132:135], a[172:175], v[80:83]
buffer_load_dwordx4 v9, s[12:15], s24 offen offset:3072 lds
v_cvt_pk_bf16_f32 v56, v56, v57
v_cvt_pk_bf16_f32 v57, v58, v59
M v[84:87], a[140:143], a[172:175], v[84:87]
v_cvt_pk_bf16_f32 v58, v60, v61
v_cvt_pk_bf16_f32 v59, v62, v63
M v[84:87], a[136:139], a[168:171], v[84:87]
ds_read_b64_tr_b16 a[80:81], v18 offset:0
ds_read_b64_tr_b16 a[82:83], v18 offset:2048
M v[88:91], a[144:147], a[168:171], v[88:91]
M v[88:91], a[148:151], a[172:175], v[88:91]
M v[92:95], a[156:159], a[172:175], v[92:95]
s_add_u32 s94, s92, 0
buffer_store_dwordx4 v[32:35], v1, s[16:19], s94 offen offset:0 sc1
M v[92:95], a[152:155], a[168:171], v[92:95]
s_waitcnt lgkmcnt(15)
ds_read_b64_tr_b16 a[88:89], v19 offset:0
ds_read_b64_tr_b16 a[90:91], v19 offset:2048
M v[96:99], a[96:99], a[176:179], v[96:99]
s_add_u32 s24, s24, 262144
s_cmp_eq_u32 s24, s27
s_cselect_b32 s24, s28, s24
s_sub_u32 s6, s6, 1
s_cmp_eq_u32 s6, 0
s_cselect_b64 s[12:13], s[64:65], s[12:13]
M v[96:99], a[100:103], a[180:183], v[96:99]
M v[100:103], a[108:111], a[180:183], v[100:103]
M v[100:103], a[104:107], a[176:179], v[100:103]
v_cvt_pk_bf16_f32 v64, v64, v65
v_cvt_pk_bf16_f32 v65, v66, v67
M v[104:107], a[112:115], a[176:179], v[104:107]
v_cvt_pk_bf16_f32 v66, v68, v69
v_cvt_pk_bf16_f32 v67, v70, v71
M v[104:107], a[116:119], a[180:183], v[104:107]
v_cvt_pk_bf16_f32 v72, v72, v73
v_cvt_pk_bf16_f32 v73, v74, v75
M v[108:111], a[124:127], a[180:183], v[108:111]
v_cvt_pk_bf16_f32 v74, v76, v77
v_cvt_pk_bf16_f32 v75, v78, v79
M v[108:111], a[120:123], a[176:179], v[108:111]
s_waitcnt vmcnt(17) lgkmcnt(0)
s_barrier
ds_read_b128 a[160:163], v10 offset:49152
ds_read_b128 a[164:167], v11 offset:49152
v_cvt_pk_bf16_f32 v80, v80, v81
v_cvt_pk_bf16_f32 v81, v82, v83
M v[112:115], a[128:131], a[176:179], v[112:115]
s_add_u32 s94, s92, 0
buffer_store_dwordx4 v[40:43], v1, s[16:19], s94 offen offset:1024 sc1
v_cvt_pk_bf16_f32 v82, v84, v85
v_cvt_pk_bf16_f32 v83, v86, v87
M v[112:115], a[132:135], a[180:183], v[112:115]
s_add_u32 m0, s29, 32768
s_nop 0
buffer_load_dwordx4 v2, s[8:11], s23 offen offset:0 lds
v_cvt_pk_bf16_f32 v88, v88, v89
v_cvt_pk_bf16_f32 v89, v90, v91
M v[116:119], a[140:143], a[180:183], v[116:119]
v_cvt_pk_bf16_f32 v90, v92, v93
v_cvt_pk_bf16_f32 v91, v94, v95
M v[116:119], a[136:139], a[176:179], v[116:119]
ds_read_b64_tr_b16 a[36:37], v12 offset:16384
ds_read_b64_tr_b16 a[38:39], v12 offset:18432
M v[120:123], a[144:147], a[176:179], v[120:123]
M v[120:123], a[148:151], a[180:183], v[120:123]
M v[124:127], a[156:159], a[180:183], v[124:127]
buffer_load_dwordx4 v3, s[8:11], s23 offen offset:1024 lds
M v[124:127], a[152:155], a[176:179], v[124:127]
M v[128:131], a[96:99], a[184:187], v[128:131]
M v[128:131], a[100:103], a[188:191], v[128:131]
ds_read_b128 a[168:171], v10 offset:51200
ds_read_b128 a[172:175], v11 offset:51200
ds_read_b64_tr_b16 a[44:45], v13 offset:16384
ds_read_b64_tr_b16 a[46:47], v13 offset:18432
M v[132:135], a[108:111], a[188:191], v[132:135]
M v[132:135], a[104:107], a[184:187], v[132:135]
s_add_u32 s94, s92, 0
buffer_store_dwordx4 v[48:51], v1, s[16:19], s94 offen offset:2048 sc1
v_cvt_pk_bf16_f32 v96, v96, v97
v_cvt_pk_bf16_f32 v97, v98, v99
M v[136:139], a[112:115], a[184:187], v[136:139]
v_cvt_pk_bf16_f32 v98, v100, v101
v_cvt_pk_bf16_f32 v99, v102, v103
M v[136:139], a[116:119], a[188:191], v[136:139]
v_cvt_pk_bf16_f32 v104, v104, v105
v_cvt_pk_bf16_f32 v105, v106, v107
M v[140:143], a[124:127], a[188:191], v[140:143]
buffer_load_dwordx4 v4, s[8:11], s23 offen offset:2048 lds
v_cvt_pk_bf16_f32 v106, v108, v109
v_cvt_pk_bf16_f32 v107, v110, v111
M v[140:143], a[120:123], a[184:187], v[140:143]
ds_read_b64_tr_b16 a[52:53], v14 offset:16384
ds_read_b64_tr_b16 a[54:55], v14 offset:18432
v_cvt_pk_bf16_f32 v112, v112, v113
v_cvt_pk_bf16_f32 v113, v114, v115
M v[144:147], a[128:131], a[184:187], v[144:147]
v_cvt_pk_bf16_f32 v114, v116, v117
v_cvt_pk_bf16_f32 v115, v118, v119
M v[144:147], a[132:135], a[188:191], v[144:147]
v_cvt_pk_bf16_f32 v120, v120, v121
v_cvt_pk_bf16_f32 v121, v122, v123
M v[148:151], a[140:143], a[188:191], v[148:151]
v_cvt_pk_bf16_f32 v122, v124, v125
v_cvt_pk_bf16_f32 v123, v126, v127
M v[148:151], a[136:139], a[184:187], v[148:151]
M v[152:155], a[144:147], a[184:187], v[152:155]
buffer_load_dwordx4 v5, s[8:11], s23 offen offset:3072 lds
M v[152:155], a[148:151], a[188:191], v[152:155]
ds_read_b64_tr_b16 a[60:61], v15 offset:16384
ds_read_b64_tr_b16 a[62:63], v15 offset:18432
M v[156:159], a[156:159], a[188:191], v[156:159]
s_add_u32 s94, s92, 0
buffer_store_dwordx4 v[56:59], v1, s[16:19], s94 offen offset:3072 sc1
M v[156:159], a[152:155], a[184:187], v[156:159]
s_waitcnt lgkmcnt(10)
M v[160:163], a[96:99], a[160:163], v[160:163]
M v[160:163], a[100:103], a[164:167], v[160:163]
ds_read_b128 a[176:179], v10 offset:53248
ds_read_b128 a[180:183], v11 offset:53248
M v[164:167], a[108:111], a[164:167], v[164:167]
M v[164:167], a[104:107], a[160:163], v[164:167]
ds_read_b64_tr_b16 a[68:69], v16 offset:16384
ds_read_b64_tr_b16 a[70:71], v16 offset:18432
v_cvt_pk_bf16_f32 v128, v128, v129
v_cvt_pk_bf16_f32 v129, v130, v131
M v[168:171], a[112:115], a[160:163], v[168:171]
v_cvt_pk_bf16_f32 v130, v132, v133
v_cvt_pk_bf16_f32 v131, v134, v135
M v[168:171], a[116:119], a[164:167], v[168:171]
s_add_u32 m0, s29, 65536
s_nop 0
buffer_load_dwordx4 v6, s[12:15], s24 offen offset:0 lds
v_cvt_pk_bf16_f32 v136, v136, v137
v_cvt_pk_bf16_f32 v137, v138, v139
M v[172:175], a[124:127], a[164:167], v[172:175]
v_cvt_pk_bf16_f32 v138, v140, v141
v_cvt_pk_bf16_f32 v139, v142, v143
M v[172:175], a[120:123], a[160:163], v[172:175]
v_cvt_pk_bf16_f32 v144, v144, v145
v_cvt_pk_bf16_f32 v145, v146, v147
M v[176:179], a[128:131], a[160:163], v[176:179]
s_add_u32 s94, s92, 4096
buffer_store_dwordx4 v[64:67], v1, s[16:19], s94 offen offset:0 sc1
v_cvt_pk_bf16_f32 v146, v148, v149
v_cvt_pk_bf16_f32 v147, v150, v151
M v[176:179], a[132:135], a[164:167], v[176:179]
ds_read_b64_tr_b16 a[76:77], v17 offset:16384
ds_read_b64_tr_b16 a[78:79], v17 offset:18432
v_cvt_pk_bf16_f32 v152, v152, v153
v_cvt_pk_bf16_f32 v153, v154, v155
M v[180:183], a[140:143], a[164:167], v[180:183]
v_cvt_pk_bf16_f32 v154, v156, v157
v_cvt_pk_bf16_f32 v155, v158, v159
M v[180:183], a[136:139], a[160:163], v[180:183]
M v[184:187], a[144:147], a[160:163], v[184:187]
buffer_load_dwordx4 v7, s[12:15], s24 offen offset:1024 lds
v_accvgpr_write_b32 a192, v128
v_accvgpr_write_b32 a193, v129
v_accvgpr_write_b32 a194, v130
v_accvgpr_write_b32 a195, v131
M v[184:187], a[148:151], a[164:167], v[184:187]
v_accvgpr_write_b32 a196, v136
v_accvgpr_write_b32 a197, v137
v_accvgpr_write_b32 a198, v138
v_accvgpr_write_b32 a199, v139
M v[188:191], a[156:159], a[164:167], v[188:191]
v_accvgpr_write_b32 a200, v144
v_accvgpr_write_b32 a201, v145
v_accvgpr_write_b32 a202, v146
v_accvgpr_write_b32 a203, v147
M v[188:191], a[152:155], a[160:163], v[188:191]
s_waitcnt lgkmcnt(12)
ds_read_b64_tr_b16 a[84:85], v18 offset:16384
ds_read_b64_tr_b16 a[86:87], v18 offset:18432
v_accvgpr_write_b32 a204, v152
v_accvgpr_write_b32 a205, v153
v_accvgpr_write_b32 a206, v154
v_accvgpr_write_b32 a207, v155
M v[192:195], a[96:99], a[168:171], v[192:195]
M v[192:195], a[100:103], a[172:175], v[192:195]
ds_read_b128 a[184:187], v10 offset:55296
ds_read_b128 a[188:191], v11 offset:55296
M v[196:199], a[108:111], a[172:175], v[196:199]
s_add_u32 s94, s92, 4096
buffer_store_dwordx4 v[72:75], v1, s[16:19], s94 offen offset:1024 sc1
M v[196:199], a[104:107], a[168:171], v[196:199]
v_cvt_pk_bf16_f32 v160, v160, v161
v_cvt_pk_bf16_f32 v161, v162, v163
M v[200:203], a[112:115], a[168:171], v[200:203]
buffer_load_dwordx4 v8, s[12:15], s24 offen offset:2048 lds
v_cvt_pk_bf16_f32 v162, v164, v165
v_cvt_pk_bf16_f32 v163, v166, v167
M v[200:203], a[116:119], a[172:175], v[200:203]
ds_read_b64_tr_b16 a[92:93], v19 offset:16384
ds_read_b64_tr_b16 a[94:95], v19 offset:18432
v_cvt_pk_bf16_f32 v168, v168, v169
v_cvt_pk_bf16_f32 v169, v170, v171
M v[204:207], a[124:127], a[172:175], v[204:207]
v_cvt_pk_bf16_f32 v170, v172, v173
v_cvt_pk_bf16_f32 v171, v174, v175
M v[204:207], a[120:123], a[168:171], v[204:207]
v_cvt_pk_bf16_f32 v176, v176, v177
v_cvt_pk_bf16_f32 v177, v178, v179
M v[208:211], a[128:131], a[168:171], v[208:211]
v_cvt_pk_bf16_f32 v178, v180, v181
v_cvt_pk_bf16_f32 v179, v182, v183
M v[208:211], a[132:135], a[172:175], v[208:211]
buffer_load_dwordx4 v9, s[12:15], s24 offen offset:3072 lds
v_cvt_pk_bf16_f32 v184, v184, v185
v_cvt_pk_bf16_f32 v185, v186, v187
M v[212:215], a[140:143], a[172:175], v[212:215]
v_cvt_pk_bf16_f32 v186, v188, v189
v_cvt_pk_bf16_f32 v187, v190, v191
M v[212:215], a[136:139], a[168:171], v[212:215]
M v[216:219], a[144:147], a[168:171], v[216:219]
v_accvgpr_write_b32 a208, v160
v_accvgpr_write_b32 a209, v161
v_accvgpr_write_b32 a210, v162
v_accvgpr_write_b32 a211, v163
M v[216:219], a[148:151], a[172:175], v[216:219]
s_add_u32 s94, s92, 4096
buffer_store_dwordx4 v[80:83], v1, s[16:19], s94 offen offset:2048 sc1
v_accvgpr_write_b32 a212, v168
v_accvgpr_write_b32 a213, v169
v_accvgpr_write_b32 a214, v170
v_accvgpr_write_b32 a215, v171
M v[220:223], a[156:159], a[172:175], v[220:223]
v_accvgpr_write_b32 a216, v176
v_accvgpr_write_b32 a217, v177
v_accvgpr_write_b32 a218, v178
v_accvgpr_write_b32 a219, v179
M v[220:223], a[152:155], a[168:171], v[220:223]
s_waitcnt lgkmcnt(10)
v_accvgpr_write_b32 a220, v184
v_accvgpr_write_b32 a221, v185
v_accvgpr_write_b32 a222, v186
v_accvgpr_write_b32 a223, v187
M v[224:227], a[96:99], a[176:179], v[224:227]
s_add_u32 s24, s24, 262144
M v[224:227], a[100:103], a[180:183], v[224:227]
M v[228:231], a[108:111], a[180:183], v[228:231]
M v[228:231], a[104:107], a[176:179], v[228:231]
v_cvt_pk_bf16_f32 v192, v192, v193
v_cvt_pk_bf16_f32 v193, v194, v195
M v[232:235], a[112:115], a[176:179], v[232:235]
v_cvt_pk_bf16_f32 v194, v196, v197
v_cvt_pk_bf16_f32 v195, v198, v199
M v[232:235], a[116:119], a[180:183], v[232:235]
v_cvt_pk_bf16_f32 v200, v200, v201
v_cvt_pk_bf16_f32 v201, v202, v203
M v[236:239], a[124:127], a[180:183], v[236:239]
v_cvt_pk_bf16_f32 v202, v204, v205
v_cvt_pk_bf16_f32 v203, v206, v207
M v[236:239], a[120:123], a[176:179], v[236:239]
s_waitcnt vmcnt(23) lgkmcnt(0)
s_barrier
ds_read_b128 a[160:163], v10 offset:0
ds_read_b128 a[164:167], v11 offset:0
v_cvt_pk_bf16_f32 v208, v208, v209
v_cvt_pk_bf16_f32 v209, v210, v211
M v[240:243], a[128:131], a[176:179], v[240:243]
s_add_u32 s94, s92, 4096
buffer_store_dwordx4 v[88:91], v1, s[16:19], s94 offen offset:3072 sc1
v_cvt_pk_bf16_f32 v210, v212, v213
v_cvt_pk_bf16_f32 v211, v214, v215
M v[240:243], a[132:135], a[180:183], v[240:243]
s_add_u32 m0, s29, 49152
s_add_u32 s3, s23, s31
buffer_load_dwordx4 v2, s[8:11], s3 offen offset:0 lds
v_cvt_pk_bf16_f32 v216, v216, v217
v_cvt_pk_bf16_f32 v217, v218, v219
M v[244:247], a[140:143], a[180:183], v[244:247]
v_cvt_pk_bf16_f32 v218, v220, v221
v_cvt_pk_bf16_f32 v219, v222, v223
M v[244:247], a[136:139], a[176:179], v[244:247]
M v[248:251], a[144:147], a[176:179], v[248:251]
v_accvgpr_write_b32 a224, v192
v_accvgpr_write_b32 a225, v193
v_accvgpr_write_b32 a226, v194
v_accvgpr_write_b32 a227, v195
M v[248:251], a[148:151], a[180:183], v[248:251]
buffer_load_dwordx4 v3, s[8:11], s3 offen offset:1024 lds
v_accvgpr_write_b32 a228, v200
v_accvgpr_write_b32 a229, v201
v_accvgpr_write_b32 a230, v202
v_accvgpr_write_b32 a231, v203
M v[252:255], a[156:159], a[180:183], v[252:255]
v_accvgpr_write_b32 a232, v208
v_accvgpr_write_b32 a233, v209
v_accvgpr_write_b32 a234, v210
v_accvgpr_write_b32 a235, v211
M v[252:255], a[152:155], a[176:179], v[252:255]
v_accvgpr_write_b32 a236, v216
v_accvgpr_write_b32 a237, v217
v_accvgpr_write_b32 a238, v218
v_accvgpr_write_b32 a239, v219
M a[0:3], a[96:99], a[184:187], a[0:3]
M a[0:3], a[100:103], a[188:191], a[0:3]
ds_read_b128 a[168:171], v10 offset:2048
ds_read_b128 a[172:175], v11 offset:2048
M a[4:7], a[108:111], a[188:191], a[4:7]
s_add_u32 s94, s92, 8192
buffer_store_dwordx4 v[96:99], v1, s[16:19], s94 offen offset:0 sc1
M a[4:7], a[104:107], a[184:187], a[4:7]
v_cvt_pk_bf16_f32 v224, v224, v225
v_cvt_pk_bf16_f32 v225, v226, v227
M a[8:11], a[112:115], a[184:187], a[8:11]
v_cvt_pk_bf16_f32 v226, v228, v229
v_cvt_pk_bf16_f32 v227, v230, v231
M a[8:11], a[116:119], a[188:191], a[8:11]
buffer_load_dwordx4 v4, s[8:11], s3 offen offset:2048 lds
v_cvt_pk_bf16_f32 v232, v232, v233
v_cvt_pk_bf16_f32 v233, v234, v235
M a[12:15], a[124:127], a[188:191], a[12:15]
v_cvt_pk_bf16_f32 v234, v236, v237
v_cvt_pk_bf16_f32 v235, v238, v239
M a[12:15], a[120:123], a[184:187], a[12:15]
v_cvt_pk_bf16_f32 v240, v240, v241
v_cvt_pk_bf16_f32 v241, v242, v243
M a[16:19], a[128:131], a[184:187], a[16:19]
v_cvt_pk_bf16_f32 v242, v244, v245
v_cvt_pk_bf16_f32 v243, v246, v247
M a[16:19], a[132:135], a[188:191], a[16:19]
buffer_load_dwordx4 v5, s[8:11], s3 offen offset:3072 lds
v_cvt_pk_bf16_f32 v248, v248, v249
v_cvt_pk_bf16_f32 v249, v250, v251
M a[20:23], a[140:143], a[188:191], a[20:23]
v_cvt_pk_bf16_f32 v250, v252, v253
v_cvt_pk_bf16_f32 v251, v254, v255
M a[20:23], a[136:139], a[184:187], a[20:23]
M a[24:27], a[144:147], a[184:187], a[24:27]
s_add_u32 s94, s92, 8192
buffer_store_dwordx4 v[104:107], v1, s[16:19], s94 offen offset:1024 sc1
v_accvgpr_write_b32 a240, v224
v_accvgpr_write_b32 a241, v225
v_accvgpr_write_b32 a242, v226
v_accvgpr_write_b32 a243, v227
M a[24:27], a[148:151], a[188:191], a[24:27]
v_accvgpr_write_b32 a244, v232
v_accvgpr_write_b32 a245, v233
v_accvgpr_write_b32 a246, v234
v_accvgpr_write_b32 a247, v235
M a[28:31], a[156:159], a[188:191], a[28:31]
v_accvgpr_write_b32 a248, v240
v_accvgpr_write_b32 a249, v241
v_accvgpr_write_b32 a250, v242
v_accvgpr_write_b32 a251, v243
M a[28:31], a[152:155], a[184:187], a[28:31]
s_waitcnt lgkmcnt(2)
v_accvgpr_write_b32 a252, v248
v_accvgpr_write_b32 a253, v249
v_accvgpr_write_b32 a254, v250
v_accvgpr_write_b32 a255, v251
M v[32:35], a[160:163], a[32:35], 0
s_add_u32 s23, s23, 128
s_cmp_eq_u32 s23, s25
s_cselect_b32 s23, s26, s23
M v[32:35], a[164:167], a[36:39], v[32:35]
ds_read_b128 a[176:179], v10 offset:4096
ds_read_b128 a[180:183], v11 offset:4096
M v[36:39], a[164:167], a[44:47], 0
M v[36:39], a[160:163], a[40:43], v[36:39]
ds_read_b64_tr_b16 a[96:97], v12 offset:32768
ds_read_b64_tr_b16 a[98:99], v12 offset:34816
M v[40:43], a[160:163], a[48:51], 0
M v[40:43], a[164:167], a[52:55], v[40:43]
M v[44:47], a[164:167], a[60:63], 0
s_add_u32 m0, s29, 81920
s_nop 0
buffer_load_dwordx4 v6, s[12:15], s24 offen offset:0 lds
M v[44:47], a[160:163], a[56:59], v[44:47]
ds_read_b64_tr_b16 a[104:105], v13 offset:32768
ds_read_b64_tr_b16 a[106:107], v13 offset:34816
M v[48:51], a[160:163], a[64:67], 0
s_add_u32 s94, s92, 8192
buffer_store_dwordx4 v[112:115], v1, s[16:19], s94 offen offset:2048 sc1
M v[48:51], a[164:167], a[68:71], v[48:51]
M v[52:55], a[164:167], a[76:79], 0
M v[52:55], a[160:163], a[72:75], v[52:55]
ds_read_b64_tr_b16 a[112:113], v14 offset:32768
ds_read_b64_tr_b16 a[114:115], v14 offset:34816
M v[56:59], a[160:163], a[80:83], 0
M v[56:59], a[164:167], a[84:87], v[56:59]
buffer_load_dwordx4 v7, s[12:15], s24 offen offset:1024 lds
M v[60:63], a[164:167], a[92:95], 0
M v[60:63], a[160:163], a[88:91], v[60:63]
s_waitcnt lgkmcnt(8)
ds_read_b64_tr_b16 a[120:121], v15 offset:32768
ds_read_b64_tr_b16 a[122:123], v15 offset:34816
M v[64:67], a[168:171], a[32:35], 0
M v[64:67], a[172:175], a[36:39], v[64:67]
ds_read_b128 a[184:187], v10 offset:6144
ds_read_b128 a[188:191], v11 offset:6144
M v[68:71], a[172:175], a[44:47], 0
s_add_u32 s94, s92, 8192
buffer_store_dwordx4 v[120:123], v1, s[16:19], s94 offen offset:3072 sc1
M v[68:71], a[168:171], a[40:43], v[68:71]
ds_read_b64_tr_b16 a[128:129], v16 offset:32768
ds_read_b64_tr_b16 a[130:131], v16 offset:34816
M v[72:75], a[168:171], a[48:51], 0
v_accvgpr_read_b32 v24, a0
v_accvgpr_read_b32 v25, a1
M v[72:75], a[172:175], a[52:55], v[72:75]
buffer_load_dwordx4 v8, s[12:15], s24 offen offset:2048 lds
v_accvgpr_read_b32 v26, a2
v_accvgpr_read_b32 v27, a3
M v[76:79], a[172:175], a[60:63], 0
v_accvgpr_read_b32 v28, a4
v_accvgpr_read_b32 v29, a5
M v[76:79], a[168:171], a[56:59], v[76:79]
ds_read_b64_tr_b16 a[136:137], v17 offset:32768
ds_read_b64_tr_b16 a[138:139], v17 offset:34816
v_accvgpr_read_b32 v30, a6
v_accvgpr_read_b32 v31, a7
M v[80:83], a[168:171], a[64:67], 0
v_cvt_pk_bf16_f32 v24, v24, v25
v_cvt_pk_bf16_f32 v25, v26, v27
M v[80:83], a[172:175], a[68:71], v[80:83]
v_cvt_pk_bf16_f32 v26, v28, v29
v_cvt_pk_bf16_f32 v27, v30, v31
M v[84:87], a[172:175], a[76:79], 0
buffer_load_dwordx4 v9, s[12:15], s24 offen offset:3072 lds
M v[84:87], a[168:171], a[72:75], v[84:87]
ds_read_b64_tr_b16 a[144:145], v18 offset:32768
ds_read_b64_tr_b16 a[146:147], v18 offset:34816
M v[88:91], a[168:171], a[80:83], 0
M v[88:91], a[172:175], a[84:87], v[88:91]
s_add_u32 s94, s93, 12288
buffer_store_dwordx4 v[24:27], v1, s[16:19], s94 offen offset:0 sc1
M v[92:95], a[172:175], a[92:95], 0
M v[92:95], a[168:171], a[88:91], v[92:95]
s_waitcnt lgkmcnt(15)
ds_read_b64_tr_b16 a[152:153], v19 offset:32768
ds_read_b64_tr_b16 a[154:155], v19 offset:34816
M v[96:99], a[176:179], a[32:35], 0
M v[96:99], a[180:183], a[36:39], v[96:99]
s_add_u32 s24, s24, 262144
s_cmp_eq_u32 s24, s27
s_cselect_b32 s24, s28, s24
s_sub_u32 s6, s6, 1
s_cmp_eq_u32 s6, 0
s_cselect_b64 s[12:13], s[64:65], s[12:13]
M v[100:103], a[180:183], a[44:47], 0
M v[100:103], a[176:179], a[40:43], v[100:103]
M v[104:107], a[176:179], a[48:51], 0
M v[104:107], a[180:183], a[52:55], v[104:107]
M v[108:111], a[180:183], a[60:63], 0
M v[108:111], a[176:179], a[56:59], v[108:111]
s_waitcnt vmcnt(29) lgkmcnt(0)
s_barrier
ds_read_b128 a[160:163], v10 offset:16384
ds_read_b128 a[164:167], v11 offset:16384
M v[112:115], a[176:179], a[64:67], 0
s_add_u32 m0, s29, 0
s_nop 0
buffer_load_dwordx4 v2, s[8:11], s23 offen offset:0 lds
M v[112:115], a[180:183], a[68:71], v[112:115]
M v[116:119], a[180:183], a[76:79], 0
M v[116:119], a[176:179], a[72:75], v[116:119]
ds_read_b64_tr_b16 a[100:101], v12 offset:49152
ds_read_b64_tr_b16 a[102:103], v12 offset:51200
M v[120:123], a[176:179], a[80:83], 0
v_accvgpr_read_b32 v24, a8
v_accvgpr_read_b32 v25, a9
M v[120:123], a[180:183], a[84:87], v[120:123]
v_accvgpr_read_b32 v26, a10
v_accvgpr_read_b32 v27, a11
M v[124:127], a[180:183], a[92:95], 0
buffer_load_dwordx4 v3, s[8:11], s23 offen offset:1024 lds
v_accvgpr_read_b32 v28, a12
v_accvgpr_read_b32 v29, a13
M v[124:127], a[176:179], a[88:91], v[124:127]
v_accvgpr_read_b32 v30, a14
v_accvgpr_read_b32 v31, a15
M v[128:131], a[184:187], a[32:35], 0
v_cvt_pk_bf16_f32 v24, v24, v25
v_cvt_pk_bf16_f32 v25, v26, v27
M v[128:131], a[188:191], a[36:39], v[128:131]
ds_read_b128 a[168:171], v10 offset:18432
ds_read_b128 a[172:175], v11 offset:18432
ds_read_b64_tr_b16 a[108:109], v13 offset:49152
ds_read_b64_tr_b16 a[110:111], v13 offset:51200
v_cvt_pk_bf16_f32 v26, v28, v29
v_cvt_pk_bf16_f32 v27, v30, v31
M v[132:135], a[188:191], a[44:47], 0
M v[132:135], a[184:187], a[40:43], v[132:135]
M v[136:139], a[184:187], a[48:51], 0
M v[136:139], a[188:191], a[52:55], v[136:139]
s_add_u32 s94, s93, 12288
buffer_store_dwordx4 v[24:27], v1, s[16:19], s94 offen offset:1024 sc1
M v[140:143], a[188:191], a[60:63], 0
buffer_load_dwordx4 v4, s[8:11], s23 offen offset:2048 lds
M v[140:143], a[184:187], a[56:59], v[140:143]
ds_read_b64_tr_b16 a[116:117], v14 offset:49152
ds_read_b64_tr_b16 a[118:119], v14 offset:51200
M v[144:147], a[184:187], a[64:67], 0
M v[144:147], a[188:191], a[68:71], v[144:147]
M v[148:151], a[188:191], a[76:79], 0
M v[148:151], a[184:187], a[72:75], v[148:151]
M v[152:155], a[184:187], a[80:83], 0
buffer_load_dwordx4 v5, s[8:11], s23 offen offset:3072 lds
M v[152:155], a[188:191], a[84:87], v[152:155]
ds_read_b64_tr_b16 a[124:125], v15 offset:49152
ds_read_b64_tr_b16 a[126:127], v15 offset:51200
M v[156:159], a[188:191], a[92:95], 0
M v[156:159], a[184:187], a[88:91], v[156:159]
s_waitcnt lgkmcnt(10)
M v[160:163], a[160:163], a[32:35], 0
M v[160:163], a[164:167], a[36:39], v[160:163]
ds_read_b128 a[176:179], v10 offset:20480
ds_read_b128 a[180:183], v11 offset:20480
M v[164:167], a[164:167], a[44:47], 0
M v[164:167], a[160:163], a[40:43], v[164:167]
ds_read_b64_tr_b16 a[132:133], v16 offset:49152
ds_read_b64_tr_b16 a[134:135], v16 offset:51200
M v[168:171], a[160:163], a[48:51], 0
v_accvgpr_read_b32 v24, a16
v_accvgpr_read_b32 v25, a17
M v[168:171], a[164:167], a[52:55], v[168:171]
s_add_u32 m0, s29, 98304
s_nop 0
buffer_load_dwordx4 v6, s[12:15], s24 offen offset:0 lds
v_accvgpr_read_b32 v26, a18
v_accvgpr_read_b32 v27, a19
M v[172:175], a[164:167], a[60:63], 0
v_accvgpr_read_b32 v28, a20
v_accvgpr_read_b32 v29, a21
M v[172:175], a[160:163], a[56:59], v[172:175]
v_accvgpr_read_b32 v30, a22
v_accvgpr_read_b32 v31, a23
M v[176:179], a[160:163], a[64:67], 0
v_cvt_pk_bf16_f32 v24, v24, v25
v_cvt_pk_bf16_f32 v25, v26, v27
M v[176:179], a[164:167], a[68:71], v[176:179]
ds_read_b64_tr_b16 a[140:141], v17 offset:49152
ds_read_b64_tr_b16 a[142:143], v17 offset:51200
v_cvt_pk_bf16_f32 v26, v28, v29
v_cvt_pk_bf16_f32 v27, v30, v31
M v[180:183], a[164:167], a[76:79], 0
M v[180:183], a[160:163], a[72:75], v[180:183]
buffer_load_dwordx4 v7, s[12:15], s24 offen offset:1024 lds
M v[184:187], a[160:163], a[80:83], 0
M v[184:187], a[164:167], a[84:87], v[184:187]
s_add_u32 s94, s93, 12288
buffer_store_dwordx4 v[24:27], v1, s[16:19], s94 offen offset:2048 sc1
M v[188:191], a[164:167], a[92:95], 0
M v[188:191], a[160:163], a[88:91], v[188:191]
s_waitcnt lgkmcnt(12)
ds_read_b64_tr_b16 a[148:149], v18 offset:49152
ds_read_b64_tr_b16 a[150:151], v18 offset:51200
M v[192:195], a[168:171], a[32:35], 0
M v[192:195], a[172:175], a[36:39], v[192:195]
ds_read_b128 a[184:187], v10 offset:22528
ds_read_b128 a[188:191], v11 offset:22528
M v[196:199], a[172:175], a[44:47], 0
M v[196:199], a[168:171], a[40:43], v[196:199]
buffer_load_dwordx4 v8, s[12:15], s24 offen offset:2048 lds
M v[200:203], a[168:171], a[48:51], 0
M v[200:203], a[172:175], a[52:55], v[200:203]
ds_read_b64_tr_b16 a[156:157], v19 offset:49152
ds_read_b64_tr_b16 a[158:159], v19 offset:51200
M v[204:207], a[172:175], a[60:63], 0
M v[204:207], a[168:171], a[56:59], v[204:207]
M v[208:211], a[168:171], a[64:67], 0
M v[208:211], a[172:175], a[68:71], v[208:211]
buffer_load_dwordx4 v9, s[12:15], s24 offen offset:3072 lds
M v[212:215], a[172:175], a[76:79], 0
M v[212:215], a[168:171], a[72:75], v[212:215]
M v[216:219], a[168:171], a[80:83], 0
v_accvgpr_read_b32 v24, a24
v_accvgpr_read_b32 v25, a25
M v[216:219], a[172:175], a[84:87], v[216:219]
v_accvgpr_read_b32 v26, a26
v_accvgpr_read_b32 v27, a27
M v[220:223], a[172:175], a[92:95], 0
s_add_u32 s24, s24, 262144
v_accvgpr_read_b32 v28, a28
v_accvgpr_read_b32 v29, a29
M v[220:223], a[168:171], a[88:91], v[220:223]
s_waitcnt lgkmcnt(10)
v_accvgpr_read_b32 v30, a30
v_accvgpr_read_b32 v31, a31
M v[224:227], a[176:179], a[32:35], 0
v_cvt_pk_bf16_f32 v24, v24, v25
v_cvt_pk_bf16_f32 v25, v26, v27
M v[224:227], a[180:183], a[36:39], v[224:227]
v_cvt_pk_bf16_f32 v26, v28, v29
v_cvt_pk_bf16_f32 v27, v30, v31
M v[228:231], a[180:183], a[44:47], 0
M v[228:231], a[176:179], a[40:43], v[228:231]
M v[232:235], a[176:179], a[48:51], 0
M v[232:235], a[180:183], a[52:55], v[232:235]
s_add_u32 s94, s93, 12288
buffer_store_dwordx4 v[24:27], v1, s[16:19], s94 offen offset:3072 sc1
M v[236:239], a[180:183], a[60:63], 0
M v[236:239], a[176:179], a[56:59], v[236:239]
s_waitcnt vmcnt(26) lgkmcnt(0)
s_barrier
ds_read_b128 a[160:163], v10 offset:32768
ds_read_b128 a[164:167], v11 offset:32768
M v[240:243], a[176:179], a[64:67], 0
s_add_u32 m0, s29, 16384
s_add_u32 s3, s23, s31
buffer_load_dwordx4 v2, s[8:11], s3 offen offset:0 lds
M v[240:243], a[180:183], a[68:71], v[240:243]
M v[244:247], a[180:183], a[76:79], 0
M v[244:247], a[176:179], a[72:75], v[244:247]
M v[248:251], a[176:179], a[80:83], 0
M v[248:251], a[180:183], a[84:87], v[248:251]
buffer_load_dwordx4 v3, s[8:11], s3 offen offset:1024 lds
M v[252:255], a[180:183], a[92:95], 0
M v[252:255], a[176:179], a[88:91], v[252:255]
M a[0:3], a[184:187], a[32:35], 0
M a[0:3], a[188:191], a[36:39], a[0:3]
ds_read_b128 a[168:171], v10 offset:34816
ds_read_b128 a[172:175], v11 offset:34816
M a[4:7], a[188:191], a[44:47], 0
M a[4:7], a[184:187], a[40:43], a[4:7]
M a[8:11], a[184:187], a[48:51], 0
buffer_load_dwordx4 v4, s[8:11], s3 offen offset:2048 lds
M a[8:11], a[188:191], a[52:55], a[8:11]
M a[12:15], a[188:191], a[60:63], 0
M a[12:15], a[184:187], a[56:59], a[12:15]
M a[16:19], a[184:187], a[64:67], 0
M a[16:19], a[188:191], a[68:71], a[16:19]
buffer_load_dwordx4 v5, s[8:11], s3 offen offset:3072 lds
M a[20:23], a[188:191], a[76:79], 0
M a[20:23], a[184:187], a[72:75], a[20:23]
M a[24:27], a[184:187], a[80:83], 0
M a[24:27], a[188:191], a[84:87], a[24:27]
M a[28:31], a[188:191], a[92:95], 0
M a[28:31], a[184:187], a[88:91], a[28:31]
s_waitcnt lgkmcnt(2)
M v[32:35], a[160:163], a[96:99], v[32:35]
s_add_u32 s23, s23, 128
s_cmp_eq_u32 s23, s25
s_cselect_b32 s23, s26, s23
M v[32:35], a[164:167], a[100:103], v[32:35]
ds_read_b128 a[176:179], v10 offset:36864
ds_read_b128 a[180:183], v11 offset:36864
M v[36:39], a[164:167], a[108:111], v[36:39]
M v[36:39], a[160:163], a[104:107], v[36:39]
ds_read_b64_tr_b16 a[32:33], v12 offset:0
ds_read_b64_tr_b16 a[34:35], v12 offset:2048
M v[40:43], a[160:163], a[112:115], v[40:43]
M v[40:43], a[164:167], a[116:119], v[40:43]
M v[44:47], a[164:167], a[124:127], v[44:47]
s_add_u32 m0, s29, 114688
s_nop 0
buffer_load_dwordx4 v6, s[12:15], s24 offen offset:0 lds
M v[44:47], a[160:163], a[120:123], v[44:47]
ds_read_b64_tr_b16 a[40:41], v13 offset:0
ds_read_b64_tr_b16 a[42:43], v13 offset:2048
M v[48:51], a[160:163], a[128:131], v[48:51]
s_add_u32 s94, s92, 12288
buffer_store_dwordx4 a[192:195], v1, s[16:19], s94 offen offset:0 sc1
M v[48:51], a[164:167], a[132:135], v[48:51]
M v[52:55], a[164:167], a[140:143], v[52:55]
M v[52:55], a[160:163], a[136:139], v[52:55]
ds_read_b64_tr_b16 a[48:49], v14 offset:0
ds_read_b64_tr_b16 a[50:51], v14 offset:2048
M v[56:59], a[160:163], a[144:147], v[56:59]
M v[56:59], a[164:167], a[148:151], v[56:59]
buffer_load_dwordx4 v7, s[12:15], s24 offen offset:1024 lds
M v[60:63], a[164:167], a[156:159], v[60:63]
M v[60:63], a[160:163], a[152:155], v[60:63]
s_waitcnt lgkmcnt(8)
ds_read_b64_tr_b16 a[56:57], v15 offset:0
ds_read_b64_tr_b16 a[58:59], v15 offset:2048
M v[64:67], a[168:171], a[96:99], v[64:67]
M v[64:67], a[172:175], a[100:103], v[64:67]
ds_read_b128 a[184:187], v10 offset:38912
ds_read_b128 a[188:191], v11 offset:38912
M v[68:71], a[172:175], a[108:111], v[68:71]
M v[68:71], a[168:171], a[104:107], v[68:71]
ds_read_b64_tr_b16 a[64:65], v16 offset:0
ds_read_b64_tr_b16 a[66:67], v16 offset:2048
M v[72:75], a[168:171], a[112:115], v[72:75]
buffer_load_dwordx4 v8, s[12:15], s24 offen offset:2048 lds
M v[72:75], a[172:175], a[116:119], v[72:75]
M v[76:79], a[172:175], a[124:127], v[76:79]
M v[76:79], a[168:171], a[120:123], v[76:79]
ds_read_b64_tr_b16 a[72:73], v17 offset:0
ds_read_b64_tr_b16 a[74:75], v17 offset:2048
M v[80:83], a[168:171], a[128:131], v[80:83]
M v[80:83], a[172:175], a[132:135], v[80:83]
buffer_load_dwordx4 v9, s[12:15], s24 offen offset:3072 lds
M v[84:87], a[172:175], a[140:143], v[84:87]
M v[84:87], a[168:171], a[136:139], v[84:87]
ds_read_b64_tr_b16 a[80:81], v18 offset:0
ds_read_b64_tr_b16 a[82:83], v18 offset:2048
M v[88:91], a[168:171], a[144:147], v[88:91]
M v[88:91], a[172:175], a[148:151], v[88:91]
M v[92:95], a[172:175], a[156:159], v[92:95]
s_add_u32 s24, s24, 262144
s_cmp_eq_u32 s24, s27
s_cselect_b32 s24, s28, s24
s_sub_u32 s6, s6, 1
s_cmp_eq_u32 s6, 0
s_cselect_b64 s[12:13], s[64:65], s[12:13]
M v[92:95], a[168:171], a[152:155], v[92:95]
s_waitcnt lgkmcnt(15)
ds_read_b64_tr_b16 a[88:89], v19 offset:0
ds_read_b64_tr_b16 a[90:91], v19 offset:2048
M v[96:99], a[176:179], a[96:99], v[96:99]
M v[96:99], a[180:183], a[100:103], v[96:99]
M v[100:103], a[180:183], a[108:111], v[100:103]
M v[100:103], a[176:179], a[104:107], v[100:103]
M v[104:107], a[176:179], a[112:115], v[104:107]
s_add_u32 s94, s92, 12288
buffer_store_dwordx4 a[196:199], v1, s[16:19], s94 offen offset:1024 sc1
M v[104:107], a[180:183], a[116:119], v[104:107]
M v[108:111], a[180:183], a[124:127], v[108:111]
M v[108:111], a[176:179], a[120:123], v[108:111]
s_waitcnt vmcnt(22) lgkmcnt(0)
s_barrier
ds_read_b128 a[160:163], v10 offset:49152
ds_read_b128 a[164:167], v11 offset:49152
M v[112:115], a[176:179], a[128:131], v[112:115]
s_add_u32 m0, s29, 32768
s_nop 0
buffer_load_dwordx4 v2, s[8:11], s23 offen offset:0 lds
M v[112:115], a[180:183], a[132:135], v[112:115]
M v[116:119], a[180:183], a[140:143], v[116:119]
M v[116:119], a[176:179], a[136:139], v[116:119]
ds_read_b64_tr_b16 a[36:37], v12 offset:16384
ds_read_b64_tr_b16 a[38:39], v12 offset:18432
M v[120:123], a[176:179], a[144:147], v[120:123]
M v[120:123], a[180:183], a[148:151], v[120:123]
M v[124:127], a[180:183], a[156:159], v[124:127]
buffer_load_dwordx4 v3, s[8:11], s23 offen offset:1024 lds
M v[124:127], a[176:179], a[152:155], v[124:127]
M v[128:131], a[184:187], a[96:99], v[128:131]
M v[128:131], a[188:191], a[100:103], v[128:131]
ds_read_b128 a[168:171], v10 offset:51200
ds_read_b128 a[172:175], v11 offset:51200
ds_read_b64_tr_b16 a[44:45], v13 offset:16384
ds_read_b64_tr_b16 a[46:47], v13 offset:18432
M v[132:135], a[188:191], a[108:111], v[132:135]
M v[132:135], a[184:187], a[104:107], v[132:135]
M v[136:139], a[184:187], a[112:115], v[136:139]
M v[136:139], a[188:191], a[116:119], v[136:139]
buffer_load_dwordx4 v4, s[8:11], s23 offen offset:2048 lds
M v[140:143], a[188:191], a[124:127], v[140:143]
M v[140:143], a[184:187], a[120:123], v[140:143]
ds_read_b64_tr_b16 a[52:53], v14 offset:16384
ds_read_b64_tr_b16 a[54:55], v14 offset:18432
M v[144:147], a[184:187], a[128:131], v[144:147]
M v[144:147], a[188:191], a[132:135], v[144:147]
M v[148:151], a[188:191], a[140:143], v[148:151]
M v[148:151], a[184:187], a[136:139], v[148:151]
buffer_load_dwordx4 v5, s[8:11], s23 offen offset:3072 lds
M v[152:155], a[184:187], a[144:147], v[152:155]
M v[152:155], a[188:191], a[148:151], v[152:155]
ds_read_b64_tr_b16 a[60:61], v15 offset:16384
ds_read_b64_tr_b16 a[62:63], v15 offset:18432
M v[156:159], a[188:191], a[156:159], v[156:159]
M v[156:159], a[184:187], a[152:155], v[156:159]
s_waitcnt lgkmcnt(10)
M v[160:163], a[160:163], a[96:99], v[160:163]
s_add_u32 s94, s92, 12288
buffer_store_dwordx4 a[200:203], v1, s[16:19], s94 offen offset:2048 sc1
M v[160:163], a[164:167], a[100:103], v[160:163]
ds_read_b128 a[176:179], v10 offset:53248
ds_read_b128 a[180:183], v11 offset:53248
M v[164:167], a[164:167], a[108:111], v[164:167]
M v[164:167], a[160:163], a[104:107], v[164:167]
ds_read_b64_tr_b16 a[68:69], v16 offset:16384
ds_read_b64_tr_b16 a[70:71], v16 offset:18432
M v[168:171], a[160:163], a[112:115], v[168:171]
M v[168:171], a[164:167], a[116:119], v[168:171]
s_add_u32 m0, s29, 65536
s_nop 0
buffer_load_dwordx4 v6, s[12:15], s24 offen offset:0 lds
M v[172:175], a[164:167], a[124:127], v[172:175]
M v[172:175], a[160:163], a[120:123], v[172:175]
M v[176:179], a[160:163], a[128:131], v[176:179]
M v[176:179], a[164:167], a[132:135], v[176:179]
ds_read_b64_tr_b16 a[76:77], v17 offset:16384
ds_read_b64_tr_b16 a[78:79], v17 offset:18432
M v[180:183], a[164:167], a[140:143], v[180:183]
M v[180:183], a[160:163], a[136:139], v[180:183]
buffer_load_dwordx4 v7, s[12:15], s24 offen offset:1024 lds
M v[184:187], a[160:163], a[144:147], v[184:187]
M v[184:187], a[164:167], a[148:151], v[184:187]
M v[188:191], a[164:167], a[156:159], v[188:191]
M v[188:191], a[160:163], a[152:155], v[188:191]
s_waitcnt lgkmcnt(12)
ds_read_b64_tr_b16 a[84:85], v18 offset:16384
ds_read_b64_tr_b16 a[86:87], v18 offset:18432
M v[192:195], a[168:171], a[96:99], v[192:195]
M v[192:195], a[172:175], a[100:103], v[192:195]
ds_read_b128 a[184:187], v10 offset:55296
ds_read_b128 a[188:191], v11 offset:55296
M v[196:199], a[172:175], a[108:111], v[196:199]
buffer_load_dwordx4 v8, s[12:15], s24 offen offset:2048 lds
M v[196:199], a[168:171], a[104:107], v[196:199]
M v[200:203], a[168:171], a[112:115], v[200:203]
M v[200:203], a[172:175], a[116:119], v[200:203]
ds_read_b64_tr_b16 a[92:93], v19 offset:16384
ds_read_b64_tr_b16 a[94:95], v19 offset:18432
M v[204:207], a[172:175], a[124:127], v[204:207]
M v[204:207], a[168:171], a[120:123], v[204:207]
M v[208:211], a[168:171], a[128:131], v[208:211]
buffer_load_dwordx4 v9, s[12:15], s24 offen offset:3072 lds
M v[208:211], a[172:175], a[132:135], v[208:211]
M v[212:215], a[172:175], a[140:143], v[212:215]
M v[212:215], a[168:171], a[136:139], v[212:215]
M v[216:219], a[168:171], a[144:147], v[216:219]
s_add_u32 s94, s92, 12288
buffer_store_dwordx4 a[204:207], v1, s[16:19], s94 offen offset:3072 sc1
M v[216:219], a[172:175], a[148:151], v[216:219]
M v[220:223], a[172:175], a[156:159], v[220:223]
s_add_u32 s24, s24, 262144
M v[220:223], a[168:171], a[152:155], v[220:223]
s_waitcnt lgkmcnt(10)
M v[224:227], a[176:179], a[96:99], v[224:227]
M v[224:227], a[180:183], a[100:103], v[224:227]
M v[228:231], a[180:183], a[108:111], v[228:231]
M v[228:231], a[176:179], a[104:107], v[228:231]
M v[232:235], a[176:179], a[112:115], v[232:235]
M v[232:235], a[180:183], a[116:119], v[232:235]
M v[236:239], a[180:183], a[124:127], v[236:239]
M v[236:239], a[176:179], a[120:123], v[236:239]
s_waitcnt vmcnt(21) lgkmcnt(0)
s_barrier
ds_read_b128 a[160:163], v10 offset:0
ds_read_b128 a[164:167], v11 offset:0
M v[240:243], a[176:179], a[128:131], v[240:243]
s_add_u32 m0, s29, 49152
s_add_u32 s3, s23, s31
buffer_load_dwordx4 v2, s[8:11], s3 offen offset:0 lds
M v[240:243], a[180:183], a[132:135], v[240:243]
M v[244:247], a[180:183], a[140:143], v[244:247]
M v[244:247], a[176:179], a[136:139], v[244:247]
M v[248:251], a[176:179], a[144:147], v[248:251]
M v[248:251], a[180:183], a[148:151], v[248:251]
buffer_load_dwordx4 v3, s[8:11], s3 offen offset:1024 lds
M v[252:255], a[180:183], a[156:159], v[252:255]
M v[252:255], a[176:179], a[152:155], v[252:255]
M a[0:3], a[184:187], a[96:99], a[0:3]
M a[0:3], a[188:191], a[100:103], a[0:3]
ds_read_b128 a[168:171], v10 offset:2048
ds_read_b128 a[172:175], v11 offset:2048
M a[4:7], a[188:191], a[108:111], a[4:7]
M a[4:7], a[184:187], a[104:107], a[4:7]
M a[8:11], a[184:187], a[112:115], a[8:11]
buffer_load_dwordx4 v4, s[8:11], s3 offen offset:2048 lds
M a[8:11], a[188:191], a[116:119], a[8:11]
M a[12:15], a[188:191], a[124:127], a[12:15]
M a[12:15], a[184:187], a[120:123], a[12:15]
M a[16:19], a[184:187], a[128:131], a[16:19]
M a[16:19], a[188:191], a[132:135], a[16:19]
buffer_load_dwordx4 v5, s[8:11], s3 offen offset:3072 lds
M a[20:23], a[188:191], a[140:143], a[20:23]
M a[20:23], a[184:187], a[136:139], a[20:23]
M a[24:27], a[184:187], a[144:147], a[24:27]
M a[24:27], a[188:191], a[148:151], a[24:27]
M a[28:31], a[188:191], a[156:159], a[28:31]
M a[28:31], a[184:187], a[152:155], a[28:31]
s_waitcnt lgkmcnt(2)
M v[32:35], a[160:163], a[32:35], v[32:35]
s_add_u32 s23, s23, 128
s_cmp_eq_u32 s23, s25
s_cselect_b32 s23, s26, s23
M v[32:35], a[164:167], a[36:39], v[32:35]
ds_read_b128 a[176:179], v10 offset:4096
ds_read_b128 a[180:183], v11 offset:4096
M v[36:39], a[164:167], a[44:47], v[36:39]
M v[36:39], a[160:163], a[40:43], v[36:39]
ds_read_b64_tr_b16 a[96:97], v12 offset:32768
ds_read_b64_tr_b16 a[98:99], v12 offset:34816
M v[40:43], a[160:163], a[48:51], v[40:43]
M v[40:43], a[164:167], a[52:55], v[40:43]
M v[44:47], a[164:167], a[60:63], v[44:47]
s_add_u32 m0, s29, 81920
s_nop 0
buffer_load_dwordx4 v6, s[12:15], s24 offen offset:0 lds
M v[44:47], a[160:163], a[56:59], v[44:47]
ds_read_b64_tr_b16 a[104:105], v13 offset:32768
ds_read_b64_tr_b16 a[106:107], v13 offset:34816
M v[48:51], a[160:163], a[64:67], v[48:51]
s_add_u32 s94, s93, 0
buffer_store_dwordx4 a[208:211], v1, s[16:19], s94 offen offset:0 sc1
M v[48:51], a[164:167], a[68:71], v[48:51]
M v[52:55], a[164:167], a[76:79], v[52:55]
M v[52:55], a[160:163], a[72:75], v[52:55]
ds_read_b64_tr_b16 a[112:113], v14 offset:32768
ds_read_b64_tr_b16 a[114:115], v14 offset:34816
M v[56:59], a[160:163], a[80:83], v[56:59]
M v[56:59], a[164:167], a[84:87], v[56:59]
buffer_load_dwordx4 v7, s[12:15], s24 offen offset:1024 lds
M v[60:63], a[164:167], a[92:95], v[60:63]
M v[60:63], a[160:163], a[88:91], v[60:63]
s_waitcnt lgkmcnt(8)
ds_read_b64_tr_b16 a[120:121], v15 offset:32768
ds_read_b64_tr_b16 a[122:123], v15 offset:34816
M v[64:67], a[168:171], a[32:35], v[64:67]
M v[64:67], a[172:175], a[36:39], v[64:67]
ds_read_b128 a[184:187], v10 offset:6144
ds_read_b128 a[188:191], v11 offset:6144
M v[68:71], a[172:175], a[44:47], v[68:71]
M v[68:71], a[168:171], a[40:43], v[68:71]
ds_read_b64_tr_b16 a[128:129], v16 offset:32768
ds_read_b64_tr_b16 a[130:131], v16 offset:34816
M v[72:75], a[168:171], a[48:51], v[72:75]
buffer_load_dwordx4 v8, s[12:15], s24 offen offset:2048 lds
M v[72:75], a[172:175], a[52:55], v[72:75]
M v[76:79], a[172:175], a[60:63], v[76:79]
M v[76:79], a[168:171], a[56:59], v[76:79]
ds_read_b64_tr_b16 a[136:137], v17 offset:32768
ds_read_b64_tr_b16 a[138:139], v17 offset:34816
M v[80:83], a[168:171], a[64:67], v[80:83]
M v[80:83], a[172:175], a[68:71], v[80:83]
buffer_load_dwordx4 v9, s[12:15], s24 offen offset:3072 lds
M v[84:87], a[172:175], a[76:79], v[84:87]
M v[84:87], a[168:171], a[72:75], v[84:87]
ds_read_b64_tr_b16 a[144:145], v18 offset:32768
ds_read_b64_tr_b16 a[146:147], v18 offset:34816
M v[88:91], a[168:171], a[80:83], v[88:91]
M v[88:91], a[172:175], a[84:87], v[88:91]
M v[92:95], a[172:175], a[92:95], v[92:95]
s_add_u32 s24, s24, 262144
s_cmp_eq_u32 s24, s27
s_cselect_b32 s24, s28, s24
s_sub_u32 s6, s6, 1
s_cmp_eq_u32 s6, 0
s_cselect_b64 s[12:13], s[64:65], s[12:13]
M v[92:95], a[168:171], a[88:91], v[92:95]
s_waitcnt lgkmcnt(15)
ds_read_b64_tr_b16 a[152:153], v19 offset:32768
ds_read_b64_tr_b16 a[154:155], v19 offset:34816
M v[96:99], a[176:179], a[32:35], v[96:99]
M v[96:99], a[180:183], a[36:39], v[96:99]
M v[100:103], a[180:183], a[44:47], v[100:103]
M v[100:103], a[176:179], a[40:43], v[100:103]
M v[104:107], a[176:179], a[48:51], v[104:107]
s_add_u32 s94, s93, 0
buffer_store_dwordx4 a[212:215], v1, s[16:19], s94 offen offset:1024 sc1
M v[104:107], a[180:183], a[52:55], v[104:107]
M v[108:111], a[180:183], a[60:63], v[108:111]
M v[108:111], a[176:179], a[56:59], v[108:111]
s_waitcnt vmcnt(21) lgkmcnt(0)
s_barrier
ds_read_b128 a[160:163], v10 offset:16384
ds_read_b128 a[164:167], v11 offset:16384
M v[112:115], a[176:179], a[64:67], v[112:115]
s_add_u32 m0, s29, 0
s_nop 0
buffer_load_dwordx4 v2, s[8:11], s23 offen offset:0 lds
M v[112:115], a[180:183], a[68:71], v[112:115]
M v[116:119], a[180:183], a[76:79], v[116:119]
M v[116:119], a[176:179], a[72:75], v[116:119]
ds_read_b64_tr_b16 a[100:101], v12 offset:49152
ds_read_b64_tr_b16 a[102:103], v12 offset:51200
M v[120:123], a[176:179], a[80:83], v[120:123]
M v[120:123], a[180:183], a[84:87], v[120:123]
M v[124:127], a[180:183], a[92:95], v[124:127]
buffer_load_dwordx4 v3, s[8:11], s23 offen offset:1024 lds
M v[124:127], a[176:179], a[88:91], v[124:127]
M v[128:131], a[184:187], a[32:35], v[128:131]
M v[128:131], a[188:191], a[36:39], v[128:131]
ds_read_b128 a[168:171], v10 offset:18432
ds_read_b128 a[172:175], v11 offset:18432
ds_read_b64_tr_b16 a[108:109], v13 offset:49152
ds_read_b64_tr_b16 a[110:111], v13 offset:51200
M v[132:135], a[188:191], a[44:47], v[132:135]
M v[132:135], a[184:187], a[40:43], v[132:135]
M v[136:139], a[184:187], a[48:51], v[136:139]
M v[136:139], a[188:191], a[52:55], v[136:139]
buffer_load_dwordx4 v4, s[8:11], s23 offen offset:2048 lds
M v[140:143], a[188:191], a[60:63], v[140:143]
M v[140:143], a[184:187], a[56:59], v[140:143]
ds_read_b64_tr_b16 a[116:117], v14 offset:49152
ds_read_b64_tr_b16 a[118:119], v14 offset:51200
M v[144:147], a[184:187], a[64:67], v[144:147]
M v[144:147], a[188:191], a[68:71], v[144:147]
M v[148:151], a[188:191], a[76:79], v[148:151]
M v[148:151], a[184:187], a[72:75], v[148:151]
buffer_load_dwordx4 v5, s[8:11], s23 offen offset:3072 lds
M v[152:155], a[184:187], a[80:83], v[152:155]
M v[152:155], a[188:191], a[84:87], v[152:155]
ds_read_b64_tr_b16 a[124:125], v15 offset:49152
ds_read_b64_tr_b16 a[126:127], v15 offset:51200
M v[156:159], a[188:191], a[92:95], v[156:159]
M v[156:159], a[184:187], a[88:91], v[156:159]
s_waitcnt lgkmcnt(10)
M v[160:163], a[160:163], a[32:35], v[160:163]
s_add_u32 s94, s93, 0
buffer_store_dwordx4 a[216:219], v1, s[16:19], s94 offen offset:2048 sc1
M v[160:163], a[164:167], a[36:39], v[160:163]
ds_read_b128 a[176:179], v10 offset:20480
ds_read_b128 a[180:183], v11 offset:20480
M v[164:167], a[164:167], a[44:47], v[164:167]
M v[164:167], a[160:163], a[40:43], v[164:167]
ds_read_b64_tr_b16 a[132:133], v16 offset:49152
ds_read_b64_tr_b16 a[134:135], v16 offset:51200
M v[168:171], a[160:163], a[48:51], v[168:171]
M v[168:171], a[164:167], a[52:55], v[168:171]
s_add_u32 m0, s29, 98304
s_nop 0
buffer_load_dwordx4 v6, s[12:15], s24 offen offset:0 lds
M v[172:175], a[164:167], a[60:63], v[172:175]
M v[172:175], a[160:163], a[56:59], v[172:175]
M v[176:179], a[160:163], a[64:67], v[176:179]
M v[176:179], a[164:167], a[68:71], v[176:179]
ds_read_b64_tr_b16 a[140:141], v17 offset:49152
ds_read_b64_tr_b16 a[142:143], v17 offset:51200
M v[180:183], a[164:167], a[76:79], v[180:183]
M v[180:183], a[160:163], a[72:75], v[180:183]
buffer_load_dwordx4 v7, s[12:15], s24 offen offset:1024 lds
M v[184:187], a[160:163], a[80:83], v[184:187]
M v[184:187], a[164:167], a[84:87], v[184:187]
M v[188:191], a[164:167], a[92:95], v[188:191]
M v[188:191], a[160:163], a[88:91], v[188:191]
s_waitcnt lgkmcnt(12)
ds_read_b64_tr_b16 a[148:149], v18 offset:49152
ds_read_b64_tr_b16 a[150:151], v18 offset:51200
M v[192:195], a[168:171], a[32:35], v[192:195]
M v[192:195], a[172:175], a[36:39], v[192:195]
ds_read_b128 a[184:187], v10 offset:22528
ds_read_b128 a[188:191], v11 offset:22528
M v[196:199], a[172:175], a[44:47], v[196:199]
buffer_load_dwordx4 v8, s[12:15], s24 offen offset:2048 lds
M v[196:199], a[168:171], a[40:43], v[196:199]
M v[200:203], a[168:171], a[48:51], v[200:203]
M v[200:203], a[172:175], a[52:55], v[200:203]
ds_read_b64_tr_b16 a[156:157], v19 offset:49152
ds_read_b64_tr_b16 a[158:159], v19 offset:51200
M v[204:207], a[172:175], a[60:63], v[204:207]
M v[204:207], a[168:171], a[56:59], v[204:207]
M v[208:211], a[168:171], a[64:67], v[208:211]
buffer_load_dwordx4 v9, s[12:15], s24 offen offset:3072 lds
M v[208:211], a[172:175], a[68:71], v[208:211]
M v[212:215], a[172:175], a[76:79], v[212:215]
M v[212:215], a[168:171], a[72:75], v[212:215]
M v[216:219], a[168:171], a[80:83], v[216:219]
s_add_u32 s94, s93, 0
buffer_store_dwordx4 a[220:223], v1, s[16:19], s94 offen offset:3072 sc1
M v[216:219], a[172:175], a[84:87], v[216:219]
M v[220:223], a[172:175], a[92:95], v[220:223]
s_add_u32 s24, s24, 262144
M v[220:223], a[168:171], a[88:91], v[220:223]
s_waitcnt lgkmcnt(10)
M v[224:227], a[176:179], a[32:35], v[224:227]
M v[224:227], a[180:183], a[36:39], v[224:227]
M v[228:231], a[180:183], a[44:47], v[228:231]
M v[228:231], a[176:179], a[40:43], v[228:231]
M v[232:235], a[176:179], a[48:51], v[232:235]
M v[232:235], a[180:183], a[52:55], v[232:235]
M v[236:239], a[180:183], a[60:63], v[236:239]
M v[236:239], a[176:179], a[56:59], v[236:239]
s_waitcnt vmcnt(21) lgkmcnt(0)
s_barrier
ds_read_b128 a[160:163], v10 offset:32768
ds_read_b128 a[164:167], v11 offset:32768
M v[240:243], a[176:179], a[64:67], v[240:243]
s_add_u32 m0, s29, 16384
s_add_u32 s3, s23, s31
buffer_load_dwordx4 v2, s[8:11], s3 offen offset:0 lds
M v[240:243], a[180:183], a[68:71], v[240:243]
M v[244:247], a[180:183], a[76:79], v[244:247]
M v[244:247], a[176:179], a[72:75], v[244:247]
M v[248:251], a[176:179], a[80:83], v[248:251]
M v[248:251], a[180:183], a[84:87], v[248:251]
buffer_load_dwordx4 v3, s[8:11], s3 offen offset:1024 lds
M v[252:255], a[180:183], a[92:95], v[252:255]
M v[252:255], a[176:179], a[88:91], v[252:255]
M a[0:3], a[184:187], a[32:35], a[0:3]
M a[0:3], a[188:191], a[36:39], a[0:3]
ds_read_b128 a[168:171], v10 offset:34816
ds_read_b128 a[172:175], v11 offset:34816
M a[4:7], a[188:191], a[44:47], a[4:7]
M a[4:7], a[184:187], a[40:43], a[4:7]
M a[8:11], a[184:187], a[48:51], a[8:11]
buffer_load_dwordx4 v4, s[8:11], s3 offen offset:2048 lds
M a[8:11], a[188:191], a[52:55], a[8:11]
M a[12:15], a[188:191], a[60:63], a[12:15]
M a[12:15], a[184:187], a[56:59], a[12:15]
M a[16:19], a[184:187], a[64:67], a[16:19]
M a[16:19], a[188:191], a[68:71], a[16:19]
buffer_load_dwordx4 v5, s[8:11], s3 offen offset:3072 lds
M a[20:23], a[188:191], a[76:79], a[20:23]
M a[20:23], a[184:187], a[72:75], a[20:23]
M a[24:27], a[184:187], a[80:83], a[24:27]
M a[24:27], a[188:191], a[84:87], a[24:27]
M a[28:31], a[188:191], a[92:95], a[28:31]
M a[28:31], a[184:187], a[88:91], a[28:31]
s_waitcnt lgkmcnt(2)
M v[32:35], a[160:163], a[96:99], v[32:35]
s_add_u32 s23, s23, 128
s_cmp_eq_u32 s23, s25
s_cselect_b32 s23, s26, s23
M v[32:35], a[164:167], a[100:103], v[32:35]
ds_read_b128 a[176:179], v10 offset:36864
ds_read_b128 a[180:183], v11 offset:36864
M v[36:39], a[164:167], a[108:111], v[36:39]
M v[36:39], a[160:163], a[104:107], v[36:39]
ds_read_b64_tr_b16 a[32:33], v12 offset:0
ds_read_b64_tr_b16 a[34:35], v12 offset:2048
M v[40:43], a[160:163], a[112:115], v[40:43]
M v[40:43], a[164:167], a[116:119], v[40:43]
M v[44:47], a[164:167], a[124:127], v[44:47]
s_add_u32 m0, s29, 114688
s_nop 0
buffer_load_dwordx4 v6, s[12:15], s24 offen offset:0 lds
M v[44:47], a[160:163], a[120:123], v[44:47]
ds_read_b64_tr_b16 a[40:41], v13 offset:0
ds_read_b64_tr_b16 a[42:43], v13 offset:2048
M v[48:51], a[160:163], a[128:131], v[48:51]
s_add_u32 s94, s93, 4096
buffer_store_dwordx4 a[224:227], v1, s[16:19], s94 offen offset:0 sc1
M v[48:51], a[164:167], a[132:135], v[48:51]
M v[52:55], a[164:167], a[140:143], v[52:55]
M v[52:55], a[160:163], a[136:139], v[52:55]
ds_read_b64_tr_b16 a[48:49], v14 offset:0
ds_read_b64_tr_b16 a[50:51], v14 offset:2048
M v[56:59], a[160:163], a[144:147], v[56:59]
M v[56:59], a[164:167], a[148:151], v[56:59]
buffer_load_dwordx4 v7, s[12:15], s24 offen offset:1024 lds
M v[60:63], a[164:167], a[156:159], v[60:63]
M v[60:63], a[160:163], a[152:155], v[60:63]
s_waitcnt lgkmcnt(8)
ds_read_b64_tr_b16 a[56:57], v15 offset:0
ds_read_b64_tr_b16 a[58:59], v15 offset:2048
M v[64:67], a[168:171], a[96:99], v[64:67]
M v[64:67], a[172:175], a[100:103], v[64:67]
ds_read_b128 a[184:187], v10 offset:38912
ds_read_b128 a[188:191], v11 offset:38912
M v[68:71], a[172:175], a[108:111], v[68:71]
M v[68:71], a[168:171], a[104:107], v[68:71]
ds_read_b64_tr_b16 a[64:65], v16 offset:0
ds_read_b64_tr_b16 a[66:67], v16 offset:2048
M v[72:75], a[168:171], a[112:115], v[72:75]
buffer_load_dwordx4 v8, s[12:15], s24 offen offset:2048 lds
M v[72:75], a[172:175], a[116:119], v[72:75]
M v[76:79], a[172:175], a[124:127], v[76:79]
M v[76:79], a[168:171], a[120:123], v[76:79]
ds_read_b64_tr_b16 a[72:73], v17 offset:0
ds_read_b64_tr_b16 a[74:75], v17 offset:2048
M v[80:83], a[168:171], a[128:131], v[80:83]
M v[80:83], a[172:175], a[132:135], v[80:83]
buffer_load_dwordx4 v9, s[12:15], s24 offen offset:3072 lds
M v[84:87], a[172:175], a[140:143], v[84:87]
M v[84:87], a[168:171], a[136:139], v[84:87]
ds_read_b64_tr_b16 a[80:81], v18 offset:0
ds_read_b64_tr_b16 a[82:83], v18 offset:2048
M v[88:91], a[168:171], a[144:147], v[88:91]
M v[88:91], a[172:175], a[148:151], v[88:91]
M v[92:95], a[172:175], a[156:159], v[92:95]
s_add_u32 s24, s24, 262144
s_cmp_eq_u32 s24, s27
s_cselect_b32 s24, s28, s24
s_sub_u32 s6, s6, 1
s_cmp_eq_u32 s6, 0
s_cselect_b64 s[12:13], s[64:65], s[12:13]
M v[92:95], a[168:171], a[152:155], v[92:95]
s_waitcnt lgkmcnt(15)
ds_read_b64_tr_b16 a[88:89], v19 offset:0
ds_read_b64_tr_b16 a[90:91], v19 offset:2048
M v[96:99], a[176:179], a[96:99], v[96:99]
M v[96:99], a[180:183], a[100:103], v[96:99]
M v[100:103], a[180:183], a[108:111], v[100:103]
M v[100:103], a[176:179], a[104:107], v[100:103]
M v[104:107], a[176:179], a[112:115], v[104:107]
s_add_u32 s94, s93, 4096
buffer_store_dwordx4 a[228:231], v1, s[16:19], s94 offen offset:1024 sc1
M v[104:107], a[180:183], a[116:119], v[104:107]
M v[108:111], a[180:183], a[124:127], v[108:111]
M v[108:111], a[176:179], a[120:123], v[108:111]
s_waitcnt vmcnt(21) lgkmcnt(0)
s_barrier
ds_read_b128 a[160:163], v10 offset:49152
ds_read_b128 a[164:167], v11 offset:49152
M v[112:115], a[176:179], a[128:131], v[112:115]
s_add_u32 m0, s29, 32768
s_nop 0
buffer_load_dwordx4 v2, s[8:11], s23 offen offset:0 lds
M v[112:115], a[180:183], a[132:135], v[112:115]
M v[116:119], a[180:183], a[140:143], v[116:119]
M v[116:119], a[176:179], a[136:139], v[116:119]
ds_read_b64_tr_b16 a[36:37], v12 offset:16384
ds_read_b64_tr_b16 a[38:39], v12 offset:18432
M v[120:123], a[176:179], a[144:147], v[120:123]
M v[120:123], a[180:183], a[148:151], v[120:123]
M v[124:127], a[180:183], a[156:159], v[124:127]
buffer_load_dwordx4 v3, s[8:11], s23 offen offset:1024 lds
M v[124:127], a[176:179], a[152:155], v[124:127]
M v[128:131], a[184:187], a[96:99], v[128:131]
M v[128:131], a[188:191], a[100:103], v[128:131]
ds_read_b128 a[168:171], v10 offset:51200
ds_read_b128 a[172:175], v11 offset:51200
ds_read_b64_tr_b16 a[44:45], v13 offset:16384
ds_read_b64_tr_b16 a[46:47], v13 offset:18432
M v[132:135], a[188:191], a[108:111], v[132:135]
M v[132:135], a[184:187], a[104:107], v[132:135]
M v[136:139], a[184:187], a[112:115], v[136:139]
M v[136:139], a[188:191], a[116:119], v[136:139]
buffer_load_dwordx4 v4, s[8:11], s23 offen offset:2048 lds
M v[140:143], a[188:191], a[124:127], v[140:143]
M v[140:143], a[184:187], a[120:123], v[140:143]
ds_read_b64_tr_b16 a[52:53], v14 offset:16384
ds_read_b64_tr_b16 a[54:55], v14 offset:18432
M v[144:147], a[184:187], a[128:131], v[144:147]
M v[144:147], a[188:191], a[132:135], v[144:147]
M v[148:151], a[188:191], a[140:143], v[148:151]
M v[148:151], a[184:187], a[136:139], v[148:151]
buffer_load_dwordx4 v5, s[8:11], s23 offen offset:3072 lds
M v[152:155], a[184:187], a[144:147], v[152:155]
M v[152:155], a[188:191], a[148:151], v[152:155]
ds_read_b64_tr_b16 a[60:61], v15 offset:16384
ds_read_b64_tr_b16 a[62:63], v15 offset:18432
M v[156:159], a[188:191], a[156:159], v[156:159]
M v[156:159], a[184:187], a[152:155], v[156:159]
s_waitcnt lgkmcnt(10)
M v[160:163], a[160:163], a[96:99], v[160:163]
s_add_u32 s94, s93, 4096
buffer_store_dwordx4 a[232:235], v1, s[16:19], s94 offen offset:2048 sc1
M v[160:163], a[164:167], a[100:103], v[160:163]
ds_read_b128 a[176:179], v10 offset:53248
ds_read_b128 a[180:183], v11 offset:53248
M v[164:167], a[164:167], a[108:111], v[164:167]
M v[164:167], a[160:163], a[104:107], v[164:167]
ds_read_b64_tr_b16 a[68:69], v16 offset:16384
ds_read_b64_tr_b16 a[70:71], v16 offset:18432
M v[168:171], a[160:163], a[112:115], v[168:171]
M v[168:171], a[164:167], a[116:119], v[168:171]
s_add_u32 m0, s29, 65536
s_nop 0
buffer_load_dwordx4 v6, s[12:15], s24 offen offset:0 lds
M v[172:175], a[164:167], a[124:127], v[172:175]
M v[172:175], a[160:163], a[120:123], v[172:175]
M v[176:179], a[160:163], a[128:131], v[176:179]
M v[176:179], a[164:167], a[132:135], v[176:179]
ds_read_b64_tr_b16 a[76:77], v17 offset:16384
ds_read_b64_tr_b16 a[78:79], v17 offset:18432
M v[180:183], a[164:167], a[140:143], v[180:183]
M v[180:183], a[160:163], a[136:139], v[180:183]
buffer_load_dwordx4 v7, s[12:15], s24 offen offset:1024 lds
M v[184:187], a[160:163], a[144:147], v[184:187]
M v[184:187], a[164:167], a[148:151], v[184:187]
M v[188:191], a[164:167], a[156:159], v[188:191]
M v[188:191], a[160:163], a[152:155], v[188:191]
s_waitcnt lgkmcnt(12)
ds_read_b64_tr_b16 a[84:85], v18 offset:16384
ds_read_b64_tr_b16 a[86:87], v18 offset:18432
M v[192:195], a[168:171], a[96:99], v[192:195]
M v[192:195], a[172:175], a[100:103], v[192:195]
ds_read_b128 a[184:187], v10 offset:55296
ds_read_b128 a[188:191], v11 offset:55296
M v[196:199], a[172:175], a[108:111], v[196:199]
buffer_load_dwordx4 v8, s[12:15], s24 offen offset:2048 lds
M v[196:199], a[168:171], a[104:107], v[196:199]
M v[200:203], a[168:171], a[112:115], v[200:203]
M v[200:203], a[172:175], a[116:119], v[200:203]
ds_read_b64_tr_b16 a[92:93], v19 offset:16384
ds_read_b64_tr_b16 a[94:95], v19 offset:18432
M v[204:207], a[172:175], a[124:127], v[204:207]
M v[204:207], a[168:171], a[120:123], v[204:207]
M v[208:211], a[168:171], a[128:131], v[208:211]
buffer_load_dwordx4 v9, s[12:15], s24 offen offset:3072 lds
M v[208:211], a[172:175], a[132:135], v[208:211]
M v[212:215], a[172:175], a[140:143], v[212:215]
M v[212:215], a[168:171], a[136:139], v[212:215]
M v[216:219], a[168:171], a[144:147], v[216:219]
s_add_u32 s94, s93, 4096
buffer_store_dwordx4 a[236:239], v1, s[16:19], s94 offen offset:3072 sc1
M v[216:219], a[172:175], a[148:151], v[216:219]
M v[220:223], a[172:175], a[156:159], v[220:223]
s_add_u32 s24, s24, 262144
M v[220:223], a[168:171], a[152:155], v[220:223]
s_waitcnt lgkmcnt(10)
M v[224:227], a[176:179], a[96:99], v[224:227]
M v[224:227], a[180:183], a[100:103], v[224:227]
M v[228:231], a[180:183], a[108:111], v[228:231]
M v[228:231], a[176:179], a[104:107], v[228:231]
M v[232:235], a[176:179], a[112:115], v[232:235]
M v[232:235], a[180:183], a[116:119], v[232:235]
M v[236:239], a[180:183], a[124:127], v[236:239]
M v[236:239], a[176:179], a[120:123], v[236:239]
s_waitcnt vmcnt(21) lgkmcnt(0)
s_barrier
ds_read_b128 a[160:163], v10 offset:0
ds_read_b128 a[164:167], v11 offset:0
M v[240:243], a[176:179], a[128:131], v[240:243]
s_add_u32 m0, s29, 49152
s_add_u32 s3, s23, s31
buffer_load_dwordx4 v2, s[8:11], s3 offen offset:0 lds
M v[240:243], a[180:183], a[132:135], v[240:243]
M v[244:247], a[180:183], a[140:143], v[244:247]
M v[244:247], a[176:179], a[136:139], v[244:247]
M v[248:251], a[176:179], a[144:147], v[248:251]
M v[248:251], a[180:183], a[148:151], v[248:251]
buffer_load_dwordx4 v3, s[8:11], s3 offen offset:1024 lds
M v[252:255], a[180:183], a[156:159], v[252:255]
M v[252:255], a[176:179], a[152:155], v[252:255]
M a[0:3], a[184:187], a[96:99], a[0:3]
M a[0:3], a[188:191], a[100:103], a[0:3]
ds_read_b128 a[168:171], v10 offset:2048
ds_read_b128 a[172:175], v11 offset:2048
M a[4:7], a[188:191], a[108:111], a[4:7]
M a[4:7], a[184:187], a[104:107], a[4:7]
M a[8:11], a[184:187], a[112:115], a[8:11]
buffer_load_dwordx4 v4, s[8:11], s3 offen offset:2048 lds
M a[8:11], a[188:191], a[116:119], a[8:11]
M a[12:15], a[188:191], a[124:127], a[12:15]
M a[12:15], a[184:187], a[120:123], a[12:15]
M a[16:19], a[184:187], a[128:131], a[16:19]
M a[16:19], a[188:191], a[132:135], a[16:19]
buffer_load_dwordx4 v5, s[8:11], s3 offen offset:3072 lds
M a[20:23], a[188:191], a[140:143], a[20:23]
M a[20:23], a[184:187], a[136:139], a[20:23]
M a[24:27], a[184:187], a[144:147], a[24:27]
M a[24:27], a[188:191], a[148:151], a[24:27]
M a[28:31], a[188:191], a[156:159], a[28:31]
M a[28:31], a[184:187], a[152:155], a[28:31]
s_waitcnt lgkmcnt(2)
M v[32:35], a[160:163], a[32:35], v[32:35]
s_add_u32 s23, s23, 128
s_cmp_eq_u32 s23, s25
s_cselect_b32 s23, s26, s23
M v[32:35], a[164:167], a[36:39], v[32:35]
ds_read_b128 a[176:179], v10 offset:4096
ds_read_b128 a[180:183], v11 offset:4096
M v[36:39], a[164:167], a[44:47], v[36:39]
M v[36:39], a[160:163], a[40:43], v[36:39]
ds_read_b64_tr_b16 a[96:97], v12 offset:32768
ds_read_b64_tr_b16 a[98:99], v12 offset:34816
M v[40:43], a[160:163], a[48:51], v[40:43]
M v[40:43], a[164:167], a[52:55], v[40:43]
M v[44:47], a[164:167], a[60:63], v[44:47]
s_add_u32 m0, s29, 81920
s_nop 0
buffer_load_dwordx4 v6, s[12:15], s24 offen offset:0 lds
M v[44:47], a[160:163], a[56:59], v[44:47]
ds_read_b64_tr_b16 a[104:105], v13 offset:32768
ds_read_b64_tr_b16 a[106:107], v13 offset:34816
M v[48:51], a[160:163], a[64:67], v[48:51]
s_add_u32 s94, s93, 8192
buffer_store_dwordx4 a[240:243], v1, s[16:19], s94 offen offset:0 sc1
M v[48:51], a[164:167], a[68:71], v[48:51]
M v[52:55], a[164:167], a[76:79], v[52:55]
M v[52:55], a[160:163], a[72:75], v[52:55]
ds_read_b64_tr_b16 a[112:113], v14 offset:32768
ds_read_b64_tr_b16 a[114:115], v14 offset:34816
M v[56:59], a[160:163], a[80:83], v[56:59]
M v[56:59], a[164:167], a[84:87], v[56:59]
buffer_load_dwordx4 v7, s[12:15], s24 offen offset:1024 lds
M v[60:63], a[164:167], a[92:95], v[60:63]
M v[60:63], a[160:163], a[88:91], v[60:63]
s_waitcnt lgkmcnt(8)
ds_read_b64_tr_b16 a[120:121], v15 offset:32768
ds_read_b64_tr_b16 a[122:123], v15 offset:34816
M v[64:67], a[168:171], a[32:35], v[64:67]
M v[64:67], a[172:175], a[36:39], v[64:67]
ds_read_b128 a[184:187], v10 offset:6144
ds_read_b128 a[188:191], v11 offset:6144
M v[68:71], a[172:175], a[44:47], v[68:71]
M v[68:71], a[168:171], a[40:43], v[68:71]
ds_read_b64_tr_b16 a[128:129], v16 offset:32768
ds_read_b64_tr_b16 a[130:131], v16 offset:34816
M v[72:75], a[168:171], a[48:51], v[72:75]
buffer_load_dwordx4 v8, s[12:15], s24 offen offset:2048 lds
M v[72:75], a[172:175], a[52:55], v[72:75]
M v[76:79], a[172:175], a[60:63], v[76:79]
M v[76:79], a[168:171], a[56:59], v[76:79]
ds_read_b64_tr_b16 a[136:137], v17 offset:32768
ds_read_b64_tr_b16 a[138:139], v17 offset:34816
M v[80:83], a[168:171], a[64:67], v[80:83]
M v[80:83], a[172:175], a[68:71], v[80:83]
buffer_load_dwordx4 v9, s[12:15], s24 offen offset:3072 lds
M v[84:87], a[172:175], a[76:79], v[84:87]
M v[84:87], a[168:171], a[72:75], v[84:87]
ds_read_b64_tr_b16 a[144:145], v18 offset:32768
ds_read_b64_tr_b16 a[146:147], v18 offset:34816
M v[88:91], a[168:171], a[80:83], v[88:91]
M v[88:91], a[172:175], a[84:87], v[88:91]
M v[92:95], a[172:175], a[92:95], v[92:95]
s_add_u32 s24, s24, 262144
s_cmp_eq_u32 s24, s27
s_cselect_b32 s24, s28, s24
s_sub_u32 s6, s6, 1
s_cmp_eq_u32 s6, 0
s_cselect_b64 s[12:13], s[64:65], s[12:13]
M v[92:95], a[168:171], a[88:91], v[92:95]
s_waitcnt lgkmcnt(15)
ds_read_b64_tr_b16 a[152:153], v19 offset:32768
ds_read_b64_tr_b16 a[154:155], v19 offset:34816
M v[96:99], a[176:179], a[32:35], v[96:99]
M v[96:99], a[180:183], a[36:39], v[96:99]
M v[100:103], a[180:183], a[44:47], v[100:103]
M v[100:103], a[176:179], a[40:43], v[100:103]
M v[104:107], a[176:179], a[48:51], v[104:107]
s_add_u32 s94, s93, 8192
buffer_store_dwordx4 a[244:247], v1, s[16:19], s94 offen offset:1024 sc1
M v[104:107], a[180:183], a[52:55], v[104:107]
M v[108:111], a[180:183], a[60:63], v[108:111]
M v[108:111], a[176:179], a[56:59], v[108:111]
s_waitcnt vmcnt(21) lgkmcnt(0)
s_barrier
ds_read_b128 a[160:163], v10 offset:16384
ds_read_b128 a[164:167], v11 offset:16384
M v[112:115], a[176:179], a[64:67], v[112:115]
s_add_u32 m0, s29, 0
s_nop 0
buffer_load_dwordx4 v2, s[8:11], s23 offen offset:0 lds
M v[112:115], a[180:183], a[68:71], v[112:115]
M v[116:119], a[180:183], a[76:79], v[116:119]
M v[116:119], a[176:179], a[72:75], v[116:119]
ds_read_b64_tr_b16 a[100:101], v12 offset:49152
ds_read_b64_tr_b16 a[102:103], v12 offset:51200
M v[120:123], a[176:179], a[80:83], v[120:123]
M v[120:123], a[180:183], a[84:87], v[120:123]
M v[124:127], a[180:183], a[92:95], v[124:127]
buffer_load_dwordx4 v3, s[8:11], s23 offen offset:1024 lds
M v[124:127], a[176:179], a[88:91], v[124:127]
M v[128:131], a[184:187], a[32:35], v[128:131]
M v[128:131], a[188:191], a[36:39], v[128:131]
ds_read_b128 a[168:171], v10 offset:18432
ds_read_b128 a[172:175], v11 offset:18432
ds_read_b64_tr_b16 a[108:109], v13 offset:49152
ds_read_b64_tr_b16 a[110:111], v13 offset:51200
M v[132:135], a[188:191], a[44:47], v[132:135]
M v[132:135], a[184:187], a[40:43], v[132:135]
M v[136:139], a[184:187], a[48:51], v[136:139]
M v[136:139], a[188:191], a[52:55], v[136:139]
buffer_load_dwordx4 v4, s[8:11], s23 offen offset:2048 lds
M v[140:143], a[188:191], a[60:63], v[140:143]
M v[140:143], a[184:187], a[56:59], v[140:143]
ds_read_b64_tr_b16 a[116:117], v14 offset:49152
ds_read_b64_tr_b16 a[118:119], v14 offset:51200
M v[144:147], a[184:187], a[64:67], v[144:147]
M v[144:147], a[188:191], a[68:71], v[144:147]
M v[148:151], a[188:191], a[76:79], v[148:151]
M v[148:151], a[184:187], a[72:75], v[148:151]
buffer_load_dwordx4 v5, s[8:11], s23 offen offset:3072 lds
M v[152:155], a[184:187], a[80:83], v[152:155]
M v[152:155], a[188:191], a[84:87], v[152:155]
ds_read_b64_tr_b16 a[124:125], v15 offset:49152
ds_read_b64_tr_b16 a[126:127], v15 offset:51200
M v[156:159], a[188:191], a[92:95], v[156:159]
M v[156:159], a[184:187], a[88:91], v[156:159]
s_waitcnt lgkmcnt(10)
M v[160:163], a[160:163], a[32:35], v[160:163]
s_add_u32 s94, s93, 8192
buffer_store_dwordx4 a[248:251], v1, s[16:19], s94 offen offset:2048 sc1
M v[160:163], a[164:167], a[36:39], v[160:163]
ds_read_b128 a[176:179], v10 offset:20480
ds_read_b128 a[180:183], v11 offset:20480
M v[164:167], a[164:167], a[44:47], v[164:167]
M v[164:167], a[160:163], a[40:43], v[164:167]
ds_read_b64_tr_b16 a[132:133], v16 offset:49152
ds_read_b64_tr_b16 a[134:135], v16 offset:51200
M v[168:171], a[160:163], a[48:51], v[168:171]
M v[168:171], a[164:167], a[52:55], v[168:171]
s_add_u32 m0, s29, 98304
s_nop 0
buffer_load_dwordx4 v6, s[12:15], s24 offen offset:0 lds
M v[172:175], a[164:167], a[60:63], v[172:175]
M v[172:175], a[160:163], a[56:59], v[172:175]
M v[176:179], a[160:163], a[64:67], v[176:179]
M v[176:179], a[164:167], a[68:71], v[176:179]
ds_read_b64_tr_b16 a[140:141], v17 offset:49152
ds_read_b64_tr_b16 a[142:143], v17 offset:51200
M v[180:183], a[164:167], a[76:79], v[180:183]
M v[180:183], a[160:163], a[72:75], v[180:183]
buffer_load_dwordx4 v7, s[12:15], s24 offen offset:1024 lds
M v[184:187], a[160:163], a[80:83], v[184:187]
M v[184:187], a[164:167], a[84:87], v[184:187]
M v[188:191], a[164:167], a[92:95], v[188:191]
M v[188:191], a[160:163], a[88:91], v[188:191]
s_waitcnt lgkmcnt(12)
ds_read_b64_tr_b16 a[148:149], v18 offset:49152
ds_read_b64_tr_b16 a[150:151], v18 offset:51200
M v[192:195], a[168:171], a[32:35], v[192:195]
M v[192:195], a[172:175], a[36:39], v[192:195]
ds_read_b128 a[184:187], v10 offset:22528
ds_read_b128 a[188:191], v11 offset:22528
M v[196:199], a[172:175], a[44:47], v[196:199]
buffer_load_dwordx4 v8, s[12:15], s24 offen offset:2048 lds
M v[196:199], a[168:171], a[40:43], v[196:199]
M v[200:203], a[168:171], a[48:51], v[200:203]
M v[200:203], a[172:175], a[52:55], v[200:203]
ds_read_b64_tr_b16 a[156:157], v19 offset:49152
ds_read_b64_tr_b16 a[158:159], v19 offset:51200
M v[204:207], a[172:175], a[60:63], v[204:207]
M v[204:207], a[168:171], a[56:59], v[204:207]
M v[208:211], a[168:171], a[64:67], v[208:211]
buffer_load_dwordx4 v9, s[12:15], s24 offen offset:3072 lds
M v[208:211], a[172:175], a[68:71], v[208:211]
M v[212:215], a[172:175], a[76:79], v[212:215]
M v[212:215], a[168:171], a[72:75], v[212:215]
M v[216:219], a[168:171], a[80:83], v[216:219]
s_add_u32 s94, s93, 8192
buffer_store_dwordx4 a[252:255], v1, s[16:19], s94 offen offset:3072 sc1
M v[216:219], a[172:175], a[84:87], v[216:219]
M v[220:223], a[172:175], a[92:95], v[220:223]
s_add_u32 s24, s24, 262144
M v[220:223], a[168:171], a[88:91], v[220:223]
s_waitcnt lgkmcnt(10)
M v[224:227], a[176:179], a[32:35], v[224:227]
M v[224:227], a[180:183], a[36:39], v[224:227]
M v[228:231], a[180:183], a[44:47], v[228:231]
M v[228:231], a[176:179], a[40:43], v[228:231]
M v[232:235], a[176:179], a[48:51], v[232:235]
M v[232:235], a[180:183], a[52:55], v[232:235]
M v[236:239], a[180:183], a[60:63], v[236:239]
M v[236:239], a[176:179], a[56:59], v[236:239]
s_waitcnt vmcnt(21) lgkmcnt(0)
s_barrier
ds_read_b128 a[160:163], v10 offset:32768
ds_read_b128 a[164:167], v11 offset:32768
M v[240:243], a[176:179], a[64:67], v[240:243]
s_add_u32 m0, s29, 16384
s_add_u32 s3, s23, s31
buffer_load_dwordx4 v2, s[8:11], s3 offen offset:0 lds
M v[240:243], a[180:183], a[68:71], v[240:243]
M v[244:247], a[180:183], a[76:79], v[244:247]
M v[244:247], a[176:179], a[72:75], v[244:247]
M v[248:251], a[176:179], a[80:83], v[248:251]
M v[248:251], a[180:183], a[84:87], v[248:251]
buffer_load_dwordx4 v3, s[8:11], s3 offen offset:1024 lds
M v[252:255], a[180:183], a[92:95], v[252:255]
M v[252:255], a[176:179], a[88:91], v[252:255]
M a[0:3], a[184:187], a[32:35], a[0:3]
M a[0:3], a[188:191], a[36:39], a[0:3]
ds_read_b128 a[168:171], v10 offset:34816
ds_read_b128 a[172:175], v11 offset:34816
M a[4:7], a[188:191], a[44:47], a[4:7]
M a[4:7], a[184:187], a[40:43], a[4:7]
M a[8:11], a[184:187], a[48:51], a[8:11]
buffer_load_dwordx4 v4, s[8:11], s3 offen offset:2048 lds
M a[8:11], a[188:191], a[52:55], a[8:11]
M a[12:15], a[188:191], a[60:63], a[12:15]
M a[12:15], a[184:187], a[56:59], a[12:15]
M a[16:19], a[184:187], a[64:67], a[16:19]
M a[16:19], a[188:191], a[68:71], a[16:19]
buffer_load_dwordx4 v5, s[8:11], s3 offen offset:3072 lds
M a[20:23], a[188:191], a[76:79], a[20:23]
M a[20:23], a[184:187], a[72:75], a[20:23]
M a[24:27], a[184:187], a[80:83], a[24:27]
M a[24:27], a[188:191], a[84:87], a[24:27]
M a[28:31], a[188:191], a[92:95], a[28:31]
M a[28:31], a[184:187], a[88:91], a[28:31]
s_waitcnt lgkmcnt(2)
M v[32:35], a[160:163], a[96:99], v[32:35]
s_add_u32 s23, s23, 128
s_cmp_eq_u32 s23, s25
s_cselect_b32 s23, s26, s23
M v[32:35], a[164:167], a[100:103], v[32:35]
ds_read_b128 a[176:179], v10 offset:36864
ds_read_b128 a[180:183], v11 offset:36864
M v[36:39], a[164:167], a[108:111], v[36:39]
M v[36:39], a[160:163], a[104:107], v[36:39]
ds_read_b64_tr_b16 a[32:33], v12 offset:0
ds_read_b64_tr_b16 a[34:35], v12 offset:2048
M v[40:43], a[160:163], a[112:115], v[40:43]
M v[40:43], a[164:167], a[116:119], v[40:43]
M v[44:47], a[164:167], a[124:127], v[44:47]
s_add_u32 m0, s29, 114688
s_nop 0
buffer_load_dwordx4 v6, s[12:15], s24 offen offset:0 lds
M v[44:47], a[160:163], a[120:123], v[44:47]
ds_read_b64_tr_b16 a[40:41], v13 offset:0
ds_read_b64_tr_b16 a[42:43], v13 offset:2048
M v[48:51], a[160:163], a[128:131], v[48:51]
M v[48:51], a[164:167], a[132:135], v[48:51]
M v[52:55], a[164:167], a[140:143], v[52:55]
M v[52:55], a[160:163], a[136:139], v[52:55]
ds_read_b64_tr_b16 a[48:49], v14 offset:0
ds_read_b64_tr_b16 a[50:51], v14 offset:2048
M v[56:59], a[160:163], a[144:147], v[56:59]
M v[56:59], a[164:167], a[148:151], v[56:59]
buffer_load_dwordx4 v7, s[12:15], s24 offen offset:1024 lds
M v[60:63], a[164:167], a[156:159], v[60:63]
M v[60:63], a[160:163], a[152:155], v[60:63]
s_waitcnt lgkmcnt(8)
ds_read_b64_tr_b16 a[56:57], v15 offset:0
ds_read_b64_tr_b16 a[58:59], v15 offset:2048
M v[64:67], a[168:171], a[96:99], v[64:67]
M v[64:67], a[172:175], a[100:103], v[64:67]
ds_read_b128 a[184:187], v10 offset:38912
ds_read_b128 a[188:191], v11 offset:38912
M v[68:71], a[172:175], a[108:111], v[68:71]
M v[68:71], a[168:171], a[104:107], v[68:71]
ds_read_b64_tr_b16 a[64:65], v16 offset:0
ds_read_b64_tr_b16 a[66:67], v16 offset:2048
M v[72:75], a[168:171], a[112:115], v[72:75]
buffer_load_dwordx4 v8, s[12:15], s24 offen offset:2048 lds
M v[72:75], a[172:175], a[116:119], v[72:75]
M v[76:79], a[172:175], a[124:127], v[76:79]
M v[76:79], a[168:171], a[120:123], v[76:79]
ds_read_b64_tr_b16 a[72:73], v17 offset:0
ds_read_b64_tr_b16 a[74:75], v17 offset:2048
M v[80:83], a[168:171], a[128:131], v[80:83]
M v[80:83], a[172:175], a[132:135], v[80:83]
M v[84:87], a[172:175], a[140:143], v[84:87]
buffer_load_dwordx4 v9, s[12:15], s24 offen offset:3072 lds
M v[84:87], a[168:171], a[136:139], v[84:87]
ds_read_b64_tr_b16 a[80:81], v18 offset:0
ds_read_b64_tr_b16 a[82:83], v18 offset:2048
M v[88:91], a[168:171], a[144:147], v[88:91]
M v[88:91], a[172:175], a[148:151], v[88:91]
M v[92:95], a[172:175], a[156:159], v[92:95]
M v[92:95], a[168:171], a[152:155], v[92:95]
s_waitcnt lgkmcnt(15)
ds_read_b64_tr_b16 a[88:89], v19 offset:0
ds_read_b64_tr_b16 a[90:91], v19 offset:2048
M v[96:99], a[176:179], a[96:99], v[96:99]
s_add_u32 s24, s24, 262144
s_cmp_eq_u32 s24, s27
s_cselect_b32 s24, s28, s24
s_sub_u32 s6, s6, 1
s_cmp_eq_u32 s6, 0
s_cselect_b64 s[12:13], s[64:65], s[12:13]
M v[96:99], a[180:183], a[100:103], v[96:99]
M v[100:103], a[180:183], a[108:111], v[100:103]
M v[100:103], a[176:179], a[104:107], v[100:103]
M v[104:107], a[176:179], a[112:115], v[104:107]
M v[104:107], a[180:183], a[116:119], v[104:107]
M v[108:111], a[180:183], a[124:127], v[108:111]
M v[108:111], a[176:179], a[120:123], v[108:111]
s_waitcnt vmcnt(19) lgkmcnt(0)
s_barrier
ds_read_b128 a[160:163], v10 offset:49152
ds_read_b128 a[164:167], v11 offset:49152
M v[112:115], a[176:179], a[128:131], v[112:115]
s_add_u32 m0, s29, 32768
s_nop 0
buffer_load_dwordx4 v2, s[8:11], s23 offen offset:0 lds
M v[112:115], a[180:183], a[132:135], v[112:115]
M v[116:119], a[180:183], a[140:143], v[116:119]
M v[116:119], a[176:179], a[136:139], v[116:119]
ds_read_b64_tr_b16 a[36:37], v12 offset:16384
ds_read_b64_tr_b16 a[38:39], v12 offset:18432
M v[120:123], a[176:179], a[144:147], v[120:123]
M v[120:123], a[180:183], a[148:151], v[120:123]
M v[124:127], a[180:183], a[156:159], v[124:127]
M v[124:127], a[176:179], a[152:155], v[124:127]
M v[128:131], a[184:187], a[96:99], v[128:131]
M v[128:131], a[188:191], a[100:103], v[128:131]
ds_read_b128 a[168:171], v10 offset:51200
ds_read_b128 a[172:175], v11 offset:51200
ds_read_b64_tr_b16 a[44:45], v13 offset:16384
ds_read_b64_tr_b16 a[46:47], v13 offset:18432
M v[132:135], a[188:191], a[108:111], v[132:135]
M v[132:135], a[184:187], a[104:107], v[132:135]
M v[136:139], a[184:187], a[112:115], v[136:139]
M v[136:139], a[188:191], a[116:119], v[136:139]
M v[140:143], a[188:191], a[124:127], v[140:143]
M v[140:143], a[184:187], a[120:123], v[140:143]
ds_read_b64_tr_b16 a[52:53], v14 offset:16384
ds_read_b64_tr_b16 a[54:55], v14 offset:18432
M v[144:147], a[184:187], a[128:131], v[144:147]
buffer_load_dwordx4 v3, s[8:11], s23 offen offset:1024 lds
M v[144:147], a[188:191], a[132:135], v[144:147]
M v[148:151], a[188:191], a[140:143], v[148:151]
M v[148:151], a[184:187], a[136:139], v[148:151]
M v[152:155], a[184:187], a[144:147], v[152:155]
M v[152:155], a[188:191], a[148:151], v[152:155]
ds_read_b64_tr_b16 a[60:61], v15 offset:16384
ds_read_b64_tr_b16 a[62:63], v15 offset:18432
M v[156:159], a[188:191], a[156:159], v[156:159]
M v[156:159], a[184:187], a[152:155], v[156:159]
s_waitcnt lgkmcnt(10)
M v[160:163], a[160:163], a[96:99], v[160:163]
M v[160:163], a[164:167], a[100:103], v[160:163]
ds_read_b128 a[176:179], v10 offset:53248
ds_read_b128 a[180:183], v11 offset:53248
M v[164:167], a[164:167], a[108:111], v[164:167]
M v[164:167], a[160:163], a[104:107], v[164:167]
ds_read_b64_tr_b16 a[68:69], v16 offset:16384
ds_read_b64_tr_b16 a[70:71], v16 offset:18432
M v[168:171], a[160:163], a[112:115], v[168:171]
M v[168:171], a[164:167], a[116:119], v[168:171]
M v[172:175], a[164:167], a[124:127], v[172:175]
M v[172:175], a[160:163], a[120:123], v[172:175]
M v[176:179], a[160:163], a[128:131], v[176:179]
buffer_load_dwordx4 v4, s[8:11], s23 offen offset:2048 lds
M v[176:179], a[164:167], a[132:135], v[176:179]
ds_read_b64_tr_b16 a[76:77], v17 offset:16384
ds_read_b64_tr_b16 a[78:79], v17 offset:18432
M v[180:183], a[164:167], a[140:143], v[180:183]
M v[180:183], a[160:163], a[136:139], v[180:183]
M v[184:187], a[160:163], a[144:147], v[184:187]
M v[184:187], a[164:167], a[148:151], v[184:187]
M v[188:191], a[164:167], a[156:159], v[188:191]
M v[188:191], a[160:163], a[152:155], v[188:191]
s_waitcnt lgkmcnt(12)
ds_read_b64_tr_b16 a[84:85], v18 offset:16384
ds_read_b64_tr_b16 a[86:87], v18 offset:18432
M v[192:195], a[168:171], a[96:99], v[192:195]
M v[192:195], a[172:175], a[100:103], v[192:195]
ds_read_b128 a[184:187], v10 offset:55296
ds_read_b128 a[188:191], v11 offset:55296
M v[196:199], a[172:175], a[108:111], v[196:199]
M v[196:199], a[168:171], a[104:107], v[196:199]
M v[200:203], a[168:171], a[112:115], v[200:203]
M v[200:203], a[172:175], a[116:119], v[200:203]
ds_read_b64_tr_b16 a[92:93], v19 offset:16384
ds_read_b64_tr_b16 a[94:95], v19 offset:18432
M v[204:207], a[172:175], a[124:127], v[204:207]
M v[204:207], a[168:171], a[120:123], v[204:207]
M v[208:211], a[168:171], a[128:131], v[208:211]
buffer_load_dwordx4 v5, s[8:11], s23 offen offset:3072 lds
M v[208:211], a[172:175], a[132:135], v[208:211]
M v[212:215], a[172:175], a[140:143], v[212:215]
M v[212:215], a[168:171], a[136:139], v[212:215]
M v[216:219], a[168:171], a[144:147], v[216:219]
M v[216:219], a[172:175], a[148:151], v[216:219]
M v[220:223], a[172:175], a[156:159], v[220:223]
M v[220:223], a[168:171], a[152:155], v[220:223]
s_waitcnt lgkmcnt(10)
M v[224:227], a[176:179], a[96:99], v[224:227]
M v[224:227], a[180:183], a[100:103], v[224:227]
M v[228:231], a[180:183], a[108:111], v[228:231]
M v[228:231], a[176:179], a[104:107], v[228:231]
M v[232:235], a[176:179], a[112:115], v[232:235]
M v[232:235], a[180:183], a[116:119], v[232:235]
M v[236:239], a[180:183], a[124:127], v[236:239]
M v[236:239], a[176:179], a[120:123], v[236:239]
s_waitcnt vmcnt(13) lgkmcnt(0)
s_barrier
ds_read_b128 a[160:163], v10 offset:0
ds_read_b128 a[164:167], v11 offset:0
M v[240:243], a[176:179], a[128:131], v[240:243]
s_add_u32 m0, s29, 49152
s_add_u32 s3, s23, s31
buffer_load_dwordx4 v2, s[8:11], s3 offen offset:0 lds
M v[240:243], a[180:183], a[132:135], v[240:243]
M v[244:247], a[180:183], a[140:143], v[244:247]
M v[244:247], a[176:179], a[136:139], v[244:247]
M v[248:251], a[176:179], a[144:147], v[248:251]
M v[248:251], a[180:183], a[148:151], v[248:251]
M v[252:255], a[180:183], a[156:159], v[252:255]
M v[252:255], a[176:179], a[152:155], v[252:255]
M a[0:3], a[184:187], a[96:99], a[0:3]
M a[0:3], a[188:191], a[100:103], a[0:3]
ds_read_b128 a[168:171], v10 offset:2048
ds_read_b128 a[172:175], v11 offset:2048
M a[4:7], a[188:191], a[108:111], a[4:7]
M a[4:7], a[184:187], a[104:107], a[4:7]
M a[8:11], a[184:187], a[112:115], a[8:11]
buffer_load_dwordx4 v3, s[8:11], s3 offen offset:1024 lds
M a[8:11], a[188:191], a[116:119], a[8:11]
M a[12:15], a[188:191], a[124:127], a[12:15]
M a[12:15], a[184:187], a[120:123], a[12:15]
M a[16:19], a[184:187], a[128:131], a[16:19]
M a[16:19], a[188:191], a[132:135], a[16:19]
M a[20:23], a[188:191], a[140:143], a[20:23]
M a[20:23], a[184:187], a[136:139], a[20:23]
M a[24:27], a[184:187], a[144:147], a[24:27]
M a[24:27], a[188:191], a[148:151], a[24:27]
M a[28:31], a[188:191], a[156:159], a[28:31]
M a[28:31], a[184:187], a[152:155], a[28:31]
s_waitcnt lgkmcnt(2)
M v[32:35], a[160:163], a[32:35], v[32:35]
buffer_load_dwordx4 v4, s[8:11], s3 offen offset:2048 lds
M v[32:35], a[164:167], a[36:39], v[32:35]
ds_read_b128 a[176:179], v10 offset:4096
ds_read_b128 a[180:183], v11 offset:4096
M v[36:39], a[164:167], a[44:47], v[36:39]
M v[36:39], a[160:163], a[40:43], v[36:39]
ds_read_b64_tr_b16 a[96:97], v12 offset:32768
ds_read_b64_tr_b16 a[98:99], v12 offset:34816
M v[40:43], a[160:163], a[48:51], v[40:43]
M v[40:43], a[164:167], a[52:55], v[40:43]
M v[44:47], a[164:167], a[60:63], v[44:47]
M v[44:47], a[160:163], a[56:59], v[44:47]
ds_read_b64_tr_b16 a[104:105], v13 offset:32768
ds_read_b64_tr_b16 a[106:107], v13 offset:34816
M v[48:51], a[160:163], a[64:67], v[48:51]
M v[48:51], a[164:167], a[68:71], v[48:51]
M v[52:55], a[164:167], a[76:79], v[52:55]
M v[52:55], a[160:163], a[72:75], v[52:55]
ds_read_b64_tr_b16 a[112:113], v14 offset:32768
ds_read_b64_tr_b16 a[114:115], v14 offset:34816
M v[56:59], a[160:163], a[80:83], v[56:59]
M v[56:59], a[164:167], a[84:87], v[56:59]
buffer_load_dwordx4 v5, s[8:11], s3 offen offset:3072 lds
M v[60:63], a[164:167], a[92:95], v[60:63]
M v[60:63], a[160:163], a[88:91], v[60:63]
s_waitcnt lgkmcnt(8)
ds_read_b64_tr_b16 a[120:121], v15 offset:32768
ds_read_b64_tr_b16 a[122:123], v15 offset:34816
M v[64:67], a[168:171], a[32:35], v[64:67]
M v[64:67], a[172:175], a[36:39], v[64:67]
ds_read_b128 a[184:187], v10 offset:6144
ds_read_b128 a[188:191], v11 offset:6144
M v[68:71], a[172:175], a[44:47], v[68:71]
M v[68:71], a[168:171], a[40:43], v[68:71]
ds_read_b64_tr_b16 a[128:129], v16 offset:32768
ds_read_b64_tr_b16 a[130:131], v16 offset:34816
M v[72:75], a[168:171], a[48:51], v[72:75]
M v[72:75], a[172:175], a[52:55], v[72:75]
M v[76:79], a[172:175], a[60:63], v[76:79]
M v[76:79], a[168:171], a[56:59], v[76:79]
ds_read_b64_tr_b16 a[136:137], v17 offset:32768
ds_read_b64_tr_b16 a[138:139], v17 offset:34816
M v[80:83], a[168:171], a[64:67], v[80:83]
M v[80:83], a[172:175], a[68:71], v[80:83]
M v[84:87], a[172:175], a[76:79], v[84:87]
s_add_u32 s23, s23, 128
s_cmp_eq_u32 s23, s25
s_cselect_b32 s23, s26, s23
M v[84:87], a[168:171], a[72:75], v[84:87]
ds_read_b64_tr_b16 a[144:145], v18 offset:32768
ds_read_b64_tr_b16 a[146:147], v18 offset:34816
M v[88:91], a[168:171], a[80:83], v[88:91]
M v[88:91], a[172:175], a[84:87], v[88:91]
M v[92:95], a[172:175], a[92:95], v[92:95]
M v[92:95], a[168:171], a[88:91], v[92:95]
s_waitcnt lgkmcnt(15)
ds_read_b64_tr_b16 a[152:153], v19 offset:32768
ds_read_b64_tr_b16 a[154:155], v19 offset:34816
M v[96:99], a[176:179], a[32:35], v[96:99]
M v[96:99], a[180:183], a[36:39], v[96:99]
M v[100:103], a[180:183], a[44:47], v[100:103]
M v[100:103], a[176:179], a[40:43], v[100:103]
M v[104:107], a[176:179], a[48:51], v[104:107]
M v[104:107], a[180:183], a[52:55], v[104:107]
M v[108:111], a[180:183], a[60:63], v[108:111]
M v[108:111], a[176:179], a[56:59], v[108:111]
s_waitcnt vmcnt(8) lgkmcnt(0)
s_barrier
ds_read_b128 a[160:163], v10 offset:16384
ds_read_b128 a[164:167], v11 offset:16384
M v[112:115], a[176:179], a[64:67], v[112:115]
M v[112:115], a[180:183], a[68:71], v[112:115]
s_and_b32 s3, s2, 1
s_lshl_b32 s3, s3, 3
s_bfe_u32 s4, s2, 0x30003
M v[116:119], a[180:183], a[76:79], v[116:119]
s_add_u32 s26, s3, s4
s_bfe_u32 s3, s2, 0x20001
s_lshl_b32 s3, s3, 2
M v[116:119], a[176:179], a[72:75], v[116:119]
ds_read_b64_tr_b16 a[100:101], v12 offset:49152
ds_read_b64_tr_b16 a[102:103], v12 offset:51200
s_lshr_b32 s4, s2, 6
s_xor_b32 s4, s4, 2
s_add_u32 s27, s3, s4
M v[120:123], a[176:179], a[80:83], v[120:123]
s_lshl_b32 s23, s26, 18
s_sub_u32 s24, s23, 32768
M v[120:123], a[180:183], a[84:87], v[120:123]
s_max_i32 s24, s24, 0
s_lshl_b32 s25, s27, 7
s_xor_b32 s3, s26, s27
M v[124:127], a[180:183], a[92:95], v[124:127]
s_and_b32 s3, s3, 0
s_lshl_b32 s3, s3, 3
s_sub_u32 s31, 16, s3
M v[124:127], a[176:179], a[88:91], v[124:127]
s_mov_b32 s54, s31
s_movk_i32 s57, 128
M v[128:131], a[184:187], a[32:35], v[128:131]
s_mov_b32 s55, 4289069056
s_mov_b32 s56, 393216
s_lshl_b32 s4, s3, 7
M v[128:131], a[188:191], a[36:39], v[128:131]
ds_read_b128 a[168:171], v10 offset:18432
ds_read_b128 a[172:175], v11 offset:18432
ds_read_b64_tr_b16 a[108:109], v13 offset:49152
ds_read_b64_tr_b16 a[110:111], v13 offset:51200
s_add_u32 s23, s23, s4
s_add_u32 s24, s24, s4
s_mul_i32 s4, s3, 393216
M v[132:135], a[188:191], a[44:47], v[132:135]
s_add_u32 s25, s25, s4
s_mov_b64 s[8:9], s[44:45]
s_mov_b32 s10, 4194304
M v[132:135], a[184:187], a[40:43], v[132:135]
s_mov_b64 s[12:13], s[46:47]
s_mov_b32 s14, 6291456
M v[136:139], a[184:187], a[48:51], v[136:139]
s_mov_b64 s[36:37], s[90:91]
s_mov_b32 s38, 256
s_mov_b32 s39, 0x00020000
M v[136:139], a[188:191], a[52:55], v[136:139]
s_lshl_b32 s28, s20, 9
s_mul_i32 s30, s20, 6144
s_lshl_b32 s3, s20, 5
M v[140:143], a[188:191], a[60:63], v[140:143]
v_lshrrev_b32 v24, 3, v0
v_and_b32 v25, 7, v0
M v[140:143], a[184:187], a[56:59], v[140:143]
ds_read_b64_tr_b16 a[116:117], v14 offset:49152
ds_read_b64_tr_b16 a[118:119], v14 offset:51200
v_add_u32 v28, s3, v24
v_add_u32 v26, 0, v28
v_bfe_u32 v27, v26, 1, 3
M v[144:147], a[184:187], a[64:67], v[144:147]
v_xor_b32 v27, v27, v25
v_lshlrev_b32 v26, 11, v26
v_lshl_add_u32 v26, v27, 4, v26
M v[144:147], a[188:191], a[68:71], v[144:147]
v_subrev_u32 v2, 0, v26
v_add_u32 v26, 8, v28
v_bfe_u32 v27, v26, 1, 3
M v[148:151], a[188:191], a[76:79], v[148:151]
v_xor_b32 v27, v27, v25
v_lshlrev_b32 v26, 11, v26
M v[148:151], a[184:187], a[72:75], v[148:151]
v_lshl_add_u32 v26, v27, 4, v26
v_subrev_u32 v3, 1024, v26
v_add_u32 v26, 16, v28
M v[152:155], a[184:187], a[80:83], v[152:155]
v_bfe_u32 v27, v26, 1, 3
v_xor_b32 v27, v27, v25
v_lshlrev_b32 v26, 11, v26
M v[152:155], a[188:191], a[84:87], v[152:155]
ds_read_b64_tr_b16 a[124:125], v15 offset:49152
ds_read_b64_tr_b16 a[126:127], v15 offset:51200
v_lshl_add_u32 v26, v27, 4, v26
v_subrev_u32 v4, 2048, v26
M v[156:159], a[188:191], a[92:95], v[156:159]
v_add_u32 v26, 24, v28
v_bfe_u32 v27, v26, 1, 3
v_xor_b32 v27, v27, v25
M v[156:159], a[184:187], a[88:91], v[156:159]
s_waitcnt lgkmcnt(10)
v_lshlrev_b32 v26, 11, v26
v_lshl_add_u32 v26, v27, 4, v26
v_subrev_u32 v5, 3072, v26
M v[160:163], a[160:163], a[32:35], v[160:163]
s_lshl_b32 s3, s20, 2
v_lshrrev_b32 v26, 5, v0
M v[160:163], a[164:167], a[36:39], v[160:163]
ds_read_b128 a[176:179], v10 offset:20480
ds_read_b128 a[180:183], v11 offset:20480
v_add_u32 v26, s3, v26
v_bfe_u32 v29, v0, 2, 3
v_bfe_u32 v27, v26, 1, 3
M v[164:167], a[164:167], a[44:47], v[164:167]
v_xor_b32 v27, v27, v29
v_lshlrev_b32 v27, 4, v27
v_and_b32 v30, 3, v0
M v[164:167], a[160:163], a[40:43], v[164:167]
ds_read_b64_tr_b16 a[132:133], v16 offset:49152
ds_read_b64_tr_b16 a[134:135], v16 offset:51200
v_lshl_add_u32 v27, v30, 2, v27
v_lshl_add_u32 v20, v26, 11, v27
v_add_u32 v26, 2, v26
M v[168:171], a[160:163], a[48:51], v[168:171]
v_bfe_u32 v27, v26, 1, 3
v_xor_b32 v27, v27, v29
M v[168:171], a[164:167], a[52:55], v[168:171]
v_lshlrev_b32 v27, 4, v27
v_and_b32 v30, 3, v0
v_lshl_add_u32 v27, v30, 2, v27
M v[172:175], a[164:167], a[60:63], v[172:175]
v_lshl_add_u32 v23, v26, 11, v27
v_subrev_u32 v23, 256, v23
s_mul_i32 s3, s20, 48
M v[172:175], a[160:163], a[56:59], v[172:175]
v_add_u32 v28, s3, v24
v_add_u32 v26, 0, v28
M v[176:179], a[160:163], a[64:67], v[176:179]
v_mul_u32_u24 v27, 0xaaab, v26
v_lshrrev_b32 v27, 17, v27
v_lshrrev_b32 v29, 1, v27
M v[176:179], a[164:167], a[68:71], v[176:179]
ds_read_b64_tr_b16 a[140:141], v17 offset:49152
ds_read_b64_tr_b16 a[142:143], v17 offset:51200
v_and_b32 v29, 4, v29
v_and_or_b32 v27, v27, 2, v29
v_xor_b32 v27, v27, v25
M v[180:183], a[164:167], a[76:79], v[180:183]
v_lshlrev_b32 v26, 11, v26
v_lshl_add_u32 v26, v27, 4, v26
v_subrev_u32 v6, 0, v26
M v[180:183], a[160:163], a[72:75], v[180:183]
v_add_u32 v26, 8, v28
v_mul_u32_u24 v27, 0xaaab, v26
M v[184:187], a[160:163], a[80:83], v[184:187]
v_lshrrev_b32 v27, 17, v27
v_lshrrev_b32 v29, 1, v27
v_and_b32 v29, 4, v29
M v[184:187], a[164:167], a[84:87], v[184:187]
v_and_or_b32 v27, v27, 2, v29
v_xor_b32 v27, v27, v25
v_lshlrev_b32 v26, 11, v26
M v[188:191], a[164:167], a[92:95], v[188:191]
v_lshl_add_u32 v26, v27, 4, v26
v_subrev_u32 v7, 1024, v26
M v[188:191], a[160:163], a[88:91], v[188:191]
s_waitcnt lgkmcnt(12)
ds_read_b64_tr_b16 a[148:149], v18 offset:49152
ds_read_b64_tr_b16 a[150:151], v18 offset:51200
v_add_u32 v26, 16, v28
v_mul_u32_u24 v27, 0xaaab, v26
v_lshrrev_b32 v27, 17, v27
M v[192:195], a[168:171], a[32:35], v[192:195]
v_lshrrev_b32 v29, 1, v27
v_and_b32 v29, 4, v29
v_and_or_b32 v27, v27, 2, v29
M v[192:195], a[172:175], a[36:39], v[192:195]
ds_read_b128 a[184:187], v10 offset:22528
ds_read_b128 a[188:191], v11 offset:22528
v_xor_b32 v27, v27, v25
v_lshlrev_b32 v26, 11, v26
M v[196:199], a[172:175], a[44:47], v[196:199]
v_lshl_add_u32 v26, v27, 4, v26
v_subrev_u32 v8, 2048, v26
v_add_u32 v26, 24, v28
M v[196:199], a[168:171], a[40:43], v[196:199]
v_mul_u32_u24 v27, 0xaaab, v26
v_lshrrev_b32 v27, 17, v27
v_lshrrev_b32 v29, 1, v27
M v[200:203], a[168:171], a[48:51], v[200:203]
v_and_b32 v29, 4, v29
v_and_or_b32 v27, v27, 2, v29
v_xor_b32 v27, v27, v25
M v[200:203], a[172:175], a[52:55], v[200:203]
ds_read_b64_tr_b16 a[156:157], v19 offset:49152
ds_read_b64_tr_b16 a[158:159], v19 offset:51200
v_lshlrev_b32 v26, 11, v26
v_lshl_add_u32 v26, v27, 4, v26
M v[204:207], a[172:175], a[60:63], v[204:207]
v_subrev_u32 v9, 3072, v26
v_add_u32 v26, 32, v28
v_mul_u32_u24 v27, 0xaaab, v26
M v[204:207], a[168:171], a[56:59], v[204:207]
v_lshrrev_b32 v27, 17, v27
v_lshrrev_b32 v29, 1, v27
v_and_b32 v29, 4, v29
M v[208:211], a[168:171], a[64:67], v[208:211]
v_and_or_b32 v27, v27, 2, v29
v_xor_b32 v27, v27, v25
M v[208:211], a[172:175], a[68:71], v[208:211]
v_lshlrev_b32 v26, 11, v26
v_lshl_add_u32 v26, v27, 4, v26
v_subrev_u32 v21, 0, v26
M v[212:215], a[172:175], a[76:79], v[212:215]
v_add_u32 v26, 40, v28
v_mul_u32_u24 v27, 0xaaab, v26
v_lshrrev_b32 v27, 17, v27
M v[212:215], a[168:171], a[72:75], v[212:215]
v_lshrrev_b32 v29, 1, v27
v_and_b32 v29, 4, v29
v_and_or_b32 v27, v27, 2, v29
M v[216:219], a[168:171], a[80:83], v[216:219]
v_xor_b32 v27, v27, v25
v_lshlrev_b32 v26, 11, v26
M v[216:219], a[172:175], a[84:87], v[216:219]
v_lshl_add_u32 v26, v27, 4, v26
v_subrev_u32 v22, 1024, v26
s_lshr_b32 s3, s53, 7
M v[220:223], a[172:175], a[92:95], v[220:223]
s_add_u32 s3, s3, s22
s_lshl_b32 s3, s3, 5
s_lshr_b32 s19, s52, 6
M v[220:223], a[168:171], a[88:91], v[220:223]
s_waitcnt lgkmcnt(10)
s_add_u32 s3, s3, s19
s_lshl_b32 s19, s21, 1
M v[224:227], a[176:179], a[32:35], v[224:227]
s_add_u32 s3, s3, s19
s_lshl_b32 s92, s3, 15
s_add_u32 s92, s92, 16384
M v[224:227], a[180:183], a[36:39], v[224:227]
s_add_u32 s93, s92, 32768
s_add_u32 s16, s50, 16777216
s_addc_u32 s17, s51, 0
M v[228:231], a[180:183], a[44:47], v[228:231]
s_mov_b32 s18, 33554432
s_mov_b32 s19, 0x00020000
M v[228:231], a[176:179], a[40:43], v[228:231]
M v[232:235], a[176:179], a[48:51], v[232:235]
M v[232:235], a[180:183], a[52:55], v[232:235]
M v[236:239], a[180:183], a[60:63], v[236:239]
M v[236:239], a[176:179], a[56:59], v[236:239]
s_waitcnt vmcnt(4) lgkmcnt(0)
s_barrier
ds_read_b128 a[160:163], v10 offset:32768
ds_read_b128 a[164:167], v11 offset:32768
M v[240:243], a[176:179], a[64:67], v[240:243]
s_add_u32 m0, s28, 131072
s_nop 0
buffer_load_dword v20, s[8:11], s24 offen lds
M v[240:243], a[180:183], a[68:71], v[240:243]
M v[244:247], a[180:183], a[76:79], v[244:247]
M v[244:247], a[176:179], a[72:75], v[244:247]
buffer_load_dword v23, s[8:11], s24 offen offset:256 lds
M v[248:251], a[176:179], a[80:83], v[248:251]
M v[248:251], a[180:183], a[84:87], v[248:251]
M v[252:255], a[180:183], a[92:95], v[252:255]
M v[252:255], a[176:179], a[88:91], v[252:255]
M a[0:3], a[184:187], a[32:35], a[0:3]
s_add_u32 m0, s29, 133120
s_nop 0
buffer_load_dwordx4 v2, s[8:11], s23 offen offset:0 lds
M a[0:3], a[188:191], a[36:39], a[0:3]
ds_read_b128 a[168:171], v10 offset:34816
ds_read_b128 a[172:175], v11 offset:34816
M a[4:7], a[188:191], a[44:47], a[4:7]
M a[4:7], a[184:187], a[40:43], a[4:7]
M a[8:11], a[184:187], a[48:51], a[8:11]
buffer_load_dwordx4 v3, s[8:11], s23 offen offset:1024 lds
M a[8:11], a[188:191], a[52:55], a[8:11]
M a[12:15], a[188:191], a[60:63], a[12:15]
M a[12:15], a[184:187], a[56:59], a[12:15]
M a[16:19], a[184:187], a[64:67], a[16:19]
buffer_load_dwordx4 v4, s[8:11], s23 offen offset:2048 lds
M a[16:19], a[188:191], a[68:71], a[16:19]
M a[20:23], a[188:191], a[76:79], a[20:23]
M a[20:23], a[184:187], a[72:75], a[20:23]
buffer_load_dwordx4 v5, s[8:11], s23 offen offset:3072 lds
M a[24:27], a[184:187], a[80:83], a[24:27]
M a[24:27], a[188:191], a[84:87], a[24:27]
M a[28:31], a[188:191], a[92:95], a[28:31]
M a[28:31], a[184:187], a[88:91], a[28:31]
s_waitcnt lgkmcnt(2)
M v[32:35], a[160:163], a[96:99], v[32:35]
s_sub_u32 s31, s31, 1
s_cmp_eq_u32 s31, 0
s_cselect_b32 s58, -1920, s57
s_add_u32 s23, s23, s58
s_add_u32 s24, s24, s58
M v[32:35], a[164:167], a[100:103], v[32:35]
ds_read_b128 a[176:179], v10 offset:36864
ds_read_b128 a[180:183], v11 offset:36864
M v[36:39], a[164:167], a[108:111], v[36:39]
M v[36:39], a[160:163], a[104:107], v[36:39]
M v[40:43], a[160:163], a[112:115], v[40:43]
M v[40:43], a[164:167], a[116:119], v[40:43]
s_add_u32 m0, s30, 65536
s_nop 0
buffer_load_dwordx4 v6, s[12:15], s25 offen offset:0 lds
M v[44:47], a[164:167], a[124:127], v[44:47]
M v[44:47], a[160:163], a[120:123], v[44:47]
M v[48:51], a[160:163], a[128:131], v[48:51]
M v[48:51], a[164:167], a[132:135], v[48:51]
buffer_load_dwordx4 v7, s[12:15], s25 offen offset:1024 lds
M v[52:55], a[164:167], a[140:143], v[52:55]
M v[52:55], a[160:163], a[136:139], v[52:55]
M v[56:59], a[160:163], a[144:147], v[56:59]
M v[56:59], a[164:167], a[148:151], v[56:59]
buffer_load_dwordx4 v8, s[12:15], s25 offen offset:2048 lds
M v[60:63], a[164:167], a[156:159], v[60:63]
M v[60:63], a[160:163], a[152:155], v[60:63]
s_waitcnt lgkmcnt(2)
M v[64:67], a[168:171], a[96:99], v[64:67]
M v[64:67], a[172:175], a[100:103], v[64:67]
ds_read_b128 a[184:187], v10 offset:38912
ds_read_b128 a[188:191], v11 offset:38912
M v[68:71], a[172:175], a[108:111], v[68:71]
M v[68:71], a[168:171], a[104:107], v[68:71]
buffer_load_dwordx4 v9, s[12:15], s25 offen offset:3072 lds
M v[72:75], a[168:171], a[112:115], v[72:75]
M v[72:75], a[172:175], a[116:119], v[72:75]
M v[76:79], a[172:175], a[124:127], v[76:79]
M v[76:79], a[168:171], a[120:123], v[76:79]
s_add_u32 m0, s30, 69632
s_nop 0
buffer_load_dwordx4 v21, s[12:15], s25 offen offset:0 lds
M v[80:83], a[168:171], a[128:131], v[80:83]
M v[80:83], a[172:175], a[132:135], v[80:83]
M v[84:87], a[172:175], a[140:143], v[84:87]
M v[84:87], a[168:171], a[136:139], v[84:87]
buffer_load_dwordx4 v22, s[12:15], s25 offen offset:1024 lds
M v[88:91], a[168:171], a[144:147], v[88:91]
M v[88:91], a[172:175], a[148:151], v[88:91]
M v[92:95], a[172:175], a[156:159], v[92:95]
M v[92:95], a[168:171], a[152:155], v[92:95]
s_waitcnt lgkmcnt(2)
M v[96:99], a[176:179], a[96:99], v[96:99]
s_sub_u32 s54, s54, 1
s_cmp_eq_u32 s54, 0
s_cselect_b32 s58, s55, s56
s_add_u32 s25, s25, s58
M v[96:99], a[180:183], a[100:103], v[96:99]
M v[100:103], a[180:183], a[108:111], v[100:103]
M v[100:103], a[176:179], a[104:107], v[100:103]
v_cvt_pk_bf16_f32 v32, v32, v33
v_cvt_pk_bf16_f32 v33, v34, v35
M v[104:107], a[176:179], a[112:115], v[104:107]
v_cvt_pk_bf16_f32 v34, v64, v65
v_cvt_pk_bf16_f32 v35, v66, v67
M v[104:107], a[180:183], a[116:119], v[104:107]
v_cvt_pk_bf16_f32 v64, v48, v49
M v[108:111], a[180:183], a[124:127], v[108:111]
v_cvt_pk_bf16_f32 v65, v50, v51
v_cvt_pk_bf16_f32 v66, v80, v81
M v[108:111], a[176:179], a[120:123], v[108:111]
s_waitcnt vmcnt(12) lgkmcnt(0)
s_barrier
ds_read_b128 a[160:163], v10 offset:49152
ds_read_b128 a[164:167], v11 offset:49152
v_cvt_pk_bf16_f32 v67, v82, v83
M v[112:115], a[176:179], a[128:131], v[112:115]
s_add_u32 m0, s28, 0
s_nop 0
buffer_load_dword v20, s[8:11], s24 offen lds
v_cvt_pk_bf16_f32 v48, v40, v41
v_cvt_pk_bf16_f32 v49, v42, v43
M v[112:115], a[180:183], a[132:135], v[112:115]
v_cvt_pk_bf16_f32 v50, v72, v73
v_cvt_pk_bf16_f32 v51, v74, v75
M v[116:119], a[180:183], a[140:143], v[116:119]
v_cvt_pk_bf16_f32 v80, v56, v57
M v[116:119], a[176:179], a[136:139], v[116:119]
buffer_load_dword v23, s[8:11], s24 offen offset:256 lds
v_cvt_pk_bf16_f32 v81, v58, v59
v_cvt_pk_bf16_f32 v82, v88, v89
M v[120:123], a[176:179], a[144:147], v[120:123]
v_cvt_pk_bf16_f32 v83, v90, v91
M v[120:123], a[180:183], a[148:151], v[120:123]
v_cvt_pk_bf16_f32 v40, v36, v37
v_cvt_pk_bf16_f32 v41, v38, v39
M v[124:127], a[180:183], a[156:159], v[124:127]
s_add_u32 m0, s29, 2048
s_nop 0
buffer_load_dwordx4 v2, s[8:11], s23 offen offset:0 lds
v_cvt_pk_bf16_f32 v42, v68, v69
v_cvt_pk_bf16_f32 v43, v70, v71
M v[124:127], a[176:179], a[152:155], v[124:127]
v_cvt_pk_bf16_f32 v72, v52, v53
M v[128:131], a[184:187], a[96:99], v[128:131]
v_cvt_pk_bf16_f32 v73, v54, v55
v_cvt_pk_bf16_f32 v74, v84, v85
M v[128:131], a[188:191], a[100:103], v[128:131]
ds_read_b128 a[168:171], v10 offset:51200
ds_read_b128 a[172:175], v11 offset:51200
v_cvt_pk_bf16_f32 v75, v86, v87
M v[132:135], a[188:191], a[108:111], v[132:135]
v_cvt_pk_bf16_f32 v56, v44, v45
v_cvt_pk_bf16_f32 v57, v46, v47
M v[132:135], a[184:187], a[104:107], v[132:135]
buffer_load_dwordx4 v3, s[8:11], s23 offen offset:1024 lds
v_cvt_pk_bf16_f32 v58, v76, v77
v_cvt_pk_bf16_f32 v59, v78, v79
M v[136:139], a[184:187], a[112:115], v[136:139]
v_cvt_pk_bf16_f32 v88, v60, v61
M v[136:139], a[188:191], a[116:119], v[136:139]
v_cvt_pk_bf16_f32 v89, v62, v63
v_cvt_pk_bf16_f32 v90, v92, v93
M v[140:143], a[188:191], a[124:127], v[140:143]
buffer_load_dwordx4 v4, s[8:11], s23 offen offset:2048 lds
v_cvt_pk_bf16_f32 v91, v94, v95
M v[140:143], a[184:187], a[120:123], v[140:143]
M v[144:147], a[184:187], a[128:131], v[144:147]
M v[144:147], a[188:191], a[132:135], v[144:147]
buffer_load_dwordx4 v5, s[8:11], s23 offen offset:3072 lds
M v[148:151], a[188:191], a[140:143], v[148:151]
s_add_u32 s94, s92, 0
buffer_store_dwordx4 v[32:35], v1, s[16:19], s94 offen offset:0 sc1
M v[148:151], a[184:187], a[136:139], v[148:151]
M v[152:155], a[184:187], a[144:147], v[152:155]
M v[152:155], a[188:191], a[148:151], v[152:155]
s_sub_u32 s31, s31, 1
s_cmp_eq_u32 s31, 0
s_cselect_b32 s58, -1920, s57
s_add_u32 s23, s23, s58
s_add_u32 s24, s24, s58
M v[156:159], a[188:191], a[156:159], v[156:159]
s_add_u32 s94, s92, 0
buffer_store_dwordx4 v[40:43], v1, s[16:19], s94 offen offset:1024 sc1
M v[156:159], a[184:187], a[152:155], v[156:159]
s_waitcnt lgkmcnt(2)
M v[160:163], a[160:163], a[96:99], v[160:163]
M v[160:163], a[164:167], a[100:103], v[160:163]
ds_read_b128 a[176:179], v10 offset:53248
ds_read_b128 a[180:183], v11 offset:53248
M v[164:167], a[164:167], a[108:111], v[164:167]
s_add_u32 s94, s92, 0
buffer_store_dwordx4 v[48:51], v1, s[16:19], s94 offen offset:2048 sc1
M v[164:167], a[160:163], a[104:107], v[164:167]
v_cvt_pk_bf16_f32 v96, v96, v97
v_cvt_pk_bf16_f32 v97, v98, v99
M v[168:171], a[160:163], a[112:115], v[168:171]
v_cvt_pk_bf16_f32 v98, v128, v129
v_cvt_pk_bf16_f32 v99, v130, v131
M v[168:171], a[164:167], a[116:119], v[168:171]
s_add_u32 m0, s30, 98304
s_nop 0
buffer_load_dwordx4 v6, s[12:15], s25 offen offset:0 lds
v_cvt_pk_bf16_f32 v128, v112, v113
M v[172:175], a[164:167], a[124:127], v[172:175]
s_add_u32 s94, s92, 0
buffer_store_dwordx4 v[56:59], v1, s[16:19], s94 offen offset:3072 sc1
v_cvt_pk_bf16_f32 v129, v114, v115
v_cvt_pk_bf16_f32 v130, v144, v145
M v[172:175], a[160:163], a[120:123], v[172:175]
v_cvt_pk_bf16_f32 v131, v146, v147
M v[176:179], a[160:163], a[128:131], v[176:179]
v_cvt_pk_bf16_f32 v112, v104, v105
v_cvt_pk_bf16_f32 v113, v106, v107
M v[176:179], a[164:167], a[132:135], v[176:179]
buffer_load_dwordx4 v7, s[12:15], s25 offen offset:1024 lds
v_cvt_pk_bf16_f32 v114, v136, v137
v_cvt_pk_bf16_f32 v115, v138, v139
M v[180:183], a[164:167], a[140:143], v[180:183]
s_add_u32 s94, s92, 4096
buffer_store_dwordx4 v[64:67], v1, s[16:19], s94 offen offset:0 sc1
v_cvt_pk_bf16_f32 v144, v120, v121
M v[180:183], a[160:163], a[136:139], v[180:183]
v_cvt_pk_bf16_f32 v145, v122, v123
v_cvt_pk_bf16_f32 v146, v152, v153
M v[184:187], a[160:163], a[144:147], v[184:187]
v_cvt_pk_bf16_f32 v147, v154, v155
M v[184:187], a[164:167], a[148:151], v[184:187]
buffer_load_dwordx4 v8, s[12:15], s25 offen offset:2048 lds
v_cvt_pk_bf16_f32 v104, v100, v101
v_cvt_pk_bf16_f32 v105, v102, v103
M v[188:191], a[164:167], a[156:159], v[188:191]
s_add_u32 s94, s92, 4096
buffer_store_dwordx4 v[72:75], v1, s[16:19], s94 offen offset:1024 sc1
v_cvt_pk_bf16_f32 v106, v132, v133
v_cvt_pk_bf16_f32 v107, v134, v135
M v[188:191], a[160:163], a[152:155], v[188:191]
s_waitcnt lgkmcnt(2)
v_cvt_pk_bf16_f32 v136, v116, v117
M v[192:195], a[168:171], a[96:99], v[192:195]
v_cvt_pk_bf16_f32 v137, v118, v119
v_cvt_pk_bf16_f32 v138, v148, v149
M v[192:195], a[172:175], a[100:103], v[192:195]
ds_read_b128 a[184:187], v10 offset:55296
ds_read_b128 a[188:191], v11 offset:55296
v_cvt_pk_bf16_f32 v139, v150, v151
M v[196:199], a[172:175], a[108:111], v[196:199]
s_add_u32 s94, s92, 4096
buffer_store_dwordx4 v[80:83], v1, s[16:19], s94 offen offset:2048 sc1
v_cvt_pk_bf16_f32 v120, v108, v109
v_cvt_pk_bf16_f32 v121, v110, v111
M v[196:199], a[168:171], a[104:107], v[196:199]
v_cvt_pk_bf16_f32 v122, v140, v141
v_cvt_pk_bf16_f32 v123, v142, v143
M v[200:203], a[168:171], a[112:115], v[200:203]
buffer_load_dwordx4 v9, s[12:15], s25 offen offset:3072 lds
v_cvt_pk_bf16_f32 v152, v124, v125
M v[200:203], a[172:175], a[116:119], v[200:203]
v_cvt_pk_bf16_f32 v153, v126, v127
v_cvt_pk_bf16_f32 v154, v156, v157
M v[204:207], a[172:175], a[124:127], v[204:207]
s_add_u32 s94, s92, 4096
buffer_store_dwordx4 v[88:91], v1, s[16:19], s94 offen offset:3072 sc1
v_cvt_pk_bf16_f32 v155, v158, v159
M v[204:207], a[168:171], a[120:123], v[204:207]
M v[208:211], a[168:171], a[128:131], v[208:211]
s_add_u32 m0, s30, 102400
s_nop 0
buffer_load_dwordx4 v21, s[12:15], s25 offen offset:0 lds
M v[208:211], a[172:175], a[132:135], v[208:211]
M v[212:215], a[172:175], a[140:143], v[212:215]
M v[212:215], a[168:171], a[136:139], v[212:215]
buffer_load_dwordx4 v22, s[12:15], s25 offen offset:1024 lds
M v[216:219], a[168:171], a[144:147], v[216:219]
s_add_u32 s94, s92, 8192
buffer_store_dwordx4 v[96:99], v1, s[16:19], s94 offen offset:0 sc1
M v[216:219], a[172:175], a[148:151], v[216:219]
M v[220:223], a[172:175], a[156:159], v[220:223]
M v[220:223], a[168:171], a[152:155], v[220:223]
s_waitcnt lgkmcnt(2)
M v[224:227], a[176:179], a[96:99], v[224:227]
s_sub_u32 s54, s54, 1
s_cmp_eq_u32 s54, 0
s_cselect_b32 s58, s55, s56
s_add_u32 s25, s25, s58
M v[224:227], a[180:183], a[100:103], v[224:227]
M v[228:231], a[180:183], a[108:111], v[228:231]
s_add_u32 s94, s92, 8192
buffer_store_dwordx4 v[104:107], v1, s[16:19], s94 offen offset:1024 sc1
M v[228:231], a[176:179], a[104:107], v[228:231]
v_cvt_pk_bf16_f32 v160, v160, v161
v_cvt_pk_bf16_f32 v161, v162, v163
M v[232:235], a[176:179], a[112:115], v[232:235]
v_cvt_pk_bf16_f32 v162, v192, v193
v_cvt_pk_bf16_f32 v163, v194, v195
M v[232:235], a[180:183], a[116:119], v[232:235]
v_cvt_pk_bf16_f32 v192, v176, v177
M v[236:239], a[180:183], a[124:127], v[236:239]
v_cvt_pk_bf16_f32 v193, v178, v179
v_cvt_pk_bf16_f32 v194, v208, v209
M v[236:239], a[176:179], a[120:123], v[236:239]
s_waitcnt vmcnt(63) lgkmcnt(0)
s_barrier
v_cvt_pk_bf16_f32 v195, v210, v211
M v[240:243], a[176:179], a[128:131], v[240:243]
s_add_u32 s94, s92, 8192
buffer_store_dwordx4 v[112:115], v1, s[16:19], s94 offen offset:2048 sc1
v_cvt_pk_bf16_f32 v176, v168, v169
v_cvt_pk_bf16_f32 v177, v170, v171
M v[240:243], a[180:183], a[132:135], v[240:243]
s_add_u32 m0, s28, 18432
s_nop 0
buffer_load_dword v20, s[8:11], s24 offen lds
v_cvt_pk_bf16_f32 v178, v200, v201
v_cvt_pk_bf16_f32 v179, v202, v203
M v[244:247], a[180:183], a[140:143], v[244:247]
v_cvt_pk_bf16_f32 v208, v184, v185
M v[244:247], a[176:179], a[136:139], v[244:247]
v_cvt_pk_bf16_f32 v209, v186, v187
v_cvt_pk_bf16_f32 v210, v216, v217
M v[248:251], a[176:179], a[144:147], v[248:251]
buffer_load_dword v23, s[8:11], s24 offen offset:256 lds
v_cvt_pk_bf16_f32 v211, v218, v219
M v[248:251], a[180:183], a[148:151], v[248:251]
v_cvt_pk_bf16_f32 v168, v164, v165
v_cvt_pk_bf16_f32 v169, v166, v167
M v[252:255], a[180:183], a[156:159], v[252:255]
s_add_u32 s94, s92, 8192
buffer_store_dwordx4 v[120:123], v1, s[16:19], s94 offen offset:3072 sc1
v_cvt_pk_bf16_f32 v170, v196, v197
v_cvt_pk_bf16_f32 v171, v198, v199
M v[252:255], a[176:179], a[152:155], v[252:255]
v_cvt_pk_bf16_f32 v200, v180, v181
M a[0:3], a[184:187], a[96:99], a[0:3]
v_cvt_pk_bf16_f32 v201, v182, v183
v_cvt_pk_bf16_f32 v202, v212, v213
M a[0:3], a[188:191], a[100:103], a[0:3]
s_add_u32 m0, s29, 20480
s_nop 0
buffer_load_dwordx4 v2, s[8:11], s23 offen offset:0 lds
v_cvt_pk_bf16_f32 v203, v214, v215
M a[4:7], a[188:191], a[108:111], a[4:7]
v_cvt_pk_bf16_f32 v184, v172, v173
v_cvt_pk_bf16_f32 v185, v174, v175
M a[4:7], a[184:187], a[104:107], a[4:7]
v_cvt_pk_bf16_f32 v186, v204, v205
v_cvt_pk_bf16_f32 v187, v206, v207
M a[8:11], a[184:187], a[112:115], a[8:11]
s_add_u32 s94, s92, 12288
buffer_store_dwordx4 v[128:131], v1, s[16:19], s94 offen offset:0 sc1
v_cvt_pk_bf16_f32 v216, v188, v189
M a[8:11], a[188:191], a[116:119], a[8:11]
buffer_load_dwordx4 v3, s[8:11], s23 offen offset:1024 lds
v_cvt_pk_bf16_f32 v217, v190, v191
v_cvt_pk_bf16_f32 v218, v220, v221
M a[12:15], a[188:191], a[124:127], a[12:15]
v_cvt_pk_bf16_f32 v219, v222, v223
M a[12:15], a[184:187], a[120:123], a[12:15]
M a[16:19], a[184:187], a[128:131], a[16:19]
buffer_load_dwordx4 v4, s[8:11], s23 offen offset:2048 lds
M a[16:19], a[188:191], a[132:135], a[16:19]
M a[20:23], a[188:191], a[140:143], a[20:23]
s_add_u32 s94, s92, 12288
buffer_store_dwordx4 v[136:139], v1, s[16:19], s94 offen offset:1024 sc1
M a[20:23], a[184:187], a[136:139], a[20:23]
M a[24:27], a[184:187], a[144:147], a[24:27]
buffer_load_dwordx4 v5, s[8:11], s23 offen offset:3072 lds
M a[24:27], a[188:191], a[148:151], a[24:27]
M a[28:31], a[188:191], a[156:159], a[28:31]
M a[28:31], a[184:187], a[152:155], a[28:31]
v_accvgpr_read_b32 v24, a0
v_accvgpr_read_b32 v25, a1
v_accvgpr_read_b32 v26, a2
v_accvgpr_read_b32 v27, a3
v_cvt_pk_bf16_f32 v224, v224, v225
v_cvt_pk_bf16_f32 v225, v226, v227
v_cvt_pk_bf16_f32 v226, v24, v25
v_cvt_pk_bf16_f32 v227, v26, v27
v_accvgpr_read_b32 v24, a16
v_accvgpr_read_b32 v25, a17
v_accvgpr_read_b32 v26, a18
v_accvgpr_read_b32 v27, a19
v_cvt_pk_bf16_f32 v36, v240, v241
v_cvt_pk_bf16_f32 v37, v242, v243
v_cvt_pk_bf16_f32 v38, v24, v25
v_cvt_pk_bf16_f32 v39, v26, v27
v_accvgpr_read_b32 v24, a24
v_accvgpr_read_b32 v25, a25
v_accvgpr_read_b32 v26, a26
v_accvgpr_read_b32 v27, a27
v_cvt_pk_bf16_f32 v52, v248, v249
v_cvt_pk_bf16_f32 v53, v250, v251
v_cvt_pk_bf16_f32 v54, v24, v25
v_cvt_pk_bf16_f32 v55, v26, v27
v_accvgpr_read_b32 v24, a8
v_accvgpr_read_b32 v25, a9
v_accvgpr_read_b32 v26, a10
v_accvgpr_read_b32 v27, a11
v_cvt_pk_bf16_f32 v240, v232, v233
v_cvt_pk_bf16_f32 v241, v234, v235
v_cvt_pk_bf16_f32 v242, v24, v25
v_cvt_pk_bf16_f32 v243, v26, v27
v_accvgpr_read_b32 v28, a4
v_accvgpr_read_b32 v29, a5
v_accvgpr_read_b32 v30, a6
v_accvgpr_read_b32 v31, a7
v_cvt_pk_bf16_f32 v232, v228, v229
v_cvt_pk_bf16_f32 v233, v230, v231
v_cvt_pk_bf16_f32 v234, v28, v29
v_cvt_pk_bf16_f32 v235, v30, v31
v_accvgpr_read_b32 v28, a12
v_accvgpr_read_b32 v29, a13
v_accvgpr_read_b32 v30, a14
v_accvgpr_read_b32 v31, a15
v_cvt_pk_bf16_f32 v248, v236, v237
v_cvt_pk_bf16_f32 v249, v238, v239
v_cvt_pk_bf16_f32 v250, v28, v29
v_cvt_pk_bf16_f32 v251, v30, v31
v_accvgpr_read_b32 v28, a20
v_accvgpr_read_b32 v29, a21
v_accvgpr_read_b32 v30, a22
v_accvgpr_read_b32 v31, a23
v_cvt_pk_bf16_f32 v44, v244, v245
v_cvt_pk_bf16_f32 v45, v246, v247
v_cvt_pk_bf16_f32 v46, v28, v29
v_cvt_pk_bf16_f32 v47, v30, v31
v_accvgpr_read_b32 v28, a28
v_accvgpr_read_b32 v29, a29
v_accvgpr_read_b32 v30, a30
v_accvgpr_read_b32 v31, a31
v_cvt_pk_bf16_f32 v60, v252, v253
v_cvt_pk_bf16_f32 v61, v254, v255
v_cvt_pk_bf16_f32 v62, v28, v29
v_cvt_pk_bf16_f32 v63, v30, v31
Lk1_b:
v_and_b32 v24, 15, v0
v_lshlrev_b32 v24, 7, v24
v_bfe_u32 v25, v0, 1, 3
v_lshrrev_b32 v26, 4, v0
v_xor_b32 v25, v25, v26
v_lshl_add_u32 v10, v25, 4, v24
v_xor_b32 v11, 64, v10
v_add_u32 v12, 131072, v10
v_add_u32 v13, 131072, v11
v_bfe_u32 v24, v0, 2, 2
v_lshl_add_u32 v29, v26, 3, v24
v_mul_u32_u24 v25, 384, v29
v_and_b32 v27, 1, v0
v_lshl_add_u32 v25, v27, 3, v25
v_add_u32 v25, 36864, v25
v_lshrrev_b32 v24, 1, v29
v_and_b32 v24, 4, v24
v_and_or_b32 v24, v29, 2, v24
v_bfe_u32 v26, v0, 1, 1
s_mul_i32 s4, s20, 3
s_add_u32 s3, s4, 0
s_and_b32 s5, s3, 3
s_lshl_b32 s5, s5, 1
s_lshr_b32 s3, s3, 2
s_lshl_b32 s3, s3, 7
v_add_u32 v27, s5, v26
v_xor_b32 v27, v27, v24
v_lshl_add_u32 v27, v27, 4, v25
v_add_u32 v14, s3, v27
v_add_u32 v17, 61440, v14
s_add_u32 s3, s4, 1
s_and_b32 s5, s3, 3
s_lshl_b32 s5, s5, 1
s_lshr_b32 s3, s3, 2
s_lshl_b32 s3, s3, 7
v_add_u32 v27, s5, v26
v_xor_b32 v27, v27, v24
v_lshl_add_u32 v27, v27, 4, v25
v_add_u32 v15, s3, v27
v_add_u32 v18, 61440, v15
s_add_u32 s3, s4, 2
s_and_b32 s5, s3, 3
s_lshl_b32 s5, s5, 1
s_lshr_b32 s3, s3, 2
s_lshl_b32 s3, s3, 7
v_add_u32 v27, s5, v26
v_xor_b32 v27, v27, v24
v_lshl_add_u32 v27, v27, 4, v25
v_add_u32 v16, s3, v27
v_add_u32 v19, 61440, v16
s_waitcnt vmcnt(11)
s_barrier
ds_read_b64_tr_b16 a[176:177], v14 offset:28672
ds_read_b64_tr_b16 a[178:179], v14 offset:30208
ds_read_b64_tr_b16 a[184:185], v15 offset:28672
ds_read_b64_tr_b16 a[186:187], v15 offset:30208
ds_read_b64_tr_b16 a[192:193], v16 offset:28672
ds_read_b64_tr_b16 a[194:195], v16 offset:30208
ds_read_b64_tr_b16 a[180:181], v14 offset:40960
ds_read_b64_tr_b16 a[182:183], v14 offset:42496
ds_read_b64_tr_b16 a[188:189], v15 offset:40960
ds_read_b64_tr_b16 a[190:191], v15 offset:42496
ds_read_b64_tr_b16 a[196:197], v16 offset:40960
ds_read_b64_tr_b16 a[198:199], v16 offset:42496
ds_read_b128 a[224:227], v12 offset:0
ds_read_b128 a[228:231], v13 offset:0
ds_read_b128 a[232:235], v12 offset:2048
ds_read_b128 a[236:239], v13 offset:2048
ds_read_b128 a[240:243], v12 offset:4096
ds_read_b128 a[244:247], v13 offset:4096
s_waitcnt lgkmcnt(0)
s_barrier
M a[68:71], a[176:179], a[224:227], 0
ds_read_b128 a[248:251], v12 offset:6144
ds_read_b128 a[252:255], v13 offset:6144
M a[68:71], a[180:183], a[228:231], a[68:71]
s_sub_u32 s31, s31, 1
s_cmp_eq_u32 s31, 0
s_cselect_b32 s58, -1920, s57
s_add_u32 s23, s23, s58
s_add_u32 s24, s24, s58
M a[72:75], a[188:191], a[228:231], 0
ds_read_b64_tr_b16 a[200:201], v17 offset:0
ds_read_b64_tr_b16 a[202:203], v17 offset:1536
M a[72:75], a[184:187], a[224:227], a[72:75]
s_add_u32 m0, s30, 36864
s_nop 0
buffer_load_dwordx4 v6, s[12:15], s25 offen offset:0 lds
M a[76:79], a[192:195], a[224:227], 0
M a[76:79], a[196:199], a[228:231], a[76:79]
buffer_load_dwordx4 v7, s[12:15], s25 offen offset:1024 lds
M a[80:83], a[180:183], a[236:239], 0
ds_read_b128 a[224:227], v12 offset:8192
ds_read_b128 a[228:231], v13 offset:8192
M a[80:83], a[176:179], a[232:235], a[80:83]
M a[84:87], a[184:187], a[232:235], 0
ds_read_b64_tr_b16 a[208:209], v18 offset:0
ds_read_b64_tr_b16 a[210:211], v18 offset:1536
M a[84:87], a[188:191], a[236:239], a[84:87]
buffer_load_dwordx4 v8, s[12:15], s25 offen offset:2048 lds
M a[88:91], a[196:199], a[236:239], 0
M a[88:91], a[192:195], a[232:235], a[88:91]
buffer_load_dwordx4 v9, s[12:15], s25 offen offset:3072 lds
M a[92:95], a[176:179], a[240:243], 0
ds_read_b128 a[232:235], v12 offset:10240
ds_read_b128 a[236:239], v13 offset:10240
M a[92:95], a[180:183], a[244:247], a[92:95]
M a[96:99], a[188:191], a[244:247], 0
ds_read_b64_tr_b16 a[216:217], v19 offset:0
ds_read_b64_tr_b16 a[218:219], v19 offset:1536
M a[96:99], a[184:187], a[240:243], a[96:99]
s_add_u32 m0, s30, 40960
s_nop 0
buffer_load_dwordx4 v21, s[12:15], s25 offen offset:0 lds
M a[100:103], a[192:195], a[240:243], 0
buffer_load_dwordx4 v22, s[12:15], s25 offen offset:1024 lds
M a[100:103], a[196:199], a[244:247], a[100:103]
s_waitcnt lgkmcnt(10)
M a[104:107], a[180:183], a[252:255], 0
ds_read_b128 a[240:243], v12 offset:12288
ds_read_b128 a[244:247], v13 offset:12288
M a[104:107], a[176:179], a[248:251], a[104:107]
s_sub_u32 s54, s54, 1
s_cmp_eq_u32 s54, 0
s_cselect_b32 s58, s55, s56
s_add_u32 s25, s25, s58
M a[108:111], a[184:187], a[248:251], 0
ds_read_b64_tr_b16 a[204:205], v17 offset:12288
ds_read_b64_tr_b16 a[206:207], v17 offset:13824
M a[108:111], a[188:191], a[252:255], a[108:111]
M a[112:115], a[196:199], a[252:255], 0
s_add_u32 m0, s30, 65536
s_nop 0
buffer_load_dwordx4 v6, s[12:15], s25 offen offset:0 lds
M a[112:115], a[192:195], a[248:251], a[112:115]
s_waitcnt lgkmcnt(10)
M a[116:119], a[176:179], a[224:227], 0
ds_read_b128 a[248:251], v12 offset:14336
ds_read_b128 a[252:255], v13 offset:14336
M a[116:119], a[180:183], a[228:231], a[116:119]
buffer_load_dwordx4 v7, s[12:15], s25 offen offset:1024 lds
M a[120:123], a[188:191], a[228:231], 0
ds_read_b64_tr_b16 a[212:213], v18 offset:12288
ds_read_b64_tr_b16 a[214:215], v18 offset:13824
M a[120:123], a[184:187], a[224:227], a[120:123]
M a[124:127], a[192:195], a[224:227], 0
buffer_load_dwordx4 v8, s[12:15], s25 offen offset:2048 lds
M a[124:127], a[196:199], a[228:231], a[124:127]
buffer_load_dwordx4 v9, s[12:15], s25 offen offset:3072 lds
s_waitcnt lgkmcnt(10)
M a[128:131], a[180:183], a[236:239], 0
ds_read_b128 a[224:227], v12 offset:16384
ds_read_b128 a[228:231], v13 offset:16384
M a[128:131], a[176:179], a[232:235], a[128:131]
M a[132:135], a[184:187], a[232:235], 0
ds_read_b64_tr_b16 a[220:221], v19 offset:12288
ds_read_b64_tr_b16 a[222:223], v19 offset:13824
M a[132:135], a[188:191], a[236:239], a[132:135]
s_add_u32 m0, s30, 69632
s_nop 0
buffer_load_dwordx4 v21, s[12:15], s25 offen offset:0 lds
M a[136:139], a[196:199], a[236:239], 0
M a[136:139], a[192:195], a[232:235], a[136:139]
buffer_load_dwordx4 v22, s[12:15], s25 offen offset:1024 lds
s_waitcnt lgkmcnt(10)
M a[140:143], a[176:179], a[240:243], 0
M a[140:143], a[180:183], a[244:247], a[140:143]
s_sub_u32 s54, s54, 1
s_cmp_eq_u32 s54, 0
s_cselect_b32 s58, s55, s56
s_add_u32 s25, s25, s58
M a[144:147], a[188:191], a[244:247], 0
M a[144:147], a[184:187], a[240:243], a[144:147]
M a[148:151], a[192:195], a[240:243], 0
s_waitcnt vmcnt(6) lgkmcnt(0)
s_barrier
ds_read_b128 a[232:235], v10 offset:0
ds_read_b128 a[236:239], v11 offset:0
M a[148:151], a[196:199], a[244:247], a[148:151]
s_add_u32 m0, s28, 131072
s_nop 0
buffer_load_dword v20, s[8:11], s24 offen lds
M a[152:155], a[180:183], a[252:255], 0
ds_read_b128 a[240:243], v10 offset:2048
ds_read_b128 a[244:247], v11 offset:2048
M a[152:155], a[176:179], a[248:251], a[152:155]
M a[156:159], a[184:187], a[248:251], 0
buffer_load_dword v23, s[8:11], s24 offen offset:256 lds
M a[156:159], a[188:191], a[252:255], a[156:159]
M a[160:163], a[196:199], a[252:255], 0
M a[160:163], a[192:195], a[248:251], a[160:163]
s_add_u32 m0, s29, 133120
s_nop 0
buffer_load_dwordx4 v2, s[8:11], s23 offen offset:0 lds
M a[164:167], a[176:179], a[224:227], 0
ds_read_b128 a[248:251], v10 offset:4096
ds_read_b128 a[252:255], v11 offset:4096
M a[164:167], a[180:183], a[228:231], a[164:167]
M a[168:171], a[188:191], a[228:231], 0
M a[168:171], a[184:187], a[224:227], a[168:171]
buffer_load_dwordx4 v3, s[8:11], s23 offen offset:1024 lds
M a[172:175], a[192:195], a[224:227], 0
M a[172:175], a[196:199], a[228:231], a[172:175]
s_waitcnt lgkmcnt(4)
M a[68:71], a[200:203], a[232:235], a[68:71]
ds_read_b128 a[224:227], v10 offset:6144
ds_read_b128 a[228:231], v11 offset:6144
M a[68:71], a[204:207], a[236:239], a[68:71]
buffer_load_dwordx4 v4, s[8:11], s23 offen offset:2048 lds
M a[72:75], a[212:215], a[236:239], a[72:75]
ds_read_b64_tr_b16 a[176:177], v14 offset:0
ds_read_b64_tr_b16 a[178:179], v14 offset:1536
M a[72:75], a[208:211], a[232:235], a[72:75]
buffer_load_dwordx4 v5, s[8:11], s23 offen offset:3072 lds
M a[76:79], a[216:219], a[232:235], a[76:79]
M a[76:79], a[220:223], a[236:239], a[76:79]
s_sub_u32 s31, s31, 1
s_cmp_eq_u32 s31, 0
s_cselect_b32 s58, -1920, s57
s_add_u32 s23, s23, s58
s_add_u32 s24, s24, s58
s_waitcnt lgkmcnt(6)
M a[80:83], a[204:207], a[244:247], a[80:83]
ds_read_b128 a[232:235], v10 offset:8192
ds_read_b128 a[236:239], v11 offset:8192
M a[80:83], a[200:203], a[240:243], a[80:83]
M a[84:87], a[208:211], a[240:243], a[84:87]
ds_read_b64_tr_b16 a[184:185], v15 offset:0
ds_read_b64_tr_b16 a[186:187], v15 offset:1536
M a[84:87], a[212:215], a[244:247], a[84:87]
s_add_u32 m0, s30, 98304
s_nop 0
buffer_load_dwordx4 v6, s[12:15], s25 offen offset:0 lds
M a[88:91], a[220:223], a[244:247], a[88:91]
M a[88:91], a[216:219], a[240:243], a[88:91]
buffer_load_dwordx4 v7, s[12:15], s25 offen offset:1024 lds
s_waitcnt lgkmcnt(8)
M a[92:95], a[200:203], a[248:251], a[92:95]
ds_read_b128 a[240:243], v10 offset:10240
ds_read_b128 a[244:247], v11 offset:10240
M a[92:95], a[204:207], a[252:255], a[92:95]
M a[96:99], a[212:215], a[252:255], a[96:99]
ds_read_b64_tr_b16 a[192:193], v16 offset:0
ds_read_b64_tr_b16 a[194:195], v16 offset:1536
M a[96:99], a[208:211], a[248:251], a[96:99]
buffer_load_dwordx4 v8, s[12:15], s25 offen offset:2048 lds
M a[100:103], a[216:219], a[248:251], a[100:103]
M a[100:103], a[220:223], a[252:255], a[100:103]
buffer_load_dwordx4 v9, s[12:15], s25 offen offset:3072 lds
s_waitcnt lgkmcnt(10)
M a[104:107], a[204:207], a[228:231], a[104:107]
ds_read_b128 a[248:251], v10 offset:12288
ds_read_b128 a[252:255], v11 offset:12288
M a[104:107], a[200:203], a[224:227], a[104:107]
M a[108:111], a[208:211], a[224:227], a[108:111]
ds_read_b64_tr_b16 a[180:181], v14 offset:12288
ds_read_b64_tr_b16 a[182:183], v14 offset:13824
M a[108:111], a[212:215], a[228:231], a[108:111]
s_add_u32 m0, s30, 102400
s_nop 0
buffer_load_dwordx4 v21, s[12:15], s25 offen offset:0 lds
M a[112:115], a[220:223], a[228:231], a[112:115]
M a[112:115], a[216:219], a[224:227], a[112:115]
buffer_load_dwordx4 v22, s[12:15], s25 offen offset:1024 lds
s_waitcnt lgkmcnt(10)
M a[116:119], a[200:203], a[232:235], a[116:119]
ds_read_b128 a[224:227], v10 offset:14336
ds_read_b128 a[228:231], v11 offset:14336
M a[116:119], a[204:207], a[236:239], a[116:119]
M a[120:123], a[212:215], a[236:239], a[120:123]
ds_read_b64_tr_b16 a[188:189], v15 offset:12288
ds_read_b64_tr_b16 a[190:191], v15 offset:13824
M a[120:123], a[208:211], a[232:235], a[120:123]
s_sub_u32 s54, s54, 1
s_cmp_eq_u32 s54, 0
s_cselect_b32 s58, s55, s56
s_add_u32 s25, s25, s58
M a[124:127], a[216:219], a[232:235], a[124:127]
M a[124:127], a[220:223], a[236:239], a[124:127]
s_add_u32 s94, s92, 12288
buffer_store_dwordx4 v[144:147], v1, s[16:19], s94 offen offset:2048 sc1
s_waitcnt lgkmcnt(10)
M a[128:131], a[204:207], a[244:247], a[128:131]
ds_read_b128 a[232:235], v10 offset:16384
ds_read_b128 a[236:239], v11 offset:16384
M a[128:131], a[200:203], a[240:243], a[128:131]
M a[132:135], a[208:211], a[240:243], a[132:135]
ds_read_b64_tr_b16 a[196:197], v16 offset:12288
ds_read_b64_tr_b16 a[198:199], v16 offset:13824
M a[132:135], a[212:215], a[244:247], a[132:135]
s_add_u32 s94, s92, 12288
buffer_store_dwordx4 v[152:155], v1, s[16:19], s94 offen offset:3072 sc1
M a[136:139], a[220:223], a[244:247], a[136:139]
M a[136:139], a[216:219], a[240:243], a[136:139]
s_add_u32 s94, s93, 0
buffer_store_dwordx4 v[160:163], v1, s[16:19], s94 offen offset:0 sc1
s_waitcnt lgkmcnt(10)
M a[140:143], a[200:203], a[248:251], a[140:143]
M a[140:143], a[204:207], a[252:255], a[140:143]
s_add_u32 s94, s93, 0
buffer_store_dwordx4 v[168:171], v1, s[16:19], s94 offen offset:1024 sc1
M a[144:147], a[212:215], a[252:255], a[144:147]
M a[144:147], a[208:211], a[248:251], a[144:147]
M a[148:151], a[216:219], a[248:251], a[148:151]
s_waitcnt vmcnt(16) lgkmcnt(0)
s_barrier
ds_read_b128 a[240:243], v10 offset:18432
ds_read_b128 a[244:247], v11 offset:18432
M a[148:151], a[220:223], a[252:255], a[148:151]
s_add_u32 m0, s28, 0
s_nop 0
buffer_load_dword v20, s[8:11], s24 offen lds
M a[152:155], a[204:207], a[228:231], a[152:155]
ds_read_b128 a[248:251], v10 offset:20480
ds_read_b128 a[252:255], v11 offset:20480
M a[152:155], a[200:203], a[224:227], a[152:155]
M a[156:159], a[208:211], a[224:227], a[156:159]
buffer_load_dword v23, s[8:11], s24 offen offset:256 lds
M a[156:159], a[212:215], a[228:231], a[156:159]
M a[160:163], a[220:223], a[228:231], a[160:163]
M a[160:163], a[216:219], a[224:227], a[160:163]
s_add_u32 m0, s29, 2048
s_nop 0
buffer_load_dwordx4 v2, s[8:11], s23 offen offset:0 lds
M a[164:167], a[200:203], a[232:235], a[164:167]
ds_read_b128 a[224:227], v10 offset:22528
ds_read_b128 a[228:231], v11 offset:22528
M a[164:167], a[204:207], a[236:239], a[164:167]
M a[168:171], a[212:215], a[236:239], a[168:171]
M a[168:171], a[208:211], a[232:235], a[168:171]
buffer_load_dwordx4 v3, s[8:11], s23 offen offset:1024 lds
M a[172:175], a[216:219], a[232:235], a[172:175]
M a[172:175], a[220:223], a[236:239], a[172:175]
s_waitcnt lgkmcnt(4)
M a[68:71], a[176:179], a[240:243], a[68:71]
ds_read_b128 a[232:235], v10 offset:24576
ds_read_b128 a[236:239], v11 offset:24576
M a[68:71], a[180:183], a[244:247], a[68:71]
buffer_load_dwordx4 v4, s[8:11], s23 offen offset:2048 lds
M a[72:75], a[188:191], a[244:247], a[72:75]
ds_read_b64_tr_b16 a[200:201], v14 offset:28672
ds_read_b64_tr_b16 a[202:203], v14 offset:30208
M a[72:75], a[184:187], a[240:243], a[72:75]
buffer_load_dwordx4 v5, s[8:11], s23 offen offset:3072 lds
M a[76:79], a[192:195], a[240:243], a[76:79]
M a[76:79], a[196:199], a[244:247], a[76:79]
s_sub_u32 s31, s31, 1
s_cmp_eq_u32 s31, 0
s_cselect_b32 s58, -1920, s57
s_add_u32 s23, s23, s58
s_add_u32 s24, s24, s58
s_waitcnt lgkmcnt(6)
M a[80:83], a[180:183], a[252:255], a[80:83]
ds_read_b128 a[240:243], v10 offset:26624
ds_read_b128 a[244:247], v11 offset:26624
M a[80:83], a[176:179], a[248:251], a[80:83]
M a[84:87], a[184:187], a[248:251], a[84:87]
ds_read_b64_tr_b16 a[208:209], v15 offset:28672
ds_read_b64_tr_b16 a[210:211], v15 offset:30208
M a[84:87], a[188:191], a[252:255], a[84:87]
s_add_u32 m0, s30, 36864
s_nop 0
buffer_load_dwordx4 v6, s[12:15], s25 offen offset:0 lds
M a[88:91], a[196:199], a[252:255], a[88:91]
M a[88:91], a[192:195], a[248:251], a[88:91]
buffer_load_dwordx4 v7, s[12:15], s25 offen offset:1024 lds
s_waitcnt lgkmcnt(8)
M a[92:95], a[176:179], a[224:227], a[92:95]
ds_read_b128 a[248:251], v10 offset:28672
ds_read_b128 a[252:255], v11 offset:28672
M a[92:95], a[180:183], a[228:231], a[92:95]
M a[96:99], a[188:191], a[228:231], a[96:99]
ds_read_b64_tr_b16 a[216:217], v16 offset:28672
ds_read_b64_tr_b16 a[218:219], v16 offset:30208
M a[96:99], a[184:187], a[224:227], a[96:99]
buffer_load_dwordx4 v8, s[12:15], s25 offen offset:2048 lds
M a[100:103], a[192:195], a[224:227], a[100:103]
M a[100:103], a[196:199], a[228:231], a[100:103]
buffer_load_dwordx4 v9, s[12:15], s25 offen offset:3072 lds
s_waitcnt lgkmcnt(10)
M a[104:107], a[180:183], a[236:239], a[104:107]
ds_read_b128 a[224:227], v10 offset:30720
ds_read_b128 a[228:231], v11 offset:30720
M a[104:107], a[176:179], a[232:235], a[104:107]
M a[108:111], a[184:187], a[232:235], a[108:111]
ds_read_b64_tr_b16 a[204:205], v14 offset:40960
ds_read_b64_tr_b16 a[206:207], v14 offset:42496
M a[108:111], a[188:191], a[236:239], a[108:111]
s_add_u32 m0, s30, 40960
s_nop 0
buffer_load_dwordx4 v21, s[12:15], s25 offen offset:0 lds
M a[112:115], a[196:199], a[236:239], a[112:115]
M a[112:115], a[192:195], a[232:235], a[112:115]
buffer_load_dwordx4 v22, s[12:15], s25 offen offset:1024 lds
s_waitcnt lgkmcnt(10)
M a[116:119], a[176:179], a[240:243], a[116:119]
ds_read_b128 a[232:235], v10 offset:32768
ds_read_b128 a[236:239], v11 offset:32768
M a[116:119], a[180:183], a[244:247], a[116:119]
M a[120:123], a[188:191], a[244:247], a[120:123]
ds_read_b64_tr_b16 a[212:213], v15 offset:40960
ds_read_b64_tr_b16 a[214:215], v15 offset:42496
M a[120:123], a[184:187], a[240:243], a[120:123]
s_sub_u32 s54, s54, 1
s_cmp_eq_u32 s54, 0
s_cselect_b32 s58, s55, s56
s_add_u32 s25, s25, s58
M a[124:127], a[192:195], a[240:243], a[124:127]
M a[124:127], a[196:199], a[244:247], a[124:127]
s_add_u32 s94, s93, 0
buffer_store_dwordx4 v[176:179], v1, s[16:19], s94 offen offset:2048 sc1
s_waitcnt lgkmcnt(10)
M a[128:131], a[180:183], a[252:255], a[128:131]
ds_read_b128 a[240:243], v10 offset:34816
ds_read_b128 a[244:247], v11 offset:34816
M a[128:131], a[176:179], a[248:251], a[128:131]
M a[132:135], a[184:187], a[248:251], a[132:135]
ds_read_b64_tr_b16 a[220:221], v16 offset:40960
ds_read_b64_tr_b16 a[222:223], v16 offset:42496
M a[132:135], a[188:191], a[252:255], a[132:135]
s_add_u32 s94, s93, 0
buffer_store_dwordx4 v[184:187], v1, s[16:19], s94 offen offset:3072 sc1
M a[136:139], a[196:199], a[252:255], a[136:139]
M a[136:139], a[192:195], a[248:251], a[136:139]
s_add_u32 s94, s93, 4096
buffer_store_dwordx4 v[192:195], v1, s[16:19], s94 offen offset:0 sc1
s_waitcnt lgkmcnt(10)
M a[140:143], a[176:179], a[224:227], a[140:143]
M a[140:143], a[180:183], a[228:231], a[140:143]
s_add_u32 s94, s93, 4096
buffer_store_dwordx4 v[200:203], v1, s[16:19], s94 offen offset:1024 sc1
M a[144:147], a[188:191], a[228:231], a[144:147]
M a[144:147], a[184:187], a[224:227], a[144:147]
M a[148:151], a[192:195], a[224:227], a[148:151]
s_waitcnt vmcnt(20) lgkmcnt(0)
s_barrier
ds_read_b128 a[248:251], v12 offset:0
ds_read_b128 a[252:255], v13 offset:0
M a[148:151], a[196:199], a[228:231], a[148:151]
s_add_u32 m0, s28, 18432
s_nop 0
buffer_load_dword v20, s[8:11], s24 offen lds
M a[152:155], a[180:183], a[236:239], a[152:155]
ds_read_b128 a[224:227], v12 offset:2048
ds_read_b128 a[228:231], v13 offset:2048
M a[152:155], a[176:179], a[232:235], a[152:155]
M a[156:159], a[184:187], a[232:235], a[156:159]
buffer_load_dword v23, s[8:11], s24 offen offset:256 lds
M a[156:159], a[188:191], a[236:239], a[156:159]
M a[160:163], a[196:199], a[236:239], a[160:163]
M a[160:163], a[192:195], a[232:235], a[160:163]
s_add_u32 m0, s29, 20480
s_nop 0
buffer_load_dwordx4 v2, s[8:11], s23 offen offset:0 lds
M a[164:167], a[176:179], a[240:243], a[164:167]
ds_read_b128 a[232:235], v12 offset:4096
ds_read_b128 a[236:239], v13 offset:4096
M a[164:167], a[180:183], a[244:247], a[164:167]
M a[168:171], a[188:191], a[244:247], a[168:171]
M a[168:171], a[184:187], a[240:243], a[168:171]
buffer_load_dwordx4 v3, s[8:11], s23 offen offset:1024 lds
M a[172:175], a[192:195], a[240:243], a[172:175]
M a[172:175], a[196:199], a[244:247], a[172:175]
s_waitcnt lgkmcnt(4)
M a[68:71], a[200:203], a[248:251], a[68:71]
ds_read_b128 a[240:243], v12 offset:6144
ds_read_b128 a[244:247], v13 offset:6144
M a[68:71], a[204:207], a[252:255], a[68:71]
buffer_load_dwordx4 v4, s[8:11], s23 offen offset:2048 lds
M a[72:75], a[212:215], a[252:255], a[72:75]
ds_read_b64_tr_b16 a[176:177], v17 offset:0
ds_read_b64_tr_b16 a[178:179], v17 offset:1536
M a[72:75], a[208:211], a[248:251], a[72:75]
buffer_load_dwordx4 v5, s[8:11], s23 offen offset:3072 lds
M a[76:79], a[216:219], a[248:251], a[76:79]
M a[76:79], a[220:223], a[252:255], a[76:79]
s_sub_u32 s31, s31, 1
s_cmp_eq_u32 s31, 0
s_cselect_b32 s58, -1920, s57
s_add_u32 s23, s23, s58
s_add_u32 s24, s24, s58
s_waitcnt lgkmcnt(6)
M a[80:83], a[204:207], a[228:231], a[80:83]
ds_read_b128 a[248:251], v12 offset:8192
ds_read_b128 a[252:255], v13 offset:8192
M a[80:83], a[200:203], a[224:227], a[80:83]
M a[84:87], a[208:211], a[224:227], a[84:87]
ds_read_b64_tr_b16 a[184:185], v18 offset:0
ds_read_b64_tr_b16 a[186:187], v18 offset:1536
M a[84:87], a[212:215], a[228:231], a[84:87]
s_add_u32 m0, s30, 65536
s_nop 0
buffer_load_dwordx4 v6, s[12:15], s25 offen offset:0 lds
M a[88:91], a[220:223], a[228:231], a[88:91]
M a[88:91], a[216:219], a[224:227], a[88:91]
buffer_load_dwordx4 v7, s[12:15], s25 offen offset:1024 lds
s_waitcnt lgkmcnt(8)
M a[92:95], a[200:203], a[232:235], a[92:95]
ds_read_b128 a[224:227], v12 offset:10240
ds_read_b128 a[228:231], v13 offset:10240
M a[92:95], a[204:207], a[236:239], a[92:95]
M a[96:99], a[212:215], a[236:239], a[96:99]
ds_read_b64_tr_b16 a[192:193], v19 offset:0
ds_read_b64_tr_b16 a[194:195], v19 offset:1536
M a[96:99], a[208:211], a[232:235], a[96:99]
buffer_load_dwordx4 v8, s[12:15], s25 offen offset:2048 lds
M a[100:103], a[216:219], a[232:235], a[100:103]
M a[100:103], a[220:223], a[236:239], a[100:103]
buffer_load_dwordx4 v9, s[12:15], s25 offen offset:3072 lds
s_waitcnt lgkmcnt(10)
M a[104:107], a[204:207], a[244:247], a[104:107]
ds_read_b128 a[232:235], v12 offset:12288
ds_read_b128 a[236:239], v13 offset:12288
M a[104:107], a[200:203], a[240:243], a[104:107]
M a[108:111], a[208:211], a[240:243], a[108:111]
ds_read_b64_tr_b16 a[180:181], v17 offset:12288
ds_read_b64_tr_b16 a[182:183], v17 offset:13824
M a[108:111], a[212:215], a[244:247], a[108:111]
s_add_u32 m0, s30, 69632
s_nop 0
buffer_load_dwordx4 v21, s[12:15], s25 offen offset:0 lds
M a[112:115], a[220:223], a[244:247], a[112:115]
M a[112:115], a[216:219], a[240:243], a[112:115]
buffer_load_dwordx4 v22, s[12:15], s25 offen offset:1024 lds
s_waitcnt lgkmcnt(10)
M a[116:119], a[200:203], a[248:251], a[116:119]
ds_read_b128 a[240:243], v12 offset:14336
ds_read_b128 a[244:247], v13 offset:14336
M a[116:119], a[204:207], a[252:255], a[116:119]
M a[120:123], a[212:215], a[252:255], a[120:123]
ds_read_b64_tr_b16 a[188:189], v18 offset:12288
ds_read_b64_tr_b16 a[190:191], v18 offset:13824
M a[120:123], a[208:211], a[248:251], a[120:123]
s_sub_u32 s54, s54, 1
s_cmp_eq_u32 s54, 0
s_cselect_b32 s58, s55, s56
s_add_u32 s25, s25, s58
M a[124:127], a[216:219], a[248:251], a[124:127]
M a[124:127], a[220:223], a[252:255], a[124:127]
s_add_u32 s94, s93, 4096
buffer_store_dwordx4 v[208:211], v1, s[16:19], s94 offen offset:2048 sc1
s_waitcnt lgkmcnt(10)
M a[128:131], a[204:207], a[228:231], a[128:131]
ds_read_b128 a[248:251], v12 offset:16384
ds_read_b128 a[252:255], v13 offset:16384
M a[128:131], a[200:203], a[224:227], a[128:131]
M a[132:135], a[208:211], a[224:227], a[132:135]
ds_read_b64_tr_b16 a[196:197], v19 offset:12288
ds_read_b64_tr_b16 a[198:199], v19 offset:13824
M a[132:135], a[212:215], a[228:231], a[132:135]
s_add_u32 s94, s93, 4096
buffer_store_dwordx4 v[216:219], v1, s[16:19], s94 offen offset:3072 sc1
M a[136:139], a[220:223], a[228:231], a[136:139]
M a[136:139], a[216:219], a[224:227], a[136:139]
s_add_u32 s94, s93, 8192
buffer_store_dwordx4 v[224:227], v1, s[16:19], s94 offen offset:0 sc1
s_waitcnt lgkmcnt(10)
M a[140:143], a[200:203], a[232:235], a[140:143]
M a[140:143], a[204:207], a[236:239], a[140:143]
s_add_u32 s94, s93, 8192
buffer_store_dwordx4 v[232:235], v1, s[16:19], s94 offen offset:1024 sc1
M a[144:147], a[212:215], a[236:239], a[144:147]
M a[144:147], a[208:211], a[232:235], a[144:147]
M a[148:151], a[216:219], a[232:235], a[148:151]
s_waitcnt vmcnt(20) lgkmcnt(0)
s_barrier
ds_read_b128 a[224:227], v10 offset:0
ds_read_b128 a[228:231], v11 offset:0
M a[148:151], a[220:223], a[236:239], a[148:151]
s_add_u32 m0, s28, 131072
s_nop 0
buffer_load_dword v20, s[8:11], s24 offen lds
M a[152:155], a[204:207], a[244:247], a[152:155]
ds_read_b128 a[232:235], v10 offset:2048
ds_read_b128 a[236:239], v11 offset:2048
M a[152:155], a[200:203], a[240:243], a[152:155]
M a[156:159], a[208:211], a[240:243], a[156:159]
buffer_load_dword v23, s[8:11], s24 offen offset:256 lds
M a[156:159], a[212:215], a[244:247], a[156:159]
M a[160:163], a[220:223], a[244:247], a[160:163]
M a[160:163], a[216:219], a[240:243], a[160:163]
s_add_u32 m0, s29, 133120
s_nop 0
buffer_load_dwordx4 v2, s[8:11], s23 offen offset:0 lds
M a[164:167], a[200:203], a[248:251], a[164:167]
ds_read_b128 a[240:243], v10 offset:4096
ds_read_b128 a[244:247], v11 offset:4096
M a[164:167], a[204:207], a[252:255], a[164:167]
M a[168:171], a[212:215], a[252:255], a[168:171]
M a[168:171], a[208:211], a[248:251], a[168:171]
buffer_load_dwordx4 v3, s[8:11], s23 offen offset:1024 lds
M a[172:175], a[216:219], a[248:251], a[172:175]
M a[172:175], a[220:223], a[252:255], a[172:175]
s_waitcnt lgkmcnt(4)
M a[68:71], a[176:179], a[224:227], a[68:71]
ds_read_b128 a[248:251], v10 offset:6144
ds_read_b128 a[252:255], v11 offset:6144
M a[68:71], a[180:183], a[228:231], a[68:71]
buffer_load_dwordx4 v4, s[8:11], s23 offen offset:2048 lds
M a[72:75], a[188:191], a[228:231], a[72:75]
ds_read_b64_tr_b16 a[200:201], v14 offset:0
ds_read_b64_tr_b16 a[202:203], v14 offset:1536
M a[72:75], a[184:187], a[224:227], a[72:75]
buffer_load_dwordx4 v5, s[8:11], s23 offen offset:3072 lds
M a[76:79], a[192:195], a[224:227], a[76:79]
M a[76:79], a[196:199], a[228:231], a[76:79]
s_sub_u32 s31, s31, 1
s_cmp_eq_u32 s31, 0
s_cselect_b32 s58, -1920, s57
s_add_u32 s23, s23, s58
s_add_u32 s24, s24, s58
s_waitcnt lgkmcnt(6)
M a[80:83], a[180:183], a[236:239], a[80:83]
ds_read_b128 a[224:227], v10 offset:8192
ds_read_b128 a[228:231], v11 offset:8192
M a[80:83], a[176:179], a[232:235], a[80:83]
M a[84:87], a[184:187], a[232:235], a[84:87]
ds_read_b64_tr_b16 a[208:209], v15 offset:0
ds_read_b64_tr_b16 a[210:211], v15 offset:1536
M a[84:87], a[188:191], a[236:239], a[84:87]
s_add_u32 m0, s30, 98304
s_nop 0
buffer_load_dwordx4 v6, s[12:15], s25 offen offset:0 lds
M a[88:91], a[196:199], a[236:239], a[88:91]
M a[88:91], a[192:195], a[232:235], a[88:91]
buffer_load_dwordx4 v7, s[12:15], s25 offen offset:1024 lds
s_waitcnt lgkmcnt(8)
M a[92:95], a[176:179], a[240:243], a[92:95]
ds_read_b128 a[232:235], v10 offset:10240
ds_read_b128 a[236:239], v11 offset:10240
M a[92:95], a[180:183], a[244:247], a[92:95]
M a[96:99], a[188:191], a[244:247], a[96:99]
ds_read_b64_tr_b16 a[216:217], v16 offset:0
ds_read_b64_tr_b16 a[218:219], v16 offset:1536
M a[96:99], a[184:187], a[240:243], a[96:99]
buffer_load_dwordx4 v8, s[12:15], s25 offen offset:2048 lds
M a[100:103], a[192:195], a[240:243], a[100:103]
M a[100:103], a[196:199], a[244:247], a[100:103]
buffer_load_dwordx4 v9, s[12:15], s25 offen offset:3072 lds
s_waitcnt lgkmcnt(10)
M a[104:107], a[180:183], a[252:255], a[104:107]
ds_read_b128 a[240:243], v10 offset:12288
ds_read_b128 a[244:247], v11 offset:12288
M a[104:107], a[176:179], a[248:251], a[104:107]
M a[108:111], a[184:187], a[248:251], a[108:111]
ds_read_b64_tr_b16 a[204:205], v14 offset:12288
ds_read_b64_tr_b16 a[206:207], v14 offset:13824
M a[108:111], a[188:191], a[252:255], a[108:111]
s_add_u32 m0, s30, 102400
s_nop 0
buffer_load_dwordx4 v21, s[12:15], s25 offen offset:0 lds
M a[112:115], a[196:199], a[252:255], a[112:115]
M a[112:115], a[192:195], a[248:251], a[112:115]
buffer_load_dwordx4 v22, s[12:15], s25 offen offset:1024 lds
s_waitcnt lgkmcnt(10)
M a[116:119], a[176:179], a[224:227], a[116:119]
ds_read_b128 a[248:251], v10 offset:14336
ds_read_b128 a[252:255], v11 offset:14336
M a[116:119], a[180:183], a[228:231], a[116:119]
M a[120:123], a[188:191], a[228:231], a[120:123]
ds_read_b64_tr_b16 a[212:213], v15 offset:12288
ds_read_b64_tr_b16 a[214:215], v15 offset:13824
M a[120:123], a[184:187], a[224:227], a[120:123]
s_sub_u32 s54, s54, 1
s_cmp_eq_u32 s54, 0
s_cselect_b32 s58, s55, s56
s_add_u32 s25, s25, s58
M a[124:127], a[192:195], a[224:227], a[124:127]
M a[124:127], a[196:199], a[228:231], a[124:127]
s_add_u32 s94, s93, 8192
buffer_store_dwordx4 v[240:243], v1, s[16:19], s94 offen offset:2048 sc1
s_waitcnt lgkmcnt(10)
M a[128:131], a[180:183], a[236:239], a[128:131]
ds_read_b128 a[224:227], v10 offset:16384
ds_read_b128 a[228:231], v11 offset:16384
M a[128:131], a[176:179], a[232:235], a[128:131]
M a[132:135], a[184:187], a[232:235], a[132:135]
ds_read_b64_tr_b16 a[220:221], v16 offset:12288
ds_read_b64_tr_b16 a[222:223], v16 offset:13824
M a[132:135], a[188:191], a[236:239], a[132:135]
s_add_u32 s94, s93, 8192
buffer_store_dwordx4 v[248:251], v1, s[16:19], s94 offen offset:3072 sc1
M a[136:139], a[196:199], a[236:239], a[136:139]
M a[136:139], a[192:195], a[232:235], a[136:139]
s_add_u32 s94, s93, 12288
buffer_store_dwordx4 v[36:39], v1, s[16:19], s94 offen offset:0 sc1
s_waitcnt lgkmcnt(10)
M a[140:143], a[176:179], a[240:243], a[140:143]
M a[140:143], a[180:183], a[244:247], a[140:143]
s_add_u32 s94, s93, 12288
buffer_store_dwordx4 v[44:47], v1, s[16:19], s94 offen offset:1024 sc1
M a[144:147], a[188:191], a[244:247], a[144:147]
M a[144:147], a[184:187], a[240:243], a[144:147]
M a[148:151], a[192:195], a[240:243], a[148:151]
s_waitcnt vmcnt(20) lgkmcnt(0)
s_barrier
ds_read_b128 a[232:235], v10 offset:18432
ds_read_b128 a[236:239], v11 offset:18432
M a[148:151], a[196:199], a[244:247], a[148:151]
s_add_u32 m0, s28, 0
s_nop 0
buffer_load_dword v20, s[8:11], s24 offen lds
M a[152:155], a[180:183], a[252:255], a[152:155]
ds_read_b128 a[240:243], v10 offset:20480
ds_read_b128 a[244:247], v11 offset:20480
M a[152:155], a[176:179], a[248:251], a[152:155]
M a[156:159], a[184:187], a[248:251], a[156:159]
buffer_load_dword v23, s[8:11], s24 offen offset:256 lds
M a[156:159], a[188:191], a[252:255], a[156:159]
M a[160:163], a[196:199], a[252:255], a[160:163]
M a[160:163], a[192:195], a[248:251], a[160:163]
s_add_u32 m0, s29, 2048
s_nop 0
buffer_load_dwordx4 v2, s[8:11], s23 offen offset:0 lds
M a[164:167], a[176:179], a[224:227], a[164:167]
ds_read_b128 a[248:251], v10 offset:22528
ds_read_b128 a[252:255], v11 offset:22528
M a[164:167], a[180:183], a[228:231], a[164:167]
M a[168:171], a[188:191], a[228:231], a[168:171]
M a[168:171], a[184:187], a[224:227], a[168:171]
buffer_load_dwordx4 v3, s[8:11], s23 offen offset:1024 lds
M a[172:175], a[192:195], a[224:227], a[172:175]
M a[172:175], a[196:199], a[228:231], a[172:175]
s_waitcnt lgkmcnt(4)
M a[68:71], a[200:203], a[232:235], a[68:71]
ds_read_b128 a[224:227], v10 offset:24576
ds_read_b128 a[228:231], v11 offset:24576
M a[68:71], a[204:207], a[236:239], a[68:71]
buffer_load_dwordx4 v4, s[8:11], s23 offen offset:2048 lds
M a[72:75], a[212:215], a[236:239], a[72:75]
ds_read_b64_tr_b16 a[176:177], v14 offset:28672
ds_read_b64_tr_b16 a[178:179], v14 offset:30208
M a[72:75], a[208:211], a[232:235], a[72:75]
M a[76:79], a[216:219], a[232:235], a[76:79]
buffer_load_dwordx4 v5, s[8:11], s23 offen offset:3072 lds
M a[76:79], a[220:223], a[236:239], a[76:79]
s_waitcnt lgkmcnt(6)
M a[80:83], a[204:207], a[244:247], a[80:83]
ds_read_b128 a[232:235], v10 offset:26624
ds_read_b128 a[236:239], v11 offset:26624
M a[80:83], a[200:203], a[240:243], a[80:83]
s_sub_u32 s31, s31, 1
s_cmp_eq_u32 s31, 0
s_cselect_b32 s58, -1920, s57
s_add_u32 s23, s23, s58
s_add_u32 s24, s24, s58
M a[84:87], a[208:211], a[240:243], a[84:87]
ds_read_b64_tr_b16 a[184:185], v15 offset:28672
ds_read_b64_tr_b16 a[186:187], v15 offset:30208
M a[84:87], a[212:215], a[244:247], a[84:87]
M a[88:91], a[220:223], a[244:247], a[88:91]
s_add_u32 m0, s30, 36864
s_nop 0
buffer_load_dwordx4 v6, s[12:15], s25 offen offset:0 lds
M a[88:91], a[216:219], a[240:243], a[88:91]
s_waitcnt lgkmcnt(8)
M a[92:95], a[200:203], a[248:251], a[92:95]
ds_read_b128 a[240:243], v10 offset:28672
ds_read_b128 a[244:247], v11 offset:28672
M a[92:95], a[204:207], a[252:255], a[92:95]
M a[96:99], a[212:215], a[252:255], a[96:99]
ds_read_b64_tr_b16 a[192:193], v16 offset:28672
ds_read_b64_tr_b16 a[194:195], v16 offset:30208
M a[96:99], a[208:211], a[248:251], a[96:99]
buffer_load_dwordx4 v7, s[12:15], s25 offen offset:1024 lds
M a[100:103], a[216:219], a[248:251], a[100:103]
M a[100:103], a[220:223], a[252:255], a[100:103]
buffer_load_dwordx4 v8, s[12:15], s25 offen offset:2048 lds
s_waitcnt lgkmcnt(10)
M a[104:107], a[204:207], a[228:231], a[104:107]
ds_read_b128 a[248:251], v10 offset:30720
ds_read_b128 a[252:255], v11 offset:30720
M a[104:107], a[200:203], a[224:227], a[104:107]
M a[108:111], a[208:211], a[224:227], a[108:111]
ds_read_b64_tr_b16 a[180:181], v14 offset:40960
ds_read_b64_tr_b16 a[182:183], v14 offset:42496
M a[108:111], a[212:215], a[228:231], a[108:111]
buffer_load_dwordx4 v9, s[12:15], s25 offen offset:3072 lds
M a[112:115], a[220:223], a[228:231], a[112:115]
M a[112:115], a[216:219], a[224:227], a[112:115]
s_add_u32 m0, s30, 40960
s_nop 0
buffer_load_dwordx4 v21, s[12:15], s25 offen offset:0 lds
s_waitcnt lgkmcnt(10)
M a[116:119], a[200:203], a[232:235], a[116:119]
ds_read_b128 a[224:227], v10 offset:32768
ds_read_b128 a[228:231], v11 offset:32768
M a[116:119], a[204:207], a[236:239], a[116:119]
M a[120:123], a[212:215], a[236:239], a[120:123]
ds_read_b64_tr_b16 a[188:189], v15 offset:40960
ds_read_b64_tr_b16 a[190:191], v15 offset:42496
M a[120:123], a[208:211], a[232:235], a[120:123]
M a[124:127], a[216:219], a[232:235], a[124:127]
buffer_load_dwordx4 v22, s[12:15], s25 offen offset:1024 lds
M a[124:127], a[220:223], a[236:239], a[124:127]
s_waitcnt lgkmcnt(10)
M a[128:131], a[204:207], a[244:247], a[128:131]
ds_read_b128 a[232:235], v10 offset:34816
ds_read_b128 a[236:239], v11 offset:34816
M a[128:131], a[200:203], a[240:243], a[128:131]
s_sub_u32 s54, s54, 1
s_cmp_eq_u32 s54, 0
s_cselect_b32 s58, s55, s56
s_add_u32 s25, s25, s58
M a[132:135], a[208:211], a[240:243], a[132:135]
ds_read_b64_tr_b16 a[196:197], v16 offset:40960
ds_read_b64_tr_b16 a[198:199], v16 offset:42496
M a[132:135], a[212:215], a[244:247], a[132:135]
M a[136:139], a[220:223], a[244:247], a[136:139]
s_add_u32 s94, s93, 12288
buffer_store_dwordx4 v[52:55], v1, s[16:19], s94 offen offset:2048 sc1
M a[136:139], a[216:219], a[240:243], a[136:139]
s_waitcnt lgkmcnt(10)
M a[140:143], a[200:203], a[248:251], a[140:143]
s_add_u32 s94, s93, 12288
buffer_store_dwordx4 v[60:63], v1, s[16:19], s94 offen offset:3072 sc1
M a[140:143], a[204:207], a[252:255], a[140:143]
M a[144:147], a[212:215], a[252:255], a[144:147]
M a[144:147], a[208:211], a[248:251], a[144:147]
M a[148:151], a[216:219], a[248:251], a[148:151]
s_waitcnt vmcnt(18) lgkmcnt(0)
s_barrier
ds_read_b128 a[240:243], v12 offset:0
ds_read_b128 a[244:247], v13 offset:0
M a[148:151], a[220:223], a[252:255], a[148:151]
s_add_u32 m0, s28, 18432
s_nop 0
buffer_load_dword v20, s[8:11], s24 offen lds
M a[152:155], a[204:207], a[228:231], a[152:155]
ds_read_b128 a[248:251], v12 offset:2048
ds_read_b128 a[252:255], v13 offset:2048
M a[152:155], a[200:203], a[224:227], a[152:155]
M a[156:159], a[208:211], a[224:227], a[156:159]
buffer_load_dword v23, s[8:11], s24 offen offset:256 lds
M a[156:159], a[212:215], a[228:231], a[156:159]
M a[160:163], a[220:223], a[228:231], a[160:163]
M a[160:163], a[216:219], a[224:227], a[160:163]
s_add_u32 m0, s29, 20480
s_nop 0
buffer_load_dwordx4 v2, s[8:11], s23 offen offset:0 lds
M a[164:167], a[200:203], a[232:235], a[164:167]
ds_read_b128 a[224:227], v12 offset:4096
ds_read_b128 a[228:231], v13 offset:4096
M a[164:167], a[204:207], a[236:239], a[164:167]
M a[168:171], a[212:215], a[236:239], a[168:171]
M a[168:171], a[208:211], a[232:235], a[168:171]
buffer_load_dwordx4 v3, s[8:11], s23 offen offset:1024 lds
M a[172:175], a[216:219], a[232:235], a[172:175]
M a[172:175], a[220:223], a[236:239], a[172:175]
s_waitcnt lgkmcnt(4)
M a[68:71], a[176:179], a[240:243], a[68:71]
ds_read_b128 a[232:235], v12 offset:6144
ds_read_b128 a[236:239], v13 offset:6144
M a[68:71], a[180:183], a[244:247], a[68:71]
buffer_load_dwordx4 v4, s[8:11], s23 offen offset:2048 lds
M a[72:75], a[188:191], a[244:247], a[72:75]
ds_read_b64_tr_b16 a[200:201], v17 offset:0
ds_read_b64_tr_b16 a[202:203], v17 offset:1536
M a[72:75], a[184:187], a[240:243], a[72:75]
M a[76:79], a[192:195], a[240:243], a[76:79]
buffer_load_dwordx4 v5, s[8:11], s23 offen offset:3072 lds
M a[76:79], a[196:199], a[244:247], a[76:79]
s_waitcnt lgkmcnt(6)
M a[80:83], a[180:183], a[252:255], a[80:83]
ds_read_b128 a[240:243], v12 offset:8192
ds_read_b128 a[244:247], v13 offset:8192
M a[80:83], a[176:179], a[248:251], a[80:83]
M a[84:87], a[184:187], a[248:251], a[84:87]
ds_read_b64_tr_b16 a[208:209], v18 offset:0
ds_read_b64_tr_b16 a[210:211], v18 offset:1536
M a[84:87], a[188:191], a[252:255], a[84:87]
s_sub_u32 s31, s31, 1
s_cmp_eq_u32 s31, 0
s_cselect_b32 s58, -1920, s57
s_add_u32 s23, s23, s58
s_add_u32 s24, s24, s58
M a[88:91], a[196:199], a[252:255], a[88:91]
M a[88:91], a[192:195], a[248:251], a[88:91]
s_waitcnt lgkmcnt(8)
M a[92:95], a[176:179], a[224:227], a[92:95]
ds_read_b128 a[248:251], v12 offset:10240
ds_read_b128 a[252:255], v13 offset:10240
M a[92:95], a[180:183], a[228:231], a[92:95]
s_add_u32 m0, s30, 65536
s_nop 0
buffer_load_dwordx4 v6, s[12:15], s25 offen offset:0 lds
M a[96:99], a[188:191], a[228:231], a[96:99]
ds_read_b64_tr_b16 a[216:217], v19 offset:0
ds_read_b64_tr_b16 a[218:219], v19 offset:1536
M a[96:99], a[184:187], a[224:227], a[96:99]
M a[100:103], a[192:195], a[224:227], a[100:103]
buffer_load_dwordx4 v7, s[12:15], s25 offen offset:1024 lds
M a[100:103], a[196:199], a[228:231], a[100:103]
s_waitcnt lgkmcnt(10)
M a[104:107], a[180:183], a[236:239], a[104:107]
ds_read_b128 a[224:227], v12 offset:12288
ds_read_b128 a[228:231], v13 offset:12288
M a[104:107], a[176:179], a[232:235], a[104:107]
M a[108:111], a[184:187], a[232:235], a[108:111]
ds_read_b64_tr_b16 a[204:205], v17 offset:12288
ds_read_b64_tr_b16 a[206:207], v17 offset:13824
M a[108:111], a[188:191], a[236:239], a[108:111]
buffer_load_dwordx4 v8, s[12:15], s25 offen offset:2048 lds
M a[112:115], a[196:199], a[236:239], a[112:115]
M a[112:115], a[192:195], a[232:235], a[112:115]
s_waitcnt lgkmcnt(10)
M a[116:119], a[176:179], a[240:243], a[116:119]
ds_read_b128 a[232:235], v12 offset:14336
ds_read_b128 a[236:239], v13 offset:14336
M a[116:119], a[180:183], a[244:247], a[116:119]
buffer_load_dwordx4 v9, s[12:15], s25 offen offset:3072 lds
M a[120:123], a[188:191], a[244:247], a[120:123]
ds_read_b64_tr_b16 a[212:213], v18 offset:12288
ds_read_b64_tr_b16 a[214:215], v18 offset:13824
M a[120:123], a[184:187], a[240:243], a[120:123]
M a[124:127], a[192:195], a[240:243], a[124:127]
s_add_u32 m0, s30, 69632
s_nop 0
buffer_load_dwordx4 v21, s[12:15], s25 offen offset:0 lds
M a[124:127], a[196:199], a[244:247], a[124:127]
s_waitcnt lgkmcnt(10)
M a[128:131], a[180:183], a[252:255], a[128:131]
ds_read_b128 a[240:243], v12 offset:16384
ds_read_b128 a[244:247], v13 offset:16384
M a[128:131], a[176:179], a[248:251], a[128:131]
M a[132:135], a[184:187], a[248:251], a[132:135]
ds_read_b64_tr_b16 a[220:221], v19 offset:12288
ds_read_b64_tr_b16 a[222:223], v19 offset:13824
M a[132:135], a[188:191], a[252:255], a[132:135]
buffer_load_dwordx4 v22, s[12:15], s25 offen offset:1024 lds
M a[136:139], a[196:199], a[252:255], a[136:139]
M a[136:139], a[192:195], a[248:251], a[136:139]
s_waitcnt lgkmcnt(10)
M a[140:143], a[176:179], a[224:227], a[140:143]
s_sub_u32 s54, s54, 1
s_cmp_eq_u32 s54, 0
s_cselect_b32 s58, s55, s56
s_add_u32 s25, s25, s58
M a[140:143], a[180:183], a[228:231], a[140:143]
M a[144:147], a[188:191], a[228:231], a[144:147]
M a[144:147], a[184:187], a[224:227], a[144:147]
M a[148:151], a[192:195], a[224:227], a[148:151]
s_waitcnt vmcnt(12) lgkmcnt(0)
s_barrier
ds_read_b128 a[248:251], v10 offset:0
ds_read_b128 a[252:255], v11 offset:0
s_cmp_lg_u32 s101, 0
s_cbranch_scc1 Lk1_arr
v_mov_b32 v127, 1
s_and_b32 s41, s2, 128
s_mov_b64 exec, 1
buffer_atomic_add v127, off, s[36:39], s41 sc1
s_mov_b64 exec, -1
Lk1_arr:
M a[148:151], a[196:199], a[228:231], a[148:151]
s_add_u32 m0, s28, 131072
s_nop 0
buffer_load_dword v20, s[8:11], s24 offen lds
M a[152:155], a[180:183], a[236:239], a[152:155]
ds_read_b128 a[224:227], v10 offset:2048
ds_read_b128 a[228:231], v11 offset:2048
M a[152:155], a[176:179], a[232:235], a[152:155]
M a[156:159], a[184:187], a[232:235], a[156:159]
buffer_load_dword v23, s[8:11], s24 offen offset:256 lds
M a[156:159], a[188:191], a[236:239], a[156:159]
M a[160:163], a[196:199], a[236:239], a[160:163]
M a[160:163], a[192:195], a[232:235], a[160:163]
s_add_u32 m0, s29, 133120
s_nop 0
buffer_load_dwordx4 v2, s[8:11], s23 offen offset:0 lds
M a[164:167], a[176:179], a[240:243], a[164:167]
ds_read_b128 a[232:235], v10 offset:4096
ds_read_b128 a[236:239], v11 offset:4096
M a[164:167], a[180:183], a[244:247], a[164:167]
M a[168:171], a[188:191], a[244:247], a[168:171]
M a[168:171], a[184:187], a[240:243], a[168:171]
buffer_load_dwordx4 v3, s[8:11], s23 offen offset:1024 lds
M a[172:175], a[192:195], a[240:243], a[172:175]
M a[172:175], a[196:199], a[244:247], a[172:175]
s_waitcnt lgkmcnt(4)
M a[68:71], a[200:203], a[248:251], a[68:71]
ds_read_b128 a[240:243], v10 offset:6144
ds_read_b128 a[244:247], v11 offset:6144
M a[68:71], a[204:207], a[252:255], a[68:71]
buffer_load_dwordx4 v4, s[8:11], s23 offen offset:2048 lds
M a[72:75], a[212:215], a[252:255], a[72:75]
ds_read_b64_tr_b16 a[176:177], v14 offset:0
ds_read_b64_tr_b16 a[178:179], v14 offset:1536
M a[72:75], a[208:211], a[248:251], a[72:75]
M a[76:79], a[216:219], a[248:251], a[76:79]
buffer_load_dwordx4 v5, s[8:11], s23 offen offset:3072 lds
M a[76:79], a[220:223], a[252:255], a[76:79]
s_waitcnt lgkmcnt(6)
M a[80:83], a[204:207], a[228:231], a[80:83]
ds_read_b128 a[248:251], v10 offset:8192
ds_read_b128 a[252:255], v11 offset:8192
M a[80:83], a[200:203], a[224:227], a[80:83]
M a[84:87], a[208:211], a[224:227], a[84:87]
ds_read_b64_tr_b16 a[184:185], v15 offset:0
ds_read_b64_tr_b16 a[186:187], v15 offset:1536
M a[84:87], a[212:215], a[228:231], a[84:87]
s_sub_u32 s31, s31, 1
s_cmp_eq_u32 s31, 0
s_cselect_b32 s58, -1920, s57
s_add_u32 s23, s23, s58
s_add_u32 s24, s24, s58
M a[88:91], a[220:223], a[228:231], a[88:91]
M a[88:91], a[216:219], a[224:227], a[88:91]
s_waitcnt lgkmcnt(8)
M a[92:95], a[200:203], a[232:235], a[92:95]
ds_read_b128 a[224:227], v10 offset:10240
ds_read_b128 a[228:231], v11 offset:10240
M a[92:95], a[204:207], a[236:239], a[92:95]
s_add_u32 m0, s30, 98304
s_nop 0
buffer_load_dwordx4 v6, s[12:15], s25 offen offset:0 lds
M a[96:99], a[212:215], a[236:239], a[96:99]
ds_read_b64_tr_b16 a[192:193], v16 offset:0
ds_read_b64_tr_b16 a[194:195], v16 offset:1536
M a[96:99], a[208:211], a[232:235], a[96:99]
M a[100:103], a[216:219], a[232:235], a[100:103]
buffer_load_dwordx4 v7, s[12:15], s25 offen offset:1024 lds
M a[100:103], a[220:223], a[236:239], a[100:103]
s_waitcnt lgkmcnt(10)
M a[104:107], a[204:207], a[244:247], a[104:107]
ds_read_b128 a[232:235], v10 offset:12288
ds_read_b128 a[236:239], v11 offset:12288
M a[104:107], a[200:203], a[240:243], a[104:107]
M a[108:111], a[208:211], a[240:243], a[108:111]
ds_read_b64_tr_b16 a[180:181], v14 offset:12288
ds_read_b64_tr_b16 a[182:183], v14 offset:13824
M a[108:111], a[212:215], a[244:247], a[108:111]
buffer_load_dwordx4 v8, s[12:15], s25 offen offset:2048 lds
M a[112:115], a[220:223], a[244:247], a[112:115]
M a[112:115], a[216:219], a[240:243], a[112:115]
s_waitcnt lgkmcnt(10)
M a[116:119], a[200:203], a[248:251], a[116:119]
ds_read_b128 a[240:243], v10 offset:14336
ds_read_b128 a[244:247], v11 offset:14336
M a[116:119], a[204:207], a[252:255], a[116:119]
buffer_load_dwordx4 v9, s[12:15], s25 offen offset:3072 lds
M a[120:123], a[212:215], a[252:255], a[120:123]
ds_read_b64_tr_b16 a[188:189], v15 offset:12288
ds_read_b64_tr_b16 a[190:191], v15 offset:13824
M a[120:123], a[208:211], a[248:251], a[120:123]
M a[124:127], a[216:219], a[248:251], a[124:127]
s_add_u32 m0, s30, 102400
s_nop 0
buffer_load_dwordx4 v21, s[12:15], s25 offen offset:0 lds
M a[124:127], a[220:223], a[252:255], a[124:127]
s_waitcnt lgkmcnt(10)
M a[128:131], a[204:207], a[228:231], a[128:131]
ds_read_b128 a[248:251], v10 offset:16384
ds_read_b128 a[252:255], v11 offset:16384
M a[128:131], a[200:203], a[224:227], a[128:131]
M a[132:135], a[208:211], a[224:227], a[132:135]
ds_read_b64_tr_b16 a[196:197], v16 offset:12288
ds_read_b64_tr_b16 a[198:199], v16 offset:13824
M a[132:135], a[212:215], a[228:231], a[132:135]
buffer_load_dwordx4 v22, s[12:15], s25 offen offset:1024 lds
M a[136:139], a[220:223], a[228:231], a[136:139]
M a[136:139], a[216:219], a[224:227], a[136:139]
s_waitcnt lgkmcnt(10)
M a[140:143], a[200:203], a[232:235], a[140:143]
s_sub_u32 s54, s54, 1
s_cmp_eq_u32 s54, 0
s_cselect_b32 s58, s55, s56
s_add_u32 s25, s25, s58
M a[140:143], a[204:207], a[236:239], a[140:143]
M a[144:147], a[212:215], a[236:239], a[144:147]
M a[144:147], a[208:211], a[232:235], a[144:147]
M a[148:151], a[216:219], a[232:235], a[148:151]
s_waitcnt vmcnt(12) lgkmcnt(0)
s_barrier
ds_read_b128 a[224:227], v10 offset:18432
ds_read_b128 a[228:231], v11 offset:18432
M a[148:151], a[220:223], a[236:239], a[148:151]
s_add_u32 m0, s28, 0
s_nop 0
buffer_load_dword v20, s[8:11], s24 offen lds
M a[152:155], a[204:207], a[244:247], a[152:155]
ds_read_b128 a[232:235], v10 offset:20480
ds_read_b128 a[236:239], v11 offset:20480
M a[152:155], a[200:203], a[240:243], a[152:155]
M a[156:159], a[208:211], a[240:243], a[156:159]
buffer_load_dword v23, s[8:11], s24 offen offset:256 lds
M a[156:159], a[212:215], a[244:247], a[156:159]
M a[160:163], a[220:223], a[244:247], a[160:163]
M a[160:163], a[216:219], a[240:243], a[160:163]
s_add_u32 m0, s29, 2048
s_nop 0
buffer_load_dwordx4 v2, s[8:11], s23 offen offset:0 lds
M a[164:167], a[200:203], a[248:251], a[164:167]
ds_read_b128 a[240:243], v10 offset:22528
ds_read_b128 a[244:247], v11 offset:22528
M a[164:167], a[204:207], a[252:255], a[164:167]
M a[168:171], a[212:215], a[252:255], a[168:171]
M a[168:171], a[208:211], a[248:251], a[168:171]
buffer_load_dwordx4 v3, s[8:11], s23 offen offset:1024 lds
M a[172:175], a[216:219], a[248:251], a[172:175]
M a[172:175], a[220:223], a[252:255], a[172:175]
s_waitcnt lgkmcnt(4)
M a[68:71], a[176:179], a[224:227], a[68:71]
ds_read_b128 a[248:251], v10 offset:24576
ds_read_b128 a[252:255], v11 offset:24576
v_mov_b32 v160, 0
v_mov_b32 v161, 0
M a[68:71], a[180:183], a[228:231], a[68:71]
buffer_load_dwordx4 v4, s[8:11], s23 offen offset:2048 lds
M a[72:75], a[188:191], a[228:231], a[72:75]
ds_read_b64_tr_b16 a[200:201], v14 offset:28672
ds_read_b64_tr_b16 a[202:203], v14 offset:30208
v_mov_b32 v162, 0
v_mov_b32 v163, 0
M a[72:75], a[184:187], a[224:227], a[72:75]
M a[76:79], a[192:195], a[224:227], a[76:79]
buffer_load_dwordx4 v5, s[8:11], s23 offen offset:3072 lds
v_mov_b32 v164, 0
v_mov_b32 v165, 0
M a[76:79], a[196:199], a[228:231], a[76:79]
s_waitcnt lgkmcnt(6)
M a[80:83], a[180:183], a[236:239], a[80:83]
ds_read_b128 a[224:227], v10 offset:26624
ds_read_b128 a[228:231], v11 offset:26624
v_mov_b32 v166, 0
v_mov_b32 v167, 0
M a[80:83], a[176:179], a[232:235], a[80:83]
M a[84:87], a[184:187], a[232:235], a[84:87]
ds_read_b64_tr_b16 a[208:209], v15 offset:28672
ds_read_b64_tr_b16 a[210:211], v15 offset:30208
M a[84:87], a[188:191], a[236:239], a[84:87]
s_sub_u32 s31, s31, 1
s_cmp_eq_u32 s31, 0
s_cselect_b32 s58, -1920, s57
s_add_u32 s23, s23, s58
s_add_u32 s24, s24, s58
v_mov_b32 v168, 0
v_mov_b32 v169, 0
M a[88:91], a[196:199], a[236:239], a[88:91]
M a[88:91], a[192:195], a[232:235], a[88:91]
s_waitcnt lgkmcnt(8)
v_mov_b32 v170, 0
v_mov_b32 v171, 0
M a[92:95], a[176:179], a[240:243], a[92:95]
ds_read_b128 a[232:235], v10 offset:28672
ds_read_b128 a[236:239], v11 offset:28672
M a[92:95], a[180:183], a[244:247], a[92:95]
s_add_u32 m0, s30, 36864
s_nop 0
buffer_load_dwordx4 v6, s[12:15], s25 offen offset:0 lds
v_mov_b32 v172, 0
v_mov_b32 v173, 0
M a[96:99], a[188:191], a[244:247], a[96:99]
ds_read_b64_tr_b16 a[216:217], v16 offset:28672
ds_read_b64_tr_b16 a[218:219], v16 offset:30208
M a[96:99], a[184:187], a[240:243], a[96:99]
v_mov_b32 v174, 0
v_mov_b32 v175, 0
M a[100:103], a[192:195], a[240:243], a[100:103]
buffer_load_dwordx4 v7, s[12:15], s25 offen offset:1024 lds
M a[100:103], a[196:199], a[244:247], a[100:103]
s_waitcnt lgkmcnt(10)
M a[104:107], a[180:183], a[252:255], a[104:107]
ds_read_b128 a[240:243], v10 offset:30720
ds_read_b128 a[244:247], v11 offset:30720
v_mov_b32 v176, 0
v_mov_b32 v177, 0
M a[104:107], a[176:179], a[248:251], a[104:107]
M a[108:111], a[184:187], a[248:251], a[108:111]
ds_read_b64_tr_b16 a[204:205], v14 offset:40960
ds_read_b64_tr_b16 a[206:207], v14 offset:42496
v_mov_b32 v178, 0
v_mov_b32 v179, 0
M a[108:111], a[188:191], a[252:255], a[108:111]
buffer_load_dwordx4 v8, s[12:15], s25 offen offset:2048 lds
M a[112:115], a[196:199], a[252:255], a[112:115]
v_mov_b32 v180, 0
v_mov_b32 v181, 0
M a[112:115], a[192:195], a[248:251], a[112:115]
s_waitcnt lgkmcnt(10)
M a[116:119], a[176:179], a[224:227], a[116:119]
ds_read_b128 a[248:251], v10 offset:32768
ds_read_b128 a[252:255], v11 offset:32768
v_mov_b32 v182, 0
v_mov_b32 v183, 0
M a[116:119], a[180:183], a[228:231], a[116:119]
buffer_load_dwordx4 v9, s[12:15], s25 offen offset:3072 lds
M a[120:123], a[188:191], a[228:231], a[120:123]
ds_read_b64_tr_b16 a[212:213], v15 offset:40960
ds_read_b64_tr_b16 a[214:215], v15 offset:42496
M a[120:123], a[184:187], a[224:227], a[120:123]
v_mov_b32 v184, 0
v_mov_b32 v185, 0
M a[124:127], a[192:195], a[224:227], a[124:127]
s_add_u32 m0, s30, 40960
s_nop 0
buffer_load_dwordx4 v21, s[12:15], s25 offen offset:0 lds
M a[124:127], a[196:199], a[228:231], a[124:127]
s_waitcnt lgkmcnt(10)
v_mov_b32 v186, 0
v_mov_b32 v187, 0
M a[128:131], a[180:183], a[236:239], a[128:131]
ds_read_b128 a[224:227], v10 offset:34816
ds_read_b128 a[228:231], v11 offset:34816
M a[128:131], a[176:179], a[232:235], a[128:131]
v_mov_b32 v188, 0
v_mov_b32 v189, 0
M a[132:135], a[184:187], a[232:235], a[132:135]
ds_read_b64_tr_b16 a[220:221], v16 offset:40960
ds_read_b64_tr_b16 a[222:223], v16 offset:42496
M a[132:135], a[188:191], a[236:239], a[132:135]
buffer_load_dwordx4 v22, s[12:15], s25 offen offset:1024 lds
v_mov_b32 v190, 0
v_mov_b32 v191, 0
M a[136:139], a[196:199], a[236:239], a[136:139]
M a[136:139], a[192:195], a[232:235], a[136:139]
s_waitcnt lgkmcnt(10)
M a[140:143], a[176:179], a[240:243], a[140:143]
s_sub_u32 s54, s54, 1
s_cmp_eq_u32 s54, 0
s_cselect_b32 s58, s55, s56
s_add_u32 s25, s25, s58
v_mov_b32 v192, 0
v_mov_b32 v193, 0
M a[140:143], a[180:183], a[244:247], a[140:143]
M a[144:147], a[188:191], a[244:247], a[144:147]
v_mov_b32 v194, 0
v_mov_b32 v195, 0
M a[144:147], a[184:187], a[240:243], a[144:147]
M a[148:151], a[192:195], a[240:243], a[148:151]
s_waitcnt vmcnt(12) lgkmcnt(0)
s_barrier
ds_read_b128 a[232:235], v12 offset:0
ds_read_b128 a[236:239], v13 offset:0
v_mov_b32 v196, 0
v_mov_b32 v197, 0
M a[148:151], a[196:199], a[244:247], a[148:151]
s_add_u32 m0, s28, 18432
s_nop 0
buffer_load_dword v20, s[8:11], s24 offen lds
M a[152:155], a[180:183], a[252:255], a[152:155]
ds_read_b128 a[240:243], v12 offset:2048
ds_read_b128 a[244:247], v13 offset:2048
v_mov_b32 v198, 0
v_mov_b32 v199, 0
M a[152:155], a[176:179], a[248:251], a[152:155]
M a[156:159], a[184:187], a[248:251], a[156:159]
buffer_load_dword v23, s[8:11], s24 offen offset:256 lds
M a[156:159], a[188:191], a[252:255], a[156:159]
v_mov_b32 v200, 0
v_mov_b32 v201, 0
M a[160:163], a[196:199], a[252:255], a[160:163]
M a[160:163], a[192:195], a[248:251], a[160:163]
s_add_u32 m0, s29, 20480
s_nop 0
buffer_load_dwordx4 v2, s[8:11], s23 offen offset:0 lds
v_mov_b32 v202, 0
v_mov_b32 v203, 0
M a[164:167], a[176:179], a[224:227], a[164:167]
ds_read_b128 a[248:251], v12 offset:4096
ds_read_b128 a[252:255], v13 offset:4096
M a[164:167], a[180:183], a[228:231], a[164:167]
v_mov_b32 v204, 0
v_mov_b32 v205, 0
M a[168:171], a[188:191], a[228:231], a[168:171]
M a[168:171], a[184:187], a[224:227], a[168:171]
buffer_load_dwordx4 v3, s[8:11], s23 offen offset:1024 lds
v_mov_b32 v206, 0
v_mov_b32 v207, 0
M a[172:175], a[192:195], a[224:227], a[172:175]
M a[172:175], a[196:199], a[228:231], a[172:175]
s_waitcnt lgkmcnt(4)
M a[68:71], a[200:203], a[232:235], a[68:71]
ds_read_b128 a[224:227], v12 offset:6144
ds_read_b128 a[228:231], v13 offset:6144
v_and_b32 v128, 15, v0
v_mul_u32_u24 v128, 400, v128
M a[68:71], a[204:207], a[236:239], a[68:71]
buffer_load_dwordx4 v4, s[8:11], s23 offen offset:2048 lds
M a[72:75], a[212:215], a[236:239], a[72:75]
ds_read_b64_tr_b16 a[176:177], v17 offset:0
ds_read_b64_tr_b16 a[178:179], v17 offset:1536
v_lshrrev_b32 v129, 4, v0
v_lshl_add_u32 v128, v129, 3, v128
M a[72:75], a[208:211], a[232:235], a[72:75]
M a[76:79], a[216:219], a[232:235], a[76:79]
buffer_load_dwordx4 v5, s[8:11], s23 offen offset:3072 lds
s_mul_i32 s3, s20, 96
s_add_u32 s3, s3, 98304
M a[76:79], a[220:223], a[236:239], a[76:79]
s_waitcnt lgkmcnt(6)
M a[80:83], a[204:207], a[244:247], a[80:83]
ds_read_b128 a[232:235], v12 offset:8192
ds_read_b128 a[236:239], v13 offset:8192
v_add_u32 v124, s3, v128
v_and_b32 v128, 15, v0
M a[80:83], a[200:203], a[240:243], a[80:83]
M a[84:87], a[208:211], a[240:243], a[84:87]
ds_read_b64_tr_b16 a[184:185], v18 offset:0
ds_read_b64_tr_b16 a[186:187], v18 offset:1536
v_lshrrev_b32 v129, 4, v0
s_add_u32 s3, s21, 16
M a[84:87], a[212:215], a[244:247], a[84:87]
s_sub_u32 s31, s31, 1
s_cmp_eq_u32 s31, 0
s_cselect_b32 s58, -1920, s57
s_add_u32 s23, s23, s58
s_add_u32 s24, s24, s58
M a[88:91], a[220:223], a[244:247], a[88:91]
v_lshl_add_u32 v130, v128, 1, s3
s_lshl_b32 s4, s22, 6
M a[88:91], a[216:219], a[240:243], a[88:91]
s_waitcnt lgkmcnt(8)
M a[92:95], a[200:203], a[248:251], a[92:95]
ds_read_b128 a[240:243], v12 offset:10240
ds_read_b128 a[244:247], v13 offset:10240
s_add_u32 s4, s4, 98304
v_mul_u32_u24 v120, 400, v130
M a[92:95], a[204:207], a[252:255], a[92:95]
s_add_u32 m0, s30, 65536
s_nop 0
buffer_load_dwordx4 v6, s[12:15], s25 offen offset:0 lds
M a[96:99], a[212:215], a[252:255], a[96:99]
ds_read_b64_tr_b16 a[192:193], v19 offset:0
ds_read_b64_tr_b16 a[194:195], v19 offset:1536
M a[96:99], a[208:211], a[248:251], a[96:99]
v_lshl_add_u32 v120, v129, 4, v120
v_add_u32 v120, s4, v120
M a[100:103], a[216:219], a[248:251], a[100:103]
buffer_load_dwordx4 v7, s[12:15], s25 offen offset:1024 lds
M a[100:103], a[220:223], a[252:255], a[100:103]
s_waitcnt lgkmcnt(10)
v_subrev_u32 v130, 32, v130
v_max_i32 v130, 0, v130
M a[104:107], a[204:207], a[228:231], a[104:107]
ds_read_b128 a[248:251], v12 offset:12288
ds_read_b128 a[252:255], v13 offset:12288
M a[104:107], a[200:203], a[224:227], a[104:107]
v_mul_u32_u24 v121, 400, v130
v_lshl_add_u32 v121, v129, 4, v121
M a[108:111], a[208:211], a[224:227], a[108:111]
ds_read_b64_tr_b16 a[180:181], v17 offset:12288
ds_read_b64_tr_b16 a[182:183], v17 offset:13824
M a[108:111], a[212:215], a[228:231], a[108:111]
buffer_load_dwordx4 v8, s[12:15], s25 offen offset:2048 lds
v_add_u32 v121, s4, v121
v_bfe_u32 v131, v0, 2, 2
M a[112:115], a[220:223], a[228:231], a[112:115]
M a[112:115], a[216:219], a[224:227], a[112:115]
s_waitcnt lgkmcnt(10)
v_lshl_add_u32 v131, v129, 2, v131
v_lshl_add_u32 v131, v131, 1, s3
M a[116:119], a[200:203], a[232:235], a[116:119]
ds_read_b128 a[224:227], v12 offset:14336
ds_read_b128 a[228:231], v13 offset:14336
M a[116:119], a[204:207], a[236:239], a[116:119]
buffer_load_dwordx4 v9, s[12:15], s25 offen offset:3072 lds
v_and_b32 v132, 3, v0
v_lshlrev_b32 v132, 3, v132
M a[120:123], a[212:215], a[236:239], a[120:123]
ds_read_b64_tr_b16 a[188:189], v18 offset:12288
ds_read_b64_tr_b16 a[190:191], v18 offset:13824
M a[120:123], a[208:211], a[232:235], a[120:123]
M a[124:127], a[216:219], a[232:235], a[124:127]
s_add_u32 m0, s30, 69632
s_nop 0
buffer_load_dwordx4 v21, s[12:15], s25 offen offset:0 lds
v_add_u32 v132, s4, v132
s_movk_i32 s5, 400
M a[124:127], a[220:223], a[236:239], a[124:127]
s_waitcnt lgkmcnt(10)
M a[128:131], a[204:207], a[244:247], a[128:131]
ds_read_b128 a[232:235], v12 offset:16384
ds_read_b128 a[236:239], v13 offset:16384
v_mad_u32_u24 v122, v131, s5, v132
v_subrev_u32 v131, 32, v131
M a[128:131], a[200:203], a[240:243], a[128:131]
M a[132:135], a[208:211], a[240:243], a[132:135]
ds_read_b64_tr_b16 a[196:197], v19 offset:12288
ds_read_b64_tr_b16 a[198:199], v19 offset:13824
v_max_i32 v131, 0, v131
v_mad_u32_u24 v123, v131, s5, v132
M a[132:135], a[212:215], a[244:247], a[132:135]
buffer_load_dwordx4 v22, s[12:15], s25 offen offset:1024 lds
M a[136:139], a[220:223], a[244:247], a[136:139]
v_lshlrev_b32 v129, 2, v129
v_sub_u32 v128, v128, v129
M a[136:139], a[216:219], a[240:243], a[136:139]
s_waitcnt lgkmcnt(10)
M a[140:143], a[200:203], a[248:251], a[140:143]
s_sub_u32 s54, s54, 1
s_cmp_eq_u32 s54, 0
s_cselect_b32 s58, s55, s56
s_add_u32 s25, s25, s58
v_mov_b32 v129, 0xf149f2ca
s_cmp_eq_u32 s26, 0
s_cselect_b32 s3, 0xf149f2ca, 0
M a[140:143], a[204:207], a[252:255], a[140:143]
M a[144:147], a[212:215], a[252:255], a[144:147]
v_cmp_lt_i32 vcc, -9, v128
s_nop 1
v_cndmask_b32 v144, 0, v129, vcc
M a[144:147], a[208:211], a[248:251], a[144:147]
M a[148:151], a[216:219], a[248:251], a[148:151]
s_waitcnt vmcnt(12) lgkmcnt(0)
s_barrier
ds_read_b128 a[240:243], v10 offset:0
ds_read_b128 a[244:247], v11 offset:0
M a[148:151], a[220:223], a[252:255], a[148:151]
s_add_u32 m0, s28, 131072
s_nop 0
buffer_load_dword v20, s[8:11], s24 offen lds
v_subrev_u32 v130, 0, v128
v_cmp_lt_u32 vcc, 7, v130
s_nop 1
v_cndmask_b32 v148, 0, v129, vcc
M a[152:155], a[204:207], a[228:231], a[152:155]
ds_read_b128 a[248:251], v10 offset:2048
ds_read_b128 a[252:255], v11 offset:2048
M a[152:155], a[200:203], a[224:227], a[152:155]
v_min_f32 v152, s3, v144
v_mov_b32 v156, 0x3f803f80
M a[156:159], a[208:211], a[224:227], a[156:159]
buffer_load_dword v23, s[8:11], s24 offen offset:256 lds
M a[156:159], a[212:215], a[228:231], a[156:159]
v_cmp_lt_i32 vcc, -8, v128
s_nop 1
v_cndmask_b32 v145, 0, v129, vcc
M a[160:163], a[220:223], a[228:231], a[160:163]
M a[160:163], a[216:219], a[224:227], a[160:163]
s_add_u32 m0, s29, 133120
s_nop 0
buffer_load_dwordx4 v2, s[8:11], s23 offen offset:0 lds
v_subrev_u32 v130, 1, v128
v_cmp_lt_u32 vcc, 7, v130
s_nop 1
v_cndmask_b32 v149, 0, v129, vcc
M a[164:167], a[200:203], a[232:235], a[164:167]
ds_read_b128 a[224:227], v10 offset:4096
ds_read_b128 a[228:231], v11 offset:4096
M a[164:167], a[204:207], a[236:239], a[164:167]
v_min_f32 v153, s3, v145
v_mov_b32 v157, 0x3f803f80
M a[168:171], a[212:215], a[236:239], a[168:171]
M a[168:171], a[208:211], a[232:235], a[168:171]
buffer_load_dwordx4 v3, s[8:11], s23 offen offset:1024 lds
v_cmp_lt_i32 vcc, -7, v128
s_nop 1
v_cndmask_b32 v146, 0, v129, vcc
M a[172:175], a[216:219], a[232:235], a[172:175]
M a[172:175], a[220:223], a[236:239], a[172:175]
s_waitcnt lgkmcnt(4)
M a[68:71], a[176:179], a[240:243], a[68:71]
ds_read_b128 a[232:235], v10 offset:6144
ds_read_b128 a[236:239], v11 offset:6144
v_subrev_u32 v130, 2, v128
v_cmp_lt_u32 vcc, 7, v130
s_nop 1
v_cndmask_b32 v150, 0, v129, vcc
M a[68:71], a[180:183], a[244:247], a[68:71]
buffer_load_dwordx4 v4, s[8:11], s23 offen offset:2048 lds
v_min_f32 v154, s3, v146
v_mov_b32 v158, 0x3f803f80
M a[72:75], a[188:191], a[244:247], a[72:75]
ds_read_b64_tr_b16 a[200:201], v14 offset:0
ds_read_b64_tr_b16 a[202:203], v14 offset:1536
M a[72:75], a[184:187], a[240:243], a[72:75]
v_cmp_lt_i32 vcc, -6, v128
s_nop 1
v_cndmask_b32 v147, 0, v129, vcc
M a[76:79], a[192:195], a[240:243], a[76:79]
buffer_load_dwordx4 v5, s[8:11], s23 offen offset:3072 lds
v_subrev_u32 v130, 3, v128
v_cmp_lt_u32 vcc, 7, v130
s_nop 1
v_cndmask_b32 v151, 0, v129, vcc
M a[76:79], a[196:199], a[244:247], a[76:79]
s_waitcnt lgkmcnt(6)
M a[80:83], a[180:183], a[252:255], a[80:83]
ds_read_b128 a[240:243], v10 offset:8192
ds_read_b128 a[244:247], v11 offset:8192
v_min_f32 v155, s3, v147
v_mov_b32 v159, 0x3f803f80
M a[80:83], a[176:179], a[248:251], a[80:83]
s_add_u32 s16, s50, 83886080
s_addc_u32 s17, s51, 0
M a[84:87], a[184:187], a[248:251], a[84:87]
ds_read_b64_tr_b16 a[208:209], v15 offset:0
ds_read_b64_tr_b16 a[210:211], v15 offset:1536
M a[84:87], a[188:191], a[252:255], a[84:87]
s_sub_u32 s31, s31, 1
s_cmp_eq_u32 s31, 0
s_cselect_b32 s58, -1920, s57
s_add_u32 s23, s23, s58
s_add_u32 s24, s24, s58
s_mov_b32 s18, 4194304
s_mov_b32 s19, 0x00020000
M a[88:91], a[196:199], a[252:255], a[88:91]
s_lshl_b32 s3, s26, 18
s_lshl_b32 s4, s27, 14
M a[88:91], a[192:195], a[248:251], a[88:91]
s_waitcnt lgkmcnt(8)
M a[92:95], a[176:179], a[224:227], a[92:95]
ds_read_b128 a[248:251], v10 offset:10240
ds_read_b128 a[252:255], v11 offset:10240
s_add_u32 s3, s3, s4
s_lshl_b32 s4, s21, 13
M a[92:95], a[180:183], a[228:231], a[92:95]
s_add_u32 m0, s30, 98304
s_nop 0
buffer_load_dwordx4 v6, s[12:15], s25 offen offset:0 lds
s_add_u32 s3, s3, s4
s_lshl_b32 s4, s22, 10
M a[96:99], a[188:191], a[228:231], a[96:99]
ds_read_b64_tr_b16 a[216:217], v16 offset:0
ds_read_b64_tr_b16 a[218:219], v16 offset:1536
M a[96:99], a[184:187], a[224:227], a[96:99]
s_add_u32 s6, s3, s4
s_mov_b32 s7, 0x3e8293ee
M a[100:103], a[192:195], a[224:227], a[100:103]
buffer_load_dwordx4 v7, s[12:15], s25 offen offset:1024 lds
s_lshl_b32 s65, s26, 8
s_lshl_b32 s3, s27, 4
M a[100:103], a[196:199], a[228:231], a[100:103]
s_waitcnt lgkmcnt(10)
M a[104:107], a[180:183], a[236:239], a[104:107]
ds_read_b128 a[224:227], v10 offset:12288
ds_read_b128 a[228:231], v11 offset:12288
s_add_u32 s65, s65, s3
s_lshl_b32 s3, s101, 2
M a[104:107], a[176:179], a[232:235], a[104:107]
s_add_u32 s65, s65, s3
s_add_u32 s65, s65, 8400896
M a[108:111], a[184:187], a[232:235], a[108:111]
ds_read_b64_tr_b16 a[204:205], v14 offset:12288
ds_read_b64_tr_b16 a[206:207], v14 offset:13824
M a[108:111], a[188:191], a[236:239], a[108:111]
buffer_load_dwordx4 v8, s[12:15], s25 offen offset:2048 lds
s_mov_b32 s40, 0
v_mov_b32 v119, 0
M a[112:115], a[196:199], a[236:239], a[112:115]
s_mov_b64 s[4:5], s[50:51]
s_and_b32 s20, s2, 7
M a[112:115], a[192:195], a[232:235], a[112:115]
s_waitcnt lgkmcnt(10)
M a[116:119], a[176:179], a[240:243], a[116:119]
ds_read_b128 a[232:235], v10 offset:14336
ds_read_b128 a[236:239], v11 offset:14336
s_lshr_b32 s33, s2, 6
s_lshl_b32 s33, s33, 3
M a[116:119], a[180:183], a[244:247], a[116:119]
buffer_load_dwordx4 v9, s[12:15], s25 offen offset:3072 lds
s_add_u32 s20, s20, s33
s_bfe_u32 s21, s2, 0x30003
M a[120:123], a[188:191], a[244:247], a[120:123]
ds_read_b64_tr_b16 a[212:213], v15 offset:12288
ds_read_b64_tr_b16 a[214:215], v15 offset:13824
M a[120:123], a[184:187], a[240:243], a[120:123]
s_sub_u32 s35, 15, s21
s_cmp_lt_u32 s101, 2
s_cselect_b32 s35, s21, s35
M a[124:127], a[192:195], a[240:243], a[124:127]
s_add_u32 m0, s30, 102400
s_nop 0
buffer_load_dwordx4 v21, s[12:15], s25 offen offset:0 lds
s_lshl_b32 s33, s20, 7
s_lshl_b32 s34, s35, 3
M a[124:127], a[196:199], a[244:247], a[124:127]
s_waitcnt lgkmcnt(10)
M a[128:131], a[180:183], a[252:255], a[128:131]
ds_read_b128 a[240:243], v10 offset:16384
ds_read_b128 a[244:247], v11 offset:16384
s_add_u32 s33, s33, s34
s_and_b32 s34, s101, 1
M a[128:131], a[176:179], a[248:251], a[128:131]
s_lshl_b32 s34, s34, 2
s_add_u32 s33, s33, s34
M a[132:135], a[184:187], a[248:251], a[132:135]
ds_read_b64_tr_b16 a[220:221], v16 offset:12288
ds_read_b64_tr_b16 a[222:223], v16 offset:13824
M a[132:135], a[188:191], a[252:255], a[132:135]
buffer_load_dwordx4 v22, s[12:15], s25 offen offset:1024 lds
s_lshl_b32 s64, s33, 12
s_mov_b32 s44, s4
M a[136:139], a[196:199], a[252:255], a[136:139]
s_mov_b32 s45, s5
s_mov_b32 s46, 16777216
M a[136:139], a[192:195], a[248:251], a[136:139]
s_waitcnt lgkmcnt(10)
M a[140:143], a[176:179], a[224:227], a[140:143]
s_sub_u32 s54, s54, 1
s_cmp_eq_u32 s54, 0
s_cselect_b32 s58, s55, s56
s_add_u32 s25, s25, s58
s_mov_b32 s47, 0x00020000
M a[140:143], a[180:183], a[228:231], a[140:143]
M a[144:147], a[188:191], a[228:231], a[144:147]
M a[144:147], a[184:187], a[224:227], a[144:147]
M a[148:151], a[192:195], a[224:227], a[148:151]
s_waitcnt vmcnt(12) lgkmcnt(0)
s_barrier
ds_read_b128 a[248:251], v10 offset:18432
ds_read_b128 a[252:255], v11 offset:18432
M a[148:151], a[196:199], a[228:231], a[148:151]
s_add_u32 m0, s28, 0
s_nop 0
buffer_load_dword v20, s[8:11], s24 offen lds
M a[152:155], a[180:183], a[236:239], a[152:155]
ds_read_b128 a[224:227], v10 offset:20480
ds_read_b128 a[228:231], v11 offset:20480
M a[152:155], a[176:179], a[232:235], a[152:155]
M a[156:159], a[184:187], a[232:235], a[156:159]
buffer_load_dword v23, s[8:11], s24 offen offset:256 lds
M a[156:159], a[188:191], a[236:239], a[156:159]
M a[160:163], a[196:199], a[236:239], a[160:163]
M a[160:163], a[192:195], a[232:235], a[160:163]
s_add_u32 m0, s29, 2048
s_nop 0
buffer_load_dwordx4 v2, s[8:11], s23 offen offset:0 lds
M a[164:167], a[176:179], a[240:243], a[164:167]
ds_read_b128 a[232:235], v10 offset:22528
ds_read_b128 a[236:239], v11 offset:22528
M a[164:167], a[180:183], a[244:247], a[164:167]
M a[168:171], a[188:191], a[244:247], a[168:171]
M a[168:171], a[184:187], a[240:243], a[168:171]
buffer_load_dwordx4 v3, s[8:11], s23 offen offset:1024 lds
M a[172:175], a[192:195], a[240:243], a[172:175]
M a[172:175], a[196:199], a[244:247], a[172:175]
s_waitcnt lgkmcnt(4)
M a[68:71], a[200:203], a[248:251], a[68:71]
ds_read_b128 a[240:243], v10 offset:24576
ds_read_b128 a[244:247], v11 offset:24576
M a[68:71], a[204:207], a[252:255], a[68:71]
buffer_load_dwordx4 v4, s[8:11], s23 offen offset:2048 lds
M a[72:75], a[212:215], a[252:255], a[72:75]
ds_read_b64_tr_b16 a[176:177], v14 offset:28672
ds_read_b64_tr_b16 a[178:179], v14 offset:30208
M a[72:75], a[208:211], a[248:251], a[72:75]
M a[76:79], a[216:219], a[248:251], a[76:79]
buffer_load_dwordx4 v5, s[8:11], s23 offen offset:3072 lds
M a[76:79], a[220:223], a[252:255], a[76:79]
s_waitcnt lgkmcnt(6)
M a[80:83], a[204:207], a[228:231], a[80:83]
ds_read_b128 a[248:251], v10 offset:26624
ds_read_b128 a[252:255], v11 offset:26624
M a[80:83], a[200:203], a[224:227], a[80:83]
M a[84:87], a[208:211], a[224:227], a[84:87]
ds_read_b64_tr_b16 a[184:185], v15 offset:28672
ds_read_b64_tr_b16 a[186:187], v15 offset:30208
M a[84:87], a[212:215], a[228:231], a[84:87]
s_sub_u32 s31, s31, 1
s_cmp_eq_u32 s31, 0
s_cselect_b32 s58, -1920, s57
s_add_u32 s23, s23, s58
s_add_u32 s24, s24, s58
M a[88:91], a[220:223], a[228:231], a[88:91]
M a[88:91], a[216:219], a[224:227], a[88:91]
s_waitcnt lgkmcnt(8)
M a[92:95], a[200:203], a[232:235], a[92:95]
ds_read_b128 a[224:227], v10 offset:28672
ds_read_b128 a[228:231], v11 offset:28672
M a[92:95], a[204:207], a[236:239], a[92:95]
s_add_u32 m0, s30, 36864
s_nop 0
buffer_load_dwordx4 v6, s[12:15], s25 offen offset:0 lds
M a[96:99], a[212:215], a[236:239], a[96:99]
ds_read_b64_tr_b16 a[192:193], v16 offset:28672
ds_read_b64_tr_b16 a[194:195], v16 offset:30208
M a[96:99], a[208:211], a[232:235], a[96:99]
M a[100:103], a[216:219], a[232:235], a[100:103]
buffer_load_dwordx4 v7, s[12:15], s25 offen offset:1024 lds
M a[100:103], a[220:223], a[236:239], a[100:103]
s_waitcnt lgkmcnt(10)
M a[104:107], a[204:207], a[244:247], a[104:107]
ds_read_b128 a[232:235], v10 offset:30720
ds_read_b128 a[236:239], v11 offset:30720
M a[104:107], a[200:203], a[240:243], a[104:107]
M a[108:111], a[208:211], a[240:243], a[108:111]
ds_read_b64_tr_b16 a[180:181], v14 offset:40960
ds_read_b64_tr_b16 a[182:183], v14 offset:42496
M a[108:111], a[212:215], a[244:247], a[108:111]
buffer_load_dwordx4 v8, s[12:15], s25 offen offset:2048 lds
M a[112:115], a[220:223], a[244:247], a[112:115]
M a[112:115], a[216:219], a[240:243], a[112:115]
s_waitcnt lgkmcnt(10)
M a[116:119], a[200:203], a[248:251], a[116:119]
ds_read_b128 a[240:243], v10 offset:32768
ds_read_b128 a[244:247], v11 offset:32768
M a[116:119], a[204:207], a[252:255], a[116:119]
buffer_load_dwordx4 v9, s[12:15], s25 offen offset:3072 lds
M a[120:123], a[212:215], a[252:255], a[120:123]
ds_read_b64_tr_b16 a[188:189], v15 offset:40960
ds_read_b64_tr_b16 a[190:191], v15 offset:42496
M a[120:123], a[208:211], a[248:251], a[120:123]
M a[124:127], a[216:219], a[248:251], a[124:127]
s_add_u32 m0, s30, 40960
s_nop 0
buffer_load_dwordx4 v21, s[12:15], s25 offen offset:0 lds
M a[124:127], a[220:223], a[252:255], a[124:127]
s_waitcnt lgkmcnt(10)
M a[128:131], a[204:207], a[228:231], a[128:131]
ds_read_b128 a[248:251], v10 offset:34816
ds_read_b128 a[252:255], v11 offset:34816
M a[128:131], a[200:203], a[224:227], a[128:131]
M a[132:135], a[208:211], a[224:227], a[132:135]
ds_read_b64_tr_b16 a[196:197], v16 offset:40960
ds_read_b64_tr_b16 a[198:199], v16 offset:42496
M a[132:135], a[212:215], a[228:231], a[132:135]
buffer_load_dwordx4 v22, s[12:15], s25 offen offset:1024 lds
M a[136:139], a[220:223], a[228:231], a[136:139]
M a[136:139], a[216:219], a[224:227], a[136:139]
s_waitcnt lgkmcnt(10)
M a[140:143], a[200:203], a[232:235], a[140:143]
s_sub_u32 s54, s54, 1
s_cmp_eq_u32 s54, 0
s_cselect_b32 s58, s55, s56
s_add_u32 s25, s25, s58
M a[140:143], a[204:207], a[236:239], a[140:143]
M a[144:147], a[212:215], a[236:239], a[144:147]
M a[144:147], a[208:211], a[232:235], a[144:147]
M a[148:151], a[216:219], a[232:235], a[148:151]
s_waitcnt vmcnt(12) lgkmcnt(0)
s_barrier
ds_read_b128 a[224:227], v12 offset:0
ds_read_b128 a[228:231], v13 offset:0
M a[148:151], a[220:223], a[236:239], a[148:151]
s_add_u32 m0, s28, 18432
s_nop 0
buffer_load_dword v20, s[8:11], s24 offen lds
M a[152:155], a[204:207], a[244:247], a[152:155]
ds_read_b128 a[232:235], v12 offset:2048
ds_read_b128 a[236:239], v13 offset:2048
M a[152:155], a[200:203], a[240:243], a[152:155]
M a[156:159], a[208:211], a[240:243], a[156:159]
buffer_load_dword v23, s[8:11], s24 offen offset:256 lds
M a[156:159], a[212:215], a[244:247], a[156:159]
M a[160:163], a[220:223], a[244:247], a[160:163]
M a[160:163], a[216:219], a[240:243], a[160:163]
s_add_u32 m0, s29, 20480
s_nop 0
buffer_load_dwordx4 v2, s[8:11], s23 offen offset:0 lds
M a[164:167], a[200:203], a[248:251], a[164:167]
ds_read_b128 a[240:243], v12 offset:4096
ds_read_b128 a[244:247], v13 offset:4096
M a[164:167], a[204:207], a[252:255], a[164:167]
M a[168:171], a[212:215], a[252:255], a[168:171]
M a[168:171], a[208:211], a[248:251], a[168:171]
buffer_load_dwordx4 v3, s[8:11], s23 offen offset:1024 lds
M a[172:175], a[216:219], a[248:251], a[172:175]
M a[172:175], a[220:223], a[252:255], a[172:175]
s_waitcnt lgkmcnt(4)
M a[68:71], a[176:179], a[224:227], a[68:71]
ds_read_b128 a[248:251], v12 offset:6144
ds_read_b128 a[252:255], v13 offset:6144
M a[68:71], a[180:183], a[228:231], a[68:71]
buffer_load_dwordx4 v4, s[8:11], s23 offen offset:2048 lds
M a[72:75], a[188:191], a[228:231], a[72:75]
ds_read_b64_tr_b16 a[200:201], v17 offset:0
ds_read_b64_tr_b16 a[202:203], v17 offset:1536
M a[72:75], a[184:187], a[224:227], a[72:75]
M a[76:79], a[192:195], a[224:227], a[76:79]
buffer_load_dwordx4 v5, s[8:11], s23 offen offset:3072 lds
M a[76:79], a[196:199], a[228:231], a[76:79]
s_waitcnt lgkmcnt(6)
M a[80:83], a[180:183], a[236:239], a[80:83]
ds_read_b128 a[224:227], v12 offset:8192
ds_read_b128 a[228:231], v13 offset:8192
M a[80:83], a[176:179], a[232:235], a[80:83]
s_sub_u32 s31, s31, 1
s_cmp_eq_u32 s31, 0
s_cselect_b32 s58, -1920, s57
s_add_u32 s23, s23, s58
s_add_u32 s24, s24, s58
M a[84:87], a[184:187], a[232:235], a[84:87]
ds_read_b64_tr_b16 a[208:209], v18 offset:0
ds_read_b64_tr_b16 a[210:211], v18 offset:1536
M a[84:87], a[188:191], a[236:239], a[84:87]
M a[88:91], a[196:199], a[236:239], a[88:91]
M a[88:91], a[192:195], a[232:235], a[88:91]
s_add_u32 m0, s30, 65536
s_nop 0
buffer_load_dwordx4 v6, s[12:15], s25 offen offset:0 lds
s_waitcnt lgkmcnt(8)
M a[92:95], a[176:179], a[240:243], a[92:95]
ds_read_b128 a[232:235], v12 offset:10240
ds_read_b128 a[236:239], v13 offset:10240
M a[92:95], a[180:183], a[244:247], a[92:95]
M a[96:99], a[188:191], a[244:247], a[96:99]
ds_read_b64_tr_b16 a[216:217], v19 offset:0
ds_read_b64_tr_b16 a[218:219], v19 offset:1536
M a[96:99], a[184:187], a[240:243], a[96:99]
buffer_load_dwordx4 v7, s[12:15], s25 offen offset:1024 lds
M a[100:103], a[192:195], a[240:243], a[100:103]
M a[100:103], a[196:199], a[244:247], a[100:103]
s_waitcnt lgkmcnt(10)
M a[104:107], a[180:183], a[252:255], a[104:107]
ds_read_b128 a[240:243], v12 offset:12288
ds_read_b128 a[244:247], v13 offset:12288
M a[104:107], a[176:179], a[248:251], a[104:107]
buffer_load_dwordx4 v8, s[12:15], s25 offen offset:2048 lds
M a[108:111], a[184:187], a[248:251], a[108:111]
ds_read_b64_tr_b16 a[204:205], v17 offset:12288
ds_read_b64_tr_b16 a[206:207], v17 offset:13824
M a[108:111], a[188:191], a[252:255], a[108:111]
M a[112:115], a[196:199], a[252:255], a[112:115]
buffer_load_dwordx4 v9, s[12:15], s25 offen offset:3072 lds
M a[112:115], a[192:195], a[248:251], a[112:115]
s_waitcnt lgkmcnt(10)
M a[116:119], a[176:179], a[224:227], a[116:119]
ds_read_b128 a[248:251], v12 offset:14336
ds_read_b128 a[252:255], v13 offset:14336
M a[116:119], a[180:183], a[228:231], a[116:119]
M a[120:123], a[188:191], a[228:231], a[120:123]
ds_read_b64_tr_b16 a[212:213], v18 offset:12288
ds_read_b64_tr_b16 a[214:215], v18 offset:13824
M a[120:123], a[184:187], a[224:227], a[120:123]
s_add_u32 m0, s30, 69632
s_nop 0
buffer_load_dwordx4 v21, s[12:15], s25 offen offset:0 lds
M a[124:127], a[192:195], a[224:227], a[124:127]
M a[124:127], a[196:199], a[228:231], a[124:127]
buffer_load_dwordx4 v22, s[12:15], s25 offen offset:1024 lds
s_waitcnt lgkmcnt(10)
M a[128:131], a[180:183], a[236:239], a[128:131]
ds_read_b128 a[224:227], v12 offset:16384
ds_read_b128 a[228:231], v13 offset:16384
M a[128:131], a[176:179], a[232:235], a[128:131]
M a[132:135], a[184:187], a[232:235], a[132:135]
ds_read_b64_tr_b16 a[220:221], v19 offset:12288
ds_read_b64_tr_b16 a[222:223], v19 offset:13824
M a[132:135], a[188:191], a[236:239], a[132:135]
M a[136:139], a[196:199], a[236:239], a[136:139]
s_sub_u32 s54, s54, 1
s_cmp_eq_u32 s54, 0
s_cselect_b32 s58, s55, s56
s_add_u32 s25, s25, s58
M a[136:139], a[192:195], a[232:235], a[136:139]
s_waitcnt lgkmcnt(10)
M a[140:143], a[176:179], a[240:243], a[140:143]
buffer_load_dword v125, v119, s[36:39], 0 offen sc1
M a[140:143], a[180:183], a[244:247], a[140:143]
M a[144:147], a[188:191], a[244:247], a[144:147]
M a[144:147], a[184:187], a[240:243], a[144:147]
M a[148:151], a[192:195], a[240:243], a[148:151]
s_waitcnt vmcnt(13) lgkmcnt(0)
s_barrier
ds_read_b128 a[232:235], v10 offset:0
ds_read_b128 a[236:239], v11 offset:0
s_waitcnt vmcnt(0)
v_cmp_gt_u32 vcc, 0x80, v125
s_nop 0
s_cbranch_vccnz Lk1_spinq
Lk1_gotq:
M a[148:151], a[196:199], a[244:247], a[148:151]
s_add_u32 m0, s28, 131072
s_nop 0
buffer_load_dword v20, s[8:11], s24 offen lds
M a[152:155], a[180:183], a[252:255], a[152:155]
ds_read_b128 a[240:243], v10 offset:2048
ds_read_b128 a[244:247], v11 offset:2048
M a[152:155], a[176:179], a[248:251], a[152:155]
M a[156:159], a[184:187], a[248:251], a[156:159]
buffer_load_dword v23, s[8:11], s24 offen offset:256 lds
M a[156:159], a[188:191], a[252:255], a[156:159]
M a[160:163], a[196:199], a[252:255], a[160:163]
M a[160:163], a[192:195], a[248:251], a[160:163]
s_add_u32 m0, s29, 133120
s_nop 0
buffer_load_dwordx4 v2, s[8:11], s23 offen offset:0 lds
M a[164:167], a[176:179], a[224:227], a[164:167]
ds_read_b128 a[248:251], v10 offset:4096
ds_read_b128 a[252:255], v11 offset:4096
M a[164:167], a[180:183], a[228:231], a[164:167]
M a[168:171], a[188:191], a[228:231], a[168:171]
M a[168:171], a[184:187], a[224:227], a[168:171]
buffer_load_dwordx4 v3, s[8:11], s23 offen offset:1024 lds
M a[172:175], a[192:195], a[224:227], a[172:175]
M a[172:175], a[196:199], a[228:231], a[172:175]
s_waitcnt lgkmcnt(4)
M a[68:71], a[200:203], a[232:235], a[68:71]
ds_read_b128 a[224:227], v10 offset:6144
ds_read_b128 a[228:231], v11 offset:6144
v_mov_b32 v208, 0
v_mov_b32 v209, 0
M a[68:71], a[204:207], a[236:239], a[68:71]
buffer_load_dwordx4 v4, s[8:11], s23 offen offset:2048 lds
M a[72:75], a[212:215], a[236:239], a[72:75]
ds_read_b64_tr_b16 a[176:177], v14 offset:0
ds_read_b64_tr_b16 a[178:179], v14 offset:1536
v_mov_b32 v210, 0
v_mov_b32 v211, 0
M a[72:75], a[208:211], a[232:235], a[72:75]
M a[76:79], a[216:219], a[232:235], a[76:79]
buffer_load_dwordx4 v5, s[8:11], s23 offen offset:3072 lds
v_mov_b32 v212, 0
v_mov_b32 v213, 0
M a[76:79], a[220:223], a[236:239], a[76:79]
s_waitcnt lgkmcnt(6)
M a[80:83], a[204:207], a[244:247], a[80:83]
ds_read_b128 a[232:235], v10 offset:8192
ds_read_b128 a[236:239], v11 offset:8192
v_mov_b32 v214, 0
v_mov_b32 v215, 0
M a[80:83], a[200:203], a[240:243], a[80:83]
s_sub_u32 s31, s31, 1
s_cmp_eq_u32 s31, 0
s_cselect_b32 s58, -1920, s57
s_add_u32 s23, s23, s58
s_add_u32 s24, s24, s58
M a[84:87], a[208:211], a[240:243], a[84:87]
ds_read_b64_tr_b16 a[184:185], v15 offset:0
ds_read_b64_tr_b16 a[186:187], v15 offset:1536
M a[84:87], a[212:215], a[244:247], a[84:87]
v_mov_b32 v216, 0
v_mov_b32 v217, 0
M a[88:91], a[220:223], a[244:247], a[88:91]
M a[88:91], a[216:219], a[240:243], a[88:91]
buffer_load_dwordx4 a[0:3], v1, s[44:47], s64 offen offset:0 sc1
s_waitcnt lgkmcnt(8)
v_mov_b32 v218, 0
v_mov_b32 v219, 0
M a[92:95], a[200:203], a[248:251], a[92:95]
ds_read_b128 a[240:243], v10 offset:10240
ds_read_b128 a[244:247], v11 offset:10240
M a[92:95], a[204:207], a[252:255], a[92:95]
v_mov_b32 v220, 0
v_mov_b32 v221, 0
M a[96:99], a[212:215], a[252:255], a[96:99]
ds_read_b64_tr_b16 a[192:193], v16 offset:0
ds_read_b64_tr_b16 a[194:195], v16 offset:1536
M a[96:99], a[208:211], a[248:251], a[96:99]
buffer_load_dwordx4 a[4:7], v1, s[44:47], s64 offen offset:1024 sc1
v_mov_b32 v222, 0
v_mov_b32 v223, 0
M a[100:103], a[216:219], a[248:251], a[100:103]
M a[100:103], a[220:223], a[252:255], a[100:103]
s_waitcnt lgkmcnt(10)
M a[104:107], a[204:207], a[228:231], a[104:107]
ds_read_b128 a[248:251], v10 offset:12288
ds_read_b128 a[252:255], v11 offset:12288
v_mov_b32 v224, 0
v_mov_b32 v225, 0
M a[104:107], a[200:203], a[224:227], a[104:107]
buffer_load_dwordx4 a[8:11], v1, s[44:47], s64 offen offset:2048 sc1
M a[108:111], a[208:211], a[224:227], a[108:111]
ds_read_b64_tr_b16 a[180:181], v14 offset:12288
ds_read_b64_tr_b16 a[182:183], v14 offset:13824
v_mov_b32 v226, 0
v_mov_b32 v227, 0
M a[108:111], a[212:215], a[228:231], a[108:111]
M a[112:115], a[220:223], a[228:231], a[112:115]
buffer_load_dwordx4 a[12:15], v1, s[44:47], s64 offen offset:3072 sc1
s_add_u32 s64, s64, 4096
v_mov_b32 v228, 0
v_mov_b32 v229, 0
M a[112:115], a[216:219], a[224:227], a[112:115]
s_waitcnt lgkmcnt(10)
M a[116:119], a[200:203], a[232:235], a[116:119]
ds_read_b128 a[224:227], v10 offset:14336
ds_read_b128 a[228:231], v11 offset:14336
v_mov_b32 v230, 0
v_mov_b32 v231, 0
M a[116:119], a[204:207], a[236:239], a[116:119]
M a[120:123], a[212:215], a[236:239], a[120:123]
ds_read_b64_tr_b16 a[188:189], v15 offset:12288
ds_read_b64_tr_b16 a[190:191], v15 offset:13824
M a[120:123], a[208:211], a[232:235], a[120:123]
buffer_load_dwordx4 a[16:19], v1, s[44:47], s64 offen offset:0 sc1
v_mov_b32 v232, 0
v_mov_b32 v233, 0
M a[124:127], a[216:219], a[232:235], a[124:127]
M a[124:127], a[220:223], a[236:239], a[124:127]
buffer_load_dwordx4 a[20:23], v1, s[44:47], s64 offen offset:1024 sc1
s_waitcnt lgkmcnt(10)
v_mov_b32 v234, 0
v_mov_b32 v235, 0
M a[128:131], a[204:207], a[244:247], a[128:131]
ds_read_b128 a[232:235], v10 offset:16384
ds_read_b128 a[236:239], v11 offset:16384
M a[128:131], a[200:203], a[240:243], a[128:131]
v_mov_b32 v236, 0
v_mov_b32 v237, 0
M a[132:135], a[208:211], a[240:243], a[132:135]
ds_read_b64_tr_b16 a[196:197], v16 offset:12288
ds_read_b64_tr_b16 a[198:199], v16 offset:13824
M a[132:135], a[212:215], a[244:247], a[132:135]
v_mov_b32 v238, 0
v_mov_b32 v239, 0
M a[136:139], a[220:223], a[244:247], a[136:139]
buffer_load_dwordx4 a[24:27], v1, s[44:47], s64 offen offset:2048 sc1
M a[136:139], a[216:219], a[240:243], a[136:139]
s_waitcnt lgkmcnt(10)
M a[140:143], a[200:203], a[248:251], a[140:143]
buffer_load_dwordx4 a[28:31], v1, s[44:47], s64 offen offset:3072 sc1
s_add_u32 s64, s64, 4096
v_mov_b32 v240, 0
v_mov_b32 v241, 0
M a[140:143], a[204:207], a[252:255], a[140:143]
M a[144:147], a[212:215], a[252:255], a[144:147]
v_mov_b32 v242, 0
v_mov_b32 v243, 0
M a[144:147], a[208:211], a[248:251], a[144:147]
M a[148:151], a[216:219], a[248:251], a[148:151]
s_waitcnt vmcnt(15) lgkmcnt(0)
s_barrier
ds_read_b128 a[240:243], v10 offset:18432
ds_read_b128 a[244:247], v11 offset:18432
v_mov_b32 v244, 0
v_mov_b32 v245, 0
M a[148:151], a[220:223], a[252:255], a[148:151]
buffer_load_dwordx4 a[32:35], v1, s[44:47], s64 offen offset:0 sc1
M a[152:155], a[204:207], a[228:231], a[152:155]
ds_read_b128 a[248:251], v10 offset:20480
ds_read_b128 a[252:255], v11 offset:20480
v_mov_b32 v246, 0
v_mov_b32 v247, 0
M a[152:155], a[200:203], a[224:227], a[152:155]
M a[156:159], a[208:211], a[224:227], a[156:159]
buffer_load_dwordx4 a[36:39], v1, s[44:47], s64 offen offset:1024 sc1
M a[156:159], a[212:215], a[228:231], a[156:159]
v_mov_b32 v248, 0
v_mov_b32 v249, 0
M a[160:163], a[220:223], a[228:231], a[160:163]
M a[160:163], a[216:219], a[224:227], a[160:163]
buffer_load_dwordx4 a[40:43], v1, s[44:47], s64 offen offset:2048 sc1
v_mov_b32 v250, 0
v_mov_b32 v251, 0
M a[164:167], a[200:203], a[232:235], a[164:167]
ds_read_b128 a[224:227], v10 offset:22528
ds_read_b128 a[228:231], v11 offset:22528
M a[164:167], a[204:207], a[236:239], a[164:167]
v_mov_b32 v252, 0
v_mov_b32 v253, 0
M a[168:171], a[212:215], a[236:239], a[168:171]
M a[168:171], a[208:211], a[232:235], a[168:171]
buffer_load_dwordx4 a[44:47], v1, s[44:47], s64 offen offset:3072 sc1
s_add_u32 s64, s64, 4096
v_mov_b32 v254, 0
v_mov_b32 v255, 0
M a[172:175], a[216:219], a[232:235], a[172:175]
M a[172:175], a[220:223], a[236:239], a[172:175]
s_waitcnt lgkmcnt(4)
M a[68:71], a[176:179], a[240:243], a[68:71]
ds_read_b128 a[232:235], v10 offset:24576
ds_read_b128 a[236:239], v11 offset:24576
s_mov_b32 s22, s101
s_and_b32 s23, s22, 1
M a[68:71], a[180:183], a[244:247], a[68:71]
buffer_load_dwordx4 a[48:51], v1, s[44:47], s64 offen offset:0 sc1
M a[72:75], a[188:191], a[244:247], a[72:75]
ds_read_b64_tr_b16 a[200:201], v14 offset:28672
ds_read_b64_tr_b16 a[202:203], v14 offset:30208
s_lshr_b32 s24, s22, 1
s_lshl_b32 s33, s24, 14
M a[72:75], a[184:187], a[240:243], a[72:75]
M a[76:79], a[192:195], a[240:243], a[76:79]
M a[76:79], a[196:199], a[244:247], a[76:79]
s_waitcnt lgkmcnt(6)
s_lshl_b32 s34, s23, 13
s_add_u32 s29, s33, s34
M a[80:83], a[180:183], a[252:255], a[80:83]
ds_read_b128 a[240:243], v10 offset:26624
ds_read_b128 a[244:247], v11 offset:26624
M a[80:83], a[176:179], a[248:251], a[80:83]
s_lshl_b32 s28, s20, 20
s_add_u32 s28, s28, s34
M a[84:87], a[184:187], a[248:251], a[84:87]
ds_read_b64_tr_b16 a[208:209], v15 offset:28672
ds_read_b64_tr_b16 a[210:211], v15 offset:30208
M a[84:87], a[188:191], a[252:255], a[84:87]
buffer_load_dwordx4 a[52:55], v1, s[44:47], s64 offen offset:1024 sc1
M a[88:91], a[196:199], a[252:255], a[88:91]
s_mov_b32 s25, s28
s_lshl_b32 s33, s21, 16
M a[88:91], a[192:195], a[248:251], a[88:91]
s_waitcnt lgkmcnt(8)
M a[92:95], a[176:179], a[224:227], a[92:95]
ds_read_b128 a[248:251], v10 offset:28672
ds_read_b128 a[252:255], v11 offset:28672
s_add_u32 s34, s28, s33
s_add_u32 s34, s34, 65536
M a[92:95], a[180:183], a[228:231], a[92:95]
M a[96:99], a[188:191], a[228:231], a[96:99]
ds_read_b64_tr_b16 a[216:217], v16 offset:28672
ds_read_b64_tr_b16 a[218:219], v16 offset:30208
M a[96:99], a[184:187], a[224:227], a[96:99]
s_add_u32 s32, s28, 491520
s_sub_u32 s33, s32, s33
M a[100:103], a[192:195], a[224:227], a[100:103]
buffer_load_dwordx4 a[56:59], v1, s[44:47], s64 offen offset:2048 sc1
M a[100:103], a[196:199], a[228:231], a[100:103]
s_waitcnt lgkmcnt(10)
s_add_u32 s33, s33, 491520
s_cmp_eq_u32 s24, 0
s_cselect_b32 s27, s34, s32
s_cselect_b32 s28, s32, s33
M a[104:107], a[180:183], a[236:239], a[104:107]
ds_read_b128 a[224:227], v10 offset:30720
ds_read_b128 a[228:231], v11 offset:30720
M a[104:107], a[176:179], a[232:235], a[104:107]
M a[108:111], a[184:187], a[232:235], a[108:111]
ds_read_b64_tr_b16 a[204:205], v14 offset:40960
ds_read_b64_tr_b16 a[206:207], v14 offset:42496
s_add_u32 s26, s25, 16384
s_add_u32 s62, s27, 16384
M a[108:111], a[188:191], a[236:239], a[108:111]
M a[112:115], a[196:199], a[236:239], a[112:115]
s_add_u32 s63, s28, 16384
s_lshl_b32 s31, s21, 7
M a[112:115], a[192:195], a[232:235], a[112:115]
s_waitcnt lgkmcnt(10)
M a[116:119], a[176:179], a[240:243], a[116:119]
ds_read_b128 a[232:235], v10 offset:32768
ds_read_b128 a[236:239], v11 offset:32768
M a[116:119], a[180:183], a[244:247], a[116:119]
buffer_load_dwordx4 a[60:63], v1, s[44:47], s64 offen offset:3072 sc1
s_cmp_eq_u32 s24, 0
s_cselect_b32 s31, s31, 960
M a[120:123], a[188:191], a[244:247], a[120:123]
ds_read_b64_tr_b16 a[212:213], v15 offset:40960
ds_read_b64_tr_b16 a[214:215], v15 offset:42496
M a[120:123], a[184:187], a[240:243], a[120:123]
s_mov_b32 s60, 0
s_add_u32 s12, s4, 16777216
s_addc_u32 s13, s5, 0
M a[124:127], a[192:195], a[240:243], a[124:127]
M a[124:127], a[196:199], a[244:247], a[124:127]
s_waitcnt lgkmcnt(10)
M a[128:131], a[180:183], a[252:255], a[128:131]
ds_read_b128 a[240:243], v10 offset:34816
ds_read_b128 a[244:247], v11 offset:34816
s_mov_b32 s14, 33554432
s_mov_b32 s15, 0x00020000
M a[128:131], a[176:179], a[248:251], a[128:131]
M a[132:135], a[184:187], a[248:251], a[132:135]
ds_read_b64_tr_b16 a[220:221], v16 offset:40960
ds_read_b64_tr_b16 a[222:223], v16 offset:42496
s_mov_b32 s8, s4
s_mov_b32 s9, s5
M a[132:135], a[188:191], a[252:255], a[132:135]
buffer_load_dword v126, v119, s[36:39], 0 offen offset:128 sc1
M a[136:139], a[196:199], a[252:255], a[136:139]
M a[136:139], a[192:195], a[248:251], a[136:139]
s_waitcnt lgkmcnt(10)
s_mov_b32 s10, 16777216
s_mov_b32 s11, 0x00020000
M a[140:143], a[176:179], a[224:227], a[140:143]
M a[140:143], a[180:183], a[228:231], a[140:143]
M a[144:147], a[188:191], a[228:231], a[144:147]
M a[144:147], a[184:187], a[224:227], a[144:147]
M a[148:151], a[192:195], a[224:227], a[148:151]
s_waitcnt vmcnt(17) lgkmcnt(0)
s_barrier
ds_read_b128 a[248:251], v12 offset:0
ds_read_b128 a[252:255], v13 offset:0
s_waitcnt vmcnt(0)
v_cmp_gt_u32 vcc, 0x80, v126
s_nop 0
s_cbranch_vccnz Lk1_spin
Lk1_got:
M a[148:151], a[196:199], a[228:231], a[148:151]
s_add_u32 m0, s29, 65536
s_add_u32 s32, s25, 4096
buffer_load_dwordx4 v1, s[12:15], s25 offen offset:0 sc1 lds
M a[152:155], a[180:183], a[236:239], a[152:155]
ds_read_b128 a[224:227], v12 offset:2048
ds_read_b128 a[228:231], v13 offset:2048
M a[152:155], a[176:179], a[232:235], a[152:155]
buffer_load_dwordx4 v1, s[12:15], s25 offen offset:1024 sc1 lds
M a[156:159], a[184:187], a[232:235], a[156:159]
M a[156:159], a[188:191], a[236:239], a[156:159]
buffer_load_dwordx4 v1, s[12:15], s25 offen offset:2048 sc1 lds
M a[160:163], a[196:199], a[236:239], a[160:163]
buffer_load_dwordx4 v1, s[12:15], s25 offen offset:3072 sc1 lds
M a[160:163], a[192:195], a[232:235], a[160:163]
M a[164:167], a[176:179], a[240:243], a[164:167]
ds_read_b128 a[232:235], v12 offset:4096
ds_read_b128 a[236:239], v13 offset:4096
M a[164:167], a[180:183], a[244:247], a[164:167]
s_add_u32 m0, s29, 69632
s_nop 0
buffer_load_dwordx4 v1, s[12:15], s32 offen offset:0 sc1 lds
M a[168:171], a[188:191], a[244:247], a[168:171]
buffer_load_dwordx4 v1, s[12:15], s32 offen offset:1024 sc1 lds
M a[168:171], a[184:187], a[240:243], a[168:171]
M a[172:175], a[192:195], a[240:243], a[172:175]
buffer_load_dwordx4 v1, s[12:15], s32 offen offset:2048 sc1 lds
M a[172:175], a[196:199], a[244:247], a[172:175]
s_waitcnt lgkmcnt(4)
M a[68:71], a[200:203], a[248:251], a[68:71]
ds_read_b128 a[240:243], v12 offset:6144
ds_read_b128 a[244:247], v13 offset:6144
M a[68:71], a[204:207], a[252:255], a[68:71]
buffer_load_dwordx4 v1, s[12:15], s32 offen offset:3072 sc1 lds
M a[72:75], a[212:215], a[252:255], a[72:75]
M a[72:75], a[208:211], a[248:251], a[72:75]
M a[76:79], a[216:219], a[248:251], a[76:79]
M a[76:79], a[220:223], a[252:255], a[76:79]
s_waitcnt lgkmcnt(4)
M a[80:83], a[204:207], a[228:231], a[80:83]
ds_read_b128 a[248:251], v12 offset:8192
ds_read_b128 a[252:255], v13 offset:8192
M a[80:83], a[200:203], a[224:227], a[80:83]
M a[84:87], a[208:211], a[224:227], a[84:87]
M a[84:87], a[212:215], a[228:231], a[84:87]
M a[88:91], a[220:223], a[228:231], a[88:91]
M a[88:91], a[216:219], a[224:227], a[88:91]
s_waitcnt lgkmcnt(4)
M a[92:95], a[200:203], a[232:235], a[92:95]
ds_read_b128 a[224:227], v12 offset:10240
ds_read_b128 a[228:231], v13 offset:10240
v_accvgpr_read_b32 v24, a68
v_accvgpr_read_b32 v25, a69
v_accvgpr_read_b32 v26, a70
M a[92:95], a[204:207], a[236:239], a[92:95]
v_accvgpr_read_b32 v27, a71
v_cvt_pk_bf16_f32 v24, v24, v25
v_cvt_pk_bf16_f32 v25, v26, v27
ds_write_b64 v124, v[24:25] offset:0
M a[96:99], a[212:215], a[236:239], a[96:99]
v_accvgpr_read_b32 v28, a72
v_accvgpr_read_b32 v29, a73
v_accvgpr_read_b32 v30, a74
M a[96:99], a[208:211], a[232:235], a[96:99]
v_accvgpr_read_b32 v31, a75
v_cvt_pk_bf16_f32 v28, v28, v29
v_cvt_pk_bf16_f32 v29, v30, v31
ds_write_b64 v124, v[28:29] offset:32
M a[100:103], a[216:219], a[232:235], a[100:103]
v_accvgpr_read_b32 v24, a76
v_accvgpr_read_b32 v25, a77
v_accvgpr_read_b32 v26, a78
M a[100:103], a[220:223], a[236:239], a[100:103]
s_waitcnt lgkmcnt(6)
v_accvgpr_read_b32 v27, a79
v_cvt_pk_bf16_f32 v24, v24, v25
v_cvt_pk_bf16_f32 v25, v26, v27
ds_write_b64 v124, v[24:25] offset:64
M a[104:107], a[204:207], a[244:247], a[104:107]
ds_read_b128 a[232:235], v12 offset:12288
ds_read_b128 a[236:239], v13 offset:12288
v_accvgpr_read_b32 v24, a80
v_accvgpr_read_b32 v25, a81
v_accvgpr_read_b32 v26, a82
M a[104:107], a[200:203], a[240:243], a[104:107]
v_accvgpr_read_b32 v27, a83
v_cvt_pk_bf16_f32 v24, v24, v25
v_cvt_pk_bf16_f32 v25, v26, v27
ds_write_b64 v124, v[24:25] offset:6400
M a[108:111], a[208:211], a[240:243], a[108:111]
v_accvgpr_read_b32 v28, a84
v_accvgpr_read_b32 v29, a85
v_accvgpr_read_b32 v30, a86
M a[108:111], a[212:215], a[244:247], a[108:111]
v_accvgpr_read_b32 v31, a87
v_cvt_pk_bf16_f32 v28, v28, v29
v_cvt_pk_bf16_f32 v29, v30, v31
ds_write_b64 v124, v[28:29] offset:6432
M a[112:115], a[220:223], a[244:247], a[112:115]
v_accvgpr_read_b32 v24, a88
v_accvgpr_read_b32 v25, a89
v_accvgpr_read_b32 v26, a90
M a[112:115], a[216:219], a[240:243], a[112:115]
s_waitcnt lgkmcnt(9)
v_accvgpr_read_b32 v27, a91
v_cvt_pk_bf16_f32 v24, v24, v25
v_cvt_pk_bf16_f32 v25, v26, v27
ds_write_b64 v124, v[24:25] offset:6464
M a[116:119], a[200:203], a[248:251], a[116:119]
ds_read_b128 a[240:243], v12 offset:14336
ds_read_b128 a[244:247], v13 offset:14336
v_accvgpr_read_b32 v24, a92
v_accvgpr_read_b32 v25, a93
v_accvgpr_read_b32 v26, a94
M a[116:119], a[204:207], a[252:255], a[116:119]
v_accvgpr_read_b32 v27, a95
v_cvt_pk_bf16_f32 v24, v24, v25
v_cvt_pk_bf16_f32 v25, v26, v27
ds_write_b64 v124, v[24:25] offset:12800
M a[120:123], a[212:215], a[252:255], a[120:123]
v_accvgpr_read_b32 v28, a96
v_accvgpr_read_b32 v29, a97
v_accvgpr_read_b32 v30, a98
M a[120:123], a[208:211], a[248:251], a[120:123]
v_accvgpr_read_b32 v31, a99
v_cvt_pk_bf16_f32 v28, v28, v29
v_cvt_pk_bf16_f32 v29, v30, v31
ds_write_b64 v124, v[28:29] offset:12832
M a[124:127], a[216:219], a[248:251], a[124:127]
v_accvgpr_read_b32 v24, a100
v_accvgpr_read_b32 v25, a101
v_accvgpr_read_b32 v26, a102
M a[124:127], a[220:223], a[252:255], a[124:127]
s_add_u32 s25, s25, 32768
s_cmp_eq_u32 s25, s27
s_cselect_b32 s25, s28, s25
s_cselect_b32 s27, -1, s27
s_waitcnt lgkmcnt(12)
v_accvgpr_read_b32 v27, a103
v_cvt_pk_bf16_f32 v24, v24, v25
v_cvt_pk_bf16_f32 v25, v26, v27
ds_write_b64 v124, v[24:25] offset:12864
M a[128:131], a[204:207], a[228:231], a[128:131]
ds_read_b128 a[248:251], v12 offset:16384
ds_read_b128 a[252:255], v13 offset:16384
v_accvgpr_read_b32 v24, a104
v_accvgpr_read_b32 v25, a105
v_accvgpr_read_b32 v26, a106
M a[128:131], a[200:203], a[224:227], a[128:131]
v_accvgpr_read_b32 v27, a107
v_cvt_pk_bf16_f32 v24, v24, v25
v_cvt_pk_bf16_f32 v25, v26, v27
ds_write_b64 v124, v[24:25] offset:19200
M a[132:135], a[208:211], a[224:227], a[132:135]
v_accvgpr_read_b32 v28, a108
v_accvgpr_read_b32 v29, a109
v_accvgpr_read_b32 v30, a110
M a[132:135], a[212:215], a[228:231], a[132:135]
v_accvgpr_read_b32 v31, a111
v_cvt_pk_bf16_f32 v28, v28, v29
v_cvt_pk_bf16_f32 v29, v30, v31
ds_write_b64 v124, v[28:29] offset:19232
M a[136:139], a[220:223], a[228:231], a[136:139]
v_accvgpr_read_b32 v24, a112
v_accvgpr_read_b32 v25, a113
v_accvgpr_read_b32 v26, a114
M a[136:139], a[216:219], a[224:227], a[136:139]
s_waitcnt lgkmcnt(12)
v_accvgpr_read_b32 v27, a115
v_cvt_pk_bf16_f32 v24, v24, v25
v_cvt_pk_bf16_f32 v25, v26, v27
ds_write_b64 v124, v[24:25] offset:19264
M a[140:143], a[200:203], a[232:235], a[140:143]
v_accvgpr_read_b32 v24, a116
v_accvgpr_read_b32 v25, a117
v_accvgpr_read_b32 v26, a118
M a[140:143], a[204:207], a[236:239], a[140:143]
v_accvgpr_read_b32 v27, a119
v_cvt_pk_bf16_f32 v24, v24, v25
v_cvt_pk_bf16_f32 v25, v26, v27
ds_write_b64 v124, v[24:25] offset:25600
M a[144:147], a[212:215], a[236:239], a[144:147]
v_accvgpr_read_b32 v28, a120
v_accvgpr_read_b32 v29, a121
v_accvgpr_read_b32 v30, a122
M a[144:147], a[208:211], a[232:235], a[144:147]
v_accvgpr_read_b32 v31, a123
v_cvt_pk_bf16_f32 v28, v28, v29
v_cvt_pk_bf16_f32 v29, v30, v31
ds_write_b64 v124, v[28:29] offset:25632
M a[148:151], a[216:219], a[232:235], a[148:151]
s_waitcnt lgkmcnt(0)
s_barrier
v_accvgpr_read_b32 v24, a124
v_accvgpr_read_b32 v25, a125
v_accvgpr_read_b32 v26, a126
M a[148:151], a[220:223], a[236:239], a[148:151]
v_accvgpr_read_b32 v27, a127
v_cvt_pk_bf16_f32 v24, v24, v25
v_cvt_pk_bf16_f32 v25, v26, v27
ds_write_b64 v124, v[24:25] offset:25664
v_accvgpr_read_b32 v24, a128
v_accvgpr_read_b32 v25, a129
v_accvgpr_read_b32 v26, a130
M a[152:155], a[204:207], a[244:247], a[152:155]
v_accvgpr_read_b32 v27, a131
v_cvt_pk_bf16_f32 v24, v24, v25
v_cvt_pk_bf16_f32 v25, v26, v27
M a[152:155], a[200:203], a[240:243], a[152:155]
ds_write_b64 v124, v[24:25] offset:32000
v_accvgpr_read_b32 v28, a132
v_accvgpr_read_b32 v29, a133
M a[156:159], a[208:211], a[240:243], a[156:159]
v_accvgpr_read_b32 v30, a134
v_accvgpr_read_b32 v31, a135
v_cvt_pk_bf16_f32 v28, v28, v29
M a[156:159], a[212:215], a[244:247], a[156:159]
v_cvt_pk_bf16_f32 v29, v30, v31
ds_write_b64 v124, v[28:29] offset:32032
v_accvgpr_read_b32 v24, a136
M a[160:163], a[220:223], a[244:247], a[160:163]
v_accvgpr_read_b32 v25, a137
v_accvgpr_read_b32 v26, a138
v_accvgpr_read_b32 v27, a139
M a[160:163], a[216:219], a[240:243], a[160:163]
v_cvt_pk_bf16_f32 v24, v24, v25
v_cvt_pk_bf16_f32 v25, v26, v27
ds_write_b64 v124, v[24:25] offset:32064
M a[164:167], a[200:203], a[248:251], a[164:167]
v_accvgpr_read_b32 v24, a140
v_accvgpr_read_b32 v25, a141
v_accvgpr_read_b32 v26, a142
M a[164:167], a[204:207], a[252:255], a[164:167]
v_accvgpr_read_b32 v27, a143
v_cvt_pk_bf16_f32 v24, v24, v25
v_cvt_pk_bf16_f32 v25, v26, v27
ds_write_b64 v124, v[24:25] offset:38400
M a[168:171], a[212:215], a[252:255], a[168:171]
v_accvgpr_read_b32 v28, a144
v_accvgpr_read_b32 v29, a145
v_accvgpr_read_b32 v30, a146
M a[168:171], a[208:211], a[248:251], a[168:171]
v_accvgpr_read_b32 v31, a147
v_cvt_pk_bf16_f32 v28, v28, v29
v_cvt_pk_bf16_f32 v29, v30, v31
ds_write_b64 v124, v[28:29] offset:38432
M a[172:175], a[216:219], a[248:251], a[172:175]
v_accvgpr_read_b32 v24, a148
v_accvgpr_read_b32 v25, a149
v_accvgpr_read_b32 v26, a150
M a[172:175], a[220:223], a[252:255], a[172:175]
v_accvgpr_read_b32 v27, a151
v_cvt_pk_bf16_f32 v24, v24, v25
v_cvt_pk_bf16_f32 v25, v26, v27
ds_write_b64 v124, v[24:25] offset:38464
s_mov_b64 s[44:45], s[42:43]
v_accvgpr_read_b32 v24, a152
v_accvgpr_read_b32 v25, a153
v_accvgpr_read_b32 v26, a154
v_accvgpr_read_b32 v27, a155
v_cvt_pk_bf16_f32 v24, v24, v25
v_cvt_pk_bf16_f32 v25, v26, v27
ds_write_b64 v124, v[24:25] offset:44800
v_accvgpr_read_b32 v28, a156
v_accvgpr_read_b32 v29, a157
v_accvgpr_read_b32 v30, a158
v_accvgpr_read_b32 v31, a159
v_cvt_pk_bf16_f32 v28, v28, v29
v_cvt_pk_bf16_f32 v29, v30, v31
ds_write_b64 v124, v[28:29] offset:44832
v_accvgpr_read_b32 v24, a160
v_accvgpr_read_b32 v25, a161
v_accvgpr_read_b32 v26, a162
v_accvgpr_read_b32 v27, a163
v_cvt_pk_bf16_f32 v24, v24, v25
v_cvt_pk_bf16_f32 v25, v26, v27
ds_write_b64 v124, v[24:25] offset:44864
v_accvgpr_read_b32 v24, a164
v_accvgpr_read_b32 v25, a165
v_accvgpr_read_b32 v26, a166
v_accvgpr_read_b32 v27, a167
v_cvt_pk_bf16_f32 v24, v24, v25
v_cvt_pk_bf16_f32 v25, v26, v27
ds_write_b64 v124, v[24:25] offset:51200
v_accvgpr_read_b32 v28, a168
v_accvgpr_read_b32 v29, a169
v_accvgpr_read_b32 v30, a170
v_accvgpr_read_b32 v31, a171
v_cvt_pk_bf16_f32 v28, v28, v29
v_cvt_pk_bf16_f32 v29, v30, v31
ds_write_b64 v124, v[28:29] offset:51232
v_accvgpr_read_b32 v24, a172
v_accvgpr_read_b32 v25, a173
v_accvgpr_read_b32 v26, a174
v_accvgpr_read_b32 v27, a175
v_cvt_pk_bf16_f32 v24, v24, v25
v_cvt_pk_bf16_f32 v25, v26, v27
ds_write_b64 v124, v[24:25] offset:51264
s_waitcnt lgkmcnt(0)
s_barrier
ds_read_b128 v[48:51], v121 offset:128
ds_read_b128 v[32:35], v120 offset:0
ds_read_b128 v[52:55], v120 offset:128
ds_read_b128 v[36:39], v120 offset:12800
ds_read_b128 v[56:59], v120 offset:12928
ds_read_b128 v[40:43], v120 offset:25600
ds_read_b128 v[60:63], v120 offset:25728
ds_read_b128 v[44:47], v120 offset:38400
ds_read_b128 v[64:67], v120 offset:38528
ds_read_b64_tr_b16 v[68:69], v123 offset:256
ds_read_b64_tr_b16 v[70:71], v122 offset:256
ds_read_b64_tr_b16 v[72:73], v122 offset:13056
ds_read_b64_tr_b16 v[74:75], v122 offset:25856
ds_read_b64_tr_b16 v[76:77], v122 offset:38656
ds_read_b64_tr_b16 v[78:79], v123 offset:288
ds_read_b64_tr_b16 v[80:81], v122 offset:288
ds_read_b64_tr_b16 v[82:83], v122 offset:13088
ds_read_b64_tr_b16 v[84:85], v122 offset:25888
ds_read_b64_tr_b16 v[86:87], v122 offset:38688
v_accvgpr_write_b32 a64, 0
v_accvgpr_write_b32 a65, 0
v_accvgpr_write_b32 a66, 0
v_accvgpr_write_b32 a67, 0
v_accvgpr_write_b32 a68, 0
v_accvgpr_write_b32 a69, 0
v_accvgpr_write_b32 a70, 0
v_accvgpr_write_b32 a71, 0
v_accvgpr_write_b32 a72, 0
v_accvgpr_write_b32 a73, 0
v_accvgpr_write_b32 a74, 0
v_accvgpr_write_b32 a75, 0
s_add_u32 m0, s29, 0
s_add_u32 s32, s25, 4096
buffer_load_dwordx4 v1, s[12:15], s25 offen offset:0 sc1 lds
v_accvgpr_write_b32 a76, 0
v_accvgpr_write_b32 a77, 0
v_accvgpr_write_b32 a78, 0
v_accvgpr_write_b32 a79, 0
v_accvgpr_write_b32 a80, 0
v_accvgpr_write_b32 a81, 0
v_accvgpr_write_b32 a82, 0
v_accvgpr_write_b32 a83, 0
v_accvgpr_write_b32 a84, 0
v_accvgpr_write_b32 a85, 0
v_accvgpr_write_b32 a86, 0
buffer_load_dwordx4 v1, s[12:15], s25 offen offset:1024 sc1 lds
v_accvgpr_write_b32 a87, 0
v_accvgpr_write_b32 a88, 0
v_accvgpr_write_b32 a89, 0
v_accvgpr_write_b32 a90, 0
v_accvgpr_write_b32 a91, 0
v_accvgpr_write_b32 a92, 0
v_accvgpr_write_b32 a93, 0
v_accvgpr_write_b32 a94, 0
v_accvgpr_write_b32 a95, 0
v_accvgpr_write_b32 a96, 0
buffer_load_dwordx4 v1, s[12:15], s25 offen offset:2048 sc1 lds
v_accvgpr_write_b32 a97, 0
v_accvgpr_write_b32 a98, 0
v_accvgpr_write_b32 a99, 0
v_accvgpr_write_b32 a100, 0
v_accvgpr_write_b32 a101, 0
v_accvgpr_write_b32 a102, 0
v_accvgpr_write_b32 a103, 0
v_accvgpr_write_b32 a104, 0
v_accvgpr_write_b32 a105, 0
v_accvgpr_write_b32 a106, 0
v_accvgpr_write_b32 a107, 0
buffer_load_dwordx4 v1, s[12:15], s25 offen offset:3072 sc1 lds
v_accvgpr_write_b32 a108, 0
v_accvgpr_write_b32 a109, 0
v_accvgpr_write_b32 a110, 0
v_accvgpr_write_b32 a111, 0
s_waitcnt lgkmcnt(15)
M v[88:91], v[48:51], v[32:35], v[152:155]
M v[92:95], v[52:55], v[32:35], v[148:151]
M v[96:99], v[52:55], v[36:39], v[144:147]
s_waitcnt lgkmcnt(14)
M v[100:103], v[56:59], v[36:39], v[148:151]
s_waitcnt lgkmcnt(13)
M v[104:107], v[56:59], v[40:43], v[144:147]
s_waitcnt lgkmcnt(12)
M v[108:111], v[60:63], v[40:43], v[148:151]
s_add_u32 m0, s29, 4096
s_nop 0
buffer_load_dwordx4 v1, s[12:15], s32 offen offset:0 sc1 lds
s_waitcnt lgkmcnt(11)
M v[112:115], v[60:63], v[44:47], v[144:147]
s_waitcnt lgkmcnt(10)
M v[116:119], v[64:67], v[44:47], v[148:151]
v_max3_f32 v136, v88, v89, v90
v_max3_f32 v136, v136, v91, v92
v_max3_f32 v136, v136, v93, v94
v_max_f32 v136, v136, v95
v_max3_f32 v137, v96, v97, v98
v_max3_f32 v137, v137, v99, v100
v_max3_f32 v137, v137, v101, v102
v_max_f32 v137, v137, v103
v_max3_f32 v138, v104, v105, v106
buffer_load_dwordx4 v1, s[12:15], s32 offen offset:1024 sc1 lds
v_max3_f32 v138, v138, v107, v108
v_max3_f32 v138, v138, v109, v110
v_max_f32 v138, v138, v111
v_max3_f32 v139, v112, v113, v114
v_max3_f32 v139, v139, v115, v116
v_max3_f32 v139, v139, v117, v118
v_max_f32 v139, v139, v119
v_mov_b32 v140, v136
v_mov_b32 v141, v137
v_mov_b32 v142, v138
buffer_load_dwordx4 v1, s[12:15], s32 offen offset:2048 sc1 lds
v_mov_b32 v143, v139
v_permlane16_swap_b32 v136, v140
v_permlane16_swap_b32 v137, v141
v_permlane16_swap_b32 v138, v142
v_permlane16_swap_b32 v139, v143
v_max_f32 v136, v136, v140
v_max_f32 v137, v137, v141
v_max_f32 v138, v138, v142
v_max_f32 v139, v139, v143
v_mov_b32 v140, v136
v_mov_b32 v141, v137
buffer_load_dwordx4 v1, s[12:15], s32 offen offset:3072 sc1 lds
v_mov_b32 v142, v138
v_mov_b32 v143, v139
v_permlane32_swap_b32 v136, v140
v_permlane32_swap_b32 v137, v141
v_permlane32_swap_b32 v138, v142
v_permlane32_swap_b32 v139, v143
v_max_f32 v136, v136, v140
v_max_f32 v137, v137, v141
v_max_f32 v138, v138, v142
v_max_f32 v139, v139, v143
s_add_u32 s25, s25, 32768
s_cmp_eq_u32 s25, s27
s_cselect_b32 s25, s28, s25
s_cselect_b32 s27, -1, s27
v_mul_f32 v136, s7, v136
v_mul_f32 v137, s7, v137
v_mul_f32 v138, s7, v138
v_mul_f32 v139, s7, v139
v_fma_f32 v88, v88, s7, -v136
v_fma_f32 v89, v89, s7, -v136
v_fma_f32 v90, v90, s7, -v136
v_fma_f32 v91, v91, s7, -v136
v_fma_f32 v92, v92, s7, -v136
v_fma_f32 v93, v93, s7, -v136
v_fma_f32 v94, v94, s7, -v136
s_add_u32 m0, s29, 32768
s_add_u32 s32, s26, 4096
buffer_load_dwordx4 v1, s[12:15], s26 offen offset:0 sc1 lds
v_fma_f32 v95, v95, s7, -v136
v_exp_f32 v88, v88
v_exp_f32 v89, v89
v_exp_f32 v90, v90
v_exp_f32 v91, v91
v_exp_f32 v92, v92
v_exp_f32 v93, v93
v_exp_f32 v94, v94
v_exp_f32 v95, v95
v_fma_f32 v96, v96, s7, -v137
v_fma_f32 v97, v97, s7, -v137
buffer_load_dwordx4 v1, s[12:15], s26 offen offset:1024 sc1 lds
v_fma_f32 v98, v98, s7, -v137
v_fma_f32 v99, v99, s7, -v137
v_fma_f32 v100, v100, s7, -v137
v_fma_f32 v101, v101, s7, -v137
v_fma_f32 v102, v102, s7, -v137
v_fma_f32 v103, v103, s7, -v137
v_exp_f32 v96, v96
v_exp_f32 v97, v97
v_exp_f32 v98, v98
v_exp_f32 v99, v99
buffer_load_dwordx4 v1, s[12:15], s26 offen offset:2048 sc1 lds
v_exp_f32 v100, v100
v_exp_f32 v101, v101
v_exp_f32 v102, v102
v_exp_f32 v103, v103
v_fma_f32 v104, v104, s7, -v138
v_fma_f32 v105, v105, s7, -v138
v_fma_f32 v106, v106, s7, -v138
v_fma_f32 v107, v107, s7, -v138
v_fma_f32 v108, v108, s7, -v138
v_fma_f32 v109, v109, s7, -v138
v_fma_f32 v110, v110, s7, -v138
buffer_load_dwordx4 v1, s[12:15], s26 offen offset:3072 sc1 lds
v_fma_f32 v111, v111, s7, -v138
v_exp_f32 v104, v104
v_exp_f32 v105, v105
v_exp_f32 v106, v106
v_exp_f32 v107, v107
v_exp_f32 v108, v108
v_exp_f32 v109, v109
v_exp_f32 v110, v110
v_exp_f32 v111, v111
v_fma_f32 v112, v112, s7, -v139
s_add_u32 m0, s29, 36864
s_nop 0
buffer_load_dwordx4 v1, s[12:15], s32 offen offset:0 sc1 lds
v_fma_f32 v113, v113, s7, -v139
v_fma_f32 v114, v114, s7, -v139
v_fma_f32 v115, v115, s7, -v139
v_fma_f32 v116, v116, s7, -v139
v_fma_f32 v117, v117, s7, -v139
v_fma_f32 v118, v118, s7, -v139
v_fma_f32 v119, v119, s7, -v139
v_exp_f32 v112, v112
v_exp_f32 v113, v113
v_exp_f32 v114, v114
v_exp_f32 v115, v115
buffer_load_dwordx4 v1, s[12:15], s32 offen offset:1024 sc1 lds
v_exp_f32 v116, v116
v_exp_f32 v117, v117
v_exp_f32 v118, v118
v_exp_f32 v119, v119
v_cvt_pk_bf16_f32 v88, v88, v89
v_cvt_pk_bf16_f32 v89, v90, v91
v_cvt_pk_bf16_f32 v90, v92, v93
v_cvt_pk_bf16_f32 v91, v94, v95
v_cvt_pk_bf16_f32 v96, v96, v97
v_cvt_pk_bf16_f32 v97, v98, v99
buffer_load_dwordx4 v1, s[12:15], s32 offen offset:2048 sc1 lds
v_cvt_pk_bf16_f32 v98, v100, v101
v_cvt_pk_bf16_f32 v99, v102, v103
v_cvt_pk_bf16_f32 v104, v104, v105
v_cvt_pk_bf16_f32 v105, v106, v107
v_cvt_pk_bf16_f32 v106, v108, v109
v_cvt_pk_bf16_f32 v107, v110, v111
v_cvt_pk_bf16_f32 v112, v112, v113
v_cvt_pk_bf16_f32 v113, v114, v115
v_cvt_pk_bf16_f32 v114, v116, v117
v_cvt_pk_bf16_f32 v115, v118, v119
M v[120:123], v[156:159], v[88:91], 0
buffer_load_dwordx4 v1, s[12:15], s32 offen offset:3072 sc1 lds
s_waitcnt lgkmcnt(8)
M v[32:35], v[68:71], v[88:91], 0
s_waitcnt lgkmcnt(3)
M v[36:39], v[78:81], v[88:91], 0
M v[124:127], v[156:159], v[96:99], 0
M v[40:43], v[70:73], v[96:99], 0
s_waitcnt lgkmcnt(2)
M v[44:47], v[80:83], v[96:99], 0
M v[128:131], v[156:159], v[104:107], 0
M v[48:51], v[72:75], v[104:107], 0
s_waitcnt lgkmcnt(1)
M v[52:55], v[82:85], v[104:107], 0
M v[132:135], v[156:159], v[112:115], 0
M v[56:59], v[74:77], v[112:115], 0
s_add_u32 s26, s26, 32768
s_cmp_eq_u32 s26, s62
s_cselect_b32 s26, s63, s26
s_cselect_b32 s62, -1, s62
s_waitcnt lgkmcnt(0)
M v[60:63], v[84:87], v[112:115], 0
v_rcp_f32 v120, v120
v_rcp_f32 v124, v124
v_rcp_f32 v128, v128
v_rcp_f32 v132, v132
v_pk_mul_f32 v[32:33], v[32:33], v[120:121] op_sel_hi:[1,0]
v_pk_mul_f32 v[34:35], v[34:35], v[120:121] op_sel_hi:[1,0]
v_pk_mul_f32 v[36:37], v[36:37], v[120:121] op_sel_hi:[1,0]
v_pk_mul_f32 v[38:39], v[38:39], v[120:121] op_sel_hi:[1,0]
v_cvt_pk_bf16_f32 v32, v32, v33
v_cvt_pk_bf16_f32 v33, v34, v35
v_cvt_pk_bf16_f32 v34, v36, v37
v_cvt_pk_bf16_f32 v35, v38, v39
s_add_u32 s3, s6, 0
buffer_store_dwordx4 v[32:35], v1, s[16:19], s3 offen sc1
v_pk_mul_f32 v[40:41], v[40:41], v[124:125] op_sel_hi:[1,0]
v_pk_mul_f32 v[42:43], v[42:43], v[124:125] op_sel_hi:[1,0]
v_pk_mul_f32 v[44:45], v[44:45], v[124:125] op_sel_hi:[1,0]
v_pk_mul_f32 v[46:47], v[46:47], v[124:125] op_sel_hi:[1,0]
v_cvt_pk_bf16_f32 v40, v40, v41
v_cvt_pk_bf16_f32 v41, v42, v43
v_cvt_pk_bf16_f32 v42, v44, v45
v_cvt_pk_bf16_f32 v43, v46, v47
s_add_u32 s3, s6, 2048
buffer_store_dwordx4 v[40:43], v1, s[16:19], s3 offen sc1
v_pk_mul_f32 v[48:49], v[48:49], v[128:129] op_sel_hi:[1,0]
v_pk_mul_f32 v[50:51], v[50:51], v[128:129] op_sel_hi:[1,0]
v_pk_mul_f32 v[52:53], v[52:53], v[128:129] op_sel_hi:[1,0]
v_pk_mul_f32 v[54:55], v[54:55], v[128:129] op_sel_hi:[1,0]
v_cvt_pk_bf16_f32 v48, v48, v49
v_cvt_pk_bf16_f32 v49, v50, v51
v_cvt_pk_bf16_f32 v50, v52, v53
v_cvt_pk_bf16_f32 v51, v54, v55
s_add_u32 s3, s6, 4096
buffer_store_dwordx4 v[48:51], v1, s[16:19], s3 offen sc1
v_pk_mul_f32 v[56:57], v[56:57], v[132:133] op_sel_hi:[1,0]
v_pk_mul_f32 v[58:59], v[58:59], v[132:133] op_sel_hi:[1,0]
v_pk_mul_f32 v[60:61], v[60:61], v[132:133] op_sel_hi:[1,0]
v_pk_mul_f32 v[62:63], v[62:63], v[132:133] op_sel_hi:[1,0]
v_cvt_pk_bf16_f32 v56, v56, v57
v_cvt_pk_bf16_f32 v57, v58, v59
v_cvt_pk_bf16_f32 v58, v60, v61
v_cvt_pk_bf16_f32 v59, v62, v63
s_add_u32 s3, s6, 6144
buffer_store_dwordx4 v[56:59], v1, s[16:19], s3 offen sc1
Lc2:
s_add_u32 s16, s4, 67108864
s_addc_u32 s17, s5, 0
s_mov_b32 s18, 16777216
s_mov_b32 s19, 0x00020000
s_add_u32 s52, s4, 100663296
s_addc_u32 s53, s5, 0
s_mov_b32 s54, 8404992
s_mov_b32 s55, 0x00020000
s_mov_b32 s46, 8388608
s_mov_b32 s47, 0x00020000
s_mov_b32 s50, 2097152
s_mov_b32 s51, 0x00020000
s_lshl_b32 s33, s24, 14
v_add_u32 v2, s33, v1
v_add_u32 v3, 0x10000, v2
v_and_b32 v8, 15, v0
v_bfe_u32 v9, v0, 4, 2
v_lshlrev_b32 v9, 2, v9
v_sub_u32 v8, v8, v9
v_mov_b32 v4, 0xf149f2ca
v_cmp_gt_i32 vcc, 0, v8
s_nop 1
v_cndmask_b32 v16, 0, v4, vcc
v_cmp_gt_i32 vcc, 1, v8
s_nop 1
v_cndmask_b32 v17, 0, v4, vcc
v_cmp_gt_i32 vcc, 2, v8
s_nop 1
v_cndmask_b32 v18, 0, v4, vcc
v_cmp_gt_i32 vcc, 3, v8
s_nop 1
v_cndmask_b32 v19, 0, v4, vcc
v_mov_b32 v8, 0x3f803f80
v_accvgpr_write_b32 a112, v8
v_accvgpr_write_b32 a113, v8
v_accvgpr_write_b32 a114, v8
v_accvgpr_write_b32 a115, v8
s_lshl_b32 s33, s23, 6
s_add_i32 s33, s33, s31
s_cmp_gt_i32 s33, 0
s_cselect_b32 s34, 0, 0xf149f2ca
s_cmp_lt_i32 s33, 0
s_cselect_b32 s33, 0xf149f2ca, 0
v_mov_b32 v20, s34
v_mov_b32 v21, s34
v_mov_b32 v22, s34
v_mov_b32 v23, s34
v_mov_b32 v28, s33
v_mov_b32 v29, s33
v_mov_b32 v30, s33
v_mov_b32 v31, s33
v_med3_f32 v24, v16, v20, v28
v_med3_f32 v25, v17, v20, v28
v_med3_f32 v26, v18, v20, v28
v_med3_f32 v27, v19, v20, v28
v_mov_b32 v5, 0
v_mov_b32 v6, 1
s_waitcnt vmcnt(20)
s_barrier
ds_read_b128 a[116:119], v3 offset:0
ds_read_b128 a[120:123], v3 offset:1024
ds_read_b128 a[124:127], v3 offset:2048
ds_read_b128 a[128:131], v3 offset:3072
ds_read_b128 a[132:135], v3 offset:4096
ds_read_b128 a[136:139], v3 offset:5120
ds_read_b128 a[140:143], v3 offset:6144
ds_read_b128 a[144:147], v3 offset:7168
s_waitcnt lgkmcnt(4)
M v[32:35], a[116:119], a[0:3], v[24:27]
M v[32:35], a[120:123], a[4:7], v[32:35]
ds_read_b128 a[148:151], v3 offset:8192
ds_read_b128 a[152:155], v3 offset:9216
M v[32:35], a[124:127], a[8:11], v[32:35]
M v[32:35], a[128:131], a[12:15], v[32:35]
M v[36:39], a[128:131], a[28:31], v[28:31]
M v[36:39], a[124:127], a[24:27], v[36:39]
M v[36:39], a[120:123], a[20:23], v[36:39]
M v[36:39], a[116:119], a[16:19], v[36:39]
M v[40:43], a[116:119], a[32:35], v[28:31]
M v[40:43], a[120:123], a[36:39], v[40:43]
ds_read_b128 a[156:159], v3 offset:10240
ds_read_b128 a[160:163], v3 offset:11264
M v[40:43], a[124:127], a[40:43], v[40:43]
M v[40:43], a[128:131], a[44:47], v[40:43]
M v[44:47], a[128:131], a[60:63], v[28:31]
M v[44:47], a[124:127], a[56:59], v[44:47]
M v[44:47], a[120:123], a[52:55], v[44:47]
M v[44:47], a[116:119], a[48:51], v[44:47]
s_waitcnt lgkmcnt(4)
M v[48:51], a[132:135], a[0:3], v[20:23]
M v[48:51], a[136:139], a[4:7], v[48:51]
ds_read_b128 a[164:167], v3 offset:12288
ds_read_b128 a[168:171], v3 offset:13312
M v[48:51], a[140:143], a[8:11], v[48:51]
M v[48:51], a[144:147], a[12:15], v[48:51]
M v[52:55], a[144:147], a[28:31], v[24:27]
M v[52:55], a[140:143], a[24:27], v[52:55]
M v[52:55], a[136:139], a[20:23], v[52:55]
M v[52:55], a[132:135], a[16:19], v[52:55]
M v[56:59], a[132:135], a[32:35], v[28:31]
M v[56:59], a[136:139], a[36:39], v[56:59]
ds_read_b128 a[172:175], v3 offset:14336
ds_read_b128 a[176:179], v3 offset:15360
M v[56:59], a[140:143], a[40:43], v[56:59]
M v[56:59], a[144:147], a[44:47], v[56:59]
M v[60:63], a[144:147], a[60:63], v[28:31]
M v[60:63], a[140:143], a[56:59], v[60:63]
M v[60:63], a[136:139], a[52:55], v[60:63]
M v[60:63], a[132:135], a[48:51], v[60:63]
s_waitcnt lgkmcnt(4)
M v[64:67], a[148:151], a[0:3], v[20:23]
M v[64:67], a[152:155], a[4:7], v[64:67]
M v[64:67], a[156:159], a[8:11], v[64:67]
M v[64:67], a[160:163], a[12:15], v[64:67]
M v[68:71], a[160:163], a[28:31], v[20:23]
M v[68:71], a[156:159], a[24:27], v[68:71]
M v[68:71], a[152:155], a[20:23], v[68:71]
M v[68:71], a[148:151], a[16:19], v[68:71]
M v[72:75], a[148:151], a[32:35], v[24:27]
M v[72:75], a[152:155], a[36:39], v[72:75]
M v[72:75], a[156:159], a[40:43], v[72:75]
M v[72:75], a[160:163], a[44:47], v[72:75]
M v[76:79], a[160:163], a[60:63], v[28:31]
M v[76:79], a[156:159], a[56:59], v[76:79]
s_waitcnt vmcnt(4) lgkmcnt(0)
s_barrier
ds_read_b128 a[116:119], v2 offset:0
ds_read_b128 a[120:123], v2 offset:1024
M v[76:79], a[152:155], a[52:55], v[76:79]
M v[76:79], a[148:151], a[48:51], v[76:79]
M v[80:83], a[164:167], a[0:3], v[20:23]
M v[80:83], a[168:171], a[4:7], v[80:83]
ds_read_b128 a[124:127], v2 offset:2048
ds_read_b128 a[128:131], v2 offset:3072
M v[80:83], a[172:175], a[8:11], v[80:83]
M v[80:83], a[176:179], a[12:15], v[80:83]
M v[84:87], a[176:179], a[28:31], v[20:23]
M v[84:87], a[172:175], a[24:27], v[84:87]
ds_read_b128 a[132:135], v2 offset:4096
ds_read_b128 a[136:139], v2 offset:5120
M v[84:87], a[168:171], a[20:23], v[84:87]
M v[84:87], a[164:167], a[16:19], v[84:87]
M v[88:91], a[164:167], a[32:35], v[20:23]
M v[88:91], a[168:171], a[36:39], v[88:91]
ds_read_b128 a[140:143], v2 offset:6144
ds_read_b128 a[144:147], v2 offset:7168
M v[88:91], a[172:175], a[40:43], v[88:91]
M v[88:91], a[176:179], a[44:47], v[88:91]
M v[92:95], a[176:179], a[60:63], v[24:27]
M v[92:95], a[172:175], a[56:59], v[92:95]
M v[92:95], a[168:171], a[52:55], v[92:95]
M v[92:95], a[164:167], a[48:51], v[92:95]
s_waitcnt vmcnt(0)
s_mov_b64 exec, 1
buffer_store_dword v6, v5, s[52:55], s65 offen sc1
s_mov_b64 exec, -1
v_exp_f32 v32, v32
v_exp_f32 v33, v33
v_exp_f32 v34, v34
v_exp_f32 v35, v35
v_exp_f32 v48, v48
v_exp_f32 v49, v49
v_exp_f32 v50, v50
v_exp_f32 v51, v51
v_cvt_pk_bf16_f32 v32, v32, v33
v_cvt_pk_bf16_f32 v33, v34, v35
v_exp_f32 v36, v36
v_exp_f32 v37, v37
v_exp_f32 v38, v38
v_exp_f32 v39, v39
v_cvt_pk_bf16_f32 v34, v48, v49
v_cvt_pk_bf16_f32 v35, v50, v51
v_exp_f32 v52, v52
v_exp_f32 v53, v53
v_exp_f32 v54, v54
v_exp_f32 v55, v55
v_cvt_pk_bf16_f32 v36, v36, v37
v_cvt_pk_bf16_f32 v37, v38, v39
v_exp_f32 v40, v40
v_exp_f32 v41, v41
v_exp_f32 v42, v42
v_exp_f32 v43, v43
v_cvt_pk_bf16_f32 v38, v52, v53
v_cvt_pk_bf16_f32 v39, v54, v55
v_exp_f32 v56, v56
v_exp_f32 v57, v57
v_exp_f32 v58, v58
v_exp_f32 v59, v59
v_cvt_pk_bf16_f32 v40, v40, v41
v_cvt_pk_bf16_f32 v41, v42, v43
v_exp_f32 v44, v44
v_exp_f32 v45, v45
v_exp_f32 v46, v46
v_exp_f32 v47, v47
v_cvt_pk_bf16_f32 v42, v56, v57
v_cvt_pk_bf16_f32 v43, v58, v59
v_exp_f32 v60, v60
v_exp_f32 v61, v61
v_exp_f32 v62, v62
v_exp_f32 v63, v63
v_cvt_pk_bf16_f32 v44, v44, v45
v_cvt_pk_bf16_f32 v45, v46, v47
v_cvt_pk_bf16_f32 v46, v60, v61
v_cvt_pk_bf16_f32 v47, v62, v63
s_cmp_eq_u32 s24, 1
s_cbranch_scc1 Lk2_g1
s_mov_b32 s30, s21
s_cmp_eq_u32 s21, 0
s_cbranch_scc1 Lk2_m2
Lk2_l1:
s_add_u32 m0, s29, 65536
s_waitcnt lgkmcnt(4)
M v[96:99], a[116:119], a[0:3], 0
v_exp_f32 v64, v64
M v[96:99], a[120:123], a[4:7], v[96:99]
ds_read_b128 a[148:151], v2 offset:8192
ds_read_b128 a[152:155], v2 offset:9216
M v[96:99], a[124:127], a[8:11], v[96:99]
v_exp_f32 v65, v65
M v[96:99], a[128:131], a[12:15], v[96:99]
buffer_load_dwordx4 v1, s[12:15], s25 offen offset:0 sc1 lds
s_add_u32 s32, s25, 4096
M v[100:103], a[128:131], a[28:31], 0
v_exp_f32 v66, v66
M v[100:103], a[124:127], a[24:27], v[100:103]
v_cvt_pk_bf16_f32 v64, v64, v65
M v[100:103], a[120:123], a[20:23], v[100:103]
v_exp_f32 v67, v67
M v[100:103], a[116:119], a[16:19], v[100:103]
buffer_load_dwordx4 v1, s[12:15], s25 offen offset:1024 sc1 lds
M v[104:107], a[116:119], a[32:35], 0
v_exp_f32 v80, v80
M v[104:107], a[120:123], a[36:39], v[104:107]
ds_read_b128 a[156:159], v2 offset:10240
ds_read_b128 a[160:163], v2 offset:11264
M v[104:107], a[124:127], a[40:43], v[104:107]
v_exp_f32 v81, v81
M v[104:107], a[128:131], a[44:47], v[104:107]
buffer_load_dwordx4 v1, s[12:15], s25 offen offset:2048 sc1 lds
M v[108:111], a[128:131], a[60:63], 0
v_exp_f32 v82, v82
M v[108:111], a[124:127], a[56:59], v[108:111]
v_cvt_pk_bf16_f32 v65, v66, v67
v_cvt_pk_bf16_f32 v66, v80, v81
M v[108:111], a[120:123], a[52:55], v[108:111]
v_exp_f32 v83, v83
M v[108:111], a[116:119], a[48:51], v[108:111]
buffer_load_dwordx4 v1, s[12:15], s25 offen offset:3072 sc1 lds
s_add_u32 m0, s29, 69632
s_waitcnt lgkmcnt(4)
M v[112:115], a[132:135], a[0:3], 0
v_exp_f32 v68, v68
M v[112:115], a[136:139], a[4:7], v[112:115]
ds_read_b128 a[164:167], v2 offset:12288
ds_read_b128 a[168:171], v2 offset:13312
M v[112:115], a[140:143], a[8:11], v[112:115]
v_exp_f32 v69, v69
M v[112:115], a[144:147], a[12:15], v[112:115]
buffer_load_dwordx4 v1, s[12:15], s32 offen offset:0 sc1 lds
M v[116:119], a[144:147], a[28:31], 0
v_exp_f32 v70, v70
M v[116:119], a[140:143], a[24:27], v[116:119]
v_cvt_pk_bf16_f32 v67, v82, v83
v_cvt_pk_bf16_f32 v68, v68, v69
M v[116:119], a[136:139], a[20:23], v[116:119]
v_exp_f32 v71, v71
M v[116:119], a[132:135], a[16:19], v[116:119]
buffer_load_dwordx4 v1, s[12:15], s32 offen offset:1024 sc1 lds
M v[120:123], a[132:135], a[32:35], 0
v_exp_f32 v84, v84
M v[120:123], a[136:139], a[36:39], v[120:123]
ds_read_b128 a[172:175], v2 offset:14336
ds_read_b128 a[176:179], v2 offset:15360
M v[120:123], a[140:143], a[40:43], v[120:123]
v_exp_f32 v85, v85
M v[120:123], a[144:147], a[44:47], v[120:123]
buffer_load_dwordx4 v1, s[12:15], s32 offen offset:2048 sc1 lds
M v[124:127], a[144:147], a[60:63], 0
v_exp_f32 v86, v86
M v[124:127], a[140:143], a[56:59], v[124:127]
v_cvt_pk_bf16_f32 v69, v70, v71
v_cvt_pk_bf16_f32 v70, v84, v85
M v[124:127], a[136:139], a[52:55], v[124:127]
v_exp_f32 v87, v87
M v[124:127], a[132:135], a[48:51], v[124:127]
buffer_load_dwordx4 v1, s[12:15], s32 offen offset:3072 sc1 lds
s_add_u32 m0, s29, 98304
s_waitcnt lgkmcnt(4)
M v[128:131], a[148:151], a[0:3], 0
v_exp_f32 v72, v72
M v[128:131], a[152:155], a[4:7], v[128:131]
ds_read_b128 a[116:119], v2 offset:32768
ds_read_b128 a[120:123], v2 offset:40960
M v[128:131], a[156:159], a[8:11], v[128:131]
v_exp_f32 v73, v73
M v[128:131], a[160:163], a[12:15], v[128:131]
buffer_load_dwordx4 v1, s[12:15], s26 offen offset:0 sc1 lds
s_add_u32 s43, s26, 4096
M v[132:135], a[160:163], a[28:31], 0
v_exp_f32 v74, v74
M v[132:135], a[156:159], a[24:27], v[132:135]
v_cvt_pk_bf16_f32 v71, v86, v87
v_cvt_pk_bf16_f32 v72, v72, v73
M v[132:135], a[152:155], a[20:23], v[132:135]
v_exp_f32 v75, v75
M v[132:135], a[148:151], a[16:19], v[132:135]
buffer_load_dwordx4 v1, s[12:15], s26 offen offset:1024 sc1 lds
M v[136:139], a[148:151], a[32:35], 0
v_exp_f32 v88, v88
M v[136:139], a[152:155], a[36:39], v[136:139]
ds_read_b128 a[124:127], v2 offset:33792
ds_read_b128 a[128:131], v2 offset:41984
M v[136:139], a[156:159], a[40:43], v[136:139]
v_exp_f32 v89, v89
M v[136:139], a[160:163], a[44:47], v[136:139]
buffer_load_dwordx4 v1, s[12:15], s26 offen offset:2048 sc1 lds
M v[140:143], a[160:163], a[60:63], 0
v_exp_f32 v90, v90
M v[140:143], a[156:159], a[56:59], v[140:143]
v_cvt_pk_bf16_f32 v73, v74, v75
v_cvt_pk_bf16_f32 v74, v88, v89
M v[140:143], a[152:155], a[52:55], v[140:143]
v_exp_f32 v91, v91
M v[140:143], a[148:151], a[48:51], v[140:143]
buffer_load_dwordx4 v1, s[12:15], s26 offen offset:3072 sc1 lds
s_add_u32 m0, s29, 102400
s_waitcnt lgkmcnt(4)
M v[144:147], a[164:167], a[0:3], 0
v_exp_f32 v76, v76
M v[144:147], a[168:171], a[4:7], v[144:147]
ds_read_b128 a[132:135], v2 offset:34816
ds_read_b128 a[136:139], v2 offset:43008
M v[144:147], a[172:175], a[8:11], v[144:147]
v_exp_f32 v77, v77
M v[144:147], a[176:179], a[12:15], v[144:147]
buffer_load_dwordx4 v1, s[12:15], s43 offen offset:0 sc1 lds
M v[148:151], a[176:179], a[28:31], 0
v_exp_f32 v78, v78
M v[148:151], a[172:175], a[24:27], v[148:151]
v_cvt_pk_bf16_f32 v75, v90, v91
v_cvt_pk_bf16_f32 v76, v76, v77
M v[148:151], a[168:171], a[20:23], v[148:151]
v_exp_f32 v79, v79
M v[148:151], a[164:167], a[16:19], v[148:151]
buffer_load_dwordx4 v1, s[12:15], s43 offen offset:1024 sc1 lds
M v[152:155], a[164:167], a[32:35], 0
v_exp_f32 v92, v92
M v[152:155], a[168:171], a[36:39], v[152:155]
ds_read_b128 a[140:143], v2 offset:35840
ds_read_b128 a[144:147], v2 offset:44032
M v[152:155], a[172:175], a[40:43], v[152:155]
v_exp_f32 v93, v93
M v[152:155], a[176:179], a[44:47], v[152:155]
buffer_load_dwordx4 v1, s[12:15], s43 offen offset:2048 sc1 lds
M v[156:159], a[176:179], a[60:63], 0
v_exp_f32 v94, v94
M v[156:159], a[172:175], a[56:59], v[156:159]
v_cvt_pk_bf16_f32 v77, v78, v79
v_cvt_pk_bf16_f32 v78, v92, v93
M v[156:159], a[168:171], a[52:55], v[156:159]
v_exp_f32 v95, v95
M v[156:159], a[164:167], a[48:51], v[156:159]
buffer_load_dwordx4 v1, s[12:15], s43 offen offset:3072 sc1 lds
v_cvt_pk_bf16_f32 v79, v94, v95
s_waitcnt lgkmcnt(6)
M v[160:163], a[116:119], v[32:35], v[160:163]
v_exp_f32 v96, v96
M v[160:163], a[120:123], v[64:67], v[160:163]
ds_read_b128 a[148:151], v2 offset:36864
ds_read_b128 a[152:155], v2 offset:45056
M v[164:167], a[120:123], v[68:71], v[164:167]
v_exp_f32 v97, v97
M v[164:167], a[116:119], v[36:39], v[164:167]
v_cvt_pk_bf16_f32 v96, v96, v97
M v[168:171], a[116:119], v[40:43], v[168:171]
v_exp_f32 v98, v98
M v[168:171], a[120:123], v[72:75], v[168:171]
s_add_u32 s25, s25, 32768
s_cmp_eq_u32 s25, s27
M v[172:175], a[120:123], v[76:79], v[172:175]
v_exp_f32 v99, v99
M v[172:175], a[116:119], v[44:47], v[172:175]
v_cvt_pk_bf16_f32 v97, v98, v99
s_waitcnt lgkmcnt(6)
M a[96:99], a[112:115], v[32:35], a[96:99]
s_cselect_b32 s25, s28, s25
s_cselect_b32 s27, -1, s27
M a[96:99], a[112:115], v[64:67], a[96:99]
s_add_u32 s26, s26, 32768
s_cmp_eq_u32 s26, s62
M v[176:179], a[124:127], v[32:35], v[176:179]
v_exp_f32 v112, v112
M v[176:179], a[128:131], v[64:67], v[176:179]
ds_read_b128 a[156:159], v2 offset:37888
ds_read_b128 a[160:163], v2 offset:46080
M v[180:183], a[128:131], v[68:71], v[180:183]
v_exp_f32 v113, v113
M v[180:183], a[124:127], v[36:39], v[180:183]
v_cvt_pk_bf16_f32 v98, v112, v113
M v[184:187], a[124:127], v[40:43], v[184:187]
v_exp_f32 v114, v114
M v[184:187], a[128:131], v[72:75], v[184:187]
s_cselect_b32 s26, s63, s26
s_cselect_b32 s62, -1, s62
M v[188:191], a[128:131], v[76:79], v[188:191]
v_exp_f32 v115, v115
M v[188:191], a[124:127], v[44:47], v[188:191]
v_cvt_pk_bf16_f32 v99, v114, v115
s_waitcnt lgkmcnt(6)
M a[100:103], a[112:115], v[36:39], a[100:103]
M a[100:103], a[112:115], v[68:71], a[100:103]
M v[192:195], a[132:135], v[32:35], v[192:195]
v_exp_f32 v100, v100
M v[192:195], a[136:139], v[64:67], v[192:195]
ds_read_b128 a[164:167], v2 offset:38912
ds_read_b128 a[168:171], v2 offset:47104
M v[196:199], a[136:139], v[68:71], v[196:199]
v_exp_f32 v101, v101
M v[196:199], a[132:135], v[36:39], v[196:199]
v_cvt_pk_bf16_f32 v100, v100, v101
M v[200:203], a[132:135], v[40:43], v[200:203]
v_exp_f32 v102, v102
M v[200:203], a[136:139], v[72:75], v[200:203]
M v[204:207], a[136:139], v[76:79], v[204:207]
v_exp_f32 v103, v103
M v[204:207], a[132:135], v[44:47], v[204:207]
v_cvt_pk_bf16_f32 v101, v102, v103
s_waitcnt lgkmcnt(6)
M a[104:107], a[112:115], v[40:43], a[104:107]
M a[104:107], a[112:115], v[72:75], a[104:107]
M v[208:211], a[140:143], v[32:35], v[208:211]
v_exp_f32 v116, v116
M v[208:211], a[144:147], v[64:67], v[208:211]
ds_read_b128 a[172:175], v2 offset:39936
ds_read_b128 a[176:179], v2 offset:48128
M v[212:215], a[144:147], v[68:71], v[212:215]
v_exp_f32 v117, v117
M v[212:215], a[140:143], v[36:39], v[212:215]
v_cvt_pk_bf16_f32 v102, v116, v117
M v[216:219], a[140:143], v[40:43], v[216:219]
v_exp_f32 v118, v118
M v[216:219], a[144:147], v[72:75], v[216:219]
M v[220:223], a[144:147], v[76:79], v[220:223]
v_exp_f32 v119, v119
M v[220:223], a[140:143], v[44:47], v[220:223]
v_cvt_pk_bf16_f32 v103, v118, v119
s_waitcnt lgkmcnt(6)
M a[108:111], a[112:115], v[44:47], a[108:111]
M a[108:111], a[112:115], v[76:79], a[108:111]
M v[224:227], a[148:151], v[32:35], v[224:227]
v_exp_f32 v104, v104
M v[224:227], a[152:155], v[64:67], v[224:227]
M v[228:231], a[152:155], v[68:71], v[228:231]
v_exp_f32 v105, v105
M v[228:231], a[148:151], v[36:39], v[228:231]
v_cvt_pk_bf16_f32 v104, v104, v105
M v[232:235], a[148:151], v[40:43], v[232:235]
v_exp_f32 v106, v106
M v[232:235], a[152:155], v[72:75], v[232:235]
M v[236:239], a[152:155], v[76:79], v[236:239]
v_exp_f32 v107, v107
M v[236:239], a[148:151], v[44:47], v[236:239]
v_cvt_pk_bf16_f32 v105, v106, v107
s_waitcnt lgkmcnt(4)
M v[240:243], a[156:159], v[32:35], v[240:243]
v_exp_f32 v120, v120
M v[240:243], a[160:163], v[64:67], v[240:243]
M v[244:247], a[160:163], v[68:71], v[244:247]
v_exp_f32 v121, v121
M v[244:247], a[156:159], v[36:39], v[244:247]
v_cvt_pk_bf16_f32 v106, v120, v121
M v[248:251], a[156:159], v[40:43], v[248:251]
v_exp_f32 v122, v122
M v[248:251], a[160:163], v[72:75], v[248:251]
s_waitcnt vmcnt(0) lgkmcnt(0)
s_barrier
ds_read_b128 a[116:119], v3 offset:0
ds_read_b128 a[120:123], v3 offset:1024
M v[252:255], a[160:163], v[76:79], v[252:255]
v_exp_f32 v123, v123
M v[252:255], a[156:159], v[44:47], v[252:255]
v_cvt_pk_bf16_f32 v107, v122, v123
M a[64:67], a[164:167], v[32:35], a[64:67]
v_exp_f32 v108, v108
M a[64:67], a[168:171], v[64:67], a[64:67]
ds_read_b128 a[124:127], v3 offset:2048
ds_read_b128 a[128:131], v3 offset:3072
M a[68:71], a[168:171], v[68:71], a[68:71]
v_exp_f32 v109, v109
M a[68:71], a[164:167], v[36:39], a[68:71]
v_cvt_pk_bf16_f32 v108, v108, v109
M a[72:75], a[164:167], v[40:43], a[72:75]
v_exp_f32 v110, v110
M a[72:75], a[168:171], v[72:75], a[72:75]
ds_read_b128 a[132:135], v3 offset:4096
ds_read_b128 a[136:139], v3 offset:5120
M a[76:79], a[168:171], v[76:79], a[76:79]
v_exp_f32 v111, v111
M a[76:79], a[164:167], v[44:47], a[76:79]
v_cvt_pk_bf16_f32 v109, v110, v111
M a[80:83], a[172:175], v[32:35], a[80:83]
v_exp_f32 v124, v124
M a[80:83], a[176:179], v[64:67], a[80:83]
ds_read_b128 a[140:143], v3 offset:6144
ds_read_b128 a[144:147], v3 offset:7168
M a[84:87], a[176:179], v[68:71], a[84:87]
v_exp_f32 v125, v125
M a[84:87], a[172:175], v[36:39], a[84:87]
v_cvt_pk_bf16_f32 v110, v124, v125
M a[88:91], a[172:175], v[40:43], a[88:91]
v_exp_f32 v126, v126
M a[88:91], a[176:179], v[72:75], a[88:91]
M a[92:95], a[176:179], v[76:79], a[92:95]
v_exp_f32 v127, v127
M a[92:95], a[172:175], v[44:47], a[92:95]
v_cvt_pk_bf16_f32 v111, v126, v127
s_sub_u32 s30, s30, 1
s_cmp_eq_u32 s30, 0
s_cbranch_scc1 Lk2_m1
s_add_u32 m0, s29, 0
s_waitcnt lgkmcnt(4)
M v[32:35], a[116:119], a[0:3], 0
v_exp_f32 v128, v128
M v[32:35], a[120:123], a[4:7], v[32:35]
ds_read_b128 a[148:151], v3 offset:8192
ds_read_b128 a[152:155], v3 offset:9216
M v[32:35], a[124:127], a[8:11], v[32:35]
v_exp_f32 v129, v129
M v[32:35], a[128:131], a[12:15], v[32:35]
buffer_load_dwordx4 v1, s[12:15], s25 offen offset:0 sc1 lds
s_add_u32 s32, s25, 4096
M v[36:39], a[128:131], a[28:31], 0
v_exp_f32 v130, v130
M v[36:39], a[124:127], a[24:27], v[36:39]
v_cvt_pk_bf16_f32 v128, v128, v129
M v[36:39], a[120:123], a[20:23], v[36:39]
v_exp_f32 v131, v131
M v[36:39], a[116:119], a[16:19], v[36:39]
buffer_load_dwordx4 v1, s[12:15], s25 offen offset:1024 sc1 lds
M v[40:43], a[116:119], a[32:35], 0
v_exp_f32 v144, v144
M v[40:43], a[120:123], a[36:39], v[40:43]
ds_read_b128 a[156:159], v3 offset:10240
ds_read_b128 a[160:163], v3 offset:11264
M v[40:43], a[124:127], a[40:43], v[40:43]
v_exp_f32 v145, v145
M v[40:43], a[128:131], a[44:47], v[40:43]
buffer_load_dwordx4 v1, s[12:15], s25 offen offset:2048 sc1 lds
M v[44:47], a[128:131], a[60:63], 0
v_exp_f32 v146, v146
M v[44:47], a[124:127], a[56:59], v[44:47]
v_cvt_pk_bf16_f32 v129, v130, v131
v_cvt_pk_bf16_f32 v130, v144, v145
M v[44:47], a[120:123], a[52:55], v[44:47]
v_exp_f32 v147, v147
M v[44:47], a[116:119], a[48:51], v[44:47]
buffer_load_dwordx4 v1, s[12:15], s25 offen offset:3072 sc1 lds
s_add_u32 m0, s29, 4096
s_waitcnt lgkmcnt(4)
M v[48:51], a[132:135], a[0:3], 0
v_exp_f32 v132, v132
M v[48:51], a[136:139], a[4:7], v[48:51]
ds_read_b128 a[164:167], v3 offset:12288
ds_read_b128 a[168:171], v3 offset:13312
M v[48:51], a[140:143], a[8:11], v[48:51]
v_exp_f32 v133, v133
M v[48:51], a[144:147], a[12:15], v[48:51]
buffer_load_dwordx4 v1, s[12:15], s32 offen offset:0 sc1 lds
M v[52:55], a[144:147], a[28:31], 0
v_exp_f32 v134, v134
M v[52:55], a[140:143], a[24:27], v[52:55]
v_cvt_pk_bf16_f32 v131, v146, v147
v_cvt_pk_bf16_f32 v132, v132, v133
M v[52:55], a[136:139], a[20:23], v[52:55]
v_exp_f32 v135, v135
M v[52:55], a[132:135], a[16:19], v[52:55]
buffer_load_dwordx4 v1, s[12:15], s32 offen offset:1024 sc1 lds
M v[56:59], a[132:135], a[32:35], 0
v_exp_f32 v148, v148
M v[56:59], a[136:139], a[36:39], v[56:59]
ds_read_b128 a[172:175], v3 offset:14336
ds_read_b128 a[176:179], v3 offset:15360
M v[56:59], a[140:143], a[40:43], v[56:59]
v_exp_f32 v149, v149
M v[56:59], a[144:147], a[44:47], v[56:59]
buffer_load_dwordx4 v1, s[12:15], s32 offen offset:2048 sc1 lds
M v[60:63], a[144:147], a[60:63], 0
v_exp_f32 v150, v150
M v[60:63], a[140:143], a[56:59], v[60:63]
v_cvt_pk_bf16_f32 v133, v134, v135
v_cvt_pk_bf16_f32 v134, v148, v149
M v[60:63], a[136:139], a[52:55], v[60:63]
v_exp_f32 v151, v151
M v[60:63], a[132:135], a[48:51], v[60:63]
buffer_load_dwordx4 v1, s[12:15], s32 offen offset:3072 sc1 lds
s_add_u32 m0, s29, 32768
s_waitcnt lgkmcnt(4)
M v[64:67], a[148:151], a[0:3], 0
v_exp_f32 v136, v136
M v[64:67], a[152:155], a[4:7], v[64:67]
ds_read_b128 a[116:119], v3 offset:32768
ds_read_b128 a[120:123], v3 offset:40960
M v[64:67], a[156:159], a[8:11], v[64:67]
v_exp_f32 v137, v137
M v[64:67], a[160:163], a[12:15], v[64:67]
buffer_load_dwordx4 v1, s[12:15], s26 offen offset:0 sc1 lds
s_add_u32 s43, s26, 4096
M v[68:71], a[160:163], a[28:31], 0
v_exp_f32 v138, v138
M v[68:71], a[156:159], a[24:27], v[68:71]
v_cvt_pk_bf16_f32 v135, v150, v151
v_cvt_pk_bf16_f32 v136, v136, v137
M v[68:71], a[152:155], a[20:23], v[68:71]
v_exp_f32 v139, v139
M v[68:71], a[148:151], a[16:19], v[68:71]
buffer_load_dwordx4 v1, s[12:15], s26 offen offset:1024 sc1 lds
M v[72:75], a[148:151], a[32:35], 0
v_exp_f32 v152, v152
M v[72:75], a[152:155], a[36:39], v[72:75]
ds_read_b128 a[124:127], v3 offset:33792
ds_read_b128 a[128:131], v3 offset:41984
M v[72:75], a[156:159], a[40:43], v[72:75]
v_exp_f32 v153, v153
M v[72:75], a[160:163], a[44:47], v[72:75]
buffer_load_dwordx4 v1, s[12:15], s26 offen offset:2048 sc1 lds
M v[76:79], a[160:163], a[60:63], 0
v_exp_f32 v154, v154
M v[76:79], a[156:159], a[56:59], v[76:79]
v_cvt_pk_bf16_f32 v137, v138, v139
v_cvt_pk_bf16_f32 v138, v152, v153
M v[76:79], a[152:155], a[52:55], v[76:79]
v_exp_f32 v155, v155
M v[76:79], a[148:151], a[48:51], v[76:79]
buffer_load_dwordx4 v1, s[12:15], s26 offen offset:3072 sc1 lds
s_add_u32 m0, s29, 36864
s_waitcnt lgkmcnt(4)
M v[80:83], a[164:167], a[0:3], 0
v_exp_f32 v140, v140
M v[80:83], a[168:171], a[4:7], v[80:83]
ds_read_b128 a[132:135], v3 offset:34816
ds_read_b128 a[136:139], v3 offset:43008
M v[80:83], a[172:175], a[8:11], v[80:83]
v_exp_f32 v141, v141
M v[80:83], a[176:179], a[12:15], v[80:83]
buffer_load_dwordx4 v1, s[12:15], s43 offen offset:0 sc1 lds
M v[84:87], a[176:179], a[28:31], 0
v_exp_f32 v142, v142
M v[84:87], a[172:175], a[24:27], v[84:87]
v_cvt_pk_bf16_f32 v139, v154, v155
v_cvt_pk_bf16_f32 v140, v140, v141
M v[84:87], a[168:171], a[20:23], v[84:87]
v_exp_f32 v143, v143
M v[84:87], a[164:167], a[16:19], v[84:87]
buffer_load_dwordx4 v1, s[12:15], s43 offen offset:1024 sc1 lds
M v[88:91], a[164:167], a[32:35], 0
v_exp_f32 v156, v156
M v[88:91], a[168:171], a[36:39], v[88:91]
ds_read_b128 a[140:143], v3 offset:35840
ds_read_b128 a[144:147], v3 offset:44032
M v[88:91], a[172:175], a[40:43], v[88:91]
v_exp_f32 v157, v157
M v[88:91], a[176:179], a[44:47], v[88:91]
buffer_load_dwordx4 v1, s[12:15], s43 offen offset:2048 sc1 lds
M v[92:95], a[176:179], a[60:63], 0
v_exp_f32 v158, v158
M v[92:95], a[172:175], a[56:59], v[92:95]
v_cvt_pk_bf16_f32 v141, v142, v143
v_cvt_pk_bf16_f32 v142, v156, v157
M v[92:95], a[168:171], a[52:55], v[92:95]
v_exp_f32 v159, v159
M v[92:95], a[164:167], a[48:51], v[92:95]
buffer_load_dwordx4 v1, s[12:15], s43 offen offset:3072 sc1 lds
v_cvt_pk_bf16_f32 v143, v158, v159
s_waitcnt lgkmcnt(6)
M v[160:163], a[116:119], v[96:99], v[160:163]
v_exp_f32 v32, v32
M v[160:163], a[120:123], v[128:131], v[160:163]
ds_read_b128 a[148:151], v3 offset:36864
ds_read_b128 a[152:155], v3 offset:45056
M v[164:167], a[120:123], v[132:135], v[164:167]
v_exp_f32 v33, v33
M v[164:167], a[116:119], v[100:103], v[164:167]
v_cvt_pk_bf16_f32 v32, v32, v33
M v[168:171], a[116:119], v[104:107], v[168:171]
v_exp_f32 v34, v34
M v[168:171], a[120:123], v[136:139], v[168:171]
s_add_u32 s25, s25, 32768
s_cmp_eq_u32 s25, s27
M v[172:175], a[120:123], v[140:143], v[172:175]
v_exp_f32 v35, v35
M v[172:175], a[116:119], v[108:111], v[172:175]
v_cvt_pk_bf16_f32 v33, v34, v35
s_waitcnt lgkmcnt(6)
M a[96:99], a[112:115], v[96:99], a[96:99]
s_cselect_b32 s25, s28, s25
s_cselect_b32 s27, -1, s27
M a[96:99], a[112:115], v[128:131], a[96:99]
s_add_u32 s26, s26, 32768
s_cmp_eq_u32 s26, s62
M v[176:179], a[124:127], v[96:99], v[176:179]
v_exp_f32 v48, v48
M v[176:179], a[128:131], v[128:131], v[176:179]
ds_read_b128 a[156:159], v3 offset:37888
ds_read_b128 a[160:163], v3 offset:46080
M v[180:183], a[128:131], v[132:135], v[180:183]
v_exp_f32 v49, v49
M v[180:183], a[124:127], v[100:103], v[180:183]
v_cvt_pk_bf16_f32 v34, v48, v49
M v[184:187], a[124:127], v[104:107], v[184:187]
v_exp_f32 v50, v50
M v[184:187], a[128:131], v[136:139], v[184:187]
s_cselect_b32 s26, s63, s26
s_cselect_b32 s62, -1, s62
M v[188:191], a[128:131], v[140:143], v[188:191]
v_exp_f32 v51, v51
M v[188:191], a[124:127], v[108:111], v[188:191]
v_cvt_pk_bf16_f32 v35, v50, v51
s_waitcnt lgkmcnt(6)
M a[100:103], a[112:115], v[100:103], a[100:103]
M a[100:103], a[112:115], v[132:135], a[100:103]
M v[192:195], a[132:135], v[96:99], v[192:195]
v_exp_f32 v36, v36
M v[192:195], a[136:139], v[128:131], v[192:195]
ds_read_b128 a[164:167], v3 offset:38912
ds_read_b128 a[168:171], v3 offset:47104
M v[196:199], a[136:139], v[132:135], v[196:199]
v_exp_f32 v37, v37
M v[196:199], a[132:135], v[100:103], v[196:199]
v_cvt_pk_bf16_f32 v36, v36, v37
M v[200:203], a[132:135], v[104:107], v[200:203]
v_exp_f32 v38, v38
M v[200:203], a[136:139], v[136:139], v[200:203]
M v[204:207], a[136:139], v[140:143], v[204:207]
v_exp_f32 v39, v39
M v[204:207], a[132:135], v[108:111], v[204:207]
v_cvt_pk_bf16_f32 v37, v38, v39
s_waitcnt lgkmcnt(6)
M a[104:107], a[112:115], v[104:107], a[104:107]
M a[104:107], a[112:115], v[136:139], a[104:107]
M v[208:211], a[140:143], v[96:99], v[208:211]
v_exp_f32 v52, v52
M v[208:211], a[144:147], v[128:131], v[208:211]
ds_read_b128 a[172:175], v3 offset:39936
ds_read_b128 a[176:179], v3 offset:48128
M v[212:215], a[144:147], v[132:135], v[212:215]
v_exp_f32 v53, v53
M v[212:215], a[140:143], v[100:103], v[212:215]
v_cvt_pk_bf16_f32 v38, v52, v53
M v[216:219], a[140:143], v[104:107], v[216:219]
v_exp_f32 v54, v54
M v[216:219], a[144:147], v[136:139], v[216:219]
M v[220:223], a[144:147], v[140:143], v[220:223]
v_exp_f32 v55, v55
M v[220:223], a[140:143], v[108:111], v[220:223]
v_cvt_pk_bf16_f32 v39, v54, v55
s_waitcnt lgkmcnt(6)
M a[108:111], a[112:115], v[108:111], a[108:111]
M a[108:111], a[112:115], v[140:143], a[108:111]
M v[224:227], a[148:151], v[96:99], v[224:227]
v_exp_f32 v40, v40
M v[224:227], a[152:155], v[128:131], v[224:227]
M v[228:231], a[152:155], v[132:135], v[228:231]
v_exp_f32 v41, v41
M v[228:231], a[148:151], v[100:103], v[228:231]
v_cvt_pk_bf16_f32 v40, v40, v41
M v[232:235], a[148:151], v[104:107], v[232:235]
v_exp_f32 v42, v42
M v[232:235], a[152:155], v[136:139], v[232:235]
M v[236:239], a[152:155], v[140:143], v[236:239]
v_exp_f32 v43, v43
M v[236:239], a[148:151], v[108:111], v[236:239]
v_cvt_pk_bf16_f32 v41, v42, v43
s_waitcnt lgkmcnt(4)
M v[240:243], a[156:159], v[96:99], v[240:243]
v_exp_f32 v56, v56
M v[240:243], a[160:163], v[128:131], v[240:243]
M v[244:247], a[160:163], v[132:135], v[244:247]
v_exp_f32 v57, v57
M v[244:247], a[156:159], v[100:103], v[244:247]
v_cvt_pk_bf16_f32 v42, v56, v57
M v[248:251], a[156:159], v[104:107], v[248:251]
v_exp_f32 v58, v58
M v[248:251], a[160:163], v[136:139], v[248:251]
s_waitcnt vmcnt(0) lgkmcnt(0)
s_barrier
ds_read_b128 a[116:119], v2 offset:0
ds_read_b128 a[120:123], v2 offset:1024
M v[252:255], a[160:163], v[140:143], v[252:255]
v_exp_f32 v59, v59
M v[252:255], a[156:159], v[108:111], v[252:255]
v_cvt_pk_bf16_f32 v43, v58, v59
M a[64:67], a[164:167], v[96:99], a[64:67]
v_exp_f32 v44, v44
M a[64:67], a[168:171], v[128:131], a[64:67]
ds_read_b128 a[124:127], v2 offset:2048
ds_read_b128 a[128:131], v2 offset:3072
M a[68:71], a[168:171], v[132:135], a[68:71]
v_exp_f32 v45, v45
M a[68:71], a[164:167], v[100:103], a[68:71]
v_cvt_pk_bf16_f32 v44, v44, v45
M a[72:75], a[164:167], v[104:107], a[72:75]
v_exp_f32 v46, v46
M a[72:75], a[168:171], v[136:139], a[72:75]
ds_read_b128 a[132:135], v2 offset:4096
ds_read_b128 a[136:139], v2 offset:5120
M a[76:79], a[168:171], v[140:143], a[76:79]
v_exp_f32 v47, v47
M a[76:79], a[164:167], v[108:111], a[76:79]
v_cvt_pk_bf16_f32 v45, v46, v47
M a[80:83], a[172:175], v[96:99], a[80:83]
v_exp_f32 v60, v60
M a[80:83], a[176:179], v[128:131], a[80:83]
ds_read_b128 a[140:143], v2 offset:6144
ds_read_b128 a[144:147], v2 offset:7168
M a[84:87], a[176:179], v[132:135], a[84:87]
v_exp_f32 v61, v61
M a[84:87], a[172:175], v[100:103], a[84:87]
v_cvt_pk_bf16_f32 v46, v60, v61
M a[88:91], a[172:175], v[104:107], a[88:91]
v_exp_f32 v62, v62
M a[88:91], a[176:179], v[136:139], a[88:91]
M a[92:95], a[176:179], v[140:143], a[92:95]
v_exp_f32 v63, v63
M a[92:95], a[172:175], v[108:111], a[92:95]
v_cvt_pk_bf16_f32 v47, v62, v63
s_branch Lk2_l1
Lk2_m1:
s_lshl_b32 s33, s23, 6
s_add_i32 s33, s33, 0
s_cmp_gt_i32 s33, 0
s_cselect_b32 s34, 0, 0xf149f2ca
s_cmp_lt_i32 s33, 0
s_cselect_b32 s33, 0xf149f2ca, 0
v_mov_b32 v20, s34
v_mov_b32 v21, s34
v_mov_b32 v22, s34
v_mov_b32 v23, s34
v_mov_b32 v28, s33
v_mov_b32 v29, s33
v_mov_b32 v30, s33
v_mov_b32 v31, s33
v_med3_f32 v24, v16, v20, v28
v_med3_f32 v25, v17, v20, v28
v_med3_f32 v26, v18, v20, v28
v_med3_f32 v27, v19, v20, v28
s_add_u32 m0, s29, 0
s_waitcnt lgkmcnt(4)
M v[32:35], a[116:119], a[0:3], v[24:27]
v_exp_f32 v128, v128
M v[32:35], a[120:123], a[4:7], v[32:35]
ds_read_b128 a[148:151], v3 offset:8192
ds_read_b128 a[152:155], v3 offset:9216
M v[32:35], a[124:127], a[8:11], v[32:35]
v_exp_f32 v129, v129
M v[32:35], a[128:131], a[12:15], v[32:35]
buffer_load_dwordx4 v1, s[12:15], s25 offen offset:0 sc1 lds
s_add_u32 s32, s25, 4096
M v[36:39], a[128:131], a[28:31], v[28:31]
v_exp_f32 v130, v130
M v[36:39], a[124:127], a[24:27], v[36:39]
v_cvt_pk_bf16_f32 v128, v128, v129
M v[36:39], a[120:123], a[20:23], v[36:39]
v_exp_f32 v131, v131
M v[36:39], a[116:119], a[16:19], v[36:39]
buffer_load_dwordx4 v1, s[12:15], s25 offen offset:1024 sc1 lds
M v[40:43], a[116:119], a[32:35], v[28:31]
v_exp_f32 v144, v144
M v[40:43], a[120:123], a[36:39], v[40:43]
ds_read_b128 a[156:159], v3 offset:10240
ds_read_b128 a[160:163], v3 offset:11264
M v[40:43], a[124:127], a[40:43], v[40:43]
v_exp_f32 v145, v145
M v[40:43], a[128:131], a[44:47], v[40:43]
buffer_load_dwordx4 v1, s[12:15], s25 offen offset:2048 sc1 lds
M v[44:47], a[128:131], a[60:63], v[28:31]
v_exp_f32 v146, v146
M v[44:47], a[124:127], a[56:59], v[44:47]
v_cvt_pk_bf16_f32 v129, v130, v131
v_cvt_pk_bf16_f32 v130, v144, v145
M v[44:47], a[120:123], a[52:55], v[44:47]
v_exp_f32 v147, v147
M v[44:47], a[116:119], a[48:51], v[44:47]
buffer_load_dwordx4 v1, s[12:15], s25 offen offset:3072 sc1 lds
s_add_u32 m0, s29, 4096
s_waitcnt lgkmcnt(4)
M v[48:51], a[132:135], a[0:3], v[20:23]
v_exp_f32 v132, v132
M v[48:51], a[136:139], a[4:7], v[48:51]
ds_read_b128 a[164:167], v3 offset:12288
ds_read_b128 a[168:171], v3 offset:13312
M v[48:51], a[140:143], a[8:11], v[48:51]
v_exp_f32 v133, v133
M v[48:51], a[144:147], a[12:15], v[48:51]
buffer_load_dwordx4 v1, s[12:15], s32 offen offset:0 sc1 lds
M v[52:55], a[144:147], a[28:31], v[24:27]
v_exp_f32 v134, v134
M v[52:55], a[140:143], a[24:27], v[52:55]
v_cvt_pk_bf16_f32 v131, v146, v147
v_cvt_pk_bf16_f32 v132, v132, v133
M v[52:55], a[136:139], a[20:23], v[52:55]
v_exp_f32 v135, v135
M v[52:55], a[132:135], a[16:19], v[52:55]
buffer_load_dwordx4 v1, s[12:15], s32 offen offset:1024 sc1 lds
M v[56:59], a[132:135], a[32:35], v[28:31]
v_exp_f32 v148, v148
M v[56:59], a[136:139], a[36:39], v[56:59]
ds_read_b128 a[172:175], v3 offset:14336
ds_read_b128 a[176:179], v3 offset:15360
M v[56:59], a[140:143], a[40:43], v[56:59]
v_exp_f32 v149, v149
M v[56:59], a[144:147], a[44:47], v[56:59]
buffer_load_dwordx4 v1, s[12:15], s32 offen offset:2048 sc1 lds
M v[60:63], a[144:147], a[60:63], v[28:31]
v_exp_f32 v150, v150
M v[60:63], a[140:143], a[56:59], v[60:63]
v_cvt_pk_bf16_f32 v133, v134, v135
v_cvt_pk_bf16_f32 v134, v148, v149
M v[60:63], a[136:139], a[52:55], v[60:63]
v_exp_f32 v151, v151
M v[60:63], a[132:135], a[48:51], v[60:63]
buffer_load_dwordx4 v1, s[12:15], s32 offen offset:3072 sc1 lds
s_add_u32 m0, s29, 32768
s_waitcnt lgkmcnt(4)
M v[64:67], a[148:151], a[0:3], v[20:23]
v_exp_f32 v136, v136
M v[64:67], a[152:155], a[4:7], v[64:67]
ds_read_b128 a[116:119], v3 offset:32768
ds_read_b128 a[120:123], v3 offset:40960
M v[64:67], a[156:159], a[8:11], v[64:67]
v_exp_f32 v137, v137
M v[64:67], a[160:163], a[12:15], v[64:67]
buffer_load_dwordx4 v1, s[12:15], s26 offen offset:0 sc1 lds
s_add_u32 s43, s26, 4096
M v[68:71], a[160:163], a[28:31], v[20:23]
v_exp_f32 v138, v138
M v[68:71], a[156:159], a[24:27], v[68:71]
v_cvt_pk_bf16_f32 v135, v150, v151
v_cvt_pk_bf16_f32 v136, v136, v137
M v[68:71], a[152:155], a[20:23], v[68:71]
v_exp_f32 v139, v139
M v[68:71], a[148:151], a[16:19], v[68:71]
buffer_load_dwordx4 v1, s[12:15], s26 offen offset:1024 sc1 lds
M v[72:75], a[148:151], a[32:35], v[24:27]
v_exp_f32 v152, v152
M v[72:75], a[152:155], a[36:39], v[72:75]
ds_read_b128 a[124:127], v3 offset:33792
ds_read_b128 a[128:131], v3 offset:41984
M v[72:75], a[156:159], a[40:43], v[72:75]
v_exp_f32 v153, v153
M v[72:75], a[160:163], a[44:47], v[72:75]
buffer_load_dwordx4 v1, s[12:15], s26 offen offset:2048 sc1 lds
M v[76:79], a[160:163], a[60:63], v[28:31]
v_exp_f32 v154, v154
M v[76:79], a[156:159], a[56:59], v[76:79]
v_cvt_pk_bf16_f32 v137, v138, v139
v_cvt_pk_bf16_f32 v138, v152, v153
M v[76:79], a[152:155], a[52:55], v[76:79]
v_exp_f32 v155, v155
M v[76:79], a[148:151], a[48:51], v[76:79]
buffer_load_dwordx4 v1, s[12:15], s26 offen offset:3072 sc1 lds
s_add_u32 m0, s29, 36864
s_waitcnt lgkmcnt(4)
M v[80:83], a[164:167], a[0:3], v[20:23]
v_exp_f32 v140, v140
M v[80:83], a[168:171], a[4:7], v[80:83]
ds_read_b128 a[132:135], v3 offset:34816
ds_read_b128 a[136:139], v3 offset:43008
M v[80:83], a[172:175], a[8:11], v[80:83]
v_exp_f32 v141, v141
M v[80:83], a[176:179], a[12:15], v[80:83]
buffer_load_dwordx4 v1, s[12:15], s43 offen offset:0 sc1 lds
M v[84:87], a[176:179], a[28:31], v[20:23]
v_exp_f32 v142, v142
M v[84:87], a[172:175], a[24:27], v[84:87]
v_cvt_pk_bf16_f32 v139, v154, v155
v_cvt_pk_bf16_f32 v140, v140, v141
M v[84:87], a[168:171], a[20:23], v[84:87]
v_exp_f32 v143, v143
M v[84:87], a[164:167], a[16:19], v[84:87]
buffer_load_dwordx4 v1, s[12:15], s43 offen offset:1024 sc1 lds
M v[88:91], a[164:167], a[32:35], v[20:23]
v_exp_f32 v156, v156
M v[88:91], a[168:171], a[36:39], v[88:91]
ds_read_b128 a[140:143], v3 offset:35840
ds_read_b128 a[144:147], v3 offset:44032
M v[88:91], a[172:175], a[40:43], v[88:91]
v_exp_f32 v157, v157
M v[88:91], a[176:179], a[44:47], v[88:91]
buffer_load_dwordx4 v1, s[12:15], s43 offen offset:2048 sc1 lds
M v[92:95], a[176:179], a[60:63], v[24:27]
v_exp_f32 v158, v158
M v[92:95], a[172:175], a[56:59], v[92:95]
v_cvt_pk_bf16_f32 v141, v142, v143
v_cvt_pk_bf16_f32 v142, v156, v157
M v[92:95], a[168:171], a[52:55], v[92:95]
v_exp_f32 v159, v159
M v[92:95], a[164:167], a[48:51], v[92:95]
buffer_load_dwordx4 v1, s[12:15], s43 offen offset:3072 sc1 lds
v_cvt_pk_bf16_f32 v143, v158, v159
s_waitcnt lgkmcnt(6)
M v[160:163], a[116:119], v[96:99], v[160:163]
v_exp_f32 v32, v32
M v[160:163], a[120:123], v[128:131], v[160:163]
ds_read_b128 a[148:151], v3 offset:36864
ds_read_b128 a[152:155], v3 offset:45056
M v[164:167], a[120:123], v[132:135], v[164:167]
v_exp_f32 v33, v33
M v[164:167], a[116:119], v[100:103], v[164:167]
v_cvt_pk_bf16_f32 v32, v32, v33
M v[168:171], a[116:119], v[104:107], v[168:171]
v_exp_f32 v34, v34
M v[168:171], a[120:123], v[136:139], v[168:171]
s_add_u32 s25, s25, 32768
s_cmp_eq_u32 s25, s27
M v[172:175], a[120:123], v[140:143], v[172:175]
v_exp_f32 v35, v35
M v[172:175], a[116:119], v[108:111], v[172:175]
v_cvt_pk_bf16_f32 v33, v34, v35
s_waitcnt lgkmcnt(6)
M a[96:99], a[112:115], v[96:99], a[96:99]
s_cselect_b32 s25, s28, s25
s_cselect_b32 s27, -1, s27
M a[96:99], a[112:115], v[128:131], a[96:99]
s_add_u32 s26, s26, 32768
s_cmp_eq_u32 s26, s62
M v[176:179], a[124:127], v[96:99], v[176:179]
v_exp_f32 v48, v48
M v[176:179], a[128:131], v[128:131], v[176:179]
ds_read_b128 a[156:159], v3 offset:37888
ds_read_b128 a[160:163], v3 offset:46080
M v[180:183], a[128:131], v[132:135], v[180:183]
v_exp_f32 v49, v49
M v[180:183], a[124:127], v[100:103], v[180:183]
v_cvt_pk_bf16_f32 v34, v48, v49
M v[184:187], a[124:127], v[104:107], v[184:187]
v_exp_f32 v50, v50
M v[184:187], a[128:131], v[136:139], v[184:187]
s_cselect_b32 s26, s63, s26
s_cselect_b32 s62, -1, s62
M v[188:191], a[128:131], v[140:143], v[188:191]
v_exp_f32 v51, v51
M v[188:191], a[124:127], v[108:111], v[188:191]
v_cvt_pk_bf16_f32 v35, v50, v51
s_waitcnt lgkmcnt(6)
M a[100:103], a[112:115], v[100:103], a[100:103]
M a[100:103], a[112:115], v[132:135], a[100:103]
M v[192:195], a[132:135], v[96:99], v[192:195]
v_exp_f32 v36, v36
M v[192:195], a[136:139], v[128:131], v[192:195]
ds_read_b128 a[164:167], v3 offset:38912
ds_read_b128 a[168:171], v3 offset:47104
M v[196:199], a[136:139], v[132:135], v[196:199]
v_exp_f32 v37, v37
M v[196:199], a[132:135], v[100:103], v[196:199]
v_cvt_pk_bf16_f32 v36, v36, v37
M v[200:203], a[132:135], v[104:107], v[200:203]
v_exp_f32 v38, v38
M v[200:203], a[136:139], v[136:139], v[200:203]
M v[204:207], a[136:139], v[140:143], v[204:207]
v_exp_f32 v39, v39
M v[204:207], a[132:135], v[108:111], v[204:207]
v_cvt_pk_bf16_f32 v37, v38, v39
s_waitcnt lgkmcnt(6)
M a[104:107], a[112:115], v[104:107], a[104:107]
M a[104:107], a[112:115], v[136:139], a[104:107]
M v[208:211], a[140:143], v[96:99], v[208:211]
v_exp_f32 v52, v52
M v[208:211], a[144:147], v[128:131], v[208:211]
ds_read_b128 a[172:175], v3 offset:39936
ds_read_b128 a[176:179], v3 offset:48128
M v[212:215], a[144:147], v[132:135], v[212:215]
v_exp_f32 v53, v53
M v[212:215], a[140:143], v[100:103], v[212:215]
v_cvt_pk_bf16_f32 v38, v52, v53
M v[216:219], a[140:143], v[104:107], v[216:219]
v_exp_f32 v54, v54
M v[216:219], a[144:147], v[136:139], v[216:219]
M v[220:223], a[144:147], v[140:143], v[220:223]
v_exp_f32 v55, v55
M v[220:223], a[140:143], v[108:111], v[220:223]
v_cvt_pk_bf16_f32 v39, v54, v55
s_waitcnt lgkmcnt(6)
M a[108:111], a[112:115], v[108:111], a[108:111]
M a[108:111], a[112:115], v[140:143], a[108:111]
M v[224:227], a[148:151], v[96:99], v[224:227]
v_exp_f32 v40, v40
M v[224:227], a[152:155], v[128:131], v[224:227]
M v[228:231], a[152:155], v[132:135], v[228:231]
v_exp_f32 v41, v41
M v[228:231], a[148:151], v[100:103], v[228:231]
v_cvt_pk_bf16_f32 v40, v40, v41
M v[232:235], a[148:151], v[104:107], v[232:235]
v_exp_f32 v42, v42
M v[232:235], a[152:155], v[136:139], v[232:235]
M v[236:239], a[152:155], v[140:143], v[236:239]
v_exp_f32 v43, v43
M v[236:239], a[148:151], v[108:111], v[236:239]
v_cvt_pk_bf16_f32 v41, v42, v43
s_waitcnt lgkmcnt(4)
M v[240:243], a[156:159], v[96:99], v[240:243]
v_exp_f32 v56, v56
M v[240:243], a[160:163], v[128:131], v[240:243]
M v[244:247], a[160:163], v[132:135], v[244:247]
v_exp_f32 v57, v57
M v[244:247], a[156:159], v[100:103], v[244:247]
v_cvt_pk_bf16_f32 v42, v56, v57
M v[248:251], a[156:159], v[104:107], v[248:251]
v_exp_f32 v58, v58
M v[248:251], a[160:163], v[136:139], v[248:251]
s_waitcnt vmcnt(0) lgkmcnt(0)
s_barrier
ds_read_b128 a[116:119], v2 offset:0
ds_read_b128 a[120:123], v2 offset:1024
M v[252:255], a[160:163], v[140:143], v[252:255]
v_exp_f32 v59, v59
M v[252:255], a[156:159], v[108:111], v[252:255]
v_cvt_pk_bf16_f32 v43, v58, v59
M a[64:67], a[164:167], v[96:99], a[64:67]
v_exp_f32 v44, v44
M a[64:67], a[168:171], v[128:131], a[64:67]
ds_read_b128 a[124:127], v2 offset:2048
ds_read_b128 a[128:131], v2 offset:3072
M a[68:71], a[168:171], v[132:135], a[68:71]
v_exp_f32 v45, v45
M a[68:71], a[164:167], v[100:103], a[68:71]
v_cvt_pk_bf16_f32 v44, v44, v45
M a[72:75], a[164:167], v[104:107], a[72:75]
v_exp_f32 v46, v46
M a[72:75], a[168:171], v[136:139], a[72:75]
ds_read_b128 a[132:135], v2 offset:4096
ds_read_b128 a[136:139], v2 offset:5120
M a[76:79], a[168:171], v[140:143], a[76:79]
v_exp_f32 v47, v47
M a[76:79], a[164:167], v[108:111], a[76:79]
v_cvt_pk_bf16_f32 v45, v46, v47
M a[80:83], a[172:175], v[96:99], a[80:83]
v_exp_f32 v60, v60
M a[80:83], a[176:179], v[128:131], a[80:83]
ds_read_b128 a[140:143], v2 offset:6144
ds_read_b128 a[144:147], v2 offset:7168
M a[84:87], a[176:179], v[132:135], a[84:87]
v_exp_f32 v61, v61
M a[84:87], a[172:175], v[100:103], a[84:87]
v_cvt_pk_bf16_f32 v46, v60, v61
M a[88:91], a[172:175], v[104:107], a[88:91]
v_exp_f32 v62, v62
M a[88:91], a[176:179], v[136:139], a[88:91]
M a[92:95], a[176:179], v[140:143], a[92:95]
v_exp_f32 v63, v63
M a[92:95], a[172:175], v[108:111], a[92:95]
v_cvt_pk_bf16_f32 v47, v62, v63
Lk2_m2:
s_sub_u32 s35, 15, s21
s_lshl_b32 s33, s20, 7
s_lshl_b32 s34, s35, 3
s_add_u32 s33, s33, s34
s_lshl_b32 s34, s23, 2
s_add_u32 s33, s33, s34
s_lshl_b32 s33, s33, 12
buffer_load_dwordx4 a[180:183], v1, s[8:11], s33 offen offset:0 sc1
buffer_load_dwordx4 a[184:187], v1, s[8:11], s33 offen offset:1024 sc1
buffer_load_dwordx4 a[188:191], v1, s[8:11], s33 offen offset:2048 sc1
buffer_load_dwordx4 a[192:195], v1, s[8:11], s33 offen offset:3072 sc1
s_add_u32 s33, s33, 4096
buffer_load_dwordx4 a[196:199], v1, s[8:11], s33 offen offset:0 sc1
buffer_load_dwordx4 a[200:203], v1, s[8:11], s33 offen offset:1024 sc1
buffer_load_dwordx4 a[204:207], v1, s[8:11], s33 offen offset:2048 sc1
buffer_load_dwordx4 a[208:211], v1, s[8:11], s33 offen offset:3072 sc1
s_add_u32 s33, s33, 4096
buffer_load_dwordx4 a[212:215], v1, s[8:11], s33 offen offset:0 sc1
buffer_load_dwordx4 a[216:219], v1, s[8:11], s33 offen offset:1024 sc1
buffer_load_dwordx4 a[220:223], v1, s[8:11], s33 offen offset:2048 sc1
buffer_load_dwordx4 a[224:227], v1, s[8:11], s33 offen offset:3072 sc1
s_add_u32 s33, s33, 4096
buffer_load_dwordx4 a[228:231], v1, s[8:11], s33 offen offset:0 sc1
buffer_load_dwordx4 a[232:235], v1, s[8:11], s33 offen offset:1024 sc1
buffer_load_dwordx4 a[236:239], v1, s[8:11], s33 offen offset:2048 sc1
buffer_load_dwordx4 a[240:243], v1, s[8:11], s33 offen offset:3072 sc1
s_lshl_b32 s33, s23, 6
s_add_i32 s33, s33, -64
s_cmp_gt_i32 s33, 0
s_cselect_b32 s34, 0, 0xf149f2ca
s_cmp_lt_i32 s33, 0
s_cselect_b32 s33, 0xf149f2ca, 0
v_mov_b32 v20, s34
v_mov_b32 v21, s34
v_mov_b32 v22, s34
v_mov_b32 v23, s34
v_mov_b32 v28, s33
v_mov_b32 v29, s33
v_mov_b32 v30, s33
v_mov_b32 v31, s33
v_med3_f32 v24, v16, v20, v28
v_med3_f32 v25, v17, v20, v28
v_med3_f32 v26, v18, v20, v28
v_med3_f32 v27, v19, v20, v28
s_add_u32 m0, s29, 65536
s_waitcnt lgkmcnt(4)
M v[96:99], a[116:119], a[0:3], v[24:27]
v_exp_f32 v64, v64
M v[96:99], a[120:123], a[4:7], v[96:99]
ds_read_b128 a[148:151], v2 offset:8192
ds_read_b128 a[152:155], v2 offset:9216
M v[96:99], a[124:127], a[8:11], v[96:99]
v_exp_f32 v65, v65
M v[96:99], a[128:131], a[12:15], v[96:99]
buffer_load_dwordx4 v1, s[12:15], s25 offen offset:0 sc1 lds
s_add_u32 s32, s25, 4096
M v[100:103], a[128:131], a[28:31], v[28:31]
v_exp_f32 v66, v66
M v[100:103], a[124:127], a[24:27], v[100:103]
v_cvt_pk_bf16_f32 v64, v64, v65
M v[100:103], a[120:123], a[20:23], v[100:103]
v_exp_f32 v67, v67
M v[100:103], a[116:119], a[16:19], v[100:103]
buffer_load_dwordx4 v1, s[12:15], s25 offen offset:1024 sc1 lds
M v[104:107], a[116:119], a[32:35], v[28:31]
v_exp_f32 v80, v80
M v[104:107], a[120:123], a[36:39], v[104:107]
ds_read_b128 a[156:159], v2 offset:10240
ds_read_b128 a[160:163], v2 offset:11264
M v[104:107], a[124:127], a[40:43], v[104:107]
v_exp_f32 v81, v81
M v[104:107], a[128:131], a[44:47], v[104:107]
buffer_load_dwordx4 v1, s[12:15], s25 offen offset:2048 sc1 lds
M v[108:111], a[128:131], a[60:63], v[28:31]
v_exp_f32 v82, v82
M v[108:111], a[124:127], a[56:59], v[108:111]
v_cvt_pk_bf16_f32 v65, v66, v67
v_cvt_pk_bf16_f32 v66, v80, v81
M v[108:111], a[120:123], a[52:55], v[108:111]
v_exp_f32 v83, v83
M v[108:111], a[116:119], a[48:51], v[108:111]
buffer_load_dwordx4 v1, s[12:15], s25 offen offset:3072 sc1 lds
s_add_u32 m0, s29, 69632
s_waitcnt lgkmcnt(4)
M v[112:115], a[132:135], a[0:3], v[20:23]
v_exp_f32 v68, v68
M v[112:115], a[136:139], a[4:7], v[112:115]
ds_read_b128 a[164:167], v2 offset:12288
ds_read_b128 a[168:171], v2 offset:13312
M v[112:115], a[140:143], a[8:11], v[112:115]
v_exp_f32 v69, v69
M v[112:115], a[144:147], a[12:15], v[112:115]
buffer_load_dwordx4 v1, s[12:15], s32 offen offset:0 sc1 lds
M v[116:119], a[144:147], a[28:31], v[24:27]
v_exp_f32 v70, v70
M v[116:119], a[140:143], a[24:27], v[116:119]
v_cvt_pk_bf16_f32 v67, v82, v83
v_cvt_pk_bf16_f32 v68, v68, v69
M v[116:119], a[136:139], a[20:23], v[116:119]
v_exp_f32 v71, v71
M v[116:119], a[132:135], a[16:19], v[116:119]
buffer_load_dwordx4 v1, s[12:15], s32 offen offset:1024 sc1 lds
M v[120:123], a[132:135], a[32:35], v[28:31]
v_exp_f32 v84, v84
M v[120:123], a[136:139], a[36:39], v[120:123]
ds_read_b128 a[172:175], v2 offset:14336
ds_read_b128 a[176:179], v2 offset:15360
M v[120:123], a[140:143], a[40:43], v[120:123]
v_exp_f32 v85, v85
M v[120:123], a[144:147], a[44:47], v[120:123]
buffer_load_dwordx4 v1, s[12:15], s32 offen offset:2048 sc1 lds
M v[124:127], a[144:147], a[60:63], v[28:31]
v_exp_f32 v86, v86
M v[124:127], a[140:143], a[56:59], v[124:127]
v_cvt_pk_bf16_f32 v69, v70, v71
v_cvt_pk_bf16_f32 v70, v84, v85
M v[124:127], a[136:139], a[52:55], v[124:127]
v_exp_f32 v87, v87
M v[124:127], a[132:135], a[48:51], v[124:127]
buffer_load_dwordx4 v1, s[12:15], s32 offen offset:3072 sc1 lds
s_add_u32 m0, s29, 98304
s_waitcnt lgkmcnt(4)
M v[128:131], a[148:151], a[0:3], v[20:23]
v_exp_f32 v72, v72
M v[128:131], a[152:155], a[4:7], v[128:131]
ds_read_b128 a[116:119], v2 offset:32768
ds_read_b128 a[120:123], v2 offset:40960
M v[128:131], a[156:159], a[8:11], v[128:131]
v_exp_f32 v73, v73
M v[128:131], a[160:163], a[12:15], v[128:131]
buffer_load_dwordx4 v1, s[12:15], s26 offen offset:0 sc1 lds
s_add_u32 s43, s26, 4096
M v[132:135], a[160:163], a[28:31], v[20:23]
v_exp_f32 v74, v74
M v[132:135], a[156:159], a[24:27], v[132:135]
v_cvt_pk_bf16_f32 v71, v86, v87
v_cvt_pk_bf16_f32 v72, v72, v73
M v[132:135], a[152:155], a[20:23], v[132:135]
v_exp_f32 v75, v75
M v[132:135], a[148:151], a[16:19], v[132:135]
buffer_load_dwordx4 v1, s[12:15], s26 offen offset:1024 sc1 lds
M v[136:139], a[148:151], a[32:35], v[24:27]
v_exp_f32 v88, v88
M v[136:139], a[152:155], a[36:39], v[136:139]
ds_read_b128 a[124:127], v2 offset:33792
ds_read_b128 a[128:131], v2 offset:41984
M v[136:139], a[156:159], a[40:43], v[136:139]
v_exp_f32 v89, v89
M v[136:139], a[160:163], a[44:47], v[136:139]
buffer_load_dwordx4 v1, s[12:15], s26 offen offset:2048 sc1 lds
M v[140:143], a[160:163], a[60:63], v[28:31]
v_exp_f32 v90, v90
M v[140:143], a[156:159], a[56:59], v[140:143]
v_cvt_pk_bf16_f32 v73, v74, v75
v_cvt_pk_bf16_f32 v74, v88, v89
M v[140:143], a[152:155], a[52:55], v[140:143]
v_exp_f32 v91, v91
M v[140:143], a[148:151], a[48:51], v[140:143]
buffer_load_dwordx4 v1, s[12:15], s26 offen offset:3072 sc1 lds
s_add_u32 m0, s29, 102400
s_waitcnt lgkmcnt(4)
M v[144:147], a[164:167], a[0:3], v[20:23]
v_exp_f32 v76, v76
M v[144:147], a[168:171], a[4:7], v[144:147]
ds_read_b128 a[132:135], v2 offset:34816
ds_read_b128 a[136:139], v2 offset:43008
M v[144:147], a[172:175], a[8:11], v[144:147]
v_exp_f32 v77, v77
M v[144:147], a[176:179], a[12:15], v[144:147]
buffer_load_dwordx4 v1, s[12:15], s43 offen offset:0 sc1 lds
M v[148:151], a[176:179], a[28:31], v[20:23]
v_exp_f32 v78, v78
M v[148:151], a[172:175], a[24:27], v[148:151]
v_cvt_pk_bf16_f32 v75, v90, v91
v_cvt_pk_bf16_f32 v76, v76, v77
M v[148:151], a[168:171], a[20:23], v[148:151]
v_exp_f32 v79, v79
M v[148:151], a[164:167], a[16:19], v[148:151]
buffer_load_dwordx4 v1, s[12:15], s43 offen offset:1024 sc1 lds
M v[152:155], a[164:167], a[32:35], v[20:23]
v_exp_f32 v92, v92
M v[152:155], a[168:171], a[36:39], v[152:155]
ds_read_b128 a[140:143], v2 offset:35840
ds_read_b128 a[144:147], v2 offset:44032
M v[152:155], a[172:175], a[40:43], v[152:155]
v_exp_f32 v93, v93
M v[152:155], a[176:179], a[44:47], v[152:155]
buffer_load_dwordx4 v1, s[12:15], s43 offen offset:2048 sc1 lds
M v[156:159], a[176:179], a[60:63], v[24:27]
v_exp_f32 v94, v94
M v[156:159], a[172:175], a[56:59], v[156:159]
v_cvt_pk_bf16_f32 v77, v78, v79
v_cvt_pk_bf16_f32 v78, v92, v93
M v[156:159], a[168:171], a[52:55], v[156:159]
v_exp_f32 v95, v95
M v[156:159], a[164:167], a[48:51], v[156:159]
buffer_load_dwordx4 v1, s[12:15], s43 offen offset:3072 sc1 lds
v_cvt_pk_bf16_f32 v79, v94, v95
s_waitcnt lgkmcnt(6)
M v[160:163], a[116:119], v[32:35], v[160:163]
v_exp_f32 v96, v96
M v[160:163], a[120:123], v[64:67], v[160:163]
ds_read_b128 a[148:151], v2 offset:36864
ds_read_b128 a[152:155], v2 offset:45056
M v[164:167], a[120:123], v[68:71], v[164:167]
v_exp_f32 v97, v97
M v[164:167], a[116:119], v[36:39], v[164:167]
v_cvt_pk_bf16_f32 v96, v96, v97
M v[168:171], a[116:119], v[40:43], v[168:171]
v_exp_f32 v98, v98
M v[168:171], a[120:123], v[72:75], v[168:171]
s_add_u32 s25, s25, 32768
s_cmp_eq_u32 s25, s27
M v[172:175], a[120:123], v[76:79], v[172:175]
v_exp_f32 v99, v99
M v[172:175], a[116:119], v[44:47], v[172:175]
v_cvt_pk_bf16_f32 v97, v98, v99
s_waitcnt lgkmcnt(6)
M a[96:99], a[112:115], v[32:35], a[96:99]
s_cselect_b32 s25, s28, s25
s_cselect_b32 s27, -1, s27
M a[96:99], a[112:115], v[64:67], a[96:99]
s_add_u32 s26, s26, 32768
s_cmp_eq_u32 s26, s62
M v[176:179], a[124:127], v[32:35], v[176:179]
v_exp_f32 v112, v112
M v[176:179], a[128:131], v[64:67], v[176:179]
ds_read_b128 a[156:159], v2 offset:37888
ds_read_b128 a[160:163], v2 offset:46080
M v[180:183], a[128:131], v[68:71], v[180:183]
v_exp_f32 v113, v113
M v[180:183], a[124:127], v[36:39], v[180:183]
v_cvt_pk_bf16_f32 v98, v112, v113
M v[184:187], a[124:127], v[40:43], v[184:187]
v_exp_f32 v114, v114
M v[184:187], a[128:131], v[72:75], v[184:187]
s_cselect_b32 s26, s63, s26
s_cselect_b32 s62, -1, s62
M v[188:191], a[128:131], v[76:79], v[188:191]
v_exp_f32 v115, v115
M v[188:191], a[124:127], v[44:47], v[188:191]
v_cvt_pk_bf16_f32 v99, v114, v115
s_waitcnt lgkmcnt(6)
M a[100:103], a[112:115], v[36:39], a[100:103]
M a[100:103], a[112:115], v[68:71], a[100:103]
M v[192:195], a[132:135], v[32:35], v[192:195]
v_exp_f32 v100, v100
M v[192:195], a[136:139], v[64:67], v[192:195]
ds_read_b128 a[164:167], v2 offset:38912
ds_read_b128 a[168:171], v2 offset:47104
M v[196:199], a[136:139], v[68:71], v[196:199]
v_exp_f32 v101, v101
M v[196:199], a[132:135], v[36:39], v[196:199]
v_cvt_pk_bf16_f32 v100, v100, v101
M v[200:203], a[132:135], v[40:43], v[200:203]
v_exp_f32 v102, v102
M v[200:203], a[136:139], v[72:75], v[200:203]
M v[204:207], a[136:139], v[76:79], v[204:207]
v_exp_f32 v103, v103
M v[204:207], a[132:135], v[44:47], v[204:207]
v_cvt_pk_bf16_f32 v101, v102, v103
s_waitcnt lgkmcnt(6)
M a[104:107], a[112:115], v[40:43], a[104:107]
M a[104:107], a[112:115], v[72:75], a[104:107]
M v[208:211], a[140:143], v[32:35], v[208:211]
v_exp_f32 v116, v116
M v[208:211], a[144:147], v[64:67], v[208:211]
ds_read_b128 a[172:175], v2 offset:39936
ds_read_b128 a[176:179], v2 offset:48128
M v[212:215], a[144:147], v[68:71], v[212:215]
v_exp_f32 v117, v117
M v[212:215], a[140:143], v[36:39], v[212:215]
v_cvt_pk_bf16_f32 v102, v116, v117
M v[216:219], a[140:143], v[40:43], v[216:219]
v_exp_f32 v118, v118
M v[216:219], a[144:147], v[72:75], v[216:219]
M v[220:223], a[144:147], v[76:79], v[220:223]
v_exp_f32 v119, v119
M v[220:223], a[140:143], v[44:47], v[220:223]
v_cvt_pk_bf16_f32 v103, v118, v119
s_waitcnt lgkmcnt(6)
M a[108:111], a[112:115], v[44:47], a[108:111]
M a[108:111], a[112:115], v[76:79], a[108:111]
M v[224:227], a[148:151], v[32:35], v[224:227]
v_exp_f32 v104, v104
M v[224:227], a[152:155], v[64:67], v[224:227]
M v[228:231], a[152:155], v[68:71], v[228:231]
v_exp_f32 v105, v105
M v[228:231], a[148:151], v[36:39], v[228:231]
v_cvt_pk_bf16_f32 v104, v104, v105
M v[232:235], a[148:151], v[40:43], v[232:235]
v_exp_f32 v106, v106
M v[232:235], a[152:155], v[72:75], v[232:235]
M v[236:239], a[152:155], v[76:79], v[236:239]
v_exp_f32 v107, v107
M v[236:239], a[148:151], v[44:47], v[236:239]
v_cvt_pk_bf16_f32 v105, v106, v107
s_waitcnt lgkmcnt(4)
M v[240:243], a[156:159], v[32:35], v[240:243]
v_exp_f32 v120, v120
M v[240:243], a[160:163], v[64:67], v[240:243]
M v[244:247], a[160:163], v[68:71], v[244:247]
v_exp_f32 v121, v121
M v[244:247], a[156:159], v[36:39], v[244:247]
v_cvt_pk_bf16_f32 v106, v120, v121
M v[248:251], a[156:159], v[40:43], v[248:251]
v_exp_f32 v122, v122
M v[248:251], a[160:163], v[72:75], v[248:251]
s_waitcnt vmcnt(0) lgkmcnt(0)
s_barrier
ds_read_b128 a[116:119], v3 offset:0
ds_read_b128 a[120:123], v3 offset:1024
M v[252:255], a[160:163], v[76:79], v[252:255]
v_exp_f32 v123, v123
M v[252:255], a[156:159], v[44:47], v[252:255]
v_cvt_pk_bf16_f32 v107, v122, v123
M a[64:67], a[164:167], v[32:35], a[64:67]
v_exp_f32 v108, v108
M a[64:67], a[168:171], v[64:67], a[64:67]
ds_read_b128 a[124:127], v3 offset:2048
ds_read_b128 a[128:131], v3 offset:3072
M a[68:71], a[168:171], v[68:71], a[68:71]
v_exp_f32 v109, v109
M a[68:71], a[164:167], v[36:39], a[68:71]
v_cvt_pk_bf16_f32 v108, v108, v109
M a[72:75], a[164:167], v[40:43], a[72:75]
v_exp_f32 v110, v110
M a[72:75], a[168:171], v[72:75], a[72:75]
ds_read_b128 a[132:135], v3 offset:4096
ds_read_b128 a[136:139], v3 offset:5120
M a[76:79], a[168:171], v[76:79], a[76:79]
v_exp_f32 v111, v111
M a[76:79], a[164:167], v[44:47], a[76:79]
v_cvt_pk_bf16_f32 v109, v110, v111
M a[80:83], a[172:175], v[32:35], a[80:83]
v_exp_f32 v124, v124
M a[80:83], a[176:179], v[64:67], a[80:83]
ds_read_b128 a[140:143], v3 offset:6144
ds_read_b128 a[144:147], v3 offset:7168
M a[84:87], a[176:179], v[68:71], a[84:87]
v_exp_f32 v125, v125
M a[84:87], a[172:175], v[36:39], a[84:87]
v_cvt_pk_bf16_f32 v110, v124, v125
M a[88:91], a[172:175], v[40:43], a[88:91]
v_exp_f32 v126, v126
M a[88:91], a[176:179], v[72:75], a[88:91]
M a[92:95], a[176:179], v[76:79], a[92:95]
v_exp_f32 v127, v127
M a[92:95], a[172:175], v[44:47], a[92:95]
v_cvt_pk_bf16_f32 v111, v126, v127
s_waitcnt vmcnt(16)
s_add_u32 m0, s29, 0
s_waitcnt lgkmcnt(4)
M v[32:35], a[116:119], a[180:183], 0
v_exp_f32 v128, v128
M v[32:35], a[120:123], a[184:187], v[32:35]
ds_read_b128 a[148:151], v3 offset:8192
ds_read_b128 a[152:155], v3 offset:9216
M v[32:35], a[124:127], a[188:191], v[32:35]
v_exp_f32 v129, v129
M v[32:35], a[128:131], a[192:195], v[32:35]
buffer_load_dwordx4 v1, s[12:15], s25 offen offset:0 sc1 lds
s_add_u32 s32, s25, 4096
M v[36:39], a[128:131], a[208:211], 0
v_exp_f32 v130, v130
M v[36:39], a[124:127], a[204:207], v[36:39]
v_cvt_pk_bf16_f32 v128, v128, v129
M v[36:39], a[120:123], a[200:203], v[36:39]
v_exp_f32 v131, v131
M v[36:39], a[116:119], a[196:199], v[36:39]
buffer_load_dwordx4 v1, s[12:15], s25 offen offset:1024 sc1 lds
M v[40:43], a[116:119], a[212:215], 0
v_exp_f32 v144, v144
M v[40:43], a[120:123], a[216:219], v[40:43]
ds_read_b128 a[156:159], v3 offset:10240
ds_read_b128 a[160:163], v3 offset:11264
M v[40:43], a[124:127], a[220:223], v[40:43]
v_exp_f32 v145, v145
M v[40:43], a[128:131], a[224:227], v[40:43]
buffer_load_dwordx4 v1, s[12:15], s25 offen offset:2048 sc1 lds
M v[44:47], a[128:131], a[240:243], 0
v_exp_f32 v146, v146
M v[44:47], a[124:127], a[236:239], v[44:47]
v_cvt_pk_bf16_f32 v129, v130, v131
v_cvt_pk_bf16_f32 v130, v144, v145
M v[44:47], a[120:123], a[232:235], v[44:47]
v_exp_f32 v147, v147
M v[44:47], a[116:119], a[228:231], v[44:47]
buffer_load_dwordx4 v1, s[12:15], s25 offen offset:3072 sc1 lds
s_add_u32 m0, s29, 4096
s_waitcnt lgkmcnt(4)
M v[48:51], a[132:135], a[180:183], 0
v_exp_f32 v132, v132
M v[48:51], a[136:139], a[184:187], v[48:51]
ds_read_b128 a[164:167], v3 offset:12288
ds_read_b128 a[168:171], v3 offset:13312
M v[48:51], a[140:143], a[188:191], v[48:51]
v_exp_f32 v133, v133
M v[48:51], a[144:147], a[192:195], v[48:51]
buffer_load_dwordx4 v1, s[12:15], s32 offen offset:0 sc1 lds
M v[52:55], a[144:147], a[208:211], 0
v_exp_f32 v134, v134
M v[52:55], a[140:143], a[204:207], v[52:55]
v_cvt_pk_bf16_f32 v131, v146, v147
v_cvt_pk_bf16_f32 v132, v132, v133
M v[52:55], a[136:139], a[200:203], v[52:55]
v_exp_f32 v135, v135
M v[52:55], a[132:135], a[196:199], v[52:55]
buffer_load_dwordx4 v1, s[12:15], s32 offen offset:1024 sc1 lds
M v[56:59], a[132:135], a[212:215], 0
v_exp_f32 v148, v148
M v[56:59], a[136:139], a[216:219], v[56:59]
ds_read_b128 a[172:175], v3 offset:14336
ds_read_b128 a[176:179], v3 offset:15360
M v[56:59], a[140:143], a[220:223], v[56:59]
v_exp_f32 v149, v149
M v[56:59], a[144:147], a[224:227], v[56:59]
buffer_load_dwordx4 v1, s[12:15], s32 offen offset:2048 sc1 lds
M v[60:63], a[144:147], a[240:243], 0
v_exp_f32 v150, v150
M v[60:63], a[140:143], a[236:239], v[60:63]
v_cvt_pk_bf16_f32 v133, v134, v135
v_cvt_pk_bf16_f32 v134, v148, v149
M v[60:63], a[136:139], a[232:235], v[60:63]
v_exp_f32 v151, v151
M v[60:63], a[132:135], a[228:231], v[60:63]
buffer_load_dwordx4 v1, s[12:15], s32 offen offset:3072 sc1 lds
s_add_u32 m0, s29, 32768
s_waitcnt lgkmcnt(4)
M v[64:67], a[148:151], a[180:183], 0
v_exp_f32 v136, v136
M v[64:67], a[152:155], a[184:187], v[64:67]
ds_read_b128 a[116:119], v3 offset:32768
ds_read_b128 a[120:123], v3 offset:40960
M v[64:67], a[156:159], a[188:191], v[64:67]
v_exp_f32 v137, v137
M v[64:67], a[160:163], a[192:195], v[64:67]
buffer_load_dwordx4 v1, s[12:15], s26 offen offset:0 sc1 lds
s_add_u32 s43, s26, 4096
M v[68:71], a[160:163], a[208:211], 0
v_exp_f32 v138, v138
M v[68:71], a[156:159], a[204:207], v[68:71]
v_cvt_pk_bf16_f32 v135, v150, v151
v_cvt_pk_bf16_f32 v136, v136, v137
M v[68:71], a[152:155], a[200:203], v[68:71]
v_exp_f32 v139, v139
M v[68:71], a[148:151], a[196:199], v[68:71]
buffer_load_dwordx4 v1, s[12:15], s26 offen offset:1024 sc1 lds
M v[72:75], a[148:151], a[212:215], 0
v_exp_f32 v152, v152
M v[72:75], a[152:155], a[216:219], v[72:75]
ds_read_b128 a[124:127], v3 offset:33792
ds_read_b128 a[128:131], v3 offset:41984
M v[72:75], a[156:159], a[220:223], v[72:75]
v_exp_f32 v153, v153
M v[72:75], a[160:163], a[224:227], v[72:75]
buffer_load_dwordx4 v1, s[12:15], s26 offen offset:2048 sc1 lds
M v[76:79], a[160:163], a[240:243], 0
v_exp_f32 v154, v154
M v[76:79], a[156:159], a[236:239], v[76:79]
v_cvt_pk_bf16_f32 v137, v138, v139
v_cvt_pk_bf16_f32 v138, v152, v153
M v[76:79], a[152:155], a[232:235], v[76:79]
v_exp_f32 v155, v155
M v[76:79], a[148:151], a[228:231], v[76:79]
buffer_load_dwordx4 v1, s[12:15], s26 offen offset:3072 sc1 lds
s_add_u32 m0, s29, 36864
s_waitcnt lgkmcnt(4)
M v[80:83], a[164:167], a[180:183], 0
v_exp_f32 v140, v140
M v[80:83], a[168:171], a[184:187], v[80:83]
ds_read_b128 a[132:135], v3 offset:34816
ds_read_b128 a[136:139], v3 offset:43008
M v[80:83], a[172:175], a[188:191], v[80:83]
v_exp_f32 v141, v141
M v[80:83], a[176:179], a[192:195], v[80:83]
buffer_load_dwordx4 v1, s[12:15], s43 offen offset:0 sc1 lds
M v[84:87], a[176:179], a[208:211], 0
v_exp_f32 v142, v142
M v[84:87], a[172:175], a[204:207], v[84:87]
v_cvt_pk_bf16_f32 v139, v154, v155
v_cvt_pk_bf16_f32 v140, v140, v141
M v[84:87], a[168:171], a[200:203], v[84:87]
v_exp_f32 v143, v143
M v[84:87], a[164:167], a[196:199], v[84:87]
buffer_load_dwordx4 v1, s[12:15], s43 offen offset:1024 sc1 lds
M v[88:91], a[164:167], a[212:215], 0
v_exp_f32 v156, v156
M v[88:91], a[168:171], a[216:219], v[88:91]
ds_read_b128 a[140:143], v3 offset:35840
ds_read_b128 a[144:147], v3 offset:44032
M v[88:91], a[172:175], a[220:223], v[88:91]
v_exp_f32 v157, v157
M v[88:91], a[176:179], a[224:227], v[88:91]
buffer_load_dwordx4 v1, s[12:15], s43 offen offset:2048 sc1 lds
M v[92:95], a[176:179], a[240:243], 0
v_exp_f32 v158, v158
M v[92:95], a[172:175], a[236:239], v[92:95]
v_cvt_pk_bf16_f32 v141, v142, v143
v_cvt_pk_bf16_f32 v142, v156, v157
M v[92:95], a[168:171], a[232:235], v[92:95]
v_exp_f32 v159, v159
M v[92:95], a[164:167], a[228:231], v[92:95]
buffer_load_dwordx4 v1, s[12:15], s43 offen offset:3072 sc1 lds
v_cvt_pk_bf16_f32 v143, v158, v159
s_waitcnt lgkmcnt(6)
M v[160:163], a[116:119], v[96:99], v[160:163]
v_exp_f32 v32, v32
M v[160:163], a[120:123], v[128:131], v[160:163]
ds_read_b128 a[148:151], v3 offset:36864
ds_read_b128 a[152:155], v3 offset:45056
M v[164:167], a[120:123], v[132:135], v[164:167]
v_exp_f32 v33, v33
M v[164:167], a[116:119], v[100:103], v[164:167]
v_cvt_pk_bf16_f32 v32, v32, v33
M v[168:171], a[116:119], v[104:107], v[168:171]
v_exp_f32 v34, v34
M v[168:171], a[120:123], v[136:139], v[168:171]
s_add_u32 s25, s25, 32768
s_cmp_eq_u32 s25, s27
M v[172:175], a[120:123], v[140:143], v[172:175]
v_exp_f32 v35, v35
M v[172:175], a[116:119], v[108:111], v[172:175]
v_cvt_pk_bf16_f32 v33, v34, v35
s_waitcnt lgkmcnt(6)
M a[96:99], a[112:115], v[96:99], a[96:99]
s_cselect_b32 s25, s28, s25
s_cselect_b32 s27, -1, s27
M a[96:99], a[112:115], v[128:131], a[96:99]
s_add_u32 s26, s26, 32768
s_cmp_eq_u32 s26, s62
M v[176:179], a[124:127], v[96:99], v[176:179]
v_exp_f32 v48, v48
M v[176:179], a[128:131], v[128:131], v[176:179]
ds_read_b128 a[156:159], v3 offset:37888
ds_read_b128 a[160:163], v3 offset:46080
M v[180:183], a[128:131], v[132:135], v[180:183]
v_exp_f32 v49, v49
M v[180:183], a[124:127], v[100:103], v[180:183]
v_cvt_pk_bf16_f32 v34, v48, v49
M v[184:187], a[124:127], v[104:107], v[184:187]
v_exp_f32 v50, v50
M v[184:187], a[128:131], v[136:139], v[184:187]
s_cselect_b32 s26, s63, s26
s_cselect_b32 s62, -1, s62
M v[188:191], a[128:131], v[140:143], v[188:191]
v_exp_f32 v51, v51
M v[188:191], a[124:127], v[108:111], v[188:191]
v_cvt_pk_bf16_f32 v35, v50, v51
s_waitcnt lgkmcnt(6)
M a[100:103], a[112:115], v[100:103], a[100:103]
M a[100:103], a[112:115], v[132:135], a[100:103]
M v[192:195], a[132:135], v[96:99], v[192:195]
v_exp_f32 v36, v36
M v[192:195], a[136:139], v[128:131], v[192:195]
ds_read_b128 a[164:167], v3 offset:38912
ds_read_b128 a[168:171], v3 offset:47104
M v[196:199], a[136:139], v[132:135], v[196:199]
v_exp_f32 v37, v37
M v[196:199], a[132:135], v[100:103], v[196:199]
v_cvt_pk_bf16_f32 v36, v36, v37
M v[200:203], a[132:135], v[104:107], v[200:203]
v_exp_f32 v38, v38
M v[200:203], a[136:139], v[136:139], v[200:203]
M v[204:207], a[136:139], v[140:143], v[204:207]
v_exp_f32 v39, v39
M v[204:207], a[132:135], v[108:111], v[204:207]
v_cvt_pk_bf16_f32 v37, v38, v39
s_waitcnt lgkmcnt(6)
M a[104:107], a[112:115], v[104:107], a[104:107]
M a[104:107], a[112:115], v[136:139], a[104:107]
M v[208:211], a[140:143], v[96:99], v[208:211]
v_exp_f32 v52, v52
M v[208:211], a[144:147], v[128:131], v[208:211]
ds_read_b128 a[172:175], v3 offset:39936
ds_read_b128 a[176:179], v3 offset:48128
M v[212:215], a[144:147], v[132:135], v[212:215]
v_exp_f32 v53, v53
M v[212:215], a[140:143], v[100:103], v[212:215]
v_cvt_pk_bf16_f32 v38, v52, v53
M v[216:219], a[140:143], v[104:107], v[216:219]
v_exp_f32 v54, v54
M v[216:219], a[144:147], v[136:139], v[216:219]
M v[220:223], a[144:147], v[140:143], v[220:223]
v_exp_f32 v55, v55
M v[220:223], a[140:143], v[108:111], v[220:223]
v_cvt_pk_bf16_f32 v39, v54, v55
s_waitcnt lgkmcnt(6)
M a[108:111], a[112:115], v[108:111], a[108:111]
M a[108:111], a[112:115], v[140:143], a[108:111]
M v[224:227], a[148:151], v[96:99], v[224:227]
v_exp_f32 v40, v40
M v[224:227], a[152:155], v[128:131], v[224:227]
M v[228:231], a[152:155], v[132:135], v[228:231]
v_exp_f32 v41, v41
M v[228:231], a[148:151], v[100:103], v[228:231]
v_cvt_pk_bf16_f32 v40, v40, v41
M v[232:235], a[148:151], v[104:107], v[232:235]
v_exp_f32 v42, v42
M v[232:235], a[152:155], v[136:139], v[232:235]
M v[236:239], a[152:155], v[140:143], v[236:239]
v_exp_f32 v43, v43
M v[236:239], a[148:151], v[108:111], v[236:239]
v_cvt_pk_bf16_f32 v41, v42, v43
s_waitcnt lgkmcnt(4)
M v[240:243], a[156:159], v[96:99], v[240:243]
v_exp_f32 v56, v56
M v[240:243], a[160:163], v[128:131], v[240:243]
M v[244:247], a[160:163], v[132:135], v[244:247]
v_exp_f32 v57, v57
M v[244:247], a[156:159], v[100:103], v[244:247]
v_cvt_pk_bf16_f32 v42, v56, v57
M v[248:251], a[156:159], v[104:107], v[248:251]
v_exp_f32 v58, v58
M v[248:251], a[160:163], v[136:139], v[248:251]
s_waitcnt vmcnt(0) lgkmcnt(0)
s_barrier
ds_read_b128 a[116:119], v2 offset:0
ds_read_b128 a[120:123], v2 offset:1024
M v[252:255], a[160:163], v[140:143], v[252:255]
v_exp_f32 v59, v59
M v[252:255], a[156:159], v[108:111], v[252:255]
v_cvt_pk_bf16_f32 v43, v58, v59
M a[64:67], a[164:167], v[96:99], a[64:67]
v_exp_f32 v44, v44
M a[64:67], a[168:171], v[128:131], a[64:67]
ds_read_b128 a[124:127], v2 offset:2048
ds_read_b128 a[128:131], v2 offset:3072
M a[68:71], a[168:171], v[132:135], a[68:71]
v_exp_f32 v45, v45
M a[68:71], a[164:167], v[100:103], a[68:71]
v_cvt_pk_bf16_f32 v44, v44, v45
M a[72:75], a[164:167], v[104:107], a[72:75]
v_exp_f32 v46, v46
M a[72:75], a[168:171], v[136:139], a[72:75]
ds_read_b128 a[132:135], v2 offset:4096
ds_read_b128 a[136:139], v2 offset:5120
M a[76:79], a[168:171], v[140:143], a[76:79]
v_exp_f32 v47, v47
M a[76:79], a[164:167], v[108:111], a[76:79]
v_cvt_pk_bf16_f32 v45, v46, v47
M a[80:83], a[172:175], v[96:99], a[80:83]
v_exp_f32 v60, v60
M a[80:83], a[176:179], v[128:131], a[80:83]
ds_read_b128 a[140:143], v2 offset:6144
ds_read_b128 a[144:147], v2 offset:7168
M a[84:87], a[176:179], v[132:135], a[84:87]
v_exp_f32 v61, v61
M a[84:87], a[172:175], v[100:103], a[84:87]
v_cvt_pk_bf16_f32 v46, v60, v61
M a[88:91], a[172:175], v[104:107], a[88:91]
v_exp_f32 v62, v62
M a[88:91], a[176:179], v[136:139], a[88:91]
M a[92:95], a[176:179], v[140:143], a[92:95]
v_exp_f32 v63, v63
M a[92:95], a[172:175], v[108:111], a[92:95]
v_cvt_pk_bf16_f32 v47, v62, v63
v_accvgpr_read_b32 v20, a96
v_accvgpr_read_b32 v21, a100
v_accvgpr_read_b32 v22, a104
v_accvgpr_read_b32 v23, a108
v_rcp_f32 v8, v20
v_rcp_f32 v9, v21
v_rcp_f32 v10, v22
v_rcp_f32 v11, v23
v_subrev_u32 v20, 0x21800000, v20
v_subrev_u32 v21, 0x21800000, v21
v_subrev_u32 v22, 0x21800000, v22
v_subrev_u32 v23, 0x21800000, v23
v_max_u32 v12, v20, v21
v_max3_u32 v12, v12, v22, v23
s_mov_b32 s64, 0x207
v_pk_mul_f32 v[160:161], v[160:161], v[8:9] op_sel:[0,0] op_sel_hi:[1,0]
v_pk_mul_f32 v[162:163], v[162:163], v[8:9] op_sel:[0,0] op_sel_hi:[1,0]
v_pk_mul_f32 v[176:177], v[176:177], v[8:9] op_sel:[0,0] op_sel_hi:[1,0]
v_pk_mul_f32 v[178:179], v[178:179], v[8:9] op_sel:[0,0] op_sel_hi:[1,0]
v_cvt_pk_bf16_f32 v160, v160, v161
v_cvt_pk_bf16_f32 v161, v162, v163
v_cvt_pk_bf16_f32 v162, v176, v177
v_cvt_pk_bf16_f32 v163, v178, v179
s_nop 1
M v[24:27], a[112:115], v[160:163], 0
v_pk_mul_f32 v[164:165], v[164:165], v[8:9] op_sel:[0,1] op_sel_hi:[1,1]
v_pk_mul_f32 v[166:167], v[166:167], v[8:9] op_sel:[0,1] op_sel_hi:[1,1]
v_pk_mul_f32 v[180:181], v[180:181], v[8:9] op_sel:[0,1] op_sel_hi:[1,1]
v_pk_mul_f32 v[182:183], v[182:183], v[8:9] op_sel:[0,1] op_sel_hi:[1,1]
v_cvt_pk_bf16_f32 v164, v164, v165
v_cvt_pk_bf16_f32 v165, v166, v167
v_cvt_pk_bf16_f32 v166, v180, v181
v_cvt_pk_bf16_f32 v167, v182, v183
s_nop 1
M v[24:27], a[112:115], v[164:167], v[24:27]
v_pk_mul_f32 v[168:169], v[168:169], v[10:11] op_sel:[0,0] op_sel_hi:[1,0]
v_pk_mul_f32 v[170:171], v[170:171], v[10:11] op_sel:[0,0] op_sel_hi:[1,0]
v_pk_mul_f32 v[184:185], v[184:185], v[10:11] op_sel:[0,0] op_sel_hi:[1,0]
v_pk_mul_f32 v[186:187], v[186:187], v[10:11] op_sel:[0,0] op_sel_hi:[1,0]
v_cvt_pk_bf16_f32 v168, v168, v169
v_cvt_pk_bf16_f32 v169, v170, v171
v_cvt_pk_bf16_f32 v170, v184, v185
v_cvt_pk_bf16_f32 v171, v186, v187
s_nop 1
M v[24:27], a[112:115], v[168:171], v[24:27]
v_pk_mul_f32 v[172:173], v[172:173], v[10:11] op_sel:[0,1] op_sel_hi:[1,1]
v_pk_mul_f32 v[174:175], v[174:175], v[10:11] op_sel:[0,1] op_sel_hi:[1,1]
v_pk_mul_f32 v[188:189], v[188:189], v[10:11] op_sel:[0,1] op_sel_hi:[1,1]
v_pk_mul_f32 v[190:191], v[190:191], v[10:11] op_sel:[0,1] op_sel_hi:[1,1]
v_cvt_pk_bf16_f32 v172, v172, v173
v_cvt_pk_bf16_f32 v173, v174, v175
v_cvt_pk_bf16_f32 v174, v188, v189
v_cvt_pk_bf16_f32 v175, v190, v191
s_nop 1
M v[24:27], a[112:115], v[172:175], v[24:27]
v_pk_mul_f32 v[192:193], v[192:193], v[8:9] op_sel:[0,0] op_sel_hi:[1,0]
v_pk_mul_f32 v[194:195], v[194:195], v[8:9] op_sel:[0,0] op_sel_hi:[1,0]
v_pk_mul_f32 v[208:209], v[208:209], v[8:9] op_sel:[0,0] op_sel_hi:[1,0]
v_pk_mul_f32 v[210:211], v[210:211], v[8:9] op_sel:[0,0] op_sel_hi:[1,0]
v_cvt_pk_bf16_f32 v192, v192, v193
v_cvt_pk_bf16_f32 v193, v194, v195
v_cvt_pk_bf16_f32 v194, v208, v209
v_cvt_pk_bf16_f32 v195, v210, v211
s_nop 1
M v[24:27], a[112:115], v[192:195], v[24:27]
v_pk_mul_f32 v[196:197], v[196:197], v[8:9] op_sel:[0,1] op_sel_hi:[1,1]
v_pk_mul_f32 v[198:199], v[198:199], v[8:9] op_sel:[0,1] op_sel_hi:[1,1]
v_pk_mul_f32 v[212:213], v[212:213], v[8:9] op_sel:[0,1] op_sel_hi:[1,1]
v_pk_mul_f32 v[214:215], v[214:215], v[8:9] op_sel:[0,1] op_sel_hi:[1,1]
v_cvt_pk_bf16_f32 v196, v196, v197
v_cvt_pk_bf16_f32 v197, v198, v199
v_cvt_pk_bf16_f32 v198, v212, v213
v_cvt_pk_bf16_f32 v199, v214, v215
s_nop 1
M v[24:27], a[112:115], v[196:199], v[24:27]
v_pk_mul_f32 v[200:201], v[200:201], v[10:11] op_sel:[0,0] op_sel_hi:[1,0]
v_pk_mul_f32 v[202:203], v[202:203], v[10:11] op_sel:[0,0] op_sel_hi:[1,0]
v_pk_mul_f32 v[216:217], v[216:217], v[10:11] op_sel:[0,0] op_sel_hi:[1,0]
v_pk_mul_f32 v[218:219], v[218:219], v[10:11] op_sel:[0,0] op_sel_hi:[1,0]
v_cvt_pk_bf16_f32 v200, v200, v201
v_cvt_pk_bf16_f32 v201, v202, v203
v_cvt_pk_bf16_f32 v202, v216, v217
v_cvt_pk_bf16_f32 v203, v218, v219
s_nop 1
M v[24:27], a[112:115], v[200:203], v[24:27]
v_pk_mul_f32 v[204:205], v[204:205], v[10:11] op_sel:[0,1] op_sel_hi:[1,1]
v_pk_mul_f32 v[206:207], v[206:207], v[10:11] op_sel:[0,1] op_sel_hi:[1,1]
v_pk_mul_f32 v[220:221], v[220:221], v[10:11] op_sel:[0,1] op_sel_hi:[1,1]
v_pk_mul_f32 v[222:223], v[222:223], v[10:11] op_sel:[0,1] op_sel_hi:[1,1]
v_cvt_pk_bf16_f32 v204, v204, v205
v_cvt_pk_bf16_f32 v205, v206, v207
v_cvt_pk_bf16_f32 v206, v220, v221
v_cvt_pk_bf16_f32 v207, v222, v223
s_nop 1
M v[24:27], a[112:115], v[204:207], v[24:27]
v_pk_mul_f32 v[224:225], v[224:225], v[8:9] op_sel:[0,0] op_sel_hi:[1,0]
v_pk_mul_f32 v[226:227], v[226:227], v[8:9] op_sel:[0,0] op_sel_hi:[1,0]
v_pk_mul_f32 v[240:241], v[240:241], v[8:9] op_sel:[0,0] op_sel_hi:[1,0]
v_pk_mul_f32 v[242:243], v[242:243], v[8:9] op_sel:[0,0] op_sel_hi:[1,0]
v_cvt_pk_bf16_f32 v224, v224, v225
v_cvt_pk_bf16_f32 v225, v226, v227
v_cvt_pk_bf16_f32 v226, v240, v241
v_cvt_pk_bf16_f32 v227, v242, v243
s_nop 1
M v[24:27], a[112:115], v[224:227], v[24:27]
v_pk_mul_f32 v[228:229], v[228:229], v[8:9] op_sel:[0,1] op_sel_hi:[1,1]
v_pk_mul_f32 v[230:231], v[230:231], v[8:9] op_sel:[0,1] op_sel_hi:[1,1]
v_pk_mul_f32 v[244:245], v[244:245], v[8:9] op_sel:[0,1] op_sel_hi:[1,1]
v_pk_mul_f32 v[246:247], v[246:247], v[8:9] op_sel:[0,1] op_sel_hi:[1,1]
v_cvt_pk_bf16_f32 v228, v228, v229
v_cvt_pk_bf16_f32 v229, v230, v231
v_cvt_pk_bf16_f32 v230, v244, v245
v_cvt_pk_bf16_f32 v231, v246, v247
s_nop 1
M v[24:27], a[112:115], v[228:231], v[24:27]
v_pk_mul_f32 v[232:233], v[232:233], v[10:11] op_sel:[0,0] op_sel_hi:[1,0]
v_pk_mul_f32 v[234:235], v[234:235], v[10:11] op_sel:[0,0] op_sel_hi:[1,0]
v_pk_mul_f32 v[248:249], v[248:249], v[10:11] op_sel:[0,0] op_sel_hi:[1,0]
v_pk_mul_f32 v[250:251], v[250:251], v[10:11] op_sel:[0,0] op_sel_hi:[1,0]
v_cvt_pk_bf16_f32 v232, v232, v233
v_cvt_pk_bf16_f32 v233, v234, v235
v_cvt_pk_bf16_f32 v234, v248, v249
v_cvt_pk_bf16_f32 v235, v250, v251
s_nop 1
M v[24:27], a[112:115], v[232:235], v[24:27]
v_pk_mul_f32 v[236:237], v[236:237], v[10:11] op_sel:[0,1] op_sel_hi:[1,1]
v_pk_mul_f32 v[238:239], v[238:239], v[10:11] op_sel:[0,1] op_sel_hi:[1,1]
v_pk_mul_f32 v[252:253], v[252:253], v[10:11] op_sel:[0,1] op_sel_hi:[1,1]
v_pk_mul_f32 v[254:255], v[254:255], v[10:11] op_sel:[0,1] op_sel_hi:[1,1]
v_cvt_pk_bf16_f32 v236, v236, v237
v_cvt_pk_bf16_f32 v237, v238, v239
v_cvt_pk_bf16_f32 v238, v252, v253
v_cvt_pk_bf16_f32 v239, v254, v255
v_accvgpr_read_b32 v176, a64
v_accvgpr_read_b32 v177, a65
v_accvgpr_read_b32 v178, a66
v_accvgpr_read_b32 v179, a67
v_accvgpr_read_b32 v180, a80
v_accvgpr_read_b32 v181, a81
v_accvgpr_read_b32 v182, a82
v_accvgpr_read_b32 v183, a83
M v[24:27], a[112:115], v[236:239], v[24:27]
v_pk_mul_f32 v[176:177], v[176:177], v[8:9] op_sel:[0,0] op_sel_hi:[1,0]
v_pk_mul_f32 v[178:179], v[178:179], v[8:9] op_sel:[0,0] op_sel_hi:[1,0]
v_pk_mul_f32 v[180:181], v[180:181], v[8:9] op_sel:[0,0] op_sel_hi:[1,0]
v_pk_mul_f32 v[182:183], v[182:183], v[8:9] op_sel:[0,0] op_sel_hi:[1,0]
v_cvt_pk_bf16_f32 v176, v176, v177
v_cvt_pk_bf16_f32 v177, v178, v179
v_cvt_pk_bf16_f32 v178, v180, v181
v_cvt_pk_bf16_f32 v179, v182, v183
v_accvgpr_read_b32 v184, a68
v_accvgpr_read_b32 v185, a69
v_accvgpr_read_b32 v186, a70
v_accvgpr_read_b32 v187, a71
v_accvgpr_read_b32 v188, a84
v_accvgpr_read_b32 v189, a85
v_accvgpr_read_b32 v190, a86
v_accvgpr_read_b32 v191, a87
M v[24:27], a[112:115], v[176:179], v[24:27]
v_pk_mul_f32 v[184:185], v[184:185], v[8:9] op_sel:[0,1] op_sel_hi:[1,1]
v_pk_mul_f32 v[186:187], v[186:187], v[8:9] op_sel:[0,1] op_sel_hi:[1,1]
v_pk_mul_f32 v[188:189], v[188:189], v[8:9] op_sel:[0,1] op_sel_hi:[1,1]
v_pk_mul_f32 v[190:191], v[190:191], v[8:9] op_sel:[0,1] op_sel_hi:[1,1]
v_cvt_pk_bf16_f32 v184, v184, v185
v_cvt_pk_bf16_f32 v185, v186, v187
v_cvt_pk_bf16_f32 v186, v188, v189
v_cvt_pk_bf16_f32 v187, v190, v191
v_accvgpr_read_b32 v208, a72
v_accvgpr_read_b32 v209, a73
v_accvgpr_read_b32 v210, a74
v_accvgpr_read_b32 v211, a75
v_accvgpr_read_b32 v212, a88
v_accvgpr_read_b32 v213, a89
v_accvgpr_read_b32 v214, a90
v_accvgpr_read_b32 v215, a91
M v[24:27], a[112:115], v[184:187], v[24:27]
v_pk_mul_f32 v[208:209], v[208:209], v[10:11] op_sel:[0,0] op_sel_hi:[1,0]
v_pk_mul_f32 v[210:211], v[210:211], v[10:11] op_sel:[0,0] op_sel_hi:[1,0]
v_pk_mul_f32 v[212:213], v[212:213], v[10:11] op_sel:[0,0] op_sel_hi:[1,0]
v_pk_mul_f32 v[214:215], v[214:215], v[10:11] op_sel:[0,0] op_sel_hi:[1,0]
v_cvt_pk_bf16_f32 v208, v208, v209
v_cvt_pk_bf16_f32 v209, v210, v211
v_cvt_pk_bf16_f32 v210, v212, v213
v_cvt_pk_bf16_f32 v211, v214, v215
v_accvgpr_read_b32 v216, a76
v_accvgpr_read_b32 v217, a77
v_accvgpr_read_b32 v218, a78
v_accvgpr_read_b32 v219, a79
v_accvgpr_read_b32 v220, a92
v_accvgpr_read_b32 v221, a93
v_accvgpr_read_b32 v222, a94
v_accvgpr_read_b32 v223, a95
M v[24:27], a[112:115], v[208:211], v[24:27]
v_pk_mul_f32 v[216:217], v[216:217], v[10:11] op_sel:[0,1] op_sel_hi:[1,1]
v_pk_mul_f32 v[218:219], v[218:219], v[10:11] op_sel:[0,1] op_sel_hi:[1,1]
v_pk_mul_f32 v[220:221], v[220:221], v[10:11] op_sel:[0,1] op_sel_hi:[1,1]
v_pk_mul_f32 v[222:223], v[222:223], v[10:11] op_sel:[0,1] op_sel_hi:[1,1]
v_cvt_pk_bf16_f32 v216, v216, v217
v_cvt_pk_bf16_f32 v217, v218, v219
v_cvt_pk_bf16_f32 v218, v220, v221
v_cvt_pk_bf16_f32 v219, v222, v223
s_nop 1
M v[24:27], a[112:115], v[216:219], v[24:27]
v_cmp_lt_u32 vcc, 0x3c000000, v12
s_nop 6
v_cmp_class_f32 s[40:41], v24, s64
s_nop 0
s_or_b64 vcc, vcc, s[40:41]
s_cbranch_vccnz Lbad_2
s_lshl_b32 s33, s21, 20
s_lshl_b32 s34, s20, 15
s_add_u32 s33, s33, s34
s_lshl_b32 s34, s23, 13
s_add_u32 s36, s33, s34
s_add_u32 s37, s36, 4096
s_add_u32 s38, s36, 16384
s_add_u32 s39, s36, 20480
buffer_store_dwordx4 v[160:163], v1, s[16:19], s36 offen offset:0 sc1
buffer_store_dwordx4 v[164:167], v1, s[16:19], s36 offen offset:2048 sc1
buffer_store_dwordx4 v[168:171], v1, s[16:19], s37 offen offset:0 sc1
buffer_store_dwordx4 v[172:175], v1, s[16:19], s37 offen offset:2048 sc1
buffer_store_dwordx4 v[192:195], v1, s[16:19], s36 offen offset:1024 sc1
buffer_store_dwordx4 v[196:199], v1, s[16:19], s36 offen offset:3072 sc1
buffer_store_dwordx4 v[200:203], v1, s[16:19], s37 offen offset:1024 sc1
buffer_store_dwordx4 v[204:207], v1, s[16:19], s37 offen offset:3072 sc1
buffer_store_dwordx4 v[224:227], v1, s[16:19], s38 offen offset:0 sc1
buffer_store_dwordx4 v[228:231], v1, s[16:19], s38 offen offset:2048 sc1
buffer_store_dwordx4 v[232:235], v1, s[16:19], s39 offen offset:0 sc1
buffer_store_dwordx4 v[236:239], v1, s[16:19], s39 offen offset:2048 sc1
buffer_store_dwordx4 v[176:179], v1, s[16:19], s38 offen offset:1024 sc1
buffer_store_dwordx4 v[184:187], v1, s[16:19], s38 offen offset:3072 sc1
buffer_store_dwordx4 v[208:211], v1, s[16:19], s39 offen offset:1024 sc1
buffer_store_dwordx4 v[216:219], v1, s[16:19], s39 offen offset:3072 sc1
s_branch Lfd_3
Lbad_2:
s_or_b32 s60, s60, 1
Lfd_3:
s_sub_u32 s30, 7, s21
s_cmp_lg_u32 s30, 0
s_cbranch_scc1 Lk2_b0
s_and_b32 s3, s2, 3
s_lshl_b32 s3, s3, 2
s_bfe_u32 s27, s2, 0x20003
s_add_u32 s27, s3, s27
s_lshl_b32 s43, s27, 8
s_add_u32 s43, s43, 8400896
v_lshlrev_b32 v15, 2, v0
buffer_load_dword v7, v15, s[52:55], s43 offen sc1
s_waitcnt lgkmcnt(7)
ds_read_b128 a[116:119], v2 offset:32768
s_waitcnt lgkmcnt(7)
ds_read_b128 a[120:123], v2 offset:40960
s_waitcnt lgkmcnt(7)
ds_read_b128 a[124:127], v2 offset:33792
s_waitcnt lgkmcnt(7)
ds_read_b128 a[128:131], v2 offset:41984
s_waitcnt lgkmcnt(7)
ds_read_b128 a[132:135], v2 offset:34816
s_waitcnt lgkmcnt(7)
ds_read_b128 a[136:139], v2 offset:43008
s_waitcnt lgkmcnt(7)
ds_read_b128 a[140:143], v2 offset:35840
s_waitcnt lgkmcnt(7)
ds_read_b128 a[144:147], v2 offset:44032
v_exp_f32 v64, v64
v_exp_f32 v65, v65
v_exp_f32 v66, v66
v_exp_f32 v67, v67
v_exp_f32 v80, v80
v_exp_f32 v81, v81
v_exp_f32 v82, v82
v_exp_f32 v83, v83
v_cvt_pk_bf16_f32 v64, v64, v65
v_cvt_pk_bf16_f32 v65, v66, v67
v_exp_f32 v68, v68
v_exp_f32 v69, v69
v_exp_f32 v70, v70
v_exp_f32 v71, v71
v_cvt_pk_bf16_f32 v66, v80, v81
v_cvt_pk_bf16_f32 v67, v82, v83
v_exp_f32 v84, v84
v_exp_f32 v85, v85
v_exp_f32 v86, v86
v_exp_f32 v87, v87
v_cvt_pk_bf16_f32 v68, v68, v69
v_cvt_pk_bf16_f32 v69, v70, v71
v_exp_f32 v72, v72
v_exp_f32 v73, v73
v_exp_f32 v74, v74
v_exp_f32 v75, v75
v_cvt_pk_bf16_f32 v70, v84, v85
v_cvt_pk_bf16_f32 v71, v86, v87
v_exp_f32 v88, v88
v_exp_f32 v89, v89
v_exp_f32 v90, v90
v_exp_f32 v91, v91
v_cvt_pk_bf16_f32 v72, v72, v73
v_cvt_pk_bf16_f32 v73, v74, v75
v_exp_f32 v76, v76
v_exp_f32 v77, v77
v_exp_f32 v78, v78
v_exp_f32 v79, v79
v_cvt_pk_bf16_f32 v74, v88, v89
v_cvt_pk_bf16_f32 v75, v90, v91
v_exp_f32 v92, v92
v_exp_f32 v93, v93
v_exp_f32 v94, v94
v_exp_f32 v95, v95
v_cvt_pk_bf16_f32 v76, v76, v77
v_cvt_pk_bf16_f32 v77, v78, v79
v_cvt_pk_bf16_f32 v78, v92, v93
v_cvt_pk_bf16_f32 v79, v94, v95
s_waitcnt lgkmcnt(6)
M v[160:163], a[116:119], v[32:35], 0
M v[160:163], a[120:123], v[64:67], v[160:163]
ds_read_b128 a[148:151], v2 offset:36864
ds_read_b128 a[152:155], v2 offset:45056
s_mov_b32 s61, 0
M v[164:167], a[120:123], v[68:71], 0
M v[164:167], a[116:119], v[36:39], v[164:167]
s_bfe_u32 s3, s2, 0x10002
M v[168:171], a[116:119], v[40:43], 0
M v[168:171], a[120:123], v[72:75], v[168:171]
s_lshl_b32 s3, s3, 3
M v[172:175], a[120:123], v[76:79], 0
M v[172:175], a[116:119], v[44:47], v[172:175]
s_waitcnt lgkmcnt(6)
s_lshr_b32 s28, s2, 5
M a[96:99], a[112:115], v[32:35], 0
M a[96:99], a[112:115], v[64:67], a[96:99]
M v[176:179], a[124:127], v[32:35], 0
M v[176:179], a[128:131], v[64:67], v[176:179]
ds_read_b128 a[156:159], v2 offset:37888
ds_read_b128 a[160:163], v2 offset:46080
s_add_u32 s28, s3, s28
M v[180:183], a[128:131], v[68:71], 0
s_lshl_b32 s25, s27, 18
M v[180:183], a[124:127], v[36:39], v[180:183]
M v[184:187], a[124:127], v[40:43], 0
s_lshl_b32 s3, s101, 12
M v[184:187], a[128:131], v[72:75], v[184:187]
M v[188:191], a[128:131], v[76:79], 0
s_add_u32 s25, s25, s3
M v[188:191], a[124:127], v[44:47], v[188:191]
s_waitcnt lgkmcnt(6)
M a[100:103], a[112:115], v[36:39], 0
M a[100:103], a[112:115], v[68:71], a[100:103]
M v[192:195], a[132:135], v[32:35], 0
s_lshl_b32 s26, s28, 7
M v[192:195], a[136:139], v[64:67], v[192:195]
ds_read_b128 a[164:167], v2 offset:38912
ds_read_b128 a[168:171], v2 offset:47104
M v[196:199], a[136:139], v[68:71], 0
s_lshl_b32 s42, s101, 11
M v[196:199], a[132:135], v[36:39], v[196:199]
M v[200:203], a[132:135], v[40:43], 0
s_add_u32 s44, s4, 83886080
s_addc_u32 s45, s5, 0
M v[200:203], a[136:139], v[72:75], v[200:203]
s_mov_b32 s46, 4194304
M v[204:207], a[136:139], v[76:79], 0
M v[204:207], a[132:135], v[44:47], v[204:207]
s_waitcnt lgkmcnt(6)
s_mov_b32 s47, 0x00020000
M a[104:107], a[112:115], v[40:43], 0
M a[104:107], a[112:115], v[72:75], a[104:107]
M v[208:211], a[140:143], v[32:35], 0
M v[208:211], a[144:147], v[64:67], v[208:211]
ds_read_b128 a[172:175], v2 offset:39936
ds_read_b128 a[176:179], v2 offset:48128
s_mov_b32 s50, 2097152
M v[212:215], a[144:147], v[68:71], 0
M v[212:215], a[140:143], v[36:39], v[212:215]
s_mov_b32 s51, 0x00020000
M v[216:219], a[140:143], v[40:43], 0
M v[216:219], a[144:147], v[72:75], v[216:219]
s_lshl_b32 s3, s101, 4
M v[220:223], a[144:147], v[76:79], 0
M v[220:223], a[140:143], v[44:47], v[220:223]
s_waitcnt lgkmcnt(6)
v_lshrrev_b32 v96, 3, v0
M a[108:111], a[112:115], v[44:47], 0
M a[108:111], a[112:115], v[76:79], a[108:111]
M v[224:227], a[148:151], v[32:35], 0
v_and_b32 v97, 6, v96
M v[224:227], a[152:155], v[64:67], v[224:227]
M v[228:231], a[152:155], v[68:71], 0
v_and_b32 v98, 7, v0
M v[228:231], a[148:151], v[36:39], v[228:231]
M v[232:235], a[148:151], v[40:43], 0
v_xor_b32 v97, v97, v98
M v[232:235], a[152:155], v[72:75], v[232:235]
M v[236:239], a[152:155], v[76:79], 0
v_add_u32 v96, s3, v96
M v[236:239], a[148:151], v[44:47], v[236:239]
s_waitcnt lgkmcnt(4)
M v[240:243], a[156:159], v[32:35], 0
v_lshlrev_b32 v96, 11, v96
M v[240:243], a[160:163], v[64:67], v[240:243]
M v[244:247], a[160:163], v[68:71], 0
v_lshl_add_u32 v99, v97, 4, v96
M v[244:247], a[156:159], v[36:39], v[244:247]
v_add_u32 v100, 15360, v99
M v[248:251], a[156:159], v[40:43], 0
M v[248:251], a[160:163], v[72:75], v[248:251]
s_waitcnt vmcnt(0) lgkmcnt(0)
s_barrier
v_cmp_ne_u32 vcc, 1, v7
s_nop 0
s_cbranch_vccnz Lk3_spinb1
Lk3_gotb1:
M v[252:255], a[160:163], v[76:79], 0
s_add_u32 m0, s42, 65536
s_nop 0
buffer_load_dwordx4 v99, s[48:51], s26 offen offset:0 lds
buffer_load_dwordx4 v100, s[48:51], s26 offen offset:1024 lds
M v[252:255], a[156:159], v[44:47], v[252:255]
buffer_load_dwordx4 a[192:195], v1, s[44:47], s25 offen offset:0 sc1
buffer_load_dwordx4 a[196:199], v1, s[44:47], s25 offen offset:1024 sc1
M a[64:67], a[164:167], v[32:35], 0
buffer_load_dwordx4 a[200:203], v1, s[44:47], s25 offen offset:2048 sc1
buffer_load_dwordx4 a[204:207], v1, s[44:47], s25 offen offset:3072 sc1
M a[64:67], a[168:171], v[64:67], a[64:67]
s_add_u32 s25, s25, 16384
s_add_u32 s26, s26, 131072
s_add_u32 m0, s42, 81920
s_nop 0
buffer_load_dwordx4 v99, s[48:51], s26 offen offset:0 lds
M a[68:71], a[168:171], v[68:71], 0
buffer_load_dwordx4 v100, s[48:51], s26 offen offset:1024 lds
buffer_load_dwordx4 a[208:211], v1, s[44:47], s25 offen offset:0 sc1
M a[68:71], a[164:167], v[36:39], a[68:71]
buffer_load_dwordx4 a[212:215], v1, s[44:47], s25 offen offset:1024 sc1
buffer_load_dwordx4 a[216:219], v1, s[44:47], s25 offen offset:2048 sc1
M a[72:75], a[164:167], v[40:43], 0
buffer_load_dwordx4 a[220:223], v1, s[44:47], s25 offen offset:3072 sc1
s_add_u32 s25, s25, 16384
s_add_u32 s26, s26, 131072
M a[72:75], a[168:171], v[72:75], a[72:75]
s_add_u32 m0, s42, 98304
s_nop 0
buffer_load_dwordx4 v99, s[48:51], s26 offen offset:0 lds
buffer_load_dwordx4 v100, s[48:51], s26 offen offset:1024 lds
M a[76:79], a[168:171], v[76:79], 0
buffer_load_dwordx4 a[224:227], v1, s[44:47], s25 offen offset:0 sc1
M a[76:79], a[164:167], v[44:47], a[76:79]
buffer_load_dwordx4 a[228:231], v1, s[44:47], s25 offen offset:1024 sc1
buffer_load_dwordx4 a[232:235], v1, s[44:47], s25 offen offset:2048 sc1
M a[80:83], a[172:175], v[32:35], 0
buffer_load_dwordx4 a[236:239], v1, s[44:47], s25 offen offset:3072 sc1
s_add_u32 s25, s25, 16384
s_add_u32 s26, s26, 131072
M a[80:83], a[176:179], v[64:67], a[80:83]
s_add_u32 m0, s42, 114688
s_nop 0
buffer_load_dwordx4 v99, s[48:51], s26 offen offset:0 lds
buffer_load_dwordx4 v100, s[48:51], s26 offen offset:1024 lds
M a[84:87], a[176:179], v[68:71], 0
buffer_load_dwordx4 a[240:243], v1, s[44:47], s25 offen offset:0 sc1
buffer_load_dwordx4 a[244:247], v1, s[44:47], s25 offen offset:1024 sc1
M a[84:87], a[172:175], v[36:39], a[84:87]
buffer_load_dwordx4 a[248:251], v1, s[44:47], s25 offen offset:2048 sc1
buffer_load_dwordx4 a[252:255], v1, s[44:47], s25 offen offset:3072 sc1
M a[88:91], a[172:175], v[40:43], 0
s_add_u32 s25, s25, 16384
s_add_u32 s26, s26, 131072
s_add_u32 m0, s42, 0
s_nop 0
buffer_load_dwordx4 v99, s[48:51], s26 offen offset:0 lds
M a[88:91], a[176:179], v[72:75], a[88:91]
buffer_load_dwordx4 v100, s[48:51], s26 offen offset:1024 lds
buffer_load_dwordx4 a[128:131], v1, s[44:47], s25 offen offset:0 sc1
M a[92:95], a[176:179], v[76:79], 0
buffer_load_dwordx4 a[132:135], v1, s[44:47], s25 offen offset:1024 sc1
buffer_load_dwordx4 a[136:139], v1, s[44:47], s25 offen offset:2048 sc1
M a[92:95], a[172:175], v[44:47], a[92:95]
buffer_load_dwordx4 a[140:143], v1, s[44:47], s25 offen offset:3072 sc1
s_add_u32 s25, s25, 16384
s_add_u32 s26, s26, 131072
s_branch Lk2_merge
Lk2_b0:
s_add_u32 m0, s29, 65536
s_waitcnt lgkmcnt(4)
M v[96:99], a[116:119], a[180:183], 0
v_exp_f32 v64, v64
M v[96:99], a[120:123], a[184:187], v[96:99]
ds_read_b128 a[148:151], v2 offset:8192
ds_read_b128 a[152:155], v2 offset:9216
M v[96:99], a[124:127], a[188:191], v[96:99]
v_exp_f32 v65, v65
M v[96:99], a[128:131], a[192:195], v[96:99]
buffer_load_dwordx4 v1, s[12:15], s25 offen offset:0 sc1 lds
s_add_u32 s32, s25, 4096
M v[100:103], a[128:131], a[208:211], 0
v_exp_f32 v66, v66
M v[100:103], a[124:127], a[204:207], v[100:103]
v_cvt_pk_bf16_f32 v64, v64, v65
M v[100:103], a[120:123], a[200:203], v[100:103]
v_exp_f32 v67, v67
M v[100:103], a[116:119], a[196:199], v[100:103]
buffer_load_dwordx4 v1, s[12:15], s25 offen offset:1024 sc1 lds
M v[104:107], a[116:119], a[212:215], 0
v_exp_f32 v80, v80
M v[104:107], a[120:123], a[216:219], v[104:107]
ds_read_b128 a[156:159], v2 offset:10240
ds_read_b128 a[160:163], v2 offset:11264
M v[104:107], a[124:127], a[220:223], v[104:107]
v_exp_f32 v81, v81
M v[104:107], a[128:131], a[224:227], v[104:107]
buffer_load_dwordx4 v1, s[12:15], s25 offen offset:2048 sc1 lds
M v[108:111], a[128:131], a[240:243], 0
v_exp_f32 v82, v82
M v[108:111], a[124:127], a[236:239], v[108:111]
v_cvt_pk_bf16_f32 v65, v66, v67
v_cvt_pk_bf16_f32 v66, v80, v81
M v[108:111], a[120:123], a[232:235], v[108:111]
v_exp_f32 v83, v83
M v[108:111], a[116:119], a[228:231], v[108:111]
buffer_load_dwordx4 v1, s[12:15], s25 offen offset:3072 sc1 lds
s_add_u32 m0, s29, 69632
s_waitcnt lgkmcnt(4)
M v[112:115], a[132:135], a[180:183], 0
v_exp_f32 v68, v68
M v[112:115], a[136:139], a[184:187], v[112:115]
ds_read_b128 a[164:167], v2 offset:12288
ds_read_b128 a[168:171], v2 offset:13312
M v[112:115], a[140:143], a[188:191], v[112:115]
v_exp_f32 v69, v69
M v[112:115], a[144:147], a[192:195], v[112:115]
buffer_load_dwordx4 v1, s[12:15], s32 offen offset:0 sc1 lds
M v[116:119], a[144:147], a[208:211], 0
v_exp_f32 v70, v70
M v[116:119], a[140:143], a[204:207], v[116:119]
v_cvt_pk_bf16_f32 v67, v82, v83
v_cvt_pk_bf16_f32 v68, v68, v69
M v[116:119], a[136:139], a[200:203], v[116:119]
v_exp_f32 v71, v71
M v[116:119], a[132:135], a[196:199], v[116:119]
buffer_load_dwordx4 v1, s[12:15], s32 offen offset:1024 sc1 lds
M v[120:123], a[132:135], a[212:215], 0
v_exp_f32 v84, v84
M v[120:123], a[136:139], a[216:219], v[120:123]
ds_read_b128 a[172:175], v2 offset:14336
ds_read_b128 a[176:179], v2 offset:15360
M v[120:123], a[140:143], a[220:223], v[120:123]
v_exp_f32 v85, v85
M v[120:123], a[144:147], a[224:227], v[120:123]
buffer_load_dwordx4 v1, s[12:15], s32 offen offset:2048 sc1 lds
M v[124:127], a[144:147], a[240:243], 0
v_exp_f32 v86, v86
M v[124:127], a[140:143], a[236:239], v[124:127]
v_cvt_pk_bf16_f32 v69, v70, v71
v_cvt_pk_bf16_f32 v70, v84, v85
M v[124:127], a[136:139], a[232:235], v[124:127]
v_exp_f32 v87, v87
M v[124:127], a[132:135], a[228:231], v[124:127]
buffer_load_dwordx4 v1, s[12:15], s32 offen offset:3072 sc1 lds
s_add_u32 m0, s29, 98304
s_waitcnt lgkmcnt(4)
M v[128:131], a[148:151], a[180:183], 0
v_exp_f32 v72, v72
M v[128:131], a[152:155], a[184:187], v[128:131]
ds_read_b128 a[116:119], v2 offset:32768
ds_read_b128 a[120:123], v2 offset:40960
M v[128:131], a[156:159], a[188:191], v[128:131]
v_exp_f32 v73, v73
M v[128:131], a[160:163], a[192:195], v[128:131]
buffer_load_dwordx4 v1, s[12:15], s26 offen offset:0 sc1 lds
s_add_u32 s43, s26, 4096
M v[132:135], a[160:163], a[208:211], 0
v_exp_f32 v74, v74
M v[132:135], a[156:159], a[204:207], v[132:135]
v_cvt_pk_bf16_f32 v71, v86, v87
v_cvt_pk_bf16_f32 v72, v72, v73
M v[132:135], a[152:155], a[200:203], v[132:135]
v_exp_f32 v75, v75
M v[132:135], a[148:151], a[196:199], v[132:135]
buffer_load_dwordx4 v1, s[12:15], s26 offen offset:1024 sc1 lds
M v[136:139], a[148:151], a[212:215], 0
v_exp_f32 v88, v88
M v[136:139], a[152:155], a[216:219], v[136:139]
ds_read_b128 a[124:127], v2 offset:33792
ds_read_b128 a[128:131], v2 offset:41984
M v[136:139], a[156:159], a[220:223], v[136:139]
v_exp_f32 v89, v89
M v[136:139], a[160:163], a[224:227], v[136:139]
buffer_load_dwordx4 v1, s[12:15], s26 offen offset:2048 sc1 lds
M v[140:143], a[160:163], a[240:243], 0
v_exp_f32 v90, v90
M v[140:143], a[156:159], a[236:239], v[140:143]
v_cvt_pk_bf16_f32 v73, v74, v75
v_cvt_pk_bf16_f32 v74, v88, v89
M v[140:143], a[152:155], a[232:235], v[140:143]
v_exp_f32 v91, v91
M v[140:143], a[148:151], a[228:231], v[140:143]
buffer_load_dwordx4 v1, s[12:15], s26 offen offset:3072 sc1 lds
s_add_u32 m0, s29, 102400
s_waitcnt lgkmcnt(4)
M v[144:147], a[164:167], a[180:183], 0
v_exp_f32 v76, v76
M v[144:147], a[168:171], a[184:187], v[144:147]
ds_read_b128 a[132:135], v2 offset:34816
ds_read_b128 a[136:139], v2 offset:43008
M v[144:147], a[172:175], a[188:191], v[144:147]
v_exp_f32 v77, v77
M v[144:147], a[176:179], a[192:195], v[144:147]
buffer_load_dwordx4 v1, s[12:15], s43 offen offset:0 sc1 lds
M v[148:151], a[176:179], a[208:211], 0
v_exp_f32 v78, v78
M v[148:151], a[172:175], a[204:207], v[148:151]
v_cvt_pk_bf16_f32 v75, v90, v91
v_cvt_pk_bf16_f32 v76, v76, v77
M v[148:151], a[168:171], a[200:203], v[148:151]
v_exp_f32 v79, v79
M v[148:151], a[164:167], a[196:199], v[148:151]
buffer_load_dwordx4 v1, s[12:15], s43 offen offset:1024 sc1 lds
M v[152:155], a[164:167], a[212:215], 0
v_exp_f32 v92, v92
M v[152:155], a[168:171], a[216:219], v[152:155]
ds_read_b128 a[140:143], v2 offset:35840
ds_read_b128 a[144:147], v2 offset:44032
M v[152:155], a[172:175], a[220:223], v[152:155]
v_exp_f32 v93, v93
M v[152:155], a[176:179], a[224:227], v[152:155]
buffer_load_dwordx4 v1, s[12:15], s43 offen offset:2048 sc1 lds
M v[156:159], a[176:179], a[240:243], 0
v_exp_f32 v94, v94
M v[156:159], a[172:175], a[236:239], v[156:159]
v_cvt_pk_bf16_f32 v77, v78, v79
v_cvt_pk_bf16_f32 v78, v92, v93
M v[156:159], a[168:171], a[232:235], v[156:159]
v_exp_f32 v95, v95
M v[156:159], a[164:167], a[228:231], v[156:159]
buffer_load_dwordx4 v1, s[12:15], s43 offen offset:3072 sc1 lds
v_cvt_pk_bf16_f32 v79, v94, v95
s_waitcnt lgkmcnt(6)
M v[160:163], a[116:119], v[32:35], 0
v_exp_f32 v96, v96
M v[160:163], a[120:123], v[64:67], v[160:163]
ds_read_b128 a[148:151], v2 offset:36864
ds_read_b128 a[152:155], v2 offset:45056
M v[164:167], a[120:123], v[68:71], 0
v_exp_f32 v97, v97
M v[164:167], a[116:119], v[36:39], v[164:167]
v_cvt_pk_bf16_f32 v96, v96, v97
M v[168:171], a[116:119], v[40:43], 0
v_exp_f32 v98, v98
M v[168:171], a[120:123], v[72:75], v[168:171]
s_add_u32 s25, s25, 32768
s_cmp_eq_u32 s25, s27
M v[172:175], a[120:123], v[76:79], 0
v_exp_f32 v99, v99
M v[172:175], a[116:119], v[44:47], v[172:175]
v_cvt_pk_bf16_f32 v97, v98, v99
s_waitcnt lgkmcnt(6)
M a[96:99], a[112:115], v[32:35], 0
s_cselect_b32 s25, s28, s25
s_cselect_b32 s27, -1, s27
M a[96:99], a[112:115], v[64:67], a[96:99]
s_add_u32 s26, s26, 32768
s_cmp_eq_u32 s26, s62
M v[176:179], a[124:127], v[32:35], 0
v_exp_f32 v112, v112
M v[176:179], a[128:131], v[64:67], v[176:179]
ds_read_b128 a[156:159], v2 offset:37888
ds_read_b128 a[160:163], v2 offset:46080
M v[180:183], a[128:131], v[68:71], 0
v_exp_f32 v113, v113
M v[180:183], a[124:127], v[36:39], v[180:183]
v_cvt_pk_bf16_f32 v98, v112, v113
M v[184:187], a[124:127], v[40:43], 0
v_exp_f32 v114, v114
M v[184:187], a[128:131], v[72:75], v[184:187]
s_cselect_b32 s26, s63, s26
s_cselect_b32 s62, -1, s62
M v[188:191], a[128:131], v[76:79], 0
v_exp_f32 v115, v115
M v[188:191], a[124:127], v[44:47], v[188:191]
v_cvt_pk_bf16_f32 v99, v114, v115
s_waitcnt lgkmcnt(6)
M a[100:103], a[112:115], v[36:39], 0
M a[100:103], a[112:115], v[68:71], a[100:103]
M v[192:195], a[132:135], v[32:35], 0
v_exp_f32 v100, v100
M v[192:195], a[136:139], v[64:67], v[192:195]
ds_read_b128 a[164:167], v2 offset:38912
ds_read_b128 a[168:171], v2 offset:47104
M v[196:199], a[136:139], v[68:71], 0
v_exp_f32 v101, v101
M v[196:199], a[132:135], v[36:39], v[196:199]
v_cvt_pk_bf16_f32 v100, v100, v101
M v[200:203], a[132:135], v[40:43], 0
v_exp_f32 v102, v102
M v[200:203], a[136:139], v[72:75], v[200:203]
M v[204:207], a[136:139], v[76:79], 0
v_exp_f32 v103, v103
M v[204:207], a[132:135], v[44:47], v[204:207]
v_cvt_pk_bf16_f32 v101, v102, v103
s_waitcnt lgkmcnt(6)
M a[104:107], a[112:115], v[40:43], 0
M a[104:107], a[112:115], v[72:75], a[104:107]
M v[208:211], a[140:143], v[32:35], 0
v_exp_f32 v116, v116
M v[208:211], a[144:147], v[64:67], v[208:211]
ds_read_b128 a[172:175], v2 offset:39936
ds_read_b128 a[176:179], v2 offset:48128
M v[212:215], a[144:147], v[68:71], 0
v_exp_f32 v117, v117
M v[212:215], a[140:143], v[36:39], v[212:215]
v_cvt_pk_bf16_f32 v102, v116, v117
M v[216:219], a[140:143], v[40:43], 0
v_exp_f32 v118, v118
M v[216:219], a[144:147], v[72:75], v[216:219]
M v[220:223], a[144:147], v[76:79], 0
v_exp_f32 v119, v119
M v[220:223], a[140:143], v[44:47], v[220:223]
v_cvt_pk_bf16_f32 v103, v118, v119
s_waitcnt lgkmcnt(6)
M a[108:111], a[112:115], v[44:47], 0
M a[108:111], a[112:115], v[76:79], a[108:111]
M v[224:227], a[148:151], v[32:35], 0
v_exp_f32 v104, v104
M v[224:227], a[152:155], v[64:67], v[224:227]
M v[228:231], a[152:155], v[68:71], 0
v_exp_f32 v105, v105
M v[228:231], a[148:151], v[36:39], v[228:231]
v_cvt_pk_bf16_f32 v104, v104, v105
M v[232:235], a[148:151], v[40:43], 0
v_exp_f32 v106, v106
M v[232:235], a[152:155], v[72:75], v[232:235]
M v[236:239], a[152:155], v[76:79], 0
v_exp_f32 v107, v107
M v[236:239], a[148:151], v[44:47], v[236:239]
v_cvt_pk_bf16_f32 v105, v106, v107
s_waitcnt lgkmcnt(4)
M v[240:243], a[156:159], v[32:35], 0
v_exp_f32 v120, v120
M v[240:243], a[160:163], v[64:67], v[240:243]
M v[244:247], a[160:163], v[68:71], 0
v_exp_f32 v121, v121
M v[244:247], a[156:159], v[36:39], v[244:247]
v_cvt_pk_bf16_f32 v106, v120, v121
M v[248:251], a[156:159], v[40:43], 0
v_exp_f32 v122, v122
M v[248:251], a[160:163], v[72:75], v[248:251]
s_waitcnt vmcnt(0) lgkmcnt(0)
s_barrier
ds_read_b128 a[116:119], v3 offset:0
ds_read_b128 a[120:123], v3 offset:1024
M v[252:255], a[160:163], v[76:79], 0
v_exp_f32 v123, v123
M v[252:255], a[156:159], v[44:47], v[252:255]
v_cvt_pk_bf16_f32 v107, v122, v123
M a[64:67], a[164:167], v[32:35], 0
v_exp_f32 v108, v108
M a[64:67], a[168:171], v[64:67], a[64:67]
ds_read_b128 a[124:127], v3 offset:2048
ds_read_b128 a[128:131], v3 offset:3072
M a[68:71], a[168:171], v[68:71], 0
v_exp_f32 v109, v109
M a[68:71], a[164:167], v[36:39], a[68:71]
v_cvt_pk_bf16_f32 v108, v108, v109
M a[72:75], a[164:167], v[40:43], 0
v_exp_f32 v110, v110
M a[72:75], a[168:171], v[72:75], a[72:75]
ds_read_b128 a[132:135], v3 offset:4096
ds_read_b128 a[136:139], v3 offset:5120
M a[76:79], a[168:171], v[76:79], 0
v_exp_f32 v111, v111
M a[76:79], a[164:167], v[44:47], a[76:79]
v_cvt_pk_bf16_f32 v109, v110, v111
M a[80:83], a[172:175], v[32:35], 0
v_exp_f32 v124, v124
M a[80:83], a[176:179], v[64:67], a[80:83]
ds_read_b128 a[140:143], v3 offset:6144
ds_read_b128 a[144:147], v3 offset:7168
M a[84:87], a[176:179], v[68:71], 0
v_exp_f32 v125, v125
M a[84:87], a[172:175], v[36:39], a[84:87]
v_cvt_pk_bf16_f32 v110, v124, v125
M a[88:91], a[172:175], v[40:43], 0
v_exp_f32 v126, v126
M a[88:91], a[176:179], v[72:75], a[88:91]
M a[92:95], a[176:179], v[76:79], 0
v_exp_f32 v127, v127
M a[92:95], a[172:175], v[44:47], a[92:95]
v_cvt_pk_bf16_f32 v111, v126, v127
s_branch Lk2_l2b
Lk2_l2:
s_add_u32 m0, s29, 65536
s_waitcnt lgkmcnt(4)
M v[96:99], a[116:119], a[180:183], 0
v_exp_f32 v64, v64
M v[96:99], a[120:123], a[184:187], v[96:99]
ds_read_b128 a[148:151], v2 offset:8192
ds_read_b128 a[152:155], v2 offset:9216
M v[96:99], a[124:127], a[188:191], v[96:99]
v_exp_f32 v65, v65
M v[96:99], a[128:131], a[192:195], v[96:99]
buffer_load_dwordx4 v1, s[12:15], s25 offen offset:0 sc1 lds
s_add_u32 s32, s25, 4096
M v[100:103], a[128:131], a[208:211], 0
v_exp_f32 v66, v66
M v[100:103], a[124:127], a[204:207], v[100:103]
v_cvt_pk_bf16_f32 v64, v64, v65
M v[100:103], a[120:123], a[200:203], v[100:103]
v_exp_f32 v67, v67
M v[100:103], a[116:119], a[196:199], v[100:103]
buffer_load_dwordx4 v1, s[12:15], s25 offen offset:1024 sc1 lds
M v[104:107], a[116:119], a[212:215], 0
v_exp_f32 v80, v80
M v[104:107], a[120:123], a[216:219], v[104:107]
ds_read_b128 a[156:159], v2 offset:10240
ds_read_b128 a[160:163], v2 offset:11264
M v[104:107], a[124:127], a[220:223], v[104:107]
v_exp_f32 v81, v81
M v[104:107], a[128:131], a[224:227], v[104:107]
buffer_load_dwordx4 v1, s[12:15], s25 offen offset:2048 sc1 lds
M v[108:111], a[128:131], a[240:243], 0
v_exp_f32 v82, v82
M v[108:111], a[124:127], a[236:239], v[108:111]
v_cvt_pk_bf16_f32 v65, v66, v67
v_cvt_pk_bf16_f32 v66, v80, v81
M v[108:111], a[120:123], a[232:235], v[108:111]
v_exp_f32 v83, v83
M v[108:111], a[116:119], a[228:231], v[108:111]
buffer_load_dwordx4 v1, s[12:15], s25 offen offset:3072 sc1 lds
s_add_u32 m0, s29, 69632
s_waitcnt lgkmcnt(4)
M v[112:115], a[132:135], a[180:183], 0
v_exp_f32 v68, v68
M v[112:115], a[136:139], a[184:187], v[112:115]
ds_read_b128 a[164:167], v2 offset:12288
ds_read_b128 a[168:171], v2 offset:13312
M v[112:115], a[140:143], a[188:191], v[112:115]
v_exp_f32 v69, v69
M v[112:115], a[144:147], a[192:195], v[112:115]
buffer_load_dwordx4 v1, s[12:15], s32 offen offset:0 sc1 lds
M v[116:119], a[144:147], a[208:211], 0
v_exp_f32 v70, v70
M v[116:119], a[140:143], a[204:207], v[116:119]
v_cvt_pk_bf16_f32 v67, v82, v83
v_cvt_pk_bf16_f32 v68, v68, v69
M v[116:119], a[136:139], a[200:203], v[116:119]
v_exp_f32 v71, v71
M v[116:119], a[132:135], a[196:199], v[116:119]
buffer_load_dwordx4 v1, s[12:15], s32 offen offset:1024 sc1 lds
M v[120:123], a[132:135], a[212:215], 0
v_exp_f32 v84, v84
M v[120:123], a[136:139], a[216:219], v[120:123]
ds_read_b128 a[172:175], v2 offset:14336
ds_read_b128 a[176:179], v2 offset:15360
M v[120:123], a[140:143], a[220:223], v[120:123]
v_exp_f32 v85, v85
M v[120:123], a[144:147], a[224:227], v[120:123]
buffer_load_dwordx4 v1, s[12:15], s32 offen offset:2048 sc1 lds
M v[124:127], a[144:147], a[240:243], 0
v_exp_f32 v86, v86
M v[124:127], a[140:143], a[236:239], v[124:127]
v_cvt_pk_bf16_f32 v69, v70, v71
v_cvt_pk_bf16_f32 v70, v84, v85
M v[124:127], a[136:139], a[232:235], v[124:127]
v_exp_f32 v87, v87
M v[124:127], a[132:135], a[228:231], v[124:127]
buffer_load_dwordx4 v1, s[12:15], s32 offen offset:3072 sc1 lds
s_add_u32 m0, s29, 98304
s_waitcnt lgkmcnt(4)
M v[128:131], a[148:151], a[180:183], 0
v_exp_f32 v72, v72
M v[128:131], a[152:155], a[184:187], v[128:131]
ds_read_b128 a[116:119], v2 offset:32768
ds_read_b128 a[120:123], v2 offset:40960
M v[128:131], a[156:159], a[188:191], v[128:131]
v_exp_f32 v73, v73
M v[128:131], a[160:163], a[192:195], v[128:131]
buffer_load_dwordx4 v1, s[12:15], s26 offen offset:0 sc1 lds
s_add_u32 s43, s26, 4096
M v[132:135], a[160:163], a[208:211], 0
v_exp_f32 v74, v74
M v[132:135], a[156:159], a[204:207], v[132:135]
v_cvt_pk_bf16_f32 v71, v86, v87
v_cvt_pk_bf16_f32 v72, v72, v73
M v[132:135], a[152:155], a[200:203], v[132:135]
v_exp_f32 v75, v75
M v[132:135], a[148:151], a[196:199], v[132:135]
buffer_load_dwordx4 v1, s[12:15], s26 offen offset:1024 sc1 lds
M v[136:139], a[148:151], a[212:215], 0
v_exp_f32 v88, v88
M v[136:139], a[152:155], a[216:219], v[136:139]
ds_read_b128 a[124:127], v2 offset:33792
ds_read_b128 a[128:131], v2 offset:41984
M v[136:139], a[156:159], a[220:223], v[136:139]
v_exp_f32 v89, v89
M v[136:139], a[160:163], a[224:227], v[136:139]
buffer_load_dwordx4 v1, s[12:15], s26 offen offset:2048 sc1 lds
M v[140:143], a[160:163], a[240:243], 0
v_exp_f32 v90, v90
M v[140:143], a[156:159], a[236:239], v[140:143]
v_cvt_pk_bf16_f32 v73, v74, v75
v_cvt_pk_bf16_f32 v74, v88, v89
M v[140:143], a[152:155], a[232:235], v[140:143]
v_exp_f32 v91, v91
M v[140:143], a[148:151], a[228:231], v[140:143]
buffer_load_dwordx4 v1, s[12:15], s26 offen offset:3072 sc1 lds
s_add_u32 m0, s29, 102400
s_waitcnt lgkmcnt(4)
M v[144:147], a[164:167], a[180:183], 0
v_exp_f32 v76, v76
M v[144:147], a[168:171], a[184:187], v[144:147]
ds_read_b128 a[132:135], v2 offset:34816
ds_read_b128 a[136:139], v2 offset:43008
M v[144:147], a[172:175], a[188:191], v[144:147]
v_exp_f32 v77, v77
M v[144:147], a[176:179], a[192:195], v[144:147]
buffer_load_dwordx4 v1, s[12:15], s43 offen offset:0 sc1 lds
M v[148:151], a[176:179], a[208:211], 0
v_exp_f32 v78, v78
M v[148:151], a[172:175], a[204:207], v[148:151]
v_cvt_pk_bf16_f32 v75, v90, v91
v_cvt_pk_bf16_f32 v76, v76, v77
M v[148:151], a[168:171], a[200:203], v[148:151]
v_exp_f32 v79, v79
M v[148:151], a[164:167], a[196:199], v[148:151]
buffer_load_dwordx4 v1, s[12:15], s43 offen offset:1024 sc1 lds
M v[152:155], a[164:167], a[212:215], 0
v_exp_f32 v92, v92
M v[152:155], a[168:171], a[216:219], v[152:155]
ds_read_b128 a[140:143], v2 offset:35840
ds_read_b128 a[144:147], v2 offset:44032
M v[152:155], a[172:175], a[220:223], v[152:155]
v_exp_f32 v93, v93
M v[152:155], a[176:179], a[224:227], v[152:155]
buffer_load_dwordx4 v1, s[12:15], s43 offen offset:2048 sc1 lds
M v[156:159], a[176:179], a[240:243], 0
v_exp_f32 v94, v94
M v[156:159], a[172:175], a[236:239], v[156:159]
v_cvt_pk_bf16_f32 v77, v78, v79
v_cvt_pk_bf16_f32 v78, v92, v93
M v[156:159], a[168:171], a[232:235], v[156:159]
v_exp_f32 v95, v95
M v[156:159], a[164:167], a[228:231], v[156:159]
buffer_load_dwordx4 v1, s[12:15], s43 offen offset:3072 sc1 lds
v_cvt_pk_bf16_f32 v79, v94, v95
s_waitcnt lgkmcnt(6)
M v[160:163], a[116:119], v[32:35], v[160:163]
v_exp_f32 v96, v96
M v[160:163], a[120:123], v[64:67], v[160:163]
ds_read_b128 a[148:151], v2 offset:36864
ds_read_b128 a[152:155], v2 offset:45056
M v[164:167], a[120:123], v[68:71], v[164:167]
v_exp_f32 v97, v97
M v[164:167], a[116:119], v[36:39], v[164:167]
v_cvt_pk_bf16_f32 v96, v96, v97
M v[168:171], a[116:119], v[40:43], v[168:171]
v_exp_f32 v98, v98
M v[168:171], a[120:123], v[72:75], v[168:171]
s_add_u32 s25, s25, 32768
s_cmp_eq_u32 s25, s27
M v[172:175], a[120:123], v[76:79], v[172:175]
v_exp_f32 v99, v99
M v[172:175], a[116:119], v[44:47], v[172:175]
v_cvt_pk_bf16_f32 v97, v98, v99
s_waitcnt lgkmcnt(6)
M a[96:99], a[112:115], v[32:35], a[96:99]
s_cselect_b32 s25, s28, s25
s_cselect_b32 s27, -1, s27
M a[96:99], a[112:115], v[64:67], a[96:99]
s_add_u32 s26, s26, 32768
s_cmp_eq_u32 s26, s62
M v[176:179], a[124:127], v[32:35], v[176:179]
v_exp_f32 v112, v112
M v[176:179], a[128:131], v[64:67], v[176:179]
ds_read_b128 a[156:159], v2 offset:37888
ds_read_b128 a[160:163], v2 offset:46080
M v[180:183], a[128:131], v[68:71], v[180:183]
v_exp_f32 v113, v113
M v[180:183], a[124:127], v[36:39], v[180:183]
v_cvt_pk_bf16_f32 v98, v112, v113
M v[184:187], a[124:127], v[40:43], v[184:187]
v_exp_f32 v114, v114
M v[184:187], a[128:131], v[72:75], v[184:187]
s_cselect_b32 s26, s63, s26
s_cselect_b32 s62, -1, s62
M v[188:191], a[128:131], v[76:79], v[188:191]
v_exp_f32 v115, v115
M v[188:191], a[124:127], v[44:47], v[188:191]
v_cvt_pk_bf16_f32 v99, v114, v115
s_waitcnt lgkmcnt(6)
M a[100:103], a[112:115], v[36:39], a[100:103]
M a[100:103], a[112:115], v[68:71], a[100:103]
M v[192:195], a[132:135], v[32:35], v[192:195]
v_exp_f32 v100, v100
M v[192:195], a[136:139], v[64:67], v[192:195]
ds_read_b128 a[164:167], v2 offset:38912
ds_read_b128 a[168:171], v2 offset:47104
M v[196:199], a[136:139], v[68:71], v[196:199]
v_exp_f32 v101, v101
M v[196:199], a[132:135], v[36:39], v[196:199]
v_cvt_pk_bf16_f32 v100, v100, v101
M v[200:203], a[132:135], v[40:43], v[200:203]
v_exp_f32 v102, v102
M v[200:203], a[136:139], v[72:75], v[200:203]
M v[204:207], a[136:139], v[76:79], v[204:207]
v_exp_f32 v103, v103
M v[204:207], a[132:135], v[44:47], v[204:207]
v_cvt_pk_bf16_f32 v101, v102, v103
s_waitcnt lgkmcnt(6)
M a[104:107], a[112:115], v[40:43], a[104:107]
M a[104:107], a[112:115], v[72:75], a[104:107]
M v[208:211], a[140:143], v[32:35], v[208:211]
v_exp_f32 v116, v116
M v[208:211], a[144:147], v[64:67], v[208:211]
ds_read_b128 a[172:175], v2 offset:39936
ds_read_b128 a[176:179], v2 offset:48128
M v[212:215], a[144:147], v[68:71], v[212:215]
v_exp_f32 v117, v117
M v[212:215], a[140:143], v[36:39], v[212:215]
v_cvt_pk_bf16_f32 v102, v116, v117
M v[216:219], a[140:143], v[40:43], v[216:219]
v_exp_f32 v118, v118
M v[216:219], a[144:147], v[72:75], v[216:219]
M v[220:223], a[144:147], v[76:79], v[220:223]
v_exp_f32 v119, v119
M v[220:223], a[140:143], v[44:47], v[220:223]
v_cvt_pk_bf16_f32 v103, v118, v119
s_waitcnt lgkmcnt(6)
M a[108:111], a[112:115], v[44:47], a[108:111]
M a[108:111], a[112:115], v[76:79], a[108:111]
M v[224:227], a[148:151], v[32:35], v[224:227]
v_exp_f32 v104, v104
M v[224:227], a[152:155], v[64:67], v[224:227]
M v[228:231], a[152:155], v[68:71], v[228:231]
v_exp_f32 v105, v105
M v[228:231], a[148:151], v[36:39], v[228:231]
v_cvt_pk_bf16_f32 v104, v104, v105
M v[232:235], a[148:151], v[40:43], v[232:235]
v_exp_f32 v106, v106
M v[232:235], a[152:155], v[72:75], v[232:235]
M v[236:239], a[152:155], v[76:79], v[236:239]
v_exp_f32 v107, v107
M v[236:239], a[148:151], v[44:47], v[236:239]
v_cvt_pk_bf16_f32 v105, v106, v107
s_waitcnt lgkmcnt(4)
M v[240:243], a[156:159], v[32:35], v[240:243]
v_exp_f32 v120, v120
M v[240:243], a[160:163], v[64:67], v[240:243]
M v[244:247], a[160:163], v[68:71], v[244:247]
v_exp_f32 v121, v121
M v[244:247], a[156:159], v[36:39], v[244:247]
v_cvt_pk_bf16_f32 v106, v120, v121
M v[248:251], a[156:159], v[40:43], v[248:251]
v_exp_f32 v122, v122
M v[248:251], a[160:163], v[72:75], v[248:251]
s_waitcnt vmcnt(0) lgkmcnt(0)
s_barrier
ds_read_b128 a[116:119], v3 offset:0
ds_read_b128 a[120:123], v3 offset:1024
M v[252:255], a[160:163], v[76:79], v[252:255]
v_exp_f32 v123, v123
M v[252:255], a[156:159], v[44:47], v[252:255]
v_cvt_pk_bf16_f32 v107, v122, v123
M a[64:67], a[164:167], v[32:35], a[64:67]
v_exp_f32 v108, v108
M a[64:67], a[168:171], v[64:67], a[64:67]
ds_read_b128 a[124:127], v3 offset:2048
ds_read_b128 a[128:131], v3 offset:3072
M a[68:71], a[168:171], v[68:71], a[68:71]
v_exp_f32 v109, v109
M a[68:71], a[164:167], v[36:39], a[68:71]
v_cvt_pk_bf16_f32 v108, v108, v109
M a[72:75], a[164:167], v[40:43], a[72:75]
v_exp_f32 v110, v110
M a[72:75], a[168:171], v[72:75], a[72:75]
ds_read_b128 a[132:135], v3 offset:4096
ds_read_b128 a[136:139], v3 offset:5120
M a[76:79], a[168:171], v[76:79], a[76:79]
v_exp_f32 v111, v111
M a[76:79], a[164:167], v[44:47], a[76:79]
v_cvt_pk_bf16_f32 v109, v110, v111
M a[80:83], a[172:175], v[32:35], a[80:83]
v_exp_f32 v124, v124
M a[80:83], a[176:179], v[64:67], a[80:83]
ds_read_b128 a[140:143], v3 offset:6144
ds_read_b128 a[144:147], v3 offset:7168
M a[84:87], a[176:179], v[68:71], a[84:87]
v_exp_f32 v125, v125
M a[84:87], a[172:175], v[36:39], a[84:87]
v_cvt_pk_bf16_f32 v110, v124, v125
M a[88:91], a[172:175], v[40:43], a[88:91]
v_exp_f32 v126, v126
M a[88:91], a[176:179], v[72:75], a[88:91]
M a[92:95], a[176:179], v[76:79], a[92:95]
v_exp_f32 v127, v127
M a[92:95], a[172:175], v[44:47], a[92:95]
v_cvt_pk_bf16_f32 v111, v126, v127
Lk2_l2b:
s_add_u32 m0, s29, 0
s_waitcnt lgkmcnt(4)
M v[32:35], a[116:119], a[180:183], 0
v_exp_f32 v128, v128
M v[32:35], a[120:123], a[184:187], v[32:35]
ds_read_b128 a[148:151], v3 offset:8192
ds_read_b128 a[152:155], v3 offset:9216
M v[32:35], a[124:127], a[188:191], v[32:35]
v_exp_f32 v129, v129
M v[32:35], a[128:131], a[192:195], v[32:35]
buffer_load_dwordx4 v1, s[12:15], s25 offen offset:0 sc1 lds
s_add_u32 s32, s25, 4096
M v[36:39], a[128:131], a[208:211], 0
v_exp_f32 v130, v130
M v[36:39], a[124:127], a[204:207], v[36:39]
v_cvt_pk_bf16_f32 v128, v128, v129
M v[36:39], a[120:123], a[200:203], v[36:39]
v_exp_f32 v131, v131
M v[36:39], a[116:119], a[196:199], v[36:39]
buffer_load_dwordx4 v1, s[12:15], s25 offen offset:1024 sc1 lds
M v[40:43], a[116:119], a[212:215], 0
v_exp_f32 v144, v144
M v[40:43], a[120:123], a[216:219], v[40:43]
ds_read_b128 a[156:159], v3 offset:10240
ds_read_b128 a[160:163], v3 offset:11264
M v[40:43], a[124:127], a[220:223], v[40:43]
v_exp_f32 v145, v145
M v[40:43], a[128:131], a[224:227], v[40:43]
buffer_load_dwordx4 v1, s[12:15], s25 offen offset:2048 sc1 lds
M v[44:47], a[128:131], a[240:243], 0
v_exp_f32 v146, v146
M v[44:47], a[124:127], a[236:239], v[44:47]
v_cvt_pk_bf16_f32 v129, v130, v131
v_cvt_pk_bf16_f32 v130, v144, v145
M v[44:47], a[120:123], a[232:235], v[44:47]
v_exp_f32 v147, v147
M v[44:47], a[116:119], a[228:231], v[44:47]
buffer_load_dwordx4 v1, s[12:15], s25 offen offset:3072 sc1 lds
s_add_u32 m0, s29, 4096
s_waitcnt lgkmcnt(4)
M v[48:51], a[132:135], a[180:183], 0
v_exp_f32 v132, v132
M v[48:51], a[136:139], a[184:187], v[48:51]
ds_read_b128 a[164:167], v3 offset:12288
ds_read_b128 a[168:171], v3 offset:13312
M v[48:51], a[140:143], a[188:191], v[48:51]
v_exp_f32 v133, v133
M v[48:51], a[144:147], a[192:195], v[48:51]
buffer_load_dwordx4 v1, s[12:15], s32 offen offset:0 sc1 lds
M v[52:55], a[144:147], a[208:211], 0
v_exp_f32 v134, v134
M v[52:55], a[140:143], a[204:207], v[52:55]
v_cvt_pk_bf16_f32 v131, v146, v147
v_cvt_pk_bf16_f32 v132, v132, v133
M v[52:55], a[136:139], a[200:203], v[52:55]
v_exp_f32 v135, v135
M v[52:55], a[132:135], a[196:199], v[52:55]
buffer_load_dwordx4 v1, s[12:15], s32 offen offset:1024 sc1 lds
M v[56:59], a[132:135], a[212:215], 0
v_exp_f32 v148, v148
M v[56:59], a[136:139], a[216:219], v[56:59]
ds_read_b128 a[172:175], v3 offset:14336
ds_read_b128 a[176:179], v3 offset:15360
M v[56:59], a[140:143], a[220:223], v[56:59]
v_exp_f32 v149, v149
M v[56:59], a[144:147], a[224:227], v[56:59]
buffer_load_dwordx4 v1, s[12:15], s32 offen offset:2048 sc1 lds
M v[60:63], a[144:147], a[240:243], 0
v_exp_f32 v150, v150
M v[60:63], a[140:143], a[236:239], v[60:63]
v_cvt_pk_bf16_f32 v133, v134, v135
v_cvt_pk_bf16_f32 v134, v148, v149
M v[60:63], a[136:139], a[232:235], v[60:63]
v_exp_f32 v151, v151
M v[60:63], a[132:135], a[228:231], v[60:63]
buffer_load_dwordx4 v1, s[12:15], s32 offen offset:3072 sc1 lds
s_add_u32 m0, s29, 32768
s_waitcnt lgkmcnt(4)
M v[64:67], a[148:151], a[180:183], 0
v_exp_f32 v136, v136
M v[64:67], a[152:155], a[184:187], v[64:67]
ds_read_b128 a[116:119], v3 offset:32768
ds_read_b128 a[120:123], v3 offset:40960
M v[64:67], a[156:159], a[188:191], v[64:67]
v_exp_f32 v137, v137
M v[64:67], a[160:163], a[192:195], v[64:67]
buffer_load_dwordx4 v1, s[12:15], s26 offen offset:0 sc1 lds
s_add_u32 s43, s26, 4096
M v[68:71], a[160:163], a[208:211], 0
v_exp_f32 v138, v138
M v[68:71], a[156:159], a[204:207], v[68:71]
v_cvt_pk_bf16_f32 v135, v150, v151
v_cvt_pk_bf16_f32 v136, v136, v137
M v[68:71], a[152:155], a[200:203], v[68:71]
v_exp_f32 v139, v139
M v[68:71], a[148:151], a[196:199], v[68:71]
buffer_load_dwordx4 v1, s[12:15], s26 offen offset:1024 sc1 lds
M v[72:75], a[148:151], a[212:215], 0
v_exp_f32 v152, v152
M v[72:75], a[152:155], a[216:219], v[72:75]
ds_read_b128 a[124:127], v3 offset:33792
ds_read_b128 a[128:131], v3 offset:41984
M v[72:75], a[156:159], a[220:223], v[72:75]
v_exp_f32 v153, v153
M v[72:75], a[160:163], a[224:227], v[72:75]
buffer_load_dwordx4 v1, s[12:15], s26 offen offset:2048 sc1 lds
M v[76:79], a[160:163], a[240:243], 0
v_exp_f32 v154, v154
M v[76:79], a[156:159], a[236:239], v[76:79]
v_cvt_pk_bf16_f32 v137, v138, v139
v_cvt_pk_bf16_f32 v138, v152, v153
M v[76:79], a[152:155], a[232:235], v[76:79]
v_exp_f32 v155, v155
M v[76:79], a[148:151], a[228:231], v[76:79]
buffer_load_dwordx4 v1, s[12:15], s26 offen offset:3072 sc1 lds
s_add_u32 m0, s29, 36864
s_waitcnt lgkmcnt(4)
M v[80:83], a[164:167], a[180:183], 0
v_exp_f32 v140, v140
M v[80:83], a[168:171], a[184:187], v[80:83]
ds_read_b128 a[132:135], v3 offset:34816
ds_read_b128 a[136:139], v3 offset:43008
M v[80:83], a[172:175], a[188:191], v[80:83]
v_exp_f32 v141, v141
M v[80:83], a[176:179], a[192:195], v[80:83]
buffer_load_dwordx4 v1, s[12:15], s43 offen offset:0 sc1 lds
M v[84:87], a[176:179], a[208:211], 0
v_exp_f32 v142, v142
M v[84:87], a[172:175], a[204:207], v[84:87]
v_cvt_pk_bf16_f32 v139, v154, v155
v_cvt_pk_bf16_f32 v140, v140, v141
M v[84:87], a[168:171], a[200:203], v[84:87]
v_exp_f32 v143, v143
M v[84:87], a[164:167], a[196:199], v[84:87]
buffer_load_dwordx4 v1, s[12:15], s43 offen offset:1024 sc1 lds
M v[88:91], a[164:167], a[212:215], 0
v_exp_f32 v156, v156
M v[88:91], a[168:171], a[216:219], v[88:91]
ds_read_b128 a[140:143], v3 offset:35840
ds_read_b128 a[144:147], v3 offset:44032
M v[88:91], a[172:175], a[220:223], v[88:91]
v_exp_f32 v157, v157
M v[88:91], a[176:179], a[224:227], v[88:91]
buffer_load_dwordx4 v1, s[12:15], s43 offen offset:2048 sc1 lds
M v[92:95], a[176:179], a[240:243], 0
v_exp_f32 v158, v158
M v[92:95], a[172:175], a[236:239], v[92:95]
v_cvt_pk_bf16_f32 v141, v142, v143
v_cvt_pk_bf16_f32 v142, v156, v157
M v[92:95], a[168:171], a[232:235], v[92:95]
v_exp_f32 v159, v159
M v[92:95], a[164:167], a[228:231], v[92:95]
buffer_load_dwordx4 v1, s[12:15], s43 offen offset:3072 sc1 lds
v_cvt_pk_bf16_f32 v143, v158, v159
s_waitcnt lgkmcnt(6)
M v[160:163], a[116:119], v[96:99], v[160:163]
v_exp_f32 v32, v32
M v[160:163], a[120:123], v[128:131], v[160:163]
ds_read_b128 a[148:151], v3 offset:36864
ds_read_b128 a[152:155], v3 offset:45056
M v[164:167], a[120:123], v[132:135], v[164:167]
v_exp_f32 v33, v33
M v[164:167], a[116:119], v[100:103], v[164:167]
v_cvt_pk_bf16_f32 v32, v32, v33
M v[168:171], a[116:119], v[104:107], v[168:171]
v_exp_f32 v34, v34
M v[168:171], a[120:123], v[136:139], v[168:171]
s_add_u32 s25, s25, 32768
s_cmp_eq_u32 s25, s27
M v[172:175], a[120:123], v[140:143], v[172:175]
v_exp_f32 v35, v35
M v[172:175], a[116:119], v[108:111], v[172:175]
v_cvt_pk_bf16_f32 v33, v34, v35
s_waitcnt lgkmcnt(6)
M a[96:99], a[112:115], v[96:99], a[96:99]
s_cselect_b32 s25, s28, s25
s_cselect_b32 s27, -1, s27
M a[96:99], a[112:115], v[128:131], a[96:99]
s_add_u32 s26, s26, 32768
s_cmp_eq_u32 s26, s62
M v[176:179], a[124:127], v[96:99], v[176:179]
v_exp_f32 v48, v48
M v[176:179], a[128:131], v[128:131], v[176:179]
ds_read_b128 a[156:159], v3 offset:37888
ds_read_b128 a[160:163], v3 offset:46080
M v[180:183], a[128:131], v[132:135], v[180:183]
v_exp_f32 v49, v49
M v[180:183], a[124:127], v[100:103], v[180:183]
v_cvt_pk_bf16_f32 v34, v48, v49
M v[184:187], a[124:127], v[104:107], v[184:187]
v_exp_f32 v50, v50
M v[184:187], a[128:131], v[136:139], v[184:187]
s_cselect_b32 s26, s63, s26
s_cselect_b32 s62, -1, s62
M v[188:191], a[128:131], v[140:143], v[188:191]
v_exp_f32 v51, v51
M v[188:191], a[124:127], v[108:111], v[188:191]
v_cvt_pk_bf16_f32 v35, v50, v51
s_waitcnt lgkmcnt(6)
M a[100:103], a[112:115], v[100:103], a[100:103]
M a[100:103], a[112:115], v[132:135], a[100:103]
M v[192:195], a[132:135], v[96:99], v[192:195]
v_exp_f32 v36, v36
M v[192:195], a[136:139], v[128:131], v[192:195]
ds_read_b128 a[164:167], v3 offset:38912
ds_read_b128 a[168:171], v3 offset:47104
M v[196:199], a[136:139], v[132:135], v[196:199]
v_exp_f32 v37, v37
M v[196:199], a[132:135], v[100:103], v[196:199]
v_cvt_pk_bf16_f32 v36, v36, v37
M v[200:203], a[132:135], v[104:107], v[200:203]
v_exp_f32 v38, v38
M v[200:203], a[136:139], v[136:139], v[200:203]
M v[204:207], a[136:139], v[140:143], v[204:207]
v_exp_f32 v39, v39
M v[204:207], a[132:135], v[108:111], v[204:207]
v_cvt_pk_bf16_f32 v37, v38, v39
s_waitcnt lgkmcnt(6)
M a[104:107], a[112:115], v[104:107], a[104:107]
M a[104:107], a[112:115], v[136:139], a[104:107]
M v[208:211], a[140:143], v[96:99], v[208:211]
v_exp_f32 v52, v52
M v[208:211], a[144:147], v[128:131], v[208:211]
ds_read_b128 a[172:175], v3 offset:39936
ds_read_b128 a[176:179], v3 offset:48128
M v[212:215], a[144:147], v[132:135], v[212:215]
v_exp_f32 v53, v53
M v[212:215], a[140:143], v[100:103], v[212:215]
v_cvt_pk_bf16_f32 v38, v52, v53
M v[216:219], a[140:143], v[104:107], v[216:219]
v_exp_f32 v54, v54
M v[216:219], a[144:147], v[136:139], v[216:219]
M v[220:223], a[144:147], v[140:143], v[220:223]
v_exp_f32 v55, v55
M v[220:223], a[140:143], v[108:111], v[220:223]
v_cvt_pk_bf16_f32 v39, v54, v55
s_waitcnt lgkmcnt(6)
M a[108:111], a[112:115], v[108:111], a[108:111]
M a[108:111], a[112:115], v[140:143], a[108:111]
M v[224:227], a[148:151], v[96:99], v[224:227]
v_exp_f32 v40, v40
M v[224:227], a[152:155], v[128:131], v[224:227]
M v[228:231], a[152:155], v[132:135], v[228:231]
v_exp_f32 v41, v41
M v[228:231], a[148:151], v[100:103], v[228:231]
v_cvt_pk_bf16_f32 v40, v40, v41
M v[232:235], a[148:151], v[104:107], v[232:235]
v_exp_f32 v42, v42
M v[232:235], a[152:155], v[136:139], v[232:235]
M v[236:239], a[152:155], v[140:143], v[236:239]
v_exp_f32 v43, v43
M v[236:239], a[148:151], v[108:111], v[236:239]
v_cvt_pk_bf16_f32 v41, v42, v43
s_waitcnt lgkmcnt(4)
M v[240:243], a[156:159], v[96:99], v[240:243]
v_exp_f32 v56, v56
M v[240:243], a[160:163], v[128:131], v[240:243]
M v[244:247], a[160:163], v[132:135], v[244:247]
v_exp_f32 v57, v57
M v[244:247], a[156:159], v[100:103], v[244:247]
v_cvt_pk_bf16_f32 v42, v56, v57
M v[248:251], a[156:159], v[104:107], v[248:251]
v_exp_f32 v58, v58
M v[248:251], a[160:163], v[136:139], v[248:251]
s_waitcnt vmcnt(0) lgkmcnt(0)
s_barrier
ds_read_b128 a[116:119], v2 offset:0
ds_read_b128 a[120:123], v2 offset:1024
M v[252:255], a[160:163], v[140:143], v[252:255]
v_exp_f32 v59, v59
M v[252:255], a[156:159], v[108:111], v[252:255]
v_cvt_pk_bf16_f32 v43, v58, v59
M a[64:67], a[164:167], v[96:99], a[64:67]
v_exp_f32 v44, v44
M a[64:67], a[168:171], v[128:131], a[64:67]
ds_read_b128 a[124:127], v2 offset:2048
ds_read_b128 a[128:131], v2 offset:3072
M a[68:71], a[168:171], v[132:135], a[68:71]
v_exp_f32 v45, v45
M a[68:71], a[164:167], v[100:103], a[68:71]
v_cvt_pk_bf16_f32 v44, v44, v45
M a[72:75], a[164:167], v[104:107], a[72:75]
v_exp_f32 v46, v46
M a[72:75], a[168:171], v[136:139], a[72:75]
ds_read_b128 a[132:135], v2 offset:4096
ds_read_b128 a[136:139], v2 offset:5120
M a[76:79], a[168:171], v[140:143], a[76:79]
v_exp_f32 v47, v47
M a[76:79], a[164:167], v[108:111], a[76:79]
v_cvt_pk_bf16_f32 v45, v46, v47
M a[80:83], a[172:175], v[96:99], a[80:83]
v_exp_f32 v60, v60
M a[80:83], a[176:179], v[128:131], a[80:83]
ds_read_b128 a[140:143], v2 offset:6144
ds_read_b128 a[144:147], v2 offset:7168
M a[84:87], a[176:179], v[132:135], a[84:87]
v_exp_f32 v61, v61
M a[84:87], a[172:175], v[100:103], a[84:87]
v_cvt_pk_bf16_f32 v46, v60, v61
M a[88:91], a[172:175], v[104:107], a[88:91]
v_exp_f32 v62, v62
M a[88:91], a[176:179], v[136:139], a[88:91]
M a[92:95], a[176:179], v[140:143], a[92:95]
v_exp_f32 v63, v63
M a[92:95], a[172:175], v[108:111], a[92:95]
v_cvt_pk_bf16_f32 v47, v62, v63
s_sub_u32 s30, s30, 1
s_cmp_lg_u32 s30, 0
s_cbranch_scc1 Lk2_l2
s_branch Lk2_fin
s_waitcnt lgkmcnt(0)
Lk2_wm:
s_lshl_b32 s33, s2, 1
s_add_u32 s33, s33, s23
s_lshl_b32 s34, s33, 12
s_lshl_b32 s33, s33, 14
v_lshlrev_b32 v8, 3, v1
v_lshlrev_b32 v9, 2, v1
buffer_load_dword a244, v8, s[44:47], s33 offen
s_add_u32 s33, s33, 8192
buffer_load_dword a245, v8, s[44:47], s33 offen
buffer_load_dword a246, v9, s[48:51], s34 offen
s_branch Lk2_l3b
Lk2_g1:
s_mov_b32 s30, 7
s_bfe_u32 s42, s2, 0x20003
s_add_u32 s42, s42, 2
Lk2_l3:
s_cmp_eq_u32 s30, s42
s_cbranch_scc1 Lk2_wm
Lk2_l3b:
s_add_u32 m0, s29, 65536
s_waitcnt lgkmcnt(4)
M v[96:99], a[116:119], a[0:3], 0
v_exp_f32 v64, v64
M v[96:99], a[120:123], a[4:7], v[96:99]
ds_read_b128 a[148:151], v2 offset:8192
ds_read_b128 a[152:155], v2 offset:9216
M v[96:99], a[124:127], a[8:11], v[96:99]
v_exp_f32 v65, v65
M v[96:99], a[128:131], a[12:15], v[96:99]
buffer_load_dwordx4 v1, s[12:15], s25 offen offset:0 sc1 lds
s_add_u32 s32, s25, 4096
M v[100:103], a[128:131], a[28:31], 0
v_exp_f32 v66, v66
M v[100:103], a[124:127], a[24:27], v[100:103]
v_cvt_pk_bf16_f32 v64, v64, v65
M v[100:103], a[120:123], a[20:23], v[100:103]
v_exp_f32 v67, v67
M v[100:103], a[116:119], a[16:19], v[100:103]
buffer_load_dwordx4 v1, s[12:15], s25 offen offset:1024 sc1 lds
M v[104:107], a[116:119], a[32:35], 0
v_exp_f32 v80, v80
M v[104:107], a[120:123], a[36:39], v[104:107]
ds_read_b128 a[156:159], v2 offset:10240
ds_read_b128 a[160:163], v2 offset:11264
M v[104:107], a[124:127], a[40:43], v[104:107]
v_exp_f32 v81, v81
M v[104:107], a[128:131], a[44:47], v[104:107]
buffer_load_dwordx4 v1, s[12:15], s25 offen offset:2048 sc1 lds
M v[108:111], a[128:131], a[60:63], 0
v_exp_f32 v82, v82
M v[108:111], a[124:127], a[56:59], v[108:111]
v_cvt_pk_bf16_f32 v65, v66, v67
v_cvt_pk_bf16_f32 v66, v80, v81
M v[108:111], a[120:123], a[52:55], v[108:111]
v_exp_f32 v83, v83
M v[108:111], a[116:119], a[48:51], v[108:111]
buffer_load_dwordx4 v1, s[12:15], s25 offen offset:3072 sc1 lds
s_add_u32 m0, s29, 69632
s_waitcnt lgkmcnt(4)
M v[112:115], a[132:135], a[0:3], 0
v_exp_f32 v68, v68
M v[112:115], a[136:139], a[4:7], v[112:115]
ds_read_b128 a[164:167], v2 offset:12288
ds_read_b128 a[168:171], v2 offset:13312
M v[112:115], a[140:143], a[8:11], v[112:115]
v_exp_f32 v69, v69
M v[112:115], a[144:147], a[12:15], v[112:115]
buffer_load_dwordx4 v1, s[12:15], s32 offen offset:0 sc1 lds
M v[116:119], a[144:147], a[28:31], 0
v_exp_f32 v70, v70
M v[116:119], a[140:143], a[24:27], v[116:119]
v_cvt_pk_bf16_f32 v67, v82, v83
v_cvt_pk_bf16_f32 v68, v68, v69
M v[116:119], a[136:139], a[20:23], v[116:119]
v_exp_f32 v71, v71
M v[116:119], a[132:135], a[16:19], v[116:119]
buffer_load_dwordx4 v1, s[12:15], s32 offen offset:1024 sc1 lds
M v[120:123], a[132:135], a[32:35], 0
v_exp_f32 v84, v84
M v[120:123], a[136:139], a[36:39], v[120:123]
ds_read_b128 a[172:175], v2 offset:14336
ds_read_b128 a[176:179], v2 offset:15360
M v[120:123], a[140:143], a[40:43], v[120:123]
v_exp_f32 v85, v85
M v[120:123], a[144:147], a[44:47], v[120:123]
buffer_load_dwordx4 v1, s[12:15], s32 offen offset:2048 sc1 lds
M v[124:127], a[144:147], a[60:63], 0
v_exp_f32 v86, v86
M v[124:127], a[140:143], a[56:59], v[124:127]
v_cvt_pk_bf16_f32 v69, v70, v71
v_cvt_pk_bf16_f32 v70, v84, v85
M v[124:127], a[136:139], a[52:55], v[124:127]
v_exp_f32 v87, v87
M v[124:127], a[132:135], a[48:51], v[124:127]
buffer_load_dwordx4 v1, s[12:15], s32 offen offset:3072 sc1 lds
s_add_u32 m0, s29, 98304
s_waitcnt lgkmcnt(4)
M v[128:131], a[148:151], a[0:3], 0
v_exp_f32 v72, v72
M v[128:131], a[152:155], a[4:7], v[128:131]
ds_read_b128 a[116:119], v2 offset:32768
ds_read_b128 a[120:123], v2 offset:40960
M v[128:131], a[156:159], a[8:11], v[128:131]
v_exp_f32 v73, v73
M v[128:131], a[160:163], a[12:15], v[128:131]
buffer_load_dwordx4 v1, s[12:15], s26 offen offset:0 sc1 lds
s_add_u32 s43, s26, 4096
M v[132:135], a[160:163], a[28:31], 0
v_exp_f32 v74, v74
M v[132:135], a[156:159], a[24:27], v[132:135]
v_cvt_pk_bf16_f32 v71, v86, v87
v_cvt_pk_bf16_f32 v72, v72, v73
M v[132:135], a[152:155], a[20:23], v[132:135]
v_exp_f32 v75, v75
M v[132:135], a[148:151], a[16:19], v[132:135]
buffer_load_dwordx4 v1, s[12:15], s26 offen offset:1024 sc1 lds
M v[136:139], a[148:151], a[32:35], 0
v_exp_f32 v88, v88
M v[136:139], a[152:155], a[36:39], v[136:139]
ds_read_b128 a[124:127], v2 offset:33792
ds_read_b128 a[128:131], v2 offset:41984
M v[136:139], a[156:159], a[40:43], v[136:139]
v_exp_f32 v89, v89
M v[136:139], a[160:163], a[44:47], v[136:139]
buffer_load_dwordx4 v1, s[12:15], s26 offen offset:2048 sc1 lds
M v[140:143], a[160:163], a[60:63], 0
v_exp_f32 v90, v90
M v[140:143], a[156:159], a[56:59], v[140:143]
v_cvt_pk_bf16_f32 v73, v74, v75
v_cvt_pk_bf16_f32 v74, v88, v89
M v[140:143], a[152:155], a[52:55], v[140:143]
v_exp_f32 v91, v91
M v[140:143], a[148:151], a[48:51], v[140:143]
buffer_load_dwordx4 v1, s[12:15], s26 offen offset:3072 sc1 lds
s_add_u32 m0, s29, 102400
s_waitcnt lgkmcnt(4)
M v[144:147], a[164:167], a[0:3], 0
v_exp_f32 v76, v76
M v[144:147], a[168:171], a[4:7], v[144:147]
ds_read_b128 a[132:135], v2 offset:34816
ds_read_b128 a[136:139], v2 offset:43008
M v[144:147], a[172:175], a[8:11], v[144:147]
v_exp_f32 v77, v77
M v[144:147], a[176:179], a[12:15], v[144:147]
buffer_load_dwordx4 v1, s[12:15], s43 offen offset:0 sc1 lds
M v[148:151], a[176:179], a[28:31], 0
v_exp_f32 v78, v78
M v[148:151], a[172:175], a[24:27], v[148:151]
v_cvt_pk_bf16_f32 v75, v90, v91
v_cvt_pk_bf16_f32 v76, v76, v77
M v[148:151], a[168:171], a[20:23], v[148:151]
v_exp_f32 v79, v79
M v[148:151], a[164:167], a[16:19], v[148:151]
buffer_load_dwordx4 v1, s[12:15], s43 offen offset:1024 sc1 lds
M v[152:155], a[164:167], a[32:35], 0
v_exp_f32 v92, v92
M v[152:155], a[168:171], a[36:39], v[152:155]
ds_read_b128 a[140:143], v2 offset:35840
ds_read_b128 a[144:147], v2 offset:44032
M v[152:155], a[172:175], a[40:43], v[152:155]
v_exp_f32 v93, v93
M v[152:155], a[176:179], a[44:47], v[152:155]
buffer_load_dwordx4 v1, s[12:15], s43 offen offset:2048 sc1 lds
M v[156:159], a[176:179], a[60:63], 0
v_exp_f32 v94, v94
M v[156:159], a[172:175], a[56:59], v[156:159]
v_cvt_pk_bf16_f32 v77, v78, v79
v_cvt_pk_bf16_f32 v78, v92, v93
M v[156:159], a[168:171], a[52:55], v[156:159]
v_exp_f32 v95, v95
M v[156:159], a[164:167], a[48:51], v[156:159]
buffer_load_dwordx4 v1, s[12:15], s43 offen offset:3072 sc1 lds
v_cvt_pk_bf16_f32 v79, v94, v95
s_waitcnt lgkmcnt(6)
M v[160:163], a[116:119], v[32:35], v[160:163]
v_exp_f32 v96, v96
M v[160:163], a[120:123], v[64:67], v[160:163]
ds_read_b128 a[148:151], v2 offset:36864
ds_read_b128 a[152:155], v2 offset:45056
M v[164:167], a[120:123], v[68:71], v[164:167]
v_exp_f32 v97, v97
M v[164:167], a[116:119], v[36:39], v[164:167]
v_cvt_pk_bf16_f32 v96, v96, v97
M v[168:171], a[116:119], v[40:43], v[168:171]
v_exp_f32 v98, v98
M v[168:171], a[120:123], v[72:75], v[168:171]
s_add_u32 s25, s25, 32768
s_cmp_eq_u32 s25, s27
M v[172:175], a[120:123], v[76:79], v[172:175]
v_exp_f32 v99, v99
M v[172:175], a[116:119], v[44:47], v[172:175]
v_cvt_pk_bf16_f32 v97, v98, v99
s_waitcnt lgkmcnt(6)
M a[96:99], a[112:115], v[32:35], a[96:99]
s_cselect_b32 s25, s28, s25
s_cselect_b32 s27, -1, s27
M a[96:99], a[112:115], v[64:67], a[96:99]
s_add_u32 s26, s26, 32768
s_cmp_eq_u32 s26, s62
M v[176:179], a[124:127], v[32:35], v[176:179]
v_exp_f32 v112, v112
M v[176:179], a[128:131], v[64:67], v[176:179]
ds_read_b128 a[156:159], v2 offset:37888
ds_read_b128 a[160:163], v2 offset:46080
M v[180:183], a[128:131], v[68:71], v[180:183]
v_exp_f32 v113, v113
M v[180:183], a[124:127], v[36:39], v[180:183]
v_cvt_pk_bf16_f32 v98, v112, v113
M v[184:187], a[124:127], v[40:43], v[184:187]
v_exp_f32 v114, v114
M v[184:187], a[128:131], v[72:75], v[184:187]
s_cselect_b32 s26, s63, s26
s_cselect_b32 s62, -1, s62
M v[188:191], a[128:131], v[76:79], v[188:191]
v_exp_f32 v115, v115
M v[188:191], a[124:127], v[44:47], v[188:191]
v_cvt_pk_bf16_f32 v99, v114, v115
s_waitcnt lgkmcnt(6)
M a[100:103], a[112:115], v[36:39], a[100:103]
M a[100:103], a[112:115], v[68:71], a[100:103]
M v[192:195], a[132:135], v[32:35], v[192:195]
v_exp_f32 v100, v100
M v[192:195], a[136:139], v[64:67], v[192:195]
ds_read_b128 a[164:167], v2 offset:38912
ds_read_b128 a[168:171], v2 offset:47104
M v[196:199], a[136:139], v[68:71], v[196:199]
v_exp_f32 v101, v101
M v[196:199], a[132:135], v[36:39], v[196:199]
v_cvt_pk_bf16_f32 v100, v100, v101
M v[200:203], a[132:135], v[40:43], v[200:203]
v_exp_f32 v102, v102
M v[200:203], a[136:139], v[72:75], v[200:203]
M v[204:207], a[136:139], v[76:79], v[204:207]
v_exp_f32 v103, v103
M v[204:207], a[132:135], v[44:47], v[204:207]
v_cvt_pk_bf16_f32 v101, v102, v103
s_waitcnt lgkmcnt(6)
M a[104:107], a[112:115], v[40:43], a[104:107]
M a[104:107], a[112:115], v[72:75], a[104:107]
M v[208:211], a[140:143], v[32:35], v[208:211]
v_exp_f32 v116, v116
M v[208:211], a[144:147], v[64:67], v[208:211]
ds_read_b128 a[172:175], v2 offset:39936
ds_read_b128 a[176:179], v2 offset:48128
M v[212:215], a[144:147], v[68:71], v[212:215]
v_exp_f32 v117, v117
M v[212:215], a[140:143], v[36:39], v[212:215]
v_cvt_pk_bf16_f32 v102, v116, v117
M v[216:219], a[140:143], v[40:43], v[216:219]
v_exp_f32 v118, v118
M v[216:219], a[144:147], v[72:75], v[216:219]
M v[220:223], a[144:147], v[76:79], v[220:223]
v_exp_f32 v119, v119
M v[220:223], a[140:143], v[44:47], v[220:223]
v_cvt_pk_bf16_f32 v103, v118, v119
s_waitcnt lgkmcnt(6)
M a[108:111], a[112:115], v[44:47], a[108:111]
M a[108:111], a[112:115], v[76:79], a[108:111]
M v[224:227], a[148:151], v[32:35], v[224:227]
v_exp_f32 v104, v104
M v[224:227], a[152:155], v[64:67], v[224:227]
M v[228:231], a[152:155], v[68:71], v[228:231]
v_exp_f32 v105, v105
M v[228:231], a[148:151], v[36:39], v[228:231]
v_cvt_pk_bf16_f32 v104, v104, v105
M v[232:235], a[148:151], v[40:43], v[232:235]
v_exp_f32 v106, v106
M v[232:235], a[152:155], v[72:75], v[232:235]
M v[236:239], a[152:155], v[76:79], v[236:239]
v_exp_f32 v107, v107
M v[236:239], a[148:151], v[44:47], v[236:239]
v_cvt_pk_bf16_f32 v105, v106, v107
s_waitcnt lgkmcnt(4)
M v[240:243], a[156:159], v[32:35], v[240:243]
v_exp_f32 v120, v120
M v[240:243], a[160:163], v[64:67], v[240:243]
M v[244:247], a[160:163], v[68:71], v[244:247]
v_exp_f32 v121, v121
M v[244:247], a[156:159], v[36:39], v[244:247]
v_cvt_pk_bf16_f32 v106, v120, v121
M v[248:251], a[156:159], v[40:43], v[248:251]
v_exp_f32 v122, v122
M v[248:251], a[160:163], v[72:75], v[248:251]
s_waitcnt vmcnt(0) lgkmcnt(0)
s_barrier
ds_read_b128 a[116:119], v3 offset:0
ds_read_b128 a[120:123], v3 offset:1024
M v[252:255], a[160:163], v[76:79], v[252:255]
v_exp_f32 v123, v123
M v[252:255], a[156:159], v[44:47], v[252:255]
v_cvt_pk_bf16_f32 v107, v122, v123
M a[64:67], a[164:167], v[32:35], a[64:67]
v_exp_f32 v108, v108
M a[64:67], a[168:171], v[64:67], a[64:67]
ds_read_b128 a[124:127], v3 offset:2048
ds_read_b128 a[128:131], v3 offset:3072
M a[68:71], a[168:171], v[68:71], a[68:71]
v_exp_f32 v109, v109
M a[68:71], a[164:167], v[36:39], a[68:71]
v_cvt_pk_bf16_f32 v108, v108, v109
M a[72:75], a[164:167], v[40:43], a[72:75]
v_exp_f32 v110, v110
M a[72:75], a[168:171], v[72:75], a[72:75]
ds_read_b128 a[132:135], v3 offset:4096
ds_read_b128 a[136:139], v3 offset:5120
M a[76:79], a[168:171], v[76:79], a[76:79]
v_exp_f32 v111, v111
M a[76:79], a[164:167], v[44:47], a[76:79]
v_cvt_pk_bf16_f32 v109, v110, v111
M a[80:83], a[172:175], v[32:35], a[80:83]
v_exp_f32 v124, v124
M a[80:83], a[176:179], v[64:67], a[80:83]
ds_read_b128 a[140:143], v3 offset:6144
ds_read_b128 a[144:147], v3 offset:7168
M a[84:87], a[176:179], v[68:71], a[84:87]
v_exp_f32 v125, v125
M a[84:87], a[172:175], v[36:39], a[84:87]
v_cvt_pk_bf16_f32 v110, v124, v125
M a[88:91], a[172:175], v[40:43], a[88:91]
v_exp_f32 v126, v126
M a[88:91], a[176:179], v[72:75], a[88:91]
M a[92:95], a[176:179], v[76:79], a[92:95]
v_exp_f32 v127, v127
M a[92:95], a[172:175], v[44:47], a[92:95]
v_cvt_pk_bf16_f32 v111, v126, v127
s_add_u32 m0, s29, 0
s_waitcnt lgkmcnt(4)
M v[32:35], a[116:119], a[0:3], 0
v_exp_f32 v128, v128
M v[32:35], a[120:123], a[4:7], v[32:35]
ds_read_b128 a[148:151], v3 offset:8192
ds_read_b128 a[152:155], v3 offset:9216
M v[32:35], a[124:127], a[8:11], v[32:35]
v_exp_f32 v129, v129
M v[32:35], a[128:131], a[12:15], v[32:35]
buffer_load_dwordx4 v1, s[12:15], s25 offen offset:0 sc1 lds
s_add_u32 s32, s25, 4096
M v[36:39], a[128:131], a[28:31], 0
v_exp_f32 v130, v130
M v[36:39], a[124:127], a[24:27], v[36:39]
v_cvt_pk_bf16_f32 v128, v128, v129
M v[36:39], a[120:123], a[20:23], v[36:39]
v_exp_f32 v131, v131
M v[36:39], a[116:119], a[16:19], v[36:39]
buffer_load_dwordx4 v1, s[12:15], s25 offen offset:1024 sc1 lds
M v[40:43], a[116:119], a[32:35], 0
v_exp_f32 v144, v144
M v[40:43], a[120:123], a[36:39], v[40:43]
ds_read_b128 a[156:159], v3 offset:10240
ds_read_b128 a[160:163], v3 offset:11264
M v[40:43], a[124:127], a[40:43], v[40:43]
v_exp_f32 v145, v145
M v[40:43], a[128:131], a[44:47], v[40:43]
buffer_load_dwordx4 v1, s[12:15], s25 offen offset:2048 sc1 lds
M v[44:47], a[128:131], a[60:63], 0
v_exp_f32 v146, v146
M v[44:47], a[124:127], a[56:59], v[44:47]
v_cvt_pk_bf16_f32 v129, v130, v131
v_cvt_pk_bf16_f32 v130, v144, v145
M v[44:47], a[120:123], a[52:55], v[44:47]
v_exp_f32 v147, v147
M v[44:47], a[116:119], a[48:51], v[44:47]
buffer_load_dwordx4 v1, s[12:15], s25 offen offset:3072 sc1 lds
s_add_u32 m0, s29, 4096
s_waitcnt lgkmcnt(4)
M v[48:51], a[132:135], a[0:3], 0
v_exp_f32 v132, v132
M v[48:51], a[136:139], a[4:7], v[48:51]
ds_read_b128 a[164:167], v3 offset:12288
ds_read_b128 a[168:171], v3 offset:13312
M v[48:51], a[140:143], a[8:11], v[48:51]
v_exp_f32 v133, v133
M v[48:51], a[144:147], a[12:15], v[48:51]
buffer_load_dwordx4 v1, s[12:15], s32 offen offset:0 sc1 lds
M v[52:55], a[144:147], a[28:31], 0
v_exp_f32 v134, v134
M v[52:55], a[140:143], a[24:27], v[52:55]
v_cvt_pk_bf16_f32 v131, v146, v147
v_cvt_pk_bf16_f32 v132, v132, v133
M v[52:55], a[136:139], a[20:23], v[52:55]
v_exp_f32 v135, v135
M v[52:55], a[132:135], a[16:19], v[52:55]
buffer_load_dwordx4 v1, s[12:15], s32 offen offset:1024 sc1 lds
M v[56:59], a[132:135], a[32:35], 0
v_exp_f32 v148, v148
M v[56:59], a[136:139], a[36:39], v[56:59]
ds_read_b128 a[172:175], v3 offset:14336
ds_read_b128 a[176:179], v3 offset:15360
M v[56:59], a[140:143], a[40:43], v[56:59]
v_exp_f32 v149, v149
M v[56:59], a[144:147], a[44:47], v[56:59]
buffer_load_dwordx4 v1, s[12:15], s32 offen offset:2048 sc1 lds
M v[60:63], a[144:147], a[60:63], 0
v_exp_f32 v150, v150
M v[60:63], a[140:143], a[56:59], v[60:63]
v_cvt_pk_bf16_f32 v133, v134, v135
v_cvt_pk_bf16_f32 v134, v148, v149
M v[60:63], a[136:139], a[52:55], v[60:63]
v_exp_f32 v151, v151
M v[60:63], a[132:135], a[48:51], v[60:63]
buffer_load_dwordx4 v1, s[12:15], s32 offen offset:3072 sc1 lds
s_add_u32 m0, s29, 32768
s_waitcnt lgkmcnt(4)
M v[64:67], a[148:151], a[0:3], 0
v_exp_f32 v136, v136
M v[64:67], a[152:155], a[4:7], v[64:67]
ds_read_b128 a[116:119], v3 offset:32768
ds_read_b128 a[120:123], v3 offset:40960
M v[64:67], a[156:159], a[8:11], v[64:67]
v_exp_f32 v137, v137
M v[64:67], a[160:163], a[12:15], v[64:67]
buffer_load_dwordx4 v1, s[12:15], s26 offen offset:0 sc1 lds
s_add_u32 s43, s26, 4096
M v[68:71], a[160:163], a[28:31], 0
v_exp_f32 v138, v138
M v[68:71], a[156:159], a[24:27], v[68:71]
v_cvt_pk_bf16_f32 v135, v150, v151
v_cvt_pk_bf16_f32 v136, v136, v137
M v[68:71], a[152:155], a[20:23], v[68:71]
v_exp_f32 v139, v139
M v[68:71], a[148:151], a[16:19], v[68:71]
buffer_load_dwordx4 v1, s[12:15], s26 offen offset:1024 sc1 lds
M v[72:75], a[148:151], a[32:35], 0
v_exp_f32 v152, v152
M v[72:75], a[152:155], a[36:39], v[72:75]
ds_read_b128 a[124:127], v3 offset:33792
ds_read_b128 a[128:131], v3 offset:41984
M v[72:75], a[156:159], a[40:43], v[72:75]
v_exp_f32 v153, v153
M v[72:75], a[160:163], a[44:47], v[72:75]
buffer_load_dwordx4 v1, s[12:15], s26 offen offset:2048 sc1 lds
M v[76:79], a[160:163], a[60:63], 0
v_exp_f32 v154, v154
M v[76:79], a[156:159], a[56:59], v[76:79]
v_cvt_pk_bf16_f32 v137, v138, v139
v_cvt_pk_bf16_f32 v138, v152, v153
M v[76:79], a[152:155], a[52:55], v[76:79]
v_exp_f32 v155, v155
M v[76:79], a[148:151], a[48:51], v[76:79]
buffer_load_dwordx4 v1, s[12:15], s26 offen offset:3072 sc1 lds
s_add_u32 m0, s29, 36864
s_waitcnt lgkmcnt(4)
M v[80:83], a[164:167], a[0:3], 0
v_exp_f32 v140, v140
M v[80:83], a[168:171], a[4:7], v[80:83]
ds_read_b128 a[132:135], v3 offset:34816
ds_read_b128 a[136:139], v3 offset:43008
M v[80:83], a[172:175], a[8:11], v[80:83]
v_exp_f32 v141, v141
M v[80:83], a[176:179], a[12:15], v[80:83]
buffer_load_dwordx4 v1, s[12:15], s43 offen offset:0 sc1 lds
M v[84:87], a[176:179], a[28:31], 0
v_exp_f32 v142, v142
M v[84:87], a[172:175], a[24:27], v[84:87]
v_cvt_pk_bf16_f32 v139, v154, v155
v_cvt_pk_bf16_f32 v140, v140, v141
M v[84:87], a[168:171], a[20:23], v[84:87]
v_exp_f32 v143, v143
M v[84:87], a[164:167], a[16:19], v[84:87]
buffer_load_dwordx4 v1, s[12:15], s43 offen offset:1024 sc1 lds
M v[88:91], a[164:167], a[32:35], 0
v_exp_f32 v156, v156
M v[88:91], a[168:171], a[36:39], v[88:91]
ds_read_b128 a[140:143], v3 offset:35840
ds_read_b128 a[144:147], v3 offset:44032
M v[88:91], a[172:175], a[40:43], v[88:91]
v_exp_f32 v157, v157
M v[88:91], a[176:179], a[44:47], v[88:91]
buffer_load_dwordx4 v1, s[12:15], s43 offen offset:2048 sc1 lds
M v[92:95], a[176:179], a[60:63], 0
v_exp_f32 v158, v158
M v[92:95], a[172:175], a[56:59], v[92:95]
v_cvt_pk_bf16_f32 v141, v142, v143
v_cvt_pk_bf16_f32 v142, v156, v157
M v[92:95], a[168:171], a[52:55], v[92:95]
v_exp_f32 v159, v159
M v[92:95], a[164:167], a[48:51], v[92:95]
buffer_load_dwordx4 v1, s[12:15], s43 offen offset:3072 sc1 lds
v_cvt_pk_bf16_f32 v143, v158, v159
s_waitcnt lgkmcnt(6)
M v[160:163], a[116:119], v[96:99], v[160:163]
v_exp_f32 v32, v32
M v[160:163], a[120:123], v[128:131], v[160:163]
ds_read_b128 a[148:151], v3 offset:36864
ds_read_b128 a[152:155], v3 offset:45056
M v[164:167], a[120:123], v[132:135], v[164:167]
v_exp_f32 v33, v33
M v[164:167], a[116:119], v[100:103], v[164:167]
v_cvt_pk_bf16_f32 v32, v32, v33
M v[168:171], a[116:119], v[104:107], v[168:171]
v_exp_f32 v34, v34
M v[168:171], a[120:123], v[136:139], v[168:171]
s_add_u32 s25, s25, 32768
s_cmp_eq_u32 s25, s27
M v[172:175], a[120:123], v[140:143], v[172:175]
v_exp_f32 v35, v35
M v[172:175], a[116:119], v[108:111], v[172:175]
v_cvt_pk_bf16_f32 v33, v34, v35
s_waitcnt lgkmcnt(6)
M a[96:99], a[112:115], v[96:99], a[96:99]
s_cselect_b32 s25, s28, s25
s_cselect_b32 s27, -1, s27
M a[96:99], a[112:115], v[128:131], a[96:99]
s_add_u32 s26, s26, 32768
s_cmp_eq_u32 s26, s62
M v[176:179], a[124:127], v[96:99], v[176:179]
v_exp_f32 v48, v48
M v[176:179], a[128:131], v[128:131], v[176:179]
ds_read_b128 a[156:159], v3 offset:37888
ds_read_b128 a[160:163], v3 offset:46080
M v[180:183], a[128:131], v[132:135], v[180:183]
v_exp_f32 v49, v49
M v[180:183], a[124:127], v[100:103], v[180:183]
v_cvt_pk_bf16_f32 v34, v48, v49
M v[184:187], a[124:127], v[104:107], v[184:187]
v_exp_f32 v50, v50
M v[184:187], a[128:131], v[136:139], v[184:187]
s_cselect_b32 s26, s63, s26
s_cselect_b32 s62, -1, s62
M v[188:191], a[128:131], v[140:143], v[188:191]
v_exp_f32 v51, v51
M v[188:191], a[124:127], v[108:111], v[188:191]
v_cvt_pk_bf16_f32 v35, v50, v51
s_waitcnt lgkmcnt(6)
M a[100:103], a[112:115], v[100:103], a[100:103]
M a[100:103], a[112:115], v[132:135], a[100:103]
M v[192:195], a[132:135], v[96:99], v[192:195]
v_exp_f32 v36, v36
M v[192:195], a[136:139], v[128:131], v[192:195]
ds_read_b128 a[164:167], v3 offset:38912
ds_read_b128 a[168:171], v3 offset:47104
M v[196:199], a[136:139], v[132:135], v[196:199]
v_exp_f32 v37, v37
M v[196:199], a[132:135], v[100:103], v[196:199]
v_cvt_pk_bf16_f32 v36, v36, v37
M v[200:203], a[132:135], v[104:107], v[200:203]
v_exp_f32 v38, v38
M v[200:203], a[136:139], v[136:139], v[200:203]
M v[204:207], a[136:139], v[140:143], v[204:207]
v_exp_f32 v39, v39
M v[204:207], a[132:135], v[108:111], v[204:207]
v_cvt_pk_bf16_f32 v37, v38, v39
s_waitcnt lgkmcnt(6)
M a[104:107], a[112:115], v[104:107], a[104:107]
M a[104:107], a[112:115], v[136:139], a[104:107]
M v[208:211], a[140:143], v[96:99], v[208:211]
v_exp_f32 v52, v52
M v[208:211], a[144:147], v[128:131], v[208:211]
ds_read_b128 a[172:175], v3 offset:39936
ds_read_b128 a[176:179], v3 offset:48128
M v[212:215], a[144:147], v[132:135], v[212:215]
v_exp_f32 v53, v53
M v[212:215], a[140:143], v[100:103], v[212:215]
v_cvt_pk_bf16_f32 v38, v52, v53
M v[216:219], a[140:143], v[104:107], v[216:219]
v_exp_f32 v54, v54
M v[216:219], a[144:147], v[136:139], v[216:219]
M v[220:223], a[144:147], v[140:143], v[220:223]
v_exp_f32 v55, v55
M v[220:223], a[140:143], v[108:111], v[220:223]
v_cvt_pk_bf16_f32 v39, v54, v55
s_waitcnt lgkmcnt(6)
M a[108:111], a[112:115], v[108:111], a[108:111]
M a[108:111], a[112:115], v[140:143], a[108:111]
M v[224:227], a[148:151], v[96:99], v[224:227]
v_exp_f32 v40, v40
M v[224:227], a[152:155], v[128:131], v[224:227]
M v[228:231], a[152:155], v[132:135], v[228:231]
v_exp_f32 v41, v41
M v[228:231], a[148:151], v[100:103], v[228:231]
v_cvt_pk_bf16_f32 v40, v40, v41
M v[232:235], a[148:151], v[104:107], v[232:235]
v_exp_f32 v42, v42
M v[232:235], a[152:155], v[136:139], v[232:235]
M v[236:239], a[152:155], v[140:143], v[236:239]
v_exp_f32 v43, v43
M v[236:239], a[148:151], v[108:111], v[236:239]
v_cvt_pk_bf16_f32 v41, v42, v43
s_waitcnt lgkmcnt(4)
M v[240:243], a[156:159], v[96:99], v[240:243]
v_exp_f32 v56, v56
M v[240:243], a[160:163], v[128:131], v[240:243]
M v[244:247], a[160:163], v[132:135], v[244:247]
v_exp_f32 v57, v57
M v[244:247], a[156:159], v[100:103], v[244:247]
v_cvt_pk_bf16_f32 v42, v56, v57
M v[248:251], a[156:159], v[104:107], v[248:251]
v_exp_f32 v58, v58
M v[248:251], a[160:163], v[136:139], v[248:251]
s_waitcnt vmcnt(0) lgkmcnt(0)
s_barrier
ds_read_b128 a[116:119], v2 offset:0
ds_read_b128 a[120:123], v2 offset:1024
M v[252:255], a[160:163], v[140:143], v[252:255]
v_exp_f32 v59, v59
M v[252:255], a[156:159], v[108:111], v[252:255]
v_cvt_pk_bf16_f32 v43, v58, v59
M a[64:67], a[164:167], v[96:99], a[64:67]
v_exp_f32 v44, v44
M a[64:67], a[168:171], v[128:131], a[64:67]
ds_read_b128 a[124:127], v2 offset:2048
ds_read_b128 a[128:131], v2 offset:3072
M a[68:71], a[168:171], v[132:135], a[68:71]
v_exp_f32 v45, v45
M a[68:71], a[164:167], v[100:103], a[68:71]
v_cvt_pk_bf16_f32 v44, v44, v45
M a[72:75], a[164:167], v[104:107], a[72:75]
v_exp_f32 v46, v46
M a[72:75], a[168:171], v[136:139], a[72:75]
ds_read_b128 a[132:135], v2 offset:4096
ds_read_b128 a[136:139], v2 offset:5120
M a[76:79], a[168:171], v[140:143], a[76:79]
v_exp_f32 v47, v47
M a[76:79], a[164:167], v[108:111], a[76:79]
v_cvt_pk_bf16_f32 v45, v46, v47
M a[80:83], a[172:175], v[96:99], a[80:83]
v_exp_f32 v60, v60
M a[80:83], a[176:179], v[128:131], a[80:83]
ds_read_b128 a[140:143], v2 offset:6144
ds_read_b128 a[144:147], v2 offset:7168
M a[84:87], a[176:179], v[132:135], a[84:87]
v_exp_f32 v61, v61
M a[84:87], a[172:175], v[100:103], a[84:87]
v_cvt_pk_bf16_f32 v46, v60, v61
M a[88:91], a[172:175], v[104:107], a[88:91]
v_exp_f32 v62, v62
M a[88:91], a[176:179], v[136:139], a[88:91]
M a[92:95], a[176:179], v[140:143], a[92:95]
v_exp_f32 v63, v63
M a[92:95], a[172:175], v[108:111], a[92:95]
v_cvt_pk_bf16_f32 v47, v62, v63
s_sub_u32 s30, s30, 1
s_cmp_lg_u32 s30, 0
s_cbranch_scc1 Lk2_l3
s_lshl_b32 s33, s23, 6
s_add_i32 s33, s33, 0
s_cmp_gt_i32 s33, 0
s_cselect_b32 s34, 0, 0xf149f2ca
s_cmp_lt_i32 s33, 0
s_cselect_b32 s33, 0xf149f2ca, 0
v_mov_b32 v20, s34
v_mov_b32 v21, s34
v_mov_b32 v22, s34
v_mov_b32 v23, s34
v_mov_b32 v28, s33
v_mov_b32 v29, s33
v_mov_b32 v30, s33
v_mov_b32 v31, s33
v_med3_f32 v24, v16, v20, v28
v_med3_f32 v25, v17, v20, v28
v_med3_f32 v26, v18, v20, v28
v_med3_f32 v27, v19, v20, v28
s_add_u32 m0, s29, 65536
s_waitcnt lgkmcnt(4)
M v[96:99], a[116:119], a[0:3], v[24:27]
v_exp_f32 v64, v64
M v[96:99], a[120:123], a[4:7], v[96:99]
ds_read_b128 a[148:151], v2 offset:8192
ds_read_b128 a[152:155], v2 offset:9216
M v[96:99], a[124:127], a[8:11], v[96:99]
v_exp_f32 v65, v65
M v[96:99], a[128:131], a[12:15], v[96:99]
buffer_load_dwordx4 v1, s[12:15], s25 offen offset:0 sc1 lds
s_add_u32 s32, s25, 4096
M v[100:103], a[128:131], a[28:31], v[28:31]
v_exp_f32 v66, v66
M v[100:103], a[124:127], a[24:27], v[100:103]
v_cvt_pk_bf16_f32 v64, v64, v65
M v[100:103], a[120:123], a[20:23], v[100:103]
v_exp_f32 v67, v67
M v[100:103], a[116:119], a[16:19], v[100:103]
buffer_load_dwordx4 v1, s[12:15], s25 offen offset:1024 sc1 lds
M v[104:107], a[116:119], a[32:35], v[28:31]
v_exp_f32 v80, v80
M v[104:107], a[120:123], a[36:39], v[104:107]
ds_read_b128 a[156:159], v2 offset:10240
ds_read_b128 a[160:163], v2 offset:11264
M v[104:107], a[124:127], a[40:43], v[104:107]
v_exp_f32 v81, v81
M v[104:107], a[128:131], a[44:47], v[104:107]
buffer_load_dwordx4 v1, s[12:15], s25 offen offset:2048 sc1 lds
M v[108:111], a[128:131], a[60:63], v[28:31]
v_exp_f32 v82, v82
M v[108:111], a[124:127], a[56:59], v[108:111]
v_cvt_pk_bf16_f32 v65, v66, v67
v_cvt_pk_bf16_f32 v66, v80, v81
M v[108:111], a[120:123], a[52:55], v[108:111]
v_exp_f32 v83, v83
M v[108:111], a[116:119], a[48:51], v[108:111]
buffer_load_dwordx4 v1, s[12:15], s25 offen offset:3072 sc1 lds
s_add_u32 m0, s29, 69632
s_waitcnt lgkmcnt(4)
M v[112:115], a[132:135], a[0:3], v[20:23]
v_exp_f32 v68, v68
M v[112:115], a[136:139], a[4:7], v[112:115]
ds_read_b128 a[164:167], v2 offset:12288
ds_read_b128 a[168:171], v2 offset:13312
M v[112:115], a[140:143], a[8:11], v[112:115]
v_exp_f32 v69, v69
M v[112:115], a[144:147], a[12:15], v[112:115]
buffer_load_dwordx4 v1, s[12:15], s32 offen offset:0 sc1 lds
M v[116:119], a[144:147], a[28:31], v[24:27]
v_exp_f32 v70, v70
M v[116:119], a[140:143], a[24:27], v[116:119]
v_cvt_pk_bf16_f32 v67, v82, v83
v_cvt_pk_bf16_f32 v68, v68, v69
M v[116:119], a[136:139], a[20:23], v[116:119]
v_exp_f32 v71, v71
M v[116:119], a[132:135], a[16:19], v[116:119]
buffer_load_dwordx4 v1, s[12:15], s32 offen offset:1024 sc1 lds
M v[120:123], a[132:135], a[32:35], v[28:31]
v_exp_f32 v84, v84
M v[120:123], a[136:139], a[36:39], v[120:123]
ds_read_b128 a[172:175], v2 offset:14336
ds_read_b128 a[176:179], v2 offset:15360
M v[120:123], a[140:143], a[40:43], v[120:123]
v_exp_f32 v85, v85
M v[120:123], a[144:147], a[44:47], v[120:123]
buffer_load_dwordx4 v1, s[12:15], s32 offen offset:2048 sc1 lds
M v[124:127], a[144:147], a[60:63], v[28:31]
v_exp_f32 v86, v86
M v[124:127], a[140:143], a[56:59], v[124:127]
v_cvt_pk_bf16_f32 v69, v70, v71
v_cvt_pk_bf16_f32 v70, v84, v85
M v[124:127], a[136:139], a[52:55], v[124:127]
v_exp_f32 v87, v87
M v[124:127], a[132:135], a[48:51], v[124:127]
buffer_load_dwordx4 v1, s[12:15], s32 offen offset:3072 sc1 lds
s_add_u32 m0, s29, 98304
s_waitcnt lgkmcnt(4)
M v[128:131], a[148:151], a[0:3], v[20:23]
v_exp_f32 v72, v72
M v[128:131], a[152:155], a[4:7], v[128:131]
ds_read_b128 a[116:119], v2 offset:32768
ds_read_b128 a[120:123], v2 offset:40960
M v[128:131], a[156:159], a[8:11], v[128:131]
v_exp_f32 v73, v73
M v[128:131], a[160:163], a[12:15], v[128:131]
buffer_load_dwordx4 v1, s[12:15], s26 offen offset:0 sc1 lds
s_add_u32 s43, s26, 4096
M v[132:135], a[160:163], a[28:31], v[20:23]
v_exp_f32 v74, v74
M v[132:135], a[156:159], a[24:27], v[132:135]
v_cvt_pk_bf16_f32 v71, v86, v87
v_cvt_pk_bf16_f32 v72, v72, v73
M v[132:135], a[152:155], a[20:23], v[132:135]
v_exp_f32 v75, v75
M v[132:135], a[148:151], a[16:19], v[132:135]
buffer_load_dwordx4 v1, s[12:15], s26 offen offset:1024 sc1 lds
M v[136:139], a[148:151], a[32:35], v[24:27]
v_exp_f32 v88, v88
M v[136:139], a[152:155], a[36:39], v[136:139]
ds_read_b128 a[124:127], v2 offset:33792
ds_read_b128 a[128:131], v2 offset:41984
M v[136:139], a[156:159], a[40:43], v[136:139]
v_exp_f32 v89, v89
M v[136:139], a[160:163], a[44:47], v[136:139]
buffer_load_dwordx4 v1, s[12:15], s26 offen offset:2048 sc1 lds
M v[140:143], a[160:163], a[60:63], v[28:31]
v_exp_f32 v90, v90
M v[140:143], a[156:159], a[56:59], v[140:143]
v_cvt_pk_bf16_f32 v73, v74, v75
v_cvt_pk_bf16_f32 v74, v88, v89
M v[140:143], a[152:155], a[52:55], v[140:143]
v_exp_f32 v91, v91
M v[140:143], a[148:151], a[48:51], v[140:143]
buffer_load_dwordx4 v1, s[12:15], s26 offen offset:3072 sc1 lds
s_add_u32 m0, s29, 102400
s_waitcnt lgkmcnt(4)
M v[144:147], a[164:167], a[0:3], v[20:23]
v_exp_f32 v76, v76
M v[144:147], a[168:171], a[4:7], v[144:147]
ds_read_b128 a[132:135], v2 offset:34816
ds_read_b128 a[136:139], v2 offset:43008
M v[144:147], a[172:175], a[8:11], v[144:147]
v_exp_f32 v77, v77
M v[144:147], a[176:179], a[12:15], v[144:147]
buffer_load_dwordx4 v1, s[12:15], s43 offen offset:0 sc1 lds
M v[148:151], a[176:179], a[28:31], v[20:23]
v_exp_f32 v78, v78
M v[148:151], a[172:175], a[24:27], v[148:151]
v_cvt_pk_bf16_f32 v75, v90, v91
v_cvt_pk_bf16_f32 v76, v76, v77
M v[148:151], a[168:171], a[20:23], v[148:151]
v_exp_f32 v79, v79
M v[148:151], a[164:167], a[16:19], v[148:151]
buffer_load_dwordx4 v1, s[12:15], s43 offen offset:1024 sc1 lds
M v[152:155], a[164:167], a[32:35], v[20:23]
v_exp_f32 v92, v92
M v[152:155], a[168:171], a[36:39], v[152:155]
ds_read_b128 a[140:143], v2 offset:35840
ds_read_b128 a[144:147], v2 offset:44032
M v[152:155], a[172:175], a[40:43], v[152:155]
v_exp_f32 v93, v93
M v[152:155], a[176:179], a[44:47], v[152:155]
buffer_load_dwordx4 v1, s[12:15], s43 offen offset:2048 sc1 lds
M v[156:159], a[176:179], a[60:63], v[24:27]
v_exp_f32 v94, v94
M v[156:159], a[172:175], a[56:59], v[156:159]
v_cvt_pk_bf16_f32 v77, v78, v79
v_cvt_pk_bf16_f32 v78, v92, v93
M v[156:159], a[168:171], a[52:55], v[156:159]
v_exp_f32 v95, v95
M v[156:159], a[164:167], a[48:51], v[156:159]
buffer_load_dwordx4 v1, s[12:15], s43 offen offset:3072 sc1 lds
v_cvt_pk_bf16_f32 v79, v94, v95
s_waitcnt lgkmcnt(6)
M v[160:163], a[116:119], v[32:35], v[160:163]
v_exp_f32 v96, v96
M v[160:163], a[120:123], v[64:67], v[160:163]
ds_read_b128 a[148:151], v2 offset:36864
ds_read_b128 a[152:155], v2 offset:45056
M v[164:167], a[120:123], v[68:71], v[164:167]
v_exp_f32 v97, v97
M v[164:167], a[116:119], v[36:39], v[164:167]
v_cvt_pk_bf16_f32 v96, v96, v97
M v[168:171], a[116:119], v[40:43], v[168:171]
v_exp_f32 v98, v98
M v[168:171], a[120:123], v[72:75], v[168:171]
s_add_u32 s25, s25, 32768
s_cmp_eq_u32 s25, s27
M v[172:175], a[120:123], v[76:79], v[172:175]
v_exp_f32 v99, v99
M v[172:175], a[116:119], v[44:47], v[172:175]
v_cvt_pk_bf16_f32 v97, v98, v99
s_waitcnt lgkmcnt(6)
M a[96:99], a[112:115], v[32:35], a[96:99]
s_cselect_b32 s25, s28, s25
s_cselect_b32 s27, -1, s27
M a[96:99], a[112:115], v[64:67], a[96:99]
s_add_u32 s26, s26, 32768
s_cmp_eq_u32 s26, s62
M v[176:179], a[124:127], v[32:35], v[176:179]
v_exp_f32 v112, v112
M v[176:179], a[128:131], v[64:67], v[176:179]
ds_read_b128 a[156:159], v2 offset:37888
ds_read_b128 a[160:163], v2 offset:46080
M v[180:183], a[128:131], v[68:71], v[180:183]
v_exp_f32 v113, v113
M v[180:183], a[124:127], v[36:39], v[180:183]
v_cvt_pk_bf16_f32 v98, v112, v113
M v[184:187], a[124:127], v[40:43], v[184:187]
v_exp_f32 v114, v114
M v[184:187], a[128:131], v[72:75], v[184:187]
s_cselect_b32 s26, s63, s26
s_cselect_b32 s62, -1, s62
M v[188:191], a[128:131], v[76:79], v[188:191]
v_exp_f32 v115, v115
M v[188:191], a[124:127], v[44:47], v[188:191]
v_cvt_pk_bf16_f32 v99, v114, v115
s_waitcnt lgkmcnt(6)
M a[100:103], a[112:115], v[36:39], a[100:103]
M a[100:103], a[112:115], v[68:71], a[100:103]
M v[192:195], a[132:135], v[32:35], v[192:195]
v_exp_f32 v100, v100
M v[192:195], a[136:139], v[64:67], v[192:195]
ds_read_b128 a[164:167], v2 offset:38912
ds_read_b128 a[168:171], v2 offset:47104
M v[196:199], a[136:139], v[68:71], v[196:199]
v_exp_f32 v101, v101
M v[196:199], a[132:135], v[36:39], v[196:199]
v_cvt_pk_bf16_f32 v100, v100, v101
M v[200:203], a[132:135], v[40:43], v[200:203]
v_exp_f32 v102, v102
M v[200:203], a[136:139], v[72:75], v[200:203]
M v[204:207], a[136:139], v[76:79], v[204:207]
v_exp_f32 v103, v103
M v[204:207], a[132:135], v[44:47], v[204:207]
v_cvt_pk_bf16_f32 v101, v102, v103
s_waitcnt lgkmcnt(6)
M a[104:107], a[112:115], v[40:43], a[104:107]
M a[104:107], a[112:115], v[72:75], a[104:107]
M v[208:211], a[140:143], v[32:35], v[208:211]
v_exp_f32 v116, v116
M v[208:211], a[144:147], v[64:67], v[208:211]
ds_read_b128 a[172:175], v2 offset:39936
ds_read_b128 a[176:179], v2 offset:48128
M v[212:215], a[144:147], v[68:71], v[212:215]
v_exp_f32 v117, v117
M v[212:215], a[140:143], v[36:39], v[212:215]
v_cvt_pk_bf16_f32 v102, v116, v117
M v[216:219], a[140:143], v[40:43], v[216:219]
v_exp_f32 v118, v118
M v[216:219], a[144:147], v[72:75], v[216:219]
M v[220:223], a[144:147], v[76:79], v[220:223]
v_exp_f32 v119, v119
M v[220:223], a[140:143], v[44:47], v[220:223]
v_cvt_pk_bf16_f32 v103, v118, v119
s_waitcnt lgkmcnt(6)
M a[108:111], a[112:115], v[44:47], a[108:111]
M a[108:111], a[112:115], v[76:79], a[108:111]
M v[224:227], a[148:151], v[32:35], v[224:227]
v_exp_f32 v104, v104
M v[224:227], a[152:155], v[64:67], v[224:227]
M v[228:231], a[152:155], v[68:71], v[228:231]
v_exp_f32 v105, v105
M v[228:231], a[148:151], v[36:39], v[228:231]
v_cvt_pk_bf16_f32 v104, v104, v105
M v[232:235], a[148:151], v[40:43], v[232:235]
v_exp_f32 v106, v106
M v[232:235], a[152:155], v[72:75], v[232:235]
M v[236:239], a[152:155], v[76:79], v[236:239]
v_exp_f32 v107, v107
M v[236:239], a[148:151], v[44:47], v[236:239]
v_cvt_pk_bf16_f32 v105, v106, v107
s_waitcnt lgkmcnt(4)
M v[240:243], a[156:159], v[32:35], v[240:243]
v_exp_f32 v120, v120
M v[240:243], a[160:163], v[64:67], v[240:243]
M v[244:247], a[160:163], v[68:71], v[244:247]
v_exp_f32 v121, v121
M v[244:247], a[156:159], v[36:39], v[244:247]
v_cvt_pk_bf16_f32 v106, v120, v121
M v[248:251], a[156:159], v[40:43], v[248:251]
v_exp_f32 v122, v122
M v[248:251], a[160:163], v[72:75], v[248:251]
s_waitcnt vmcnt(0) lgkmcnt(0)
s_barrier
ds_read_b128 a[116:119], v3 offset:0
ds_read_b128 a[120:123], v3 offset:1024
M v[252:255], a[160:163], v[76:79], v[252:255]
v_exp_f32 v123, v123
M v[252:255], a[156:159], v[44:47], v[252:255]
v_cvt_pk_bf16_f32 v107, v122, v123
M a[64:67], a[164:167], v[32:35], a[64:67]
v_exp_f32 v108, v108
M a[64:67], a[168:171], v[64:67], a[64:67]
ds_read_b128 a[124:127], v3 offset:2048
ds_read_b128 a[128:131], v3 offset:3072
M a[68:71], a[168:171], v[68:71], a[68:71]
v_exp_f32 v109, v109
M a[68:71], a[164:167], v[36:39], a[68:71]
v_cvt_pk_bf16_f32 v108, v108, v109
M a[72:75], a[164:167], v[40:43], a[72:75]
v_exp_f32 v110, v110
M a[72:75], a[168:171], v[72:75], a[72:75]
ds_read_b128 a[132:135], v3 offset:4096
ds_read_b128 a[136:139], v3 offset:5120
M a[76:79], a[168:171], v[76:79], a[76:79]
v_exp_f32 v111, v111
M a[76:79], a[164:167], v[44:47], a[76:79]
v_cvt_pk_bf16_f32 v109, v110, v111
M a[80:83], a[172:175], v[32:35], a[80:83]
v_exp_f32 v124, v124
M a[80:83], a[176:179], v[64:67], a[80:83]
ds_read_b128 a[140:143], v3 offset:6144
ds_read_b128 a[144:147], v3 offset:7168
M a[84:87], a[176:179], v[68:71], a[84:87]
v_exp_f32 v125, v125
M a[84:87], a[172:175], v[36:39], a[84:87]
v_cvt_pk_bf16_f32 v110, v124, v125
M a[88:91], a[172:175], v[40:43], a[88:91]
v_exp_f32 v126, v126
M a[88:91], a[176:179], v[72:75], a[88:91]
M a[92:95], a[176:179], v[76:79], a[92:95]
v_exp_f32 v127, v127
M a[92:95], a[172:175], v[44:47], a[92:95]
v_cvt_pk_bf16_f32 v111, v126, v127
s_lshl_b32 s33, s23, 6
s_add_i32 s33, s33, -64
s_cmp_gt_i32 s33, 0
s_cselect_b32 s34, 0, 0xf149f2ca
s_cmp_lt_i32 s33, 0
s_cselect_b32 s33, 0xf149f2ca, 0
v_mov_b32 v20, s34
v_mov_b32 v21, s34
v_mov_b32 v22, s34
v_mov_b32 v23, s34
v_mov_b32 v28, s33
v_mov_b32 v29, s33
v_mov_b32 v30, s33
v_mov_b32 v31, s33
v_med3_f32 v24, v16, v20, v28
v_med3_f32 v25, v17, v20, v28
v_med3_f32 v26, v18, v20, v28
v_med3_f32 v27, v19, v20, v28
s_add_u32 m0, s29, 0
s_waitcnt lgkmcnt(4)
M v[32:35], a[116:119], a[0:3], v[24:27]
v_exp_f32 v128, v128
M v[32:35], a[120:123], a[4:7], v[32:35]
ds_read_b128 a[148:151], v3 offset:8192
ds_read_b128 a[152:155], v3 offset:9216
M v[32:35], a[124:127], a[8:11], v[32:35]
v_exp_f32 v129, v129
M v[32:35], a[128:131], a[12:15], v[32:35]
buffer_load_dwordx4 v1, s[12:15], s25 offen offset:0 sc1 lds
s_add_u32 s32, s25, 4096
M v[36:39], a[128:131], a[28:31], v[28:31]
v_exp_f32 v130, v130
M v[36:39], a[124:127], a[24:27], v[36:39]
v_cvt_pk_bf16_f32 v128, v128, v129
M v[36:39], a[120:123], a[20:23], v[36:39]
v_exp_f32 v131, v131
M v[36:39], a[116:119], a[16:19], v[36:39]
buffer_load_dwordx4 v1, s[12:15], s25 offen offset:1024 sc1 lds
M v[40:43], a[116:119], a[32:35], v[28:31]
v_exp_f32 v144, v144
M v[40:43], a[120:123], a[36:39], v[40:43]
ds_read_b128 a[156:159], v3 offset:10240
ds_read_b128 a[160:163], v3 offset:11264
M v[40:43], a[124:127], a[40:43], v[40:43]
v_exp_f32 v145, v145
M v[40:43], a[128:131], a[44:47], v[40:43]
buffer_load_dwordx4 v1, s[12:15], s25 offen offset:2048 sc1 lds
M v[44:47], a[128:131], a[60:63], v[28:31]
v_exp_f32 v146, v146
M v[44:47], a[124:127], a[56:59], v[44:47]
v_cvt_pk_bf16_f32 v129, v130, v131
v_cvt_pk_bf16_f32 v130, v144, v145
M v[44:47], a[120:123], a[52:55], v[44:47]
v_exp_f32 v147, v147
M v[44:47], a[116:119], a[48:51], v[44:47]
buffer_load_dwordx4 v1, s[12:15], s25 offen offset:3072 sc1 lds
s_add_u32 m0, s29, 4096
s_waitcnt lgkmcnt(4)
M v[48:51], a[132:135], a[0:3], v[20:23]
v_exp_f32 v132, v132
M v[48:51], a[136:139], a[4:7], v[48:51]
ds_read_b128 a[164:167], v3 offset:12288
ds_read_b128 a[168:171], v3 offset:13312
M v[48:51], a[140:143], a[8:11], v[48:51]
v_exp_f32 v133, v133
M v[48:51], a[144:147], a[12:15], v[48:51]
buffer_load_dwordx4 v1, s[12:15], s32 offen offset:0 sc1 lds
M v[52:55], a[144:147], a[28:31], v[24:27]
v_exp_f32 v134, v134
M v[52:55], a[140:143], a[24:27], v[52:55]
v_cvt_pk_bf16_f32 v131, v146, v147
v_cvt_pk_bf16_f32 v132, v132, v133
M v[52:55], a[136:139], a[20:23], v[52:55]
v_exp_f32 v135, v135
M v[52:55], a[132:135], a[16:19], v[52:55]
buffer_load_dwordx4 v1, s[12:15], s32 offen offset:1024 sc1 lds
M v[56:59], a[132:135], a[32:35], v[28:31]
v_exp_f32 v148, v148
M v[56:59], a[136:139], a[36:39], v[56:59]
ds_read_b128 a[172:175], v3 offset:14336
ds_read_b128 a[176:179], v3 offset:15360
M v[56:59], a[140:143], a[40:43], v[56:59]
v_exp_f32 v149, v149
M v[56:59], a[144:147], a[44:47], v[56:59]
buffer_load_dwordx4 v1, s[12:15], s32 offen offset:2048 sc1 lds
M v[60:63], a[144:147], a[60:63], v[28:31]
v_exp_f32 v150, v150
M v[60:63], a[140:143], a[56:59], v[60:63]
v_cvt_pk_bf16_f32 v133, v134, v135
v_cvt_pk_bf16_f32 v134, v148, v149
M v[60:63], a[136:139], a[52:55], v[60:63]
v_exp_f32 v151, v151
M v[60:63], a[132:135], a[48:51], v[60:63]
buffer_load_dwordx4 v1, s[12:15], s32 offen offset:3072 sc1 lds
s_add_u32 m0, s29, 32768
s_waitcnt lgkmcnt(4)
M v[64:67], a[148:151], a[0:3], v[20:23]
v_exp_f32 v136, v136
M v[64:67], a[152:155], a[4:7], v[64:67]
ds_read_b128 a[116:119], v3 offset:32768
ds_read_b128 a[120:123], v3 offset:40960
M v[64:67], a[156:159], a[8:11], v[64:67]
v_exp_f32 v137, v137
M v[64:67], a[160:163], a[12:15], v[64:67]
buffer_load_dwordx4 v1, s[12:15], s26 offen offset:0 sc1 lds
s_add_u32 s43, s26, 4096
M v[68:71], a[160:163], a[28:31], v[20:23]
v_exp_f32 v138, v138
M v[68:71], a[156:159], a[24:27], v[68:71]
v_cvt_pk_bf16_f32 v135, v150, v151
v_cvt_pk_bf16_f32 v136, v136, v137
M v[68:71], a[152:155], a[20:23], v[68:71]
v_exp_f32 v139, v139
M v[68:71], a[148:151], a[16:19], v[68:71]
buffer_load_dwordx4 v1, s[12:15], s26 offen offset:1024 sc1 lds
M v[72:75], a[148:151], a[32:35], v[24:27]
v_exp_f32 v152, v152
M v[72:75], a[152:155], a[36:39], v[72:75]
ds_read_b128 a[124:127], v3 offset:33792
ds_read_b128 a[128:131], v3 offset:41984
M v[72:75], a[156:159], a[40:43], v[72:75]
v_exp_f32 v153, v153
M v[72:75], a[160:163], a[44:47], v[72:75]
buffer_load_dwordx4 v1, s[12:15], s26 offen offset:2048 sc1 lds
M v[76:79], a[160:163], a[60:63], v[28:31]
v_exp_f32 v154, v154
M v[76:79], a[156:159], a[56:59], v[76:79]
v_cvt_pk_bf16_f32 v137, v138, v139
v_cvt_pk_bf16_f32 v138, v152, v153
M v[76:79], a[152:155], a[52:55], v[76:79]
v_exp_f32 v155, v155
M v[76:79], a[148:151], a[48:51], v[76:79]
buffer_load_dwordx4 v1, s[12:15], s26 offen offset:3072 sc1 lds
s_add_u32 m0, s29, 36864
s_waitcnt lgkmcnt(4)
M v[80:83], a[164:167], a[0:3], v[20:23]
v_exp_f32 v140, v140
M v[80:83], a[168:171], a[4:7], v[80:83]
ds_read_b128 a[132:135], v3 offset:34816
ds_read_b128 a[136:139], v3 offset:43008
M v[80:83], a[172:175], a[8:11], v[80:83]
v_exp_f32 v141, v141
M v[80:83], a[176:179], a[12:15], v[80:83]
buffer_load_dwordx4 v1, s[12:15], s43 offen offset:0 sc1 lds
M v[84:87], a[176:179], a[28:31], v[20:23]
v_exp_f32 v142, v142
M v[84:87], a[172:175], a[24:27], v[84:87]
v_cvt_pk_bf16_f32 v139, v154, v155
v_cvt_pk_bf16_f32 v140, v140, v141
M v[84:87], a[168:171], a[20:23], v[84:87]
v_exp_f32 v143, v143
M v[84:87], a[164:167], a[16:19], v[84:87]
buffer_load_dwordx4 v1, s[12:15], s43 offen offset:1024 sc1 lds
M v[88:91], a[164:167], a[32:35], v[20:23]
v_exp_f32 v156, v156
M v[88:91], a[168:171], a[36:39], v[88:91]
ds_read_b128 a[140:143], v3 offset:35840
ds_read_b128 a[144:147], v3 offset:44032
M v[88:91], a[172:175], a[40:43], v[88:91]
v_exp_f32 v157, v157
M v[88:91], a[176:179], a[44:47], v[88:91]
buffer_load_dwordx4 v1, s[12:15], s43 offen offset:2048 sc1 lds
M v[92:95], a[176:179], a[60:63], v[24:27]
v_exp_f32 v158, v158
M v[92:95], a[172:175], a[56:59], v[92:95]
v_cvt_pk_bf16_f32 v141, v142, v143
v_cvt_pk_bf16_f32 v142, v156, v157
M v[92:95], a[168:171], a[52:55], v[92:95]
v_exp_f32 v159, v159
M v[92:95], a[164:167], a[48:51], v[92:95]
buffer_load_dwordx4 v1, s[12:15], s43 offen offset:3072 sc1 lds
v_cvt_pk_bf16_f32 v143, v158, v159
s_waitcnt lgkmcnt(6)
M v[160:163], a[116:119], v[96:99], v[160:163]
v_exp_f32 v32, v32
M v[160:163], a[120:123], v[128:131], v[160:163]
ds_read_b128 a[148:151], v3 offset:36864
ds_read_b128 a[152:155], v3 offset:45056
M v[164:167], a[120:123], v[132:135], v[164:167]
v_exp_f32 v33, v33
M v[164:167], a[116:119], v[100:103], v[164:167]
v_cvt_pk_bf16_f32 v32, v32, v33
M v[168:171], a[116:119], v[104:107], v[168:171]
v_exp_f32 v34, v34
M v[168:171], a[120:123], v[136:139], v[168:171]
s_add_u32 s25, s25, 32768
s_cmp_eq_u32 s25, s27
M v[172:175], a[120:123], v[140:143], v[172:175]
v_exp_f32 v35, v35
M v[172:175], a[116:119], v[108:111], v[172:175]
v_cvt_pk_bf16_f32 v33, v34, v35
s_waitcnt lgkmcnt(6)
M a[96:99], a[112:115], v[96:99], a[96:99]
s_cselect_b32 s25, s28, s25
s_cselect_b32 s27, -1, s27
M a[96:99], a[112:115], v[128:131], a[96:99]
s_add_u32 s26, s26, 32768
s_cmp_eq_u32 s26, s62
M v[176:179], a[124:127], v[96:99], v[176:179]
v_exp_f32 v48, v48
M v[176:179], a[128:131], v[128:131], v[176:179]
ds_read_b128 a[156:159], v3 offset:37888
ds_read_b128 a[160:163], v3 offset:46080
M v[180:183], a[128:131], v[132:135], v[180:183]
v_exp_f32 v49, v49
M v[180:183], a[124:127], v[100:103], v[180:183]
v_cvt_pk_bf16_f32 v34, v48, v49
M v[184:187], a[124:127], v[104:107], v[184:187]
v_exp_f32 v50, v50
M v[184:187], a[128:131], v[136:139], v[184:187]
s_cselect_b32 s26, s63, s26
s_cselect_b32 s62, -1, s62
M v[188:191], a[128:131], v[140:143], v[188:191]
v_exp_f32 v51, v51
M v[188:191], a[124:127], v[108:111], v[188:191]
v_cvt_pk_bf16_f32 v35, v50, v51
s_waitcnt lgkmcnt(6)
M a[100:103], a[112:115], v[100:103], a[100:103]
M a[100:103], a[112:115], v[132:135], a[100:103]
M v[192:195], a[132:135], v[96:99], v[192:195]
v_exp_f32 v36, v36
M v[192:195], a[136:139], v[128:131], v[192:195]
ds_read_b128 a[164:167], v3 offset:38912
ds_read_b128 a[168:171], v3 offset:47104
M v[196:199], a[136:139], v[132:135], v[196:199]
v_exp_f32 v37, v37
M v[196:199], a[132:135], v[100:103], v[196:199]
v_cvt_pk_bf16_f32 v36, v36, v37
M v[200:203], a[132:135], v[104:107], v[200:203]
v_exp_f32 v38, v38
M v[200:203], a[136:139], v[136:139], v[200:203]
M v[204:207], a[136:139], v[140:143], v[204:207]
v_exp_f32 v39, v39
M v[204:207], a[132:135], v[108:111], v[204:207]
v_cvt_pk_bf16_f32 v37, v38, v39
s_waitcnt lgkmcnt(6)
M a[104:107], a[112:115], v[104:107], a[104:107]
M a[104:107], a[112:115], v[136:139], a[104:107]
M v[208:211], a[140:143], v[96:99], v[208:211]
v_exp_f32 v52, v52
M v[208:211], a[144:147], v[128:131], v[208:211]
ds_read_b128 a[172:175], v3 offset:39936
ds_read_b128 a[176:179], v3 offset:48128
M v[212:215], a[144:147], v[132:135], v[212:215]
v_exp_f32 v53, v53
M v[212:215], a[140:143], v[100:103], v[212:215]
v_cvt_pk_bf16_f32 v38, v52, v53
M v[216:219], a[140:143], v[104:107], v[216:219]
v_exp_f32 v54, v54
M v[216:219], a[144:147], v[136:139], v[216:219]
M v[220:223], a[144:147], v[140:143], v[220:223]
v_exp_f32 v55, v55
M v[220:223], a[140:143], v[108:111], v[220:223]
v_cvt_pk_bf16_f32 v39, v54, v55
s_waitcnt lgkmcnt(6)
M a[108:111], a[112:115], v[108:111], a[108:111]
M a[108:111], a[112:115], v[140:143], a[108:111]
M v[224:227], a[148:151], v[96:99], v[224:227]
v_exp_f32 v40, v40
M v[224:227], a[152:155], v[128:131], v[224:227]
M v[228:231], a[152:155], v[132:135], v[228:231]
v_exp_f32 v41, v41
M v[228:231], a[148:151], v[100:103], v[228:231]
v_cvt_pk_bf16_f32 v40, v40, v41
M v[232:235], a[148:151], v[104:107], v[232:235]
v_exp_f32 v42, v42
M v[232:235], a[152:155], v[136:139], v[232:235]
M v[236:239], a[152:155], v[140:143], v[236:239]
v_exp_f32 v43, v43
M v[236:239], a[148:151], v[108:111], v[236:239]
v_cvt_pk_bf16_f32 v41, v42, v43
s_waitcnt lgkmcnt(4)
M v[240:243], a[156:159], v[96:99], v[240:243]
v_exp_f32 v56, v56
M v[240:243], a[160:163], v[128:131], v[240:243]
M v[244:247], a[160:163], v[132:135], v[244:247]
v_exp_f32 v57, v57
M v[244:247], a[156:159], v[100:103], v[244:247]
v_cvt_pk_bf16_f32 v42, v56, v57
M v[248:251], a[156:159], v[104:107], v[248:251]
v_exp_f32 v58, v58
M v[248:251], a[160:163], v[136:139], v[248:251]
s_waitcnt vmcnt(0) lgkmcnt(0)
s_barrier
ds_read_b128 a[116:119], v2 offset:0
ds_read_b128 a[120:123], v2 offset:1024
M v[252:255], a[160:163], v[140:143], v[252:255]
v_exp_f32 v59, v59
M v[252:255], a[156:159], v[108:111], v[252:255]
v_cvt_pk_bf16_f32 v43, v58, v59
M a[64:67], a[164:167], v[96:99], a[64:67]
v_exp_f32 v44, v44
M a[64:67], a[168:171], v[128:131], a[64:67]
ds_read_b128 a[124:127], v2 offset:2048
ds_read_b128 a[128:131], v2 offset:3072
M a[68:71], a[168:171], v[132:135], a[68:71]
v_exp_f32 v45, v45
M a[68:71], a[164:167], v[100:103], a[68:71]
v_cvt_pk_bf16_f32 v44, v44, v45
M a[72:75], a[164:167], v[104:107], a[72:75]
v_exp_f32 v46, v46
M a[72:75], a[168:171], v[136:139], a[72:75]
ds_read_b128 a[132:135], v2 offset:4096
ds_read_b128 a[136:139], v2 offset:5120
M a[76:79], a[168:171], v[140:143], a[76:79]
v_exp_f32 v47, v47
M a[76:79], a[164:167], v[108:111], a[76:79]
v_cvt_pk_bf16_f32 v45, v46, v47
M a[80:83], a[172:175], v[96:99], a[80:83]
v_exp_f32 v60, v60
M a[80:83], a[176:179], v[128:131], a[80:83]
ds_read_b128 a[140:143], v2 offset:6144
ds_read_b128 a[144:147], v2 offset:7168
M a[84:87], a[176:179], v[132:135], a[84:87]
v_exp_f32 v61, v61
M a[84:87], a[172:175], v[100:103], a[84:87]
v_cvt_pk_bf16_f32 v46, v60, v61
M a[88:91], a[172:175], v[104:107], a[88:91]
v_exp_f32 v62, v62
M a[88:91], a[176:179], v[136:139], a[88:91]
M a[92:95], a[176:179], v[140:143], a[92:95]
v_exp_f32 v63, v63
M a[92:95], a[172:175], v[108:111], a[92:95]
v_cvt_pk_bf16_f32 v47, v62, v63
s_waitcnt lgkmcnt(0)
Lk2_fin:
s_and_b32 s3, s2, 3
s_lshl_b32 s3, s3, 2
s_bfe_u32 s27, s2, 0x20003
s_add_u32 s27, s3, s27
s_lshl_b32 s43, s27, 8
s_add_u32 s43, s43, 8400896
v_lshlrev_b32 v15, 2, v0
buffer_load_dword v7, v15, s[52:55], s43 offen sc1
ds_read_b128 a[116:119], v2 offset:32768
ds_read_b128 a[120:123], v2 offset:40960
ds_read_b128 a[124:127], v2 offset:33792
ds_read_b128 a[128:131], v2 offset:41984
ds_read_b128 a[132:135], v2 offset:34816
ds_read_b128 a[136:139], v2 offset:43008
ds_read_b128 a[140:143], v2 offset:35840
ds_read_b128 a[144:147], v2 offset:44032
v_exp_f32 v64, v64
v_exp_f32 v65, v65
v_exp_f32 v66, v66
v_exp_f32 v67, v67
v_exp_f32 v80, v80
v_exp_f32 v81, v81
v_exp_f32 v82, v82
v_exp_f32 v83, v83
v_cvt_pk_bf16_f32 v64, v64, v65
v_cvt_pk_bf16_f32 v65, v66, v67
v_exp_f32 v68, v68
v_exp_f32 v69, v69
v_exp_f32 v70, v70
v_exp_f32 v71, v71
v_cvt_pk_bf16_f32 v66, v80, v81
v_cvt_pk_bf16_f32 v67, v82, v83
v_exp_f32 v84, v84
v_exp_f32 v85, v85
v_exp_f32 v86, v86
v_exp_f32 v87, v87
v_cvt_pk_bf16_f32 v68, v68, v69
v_cvt_pk_bf16_f32 v69, v70, v71
v_exp_f32 v72, v72
v_exp_f32 v73, v73
v_exp_f32 v74, v74
v_exp_f32 v75, v75
v_cvt_pk_bf16_f32 v70, v84, v85
v_cvt_pk_bf16_f32 v71, v86, v87
v_exp_f32 v88, v88
v_exp_f32 v89, v89
v_exp_f32 v90, v90
v_exp_f32 v91, v91
v_cvt_pk_bf16_f32 v72, v72, v73
v_cvt_pk_bf16_f32 v73, v74, v75
v_exp_f32 v76, v76
v_exp_f32 v77, v77
v_exp_f32 v78, v78
v_exp_f32 v79, v79
v_cvt_pk_bf16_f32 v74, v88, v89
v_cvt_pk_bf16_f32 v75, v90, v91
v_exp_f32 v92, v92
v_exp_f32 v93, v93
v_exp_f32 v94, v94
v_exp_f32 v95, v95
v_cvt_pk_bf16_f32 v76, v76, v77
v_cvt_pk_bf16_f32 v77, v78, v79
v_cvt_pk_bf16_f32 v78, v92, v93
v_cvt_pk_bf16_f32 v79, v94, v95
s_waitcnt lgkmcnt(6)
M v[160:163], a[116:119], v[32:35], v[160:163]
M v[160:163], a[120:123], v[64:67], v[160:163]
ds_read_b128 a[148:151], v2 offset:36864
ds_read_b128 a[152:155], v2 offset:45056
s_mov_b32 s61, 0
M v[164:167], a[120:123], v[68:71], v[164:167]
M v[164:167], a[116:119], v[36:39], v[164:167]
s_bfe_u32 s3, s2, 0x10002
M v[168:171], a[116:119], v[40:43], v[168:171]
M v[168:171], a[120:123], v[72:75], v[168:171]
s_lshl_b32 s3, s3, 3
M v[172:175], a[120:123], v[76:79], v[172:175]
M v[172:175], a[116:119], v[44:47], v[172:175]
s_waitcnt lgkmcnt(6)
s_lshr_b32 s28, s2, 5
M a[96:99], a[112:115], v[32:35], a[96:99]
M a[96:99], a[112:115], v[64:67], a[96:99]
M v[176:179], a[124:127], v[32:35], v[176:179]
M v[176:179], a[128:131], v[64:67], v[176:179]
ds_read_b128 a[156:159], v2 offset:37888
ds_read_b128 a[160:163], v2 offset:46080
s_add_u32 s28, s3, s28
M v[180:183], a[128:131], v[68:71], v[180:183]
s_lshl_b32 s25, s27, 18
M v[180:183], a[124:127], v[36:39], v[180:183]
M v[184:187], a[124:127], v[40:43], v[184:187]
s_lshl_b32 s3, s101, 12
M v[184:187], a[128:131], v[72:75], v[184:187]
M v[188:191], a[128:131], v[76:79], v[188:191]
s_add_u32 s25, s25, s3
M v[188:191], a[124:127], v[44:47], v[188:191]
s_waitcnt lgkmcnt(6)
M a[100:103], a[112:115], v[36:39], a[100:103]
M a[100:103], a[112:115], v[68:71], a[100:103]
M v[192:195], a[132:135], v[32:35], v[192:195]
s_lshl_b32 s26, s28, 7
M v[192:195], a[136:139], v[64:67], v[192:195]
ds_read_b128 a[164:167], v2 offset:38912
ds_read_b128 a[168:171], v2 offset:47104
M v[196:199], a[136:139], v[68:71], v[196:199]
s_lshl_b32 s42, s101, 11
M v[196:199], a[132:135], v[36:39], v[196:199]
M v[200:203], a[132:135], v[40:43], v[200:203]
s_add_u32 s44, s4, 83886080
s_addc_u32 s45, s5, 0
M v[200:203], a[136:139], v[72:75], v[200:203]
s_mov_b32 s46, 4194304
M v[204:207], a[136:139], v[76:79], v[204:207]
M v[204:207], a[132:135], v[44:47], v[204:207]
s_waitcnt lgkmcnt(6)
s_mov_b32 s47, 0x00020000
M a[104:107], a[112:115], v[40:43], a[104:107]
M a[104:107], a[112:115], v[72:75], a[104:107]
M v[208:211], a[140:143], v[32:35], v[208:211]
M v[208:211], a[144:147], v[64:67], v[208:211]
ds_read_b128 a[172:175], v2 offset:39936
ds_read_b128 a[176:179], v2 offset:48128
s_mov_b32 s50, 2097152
M v[212:215], a[144:147], v[68:71], v[212:215]
M v[212:215], a[140:143], v[36:39], v[212:215]
s_mov_b32 s51, 0x00020000
M v[216:219], a[140:143], v[40:43], v[216:219]
M v[216:219], a[144:147], v[72:75], v[216:219]
s_lshl_b32 s3, s101, 4
M v[220:223], a[144:147], v[76:79], v[220:223]
M v[220:223], a[140:143], v[44:47], v[220:223]
s_waitcnt lgkmcnt(6)
v_lshrrev_b32 v96, 3, v0
M a[108:111], a[112:115], v[44:47], a[108:111]
M a[108:111], a[112:115], v[76:79], a[108:111]
M v[224:227], a[148:151], v[32:35], v[224:227]
v_and_b32 v97, 6, v96
M v[224:227], a[152:155], v[64:67], v[224:227]
M v[228:231], a[152:155], v[68:71], v[228:231]
v_and_b32 v98, 7, v0
M v[228:231], a[148:151], v[36:39], v[228:231]
M v[232:235], a[148:151], v[40:43], v[232:235]
v_xor_b32 v97, v97, v98
M v[232:235], a[152:155], v[72:75], v[232:235]
M v[236:239], a[152:155], v[76:79], v[236:239]
v_add_u32 v96, s3, v96
M v[236:239], a[148:151], v[44:47], v[236:239]
s_waitcnt lgkmcnt(4)
M v[240:243], a[156:159], v[32:35], v[240:243]
v_lshlrev_b32 v96, 11, v96
M v[240:243], a[160:163], v[64:67], v[240:243]
M v[244:247], a[160:163], v[68:71], v[244:247]
v_lshl_add_u32 v99, v97, 4, v96
M v[244:247], a[156:159], v[36:39], v[244:247]
v_add_u32 v100, 15360, v99
M v[248:251], a[156:159], v[40:43], v[248:251]
M v[248:251], a[160:163], v[72:75], v[248:251]
s_waitcnt vmcnt(0) lgkmcnt(0)
s_barrier
v_cmp_ne_u32 vcc, 1, v7
s_nop 0
s_cbranch_vccnz Lk3_spinb0
Lk3_gotb0:
M v[252:255], a[160:163], v[76:79], v[252:255]
s_add_u32 m0, s42, 65536
s_nop 0
buffer_load_dwordx4 v99, s[48:51], s26 offen offset:0 lds
buffer_load_dwordx4 v100, s[48:51], s26 offen offset:1024 lds
M v[252:255], a[156:159], v[44:47], v[252:255]
buffer_load_dwordx4 a[192:195], v1, s[44:47], s25 offen offset:0 sc1
buffer_load_dwordx4 a[196:199], v1, s[44:47], s25 offen offset:1024 sc1
M a[64:67], a[164:167], v[32:35], a[64:67]
buffer_load_dwordx4 a[200:203], v1, s[44:47], s25 offen offset:2048 sc1
buffer_load_dwordx4 a[204:207], v1, s[44:47], s25 offen offset:3072 sc1
M a[64:67], a[168:171], v[64:67], a[64:67]
s_add_u32 s25, s25, 16384
s_add_u32 s26, s26, 131072
s_add_u32 m0, s42, 81920
s_nop 0
buffer_load_dwordx4 v99, s[48:51], s26 offen offset:0 lds
M a[68:71], a[168:171], v[68:71], a[68:71]
buffer_load_dwordx4 v100, s[48:51], s26 offen offset:1024 lds
buffer_load_dwordx4 a[208:211], v1, s[44:47], s25 offen offset:0 sc1
M a[68:71], a[164:167], v[36:39], a[68:71]
buffer_load_dwordx4 a[212:215], v1, s[44:47], s25 offen offset:1024 sc1
buffer_load_dwordx4 a[216:219], v1, s[44:47], s25 offen offset:2048 sc1
M a[72:75], a[164:167], v[40:43], a[72:75]
buffer_load_dwordx4 a[220:223], v1, s[44:47], s25 offen offset:3072 sc1
s_add_u32 s25, s25, 16384
s_add_u32 s26, s26, 131072
M a[72:75], a[168:171], v[72:75], a[72:75]
s_add_u32 m0, s42, 98304
s_nop 0
buffer_load_dwordx4 v99, s[48:51], s26 offen offset:0 lds
buffer_load_dwordx4 v100, s[48:51], s26 offen offset:1024 lds
M a[76:79], a[168:171], v[76:79], a[76:79]
buffer_load_dwordx4 a[224:227], v1, s[44:47], s25 offen offset:0 sc1
M a[76:79], a[164:167], v[44:47], a[76:79]
buffer_load_dwordx4 a[228:231], v1, s[44:47], s25 offen offset:1024 sc1
buffer_load_dwordx4 a[232:235], v1, s[44:47], s25 offen offset:2048 sc1
M a[80:83], a[172:175], v[32:35], a[80:83]
buffer_load_dwordx4 a[236:239], v1, s[44:47], s25 offen offset:3072 sc1
s_add_u32 s25, s25, 16384
s_add_u32 s26, s26, 131072
M a[80:83], a[176:179], v[64:67], a[80:83]
s_add_u32 m0, s42, 114688
s_nop 0
buffer_load_dwordx4 v99, s[48:51], s26 offen offset:0 lds
buffer_load_dwordx4 v100, s[48:51], s26 offen offset:1024 lds
M a[84:87], a[176:179], v[68:71], a[84:87]
buffer_load_dwordx4 a[240:243], v1, s[44:47], s25 offen offset:0 sc1
buffer_load_dwordx4 a[244:247], v1, s[44:47], s25 offen offset:1024 sc1
M a[84:87], a[172:175], v[36:39], a[84:87]
buffer_load_dwordx4 a[248:251], v1, s[44:47], s25 offen offset:2048 sc1
buffer_load_dwordx4 a[252:255], v1, s[44:47], s25 offen offset:3072 sc1
M a[88:91], a[172:175], v[40:43], a[88:91]
s_add_u32 s25, s25, 16384
s_add_u32 s26, s26, 131072
s_add_u32 m0, s42, 0
s_nop 0
buffer_load_dwordx4 v99, s[48:51], s26 offen offset:0 lds
M a[88:91], a[176:179], v[72:75], a[88:91]
buffer_load_dwordx4 v100, s[48:51], s26 offen offset:1024 lds
buffer_load_dwordx4 a[128:131], v1, s[44:47], s25 offen offset:0 sc1
M a[92:95], a[176:179], v[76:79], a[92:95]
buffer_load_dwordx4 a[132:135], v1, s[44:47], s25 offen offset:1024 sc1
buffer_load_dwordx4 a[136:139], v1, s[44:47], s25 offen offset:2048 sc1
M a[92:95], a[172:175], v[44:47], a[92:95]
buffer_load_dwordx4 a[140:143], v1, s[44:47], s25 offen offset:3072 sc1
s_add_u32 s25, s25, 16384
s_add_u32 s26, s26, 131072
Lk2_merge:
s_lshl_b32 s33, s23, 14
s_add_u32 s34, s33, 131072
s_add_u32 s33, s33, 32768
s_cmp_eq_u32 s24, 0
s_cselect_b32 s35, s34, s33
s_cselect_b32 s36, s33, s34
v_add_u32 v2, s35, v1
v_add_u32 v3, s36, v1
s_lshl_b32 s33, s22, 10
s_add_u32 s33, s33, 28672
s_xor_b32 s34, s33, 2048
v_add_u32 v14, s33, v1
v_add_u32 v15, s34, v1
v_accvgpr_read_b32 v20, a96
v_accvgpr_read_b32 v21, a100
v_accvgpr_read_b32 v22, a104
v_accvgpr_read_b32 v23, a108
ds_write_b128 v14, v[20:23]
s_cmp_eq_u32 s24, 1
s_waitcnt lgkmcnt(0)
s_cbranch_scc1 Lk2_mg1
ds_write_b128 v2, v[224:227] offset:0
ds_write_b128 v2, v[228:231] offset:1024
ds_write_b128 v2, v[232:235] offset:2048
ds_write_b128 v2, v[236:239] offset:3072
ds_write_b128 v2, v[240:243] offset:4096
ds_write_b128 v2, v[244:247] offset:5120
ds_write_b128 v2, v[248:251] offset:6144
ds_write_b128 v2, v[252:255] offset:7168
ds_write_b128 v2, a[64:67] offset:8192
ds_write_b128 v2, a[68:71] offset:9216
ds_write_b128 v2, a[72:75] offset:10240
ds_write_b128 v2, a[76:79] offset:11264
ds_write_b128 v2, a[80:83] offset:12288
ds_write_b128 v2, a[84:87] offset:13312
ds_write_b128 v2, a[88:91] offset:14336
ds_write_b128 v2, a[92:95] offset:15360
s_waitcnt lgkmcnt(0)
s_barrier
ds_read_b128 v[28:31], v15
ds_read_b128 v[32:35], v3 offset:0
ds_read_b128 v[36:39], v3 offset:1024
ds_read_b128 v[40:43], v3 offset:2048
ds_read_b128 v[44:47], v3 offset:3072
ds_read_b128 v[48:51], v3 offset:4096
ds_read_b128 v[52:55], v3 offset:5120
ds_read_b128 v[56:59], v3 offset:6144
ds_read_b128 v[60:63], v3 offset:7168
ds_read_b128 v[64:67], v3 offset:8192
ds_read_b128 v[68:71], v3 offset:9216
ds_read_b128 v[72:75], v3 offset:10240
ds_read_b128 v[76:79], v3 offset:11264
ds_read_b128 v[80:83], v3 offset:12288
ds_read_b128 v[84:87], v3 offset:13312
ds_read_b128 v[88:91], v3 offset:14336
ds_read_b128 v[92:95], v3 offset:15360
s_waitcnt lgkmcnt(15)
v_add_f32 v20, v20, v28
v_add_f32 v21, v21, v29
v_add_f32 v22, v22, v30
v_add_f32 v23, v23, v31
s_sub_u32 s35, 15, s21
v_rcp_f32 v8, v20
v_rcp_f32 v9, v21
v_rcp_f32 v10, v22
v_rcp_f32 v11, v23
v_subrev_u32 v20, 0x21800000, v20
v_subrev_u32 v21, 0x21800000, v21
v_subrev_u32 v22, 0x21800000, v22
v_subrev_u32 v23, 0x21800000, v23
v_max_u32 v12, v20, v21
v_max3_u32 v12, v12, v22, v23
s_mov_b32 s64, 0x207
v_pk_add_f32 v[160:161], v[160:161], v[32:33]
v_pk_add_f32 v[162:163], v[162:163], v[34:35]
s_waitcnt lgkmcnt(11)
v_pk_add_f32 v[176:177], v[176:177], v[48:49]
v_pk_add_f32 v[178:179], v[178:179], v[50:51]
v_pk_mul_f32 v[160:161], v[160:161], v[8:9] op_sel:[0,0] op_sel_hi:[1,0]
v_pk_mul_f32 v[162:163], v[162:163], v[8:9] op_sel:[0,0] op_sel_hi:[1,0]
v_pk_mul_f32 v[176:177], v[176:177], v[8:9] op_sel:[0,0] op_sel_hi:[1,0]
v_pk_mul_f32 v[178:179], v[178:179], v[8:9] op_sel:[0,0] op_sel_hi:[1,0]
v_cvt_pk_bf16_f32 v160, v160, v161
v_cvt_pk_bf16_f32 v161, v162, v163
v_cvt_pk_bf16_f32 v162, v176, v177
v_cvt_pk_bf16_f32 v163, v178, v179
v_pk_add_f32 v[164:165], v[164:165], v[36:37]
v_pk_add_f32 v[166:167], v[166:167], v[38:39]
s_waitcnt lgkmcnt(10)
v_pk_add_f32 v[180:181], v[180:181], v[52:53]
v_pk_add_f32 v[182:183], v[182:183], v[54:55]
M v[24:27], a[112:115], v[160:163], 0
v_pk_mul_f32 v[164:165], v[164:165], v[8:9] op_sel:[0,1] op_sel_hi:[1,1]
v_pk_mul_f32 v[166:167], v[166:167], v[8:9] op_sel:[0,1] op_sel_hi:[1,1]
v_pk_mul_f32 v[180:181], v[180:181], v[8:9] op_sel:[0,1] op_sel_hi:[1,1]
v_pk_mul_f32 v[182:183], v[182:183], v[8:9] op_sel:[0,1] op_sel_hi:[1,1]
v_cvt_pk_bf16_f32 v164, v164, v165
v_cvt_pk_bf16_f32 v165, v166, v167
v_cvt_pk_bf16_f32 v166, v180, v181
v_cvt_pk_bf16_f32 v167, v182, v183
v_pk_add_f32 v[168:169], v[168:169], v[40:41]
v_pk_add_f32 v[170:171], v[170:171], v[42:43]
s_waitcnt lgkmcnt(9)
v_pk_add_f32 v[184:185], v[184:185], v[56:57]
v_pk_add_f32 v[186:187], v[186:187], v[58:59]
M v[24:27], a[112:115], v[164:167], v[24:27]
v_pk_mul_f32 v[168:169], v[168:169], v[10:11] op_sel:[0,0] op_sel_hi:[1,0]
v_pk_mul_f32 v[170:171], v[170:171], v[10:11] op_sel:[0,0] op_sel_hi:[1,0]
v_pk_mul_f32 v[184:185], v[184:185], v[10:11] op_sel:[0,0] op_sel_hi:[1,0]
v_pk_mul_f32 v[186:187], v[186:187], v[10:11] op_sel:[0,0] op_sel_hi:[1,0]
v_cvt_pk_bf16_f32 v168, v168, v169
v_cvt_pk_bf16_f32 v169, v170, v171
v_cvt_pk_bf16_f32 v170, v184, v185
v_cvt_pk_bf16_f32 v171, v186, v187
v_pk_add_f32 v[172:173], v[172:173], v[44:45]
v_pk_add_f32 v[174:175], v[174:175], v[46:47]
s_waitcnt lgkmcnt(8)
v_pk_add_f32 v[188:189], v[188:189], v[60:61]
v_pk_add_f32 v[190:191], v[190:191], v[62:63]
M v[24:27], a[112:115], v[168:171], v[24:27]
v_pk_mul_f32 v[172:173], v[172:173], v[10:11] op_sel:[0,1] op_sel_hi:[1,1]
v_pk_mul_f32 v[174:175], v[174:175], v[10:11] op_sel:[0,1] op_sel_hi:[1,1]
v_pk_mul_f32 v[188:189], v[188:189], v[10:11] op_sel:[0,1] op_sel_hi:[1,1]
v_pk_mul_f32 v[190:191], v[190:191], v[10:11] op_sel:[0,1] op_sel_hi:[1,1]
v_cvt_pk_bf16_f32 v172, v172, v173
v_cvt_pk_bf16_f32 v173, v174, v175
v_cvt_pk_bf16_f32 v174, v188, v189
v_cvt_pk_bf16_f32 v175, v190, v191
s_waitcnt lgkmcnt(7)
v_pk_add_f32 v[192:193], v[192:193], v[64:65]
v_pk_add_f32 v[194:195], v[194:195], v[66:67]
s_waitcnt lgkmcnt(3)
v_pk_add_f32 v[208:209], v[208:209], v[80:81]
v_pk_add_f32 v[210:211], v[210:211], v[82:83]
M v[24:27], a[112:115], v[172:175], v[24:27]
v_pk_mul_f32 v[192:193], v[192:193], v[8:9] op_sel:[0,0] op_sel_hi:[1,0]
v_pk_mul_f32 v[194:195], v[194:195], v[8:9] op_sel:[0,0] op_sel_hi:[1,0]
v_pk_mul_f32 v[208:209], v[208:209], v[8:9] op_sel:[0,0] op_sel_hi:[1,0]
v_pk_mul_f32 v[210:211], v[210:211], v[8:9] op_sel:[0,0] op_sel_hi:[1,0]
v_cvt_pk_bf16_f32 v192, v192, v193
v_cvt_pk_bf16_f32 v193, v194, v195
v_cvt_pk_bf16_f32 v194, v208, v209
v_cvt_pk_bf16_f32 v195, v210, v211
v_pk_add_f32 v[196:197], v[196:197], v[68:69]
v_pk_add_f32 v[198:199], v[198:199], v[70:71]
s_waitcnt lgkmcnt(2)
v_pk_add_f32 v[212:213], v[212:213], v[84:85]
v_pk_add_f32 v[214:215], v[214:215], v[86:87]
M v[24:27], a[112:115], v[192:195], v[24:27]
v_pk_mul_f32 v[196:197], v[196:197], v[8:9] op_sel:[0,1] op_sel_hi:[1,1]
v_pk_mul_f32 v[198:199], v[198:199], v[8:9] op_sel:[0,1] op_sel_hi:[1,1]
v_pk_mul_f32 v[212:213], v[212:213], v[8:9] op_sel:[0,1] op_sel_hi:[1,1]
v_pk_mul_f32 v[214:215], v[214:215], v[8:9] op_sel:[0,1] op_sel_hi:[1,1]
v_cvt_pk_bf16_f32 v196, v196, v197
v_cvt_pk_bf16_f32 v197, v198, v199
v_cvt_pk_bf16_f32 v198, v212, v213
v_cvt_pk_bf16_f32 v199, v214, v215
v_pk_add_f32 v[200:201], v[200:201], v[72:73]
v_pk_add_f32 v[202:203], v[202:203], v[74:75]
s_waitcnt lgkmcnt(1)
v_pk_add_f32 v[216:217], v[216:217], v[88:89]
v_pk_add_f32 v[218:219], v[218:219], v[90:91]
M v[24:27], a[112:115], v[196:199], v[24:27]
v_pk_mul_f32 v[200:201], v[200:201], v[10:11] op_sel:[0,0] op_sel_hi:[1,0]
v_pk_mul_f32 v[202:203], v[202:203], v[10:11] op_sel:[0,0] op_sel_hi:[1,0]
v_pk_mul_f32 v[216:217], v[216:217], v[10:11] op_sel:[0,0] op_sel_hi:[1,0]
v_pk_mul_f32 v[218:219], v[218:219], v[10:11] op_sel:[0,0] op_sel_hi:[1,0]
v_cvt_pk_bf16_f32 v200, v200, v201
v_cvt_pk_bf16_f32 v201, v202, v203
v_cvt_pk_bf16_f32 v202, v216, v217
v_cvt_pk_bf16_f32 v203, v218, v219
v_pk_add_f32 v[204:205], v[204:205], v[76:77]
v_pk_add_f32 v[206:207], v[206:207], v[78:79]
s_waitcnt lgkmcnt(0)
v_pk_add_f32 v[220:221], v[220:221], v[92:93]
v_pk_add_f32 v[222:223], v[222:223], v[94:95]
M v[24:27], a[112:115], v[200:203], v[24:27]
v_pk_mul_f32 v[204:205], v[204:205], v[10:11] op_sel:[0,1] op_sel_hi:[1,1]
v_pk_mul_f32 v[206:207], v[206:207], v[10:11] op_sel:[0,1] op_sel_hi:[1,1]
v_pk_mul_f32 v[220:221], v[220:221], v[10:11] op_sel:[0,1] op_sel_hi:[1,1]
v_pk_mul_f32 v[222:223], v[222:223], v[10:11] op_sel:[0,1] op_sel_hi:[1,1]
v_cvt_pk_bf16_f32 v204, v204, v205
v_cvt_pk_bf16_f32 v205, v206, v207
v_cvt_pk_bf16_f32 v206, v220, v221
v_cvt_pk_bf16_f32 v207, v222, v223
s_nop 1
M v[24:27], a[112:115], v[204:207], v[24:27]
v_cmp_lt_u32 vcc, 0x3c000000, v12
s_nop 6
v_cmp_class_f32 s[40:41], v24, s64
s_nop 0
s_or_b64 vcc, vcc, s[40:41]
s_cbranch_vccnz Lbad_4
s_lshl_b32 s33, s35, 20
s_lshl_b32 s34, s20, 15
s_add_u32 s33, s33, s34
s_lshl_b32 s34, s23, 13
s_add_u32 s36, s33, s34
s_add_u32 s37, s36, 4096
s_add_u32 s38, s36, 16384
s_add_u32 s39, s36, 20480
buffer_store_dwordx4 v[160:163], v1, s[16:19], s36 offen offset:0 sc1
buffer_store_dwordx4 v[164:167], v1, s[16:19], s36 offen offset:2048 sc1
buffer_store_dwordx4 v[168:171], v1, s[16:19], s37 offen offset:0 sc1
buffer_store_dwordx4 v[172:175], v1, s[16:19], s37 offen offset:2048 sc1
buffer_store_dwordx4 v[192:195], v1, s[16:19], s36 offen offset:1024 sc1
buffer_store_dwordx4 v[196:199], v1, s[16:19], s36 offen offset:3072 sc1
buffer_store_dwordx4 v[200:203], v1, s[16:19], s37 offen offset:1024 sc1
buffer_store_dwordx4 v[204:207], v1, s[16:19], s37 offen offset:3072 sc1
s_branch Lfd_5
Lbad_4:
s_or_b32 s60, s60, 2
Lfd_5:
s_branch Lk2_chk
Lk2_mg1:
ds_write_b128 v2, v[160:163] offset:0
ds_write_b128 v2, v[164:167] offset:1024
ds_write_b128 v2, v[168:171] offset:2048
ds_write_b128 v2, v[172:175] offset:3072
ds_write_b128 v2, v[176:179] offset:4096
ds_write_b128 v2, v[180:183] offset:5120
ds_write_b128 v2, v[184:187] offset:6144
ds_write_b128 v2, v[188:191] offset:7168
ds_write_b128 v2, v[192:195] offset:8192
ds_write_b128 v2, v[196:199] offset:9216
ds_write_b128 v2, v[200:203] offset:10240
ds_write_b128 v2, v[204:207] offset:11264
ds_write_b128 v2, v[208:211] offset:12288
ds_write_b128 v2, v[212:215] offset:13312
ds_write_b128 v2, v[216:219] offset:14336
ds_write_b128 v2, v[220:223] offset:15360
s_waitcnt lgkmcnt(0)
s_barrier
ds_read_b128 v[28:31], v15
ds_read_b128 v[32:35], v3 offset:0
ds_read_b128 v[36:39], v3 offset:1024
ds_read_b128 v[40:43], v3 offset:2048
ds_read_b128 v[44:47], v3 offset:3072
ds_read_b128 v[48:51], v3 offset:4096
ds_read_b128 v[52:55], v3 offset:5120
ds_read_b128 v[56:59], v3 offset:6144
ds_read_b128 v[60:63], v3 offset:7168
ds_read_b128 v[64:67], v3 offset:8192
ds_read_b128 v[68:71], v3 offset:9216
ds_read_b128 v[72:75], v3 offset:10240
ds_read_b128 v[76:79], v3 offset:11264
ds_read_b128 v[80:83], v3 offset:12288
ds_read_b128 v[84:87], v3 offset:13312
ds_read_b128 v[88:91], v3 offset:14336
ds_read_b128 v[92:95], v3 offset:15360
s_waitcnt lgkmcnt(15)
v_add_f32 v20, v20, v28
v_add_f32 v21, v21, v29
v_add_f32 v22, v22, v30
v_add_f32 v23, v23, v31
s_sub_u32 s35, 15, s21
v_rcp_f32 v8, v20
v_rcp_f32 v9, v21
v_rcp_f32 v10, v22
v_rcp_f32 v11, v23
v_subrev_u32 v20, 0x21800000, v20
v_subrev_u32 v21, 0x21800000, v21
v_subrev_u32 v22, 0x21800000, v22
v_subrev_u32 v23, 0x21800000, v23
v_max_u32 v12, v20, v21
v_max3_u32 v12, v12, v22, v23
s_mov_b32 s64, 0x207
v_pk_add_f32 v[224:225], v[224:225], v[32:33]
v_pk_add_f32 v[226:227], v[226:227], v[34:35]
s_waitcnt lgkmcnt(11)
v_pk_add_f32 v[240:241], v[240:241], v[48:49]
v_pk_add_f32 v[242:243], v[242:243], v[50:51]
v_pk_mul_f32 v[224:225], v[224:225], v[8:9] op_sel:[0,0] op_sel_hi:[1,0]
v_pk_mul_f32 v[226:227], v[226:227], v[8:9] op_sel:[0,0] op_sel_hi:[1,0]
v_pk_mul_f32 v[240:241], v[240:241], v[8:9] op_sel:[0,0] op_sel_hi:[1,0]
v_pk_mul_f32 v[242:243], v[242:243], v[8:9] op_sel:[0,0] op_sel_hi:[1,0]
v_cvt_pk_bf16_f32 v224, v224, v225
v_cvt_pk_bf16_f32 v225, v226, v227
v_cvt_pk_bf16_f32 v226, v240, v241
v_cvt_pk_bf16_f32 v227, v242, v243
v_pk_add_f32 v[228:229], v[228:229], v[36:37]
v_pk_add_f32 v[230:231], v[230:231], v[38:39]
s_waitcnt lgkmcnt(10)
v_pk_add_f32 v[244:245], v[244:245], v[52:53]
v_pk_add_f32 v[246:247], v[246:247], v[54:55]
M v[24:27], a[112:115], v[224:227], 0
v_pk_mul_f32 v[228:229], v[228:229], v[8:9] op_sel:[0,1] op_sel_hi:[1,1]
v_pk_mul_f32 v[230:231], v[230:231], v[8:9] op_sel:[0,1] op_sel_hi:[1,1]
v_pk_mul_f32 v[244:245], v[244:245], v[8:9] op_sel:[0,1] op_sel_hi:[1,1]
v_pk_mul_f32 v[246:247], v[246:247], v[8:9] op_sel:[0,1] op_sel_hi:[1,1]
v_cvt_pk_bf16_f32 v228, v228, v229
v_cvt_pk_bf16_f32 v229, v230, v231
v_cvt_pk_bf16_f32 v230, v244, v245
v_cvt_pk_bf16_f32 v231, v246, v247
v_pk_add_f32 v[232:233], v[232:233], v[40:41]
v_pk_add_f32 v[234:235], v[234:235], v[42:43]
s_waitcnt lgkmcnt(9)
v_pk_add_f32 v[248:249], v[248:249], v[56:57]
v_pk_add_f32 v[250:251], v[250:251], v[58:59]
M v[24:27], a[112:115], v[228:231], v[24:27]
v_pk_mul_f32 v[232:233], v[232:233], v[10:11] op_sel:[0,0] op_sel_hi:[1,0]
v_pk_mul_f32 v[234:235], v[234:235], v[10:11] op_sel:[0,0] op_sel_hi:[1,0]
v_pk_mul_f32 v[248:249], v[248:249], v[10:11] op_sel:[0,0] op_sel_hi:[1,0]
v_pk_mul_f32 v[250:251], v[250:251], v[10:11] op_sel:[0,0] op_sel_hi:[1,0]
v_cvt_pk_bf16_f32 v232, v232, v233
v_cvt_pk_bf16_f32 v233, v234, v235
v_cvt_pk_bf16_f32 v234, v248, v249
v_cvt_pk_bf16_f32 v235, v250, v251
v_pk_add_f32 v[236:237], v[236:237], v[44:45]
v_pk_add_f32 v[238:239], v[238:239], v[46:47]
s_waitcnt lgkmcnt(8)
v_pk_add_f32 v[252:253], v[252:253], v[60:61]
v_pk_add_f32 v[254:255], v[254:255], v[62:63]
M v[24:27], a[112:115], v[232:235], v[24:27]
v_pk_mul_f32 v[236:237], v[236:237], v[10:11] op_sel:[0,1] op_sel_hi:[1,1]
v_pk_mul_f32 v[238:239], v[238:239], v[10:11] op_sel:[0,1] op_sel_hi:[1,1]
v_pk_mul_f32 v[252:253], v[252:253], v[10:11] op_sel:[0,1] op_sel_hi:[1,1]
v_pk_mul_f32 v[254:255], v[254:255], v[10:11] op_sel:[0,1] op_sel_hi:[1,1]
v_cvt_pk_bf16_f32 v236, v236, v237
v_cvt_pk_bf16_f32 v237, v238, v239
v_cvt_pk_bf16_f32 v238, v252, v253
v_cvt_pk_bf16_f32 v239, v254, v255
v_accvgpr_read_b32 v32, a64
v_accvgpr_read_b32 v33, a65
v_accvgpr_read_b32 v34, a66
v_accvgpr_read_b32 v35, a67
s_waitcnt lgkmcnt(7)
v_pk_add_f32 v[32:33], v[32:33], v[64:65]
v_pk_add_f32 v[34:35], v[34:35], v[66:67]
v_accvgpr_read_b32 v48, a80
v_accvgpr_read_b32 v49, a81
v_accvgpr_read_b32 v50, a82
v_accvgpr_read_b32 v51, a83
s_waitcnt lgkmcnt(3)
v_pk_add_f32 v[48:49], v[48:49], v[80:81]
v_pk_add_f32 v[50:51], v[50:51], v[82:83]
M v[24:27], a[112:115], v[236:239], v[24:27]
v_pk_mul_f32 v[32:33], v[32:33], v[8:9] op_sel:[0,0] op_sel_hi:[1,0]
v_pk_mul_f32 v[34:35], v[34:35], v[8:9] op_sel:[0,0] op_sel_hi:[1,0]
v_pk_mul_f32 v[48:49], v[48:49], v[8:9] op_sel:[0,0] op_sel_hi:[1,0]
v_pk_mul_f32 v[50:51], v[50:51], v[8:9] op_sel:[0,0] op_sel_hi:[1,0]
v_cvt_pk_bf16_f32 v32, v32, v33
v_cvt_pk_bf16_f32 v33, v34, v35
v_cvt_pk_bf16_f32 v34, v48, v49
v_cvt_pk_bf16_f32 v35, v50, v51
v_accvgpr_read_b32 v240, a68
v_accvgpr_read_b32 v241, a69
v_accvgpr_read_b32 v242, a70
v_accvgpr_read_b32 v243, a71
v_pk_add_f32 v[240:241], v[240:241], v[68:69]
v_pk_add_f32 v[242:243], v[242:243], v[70:71]
v_accvgpr_read_b32 v36, a84
v_accvgpr_read_b32 v37, a85
v_accvgpr_read_b32 v38, a86
v_accvgpr_read_b32 v39, a87
s_waitcnt lgkmcnt(2)
v_pk_add_f32 v[36:37], v[36:37], v[84:85]
v_pk_add_f32 v[38:39], v[38:39], v[86:87]
M v[24:27], a[112:115], v[32:35], v[24:27]
v_pk_mul_f32 v[240:241], v[240:241], v[8:9] op_sel:[0,1] op_sel_hi:[1,1]
v_pk_mul_f32 v[242:243], v[242:243], v[8:9] op_sel:[0,1] op_sel_hi:[1,1]
v_pk_mul_f32 v[36:37], v[36:37], v[8:9] op_sel:[0,1] op_sel_hi:[1,1]
v_pk_mul_f32 v[38:39], v[38:39], v[8:9] op_sel:[0,1] op_sel_hi:[1,1]
v_cvt_pk_bf16_f32 v240, v240, v241
v_cvt_pk_bf16_f32 v241, v242, v243
v_cvt_pk_bf16_f32 v242, v36, v37
v_cvt_pk_bf16_f32 v243, v38, v39
v_accvgpr_read_b32 v52, a72
v_accvgpr_read_b32 v53, a73
v_accvgpr_read_b32 v54, a74
v_accvgpr_read_b32 v55, a75
v_pk_add_f32 v[52:53], v[52:53], v[72:73]
v_pk_add_f32 v[54:55], v[54:55], v[74:75]
v_accvgpr_read_b32 v244, a88
v_accvgpr_read_b32 v245, a89
v_accvgpr_read_b32 v246, a90
v_accvgpr_read_b32 v247, a91
s_waitcnt lgkmcnt(1)
v_pk_add_f32 v[244:245], v[244:245], v[88:89]
v_pk_add_f32 v[246:247], v[246:247], v[90:91]
M v[24:27], a[112:115], v[240:243], v[24:27]
v_pk_mul_f32 v[52:53], v[52:53], v[10:11] op_sel:[0,0] op_sel_hi:[1,0]
v_pk_mul_f32 v[54:55], v[54:55], v[10:11] op_sel:[0,0] op_sel_hi:[1,0]
v_pk_mul_f32 v[244:245], v[244:245], v[10:11] op_sel:[0,0] op_sel_hi:[1,0]
v_pk_mul_f32 v[246:247], v[246:247], v[10:11] op_sel:[0,0] op_sel_hi:[1,0]
v_cvt_pk_bf16_f32 v52, v52, v53
v_cvt_pk_bf16_f32 v53, v54, v55
v_cvt_pk_bf16_f32 v54, v244, v245
v_cvt_pk_bf16_f32 v55, v246, v247
v_accvgpr_read_b32 v40, a76
v_accvgpr_read_b32 v41, a77
v_accvgpr_read_b32 v42, a78
v_accvgpr_read_b32 v43, a79
v_pk_add_f32 v[40:41], v[40:41], v[76:77]
v_pk_add_f32 v[42:43], v[42:43], v[78:79]
v_accvgpr_read_b32 v56, a92
v_accvgpr_read_b32 v57, a93
v_accvgpr_read_b32 v58, a94
v_accvgpr_read_b32 v59, a95
s_waitcnt lgkmcnt(0)
v_pk_add_f32 v[56:57], v[56:57], v[92:93]
v_pk_add_f32 v[58:59], v[58:59], v[94:95]
M v[24:27], a[112:115], v[52:55], v[24:27]
v_pk_mul_f32 v[40:41], v[40:41], v[10:11] op_sel:[0,1] op_sel_hi:[1,1]
v_pk_mul_f32 v[42:43], v[42:43], v[10:11] op_sel:[0,1] op_sel_hi:[1,1]
v_pk_mul_f32 v[56:57], v[56:57], v[10:11] op_sel:[0,1] op_sel_hi:[1,1]
v_pk_mul_f32 v[58:59], v[58:59], v[10:11] op_sel:[0,1] op_sel_hi:[1,1]
v_cvt_pk_bf16_f32 v40, v40, v41
v_cvt_pk_bf16_f32 v41, v42, v43
v_cvt_pk_bf16_f32 v42, v56, v57
v_cvt_pk_bf16_f32 v43, v58, v59
s_nop 1
M v[24:27], a[112:115], v[40:43], v[24:27]
v_cmp_lt_u32 vcc, 0x3c000000, v12
s_nop 6
v_cmp_class_f32 s[40:41], v24, s64
s_nop 0
s_or_b64 vcc, vcc, s[40:41]
s_cbranch_vccnz Lbad_6
s_lshl_b32 s33, s35, 20
s_lshl_b32 s34, s20, 15
s_add_u32 s33, s33, s34
s_lshl_b32 s34, s23, 13
s_add_u32 s36, s33, s34
s_add_u32 s37, s36, 4096
s_add_u32 s38, s36, 16384
s_add_u32 s39, s36, 20480
buffer_store_dwordx4 v[224:227], v1, s[16:19], s38 offen offset:0 sc1
buffer_store_dwordx4 v[228:231], v1, s[16:19], s38 offen offset:2048 sc1
buffer_store_dwordx4 v[232:235], v1, s[16:19], s39 offen offset:0 sc1
buffer_store_dwordx4 v[236:239], v1, s[16:19], s39 offen offset:2048 sc1
buffer_store_dwordx4 v[32:35], v1, s[16:19], s38 offen offset:1024 sc1
buffer_store_dwordx4 v[240:243], v1, s[16:19], s38 offen offset:3072 sc1
buffer_store_dwordx4 v[52:55], v1, s[16:19], s39 offen offset:1024 sc1
buffer_store_dwordx4 v[40:43], v1, s[16:19], s39 offen offset:3072 sc1
s_branch Lfd_7
Lbad_6:
s_or_b32 s60, s60, 2
Lfd_7:
Lk2_chk:
s_cmp_eq_u32 s60, 0
s_cbranch_scc1 Lk2_done
s_sub_u32 s56, 15, s21
s_lshl_b32 s33, s24, 1
s_lshl_b32 s61, 3, s33
s_and_b32 s34, s60, 2
s_bitcmp1_b32 s60, 0
s_cselect_b32 s56, s21, s56
s_cselect_b32 s61, 15, s61
s_cselect_b32 s60, s34, 0
s_waitcnt vmcnt(0)
s_lshl_b32 s33, s20, 7
s_lshl_b32 s34, s56, 3
s_add_u32 s33, s33, s34
s_lshl_b32 s34, s23, 2
s_add_u32 s33, s33, s34
s_lshl_b32 s33, s33, 12
buffer_load_dwordx4 a[0:3], v1, s[8:11], s33 offen offset:0 sc1
buffer_load_dwordx4 a[4:7], v1, s[8:11], s33 offen offset:1024 sc1
buffer_load_dwordx4 a[8:11], v1, s[8:11], s33 offen offset:2048 sc1
buffer_load_dwordx4 a[12:15], v1, s[8:11], s33 offen offset:3072 sc1
s_add_u32 s33, s33, 4096
buffer_load_dwordx4 a[16:19], v1, s[8:11], s33 offen offset:0 sc1
buffer_load_dwordx4 a[20:23], v1, s[8:11], s33 offen offset:1024 sc1
buffer_load_dwordx4 a[24:27], v1, s[8:11], s33 offen offset:2048 sc1
buffer_load_dwordx4 a[28:31], v1, s[8:11], s33 offen offset:3072 sc1
s_add_u32 s33, s33, 4096
buffer_load_dwordx4 a[32:35], v1, s[8:11], s33 offen offset:0 sc1
buffer_load_dwordx4 a[36:39], v1, s[8:11], s33 offen offset:1024 sc1
buffer_load_dwordx4 a[40:43], v1, s[8:11], s33 offen offset:2048 sc1
buffer_load_dwordx4 a[44:47], v1, s[8:11], s33 offen offset:3072 sc1
s_add_u32 s33, s33, 4096
buffer_load_dwordx4 a[48:51], v1, s[8:11], s33 offen offset:0 sc1
buffer_load_dwordx4 a[52:55], v1, s[8:11], s33 offen offset:1024 sc1
buffer_load_dwordx4 a[56:59], v1, s[8:11], s33 offen offset:2048 sc1
buffer_load_dwordx4 a[60:63], v1, s[8:11], s33 offen offset:3072 sc1
v_accvgpr_write_b32 a64, 0
v_accvgpr_write_b32 a65, 0
v_accvgpr_write_b32 a66, 0
v_accvgpr_write_b32 a67, 0
v_accvgpr_write_b32 a68, 0
v_accvgpr_write_b32 a69, 0
v_accvgpr_write_b32 a70, 0
v_accvgpr_write_b32 a71, 0
v_accvgpr_write_b32 a72, 0
v_accvgpr_write_b32 a73, 0
v_accvgpr_write_b32 a74, 0
v_accvgpr_write_b32 a75, 0
v_accvgpr_write_b32 a76, 0
v_accvgpr_write_b32 a77, 0
v_accvgpr_write_b32 a78, 0
v_accvgpr_write_b32 a79, 0
v_accvgpr_write_b32 a80, 0
v_accvgpr_write_b32 a81, 0
v_accvgpr_write_b32 a82, 0
v_accvgpr_write_b32 a83, 0
v_accvgpr_write_b32 a84, 0
v_accvgpr_write_b32 a85, 0
v_accvgpr_write_b32 a86, 0
v_accvgpr_write_b32 a87, 0
v_accvgpr_write_b32 a88, 0
v_accvgpr_write_b32 a89, 0
v_accvgpr_write_b32 a90, 0
v_accvgpr_write_b32 a91, 0
v_accvgpr_write_b32 a92, 0
v_accvgpr_write_b32 a93, 0
v_accvgpr_write_b32 a94, 0
v_accvgpr_write_b32 a95, 0
v_accvgpr_write_b32 a96, 0
v_accvgpr_write_b32 a97, 0
v_accvgpr_write_b32 a98, 0
v_accvgpr_write_b32 a99, 0
v_accvgpr_write_b32 a100, 0
v_accvgpr_write_b32 a101, 0
v_accvgpr_write_b32 a102, 0
v_accvgpr_write_b32 a103, 0
v_accvgpr_write_b32 a104, 0
v_accvgpr_write_b32 a105, 0
v_accvgpr_write_b32 a106, 0
v_accvgpr_write_b32 a107, 0
v_accvgpr_write_b32 a108, 0
v_accvgpr_write_b32 a109, 0
v_accvgpr_write_b32 a110, 0
v_accvgpr_write_b32 a111, 0
v_mov_b32 v160, 0
v_mov_b32 v161, 0
v_mov_b32 v162, 0
v_mov_b32 v163, 0
v_mov_b32 v164, 0
v_mov_b32 v165, 0
v_mov_b32 v166, 0
v_mov_b32 v167, 0
v_mov_b32 v168, 0
v_mov_b32 v169, 0
v_mov_b32 v170, 0
v_mov_b32 v171, 0
v_mov_b32 v172, 0
v_mov_b32 v173, 0
v_mov_b32 v174, 0
v_mov_b32 v175, 0
v_mov_b32 v176, 0
v_mov_b32 v177, 0
v_mov_b32 v178, 0
v_mov_b32 v179, 0
v_mov_b32 v180, 0
v_mov_b32 v181, 0
v_mov_b32 v182, 0
v_mov_b32 v183, 0
v_mov_b32 v184, 0
v_mov_b32 v185, 0
v_mov_b32 v186, 0
v_mov_b32 v187, 0
v_mov_b32 v188, 0
v_mov_b32 v189, 0
v_mov_b32 v190, 0
v_mov_b32 v191, 0
v_mov_b32 v192, 0
v_mov_b32 v193, 0
v_mov_b32 v194, 0
v_mov_b32 v195, 0
v_mov_b32 v196, 0
v_mov_b32 v197, 0
v_mov_b32 v198, 0
v_mov_b32 v199, 0
v_mov_b32 v200, 0
v_mov_b32 v201, 0
v_mov_b32 v202, 0
v_mov_b32 v203, 0
v_mov_b32 v204, 0
v_mov_b32 v205, 0
v_mov_b32 v206, 0
v_mov_b32 v207, 0
v_mov_b32 v208, 0
v_mov_b32 v209, 0
v_mov_b32 v210, 0
v_mov_b32 v211, 0
v_mov_b32 v212, 0
v_mov_b32 v213, 0
v_mov_b32 v214, 0
v_mov_b32 v215, 0
v_mov_b32 v216, 0
v_mov_b32 v217, 0
v_mov_b32 v218, 0
v_mov_b32 v219, 0
v_mov_b32 v220, 0
v_mov_b32 v221, 0
v_mov_b32 v222, 0
v_mov_b32 v223, 0
v_mov_b32 v224, 0
v_mov_b32 v225, 0
v_mov_b32 v226, 0
v_mov_b32 v227, 0
v_mov_b32 v228, 0
v_mov_b32 v229, 0
v_mov_b32 v230, 0
v_mov_b32 v231, 0
v_mov_b32 v232, 0
v_mov_b32 v233, 0
v_mov_b32 v234, 0
v_mov_b32 v235, 0
v_mov_b32 v236, 0
v_mov_b32 v237, 0
v_mov_b32 v238, 0
v_mov_b32 v239, 0
v_mov_b32 v240, 0
v_mov_b32 v241, 0
v_mov_b32 v242, 0
v_mov_b32 v243, 0
v_mov_b32 v244, 0
v_mov_b32 v245, 0
v_mov_b32 v246, 0
v_mov_b32 v247, 0
v_mov_b32 v248, 0
v_mov_b32 v249, 0
v_mov_b32 v250, 0
v_mov_b32 v251, 0
v_mov_b32 v252, 0
v_mov_b32 v253, 0
v_mov_b32 v254, 0
v_mov_b32 v255, 0
v_mov_b32 v8, v4
v_mov_b32 v9, v4
v_mov_b32 v10, v4
v_mov_b32 v11, v4
s_lshl_b32 s57, s20, 20
s_lshl_b32 s58, s56, 7
s_lshl_b32 s59, s56, 1
s_add_u32 s59, s59, 2
Lslow_8:
s_add_u32 s35, s57, 0
buffer_load_dwordx4 v[96:99], v1, s[12:15], s35 offen offset:0 sc1
buffer_load_dwordx4 v[100:103], v1, s[12:15], s35 offen offset:1024 sc1
buffer_load_dwordx4 v[104:107], v1, s[12:15], s35 offen offset:2048 sc1
buffer_load_dwordx4 v[108:111], v1, s[12:15], s35 offen offset:3072 sc1
s_add_u32 s35, s57, 4096
buffer_load_dwordx4 v[112:115], v1, s[12:15], s35 offen offset:0 sc1
buffer_load_dwordx4 v[116:119], v1, s[12:15], s35 offen offset:1024 sc1
buffer_load_dwordx4 v[120:123], v1, s[12:15], s35 offen offset:2048 sc1
buffer_load_dwordx4 v[124:127], v1, s[12:15], s35 offen offset:3072 sc1
s_add_u32 s35, s57, 8192
buffer_load_dwordx4 v[128:131], v1, s[12:15], s35 offen offset:0 sc1
buffer_load_dwordx4 v[132:135], v1, s[12:15], s35 offen offset:1024 sc1
buffer_load_dwordx4 v[136:139], v1, s[12:15], s35 offen offset:2048 sc1
buffer_load_dwordx4 v[140:143], v1, s[12:15], s35 offen offset:3072 sc1
s_add_u32 s35, s57, 12288
buffer_load_dwordx4 v[144:147], v1, s[12:15], s35 offen offset:0 sc1
buffer_load_dwordx4 v[148:151], v1, s[12:15], s35 offen offset:1024 sc1
buffer_load_dwordx4 v[152:155], v1, s[12:15], s35 offen offset:2048 sc1
buffer_load_dwordx4 v[156:159], v1, s[12:15], s35 offen offset:3072 sc1
s_lshl_b32 s33, s23, 6
s_add_i32 s33, s33, s58
s_cmp_gt_i32 s33, 0
s_cselect_b32 s34, 0, 0xf149f2ca
s_cmp_lt_i32 s33, 0
s_cselect_b32 s33, 0xf149f2ca, 0
v_mov_b32 v20, s34
v_mov_b32 v21, s34
v_mov_b32 v22, s34
v_mov_b32 v23, s34
v_mov_b32 v28, s33
v_mov_b32 v29, s33
v_mov_b32 v30, s33
v_mov_b32 v31, s33
v_med3_f32 v24, v16, v20, v28
v_med3_f32 v25, v17, v20, v28
v_med3_f32 v26, v18, v20, v28
v_med3_f32 v27, v19, v20, v28
s_waitcnt vmcnt(0)
s_nop 0
M v[32:35], v[96:99], a[0:3], v[24:27]
M v[32:35], v[100:103], a[4:7], v[32:35]
M v[32:35], v[104:107], a[8:11], v[32:35]
M v[32:35], v[108:111], a[12:15], v[32:35]
M v[36:39], v[96:99], a[16:19], v[28:31]
M v[36:39], v[100:103], a[20:23], v[36:39]
M v[36:39], v[104:107], a[24:27], v[36:39]
M v[36:39], v[108:111], a[28:31], v[36:39]
M v[40:43], v[96:99], a[32:35], v[28:31]
M v[40:43], v[100:103], a[36:39], v[40:43]
M v[40:43], v[104:107], a[40:43], v[40:43]
M v[40:43], v[108:111], a[44:47], v[40:43]
M v[44:47], v[96:99], a[48:51], v[28:31]
M v[44:47], v[100:103], a[52:55], v[44:47]
M v[44:47], v[104:107], a[56:59], v[44:47]
M v[44:47], v[108:111], a[60:63], v[44:47]
M v[48:51], v[112:115], a[0:3], v[20:23]
M v[48:51], v[116:119], a[4:7], v[48:51]
M v[48:51], v[120:123], a[8:11], v[48:51]
M v[48:51], v[124:127], a[12:15], v[48:51]
M v[52:55], v[112:115], a[16:19], v[24:27]
M v[52:55], v[116:119], a[20:23], v[52:55]
M v[52:55], v[120:123], a[24:27], v[52:55]
M v[52:55], v[124:127], a[28:31], v[52:55]
M v[56:59], v[112:115], a[32:35], v[28:31]
M v[56:59], v[116:119], a[36:39], v[56:59]
M v[56:59], v[120:123], a[40:43], v[56:59]
M v[56:59], v[124:127], a[44:47], v[56:59]
M v[60:63], v[112:115], a[48:51], v[28:31]
M v[60:63], v[116:119], a[52:55], v[60:63]
M v[60:63], v[120:123], a[56:59], v[60:63]
M v[60:63], v[124:127], a[60:63], v[60:63]
M v[64:67], v[128:131], a[0:3], v[20:23]
M v[64:67], v[132:135], a[4:7], v[64:67]
M v[64:67], v[136:139], a[8:11], v[64:67]
M v[64:67], v[140:143], a[12:15], v[64:67]
M v[68:71], v[128:131], a[16:19], v[20:23]
M v[68:71], v[132:135], a[20:23], v[68:71]
M v[68:71], v[136:139], a[24:27], v[68:71]
M v[68:71], v[140:143], a[28:31], v[68:71]
M v[72:75], v[128:131], a[32:35], v[24:27]
M v[72:75], v[132:135], a[36:39], v[72:75]
M v[72:75], v[136:139], a[40:43], v[72:75]
M v[72:75], v[140:143], a[44:47], v[72:75]
M v[76:79], v[128:131], a[48:51], v[28:31]
M v[76:79], v[132:135], a[52:55], v[76:79]
M v[76:79], v[136:139], a[56:59], v[76:79]
M v[76:79], v[140:143], a[60:63], v[76:79]
M v[80:83], v[144:147], a[0:3], v[20:23]
M v[80:83], v[148:151], a[4:7], v[80:83]
M v[80:83], v[152:155], a[8:11], v[80:83]
M v[80:83], v[156:159], a[12:15], v[80:83]
M v[84:87], v[144:147], a[16:19], v[20:23]
M v[84:87], v[148:151], a[20:23], v[84:87]
M v[84:87], v[152:155], a[24:27], v[84:87]
M v[84:87], v[156:159], a[28:31], v[84:87]
M v[88:91], v[144:147], a[32:35], v[20:23]
M v[88:91], v[148:151], a[36:39], v[88:91]
M v[88:91], v[152:155], a[40:43], v[88:91]
M v[88:91], v[156:159], a[44:47], v[88:91]
M v[92:95], v[144:147], a[48:51], v[24:27]
M v[92:95], v[148:151], a[52:55], v[92:95]
M v[92:95], v[152:155], a[56:59], v[92:95]
M v[92:95], v[156:159], a[60:63], v[92:95]
s_nop 7
s_add_u32 s35, s57, 16384
buffer_load_dwordx4 v[96:99], v1, s[12:15], s35 offen offset:0 sc1
buffer_load_dwordx4 v[100:103], v1, s[12:15], s35 offen offset:1024 sc1
buffer_load_dwordx4 v[104:107], v1, s[12:15], s35 offen offset:2048 sc1
buffer_load_dwordx4 v[108:111], v1, s[12:15], s35 offen offset:3072 sc1
s_add_u32 s35, s57, 20480
buffer_load_dwordx4 v[112:115], v1, s[12:15], s35 offen offset:0 sc1
buffer_load_dwordx4 v[116:119], v1, s[12:15], s35 offen offset:1024 sc1
buffer_load_dwordx4 v[120:123], v1, s[12:15], s35 offen offset:2048 sc1
buffer_load_dwordx4 v[124:127], v1, s[12:15], s35 offen offset:3072 sc1
s_add_u32 s35, s57, 24576
buffer_load_dwordx4 v[128:131], v1, s[12:15], s35 offen offset:0 sc1
buffer_load_dwordx4 v[132:135], v1, s[12:15], s35 offen offset:1024 sc1
buffer_load_dwordx4 v[136:139], v1, s[12:15], s35 offen offset:2048 sc1
buffer_load_dwordx4 v[140:143], v1, s[12:15], s35 offen offset:3072 sc1
s_add_u32 s35, s57, 28672
buffer_load_dwordx4 v[144:147], v1, s[12:15], s35 offen offset:0 sc1
buffer_load_dwordx4 v[148:151], v1, s[12:15], s35 offen offset:1024 sc1
buffer_load_dwordx4 v[152:155], v1, s[12:15], s35 offen offset:2048 sc1
buffer_load_dwordx4 v[156:159], v1, s[12:15], s35 offen offset:3072 sc1
v_max3_f32 v13, v32, v33, v8
v_max3_f32 v13, v13, v34, v35
v_max3_f32 v13, v13, v48, v49
v_max3_f32 v13, v13, v50, v51
v_max3_f32 v13, v13, v64, v65
v_max3_f32 v13, v13, v66, v67
v_max3_f32 v13, v13, v80, v81
v_max3_f32 v13, v13, v82, v83
v_mov_b32 v14, v13
s_nop 1
v_permlane16_swap_b32 v13, v14
v_max_f32 v13, v13, v14
v_mov_b32 v14, v13
s_nop 1
v_permlane32_swap_b32 v13, v14
v_max_f32 v13, v13, v14
v_sub_f32 v12, v8, v13
v_exp_f32 v12, v12
v_mov_b32 v8, v13
v_sub_f32 v32, v32, v13
v_sub_f32 v33, v33, v13
v_sub_f32 v34, v34, v13
v_sub_f32 v35, v35, v13
v_sub_f32 v48, v48, v13
v_sub_f32 v49, v49, v13
v_sub_f32 v50, v50, v13
v_sub_f32 v51, v51, v13
v_sub_f32 v64, v64, v13
v_sub_f32 v65, v65, v13
v_sub_f32 v66, v66, v13
v_sub_f32 v67, v67, v13
v_sub_f32 v80, v80, v13
v_sub_f32 v81, v81, v13
v_sub_f32 v82, v82, v13
v_sub_f32 v83, v83, v13
v_mul_f32 v160, v160, v12
v_mul_f32 v161, v161, v12
v_mul_f32 v162, v162, v12
v_mul_f32 v163, v163, v12
v_mul_f32 v176, v176, v12
v_mul_f32 v177, v177, v12
v_mul_f32 v178, v178, v12
v_mul_f32 v179, v179, v12
v_mul_f32 v192, v192, v12
v_mul_f32 v193, v193, v12
v_mul_f32 v194, v194, v12
v_mul_f32 v195, v195, v12
v_mul_f32 v208, v208, v12
v_mul_f32 v209, v209, v12
v_mul_f32 v210, v210, v12
v_mul_f32 v211, v211, v12
v_mul_f32 v224, v224, v12
v_mul_f32 v225, v225, v12
v_mul_f32 v226, v226, v12
v_mul_f32 v227, v227, v12
v_mul_f32 v240, v240, v12
v_mul_f32 v241, v241, v12
v_mul_f32 v242, v242, v12
v_mul_f32 v243, v243, v12
v_accvgpr_read_b32 v14, a64
v_mul_f32 v14, v14, v12
v_accvgpr_write_b32 a64, v14
v_accvgpr_read_b32 v14, a65
v_mul_f32 v14, v14, v12
v_accvgpr_write_b32 a65, v14
v_accvgpr_read_b32 v14, a66
v_mul_f32 v14, v14, v12
v_accvgpr_write_b32 a66, v14
v_accvgpr_read_b32 v14, a67
v_mul_f32 v14, v14, v12
v_accvgpr_write_b32 a67, v14
v_accvgpr_read_b32 v14, a80
v_mul_f32 v14, v14, v12
v_accvgpr_write_b32 a80, v14
v_accvgpr_read_b32 v14, a81
v_mul_f32 v14, v14, v12
v_accvgpr_write_b32 a81, v14
v_accvgpr_read_b32 v14, a82
v_mul_f32 v14, v14, v12
v_accvgpr_write_b32 a82, v14
v_accvgpr_read_b32 v14, a83
v_mul_f32 v14, v14, v12
v_accvgpr_write_b32 a83, v14
v_accvgpr_read_b32 v14, a96
v_mul_f32 v14, v14, v12
v_accvgpr_write_b32 a96, v14
v_accvgpr_read_b32 v14, a97
v_mul_f32 v14, v14, v12
v_accvgpr_write_b32 a97, v14
v_accvgpr_read_b32 v14, a98
v_mul_f32 v14, v14, v12
v_accvgpr_write_b32 a98, v14
v_accvgpr_read_b32 v14, a99
v_mul_f32 v14, v14, v12
v_accvgpr_write_b32 a99, v14
v_max3_f32 v13, v36, v37, v9
v_max3_f32 v13, v13, v38, v39
v_max3_f32 v13, v13, v52, v53
v_max3_f32 v13, v13, v54, v55
v_max3_f32 v13, v13, v68, v69
v_max3_f32 v13, v13, v70, v71
v_max3_f32 v13, v13, v84, v85
v_max3_f32 v13, v13, v86, v87
v_mov_b32 v14, v13
s_nop 1
v_permlane16_swap_b32 v13, v14
v_max_f32 v13, v13, v14
v_mov_b32 v14, v13
s_nop 1
v_permlane32_swap_b32 v13, v14
v_max_f32 v13, v13, v14
v_sub_f32 v12, v9, v13
v_exp_f32 v12, v12
v_mov_b32 v9, v13
v_sub_f32 v36, v36, v13
v_sub_f32 v37, v37, v13
v_sub_f32 v38, v38, v13
v_sub_f32 v39, v39, v13
v_sub_f32 v52, v52, v13
v_sub_f32 v53, v53, v13
v_sub_f32 v54, v54, v13
v_sub_f32 v55, v55, v13
v_sub_f32 v68, v68, v13
v_sub_f32 v69, v69, v13
v_sub_f32 v70, v70, v13
v_sub_f32 v71, v71, v13
v_sub_f32 v84, v84, v13
v_sub_f32 v85, v85, v13
v_sub_f32 v86, v86, v13
v_sub_f32 v87, v87, v13
v_mul_f32 v164, v164, v12
v_mul_f32 v165, v165, v12
v_mul_f32 v166, v166, v12
v_mul_f32 v167, v167, v12
v_mul_f32 v180, v180, v12
v_mul_f32 v181, v181, v12
v_mul_f32 v182, v182, v12
v_mul_f32 v183, v183, v12
v_mul_f32 v196, v196, v12
v_mul_f32 v197, v197, v12
v_mul_f32 v198, v198, v12
v_mul_f32 v199, v199, v12
v_mul_f32 v212, v212, v12
v_mul_f32 v213, v213, v12
v_mul_f32 v214, v214, v12
v_mul_f32 v215, v215, v12
v_mul_f32 v228, v228, v12
v_mul_f32 v229, v229, v12
v_mul_f32 v230, v230, v12
v_mul_f32 v231, v231, v12
v_mul_f32 v244, v244, v12
v_mul_f32 v245, v245, v12
v_mul_f32 v246, v246, v12
v_mul_f32 v247, v247, v12
v_accvgpr_read_b32 v14, a68
v_mul_f32 v14, v14, v12
v_accvgpr_write_b32 a68, v14
v_accvgpr_read_b32 v14, a69
v_mul_f32 v14, v14, v12
v_accvgpr_write_b32 a69, v14
v_accvgpr_read_b32 v14, a70
v_mul_f32 v14, v14, v12
v_accvgpr_write_b32 a70, v14
v_accvgpr_read_b32 v14, a71
v_mul_f32 v14, v14, v12
v_accvgpr_write_b32 a71, v14
v_accvgpr_read_b32 v14, a84
v_mul_f32 v14, v14, v12
v_accvgpr_write_b32 a84, v14
v_accvgpr_read_b32 v14, a85
v_mul_f32 v14, v14, v12
v_accvgpr_write_b32 a85, v14
v_accvgpr_read_b32 v14, a86
v_mul_f32 v14, v14, v12
v_accvgpr_write_b32 a86, v14
v_accvgpr_read_b32 v14, a87
v_mul_f32 v14, v14, v12
v_accvgpr_write_b32 a87, v14
v_accvgpr_read_b32 v14, a100
v_mul_f32 v14, v14, v12
v_accvgpr_write_b32 a100, v14
v_accvgpr_read_b32 v14, a101
v_mul_f32 v14, v14, v12
v_accvgpr_write_b32 a101, v14
v_accvgpr_read_b32 v14, a102
v_mul_f32 v14, v14, v12
v_accvgpr_write_b32 a102, v14
v_accvgpr_read_b32 v14, a103
v_mul_f32 v14, v14, v12
v_accvgpr_write_b32 a103, v14
v_max3_f32 v13, v40, v41, v10
v_max3_f32 v13, v13, v42, v43
v_max3_f32 v13, v13, v56, v57
v_max3_f32 v13, v13, v58, v59
v_max3_f32 v13, v13, v72, v73
v_max3_f32 v13, v13, v74, v75
v_max3_f32 v13, v13, v88, v89
v_max3_f32 v13, v13, v90, v91
v_mov_b32 v14, v13
s_nop 1
v_permlane16_swap_b32 v13, v14
v_max_f32 v13, v13, v14
v_mov_b32 v14, v13
s_nop 1
v_permlane32_swap_b32 v13, v14
v_max_f32 v13, v13, v14
v_sub_f32 v12, v10, v13
v_exp_f32 v12, v12
v_mov_b32 v10, v13
v_sub_f32 v40, v40, v13
v_sub_f32 v41, v41, v13
v_sub_f32 v42, v42, v13
v_sub_f32 v43, v43, v13
v_sub_f32 v56, v56, v13
v_sub_f32 v57, v57, v13
v_sub_f32 v58, v58, v13
v_sub_f32 v59, v59, v13
v_sub_f32 v72, v72, v13
v_sub_f32 v73, v73, v13
v_sub_f32 v74, v74, v13
v_sub_f32 v75, v75, v13
v_sub_f32 v88, v88, v13
v_sub_f32 v89, v89, v13
v_sub_f32 v90, v90, v13
v_sub_f32 v91, v91, v13
v_mul_f32 v168, v168, v12
v_mul_f32 v169, v169, v12
v_mul_f32 v170, v170, v12
v_mul_f32 v171, v171, v12
v_mul_f32 v184, v184, v12
v_mul_f32 v185, v185, v12
v_mul_f32 v186, v186, v12
v_mul_f32 v187, v187, v12
v_mul_f32 v200, v200, v12
v_mul_f32 v201, v201, v12
v_mul_f32 v202, v202, v12
v_mul_f32 v203, v203, v12
v_mul_f32 v216, v216, v12
v_mul_f32 v217, v217, v12
v_mul_f32 v218, v218, v12
v_mul_f32 v219, v219, v12
v_mul_f32 v232, v232, v12
v_mul_f32 v233, v233, v12
v_mul_f32 v234, v234, v12
v_mul_f32 v235, v235, v12
v_mul_f32 v248, v248, v12
v_mul_f32 v249, v249, v12
v_mul_f32 v250, v250, v12
v_mul_f32 v251, v251, v12
v_accvgpr_read_b32 v14, a72
v_mul_f32 v14, v14, v12
v_accvgpr_write_b32 a72, v14
v_accvgpr_read_b32 v14, a73
v_mul_f32 v14, v14, v12
v_accvgpr_write_b32 a73, v14
v_accvgpr_read_b32 v14, a74
v_mul_f32 v14, v14, v12
v_accvgpr_write_b32 a74, v14
v_accvgpr_read_b32 v14, a75
v_mul_f32 v14, v14, v12
v_accvgpr_write_b32 a75, v14
v_accvgpr_read_b32 v14, a88
v_mul_f32 v14, v14, v12
v_accvgpr_write_b32 a88, v14
v_accvgpr_read_b32 v14, a89
v_mul_f32 v14, v14, v12
v_accvgpr_write_b32 a89, v14
v_accvgpr_read_b32 v14, a90
v_mul_f32 v14, v14, v12
v_accvgpr_write_b32 a90, v14
v_accvgpr_read_b32 v14, a91
v_mul_f32 v14, v14, v12
v_accvgpr_write_b32 a91, v14
v_accvgpr_read_b32 v14, a104
v_mul_f32 v14, v14, v12
v_accvgpr_write_b32 a104, v14
v_accvgpr_read_b32 v14, a105
v_mul_f32 v14, v14, v12
v_accvgpr_write_b32 a105, v14
v_accvgpr_read_b32 v14, a106
v_mul_f32 v14, v14, v12
v_accvgpr_write_b32 a106, v14
v_accvgpr_read_b32 v14, a107
v_mul_f32 v14, v14, v12
v_accvgpr_write_b32 a107, v14
v_max3_f32 v13, v44, v45, v11
v_max3_f32 v13, v13, v46, v47
v_max3_f32 v13, v13, v60, v61
v_max3_f32 v13, v13, v62, v63
v_max3_f32 v13, v13, v76, v77
v_max3_f32 v13, v13, v78, v79
v_max3_f32 v13, v13, v92, v93
v_max3_f32 v13, v13, v94, v95
v_mov_b32 v14, v13
s_nop 1
v_permlane16_swap_b32 v13, v14
v_max_f32 v13, v13, v14
v_mov_b32 v14, v13
s_nop 1
v_permlane32_swap_b32 v13, v14
v_max_f32 v13, v13, v14
v_sub_f32 v12, v11, v13
v_exp_f32 v12, v12
v_mov_b32 v11, v13
v_sub_f32 v44, v44, v13
v_sub_f32 v45, v45, v13
v_sub_f32 v46, v46, v13
v_sub_f32 v47, v47, v13
v_sub_f32 v60, v60, v13
v_sub_f32 v61, v61, v13
v_sub_f32 v62, v62, v13
v_sub_f32 v63, v63, v13
v_sub_f32 v76, v76, v13
v_sub_f32 v77, v77, v13
v_sub_f32 v78, v78, v13
v_sub_f32 v79, v79, v13
v_sub_f32 v92, v92, v13
v_sub_f32 v93, v93, v13
v_sub_f32 v94, v94, v13
v_sub_f32 v95, v95, v13
v_mul_f32 v172, v172, v12
v_mul_f32 v173, v173, v12
v_mul_f32 v174, v174, v12
v_mul_f32 v175, v175, v12
v_mul_f32 v188, v188, v12
v_mul_f32 v189, v189, v12
v_mul_f32 v190, v190, v12
v_mul_f32 v191, v191, v12
v_mul_f32 v204, v204, v12
v_mul_f32 v205, v205, v12
v_mul_f32 v206, v206, v12
v_mul_f32 v207, v207, v12
v_mul_f32 v220, v220, v12
v_mul_f32 v221, v221, v12
v_mul_f32 v222, v222, v12
v_mul_f32 v223, v223, v12
v_mul_f32 v236, v236, v12
v_mul_f32 v237, v237, v12
v_mul_f32 v238, v238, v12
v_mul_f32 v239, v239, v12
v_mul_f32 v252, v252, v12
v_mul_f32 v253, v253, v12
v_mul_f32 v254, v254, v12
v_mul_f32 v255, v255, v12
v_accvgpr_read_b32 v14, a76
v_mul_f32 v14, v14, v12
v_accvgpr_write_b32 a76, v14
v_accvgpr_read_b32 v14, a77
v_mul_f32 v14, v14, v12
v_accvgpr_write_b32 a77, v14
v_accvgpr_read_b32 v14, a78
v_mul_f32 v14, v14, v12
v_accvgpr_write_b32 a78, v14
v_accvgpr_read_b32 v14, a79
v_mul_f32 v14, v14, v12
v_accvgpr_write_b32 a79, v14
v_accvgpr_read_b32 v14, a92
v_mul_f32 v14, v14, v12
v_accvgpr_write_b32 a92, v14
v_accvgpr_read_b32 v14, a93
v_mul_f32 v14, v14, v12
v_accvgpr_write_b32 a93, v14
v_accvgpr_read_b32 v14, a94
v_mul_f32 v14, v14, v12
v_accvgpr_write_b32 a94, v14
v_accvgpr_read_b32 v14, a95
v_mul_f32 v14, v14, v12
v_accvgpr_write_b32 a95, v14
v_accvgpr_read_b32 v14, a108
v_mul_f32 v14, v14, v12
v_accvgpr_write_b32 a108, v14
v_accvgpr_read_b32 v14, a109
v_mul_f32 v14, v14, v12
v_accvgpr_write_b32 a109, v14
v_accvgpr_read_b32 v14, a110
v_mul_f32 v14, v14, v12
v_accvgpr_write_b32 a110, v14
v_accvgpr_read_b32 v14, a111
v_mul_f32 v14, v14, v12
v_accvgpr_write_b32 a111, v14
v_exp_f32 v32, v32
v_exp_f32 v33, v33
v_exp_f32 v34, v34
v_exp_f32 v35, v35
v_exp_f32 v48, v48
v_exp_f32 v49, v49
v_exp_f32 v50, v50
v_exp_f32 v51, v51
v_cvt_pk_bf16_f32 v32, v32, v33
v_cvt_pk_bf16_f32 v33, v34, v35
v_exp_f32 v36, v36
v_exp_f32 v37, v37
v_exp_f32 v38, v38
v_exp_f32 v39, v39
v_cvt_pk_bf16_f32 v34, v48, v49
v_cvt_pk_bf16_f32 v35, v50, v51
v_exp_f32 v52, v52
v_exp_f32 v53, v53
v_exp_f32 v54, v54
v_exp_f32 v55, v55
v_cvt_pk_bf16_f32 v36, v36, v37
v_cvt_pk_bf16_f32 v37, v38, v39
v_exp_f32 v40, v40
v_exp_f32 v41, v41
v_exp_f32 v42, v42
v_exp_f32 v43, v43
v_cvt_pk_bf16_f32 v38, v52, v53
v_cvt_pk_bf16_f32 v39, v54, v55
v_exp_f32 v56, v56
v_exp_f32 v57, v57
v_exp_f32 v58, v58
v_exp_f32 v59, v59
v_cvt_pk_bf16_f32 v40, v40, v41
v_cvt_pk_bf16_f32 v41, v42, v43
v_exp_f32 v44, v44
v_exp_f32 v45, v45
v_exp_f32 v46, v46
v_exp_f32 v47, v47
v_cvt_pk_bf16_f32 v42, v56, v57
v_cvt_pk_bf16_f32 v43, v58, v59
v_exp_f32 v60, v60
v_exp_f32 v61, v61
v_exp_f32 v62, v62
v_exp_f32 v63, v63
v_cvt_pk_bf16_f32 v44, v44, v45
v_cvt_pk_bf16_f32 v45, v46, v47
v_cvt_pk_bf16_f32 v46, v60, v61
v_cvt_pk_bf16_f32 v47, v62, v63
v_exp_f32 v64, v64
v_exp_f32 v65, v65
v_exp_f32 v66, v66
v_exp_f32 v67, v67
v_exp_f32 v80, v80
v_exp_f32 v81, v81
v_exp_f32 v82, v82
v_exp_f32 v83, v83
v_cvt_pk_bf16_f32 v64, v64, v65
v_cvt_pk_bf16_f32 v65, v66, v67
v_exp_f32 v68, v68
v_exp_f32 v69, v69
v_exp_f32 v70, v70
v_exp_f32 v71, v71
v_cvt_pk_bf16_f32 v66, v80, v81
v_cvt_pk_bf16_f32 v67, v82, v83
v_exp_f32 v84, v84
v_exp_f32 v85, v85
v_exp_f32 v86, v86
v_exp_f32 v87, v87
v_cvt_pk_bf16_f32 v68, v68, v69
v_cvt_pk_bf16_f32 v69, v70, v71
v_exp_f32 v72, v72
v_exp_f32 v73, v73
v_exp_f32 v74, v74
v_exp_f32 v75, v75
v_cvt_pk_bf16_f32 v70, v84, v85
v_cvt_pk_bf16_f32 v71, v86, v87
v_exp_f32 v88, v88
v_exp_f32 v89, v89
v_exp_f32 v90, v90
v_exp_f32 v91, v91
v_cvt_pk_bf16_f32 v72, v72, v73
v_cvt_pk_bf16_f32 v73, v74, v75
v_exp_f32 v76, v76
v_exp_f32 v77, v77
v_exp_f32 v78, v78
v_exp_f32 v79, v79
v_cvt_pk_bf16_f32 v74, v88, v89
v_cvt_pk_bf16_f32 v75, v90, v91
v_exp_f32 v92, v92
v_exp_f32 v93, v93
v_exp_f32 v94, v94
v_exp_f32 v95, v95
v_cvt_pk_bf16_f32 v76, v76, v77
v_cvt_pk_bf16_f32 v77, v78, v79
v_cvt_pk_bf16_f32 v78, v92, v93
v_cvt_pk_bf16_f32 v79, v94, v95
s_waitcnt vmcnt(0)
M a[96:99], a[112:115], v[32:35], a[96:99]
M a[100:103], a[112:115], v[36:39], a[100:103]
M a[104:107], a[112:115], v[40:43], a[104:107]
M a[108:111], a[112:115], v[44:47], a[108:111]
M v[160:163], v[96:99], v[32:35], v[160:163]
M v[164:167], v[96:99], v[36:39], v[164:167]
M v[168:171], v[96:99], v[40:43], v[168:171]
M v[172:175], v[96:99], v[44:47], v[172:175]
M v[176:179], v[100:103], v[32:35], v[176:179]
M v[180:183], v[100:103], v[36:39], v[180:183]
M v[184:187], v[100:103], v[40:43], v[184:187]
M v[188:191], v[100:103], v[44:47], v[188:191]
M v[192:195], v[104:107], v[32:35], v[192:195]
M v[196:199], v[104:107], v[36:39], v[196:199]
M v[200:203], v[104:107], v[40:43], v[200:203]
M v[204:207], v[104:107], v[44:47], v[204:207]
M v[208:211], v[108:111], v[32:35], v[208:211]
M v[212:215], v[108:111], v[36:39], v[212:215]
M v[216:219], v[108:111], v[40:43], v[216:219]
M v[220:223], v[108:111], v[44:47], v[220:223]
M v[224:227], v[112:115], v[32:35], v[224:227]
M v[228:231], v[112:115], v[36:39], v[228:231]
M v[232:235], v[112:115], v[40:43], v[232:235]
M v[236:239], v[112:115], v[44:47], v[236:239]
M v[240:243], v[116:119], v[32:35], v[240:243]
M v[244:247], v[116:119], v[36:39], v[244:247]
M v[248:251], v[116:119], v[40:43], v[248:251]
M v[252:255], v[116:119], v[44:47], v[252:255]
M a[64:67], v[120:123], v[32:35], a[64:67]
M a[68:71], v[120:123], v[36:39], a[68:71]
M a[72:75], v[120:123], v[40:43], a[72:75]
M a[76:79], v[120:123], v[44:47], a[76:79]
M a[80:83], v[124:127], v[32:35], a[80:83]
M a[84:87], v[124:127], v[36:39], a[84:87]
M a[88:91], v[124:127], v[40:43], a[88:91]
M a[92:95], v[124:127], v[44:47], a[92:95]
M a[96:99], a[112:115], v[64:67], a[96:99]
M a[100:103], a[112:115], v[68:71], a[100:103]
M a[104:107], a[112:115], v[72:75], a[104:107]
M a[108:111], a[112:115], v[76:79], a[108:111]
M v[160:163], v[128:131], v[64:67], v[160:163]
M v[164:167], v[128:131], v[68:71], v[164:167]
M v[168:171], v[128:131], v[72:75], v[168:171]
M v[172:175], v[128:131], v[76:79], v[172:175]
M v[176:179], v[132:135], v[64:67], v[176:179]
M v[180:183], v[132:135], v[68:71], v[180:183]
M v[184:187], v[132:135], v[72:75], v[184:187]
M v[188:191], v[132:135], v[76:79], v[188:191]
M v[192:195], v[136:139], v[64:67], v[192:195]
M v[196:199], v[136:139], v[68:71], v[196:199]
M v[200:203], v[136:139], v[72:75], v[200:203]
M v[204:207], v[136:139], v[76:79], v[204:207]
M v[208:211], v[140:143], v[64:67], v[208:211]
M v[212:215], v[140:143], v[68:71], v[212:215]
M v[216:219], v[140:143], v[72:75], v[216:219]
M v[220:223], v[140:143], v[76:79], v[220:223]
M v[224:227], v[144:147], v[64:67], v[224:227]
M v[228:231], v[144:147], v[68:71], v[228:231]
M v[232:235], v[144:147], v[72:75], v[232:235]
M v[236:239], v[144:147], v[76:79], v[236:239]
M v[240:243], v[148:151], v[64:67], v[240:243]
M v[244:247], v[148:151], v[68:71], v[244:247]
M v[248:251], v[148:151], v[72:75], v[248:251]
M v[252:255], v[148:151], v[76:79], v[252:255]
M a[64:67], v[152:155], v[64:67], a[64:67]
M a[68:71], v[152:155], v[68:71], a[68:71]
M a[72:75], v[152:155], v[72:75], a[72:75]
M a[76:79], v[152:155], v[76:79], a[76:79]
M a[80:83], v[156:159], v[64:67], a[80:83]
M a[84:87], v[156:159], v[68:71], a[84:87]
M a[88:91], v[156:159], v[72:75], a[88:91]
M a[92:95], v[156:159], v[76:79], a[92:95]
s_nop 7
s_add_u32 s57, s57, 32768
s_sub_u32 s58, s58, 64
s_sub_u32 s59, s59, 1
s_cmp_lg_u32 s59, 0
s_cbranch_scc1 Lslow_8
v_accvgpr_read_b32 v20, a96
v_accvgpr_read_b32 v21, a100
v_accvgpr_read_b32 v22, a104
v_accvgpr_read_b32 v23, a108
v_rcp_f32 v8, v20
v_rcp_f32 v9, v21
v_rcp_f32 v10, v22
v_rcp_f32 v11, v23
v_pk_mul_f32 v[160:161], v[160:161], v[8:9] op_sel:[0,0] op_sel_hi:[1,0]
v_pk_mul_f32 v[162:163], v[162:163], v[8:9] op_sel:[0,0] op_sel_hi:[1,0]
v_pk_mul_f32 v[176:177], v[176:177], v[8:9] op_sel:[0,0] op_sel_hi:[1,0]
v_pk_mul_f32 v[178:179], v[178:179], v[8:9] op_sel:[0,0] op_sel_hi:[1,0]
v_cvt_pk_bf16_f32 v160, v160, v161
v_cvt_pk_bf16_f32 v161, v162, v163
v_cvt_pk_bf16_f32 v162, v176, v177
v_cvt_pk_bf16_f32 v163, v178, v179
v_pk_mul_f32 v[164:165], v[164:165], v[8:9] op_sel:[0,1] op_sel_hi:[1,1]
v_pk_mul_f32 v[166:167], v[166:167], v[8:9] op_sel:[0,1] op_sel_hi:[1,1]
v_pk_mul_f32 v[180:181], v[180:181], v[8:9] op_sel:[0,1] op_sel_hi:[1,1]
v_pk_mul_f32 v[182:183], v[182:183], v[8:9] op_sel:[0,1] op_sel_hi:[1,1]
v_cvt_pk_bf16_f32 v164, v164, v165
v_cvt_pk_bf16_f32 v165, v166, v167
v_cvt_pk_bf16_f32 v166, v180, v181
v_cvt_pk_bf16_f32 v167, v182, v183
v_pk_mul_f32 v[168:169], v[168:169], v[10:11] op_sel:[0,0] op_sel_hi:[1,0]
v_pk_mul_f32 v[170:171], v[170:171], v[10:11] op_sel:[0,0] op_sel_hi:[1,0]
v_pk_mul_f32 v[184:185], v[184:185], v[10:11] op_sel:[0,0] op_sel_hi:[1,0]
v_pk_mul_f32 v[186:187], v[186:187], v[10:11] op_sel:[0,0] op_sel_hi:[1,0]
v_cvt_pk_bf16_f32 v168, v168, v169
v_cvt_pk_bf16_f32 v169, v170, v171
v_cvt_pk_bf16_f32 v170, v184, v185
v_cvt_pk_bf16_f32 v171, v186, v187
v_pk_mul_f32 v[172:173], v[172:173], v[10:11] op_sel:[0,1] op_sel_hi:[1,1]
v_pk_mul_f32 v[174:175], v[174:175], v[10:11] op_sel:[0,1] op_sel_hi:[1,1]
v_pk_mul_f32 v[188:189], v[188:189], v[10:11] op_sel:[0,1] op_sel_hi:[1,1]
v_pk_mul_f32 v[190:191], v[190:191], v[10:11] op_sel:[0,1] op_sel_hi:[1,1]
v_cvt_pk_bf16_f32 v172, v172, v173
v_cvt_pk_bf16_f32 v173, v174, v175
v_cvt_pk_bf16_f32 v174, v188, v189
v_cvt_pk_bf16_f32 v175, v190, v191
v_pk_mul_f32 v[192:193], v[192:193], v[8:9] op_sel:[0,0] op_sel_hi:[1,0]
v_pk_mul_f32 v[194:195], v[194:195], v[8:9] op_sel:[0,0] op_sel_hi:[1,0]
v_pk_mul_f32 v[208:209], v[208:209], v[8:9] op_sel:[0,0] op_sel_hi:[1,0]
v_pk_mul_f32 v[210:211], v[210:211], v[8:9] op_sel:[0,0] op_sel_hi:[1,0]
v_cvt_pk_bf16_f32 v192, v192, v193
v_cvt_pk_bf16_f32 v193, v194, v195
v_cvt_pk_bf16_f32 v194, v208, v209
v_cvt_pk_bf16_f32 v195, v210, v211
v_pk_mul_f32 v[196:197], v[196:197], v[8:9] op_sel:[0,1] op_sel_hi:[1,1]
v_pk_mul_f32 v[198:199], v[198:199], v[8:9] op_sel:[0,1] op_sel_hi:[1,1]
v_pk_mul_f32 v[212:213], v[212:213], v[8:9] op_sel:[0,1] op_sel_hi:[1,1]
v_pk_mul_f32 v[214:215], v[214:215], v[8:9] op_sel:[0,1] op_sel_hi:[1,1]
v_cvt_pk_bf16_f32 v196, v196, v197
v_cvt_pk_bf16_f32 v197, v198, v199
v_cvt_pk_bf16_f32 v198, v212, v213
v_cvt_pk_bf16_f32 v199, v214, v215
v_pk_mul_f32 v[200:201], v[200:201], v[10:11] op_sel:[0,0] op_sel_hi:[1,0]
v_pk_mul_f32 v[202:203], v[202:203], v[10:11] op_sel:[0,0] op_sel_hi:[1,0]
v_pk_mul_f32 v[216:217], v[216:217], v[10:11] op_sel:[0,0] op_sel_hi:[1,0]
v_pk_mul_f32 v[218:219], v[218:219], v[10:11] op_sel:[0,0] op_sel_hi:[1,0]
v_cvt_pk_bf16_f32 v200, v200, v201
v_cvt_pk_bf16_f32 v201, v202, v203
v_cvt_pk_bf16_f32 v202, v216, v217
v_cvt_pk_bf16_f32 v203, v218, v219
v_pk_mul_f32 v[204:205], v[204:205], v[10:11] op_sel:[0,1] op_sel_hi:[1,1]
v_pk_mul_f32 v[206:207], v[206:207], v[10:11] op_sel:[0,1] op_sel_hi:[1,1]
v_pk_mul_f32 v[220:221], v[220:221], v[10:11] op_sel:[0,1] op_sel_hi:[1,1]
v_pk_mul_f32 v[222:223], v[222:223], v[10:11] op_sel:[0,1] op_sel_hi:[1,1]
v_cvt_pk_bf16_f32 v204, v204, v205
v_cvt_pk_bf16_f32 v205, v206, v207
v_cvt_pk_bf16_f32 v206, v220, v221
v_cvt_pk_bf16_f32 v207, v222, v223
v_pk_mul_f32 v[224:225], v[224:225], v[8:9] op_sel:[0,0] op_sel_hi:[1,0]
v_pk_mul_f32 v[226:227], v[226:227], v[8:9] op_sel:[0,0] op_sel_hi:[1,0]
v_pk_mul_f32 v[240:241], v[240:241], v[8:9] op_sel:[0,0] op_sel_hi:[1,0]
v_pk_mul_f32 v[242:243], v[242:243], v[8:9] op_sel:[0,0] op_sel_hi:[1,0]
v_cvt_pk_bf16_f32 v224, v224, v225
v_cvt_pk_bf16_f32 v225, v226, v227
v_cvt_pk_bf16_f32 v226, v240, v241
v_cvt_pk_bf16_f32 v227, v242, v243
v_pk_mul_f32 v[228:229], v[228:229], v[8:9] op_sel:[0,1] op_sel_hi:[1,1]
v_pk_mul_f32 v[230:231], v[230:231], v[8:9] op_sel:[0,1] op_sel_hi:[1,1]
v_pk_mul_f32 v[244:245], v[244:245], v[8:9] op_sel:[0,1] op_sel_hi:[1,1]
v_pk_mul_f32 v[246:247], v[246:247], v[8:9] op_sel:[0,1] op_sel_hi:[1,1]
v_cvt_pk_bf16_f32 v228, v228, v229
v_cvt_pk_bf16_f32 v229, v230, v231
v_cvt_pk_bf16_f32 v230, v244, v245
v_cvt_pk_bf16_f32 v231, v246, v247
v_pk_mul_f32 v[232:233], v[232:233], v[10:11] op_sel:[0,0] op_sel_hi:[1,0]
v_pk_mul_f32 v[234:235], v[234:235], v[10:11] op_sel:[0,0] op_sel_hi:[1,0]
v_pk_mul_f32 v[248:249], v[248:249], v[10:11] op_sel:[0,0] op_sel_hi:[1,0]
v_pk_mul_f32 v[250:251], v[250:251], v[10:11] op_sel:[0,0] op_sel_hi:[1,0]
v_cvt_pk_bf16_f32 v232, v232, v233
v_cvt_pk_bf16_f32 v233, v234, v235
v_cvt_pk_bf16_f32 v234, v248, v249
v_cvt_pk_bf16_f32 v235, v250, v251
v_pk_mul_f32 v[236:237], v[236:237], v[10:11] op_sel:[0,1] op_sel_hi:[1,1]
v_pk_mul_f32 v[238:239], v[238:239], v[10:11] op_sel:[0,1] op_sel_hi:[1,1]
v_pk_mul_f32 v[252:253], v[252:253], v[10:11] op_sel:[0,1] op_sel_hi:[1,1]
v_pk_mul_f32 v[254:255], v[254:255], v[10:11] op_sel:[0,1] op_sel_hi:[1,1]
v_cvt_pk_bf16_f32 v236, v236, v237
v_cvt_pk_bf16_f32 v237, v238, v239
v_cvt_pk_bf16_f32 v238, v252, v253
v_cvt_pk_bf16_f32 v239, v254, v255
v_accvgpr_read_b32 v176, a64
v_accvgpr_read_b32 v177, a65
v_accvgpr_read_b32 v178, a66
v_accvgpr_read_b32 v179, a67
v_accvgpr_read_b32 v180, a80
v_accvgpr_read_b32 v181, a81
v_accvgpr_read_b32 v182, a82
v_accvgpr_read_b32 v183, a83
v_pk_mul_f32 v[176:177], v[176:177], v[8:9] op_sel:[0,0] op_sel_hi:[1,0]
v_pk_mul_f32 v[178:179], v[178:179], v[8:9] op_sel:[0,0] op_sel_hi:[1,0]
v_pk_mul_f32 v[180:181], v[180:181], v[8:9] op_sel:[0,0] op_sel_hi:[1,0]
v_pk_mul_f32 v[182:183], v[182:183], v[8:9] op_sel:[0,0] op_sel_hi:[1,0]
v_cvt_pk_bf16_f32 v176, v176, v177
v_cvt_pk_bf16_f32 v177, v178, v179
v_cvt_pk_bf16_f32 v178, v180, v181
v_cvt_pk_bf16_f32 v179, v182, v183
v_accvgpr_read_b32 v184, a68
v_accvgpr_read_b32 v185, a69
v_accvgpr_read_b32 v186, a70
v_accvgpr_read_b32 v187, a71
v_accvgpr_read_b32 v188, a84
v_accvgpr_read_b32 v189, a85
v_accvgpr_read_b32 v190, a86
v_accvgpr_read_b32 v191, a87
v_pk_mul_f32 v[184:185], v[184:185], v[8:9] op_sel:[0,1] op_sel_hi:[1,1]
v_pk_mul_f32 v[186:187], v[186:187], v[8:9] op_sel:[0,1] op_sel_hi:[1,1]
v_pk_mul_f32 v[188:189], v[188:189], v[8:9] op_sel:[0,1] op_sel_hi:[1,1]
v_pk_mul_f32 v[190:191], v[190:191], v[8:9] op_sel:[0,1] op_sel_hi:[1,1]
v_cvt_pk_bf16_f32 v184, v184, v185
v_cvt_pk_bf16_f32 v185, v186, v187
v_cvt_pk_bf16_f32 v186, v188, v189
v_cvt_pk_bf16_f32 v187, v190, v191
v_accvgpr_read_b32 v208, a72
v_accvgpr_read_b32 v209, a73
v_accvgpr_read_b32 v210, a74
v_accvgpr_read_b32 v211, a75
v_accvgpr_read_b32 v212, a88
v_accvgpr_read_b32 v213, a89
v_accvgpr_read_b32 v214, a90
v_accvgpr_read_b32 v215, a91
v_pk_mul_f32 v[208:209], v[208:209], v[10:11] op_sel:[0,0] op_sel_hi:[1,0]
v_pk_mul_f32 v[210:211], v[210:211], v[10:11] op_sel:[0,0] op_sel_hi:[1,0]
v_pk_mul_f32 v[212:213], v[212:213], v[10:11] op_sel:[0,0] op_sel_hi:[1,0]
v_pk_mul_f32 v[214:215], v[214:215], v[10:11] op_sel:[0,0] op_sel_hi:[1,0]
v_cvt_pk_bf16_f32 v208, v208, v209
v_cvt_pk_bf16_f32 v209, v210, v211
v_cvt_pk_bf16_f32 v210, v212, v213
v_cvt_pk_bf16_f32 v211, v214, v215
v_accvgpr_read_b32 v216, a76
v_accvgpr_read_b32 v217, a77
v_accvgpr_read_b32 v218, a78
v_accvgpr_read_b32 v219, a79
v_accvgpr_read_b32 v220, a92
v_accvgpr_read_b32 v221, a93
v_accvgpr_read_b32 v222, a94
v_accvgpr_read_b32 v223, a95
v_pk_mul_f32 v[216:217], v[216:217], v[10:11] op_sel:[0,1] op_sel_hi:[1,1]
v_pk_mul_f32 v[218:219], v[218:219], v[10:11] op_sel:[0,1] op_sel_hi:[1,1]
v_pk_mul_f32 v[220:221], v[220:221], v[10:11] op_sel:[0,1] op_sel_hi:[1,1]
v_pk_mul_f32 v[222:223], v[222:223], v[10:11] op_sel:[0,1] op_sel_hi:[1,1]
v_cvt_pk_bf16_f32 v216, v216, v217
v_cvt_pk_bf16_f32 v217, v218, v219
v_cvt_pk_bf16_f32 v218, v220, v221
v_cvt_pk_bf16_f32 v219, v222, v223
s_lshl_b32 s33, s56, 20
s_lshl_b32 s34, s20, 15
s_add_u32 s33, s33, s34
s_lshl_b32 s34, s23, 13
s_add_u32 s36, s33, s34
s_add_u32 s37, s36, 4096
s_add_u32 s38, s36, 16384
s_add_u32 s39, s36, 20480
s_bitcmp1_b32 s61, 0
s_cbranch_scc0 Lss_11
buffer_store_dwordx4 v[160:163], v1, s[16:19], s36 offen offset:0 sc1
buffer_store_dwordx4 v[164:167], v1, s[16:19], s36 offen offset:2048 sc1
buffer_store_dwordx4 v[168:171], v1, s[16:19], s37 offen offset:0 sc1
buffer_store_dwordx4 v[172:175], v1, s[16:19], s37 offen offset:2048 sc1
Lss_11:
s_bitcmp1_b32 s61, 1
s_cbranch_scc0 Lss_12
buffer_store_dwordx4 v[192:195], v1, s[16:19], s36 offen offset:1024 sc1
buffer_store_dwordx4 v[196:199], v1, s[16:19], s36 offen offset:3072 sc1
buffer_store_dwordx4 v[200:203], v1, s[16:19], s37 offen offset:1024 sc1
buffer_store_dwordx4 v[204:207], v1, s[16:19], s37 offen offset:3072 sc1
Lss_12:
s_bitcmp1_b32 s61, 2
s_cbranch_scc0 Lss_13
buffer_store_dwordx4 v[224:227], v1, s[16:19], s38 offen offset:0 sc1
buffer_store_dwordx4 v[228:231], v1, s[16:19], s38 offen offset:2048 sc1
buffer_store_dwordx4 v[232:235], v1, s[16:19], s39 offen offset:0 sc1
buffer_store_dwordx4 v[236:239], v1, s[16:19], s39 offen offset:2048 sc1
Lss_13:
s_bitcmp1_b32 s61, 3
s_cbranch_scc0 Lss_14
buffer_store_dwordx4 v[176:179], v1, s[16:19], s38 offen offset:1024 sc1
buffer_store_dwordx4 v[184:187], v1, s[16:19], s38 offen offset:3072 sc1
buffer_store_dwordx4 v[208:211], v1, s[16:19], s39 offen offset:1024 sc1
buffer_store_dwordx4 v[216:219], v1, s[16:19], s39 offen offset:3072 sc1
Lss_14:
s_branch Lk2_chk
Lk2_done:
s_lshl_b32 s33, s20, 4
s_add_u32 s33, s33, 8392704
s_sub_u32 s34, 15, s21
s_lshl_b32 s34, s34, 9
s_add_u32 s92, s33, s34
s_lshl_b32 s34, s22, 2
s_add_u32 s92, s92, s34
s_lshl_b32 s34, s21, 9
s_add_u32 s93, s33, s34
s_lshl_b32 s34, s23, 3
s_add_u32 s93, s93, s34
s_cmp_eq_u32 s24, 0
s_cselect_b32 s93, s93, s92
s_cselect_b32 s94, 4, 0
s_add_u32 s94, s94, s93
s_load_dwordx2 s[10:11], s[0:1], 40
s_load_dwordx2 s[14:15], s[0:1], 72
s_lshl_b32 s21, s27, 7
s_lshl_b32 s22, s28, 6
s_lshl_b32 s3, s101, 4
v_lshrrev_b32 v224, 3, v0
v_and_b32 v225, 6, v224
v_and_b32 v226, 7, v0
v_xor_b32 v225, v225, v226
v_add_u32 v224, s3, v224
v_lshlrev_b32 v224, 11, v224
v_lshl_add_u32 v6, v225, 4, v224
v_add_u32 v7, 15360, v6
v_lshrrev_b32 v224, 2, v0
v_and_b32 v226, 1, v0
v_bfe_u32 v229, v0, 1, 1
v_lshlrev_b32 v225, 7, v224
v_lshl_add_u32 v225, v226, 3, v225
v_and_b32 v228, 6, v224
v_add_u32 v227, 0, v229
v_xor_b32 v227, v227, v228
v_lshl_add_u32 v24, v227, 4, v225
v_add_u32 v28, 0x10000, v24
v_add_u32 v227, 2, v229
v_xor_b32 v227, v227, v228
v_lshl_add_u32 v25, v227, 4, v225
v_add_u32 v29, 0x10000, v25
v_add_u32 v227, 4, v229
v_xor_b32 v227, v227, v228
v_lshl_add_u32 v26, v227, 4, v225
v_add_u32 v30, 0x10000, v26
v_add_u32 v227, 6, v229
v_xor_b32 v227, v227, v228
v_lshl_add_u32 v27, v227, 4, v225
v_add_u32 v31, 0x10000, v27
s_waitcnt vmcnt(32)
s_barrier
ds_read_b64_tr_b16 v[96:97], v28 offset:0
ds_read_b64_tr_b16 v[98:99], v28 offset:2048
ds_read_b64_tr_b16 v[100:101], v28 offset:4096
ds_read_b64_tr_b16 v[102:103], v28 offset:6144
ds_read_b64_tr_b16 v[104:105], v29 offset:0
ds_read_b64_tr_b16 v[106:107], v29 offset:2048
ds_read_b64_tr_b16 v[108:109], v29 offset:4096
ds_read_b64_tr_b16 v[110:111], v29 offset:6144
ds_read_b64_tr_b16 v[112:113], v30 offset:0
ds_read_b64_tr_b16 v[114:115], v30 offset:2048
ds_read_b64_tr_b16 v[116:117], v30 offset:4096
ds_read_b64_tr_b16 v[118:119], v30 offset:6144
ds_read_b64_tr_b16 v[120:121], v31 offset:0
ds_read_b64_tr_b16 v[122:123], v31 offset:2048
ds_read_b64_tr_b16 v[124:125], v31 offset:4096
ds_read_b64_tr_b16 v[126:127], v31 offset:6144
s_and_b32 s40, s2, 1
s_bfe_u32 s3, s2, 0x10001
s_lshl_b32 s3, s3, 3
s_bfe_u32 s36, s2, 0x30003
s_add_u32 s36, s3, s36
s_lshl_b32 s29, s36, 7
s_bfe_u32 s3, s2, 0x10002
s_lshl_b32 s3, s3, 2
s_lshr_b32 s37, s2, 6
s_add_u32 s3, s3, s37
s_lshl_b32 s13, s3, 8
s_lshl_b32 s30, s3, 7
s_lshl_b32 s3, s40, 6
s_add_u32 s30, s30, s3
s_lshl_b32 s41, s101, 12
s_lshl_b32 s12, s36, 20
s_add_u32 s12, s12, s41
s_lshl_b32 s62, s36, 9
s_lshl_b32 s3, s40, 8
s_add_u32 s62, s62, s3
s_add_u32 s62, s62, 8392704
s_lshr_b32 s3, s2, 1
s_lshr_b32 s38, s2, 2
s_xor_b32 s3, s3, s38
s_and_b32 s3, s3, 1
s_lshl_b32 s3, s3, 4
s_sub_u32 s39, 32, s3
s_lshl_b32 s38, s40, 5
s_add_u32 s3, s3, s38
s_lshl_b32 s3, s3, 14
s_add_u32 s12, s12, s3
s_lshl_b32 s3, s3, 3
s_add_u32 s13, s13, s3
s_mov_b32 s64, 4294459392
s_mov_b32 s65, 16384
s_add_u32 s8, s4, 67108864
s_addc_u32 s9, s5, 0
s_lshl_b32 s56, s2, 15
s_lshl_b32 s38, s101, 13
s_add_u32 s56, s56, s38
s_xor_b32 s57, s56, 32768
s_lshl_b32 s58, s2, 2
s_add_u32 s58, s58, 8388608
s_xor_b32 s59, s58, 4
s_mov_b32 s61, 0
s_lshl_b32 s3, s101, 4
v_lshrrev_b32 v232, 4, v0
v_and_b32 v234, 15, v0
v_add_u32 v233, 0, v232
v_lshlrev_b32 v233, 1, v233
v_xor_b32 v233, v233, v234
v_add_u32 v235, s3, v232
v_lshlrev_b32 v235, 11, v235
v_lshl_add_u32 v235, v233, 4, v235
v_add_u32 v2, 0, v235
v_add_u32 v233, 4, v232
v_lshlrev_b32 v233, 1, v233
v_xor_b32 v233, v233, v234
v_add_u32 v235, s3, v232
v_lshlrev_b32 v235, 11, v235
v_lshl_add_u32 v235, v233, 4, v235
v_add_u32 v3, 7168, v235
v_add_u32 v233, 0, v232
v_lshlrev_b32 v233, 1, v233
v_xor_b32 v233, v233, v234
v_add_u32 v235, s3, v232
v_lshlrev_b32 v235, 11, v235
v_lshl_add_u32 v235, v233, 4, v235
v_add_u32 v4, 14336, v235
v_add_u32 v233, 4, v232
v_lshlrev_b32 v233, 1, v233
v_xor_b32 v233, v233, v234
v_add_u32 v235, s3, v232
v_lshlrev_b32 v235, 11, v235
v_lshl_add_u32 v235, v233, 4, v235
v_add_u32 v5, 21504, v235
v_lshlrev_b32 v225, 8, v224
v_lshl_add_u32 v225, v226, 3, v225
v_and_b32 v228, 7, v224
v_lshlrev_b32 v228, 1, v228
s_lshl_b32 s38, s40, 3
v_xor_b32 v228, s38, v228
v_add_u32 v227, 0, v229
v_xor_b32 v227, v227, v228
v_lshl_add_u32 v8, v227, 4, v225
v_add_u32 v16, 0x10000, v8
v_add_u32 v227, 2, v229
v_xor_b32 v227, v227, v228
v_lshl_add_u32 v9, v227, 4, v225
v_add_u32 v17, 0x10000, v9
v_add_u32 v227, 4, v229
v_xor_b32 v227, v227, v228
v_lshl_add_u32 v10, v227, 4, v225
v_add_u32 v18, 0x10000, v10
v_add_u32 v227, 6, v229
v_xor_b32 v227, v227, v228
v_lshl_add_u32 v11, v227, 4, v225
v_add_u32 v19, 0x10000, v11
v_add_u32 v227, 8, v229
v_xor_b32 v227, v227, v228
v_lshl_add_u32 v12, v227, 4, v225
v_add_u32 v20, 0x10000, v12
v_add_u32 v227, 10, v229
v_xor_b32 v227, v227, v228
v_lshl_add_u32 v13, v227, 4, v225
v_add_u32 v21, 0x10000, v13
v_add_u32 v227, 12, v229
v_xor_b32 v227, v227, v228
v_lshl_add_u32 v14, v227, 4, v225
v_add_u32 v22, 0x10000, v14
v_add_u32 v227, 14, v229
v_xor_b32 v227, v227, v228
v_lshl_add_u32 v15, v227, 4, v225
v_add_u32 v23, 0x10000, v15
v_mov_b32 v253, 0
v_mov_b32 v254, 1
v_lshlrev_b32 v255, 2, v0
s_waitcnt lgkmcnt(0)
s_mov_b32 s16, s14
s_mov_b32 s17, s15
s_mov_b32 s18, 8388608
s_mov_b32 s19, 0x00020000
s_waitcnt vmcnt(26) lgkmcnt(0)
s_barrier
M a[0:3], v[96:99], a[192:195], 0
s_add_u32 m0, s42, 16384
s_nop 0
buffer_load_dwordx4 v6, s[48:51], s26 offen offset:0 lds
ds_read_b64_tr_b16 v[160:161], v28 offset:16384
ds_read_b64_tr_b16 v[162:163], v28 offset:18432
M a[0:3], v[100:103], a[196:199], a[0:3]
buffer_load_dwordx4 v7, s[48:51], s26 offen offset:1024 lds
M a[4:7], v[108:111], a[196:199], 0
ds_read_b64_tr_b16 v[164:165], v28 offset:20480
ds_read_b64_tr_b16 v[166:167], v28 offset:22528
M a[4:7], v[104:107], a[192:195], a[4:7]
buffer_load_dwordx4 a[144:147], v1, s[44:47], s25 offen offset:0 sc1
M a[8:11], v[112:115], a[192:195], 0
ds_read_b64_tr_b16 v[168:169], v29 offset:16384
ds_read_b64_tr_b16 v[170:171], v29 offset:18432
M a[8:11], v[116:119], a[196:199], a[8:11]
buffer_load_dwordx4 a[148:151], v1, s[44:47], s25 offen offset:1024 sc1
M a[12:15], v[124:127], a[196:199], 0
ds_read_b64_tr_b16 v[172:173], v29 offset:20480
ds_read_b64_tr_b16 v[174:175], v29 offset:22528
M a[12:15], v[120:123], a[192:195], a[12:15]
buffer_load_dwordx4 a[152:155], v1, s[44:47], s25 offen offset:2048 sc1
M a[16:19], v[96:99], a[200:203], 0
ds_read_b64_tr_b16 v[176:177], v30 offset:16384
ds_read_b64_tr_b16 v[178:179], v30 offset:18432
M a[16:19], v[100:103], a[204:207], a[16:19]
buffer_load_dwordx4 a[156:159], v1, s[44:47], s25 offen offset:3072 sc1
M a[20:23], v[108:111], a[204:207], 0
ds_read_b64_tr_b16 v[180:181], v30 offset:20480
ds_read_b64_tr_b16 v[182:183], v30 offset:22528
M a[20:23], v[104:107], a[200:203], a[20:23]
s_add_u32 s25, s25, 16384
s_add_u32 s26, s26, 131072
M a[24:27], v[112:115], a[200:203], 0
ds_read_b64_tr_b16 v[184:185], v31 offset:16384
ds_read_b64_tr_b16 v[186:187], v31 offset:18432
M a[24:27], v[116:119], a[204:207], a[24:27]
ds_read_b64_tr_b16 v[188:189], v31 offset:20480
ds_read_b64_tr_b16 v[190:191], v31 offset:22528
M a[28:31], v[124:127], a[204:207], 0
M a[28:31], v[120:123], a[200:203], a[28:31]
s_waitcnt vmcnt(6) lgkmcnt(0)
s_barrier
s_mov_b64 exec, 1
buffer_store_dword v254, v253, s[52:55], s92 offen sc1
buffer_store_dword v254, v253, s[52:55], s93 offen sc1
buffer_store_dword v254, v253, s[52:55], s94 offen sc1
s_mov_b64 exec, -1
M a[0:3], v[160:163], a[208:211], a[0:3]
s_add_u32 m0, s42, 32768
s_nop 0
buffer_load_dwordx4 v6, s[48:51], s26 offen offset:0 lds
ds_read_b64_tr_b16 v[96:97], v28 offset:32768
ds_read_b64_tr_b16 v[98:99], v28 offset:34816
M a[0:3], v[164:167], a[212:215], a[0:3]
buffer_load_dwordx4 v7, s[48:51], s26 offen offset:1024 lds
M a[4:7], v[172:175], a[212:215], a[4:7]
ds_read_b64_tr_b16 v[100:101], v28 offset:36864
ds_read_b64_tr_b16 v[102:103], v28 offset:38912
M a[4:7], v[168:171], a[208:211], a[4:7]
buffer_load_dwordx4 a[160:163], v1, s[44:47], s25 offen offset:0 sc1
M a[8:11], v[176:179], a[208:211], a[8:11]
ds_read_b64_tr_b16 v[104:105], v29 offset:32768
ds_read_b64_tr_b16 v[106:107], v29 offset:34816
M a[8:11], v[180:183], a[212:215], a[8:11]
buffer_load_dwordx4 a[164:167], v1, s[44:47], s25 offen offset:1024 sc1
M a[12:15], v[188:191], a[212:215], a[12:15]
ds_read_b64_tr_b16 v[108:109], v29 offset:36864
ds_read_b64_tr_b16 v[110:111], v29 offset:38912
M a[12:15], v[184:187], a[208:211], a[12:15]
buffer_load_dwordx4 a[168:171], v1, s[44:47], s25 offen offset:2048 sc1
M a[16:19], v[160:163], a[216:219], a[16:19]
ds_read_b64_tr_b16 v[112:113], v30 offset:32768
ds_read_b64_tr_b16 v[114:115], v30 offset:34816
M a[16:19], v[164:167], a[220:223], a[16:19]
buffer_load_dwordx4 a[172:175], v1, s[44:47], s25 offen offset:3072 sc1
M a[20:23], v[172:175], a[220:223], a[20:23]
ds_read_b64_tr_b16 v[116:117], v30 offset:36864
ds_read_b64_tr_b16 v[118:119], v30 offset:38912
M a[20:23], v[168:171], a[216:219], a[20:23]
s_add_u32 s25, s25, 16384
s_add_u32 s26, s26, 131072
M a[24:27], v[176:179], a[216:219], a[24:27]
ds_read_b64_tr_b16 v[120:121], v31 offset:32768
ds_read_b64_tr_b16 v[122:123], v31 offset:34816
M a[24:27], v[180:183], a[220:223], a[24:27]
ds_read_b64_tr_b16 v[124:125], v31 offset:36864
ds_read_b64_tr_b16 v[126:127], v31 offset:38912
M a[28:31], v[188:191], a[220:223], a[28:31]
M a[28:31], v[184:187], a[216:219], a[28:31]
s_waitcnt vmcnt(29) lgkmcnt(0)
s_barrier
M a[0:3], v[96:99], a[224:227], a[0:3]
s_add_u32 m0, s42, 49152
s_nop 0
buffer_load_dwordx4 v6, s[48:51], s26 offen offset:0 lds
ds_read_b64_tr_b16 v[160:161], v28 offset:49152
ds_read_b64_tr_b16 v[162:163], v28 offset:51200
M a[0:3], v[100:103], a[228:231], a[0:3]
buffer_load_dwordx4 v7, s[48:51], s26 offen offset:1024 lds
M a[4:7], v[108:111], a[228:231], a[4:7]
ds_read_b64_tr_b16 v[164:165], v28 offset:53248
ds_read_b64_tr_b16 v[166:167], v28 offset:55296
M a[4:7], v[104:107], a[224:227], a[4:7]
buffer_load_dwordx4 a[176:179], v1, s[44:47], s25 offen offset:0 sc1
M a[8:11], v[112:115], a[224:227], a[8:11]
ds_read_b64_tr_b16 v[168:169], v29 offset:49152
ds_read_b64_tr_b16 v[170:171], v29 offset:51200
M a[8:11], v[116:119], a[228:231], a[8:11]
buffer_load_dwordx4 a[180:183], v1, s[44:47], s25 offen offset:1024 sc1
M a[12:15], v[124:127], a[228:231], a[12:15]
ds_read_b64_tr_b16 v[172:173], v29 offset:53248
ds_read_b64_tr_b16 v[174:175], v29 offset:55296
M a[12:15], v[120:123], a[224:227], a[12:15]
buffer_load_dwordx4 a[184:187], v1, s[44:47], s25 offen offset:2048 sc1
ds_read_b64_tr_b16 v[176:177], v30 offset:49152
ds_read_b64_tr_b16 v[178:179], v30 offset:51200
M a[16:19], v[96:99], a[232:235], a[16:19]
buffer_load_dwordx4 a[188:191], v1, s[44:47], s25 offen offset:3072 sc1
M a[16:19], v[100:103], a[236:239], a[16:19]
ds_read_b64_tr_b16 v[180:181], v30 offset:53248
ds_read_b64_tr_b16 v[182:183], v30 offset:55296
M a[20:23], v[108:111], a[236:239], a[20:23]
s_add_u32 s25, s25, 16384
s_add_u32 s26, s26, 131072
M a[20:23], v[104:107], a[232:235], a[20:23]
ds_read_b64_tr_b16 v[184:185], v31 offset:49152
ds_read_b64_tr_b16 v[186:187], v31 offset:51200
M a[24:27], v[112:115], a[232:235], a[24:27]
buffer_load_dword v252, v255, s[52:55], s62 offen sc1
M a[24:27], v[116:119], a[236:239], a[24:27]
ds_read_b64_tr_b16 v[188:189], v31 offset:53248
ds_read_b64_tr_b16 v[190:191], v31 offset:55296
M a[28:31], v[124:127], a[236:239], a[28:31]
M a[28:31], v[120:123], a[232:235], a[28:31]
s_waitcnt vmcnt(30) lgkmcnt(0)
s_barrier
s_waitcnt vmcnt(0)
v_cmp_ne_u32 vcc, 1, v252
s_nop 0
s_cbranch_vccnz Lk3_spinft
Lk3_gotft:
M a[0:3], v[160:163], a[240:243], a[0:3]
s_mov_b32 s32, s25
s_mov_b32 s33, s26
s_mov_b64 s[34:35], s[44:45]
s_mov_b64 s[36:37], s[48:49]
s_mov_b64 s[44:45], s[8:9]
s_mov_b32 s46, 16777216
s_mov_b64 s[48:49], s[10:11]
s_mov_b32 s50, 8388608
s_mov_b32 s25, s12
s_mov_b32 s26, s13
s_add_u32 m0, s41, 65536
s_nop 0
buffer_load_dwordx4 v2, s[48:51], s26 offen offset:0 lds
ds_read_b64_tr_b16 v[96:97], v24 offset:0
ds_read_b64_tr_b16 v[98:99], v24 offset:2048
M a[0:3], v[164:167], a[244:247], a[0:3]
buffer_load_dwordx4 v3, s[48:51], s26 offen offset:1024 lds
M a[4:7], v[172:175], a[244:247], a[4:7]
ds_read_b64_tr_b16 v[100:101], v24 offset:4096
ds_read_b64_tr_b16 v[102:103], v24 offset:6144
M a[4:7], v[168:171], a[240:243], a[4:7]
buffer_load_dwordx4 v4, s[48:51], s26 offen offset:2048 lds
ds_read_b64_tr_b16 v[104:105], v25 offset:0
ds_read_b64_tr_b16 v[106:107], v25 offset:2048
M a[8:11], v[176:179], a[240:243], a[8:11]
buffer_load_dwordx4 v5, s[48:51], s26 offen offset:3072 lds
M a[8:11], v[180:183], a[244:247], a[8:11]
ds_read_b64_tr_b16 v[108:109], v25 offset:4096
ds_read_b64_tr_b16 v[110:111], v25 offset:6144
M a[12:15], v[188:191], a[244:247], a[12:15]
buffer_load_dwordx4 a[192:195], v1, s[44:47], s25 offen offset:0 sc1
M a[12:15], v[184:187], a[240:243], a[12:15]
ds_read_b64_tr_b16 v[112:113], v26 offset:0
ds_read_b64_tr_b16 v[114:115], v26 offset:2048
buffer_load_dwordx4 a[196:199], v1, s[44:47], s25 offen offset:1024 sc1
M a[16:19], v[160:163], a[248:251], a[16:19]
ds_read_b64_tr_b16 v[116:117], v26 offset:4096
ds_read_b64_tr_b16 v[118:119], v26 offset:6144
M a[16:19], v[164:167], a[252:255], a[16:19]
buffer_load_dwordx4 a[200:203], v1, s[44:47], s25 offen offset:2048 sc1
M a[20:23], v[172:175], a[252:255], a[20:23]
ds_read_b64_tr_b16 v[120:121], v27 offset:0
ds_read_b64_tr_b16 v[122:123], v27 offset:2048
buffer_load_dwordx4 a[204:207], v1, s[44:47], s25 offen offset:3072 sc1
M a[20:23], v[168:171], a[248:251], a[20:23]
ds_read_b64_tr_b16 v[124:125], v27 offset:4096
ds_read_b64_tr_b16 v[126:127], v27 offset:6144
M a[24:27], v[176:179], a[248:251], a[24:27]
s_sub_u32 s39, s39, 1
s_cmp_eq_u32 s39, 0
s_cselect_b32 s3, s64, s65
M a[24:27], v[180:183], a[252:255], a[24:27]
s_add_u32 s25, s25, s3
s_lshl_b32 s3, s3, 3
s_add_u32 s26, s26, s3
M a[28:31], v[188:191], a[252:255], a[28:31]
M a[28:31], v[184:187], a[248:251], a[28:31]
s_waitcnt vmcnt(24) lgkmcnt(0)
s_barrier
M a[0:3], v[96:99], a[128:131], a[0:3]
s_add_u32 m0, s41, 81920
s_nop 0
buffer_load_dwordx4 v2, s[48:51], s26 offen offset:0 lds
ds_read_b64_tr_b16 v[160:161], v24 offset:16384
ds_read_b64_tr_b16 v[162:163], v24 offset:18432
M a[0:3], v[100:103], a[132:135], a[0:3]
buffer_load_dwordx4 v3, s[48:51], s26 offen offset:1024 lds
M a[4:7], v[108:111], a[132:135], a[4:7]
ds_read_b64_tr_b16 v[164:165], v24 offset:20480
ds_read_b64_tr_b16 v[166:167], v24 offset:22528
M a[4:7], v[104:107], a[128:131], a[4:7]
buffer_load_dwordx4 v4, s[48:51], s26 offen offset:2048 lds
ds_read_b64_tr_b16 v[168:169], v25 offset:16384
ds_read_b64_tr_b16 v[170:171], v25 offset:18432
M a[8:11], v[112:115], a[128:131], a[8:11]
buffer_load_dwordx4 v5, s[48:51], s26 offen offset:3072 lds
M a[8:11], v[116:119], a[132:135], a[8:11]
ds_read_b64_tr_b16 v[172:173], v25 offset:20480
ds_read_b64_tr_b16 v[174:175], v25 offset:22528
M a[12:15], v[124:127], a[132:135], a[12:15]
buffer_load_dwordx4 a[208:211], v1, s[44:47], s25 offen offset:0 sc1
M a[12:15], v[120:123], a[128:131], a[12:15]
ds_read_b64_tr_b16 v[176:177], v26 offset:16384
ds_read_b64_tr_b16 v[178:179], v26 offset:18432
buffer_load_dwordx4 a[212:215], v1, s[44:47], s25 offen offset:1024 sc1
M a[16:19], v[96:99], a[136:139], a[16:19]
ds_read_b64_tr_b16 v[180:181], v26 offset:20480
ds_read_b64_tr_b16 v[182:183], v26 offset:22528
M a[16:19], v[100:103], a[140:143], a[16:19]
buffer_load_dwordx4 a[216:219], v1, s[44:47], s25 offen offset:2048 sc1
M a[20:23], v[108:111], a[140:143], a[20:23]
ds_read_b64_tr_b16 v[184:185], v27 offset:16384
ds_read_b64_tr_b16 v[186:187], v27 offset:18432
buffer_load_dwordx4 a[220:223], v1, s[44:47], s25 offen offset:3072 sc1
M a[20:23], v[104:107], a[136:139], a[20:23]
ds_read_b64_tr_b16 v[188:189], v27 offset:20480
ds_read_b64_tr_b16 v[190:191], v27 offset:22528
M a[24:27], v[112:115], a[136:139], a[24:27]
s_sub_u32 s39, s39, 1
s_cmp_eq_u32 s39, 0
s_cselect_b32 s3, s64, s65
M a[24:27], v[116:119], a[140:143], a[24:27]
s_add_u32 s25, s25, s3
s_lshl_b32 s3, s3, 3
s_add_u32 s26, s26, s3
M a[28:31], v[124:127], a[140:143], a[28:31]
M a[28:31], v[120:123], a[136:139], a[28:31]
s_waitcnt vmcnt(23) lgkmcnt(0)
s_barrier
M a[0:3], v[160:163], a[144:147], a[0:3]
s_add_u32 m0, s41, 98304
s_nop 0
buffer_load_dwordx4 v2, s[48:51], s26 offen offset:0 lds
ds_read_b64_tr_b16 v[96:97], v24 offset:32768
ds_read_b64_tr_b16 v[98:99], v24 offset:34816
M a[0:3], v[164:167], a[148:151], a[0:3]
buffer_load_dwordx4 v3, s[48:51], s26 offen offset:1024 lds
M a[4:7], v[172:175], a[148:151], a[4:7]
ds_read_b64_tr_b16 v[100:101], v24 offset:36864
ds_read_b64_tr_b16 v[102:103], v24 offset:38912
M a[4:7], v[168:171], a[144:147], a[4:7]
buffer_load_dwordx4 v4, s[48:51], s26 offen offset:2048 lds
ds_read_b64_tr_b16 v[104:105], v25 offset:32768
ds_read_b64_tr_b16 v[106:107], v25 offset:34816
M a[8:11], v[176:179], a[144:147], a[8:11]
buffer_load_dwordx4 v5, s[48:51], s26 offen offset:3072 lds
M a[8:11], v[180:183], a[148:151], a[8:11]
ds_read_b64_tr_b16 v[108:109], v25 offset:36864
ds_read_b64_tr_b16 v[110:111], v25 offset:38912
M a[12:15], v[188:191], a[148:151], a[12:15]
buffer_load_dwordx4 a[224:227], v1, s[44:47], s25 offen offset:0 sc1
M a[12:15], v[184:187], a[144:147], a[12:15]
ds_read_b64_tr_b16 v[112:113], v26 offset:32768
ds_read_b64_tr_b16 v[114:115], v26 offset:34816
buffer_load_dwordx4 a[228:231], v1, s[44:47], s25 offen offset:1024 sc1
M a[16:19], v[160:163], a[152:155], a[16:19]
ds_read_b64_tr_b16 v[116:117], v26 offset:36864
ds_read_b64_tr_b16 v[118:119], v26 offset:38912
M a[16:19], v[164:167], a[156:159], a[16:19]
buffer_load_dwordx4 a[232:235], v1, s[44:47], s25 offen offset:2048 sc1
M a[20:23], v[172:175], a[156:159], a[20:23]
ds_read_b64_tr_b16 v[120:121], v27 offset:32768
ds_read_b64_tr_b16 v[122:123], v27 offset:34816
buffer_load_dwordx4 a[236:239], v1, s[44:47], s25 offen offset:3072 sc1
M a[20:23], v[168:171], a[152:155], a[20:23]
ds_read_b64_tr_b16 v[124:125], v27 offset:36864
ds_read_b64_tr_b16 v[126:127], v27 offset:38912
M a[24:27], v[176:179], a[152:155], a[24:27]
s_sub_u32 s39, s39, 1
s_cmp_eq_u32 s39, 0
s_cselect_b32 s3, s64, s65
M a[24:27], v[180:183], a[156:159], a[24:27]
s_add_u32 s25, s25, s3
s_lshl_b32 s3, s3, 3
s_add_u32 s26, s26, s3
M a[28:31], v[188:191], a[156:159], a[28:31]
M a[28:31], v[184:187], a[152:155], a[28:31]
s_waitcnt vmcnt(25) lgkmcnt(0)
s_barrier
M a[0:3], v[96:99], a[160:163], a[0:3]
s_add_u32 m0, s41, 114688
s_nop 0
buffer_load_dwordx4 v2, s[48:51], s26 offen offset:0 lds
ds_read_b64_tr_b16 v[160:161], v24 offset:49152
ds_read_b64_tr_b16 v[162:163], v24 offset:51200
M a[0:3], v[100:103], a[164:167], a[0:3]
buffer_load_dwordx4 v3, s[48:51], s26 offen offset:1024 lds
M a[4:7], v[108:111], a[164:167], a[4:7]
ds_read_b64_tr_b16 v[164:165], v24 offset:53248
ds_read_b64_tr_b16 v[166:167], v24 offset:55296
M a[4:7], v[104:107], a[160:163], a[4:7]
buffer_load_dwordx4 v4, s[48:51], s26 offen offset:2048 lds
ds_read_b64_tr_b16 v[168:169], v25 offset:49152
ds_read_b64_tr_b16 v[170:171], v25 offset:51200
M a[8:11], v[112:115], a[160:163], a[8:11]
buffer_load_dwordx4 v5, s[48:51], s26 offen offset:3072 lds
M a[8:11], v[116:119], a[164:167], a[8:11]
ds_read_b64_tr_b16 v[172:173], v25 offset:53248
ds_read_b64_tr_b16 v[174:175], v25 offset:55296
M a[12:15], v[124:127], a[164:167], a[12:15]
buffer_load_dwordx4 a[240:243], v1, s[44:47], s25 offen offset:0 sc1
M a[12:15], v[120:123], a[160:163], a[12:15]
ds_read_b64_tr_b16 v[176:177], v26 offset:49152
ds_read_b64_tr_b16 v[178:179], v26 offset:51200
buffer_load_dwordx4 a[244:247], v1, s[44:47], s25 offen offset:1024 sc1
M a[16:19], v[96:99], a[168:171], a[16:19]
ds_read_b64_tr_b16 v[180:181], v26 offset:53248
ds_read_b64_tr_b16 v[182:183], v26 offset:55296
M a[16:19], v[100:103], a[172:175], a[16:19]
buffer_load_dwordx4 a[248:251], v1, s[44:47], s25 offen offset:2048 sc1
M a[20:23], v[108:111], a[172:175], a[20:23]
ds_read_b64_tr_b16 v[184:185], v27 offset:49152
ds_read_b64_tr_b16 v[186:187], v27 offset:51200
buffer_load_dwordx4 a[252:255], v1, s[44:47], s25 offen offset:3072 sc1
M a[20:23], v[104:107], a[168:171], a[20:23]
ds_read_b64_tr_b16 v[188:189], v27 offset:53248
ds_read_b64_tr_b16 v[190:191], v27 offset:55296
M a[24:27], v[112:115], a[168:171], a[24:27]
s_sub_u32 s39, s39, 1
s_cmp_eq_u32 s39, 0
s_cselect_b32 s3, s64, s65
M a[24:27], v[116:119], a[172:175], a[24:27]
s_add_u32 s25, s25, s3
s_lshl_b32 s3, s3, 3
s_add_u32 s26, s26, s3
M a[28:31], v[124:127], a[172:175], a[28:31]
M a[28:31], v[120:123], a[168:171], a[28:31]
s_waitcnt vmcnt(24) lgkmcnt(0)
s_barrier
M a[0:3], v[160:163], a[176:179], a[0:3]
s_add_u32 m0, s41, 0
s_nop 0
buffer_load_dwordx4 v2, s[48:51], s26 offen offset:0 lds
ds_read_b64_tr_b16 v[96:97], v16 offset:0
ds_read_b64_tr_b16 v[98:99], v16 offset:4096
M a[0:3], v[164:167], a[180:183], a[0:3]
buffer_load_dwordx4 v3, s[48:51], s26 offen offset:1024 lds
ds_read_b64_tr_b16 v[100:101], v16 offset:8192
ds_read_b64_tr_b16 v[102:103], v16 offset:12288
M a[4:7], v[172:175], a[180:183], a[4:7]
buffer_load_dwordx4 v4, s[48:51], s26 offen offset:2048 lds
ds_read_b64_tr_b16 v[104:105], v17 offset:0
ds_read_b64_tr_b16 v[106:107], v17 offset:4096
M a[4:7], v[168:171], a[176:179], a[4:7]
buffer_load_dwordx4 v5, s[48:51], s26 offen offset:3072 lds
ds_read_b64_tr_b16 v[108:109], v17 offset:8192
ds_read_b64_tr_b16 v[110:111], v17 offset:12288
M a[8:11], v[176:179], a[176:179], a[8:11]
buffer_load_dwordx4 a[128:131], v1, s[44:47], s25 offen offset:0 sc1
ds_read_b64_tr_b16 v[112:113], v18 offset:0
ds_read_b64_tr_b16 v[114:115], v18 offset:4096
M a[8:11], v[180:183], a[180:183], a[8:11]
buffer_load_dwordx4 a[132:135], v1, s[44:47], s25 offen offset:1024 sc1
ds_read_b64_tr_b16 v[116:117], v18 offset:8192
ds_read_b64_tr_b16 v[118:119], v18 offset:12288
M a[12:15], v[188:191], a[180:183], a[12:15]
buffer_load_dwordx4 a[136:139], v1, s[44:47], s25 offen offset:2048 sc1
M a[12:15], v[184:187], a[176:179], a[12:15]
ds_read_b64_tr_b16 v[120:121], v19 offset:0
ds_read_b64_tr_b16 v[122:123], v19 offset:4096
buffer_load_dwordx4 a[140:143], v1, s[44:47], s25 offen offset:3072 sc1
M a[16:19], v[160:163], a[184:187], a[16:19]
ds_read_b64_tr_b16 v[124:125], v19 offset:8192
ds_read_b64_tr_b16 v[126:127], v19 offset:12288
s_sub_u32 s39, s39, 1
s_cmp_eq_u32 s39, 0
s_cselect_b32 s3, s64, s65
M a[16:19], v[164:167], a[188:191], a[16:19]
ds_read_b64_tr_b16 v[128:129], v20 offset:0
ds_read_b64_tr_b16 v[130:131], v20 offset:4096
s_add_u32 s25, s25, s3
s_lshl_b32 s3, s3, 3
s_add_u32 s26, s26, s3
M a[20:23], v[172:175], a[188:191], a[20:23]
ds_read_b64_tr_b16 v[132:133], v20 offset:8192
ds_read_b64_tr_b16 v[134:135], v20 offset:12288
ds_read_b64_tr_b16 v[136:137], v21 offset:0
ds_read_b64_tr_b16 v[138:139], v21 offset:4096
M a[20:23], v[168:171], a[184:187], a[20:23]
ds_read_b64_tr_b16 v[140:141], v21 offset:8192
ds_read_b64_tr_b16 v[142:143], v21 offset:12288
ds_read_b64_tr_b16 v[144:145], v22 offset:0
ds_read_b64_tr_b16 v[146:147], v22 offset:4096
M a[24:27], v[176:179], a[184:187], a[24:27]
ds_read_b64_tr_b16 v[148:149], v22 offset:8192
ds_read_b64_tr_b16 v[150:151], v22 offset:12288
ds_read_b64_tr_b16 v[152:153], v23 offset:0
ds_read_b64_tr_b16 v[154:155], v23 offset:4096
M a[24:27], v[180:183], a[188:191], a[24:27]
ds_read_b64_tr_b16 v[156:157], v23 offset:8192
ds_read_b64_tr_b16 v[158:159], v23 offset:12288
M a[28:31], v[188:191], a[188:191], a[28:31]
M a[28:31], v[184:187], a[184:187], a[28:31]
s_waitcnt vmcnt(24) lgkmcnt(0)
s_barrier
M v[32:35], v[96:99], a[192:195], 0
s_add_u32 m0, s41, 16384
s_nop 0
buffer_load_dwordx4 v2, s[48:51], s26 offen offset:0 lds
M v[32:35], v[100:103], a[196:199], v[32:35]
ds_read_b64_tr_b16 v[160:161], v16 offset:16384
ds_read_b64_tr_b16 v[162:163], v16 offset:20480
M v[36:39], v[108:111], a[196:199], 0
buffer_load_dwordx4 v3, s[48:51], s26 offen offset:1024 lds
M v[36:39], v[104:107], a[192:195], v[36:39]
ds_read_b64_tr_b16 v[164:165], v16 offset:24576
ds_read_b64_tr_b16 v[166:167], v16 offset:28672
M v[40:43], v[112:115], a[192:195], 0
buffer_load_dwordx4 v4, s[48:51], s26 offen offset:2048 lds
M v[40:43], v[116:119], a[196:199], v[40:43]
ds_read_b64_tr_b16 v[168:169], v17 offset:16384
ds_read_b64_tr_b16 v[170:171], v17 offset:20480
M v[44:47], v[124:127], a[196:199], 0
buffer_load_dwordx4 v5, s[48:51], s26 offen offset:3072 lds
M v[44:47], v[120:123], a[192:195], v[44:47]
M v[48:51], v[128:131], a[192:195], 0
ds_read_b64_tr_b16 v[172:173], v17 offset:24576
ds_read_b64_tr_b16 v[174:175], v17 offset:28672
M v[48:51], v[132:135], a[196:199], v[48:51]
buffer_load_dwordx4 a[144:147], v1, s[44:47], s25 offen offset:0 sc1
M v[52:55], v[140:143], a[196:199], 0
ds_read_b64_tr_b16 v[176:177], v18 offset:16384
ds_read_b64_tr_b16 v[178:179], v18 offset:20480
M v[52:55], v[136:139], a[192:195], v[52:55]
buffer_load_dwordx4 a[148:151], v1, s[44:47], s25 offen offset:1024 sc1
M v[56:59], v[144:147], a[192:195], 0
ds_read_b64_tr_b16 v[180:181], v18 offset:24576
ds_read_b64_tr_b16 v[182:183], v18 offset:28672
M v[56:59], v[148:151], a[196:199], v[56:59]
buffer_load_dwordx4 a[152:155], v1, s[44:47], s25 offen offset:2048 sc1
M v[60:63], v[156:159], a[196:199], 0
M v[60:63], v[152:155], a[192:195], v[60:63]
ds_read_b64_tr_b16 v[184:185], v19 offset:16384
ds_read_b64_tr_b16 v[186:187], v19 offset:20480
M v[64:67], v[96:99], a[200:203], 0
buffer_load_dwordx4 a[156:159], v1, s[44:47], s25 offen offset:3072 sc1
M v[64:67], v[100:103], a[204:207], v[64:67]
ds_read_b64_tr_b16 v[188:189], v19 offset:24576
ds_read_b64_tr_b16 v[190:191], v19 offset:28672
M v[68:71], v[108:111], a[204:207], 0
s_sub_u32 s39, s39, 1
s_cmp_eq_u32 s39, 0
s_cselect_b32 s3, s64, s65
M v[68:71], v[104:107], a[200:203], v[68:71]
ds_read_b64_tr_b16 v[192:193], v20 offset:16384
ds_read_b64_tr_b16 v[194:195], v20 offset:20480
M v[72:75], v[112:115], a[200:203], 0
s_add_u32 s25, s25, s3
s_lshl_b32 s3, s3, 3
s_add_u32 s26, s26, s3
M v[72:75], v[116:119], a[204:207], v[72:75]
ds_read_b64_tr_b16 v[196:197], v20 offset:24576
ds_read_b64_tr_b16 v[198:199], v20 offset:28672
M v[76:79], v[124:127], a[204:207], 0
M v[76:79], v[120:123], a[200:203], v[76:79]
ds_read_b64_tr_b16 v[200:201], v21 offset:16384
ds_read_b64_tr_b16 v[202:203], v21 offset:20480
M v[80:83], v[128:131], a[200:203], 0
ds_read_b64_tr_b16 v[204:205], v21 offset:24576
ds_read_b64_tr_b16 v[206:207], v21 offset:28672
M v[80:83], v[132:135], a[204:207], v[80:83]
ds_read_b64_tr_b16 v[208:209], v22 offset:16384
ds_read_b64_tr_b16 v[210:211], v22 offset:20480
M v[84:87], v[140:143], a[204:207], 0
ds_read_b64_tr_b16 v[212:213], v22 offset:24576
ds_read_b64_tr_b16 v[214:215], v22 offset:28672
M v[84:87], v[136:139], a[200:203], v[84:87]
ds_read_b64_tr_b16 v[216:217], v23 offset:16384
ds_read_b64_tr_b16 v[218:219], v23 offset:20480
M v[88:91], v[144:147], a[200:203], 0
ds_read_b64_tr_b16 v[220:221], v23 offset:24576
ds_read_b64_tr_b16 v[222:223], v23 offset:28672
M v[88:91], v[148:151], a[204:207], v[88:91]
M v[92:95], v[156:159], a[204:207], 0
M v[92:95], v[152:155], a[200:203], v[92:95]
s_mov_b32 s28, 3
Lk3_la:
s_waitcnt vmcnt(24) lgkmcnt(0)
s_barrier
M v[32:35], v[160:163], a[208:211], v[32:35]
s_add_u32 m0, s41, 32768
s_nop 0
buffer_load_dwordx4 v2, s[48:51], s26 offen offset:0 lds
M v[32:35], v[164:167], a[212:215], v[32:35]
ds_read_b64_tr_b16 v[96:97], v16 offset:32768
ds_read_b64_tr_b16 v[98:99], v16 offset:36864
M v[36:39], v[172:175], a[212:215], v[36:39]
buffer_load_dwordx4 v3, s[48:51], s26 offen offset:1024 lds
M v[36:39], v[168:171], a[208:211], v[36:39]
ds_read_b64_tr_b16 v[100:101], v16 offset:40960
ds_read_b64_tr_b16 v[102:103], v16 offset:45056
M v[40:43], v[176:179], a[208:211], v[40:43]
buffer_load_dwordx4 v4, s[48:51], s26 offen offset:2048 lds
M v[40:43], v[180:183], a[212:215], v[40:43]
ds_read_b64_tr_b16 v[104:105], v17 offset:32768
ds_read_b64_tr_b16 v[106:107], v17 offset:36864
M v[44:47], v[188:191], a[212:215], v[44:47]
buffer_load_dwordx4 v5, s[48:51], s26 offen offset:3072 lds
M v[44:47], v[184:187], a[208:211], v[44:47]
M v[48:51], v[192:195], a[208:211], v[48:51]
ds_read_b64_tr_b16 v[108:109], v17 offset:40960
ds_read_b64_tr_b16 v[110:111], v17 offset:45056
M v[48:51], v[196:199], a[212:215], v[48:51]
buffer_load_dwordx4 a[160:163], v1, s[44:47], s25 offen offset:0 sc1
M v[52:55], v[204:207], a[212:215], v[52:55]
ds_read_b64_tr_b16 v[112:113], v18 offset:32768
ds_read_b64_tr_b16 v[114:115], v18 offset:36864
M v[52:55], v[200:203], a[208:211], v[52:55]
buffer_load_dwordx4 a[164:167], v1, s[44:47], s25 offen offset:1024 sc1
M v[56:59], v[208:211], a[208:211], v[56:59]
ds_read_b64_tr_b16 v[116:117], v18 offset:40960
ds_read_b64_tr_b16 v[118:119], v18 offset:45056
M v[56:59], v[212:215], a[212:215], v[56:59]
buffer_load_dwordx4 a[168:171], v1, s[44:47], s25 offen offset:2048 sc1
M v[60:63], v[220:223], a[212:215], v[60:63]
M v[60:63], v[216:219], a[208:211], v[60:63]
ds_read_b64_tr_b16 v[120:121], v19 offset:32768
ds_read_b64_tr_b16 v[122:123], v19 offset:36864
M v[64:67], v[160:163], a[216:219], v[64:67]
buffer_load_dwordx4 a[172:175], v1, s[44:47], s25 offen offset:3072 sc1
M v[64:67], v[164:167], a[220:223], v[64:67]
ds_read_b64_tr_b16 v[124:125], v19 offset:40960
ds_read_b64_tr_b16 v[126:127], v19 offset:45056
M v[68:71], v[172:175], a[220:223], v[68:71]
s_sub_u32 s39, s39, 1
s_cmp_eq_u32 s39, 0
s_cselect_b32 s3, s64, s65
M v[68:71], v[168:171], a[216:219], v[68:71]
ds_read_b64_tr_b16 v[128:129], v20 offset:32768
ds_read_b64_tr_b16 v[130:131], v20 offset:36864
M v[72:75], v[176:179], a[216:219], v[72:75]
s_add_u32 s25, s25, s3
s_lshl_b32 s3, s3, 3
s_add_u32 s26, s26, s3
M v[72:75], v[180:183], a[220:223], v[72:75]
ds_read_b64_tr_b16 v[132:133], v20 offset:40960
ds_read_b64_tr_b16 v[134:135], v20 offset:45056
M v[76:79], v[188:191], a[220:223], v[76:79]
M v[76:79], v[184:187], a[216:219], v[76:79]
ds_read_b64_tr_b16 v[136:137], v21 offset:32768
ds_read_b64_tr_b16 v[138:139], v21 offset:36864
M v[80:83], v[192:195], a[216:219], v[80:83]
ds_read_b64_tr_b16 v[140:141], v21 offset:40960
ds_read_b64_tr_b16 v[142:143], v21 offset:45056
M v[80:83], v[196:199], a[220:223], v[80:83]
ds_read_b64_tr_b16 v[144:145], v22 offset:32768
ds_read_b64_tr_b16 v[146:147], v22 offset:36864
M v[84:87], v[204:207], a[220:223], v[84:87]
ds_read_b64_tr_b16 v[148:149], v22 offset:40960
ds_read_b64_tr_b16 v[150:151], v22 offset:45056
M v[84:87], v[200:203], a[216:219], v[84:87]
ds_read_b64_tr_b16 v[152:153], v23 offset:32768
ds_read_b64_tr_b16 v[154:155], v23 offset:36864
M v[88:91], v[208:211], a[216:219], v[88:91]
ds_read_b64_tr_b16 v[156:157], v23 offset:40960
ds_read_b64_tr_b16 v[158:159], v23 offset:45056
M v[88:91], v[212:215], a[220:223], v[88:91]
M v[92:95], v[220:223], a[220:223], v[92:95]
M v[92:95], v[216:219], a[216:219], v[92:95]
s_waitcnt vmcnt(24) lgkmcnt(0)
s_barrier
M v[32:35], v[96:99], a[224:227], v[32:35]
s_add_u32 m0, s41, 49152
s_nop 0
buffer_load_dwordx4 v2, s[48:51], s26 offen offset:0 lds
M v[32:35], v[100:103], a[228:231], v[32:35]
ds_read_b64_tr_b16 v[160:161], v16 offset:49152
ds_read_b64_tr_b16 v[162:163], v16 offset:53248
M v[36:39], v[108:111], a[228:231], v[36:39]
buffer_load_dwordx4 v3, s[48:51], s26 offen offset:1024 lds
M v[36:39], v[104:107], a[224:227], v[36:39]
ds_read_b64_tr_b16 v[164:165], v16 offset:57344
ds_read_b64_tr_b16 v[166:167], v16 offset:61440
M v[40:43], v[112:115], a[224:227], v[40:43]
buffer_load_dwordx4 v4, s[48:51], s26 offen offset:2048 lds
M v[40:43], v[116:119], a[228:231], v[40:43]
ds_read_b64_tr_b16 v[168:169], v17 offset:49152
ds_read_b64_tr_b16 v[170:171], v17 offset:53248
M v[44:47], v[124:127], a[228:231], v[44:47]
buffer_load_dwordx4 v5, s[48:51], s26 offen offset:3072 lds
M v[44:47], v[120:123], a[224:227], v[44:47]
M v[48:51], v[128:131], a[224:227], v[48:51]
ds_read_b64_tr_b16 v[172:173], v17 offset:57344
ds_read_b64_tr_b16 v[174:175], v17 offset:61440
M v[48:51], v[132:135], a[228:231], v[48:51]
buffer_load_dwordx4 a[176:179], v1, s[44:47], s25 offen offset:0 sc1
M v[52:55], v[140:143], a[228:231], v[52:55]
ds_read_b64_tr_b16 v[176:177], v18 offset:49152
ds_read_b64_tr_b16 v[178:179], v18 offset:53248
M v[52:55], v[136:139], a[224:227], v[52:55]
buffer_load_dwordx4 a[180:183], v1, s[44:47], s25 offen offset:1024 sc1
M v[56:59], v[144:147], a[224:227], v[56:59]
ds_read_b64_tr_b16 v[180:181], v18 offset:57344
ds_read_b64_tr_b16 v[182:183], v18 offset:61440
M v[56:59], v[148:151], a[228:231], v[56:59]
buffer_load_dwordx4 a[184:187], v1, s[44:47], s25 offen offset:2048 sc1
M v[60:63], v[156:159], a[228:231], v[60:63]
M v[60:63], v[152:155], a[224:227], v[60:63]
ds_read_b64_tr_b16 v[184:185], v19 offset:49152
ds_read_b64_tr_b16 v[186:187], v19 offset:53248
M v[64:67], v[96:99], a[232:235], v[64:67]
buffer_load_dwordx4 a[188:191], v1, s[44:47], s25 offen offset:3072 sc1
M v[64:67], v[100:103], a[236:239], v[64:67]
ds_read_b64_tr_b16 v[188:189], v19 offset:57344
ds_read_b64_tr_b16 v[190:191], v19 offset:61440
M v[68:71], v[108:111], a[236:239], v[68:71]
s_sub_u32 s39, s39, 1
s_cmp_eq_u32 s39, 0
s_cselect_b32 s3, s64, s65
M v[68:71], v[104:107], a[232:235], v[68:71]
ds_read_b64_tr_b16 v[192:193], v20 offset:49152
ds_read_b64_tr_b16 v[194:195], v20 offset:53248
M v[72:75], v[112:115], a[232:235], v[72:75]
s_add_u32 s25, s25, s3
s_lshl_b32 s3, s3, 3
s_add_u32 s26, s26, s3
M v[72:75], v[116:119], a[236:239], v[72:75]
ds_read_b64_tr_b16 v[196:197], v20 offset:57344
ds_read_b64_tr_b16 v[198:199], v20 offset:61440
M v[76:79], v[124:127], a[236:239], v[76:79]
M v[76:79], v[120:123], a[232:235], v[76:79]
ds_read_b64_tr_b16 v[200:201], v21 offset:49152
ds_read_b64_tr_b16 v[202:203], v21 offset:53248
M v[80:83], v[128:131], a[232:235], v[80:83]
ds_read_b64_tr_b16 v[204:205], v21 offset:57344
ds_read_b64_tr_b16 v[206:207], v21 offset:61440
M v[80:83], v[132:135], a[236:239], v[80:83]
ds_read_b64_tr_b16 v[208:209], v22 offset:49152
ds_read_b64_tr_b16 v[210:211], v22 offset:53248
M v[84:87], v[140:143], a[236:239], v[84:87]
ds_read_b64_tr_b16 v[212:213], v22 offset:57344
ds_read_b64_tr_b16 v[214:215], v22 offset:61440
M v[84:87], v[136:139], a[232:235], v[84:87]
ds_read_b64_tr_b16 v[216:217], v23 offset:49152
ds_read_b64_tr_b16 v[218:219], v23 offset:53248
M v[88:91], v[144:147], a[232:235], v[88:91]
ds_read_b64_tr_b16 v[220:221], v23 offset:57344
ds_read_b64_tr_b16 v[222:223], v23 offset:61440
M v[88:91], v[148:151], a[236:239], v[88:91]
M v[92:95], v[156:159], a[236:239], v[92:95]
M v[92:95], v[152:155], a[232:235], v[92:95]
s_waitcnt vmcnt(24) lgkmcnt(0)
s_barrier
M v[32:35], v[160:163], a[240:243], v[32:35]
s_add_u32 m0, s41, 65536
s_nop 0
buffer_load_dwordx4 v2, s[48:51], s26 offen offset:0 lds
M v[32:35], v[164:167], a[244:247], v[32:35]
ds_read_b64_tr_b16 v[96:97], v8 offset:0
ds_read_b64_tr_b16 v[98:99], v8 offset:4096
M v[36:39], v[172:175], a[244:247], v[36:39]
buffer_load_dwordx4 v3, s[48:51], s26 offen offset:1024 lds
M v[36:39], v[168:171], a[240:243], v[36:39]
ds_read_b64_tr_b16 v[100:101], v8 offset:8192
ds_read_b64_tr_b16 v[102:103], v8 offset:12288
M v[40:43], v[176:179], a[240:243], v[40:43]
buffer_load_dwordx4 v4, s[48:51], s26 offen offset:2048 lds
M v[40:43], v[180:183], a[244:247], v[40:43]
ds_read_b64_tr_b16 v[104:105], v9 offset:0
ds_read_b64_tr_b16 v[106:107], v9 offset:4096
M v[44:47], v[188:191], a[244:247], v[44:47]
buffer_load_dwordx4 v5, s[48:51], s26 offen offset:3072 lds
M v[44:47], v[184:187], a[240:243], v[44:47]
M v[48:51], v[192:195], a[240:243], v[48:51]
ds_read_b64_tr_b16 v[108:109], v9 offset:8192
ds_read_b64_tr_b16 v[110:111], v9 offset:12288
M v[48:51], v[196:199], a[244:247], v[48:51]
buffer_load_dwordx4 a[192:195], v1, s[44:47], s25 offen offset:0 sc1
M v[52:55], v[204:207], a[244:247], v[52:55]
ds_read_b64_tr_b16 v[112:113], v10 offset:0
ds_read_b64_tr_b16 v[114:115], v10 offset:4096
M v[52:55], v[200:203], a[240:243], v[52:55]
buffer_load_dwordx4 a[196:199], v1, s[44:47], s25 offen offset:1024 sc1
M v[56:59], v[208:211], a[240:243], v[56:59]
ds_read_b64_tr_b16 v[116:117], v10 offset:8192
ds_read_b64_tr_b16 v[118:119], v10 offset:12288
M v[56:59], v[212:215], a[244:247], v[56:59]
buffer_load_dwordx4 a[200:203], v1, s[44:47], s25 offen offset:2048 sc1
M v[60:63], v[220:223], a[244:247], v[60:63]
M v[60:63], v[216:219], a[240:243], v[60:63]
ds_read_b64_tr_b16 v[120:121], v11 offset:0
ds_read_b64_tr_b16 v[122:123], v11 offset:4096
M v[64:67], v[160:163], a[248:251], v[64:67]
buffer_load_dwordx4 a[204:207], v1, s[44:47], s25 offen offset:3072 sc1
M v[64:67], v[164:167], a[252:255], v[64:67]
ds_read_b64_tr_b16 v[124:125], v11 offset:8192
ds_read_b64_tr_b16 v[126:127], v11 offset:12288
M v[68:71], v[172:175], a[252:255], v[68:71]
s_sub_u32 s39, s39, 1
s_cmp_eq_u32 s39, 0
s_cselect_b32 s3, s64, s65
M v[68:71], v[168:171], a[248:251], v[68:71]
ds_read_b64_tr_b16 v[128:129], v12 offset:0
ds_read_b64_tr_b16 v[130:131], v12 offset:4096
M v[72:75], v[176:179], a[248:251], v[72:75]
s_add_u32 s25, s25, s3
s_lshl_b32 s3, s3, 3
s_add_u32 s26, s26, s3
M v[72:75], v[180:183], a[252:255], v[72:75]
ds_read_b64_tr_b16 v[132:133], v12 offset:8192
ds_read_b64_tr_b16 v[134:135], v12 offset:12288
M v[76:79], v[188:191], a[252:255], v[76:79]
M v[76:79], v[184:187], a[248:251], v[76:79]
ds_read_b64_tr_b16 v[136:137], v13 offset:0
ds_read_b64_tr_b16 v[138:139], v13 offset:4096
M v[80:83], v[192:195], a[248:251], v[80:83]
ds_read_b64_tr_b16 v[140:141], v13 offset:8192
ds_read_b64_tr_b16 v[142:143], v13 offset:12288
M v[80:83], v[196:199], a[252:255], v[80:83]
ds_read_b64_tr_b16 v[144:145], v14 offset:0
ds_read_b64_tr_b16 v[146:147], v14 offset:4096
M v[84:87], v[204:207], a[252:255], v[84:87]
ds_read_b64_tr_b16 v[148:149], v14 offset:8192
ds_read_b64_tr_b16 v[150:151], v14 offset:12288
M v[84:87], v[200:203], a[248:251], v[84:87]
ds_read_b64_tr_b16 v[152:153], v15 offset:0
ds_read_b64_tr_b16 v[154:155], v15 offset:4096
M v[88:91], v[208:211], a[248:251], v[88:91]
ds_read_b64_tr_b16 v[156:157], v15 offset:8192
ds_read_b64_tr_b16 v[158:159], v15 offset:12288
M v[88:91], v[212:215], a[252:255], v[88:91]
M v[92:95], v[220:223], a[252:255], v[92:95]
M v[92:95], v[216:219], a[248:251], v[92:95]
s_waitcnt vmcnt(24) lgkmcnt(0)
s_barrier
M v[32:35], v[96:99], a[128:131], v[32:35]
s_add_u32 m0, s41, 81920
s_nop 0
buffer_load_dwordx4 v2, s[48:51], s26 offen offset:0 lds
M v[32:35], v[100:103], a[132:135], v[32:35]
ds_read_b64_tr_b16 v[160:161], v8 offset:16384
ds_read_b64_tr_b16 v[162:163], v8 offset:20480
M v[36:39], v[108:111], a[132:135], v[36:39]
buffer_load_dwordx4 v3, s[48:51], s26 offen offset:1024 lds
M v[36:39], v[104:107], a[128:131], v[36:39]
ds_read_b64_tr_b16 v[164:165], v8 offset:24576
ds_read_b64_tr_b16 v[166:167], v8 offset:28672
M v[40:43], v[112:115], a[128:131], v[40:43]
buffer_load_dwordx4 v4, s[48:51], s26 offen offset:2048 lds
M v[40:43], v[116:119], a[132:135], v[40:43]
ds_read_b64_tr_b16 v[168:169], v9 offset:16384
ds_read_b64_tr_b16 v[170:171], v9 offset:20480
M v[44:47], v[124:127], a[132:135], v[44:47]
buffer_load_dwordx4 v5, s[48:51], s26 offen offset:3072 lds
M v[44:47], v[120:123], a[128:131], v[44:47]
M v[48:51], v[128:131], a[128:131], v[48:51]
ds_read_b64_tr_b16 v[172:173], v9 offset:24576
ds_read_b64_tr_b16 v[174:175], v9 offset:28672
M v[48:51], v[132:135], a[132:135], v[48:51]
buffer_load_dwordx4 a[208:211], v1, s[44:47], s25 offen offset:0 sc1
M v[52:55], v[140:143], a[132:135], v[52:55]
ds_read_b64_tr_b16 v[176:177], v10 offset:16384
ds_read_b64_tr_b16 v[178:179], v10 offset:20480
M v[52:55], v[136:139], a[128:131], v[52:55]
buffer_load_dwordx4 a[212:215], v1, s[44:47], s25 offen offset:1024 sc1
M v[56:59], v[144:147], a[128:131], v[56:59]
ds_read_b64_tr_b16 v[180:181], v10 offset:24576
ds_read_b64_tr_b16 v[182:183], v10 offset:28672
M v[56:59], v[148:151], a[132:135], v[56:59]
buffer_load_dwordx4 a[216:219], v1, s[44:47], s25 offen offset:2048 sc1
M v[60:63], v[156:159], a[132:135], v[60:63]
M v[60:63], v[152:155], a[128:131], v[60:63]
ds_read_b64_tr_b16 v[184:185], v11 offset:16384
ds_read_b64_tr_b16 v[186:187], v11 offset:20480
M v[64:67], v[96:99], a[136:139], v[64:67]
buffer_load_dwordx4 a[220:223], v1, s[44:47], s25 offen offset:3072 sc1
M v[64:67], v[100:103], a[140:143], v[64:67]
ds_read_b64_tr_b16 v[188:189], v11 offset:24576
ds_read_b64_tr_b16 v[190:191], v11 offset:28672
M v[68:71], v[108:111], a[140:143], v[68:71]
s_sub_u32 s39, s39, 1
s_cmp_eq_u32 s39, 0
s_cselect_b32 s3, s64, s65
M v[68:71], v[104:107], a[136:139], v[68:71]
ds_read_b64_tr_b16 v[192:193], v12 offset:16384
ds_read_b64_tr_b16 v[194:195], v12 offset:20480
M v[72:75], v[112:115], a[136:139], v[72:75]
s_add_u32 s25, s25, s3
s_lshl_b32 s3, s3, 3
s_add_u32 s26, s26, s3
M v[72:75], v[116:119], a[140:143], v[72:75]
ds_read_b64_tr_b16 v[196:197], v12 offset:24576
ds_read_b64_tr_b16 v[198:199], v12 offset:28672
M v[76:79], v[124:127], a[140:143], v[76:79]
M v[76:79], v[120:123], a[136:139], v[76:79]
ds_read_b64_tr_b16 v[200:201], v13 offset:16384
ds_read_b64_tr_b16 v[202:203], v13 offset:20480
M v[80:83], v[128:131], a[136:139], v[80:83]
ds_read_b64_tr_b16 v[204:205], v13 offset:24576
ds_read_b64_tr_b16 v[206:207], v13 offset:28672
M v[80:83], v[132:135], a[140:143], v[80:83]
ds_read_b64_tr_b16 v[208:209], v14 offset:16384
ds_read_b64_tr_b16 v[210:211], v14 offset:20480
M v[84:87], v[140:143], a[140:143], v[84:87]
ds_read_b64_tr_b16 v[212:213], v14 offset:24576
ds_read_b64_tr_b16 v[214:215], v14 offset:28672
M v[84:87], v[136:139], a[136:139], v[84:87]
ds_read_b64_tr_b16 v[216:217], v15 offset:16384
ds_read_b64_tr_b16 v[218:219], v15 offset:20480
M v[88:91], v[144:147], a[136:139], v[88:91]
ds_read_b64_tr_b16 v[220:221], v15 offset:24576
ds_read_b64_tr_b16 v[222:223], v15 offset:28672
M v[88:91], v[148:151], a[140:143], v[88:91]
M v[92:95], v[156:159], a[140:143], v[92:95]
M v[92:95], v[152:155], a[136:139], v[92:95]
s_waitcnt vmcnt(24) lgkmcnt(0)
s_barrier
M v[32:35], v[160:163], a[144:147], v[32:35]
s_add_u32 m0, s41, 98304
s_nop 0
buffer_load_dwordx4 v2, s[48:51], s26 offen offset:0 lds
M v[32:35], v[164:167], a[148:151], v[32:35]
ds_read_b64_tr_b16 v[96:97], v8 offset:32768
ds_read_b64_tr_b16 v[98:99], v8 offset:36864
M v[36:39], v[172:175], a[148:151], v[36:39]
buffer_load_dwordx4 v3, s[48:51], s26 offen offset:1024 lds
M v[36:39], v[168:171], a[144:147], v[36:39]
ds_read_b64_tr_b16 v[100:101], v8 offset:40960
ds_read_b64_tr_b16 v[102:103], v8 offset:45056
M v[40:43], v[176:179], a[144:147], v[40:43]
buffer_load_dwordx4 v4, s[48:51], s26 offen offset:2048 lds
M v[40:43], v[180:183], a[148:151], v[40:43]
ds_read_b64_tr_b16 v[104:105], v9 offset:32768
ds_read_b64_tr_b16 v[106:107], v9 offset:36864
M v[44:47], v[188:191], a[148:151], v[44:47]
buffer_load_dwordx4 v5, s[48:51], s26 offen offset:3072 lds
M v[44:47], v[184:187], a[144:147], v[44:47]
M v[48:51], v[192:195], a[144:147], v[48:51]
ds_read_b64_tr_b16 v[108:109], v9 offset:40960
ds_read_b64_tr_b16 v[110:111], v9 offset:45056
M v[48:51], v[196:199], a[148:151], v[48:51]
buffer_load_dwordx4 a[224:227], v1, s[44:47], s25 offen offset:0 sc1
M v[52:55], v[204:207], a[148:151], v[52:55]
ds_read_b64_tr_b16 v[112:113], v10 offset:32768
ds_read_b64_tr_b16 v[114:115], v10 offset:36864
M v[52:55], v[200:203], a[144:147], v[52:55]
buffer_load_dwordx4 a[228:231], v1, s[44:47], s25 offen offset:1024 sc1
M v[56:59], v[208:211], a[144:147], v[56:59]
ds_read_b64_tr_b16 v[116:117], v10 offset:40960
ds_read_b64_tr_b16 v[118:119], v10 offset:45056
M v[56:59], v[212:215], a[148:151], v[56:59]
buffer_load_dwordx4 a[232:235], v1, s[44:47], s25 offen offset:2048 sc1
M v[60:63], v[220:223], a[148:151], v[60:63]
M v[60:63], v[216:219], a[144:147], v[60:63]
ds_read_b64_tr_b16 v[120:121], v11 offset:32768
ds_read_b64_tr_b16 v[122:123], v11 offset:36864
M v[64:67], v[160:163], a[152:155], v[64:67]
buffer_load_dwordx4 a[236:239], v1, s[44:47], s25 offen offset:3072 sc1
M v[64:67], v[164:167], a[156:159], v[64:67]
ds_read_b64_tr_b16 v[124:125], v11 offset:40960
ds_read_b64_tr_b16 v[126:127], v11 offset:45056
M v[68:71], v[172:175], a[156:159], v[68:71]
s_sub_u32 s39, s39, 1
s_cmp_eq_u32 s39, 0
s_cselect_b32 s3, s64, s65
M v[68:71], v[168:171], a[152:155], v[68:71]
ds_read_b64_tr_b16 v[128:129], v12 offset:32768
ds_read_b64_tr_b16 v[130:131], v12 offset:36864
M v[72:75], v[176:179], a[152:155], v[72:75]
s_add_u32 s25, s25, s3
s_lshl_b32 s3, s3, 3
s_add_u32 s26, s26, s3
M v[72:75], v[180:183], a[156:159], v[72:75]
ds_read_b64_tr_b16 v[132:133], v12 offset:40960
ds_read_b64_tr_b16 v[134:135], v12 offset:45056
M v[76:79], v[188:191], a[156:159], v[76:79]
M v[76:79], v[184:187], a[152:155], v[76:79]
ds_read_b64_tr_b16 v[136:137], v13 offset:32768
ds_read_b64_tr_b16 v[138:139], v13 offset:36864
M v[80:83], v[192:195], a[152:155], v[80:83]
ds_read_b64_tr_b16 v[140:141], v13 offset:40960
ds_read_b64_tr_b16 v[142:143], v13 offset:45056
M v[80:83], v[196:199], a[156:159], v[80:83]
ds_read_b64_tr_b16 v[144:145], v14 offset:32768
ds_read_b64_tr_b16 v[146:147], v14 offset:36864
M v[84:87], v[204:207], a[156:159], v[84:87]
ds_read_b64_tr_b16 v[148:149], v14 offset:40960
ds_read_b64_tr_b16 v[150:151], v14 offset:45056
M v[84:87], v[200:203], a[152:155], v[84:87]
ds_read_b64_tr_b16 v[152:153], v15 offset:32768
ds_read_b64_tr_b16 v[154:155], v15 offset:36864
M v[88:91], v[208:211], a[152:155], v[88:91]
ds_read_b64_tr_b16 v[156:157], v15 offset:40960
ds_read_b64_tr_b16 v[158:159], v15 offset:45056
M v[88:91], v[212:215], a[156:159], v[88:91]
M v[92:95], v[220:223], a[156:159], v[92:95]
M v[92:95], v[216:219], a[152:155], v[92:95]
s_waitcnt vmcnt(24) lgkmcnt(0)
s_barrier
M v[32:35], v[96:99], a[160:163], v[32:35]
s_add_u32 m0, s41, 114688
s_nop 0
buffer_load_dwordx4 v2, s[48:51], s26 offen offset:0 lds
M v[32:35], v[100:103], a[164:167], v[32:35]
ds_read_b64_tr_b16 v[160:161], v8 offset:49152
ds_read_b64_tr_b16 v[162:163], v8 offset:53248
M v[36:39], v[108:111], a[164:167], v[36:39]
buffer_load_dwordx4 v3, s[48:51], s26 offen offset:1024 lds
M v[36:39], v[104:107], a[160:163], v[36:39]
ds_read_b64_tr_b16 v[164:165], v8 offset:57344
ds_read_b64_tr_b16 v[166:167], v8 offset:61440
M v[40:43], v[112:115], a[160:163], v[40:43]
buffer_load_dwordx4 v4, s[48:51], s26 offen offset:2048 lds
M v[40:43], v[116:119], a[164:167], v[40:43]
ds_read_b64_tr_b16 v[168:169], v9 offset:49152
ds_read_b64_tr_b16 v[170:171], v9 offset:53248
M v[44:47], v[124:127], a[164:167], v[44:47]
buffer_load_dwordx4 v5, s[48:51], s26 offen offset:3072 lds
M v[44:47], v[120:123], a[160:163], v[44:47]
M v[48:51], v[128:131], a[160:163], v[48:51]
ds_read_b64_tr_b16 v[172:173], v9 offset:57344
ds_read_b64_tr_b16 v[174:175], v9 offset:61440
M v[48:51], v[132:135], a[164:167], v[48:51]
buffer_load_dwordx4 a[240:243], v1, s[44:47], s25 offen offset:0 sc1
M v[52:55], v[140:143], a[164:167], v[52:55]
ds_read_b64_tr_b16 v[176:177], v10 offset:49152
ds_read_b64_tr_b16 v[178:179], v10 offset:53248
M v[52:55], v[136:139], a[160:163], v[52:55]
buffer_load_dwordx4 a[244:247], v1, s[44:47], s25 offen offset:1024 sc1
M v[56:59], v[144:147], a[160:163], v[56:59]
ds_read_b64_tr_b16 v[180:181], v10 offset:57344
ds_read_b64_tr_b16 v[182:183], v10 offset:61440
M v[56:59], v[148:151], a[164:167], v[56:59]
buffer_load_dwordx4 a[248:251], v1, s[44:47], s25 offen offset:2048 sc1
M v[60:63], v[156:159], a[164:167], v[60:63]
M v[60:63], v[152:155], a[160:163], v[60:63]
ds_read_b64_tr_b16 v[184:185], v11 offset:49152
ds_read_b64_tr_b16 v[186:187], v11 offset:53248
M v[64:67], v[96:99], a[168:171], v[64:67]
buffer_load_dwordx4 a[252:255], v1, s[44:47], s25 offen offset:3072 sc1
M v[64:67], v[100:103], a[172:175], v[64:67]
ds_read_b64_tr_b16 v[188:189], v11 offset:57344
ds_read_b64_tr_b16 v[190:191], v11 offset:61440
M v[68:71], v[108:111], a[172:175], v[68:71]
s_sub_u32 s39, s39, 1
s_cmp_eq_u32 s39, 0
s_cselect_b32 s3, s64, s65
M v[68:71], v[104:107], a[168:171], v[68:71]
ds_read_b64_tr_b16 v[192:193], v12 offset:49152
ds_read_b64_tr_b16 v[194:195], v12 offset:53248
M v[72:75], v[112:115], a[168:171], v[72:75]
s_add_u32 s25, s25, s3
s_lshl_b32 s3, s3, 3
s_add_u32 s26, s26, s3
M v[72:75], v[116:119], a[172:175], v[72:75]
ds_read_b64_tr_b16 v[196:197], v12 offset:57344
ds_read_b64_tr_b16 v[198:199], v12 offset:61440
M v[76:79], v[124:127], a[172:175], v[76:79]
M v[76:79], v[120:123], a[168:171], v[76:79]
ds_read_b64_tr_b16 v[200:201], v13 offset:49152
ds_read_b64_tr_b16 v[202:203], v13 offset:53248
M v[80:83], v[128:131], a[168:171], v[80:83]
ds_read_b64_tr_b16 v[204:205], v13 offset:57344
ds_read_b64_tr_b16 v[206:207], v13 offset:61440
M v[80:83], v[132:135], a[172:175], v[80:83]
ds_read_b64_tr_b16 v[208:209], v14 offset:49152
ds_read_b64_tr_b16 v[210:211], v14 offset:53248
M v[84:87], v[140:143], a[172:175], v[84:87]
ds_read_b64_tr_b16 v[212:213], v14 offset:57344
ds_read_b64_tr_b16 v[214:215], v14 offset:61440
M v[84:87], v[136:139], a[168:171], v[84:87]
ds_read_b64_tr_b16 v[216:217], v15 offset:49152
ds_read_b64_tr_b16 v[218:219], v15 offset:53248
M v[88:91], v[144:147], a[168:171], v[88:91]
ds_read_b64_tr_b16 v[220:221], v15 offset:57344
ds_read_b64_tr_b16 v[222:223], v15 offset:61440
M v[88:91], v[148:151], a[172:175], v[88:91]
M v[92:95], v[156:159], a[172:175], v[92:95]
M v[92:95], v[152:155], a[168:171], v[92:95]
s_waitcnt vmcnt(24) lgkmcnt(0)
s_barrier
M v[32:35], v[160:163], a[176:179], v[32:35]
s_add_u32 m0, s41, 0
s_nop 0
buffer_load_dwordx4 v2, s[48:51], s26 offen offset:0 lds
M v[32:35], v[164:167], a[180:183], v[32:35]
ds_read_b64_tr_b16 v[96:97], v16 offset:0
ds_read_b64_tr_b16 v[98:99], v16 offset:4096
M v[36:39], v[172:175], a[180:183], v[36:39]
buffer_load_dwordx4 v3, s[48:51], s26 offen offset:1024 lds
M v[36:39], v[168:171], a[176:179], v[36:39]
ds_read_b64_tr_b16 v[100:101], v16 offset:8192
ds_read_b64_tr_b16 v[102:103], v16 offset:12288
M v[40:43], v[176:179], a[176:179], v[40:43]
buffer_load_dwordx4 v4, s[48:51], s26 offen offset:2048 lds
M v[40:43], v[180:183], a[180:183], v[40:43]
ds_read_b64_tr_b16 v[104:105], v17 offset:0
ds_read_b64_tr_b16 v[106:107], v17 offset:4096
M v[44:47], v[188:191], a[180:183], v[44:47]
buffer_load_dwordx4 v5, s[48:51], s26 offen offset:3072 lds
M v[44:47], v[184:187], a[176:179], v[44:47]
M v[48:51], v[192:195], a[176:179], v[48:51]
ds_read_b64_tr_b16 v[108:109], v17 offset:8192
ds_read_b64_tr_b16 v[110:111], v17 offset:12288
M v[48:51], v[196:199], a[180:183], v[48:51]
buffer_load_dwordx4 a[128:131], v1, s[44:47], s25 offen offset:0 sc1
M v[52:55], v[204:207], a[180:183], v[52:55]
ds_read_b64_tr_b16 v[112:113], v18 offset:0
ds_read_b64_tr_b16 v[114:115], v18 offset:4096
M v[52:55], v[200:203], a[176:179], v[52:55]
buffer_load_dwordx4 a[132:135], v1, s[44:47], s25 offen offset:1024 sc1
M v[56:59], v[208:211], a[176:179], v[56:59]
ds_read_b64_tr_b16 v[116:117], v18 offset:8192
ds_read_b64_tr_b16 v[118:119], v18 offset:12288
M v[56:59], v[212:215], a[180:183], v[56:59]
buffer_load_dwordx4 a[136:139], v1, s[44:47], s25 offen offset:2048 sc1
M v[60:63], v[220:223], a[180:183], v[60:63]
M v[60:63], v[216:219], a[176:179], v[60:63]
ds_read_b64_tr_b16 v[120:121], v19 offset:0
ds_read_b64_tr_b16 v[122:123], v19 offset:4096
M v[64:67], v[160:163], a[184:187], v[64:67]
buffer_load_dwordx4 a[140:143], v1, s[44:47], s25 offen offset:3072 sc1
M v[64:67], v[164:167], a[188:191], v[64:67]
ds_read_b64_tr_b16 v[124:125], v19 offset:8192
ds_read_b64_tr_b16 v[126:127], v19 offset:12288
M v[68:71], v[172:175], a[188:191], v[68:71]
s_sub_u32 s39, s39, 1
s_cmp_eq_u32 s39, 0
s_cselect_b32 s3, s64, s65
M v[68:71], v[168:171], a[184:187], v[68:71]
ds_read_b64_tr_b16 v[128:129], v20 offset:0
ds_read_b64_tr_b16 v[130:131], v20 offset:4096
M v[72:75], v[176:179], a[184:187], v[72:75]
s_add_u32 s25, s25, s3
s_lshl_b32 s3, s3, 3
s_add_u32 s26, s26, s3
M v[72:75], v[180:183], a[188:191], v[72:75]
ds_read_b64_tr_b16 v[132:133], v20 offset:8192
ds_read_b64_tr_b16 v[134:135], v20 offset:12288
M v[76:79], v[188:191], a[188:191], v[76:79]
M v[76:79], v[184:187], a[184:187], v[76:79]
ds_read_b64_tr_b16 v[136:137], v21 offset:0
ds_read_b64_tr_b16 v[138:139], v21 offset:4096
M v[80:83], v[192:195], a[184:187], v[80:83]
ds_read_b64_tr_b16 v[140:141], v21 offset:8192
ds_read_b64_tr_b16 v[142:143], v21 offset:12288
M v[80:83], v[196:199], a[188:191], v[80:83]
ds_read_b64_tr_b16 v[144:145], v22 offset:0
ds_read_b64_tr_b16 v[146:147], v22 offset:4096
M v[84:87], v[204:207], a[188:191], v[84:87]
ds_read_b64_tr_b16 v[148:149], v22 offset:8192
ds_read_b64_tr_b16 v[150:151], v22 offset:12288
M v[84:87], v[200:203], a[184:187], v[84:87]
ds_read_b64_tr_b16 v[152:153], v23 offset:0
ds_read_b64_tr_b16 v[154:155], v23 offset:4096
M v[88:91], v[208:211], a[184:187], v[88:91]
ds_read_b64_tr_b16 v[156:157], v23 offset:8192
ds_read_b64_tr_b16 v[158:159], v23 offset:12288
M v[88:91], v[212:215], a[188:191], v[88:91]
M v[92:95], v[220:223], a[188:191], v[92:95]
M v[92:95], v[216:219], a[184:187], v[92:95]
s_waitcnt vmcnt(24) lgkmcnt(0)
s_barrier
M v[32:35], v[96:99], a[192:195], v[32:35]
s_add_u32 m0, s41, 16384
s_nop 0
buffer_load_dwordx4 v2, s[48:51], s26 offen offset:0 lds
M v[32:35], v[100:103], a[196:199], v[32:35]
ds_read_b64_tr_b16 v[160:161], v16 offset:16384
ds_read_b64_tr_b16 v[162:163], v16 offset:20480
M v[36:39], v[108:111], a[196:199], v[36:39]
buffer_load_dwordx4 v3, s[48:51], s26 offen offset:1024 lds
M v[36:39], v[104:107], a[192:195], v[36:39]
ds_read_b64_tr_b16 v[164:165], v16 offset:24576
ds_read_b64_tr_b16 v[166:167], v16 offset:28672
M v[40:43], v[112:115], a[192:195], v[40:43]
buffer_load_dwordx4 v4, s[48:51], s26 offen offset:2048 lds
M v[40:43], v[116:119], a[196:199], v[40:43]
ds_read_b64_tr_b16 v[168:169], v17 offset:16384
ds_read_b64_tr_b16 v[170:171], v17 offset:20480
M v[44:47], v[124:127], a[196:199], v[44:47]
buffer_load_dwordx4 v5, s[48:51], s26 offen offset:3072 lds
M v[44:47], v[120:123], a[192:195], v[44:47]
M v[48:51], v[128:131], a[192:195], v[48:51]
ds_read_b64_tr_b16 v[172:173], v17 offset:24576
ds_read_b64_tr_b16 v[174:175], v17 offset:28672
M v[48:51], v[132:135], a[196:199], v[48:51]
buffer_load_dwordx4 a[144:147], v1, s[44:47], s25 offen offset:0 sc1
M v[52:55], v[140:143], a[196:199], v[52:55]
ds_read_b64_tr_b16 v[176:177], v18 offset:16384
ds_read_b64_tr_b16 v[178:179], v18 offset:20480
M v[52:55], v[136:139], a[192:195], v[52:55]
buffer_load_dwordx4 a[148:151], v1, s[44:47], s25 offen offset:1024 sc1
M v[56:59], v[144:147], a[192:195], v[56:59]
ds_read_b64_tr_b16 v[180:181], v18 offset:24576
ds_read_b64_tr_b16 v[182:183], v18 offset:28672
M v[56:59], v[148:151], a[196:199], v[56:59]
buffer_load_dwordx4 a[152:155], v1, s[44:47], s25 offen offset:2048 sc1
M v[60:63], v[156:159], a[196:199], v[60:63]
M v[60:63], v[152:155], a[192:195], v[60:63]
ds_read_b64_tr_b16 v[184:185], v19 offset:16384
ds_read_b64_tr_b16 v[186:187], v19 offset:20480
M v[64:67], v[96:99], a[200:203], v[64:67]
buffer_load_dwordx4 a[156:159], v1, s[44:47], s25 offen offset:3072 sc1
M v[64:67], v[100:103], a[204:207], v[64:67]
ds_read_b64_tr_b16 v[188:189], v19 offset:24576
ds_read_b64_tr_b16 v[190:191], v19 offset:28672
M v[68:71], v[108:111], a[204:207], v[68:71]
s_sub_u32 s39, s39, 1
s_cmp_eq_u32 s39, 0
s_cselect_b32 s3, s64, s65
M v[68:71], v[104:107], a[200:203], v[68:71]
ds_read_b64_tr_b16 v[192:193], v20 offset:16384
ds_read_b64_tr_b16 v[194:195], v20 offset:20480
M v[72:75], v[112:115], a[200:203], v[72:75]
s_add_u32 s25, s25, s3
s_lshl_b32 s3, s3, 3
s_add_u32 s26, s26, s3
M v[72:75], v[116:119], a[204:207], v[72:75]
ds_read_b64_tr_b16 v[196:197], v20 offset:24576
ds_read_b64_tr_b16 v[198:199], v20 offset:28672
M v[76:79], v[124:127], a[204:207], v[76:79]
M v[76:79], v[120:123], a[200:203], v[76:79]
ds_read_b64_tr_b16 v[200:201], v21 offset:16384
ds_read_b64_tr_b16 v[202:203], v21 offset:20480
M v[80:83], v[128:131], a[200:203], v[80:83]
ds_read_b64_tr_b16 v[204:205], v21 offset:24576
ds_read_b64_tr_b16 v[206:207], v21 offset:28672
M v[80:83], v[132:135], a[204:207], v[80:83]
ds_read_b64_tr_b16 v[208:209], v22 offset:16384
ds_read_b64_tr_b16 v[210:211], v22 offset:20480
M v[84:87], v[140:143], a[204:207], v[84:87]
ds_read_b64_tr_b16 v[212:213], v22 offset:24576
ds_read_b64_tr_b16 v[214:215], v22 offset:28672
M v[84:87], v[136:139], a[200:203], v[84:87]
ds_read_b64_tr_b16 v[216:217], v23 offset:16384
ds_read_b64_tr_b16 v[218:219], v23 offset:20480
M v[88:91], v[144:147], a[200:203], v[88:91]
ds_read_b64_tr_b16 v[220:221], v23 offset:24576
ds_read_b64_tr_b16 v[222:223], v23 offset:28672
M v[88:91], v[148:151], a[204:207], v[88:91]
M v[92:95], v[156:159], a[204:207], v[92:95]
M v[92:95], v[152:155], a[200:203], v[92:95]
s_sub_u32 s28, s28, 1
s_cmp_lg_u32 s28, 0
s_cbranch_scc1 Lk3_la
s_waitcnt vmcnt(24) lgkmcnt(0)
s_barrier
M v[32:35], v[160:163], a[208:211], v[32:35]
s_add_u32 m0, s41, 32768
s_nop 0
buffer_load_dwordx4 v2, s[48:51], s26 offen offset:0 lds
M v[32:35], v[164:167], a[212:215], v[32:35]
ds_read_b64_tr_b16 v[96:97], v16 offset:32768
ds_read_b64_tr_b16 v[98:99], v16 offset:36864
M v[36:39], v[172:175], a[212:215], v[36:39]
buffer_load_dwordx4 v3, s[48:51], s26 offen offset:1024 lds
M v[36:39], v[168:171], a[208:211], v[36:39]
ds_read_b64_tr_b16 v[100:101], v16 offset:40960
ds_read_b64_tr_b16 v[102:103], v16 offset:45056
M v[40:43], v[176:179], a[208:211], v[40:43]
buffer_load_dwordx4 v4, s[48:51], s26 offen offset:2048 lds
M v[40:43], v[180:183], a[212:215], v[40:43]
ds_read_b64_tr_b16 v[104:105], v17 offset:32768
ds_read_b64_tr_b16 v[106:107], v17 offset:36864
M v[44:47], v[188:191], a[212:215], v[44:47]
buffer_load_dwordx4 v5, s[48:51], s26 offen offset:3072 lds
M v[44:47], v[184:187], a[208:211], v[44:47]
M v[48:51], v[192:195], a[208:211], v[48:51]
ds_read_b64_tr_b16 v[108:109], v17 offset:40960
ds_read_b64_tr_b16 v[110:111], v17 offset:45056
M v[48:51], v[196:199], a[212:215], v[48:51]
buffer_load_dwordx4 a[160:163], v1, s[44:47], s25 offen offset:0 sc1
M v[52:55], v[204:207], a[212:215], v[52:55]
ds_read_b64_tr_b16 v[112:113], v18 offset:32768
ds_read_b64_tr_b16 v[114:115], v18 offset:36864
M v[52:55], v[200:203], a[208:211], v[52:55]
buffer_load_dwordx4 a[164:167], v1, s[44:47], s25 offen offset:1024 sc1
M v[56:59], v[208:211], a[208:211], v[56:59]
ds_read_b64_tr_b16 v[116:117], v18 offset:40960
ds_read_b64_tr_b16 v[118:119], v18 offset:45056
M v[56:59], v[212:215], a[212:215], v[56:59]
buffer_load_dwordx4 a[168:171], v1, s[44:47], s25 offen offset:2048 sc1
M v[60:63], v[220:223], a[212:215], v[60:63]
M v[60:63], v[216:219], a[208:211], v[60:63]
ds_read_b64_tr_b16 v[120:121], v19 offset:32768
ds_read_b64_tr_b16 v[122:123], v19 offset:36864
M v[64:67], v[160:163], a[216:219], v[64:67]
buffer_load_dwordx4 a[172:175], v1, s[44:47], s25 offen offset:3072 sc1
M v[64:67], v[164:167], a[220:223], v[64:67]
ds_read_b64_tr_b16 v[124:125], v19 offset:40960
ds_read_b64_tr_b16 v[126:127], v19 offset:45056
M v[68:71], v[172:175], a[220:223], v[68:71]
s_sub_u32 s39, s39, 1
s_cmp_eq_u32 s39, 0
s_cselect_b32 s3, s64, s65
M v[68:71], v[168:171], a[216:219], v[68:71]
ds_read_b64_tr_b16 v[128:129], v20 offset:32768
ds_read_b64_tr_b16 v[130:131], v20 offset:36864
M v[72:75], v[176:179], a[216:219], v[72:75]
s_add_u32 s25, s25, s3
s_lshl_b32 s3, s3, 3
s_add_u32 s26, s26, s3
M v[72:75], v[180:183], a[220:223], v[72:75]
ds_read_b64_tr_b16 v[132:133], v20 offset:40960
ds_read_b64_tr_b16 v[134:135], v20 offset:45056
M v[76:79], v[188:191], a[220:223], v[76:79]
M v[76:79], v[184:187], a[216:219], v[76:79]
ds_read_b64_tr_b16 v[136:137], v21 offset:32768
ds_read_b64_tr_b16 v[138:139], v21 offset:36864
M v[80:83], v[192:195], a[216:219], v[80:83]
ds_read_b64_tr_b16 v[140:141], v21 offset:40960
ds_read_b64_tr_b16 v[142:143], v21 offset:45056
M v[80:83], v[196:199], a[220:223], v[80:83]
ds_read_b64_tr_b16 v[144:145], v22 offset:32768
ds_read_b64_tr_b16 v[146:147], v22 offset:36864
M v[84:87], v[204:207], a[220:223], v[84:87]
ds_read_b64_tr_b16 v[148:149], v22 offset:40960
ds_read_b64_tr_b16 v[150:151], v22 offset:45056
M v[84:87], v[200:203], a[216:219], v[84:87]
ds_read_b64_tr_b16 v[152:153], v23 offset:32768
ds_read_b64_tr_b16 v[154:155], v23 offset:36864
M v[88:91], v[208:211], a[216:219], v[88:91]
ds_read_b64_tr_b16 v[156:157], v23 offset:40960
ds_read_b64_tr_b16 v[158:159], v23 offset:45056
M v[88:91], v[212:215], a[220:223], v[88:91]
M v[92:95], v[220:223], a[220:223], v[92:95]
M v[92:95], v[216:219], a[216:219], v[92:95]
s_waitcnt vmcnt(24) lgkmcnt(0)
s_barrier
M v[32:35], v[96:99], a[224:227], v[32:35]
s_add_u32 m0, s41, 49152
s_nop 0
buffer_load_dwordx4 v2, s[48:51], s26 offen offset:0 lds
M v[32:35], v[100:103], a[228:231], v[32:35]
ds_read_b64_tr_b16 v[160:161], v16 offset:49152
ds_read_b64_tr_b16 v[162:163], v16 offset:53248
M v[36:39], v[108:111], a[228:231], v[36:39]
buffer_load_dwordx4 v3, s[48:51], s26 offen offset:1024 lds
M v[36:39], v[104:107], a[224:227], v[36:39]
ds_read_b64_tr_b16 v[164:165], v16 offset:57344
ds_read_b64_tr_b16 v[166:167], v16 offset:61440
M v[40:43], v[112:115], a[224:227], v[40:43]
buffer_load_dwordx4 v4, s[48:51], s26 offen offset:2048 lds
M v[40:43], v[116:119], a[228:231], v[40:43]
ds_read_b64_tr_b16 v[168:169], v17 offset:49152
ds_read_b64_tr_b16 v[170:171], v17 offset:53248
M v[44:47], v[124:127], a[228:231], v[44:47]
buffer_load_dwordx4 v5, s[48:51], s26 offen offset:3072 lds
M v[44:47], v[120:123], a[224:227], v[44:47]
M v[48:51], v[128:131], a[224:227], v[48:51]
ds_read_b64_tr_b16 v[172:173], v17 offset:57344
ds_read_b64_tr_b16 v[174:175], v17 offset:61440
M v[48:51], v[132:135], a[228:231], v[48:51]
buffer_load_dwordx4 a[176:179], v1, s[44:47], s25 offen offset:0 sc1
M v[52:55], v[140:143], a[228:231], v[52:55]
ds_read_b64_tr_b16 v[176:177], v18 offset:49152
ds_read_b64_tr_b16 v[178:179], v18 offset:53248
M v[52:55], v[136:139], a[224:227], v[52:55]
buffer_load_dwordx4 a[180:183], v1, s[44:47], s25 offen offset:1024 sc1
M v[56:59], v[144:147], a[224:227], v[56:59]
ds_read_b64_tr_b16 v[180:181], v18 offset:57344
ds_read_b64_tr_b16 v[182:183], v18 offset:61440
M v[56:59], v[148:151], a[228:231], v[56:59]
buffer_load_dwordx4 a[184:187], v1, s[44:47], s25 offen offset:2048 sc1
M v[60:63], v[156:159], a[228:231], v[60:63]
M v[60:63], v[152:155], a[224:227], v[60:63]
ds_read_b64_tr_b16 v[184:185], v19 offset:49152
ds_read_b64_tr_b16 v[186:187], v19 offset:53248
M v[64:67], v[96:99], a[232:235], v[64:67]
buffer_load_dwordx4 a[188:191], v1, s[44:47], s25 offen offset:3072 sc1
M v[64:67], v[100:103], a[236:239], v[64:67]
ds_read_b64_tr_b16 v[188:189], v19 offset:57344
ds_read_b64_tr_b16 v[190:191], v19 offset:61440
M v[68:71], v[108:111], a[236:239], v[68:71]
s_sub_u32 s39, s39, 1
s_cmp_eq_u32 s39, 0
s_cselect_b32 s3, s64, s65
M v[68:71], v[104:107], a[232:235], v[68:71]
ds_read_b64_tr_b16 v[192:193], v20 offset:49152
ds_read_b64_tr_b16 v[194:195], v20 offset:53248
M v[72:75], v[112:115], a[232:235], v[72:75]
s_add_u32 s25, s25, s3
s_lshl_b32 s3, s3, 3
s_add_u32 s26, s26, s3
M v[72:75], v[116:119], a[236:239], v[72:75]
ds_read_b64_tr_b16 v[196:197], v20 offset:57344
ds_read_b64_tr_b16 v[198:199], v20 offset:61440
M v[76:79], v[124:127], a[236:239], v[76:79]
M v[76:79], v[120:123], a[232:235], v[76:79]
ds_read_b64_tr_b16 v[200:201], v21 offset:49152
ds_read_b64_tr_b16 v[202:203], v21 offset:53248
M v[80:83], v[128:131], a[232:235], v[80:83]
ds_read_b64_tr_b16 v[204:205], v21 offset:57344
ds_read_b64_tr_b16 v[206:207], v21 offset:61440
M v[80:83], v[132:135], a[236:239], v[80:83]
ds_read_b64_tr_b16 v[208:209], v22 offset:49152
ds_read_b64_tr_b16 v[210:211], v22 offset:53248
M v[84:87], v[140:143], a[236:239], v[84:87]
ds_read_b64_tr_b16 v[212:213], v22 offset:57344
ds_read_b64_tr_b16 v[214:215], v22 offset:61440
M v[84:87], v[136:139], a[232:235], v[84:87]
ds_read_b64_tr_b16 v[216:217], v23 offset:49152
ds_read_b64_tr_b16 v[218:219], v23 offset:53248
M v[88:91], v[144:147], a[232:235], v[88:91]
ds_read_b64_tr_b16 v[220:221], v23 offset:57344
ds_read_b64_tr_b16 v[222:223], v23 offset:61440
M v[88:91], v[148:151], a[236:239], v[88:91]
M v[92:95], v[156:159], a[236:239], v[92:95]
M v[92:95], v[152:155], a[232:235], v[92:95]
s_waitcnt vmcnt(24) lgkmcnt(0)
s_barrier
M v[32:35], v[160:163], a[240:243], v[32:35]
s_mov_b64 s[44:45], s[34:35]
s_mov_b32 s46, 4194304
s_mov_b64 s[48:49], s[36:37]
s_mov_b32 s50, 2097152
s_mov_b32 s25, s32
s_mov_b32 s26, s33
s_add_u32 m0, s42, 65536
s_nop 0
buffer_load_dwordx4 v6, s[48:51], s26 offen offset:0 lds
M v[32:35], v[164:167], a[244:247], v[32:35]
ds_read_b64_tr_b16 v[96:97], v8 offset:0
ds_read_b64_tr_b16 v[98:99], v8 offset:4096
M v[36:39], v[172:175], a[244:247], v[36:39]
buffer_load_dwordx4 v7, s[48:51], s26 offen offset:1024 lds
M v[36:39], v[168:171], a[240:243], v[36:39]
ds_read_b64_tr_b16 v[100:101], v8 offset:8192
ds_read_b64_tr_b16 v[102:103], v8 offset:12288
M v[40:43], v[176:179], a[240:243], v[40:43]
M v[40:43], v[180:183], a[244:247], v[40:43]
buffer_load_dwordx4 a[192:195], v1, s[44:47], s25 offen offset:0 sc1
M v[44:47], v[188:191], a[244:247], v[44:47]
ds_read_b64_tr_b16 v[104:105], v9 offset:0
ds_read_b64_tr_b16 v[106:107], v9 offset:4096
M v[44:47], v[184:187], a[240:243], v[44:47]
buffer_load_dwordx4 a[196:199], v1, s[44:47], s25 offen offset:1024 sc1
M v[48:51], v[192:195], a[240:243], v[48:51]
M v[48:51], v[196:199], a[244:247], v[48:51]
ds_read_b64_tr_b16 v[108:109], v9 offset:8192
ds_read_b64_tr_b16 v[110:111], v9 offset:12288
M v[52:55], v[204:207], a[244:247], v[52:55]
buffer_load_dwordx4 a[200:203], v1, s[44:47], s25 offen offset:2048 sc1
M v[52:55], v[200:203], a[240:243], v[52:55]
ds_read_b64_tr_b16 v[112:113], v10 offset:0
ds_read_b64_tr_b16 v[114:115], v10 offset:4096
M v[56:59], v[208:211], a[240:243], v[56:59]
M v[56:59], v[212:215], a[244:247], v[56:59]
buffer_load_dwordx4 a[204:207], v1, s[44:47], s25 offen offset:3072 sc1
M v[60:63], v[220:223], a[244:247], v[60:63]
ds_read_b64_tr_b16 v[116:117], v10 offset:8192
ds_read_b64_tr_b16 v[118:119], v10 offset:12288
M v[60:63], v[216:219], a[240:243], v[60:63]
s_add_u32 s25, s25, 16384
s_add_u32 s26, s26, 131072
M v[64:67], v[160:163], a[248:251], v[64:67]
ds_read_b64_tr_b16 v[120:121], v11 offset:0
ds_read_b64_tr_b16 v[122:123], v11 offset:4096
M v[64:67], v[164:167], a[252:255], v[64:67]
M v[68:71], v[172:175], a[252:255], v[68:71]
ds_read_b64_tr_b16 v[124:125], v11 offset:8192
ds_read_b64_tr_b16 v[126:127], v11 offset:12288
M v[68:71], v[168:171], a[248:251], v[68:71]
ds_read_b64_tr_b16 v[128:129], v12 offset:0
ds_read_b64_tr_b16 v[130:131], v12 offset:4096
M v[72:75], v[176:179], a[248:251], v[72:75]
ds_read_b64_tr_b16 v[132:133], v12 offset:8192
ds_read_b64_tr_b16 v[134:135], v12 offset:12288
M v[72:75], v[180:183], a[252:255], v[72:75]
M v[76:79], v[188:191], a[252:255], v[76:79]
ds_read_b64_tr_b16 v[136:137], v13 offset:0
ds_read_b64_tr_b16 v[138:139], v13 offset:4096
M v[76:79], v[184:187], a[248:251], v[76:79]
ds_read_b64_tr_b16 v[140:141], v13 offset:8192
ds_read_b64_tr_b16 v[142:143], v13 offset:12288
M v[80:83], v[192:195], a[248:251], v[80:83]
ds_read_b64_tr_b16 v[144:145], v14 offset:0
ds_read_b64_tr_b16 v[146:147], v14 offset:4096
M v[80:83], v[196:199], a[252:255], v[80:83]
M v[84:87], v[204:207], a[252:255], v[84:87]
ds_read_b64_tr_b16 v[148:149], v14 offset:8192
ds_read_b64_tr_b16 v[150:151], v14 offset:12288
M v[84:87], v[200:203], a[248:251], v[84:87]
ds_read_b64_tr_b16 v[152:153], v15 offset:0
ds_read_b64_tr_b16 v[154:155], v15 offset:4096
M v[88:91], v[208:211], a[248:251], v[88:91]
ds_read_b64_tr_b16 v[156:157], v15 offset:8192
ds_read_b64_tr_b16 v[158:159], v15 offset:12288
M v[88:91], v[212:215], a[252:255], v[88:91]
M v[92:95], v[220:223], a[252:255], v[92:95]
M v[92:95], v[216:219], a[248:251], v[92:95]
s_waitcnt vmcnt(22) lgkmcnt(0)
s_barrier
M v[32:35], v[96:99], a[128:131], v[32:35]
s_add_u32 m0, s42, 81920
s_nop 0
buffer_load_dwordx4 v6, s[48:51], s26 offen offset:0 lds
M v[32:35], v[100:103], a[132:135], v[32:35]
ds_read_b64_tr_b16 v[160:161], v8 offset:16384
ds_read_b64_tr_b16 v[162:163], v8 offset:20480
M v[36:39], v[108:111], a[132:135], v[36:39]
buffer_load_dwordx4 v7, s[48:51], s26 offen offset:1024 lds
M v[36:39], v[104:107], a[128:131], v[36:39]
ds_read_b64_tr_b16 v[164:165], v8 offset:24576
ds_read_b64_tr_b16 v[166:167], v8 offset:28672
M v[40:43], v[112:115], a[128:131], v[40:43]
M v[40:43], v[116:119], a[132:135], v[40:43]
buffer_load_dwordx4 a[208:211], v1, s[44:47], s25 offen offset:0 sc1
M v[44:47], v[124:127], a[132:135], v[44:47]
ds_read_b64_tr_b16 v[168:169], v9 offset:16384
ds_read_b64_tr_b16 v[170:171], v9 offset:20480
M v[44:47], v[120:123], a[128:131], v[44:47]
buffer_load_dwordx4 a[212:215], v1, s[44:47], s25 offen offset:1024 sc1
M v[48:51], v[128:131], a[128:131], v[48:51]
M v[48:51], v[132:135], a[132:135], v[48:51]
ds_read_b64_tr_b16 v[172:173], v9 offset:24576
ds_read_b64_tr_b16 v[174:175], v9 offset:28672
M v[52:55], v[140:143], a[132:135], v[52:55]
buffer_load_dwordx4 a[216:219], v1, s[44:47], s25 offen offset:2048 sc1
M v[52:55], v[136:139], a[128:131], v[52:55]
ds_read_b64_tr_b16 v[176:177], v10 offset:16384
ds_read_b64_tr_b16 v[178:179], v10 offset:20480
M v[56:59], v[144:147], a[128:131], v[56:59]
M v[56:59], v[148:151], a[132:135], v[56:59]
buffer_load_dwordx4 a[220:223], v1, s[44:47], s25 offen offset:3072 sc1
M v[60:63], v[156:159], a[132:135], v[60:63]
ds_read_b64_tr_b16 v[180:181], v10 offset:24576
ds_read_b64_tr_b16 v[182:183], v10 offset:28672
M v[60:63], v[152:155], a[128:131], v[60:63]
s_add_u32 s25, s25, 16384
s_add_u32 s26, s26, 131072
M v[64:67], v[96:99], a[136:139], v[64:67]
ds_read_b64_tr_b16 v[184:185], v11 offset:16384
ds_read_b64_tr_b16 v[186:187], v11 offset:20480
M v[64:67], v[100:103], a[140:143], v[64:67]
M v[68:71], v[108:111], a[140:143], v[68:71]
ds_read_b64_tr_b16 v[188:189], v11 offset:24576
ds_read_b64_tr_b16 v[190:191], v11 offset:28672
M v[68:71], v[104:107], a[136:139], v[68:71]
ds_read_b64_tr_b16 v[192:193], v12 offset:16384
ds_read_b64_tr_b16 v[194:195], v12 offset:20480
M v[72:75], v[112:115], a[136:139], v[72:75]
ds_read_b64_tr_b16 v[196:197], v12 offset:24576
ds_read_b64_tr_b16 v[198:199], v12 offset:28672
M v[72:75], v[116:119], a[140:143], v[72:75]
M v[76:79], v[124:127], a[140:143], v[76:79]
ds_read_b64_tr_b16 v[200:201], v13 offset:16384
ds_read_b64_tr_b16 v[202:203], v13 offset:20480
M v[76:79], v[120:123], a[136:139], v[76:79]
ds_read_b64_tr_b16 v[204:205], v13 offset:24576
ds_read_b64_tr_b16 v[206:207], v13 offset:28672
M v[80:83], v[128:131], a[136:139], v[80:83]
ds_read_b64_tr_b16 v[208:209], v14 offset:16384
ds_read_b64_tr_b16 v[210:211], v14 offset:20480
M v[80:83], v[132:135], a[140:143], v[80:83]
M v[84:87], v[140:143], a[140:143], v[84:87]
ds_read_b64_tr_b16 v[212:213], v14 offset:24576
ds_read_b64_tr_b16 v[214:215], v14 offset:28672
M v[84:87], v[136:139], a[136:139], v[84:87]
ds_read_b64_tr_b16 v[216:217], v15 offset:16384
ds_read_b64_tr_b16 v[218:219], v15 offset:20480
M v[88:91], v[144:147], a[136:139], v[88:91]
ds_read_b64_tr_b16 v[220:221], v15 offset:24576
ds_read_b64_tr_b16 v[222:223], v15 offset:28672
M v[88:91], v[148:151], a[140:143], v[88:91]
M v[92:95], v[156:159], a[140:143], v[92:95]
M v[92:95], v[152:155], a[136:139], v[92:95]
s_waitcnt vmcnt(20) lgkmcnt(0)
s_barrier
M v[32:35], v[160:163], a[144:147], v[32:35]
s_add_u32 m0, s42, 98304
s_nop 0
buffer_load_dwordx4 v6, s[48:51], s26 offen offset:0 lds
M v[32:35], v[164:167], a[148:151], v[32:35]
ds_read_b64_tr_b16 v[96:97], v8 offset:32768
ds_read_b64_tr_b16 v[98:99], v8 offset:36864
M v[36:39], v[172:175], a[148:151], v[36:39]
buffer_load_dwordx4 v7, s[48:51], s26 offen offset:1024 lds
M v[36:39], v[168:171], a[144:147], v[36:39]
ds_read_b64_tr_b16 v[100:101], v8 offset:40960
ds_read_b64_tr_b16 v[102:103], v8 offset:45056
M v[40:43], v[176:179], a[144:147], v[40:43]
M v[40:43], v[180:183], a[148:151], v[40:43]
buffer_load_dwordx4 a[224:227], v1, s[44:47], s25 offen offset:0 sc1
M v[44:47], v[188:191], a[148:151], v[44:47]
ds_read_b64_tr_b16 v[104:105], v9 offset:32768
ds_read_b64_tr_b16 v[106:107], v9 offset:36864
M v[44:47], v[184:187], a[144:147], v[44:47]
buffer_load_dwordx4 a[228:231], v1, s[44:47], s25 offen offset:1024 sc1
M v[48:51], v[192:195], a[144:147], v[48:51]
M v[48:51], v[196:199], a[148:151], v[48:51]
ds_read_b64_tr_b16 v[108:109], v9 offset:40960
ds_read_b64_tr_b16 v[110:111], v9 offset:45056
M v[52:55], v[204:207], a[148:151], v[52:55]
buffer_load_dwordx4 a[232:235], v1, s[44:47], s25 offen offset:2048 sc1
M v[52:55], v[200:203], a[144:147], v[52:55]
ds_read_b64_tr_b16 v[112:113], v10 offset:32768
ds_read_b64_tr_b16 v[114:115], v10 offset:36864
M v[56:59], v[208:211], a[144:147], v[56:59]
M v[56:59], v[212:215], a[148:151], v[56:59]
buffer_load_dwordx4 a[236:239], v1, s[44:47], s25 offen offset:3072 sc1
M v[60:63], v[220:223], a[148:151], v[60:63]
ds_read_b64_tr_b16 v[116:117], v10 offset:40960
ds_read_b64_tr_b16 v[118:119], v10 offset:45056
M v[60:63], v[216:219], a[144:147], v[60:63]
s_add_u32 s25, s25, 16384
s_add_u32 s26, s26, 131072
M v[64:67], v[160:163], a[152:155], v[64:67]
ds_read_b64_tr_b16 v[120:121], v11 offset:32768
ds_read_b64_tr_b16 v[122:123], v11 offset:36864
M v[64:67], v[164:167], a[156:159], v[64:67]
M v[68:71], v[172:175], a[156:159], v[68:71]
ds_read_b64_tr_b16 v[124:125], v11 offset:40960
ds_read_b64_tr_b16 v[126:127], v11 offset:45056
M v[68:71], v[168:171], a[152:155], v[68:71]
ds_read_b64_tr_b16 v[128:129], v12 offset:32768
ds_read_b64_tr_b16 v[130:131], v12 offset:36864
M v[72:75], v[176:179], a[152:155], v[72:75]
ds_read_b64_tr_b16 v[132:133], v12 offset:40960
ds_read_b64_tr_b16 v[134:135], v12 offset:45056
M v[72:75], v[180:183], a[156:159], v[72:75]
M v[76:79], v[188:191], a[156:159], v[76:79]
ds_read_b64_tr_b16 v[136:137], v13 offset:32768
ds_read_b64_tr_b16 v[138:139], v13 offset:36864
M v[76:79], v[184:187], a[152:155], v[76:79]
ds_read_b64_tr_b16 v[140:141], v13 offset:40960
ds_read_b64_tr_b16 v[142:143], v13 offset:45056
M v[80:83], v[192:195], a[152:155], v[80:83]
ds_read_b64_tr_b16 v[144:145], v14 offset:32768
ds_read_b64_tr_b16 v[146:147], v14 offset:36864
M v[80:83], v[196:199], a[156:159], v[80:83]
M v[84:87], v[204:207], a[156:159], v[84:87]
ds_read_b64_tr_b16 v[148:149], v14 offset:40960
ds_read_b64_tr_b16 v[150:151], v14 offset:45056
M v[84:87], v[200:203], a[152:155], v[84:87]
ds_read_b64_tr_b16 v[152:153], v15 offset:32768
ds_read_b64_tr_b16 v[154:155], v15 offset:36864
M v[88:91], v[208:211], a[152:155], v[88:91]
ds_read_b64_tr_b16 v[156:157], v15 offset:40960
ds_read_b64_tr_b16 v[158:159], v15 offset:45056
M v[88:91], v[212:215], a[156:159], v[88:91]
M v[92:95], v[220:223], a[156:159], v[92:95]
M v[92:95], v[216:219], a[152:155], v[92:95]
s_waitcnt vmcnt(18) lgkmcnt(0)
s_barrier
M v[32:35], v[96:99], a[160:163], v[32:35]
s_add_u32 m0, s42, 114688
s_nop 0
buffer_load_dwordx4 v6, s[48:51], s26 offen offset:0 lds
M v[32:35], v[100:103], a[164:167], v[32:35]
ds_read_b64_tr_b16 v[160:161], v8 offset:49152
ds_read_b64_tr_b16 v[162:163], v8 offset:53248
M v[36:39], v[108:111], a[164:167], v[36:39]
buffer_load_dwordx4 v7, s[48:51], s26 offen offset:1024 lds
M v[36:39], v[104:107], a[160:163], v[36:39]
ds_read_b64_tr_b16 v[164:165], v8 offset:57344
ds_read_b64_tr_b16 v[166:167], v8 offset:61440
M v[40:43], v[112:115], a[160:163], v[40:43]
M v[40:43], v[116:119], a[164:167], v[40:43]
buffer_load_dwordx4 a[240:243], v1, s[44:47], s25 offen offset:0 sc1
M v[44:47], v[124:127], a[164:167], v[44:47]
ds_read_b64_tr_b16 v[168:169], v9 offset:49152
ds_read_b64_tr_b16 v[170:171], v9 offset:53248
M v[44:47], v[120:123], a[160:163], v[44:47]
buffer_load_dwordx4 a[244:247], v1, s[44:47], s25 offen offset:1024 sc1
M v[48:51], v[128:131], a[160:163], v[48:51]
M v[48:51], v[132:135], a[164:167], v[48:51]
ds_read_b64_tr_b16 v[172:173], v9 offset:57344
ds_read_b64_tr_b16 v[174:175], v9 offset:61440
M v[52:55], v[140:143], a[164:167], v[52:55]
buffer_load_dwordx4 a[248:251], v1, s[44:47], s25 offen offset:2048 sc1
M v[52:55], v[136:139], a[160:163], v[52:55]
ds_read_b64_tr_b16 v[176:177], v10 offset:49152
ds_read_b64_tr_b16 v[178:179], v10 offset:53248
M v[56:59], v[144:147], a[160:163], v[56:59]
M v[56:59], v[148:151], a[164:167], v[56:59]
buffer_load_dwordx4 a[252:255], v1, s[44:47], s25 offen offset:3072 sc1
M v[60:63], v[156:159], a[164:167], v[60:63]
ds_read_b64_tr_b16 v[180:181], v10 offset:57344
ds_read_b64_tr_b16 v[182:183], v10 offset:61440
M v[60:63], v[152:155], a[160:163], v[60:63]
s_add_u32 s25, s25, 16384
s_add_u32 s26, s26, 131072
M v[64:67], v[96:99], a[168:171], v[64:67]
ds_read_b64_tr_b16 v[184:185], v11 offset:49152
ds_read_b64_tr_b16 v[186:187], v11 offset:53248
M v[64:67], v[100:103], a[172:175], v[64:67]
M v[68:71], v[108:111], a[172:175], v[68:71]
ds_read_b64_tr_b16 v[188:189], v11 offset:57344
ds_read_b64_tr_b16 v[190:191], v11 offset:61440
M v[68:71], v[104:107], a[168:171], v[68:71]
ds_read_b64_tr_b16 v[192:193], v12 offset:49152
ds_read_b64_tr_b16 v[194:195], v12 offset:53248
M v[72:75], v[112:115], a[168:171], v[72:75]
ds_read_b64_tr_b16 v[196:197], v12 offset:57344
ds_read_b64_tr_b16 v[198:199], v12 offset:61440
M v[72:75], v[116:119], a[172:175], v[72:75]
M v[76:79], v[124:127], a[172:175], v[76:79]
ds_read_b64_tr_b16 v[200:201], v13 offset:49152
ds_read_b64_tr_b16 v[202:203], v13 offset:53248
M v[76:79], v[120:123], a[168:171], v[76:79]
ds_read_b64_tr_b16 v[204:205], v13 offset:57344
ds_read_b64_tr_b16 v[206:207], v13 offset:61440
M v[80:83], v[128:131], a[168:171], v[80:83]
ds_read_b64_tr_b16 v[208:209], v14 offset:49152
ds_read_b64_tr_b16 v[210:211], v14 offset:53248
M v[80:83], v[132:135], a[172:175], v[80:83]
M v[84:87], v[140:143], a[172:175], v[84:87]
ds_read_b64_tr_b16 v[212:213], v14 offset:57344
ds_read_b64_tr_b16 v[214:215], v14 offset:61440
M v[84:87], v[136:139], a[168:171], v[84:87]
ds_read_b64_tr_b16 v[216:217], v15 offset:49152
ds_read_b64_tr_b16 v[218:219], v15 offset:53248
M v[88:91], v[144:147], a[168:171], v[88:91]
ds_read_b64_tr_b16 v[220:221], v15 offset:57344
ds_read_b64_tr_b16 v[222:223], v15 offset:61440
M v[88:91], v[148:151], a[172:175], v[88:91]
M v[92:95], v[156:159], a[172:175], v[92:95]
M v[92:95], v[152:155], a[168:171], v[92:95]
s_waitcnt vmcnt(18) lgkmcnt(0)
s_barrier
M v[32:35], v[160:163], a[176:179], v[32:35]
s_add_u32 m0, s42, 0
s_nop 0
buffer_load_dwordx4 v6, s[48:51], s26 offen offset:0 lds
M v[32:35], v[164:167], a[180:183], v[32:35]
M v[36:39], v[172:175], a[180:183], v[36:39]
ds_read_b64_tr_b16 v[96:97], v28 offset:0
ds_read_b64_tr_b16 v[98:99], v28 offset:2048
M v[36:39], v[168:171], a[176:179], v[36:39]
M v[40:43], v[176:179], a[176:179], v[40:43]
buffer_load_dwordx4 v7, s[48:51], s26 offen offset:1024 lds
M v[40:43], v[180:183], a[180:183], v[40:43]
M v[44:47], v[188:191], a[180:183], v[44:47]
ds_read_b64_tr_b16 v[100:101], v28 offset:4096
ds_read_b64_tr_b16 v[102:103], v28 offset:6144
M v[44:47], v[184:187], a[176:179], v[44:47]
M v[48:51], v[192:195], a[176:179], v[48:51]
buffer_load_dwordx4 a[128:131], v1, s[44:47], s25 offen offset:0 sc1
M v[48:51], v[196:199], a[180:183], v[48:51]
M v[52:55], v[204:207], a[180:183], v[52:55]
ds_read_b64_tr_b16 v[104:105], v29 offset:0
ds_read_b64_tr_b16 v[106:107], v29 offset:2048
M v[52:55], v[200:203], a[176:179], v[52:55]
M v[56:59], v[208:211], a[176:179], v[56:59]
buffer_load_dwordx4 a[132:135], v1, s[44:47], s25 offen offset:1024 sc1
M v[56:59], v[212:215], a[180:183], v[56:59]
M v[60:63], v[220:223], a[180:183], v[60:63]
ds_read_b64_tr_b16 v[108:109], v29 offset:4096
ds_read_b64_tr_b16 v[110:111], v29 offset:6144
M v[60:63], v[216:219], a[176:179], v[60:63]
M v[64:67], v[160:163], a[184:187], v[64:67]
buffer_load_dwordx4 a[136:139], v1, s[44:47], s25 offen offset:2048 sc1
M v[64:67], v[164:167], a[188:191], v[64:67]
M v[68:71], v[172:175], a[188:191], v[68:71]
ds_read_b64_tr_b16 v[112:113], v30 offset:0
ds_read_b64_tr_b16 v[114:115], v30 offset:2048
M v[68:71], v[168:171], a[184:187], v[68:71]
M v[72:75], v[176:179], a[184:187], v[72:75]
buffer_load_dwordx4 a[140:143], v1, s[44:47], s25 offen offset:3072 sc1
M v[72:75], v[180:183], a[188:191], v[72:75]
M v[76:79], v[188:191], a[188:191], v[76:79]
ds_read_b64_tr_b16 v[116:117], v30 offset:4096
ds_read_b64_tr_b16 v[118:119], v30 offset:6144
M v[76:79], v[184:187], a[184:187], v[76:79]
M v[80:83], v[192:195], a[184:187], v[80:83]
s_add_u32 s25, s25, 16384
s_add_u32 s26, s26, 131072
M v[80:83], v[196:199], a[188:191], v[80:83]
M v[84:87], v[204:207], a[188:191], v[84:87]
ds_read_b64_tr_b16 v[120:121], v31 offset:0
ds_read_b64_tr_b16 v[122:123], v31 offset:2048
M v[84:87], v[200:203], a[184:187], v[84:87]
M v[88:91], v[208:211], a[184:187], v[88:91]
ds_read_b64_tr_b16 v[124:125], v31 offset:4096
ds_read_b64_tr_b16 v[126:127], v31 offset:6144
M v[88:91], v[212:215], a[188:191], v[88:91]
M v[92:95], v[220:223], a[188:191], v[92:95]
M v[92:95], v[216:219], a[184:187], v[92:95]
s_waitcnt vmcnt(18) lgkmcnt(0)
s_barrier
M a[0:3], v[96:99], a[192:195], a[0:3]
s_add_u32 m0, s42, 16384
s_nop 0
buffer_load_dwordx4 v6, s[48:51], s26 offen offset:0 lds
ds_read_b64_tr_b16 v[160:161], v28 offset:16384
ds_read_b64_tr_b16 v[162:163], v28 offset:18432
M a[0:3], v[100:103], a[196:199], a[0:3]
buffer_load_dwordx4 v7, s[48:51], s26 offen offset:1024 lds
ds_read_b64_tr_b16 v[164:165], v28 offset:20480
ds_read_b64_tr_b16 v[166:167], v28 offset:22528
M a[4:7], v[108:111], a[196:199], a[4:7]
buffer_load_dwordx4 a[144:147], v1, s[44:47], s25 offen offset:0 sc1
ds_read_b64_tr_b16 v[168:169], v29 offset:16384
ds_read_b64_tr_b16 v[170:171], v29 offset:18432
M a[4:7], v[104:107], a[192:195], a[4:7]
buffer_load_dwordx4 a[148:151], v1, s[44:47], s25 offen offset:1024 sc1
M a[8:11], v[112:115], a[192:195], a[8:11]
ds_read_b64_tr_b16 v[172:173], v29 offset:20480
ds_read_b64_tr_b16 v[174:175], v29 offset:22528
buffer_load_dwordx4 a[152:155], v1, s[44:47], s25 offen offset:2048 sc1
M a[8:11], v[116:119], a[196:199], a[8:11]
ds_read_b64_tr_b16 v[176:177], v30 offset:16384
ds_read_b64_tr_b16 v[178:179], v30 offset:18432
buffer_load_dwordx4 a[156:159], v1, s[44:47], s25 offen offset:3072 sc1
M a[12:15], v[124:127], a[196:199], a[12:15]
ds_read_b64_tr_b16 v[180:181], v30 offset:20480
ds_read_b64_tr_b16 v[182:183], v30 offset:22528
M a[12:15], v[120:123], a[192:195], a[12:15]
s_add_u32 s25, s25, 16384
s_add_u32 s26, s26, 131072
ds_read_b64_tr_b16 v[184:185], v31 offset:16384
ds_read_b64_tr_b16 v[186:187], v31 offset:18432
M a[16:19], v[96:99], a[200:203], a[16:19]
s_add_u32 s60, s56, 0
buffer_store_dwordx4 v[48:51], v1, s[52:55], s60 offen offset:0 sc1
ds_read_b64_tr_b16 v[188:189], v31 offset:20480
ds_read_b64_tr_b16 v[190:191], v31 offset:22528
M a[16:19], v[100:103], a[204:207], a[16:19]
buffer_store_dwordx4 v[52:55], v1, s[52:55], s60 offen offset:1024 sc1
buffer_store_dwordx4 v[56:59], v1, s[52:55], s60 offen offset:2048 sc1
M a[20:23], v[108:111], a[204:207], a[20:23]
buffer_store_dwordx4 v[60:63], v1, s[52:55], s60 offen offset:3072 sc1
M a[20:23], v[104:107], a[200:203], a[20:23]
s_add_u32 s60, s56, 4096
buffer_store_dwordx4 v[80:83], v1, s[52:55], s60 offen offset:0 sc1
buffer_store_dwordx4 v[84:87], v1, s[52:55], s60 offen offset:1024 sc1
M a[24:27], v[112:115], a[200:203], a[24:27]
buffer_store_dwordx4 v[88:91], v1, s[52:55], s60 offen offset:2048 sc1
buffer_store_dwordx4 v[92:95], v1, s[52:55], s60 offen offset:3072 sc1
M a[24:27], v[116:119], a[204:207], a[24:27]
v_mov_b32 v11, 0
M a[28:31], v[124:127], a[204:207], a[28:31]
M a[28:31], v[120:123], a[200:203], a[28:31]
s_waitcnt vmcnt(26) lgkmcnt(0)
s_barrier
M a[0:3], v[160:163], a[208:211], a[0:3]
s_add_u32 m0, s42, 32768
s_nop 0
buffer_load_dwordx4 v6, s[48:51], s26 offen offset:0 lds
ds_read_b64_tr_b16 v[96:97], v28 offset:32768
ds_read_b64_tr_b16 v[98:99], v28 offset:34816
M a[0:3], v[164:167], a[212:215], a[0:3]
buffer_load_dwordx4 v7, s[48:51], s26 offen offset:1024 lds
M a[4:7], v[172:175], a[212:215], a[4:7]
ds_read_b64_tr_b16 v[100:101], v28 offset:36864
ds_read_b64_tr_b16 v[102:103], v28 offset:38912
M a[4:7], v[168:171], a[208:211], a[4:7]
buffer_load_dwordx4 a[160:163], v1, s[44:47], s25 offen offset:0 sc1
M a[8:11], v[176:179], a[208:211], a[8:11]
ds_read_b64_tr_b16 v[104:105], v29 offset:32768
ds_read_b64_tr_b16 v[106:107], v29 offset:34816
M a[8:11], v[180:183], a[212:215], a[8:11]
buffer_load_dwordx4 a[164:167], v1, s[44:47], s25 offen offset:1024 sc1
M a[12:15], v[188:191], a[212:215], a[12:15]
ds_read_b64_tr_b16 v[108:109], v29 offset:36864
ds_read_b64_tr_b16 v[110:111], v29 offset:38912
M a[12:15], v[184:187], a[208:211], a[12:15]
buffer_load_dwordx4 a[168:171], v1, s[44:47], s25 offen offset:2048 sc1
M a[16:19], v[160:163], a[216:219], a[16:19]
ds_read_b64_tr_b16 v[112:113], v30 offset:32768
ds_read_b64_tr_b16 v[114:115], v30 offset:34816
M a[16:19], v[164:167], a[220:223], a[16:19]
buffer_load_dwordx4 a[172:175], v1, s[44:47], s25 offen offset:3072 sc1
M a[20:23], v[172:175], a[220:223], a[20:23]
ds_read_b64_tr_b16 v[116:117], v30 offset:36864
ds_read_b64_tr_b16 v[118:119], v30 offset:38912
M a[20:23], v[168:171], a[216:219], a[20:23]
s_add_u32 s25, s25, 16384
s_add_u32 s26, s26, 131072
M a[24:27], v[176:179], a[216:219], a[24:27]
ds_read_b64_tr_b16 v[120:121], v31 offset:32768
ds_read_b64_tr_b16 v[122:123], v31 offset:34816
M a[24:27], v[180:183], a[220:223], a[24:27]
ds_read_b64_tr_b16 v[124:125], v31 offset:36864
ds_read_b64_tr_b16 v[126:127], v31 offset:38912
M a[28:31], v[188:191], a[220:223], a[28:31]
M a[28:31], v[184:187], a[216:219], a[28:31]
s_waitcnt vmcnt(6) lgkmcnt(0)
s_barrier
s_cmp_lg_u32 s101, 0
s_cbranch_scc1 Lk3f_15
v_mov_b32 v9, 1
s_mov_b64 exec, 1
buffer_store_dword v9, v11, s[52:55], s58 offen sc1
s_mov_b64 exec, -1
Lk3f_15:
M a[0:3], v[96:99], a[224:227], a[0:3]
s_add_u32 m0, s42, 49152
s_nop 0
buffer_load_dwordx4 v6, s[48:51], s26 offen offset:0 lds
ds_read_b64_tr_b16 v[160:161], v28 offset:49152
ds_read_b64_tr_b16 v[162:163], v28 offset:51200
M a[0:3], v[100:103], a[228:231], a[0:3]
buffer_load_dwordx4 v7, s[48:51], s26 offen offset:1024 lds
M a[4:7], v[108:111], a[228:231], a[4:7]
ds_read_b64_tr_b16 v[164:165], v28 offset:53248
ds_read_b64_tr_b16 v[166:167], v28 offset:55296
M a[4:7], v[104:107], a[224:227], a[4:7]
buffer_load_dwordx4 a[176:179], v1, s[44:47], s25 offen offset:0 sc1
M a[8:11], v[112:115], a[224:227], a[8:11]
ds_read_b64_tr_b16 v[168:169], v29 offset:49152
ds_read_b64_tr_b16 v[170:171], v29 offset:51200
M a[8:11], v[116:119], a[228:231], a[8:11]
buffer_load_dwordx4 a[180:183], v1, s[44:47], s25 offen offset:1024 sc1
M a[12:15], v[124:127], a[228:231], a[12:15]
ds_read_b64_tr_b16 v[172:173], v29 offset:53248
ds_read_b64_tr_b16 v[174:175], v29 offset:55296
M a[12:15], v[120:123], a[224:227], a[12:15]
buffer_load_dwordx4 a[184:187], v1, s[44:47], s25 offen offset:2048 sc1
M a[16:19], v[96:99], a[232:235], a[16:19]
ds_read_b64_tr_b16 v[176:177], v30 offset:49152
ds_read_b64_tr_b16 v[178:179], v30 offset:51200
M a[16:19], v[100:103], a[236:239], a[16:19]
buffer_load_dwordx4 a[188:191], v1, s[44:47], s25 offen offset:3072 sc1
M a[20:23], v[108:111], a[236:239], a[20:23]
ds_read_b64_tr_b16 v[180:181], v30 offset:53248
ds_read_b64_tr_b16 v[182:183], v30 offset:55296
M a[20:23], v[104:107], a[232:235], a[20:23]
s_add_u32 s25, s25, 16384
s_add_u32 s26, s26, 131072
M a[24:27], v[112:115], a[232:235], a[24:27]
ds_read_b64_tr_b16 v[184:185], v31 offset:49152
ds_read_b64_tr_b16 v[186:187], v31 offset:51200
M a[24:27], v[116:119], a[236:239], a[24:27]
ds_read_b64_tr_b16 v[188:189], v31 offset:53248
ds_read_b64_tr_b16 v[190:191], v31 offset:55296
M a[28:31], v[124:127], a[236:239], a[28:31]
M a[28:31], v[120:123], a[232:235], a[28:31]
s_waitcnt vmcnt(26) lgkmcnt(0)
s_barrier
M a[0:3], v[160:163], a[240:243], a[0:3]
ds_read_b64_tr_b16 v[96:97], v24 offset:0
ds_read_b64_tr_b16 v[98:99], v24 offset:2048
M a[0:3], v[164:167], a[244:247], a[0:3]
ds_read_b64_tr_b16 v[100:101], v24 offset:4096
ds_read_b64_tr_b16 v[102:103], v24 offset:6144
M a[4:7], v[172:175], a[244:247], a[4:7]
M a[4:7], v[168:171], a[240:243], a[4:7]
ds_read_b64_tr_b16 v[104:105], v25 offset:0
ds_read_b64_tr_b16 v[106:107], v25 offset:2048
M a[8:11], v[176:179], a[240:243], a[8:11]
M a[8:11], v[180:183], a[244:247], a[8:11]
ds_read_b64_tr_b16 v[108:109], v25 offset:4096
ds_read_b64_tr_b16 v[110:111], v25 offset:6144
M a[12:15], v[188:191], a[244:247], a[12:15]
M a[12:15], v[184:187], a[240:243], a[12:15]
ds_read_b64_tr_b16 v[112:113], v26 offset:0
ds_read_b64_tr_b16 v[114:115], v26 offset:2048
M a[16:19], v[160:163], a[248:251], a[16:19]
ds_read_b64_tr_b16 v[116:117], v26 offset:4096
ds_read_b64_tr_b16 v[118:119], v26 offset:6144
M a[16:19], v[164:167], a[252:255], a[16:19]
M a[20:23], v[172:175], a[252:255], a[20:23]
ds_read_b64_tr_b16 v[120:121], v27 offset:0
ds_read_b64_tr_b16 v[122:123], v27 offset:2048
M a[20:23], v[168:171], a[248:251], a[20:23]
M a[24:27], v[176:179], a[248:251], a[24:27]
ds_read_b64_tr_b16 v[124:125], v27 offset:4096
ds_read_b64_tr_b16 v[126:127], v27 offset:6144
M a[24:27], v[180:183], a[252:255], a[24:27]
M a[28:31], v[188:191], a[252:255], a[28:31]
M a[28:31], v[184:187], a[248:251], a[28:31]
s_waitcnt vmcnt(20) lgkmcnt(0)
s_barrier
M a[0:3], v[96:99], a[128:131], a[0:3]
ds_read_b64_tr_b16 v[160:161], v24 offset:16384
ds_read_b64_tr_b16 v[162:163], v24 offset:18432
M a[0:3], v[100:103], a[132:135], a[0:3]
ds_read_b64_tr_b16 v[164:165], v24 offset:20480
ds_read_b64_tr_b16 v[166:167], v24 offset:22528
M a[4:7], v[108:111], a[132:135], a[4:7]
M a[4:7], v[104:107], a[128:131], a[4:7]
ds_read_b64_tr_b16 v[168:169], v25 offset:16384
ds_read_b64_tr_b16 v[170:171], v25 offset:18432
M a[8:11], v[112:115], a[128:131], a[8:11]
M a[8:11], v[116:119], a[132:135], a[8:11]
ds_read_b64_tr_b16 v[172:173], v25 offset:20480
ds_read_b64_tr_b16 v[174:175], v25 offset:22528
M a[12:15], v[124:127], a[132:135], a[12:15]
M a[12:15], v[120:123], a[128:131], a[12:15]
ds_read_b64_tr_b16 v[176:177], v26 offset:16384
ds_read_b64_tr_b16 v[178:179], v26 offset:18432
M a[16:19], v[96:99], a[136:139], a[16:19]
ds_read_b64_tr_b16 v[180:181], v26 offset:20480
ds_read_b64_tr_b16 v[182:183], v26 offset:22528
M a[16:19], v[100:103], a[140:143], a[16:19]
M a[20:23], v[108:111], a[140:143], a[20:23]
ds_read_b64_tr_b16 v[184:185], v27 offset:16384
ds_read_b64_tr_b16 v[186:187], v27 offset:18432
M a[20:23], v[104:107], a[136:139], a[20:23]
M a[24:27], v[112:115], a[136:139], a[24:27]
ds_read_b64_tr_b16 v[188:189], v27 offset:20480
ds_read_b64_tr_b16 v[190:191], v27 offset:22528
M a[24:27], v[116:119], a[140:143], a[24:27]
M a[28:31], v[124:127], a[140:143], a[28:31]
M a[28:31], v[120:123], a[136:139], a[28:31]
s_waitcnt vmcnt(6) lgkmcnt(0)
s_barrier
M a[0:3], v[160:163], a[144:147], a[0:3]
buffer_load_dword v8, v11, s[52:55], s59 offen sc1
M a[0:3], v[164:167], a[148:151], a[0:3]
ds_read_b64_tr_b16 v[96:97], v24 offset:32768
ds_read_b64_tr_b16 v[98:99], v24 offset:34816
M a[4:7], v[172:175], a[148:151], a[4:7]
M a[4:7], v[168:171], a[144:147], a[4:7]
ds_read_b64_tr_b16 v[100:101], v24 offset:36864
ds_read_b64_tr_b16 v[102:103], v24 offset:38912
M a[8:11], v[176:179], a[144:147], a[8:11]
ds_read_b64_tr_b16 v[104:105], v25 offset:32768
ds_read_b64_tr_b16 v[106:107], v25 offset:34816
M a[8:11], v[180:183], a[148:151], a[8:11]
M a[12:15], v[188:191], a[148:151], a[12:15]
ds_read_b64_tr_b16 v[108:109], v25 offset:36864
ds_read_b64_tr_b16 v[110:111], v25 offset:38912
M a[12:15], v[184:187], a[144:147], a[12:15]
ds_read_b64_tr_b16 v[112:113], v26 offset:32768
ds_read_b64_tr_b16 v[114:115], v26 offset:34816
M a[16:19], v[160:163], a[152:155], a[16:19]
M a[16:19], v[164:167], a[156:159], a[16:19]
ds_read_b64_tr_b16 v[116:117], v26 offset:36864
ds_read_b64_tr_b16 v[118:119], v26 offset:38912
M a[20:23], v[172:175], a[156:159], a[20:23]
ds_read_b64_tr_b16 v[120:121], v27 offset:32768
ds_read_b64_tr_b16 v[122:123], v27 offset:34816
M a[20:23], v[168:171], a[152:155], a[20:23]
M a[24:27], v[176:179], a[152:155], a[24:27]
ds_read_b64_tr_b16 v[124:125], v27 offset:36864
ds_read_b64_tr_b16 v[126:127], v27 offset:38912
M a[24:27], v[180:183], a[156:159], a[24:27]
M a[28:31], v[188:191], a[156:159], a[28:31]
M a[28:31], v[184:187], a[152:155], a[28:31]
s_waitcnt vmcnt(1) lgkmcnt(0)
s_barrier
s_waitcnt vmcnt(0)
v_cmp_ne_u32 vcc, 1, v8
s_nop 0
s_cbranch_vccnz Lk3_spinfl
Lk3_gotfl:
M a[0:3], v[96:99], a[160:163], a[0:3]
s_add_u32 s60, s57, 0
buffer_load_dwordx4 v[224:227], v1, s[52:55], s60 offen offset:0 sc1
ds_read_b64_tr_b16 v[160:161], v24 offset:49152
ds_read_b64_tr_b16 v[162:163], v24 offset:51200
M a[0:3], v[100:103], a[164:167], a[0:3]
buffer_load_dwordx4 v[228:231], v1, s[52:55], s60 offen offset:1024 sc1
M a[4:7], v[108:111], a[164:167], a[4:7]
ds_read_b64_tr_b16 v[164:165], v24 offset:53248
ds_read_b64_tr_b16 v[166:167], v24 offset:55296
M a[4:7], v[104:107], a[160:163], a[4:7]
buffer_load_dwordx4 v[232:235], v1, s[52:55], s60 offen offset:2048 sc1
M a[8:11], v[112:115], a[160:163], a[8:11]
ds_read_b64_tr_b16 v[168:169], v25 offset:49152
ds_read_b64_tr_b16 v[170:171], v25 offset:51200
M a[8:11], v[116:119], a[164:167], a[8:11]
buffer_load_dwordx4 v[236:239], v1, s[52:55], s60 offen offset:3072 sc1
M a[12:15], v[124:127], a[164:167], a[12:15]
ds_read_b64_tr_b16 v[172:173], v25 offset:53248
ds_read_b64_tr_b16 v[174:175], v25 offset:55296
M a[12:15], v[120:123], a[160:163], a[12:15]
s_add_u32 s60, s57, 4096
buffer_load_dwordx4 v[240:243], v1, s[52:55], s60 offen offset:0 sc1
ds_read_b64_tr_b16 v[176:177], v26 offset:49152
ds_read_b64_tr_b16 v[178:179], v26 offset:51200
M a[16:19], v[96:99], a[168:171], a[16:19]
buffer_load_dwordx4 v[244:247], v1, s[52:55], s60 offen offset:1024 sc1
M a[16:19], v[100:103], a[172:175], a[16:19]
ds_read_b64_tr_b16 v[180:181], v26 offset:53248
ds_read_b64_tr_b16 v[182:183], v26 offset:55296
M a[20:23], v[108:111], a[172:175], a[20:23]
buffer_load_dwordx4 v[248:251], v1, s[52:55], s60 offen offset:2048 sc1
M a[20:23], v[104:107], a[168:171], a[20:23]
ds_read_b64_tr_b16 v[184:185], v27 offset:49152
ds_read_b64_tr_b16 v[186:187], v27 offset:51200
M a[24:27], v[112:115], a[168:171], a[24:27]
buffer_load_dwordx4 v[252:255], v1, s[52:55], s60 offen offset:3072 sc1
M a[24:27], v[116:119], a[172:175], a[24:27]
ds_read_b64_tr_b16 v[188:189], v27 offset:53248
ds_read_b64_tr_b16 v[190:191], v27 offset:55296
M a[28:31], v[124:127], a[172:175], a[28:31]
M a[28:31], v[120:123], a[168:171], a[28:31]
s_waitcnt lgkmcnt(0)
M a[0:3], v[160:163], a[176:179], a[0:3]
M a[0:3], v[164:167], a[180:183], a[0:3]
M a[4:7], v[172:175], a[180:183], a[4:7]
M a[4:7], v[168:171], a[176:179], a[4:7]
M a[8:11], v[176:179], a[176:179], a[8:11]
M a[8:11], v[180:183], a[180:183], a[8:11]
M a[12:15], v[188:191], a[180:183], a[12:15]
M a[12:15], v[184:187], a[176:179], a[12:15]
M a[16:19], v[160:163], a[184:187], a[16:19]
M a[16:19], v[164:167], a[188:191], a[16:19]
M a[20:23], v[172:175], a[188:191], a[20:23]
M a[20:23], v[168:171], a[184:187], a[20:23]
M a[24:27], v[176:179], a[184:187], a[24:27]
M a[24:27], v[180:183], a[188:191], a[24:27]
M a[28:31], v[188:191], a[188:191], a[28:31]
M a[28:31], v[184:187], a[184:187], a[28:31]
v_bfe_u32 v96, v0, 4, 1
v_lshrrev_b32 v97, 5, v0
v_lshl_or_b32 v96, v96, 1, v97
v_and_b32 v97, 15, v0
v_lshlrev_b32 v97, 13, v97
v_lshl_add_u32 v96, v96, 4, v97
s_and_b32 s3, s101, 1
s_lshl_b32 s3, s3, 6
s_lshr_b32 s6, s101, 1
s_add_u32 s3, s3, s6
s_add_u32 s3, s3, s21
s_lshl_b32 s3, s3, 12
s_lshl_b32 s6, s22, 1
s_add_u32 s3, s3, s6
s_add_u32 s3, s3, 2048
v_accvgpr_read_b32 v108, a0
v_accvgpr_read_b32 v109, a1
v_accvgpr_read_b32 v110, a2
v_accvgpr_read_b32 v111, a3
v_accvgpr_read_b32 v112, a4
v_accvgpr_read_b32 v113, a5
v_accvgpr_read_b32 v114, a6
v_accvgpr_read_b32 v115, a7
v_cvt_pk_bf16_f32 v100, v108, v109
v_cvt_pk_bf16_f32 v101, v110, v111
v_cvt_pk_bf16_f32 v102, v112, v113
v_cvt_pk_bf16_f32 v103, v114, v115
s_nop 0
v_permlane16_swap_b32 v100, v102
v_permlane16_swap_b32 v101, v103
buffer_store_dwordx4 v[100:103], v96, s[16:19], s3 offen offset:0
v_accvgpr_read_b32 v108, a8
v_accvgpr_read_b32 v109, a9
v_accvgpr_read_b32 v110, a10
v_accvgpr_read_b32 v111, a11
v_accvgpr_read_b32 v112, a12
v_accvgpr_read_b32 v113, a13
v_accvgpr_read_b32 v114, a14
v_accvgpr_read_b32 v115, a15
v_cvt_pk_bf16_f32 v104, v108, v109
v_cvt_pk_bf16_f32 v105, v110, v111
v_cvt_pk_bf16_f32 v106, v112, v113
v_cvt_pk_bf16_f32 v107, v114, v115
s_nop 0
v_permlane16_swap_b32 v104, v106
v_permlane16_swap_b32 v105, v107
buffer_store_dwordx4 v[104:107], v96, s[16:19], s3 offen offset:64
s_add_u32 s3, s3, 131072
v_accvgpr_read_b32 v108, a16
v_accvgpr_read_b32 v109, a17
v_accvgpr_read_b32 v110, a18
v_accvgpr_read_b32 v111, a19
v_accvgpr_read_b32 v112, a20
v_accvgpr_read_b32 v113, a21
v_accvgpr_read_b32 v114, a22
v_accvgpr_read_b32 v115, a23
v_cvt_pk_bf16_f32 v100, v108, v109
v_cvt_pk_bf16_f32 v101, v110, v111
v_cvt_pk_bf16_f32 v102, v112, v113
v_cvt_pk_bf16_f32 v103, v114, v115
s_nop 0
v_permlane16_swap_b32 v100, v102
v_permlane16_swap_b32 v101, v103
buffer_store_dwordx4 v[100:103], v96, s[16:19], s3 offen offset:0
v_accvgpr_read_b32 v108, a24
v_accvgpr_read_b32 v109, a25
v_accvgpr_read_b32 v110, a26
v_accvgpr_read_b32 v111, a27
v_accvgpr_read_b32 v112, a28
v_accvgpr_read_b32 v113, a29
v_accvgpr_read_b32 v114, a30
v_accvgpr_read_b32 v115, a31
v_cvt_pk_bf16_f32 v104, v108, v109
v_cvt_pk_bf16_f32 v105, v110, v111
v_cvt_pk_bf16_f32 v106, v112, v113
v_cvt_pk_bf16_f32 v107, v114, v115
s_nop 0
v_permlane16_swap_b32 v104, v106
v_permlane16_swap_b32 v105, v107
buffer_store_dwordx4 v[104:107], v96, s[16:19], s3 offen offset:64
v_bfe_u32 v128, v0, 4, 1
v_lshrrev_b32 v129, 5, v0
v_lshl_or_b32 v128, v128, 1, v129
v_and_b32 v129, 15, v0
v_lshlrev_b32 v129, 12, v129
v_lshl_add_u32 v128, v128, 4, v129
s_lshl_b32 s3, s101, 5
s_add_u32 s3, s3, s29
s_lshl_b32 s3, s3, 12
s_lshl_b32 s6, s30, 1
s_add_u32 s3, s3, s6
s_waitcnt vmcnt(4)
v_pk_add_f32 v[32:33], v[32:33], v[224:225]
v_pk_add_f32 v[34:35], v[34:35], v[226:227]
v_pk_add_f32 v[36:37], v[36:37], v[228:229]
v_pk_add_f32 v[38:39], v[38:39], v[230:231]
v_cvt_pk_bf16_f32 v132, v32, v33
v_cvt_pk_bf16_f32 v133, v34, v35
v_cvt_pk_bf16_f32 v134, v36, v37
v_cvt_pk_bf16_f32 v135, v38, v39
s_nop 0
v_permlane16_swap_b32 v132, v134
v_permlane16_swap_b32 v133, v135
buffer_store_dwordx4 v[132:135], v128, s[16:19], s3 offen offset:0
v_pk_add_f32 v[40:41], v[40:41], v[232:233]
v_pk_add_f32 v[42:43], v[42:43], v[234:235]
v_pk_add_f32 v[44:45], v[44:45], v[236:237]
v_pk_add_f32 v[46:47], v[46:47], v[238:239]
v_cvt_pk_bf16_f32 v136, v40, v41
v_cvt_pk_bf16_f32 v137, v42, v43
v_cvt_pk_bf16_f32 v138, v44, v45
v_cvt_pk_bf16_f32 v139, v46, v47
s_nop 0
v_permlane16_swap_b32 v136, v138
v_permlane16_swap_b32 v137, v139
buffer_store_dwordx4 v[136:139], v128, s[16:19], s3 offen offset:64
s_add_u32 s3, s3, 65536
v_pk_add_f32 v[64:65], v[64:65], v[240:241]
v_pk_add_f32 v[66:67], v[66:67], v[242:243]
v_pk_add_f32 v[68:69], v[68:69], v[244:245]
v_pk_add_f32 v[70:71], v[70:71], v[246:247]
v_cvt_pk_bf16_f32 v132, v64, v65
v_cvt_pk_bf16_f32 v133, v66, v67
v_cvt_pk_bf16_f32 v134, v68, v69
v_cvt_pk_bf16_f32 v135, v70, v71
s_nop 0
v_permlane16_swap_b32 v132, v134
v_permlane16_swap_b32 v133, v135
buffer_store_dwordx4 v[132:135], v128, s[16:19], s3 offen offset:0
v_pk_add_f32 v[72:73], v[72:73], v[248:249]
v_pk_add_f32 v[74:75], v[74:75], v[250:251]
v_pk_add_f32 v[76:77], v[76:77], v[252:253]
v_pk_add_f32 v[78:79], v[78:79], v[254:255]
v_cvt_pk_bf16_f32 v136, v72, v73
v_cvt_pk_bf16_f32 v137, v74, v75
v_cvt_pk_bf16_f32 v138, v76, v77
v_cvt_pk_bf16_f32 v139, v78, v79
s_nop 0
v_permlane16_swap_b32 v136, v138
v_permlane16_swap_b32 v137, v139
buffer_store_dwordx4 v[136:139], v128, s[16:19], s3 offen offset:64
s_endpgm
Lk3_spinb0:
Lk3_spinb0_:
s_add_u32 s61, s61, 1
s_cmp_gt_u32 s61, 1048576
s_cbranch_scc1 Lk3_gotb0
s_sleep 2
buffer_load_dword v7, v15, s[52:55], s43 offen sc1
s_waitcnt vmcnt(0)
v_cmp_ne_u32 vcc, 1, v7
s_nop 0
s_cbranch_vccnz Lk3_spinb0_
s_branch Lk3_gotb0
Lk3_spinb1:
Lk3_spinb1_:
s_add_u32 s61, s61, 1
s_cmp_gt_u32 s61, 1048576
s_cbranch_scc1 Lk3_gotb1
s_sleep 2
buffer_load_dword v7, v15, s[52:55], s43 offen sc1
s_waitcnt vmcnt(0)
v_cmp_ne_u32 vcc, 1, v7
s_nop 0
s_cbranch_vccnz Lk3_spinb1_
s_branch Lk3_gotb1
Lk3_spinft:
s_add_u32 s61, s61, 1
s_cmp_gt_u32 s61, 1048576
s_cbranch_scc1 Lk3_gotft
s_sleep 2
buffer_load_dword v252, v255, s[52:55], s62 offen sc1
s_waitcnt vmcnt(0)
v_cmp_ne_u32 vcc, 1, v252
s_nop 0
s_cbranch_vccnz Lk3_spinft
s_branch Lk3_gotft
Lk3_spinfl:
s_add_u32 s61, s61, 1
s_cmp_gt_u32 s61, 1048576
s_cbranch_scc1 Lk3_gotfl
s_sleep 2
buffer_load_dword v8, v11, s[52:55], s59 offen sc1
s_waitcnt vmcnt(0)
v_cmp_ne_u32 vcc, 1, v8
s_nop 0
s_cbranch_vccnz Lk3_spinfl
s_branch Lk3_gotfl
Lc3:
.section .rodata,"a"
.p2align 6
.amdhsa_kernel concat_heads__compressed_kv_cla__sliding_local_dilated__prompt_kernel
  .amdhsa_next_free_vgpr 512
  .amdhsa_next_free_sgpr 102
  .amdhsa_accum_offset 256
  .amdhsa_group_segment_fixed_size 0
  .amdhsa_kernarg_size 96
  .amdhsa_user_sgpr_count 2
  .amdhsa_user_sgpr_kernarg_segment_ptr 1
  .amdhsa_system_sgpr_workgroup_id_x 1
.end_amdhsa_kernel
```

```asm
; @launch grid=(256,1,1) block=(256,1,1) lds=163840
.amdgcn_target "amdgcn-amd-amdhsa--gfx950"
.text
.macro M d, a, b, c
v_mfma_f32_16x16x32_bf16 \d, \a, \b, \c
.endm
.globl concat_heads__compressed_kv_cla__sliding_local_dilated__prompt_kernel
.p2align 8
.type concat_heads__compressed_kv_cla__sliding_local_dilated__prompt_kernel,@function
concat_heads__compressed_kv_cla__sliding_local_dilated__prompt_kernel:
s_cmp_lt_u32 s2, 256
s_cbranch_scc1 Lk1_go
s_endpgm
Lk1_go:
s_load_dwordx16 s[32:47], s[0:1], 0
s_load_dwordx2 s[48:49], s[0:1], 64
s_load_dwordx2 s[50:51], s[0:1], 88
s_load_dwordx2 s[90:91], s[0:1], 80
v_lshrrev_b32 v24, 6, v0
s_nop 0
v_readfirstlane_b32 s20, v24
v_and_b32 v0, 63, v0
v_lshlrev_b32 v1, 4, v0
s_mov_b32 s101, s20
s_lshr_b32 s21, s20, 1
s_and_b32 s22, s20, 1
s_lshl_b32 s29, s20, 12
s_and_b32 s3, s2, 1
s_lshl_b32 s3, s3, 2
s_bfe_u32 s6, s2, 0x20003
s_add_u32 s3, s3, s6
s_lshl_b32 s52, s3, 8
s_bfe_u32 s3, s2, 0x20001
s_lshl_b32 s3, s3, 2
s_bfe_u32 s7, s2, 0x20005
s_add_u32 s3, s3, s7
s_lshl_b32 s53, s3, 8
s_cmp_lt_u32 s2, 128
s_cselect_b32 s5, 11, 10
s_lshl_b32 s3, s21, 7
s_lshl_b32 s4, s22, 5
s_add_u32 s3, s3, s4
v_lshrrev_b32 v24, 3, v0
v_add_u32 v24, s3, v24
v_and_b32 v25, 7, v0
v_add_u32 v26, 0, v24
v_bfe_u32 v27, v26, 1, 3
v_xor_b32 v27, v27, v25
v_lshlrev_b32 v26, s5, v26
v_lshl_add_u32 v26, v27, 4, v26
v_subrev_u32 v2, 0, v26
v_add_u32 v26, 8, v24
v_bfe_u32 v27, v26, 1, 3
v_xor_b32 v27, v27, v25
v_lshlrev_b32 v26, s5, v26
v_lshl_add_u32 v26, v27, 4, v26
v_subrev_u32 v3, 1024, v26
v_add_u32 v26, 16, v24
v_bfe_u32 v27, v26, 1, 3
v_xor_b32 v27, v27, v25
v_lshlrev_b32 v26, s5, v26
v_lshl_add_u32 v26, v27, 4, v26
v_subrev_u32 v4, 2048, v26
v_add_u32 v26, 24, v24
v_bfe_u32 v27, v26, 1, 3
v_xor_b32 v27, v27, v25
v_lshlrev_b32 v26, s5, v26
v_lshl_add_u32 v26, v27, 4, v26
v_subrev_u32 v5, 3072, v26
s_lshl_b32 s3, s20, 3
v_lshrrev_b32 v24, 5, v0
v_add_u32 v24, s3, v24
v_and_b32 v25, 31, v0
v_add_u32 v26, 0, v24
v_and_b32 v27, 3, v26
v_lshlrev_b32 v27, 1, v27
v_and_or_b32 v27, v26, 8, v27
v_xor_b32 v27, v27, v25
v_lshlrev_b32 v26, 13, v26
v_lshl_add_u32 v26, v27, 4, v26
v_subrev_u32 v6, 0, v26
v_add_u32 v26, 2, v24
v_and_b32 v27, 3, v26
v_lshlrev_b32 v27, 1, v27
v_and_or_b32 v27, v26, 8, v27
v_xor_b32 v27, v27, v25
v_lshlrev_b32 v26, 13, v26
v_lshl_add_u32 v26, v27, 4, v26
v_subrev_u32 v7, 1024, v26
v_add_u32 v26, 4, v24
v_and_b32 v27, 3, v26
v_lshlrev_b32 v27, 1, v27
v_and_or_b32 v27, v26, 8, v27
v_xor_b32 v27, v27, v25
v_lshlrev_b32 v26, 13, v26
v_lshl_add_u32 v26, v27, 4, v26
v_subrev_u32 v8, 2048, v26
v_add_u32 v26, 6, v24
v_and_b32 v27, 3, v26
v_lshlrev_b32 v27, 1, v27
v_and_or_b32 v27, v26, 8, v27
v_xor_b32 v27, v27, v25
v_lshlrev_b32 v26, 13, v26
v_lshl_add_u32 v26, v27, 4, v26
v_subrev_u32 v9, 3072, v26
s_lshl_b32 s23, s52, s5
s_lshl_b32 s31, 64, s5
s_mov_b32 s26, s23
s_lshl_b32 s24, s53, 1
s_mov_b32 s28, s24
s_lshl_b32 s3, 1, s5
s_add_u32 s25, s23, s3
s_lshl_b32 s3, s3, 12
s_add_u32 s27, s24, s3
s_bfe_u32 s3, s2, 0x20001
s_and_b32 s4, s2, 1
s_lshl_b32 s4, s4, 1
s_add_u32 s3, s3, s4
s_and_b32 s3, s3, 3
s_sub_u32 s4, s5, 2
s_lshl_b32 s3, s3, s4
s_add_u32 s23, s23, s3
s_lshl_b32 s3, s3, 12
s_add_u32 s24, s24, s3
s_mov_b32 s95, s6
s_cmp_lt_u32 s2, 128
s_cselect_b32 s6, -1, 8
s_waitcnt lgkmcnt(0)
s_cmp_lt_u32 s2, 128
s_cselect_b64 s[8:9], s[32:33], s[34:35]
s_mov_b32 s10, 2097152
s_cselect_b32 s10, 4194304, s10
s_mov_b32 s11, 0x00020000
s_cselect_b64 s[12:13], s[36:37], s[38:39]
s_mov_b32 s14, 4194304
s_cselect_b32 s14, 8388608, s14
s_mov_b32 s15, 0x00020000
s_mov_b64 s[64:65], s[40:41]
s_add_u32 m0, s29, 65536
s_nop 0
buffer_load_dwordx4 v6, s[12:15], s24 offen offset:0 lds
buffer_load_dwordx4 v7, s[12:15], s24 offen offset:1024 lds
buffer_load_dwordx4 v8, s[12:15], s24 offen offset:2048 lds
buffer_load_dwordx4 v9, s[12:15], s24 offen offset:3072 lds
s_add_u32 s24, s24, 262144
s_add_u32 m0, s29, 0
s_nop 0
buffer_load_dwordx4 v2, s[8:11], s23 offen offset:0 lds
buffer_load_dwordx4 v3, s[8:11], s23 offen offset:1024 lds
buffer_load_dwordx4 v4, s[8:11], s23 offen offset:2048 lds
buffer_load_dwordx4 v5, s[8:11], s23 offen offset:3072 lds
s_add_u32 m0, s29, 81920
s_nop 0
buffer_load_dwordx4 v6, s[12:15], s24 offen offset:0 lds
buffer_load_dwordx4 v7, s[12:15], s24 offen offset:1024 lds
buffer_load_dwordx4 v8, s[12:15], s24 offen offset:2048 lds
buffer_load_dwordx4 v9, s[12:15], s24 offen offset:3072 lds
s_add_u32 s24, s24, 262144
s_cmp_eq_u32 s24, s27
s_cselect_b32 s24, s28, s24
s_sub_u32 s6, s6, 1
s_cmp_eq_u32 s6, 0
s_cselect_b64 s[12:13], s[64:65], s[12:13]
s_add_u32 s16, s50, 109051904
s_addc_u32 s17, s51, 0
s_mov_b32 s18, 16384
s_mov_b32 s19, 0x00020000
v_mov_b32 v24, 0
v_mov_b32 v25, 0
v_mov_b32 v26, 0
v_mov_b32 v27, 0
s_lshl_b32 s3, s2, 2
buffer_store_dword v24, v24, s[16:19], s3 offen sc1
s_and_b32 s3, s2, 7
s_lshr_b32 s4, s2, 6
s_lshl_b32 s4, s4, 3
s_add_u32 s3, s3, s4
s_lshl_b32 s3, s3, 4
s_add_u32 s3, s3, 4096
s_bfe_u32 s4, s2, 0x30003
s_lshl_b32 s4, s4, 9
s_add_u32 s92, s3, s4
s_sub_u32 s4, 7680, s4
s_add_u32 s93, s3, s4
buffer_store_dwordx4 v[24:27], v24, s[16:19], s92 offen sc1
buffer_store_dwordx4 v[24:27], v24, s[16:19], s93 offen sc1
s_and_b32 s3, s2, 1
s_lshl_b32 s3, s3, 3
s_bfe_u32 s4, s2, 0x30003
s_add_u32 s92, s3, s4
s_bfe_u32 s3, s2, 0x20001
s_lshl_b32 s3, s3, 2
s_lshr_b32 s4, s2, 6
s_xor_b32 s4, s4, 2
s_add_u32 s93, s3, s4
s_lshl_b32 s92, s92, 8
s_lshl_b32 s93, s93, 4
s_add_u32 s92, s92, s93
s_add_u32 s92, s92, 12288
buffer_store_dwordx4 v[24:27], v24, s[16:19], s92 offen sc1
v_lshlrev_b32 v20, 7, v0
s_lshl_b32 s54, s2, 13
s_mov_b64 s[60:61], s[40:41]
s_mov_b32 s62, 0
s_cmp_eq_u32 s20, 1
s_cselect_b64 s[60:61], s[46:47], s[60:61]
s_cselect_b32 s62, 6291456, s62
s_cmp_eq_u32 s20, 2
s_cselect_b64 s[60:61], s[44:45], s[60:61]
s_cselect_b32 s62, 4194304, s62
s_cmp_eq_u32 s20, 3
s_cselect_b32 s62, 0, s62
s_mov_b32 s63, 0x00020000
s_mov_b32 s3, 0
s_cmp_eq_u32 s20, 1
s_cselect_b32 s3, 6291456, s3
s_cmp_eq_u32 s20, 2
s_cselect_b32 s3, 6291456, s3
s_sub_u32 s54, s54, s3
Lc0:
s_add_u32 m0, s29, 98304
s_nop 0
buffer_load_dwordx4 v6, s[12:15], s24 offen offset:0 lds
buffer_load_dwordx4 v7, s[12:15], s24 offen offset:1024 lds
buffer_load_dwordx4 v8, s[12:15], s24 offen offset:2048 lds
buffer_load_dwordx4 v9, s[12:15], s24 offen offset:3072 lds
s_add_u32 s24, s24, 262144
s_lshl_b32 s4, s21, 13
v_and_b32 v24, 15, v0
v_lshlrev_b32 v24, 7, v24
v_add_u32 v24, s4, v24
v_bfe_u32 v25, v0, 1, 3
v_lshrrev_b32 v26, 4, v0
v_xor_b32 v25, v25, v26
v_lshl_add_u32 v10, v25, 4, v24
v_xor_b32 v11, 64, v10
v_bfe_u32 v24, v0, 2, 2
v_lshl_add_u32 v29, v26, 3, v24
v_lshlrev_b32 v25, 9, v29
v_and_b32 v27, 1, v0
v_lshl_add_u32 v25, v27, 3, v25
v_add_u32 v25, 65536, v25
v_lshlrev_b32 v24, 1, v24
v_and_or_b32 v24, v29, 8, v24
v_bfe_u32 v26, v0, 1, 1
s_lshl_b32 s4, s22, 4
s_add_u32 s3, s4, 0
v_add_u32 v27, s3, v26
v_xor_b32 v27, v27, v24
v_lshl_add_u32 v12, v27, 4, v25
s_add_u32 s3, s4, 2
v_add_u32 v27, s3, v26
v_xor_b32 v27, v27, v24
v_lshl_add_u32 v13, v27, 4, v25
s_add_u32 s3, s4, 4
v_add_u32 v27, s3, v26
v_xor_b32 v27, v27, v24
v_lshl_add_u32 v14, v27, 4, v25
s_add_u32 s3, s4, 6
v_add_u32 v27, s3, v26
v_xor_b32 v27, v27, v24
v_lshl_add_u32 v15, v27, 4, v25
s_add_u32 s3, s4, 8
v_add_u32 v27, s3, v26
v_xor_b32 v27, v27, v24
v_lshl_add_u32 v16, v27, 4, v25
s_add_u32 s3, s4, 10
v_add_u32 v27, s3, v26
v_xor_b32 v27, v27, v24
v_lshl_add_u32 v17, v27, 4, v25
s_add_u32 s3, s4, 12
v_add_u32 v27, s3, v26
v_xor_b32 v27, v27, v24
v_lshl_add_u32 v18, v27, 4, v25
s_add_u32 s3, s4, 14
v_add_u32 v27, s3, v26
v_xor_b32 v27, v27, v24
v_lshl_add_u32 v19, v27, 4, v25
s_waitcnt vmcnt(8)
s_barrier
ds_read_b64_tr_b16 a[32:33], v12 offset:0
ds_read_b64_tr_b16 a[34:35], v12 offset:2048
ds_read_b64_tr_b16 a[40:41], v13 offset:0
ds_read_b64_tr_b16 a[42:43], v13 offset:2048
ds_read_b64_tr_b16 a[48:49], v14 offset:0
ds_read_b64_tr_b16 a[50:51], v14 offset:2048
ds_read_b64_tr_b16 a[56:57], v15 offset:0
ds_read_b64_tr_b16 a[58:59], v15 offset:2048
ds_read_b64_tr_b16 a[64:65], v16 offset:0
ds_read_b64_tr_b16 a[66:67], v16 offset:2048
ds_read_b64_tr_b16 a[72:73], v17 offset:0
ds_read_b64_tr_b16 a[74:75], v17 offset:2048
ds_read_b64_tr_b16 a[80:81], v18 offset:0
ds_read_b64_tr_b16 a[82:83], v18 offset:2048
ds_read_b64_tr_b16 a[88:89], v19 offset:0
ds_read_b64_tr_b16 a[90:91], v19 offset:2048
ds_read_b64_tr_b16 a[36:37], v12 offset:16384
ds_read_b64_tr_b16 a[38:39], v12 offset:18432
ds_read_b64_tr_b16 a[44:45], v13 offset:16384
ds_read_b64_tr_b16 a[46:47], v13 offset:18432
ds_read_b64_tr_b16 a[52:53], v14 offset:16384
ds_read_b64_tr_b16 a[54:55], v14 offset:18432
ds_read_b64_tr_b16 a[60:61], v15 offset:16384
ds_read_b64_tr_b16 a[62:63], v15 offset:18432
ds_read_b64_tr_b16 a[68:69], v16 offset:16384
ds_read_b64_tr_b16 a[70:71], v16 offset:18432
ds_read_b64_tr_b16 a[76:77], v17 offset:16384
ds_read_b64_tr_b16 a[78:79], v17 offset:18432
ds_read_b64_tr_b16 a[84:85], v18 offset:16384
ds_read_b64_tr_b16 a[86:87], v18 offset:18432
ds_read_b64_tr_b16 a[92:93], v19 offset:16384
ds_read_b64_tr_b16 a[94:95], v19 offset:18432
ds_read_b128 a[160:163], v10 offset:0
ds_read_b128 a[164:167], v11 offset:0
ds_read_b128 a[168:171], v10 offset:2048
ds_read_b128 a[172:175], v11 offset:2048
s_add_u32 m0, s29, 16384
s_add_u32 s3, s23, s31
s_nop 0
buffer_load_dwordx4 v2, s[8:11], s3 offen offset:0 lds
buffer_load_dwordx4 v3, s[8:11], s3 offen offset:1024 lds
buffer_load_dwordx4 v4, s[8:11], s3 offen offset:2048 lds
buffer_load_dwordx4 v5, s[8:11], s3 offen offset:3072 lds
s_add_u32 s23, s23, 128
s_cmp_eq_u32 s23, s25
s_cselect_b32 s23, s26, s23
s_add_u32 m0, s29, 114688
s_nop 0
buffer_load_dwordx4 v6, s[12:15], s24 offen offset:0 lds
buffer_load_dwordx4 v7, s[12:15], s24 offen offset:1024 lds
buffer_load_dwordx4 v8, s[12:15], s24 offen offset:2048 lds
buffer_load_dwordx4 v9, s[12:15], s24 offen offset:3072 lds
s_add_u32 s24, s24, 262144
s_cmp_eq_u32 s24, s27
s_cselect_b32 s24, s28, s24
s_sub_u32 s6, s6, 1
s_cmp_eq_u32 s6, 0
s_cselect_b64 s[12:13], s[64:65], s[12:13]
s_waitcnt vmcnt(8) lgkmcnt(0)
s_barrier
s_getpc_b64 s[92:93]
Lpc_1:
s_add_u32 s92, s92, Lc1-Lpc_1
s_addc_u32 s93, s93, 0
s_lshr_b32 s94, s2, 3
s_mul_i32 s94, s94, ((Lc3-Lc1)/32+127)&~127
v_lshlrev_b32 v24, 7, v0
v_add_u32 v24, s94, v24
v_min_u32 v24, Lc3-Lc1-4, v24
global_load_dword v21, v24, s[92:93]
Lc1:
s_cmp_lt_u32 s2, 128
s_cbranch_scc0 Lk1_kv
M v[32:35], a[32:35], a[160:163], 0
s_add_u32 m0, s29, 32768
s_nop 0
buffer_load_dwordx4 v2, s[8:11], s23 offen offset:0 lds
M v[32:35], a[36:39], a[164:167], v[32:35]
ds_read_b128 a[176:179], v10 offset:4096
ds_read_b128 a[180:183], v11 offset:4096
M v[36:39], a[44:47], a[164:167], 0
buffer_load_dwordx4 v3, s[8:11], s23 offen offset:1024 lds
M v[36:39], a[40:43], a[160:163], v[36:39]
ds_read_b64_tr_b16 a[96:97], v12 offset:32768
ds_read_b64_tr_b16 a[98:99], v12 offset:34816
M v[40:43], a[48:51], a[160:163], 0
buffer_load_dwordx4 v4, s[8:11], s23 offen offset:2048 lds
M v[40:43], a[52:55], a[164:167], v[40:43]
M v[44:47], a[60:63], a[164:167], 0
buffer_load_dwordx4 v5, s[8:11], s23 offen offset:3072 lds
M v[44:47], a[56:59], a[160:163], v[44:47]
ds_read_b64_tr_b16 a[104:105], v13 offset:32768
ds_read_b64_tr_b16 a[106:107], v13 offset:34816
M v[48:51], a[64:67], a[160:163], 0
s_add_u32 m0, s29, 65536
s_nop 0
buffer_load_dwordx4 v6, s[12:15], s24 offen offset:0 lds
M v[48:51], a[68:71], a[164:167], v[48:51]
M v[52:55], a[76:79], a[164:167], 0
buffer_load_dwordx4 v7, s[12:15], s24 offen offset:1024 lds
M v[52:55], a[72:75], a[160:163], v[52:55]
ds_read_b64_tr_b16 a[112:113], v14 offset:32768
ds_read_b64_tr_b16 a[114:115], v14 offset:34816
M v[56:59], a[80:83], a[160:163], 0
buffer_load_dwordx4 v8, s[12:15], s24 offen offset:2048 lds
M v[56:59], a[84:87], a[164:167], v[56:59]
buffer_load_dwordx4 v9, s[12:15], s24 offen offset:3072 lds
M v[60:63], a[92:95], a[164:167], 0
M v[60:63], a[88:91], a[160:163], v[60:63]
ds_read_b64_tr_b16 a[120:121], v15 offset:32768
ds_read_b64_tr_b16 a[122:123], v15 offset:34816
M v[64:67], a[32:35], a[168:171], 0
s_add_u32 s24, s24, 262144
M v[64:67], a[36:39], a[172:175], v[64:67]
ds_read_b128 a[184:187], v10 offset:6144
ds_read_b128 a[188:191], v11 offset:6144
M v[68:71], a[44:47], a[172:175], 0
s_add_u32 m0, s29, 49152
s_add_u32 s3, s23, s31
buffer_load_dwordx4 v2, s[8:11], s3 offen offset:0 lds
M v[68:71], a[40:43], a[168:171], v[68:71]
ds_read_b64_tr_b16 a[128:129], v16 offset:32768
ds_read_b64_tr_b16 a[130:131], v16 offset:34816
M v[72:75], a[48:51], a[168:171], 0
M v[72:75], a[52:55], a[172:175], v[72:75]
buffer_load_dwordx4 v3, s[8:11], s3 offen offset:1024 lds
M v[76:79], a[60:63], a[172:175], 0
buffer_load_dwordx4 v4, s[8:11], s3 offen offset:2048 lds
M v[76:79], a[56:59], a[168:171], v[76:79]
ds_read_b64_tr_b16 a[136:137], v17 offset:32768
ds_read_b64_tr_b16 a[138:139], v17 offset:34816
M v[80:83], a[64:67], a[168:171], 0
M v[80:83], a[68:71], a[172:175], v[80:83]
buffer_load_dwordx4 v5, s[8:11], s3 offen offset:3072 lds
M v[84:87], a[76:79], a[172:175], 0
s_add_u32 s23, s23, 128
s_cmp_eq_u32 s23, s25
s_cselect_b32 s23, s26, s23
M v[84:87], a[72:75], a[168:171], v[84:87]
ds_read_b64_tr_b16 a[144:145], v18 offset:32768
ds_read_b64_tr_b16 a[146:147], v18 offset:34816
M v[88:91], a[80:83], a[168:171], 0
s_add_u32 m0, s29, 81920
s_nop 0
buffer_load_dwordx4 v6, s[12:15], s24 offen offset:0 lds
M v[88:91], a[84:87], a[172:175], v[88:91]
M v[92:95], a[92:95], a[172:175], 0
buffer_load_dwordx4 v7, s[12:15], s24 offen offset:1024 lds
M v[92:95], a[88:91], a[168:171], v[92:95]
s_waitcnt lgkmcnt(15)
ds_read_b64_tr_b16 a[152:153], v19 offset:32768
ds_read_b64_tr_b16 a[154:155], v19 offset:34816
M v[96:99], a[32:35], a[176:179], 0
buffer_load_dwordx4 v8, s[12:15], s24 offen offset:2048 lds
M v[96:99], a[36:39], a[180:183], v[96:99]
M v[100:103], a[44:47], a[180:183], 0
buffer_load_dwordx4 v9, s[12:15], s24 offen offset:3072 lds
M v[100:103], a[40:43], a[176:179], v[100:103]
s_add_u32 s24, s24, 262144
s_cmp_eq_u32 s24, s27
s_cselect_b32 s24, s28, s24
s_sub_u32 s6, s6, 1
s_cmp_eq_u32 s6, 0
s_cselect_b64 s[12:13], s[64:65], s[12:13]
M v[104:107], a[48:51], a[176:179], 0
M v[104:107], a[52:55], a[180:183], v[104:107]
M v[108:111], a[60:63], a[180:183], 0
M v[108:111], a[56:59], a[176:179], v[108:111]
s_waitcnt vmcnt(17) lgkmcnt(0)
s_barrier
ds_read_b128 a[160:163], v10 offset:16384
ds_read_b128 a[164:167], v11 offset:16384
M v[112:115], a[64:67], a[176:179], 0
s_add_u32 m0, s29, 0
s_nop 0
buffer_load_dwordx4 v2, s[8:11], s23 offen offset:0 lds
M v[112:115], a[68:71], a[180:183], v[112:115]
M v[116:119], a[76:79], a[180:183], 0
M v[116:119], a[72:75], a[176:179], v[116:119]
ds_read_b64_tr_b16 a[100:101], v12 offset:49152
ds_read_b64_tr_b16 a[102:103], v12 offset:51200
M v[120:123], a[80:83], a[176:179], 0
M v[120:123], a[84:87], a[180:183], v[120:123]
buffer_load_dwordx4 v3, s[8:11], s23 offen offset:1024 lds
M v[124:127], a[92:95], a[180:183], 0
M v[124:127], a[88:91], a[176:179], v[124:127]
M v[128:131], a[32:35], a[184:187], 0
M v[128:131], a[36:39], a[188:191], v[128:131]
ds_read_b128 a[168:171], v10 offset:18432
ds_read_b128 a[172:175], v11 offset:18432
ds_read_b64_tr_b16 a[108:109], v13 offset:49152
ds_read_b64_tr_b16 a[110:111], v13 offset:51200
M v[132:135], a[44:47], a[188:191], 0
M v[132:135], a[40:43], a[184:187], v[132:135]
M v[136:139], a[48:51], a[184:187], 0
buffer_load_dwordx4 v4, s[8:11], s23 offen offset:2048 lds
M v[136:139], a[52:55], a[188:191], v[136:139]
M v[140:143], a[60:63], a[188:191], 0
M v[140:143], a[56:59], a[184:187], v[140:143]
ds_read_b64_tr_b16 a[116:117], v14 offset:49152
ds_read_b64_tr_b16 a[118:119], v14 offset:51200
M v[144:147], a[64:67], a[184:187], 0
M v[144:147], a[68:71], a[188:191], v[144:147]
M v[148:151], a[76:79], a[188:191], 0
buffer_load_dwordx4 v5, s[8:11], s23 offen offset:3072 lds
M v[148:151], a[72:75], a[184:187], v[148:151]
M v[152:155], a[80:83], a[184:187], 0
M v[152:155], a[84:87], a[188:191], v[152:155]
ds_read_b64_tr_b16 a[124:125], v15 offset:49152
ds_read_b64_tr_b16 a[126:127], v15 offset:51200
M v[156:159], a[92:95], a[188:191], 0
M v[156:159], a[88:91], a[184:187], v[156:159]
s_waitcnt lgkmcnt(10)
M v[160:163], a[32:35], a[160:163], 0
M v[160:163], a[36:39], a[164:167], v[160:163]
ds_read_b128 a[176:179], v10 offset:20480
ds_read_b128 a[180:183], v11 offset:20480
M v[164:167], a[44:47], a[164:167], 0
s_add_u32 m0, s29, 98304
s_nop 0
buffer_load_dwordx4 v6, s[12:15], s24 offen offset:0 lds
M v[164:167], a[40:43], a[160:163], v[164:167]
ds_read_b64_tr_b16 a[132:133], v16 offset:49152
ds_read_b64_tr_b16 a[134:135], v16 offset:51200
M v[168:171], a[48:51], a[160:163], 0
M v[168:171], a[52:55], a[164:167], v[168:171]
M v[172:175], a[60:63], a[164:167], 0
M v[172:175], a[56:59], a[160:163], v[172:175]
M v[176:179], a[64:67], a[160:163], 0
buffer_load_dwordx4 v7, s[12:15], s24 offen offset:1024 lds
M v[176:179], a[68:71], a[164:167], v[176:179]
ds_read_b64_tr_b16 a[140:141], v17 offset:49152
ds_read_b64_tr_b16 a[142:143], v17 offset:51200
M v[180:183], a[76:79], a[164:167], 0
M v[180:183], a[72:75], a[160:163], v[180:183]
M v[184:187], a[80:83], a[160:163], 0
M v[184:187], a[84:87], a[164:167], v[184:187]
buffer_load_dwordx4 v8, s[12:15], s24 offen offset:2048 lds
M v[188:191], a[92:95], a[164:167], 0
M v[188:191], a[88:91], a[160:163], v[188:191]
s_waitcnt lgkmcnt(12)
ds_read_b64_tr_b16 a[148:149], v18 offset:49152
ds_read_b64_tr_b16 a[150:151], v18 offset:51200
M v[192:195], a[32:35], a[168:171], 0
M v[192:195], a[36:39], a[172:175], v[192:195]
ds_read_b128 a[184:187], v10 offset:22528
ds_read_b128 a[188:191], v11 offset:22528
M v[196:199], a[44:47], a[172:175], 0
M v[196:199], a[40:43], a[168:171], v[196:199]
M v[200:203], a[48:51], a[168:171], 0
buffer_load_dwordx4 v9, s[12:15], s24 offen offset:3072 lds
M v[200:203], a[52:55], a[172:175], v[200:203]
ds_read_b64_tr_b16 a[156:157], v19 offset:49152
ds_read_b64_tr_b16 a[158:159], v19 offset:51200
M v[204:207], a[60:63], a[172:175], 0
M v[204:207], a[56:59], a[168:171], v[204:207]
M v[208:211], a[64:67], a[168:171], 0
M v[208:211], a[68:71], a[172:175], v[208:211]
M v[212:215], a[76:79], a[172:175], 0
s_add_u32 s24, s24, 262144
M v[212:215], a[72:75], a[168:171], v[212:215]
M v[216:219], a[80:83], a[168:171], 0
M v[216:219], a[84:87], a[172:175], v[216:219]
M v[220:223], a[92:95], a[172:175], 0
M v[220:223], a[88:91], a[168:171], v[220:223]
s_waitcnt lgkmcnt(10)
M v[224:227], a[32:35], a[176:179], 0
buffer_load_dword v21, v20, s[60:63], s54 offen
s_add_u32 s54, s54, 1048576
M v[224:227], a[36:39], a[180:183], v[224:227]
M v[228:231], a[44:47], a[180:183], 0
M v[228:231], a[40:43], a[176:179], v[228:231]
M v[232:235], a[48:51], a[176:179], 0
M v[232:235], a[52:55], a[180:183], v[232:235]
M v[236:239], a[60:63], a[180:183], 0
M v[236:239], a[56:59], a[176:179], v[236:239]
s_waitcnt vmcnt(17) lgkmcnt(0)
s_barrier
ds_read_b128 a[160:163], v10 offset:32768
ds_read_b128 a[164:167], v11 offset:32768
M v[240:243], a[64:67], a[176:179], 0
s_add_u32 m0, s29, 16384
s_add_u32 s3, s23, s31
buffer_load_dwordx4 v2, s[8:11], s3 offen offset:0 lds
M v[240:243], a[68:71], a[180:183], v[240:243]
M v[244:247], a[76:79], a[180:183], 0
M v[244:247], a[72:75], a[176:179], v[244:247]
M v[248:251], a[80:83], a[176:179], 0
M v[248:251], a[84:87], a[180:183], v[248:251]
buffer_load_dwordx4 v3, s[8:11], s3 offen offset:1024 lds
M v[252:255], a[92:95], a[180:183], 0
M v[252:255], a[88:91], a[176:179], v[252:255]
M a[0:3], a[32:35], a[184:187], 0
M a[0:3], a[36:39], a[188:191], a[0:3]
ds_read_b128 a[168:171], v10 offset:34816
ds_read_b128 a[172:175], v11 offset:34816
M a[4:7], a[44:47], a[188:191], 0
M a[4:7], a[40:43], a[184:187], a[4:7]
M a[8:11], a[48:51], a[184:187], 0
buffer_load_dwordx4 v4, s[8:11], s3 offen offset:2048 lds
M a[8:11], a[52:55], a[188:191], a[8:11]
M a[12:15], a[60:63], a[188:191], 0
M a[12:15], a[56:59], a[184:187], a[12:15]
M a[16:19], a[64:67], a[184:187], 0
M a[16:19], a[68:71], a[188:191], a[16:19]
buffer_load_dwordx4 v5, s[8:11], s3 offen offset:3072 lds
M a[20:23], a[76:79], a[188:191], 0
M a[20:23], a[72:75], a[184:187], a[20:23]
M a[24:27], a[80:83], a[184:187], 0
M a[24:27], a[84:87], a[188:191], a[24:27]
M a[28:31], a[92:95], a[188:191], 0
M a[28:31], a[88:91], a[184:187], a[28:31]
s_waitcnt lgkmcnt(2)
M v[32:35], a[96:99], a[160:163], v[32:35]
s_add_u32 s23, s23, 128
s_cmp_eq_u32 s23, s25
s_cselect_b32 s23, s26, s23
M v[32:35], a[100:103], a[164:167], v[32:35]
ds_read_b128 a[176:179], v10 offset:36864
ds_read_b128 a[180:183], v11 offset:36864
M v[36:39], a[108:111], a[164:167], v[36:39]
M v[36:39], a[104:107], a[160:163], v[36:39]
ds_read_b64_tr_b16 a[32:33], v12 offset:0
ds_read_b64_tr_b16 a[34:35], v12 offset:2048
M v[40:43], a[112:115], a[160:163], v[40:43]
M v[40:43], a[116:119], a[164:167], v[40:43]
M v[44:47], a[124:127], a[164:167], v[44:47]
s_add_u32 m0, s29, 114688
s_nop 0
buffer_load_dwordx4 v6, s[12:15], s24 offen offset:0 lds
M v[44:47], a[120:123], a[160:163], v[44:47]
ds_read_b64_tr_b16 a[40:41], v13 offset:0
ds_read_b64_tr_b16 a[42:43], v13 offset:2048
M v[48:51], a[128:131], a[160:163], v[48:51]
M v[48:51], a[132:135], a[164:167], v[48:51]
M v[52:55], a[140:143], a[164:167], v[52:55]
M v[52:55], a[136:139], a[160:163], v[52:55]
ds_read_b64_tr_b16 a[48:49], v14 offset:0
ds_read_b64_tr_b16 a[50:51], v14 offset:2048
M v[56:59], a[144:147], a[160:163], v[56:59]
M v[56:59], a[148:151], a[164:167], v[56:59]
buffer_load_dwordx4 v7, s[12:15], s24 offen offset:1024 lds
M v[60:63], a[156:159], a[164:167], v[60:63]
M v[60:63], a[152:155], a[160:163], v[60:63]
s_waitcnt lgkmcnt(8)
ds_read_b64_tr_b16 a[56:57], v15 offset:0
ds_read_b64_tr_b16 a[58:59], v15 offset:2048
M v[64:67], a[96:99], a[168:171], v[64:67]
M v[64:67], a[100:103], a[172:175], v[64:67]
ds_read_b128 a[184:187], v10 offset:38912
ds_read_b128 a[188:191], v11 offset:38912
M v[68:71], a[108:111], a[172:175], v[68:71]
M v[68:71], a[104:107], a[168:171], v[68:71]
ds_read_b64_tr_b16 a[64:65], v16 offset:0
ds_read_b64_tr_b16 a[66:67], v16 offset:2048
M v[72:75], a[112:115], a[168:171], v[72:75]
buffer_load_dwordx4 v8, s[12:15], s24 offen offset:2048 lds
M v[72:75], a[116:119], a[172:175], v[72:75]
M v[76:79], a[124:127], a[172:175], v[76:79]
M v[76:79], a[120:123], a[168:171], v[76:79]
ds_read_b64_tr_b16 a[72:73], v17 offset:0
ds_read_b64_tr_b16 a[74:75], v17 offset:2048
M v[80:83], a[128:131], a[168:171], v[80:83]
M v[80:83], a[132:135], a[172:175], v[80:83]
M v[84:87], a[140:143], a[172:175], v[84:87]
buffer_load_dwordx4 v9, s[12:15], s24 offen offset:3072 lds
M v[84:87], a[136:139], a[168:171], v[84:87]
ds_read_b64_tr_b16 a[80:81], v18 offset:0
ds_read_b64_tr_b16 a[82:83], v18 offset:2048
M v[88:91], a[144:147], a[168:171], v[88:91]
M v[88:91], a[148:151], a[172:175], v[88:91]
M v[92:95], a[156:159], a[172:175], v[92:95]
M v[92:95], a[152:155], a[168:171], v[92:95]
s_waitcnt lgkmcnt(15)
ds_read_b64_tr_b16 a[88:89], v19 offset:0
ds_read_b64_tr_b16 a[90:91], v19 offset:2048
M v[96:99], a[96:99], a[176:179], v[96:99]
s_add_u32 s24, s24, 262144
s_cmp_eq_u32 s24, s27
s_cselect_b32 s24, s28, s24
s_sub_u32 s6, s6, 1
s_cmp_eq_u32 s6, 0
s_cselect_b64 s[12:13], s[64:65], s[12:13]
M v[96:99], a[100:103], a[180:183], v[96:99]
M v[100:103], a[108:111], a[180:183], v[100:103]
M v[100:103], a[104:107], a[176:179], v[100:103]
M v[104:107], a[112:115], a[176:179], v[104:107]
M v[104:107], a[116:119], a[180:183], v[104:107]
M v[108:111], a[124:127], a[180:183], v[108:111]
M v[108:111], a[120:123], a[176:179], v[108:111]
s_waitcnt vmcnt(17) lgkmcnt(0)
s_barrier
ds_read_b128 a[160:163], v10 offset:49152
ds_read_b128 a[164:167], v11 offset:49152
M v[112:115], a[128:131], a[176:179], v[112:115]
s_add_u32 m0, s29, 32768
s_nop 0
buffer_load_dwordx4 v2, s[8:11], s23 offen offset:0 lds
M v[112:115], a[132:135], a[180:183], v[112:115]
M v[116:119], a[140:143], a[180:183], v[116:119]
M v[116:119], a[136:139], a[176:179], v[116:119]
ds_read_b64_tr_b16 a[36:37], v12 offset:16384
ds_read_b64_tr_b16 a[38:39], v12 offset:18432
M v[120:123], a[144:147], a[176:179], v[120:123]
M v[120:123], a[148:151], a[180:183], v[120:123]
buffer_load_dwordx4 v3, s[8:11], s23 offen offset:1024 lds
M v[124:127], a[156:159], a[180:183], v[124:127]
M v[124:127], a[152:155], a[176:179], v[124:127]
M v[128:131], a[96:99], a[184:187], v[128:131]
M v[128:131], a[100:103], a[188:191], v[128:131]
ds_read_b128 a[168:171], v10 offset:51200
ds_read_b128 a[172:175], v11 offset:51200
ds_read_b64_tr_b16 a[44:45], v13 offset:16384
ds_read_b64_tr_b16 a[46:47], v13 offset:18432
M v[132:135], a[108:111], a[188:191], v[132:135]
M v[132:135], a[104:107], a[184:187], v[132:135]
M v[136:139], a[112:115], a[184:187], v[136:139]
buffer_load_dwordx4 v4, s[8:11], s23 offen offset:2048 lds
M v[136:139], a[116:119], a[188:191], v[136:139]
M v[140:143], a[124:127], a[188:191], v[140:143]
M v[140:143], a[120:123], a[184:187], v[140:143]
ds_read_b64_tr_b16 a[52:53], v14 offset:16384
ds_read_b64_tr_b16 a[54:55], v14 offset:18432
M v[144:147], a[128:131], a[184:187], v[144:147]
M v[144:147], a[132:135], a[188:191], v[144:147]
M v[148:151], a[140:143], a[188:191], v[148:151]
buffer_load_dwordx4 v5, s[8:11], s23 offen offset:3072 lds
M v[148:151], a[136:139], a[184:187], v[148:151]
M v[152:155], a[144:147], a[184:187], v[152:155]
M v[152:155], a[148:151], a[188:191], v[152:155]
ds_read_b64_tr_b16 a[60:61], v15 offset:16384
ds_read_b64_tr_b16 a[62:63], v15 offset:18432
M v[156:159], a[156:159], a[188:191], v[156:159]
M v[156:159], a[152:155], a[184:187], v[156:159]
s_waitcnt lgkmcnt(10)
M v[160:163], a[96:99], a[160:163], v[160:163]
M v[160:163], a[100:103], a[164:167], v[160:163]
ds_read_b128 a[176:179], v10 offset:53248
ds_read_b128 a[180:183], v11 offset:53248
M v[164:167], a[108:111], a[164:167], v[164:167]
s_add_u32 m0, s29, 65536
s_nop 0
buffer_load_dwordx4 v6, s[12:15], s24 offen offset:0 lds
M v[164:167], a[104:107], a[160:163], v[164:167]
ds_read_b64_tr_b16 a[68:69], v16 offset:16384
ds_read_b64_tr_b16 a[70:71], v16 offset:18432
M v[168:171], a[112:115], a[160:163], v[168:171]
M v[168:171], a[116:119], a[164:167], v[168:171]
M v[172:175], a[124:127], a[164:167], v[172:175]
M v[172:175], a[120:123], a[160:163], v[172:175]
M v[176:179], a[128:131], a[160:163], v[176:179]
buffer_load_dwordx4 v7, s[12:15], s24 offen offset:1024 lds
M v[176:179], a[132:135], a[164:167], v[176:179]
ds_read_b64_tr_b16 a[76:77], v17 offset:16384
ds_read_b64_tr_b16 a[78:79], v17 offset:18432
M v[180:183], a[140:143], a[164:167], v[180:183]
M v[180:183], a[136:139], a[160:163], v[180:183]
M v[184:187], a[144:147], a[160:163], v[184:187]
M v[184:187], a[148:151], a[164:167], v[184:187]
buffer_load_dwordx4 v8, s[12:15], s24 offen offset:2048 lds
M v[188:191], a[156:159], a[164:167], v[188:191]
M v[188:191], a[152:155], a[160:163], v[188:191]
s_waitcnt lgkmcnt(12)
ds_read_b64_tr_b16 a[84:85], v18 offset:16384
ds_read_b64_tr_b16 a[86:87], v18 offset:18432
M v[192:195], a[96:99], a[168:171], v[192:195]
M v[192:195], a[100:103], a[172:175], v[192:195]
ds_read_b128 a[184:187], v10 offset:55296
ds_read_b128 a[188:191], v11 offset:55296
M v[196:199], a[108:111], a[172:175], v[196:199]
M v[196:199], a[104:107], a[168:171], v[196:199]
M v[200:203], a[112:115], a[168:171], v[200:203]
buffer_load_dwordx4 v9, s[12:15], s24 offen offset:3072 lds
M v[200:203], a[116:119], a[172:175], v[200:203]
ds_read_b64_tr_b16 a[92:93], v19 offset:16384
ds_read_b64_tr_b16 a[94:95], v19 offset:18432
M v[204:207], a[124:127], a[172:175], v[204:207]
M v[204:207], a[120:123], a[168:171], v[204:207]
M v[208:211], a[128:131], a[168:171], v[208:211]
M v[208:211], a[132:135], a[172:175], v[208:211]
M v[212:215], a[140:143], a[172:175], v[212:215]
s_add_u32 s24, s24, 262144
M v[212:215], a[136:139], a[168:171], v[212:215]
M v[216:219], a[144:147], a[168:171], v[216:219]
M v[216:219], a[148:151], a[172:175], v[216:219]
M v[220:223], a[156:159], a[172:175], v[220:223]
M v[220:223], a[152:155], a[168:171], v[220:223]
s_waitcnt lgkmcnt(10)
M v[224:227], a[96:99], a[176:179], v[224:227]
buffer_load_dword v21, v20, s[60:63], s54 offen
s_add_u32 s54, s54, 1048576
M v[224:227], a[100:103], a[180:183], v[224:227]
M v[228:231], a[108:111], a[180:183], v[228:231]
M v[228:231], a[104:107], a[176:179], v[228:231]
M v[232:235], a[112:115], a[176:179], v[232:235]
M v[232:235], a[116:119], a[180:183], v[232:235]
M v[236:239], a[124:127], a[180:183], v[236:239]
M v[236:239], a[120:123], a[176:179], v[236:239]
s_waitcnt vmcnt(18) lgkmcnt(0)
s_barrier
ds_read_b128 a[160:163], v10 offset:0
ds_read_b128 a[164:167], v11 offset:0
M v[240:243], a[128:131], a[176:179], v[240:243]
s_add_u32 m0, s29, 49152
s_add_u32 s3, s23, s31
buffer_load_dwordx4 v2, s[8:11], s3 offen offset:0 lds
M v[240:243], a[132:135], a[180:183], v[240:243]
M v[244:247], a[140:143], a[180:183], v[244:247]
M v[244:247], a[136:139], a[176:179], v[244:247]
M v[248:251], a[144:147], a[176:179], v[248:251]
M v[248:251], a[148:151], a[180:183], v[248:251]
buffer_load_dwordx4 v3, s[8:11], s3 offen offset:1024 lds
M v[252:255], a[156:159], a[180:183], v[252:255]
M v[252:255], a[152:155], a[176:179], v[252:255]
M a[0:3], a[96:99], a[184:187], a[0:3]
M a[0:3], a[100:103], a[188:191], a[0:3]
ds_read_b128 a[168:171], v10 offset:2048
ds_read_b128 a[172:175], v11 offset:2048
M a[4:7], a[108:111], a[188:191], a[4:7]
M a[4:7], a[104:107], a[184:187], a[4:7]
M a[8:11], a[112:115], a[184:187], a[8:11]
buffer_load_dwordx4 v4, s[8:11], s3 offen offset:2048 lds
M a[8:11], a[116:119], a[188:191], a[8:11]
M a[12:15], a[124:127], a[188:191], a[12:15]
M a[12:15], a[120:123], a[184:187], a[12:15]
M a[16:19], a[128:131], a[184:187], a[16:19]
M a[16:19], a[132:135], a[188:191], a[16:19]
buffer_load_dwordx4 v5, s[8:11], s3 offen offset:3072 lds
M a[20:23], a[140:143], a[188:191], a[20:23]
M a[20:23], a[136:139], a[184:187], a[20:23]
M a[24:27], a[144:147], a[184:187], a[24:27]
M a[24:27], a[148:151], a[188:191], a[24:27]
M a[28:31], a[156:159], a[188:191], a[28:31]
M a[28:31], a[152:155], a[184:187], a[28:31]
s_waitcnt lgkmcnt(2)
s_mov_b32 s30, 5
Lk1_ql:
M v[32:35], a[32:35], a[160:163], v[32:35]
s_add_u32 s23, s23, 128
s_cmp_eq_u32 s23, s25
s_cselect_b32 s23, s26, s23
M v[32:35], a[36:39], a[164:167], v[32:35]
ds_read_b128 a[176:179], v10 offset:4096
ds_read_b128 a[180:183], v11 offset:4096
M v[36:39], a[44:47], a[164:167], v[36:39]
M v[36:39], a[40:43], a[160:163], v[36:39]
ds_read_b64_tr_b16 a[96:97], v12 offset:32768
ds_read_b64_tr_b16 a[98:99], v12 offset:34816
M v[40:43], a[48:51], a[160:163], v[40:43]
M v[40:43], a[52:55], a[164:167], v[40:43]
M v[44:47], a[60:63], a[164:167], v[44:47]
s_add_u32 m0, s29, 81920
s_nop 0
buffer_load_dwordx4 v6, s[12:15], s24 offen offset:0 lds
M v[44:47], a[56:59], a[160:163], v[44:47]
ds_read_b64_tr_b16 a[104:105], v13 offset:32768
ds_read_b64_tr_b16 a[106:107], v13 offset:34816
M v[48:51], a[64:67], a[160:163], v[48:51]
M v[48:51], a[68:71], a[164:167], v[48:51]
M v[52:55], a[76:79], a[164:167], v[52:55]
M v[52:55], a[72:75], a[160:163], v[52:55]
ds_read_b64_tr_b16 a[112:113], v14 offset:32768
ds_read_b64_tr_b16 a[114:115], v14 offset:34816
M v[56:59], a[80:83], a[160:163], v[56:59]
M v[56:59], a[84:87], a[164:167], v[56:59]
buffer_load_dwordx4 v7, s[12:15], s24 offen offset:1024 lds
M v[60:63], a[92:95], a[164:167], v[60:63]
M v[60:63], a[88:91], a[160:163], v[60:63]
s_waitcnt lgkmcnt(8)
ds_read_b64_tr_b16 a[120:121], v15 offset:32768
ds_read_b64_tr_b16 a[122:123], v15 offset:34816
M v[64:67], a[32:35], a[168:171], v[64:67]
M v[64:67], a[36:39], a[172:175], v[64:67]
ds_read_b128 a[184:187], v10 offset:6144
ds_read_b128 a[188:191], v11 offset:6144
M v[68:71], a[44:47], a[172:175], v[68:71]
M v[68:71], a[40:43], a[168:171], v[68:71]
ds_read_b64_tr_b16 a[128:129], v16 offset:32768
ds_read_b64_tr_b16 a[130:131], v16 offset:34816
M v[72:75], a[48:51], a[168:171], v[72:75]
buffer_load_dwordx4 v8, s[12:15], s24 offen offset:2048 lds
M v[72:75], a[52:55], a[172:175], v[72:75]
M v[76:79], a[60:63], a[172:175], v[76:79]
M v[76:79], a[56:59], a[168:171], v[76:79]
ds_read_b64_tr_b16 a[136:137], v17 offset:32768
ds_read_b64_tr_b16 a[138:139], v17 offset:34816
M v[80:83], a[64:67], a[168:171], v[80:83]
M v[80:83], a[68:71], a[172:175], v[80:83]
M v[84:87], a[76:79], a[172:175], v[84:87]
buffer_load_dwordx4 v9, s[12:15], s24 offen offset:3072 lds
M v[84:87], a[72:75], a[168:171], v[84:87]
ds_read_b64_tr_b16 a[144:145], v18 offset:32768
ds_read_b64_tr_b16 a[146:147], v18 offset:34816
M v[88:91], a[80:83], a[168:171], v[88:91]
M v[88:91], a[84:87], a[172:175], v[88:91]
M v[92:95], a[92:95], a[172:175], v[92:95]
M v[92:95], a[88:91], a[168:171], v[92:95]
s_waitcnt lgkmcnt(15)
ds_read_b64_tr_b16 a[152:153], v19 offset:32768
ds_read_b64_tr_b16 a[154:155], v19 offset:34816
M v[96:99], a[32:35], a[176:179], v[96:99]
s_add_u32 s24, s24, 262144
s_cmp_eq_u32 s24, s27
s_cselect_b32 s24, s28, s24
s_sub_u32 s6, s6, 1
s_cmp_eq_u32 s6, 0
s_cselect_b64 s[12:13], s[64:65], s[12:13]
M v[96:99], a[36:39], a[180:183], v[96:99]
M v[100:103], a[44:47], a[180:183], v[100:103]
M v[100:103], a[40:43], a[176:179], v[100:103]
M v[104:107], a[48:51], a[176:179], v[104:107]
M v[104:107], a[52:55], a[180:183], v[104:107]
M v[108:111], a[60:63], a[180:183], v[108:111]
M v[108:111], a[56:59], a[176:179], v[108:111]
s_waitcnt vmcnt(17) lgkmcnt(0)
s_barrier
ds_read_b128 a[160:163], v10 offset:16384
ds_read_b128 a[164:167], v11 offset:16384
M v[112:115], a[64:67], a[176:179], v[112:115]
s_add_u32 m0, s29, 0
s_nop 0
buffer_load_dwordx4 v2, s[8:11], s23 offen offset:0 lds
M v[112:115], a[68:71], a[180:183], v[112:115]
M v[116:119], a[76:79], a[180:183], v[116:119]
M v[116:119], a[72:75], a[176:179], v[116:119]
ds_read_b64_tr_b16 a[100:101], v12 offset:49152
ds_read_b64_tr_b16 a[102:103], v12 offset:51200
M v[120:123], a[80:83], a[176:179], v[120:123]
M v[120:123], a[84:87], a[180:183], v[120:123]
buffer_load_dwordx4 v3, s[8:11], s23 offen offset:1024 lds
M v[124:127], a[92:95], a[180:183], v[124:127]
M v[124:127], a[88:91], a[176:179], v[124:127]
M v[128:131], a[32:35], a[184:187], v[128:131]
M v[128:131], a[36:39], a[188:191], v[128:131]
ds_read_b128 a[168:171], v10 offset:18432
ds_read_b128 a[172:175], v11 offset:18432
ds_read_b64_tr_b16 a[108:109], v13 offset:49152
ds_read_b64_tr_b16 a[110:111], v13 offset:51200
M v[132:135], a[44:47], a[188:191], v[132:135]
M v[132:135], a[40:43], a[184:187], v[132:135]
M v[136:139], a[48:51], a[184:187], v[136:139]
buffer_load_dwordx4 v4, s[8:11], s23 offen offset:2048 lds
M v[136:139], a[52:55], a[188:191], v[136:139]
M v[140:143], a[60:63], a[188:191], v[140:143]
M v[140:143], a[56:59], a[184:187], v[140:143]
ds_read_b64_tr_b16 a[116:117], v14 offset:49152
ds_read_b64_tr_b16 a[118:119], v14 offset:51200
M v[144:147], a[64:67], a[184:187], v[144:147]
M v[144:147], a[68:71], a[188:191], v[144:147]
M v[148:151], a[76:79], a[188:191], v[148:151]
buffer_load_dwordx4 v5, s[8:11], s23 offen offset:3072 lds
M v[148:151], a[72:75], a[184:187], v[148:151]
M v[152:155], a[80:83], a[184:187], v[152:155]
M v[152:155], a[84:87], a[188:191], v[152:155]
ds_read_b64_tr_b16 a[124:125], v15 offset:49152
ds_read_b64_tr_b16 a[126:127], v15 offset:51200
M v[156:159], a[92:95], a[188:191], v[156:159]
M v[156:159], a[88:91], a[184:187], v[156:159]
s_waitcnt lgkmcnt(10)
M v[160:163], a[32:35], a[160:163], v[160:163]
M v[160:163], a[36:39], a[164:167], v[160:163]
ds_read_b128 a[176:179], v10 offset:20480
ds_read_b128 a[180:183], v11 offset:20480
M v[164:167], a[44:47], a[164:167], v[164:167]
s_add_u32 m0, s29, 98304
s_nop 0
buffer_load_dwordx4 v6, s[12:15], s24 offen offset:0 lds
M v[164:167], a[40:43], a[160:163], v[164:167]
ds_read_b64_tr_b16 a[132:133], v16 offset:49152
ds_read_b64_tr_b16 a[134:135], v16 offset:51200
M v[168:171], a[48:51], a[160:163], v[168:171]
M v[168:171], a[52:55], a[164:167], v[168:171]
M v[172:175], a[60:63], a[164:167], v[172:175]
M v[172:175], a[56:59], a[160:163], v[172:175]
M v[176:179], a[64:67], a[160:163], v[176:179]
buffer_load_dwordx4 v7, s[12:15], s24 offen offset:1024 lds
M v[176:179], a[68:71], a[164:167], v[176:179]
ds_read_b64_tr_b16 a[140:141], v17 offset:49152
ds_read_b64_tr_b16 a[142:143], v17 offset:51200
M v[180:183], a[76:79], a[164:167], v[180:183]
M v[180:183], a[72:75], a[160:163], v[180:183]
M v[184:187], a[80:83], a[160:163], v[184:187]
M v[184:187], a[84:87], a[164:167], v[184:187]
buffer_load_dwordx4 v8, s[12:15], s24 offen offset:2048 lds
M v[188:191], a[92:95], a[164:167], v[188:191]
M v[188:191], a[88:91], a[160:163], v[188:191]
s_waitcnt lgkmcnt(12)
ds_read_b64_tr_b16 a[148:149], v18 offset:49152
ds_read_b64_tr_b16 a[150:151], v18 offset:51200
M v[192:195], a[32:35], a[168:171], v[192:195]
M v[192:195], a[36:39], a[172:175], v[192:195]
ds_read_b128 a[184:187], v10 offset:22528
ds_read_b128 a[188:191], v11 offset:22528
M v[196:199], a[44:47], a[172:175], v[196:199]
M v[196:199], a[40:43], a[168:171], v[196:199]
M v[200:203], a[48:51], a[168:171], v[200:203]
buffer_load_dwordx4 v9, s[12:15], s24 offen offset:3072 lds
M v[200:203], a[52:55], a[172:175], v[200:203]
ds_read_b64_tr_b16 a[156:157], v19 offset:49152
ds_read_b64_tr_b16 a[158:159], v19 offset:51200
M v[204:207], a[60:63], a[172:175], v[204:207]
M v[204:207], a[56:59], a[168:171], v[204:207]
M v[208:211], a[64:67], a[168:171], v[208:211]
M v[208:211], a[68:71], a[172:175], v[208:211]
M v[212:215], a[76:79], a[172:175], v[212:215]
s_add_u32 s24, s24, 262144
M v[212:215], a[72:75], a[168:171], v[212:215]
M v[216:219], a[80:83], a[168:171], v[216:219]
M v[216:219], a[84:87], a[172:175], v[216:219]
M v[220:223], a[92:95], a[172:175], v[220:223]
M v[220:223], a[88:91], a[168:171], v[220:223]
s_waitcnt lgkmcnt(10)
M v[224:227], a[32:35], a[176:179], v[224:227]
buffer_load_dword v21, v20, s[60:63], s54 offen
s_add_u32 s54, s54, 1048576
M v[224:227], a[36:39], a[180:183], v[224:227]
M v[228:231], a[44:47], a[180:183], v[228:231]
M v[228:231], a[40:43], a[176:179], v[228:231]
M v[232:235], a[48:51], a[176:179], v[232:235]
M v[232:235], a[52:55], a[180:183], v[232:235]
M v[236:239], a[60:63], a[180:183], v[236:239]
M v[236:239], a[56:59], a[176:179], v[236:239]
s_waitcnt vmcnt(18) lgkmcnt(0)
s_barrier
ds_read_b128 a[160:163], v10 offset:32768
ds_read_b128 a[164:167], v11 offset:32768
M v[240:243], a[64:67], a[176:179], v[240:243]
s_add_u32 m0, s29, 16384
s_add_u32 s3, s23, s31
buffer_load_dwordx4 v2, s[8:11], s3 offen offset:0 lds
M v[240:243], a[68:71], a[180:183], v[240:243]
M v[244:247], a[76:79], a[180:183], v[244:247]
M v[244:247], a[72:75], a[176:179], v[244:247]
M v[248:251], a[80:83], a[176:179], v[248:251]
M v[248:251], a[84:87], a[180:183], v[248:251]
buffer_load_dwordx4 v3, s[8:11], s3 offen offset:1024 lds
M v[252:255], a[92:95], a[180:183], v[252:255]
M v[252:255], a[88:91], a[176:179], v[252:255]
M a[0:3], a[32:35], a[184:187], a[0:3]
M a[0:3], a[36:39], a[188:191], a[0:3]
ds_read_b128 a[168:171], v10 offset:34816
ds_read_b128 a[172:175], v11 offset:34816
M a[4:7], a[44:47], a[188:191], a[4:7]
M a[4:7], a[40:43], a[184:187], a[4:7]
M a[8:11], a[48:51], a[184:187], a[8:11]
buffer_load_dwordx4 v4, s[8:11], s3 offen offset:2048 lds
M a[8:11], a[52:55], a[188:191], a[8:11]
M a[12:15], a[60:63], a[188:191], a[12:15]
M a[12:15], a[56:59], a[184:187], a[12:15]
M a[16:19], a[64:67], a[184:187], a[16:19]
M a[16:19], a[68:71], a[188:191], a[16:19]
buffer_load_dwordx4 v5, s[8:11], s3 offen offset:3072 lds
M a[20:23], a[76:79], a[188:191], a[20:23]
M a[20:23], a[72:75], a[184:187], a[20:23]
M a[24:27], a[80:83], a[184:187], a[24:27]
M a[24:27], a[84:87], a[188:191], a[24:27]
M a[28:31], a[92:95], a[188:191], a[28:31]
M a[28:31], a[88:91], a[184:187], a[28:31]
s_waitcnt lgkmcnt(2)
M v[32:35], a[96:99], a[160:163], v[32:35]
s_add_u32 s23, s23, 128
s_cmp_eq_u32 s23, s25
s_cselect_b32 s23, s26, s23
M v[32:35], a[100:103], a[164:167], v[32:35]
ds_read_b128 a[176:179], v10 offset:36864
ds_read_b128 a[180:183], v11 offset:36864
M v[36:39], a[108:111], a[164:167], v[36:39]
M v[36:39], a[104:107], a[160:163], v[36:39]
ds_read_b64_tr_b16 a[32:33], v12 offset:0
ds_read_b64_tr_b16 a[34:35], v12 offset:2048
M v[40:43], a[112:115], a[160:163], v[40:43]
M v[40:43], a[116:119], a[164:167], v[40:43]
M v[44:47], a[124:127], a[164:167], v[44:47]
s_add_u32 m0, s29, 114688
s_nop 0
buffer_load_dwordx4 v6, s[12:15], s24 offen offset:0 lds
M v[44:47], a[120:123], a[160:163], v[44:47]
ds_read_b64_tr_b16 a[40:41], v13 offset:0
ds_read_b64_tr_b16 a[42:43], v13 offset:2048
M v[48:51], a[128:131], a[160:163], v[48:51]
M v[48:51], a[132:135], a[164:167], v[48:51]
M v[52:55], a[140:143], a[164:167], v[52:55]
M v[52:55], a[136:139], a[160:163], v[52:55]
ds_read_b64_tr_b16 a[48:49], v14 offset:0
ds_read_b64_tr_b16 a[50:51], v14 offset:2048
M v[56:59], a[144:147], a[160:163], v[56:59]
M v[56:59], a[148:151], a[164:167], v[56:59]
buffer_load_dwordx4 v7, s[12:15], s24 offen offset:1024 lds
M v[60:63], a[156:159], a[164:167], v[60:63]
M v[60:63], a[152:155], a[160:163], v[60:63]
s_waitcnt lgkmcnt(8)
ds_read_b64_tr_b16 a[56:57], v15 offset:0
ds_read_b64_tr_b16 a[58:59], v15 offset:2048
M v[64:67], a[96:99], a[168:171], v[64:67]
M v[64:67], a[100:103], a[172:175], v[64:67]
ds_read_b128 a[184:187], v10 offset:38912
ds_read_b128 a[188:191], v11 offset:38912
M v[68:71], a[108:111], a[172:175], v[68:71]
M v[68:71], a[104:107], a[168:171], v[68:71]
ds_read_b64_tr_b16 a[64:65], v16 offset:0
ds_read_b64_tr_b16 a[66:67], v16 offset:2048
M v[72:75], a[112:115], a[168:171], v[72:75]
buffer_load_dwordx4 v8, s[12:15], s24 offen offset:2048 lds
M v[72:75], a[116:119], a[172:175], v[72:75]
M v[76:79], a[124:127], a[172:175], v[76:79]
M v[76:79], a[120:123], a[168:171], v[76:79]
ds_read_b64_tr_b16 a[72:73], v17 offset:0
ds_read_b64_tr_b16 a[74:75], v17 offset:2048
M v[80:83], a[128:131], a[168:171], v[80:83]
M v[80:83], a[132:135], a[172:175], v[80:83]
M v[84:87], a[140:143], a[172:175], v[84:87]
buffer_load_dwordx4 v9, s[12:15], s24 offen offset:3072 lds
M v[84:87], a[136:139], a[168:171], v[84:87]
ds_read_b64_tr_b16 a[80:81], v18 offset:0
ds_read_b64_tr_b16 a[82:83], v18 offset:2048
M v[88:91], a[144:147], a[168:171], v[88:91]
M v[88:91], a[148:151], a[172:175], v[88:91]
M v[92:95], a[156:159], a[172:175], v[92:95]
M v[92:95], a[152:155], a[168:171], v[92:95]
s_waitcnt lgkmcnt(15)
ds_read_b64_tr_b16 a[88:89], v19 offset:0
ds_read_b64_tr_b16 a[90:91], v19 offset:2048
M v[96:99], a[96:99], a[176:179], v[96:99]
s_add_u32 s24, s24, 262144
s_cmp_eq_u32 s24, s27
s_cselect_b32 s24, s28, s24
s_sub_u32 s6, s6, 1
s_cmp_eq_u32 s6, 0
s_cselect_b64 s[12:13], s[64:65], s[12:13]
M v[96:99], a[100:103], a[180:183], v[96:99]
M v[100:103], a[108:111], a[180:183], v[100:103]
M v[100:103], a[104:107], a[176:179], v[100:103]
M v[104:107], a[112:115], a[176:179], v[104:107]
M v[104:107], a[116:119], a[180:183], v[104:107]
M v[108:111], a[124:127], a[180:183], v[108:111]
M v[108:111], a[120:123], a[176:179], v[108:111]
s_waitcnt vmcnt(17) lgkmcnt(0)
s_barrier
ds_read_b128 a[160:163], v10 offset:49152
ds_read_b128 a[164:167], v11 offset:49152
M v[112:115], a[128:131], a[176:179], v[112:115]
s_add_u32 m0, s29, 32768
s_nop 0
buffer_load_dwordx4 v2, s[8:11], s23 offen offset:0 lds
M v[112:115], a[132:135], a[180:183], v[112:115]
M v[116:119], a[140:143], a[180:183], v[116:119]
M v[116:119], a[136:139], a[176:179], v[116:119]
ds_read_b64_tr_b16 a[36:37], v12 offset:16384
ds_read_b64_tr_b16 a[38:39], v12 offset:18432
M v[120:123], a[144:147], a[176:179], v[120:123]
M v[120:123], a[148:151], a[180:183], v[120:123]
buffer_load_dwordx4 v3, s[8:11], s23 offen offset:1024 lds
M v[124:127], a[156:159], a[180:183], v[124:127]
M v[124:127], a[152:155], a[176:179], v[124:127]
M v[128:131], a[96:99], a[184:187], v[128:131]
M v[128:131], a[100:103], a[188:191], v[128:131]
ds_read_b128 a[168:171], v10 offset:51200
ds_read_b128 a[172:175], v11 offset:51200
ds_read_b64_tr_b16 a[44:45], v13 offset:16384
ds_read_b64_tr_b16 a[46:47], v13 offset:18432
M v[132:135], a[108:111], a[188:191], v[132:135]
M v[132:135], a[104:107], a[184:187], v[132:135]
M v[136:139], a[112:115], a[184:187], v[136:139]
buffer_load_dwordx4 v4, s[8:11], s23 offen offset:2048 lds
M v[136:139], a[116:119], a[188:191], v[136:139]
M v[140:143], a[124:127], a[188:191], v[140:143]
M v[140:143], a[120:123], a[184:187], v[140:143]
ds_read_b64_tr_b16 a[52:53], v14 offset:16384
ds_read_b64_tr_b16 a[54:55], v14 offset:18432
M v[144:147], a[128:131], a[184:187], v[144:147]
M v[144:147], a[132:135], a[188:191], v[144:147]
M v[148:151], a[140:143], a[188:191], v[148:151]
buffer_load_dwordx4 v5, s[8:11], s23 offen offset:3072 lds
M v[148:151], a[136:139], a[184:187], v[148:151]
M v[152:155], a[144:147], a[184:187], v[152:155]
M v[152:155], a[148:151], a[188:191], v[152:155]
ds_read_b64_tr_b16 a[60:61], v15 offset:16384
ds_read_b64_tr_b16 a[62:63], v15 offset:18432
M v[156:159], a[156:159], a[188:191], v[156:159]
M v[156:159], a[152:155], a[184:187], v[156:159]
s_waitcnt lgkmcnt(10)
M v[160:163], a[96:99], a[160:163], v[160:163]
M v[160:163], a[100:103], a[164:167], v[160:163]
ds_read_b128 a[176:179], v10 offset:53248
ds_read_b128 a[180:183], v11 offset:53248
M v[164:167], a[108:111], a[164:167], v[164:167]
s_add_u32 m0, s29, 65536
s_nop 0
buffer_load_dwordx4 v6, s[12:15], s24 offen offset:0 lds
M v[164:167], a[104:107], a[160:163], v[164:167]
ds_read_b64_tr_b16 a[68:69], v16 offset:16384
ds_read_b64_tr_b16 a[70:71], v16 offset:18432
M v[168:171], a[112:115], a[160:163], v[168:171]
M v[168:171], a[116:119], a[164:167], v[168:171]
M v[172:175], a[124:127], a[164:167], v[172:175]
M v[172:175], a[120:123], a[160:163], v[172:175]
M v[176:179], a[128:131], a[160:163], v[176:179]
buffer_load_dwordx4 v7, s[12:15], s24 offen offset:1024 lds
M v[176:179], a[132:135], a[164:167], v[176:179]
ds_read_b64_tr_b16 a[76:77], v17 offset:16384
ds_read_b64_tr_b16 a[78:79], v17 offset:18432
M v[180:183], a[140:143], a[164:167], v[180:183]
M v[180:183], a[136:139], a[160:163], v[180:183]
M v[184:187], a[144:147], a[160:163], v[184:187]
M v[184:187], a[148:151], a[164:167], v[184:187]
buffer_load_dwordx4 v8, s[12:15], s24 offen offset:2048 lds
M v[188:191], a[156:159], a[164:167], v[188:191]
M v[188:191], a[152:155], a[160:163], v[188:191]
s_waitcnt lgkmcnt(12)
ds_read_b64_tr_b16 a[84:85], v18 offset:16384
ds_read_b64_tr_b16 a[86:87], v18 offset:18432
M v[192:195], a[96:99], a[168:171], v[192:195]
M v[192:195], a[100:103], a[172:175], v[192:195]
ds_read_b128 a[184:187], v10 offset:55296
ds_read_b128 a[188:191], v11 offset:55296
M v[196:199], a[108:111], a[172:175], v[196:199]
M v[196:199], a[104:107], a[168:171], v[196:199]
M v[200:203], a[112:115], a[168:171], v[200:203]
buffer_load_dwordx4 v9, s[12:15], s24 offen offset:3072 lds
M v[200:203], a[116:119], a[172:175], v[200:203]
ds_read_b64_tr_b16 a[92:93], v19 offset:16384
ds_read_b64_tr_b16 a[94:95], v19 offset:18432
M v[204:207], a[124:127], a[172:175], v[204:207]
M v[204:207], a[120:123], a[168:171], v[204:207]
M v[208:211], a[128:131], a[168:171], v[208:211]
M v[208:211], a[132:135], a[172:175], v[208:211]
M v[212:215], a[140:143], a[172:175], v[212:215]
s_add_u32 s24, s24, 262144
M v[212:215], a[136:139], a[168:171], v[212:215]
M v[216:219], a[144:147], a[168:171], v[216:219]
M v[216:219], a[148:151], a[172:175], v[216:219]
M v[220:223], a[156:159], a[172:175], v[220:223]
M v[220:223], a[152:155], a[168:171], v[220:223]
s_waitcnt lgkmcnt(10)
M v[224:227], a[96:99], a[176:179], v[224:227]
buffer_load_dword v21, v20, s[60:63], s54 offen
s_add_u32 s54, s54, 1048576
M v[224:227], a[100:103], a[180:183], v[224:227]
M v[228:231], a[108:111], a[180:183], v[228:231]
M v[228:231], a[104:107], a[176:179], v[228:231]
M v[232:235], a[112:115], a[176:179], v[232:235]
M v[232:235], a[116:119], a[180:183], v[232:235]
M v[236:239], a[124:127], a[180:183], v[236:239]
M v[236:239], a[120:123], a[176:179], v[236:239]
s_waitcnt vmcnt(18) lgkmcnt(0)
s_barrier
ds_read_b128 a[160:163], v10 offset:0
ds_read_b128 a[164:167], v11 offset:0
M v[240:243], a[128:131], a[176:179], v[240:243]
s_add_u32 m0, s29, 49152
s_add_u32 s3, s23, s31
buffer_load_dwordx4 v2, s[8:11], s3 offen offset:0 lds
M v[240:243], a[132:135], a[180:183], v[240:243]
M v[244:247], a[140:143], a[180:183], v[244:247]
M v[244:247], a[136:139], a[176:179], v[244:247]
M v[248:251], a[144:147], a[176:179], v[248:251]
M v[248:251], a[148:151], a[180:183], v[248:251]
buffer_load_dwordx4 v3, s[8:11], s3 offen offset:1024 lds
M v[252:255], a[156:159], a[180:183], v[252:255]
M v[252:255], a[152:155], a[176:179], v[252:255]
M a[0:3], a[96:99], a[184:187], a[0:3]
M a[0:3], a[100:103], a[188:191], a[0:3]
ds_read_b128 a[168:171], v10 offset:2048
ds_read_b128 a[172:175], v11 offset:2048
M a[4:7], a[108:111], a[188:191], a[4:7]
M a[4:7], a[104:107], a[184:187], a[4:7]
M a[8:11], a[112:115], a[184:187], a[8:11]
buffer_load_dwordx4 v4, s[8:11], s3 offen offset:2048 lds
M a[8:11], a[116:119], a[188:191], a[8:11]
M a[12:15], a[124:127], a[188:191], a[12:15]
M a[12:15], a[120:123], a[184:187], a[12:15]
M a[16:19], a[128:131], a[184:187], a[16:19]
M a[16:19], a[132:135], a[188:191], a[16:19]
buffer_load_dwordx4 v5, s[8:11], s3 offen offset:3072 lds
M a[20:23], a[140:143], a[188:191], a[20:23]
M a[20:23], a[136:139], a[184:187], a[20:23]
M a[24:27], a[144:147], a[184:187], a[24:27]
M a[24:27], a[148:151], a[188:191], a[24:27]
M a[28:31], a[156:159], a[188:191], a[28:31]
M a[28:31], a[152:155], a[184:187], a[28:31]
s_waitcnt lgkmcnt(2)
s_sub_u32 s30, s30, 1
s_cmp_lg_u32 s30, 0
s_cbranch_scc1 Lk1_ql
M v[32:35], a[32:35], a[160:163], v[32:35]
s_add_u32 s23, s23, 128
s_cmp_eq_u32 s23, s25
s_cselect_b32 s23, s26, s23
M v[32:35], a[36:39], a[164:167], v[32:35]
ds_read_b128 a[176:179], v10 offset:4096
ds_read_b128 a[180:183], v11 offset:4096
M v[36:39], a[44:47], a[164:167], v[36:39]
M v[36:39], a[40:43], a[160:163], v[36:39]
ds_read_b64_tr_b16 a[96:97], v12 offset:32768
ds_read_b64_tr_b16 a[98:99], v12 offset:34816
M v[40:43], a[48:51], a[160:163], v[40:43]
M v[40:43], a[52:55], a[164:167], v[40:43]
M v[44:47], a[60:63], a[164:167], v[44:47]
s_add_u32 m0, s29, 81920
s_nop 0
buffer_load_dwordx4 v6, s[12:15], s24 offen offset:0 lds
M v[44:47], a[56:59], a[160:163], v[44:47]
ds_read_b64_tr_b16 a[104:105], v13 offset:32768
ds_read_b64_tr_b16 a[106:107], v13 offset:34816
M v[48:51], a[64:67], a[160:163], v[48:51]
M v[48:51], a[68:71], a[164:167], v[48:51]
M v[52:55], a[76:79], a[164:167], v[52:55]
M v[52:55], a[72:75], a[160:163], v[52:55]
ds_read_b64_tr_b16 a[112:113], v14 offset:32768
ds_read_b64_tr_b16 a[114:115], v14 offset:34816
M v[56:59], a[80:83], a[160:163], v[56:59]
M v[56:59], a[84:87], a[164:167], v[56:59]
buffer_load_dwordx4 v7, s[12:15], s24 offen offset:1024 lds
M v[60:63], a[92:95], a[164:167], v[60:63]
M v[60:63], a[88:91], a[160:163], v[60:63]
s_waitcnt lgkmcnt(8)
ds_read_b64_tr_b16 a[120:121], v15 offset:32768
ds_read_b64_tr_b16 a[122:123], v15 offset:34816
M v[64:67], a[32:35], a[168:171], v[64:67]
M v[64:67], a[36:39], a[172:175], v[64:67]
ds_read_b128 a[184:187], v10 offset:6144
ds_read_b128 a[188:191], v11 offset:6144
M v[68:71], a[44:47], a[172:175], v[68:71]
M v[68:71], a[40:43], a[168:171], v[68:71]
ds_read_b64_tr_b16 a[128:129], v16 offset:32768
ds_read_b64_tr_b16 a[130:131], v16 offset:34816
M v[72:75], a[48:51], a[168:171], v[72:75]
buffer_load_dwordx4 v8, s[12:15], s24 offen offset:2048 lds
M v[72:75], a[52:55], a[172:175], v[72:75]
M v[76:79], a[60:63], a[172:175], v[76:79]
M v[76:79], a[56:59], a[168:171], v[76:79]
ds_read_b64_tr_b16 a[136:137], v17 offset:32768
ds_read_b64_tr_b16 a[138:139], v17 offset:34816
M v[80:83], a[64:67], a[168:171], v[80:83]
M v[80:83], a[68:71], a[172:175], v[80:83]
M v[84:87], a[76:79], a[172:175], v[84:87]
buffer_load_dwordx4 v9, s[12:15], s24 offen offset:3072 lds
M v[84:87], a[72:75], a[168:171], v[84:87]
ds_read_b64_tr_b16 a[144:145], v18 offset:32768
ds_read_b64_tr_b16 a[146:147], v18 offset:34816
M v[88:91], a[80:83], a[168:171], v[88:91]
M v[88:91], a[84:87], a[172:175], v[88:91]
M v[92:95], a[92:95], a[172:175], v[92:95]
M v[92:95], a[88:91], a[168:171], v[92:95]
s_waitcnt lgkmcnt(15)
ds_read_b64_tr_b16 a[152:153], v19 offset:32768
ds_read_b64_tr_b16 a[154:155], v19 offset:34816
M v[96:99], a[32:35], a[176:179], v[96:99]
s_add_u32 s24, s24, 262144
s_cmp_eq_u32 s24, s27
s_cselect_b32 s24, s28, s24
s_sub_u32 s6, s6, 1
s_cmp_eq_u32 s6, 0
s_cselect_b64 s[12:13], s[64:65], s[12:13]
M v[96:99], a[36:39], a[180:183], v[96:99]
M v[100:103], a[44:47], a[180:183], v[100:103]
M v[100:103], a[40:43], a[176:179], v[100:103]
M v[104:107], a[48:51], a[176:179], v[104:107]
M v[104:107], a[52:55], a[180:183], v[104:107]
M v[108:111], a[60:63], a[180:183], v[108:111]
M v[108:111], a[56:59], a[176:179], v[108:111]
s_waitcnt vmcnt(17) lgkmcnt(0)
s_barrier
ds_read_b128 a[160:163], v10 offset:16384
ds_read_b128 a[164:167], v11 offset:16384
M v[112:115], a[64:67], a[176:179], v[112:115]
s_add_u32 m0, s29, 0
s_nop 0
buffer_load_dwordx4 v2, s[8:11], s23 offen offset:0 lds
M v[112:115], a[68:71], a[180:183], v[112:115]
M v[116:119], a[76:79], a[180:183], v[116:119]
M v[116:119], a[72:75], a[176:179], v[116:119]
ds_read_b64_tr_b16 a[100:101], v12 offset:49152
ds_read_b64_tr_b16 a[102:103], v12 offset:51200
M v[120:123], a[80:83], a[176:179], v[120:123]
M v[120:123], a[84:87], a[180:183], v[120:123]
M v[124:127], a[92:95], a[180:183], v[124:127]
buffer_load_dwordx4 v3, s[8:11], s23 offen offset:1024 lds
M v[124:127], a[88:91], a[176:179], v[124:127]
M v[128:131], a[32:35], a[184:187], v[128:131]
M v[128:131], a[36:39], a[188:191], v[128:131]
ds_read_b128 a[168:171], v10 offset:18432
ds_read_b128 a[172:175], v11 offset:18432
ds_read_b64_tr_b16 a[108:109], v13 offset:49152
ds_read_b64_tr_b16 a[110:111], v13 offset:51200
M v[132:135], a[44:47], a[188:191], v[132:135]
M v[132:135], a[40:43], a[184:187], v[132:135]
M v[136:139], a[48:51], a[184:187], v[136:139]
M v[136:139], a[52:55], a[188:191], v[136:139]
buffer_load_dwordx4 v4, s[8:11], s23 offen offset:2048 lds
M v[140:143], a[60:63], a[188:191], v[140:143]
M v[140:143], a[56:59], a[184:187], v[140:143]
ds_read_b64_tr_b16 a[116:117], v14 offset:49152
ds_read_b64_tr_b16 a[118:119], v14 offset:51200
M v[144:147], a[64:67], a[184:187], v[144:147]
M v[144:147], a[68:71], a[188:191], v[144:147]
M v[148:151], a[76:79], a[188:191], v[148:151]
M v[148:151], a[72:75], a[184:187], v[148:151]
M v[152:155], a[80:83], a[184:187], v[152:155]
buffer_load_dwordx4 v5, s[8:11], s23 offen offset:3072 lds
M v[152:155], a[84:87], a[188:191], v[152:155]
ds_read_b64_tr_b16 a[124:125], v15 offset:49152
ds_read_b64_tr_b16 a[126:127], v15 offset:51200
M v[156:159], a[92:95], a[188:191], v[156:159]
M v[156:159], a[88:91], a[184:187], v[156:159]
s_waitcnt lgkmcnt(10)
M v[160:163], a[32:35], a[160:163], v[160:163]
M v[160:163], a[36:39], a[164:167], v[160:163]
ds_read_b128 a[176:179], v10 offset:20480
ds_read_b128 a[180:183], v11 offset:20480
M v[164:167], a[44:47], a[164:167], v[164:167]
M v[164:167], a[40:43], a[160:163], v[164:167]
ds_read_b64_tr_b16 a[132:133], v16 offset:49152
ds_read_b64_tr_b16 a[134:135], v16 offset:51200
M v[168:171], a[48:51], a[160:163], v[168:171]
M v[168:171], a[52:55], a[164:167], v[168:171]
s_add_u32 m0, s29, 98304
s_nop 0
buffer_load_dwordx4 v6, s[12:15], s24 offen offset:0 lds
M v[172:175], a[60:63], a[164:167], v[172:175]
M v[172:175], a[56:59], a[160:163], v[172:175]
M v[176:179], a[64:67], a[160:163], v[176:179]
M v[176:179], a[68:71], a[164:167], v[176:179]
ds_read_b64_tr_b16 a[140:141], v17 offset:49152
ds_read_b64_tr_b16 a[142:143], v17 offset:51200
M v[180:183], a[76:79], a[164:167], v[180:183]
M v[180:183], a[72:75], a[160:163], v[180:183]
buffer_load_dwordx4 v7, s[12:15], s24 offen offset:1024 lds
M v[184:187], a[80:83], a[160:163], v[184:187]
M v[184:187], a[84:87], a[164:167], v[184:187]
M v[188:191], a[92:95], a[164:167], v[188:191]
M v[188:191], a[88:91], a[160:163], v[188:191]
s_waitcnt lgkmcnt(12)
ds_read_b64_tr_b16 a[148:149], v18 offset:49152
ds_read_b64_tr_b16 a[150:151], v18 offset:51200
M v[192:195], a[32:35], a[168:171], v[192:195]
M v[192:195], a[36:39], a[172:175], v[192:195]
ds_read_b128 a[184:187], v10 offset:22528
ds_read_b128 a[188:191], v11 offset:22528
M v[196:199], a[44:47], a[172:175], v[196:199]
M v[196:199], a[40:43], a[168:171], v[196:199]
buffer_load_dwordx4 v8, s[12:15], s24 offen offset:2048 lds
M v[200:203], a[48:51], a[168:171], v[200:203]
M v[200:203], a[52:55], a[172:175], v[200:203]
ds_read_b64_tr_b16 a[156:157], v19 offset:49152
ds_read_b64_tr_b16 a[158:159], v19 offset:51200
M v[204:207], a[60:63], a[172:175], v[204:207]
M v[204:207], a[56:59], a[168:171], v[204:207]
M v[208:211], a[64:67], a[168:171], v[208:211]
M v[208:211], a[68:71], a[172:175], v[208:211]
buffer_load_dwordx4 v9, s[12:15], s24 offen offset:3072 lds
M v[212:215], a[76:79], a[172:175], v[212:215]
M v[212:215], a[72:75], a[168:171], v[212:215]
M v[216:219], a[80:83], a[168:171], v[216:219]
M v[216:219], a[84:87], a[172:175], v[216:219]
M v[220:223], a[92:95], a[172:175], v[220:223]
s_add_u32 s24, s24, 262144
M v[220:223], a[88:91], a[168:171], v[220:223]
s_waitcnt lgkmcnt(10)
M v[224:227], a[32:35], a[176:179], v[224:227]
M v[224:227], a[36:39], a[180:183], v[224:227]
M v[228:231], a[44:47], a[180:183], v[228:231]
M v[228:231], a[40:43], a[176:179], v[228:231]
M v[232:235], a[48:51], a[176:179], v[232:235]
M v[232:235], a[52:55], a[180:183], v[232:235]
M v[236:239], a[60:63], a[180:183], v[236:239]
M v[236:239], a[56:59], a[176:179], v[236:239]
s_waitcnt vmcnt(17) lgkmcnt(0)
s_barrier
ds_read_b128 a[160:163], v10 offset:32768
ds_read_b128 a[164:167], v11 offset:32768
M v[240:243], a[64:67], a[176:179], v[240:243]
s_add_u32 m0, s29, 16384
s_add_u32 s3, s23, s31
buffer_load_dwordx4 v2, s[8:11], s3 offen offset:0 lds
M v[240:243], a[68:71], a[180:183], v[240:243]
M v[244:247], a[76:79], a[180:183], v[244:247]
M v[244:247], a[72:75], a[176:179], v[244:247]
M v[248:251], a[80:83], a[176:179], v[248:251]
M v[248:251], a[84:87], a[180:183], v[248:251]
buffer_load_dwordx4 v3, s[8:11], s3 offen offset:1024 lds
M v[252:255], a[92:95], a[180:183], v[252:255]
M v[252:255], a[88:91], a[176:179], v[252:255]
M a[0:3], a[32:35], a[184:187], a[0:3]
M a[0:3], a[36:39], a[188:191], a[0:3]
ds_read_b128 a[168:171], v10 offset:34816
ds_read_b128 a[172:175], v11 offset:34816
M a[4:7], a[44:47], a[188:191], a[4:7]
M a[4:7], a[40:43], a[184:187], a[4:7]
M a[8:11], a[48:51], a[184:187], a[8:11]
buffer_load_dwordx4 v4, s[8:11], s3 offen offset:2048 lds
M a[8:11], a[52:55], a[188:191], a[8:11]
M a[12:15], a[60:63], a[188:191], a[12:15]
M a[12:15], a[56:59], a[184:187], a[12:15]
M a[16:19], a[64:67], a[184:187], a[16:19]
M a[16:19], a[68:71], a[188:191], a[16:19]
buffer_load_dwordx4 v5, s[8:11], s3 offen offset:3072 lds
M a[20:23], a[76:79], a[188:191], a[20:23]
M a[20:23], a[72:75], a[184:187], a[20:23]
M a[24:27], a[80:83], a[184:187], a[24:27]
M a[24:27], a[84:87], a[188:191], a[24:27]
M a[28:31], a[92:95], a[188:191], a[28:31]
M a[28:31], a[88:91], a[184:187], a[28:31]
s_waitcnt lgkmcnt(2)
M v[32:35], a[96:99], a[160:163], v[32:35]
s_add_u32 s23, s23, 128
s_cmp_eq_u32 s23, s25
s_cselect_b32 s23, s26, s23
M v[32:35], a[100:103], a[164:167], v[32:35]
ds_read_b128 a[176:179], v10 offset:36864
ds_read_b128 a[180:183], v11 offset:36864
M v[36:39], a[108:111], a[164:167], v[36:39]
M v[36:39], a[104:107], a[160:163], v[36:39]
ds_read_b64_tr_b16 a[32:33], v12 offset:0
ds_read_b64_tr_b16 a[34:35], v12 offset:2048
M v[40:43], a[112:115], a[160:163], v[40:43]
M v[40:43], a[116:119], a[164:167], v[40:43]
M v[44:47], a[124:127], a[164:167], v[44:47]
s_add_u32 m0, s29, 114688
s_nop 0
buffer_load_dwordx4 v6, s[12:15], s24 offen offset:0 lds
M v[44:47], a[120:123], a[160:163], v[44:47]
ds_read_b64_tr_b16 a[40:41], v13 offset:0
ds_read_b64_tr_b16 a[42:43], v13 offset:2048
M v[48:51], a[128:131], a[160:163], v[48:51]
M v[48:51], a[132:135], a[164:167], v[48:51]
M v[52:55], a[140:143], a[164:167], v[52:55]
M v[52:55], a[136:139], a[160:163], v[52:55]
ds_read_b64_tr_b16 a[48:49], v14 offset:0
ds_read_b64_tr_b16 a[50:51], v14 offset:2048
M v[56:59], a[144:147], a[160:163], v[56:59]
M v[56:59], a[148:151], a[164:167], v[56:59]
buffer_load_dwordx4 v7, s[12:15], s24 offen offset:1024 lds
M v[60:63], a[156:159], a[164:167], v[60:63]
M v[60:63], a[152:155], a[160:163], v[60:63]
s_waitcnt lgkmcnt(8)
ds_read_b64_tr_b16 a[56:57], v15 offset:0
ds_read_b64_tr_b16 a[58:59], v15 offset:2048
M v[64:67], a[96:99], a[168:171], v[64:67]
M v[64:67], a[100:103], a[172:175], v[64:67]
ds_read_b128 a[184:187], v10 offset:38912
ds_read_b128 a[188:191], v11 offset:38912
M v[68:71], a[108:111], a[172:175], v[68:71]
M v[68:71], a[104:107], a[168:171], v[68:71]
ds_read_b64_tr_b16 a[64:65], v16 offset:0
ds_read_b64_tr_b16 a[66:67], v16 offset:2048
M v[72:75], a[112:115], a[168:171], v[72:75]
buffer_load_dwordx4 v8, s[12:15], s24 offen offset:2048 lds
M v[72:75], a[116:119], a[172:175], v[72:75]
M v[76:79], a[124:127], a[172:175], v[76:79]
M v[76:79], a[120:123], a[168:171], v[76:79]
ds_read_b64_tr_b16 a[72:73], v17 offset:0
ds_read_b64_tr_b16 a[74:75], v17 offset:2048
M v[80:83], a[128:131], a[168:171], v[80:83]
M v[80:83], a[132:135], a[172:175], v[80:83]
M v[84:87], a[140:143], a[172:175], v[84:87]
buffer_load_dwordx4 v9, s[12:15], s24 offen offset:3072 lds
M v[84:87], a[136:139], a[168:171], v[84:87]
ds_read_b64_tr_b16 a[80:81], v18 offset:0
ds_read_b64_tr_b16 a[82:83], v18 offset:2048
M v[88:91], a[144:147], a[168:171], v[88:91]
M v[88:91], a[148:151], a[172:175], v[88:91]
M v[92:95], a[156:159], a[172:175], v[92:95]
M v[92:95], a[152:155], a[168:171], v[92:95]
s_waitcnt lgkmcnt(15)
ds_read_b64_tr_b16 a[88:89], v19 offset:0
ds_read_b64_tr_b16 a[90:91], v19 offset:2048
M v[96:99], a[96:99], a[176:179], v[96:99]
s_add_u32 s24, s24, 262144
s_cmp_eq_u32 s24, s27
s_cselect_b32 s24, s28, s24
s_sub_u32 s6, s6, 1
s_cmp_eq_u32 s6, 0
s_cselect_b64 s[12:13], s[64:65], s[12:13]
M v[96:99], a[100:103], a[180:183], v[96:99]
M v[100:103], a[108:111], a[180:183], v[100:103]
M v[100:103], a[104:107], a[176:179], v[100:103]
M v[104:107], a[112:115], a[176:179], v[104:107]
M v[104:107], a[116:119], a[180:183], v[104:107]
M v[108:111], a[124:127], a[180:183], v[108:111]
M v[108:111], a[120:123], a[176:179], v[108:111]
s_waitcnt vmcnt(16) lgkmcnt(0)
s_barrier
ds_read_b128 a[160:163], v10 offset:49152
ds_read_b128 a[164:167], v11 offset:49152
M v[112:115], a[128:131], a[176:179], v[112:115]
s_add_u32 m0, s29, 32768
s_nop 0
buffer_load_dwordx4 v2, s[8:11], s23 offen offset:0 lds
M v[112:115], a[132:135], a[180:183], v[112:115]
M v[116:119], a[140:143], a[180:183], v[116:119]
M v[116:119], a[136:139], a[176:179], v[116:119]
ds_read_b64_tr_b16 a[36:37], v12 offset:16384
ds_read_b64_tr_b16 a[38:39], v12 offset:18432
M v[120:123], a[144:147], a[176:179], v[120:123]
M v[120:123], a[148:151], a[180:183], v[120:123]
M v[124:127], a[156:159], a[180:183], v[124:127]
M v[124:127], a[152:155], a[176:179], v[124:127]
M v[128:131], a[96:99], a[184:187], v[128:131]
M v[128:131], a[100:103], a[188:191], v[128:131]
ds_read_b128 a[168:171], v10 offset:51200
ds_read_b128 a[172:175], v11 offset:51200
ds_read_b64_tr_b16 a[44:45], v13 offset:16384
ds_read_b64_tr_b16 a[46:47], v13 offset:18432
M v[132:135], a[108:111], a[188:191], v[132:135]
M v[132:135], a[104:107], a[184:187], v[132:135]
M v[136:139], a[112:115], a[184:187], v[136:139]
M v[136:139], a[116:119], a[188:191], v[136:139]
M v[140:143], a[124:127], a[188:191], v[140:143]
M v[140:143], a[120:123], a[184:187], v[140:143]
ds_read_b64_tr_b16 a[52:53], v14 offset:16384
ds_read_b64_tr_b16 a[54:55], v14 offset:18432
M v[144:147], a[128:131], a[184:187], v[144:147]
buffer_load_dwordx4 v3, s[8:11], s23 offen offset:1024 lds
M v[144:147], a[132:135], a[188:191], v[144:147]
M v[148:151], a[140:143], a[188:191], v[148:151]
M v[148:151], a[136:139], a[184:187], v[148:151]
M v[152:155], a[144:147], a[184:187], v[152:155]
M v[152:155], a[148:151], a[188:191], v[152:155]
ds_read_b64_tr_b16 a[60:61], v15 offset:16384
ds_read_b64_tr_b16 a[62:63], v15 offset:18432
M v[156:159], a[156:159], a[188:191], v[156:159]
M v[156:159], a[152:155], a[184:187], v[156:159]
s_waitcnt lgkmcnt(10)
M v[160:163], a[96:99], a[160:163], v[160:163]
M v[160:163], a[100:103], a[164:167], v[160:163]
ds_read_b128 a[176:179], v10 offset:53248
ds_read_b128 a[180:183], v11 offset:53248
M v[164:167], a[108:111], a[164:167], v[164:167]
M v[164:167], a[104:107], a[160:163], v[164:167]
ds_read_b64_tr_b16 a[68:69], v16 offset:16384
ds_read_b64_tr_b16 a[70:71], v16 offset:18432
M v[168:171], a[112:115], a[160:163], v[168:171]
M v[168:171], a[116:119], a[164:167], v[168:171]
M v[172:175], a[124:127], a[164:167], v[172:175]
M v[172:175], a[120:123], a[160:163], v[172:175]
M v[176:179], a[128:131], a[160:163], v[176:179]
buffer_load_dwordx4 v4, s[8:11], s23 offen offset:2048 lds
M v[176:179], a[132:135], a[164:167], v[176:179]
ds_read_b64_tr_b16 a[76:77], v17 offset:16384
ds_read_b64_tr_b16 a[78:79], v17 offset:18432
M v[180:183], a[140:143], a[164:167], v[180:183]
M v[180:183], a[136:139], a[160:163], v[180:183]
M v[184:187], a[144:147], a[160:163], v[184:187]
M v[184:187], a[148:151], a[164:167], v[184:187]
M v[188:191], a[156:159], a[164:167], v[188:191]
M v[188:191], a[152:155], a[160:163], v[188:191]
s_waitcnt lgkmcnt(12)
ds_read_b64_tr_b16 a[84:85], v18 offset:16384
ds_read_b64_tr_b16 a[86:87], v18 offset:18432
M v[192:195], a[96:99], a[168:171], v[192:195]
M v[192:195], a[100:103], a[172:175], v[192:195]
ds_read_b128 a[184:187], v10 offset:55296
ds_read_b128 a[188:191], v11 offset:55296
M v[196:199], a[108:111], a[172:175], v[196:199]
M v[196:199], a[104:107], a[168:171], v[196:199]
M v[200:203], a[112:115], a[168:171], v[200:203]
M v[200:203], a[116:119], a[172:175], v[200:203]
ds_read_b64_tr_b16 a[92:93], v19 offset:16384
ds_read_b64_tr_b16 a[94:95], v19 offset:18432
M v[204:207], a[124:127], a[172:175], v[204:207]
M v[204:207], a[120:123], a[168:171], v[204:207]
M v[208:211], a[128:131], a[168:171], v[208:211]
buffer_load_dwordx4 v5, s[8:11], s23 offen offset:3072 lds
M v[208:211], a[132:135], a[172:175], v[208:211]
M v[212:215], a[140:143], a[172:175], v[212:215]
M v[212:215], a[136:139], a[168:171], v[212:215]
M v[216:219], a[144:147], a[168:171], v[216:219]
M v[216:219], a[148:151], a[172:175], v[216:219]
M v[220:223], a[156:159], a[172:175], v[220:223]
M v[220:223], a[152:155], a[168:171], v[220:223]
s_waitcnt lgkmcnt(10)
M v[224:227], a[96:99], a[176:179], v[224:227]
M v[224:227], a[100:103], a[180:183], v[224:227]
M v[228:231], a[108:111], a[180:183], v[228:231]
M v[228:231], a[104:107], a[176:179], v[228:231]
M v[232:235], a[112:115], a[176:179], v[232:235]
M v[232:235], a[116:119], a[180:183], v[232:235]
M v[236:239], a[124:127], a[180:183], v[236:239]
M v[236:239], a[120:123], a[176:179], v[236:239]
s_waitcnt vmcnt(12) lgkmcnt(0)
s_barrier
ds_read_b128 a[160:163], v10 offset:0
ds_read_b128 a[164:167], v11 offset:0
M v[240:243], a[128:131], a[176:179], v[240:243]
s_add_u32 m0, s29, 49152
s_add_u32 s3, s23, s31
buffer_load_dwordx4 v2, s[8:11], s3 offen offset:0 lds
M v[240:243], a[132:135], a[180:183], v[240:243]
M v[244:247], a[140:143], a[180:183], v[244:247]
M v[244:247], a[136:139], a[176:179], v[244:247]
M v[248:251], a[144:147], a[176:179], v[248:251]
M v[248:251], a[148:151], a[180:183], v[248:251]
M v[252:255], a[156:159], a[180:183], v[252:255]
M v[252:255], a[152:155], a[176:179], v[252:255]
M a[0:3], a[96:99], a[184:187], a[0:3]
M a[0:3], a[100:103], a[188:191], a[0:3]
ds_read_b128 a[168:171], v10 offset:2048
ds_read_b128 a[172:175], v11 offset:2048
M a[4:7], a[108:111], a[188:191], a[4:7]
M a[4:7], a[104:107], a[184:187], a[4:7]
M a[8:11], a[112:115], a[184:187], a[8:11]
buffer_load_dwordx4 v3, s[8:11], s3 offen offset:1024 lds
M a[8:11], a[116:119], a[188:191], a[8:11]
M a[12:15], a[124:127], a[188:191], a[12:15]
M a[12:15], a[120:123], a[184:187], a[12:15]
M a[16:19], a[128:131], a[184:187], a[16:19]
M a[16:19], a[132:135], a[188:191], a[16:19]
M a[20:23], a[140:143], a[188:191], a[20:23]
M a[20:23], a[136:139], a[184:187], a[20:23]
M a[24:27], a[144:147], a[184:187], a[24:27]
M a[24:27], a[148:151], a[188:191], a[24:27]
M a[28:31], a[156:159], a[188:191], a[28:31]
M a[28:31], a[152:155], a[184:187], a[28:31]
s_waitcnt lgkmcnt(2)
M v[32:35], a[32:35], a[160:163], v[32:35]
buffer_load_dwordx4 v4, s[8:11], s3 offen offset:2048 lds
M v[32:35], a[36:39], a[164:167], v[32:35]
ds_read_b128 a[176:179], v10 offset:4096
ds_read_b128 a[180:183], v11 offset:4096
M v[36:39], a[44:47], a[164:167], v[36:39]
M v[36:39], a[40:43], a[160:163], v[36:39]
ds_read_b64_tr_b16 a[96:97], v12 offset:32768
ds_read_b64_tr_b16 a[98:99], v12 offset:34816
M v[40:43], a[48:51], a[160:163], v[40:43]
M v[40:43], a[52:55], a[164:167], v[40:43]
M v[44:47], a[60:63], a[164:167], v[44:47]
M v[44:47], a[56:59], a[160:163], v[44:47]
ds_read_b64_tr_b16 a[104:105], v13 offset:32768
ds_read_b64_tr_b16 a[106:107], v13 offset:34816
M v[48:51], a[64:67], a[160:163], v[48:51]
M v[48:51], a[68:71], a[164:167], v[48:51]
M v[52:55], a[76:79], a[164:167], v[52:55]
M v[52:55], a[72:75], a[160:163], v[52:55]
ds_read_b64_tr_b16 a[112:113], v14 offset:32768
ds_read_b64_tr_b16 a[114:115], v14 offset:34816
M v[56:59], a[80:83], a[160:163], v[56:59]
M v[56:59], a[84:87], a[164:167], v[56:59]
buffer_load_dwordx4 v5, s[8:11], s3 offen offset:3072 lds
M v[60:63], a[92:95], a[164:167], v[60:63]
M v[60:63], a[88:91], a[160:163], v[60:63]
s_waitcnt lgkmcnt(8)
ds_read_b64_tr_b16 a[120:121], v15 offset:32768
ds_read_b64_tr_b16 a[122:123], v15 offset:34816
M v[64:67], a[32:35], a[168:171], v[64:67]
M v[64:67], a[36:39], a[172:175], v[64:67]
ds_read_b128 a[184:187], v10 offset:6144
ds_read_b128 a[188:191], v11 offset:6144
M v[68:71], a[44:47], a[172:175], v[68:71]
M v[68:71], a[40:43], a[168:171], v[68:71]
ds_read_b64_tr_b16 a[128:129], v16 offset:32768
ds_read_b64_tr_b16 a[130:131], v16 offset:34816
M v[72:75], a[48:51], a[168:171], v[72:75]
M v[72:75], a[52:55], a[172:175], v[72:75]
M v[76:79], a[60:63], a[172:175], v[76:79]
M v[76:79], a[56:59], a[168:171], v[76:79]
ds_read_b64_tr_b16 a[136:137], v17 offset:32768
ds_read_b64_tr_b16 a[138:139], v17 offset:34816
M v[80:83], a[64:67], a[168:171], v[80:83]
M v[80:83], a[68:71], a[172:175], v[80:83]
M v[84:87], a[76:79], a[172:175], v[84:87]
s_add_u32 s23, s23, 128
s_cmp_eq_u32 s23, s25
s_cselect_b32 s23, s26, s23
M v[84:87], a[72:75], a[168:171], v[84:87]
ds_read_b64_tr_b16 a[144:145], v18 offset:32768
ds_read_b64_tr_b16 a[146:147], v18 offset:34816
M v[88:91], a[80:83], a[168:171], v[88:91]
M v[88:91], a[84:87], a[172:175], v[88:91]
M v[92:95], a[92:95], a[172:175], v[92:95]
M v[92:95], a[88:91], a[168:171], v[92:95]
s_waitcnt lgkmcnt(15)
ds_read_b64_tr_b16 a[152:153], v19 offset:32768
ds_read_b64_tr_b16 a[154:155], v19 offset:34816
M v[96:99], a[32:35], a[176:179], v[96:99]
M v[96:99], a[36:39], a[180:183], v[96:99]
M v[100:103], a[44:47], a[180:183], v[100:103]
M v[100:103], a[40:43], a[176:179], v[100:103]
M v[104:107], a[48:51], a[176:179], v[104:107]
M v[104:107], a[52:55], a[180:183], v[104:107]
M v[108:111], a[60:63], a[180:183], v[108:111]
M v[108:111], a[56:59], a[176:179], v[108:111]
s_waitcnt vmcnt(8) lgkmcnt(0)
s_barrier
ds_read_b128 a[160:163], v10 offset:16384
ds_read_b128 a[164:167], v11 offset:16384
M v[112:115], a[64:67], a[176:179], v[112:115]
M v[112:115], a[68:71], a[180:183], v[112:115]
s_and_b32 s3, s2, 1
s_lshl_b32 s3, s3, 3
s_bfe_u32 s4, s2, 0x30003
M v[116:119], a[76:79], a[180:183], v[116:119]
s_add_u32 s26, s3, s4
s_bfe_u32 s3, s2, 0x20001
s_lshl_b32 s3, s3, 2
M v[116:119], a[72:75], a[176:179], v[116:119]
ds_read_b64_tr_b16 a[100:101], v12 offset:49152
ds_read_b64_tr_b16 a[102:103], v12 offset:51200
s_lshr_b32 s4, s2, 6
s_xor_b32 s4, s4, 2
s_add_u32 s27, s3, s4
M v[120:123], a[80:83], a[176:179], v[120:123]
s_lshl_b32 s23, s26, 18
s_sub_u32 s24, s23, 32768
M v[120:123], a[84:87], a[180:183], v[120:123]
s_max_i32 s24, s24, 0
s_lshl_b32 s25, s27, 7
s_add_u32 s3, s26, s27
M v[124:127], a[92:95], a[180:183], v[124:127]
s_and_b32 s3, s3, 0
s_mul_i32 s3, s3, 16
s_sub_u32 s31, 16, s3
M v[124:127], a[88:91], a[176:179], v[124:127]
s_mov_b32 s54, s31
s_movk_i32 s57, 128
s_mov_b32 s55, 4289069056
M v[128:131], a[32:35], a[184:187], v[128:131]
s_mov_b32 s56, 393216
s_lshl_b32 s4, s3, 7
M v[128:131], a[36:39], a[188:191], v[128:131]
ds_read_b128 a[168:171], v10 offset:18432
ds_read_b128 a[172:175], v11 offset:18432
ds_read_b64_tr_b16 a[108:109], v13 offset:49152
ds_read_b64_tr_b16 a[110:111], v13 offset:51200
s_add_u32 s23, s23, s4
s_add_u32 s24, s24, s4
s_mul_i32 s4, s3, 393216
M v[132:135], a[44:47], a[188:191], v[132:135]
s_add_u32 s25, s25, s4
s_mov_b64 s[8:9], s[44:45]
s_mov_b32 s10, 4194304
M v[132:135], a[40:43], a[184:187], v[132:135]
s_mov_b64 s[12:13], s[46:47]
s_mov_b32 s14, 6291456
M v[136:139], a[48:51], a[184:187], v[136:139]
s_mov_b64 s[36:37], s[90:91]
s_mov_b32 s38, 256
s_mov_b32 s39, 0x00020000
M v[136:139], a[52:55], a[188:191], v[136:139]
s_lshl_b32 s28, s20, 9
s_mul_i32 s30, s20, 6144
s_lshl_b32 s3, s20, 5
M v[140:143], a[60:63], a[188:191], v[140:143]
v_lshrrev_b32 v24, 3, v0
v_and_b32 v25, 7, v0
v_add_u32 v28, s3, v24
M v[140:143], a[56:59], a[184:187], v[140:143]
ds_read_b64_tr_b16 a[116:117], v14 offset:49152
ds_read_b64_tr_b16 a[118:119], v14 offset:51200
v_add_u32 v26, 0, v28
v_bfe_u32 v27, v26, 1, 3
M v[144:147], a[64:67], a[184:187], v[144:147]
v_xor_b32 v27, v27, v25
v_lshlrev_b32 v26, 11, v26
v_lshl_add_u32 v26, v27, 4, v26
M v[144:147], a[68:71], a[188:191], v[144:147]
v_subrev_u32 v2, 0, v26
v_add_u32 v26, 8, v28
v_bfe_u32 v27, v26, 1, 3
M v[148:151], a[76:79], a[188:191], v[148:151]
v_xor_b32 v27, v27, v25
v_lshlrev_b32 v26, 11, v26
v_lshl_add_u32 v26, v27, 4, v26
M v[148:151], a[72:75], a[184:187], v[148:151]
v_subrev_u32 v3, 1024, v26
v_add_u32 v26, 16, v28
M v[152:155], a[80:83], a[184:187], v[152:155]
v_bfe_u32 v27, v26, 1, 3
v_xor_b32 v27, v27, v25
v_lshlrev_b32 v26, 11, v26
M v[152:155], a[84:87], a[188:191], v[152:155]
ds_read_b64_tr_b16 a[124:125], v15 offset:49152
ds_read_b64_tr_b16 a[126:127], v15 offset:51200
v_lshl_add_u32 v26, v27, 4, v26
v_subrev_u32 v4, 2048, v26
v_add_u32 v26, 24, v28
M v[156:159], a[92:95], a[188:191], v[156:159]
v_bfe_u32 v27, v26, 1, 3
v_xor_b32 v27, v27, v25
M v[156:159], a[88:91], a[184:187], v[156:159]
s_waitcnt lgkmcnt(10)
v_lshlrev_b32 v26, 11, v26
v_lshl_add_u32 v26, v27, 4, v26
v_subrev_u32 v5, 3072, v26
M v[160:163], a[32:35], a[160:163], v[160:163]
s_lshl_b32 s3, s20, 2
v_lshrrev_b32 v26, 5, v0
v_add_u32 v26, s3, v26
M v[160:163], a[36:39], a[164:167], v[160:163]
ds_read_b128 a[176:179], v10 offset:20480
ds_read_b128 a[180:183], v11 offset:20480
v_bfe_u32 v29, v0, 2, 3
v_bfe_u32 v27, v26, 1, 3
v_xor_b32 v27, v27, v29
M v[164:167], a[44:47], a[164:167], v[164:167]
v_lshlrev_b32 v27, 4, v27
v_and_b32 v30, 3, v0
M v[164:167], a[40:43], a[160:163], v[164:167]
ds_read_b64_tr_b16 a[132:133], v16 offset:49152
ds_read_b64_tr_b16 a[134:135], v16 offset:51200
v_lshl_add_u32 v27, v30, 2, v27
v_lshl_add_u32 v20, v26, 11, v27
v_add_u32 v26, 2, v26
M v[168:171], a[48:51], a[160:163], v[168:171]
v_bfe_u32 v27, v26, 1, 3
v_xor_b32 v27, v27, v29
v_lshlrev_b32 v27, 4, v27
M v[168:171], a[52:55], a[164:167], v[168:171]
v_and_b32 v30, 3, v0
v_lshl_add_u32 v27, v30, 2, v27
M v[172:175], a[60:63], a[164:167], v[172:175]
v_lshl_add_u32 v23, v26, 11, v27
v_subrev_u32 v23, 256, v23
s_mul_i32 s3, s20, 48
M v[172:175], a[56:59], a[160:163], v[172:175]
v_add_u32 v28, s3, v24
v_add_u32 v26, 0, v28
v_mul_u32_u24 v27, 0xaaab, v26
M v[176:179], a[64:67], a[160:163], v[176:179]
v_lshrrev_b32 v27, 17, v27
v_lshrrev_b32 v29, 1, v27
v_and_b32 v29, 4, v29
M v[176:179], a[68:71], a[164:167], v[176:179]
ds_read_b64_tr_b16 a[140:141], v17 offset:49152
ds_read_b64_tr_b16 a[142:143], v17 offset:51200
v_and_or_b32 v27, v27, 2, v29
v_xor_b32 v27, v27, v25
M v[180:183], a[76:79], a[164:167], v[180:183]
v_lshlrev_b32 v26, 11, v26
v_lshl_add_u32 v26, v27, 4, v26
v_subrev_u32 v6, 0, v26
M v[180:183], a[72:75], a[160:163], v[180:183]
v_add_u32 v26, 8, v28
v_mul_u32_u24 v27, 0xaaab, v26
v_lshrrev_b32 v27, 17, v27
M v[184:187], a[80:83], a[160:163], v[184:187]
v_lshrrev_b32 v29, 1, v27
v_and_b32 v29, 4, v29
v_and_or_b32 v27, v27, 2, v29
M v[184:187], a[84:87], a[164:167], v[184:187]
v_xor_b32 v27, v27, v25
v_lshlrev_b32 v26, 11, v26
M v[188:191], a[92:95], a[164:167], v[188:191]
v_lshl_add_u32 v26, v27, 4, v26
v_subrev_u32 v7, 1024, v26
v_add_u32 v26, 16, v28
M v[188:191], a[88:91], a[160:163], v[188:191]
s_waitcnt lgkmcnt(12)
ds_read_b64_tr_b16 a[148:149], v18 offset:49152
ds_read_b64_tr_b16 a[150:151], v18 offset:51200
v_mul_u32_u24 v27, 0xaaab, v26
v_lshrrev_b32 v27, 17, v27
v_lshrrev_b32 v29, 1, v27
M v[192:195], a[32:35], a[168:171], v[192:195]
v_and_b32 v29, 4, v29
v_and_or_b32 v27, v27, 2, v29
M v[192:195], a[36:39], a[172:175], v[192:195]
ds_read_b128 a[184:187], v10 offset:22528
ds_read_b128 a[188:191], v11 offset:22528
v_xor_b32 v27, v27, v25
v_lshlrev_b32 v26, 11, v26
v_lshl_add_u32 v26, v27, 4, v26
M v[196:199], a[44:47], a[172:175], v[196:199]
v_subrev_u32 v8, 2048, v26
v_add_u32 v26, 24, v28
v_mul_u32_u24 v27, 0xaaab, v26
M v[196:199], a[40:43], a[168:171], v[196:199]
v_lshrrev_b32 v27, 17, v27
v_lshrrev_b32 v29, 1, v27
v_and_b32 v29, 4, v29
M v[200:203], a[48:51], a[168:171], v[200:203]
v_and_or_b32 v27, v27, 2, v29
v_xor_b32 v27, v27, v25
M v[200:203], a[52:55], a[172:175], v[200:203]
ds_read_b64_tr_b16 a[156:157], v19 offset:49152
ds_read_b64_tr_b16 a[158:159], v19 offset:51200
v_lshlrev_b32 v26, 11, v26
v_lshl_add_u32 v26, v27, 4, v26
v_subrev_u32 v9, 3072, v26
M v[204:207], a[60:63], a[172:175], v[204:207]
v_add_u32 v26, 32, v28
v_mul_u32_u24 v27, 0xaaab, v26
v_lshrrev_b32 v27, 17, v27
M v[204:207], a[56:59], a[168:171], v[204:207]
v_lshrrev_b32 v29, 1, v27
v_and_b32 v29, 4, v29
v_and_or_b32 v27, v27, 2, v29
M v[208:211], a[64:67], a[168:171], v[208:211]
v_xor_b32 v27, v27, v25
v_lshlrev_b32 v26, 11, v26
M v[208:211], a[68:71], a[172:175], v[208:211]
v_lshl_add_u32 v26, v27, 4, v26
v_subrev_u32 v21, 0, v26
v_add_u32 v26, 40, v28
M v[212:215], a[76:79], a[172:175], v[212:215]
v_mul_u32_u24 v27, 0xaaab, v26
v_lshrrev_b32 v27, 17, v27
v_lshrrev_b32 v29, 1, v27
M v[212:215], a[72:75], a[168:171], v[212:215]
v_and_b32 v29, 4, v29
v_and_or_b32 v27, v27, 2, v29
M v[216:219], a[80:83], a[168:171], v[216:219]
v_xor_b32 v27, v27, v25
v_lshlrev_b32 v26, 11, v26
v_lshl_add_u32 v26, v27, 4, v26
M v[216:219], a[84:87], a[172:175], v[216:219]
v_subrev_u32 v22, 1024, v26
s_lshr_b32 s3, s53, 7
s_add_u32 s3, s3, s22
M v[220:223], a[92:95], a[172:175], v[220:223]
s_lshl_b32 s3, s3, 5
s_lshr_b32 s19, s52, 6
s_add_u32 s3, s3, s19
M v[220:223], a[88:91], a[168:171], v[220:223]
s_waitcnt lgkmcnt(10)
s_lshl_b32 s19, s21, 1
s_add_u32 s3, s3, s19
M v[224:227], a[32:35], a[176:179], v[224:227]
s_lshl_b32 s92, s3, 14
s_add_u32 s93, s92, 16384
s_add_u32 s16, s50, 0
M v[224:227], a[36:39], a[180:183], v[224:227]
s_addc_u32 s17, s51, 0
s_mov_b32 s18, 16777216
s_mov_b32 s19, 0x00020000
M v[228:231], a[44:47], a[180:183], v[228:231]
s_mov_b32 s4, 0x3e0293ee
s_mov_b32 s5, 0x3e0293ee
M v[228:231], a[40:43], a[176:179], v[228:231]
M v[232:235], a[48:51], a[176:179], v[232:235]
M v[232:235], a[52:55], a[180:183], v[232:235]
M v[236:239], a[60:63], a[180:183], v[236:239]
M v[236:239], a[56:59], a[176:179], v[236:239]
s_waitcnt vmcnt(4) lgkmcnt(0)
s_barrier
ds_read_b128 a[160:163], v10 offset:32768
ds_read_b128 a[164:167], v11 offset:32768
M v[240:243], a[64:67], a[176:179], v[240:243]
s_add_u32 m0, s28, 131072
s_nop 0
buffer_load_dword v20, s[8:11], s24 offen lds
M v[240:243], a[68:71], a[180:183], v[240:243]
M v[244:247], a[76:79], a[180:183], v[244:247]
M v[244:247], a[72:75], a[176:179], v[244:247]
buffer_load_dword v23, s[8:11], s24 offen offset:256 lds
M v[248:251], a[80:83], a[176:179], v[248:251]
M v[248:251], a[84:87], a[180:183], v[248:251]
M v[252:255], a[92:95], a[180:183], v[252:255]
M v[252:255], a[88:91], a[176:179], v[252:255]
M a[0:3], a[32:35], a[184:187], a[0:3]
s_add_u32 m0, s29, 133120
s_nop 0
buffer_load_dwordx4 v2, s[8:11], s23 offen offset:0 lds
M a[0:3], a[36:39], a[188:191], a[0:3]
ds_read_b128 a[168:171], v10 offset:34816
ds_read_b128 a[172:175], v11 offset:34816
M a[4:7], a[44:47], a[188:191], a[4:7]
M a[4:7], a[40:43], a[184:187], a[4:7]
M a[8:11], a[48:51], a[184:187], a[8:11]
buffer_load_dwordx4 v3, s[8:11], s23 offen offset:1024 lds
M a[8:11], a[52:55], a[188:191], a[8:11]
M a[12:15], a[60:63], a[188:191], a[12:15]
M a[12:15], a[56:59], a[184:187], a[12:15]
M a[16:19], a[64:67], a[184:187], a[16:19]
buffer_load_dwordx4 v4, s[8:11], s23 offen offset:2048 lds
M a[16:19], a[68:71], a[188:191], a[16:19]
M a[20:23], a[76:79], a[188:191], a[20:23]
M a[20:23], a[72:75], a[184:187], a[20:23]
buffer_load_dwordx4 v5, s[8:11], s23 offen offset:3072 lds
M a[24:27], a[80:83], a[184:187], a[24:27]
M a[24:27], a[84:87], a[188:191], a[24:27]
M a[28:31], a[92:95], a[188:191], a[28:31]
M a[28:31], a[88:91], a[184:187], a[28:31]
s_waitcnt lgkmcnt(2)
M v[32:35], a[96:99], a[160:163], v[32:35]
s_sub_u32 s31, s31, 1
s_cmp_eq_u32 s31, 0
s_cselect_b32 s58, -1920, s57
s_add_u32 s23, s23, s58
s_add_u32 s24, s24, s58
M v[32:35], a[100:103], a[164:167], v[32:35]
ds_read_b128 a[176:179], v10 offset:36864
ds_read_b128 a[180:183], v11 offset:36864
M v[36:39], a[108:111], a[164:167], v[36:39]
M v[36:39], a[104:107], a[160:163], v[36:39]
M v[40:43], a[112:115], a[160:163], v[40:43]
M v[40:43], a[116:119], a[164:167], v[40:43]
s_add_u32 m0, s30, 65536
s_nop 0
buffer_load_dwordx4 v6, s[12:15], s25 offen offset:0 lds
M v[44:47], a[124:127], a[164:167], v[44:47]
M v[44:47], a[120:123], a[160:163], v[44:47]
M v[48:51], a[128:131], a[160:163], v[48:51]
M v[48:51], a[132:135], a[164:167], v[48:51]
buffer_load_dwordx4 v7, s[12:15], s25 offen offset:1024 lds
M v[52:55], a[140:143], a[164:167], v[52:55]
M v[52:55], a[136:139], a[160:163], v[52:55]
M v[56:59], a[144:147], a[160:163], v[56:59]
M v[56:59], a[148:151], a[164:167], v[56:59]
buffer_load_dwordx4 v8, s[12:15], s25 offen offset:2048 lds
M v[60:63], a[156:159], a[164:167], v[60:63]
M v[60:63], a[152:155], a[160:163], v[60:63]
s_waitcnt lgkmcnt(2)
M v[64:67], a[96:99], a[168:171], v[64:67]
M v[64:67], a[100:103], a[172:175], v[64:67]
ds_read_b128 a[184:187], v10 offset:38912
ds_read_b128 a[188:191], v11 offset:38912
M v[68:71], a[108:111], a[172:175], v[68:71]
M v[68:71], a[104:107], a[168:171], v[68:71]
buffer_load_dwordx4 v9, s[12:15], s25 offen offset:3072 lds
v_pk_mul_f32 v[32:33], v[32:33], s[4:5]
v_pk_mul_f32 v[34:35], v[34:35], s[4:5]
v_pk_mul_f32 v[36:37], v[36:37], s[4:5]
M v[72:75], a[112:115], a[168:171], v[72:75]
v_pk_mul_f32 v[38:39], v[38:39], s[4:5]
v_cvt_pk_bf16_f32 v32, v32, v33
M v[72:75], a[116:119], a[172:175], v[72:75]
v_cvt_pk_bf16_f32 v33, v34, v35
v_cvt_pk_bf16_f32 v34, v36, v37
M v[76:79], a[124:127], a[172:175], v[76:79]
v_cvt_pk_bf16_f32 v35, v38, v39
v_pk_mul_f32 v[40:41], v[40:41], s[4:5]
v_pk_mul_f32 v[42:43], v[42:43], s[4:5]
M v[76:79], a[120:123], a[168:171], v[76:79]
s_add_u32 m0, s30, 69632
s_nop 0
buffer_load_dwordx4 v21, s[12:15], s25 offen offset:0 lds
v_pk_mul_f32 v[44:45], v[44:45], s[4:5]
v_pk_mul_f32 v[46:47], v[46:47], s[4:5]
M v[80:83], a[128:131], a[168:171], v[80:83]
v_cvt_pk_bf16_f32 v40, v40, v41
v_cvt_pk_bf16_f32 v41, v42, v43
M v[80:83], a[132:135], a[172:175], v[80:83]
v_cvt_pk_bf16_f32 v42, v44, v45
v_cvt_pk_bf16_f32 v43, v46, v47
M v[84:87], a[140:143], a[172:175], v[84:87]
v_pk_mul_f32 v[48:49], v[48:49], s[4:5]
v_pk_mul_f32 v[50:51], v[50:51], s[4:5]
v_pk_mul_f32 v[52:53], v[52:53], s[4:5]
M v[84:87], a[136:139], a[168:171], v[84:87]
buffer_load_dwordx4 v22, s[12:15], s25 offen offset:1024 lds
v_pk_mul_f32 v[54:55], v[54:55], s[4:5]
v_cvt_pk_bf16_f32 v48, v48, v49
M v[88:91], a[144:147], a[168:171], v[88:91]
v_cvt_pk_bf16_f32 v49, v50, v51
v_cvt_pk_bf16_f32 v50, v52, v53
M v[88:91], a[148:151], a[172:175], v[88:91]
v_cvt_pk_bf16_f32 v51, v54, v55
v_pk_mul_f32 v[56:57], v[56:57], s[4:5]
v_pk_mul_f32 v[58:59], v[58:59], s[4:5]
M v[92:95], a[156:159], a[172:175], v[92:95]
v_pk_mul_f32 v[60:61], v[60:61], s[4:5]
v_pk_mul_f32 v[62:63], v[62:63], s[4:5]
M v[92:95], a[152:155], a[168:171], v[92:95]
s_waitcnt lgkmcnt(2)
v_cvt_pk_bf16_f32 v56, v56, v57
v_cvt_pk_bf16_f32 v57, v58, v59
M v[96:99], a[96:99], a[176:179], v[96:99]
s_sub_u32 s54, s54, 1
s_cmp_eq_u32 s54, 0
s_cselect_b32 s58, s55, s56
s_add_u32 s25, s25, s58
v_cvt_pk_bf16_f32 v58, v60, v61
v_cvt_pk_bf16_f32 v59, v62, v63
M v[96:99], a[100:103], a[180:183], v[96:99]
M v[100:103], a[108:111], a[180:183], v[100:103]
M v[100:103], a[104:107], a[176:179], v[100:103]
v_pk_mul_f32 v[64:65], v[64:65], s[4:5]
v_pk_mul_f32 v[66:67], v[66:67], s[4:5]
v_pk_mul_f32 v[68:69], v[68:69], s[4:5]
M v[104:107], a[112:115], a[176:179], v[104:107]
s_add_u32 s94, s92, 0
buffer_store_dwordx4 v[32:35], v1, s[16:19], s94 offen offset:0 sc1
v_pk_mul_f32 v[70:71], v[70:71], s[4:5]
v_cvt_pk_bf16_f32 v64, v64, v65
M v[104:107], a[116:119], a[180:183], v[104:107]
v_cvt_pk_bf16_f32 v65, v66, v67
v_cvt_pk_bf16_f32 v66, v68, v69
M v[108:111], a[124:127], a[180:183], v[108:111]
v_cvt_pk_bf16_f32 v67, v70, v71
v_pk_mul_f32 v[72:73], v[72:73], s[4:5]
v_pk_mul_f32 v[74:75], v[74:75], s[4:5]
M v[108:111], a[120:123], a[176:179], v[108:111]
s_waitcnt vmcnt(13) lgkmcnt(0)
s_barrier
ds_read_b128 a[160:163], v10 offset:49152
ds_read_b128 a[164:167], v11 offset:49152
v_pk_mul_f32 v[76:77], v[76:77], s[4:5]
v_pk_mul_f32 v[78:79], v[78:79], s[4:5]
M v[112:115], a[128:131], a[176:179], v[112:115]
s_add_u32 m0, s28, 0
s_nop 0
buffer_load_dword v20, s[8:11], s24 offen lds
v_cvt_pk_bf16_f32 v72, v72, v73
v_cvt_pk_bf16_f32 v73, v74, v75
M v[112:115], a[132:135], a[180:183], v[112:115]
v_cvt_pk_bf16_f32 v74, v76, v77
v_cvt_pk_bf16_f32 v75, v78, v79
M v[116:119], a[140:143], a[180:183], v[116:119]
s_add_u32 s94, s92, 0
buffer_store_dwordx4 v[40:43], v1, s[16:19], s94 offen offset:1024 sc1
v_pk_mul_f32 v[80:81], v[80:81], s[4:5]
v_pk_mul_f32 v[82:83], v[82:83], s[4:5]
v_pk_mul_f32 v[84:85], v[84:85], s[4:5]
M v[116:119], a[136:139], a[176:179], v[116:119]
v_pk_mul_f32 v[86:87], v[86:87], s[4:5]
v_cvt_pk_bf16_f32 v80, v80, v81
M v[120:123], a[144:147], a[176:179], v[120:123]
buffer_load_dword v23, s[8:11], s24 offen offset:256 lds
v_cvt_pk_bf16_f32 v81, v82, v83
v_cvt_pk_bf16_f32 v82, v84, v85
M v[120:123], a[148:151], a[180:183], v[120:123]
v_cvt_pk_bf16_f32 v83, v86, v87
v_pk_mul_f32 v[88:89], v[88:89], s[4:5]
v_pk_mul_f32 v[90:91], v[90:91], s[4:5]
M v[124:127], a[156:159], a[180:183], v[124:127]
v_pk_mul_f32 v[92:93], v[92:93], s[4:5]
v_pk_mul_f32 v[94:95], v[94:95], s[4:5]
M v[124:127], a[152:155], a[176:179], v[124:127]
v_cvt_pk_bf16_f32 v88, v88, v89
v_cvt_pk_bf16_f32 v89, v90, v91
M v[128:131], a[96:99], a[184:187], v[128:131]
s_add_u32 m0, s29, 2048
s_nop 0
buffer_load_dwordx4 v2, s[8:11], s23 offen offset:0 lds
v_cvt_pk_bf16_f32 v90, v92, v93
v_cvt_pk_bf16_f32 v91, v94, v95
M v[128:131], a[100:103], a[188:191], v[128:131]
ds_read_b128 a[168:171], v10 offset:51200
ds_read_b128 a[172:175], v11 offset:51200
M v[132:135], a[108:111], a[188:191], v[132:135]
s_add_u32 s94, s92, 0
buffer_store_dwordx4 v[48:51], v1, s[16:19], s94 offen offset:2048 sc1
M v[132:135], a[104:107], a[184:187], v[132:135]
v_pk_mul_f32 v[96:97], v[96:97], s[4:5]
v_pk_mul_f32 v[98:99], v[98:99], s[4:5]
v_pk_mul_f32 v[100:101], v[100:101], s[4:5]
M v[136:139], a[112:115], a[184:187], v[136:139]
v_pk_mul_f32 v[102:103], v[102:103], s[4:5]
v_cvt_pk_bf16_f32 v96, v96, v97
M v[136:139], a[116:119], a[188:191], v[136:139]
buffer_load_dwordx4 v3, s[8:11], s23 offen offset:1024 lds
v_cvt_pk_bf16_f32 v97, v98, v99
v_cvt_pk_bf16_f32 v98, v100, v101
M v[140:143], a[124:127], a[188:191], v[140:143]
v_cvt_pk_bf16_f32 v99, v102, v103
v_pk_mul_f32 v[104:105], v[104:105], s[4:5]
v_pk_mul_f32 v[106:107], v[106:107], s[4:5]
M v[140:143], a[120:123], a[184:187], v[140:143]
v_pk_mul_f32 v[108:109], v[108:109], s[4:5]
v_pk_mul_f32 v[110:111], v[110:111], s[4:5]
M v[144:147], a[128:131], a[184:187], v[144:147]
s_add_u32 s94, s92, 0
buffer_store_dwordx4 v[56:59], v1, s[16:19], s94 offen offset:3072 sc1
v_cvt_pk_bf16_f32 v104, v104, v105
v_cvt_pk_bf16_f32 v105, v106, v107
M v[144:147], a[132:135], a[188:191], v[144:147]
v_cvt_pk_bf16_f32 v106, v108, v109
v_cvt_pk_bf16_f32 v107, v110, v111
M v[148:151], a[140:143], a[188:191], v[148:151]
buffer_load_dwordx4 v4, s[8:11], s23 offen offset:2048 lds
v_pk_mul_f32 v[112:113], v[112:113], s[4:5]
v_pk_mul_f32 v[114:115], v[114:115], s[4:5]
v_pk_mul_f32 v[116:117], v[116:117], s[4:5]
M v[148:151], a[136:139], a[184:187], v[148:151]
v_pk_mul_f32 v[118:119], v[118:119], s[4:5]
v_cvt_pk_bf16_f32 v112, v112, v113
M v[152:155], a[144:147], a[184:187], v[152:155]
v_cvt_pk_bf16_f32 v113, v114, v115
v_cvt_pk_bf16_f32 v114, v116, v117
M v[152:155], a[148:151], a[188:191], v[152:155]
buffer_load_dwordx4 v5, s[8:11], s23 offen offset:3072 lds
v_cvt_pk_bf16_f32 v115, v118, v119
v_pk_mul_f32 v[120:121], v[120:121], s[4:5]
v_pk_mul_f32 v[122:123], v[122:123], s[4:5]
M v[156:159], a[156:159], a[188:191], v[156:159]
v_pk_mul_f32 v[124:125], v[124:125], s[4:5]
v_pk_mul_f32 v[126:127], v[126:127], s[4:5]
M v[156:159], a[152:155], a[184:187], v[156:159]
s_add_u32 s94, s92, 4096
buffer_store_dwordx4 v[64:67], v1, s[16:19], s94 offen offset:0 sc1
s_waitcnt lgkmcnt(2)
v_cvt_pk_bf16_f32 v120, v120, v121
v_cvt_pk_bf16_f32 v121, v122, v123
M v[160:163], a[96:99], a[160:163], v[160:163]
v_cvt_pk_bf16_f32 v122, v124, v125
v_cvt_pk_bf16_f32 v123, v126, v127
M v[160:163], a[100:103], a[164:167], v[160:163]
ds_read_b128 a[176:179], v10 offset:53248
ds_read_b128 a[180:183], v11 offset:53248
M v[164:167], a[108:111], a[164:167], v[164:167]
s_sub_u32 s31, s31, 1
s_cmp_eq_u32 s31, 0
s_cselect_b32 s58, -1920, s57
s_add_u32 s23, s23, s58
s_add_u32 s24, s24, s58
M v[164:167], a[104:107], a[160:163], v[164:167]
v_pk_mul_f32 v[128:129], v[128:129], s[4:5]
v_pk_mul_f32 v[130:131], v[130:131], s[4:5]
v_pk_mul_f32 v[132:133], v[132:133], s[4:5]
M v[168:171], a[112:115], a[160:163], v[168:171]
v_pk_mul_f32 v[134:135], v[134:135], s[4:5]
v_cvt_pk_bf16_f32 v128, v128, v129
M v[168:171], a[116:119], a[164:167], v[168:171]
s_add_u32 s94, s92, 4096
buffer_store_dwordx4 v[72:75], v1, s[16:19], s94 offen offset:1024 sc1
v_cvt_pk_bf16_f32 v129, v130, v131
v_cvt_pk_bf16_f32 v130, v132, v133
M v[172:175], a[124:127], a[164:167], v[172:175]
v_cvt_pk_bf16_f32 v131, v134, v135
v_pk_mul_f32 v[136:137], v[136:137], s[4:5]
v_pk_mul_f32 v[138:139], v[138:139], s[4:5]
M v[172:175], a[120:123], a[160:163], v[172:175]
s_add_u32 m0, s30, 98304
s_nop 0
buffer_load_dwordx4 v6, s[12:15], s25 offen offset:0 lds
v_pk_mul_f32 v[140:141], v[140:141], s[4:5]
v_pk_mul_f32 v[142:143], v[142:143], s[4:5]
M v[176:179], a[128:131], a[160:163], v[176:179]
v_cvt_pk_bf16_f32 v136, v136, v137
v_cvt_pk_bf16_f32 v137, v138, v139
M v[176:179], a[132:135], a[164:167], v[176:179]
v_cvt_pk_bf16_f32 v138, v140, v141
v_cvt_pk_bf16_f32 v139, v142, v143
M v[180:183], a[140:143], a[164:167], v[180:183]
buffer_load_dwordx4 v7, s[12:15], s25 offen offset:1024 lds
v_pk_mul_f32 v[144:145], v[144:145], s[4:5]
v_pk_mul_f32 v[146:147], v[146:147], s[4:5]
v_pk_mul_f32 v[148:149], v[148:149], s[4:5]
M v[180:183], a[136:139], a[160:163], v[180:183]
v_pk_mul_f32 v[150:151], v[150:151], s[4:5]
v_cvt_pk_bf16_f32 v144, v144, v145
M v[184:187], a[144:147], a[160:163], v[184:187]
s_add_u32 s94, s92, 4096
buffer_store_dwordx4 v[80:83], v1, s[16:19], s94 offen offset:2048 sc1
v_cvt_pk_bf16_f32 v145, v146, v147
v_cvt_pk_bf16_f32 v146, v148, v149
M v[184:187], a[148:151], a[164:167], v[184:187]
v_cvt_pk_bf16_f32 v147, v150, v151
v_pk_mul_f32 v[152:153], v[152:153], s[4:5]
v_pk_mul_f32 v[154:155], v[154:155], s[4:5]
M v[188:191], a[156:159], a[164:167], v[188:191]
buffer_load_dwordx4 v8, s[12:15], s25 offen offset:2048 lds
v_pk_mul_f32 v[156:157], v[156:157], s[4:5]
v_pk_mul_f32 v[158:159], v[158:159], s[4:5]
M v[188:191], a[152:155], a[160:163], v[188:191]
s_waitcnt lgkmcnt(2)
v_cvt_pk_bf16_f32 v152, v152, v153
v_cvt_pk_bf16_f32 v153, v154, v155
M v[192:195], a[96:99], a[168:171], v[192:195]
v_cvt_pk_bf16_f32 v154, v156, v157
v_cvt_pk_bf16_f32 v155, v158, v159
M v[192:195], a[100:103], a[172:175], v[192:195]
ds_read_b128 a[184:187], v10 offset:55296
ds_read_b128 a[188:191], v11 offset:55296
M v[196:199], a[108:111], a[172:175], v[196:199]
M v[196:199], a[104:107], a[168:171], v[196:199]
s_add_u32 s94, s92, 4096
buffer_store_dwordx4 v[88:91], v1, s[16:19], s94 offen offset:3072 sc1
v_pk_mul_f32 v[160:161], v[160:161], s[4:5]
v_pk_mul_f32 v[162:163], v[162:163], s[4:5]
v_pk_mul_f32 v[164:165], v[164:165], s[4:5]
M v[200:203], a[112:115], a[168:171], v[200:203]
buffer_load_dwordx4 v9, s[12:15], s25 offen offset:3072 lds
v_pk_mul_f32 v[166:167], v[166:167], s[4:5]
v_cvt_pk_bf16_f32 v160, v160, v161
M v[200:203], a[116:119], a[172:175], v[200:203]
v_cvt_pk_bf16_f32 v161, v162, v163
v_cvt_pk_bf16_f32 v162, v164, v165
M v[204:207], a[124:127], a[172:175], v[204:207]
v_cvt_pk_bf16_f32 v163, v166, v167
v_pk_mul_f32 v[168:169], v[168:169], s[4:5]
v_pk_mul_f32 v[170:171], v[170:171], s[4:5]
M v[204:207], a[120:123], a[168:171], v[204:207]
v_pk_mul_f32 v[172:173], v[172:173], s[4:5]
v_pk_mul_f32 v[174:175], v[174:175], s[4:5]
M v[208:211], a[128:131], a[168:171], v[208:211]
s_add_u32 m0, s30, 102400
s_nop 0
buffer_load_dwordx4 v21, s[12:15], s25 offen offset:0 lds
v_cvt_pk_bf16_f32 v168, v168, v169
v_cvt_pk_bf16_f32 v169, v170, v171
M v[208:211], a[132:135], a[172:175], v[208:211]
v_cvt_pk_bf16_f32 v170, v172, v173
v_cvt_pk_bf16_f32 v171, v174, v175
M v[212:215], a[140:143], a[172:175], v[212:215]
s_add_u32 s94, s92, 8192
buffer_store_dwordx4 v[96:99], v1, s[16:19], s94 offen offset:0 sc1
v_pk_mul_f32 v[176:177], v[176:177], s[4:5]
v_pk_mul_f32 v[178:179], v[178:179], s[4:5]
v_pk_mul_f32 v[180:181], v[180:181], s[4:5]
M v[212:215], a[136:139], a[168:171], v[212:215]
v_pk_mul_f32 v[182:183], v[182:183], s[4:5]
v_cvt_pk_bf16_f32 v176, v176, v177
M v[216:219], a[144:147], a[168:171], v[216:219]
buffer_load_dwordx4 v22, s[12:15], s25 offen offset:1024 lds
v_cvt_pk_bf16_f32 v177, v178, v179
v_cvt_pk_bf16_f32 v178, v180, v181
M v[216:219], a[148:151], a[172:175], v[216:219]
v_cvt_pk_bf16_f32 v179, v182, v183
v_pk_mul_f32 v[184:185], v[184:185], s[4:5]
v_pk_mul_f32 v[186:187], v[186:187], s[4:5]
M v[220:223], a[156:159], a[172:175], v[220:223]
v_pk_mul_f32 v[188:189], v[188:189], s[4:5]
v_pk_mul_f32 v[190:191], v[190:191], s[4:5]
M v[220:223], a[152:155], a[168:171], v[220:223]
s_waitcnt lgkmcnt(2)
v_cvt_pk_bf16_f32 v184, v184, v185
v_cvt_pk_bf16_f32 v185, v186, v187
M v[224:227], a[96:99], a[176:179], v[224:227]
s_add_u32 s94, s92, 8192
buffer_store_dwordx4 v[104:107], v1, s[16:19], s94 offen offset:1024 sc1
v_cvt_pk_bf16_f32 v186, v188, v189
v_cvt_pk_bf16_f32 v187, v190, v191
M v[224:227], a[100:103], a[180:183], v[224:227]
s_sub_u32 s54, s54, 1
s_cmp_eq_u32 s54, 0
s_cselect_b32 s58, s55, s56
s_add_u32 s25, s25, s58
M v[228:231], a[108:111], a[180:183], v[228:231]
M v[228:231], a[104:107], a[176:179], v[228:231]
v_pk_mul_f32 v[192:193], v[192:193], s[4:5]
v_pk_mul_f32 v[194:195], v[194:195], s[4:5]
v_pk_mul_f32 v[196:197], v[196:197], s[4:5]
M v[232:235], a[112:115], a[176:179], v[232:235]
v_pk_mul_f32 v[198:199], v[198:199], s[4:5]
v_cvt_pk_bf16_f32 v192, v192, v193
M v[232:235], a[116:119], a[180:183], v[232:235]
v_cvt_pk_bf16_f32 v193, v194, v195
v_cvt_pk_bf16_f32 v194, v196, v197
M v[236:239], a[124:127], a[180:183], v[236:239]
v_cvt_pk_bf16_f32 v195, v198, v199
v_pk_mul_f32 v[200:201], v[200:201], s[4:5]
v_pk_mul_f32 v[202:203], v[202:203], s[4:5]
M v[236:239], a[120:123], a[176:179], v[236:239]
s_waitcnt vmcnt(63) lgkmcnt(0)
s_barrier
v_pk_mul_f32 v[204:205], v[204:205], s[4:5]
v_pk_mul_f32 v[206:207], v[206:207], s[4:5]
M v[240:243], a[128:131], a[176:179], v[240:243]
s_add_u32 s94, s92, 8192
buffer_store_dwordx4 v[112:115], v1, s[16:19], s94 offen offset:2048 sc1
v_cvt_pk_bf16_f32 v200, v200, v201
v_cvt_pk_bf16_f32 v201, v202, v203
M v[240:243], a[132:135], a[180:183], v[240:243]
s_add_u32 m0, s28, 18432
s_nop 0
buffer_load_dword v20, s[8:11], s24 offen lds
v_cvt_pk_bf16_f32 v202, v204, v205
v_cvt_pk_bf16_f32 v203, v206, v207
M v[244:247], a[140:143], a[180:183], v[244:247]
v_pk_mul_f32 v[208:209], v[208:209], s[4:5]
v_pk_mul_f32 v[210:211], v[210:211], s[4:5]
v_pk_mul_f32 v[212:213], v[212:213], s[4:5]
M v[244:247], a[136:139], a[176:179], v[244:247]
v_pk_mul_f32 v[214:215], v[214:215], s[4:5]
v_cvt_pk_bf16_f32 v208, v208, v209
M v[248:251], a[144:147], a[176:179], v[248:251]
buffer_load_dword v23, s[8:11], s24 offen offset:256 lds
v_cvt_pk_bf16_f32 v209, v210, v211
v_cvt_pk_bf16_f32 v210, v212, v213
M v[248:251], a[148:151], a[180:183], v[248:251]
v_cvt_pk_bf16_f32 v211, v214, v215
v_pk_mul_f32 v[216:217], v[216:217], s[4:5]
v_pk_mul_f32 v[218:219], v[218:219], s[4:5]
M v[252:255], a[156:159], a[180:183], v[252:255]
s_add_u32 s94, s92, 8192
buffer_store_dwordx4 v[120:123], v1, s[16:19], s94 offen offset:3072 sc1
v_pk_mul_f32 v[220:221], v[220:221], s[4:5]
v_pk_mul_f32 v[222:223], v[222:223], s[4:5]
M v[252:255], a[152:155], a[176:179], v[252:255]
v_cvt_pk_bf16_f32 v216, v216, v217
v_cvt_pk_bf16_f32 v217, v218, v219
M a[0:3], a[96:99], a[184:187], a[0:3]
v_cvt_pk_bf16_f32 v218, v220, v221
v_cvt_pk_bf16_f32 v219, v222, v223
M a[0:3], a[100:103], a[188:191], a[0:3]
s_add_u32 m0, s29, 20480
s_nop 0
buffer_load_dwordx4 v2, s[8:11], s23 offen offset:0 lds
M a[4:7], a[108:111], a[188:191], a[4:7]
M a[4:7], a[104:107], a[184:187], a[4:7]
v_pk_mul_f32 v[224:225], v[224:225], s[4:5]
v_pk_mul_f32 v[226:227], v[226:227], s[4:5]
v_pk_mul_f32 v[228:229], v[228:229], s[4:5]
M a[8:11], a[112:115], a[184:187], a[8:11]
buffer_load_dwordx4 v3, s[8:11], s23 offen offset:1024 lds
v_pk_mul_f32 v[230:231], v[230:231], s[4:5]
v_cvt_pk_bf16_f32 v224, v224, v225
M a[8:11], a[116:119], a[188:191], a[8:11]
s_add_u32 s94, s92, 12288
buffer_store_dwordx4 v[128:131], v1, s[16:19], s94 offen offset:0 sc1
v_cvt_pk_bf16_f32 v225, v226, v227
v_cvt_pk_bf16_f32 v226, v228, v229
M a[12:15], a[124:127], a[188:191], a[12:15]
v_cvt_pk_bf16_f32 v227, v230, v231
v_pk_mul_f32 v[232:233], v[232:233], s[4:5]
v_pk_mul_f32 v[234:235], v[234:235], s[4:5]
M a[12:15], a[120:123], a[184:187], a[12:15]
v_pk_mul_f32 v[236:237], v[236:237], s[4:5]
v_pk_mul_f32 v[238:239], v[238:239], s[4:5]
M a[16:19], a[128:131], a[184:187], a[16:19]
buffer_load_dwordx4 v4, s[8:11], s23 offen offset:2048 lds
v_cvt_pk_bf16_f32 v232, v232, v233
v_cvt_pk_bf16_f32 v233, v234, v235
M a[16:19], a[132:135], a[188:191], a[16:19]
v_cvt_pk_bf16_f32 v234, v236, v237
v_cvt_pk_bf16_f32 v235, v238, v239
M a[20:23], a[140:143], a[188:191], a[20:23]
v_pk_mul_f32 v[240:241], v[240:241], s[4:5]
v_pk_mul_f32 v[242:243], v[242:243], s[4:5]
v_pk_mul_f32 v[244:245], v[244:245], s[4:5]
M a[20:23], a[136:139], a[184:187], a[20:23]
buffer_load_dwordx4 v5, s[8:11], s23 offen offset:3072 lds
v_pk_mul_f32 v[246:247], v[246:247], s[4:5]
v_cvt_pk_bf16_f32 v240, v240, v241
M a[24:27], a[144:147], a[184:187], a[24:27]
s_add_u32 s94, s92, 12288
buffer_store_dwordx4 v[136:139], v1, s[16:19], s94 offen offset:1024 sc1
v_cvt_pk_bf16_f32 v241, v242, v243
v_cvt_pk_bf16_f32 v242, v244, v245
M a[24:27], a[148:151], a[188:191], a[24:27]
v_cvt_pk_bf16_f32 v243, v246, v247
v_pk_mul_f32 v[248:249], v[248:249], s[4:5]
v_pk_mul_f32 v[250:251], v[250:251], s[4:5]
M a[28:31], a[156:159], a[188:191], a[28:31]
v_pk_mul_f32 v[252:253], v[252:253], s[4:5]
v_pk_mul_f32 v[254:255], v[254:255], s[4:5]
M a[28:31], a[152:155], a[184:187], a[28:31]
v_cvt_pk_bf16_f32 v248, v248, v249
v_cvt_pk_bf16_f32 v249, v250, v251
v_cvt_pk_bf16_f32 v250, v252, v253
v_cvt_pk_bf16_f32 v251, v254, v255
v_accvgpr_read_b32 v24, a0
v_accvgpr_read_b32 v25, a1
v_accvgpr_read_b32 v26, a2
v_accvgpr_read_b32 v27, a3
v_accvgpr_read_b32 v28, a4
v_accvgpr_read_b32 v29, a5
v_accvgpr_read_b32 v30, a6
v_accvgpr_read_b32 v31, a7
v_pk_mul_f32 v[24:25], v[24:25], s[4:5]
v_pk_mul_f32 v[26:27], v[26:27], s[4:5]
v_pk_mul_f32 v[28:29], v[28:29], s[4:5]
v_pk_mul_f32 v[30:31], v[30:31], s[4:5]
v_cvt_pk_bf16_f32 v36, v24, v25
v_cvt_pk_bf16_f32 v37, v26, v27
v_cvt_pk_bf16_f32 v38, v28, v29
v_cvt_pk_bf16_f32 v39, v30, v31
v_accvgpr_read_b32 v24, a8
v_accvgpr_read_b32 v25, a9
v_accvgpr_read_b32 v26, a10
v_accvgpr_read_b32 v27, a11
v_accvgpr_read_b32 v28, a12
v_accvgpr_read_b32 v29, a13
v_accvgpr_read_b32 v30, a14
v_accvgpr_read_b32 v31, a15
v_pk_mul_f32 v[24:25], v[24:25], s[4:5]
v_pk_mul_f32 v[26:27], v[26:27], s[4:5]
v_pk_mul_f32 v[28:29], v[28:29], s[4:5]
v_pk_mul_f32 v[30:31], v[30:31], s[4:5]
v_cvt_pk_bf16_f32 v44, v24, v25
v_cvt_pk_bf16_f32 v45, v26, v27
v_cvt_pk_bf16_f32 v46, v28, v29
v_cvt_pk_bf16_f32 v47, v30, v31
v_accvgpr_read_b32 v24, a16
v_accvgpr_read_b32 v25, a17
v_accvgpr_read_b32 v26, a18
v_accvgpr_read_b32 v27, a19
v_accvgpr_read_b32 v28, a20
v_accvgpr_read_b32 v29, a21
v_accvgpr_read_b32 v30, a22
v_accvgpr_read_b32 v31, a23
v_pk_mul_f32 v[24:25], v[24:25], s[4:5]
v_pk_mul_f32 v[26:27], v[26:27], s[4:5]
v_pk_mul_f32 v[28:29], v[28:29], s[4:5]
v_pk_mul_f32 v[30:31], v[30:31], s[4:5]
v_cvt_pk_bf16_f32 v52, v24, v25
v_cvt_pk_bf16_f32 v53, v26, v27
v_cvt_pk_bf16_f32 v54, v28, v29
v_cvt_pk_bf16_f32 v55, v30, v31
v_accvgpr_read_b32 v24, a24
v_accvgpr_read_b32 v25, a25
v_accvgpr_read_b32 v26, a26
v_accvgpr_read_b32 v27, a27
v_accvgpr_read_b32 v28, a28
v_accvgpr_read_b32 v29, a29
v_accvgpr_read_b32 v30, a30
v_accvgpr_read_b32 v31, a31
v_pk_mul_f32 v[24:25], v[24:25], s[4:5]
v_pk_mul_f32 v[26:27], v[26:27], s[4:5]
v_pk_mul_f32 v[28:29], v[28:29], s[4:5]
v_pk_mul_f32 v[30:31], v[30:31], s[4:5]
v_cvt_pk_bf16_f32 v60, v24, v25
v_cvt_pk_bf16_f32 v61, v26, v27
v_cvt_pk_bf16_f32 v62, v28, v29
v_cvt_pk_bf16_f32 v63, v30, v31
s_branch Lk1_b
Lk1_spin:
s_add_u32 s40, s40, 1
s_cmp_gt_u32 s40, 1048576
s_cbranch_scc1 Lk1_got
s_sleep 2
buffer_load_dword v126, v119, s[36:39], 0 offen offset:128 sc1
s_waitcnt vmcnt(0)
v_cmp_gt_u32 vcc, 0x80, v126
s_nop 0
s_cbranch_vccnz Lk1_spin
s_branch Lk1_got
Lk1_spinq:
s_add_u32 s40, s40, 1
s_cmp_gt_u32 s40, 1048576
s_cbranch_scc1 Lk1_gotq
s_sleep 2
buffer_load_dword v125, v119, s[36:39], 0 offen offset:0 sc1
s_waitcnt vmcnt(0)
v_cmp_gt_u32 vcc, 0x80, v125
s_nop 0
s_cbranch_vccnz Lk1_spinq
s_branch Lk1_gotq
Lk1_kv:
M v[32:35], a[32:35], a[160:163], 0
s_add_u32 m0, s29, 32768
s_nop 0
buffer_load_dwordx4 v2, s[8:11], s23 offen offset:0 lds
M v[32:35], a[36:39], a[164:167], v[32:35]
ds_read_b128 a[176:179], v10 offset:4096
ds_read_b128 a[180:183], v11 offset:4096
M v[36:39], a[44:47], a[164:167], 0
buffer_load_dwordx4 v3, s[8:11], s23 offen offset:1024 lds
M v[36:39], a[40:43], a[160:163], v[36:39]
ds_read_b64_tr_b16 a[96:97], v12 offset:32768
ds_read_b64_tr_b16 a[98:99], v12 offset:34816
M v[40:43], a[48:51], a[160:163], 0
buffer_load_dwordx4 v4, s[8:11], s23 offen offset:2048 lds
M v[40:43], a[52:55], a[164:167], v[40:43]
M v[44:47], a[60:63], a[164:167], 0
buffer_load_dwordx4 v5, s[8:11], s23 offen offset:3072 lds
M v[44:47], a[56:59], a[160:163], v[44:47]
ds_read_b64_tr_b16 a[104:105], v13 offset:32768
ds_read_b64_tr_b16 a[106:107], v13 offset:34816
M v[48:51], a[64:67], a[160:163], 0
s_add_u32 m0, s29, 65536
s_nop 0
buffer_load_dwordx4 v6, s[12:15], s24 offen offset:0 lds
M v[48:51], a[68:71], a[164:167], v[48:51]
M v[52:55], a[76:79], a[164:167], 0
buffer_load_dwordx4 v7, s[12:15], s24 offen offset:1024 lds
M v[52:55], a[72:75], a[160:163], v[52:55]
ds_read_b64_tr_b16 a[112:113], v14 offset:32768
ds_read_b64_tr_b16 a[114:115], v14 offset:34816
M v[56:59], a[80:83], a[160:163], 0
buffer_load_dwordx4 v8, s[12:15], s24 offen offset:2048 lds
M v[56:59], a[84:87], a[164:167], v[56:59]
buffer_load_dwordx4 v9, s[12:15], s24 offen offset:3072 lds
M v[60:63], a[92:95], a[164:167], 0
M v[60:63], a[88:91], a[160:163], v[60:63]
ds_read_b64_tr_b16 a[120:121], v15 offset:32768
ds_read_b64_tr_b16 a[122:123], v15 offset:34816
M v[64:67], a[32:35], a[168:171], 0
s_add_u32 s24, s24, 262144
M v[64:67], a[36:39], a[172:175], v[64:67]
ds_read_b128 a[184:187], v10 offset:6144
ds_read_b128 a[188:191], v11 offset:6144
M v[68:71], a[44:47], a[172:175], 0
s_add_u32 m0, s29, 49152
s_add_u32 s3, s23, s31
buffer_load_dwordx4 v2, s[8:11], s3 offen offset:0 lds
M v[68:71], a[40:43], a[168:171], v[68:71]
ds_read_b64_tr_b16 a[128:129], v16 offset:32768
ds_read_b64_tr_b16 a[130:131], v16 offset:34816
M v[72:75], a[48:51], a[168:171], 0
M v[72:75], a[52:55], a[172:175], v[72:75]
buffer_load_dwordx4 v3, s[8:11], s3 offen offset:1024 lds
M v[76:79], a[60:63], a[172:175], 0
buffer_load_dwordx4 v4, s[8:11], s3 offen offset:2048 lds
M v[76:79], a[56:59], a[168:171], v[76:79]
ds_read_b64_tr_b16 a[136:137], v17 offset:32768
ds_read_b64_tr_b16 a[138:139], v17 offset:34816
M v[80:83], a[64:67], a[168:171], 0
M v[80:83], a[68:71], a[172:175], v[80:83]
buffer_load_dwordx4 v5, s[8:11], s3 offen offset:3072 lds
M v[84:87], a[76:79], a[172:175], 0
s_add_u32 s23, s23, 128
s_cmp_eq_u32 s23, s25
s_cselect_b32 s23, s26, s23
M v[84:87], a[72:75], a[168:171], v[84:87]
ds_read_b64_tr_b16 a[144:145], v18 offset:32768
ds_read_b64_tr_b16 a[146:147], v18 offset:34816
M v[88:91], a[80:83], a[168:171], 0
s_add_u32 m0, s29, 81920
s_nop 0
buffer_load_dwordx4 v6, s[12:15], s24 offen offset:0 lds
M v[88:91], a[84:87], a[172:175], v[88:91]
M v[92:95], a[92:95], a[172:175], 0
buffer_load_dwordx4 v7, s[12:15], s24 offen offset:1024 lds
M v[92:95], a[88:91], a[168:171], v[92:95]
s_waitcnt lgkmcnt(15)
ds_read_b64_tr_b16 a[152:153], v19 offset:32768
ds_read_b64_tr_b16 a[154:155], v19 offset:34816
M v[96:99], a[32:35], a[176:179], 0
buffer_load_dwordx4 v8, s[12:15], s24 offen offset:2048 lds
M v[96:99], a[36:39], a[180:183], v[96:99]
M v[100:103], a[44:47], a[180:183], 0
buffer_load_dwordx4 v9, s[12:15], s24 offen offset:3072 lds
M v[100:103], a[40:43], a[176:179], v[100:103]
s_add_u32 s24, s24, 262144
s_cmp_eq_u32 s24, s27
s_cselect_b32 s24, s28, s24
s_sub_u32 s6, s6, 1
s_cmp_eq_u32 s6, 0
s_cselect_b64 s[12:13], s[64:65], s[12:13]
M v[104:107], a[48:51], a[176:179], 0
M v[104:107], a[52:55], a[180:183], v[104:107]
M v[108:111], a[60:63], a[180:183], 0
M v[108:111], a[56:59], a[176:179], v[108:111]
s_waitcnt vmcnt(17) lgkmcnt(0)
s_barrier
ds_read_b128 a[160:163], v10 offset:16384
ds_read_b128 a[164:167], v11 offset:16384
M v[112:115], a[64:67], a[176:179], 0
s_add_u32 m0, s29, 0
s_nop 0
buffer_load_dwordx4 v2, s[8:11], s23 offen offset:0 lds
M v[112:115], a[68:71], a[180:183], v[112:115]
M v[116:119], a[76:79], a[180:183], 0
M v[116:119], a[72:75], a[176:179], v[116:119]
ds_read_b64_tr_b16 a[100:101], v12 offset:49152
ds_read_b64_tr_b16 a[102:103], v12 offset:51200
M v[120:123], a[80:83], a[176:179], 0
M v[120:123], a[84:87], a[180:183], v[120:123]
M v[124:127], a[92:95], a[180:183], 0
buffer_load_dwordx4 v3, s[8:11], s23 offen offset:1024 lds
M v[124:127], a[88:91], a[176:179], v[124:127]
M v[128:131], a[32:35], a[184:187], 0
M v[128:131], a[36:39], a[188:191], v[128:131]
ds_read_b128 a[168:171], v10 offset:18432
ds_read_b128 a[172:175], v11 offset:18432
ds_read_b64_tr_b16 a[108:109], v13 offset:49152
ds_read_b64_tr_b16 a[110:111], v13 offset:51200
M v[132:135], a[44:47], a[188:191], 0
M v[132:135], a[40:43], a[184:187], v[132:135]
M v[136:139], a[48:51], a[184:187], 0
M v[136:139], a[52:55], a[188:191], v[136:139]
buffer_load_dwordx4 v4, s[8:11], s23 offen offset:2048 lds
M v[140:143], a[60:63], a[188:191], 0
M v[140:143], a[56:59], a[184:187], v[140:143]
ds_read_b64_tr_b16 a[116:117], v14 offset:49152
ds_read_b64_tr_b16 a[118:119], v14 offset:51200
M v[144:147], a[64:67], a[184:187], 0
M v[144:147], a[68:71], a[188:191], v[144:147]
M v[148:151], a[76:79], a[188:191], 0
M v[148:151], a[72:75], a[184:187], v[148:151]
M v[152:155], a[80:83], a[184:187], 0
buffer_load_dwordx4 v5, s[8:11], s23 offen offset:3072 lds
M v[152:155], a[84:87], a[188:191], v[152:155]
ds_read_b64_tr_b16 a[124:125], v15 offset:49152
ds_read_b64_tr_b16 a[126:127], v15 offset:51200
M v[156:159], a[92:95], a[188:191], 0
M v[156:159], a[88:91], a[184:187], v[156:159]
s_waitcnt lgkmcnt(10)
M v[160:163], a[32:35], a[160:163], 0
M v[160:163], a[36:39], a[164:167], v[160:163]
ds_read_b128 a[176:179], v10 offset:20480
ds_read_b128 a[180:183], v11 offset:20480
M v[164:167], a[44:47], a[164:167], 0
M v[164:167], a[40:43], a[160:163], v[164:167]
ds_read_b64_tr_b16 a[132:133], v16 offset:49152
ds_read_b64_tr_b16 a[134:135], v16 offset:51200
M v[168:171], a[48:51], a[160:163], 0
M v[168:171], a[52:55], a[164:167], v[168:171]
s_add_u32 m0, s29, 98304
s_nop 0
buffer_load_dwordx4 v6, s[12:15], s24 offen offset:0 lds
M v[172:175], a[60:63], a[164:167], 0
M v[172:175], a[56:59], a[160:163], v[172:175]
M v[176:179], a[64:67], a[160:163], 0
M v[176:179], a[68:71], a[164:167], v[176:179]
ds_read_b64_tr_b16 a[140:141], v17 offset:49152
ds_read_b64_tr_b16 a[142:143], v17 offset:51200
M v[180:183], a[76:79], a[164:167], 0
M v[180:183], a[72:75], a[160:163], v[180:183]
buffer_load_dwordx4 v7, s[12:15], s24 offen offset:1024 lds
M v[184:187], a[80:83], a[160:163], 0
M v[184:187], a[84:87], a[164:167], v[184:187]
M v[188:191], a[92:95], a[164:167], 0
M v[188:191], a[88:91], a[160:163], v[188:191]
s_waitcnt lgkmcnt(12)
ds_read_b64_tr_b16 a[148:149], v18 offset:49152
ds_read_b64_tr_b16 a[150:151], v18 offset:51200
M v[192:195], a[32:35], a[168:171], 0
M v[192:195], a[36:39], a[172:175], v[192:195]
ds_read_b128 a[184:187], v10 offset:22528
ds_read_b128 a[188:191], v11 offset:22528
M v[196:199], a[44:47], a[172:175], 0
M v[196:199], a[40:43], a[168:171], v[196:199]
buffer_load_dwordx4 v8, s[12:15], s24 offen offset:2048 lds
M v[200:203], a[48:51], a[168:171], 0
M v[200:203], a[52:55], a[172:175], v[200:203]
ds_read_b64_tr_b16 a[156:157], v19 offset:49152
ds_read_b64_tr_b16 a[158:159], v19 offset:51200
M v[204:207], a[60:63], a[172:175], 0
M v[204:207], a[56:59], a[168:171], v[204:207]
M v[208:211], a[64:67], a[168:171], 0
M v[208:211], a[68:71], a[172:175], v[208:211]
buffer_load_dwordx4 v9, s[12:15], s24 offen offset:3072 lds
M v[212:215], a[76:79], a[172:175], 0
M v[212:215], a[72:75], a[168:171], v[212:215]
M v[216:219], a[80:83], a[168:171], 0
M v[216:219], a[84:87], a[172:175], v[216:219]
M v[220:223], a[92:95], a[172:175], 0
s_add_u32 s24, s24, 262144
M v[220:223], a[88:91], a[168:171], v[220:223]
s_waitcnt lgkmcnt(10)
M v[224:227], a[32:35], a[176:179], 0
M v[224:227], a[36:39], a[180:183], v[224:227]
M v[228:231], a[44:47], a[180:183], 0
M v[228:231], a[40:43], a[176:179], v[228:231]
M v[232:235], a[48:51], a[176:179], 0
M v[232:235], a[52:55], a[180:183], v[232:235]
M v[236:239], a[60:63], a[180:183], 0
M v[236:239], a[56:59], a[176:179], v[236:239]
s_waitcnt vmcnt(16) lgkmcnt(0)
s_barrier
ds_read_b128 a[160:163], v10 offset:32768
ds_read_b128 a[164:167], v11 offset:32768
M v[240:243], a[64:67], a[176:179], 0
s_add_u32 m0, s29, 16384
s_add_u32 s3, s23, s31
buffer_load_dwordx4 v2, s[8:11], s3 offen offset:0 lds
M v[240:243], a[68:71], a[180:183], v[240:243]
M v[244:247], a[76:79], a[180:183], 0
M v[244:247], a[72:75], a[176:179], v[244:247]
M v[248:251], a[80:83], a[176:179], 0
M v[248:251], a[84:87], a[180:183], v[248:251]
buffer_load_dwordx4 v3, s[8:11], s3 offen offset:1024 lds
M v[252:255], a[92:95], a[180:183], 0
M v[252:255], a[88:91], a[176:179], v[252:255]
M a[0:3], a[32:35], a[184:187], 0
M a[0:3], a[36:39], a[188:191], a[0:3]
ds_read_b128 a[168:171], v10 offset:34816
ds_read_b128 a[172:175], v11 offset:34816
M a[4:7], a[44:47], a[188:191], 0
M a[4:7], a[40:43], a[184:187], a[4:7]
M a[8:11], a[48:51], a[184:187], 0
buffer_load_dwordx4 v4, s[8:11], s3 offen offset:2048 lds
M a[8:11], a[52:55], a[188:191], a[8:11]
M a[12:15], a[60:63], a[188:191], 0
M a[12:15], a[56:59], a[184:187], a[12:15]
M a[16:19], a[64:67], a[184:187], 0
M a[16:19], a[68:71], a[188:191], a[16:19]
buffer_load_dwordx4 v5, s[8:11], s3 offen offset:3072 lds
M a[20:23], a[76:79], a[188:191], 0
M a[20:23], a[72:75], a[184:187], a[20:23]
M a[24:27], a[80:83], a[184:187], 0
M a[24:27], a[84:87], a[188:191], a[24:27]
M a[28:31], a[92:95], a[188:191], 0
M a[28:31], a[88:91], a[184:187], a[28:31]
s_waitcnt lgkmcnt(2)
M v[32:35], a[96:99], a[160:163], v[32:35]
s_add_u32 s23, s23, 128
s_cmp_eq_u32 s23, s25
s_cselect_b32 s23, s26, s23
M v[32:35], a[100:103], a[164:167], v[32:35]
ds_read_b128 a[176:179], v10 offset:36864
ds_read_b128 a[180:183], v11 offset:36864
M v[36:39], a[108:111], a[164:167], v[36:39]
M v[36:39], a[104:107], a[160:163], v[36:39]
ds_read_b64_tr_b16 a[32:33], v12 offset:0
ds_read_b64_tr_b16 a[34:35], v12 offset:2048
M v[40:43], a[112:115], a[160:163], v[40:43]
M v[40:43], a[116:119], a[164:167], v[40:43]
M v[44:47], a[124:127], a[164:167], v[44:47]
s_add_u32 m0, s29, 114688
s_nop 0
buffer_load_dwordx4 v6, s[12:15], s24 offen offset:0 lds
M v[44:47], a[120:123], a[160:163], v[44:47]
ds_read_b64_tr_b16 a[40:41], v13 offset:0
ds_read_b64_tr_b16 a[42:43], v13 offset:2048
M v[48:51], a[128:131], a[160:163], v[48:51]
M v[48:51], a[132:135], a[164:167], v[48:51]
M v[52:55], a[140:143], a[164:167], v[52:55]
M v[52:55], a[136:139], a[160:163], v[52:55]
ds_read_b64_tr_b16 a[48:49], v14 offset:0
ds_read_b64_tr_b16 a[50:51], v14 offset:2048
M v[56:59], a[144:147], a[160:163], v[56:59]
M v[56:59], a[148:151], a[164:167], v[56:59]
buffer_load_dwordx4 v7, s[12:15], s24 offen offset:1024 lds
M v[60:63], a[156:159], a[164:167], v[60:63]
M v[60:63], a[152:155], a[160:163], v[60:63]
s_waitcnt lgkmcnt(8)
ds_read_b64_tr_b16 a[56:57], v15 offset:0
ds_read_b64_tr_b16 a[58:59], v15 offset:2048
M v[64:67], a[96:99], a[168:171], v[64:67]
M v[64:67], a[100:103], a[172:175], v[64:67]
ds_read_b128 a[184:187], v10 offset:38912
ds_read_b128 a[188:191], v11 offset:38912
M v[68:71], a[108:111], a[172:175], v[68:71]
M v[68:71], a[104:107], a[168:171], v[68:71]
ds_read_b64_tr_b16 a[64:65], v16 offset:0
ds_read_b64_tr_b16 a[66:67], v16 offset:2048
M v[72:75], a[112:115], a[168:171], v[72:75]
buffer_load_dwordx4 v8, s[12:15], s24 offen offset:2048 lds
M v[72:75], a[116:119], a[172:175], v[72:75]
M v[76:79], a[124:127], a[172:175], v[76:79]
M v[76:79], a[120:123], a[168:171], v[76:79]
ds_read_b64_tr_b16 a[72:73], v17 offset:0
ds_read_b64_tr_b16 a[74:75], v17 offset:2048
M v[80:83], a[128:131], a[168:171], v[80:83]
M v[80:83], a[132:135], a[172:175], v[80:83]
M v[84:87], a[140:143], a[172:175], v[84:87]
buffer_load_dwordx4 v9, s[12:15], s24 offen offset:3072 lds
M v[84:87], a[136:139], a[168:171], v[84:87]
ds_read_b64_tr_b16 a[80:81], v18 offset:0
ds_read_b64_tr_b16 a[82:83], v18 offset:2048
M v[88:91], a[144:147], a[168:171], v[88:91]
M v[88:91], a[148:151], a[172:175], v[88:91]
M v[92:95], a[156:159], a[172:175], v[92:95]
M v[92:95], a[152:155], a[168:171], v[92:95]
s_waitcnt lgkmcnt(15)
ds_read_b64_tr_b16 a[88:89], v19 offset:0
ds_read_b64_tr_b16 a[90:91], v19 offset:2048
M v[96:99], a[96:99], a[176:179], v[96:99]
s_add_u32 s24, s24, 262144
s_cmp_eq_u32 s24, s27
s_cselect_b32 s24, s28, s24
s_sub_u32 s6, s6, 1
s_cmp_eq_u32 s6, 0
s_cselect_b64 s[12:13], s[64:65], s[12:13]
M v[96:99], a[100:103], a[180:183], v[96:99]
M v[100:103], a[108:111], a[180:183], v[100:103]
M v[100:103], a[104:107], a[176:179], v[100:103]
M v[104:107], a[112:115], a[176:179], v[104:107]
M v[104:107], a[116:119], a[180:183], v[104:107]
M v[108:111], a[124:127], a[180:183], v[108:111]
M v[108:111], a[120:123], a[176:179], v[108:111]
s_waitcnt vmcnt(16) lgkmcnt(0)
s_barrier
ds_read_b128 a[160:163], v10 offset:49152
ds_read_b128 a[164:167], v11 offset:49152
M v[112:115], a[128:131], a[176:179], v[112:115]
s_add_u32 m0, s29, 32768
s_nop 0
buffer_load_dwordx4 v2, s[8:11], s23 offen offset:0 lds
M v[112:115], a[132:135], a[180:183], v[112:115]
M v[116:119], a[140:143], a[180:183], v[116:119]
M v[116:119], a[136:139], a[176:179], v[116:119]
ds_read_b64_tr_b16 a[36:37], v12 offset:16384
ds_read_b64_tr_b16 a[38:39], v12 offset:18432
M v[120:123], a[144:147], a[176:179], v[120:123]
M v[120:123], a[148:151], a[180:183], v[120:123]
M v[124:127], a[156:159], a[180:183], v[124:127]
buffer_load_dwordx4 v3, s[8:11], s23 offen offset:1024 lds
M v[124:127], a[152:155], a[176:179], v[124:127]
M v[128:131], a[96:99], a[184:187], v[128:131]
M v[128:131], a[100:103], a[188:191], v[128:131]
ds_read_b128 a[168:171], v10 offset:51200
ds_read_b128 a[172:175], v11 offset:51200
ds_read_b64_tr_b16 a[44:45], v13 offset:16384
ds_read_b64_tr_b16 a[46:47], v13 offset:18432
M v[132:135], a[108:111], a[188:191], v[132:135]
M v[132:135], a[104:107], a[184:187], v[132:135]
M v[136:139], a[112:115], a[184:187], v[136:139]
M v[136:139], a[116:119], a[188:191], v[136:139]
buffer_load_dwordx4 v4, s[8:11], s23 offen offset:2048 lds
M v[140:143], a[124:127], a[188:191], v[140:143]
M v[140:143], a[120:123], a[184:187], v[140:143]
ds_read_b64_tr_b16 a[52:53], v14 offset:16384
ds_read_b64_tr_b16 a[54:55], v14 offset:18432
M v[144:147], a[128:131], a[184:187], v[144:147]
M v[144:147], a[132:135], a[188:191], v[144:147]
M v[148:151], a[140:143], a[188:191], v[148:151]
M v[148:151], a[136:139], a[184:187], v[148:151]
M v[152:155], a[144:147], a[184:187], v[152:155]
buffer_load_dwordx4 v5, s[8:11], s23 offen offset:3072 lds
M v[152:155], a[148:151], a[188:191], v[152:155]
ds_read_b64_tr_b16 a[60:61], v15 offset:16384
ds_read_b64_tr_b16 a[62:63], v15 offset:18432
M v[156:159], a[156:159], a[188:191], v[156:159]
M v[156:159], a[152:155], a[184:187], v[156:159]
s_waitcnt lgkmcnt(10)
M v[160:163], a[96:99], a[160:163], v[160:163]
M v[160:163], a[100:103], a[164:167], v[160:163]
ds_read_b128 a[176:179], v10 offset:53248
ds_read_b128 a[180:183], v11 offset:53248
M v[164:167], a[108:111], a[164:167], v[164:167]
M v[164:167], a[104:107], a[160:163], v[164:167]
ds_read_b64_tr_b16 a[68:69], v16 offset:16384
ds_read_b64_tr_b16 a[70:71], v16 offset:18432
M v[168:171], a[112:115], a[160:163], v[168:171]
M v[168:171], a[116:119], a[164:167], v[168:171]
s_add_u32 m0, s29, 65536
s_nop 0
buffer_load_dwordx4 v6, s[12:15], s24 offen offset:0 lds
M v[172:175], a[124:127], a[164:167], v[172:175]
M v[172:175], a[120:123], a[160:163], v[172:175]
M v[176:179], a[128:131], a[160:163], v[176:179]
M v[176:179], a[132:135], a[164:167], v[176:179]
ds_read_b64_tr_b16 a[76:77], v17 offset:16384
ds_read_b64_tr_b16 a[78:79], v17 offset:18432
M v[180:183], a[140:143], a[164:167], v[180:183]
M v[180:183], a[136:139], a[160:163], v[180:183]
buffer_load_dwordx4 v7, s[12:15], s24 offen offset:1024 lds
M v[184:187], a[144:147], a[160:163], v[184:187]
M v[184:187], a[148:151], a[164:167], v[184:187]
M v[188:191], a[156:159], a[164:167], v[188:191]
M v[188:191], a[152:155], a[160:163], v[188:191]
s_waitcnt lgkmcnt(12)
ds_read_b64_tr_b16 a[84:85], v18 offset:16384
ds_read_b64_tr_b16 a[86:87], v18 offset:18432
M v[192:195], a[96:99], a[168:171], v[192:195]
M v[192:195], a[100:103], a[172:175], v[192:195]
ds_read_b128 a[184:187], v10 offset:55296
ds_read_b128 a[188:191], v11 offset:55296
M v[196:199], a[108:111], a[172:175], v[196:199]
M v[196:199], a[104:107], a[168:171], v[196:199]
buffer_load_dwordx4 v8, s[12:15], s24 offen offset:2048 lds
M v[200:203], a[112:115], a[168:171], v[200:203]
M v[200:203], a[116:119], a[172:175], v[200:203]
ds_read_b64_tr_b16 a[92:93], v19 offset:16384
ds_read_b64_tr_b16 a[94:95], v19 offset:18432
M v[204:207], a[124:127], a[172:175], v[204:207]
M v[204:207], a[120:123], a[168:171], v[204:207]
M v[208:211], a[128:131], a[168:171], v[208:211]
M v[208:211], a[132:135], a[172:175], v[208:211]
buffer_load_dwordx4 v9, s[12:15], s24 offen offset:3072 lds
M v[212:215], a[140:143], a[172:175], v[212:215]
M v[212:215], a[136:139], a[168:171], v[212:215]
M v[216:219], a[144:147], a[168:171], v[216:219]
M v[216:219], a[148:151], a[172:175], v[216:219]
M v[220:223], a[156:159], a[172:175], v[220:223]
s_add_u32 s24, s24, 262144
M v[220:223], a[152:155], a[168:171], v[220:223]
s_waitcnt lgkmcnt(10)
M v[224:227], a[96:99], a[176:179], v[224:227]
M v[224:227], a[100:103], a[180:183], v[224:227]
M v[228:231], a[108:111], a[180:183], v[228:231]
M v[228:231], a[104:107], a[176:179], v[228:231]
M v[232:235], a[112:115], a[176:179], v[232:235]
M v[232:235], a[116:119], a[180:183], v[232:235]
M v[236:239], a[124:127], a[180:183], v[236:239]
M v[236:239], a[120:123], a[176:179], v[236:239]
s_waitcnt vmcnt(16) lgkmcnt(0)
s_barrier
ds_read_b128 a[160:163], v10 offset:0
ds_read_b128 a[164:167], v11 offset:0
M v[240:243], a[128:131], a[176:179], v[240:243]
s_add_u32 m0, s29, 49152
s_add_u32 s3, s23, s31
buffer_load_dwordx4 v2, s[8:11], s3 offen offset:0 lds
M v[240:243], a[132:135], a[180:183], v[240:243]
M v[244:247], a[140:143], a[180:183], v[244:247]
M v[244:247], a[136:139], a[176:179], v[244:247]
M v[248:251], a[144:147], a[176:179], v[248:251]
M v[248:251], a[148:151], a[180:183], v[248:251]
buffer_load_dwordx4 v3, s[8:11], s3 offen offset:1024 lds
M v[252:255], a[156:159], a[180:183], v[252:255]
M v[252:255], a[152:155], a[176:179], v[252:255]
M a[0:3], a[96:99], a[184:187], a[0:3]
M a[0:3], a[100:103], a[188:191], a[0:3]
ds_read_b128 a[168:171], v10 offset:2048
ds_read_b128 a[172:175], v11 offset:2048
M a[4:7], a[108:111], a[188:191], a[4:7]
M a[4:7], a[104:107], a[184:187], a[4:7]
M a[8:11], a[112:115], a[184:187], a[8:11]
buffer_load_dwordx4 v4, s[8:11], s3 offen offset:2048 lds
M a[8:11], a[116:119], a[188:191], a[8:11]
M a[12:15], a[124:127], a[188:191], a[12:15]
M a[12:15], a[120:123], a[184:187], a[12:15]
M a[16:19], a[128:131], a[184:187], a[16:19]
M a[16:19], a[132:135], a[188:191], a[16:19]
buffer_load_dwordx4 v5, s[8:11], s3 offen offset:3072 lds
M a[20:23], a[140:143], a[188:191], a[20:23]
M a[20:23], a[136:139], a[184:187], a[20:23]
M a[24:27], a[144:147], a[184:187], a[24:27]
M a[24:27], a[148:151], a[188:191], a[24:27]
M a[28:31], a[156:159], a[188:191], a[28:31]
M a[28:31], a[152:155], a[184:187], a[28:31]
s_waitcnt lgkmcnt(2)
s_mov_b32 s30, 2
Lk1_kl:
M v[32:35], a[32:35], a[160:163], v[32:35]
s_add_u32 s23, s23, 128
s_cmp_eq_u32 s23, s25
s_cselect_b32 s23, s26, s23
M v[32:35], a[36:39], a[164:167], v[32:35]
ds_read_b128 a[176:179], v10 offset:4096
ds_read_b128 a[180:183], v11 offset:4096
M v[36:39], a[44:47], a[164:167], v[36:39]
M v[36:39], a[40:43], a[160:163], v[36:39]
ds_read_b64_tr_b16 a[96:97], v12 offset:32768
ds_read_b64_tr_b16 a[98:99], v12 offset:34816
M v[40:43], a[48:51], a[160:163], v[40:43]
M v[40:43], a[52:55], a[164:167], v[40:43]
M v[44:47], a[60:63], a[164:167], v[44:47]
s_add_u32 m0, s29, 81920
s_nop 0
buffer_load_dwordx4 v6, s[12:15], s24 offen offset:0 lds
M v[44:47], a[56:59], a[160:163], v[44:47]
ds_read_b64_tr_b16 a[104:105], v13 offset:32768
ds_read_b64_tr_b16 a[106:107], v13 offset:34816
M v[48:51], a[64:67], a[160:163], v[48:51]
M v[48:51], a[68:71], a[164:167], v[48:51]
M v[52:55], a[76:79], a[164:167], v[52:55]
M v[52:55], a[72:75], a[160:163], v[52:55]
ds_read_b64_tr_b16 a[112:113], v14 offset:32768
ds_read_b64_tr_b16 a[114:115], v14 offset:34816
M v[56:59], a[80:83], a[160:163], v[56:59]
M v[56:59], a[84:87], a[164:167], v[56:59]
buffer_load_dwordx4 v7, s[12:15], s24 offen offset:1024 lds
M v[60:63], a[92:95], a[164:167], v[60:63]
M v[60:63], a[88:91], a[160:163], v[60:63]
s_waitcnt lgkmcnt(8)
ds_read_b64_tr_b16 a[120:121], v15 offset:32768
ds_read_b64_tr_b16 a[122:123], v15 offset:34816
M v[64:67], a[32:35], a[168:171], v[64:67]
M v[64:67], a[36:39], a[172:175], v[64:67]
ds_read_b128 a[184:187], v10 offset:6144
ds_read_b128 a[188:191], v11 offset:6144
M v[68:71], a[44:47], a[172:175], v[68:71]
M v[68:71], a[40:43], a[168:171], v[68:71]
ds_read_b64_tr_b16 a[128:129], v16 offset:32768
ds_read_b64_tr_b16 a[130:131], v16 offset:34816
M v[72:75], a[48:51], a[168:171], v[72:75]
buffer_load_dwordx4 v8, s[12:15], s24 offen offset:2048 lds
M v[72:75], a[52:55], a[172:175], v[72:75]
M v[76:79], a[60:63], a[172:175], v[76:79]
M v[76:79], a[56:59], a[168:171], v[76:79]
ds_read_b64_tr_b16 a[136:137], v17 offset:32768
ds_read_b64_tr_b16 a[138:139], v17 offset:34816
M v[80:83], a[64:67], a[168:171], v[80:83]
M v[80:83], a[68:71], a[172:175], v[80:83]
M v[84:87], a[76:79], a[172:175], v[84:87]
buffer_load_dwordx4 v9, s[12:15], s24 offen offset:3072 lds
M v[84:87], a[72:75], a[168:171], v[84:87]
ds_read_b64_tr_b16 a[144:145], v18 offset:32768
ds_read_b64_tr_b16 a[146:147], v18 offset:34816
M v[88:91], a[80:83], a[168:171], v[88:91]
M v[88:91], a[84:87], a[172:175], v[88:91]
M v[92:95], a[92:95], a[172:175], v[92:95]
M v[92:95], a[88:91], a[168:171], v[92:95]
s_waitcnt lgkmcnt(15)
ds_read_b64_tr_b16 a[152:153], v19 offset:32768
ds_read_b64_tr_b16 a[154:155], v19 offset:34816
M v[96:99], a[32:35], a[176:179], v[96:99]
s_add_u32 s24, s24, 262144
s_cmp_eq_u32 s24, s27
s_cselect_b32 s24, s28, s24
s_sub_u32 s6, s6, 1
s_cmp_eq_u32 s6, 0
s_cselect_b64 s[12:13], s[64:65], s[12:13]
M v[96:99], a[36:39], a[180:183], v[96:99]
M v[100:103], a[44:47], a[180:183], v[100:103]
M v[100:103], a[40:43], a[176:179], v[100:103]
M v[104:107], a[48:51], a[176:179], v[104:107]
M v[104:107], a[52:55], a[180:183], v[104:107]
M v[108:111], a[60:63], a[180:183], v[108:111]
M v[108:111], a[56:59], a[176:179], v[108:111]
s_waitcnt vmcnt(16) lgkmcnt(0)
s_barrier
ds_read_b128 a[160:163], v10 offset:16384
ds_read_b128 a[164:167], v11 offset:16384
M v[112:115], a[64:67], a[176:179], v[112:115]
s_add_u32 m0, s29, 0
s_nop 0
buffer_load_dwordx4 v2, s[8:11], s23 offen offset:0 lds
M v[112:115], a[68:71], a[180:183], v[112:115]
M v[116:119], a[76:79], a[180:183], v[116:119]
M v[116:119], a[72:75], a[176:179], v[116:119]
ds_read_b64_tr_b16 a[100:101], v12 offset:49152
ds_read_b64_tr_b16 a[102:103], v12 offset:51200
M v[120:123], a[80:83], a[176:179], v[120:123]
M v[120:123], a[84:87], a[180:183], v[120:123]
M v[124:127], a[92:95], a[180:183], v[124:127]
buffer_load_dwordx4 v3, s[8:11], s23 offen offset:1024 lds
M v[124:127], a[88:91], a[176:179], v[124:127]
M v[128:131], a[32:35], a[184:187], v[128:131]
M v[128:131], a[36:39], a[188:191], v[128:131]
ds_read_b128 a[168:171], v10 offset:18432
ds_read_b128 a[172:175], v11 offset:18432
ds_read_b64_tr_b16 a[108:109], v13 offset:49152
ds_read_b64_tr_b16 a[110:111], v13 offset:51200
M v[132:135], a[44:47], a[188:191], v[132:135]
M v[132:135], a[40:43], a[184:187], v[132:135]
M v[136:139], a[48:51], a[184:187], v[136:139]
M v[136:139], a[52:55], a[188:191], v[136:139]
buffer_load_dwordx4 v4, s[8:11], s23 offen offset:2048 lds
M v[140:143], a[60:63], a[188:191], v[140:143]
M v[140:143], a[56:59], a[184:187], v[140:143]
ds_read_b64_tr_b16 a[116:117], v14 offset:49152
ds_read_b64_tr_b16 a[118:119], v14 offset:51200
M v[144:147], a[64:67], a[184:187], v[144:147]
M v[144:147], a[68:71], a[188:191], v[144:147]
M v[148:151], a[76:79], a[188:191], v[148:151]
M v[148:151], a[72:75], a[184:187], v[148:151]
M v[152:155], a[80:83], a[184:187], v[152:155]
buffer_load_dwordx4 v5, s[8:11], s23 offen offset:3072 lds
M v[152:155], a[84:87], a[188:191], v[152:155]
ds_read_b64_tr_b16 a[124:125], v15 offset:49152
ds_read_b64_tr_b16 a[126:127], v15 offset:51200
M v[156:159], a[92:95], a[188:191], v[156:159]
M v[156:159], a[88:91], a[184:187], v[156:159]
s_waitcnt lgkmcnt(10)
M v[160:163], a[32:35], a[160:163], v[160:163]
M v[160:163], a[36:39], a[164:167], v[160:163]
ds_read_b128 a[176:179], v10 offset:20480
ds_read_b128 a[180:183], v11 offset:20480
M v[164:167], a[44:47], a[164:167], v[164:167]
M v[164:167], a[40:43], a[160:163], v[164:167]
ds_read_b64_tr_b16 a[132:133], v16 offset:49152
ds_read_b64_tr_b16 a[134:135], v16 offset:51200
M v[168:171], a[48:51], a[160:163], v[168:171]
M v[168:171], a[52:55], a[164:167], v[168:171]
s_add_u32 m0, s29, 98304
s_nop 0
buffer_load_dwordx4 v6, s[12:15], s24 offen offset:0 lds
M v[172:175], a[60:63], a[164:167], v[172:175]
M v[172:175], a[56:59], a[160:163], v[172:175]
M v[176:179], a[64:67], a[160:163], v[176:179]
M v[176:179], a[68:71], a[164:167], v[176:179]
ds_read_b64_tr_b16 a[140:141], v17 offset:49152
ds_read_b64_tr_b16 a[142:143], v17 offset:51200
M v[180:183], a[76:79], a[164:167], v[180:183]
M v[180:183], a[72:75], a[160:163], v[180:183]
buffer_load_dwordx4 v7, s[12:15], s24 offen offset:1024 lds
M v[184:187], a[80:83], a[160:163], v[184:187]
M v[184:187], a[84:87], a[164:167], v[184:187]
M v[188:191], a[92:95], a[164:167], v[188:191]
M v[188:191], a[88:91], a[160:163], v[188:191]
s_waitcnt lgkmcnt(12)
ds_read_b64_tr_b16 a[148:149], v18 offset:49152
ds_read_b64_tr_b16 a[150:151], v18 offset:51200
M v[192:195], a[32:35], a[168:171], v[192:195]
M v[192:195], a[36:39], a[172:175], v[192:195]
ds_read_b128 a[184:187], v10 offset:22528
ds_read_b128 a[188:191], v11 offset:22528
M v[196:199], a[44:47], a[172:175], v[196:199]
M v[196:199], a[40:43], a[168:171], v[196:199]
buffer_load_dwordx4 v8, s[12:15], s24 offen offset:2048 lds
M v[200:203], a[48:51], a[168:171], v[200:203]
M v[200:203], a[52:55], a[172:175], v[200:203]
ds_read_b64_tr_b16 a[156:157], v19 offset:49152
ds_read_b64_tr_b16 a[158:159], v19 offset:51200
M v[204:207], a[60:63], a[172:175], v[204:207]
M v[204:207], a[56:59], a[168:171], v[204:207]
M v[208:211], a[64:67], a[168:171], v[208:211]
M v[208:211], a[68:71], a[172:175], v[208:211]
buffer_load_dwordx4 v9, s[12:15], s24 offen offset:3072 lds
M v[212:215], a[76:79], a[172:175], v[212:215]
M v[212:215], a[72:75], a[168:171], v[212:215]
M v[216:219], a[80:83], a[168:171], v[216:219]
M v[216:219], a[84:87], a[172:175], v[216:219]
M v[220:223], a[92:95], a[172:175], v[220:223]
s_add_u32 s24, s24, 262144
M v[220:223], a[88:91], a[168:171], v[220:223]
s_waitcnt lgkmcnt(10)
M v[224:227], a[32:35], a[176:179], v[224:227]
M v[224:227], a[36:39], a[180:183], v[224:227]
M v[228:231], a[44:47], a[180:183], v[228:231]
M v[228:231], a[40:43], a[176:179], v[228:231]
M v[232:235], a[48:51], a[176:179], v[232:235]
M v[232:235], a[52:55], a[180:183], v[232:235]
M v[236:239], a[60:63], a[180:183], v[236:239]
M v[236:239], a[56:59], a[176:179], v[236:239]
s_waitcnt vmcnt(16) lgkmcnt(0)
s_barrier
ds_read_b128 a[160:163], v10 offset:32768
ds_read_b128 a[164:167], v11 offset:32768
M v[240:243], a[64:67], a[176:179], v[240:243]
s_add_u32 m0, s29, 16384
s_add_u32 s3, s23, s31
buffer_load_dwordx4 v2, s[8:11], s3 offen offset:0 lds
M v[240:243], a[68:71], a[180:183], v[240:243]
M v[244:247], a[76:79], a[180:183], v[244:247]
M v[244:247], a[72:75], a[176:179], v[244:247]
M v[248:251], a[80:83], a[176:179], v[248:251]
M v[248:251], a[84:87], a[180:183], v[248:251]
buffer_load_dwordx4 v3, s[8:11], s3 offen offset:1024 lds
M v[252:255], a[92:95], a[180:183], v[252:255]
M v[252:255], a[88:91], a[176:179], v[252:255]
M a[0:3], a[32:35], a[184:187], a[0:3]
M a[0:3], a[36:39], a[188:191], a[0:3]
ds_read_b128 a[168:171], v10 offset:34816
ds_read_b128 a[172:175], v11 offset:34816
M a[4:7], a[44:47], a[188:191], a[4:7]
M a[4:7], a[40:43], a[184:187], a[4:7]
M a[8:11], a[48:51], a[184:187], a[8:11]
buffer_load_dwordx4 v4, s[8:11], s3 offen offset:2048 lds
M a[8:11], a[52:55], a[188:191], a[8:11]
M a[12:15], a[60:63], a[188:191], a[12:15]
M a[12:15], a[56:59], a[184:187], a[12:15]
M a[16:19], a[64:67], a[184:187], a[16:19]
M a[16:19], a[68:71], a[188:191], a[16:19]
buffer_load_dwordx4 v5, s[8:11], s3 offen offset:3072 lds
M a[20:23], a[76:79], a[188:191], a[20:23]
M a[20:23], a[72:75], a[184:187], a[20:23]
M a[24:27], a[80:83], a[184:187], a[24:27]
M a[24:27], a[84:87], a[188:191], a[24:27]
M a[28:31], a[92:95], a[188:191], a[28:31]
M a[28:31], a[88:91], a[184:187], a[28:31]
s_waitcnt lgkmcnt(2)
M v[32:35], a[96:99], a[160:163], v[32:35]
s_add_u32 s23, s23, 128
s_cmp_eq_u32 s23, s25
s_cselect_b32 s23, s26, s23
M v[32:35], a[100:103], a[164:167], v[32:35]
ds_read_b128 a[176:179], v10 offset:36864
ds_read_b128 a[180:183], v11 offset:36864
M v[36:39], a[108:111], a[164:167], v[36:39]
M v[36:39], a[104:107], a[160:163], v[36:39]
ds_read_b64_tr_b16 a[32:33], v12 offset:0
ds_read_b64_tr_b16 a[34:35], v12 offset:2048
M v[40:43], a[112:115], a[160:163], v[40:43]
M v[40:43], a[116:119], a[164:167], v[40:43]
M v[44:47], a[124:127], a[164:167], v[44:47]
s_add_u32 m0, s29, 114688
s_nop 0
buffer_load_dwordx4 v6, s[12:15], s24 offen offset:0 lds
M v[44:47], a[120:123], a[160:163], v[44:47]
ds_read_b64_tr_b16 a[40:41], v13 offset:0
ds_read_b64_tr_b16 a[42:43], v13 offset:2048
M v[48:51], a[128:131], a[160:163], v[48:51]
M v[48:51], a[132:135], a[164:167], v[48:51]
M v[52:55], a[140:143], a[164:167], v[52:55]
M v[52:55], a[136:139], a[160:163], v[52:55]
ds_read_b64_tr_b16 a[48:49], v14 offset:0
ds_read_b64_tr_b16 a[50:51], v14 offset:2048
M v[56:59], a[144:147], a[160:163], v[56:59]
M v[56:59], a[148:151], a[164:167], v[56:59]
buffer_load_dwordx4 v7, s[12:15], s24 offen offset:1024 lds
M v[60:63], a[156:159], a[164:167], v[60:63]
M v[60:63], a[152:155], a[160:163], v[60:63]
s_waitcnt lgkmcnt(8)
ds_read_b64_tr_b16 a[56:57], v15 offset:0
ds_read_b64_tr_b16 a[58:59], v15 offset:2048
M v[64:67], a[96:99], a[168:171], v[64:67]
M v[64:67], a[100:103], a[172:175], v[64:67]
ds_read_b128 a[184:187], v10 offset:38912
ds_read_b128 a[188:191], v11 offset:38912
M v[68:71], a[108:111], a[172:175], v[68:71]
M v[68:71], a[104:107], a[168:171], v[68:71]
ds_read_b64_tr_b16 a[64:65], v16 offset:0
ds_read_b64_tr_b16 a[66:67], v16 offset:2048
M v[72:75], a[112:115], a[168:171], v[72:75]
buffer_load_dwordx4 v8, s[12:15], s24 offen offset:2048 lds
M v[72:75], a[116:119], a[172:175], v[72:75]
M v[76:79], a[124:127], a[172:175], v[76:79]
M v[76:79], a[120:123], a[168:171], v[76:79]
ds_read_b64_tr_b16 a[72:73], v17 offset:0
ds_read_b64_tr_b16 a[74:75], v17 offset:2048
M v[80:83], a[128:131], a[168:171], v[80:83]
M v[80:83], a[132:135], a[172:175], v[80:83]
M v[84:87], a[140:143], a[172:175], v[84:87]
buffer_load_dwordx4 v9, s[12:15], s24 offen offset:3072 lds
M v[84:87], a[136:139], a[168:171], v[84:87]
ds_read_b64_tr_b16 a[80:81], v18 offset:0
ds_read_b64_tr_b16 a[82:83], v18 offset:2048
M v[88:91], a[144:147], a[168:171], v[88:91]
M v[88:91], a[148:151], a[172:175], v[88:91]
M v[92:95], a[156:159], a[172:175], v[92:95]
M v[92:95], a[152:155], a[168:171], v[92:95]
s_waitcnt lgkmcnt(15)
ds_read_b64_tr_b16 a[88:89], v19 offset:0
ds_read_b64_tr_b16 a[90:91], v19 offset:2048
M v[96:99], a[96:99], a[176:179], v[96:99]
s_add_u32 s24, s24, 262144
s_cmp_eq_u32 s24, s27
s_cselect_b32 s24, s28, s24
s_sub_u32 s6, s6, 1
s_cmp_eq_u32 s6, 0
s_cselect_b64 s[12:13], s[64:65], s[12:13]
M v[96:99], a[100:103], a[180:183], v[96:99]
M v[100:103], a[108:111], a[180:183], v[100:103]
M v[100:103], a[104:107], a[176:179], v[100:103]
M v[104:107], a[112:115], a[176:179], v[104:107]
M v[104:107], a[116:119], a[180:183], v[104:107]
M v[108:111], a[124:127], a[180:183], v[108:111]
M v[108:111], a[120:123], a[176:179], v[108:111]
s_waitcnt vmcnt(16) lgkmcnt(0)
s_barrier
ds_read_b128 a[160:163], v10 offset:49152
ds_read_b128 a[164:167], v11 offset:49152
M v[112:115], a[128:131], a[176:179], v[112:115]
s_add_u32 m0, s29, 32768
s_nop 0
buffer_load_dwordx4 v2, s[8:11], s23 offen offset:0 lds
M v[112:115], a[132:135], a[180:183], v[112:115]
M v[116:119], a[140:143], a[180:183], v[116:119]
M v[116:119], a[136:139], a[176:179], v[116:119]
ds_read_b64_tr_b16 a[36:37], v12 offset:16384
ds_read_b64_tr_b16 a[38:39], v12 offset:18432
M v[120:123], a[144:147], a[176:179], v[120:123]
M v[120:123], a[148:151], a[180:183], v[120:123]
M v[124:127], a[156:159], a[180:183], v[124:127]
buffer_load_dwordx4 v3, s[8:11], s23 offen offset:1024 lds
M v[124:127], a[152:155], a[176:179], v[124:127]
M v[128:131], a[96:99], a[184:187], v[128:131]
M v[128:131], a[100:103], a[188:191], v[128:131]
ds_read_b128 a[168:171], v10 offset:51200
ds_read_b128 a[172:175], v11 offset:51200
ds_read_b64_tr_b16 a[44:45], v13 offset:16384
ds_read_b64_tr_b16 a[46:47], v13 offset:18432
M v[132:135], a[108:111], a[188:191], v[132:135]
M v[132:135], a[104:107], a[184:187], v[132:135]
M v[136:139], a[112:115], a[184:187], v[136:139]
M v[136:139], a[116:119], a[188:191], v[136:139]
buffer_load_dwordx4 v4, s[8:11], s23 offen offset:2048 lds
M v[140:143], a[124:127], a[188:191], v[140:143]
M v[140:143], a[120:123], a[184:187], v[140:143]
ds_read_b64_tr_b16 a[52:53], v14 offset:16384
ds_read_b64_tr_b16 a[54:55], v14 offset:18432
M v[144:147], a[128:131], a[184:187], v[144:147]
M v[144:147], a[132:135], a[188:191], v[144:147]
M v[148:151], a[140:143], a[188:191], v[148:151]
M v[148:151], a[136:139], a[184:187], v[148:151]
M v[152:155], a[144:147], a[184:187], v[152:155]
buffer_load_dwordx4 v5, s[8:11], s23 offen offset:3072 lds
M v[152:155], a[148:151], a[188:191], v[152:155]
ds_read_b64_tr_b16 a[60:61], v15 offset:16384
ds_read_b64_tr_b16 a[62:63], v15 offset:18432
M v[156:159], a[156:159], a[188:191], v[156:159]
M v[156:159], a[152:155], a[184:187], v[156:159]
s_waitcnt lgkmcnt(10)
M v[160:163], a[96:99], a[160:163], v[160:163]
M v[160:163], a[100:103], a[164:167], v[160:163]
ds_read_b128 a[176:179], v10 offset:53248
ds_read_b128 a[180:183], v11 offset:53248
M v[164:167], a[108:111], a[164:167], v[164:167]
M v[164:167], a[104:107], a[160:163], v[164:167]
ds_read_b64_tr_b16 a[68:69], v16 offset:16384
ds_read_b64_tr_b16 a[70:71], v16 offset:18432
M v[168:171], a[112:115], a[160:163], v[168:171]
M v[168:171], a[116:119], a[164:167], v[168:171]
s_add_u32 m0, s29, 65536
s_nop 0
buffer_load_dwordx4 v6, s[12:15], s24 offen offset:0 lds
M v[172:175], a[124:127], a[164:167], v[172:175]
M v[172:175], a[120:123], a[160:163], v[172:175]
M v[176:179], a[128:131], a[160:163], v[176:179]
M v[176:179], a[132:135], a[164:167], v[176:179]
ds_read_b64_tr_b16 a[76:77], v17 offset:16384
ds_read_b64_tr_b16 a[78:79], v17 offset:18432
M v[180:183], a[140:143], a[164:167], v[180:183]
M v[180:183], a[136:139], a[160:163], v[180:183]
buffer_load_dwordx4 v7, s[12:15], s24 offen offset:1024 lds
M v[184:187], a[144:147], a[160:163], v[184:187]
M v[184:187], a[148:151], a[164:167], v[184:187]
M v[188:191], a[156:159], a[164:167], v[188:191]
M v[188:191], a[152:155], a[160:163], v[188:191]
s_waitcnt lgkmcnt(12)
ds_read_b64_tr_b16 a[84:85], v18 offset:16384
ds_read_b64_tr_b16 a[86:87], v18 offset:18432
M v[192:195], a[96:99], a[168:171], v[192:195]
M v[192:195], a[100:103], a[172:175], v[192:195]
ds_read_b128 a[184:187], v10 offset:55296
ds_read_b128 a[188:191], v11 offset:55296
M v[196:199], a[108:111], a[172:175], v[196:199]
M v[196:199], a[104:107], a[168:171], v[196:199]
buffer_load_dwordx4 v8, s[12:15], s24 offen offset:2048 lds
M v[200:203], a[112:115], a[168:171], v[200:203]
M v[200:203], a[116:119], a[172:175], v[200:203]
ds_read_b64_tr_b16 a[92:93], v19 offset:16384
ds_read_b64_tr_b16 a[94:95], v19 offset:18432
M v[204:207], a[124:127], a[172:175], v[204:207]
M v[204:207], a[120:123], a[168:171], v[204:207]
M v[208:211], a[128:131], a[168:171], v[208:211]
M v[208:211], a[132:135], a[172:175], v[208:211]
buffer_load_dwordx4 v9, s[12:15], s24 offen offset:3072 lds
M v[212:215], a[140:143], a[172:175], v[212:215]
M v[212:215], a[136:139], a[168:171], v[212:215]
M v[216:219], a[144:147], a[168:171], v[216:219]
M v[216:219], a[148:151], a[172:175], v[216:219]
M v[220:223], a[156:159], a[172:175], v[220:223]
s_add_u32 s24, s24, 262144
M v[220:223], a[152:155], a[168:171], v[220:223]
s_waitcnt lgkmcnt(10)
M v[224:227], a[96:99], a[176:179], v[224:227]
M v[224:227], a[100:103], a[180:183], v[224:227]
M v[228:231], a[108:111], a[180:183], v[228:231]
M v[228:231], a[104:107], a[176:179], v[228:231]
M v[232:235], a[112:115], a[176:179], v[232:235]
M v[232:235], a[116:119], a[180:183], v[232:235]
M v[236:239], a[124:127], a[180:183], v[236:239]
M v[236:239], a[120:123], a[176:179], v[236:239]
s_waitcnt vmcnt(16) lgkmcnt(0)
s_barrier
ds_read_b128 a[160:163], v10 offset:0
ds_read_b128 a[164:167], v11 offset:0
M v[240:243], a[128:131], a[176:179], v[240:243]
s_add_u32 m0, s29, 49152
s_add_u32 s3, s23, s31
buffer_load_dwordx4 v2, s[8:11], s3 offen offset:0 lds
M v[240:243], a[132:135], a[180:183], v[240:243]
M v[244:247], a[140:143], a[180:183], v[244:247]
M v[244:247], a[136:139], a[176:179], v[244:247]
M v[248:251], a[144:147], a[176:179], v[248:251]
M v[248:251], a[148:151], a[180:183], v[248:251]
buffer_load_dwordx4 v3, s[8:11], s3 offen offset:1024 lds
M v[252:255], a[156:159], a[180:183], v[252:255]
M v[252:255], a[152:155], a[176:179], v[252:255]
M a[0:3], a[96:99], a[184:187], a[0:3]
M a[0:3], a[100:103], a[188:191], a[0:3]
ds_read_b128 a[168:171], v10 offset:2048
ds_read_b128 a[172:175], v11 offset:2048
M a[4:7], a[108:111], a[188:191], a[4:7]
M a[4:7], a[104:107], a[184:187], a[4:7]
M a[8:11], a[112:115], a[184:187], a[8:11]
buffer_load_dwordx4 v4, s[8:11], s3 offen offset:2048 lds
M a[8:11], a[116:119], a[188:191], a[8:11]
M a[12:15], a[124:127], a[188:191], a[12:15]
M a[12:15], a[120:123], a[184:187], a[12:15]
M a[16:19], a[128:131], a[184:187], a[16:19]
M a[16:19], a[132:135], a[188:191], a[16:19]
buffer_load_dwordx4 v5, s[8:11], s3 offen offset:3072 lds
M a[20:23], a[140:143], a[188:191], a[20:23]
M a[20:23], a[136:139], a[184:187], a[20:23]
M a[24:27], a[144:147], a[184:187], a[24:27]
M a[24:27], a[148:151], a[188:191], a[24:27]
M a[28:31], a[156:159], a[188:191], a[28:31]
M a[28:31], a[152:155], a[184:187], a[28:31]
s_waitcnt lgkmcnt(2)
s_sub_u32 s30, s30, 1
s_cmp_lg_u32 s30, 0
s_cbranch_scc1 Lk1_kl
M v[32:35], a[32:35], a[160:163], v[32:35]
s_add_u32 s23, s23, 128
s_cmp_eq_u32 s23, s25
s_cselect_b32 s23, s26, s23
M v[32:35], a[36:39], a[164:167], v[32:35]
ds_read_b128 a[176:179], v10 offset:4096
ds_read_b128 a[180:183], v11 offset:4096
M v[36:39], a[44:47], a[164:167], v[36:39]
M v[36:39], a[40:43], a[160:163], v[36:39]
ds_read_b64_tr_b16 a[96:97], v12 offset:32768
ds_read_b64_tr_b16 a[98:99], v12 offset:34816
M v[40:43], a[48:51], a[160:163], v[40:43]
M v[40:43], a[52:55], a[164:167], v[40:43]
M v[44:47], a[60:63], a[164:167], v[44:47]
s_add_u32 m0, s29, 81920
s_nop 0
buffer_load_dwordx4 v6, s[12:15], s24 offen offset:0 lds
M v[44:47], a[56:59], a[160:163], v[44:47]
ds_read_b64_tr_b16 a[104:105], v13 offset:32768
ds_read_b64_tr_b16 a[106:107], v13 offset:34816
M v[48:51], a[64:67], a[160:163], v[48:51]
M v[48:51], a[68:71], a[164:167], v[48:51]
M v[52:55], a[76:79], a[164:167], v[52:55]
M v[52:55], a[72:75], a[160:163], v[52:55]
ds_read_b64_tr_b16 a[112:113], v14 offset:32768
ds_read_b64_tr_b16 a[114:115], v14 offset:34816
M v[56:59], a[80:83], a[160:163], v[56:59]
M v[56:59], a[84:87], a[164:167], v[56:59]
buffer_load_dwordx4 v7, s[12:15], s24 offen offset:1024 lds
M v[60:63], a[92:95], a[164:167], v[60:63]
M v[60:63], a[88:91], a[160:163], v[60:63]
s_waitcnt lgkmcnt(8)
ds_read_b64_tr_b16 a[120:121], v15 offset:32768
ds_read_b64_tr_b16 a[122:123], v15 offset:34816
M v[64:67], a[32:35], a[168:171], v[64:67]
M v[64:67], a[36:39], a[172:175], v[64:67]
ds_read_b128 a[184:187], v10 offset:6144
ds_read_b128 a[188:191], v11 offset:6144
M v[68:71], a[44:47], a[172:175], v[68:71]
M v[68:71], a[40:43], a[168:171], v[68:71]
ds_read_b64_tr_b16 a[128:129], v16 offset:32768
ds_read_b64_tr_b16 a[130:131], v16 offset:34816
M v[72:75], a[48:51], a[168:171], v[72:75]
buffer_load_dwordx4 v8, s[12:15], s24 offen offset:2048 lds
M v[72:75], a[52:55], a[172:175], v[72:75]
M v[76:79], a[60:63], a[172:175], v[76:79]
M v[76:79], a[56:59], a[168:171], v[76:79]
ds_read_b64_tr_b16 a[136:137], v17 offset:32768
ds_read_b64_tr_b16 a[138:139], v17 offset:34816
M v[80:83], a[64:67], a[168:171], v[80:83]
M v[80:83], a[68:71], a[172:175], v[80:83]
M v[84:87], a[76:79], a[172:175], v[84:87]
buffer_load_dwordx4 v9, s[12:15], s24 offen offset:3072 lds
M v[84:87], a[72:75], a[168:171], v[84:87]
ds_read_b64_tr_b16 a[144:145], v18 offset:32768
ds_read_b64_tr_b16 a[146:147], v18 offset:34816
M v[88:91], a[80:83], a[168:171], v[88:91]
M v[88:91], a[84:87], a[172:175], v[88:91]
M v[92:95], a[92:95], a[172:175], v[92:95]
M v[92:95], a[88:91], a[168:171], v[92:95]
s_waitcnt lgkmcnt(15)
ds_read_b64_tr_b16 a[152:153], v19 offset:32768
ds_read_b64_tr_b16 a[154:155], v19 offset:34816
M v[96:99], a[32:35], a[176:179], v[96:99]
s_add_u32 s24, s24, 262144
s_cmp_eq_u32 s24, s27
s_cselect_b32 s24, s28, s24
s_sub_u32 s6, s6, 1
s_cmp_eq_u32 s6, 0
s_cselect_b64 s[12:13], s[64:65], s[12:13]
M v[96:99], a[36:39], a[180:183], v[96:99]
M v[100:103], a[44:47], a[180:183], v[100:103]
M v[100:103], a[40:43], a[176:179], v[100:103]
M v[104:107], a[48:51], a[176:179], v[104:107]
M v[104:107], a[52:55], a[180:183], v[104:107]
M v[108:111], a[60:63], a[180:183], v[108:111]
M v[108:111], a[56:59], a[176:179], v[108:111]
s_waitcnt vmcnt(16) lgkmcnt(0)
s_barrier
ds_read_b128 a[160:163], v10 offset:16384
ds_read_b128 a[164:167], v11 offset:16384
M v[112:115], a[64:67], a[176:179], v[112:115]
s_add_u32 m0, s29, 0
s_nop 0
buffer_load_dwordx4 v2, s[8:11], s23 offen offset:0 lds
M v[112:115], a[68:71], a[180:183], v[112:115]
M v[116:119], a[76:79], a[180:183], v[116:119]
M v[116:119], a[72:75], a[176:179], v[116:119]
ds_read_b64_tr_b16 a[100:101], v12 offset:49152
ds_read_b64_tr_b16 a[102:103], v12 offset:51200
M v[120:123], a[80:83], a[176:179], v[120:123]
M v[120:123], a[84:87], a[180:183], v[120:123]
M v[124:127], a[92:95], a[180:183], v[124:127]
buffer_load_dwordx4 v3, s[8:11], s23 offen offset:1024 lds
M v[124:127], a[88:91], a[176:179], v[124:127]
M v[128:131], a[32:35], a[184:187], v[128:131]
M v[128:131], a[36:39], a[188:191], v[128:131]
ds_read_b128 a[168:171], v10 offset:18432
ds_read_b128 a[172:175], v11 offset:18432
ds_read_b64_tr_b16 a[108:109], v13 offset:49152
ds_read_b64_tr_b16 a[110:111], v13 offset:51200
M v[132:135], a[44:47], a[188:191], v[132:135]
M v[132:135], a[40:43], a[184:187], v[132:135]
M v[136:139], a[48:51], a[184:187], v[136:139]
M v[136:139], a[52:55], a[188:191], v[136:139]
buffer_load_dwordx4 v4, s[8:11], s23 offen offset:2048 lds
M v[140:143], a[60:63], a[188:191], v[140:143]
M v[140:143], a[56:59], a[184:187], v[140:143]
ds_read_b64_tr_b16 a[116:117], v14 offset:49152
ds_read_b64_tr_b16 a[118:119], v14 offset:51200
M v[144:147], a[64:67], a[184:187], v[144:147]
M v[144:147], a[68:71], a[188:191], v[144:147]
M v[148:151], a[76:79], a[188:191], v[148:151]
M v[148:151], a[72:75], a[184:187], v[148:151]
M v[152:155], a[80:83], a[184:187], v[152:155]
buffer_load_dwordx4 v5, s[8:11], s23 offen offset:3072 lds
s_lshr_b32 s3, s53, 7
s_add_u32 s3, s3, s22
M v[152:155], a[84:87], a[188:191], v[152:155]
ds_read_b64_tr_b16 a[124:125], v15 offset:49152
ds_read_b64_tr_b16 a[126:127], v15 offset:51200
s_lshl_b32 s3, s3, 5
s_lshr_b32 s19, s52, 6
M v[156:159], a[92:95], a[188:191], v[156:159]
s_add_u32 s3, s3, s19
s_lshl_b32 s19, s21, 1
M v[156:159], a[88:91], a[184:187], v[156:159]
s_waitcnt lgkmcnt(10)
s_add_u32 s3, s3, s19
s_lshl_b32 s92, s3, 15
M v[160:163], a[32:35], a[160:163], v[160:163]
s_add_u32 s93, s92, 32768
s_add_u32 s16, s50, 16777216
M v[160:163], a[36:39], a[164:167], v[160:163]
ds_read_b128 a[176:179], v10 offset:20480
ds_read_b128 a[180:183], v11 offset:20480
s_addc_u32 s17, s51, 0
s_mov_b32 s18, 33554432
M v[164:167], a[44:47], a[164:167], v[164:167]
s_mov_b32 s19, 0x00020000
M v[164:167], a[40:43], a[160:163], v[164:167]
ds_read_b64_tr_b16 a[132:133], v16 offset:49152
ds_read_b64_tr_b16 a[134:135], v16 offset:51200
M v[168:171], a[48:51], a[160:163], v[168:171]
M v[168:171], a[52:55], a[164:167], v[168:171]
s_add_u32 m0, s29, 98304
s_nop 0
buffer_load_dwordx4 v6, s[12:15], s24 offen offset:0 lds
M v[172:175], a[60:63], a[164:167], v[172:175]
M v[172:175], a[56:59], a[160:163], v[172:175]
M v[176:179], a[64:67], a[160:163], v[176:179]
M v[176:179], a[68:71], a[164:167], v[176:179]
ds_read_b64_tr_b16 a[140:141], v17 offset:49152
ds_read_b64_tr_b16 a[142:143], v17 offset:51200
M v[180:183], a[76:79], a[164:167], v[180:183]
M v[180:183], a[72:75], a[160:163], v[180:183]
buffer_load_dwordx4 v7, s[12:15], s24 offen offset:1024 lds
M v[184:187], a[80:83], a[160:163], v[184:187]
M v[184:187], a[84:87], a[164:167], v[184:187]
M v[188:191], a[92:95], a[164:167], v[188:191]
M v[188:191], a[88:91], a[160:163], v[188:191]
s_waitcnt lgkmcnt(12)
ds_read_b64_tr_b16 a[148:149], v18 offset:49152
ds_read_b64_tr_b16 a[150:151], v18 offset:51200
M v[192:195], a[32:35], a[168:171], v[192:195]
M v[192:195], a[36:39], a[172:175], v[192:195]
ds_read_b128 a[184:187], v10 offset:22528
ds_read_b128 a[188:191], v11 offset:22528
M v[196:199], a[44:47], a[172:175], v[196:199]
M v[196:199], a[40:43], a[168:171], v[196:199]
buffer_load_dwordx4 v8, s[12:15], s24 offen offset:2048 lds
M v[200:203], a[48:51], a[168:171], v[200:203]
M v[200:203], a[52:55], a[172:175], v[200:203]
ds_read_b64_tr_b16 a[156:157], v19 offset:49152
ds_read_b64_tr_b16 a[158:159], v19 offset:51200
M v[204:207], a[60:63], a[172:175], v[204:207]
M v[204:207], a[56:59], a[168:171], v[204:207]
M v[208:211], a[64:67], a[168:171], v[208:211]
M v[208:211], a[68:71], a[172:175], v[208:211]
buffer_load_dwordx4 v9, s[12:15], s24 offen offset:3072 lds
M v[212:215], a[76:79], a[172:175], v[212:215]
M v[212:215], a[72:75], a[168:171], v[212:215]
M v[216:219], a[80:83], a[168:171], v[216:219]
M v[216:219], a[84:87], a[172:175], v[216:219]
M v[220:223], a[92:95], a[172:175], v[220:223]
s_add_u32 s24, s24, 262144
M v[220:223], a[88:91], a[168:171], v[220:223]
s_waitcnt lgkmcnt(10)
M v[224:227], a[32:35], a[176:179], v[224:227]
M v[224:227], a[36:39], a[180:183], v[224:227]
M v[228:231], a[44:47], a[180:183], v[228:231]
M v[228:231], a[40:43], a[176:179], v[228:231]
M v[232:235], a[48:51], a[176:179], v[232:235]
M v[232:235], a[52:55], a[180:183], v[232:235]
M v[236:239], a[60:63], a[180:183], v[236:239]
M v[236:239], a[56:59], a[176:179], v[236:239]
s_waitcnt vmcnt(16) lgkmcnt(0)
s_barrier
ds_read_b128 a[160:163], v10 offset:32768
ds_read_b128 a[164:167], v11 offset:32768
M v[240:243], a[64:67], a[176:179], v[240:243]
s_add_u32 m0, s29, 16384
s_add_u32 s3, s23, s31
buffer_load_dwordx4 v2, s[8:11], s3 offen offset:0 lds
M v[240:243], a[68:71], a[180:183], v[240:243]
M v[244:247], a[76:79], a[180:183], v[244:247]
M v[244:247], a[72:75], a[176:179], v[244:247]
M v[248:251], a[80:83], a[176:179], v[248:251]
M v[248:251], a[84:87], a[180:183], v[248:251]
buffer_load_dwordx4 v3, s[8:11], s3 offen offset:1024 lds
M v[252:255], a[92:95], a[180:183], v[252:255]
M v[252:255], a[88:91], a[176:179], v[252:255]
M a[0:3], a[32:35], a[184:187], a[0:3]
M a[0:3], a[36:39], a[188:191], a[0:3]
ds_read_b128 a[168:171], v10 offset:34816
ds_read_b128 a[172:175], v11 offset:34816
M a[4:7], a[44:47], a[188:191], a[4:7]
M a[4:7], a[40:43], a[184:187], a[4:7]
M a[8:11], a[48:51], a[184:187], a[8:11]
buffer_load_dwordx4 v4, s[8:11], s3 offen offset:2048 lds
M a[8:11], a[52:55], a[188:191], a[8:11]
M a[12:15], a[60:63], a[188:191], a[12:15]
M a[12:15], a[56:59], a[184:187], a[12:15]
M a[16:19], a[64:67], a[184:187], a[16:19]
M a[16:19], a[68:71], a[188:191], a[16:19]
buffer_load_dwordx4 v5, s[8:11], s3 offen offset:3072 lds
M a[20:23], a[76:79], a[188:191], a[20:23]
M a[20:23], a[72:75], a[184:187], a[20:23]
M a[24:27], a[80:83], a[184:187], a[24:27]
M a[24:27], a[84:87], a[188:191], a[24:27]
M a[28:31], a[92:95], a[188:191], a[28:31]
M a[28:31], a[88:91], a[184:187], a[28:31]
s_waitcnt lgkmcnt(2)
M v[32:35], a[96:99], a[160:163], v[32:35]
s_add_u32 s23, s23, 128
s_cmp_eq_u32 s23, s25
s_cselect_b32 s23, s26, s23
M v[32:35], a[100:103], a[164:167], v[32:35]
ds_read_b128 a[176:179], v10 offset:36864
ds_read_b128 a[180:183], v11 offset:36864
M v[36:39], a[108:111], a[164:167], v[36:39]
M v[36:39], a[104:107], a[160:163], v[36:39]
ds_read_b64_tr_b16 a[32:33], v12 offset:0
ds_read_b64_tr_b16 a[34:35], v12 offset:2048
M v[40:43], a[112:115], a[160:163], v[40:43]
M v[40:43], a[116:119], a[164:167], v[40:43]
M v[44:47], a[124:127], a[164:167], v[44:47]
s_add_u32 m0, s29, 114688
s_nop 0
buffer_load_dwordx4 v6, s[12:15], s24 offen offset:0 lds
M v[44:47], a[120:123], a[160:163], v[44:47]
ds_read_b64_tr_b16 a[40:41], v13 offset:0
ds_read_b64_tr_b16 a[42:43], v13 offset:2048
M v[48:51], a[128:131], a[160:163], v[48:51]
M v[48:51], a[132:135], a[164:167], v[48:51]
M v[52:55], a[140:143], a[164:167], v[52:55]
M v[52:55], a[136:139], a[160:163], v[52:55]
ds_read_b64_tr_b16 a[48:49], v14 offset:0
ds_read_b64_tr_b16 a[50:51], v14 offset:2048
M v[56:59], a[144:147], a[160:163], v[56:59]
buffer_load_dwordx4 v7, s[12:15], s24 offen offset:1024 lds
M v[56:59], a[148:151], a[164:167], v[56:59]
M v[60:63], a[156:159], a[164:167], v[60:63]
M v[60:63], a[152:155], a[160:163], v[60:63]
s_waitcnt lgkmcnt(8)
ds_read_b64_tr_b16 a[56:57], v15 offset:0
ds_read_b64_tr_b16 a[58:59], v15 offset:2048
M v[64:67], a[96:99], a[168:171], v[64:67]
M v[64:67], a[100:103], a[172:175], v[64:67]
ds_read_b128 a[184:187], v10 offset:38912
ds_read_b128 a[188:191], v11 offset:38912
M v[68:71], a[108:111], a[172:175], v[68:71]
M v[68:71], a[104:107], a[168:171], v[68:71]
ds_read_b64_tr_b16 a[64:65], v16 offset:0
ds_read_b64_tr_b16 a[66:67], v16 offset:2048
v_cvt_pk_bf16_f32 v32, v32, v33
v_cvt_pk_bf16_f32 v33, v34, v35
M v[72:75], a[112:115], a[168:171], v[72:75]
buffer_load_dwordx4 v8, s[12:15], s24 offen offset:2048 lds
v_cvt_pk_bf16_f32 v34, v36, v37
v_cvt_pk_bf16_f32 v35, v38, v39
M v[72:75], a[116:119], a[172:175], v[72:75]
v_cvt_pk_bf16_f32 v40, v40, v41
v_cvt_pk_bf16_f32 v41, v42, v43
M v[76:79], a[124:127], a[172:175], v[76:79]
v_cvt_pk_bf16_f32 v42, v44, v45
v_cvt_pk_bf16_f32 v43, v46, v47
M v[76:79], a[120:123], a[168:171], v[76:79]
ds_read_b64_tr_b16 a[72:73], v17 offset:0
ds_read_b64_tr_b16 a[74:75], v17 offset:2048
v_cvt_pk_bf16_f32 v48, v48, v49
v_cvt_pk_bf16_f32 v49, v50, v51
M v[80:83], a[128:131], a[168:171], v[80:83]
v_cvt_pk_bf16_f32 v50, v52, v53
v_cvt_pk_bf16_f32 v51, v54, v55
M v[80:83], a[132:135], a[172:175], v[80:83]
buffer_load_dwordx4 v9, s[12:15], s24 offen offset:3072 lds
v_cvt_pk_bf16_f32 v56, v56, v57
v_cvt_pk_bf16_f32 v57, v58, v59
M v[84:87], a[140:143], a[172:175], v[84:87]
v_cvt_pk_bf16_f32 v58, v60, v61
v_cvt_pk_bf16_f32 v59, v62, v63
M v[84:87], a[136:139], a[168:171], v[84:87]
ds_read_b64_tr_b16 a[80:81], v18 offset:0
ds_read_b64_tr_b16 a[82:83], v18 offset:2048
M v[88:91], a[144:147], a[168:171], v[88:91]
M v[88:91], a[148:151], a[172:175], v[88:91]
M v[92:95], a[156:159], a[172:175], v[92:95]
s_add_u32 s94, s92, 0
buffer_store_dwordx4 v[32:35], v1, s[16:19], s94 offen offset:0 sc1
M v[92:95], a[152:155], a[168:171], v[92:95]
s_waitcnt lgkmcnt(15)
ds_read_b64_tr_b16 a[88:89], v19 offset:0
ds_read_b64_tr_b16 a[90:91], v19 offset:2048
M v[96:99], a[96:99], a[176:179], v[96:99]
s_add_u32 s24, s24, 262144
s_cmp_eq_u32 s24, s27
s_cselect_b32 s24, s28, s24
s_sub_u32 s6, s6, 1
s_cmp_eq_u32 s6, 0
s_cselect_b64 s[12:13], s[64:65], s[12:13]
M v[96:99], a[100:103], a[180:183], v[96:99]
M v[100:103], a[108:111], a[180:183], v[100:103]
M v[100:103], a[104:107], a[176:179], v[100:103]
v_cvt_pk_bf16_f32 v64, v64, v65
v_cvt_pk_bf16_f32 v65, v66, v67
M v[104:107], a[112:115], a[176:179], v[104:107]
v_cvt_pk_bf16_f32 v66, v68, v69
v_cvt_pk_bf16_f32 v67, v70, v71
M v[104:107], a[116:119], a[180:183], v[104:107]
v_cvt_pk_bf16_f32 v72, v72, v73
v_cvt_pk_bf16_f32 v73, v74, v75
M v[108:111], a[124:127], a[180:183], v[108:111]
v_cvt_pk_bf16_f32 v74, v76, v77
v_cvt_pk_bf16_f32 v75, v78, v79
M v[108:111], a[120:123], a[176:179], v[108:111]
s_waitcnt vmcnt(17) lgkmcnt(0)
s_barrier
ds_read_b128 a[160:163], v10 offset:49152
ds_read_b128 a[164:167], v11 offset:49152
v_cvt_pk_bf16_f32 v80, v80, v81
v_cvt_pk_bf16_f32 v81, v82, v83
M v[112:115], a[128:131], a[176:179], v[112:115]
s_add_u32 s94, s92, 0
buffer_store_dwordx4 v[40:43], v1, s[16:19], s94 offen offset:1024 sc1
v_cvt_pk_bf16_f32 v82, v84, v85
v_cvt_pk_bf16_f32 v83, v86, v87
M v[112:115], a[132:135], a[180:183], v[112:115]
s_add_u32 m0, s29, 32768
s_nop 0
buffer_load_dwordx4 v2, s[8:11], s23 offen offset:0 lds
v_cvt_pk_bf16_f32 v88, v88, v89
v_cvt_pk_bf16_f32 v89, v90, v91
M v[116:119], a[140:143], a[180:183], v[116:119]
v_cvt_pk_bf16_f32 v90, v92, v93
v_cvt_pk_bf16_f32 v91, v94, v95
M v[116:119], a[136:139], a[176:179], v[116:119]
ds_read_b64_tr_b16 a[36:37], v12 offset:16384
ds_read_b64_tr_b16 a[38:39], v12 offset:18432
M v[120:123], a[144:147], a[176:179], v[120:123]
M v[120:123], a[148:151], a[180:183], v[120:123]
M v[124:127], a[156:159], a[180:183], v[124:127]
buffer_load_dwordx4 v3, s[8:11], s23 offen offset:1024 lds
M v[124:127], a[152:155], a[176:179], v[124:127]
M v[128:131], a[96:99], a[184:187], v[128:131]
M v[128:131], a[100:103], a[188:191], v[128:131]
ds_read_b128 a[168:171], v10 offset:51200
ds_read_b128 a[172:175], v11 offset:51200
ds_read_b64_tr_b16 a[44:45], v13 offset:16384
ds_read_b64_tr_b16 a[46:47], v13 offset:18432
M v[132:135], a[108:111], a[188:191], v[132:135]
M v[132:135], a[104:107], a[184:187], v[132:135]
s_add_u32 s94, s92, 0
buffer_store_dwordx4 v[48:51], v1, s[16:19], s94 offen offset:2048 sc1
v_cvt_pk_bf16_f32 v96, v96, v97
v_cvt_pk_bf16_f32 v97, v98, v99
M v[136:139], a[112:115], a[184:187], v[136:139]
v_cvt_pk_bf16_f32 v98, v100, v101
v_cvt_pk_bf16_f32 v99, v102, v103
M v[136:139], a[116:119], a[188:191], v[136:139]
v_cvt_pk_bf16_f32 v104, v104, v105
v_cvt_pk_bf16_f32 v105, v106, v107
M v[140:143], a[124:127], a[188:191], v[140:143]
buffer_load_dwordx4 v4, s[8:11], s23 offen offset:2048 lds
v_cvt_pk_bf16_f32 v106, v108, v109
v_cvt_pk_bf16_f32 v107, v110, v111
M v[140:143], a[120:123], a[184:187], v[140:143]
ds_read_b64_tr_b16 a[52:53], v14 offset:16384
ds_read_b64_tr_b16 a[54:55], v14 offset:18432
v_cvt_pk_bf16_f32 v112, v112, v113
v_cvt_pk_bf16_f32 v113, v114, v115
M v[144:147], a[128:131], a[184:187], v[144:147]
v_cvt_pk_bf16_f32 v114, v116, v117
v_cvt_pk_bf16_f32 v115, v118, v119
M v[144:147], a[132:135], a[188:191], v[144:147]
v_cvt_pk_bf16_f32 v120, v120, v121
v_cvt_pk_bf16_f32 v121, v122, v123
M v[148:151], a[140:143], a[188:191], v[148:151]
v_cvt_pk_bf16_f32 v122, v124, v125
v_cvt_pk_bf16_f32 v123, v126, v127
M v[148:151], a[136:139], a[184:187], v[148:151]
M v[152:155], a[144:147], a[184:187], v[152:155]
buffer_load_dwordx4 v5, s[8:11], s23 offen offset:3072 lds
M v[152:155], a[148:151], a[188:191], v[152:155]
ds_read_b64_tr_b16 a[60:61], v15 offset:16384
ds_read_b64_tr_b16 a[62:63], v15 offset:18432
M v[156:159], a[156:159], a[188:191], v[156:159]
s_add_u32 s94, s92, 0
buffer_store_dwordx4 v[56:59], v1, s[16:19], s94 offen offset:3072 sc1
M v[156:159], a[152:155], a[184:187], v[156:159]
s_waitcnt lgkmcnt(10)
M v[160:163], a[96:99], a[160:163], v[160:163]
M v[160:163], a[100:103], a[164:167], v[160:163]
ds_read_b128 a[176:179], v10 offset:53248
ds_read_b128 a[180:183], v11 offset:53248
M v[164:167], a[108:111], a[164:167], v[164:167]
M v[164:167], a[104:107], a[160:163], v[164:167]
ds_read_b64_tr_b16 a[68:69], v16 offset:16384
ds_read_b64_tr_b16 a[70:71], v16 offset:18432
v_cvt_pk_bf16_f32 v128, v128, v129
v_cvt_pk_bf16_f32 v129, v130, v131
M v[168:171], a[112:115], a[160:163], v[168:171]
v_cvt_pk_bf16_f32 v130, v132, v133
v_cvt_pk_bf16_f32 v131, v134, v135
M v[168:171], a[116:119], a[164:167], v[168:171]
s_add_u32 m0, s29, 65536
s_nop 0
buffer_load_dwordx4 v6, s[12:15], s24 offen offset:0 lds
v_cvt_pk_bf16_f32 v136, v136, v137
v_cvt_pk_bf16_f32 v137, v138, v139
M v[172:175], a[124:127], a[164:167], v[172:175]
v_cvt_pk_bf16_f32 v138, v140, v141
v_cvt_pk_bf16_f32 v139, v142, v143
M v[172:175], a[120:123], a[160:163], v[172:175]
v_cvt_pk_bf16_f32 v144, v144, v145
v_cvt_pk_bf16_f32 v145, v146, v147
M v[176:179], a[128:131], a[160:163], v[176:179]
s_add_u32 s94, s92, 4096
buffer_store_dwordx4 v[64:67], v1, s[16:19], s94 offen offset:0 sc1
v_cvt_pk_bf16_f32 v146, v148, v149
v_cvt_pk_bf16_f32 v147, v150, v151
M v[176:179], a[132:135], a[164:167], v[176:179]
ds_read_b64_tr_b16 a[76:77], v17 offset:16384
ds_read_b64_tr_b16 a[78:79], v17 offset:18432
v_cvt_pk_bf16_f32 v152, v152, v153
v_cvt_pk_bf16_f32 v153, v154, v155
M v[180:183], a[140:143], a[164:167], v[180:183]
v_cvt_pk_bf16_f32 v154, v156, v157
v_cvt_pk_bf16_f32 v155, v158, v159
M v[180:183], a[136:139], a[160:163], v[180:183]
M v[184:187], a[144:147], a[160:163], v[184:187]
buffer_load_dwordx4 v7, s[12:15], s24 offen offset:1024 lds
v_accvgpr_write_b32 a192, v128
v_accvgpr_write_b32 a193, v129
v_accvgpr_write_b32 a194, v130
v_accvgpr_write_b32 a195, v131
M v[184:187], a[148:151], a[164:167], v[184:187]
v_accvgpr_write_b32 a196, v136
v_accvgpr_write_b32 a197, v137
v_accvgpr_write_b32 a198, v138
v_accvgpr_write_b32 a199, v139
M v[188:191], a[156:159], a[164:167], v[188:191]
v_accvgpr_write_b32 a200, v144
v_accvgpr_write_b32 a201, v145
v_accvgpr_write_b32 a202, v146
v_accvgpr_write_b32 a203, v147
M v[188:191], a[152:155], a[160:163], v[188:191]
s_waitcnt lgkmcnt(12)
ds_read_b64_tr_b16 a[84:85], v18 offset:16384
ds_read_b64_tr_b16 a[86:87], v18 offset:18432
v_accvgpr_write_b32 a204, v152
v_accvgpr_write_b32 a205, v153
v_accvgpr_write_b32 a206, v154
v_accvgpr_write_b32 a207, v155
M v[192:195], a[96:99], a[168:171], v[192:195]
M v[192:195], a[100:103], a[172:175], v[192:195]
ds_read_b128 a[184:187], v10 offset:55296
ds_read_b128 a[188:191], v11 offset:55296
M v[196:199], a[108:111], a[172:175], v[196:199]
s_add_u32 s94, s92, 4096
buffer_store_dwordx4 v[72:75], v1, s[16:19], s94 offen offset:1024 sc1
M v[196:199], a[104:107], a[168:171], v[196:199]
v_cvt_pk_bf16_f32 v160, v160, v161
v_cvt_pk_bf16_f32 v161, v162, v163
M v[200:203], a[112:115], a[168:171], v[200:203]
buffer_load_dwordx4 v8, s[12:15], s24 offen offset:2048 lds
v_cvt_pk_bf16_f32 v162, v164, v165
v_cvt_pk_bf16_f32 v163, v166, v167
M v[200:203], a[116:119], a[172:175], v[200:203]
ds_read_b64_tr_b16 a[92:93], v19 offset:16384
ds_read_b64_tr_b16 a[94:95], v19 offset:18432
v_cvt_pk_bf16_f32 v168, v168, v169
v_cvt_pk_bf16_f32 v169, v170, v171
M v[204:207], a[124:127], a[172:175], v[204:207]
v_cvt_pk_bf16_f32 v170, v172, v173
v_cvt_pk_bf16_f32 v171, v174, v175
M v[204:207], a[120:123], a[168:171], v[204:207]
v_cvt_pk_bf16_f32 v176, v176, v177
v_cvt_pk_bf16_f32 v177, v178, v179
M v[208:211], a[128:131], a[168:171], v[208:211]
v_cvt_pk_bf16_f32 v178, v180, v181
v_cvt_pk_bf16_f32 v179, v182, v183
M v[208:211], a[132:135], a[172:175], v[208:211]
buffer_load_dwordx4 v9, s[12:15], s24 offen offset:3072 lds
v_cvt_pk_bf16_f32 v184, v184, v185
v_cvt_pk_bf16_f32 v185, v186, v187
M v[212:215], a[140:143], a[172:175], v[212:215]
v_cvt_pk_bf16_f32 v186, v188, v189
v_cvt_pk_bf16_f32 v187, v190, v191
M v[212:215], a[136:139], a[168:171], v[212:215]
M v[216:219], a[144:147], a[168:171], v[216:219]
v_accvgpr_write_b32 a208, v160
v_accvgpr_write_b32 a209, v161
v_accvgpr_write_b32 a210, v162
v_accvgpr_write_b32 a211, v163
M v[216:219], a[148:151], a[172:175], v[216:219]
s_add_u32 s94, s92, 4096
buffer_store_dwordx4 v[80:83], v1, s[16:19], s94 offen offset:2048 sc1
v_accvgpr_write_b32 a212, v168
v_accvgpr_write_b32 a213, v169
v_accvgpr_write_b32 a214, v170
v_accvgpr_write_b32 a215, v171
M v[220:223], a[156:159], a[172:175], v[220:223]
v_accvgpr_write_b32 a216, v176
v_accvgpr_write_b32 a217, v177
v_accvgpr_write_b32 a218, v178
v_accvgpr_write_b32 a219, v179
M v[220:223], a[152:155], a[168:171], v[220:223]
s_waitcnt lgkmcnt(10)
v_accvgpr_write_b32 a220, v184
v_accvgpr_write_b32 a221, v185
v_accvgpr_write_b32 a222, v186
v_accvgpr_write_b32 a223, v187
M v[224:227], a[96:99], a[176:179], v[224:227]
s_add_u32 s24, s24, 262144
M v[224:227], a[100:103], a[180:183], v[224:227]
M v[228:231], a[108:111], a[180:183], v[228:231]
M v[228:231], a[104:107], a[176:179], v[228:231]
v_cvt_pk_bf16_f32 v192, v192, v193
v_cvt_pk_bf16_f32 v193, v194, v195
M v[232:235], a[112:115], a[176:179], v[232:235]
v_cvt_pk_bf16_f32 v194, v196, v197
v_cvt_pk_bf16_f32 v195, v198, v199
M v[232:235], a[116:119], a[180:183], v[232:235]
v_cvt_pk_bf16_f32 v200, v200, v201
v_cvt_pk_bf16_f32 v201, v202, v203
M v[236:239], a[124:127], a[180:183], v[236:239]
v_cvt_pk_bf16_f32 v202, v204, v205
v_cvt_pk_bf16_f32 v203, v206, v207
M v[236:239], a[120:123], a[176:179], v[236:239]
s_waitcnt vmcnt(23) lgkmcnt(0)
s_barrier
ds_read_b128 a[160:163], v10 offset:0
ds_read_b128 a[164:167], v11 offset:0
v_cvt_pk_bf16_f32 v208, v208, v209
v_cvt_pk_bf16_f32 v209, v210, v211
M v[240:243], a[128:131], a[176:179], v[240:243]
s_add_u32 s94, s92, 4096
buffer_store_dwordx4 v[88:91], v1, s[16:19], s94 offen offset:3072 sc1
v_cvt_pk_bf16_f32 v210, v212, v213
v_cvt_pk_bf16_f32 v211, v214, v215
M v[240:243], a[132:135], a[180:183], v[240:243]
s_add_u32 m0, s29, 49152
s_add_u32 s3, s23, s31
buffer_load_dwordx4 v2, s[8:11], s3 offen offset:0 lds
v_cvt_pk_bf16_f32 v216, v216, v217
v_cvt_pk_bf16_f32 v217, v218, v219
M v[244:247], a[140:143], a[180:183], v[244:247]
v_cvt_pk_bf16_f32 v218, v220, v221
v_cvt_pk_bf16_f32 v219, v222, v223
M v[244:247], a[136:139], a[176:179], v[244:247]
M v[248:251], a[144:147], a[176:179], v[248:251]
v_accvgpr_write_b32 a224, v192
v_accvgpr_write_b32 a225, v193
v_accvgpr_write_b32 a226, v194
v_accvgpr_write_b32 a227, v195
M v[248:251], a[148:151], a[180:183], v[248:251]
buffer_load_dwordx4 v3, s[8:11], s3 offen offset:1024 lds
v_accvgpr_write_b32 a228, v200
v_accvgpr_write_b32 a229, v201
v_accvgpr_write_b32 a230, v202
v_accvgpr_write_b32 a231, v203
M v[252:255], a[156:159], a[180:183], v[252:255]
v_accvgpr_write_b32 a232, v208
v_accvgpr_write_b32 a233, v209
v_accvgpr_write_b32 a234, v210
v_accvgpr_write_b32 a235, v211
M v[252:255], a[152:155], a[176:179], v[252:255]
v_accvgpr_write_b32 a236, v216
v_accvgpr_write_b32 a237, v217
v_accvgpr_write_b32 a238, v218
v_accvgpr_write_b32 a239, v219
M a[0:3], a[96:99], a[184:187], a[0:3]
M a[0:3], a[100:103], a[188:191], a[0:3]
ds_read_b128 a[168:171], v10 offset:2048
ds_read_b128 a[172:175], v11 offset:2048
M a[4:7], a[108:111], a[188:191], a[4:7]
s_add_u32 s94, s92, 8192
buffer_store_dwordx4 v[96:99], v1, s[16:19], s94 offen offset:0 sc1
M a[4:7], a[104:107], a[184:187], a[4:7]
v_cvt_pk_bf16_f32 v224, v224, v225
v_cvt_pk_bf16_f32 v225, v226, v227
M a[8:11], a[112:115], a[184:187], a[8:11]
v_cvt_pk_bf16_f32 v226, v228, v229
v_cvt_pk_bf16_f32 v227, v230, v231
M a[8:11], a[116:119], a[188:191], a[8:11]
buffer_load_dwordx4 v4, s[8:11], s3 offen offset:2048 lds
v_cvt_pk_bf16_f32 v232, v232, v233
v_cvt_pk_bf16_f32 v233, v234, v235
M a[12:15], a[124:127], a[188:191], a[12:15]
v_cvt_pk_bf16_f32 v234, v236, v237
v_cvt_pk_bf16_f32 v235, v238, v239
M a[12:15], a[120:123], a[184:187], a[12:15]
v_cvt_pk_bf16_f32 v240, v240, v241
v_cvt_pk_bf16_f32 v241, v242, v243
M a[16:19], a[128:131], a[184:187], a[16:19]
v_cvt_pk_bf16_f32 v242, v244, v245
v_cvt_pk_bf16_f32 v243, v246, v247
M a[16:19], a[132:135], a[188:191], a[16:19]
buffer_load_dwordx4 v5, s[8:11], s3 offen offset:3072 lds
v_cvt_pk_bf16_f32 v248, v248, v249
v_cvt_pk_bf16_f32 v249, v250, v251
M a[20:23], a[140:143], a[188:191], a[20:23]
v_cvt_pk_bf16_f32 v250, v252, v253
v_cvt_pk_bf16_f32 v251, v254, v255
M a[20:23], a[136:139], a[184:187], a[20:23]
M a[24:27], a[144:147], a[184:187], a[24:27]
s_add_u32 s94, s92, 8192
buffer_store_dwordx4 v[104:107], v1, s[16:19], s94 offen offset:1024 sc1
v_accvgpr_write_b32 a240, v224
v_accvgpr_write_b32 a241, v225
v_accvgpr_write_b32 a242, v226
v_accvgpr_write_b32 a243, v227
M a[24:27], a[148:151], a[188:191], a[24:27]
v_accvgpr_write_b32 a244, v232
v_accvgpr_write_b32 a245, v233
v_accvgpr_write_b32 a246, v234
v_accvgpr_write_b32 a247, v235
M a[28:31], a[156:159], a[188:191], a[28:31]
v_accvgpr_write_b32 a248, v240
v_accvgpr_write_b32 a249, v241
v_accvgpr_write_b32 a250, v242
v_accvgpr_write_b32 a251, v243
M a[28:31], a[152:155], a[184:187], a[28:31]
s_waitcnt lgkmcnt(2)
v_accvgpr_write_b32 a252, v248
v_accvgpr_write_b32 a253, v249
v_accvgpr_write_b32 a254, v250
v_accvgpr_write_b32 a255, v251
M v[32:35], a[160:163], a[32:35], 0
s_add_u32 s23, s23, 128
s_cmp_eq_u32 s23, s25
s_cselect_b32 s23, s26, s23
M v[32:35], a[164:167], a[36:39], v[32:35]
ds_read_b128 a[176:179], v10 offset:4096
ds_read_b128 a[180:183], v11 offset:4096
M v[36:39], a[164:167], a[44:47], 0
M v[36:39], a[160:163], a[40:43], v[36:39]
ds_read_b64_tr_b16 a[96:97], v12 offset:32768
ds_read_b64_tr_b16 a[98:99], v12 offset:34816
M v[40:43], a[160:163], a[48:51], 0
M v[40:43], a[164:167], a[52:55], v[40:43]
M v[44:47], a[164:167], a[60:63], 0
s_add_u32 m0, s29, 81920
s_nop 0
buffer_load_dwordx4 v6, s[12:15], s24 offen offset:0 lds
M v[44:47], a[160:163], a[56:59], v[44:47]
ds_read_b64_tr_b16 a[104:105], v13 offset:32768
ds_read_b64_tr_b16 a[106:107], v13 offset:34816
M v[48:51], a[160:163], a[64:67], 0
s_add_u32 s94, s92, 8192
buffer_store_dwordx4 v[112:115], v1, s[16:19], s94 offen offset:2048 sc1
M v[48:51], a[164:167], a[68:71], v[48:51]
M v[52:55], a[164:167], a[76:79], 0
M v[52:55], a[160:163], a[72:75], v[52:55]
ds_read_b64_tr_b16 a[112:113], v14 offset:32768
ds_read_b64_tr_b16 a[114:115], v14 offset:34816
M v[56:59], a[160:163], a[80:83], 0
M v[56:59], a[164:167], a[84:87], v[56:59]
buffer_load_dwordx4 v7, s[12:15], s24 offen offset:1024 lds
M v[60:63], a[164:167], a[92:95], 0
M v[60:63], a[160:163], a[88:91], v[60:63]
s_waitcnt lgkmcnt(8)
ds_read_b64_tr_b16 a[120:121], v15 offset:32768
ds_read_b64_tr_b16 a[122:123], v15 offset:34816
M v[64:67], a[168:171], a[32:35], 0
M v[64:67], a[172:175], a[36:39], v[64:67]
ds_read_b128 a[184:187], v10 offset:6144
ds_read_b128 a[188:191], v11 offset:6144
M v[68:71], a[172:175], a[44:47], 0
s_add_u32 s94, s92, 8192
buffer_store_dwordx4 v[120:123], v1, s[16:19], s94 offen offset:3072 sc1
M v[68:71], a[168:171], a[40:43], v[68:71]
ds_read_b64_tr_b16 a[128:129], v16 offset:32768
ds_read_b64_tr_b16 a[130:131], v16 offset:34816
M v[72:75], a[168:171], a[48:51], 0
v_accvgpr_read_b32 v24, a0
v_accvgpr_read_b32 v25, a1
M v[72:75], a[172:175], a[52:55], v[72:75]
buffer_load_dwordx4 v8, s[12:15], s24 offen offset:2048 lds
v_accvgpr_read_b32 v26, a2
v_accvgpr_read_b32 v27, a3
M v[76:79], a[172:175], a[60:63], 0
v_accvgpr_read_b32 v28, a4
v_accvgpr_read_b32 v29, a5
M v[76:79], a[168:171], a[56:59], v[76:79]
ds_read_b64_tr_b16 a[136:137], v17 offset:32768
ds_read_b64_tr_b16 a[138:139], v17 offset:34816
v_accvgpr_read_b32 v30, a6
v_accvgpr_read_b32 v31, a7
M v[80:83], a[168:171], a[64:67], 0
v_cvt_pk_bf16_f32 v24, v24, v25
v_cvt_pk_bf16_f32 v25, v26, v27
M v[80:83], a[172:175], a[68:71], v[80:83]
v_cvt_pk_bf16_f32 v26, v28, v29
v_cvt_pk_bf16_f32 v27, v30, v31
M v[84:87], a[172:175], a[76:79], 0
buffer_load_dwordx4 v9, s[12:15], s24 offen offset:3072 lds
M v[84:87], a[168:171], a[72:75], v[84:87]
ds_read_b64_tr_b16 a[144:145], v18 offset:32768
ds_read_b64_tr_b16 a[146:147], v18 offset:34816
M v[88:91], a[168:171], a[80:83], 0
M v[88:91], a[172:175], a[84:87], v[88:91]
s_add_u32 s94, s93, 12288
buffer_store_dwordx4 v[24:27], v1, s[16:19], s94 offen offset:0 sc1
M v[92:95], a[172:175], a[92:95], 0
M v[92:95], a[168:171], a[88:91], v[92:95]
s_waitcnt lgkmcnt(15)
ds_read_b64_tr_b16 a[152:153], v19 offset:32768
ds_read_b64_tr_b16 a[154:155], v19 offset:34816
M v[96:99], a[176:179], a[32:35], 0
M v[96:99], a[180:183], a[36:39], v[96:99]
s_add_u32 s24, s24, 262144
s_cmp_eq_u32 s24, s27
s_cselect_b32 s24, s28, s24
s_sub_u32 s6, s6, 1
s_cmp_eq_u32 s6, 0
s_cselect_b64 s[12:13], s[64:65], s[12:13]
M v[100:103], a[180:183], a[44:47], 0
M v[100:103], a[176:179], a[40:43], v[100:103]
M v[104:107], a[176:179], a[48:51], 0
M v[104:107], a[180:183], a[52:55], v[104:107]
M v[108:111], a[180:183], a[60:63], 0
M v[108:111], a[176:179], a[56:59], v[108:111]
s_waitcnt vmcnt(29) lgkmcnt(0)
s_barrier
ds_read_b128 a[160:163], v10 offset:16384
ds_read_b128 a[164:167], v11 offset:16384
M v[112:115], a[176:179], a[64:67], 0
s_add_u32 m0, s29, 0
s_nop 0
buffer_load_dwordx4 v2, s[8:11], s23 offen offset:0 lds
M v[112:115], a[180:183], a[68:71], v[112:115]
M v[116:119], a[180:183], a[76:79], 0
M v[116:119], a[176:179], a[72:75], v[116:119]
ds_read_b64_tr_b16 a[100:101], v12 offset:49152
ds_read_b64_tr_b16 a[102:103], v12 offset:51200
M v[120:123], a[176:179], a[80:83], 0
v_accvgpr_read_b32 v24, a8
v_accvgpr_read_b32 v25, a9
M v[120:123], a[180:183], a[84:87], v[120:123]
v_accvgpr_read_b32 v26, a10
v_accvgpr_read_b32 v27, a11
M v[124:127], a[180:183], a[92:95], 0
buffer_load_dwordx4 v3, s[8:11], s23 offen offset:1024 lds
v_accvgpr_read_b32 v28, a12
v_accvgpr_read_b32 v29, a13
M v[124:127], a[176:179], a[88:91], v[124:127]
v_accvgpr_read_b32 v30, a14
v_accvgpr_read_b32 v31, a15
M v[128:131], a[184:187], a[32:35], 0
v_cvt_pk_bf16_f32 v24, v24, v25
v_cvt_pk_bf16_f32 v25, v26, v27
M v[128:131], a[188:191], a[36:39], v[128:131]
ds_read_b128 a[168:171], v10 offset:18432
ds_read_b128 a[172:175], v11 offset:18432
ds_read_b64_tr_b16 a[108:109], v13 offset:49152
ds_read_b64_tr_b16 a[110:111], v13 offset:51200
v_cvt_pk_bf16_f32 v26, v28, v29
v_cvt_pk_bf16_f32 v27, v30, v31
M v[132:135], a[188:191], a[44:47], 0
M v[132:135], a[184:187], a[40:43], v[132:135]
M v[136:139], a[184:187], a[48:51], 0
M v[136:139], a[188:191], a[52:55], v[136:139]
s_add_u32 s94, s93, 12288
buffer_store_dwordx4 v[24:27], v1, s[16:19], s94 offen offset:1024 sc1
M v[140:143], a[188:191], a[60:63], 0
buffer_load_dwordx4 v4, s[8:11], s23 offen offset:2048 lds
M v[140:143], a[184:187], a[56:59], v[140:143]
ds_read_b64_tr_b16 a[116:117], v14 offset:49152
ds_read_b64_tr_b16 a[118:119], v14 offset:51200
M v[144:147], a[184:187], a[64:67], 0
M v[144:147], a[188:191], a[68:71], v[144:147]
M v[148:151], a[188:191], a[76:79], 0
M v[148:151], a[184:187], a[72:75], v[148:151]
M v[152:155], a[184:187], a[80:83], 0
buffer_load_dwordx4 v5, s[8:11], s23 offen offset:3072 lds
M v[152:155], a[188:191], a[84:87], v[152:155]
ds_read_b64_tr_b16 a[124:125], v15 offset:49152
ds_read_b64_tr_b16 a[126:127], v15 offset:51200
M v[156:159], a[188:191], a[92:95], 0
M v[156:159], a[184:187], a[88:91], v[156:159]
s_waitcnt lgkmcnt(10)
M v[160:163], a[160:163], a[32:35], 0
M v[160:163], a[164:167], a[36:39], v[160:163]
ds_read_b128 a[176:179], v10 offset:20480
ds_read_b128 a[180:183], v11 offset:20480
M v[164:167], a[164:167], a[44:47], 0
M v[164:167], a[160:163], a[40:43], v[164:167]
ds_read_b64_tr_b16 a[132:133], v16 offset:49152
ds_read_b64_tr_b16 a[134:135], v16 offset:51200
M v[168:171], a[160:163], a[48:51], 0
v_accvgpr_read_b32 v24, a16
v_accvgpr_read_b32 v25, a17
M v[168:171], a[164:167], a[52:55], v[168:171]
s_add_u32 m0, s29, 98304
s_nop 0
buffer_load_dwordx4 v6, s[12:15], s24 offen offset:0 lds
v_accvgpr_read_b32 v26, a18
v_accvgpr_read_b32 v27, a19
M v[172:175], a[164:167], a[60:63], 0
v_accvgpr_read_b32 v28, a20
v_accvgpr_read_b32 v29, a21
M v[172:175], a[160:163], a[56:59], v[172:175]
v_accvgpr_read_b32 v30, a22
v_accvgpr_read_b32 v31, a23
M v[176:179], a[160:163], a[64:67], 0
v_cvt_pk_bf16_f32 v24, v24, v25
v_cvt_pk_bf16_f32 v25, v26, v27
M v[176:179], a[164:167], a[68:71], v[176:179]
ds_read_b64_tr_b16 a[140:141], v17 offset:49152
ds_read_b64_tr_b16 a[142:143], v17 offset:51200
v_cvt_pk_bf16_f32 v26, v28, v29
v_cvt_pk_bf16_f32 v27, v30, v31
M v[180:183], a[164:167], a[76:79], 0
M v[180:183], a[160:163], a[72:75], v[180:183]
buffer_load_dwordx4 v7, s[12:15], s24 offen offset:1024 lds
M v[184:187], a[160:163], a[80:83], 0
M v[184:187], a[164:167], a[84:87], v[184:187]
s_add_u32 s94, s93, 12288
buffer_store_dwordx4 v[24:27], v1, s[16:19], s94 offen offset:2048 sc1
M v[188:191], a[164:167], a[92:95], 0
M v[188:191], a[160:163], a[88:91], v[188:191]
s_waitcnt lgkmcnt(12)
ds_read_b64_tr_b16 a[148:149], v18 offset:49152
ds_read_b64_tr_b16 a[150:151], v18 offset:51200
M v[192:195], a[168:171], a[32:35], 0
M v[192:195], a[172:175], a[36:39], v[192:195]
ds_read_b128 a[184:187], v10 offset:22528
ds_read_b128 a[188:191], v11 offset:22528
M v[196:199], a[172:175], a[44:47], 0
M v[196:199], a[168:171], a[40:43], v[196:199]
buffer_load_dwordx4 v8, s[12:15], s24 offen offset:2048 lds
M v[200:203], a[168:171], a[48:51], 0
M v[200:203], a[172:175], a[52:55], v[200:203]
ds_read_b64_tr_b16 a[156:157], v19 offset:49152
ds_read_b64_tr_b16 a[158:159], v19 offset:51200
M v[204:207], a[172:175], a[60:63], 0
M v[204:207], a[168:171], a[56:59], v[204:207]
M v[208:211], a[168:171], a[64:67], 0
M v[208:211], a[172:175], a[68:71], v[208:211]
buffer_load_dwordx4 v9, s[12:15], s24 offen offset:3072 lds
M v[212:215], a[172:175], a[76:79], 0
M v[212:215], a[168:171], a[72:75], v[212:215]
M v[216:219], a[168:171], a[80:83], 0
v_accvgpr_read_b32 v24, a24
v_accvgpr_read_b32 v25, a25
M v[216:219], a[172:175], a[84:87], v[216:219]
v_accvgpr_read_b32 v26, a26
v_accvgpr_read_b32 v27, a27
M v[220:223], a[172:175], a[92:95], 0
s_add_u32 s24, s24, 262144
v_accvgpr_read_b32 v28, a28
v_accvgpr_read_b32 v29, a29
M v[220:223], a[168:171], a[88:91], v[220:223]
s_waitcnt lgkmcnt(10)
v_accvgpr_read_b32 v30, a30
v_accvgpr_read_b32 v31, a31
M v[224:227], a[176:179], a[32:35], 0
v_cvt_pk_bf16_f32 v24, v24, v25
v_cvt_pk_bf16_f32 v25, v26, v27
M v[224:227], a[180:183], a[36:39], v[224:227]
v_cvt_pk_bf16_f32 v26, v28, v29
v_cvt_pk_bf16_f32 v27, v30, v31
M v[228:231], a[180:183], a[44:47], 0
M v[228:231], a[176:179], a[40:43], v[228:231]
M v[232:235], a[176:179], a[48:51], 0
M v[232:235], a[180:183], a[52:55], v[232:235]
s_add_u32 s94, s93, 12288
buffer_store_dwordx4 v[24:27], v1, s[16:19], s94 offen offset:3072 sc1
M v[236:239], a[180:183], a[60:63], 0
M v[236:239], a[176:179], a[56:59], v[236:239]
s_waitcnt vmcnt(26) lgkmcnt(0)
s_barrier
ds_read_b128 a[160:163], v10 offset:32768
ds_read_b128 a[164:167], v11 offset:32768
M v[240:243], a[176:179], a[64:67], 0
s_add_u32 m0, s29, 16384
s_add_u32 s3, s23, s31
buffer_load_dwordx4 v2, s[8:11], s3 offen offset:0 lds
M v[240:243], a[180:183], a[68:71], v[240:243]
M v[244:247], a[180:183], a[76:79], 0
M v[244:247], a[176:179], a[72:75], v[244:247]
M v[248:251], a[176:179], a[80:83], 0
M v[248:251], a[180:183], a[84:87], v[248:251]
buffer_load_dwordx4 v3, s[8:11], s3 offen offset:1024 lds
M v[252:255], a[180:183], a[92:95], 0
M v[252:255], a[176:179], a[88:91], v[252:255]
M a[0:3], a[184:187], a[32:35], 0
M a[0:3], a[188:191], a[36:39], a[0:3]
ds_read_b128 a[168:171], v10 offset:34816
ds_read_b128 a[172:175], v11 offset:34816
M a[4:7], a[188:191], a[44:47], 0
M a[4:7], a[184:187], a[40:43], a[4:7]
M a[8:11], a[184:187], a[48:51], 0
buffer_load_dwordx4 v4, s[8:11], s3 offen offset:2048 lds
M a[8:11], a[188:191], a[52:55], a[8:11]
M a[12:15], a[188:191], a[60:63], 0
M a[12:15], a[184:187], a[56:59], a[12:15]
M a[16:19], a[184:187], a[64:67], 0
M a[16:19], a[188:191], a[68:71], a[16:19]
buffer_load_dwordx4 v5, s[8:11], s3 offen offset:3072 lds
M a[20:23], a[188:191], a[76:79], 0
M a[20:23], a[184:187], a[72:75], a[20:23]
M a[24:27], a[184:187], a[80:83], 0
M a[24:27], a[188:191], a[84:87], a[24:27]
M a[28:31], a[188:191], a[92:95], 0
M a[28:31], a[184:187], a[88:91], a[28:31]
s_waitcnt lgkmcnt(2)
M v[32:35], a[160:163], a[96:99], v[32:35]
s_add_u32 s23, s23, 128
s_cmp_eq_u32 s23, s25
s_cselect_b32 s23, s26, s23
M v[32:35], a[164:167], a[100:103], v[32:35]
ds_read_b128 a[176:179], v10 offset:36864
ds_read_b128 a[180:183], v11 offset:36864
M v[36:39], a[164:167], a[108:111], v[36:39]
M v[36:39], a[160:163], a[104:107], v[36:39]
ds_read_b64_tr_b16 a[32:33], v12 offset:0
ds_read_b64_tr_b16 a[34:35], v12 offset:2048
M v[40:43], a[160:163], a[112:115], v[40:43]
M v[40:43], a[164:167], a[116:119], v[40:43]
M v[44:47], a[164:167], a[124:127], v[44:47]
s_add_u32 m0, s29, 114688
s_nop 0
buffer_load_dwordx4 v6, s[12:15], s24 offen offset:0 lds
M v[44:47], a[160:163], a[120:123], v[44:47]
ds_read_b64_tr_b16 a[40:41], v13 offset:0
ds_read_b64_tr_b16 a[42:43], v13 offset:2048
M v[48:51], a[160:163], a[128:131], v[48:51]
s_add_u32 s94, s92, 12288
buffer_store_dwordx4 a[192:195], v1, s[16:19], s94 offen offset:0 sc1
M v[48:51], a[164:167], a[132:135], v[48:51]
M v[52:55], a[164:167], a[140:143], v[52:55]
M v[52:55], a[160:163], a[136:139], v[52:55]
ds_read_b64_tr_b16 a[48:49], v14 offset:0
ds_read_b64_tr_b16 a[50:51], v14 offset:2048
M v[56:59], a[160:163], a[144:147], v[56:59]
M v[56:59], a[164:167], a[148:151], v[56:59]
buffer_load_dwordx4 v7, s[12:15], s24 offen offset:1024 lds
M v[60:63], a[164:167], a[156:159], v[60:63]
M v[60:63], a[160:163], a[152:155], v[60:63]
s_waitcnt lgkmcnt(8)
ds_read_b64_tr_b16 a[56:57], v15 offset:0
ds_read_b64_tr_b16 a[58:59], v15 offset:2048
M v[64:67], a[168:171], a[96:99], v[64:67]
M v[64:67], a[172:175], a[100:103], v[64:67]
ds_read_b128 a[184:187], v10 offset:38912
ds_read_b128 a[188:191], v11 offset:38912
M v[68:71], a[172:175], a[108:111], v[68:71]
M v[68:71], a[168:171], a[104:107], v[68:71]
ds_read_b64_tr_b16 a[64:65], v16 offset:0
ds_read_b64_tr_b16 a[66:67], v16 offset:2048
M v[72:75], a[168:171], a[112:115], v[72:75]
buffer_load_dwordx4 v8, s[12:15], s24 offen offset:2048 lds
M v[72:75], a[172:175], a[116:119], v[72:75]
M v[76:79], a[172:175], a[124:127], v[76:79]
M v[76:79], a[168:171], a[120:123], v[76:79]
ds_read_b64_tr_b16 a[72:73], v17 offset:0
ds_read_b64_tr_b16 a[74:75], v17 offset:2048
M v[80:83], a[168:171], a[128:131], v[80:83]
M v[80:83], a[172:175], a[132:135], v[80:83]
buffer_load_dwordx4 v9, s[12:15], s24 offen offset:3072 lds
M v[84:87], a[172:175], a[140:143], v[84:87]
M v[84:87], a[168:171], a[136:139], v[84:87]
ds_read_b64_tr_b16 a[80:81], v18 offset:0
ds_read_b64_tr_b16 a[82:83], v18 offset:2048
M v[88:91], a[168:171], a[144:147], v[88:91]
M v[88:91], a[172:175], a[148:151], v[88:91]
M v[92:95], a[172:175], a[156:159], v[92:95]
s_add_u32 s24, s24, 262144
s_cmp_eq_u32 s24, s27
s_cselect_b32 s24, s28, s24
s_sub_u32 s6, s6, 1
s_cmp_eq_u32 s6, 0
s_cselect_b64 s[12:13], s[64:65], s[12:13]
M v[92:95], a[168:171], a[152:155], v[92:95]
s_waitcnt lgkmcnt(15)
ds_read_b64_tr_b16 a[88:89], v19 offset:0
ds_read_b64_tr_b16 a[90:91], v19 offset:2048
M v[96:99], a[176:179], a[96:99], v[96:99]
M v[96:99], a[180:183], a[100:103], v[96:99]
M v[100:103], a[180:183], a[108:111], v[100:103]
M v[100:103], a[176:179], a[104:107], v[100:103]
M v[104:107], a[176:179], a[112:115], v[104:107]
s_add_u32 s94, s92, 12288
buffer_store_dwordx4 a[196:199], v1, s[16:19], s94 offen offset:1024 sc1
M v[104:107], a[180:183], a[116:119], v[104:107]
M v[108:111], a[180:183], a[124:127], v[108:111]
M v[108:111], a[176:179], a[120:123], v[108:111]
s_waitcnt vmcnt(22) lgkmcnt(0)
s_barrier
ds_read_b128 a[160:163], v10 offset:49152
ds_read_b128 a[164:167], v11 offset:49152
M v[112:115], a[176:179], a[128:131], v[112:115]
s_add_u32 m0, s29, 32768
s_nop 0
buffer_load_dwordx4 v2, s[8:11], s23 offen offset:0 lds
M v[112:115], a[180:183], a[132:135], v[112:115]
M v[116:119], a[180:183], a[140:143], v[116:119]
M v[116:119], a[176:179], a[136:139], v[116:119]
ds_read_b64_tr_b16 a[36:37], v12 offset:16384
ds_read_b64_tr_b16 a[38:39], v12 offset:18432
M v[120:123], a[176:179], a[144:147], v[120:123]
M v[120:123], a[180:183], a[148:151], v[120:123]
M v[124:127], a[180:183], a[156:159], v[124:127]
buffer_load_dwordx4 v3, s[8:11], s23 offen offset:1024 lds
M v[124:127], a[176:179], a[152:155], v[124:127]
M v[128:131], a[184:187], a[96:99], v[128:131]
M v[128:131], a[188:191], a[100:103], v[128:131]
ds_read_b128 a[168:171], v10 offset:51200
ds_read_b128 a[172:175], v11 offset:51200
ds_read_b64_tr_b16 a[44:45], v13 offset:16384
ds_read_b64_tr_b16 a[46:47], v13 offset:18432
M v[132:135], a[188:191], a[108:111], v[132:135]
M v[132:135], a[184:187], a[104:107], v[132:135]
M v[136:139], a[184:187], a[112:115], v[136:139]
M v[136:139], a[188:191], a[116:119], v[136:139]
buffer_load_dwordx4 v4, s[8:11], s23 offen offset:2048 lds
M v[140:143], a[188:191], a[124:127], v[140:143]
M v[140:143], a[184:187], a[120:123], v[140:143]
ds_read_b64_tr_b16 a[52:53], v14 offset:16384
ds_read_b64_tr_b16 a[54:55], v14 offset:18432
M v[144:147], a[184:187], a[128:131], v[144:147]
M v[144:147], a[188:191], a[132:135], v[144:147]
M v[148:151], a[188:191], a[140:143], v[148:151]
M v[148:151], a[184:187], a[136:139], v[148:151]
buffer_load_dwordx4 v5, s[8:11], s23 offen offset:3072 lds
M v[152:155], a[184:187], a[144:147], v[152:155]
M v[152:155], a[188:191], a[148:151], v[152:155]
ds_read_b64_tr_b16 a[60:61], v15 offset:16384
ds_read_b64_tr_b16 a[62:63], v15 offset:18432
M v[156:159], a[188:191], a[156:159], v[156:159]
M v[156:159], a[184:187], a[152:155], v[156:159]
s_waitcnt lgkmcnt(10)
M v[160:163], a[160:163], a[96:99], v[160:163]
s_add_u32 s94, s92, 12288
buffer_store_dwordx4 a[200:203], v1, s[16:19], s94 offen offset:2048 sc1
M v[160:163], a[164:167], a[100:103], v[160:163]
ds_read_b128 a[176:179], v10 offset:53248
ds_read_b128 a[180:183], v11 offset:53248
M v[164:167], a[164:167], a[108:111], v[164:167]
M v[164:167], a[160:163], a[104:107], v[164:167]
ds_read_b64_tr_b16 a[68:69], v16 offset:16384
ds_read_b64_tr_b16 a[70:71], v16 offset:18432
M v[168:171], a[160:163], a[112:115], v[168:171]
M v[168:171], a[164:167], a[116:119], v[168:171]
s_add_u32 m0, s29, 65536
s_nop 0
buffer_load_dwordx4 v6, s[12:15], s24 offen offset:0 lds
M v[172:175], a[164:167], a[124:127], v[172:175]
M v[172:175], a[160:163], a[120:123], v[172:175]
M v[176:179], a[160:163], a[128:131], v[176:179]
M v[176:179], a[164:167], a[132:135], v[176:179]
ds_read_b64_tr_b16 a[76:77], v17 offset:16384
ds_read_b64_tr_b16 a[78:79], v17 offset:18432
M v[180:183], a[164:167], a[140:143], v[180:183]
M v[180:183], a[160:163], a[136:139], v[180:183]
buffer_load_dwordx4 v7, s[12:15], s24 offen offset:1024 lds
M v[184:187], a[160:163], a[144:147], v[184:187]
M v[184:187], a[164:167], a[148:151], v[184:187]
M v[188:191], a[164:167], a[156:159], v[188:191]
M v[188:191], a[160:163], a[152:155], v[188:191]
s_waitcnt lgkmcnt(12)
ds_read_b64_tr_b16 a[84:85], v18 offset:16384
ds_read_b64_tr_b16 a[86:87], v18 offset:18432
M v[192:195], a[168:171], a[96:99], v[192:195]
M v[192:195], a[172:175], a[100:103], v[192:195]
ds_read_b128 a[184:187], v10 offset:55296
ds_read_b128 a[188:191], v11 offset:55296
M v[196:199], a[172:175], a[108:111], v[196:199]
buffer_load_dwordx4 v8, s[12:15], s24 offen offset:2048 lds
M v[196:199], a[168:171], a[104:107], v[196:199]
M v[200:203], a[168:171], a[112:115], v[200:203]
M v[200:203], a[172:175], a[116:119], v[200:203]
ds_read_b64_tr_b16 a[92:93], v19 offset:16384
ds_read_b64_tr_b16 a[94:95], v19 offset:18432
M v[204:207], a[172:175], a[124:127], v[204:207]
M v[204:207], a[168:171], a[120:123], v[204:207]
M v[208:211], a[168:171], a[128:131], v[208:211]
buffer_load_dwordx4 v9, s[12:15], s24 offen offset:3072 lds
M v[208:211], a[172:175], a[132:135], v[208:211]
M v[212:215], a[172:175], a[140:143], v[212:215]
M v[212:215], a[168:171], a[136:139], v[212:215]
M v[216:219], a[168:171], a[144:147], v[216:219]
s_add_u32 s94, s92, 12288
buffer_store_dwordx4 a[204:207], v1, s[16:19], s94 offen offset:3072 sc1
M v[216:219], a[172:175], a[148:151], v[216:219]
M v[220:223], a[172:175], a[156:159], v[220:223]
s_add_u32 s24, s24, 262144
M v[220:223], a[168:171], a[152:155], v[220:223]
s_waitcnt lgkmcnt(10)
M v[224:227], a[176:179], a[96:99], v[224:227]
M v[224:227], a[180:183], a[100:103], v[224:227]
M v[228:231], a[180:183], a[108:111], v[228:231]
M v[228:231], a[176:179], a[104:107], v[228:231]
M v[232:235], a[176:179], a[112:115], v[232:235]
M v[232:235], a[180:183], a[116:119], v[232:235]
M v[236:239], a[180:183], a[124:127], v[236:239]
M v[236:239], a[176:179], a[120:123], v[236:239]
s_waitcnt vmcnt(21) lgkmcnt(0)
s_barrier
ds_read_b128 a[160:163], v10 offset:0
ds_read_b128 a[164:167], v11 offset:0
M v[240:243], a[176:179], a[128:131], v[240:243]
s_add_u32 m0, s29, 49152
s_add_u32 s3, s23, s31
buffer_load_dwordx4 v2, s[8:11], s3 offen offset:0 lds
M v[240:243], a[180:183], a[132:135], v[240:243]
M v[244:247], a[180:183], a[140:143], v[244:247]
M v[244:247], a[176:179], a[136:139], v[244:247]
M v[248:251], a[176:179], a[144:147], v[248:251]
M v[248:251], a[180:183], a[148:151], v[248:251]
buffer_load_dwordx4 v3, s[8:11], s3 offen offset:1024 lds
M v[252:255], a[180:183], a[156:159], v[252:255]
M v[252:255], a[176:179], a[152:155], v[252:255]
M a[0:3], a[184:187], a[96:99], a[0:3]
M a[0:3], a[188:191], a[100:103], a[0:3]
ds_read_b128 a[168:171], v10 offset:2048
ds_read_b128 a[172:175], v11 offset:2048
M a[4:7], a[188:191], a[108:111], a[4:7]
M a[4:7], a[184:187], a[104:107], a[4:7]
M a[8:11], a[184:187], a[112:115], a[8:11]
buffer_load_dwordx4 v4, s[8:11], s3 offen offset:2048 lds
M a[8:11], a[188:191], a[116:119], a[8:11]
M a[12:15], a[188:191], a[124:127], a[12:15]
M a[12:15], a[184:187], a[120:123], a[12:15]
M a[16:19], a[184:187], a[128:131], a[16:19]
M a[16:19], a[188:191], a[132:135], a[16:19]
buffer_load_dwordx4 v5, s[8:11], s3 offen offset:3072 lds
M a[20:23], a[188:191], a[140:143], a[20:23]
M a[20:23], a[184:187], a[136:139], a[20:23]
M a[24:27], a[184:187], a[144:147], a[24:27]
M a[24:27], a[188:191], a[148:151], a[24:27]
M a[28:31], a[188:191], a[156:159], a[28:31]
M a[28:31], a[184:187], a[152:155], a[28:31]
s_waitcnt lgkmcnt(2)
M v[32:35], a[160:163], a[32:35], v[32:35]
s_add_u32 s23, s23, 128
s_cmp_eq_u32 s23, s25
s_cselect_b32 s23, s26, s23
M v[32:35], a[164:167], a[36:39], v[32:35]
ds_read_b128 a[176:179], v10 offset:4096
ds_read_b128 a[180:183], v11 offset:4096
M v[36:39], a[164:167], a[44:47], v[36:39]
M v[36:39], a[160:163], a[40:43], v[36:39]
ds_read_b64_tr_b16 a[96:97], v12 offset:32768
ds_read_b64_tr_b16 a[98:99], v12 offset:34816
M v[40:43], a[160:163], a[48:51], v[40:43]
M v[40:43], a[164:167], a[52:55], v[40:43]
M v[44:47], a[164:167], a[60:63], v[44:47]
s_add_u32 m0, s29, 81920
s_nop 0
buffer_load_dwordx4 v6, s[12:15], s24 offen offset:0 lds
M v[44:47], a[160:163], a[56:59], v[44:47]
ds_read_b64_tr_b16 a[104:105], v13 offset:32768
ds_read_b64_tr_b16 a[106:107], v13 offset:34816
M v[48:51], a[160:163], a[64:67], v[48:51]
s_add_u32 s94, s93, 0
buffer_store_dwordx4 a[208:211], v1, s[16:19], s94 offen offset:0 sc1
M v[48:51], a[164:167], a[68:71], v[48:51]
M v[52:55], a[164:167], a[76:79], v[52:55]
M v[52:55], a[160:163], a[72:75], v[52:55]
ds_read_b64_tr_b16 a[112:113], v14 offset:32768
ds_read_b64_tr_b16 a[114:115], v14 offset:34816
M v[56:59], a[160:163], a[80:83], v[56:59]
M v[56:59], a[164:167], a[84:87], v[56:59]
buffer_load_dwordx4 v7, s[12:15], s24 offen offset:1024 lds
M v[60:63], a[164:167], a[92:95], v[60:63]
M v[60:63], a[160:163], a[88:91], v[60:63]
s_waitcnt lgkmcnt(8)
ds_read_b64_tr_b16 a[120:121], v15 offset:32768
ds_read_b64_tr_b16 a[122:123], v15 offset:34816
M v[64:67], a[168:171], a[32:35], v[64:67]
M v[64:67], a[172:175], a[36:39], v[64:67]
ds_read_b128 a[184:187], v10 offset:6144
ds_read_b128 a[188:191], v11 offset:6144
M v[68:71], a[172:175], a[44:47], v[68:71]
M v[68:71], a[168:171], a[40:43], v[68:71]
ds_read_b64_tr_b16 a[128:129], v16 offset:32768
ds_read_b64_tr_b16 a[130:131], v16 offset:34816
M v[72:75], a[168:171], a[48:51], v[72:75]
buffer_load_dwordx4 v8, s[12:15], s24 offen offset:2048 lds
M v[72:75], a[172:175], a[52:55], v[72:75]
M v[76:79], a[172:175], a[60:63], v[76:79]
M v[76:79], a[168:171], a[56:59], v[76:79]
ds_read_b64_tr_b16 a[136:137], v17 offset:32768
ds_read_b64_tr_b16 a[138:139], v17 offset:34816
M v[80:83], a[168:171], a[64:67], v[80:83]
M v[80:83], a[172:175], a[68:71], v[80:83]
buffer_load_dwordx4 v9, s[12:15], s24 offen offset:3072 lds
M v[84:87], a[172:175], a[76:79], v[84:87]
M v[84:87], a[168:171], a[72:75], v[84:87]
ds_read_b64_tr_b16 a[144:145], v18 offset:32768
ds_read_b64_tr_b16 a[146:147], v18 offset:34816
M v[88:91], a[168:171], a[80:83], v[88:91]
M v[88:91], a[172:175], a[84:87], v[88:91]
M v[92:95], a[172:175], a[92:95], v[92:95]
s_add_u32 s24, s24, 262144
s_cmp_eq_u32 s24, s27
s_cselect_b32 s24, s28, s24
s_sub_u32 s6, s6, 1
s_cmp_eq_u32 s6, 0
s_cselect_b64 s[12:13], s[64:65], s[12:13]
M v[92:95], a[168:171], a[88:91], v[92:95]
s_waitcnt lgkmcnt(15)
ds_read_b64_tr_b16 a[152:153], v19 offset:32768
ds_read_b64_tr_b16 a[154:155], v19 offset:34816
M v[96:99], a[176:179], a[32:35], v[96:99]
M v[96:99], a[180:183], a[36:39], v[96:99]
M v[100:103], a[180:183], a[44:47], v[100:103]
M v[100:103], a[176:179], a[40:43], v[100:103]
M v[104:107], a[176:179], a[48:51], v[104:107]
s_add_u32 s94, s93, 0
buffer_store_dwordx4 a[212:215], v1, s[16:19], s94 offen offset:1024 sc1
M v[104:107], a[180:183], a[52:55], v[104:107]
M v[108:111], a[180:183], a[60:63], v[108:111]
M v[108:111], a[176:179], a[56:59], v[108:111]
s_waitcnt vmcnt(21) lgkmcnt(0)
s_barrier
ds_read_b128 a[160:163], v10 offset:16384
ds_read_b128 a[164:167], v11 offset:16384
M v[112:115], a[176:179], a[64:67], v[112:115]
s_add_u32 m0, s29, 0
s_nop 0
buffer_load_dwordx4 v2, s[8:11], s23 offen offset:0 lds
M v[112:115], a[180:183], a[68:71], v[112:115]
M v[116:119], a[180:183], a[76:79], v[116:119]
M v[116:119], a[176:179], a[72:75], v[116:119]
ds_read_b64_tr_b16 a[100:101], v12 offset:49152
ds_read_b64_tr_b16 a[102:103], v12 offset:51200
M v[120:123], a[176:179], a[80:83], v[120:123]
M v[120:123], a[180:183], a[84:87], v[120:123]
M v[124:127], a[180:183], a[92:95], v[124:127]
buffer_load_dwordx4 v3, s[8:11], s23 offen offset:1024 lds
M v[124:127], a[176:179], a[88:91], v[124:127]
M v[128:131], a[184:187], a[32:35], v[128:131]
M v[128:131], a[188:191], a[36:39], v[128:131]
ds_read_b128 a[168:171], v10 offset:18432
ds_read_b128 a[172:175], v11 offset:18432
ds_read_b64_tr_b16 a[108:109], v13 offset:49152
ds_read_b64_tr_b16 a[110:111], v13 offset:51200
M v[132:135], a[188:191], a[44:47], v[132:135]
M v[132:135], a[184:187], a[40:43], v[132:135]
M v[136:139], a[184:187], a[48:51], v[136:139]
M v[136:139], a[188:191], a[52:55], v[136:139]
buffer_load_dwordx4 v4, s[8:11], s23 offen offset:2048 lds
M v[140:143], a[188:191], a[60:63], v[140:143]
M v[140:143], a[184:187], a[56:59], v[140:143]
ds_read_b64_tr_b16 a[116:117], v14 offset:49152
ds_read_b64_tr_b16 a[118:119], v14 offset:51200
M v[144:147], a[184:187], a[64:67], v[144:147]
M v[144:147], a[188:191], a[68:71], v[144:147]
M v[148:151], a[188:191], a[76:79], v[148:151]
M v[148:151], a[184:187], a[72:75], v[148:151]
buffer_load_dwordx4 v5, s[8:11], s23 offen offset:3072 lds
M v[152:155], a[184:187], a[80:83], v[152:155]
M v[152:155], a[188:191], a[84:87], v[152:155]
ds_read_b64_tr_b16 a[124:125], v15 offset:49152
ds_read_b64_tr_b16 a[126:127], v15 offset:51200
M v[156:159], a[188:191], a[92:95], v[156:159]
M v[156:159], a[184:187], a[88:91], v[156:159]
s_waitcnt lgkmcnt(10)
M v[160:163], a[160:163], a[32:35], v[160:163]
s_add_u32 s94, s93, 0
buffer_store_dwordx4 a[216:219], v1, s[16:19], s94 offen offset:2048 sc1
M v[160:163], a[164:167], a[36:39], v[160:163]
ds_read_b128 a[176:179], v10 offset:20480
ds_read_b128 a[180:183], v11 offset:20480
M v[164:167], a[164:167], a[44:47], v[164:167]
M v[164:167], a[160:163], a[40:43], v[164:167]
ds_read_b64_tr_b16 a[132:133], v16 offset:49152
ds_read_b64_tr_b16 a[134:135], v16 offset:51200
M v[168:171], a[160:163], a[48:51], v[168:171]
M v[168:171], a[164:167], a[52:55], v[168:171]
s_add_u32 m0, s29, 98304
s_nop 0
buffer_load_dwordx4 v6, s[12:15], s24 offen offset:0 lds
M v[172:175], a[164:167], a[60:63], v[172:175]
M v[172:175], a[160:163], a[56:59], v[172:175]
M v[176:179], a[160:163], a[64:67], v[176:179]
M v[176:179], a[164:167], a[68:71], v[176:179]
ds_read_b64_tr_b16 a[140:141], v17 offset:49152
ds_read_b64_tr_b16 a[142:143], v17 offset:51200
M v[180:183], a[164:167], a[76:79], v[180:183]
M v[180:183], a[160:163], a[72:75], v[180:183]
buffer_load_dwordx4 v7, s[12:15], s24 offen offset:1024 lds
M v[184:187], a[160:163], a[80:83], v[184:187]
M v[184:187], a[164:167], a[84:87], v[184:187]
M v[188:191], a[164:167], a[92:95], v[188:191]
M v[188:191], a[160:163], a[88:91], v[188:191]
s_waitcnt lgkmcnt(12)
ds_read_b64_tr_b16 a[148:149], v18 offset:49152
ds_read_b64_tr_b16 a[150:151], v18 offset:51200
M v[192:195], a[168:171], a[32:35], v[192:195]
M v[192:195], a[172:175], a[36:39], v[192:195]
ds_read_b128 a[184:187], v10 offset:22528
ds_read_b128 a[188:191], v11 offset:22528
M v[196:199], a[172:175], a[44:47], v[196:199]
buffer_load_dwordx4 v8, s[12:15], s24 offen offset:2048 lds
M v[196:199], a[168:171], a[40:43], v[196:199]
M v[200:203], a[168:171], a[48:51], v[200:203]
M v[200:203], a[172:175], a[52:55], v[200:203]
ds_read_b64_tr_b16 a[156:157], v19 offset:49152
ds_read_b64_tr_b16 a[158:159], v19 offset:51200
M v[204:207], a[172:175], a[60:63], v[204:207]
M v[204:207], a[168:171], a[56:59], v[204:207]
M v[208:211], a[168:171], a[64:67], v[208:211]
buffer_load_dwordx4 v9, s[12:15], s24 offen offset:3072 lds
M v[208:211], a[172:175], a[68:71], v[208:211]
M v[212:215], a[172:175], a[76:79], v[212:215]
M v[212:215], a[168:171], a[72:75], v[212:215]
M v[216:219], a[168:171], a[80:83], v[216:219]
s_add_u32 s94, s93, 0
buffer_store_dwordx4 a[220:223], v1, s[16:19], s94 offen offset:3072 sc1
M v[216:219], a[172:175], a[84:87], v[216:219]
M v[220:223], a[172:175], a[92:95], v[220:223]
s_add_u32 s24, s24, 262144
M v[220:223], a[168:171], a[88:91], v[220:223]
s_waitcnt lgkmcnt(10)
M v[224:227], a[176:179], a[32:35], v[224:227]
M v[224:227], a[180:183], a[36:39], v[224:227]
M v[228:231], a[180:183], a[44:47], v[228:231]
M v[228:231], a[176:179], a[40:43], v[228:231]
M v[232:235], a[176:179], a[48:51], v[232:235]
M v[232:235], a[180:183], a[52:55], v[232:235]
M v[236:239], a[180:183], a[60:63], v[236:239]
M v[236:239], a[176:179], a[56:59], v[236:239]
s_waitcnt vmcnt(21) lgkmcnt(0)
s_barrier
ds_read_b128 a[160:163], v10 offset:32768
ds_read_b128 a[164:167], v11 offset:32768
M v[240:243], a[176:179], a[64:67], v[240:243]
s_add_u32 m0, s29, 16384
s_add_u32 s3, s23, s31
buffer_load_dwordx4 v2, s[8:11], s3 offen offset:0 lds
M v[240:243], a[180:183], a[68:71], v[240:243]
M v[244:247], a[180:183], a[76:79], v[244:247]
M v[244:247], a[176:179], a[72:75], v[244:247]
M v[248:251], a[176:179], a[80:83], v[248:251]
M v[248:251], a[180:183], a[84:87], v[248:251]
buffer_load_dwordx4 v3, s[8:11], s3 offen offset:1024 lds
M v[252:255], a[180:183], a[92:95], v[252:255]
M v[252:255], a[176:179], a[88:91], v[252:255]
M a[0:3], a[184:187], a[32:35], a[0:3]
M a[0:3], a[188:191], a[36:39], a[0:3]
ds_read_b128 a[168:171], v10 offset:34816
ds_read_b128 a[172:175], v11 offset:34816
M a[4:7], a[188:191], a[44:47], a[4:7]
M a[4:7], a[184:187], a[40:43], a[4:7]
M a[8:11], a[184:187], a[48:51], a[8:11]
buffer_load_dwordx4 v4, s[8:11], s3 offen offset:2048 lds
M a[8:11], a[188:191], a[52:55], a[8:11]
M a[12:15], a[188:191], a[60:63], a[12:15]
M a[12:15], a[184:187], a[56:59], a[12:15]
M a[16:19], a[184:187], a[64:67], a[16:19]
M a[16:19], a[188:191], a[68:71], a[16:19]
buffer_load_dwordx4 v5, s[8:11], s3 offen offset:3072 lds
M a[20:23], a[188:191], a[76:79], a[20:23]
M a[20:23], a[184:187], a[72:75], a[20:23]
M a[24:27], a[184:187], a[80:83], a[24:27]
M a[24:27], a[188:191], a[84:87], a[24:27]
M a[28:31], a[188:191], a[92:95], a[28:31]
M a[28:31], a[184:187], a[88:91], a[28:31]
s_waitcnt lgkmcnt(2)
M v[32:35], a[160:163], a[96:99], v[32:35]
s_add_u32 s23, s23, 128
s_cmp_eq_u32 s23, s25
s_cselect_b32 s23, s26, s23
M v[32:35], a[164:167], a[100:103], v[32:35]
ds_read_b128 a[176:179], v10 offset:36864
ds_read_b128 a[180:183], v11 offset:36864
M v[36:39], a[164:167], a[108:111], v[36:39]
M v[36:39], a[160:163], a[104:107], v[36:39]
ds_read_b64_tr_b16 a[32:33], v12 offset:0
ds_read_b64_tr_b16 a[34:35], v12 offset:2048
M v[40:43], a[160:163], a[112:115], v[40:43]
M v[40:43], a[164:167], a[116:119], v[40:43]
M v[44:47], a[164:167], a[124:127], v[44:47]
s_add_u32 m0, s29, 114688
s_nop 0
buffer_load_dwordx4 v6, s[12:15], s24 offen offset:0 lds
M v[44:47], a[160:163], a[120:123], v[44:47]
ds_read_b64_tr_b16 a[40:41], v13 offset:0
ds_read_b64_tr_b16 a[42:43], v13 offset:2048
M v[48:51], a[160:163], a[128:131], v[48:51]
s_add_u32 s94, s93, 4096
buffer_store_dwordx4 a[224:227], v1, s[16:19], s94 offen offset:0 sc1
M v[48:51], a[164:167], a[132:135], v[48:51]
M v[52:55], a[164:167], a[140:143], v[52:55]
M v[52:55], a[160:163], a[136:139], v[52:55]
ds_read_b64_tr_b16 a[48:49], v14 offset:0
ds_read_b64_tr_b16 a[50:51], v14 offset:2048
M v[56:59], a[160:163], a[144:147], v[56:59]
M v[56:59], a[164:167], a[148:151], v[56:59]
buffer_load_dwordx4 v7, s[12:15], s24 offen offset:1024 lds
M v[60:63], a[164:167], a[156:159], v[60:63]
M v[60:63], a[160:163], a[152:155], v[60:63]
s_waitcnt lgkmcnt(8)
ds_read_b64_tr_b16 a[56:57], v15 offset:0
ds_read_b64_tr_b16 a[58:59], v15 offset:2048
M v[64:67], a[168:171], a[96:99], v[64:67]
M v[64:67], a[172:175], a[100:103], v[64:67]
ds_read_b128 a[184:187], v10 offset:38912
ds_read_b128 a[188:191], v11 offset:38912
M v[68:71], a[172:175], a[108:111], v[68:71]
M v[68:71], a[168:171], a[104:107], v[68:71]
ds_read_b64_tr_b16 a[64:65], v16 offset:0
ds_read_b64_tr_b16 a[66:67], v16 offset:2048
M v[72:75], a[168:171], a[112:115], v[72:75]
buffer_load_dwordx4 v8, s[12:15], s24 offen offset:2048 lds
M v[72:75], a[172:175], a[116:119], v[72:75]
M v[76:79], a[172:175], a[124:127], v[76:79]
M v[76:79], a[168:171], a[120:123], v[76:79]
ds_read_b64_tr_b16 a[72:73], v17 offset:0
ds_read_b64_tr_b16 a[74:75], v17 offset:2048
M v[80:83], a[168:171], a[128:131], v[80:83]
M v[80:83], a[172:175], a[132:135], v[80:83]
buffer_load_dwordx4 v9, s[12:15], s24 offen offset:3072 lds
M v[84:87], a[172:175], a[140:143], v[84:87]
M v[84:87], a[168:171], a[136:139], v[84:87]
ds_read_b64_tr_b16 a[80:81], v18 offset:0
ds_read_b64_tr_b16 a[82:83], v18 offset:2048
M v[88:91], a[168:171], a[144:147], v[88:91]
M v[88:91], a[172:175], a[148:151], v[88:91]
M v[92:95], a[172:175], a[156:159], v[92:95]
s_add_u32 s24, s24, 262144
s_cmp_eq_u32 s24, s27
s_cselect_b32 s24, s28, s24
s_sub_u32 s6, s6, 1
s_cmp_eq_u32 s6, 0
s_cselect_b64 s[12:13], s[64:65], s[12:13]
M v[92:95], a[168:171], a[152:155], v[92:95]
s_waitcnt lgkmcnt(15)
ds_read_b64_tr_b16 a[88:89], v19 offset:0
ds_read_b64_tr_b16 a[90:91], v19 offset:2048
M v[96:99], a[176:179], a[96:99], v[96:99]
M v[96:99], a[180:183], a[100:103], v[96:99]
M v[100:103], a[180:183], a[108:111], v[100:103]
M v[100:103], a[176:179], a[104:107], v[100:103]
M v[104:107], a[176:179], a[112:115], v[104:107]
s_add_u32 s94, s93, 4096
buffer_store_dwordx4 a[228:231], v1, s[16:19], s94 offen offset:1024 sc1
M v[104:107], a[180:183], a[116:119], v[104:107]
M v[108:111], a[180:183], a[124:127], v[108:111]
M v[108:111], a[176:179], a[120:123], v[108:111]
s_waitcnt vmcnt(21) lgkmcnt(0)
s_barrier
ds_read_b128 a[160:163], v10 offset:49152
ds_read_b128 a[164:167], v11 offset:49152
M v[112:115], a[176:179], a[128:131], v[112:115]
s_add_u32 m0, s29, 32768
s_nop 0
buffer_load_dwordx4 v2, s[8:11], s23 offen offset:0 lds
M v[112:115], a[180:183], a[132:135], v[112:115]
M v[116:119], a[180:183], a[140:143], v[116:119]
M v[116:119], a[176:179], a[136:139], v[116:119]
ds_read_b64_tr_b16 a[36:37], v12 offset:16384
ds_read_b64_tr_b16 a[38:39], v12 offset:18432
M v[120:123], a[176:179], a[144:147], v[120:123]
M v[120:123], a[180:183], a[148:151], v[120:123]
M v[124:127], a[180:183], a[156:159], v[124:127]
buffer_load_dwordx4 v3, s[8:11], s23 offen offset:1024 lds
M v[124:127], a[176:179], a[152:155], v[124:127]
M v[128:131], a[184:187], a[96:99], v[128:131]
M v[128:131], a[188:191], a[100:103], v[128:131]
ds_read_b128 a[168:171], v10 offset:51200
ds_read_b128 a[172:175], v11 offset:51200
ds_read_b64_tr_b16 a[44:45], v13 offset:16384
ds_read_b64_tr_b16 a[46:47], v13 offset:18432
M v[132:135], a[188:191], a[108:111], v[132:135]
M v[132:135], a[184:187], a[104:107], v[132:135]
M v[136:139], a[184:187], a[112:115], v[136:139]
M v[136:139], a[188:191], a[116:119], v[136:139]
buffer_load_dwordx4 v4, s[8:11], s23 offen offset:2048 lds
M v[140:143], a[188:191], a[124:127], v[140:143]
M v[140:143], a[184:187], a[120:123], v[140:143]
ds_read_b64_tr_b16 a[52:53], v14 offset:16384
ds_read_b64_tr_b16 a[54:55], v14 offset:18432
M v[144:147], a[184:187], a[128:131], v[144:147]
M v[144:147], a[188:191], a[132:135], v[144:147]
M v[148:151], a[188:191], a[140:143], v[148:151]
M v[148:151], a[184:187], a[136:139], v[148:151]
buffer_load_dwordx4 v5, s[8:11], s23 offen offset:3072 lds
M v[152:155], a[184:187], a[144:147], v[152:155]
M v[152:155], a[188:191], a[148:151], v[152:155]
ds_read_b64_tr_b16 a[60:61], v15 offset:16384
ds_read_b64_tr_b16 a[62:63], v15 offset:18432
M v[156:159], a[188:191], a[156:159], v[156:159]
M v[156:159], a[184:187], a[152:155], v[156:159]
s_waitcnt lgkmcnt(10)
M v[160:163], a[160:163], a[96:99], v[160:163]
s_add_u32 s94, s93, 4096
buffer_store_dwordx4 a[232:235], v1, s[16:19], s94 offen offset:2048 sc1
M v[160:163], a[164:167], a[100:103], v[160:163]
ds_read_b128 a[176:179], v10 offset:53248
ds_read_b128 a[180:183], v11 offset:53248
M v[164:167], a[164:167], a[108:111], v[164:167]
M v[164:167], a[160:163], a[104:107], v[164:167]
ds_read_b64_tr_b16 a[68:69], v16 offset:16384
ds_read_b64_tr_b16 a[70:71], v16 offset:18432
M v[168:171], a[160:163], a[112:115], v[168:171]
M v[168:171], a[164:167], a[116:119], v[168:171]
s_add_u32 m0, s29, 65536
s_nop 0
buffer_load_dwordx4 v6, s[12:15], s24 offen offset:0 lds
M v[172:175], a[164:167], a[124:127], v[172:175]
M v[172:175], a[160:163], a[120:123], v[172:175]
M v[176:179], a[160:163], a[128:131], v[176:179]
M v[176:179], a[164:167], a[132:135], v[176:179]
ds_read_b64_tr_b16 a[76:77], v17 offset:16384
ds_read_b64_tr_b16 a[78:79], v17 offset:18432
M v[180:183], a[164:167], a[140:143], v[180:183]
M v[180:183], a[160:163], a[136:139], v[180:183]
buffer_load_dwordx4 v7, s[12:15], s24 offen offset:1024 lds
M v[184:187], a[160:163], a[144:147], v[184:187]
M v[184:187], a[164:167], a[148:151], v[184:187]
M v[188:191], a[164:167], a[156:159], v[188:191]
M v[188:191], a[160:163], a[152:155], v[188:191]
s_waitcnt lgkmcnt(12)
ds_read_b64_tr_b16 a[84:85], v18 offset:16384
ds_read_b64_tr_b16 a[86:87], v18 offset:18432
M v[192:195], a[168:171], a[96:99], v[192:195]
M v[192:195], a[172:175], a[100:103], v[192:195]
ds_read_b128 a[184:187], v10 offset:55296
ds_read_b128 a[188:191], v11 offset:55296
M v[196:199], a[172:175], a[108:111], v[196:199]
buffer_load_dwordx4 v8, s[12:15], s24 offen offset:2048 lds
M v[196:199], a[168:171], a[104:107], v[196:199]
M v[200:203], a[168:171], a[112:115], v[200:203]
M v[200:203], a[172:175], a[116:119], v[200:203]
ds_read_b64_tr_b16 a[92:93], v19 offset:16384
ds_read_b64_tr_b16 a[94:95], v19 offset:18432
M v[204:207], a[172:175], a[124:127], v[204:207]
M v[204:207], a[168:171], a[120:123], v[204:207]
M v[208:211], a[168:171], a[128:131], v[208:211]
buffer_load_dwordx4 v9, s[12:15], s24 offen offset:3072 lds
M v[208:211], a[172:175], a[132:135], v[208:211]
M v[212:215], a[172:175], a[140:143], v[212:215]
M v[212:215], a[168:171], a[136:139], v[212:215]
M v[216:219], a[168:171], a[144:147], v[216:219]
s_add_u32 s94, s93, 4096
buffer_store_dwordx4 a[236:239], v1, s[16:19], s94 offen offset:3072 sc1
M v[216:219], a[172:175], a[148:151], v[216:219]
M v[220:223], a[172:175], a[156:159], v[220:223]
s_add_u32 s24, s24, 262144
M v[220:223], a[168:171], a[152:155], v[220:223]
s_waitcnt lgkmcnt(10)
M v[224:227], a[176:179], a[96:99], v[224:227]
M v[224:227], a[180:183], a[100:103], v[224:227]
M v[228:231], a[180:183], a[108:111], v[228:231]
M v[228:231], a[176:179], a[104:107], v[228:231]
M v[232:235], a[176:179], a[112:115], v[232:235]
M v[232:235], a[180:183], a[116:119], v[232:235]
M v[236:239], a[180:183], a[124:127], v[236:239]
M v[236:239], a[176:179], a[120:123], v[236:239]
s_waitcnt vmcnt(21) lgkmcnt(0)
s_barrier
ds_read_b128 a[160:163], v10 offset:0
ds_read_b128 a[164:167], v11 offset:0
M v[240:243], a[176:179], a[128:131], v[240:243]
s_add_u32 m0, s29, 49152
s_add_u32 s3, s23, s31
buffer_load_dwordx4 v2, s[8:11], s3 offen offset:0 lds
M v[240:243], a[180:183], a[132:135], v[240:243]
M v[244:247], a[180:183], a[140:143], v[244:247]
M v[244:247], a[176:179], a[136:139], v[244:247]
M v[248:251], a[176:179], a[144:147], v[248:251]
M v[248:251], a[180:183], a[148:151], v[248:251]
buffer_load_dwordx4 v3, s[8:11], s3 offen offset:1024 lds
M v[252:255], a[180:183], a[156:159], v[252:255]
M v[252:255], a[176:179], a[152:155], v[252:255]
M a[0:3], a[184:187], a[96:99], a[0:3]
M a[0:3], a[188:191], a[100:103], a[0:3]
ds_read_b128 a[168:171], v10 offset:2048
ds_read_b128 a[172:175], v11 offset:2048
M a[4:7], a[188:191], a[108:111], a[4:7]
M a[4:7], a[184:187], a[104:107], a[4:7]
M a[8:11], a[184:187], a[112:115], a[8:11]
buffer_load_dwordx4 v4, s[8:11], s3 offen offset:2048 lds
M a[8:11], a[188:191], a[116:119], a[8:11]
M a[12:15], a[188:191], a[124:127], a[12:15]
M a[12:15], a[184:187], a[120:123], a[12:15]
M a[16:19], a[184:187], a[128:131], a[16:19]
M a[16:19], a[188:191], a[132:135], a[16:19]
buffer_load_dwordx4 v5, s[8:11], s3 offen offset:3072 lds
M a[20:23], a[188:191], a[140:143], a[20:23]
M a[20:23], a[184:187], a[136:139], a[20:23]
M a[24:27], a[184:187], a[144:147], a[24:27]
M a[24:27], a[188:191], a[148:151], a[24:27]
M a[28:31], a[188:191], a[156:159], a[28:31]
M a[28:31], a[184:187], a[152:155], a[28:31]
s_waitcnt lgkmcnt(2)
M v[32:35], a[160:163], a[32:35], v[32:35]
s_add_u32 s23, s23, 128
s_cmp_eq_u32 s23, s25
s_cselect_b32 s23, s26, s23
M v[32:35], a[164:167], a[36:39], v[32:35]
ds_read_b128 a[176:179], v10 offset:4096
ds_read_b128 a[180:183], v11 offset:4096
M v[36:39], a[164:167], a[44:47], v[36:39]
M v[36:39], a[160:163], a[40:43], v[36:39]
ds_read_b64_tr_b16 a[96:97], v12 offset:32768
ds_read_b64_tr_b16 a[98:99], v12 offset:34816
M v[40:43], a[160:163], a[48:51], v[40:43]
M v[40:43], a[164:167], a[52:55], v[40:43]
M v[44:47], a[164:167], a[60:63], v[44:47]
s_add_u32 m0, s29, 81920
s_nop 0
buffer_load_dwordx4 v6, s[12:15], s24 offen offset:0 lds
M v[44:47], a[160:163], a[56:59], v[44:47]
ds_read_b64_tr_b16 a[104:105], v13 offset:32768
ds_read_b64_tr_b16 a[106:107], v13 offset:34816
M v[48:51], a[160:163], a[64:67], v[48:51]
s_add_u32 s94, s93, 8192
buffer_store_dwordx4 a[240:243], v1, s[16:19], s94 offen offset:0 sc1
M v[48:51], a[164:167], a[68:71], v[48:51]
M v[52:55], a[164:167], a[76:79], v[52:55]
M v[52:55], a[160:163], a[72:75], v[52:55]
ds_read_b64_tr_b16 a[112:113], v14 offset:32768
ds_read_b64_tr_b16 a[114:115], v14 offset:34816
M v[56:59], a[160:163], a[80:83], v[56:59]
M v[56:59], a[164:167], a[84:87], v[56:59]
buffer_load_dwordx4 v7, s[12:15], s24 offen offset:1024 lds
M v[60:63], a[164:167], a[92:95], v[60:63]
M v[60:63], a[160:163], a[88:91], v[60:63]
s_waitcnt lgkmcnt(8)
ds_read_b64_tr_b16 a[120:121], v15 offset:32768
ds_read_b64_tr_b16 a[122:123], v15 offset:34816
M v[64:67], a[168:171], a[32:35], v[64:67]
M v[64:67], a[172:175], a[36:39], v[64:67]
ds_read_b128 a[184:187], v10 offset:6144
ds_read_b128 a[188:191], v11 offset:6144
M v[68:71], a[172:175], a[44:47], v[68:71]
M v[68:71], a[168:171], a[40:43], v[68:71]
ds_read_b64_tr_b16 a[128:129], v16 offset:32768
ds_read_b64_tr_b16 a[130:131], v16 offset:34816
M v[72:75], a[168:171], a[48:51], v[72:75]
buffer_load_dwordx4 v8, s[12:15], s24 offen offset:2048 lds
M v[72:75], a[172:175], a[52:55], v[72:75]
M v[76:79], a[172:175], a[60:63], v[76:79]
M v[76:79], a[168:171], a[56:59], v[76:79]
ds_read_b64_tr_b16 a[136:137], v17 offset:32768
ds_read_b64_tr_b16 a[138:139], v17 offset:34816
M v[80:83], a[168:171], a[64:67], v[80:83]
M v[80:83], a[172:175], a[68:71], v[80:83]
buffer_load_dwordx4 v9, s[12:15], s24 offen offset:3072 lds
M v[84:87], a[172:175], a[76:79], v[84:87]
M v[84:87], a[168:171], a[72:75], v[84:87]
ds_read_b64_tr_b16 a[144:145], v18 offset:32768
ds_read_b64_tr_b16 a[146:147], v18 offset:34816
M v[88:91], a[168:171], a[80:83], v[88:91]
M v[88:91], a[172:175], a[84:87], v[88:91]
M v[92:95], a[172:175], a[92:95], v[92:95]
s_add_u32 s24, s24, 262144
s_cmp_eq_u32 s24, s27
s_cselect_b32 s24, s28, s24
s_sub_u32 s6, s6, 1
s_cmp_eq_u32 s6, 0
s_cselect_b64 s[12:13], s[64:65], s[12:13]
M v[92:95], a[168:171], a[88:91], v[92:95]
s_waitcnt lgkmcnt(15)
ds_read_b64_tr_b16 a[152:153], v19 offset:32768
ds_read_b64_tr_b16 a[154:155], v19 offset:34816
M v[96:99], a[176:179], a[32:35], v[96:99]
M v[96:99], a[180:183], a[36:39], v[96:99]
M v[100:103], a[180:183], a[44:47], v[100:103]
M v[100:103], a[176:179], a[40:43], v[100:103]
M v[104:107], a[176:179], a[48:51], v[104:107]
s_add_u32 s94, s93, 8192
buffer_store_dwordx4 a[244:247], v1, s[16:19], s94 offen offset:1024 sc1
M v[104:107], a[180:183], a[52:55], v[104:107]
M v[108:111], a[180:183], a[60:63], v[108:111]
M v[108:111], a[176:179], a[56:59], v[108:111]
s_waitcnt vmcnt(21) lgkmcnt(0)
s_barrier
ds_read_b128 a[160:163], v10 offset:16384
ds_read_b128 a[164:167], v11 offset:16384
M v[112:115], a[176:179], a[64:67], v[112:115]
s_add_u32 m0, s29, 0
s_nop 0
buffer_load_dwordx4 v2, s[8:11], s23 offen offset:0 lds
M v[112:115], a[180:183], a[68:71], v[112:115]
M v[116:119], a[180:183], a[76:79], v[116:119]
M v[116:119], a[176:179], a[72:75], v[116:119]
ds_read_b64_tr_b16 a[100:101], v12 offset:49152
ds_read_b64_tr_b16 a[102:103], v12 offset:51200
M v[120:123], a[176:179], a[80:83], v[120:123]
M v[120:123], a[180:183], a[84:87], v[120:123]
M v[124:127], a[180:183], a[92:95], v[124:127]
buffer_load_dwordx4 v3, s[8:11], s23 offen offset:1024 lds
M v[124:127], a[176:179], a[88:91], v[124:127]
M v[128:131], a[184:187], a[32:35], v[128:131]
M v[128:131], a[188:191], a[36:39], v[128:131]
ds_read_b128 a[168:171], v10 offset:18432
ds_read_b128 a[172:175], v11 offset:18432
ds_read_b64_tr_b16 a[108:109], v13 offset:49152
ds_read_b64_tr_b16 a[110:111], v13 offset:51200
M v[132:135], a[188:191], a[44:47], v[132:135]
M v[132:135], a[184:187], a[40:43], v[132:135]
M v[136:139], a[184:187], a[48:51], v[136:139]
M v[136:139], a[188:191], a[52:55], v[136:139]
buffer_load_dwordx4 v4, s[8:11], s23 offen offset:2048 lds
M v[140:143], a[188:191], a[60:63], v[140:143]
M v[140:143], a[184:187], a[56:59], v[140:143]
ds_read_b64_tr_b16 a[116:117], v14 offset:49152
ds_read_b64_tr_b16 a[118:119], v14 offset:51200
M v[144:147], a[184:187], a[64:67], v[144:147]
M v[144:147], a[188:191], a[68:71], v[144:147]
M v[148:151], a[188:191], a[76:79], v[148:151]
M v[148:151], a[184:187], a[72:75], v[148:151]
buffer_load_dwordx4 v5, s[8:11], s23 offen offset:3072 lds
M v[152:155], a[184:187], a[80:83], v[152:155]
M v[152:155], a[188:191], a[84:87], v[152:155]
ds_read_b64_tr_b16 a[124:125], v15 offset:49152
ds_read_b64_tr_b16 a[126:127], v15 offset:51200
M v[156:159], a[188:191], a[92:95], v[156:159]
M v[156:159], a[184:187], a[88:91], v[156:159]
s_waitcnt lgkmcnt(10)
M v[160:163], a[160:163], a[32:35], v[160:163]
s_add_u32 s94, s93, 8192
buffer_store_dwordx4 a[248:251], v1, s[16:19], s94 offen offset:2048 sc1
M v[160:163], a[164:167], a[36:39], v[160:163]
ds_read_b128 a[176:179], v10 offset:20480
ds_read_b128 a[180:183], v11 offset:20480
M v[164:167], a[164:167], a[44:47], v[164:167]
M v[164:167], a[160:163], a[40:43], v[164:167]
ds_read_b64_tr_b16 a[132:133], v16 offset:49152
ds_read_b64_tr_b16 a[134:135], v16 offset:51200
M v[168:171], a[160:163], a[48:51], v[168:171]
M v[168:171], a[164:167], a[52:55], v[168:171]
s_add_u32 m0, s29, 98304
s_nop 0
buffer_load_dwordx4 v6, s[12:15], s24 offen offset:0 lds
M v[172:175], a[164:167], a[60:63], v[172:175]
M v[172:175], a[160:163], a[56:59], v[172:175]
M v[176:179], a[160:163], a[64:67], v[176:179]
M v[176:179], a[164:167], a[68:71], v[176:179]
ds_read_b64_tr_b16 a[140:141], v17 offset:49152
ds_read_b64_tr_b16 a[142:143], v17 offset:51200
M v[180:183], a[164:167], a[76:79], v[180:183]
M v[180:183], a[160:163], a[72:75], v[180:183]
buffer_load_dwordx4 v7, s[12:15], s24 offen offset:1024 lds
M v[184:187], a[160:163], a[80:83], v[184:187]
M v[184:187], a[164:167], a[84:87], v[184:187]
M v[188:191], a[164:167], a[92:95], v[188:191]
M v[188:191], a[160:163], a[88:91], v[188:191]
s_waitcnt lgkmcnt(12)
ds_read_b64_tr_b16 a[148:149], v18 offset:49152
ds_read_b64_tr_b16 a[150:151], v18 offset:51200
M v[192:195], a[168:171], a[32:35], v[192:195]
M v[192:195], a[172:175], a[36:39], v[192:195]
ds_read_b128 a[184:187], v10 offset:22528
ds_read_b128 a[188:191], v11 offset:22528
M v[196:199], a[172:175], a[44:47], v[196:199]
buffer_load_dwordx4 v8, s[12:15], s24 offen offset:2048 lds
M v[196:199], a[168:171], a[40:43], v[196:199]
M v[200:203], a[168:171], a[48:51], v[200:203]
M v[200:203], a[172:175], a[52:55], v[200:203]
ds_read_b64_tr_b16 a[156:157], v19 offset:49152
ds_read_b64_tr_b16 a[158:159], v19 offset:51200
M v[204:207], a[172:175], a[60:63], v[204:207]
M v[204:207], a[168:171], a[56:59], v[204:207]
M v[208:211], a[168:171], a[64:67], v[208:211]
buffer_load_dwordx4 v9, s[12:15], s24 offen offset:3072 lds
M v[208:211], a[172:175], a[68:71], v[208:211]
M v[212:215], a[172:175], a[76:79], v[212:215]
M v[212:215], a[168:171], a[72:75], v[212:215]
M v[216:219], a[168:171], a[80:83], v[216:219]
s_add_u32 s94, s93, 8192
buffer_store_dwordx4 a[252:255], v1, s[16:19], s94 offen offset:3072 sc1
M v[216:219], a[172:175], a[84:87], v[216:219]
M v[220:223], a[172:175], a[92:95], v[220:223]
s_add_u32 s24, s24, 262144
M v[220:223], a[168:171], a[88:91], v[220:223]
s_waitcnt lgkmcnt(10)
M v[224:227], a[176:179], a[32:35], v[224:227]
M v[224:227], a[180:183], a[36:39], v[224:227]
M v[228:231], a[180:183], a[44:47], v[228:231]
M v[228:231], a[176:179], a[40:43], v[228:231]
M v[232:235], a[176:179], a[48:51], v[232:235]
M v[232:235], a[180:183], a[52:55], v[232:235]
M v[236:239], a[180:183], a[60:63], v[236:239]
M v[236:239], a[176:179], a[56:59], v[236:239]
s_waitcnt vmcnt(21) lgkmcnt(0)
s_barrier
ds_read_b128 a[160:163], v10 offset:32768
ds_read_b128 a[164:167], v11 offset:32768
M v[240:243], a[176:179], a[64:67], v[240:243]
s_add_u32 m0, s29, 16384
s_add_u32 s3, s23, s31
buffer_load_dwordx4 v2, s[8:11], s3 offen offset:0 lds
M v[240:243], a[180:183], a[68:71], v[240:243]
M v[244:247], a[180:183], a[76:79], v[244:247]
M v[244:247], a[176:179], a[72:75], v[244:247]
M v[248:251], a[176:179], a[80:83], v[248:251]
M v[248:251], a[180:183], a[84:87], v[248:251]
buffer_load_dwordx4 v3, s[8:11], s3 offen offset:1024 lds
M v[252:255], a[180:183], a[92:95], v[252:255]
M v[252:255], a[176:179], a[88:91], v[252:255]
M a[0:3], a[184:187], a[32:35], a[0:3]
M a[0:3], a[188:191], a[36:39], a[0:3]
ds_read_b128 a[168:171], v10 offset:34816
ds_read_b128 a[172:175], v11 offset:34816
M a[4:7], a[188:191], a[44:47], a[4:7]
M a[4:7], a[184:187], a[40:43], a[4:7]
M a[8:11], a[184:187], a[48:51], a[8:11]
buffer_load_dwordx4 v4, s[8:11], s3 offen offset:2048 lds
M a[8:11], a[188:191], a[52:55], a[8:11]
M a[12:15], a[188:191], a[60:63], a[12:15]
M a[12:15], a[184:187], a[56:59], a[12:15]
M a[16:19], a[184:187], a[64:67], a[16:19]
M a[16:19], a[188:191], a[68:71], a[16:19]
buffer_load_dwordx4 v5, s[8:11], s3 offen offset:3072 lds
M a[20:23], a[188:191], a[76:79], a[20:23]
M a[20:23], a[184:187], a[72:75], a[20:23]
M a[24:27], a[184:187], a[80:83], a[24:27]
M a[24:27], a[188:191], a[84:87], a[24:27]
M a[28:31], a[188:191], a[92:95], a[28:31]
M a[28:31], a[184:187], a[88:91], a[28:31]
s_waitcnt lgkmcnt(2)
M v[32:35], a[160:163], a[96:99], v[32:35]
s_add_u32 s23, s23, 128
s_cmp_eq_u32 s23, s25
s_cselect_b32 s23, s26, s23
M v[32:35], a[164:167], a[100:103], v[32:35]
ds_read_b128 a[176:179], v10 offset:36864
ds_read_b128 a[180:183], v11 offset:36864
M v[36:39], a[164:167], a[108:111], v[36:39]
M v[36:39], a[160:163], a[104:107], v[36:39]
ds_read_b64_tr_b16 a[32:33], v12 offset:0
ds_read_b64_tr_b16 a[34:35], v12 offset:2048
M v[40:43], a[160:163], a[112:115], v[40:43]
M v[40:43], a[164:167], a[116:119], v[40:43]
M v[44:47], a[164:167], a[124:127], v[44:47]
s_add_u32 m0, s29, 114688
s_nop 0
buffer_load_dwordx4 v6, s[12:15], s24 offen offset:0 lds
M v[44:47], a[160:163], a[120:123], v[44:47]
ds_read_b64_tr_b16 a[40:41], v13 offset:0
ds_read_b64_tr_b16 a[42:43], v13 offset:2048
M v[48:51], a[160:163], a[128:131], v[48:51]
M v[48:51], a[164:167], a[132:135], v[48:51]
M v[52:55], a[164:167], a[140:143], v[52:55]
M v[52:55], a[160:163], a[136:139], v[52:55]
ds_read_b64_tr_b16 a[48:49], v14 offset:0
ds_read_b64_tr_b16 a[50:51], v14 offset:2048
M v[56:59], a[160:163], a[144:147], v[56:59]
M v[56:59], a[164:167], a[148:151], v[56:59]
buffer_load_dwordx4 v7, s[12:15], s24 offen offset:1024 lds
M v[60:63], a[164:167], a[156:159], v[60:63]
M v[60:63], a[160:163], a[152:155], v[60:63]
s_waitcnt lgkmcnt(8)
ds_read_b64_tr_b16 a[56:57], v15 offset:0
ds_read_b64_tr_b16 a[58:59], v15 offset:2048
M v[64:67], a[168:171], a[96:99], v[64:67]
M v[64:67], a[172:175], a[100:103], v[64:67]
ds_read_b128 a[184:187], v10 offset:38912
ds_read_b128 a[188:191], v11 offset:38912
M v[68:71], a[172:175], a[108:111], v[68:71]
M v[68:71], a[168:171], a[104:107], v[68:71]
ds_read_b64_tr_b16 a[64:65], v16 offset:0
ds_read_b64_tr_b16 a[66:67], v16 offset:2048
M v[72:75], a[168:171], a[112:115], v[72:75]
buffer_load_dwordx4 v8, s[12:15], s24 offen offset:2048 lds
M v[72:75], a[172:175], a[116:119], v[72:75]
M v[76:79], a[172:175], a[124:127], v[76:79]
M v[76:79], a[168:171], a[120:123], v[76:79]
ds_read_b64_tr_b16 a[72:73], v17 offset:0
ds_read_b64_tr_b16 a[74:75], v17 offset:2048
M v[80:83], a[168:171], a[128:131], v[80:83]
M v[80:83], a[172:175], a[132:135], v[80:83]
M v[84:87], a[172:175], a[140:143], v[84:87]
buffer_load_dwordx4 v9, s[12:15], s24 offen offset:3072 lds
M v[84:87], a[168:171], a[136:139], v[84:87]
ds_read_b64_tr_b16 a[80:81], v18 offset:0
ds_read_b64_tr_b16 a[82:83], v18 offset:2048
M v[88:91], a[168:171], a[144:147], v[88:91]
M v[88:91], a[172:175], a[148:151], v[88:91]
M v[92:95], a[172:175], a[156:159], v[92:95]
M v[92:95], a[168:171], a[152:155], v[92:95]
s_waitcnt lgkmcnt(15)
ds_read_b64_tr_b16 a[88:89], v19 offset:0
ds_read_b64_tr_b16 a[90:91], v19 offset:2048
M v[96:99], a[176:179], a[96:99], v[96:99]
s_add_u32 s24, s24, 262144
s_cmp_eq_u32 s24, s27
s_cselect_b32 s24, s28, s24
s_sub_u32 s6, s6, 1
s_cmp_eq_u32 s6, 0
s_cselect_b64 s[12:13], s[64:65], s[12:13]
M v[96:99], a[180:183], a[100:103], v[96:99]
M v[100:103], a[180:183], a[108:111], v[100:103]
M v[100:103], a[176:179], a[104:107], v[100:103]
M v[104:107], a[176:179], a[112:115], v[104:107]
M v[104:107], a[180:183], a[116:119], v[104:107]
M v[108:111], a[180:183], a[124:127], v[108:111]
M v[108:111], a[176:179], a[120:123], v[108:111]
s_waitcnt vmcnt(19) lgkmcnt(0)
s_barrier
ds_read_b128 a[160:163], v10 offset:49152
ds_read_b128 a[164:167], v11 offset:49152
M v[112:115], a[176:179], a[128:131], v[112:115]
s_add_u32 m0, s29, 32768
s_nop 0
buffer_load_dwordx4 v2, s[8:11], s23 offen offset:0 lds
M v[112:115], a[180:183], a[132:135], v[112:115]
M v[116:119], a[180:183], a[140:143], v[116:119]
M v[116:119], a[176:179], a[136:139], v[116:119]
ds_read_b64_tr_b16 a[36:37], v12 offset:16384
ds_read_b64_tr_b16 a[38:39], v12 offset:18432
M v[120:123], a[176:179], a[144:147], v[120:123]
M v[120:123], a[180:183], a[148:151], v[120:123]
M v[124:127], a[180:183], a[156:159], v[124:127]
M v[124:127], a[176:179], a[152:155], v[124:127]
M v[128:131], a[184:187], a[96:99], v[128:131]
M v[128:131], a[188:191], a[100:103], v[128:131]
ds_read_b128 a[168:171], v10 offset:51200
ds_read_b128 a[172:175], v11 offset:51200
ds_read_b64_tr_b16 a[44:45], v13 offset:16384
ds_read_b64_tr_b16 a[46:47], v13 offset:18432
M v[132:135], a[188:191], a[108:111], v[132:135]
M v[132:135], a[184:187], a[104:107], v[132:135]
M v[136:139], a[184:187], a[112:115], v[136:139]
M v[136:139], a[188:191], a[116:119], v[136:139]
M v[140:143], a[188:191], a[124:127], v[140:143]
M v[140:143], a[184:187], a[120:123], v[140:143]
ds_read_b64_tr_b16 a[52:53], v14 offset:16384
ds_read_b64_tr_b16 a[54:55], v14 offset:18432
M v[144:147], a[184:187], a[128:131], v[144:147]
buffer_load_dwordx4 v3, s[8:11], s23 offen offset:1024 lds
M v[144:147], a[188:191], a[132:135], v[144:147]
M v[148:151], a[188:191], a[140:143], v[148:151]
M v[148:151], a[184:187], a[136:139], v[148:151]
M v[152:155], a[184:187], a[144:147], v[152:155]
M v[152:155], a[188:191], a[148:151], v[152:155]
ds_read_b64_tr_b16 a[60:61], v15 offset:16384
ds_read_b64_tr_b16 a[62:63], v15 offset:18432
M v[156:159], a[188:191], a[156:159], v[156:159]
M v[156:159], a[184:187], a[152:155], v[156:159]
s_waitcnt lgkmcnt(10)
M v[160:163], a[160:163], a[96:99], v[160:163]
M v[160:163], a[164:167], a[100:103], v[160:163]
ds_read_b128 a[176:179], v10 offset:53248
ds_read_b128 a[180:183], v11 offset:53248
M v[164:167], a[164:167], a[108:111], v[164:167]
M v[164:167], a[160:163], a[104:107], v[164:167]
ds_read_b64_tr_b16 a[68:69], v16 offset:16384
ds_read_b64_tr_b16 a[70:71], v16 offset:18432
M v[168:171], a[160:163], a[112:115], v[168:171]
M v[168:171], a[164:167], a[116:119], v[168:171]
M v[172:175], a[164:167], a[124:127], v[172:175]
M v[172:175], a[160:163], a[120:123], v[172:175]
M v[176:179], a[160:163], a[128:131], v[176:179]
buffer_load_dwordx4 v4, s[8:11], s23 offen offset:2048 lds
M v[176:179], a[164:167], a[132:135], v[176:179]
ds_read_b64_tr_b16 a[76:77], v17 offset:16384
ds_read_b64_tr_b16 a[78:79], v17 offset:18432
M v[180:183], a[164:167], a[140:143], v[180:183]
M v[180:183], a[160:163], a[136:139], v[180:183]
M v[184:187], a[160:163], a[144:147], v[184:187]
M v[184:187], a[164:167], a[148:151], v[184:187]
M v[188:191], a[164:167], a[156:159], v[188:191]
M v[188:191], a[160:163], a[152:155], v[188:191]
s_waitcnt lgkmcnt(12)
ds_read_b64_tr_b16 a[84:85], v18 offset:16384
ds_read_b64_tr_b16 a[86:87], v18 offset:18432
M v[192:195], a[168:171], a[96:99], v[192:195]
M v[192:195], a[172:175], a[100:103], v[192:195]
ds_read_b128 a[184:187], v10 offset:55296
ds_read_b128 a[188:191], v11 offset:55296
M v[196:199], a[172:175], a[108:111], v[196:199]
M v[196:199], a[168:171], a[104:107], v[196:199]
M v[200:203], a[168:171], a[112:115], v[200:203]
M v[200:203], a[172:175], a[116:119], v[200:203]
ds_read_b64_tr_b16 a[92:93], v19 offset:16384
ds_read_b64_tr_b16 a[94:95], v19 offset:18432
M v[204:207], a[172:175], a[124:127], v[204:207]
M v[204:207], a[168:171], a[120:123], v[204:207]
M v[208:211], a[168:171], a[128:131], v[208:211]
buffer_load_dwordx4 v5, s[8:11], s23 offen offset:3072 lds
M v[208:211], a[172:175], a[132:135], v[208:211]
M v[212:215], a[172:175], a[140:143], v[212:215]
M v[212:215], a[168:171], a[136:139], v[212:215]
M v[216:219], a[168:171], a[144:147], v[216:219]
M v[216:219], a[172:175], a[148:151], v[216:219]
M v[220:223], a[172:175], a[156:159], v[220:223]
M v[220:223], a[168:171], a[152:155], v[220:223]
s_waitcnt lgkmcnt(10)
M v[224:227], a[176:179], a[96:99], v[224:227]
M v[224:227], a[180:183], a[100:103], v[224:227]
M v[228:231], a[180:183], a[108:111], v[228:231]
M v[228:231], a[176:179], a[104:107], v[228:231]
M v[232:235], a[176:179], a[112:115], v[232:235]
M v[232:235], a[180:183], a[116:119], v[232:235]
M v[236:239], a[180:183], a[124:127], v[236:239]
M v[236:239], a[176:179], a[120:123], v[236:239]
s_waitcnt vmcnt(13) lgkmcnt(0)
s_barrier
ds_read_b128 a[160:163], v10 offset:0
ds_read_b128 a[164:167], v11 offset:0
M v[240:243], a[176:179], a[128:131], v[240:243]
s_add_u32 m0, s29, 49152
s_add_u32 s3, s23, s31
buffer_load_dwordx4 v2, s[8:11], s3 offen offset:0 lds
M v[240:243], a[180:183], a[132:135], v[240:243]
M v[244:247], a[180:183], a[140:143], v[244:247]
M v[244:247], a[176:179], a[136:139], v[244:247]
M v[248:251], a[176:179], a[144:147], v[248:251]
M v[248:251], a[180:183], a[148:151], v[248:251]
M v[252:255], a[180:183], a[156:159], v[252:255]
M v[252:255], a[176:179], a[152:155], v[252:255]
M a[0:3], a[184:187], a[96:99], a[0:3]
M a[0:3], a[188:191], a[100:103], a[0:3]
ds_read_b128 a[168:171], v10 offset:2048
ds_read_b128 a[172:175], v11 offset:2048
M a[4:7], a[188:191], a[108:111], a[4:7]
M a[4:7], a[184:187], a[104:107], a[4:7]
M a[8:11], a[184:187], a[112:115], a[8:11]
buffer_load_dwordx4 v3, s[8:11], s3 offen offset:1024 lds
M a[8:11], a[188:191], a[116:119], a[8:11]
M a[12:15], a[188:191], a[124:127], a[12:15]
M a[12:15], a[184:187], a[120:123], a[12:15]
M a[16:19], a[184:187], a[128:131], a[16:19]
M a[16:19], a[188:191], a[132:135], a[16:19]
M a[20:23], a[188:191], a[140:143], a[20:23]
M a[20:23], a[184:187], a[136:139], a[20:23]
M a[24:27], a[184:187], a[144:147], a[24:27]
M a[24:27], a[188:191], a[148:151], a[24:27]
M a[28:31], a[188:191], a[156:159], a[28:31]
M a[28:31], a[184:187], a[152:155], a[28:31]
s_waitcnt lgkmcnt(2)
M v[32:35], a[160:163], a[32:35], v[32:35]
buffer_load_dwordx4 v4, s[8:11], s3 offen offset:2048 lds
M v[32:35], a[164:167], a[36:39], v[32:35]
ds_read_b128 a[176:179], v10 offset:4096
ds_read_b128 a[180:183], v11 offset:4096
M v[36:39], a[164:167], a[44:47], v[36:39]
M v[36:39], a[160:163], a[40:43], v[36:39]
ds_read_b64_tr_b16 a[96:97], v12 offset:32768
ds_read_b64_tr_b16 a[98:99], v12 offset:34816
M v[40:43], a[160:163], a[48:51], v[40:43]
M v[40:43], a[164:167], a[52:55], v[40:43]
M v[44:47], a[164:167], a[60:63], v[44:47]
M v[44:47], a[160:163], a[56:59], v[44:47]
ds_read_b64_tr_b16 a[104:105], v13 offset:32768
ds_read_b64_tr_b16 a[106:107], v13 offset:34816
M v[48:51], a[160:163], a[64:67], v[48:51]
M v[48:51], a[164:167], a[68:71], v[48:51]
M v[52:55], a[164:167], a[76:79], v[52:55]
M v[52:55], a[160:163], a[72:75], v[52:55]
ds_read_b64_tr_b16 a[112:113], v14 offset:32768
ds_read_b64_tr_b16 a[114:115], v14 offset:34816
M v[56:59], a[160:163], a[80:83], v[56:59]
M v[56:59], a[164:167], a[84:87], v[56:59]
buffer_load_dwordx4 v5, s[8:11], s3 offen offset:3072 lds
M v[60:63], a[164:167], a[92:95], v[60:63]
M v[60:63], a[160:163], a[88:91], v[60:63]
s_waitcnt lgkmcnt(8)
ds_read_b64_tr_b16 a[120:121], v15 offset:32768
ds_read_b64_tr_b16 a[122:123], v15 offset:34816
M v[64:67], a[168:171], a[32:35], v[64:67]
M v[64:67], a[172:175], a[36:39], v[64:67]
ds_read_b128 a[184:187], v10 offset:6144
ds_read_b128 a[188:191], v11 offset:6144
M v[68:71], a[172:175], a[44:47], v[68:71]
M v[68:71], a[168:171], a[40:43], v[68:71]
ds_read_b64_tr_b16 a[128:129], v16 offset:32768
ds_read_b64_tr_b16 a[130:131], v16 offset:34816
M v[72:75], a[168:171], a[48:51], v[72:75]
M v[72:75], a[172:175], a[52:55], v[72:75]
M v[76:79], a[172:175], a[60:63], v[76:79]
M v[76:79], a[168:171], a[56:59], v[76:79]
ds_read_b64_tr_b16 a[136:137], v17 offset:32768
ds_read_b64_tr_b16 a[138:139], v17 offset:34816
M v[80:83], a[168:171], a[64:67], v[80:83]
M v[80:83], a[172:175], a[68:71], v[80:83]
M v[84:87], a[172:175], a[76:79], v[84:87]
s_add_u32 s23, s23, 128
s_cmp_eq_u32 s23, s25
s_cselect_b32 s23, s26, s23
M v[84:87], a[168:171], a[72:75], v[84:87]
ds_read_b64_tr_b16 a[144:145], v18 offset:32768
ds_read_b64_tr_b16 a[146:147], v18 offset:34816
M v[88:91], a[168:171], a[80:83], v[88:91]
M v[88:91], a[172:175], a[84:87], v[88:91]
M v[92:95], a[172:175], a[92:95], v[92:95]
M v[92:95], a[168:171], a[88:91], v[92:95]
s_waitcnt lgkmcnt(15)
ds_read_b64_tr_b16 a[152:153], v19 offset:32768
ds_read_b64_tr_b16 a[154:155], v19 offset:34816
M v[96:99], a[176:179], a[32:35], v[96:99]
M v[96:99], a[180:183], a[36:39], v[96:99]
M v[100:103], a[180:183], a[44:47], v[100:103]
M v[100:103], a[176:179], a[40:43], v[100:103]
M v[104:107], a[176:179], a[48:51], v[104:107]
M v[104:107], a[180:183], a[52:55], v[104:107]
M v[108:111], a[180:183], a[60:63], v[108:111]
M v[108:111], a[176:179], a[56:59], v[108:111]
s_waitcnt vmcnt(8) lgkmcnt(0)
s_barrier
ds_read_b128 a[160:163], v10 offset:16384
ds_read_b128 a[164:167], v11 offset:16384
M v[112:115], a[176:179], a[64:67], v[112:115]
M v[112:115], a[180:183], a[68:71], v[112:115]
s_and_b32 s3, s2, 1
s_lshl_b32 s3, s3, 3
s_bfe_u32 s4, s2, 0x30003
M v[116:119], a[180:183], a[76:79], v[116:119]
s_add_u32 s26, s3, s4
s_bfe_u32 s3, s2, 0x20001
s_lshl_b32 s3, s3, 2
M v[116:119], a[176:179], a[72:75], v[116:119]
ds_read_b64_tr_b16 a[100:101], v12 offset:49152
ds_read_b64_tr_b16 a[102:103], v12 offset:51200
s_lshr_b32 s4, s2, 6
s_xor_b32 s4, s4, 2
s_add_u32 s27, s3, s4
M v[120:123], a[176:179], a[80:83], v[120:123]
s_lshl_b32 s23, s26, 18
s_sub_u32 s24, s23, 32768
M v[120:123], a[180:183], a[84:87], v[120:123]
s_max_i32 s24, s24, 0
s_lshl_b32 s25, s27, 7
s_add_u32 s3, s26, s27
M v[124:127], a[180:183], a[92:95], v[124:127]
s_and_b32 s3, s3, 0
s_mul_i32 s3, s3, 16
s_sub_u32 s31, 16, s3
M v[124:127], a[176:179], a[88:91], v[124:127]
s_mov_b32 s54, s31
s_movk_i32 s57, 128
M v[128:131], a[184:187], a[32:35], v[128:131]
s_mov_b32 s55, 4289069056
s_mov_b32 s56, 393216
s_lshl_b32 s4, s3, 7
M v[128:131], a[188:191], a[36:39], v[128:131]
ds_read_b128 a[168:171], v10 offset:18432
ds_read_b128 a[172:175], v11 offset:18432
ds_read_b64_tr_b16 a[108:109], v13 offset:49152
ds_read_b64_tr_b16 a[110:111], v13 offset:51200
s_add_u32 s23, s23, s4
s_add_u32 s24, s24, s4
s_mul_i32 s4, s3, 393216
M v[132:135], a[188:191], a[44:47], v[132:135]
s_add_u32 s25, s25, s4
s_mov_b64 s[8:9], s[44:45]
s_mov_b32 s10, 4194304
M v[132:135], a[184:187], a[40:43], v[132:135]
s_mov_b64 s[12:13], s[46:47]
s_mov_b32 s14, 6291456
M v[136:139], a[184:187], a[48:51], v[136:139]
s_mov_b64 s[36:37], s[90:91]
s_mov_b32 s38, 256
s_mov_b32 s39, 0x00020000
M v[136:139], a[188:191], a[52:55], v[136:139]
s_lshl_b32 s28, s20, 9
s_mul_i32 s30, s20, 6144
s_lshl_b32 s3, s20, 5
M v[140:143], a[188:191], a[60:63], v[140:143]
v_lshrrev_b32 v24, 3, v0
v_and_b32 v25, 7, v0
M v[140:143], a[184:187], a[56:59], v[140:143]
ds_read_b64_tr_b16 a[116:117], v14 offset:49152
ds_read_b64_tr_b16 a[118:119], v14 offset:51200
v_add_u32 v28, s3, v24
v_add_u32 v26, 0, v28
v_bfe_u32 v27, v26, 1, 3
M v[144:147], a[184:187], a[64:67], v[144:147]
v_xor_b32 v27, v27, v25
v_lshlrev_b32 v26, 11, v26
v_lshl_add_u32 v26, v27, 4, v26
M v[144:147], a[188:191], a[68:71], v[144:147]
v_subrev_u32 v2, 0, v26
v_add_u32 v26, 8, v28
v_bfe_u32 v27, v26, 1, 3
M v[148:151], a[188:191], a[76:79], v[148:151]
v_xor_b32 v27, v27, v25
v_lshlrev_b32 v26, 11, v26
M v[148:151], a[184:187], a[72:75], v[148:151]
v_lshl_add_u32 v26, v27, 4, v26
v_subrev_u32 v3, 1024, v26
v_add_u32 v26, 16, v28
M v[152:155], a[184:187], a[80:83], v[152:155]
v_bfe_u32 v27, v26, 1, 3
v_xor_b32 v27, v27, v25
v_lshlrev_b32 v26, 11, v26
M v[152:155], a[188:191], a[84:87], v[152:155]
ds_read_b64_tr_b16 a[124:125], v15 offset:49152
ds_read_b64_tr_b16 a[126:127], v15 offset:51200
v_lshl_add_u32 v26, v27, 4, v26
v_subrev_u32 v4, 2048, v26
M v[156:159], a[188:191], a[92:95], v[156:159]
v_add_u32 v26, 24, v28
v_bfe_u32 v27, v26, 1, 3
v_xor_b32 v27, v27, v25
M v[156:159], a[184:187], a[88:91], v[156:159]
s_waitcnt lgkmcnt(10)
v_lshlrev_b32 v26, 11, v26
v_lshl_add_u32 v26, v27, 4, v26
v_subrev_u32 v5, 3072, v26
M v[160:163], a[160:163], a[32:35], v[160:163]
s_lshl_b32 s3, s20, 2
v_lshrrev_b32 v26, 5, v0
M v[160:163], a[164:167], a[36:39], v[160:163]
ds_read_b128 a[176:179], v10 offset:20480
ds_read_b128 a[180:183], v11 offset:20480
v_add_u32 v26, s3, v26
v_bfe_u32 v29, v0, 2, 3
v_bfe_u32 v27, v26, 1, 3
M v[164:167], a[164:167], a[44:47], v[164:167]
v_xor_b32 v27, v27, v29
v_lshlrev_b32 v27, 4, v27
v_and_b32 v30, 3, v0
M v[164:167], a[160:163], a[40:43], v[164:167]
ds_read_b64_tr_b16 a[132:133], v16 offset:49152
ds_read_b64_tr_b16 a[134:135], v16 offset:51200
v_lshl_add_u32 v27, v30, 2, v27
v_lshl_add_u32 v20, v26, 11, v27
v_add_u32 v26, 2, v26
M v[168:171], a[160:163], a[48:51], v[168:171]
v_bfe_u32 v27, v26, 1, 3
v_xor_b32 v27, v27, v29
M v[168:171], a[164:167], a[52:55], v[168:171]
v_lshlrev_b32 v27, 4, v27
v_and_b32 v30, 3, v0
v_lshl_add_u32 v27, v30, 2, v27
M v[172:175], a[164:167], a[60:63], v[172:175]
v_lshl_add_u32 v23, v26, 11, v27
v_subrev_u32 v23, 256, v23
s_mul_i32 s3, s20, 48
M v[172:175], a[160:163], a[56:59], v[172:175]
v_add_u32 v28, s3, v24
v_add_u32 v26, 0, v28
M v[176:179], a[160:163], a[64:67], v[176:179]
v_mul_u32_u24 v27, 0xaaab, v26
v_lshrrev_b32 v27, 17, v27
v_lshrrev_b32 v29, 1, v27
M v[176:179], a[164:167], a[68:71], v[176:179]
ds_read_b64_tr_b16 a[140:141], v17 offset:49152
ds_read_b64_tr_b16 a[142:143], v17 offset:51200
v_and_b32 v29, 4, v29
v_and_or_b32 v27, v27, 2, v29
v_xor_b32 v27, v27, v25
M v[180:183], a[164:167], a[76:79], v[180:183]
v_lshlrev_b32 v26, 11, v26
v_lshl_add_u32 v26, v27, 4, v26
v_subrev_u32 v6, 0, v26
M v[180:183], a[160:163], a[72:75], v[180:183]
v_add_u32 v26, 8, v28
v_mul_u32_u24 v27, 0xaaab, v26
M v[184:187], a[160:163], a[80:83], v[184:187]
v_lshrrev_b32 v27, 17, v27
v_lshrrev_b32 v29, 1, v27
v_and_b32 v29, 4, v29
M v[184:187], a[164:167], a[84:87], v[184:187]
v_and_or_b32 v27, v27, 2, v29
v_xor_b32 v27, v27, v25
v_lshlrev_b32 v26, 11, v26
M v[188:191], a[164:167], a[92:95], v[188:191]
v_lshl_add_u32 v26, v27, 4, v26
v_subrev_u32 v7, 1024, v26
M v[188:191], a[160:163], a[88:91], v[188:191]
s_waitcnt lgkmcnt(12)
ds_read_b64_tr_b16 a[148:149], v18 offset:49152
ds_read_b64_tr_b16 a[150:151], v18 offset:51200
v_add_u32 v26, 16, v28
v_mul_u32_u24 v27, 0xaaab, v26
v_lshrrev_b32 v27, 17, v27
M v[192:195], a[168:171], a[32:35], v[192:195]
v_lshrrev_b32 v29, 1, v27
v_and_b32 v29, 4, v29
v_and_or_b32 v27, v27, 2, v29
M v[192:195], a[172:175], a[36:39], v[192:195]
ds_read_b128 a[184:187], v10 offset:22528
ds_read_b128 a[188:191], v11 offset:22528
v_xor_b32 v27, v27, v25
v_lshlrev_b32 v26, 11, v26
M v[196:199], a[172:175], a[44:47], v[196:199]
v_lshl_add_u32 v26, v27, 4, v26
v_subrev_u32 v8, 2048, v26
v_add_u32 v26, 24, v28
M v[196:199], a[168:171], a[40:43], v[196:199]
v_mul_u32_u24 v27, 0xaaab, v26
v_lshrrev_b32 v27, 17, v27
v_lshrrev_b32 v29, 1, v27
M v[200:203], a[168:171], a[48:51], v[200:203]
v_and_b32 v29, 4, v29
v_and_or_b32 v27, v27, 2, v29
v_xor_b32 v27, v27, v25
M v[200:203], a[172:175], a[52:55], v[200:203]
ds_read_b64_tr_b16 a[156:157], v19 offset:49152
ds_read_b64_tr_b16 a[158:159], v19 offset:51200
v_lshlrev_b32 v26, 11, v26
v_lshl_add_u32 v26, v27, 4, v26
M v[204:207], a[172:175], a[60:63], v[204:207]
v_subrev_u32 v9, 3072, v26
v_add_u32 v26, 32, v28
v_mul_u32_u24 v27, 0xaaab, v26
M v[204:207], a[168:171], a[56:59], v[204:207]
v_lshrrev_b32 v27, 17, v27
v_lshrrev_b32 v29, 1, v27
v_and_b32 v29, 4, v29
M v[208:211], a[168:171], a[64:67], v[208:211]
v_and_or_b32 v27, v27, 2, v29
v_xor_b32 v27, v27, v25
M v[208:211], a[172:175], a[68:71], v[208:211]
v_lshlrev_b32 v26, 11, v26
v_lshl_add_u32 v26, v27, 4, v26
v_subrev_u32 v21, 0, v26
M v[212:215], a[172:175], a[76:79], v[212:215]
v_add_u32 v26, 40, v28
v_mul_u32_u24 v27, 0xaaab, v26
v_lshrrev_b32 v27, 17, v27
M v[212:215], a[168:171], a[72:75], v[212:215]
v_lshrrev_b32 v29, 1, v27
v_and_b32 v29, 4, v29
v_and_or_b32 v27, v27, 2, v29
M v[216:219], a[168:171], a[80:83], v[216:219]
v_xor_b32 v27, v27, v25
v_lshlrev_b32 v26, 11, v26
M v[216:219], a[172:175], a[84:87], v[216:219]
v_lshl_add_u32 v26, v27, 4, v26
v_subrev_u32 v22, 1024, v26
s_lshr_b32 s3, s53, 7
M v[220:223], a[172:175], a[92:95], v[220:223]
s_add_u32 s3, s3, s22
s_lshl_b32 s3, s3, 5
s_lshr_b32 s19, s52, 6
M v[220:223], a[168:171], a[88:91], v[220:223]
s_waitcnt lgkmcnt(10)
s_add_u32 s3, s3, s19
s_lshl_b32 s19, s21, 1
M v[224:227], a[176:179], a[32:35], v[224:227]
s_add_u32 s3, s3, s19
s_lshl_b32 s92, s3, 15
s_add_u32 s92, s92, 16384
M v[224:227], a[180:183], a[36:39], v[224:227]
s_add_u32 s93, s92, 32768
s_add_u32 s16, s50, 16777216
s_addc_u32 s17, s51, 0
M v[228:231], a[180:183], a[44:47], v[228:231]
s_mov_b32 s18, 33554432
s_mov_b32 s19, 0x00020000
M v[228:231], a[176:179], a[40:43], v[228:231]
M v[232:235], a[176:179], a[48:51], v[232:235]
M v[232:235], a[180:183], a[52:55], v[232:235]
M v[236:239], a[180:183], a[60:63], v[236:239]
M v[236:239], a[176:179], a[56:59], v[236:239]
s_waitcnt vmcnt(4) lgkmcnt(0)
s_barrier
ds_read_b128 a[160:163], v10 offset:32768
ds_read_b128 a[164:167], v11 offset:32768
M v[240:243], a[176:179], a[64:67], v[240:243]
s_add_u32 m0, s28, 131072
s_nop 0
buffer_load_dword v20, s[8:11], s24 offen lds
M v[240:243], a[180:183], a[68:71], v[240:243]
M v[244:247], a[180:183], a[76:79], v[244:247]
M v[244:247], a[176:179], a[72:75], v[244:247]
buffer_load_dword v23, s[8:11], s24 offen offset:256 lds
M v[248:251], a[176:179], a[80:83], v[248:251]
M v[248:251], a[180:183], a[84:87], v[248:251]
M v[252:255], a[180:183], a[92:95], v[252:255]
M v[252:255], a[176:179], a[88:91], v[252:255]
M a[0:3], a[184:187], a[32:35], a[0:3]
s_add_u32 m0, s29, 133120
s_nop 0
buffer_load_dwordx4 v2, s[8:11], s23 offen offset:0 lds
M a[0:3], a[188:191], a[36:39], a[0:3]
ds_read_b128 a[168:171], v10 offset:34816
ds_read_b128 a[172:175], v11 offset:34816
M a[4:7], a[188:191], a[44:47], a[4:7]
M a[4:7], a[184:187], a[40:43], a[4:7]
M a[8:11], a[184:187], a[48:51], a[8:11]
buffer_load_dwordx4 v3, s[8:11], s23 offen offset:1024 lds
M a[8:11], a[188:191], a[52:55], a[8:11]
M a[12:15], a[188:191], a[60:63], a[12:15]
M a[12:15], a[184:187], a[56:59], a[12:15]
M a[16:19], a[184:187], a[64:67], a[16:19]
buffer_load_dwordx4 v4, s[8:11], s23 offen offset:2048 lds
M a[16:19], a[188:191], a[68:71], a[16:19]
M a[20:23], a[188:191], a[76:79], a[20:23]
M a[20:23], a[184:187], a[72:75], a[20:23]
buffer_load_dwordx4 v5, s[8:11], s23 offen offset:3072 lds
M a[24:27], a[184:187], a[80:83], a[24:27]
M a[24:27], a[188:191], a[84:87], a[24:27]
M a[28:31], a[188:191], a[92:95], a[28:31]
M a[28:31], a[184:187], a[88:91], a[28:31]
s_waitcnt lgkmcnt(2)
M v[32:35], a[160:163], a[96:99], v[32:35]
s_sub_u32 s31, s31, 1
s_cmp_eq_u32 s31, 0
s_cselect_b32 s58, -1920, s57
s_add_u32 s23, s23, s58
s_add_u32 s24, s24, s58
M v[32:35], a[164:167], a[100:103], v[32:35]
ds_read_b128 a[176:179], v10 offset:36864
ds_read_b128 a[180:183], v11 offset:36864
M v[36:39], a[164:167], a[108:111], v[36:39]
M v[36:39], a[160:163], a[104:107], v[36:39]
M v[40:43], a[160:163], a[112:115], v[40:43]
M v[40:43], a[164:167], a[116:119], v[40:43]
s_add_u32 m0, s30, 65536
s_nop 0
buffer_load_dwordx4 v6, s[12:15], s25 offen offset:0 lds
M v[44:47], a[164:167], a[124:127], v[44:47]
M v[44:47], a[160:163], a[120:123], v[44:47]
M v[48:51], a[160:163], a[128:131], v[48:51]
M v[48:51], a[164:167], a[132:135], v[48:51]
buffer_load_dwordx4 v7, s[12:15], s25 offen offset:1024 lds
M v[52:55], a[164:167], a[140:143], v[52:55]
M v[52:55], a[160:163], a[136:139], v[52:55]
M v[56:59], a[160:163], a[144:147], v[56:59]
M v[56:59], a[164:167], a[148:151], v[56:59]
buffer_load_dwordx4 v8, s[12:15], s25 offen offset:2048 lds
M v[60:63], a[164:167], a[156:159], v[60:63]
M v[60:63], a[160:163], a[152:155], v[60:63]
s_waitcnt lgkmcnt(2)
M v[64:67], a[168:171], a[96:99], v[64:67]
M v[64:67], a[172:175], a[100:103], v[64:67]
ds_read_b128 a[184:187], v10 offset:38912
ds_read_b128 a[188:191], v11 offset:38912
M v[68:71], a[172:175], a[108:111], v[68:71]
M v[68:71], a[168:171], a[104:107], v[68:71]
buffer_load_dwordx4 v9, s[12:15], s25 offen offset:3072 lds
M v[72:75], a[168:171], a[112:115], v[72:75]
M v[72:75], a[172:175], a[116:119], v[72:75]
M v[76:79], a[172:175], a[124:127], v[76:79]
M v[76:79], a[168:171], a[120:123], v[76:79]
s_add_u32 m0, s30, 69632
s_nop 0
buffer_load_dwordx4 v21, s[12:15], s25 offen offset:0 lds
M v[80:83], a[168:171], a[128:131], v[80:83]
M v[80:83], a[172:175], a[132:135], v[80:83]
M v[84:87], a[172:175], a[140:143], v[84:87]
M v[84:87], a[168:171], a[136:139], v[84:87]
buffer_load_dwordx4 v22, s[12:15], s25 offen offset:1024 lds
M v[88:91], a[168:171], a[144:147], v[88:91]
M v[88:91], a[172:175], a[148:151], v[88:91]
M v[92:95], a[172:175], a[156:159], v[92:95]
M v[92:95], a[168:171], a[152:155], v[92:95]
s_waitcnt lgkmcnt(2)
M v[96:99], a[176:179], a[96:99], v[96:99]
s_sub_u32 s54, s54, 1
s_cmp_eq_u32 s54, 0
s_cselect_b32 s58, s55, s56
s_add_u32 s25, s25, s58
M v[96:99], a[180:183], a[100:103], v[96:99]
M v[100:103], a[180:183], a[108:111], v[100:103]
M v[100:103], a[176:179], a[104:107], v[100:103]
v_cvt_pk_bf16_f32 v32, v32, v33
v_cvt_pk_bf16_f32 v33, v34, v35
M v[104:107], a[176:179], a[112:115], v[104:107]
v_cvt_pk_bf16_f32 v34, v64, v65
v_cvt_pk_bf16_f32 v35, v66, v67
M v[104:107], a[180:183], a[116:119], v[104:107]
v_cvt_pk_bf16_f32 v64, v48, v49
M v[108:111], a[180:183], a[124:127], v[108:111]
v_cvt_pk_bf16_f32 v65, v50, v51
v_cvt_pk_bf16_f32 v66, v80, v81
M v[108:111], a[176:179], a[120:123], v[108:111]
s_waitcnt vmcnt(12) lgkmcnt(0)
s_barrier
ds_read_b128 a[160:163], v10 offset:49152
ds_read_b128 a[164:167], v11 offset:49152
v_cvt_pk_bf16_f32 v67, v82, v83
M v[112:115], a[176:179], a[128:131], v[112:115]
s_add_u32 m0, s28, 0
s_nop 0
buffer_load_dword v20, s[8:11], s24 offen lds
v_cvt_pk_bf16_f32 v48, v40, v41
v_cvt_pk_bf16_f32 v49, v42, v43
M v[112:115], a[180:183], a[132:135], v[112:115]
v_cvt_pk_bf16_f32 v50, v72, v73
v_cvt_pk_bf16_f32 v51, v74, v75
M v[116:119], a[180:183], a[140:143], v[116:119]
v_cvt_pk_bf16_f32 v80, v56, v57
M v[116:119], a[176:179], a[136:139], v[116:119]
buffer_load_dword v23, s[8:11], s24 offen offset:256 lds
v_cvt_pk_bf16_f32 v81, v58, v59
v_cvt_pk_bf16_f32 v82, v88, v89
M v[120:123], a[176:179], a[144:147], v[120:123]
v_cvt_pk_bf16_f32 v83, v90, v91
M v[120:123], a[180:183], a[148:151], v[120:123]
v_cvt_pk_bf16_f32 v40, v36, v37
v_cvt_pk_bf16_f32 v41, v38, v39
M v[124:127], a[180:183], a[156:159], v[124:127]
s_add_u32 m0, s29, 2048
s_nop 0
buffer_load_dwordx4 v2, s[8:11], s23 offen offset:0 lds
v_cvt_pk_bf16_f32 v42, v68, v69
v_cvt_pk_bf16_f32 v43, v70, v71
M v[124:127], a[176:179], a[152:155], v[124:127]
v_cvt_pk_bf16_f32 v72, v52, v53
M v[128:131], a[184:187], a[96:99], v[128:131]
v_cvt_pk_bf16_f32 v73, v54, v55
v_cvt_pk_bf16_f32 v74, v84, v85
M v[128:131], a[188:191], a[100:103], v[128:131]
ds_read_b128 a[168:171], v10 offset:51200
ds_read_b128 a[172:175], v11 offset:51200
v_cvt_pk_bf16_f32 v75, v86, v87
M v[132:135], a[188:191], a[108:111], v[132:135]
v_cvt_pk_bf16_f32 v56, v44, v45
v_cvt_pk_bf16_f32 v57, v46, v47
M v[132:135], a[184:187], a[104:107], v[132:135]
buffer_load_dwordx4 v3, s[8:11], s23 offen offset:1024 lds
v_cvt_pk_bf16_f32 v58, v76, v77
v_cvt_pk_bf16_f32 v59, v78, v79
M v[136:139], a[184:187], a[112:115], v[136:139]
v_cvt_pk_bf16_f32 v88, v60, v61
M v[136:139], a[188:191], a[116:119], v[136:139]
v_cvt_pk_bf16_f32 v89, v62, v63
v_cvt_pk_bf16_f32 v90, v92, v93
M v[140:143], a[188:191], a[124:127], v[140:143]
buffer_load_dwordx4 v4, s[8:11], s23 offen offset:2048 lds
v_cvt_pk_bf16_f32 v91, v94, v95
M v[140:143], a[184:187], a[120:123], v[140:143]
M v[144:147], a[184:187], a[128:131], v[144:147]
M v[144:147], a[188:191], a[132:135], v[144:147]
buffer_load_dwordx4 v5, s[8:11], s23 offen offset:3072 lds
M v[148:151], a[188:191], a[140:143], v[148:151]
s_add_u32 s94, s92, 0
buffer_store_dwordx4 v[32:35], v1, s[16:19], s94 offen offset:0 sc1
M v[148:151], a[184:187], a[136:139], v[148:151]
M v[152:155], a[184:187], a[144:147], v[152:155]
M v[152:155], a[188:191], a[148:151], v[152:155]
s_sub_u32 s31, s31, 1
s_cmp_eq_u32 s31, 0
s_cselect_b32 s58, -1920, s57
s_add_u32 s23, s23, s58
s_add_u32 s24, s24, s58
M v[156:159], a[188:191], a[156:159], v[156:159]
s_add_u32 s94, s92, 0
buffer_store_dwordx4 v[40:43], v1, s[16:19], s94 offen offset:1024 sc1
M v[156:159], a[184:187], a[152:155], v[156:159]
s_waitcnt lgkmcnt(2)
M v[160:163], a[160:163], a[96:99], v[160:163]
M v[160:163], a[164:167], a[100:103], v[160:163]
ds_read_b128 a[176:179], v10 offset:53248
ds_read_b128 a[180:183], v11 offset:53248
M v[164:167], a[164:167], a[108:111], v[164:167]
s_add_u32 s94, s92, 0
buffer_store_dwordx4 v[48:51], v1, s[16:19], s94 offen offset:2048 sc1
M v[164:167], a[160:163], a[104:107], v[164:167]
v_cvt_pk_bf16_f32 v96, v96, v97
v_cvt_pk_bf16_f32 v97, v98, v99
M v[168:171], a[160:163], a[112:115], v[168:171]
v_cvt_pk_bf16_f32 v98, v128, v129
v_cvt_pk_bf16_f32 v99, v130, v131
M v[168:171], a[164:167], a[116:119], v[168:171]
s_add_u32 m0, s30, 98304
s_nop 0
buffer_load_dwordx4 v6, s[12:15], s25 offen offset:0 lds
v_cvt_pk_bf16_f32 v128, v112, v113
M v[172:175], a[164:167], a[124:127], v[172:175]
s_add_u32 s94, s92, 0
buffer_store_dwordx4 v[56:59], v1, s[16:19], s94 offen offset:3072 sc1
v_cvt_pk_bf16_f32 v129, v114, v115
v_cvt_pk_bf16_f32 v130, v144, v145
M v[172:175], a[160:163], a[120:123], v[172:175]
v_cvt_pk_bf16_f32 v131, v146, v147
M v[176:179], a[160:163], a[128:131], v[176:179]
v_cvt_pk_bf16_f32 v112, v104, v105
v_cvt_pk_bf16_f32 v113, v106, v107
M v[176:179], a[164:167], a[132:135], v[176:179]
buffer_load_dwordx4 v7, s[12:15], s25 offen offset:1024 lds
v_cvt_pk_bf16_f32 v114, v136, v137
v_cvt_pk_bf16_f32 v115, v138, v139
M v[180:183], a[164:167], a[140:143], v[180:183]
s_add_u32 s94, s92, 4096
buffer_store_dwordx4 v[64:67], v1, s[16:19], s94 offen offset:0 sc1
v_cvt_pk_bf16_f32 v144, v120, v121
M v[180:183], a[160:163], a[136:139], v[180:183]
v_cvt_pk_bf16_f32 v145, v122, v123
v_cvt_pk_bf16_f32 v146, v152, v153
M v[184:187], a[160:163], a[144:147], v[184:187]
v_cvt_pk_bf16_f32 v147, v154, v155
M v[184:187], a[164:167], a[148:151], v[184:187]
buffer_load_dwordx4 v8, s[12:15], s25 offen offset:2048 lds
v_cvt_pk_bf16_f32 v104, v100, v101
v_cvt_pk_bf16_f32 v105, v102, v103
M v[188:191], a[164:167], a[156:159], v[188:191]
s_add_u32 s94, s92, 4096
buffer_store_dwordx4 v[72:75], v1, s[16:19], s94 offen offset:1024 sc1
v_cvt_pk_bf16_f32 v106, v132, v133
v_cvt_pk_bf16_f32 v107, v134, v135
M v[188:191], a[160:163], a[152:155], v[188:191]
s_waitcnt lgkmcnt(2)
v_cvt_pk_bf16_f32 v136, v116, v117
M v[192:195], a[168:171], a[96:99], v[192:195]
v_cvt_pk_bf16_f32 v137, v118, v119
v_cvt_pk_bf16_f32 v138, v148, v149
M v[192:195], a[172:175], a[100:103], v[192:195]
ds_read_b128 a[184:187], v10 offset:55296
ds_read_b128 a[188:191], v11 offset:55296
v_cvt_pk_bf16_f32 v139, v150, v151
M v[196:199], a[172:175], a[108:111], v[196:199]
s_add_u32 s94, s92, 4096
buffer_store_dwordx4 v[80:83], v1, s[16:19], s94 offen offset:2048 sc1
v_cvt_pk_bf16_f32 v120, v108, v109
v_cvt_pk_bf16_f32 v121, v110, v111
M v[196:199], a[168:171], a[104:107], v[196:199]
v_cvt_pk_bf16_f32 v122, v140, v141
v_cvt_pk_bf16_f32 v123, v142, v143
M v[200:203], a[168:171], a[112:115], v[200:203]
buffer_load_dwordx4 v9, s[12:15], s25 offen offset:3072 lds
v_cvt_pk_bf16_f32 v152, v124, v125
M v[200:203], a[172:175], a[116:119], v[200:203]
v_cvt_pk_bf16_f32 v153, v126, v127
v_cvt_pk_bf16_f32 v154, v156, v157
M v[204:207], a[172:175], a[124:127], v[204:207]
s_add_u32 s94, s92, 4096
buffer_store_dwordx4 v[88:91], v1, s[16:19], s94 offen offset:3072 sc1
v_cvt_pk_bf16_f32 v155, v158, v159
M v[204:207], a[168:171], a[120:123], v[204:207]
M v[208:211], a[168:171], a[128:131], v[208:211]
s_add_u32 m0, s30, 102400
s_nop 0
buffer_load_dwordx4 v21, s[12:15], s25 offen offset:0 lds
M v[208:211], a[172:175], a[132:135], v[208:211]
M v[212:215], a[172:175], a[140:143], v[212:215]
M v[212:215], a[168:171], a[136:139], v[212:215]
buffer_load_dwordx4 v22, s[12:15], s25 offen offset:1024 lds
M v[216:219], a[168:171], a[144:147], v[216:219]
s_add_u32 s94, s92, 8192
buffer_store_dwordx4 v[96:99], v1, s[16:19], s94 offen offset:0 sc1
M v[216:219], a[172:175], a[148:151], v[216:219]
M v[220:223], a[172:175], a[156:159], v[220:223]
M v[220:223], a[168:171], a[152:155], v[220:223]
s_waitcnt lgkmcnt(2)
M v[224:227], a[176:179], a[96:99], v[224:227]
s_sub_u32 s54, s54, 1
s_cmp_eq_u32 s54, 0
s_cselect_b32 s58, s55, s56
s_add_u32 s25, s25, s58
M v[224:227], a[180:183], a[100:103], v[224:227]
M v[228:231], a[180:183], a[108:111], v[228:231]
s_add_u32 s94, s92, 8192
buffer_store_dwordx4 v[104:107], v1, s[16:19], s94 offen offset:1024 sc1
M v[228:231], a[176:179], a[104:107], v[228:231]
v_cvt_pk_bf16_f32 v160, v160, v161
v_cvt_pk_bf16_f32 v161, v162, v163
M v[232:235], a[176:179], a[112:115], v[232:235]
v_cvt_pk_bf16_f32 v162, v192, v193
v_cvt_pk_bf16_f32 v163, v194, v195
M v[232:235], a[180:183], a[116:119], v[232:235]
v_cvt_pk_bf16_f32 v192, v176, v177
M v[236:239], a[180:183], a[124:127], v[236:239]
v_cvt_pk_bf16_f32 v193, v178, v179
v_cvt_pk_bf16_f32 v194, v208, v209
M v[236:239], a[176:179], a[120:123], v[236:239]
s_waitcnt vmcnt(63) lgkmcnt(0)
s_barrier
v_cvt_pk_bf16_f32 v195, v210, v211
M v[240:243], a[176:179], a[128:131], v[240:243]
s_add_u32 s94, s92, 8192
buffer_store_dwordx4 v[112:115], v1, s[16:19], s94 offen offset:2048 sc1
v_cvt_pk_bf16_f32 v176, v168, v169
v_cvt_pk_bf16_f32 v177, v170, v171
M v[240:243], a[180:183], a[132:135], v[240:243]
s_add_u32 m0, s28, 18432
s_nop 0
buffer_load_dword v20, s[8:11], s24 offen lds
v_cvt_pk_bf16_f32 v178, v200, v201
v_cvt_pk_bf16_f32 v179, v202, v203
M v[244:247], a[180:183], a[140:143], v[244:247]
v_cvt_pk_bf16_f32 v208, v184, v185
M v[244:247], a[176:179], a[136:139], v[244:247]
v_cvt_pk_bf16_f32 v209, v186, v187
v_cvt_pk_bf16_f32 v210, v216, v217
M v[248:251], a[176:179], a[144:147], v[248:251]
buffer_load_dword v23, s[8:11], s24 offen offset:256 lds
v_cvt_pk_bf16_f32 v211, v218, v219
M v[248:251], a[180:183], a[148:151], v[248:251]
v_cvt_pk_bf16_f32 v168, v164, v165
v_cvt_pk_bf16_f32 v169, v166, v167
M v[252:255], a[180:183], a[156:159], v[252:255]
s_add_u32 s94, s92, 8192
buffer_store_dwordx4 v[120:123], v1, s[16:19], s94 offen offset:3072 sc1
v_cvt_pk_bf16_f32 v170, v196, v197
v_cvt_pk_bf16_f32 v171, v198, v199
M v[252:255], a[176:179], a[152:155], v[252:255]
v_cvt_pk_bf16_f32 v200, v180, v181
M a[0:3], a[184:187], a[96:99], a[0:3]
v_cvt_pk_bf16_f32 v201, v182, v183
v_cvt_pk_bf16_f32 v202, v212, v213
M a[0:3], a[188:191], a[100:103], a[0:3]
s_add_u32 m0, s29, 20480
s_nop 0
buffer_load_dwordx4 v2, s[8:11], s23 offen offset:0 lds
v_cvt_pk_bf16_f32 v203, v214, v215
M a[4:7], a[188:191], a[108:111], a[4:7]
v_cvt_pk_bf16_f32 v184, v172, v173
v_cvt_pk_bf16_f32 v185, v174, v175
M a[4:7], a[184:187], a[104:107], a[4:7]
v_cvt_pk_bf16_f32 v186, v204, v205
v_cvt_pk_bf16_f32 v187, v206, v207
M a[8:11], a[184:187], a[112:115], a[8:11]
s_add_u32 s94, s92, 12288
buffer_store_dwordx4 v[128:131], v1, s[16:19], s94 offen offset:0 sc1
v_cvt_pk_bf16_f32 v216, v188, v189
M a[8:11], a[188:191], a[116:119], a[8:11]
buffer_load_dwordx4 v3, s[8:11], s23 offen offset:1024 lds
v_cvt_pk_bf16_f32 v217, v190, v191
v_cvt_pk_bf16_f32 v218, v220, v221
M a[12:15], a[188:191], a[124:127], a[12:15]
v_cvt_pk_bf16_f32 v219, v222, v223
M a[12:15], a[184:187], a[120:123], a[12:15]
M a[16:19], a[184:187], a[128:131], a[16:19]
buffer_load_dwordx4 v4, s[8:11], s23 offen offset:2048 lds
M a[16:19], a[188:191], a[132:135], a[16:19]
M a[20:23], a[188:191], a[140:143], a[20:23]
s_add_u32 s94, s92, 12288
buffer_store_dwordx4 v[136:139], v1, s[16:19], s94 offen offset:1024 sc1
M a[20:23], a[184:187], a[136:139], a[20:23]
M a[24:27], a[184:187], a[144:147], a[24:27]
buffer_load_dwordx4 v5, s[8:11], s23 offen offset:3072 lds
M a[24:27], a[188:191], a[148:151], a[24:27]
M a[28:31], a[188:191], a[156:159], a[28:31]
M a[28:31], a[184:187], a[152:155], a[28:31]
v_accvgpr_read_b32 v24, a0
v_accvgpr_read_b32 v25, a1
v_accvgpr_read_b32 v26, a2
v_accvgpr_read_b32 v27, a3
v_cvt_pk_bf16_f32 v224, v224, v225
v_cvt_pk_bf16_f32 v225, v226, v227
v_cvt_pk_bf16_f32 v226, v24, v25
v_cvt_pk_bf16_f32 v227, v26, v27
v_accvgpr_read_b32 v24, a16
v_accvgpr_read_b32 v25, a17
v_accvgpr_read_b32 v26, a18
v_accvgpr_read_b32 v27, a19
v_cvt_pk_bf16_f32 v36, v240, v241
v_cvt_pk_bf16_f32 v37, v242, v243
v_cvt_pk_bf16_f32 v38, v24, v25
v_cvt_pk_bf16_f32 v39, v26, v27
v_accvgpr_read_b32 v24, a24
v_accvgpr_read_b32 v25, a25
v_accvgpr_read_b32 v26, a26
v_accvgpr_read_b32 v27, a27
v_cvt_pk_bf16_f32 v52, v248, v249
v_cvt_pk_bf16_f32 v53, v250, v251
v_cvt_pk_bf16_f32 v54, v24, v25
v_cvt_pk_bf16_f32 v55, v26, v27
v_accvgpr_read_b32 v24, a8
v_accvgpr_read_b32 v25, a9
v_accvgpr_read_b32 v26, a10
v_accvgpr_read_b32 v27, a11
v_cvt_pk_bf16_f32 v240, v232, v233
v_cvt_pk_bf16_f32 v241, v234, v235
v_cvt_pk_bf16_f32 v242, v24, v25
v_cvt_pk_bf16_f32 v243, v26, v27
v_accvgpr_read_b32 v28, a4
v_accvgpr_read_b32 v29, a5
v_accvgpr_read_b32 v30, a6
v_accvgpr_read_b32 v31, a7
v_cvt_pk_bf16_f32 v232, v228, v229
v_cvt_pk_bf16_f32 v233, v230, v231
v_cvt_pk_bf16_f32 v234, v28, v29
v_cvt_pk_bf16_f32 v235, v30, v31
v_accvgpr_read_b32 v28, a12
v_accvgpr_read_b32 v29, a13
v_accvgpr_read_b32 v30, a14
v_accvgpr_read_b32 v31, a15
v_cvt_pk_bf16_f32 v248, v236, v237
v_cvt_pk_bf16_f32 v249, v238, v239
v_cvt_pk_bf16_f32 v250, v28, v29
v_cvt_pk_bf16_f32 v251, v30, v31
v_accvgpr_read_b32 v28, a20
v_accvgpr_read_b32 v29, a21
v_accvgpr_read_b32 v30, a22
v_accvgpr_read_b32 v31, a23
v_cvt_pk_bf16_f32 v44, v244, v245
v_cvt_pk_bf16_f32 v45, v246, v247
v_cvt_pk_bf16_f32 v46, v28, v29
v_cvt_pk_bf16_f32 v47, v30, v31
v_accvgpr_read_b32 v28, a28
v_accvgpr_read_b32 v29, a29
v_accvgpr_read_b32 v30, a30
v_accvgpr_read_b32 v31, a31
v_cvt_pk_bf16_f32 v60, v252, v253
v_cvt_pk_bf16_f32 v61, v254, v255
v_cvt_pk_bf16_f32 v62, v28, v29
v_cvt_pk_bf16_f32 v63, v30, v31
Lk1_b:
v_and_b32 v24, 15, v0
v_lshlrev_b32 v24, 7, v24
v_bfe_u32 v25, v0, 1, 3
v_lshrrev_b32 v26, 4, v0
v_xor_b32 v25, v25, v26
v_lshl_add_u32 v10, v25, 4, v24
v_xor_b32 v11, 64, v10
v_add_u32 v12, 131072, v10
v_add_u32 v13, 131072, v11
v_bfe_u32 v24, v0, 2, 2
v_lshl_add_u32 v29, v26, 3, v24
v_mul_u32_u24 v25, 384, v29
v_and_b32 v27, 1, v0
v_lshl_add_u32 v25, v27, 3, v25
v_add_u32 v25, 36864, v25
v_lshrrev_b32 v24, 1, v29
v_and_b32 v24, 4, v24
v_and_or_b32 v24, v29, 2, v24
v_bfe_u32 v26, v0, 1, 1
s_mul_i32 s4, s20, 3
s_add_u32 s3, s4, 0
s_and_b32 s5, s3, 3
s_lshl_b32 s5, s5, 1
s_lshr_b32 s3, s3, 2
s_lshl_b32 s3, s3, 7
v_add_u32 v27, s5, v26
v_xor_b32 v27, v27, v24
v_lshl_add_u32 v27, v27, 4, v25
v_add_u32 v14, s3, v27
v_add_u32 v17, 61440, v14
s_add_u32 s3, s4, 1
s_and_b32 s5, s3, 3
s_lshl_b32 s5, s5, 1
s_lshr_b32 s3, s3, 2
s_lshl_b32 s3, s3, 7
v_add_u32 v27, s5, v26
v_xor_b32 v27, v27, v24
v_lshl_add_u32 v27, v27, 4, v25
v_add_u32 v15, s3, v27
v_add_u32 v18, 61440, v15
s_add_u32 s3, s4, 2
s_and_b32 s5, s3, 3
s_lshl_b32 s5, s5, 1
s_lshr_b32 s3, s3, 2
s_lshl_b32 s3, s3, 7
v_add_u32 v27, s5, v26
v_xor_b32 v27, v27, v24
v_lshl_add_u32 v27, v27, 4, v25
v_add_u32 v16, s3, v27
v_add_u32 v19, 61440, v16
s_waitcnt vmcnt(11)
s_barrier
ds_read_b64_tr_b16 a[176:177], v14 offset:28672
ds_read_b64_tr_b16 a[178:179], v14 offset:30208
ds_read_b64_tr_b16 a[184:185], v15 offset:28672
ds_read_b64_tr_b16 a[186:187], v15 offset:30208
ds_read_b64_tr_b16 a[192:193], v16 offset:28672
ds_read_b64_tr_b16 a[194:195], v16 offset:30208
ds_read_b64_tr_b16 a[180:181], v14 offset:40960
ds_read_b64_tr_b16 a[182:183], v14 offset:42496
ds_read_b64_tr_b16 a[188:189], v15 offset:40960
ds_read_b64_tr_b16 a[190:191], v15 offset:42496
ds_read_b64_tr_b16 a[196:197], v16 offset:40960
ds_read_b64_tr_b16 a[198:199], v16 offset:42496
ds_read_b128 a[224:227], v12 offset:0
ds_read_b128 a[228:231], v13 offset:0
ds_read_b128 a[232:235], v12 offset:2048
ds_read_b128 a[236:239], v13 offset:2048
ds_read_b128 a[240:243], v12 offset:4096
ds_read_b128 a[244:247], v13 offset:4096
s_waitcnt lgkmcnt(0)
s_barrier
M a[68:71], a[176:179], a[224:227], 0
ds_read_b128 a[248:251], v12 offset:6144
ds_read_b128 a[252:255], v13 offset:6144
M a[68:71], a[180:183], a[228:231], a[68:71]
s_sub_u32 s31, s31, 1
s_cmp_eq_u32 s31, 0
s_cselect_b32 s58, -1920, s57
s_add_u32 s23, s23, s58
s_add_u32 s24, s24, s58
M a[72:75], a[188:191], a[228:231], 0
ds_read_b64_tr_b16 a[200:201], v17 offset:0
ds_read_b64_tr_b16 a[202:203], v17 offset:1536
M a[72:75], a[184:187], a[224:227], a[72:75]
s_add_u32 m0, s30, 36864
s_nop 0
buffer_load_dwordx4 v6, s[12:15], s25 offen offset:0 lds
M a[76:79], a[192:195], a[224:227], 0
M a[76:79], a[196:199], a[228:231], a[76:79]
buffer_load_dwordx4 v7, s[12:15], s25 offen offset:1024 lds
M a[80:83], a[180:183], a[236:239], 0
ds_read_b128 a[224:227], v12 offset:8192
ds_read_b128 a[228:231], v13 offset:8192
M a[80:83], a[176:179], a[232:235], a[80:83]
M a[84:87], a[184:187], a[232:235], 0
ds_read_b64_tr_b16 a[208:209], v18 offset:0
ds_read_b64_tr_b16 a[210:211], v18 offset:1536
M a[84:87], a[188:191], a[236:239], a[84:87]
buffer_load_dwordx4 v8, s[12:15], s25 offen offset:2048 lds
M a[88:91], a[196:199], a[236:239], 0
M a[88:91], a[192:195], a[232:235], a[88:91]
buffer_load_dwordx4 v9, s[12:15], s25 offen offset:3072 lds
M a[92:95], a[176:179], a[240:243], 0
ds_read_b128 a[232:235], v12 offset:10240
ds_read_b128 a[236:239], v13 offset:10240
M a[92:95], a[180:183], a[244:247], a[92:95]
M a[96:99], a[188:191], a[244:247], 0
ds_read_b64_tr_b16 a[216:217], v19 offset:0
ds_read_b64_tr_b16 a[218:219], v19 offset:1536
M a[96:99], a[184:187], a[240:243], a[96:99]
s_add_u32 m0, s30, 40960
s_nop 0
buffer_load_dwordx4 v21, s[12:15], s25 offen offset:0 lds
M a[100:103], a[192:195], a[240:243], 0
buffer_load_dwordx4 v22, s[12:15], s25 offen offset:1024 lds
M a[100:103], a[196:199], a[244:247], a[100:103]
s_waitcnt lgkmcnt(10)
M a[104:107], a[180:183], a[252:255], 0
ds_read_b128 a[240:243], v12 offset:12288
ds_read_b128 a[244:247], v13 offset:12288
M a[104:107], a[176:179], a[248:251], a[104:107]
s_sub_u32 s54, s54, 1
s_cmp_eq_u32 s54, 0
s_cselect_b32 s58, s55, s56
s_add_u32 s25, s25, s58
M a[108:111], a[184:187], a[248:251], 0
ds_read_b64_tr_b16 a[204:205], v17 offset:12288
ds_read_b64_tr_b16 a[206:207], v17 offset:13824
M a[108:111], a[188:191], a[252:255], a[108:111]
M a[112:115], a[196:199], a[252:255], 0
s_add_u32 m0, s30, 65536
s_nop 0
buffer_load_dwordx4 v6, s[12:15], s25 offen offset:0 lds
M a[112:115], a[192:195], a[248:251], a[112:115]
s_waitcnt lgkmcnt(10)
M a[116:119], a[176:179], a[224:227], 0
ds_read_b128 a[248:251], v12 offset:14336
ds_read_b128 a[252:255], v13 offset:14336
M a[116:119], a[180:183], a[228:231], a[116:119]
buffer_load_dwordx4 v7, s[12:15], s25 offen offset:1024 lds
M a[120:123], a[188:191], a[228:231], 0
ds_read_b64_tr_b16 a[212:213], v18 offset:12288
ds_read_b64_tr_b16 a[214:215], v18 offset:13824
M a[120:123], a[184:187], a[224:227], a[120:123]
M a[124:127], a[192:195], a[224:227], 0
buffer_load_dwordx4 v8, s[12:15], s25 offen offset:2048 lds
M a[124:127], a[196:199], a[228:231], a[124:127]
buffer_load_dwordx4 v9, s[12:15], s25 offen offset:3072 lds
s_waitcnt lgkmcnt(10)
M a[128:131], a[180:183], a[236:239], 0
ds_read_b128 a[224:227], v12 offset:16384
ds_read_b128 a[228:231], v13 offset:16384
M a[128:131], a[176:179], a[232:235], a[128:131]
M a[132:135], a[184:187], a[232:235], 0
ds_read_b64_tr_b16 a[220:221], v19 offset:12288
ds_read_b64_tr_b16 a[222:223], v19 offset:13824
M a[132:135], a[188:191], a[236:239], a[132:135]
s_add_u32 m0, s30, 69632
s_nop 0
buffer_load_dwordx4 v21, s[12:15], s25 offen offset:0 lds
M a[136:139], a[196:199], a[236:239], 0
M a[136:139], a[192:195], a[232:235], a[136:139]
buffer_load_dwordx4 v22, s[12:15], s25 offen offset:1024 lds
s_waitcnt lgkmcnt(10)
M a[140:143], a[176:179], a[240:243], 0
M a[140:143], a[180:183], a[244:247], a[140:143]
s_sub_u32 s54, s54, 1
s_cmp_eq_u32 s54, 0
s_cselect_b32 s58, s55, s56
s_add_u32 s25, s25, s58
M a[144:147], a[188:191], a[244:247], 0
M a[144:147], a[184:187], a[240:243], a[144:147]
M a[148:151], a[192:195], a[240:243], 0
s_waitcnt vmcnt(6) lgkmcnt(0)
s_barrier
ds_read_b128 a[232:235], v10 offset:0
ds_read_b128 a[236:239], v11 offset:0
M a[148:151], a[196:199], a[244:247], a[148:151]
s_add_u32 m0, s28, 131072
s_nop 0
buffer_load_dword v20, s[8:11], s24 offen lds
M a[152:155], a[180:183], a[252:255], 0
ds_read_b128 a[240:243], v10 offset:2048
ds_read_b128 a[244:247], v11 offset:2048
M a[152:155], a[176:179], a[248:251], a[152:155]
M a[156:159], a[184:187], a[248:251], 0
buffer_load_dword v23, s[8:11], s24 offen offset:256 lds
M a[156:159], a[188:191], a[252:255], a[156:159]
M a[160:163], a[196:199], a[252:255], 0
M a[160:163], a[192:195], a[248:251], a[160:163]
s_add_u32 m0, s29, 133120
s_nop 0
buffer_load_dwordx4 v2, s[8:11], s23 offen offset:0 lds
M a[164:167], a[176:179], a[224:227], 0
ds_read_b128 a[248:251], v10 offset:4096
ds_read_b128 a[252:255], v11 offset:4096
M a[164:167], a[180:183], a[228:231], a[164:167]
M a[168:171], a[188:191], a[228:231], 0
M a[168:171], a[184:187], a[224:227], a[168:171]
buffer_load_dwordx4 v3, s[8:11], s23 offen offset:1024 lds
M a[172:175], a[192:195], a[224:227], 0
M a[172:175], a[196:199], a[228:231], a[172:175]
s_waitcnt lgkmcnt(4)
M a[68:71], a[200:203], a[232:235], a[68:71]
ds_read_b128 a[224:227], v10 offset:6144
ds_read_b128 a[228:231], v11 offset:6144
M a[68:71], a[204:207], a[236:239], a[68:71]
buffer_load_dwordx4 v4, s[8:11], s23 offen offset:2048 lds
M a[72:75], a[212:215], a[236:239], a[72:75]
ds_read_b64_tr_b16 a[176:177], v14 offset:0
ds_read_b64_tr_b16 a[178:179], v14 offset:1536
M a[72:75], a[208:211], a[232:235], a[72:75]
buffer_load_dwordx4 v5, s[8:11], s23 offen offset:3072 lds
M a[76:79], a[216:219], a[232:235], a[76:79]
M a[76:79], a[220:223], a[236:239], a[76:79]
s_sub_u32 s31, s31, 1
s_cmp_eq_u32 s31, 0
s_cselect_b32 s58, -1920, s57
s_add_u32 s23, s23, s58
s_add_u32 s24, s24, s58
s_waitcnt lgkmcnt(6)
M a[80:83], a[204:207], a[244:247], a[80:83]
ds_read_b128 a[232:235], v10 offset:8192
ds_read_b128 a[236:239], v11 offset:8192
M a[80:83], a[200:203], a[240:243], a[80:83]
M a[84:87], a[208:211], a[240:243], a[84:87]
ds_read_b64_tr_b16 a[184:185], v15 offset:0
ds_read_b64_tr_b16 a[186:187], v15 offset:1536
M a[84:87], a[212:215], a[244:247], a[84:87]
s_add_u32 m0, s30, 98304
s_nop 0
buffer_load_dwordx4 v6, s[12:15], s25 offen offset:0 lds
M a[88:91], a[220:223], a[244:247], a[88:91]
M a[88:91], a[216:219], a[240:243], a[88:91]
buffer_load_dwordx4 v7, s[12:15], s25 offen offset:1024 lds
s_waitcnt lgkmcnt(8)
M a[92:95], a[200:203], a[248:251], a[92:95]
ds_read_b128 a[240:243], v10 offset:10240
ds_read_b128 a[244:247], v11 offset:10240
M a[92:95], a[204:207], a[252:255], a[92:95]
M a[96:99], a[212:215], a[252:255], a[96:99]
ds_read_b64_tr_b16 a[192:193], v16 offset:0
ds_read_b64_tr_b16 a[194:195], v16 offset:1536
M a[96:99], a[208:211], a[248:251], a[96:99]
buffer_load_dwordx4 v8, s[12:15], s25 offen offset:2048 lds
M a[100:103], a[216:219], a[248:251], a[100:103]
M a[100:103], a[220:223], a[252:255], a[100:103]
buffer_load_dwordx4 v9, s[12:15], s25 offen offset:3072 lds
s_waitcnt lgkmcnt(10)
M a[104:107], a[204:207], a[228:231], a[104:107]
ds_read_b128 a[248:251], v10 offset:12288
ds_read_b128 a[252:255], v11 offset:12288
M a[104:107], a[200:203], a[224:227], a[104:107]
M a[108:111], a[208:211], a[224:227], a[108:111]
ds_read_b64_tr_b16 a[180:181], v14 offset:12288
ds_read_b64_tr_b16 a[182:183], v14 offset:13824
M a[108:111], a[212:215], a[228:231], a[108:111]
s_add_u32 m0, s30, 102400
s_nop 0
buffer_load_dwordx4 v21, s[12:15], s25 offen offset:0 lds
M a[112:115], a[220:223], a[228:231], a[112:115]
M a[112:115], a[216:219], a[224:227], a[112:115]
buffer_load_dwordx4 v22, s[12:15], s25 offen offset:1024 lds
s_waitcnt lgkmcnt(10)
M a[116:119], a[200:203], a[232:235], a[116:119]
ds_read_b128 a[224:227], v10 offset:14336
ds_read_b128 a[228:231], v11 offset:14336
M a[116:119], a[204:207], a[236:239], a[116:119]
M a[120:123], a[212:215], a[236:239], a[120:123]
ds_read_b64_tr_b16 a[188:189], v15 offset:12288
ds_read_b64_tr_b16 a[190:191], v15 offset:13824
M a[120:123], a[208:211], a[232:235], a[120:123]
s_sub_u32 s54, s54, 1
s_cmp_eq_u32 s54, 0
s_cselect_b32 s58, s55, s56
s_add_u32 s25, s25, s58
M a[124:127], a[216:219], a[232:235], a[124:127]
M a[124:127], a[220:223], a[236:239], a[124:127]
s_add_u32 s94, s92, 12288
buffer_store_dwordx4 v[144:147], v1, s[16:19], s94 offen offset:2048 sc1
s_waitcnt lgkmcnt(10)
M a[128:131], a[204:207], a[244:247], a[128:131]
ds_read_b128 a[232:235], v10 offset:16384
ds_read_b128 a[236:239], v11 offset:16384
M a[128:131], a[200:203], a[240:243], a[128:131]
M a[132:135], a[208:211], a[240:243], a[132:135]
ds_read_b64_tr_b16 a[196:197], v16 offset:12288
ds_read_b64_tr_b16 a[198:199], v16 offset:13824
M a[132:135], a[212:215], a[244:247], a[132:135]
s_add_u32 s94, s92, 12288
buffer_store_dwordx4 v[152:155], v1, s[16:19], s94 offen offset:3072 sc1
M a[136:139], a[220:223], a[244:247], a[136:139]
M a[136:139], a[216:219], a[240:243], a[136:139]
s_add_u32 s94, s93, 0
buffer_store_dwordx4 v[160:163], v1, s[16:19], s94 offen offset:0 sc1
s_waitcnt lgkmcnt(10)
M a[140:143], a[200:203], a[248:251], a[140:143]
M a[140:143], a[204:207], a[252:255], a[140:143]
s_add_u32 s94, s93, 0
buffer_store_dwordx4 v[168:171], v1, s[16:19], s94 offen offset:1024 sc1
M a[144:147], a[212:215], a[252:255], a[144:147]
M a[144:147], a[208:211], a[248:251], a[144:147]
M a[148:151], a[216:219], a[248:251], a[148:151]
s_waitcnt vmcnt(16) lgkmcnt(0)
s_barrier
ds_read_b128 a[240:243], v10 offset:18432
ds_read_b128 a[244:247], v11 offset:18432
M a[148:151], a[220:223], a[252:255], a[148:151]
s_add_u32 m0, s28, 0
s_nop 0
buffer_load_dword v20, s[8:11], s24 offen lds
M a[152:155], a[204:207], a[228:231], a[152:155]
ds_read_b128 a[248:251], v10 offset:20480
ds_read_b128 a[252:255], v11 offset:20480
M a[152:155], a[200:203], a[224:227], a[152:155]
M a[156:159], a[208:211], a[224:227], a[156:159]
buffer_load_dword v23, s[8:11], s24 offen offset:256 lds
M a[156:159], a[212:215], a[228:231], a[156:159]
M a[160:163], a[220:223], a[228:231], a[160:163]
M a[160:163], a[216:219], a[224:227], a[160:163]
s_add_u32 m0, s29, 2048
s_nop 0
buffer_load_dwordx4 v2, s[8:11], s23 offen offset:0 lds
M a[164:167], a[200:203], a[232:235], a[164:167]
ds_read_b128 a[224:227], v10 offset:22528
ds_read_b128 a[228:231], v11 offset:22528
M a[164:167], a[204:207], a[236:239], a[164:167]
M a[168:171], a[212:215], a[236:239], a[168:171]
M a[168:171], a[208:211], a[232:235], a[168:171]
buffer_load_dwordx4 v3, s[8:11], s23 offen offset:1024 lds
M a[172:175], a[216:219], a[232:235], a[172:175]
M a[172:175], a[220:223], a[236:239], a[172:175]
s_waitcnt lgkmcnt(4)
M a[68:71], a[176:179], a[240:243], a[68:71]
ds_read_b128 a[232:235], v10 offset:24576
ds_read_b128 a[236:239], v11 offset:24576
M a[68:71], a[180:183], a[244:247], a[68:71]
buffer_load_dwordx4 v4, s[8:11], s23 offen offset:2048 lds
M a[72:75], a[188:191], a[244:247], a[72:75]
ds_read_b64_tr_b16 a[200:201], v14 offset:28672
ds_read_b64_tr_b16 a[202:203], v14 offset:30208
M a[72:75], a[184:187], a[240:243], a[72:75]
buffer_load_dwordx4 v5, s[8:11], s23 offen offset:3072 lds
M a[76:79], a[192:195], a[240:243], a[76:79]
M a[76:79], a[196:199], a[244:247], a[76:79]
s_sub_u32 s31, s31, 1
s_cmp_eq_u32 s31, 0
s_cselect_b32 s58, -1920, s57
s_add_u32 s23, s23, s58
s_add_u32 s24, s24, s58
s_waitcnt lgkmcnt(6)
M a[80:83], a[180:183], a[252:255], a[80:83]
ds_read_b128 a[240:243], v10 offset:26624
ds_read_b128 a[244:247], v11 offset:26624
M a[80:83], a[176:179], a[248:251], a[80:83]
M a[84:87], a[184:187], a[248:251], a[84:87]
ds_read_b64_tr_b16 a[208:209], v15 offset:28672
ds_read_b64_tr_b16 a[210:211], v15 offset:30208
M a[84:87], a[188:191], a[252:255], a[84:87]
s_add_u32 m0, s30, 36864
s_nop 0
buffer_load_dwordx4 v6, s[12:15], s25 offen offset:0 lds
M a[88:91], a[196:199], a[252:255], a[88:91]
M a[88:91], a[192:195], a[248:251], a[88:91]
buffer_load_dwordx4 v7, s[12:15], s25 offen offset:1024 lds
s_waitcnt lgkmcnt(8)
M a[92:95], a[176:179], a[224:227], a[92:95]
ds_read_b128 a[248:251], v10 offset:28672
ds_read_b128 a[252:255], v11 offset:28672
M a[92:95], a[180:183], a[228:231], a[92:95]
M a[96:99], a[188:191], a[228:231], a[96:99]
ds_read_b64_tr_b16 a[216:217], v16 offset:28672
ds_read_b64_tr_b16 a[218:219], v16 offset:30208
M a[96:99], a[184:187], a[224:227], a[96:99]
buffer_load_dwordx4 v8, s[12:15], s25 offen offset:2048 lds
M a[100:103], a[192:195], a[224:227], a[100:103]
M a[100:103], a[196:199], a[228:231], a[100:103]
buffer_load_dwordx4 v9, s[12:15], s25 offen offset:3072 lds
s_waitcnt lgkmcnt(10)
M a[104:107], a[180:183], a[236:239], a[104:107]
ds_read_b128 a[224:227], v10 offset:30720
ds_read_b128 a[228:231], v11 offset:30720
M a[104:107], a[176:179], a[232:235], a[104:107]
M a[108:111], a[184:187], a[232:235], a[108:111]
ds_read_b64_tr_b16 a[204:205], v14 offset:40960
ds_read_b64_tr_b16 a[206:207], v14 offset:42496
M a[108:111], a[188:191], a[236:239], a[108:111]
s_add_u32 m0, s30, 40960
s_nop 0
buffer_load_dwordx4 v21, s[12:15], s25 offen offset:0 lds
M a[112:115], a[196:199], a[236:239], a[112:115]
M a[112:115], a[192:195], a[232:235], a[112:115]
buffer_load_dwordx4 v22, s[12:15], s25 offen offset:1024 lds
s_waitcnt lgkmcnt(10)
M a[116:119], a[176:179], a[240:243], a[116:119]
ds_read_b128 a[232:235], v10 offset:32768
ds_read_b128 a[236:239], v11 offset:32768
M a[116:119], a[180:183], a[244:247], a[116:119]
M a[120:123], a[188:191], a[244:247], a[120:123]
ds_read_b64_tr_b16 a[212:213], v15 offset:40960
ds_read_b64_tr_b16 a[214:215], v15 offset:42496
M a[120:123], a[184:187], a[240:243], a[120:123]
s_sub_u32 s54, s54, 1
s_cmp_eq_u32 s54, 0
s_cselect_b32 s58, s55, s56
s_add_u32 s25, s25, s58
M a[124:127], a[192:195], a[240:243], a[124:127]
M a[124:127], a[196:199], a[244:247], a[124:127]
s_add_u32 s94, s93, 0
buffer_store_dwordx4 v[176:179], v1, s[16:19], s94 offen offset:2048 sc1
s_waitcnt lgkmcnt(10)
M a[128:131], a[180:183], a[252:255], a[128:131]
ds_read_b128 a[240:243], v10 offset:34816
ds_read_b128 a[244:247], v11 offset:34816
M a[128:131], a[176:179], a[248:251], a[128:131]
M a[132:135], a[184:187], a[248:251], a[132:135]
ds_read_b64_tr_b16 a[220:221], v16 offset:40960
ds_read_b64_tr_b16 a[222:223], v16 offset:42496
M a[132:135], a[188:191], a[252:255], a[132:135]
s_add_u32 s94, s93, 0
buffer_store_dwordx4 v[184:187], v1, s[16:19], s94 offen offset:3072 sc1
M a[136:139], a[196:199], a[252:255], a[136:139]
M a[136:139], a[192:195], a[248:251], a[136:139]
s_add_u32 s94, s93, 4096
buffer_store_dwordx4 v[192:195], v1, s[16:19], s94 offen offset:0 sc1
s_waitcnt lgkmcnt(10)
M a[140:143], a[176:179], a[224:227], a[140:143]
M a[140:143], a[180:183], a[228:231], a[140:143]
s_add_u32 s94, s93, 4096
buffer_store_dwordx4 v[200:203], v1, s[16:19], s94 offen offset:1024 sc1
M a[144:147], a[188:191], a[228:231], a[144:147]
M a[144:147], a[184:187], a[224:227], a[144:147]
M a[148:151], a[192:195], a[224:227], a[148:151]
s_waitcnt vmcnt(20) lgkmcnt(0)
s_barrier
ds_read_b128 a[248:251], v12 offset:0
ds_read_b128 a[252:255], v13 offset:0
M a[148:151], a[196:199], a[228:231], a[148:151]
s_add_u32 m0, s28, 18432
s_nop 0
buffer_load_dword v20, s[8:11], s24 offen lds
M a[152:155], a[180:183], a[236:239], a[152:155]
ds_read_b128 a[224:227], v12 offset:2048
ds_read_b128 a[228:231], v13 offset:2048
M a[152:155], a[176:179], a[232:235], a[152:155]
M a[156:159], a[184:187], a[232:235], a[156:159]
buffer_load_dword v23, s[8:11], s24 offen offset:256 lds
M a[156:159], a[188:191], a[236:239], a[156:159]
M a[160:163], a[196:199], a[236:239], a[160:163]
M a[160:163], a[192:195], a[232:235], a[160:163]
s_add_u32 m0, s29, 20480
s_nop 0
buffer_load_dwordx4 v2, s[8:11], s23 offen offset:0 lds
M a[164:167], a[176:179], a[240:243], a[164:167]
ds_read_b128 a[232:235], v12 offset:4096
ds_read_b128 a[236:239], v13 offset:4096
M a[164:167], a[180:183], a[244:247], a[164:167]
M a[168:171], a[188:191], a[244:247], a[168:171]
M a[168:171], a[184:187], a[240:243], a[168:171]
buffer_load_dwordx4 v3, s[8:11], s23 offen offset:1024 lds
M a[172:175], a[192:195], a[240:243], a[172:175]
M a[172:175], a[196:199], a[244:247], a[172:175]
s_waitcnt lgkmcnt(4)
M a[68:71], a[200:203], a[248:251], a[68:71]
ds_read_b128 a[240:243], v12 offset:6144
ds_read_b128 a[244:247], v13 offset:6144
M a[68:71], a[204:207], a[252:255], a[68:71]
buffer_load_dwordx4 v4, s[8:11], s23 offen offset:2048 lds
M a[72:75], a[212:215], a[252:255], a[72:75]
ds_read_b64_tr_b16 a[176:177], v17 offset:0
ds_read_b64_tr_b16 a[178:179], v17 offset:1536
M a[72:75], a[208:211], a[248:251], a[72:75]
buffer_load_dwordx4 v5, s[8:11], s23 offen offset:3072 lds
M a[76:79], a[216:219], a[248:251], a[76:79]
M a[76:79], a[220:223], a[252:255], a[76:79]
s_sub_u32 s31, s31, 1
s_cmp_eq_u32 s31, 0
s_cselect_b32 s58, -1920, s57
s_add_u32 s23, s23, s58
s_add_u32 s24, s24, s58
s_waitcnt lgkmcnt(6)
M a[80:83], a[204:207], a[228:231], a[80:83]
ds_read_b128 a[248:251], v12 offset:8192
ds_read_b128 a[252:255], v13 offset:8192
M a[80:83], a[200:203], a[224:227], a[80:83]
M a[84:87], a[208:211], a[224:227], a[84:87]
ds_read_b64_tr_b16 a[184:185], v18 offset:0
ds_read_b64_tr_b16 a[186:187], v18 offset:1536
M a[84:87], a[212:215], a[228:231], a[84:87]
s_add_u32 m0, s30, 65536
s_nop 0
buffer_load_dwordx4 v6, s[12:15], s25 offen offset:0 lds
M a[88:91], a[220:223], a[228:231], a[88:91]
M a[88:91], a[216:219], a[224:227], a[88:91]
buffer_load_dwordx4 v7, s[12:15], s25 offen offset:1024 lds
s_waitcnt lgkmcnt(8)
M a[92:95], a[200:203], a[232:235], a[92:95]
ds_read_b128 a[224:227], v12 offset:10240
ds_read_b128 a[228:231], v13 offset:10240
M a[92:95], a[204:207], a[236:239], a[92:95]
M a[96:99], a[212:215], a[236:239], a[96:99]
ds_read_b64_tr_b16 a[192:193], v19 offset:0
ds_read_b64_tr_b16 a[194:195], v19 offset:1536
M a[96:99], a[208:211], a[232:235], a[96:99]
buffer_load_dwordx4 v8, s[12:15], s25 offen offset:2048 lds
M a[100:103], a[216:219], a[232:235], a[100:103]
M a[100:103], a[220:223], a[236:239], a[100:103]
buffer_load_dwordx4 v9, s[12:15], s25 offen offset:3072 lds
s_waitcnt lgkmcnt(10)
M a[104:107], a[204:207], a[244:247], a[104:107]
ds_read_b128 a[232:235], v12 offset:12288
ds_read_b128 a[236:239], v13 offset:12288
M a[104:107], a[200:203], a[240:243], a[104:107]
M a[108:111], a[208:211], a[240:243], a[108:111]
ds_read_b64_tr_b16 a[180:181], v17 offset:12288
ds_read_b64_tr_b16 a[182:183], v17 offset:13824
M a[108:111], a[212:215], a[244:247], a[108:111]
s_add_u32 m0, s30, 69632
s_nop 0
buffer_load_dwordx4 v21, s[12:15], s25 offen offset:0 lds
M a[112:115], a[220:223], a[244:247], a[112:115]
M a[112:115], a[216:219], a[240:243], a[112:115]
buffer_load_dwordx4 v22, s[12:15], s25 offen offset:1024 lds
s_waitcnt lgkmcnt(10)
M a[116:119], a[200:203], a[248:251], a[116:119]
ds_read_b128 a[240:243], v12 offset:14336
ds_read_b128 a[244:247], v13 offset:14336
M a[116:119], a[204:207], a[252:255], a[116:119]
M a[120:123], a[212:215], a[252:255], a[120:123]
ds_read_b64_tr_b16 a[188:189], v18 offset:12288
ds_read_b64_tr_b16 a[190:191], v18 offset:13824
M a[120:123], a[208:211], a[248:251], a[120:123]
s_sub_u32 s54, s54, 1
s_cmp_eq_u32 s54, 0
s_cselect_b32 s58, s55, s56
s_add_u32 s25, s25, s58
M a[124:127], a[216:219], a[248:251], a[124:127]
M a[124:127], a[220:223], a[252:255], a[124:127]
s_add_u32 s94, s93, 4096
buffer_store_dwordx4 v[208:211], v1, s[16:19], s94 offen offset:2048 sc1
s_waitcnt lgkmcnt(10)
M a[128:131], a[204:207], a[228:231], a[128:131]
ds_read_b128 a[248:251], v12 offset:16384
ds_read_b128 a[252:255], v13 offset:16384
M a[128:131], a[200:203], a[224:227], a[128:131]
M a[132:135], a[208:211], a[224:227], a[132:135]
ds_read_b64_tr_b16 a[196:197], v19 offset:12288
ds_read_b64_tr_b16 a[198:199], v19 offset:13824
M a[132:135], a[212:215], a[228:231], a[132:135]
s_add_u32 s94, s93, 4096
buffer_store_dwordx4 v[216:219], v1, s[16:19], s94 offen offset:3072 sc1
M a[136:139], a[220:223], a[228:231], a[136:139]
M a[136:139], a[216:219], a[224:227], a[136:139]
s_add_u32 s94, s93, 8192
buffer_store_dwordx4 v[224:227], v1, s[16:19], s94 offen offset:0 sc1
s_waitcnt lgkmcnt(10)
M a[140:143], a[200:203], a[232:235], a[140:143]
M a[140:143], a[204:207], a[236:239], a[140:143]
s_add_u32 s94, s93, 8192
buffer_store_dwordx4 v[232:235], v1, s[16:19], s94 offen offset:1024 sc1
M a[144:147], a[212:215], a[236:239], a[144:147]
M a[144:147], a[208:211], a[232:235], a[144:147]
M a[148:151], a[216:219], a[232:235], a[148:151]
s_waitcnt vmcnt(20) lgkmcnt(0)
s_barrier
ds_read_b128 a[224:227], v10 offset:0
ds_read_b128 a[228:231], v11 offset:0
M a[148:151], a[220:223], a[236:239], a[148:151]
s_add_u32 m0, s28, 131072
s_nop 0
buffer_load_dword v20, s[8:11], s24 offen lds
M a[152:155], a[204:207], a[244:247], a[152:155]
ds_read_b128 a[232:235], v10 offset:2048
ds_read_b128 a[236:239], v11 offset:2048
M a[152:155], a[200:203], a[240:243], a[152:155]
M a[156:159], a[208:211], a[240:243], a[156:159]
buffer_load_dword v23, s[8:11], s24 offen offset:256 lds
M a[156:159], a[212:215], a[244:247], a[156:159]
M a[160:163], a[220:223], a[244:247], a[160:163]
M a[160:163], a[216:219], a[240:243], a[160:163]
s_add_u32 m0, s29, 133120
s_nop 0
buffer_load_dwordx4 v2, s[8:11], s23 offen offset:0 lds
M a[164:167], a[200:203], a[248:251], a[164:167]
ds_read_b128 a[240:243], v10 offset:4096
ds_read_b128 a[244:247], v11 offset:4096
M a[164:167], a[204:207], a[252:255], a[164:167]
M a[168:171], a[212:215], a[252:255], a[168:171]
M a[168:171], a[208:211], a[248:251], a[168:171]
buffer_load_dwordx4 v3, s[8:11], s23 offen offset:1024 lds
M a[172:175], a[216:219], a[248:251], a[172:175]
M a[172:175], a[220:223], a[252:255], a[172:175]
s_waitcnt lgkmcnt(4)
M a[68:71], a[176:179], a[224:227], a[68:71]
ds_read_b128 a[248:251], v10 offset:6144
ds_read_b128 a[252:255], v11 offset:6144
M a[68:71], a[180:183], a[228:231], a[68:71]
buffer_load_dwordx4 v4, s[8:11], s23 offen offset:2048 lds
M a[72:75], a[188:191], a[228:231], a[72:75]
ds_read_b64_tr_b16 a[200:201], v14 offset:0
ds_read_b64_tr_b16 a[202:203], v14 offset:1536
M a[72:75], a[184:187], a[224:227], a[72:75]
buffer_load_dwordx4 v5, s[8:11], s23 offen offset:3072 lds
M a[76:79], a[192:195], a[224:227], a[76:79]
M a[76:79], a[196:199], a[228:231], a[76:79]
s_sub_u32 s31, s31, 1
s_cmp_eq_u32 s31, 0
s_cselect_b32 s58, -1920, s57
s_add_u32 s23, s23, s58
s_add_u32 s24, s24, s58
s_waitcnt lgkmcnt(6)
M a[80:83], a[180:183], a[236:239], a[80:83]
ds_read_b128 a[224:227], v10 offset:8192
ds_read_b128 a[228:231], v11 offset:8192
M a[80:83], a[176:179], a[232:235], a[80:83]
M a[84:87], a[184:187], a[232:235], a[84:87]
ds_read_b64_tr_b16 a[208:209], v15 offset:0
ds_read_b64_tr_b16 a[210:211], v15 offset:1536
M a[84:87], a[188:191], a[236:239], a[84:87]
s_add_u32 m0, s30, 98304
s_nop 0
buffer_load_dwordx4 v6, s[12:15], s25 offen offset:0 lds
M a[88:91], a[196:199], a[236:239], a[88:91]
M a[88:91], a[192:195], a[232:235], a[88:91]
buffer_load_dwordx4 v7, s[12:15], s25 offen offset:1024 lds
s_waitcnt lgkmcnt(8)
M a[92:95], a[176:179], a[240:243], a[92:95]
ds_read_b128 a[232:235], v10 offset:10240
ds_read_b128 a[236:239], v11 offset:10240
M a[92:95], a[180:183], a[244:247], a[92:95]
M a[96:99], a[188:191], a[244:247], a[96:99]
ds_read_b64_tr_b16 a[216:217], v16 offset:0
ds_read_b64_tr_b16 a[218:219], v16 offset:1536
M a[96:99], a[184:187], a[240:243], a[96:99]
buffer_load_dwordx4 v8, s[12:15], s25 offen offset:2048 lds
M a[100:103], a[192:195], a[240:243], a[100:103]
M a[100:103], a[196:199], a[244:247], a[100:103]
buffer_load_dwordx4 v9, s[12:15], s25 offen offset:3072 lds
s_waitcnt lgkmcnt(10)
M a[104:107], a[180:183], a[252:255], a[104:107]
ds_read_b128 a[240:243], v10 offset:12288
ds_read_b128 a[244:247], v11 offset:12288
M a[104:107], a[176:179], a[248:251], a[104:107]
M a[108:111], a[184:187], a[248:251], a[108:111]
ds_read_b64_tr_b16 a[204:205], v14 offset:12288
ds_read_b64_tr_b16 a[206:207], v14 offset:13824
M a[108:111], a[188:191], a[252:255], a[108:111]
s_add_u32 m0, s30, 102400
s_nop 0
buffer_load_dwordx4 v21, s[12:15], s25 offen offset:0 lds
M a[112:115], a[196:199], a[252:255], a[112:115]
M a[112:115], a[192:195], a[248:251], a[112:115]
buffer_load_dwordx4 v22, s[12:15], s25 offen offset:1024 lds
s_waitcnt lgkmcnt(10)
M a[116:119], a[176:179], a[224:227], a[116:119]
ds_read_b128 a[248:251], v10 offset:14336
ds_read_b128 a[252:255], v11 offset:14336
M a[116:119], a[180:183], a[228:231], a[116:119]
M a[120:123], a[188:191], a[228:231], a[120:123]
ds_read_b64_tr_b16 a[212:213], v15 offset:12288
ds_read_b64_tr_b16 a[214:215], v15 offset:13824
M a[120:123], a[184:187], a[224:227], a[120:123]
s_sub_u32 s54, s54, 1
s_cmp_eq_u32 s54, 0
s_cselect_b32 s58, s55, s56
s_add_u32 s25, s25, s58
M a[124:127], a[192:195], a[224:227], a[124:127]
M a[124:127], a[196:199], a[228:231], a[124:127]
s_add_u32 s94, s93, 8192
buffer_store_dwordx4 v[240:243], v1, s[16:19], s94 offen offset:2048 sc1
s_waitcnt lgkmcnt(10)
M a[128:131], a[180:183], a[236:239], a[128:131]
ds_read_b128 a[224:227], v10 offset:16384
ds_read_b128 a[228:231], v11 offset:16384
M a[128:131], a[176:179], a[232:235], a[128:131]
M a[132:135], a[184:187], a[232:235], a[132:135]
ds_read_b64_tr_b16 a[220:221], v16 offset:12288
ds_read_b64_tr_b16 a[222:223], v16 offset:13824
M a[132:135], a[188:191], a[236:239], a[132:135]
s_add_u32 s94, s93, 8192
buffer_store_dwordx4 v[248:251], v1, s[16:19], s94 offen offset:3072 sc1
M a[136:139], a[196:199], a[236:239], a[136:139]
M a[136:139], a[192:195], a[232:235], a[136:139]
s_add_u32 s94, s93, 12288
buffer_store_dwordx4 v[36:39], v1, s[16:19], s94 offen offset:0 sc1
s_waitcnt lgkmcnt(10)
M a[140:143], a[176:179], a[240:243], a[140:143]
M a[140:143], a[180:183], a[244:247], a[140:143]
s_add_u32 s94, s93, 12288
buffer_store_dwordx4 v[44:47], v1, s[16:19], s94 offen offset:1024 sc1
M a[144:147], a[188:191], a[244:247], a[144:147]
M a[144:147], a[184:187], a[240:243], a[144:147]
M a[148:151], a[192:195], a[240:243], a[148:151]
s_waitcnt vmcnt(20) lgkmcnt(0)
s_barrier
ds_read_b128 a[232:235], v10 offset:18432
ds_read_b128 a[236:239], v11 offset:18432
M a[148:151], a[196:199], a[244:247], a[148:151]
s_add_u32 m0, s28, 0
s_nop 0
buffer_load_dword v20, s[8:11], s24 offen lds
M a[152:155], a[180:183], a[252:255], a[152:155]
ds_read_b128 a[240:243], v10 offset:20480
ds_read_b128 a[244:247], v11 offset:20480
M a[152:155], a[176:179], a[248:251], a[152:155]
M a[156:159], a[184:187], a[248:251], a[156:159]
buffer_load_dword v23, s[8:11], s24 offen offset:256 lds
M a[156:159], a[188:191], a[252:255], a[156:159]
M a[160:163], a[196:199], a[252:255], a[160:163]
M a[160:163], a[192:195], a[248:251], a[160:163]
s_add_u32 m0, s29, 2048
s_nop 0
buffer_load_dwordx4 v2, s[8:11], s23 offen offset:0 lds
M a[164:167], a[176:179], a[224:227], a[164:167]
ds_read_b128 a[248:251], v10 offset:22528
ds_read_b128 a[252:255], v11 offset:22528
M a[164:167], a[180:183], a[228:231], a[164:167]
M a[168:171], a[188:191], a[228:231], a[168:171]
M a[168:171], a[184:187], a[224:227], a[168:171]
buffer_load_dwordx4 v3, s[8:11], s23 offen offset:1024 lds
M a[172:175], a[192:195], a[224:227], a[172:175]
M a[172:175], a[196:199], a[228:231], a[172:175]
s_waitcnt lgkmcnt(4)
M a[68:71], a[200:203], a[232:235], a[68:71]
ds_read_b128 a[224:227], v10 offset:24576
ds_read_b128 a[228:231], v11 offset:24576
M a[68:71], a[204:207], a[236:239], a[68:71]
buffer_load_dwordx4 v4, s[8:11], s23 offen offset:2048 lds
M a[72:75], a[212:215], a[236:239], a[72:75]
ds_read_b64_tr_b16 a[176:177], v14 offset:28672
ds_read_b64_tr_b16 a[178:179], v14 offset:30208
M a[72:75], a[208:211], a[232:235], a[72:75]
M a[76:79], a[216:219], a[232:235], a[76:79]
buffer_load_dwordx4 v5, s[8:11], s23 offen offset:3072 lds
M a[76:79], a[220:223], a[236:239], a[76:79]
s_waitcnt lgkmcnt(6)
M a[80:83], a[204:207], a[244:247], a[80:83]
ds_read_b128 a[232:235], v10 offset:26624
ds_read_b128 a[236:239], v11 offset:26624
M a[80:83], a[200:203], a[240:243], a[80:83]
s_sub_u32 s31, s31, 1
s_cmp_eq_u32 s31, 0
s_cselect_b32 s58, -1920, s57
s_add_u32 s23, s23, s58
s_add_u32 s24, s24, s58
M a[84:87], a[208:211], a[240:243], a[84:87]
ds_read_b64_tr_b16 a[184:185], v15 offset:28672
ds_read_b64_tr_b16 a[186:187], v15 offset:30208
M a[84:87], a[212:215], a[244:247], a[84:87]
M a[88:91], a[220:223], a[244:247], a[88:91]
s_add_u32 m0, s30, 36864
s_nop 0
buffer_load_dwordx4 v6, s[12:15], s25 offen offset:0 lds
M a[88:91], a[216:219], a[240:243], a[88:91]
s_waitcnt lgkmcnt(8)
M a[92:95], a[200:203], a[248:251], a[92:95]
ds_read_b128 a[240:243], v10 offset:28672
ds_read_b128 a[244:247], v11 offset:28672
M a[92:95], a[204:207], a[252:255], a[92:95]
M a[96:99], a[212:215], a[252:255], a[96:99]
ds_read_b64_tr_b16 a[192:193], v16 offset:28672
ds_read_b64_tr_b16 a[194:195], v16 offset:30208
M a[96:99], a[208:211], a[248:251], a[96:99]
buffer_load_dwordx4 v7, s[12:15], s25 offen offset:1024 lds
M a[100:103], a[216:219], a[248:251], a[100:103]
M a[100:103], a[220:223], a[252:255], a[100:103]
buffer_load_dwordx4 v8, s[12:15], s25 offen offset:2048 lds
s_waitcnt lgkmcnt(10)
M a[104:107], a[204:207], a[228:231], a[104:107]
ds_read_b128 a[248:251], v10 offset:30720
ds_read_b128 a[252:255], v11 offset:30720
M a[104:107], a[200:203], a[224:227], a[104:107]
M a[108:111], a[208:211], a[224:227], a[108:111]
ds_read_b64_tr_b16 a[180:181], v14 offset:40960
ds_read_b64_tr_b16 a[182:183], v14 offset:42496
M a[108:111], a[212:215], a[228:231], a[108:111]
buffer_load_dwordx4 v9, s[12:15], s25 offen offset:3072 lds
M a[112:115], a[220:223], a[228:231], a[112:115]
M a[112:115], a[216:219], a[224:227], a[112:115]
s_add_u32 m0, s30, 40960
s_nop 0
buffer_load_dwordx4 v21, s[12:15], s25 offen offset:0 lds
s_waitcnt lgkmcnt(10)
M a[116:119], a[200:203], a[232:235], a[116:119]
ds_read_b128 a[224:227], v10 offset:32768
ds_read_b128 a[228:231], v11 offset:32768
M a[116:119], a[204:207], a[236:239], a[116:119]
M a[120:123], a[212:215], a[236:239], a[120:123]
ds_read_b64_tr_b16 a[188:189], v15 offset:40960
ds_read_b64_tr_b16 a[190:191], v15 offset:42496
M a[120:123], a[208:211], a[232:235], a[120:123]
M a[124:127], a[216:219], a[232:235], a[124:127]
buffer_load_dwordx4 v22, s[12:15], s25 offen offset:1024 lds
M a[124:127], a[220:223], a[236:239], a[124:127]
s_waitcnt lgkmcnt(10)
M a[128:131], a[204:207], a[244:247], a[128:131]
ds_read_b128 a[232:235], v10 offset:34816
ds_read_b128 a[236:239], v11 offset:34816
M a[128:131], a[200:203], a[240:243], a[128:131]
s_sub_u32 s54, s54, 1
s_cmp_eq_u32 s54, 0
s_cselect_b32 s58, s55, s56
s_add_u32 s25, s25, s58
M a[132:135], a[208:211], a[240:243], a[132:135]
ds_read_b64_tr_b16 a[196:197], v16 offset:40960
ds_read_b64_tr_b16 a[198:199], v16 offset:42496
M a[132:135], a[212:215], a[244:247], a[132:135]
M a[136:139], a[220:223], a[244:247], a[136:139]
s_add_u32 s94, s93, 12288
buffer_store_dwordx4 v[52:55], v1, s[16:19], s94 offen offset:2048 sc1
M a[136:139], a[216:219], a[240:243], a[136:139]
s_waitcnt lgkmcnt(10)
M a[140:143], a[200:203], a[248:251], a[140:143]
s_add_u32 s94, s93, 12288
buffer_store_dwordx4 v[60:63], v1, s[16:19], s94 offen offset:3072 sc1
M a[140:143], a[204:207], a[252:255], a[140:143]
M a[144:147], a[212:215], a[252:255], a[144:147]
M a[144:147], a[208:211], a[248:251], a[144:147]
M a[148:151], a[216:219], a[248:251], a[148:151]
s_waitcnt vmcnt(18) lgkmcnt(0)
s_barrier
ds_read_b128 a[240:243], v12 offset:0
ds_read_b128 a[244:247], v13 offset:0
M a[148:151], a[220:223], a[252:255], a[148:151]
s_add_u32 m0, s28, 18432
s_nop 0
buffer_load_dword v20, s[8:11], s24 offen lds
M a[152:155], a[204:207], a[228:231], a[152:155]
ds_read_b128 a[248:251], v12 offset:2048
ds_read_b128 a[252:255], v13 offset:2048
M a[152:155], a[200:203], a[224:227], a[152:155]
M a[156:159], a[208:211], a[224:227], a[156:159]
buffer_load_dword v23, s[8:11], s24 offen offset:256 lds
M a[156:159], a[212:215], a[228:231], a[156:159]
M a[160:163], a[220:223], a[228:231], a[160:163]
M a[160:163], a[216:219], a[224:227], a[160:163]
s_add_u32 m0, s29, 20480
s_nop 0
buffer_load_dwordx4 v2, s[8:11], s23 offen offset:0 lds
M a[164:167], a[200:203], a[232:235], a[164:167]
ds_read_b128 a[224:227], v12 offset:4096
ds_read_b128 a[228:231], v13 offset:4096
M a[164:167], a[204:207], a[236:239], a[164:167]
M a[168:171], a[212:215], a[236:239], a[168:171]
M a[168:171], a[208:211], a[232:235], a[168:171]
buffer_load_dwordx4 v3, s[8:11], s23 offen offset:1024 lds
M a[172:175], a[216:219], a[232:235], a[172:175]
M a[172:175], a[220:223], a[236:239], a[172:175]
s_waitcnt lgkmcnt(4)
M a[68:71], a[176:179], a[240:243], a[68:71]
ds_read_b128 a[232:235], v12 offset:6144
ds_read_b128 a[236:239], v13 offset:6144
M a[68:71], a[180:183], a[244:247], a[68:71]
buffer_load_dwordx4 v4, s[8:11], s23 offen offset:2048 lds
M a[72:75], a[188:191], a[244:247], a[72:75]
ds_read_b64_tr_b16 a[200:201], v17 offset:0
ds_read_b64_tr_b16 a[202:203], v17 offset:1536
M a[72:75], a[184:187], a[240:243], a[72:75]
M a[76:79], a[192:195], a[240:243], a[76:79]
buffer_load_dwordx4 v5, s[8:11], s23 offen offset:3072 lds
M a[76:79], a[196:199], a[244:247], a[76:79]
s_waitcnt lgkmcnt(6)
M a[80:83], a[180:183], a[252:255], a[80:83]
ds_read_b128 a[240:243], v12 offset:8192
ds_read_b128 a[244:247], v13 offset:8192
M a[80:83], a[176:179], a[248:251], a[80:83]
M a[84:87], a[184:187], a[248:251], a[84:87]
ds_read_b64_tr_b16 a[208:209], v18 offset:0
ds_read_b64_tr_b16 a[210:211], v18 offset:1536
M a[84:87], a[188:191], a[252:255], a[84:87]
s_sub_u32 s31, s31, 1
s_cmp_eq_u32 s31, 0
s_cselect_b32 s58, -1920, s57
s_add_u32 s23, s23, s58
s_add_u32 s24, s24, s58
M a[88:91], a[196:199], a[252:255], a[88:91]
M a[88:91], a[192:195], a[248:251], a[88:91]
s_waitcnt lgkmcnt(8)
M a[92:95], a[176:179], a[224:227], a[92:95]
ds_read_b128 a[248:251], v12 offset:10240
ds_read_b128 a[252:255], v13 offset:10240
M a[92:95], a[180:183], a[228:231], a[92:95]
s_add_u32 m0, s30, 65536
s_nop 0
buffer_load_dwordx4 v6, s[12:15], s25 offen offset:0 lds
M a[96:99], a[188:191], a[228:231], a[96:99]
ds_read_b64_tr_b16 a[216:217], v19 offset:0
ds_read_b64_tr_b16 a[218:219], v19 offset:1536
M a[96:99], a[184:187], a[224:227], a[96:99]
M a[100:103], a[192:195], a[224:227], a[100:103]
buffer_load_dwordx4 v7, s[12:15], s25 offen offset:1024 lds
M a[100:103], a[196:199], a[228:231], a[100:103]
s_waitcnt lgkmcnt(10)
M a[104:107], a[180:183], a[236:239], a[104:107]
ds_read_b128 a[224:227], v12 offset:12288
ds_read_b128 a[228:231], v13 offset:12288
M a[104:107], a[176:179], a[232:235], a[104:107]
M a[108:111], a[184:187], a[232:235], a[108:111]
ds_read_b64_tr_b16 a[204:205], v17 offset:12288
ds_read_b64_tr_b16 a[206:207], v17 offset:13824
M a[108:111], a[188:191], a[236:239], a[108:111]
buffer_load_dwordx4 v8, s[12:15], s25 offen offset:2048 lds
M a[112:115], a[196:199], a[236:239], a[112:115]
M a[112:115], a[192:195], a[232:235], a[112:115]
s_waitcnt lgkmcnt(10)
M a[116:119], a[176:179], a[240:243], a[116:119]
ds_read_b128 a[232:235], v12 offset:14336
ds_read_b128 a[236:239], v13 offset:14336
M a[116:119], a[180:183], a[244:247], a[116:119]
buffer_load_dwordx4 v9, s[12:15], s25 offen offset:3072 lds
M a[120:123], a[188:191], a[244:247], a[120:123]
ds_read_b64_tr_b16 a[212:213], v18 offset:12288
ds_read_b64_tr_b16 a[214:215], v18 offset:13824
M a[120:123], a[184:187], a[240:243], a[120:123]
M a[124:127], a[192:195], a[240:243], a[124:127]
s_add_u32 m0, s30, 69632
s_nop 0
buffer_load_dwordx4 v21, s[12:15], s25 offen offset:0 lds
M a[124:127], a[196:199], a[244:247], a[124:127]
s_waitcnt lgkmcnt(10)
M a[128:131], a[180:183], a[252:255], a[128:131]
ds_read_b128 a[240:243], v12 offset:16384
ds_read_b128 a[244:247], v13 offset:16384
M a[128:131], a[176:179], a[248:251], a[128:131]
M a[132:135], a[184:187], a[248:251], a[132:135]
ds_read_b64_tr_b16 a[220:221], v19 offset:12288
ds_read_b64_tr_b16 a[222:223], v19 offset:13824
M a[132:135], a[188:191], a[252:255], a[132:135]
buffer_load_dwordx4 v22, s[12:15], s25 offen offset:1024 lds
M a[136:139], a[196:199], a[252:255], a[136:139]
M a[136:139], a[192:195], a[248:251], a[136:139]
s_waitcnt lgkmcnt(10)
M a[140:143], a[176:179], a[224:227], a[140:143]
s_sub_u32 s54, s54, 1
s_cmp_eq_u32 s54, 0
s_cselect_b32 s58, s55, s56
s_add_u32 s25, s25, s58
M a[140:143], a[180:183], a[228:231], a[140:143]
M a[144:147], a[188:191], a[228:231], a[144:147]
M a[144:147], a[184:187], a[224:227], a[144:147]
M a[148:151], a[192:195], a[224:227], a[148:151]
s_waitcnt vmcnt(12) lgkmcnt(0)
s_barrier
ds_read_b128 a[248:251], v10 offset:0
ds_read_b128 a[252:255], v11 offset:0
s_cmp_lg_u32 s101, 0
s_cbranch_scc1 Lk1_arr
v_mov_b32 v127, 1
s_and_b32 s41, s2, 128
s_mov_b64 exec, 1
buffer_atomic_add v127, off, s[36:39], s41 sc1
s_mov_b64 exec, -1
Lk1_arr:
M a[148:151], a[196:199], a[228:231], a[148:151]
s_add_u32 m0, s28, 131072
s_nop 0
buffer_load_dword v20, s[8:11], s24 offen lds
M a[152:155], a[180:183], a[236:239], a[152:155]
ds_read_b128 a[224:227], v10 offset:2048
ds_read_b128 a[228:231], v11 offset:2048
M a[152:155], a[176:179], a[232:235], a[152:155]
M a[156:159], a[184:187], a[232:235], a[156:159]
buffer_load_dword v23, s[8:11], s24 offen offset:256 lds
M a[156:159], a[188:191], a[236:239], a[156:159]
M a[160:163], a[196:199], a[236:239], a[160:163]
M a[160:163], a[192:195], a[232:235], a[160:163]
s_add_u32 m0, s29, 133120
s_nop 0
buffer_load_dwordx4 v2, s[8:11], s23 offen offset:0 lds
M a[164:167], a[176:179], a[240:243], a[164:167]
ds_read_b128 a[232:235], v10 offset:4096
ds_read_b128 a[236:239], v11 offset:4096
M a[164:167], a[180:183], a[244:247], a[164:167]
M a[168:171], a[188:191], a[244:247], a[168:171]
M a[168:171], a[184:187], a[240:243], a[168:171]
buffer_load_dwordx4 v3, s[8:11], s23 offen offset:1024 lds
M a[172:175], a[192:195], a[240:243], a[172:175]
M a[172:175], a[196:199], a[244:247], a[172:175]
s_waitcnt lgkmcnt(4)
M a[68:71], a[200:203], a[248:251], a[68:71]
ds_read_b128 a[240:243], v10 offset:6144
ds_read_b128 a[244:247], v11 offset:6144
M a[68:71], a[204:207], a[252:255], a[68:71]
buffer_load_dwordx4 v4, s[8:11], s23 offen offset:2048 lds
M a[72:75], a[212:215], a[252:255], a[72:75]
ds_read_b64_tr_b16 a[176:177], v14 offset:0
ds_read_b64_tr_b16 a[178:179], v14 offset:1536
M a[72:75], a[208:211], a[248:251], a[72:75]
M a[76:79], a[216:219], a[248:251], a[76:79]
buffer_load_dwordx4 v5, s[8:11], s23 offen offset:3072 lds
M a[76:79], a[220:223], a[252:255], a[76:79]
s_waitcnt lgkmcnt(6)
M a[80:83], a[204:207], a[228:231], a[80:83]
ds_read_b128 a[248:251], v10 offset:8192
ds_read_b128 a[252:255], v11 offset:8192
M a[80:83], a[200:203], a[224:227], a[80:83]
M a[84:87], a[208:211], a[224:227], a[84:87]
ds_read_b64_tr_b16 a[184:185], v15 offset:0
ds_read_b64_tr_b16 a[186:187], v15 offset:1536
M a[84:87], a[212:215], a[228:231], a[84:87]
s_sub_u32 s31, s31, 1
s_cmp_eq_u32 s31, 0
s_cselect_b32 s58, -1920, s57
s_add_u32 s23, s23, s58
s_add_u32 s24, s24, s58
M a[88:91], a[220:223], a[228:231], a[88:91]
M a[88:91], a[216:219], a[224:227], a[88:91]
s_waitcnt lgkmcnt(8)
M a[92:95], a[200:203], a[232:235], a[92:95]
ds_read_b128 a[224:227], v10 offset:10240
ds_read_b128 a[228:231], v11 offset:10240
M a[92:95], a[204:207], a[236:239], a[92:95]
s_add_u32 m0, s30, 98304
s_nop 0
buffer_load_dwordx4 v6, s[12:15], s25 offen offset:0 lds
M a[96:99], a[212:215], a[236:239], a[96:99]
ds_read_b64_tr_b16 a[192:193], v16 offset:0
ds_read_b64_tr_b16 a[194:195], v16 offset:1536
M a[96:99], a[208:211], a[232:235], a[96:99]
M a[100:103], a[216:219], a[232:235], a[100:103]
buffer_load_dwordx4 v7, s[12:15], s25 offen offset:1024 lds
M a[100:103], a[220:223], a[236:239], a[100:103]
s_waitcnt lgkmcnt(10)
M a[104:107], a[204:207], a[244:247], a[104:107]
ds_read_b128 a[232:235], v10 offset:12288
ds_read_b128 a[236:239], v11 offset:12288
M a[104:107], a[200:203], a[240:243], a[104:107]
M a[108:111], a[208:211], a[240:243], a[108:111]
ds_read_b64_tr_b16 a[180:181], v14 offset:12288
ds_read_b64_tr_b16 a[182:183], v14 offset:13824
M a[108:111], a[212:215], a[244:247], a[108:111]
buffer_load_dwordx4 v8, s[12:15], s25 offen offset:2048 lds
M a[112:115], a[220:223], a[244:247], a[112:115]
M a[112:115], a[216:219], a[240:243], a[112:115]
s_waitcnt lgkmcnt(10)
M a[116:119], a[200:203], a[248:251], a[116:119]
ds_read_b128 a[240:243], v10 offset:14336
ds_read_b128 a[244:247], v11 offset:14336
M a[116:119], a[204:207], a[252:255], a[116:119]
buffer_load_dwordx4 v9, s[12:15], s25 offen offset:3072 lds
M a[120:123], a[212:215], a[252:255], a[120:123]
ds_read_b64_tr_b16 a[188:189], v15 offset:12288
ds_read_b64_tr_b16 a[190:191], v15 offset:13824
M a[120:123], a[208:211], a[248:251], a[120:123]
M a[124:127], a[216:219], a[248:251], a[124:127]
s_add_u32 m0, s30, 102400
s_nop 0
buffer_load_dwordx4 v21, s[12:15], s25 offen offset:0 lds
M a[124:127], a[220:223], a[252:255], a[124:127]
s_waitcnt lgkmcnt(10)
M a[128:131], a[204:207], a[228:231], a[128:131]
ds_read_b128 a[248:251], v10 offset:16384
ds_read_b128 a[252:255], v11 offset:16384
M a[128:131], a[200:203], a[224:227], a[128:131]
M a[132:135], a[208:211], a[224:227], a[132:135]
ds_read_b64_tr_b16 a[196:197], v16 offset:12288
ds_read_b64_tr_b16 a[198:199], v16 offset:13824
M a[132:135], a[212:215], a[228:231], a[132:135]
buffer_load_dwordx4 v22, s[12:15], s25 offen offset:1024 lds
M a[136:139], a[220:223], a[228:231], a[136:139]
M a[136:139], a[216:219], a[224:227], a[136:139]
s_waitcnt lgkmcnt(10)
M a[140:143], a[200:203], a[232:235], a[140:143]
s_sub_u32 s54, s54, 1
s_cmp_eq_u32 s54, 0
s_cselect_b32 s58, s55, s56
s_add_u32 s25, s25, s58
M a[140:143], a[204:207], a[236:239], a[140:143]
M a[144:147], a[212:215], a[236:239], a[144:147]
M a[144:147], a[208:211], a[232:235], a[144:147]
M a[148:151], a[216:219], a[232:235], a[148:151]
s_waitcnt vmcnt(12) lgkmcnt(0)
s_barrier
ds_read_b128 a[224:227], v10 offset:18432
ds_read_b128 a[228:231], v11 offset:18432
M a[148:151], a[220:223], a[236:239], a[148:151]
s_add_u32 m0, s28, 0
s_nop 0
buffer_load_dword v20, s[8:11], s24 offen lds
M a[152:155], a[204:207], a[244:247], a[152:155]
ds_read_b128 a[232:235], v10 offset:20480
ds_read_b128 a[236:239], v11 offset:20480
M a[152:155], a[200:203], a[240:243], a[152:155]
M a[156:159], a[208:211], a[240:243], a[156:159]
buffer_load_dword v23, s[8:11], s24 offen offset:256 lds
M a[156:159], a[212:215], a[244:247], a[156:159]
M a[160:163], a[220:223], a[244:247], a[160:163]
M a[160:163], a[216:219], a[240:243], a[160:163]
s_add_u32 m0, s29, 2048
s_nop 0
buffer_load_dwordx4 v2, s[8:11], s23 offen offset:0 lds
M a[164:167], a[200:203], a[248:251], a[164:167]
ds_read_b128 a[240:243], v10 offset:22528
ds_read_b128 a[244:247], v11 offset:22528
M a[164:167], a[204:207], a[252:255], a[164:167]
M a[168:171], a[212:215], a[252:255], a[168:171]
M a[168:171], a[208:211], a[248:251], a[168:171]
buffer_load_dwordx4 v3, s[8:11], s23 offen offset:1024 lds
M a[172:175], a[216:219], a[248:251], a[172:175]
M a[172:175], a[220:223], a[252:255], a[172:175]
s_waitcnt lgkmcnt(4)
M a[68:71], a[176:179], a[224:227], a[68:71]
ds_read_b128 a[248:251], v10 offset:24576
ds_read_b128 a[252:255], v11 offset:24576
v_mov_b32 v160, 0
v_mov_b32 v161, 0
M a[68:71], a[180:183], a[228:231], a[68:71]
buffer_load_dwordx4 v4, s[8:11], s23 offen offset:2048 lds
M a[72:75], a[188:191], a[228:231], a[72:75]
ds_read_b64_tr_b16 a[200:201], v14 offset:28672
ds_read_b64_tr_b16 a[202:203], v14 offset:30208
v_mov_b32 v162, 0
v_mov_b32 v163, 0
M a[72:75], a[184:187], a[224:227], a[72:75]
M a[76:79], a[192:195], a[224:227], a[76:79]
buffer_load_dwordx4 v5, s[8:11], s23 offen offset:3072 lds
v_mov_b32 v164, 0
v_mov_b32 v165, 0
M a[76:79], a[196:199], a[228:231], a[76:79]
s_waitcnt lgkmcnt(6)
M a[80:83], a[180:183], a[236:239], a[80:83]
ds_read_b128 a[224:227], v10 offset:26624
ds_read_b128 a[228:231], v11 offset:26624
v_mov_b32 v166, 0
v_mov_b32 v167, 0
M a[80:83], a[176:179], a[232:235], a[80:83]
M a[84:87], a[184:187], a[232:235], a[84:87]
ds_read_b64_tr_b16 a[208:209], v15 offset:28672
ds_read_b64_tr_b16 a[210:211], v15 offset:30208
M a[84:87], a[188:191], a[236:239], a[84:87]
s_sub_u32 s31, s31, 1
s_cmp_eq_u32 s31, 0
s_cselect_b32 s58, -1920, s57
s_add_u32 s23, s23, s58
s_add_u32 s24, s24, s58
v_mov_b32 v168, 0
v_mov_b32 v169, 0
M a[88:91], a[196:199], a[236:239], a[88:91]
M a[88:91], a[192:195], a[232:235], a[88:91]
s_waitcnt lgkmcnt(8)
v_mov_b32 v170, 0
v_mov_b32 v171, 0
M a[92:95], a[176:179], a[240:243], a[92:95]
ds_read_b128 a[232:235], v10 offset:28672
ds_read_b128 a[236:239], v11 offset:28672
M a[92:95], a[180:183], a[244:247], a[92:95]
s_add_u32 m0, s30, 36864
s_nop 0
buffer_load_dwordx4 v6, s[12:15], s25 offen offset:0 lds
v_mov_b32 v172, 0
v_mov_b32 v173, 0
M a[96:99], a[188:191], a[244:247], a[96:99]
ds_read_b64_tr_b16 a[216:217], v16 offset:28672
ds_read_b64_tr_b16 a[218:219], v16 offset:30208
M a[96:99], a[184:187], a[240:243], a[96:99]
v_mov_b32 v174, 0
v_mov_b32 v175, 0
M a[100:103], a[192:195], a[240:243], a[100:103]
buffer_load_dwordx4 v7, s[12:15], s25 offen offset:1024 lds
M a[100:103], a[196:199], a[244:247], a[100:103]
s_waitcnt lgkmcnt(10)
M a[104:107], a[180:183], a[252:255], a[104:107]
ds_read_b128 a[240:243], v10 offset:30720
ds_read_b128 a[244:247], v11 offset:30720
v_mov_b32 v176, 0
v_mov_b32 v177, 0
M a[104:107], a[176:179], a[248:251], a[104:107]
M a[108:111], a[184:187], a[248:251], a[108:111]
ds_read_b64_tr_b16 a[204:205], v14 offset:40960
ds_read_b64_tr_b16 a[206:207], v14 offset:42496
v_mov_b32 v178, 0
v_mov_b32 v179, 0
M a[108:111], a[188:191], a[252:255], a[108:111]
buffer_load_dwordx4 v8, s[12:15], s25 offen offset:2048 lds
M a[112:115], a[196:199], a[252:255], a[112:115]
v_mov_b32 v180, 0
v_mov_b32 v181, 0
M a[112:115], a[192:195], a[248:251], a[112:115]
s_waitcnt lgkmcnt(10)
M a[116:119], a[176:179], a[224:227], a[116:119]
ds_read_b128 a[248:251], v10 offset:32768
ds_read_b128 a[252:255], v11 offset:32768
v_mov_b32 v182, 0
v_mov_b32 v183, 0
M a[116:119], a[180:183], a[228:231], a[116:119]
buffer_load_dwordx4 v9, s[12:15], s25 offen offset:3072 lds
M a[120:123], a[188:191], a[228:231], a[120:123]
ds_read_b64_tr_b16 a[212:213], v15 offset:40960
ds_read_b64_tr_b16 a[214:215], v15 offset:42496
M a[120:123], a[184:187], a[224:227], a[120:123]
v_mov_b32 v184, 0
v_mov_b32 v185, 0
M a[124:127], a[192:195], a[224:227], a[124:127]
s_add_u32 m0, s30, 40960
s_nop 0
buffer_load_dwordx4 v21, s[12:15], s25 offen offset:0 lds
M a[124:127], a[196:199], a[228:231], a[124:127]
s_waitcnt lgkmcnt(10)
v_mov_b32 v186, 0
v_mov_b32 v187, 0
M a[128:131], a[180:183], a[236:239], a[128:131]
ds_read_b128 a[224:227], v10 offset:34816
ds_read_b128 a[228:231], v11 offset:34816
M a[128:131], a[176:179], a[232:235], a[128:131]
v_mov_b32 v188, 0
v_mov_b32 v189, 0
M a[132:135], a[184:187], a[232:235], a[132:135]
ds_read_b64_tr_b16 a[220:221], v16 offset:40960
ds_read_b64_tr_b16 a[222:223], v16 offset:42496
M a[132:135], a[188:191], a[236:239], a[132:135]
buffer_load_dwordx4 v22, s[12:15], s25 offen offset:1024 lds
v_mov_b32 v190, 0
v_mov_b32 v191, 0
M a[136:139], a[196:199], a[236:239], a[136:139]
M a[136:139], a[192:195], a[232:235], a[136:139]
s_waitcnt lgkmcnt(10)
M a[140:143], a[176:179], a[240:243], a[140:143]
s_sub_u32 s54, s54, 1
s_cmp_eq_u32 s54, 0
s_cselect_b32 s58, s55, s56
s_add_u32 s25, s25, s58
v_mov_b32 v192, 0
v_mov_b32 v193, 0
M a[140:143], a[180:183], a[244:247], a[140:143]
M a[144:147], a[188:191], a[244:247], a[144:147]
v_mov_b32 v194, 0
v_mov_b32 v195, 0
M a[144:147], a[184:187], a[240:243], a[144:147]
M a[148:151], a[192:195], a[240:243], a[148:151]
s_waitcnt vmcnt(12) lgkmcnt(0)
s_barrier
ds_read_b128 a[232:235], v12 offset:0
ds_read_b128 a[236:239], v13 offset:0
v_mov_b32 v196, 0
v_mov_b32 v197, 0
M a[148:151], a[196:199], a[244:247], a[148:151]
s_add_u32 m0, s28, 18432
s_nop 0
buffer_load_dword v20, s[8:11], s24 offen lds
M a[152:155], a[180:183], a[252:255], a[152:155]
ds_read_b128 a[240:243], v12 offset:2048
ds_read_b128 a[244:247], v13 offset:2048
v_mov_b32 v198, 0
v_mov_b32 v199, 0
M a[152:155], a[176:179], a[248:251], a[152:155]
M a[156:159], a[184:187], a[248:251], a[156:159]
buffer_load_dword v23, s[8:11], s24 offen offset:256 lds
M a[156:159], a[188:191], a[252:255], a[156:159]
v_mov_b32 v200, 0
v_mov_b32 v201, 0
M a[160:163], a[196:199], a[252:255], a[160:163]
M a[160:163], a[192:195], a[248:251], a[160:163]
s_add_u32 m0, s29, 20480
s_nop 0
buffer_load_dwordx4 v2, s[8:11], s23 offen offset:0 lds
v_mov_b32 v202, 0
v_mov_b32 v203, 0
M a[164:167], a[176:179], a[224:227], a[164:167]
ds_read_b128 a[248:251], v12 offset:4096
ds_read_b128 a[252:255], v13 offset:4096
M a[164:167], a[180:183], a[228:231], a[164:167]
v_mov_b32 v204, 0
v_mov_b32 v205, 0
M a[168:171], a[188:191], a[228:231], a[168:171]
M a[168:171], a[184:187], a[224:227], a[168:171]
buffer_load_dwordx4 v3, s[8:11], s23 offen offset:1024 lds
v_mov_b32 v206, 0
v_mov_b32 v207, 0
M a[172:175], a[192:195], a[224:227], a[172:175]
M a[172:175], a[196:199], a[228:231], a[172:175]
s_waitcnt lgkmcnt(4)
M a[68:71], a[200:203], a[232:235], a[68:71]
ds_read_b128 a[224:227], v12 offset:6144
ds_read_b128 a[228:231], v13 offset:6144
v_and_b32 v128, 15, v0
v_mul_u32_u24 v128, 400, v128
M a[68:71], a[204:207], a[236:239], a[68:71]
buffer_load_dwordx4 v4, s[8:11], s23 offen offset:2048 lds
M a[72:75], a[212:215], a[236:239], a[72:75]
ds_read_b64_tr_b16 a[176:177], v17 offset:0
ds_read_b64_tr_b16 a[178:179], v17 offset:1536
v_lshrrev_b32 v129, 4, v0
v_lshl_add_u32 v128, v129, 3, v128
M a[72:75], a[208:211], a[232:235], a[72:75]
M a[76:79], a[216:219], a[232:235], a[76:79]
buffer_load_dwordx4 v5, s[8:11], s23 offen offset:3072 lds
s_mul_i32 s3, s20, 96
s_add_u32 s3, s3, 98304
M a[76:79], a[220:223], a[236:239], a[76:79]
s_waitcnt lgkmcnt(6)
M a[80:83], a[204:207], a[244:247], a[80:83]
ds_read_b128 a[232:235], v12 offset:8192
ds_read_b128 a[236:239], v13 offset:8192
v_add_u32 v124, s3, v128
v_and_b32 v128, 15, v0
M a[80:83], a[200:203], a[240:243], a[80:83]
M a[84:87], a[208:211], a[240:243], a[84:87]
ds_read_b64_tr_b16 a[184:185], v18 offset:0
ds_read_b64_tr_b16 a[186:187], v18 offset:1536
v_lshrrev_b32 v129, 4, v0
s_add_u32 s3, s21, 16
M a[84:87], a[212:215], a[244:247], a[84:87]
s_sub_u32 s31, s31, 1
s_cmp_eq_u32 s31, 0
s_cselect_b32 s58, -1920, s57
s_add_u32 s23, s23, s58
s_add_u32 s24, s24, s58
M a[88:91], a[220:223], a[244:247], a[88:91]
v_lshl_add_u32 v130, v128, 1, s3
s_lshl_b32 s4, s22, 6
M a[88:91], a[216:219], a[240:243], a[88:91]
s_waitcnt lgkmcnt(8)
M a[92:95], a[200:203], a[248:251], a[92:95]
ds_read_b128 a[240:243], v12 offset:10240
ds_read_b128 a[244:247], v13 offset:10240
s_add_u32 s4, s4, 98304
v_mul_u32_u24 v120, 400, v130
M a[92:95], a[204:207], a[252:255], a[92:95]
s_add_u32 m0, s30, 65536
s_nop 0
buffer_load_dwordx4 v6, s[12:15], s25 offen offset:0 lds
M a[96:99], a[212:215], a[252:255], a[96:99]
ds_read_b64_tr_b16 a[192:193], v19 offset:0
ds_read_b64_tr_b16 a[194:195], v19 offset:1536
M a[96:99], a[208:211], a[248:251], a[96:99]
v_lshl_add_u32 v120, v129, 4, v120
v_add_u32 v120, s4, v120
M a[100:103], a[216:219], a[248:251], a[100:103]
buffer_load_dwordx4 v7, s[12:15], s25 offen offset:1024 lds
M a[100:103], a[220:223], a[252:255], a[100:103]
s_waitcnt lgkmcnt(10)
v_subrev_u32 v130, 32, v130
v_max_i32 v130, 0, v130
M a[104:107], a[204:207], a[228:231], a[104:107]
ds_read_b128 a[248:251], v12 offset:12288
ds_read_b128 a[252:255], v13 offset:12288
M a[104:107], a[200:203], a[224:227], a[104:107]
v_mul_u32_u24 v121, 400, v130
v_lshl_add_u32 v121, v129, 4, v121
M a[108:111], a[208:211], a[224:227], a[108:111]
ds_read_b64_tr_b16 a[180:181], v17 offset:12288
ds_read_b64_tr_b16 a[182:183], v17 offset:13824
M a[108:111], a[212:215], a[228:231], a[108:111]
buffer_load_dwordx4 v8, s[12:15], s25 offen offset:2048 lds
v_add_u32 v121, s4, v121
v_bfe_u32 v131, v0, 2, 2
M a[112:115], a[220:223], a[228:231], a[112:115]
M a[112:115], a[216:219], a[224:227], a[112:115]
s_waitcnt lgkmcnt(10)
v_lshl_add_u32 v131, v129, 2, v131
v_lshl_add_u32 v131, v131, 1, s3
M a[116:119], a[200:203], a[232:235], a[116:119]
ds_read_b128 a[224:227], v12 offset:14336
ds_read_b128 a[228:231], v13 offset:14336
M a[116:119], a[204:207], a[236:239], a[116:119]
buffer_load_dwordx4 v9, s[12:15], s25 offen offset:3072 lds
v_and_b32 v132, 3, v0
v_lshlrev_b32 v132, 3, v132
M a[120:123], a[212:215], a[236:239], a[120:123]
ds_read_b64_tr_b16 a[188:189], v18 offset:12288
ds_read_b64_tr_b16 a[190:191], v18 offset:13824
M a[120:123], a[208:211], a[232:235], a[120:123]
M a[124:127], a[216:219], a[232:235], a[124:127]
s_add_u32 m0, s30, 69632
s_nop 0
buffer_load_dwordx4 v21, s[12:15], s25 offen offset:0 lds
v_add_u32 v132, s4, v132
s_movk_i32 s5, 400
M a[124:127], a[220:223], a[236:239], a[124:127]
s_waitcnt lgkmcnt(10)
M a[128:131], a[204:207], a[244:247], a[128:131]
ds_read_b128 a[232:235], v12 offset:16384
ds_read_b128 a[236:239], v13 offset:16384
v_mad_u32_u24 v122, v131, s5, v132
v_subrev_u32 v131, 32, v131
M a[128:131], a[200:203], a[240:243], a[128:131]
M a[132:135], a[208:211], a[240:243], a[132:135]
ds_read_b64_tr_b16 a[196:197], v19 offset:12288
ds_read_b64_tr_b16 a[198:199], v19 offset:13824
v_max_i32 v131, 0, v131
v_mad_u32_u24 v123, v131, s5, v132
M a[132:135], a[212:215], a[244:247], a[132:135]
buffer_load_dwordx4 v22, s[12:15], s25 offen offset:1024 lds
M a[136:139], a[220:223], a[244:247], a[136:139]
v_lshlrev_b32 v129, 2, v129
v_sub_u32 v128, v128, v129
M a[136:139], a[216:219], a[240:243], a[136:139]
s_waitcnt lgkmcnt(10)
M a[140:143], a[200:203], a[248:251], a[140:143]
s_sub_u32 s54, s54, 1
s_cmp_eq_u32 s54, 0
s_cselect_b32 s58, s55, s56
s_add_u32 s25, s25, s58
v_mov_b32 v129, 0xf149f2ca
s_cmp_eq_u32 s26, 0
s_cselect_b32 s3, 0xf149f2ca, 0
M a[140:143], a[204:207], a[252:255], a[140:143]
M a[144:147], a[212:215], a[252:255], a[144:147]
v_cmp_lt_i32 vcc, -9, v128
s_nop 1
v_cndmask_b32 v144, 0, v129, vcc
M a[144:147], a[208:211], a[248:251], a[144:147]
M a[148:151], a[216:219], a[248:251], a[148:151]
s_waitcnt vmcnt(12) lgkmcnt(0)
s_barrier
ds_read_b128 a[240:243], v10 offset:0
ds_read_b128 a[244:247], v11 offset:0
M a[148:151], a[220:223], a[252:255], a[148:151]
s_add_u32 m0, s28, 131072
s_nop 0
buffer_load_dword v20, s[8:11], s24 offen lds
v_subrev_u32 v130, 0, v128
v_cmp_lt_u32 vcc, 7, v130
s_nop 1
v_cndmask_b32 v148, 0, v129, vcc
M a[152:155], a[204:207], a[228:231], a[152:155]
ds_read_b128 a[248:251], v10 offset:2048
ds_read_b128 a[252:255], v11 offset:2048
M a[152:155], a[200:203], a[224:227], a[152:155]
v_min_f32 v152, s3, v144
v_mov_b32 v156, 0x3f803f80
M a[156:159], a[208:211], a[224:227], a[156:159]
buffer_load_dword v23, s[8:11], s24 offen offset:256 lds
M a[156:159], a[212:215], a[228:231], a[156:159]
v_cmp_lt_i32 vcc, -8, v128
s_nop 1
v_cndmask_b32 v145, 0, v129, vcc
M a[160:163], a[220:223], a[228:231], a[160:163]
M a[160:163], a[216:219], a[224:227], a[160:163]
s_add_u32 m0, s29, 133120
s_nop 0
buffer_load_dwordx4 v2, s[8:11], s23 offen offset:0 lds
v_subrev_u32 v130, 1, v128
v_cmp_lt_u32 vcc, 7, v130
s_nop 1
v_cndmask_b32 v149, 0, v129, vcc
M a[164:167], a[200:203], a[232:235], a[164:167]
ds_read_b128 a[224:227], v10 offset:4096
ds_read_b128 a[228:231], v11 offset:4096
M a[164:167], a[204:207], a[236:239], a[164:167]
v_min_f32 v153, s3, v145
v_mov_b32 v157, 0x3f803f80
M a[168:171], a[212:215], a[236:239], a[168:171]
M a[168:171], a[208:211], a[232:235], a[168:171]
buffer_load_dwordx4 v3, s[8:11], s23 offen offset:1024 lds
v_cmp_lt_i32 vcc, -7, v128
s_nop 1
v_cndmask_b32 v146, 0, v129, vcc
M a[172:175], a[216:219], a[232:235], a[172:175]
M a[172:175], a[220:223], a[236:239], a[172:175]
s_waitcnt lgkmcnt(4)
M a[68:71], a[176:179], a[240:243], a[68:71]
ds_read_b128 a[232:235], v10 offset:6144
ds_read_b128 a[236:239], v11 offset:6144
v_subrev_u32 v130, 2, v128
v_cmp_lt_u32 vcc, 7, v130
s_nop 1
v_cndmask_b32 v150, 0, v129, vcc
M a[68:71], a[180:183], a[244:247], a[68:71]
buffer_load_dwordx4 v4, s[8:11], s23 offen offset:2048 lds
v_min_f32 v154, s3, v146
v_mov_b32 v158, 0x3f803f80
M a[72:75], a[188:191], a[244:247], a[72:75]
ds_read_b64_tr_b16 a[200:201], v14 offset:0
ds_read_b64_tr_b16 a[202:203], v14 offset:1536
M a[72:75], a[184:187], a[240:243], a[72:75]
v_cmp_lt_i32 vcc, -6, v128
s_nop 1
v_cndmask_b32 v147, 0, v129, vcc
M a[76:79], a[192:195], a[240:243], a[76:79]
buffer_load_dwordx4 v5, s[8:11], s23 offen offset:3072 lds
v_subrev_u32 v130, 3, v128
v_cmp_lt_u32 vcc, 7, v130
s_nop 1
v_cndmask_b32 v151, 0, v129, vcc
M a[76:79], a[196:199], a[244:247], a[76:79]
s_waitcnt lgkmcnt(6)
M a[80:83], a[180:183], a[252:255], a[80:83]
ds_read_b128 a[240:243], v10 offset:8192
ds_read_b128 a[244:247], v11 offset:8192
v_min_f32 v155, s3, v147
v_mov_b32 v159, 0x3f803f80
M a[80:83], a[176:179], a[248:251], a[80:83]
s_add_u32 s16, s50, 83886080
s_addc_u32 s17, s51, 0
M a[84:87], a[184:187], a[248:251], a[84:87]
ds_read_b64_tr_b16 a[208:209], v15 offset:0
ds_read_b64_tr_b16 a[210:211], v15 offset:1536
M a[84:87], a[188:191], a[252:255], a[84:87]
s_sub_u32 s31, s31, 1
s_cmp_eq_u32 s31, 0
s_cselect_b32 s58, -1920, s57
s_add_u32 s23, s23, s58
s_add_u32 s24, s24, s58
s_mov_b32 s18, 4194304
s_mov_b32 s19, 0x00020000
M a[88:91], a[196:199], a[252:255], a[88:91]
s_lshl_b32 s3, s26, 18
s_lshl_b32 s4, s27, 14
M a[88:91], a[192:195], a[248:251], a[88:91]
s_waitcnt lgkmcnt(8)
M a[92:95], a[176:179], a[224:227], a[92:95]
ds_read_b128 a[248:251], v10 offset:10240
ds_read_b128 a[252:255], v11 offset:10240
s_add_u32 s3, s3, s4
s_lshl_b32 s4, s21, 13
M a[92:95], a[180:183], a[228:231], a[92:95]
s_add_u32 m0, s30, 98304
s_nop 0
buffer_load_dwordx4 v6, s[12:15], s25 offen offset:0 lds
s_add_u32 s3, s3, s4
s_lshl_b32 s4, s22, 10
M a[96:99], a[188:191], a[228:231], a[96:99]
ds_read_b64_tr_b16 a[216:217], v16 offset:0
ds_read_b64_tr_b16 a[218:219], v16 offset:1536
M a[96:99], a[184:187], a[224:227], a[96:99]
s_add_u32 s6, s3, s4
s_mov_b32 s7, 0x3e8293ee
M a[100:103], a[192:195], a[224:227], a[100:103]
buffer_load_dwordx4 v7, s[12:15], s25 offen offset:1024 lds
s_lshl_b32 s65, s26, 8
s_lshl_b32 s3, s27, 4
M a[100:103], a[196:199], a[228:231], a[100:103]
s_waitcnt lgkmcnt(10)
M a[104:107], a[180:183], a[236:239], a[104:107]
ds_read_b128 a[224:227], v10 offset:12288
ds_read_b128 a[228:231], v11 offset:12288
s_add_u32 s65, s65, s3
s_lshl_b32 s3, s101, 2
M a[104:107], a[176:179], a[232:235], a[104:107]
s_add_u32 s65, s65, s3
s_add_u32 s65, s65, 8400896
M a[108:111], a[184:187], a[232:235], a[108:111]
ds_read_b64_tr_b16 a[204:205], v14 offset:12288
ds_read_b64_tr_b16 a[206:207], v14 offset:13824
M a[108:111], a[188:191], a[236:239], a[108:111]
buffer_load_dwordx4 v8, s[12:15], s25 offen offset:2048 lds
s_mov_b32 s40, 0
v_mov_b32 v119, 0
M a[112:115], a[196:199], a[236:239], a[112:115]
s_mov_b64 s[4:5], s[50:51]
s_and_b32 s20, s2, 7
M a[112:115], a[192:195], a[232:235], a[112:115]
s_waitcnt lgkmcnt(10)
M a[116:119], a[176:179], a[240:243], a[116:119]
ds_read_b128 a[232:235], v10 offset:14336
ds_read_b128 a[236:239], v11 offset:14336
s_lshr_b32 s33, s2, 6
s_lshl_b32 s33, s33, 3
M a[116:119], a[180:183], a[244:247], a[116:119]
buffer_load_dwordx4 v9, s[12:15], s25 offen offset:3072 lds
s_add_u32 s20, s20, s33
s_bfe_u32 s21, s2, 0x30003
M a[120:123], a[188:191], a[244:247], a[120:123]
ds_read_b64_tr_b16 a[212:213], v15 offset:12288
ds_read_b64_tr_b16 a[214:215], v15 offset:13824
M a[120:123], a[184:187], a[240:243], a[120:123]
s_sub_u32 s35, 15, s21
s_cmp_lt_u32 s101, 2
s_cselect_b32 s35, s21, s35
M a[124:127], a[192:195], a[240:243], a[124:127]
s_add_u32 m0, s30, 102400
s_nop 0
buffer_load_dwordx4 v21, s[12:15], s25 offen offset:0 lds
s_lshl_b32 s33, s20, 7
s_lshl_b32 s34, s35, 3
M a[124:127], a[196:199], a[244:247], a[124:127]
s_waitcnt lgkmcnt(10)
M a[128:131], a[180:183], a[252:255], a[128:131]
ds_read_b128 a[240:243], v10 offset:16384
ds_read_b128 a[244:247], v11 offset:16384
s_add_u32 s33, s33, s34
s_and_b32 s34, s101, 1
M a[128:131], a[176:179], a[248:251], a[128:131]
s_lshl_b32 s34, s34, 2
s_add_u32 s33, s33, s34
M a[132:135], a[184:187], a[248:251], a[132:135]
ds_read_b64_tr_b16 a[220:221], v16 offset:12288
ds_read_b64_tr_b16 a[222:223], v16 offset:13824
M a[132:135], a[188:191], a[252:255], a[132:135]
buffer_load_dwordx4 v22, s[12:15], s25 offen offset:1024 lds
s_lshl_b32 s64, s33, 12
s_mov_b32 s44, s4
M a[136:139], a[196:199], a[252:255], a[136:139]
s_mov_b32 s45, s5
s_mov_b32 s46, 16777216
M a[136:139], a[192:195], a[248:251], a[136:139]
s_waitcnt lgkmcnt(10)
M a[140:143], a[176:179], a[224:227], a[140:143]
s_sub_u32 s54, s54, 1
s_cmp_eq_u32 s54, 0
s_cselect_b32 s58, s55, s56
s_add_u32 s25, s25, s58
s_mov_b32 s47, 0x00020000
M a[140:143], a[180:183], a[228:231], a[140:143]
M a[144:147], a[188:191], a[228:231], a[144:147]
M a[144:147], a[184:187], a[224:227], a[144:147]
M a[148:151], a[192:195], a[224:227], a[148:151]
s_waitcnt vmcnt(12) lgkmcnt(0)
s_barrier
ds_read_b128 a[248:251], v10 offset:18432
ds_read_b128 a[252:255], v11 offset:18432
M a[148:151], a[196:199], a[228:231], a[148:151]
s_add_u32 m0, s28, 0
s_nop 0
buffer_load_dword v20, s[8:11], s24 offen lds
M a[152:155], a[180:183], a[236:239], a[152:155]
ds_read_b128 a[224:227], v10 offset:20480
ds_read_b128 a[228:231], v11 offset:20480
M a[152:155], a[176:179], a[232:235], a[152:155]
M a[156:159], a[184:187], a[232:235], a[156:159]
buffer_load_dword v23, s[8:11], s24 offen offset:256 lds
M a[156:159], a[188:191], a[236:239], a[156:159]
M a[160:163], a[196:199], a[236:239], a[160:163]
M a[160:163], a[192:195], a[232:235], a[160:163]
s_add_u32 m0, s29, 2048
s_nop 0
buffer_load_dwordx4 v2, s[8:11], s23 offen offset:0 lds
M a[164:167], a[176:179], a[240:243], a[164:167]
ds_read_b128 a[232:235], v10 offset:22528
ds_read_b128 a[236:239], v11 offset:22528
M a[164:167], a[180:183], a[244:247], a[164:167]
M a[168:171], a[188:191], a[244:247], a[168:171]
M a[168:171], a[184:187], a[240:243], a[168:171]
buffer_load_dwordx4 v3, s[8:11], s23 offen offset:1024 lds
M a[172:175], a[192:195], a[240:243], a[172:175]
M a[172:175], a[196:199], a[244:247], a[172:175]
s_waitcnt lgkmcnt(4)
M a[68:71], a[200:203], a[248:251], a[68:71]
ds_read_b128 a[240:243], v10 offset:24576
ds_read_b128 a[244:247], v11 offset:24576
M a[68:71], a[204:207], a[252:255], a[68:71]
buffer_load_dwordx4 v4, s[8:11], s23 offen offset:2048 lds
M a[72:75], a[212:215], a[252:255], a[72:75]
ds_read_b64_tr_b16 a[176:177], v14 offset:28672
ds_read_b64_tr_b16 a[178:179], v14 offset:30208
M a[72:75], a[208:211], a[248:251], a[72:75]
M a[76:79], a[216:219], a[248:251], a[76:79]
buffer_load_dwordx4 v5, s[8:11], s23 offen offset:3072 lds
M a[76:79], a[220:223], a[252:255], a[76:79]
s_waitcnt lgkmcnt(6)
M a[80:83], a[204:207], a[228:231], a[80:83]
ds_read_b128 a[248:251], v10 offset:26624
ds_read_b128 a[252:255], v11 offset:26624
M a[80:83], a[200:203], a[224:227], a[80:83]
M a[84:87], a[208:211], a[224:227], a[84:87]
ds_read_b64_tr_b16 a[184:185], v15 offset:28672
ds_read_b64_tr_b16 a[186:187], v15 offset:30208
M a[84:87], a[212:215], a[228:231], a[84:87]
s_sub_u32 s31, s31, 1
s_cmp_eq_u32 s31, 0
s_cselect_b32 s58, -1920, s57
s_add_u32 s23, s23, s58
s_add_u32 s24, s24, s58
M a[88:91], a[220:223], a[228:231], a[88:91]
M a[88:91], a[216:219], a[224:227], a[88:91]
s_waitcnt lgkmcnt(8)
M a[92:95], a[200:203], a[232:235], a[92:95]
ds_read_b128 a[224:227], v10 offset:28672
ds_read_b128 a[228:231], v11 offset:28672
M a[92:95], a[204:207], a[236:239], a[92:95]
s_add_u32 m0, s30, 36864
s_nop 0
buffer_load_dwordx4 v6, s[12:15], s25 offen offset:0 lds
M a[96:99], a[212:215], a[236:239], a[96:99]
ds_read_b64_tr_b16 a[192:193], v16 offset:28672
ds_read_b64_tr_b16 a[194:195], v16 offset:30208
M a[96:99], a[208:211], a[232:235], a[96:99]
M a[100:103], a[216:219], a[232:235], a[100:103]
buffer_load_dwordx4 v7, s[12:15], s25 offen offset:1024 lds
M a[100:103], a[220:223], a[236:239], a[100:103]
s_waitcnt lgkmcnt(10)
M a[104:107], a[204:207], a[244:247], a[104:107]
ds_read_b128 a[232:235], v10 offset:30720
ds_read_b128 a[236:239], v11 offset:30720
M a[104:107], a[200:203], a[240:243], a[104:107]
M a[108:111], a[208:211], a[240:243], a[108:111]
ds_read_b64_tr_b16 a[180:181], v14 offset:40960
ds_read_b64_tr_b16 a[182:183], v14 offset:42496
M a[108:111], a[212:215], a[244:247], a[108:111]
buffer_load_dwordx4 v8, s[12:15], s25 offen offset:2048 lds
M a[112:115], a[220:223], a[244:247], a[112:115]
M a[112:115], a[216:219], a[240:243], a[112:115]
s_waitcnt lgkmcnt(10)
M a[116:119], a[200:203], a[248:251], a[116:119]
ds_read_b128 a[240:243], v10 offset:32768
ds_read_b128 a[244:247], v11 offset:32768
M a[116:119], a[204:207], a[252:255], a[116:119]
buffer_load_dwordx4 v9, s[12:15], s25 offen offset:3072 lds
M a[120:123], a[212:215], a[252:255], a[120:123]
ds_read_b64_tr_b16 a[188:189], v15 offset:40960
ds_read_b64_tr_b16 a[190:191], v15 offset:42496
M a[120:123], a[208:211], a[248:251], a[120:123]
M a[124:127], a[216:219], a[248:251], a[124:127]
s_add_u32 m0, s30, 40960
s_nop 0
buffer_load_dwordx4 v21, s[12:15], s25 offen offset:0 lds
M a[124:127], a[220:223], a[252:255], a[124:127]
s_waitcnt lgkmcnt(10)
M a[128:131], a[204:207], a[228:231], a[128:131]
ds_read_b128 a[248:251], v10 offset:34816
ds_read_b128 a[252:255], v11 offset:34816
M a[128:131], a[200:203], a[224:227], a[128:131]
M a[132:135], a[208:211], a[224:227], a[132:135]
ds_read_b64_tr_b16 a[196:197], v16 offset:40960
ds_read_b64_tr_b16 a[198:199], v16 offset:42496
M a[132:135], a[212:215], a[228:231], a[132:135]
buffer_load_dwordx4 v22, s[12:15], s25 offen offset:1024 lds
M a[136:139], a[220:223], a[228:231], a[136:139]
M a[136:139], a[216:219], a[224:227], a[136:139]
s_waitcnt lgkmcnt(10)
M a[140:143], a[200:203], a[232:235], a[140:143]
s_sub_u32 s54, s54, 1
s_cmp_eq_u32 s54, 0
s_cselect_b32 s58, s55, s56
s_add_u32 s25, s25, s58
M a[140:143], a[204:207], a[236:239], a[140:143]
M a[144:147], a[212:215], a[236:239], a[144:147]
M a[144:147], a[208:211], a[232:235], a[144:147]
M a[148:151], a[216:219], a[232:235], a[148:151]
s_waitcnt vmcnt(12) lgkmcnt(0)
s_barrier
ds_read_b128 a[224:227], v12 offset:0
ds_read_b128 a[228:231], v13 offset:0
M a[148:151], a[220:223], a[236:239], a[148:151]
s_add_u32 m0, s28, 18432
s_nop 0
buffer_load_dword v20, s[8:11], s24 offen lds
M a[152:155], a[204:207], a[244:247], a[152:155]
ds_read_b128 a[232:235], v12 offset:2048
ds_read_b128 a[236:239], v13 offset:2048
M a[152:155], a[200:203], a[240:243], a[152:155]
M a[156:159], a[208:211], a[240:243], a[156:159]
buffer_load_dword v23, s[8:11], s24 offen offset:256 lds
M a[156:159], a[212:215], a[244:247], a[156:159]
M a[160:163], a[220:223], a[244:247], a[160:163]
M a[160:163], a[216:219], a[240:243], a[160:163]
s_add_u32 m0, s29, 20480
s_nop 0
buffer_load_dwordx4 v2, s[8:11], s23 offen offset:0 lds
M a[164:167], a[200:203], a[248:251], a[164:167]
ds_read_b128 a[240:243], v12 offset:4096
ds_read_b128 a[244:247], v13 offset:4096
M a[164:167], a[204:207], a[252:255], a[164:167]
M a[168:171], a[212:215], a[252:255], a[168:171]
M a[168:171], a[208:211], a[248:251], a[168:171]
buffer_load_dwordx4 v3, s[8:11], s23 offen offset:1024 lds
M a[172:175], a[216:219], a[248:251], a[172:175]
M a[172:175], a[220:223], a[252:255], a[172:175]
s_waitcnt lgkmcnt(4)
M a[68:71], a[176:179], a[224:227], a[68:71]
ds_read_b128 a[248:251], v12 offset:6144
ds_read_b128 a[252:255], v13 offset:6144
M a[68:71], a[180:183], a[228:231], a[68:71]
buffer_load_dwordx4 v4, s[8:11], s23 offen offset:2048 lds
M a[72:75], a[188:191], a[228:231], a[72:75]
ds_read_b64_tr_b16 a[200:201], v17 offset:0
ds_read_b64_tr_b16 a[202:203], v17 offset:1536
M a[72:75], a[184:187], a[224:227], a[72:75]
M a[76:79], a[192:195], a[224:227], a[76:79]
buffer_load_dwordx4 v5, s[8:11], s23 offen offset:3072 lds
M a[76:79], a[196:199], a[228:231], a[76:79]
s_waitcnt lgkmcnt(6)
M a[80:83], a[180:183], a[236:239], a[80:83]
ds_read_b128 a[224:227], v12 offset:8192
ds_read_b128 a[228:231], v13 offset:8192
M a[80:83], a[176:179], a[232:235], a[80:83]
s_sub_u32 s31, s31, 1
s_cmp_eq_u32 s31, 0
s_cselect_b32 s58, -1920, s57
s_add_u32 s23, s23, s58
s_add_u32 s24, s24, s58
M a[84:87], a[184:187], a[232:235], a[84:87]
ds_read_b64_tr_b16 a[208:209], v18 offset:0
ds_read_b64_tr_b16 a[210:211], v18 offset:1536
M a[84:87], a[188:191], a[236:239], a[84:87]
M a[88:91], a[196:199], a[236:239], a[88:91]
M a[88:91], a[192:195], a[232:235], a[88:91]
s_add_u32 m0, s30, 65536
s_nop 0
buffer_load_dwordx4 v6, s[12:15], s25 offen offset:0 lds
s_waitcnt lgkmcnt(8)
M a[92:95], a[176:179], a[240:243], a[92:95]
ds_read_b128 a[232:235], v12 offset:10240
ds_read_b128 a[236:239], v13 offset:10240
M a[92:95], a[180:183], a[244:247], a[92:95]
M a[96:99], a[188:191], a[244:247], a[96:99]
ds_read_b64_tr_b16 a[216:217], v19 offset:0
ds_read_b64_tr_b16 a[218:219], v19 offset:1536
M a[96:99], a[184:187], a[240:243], a[96:99]
buffer_load_dwordx4 v7, s[12:15], s25 offen offset:1024 lds
M a[100:103], a[192:195], a[240:243], a[100:103]
M a[100:103], a[196:199], a[244:247], a[100:103]
s_waitcnt lgkmcnt(10)
M a[104:107], a[180:183], a[252:255], a[104:107]
ds_read_b128 a[240:243], v12 offset:12288
ds_read_b128 a[244:247], v13 offset:12288
M a[104:107], a[176:179], a[248:251], a[104:107]
buffer_load_dwordx4 v8, s[12:15], s25 offen offset:2048 lds
M a[108:111], a[184:187], a[248:251], a[108:111]
ds_read_b64_tr_b16 a[204:205], v17 offset:12288
ds_read_b64_tr_b16 a[206:207], v17 offset:13824
M a[108:111], a[188:191], a[252:255], a[108:111]
M a[112:115], a[196:199], a[252:255], a[112:115]
buffer_load_dwordx4 v9, s[12:15], s25 offen offset:3072 lds
M a[112:115], a[192:195], a[248:251], a[112:115]
s_waitcnt lgkmcnt(10)
M a[116:119], a[176:179], a[224:227], a[116:119]
ds_read_b128 a[248:251], v12 offset:14336
ds_read_b128 a[252:255], v13 offset:14336
M a[116:119], a[180:183], a[228:231], a[116:119]
M a[120:123], a[188:191], a[228:231], a[120:123]
ds_read_b64_tr_b16 a[212:213], v18 offset:12288
ds_read_b64_tr_b16 a[214:215], v18 offset:13824
M a[120:123], a[184:187], a[224:227], a[120:123]
s_add_u32 m0, s30, 69632
s_nop 0
buffer_load_dwordx4 v21, s[12:15], s25 offen offset:0 lds
M a[124:127], a[192:195], a[224:227], a[124:127]
M a[124:127], a[196:199], a[228:231], a[124:127]
buffer_load_dwordx4 v22, s[12:15], s25 offen offset:1024 lds
s_waitcnt lgkmcnt(10)
M a[128:131], a[180:183], a[236:239], a[128:131]
ds_read_b128 a[224:227], v12 offset:16384
ds_read_b128 a[228:231], v13 offset:16384
M a[128:131], a[176:179], a[232:235], a[128:131]
M a[132:135], a[184:187], a[232:235], a[132:135]
ds_read_b64_tr_b16 a[220:221], v19 offset:12288
ds_read_b64_tr_b16 a[222:223], v19 offset:13824
M a[132:135], a[188:191], a[236:239], a[132:135]
M a[136:139], a[196:199], a[236:239], a[136:139]
s_sub_u32 s54, s54, 1
s_cmp_eq_u32 s54, 0
s_cselect_b32 s58, s55, s56
s_add_u32 s25, s25, s58
M a[136:139], a[192:195], a[232:235], a[136:139]
s_waitcnt lgkmcnt(10)
M a[140:143], a[176:179], a[240:243], a[140:143]
buffer_load_dword v125, v119, s[36:39], 0 offen sc1
M a[140:143], a[180:183], a[244:247], a[140:143]
M a[144:147], a[188:191], a[244:247], a[144:147]
M a[144:147], a[184:187], a[240:243], a[144:147]
M a[148:151], a[192:195], a[240:243], a[148:151]
s_waitcnt vmcnt(13) lgkmcnt(0)
s_barrier
ds_read_b128 a[232:235], v10 offset:0
ds_read_b128 a[236:239], v11 offset:0
s_waitcnt vmcnt(0)
v_cmp_gt_u32 vcc, 0x80, v125
s_nop 0
s_cbranch_vccnz Lk1_spinq
Lk1_gotq:
M a[148:151], a[196:199], a[244:247], a[148:151]
s_add_u32 m0, s28, 131072
s_nop 0
buffer_load_dword v20, s[8:11], s24 offen lds
M a[152:155], a[180:183], a[252:255], a[152:155]
ds_read_b128 a[240:243], v10 offset:2048
ds_read_b128 a[244:247], v11 offset:2048
M a[152:155], a[176:179], a[248:251], a[152:155]
M a[156:159], a[184:187], a[248:251], a[156:159]
buffer_load_dword v23, s[8:11], s24 offen offset:256 lds
M a[156:159], a[188:191], a[252:255], a[156:159]
M a[160:163], a[196:199], a[252:255], a[160:163]
M a[160:163], a[192:195], a[248:251], a[160:163]
s_add_u32 m0, s29, 133120
s_nop 0
buffer_load_dwordx4 v2, s[8:11], s23 offen offset:0 lds
M a[164:167], a[176:179], a[224:227], a[164:167]
ds_read_b128 a[248:251], v10 offset:4096
ds_read_b128 a[252:255], v11 offset:4096
M a[164:167], a[180:183], a[228:231], a[164:167]
M a[168:171], a[188:191], a[228:231], a[168:171]
M a[168:171], a[184:187], a[224:227], a[168:171]
buffer_load_dwordx4 v3, s[8:11], s23 offen offset:1024 lds
M a[172:175], a[192:195], a[224:227], a[172:175]
M a[172:175], a[196:199], a[228:231], a[172:175]
s_waitcnt lgkmcnt(4)
M a[68:71], a[200:203], a[232:235], a[68:71]
ds_read_b128 a[224:227], v10 offset:6144
ds_read_b128 a[228:231], v11 offset:6144
v_mov_b32 v208, 0
v_mov_b32 v209, 0
M a[68:71], a[204:207], a[236:239], a[68:71]
buffer_load_dwordx4 v4, s[8:11], s23 offen offset:2048 lds
M a[72:75], a[212:215], a[236:239], a[72:75]
ds_read_b64_tr_b16 a[176:177], v14 offset:0
ds_read_b64_tr_b16 a[178:179], v14 offset:1536
v_mov_b32 v210, 0
v_mov_b32 v211, 0
M a[72:75], a[208:211], a[232:235], a[72:75]
M a[76:79], a[216:219], a[232:235], a[76:79]
buffer_load_dwordx4 v5, s[8:11], s23 offen offset:3072 lds
v_mov_b32 v212, 0
v_mov_b32 v213, 0
M a[76:79], a[220:223], a[236:239], a[76:79]
s_waitcnt lgkmcnt(6)
M a[80:83], a[204:207], a[244:247], a[80:83]
ds_read_b128 a[232:235], v10 offset:8192
ds_read_b128 a[236:239], v11 offset:8192
v_mov_b32 v214, 0
v_mov_b32 v215, 0
M a[80:83], a[200:203], a[240:243], a[80:83]
s_sub_u32 s31, s31, 1
s_cmp_eq_u32 s31, 0
s_cselect_b32 s58, -1920, s57
s_add_u32 s23, s23, s58
s_add_u32 s24, s24, s58
M a[84:87], a[208:211], a[240:243], a[84:87]
ds_read_b64_tr_b16 a[184:185], v15 offset:0
ds_read_b64_tr_b16 a[186:187], v15 offset:1536
M a[84:87], a[212:215], a[244:247], a[84:87]
v_mov_b32 v216, 0
v_mov_b32 v217, 0
M a[88:91], a[220:223], a[244:247], a[88:91]
M a[88:91], a[216:219], a[240:243], a[88:91]
buffer_load_dwordx4 a[0:3], v1, s[44:47], s64 offen offset:0 sc1
s_waitcnt lgkmcnt(8)
v_mov_b32 v218, 0
v_mov_b32 v219, 0
M a[92:95], a[200:203], a[248:251], a[92:95]
ds_read_b128 a[240:243], v10 offset:10240
ds_read_b128 a[244:247], v11 offset:10240
M a[92:95], a[204:207], a[252:255], a[92:95]
v_mov_b32 v220, 0
v_mov_b32 v221, 0
M a[96:99], a[212:215], a[252:255], a[96:99]
ds_read_b64_tr_b16 a[192:193], v16 offset:0
ds_read_b64_tr_b16 a[194:195], v16 offset:1536
M a[96:99], a[208:211], a[248:251], a[96:99]
buffer_load_dwordx4 a[4:7], v1, s[44:47], s64 offen offset:1024 sc1
v_mov_b32 v222, 0
v_mov_b32 v223, 0
M a[100:103], a[216:219], a[248:251], a[100:103]
M a[100:103], a[220:223], a[252:255], a[100:103]
s_waitcnt lgkmcnt(10)
M a[104:107], a[204:207], a[228:231], a[104:107]
ds_read_b128 a[248:251], v10 offset:12288
ds_read_b128 a[252:255], v11 offset:12288
v_mov_b32 v224, 0
v_mov_b32 v225, 0
M a[104:107], a[200:203], a[224:227], a[104:107]
buffer_load_dwordx4 a[8:11], v1, s[44:47], s64 offen offset:2048 sc1
M a[108:111], a[208:211], a[224:227], a[108:111]
ds_read_b64_tr_b16 a[180:181], v14 offset:12288
ds_read_b64_tr_b16 a[182:183], v14 offset:13824
v_mov_b32 v226, 0
v_mov_b32 v227, 0
M a[108:111], a[212:215], a[228:231], a[108:111]
M a[112:115], a[220:223], a[228:231], a[112:115]
buffer_load_dwordx4 a[12:15], v1, s[44:47], s64 offen offset:3072 sc1
s_add_u32 s64, s64, 4096
v_mov_b32 v228, 0
v_mov_b32 v229, 0
M a[112:115], a[216:219], a[224:227], a[112:115]
s_waitcnt lgkmcnt(10)
M a[116:119], a[200:203], a[232:235], a[116:119]
ds_read_b128 a[224:227], v10 offset:14336
ds_read_b128 a[228:231], v11 offset:14336
v_mov_b32 v230, 0
v_mov_b32 v231, 0
M a[116:119], a[204:207], a[236:239], a[116:119]
M a[120:123], a[212:215], a[236:239], a[120:123]
ds_read_b64_tr_b16 a[188:189], v15 offset:12288
ds_read_b64_tr_b16 a[190:191], v15 offset:13824
M a[120:123], a[208:211], a[232:235], a[120:123]
buffer_load_dwordx4 a[16:19], v1, s[44:47], s64 offen offset:0 sc1
v_mov_b32 v232, 0
v_mov_b32 v233, 0
M a[124:127], a[216:219], a[232:235], a[124:127]
M a[124:127], a[220:223], a[236:239], a[124:127]
buffer_load_dwordx4 a[20:23], v1, s[44:47], s64 offen offset:1024 sc1
s_waitcnt lgkmcnt(10)
v_mov_b32 v234, 0
v_mov_b32 v235, 0
M a[128:131], a[204:207], a[244:247], a[128:131]
ds_read_b128 a[232:235], v10 offset:16384
ds_read_b128 a[236:239], v11 offset:16384
M a[128:131], a[200:203], a[240:243], a[128:131]
v_mov_b32 v236, 0
v_mov_b32 v237, 0
M a[132:135], a[208:211], a[240:243], a[132:135]
ds_read_b64_tr_b16 a[196:197], v16 offset:12288
ds_read_b64_tr_b16 a[198:199], v16 offset:13824
M a[132:135], a[212:215], a[244:247], a[132:135]
v_mov_b32 v238, 0
v_mov_b32 v239, 0
M a[136:139], a[220:223], a[244:247], a[136:139]
buffer_load_dwordx4 a[24:27], v1, s[44:47], s64 offen offset:2048 sc1
M a[136:139], a[216:219], a[240:243], a[136:139]
s_waitcnt lgkmcnt(10)
M a[140:143], a[200:203], a[248:251], a[140:143]
buffer_load_dwordx4 a[28:31], v1, s[44:47], s64 offen offset:3072 sc1
s_add_u32 s64, s64, 4096
v_mov_b32 v240, 0
v_mov_b32 v241, 0
M a[140:143], a[204:207], a[252:255], a[140:143]
M a[144:147], a[212:215], a[252:255], a[144:147]
v_mov_b32 v242, 0
v_mov_b32 v243, 0
M a[144:147], a[208:211], a[248:251], a[144:147]
M a[148:151], a[216:219], a[248:251], a[148:151]
s_waitcnt vmcnt(15) lgkmcnt(0)
s_barrier
ds_read_b128 a[240:243], v10 offset:18432
ds_read_b128 a[244:247], v11 offset:18432
v_mov_b32 v244, 0
v_mov_b32 v245, 0
M a[148:151], a[220:223], a[252:255], a[148:151]
buffer_load_dwordx4 a[32:35], v1, s[44:47], s64 offen offset:0 sc1
M a[152:155], a[204:207], a[228:231], a[152:155]
ds_read_b128 a[248:251], v10 offset:20480
ds_read_b128 a[252:255], v11 offset:20480
v_mov_b32 v246, 0
v_mov_b32 v247, 0
M a[152:155], a[200:203], a[224:227], a[152:155]
M a[156:159], a[208:211], a[224:227], a[156:159]
buffer_load_dwordx4 a[36:39], v1, s[44:47], s64 offen offset:1024 sc1
M a[156:159], a[212:215], a[228:231], a[156:159]
v_mov_b32 v248, 0
v_mov_b32 v249, 0
M a[160:163], a[220:223], a[228:231], a[160:163]
M a[160:163], a[216:219], a[224:227], a[160:163]
buffer_load_dwordx4 a[40:43], v1, s[44:47], s64 offen offset:2048 sc1
v_mov_b32 v250, 0
v_mov_b32 v251, 0
M a[164:167], a[200:203], a[232:235], a[164:167]
ds_read_b128 a[224:227], v10 offset:22528
ds_read_b128 a[228:231], v11 offset:22528
M a[164:167], a[204:207], a[236:239], a[164:167]
v_mov_b32 v252, 0
v_mov_b32 v253, 0
M a[168:171], a[212:215], a[236:239], a[168:171]
M a[168:171], a[208:211], a[232:235], a[168:171]
buffer_load_dwordx4 a[44:47], v1, s[44:47], s64 offen offset:3072 sc1
s_add_u32 s64, s64, 4096
v_mov_b32 v254, 0
v_mov_b32 v255, 0
M a[172:175], a[216:219], a[232:235], a[172:175]
M a[172:175], a[220:223], a[236:239], a[172:175]
s_waitcnt lgkmcnt(4)
M a[68:71], a[176:179], a[240:243], a[68:71]
ds_read_b128 a[232:235], v10 offset:24576
ds_read_b128 a[236:239], v11 offset:24576
s_mov_b32 s22, s101
s_and_b32 s23, s22, 1
M a[68:71], a[180:183], a[244:247], a[68:71]
buffer_load_dwordx4 a[48:51], v1, s[44:47], s64 offen offset:0 sc1
M a[72:75], a[188:191], a[244:247], a[72:75]
ds_read_b64_tr_b16 a[200:201], v14 offset:28672
ds_read_b64_tr_b16 a[202:203], v14 offset:30208
s_lshr_b32 s24, s22, 1
s_lshl_b32 s33, s24, 14
M a[72:75], a[184:187], a[240:243], a[72:75]
M a[76:79], a[192:195], a[240:243], a[76:79]
M a[76:79], a[196:199], a[244:247], a[76:79]
s_waitcnt lgkmcnt(6)
s_lshl_b32 s34, s23, 13
s_add_u32 s29, s33, s34
M a[80:83], a[180:183], a[252:255], a[80:83]
ds_read_b128 a[240:243], v10 offset:26624
ds_read_b128 a[244:247], v11 offset:26624
M a[80:83], a[176:179], a[248:251], a[80:83]
s_lshl_b32 s28, s20, 20
s_add_u32 s28, s28, s34
M a[84:87], a[184:187], a[248:251], a[84:87]
ds_read_b64_tr_b16 a[208:209], v15 offset:28672
ds_read_b64_tr_b16 a[210:211], v15 offset:30208
M a[84:87], a[188:191], a[252:255], a[84:87]
buffer_load_dwordx4 a[52:55], v1, s[44:47], s64 offen offset:1024 sc1
M a[88:91], a[196:199], a[252:255], a[88:91]
s_mov_b32 s25, s28
s_lshl_b32 s33, s21, 16
M a[88:91], a[192:195], a[248:251], a[88:91]
s_waitcnt lgkmcnt(8)
M a[92:95], a[176:179], a[224:227], a[92:95]
ds_read_b128 a[248:251], v10 offset:28672
ds_read_b128 a[252:255], v11 offset:28672
s_add_u32 s34, s28, s33
s_add_u32 s34, s34, 65536
M a[92:95], a[180:183], a[228:231], a[92:95]
M a[96:99], a[188:191], a[228:231], a[96:99]
ds_read_b64_tr_b16 a[216:217], v16 offset:28672
ds_read_b64_tr_b16 a[218:219], v16 offset:30208
M a[96:99], a[184:187], a[224:227], a[96:99]
s_add_u32 s32, s28, 491520
s_sub_u32 s33, s32, s33
M a[100:103], a[192:195], a[224:227], a[100:103]
buffer_load_dwordx4 a[56:59], v1, s[44:47], s64 offen offset:2048 sc1
M a[100:103], a[196:199], a[228:231], a[100:103]
s_waitcnt lgkmcnt(10)
s_add_u32 s33, s33, 491520
s_cmp_eq_u32 s24, 0
s_cselect_b32 s27, s34, s32
s_cselect_b32 s28, s32, s33
M a[104:107], a[180:183], a[236:239], a[104:107]
ds_read_b128 a[224:227], v10 offset:30720
ds_read_b128 a[228:231], v11 offset:30720
M a[104:107], a[176:179], a[232:235], a[104:107]
M a[108:111], a[184:187], a[232:235], a[108:111]
ds_read_b64_tr_b16 a[204:205], v14 offset:40960
ds_read_b64_tr_b16 a[206:207], v14 offset:42496
s_add_u32 s26, s25, 16384
s_add_u32 s62, s27, 16384
M a[108:111], a[188:191], a[236:239], a[108:111]
M a[112:115], a[196:199], a[236:239], a[112:115]
s_add_u32 s63, s28, 16384
s_lshl_b32 s31, s21, 7
M a[112:115], a[192:195], a[232:235], a[112:115]
s_waitcnt lgkmcnt(10)
M a[116:119], a[176:179], a[240:243], a[116:119]
ds_read_b128 a[232:235], v10 offset:32768
ds_read_b128 a[236:239], v11 offset:32768
M a[116:119], a[180:183], a[244:247], a[116:119]
buffer_load_dwordx4 a[60:63], v1, s[44:47], s64 offen offset:3072 sc1
s_cmp_eq_u32 s24, 0
s_cselect_b32 s31, s31, 960
M a[120:123], a[188:191], a[244:247], a[120:123]
ds_read_b64_tr_b16 a[212:213], v15 offset:40960
ds_read_b64_tr_b16 a[214:215], v15 offset:42496
M a[120:123], a[184:187], a[240:243], a[120:123]
s_mov_b32 s60, 0
s_add_u32 s12, s4, 16777216
s_addc_u32 s13, s5, 0
M a[124:127], a[192:195], a[240:243], a[124:127]
M a[124:127], a[196:199], a[244:247], a[124:127]
s_waitcnt lgkmcnt(10)
M a[128:131], a[180:183], a[252:255], a[128:131]
ds_read_b128 a[240:243], v10 offset:34816
ds_read_b128 a[244:247], v11 offset:34816
s_mov_b32 s14, 33554432
s_mov_b32 s15, 0x00020000
M a[128:131], a[176:179], a[248:251], a[128:131]
M a[132:135], a[184:187], a[248:251], a[132:135]
ds_read_b64_tr_b16 a[220:221], v16 offset:40960
ds_read_b64_tr_b16 a[222:223], v16 offset:42496
s_mov_b32 s8, s4
s_mov_b32 s9, s5
M a[132:135], a[188:191], a[252:255], a[132:135]
buffer_load_dword v126, v119, s[36:39], 0 offen offset:128 sc1
M a[136:139], a[196:199], a[252:255], a[136:139]
M a[136:139], a[192:195], a[248:251], a[136:139]
s_waitcnt lgkmcnt(10)
s_mov_b32 s10, 16777216
s_mov_b32 s11, 0x00020000
M a[140:143], a[176:179], a[224:227], a[140:143]
M a[140:143], a[180:183], a[228:231], a[140:143]
M a[144:147], a[188:191], a[228:231], a[144:147]
M a[144:147], a[184:187], a[224:227], a[144:147]
M a[148:151], a[192:195], a[224:227], a[148:151]
s_waitcnt vmcnt(17) lgkmcnt(0)
s_barrier
ds_read_b128 a[248:251], v12 offset:0
ds_read_b128 a[252:255], v13 offset:0
s_waitcnt vmcnt(0)
v_cmp_gt_u32 vcc, 0x80, v126
s_nop 0
s_cbranch_vccnz Lk1_spin
Lk1_got:
M a[148:151], a[196:199], a[228:231], a[148:151]
s_add_u32 m0, s29, 65536
s_add_u32 s32, s25, 4096
buffer_load_dwordx4 v1, s[12:15], s25 offen offset:0 sc1 lds
M a[152:155], a[180:183], a[236:239], a[152:155]
ds_read_b128 a[224:227], v12 offset:2048
ds_read_b128 a[228:231], v13 offset:2048
M a[152:155], a[176:179], a[232:235], a[152:155]
buffer_load_dwordx4 v1, s[12:15], s25 offen offset:1024 sc1 lds
M a[156:159], a[184:187], a[232:235], a[156:159]
M a[156:159], a[188:191], a[236:239], a[156:159]
buffer_load_dwordx4 v1, s[12:15], s25 offen offset:2048 sc1 lds
M a[160:163], a[196:199], a[236:239], a[160:163]
buffer_load_dwordx4 v1, s[12:15], s25 offen offset:3072 sc1 lds
M a[160:163], a[192:195], a[232:235], a[160:163]
M a[164:167], a[176:179], a[240:243], a[164:167]
ds_read_b128 a[232:235], v12 offset:4096
ds_read_b128 a[236:239], v13 offset:4096
M a[164:167], a[180:183], a[244:247], a[164:167]
s_add_u32 m0, s29, 69632
s_nop 0
buffer_load_dwordx4 v1, s[12:15], s32 offen offset:0 sc1 lds
M a[168:171], a[188:191], a[244:247], a[168:171]
buffer_load_dwordx4 v1, s[12:15], s32 offen offset:1024 sc1 lds
M a[168:171], a[184:187], a[240:243], a[168:171]
M a[172:175], a[192:195], a[240:243], a[172:175]
buffer_load_dwordx4 v1, s[12:15], s32 offen offset:2048 sc1 lds
M a[172:175], a[196:199], a[244:247], a[172:175]
s_waitcnt lgkmcnt(4)
M a[68:71], a[200:203], a[248:251], a[68:71]
ds_read_b128 a[240:243], v12 offset:6144
ds_read_b128 a[244:247], v13 offset:6144
M a[68:71], a[204:207], a[252:255], a[68:71]
buffer_load_dwordx4 v1, s[12:15], s32 offen offset:3072 sc1 lds
M a[72:75], a[212:215], a[252:255], a[72:75]
M a[72:75], a[208:211], a[248:251], a[72:75]
M a[76:79], a[216:219], a[248:251], a[76:79]
M a[76:79], a[220:223], a[252:255], a[76:79]
s_waitcnt lgkmcnt(4)
M a[80:83], a[204:207], a[228:231], a[80:83]
ds_read_b128 a[248:251], v12 offset:8192
ds_read_b128 a[252:255], v13 offset:8192
M a[80:83], a[200:203], a[224:227], a[80:83]
M a[84:87], a[208:211], a[224:227], a[84:87]
M a[84:87], a[212:215], a[228:231], a[84:87]
M a[88:91], a[220:223], a[228:231], a[88:91]
M a[88:91], a[216:219], a[224:227], a[88:91]
s_waitcnt lgkmcnt(4)
M a[92:95], a[200:203], a[232:235], a[92:95]
ds_read_b128 a[224:227], v12 offset:10240
ds_read_b128 a[228:231], v13 offset:10240
v_accvgpr_read_b32 v24, a68
v_accvgpr_read_b32 v25, a69
v_accvgpr_read_b32 v26, a70
M a[92:95], a[204:207], a[236:239], a[92:95]
v_accvgpr_read_b32 v27, a71
v_cvt_pk_bf16_f32 v24, v24, v25
v_cvt_pk_bf16_f32 v25, v26, v27
ds_write_b64 v124, v[24:25] offset:0
M a[96:99], a[212:215], a[236:239], a[96:99]
v_accvgpr_read_b32 v28, a72
v_accvgpr_read_b32 v29, a73
v_accvgpr_read_b32 v30, a74
M a[96:99], a[208:211], a[232:235], a[96:99]
v_accvgpr_read_b32 v31, a75
v_cvt_pk_bf16_f32 v28, v28, v29
v_cvt_pk_bf16_f32 v29, v30, v31
ds_write_b64 v124, v[28:29] offset:32
M a[100:103], a[216:219], a[232:235], a[100:103]
v_accvgpr_read_b32 v24, a76
v_accvgpr_read_b32 v25, a77
v_accvgpr_read_b32 v26, a78
M a[100:103], a[220:223], a[236:239], a[100:103]
s_waitcnt lgkmcnt(6)
v_accvgpr_read_b32 v27, a79
v_cvt_pk_bf16_f32 v24, v24, v25
v_cvt_pk_bf16_f32 v25, v26, v27
ds_write_b64 v124, v[24:25] offset:64
M a[104:107], a[204:207], a[244:247], a[104:107]
ds_read_b128 a[232:235], v12 offset:12288
ds_read_b128 a[236:239], v13 offset:12288
v_accvgpr_read_b32 v24, a80
v_accvgpr_read_b32 v25, a81
v_accvgpr_read_b32 v26, a82
M a[104:107], a[200:203], a[240:243], a[104:107]
v_accvgpr_read_b32 v27, a83
v_cvt_pk_bf16_f32 v24, v24, v25
v_cvt_pk_bf16_f32 v25, v26, v27
ds_write_b64 v124, v[24:25] offset:6400
M a[108:111], a[208:211], a[240:243], a[108:111]
v_accvgpr_read_b32 v28, a84
v_accvgpr_read_b32 v29, a85
v_accvgpr_read_b32 v30, a86
M a[108:111], a[212:215], a[244:247], a[108:111]
v_accvgpr_read_b32 v31, a87
v_cvt_pk_bf16_f32 v28, v28, v29
v_cvt_pk_bf16_f32 v29, v30, v31
ds_write_b64 v124, v[28:29] offset:6432
M a[112:115], a[220:223], a[244:247], a[112:115]
v_accvgpr_read_b32 v24, a88
v_accvgpr_read_b32 v25, a89
v_accvgpr_read_b32 v26, a90
M a[112:115], a[216:219], a[240:243], a[112:115]
s_waitcnt lgkmcnt(9)
v_accvgpr_read_b32 v27, a91
v_cvt_pk_bf16_f32 v24, v24, v25
v_cvt_pk_bf16_f32 v25, v26, v27
ds_write_b64 v124, v[24:25] offset:6464
M a[116:119], a[200:203], a[248:251], a[116:119]
ds_read_b128 a[240:243], v12 offset:14336
ds_read_b128 a[244:247], v13 offset:14336
v_accvgpr_read_b32 v24, a92
v_accvgpr_read_b32 v25, a93
v_accvgpr_read_b32 v26, a94
M a[116:119], a[204:207], a[252:255], a[116:119]
v_accvgpr_read_b32 v27, a95
v_cvt_pk_bf16_f32 v24, v24, v25
v_cvt_pk_bf16_f32 v25, v26, v27
ds_write_b64 v124, v[24:25] offset:12800
M a[120:123], a[212:215], a[252:255], a[120:123]
v_accvgpr_read_b32 v28, a96
v_accvgpr_read_b32 v29, a97
v_accvgpr_read_b32 v30, a98
M a[120:123], a[208:211], a[248:251], a[120:123]
v_accvgpr_read_b32 v31, a99
v_cvt_pk_bf16_f32 v28, v28, v29
v_cvt_pk_bf16_f32 v29, v30, v31
ds_write_b64 v124, v[28:29] offset:12832
M a[124:127], a[216:219], a[248:251], a[124:127]
v_accvgpr_read_b32 v24, a100
v_accvgpr_read_b32 v25, a101
v_accvgpr_read_b32 v26, a102
M a[124:127], a[220:223], a[252:255], a[124:127]
s_add_u32 s25, s25, 32768
s_cmp_eq_u32 s25, s27
s_cselect_b32 s25, s28, s25
s_cselect_b32 s27, -1, s27
s_waitcnt lgkmcnt(12)
v_accvgpr_read_b32 v27, a103
v_cvt_pk_bf16_f32 v24, v24, v25
v_cvt_pk_bf16_f32 v25, v26, v27
ds_write_b64 v124, v[24:25] offset:12864
M a[128:131], a[204:207], a[228:231], a[128:131]
ds_read_b128 a[248:251], v12 offset:16384
ds_read_b128 a[252:255], v13 offset:16384
v_accvgpr_read_b32 v24, a104
v_accvgpr_read_b32 v25, a105
v_accvgpr_read_b32 v26, a106
M a[128:131], a[200:203], a[224:227], a[128:131]
v_accvgpr_read_b32 v27, a107
v_cvt_pk_bf16_f32 v24, v24, v25
v_cvt_pk_bf16_f32 v25, v26, v27
ds_write_b64 v124, v[24:25] offset:19200
M a[132:135], a[208:211], a[224:227], a[132:135]
v_accvgpr_read_b32 v28, a108
v_accvgpr_read_b32 v29, a109
v_accvgpr_read_b32 v30, a110
M a[132:135], a[212:215], a[228:231], a[132:135]
v_accvgpr_read_b32 v31, a111
v_cvt_pk_bf16_f32 v28, v28, v29
v_cvt_pk_bf16_f32 v29, v30, v31
ds_write_b64 v124, v[28:29] offset:19232
M a[136:139], a[220:223], a[228:231], a[136:139]
v_accvgpr_read_b32 v24, a112
v_accvgpr_read_b32 v25, a113
v_accvgpr_read_b32 v26, a114
M a[136:139], a[216:219], a[224:227], a[136:139]
s_waitcnt lgkmcnt(12)
v_accvgpr_read_b32 v27, a115
v_cvt_pk_bf16_f32 v24, v24, v25
v_cvt_pk_bf16_f32 v25, v26, v27
ds_write_b64 v124, v[24:25] offset:19264
M a[140:143], a[200:203], a[232:235], a[140:143]
v_accvgpr_read_b32 v24, a116
v_accvgpr_read_b32 v25, a117
v_accvgpr_read_b32 v26, a118
M a[140:143], a[204:207], a[236:239], a[140:143]
v_accvgpr_read_b32 v27, a119
v_cvt_pk_bf16_f32 v24, v24, v25
v_cvt_pk_bf16_f32 v25, v26, v27
ds_write_b64 v124, v[24:25] offset:25600
M a[144:147], a[212:215], a[236:239], a[144:147]
v_accvgpr_read_b32 v28, a120
v_accvgpr_read_b32 v29, a121
v_accvgpr_read_b32 v30, a122
M a[144:147], a[208:211], a[232:235], a[144:147]
v_accvgpr_read_b32 v31, a123
v_cvt_pk_bf16_f32 v28, v28, v29
v_cvt_pk_bf16_f32 v29, v30, v31
ds_write_b64 v124, v[28:29] offset:25632
M a[148:151], a[216:219], a[232:235], a[148:151]
s_waitcnt lgkmcnt(0)
s_barrier
v_accvgpr_read_b32 v24, a124
v_accvgpr_read_b32 v25, a125
v_accvgpr_read_b32 v26, a126
M a[148:151], a[220:223], a[236:239], a[148:151]
v_accvgpr_read_b32 v27, a127
v_cvt_pk_bf16_f32 v24, v24, v25
v_cvt_pk_bf16_f32 v25, v26, v27
ds_write_b64 v124, v[24:25] offset:25664
v_accvgpr_read_b32 v24, a128
v_accvgpr_read_b32 v25, a129
v_accvgpr_read_b32 v26, a130
M a[152:155], a[204:207], a[244:247], a[152:155]
v_accvgpr_read_b32 v27, a131
v_cvt_pk_bf16_f32 v24, v24, v25
v_cvt_pk_bf16_f32 v25, v26, v27
M a[152:155], a[200:203], a[240:243], a[152:155]
ds_write_b64 v124, v[24:25] offset:32000
v_accvgpr_read_b32 v28, a132
v_accvgpr_read_b32 v29, a133
M a[156:159], a[208:211], a[240:243], a[156:159]
v_accvgpr_read_b32 v30, a134
v_accvgpr_read_b32 v31, a135
v_cvt_pk_bf16_f32 v28, v28, v29
M a[156:159], a[212:215], a[244:247], a[156:159]
v_cvt_pk_bf16_f32 v29, v30, v31
ds_write_b64 v124, v[28:29] offset:32032
v_accvgpr_read_b32 v24, a136
M a[160:163], a[220:223], a[244:247], a[160:163]
v_accvgpr_read_b32 v25, a137
v_accvgpr_read_b32 v26, a138
v_accvgpr_read_b32 v27, a139
M a[160:163], a[216:219], a[240:243], a[160:163]
v_cvt_pk_bf16_f32 v24, v24, v25
v_cvt_pk_bf16_f32 v25, v26, v27
ds_write_b64 v124, v[24:25] offset:32064
M a[164:167], a[200:203], a[248:251], a[164:167]
v_accvgpr_read_b32 v24, a140
v_accvgpr_read_b32 v25, a141
v_accvgpr_read_b32 v26, a142
M a[164:167], a[204:207], a[252:255], a[164:167]
v_accvgpr_read_b32 v27, a143
v_cvt_pk_bf16_f32 v24, v24, v25
v_cvt_pk_bf16_f32 v25, v26, v27
ds_write_b64 v124, v[24:25] offset:38400
M a[168:171], a[212:215], a[252:255], a[168:171]
v_accvgpr_read_b32 v28, a144
v_accvgpr_read_b32 v29, a145
v_accvgpr_read_b32 v30, a146
M a[168:171], a[208:211], a[248:251], a[168:171]
v_accvgpr_read_b32 v31, a147
v_cvt_pk_bf16_f32 v28, v28, v29
v_cvt_pk_bf16_f32 v29, v30, v31
ds_write_b64 v124, v[28:29] offset:38432
M a[172:175], a[216:219], a[248:251], a[172:175]
v_accvgpr_read_b32 v24, a148
v_accvgpr_read_b32 v25, a149
v_accvgpr_read_b32 v26, a150
M a[172:175], a[220:223], a[252:255], a[172:175]
v_accvgpr_read_b32 v27, a151
v_cvt_pk_bf16_f32 v24, v24, v25
v_cvt_pk_bf16_f32 v25, v26, v27
ds_write_b64 v124, v[24:25] offset:38464
s_mov_b64 s[44:45], s[42:43]
v_accvgpr_read_b32 v24, a152
v_accvgpr_read_b32 v25, a153
v_accvgpr_read_b32 v26, a154
v_accvgpr_read_b32 v27, a155
v_cvt_pk_bf16_f32 v24, v24, v25
v_cvt_pk_bf16_f32 v25, v26, v27
ds_write_b64 v124, v[24:25] offset:44800
v_accvgpr_read_b32 v28, a156
v_accvgpr_read_b32 v29, a157
v_accvgpr_read_b32 v30, a158
v_accvgpr_read_b32 v31, a159
v_cvt_pk_bf16_f32 v28, v28, v29
v_cvt_pk_bf16_f32 v29, v30, v31
ds_write_b64 v124, v[28:29] offset:44832
v_accvgpr_read_b32 v24, a160
v_accvgpr_read_b32 v25, a161
v_accvgpr_read_b32 v26, a162
v_accvgpr_read_b32 v27, a163
v_cvt_pk_bf16_f32 v24, v24, v25
v_cvt_pk_bf16_f32 v25, v26, v27
ds_write_b64 v124, v[24:25] offset:44864
v_accvgpr_read_b32 v24, a164
v_accvgpr_read_b32 v25, a165
v_accvgpr_read_b32 v26, a166
v_accvgpr_read_b32 v27, a167
v_cvt_pk_bf16_f32 v24, v24, v25
v_cvt_pk_bf16_f32 v25, v26, v27
ds_write_b64 v124, v[24:25] offset:51200
v_accvgpr_read_b32 v28, a168
v_accvgpr_read_b32 v29, a169
v_accvgpr_read_b32 v30, a170
v_accvgpr_read_b32 v31, a171
v_cvt_pk_bf16_f32 v28, v28, v29
v_cvt_pk_bf16_f32 v29, v30, v31
ds_write_b64 v124, v[28:29] offset:51232
v_accvgpr_read_b32 v24, a172
v_accvgpr_read_b32 v25, a173
v_accvgpr_read_b32 v26, a174
v_accvgpr_read_b32 v27, a175
v_cvt_pk_bf16_f32 v24, v24, v25
v_cvt_pk_bf16_f32 v25, v26, v27
ds_write_b64 v124, v[24:25] offset:51264
s_waitcnt lgkmcnt(0)
s_barrier
ds_read_b128 v[48:51], v121 offset:128
ds_read_b128 v[32:35], v120 offset:0
ds_read_b128 v[52:55], v120 offset:128
ds_read_b128 v[36:39], v120 offset:12800
ds_read_b128 v[56:59], v120 offset:12928
ds_read_b128 v[40:43], v120 offset:25600
ds_read_b128 v[60:63], v120 offset:25728
ds_read_b128 v[44:47], v120 offset:38400
ds_read_b128 v[64:67], v120 offset:38528
ds_read_b64_tr_b16 v[68:69], v123 offset:256
ds_read_b64_tr_b16 v[70:71], v122 offset:256
ds_read_b64_tr_b16 v[72:73], v122 offset:13056
ds_read_b64_tr_b16 v[74:75], v122 offset:25856
ds_read_b64_tr_b16 v[76:77], v122 offset:38656
ds_read_b64_tr_b16 v[78:79], v123 offset:288
ds_read_b64_tr_b16 v[80:81], v122 offset:288
ds_read_b64_tr_b16 v[82:83], v122 offset:13088
ds_read_b64_tr_b16 v[84:85], v122 offset:25888
ds_read_b64_tr_b16 v[86:87], v122 offset:38688
v_accvgpr_write_b32 a64, 0
v_accvgpr_write_b32 a65, 0
v_accvgpr_write_b32 a66, 0
v_accvgpr_write_b32 a67, 0
v_accvgpr_write_b32 a68, 0
v_accvgpr_write_b32 a69, 0
v_accvgpr_write_b32 a70, 0
v_accvgpr_write_b32 a71, 0
v_accvgpr_write_b32 a72, 0
v_accvgpr_write_b32 a73, 0
v_accvgpr_write_b32 a74, 0
v_accvgpr_write_b32 a75, 0
s_add_u32 m0, s29, 0
s_add_u32 s32, s25, 4096
buffer_load_dwordx4 v1, s[12:15], s25 offen offset:0 sc1 lds
v_accvgpr_write_b32 a76, 0
v_accvgpr_write_b32 a77, 0
v_accvgpr_write_b32 a78, 0
v_accvgpr_write_b32 a79, 0
v_accvgpr_write_b32 a80, 0
v_accvgpr_write_b32 a81, 0
v_accvgpr_write_b32 a82, 0
v_accvgpr_write_b32 a83, 0
v_accvgpr_write_b32 a84, 0
v_accvgpr_write_b32 a85, 0
v_accvgpr_write_b32 a86, 0
buffer_load_dwordx4 v1, s[12:15], s25 offen offset:1024 sc1 lds
v_accvgpr_write_b32 a87, 0
v_accvgpr_write_b32 a88, 0
v_accvgpr_write_b32 a89, 0
v_accvgpr_write_b32 a90, 0
v_accvgpr_write_b32 a91, 0
v_accvgpr_write_b32 a92, 0
v_accvgpr_write_b32 a93, 0
v_accvgpr_write_b32 a94, 0
v_accvgpr_write_b32 a95, 0
v_accvgpr_write_b32 a96, 0
buffer_load_dwordx4 v1, s[12:15], s25 offen offset:2048 sc1 lds
v_accvgpr_write_b32 a97, 0
v_accvgpr_write_b32 a98, 0
v_accvgpr_write_b32 a99, 0
v_accvgpr_write_b32 a100, 0
v_accvgpr_write_b32 a101, 0
v_accvgpr_write_b32 a102, 0
v_accvgpr_write_b32 a103, 0
v_accvgpr_write_b32 a104, 0
v_accvgpr_write_b32 a105, 0
v_accvgpr_write_b32 a106, 0
v_accvgpr_write_b32 a107, 0
buffer_load_dwordx4 v1, s[12:15], s25 offen offset:3072 sc1 lds
v_accvgpr_write_b32 a108, 0
v_accvgpr_write_b32 a109, 0
v_accvgpr_write_b32 a110, 0
v_accvgpr_write_b32 a111, 0
s_waitcnt lgkmcnt(15)
M v[88:91], v[48:51], v[32:35], v[152:155]
M v[92:95], v[52:55], v[32:35], v[148:151]
M v[96:99], v[52:55], v[36:39], v[144:147]
s_waitcnt lgkmcnt(14)
M v[100:103], v[56:59], v[36:39], v[148:151]
s_waitcnt lgkmcnt(13)
M v[104:107], v[56:59], v[40:43], v[144:147]
s_waitcnt lgkmcnt(12)
M v[108:111], v[60:63], v[40:43], v[148:151]
s_add_u32 m0, s29, 4096
s_nop 0
buffer_load_dwordx4 v1, s[12:15], s32 offen offset:0 sc1 lds
s_waitcnt lgkmcnt(11)
M v[112:115], v[60:63], v[44:47], v[144:147]
s_waitcnt lgkmcnt(10)
M v[116:119], v[64:67], v[44:47], v[148:151]
v_max3_f32 v136, v88, v89, v90
v_max3_f32 v136, v136, v91, v92
v_max3_f32 v136, v136, v93, v94
v_max_f32 v136, v136, v95
v_max3_f32 v137, v96, v97, v98
v_max3_f32 v137, v137, v99, v100
v_max3_f32 v137, v137, v101, v102
v_max_f32 v137, v137, v103
v_max3_f32 v138, v104, v105, v106
buffer_load_dwordx4 v1, s[12:15], s32 offen offset:1024 sc1 lds
v_max3_f32 v138, v138, v107, v108
v_max3_f32 v138, v138, v109, v110
v_max_f32 v138, v138, v111
v_max3_f32 v139, v112, v113, v114
v_max3_f32 v139, v139, v115, v116
v_max3_f32 v139, v139, v117, v118
v_max_f32 v139, v139, v119
v_mov_b32 v140, v136
v_mov_b32 v141, v137
v_mov_b32 v142, v138
buffer_load_dwordx4 v1, s[12:15], s32 offen offset:2048 sc1 lds
v_mov_b32 v143, v139
v_permlane16_swap_b32 v136, v140
v_permlane16_swap_b32 v137, v141
v_permlane16_swap_b32 v138, v142
v_permlane16_swap_b32 v139, v143
v_max_f32 v136, v136, v140
v_max_f32 v137, v137, v141
v_max_f32 v138, v138, v142
v_max_f32 v139, v139, v143
v_mov_b32 v140, v136
v_mov_b32 v141, v137
buffer_load_dwordx4 v1, s[12:15], s32 offen offset:3072 sc1 lds
v_mov_b32 v142, v138
v_mov_b32 v143, v139
v_permlane32_swap_b32 v136, v140
v_permlane32_swap_b32 v137, v141
v_permlane32_swap_b32 v138, v142
v_permlane32_swap_b32 v139, v143
v_max_f32 v136, v136, v140
v_max_f32 v137, v137, v141
v_max_f32 v138, v138, v142
v_max_f32 v139, v139, v143
s_add_u32 s25, s25, 32768
s_cmp_eq_u32 s25, s27
s_cselect_b32 s25, s28, s25
s_cselect_b32 s27, -1, s27
v_mul_f32 v136, s7, v136
v_mul_f32 v137, s7, v137
v_mul_f32 v138, s7, v138
v_mul_f32 v139, s7, v139
v_fma_f32 v88, v88, s7, -v136
v_fma_f32 v89, v89, s7, -v136
v_fma_f32 v90, v90, s7, -v136
v_fma_f32 v91, v91, s7, -v136
v_fma_f32 v92, v92, s7, -v136
v_fma_f32 v93, v93, s7, -v136
v_fma_f32 v94, v94, s7, -v136
s_add_u32 m0, s29, 32768
s_add_u32 s32, s26, 4096
buffer_load_dwordx4 v1, s[12:15], s26 offen offset:0 sc1 lds
v_fma_f32 v95, v95, s7, -v136
v_exp_f32 v88, v88
v_exp_f32 v89, v89
v_exp_f32 v90, v90
v_exp_f32 v91, v91
v_exp_f32 v92, v92
v_exp_f32 v93, v93
v_exp_f32 v94, v94
v_exp_f32 v95, v95
v_fma_f32 v96, v96, s7, -v137
v_fma_f32 v97, v97, s7, -v137
buffer_load_dwordx4 v1, s[12:15], s26 offen offset:1024 sc1 lds
v_fma_f32 v98, v98, s7, -v137
v_fma_f32 v99, v99, s7, -v137
v_fma_f32 v100, v100, s7, -v137
v_fma_f32 v101, v101, s7, -v137
v_fma_f32 v102, v102, s7, -v137
v_fma_f32 v103, v103, s7, -v137
v_exp_f32 v96, v96
v_exp_f32 v97, v97
v_exp_f32 v98, v98
v_exp_f32 v99, v99
buffer_load_dwordx4 v1, s[12:15], s26 offen offset:2048 sc1 lds
v_exp_f32 v100, v100
v_exp_f32 v101, v101
v_exp_f32 v102, v102
v_exp_f32 v103, v103
v_fma_f32 v104, v104, s7, -v138
v_fma_f32 v105, v105, s7, -v138
v_fma_f32 v106, v106, s7, -v138
v_fma_f32 v107, v107, s7, -v138
v_fma_f32 v108, v108, s7, -v138
v_fma_f32 v109, v109, s7, -v138
v_fma_f32 v110, v110, s7, -v138
buffer_load_dwordx4 v1, s[12:15], s26 offen offset:3072 sc1 lds
v_fma_f32 v111, v111, s7, -v138
v_exp_f32 v104, v104
v_exp_f32 v105, v105
v_exp_f32 v106, v106
v_exp_f32 v107, v107
v_exp_f32 v108, v108
v_exp_f32 v109, v109
v_exp_f32 v110, v110
v_exp_f32 v111, v111
v_fma_f32 v112, v112, s7, -v139
s_add_u32 m0, s29, 36864
s_nop 0
buffer_load_dwordx4 v1, s[12:15], s32 offen offset:0 sc1 lds
v_fma_f32 v113, v113, s7, -v139
v_fma_f32 v114, v114, s7, -v139
v_fma_f32 v115, v115, s7, -v139
v_fma_f32 v116, v116, s7, -v139
v_fma_f32 v117, v117, s7, -v139
v_fma_f32 v118, v118, s7, -v139
v_fma_f32 v119, v119, s7, -v139
v_exp_f32 v112, v112
v_exp_f32 v113, v113
v_exp_f32 v114, v114
v_exp_f32 v115, v115
buffer_load_dwordx4 v1, s[12:15], s32 offen offset:1024 sc1 lds
v_exp_f32 v116, v116
v_exp_f32 v117, v117
v_exp_f32 v118, v118
v_exp_f32 v119, v119
v_cvt_pk_bf16_f32 v88, v88, v89
v_cvt_pk_bf16_f32 v89, v90, v91
v_cvt_pk_bf16_f32 v90, v92, v93
v_cvt_pk_bf16_f32 v91, v94, v95
v_cvt_pk_bf16_f32 v96, v96, v97
v_cvt_pk_bf16_f32 v97, v98, v99
buffer_load_dwordx4 v1, s[12:15], s32 offen offset:2048 sc1 lds
v_cvt_pk_bf16_f32 v98, v100, v101
v_cvt_pk_bf16_f32 v99, v102, v103
v_cvt_pk_bf16_f32 v104, v104, v105
v_cvt_pk_bf16_f32 v105, v106, v107
v_cvt_pk_bf16_f32 v106, v108, v109
v_cvt_pk_bf16_f32 v107, v110, v111
v_cvt_pk_bf16_f32 v112, v112, v113
v_cvt_pk_bf16_f32 v113, v114, v115
v_cvt_pk_bf16_f32 v114, v116, v117
v_cvt_pk_bf16_f32 v115, v118, v119
M v[120:123], v[156:159], v[88:91], 0
buffer_load_dwordx4 v1, s[12:15], s32 offen offset:3072 sc1 lds
s_waitcnt lgkmcnt(8)
M v[32:35], v[68:71], v[88:91], 0
s_waitcnt lgkmcnt(3)
M v[36:39], v[78:81], v[88:91], 0
M v[124:127], v[156:159], v[96:99], 0
M v[40:43], v[70:73], v[96:99], 0
s_waitcnt lgkmcnt(2)
M v[44:47], v[80:83], v[96:99], 0
M v[128:131], v[156:159], v[104:107], 0
M v[48:51], v[72:75], v[104:107], 0
s_waitcnt lgkmcnt(1)
M v[52:55], v[82:85], v[104:107], 0
M v[132:135], v[156:159], v[112:115], 0
M v[56:59], v[74:77], v[112:115], 0
s_add_u32 s26, s26, 32768
s_cmp_eq_u32 s26, s62
s_cselect_b32 s26, s63, s26
s_cselect_b32 s62, -1, s62
s_waitcnt lgkmcnt(0)
M v[60:63], v[84:87], v[112:115], 0
v_rcp_f32 v120, v120
v_rcp_f32 v124, v124
v_rcp_f32 v128, v128
v_rcp_f32 v132, v132
v_pk_mul_f32 v[32:33], v[32:33], v[120:121] op_sel_hi:[1,0]
v_pk_mul_f32 v[34:35], v[34:35], v[120:121] op_sel_hi:[1,0]
v_pk_mul_f32 v[36:37], v[36:37], v[120:121] op_sel_hi:[1,0]
v_pk_mul_f32 v[38:39], v[38:39], v[120:121] op_sel_hi:[1,0]
v_cvt_pk_bf16_f32 v32, v32, v33
v_cvt_pk_bf16_f32 v33, v34, v35
v_cvt_pk_bf16_f32 v34, v36, v37
v_cvt_pk_bf16_f32 v35, v38, v39
s_add_u32 s3, s6, 0
buffer_store_dwordx4 v[32:35], v1, s[16:19], s3 offen sc1
v_pk_mul_f32 v[40:41], v[40:41], v[124:125] op_sel_hi:[1,0]
v_pk_mul_f32 v[42:43], v[42:43], v[124:125] op_sel_hi:[1,0]
v_pk_mul_f32 v[44:45], v[44:45], v[124:125] op_sel_hi:[1,0]
v_pk_mul_f32 v[46:47], v[46:47], v[124:125] op_sel_hi:[1,0]
v_cvt_pk_bf16_f32 v40, v40, v41
v_cvt_pk_bf16_f32 v41, v42, v43
v_cvt_pk_bf16_f32 v42, v44, v45
v_cvt_pk_bf16_f32 v43, v46, v47
s_add_u32 s3, s6, 2048
buffer_store_dwordx4 v[40:43], v1, s[16:19], s3 offen sc1
v_pk_mul_f32 v[48:49], v[48:49], v[128:129] op_sel_hi:[1,0]
v_pk_mul_f32 v[50:51], v[50:51], v[128:129] op_sel_hi:[1,0]
v_pk_mul_f32 v[52:53], v[52:53], v[128:129] op_sel_hi:[1,0]
v_pk_mul_f32 v[54:55], v[54:55], v[128:129] op_sel_hi:[1,0]
v_cvt_pk_bf16_f32 v48, v48, v49
v_cvt_pk_bf16_f32 v49, v50, v51
v_cvt_pk_bf16_f32 v50, v52, v53
v_cvt_pk_bf16_f32 v51, v54, v55
s_add_u32 s3, s6, 4096
buffer_store_dwordx4 v[48:51], v1, s[16:19], s3 offen sc1
v_pk_mul_f32 v[56:57], v[56:57], v[132:133] op_sel_hi:[1,0]
v_pk_mul_f32 v[58:59], v[58:59], v[132:133] op_sel_hi:[1,0]
v_pk_mul_f32 v[60:61], v[60:61], v[132:133] op_sel_hi:[1,0]
v_pk_mul_f32 v[62:63], v[62:63], v[132:133] op_sel_hi:[1,0]
v_cvt_pk_bf16_f32 v56, v56, v57
v_cvt_pk_bf16_f32 v57, v58, v59
v_cvt_pk_bf16_f32 v58, v60, v61
v_cvt_pk_bf16_f32 v59, v62, v63
s_add_u32 s3, s6, 6144
buffer_store_dwordx4 v[56:59], v1, s[16:19], s3 offen sc1
Lc2:
s_add_u32 s16, s4, 67108864
s_addc_u32 s17, s5, 0
s_mov_b32 s18, 16777216
s_mov_b32 s19, 0x00020000
s_add_u32 s52, s4, 100663296
s_addc_u32 s53, s5, 0
s_mov_b32 s54, 8404992
s_mov_b32 s55, 0x00020000
s_mov_b32 s46, 8388608
s_mov_b32 s47, 0x00020000
s_mov_b32 s50, 2097152
s_mov_b32 s51, 0x00020000
s_lshl_b32 s33, s24, 14
v_add_u32 v2, s33, v1
v_add_u32 v3, 0x10000, v2
v_and_b32 v8, 15, v0
v_bfe_u32 v9, v0, 4, 2
v_lshlrev_b32 v9, 2, v9
v_sub_u32 v8, v8, v9
v_mov_b32 v4, 0xf149f2ca
v_cmp_gt_i32 vcc, 0, v8
s_nop 1
v_cndmask_b32 v16, 0, v4, vcc
v_cmp_gt_i32 vcc, 1, v8
s_nop 1
v_cndmask_b32 v17, 0, v4, vcc
v_cmp_gt_i32 vcc, 2, v8
s_nop 1
v_cndmask_b32 v18, 0, v4, vcc
v_cmp_gt_i32 vcc, 3, v8
s_nop 1
v_cndmask_b32 v19, 0, v4, vcc
v_mov_b32 v8, 0x3f803f80
v_accvgpr_write_b32 a112, v8
v_accvgpr_write_b32 a113, v8
v_accvgpr_write_b32 a114, v8
v_accvgpr_write_b32 a115, v8
s_lshl_b32 s33, s23, 6
s_add_i32 s33, s33, s31
s_cmp_gt_i32 s33, 0
s_cselect_b32 s34, 0, 0xf149f2ca
s_cmp_lt_i32 s33, 0
s_cselect_b32 s33, 0xf149f2ca, 0
v_mov_b32 v20, s34
v_mov_b32 v21, s34
v_mov_b32 v22, s34
v_mov_b32 v23, s34
v_mov_b32 v28, s33
v_mov_b32 v29, s33
v_mov_b32 v30, s33
v_mov_b32 v31, s33
v_med3_f32 v24, v16, v20, v28
v_med3_f32 v25, v17, v20, v28
v_med3_f32 v26, v18, v20, v28
v_med3_f32 v27, v19, v20, v28
v_mov_b32 v5, 0
v_mov_b32 v6, 1
s_waitcnt vmcnt(20)
s_barrier
ds_read_b128 a[116:119], v3 offset:0
ds_read_b128 a[120:123], v3 offset:1024
ds_read_b128 a[124:127], v3 offset:2048
ds_read_b128 a[128:131], v3 offset:3072
ds_read_b128 a[132:135], v3 offset:4096
ds_read_b128 a[136:139], v3 offset:5120
ds_read_b128 a[140:143], v3 offset:6144
ds_read_b128 a[144:147], v3 offset:7168
s_waitcnt lgkmcnt(4)
M v[32:35], a[116:119], a[0:3], v[24:27]
M v[32:35], a[120:123], a[4:7], v[32:35]
ds_read_b128 a[148:151], v3 offset:8192
ds_read_b128 a[152:155], v3 offset:9216
M v[32:35], a[124:127], a[8:11], v[32:35]
M v[32:35], a[128:131], a[12:15], v[32:35]
M v[36:39], a[128:131], a[28:31], v[28:31]
M v[36:39], a[124:127], a[24:27], v[36:39]
M v[36:39], a[120:123], a[20:23], v[36:39]
M v[36:39], a[116:119], a[16:19], v[36:39]
M v[40:43], a[116:119], a[32:35], v[28:31]
M v[40:43], a[120:123], a[36:39], v[40:43]
ds_read_b128 a[156:159], v3 offset:10240
ds_read_b128 a[160:163], v3 offset:11264
M v[40:43], a[124:127], a[40:43], v[40:43]
M v[40:43], a[128:131], a[44:47], v[40:43]
M v[44:47], a[128:131], a[60:63], v[28:31]
M v[44:47], a[124:127], a[56:59], v[44:47]
M v[44:47], a[120:123], a[52:55], v[44:47]
M v[44:47], a[116:119], a[48:51], v[44:47]
s_waitcnt lgkmcnt(4)
M v[48:51], a[132:135], a[0:3], v[20:23]
M v[48:51], a[136:139], a[4:7], v[48:51]
ds_read_b128 a[164:167], v3 offset:12288
ds_read_b128 a[168:171], v3 offset:13312
M v[48:51], a[140:143], a[8:11], v[48:51]
M v[48:51], a[144:147], a[12:15], v[48:51]
M v[52:55], a[144:147], a[28:31], v[24:27]
M v[52:55], a[140:143], a[24:27], v[52:55]
M v[52:55], a[136:139], a[20:23], v[52:55]
M v[52:55], a[132:135], a[16:19], v[52:55]
M v[56:59], a[132:135], a[32:35], v[28:31]
M v[56:59], a[136:139], a[36:39], v[56:59]
ds_read_b128 a[172:175], v3 offset:14336
ds_read_b128 a[176:179], v3 offset:15360
M v[56:59], a[140:143], a[40:43], v[56:59]
M v[56:59], a[144:147], a[44:47], v[56:59]
M v[60:63], a[144:147], a[60:63], v[28:31]
M v[60:63], a[140:143], a[56:59], v[60:63]
M v[60:63], a[136:139], a[52:55], v[60:63]
M v[60:63], a[132:135], a[48:51], v[60:63]
s_waitcnt lgkmcnt(4)
M v[64:67], a[148:151], a[0:3], v[20:23]
M v[64:67], a[152:155], a[4:7], v[64:67]
M v[64:67], a[156:159], a[8:11], v[64:67]
M v[64:67], a[160:163], a[12:15], v[64:67]
M v[68:71], a[160:163], a[28:31], v[20:23]
M v[68:71], a[156:159], a[24:27], v[68:71]
M v[68:71], a[152:155], a[20:23], v[68:71]
M v[68:71], a[148:151], a[16:19], v[68:71]
M v[72:75], a[148:151], a[32:35], v[24:27]
M v[72:75], a[152:155], a[36:39], v[72:75]
M v[72:75], a[156:159], a[40:43], v[72:75]
M v[72:75], a[160:163], a[44:47], v[72:75]
M v[76:79], a[160:163], a[60:63], v[28:31]
M v[76:79], a[156:159], a[56:59], v[76:79]
s_waitcnt vmcnt(4) lgkmcnt(0)
s_barrier
ds_read_b128 a[116:119], v2 offset:0
ds_read_b128 a[120:123], v2 offset:1024
M v[76:79], a[152:155], a[52:55], v[76:79]
M v[76:79], a[148:151], a[48:51], v[76:79]
M v[80:83], a[164:167], a[0:3], v[20:23]
M v[80:83], a[168:171], a[4:7], v[80:83]
ds_read_b128 a[124:127], v2 offset:2048
ds_read_b128 a[128:131], v2 offset:3072
M v[80:83], a[172:175], a[8:11], v[80:83]
M v[80:83], a[176:179], a[12:15], v[80:83]
M v[84:87], a[176:179], a[28:31], v[20:23]
M v[84:87], a[172:175], a[24:27], v[84:87]
ds_read_b128 a[132:135], v2 offset:4096
ds_read_b128 a[136:139], v2 offset:5120
M v[84:87], a[168:171], a[20:23], v[84:87]
M v[84:87], a[164:167], a[16:19], v[84:87]
M v[88:91], a[164:167], a[32:35], v[20:23]
M v[88:91], a[168:171], a[36:39], v[88:91]
ds_read_b128 a[140:143], v2 offset:6144
ds_read_b128 a[144:147], v2 offset:7168
M v[88:91], a[172:175], a[40:43], v[88:91]
M v[88:91], a[176:179], a[44:47], v[88:91]
M v[92:95], a[176:179], a[60:63], v[24:27]
M v[92:95], a[172:175], a[56:59], v[92:95]
M v[92:95], a[168:171], a[52:55], v[92:95]
M v[92:95], a[164:167], a[48:51], v[92:95]
s_waitcnt vmcnt(0)
s_mov_b64 exec, 1
buffer_store_dword v6, v5, s[52:55], s65 offen sc1
s_mov_b64 exec, -1
v_exp_f32 v32, v32
v_exp_f32 v33, v33
v_exp_f32 v34, v34
v_exp_f32 v35, v35
v_exp_f32 v48, v48
v_exp_f32 v49, v49
v_exp_f32 v50, v50
v_exp_f32 v51, v51
v_cvt_pk_bf16_f32 v32, v32, v33
v_cvt_pk_bf16_f32 v33, v34, v35
v_exp_f32 v36, v36
v_exp_f32 v37, v37
v_exp_f32 v38, v38
v_exp_f32 v39, v39
v_cvt_pk_bf16_f32 v34, v48, v49
v_cvt_pk_bf16_f32 v35, v50, v51
v_exp_f32 v52, v52
v_exp_f32 v53, v53
v_exp_f32 v54, v54
v_exp_f32 v55, v55
v_cvt_pk_bf16_f32 v36, v36, v37
v_cvt_pk_bf16_f32 v37, v38, v39
v_exp_f32 v40, v40
v_exp_f32 v41, v41
v_exp_f32 v42, v42
v_exp_f32 v43, v43
v_cvt_pk_bf16_f32 v38, v52, v53
v_cvt_pk_bf16_f32 v39, v54, v55
v_exp_f32 v56, v56
v_exp_f32 v57, v57
v_exp_f32 v58, v58
v_exp_f32 v59, v59
v_cvt_pk_bf16_f32 v40, v40, v41
v_cvt_pk_bf16_f32 v41, v42, v43
v_exp_f32 v44, v44
v_exp_f32 v45, v45
v_exp_f32 v46, v46
v_exp_f32 v47, v47
v_cvt_pk_bf16_f32 v42, v56, v57
v_cvt_pk_bf16_f32 v43, v58, v59
v_exp_f32 v60, v60
v_exp_f32 v61, v61
v_exp_f32 v62, v62
v_exp_f32 v63, v63
v_cvt_pk_bf16_f32 v44, v44, v45
v_cvt_pk_bf16_f32 v45, v46, v47
v_cvt_pk_bf16_f32 v46, v60, v61
v_cvt_pk_bf16_f32 v47, v62, v63
s_cmp_eq_u32 s24, 1
s_cbranch_scc1 Lk2_g1
s_mov_b32 s30, s21
s_cmp_eq_u32 s21, 0
s_cbranch_scc1 Lk2_m2
Lk2_l1:
s_add_u32 m0, s29, 65536
s_waitcnt lgkmcnt(4)
M v[96:99], a[116:119], a[0:3], 0
v_exp_f32 v64, v64
M v[96:99], a[120:123], a[4:7], v[96:99]
ds_read_b128 a[148:151], v2 offset:8192
ds_read_b128 a[152:155], v2 offset:9216
M v[96:99], a[124:127], a[8:11], v[96:99]
v_exp_f32 v65, v65
M v[96:99], a[128:131], a[12:15], v[96:99]
buffer_load_dwordx4 v1, s[12:15], s25 offen offset:0 sc1 lds
s_add_u32 s32, s25, 4096
M v[100:103], a[128:131], a[28:31], 0
v_exp_f32 v66, v66
M v[100:103], a[124:127], a[24:27], v[100:103]
v_cvt_pk_bf16_f32 v64, v64, v65
M v[100:103], a[120:123], a[20:23], v[100:103]
v_exp_f32 v67, v67
M v[100:103], a[116:119], a[16:19], v[100:103]
buffer_load_dwordx4 v1, s[12:15], s25 offen offset:1024 sc1 lds
M v[104:107], a[116:119], a[32:35], 0
v_exp_f32 v80, v80
M v[104:107], a[120:123], a[36:39], v[104:107]
ds_read_b128 a[156:159], v2 offset:10240
ds_read_b128 a[160:163], v2 offset:11264
M v[104:107], a[124:127], a[40:43], v[104:107]
v_exp_f32 v81, v81
M v[104:107], a[128:131], a[44:47], v[104:107]
buffer_load_dwordx4 v1, s[12:15], s25 offen offset:2048 sc1 lds
M v[108:111], a[128:131], a[60:63], 0
v_exp_f32 v82, v82
M v[108:111], a[124:127], a[56:59], v[108:111]
v_cvt_pk_bf16_f32 v65, v66, v67
v_cvt_pk_bf16_f32 v66, v80, v81
M v[108:111], a[120:123], a[52:55], v[108:111]
v_exp_f32 v83, v83
M v[108:111], a[116:119], a[48:51], v[108:111]
buffer_load_dwordx4 v1, s[12:15], s25 offen offset:3072 sc1 lds
s_add_u32 m0, s29, 69632
s_waitcnt lgkmcnt(4)
M v[112:115], a[132:135], a[0:3], 0
v_exp_f32 v68, v68
M v[112:115], a[136:139], a[4:7], v[112:115]
ds_read_b128 a[164:167], v2 offset:12288
ds_read_b128 a[168:171], v2 offset:13312
M v[112:115], a[140:143], a[8:11], v[112:115]
v_exp_f32 v69, v69
M v[112:115], a[144:147], a[12:15], v[112:115]
buffer_load_dwordx4 v1, s[12:15], s32 offen offset:0 sc1 lds
M v[116:119], a[144:147], a[28:31], 0
v_exp_f32 v70, v70
M v[116:119], a[140:143], a[24:27], v[116:119]
v_cvt_pk_bf16_f32 v67, v82, v83
v_cvt_pk_bf16_f32 v68, v68, v69
M v[116:119], a[136:139], a[20:23], v[116:119]
v_exp_f32 v71, v71
M v[116:119], a[132:135], a[16:19], v[116:119]
buffer_load_dwordx4 v1, s[12:15], s32 offen offset:1024 sc1 lds
M v[120:123], a[132:135], a[32:35], 0
v_exp_f32 v84, v84
M v[120:123], a[136:139], a[36:39], v[120:123]
ds_read_b128 a[172:175], v2 offset:14336
ds_read_b128 a[176:179], v2 offset:15360
M v[120:123], a[140:143], a[40:43], v[120:123]
v_exp_f32 v85, v85
M v[120:123], a[144:147], a[44:47], v[120:123]
buffer_load_dwordx4 v1, s[12:15], s32 offen offset:2048 sc1 lds
M v[124:127], a[144:147], a[60:63], 0
v_exp_f32 v86, v86
M v[124:127], a[140:143], a[56:59], v[124:127]
v_cvt_pk_bf16_f32 v69, v70, v71
v_cvt_pk_bf16_f32 v70, v84, v85
M v[124:127], a[136:139], a[52:55], v[124:127]
v_exp_f32 v87, v87
M v[124:127], a[132:135], a[48:51], v[124:127]
buffer_load_dwordx4 v1, s[12:15], s32 offen offset:3072 sc1 lds
s_add_u32 m0, s29, 98304
s_waitcnt lgkmcnt(4)
M v[128:131], a[148:151], a[0:3], 0
v_exp_f32 v72, v72
M v[128:131], a[152:155], a[4:7], v[128:131]
ds_read_b128 a[116:119], v2 offset:32768
ds_read_b128 a[120:123], v2 offset:40960
M v[128:131], a[156:159], a[8:11], v[128:131]
v_exp_f32 v73, v73
M v[128:131], a[160:163], a[12:15], v[128:131]
buffer_load_dwordx4 v1, s[12:15], s26 offen offset:0 sc1 lds
s_add_u32 s43, s26, 4096
M v[132:135], a[160:163], a[28:31], 0
v_exp_f32 v74, v74
M v[132:135], a[156:159], a[24:27], v[132:135]
v_cvt_pk_bf16_f32 v71, v86, v87
v_cvt_pk_bf16_f32 v72, v72, v73
M v[132:135], a[152:155], a[20:23], v[132:135]
v_exp_f32 v75, v75
M v[132:135], a[148:151], a[16:19], v[132:135]
buffer_load_dwordx4 v1, s[12:15], s26 offen offset:1024 sc1 lds
M v[136:139], a[148:151], a[32:35], 0
v_exp_f32 v88, v88
M v[136:139], a[152:155], a[36:39], v[136:139]
ds_read_b128 a[124:127], v2 offset:33792
ds_read_b128 a[128:131], v2 offset:41984
M v[136:139], a[156:159], a[40:43], v[136:139]
v_exp_f32 v89, v89
M v[136:139], a[160:163], a[44:47], v[136:139]
buffer_load_dwordx4 v1, s[12:15], s26 offen offset:2048 sc1 lds
M v[140:143], a[160:163], a[60:63], 0
v_exp_f32 v90, v90
M v[140:143], a[156:159], a[56:59], v[140:143]
v_cvt_pk_bf16_f32 v73, v74, v75
v_cvt_pk_bf16_f32 v74, v88, v89
M v[140:143], a[152:155], a[52:55], v[140:143]
v_exp_f32 v91, v91
M v[140:143], a[148:151], a[48:51], v[140:143]
buffer_load_dwordx4 v1, s[12:15], s26 offen offset:3072 sc1 lds
s_add_u32 m0, s29, 102400
s_waitcnt lgkmcnt(4)
M v[144:147], a[164:167], a[0:3], 0
v_exp_f32 v76, v76
M v[144:147], a[168:171], a[4:7], v[144:147]
ds_read_b128 a[132:135], v2 offset:34816
ds_read_b128 a[136:139], v2 offset:43008
M v[144:147], a[172:175], a[8:11], v[144:147]
v_exp_f32 v77, v77
M v[144:147], a[176:179], a[12:15], v[144:147]
buffer_load_dwordx4 v1, s[12:15], s43 offen offset:0 sc1 lds
M v[148:151], a[176:179], a[28:31], 0
v_exp_f32 v78, v78
M v[148:151], a[172:175], a[24:27], v[148:151]
v_cvt_pk_bf16_f32 v75, v90, v91
v_cvt_pk_bf16_f32 v76, v76, v77
M v[148:151], a[168:171], a[20:23], v[148:151]
v_exp_f32 v79, v79
M v[148:151], a[164:167], a[16:19], v[148:151]
buffer_load_dwordx4 v1, s[12:15], s43 offen offset:1024 sc1 lds
M v[152:155], a[164:167], a[32:35], 0
v_exp_f32 v92, v92
M v[152:155], a[168:171], a[36:39], v[152:155]
ds_read_b128 a[140:143], v2 offset:35840
ds_read_b128 a[144:147], v2 offset:44032
M v[152:155], a[172:175], a[40:43], v[152:155]
v_exp_f32 v93, v93
M v[152:155], a[176:179], a[44:47], v[152:155]
buffer_load_dwordx4 v1, s[12:15], s43 offen offset:2048 sc1 lds
M v[156:159], a[176:179], a[60:63], 0
v_exp_f32 v94, v94
M v[156:159], a[172:175], a[56:59], v[156:159]
v_cvt_pk_bf16_f32 v77, v78, v79
v_cvt_pk_bf16_f32 v78, v92, v93
M v[156:159], a[168:171], a[52:55], v[156:159]
v_exp_f32 v95, v95
M v[156:159], a[164:167], a[48:51], v[156:159]
buffer_load_dwordx4 v1, s[12:15], s43 offen offset:3072 sc1 lds
v_cvt_pk_bf16_f32 v79, v94, v95
s_waitcnt lgkmcnt(6)
M v[160:163], a[116:119], v[32:35], v[160:163]
v_exp_f32 v96, v96
M v[160:163], a[120:123], v[64:67], v[160:163]
ds_read_b128 a[148:151], v2 offset:36864
ds_read_b128 a[152:155], v2 offset:45056
M v[164:167], a[120:123], v[68:71], v[164:167]
v_exp_f32 v97, v97
M v[164:167], a[116:119], v[36:39], v[164:167]
v_cvt_pk_bf16_f32 v96, v96, v97
M v[168:171], a[116:119], v[40:43], v[168:171]
v_exp_f32 v98, v98
M v[168:171], a[120:123], v[72:75], v[168:171]
s_add_u32 s25, s25, 32768
s_cmp_eq_u32 s25, s27
M v[172:175], a[120:123], v[76:79], v[172:175]
v_exp_f32 v99, v99
M v[172:175], a[116:119], v[44:47], v[172:175]
v_cvt_pk_bf16_f32 v97, v98, v99
s_waitcnt lgkmcnt(6)
M a[96:99], a[112:115], v[32:35], a[96:99]
s_cselect_b32 s25, s28, s25
s_cselect_b32 s27, -1, s27
M a[96:99], a[112:115], v[64:67], a[96:99]
s_add_u32 s26, s26, 32768
s_cmp_eq_u32 s26, s62
M v[176:179], a[124:127], v[32:35], v[176:179]
v_exp_f32 v112, v112
M v[176:179], a[128:131], v[64:67], v[176:179]
ds_read_b128 a[156:159], v2 offset:37888
ds_read_b128 a[160:163], v2 offset:46080
M v[180:183], a[128:131], v[68:71], v[180:183]
v_exp_f32 v113, v113
M v[180:183], a[124:127], v[36:39], v[180:183]
v_cvt_pk_bf16_f32 v98, v112, v113
M v[184:187], a[124:127], v[40:43], v[184:187]
v_exp_f32 v114, v114
M v[184:187], a[128:131], v[72:75], v[184:187]
s_cselect_b32 s26, s63, s26
s_cselect_b32 s62, -1, s62
M v[188:191], a[128:131], v[76:79], v[188:191]
v_exp_f32 v115, v115
M v[188:191], a[124:127], v[44:47], v[188:191]
v_cvt_pk_bf16_f32 v99, v114, v115
s_waitcnt lgkmcnt(6)
M a[100:103], a[112:115], v[36:39], a[100:103]
M a[100:103], a[112:115], v[68:71], a[100:103]
M v[192:195], a[132:135], v[32:35], v[192:195]
v_exp_f32 v100, v100
M v[192:195], a[136:139], v[64:67], v[192:195]
ds_read_b128 a[164:167], v2 offset:38912
ds_read_b128 a[168:171], v2 offset:47104
M v[196:199], a[136:139], v[68:71], v[196:199]
v_exp_f32 v101, v101
M v[196:199], a[132:135], v[36:39], v[196:199]
v_cvt_pk_bf16_f32 v100, v100, v101
M v[200:203], a[132:135], v[40:43], v[200:203]
v_exp_f32 v102, v102
M v[200:203], a[136:139], v[72:75], v[200:203]
M v[204:207], a[136:139], v[76:79], v[204:207]
v_exp_f32 v103, v103
M v[204:207], a[132:135], v[44:47], v[204:207]
v_cvt_pk_bf16_f32 v101, v102, v103
s_waitcnt lgkmcnt(6)
M a[104:107], a[112:115], v[40:43], a[104:107]
M a[104:107], a[112:115], v[72:75], a[104:107]
M v[208:211], a[140:143], v[32:35], v[208:211]
v_exp_f32 v116, v116
M v[208:211], a[144:147], v[64:67], v[208:211]
ds_read_b128 a[172:175], v2 offset:39936
ds_read_b128 a[176:179], v2 offset:48128
M v[212:215], a[144:147], v[68:71], v[212:215]
v_exp_f32 v117, v117
M v[212:215], a[140:143], v[36:39], v[212:215]
v_cvt_pk_bf16_f32 v102, v116, v117
M v[216:219], a[140:143], v[40:43], v[216:219]
v_exp_f32 v118, v118
M v[216:219], a[144:147], v[72:75], v[216:219]
M v[220:223], a[144:147], v[76:79], v[220:223]
v_exp_f32 v119, v119
M v[220:223], a[140:143], v[44:47], v[220:223]
v_cvt_pk_bf16_f32 v103, v118, v119
s_waitcnt lgkmcnt(6)
M a[108:111], a[112:115], v[44:47], a[108:111]
M a[108:111], a[112:115], v[76:79], a[108:111]
M v[224:227], a[148:151], v[32:35], v[224:227]
v_exp_f32 v104, v104
M v[224:227], a[152:155], v[64:67], v[224:227]
M v[228:231], a[152:155], v[68:71], v[228:231]
v_exp_f32 v105, v105
M v[228:231], a[148:151], v[36:39], v[228:231]
v_cvt_pk_bf16_f32 v104, v104, v105
M v[232:235], a[148:151], v[40:43], v[232:235]
v_exp_f32 v106, v106
M v[232:235], a[152:155], v[72:75], v[232:235]
M v[236:239], a[152:155], v[76:79], v[236:239]
v_exp_f32 v107, v107
M v[236:239], a[148:151], v[44:47], v[236:239]
v_cvt_pk_bf16_f32 v105, v106, v107
s_waitcnt lgkmcnt(4)
M v[240:243], a[156:159], v[32:35], v[240:243]
v_exp_f32 v120, v120
M v[240:243], a[160:163], v[64:67], v[240:243]
M v[244:247], a[160:163], v[68:71], v[244:247]
v_exp_f32 v121, v121
M v[244:247], a[156:159], v[36:39], v[244:247]
v_cvt_pk_bf16_f32 v106, v120, v121
M v[248:251], a[156:159], v[40:43], v[248:251]
v_exp_f32 v122, v122
M v[248:251], a[160:163], v[72:75], v[248:251]
s_waitcnt vmcnt(0) lgkmcnt(0)
s_barrier
ds_read_b128 a[116:119], v3 offset:0
ds_read_b128 a[120:123], v3 offset:1024
M v[252:255], a[160:163], v[76:79], v[252:255]
v_exp_f32 v123, v123
M v[252:255], a[156:159], v[44:47], v[252:255]
v_cvt_pk_bf16_f32 v107, v122, v123
M a[64:67], a[164:167], v[32:35], a[64:67]
v_exp_f32 v108, v108
M a[64:67], a[168:171], v[64:67], a[64:67]
ds_read_b128 a[124:127], v3 offset:2048
ds_read_b128 a[128:131], v3 offset:3072
M a[68:71], a[168:171], v[68:71], a[68:71]
v_exp_f32 v109, v109
M a[68:71], a[164:167], v[36:39], a[68:71]
v_cvt_pk_bf16_f32 v108, v108, v109
M a[72:75], a[164:167], v[40:43], a[72:75]
v_exp_f32 v110, v110
M a[72:75], a[168:171], v[72:75], a[72:75]
ds_read_b128 a[132:135], v3 offset:4096
ds_read_b128 a[136:139], v3 offset:5120
M a[76:79], a[168:171], v[76:79], a[76:79]
v_exp_f32 v111, v111
M a[76:79], a[164:167], v[44:47], a[76:79]
v_cvt_pk_bf16_f32 v109, v110, v111
M a[80:83], a[172:175], v[32:35], a[80:83]
v_exp_f32 v124, v124
M a[80:83], a[176:179], v[64:67], a[80:83]
ds_read_b128 a[140:143], v3 offset:6144
ds_read_b128 a[144:147], v3 offset:7168
M a[84:87], a[176:179], v[68:71], a[84:87]
v_exp_f32 v125, v125
M a[84:87], a[172:175], v[36:39], a[84:87]
v_cvt_pk_bf16_f32 v110, v124, v125
M a[88:91], a[172:175], v[40:43], a[88:91]
v_exp_f32 v126, v126
M a[88:91], a[176:179], v[72:75], a[88:91]
M a[92:95], a[176:179], v[76:79], a[92:95]
v_exp_f32 v127, v127
M a[92:95], a[172:175], v[44:47], a[92:95]
v_cvt_pk_bf16_f32 v111, v126, v127
s_sub_u32 s30, s30, 1
s_cmp_eq_u32 s30, 0
s_cbranch_scc1 Lk2_m1
s_add_u32 m0, s29, 0
s_waitcnt lgkmcnt(4)
M v[32:35], a[116:119], a[0:3], 0
v_exp_f32 v128, v128
M v[32:35], a[120:123], a[4:7], v[32:35]
ds_read_b128 a[148:151], v3 offset:8192
ds_read_b128 a[152:155], v3 offset:9216
M v[32:35], a[124:127], a[8:11], v[32:35]
v_exp_f32 v129, v129
M v[32:35], a[128:131], a[12:15], v[32:35]
buffer_load_dwordx4 v1, s[12:15], s25 offen offset:0 sc1 lds
s_add_u32 s32, s25, 4096
M v[36:39], a[128:131], a[28:31], 0
v_exp_f32 v130, v130
M v[36:39], a[124:127], a[24:27], v[36:39]
v_cvt_pk_bf16_f32 v128, v128, v129
M v[36:39], a[120:123], a[20:23], v[36:39]
v_exp_f32 v131, v131
M v[36:39], a[116:119], a[16:19], v[36:39]
buffer_load_dwordx4 v1, s[12:15], s25 offen offset:1024 sc1 lds
M v[40:43], a[116:119], a[32:35], 0
v_exp_f32 v144, v144
M v[40:43], a[120:123], a[36:39], v[40:43]
ds_read_b128 a[156:159], v3 offset:10240
ds_read_b128 a[160:163], v3 offset:11264
M v[40:43], a[124:127], a[40:43], v[40:43]
v_exp_f32 v145, v145
M v[40:43], a[128:131], a[44:47], v[40:43]
buffer_load_dwordx4 v1, s[12:15], s25 offen offset:2048 sc1 lds
M v[44:47], a[128:131], a[60:63], 0
v_exp_f32 v146, v146
M v[44:47], a[124:127], a[56:59], v[44:47]
v_cvt_pk_bf16_f32 v129, v130, v131
v_cvt_pk_bf16_f32 v130, v144, v145
M v[44:47], a[120:123], a[52:55], v[44:47]
v_exp_f32 v147, v147
M v[44:47], a[116:119], a[48:51], v[44:47]
buffer_load_dwordx4 v1, s[12:15], s25 offen offset:3072 sc1 lds
s_add_u32 m0, s29, 4096
s_waitcnt lgkmcnt(4)
M v[48:51], a[132:135], a[0:3], 0
v_exp_f32 v132, v132
M v[48:51], a[136:139], a[4:7], v[48:51]
ds_read_b128 a[164:167], v3 offset:12288
ds_read_b128 a[168:171], v3 offset:13312
M v[48:51], a[140:143], a[8:11], v[48:51]
v_exp_f32 v133, v133
M v[48:51], a[144:147], a[12:15], v[48:51]
buffer_load_dwordx4 v1, s[12:15], s32 offen offset:0 sc1 lds
M v[52:55], a[144:147], a[28:31], 0
v_exp_f32 v134, v134
M v[52:55], a[140:143], a[24:27], v[52:55]
v_cvt_pk_bf16_f32 v131, v146, v147
v_cvt_pk_bf16_f32 v132, v132, v133
M v[52:55], a[136:139], a[20:23], v[52:55]
v_exp_f32 v135, v135
M v[52:55], a[132:135], a[16:19], v[52:55]
buffer_load_dwordx4 v1, s[12:15], s32 offen offset:1024 sc1 lds
M v[56:59], a[132:135], a[32:35], 0
v_exp_f32 v148, v148
M v[56:59], a[136:139], a[36:39], v[56:59]
ds_read_b128 a[172:175], v3 offset:14336
ds_read_b128 a[176:179], v3 offset:15360
M v[56:59], a[140:143], a[40:43], v[56:59]
v_exp_f32 v149, v149
M v[56:59], a[144:147], a[44:47], v[56:59]
buffer_load_dwordx4 v1, s[12:15], s32 offen offset:2048 sc1 lds
M v[60:63], a[144:147], a[60:63], 0
v_exp_f32 v150, v150
M v[60:63], a[140:143], a[56:59], v[60:63]
v_cvt_pk_bf16_f32 v133, v134, v135
v_cvt_pk_bf16_f32 v134, v148, v149
M v[60:63], a[136:139], a[52:55], v[60:63]
v_exp_f32 v151, v151
M v[60:63], a[132:135], a[48:51], v[60:63]
buffer_load_dwordx4 v1, s[12:15], s32 offen offset:3072 sc1 lds
s_add_u32 m0, s29, 32768
s_waitcnt lgkmcnt(4)
M v[64:67], a[148:151], a[0:3], 0
v_exp_f32 v136, v136
M v[64:67], a[152:155], a[4:7], v[64:67]
ds_read_b128 a[116:119], v3 offset:32768
ds_read_b128 a[120:123], v3 offset:40960
M v[64:67], a[156:159], a[8:11], v[64:67]
v_exp_f32 v137, v137
M v[64:67], a[160:163], a[12:15], v[64:67]
buffer_load_dwordx4 v1, s[12:15], s26 offen offset:0 sc1 lds
s_add_u32 s43, s26, 4096
M v[68:71], a[160:163], a[28:31], 0
v_exp_f32 v138, v138
M v[68:71], a[156:159], a[24:27], v[68:71]
v_cvt_pk_bf16_f32 v135, v150, v151
v_cvt_pk_bf16_f32 v136, v136, v137
M v[68:71], a[152:155], a[20:23], v[68:71]
v_exp_f32 v139, v139
M v[68:71], a[148:151], a[16:19], v[68:71]
buffer_load_dwordx4 v1, s[12:15], s26 offen offset:1024 sc1 lds
M v[72:75], a[148:151], a[32:35], 0
v_exp_f32 v152, v152
M v[72:75], a[152:155], a[36:39], v[72:75]
ds_read_b128 a[124:127], v3 offset:33792
ds_read_b128 a[128:131], v3 offset:41984
M v[72:75], a[156:159], a[40:43], v[72:75]
v_exp_f32 v153, v153
M v[72:75], a[160:163], a[44:47], v[72:75]
buffer_load_dwordx4 v1, s[12:15], s26 offen offset:2048 sc1 lds
M v[76:79], a[160:163], a[60:63], 0
v_exp_f32 v154, v154
M v[76:79], a[156:159], a[56:59], v[76:79]
v_cvt_pk_bf16_f32 v137, v138, v139
v_cvt_pk_bf16_f32 v138, v152, v153
M v[76:79], a[152:155], a[52:55], v[76:79]
v_exp_f32 v155, v155
M v[76:79], a[148:151], a[48:51], v[76:79]
buffer_load_dwordx4 v1, s[12:15], s26 offen offset:3072 sc1 lds
s_add_u32 m0, s29, 36864
s_waitcnt lgkmcnt(4)
M v[80:83], a[164:167], a[0:3], 0
v_exp_f32 v140, v140
M v[80:83], a[168:171], a[4:7], v[80:83]
ds_read_b128 a[132:135], v3 offset:34816
ds_read_b128 a[136:139], v3 offset:43008
M v[80:83], a[172:175], a[8:11], v[80:83]
v_exp_f32 v141, v141
M v[80:83], a[176:179], a[12:15], v[80:83]
buffer_load_dwordx4 v1, s[12:15], s43 offen offset:0 sc1 lds
M v[84:87], a[176:179], a[28:31], 0
v_exp_f32 v142, v142
M v[84:87], a[172:175], a[24:27], v[84:87]
v_cvt_pk_bf16_f32 v139, v154, v155
v_cvt_pk_bf16_f32 v140, v140, v141
M v[84:87], a[168:171], a[20:23], v[84:87]
v_exp_f32 v143, v143
M v[84:87], a[164:167], a[16:19], v[84:87]
buffer_load_dwordx4 v1, s[12:15], s43 offen offset:1024 sc1 lds
M v[88:91], a[164:167], a[32:35], 0
v_exp_f32 v156, v156
M v[88:91], a[168:171], a[36:39], v[88:91]
ds_read_b128 a[140:143], v3 offset:35840
ds_read_b128 a[144:147], v3 offset:44032
M v[88:91], a[172:175], a[40:43], v[88:91]
v_exp_f32 v157, v157
M v[88:91], a[176:179], a[44:47], v[88:91]
buffer_load_dwordx4 v1, s[12:15], s43 offen offset:2048 sc1 lds
M v[92:95], a[176:179], a[60:63], 0
v_exp_f32 v158, v158
M v[92:95], a[172:175], a[56:59], v[92:95]
v_cvt_pk_bf16_f32 v141, v142, v143
v_cvt_pk_bf16_f32 v142, v156, v157
M v[92:95], a[168:171], a[52:55], v[92:95]
v_exp_f32 v159, v159
M v[92:95], a[164:167], a[48:51], v[92:95]
buffer_load_dwordx4 v1, s[12:15], s43 offen offset:3072 sc1 lds
v_cvt_pk_bf16_f32 v143, v158, v159
s_waitcnt lgkmcnt(6)
M v[160:163], a[116:119], v[96:99], v[160:163]
v_exp_f32 v32, v32
M v[160:163], a[120:123], v[128:131], v[160:163]
ds_read_b128 a[148:151], v3 offset:36864
ds_read_b128 a[152:155], v3 offset:45056
M v[164:167], a[120:123], v[132:135], v[164:167]
v_exp_f32 v33, v33
M v[164:167], a[116:119], v[100:103], v[164:167]
v_cvt_pk_bf16_f32 v32, v32, v33
M v[168:171], a[116:119], v[104:107], v[168:171]
v_exp_f32 v34, v34
M v[168:171], a[120:123], v[136:139], v[168:171]
s_add_u32 s25, s25, 32768
s_cmp_eq_u32 s25, s27
M v[172:175], a[120:123], v[140:143], v[172:175]
v_exp_f32 v35, v35
M v[172:175], a[116:119], v[108:111], v[172:175]
v_cvt_pk_bf16_f32 v33, v34, v35
s_waitcnt lgkmcnt(6)
M a[96:99], a[112:115], v[96:99], a[96:99]
s_cselect_b32 s25, s28, s25
s_cselect_b32 s27, -1, s27
M a[96:99], a[112:115], v[128:131], a[96:99]
s_add_u32 s26, s26, 32768
s_cmp_eq_u32 s26, s62
M v[176:179], a[124:127], v[96:99], v[176:179]
v_exp_f32 v48, v48
M v[176:179], a[128:131], v[128:131], v[176:179]
ds_read_b128 a[156:159], v3 offset:37888
ds_read_b128 a[160:163], v3 offset:46080
M v[180:183], a[128:131], v[132:135], v[180:183]
v_exp_f32 v49, v49
M v[180:183], a[124:127], v[100:103], v[180:183]
v_cvt_pk_bf16_f32 v34, v48, v49
M v[184:187], a[124:127], v[104:107], v[184:187]
v_exp_f32 v50, v50
M v[184:187], a[128:131], v[136:139], v[184:187]
s_cselect_b32 s26, s63, s26
s_cselect_b32 s62, -1, s62
M v[188:191], a[128:131], v[140:143], v[188:191]
v_exp_f32 v51, v51
M v[188:191], a[124:127], v[108:111], v[188:191]
v_cvt_pk_bf16_f32 v35, v50, v51
s_waitcnt lgkmcnt(6)
M a[100:103], a[112:115], v[100:103], a[100:103]
M a[100:103], a[112:115], v[132:135], a[100:103]
M v[192:195], a[132:135], v[96:99], v[192:195]
v_exp_f32 v36, v36
M v[192:195], a[136:139], v[128:131], v[192:195]
ds_read_b128 a[164:167], v3 offset:38912
ds_read_b128 a[168:171], v3 offset:47104
M v[196:199], a[136:139], v[132:135], v[196:199]
v_exp_f32 v37, v37
M v[196:199], a[132:135], v[100:103], v[196:199]
v_cvt_pk_bf16_f32 v36, v36, v37
M v[200:203], a[132:135], v[104:107], v[200:203]
v_exp_f32 v38, v38
M v[200:203], a[136:139], v[136:139], v[200:203]
M v[204:207], a[136:139], v[140:143], v[204:207]
v_exp_f32 v39, v39
M v[204:207], a[132:135], v[108:111], v[204:207]
v_cvt_pk_bf16_f32 v37, v38, v39
s_waitcnt lgkmcnt(6)
M a[104:107], a[112:115], v[104:107], a[104:107]
M a[104:107], a[112:115], v[136:139], a[104:107]
M v[208:211], a[140:143], v[96:99], v[208:211]
v_exp_f32 v52, v52
M v[208:211], a[144:147], v[128:131], v[208:211]
ds_read_b128 a[172:175], v3 offset:39936
ds_read_b128 a[176:179], v3 offset:48128
M v[212:215], a[144:147], v[132:135], v[212:215]
v_exp_f32 v53, v53
M v[212:215], a[140:143], v[100:103], v[212:215]
v_cvt_pk_bf16_f32 v38, v52, v53
M v[216:219], a[140:143], v[104:107], v[216:219]
v_exp_f32 v54, v54
M v[216:219], a[144:147], v[136:139], v[216:219]
M v[220:223], a[144:147], v[140:143], v[220:223]
v_exp_f32 v55, v55
M v[220:223], a[140:143], v[108:111], v[220:223]
v_cvt_pk_bf16_f32 v39, v54, v55
s_waitcnt lgkmcnt(6)
M a[108:111], a[112:115], v[108:111], a[108:111]
M a[108:111], a[112:115], v[140:143], a[108:111]
M v[224:227], a[148:151], v[96:99], v[224:227]
v_exp_f32 v40, v40
M v[224:227], a[152:155], v[128:131], v[224:227]
M v[228:231], a[152:155], v[132:135], v[228:231]
v_exp_f32 v41, v41
M v[228:231], a[148:151], v[100:103], v[228:231]
v_cvt_pk_bf16_f32 v40, v40, v41
M v[232:235], a[148:151], v[104:107], v[232:235]
v_exp_f32 v42, v42
M v[232:235], a[152:155], v[136:139], v[232:235]
M v[236:239], a[152:155], v[140:143], v[236:239]
v_exp_f32 v43, v43
M v[236:239], a[148:151], v[108:111], v[236:239]
v_cvt_pk_bf16_f32 v41, v42, v43
s_waitcnt lgkmcnt(4)
M v[240:243], a[156:159], v[96:99], v[240:243]
v_exp_f32 v56, v56
M v[240:243], a[160:163], v[128:131], v[240:243]
M v[244:247], a[160:163], v[132:135], v[244:247]
v_exp_f32 v57, v57
M v[244:247], a[156:159], v[100:103], v[244:247]
v_cvt_pk_bf16_f32 v42, v56, v57
M v[248:251], a[156:159], v[104:107], v[248:251]
v_exp_f32 v58, v58
M v[248:251], a[160:163], v[136:139], v[248:251]
s_waitcnt vmcnt(0) lgkmcnt(0)
s_barrier
ds_read_b128 a[116:119], v2 offset:0
ds_read_b128 a[120:123], v2 offset:1024
M v[252:255], a[160:163], v[140:143], v[252:255]
v_exp_f32 v59, v59
M v[252:255], a[156:159], v[108:111], v[252:255]
v_cvt_pk_bf16_f32 v43, v58, v59
M a[64:67], a[164:167], v[96:99], a[64:67]
v_exp_f32 v44, v44
M a[64:67], a[168:171], v[128:131], a[64:67]
ds_read_b128 a[124:127], v2 offset:2048
ds_read_b128 a[128:131], v2 offset:3072
M a[68:71], a[168:171], v[132:135], a[68:71]
v_exp_f32 v45, v45
M a[68:71], a[164:167], v[100:103], a[68:71]
v_cvt_pk_bf16_f32 v44, v44, v45
M a[72:75], a[164:167], v[104:107], a[72:75]
v_exp_f32 v46, v46
M a[72:75], a[168:171], v[136:139], a[72:75]
ds_read_b128 a[132:135], v2 offset:4096
ds_read_b128 a[136:139], v2 offset:5120
M a[76:79], a[168:171], v[140:143], a[76:79]
v_exp_f32 v47, v47
M a[76:79], a[164:167], v[108:111], a[76:79]
v_cvt_pk_bf16_f32 v45, v46, v47
M a[80:83], a[172:175], v[96:99], a[80:83]
v_exp_f32 v60, v60
M a[80:83], a[176:179], v[128:131], a[80:83]
ds_read_b128 a[140:143], v2 offset:6144
ds_read_b128 a[144:147], v2 offset:7168
M a[84:87], a[176:179], v[132:135], a[84:87]
v_exp_f32 v61, v61
M a[84:87], a[172:175], v[100:103], a[84:87]
v_cvt_pk_bf16_f32 v46, v60, v61
M a[88:91], a[172:175], v[104:107], a[88:91]
v_exp_f32 v62, v62
M a[88:91], a[176:179], v[136:139], a[88:91]
M a[92:95], a[176:179], v[140:143], a[92:95]
v_exp_f32 v63, v63
M a[92:95], a[172:175], v[108:111], a[92:95]
v_cvt_pk_bf16_f32 v47, v62, v63
s_branch Lk2_l1
Lk2_m1:
s_lshl_b32 s33, s23, 6
s_add_i32 s33, s33, 0
s_cmp_gt_i32 s33, 0
s_cselect_b32 s34, 0, 0xf149f2ca
s_cmp_lt_i32 s33, 0
s_cselect_b32 s33, 0xf149f2ca, 0
v_mov_b32 v20, s34
v_mov_b32 v21, s34
v_mov_b32 v22, s34
v_mov_b32 v23, s34
v_mov_b32 v28, s33
v_mov_b32 v29, s33
v_mov_b32 v30, s33
v_mov_b32 v31, s33
v_med3_f32 v24, v16, v20, v28
v_med3_f32 v25, v17, v20, v28
v_med3_f32 v26, v18, v20, v28
v_med3_f32 v27, v19, v20, v28
s_add_u32 m0, s29, 0
s_waitcnt lgkmcnt(4)
M v[32:35], a[116:119], a[0:3], v[24:27]
v_exp_f32 v128, v128
M v[32:35], a[120:123], a[4:7], v[32:35]
ds_read_b128 a[148:151], v3 offset:8192
ds_read_b128 a[152:155], v3 offset:9216
M v[32:35], a[124:127], a[8:11], v[32:35]
v_exp_f32 v129, v129
M v[32:35], a[128:131], a[12:15], v[32:35]
buffer_load_dwordx4 v1, s[12:15], s25 offen offset:0 sc1 lds
s_add_u32 s32, s25, 4096
M v[36:39], a[128:131], a[28:31], v[28:31]
v_exp_f32 v130, v130
M v[36:39], a[124:127], a[24:27], v[36:39]
v_cvt_pk_bf16_f32 v128, v128, v129
M v[36:39], a[120:123], a[20:23], v[36:39]
v_exp_f32 v131, v131
M v[36:39], a[116:119], a[16:19], v[36:39]
buffer_load_dwordx4 v1, s[12:15], s25 offen offset:1024 sc1 lds
M v[40:43], a[116:119], a[32:35], v[28:31]
v_exp_f32 v144, v144
M v[40:43], a[120:123], a[36:39], v[40:43]
ds_read_b128 a[156:159], v3 offset:10240
ds_read_b128 a[160:163], v3 offset:11264
M v[40:43], a[124:127], a[40:43], v[40:43]
v_exp_f32 v145, v145
M v[40:43], a[128:131], a[44:47], v[40:43]
buffer_load_dwordx4 v1, s[12:15], s25 offen offset:2048 sc1 lds
M v[44:47], a[128:131], a[60:63], v[28:31]
v_exp_f32 v146, v146
M v[44:47], a[124:127], a[56:59], v[44:47]
v_cvt_pk_bf16_f32 v129, v130, v131
v_cvt_pk_bf16_f32 v130, v144, v145
M v[44:47], a[120:123], a[52:55], v[44:47]
v_exp_f32 v147, v147
M v[44:47], a[116:119], a[48:51], v[44:47]
buffer_load_dwordx4 v1, s[12:15], s25 offen offset:3072 sc1 lds
s_add_u32 m0, s29, 4096
s_waitcnt lgkmcnt(4)
M v[48:51], a[132:135], a[0:3], v[20:23]
v_exp_f32 v132, v132
M v[48:51], a[136:139], a[4:7], v[48:51]
ds_read_b128 a[164:167], v3 offset:12288
ds_read_b128 a[168:171], v3 offset:13312
M v[48:51], a[140:143], a[8:11], v[48:51]
v_exp_f32 v133, v133
M v[48:51], a[144:147], a[12:15], v[48:51]
buffer_load_dwordx4 v1, s[12:15], s32 offen offset:0 sc1 lds
M v[52:55], a[144:147], a[28:31], v[24:27]
v_exp_f32 v134, v134
M v[52:55], a[140:143], a[24:27], v[52:55]
v_cvt_pk_bf16_f32 v131, v146, v147
v_cvt_pk_bf16_f32 v132, v132, v133
M v[52:55], a[136:139], a[20:23], v[52:55]
v_exp_f32 v135, v135
M v[52:55], a[132:135], a[16:19], v[52:55]
buffer_load_dwordx4 v1, s[12:15], s32 offen offset:1024 sc1 lds
M v[56:59], a[132:135], a[32:35], v[28:31]
v_exp_f32 v148, v148
M v[56:59], a[136:139], a[36:39], v[56:59]
ds_read_b128 a[172:175], v3 offset:14336
ds_read_b128 a[176:179], v3 offset:15360
M v[56:59], a[140:143], a[40:43], v[56:59]
v_exp_f32 v149, v149
M v[56:59], a[144:147], a[44:47], v[56:59]
buffer_load_dwordx4 v1, s[12:15], s32 offen offset:2048 sc1 lds
M v[60:63], a[144:147], a[60:63], v[28:31]
v_exp_f32 v150, v150
M v[60:63], a[140:143], a[56:59], v[60:63]
v_cvt_pk_bf16_f32 v133, v134, v135
v_cvt_pk_bf16_f32 v134, v148, v149
M v[60:63], a[136:139], a[52:55], v[60:63]
v_exp_f32 v151, v151
M v[60:63], a[132:135], a[48:51], v[60:63]
buffer_load_dwordx4 v1, s[12:15], s32 offen offset:3072 sc1 lds
s_add_u32 m0, s29, 32768
s_waitcnt lgkmcnt(4)
M v[64:67], a[148:151], a[0:3], v[20:23]
v_exp_f32 v136, v136
M v[64:67], a[152:155], a[4:7], v[64:67]
ds_read_b128 a[116:119], v3 offset:32768
ds_read_b128 a[120:123], v3 offset:40960
M v[64:67], a[156:159], a[8:11], v[64:67]
v_exp_f32 v137, v137
M v[64:67], a[160:163], a[12:15], v[64:67]
buffer_load_dwordx4 v1, s[12:15], s26 offen offset:0 sc1 lds
s_add_u32 s43, s26, 4096
M v[68:71], a[160:163], a[28:31], v[20:23]
v_exp_f32 v138, v138
M v[68:71], a[156:159], a[24:27], v[68:71]
v_cvt_pk_bf16_f32 v135, v150, v151
v_cvt_pk_bf16_f32 v136, v136, v137
M v[68:71], a[152:155], a[20:23], v[68:71]
v_exp_f32 v139, v139
M v[68:71], a[148:151], a[16:19], v[68:71]
buffer_load_dwordx4 v1, s[12:15], s26 offen offset:1024 sc1 lds
M v[72:75], a[148:151], a[32:35], v[24:27]
v_exp_f32 v152, v152
M v[72:75], a[152:155], a[36:39], v[72:75]
ds_read_b128 a[124:127], v3 offset:33792
ds_read_b128 a[128:131], v3 offset:41984
M v[72:75], a[156:159], a[40:43], v[72:75]
v_exp_f32 v153, v153
M v[72:75], a[160:163], a[44:47], v[72:75]
buffer_load_dwordx4 v1, s[12:15], s26 offen offset:2048 sc1 lds
M v[76:79], a[160:163], a[60:63], v[28:31]
v_exp_f32 v154, v154
M v[76:79], a[156:159], a[56:59], v[76:79]
v_cvt_pk_bf16_f32 v137, v138, v139
v_cvt_pk_bf16_f32 v138, v152, v153
M v[76:79], a[152:155], a[52:55], v[76:79]
v_exp_f32 v155, v155
M v[76:79], a[148:151], a[48:51], v[76:79]
buffer_load_dwordx4 v1, s[12:15], s26 offen offset:3072 sc1 lds
s_add_u32 m0, s29, 36864
s_waitcnt lgkmcnt(4)
M v[80:83], a[164:167], a[0:3], v[20:23]
v_exp_f32 v140, v140
M v[80:83], a[168:171], a[4:7], v[80:83]
ds_read_b128 a[132:135], v3 offset:34816
ds_read_b128 a[136:139], v3 offset:43008
M v[80:83], a[172:175], a[8:11], v[80:83]
v_exp_f32 v141, v141
M v[80:83], a[176:179], a[12:15], v[80:83]
buffer_load_dwordx4 v1, s[12:15], s43 offen offset:0 sc1 lds
M v[84:87], a[176:179], a[28:31], v[20:23]
v_exp_f32 v142, v142
M v[84:87], a[172:175], a[24:27], v[84:87]
v_cvt_pk_bf16_f32 v139, v154, v155
v_cvt_pk_bf16_f32 v140, v140, v141
M v[84:87], a[168:171], a[20:23], v[84:87]
v_exp_f32 v143, v143
M v[84:87], a[164:167], a[16:19], v[84:87]
buffer_load_dwordx4 v1, s[12:15], s43 offen offset:1024 sc1 lds
M v[88:91], a[164:167], a[32:35], v[20:23]
v_exp_f32 v156, v156
M v[88:91], a[168:171], a[36:39], v[88:91]
ds_read_b128 a[140:143], v3 offset:35840
ds_read_b128 a[144:147], v3 offset:44032
M v[88:91], a[172:175], a[40:43], v[88:91]
v_exp_f32 v157, v157
M v[88:91], a[176:179], a[44:47], v[88:91]
buffer_load_dwordx4 v1, s[12:15], s43 offen offset:2048 sc1 lds
M v[92:95], a[176:179], a[60:63], v[24:27]
v_exp_f32 v158, v158
M v[92:95], a[172:175], a[56:59], v[92:95]
v_cvt_pk_bf16_f32 v141, v142, v143
v_cvt_pk_bf16_f32 v142, v156, v157
M v[92:95], a[168:171], a[52:55], v[92:95]
v_exp_f32 v159, v159
M v[92:95], a[164:167], a[48:51], v[92:95]
buffer_load_dwordx4 v1, s[12:15], s43 offen offset:3072 sc1 lds
v_cvt_pk_bf16_f32 v143, v158, v159
s_waitcnt lgkmcnt(6)
M v[160:163], a[116:119], v[96:99], v[160:163]
v_exp_f32 v32, v32
M v[160:163], a[120:123], v[128:131], v[160:163]
ds_read_b128 a[148:151], v3 offset:36864
ds_read_b128 a[152:155], v3 offset:45056
M v[164:167], a[120:123], v[132:135], v[164:167]
v_exp_f32 v33, v33
M v[164:167], a[116:119], v[100:103], v[164:167]
v_cvt_pk_bf16_f32 v32, v32, v33
M v[168:171], a[116:119], v[104:107], v[168:171]
v_exp_f32 v34, v34
M v[168:171], a[120:123], v[136:139], v[168:171]
s_add_u32 s25, s25, 32768
s_cmp_eq_u32 s25, s27
M v[172:175], a[120:123], v[140:143], v[172:175]
v_exp_f32 v35, v35
M v[172:175], a[116:119], v[108:111], v[172:175]
v_cvt_pk_bf16_f32 v33, v34, v35
s_waitcnt lgkmcnt(6)
M a[96:99], a[112:115], v[96:99], a[96:99]
s_cselect_b32 s25, s28, s25
s_cselect_b32 s27, -1, s27
M a[96:99], a[112:115], v[128:131], a[96:99]
s_add_u32 s26, s26, 32768
s_cmp_eq_u32 s26, s62
M v[176:179], a[124:127], v[96:99], v[176:179]
v_exp_f32 v48, v48
M v[176:179], a[128:131], v[128:131], v[176:179]
ds_read_b128 a[156:159], v3 offset:37888
ds_read_b128 a[160:163], v3 offset:46080
M v[180:183], a[128:131], v[132:135], v[180:183]
v_exp_f32 v49, v49
M v[180:183], a[124:127], v[100:103], v[180:183]
v_cvt_pk_bf16_f32 v34, v48, v49
M v[184:187], a[124:127], v[104:107], v[184:187]
v_exp_f32 v50, v50
M v[184:187], a[128:131], v[136:139], v[184:187]
s_cselect_b32 s26, s63, s26
s_cselect_b32 s62, -1, s62
M v[188:191], a[128:131], v[140:143], v[188:191]
v_exp_f32 v51, v51
M v[188:191], a[124:127], v[108:111], v[188:191]
v_cvt_pk_bf16_f32 v35, v50, v51
s_waitcnt lgkmcnt(6)
M a[100:103], a[112:115], v[100:103], a[100:103]
M a[100:103], a[112:115], v[132:135], a[100:103]
M v[192:195], a[132:135], v[96:99], v[192:195]
v_exp_f32 v36, v36
M v[192:195], a[136:139], v[128:131], v[192:195]
ds_read_b128 a[164:167], v3 offset:38912
ds_read_b128 a[168:171], v3 offset:47104
M v[196:199], a[136:139], v[132:135], v[196:199]
v_exp_f32 v37, v37
M v[196:199], a[132:135], v[100:103], v[196:199]
v_cvt_pk_bf16_f32 v36, v36, v37
M v[200:203], a[132:135], v[104:107], v[200:203]
v_exp_f32 v38, v38
M v[200:203], a[136:139], v[136:139], v[200:203]
M v[204:207], a[136:139], v[140:143], v[204:207]
v_exp_f32 v39, v39
M v[204:207], a[132:135], v[108:111], v[204:207]
v_cvt_pk_bf16_f32 v37, v38, v39
s_waitcnt lgkmcnt(6)
M a[104:107], a[112:115], v[104:107], a[104:107]
M a[104:107], a[112:115], v[136:139], a[104:107]
M v[208:211], a[140:143], v[96:99], v[208:211]
v_exp_f32 v52, v52
M v[208:211], a[144:147], v[128:131], v[208:211]
ds_read_b128 a[172:175], v3 offset:39936
ds_read_b128 a[176:179], v3 offset:48128
M v[212:215], a[144:147], v[132:135], v[212:215]
v_exp_f32 v53, v53
M v[212:215], a[140:143], v[100:103], v[212:215]
v_cvt_pk_bf16_f32 v38, v52, v53
M v[216:219], a[140:143], v[104:107], v[216:219]
v_exp_f32 v54, v54
M v[216:219], a[144:147], v[136:139], v[216:219]
M v[220:223], a[144:147], v[140:143], v[220:223]
v_exp_f32 v55, v55
M v[220:223], a[140:143], v[108:111], v[220:223]
v_cvt_pk_bf16_f32 v39, v54, v55
s_waitcnt lgkmcnt(6)
M a[108:111], a[112:115], v[108:111], a[108:111]
M a[108:111], a[112:115], v[140:143], a[108:111]
M v[224:227], a[148:151], v[96:99], v[224:227]
v_exp_f32 v40, v40
M v[224:227], a[152:155], v[128:131], v[224:227]
M v[228:231], a[152:155], v[132:135], v[228:231]
v_exp_f32 v41, v41
M v[228:231], a[148:151], v[100:103], v[228:231]
v_cvt_pk_bf16_f32 v40, v40, v41
M v[232:235], a[148:151], v[104:107], v[232:235]
v_exp_f32 v42, v42
M v[232:235], a[152:155], v[136:139], v[232:235]
M v[236:239], a[152:155], v[140:143], v[236:239]
v_exp_f32 v43, v43
M v[236:239], a[148:151], v[108:111], v[236:239]
v_cvt_pk_bf16_f32 v41, v42, v43
s_waitcnt lgkmcnt(4)
M v[240:243], a[156:159], v[96:99], v[240:243]
v_exp_f32 v56, v56
M v[240:243], a[160:163], v[128:131], v[240:243]
M v[244:247], a[160:163], v[132:135], v[244:247]
v_exp_f32 v57, v57
M v[244:247], a[156:159], v[100:103], v[244:247]
v_cvt_pk_bf16_f32 v42, v56, v57
M v[248:251], a[156:159], v[104:107], v[248:251]
v_exp_f32 v58, v58
M v[248:251], a[160:163], v[136:139], v[248:251]
s_waitcnt vmcnt(0) lgkmcnt(0)
s_barrier
ds_read_b128 a[116:119], v2 offset:0
ds_read_b128 a[120:123], v2 offset:1024
M v[252:255], a[160:163], v[140:143], v[252:255]
v_exp_f32 v59, v59
M v[252:255], a[156:159], v[108:111], v[252:255]
v_cvt_pk_bf16_f32 v43, v58, v59
M a[64:67], a[164:167], v[96:99], a[64:67]
v_exp_f32 v44, v44
M a[64:67], a[168:171], v[128:131], a[64:67]
ds_read_b128 a[124:127], v2 offset:2048
ds_read_b128 a[128:131], v2 offset:3072
M a[68:71], a[168:171], v[132:135], a[68:71]
v_exp_f32 v45, v45
M a[68:71], a[164:167], v[100:103], a[68:71]
v_cvt_pk_bf16_f32 v44, v44, v45
M a[72:75], a[164:167], v[104:107], a[72:75]
v_exp_f32 v46, v46
M a[72:75], a[168:171], v[136:139], a[72:75]
ds_read_b128 a[132:135], v2 offset:4096
ds_read_b128 a[136:139], v2 offset:5120
M a[76:79], a[168:171], v[140:143], a[76:79]
v_exp_f32 v47, v47
M a[76:79], a[164:167], v[108:111], a[76:79]
v_cvt_pk_bf16_f32 v45, v46, v47
M a[80:83], a[172:175], v[96:99], a[80:83]
v_exp_f32 v60, v60
M a[80:83], a[176:179], v[128:131], a[80:83]
ds_read_b128 a[140:143], v2 offset:6144
ds_read_b128 a[144:147], v2 offset:7168
M a[84:87], a[176:179], v[132:135], a[84:87]
v_exp_f32 v61, v61
M a[84:87], a[172:175], v[100:103], a[84:87]
v_cvt_pk_bf16_f32 v46, v60, v61
M a[88:91], a[172:175], v[104:107], a[88:91]
v_exp_f32 v62, v62
M a[88:91], a[176:179], v[136:139], a[88:91]
M a[92:95], a[176:179], v[140:143], a[92:95]
v_exp_f32 v63, v63
M a[92:95], a[172:175], v[108:111], a[92:95]
v_cvt_pk_bf16_f32 v47, v62, v63
Lk2_m2:
s_sub_u32 s35, 15, s21
s_lshl_b32 s33, s20, 7
s_lshl_b32 s34, s35, 3
s_add_u32 s33, s33, s34
s_lshl_b32 s34, s23, 2
s_add_u32 s33, s33, s34
s_lshl_b32 s33, s33, 12
buffer_load_dwordx4 a[180:183], v1, s[8:11], s33 offen offset:0 sc1
buffer_load_dwordx4 a[184:187], v1, s[8:11], s33 offen offset:1024 sc1
buffer_load_dwordx4 a[188:191], v1, s[8:11], s33 offen offset:2048 sc1
buffer_load_dwordx4 a[192:195], v1, s[8:11], s33 offen offset:3072 sc1
s_add_u32 s33, s33, 4096
buffer_load_dwordx4 a[196:199], v1, s[8:11], s33 offen offset:0 sc1
buffer_load_dwordx4 a[200:203], v1, s[8:11], s33 offen offset:1024 sc1
buffer_load_dwordx4 a[204:207], v1, s[8:11], s33 offen offset:2048 sc1
buffer_load_dwordx4 a[208:211], v1, s[8:11], s33 offen offset:3072 sc1
s_add_u32 s33, s33, 4096
buffer_load_dwordx4 a[212:215], v1, s[8:11], s33 offen offset:0 sc1
buffer_load_dwordx4 a[216:219], v1, s[8:11], s33 offen offset:1024 sc1
buffer_load_dwordx4 a[220:223], v1, s[8:11], s33 offen offset:2048 sc1
buffer_load_dwordx4 a[224:227], v1, s[8:11], s33 offen offset:3072 sc1
s_add_u32 s33, s33, 4096
buffer_load_dwordx4 a[228:231], v1, s[8:11], s33 offen offset:0 sc1
buffer_load_dwordx4 a[232:235], v1, s[8:11], s33 offen offset:1024 sc1
buffer_load_dwordx4 a[236:239], v1, s[8:11], s33 offen offset:2048 sc1
buffer_load_dwordx4 a[240:243], v1, s[8:11], s33 offen offset:3072 sc1
s_lshl_b32 s33, s23, 6
s_add_i32 s33, s33, -64
s_cmp_gt_i32 s33, 0
s_cselect_b32 s34, 0, 0xf149f2ca
s_cmp_lt_i32 s33, 0
s_cselect_b32 s33, 0xf149f2ca, 0
v_mov_b32 v20, s34
v_mov_b32 v21, s34
v_mov_b32 v22, s34
v_mov_b32 v23, s34
v_mov_b32 v28, s33
v_mov_b32 v29, s33
v_mov_b32 v30, s33
v_mov_b32 v31, s33
v_med3_f32 v24, v16, v20, v28
v_med3_f32 v25, v17, v20, v28
v_med3_f32 v26, v18, v20, v28
v_med3_f32 v27, v19, v20, v28
s_add_u32 m0, s29, 65536
s_waitcnt lgkmcnt(4)
M v[96:99], a[116:119], a[0:3], v[24:27]
v_exp_f32 v64, v64
M v[96:99], a[120:123], a[4:7], v[96:99]
ds_read_b128 a[148:151], v2 offset:8192
ds_read_b128 a[152:155], v2 offset:9216
M v[96:99], a[124:127], a[8:11], v[96:99]
v_exp_f32 v65, v65
M v[96:99], a[128:131], a[12:15], v[96:99]
buffer_load_dwordx4 v1, s[12:15], s25 offen offset:0 sc1 lds
s_add_u32 s32, s25, 4096
M v[100:103], a[128:131], a[28:31], v[28:31]
v_exp_f32 v66, v66
M v[100:103], a[124:127], a[24:27], v[100:103]
v_cvt_pk_bf16_f32 v64, v64, v65
M v[100:103], a[120:123], a[20:23], v[100:103]
v_exp_f32 v67, v67
M v[100:103], a[116:119], a[16:19], v[100:103]
buffer_load_dwordx4 v1, s[12:15], s25 offen offset:1024 sc1 lds
M v[104:107], a[116:119], a[32:35], v[28:31]
v_exp_f32 v80, v80
M v[104:107], a[120:123], a[36:39], v[104:107]
ds_read_b128 a[156:159], v2 offset:10240
ds_read_b128 a[160:163], v2 offset:11264
M v[104:107], a[124:127], a[40:43], v[104:107]
v_exp_f32 v81, v81
M v[104:107], a[128:131], a[44:47], v[104:107]
buffer_load_dwordx4 v1, s[12:15], s25 offen offset:2048 sc1 lds
M v[108:111], a[128:131], a[60:63], v[28:31]
v_exp_f32 v82, v82
M v[108:111], a[124:127], a[56:59], v[108:111]
v_cvt_pk_bf16_f32 v65, v66, v67
v_cvt_pk_bf16_f32 v66, v80, v81
M v[108:111], a[120:123], a[52:55], v[108:111]
v_exp_f32 v83, v83
M v[108:111], a[116:119], a[48:51], v[108:111]
buffer_load_dwordx4 v1, s[12:15], s25 offen offset:3072 sc1 lds
s_add_u32 m0, s29, 69632
s_waitcnt lgkmcnt(4)
M v[112:115], a[132:135], a[0:3], v[20:23]
v_exp_f32 v68, v68
M v[112:115], a[136:139], a[4:7], v[112:115]
ds_read_b128 a[164:167], v2 offset:12288
ds_read_b128 a[168:171], v2 offset:13312
M v[112:115], a[140:143], a[8:11], v[112:115]
v_exp_f32 v69, v69
M v[112:115], a[144:147], a[12:15], v[112:115]
buffer_load_dwordx4 v1, s[12:15], s32 offen offset:0 sc1 lds
M v[116:119], a[144:147], a[28:31], v[24:27]
v_exp_f32 v70, v70
M v[116:119], a[140:143], a[24:27], v[116:119]
v_cvt_pk_bf16_f32 v67, v82, v83
v_cvt_pk_bf16_f32 v68, v68, v69
M v[116:119], a[136:139], a[20:23], v[116:119]
v_exp_f32 v71, v71
M v[116:119], a[132:135], a[16:19], v[116:119]
buffer_load_dwordx4 v1, s[12:15], s32 offen offset:1024 sc1 lds
M v[120:123], a[132:135], a[32:35], v[28:31]
v_exp_f32 v84, v84
M v[120:123], a[136:139], a[36:39], v[120:123]
ds_read_b128 a[172:175], v2 offset:14336
ds_read_b128 a[176:179], v2 offset:15360
M v[120:123], a[140:143], a[40:43], v[120:123]
v_exp_f32 v85, v85
M v[120:123], a[144:147], a[44:47], v[120:123]
buffer_load_dwordx4 v1, s[12:15], s32 offen offset:2048 sc1 lds
M v[124:127], a[144:147], a[60:63], v[28:31]
v_exp_f32 v86, v86
M v[124:127], a[140:143], a[56:59], v[124:127]
v_cvt_pk_bf16_f32 v69, v70, v71
v_cvt_pk_bf16_f32 v70, v84, v85
M v[124:127], a[136:139], a[52:55], v[124:127]
v_exp_f32 v87, v87
M v[124:127], a[132:135], a[48:51], v[124:127]
buffer_load_dwordx4 v1, s[12:15], s32 offen offset:3072 sc1 lds
s_add_u32 m0, s29, 98304
s_waitcnt lgkmcnt(4)
M v[128:131], a[148:151], a[0:3], v[20:23]
v_exp_f32 v72, v72
M v[128:131], a[152:155], a[4:7], v[128:131]
ds_read_b128 a[116:119], v2 offset:32768
ds_read_b128 a[120:123], v2 offset:40960
M v[128:131], a[156:159], a[8:11], v[128:131]
v_exp_f32 v73, v73
M v[128:131], a[160:163], a[12:15], v[128:131]
buffer_load_dwordx4 v1, s[12:15], s26 offen offset:0 sc1 lds
s_add_u32 s43, s26, 4096
M v[132:135], a[160:163], a[28:31], v[20:23]
v_exp_f32 v74, v74
M v[132:135], a[156:159], a[24:27], v[132:135]
v_cvt_pk_bf16_f32 v71, v86, v87
v_cvt_pk_bf16_f32 v72, v72, v73
M v[132:135], a[152:155], a[20:23], v[132:135]
v_exp_f32 v75, v75
M v[132:135], a[148:151], a[16:19], v[132:135]
buffer_load_dwordx4 v1, s[12:15], s26 offen offset:1024 sc1 lds
M v[136:139], a[148:151], a[32:35], v[24:27]
v_exp_f32 v88, v88
M v[136:139], a[152:155], a[36:39], v[136:139]
ds_read_b128 a[124:127], v2 offset:33792
ds_read_b128 a[128:131], v2 offset:41984
M v[136:139], a[156:159], a[40:43], v[136:139]
v_exp_f32 v89, v89
M v[136:139], a[160:163], a[44:47], v[136:139]
buffer_load_dwordx4 v1, s[12:15], s26 offen offset:2048 sc1 lds
M v[140:143], a[160:163], a[60:63], v[28:31]
v_exp_f32 v90, v90
M v[140:143], a[156:159], a[56:59], v[140:143]
v_cvt_pk_bf16_f32 v73, v74, v75
v_cvt_pk_bf16_f32 v74, v88, v89
M v[140:143], a[152:155], a[52:55], v[140:143]
v_exp_f32 v91, v91
M v[140:143], a[148:151], a[48:51], v[140:143]
buffer_load_dwordx4 v1, s[12:15], s26 offen offset:3072 sc1 lds
s_add_u32 m0, s29, 102400
s_waitcnt lgkmcnt(4)
M v[144:147], a[164:167], a[0:3], v[20:23]
v_exp_f32 v76, v76
M v[144:147], a[168:171], a[4:7], v[144:147]
ds_read_b128 a[132:135], v2 offset:34816
ds_read_b128 a[136:139], v2 offset:43008
M v[144:147], a[172:175], a[8:11], v[144:147]
v_exp_f32 v77, v77
M v[144:147], a[176:179], a[12:15], v[144:147]
buffer_load_dwordx4 v1, s[12:15], s43 offen offset:0 sc1 lds
M v[148:151], a[176:179], a[28:31], v[20:23]
v_exp_f32 v78, v78
M v[148:151], a[172:175], a[24:27], v[148:151]
v_cvt_pk_bf16_f32 v75, v90, v91
v_cvt_pk_bf16_f32 v76, v76, v77
M v[148:151], a[168:171], a[20:23], v[148:151]
v_exp_f32 v79, v79
M v[148:151], a[164:167], a[16:19], v[148:151]
buffer_load_dwordx4 v1, s[12:15], s43 offen offset:1024 sc1 lds
M v[152:155], a[164:167], a[32:35], v[20:23]
v_exp_f32 v92, v92
M v[152:155], a[168:171], a[36:39], v[152:155]
ds_read_b128 a[140:143], v2 offset:35840
ds_read_b128 a[144:147], v2 offset:44032
M v[152:155], a[172:175], a[40:43], v[152:155]
v_exp_f32 v93, v93
M v[152:155], a[176:179], a[44:47], v[152:155]
buffer_load_dwordx4 v1, s[12:15], s43 offen offset:2048 sc1 lds
M v[156:159], a[176:179], a[60:63], v[24:27]
v_exp_f32 v94, v94
M v[156:159], a[172:175], a[56:59], v[156:159]
v_cvt_pk_bf16_f32 v77, v78, v79
v_cvt_pk_bf16_f32 v78, v92, v93
M v[156:159], a[168:171], a[52:55], v[156:159]
v_exp_f32 v95, v95
M v[156:159], a[164:167], a[48:51], v[156:159]
buffer_load_dwordx4 v1, s[12:15], s43 offen offset:3072 sc1 lds
v_cvt_pk_bf16_f32 v79, v94, v95
s_waitcnt lgkmcnt(6)
M v[160:163], a[116:119], v[32:35], v[160:163]
v_exp_f32 v96, v96
M v[160:163], a[120:123], v[64:67], v[160:163]
ds_read_b128 a[148:151], v2 offset:36864
ds_read_b128 a[152:155], v2 offset:45056
M v[164:167], a[120:123], v[68:71], v[164:167]
v_exp_f32 v97, v97
M v[164:167], a[116:119], v[36:39], v[164:167]
v_cvt_pk_bf16_f32 v96, v96, v97
M v[168:171], a[116:119], v[40:43], v[168:171]
v_exp_f32 v98, v98
M v[168:171], a[120:123], v[72:75], v[168:171]
s_add_u32 s25, s25, 32768
s_cmp_eq_u32 s25, s27
M v[172:175], a[120:123], v[76:79], v[172:175]
v_exp_f32 v99, v99
M v[172:175], a[116:119], v[44:47], v[172:175]
v_cvt_pk_bf16_f32 v97, v98, v99
s_waitcnt lgkmcnt(6)
M a[96:99], a[112:115], v[32:35], a[96:99]
s_cselect_b32 s25, s28, s25
s_cselect_b32 s27, -1, s27
M a[96:99], a[112:115], v[64:67], a[96:99]
s_add_u32 s26, s26, 32768
s_cmp_eq_u32 s26, s62
M v[176:179], a[124:127], v[32:35], v[176:179]
v_exp_f32 v112, v112
M v[176:179], a[128:131], v[64:67], v[176:179]
ds_read_b128 a[156:159], v2 offset:37888
ds_read_b128 a[160:163], v2 offset:46080
M v[180:183], a[128:131], v[68:71], v[180:183]
v_exp_f32 v113, v113
M v[180:183], a[124:127], v[36:39], v[180:183]
v_cvt_pk_bf16_f32 v98, v112, v113
M v[184:187], a[124:127], v[40:43], v[184:187]
v_exp_f32 v114, v114
M v[184:187], a[128:131], v[72:75], v[184:187]
s_cselect_b32 s26, s63, s26
s_cselect_b32 s62, -1, s62
M v[188:191], a[128:131], v[76:79], v[188:191]
v_exp_f32 v115, v115
M v[188:191], a[124:127], v[44:47], v[188:191]
v_cvt_pk_bf16_f32 v99, v114, v115
s_waitcnt lgkmcnt(6)
M a[100:103], a[112:115], v[36:39], a[100:103]
M a[100:103], a[112:115], v[68:71], a[100:103]
M v[192:195], a[132:135], v[32:35], v[192:195]
v_exp_f32 v100, v100
M v[192:195], a[136:139], v[64:67], v[192:195]
ds_read_b128 a[164:167], v2 offset:38912
ds_read_b128 a[168:171], v2 offset:47104
M v[196:199], a[136:139], v[68:71], v[196:199]
v_exp_f32 v101, v101
M v[196:199], a[132:135], v[36:39], v[196:199]
v_cvt_pk_bf16_f32 v100, v100, v101
M v[200:203], a[132:135], v[40:43], v[200:203]
v_exp_f32 v102, v102
M v[200:203], a[136:139], v[72:75], v[200:203]
M v[204:207], a[136:139], v[76:79], v[204:207]
v_exp_f32 v103, v103
M v[204:207], a[132:135], v[44:47], v[204:207]
v_cvt_pk_bf16_f32 v101, v102, v103
s_waitcnt lgkmcnt(6)
M a[104:107], a[112:115], v[40:43], a[104:107]
M a[104:107], a[112:115], v[72:75], a[104:107]
M v[208:211], a[140:143], v[32:35], v[208:211]
v_exp_f32 v116, v116
M v[208:211], a[144:147], v[64:67], v[208:211]
ds_read_b128 a[172:175], v2 offset:39936
ds_read_b128 a[176:179], v2 offset:48128
M v[212:215], a[144:147], v[68:71], v[212:215]
v_exp_f32 v117, v117
M v[212:215], a[140:143], v[36:39], v[212:215]
v_cvt_pk_bf16_f32 v102, v116, v117
M v[216:219], a[140:143], v[40:43], v[216:219]
v_exp_f32 v118, v118
M v[216:219], a[144:147], v[72:75], v[216:219]
M v[220:223], a[144:147], v[76:79], v[220:223]
v_exp_f32 v119, v119
M v[220:223], a[140:143], v[44:47], v[220:223]
v_cvt_pk_bf16_f32 v103, v118, v119
s_waitcnt lgkmcnt(6)
M a[108:111], a[112:115], v[44:47], a[108:111]
M a[108:111], a[112:115], v[76:79], a[108:111]
M v[224:227], a[148:151], v[32:35], v[224:227]
v_exp_f32 v104, v104
M v[224:227], a[152:155], v[64:67], v[224:227]
M v[228:231], a[152:155], v[68:71], v[228:231]
v_exp_f32 v105, v105
M v[228:231], a[148:151], v[36:39], v[228:231]
v_cvt_pk_bf16_f32 v104, v104, v105
M v[232:235], a[148:151], v[40:43], v[232:235]
v_exp_f32 v106, v106
M v[232:235], a[152:155], v[72:75], v[232:235]
M v[236:239], a[152:155], v[76:79], v[236:239]
v_exp_f32 v107, v107
M v[236:239], a[148:151], v[44:47], v[236:239]
v_cvt_pk_bf16_f32 v105, v106, v107
s_waitcnt lgkmcnt(4)
M v[240:243], a[156:159], v[32:35], v[240:243]
v_exp_f32 v120, v120
M v[240:243], a[160:163], v[64:67], v[240:243]
M v[244:247], a[160:163], v[68:71], v[244:247]
v_exp_f32 v121, v121
M v[244:247], a[156:159], v[36:39], v[244:247]
v_cvt_pk_bf16_f32 v106, v120, v121
M v[248:251], a[156:159], v[40:43], v[248:251]
v_exp_f32 v122, v122
M v[248:251], a[160:163], v[72:75], v[248:251]
s_waitcnt vmcnt(0) lgkmcnt(0)
s_barrier
ds_read_b128 a[116:119], v3 offset:0
ds_read_b128 a[120:123], v3 offset:1024
M v[252:255], a[160:163], v[76:79], v[252:255]
v_exp_f32 v123, v123
M v[252:255], a[156:159], v[44:47], v[252:255]
v_cvt_pk_bf16_f32 v107, v122, v123
M a[64:67], a[164:167], v[32:35], a[64:67]
v_exp_f32 v108, v108
M a[64:67], a[168:171], v[64:67], a[64:67]
ds_read_b128 a[124:127], v3 offset:2048
ds_read_b128 a[128:131], v3 offset:3072
M a[68:71], a[168:171], v[68:71], a[68:71]
v_exp_f32 v109, v109
M a[68:71], a[164:167], v[36:39], a[68:71]
v_cvt_pk_bf16_f32 v108, v108, v109
M a[72:75], a[164:167], v[40:43], a[72:75]
v_exp_f32 v110, v110
M a[72:75], a[168:171], v[72:75], a[72:75]
ds_read_b128 a[132:135], v3 offset:4096
ds_read_b128 a[136:139], v3 offset:5120
M a[76:79], a[168:171], v[76:79], a[76:79]
v_exp_f32 v111, v111
M a[76:79], a[164:167], v[44:47], a[76:79]
v_cvt_pk_bf16_f32 v109, v110, v111
M a[80:83], a[172:175], v[32:35], a[80:83]
v_exp_f32 v124, v124
M a[80:83], a[176:179], v[64:67], a[80:83]
ds_read_b128 a[140:143], v3 offset:6144
ds_read_b128 a[144:147], v3 offset:7168
M a[84:87], a[176:179], v[68:71], a[84:87]
v_exp_f32 v125, v125
M a[84:87], a[172:175], v[36:39], a[84:87]
v_cvt_pk_bf16_f32 v110, v124, v125
M a[88:91], a[172:175], v[40:43], a[88:91]
v_exp_f32 v126, v126
M a[88:91], a[176:179], v[72:75], a[88:91]
M a[92:95], a[176:179], v[76:79], a[92:95]
v_exp_f32 v127, v127
M a[92:95], a[172:175], v[44:47], a[92:95]
v_cvt_pk_bf16_f32 v111, v126, v127
s_waitcnt vmcnt(16)
s_add_u32 m0, s29, 0
s_waitcnt lgkmcnt(4)
M v[32:35], a[116:119], a[180:183], 0
v_exp_f32 v128, v128
M v[32:35], a[120:123], a[184:187], v[32:35]
ds_read_b128 a[148:151], v3 offset:8192
ds_read_b128 a[152:155], v3 offset:9216
M v[32:35], a[124:127], a[188:191], v[32:35]
v_exp_f32 v129, v129
M v[32:35], a[128:131], a[192:195], v[32:35]
buffer_load_dwordx4 v1, s[12:15], s25 offen offset:0 sc1 lds
s_add_u32 s32, s25, 4096
M v[36:39], a[128:131], a[208:211], 0
v_exp_f32 v130, v130
M v[36:39], a[124:127], a[204:207], v[36:39]
v_cvt_pk_bf16_f32 v128, v128, v129
M v[36:39], a[120:123], a[200:203], v[36:39]
v_exp_f32 v131, v131
M v[36:39], a[116:119], a[196:199], v[36:39]
buffer_load_dwordx4 v1, s[12:15], s25 offen offset:1024 sc1 lds
M v[40:43], a[116:119], a[212:215], 0
v_exp_f32 v144, v144
M v[40:43], a[120:123], a[216:219], v[40:43]
ds_read_b128 a[156:159], v3 offset:10240
ds_read_b128 a[160:163], v3 offset:11264
M v[40:43], a[124:127], a[220:223], v[40:43]
v_exp_f32 v145, v145
M v[40:43], a[128:131], a[224:227], v[40:43]
buffer_load_dwordx4 v1, s[12:15], s25 offen offset:2048 sc1 lds
M v[44:47], a[128:131], a[240:243], 0
v_exp_f32 v146, v146
M v[44:47], a[124:127], a[236:239], v[44:47]
v_cvt_pk_bf16_f32 v129, v130, v131
v_cvt_pk_bf16_f32 v130, v144, v145
M v[44:47], a[120:123], a[232:235], v[44:47]
v_exp_f32 v147, v147
M v[44:47], a[116:119], a[228:231], v[44:47]
buffer_load_dwordx4 v1, s[12:15], s25 offen offset:3072 sc1 lds
s_add_u32 m0, s29, 4096
s_waitcnt lgkmcnt(4)
M v[48:51], a[132:135], a[180:183], 0
v_exp_f32 v132, v132
M v[48:51], a[136:139], a[184:187], v[48:51]
ds_read_b128 a[164:167], v3 offset:12288
ds_read_b128 a[168:171], v3 offset:13312
M v[48:51], a[140:143], a[188:191], v[48:51]
v_exp_f32 v133, v133
M v[48:51], a[144:147], a[192:195], v[48:51]
buffer_load_dwordx4 v1, s[12:15], s32 offen offset:0 sc1 lds
M v[52:55], a[144:147], a[208:211], 0
v_exp_f32 v134, v134
M v[52:55], a[140:143], a[204:207], v[52:55]
v_cvt_pk_bf16_f32 v131, v146, v147
v_cvt_pk_bf16_f32 v132, v132, v133
M v[52:55], a[136:139], a[200:203], v[52:55]
v_exp_f32 v135, v135
M v[52:55], a[132:135], a[196:199], v[52:55]
buffer_load_dwordx4 v1, s[12:15], s32 offen offset:1024 sc1 lds
M v[56:59], a[132:135], a[212:215], 0
v_exp_f32 v148, v148
M v[56:59], a[136:139], a[216:219], v[56:59]
ds_read_b128 a[172:175], v3 offset:14336
ds_read_b128 a[176:179], v3 offset:15360
M v[56:59], a[140:143], a[220:223], v[56:59]
v_exp_f32 v149, v149
M v[56:59], a[144:147], a[224:227], v[56:59]
buffer_load_dwordx4 v1, s[12:15], s32 offen offset:2048 sc1 lds
M v[60:63], a[144:147], a[240:243], 0
v_exp_f32 v150, v150
M v[60:63], a[140:143], a[236:239], v[60:63]
v_cvt_pk_bf16_f32 v133, v134, v135
v_cvt_pk_bf16_f32 v134, v148, v149
M v[60:63], a[136:139], a[232:235], v[60:63]
v_exp_f32 v151, v151
M v[60:63], a[132:135], a[228:231], v[60:63]
buffer_load_dwordx4 v1, s[12:15], s32 offen offset:3072 sc1 lds
s_add_u32 m0, s29, 32768
s_waitcnt lgkmcnt(4)
M v[64:67], a[148:151], a[180:183], 0
v_exp_f32 v136, v136
M v[64:67], a[152:155], a[184:187], v[64:67]
ds_read_b128 a[116:119], v3 offset:32768
ds_read_b128 a[120:123], v3 offset:40960
M v[64:67], a[156:159], a[188:191], v[64:67]
v_exp_f32 v137, v137
M v[64:67], a[160:163], a[192:195], v[64:67]
buffer_load_dwordx4 v1, s[12:15], s26 offen offset:0 sc1 lds
s_add_u32 s43, s26, 4096
M v[68:71], a[160:163], a[208:211], 0
v_exp_f32 v138, v138
M v[68:71], a[156:159], a[204:207], v[68:71]
v_cvt_pk_bf16_f32 v135, v150, v151
v_cvt_pk_bf16_f32 v136, v136, v137
M v[68:71], a[152:155], a[200:203], v[68:71]
v_exp_f32 v139, v139
M v[68:71], a[148:151], a[196:199], v[68:71]
buffer_load_dwordx4 v1, s[12:15], s26 offen offset:1024 sc1 lds
M v[72:75], a[148:151], a[212:215], 0
v_exp_f32 v152, v152
M v[72:75], a[152:155], a[216:219], v[72:75]
ds_read_b128 a[124:127], v3 offset:33792
ds_read_b128 a[128:131], v3 offset:41984
M v[72:75], a[156:159], a[220:223], v[72:75]
v_exp_f32 v153, v153
M v[72:75], a[160:163], a[224:227], v[72:75]
buffer_load_dwordx4 v1, s[12:15], s26 offen offset:2048 sc1 lds
M v[76:79], a[160:163], a[240:243], 0
v_exp_f32 v154, v154
M v[76:79], a[156:159], a[236:239], v[76:79]
v_cvt_pk_bf16_f32 v137, v138, v139
v_cvt_pk_bf16_f32 v138, v152, v153
M v[76:79], a[152:155], a[232:235], v[76:79]
v_exp_f32 v155, v155
M v[76:79], a[148:151], a[228:231], v[76:79]
buffer_load_dwordx4 v1, s[12:15], s26 offen offset:3072 sc1 lds
s_add_u32 m0, s29, 36864
s_waitcnt lgkmcnt(4)
M v[80:83], a[164:167], a[180:183], 0
v_exp_f32 v140, v140
M v[80:83], a[168:171], a[184:187], v[80:83]
ds_read_b128 a[132:135], v3 offset:34816
ds_read_b128 a[136:139], v3 offset:43008
M v[80:83], a[172:175], a[188:191], v[80:83]
v_exp_f32 v141, v141
M v[80:83], a[176:179], a[192:195], v[80:83]
buffer_load_dwordx4 v1, s[12:15], s43 offen offset:0 sc1 lds
M v[84:87], a[176:179], a[208:211], 0
v_exp_f32 v142, v142
M v[84:87], a[172:175], a[204:207], v[84:87]
v_cvt_pk_bf16_f32 v139, v154, v155
v_cvt_pk_bf16_f32 v140, v140, v141
M v[84:87], a[168:171], a[200:203], v[84:87]
v_exp_f32 v143, v143
M v[84:87], a[164:167], a[196:199], v[84:87]
buffer_load_dwordx4 v1, s[12:15], s43 offen offset:1024 sc1 lds
M v[88:91], a[164:167], a[212:215], 0
v_exp_f32 v156, v156
M v[88:91], a[168:171], a[216:219], v[88:91]
ds_read_b128 a[140:143], v3 offset:35840
ds_read_b128 a[144:147], v3 offset:44032
M v[88:91], a[172:175], a[220:223], v[88:91]
v_exp_f32 v157, v157
M v[88:91], a[176:179], a[224:227], v[88:91]
buffer_load_dwordx4 v1, s[12:15], s43 offen offset:2048 sc1 lds
M v[92:95], a[176:179], a[240:243], 0
v_exp_f32 v158, v158
M v[92:95], a[172:175], a[236:239], v[92:95]
v_cvt_pk_bf16_f32 v141, v142, v143
v_cvt_pk_bf16_f32 v142, v156, v157
M v[92:95], a[168:171], a[232:235], v[92:95]
v_exp_f32 v159, v159
M v[92:95], a[164:167], a[228:231], v[92:95]
buffer_load_dwordx4 v1, s[12:15], s43 offen offset:3072 sc1 lds
v_cvt_pk_bf16_f32 v143, v158, v159
s_waitcnt lgkmcnt(6)
M v[160:163], a[116:119], v[96:99], v[160:163]
v_exp_f32 v32, v32
M v[160:163], a[120:123], v[128:131], v[160:163]
ds_read_b128 a[148:151], v3 offset:36864
ds_read_b128 a[152:155], v3 offset:45056
M v[164:167], a[120:123], v[132:135], v[164:167]
v_exp_f32 v33, v33
M v[164:167], a[116:119], v[100:103], v[164:167]
v_cvt_pk_bf16_f32 v32, v32, v33
M v[168:171], a[116:119], v[104:107], v[168:171]
v_exp_f32 v34, v34
M v[168:171], a[120:123], v[136:139], v[168:171]
s_add_u32 s25, s25, 32768
s_cmp_eq_u32 s25, s27
M v[172:175], a[120:123], v[140:143], v[172:175]
v_exp_f32 v35, v35
M v[172:175], a[116:119], v[108:111], v[172:175]
v_cvt_pk_bf16_f32 v33, v34, v35
s_waitcnt lgkmcnt(6)
M a[96:99], a[112:115], v[96:99], a[96:99]
s_cselect_b32 s25, s28, s25
s_cselect_b32 s27, -1, s27
M a[96:99], a[112:115], v[128:131], a[96:99]
s_add_u32 s26, s26, 32768
s_cmp_eq_u32 s26, s62
M v[176:179], a[124:127], v[96:99], v[176:179]
v_exp_f32 v48, v48
M v[176:179], a[128:131], v[128:131], v[176:179]
ds_read_b128 a[156:159], v3 offset:37888
ds_read_b128 a[160:163], v3 offset:46080
M v[180:183], a[128:131], v[132:135], v[180:183]
v_exp_f32 v49, v49
M v[180:183], a[124:127], v[100:103], v[180:183]
v_cvt_pk_bf16_f32 v34, v48, v49
M v[184:187], a[124:127], v[104:107], v[184:187]
v_exp_f32 v50, v50
M v[184:187], a[128:131], v[136:139], v[184:187]
s_cselect_b32 s26, s63, s26
s_cselect_b32 s62, -1, s62
M v[188:191], a[128:131], v[140:143], v[188:191]
v_exp_f32 v51, v51
M v[188:191], a[124:127], v[108:111], v[188:191]
v_cvt_pk_bf16_f32 v35, v50, v51
s_waitcnt lgkmcnt(6)
M a[100:103], a[112:115], v[100:103], a[100:103]
M a[100:103], a[112:115], v[132:135], a[100:103]
M v[192:195], a[132:135], v[96:99], v[192:195]
v_exp_f32 v36, v36
M v[192:195], a[136:139], v[128:131], v[192:195]
ds_read_b128 a[164:167], v3 offset:38912
ds_read_b128 a[168:171], v3 offset:47104
M v[196:199], a[136:139], v[132:135], v[196:199]
v_exp_f32 v37, v37
M v[196:199], a[132:135], v[100:103], v[196:199]
v_cvt_pk_bf16_f32 v36, v36, v37
M v[200:203], a[132:135], v[104:107], v[200:203]
v_exp_f32 v38, v38
M v[200:203], a[136:139], v[136:139], v[200:203]
M v[204:207], a[136:139], v[140:143], v[204:207]
v_exp_f32 v39, v39
M v[204:207], a[132:135], v[108:111], v[204:207]
v_cvt_pk_bf16_f32 v37, v38, v39
s_waitcnt lgkmcnt(6)
M a[104:107], a[112:115], v[104:107], a[104:107]
M a[104:107], a[112:115], v[136:139], a[104:107]
M v[208:211], a[140:143], v[96:99], v[208:211]
v_exp_f32 v52, v52
M v[208:211], a[144:147], v[128:131], v[208:211]
ds_read_b128 a[172:175], v3 offset:39936
ds_read_b128 a[176:179], v3 offset:48128
M v[212:215], a[144:147], v[132:135], v[212:215]
v_exp_f32 v53, v53
M v[212:215], a[140:143], v[100:103], v[212:215]
v_cvt_pk_bf16_f32 v38, v52, v53
M v[216:219], a[140:143], v[104:107], v[216:219]
v_exp_f32 v54, v54
M v[216:219], a[144:147], v[136:139], v[216:219]
M v[220:223], a[144:147], v[140:143], v[220:223]
v_exp_f32 v55, v55
M v[220:223], a[140:143], v[108:111], v[220:223]
v_cvt_pk_bf16_f32 v39, v54, v55
s_waitcnt lgkmcnt(6)
M a[108:111], a[112:115], v[108:111], a[108:111]
M a[108:111], a[112:115], v[140:143], a[108:111]
M v[224:227], a[148:151], v[96:99], v[224:227]
v_exp_f32 v40, v40
M v[224:227], a[152:155], v[128:131], v[224:227]
M v[228:231], a[152:155], v[132:135], v[228:231]
v_exp_f32 v41, v41
M v[228:231], a[148:151], v[100:103], v[228:231]
v_cvt_pk_bf16_f32 v40, v40, v41
M v[232:235], a[148:151], v[104:107], v[232:235]
v_exp_f32 v42, v42
M v[232:235], a[152:155], v[136:139], v[232:235]
M v[236:239], a[152:155], v[140:143], v[236:239]
v_exp_f32 v43, v43
M v[236:239], a[148:151], v[108:111], v[236:239]
v_cvt_pk_bf16_f32 v41, v42, v43
s_waitcnt lgkmcnt(4)
M v[240:243], a[156:159], v[96:99], v[240:243]
v_exp_f32 v56, v56
M v[240:243], a[160:163], v[128:131], v[240:243]
M v[244:247], a[160:163], v[132:135], v[244:247]
v_exp_f32 v57, v57
M v[244:247], a[156:159], v[100:103], v[244:247]
v_cvt_pk_bf16_f32 v42, v56, v57
M v[248:251], a[156:159], v[104:107], v[248:251]
v_exp_f32 v58, v58
M v[248:251], a[160:163], v[136:139], v[248:251]
s_waitcnt vmcnt(0) lgkmcnt(0)
s_barrier
ds_read_b128 a[116:119], v2 offset:0
ds_read_b128 a[120:123], v2 offset:1024
M v[252:255], a[160:163], v[140:143], v[252:255]
v_exp_f32 v59, v59
M v[252:255], a[156:159], v[108:111], v[252:255]
v_cvt_pk_bf16_f32 v43, v58, v59
M a[64:67], a[164:167], v[96:99], a[64:67]
v_exp_f32 v44, v44
M a[64:67], a[168:171], v[128:131], a[64:67]
ds_read_b128 a[124:127], v2 offset:2048
ds_read_b128 a[128:131], v2 offset:3072
M a[68:71], a[168:171], v[132:135], a[68:71]
v_exp_f32 v45, v45
M a[68:71], a[164:167], v[100:103], a[68:71]
v_cvt_pk_bf16_f32 v44, v44, v45
M a[72:75], a[164:167], v[104:107], a[72:75]
v_exp_f32 v46, v46
M a[72:75], a[168:171], v[136:139], a[72:75]
ds_read_b128 a[132:135], v2 offset:4096
ds_read_b128 a[136:139], v2 offset:5120
M a[76:79], a[168:171], v[140:143], a[76:79]
v_exp_f32 v47, v47
M a[76:79], a[164:167], v[108:111], a[76:79]
v_cvt_pk_bf16_f32 v45, v46, v47
M a[80:83], a[172:175], v[96:99], a[80:83]
v_exp_f32 v60, v60
M a[80:83], a[176:179], v[128:131], a[80:83]
ds_read_b128 a[140:143], v2 offset:6144
ds_read_b128 a[144:147], v2 offset:7168
M a[84:87], a[176:179], v[132:135], a[84:87]
v_exp_f32 v61, v61
M a[84:87], a[172:175], v[100:103], a[84:87]
v_cvt_pk_bf16_f32 v46, v60, v61
M a[88:91], a[172:175], v[104:107], a[88:91]
v_exp_f32 v62, v62
M a[88:91], a[176:179], v[136:139], a[88:91]
M a[92:95], a[176:179], v[140:143], a[92:95]
v_exp_f32 v63, v63
M a[92:95], a[172:175], v[108:111], a[92:95]
v_cvt_pk_bf16_f32 v47, v62, v63
v_accvgpr_read_b32 v20, a96
v_accvgpr_read_b32 v21, a100
v_accvgpr_read_b32 v22, a104
v_accvgpr_read_b32 v23, a108
v_rcp_f32 v8, v20
v_rcp_f32 v9, v21
v_rcp_f32 v10, v22
v_rcp_f32 v11, v23
v_subrev_u32 v20, 0x21800000, v20
v_subrev_u32 v21, 0x21800000, v21
v_subrev_u32 v22, 0x21800000, v22
v_subrev_u32 v23, 0x21800000, v23
v_max_u32 v12, v20, v21
v_max3_u32 v12, v12, v22, v23
s_mov_b32 s64, 0x207
v_pk_mul_f32 v[160:161], v[160:161], v[8:9] op_sel:[0,0] op_sel_hi:[1,0]
v_pk_mul_f32 v[162:163], v[162:163], v[8:9] op_sel:[0,0] op_sel_hi:[1,0]
v_pk_mul_f32 v[176:177], v[176:177], v[8:9] op_sel:[0,0] op_sel_hi:[1,0]
v_pk_mul_f32 v[178:179], v[178:179], v[8:9] op_sel:[0,0] op_sel_hi:[1,0]
v_cvt_pk_bf16_f32 v160, v160, v161
v_cvt_pk_bf16_f32 v161, v162, v163
v_cvt_pk_bf16_f32 v162, v176, v177
v_cvt_pk_bf16_f32 v163, v178, v179
s_nop 1
M v[24:27], a[112:115], v[160:163], 0
v_pk_mul_f32 v[164:165], v[164:165], v[8:9] op_sel:[0,1] op_sel_hi:[1,1]
v_pk_mul_f32 v[166:167], v[166:167], v[8:9] op_sel:[0,1] op_sel_hi:[1,1]
v_pk_mul_f32 v[180:181], v[180:181], v[8:9] op_sel:[0,1] op_sel_hi:[1,1]
v_pk_mul_f32 v[182:183], v[182:183], v[8:9] op_sel:[0,1] op_sel_hi:[1,1]
v_cvt_pk_bf16_f32 v164, v164, v165
v_cvt_pk_bf16_f32 v165, v166, v167
v_cvt_pk_bf16_f32 v166, v180, v181
v_cvt_pk_bf16_f32 v167, v182, v183
s_nop 1
M v[24:27], a[112:115], v[164:167], v[24:27]
v_pk_mul_f32 v[168:169], v[168:169], v[10:11] op_sel:[0,0] op_sel_hi:[1,0]
v_pk_mul_f32 v[170:171], v[170:171], v[10:11] op_sel:[0,0] op_sel_hi:[1,0]
v_pk_mul_f32 v[184:185], v[184:185], v[10:11] op_sel:[0,0] op_sel_hi:[1,0]
v_pk_mul_f32 v[186:187], v[186:187], v[10:11] op_sel:[0,0] op_sel_hi:[1,0]
v_cvt_pk_bf16_f32 v168, v168, v169
v_cvt_pk_bf16_f32 v169, v170, v171
v_cvt_pk_bf16_f32 v170, v184, v185
v_cvt_pk_bf16_f32 v171, v186, v187
s_nop 1
M v[24:27], a[112:115], v[168:171], v[24:27]
v_pk_mul_f32 v[172:173], v[172:173], v[10:11] op_sel:[0,1] op_sel_hi:[1,1]
v_pk_mul_f32 v[174:175], v[174:175], v[10:11] op_sel:[0,1] op_sel_hi:[1,1]
v_pk_mul_f32 v[188:189], v[188:189], v[10:11] op_sel:[0,1] op_sel_hi:[1,1]
v_pk_mul_f32 v[190:191], v[190:191], v[10:11] op_sel:[0,1] op_sel_hi:[1,1]
v_cvt_pk_bf16_f32 v172, v172, v173
v_cvt_pk_bf16_f32 v173, v174, v175
v_cvt_pk_bf16_f32 v174, v188, v189
v_cvt_pk_bf16_f32 v175, v190, v191
s_nop 1
M v[24:27], a[112:115], v[172:175], v[24:27]
v_pk_mul_f32 v[192:193], v[192:193], v[8:9] op_sel:[0,0] op_sel_hi:[1,0]
v_pk_mul_f32 v[194:195], v[194:195], v[8:9] op_sel:[0,0] op_sel_hi:[1,0]
v_pk_mul_f32 v[208:209], v[208:209], v[8:9] op_sel:[0,0] op_sel_hi:[1,0]
v_pk_mul_f32 v[210:211], v[210:211], v[8:9] op_sel:[0,0] op_sel_hi:[1,0]
v_cvt_pk_bf16_f32 v192, v192, v193
v_cvt_pk_bf16_f32 v193, v194, v195
v_cvt_pk_bf16_f32 v194, v208, v209
v_cvt_pk_bf16_f32 v195, v210, v211
s_nop 1
M v[24:27], a[112:115], v[192:195], v[24:27]
v_pk_mul_f32 v[196:197], v[196:197], v[8:9] op_sel:[0,1] op_sel_hi:[1,1]
v_pk_mul_f32 v[198:199], v[198:199], v[8:9] op_sel:[0,1] op_sel_hi:[1,1]
v_pk_mul_f32 v[212:213], v[212:213], v[8:9] op_sel:[0,1] op_sel_hi:[1,1]
v_pk_mul_f32 v[214:215], v[214:215], v[8:9] op_sel:[0,1] op_sel_hi:[1,1]
v_cvt_pk_bf16_f32 v196, v196, v197
v_cvt_pk_bf16_f32 v197, v198, v199
v_cvt_pk_bf16_f32 v198, v212, v213
v_cvt_pk_bf16_f32 v199, v214, v215
s_nop 1
M v[24:27], a[112:115], v[196:199], v[24:27]
v_pk_mul_f32 v[200:201], v[200:201], v[10:11] op_sel:[0,0] op_sel_hi:[1,0]
v_pk_mul_f32 v[202:203], v[202:203], v[10:11] op_sel:[0,0] op_sel_hi:[1,0]
v_pk_mul_f32 v[216:217], v[216:217], v[10:11] op_sel:[0,0] op_sel_hi:[1,0]
v_pk_mul_f32 v[218:219], v[218:219], v[10:11] op_sel:[0,0] op_sel_hi:[1,0]
v_cvt_pk_bf16_f32 v200, v200, v201
v_cvt_pk_bf16_f32 v201, v202, v203
v_cvt_pk_bf16_f32 v202, v216, v217
v_cvt_pk_bf16_f32 v203, v218, v219
s_nop 1
M v[24:27], a[112:115], v[200:203], v[24:27]
v_pk_mul_f32 v[204:205], v[204:205], v[10:11] op_sel:[0,1] op_sel_hi:[1,1]
v_pk_mul_f32 v[206:207], v[206:207], v[10:11] op_sel:[0,1] op_sel_hi:[1,1]
v_pk_mul_f32 v[220:221], v[220:221], v[10:11] op_sel:[0,1] op_sel_hi:[1,1]
v_pk_mul_f32 v[222:223], v[222:223], v[10:11] op_sel:[0,1] op_sel_hi:[1,1]
v_cvt_pk_bf16_f32 v204, v204, v205
v_cvt_pk_bf16_f32 v205, v206, v207
v_cvt_pk_bf16_f32 v206, v220, v221
v_cvt_pk_bf16_f32 v207, v222, v223
s_nop 1
M v[24:27], a[112:115], v[204:207], v[24:27]
v_pk_mul_f32 v[224:225], v[224:225], v[8:9] op_sel:[0,0] op_sel_hi:[1,0]
v_pk_mul_f32 v[226:227], v[226:227], v[8:9] op_sel:[0,0] op_sel_hi:[1,0]
v_pk_mul_f32 v[240:241], v[240:241], v[8:9] op_sel:[0,0] op_sel_hi:[1,0]
v_pk_mul_f32 v[242:243], v[242:243], v[8:9] op_sel:[0,0] op_sel_hi:[1,0]
v_cvt_pk_bf16_f32 v224, v224, v225
v_cvt_pk_bf16_f32 v225, v226, v227
v_cvt_pk_bf16_f32 v226, v240, v241
v_cvt_pk_bf16_f32 v227, v242, v243
s_nop 1
M v[24:27], a[112:115], v[224:227], v[24:27]
v_pk_mul_f32 v[228:229], v[228:229], v[8:9] op_sel:[0,1] op_sel_hi:[1,1]
v_pk_mul_f32 v[230:231], v[230:231], v[8:9] op_sel:[0,1] op_sel_hi:[1,1]
v_pk_mul_f32 v[244:245], v[244:245], v[8:9] op_sel:[0,1] op_sel_hi:[1,1]
v_pk_mul_f32 v[246:247], v[246:247], v[8:9] op_sel:[0,1] op_sel_hi:[1,1]
v_cvt_pk_bf16_f32 v228, v228, v229
v_cvt_pk_bf16_f32 v229, v230, v231
v_cvt_pk_bf16_f32 v230, v244, v245
v_cvt_pk_bf16_f32 v231, v246, v247
s_nop 1
M v[24:27], a[112:115], v[228:231], v[24:27]
v_pk_mul_f32 v[232:233], v[232:233], v[10:11] op_sel:[0,0] op_sel_hi:[1,0]
v_pk_mul_f32 v[234:235], v[234:235], v[10:11] op_sel:[0,0] op_sel_hi:[1,0]
v_pk_mul_f32 v[248:249], v[248:249], v[10:11] op_sel:[0,0] op_sel_hi:[1,0]
v_pk_mul_f32 v[250:251], v[250:251], v[10:11] op_sel:[0,0] op_sel_hi:[1,0]
v_cvt_pk_bf16_f32 v232, v232, v233
v_cvt_pk_bf16_f32 v233, v234, v235
v_cvt_pk_bf16_f32 v234, v248, v249
v_cvt_pk_bf16_f32 v235, v250, v251
s_nop 1
M v[24:27], a[112:115], v[232:235], v[24:27]
v_pk_mul_f32 v[236:237], v[236:237], v[10:11] op_sel:[0,1] op_sel_hi:[1,1]
v_pk_mul_f32 v[238:239], v[238:239], v[10:11] op_sel:[0,1] op_sel_hi:[1,1]
v_pk_mul_f32 v[252:253], v[252:253], v[10:11] op_sel:[0,1] op_sel_hi:[1,1]
v_pk_mul_f32 v[254:255], v[254:255], v[10:11] op_sel:[0,1] op_sel_hi:[1,1]
v_cvt_pk_bf16_f32 v236, v236, v237
v_cvt_pk_bf16_f32 v237, v238, v239
v_cvt_pk_bf16_f32 v238, v252, v253
v_cvt_pk_bf16_f32 v239, v254, v255
v_accvgpr_read_b32 v176, a64
v_accvgpr_read_b32 v177, a65
v_accvgpr_read_b32 v178, a66
v_accvgpr_read_b32 v179, a67
v_accvgpr_read_b32 v180, a80
v_accvgpr_read_b32 v181, a81
v_accvgpr_read_b32 v182, a82
v_accvgpr_read_b32 v183, a83
M v[24:27], a[112:115], v[236:239], v[24:27]
v_pk_mul_f32 v[176:177], v[176:177], v[8:9] op_sel:[0,0] op_sel_hi:[1,0]
v_pk_mul_f32 v[178:179], v[178:179], v[8:9] op_sel:[0,0] op_sel_hi:[1,0]
v_pk_mul_f32 v[180:181], v[180:181], v[8:9] op_sel:[0,0] op_sel_hi:[1,0]
v_pk_mul_f32 v[182:183], v[182:183], v[8:9] op_sel:[0,0] op_sel_hi:[1,0]
v_cvt_pk_bf16_f32 v176, v176, v177
v_cvt_pk_bf16_f32 v177, v178, v179
v_cvt_pk_bf16_f32 v178, v180, v181
v_cvt_pk_bf16_f32 v179, v182, v183
v_accvgpr_read_b32 v184, a68
v_accvgpr_read_b32 v185, a69
v_accvgpr_read_b32 v186, a70
v_accvgpr_read_b32 v187, a71
v_accvgpr_read_b32 v188, a84
v_accvgpr_read_b32 v189, a85
v_accvgpr_read_b32 v190, a86
v_accvgpr_read_b32 v191, a87
M v[24:27], a[112:115], v[176:179], v[24:27]
v_pk_mul_f32 v[184:185], v[184:185], v[8:9] op_sel:[0,1] op_sel_hi:[1,1]
v_pk_mul_f32 v[186:187], v[186:187], v[8:9] op_sel:[0,1] op_sel_hi:[1,1]
v_pk_mul_f32 v[188:189], v[188:189], v[8:9] op_sel:[0,1] op_sel_hi:[1,1]
v_pk_mul_f32 v[190:191], v[190:191], v[8:9] op_sel:[0,1] op_sel_hi:[1,1]
v_cvt_pk_bf16_f32 v184, v184, v185
v_cvt_pk_bf16_f32 v185, v186, v187
v_cvt_pk_bf16_f32 v186, v188, v189
v_cvt_pk_bf16_f32 v187, v190, v191
v_accvgpr_read_b32 v208, a72
v_accvgpr_read_b32 v209, a73
v_accvgpr_read_b32 v210, a74
v_accvgpr_read_b32 v211, a75
v_accvgpr_read_b32 v212, a88
v_accvgpr_read_b32 v213, a89
v_accvgpr_read_b32 v214, a90
v_accvgpr_read_b32 v215, a91
M v[24:27], a[112:115], v[184:187], v[24:27]
v_pk_mul_f32 v[208:209], v[208:209], v[10:11] op_sel:[0,0] op_sel_hi:[1,0]
v_pk_mul_f32 v[210:211], v[210:211], v[10:11] op_sel:[0,0] op_sel_hi:[1,0]
v_pk_mul_f32 v[212:213], v[212:213], v[10:11] op_sel:[0,0] op_sel_hi:[1,0]
v_pk_mul_f32 v[214:215], v[214:215], v[10:11] op_sel:[0,0] op_sel_hi:[1,0]
v_cvt_pk_bf16_f32 v208, v208, v209
v_cvt_pk_bf16_f32 v209, v210, v211
v_cvt_pk_bf16_f32 v210, v212, v213
v_cvt_pk_bf16_f32 v211, v214, v215
v_accvgpr_read_b32 v216, a76
v_accvgpr_read_b32 v217, a77
v_accvgpr_read_b32 v218, a78
v_accvgpr_read_b32 v219, a79
v_accvgpr_read_b32 v220, a92
v_accvgpr_read_b32 v221, a93
v_accvgpr_read_b32 v222, a94
v_accvgpr_read_b32 v223, a95
M v[24:27], a[112:115], v[208:211], v[24:27]
v_pk_mul_f32 v[216:217], v[216:217], v[10:11] op_sel:[0,1] op_sel_hi:[1,1]
v_pk_mul_f32 v[218:219], v[218:219], v[10:11] op_sel:[0,1] op_sel_hi:[1,1]
v_pk_mul_f32 v[220:221], v[220:221], v[10:11] op_sel:[0,1] op_sel_hi:[1,1]
v_pk_mul_f32 v[222:223], v[222:223], v[10:11] op_sel:[0,1] op_sel_hi:[1,1]
v_cvt_pk_bf16_f32 v216, v216, v217
v_cvt_pk_bf16_f32 v217, v218, v219
v_cvt_pk_bf16_f32 v218, v220, v221
v_cvt_pk_bf16_f32 v219, v222, v223
s_nop 1
M v[24:27], a[112:115], v[216:219], v[24:27]
v_cmp_lt_u32 vcc, 0x3c000000, v12
s_nop 6
v_cmp_class_f32 s[40:41], v24, s64
s_nop 0
s_or_b64 vcc, vcc, s[40:41]
s_cbranch_vccnz Lbad_2
s_lshl_b32 s33, s21, 20
s_lshl_b32 s34, s20, 15
s_add_u32 s33, s33, s34
s_lshl_b32 s34, s23, 13
s_add_u32 s36, s33, s34
s_add_u32 s37, s36, 4096
s_add_u32 s38, s36, 16384
s_add_u32 s39, s36, 20480
buffer_store_dwordx4 v[160:163], v1, s[16:19], s36 offen offset:0 sc1
buffer_store_dwordx4 v[164:167], v1, s[16:19], s36 offen offset:2048 sc1
buffer_store_dwordx4 v[168:171], v1, s[16:19], s37 offen offset:0 sc1
buffer_store_dwordx4 v[172:175], v1, s[16:19], s37 offen offset:2048 sc1
buffer_store_dwordx4 v[192:195], v1, s[16:19], s36 offen offset:1024 sc1
buffer_store_dwordx4 v[196:199], v1, s[16:19], s36 offen offset:3072 sc1
buffer_store_dwordx4 v[200:203], v1, s[16:19], s37 offen offset:1024 sc1
buffer_store_dwordx4 v[204:207], v1, s[16:19], s37 offen offset:3072 sc1
buffer_store_dwordx4 v[224:227], v1, s[16:19], s38 offen offset:0 sc1
buffer_store_dwordx4 v[228:231], v1, s[16:19], s38 offen offset:2048 sc1
buffer_store_dwordx4 v[232:235], v1, s[16:19], s39 offen offset:0 sc1
buffer_store_dwordx4 v[236:239], v1, s[16:19], s39 offen offset:2048 sc1
buffer_store_dwordx4 v[176:179], v1, s[16:19], s38 offen offset:1024 sc1
buffer_store_dwordx4 v[184:187], v1, s[16:19], s38 offen offset:3072 sc1
buffer_store_dwordx4 v[208:211], v1, s[16:19], s39 offen offset:1024 sc1
buffer_store_dwordx4 v[216:219], v1, s[16:19], s39 offen offset:3072 sc1
s_branch Lfd_3
Lbad_2:
s_or_b32 s60, s60, 1
Lfd_3:
s_sub_u32 s30, 7, s21
s_cmp_lg_u32 s30, 0
s_cbranch_scc1 Lk2_b0
s_and_b32 s3, s2, 3
s_lshl_b32 s3, s3, 2
s_bfe_u32 s27, s2, 0x20003
s_add_u32 s27, s3, s27
s_lshl_b32 s43, s27, 8
s_add_u32 s43, s43, 8400896
v_lshlrev_b32 v15, 2, v0
buffer_load_dword v7, v15, s[52:55], s43 offen sc1
s_waitcnt lgkmcnt(7)
ds_read_b128 a[116:119], v2 offset:32768
s_waitcnt lgkmcnt(7)
ds_read_b128 a[120:123], v2 offset:40960
s_waitcnt lgkmcnt(7)
ds_read_b128 a[124:127], v2 offset:33792
s_waitcnt lgkmcnt(7)
ds_read_b128 a[128:131], v2 offset:41984
s_waitcnt lgkmcnt(7)
ds_read_b128 a[132:135], v2 offset:34816
s_waitcnt lgkmcnt(7)
ds_read_b128 a[136:139], v2 offset:43008
s_waitcnt lgkmcnt(7)
ds_read_b128 a[140:143], v2 offset:35840
s_waitcnt lgkmcnt(7)
ds_read_b128 a[144:147], v2 offset:44032
v_exp_f32 v64, v64
v_exp_f32 v65, v65
v_exp_f32 v66, v66
v_exp_f32 v67, v67
v_exp_f32 v80, v80
v_exp_f32 v81, v81
v_exp_f32 v82, v82
v_exp_f32 v83, v83
v_cvt_pk_bf16_f32 v64, v64, v65
v_cvt_pk_bf16_f32 v65, v66, v67
v_exp_f32 v68, v68
v_exp_f32 v69, v69
v_exp_f32 v70, v70
v_exp_f32 v71, v71
v_cvt_pk_bf16_f32 v66, v80, v81
v_cvt_pk_bf16_f32 v67, v82, v83
v_exp_f32 v84, v84
v_exp_f32 v85, v85
v_exp_f32 v86, v86
v_exp_f32 v87, v87
v_cvt_pk_bf16_f32 v68, v68, v69
v_cvt_pk_bf16_f32 v69, v70, v71
v_exp_f32 v72, v72
v_exp_f32 v73, v73
v_exp_f32 v74, v74
v_exp_f32 v75, v75
v_cvt_pk_bf16_f32 v70, v84, v85
v_cvt_pk_bf16_f32 v71, v86, v87
v_exp_f32 v88, v88
v_exp_f32 v89, v89
v_exp_f32 v90, v90
v_exp_f32 v91, v91
v_cvt_pk_bf16_f32 v72, v72, v73
v_cvt_pk_bf16_f32 v73, v74, v75
v_exp_f32 v76, v76
v_exp_f32 v77, v77
v_exp_f32 v78, v78
v_exp_f32 v79, v79
v_cvt_pk_bf16_f32 v74, v88, v89
v_cvt_pk_bf16_f32 v75, v90, v91
v_exp_f32 v92, v92
v_exp_f32 v93, v93
v_exp_f32 v94, v94
v_exp_f32 v95, v95
v_cvt_pk_bf16_f32 v76, v76, v77
v_cvt_pk_bf16_f32 v77, v78, v79
v_cvt_pk_bf16_f32 v78, v92, v93
v_cvt_pk_bf16_f32 v79, v94, v95
s_waitcnt lgkmcnt(6)
M v[160:163], a[116:119], v[32:35], 0
M v[160:163], a[120:123], v[64:67], v[160:163]
ds_read_b128 a[148:151], v2 offset:36864
ds_read_b128 a[152:155], v2 offset:45056
s_mov_b32 s61, 0
M v[164:167], a[120:123], v[68:71], 0
M v[164:167], a[116:119], v[36:39], v[164:167]
s_bfe_u32 s3, s2, 0x10002
M v[168:171], a[116:119], v[40:43], 0
M v[168:171], a[120:123], v[72:75], v[168:171]
s_lshl_b32 s3, s3, 3
M v[172:175], a[120:123], v[76:79], 0
M v[172:175], a[116:119], v[44:47], v[172:175]
s_waitcnt lgkmcnt(6)
s_lshr_b32 s28, s2, 5
M a[96:99], a[112:115], v[32:35], 0
M a[96:99], a[112:115], v[64:67], a[96:99]
M v[176:179], a[124:127], v[32:35], 0
M v[176:179], a[128:131], v[64:67], v[176:179]
ds_read_b128 a[156:159], v2 offset:37888
ds_read_b128 a[160:163], v2 offset:46080
s_add_u32 s28, s3, s28
M v[180:183], a[128:131], v[68:71], 0
s_lshl_b32 s25, s27, 18
M v[180:183], a[124:127], v[36:39], v[180:183]
M v[184:187], a[124:127], v[40:43], 0
s_lshl_b32 s3, s101, 12
M v[184:187], a[128:131], v[72:75], v[184:187]
M v[188:191], a[128:131], v[76:79], 0
s_add_u32 s25, s25, s3
M v[188:191], a[124:127], v[44:47], v[188:191]
s_waitcnt lgkmcnt(6)
M a[100:103], a[112:115], v[36:39], 0
M a[100:103], a[112:115], v[68:71], a[100:103]
M v[192:195], a[132:135], v[32:35], 0
s_lshl_b32 s26, s28, 7
M v[192:195], a[136:139], v[64:67], v[192:195]
ds_read_b128 a[164:167], v2 offset:38912
ds_read_b128 a[168:171], v2 offset:47104
M v[196:199], a[136:139], v[68:71], 0
s_lshl_b32 s42, s101, 11
M v[196:199], a[132:135], v[36:39], v[196:199]
M v[200:203], a[132:135], v[40:43], 0
s_add_u32 s44, s4, 83886080
s_addc_u32 s45, s5, 0
M v[200:203], a[136:139], v[72:75], v[200:203]
s_mov_b32 s46, 4194304
M v[204:207], a[136:139], v[76:79], 0
M v[204:207], a[132:135], v[44:47], v[204:207]
s_waitcnt lgkmcnt(6)
s_mov_b32 s47, 0x00020000
M a[104:107], a[112:115], v[40:43], 0
M a[104:107], a[112:115], v[72:75], a[104:107]
M v[208:211], a[140:143], v[32:35], 0
M v[208:211], a[144:147], v[64:67], v[208:211]
ds_read_b128 a[172:175], v2 offset:39936
ds_read_b128 a[176:179], v2 offset:48128
s_mov_b32 s50, 2097152
M v[212:215], a[144:147], v[68:71], 0
M v[212:215], a[140:143], v[36:39], v[212:215]
s_mov_b32 s51, 0x00020000
M v[216:219], a[140:143], v[40:43], 0
M v[216:219], a[144:147], v[72:75], v[216:219]
s_lshl_b32 s3, s101, 4
M v[220:223], a[144:147], v[76:79], 0
M v[220:223], a[140:143], v[44:47], v[220:223]
s_waitcnt lgkmcnt(6)
v_lshrrev_b32 v96, 3, v0
M a[108:111], a[112:115], v[44:47], 0
M a[108:111], a[112:115], v[76:79], a[108:111]
M v[224:227], a[148:151], v[32:35], 0
v_and_b32 v97, 6, v96
M v[224:227], a[152:155], v[64:67], v[224:227]
M v[228:231], a[152:155], v[68:71], 0
v_and_b32 v98, 7, v0
M v[228:231], a[148:151], v[36:39], v[228:231]
M v[232:235], a[148:151], v[40:43], 0
v_xor_b32 v97, v97, v98
M v[232:235], a[152:155], v[72:75], v[232:235]
M v[236:239], a[152:155], v[76:79], 0
v_add_u32 v96, s3, v96
M v[236:239], a[148:151], v[44:47], v[236:239]
s_waitcnt lgkmcnt(4)
M v[240:243], a[156:159], v[32:35], 0
v_lshlrev_b32 v96, 11, v96
M v[240:243], a[160:163], v[64:67], v[240:243]
M v[244:247], a[160:163], v[68:71], 0
v_lshl_add_u32 v99, v97, 4, v96
M v[244:247], a[156:159], v[36:39], v[244:247]
v_add_u32 v100, 15360, v99
M v[248:251], a[156:159], v[40:43], 0
M v[248:251], a[160:163], v[72:75], v[248:251]
s_waitcnt vmcnt(0) lgkmcnt(0)
s_barrier
v_cmp_ne_u32 vcc, 1, v7
s_nop 0
s_cbranch_vccnz Lk3_spinb1
Lk3_gotb1:
M v[252:255], a[160:163], v[76:79], 0
s_add_u32 m0, s42, 65536
s_nop 0
buffer_load_dwordx4 v99, s[48:51], s26 offen offset:0 lds
buffer_load_dwordx4 v100, s[48:51], s26 offen offset:1024 lds
M v[252:255], a[156:159], v[44:47], v[252:255]
buffer_load_dwordx4 a[192:195], v1, s[44:47], s25 offen offset:0 sc1
buffer_load_dwordx4 a[196:199], v1, s[44:47], s25 offen offset:1024 sc1
M a[64:67], a[164:167], v[32:35], 0
buffer_load_dwordx4 a[200:203], v1, s[44:47], s25 offen offset:2048 sc1
buffer_load_dwordx4 a[204:207], v1, s[44:47], s25 offen offset:3072 sc1
M a[64:67], a[168:171], v[64:67], a[64:67]
s_add_u32 s25, s25, 16384
s_add_u32 s26, s26, 131072
s_add_u32 m0, s42, 81920
s_nop 0
buffer_load_dwordx4 v99, s[48:51], s26 offen offset:0 lds
M a[68:71], a[168:171], v[68:71], 0
buffer_load_dwordx4 v100, s[48:51], s26 offen offset:1024 lds
buffer_load_dwordx4 a[208:211], v1, s[44:47], s25 offen offset:0 sc1
M a[68:71], a[164:167], v[36:39], a[68:71]
buffer_load_dwordx4 a[212:215], v1, s[44:47], s25 offen offset:1024 sc1
buffer_load_dwordx4 a[216:219], v1, s[44:47], s25 offen offset:2048 sc1
M a[72:75], a[164:167], v[40:43], 0
buffer_load_dwordx4 a[220:223], v1, s[44:47], s25 offen offset:3072 sc1
s_add_u32 s25, s25, 16384
s_add_u32 s26, s26, 131072
M a[72:75], a[168:171], v[72:75], a[72:75]
s_add_u32 m0, s42, 98304
s_nop 0
buffer_load_dwordx4 v99, s[48:51], s26 offen offset:0 lds
buffer_load_dwordx4 v100, s[48:51], s26 offen offset:1024 lds
M a[76:79], a[168:171], v[76:79], 0
buffer_load_dwordx4 a[224:227], v1, s[44:47], s25 offen offset:0 sc1
M a[76:79], a[164:167], v[44:47], a[76:79]
buffer_load_dwordx4 a[228:231], v1, s[44:47], s25 offen offset:1024 sc1
buffer_load_dwordx4 a[232:235], v1, s[44:47], s25 offen offset:2048 sc1
M a[80:83], a[172:175], v[32:35], 0
buffer_load_dwordx4 a[236:239], v1, s[44:47], s25 offen offset:3072 sc1
s_add_u32 s25, s25, 16384
s_add_u32 s26, s26, 131072
M a[80:83], a[176:179], v[64:67], a[80:83]
s_add_u32 m0, s42, 114688
s_nop 0
buffer_load_dwordx4 v99, s[48:51], s26 offen offset:0 lds
buffer_load_dwordx4 v100, s[48:51], s26 offen offset:1024 lds
M a[84:87], a[176:179], v[68:71], 0
buffer_load_dwordx4 a[240:243], v1, s[44:47], s25 offen offset:0 sc1
buffer_load_dwordx4 a[244:247], v1, s[44:47], s25 offen offset:1024 sc1
M a[84:87], a[172:175], v[36:39], a[84:87]
buffer_load_dwordx4 a[248:251], v1, s[44:47], s25 offen offset:2048 sc1
buffer_load_dwordx4 a[252:255], v1, s[44:47], s25 offen offset:3072 sc1
M a[88:91], a[172:175], v[40:43], 0
s_add_u32 s25, s25, 16384
s_add_u32 s26, s26, 131072
s_add_u32 m0, s42, 0
s_nop 0
buffer_load_dwordx4 v99, s[48:51], s26 offen offset:0 lds
M a[88:91], a[176:179], v[72:75], a[88:91]
buffer_load_dwordx4 v100, s[48:51], s26 offen offset:1024 lds
buffer_load_dwordx4 a[128:131], v1, s[44:47], s25 offen offset:0 sc1
M a[92:95], a[176:179], v[76:79], 0
buffer_load_dwordx4 a[132:135], v1, s[44:47], s25 offen offset:1024 sc1
buffer_load_dwordx4 a[136:139], v1, s[44:47], s25 offen offset:2048 sc1
M a[92:95], a[172:175], v[44:47], a[92:95]
buffer_load_dwordx4 a[140:143], v1, s[44:47], s25 offen offset:3072 sc1
s_add_u32 s25, s25, 16384
s_add_u32 s26, s26, 131072
s_branch Lk2_merge
Lk2_b0:
s_add_u32 m0, s29, 65536
s_waitcnt lgkmcnt(4)
M v[96:99], a[116:119], a[180:183], 0
v_exp_f32 v64, v64
M v[96:99], a[120:123], a[184:187], v[96:99]
ds_read_b128 a[148:151], v2 offset:8192
ds_read_b128 a[152:155], v2 offset:9216
M v[96:99], a[124:127], a[188:191], v[96:99]
v_exp_f32 v65, v65
M v[96:99], a[128:131], a[192:195], v[96:99]
buffer_load_dwordx4 v1, s[12:15], s25 offen offset:0 sc1 lds
s_add_u32 s32, s25, 4096
M v[100:103], a[128:131], a[208:211], 0
v_exp_f32 v66, v66
M v[100:103], a[124:127], a[204:207], v[100:103]
v_cvt_pk_bf16_f32 v64, v64, v65
M v[100:103], a[120:123], a[200:203], v[100:103]
v_exp_f32 v67, v67
M v[100:103], a[116:119], a[196:199], v[100:103]
buffer_load_dwordx4 v1, s[12:15], s25 offen offset:1024 sc1 lds
M v[104:107], a[116:119], a[212:215], 0
v_exp_f32 v80, v80
M v[104:107], a[120:123], a[216:219], v[104:107]
ds_read_b128 a[156:159], v2 offset:10240
ds_read_b128 a[160:163], v2 offset:11264
M v[104:107], a[124:127], a[220:223], v[104:107]
v_exp_f32 v81, v81
M v[104:107], a[128:131], a[224:227], v[104:107]
buffer_load_dwordx4 v1, s[12:15], s25 offen offset:2048 sc1 lds
M v[108:111], a[128:131], a[240:243], 0
v_exp_f32 v82, v82
M v[108:111], a[124:127], a[236:239], v[108:111]
v_cvt_pk_bf16_f32 v65, v66, v67
v_cvt_pk_bf16_f32 v66, v80, v81
M v[108:111], a[120:123], a[232:235], v[108:111]
v_exp_f32 v83, v83
M v[108:111], a[116:119], a[228:231], v[108:111]
buffer_load_dwordx4 v1, s[12:15], s25 offen offset:3072 sc1 lds
s_add_u32 m0, s29, 69632
s_waitcnt lgkmcnt(4)
M v[112:115], a[132:135], a[180:183], 0
v_exp_f32 v68, v68
M v[112:115], a[136:139], a[184:187], v[112:115]
ds_read_b128 a[164:167], v2 offset:12288
ds_read_b128 a[168:171], v2 offset:13312
M v[112:115], a[140:143], a[188:191], v[112:115]
v_exp_f32 v69, v69
M v[112:115], a[144:147], a[192:195], v[112:115]
buffer_load_dwordx4 v1, s[12:15], s32 offen offset:0 sc1 lds
M v[116:119], a[144:147], a[208:211], 0
v_exp_f32 v70, v70
M v[116:119], a[140:143], a[204:207], v[116:119]
v_cvt_pk_bf16_f32 v67, v82, v83
v_cvt_pk_bf16_f32 v68, v68, v69
M v[116:119], a[136:139], a[200:203], v[116:119]
v_exp_f32 v71, v71
M v[116:119], a[132:135], a[196:199], v[116:119]
buffer_load_dwordx4 v1, s[12:15], s32 offen offset:1024 sc1 lds
M v[120:123], a[132:135], a[212:215], 0
v_exp_f32 v84, v84
M v[120:123], a[136:139], a[216:219], v[120:123]
ds_read_b128 a[172:175], v2 offset:14336
ds_read_b128 a[176:179], v2 offset:15360
M v[120:123], a[140:143], a[220:223], v[120:123]
v_exp_f32 v85, v85
M v[120:123], a[144:147], a[224:227], v[120:123]
buffer_load_dwordx4 v1, s[12:15], s32 offen offset:2048 sc1 lds
M v[124:127], a[144:147], a[240:243], 0
v_exp_f32 v86, v86
M v[124:127], a[140:143], a[236:239], v[124:127]
v_cvt_pk_bf16_f32 v69, v70, v71
v_cvt_pk_bf16_f32 v70, v84, v85
M v[124:127], a[136:139], a[232:235], v[124:127]
v_exp_f32 v87, v87
M v[124:127], a[132:135], a[228:231], v[124:127]
buffer_load_dwordx4 v1, s[12:15], s32 offen offset:3072 sc1 lds
s_add_u32 m0, s29, 98304
s_waitcnt lgkmcnt(4)
M v[128:131], a[148:151], a[180:183], 0
v_exp_f32 v72, v72
M v[128:131], a[152:155], a[184:187], v[128:131]
ds_read_b128 a[116:119], v2 offset:32768
ds_read_b128 a[120:123], v2 offset:40960
M v[128:131], a[156:159], a[188:191], v[128:131]
v_exp_f32 v73, v73
M v[128:131], a[160:163], a[192:195], v[128:131]
buffer_load_dwordx4 v1, s[12:15], s26 offen offset:0 sc1 lds
s_add_u32 s43, s26, 4096
M v[132:135], a[160:163], a[208:211], 0
v_exp_f32 v74, v74
M v[132:135], a[156:159], a[204:207], v[132:135]
v_cvt_pk_bf16_f32 v71, v86, v87
v_cvt_pk_bf16_f32 v72, v72, v73
M v[132:135], a[152:155], a[200:203], v[132:135]
v_exp_f32 v75, v75
M v[132:135], a[148:151], a[196:199], v[132:135]
buffer_load_dwordx4 v1, s[12:15], s26 offen offset:1024 sc1 lds
M v[136:139], a[148:151], a[212:215], 0
v_exp_f32 v88, v88
M v[136:139], a[152:155], a[216:219], v[136:139]
ds_read_b128 a[124:127], v2 offset:33792
ds_read_b128 a[128:131], v2 offset:41984
M v[136:139], a[156:159], a[220:223], v[136:139]
v_exp_f32 v89, v89
M v[136:139], a[160:163], a[224:227], v[136:139]
buffer_load_dwordx4 v1, s[12:15], s26 offen offset:2048 sc1 lds
M v[140:143], a[160:163], a[240:243], 0
v_exp_f32 v90, v90
M v[140:143], a[156:159], a[236:239], v[140:143]
v_cvt_pk_bf16_f32 v73, v74, v75
v_cvt_pk_bf16_f32 v74, v88, v89
M v[140:143], a[152:155], a[232:235], v[140:143]
v_exp_f32 v91, v91
M v[140:143], a[148:151], a[228:231], v[140:143]
buffer_load_dwordx4 v1, s[12:15], s26 offen offset:3072 sc1 lds
s_add_u32 m0, s29, 102400
s_waitcnt lgkmcnt(4)
M v[144:147], a[164:167], a[180:183], 0
v_exp_f32 v76, v76
M v[144:147], a[168:171], a[184:187], v[144:147]
ds_read_b128 a[132:135], v2 offset:34816
ds_read_b128 a[136:139], v2 offset:43008
M v[144:147], a[172:175], a[188:191], v[144:147]
v_exp_f32 v77, v77
M v[144:147], a[176:179], a[192:195], v[144:147]
buffer_load_dwordx4 v1, s[12:15], s43 offen offset:0 sc1 lds
M v[148:151], a[176:179], a[208:211], 0
v_exp_f32 v78, v78
M v[148:151], a[172:175], a[204:207], v[148:151]
v_cvt_pk_bf16_f32 v75, v90, v91
v_cvt_pk_bf16_f32 v76, v76, v77
M v[148:151], a[168:171], a[200:203], v[148:151]
v_exp_f32 v79, v79
M v[148:151], a[164:167], a[196:199], v[148:151]
buffer_load_dwordx4 v1, s[12:15], s43 offen offset:1024 sc1 lds
M v[152:155], a[164:167], a[212:215], 0
v_exp_f32 v92, v92
M v[152:155], a[168:171], a[216:219], v[152:155]
ds_read_b128 a[140:143], v2 offset:35840
ds_read_b128 a[144:147], v2 offset:44032
M v[152:155], a[172:175], a[220:223], v[152:155]
v_exp_f32 v93, v93
M v[152:155], a[176:179], a[224:227], v[152:155]
buffer_load_dwordx4 v1, s[12:15], s43 offen offset:2048 sc1 lds
M v[156:159], a[176:179], a[240:243], 0
v_exp_f32 v94, v94
M v[156:159], a[172:175], a[236:239], v[156:159]
v_cvt_pk_bf16_f32 v77, v78, v79
v_cvt_pk_bf16_f32 v78, v92, v93
M v[156:159], a[168:171], a[232:235], v[156:159]
v_exp_f32 v95, v95
M v[156:159], a[164:167], a[228:231], v[156:159]
buffer_load_dwordx4 v1, s[12:15], s43 offen offset:3072 sc1 lds
v_cvt_pk_bf16_f32 v79, v94, v95
s_waitcnt lgkmcnt(6)
M v[160:163], a[116:119], v[32:35], 0
v_exp_f32 v96, v96
M v[160:163], a[120:123], v[64:67], v[160:163]
ds_read_b128 a[148:151], v2 offset:36864
ds_read_b128 a[152:155], v2 offset:45056
M v[164:167], a[120:123], v[68:71], 0
v_exp_f32 v97, v97
M v[164:167], a[116:119], v[36:39], v[164:167]
v_cvt_pk_bf16_f32 v96, v96, v97
M v[168:171], a[116:119], v[40:43], 0
v_exp_f32 v98, v98
M v[168:171], a[120:123], v[72:75], v[168:171]
s_add_u32 s25, s25, 32768
s_cmp_eq_u32 s25, s27
M v[172:175], a[120:123], v[76:79], 0
v_exp_f32 v99, v99
M v[172:175], a[116:119], v[44:47], v[172:175]
v_cvt_pk_bf16_f32 v97, v98, v99
s_waitcnt lgkmcnt(6)
M a[96:99], a[112:115], v[32:35], 0
s_cselect_b32 s25, s28, s25
s_cselect_b32 s27, -1, s27
M a[96:99], a[112:115], v[64:67], a[96:99]
s_add_u32 s26, s26, 32768
s_cmp_eq_u32 s26, s62
M v[176:179], a[124:127], v[32:35], 0
v_exp_f32 v112, v112
M v[176:179], a[128:131], v[64:67], v[176:179]
ds_read_b128 a[156:159], v2 offset:37888
ds_read_b128 a[160:163], v2 offset:46080
M v[180:183], a[128:131], v[68:71], 0
v_exp_f32 v113, v113
M v[180:183], a[124:127], v[36:39], v[180:183]
v_cvt_pk_bf16_f32 v98, v112, v113
M v[184:187], a[124:127], v[40:43], 0
v_exp_f32 v114, v114
M v[184:187], a[128:131], v[72:75], v[184:187]
s_cselect_b32 s26, s63, s26
s_cselect_b32 s62, -1, s62
M v[188:191], a[128:131], v[76:79], 0
v_exp_f32 v115, v115
M v[188:191], a[124:127], v[44:47], v[188:191]
v_cvt_pk_bf16_f32 v99, v114, v115
s_waitcnt lgkmcnt(6)
M a[100:103], a[112:115], v[36:39], 0
M a[100:103], a[112:115], v[68:71], a[100:103]
M v[192:195], a[132:135], v[32:35], 0
v_exp_f32 v100, v100
M v[192:195], a[136:139], v[64:67], v[192:195]
ds_read_b128 a[164:167], v2 offset:38912
ds_read_b128 a[168:171], v2 offset:47104
M v[196:199], a[136:139], v[68:71], 0
v_exp_f32 v101, v101
M v[196:199], a[132:135], v[36:39], v[196:199]
v_cvt_pk_bf16_f32 v100, v100, v101
M v[200:203], a[132:135], v[40:43], 0
v_exp_f32 v102, v102
M v[200:203], a[136:139], v[72:75], v[200:203]
M v[204:207], a[136:139], v[76:79], 0
v_exp_f32 v103, v103
M v[204:207], a[132:135], v[44:47], v[204:207]
v_cvt_pk_bf16_f32 v101, v102, v103
s_waitcnt lgkmcnt(6)
M a[104:107], a[112:115], v[40:43], 0
M a[104:107], a[112:115], v[72:75], a[104:107]
M v[208:211], a[140:143], v[32:35], 0
v_exp_f32 v116, v116
M v[208:211], a[144:147], v[64:67], v[208:211]
ds_read_b128 a[172:175], v2 offset:39936
ds_read_b128 a[176:179], v2 offset:48128
M v[212:215], a[144:147], v[68:71], 0
v_exp_f32 v117, v117
M v[212:215], a[140:143], v[36:39], v[212:215]
v_cvt_pk_bf16_f32 v102, v116, v117
M v[216:219], a[140:143], v[40:43], 0
v_exp_f32 v118, v118
M v[216:219], a[144:147], v[72:75], v[216:219]
M v[220:223], a[144:147], v[76:79], 0
v_exp_f32 v119, v119
M v[220:223], a[140:143], v[44:47], v[220:223]
v_cvt_pk_bf16_f32 v103, v118, v119
s_waitcnt lgkmcnt(6)
M a[108:111], a[112:115], v[44:47], 0
M a[108:111], a[112:115], v[76:79], a[108:111]
M v[224:227], a[148:151], v[32:35], 0
v_exp_f32 v104, v104
M v[224:227], a[152:155], v[64:67], v[224:227]
M v[228:231], a[152:155], v[68:71], 0
v_exp_f32 v105, v105
M v[228:231], a[148:151], v[36:39], v[228:231]
v_cvt_pk_bf16_f32 v104, v104, v105
M v[232:235], a[148:151], v[40:43], 0
v_exp_f32 v106, v106
M v[232:235], a[152:155], v[72:75], v[232:235]
M v[236:239], a[152:155], v[76:79], 0
v_exp_f32 v107, v107
M v[236:239], a[148:151], v[44:47], v[236:239]
v_cvt_pk_bf16_f32 v105, v106, v107
s_waitcnt lgkmcnt(4)
M v[240:243], a[156:159], v[32:35], 0
v_exp_f32 v120, v120
M v[240:243], a[160:163], v[64:67], v[240:243]
M v[244:247], a[160:163], v[68:71], 0
v_exp_f32 v121, v121
M v[244:247], a[156:159], v[36:39], v[244:247]
v_cvt_pk_bf16_f32 v106, v120, v121
M v[248:251], a[156:159], v[40:43], 0
v_exp_f32 v122, v122
M v[248:251], a[160:163], v[72:75], v[248:251]
s_waitcnt vmcnt(0) lgkmcnt(0)
s_barrier
ds_read_b128 a[116:119], v3 offset:0
ds_read_b128 a[120:123], v3 offset:1024
M v[252:255], a[160:163], v[76:79], 0
v_exp_f32 v123, v123
M v[252:255], a[156:159], v[44:47], v[252:255]
v_cvt_pk_bf16_f32 v107, v122, v123
M a[64:67], a[164:167], v[32:35], 0
v_exp_f32 v108, v108
M a[64:67], a[168:171], v[64:67], a[64:67]
ds_read_b128 a[124:127], v3 offset:2048
ds_read_b128 a[128:131], v3 offset:3072
M a[68:71], a[168:171], v[68:71], 0
v_exp_f32 v109, v109
M a[68:71], a[164:167], v[36:39], a[68:71]
v_cvt_pk_bf16_f32 v108, v108, v109
M a[72:75], a[164:167], v[40:43], 0
v_exp_f32 v110, v110
M a[72:75], a[168:171], v[72:75], a[72:75]
ds_read_b128 a[132:135], v3 offset:4096
ds_read_b128 a[136:139], v3 offset:5120
M a[76:79], a[168:171], v[76:79], 0
v_exp_f32 v111, v111
M a[76:79], a[164:167], v[44:47], a[76:79]
v_cvt_pk_bf16_f32 v109, v110, v111
M a[80:83], a[172:175], v[32:35], 0
v_exp_f32 v124, v124
M a[80:83], a[176:179], v[64:67], a[80:83]
ds_read_b128 a[140:143], v3 offset:6144
ds_read_b128 a[144:147], v3 offset:7168
M a[84:87], a[176:179], v[68:71], 0
v_exp_f32 v125, v125
M a[84:87], a[172:175], v[36:39], a[84:87]
v_cvt_pk_bf16_f32 v110, v124, v125
M a[88:91], a[172:175], v[40:43], 0
v_exp_f32 v126, v126
M a[88:91], a[176:179], v[72:75], a[88:91]
M a[92:95], a[176:179], v[76:79], 0
v_exp_f32 v127, v127
M a[92:95], a[172:175], v[44:47], a[92:95]
v_cvt_pk_bf16_f32 v111, v126, v127
s_branch Lk2_l2b
Lk2_l2:
s_add_u32 m0, s29, 65536
s_waitcnt lgkmcnt(4)
M v[96:99], a[116:119], a[180:183], 0
v_exp_f32 v64, v64
M v[96:99], a[120:123], a[184:187], v[96:99]
ds_read_b128 a[148:151], v2 offset:8192
ds_read_b128 a[152:155], v2 offset:9216
M v[96:99], a[124:127], a[188:191], v[96:99]
v_exp_f32 v65, v65
M v[96:99], a[128:131], a[192:195], v[96:99]
buffer_load_dwordx4 v1, s[12:15], s25 offen offset:0 sc1 lds
s_add_u32 s32, s25, 4096
M v[100:103], a[128:131], a[208:211], 0
v_exp_f32 v66, v66
M v[100:103], a[124:127], a[204:207], v[100:103]
v_cvt_pk_bf16_f32 v64, v64, v65
M v[100:103], a[120:123], a[200:203], v[100:103]
v_exp_f32 v67, v67
M v[100:103], a[116:119], a[196:199], v[100:103]
buffer_load_dwordx4 v1, s[12:15], s25 offen offset:1024 sc1 lds
M v[104:107], a[116:119], a[212:215], 0
v_exp_f32 v80, v80
M v[104:107], a[120:123], a[216:219], v[104:107]
ds_read_b128 a[156:159], v2 offset:10240
ds_read_b128 a[160:163], v2 offset:11264
M v[104:107], a[124:127], a[220:223], v[104:107]
v_exp_f32 v81, v81
M v[104:107], a[128:131], a[224:227], v[104:107]
buffer_load_dwordx4 v1, s[12:15], s25 offen offset:2048 sc1 lds
M v[108:111], a[128:131], a[240:243], 0
v_exp_f32 v82, v82
M v[108:111], a[124:127], a[236:239], v[108:111]
v_cvt_pk_bf16_f32 v65, v66, v67
v_cvt_pk_bf16_f32 v66, v80, v81
M v[108:111], a[120:123], a[232:235], v[108:111]
v_exp_f32 v83, v83
M v[108:111], a[116:119], a[228:231], v[108:111]
buffer_load_dwordx4 v1, s[12:15], s25 offen offset:3072 sc1 lds
s_add_u32 m0, s29, 69632
s_waitcnt lgkmcnt(4)
M v[112:115], a[132:135], a[180:183], 0
v_exp_f32 v68, v68
M v[112:115], a[136:139], a[184:187], v[112:115]
ds_read_b128 a[164:167], v2 offset:12288
ds_read_b128 a[168:171], v2 offset:13312
M v[112:115], a[140:143], a[188:191], v[112:115]
v_exp_f32 v69, v69
M v[112:115], a[144:147], a[192:195], v[112:115]
buffer_load_dwordx4 v1, s[12:15], s32 offen offset:0 sc1 lds
M v[116:119], a[144:147], a[208:211], 0
v_exp_f32 v70, v70
M v[116:119], a[140:143], a[204:207], v[116:119]
v_cvt_pk_bf16_f32 v67, v82, v83
v_cvt_pk_bf16_f32 v68, v68, v69
M v[116:119], a[136:139], a[200:203], v[116:119]
v_exp_f32 v71, v71
M v[116:119], a[132:135], a[196:199], v[116:119]
buffer_load_dwordx4 v1, s[12:15], s32 offen offset:1024 sc1 lds
M v[120:123], a[132:135], a[212:215], 0
v_exp_f32 v84, v84
M v[120:123], a[136:139], a[216:219], v[120:123]
ds_read_b128 a[172:175], v2 offset:14336
ds_read_b128 a[176:179], v2 offset:15360
M v[120:123], a[140:143], a[220:223], v[120:123]
v_exp_f32 v85, v85
M v[120:123], a[144:147], a[224:227], v[120:123]
buffer_load_dwordx4 v1, s[12:15], s32 offen offset:2048 sc1 lds
M v[124:127], a[144:147], a[240:243], 0
v_exp_f32 v86, v86
M v[124:127], a[140:143], a[236:239], v[124:127]
v_cvt_pk_bf16_f32 v69, v70, v71
v_cvt_pk_bf16_f32 v70, v84, v85
M v[124:127], a[136:139], a[232:235], v[124:127]
v_exp_f32 v87, v87
M v[124:127], a[132:135], a[228:231], v[124:127]
buffer_load_dwordx4 v1, s[12:15], s32 offen offset:3072 sc1 lds
s_add_u32 m0, s29, 98304
s_waitcnt lgkmcnt(4)
M v[128:131], a[148:151], a[180:183], 0
v_exp_f32 v72, v72
M v[128:131], a[152:155], a[184:187], v[128:131]
ds_read_b128 a[116:119], v2 offset:32768
ds_read_b128 a[120:123], v2 offset:40960
M v[128:131], a[156:159], a[188:191], v[128:131]
v_exp_f32 v73, v73
M v[128:131], a[160:163], a[192:195], v[128:131]
buffer_load_dwordx4 v1, s[12:15], s26 offen offset:0 sc1 lds
s_add_u32 s43, s26, 4096
M v[132:135], a[160:163], a[208:211], 0
v_exp_f32 v74, v74
M v[132:135], a[156:159], a[204:207], v[132:135]
v_cvt_pk_bf16_f32 v71, v86, v87
v_cvt_pk_bf16_f32 v72, v72, v73
M v[132:135], a[152:155], a[200:203], v[132:135]
v_exp_f32 v75, v75
M v[132:135], a[148:151], a[196:199], v[132:135]
buffer_load_dwordx4 v1, s[12:15], s26 offen offset:1024 sc1 lds
M v[136:139], a[148:151], a[212:215], 0
v_exp_f32 v88, v88
M v[136:139], a[152:155], a[216:219], v[136:139]
ds_read_b128 a[124:127], v2 offset:33792
ds_read_b128 a[128:131], v2 offset:41984
M v[136:139], a[156:159], a[220:223], v[136:139]
v_exp_f32 v89, v89
M v[136:139], a[160:163], a[224:227], v[136:139]
buffer_load_dwordx4 v1, s[12:15], s26 offen offset:2048 sc1 lds
M v[140:143], a[160:163], a[240:243], 0
v_exp_f32 v90, v90
M v[140:143], a[156:159], a[236:239], v[140:143]
v_cvt_pk_bf16_f32 v73, v74, v75
v_cvt_pk_bf16_f32 v74, v88, v89
M v[140:143], a[152:155], a[232:235], v[140:143]
v_exp_f32 v91, v91
M v[140:143], a[148:151], a[228:231], v[140:143]
buffer_load_dwordx4 v1, s[12:15], s26 offen offset:3072 sc1 lds
s_add_u32 m0, s29, 102400
s_waitcnt lgkmcnt(4)
M v[144:147], a[164:167], a[180:183], 0
v_exp_f32 v76, v76
M v[144:147], a[168:171], a[184:187], v[144:147]
ds_read_b128 a[132:135], v2 offset:34816
ds_read_b128 a[136:139], v2 offset:43008
M v[144:147], a[172:175], a[188:191], v[144:147]
v_exp_f32 v77, v77
M v[144:147], a[176:179], a[192:195], v[144:147]
buffer_load_dwordx4 v1, s[12:15], s43 offen offset:0 sc1 lds
M v[148:151], a[176:179], a[208:211], 0
v_exp_f32 v78, v78
M v[148:151], a[172:175], a[204:207], v[148:151]
v_cvt_pk_bf16_f32 v75, v90, v91
v_cvt_pk_bf16_f32 v76, v76, v77
M v[148:151], a[168:171], a[200:203], v[148:151]
v_exp_f32 v79, v79
M v[148:151], a[164:167], a[196:199], v[148:151]
buffer_load_dwordx4 v1, s[12:15], s43 offen offset:1024 sc1 lds
M v[152:155], a[164:167], a[212:215], 0
v_exp_f32 v92, v92
M v[152:155], a[168:171], a[216:219], v[152:155]
ds_read_b128 a[140:143], v2 offset:35840
ds_read_b128 a[144:147], v2 offset:44032
M v[152:155], a[172:175], a[220:223], v[152:155]
v_exp_f32 v93, v93
M v[152:155], a[176:179], a[224:227], v[152:155]
buffer_load_dwordx4 v1, s[12:15], s43 offen offset:2048 sc1 lds
M v[156:159], a[176:179], a[240:243], 0
v_exp_f32 v94, v94
M v[156:159], a[172:175], a[236:239], v[156:159]
v_cvt_pk_bf16_f32 v77, v78, v79
v_cvt_pk_bf16_f32 v78, v92, v93
M v[156:159], a[168:171], a[232:235], v[156:159]
v_exp_f32 v95, v95
M v[156:159], a[164:167], a[228:231], v[156:159]
buffer_load_dwordx4 v1, s[12:15], s43 offen offset:3072 sc1 lds
v_cvt_pk_bf16_f32 v79, v94, v95
s_waitcnt lgkmcnt(6)
M v[160:163], a[116:119], v[32:35], v[160:163]
v_exp_f32 v96, v96
M v[160:163], a[120:123], v[64:67], v[160:163]
ds_read_b128 a[148:151], v2 offset:36864
ds_read_b128 a[152:155], v2 offset:45056
M v[164:167], a[120:123], v[68:71], v[164:167]
v_exp_f32 v97, v97
M v[164:167], a[116:119], v[36:39], v[164:167]
v_cvt_pk_bf16_f32 v96, v96, v97
M v[168:171], a[116:119], v[40:43], v[168:171]
v_exp_f32 v98, v98
M v[168:171], a[120:123], v[72:75], v[168:171]
s_add_u32 s25, s25, 32768
s_cmp_eq_u32 s25, s27
M v[172:175], a[120:123], v[76:79], v[172:175]
v_exp_f32 v99, v99
M v[172:175], a[116:119], v[44:47], v[172:175]
v_cvt_pk_bf16_f32 v97, v98, v99
s_waitcnt lgkmcnt(6)
M a[96:99], a[112:115], v[32:35], a[96:99]
s_cselect_b32 s25, s28, s25
s_cselect_b32 s27, -1, s27
M a[96:99], a[112:115], v[64:67], a[96:99]
s_add_u32 s26, s26, 32768
s_cmp_eq_u32 s26, s62
M v[176:179], a[124:127], v[32:35], v[176:179]
v_exp_f32 v112, v112
M v[176:179], a[128:131], v[64:67], v[176:179]
ds_read_b128 a[156:159], v2 offset:37888
ds_read_b128 a[160:163], v2 offset:46080
M v[180:183], a[128:131], v[68:71], v[180:183]
v_exp_f32 v113, v113
M v[180:183], a[124:127], v[36:39], v[180:183]
v_cvt_pk_bf16_f32 v98, v112, v113
M v[184:187], a[124:127], v[40:43], v[184:187]
v_exp_f32 v114, v114
M v[184:187], a[128:131], v[72:75], v[184:187]
s_cselect_b32 s26, s63, s26
s_cselect_b32 s62, -1, s62
M v[188:191], a[128:131], v[76:79], v[188:191]
v_exp_f32 v115, v115
M v[188:191], a[124:127], v[44:47], v[188:191]
v_cvt_pk_bf16_f32 v99, v114, v115
s_waitcnt lgkmcnt(6)
M a[100:103], a[112:115], v[36:39], a[100:103]
M a[100:103], a[112:115], v[68:71], a[100:103]
M v[192:195], a[132:135], v[32:35], v[192:195]
v_exp_f32 v100, v100
M v[192:195], a[136:139], v[64:67], v[192:195]
ds_read_b128 a[164:167], v2 offset:38912
ds_read_b128 a[168:171], v2 offset:47104
M v[196:199], a[136:139], v[68:71], v[196:199]
v_exp_f32 v101, v101
M v[196:199], a[132:135], v[36:39], v[196:199]
v_cvt_pk_bf16_f32 v100, v100, v101
M v[200:203], a[132:135], v[40:43], v[200:203]
v_exp_f32 v102, v102
M v[200:203], a[136:139], v[72:75], v[200:203]
M v[204:207], a[136:139], v[76:79], v[204:207]
v_exp_f32 v103, v103
M v[204:207], a[132:135], v[44:47], v[204:207]
v_cvt_pk_bf16_f32 v101, v102, v103
s_waitcnt lgkmcnt(6)
M a[104:107], a[112:115], v[40:43], a[104:107]
M a[104:107], a[112:115], v[72:75], a[104:107]
M v[208:211], a[140:143], v[32:35], v[208:211]
v_exp_f32 v116, v116
M v[208:211], a[144:147], v[64:67], v[208:211]
ds_read_b128 a[172:175], v2 offset:39936
ds_read_b128 a[176:179], v2 offset:48128
M v[212:215], a[144:147], v[68:71], v[212:215]
v_exp_f32 v117, v117
M v[212:215], a[140:143], v[36:39], v[212:215]
v_cvt_pk_bf16_f32 v102, v116, v117
M v[216:219], a[140:143], v[40:43], v[216:219]
v_exp_f32 v118, v118
M v[216:219], a[144:147], v[72:75], v[216:219]
M v[220:223], a[144:147], v[76:79], v[220:223]
v_exp_f32 v119, v119
M v[220:223], a[140:143], v[44:47], v[220:223]
v_cvt_pk_bf16_f32 v103, v118, v119
s_waitcnt lgkmcnt(6)
M a[108:111], a[112:115], v[44:47], a[108:111]
M a[108:111], a[112:115], v[76:79], a[108:111]
M v[224:227], a[148:151], v[32:35], v[224:227]
v_exp_f32 v104, v104
M v[224:227], a[152:155], v[64:67], v[224:227]
M v[228:231], a[152:155], v[68:71], v[228:231]
v_exp_f32 v105, v105
M v[228:231], a[148:151], v[36:39], v[228:231]
v_cvt_pk_bf16_f32 v104, v104, v105
M v[232:235], a[148:151], v[40:43], v[232:235]
v_exp_f32 v106, v106
M v[232:235], a[152:155], v[72:75], v[232:235]
M v[236:239], a[152:155], v[76:79], v[236:239]
v_exp_f32 v107, v107
M v[236:239], a[148:151], v[44:47], v[236:239]
v_cvt_pk_bf16_f32 v105, v106, v107
s_waitcnt lgkmcnt(4)
M v[240:243], a[156:159], v[32:35], v[240:243]
v_exp_f32 v120, v120
M v[240:243], a[160:163], v[64:67], v[240:243]
M v[244:247], a[160:163], v[68:71], v[244:247]
v_exp_f32 v121, v121
M v[244:247], a[156:159], v[36:39], v[244:247]
v_cvt_pk_bf16_f32 v106, v120, v121
M v[248:251], a[156:159], v[40:43], v[248:251]
v_exp_f32 v122, v122
M v[248:251], a[160:163], v[72:75], v[248:251]
s_waitcnt vmcnt(0) lgkmcnt(0)
s_barrier
ds_read_b128 a[116:119], v3 offset:0
ds_read_b128 a[120:123], v3 offset:1024
M v[252:255], a[160:163], v[76:79], v[252:255]
v_exp_f32 v123, v123
M v[252:255], a[156:159], v[44:47], v[252:255]
v_cvt_pk_bf16_f32 v107, v122, v123
M a[64:67], a[164:167], v[32:35], a[64:67]
v_exp_f32 v108, v108
M a[64:67], a[168:171], v[64:67], a[64:67]
ds_read_b128 a[124:127], v3 offset:2048
ds_read_b128 a[128:131], v3 offset:3072
M a[68:71], a[168:171], v[68:71], a[68:71]
v_exp_f32 v109, v109
M a[68:71], a[164:167], v[36:39], a[68:71]
v_cvt_pk_bf16_f32 v108, v108, v109
M a[72:75], a[164:167], v[40:43], a[72:75]
v_exp_f32 v110, v110
M a[72:75], a[168:171], v[72:75], a[72:75]
ds_read_b128 a[132:135], v3 offset:4096
ds_read_b128 a[136:139], v3 offset:5120
M a[76:79], a[168:171], v[76:79], a[76:79]
v_exp_f32 v111, v111
M a[76:79], a[164:167], v[44:47], a[76:79]
v_cvt_pk_bf16_f32 v109, v110, v111
M a[80:83], a[172:175], v[32:35], a[80:83]
v_exp_f32 v124, v124
M a[80:83], a[176:179], v[64:67], a[80:83]
ds_read_b128 a[140:143], v3 offset:6144
ds_read_b128 a[144:147], v3 offset:7168
M a[84:87], a[176:179], v[68:71], a[84:87]
v_exp_f32 v125, v125
M a[84:87], a[172:175], v[36:39], a[84:87]
v_cvt_pk_bf16_f32 v110, v124, v125
M a[88:91], a[172:175], v[40:43], a[88:91]
v_exp_f32 v126, v126
M a[88:91], a[176:179], v[72:75], a[88:91]
M a[92:95], a[176:179], v[76:79], a[92:95]
v_exp_f32 v127, v127
M a[92:95], a[172:175], v[44:47], a[92:95]
v_cvt_pk_bf16_f32 v111, v126, v127
Lk2_l2b:
s_add_u32 m0, s29, 0
s_waitcnt lgkmcnt(4)
M v[32:35], a[116:119], a[180:183], 0
v_exp_f32 v128, v128
M v[32:35], a[120:123], a[184:187], v[32:35]
ds_read_b128 a[148:151], v3 offset:8192
ds_read_b128 a[152:155], v3 offset:9216
M v[32:35], a[124:127], a[188:191], v[32:35]
v_exp_f32 v129, v129
M v[32:35], a[128:131], a[192:195], v[32:35]
buffer_load_dwordx4 v1, s[12:15], s25 offen offset:0 sc1 lds
s_add_u32 s32, s25, 4096
M v[36:39], a[128:131], a[208:211], 0
v_exp_f32 v130, v130
M v[36:39], a[124:127], a[204:207], v[36:39]
v_cvt_pk_bf16_f32 v128, v128, v129
M v[36:39], a[120:123], a[200:203], v[36:39]
v_exp_f32 v131, v131
M v[36:39], a[116:119], a[196:199], v[36:39]
buffer_load_dwordx4 v1, s[12:15], s25 offen offset:1024 sc1 lds
M v[40:43], a[116:119], a[212:215], 0
v_exp_f32 v144, v144
M v[40:43], a[120:123], a[216:219], v[40:43]
ds_read_b128 a[156:159], v3 offset:10240
ds_read_b128 a[160:163], v3 offset:11264
M v[40:43], a[124:127], a[220:223], v[40:43]
v_exp_f32 v145, v145
M v[40:43], a[128:131], a[224:227], v[40:43]
buffer_load_dwordx4 v1, s[12:15], s25 offen offset:2048 sc1 lds
M v[44:47], a[128:131], a[240:243], 0
v_exp_f32 v146, v146
M v[44:47], a[124:127], a[236:239], v[44:47]
v_cvt_pk_bf16_f32 v129, v130, v131
v_cvt_pk_bf16_f32 v130, v144, v145
M v[44:47], a[120:123], a[232:235], v[44:47]
v_exp_f32 v147, v147
M v[44:47], a[116:119], a[228:231], v[44:47]
buffer_load_dwordx4 v1, s[12:15], s25 offen offset:3072 sc1 lds
s_add_u32 m0, s29, 4096
s_waitcnt lgkmcnt(4)
M v[48:51], a[132:135], a[180:183], 0
v_exp_f32 v132, v132
M v[48:51], a[136:139], a[184:187], v[48:51]
ds_read_b128 a[164:167], v3 offset:12288
ds_read_b128 a[168:171], v3 offset:13312
M v[48:51], a[140:143], a[188:191], v[48:51]
v_exp_f32 v133, v133
M v[48:51], a[144:147], a[192:195], v[48:51]
buffer_load_dwordx4 v1, s[12:15], s32 offen offset:0 sc1 lds
M v[52:55], a[144:147], a[208:211], 0
v_exp_f32 v134, v134
M v[52:55], a[140:143], a[204:207], v[52:55]
v_cvt_pk_bf16_f32 v131, v146, v147
v_cvt_pk_bf16_f32 v132, v132, v133
M v[52:55], a[136:139], a[200:203], v[52:55]
v_exp_f32 v135, v135
M v[52:55], a[132:135], a[196:199], v[52:55]
buffer_load_dwordx4 v1, s[12:15], s32 offen offset:1024 sc1 lds
M v[56:59], a[132:135], a[212:215], 0
v_exp_f32 v148, v148
M v[56:59], a[136:139], a[216:219], v[56:59]
ds_read_b128 a[172:175], v3 offset:14336
ds_read_b128 a[176:179], v3 offset:15360
M v[56:59], a[140:143], a[220:223], v[56:59]
v_exp_f32 v149, v149
M v[56:59], a[144:147], a[224:227], v[56:59]
buffer_load_dwordx4 v1, s[12:15], s32 offen offset:2048 sc1 lds
M v[60:63], a[144:147], a[240:243], 0
v_exp_f32 v150, v150
M v[60:63], a[140:143], a[236:239], v[60:63]
v_cvt_pk_bf16_f32 v133, v134, v135
v_cvt_pk_bf16_f32 v134, v148, v149
M v[60:63], a[136:139], a[232:235], v[60:63]
v_exp_f32 v151, v151
M v[60:63], a[132:135], a[228:231], v[60:63]
buffer_load_dwordx4 v1, s[12:15], s32 offen offset:3072 sc1 lds
s_add_u32 m0, s29, 32768
s_waitcnt lgkmcnt(4)
M v[64:67], a[148:151], a[180:183], 0
v_exp_f32 v136, v136
M v[64:67], a[152:155], a[184:187], v[64:67]
ds_read_b128 a[116:119], v3 offset:32768
ds_read_b128 a[120:123], v3 offset:40960
M v[64:67], a[156:159], a[188:191], v[64:67]
v_exp_f32 v137, v137
M v[64:67], a[160:163], a[192:195], v[64:67]
buffer_load_dwordx4 v1, s[12:15], s26 offen offset:0 sc1 lds
s_add_u32 s43, s26, 4096
M v[68:71], a[160:163], a[208:211], 0
v_exp_f32 v138, v138
M v[68:71], a[156:159], a[204:207], v[68:71]
v_cvt_pk_bf16_f32 v135, v150, v151
v_cvt_pk_bf16_f32 v136, v136, v137
M v[68:71], a[152:155], a[200:203], v[68:71]
v_exp_f32 v139, v139
M v[68:71], a[148:151], a[196:199], v[68:71]
buffer_load_dwordx4 v1, s[12:15], s26 offen offset:1024 sc1 lds
M v[72:75], a[148:151], a[212:215], 0
v_exp_f32 v152, v152
M v[72:75], a[152:155], a[216:219], v[72:75]
ds_read_b128 a[124:127], v3 offset:33792
ds_read_b128 a[128:131], v3 offset:41984
M v[72:75], a[156:159], a[220:223], v[72:75]
v_exp_f32 v153, v153
M v[72:75], a[160:163], a[224:227], v[72:75]
buffer_load_dwordx4 v1, s[12:15], s26 offen offset:2048 sc1 lds
M v[76:79], a[160:163], a[240:243], 0
v_exp_f32 v154, v154
M v[76:79], a[156:159], a[236:239], v[76:79]
v_cvt_pk_bf16_f32 v137, v138, v139
v_cvt_pk_bf16_f32 v138, v152, v153
M v[76:79], a[152:155], a[232:235], v[76:79]
v_exp_f32 v155, v155
M v[76:79], a[148:151], a[228:231], v[76:79]
buffer_load_dwordx4 v1, s[12:15], s26 offen offset:3072 sc1 lds
s_add_u32 m0, s29, 36864
s_waitcnt lgkmcnt(4)
M v[80:83], a[164:167], a[180:183], 0
v_exp_f32 v140, v140
M v[80:83], a[168:171], a[184:187], v[80:83]
ds_read_b128 a[132:135], v3 offset:34816
ds_read_b128 a[136:139], v3 offset:43008
M v[80:83], a[172:175], a[188:191], v[80:83]
v_exp_f32 v141, v141
M v[80:83], a[176:179], a[192:195], v[80:83]
buffer_load_dwordx4 v1, s[12:15], s43 offen offset:0 sc1 lds
M v[84:87], a[176:179], a[208:211], 0
v_exp_f32 v142, v142
M v[84:87], a[172:175], a[204:207], v[84:87]
v_cvt_pk_bf16_f32 v139, v154, v155
v_cvt_pk_bf16_f32 v140, v140, v141
M v[84:87], a[168:171], a[200:203], v[84:87]
v_exp_f32 v143, v143
M v[84:87], a[164:167], a[196:199], v[84:87]
buffer_load_dwordx4 v1, s[12:15], s43 offen offset:1024 sc1 lds
M v[88:91], a[164:167], a[212:215], 0
v_exp_f32 v156, v156
M v[88:91], a[168:171], a[216:219], v[88:91]
ds_read_b128 a[140:143], v3 offset:35840
ds_read_b128 a[144:147], v3 offset:44032
M v[88:91], a[172:175], a[220:223], v[88:91]
v_exp_f32 v157, v157
M v[88:91], a[176:179], a[224:227], v[88:91]
buffer_load_dwordx4 v1, s[12:15], s43 offen offset:2048 sc1 lds
M v[92:95], a[176:179], a[240:243], 0
v_exp_f32 v158, v158
M v[92:95], a[172:175], a[236:239], v[92:95]
v_cvt_pk_bf16_f32 v141, v142, v143
v_cvt_pk_bf16_f32 v142, v156, v157
M v[92:95], a[168:171], a[232:235], v[92:95]
v_exp_f32 v159, v159
M v[92:95], a[164:167], a[228:231], v[92:95]
buffer_load_dwordx4 v1, s[12:15], s43 offen offset:3072 sc1 lds
v_cvt_pk_bf16_f32 v143, v158, v159
s_waitcnt lgkmcnt(6)
M v[160:163], a[116:119], v[96:99], v[160:163]
v_exp_f32 v32, v32
M v[160:163], a[120:123], v[128:131], v[160:163]
ds_read_b128 a[148:151], v3 offset:36864
ds_read_b128 a[152:155], v3 offset:45056
M v[164:167], a[120:123], v[132:135], v[164:167]
v_exp_f32 v33, v33
M v[164:167], a[116:119], v[100:103], v[164:167]
v_cvt_pk_bf16_f32 v32, v32, v33
M v[168:171], a[116:119], v[104:107], v[168:171]
v_exp_f32 v34, v34
M v[168:171], a[120:123], v[136:139], v[168:171]
s_add_u32 s25, s25, 32768
s_cmp_eq_u32 s25, s27
M v[172:175], a[120:123], v[140:143], v[172:175]
v_exp_f32 v35, v35
M v[172:175], a[116:119], v[108:111], v[172:175]
v_cvt_pk_bf16_f32 v33, v34, v35
s_waitcnt lgkmcnt(6)
M a[96:99], a[112:115], v[96:99], a[96:99]
s_cselect_b32 s25, s28, s25
s_cselect_b32 s27, -1, s27
M a[96:99], a[112:115], v[128:131], a[96:99]
s_add_u32 s26, s26, 32768
s_cmp_eq_u32 s26, s62
M v[176:179], a[124:127], v[96:99], v[176:179]
v_exp_f32 v48, v48
M v[176:179], a[128:131], v[128:131], v[176:179]
ds_read_b128 a[156:159], v3 offset:37888
ds_read_b128 a[160:163], v3 offset:46080
M v[180:183], a[128:131], v[132:135], v[180:183]
v_exp_f32 v49, v49
M v[180:183], a[124:127], v[100:103], v[180:183]
v_cvt_pk_bf16_f32 v34, v48, v49
M v[184:187], a[124:127], v[104:107], v[184:187]
v_exp_f32 v50, v50
M v[184:187], a[128:131], v[136:139], v[184:187]
s_cselect_b32 s26, s63, s26
s_cselect_b32 s62, -1, s62
M v[188:191], a[128:131], v[140:143], v[188:191]
v_exp_f32 v51, v51
M v[188:191], a[124:127], v[108:111], v[188:191]
v_cvt_pk_bf16_f32 v35, v50, v51
s_waitcnt lgkmcnt(6)
M a[100:103], a[112:115], v[100:103], a[100:103]
M a[100:103], a[112:115], v[132:135], a[100:103]
M v[192:195], a[132:135], v[96:99], v[192:195]
v_exp_f32 v36, v36
M v[192:195], a[136:139], v[128:131], v[192:195]
ds_read_b128 a[164:167], v3 offset:38912
ds_read_b128 a[168:171], v3 offset:47104
M v[196:199], a[136:139], v[132:135], v[196:199]
v_exp_f32 v37, v37
M v[196:199], a[132:135], v[100:103], v[196:199]
v_cvt_pk_bf16_f32 v36, v36, v37
M v[200:203], a[132:135], v[104:107], v[200:203]
v_exp_f32 v38, v38
M v[200:203], a[136:139], v[136:139], v[200:203]
M v[204:207], a[136:139], v[140:143], v[204:207]
v_exp_f32 v39, v39
M v[204:207], a[132:135], v[108:111], v[204:207]
v_cvt_pk_bf16_f32 v37, v38, v39
s_waitcnt lgkmcnt(6)
M a[104:107], a[112:115], v[104:107], a[104:107]
M a[104:107], a[112:115], v[136:139], a[104:107]
M v[208:211], a[140:143], v[96:99], v[208:211]
v_exp_f32 v52, v52
M v[208:211], a[144:147], v[128:131], v[208:211]
ds_read_b128 a[172:175], v3 offset:39936
ds_read_b128 a[176:179], v3 offset:48128
M v[212:215], a[144:147], v[132:135], v[212:215]
v_exp_f32 v53, v53
M v[212:215], a[140:143], v[100:103], v[212:215]
v_cvt_pk_bf16_f32 v38, v52, v53
M v[216:219], a[140:143], v[104:107], v[216:219]
v_exp_f32 v54, v54
M v[216:219], a[144:147], v[136:139], v[216:219]
M v[220:223], a[144:147], v[140:143], v[220:223]
v_exp_f32 v55, v55
M v[220:223], a[140:143], v[108:111], v[220:223]
v_cvt_pk_bf16_f32 v39, v54, v55
s_waitcnt lgkmcnt(6)
M a[108:111], a[112:115], v[108:111], a[108:111]
M a[108:111], a[112:115], v[140:143], a[108:111]
M v[224:227], a[148:151], v[96:99], v[224:227]
v_exp_f32 v40, v40
M v[224:227], a[152:155], v[128:131], v[224:227]
M v[228:231], a[152:155], v[132:135], v[228:231]
v_exp_f32 v41, v41
M v[228:231], a[148:151], v[100:103], v[228:231]
v_cvt_pk_bf16_f32 v40, v40, v41
M v[232:235], a[148:151], v[104:107], v[232:235]
v_exp_f32 v42, v42
M v[232:235], a[152:155], v[136:139], v[232:235]
M v[236:239], a[152:155], v[140:143], v[236:239]
v_exp_f32 v43, v43
M v[236:239], a[148:151], v[108:111], v[236:239]
v_cvt_pk_bf16_f32 v41, v42, v43
s_waitcnt lgkmcnt(4)
M v[240:243], a[156:159], v[96:99], v[240:243]
v_exp_f32 v56, v56
M v[240:243], a[160:163], v[128:131], v[240:243]
M v[244:247], a[160:163], v[132:135], v[244:247]
v_exp_f32 v57, v57
M v[244:247], a[156:159], v[100:103], v[244:247]
v_cvt_pk_bf16_f32 v42, v56, v57
M v[248:251], a[156:159], v[104:107], v[248:251]
v_exp_f32 v58, v58
M v[248:251], a[160:163], v[136:139], v[248:251]
s_waitcnt vmcnt(0) lgkmcnt(0)
s_barrier
ds_read_b128 a[116:119], v2 offset:0
ds_read_b128 a[120:123], v2 offset:1024
M v[252:255], a[160:163], v[140:143], v[252:255]
v_exp_f32 v59, v59
M v[252:255], a[156:159], v[108:111], v[252:255]
v_cvt_pk_bf16_f32 v43, v58, v59
M a[64:67], a[164:167], v[96:99], a[64:67]
v_exp_f32 v44, v44
M a[64:67], a[168:171], v[128:131], a[64:67]
ds_read_b128 a[124:127], v2 offset:2048
ds_read_b128 a[128:131], v2 offset:3072
M a[68:71], a[168:171], v[132:135], a[68:71]
v_exp_f32 v45, v45
M a[68:71], a[164:167], v[100:103], a[68:71]
v_cvt_pk_bf16_f32 v44, v44, v45
M a[72:75], a[164:167], v[104:107], a[72:75]
v_exp_f32 v46, v46
M a[72:75], a[168:171], v[136:139], a[72:75]
ds_read_b128 a[132:135], v2 offset:4096
ds_read_b128 a[136:139], v2 offset:5120
M a[76:79], a[168:171], v[140:143], a[76:79]
v_exp_f32 v47, v47
M a[76:79], a[164:167], v[108:111], a[76:79]
v_cvt_pk_bf16_f32 v45, v46, v47
M a[80:83], a[172:175], v[96:99], a[80:83]
v_exp_f32 v60, v60
M a[80:83], a[176:179], v[128:131], a[80:83]
ds_read_b128 a[140:143], v2 offset:6144
ds_read_b128 a[144:147], v2 offset:7168
M a[84:87], a[176:179], v[132:135], a[84:87]
v_exp_f32 v61, v61
M a[84:87], a[172:175], v[100:103], a[84:87]
v_cvt_pk_bf16_f32 v46, v60, v61
M a[88:91], a[172:175], v[104:107], a[88:91]
v_exp_f32 v62, v62
M a[88:91], a[176:179], v[136:139], a[88:91]
M a[92:95], a[176:179], v[140:143], a[92:95]
v_exp_f32 v63, v63
M a[92:95], a[172:175], v[108:111], a[92:95]
v_cvt_pk_bf16_f32 v47, v62, v63
s_sub_u32 s30, s30, 1
s_cmp_lg_u32 s30, 0
s_cbranch_scc1 Lk2_l2
s_branch Lk2_fin
s_waitcnt lgkmcnt(0)
Lk2_wm:
s_lshl_b32 s33, s2, 1
s_add_u32 s33, s33, s23
s_lshl_b32 s34, s33, 12
s_lshl_b32 s33, s33, 14
v_lshlrev_b32 v8, 3, v1
v_lshlrev_b32 v9, 2, v1
buffer_load_dword a244, v8, s[44:47], s33 offen
s_add_u32 s33, s33, 8192
buffer_load_dword a245, v8, s[44:47], s33 offen
buffer_load_dword a246, v9, s[48:51], s34 offen
s_branch Lk2_l3b
Lk2_g1:
s_mov_b32 s30, 7
s_bfe_u32 s42, s2, 0x20003
s_add_u32 s42, s42, 2
Lk2_l3:
s_cmp_eq_u32 s30, s42
s_cbranch_scc1 Lk2_wm
Lk2_l3b:
s_add_u32 m0, s29, 65536
s_waitcnt lgkmcnt(4)
M v[96:99], a[116:119], a[0:3], 0
v_exp_f32 v64, v64
M v[96:99], a[120:123], a[4:7], v[96:99]
ds_read_b128 a[148:151], v2 offset:8192
ds_read_b128 a[152:155], v2 offset:9216
M v[96:99], a[124:127], a[8:11], v[96:99]
v_exp_f32 v65, v65
M v[96:99], a[128:131], a[12:15], v[96:99]
buffer_load_dwordx4 v1, s[12:15], s25 offen offset:0 sc1 lds
s_add_u32 s32, s25, 4096
M v[100:103], a[128:131], a[28:31], 0
v_exp_f32 v66, v66
M v[100:103], a[124:127], a[24:27], v[100:103]
v_cvt_pk_bf16_f32 v64, v64, v65
M v[100:103], a[120:123], a[20:23], v[100:103]
v_exp_f32 v67, v67
M v[100:103], a[116:119], a[16:19], v[100:103]
buffer_load_dwordx4 v1, s[12:15], s25 offen offset:1024 sc1 lds
M v[104:107], a[116:119], a[32:35], 0
v_exp_f32 v80, v80
M v[104:107], a[120:123], a[36:39], v[104:107]
ds_read_b128 a[156:159], v2 offset:10240
ds_read_b128 a[160:163], v2 offset:11264
M v[104:107], a[124:127], a[40:43], v[104:107]
v_exp_f32 v81, v81
M v[104:107], a[128:131], a[44:47], v[104:107]
buffer_load_dwordx4 v1, s[12:15], s25 offen offset:2048 sc1 lds
M v[108:111], a[128:131], a[60:63], 0
v_exp_f32 v82, v82
M v[108:111], a[124:127], a[56:59], v[108:111]
v_cvt_pk_bf16_f32 v65, v66, v67
v_cvt_pk_bf16_f32 v66, v80, v81
M v[108:111], a[120:123], a[52:55], v[108:111]
v_exp_f32 v83, v83
M v[108:111], a[116:119], a[48:51], v[108:111]
buffer_load_dwordx4 v1, s[12:15], s25 offen offset:3072 sc1 lds
s_add_u32 m0, s29, 69632
s_waitcnt lgkmcnt(4)
M v[112:115], a[132:135], a[0:3], 0
v_exp_f32 v68, v68
M v[112:115], a[136:139], a[4:7], v[112:115]
ds_read_b128 a[164:167], v2 offset:12288
ds_read_b128 a[168:171], v2 offset:13312
M v[112:115], a[140:143], a[8:11], v[112:115]
v_exp_f32 v69, v69
M v[112:115], a[144:147], a[12:15], v[112:115]
buffer_load_dwordx4 v1, s[12:15], s32 offen offset:0 sc1 lds
M v[116:119], a[144:147], a[28:31], 0
v_exp_f32 v70, v70
M v[116:119], a[140:143], a[24:27], v[116:119]
v_cvt_pk_bf16_f32 v67, v82, v83
v_cvt_pk_bf16_f32 v68, v68, v69
M v[116:119], a[136:139], a[20:23], v[116:119]
v_exp_f32 v71, v71
M v[116:119], a[132:135], a[16:19], v[116:119]
buffer_load_dwordx4 v1, s[12:15], s32 offen offset:1024 sc1 lds
M v[120:123], a[132:135], a[32:35], 0
v_exp_f32 v84, v84
M v[120:123], a[136:139], a[36:39], v[120:123]
ds_read_b128 a[172:175], v2 offset:14336
ds_read_b128 a[176:179], v2 offset:15360
M v[120:123], a[140:143], a[40:43], v[120:123]
v_exp_f32 v85, v85
M v[120:123], a[144:147], a[44:47], v[120:123]
buffer_load_dwordx4 v1, s[12:15], s32 offen offset:2048 sc1 lds
M v[124:127], a[144:147], a[60:63], 0
v_exp_f32 v86, v86
M v[124:127], a[140:143], a[56:59], v[124:127]
v_cvt_pk_bf16_f32 v69, v70, v71
v_cvt_pk_bf16_f32 v70, v84, v85
M v[124:127], a[136:139], a[52:55], v[124:127]
v_exp_f32 v87, v87
M v[124:127], a[132:135], a[48:51], v[124:127]
buffer_load_dwordx4 v1, s[12:15], s32 offen offset:3072 sc1 lds
s_add_u32 m0, s29, 98304
s_waitcnt lgkmcnt(4)
M v[128:131], a[148:151], a[0:3], 0
v_exp_f32 v72, v72
M v[128:131], a[152:155], a[4:7], v[128:131]
ds_read_b128 a[116:119], v2 offset:32768
ds_read_b128 a[120:123], v2 offset:40960
M v[128:131], a[156:159], a[8:11], v[128:131]
v_exp_f32 v73, v73
M v[128:131], a[160:163], a[12:15], v[128:131]
buffer_load_dwordx4 v1, s[12:15], s26 offen offset:0 sc1 lds
s_add_u32 s43, s26, 4096
M v[132:135], a[160:163], a[28:31], 0
v_exp_f32 v74, v74
M v[132:135], a[156:159], a[24:27], v[132:135]
v_cvt_pk_bf16_f32 v71, v86, v87
v_cvt_pk_bf16_f32 v72, v72, v73
M v[132:135], a[152:155], a[20:23], v[132:135]
v_exp_f32 v75, v75
M v[132:135], a[148:151], a[16:19], v[132:135]
buffer_load_dwordx4 v1, s[12:15], s26 offen offset:1024 sc1 lds
M v[136:139], a[148:151], a[32:35], 0
v_exp_f32 v88, v88
M v[136:139], a[152:155], a[36:39], v[136:139]
ds_read_b128 a[124:127], v2 offset:33792
ds_read_b128 a[128:131], v2 offset:41984
M v[136:139], a[156:159], a[40:43], v[136:139]
v_exp_f32 v89, v89
M v[136:139], a[160:163], a[44:47], v[136:139]
buffer_load_dwordx4 v1, s[12:15], s26 offen offset:2048 sc1 lds
M v[140:143], a[160:163], a[60:63], 0
v_exp_f32 v90, v90
M v[140:143], a[156:159], a[56:59], v[140:143]
v_cvt_pk_bf16_f32 v73, v74, v75
v_cvt_pk_bf16_f32 v74, v88, v89
M v[140:143], a[152:155], a[52:55], v[140:143]
v_exp_f32 v91, v91
M v[140:143], a[148:151], a[48:51], v[140:143]
buffer_load_dwordx4 v1, s[12:15], s26 offen offset:3072 sc1 lds
s_add_u32 m0, s29, 102400
s_waitcnt lgkmcnt(4)
M v[144:147], a[164:167], a[0:3], 0
v_exp_f32 v76, v76
M v[144:147], a[168:171], a[4:7], v[144:147]
ds_read_b128 a[132:135], v2 offset:34816
ds_read_b128 a[136:139], v2 offset:43008
M v[144:147], a[172:175], a[8:11], v[144:147]
v_exp_f32 v77, v77
M v[144:147], a[176:179], a[12:15], v[144:147]
buffer_load_dwordx4 v1, s[12:15], s43 offen offset:0 sc1 lds
M v[148:151], a[176:179], a[28:31], 0
v_exp_f32 v78, v78
M v[148:151], a[172:175], a[24:27], v[148:151]
v_cvt_pk_bf16_f32 v75, v90, v91
v_cvt_pk_bf16_f32 v76, v76, v77
M v[148:151], a[168:171], a[20:23], v[148:151]
v_exp_f32 v79, v79
M v[148:151], a[164:167], a[16:19], v[148:151]
buffer_load_dwordx4 v1, s[12:15], s43 offen offset:1024 sc1 lds
M v[152:155], a[164:167], a[32:35], 0
v_exp_f32 v92, v92
M v[152:155], a[168:171], a[36:39], v[152:155]
ds_read_b128 a[140:143], v2 offset:35840
ds_read_b128 a[144:147], v2 offset:44032
M v[152:155], a[172:175], a[40:43], v[152:155]
v_exp_f32 v93, v93
M v[152:155], a[176:179], a[44:47], v[152:155]
buffer_load_dwordx4 v1, s[12:15], s43 offen offset:2048 sc1 lds
M v[156:159], a[176:179], a[60:63], 0
v_exp_f32 v94, v94
M v[156:159], a[172:175], a[56:59], v[156:159]
v_cvt_pk_bf16_f32 v77, v78, v79
v_cvt_pk_bf16_f32 v78, v92, v93
M v[156:159], a[168:171], a[52:55], v[156:159]
v_exp_f32 v95, v95
M v[156:159], a[164:167], a[48:51], v[156:159]
buffer_load_dwordx4 v1, s[12:15], s43 offen offset:3072 sc1 lds
v_cvt_pk_bf16_f32 v79, v94, v95
s_waitcnt lgkmcnt(6)
M v[160:163], a[116:119], v[32:35], v[160:163]
v_exp_f32 v96, v96
M v[160:163], a[120:123], v[64:67], v[160:163]
ds_read_b128 a[148:151], v2 offset:36864
ds_read_b128 a[152:155], v2 offset:45056
M v[164:167], a[120:123], v[68:71], v[164:167]
v_exp_f32 v97, v97
M v[164:167], a[116:119], v[36:39], v[164:167]
v_cvt_pk_bf16_f32 v96, v96, v97
M v[168:171], a[116:119], v[40:43], v[168:171]
v_exp_f32 v98, v98
M v[168:171], a[120:123], v[72:75], v[168:171]
s_add_u32 s25, s25, 32768
s_cmp_eq_u32 s25, s27
M v[172:175], a[120:123], v[76:79], v[172:175]
v_exp_f32 v99, v99
M v[172:175], a[116:119], v[44:47], v[172:175]
v_cvt_pk_bf16_f32 v97, v98, v99
s_waitcnt lgkmcnt(6)
M a[96:99], a[112:115], v[32:35], a[96:99]
s_cselect_b32 s25, s28, s25
s_cselect_b32 s27, -1, s27
M a[96:99], a[112:115], v[64:67], a[96:99]
s_add_u32 s26, s26, 32768
s_cmp_eq_u32 s26, s62
M v[176:179], a[124:127], v[32:35], v[176:179]
v_exp_f32 v112, v112
M v[176:179], a[128:131], v[64:67], v[176:179]
ds_read_b128 a[156:159], v2 offset:37888
ds_read_b128 a[160:163], v2 offset:46080
M v[180:183], a[128:131], v[68:71], v[180:183]
v_exp_f32 v113, v113
M v[180:183], a[124:127], v[36:39], v[180:183]
v_cvt_pk_bf16_f32 v98, v112, v113
M v[184:187], a[124:127], v[40:43], v[184:187]
v_exp_f32 v114, v114
M v[184:187], a[128:131], v[72:75], v[184:187]
s_cselect_b32 s26, s63, s26
s_cselect_b32 s62, -1, s62
M v[188:191], a[128:131], v[76:79], v[188:191]
v_exp_f32 v115, v115
M v[188:191], a[124:127], v[44:47], v[188:191]
v_cvt_pk_bf16_f32 v99, v114, v115
s_waitcnt lgkmcnt(6)
M a[100:103], a[112:115], v[36:39], a[100:103]
M a[100:103], a[112:115], v[68:71], a[100:103]
M v[192:195], a[132:135], v[32:35], v[192:195]
v_exp_f32 v100, v100
M v[192:195], a[136:139], v[64:67], v[192:195]
ds_read_b128 a[164:167], v2 offset:38912
ds_read_b128 a[168:171], v2 offset:47104
M v[196:199], a[136:139], v[68:71], v[196:199]
v_exp_f32 v101, v101
M v[196:199], a[132:135], v[36:39], v[196:199]
v_cvt_pk_bf16_f32 v100, v100, v101
M v[200:203], a[132:135], v[40:43], v[200:203]
v_exp_f32 v102, v102
M v[200:203], a[136:139], v[72:75], v[200:203]
M v[204:207], a[136:139], v[76:79], v[204:207]
v_exp_f32 v103, v103
M v[204:207], a[132:135], v[44:47], v[204:207]
v_cvt_pk_bf16_f32 v101, v102, v103
s_waitcnt lgkmcnt(6)
M a[104:107], a[112:115], v[40:43], a[104:107]
M a[104:107], a[112:115], v[72:75], a[104:107]
M v[208:211], a[140:143], v[32:35], v[208:211]
v_exp_f32 v116, v116
M v[208:211], a[144:147], v[64:67], v[208:211]
ds_read_b128 a[172:175], v2 offset:39936
ds_read_b128 a[176:179], v2 offset:48128
M v[212:215], a[144:147], v[68:71], v[212:215]
v_exp_f32 v117, v117
M v[212:215], a[140:143], v[36:39], v[212:215]
v_cvt_pk_bf16_f32 v102, v116, v117
M v[216:219], a[140:143], v[40:43], v[216:219]
v_exp_f32 v118, v118
M v[216:219], a[144:147], v[72:75], v[216:219]
M v[220:223], a[144:147], v[76:79], v[220:223]
v_exp_f32 v119, v119
M v[220:223], a[140:143], v[44:47], v[220:223]
v_cvt_pk_bf16_f32 v103, v118, v119
s_waitcnt lgkmcnt(6)
M a[108:111], a[112:115], v[44:47], a[108:111]
M a[108:111], a[112:115], v[76:79], a[108:111]
M v[224:227], a[148:151], v[32:35], v[224:227]
v_exp_f32 v104, v104
M v[224:227], a[152:155], v[64:67], v[224:227]
M v[228:231], a[152:155], v[68:71], v[228:231]
v_exp_f32 v105, v105
M v[228:231], a[148:151], v[36:39], v[228:231]
v_cvt_pk_bf16_f32 v104, v104, v105
M v[232:235], a[148:151], v[40:43], v[232:235]
v_exp_f32 v106, v106
M v[232:235], a[152:155], v[72:75], v[232:235]
M v[236:239], a[152:155], v[76:79], v[236:239]
v_exp_f32 v107, v107
M v[236:239], a[148:151], v[44:47], v[236:239]
v_cvt_pk_bf16_f32 v105, v106, v107
s_waitcnt lgkmcnt(4)
M v[240:243], a[156:159], v[32:35], v[240:243]
v_exp_f32 v120, v120
M v[240:243], a[160:163], v[64:67], v[240:243]
M v[244:247], a[160:163], v[68:71], v[244:247]
v_exp_f32 v121, v121
M v[244:247], a[156:159], v[36:39], v[244:247]
v_cvt_pk_bf16_f32 v106, v120, v121
M v[248:251], a[156:159], v[40:43], v[248:251]
v_exp_f32 v122, v122
M v[248:251], a[160:163], v[72:75], v[248:251]
s_waitcnt vmcnt(0) lgkmcnt(0)
s_barrier
ds_read_b128 a[116:119], v3 offset:0
ds_read_b128 a[120:123], v3 offset:1024
M v[252:255], a[160:163], v[76:79], v[252:255]
v_exp_f32 v123, v123
M v[252:255], a[156:159], v[44:47], v[252:255]
v_cvt_pk_bf16_f32 v107, v122, v123
M a[64:67], a[164:167], v[32:35], a[64:67]
v_exp_f32 v108, v108
M a[64:67], a[168:171], v[64:67], a[64:67]
ds_read_b128 a[124:127], v3 offset:2048
ds_read_b128 a[128:131], v3 offset:3072
M a[68:71], a[168:171], v[68:71], a[68:71]
v_exp_f32 v109, v109
M a[68:71], a[164:167], v[36:39], a[68:71]
v_cvt_pk_bf16_f32 v108, v108, v109
M a[72:75], a[164:167], v[40:43], a[72:75]
v_exp_f32 v110, v110
M a[72:75], a[168:171], v[72:75], a[72:75]
ds_read_b128 a[132:135], v3 offset:4096
ds_read_b128 a[136:139], v3 offset:5120
M a[76:79], a[168:171], v[76:79], a[76:79]
v_exp_f32 v111, v111
M a[76:79], a[164:167], v[44:47], a[76:79]
v_cvt_pk_bf16_f32 v109, v110, v111
M a[80:83], a[172:175], v[32:35], a[80:83]
v_exp_f32 v124, v124
M a[80:83], a[176:179], v[64:67], a[80:83]
ds_read_b128 a[140:143], v3 offset:6144
ds_read_b128 a[144:147], v3 offset:7168
M a[84:87], a[176:179], v[68:71], a[84:87]
v_exp_f32 v125, v125
M a[84:87], a[172:175], v[36:39], a[84:87]
v_cvt_pk_bf16_f32 v110, v124, v125
M a[88:91], a[172:175], v[40:43], a[88:91]
v_exp_f32 v126, v126
M a[88:91], a[176:179], v[72:75], a[88:91]
M a[92:95], a[176:179], v[76:79], a[92:95]
v_exp_f32 v127, v127
M a[92:95], a[172:175], v[44:47], a[92:95]
v_cvt_pk_bf16_f32 v111, v126, v127
s_add_u32 m0, s29, 0
s_waitcnt lgkmcnt(4)
M v[32:35], a[116:119], a[0:3], 0
v_exp_f32 v128, v128
M v[32:35], a[120:123], a[4:7], v[32:35]
ds_read_b128 a[148:151], v3 offset:8192
ds_read_b128 a[152:155], v3 offset:9216
M v[32:35], a[124:127], a[8:11], v[32:35]
v_exp_f32 v129, v129
M v[32:35], a[128:131], a[12:15], v[32:35]
buffer_load_dwordx4 v1, s[12:15], s25 offen offset:0 sc1 lds
s_add_u32 s32, s25, 4096
M v[36:39], a[128:131], a[28:31], 0
v_exp_f32 v130, v130
M v[36:39], a[124:127], a[24:27], v[36:39]
v_cvt_pk_bf16_f32 v128, v128, v129
M v[36:39], a[120:123], a[20:23], v[36:39]
v_exp_f32 v131, v131
M v[36:39], a[116:119], a[16:19], v[36:39]
buffer_load_dwordx4 v1, s[12:15], s25 offen offset:1024 sc1 lds
M v[40:43], a[116:119], a[32:35], 0
v_exp_f32 v144, v144
M v[40:43], a[120:123], a[36:39], v[40:43]
ds_read_b128 a[156:159], v3 offset:10240
ds_read_b128 a[160:163], v3 offset:11264
M v[40:43], a[124:127], a[40:43], v[40:43]
v_exp_f32 v145, v145
M v[40:43], a[128:131], a[44:47], v[40:43]
buffer_load_dwordx4 v1, s[12:15], s25 offen offset:2048 sc1 lds
M v[44:47], a[128:131], a[60:63], 0
v_exp_f32 v146, v146
M v[44:47], a[124:127], a[56:59], v[44:47]
v_cvt_pk_bf16_f32 v129, v130, v131
v_cvt_pk_bf16_f32 v130, v144, v145
M v[44:47], a[120:123], a[52:55], v[44:47]
v_exp_f32 v147, v147
M v[44:47], a[116:119], a[48:51], v[44:47]
buffer_load_dwordx4 v1, s[12:15], s25 offen offset:3072 sc1 lds
s_add_u32 m0, s29, 4096
s_waitcnt lgkmcnt(4)
M v[48:51], a[132:135], a[0:3], 0
v_exp_f32 v132, v132
M v[48:51], a[136:139], a[4:7], v[48:51]
ds_read_b128 a[164:167], v3 offset:12288
ds_read_b128 a[168:171], v3 offset:13312
M v[48:51], a[140:143], a[8:11], v[48:51]
v_exp_f32 v133, v133
M v[48:51], a[144:147], a[12:15], v[48:51]
buffer_load_dwordx4 v1, s[12:15], s32 offen offset:0 sc1 lds
M v[52:55], a[144:147], a[28:31], 0
v_exp_f32 v134, v134
M v[52:55], a[140:143], a[24:27], v[52:55]
v_cvt_pk_bf16_f32 v131, v146, v147
v_cvt_pk_bf16_f32 v132, v132, v133
M v[52:55], a[136:139], a[20:23], v[52:55]
v_exp_f32 v135, v135
M v[52:55], a[132:135], a[16:19], v[52:55]
buffer_load_dwordx4 v1, s[12:15], s32 offen offset:1024 sc1 lds
M v[56:59], a[132:135], a[32:35], 0
v_exp_f32 v148, v148
M v[56:59], a[136:139], a[36:39], v[56:59]
ds_read_b128 a[172:175], v3 offset:14336
ds_read_b128 a[176:179], v3 offset:15360
M v[56:59], a[140:143], a[40:43], v[56:59]
v_exp_f32 v149, v149
M v[56:59], a[144:147], a[44:47], v[56:59]
buffer_load_dwordx4 v1, s[12:15], s32 offen offset:2048 sc1 lds
M v[60:63], a[144:147], a[60:63], 0
v_exp_f32 v150, v150
M v[60:63], a[140:143], a[56:59], v[60:63]
v_cvt_pk_bf16_f32 v133, v134, v135
v_cvt_pk_bf16_f32 v134, v148, v149
M v[60:63], a[136:139], a[52:55], v[60:63]
v_exp_f32 v151, v151
M v[60:63], a[132:135], a[48:51], v[60:63]
buffer_load_dwordx4 v1, s[12:15], s32 offen offset:3072 sc1 lds
s_add_u32 m0, s29, 32768
s_waitcnt lgkmcnt(4)
M v[64:67], a[148:151], a[0:3], 0
v_exp_f32 v136, v136
M v[64:67], a[152:155], a[4:7], v[64:67]
ds_read_b128 a[116:119], v3 offset:32768
ds_read_b128 a[120:123], v3 offset:40960
M v[64:67], a[156:159], a[8:11], v[64:67]
v_exp_f32 v137, v137
M v[64:67], a[160:163], a[12:15], v[64:67]
buffer_load_dwordx4 v1, s[12:15], s26 offen offset:0 sc1 lds
s_add_u32 s43, s26, 4096
M v[68:71], a[160:163], a[28:31], 0
v_exp_f32 v138, v138
M v[68:71], a[156:159], a[24:27], v[68:71]
v_cvt_pk_bf16_f32 v135, v150, v151
v_cvt_pk_bf16_f32 v136, v136, v137
M v[68:71], a[152:155], a[20:23], v[68:71]
v_exp_f32 v139, v139
M v[68:71], a[148:151], a[16:19], v[68:71]
buffer_load_dwordx4 v1, s[12:15], s26 offen offset:1024 sc1 lds
M v[72:75], a[148:151], a[32:35], 0
v_exp_f32 v152, v152
M v[72:75], a[152:155], a[36:39], v[72:75]
ds_read_b128 a[124:127], v3 offset:33792
ds_read_b128 a[128:131], v3 offset:41984
M v[72:75], a[156:159], a[40:43], v[72:75]
v_exp_f32 v153, v153
M v[72:75], a[160:163], a[44:47], v[72:75]
buffer_load_dwordx4 v1, s[12:15], s26 offen offset:2048 sc1 lds
M v[76:79], a[160:163], a[60:63], 0
v_exp_f32 v154, v154
M v[76:79], a[156:159], a[56:59], v[76:79]
v_cvt_pk_bf16_f32 v137, v138, v139
v_cvt_pk_bf16_f32 v138, v152, v153
M v[76:79], a[152:155], a[52:55], v[76:79]
v_exp_f32 v155, v155
M v[76:79], a[148:151], a[48:51], v[76:79]
buffer_load_dwordx4 v1, s[12:15], s26 offen offset:3072 sc1 lds
s_add_u32 m0, s29, 36864
s_waitcnt lgkmcnt(4)
M v[80:83], a[164:167], a[0:3], 0
v_exp_f32 v140, v140
M v[80:83], a[168:171], a[4:7], v[80:83]
ds_read_b128 a[132:135], v3 offset:34816
ds_read_b128 a[136:139], v3 offset:43008
M v[80:83], a[172:175], a[8:11], v[80:83]
v_exp_f32 v141, v141
M v[80:83], a[176:179], a[12:15], v[80:83]
buffer_load_dwordx4 v1, s[12:15], s43 offen offset:0 sc1 lds
M v[84:87], a[176:179], a[28:31], 0
v_exp_f32 v142, v142
M v[84:87], a[172:175], a[24:27], v[84:87]
v_cvt_pk_bf16_f32 v139, v154, v155
v_cvt_pk_bf16_f32 v140, v140, v141
M v[84:87], a[168:171], a[20:23], v[84:87]
v_exp_f32 v143, v143
M v[84:87], a[164:167], a[16:19], v[84:87]
buffer_load_dwordx4 v1, s[12:15], s43 offen offset:1024 sc1 lds
M v[88:91], a[164:167], a[32:35], 0
v_exp_f32 v156, v156
M v[88:91], a[168:171], a[36:39], v[88:91]
ds_read_b128 a[140:143], v3 offset:35840
ds_read_b128 a[144:147], v3 offset:44032
M v[88:91], a[172:175], a[40:43], v[88:91]
v_exp_f32 v157, v157
M v[88:91], a[176:179], a[44:47], v[88:91]
buffer_load_dwordx4 v1, s[12:15], s43 offen offset:2048 sc1 lds
M v[92:95], a[176:179], a[60:63], 0
v_exp_f32 v158, v158
M v[92:95], a[172:175], a[56:59], v[92:95]
v_cvt_pk_bf16_f32 v141, v142, v143
v_cvt_pk_bf16_f32 v142, v156, v157
M v[92:95], a[168:171], a[52:55], v[92:95]
v_exp_f32 v159, v159
M v[92:95], a[164:167], a[48:51], v[92:95]
buffer_load_dwordx4 v1, s[12:15], s43 offen offset:3072 sc1 lds
v_cvt_pk_bf16_f32 v143, v158, v159
s_waitcnt lgkmcnt(6)
M v[160:163], a[116:119], v[96:99], v[160:163]
v_exp_f32 v32, v32
M v[160:163], a[120:123], v[128:131], v[160:163]
ds_read_b128 a[148:151], v3 offset:36864
ds_read_b128 a[152:155], v3 offset:45056
M v[164:167], a[120:123], v[132:135], v[164:167]
v_exp_f32 v33, v33
M v[164:167], a[116:119], v[100:103], v[164:167]
v_cvt_pk_bf16_f32 v32, v32, v33
M v[168:171], a[116:119], v[104:107], v[168:171]
v_exp_f32 v34, v34
M v[168:171], a[120:123], v[136:139], v[168:171]
s_add_u32 s25, s25, 32768
s_cmp_eq_u32 s25, s27
M v[172:175], a[120:123], v[140:143], v[172:175]
v_exp_f32 v35, v35
M v[172:175], a[116:119], v[108:111], v[172:175]
v_cvt_pk_bf16_f32 v33, v34, v35
s_waitcnt lgkmcnt(6)
M a[96:99], a[112:115], v[96:99], a[96:99]
s_cselect_b32 s25, s28, s25
s_cselect_b32 s27, -1, s27
M a[96:99], a[112:115], v[128:131], a[96:99]
s_add_u32 s26, s26, 32768
s_cmp_eq_u32 s26, s62
M v[176:179], a[124:127], v[96:99], v[176:179]
v_exp_f32 v48, v48
M v[176:179], a[128:131], v[128:131], v[176:179]
ds_read_b128 a[156:159], v3 offset:37888
ds_read_b128 a[160:163], v3 offset:46080
M v[180:183], a[128:131], v[132:135], v[180:183]
v_exp_f32 v49, v49
M v[180:183], a[124:127], v[100:103], v[180:183]
v_cvt_pk_bf16_f32 v34, v48, v49
M v[184:187], a[124:127], v[104:107], v[184:187]
v_exp_f32 v50, v50
M v[184:187], a[128:131], v[136:139], v[184:187]
s_cselect_b32 s26, s63, s26
s_cselect_b32 s62, -1, s62
M v[188:191], a[128:131], v[140:143], v[188:191]
v_exp_f32 v51, v51
M v[188:191], a[124:127], v[108:111], v[188:191]
v_cvt_pk_bf16_f32 v35, v50, v51
s_waitcnt lgkmcnt(6)
M a[100:103], a[112:115], v[100:103], a[100:103]
M a[100:103], a[112:115], v[132:135], a[100:103]
M v[192:195], a[132:135], v[96:99], v[192:195]
v_exp_f32 v36, v36
M v[192:195], a[136:139], v[128:131], v[192:195]
ds_read_b128 a[164:167], v3 offset:38912
ds_read_b128 a[168:171], v3 offset:47104
M v[196:199], a[136:139], v[132:135], v[196:199]
v_exp_f32 v37, v37
M v[196:199], a[132:135], v[100:103], v[196:199]
v_cvt_pk_bf16_f32 v36, v36, v37
M v[200:203], a[132:135], v[104:107], v[200:203]
v_exp_f32 v38, v38
M v[200:203], a[136:139], v[136:139], v[200:203]
M v[204:207], a[136:139], v[140:143], v[204:207]
v_exp_f32 v39, v39
M v[204:207], a[132:135], v[108:111], v[204:207]
v_cvt_pk_bf16_f32 v37, v38, v39
s_waitcnt lgkmcnt(6)
M a[104:107], a[112:115], v[104:107], a[104:107]
M a[104:107], a[112:115], v[136:139], a[104:107]
M v[208:211], a[140:143], v[96:99], v[208:211]
v_exp_f32 v52, v52
M v[208:211], a[144:147], v[128:131], v[208:211]
ds_read_b128 a[172:175], v3 offset:39936
ds_read_b128 a[176:179], v3 offset:48128
M v[212:215], a[144:147], v[132:135], v[212:215]
v_exp_f32 v53, v53
M v[212:215], a[140:143], v[100:103], v[212:215]
v_cvt_pk_bf16_f32 v38, v52, v53
M v[216:219], a[140:143], v[104:107], v[216:219]
v_exp_f32 v54, v54
M v[216:219], a[144:147], v[136:139], v[216:219]
M v[220:223], a[144:147], v[140:143], v[220:223]
v_exp_f32 v55, v55
M v[220:223], a[140:143], v[108:111], v[220:223]
v_cvt_pk_bf16_f32 v39, v54, v55
s_waitcnt lgkmcnt(6)
M a[108:111], a[112:115], v[108:111], a[108:111]
M a[108:111], a[112:115], v[140:143], a[108:111]
M v[224:227], a[148:151], v[96:99], v[224:227]
v_exp_f32 v40, v40
M v[224:227], a[152:155], v[128:131], v[224:227]
M v[228:231], a[152:155], v[132:135], v[228:231]
v_exp_f32 v41, v41
M v[228:231], a[148:151], v[100:103], v[228:231]
v_cvt_pk_bf16_f32 v40, v40, v41
M v[232:235], a[148:151], v[104:107], v[232:235]
v_exp_f32 v42, v42
M v[232:235], a[152:155], v[136:139], v[232:235]
M v[236:239], a[152:155], v[140:143], v[236:239]
v_exp_f32 v43, v43
M v[236:239], a[148:151], v[108:111], v[236:239]
v_cvt_pk_bf16_f32 v41, v42, v43
s_waitcnt lgkmcnt(4)
M v[240:243], a[156:159], v[96:99], v[240:243]
v_exp_f32 v56, v56
M v[240:243], a[160:163], v[128:131], v[240:243]
M v[244:247], a[160:163], v[132:135], v[244:247]
v_exp_f32 v57, v57
M v[244:247], a[156:159], v[100:103], v[244:247]
v_cvt_pk_bf16_f32 v42, v56, v57
M v[248:251], a[156:159], v[104:107], v[248:251]
v_exp_f32 v58, v58
M v[248:251], a[160:163], v[136:139], v[248:251]
s_waitcnt vmcnt(0) lgkmcnt(0)
s_barrier
ds_read_b128 a[116:119], v2 offset:0
ds_read_b128 a[120:123], v2 offset:1024
M v[252:255], a[160:163], v[140:143], v[252:255]
v_exp_f32 v59, v59
M v[252:255], a[156:159], v[108:111], v[252:255]
v_cvt_pk_bf16_f32 v43, v58, v59
M a[64:67], a[164:167], v[96:99], a[64:67]
v_exp_f32 v44, v44
M a[64:67], a[168:171], v[128:131], a[64:67]
ds_read_b128 a[124:127], v2 offset:2048
ds_read_b128 a[128:131], v2 offset:3072
M a[68:71], a[168:171], v[132:135], a[68:71]
v_exp_f32 v45, v45
M a[68:71], a[164:167], v[100:103], a[68:71]
v_cvt_pk_bf16_f32 v44, v44, v45
M a[72:75], a[164:167], v[104:107], a[72:75]
v_exp_f32 v46, v46
M a[72:75], a[168:171], v[136:139], a[72:75]
ds_read_b128 a[132:135], v2 offset:4096
ds_read_b128 a[136:139], v2 offset:5120
M a[76:79], a[168:171], v[140:143], a[76:79]
v_exp_f32 v47, v47
M a[76:79], a[164:167], v[108:111], a[76:79]
v_cvt_pk_bf16_f32 v45, v46, v47
M a[80:83], a[172:175], v[96:99], a[80:83]
v_exp_f32 v60, v60
M a[80:83], a[176:179], v[128:131], a[80:83]
ds_read_b128 a[140:143], v2 offset:6144
ds_read_b128 a[144:147], v2 offset:7168
M a[84:87], a[176:179], v[132:135], a[84:87]
v_exp_f32 v61, v61
M a[84:87], a[172:175], v[100:103], a[84:87]
v_cvt_pk_bf16_f32 v46, v60, v61
M a[88:91], a[172:175], v[104:107], a[88:91]
v_exp_f32 v62, v62
M a[88:91], a[176:179], v[136:139], a[88:91]
M a[92:95], a[176:179], v[140:143], a[92:95]
v_exp_f32 v63, v63
M a[92:95], a[172:175], v[108:111], a[92:95]
v_cvt_pk_bf16_f32 v47, v62, v63
s_sub_u32 s30, s30, 1
s_cmp_lg_u32 s30, 0
s_cbranch_scc1 Lk2_l3
s_lshl_b32 s33, s23, 6
s_add_i32 s33, s33, 0
s_cmp_gt_i32 s33, 0
s_cselect_b32 s34, 0, 0xf149f2ca
s_cmp_lt_i32 s33, 0
s_cselect_b32 s33, 0xf149f2ca, 0
v_mov_b32 v20, s34
v_mov_b32 v21, s34
v_mov_b32 v22, s34
v_mov_b32 v23, s34
v_mov_b32 v28, s33
v_mov_b32 v29, s33
v_mov_b32 v30, s33
v_mov_b32 v31, s33
v_med3_f32 v24, v16, v20, v28
v_med3_f32 v25, v17, v20, v28
v_med3_f32 v26, v18, v20, v28
v_med3_f32 v27, v19, v20, v28
s_add_u32 m0, s29, 65536
s_waitcnt lgkmcnt(4)
M v[96:99], a[116:119], a[0:3], v[24:27]
v_exp_f32 v64, v64
M v[96:99], a[120:123], a[4:7], v[96:99]
ds_read_b128 a[148:151], v2 offset:8192
ds_read_b128 a[152:155], v2 offset:9216
M v[96:99], a[124:127], a[8:11], v[96:99]
v_exp_f32 v65, v65
M v[96:99], a[128:131], a[12:15], v[96:99]
buffer_load_dwordx4 v1, s[12:15], s25 offen offset:0 sc1 lds
s_add_u32 s32, s25, 4096
M v[100:103], a[128:131], a[28:31], v[28:31]
v_exp_f32 v66, v66
M v[100:103], a[124:127], a[24:27], v[100:103]
v_cvt_pk_bf16_f32 v64, v64, v65
M v[100:103], a[120:123], a[20:23], v[100:103]
v_exp_f32 v67, v67
M v[100:103], a[116:119], a[16:19], v[100:103]
buffer_load_dwordx4 v1, s[12:15], s25 offen offset:1024 sc1 lds
M v[104:107], a[116:119], a[32:35], v[28:31]
v_exp_f32 v80, v80
M v[104:107], a[120:123], a[36:39], v[104:107]
ds_read_b128 a[156:159], v2 offset:10240
ds_read_b128 a[160:163], v2 offset:11264
M v[104:107], a[124:127], a[40:43], v[104:107]
v_exp_f32 v81, v81
M v[104:107], a[128:131], a[44:47], v[104:107]
buffer_load_dwordx4 v1, s[12:15], s25 offen offset:2048 sc1 lds
M v[108:111], a[128:131], a[60:63], v[28:31]
v_exp_f32 v82, v82
M v[108:111], a[124:127], a[56:59], v[108:111]
v_cvt_pk_bf16_f32 v65, v66, v67
v_cvt_pk_bf16_f32 v66, v80, v81
M v[108:111], a[120:123], a[52:55], v[108:111]
v_exp_f32 v83, v83
M v[108:111], a[116:119], a[48:51], v[108:111]
buffer_load_dwordx4 v1, s[12:15], s25 offen offset:3072 sc1 lds
s_add_u32 m0, s29, 69632
s_waitcnt lgkmcnt(4)
M v[112:115], a[132:135], a[0:3], v[20:23]
v_exp_f32 v68, v68
M v[112:115], a[136:139], a[4:7], v[112:115]
ds_read_b128 a[164:167], v2 offset:12288
ds_read_b128 a[168:171], v2 offset:13312
M v[112:115], a[140:143], a[8:11], v[112:115]
v_exp_f32 v69, v69
M v[112:115], a[144:147], a[12:15], v[112:115]
buffer_load_dwordx4 v1, s[12:15], s32 offen offset:0 sc1 lds
M v[116:119], a[144:147], a[28:31], v[24:27]
v_exp_f32 v70, v70
M v[116:119], a[140:143], a[24:27], v[116:119]
v_cvt_pk_bf16_f32 v67, v82, v83
v_cvt_pk_bf16_f32 v68, v68, v69
M v[116:119], a[136:139], a[20:23], v[116:119]
v_exp_f32 v71, v71
M v[116:119], a[132:135], a[16:19], v[116:119]
buffer_load_dwordx4 v1, s[12:15], s32 offen offset:1024 sc1 lds
M v[120:123], a[132:135], a[32:35], v[28:31]
v_exp_f32 v84, v84
M v[120:123], a[136:139], a[36:39], v[120:123]
ds_read_b128 a[172:175], v2 offset:14336
ds_read_b128 a[176:179], v2 offset:15360
M v[120:123], a[140:143], a[40:43], v[120:123]
v_exp_f32 v85, v85
M v[120:123], a[144:147], a[44:47], v[120:123]
buffer_load_dwordx4 v1, s[12:15], s32 offen offset:2048 sc1 lds
M v[124:127], a[144:147], a[60:63], v[28:31]
v_exp_f32 v86, v86
M v[124:127], a[140:143], a[56:59], v[124:127]
v_cvt_pk_bf16_f32 v69, v70, v71
v_cvt_pk_bf16_f32 v70, v84, v85
M v[124:127], a[136:139], a[52:55], v[124:127]
v_exp_f32 v87, v87
M v[124:127], a[132:135], a[48:51], v[124:127]
buffer_load_dwordx4 v1, s[12:15], s32 offen offset:3072 sc1 lds
s_add_u32 m0, s29, 98304
s_waitcnt lgkmcnt(4)
M v[128:131], a[148:151], a[0:3], v[20:23]
v_exp_f32 v72, v72
M v[128:131], a[152:155], a[4:7], v[128:131]
ds_read_b128 a[116:119], v2 offset:32768
ds_read_b128 a[120:123], v2 offset:40960
M v[128:131], a[156:159], a[8:11], v[128:131]
v_exp_f32 v73, v73
M v[128:131], a[160:163], a[12:15], v[128:131]
buffer_load_dwordx4 v1, s[12:15], s26 offen offset:0 sc1 lds
s_add_u32 s43, s26, 4096
M v[132:135], a[160:163], a[28:31], v[20:23]
v_exp_f32 v74, v74
M v[132:135], a[156:159], a[24:27], v[132:135]
v_cvt_pk_bf16_f32 v71, v86, v87
v_cvt_pk_bf16_f32 v72, v72, v73
M v[132:135], a[152:155], a[20:23], v[132:135]
v_exp_f32 v75, v75
M v[132:135], a[148:151], a[16:19], v[132:135]
buffer_load_dwordx4 v1, s[12:15], s26 offen offset:1024 sc1 lds
M v[136:139], a[148:151], a[32:35], v[24:27]
v_exp_f32 v88, v88
M v[136:139], a[152:155], a[36:39], v[136:139]
ds_read_b128 a[124:127], v2 offset:33792
ds_read_b128 a[128:131], v2 offset:41984
M v[136:139], a[156:159], a[40:43], v[136:139]
v_exp_f32 v89, v89
M v[136:139], a[160:163], a[44:47], v[136:139]
buffer_load_dwordx4 v1, s[12:15], s26 offen offset:2048 sc1 lds
M v[140:143], a[160:163], a[60:63], v[28:31]
v_exp_f32 v90, v90
M v[140:143], a[156:159], a[56:59], v[140:143]
v_cvt_pk_bf16_f32 v73, v74, v75
v_cvt_pk_bf16_f32 v74, v88, v89
M v[140:143], a[152:155], a[52:55], v[140:143]
v_exp_f32 v91, v91
M v[140:143], a[148:151], a[48:51], v[140:143]
buffer_load_dwordx4 v1, s[12:15], s26 offen offset:3072 sc1 lds
s_add_u32 m0, s29, 102400
s_waitcnt lgkmcnt(4)
M v[144:147], a[164:167], a[0:3], v[20:23]
v_exp_f32 v76, v76
M v[144:147], a[168:171], a[4:7], v[144:147]
ds_read_b128 a[132:135], v2 offset:34816
ds_read_b128 a[136:139], v2 offset:43008
M v[144:147], a[172:175], a[8:11], v[144:147]
v_exp_f32 v77, v77
M v[144:147], a[176:179], a[12:15], v[144:147]
buffer_load_dwordx4 v1, s[12:15], s43 offen offset:0 sc1 lds
M v[148:151], a[176:179], a[28:31], v[20:23]
v_exp_f32 v78, v78
M v[148:151], a[172:175], a[24:27], v[148:151]
v_cvt_pk_bf16_f32 v75, v90, v91
v_cvt_pk_bf16_f32 v76, v76, v77
M v[148:151], a[168:171], a[20:23], v[148:151]
v_exp_f32 v79, v79
M v[148:151], a[164:167], a[16:19], v[148:151]
buffer_load_dwordx4 v1, s[12:15], s43 offen offset:1024 sc1 lds
M v[152:155], a[164:167], a[32:35], v[20:23]
v_exp_f32 v92, v92
M v[152:155], a[168:171], a[36:39], v[152:155]
ds_read_b128 a[140:143], v2 offset:35840
ds_read_b128 a[144:147], v2 offset:44032
M v[152:155], a[172:175], a[40:43], v[152:155]
v_exp_f32 v93, v93
M v[152:155], a[176:179], a[44:47], v[152:155]
buffer_load_dwordx4 v1, s[12:15], s43 offen offset:2048 sc1 lds
M v[156:159], a[176:179], a[60:63], v[24:27]
v_exp_f32 v94, v94
M v[156:159], a[172:175], a[56:59], v[156:159]
v_cvt_pk_bf16_f32 v77, v78, v79
v_cvt_pk_bf16_f32 v78, v92, v93
M v[156:159], a[168:171], a[52:55], v[156:159]
v_exp_f32 v95, v95
M v[156:159], a[164:167], a[48:51], v[156:159]
buffer_load_dwordx4 v1, s[12:15], s43 offen offset:3072 sc1 lds
v_cvt_pk_bf16_f32 v79, v94, v95
s_waitcnt lgkmcnt(6)
M v[160:163], a[116:119], v[32:35], v[160:163]
v_exp_f32 v96, v96
M v[160:163], a[120:123], v[64:67], v[160:163]
ds_read_b128 a[148:151], v2 offset:36864
ds_read_b128 a[152:155], v2 offset:45056
M v[164:167], a[120:123], v[68:71], v[164:167]
v_exp_f32 v97, v97
M v[164:167], a[116:119], v[36:39], v[164:167]
v_cvt_pk_bf16_f32 v96, v96, v97
M v[168:171], a[116:119], v[40:43], v[168:171]
v_exp_f32 v98, v98
M v[168:171], a[120:123], v[72:75], v[168:171]
s_add_u32 s25, s25, 32768
s_cmp_eq_u32 s25, s27
M v[172:175], a[120:123], v[76:79], v[172:175]
v_exp_f32 v99, v99
M v[172:175], a[116:119], v[44:47], v[172:175]
v_cvt_pk_bf16_f32 v97, v98, v99
s_waitcnt lgkmcnt(6)
M a[96:99], a[112:115], v[32:35], a[96:99]
s_cselect_b32 s25, s28, s25
s_cselect_b32 s27, -1, s27
M a[96:99], a[112:115], v[64:67], a[96:99]
s_add_u32 s26, s26, 32768
s_cmp_eq_u32 s26, s62
M v[176:179], a[124:127], v[32:35], v[176:179]
v_exp_f32 v112, v112
M v[176:179], a[128:131], v[64:67], v[176:179]
ds_read_b128 a[156:159], v2 offset:37888
ds_read_b128 a[160:163], v2 offset:46080
M v[180:183], a[128:131], v[68:71], v[180:183]
v_exp_f32 v113, v113
M v[180:183], a[124:127], v[36:39], v[180:183]
v_cvt_pk_bf16_f32 v98, v112, v113
M v[184:187], a[124:127], v[40:43], v[184:187]
v_exp_f32 v114, v114
M v[184:187], a[128:131], v[72:75], v[184:187]
s_cselect_b32 s26, s63, s26
s_cselect_b32 s62, -1, s62
M v[188:191], a[128:131], v[76:79], v[188:191]
v_exp_f32 v115, v115
M v[188:191], a[124:127], v[44:47], v[188:191]
v_cvt_pk_bf16_f32 v99, v114, v115
s_waitcnt lgkmcnt(6)
M a[100:103], a[112:115], v[36:39], a[100:103]
M a[100:103], a[112:115], v[68:71], a[100:103]
M v[192:195], a[132:135], v[32:35], v[192:195]
v_exp_f32 v100, v100
M v[192:195], a[136:139], v[64:67], v[192:195]
ds_read_b128 a[164:167], v2 offset:38912
ds_read_b128 a[168:171], v2 offset:47104
M v[196:199], a[136:139], v[68:71], v[196:199]
v_exp_f32 v101, v101
M v[196:199], a[132:135], v[36:39], v[196:199]
v_cvt_pk_bf16_f32 v100, v100, v101
M v[200:203], a[132:135], v[40:43], v[200:203]
v_exp_f32 v102, v102
M v[200:203], a[136:139], v[72:75], v[200:203]
M v[204:207], a[136:139], v[76:79], v[204:207]
v_exp_f32 v103, v103
M v[204:207], a[132:135], v[44:47], v[204:207]
v_cvt_pk_bf16_f32 v101, v102, v103
s_waitcnt lgkmcnt(6)
M a[104:107], a[112:115], v[40:43], a[104:107]
M a[104:107], a[112:115], v[72:75], a[104:107]
M v[208:211], a[140:143], v[32:35], v[208:211]
v_exp_f32 v116, v116
M v[208:211], a[144:147], v[64:67], v[208:211]
ds_read_b128 a[172:175], v2 offset:39936
ds_read_b128 a[176:179], v2 offset:48128
M v[212:215], a[144:147], v[68:71], v[212:215]
v_exp_f32 v117, v117
M v[212:215], a[140:143], v[36:39], v[212:215]
v_cvt_pk_bf16_f32 v102, v116, v117
M v[216:219], a[140:143], v[40:43], v[216:219]
v_exp_f32 v118, v118
M v[216:219], a[144:147], v[72:75], v[216:219]
M v[220:223], a[144:147], v[76:79], v[220:223]
v_exp_f32 v119, v119
M v[220:223], a[140:143], v[44:47], v[220:223]
v_cvt_pk_bf16_f32 v103, v118, v119
s_waitcnt lgkmcnt(6)
M a[108:111], a[112:115], v[44:47], a[108:111]
M a[108:111], a[112:115], v[76:79], a[108:111]
M v[224:227], a[148:151], v[32:35], v[224:227]
v_exp_f32 v104, v104
M v[224:227], a[152:155], v[64:67], v[224:227]
M v[228:231], a[152:155], v[68:71], v[228:231]
v_exp_f32 v105, v105
M v[228:231], a[148:151], v[36:39], v[228:231]
v_cvt_pk_bf16_f32 v104, v104, v105
M v[232:235], a[148:151], v[40:43], v[232:235]
v_exp_f32 v106, v106
M v[232:235], a[152:155], v[72:75], v[232:235]
M v[236:239], a[152:155], v[76:79], v[236:239]
v_exp_f32 v107, v107
M v[236:239], a[148:151], v[44:47], v[236:239]
v_cvt_pk_bf16_f32 v105, v106, v107
s_waitcnt lgkmcnt(4)
M v[240:243], a[156:159], v[32:35], v[240:243]
v_exp_f32 v120, v120
M v[240:243], a[160:163], v[64:67], v[240:243]
M v[244:247], a[160:163], v[68:71], v[244:247]
v_exp_f32 v121, v121
M v[244:247], a[156:159], v[36:39], v[244:247]
v_cvt_pk_bf16_f32 v106, v120, v121
M v[248:251], a[156:159], v[40:43], v[248:251]
v_exp_f32 v122, v122
M v[248:251], a[160:163], v[72:75], v[248:251]
s_waitcnt vmcnt(0) lgkmcnt(0)
s_barrier
ds_read_b128 a[116:119], v3 offset:0
ds_read_b128 a[120:123], v3 offset:1024
M v[252:255], a[160:163], v[76:79], v[252:255]
v_exp_f32 v123, v123
M v[252:255], a[156:159], v[44:47], v[252:255]
v_cvt_pk_bf16_f32 v107, v122, v123
M a[64:67], a[164:167], v[32:35], a[64:67]
v_exp_f32 v108, v108
M a[64:67], a[168:171], v[64:67], a[64:67]
ds_read_b128 a[124:127], v3 offset:2048
ds_read_b128 a[128:131], v3 offset:3072
M a[68:71], a[168:171], v[68:71], a[68:71]
v_exp_f32 v109, v109
M a[68:71], a[164:167], v[36:39], a[68:71]
v_cvt_pk_bf16_f32 v108, v108, v109
M a[72:75], a[164:167], v[40:43], a[72:75]
v_exp_f32 v110, v110
M a[72:75], a[168:171], v[72:75], a[72:75]
ds_read_b128 a[132:135], v3 offset:4096
ds_read_b128 a[136:139], v3 offset:5120
M a[76:79], a[168:171], v[76:79], a[76:79]
v_exp_f32 v111, v111
M a[76:79], a[164:167], v[44:47], a[76:79]
v_cvt_pk_bf16_f32 v109, v110, v111
M a[80:83], a[172:175], v[32:35], a[80:83]
v_exp_f32 v124, v124
M a[80:83], a[176:179], v[64:67], a[80:83]
ds_read_b128 a[140:143], v3 offset:6144
ds_read_b128 a[144:147], v3 offset:7168
M a[84:87], a[176:179], v[68:71], a[84:87]
v_exp_f32 v125, v125
M a[84:87], a[172:175], v[36:39], a[84:87]
v_cvt_pk_bf16_f32 v110, v124, v125
M a[88:91], a[172:175], v[40:43], a[88:91]
v_exp_f32 v126, v126
M a[88:91], a[176:179], v[72:75], a[88:91]
M a[92:95], a[176:179], v[76:79], a[92:95]
v_exp_f32 v127, v127
M a[92:95], a[172:175], v[44:47], a[92:95]
v_cvt_pk_bf16_f32 v111, v126, v127
s_lshl_b32 s33, s23, 6
s_add_i32 s33, s33, -64
s_cmp_gt_i32 s33, 0
s_cselect_b32 s34, 0, 0xf149f2ca
s_cmp_lt_i32 s33, 0
s_cselect_b32 s33, 0xf149f2ca, 0
v_mov_b32 v20, s34
v_mov_b32 v21, s34
v_mov_b32 v22, s34
v_mov_b32 v23, s34
v_mov_b32 v28, s33
v_mov_b32 v29, s33
v_mov_b32 v30, s33
v_mov_b32 v31, s33
v_med3_f32 v24, v16, v20, v28
v_med3_f32 v25, v17, v20, v28
v_med3_f32 v26, v18, v20, v28
v_med3_f32 v27, v19, v20, v28
s_add_u32 m0, s29, 0
s_waitcnt lgkmcnt(4)
M v[32:35], a[116:119], a[0:3], v[24:27]
v_exp_f32 v128, v128
M v[32:35], a[120:123], a[4:7], v[32:35]
ds_read_b128 a[148:151], v3 offset:8192
ds_read_b128 a[152:155], v3 offset:9216
M v[32:35], a[124:127], a[8:11], v[32:35]
v_exp_f32 v129, v129
M v[32:35], a[128:131], a[12:15], v[32:35]
buffer_load_dwordx4 v1, s[12:15], s25 offen offset:0 sc1 lds
s_add_u32 s32, s25, 4096
M v[36:39], a[128:131], a[28:31], v[28:31]
v_exp_f32 v130, v130
M v[36:39], a[124:127], a[24:27], v[36:39]
v_cvt_pk_bf16_f32 v128, v128, v129
M v[36:39], a[120:123], a[20:23], v[36:39]
v_exp_f32 v131, v131
M v[36:39], a[116:119], a[16:19], v[36:39]
buffer_load_dwordx4 v1, s[12:15], s25 offen offset:1024 sc1 lds
M v[40:43], a[116:119], a[32:35], v[28:31]
v_exp_f32 v144, v144
M v[40:43], a[120:123], a[36:39], v[40:43]
ds_read_b128 a[156:159], v3 offset:10240
ds_read_b128 a[160:163], v3 offset:11264
M v[40:43], a[124:127], a[40:43], v[40:43]
v_exp_f32 v145, v145
M v[40:43], a[128:131], a[44:47], v[40:43]
buffer_load_dwordx4 v1, s[12:15], s25 offen offset:2048 sc1 lds
M v[44:47], a[128:131], a[60:63], v[28:31]
v_exp_f32 v146, v146
M v[44:47], a[124:127], a[56:59], v[44:47]
v_cvt_pk_bf16_f32 v129, v130, v131
v_cvt_pk_bf16_f32 v130, v144, v145
M v[44:47], a[120:123], a[52:55], v[44:47]
v_exp_f32 v147, v147
M v[44:47], a[116:119], a[48:51], v[44:47]
buffer_load_dwordx4 v1, s[12:15], s25 offen offset:3072 sc1 lds
s_add_u32 m0, s29, 4096
s_waitcnt lgkmcnt(4)
M v[48:51], a[132:135], a[0:3], v[20:23]
v_exp_f32 v132, v132
M v[48:51], a[136:139], a[4:7], v[48:51]
ds_read_b128 a[164:167], v3 offset:12288
ds_read_b128 a[168:171], v3 offset:13312
M v[48:51], a[140:143], a[8:11], v[48:51]
v_exp_f32 v133, v133
M v[48:51], a[144:147], a[12:15], v[48:51]
buffer_load_dwordx4 v1, s[12:15], s32 offen offset:0 sc1 lds
M v[52:55], a[144:147], a[28:31], v[24:27]
v_exp_f32 v134, v134
M v[52:55], a[140:143], a[24:27], v[52:55]
v_cvt_pk_bf16_f32 v131, v146, v147
v_cvt_pk_bf16_f32 v132, v132, v133
M v[52:55], a[136:139], a[20:23], v[52:55]
v_exp_f32 v135, v135
M v[52:55], a[132:135], a[16:19], v[52:55]
buffer_load_dwordx4 v1, s[12:15], s32 offen offset:1024 sc1 lds
M v[56:59], a[132:135], a[32:35], v[28:31]
v_exp_f32 v148, v148
M v[56:59], a[136:139], a[36:39], v[56:59]
ds_read_b128 a[172:175], v3 offset:14336
ds_read_b128 a[176:179], v3 offset:15360
M v[56:59], a[140:143], a[40:43], v[56:59]
v_exp_f32 v149, v149
M v[56:59], a[144:147], a[44:47], v[56:59]
buffer_load_dwordx4 v1, s[12:15], s32 offen offset:2048 sc1 lds
M v[60:63], a[144:147], a[60:63], v[28:31]
v_exp_f32 v150, v150
M v[60:63], a[140:143], a[56:59], v[60:63]
v_cvt_pk_bf16_f32 v133, v134, v135
v_cvt_pk_bf16_f32 v134, v148, v149
M v[60:63], a[136:139], a[52:55], v[60:63]
v_exp_f32 v151, v151
M v[60:63], a[132:135], a[48:51], v[60:63]
buffer_load_dwordx4 v1, s[12:15], s32 offen offset:3072 sc1 lds
s_add_u32 m0, s29, 32768
s_waitcnt lgkmcnt(4)
M v[64:67], a[148:151], a[0:3], v[20:23]
v_exp_f32 v136, v136
M v[64:67], a[152:155], a[4:7], v[64:67]
ds_read_b128 a[116:119], v3 offset:32768
ds_read_b128 a[120:123], v3 offset:40960
M v[64:67], a[156:159], a[8:11], v[64:67]
v_exp_f32 v137, v137
M v[64:67], a[160:163], a[12:15], v[64:67]
buffer_load_dwordx4 v1, s[12:15], s26 offen offset:0 sc1 lds
s_add_u32 s43, s26, 4096
M v[68:71], a[160:163], a[28:31], v[20:23]
v_exp_f32 v138, v138
M v[68:71], a[156:159], a[24:27], v[68:71]
v_cvt_pk_bf16_f32 v135, v150, v151
v_cvt_pk_bf16_f32 v136, v136, v137
M v[68:71], a[152:155], a[20:23], v[68:71]
v_exp_f32 v139, v139
M v[68:71], a[148:151], a[16:19], v[68:71]
buffer_load_dwordx4 v1, s[12:15], s26 offen offset:1024 sc1 lds
M v[72:75], a[148:151], a[32:35], v[24:27]
v_exp_f32 v152, v152
M v[72:75], a[152:155], a[36:39], v[72:75]
ds_read_b128 a[124:127], v3 offset:33792
ds_read_b128 a[128:131], v3 offset:41984
M v[72:75], a[156:159], a[40:43], v[72:75]
v_exp_f32 v153, v153
M v[72:75], a[160:163], a[44:47], v[72:75]
buffer_load_dwordx4 v1, s[12:15], s26 offen offset:2048 sc1 lds
M v[76:79], a[160:163], a[60:63], v[28:31]
v_exp_f32 v154, v154
M v[76:79], a[156:159], a[56:59], v[76:79]
v_cvt_pk_bf16_f32 v137, v138, v139
v_cvt_pk_bf16_f32 v138, v152, v153
M v[76:79], a[152:155], a[52:55], v[76:79]
v_exp_f32 v155, v155
M v[76:79], a[148:151], a[48:51], v[76:79]
buffer_load_dwordx4 v1, s[12:15], s26 offen offset:3072 sc1 lds
s_add_u32 m0, s29, 36864
s_waitcnt lgkmcnt(4)
M v[80:83], a[164:167], a[0:3], v[20:23]
v_exp_f32 v140, v140
M v[80:83], a[168:171], a[4:7], v[80:83]
ds_read_b128 a[132:135], v3 offset:34816
ds_read_b128 a[136:139], v3 offset:43008
M v[80:83], a[172:175], a[8:11], v[80:83]
v_exp_f32 v141, v141
M v[80:83], a[176:179], a[12:15], v[80:83]
buffer_load_dwordx4 v1, s[12:15], s43 offen offset:0 sc1 lds
M v[84:87], a[176:179], a[28:31], v[20:23]
v_exp_f32 v142, v142
M v[84:87], a[172:175], a[24:27], v[84:87]
v_cvt_pk_bf16_f32 v139, v154, v155
v_cvt_pk_bf16_f32 v140, v140, v141
M v[84:87], a[168:171], a[20:23], v[84:87]
v_exp_f32 v143, v143
M v[84:87], a[164:167], a[16:19], v[84:87]
buffer_load_dwordx4 v1, s[12:15], s43 offen offset:1024 sc1 lds
M v[88:91], a[164:167], a[32:35], v[20:23]
v_exp_f32 v156, v156
M v[88:91], a[168:171], a[36:39], v[88:91]
ds_read_b128 a[140:143], v3 offset:35840
ds_read_b128 a[144:147], v3 offset:44032
M v[88:91], a[172:175], a[40:43], v[88:91]
v_exp_f32 v157, v157
M v[88:91], a[176:179], a[44:47], v[88:91]
buffer_load_dwordx4 v1, s[12:15], s43 offen offset:2048 sc1 lds
M v[92:95], a[176:179], a[60:63], v[24:27]
v_exp_f32 v158, v158
M v[92:95], a[172:175], a[56:59], v[92:95]
v_cvt_pk_bf16_f32 v141, v142, v143
v_cvt_pk_bf16_f32 v142, v156, v157
M v[92:95], a[168:171], a[52:55], v[92:95]
v_exp_f32 v159, v159
M v[92:95], a[164:167], a[48:51], v[92:95]
buffer_load_dwordx4 v1, s[12:15], s43 offen offset:3072 sc1 lds
v_cvt_pk_bf16_f32 v143, v158, v159
s_waitcnt lgkmcnt(6)
M v[160:163], a[116:119], v[96:99], v[160:163]
v_exp_f32 v32, v32
M v[160:163], a[120:123], v[128:131], v[160:163]
ds_read_b128 a[148:151], v3 offset:36864
ds_read_b128 a[152:155], v3 offset:45056
M v[164:167], a[120:123], v[132:135], v[164:167]
v_exp_f32 v33, v33
M v[164:167], a[116:119], v[100:103], v[164:167]
v_cvt_pk_bf16_f32 v32, v32, v33
M v[168:171], a[116:119], v[104:107], v[168:171]
v_exp_f32 v34, v34
M v[168:171], a[120:123], v[136:139], v[168:171]
s_add_u32 s25, s25, 32768
s_cmp_eq_u32 s25, s27
M v[172:175], a[120:123], v[140:143], v[172:175]
v_exp_f32 v35, v35
M v[172:175], a[116:119], v[108:111], v[172:175]
v_cvt_pk_bf16_f32 v33, v34, v35
s_waitcnt lgkmcnt(6)
M a[96:99], a[112:115], v[96:99], a[96:99]
s_cselect_b32 s25, s28, s25
s_cselect_b32 s27, -1, s27
M a[96:99], a[112:115], v[128:131], a[96:99]
s_add_u32 s26, s26, 32768
s_cmp_eq_u32 s26, s62
M v[176:179], a[124:127], v[96:99], v[176:179]
v_exp_f32 v48, v48
M v[176:179], a[128:131], v[128:131], v[176:179]
ds_read_b128 a[156:159], v3 offset:37888
ds_read_b128 a[160:163], v3 offset:46080
M v[180:183], a[128:131], v[132:135], v[180:183]
v_exp_f32 v49, v49
M v[180:183], a[124:127], v[100:103], v[180:183]
v_cvt_pk_bf16_f32 v34, v48, v49
M v[184:187], a[124:127], v[104:107], v[184:187]
v_exp_f32 v50, v50
M v[184:187], a[128:131], v[136:139], v[184:187]
s_cselect_b32 s26, s63, s26
s_cselect_b32 s62, -1, s62
M v[188:191], a[128:131], v[140:143], v[188:191]
v_exp_f32 v51, v51
M v[188:191], a[124:127], v[108:111], v[188:191]
v_cvt_pk_bf16_f32 v35, v50, v51
s_waitcnt lgkmcnt(6)
M a[100:103], a[112:115], v[100:103], a[100:103]
M a[100:103], a[112:115], v[132:135], a[100:103]
M v[192:195], a[132:135], v[96:99], v[192:195]
v_exp_f32 v36, v36
M v[192:195], a[136:139], v[128:131], v[192:195]
ds_read_b128 a[164:167], v3 offset:38912
ds_read_b128 a[168:171], v3 offset:47104
M v[196:199], a[136:139], v[132:135], v[196:199]
v_exp_f32 v37, v37
M v[196:199], a[132:135], v[100:103], v[196:199]
v_cvt_pk_bf16_f32 v36, v36, v37
M v[200:203], a[132:135], v[104:107], v[200:203]
v_exp_f32 v38, v38
M v[200:203], a[136:139], v[136:139], v[200:203]
M v[204:207], a[136:139], v[140:143], v[204:207]
v_exp_f32 v39, v39
M v[204:207], a[132:135], v[108:111], v[204:207]
v_cvt_pk_bf16_f32 v37, v38, v39
s_waitcnt lgkmcnt(6)
M a[104:107], a[112:115], v[104:107], a[104:107]
M a[104:107], a[112:115], v[136:139], a[104:107]
M v[208:211], a[140:143], v[96:99], v[208:211]
v_exp_f32 v52, v52
M v[208:211], a[144:147], v[128:131], v[208:211]
ds_read_b128 a[172:175], v3 offset:39936
ds_read_b128 a[176:179], v3 offset:48128
M v[212:215], a[144:147], v[132:135], v[212:215]
v_exp_f32 v53, v53
M v[212:215], a[140:143], v[100:103], v[212:215]
v_cvt_pk_bf16_f32 v38, v52, v53
M v[216:219], a[140:143], v[104:107], v[216:219]
v_exp_f32 v54, v54
M v[216:219], a[144:147], v[136:139], v[216:219]
M v[220:223], a[144:147], v[140:143], v[220:223]
v_exp_f32 v55, v55
M v[220:223], a[140:143], v[108:111], v[220:223]
v_cvt_pk_bf16_f32 v39, v54, v55
s_waitcnt lgkmcnt(6)
M a[108:111], a[112:115], v[108:111], a[108:111]
M a[108:111], a[112:115], v[140:143], a[108:111]
M v[224:227], a[148:151], v[96:99], v[224:227]
v_exp_f32 v40, v40
M v[224:227], a[152:155], v[128:131], v[224:227]
M v[228:231], a[152:155], v[132:135], v[228:231]
v_exp_f32 v41, v41
M v[228:231], a[148:151], v[100:103], v[228:231]
v_cvt_pk_bf16_f32 v40, v40, v41
M v[232:235], a[148:151], v[104:107], v[232:235]
v_exp_f32 v42, v42
M v[232:235], a[152:155], v[136:139], v[232:235]
M v[236:239], a[152:155], v[140:143], v[236:239]
v_exp_f32 v43, v43
M v[236:239], a[148:151], v[108:111], v[236:239]
v_cvt_pk_bf16_f32 v41, v42, v43
s_waitcnt lgkmcnt(4)
M v[240:243], a[156:159], v[96:99], v[240:243]
v_exp_f32 v56, v56
M v[240:243], a[160:163], v[128:131], v[240:243]
M v[244:247], a[160:163], v[132:135], v[244:247]
v_exp_f32 v57, v57
M v[244:247], a[156:159], v[100:103], v[244:247]
v_cvt_pk_bf16_f32 v42, v56, v57
M v[248:251], a[156:159], v[104:107], v[248:251]
v_exp_f32 v58, v58
M v[248:251], a[160:163], v[136:139], v[248:251]
s_waitcnt vmcnt(0) lgkmcnt(0)
s_barrier
ds_read_b128 a[116:119], v2 offset:0
ds_read_b128 a[120:123], v2 offset:1024
M v[252:255], a[160:163], v[140:143], v[252:255]
v_exp_f32 v59, v59
M v[252:255], a[156:159], v[108:111], v[252:255]
v_cvt_pk_bf16_f32 v43, v58, v59
M a[64:67], a[164:167], v[96:99], a[64:67]
v_exp_f32 v44, v44
M a[64:67], a[168:171], v[128:131], a[64:67]
ds_read_b128 a[124:127], v2 offset:2048
ds_read_b128 a[128:131], v2 offset:3072
M a[68:71], a[168:171], v[132:135], a[68:71]
v_exp_f32 v45, v45
M a[68:71], a[164:167], v[100:103], a[68:71]
v_cvt_pk_bf16_f32 v44, v44, v45
M a[72:75], a[164:167], v[104:107], a[72:75]
v_exp_f32 v46, v46
M a[72:75], a[168:171], v[136:139], a[72:75]
ds_read_b128 a[132:135], v2 offset:4096
ds_read_b128 a[136:139], v2 offset:5120
M a[76:79], a[168:171], v[140:143], a[76:79]
v_exp_f32 v47, v47
M a[76:79], a[164:167], v[108:111], a[76:79]
v_cvt_pk_bf16_f32 v45, v46, v47
M a[80:83], a[172:175], v[96:99], a[80:83]
v_exp_f32 v60, v60
M a[80:83], a[176:179], v[128:131], a[80:83]
ds_read_b128 a[140:143], v2 offset:6144
ds_read_b128 a[144:147], v2 offset:7168
M a[84:87], a[176:179], v[132:135], a[84:87]
v_exp_f32 v61, v61
M a[84:87], a[172:175], v[100:103], a[84:87]
v_cvt_pk_bf16_f32 v46, v60, v61
M a[88:91], a[172:175], v[104:107], a[88:91]
v_exp_f32 v62, v62
M a[88:91], a[176:179], v[136:139], a[88:91]
M a[92:95], a[176:179], v[140:143], a[92:95]
v_exp_f32 v63, v63
M a[92:95], a[172:175], v[108:111], a[92:95]
v_cvt_pk_bf16_f32 v47, v62, v63
s_waitcnt lgkmcnt(0)
Lk2_fin:
s_and_b32 s3, s2, 3
s_lshl_b32 s3, s3, 2
s_bfe_u32 s27, s2, 0x20003
s_add_u32 s27, s3, s27
s_lshl_b32 s43, s27, 8
s_add_u32 s43, s43, 8400896
v_lshlrev_b32 v15, 2, v0
buffer_load_dword v7, v15, s[52:55], s43 offen sc1
ds_read_b128 a[116:119], v2 offset:32768
ds_read_b128 a[120:123], v2 offset:40960
ds_read_b128 a[124:127], v2 offset:33792
ds_read_b128 a[128:131], v2 offset:41984
ds_read_b128 a[132:135], v2 offset:34816
ds_read_b128 a[136:139], v2 offset:43008
ds_read_b128 a[140:143], v2 offset:35840
ds_read_b128 a[144:147], v2 offset:44032
v_exp_f32 v64, v64
v_exp_f32 v65, v65
v_exp_f32 v66, v66
v_exp_f32 v67, v67
v_exp_f32 v80, v80
v_exp_f32 v81, v81
v_exp_f32 v82, v82
v_exp_f32 v83, v83
v_cvt_pk_bf16_f32 v64, v64, v65
v_cvt_pk_bf16_f32 v65, v66, v67
v_exp_f32 v68, v68
v_exp_f32 v69, v69
v_exp_f32 v70, v70
v_exp_f32 v71, v71
v_cvt_pk_bf16_f32 v66, v80, v81
v_cvt_pk_bf16_f32 v67, v82, v83
v_exp_f32 v84, v84
v_exp_f32 v85, v85
v_exp_f32 v86, v86
v_exp_f32 v87, v87
v_cvt_pk_bf16_f32 v68, v68, v69
v_cvt_pk_bf16_f32 v69, v70, v71
v_exp_f32 v72, v72
v_exp_f32 v73, v73
v_exp_f32 v74, v74
v_exp_f32 v75, v75
v_cvt_pk_bf16_f32 v70, v84, v85
v_cvt_pk_bf16_f32 v71, v86, v87
v_exp_f32 v88, v88
v_exp_f32 v89, v89
v_exp_f32 v90, v90
v_exp_f32 v91, v91
v_cvt_pk_bf16_f32 v72, v72, v73
v_cvt_pk_bf16_f32 v73, v74, v75
v_exp_f32 v76, v76
v_exp_f32 v77, v77
v_exp_f32 v78, v78
v_exp_f32 v79, v79
v_cvt_pk_bf16_f32 v74, v88, v89
v_cvt_pk_bf16_f32 v75, v90, v91
v_exp_f32 v92, v92
v_exp_f32 v93, v93
v_exp_f32 v94, v94
v_exp_f32 v95, v95
v_cvt_pk_bf16_f32 v76, v76, v77
v_cvt_pk_bf16_f32 v77, v78, v79
v_cvt_pk_bf16_f32 v78, v92, v93
v_cvt_pk_bf16_f32 v79, v94, v95
s_waitcnt lgkmcnt(6)
M v[160:163], a[116:119], v[32:35], v[160:163]
M v[160:163], a[120:123], v[64:67], v[160:163]
ds_read_b128 a[148:151], v2 offset:36864
ds_read_b128 a[152:155], v2 offset:45056
s_mov_b32 s61, 0
M v[164:167], a[120:123], v[68:71], v[164:167]
M v[164:167], a[116:119], v[36:39], v[164:167]
s_bfe_u32 s3, s2, 0x10002
M v[168:171], a[116:119], v[40:43], v[168:171]
M v[168:171], a[120:123], v[72:75], v[168:171]
s_lshl_b32 s3, s3, 3
M v[172:175], a[120:123], v[76:79], v[172:175]
M v[172:175], a[116:119], v[44:47], v[172:175]
s_waitcnt lgkmcnt(6)
s_lshr_b32 s28, s2, 5
M a[96:99], a[112:115], v[32:35], a[96:99]
M a[96:99], a[112:115], v[64:67], a[96:99]
M v[176:179], a[124:127], v[32:35], v[176:179]
M v[176:179], a[128:131], v[64:67], v[176:179]
ds_read_b128 a[156:159], v2 offset:37888
ds_read_b128 a[160:163], v2 offset:46080
s_add_u32 s28, s3, s28
M v[180:183], a[128:131], v[68:71], v[180:183]
s_lshl_b32 s25, s27, 18
M v[180:183], a[124:127], v[36:39], v[180:183]
M v[184:187], a[124:127], v[40:43], v[184:187]
s_lshl_b32 s3, s101, 12
M v[184:187], a[128:131], v[72:75], v[184:187]
M v[188:191], a[128:131], v[76:79], v[188:191]
s_add_u32 s25, s25, s3
M v[188:191], a[124:127], v[44:47], v[188:191]
s_waitcnt lgkmcnt(6)
M a[100:103], a[112:115], v[36:39], a[100:103]
M a[100:103], a[112:115], v[68:71], a[100:103]
M v[192:195], a[132:135], v[32:35], v[192:195]
s_lshl_b32 s26, s28, 7
M v[192:195], a[136:139], v[64:67], v[192:195]
ds_read_b128 a[164:167], v2 offset:38912
ds_read_b128 a[168:171], v2 offset:47104
M v[196:199], a[136:139], v[68:71], v[196:199]
s_lshl_b32 s42, s101, 11
M v[196:199], a[132:135], v[36:39], v[196:199]
M v[200:203], a[132:135], v[40:43], v[200:203]
s_add_u32 s44, s4, 83886080
s_addc_u32 s45, s5, 0
M v[200:203], a[136:139], v[72:75], v[200:203]
s_mov_b32 s46, 4194304
M v[204:207], a[136:139], v[76:79], v[204:207]
M v[204:207], a[132:135], v[44:47], v[204:207]
s_waitcnt lgkmcnt(6)
s_mov_b32 s47, 0x00020000
M a[104:107], a[112:115], v[40:43], a[104:107]
M a[104:107], a[112:115], v[72:75], a[104:107]
M v[208:211], a[140:143], v[32:35], v[208:211]
M v[208:211], a[144:147], v[64:67], v[208:211]
ds_read_b128 a[172:175], v2 offset:39936
ds_read_b128 a[176:179], v2 offset:48128
s_mov_b32 s50, 2097152
M v[212:215], a[144:147], v[68:71], v[212:215]
M v[212:215], a[140:143], v[36:39], v[212:215]
s_mov_b32 s51, 0x00020000
M v[216:219], a[140:143], v[40:43], v[216:219]
M v[216:219], a[144:147], v[72:75], v[216:219]
s_lshl_b32 s3, s101, 4
M v[220:223], a[144:147], v[76:79], v[220:223]
M v[220:223], a[140:143], v[44:47], v[220:223]
s_waitcnt lgkmcnt(6)
v_lshrrev_b32 v96, 3, v0
M a[108:111], a[112:115], v[44:47], a[108:111]
M a[108:111], a[112:115], v[76:79], a[108:111]
M v[224:227], a[148:151], v[32:35], v[224:227]
v_and_b32 v97, 6, v96
M v[224:227], a[152:155], v[64:67], v[224:227]
M v[228:231], a[152:155], v[68:71], v[228:231]
v_and_b32 v98, 7, v0
M v[228:231], a[148:151], v[36:39], v[228:231]
M v[232:235], a[148:151], v[40:43], v[232:235]
v_xor_b32 v97, v97, v98
M v[232:235], a[152:155], v[72:75], v[232:235]
M v[236:239], a[152:155], v[76:79], v[236:239]
v_add_u32 v96, s3, v96
M v[236:239], a[148:151], v[44:47], v[236:239]
s_waitcnt lgkmcnt(4)
M v[240:243], a[156:159], v[32:35], v[240:243]
v_lshlrev_b32 v96, 11, v96
M v[240:243], a[160:163], v[64:67], v[240:243]
M v[244:247], a[160:163], v[68:71], v[244:247]
v_lshl_add_u32 v99, v97, 4, v96
M v[244:247], a[156:159], v[36:39], v[244:247]
v_add_u32 v100, 15360, v99
M v[248:251], a[156:159], v[40:43], v[248:251]
M v[248:251], a[160:163], v[72:75], v[248:251]
s_waitcnt vmcnt(0) lgkmcnt(0)
s_barrier
v_cmp_ne_u32 vcc, 1, v7
s_nop 0
s_cbranch_vccnz Lk3_spinb0
Lk3_gotb0:
M v[252:255], a[160:163], v[76:79], v[252:255]
s_add_u32 m0, s42, 65536
s_nop 0
buffer_load_dwordx4 v99, s[48:51], s26 offen offset:0 lds
buffer_load_dwordx4 v100, s[48:51], s26 offen offset:1024 lds
M v[252:255], a[156:159], v[44:47], v[252:255]
buffer_load_dwordx4 a[192:195], v1, s[44:47], s25 offen offset:0 sc1
buffer_load_dwordx4 a[196:199], v1, s[44:47], s25 offen offset:1024 sc1
M a[64:67], a[164:167], v[32:35], a[64:67]
buffer_load_dwordx4 a[200:203], v1, s[44:47], s25 offen offset:2048 sc1
buffer_load_dwordx4 a[204:207], v1, s[44:47], s25 offen offset:3072 sc1
M a[64:67], a[168:171], v[64:67], a[64:67]
s_add_u32 s25, s25, 16384
s_add_u32 s26, s26, 131072
s_add_u32 m0, s42, 81920
s_nop 0
buffer_load_dwordx4 v99, s[48:51], s26 offen offset:0 lds
M a[68:71], a[168:171], v[68:71], a[68:71]
buffer_load_dwordx4 v100, s[48:51], s26 offen offset:1024 lds
buffer_load_dwordx4 a[208:211], v1, s[44:47], s25 offen offset:0 sc1
M a[68:71], a[164:167], v[36:39], a[68:71]
buffer_load_dwordx4 a[212:215], v1, s[44:47], s25 offen offset:1024 sc1
buffer_load_dwordx4 a[216:219], v1, s[44:47], s25 offen offset:2048 sc1
M a[72:75], a[164:167], v[40:43], a[72:75]
buffer_load_dwordx4 a[220:223], v1, s[44:47], s25 offen offset:3072 sc1
s_add_u32 s25, s25, 16384
s_add_u32 s26, s26, 131072
M a[72:75], a[168:171], v[72:75], a[72:75]
s_add_u32 m0, s42, 98304
s_nop 0
buffer_load_dwordx4 v99, s[48:51], s26 offen offset:0 lds
buffer_load_dwordx4 v100, s[48:51], s26 offen offset:1024 lds
M a[76:79], a[168:171], v[76:79], a[76:79]
buffer_load_dwordx4 a[224:227], v1, s[44:47], s25 offen offset:0 sc1
M a[76:79], a[164:167], v[44:47], a[76:79]
buffer_load_dwordx4 a[228:231], v1, s[44:47], s25 offen offset:1024 sc1
buffer_load_dwordx4 a[232:235], v1, s[44:47], s25 offen offset:2048 sc1
M a[80:83], a[172:175], v[32:35], a[80:83]
buffer_load_dwordx4 a[236:239], v1, s[44:47], s25 offen offset:3072 sc1
s_add_u32 s25, s25, 16384
s_add_u32 s26, s26, 131072
M a[80:83], a[176:179], v[64:67], a[80:83]
s_add_u32 m0, s42, 114688
s_nop 0
buffer_load_dwordx4 v99, s[48:51], s26 offen offset:0 lds
buffer_load_dwordx4 v100, s[48:51], s26 offen offset:1024 lds
M a[84:87], a[176:179], v[68:71], a[84:87]
buffer_load_dwordx4 a[240:243], v1, s[44:47], s25 offen offset:0 sc1
buffer_load_dwordx4 a[244:247], v1, s[44:47], s25 offen offset:1024 sc1
M a[84:87], a[172:175], v[36:39], a[84:87]
buffer_load_dwordx4 a[248:251], v1, s[44:47], s25 offen offset:2048 sc1
buffer_load_dwordx4 a[252:255], v1, s[44:47], s25 offen offset:3072 sc1
M a[88:91], a[172:175], v[40:43], a[88:91]
s_add_u32 s25, s25, 16384
s_add_u32 s26, s26, 131072
s_add_u32 m0, s42, 0
s_nop 0
buffer_load_dwordx4 v99, s[48:51], s26 offen offset:0 lds
M a[88:91], a[176:179], v[72:75], a[88:91]
buffer_load_dwordx4 v100, s[48:51], s26 offen offset:1024 lds
buffer_load_dwordx4 a[128:131], v1, s[44:47], s25 offen offset:0 sc1
M a[92:95], a[176:179], v[76:79], a[92:95]
buffer_load_dwordx4 a[132:135], v1, s[44:47], s25 offen offset:1024 sc1
buffer_load_dwordx4 a[136:139], v1, s[44:47], s25 offen offset:2048 sc1
M a[92:95], a[172:175], v[44:47], a[92:95]
buffer_load_dwordx4 a[140:143], v1, s[44:47], s25 offen offset:3072 sc1
s_add_u32 s25, s25, 16384
s_add_u32 s26, s26, 131072
Lk2_merge:
s_lshl_b32 s33, s23, 14
s_add_u32 s34, s33, 131072
s_add_u32 s33, s33, 32768
s_cmp_eq_u32 s24, 0
s_cselect_b32 s35, s34, s33
s_cselect_b32 s36, s33, s34
v_add_u32 v2, s35, v1
v_add_u32 v3, s36, v1
s_lshl_b32 s33, s22, 10
s_add_u32 s33, s33, 28672
s_xor_b32 s34, s33, 2048
v_add_u32 v14, s33, v1
v_add_u32 v15, s34, v1
v_accvgpr_read_b32 v20, a96
v_accvgpr_read_b32 v21, a100
v_accvgpr_read_b32 v22, a104
v_accvgpr_read_b32 v23, a108
ds_write_b128 v14, v[20:23]
s_cmp_eq_u32 s24, 1
s_waitcnt lgkmcnt(0)
s_cbranch_scc1 Lk2_mg1
ds_write_b128 v2, v[224:227] offset:0
ds_write_b128 v2, v[228:231] offset:1024
ds_write_b128 v2, v[232:235] offset:2048
ds_write_b128 v2, v[236:239] offset:3072
ds_write_b128 v2, v[240:243] offset:4096
ds_write_b128 v2, v[244:247] offset:5120
ds_write_b128 v2, v[248:251] offset:6144
ds_write_b128 v2, v[252:255] offset:7168
ds_write_b128 v2, a[64:67] offset:8192
ds_write_b128 v2, a[68:71] offset:9216
ds_write_b128 v2, a[72:75] offset:10240
ds_write_b128 v2, a[76:79] offset:11264
ds_write_b128 v2, a[80:83] offset:12288
ds_write_b128 v2, a[84:87] offset:13312
ds_write_b128 v2, a[88:91] offset:14336
ds_write_b128 v2, a[92:95] offset:15360
s_waitcnt lgkmcnt(0)
s_barrier
ds_read_b128 v[28:31], v15
ds_read_b128 v[32:35], v3 offset:0
ds_read_b128 v[36:39], v3 offset:1024
ds_read_b128 v[40:43], v3 offset:2048
ds_read_b128 v[44:47], v3 offset:3072
ds_read_b128 v[48:51], v3 offset:4096
ds_read_b128 v[52:55], v3 offset:5120
ds_read_b128 v[56:59], v3 offset:6144
ds_read_b128 v[60:63], v3 offset:7168
ds_read_b128 v[64:67], v3 offset:8192
ds_read_b128 v[68:71], v3 offset:9216
ds_read_b128 v[72:75], v3 offset:10240
ds_read_b128 v[76:79], v3 offset:11264
ds_read_b128 v[80:83], v3 offset:12288
ds_read_b128 v[84:87], v3 offset:13312
ds_read_b128 v[88:91], v3 offset:14336
ds_read_b128 v[92:95], v3 offset:15360
s_waitcnt lgkmcnt(15)
v_add_f32 v20, v20, v28
v_add_f32 v21, v21, v29
v_add_f32 v22, v22, v30
v_add_f32 v23, v23, v31
s_sub_u32 s35, 15, s21
v_rcp_f32 v8, v20
v_rcp_f32 v9, v21
v_rcp_f32 v10, v22
v_rcp_f32 v11, v23
v_subrev_u32 v20, 0x21800000, v20
v_subrev_u32 v21, 0x21800000, v21
v_subrev_u32 v22, 0x21800000, v22
v_subrev_u32 v23, 0x21800000, v23
v_max_u32 v12, v20, v21
v_max3_u32 v12, v12, v22, v23
s_mov_b32 s64, 0x207
v_pk_add_f32 v[160:161], v[160:161], v[32:33]
v_pk_add_f32 v[162:163], v[162:163], v[34:35]
s_waitcnt lgkmcnt(11)
v_pk_add_f32 v[176:177], v[176:177], v[48:49]
v_pk_add_f32 v[178:179], v[178:179], v[50:51]
v_pk_mul_f32 v[160:161], v[160:161], v[8:9] op_sel:[0,0] op_sel_hi:[1,0]
v_pk_mul_f32 v[162:163], v[162:163], v[8:9] op_sel:[0,0] op_sel_hi:[1,0]
v_pk_mul_f32 v[176:177], v[176:177], v[8:9] op_sel:[0,0] op_sel_hi:[1,0]
v_pk_mul_f32 v[178:179], v[178:179], v[8:9] op_sel:[0,0] op_sel_hi:[1,0]
v_cvt_pk_bf16_f32 v160, v160, v161
v_cvt_pk_bf16_f32 v161, v162, v163
v_cvt_pk_bf16_f32 v162, v176, v177
v_cvt_pk_bf16_f32 v163, v178, v179
v_pk_add_f32 v[164:165], v[164:165], v[36:37]
v_pk_add_f32 v[166:167], v[166:167], v[38:39]
s_waitcnt lgkmcnt(10)
v_pk_add_f32 v[180:181], v[180:181], v[52:53]
v_pk_add_f32 v[182:183], v[182:183], v[54:55]
M v[24:27], a[112:115], v[160:163], 0
v_pk_mul_f32 v[164:165], v[164:165], v[8:9] op_sel:[0,1] op_sel_hi:[1,1]
v_pk_mul_f32 v[166:167], v[166:167], v[8:9] op_sel:[0,1] op_sel_hi:[1,1]
v_pk_mul_f32 v[180:181], v[180:181], v[8:9] op_sel:[0,1] op_sel_hi:[1,1]
v_pk_mul_f32 v[182:183], v[182:183], v[8:9] op_sel:[0,1] op_sel_hi:[1,1]
v_cvt_pk_bf16_f32 v164, v164, v165
v_cvt_pk_bf16_f32 v165, v166, v167
v_cvt_pk_bf16_f32 v166, v180, v181
v_cvt_pk_bf16_f32 v167, v182, v183
v_pk_add_f32 v[168:169], v[168:169], v[40:41]
v_pk_add_f32 v[170:171], v[170:171], v[42:43]
s_waitcnt lgkmcnt(9)
v_pk_add_f32 v[184:185], v[184:185], v[56:57]
v_pk_add_f32 v[186:187], v[186:187], v[58:59]
M v[24:27], a[112:115], v[164:167], v[24:27]
v_pk_mul_f32 v[168:169], v[168:169], v[10:11] op_sel:[0,0] op_sel_hi:[1,0]
v_pk_mul_f32 v[170:171], v[170:171], v[10:11] op_sel:[0,0] op_sel_hi:[1,0]
v_pk_mul_f32 v[184:185], v[184:185], v[10:11] op_sel:[0,0] op_sel_hi:[1,0]
v_pk_mul_f32 v[186:187], v[186:187], v[10:11] op_sel:[0,0] op_sel_hi:[1,0]
v_cvt_pk_bf16_f32 v168, v168, v169
v_cvt_pk_bf16_f32 v169, v170, v171
v_cvt_pk_bf16_f32 v170, v184, v185
v_cvt_pk_bf16_f32 v171, v186, v187
v_pk_add_f32 v[172:173], v[172:173], v[44:45]
v_pk_add_f32 v[174:175], v[174:175], v[46:47]
s_waitcnt lgkmcnt(8)
v_pk_add_f32 v[188:189], v[188:189], v[60:61]
v_pk_add_f32 v[190:191], v[190:191], v[62:63]
M v[24:27], a[112:115], v[168:171], v[24:27]
v_pk_mul_f32 v[172:173], v[172:173], v[10:11] op_sel:[0,1] op_sel_hi:[1,1]
v_pk_mul_f32 v[174:175], v[174:175], v[10:11] op_sel:[0,1] op_sel_hi:[1,1]
v_pk_mul_f32 v[188:189], v[188:189], v[10:11] op_sel:[0,1] op_sel_hi:[1,1]
v_pk_mul_f32 v[190:191], v[190:191], v[10:11] op_sel:[0,1] op_sel_hi:[1,1]
v_cvt_pk_bf16_f32 v172, v172, v173
v_cvt_pk_bf16_f32 v173, v174, v175
v_cvt_pk_bf16_f32 v174, v188, v189
v_cvt_pk_bf16_f32 v175, v190, v191
s_waitcnt lgkmcnt(7)
v_pk_add_f32 v[192:193], v[192:193], v[64:65]
v_pk_add_f32 v[194:195], v[194:195], v[66:67]
s_waitcnt lgkmcnt(3)
v_pk_add_f32 v[208:209], v[208:209], v[80:81]
v_pk_add_f32 v[210:211], v[210:211], v[82:83]
M v[24:27], a[112:115], v[172:175], v[24:27]
v_pk_mul_f32 v[192:193], v[192:193], v[8:9] op_sel:[0,0] op_sel_hi:[1,0]
v_pk_mul_f32 v[194:195], v[194:195], v[8:9] op_sel:[0,0] op_sel_hi:[1,0]
v_pk_mul_f32 v[208:209], v[208:209], v[8:9] op_sel:[0,0] op_sel_hi:[1,0]
v_pk_mul_f32 v[210:211], v[210:211], v[8:9] op_sel:[0,0] op_sel_hi:[1,0]
v_cvt_pk_bf16_f32 v192, v192, v193
v_cvt_pk_bf16_f32 v193, v194, v195
v_cvt_pk_bf16_f32 v194, v208, v209
v_cvt_pk_bf16_f32 v195, v210, v211
v_pk_add_f32 v[196:197], v[196:197], v[68:69]
v_pk_add_f32 v[198:199], v[198:199], v[70:71]
s_waitcnt lgkmcnt(2)
v_pk_add_f32 v[212:213], v[212:213], v[84:85]
v_pk_add_f32 v[214:215], v[214:215], v[86:87]
M v[24:27], a[112:115], v[192:195], v[24:27]
v_pk_mul_f32 v[196:197], v[196:197], v[8:9] op_sel:[0,1] op_sel_hi:[1,1]
v_pk_mul_f32 v[198:199], v[198:199], v[8:9] op_sel:[0,1] op_sel_hi:[1,1]
v_pk_mul_f32 v[212:213], v[212:213], v[8:9] op_sel:[0,1] op_sel_hi:[1,1]
v_pk_mul_f32 v[214:215], v[214:215], v[8:9] op_sel:[0,1] op_sel_hi:[1,1]
v_cvt_pk_bf16_f32 v196, v196, v197
v_cvt_pk_bf16_f32 v197, v198, v199
v_cvt_pk_bf16_f32 v198, v212, v213
v_cvt_pk_bf16_f32 v199, v214, v215
v_pk_add_f32 v[200:201], v[200:201], v[72:73]
v_pk_add_f32 v[202:203], v[202:203], v[74:75]
s_waitcnt lgkmcnt(1)
v_pk_add_f32 v[216:217], v[216:217], v[88:89]
v_pk_add_f32 v[218:219], v[218:219], v[90:91]
M v[24:27], a[112:115], v[196:199], v[24:27]
v_pk_mul_f32 v[200:201], v[200:201], v[10:11] op_sel:[0,0] op_sel_hi:[1,0]
v_pk_mul_f32 v[202:203], v[202:203], v[10:11] op_sel:[0,0] op_sel_hi:[1,0]
v_pk_mul_f32 v[216:217], v[216:217], v[10:11] op_sel:[0,0] op_sel_hi:[1,0]
v_pk_mul_f32 v[218:219], v[218:219], v[10:11] op_sel:[0,0] op_sel_hi:[1,0]
v_cvt_pk_bf16_f32 v200, v200, v201
v_cvt_pk_bf16_f32 v201, v202, v203
v_cvt_pk_bf16_f32 v202, v216, v217
v_cvt_pk_bf16_f32 v203, v218, v219
v_pk_add_f32 v[204:205], v[204:205], v[76:77]
v_pk_add_f32 v[206:207], v[206:207], v[78:79]
s_waitcnt lgkmcnt(0)
v_pk_add_f32 v[220:221], v[220:221], v[92:93]
v_pk_add_f32 v[222:223], v[222:223], v[94:95]
M v[24:27], a[112:115], v[200:203], v[24:27]
v_pk_mul_f32 v[204:205], v[204:205], v[10:11] op_sel:[0,1] op_sel_hi:[1,1]
v_pk_mul_f32 v[206:207], v[206:207], v[10:11] op_sel:[0,1] op_sel_hi:[1,1]
v_pk_mul_f32 v[220:221], v[220:221], v[10:11] op_sel:[0,1] op_sel_hi:[1,1]
v_pk_mul_f32 v[222:223], v[222:223], v[10:11] op_sel:[0,1] op_sel_hi:[1,1]
v_cvt_pk_bf16_f32 v204, v204, v205
v_cvt_pk_bf16_f32 v205, v206, v207
v_cvt_pk_bf16_f32 v206, v220, v221
v_cvt_pk_bf16_f32 v207, v222, v223
s_nop 1
M v[24:27], a[112:115], v[204:207], v[24:27]
v_cmp_lt_u32 vcc, 0x3c000000, v12
s_nop 6
v_cmp_class_f32 s[40:41], v24, s64
s_nop 0
s_or_b64 vcc, vcc, s[40:41]
s_cbranch_vccnz Lbad_4
s_lshl_b32 s33, s35, 20
s_lshl_b32 s34, s20, 15
s_add_u32 s33, s33, s34
s_lshl_b32 s34, s23, 13
s_add_u32 s36, s33, s34
s_add_u32 s37, s36, 4096
s_add_u32 s38, s36, 16384
s_add_u32 s39, s36, 20480
buffer_store_dwordx4 v[160:163], v1, s[16:19], s36 offen offset:0 sc1
buffer_store_dwordx4 v[164:167], v1, s[16:19], s36 offen offset:2048 sc1
buffer_store_dwordx4 v[168:171], v1, s[16:19], s37 offen offset:0 sc1
buffer_store_dwordx4 v[172:175], v1, s[16:19], s37 offen offset:2048 sc1
buffer_store_dwordx4 v[192:195], v1, s[16:19], s36 offen offset:1024 sc1
buffer_store_dwordx4 v[196:199], v1, s[16:19], s36 offen offset:3072 sc1
buffer_store_dwordx4 v[200:203], v1, s[16:19], s37 offen offset:1024 sc1
buffer_store_dwordx4 v[204:207], v1, s[16:19], s37 offen offset:3072 sc1
s_branch Lfd_5
Lbad_4:
s_or_b32 s60, s60, 2
Lfd_5:
s_branch Lk2_chk
Lk2_mg1:
ds_write_b128 v2, v[160:163] offset:0
ds_write_b128 v2, v[164:167] offset:1024
ds_write_b128 v2, v[168:171] offset:2048
ds_write_b128 v2, v[172:175] offset:3072
ds_write_b128 v2, v[176:179] offset:4096
ds_write_b128 v2, v[180:183] offset:5120
ds_write_b128 v2, v[184:187] offset:6144
ds_write_b128 v2, v[188:191] offset:7168
ds_write_b128 v2, v[192:195] offset:8192
ds_write_b128 v2, v[196:199] offset:9216
ds_write_b128 v2, v[200:203] offset:10240
ds_write_b128 v2, v[204:207] offset:11264
ds_write_b128 v2, v[208:211] offset:12288
ds_write_b128 v2, v[212:215] offset:13312
ds_write_b128 v2, v[216:219] offset:14336
ds_write_b128 v2, v[220:223] offset:15360
s_waitcnt lgkmcnt(0)
s_barrier
ds_read_b128 v[28:31], v15
ds_read_b128 v[32:35], v3 offset:0
ds_read_b128 v[36:39], v3 offset:1024
ds_read_b128 v[40:43], v3 offset:2048
ds_read_b128 v[44:47], v3 offset:3072
ds_read_b128 v[48:51], v3 offset:4096
ds_read_b128 v[52:55], v3 offset:5120
ds_read_b128 v[56:59], v3 offset:6144
ds_read_b128 v[60:63], v3 offset:7168
ds_read_b128 v[64:67], v3 offset:8192
ds_read_b128 v[68:71], v3 offset:9216
ds_read_b128 v[72:75], v3 offset:10240
ds_read_b128 v[76:79], v3 offset:11264
ds_read_b128 v[80:83], v3 offset:12288
ds_read_b128 v[84:87], v3 offset:13312
ds_read_b128 v[88:91], v3 offset:14336
ds_read_b128 v[92:95], v3 offset:15360
s_waitcnt lgkmcnt(15)
v_add_f32 v20, v20, v28
v_add_f32 v21, v21, v29
v_add_f32 v22, v22, v30
v_add_f32 v23, v23, v31
s_sub_u32 s35, 15, s21
v_rcp_f32 v8, v20
v_rcp_f32 v9, v21
v_rcp_f32 v10, v22
v_rcp_f32 v11, v23
v_subrev_u32 v20, 0x21800000, v20
v_subrev_u32 v21, 0x21800000, v21
v_subrev_u32 v22, 0x21800000, v22
v_subrev_u32 v23, 0x21800000, v23
v_max_u32 v12, v20, v21
v_max3_u32 v12, v12, v22, v23
s_mov_b32 s64, 0x207
v_pk_add_f32 v[224:225], v[224:225], v[32:33]
v_pk_add_f32 v[226:227], v[226:227], v[34:35]
s_waitcnt lgkmcnt(11)
v_pk_add_f32 v[240:241], v[240:241], v[48:49]
v_pk_add_f32 v[242:243], v[242:243], v[50:51]
v_pk_mul_f32 v[224:225], v[224:225], v[8:9] op_sel:[0,0] op_sel_hi:[1,0]
v_pk_mul_f32 v[226:227], v[226:227], v[8:9] op_sel:[0,0] op_sel_hi:[1,0]
v_pk_mul_f32 v[240:241], v[240:241], v[8:9] op_sel:[0,0] op_sel_hi:[1,0]
v_pk_mul_f32 v[242:243], v[242:243], v[8:9] op_sel:[0,0] op_sel_hi:[1,0]
v_cvt_pk_bf16_f32 v224, v224, v225
v_cvt_pk_bf16_f32 v225, v226, v227
v_cvt_pk_bf16_f32 v226, v240, v241
v_cvt_pk_bf16_f32 v227, v242, v243
v_pk_add_f32 v[228:229], v[228:229], v[36:37]
v_pk_add_f32 v[230:231], v[230:231], v[38:39]
s_waitcnt lgkmcnt(10)
v_pk_add_f32 v[244:245], v[244:245], v[52:53]
v_pk_add_f32 v[246:247], v[246:247], v[54:55]
M v[24:27], a[112:115], v[224:227], 0
v_pk_mul_f32 v[228:229], v[228:229], v[8:9] op_sel:[0,1] op_sel_hi:[1,1]
v_pk_mul_f32 v[230:231], v[230:231], v[8:9] op_sel:[0,1] op_sel_hi:[1,1]
v_pk_mul_f32 v[244:245], v[244:245], v[8:9] op_sel:[0,1] op_sel_hi:[1,1]
v_pk_mul_f32 v[246:247], v[246:247], v[8:9] op_sel:[0,1] op_sel_hi:[1,1]
v_cvt_pk_bf16_f32 v228, v228, v229
v_cvt_pk_bf16_f32 v229, v230, v231
v_cvt_pk_bf16_f32 v230, v244, v245
v_cvt_pk_bf16_f32 v231, v246, v247
v_pk_add_f32 v[232:233], v[232:233], v[40:41]
v_pk_add_f32 v[234:235], v[234:235], v[42:43]
s_waitcnt lgkmcnt(9)
v_pk_add_f32 v[248:249], v[248:249], v[56:57]
v_pk_add_f32 v[250:251], v[250:251], v[58:59]
M v[24:27], a[112:115], v[228:231], v[24:27]
v_pk_mul_f32 v[232:233], v[232:233], v[10:11] op_sel:[0,0] op_sel_hi:[1,0]
v_pk_mul_f32 v[234:235], v[234:235], v[10:11] op_sel:[0,0] op_sel_hi:[1,0]
v_pk_mul_f32 v[248:249], v[248:249], v[10:11] op_sel:[0,0] op_sel_hi:[1,0]
v_pk_mul_f32 v[250:251], v[250:251], v[10:11] op_sel:[0,0] op_sel_hi:[1,0]
v_cvt_pk_bf16_f32 v232, v232, v233
v_cvt_pk_bf16_f32 v233, v234, v235
v_cvt_pk_bf16_f32 v234, v248, v249
v_cvt_pk_bf16_f32 v235, v250, v251
v_pk_add_f32 v[236:237], v[236:237], v[44:45]
v_pk_add_f32 v[238:239], v[238:239], v[46:47]
s_waitcnt lgkmcnt(8)
v_pk_add_f32 v[252:253], v[252:253], v[60:61]
v_pk_add_f32 v[254:255], v[254:255], v[62:63]
M v[24:27], a[112:115], v[232:235], v[24:27]
v_pk_mul_f32 v[236:237], v[236:237], v[10:11] op_sel:[0,1] op_sel_hi:[1,1]
v_pk_mul_f32 v[238:239], v[238:239], v[10:11] op_sel:[0,1] op_sel_hi:[1,1]
v_pk_mul_f32 v[252:253], v[252:253], v[10:11] op_sel:[0,1] op_sel_hi:[1,1]
v_pk_mul_f32 v[254:255], v[254:255], v[10:11] op_sel:[0,1] op_sel_hi:[1,1]
v_cvt_pk_bf16_f32 v236, v236, v237
v_cvt_pk_bf16_f32 v237, v238, v239
v_cvt_pk_bf16_f32 v238, v252, v253
v_cvt_pk_bf16_f32 v239, v254, v255
v_accvgpr_read_b32 v32, a64
v_accvgpr_read_b32 v33, a65
v_accvgpr_read_b32 v34, a66
v_accvgpr_read_b32 v35, a67
s_waitcnt lgkmcnt(7)
v_pk_add_f32 v[32:33], v[32:33], v[64:65]
v_pk_add_f32 v[34:35], v[34:35], v[66:67]
v_accvgpr_read_b32 v48, a80
v_accvgpr_read_b32 v49, a81
v_accvgpr_read_b32 v50, a82
v_accvgpr_read_b32 v51, a83
s_waitcnt lgkmcnt(3)
v_pk_add_f32 v[48:49], v[48:49], v[80:81]
v_pk_add_f32 v[50:51], v[50:51], v[82:83]
M v[24:27], a[112:115], v[236:239], v[24:27]
v_pk_mul_f32 v[32:33], v[32:33], v[8:9] op_sel:[0,0] op_sel_hi:[1,0]
v_pk_mul_f32 v[34:35], v[34:35], v[8:9] op_sel:[0,0] op_sel_hi:[1,0]
v_pk_mul_f32 v[48:49], v[48:49], v[8:9] op_sel:[0,0] op_sel_hi:[1,0]
v_pk_mul_f32 v[50:51], v[50:51], v[8:9] op_sel:[0,0] op_sel_hi:[1,0]
v_cvt_pk_bf16_f32 v32, v32, v33
v_cvt_pk_bf16_f32 v33, v34, v35
v_cvt_pk_bf16_f32 v34, v48, v49
v_cvt_pk_bf16_f32 v35, v50, v51
v_accvgpr_read_b32 v240, a68
v_accvgpr_read_b32 v241, a69
v_accvgpr_read_b32 v242, a70
v_accvgpr_read_b32 v243, a71
v_pk_add_f32 v[240:241], v[240:241], v[68:69]
v_pk_add_f32 v[242:243], v[242:243], v[70:71]
v_accvgpr_read_b32 v36, a84
v_accvgpr_read_b32 v37, a85
v_accvgpr_read_b32 v38, a86
v_accvgpr_read_b32 v39, a87
s_waitcnt lgkmcnt(2)
v_pk_add_f32 v[36:37], v[36:37], v[84:85]
v_pk_add_f32 v[38:39], v[38:39], v[86:87]
M v[24:27], a[112:115], v[32:35], v[24:27]
v_pk_mul_f32 v[240:241], v[240:241], v[8:9] op_sel:[0,1] op_sel_hi:[1,1]
v_pk_mul_f32 v[242:243], v[242:243], v[8:9] op_sel:[0,1] op_sel_hi:[1,1]
v_pk_mul_f32 v[36:37], v[36:37], v[8:9] op_sel:[0,1] op_sel_hi:[1,1]
v_pk_mul_f32 v[38:39], v[38:39], v[8:9] op_sel:[0,1] op_sel_hi:[1,1]
v_cvt_pk_bf16_f32 v240, v240, v241
v_cvt_pk_bf16_f32 v241, v242, v243
v_cvt_pk_bf16_f32 v242, v36, v37
v_cvt_pk_bf16_f32 v243, v38, v39
v_accvgpr_read_b32 v52, a72
v_accvgpr_read_b32 v53, a73
v_accvgpr_read_b32 v54, a74
v_accvgpr_read_b32 v55, a75
v_pk_add_f32 v[52:53], v[52:53], v[72:73]
v_pk_add_f32 v[54:55], v[54:55], v[74:75]
v_accvgpr_read_b32 v244, a88
v_accvgpr_read_b32 v245, a89
v_accvgpr_read_b32 v246, a90
v_accvgpr_read_b32 v247, a91
s_waitcnt lgkmcnt(1)
v_pk_add_f32 v[244:245], v[244:245], v[88:89]
v_pk_add_f32 v[246:247], v[246:247], v[90:91]
M v[24:27], a[112:115], v[240:243], v[24:27]
v_pk_mul_f32 v[52:53], v[52:53], v[10:11] op_sel:[0,0] op_sel_hi:[1,0]
v_pk_mul_f32 v[54:55], v[54:55], v[10:11] op_sel:[0,0] op_sel_hi:[1,0]
v_pk_mul_f32 v[244:245], v[244:245], v[10:11] op_sel:[0,0] op_sel_hi:[1,0]
v_pk_mul_f32 v[246:247], v[246:247], v[10:11] op_sel:[0,0] op_sel_hi:[1,0]
v_cvt_pk_bf16_f32 v52, v52, v53
v_cvt_pk_bf16_f32 v53, v54, v55
v_cvt_pk_bf16_f32 v54, v244, v245
v_cvt_pk_bf16_f32 v55, v246, v247
v_accvgpr_read_b32 v40, a76
v_accvgpr_read_b32 v41, a77
v_accvgpr_read_b32 v42, a78
v_accvgpr_read_b32 v43, a79
v_pk_add_f32 v[40:41], v[40:41], v[76:77]
v_pk_add_f32 v[42:43], v[42:43], v[78:79]
v_accvgpr_read_b32 v56, a92
v_accvgpr_read_b32 v57, a93
v_accvgpr_read_b32 v58, a94
v_accvgpr_read_b32 v59, a95
s_waitcnt lgkmcnt(0)
v_pk_add_f32 v[56:57], v[56:57], v[92:93]
v_pk_add_f32 v[58:59], v[58:59], v[94:95]
M v[24:27], a[112:115], v[52:55], v[24:27]
v_pk_mul_f32 v[40:41], v[40:41], v[10:11] op_sel:[0,1] op_sel_hi:[1,1]
v_pk_mul_f32 v[42:43], v[42:43], v[10:11] op_sel:[0,1] op_sel_hi:[1,1]
v_pk_mul_f32 v[56:57], v[56:57], v[10:11] op_sel:[0,1] op_sel_hi:[1,1]
v_pk_mul_f32 v[58:59], v[58:59], v[10:11] op_sel:[0,1] op_sel_hi:[1,1]
v_cvt_pk_bf16_f32 v40, v40, v41
v_cvt_pk_bf16_f32 v41, v42, v43
v_cvt_pk_bf16_f32 v42, v56, v57
v_cvt_pk_bf16_f32 v43, v58, v59
s_nop 1
M v[24:27], a[112:115], v[40:43], v[24:27]
v_cmp_lt_u32 vcc, 0x3c000000, v12
s_nop 6
v_cmp_class_f32 s[40:41], v24, s64
s_nop 0
s_or_b64 vcc, vcc, s[40:41]
s_cbranch_vccnz Lbad_6
s_lshl_b32 s33, s35, 20
s_lshl_b32 s34, s20, 15
s_add_u32 s33, s33, s34
s_lshl_b32 s34, s23, 13
s_add_u32 s36, s33, s34
s_add_u32 s37, s36, 4096
s_add_u32 s38, s36, 16384
s_add_u32 s39, s36, 20480
buffer_store_dwordx4 v[224:227], v1, s[16:19], s38 offen offset:0 sc1
buffer_store_dwordx4 v[228:231], v1, s[16:19], s38 offen offset:2048 sc1
buffer_store_dwordx4 v[232:235], v1, s[16:19], s39 offen offset:0 sc1
buffer_store_dwordx4 v[236:239], v1, s[16:19], s39 offen offset:2048 sc1
buffer_store_dwordx4 v[32:35], v1, s[16:19], s38 offen offset:1024 sc1
buffer_store_dwordx4 v[240:243], v1, s[16:19], s38 offen offset:3072 sc1
buffer_store_dwordx4 v[52:55], v1, s[16:19], s39 offen offset:1024 sc1
buffer_store_dwordx4 v[40:43], v1, s[16:19], s39 offen offset:3072 sc1
s_branch Lfd_7
Lbad_6:
s_or_b32 s60, s60, 2
Lfd_7:
Lk2_chk:
s_cmp_eq_u32 s60, 0
s_cbranch_scc1 Lk2_done
s_sub_u32 s56, 15, s21
s_lshl_b32 s33, s24, 1
s_lshl_b32 s61, 3, s33
s_and_b32 s34, s60, 2
s_bitcmp1_b32 s60, 0
s_cselect_b32 s56, s21, s56
s_cselect_b32 s61, 15, s61
s_cselect_b32 s60, s34, 0
s_waitcnt vmcnt(0)
s_lshl_b32 s33, s20, 7
s_lshl_b32 s34, s56, 3
s_add_u32 s33, s33, s34
s_lshl_b32 s34, s23, 2
s_add_u32 s33, s33, s34
s_lshl_b32 s33, s33, 12
buffer_load_dwordx4 a[0:3], v1, s[8:11], s33 offen offset:0 sc1
buffer_load_dwordx4 a[4:7], v1, s[8:11], s33 offen offset:1024 sc1
buffer_load_dwordx4 a[8:11], v1, s[8:11], s33 offen offset:2048 sc1
buffer_load_dwordx4 a[12:15], v1, s[8:11], s33 offen offset:3072 sc1
s_add_u32 s33, s33, 4096
buffer_load_dwordx4 a[16:19], v1, s[8:11], s33 offen offset:0 sc1
buffer_load_dwordx4 a[20:23], v1, s[8:11], s33 offen offset:1024 sc1
buffer_load_dwordx4 a[24:27], v1, s[8:11], s33 offen offset:2048 sc1
buffer_load_dwordx4 a[28:31], v1, s[8:11], s33 offen offset:3072 sc1
s_add_u32 s33, s33, 4096
buffer_load_dwordx4 a[32:35], v1, s[8:11], s33 offen offset:0 sc1
buffer_load_dwordx4 a[36:39], v1, s[8:11], s33 offen offset:1024 sc1
buffer_load_dwordx4 a[40:43], v1, s[8:11], s33 offen offset:2048 sc1
buffer_load_dwordx4 a[44:47], v1, s[8:11], s33 offen offset:3072 sc1
s_add_u32 s33, s33, 4096
buffer_load_dwordx4 a[48:51], v1, s[8:11], s33 offen offset:0 sc1
buffer_load_dwordx4 a[52:55], v1, s[8:11], s33 offen offset:1024 sc1
buffer_load_dwordx4 a[56:59], v1, s[8:11], s33 offen offset:2048 sc1
buffer_load_dwordx4 a[60:63], v1, s[8:11], s33 offen offset:3072 sc1
v_accvgpr_write_b32 a64, 0
v_accvgpr_write_b32 a65, 0
v_accvgpr_write_b32 a66, 0
v_accvgpr_write_b32 a67, 0
v_accvgpr_write_b32 a68, 0
v_accvgpr_write_b32 a69, 0
v_accvgpr_write_b32 a70, 0
v_accvgpr_write_b32 a71, 0
v_accvgpr_write_b32 a72, 0
v_accvgpr_write_b32 a73, 0
v_accvgpr_write_b32 a74, 0
v_accvgpr_write_b32 a75, 0
v_accvgpr_write_b32 a76, 0
v_accvgpr_write_b32 a77, 0
v_accvgpr_write_b32 a78, 0
v_accvgpr_write_b32 a79, 0
v_accvgpr_write_b32 a80, 0
v_accvgpr_write_b32 a81, 0
v_accvgpr_write_b32 a82, 0
v_accvgpr_write_b32 a83, 0
v_accvgpr_write_b32 a84, 0
v_accvgpr_write_b32 a85, 0
v_accvgpr_write_b32 a86, 0
v_accvgpr_write_b32 a87, 0
v_accvgpr_write_b32 a88, 0
v_accvgpr_write_b32 a89, 0
v_accvgpr_write_b32 a90, 0
v_accvgpr_write_b32 a91, 0
v_accvgpr_write_b32 a92, 0
v_accvgpr_write_b32 a93, 0
v_accvgpr_write_b32 a94, 0
v_accvgpr_write_b32 a95, 0
v_accvgpr_write_b32 a96, 0
v_accvgpr_write_b32 a97, 0
v_accvgpr_write_b32 a98, 0
v_accvgpr_write_b32 a99, 0
v_accvgpr_write_b32 a100, 0
v_accvgpr_write_b32 a101, 0
v_accvgpr_write_b32 a102, 0
v_accvgpr_write_b32 a103, 0
v_accvgpr_write_b32 a104, 0
v_accvgpr_write_b32 a105, 0
v_accvgpr_write_b32 a106, 0
v_accvgpr_write_b32 a107, 0
v_accvgpr_write_b32 a108, 0
v_accvgpr_write_b32 a109, 0
v_accvgpr_write_b32 a110, 0
v_accvgpr_write_b32 a111, 0
v_mov_b32 v160, 0
v_mov_b32 v161, 0
v_mov_b32 v162, 0
v_mov_b32 v163, 0
v_mov_b32 v164, 0
v_mov_b32 v165, 0
v_mov_b32 v166, 0
v_mov_b32 v167, 0
v_mov_b32 v168, 0
v_mov_b32 v169, 0
v_mov_b32 v170, 0
v_mov_b32 v171, 0
v_mov_b32 v172, 0
v_mov_b32 v173, 0
v_mov_b32 v174, 0
v_mov_b32 v175, 0
v_mov_b32 v176, 0
v_mov_b32 v177, 0
v_mov_b32 v178, 0
v_mov_b32 v179, 0
v_mov_b32 v180, 0
v_mov_b32 v181, 0
v_mov_b32 v182, 0
v_mov_b32 v183, 0
v_mov_b32 v184, 0
v_mov_b32 v185, 0
v_mov_b32 v186, 0
v_mov_b32 v187, 0
v_mov_b32 v188, 0
v_mov_b32 v189, 0
v_mov_b32 v190, 0
v_mov_b32 v191, 0
v_mov_b32 v192, 0
v_mov_b32 v193, 0
v_mov_b32 v194, 0
v_mov_b32 v195, 0
v_mov_b32 v196, 0
v_mov_b32 v197, 0
v_mov_b32 v198, 0
v_mov_b32 v199, 0
v_mov_b32 v200, 0
v_mov_b32 v201, 0
v_mov_b32 v202, 0
v_mov_b32 v203, 0
v_mov_b32 v204, 0
v_mov_b32 v205, 0
v_mov_b32 v206, 0
v_mov_b32 v207, 0
v_mov_b32 v208, 0
v_mov_b32 v209, 0
v_mov_b32 v210, 0
v_mov_b32 v211, 0
v_mov_b32 v212, 0
v_mov_b32 v213, 0
v_mov_b32 v214, 0
v_mov_b32 v215, 0
v_mov_b32 v216, 0
v_mov_b32 v217, 0
v_mov_b32 v218, 0
v_mov_b32 v219, 0
v_mov_b32 v220, 0
v_mov_b32 v221, 0
v_mov_b32 v222, 0
v_mov_b32 v223, 0
v_mov_b32 v224, 0
v_mov_b32 v225, 0
v_mov_b32 v226, 0
v_mov_b32 v227, 0
v_mov_b32 v228, 0
v_mov_b32 v229, 0
v_mov_b32 v230, 0
v_mov_b32 v231, 0
v_mov_b32 v232, 0
v_mov_b32 v233, 0
v_mov_b32 v234, 0
v_mov_b32 v235, 0
v_mov_b32 v236, 0
v_mov_b32 v237, 0
v_mov_b32 v238, 0
v_mov_b32 v239, 0
v_mov_b32 v240, 0
v_mov_b32 v241, 0
v_mov_b32 v242, 0
v_mov_b32 v243, 0
v_mov_b32 v244, 0
v_mov_b32 v245, 0
v_mov_b32 v246, 0
v_mov_b32 v247, 0
v_mov_b32 v248, 0
v_mov_b32 v249, 0
v_mov_b32 v250, 0
v_mov_b32 v251, 0
v_mov_b32 v252, 0
v_mov_b32 v253, 0
v_mov_b32 v254, 0
v_mov_b32 v255, 0
v_mov_b32 v8, v4
v_mov_b32 v9, v4
v_mov_b32 v10, v4
v_mov_b32 v11, v4
s_lshl_b32 s57, s20, 20
s_lshl_b32 s58, s56, 7
s_lshl_b32 s59, s56, 1
s_add_u32 s59, s59, 2
Lslow_8:
s_add_u32 s35, s57, 0
buffer_load_dwordx4 v[96:99], v1, s[12:15], s35 offen offset:0 sc1
buffer_load_dwordx4 v[100:103], v1, s[12:15], s35 offen offset:1024 sc1
buffer_load_dwordx4 v[104:107], v1, s[12:15], s35 offen offset:2048 sc1
buffer_load_dwordx4 v[108:111], v1, s[12:15], s35 offen offset:3072 sc1
s_add_u32 s35, s57, 4096
buffer_load_dwordx4 v[112:115], v1, s[12:15], s35 offen offset:0 sc1
buffer_load_dwordx4 v[116:119], v1, s[12:15], s35 offen offset:1024 sc1
buffer_load_dwordx4 v[120:123], v1, s[12:15], s35 offen offset:2048 sc1
buffer_load_dwordx4 v[124:127], v1, s[12:15], s35 offen offset:3072 sc1
s_add_u32 s35, s57, 8192
buffer_load_dwordx4 v[128:131], v1, s[12:15], s35 offen offset:0 sc1
buffer_load_dwordx4 v[132:135], v1, s[12:15], s35 offen offset:1024 sc1
buffer_load_dwordx4 v[136:139], v1, s[12:15], s35 offen offset:2048 sc1
buffer_load_dwordx4 v[140:143], v1, s[12:15], s35 offen offset:3072 sc1
s_add_u32 s35, s57, 12288
buffer_load_dwordx4 v[144:147], v1, s[12:15], s35 offen offset:0 sc1
buffer_load_dwordx4 v[148:151], v1, s[12:15], s35 offen offset:1024 sc1
buffer_load_dwordx4 v[152:155], v1, s[12:15], s35 offen offset:2048 sc1
buffer_load_dwordx4 v[156:159], v1, s[12:15], s35 offen offset:3072 sc1
s_lshl_b32 s33, s23, 6
s_add_i32 s33, s33, s58
s_cmp_gt_i32 s33, 0
s_cselect_b32 s34, 0, 0xf149f2ca
s_cmp_lt_i32 s33, 0
s_cselect_b32 s33, 0xf149f2ca, 0
v_mov_b32 v20, s34
v_mov_b32 v21, s34
v_mov_b32 v22, s34
v_mov_b32 v23, s34
v_mov_b32 v28, s33
v_mov_b32 v29, s33
v_mov_b32 v30, s33
v_mov_b32 v31, s33
v_med3_f32 v24, v16, v20, v28
v_med3_f32 v25, v17, v20, v28
v_med3_f32 v26, v18, v20, v28
v_med3_f32 v27, v19, v20, v28
s_waitcnt vmcnt(0)
s_nop 0
M v[32:35], v[96:99], a[0:3], v[24:27]
M v[32:35], v[100:103], a[4:7], v[32:35]
M v[32:35], v[104:107], a[8:11], v[32:35]
M v[32:35], v[108:111], a[12:15], v[32:35]
M v[36:39], v[96:99], a[16:19], v[28:31]
M v[36:39], v[100:103], a[20:23], v[36:39]
M v[36:39], v[104:107], a[24:27], v[36:39]
M v[36:39], v[108:111], a[28:31], v[36:39]
M v[40:43], v[96:99], a[32:35], v[28:31]
M v[40:43], v[100:103], a[36:39], v[40:43]
M v[40:43], v[104:107], a[40:43], v[40:43]
M v[40:43], v[108:111], a[44:47], v[40:43]
M v[44:47], v[96:99], a[48:51], v[28:31]
M v[44:47], v[100:103], a[52:55], v[44:47]
M v[44:47], v[104:107], a[56:59], v[44:47]
M v[44:47], v[108:111], a[60:63], v[44:47]
M v[48:51], v[112:115], a[0:3], v[20:23]
M v[48:51], v[116:119], a[4:7], v[48:51]
M v[48:51], v[120:123], a[8:11], v[48:51]
M v[48:51], v[124:127], a[12:15], v[48:51]
M v[52:55], v[112:115], a[16:19], v[24:27]
M v[52:55], v[116:119], a[20:23], v[52:55]
M v[52:55], v[120:123], a[24:27], v[52:55]
M v[52:55], v[124:127], a[28:31], v[52:55]
M v[56:59], v[112:115], a[32:35], v[28:31]
M v[56:59], v[116:119], a[36:39], v[56:59]
M v[56:59], v[120:123], a[40:43], v[56:59]
M v[56:59], v[124:127], a[44:47], v[56:59]
M v[60:63], v[112:115], a[48:51], v[28:31]
M v[60:63], v[116:119], a[52:55], v[60:63]
M v[60:63], v[120:123], a[56:59], v[60:63]
M v[60:63], v[124:127], a[60:63], v[60:63]
M v[64:67], v[128:131], a[0:3], v[20:23]
M v[64:67], v[132:135], a[4:7], v[64:67]
M v[64:67], v[136:139], a[8:11], v[64:67]
M v[64:67], v[140:143], a[12:15], v[64:67]
M v[68:71], v[128:131], a[16:19], v[20:23]
M v[68:71], v[132:135], a[20:23], v[68:71]
M v[68:71], v[136:139], a[24:27], v[68:71]
M v[68:71], v[140:143], a[28:31], v[68:71]
M v[72:75], v[128:131], a[32:35], v[24:27]
M v[72:75], v[132:135], a[36:39], v[72:75]
M v[72:75], v[136:139], a[40:43], v[72:75]
M v[72:75], v[140:143], a[44:47], v[72:75]
M v[76:79], v[128:131], a[48:51], v[28:31]
M v[76:79], v[132:135], a[52:55], v[76:79]
M v[76:79], v[136:139], a[56:59], v[76:79]
M v[76:79], v[140:143], a[60:63], v[76:79]
M v[80:83], v[144:147], a[0:3], v[20:23]
M v[80:83], v[148:151], a[4:7], v[80:83]
M v[80:83], v[152:155], a[8:11], v[80:83]
M v[80:83], v[156:159], a[12:15], v[80:83]
M v[84:87], v[144:147], a[16:19], v[20:23]
M v[84:87], v[148:151], a[20:23], v[84:87]
M v[84:87], v[152:155], a[24:27], v[84:87]
M v[84:87], v[156:159], a[28:31], v[84:87]
M v[88:91], v[144:147], a[32:35], v[20:23]
M v[88:91], v[148:151], a[36:39], v[88:91]
M v[88:91], v[152:155], a[40:43], v[88:91]
M v[88:91], v[156:159], a[44:47], v[88:91]
M v[92:95], v[144:147], a[48:51], v[24:27]
M v[92:95], v[148:151], a[52:55], v[92:95]
M v[92:95], v[152:155], a[56:59], v[92:95]
M v[92:95], v[156:159], a[60:63], v[92:95]
s_nop 7
s_add_u32 s35, s57, 16384
buffer_load_dwordx4 v[96:99], v1, s[12:15], s35 offen offset:0 sc1
buffer_load_dwordx4 v[100:103], v1, s[12:15], s35 offen offset:1024 sc1
buffer_load_dwordx4 v[104:107], v1, s[12:15], s35 offen offset:2048 sc1
buffer_load_dwordx4 v[108:111], v1, s[12:15], s35 offen offset:3072 sc1
s_add_u32 s35, s57, 20480
buffer_load_dwordx4 v[112:115], v1, s[12:15], s35 offen offset:0 sc1
buffer_load_dwordx4 v[116:119], v1, s[12:15], s35 offen offset:1024 sc1
buffer_load_dwordx4 v[120:123], v1, s[12:15], s35 offen offset:2048 sc1
buffer_load_dwordx4 v[124:127], v1, s[12:15], s35 offen offset:3072 sc1
s_add_u32 s35, s57, 24576
buffer_load_dwordx4 v[128:131], v1, s[12:15], s35 offen offset:0 sc1
buffer_load_dwordx4 v[132:135], v1, s[12:15], s35 offen offset:1024 sc1
buffer_load_dwordx4 v[136:139], v1, s[12:15], s35 offen offset:2048 sc1
buffer_load_dwordx4 v[140:143], v1, s[12:15], s35 offen offset:3072 sc1
s_add_u32 s35, s57, 28672
buffer_load_dwordx4 v[144:147], v1, s[12:15], s35 offen offset:0 sc1
buffer_load_dwordx4 v[148:151], v1, s[12:15], s35 offen offset:1024 sc1
buffer_load_dwordx4 v[152:155], v1, s[12:15], s35 offen offset:2048 sc1
buffer_load_dwordx4 v[156:159], v1, s[12:15], s35 offen offset:3072 sc1
v_max3_f32 v13, v32, v33, v8
v_max3_f32 v13, v13, v34, v35
v_max3_f32 v13, v13, v48, v49
v_max3_f32 v13, v13, v50, v51
v_max3_f32 v13, v13, v64, v65
v_max3_f32 v13, v13, v66, v67
v_max3_f32 v13, v13, v80, v81
v_max3_f32 v13, v13, v82, v83
v_mov_b32 v14, v13
s_nop 1
v_permlane16_swap_b32 v13, v14
v_max_f32 v13, v13, v14
v_mov_b32 v14, v13
s_nop 1
v_permlane32_swap_b32 v13, v14
v_max_f32 v13, v13, v14
v_sub_f32 v12, v8, v13
v_exp_f32 v12, v12
v_mov_b32 v8, v13
v_sub_f32 v32, v32, v13
v_sub_f32 v33, v33, v13
v_sub_f32 v34, v34, v13
v_sub_f32 v35, v35, v13
v_sub_f32 v48, v48, v13
v_sub_f32 v49, v49, v13
v_sub_f32 v50, v50, v13
v_sub_f32 v51, v51, v13
v_sub_f32 v64, v64, v13
v_sub_f32 v65, v65, v13
v_sub_f32 v66, v66, v13
v_sub_f32 v67, v67, v13
v_sub_f32 v80, v80, v13
v_sub_f32 v81, v81, v13
v_sub_f32 v82, v82, v13
v_sub_f32 v83, v83, v13
v_mul_f32 v160, v160, v12
v_mul_f32 v161, v161, v12
v_mul_f32 v162, v162, v12
v_mul_f32 v163, v163, v12
v_mul_f32 v176, v176, v12
v_mul_f32 v177, v177, v12
v_mul_f32 v178, v178, v12
v_mul_f32 v179, v179, v12
v_mul_f32 v192, v192, v12
v_mul_f32 v193, v193, v12
v_mul_f32 v194, v194, v12
v_mul_f32 v195, v195, v12
v_mul_f32 v208, v208, v12
v_mul_f32 v209, v209, v12
v_mul_f32 v210, v210, v12
v_mul_f32 v211, v211, v12
v_mul_f32 v224, v224, v12
v_mul_f32 v225, v225, v12
v_mul_f32 v226, v226, v12
v_mul_f32 v227, v227, v12
v_mul_f32 v240, v240, v12
v_mul_f32 v241, v241, v12
v_mul_f32 v242, v242, v12
v_mul_f32 v243, v243, v12
v_accvgpr_read_b32 v14, a64
v_mul_f32 v14, v14, v12
v_accvgpr_write_b32 a64, v14
v_accvgpr_read_b32 v14, a65
v_mul_f32 v14, v14, v12
v_accvgpr_write_b32 a65, v14
v_accvgpr_read_b32 v14, a66
v_mul_f32 v14, v14, v12
v_accvgpr_write_b32 a66, v14
v_accvgpr_read_b32 v14, a67
v_mul_f32 v14, v14, v12
v_accvgpr_write_b32 a67, v14
v_accvgpr_read_b32 v14, a80
v_mul_f32 v14, v14, v12
v_accvgpr_write_b32 a80, v14
v_accvgpr_read_b32 v14, a81
v_mul_f32 v14, v14, v12
v_accvgpr_write_b32 a81, v14
v_accvgpr_read_b32 v14, a82
v_mul_f32 v14, v14, v12
v_accvgpr_write_b32 a82, v14
v_accvgpr_read_b32 v14, a83
v_mul_f32 v14, v14, v12
v_accvgpr_write_b32 a83, v14
v_accvgpr_read_b32 v14, a96
v_mul_f32 v14, v14, v12
v_accvgpr_write_b32 a96, v14
v_accvgpr_read_b32 v14, a97
v_mul_f32 v14, v14, v12
v_accvgpr_write_b32 a97, v14
v_accvgpr_read_b32 v14, a98
v_mul_f32 v14, v14, v12
v_accvgpr_write_b32 a98, v14
v_accvgpr_read_b32 v14, a99
v_mul_f32 v14, v14, v12
v_accvgpr_write_b32 a99, v14
v_max3_f32 v13, v36, v37, v9
v_max3_f32 v13, v13, v38, v39
v_max3_f32 v13, v13, v52, v53
v_max3_f32 v13, v13, v54, v55
v_max3_f32 v13, v13, v68, v69
v_max3_f32 v13, v13, v70, v71
v_max3_f32 v13, v13, v84, v85
v_max3_f32 v13, v13, v86, v87
v_mov_b32 v14, v13
s_nop 1
v_permlane16_swap_b32 v13, v14
v_max_f32 v13, v13, v14
v_mov_b32 v14, v13
s_nop 1
v_permlane32_swap_b32 v13, v14
v_max_f32 v13, v13, v14
v_sub_f32 v12, v9, v13
v_exp_f32 v12, v12
v_mov_b32 v9, v13
v_sub_f32 v36, v36, v13
v_sub_f32 v37, v37, v13
v_sub_f32 v38, v38, v13
v_sub_f32 v39, v39, v13
v_sub_f32 v52, v52, v13
v_sub_f32 v53, v53, v13
v_sub_f32 v54, v54, v13
v_sub_f32 v55, v55, v13
v_sub_f32 v68, v68, v13
v_sub_f32 v69, v69, v13
v_sub_f32 v70, v70, v13
v_sub_f32 v71, v71, v13
v_sub_f32 v84, v84, v13
v_sub_f32 v85, v85, v13
v_sub_f32 v86, v86, v13
v_sub_f32 v87, v87, v13
v_mul_f32 v164, v164, v12
v_mul_f32 v165, v165, v12
v_mul_f32 v166, v166, v12
v_mul_f32 v167, v167, v12
v_mul_f32 v180, v180, v12
v_mul_f32 v181, v181, v12
v_mul_f32 v182, v182, v12
v_mul_f32 v183, v183, v12
v_mul_f32 v196, v196, v12
v_mul_f32 v197, v197, v12
v_mul_f32 v198, v198, v12
v_mul_f32 v199, v199, v12
v_mul_f32 v212, v212, v12
v_mul_f32 v213, v213, v12
v_mul_f32 v214, v214, v12
v_mul_f32 v215, v215, v12
v_mul_f32 v228, v228, v12
v_mul_f32 v229, v229, v12
v_mul_f32 v230, v230, v12
v_mul_f32 v231, v231, v12
v_mul_f32 v244, v244, v12
v_mul_f32 v245, v245, v12
v_mul_f32 v246, v246, v12
v_mul_f32 v247, v247, v12
v_accvgpr_read_b32 v14, a68
v_mul_f32 v14, v14, v12
v_accvgpr_write_b32 a68, v14
v_accvgpr_read_b32 v14, a69
v_mul_f32 v14, v14, v12
v_accvgpr_write_b32 a69, v14
v_accvgpr_read_b32 v14, a70
v_mul_f32 v14, v14, v12
v_accvgpr_write_b32 a70, v14
v_accvgpr_read_b32 v14, a71
v_mul_f32 v14, v14, v12
v_accvgpr_write_b32 a71, v14
v_accvgpr_read_b32 v14, a84
v_mul_f32 v14, v14, v12
v_accvgpr_write_b32 a84, v14
v_accvgpr_read_b32 v14, a85
v_mul_f32 v14, v14, v12
v_accvgpr_write_b32 a85, v14
v_accvgpr_read_b32 v14, a86
v_mul_f32 v14, v14, v12
v_accvgpr_write_b32 a86, v14
v_accvgpr_read_b32 v14, a87
v_mul_f32 v14, v14, v12
v_accvgpr_write_b32 a87, v14
v_accvgpr_read_b32 v14, a100
v_mul_f32 v14, v14, v12
v_accvgpr_write_b32 a100, v14
v_accvgpr_read_b32 v14, a101
v_mul_f32 v14, v14, v12
v_accvgpr_write_b32 a101, v14
v_accvgpr_read_b32 v14, a102
v_mul_f32 v14, v14, v12
v_accvgpr_write_b32 a102, v14
v_accvgpr_read_b32 v14, a103
v_mul_f32 v14, v14, v12
v_accvgpr_write_b32 a103, v14
v_max3_f32 v13, v40, v41, v10
v_max3_f32 v13, v13, v42, v43
v_max3_f32 v13, v13, v56, v57
v_max3_f32 v13, v13, v58, v59
v_max3_f32 v13, v13, v72, v73
v_max3_f32 v13, v13, v74, v75
v_max3_f32 v13, v13, v88, v89
v_max3_f32 v13, v13, v90, v91
v_mov_b32 v14, v13
s_nop 1
v_permlane16_swap_b32 v13, v14
v_max_f32 v13, v13, v14
v_mov_b32 v14, v13
s_nop 1
v_permlane32_swap_b32 v13, v14
v_max_f32 v13, v13, v14
v_sub_f32 v12, v10, v13
v_exp_f32 v12, v12
v_mov_b32 v10, v13
v_sub_f32 v40, v40, v13
v_sub_f32 v41, v41, v13
v_sub_f32 v42, v42, v13
v_sub_f32 v43, v43, v13
v_sub_f32 v56, v56, v13
v_sub_f32 v57, v57, v13
v_sub_f32 v58, v58, v13
v_sub_f32 v59, v59, v13
v_sub_f32 v72, v72, v13
v_sub_f32 v73, v73, v13
v_sub_f32 v74, v74, v13
v_sub_f32 v75, v75, v13
v_sub_f32 v88, v88, v13
v_sub_f32 v89, v89, v13
v_sub_f32 v90, v90, v13
v_sub_f32 v91, v91, v13
v_mul_f32 v168, v168, v12
v_mul_f32 v169, v169, v12
v_mul_f32 v170, v170, v12
v_mul_f32 v171, v171, v12
v_mul_f32 v184, v184, v12
v_mul_f32 v185, v185, v12
v_mul_f32 v186, v186, v12
v_mul_f32 v187, v187, v12
v_mul_f32 v200, v200, v12
v_mul_f32 v201, v201, v12
v_mul_f32 v202, v202, v12
v_mul_f32 v203, v203, v12
v_mul_f32 v216, v216, v12
v_mul_f32 v217, v217, v12
v_mul_f32 v218, v218, v12
v_mul_f32 v219, v219, v12
v_mul_f32 v232, v232, v12
v_mul_f32 v233, v233, v12
v_mul_f32 v234, v234, v12
v_mul_f32 v235, v235, v12
v_mul_f32 v248, v248, v12
v_mul_f32 v249, v249, v12
v_mul_f32 v250, v250, v12
v_mul_f32 v251, v251, v12
v_accvgpr_read_b32 v14, a72
v_mul_f32 v14, v14, v12
v_accvgpr_write_b32 a72, v14
v_accvgpr_read_b32 v14, a73
v_mul_f32 v14, v14, v12
v_accvgpr_write_b32 a73, v14
v_accvgpr_read_b32 v14, a74
v_mul_f32 v14, v14, v12
v_accvgpr_write_b32 a74, v14
v_accvgpr_read_b32 v14, a75
v_mul_f32 v14, v14, v12
v_accvgpr_write_b32 a75, v14
v_accvgpr_read_b32 v14, a88
v_mul_f32 v14, v14, v12
v_accvgpr_write_b32 a88, v14
v_accvgpr_read_b32 v14, a89
v_mul_f32 v14, v14, v12
v_accvgpr_write_b32 a89, v14
v_accvgpr_read_b32 v14, a90
v_mul_f32 v14, v14, v12
v_accvgpr_write_b32 a90, v14
v_accvgpr_read_b32 v14, a91
v_mul_f32 v14, v14, v12
v_accvgpr_write_b32 a91, v14
v_accvgpr_read_b32 v14, a104
v_mul_f32 v14, v14, v12
v_accvgpr_write_b32 a104, v14
v_accvgpr_read_b32 v14, a105
v_mul_f32 v14, v14, v12
v_accvgpr_write_b32 a105, v14
v_accvgpr_read_b32 v14, a106
v_mul_f32 v14, v14, v12
v_accvgpr_write_b32 a106, v14
v_accvgpr_read_b32 v14, a107
v_mul_f32 v14, v14, v12
v_accvgpr_write_b32 a107, v14
v_max3_f32 v13, v44, v45, v11
v_max3_f32 v13, v13, v46, v47
v_max3_f32 v13, v13, v60, v61
v_max3_f32 v13, v13, v62, v63
v_max3_f32 v13, v13, v76, v77
v_max3_f32 v13, v13, v78, v79
v_max3_f32 v13, v13, v92, v93
v_max3_f32 v13, v13, v94, v95
v_mov_b32 v14, v13
s_nop 1
v_permlane16_swap_b32 v13, v14
v_max_f32 v13, v13, v14
v_mov_b32 v14, v13
s_nop 1
v_permlane32_swap_b32 v13, v14
v_max_f32 v13, v13, v14
v_sub_f32 v12, v11, v13
v_exp_f32 v12, v12
v_mov_b32 v11, v13
v_sub_f32 v44, v44, v13
v_sub_f32 v45, v45, v13
v_sub_f32 v46, v46, v13
v_sub_f32 v47, v47, v13
v_sub_f32 v60, v60, v13
v_sub_f32 v61, v61, v13
v_sub_f32 v62, v62, v13
v_sub_f32 v63, v63, v13
v_sub_f32 v76, v76, v13
v_sub_f32 v77, v77, v13
v_sub_f32 v78, v78, v13
v_sub_f32 v79, v79, v13
v_sub_f32 v92, v92, v13
v_sub_f32 v93, v93, v13
v_sub_f32 v94, v94, v13
v_sub_f32 v95, v95, v13
v_mul_f32 v172, v172, v12
v_mul_f32 v173, v173, v12
v_mul_f32 v174, v174, v12
v_mul_f32 v175, v175, v12
v_mul_f32 v188, v188, v12
v_mul_f32 v189, v189, v12
v_mul_f32 v190, v190, v12
v_mul_f32 v191, v191, v12
v_mul_f32 v204, v204, v12
v_mul_f32 v205, v205, v12
v_mul_f32 v206, v206, v12
v_mul_f32 v207, v207, v12
v_mul_f32 v220, v220, v12
v_mul_f32 v221, v221, v12
v_mul_f32 v222, v222, v12
v_mul_f32 v223, v223, v12
v_mul_f32 v236, v236, v12
v_mul_f32 v237, v237, v12
v_mul_f32 v238, v238, v12
v_mul_f32 v239, v239, v12
v_mul_f32 v252, v252, v12
v_mul_f32 v253, v253, v12
v_mul_f32 v254, v254, v12
v_mul_f32 v255, v255, v12
v_accvgpr_read_b32 v14, a76
v_mul_f32 v14, v14, v12
v_accvgpr_write_b32 a76, v14
v_accvgpr_read_b32 v14, a77
v_mul_f32 v14, v14, v12
v_accvgpr_write_b32 a77, v14
v_accvgpr_read_b32 v14, a78
v_mul_f32 v14, v14, v12
v_accvgpr_write_b32 a78, v14
v_accvgpr_read_b32 v14, a79
v_mul_f32 v14, v14, v12
v_accvgpr_write_b32 a79, v14
v_accvgpr_read_b32 v14, a92
v_mul_f32 v14, v14, v12
v_accvgpr_write_b32 a92, v14
v_accvgpr_read_b32 v14, a93
v_mul_f32 v14, v14, v12
v_accvgpr_write_b32 a93, v14
v_accvgpr_read_b32 v14, a94
v_mul_f32 v14, v14, v12
v_accvgpr_write_b32 a94, v14
v_accvgpr_read_b32 v14, a95
v_mul_f32 v14, v14, v12
v_accvgpr_write_b32 a95, v14
v_accvgpr_read_b32 v14, a108
v_mul_f32 v14, v14, v12
v_accvgpr_write_b32 a108, v14
v_accvgpr_read_b32 v14, a109
v_mul_f32 v14, v14, v12
v_accvgpr_write_b32 a109, v14
v_accvgpr_read_b32 v14, a110
v_mul_f32 v14, v14, v12
v_accvgpr_write_b32 a110, v14
v_accvgpr_read_b32 v14, a111
v_mul_f32 v14, v14, v12
v_accvgpr_write_b32 a111, v14
v_exp_f32 v32, v32
v_exp_f32 v33, v33
v_exp_f32 v34, v34
v_exp_f32 v35, v35
v_exp_f32 v48, v48
v_exp_f32 v49, v49
v_exp_f32 v50, v50
v_exp_f32 v51, v51
v_cvt_pk_bf16_f32 v32, v32, v33
v_cvt_pk_bf16_f32 v33, v34, v35
v_exp_f32 v36, v36
v_exp_f32 v37, v37
v_exp_f32 v38, v38
v_exp_f32 v39, v39
v_cvt_pk_bf16_f32 v34, v48, v49
v_cvt_pk_bf16_f32 v35, v50, v51
v_exp_f32 v52, v52
v_exp_f32 v53, v53
v_exp_f32 v54, v54
v_exp_f32 v55, v55
v_cvt_pk_bf16_f32 v36, v36, v37
v_cvt_pk_bf16_f32 v37, v38, v39
v_exp_f32 v40, v40
v_exp_f32 v41, v41
v_exp_f32 v42, v42
v_exp_f32 v43, v43
v_cvt_pk_bf16_f32 v38, v52, v53
v_cvt_pk_bf16_f32 v39, v54, v55
v_exp_f32 v56, v56
v_exp_f32 v57, v57
v_exp_f32 v58, v58
v_exp_f32 v59, v59
v_cvt_pk_bf16_f32 v40, v40, v41
v_cvt_pk_bf16_f32 v41, v42, v43
v_exp_f32 v44, v44
v_exp_f32 v45, v45
v_exp_f32 v46, v46
v_exp_f32 v47, v47
v_cvt_pk_bf16_f32 v42, v56, v57
v_cvt_pk_bf16_f32 v43, v58, v59
v_exp_f32 v60, v60
v_exp_f32 v61, v61
v_exp_f32 v62, v62
v_exp_f32 v63, v63
v_cvt_pk_bf16_f32 v44, v44, v45
v_cvt_pk_bf16_f32 v45, v46, v47
v_cvt_pk_bf16_f32 v46, v60, v61
v_cvt_pk_bf16_f32 v47, v62, v63
v_exp_f32 v64, v64
v_exp_f32 v65, v65
v_exp_f32 v66, v66
v_exp_f32 v67, v67
v_exp_f32 v80, v80
v_exp_f32 v81, v81
v_exp_f32 v82, v82
v_exp_f32 v83, v83
v_cvt_pk_bf16_f32 v64, v64, v65
v_cvt_pk_bf16_f32 v65, v66, v67
v_exp_f32 v68, v68
v_exp_f32 v69, v69
v_exp_f32 v70, v70
v_exp_f32 v71, v71
v_cvt_pk_bf16_f32 v66, v80, v81
v_cvt_pk_bf16_f32 v67, v82, v83
v_exp_f32 v84, v84
v_exp_f32 v85, v85
v_exp_f32 v86, v86
v_exp_f32 v87, v87
v_cvt_pk_bf16_f32 v68, v68, v69
v_cvt_pk_bf16_f32 v69, v70, v71
v_exp_f32 v72, v72
v_exp_f32 v73, v73
v_exp_f32 v74, v74
v_exp_f32 v75, v75
v_cvt_pk_bf16_f32 v70, v84, v85
v_cvt_pk_bf16_f32 v71, v86, v87
v_exp_f32 v88, v88
v_exp_f32 v89, v89
v_exp_f32 v90, v90
v_exp_f32 v91, v91
v_cvt_pk_bf16_f32 v72, v72, v73
v_cvt_pk_bf16_f32 v73, v74, v75
v_exp_f32 v76, v76
v_exp_f32 v77, v77
v_exp_f32 v78, v78
v_exp_f32 v79, v79
v_cvt_pk_bf16_f32 v74, v88, v89
v_cvt_pk_bf16_f32 v75, v90, v91
v_exp_f32 v92, v92
v_exp_f32 v93, v93
v_exp_f32 v94, v94
v_exp_f32 v95, v95
v_cvt_pk_bf16_f32 v76, v76, v77
v_cvt_pk_bf16_f32 v77, v78, v79
v_cvt_pk_bf16_f32 v78, v92, v93
v_cvt_pk_bf16_f32 v79, v94, v95
s_waitcnt vmcnt(0)
M a[96:99], a[112:115], v[32:35], a[96:99]
M a[100:103], a[112:115], v[36:39], a[100:103]
M a[104:107], a[112:115], v[40:43], a[104:107]
M a[108:111], a[112:115], v[44:47], a[108:111]
M v[160:163], v[96:99], v[32:35], v[160:163]
M v[164:167], v[96:99], v[36:39], v[164:167]
M v[168:171], v[96:99], v[40:43], v[168:171]
M v[172:175], v[96:99], v[44:47], v[172:175]
M v[176:179], v[100:103], v[32:35], v[176:179]
M v[180:183], v[100:103], v[36:39], v[180:183]
M v[184:187], v[100:103], v[40:43], v[184:187]
M v[188:191], v[100:103], v[44:47], v[188:191]
M v[192:195], v[104:107], v[32:35], v[192:195]
M v[196:199], v[104:107], v[36:39], v[196:199]
M v[200:203], v[104:107], v[40:43], v[200:203]
M v[204:207], v[104:107], v[44:47], v[204:207]
M v[208:211], v[108:111], v[32:35], v[208:211]
M v[212:215], v[108:111], v[36:39], v[212:215]
M v[216:219], v[108:111], v[40:43], v[216:219]
M v[220:223], v[108:111], v[44:47], v[220:223]
M v[224:227], v[112:115], v[32:35], v[224:227]
M v[228:231], v[112:115], v[36:39], v[228:231]
M v[232:235], v[112:115], v[40:43], v[232:235]
M v[236:239], v[112:115], v[44:47], v[236:239]
M v[240:243], v[116:119], v[32:35], v[240:243]
M v[244:247], v[116:119], v[36:39], v[244:247]
M v[248:251], v[116:119], v[40:43], v[248:251]
M v[252:255], v[116:119], v[44:47], v[252:255]
M a[64:67], v[120:123], v[32:35], a[64:67]
M a[68:71], v[120:123], v[36:39], a[68:71]
M a[72:75], v[120:123], v[40:43], a[72:75]
M a[76:79], v[120:123], v[44:47], a[76:79]
M a[80:83], v[124:127], v[32:35], a[80:83]
M a[84:87], v[124:127], v[36:39], a[84:87]
M a[88:91], v[124:127], v[40:43], a[88:91]
M a[92:95], v[124:127], v[44:47], a[92:95]
M a[96:99], a[112:115], v[64:67], a[96:99]
M a[100:103], a[112:115], v[68:71], a[100:103]
M a[104:107], a[112:115], v[72:75], a[104:107]
M a[108:111], a[112:115], v[76:79], a[108:111]
M v[160:163], v[128:131], v[64:67], v[160:163]
M v[164:167], v[128:131], v[68:71], v[164:167]
M v[168:171], v[128:131], v[72:75], v[168:171]
M v[172:175], v[128:131], v[76:79], v[172:175]
M v[176:179], v[132:135], v[64:67], v[176:179]
M v[180:183], v[132:135], v[68:71], v[180:183]
M v[184:187], v[132:135], v[72:75], v[184:187]
M v[188:191], v[132:135], v[76:79], v[188:191]
M v[192:195], v[136:139], v[64:67], v[192:195]
M v[196:199], v[136:139], v[68:71], v[196:199]
M v[200:203], v[136:139], v[72:75], v[200:203]
M v[204:207], v[136:139], v[76:79], v[204:207]
M v[208:211], v[140:143], v[64:67], v[208:211]
M v[212:215], v[140:143], v[68:71], v[212:215]
M v[216:219], v[140:143], v[72:75], v[216:219]
M v[220:223], v[140:143], v[76:79], v[220:223]
M v[224:227], v[144:147], v[64:67], v[224:227]
M v[228:231], v[144:147], v[68:71], v[228:231]
M v[232:235], v[144:147], v[72:75], v[232:235]
M v[236:239], v[144:147], v[76:79], v[236:239]
M v[240:243], v[148:151], v[64:67], v[240:243]
M v[244:247], v[148:151], v[68:71], v[244:247]
M v[248:251], v[148:151], v[72:75], v[248:251]
M v[252:255], v[148:151], v[76:79], v[252:255]
M a[64:67], v[152:155], v[64:67], a[64:67]
M a[68:71], v[152:155], v[68:71], a[68:71]
M a[72:75], v[152:155], v[72:75], a[72:75]
M a[76:79], v[152:155], v[76:79], a[76:79]
M a[80:83], v[156:159], v[64:67], a[80:83]
M a[84:87], v[156:159], v[68:71], a[84:87]
M a[88:91], v[156:159], v[72:75], a[88:91]
M a[92:95], v[156:159], v[76:79], a[92:95]
s_nop 7
s_add_u32 s57, s57, 32768
s_sub_u32 s58, s58, 64
s_sub_u32 s59, s59, 1
s_cmp_lg_u32 s59, 0
s_cbranch_scc1 Lslow_8
v_accvgpr_read_b32 v20, a96
v_accvgpr_read_b32 v21, a100
v_accvgpr_read_b32 v22, a104
v_accvgpr_read_b32 v23, a108
v_rcp_f32 v8, v20
v_rcp_f32 v9, v21
v_rcp_f32 v10, v22
v_rcp_f32 v11, v23
v_pk_mul_f32 v[160:161], v[160:161], v[8:9] op_sel:[0,0] op_sel_hi:[1,0]
v_pk_mul_f32 v[162:163], v[162:163], v[8:9] op_sel:[0,0] op_sel_hi:[1,0]
v_pk_mul_f32 v[176:177], v[176:177], v[8:9] op_sel:[0,0] op_sel_hi:[1,0]
v_pk_mul_f32 v[178:179], v[178:179], v[8:9] op_sel:[0,0] op_sel_hi:[1,0]
v_cvt_pk_bf16_f32 v160, v160, v161
v_cvt_pk_bf16_f32 v161, v162, v163
v_cvt_pk_bf16_f32 v162, v176, v177
v_cvt_pk_bf16_f32 v163, v178, v179
v_pk_mul_f32 v[164:165], v[164:165], v[8:9] op_sel:[0,1] op_sel_hi:[1,1]
v_pk_mul_f32 v[166:167], v[166:167], v[8:9] op_sel:[0,1] op_sel_hi:[1,1]
v_pk_mul_f32 v[180:181], v[180:181], v[8:9] op_sel:[0,1] op_sel_hi:[1,1]
v_pk_mul_f32 v[182:183], v[182:183], v[8:9] op_sel:[0,1] op_sel_hi:[1,1]
v_cvt_pk_bf16_f32 v164, v164, v165
v_cvt_pk_bf16_f32 v165, v166, v167
v_cvt_pk_bf16_f32 v166, v180, v181
v_cvt_pk_bf16_f32 v167, v182, v183
v_pk_mul_f32 v[168:169], v[168:169], v[10:11] op_sel:[0,0] op_sel_hi:[1,0]
v_pk_mul_f32 v[170:171], v[170:171], v[10:11] op_sel:[0,0] op_sel_hi:[1,0]
v_pk_mul_f32 v[184:185], v[184:185], v[10:11] op_sel:[0,0] op_sel_hi:[1,0]
v_pk_mul_f32 v[186:187], v[186:187], v[10:11] op_sel:[0,0] op_sel_hi:[1,0]
v_cvt_pk_bf16_f32 v168, v168, v169
v_cvt_pk_bf16_f32 v169, v170, v171
v_cvt_pk_bf16_f32 v170, v184, v185
v_cvt_pk_bf16_f32 v171, v186, v187
v_pk_mul_f32 v[172:173], v[172:173], v[10:11] op_sel:[0,1] op_sel_hi:[1,1]
v_pk_mul_f32 v[174:175], v[174:175], v[10:11] op_sel:[0,1] op_sel_hi:[1,1]
v_pk_mul_f32 v[188:189], v[188:189], v[10:11] op_sel:[0,1] op_sel_hi:[1,1]
v_pk_mul_f32 v[190:191], v[190:191], v[10:11] op_sel:[0,1] op_sel_hi:[1,1]
v_cvt_pk_bf16_f32 v172, v172, v173
v_cvt_pk_bf16_f32 v173, v174, v175
v_cvt_pk_bf16_f32 v174, v188, v189
v_cvt_pk_bf16_f32 v175, v190, v191
v_pk_mul_f32 v[192:193], v[192:193], v[8:9] op_sel:[0,0] op_sel_hi:[1,0]
v_pk_mul_f32 v[194:195], v[194:195], v[8:9] op_sel:[0,0] op_sel_hi:[1,0]
v_pk_mul_f32 v[208:209], v[208:209], v[8:9] op_sel:[0,0] op_sel_hi:[1,0]
v_pk_mul_f32 v[210:211], v[210:211], v[8:9] op_sel:[0,0] op_sel_hi:[1,0]
v_cvt_pk_bf16_f32 v192, v192, v193
v_cvt_pk_bf16_f32 v193, v194, v195
v_cvt_pk_bf16_f32 v194, v208, v209
v_cvt_pk_bf16_f32 v195, v210, v211
v_pk_mul_f32 v[196:197], v[196:197], v[8:9] op_sel:[0,1] op_sel_hi:[1,1]
v_pk_mul_f32 v[198:199], v[198:199], v[8:9] op_sel:[0,1] op_sel_hi:[1,1]
v_pk_mul_f32 v[212:213], v[212:213], v[8:9] op_sel:[0,1] op_sel_hi:[1,1]
v_pk_mul_f32 v[214:215], v[214:215], v[8:9] op_sel:[0,1] op_sel_hi:[1,1]
v_cvt_pk_bf16_f32 v196, v196, v197
v_cvt_pk_bf16_f32 v197, v198, v199
v_cvt_pk_bf16_f32 v198, v212, v213
v_cvt_pk_bf16_f32 v199, v214, v215
v_pk_mul_f32 v[200:201], v[200:201], v[10:11] op_sel:[0,0] op_sel_hi:[1,0]
v_pk_mul_f32 v[202:203], v[202:203], v[10:11] op_sel:[0,0] op_sel_hi:[1,0]
v_pk_mul_f32 v[216:217], v[216:217], v[10:11] op_sel:[0,0] op_sel_hi:[1,0]
v_pk_mul_f32 v[218:219], v[218:219], v[10:11] op_sel:[0,0] op_sel_hi:[1,0]
v_cvt_pk_bf16_f32 v200, v200, v201
v_cvt_pk_bf16_f32 v201, v202, v203
v_cvt_pk_bf16_f32 v202, v216, v217
v_cvt_pk_bf16_f32 v203, v218, v219
v_pk_mul_f32 v[204:205], v[204:205], v[10:11] op_sel:[0,1] op_sel_hi:[1,1]
v_pk_mul_f32 v[206:207], v[206:207], v[10:11] op_sel:[0,1] op_sel_hi:[1,1]
v_pk_mul_f32 v[220:221], v[220:221], v[10:11] op_sel:[0,1] op_sel_hi:[1,1]
v_pk_mul_f32 v[222:223], v[222:223], v[10:11] op_sel:[0,1] op_sel_hi:[1,1]
v_cvt_pk_bf16_f32 v204, v204, v205
v_cvt_pk_bf16_f32 v205, v206, v207
v_cvt_pk_bf16_f32 v206, v220, v221
v_cvt_pk_bf16_f32 v207, v222, v223
v_pk_mul_f32 v[224:225], v[224:225], v[8:9] op_sel:[0,0] op_sel_hi:[1,0]
v_pk_mul_f32 v[226:227], v[226:227], v[8:9] op_sel:[0,0] op_sel_hi:[1,0]
v_pk_mul_f32 v[240:241], v[240:241], v[8:9] op_sel:[0,0] op_sel_hi:[1,0]
v_pk_mul_f32 v[242:243], v[242:243], v[8:9] op_sel:[0,0] op_sel_hi:[1,0]
v_cvt_pk_bf16_f32 v224, v224, v225
v_cvt_pk_bf16_f32 v225, v226, v227
v_cvt_pk_bf16_f32 v226, v240, v241
v_cvt_pk_bf16_f32 v227, v242, v243
v_pk_mul_f32 v[228:229], v[228:229], v[8:9] op_sel:[0,1] op_sel_hi:[1,1]
v_pk_mul_f32 v[230:231], v[230:231], v[8:9] op_sel:[0,1] op_sel_hi:[1,1]
v_pk_mul_f32 v[244:245], v[244:245], v[8:9] op_sel:[0,1] op_sel_hi:[1,1]
v_pk_mul_f32 v[246:247], v[246:247], v[8:9] op_sel:[0,1] op_sel_hi:[1,1]
v_cvt_pk_bf16_f32 v228, v228, v229
v_cvt_pk_bf16_f32 v229, v230, v231
v_cvt_pk_bf16_f32 v230, v244, v245
v_cvt_pk_bf16_f32 v231, v246, v247
v_pk_mul_f32 v[232:233], v[232:233], v[10:11] op_sel:[0,0] op_sel_hi:[1,0]
v_pk_mul_f32 v[234:235], v[234:235], v[10:11] op_sel:[0,0] op_sel_hi:[1,0]
v_pk_mul_f32 v[248:249], v[248:249], v[10:11] op_sel:[0,0] op_sel_hi:[1,0]
v_pk_mul_f32 v[250:251], v[250:251], v[10:11] op_sel:[0,0] op_sel_hi:[1,0]
v_cvt_pk_bf16_f32 v232, v232, v233
v_cvt_pk_bf16_f32 v233, v234, v235
v_cvt_pk_bf16_f32 v234, v248, v249
v_cvt_pk_bf16_f32 v235, v250, v251
v_pk_mul_f32 v[236:237], v[236:237], v[10:11] op_sel:[0,1] op_sel_hi:[1,1]
v_pk_mul_f32 v[238:239], v[238:239], v[10:11] op_sel:[0,1] op_sel_hi:[1,1]
v_pk_mul_f32 v[252:253], v[252:253], v[10:11] op_sel:[0,1] op_sel_hi:[1,1]
v_pk_mul_f32 v[254:255], v[254:255], v[10:11] op_sel:[0,1] op_sel_hi:[1,1]
v_cvt_pk_bf16_f32 v236, v236, v237
v_cvt_pk_bf16_f32 v237, v238, v239
v_cvt_pk_bf16_f32 v238, v252, v253
v_cvt_pk_bf16_f32 v239, v254, v255
v_accvgpr_read_b32 v176, a64
v_accvgpr_read_b32 v177, a65
v_accvgpr_read_b32 v178, a66
v_accvgpr_read_b32 v179, a67
v_accvgpr_read_b32 v180, a80
v_accvgpr_read_b32 v181, a81
v_accvgpr_read_b32 v182, a82
v_accvgpr_read_b32 v183, a83
v_pk_mul_f32 v[176:177], v[176:177], v[8:9] op_sel:[0,0] op_sel_hi:[1,0]
v_pk_mul_f32 v[178:179], v[178:179], v[8:9] op_sel:[0,0] op_sel_hi:[1,0]
v_pk_mul_f32 v[180:181], v[180:181], v[8:9] op_sel:[0,0] op_sel_hi:[1,0]
v_pk_mul_f32 v[182:183], v[182:183], v[8:9] op_sel:[0,0] op_sel_hi:[1,0]
v_cvt_pk_bf16_f32 v176, v176, v177
v_cvt_pk_bf16_f32 v177, v178, v179
v_cvt_pk_bf16_f32 v178, v180, v181
v_cvt_pk_bf16_f32 v179, v182, v183
v_accvgpr_read_b32 v184, a68
v_accvgpr_read_b32 v185, a69
v_accvgpr_read_b32 v186, a70
v_accvgpr_read_b32 v187, a71
v_accvgpr_read_b32 v188, a84
v_accvgpr_read_b32 v189, a85
v_accvgpr_read_b32 v190, a86
v_accvgpr_read_b32 v191, a87
v_pk_mul_f32 v[184:185], v[184:185], v[8:9] op_sel:[0,1] op_sel_hi:[1,1]
v_pk_mul_f32 v[186:187], v[186:187], v[8:9] op_sel:[0,1] op_sel_hi:[1,1]
v_pk_mul_f32 v[188:189], v[188:189], v[8:9] op_sel:[0,1] op_sel_hi:[1,1]
v_pk_mul_f32 v[190:191], v[190:191], v[8:9] op_sel:[0,1] op_sel_hi:[1,1]
v_cvt_pk_bf16_f32 v184, v184, v185
v_cvt_pk_bf16_f32 v185, v186, v187
v_cvt_pk_bf16_f32 v186, v188, v189
v_cvt_pk_bf16_f32 v187, v190, v191
v_accvgpr_read_b32 v208, a72
v_accvgpr_read_b32 v209, a73
v_accvgpr_read_b32 v210, a74
v_accvgpr_read_b32 v211, a75
v_accvgpr_read_b32 v212, a88
v_accvgpr_read_b32 v213, a89
v_accvgpr_read_b32 v214, a90
v_accvgpr_read_b32 v215, a91
v_pk_mul_f32 v[208:209], v[208:209], v[10:11] op_sel:[0,0] op_sel_hi:[1,0]
v_pk_mul_f32 v[210:211], v[210:211], v[10:11] op_sel:[0,0] op_sel_hi:[1,0]
v_pk_mul_f32 v[212:213], v[212:213], v[10:11] op_sel:[0,0] op_sel_hi:[1,0]
v_pk_mul_f32 v[214:215], v[214:215], v[10:11] op_sel:[0,0] op_sel_hi:[1,0]
v_cvt_pk_bf16_f32 v208, v208, v209
v_cvt_pk_bf16_f32 v209, v210, v211
v_cvt_pk_bf16_f32 v210, v212, v213
v_cvt_pk_bf16_f32 v211, v214, v215
v_accvgpr_read_b32 v216, a76
v_accvgpr_read_b32 v217, a77
v_accvgpr_read_b32 v218, a78
v_accvgpr_read_b32 v219, a79
v_accvgpr_read_b32 v220, a92
v_accvgpr_read_b32 v221, a93
v_accvgpr_read_b32 v222, a94
v_accvgpr_read_b32 v223, a95
v_pk_mul_f32 v[216:217], v[216:217], v[10:11] op_sel:[0,1] op_sel_hi:[1,1]
v_pk_mul_f32 v[218:219], v[218:219], v[10:11] op_sel:[0,1] op_sel_hi:[1,1]
v_pk_mul_f32 v[220:221], v[220:221], v[10:11] op_sel:[0,1] op_sel_hi:[1,1]
v_pk_mul_f32 v[222:223], v[222:223], v[10:11] op_sel:[0,1] op_sel_hi:[1,1]
v_cvt_pk_bf16_f32 v216, v216, v217
v_cvt_pk_bf16_f32 v217, v218, v219
v_cvt_pk_bf16_f32 v218, v220, v221
v_cvt_pk_bf16_f32 v219, v222, v223
s_lshl_b32 s33, s56, 20
s_lshl_b32 s34, s20, 15
s_add_u32 s33, s33, s34
s_lshl_b32 s34, s23, 13
s_add_u32 s36, s33, s34
s_add_u32 s37, s36, 4096
s_add_u32 s38, s36, 16384
s_add_u32 s39, s36, 20480
s_bitcmp1_b32 s61, 0
s_cbranch_scc0 Lss_11
buffer_store_dwordx4 v[160:163], v1, s[16:19], s36 offen offset:0 sc1
buffer_store_dwordx4 v[164:167], v1, s[16:19], s36 offen offset:2048 sc1
buffer_store_dwordx4 v[168:171], v1, s[16:19], s37 offen offset:0 sc1
buffer_store_dwordx4 v[172:175], v1, s[16:19], s37 offen offset:2048 sc1
Lss_11:
s_bitcmp1_b32 s61, 1
s_cbranch_scc0 Lss_12
buffer_store_dwordx4 v[192:195], v1, s[16:19], s36 offen offset:1024 sc1
buffer_store_dwordx4 v[196:199], v1, s[16:19], s36 offen offset:3072 sc1
buffer_store_dwordx4 v[200:203], v1, s[16:19], s37 offen offset:1024 sc1
buffer_store_dwordx4 v[204:207], v1, s[16:19], s37 offen offset:3072 sc1
Lss_12:
s_bitcmp1_b32 s61, 2
s_cbranch_scc0 Lss_13
buffer_store_dwordx4 v[224:227], v1, s[16:19], s38 offen offset:0 sc1
buffer_store_dwordx4 v[228:231], v1, s[16:19], s38 offen offset:2048 sc1
buffer_store_dwordx4 v[232:235], v1, s[16:19], s39 offen offset:0 sc1
buffer_store_dwordx4 v[236:239], v1, s[16:19], s39 offen offset:2048 sc1
Lss_13:
s_bitcmp1_b32 s61, 3
s_cbranch_scc0 Lss_14
buffer_store_dwordx4 v[176:179], v1, s[16:19], s38 offen offset:1024 sc1
buffer_store_dwordx4 v[184:187], v1, s[16:19], s38 offen offset:3072 sc1
buffer_store_dwordx4 v[208:211], v1, s[16:19], s39 offen offset:1024 sc1
buffer_store_dwordx4 v[216:219], v1, s[16:19], s39 offen offset:3072 sc1
Lss_14:
s_branch Lk2_chk
Lk2_done:
s_lshl_b32 s33, s20, 4
s_add_u32 s33, s33, 8392704
s_sub_u32 s34, 15, s21
s_lshl_b32 s34, s34, 9
s_add_u32 s92, s33, s34
s_lshl_b32 s34, s22, 2
s_add_u32 s92, s92, s34
s_lshl_b32 s34, s21, 9
s_add_u32 s93, s33, s34
s_lshl_b32 s34, s23, 3
s_add_u32 s93, s93, s34
s_cmp_eq_u32 s24, 0
s_cselect_b32 s93, s93, s92
s_cselect_b32 s94, 4, 0
s_add_u32 s94, s94, s93
s_load_dwordx2 s[10:11], s[0:1], 40
s_load_dwordx2 s[14:15], s[0:1], 72
s_lshl_b32 s21, s27, 7
s_lshl_b32 s22, s28, 6
s_lshl_b32 s3, s101, 4
v_lshrrev_b32 v224, 3, v0
v_and_b32 v225, 6, v224
v_and_b32 v226, 7, v0
v_xor_b32 v225, v225, v226
v_add_u32 v224, s3, v224
v_lshlrev_b32 v224, 11, v224
v_lshl_add_u32 v6, v225, 4, v224
v_add_u32 v7, 15360, v6
v_lshrrev_b32 v224, 2, v0
v_and_b32 v226, 1, v0
v_bfe_u32 v229, v0, 1, 1
v_lshlrev_b32 v225, 7, v224
v_lshl_add_u32 v225, v226, 3, v225
v_and_b32 v228, 6, v224
v_add_u32 v227, 0, v229
v_xor_b32 v227, v227, v228
v_lshl_add_u32 v24, v227, 4, v225
v_add_u32 v28, 0x10000, v24
v_add_u32 v227, 2, v229
v_xor_b32 v227, v227, v228
v_lshl_add_u32 v25, v227, 4, v225
v_add_u32 v29, 0x10000, v25
v_add_u32 v227, 4, v229
v_xor_b32 v227, v227, v228
v_lshl_add_u32 v26, v227, 4, v225
v_add_u32 v30, 0x10000, v26
v_add_u32 v227, 6, v229
v_xor_b32 v227, v227, v228
v_lshl_add_u32 v27, v227, 4, v225
v_add_u32 v31, 0x10000, v27
s_waitcnt vmcnt(32)
s_barrier
ds_read_b64_tr_b16 v[96:97], v28 offset:0
ds_read_b64_tr_b16 v[98:99], v28 offset:2048
ds_read_b64_tr_b16 v[100:101], v28 offset:4096
ds_read_b64_tr_b16 v[102:103], v28 offset:6144
ds_read_b64_tr_b16 v[104:105], v29 offset:0
ds_read_b64_tr_b16 v[106:107], v29 offset:2048
ds_read_b64_tr_b16 v[108:109], v29 offset:4096
ds_read_b64_tr_b16 v[110:111], v29 offset:6144
ds_read_b64_tr_b16 v[112:113], v30 offset:0
ds_read_b64_tr_b16 v[114:115], v30 offset:2048
ds_read_b64_tr_b16 v[116:117], v30 offset:4096
ds_read_b64_tr_b16 v[118:119], v30 offset:6144
ds_read_b64_tr_b16 v[120:121], v31 offset:0
ds_read_b64_tr_b16 v[122:123], v31 offset:2048
ds_read_b64_tr_b16 v[124:125], v31 offset:4096
ds_read_b64_tr_b16 v[126:127], v31 offset:6144
s_and_b32 s40, s2, 1
s_bfe_u32 s3, s2, 0x10001
s_lshl_b32 s3, s3, 3
s_bfe_u32 s36, s2, 0x30003
s_add_u32 s36, s3, s36
s_lshl_b32 s29, s36, 7
s_bfe_u32 s3, s2, 0x10002
s_lshl_b32 s3, s3, 2
s_lshr_b32 s37, s2, 6
s_add_u32 s3, s3, s37
s_lshl_b32 s13, s3, 8
s_lshl_b32 s30, s3, 7
s_lshl_b32 s3, s40, 6
s_add_u32 s30, s30, s3
s_lshl_b32 s41, s101, 12
s_lshl_b32 s12, s36, 20
s_add_u32 s12, s12, s41
s_lshl_b32 s62, s36, 9
s_lshl_b32 s3, s40, 8
s_add_u32 s62, s62, s3
s_add_u32 s62, s62, 8392704
s_lshr_b32 s3, s2, 1
s_lshr_b32 s38, s2, 2
s_xor_b32 s3, s3, s38
s_and_b32 s3, s3, 1
s_lshl_b32 s3, s3, 4
s_sub_u32 s39, 32, s3
s_lshl_b32 s38, s40, 5
s_add_u32 s3, s3, s38
s_lshl_b32 s3, s3, 14
s_add_u32 s12, s12, s3
s_lshl_b32 s3, s3, 3
s_add_u32 s13, s13, s3
s_mov_b32 s64, 4294459392
s_mov_b32 s65, 16384
s_add_u32 s8, s4, 67108864
s_addc_u32 s9, s5, 0
s_lshl_b32 s56, s2, 15
s_lshl_b32 s38, s101, 13
s_add_u32 s56, s56, s38
s_xor_b32 s57, s56, 32768
s_lshl_b32 s58, s2, 2
s_add_u32 s58, s58, 8388608
s_xor_b32 s59, s58, 4
s_mov_b32 s61, 0
s_lshl_b32 s3, s101, 4
v_lshrrev_b32 v232, 4, v0
v_and_b32 v234, 15, v0
v_add_u32 v233, 0, v232
v_lshlrev_b32 v233, 1, v233
v_xor_b32 v233, v233, v234
v_add_u32 v235, s3, v232
v_lshlrev_b32 v235, 11, v235
v_lshl_add_u32 v235, v233, 4, v235
v_add_u32 v2, 0, v235
v_add_u32 v233, 4, v232
v_lshlrev_b32 v233, 1, v233
v_xor_b32 v233, v233, v234
v_add_u32 v235, s3, v232
v_lshlrev_b32 v235, 11, v235
v_lshl_add_u32 v235, v233, 4, v235
v_add_u32 v3, 7168, v235
v_add_u32 v233, 0, v232
v_lshlrev_b32 v233, 1, v233
v_xor_b32 v233, v233, v234
v_add_u32 v235, s3, v232
v_lshlrev_b32 v235, 11, v235
v_lshl_add_u32 v235, v233, 4, v235
v_add_u32 v4, 14336, v235
v_add_u32 v233, 4, v232
v_lshlrev_b32 v233, 1, v233
v_xor_b32 v233, v233, v234
v_add_u32 v235, s3, v232
v_lshlrev_b32 v235, 11, v235
v_lshl_add_u32 v235, v233, 4, v235
v_add_u32 v5, 21504, v235
v_lshlrev_b32 v225, 8, v224
v_lshl_add_u32 v225, v226, 3, v225
v_and_b32 v228, 7, v224
v_lshlrev_b32 v228, 1, v228
s_lshl_b32 s38, s40, 3
v_xor_b32 v228, s38, v228
v_add_u32 v227, 0, v229
v_xor_b32 v227, v227, v228
v_lshl_add_u32 v8, v227, 4, v225
v_add_u32 v16, 0x10000, v8
v_add_u32 v227, 2, v229
v_xor_b32 v227, v227, v228
v_lshl_add_u32 v9, v227, 4, v225
v_add_u32 v17, 0x10000, v9
v_add_u32 v227, 4, v229
v_xor_b32 v227, v227, v228
v_lshl_add_u32 v10, v227, 4, v225
v_add_u32 v18, 0x10000, v10
v_add_u32 v227, 6, v229
v_xor_b32 v227, v227, v228
v_lshl_add_u32 v11, v227, 4, v225
v_add_u32 v19, 0x10000, v11
v_add_u32 v227, 8, v229
v_xor_b32 v227, v227, v228
v_lshl_add_u32 v12, v227, 4, v225
v_add_u32 v20, 0x10000, v12
v_add_u32 v227, 10, v229
v_xor_b32 v227, v227, v228
v_lshl_add_u32 v13, v227, 4, v225
v_add_u32 v21, 0x10000, v13
v_add_u32 v227, 12, v229
v_xor_b32 v227, v227, v228
v_lshl_add_u32 v14, v227, 4, v225
v_add_u32 v22, 0x10000, v14
v_add_u32 v227, 14, v229
v_xor_b32 v227, v227, v228
v_lshl_add_u32 v15, v227, 4, v225
v_add_u32 v23, 0x10000, v15
v_mov_b32 v253, 0
v_mov_b32 v254, 1
v_lshlrev_b32 v255, 2, v0
s_waitcnt lgkmcnt(0)
s_mov_b32 s16, s14
s_mov_b32 s17, s15
s_mov_b32 s18, 8388608
s_mov_b32 s19, 0x00020000
s_waitcnt vmcnt(26) lgkmcnt(0)
s_barrier
M a[0:3], v[96:99], a[192:195], 0
s_add_u32 m0, s42, 16384
s_nop 0
buffer_load_dwordx4 v6, s[48:51], s26 offen offset:0 lds
ds_read_b64_tr_b16 v[160:161], v28 offset:16384
ds_read_b64_tr_b16 v[162:163], v28 offset:18432
M a[0:3], v[100:103], a[196:199], a[0:3]
buffer_load_dwordx4 v7, s[48:51], s26 offen offset:1024 lds
M a[4:7], v[108:111], a[196:199], 0
ds_read_b64_tr_b16 v[164:165], v28 offset:20480
ds_read_b64_tr_b16 v[166:167], v28 offset:22528
M a[4:7], v[104:107], a[192:195], a[4:7]
buffer_load_dwordx4 a[144:147], v1, s[44:47], s25 offen offset:0 sc1
M a[8:11], v[112:115], a[192:195], 0
ds_read_b64_tr_b16 v[168:169], v29 offset:16384
ds_read_b64_tr_b16 v[170:171], v29 offset:18432
M a[8:11], v[116:119], a[196:199], a[8:11]
buffer_load_dwordx4 a[148:151], v1, s[44:47], s25 offen offset:1024 sc1
M a[12:15], v[124:127], a[196:199], 0
ds_read_b64_tr_b16 v[172:173], v29 offset:20480
ds_read_b64_tr_b16 v[174:175], v29 offset:22528
M a[12:15], v[120:123], a[192:195], a[12:15]
buffer_load_dwordx4 a[152:155], v1, s[44:47], s25 offen offset:2048 sc1
M a[16:19], v[96:99], a[200:203], 0
ds_read_b64_tr_b16 v[176:177], v30 offset:16384
ds_read_b64_tr_b16 v[178:179], v30 offset:18432
M a[16:19], v[100:103], a[204:207], a[16:19]
buffer_load_dwordx4 a[156:159], v1, s[44:47], s25 offen offset:3072 sc1
M a[20:23], v[108:111], a[204:207], 0
ds_read_b64_tr_b16 v[180:181], v30 offset:20480
ds_read_b64_tr_b16 v[182:183], v30 offset:22528
M a[20:23], v[104:107], a[200:203], a[20:23]
s_add_u32 s25, s25, 16384
s_add_u32 s26, s26, 131072
M a[24:27], v[112:115], a[200:203], 0
ds_read_b64_tr_b16 v[184:185], v31 offset:16384
ds_read_b64_tr_b16 v[186:187], v31 offset:18432
M a[24:27], v[116:119], a[204:207], a[24:27]
ds_read_b64_tr_b16 v[188:189], v31 offset:20480
ds_read_b64_tr_b16 v[190:191], v31 offset:22528
M a[28:31], v[124:127], a[204:207], 0
M a[28:31], v[120:123], a[200:203], a[28:31]
s_waitcnt vmcnt(6) lgkmcnt(0)
s_barrier
s_mov_b64 exec, 1
buffer_store_dword v254, v253, s[52:55], s92 offen sc1
buffer_store_dword v254, v253, s[52:55], s93 offen sc1
buffer_store_dword v254, v253, s[52:55], s94 offen sc1
s_mov_b64 exec, -1
M a[0:3], v[160:163], a[208:211], a[0:3]
s_add_u32 m0, s42, 32768
s_nop 0
buffer_load_dwordx4 v6, s[48:51], s26 offen offset:0 lds
ds_read_b64_tr_b16 v[96:97], v28 offset:32768
ds_read_b64_tr_b16 v[98:99], v28 offset:34816
M a[0:3], v[164:167], a[212:215], a[0:3]
buffer_load_dwordx4 v7, s[48:51], s26 offen offset:1024 lds
M a[4:7], v[172:175], a[212:215], a[4:7]
ds_read_b64_tr_b16 v[100:101], v28 offset:36864
ds_read_b64_tr_b16 v[102:103], v28 offset:38912
M a[4:7], v[168:171], a[208:211], a[4:7]
buffer_load_dwordx4 a[160:163], v1, s[44:47], s25 offen offset:0 sc1
M a[8:11], v[176:179], a[208:211], a[8:11]
ds_read_b64_tr_b16 v[104:105], v29 offset:32768
ds_read_b64_tr_b16 v[106:107], v29 offset:34816
M a[8:11], v[180:183], a[212:215], a[8:11]
buffer_load_dwordx4 a[164:167], v1, s[44:47], s25 offen offset:1024 sc1
M a[12:15], v[188:191], a[212:215], a[12:15]
ds_read_b64_tr_b16 v[108:109], v29 offset:36864
ds_read_b64_tr_b16 v[110:111], v29 offset:38912
M a[12:15], v[184:187], a[208:211], a[12:15]
buffer_load_dwordx4 a[168:171], v1, s[44:47], s25 offen offset:2048 sc1
M a[16:19], v[160:163], a[216:219], a[16:19]
ds_read_b64_tr_b16 v[112:113], v30 offset:32768
ds_read_b64_tr_b16 v[114:115], v30 offset:34816
M a[16:19], v[164:167], a[220:223], a[16:19]
buffer_load_dwordx4 a[172:175], v1, s[44:47], s25 offen offset:3072 sc1
M a[20:23], v[172:175], a[220:223], a[20:23]
ds_read_b64_tr_b16 v[116:117], v30 offset:36864
ds_read_b64_tr_b16 v[118:119], v30 offset:38912
M a[20:23], v[168:171], a[216:219], a[20:23]
s_add_u32 s25, s25, 16384
s_add_u32 s26, s26, 131072
M a[24:27], v[176:179], a[216:219], a[24:27]
ds_read_b64_tr_b16 v[120:121], v31 offset:32768
ds_read_b64_tr_b16 v[122:123], v31 offset:34816
M a[24:27], v[180:183], a[220:223], a[24:27]
ds_read_b64_tr_b16 v[124:125], v31 offset:36864
ds_read_b64_tr_b16 v[126:127], v31 offset:38912
M a[28:31], v[188:191], a[220:223], a[28:31]
M a[28:31], v[184:187], a[216:219], a[28:31]
s_waitcnt vmcnt(29) lgkmcnt(0)
s_barrier
M a[0:3], v[96:99], a[224:227], a[0:3]
s_add_u32 m0, s42, 49152
s_nop 0
buffer_load_dwordx4 v6, s[48:51], s26 offen offset:0 lds
ds_read_b64_tr_b16 v[160:161], v28 offset:49152
ds_read_b64_tr_b16 v[162:163], v28 offset:51200
M a[0:3], v[100:103], a[228:231], a[0:3]
buffer_load_dwordx4 v7, s[48:51], s26 offen offset:1024 lds
M a[4:7], v[108:111], a[228:231], a[4:7]
ds_read_b64_tr_b16 v[164:165], v28 offset:53248
ds_read_b64_tr_b16 v[166:167], v28 offset:55296
M a[4:7], v[104:107], a[224:227], a[4:7]
buffer_load_dwordx4 a[176:179], v1, s[44:47], s25 offen offset:0 sc1
M a[8:11], v[112:115], a[224:227], a[8:11]
ds_read_b64_tr_b16 v[168:169], v29 offset:49152
ds_read_b64_tr_b16 v[170:171], v29 offset:51200
M a[8:11], v[116:119], a[228:231], a[8:11]
buffer_load_dwordx4 a[180:183], v1, s[44:47], s25 offen offset:1024 sc1
M a[12:15], v[124:127], a[228:231], a[12:15]
ds_read_b64_tr_b16 v[172:173], v29 offset:53248
ds_read_b64_tr_b16 v[174:175], v29 offset:55296
M a[12:15], v[120:123], a[224:227], a[12:15]
buffer_load_dwordx4 a[184:187], v1, s[44:47], s25 offen offset:2048 sc1
ds_read_b64_tr_b16 v[176:177], v30 offset:49152
ds_read_b64_tr_b16 v[178:179], v30 offset:51200
M a[16:19], v[96:99], a[232:235], a[16:19]
buffer_load_dwordx4 a[188:191], v1, s[44:47], s25 offen offset:3072 sc1
M a[16:19], v[100:103], a[236:239], a[16:19]
ds_read_b64_tr_b16 v[180:181], v30 offset:53248
ds_read_b64_tr_b16 v[182:183], v30 offset:55296
M a[20:23], v[108:111], a[236:239], a[20:23]
s_add_u32 s25, s25, 16384
s_add_u32 s26, s26, 131072
M a[20:23], v[104:107], a[232:235], a[20:23]
ds_read_b64_tr_b16 v[184:185], v31 offset:49152
ds_read_b64_tr_b16 v[186:187], v31 offset:51200
M a[24:27], v[112:115], a[232:235], a[24:27]
buffer_load_dword v252, v255, s[52:55], s62 offen sc1
M a[24:27], v[116:119], a[236:239], a[24:27]
ds_read_b64_tr_b16 v[188:189], v31 offset:53248
ds_read_b64_tr_b16 v[190:191], v31 offset:55296
M a[28:31], v[124:127], a[236:239], a[28:31]
M a[28:31], v[120:123], a[232:235], a[28:31]
s_waitcnt vmcnt(30) lgkmcnt(0)
s_barrier
s_waitcnt vmcnt(0)
v_cmp_ne_u32 vcc, 1, v252
s_nop 0
s_cbranch_vccnz Lk3_spinft
Lk3_gotft:
M a[0:3], v[160:163], a[240:243], a[0:3]
s_mov_b32 s32, s25
s_mov_b32 s33, s26
s_mov_b64 s[34:35], s[44:45]
s_mov_b64 s[36:37], s[48:49]
s_mov_b64 s[44:45], s[8:9]
s_mov_b32 s46, 16777216
s_mov_b64 s[48:49], s[10:11]
s_mov_b32 s50, 8388608
s_mov_b32 s25, s12
s_mov_b32 s26, s13
s_add_u32 m0, s41, 65536
s_nop 0
buffer_load_dwordx4 v2, s[48:51], s26 offen offset:0 lds
ds_read_b64_tr_b16 v[96:97], v24 offset:0
ds_read_b64_tr_b16 v[98:99], v24 offset:2048
M a[0:3], v[164:167], a[244:247], a[0:3]
buffer_load_dwordx4 v3, s[48:51], s26 offen offset:1024 lds
M a[4:7], v[172:175], a[244:247], a[4:7]
ds_read_b64_tr_b16 v[100:101], v24 offset:4096
ds_read_b64_tr_b16 v[102:103], v24 offset:6144
M a[4:7], v[168:171], a[240:243], a[4:7]
buffer_load_dwordx4 v4, s[48:51], s26 offen offset:2048 lds
ds_read_b64_tr_b16 v[104:105], v25 offset:0
ds_read_b64_tr_b16 v[106:107], v25 offset:2048
M a[8:11], v[176:179], a[240:243], a[8:11]
buffer_load_dwordx4 v5, s[48:51], s26 offen offset:3072 lds
M a[8:11], v[180:183], a[244:247], a[8:11]
ds_read_b64_tr_b16 v[108:109], v25 offset:4096
ds_read_b64_tr_b16 v[110:111], v25 offset:6144
M a[12:15], v[188:191], a[244:247], a[12:15]
buffer_load_dwordx4 a[192:195], v1, s[44:47], s25 offen offset:0 sc1
M a[12:15], v[184:187], a[240:243], a[12:15]
ds_read_b64_tr_b16 v[112:113], v26 offset:0
ds_read_b64_tr_b16 v[114:115], v26 offset:2048
buffer_load_dwordx4 a[196:199], v1, s[44:47], s25 offen offset:1024 sc1
M a[16:19], v[160:163], a[248:251], a[16:19]
ds_read_b64_tr_b16 v[116:117], v26 offset:4096
ds_read_b64_tr_b16 v[118:119], v26 offset:6144
M a[16:19], v[164:167], a[252:255], a[16:19]
buffer_load_dwordx4 a[200:203], v1, s[44:47], s25 offen offset:2048 sc1
M a[20:23], v[172:175], a[252:255], a[20:23]
ds_read_b64_tr_b16 v[120:121], v27 offset:0
ds_read_b64_tr_b16 v[122:123], v27 offset:2048
buffer_load_dwordx4 a[204:207], v1, s[44:47], s25 offen offset:3072 sc1
M a[20:23], v[168:171], a[248:251], a[20:23]
ds_read_b64_tr_b16 v[124:125], v27 offset:4096
ds_read_b64_tr_b16 v[126:127], v27 offset:6144
M a[24:27], v[176:179], a[248:251], a[24:27]
s_sub_u32 s39, s39, 1
s_cmp_eq_u32 s39, 0
s_cselect_b32 s3, s64, s65
M a[24:27], v[180:183], a[252:255], a[24:27]
s_add_u32 s25, s25, s3
s_lshl_b32 s3, s3, 3
s_add_u32 s26, s26, s3
M a[28:31], v[188:191], a[252:255], a[28:31]
M a[28:31], v[184:187], a[248:251], a[28:31]
s_waitcnt vmcnt(24) lgkmcnt(0)
s_barrier
M a[0:3], v[96:99], a[128:131], a[0:3]
s_add_u32 m0, s41, 81920
s_nop 0
buffer_load_dwordx4 v2, s[48:51], s26 offen offset:0 lds
ds_read_b64_tr_b16 v[160:161], v24 offset:16384
ds_read_b64_tr_b16 v[162:163], v24 offset:18432
M a[0:3], v[100:103], a[132:135], a[0:3]
buffer_load_dwordx4 v3, s[48:51], s26 offen offset:1024 lds
M a[4:7], v[108:111], a[132:135], a[4:7]
ds_read_b64_tr_b16 v[164:165], v24 offset:20480
ds_read_b64_tr_b16 v[166:167], v24 offset:22528
M a[4:7], v[104:107], a[128:131], a[4:7]
buffer_load_dwordx4 v4, s[48:51], s26 offen offset:2048 lds
ds_read_b64_tr_b16 v[168:169], v25 offset:16384
ds_read_b64_tr_b16 v[170:171], v25 offset:18432
M a[8:11], v[112:115], a[128:131], a[8:11]
buffer_load_dwordx4 v5, s[48:51], s26 offen offset:3072 lds
M a[8:11], v[116:119], a[132:135], a[8:11]
ds_read_b64_tr_b16 v[172:173], v25 offset:20480
ds_read_b64_tr_b16 v[174:175], v25 offset:22528
M a[12:15], v[124:127], a[132:135], a[12:15]
buffer_load_dwordx4 a[208:211], v1, s[44:47], s25 offen offset:0 sc1
M a[12:15], v[120:123], a[128:131], a[12:15]
ds_read_b64_tr_b16 v[176:177], v26 offset:16384
ds_read_b64_tr_b16 v[178:179], v26 offset:18432
buffer_load_dwordx4 a[212:215], v1, s[44:47], s25 offen offset:1024 sc1
M a[16:19], v[96:99], a[136:139], a[16:19]
ds_read_b64_tr_b16 v[180:181], v26 offset:20480
ds_read_b64_tr_b16 v[182:183], v26 offset:22528
M a[16:19], v[100:103], a[140:143], a[16:19]
buffer_load_dwordx4 a[216:219], v1, s[44:47], s25 offen offset:2048 sc1
M a[20:23], v[108:111], a[140:143], a[20:23]
ds_read_b64_tr_b16 v[184:185], v27 offset:16384
ds_read_b64_tr_b16 v[186:187], v27 offset:18432
buffer_load_dwordx4 a[220:223], v1, s[44:47], s25 offen offset:3072 sc1
M a[20:23], v[104:107], a[136:139], a[20:23]
ds_read_b64_tr_b16 v[188:189], v27 offset:20480
ds_read_b64_tr_b16 v[190:191], v27 offset:22528
M a[24:27], v[112:115], a[136:139], a[24:27]
s_sub_u32 s39, s39, 1
s_cmp_eq_u32 s39, 0
s_cselect_b32 s3, s64, s65
M a[24:27], v[116:119], a[140:143], a[24:27]
s_add_u32 s25, s25, s3
s_lshl_b32 s3, s3, 3
s_add_u32 s26, s26, s3
M a[28:31], v[124:127], a[140:143], a[28:31]
M a[28:31], v[120:123], a[136:139], a[28:31]
s_waitcnt vmcnt(23) lgkmcnt(0)
s_barrier
M a[0:3], v[160:163], a[144:147], a[0:3]
s_add_u32 m0, s41, 98304
s_nop 0
buffer_load_dwordx4 v2, s[48:51], s26 offen offset:0 lds
ds_read_b64_tr_b16 v[96:97], v24 offset:32768
ds_read_b64_tr_b16 v[98:99], v24 offset:34816
M a[0:3], v[164:167], a[148:151], a[0:3]
buffer_load_dwordx4 v3, s[48:51], s26 offen offset:1024 lds
M a[4:7], v[172:175], a[148:151], a[4:7]
ds_read_b64_tr_b16 v[100:101], v24 offset:36864
ds_read_b64_tr_b16 v[102:103], v24 offset:38912
M a[4:7], v[168:171], a[144:147], a[4:7]
buffer_load_dwordx4 v4, s[48:51], s26 offen offset:2048 lds
ds_read_b64_tr_b16 v[104:105], v25 offset:32768
ds_read_b64_tr_b16 v[106:107], v25 offset:34816
M a[8:11], v[176:179], a[144:147], a[8:11]
buffer_load_dwordx4 v5, s[48:51], s26 offen offset:3072 lds
M a[8:11], v[180:183], a[148:151], a[8:11]
ds_read_b64_tr_b16 v[108:109], v25 offset:36864
ds_read_b64_tr_b16 v[110:111], v25 offset:38912
M a[12:15], v[188:191], a[148:151], a[12:15]
buffer_load_dwordx4 a[224:227], v1, s[44:47], s25 offen offset:0 sc1
M a[12:15], v[184:187], a[144:147], a[12:15]
ds_read_b64_tr_b16 v[112:113], v26 offset:32768
ds_read_b64_tr_b16 v[114:115], v26 offset:34816
buffer_load_dwordx4 a[228:231], v1, s[44:47], s25 offen offset:1024 sc1
M a[16:19], v[160:163], a[152:155], a[16:19]
ds_read_b64_tr_b16 v[116:117], v26 offset:36864
ds_read_b64_tr_b16 v[118:119], v26 offset:38912
M a[16:19], v[164:167], a[156:159], a[16:19]
buffer_load_dwordx4 a[232:235], v1, s[44:47], s25 offen offset:2048 sc1
M a[20:23], v[172:175], a[156:159], a[20:23]
ds_read_b64_tr_b16 v[120:121], v27 offset:32768
ds_read_b64_tr_b16 v[122:123], v27 offset:34816
buffer_load_dwordx4 a[236:239], v1, s[44:47], s25 offen offset:3072 sc1
M a[20:23], v[168:171], a[152:155], a[20:23]
ds_read_b64_tr_b16 v[124:125], v27 offset:36864
ds_read_b64_tr_b16 v[126:127], v27 offset:38912
M a[24:27], v[176:179], a[152:155], a[24:27]
s_sub_u32 s39, s39, 1
s_cmp_eq_u32 s39, 0
s_cselect_b32 s3, s64, s65
M a[24:27], v[180:183], a[156:159], a[24:27]
s_add_u32 s25, s25, s3
s_lshl_b32 s3, s3, 3
s_add_u32 s26, s26, s3
M a[28:31], v[188:191], a[156:159], a[28:31]
M a[28:31], v[184:187], a[152:155], a[28:31]
s_waitcnt vmcnt(25) lgkmcnt(0)
s_barrier
M a[0:3], v[96:99], a[160:163], a[0:3]
s_add_u32 m0, s41, 114688
s_nop 0
buffer_load_dwordx4 v2, s[48:51], s26 offen offset:0 lds
ds_read_b64_tr_b16 v[160:161], v24 offset:49152
ds_read_b64_tr_b16 v[162:163], v24 offset:51200
M a[0:3], v[100:103], a[164:167], a[0:3]
buffer_load_dwordx4 v3, s[48:51], s26 offen offset:1024 lds
M a[4:7], v[108:111], a[164:167], a[4:7]
ds_read_b64_tr_b16 v[164:165], v24 offset:53248
ds_read_b64_tr_b16 v[166:167], v24 offset:55296
M a[4:7], v[104:107], a[160:163], a[4:7]
buffer_load_dwordx4 v4, s[48:51], s26 offen offset:2048 lds
ds_read_b64_tr_b16 v[168:169], v25 offset:49152
ds_read_b64_tr_b16 v[170:171], v25 offset:51200
M a[8:11], v[112:115], a[160:163], a[8:11]
buffer_load_dwordx4 v5, s[48:51], s26 offen offset:3072 lds
M a[8:11], v[116:119], a[164:167], a[8:11]
ds_read_b64_tr_b16 v[172:173], v25 offset:53248
ds_read_b64_tr_b16 v[174:175], v25 offset:55296
M a[12:15], v[124:127], a[164:167], a[12:15]
buffer_load_dwordx4 a[240:243], v1, s[44:47], s25 offen offset:0 sc1
M a[12:15], v[120:123], a[160:163], a[12:15]
ds_read_b64_tr_b16 v[176:177], v26 offset:49152
ds_read_b64_tr_b16 v[178:179], v26 offset:51200
buffer_load_dwordx4 a[244:247], v1, s[44:47], s25 offen offset:1024 sc1
M a[16:19], v[96:99], a[168:171], a[16:19]
ds_read_b64_tr_b16 v[180:181], v26 offset:53248
ds_read_b64_tr_b16 v[182:183], v26 offset:55296
M a[16:19], v[100:103], a[172:175], a[16:19]
buffer_load_dwordx4 a[248:251], v1, s[44:47], s25 offen offset:2048 sc1
M a[20:23], v[108:111], a[172:175], a[20:23]
ds_read_b64_tr_b16 v[184:185], v27 offset:49152
ds_read_b64_tr_b16 v[186:187], v27 offset:51200
buffer_load_dwordx4 a[252:255], v1, s[44:47], s25 offen offset:3072 sc1
M a[20:23], v[104:107], a[168:171], a[20:23]
ds_read_b64_tr_b16 v[188:189], v27 offset:53248
ds_read_b64_tr_b16 v[190:191], v27 offset:55296
M a[24:27], v[112:115], a[168:171], a[24:27]
s_sub_u32 s39, s39, 1
s_cmp_eq_u32 s39, 0
s_cselect_b32 s3, s64, s65
M a[24:27], v[116:119], a[172:175], a[24:27]
s_add_u32 s25, s25, s3
s_lshl_b32 s3, s3, 3
s_add_u32 s26, s26, s3
M a[28:31], v[124:127], a[172:175], a[28:31]
M a[28:31], v[120:123], a[168:171], a[28:31]
s_waitcnt vmcnt(24) lgkmcnt(0)
s_barrier
M a[0:3], v[160:163], a[176:179], a[0:3]
s_add_u32 m0, s41, 0
s_nop 0
buffer_load_dwordx4 v2, s[48:51], s26 offen offset:0 lds
ds_read_b64_tr_b16 v[96:97], v16 offset:0
ds_read_b64_tr_b16 v[98:99], v16 offset:4096
M a[0:3], v[164:167], a[180:183], a[0:3]
buffer_load_dwordx4 v3, s[48:51], s26 offen offset:1024 lds
ds_read_b64_tr_b16 v[100:101], v16 offset:8192
ds_read_b64_tr_b16 v[102:103], v16 offset:12288
M a[4:7], v[172:175], a[180:183], a[4:7]
buffer_load_dwordx4 v4, s[48:51], s26 offen offset:2048 lds
ds_read_b64_tr_b16 v[104:105], v17 offset:0
ds_read_b64_tr_b16 v[106:107], v17 offset:4096
M a[4:7], v[168:171], a[176:179], a[4:7]
buffer_load_dwordx4 v5, s[48:51], s26 offen offset:3072 lds
ds_read_b64_tr_b16 v[108:109], v17 offset:8192
ds_read_b64_tr_b16 v[110:111], v17 offset:12288
M a[8:11], v[176:179], a[176:179], a[8:11]
buffer_load_dwordx4 a[128:131], v1, s[44:47], s25 offen offset:0 sc1
ds_read_b64_tr_b16 v[112:113], v18 offset:0
ds_read_b64_tr_b16 v[114:115], v18 offset:4096
M a[8:11], v[180:183], a[180:183], a[8:11]
buffer_load_dwordx4 a[132:135], v1, s[44:47], s25 offen offset:1024 sc1
ds_read_b64_tr_b16 v[116:117], v18 offset:8192
ds_read_b64_tr_b16 v[118:119], v18 offset:12288
M a[12:15], v[188:191], a[180:183], a[12:15]
buffer_load_dwordx4 a[136:139], v1, s[44:47], s25 offen offset:2048 sc1
M a[12:15], v[184:187], a[176:179], a[12:15]
ds_read_b64_tr_b16 v[120:121], v19 offset:0
ds_read_b64_tr_b16 v[122:123], v19 offset:4096
buffer_load_dwordx4 a[140:143], v1, s[44:47], s25 offen offset:3072 sc1
M a[16:19], v[160:163], a[184:187], a[16:19]
ds_read_b64_tr_b16 v[124:125], v19 offset:8192
ds_read_b64_tr_b16 v[126:127], v19 offset:12288
s_sub_u32 s39, s39, 1
s_cmp_eq_u32 s39, 0
s_cselect_b32 s3, s64, s65
M a[16:19], v[164:167], a[188:191], a[16:19]
ds_read_b64_tr_b16 v[128:129], v20 offset:0
ds_read_b64_tr_b16 v[130:131], v20 offset:4096
s_add_u32 s25, s25, s3
s_lshl_b32 s3, s3, 3
s_add_u32 s26, s26, s3
M a[20:23], v[172:175], a[188:191], a[20:23]
ds_read_b64_tr_b16 v[132:133], v20 offset:8192
ds_read_b64_tr_b16 v[134:135], v20 offset:12288
ds_read_b64_tr_b16 v[136:137], v21 offset:0
ds_read_b64_tr_b16 v[138:139], v21 offset:4096
M a[20:23], v[168:171], a[184:187], a[20:23]
ds_read_b64_tr_b16 v[140:141], v21 offset:8192
ds_read_b64_tr_b16 v[142:143], v21 offset:12288
ds_read_b64_tr_b16 v[144:145], v22 offset:0
ds_read_b64_tr_b16 v[146:147], v22 offset:4096
M a[24:27], v[176:179], a[184:187], a[24:27]
ds_read_b64_tr_b16 v[148:149], v22 offset:8192
ds_read_b64_tr_b16 v[150:151], v22 offset:12288
ds_read_b64_tr_b16 v[152:153], v23 offset:0
ds_read_b64_tr_b16 v[154:155], v23 offset:4096
M a[24:27], v[180:183], a[188:191], a[24:27]
ds_read_b64_tr_b16 v[156:157], v23 offset:8192
ds_read_b64_tr_b16 v[158:159], v23 offset:12288
M a[28:31], v[188:191], a[188:191], a[28:31]
M a[28:31], v[184:187], a[184:187], a[28:31]
s_waitcnt vmcnt(24) lgkmcnt(0)
s_barrier
M v[32:35], v[96:99], a[192:195], 0
s_add_u32 m0, s41, 16384
s_nop 0
buffer_load_dwordx4 v2, s[48:51], s26 offen offset:0 lds
M v[32:35], v[100:103], a[196:199], v[32:35]
ds_read_b64_tr_b16 v[160:161], v16 offset:16384
ds_read_b64_tr_b16 v[162:163], v16 offset:20480
M v[36:39], v[108:111], a[196:199], 0
buffer_load_dwordx4 v3, s[48:51], s26 offen offset:1024 lds
M v[36:39], v[104:107], a[192:195], v[36:39]
ds_read_b64_tr_b16 v[164:165], v16 offset:24576
ds_read_b64_tr_b16 v[166:167], v16 offset:28672
M v[40:43], v[112:115], a[192:195], 0
buffer_load_dwordx4 v4, s[48:51], s26 offen offset:2048 lds
M v[40:43], v[116:119], a[196:199], v[40:43]
ds_read_b64_tr_b16 v[168:169], v17 offset:16384
ds_read_b64_tr_b16 v[170:171], v17 offset:20480
M v[44:47], v[124:127], a[196:199], 0
buffer_load_dwordx4 v5, s[48:51], s26 offen offset:3072 lds
M v[44:47], v[120:123], a[192:195], v[44:47]
M v[48:51], v[128:131], a[192:195], 0
ds_read_b64_tr_b16 v[172:173], v17 offset:24576
ds_read_b64_tr_b16 v[174:175], v17 offset:28672
M v[48:51], v[132:135], a[196:199], v[48:51]
buffer_load_dwordx4 a[144:147], v1, s[44:47], s25 offen offset:0 sc1
M v[52:55], v[140:143], a[196:199], 0
ds_read_b64_tr_b16 v[176:177], v18 offset:16384
ds_read_b64_tr_b16 v[178:179], v18 offset:20480
M v[52:55], v[136:139], a[192:195], v[52:55]
buffer_load_dwordx4 a[148:151], v1, s[44:47], s25 offen offset:1024 sc1
M v[56:59], v[144:147], a[192:195], 0
ds_read_b64_tr_b16 v[180:181], v18 offset:24576
ds_read_b64_tr_b16 v[182:183], v18 offset:28672
M v[56:59], v[148:151], a[196:199], v[56:59]
buffer_load_dwordx4 a[152:155], v1, s[44:47], s25 offen offset:2048 sc1
M v[60:63], v[156:159], a[196:199], 0
M v[60:63], v[152:155], a[192:195], v[60:63]
ds_read_b64_tr_b16 v[184:185], v19 offset:16384
ds_read_b64_tr_b16 v[186:187], v19 offset:20480
M v[64:67], v[96:99], a[200:203], 0
buffer_load_dwordx4 a[156:159], v1, s[44:47], s25 offen offset:3072 sc1
M v[64:67], v[100:103], a[204:207], v[64:67]
ds_read_b64_tr_b16 v[188:189], v19 offset:24576
ds_read_b64_tr_b16 v[190:191], v19 offset:28672
M v[68:71], v[108:111], a[204:207], 0
s_sub_u32 s39, s39, 1
s_cmp_eq_u32 s39, 0
s_cselect_b32 s3, s64, s65
M v[68:71], v[104:107], a[200:203], v[68:71]
ds_read_b64_tr_b16 v[192:193], v20 offset:16384
ds_read_b64_tr_b16 v[194:195], v20 offset:20480
M v[72:75], v[112:115], a[200:203], 0
s_add_u32 s25, s25, s3
s_lshl_b32 s3, s3, 3
s_add_u32 s26, s26, s3
M v[72:75], v[116:119], a[204:207], v[72:75]
ds_read_b64_tr_b16 v[196:197], v20 offset:24576
ds_read_b64_tr_b16 v[198:199], v20 offset:28672
M v[76:79], v[124:127], a[204:207], 0
M v[76:79], v[120:123], a[200:203], v[76:79]
ds_read_b64_tr_b16 v[200:201], v21 offset:16384
ds_read_b64_tr_b16 v[202:203], v21 offset:20480
M v[80:83], v[128:131], a[200:203], 0
ds_read_b64_tr_b16 v[204:205], v21 offset:24576
ds_read_b64_tr_b16 v[206:207], v21 offset:28672
M v[80:83], v[132:135], a[204:207], v[80:83]
ds_read_b64_tr_b16 v[208:209], v22 offset:16384
ds_read_b64_tr_b16 v[210:211], v22 offset:20480
M v[84:87], v[140:143], a[204:207], 0
ds_read_b64_tr_b16 v[212:213], v22 offset:24576
ds_read_b64_tr_b16 v[214:215], v22 offset:28672
M v[84:87], v[136:139], a[200:203], v[84:87]
ds_read_b64_tr_b16 v[216:217], v23 offset:16384
ds_read_b64_tr_b16 v[218:219], v23 offset:20480
M v[88:91], v[144:147], a[200:203], 0
ds_read_b64_tr_b16 v[220:221], v23 offset:24576
ds_read_b64_tr_b16 v[222:223], v23 offset:28672
M v[88:91], v[148:151], a[204:207], v[88:91]
M v[92:95], v[156:159], a[204:207], 0
M v[92:95], v[152:155], a[200:203], v[92:95]
s_mov_b32 s28, 3
Lk3_la:
s_waitcnt vmcnt(24) lgkmcnt(0)
s_barrier
M v[32:35], v[160:163], a[208:211], v[32:35]
s_add_u32 m0, s41, 32768
s_nop 0
buffer_load_dwordx4 v2, s[48:51], s26 offen offset:0 lds
M v[32:35], v[164:167], a[212:215], v[32:35]
ds_read_b64_tr_b16 v[96:97], v16 offset:32768
ds_read_b64_tr_b16 v[98:99], v16 offset:36864
M v[36:39], v[172:175], a[212:215], v[36:39]
buffer_load_dwordx4 v3, s[48:51], s26 offen offset:1024 lds
M v[36:39], v[168:171], a[208:211], v[36:39]
ds_read_b64_tr_b16 v[100:101], v16 offset:40960
ds_read_b64_tr_b16 v[102:103], v16 offset:45056
M v[40:43], v[176:179], a[208:211], v[40:43]
buffer_load_dwordx4 v4, s[48:51], s26 offen offset:2048 lds
M v[40:43], v[180:183], a[212:215], v[40:43]
ds_read_b64_tr_b16 v[104:105], v17 offset:32768
ds_read_b64_tr_b16 v[106:107], v17 offset:36864
M v[44:47], v[188:191], a[212:215], v[44:47]
buffer_load_dwordx4 v5, s[48:51], s26 offen offset:3072 lds
M v[44:47], v[184:187], a[208:211], v[44:47]
M v[48:51], v[192:195], a[208:211], v[48:51]
ds_read_b64_tr_b16 v[108:109], v17 offset:40960
ds_read_b64_tr_b16 v[110:111], v17 offset:45056
M v[48:51], v[196:199], a[212:215], v[48:51]
buffer_load_dwordx4 a[160:163], v1, s[44:47], s25 offen offset:0 sc1
M v[52:55], v[204:207], a[212:215], v[52:55]
ds_read_b64_tr_b16 v[112:113], v18 offset:32768
ds_read_b64_tr_b16 v[114:115], v18 offset:36864
M v[52:55], v[200:203], a[208:211], v[52:55]
buffer_load_dwordx4 a[164:167], v1, s[44:47], s25 offen offset:1024 sc1
M v[56:59], v[208:211], a[208:211], v[56:59]
ds_read_b64_tr_b16 v[116:117], v18 offset:40960
ds_read_b64_tr_b16 v[118:119], v18 offset:45056
M v[56:59], v[212:215], a[212:215], v[56:59]
buffer_load_dwordx4 a[168:171], v1, s[44:47], s25 offen offset:2048 sc1
M v[60:63], v[220:223], a[212:215], v[60:63]
M v[60:63], v[216:219], a[208:211], v[60:63]
ds_read_b64_tr_b16 v[120:121], v19 offset:32768
ds_read_b64_tr_b16 v[122:123], v19 offset:36864
M v[64:67], v[160:163], a[216:219], v[64:67]
buffer_load_dwordx4 a[172:175], v1, s[44:47], s25 offen offset:3072 sc1
M v[64:67], v[164:167], a[220:223], v[64:67]
ds_read_b64_tr_b16 v[124:125], v19 offset:40960
ds_read_b64_tr_b16 v[126:127], v19 offset:45056
M v[68:71], v[172:175], a[220:223], v[68:71]
s_sub_u32 s39, s39, 1
s_cmp_eq_u32 s39, 0
s_cselect_b32 s3, s64, s65
M v[68:71], v[168:171], a[216:219], v[68:71]
ds_read_b64_tr_b16 v[128:129], v20 offset:32768
ds_read_b64_tr_b16 v[130:131], v20 offset:36864
M v[72:75], v[176:179], a[216:219], v[72:75]
s_add_u32 s25, s25, s3
s_lshl_b32 s3, s3, 3
s_add_u32 s26, s26, s3
M v[72:75], v[180:183], a[220:223], v[72:75]
ds_read_b64_tr_b16 v[132:133], v20 offset:40960
ds_read_b64_tr_b16 v[134:135], v20 offset:45056
M v[76:79], v[188:191], a[220:223], v[76:79]
M v[76:79], v[184:187], a[216:219], v[76:79]
ds_read_b64_tr_b16 v[136:137], v21 offset:32768
ds_read_b64_tr_b16 v[138:139], v21 offset:36864
M v[80:83], v[192:195], a[216:219], v[80:83]
ds_read_b64_tr_b16 v[140:141], v21 offset:40960
ds_read_b64_tr_b16 v[142:143], v21 offset:45056
M v[80:83], v[196:199], a[220:223], v[80:83]
ds_read_b64_tr_b16 v[144:145], v22 offset:32768
ds_read_b64_tr_b16 v[146:147], v22 offset:36864
M v[84:87], v[204:207], a[220:223], v[84:87]
ds_read_b64_tr_b16 v[148:149], v22 offset:40960
ds_read_b64_tr_b16 v[150:151], v22 offset:45056
M v[84:87], v[200:203], a[216:219], v[84:87]
ds_read_b64_tr_b16 v[152:153], v23 offset:32768
ds_read_b64_tr_b16 v[154:155], v23 offset:36864
M v[88:91], v[208:211], a[216:219], v[88:91]
ds_read_b64_tr_b16 v[156:157], v23 offset:40960
ds_read_b64_tr_b16 v[158:159], v23 offset:45056
M v[88:91], v[212:215], a[220:223], v[88:91]
M v[92:95], v[220:223], a[220:223], v[92:95]
M v[92:95], v[216:219], a[216:219], v[92:95]
s_waitcnt vmcnt(24) lgkmcnt(0)
s_barrier
M v[32:35], v[96:99], a[224:227], v[32:35]
s_add_u32 m0, s41, 49152
s_nop 0
buffer_load_dwordx4 v2, s[48:51], s26 offen offset:0 lds
M v[32:35], v[100:103], a[228:231], v[32:35]
ds_read_b64_tr_b16 v[160:161], v16 offset:49152
ds_read_b64_tr_b16 v[162:163], v16 offset:53248
M v[36:39], v[108:111], a[228:231], v[36:39]
buffer_load_dwordx4 v3, s[48:51], s26 offen offset:1024 lds
M v[36:39], v[104:107], a[224:227], v[36:39]
ds_read_b64_tr_b16 v[164:165], v16 offset:57344
ds_read_b64_tr_b16 v[166:167], v16 offset:61440
M v[40:43], v[112:115], a[224:227], v[40:43]
buffer_load_dwordx4 v4, s[48:51], s26 offen offset:2048 lds
M v[40:43], v[116:119], a[228:231], v[40:43]
ds_read_b64_tr_b16 v[168:169], v17 offset:49152
ds_read_b64_tr_b16 v[170:171], v17 offset:53248
M v[44:47], v[124:127], a[228:231], v[44:47]
buffer_load_dwordx4 v5, s[48:51], s26 offen offset:3072 lds
M v[44:47], v[120:123], a[224:227], v[44:47]
M v[48:51], v[128:131], a[224:227], v[48:51]
ds_read_b64_tr_b16 v[172:173], v17 offset:57344
ds_read_b64_tr_b16 v[174:175], v17 offset:61440
M v[48:51], v[132:135], a[228:231], v[48:51]
buffer_load_dwordx4 a[176:179], v1, s[44:47], s25 offen offset:0 sc1
M v[52:55], v[140:143], a[228:231], v[52:55]
ds_read_b64_tr_b16 v[176:177], v18 offset:49152
ds_read_b64_tr_b16 v[178:179], v18 offset:53248
M v[52:55], v[136:139], a[224:227], v[52:55]
buffer_load_dwordx4 a[180:183], v1, s[44:47], s25 offen offset:1024 sc1
M v[56:59], v[144:147], a[224:227], v[56:59]
ds_read_b64_tr_b16 v[180:181], v18 offset:57344
ds_read_b64_tr_b16 v[182:183], v18 offset:61440
M v[56:59], v[148:151], a[228:231], v[56:59]
buffer_load_dwordx4 a[184:187], v1, s[44:47], s25 offen offset:2048 sc1
M v[60:63], v[156:159], a[228:231], v[60:63]
M v[60:63], v[152:155], a[224:227], v[60:63]
ds_read_b64_tr_b16 v[184:185], v19 offset:49152
ds_read_b64_tr_b16 v[186:187], v19 offset:53248
M v[64:67], v[96:99], a[232:235], v[64:67]
buffer_load_dwordx4 a[188:191], v1, s[44:47], s25 offen offset:3072 sc1
M v[64:67], v[100:103], a[236:239], v[64:67]
ds_read_b64_tr_b16 v[188:189], v19 offset:57344
ds_read_b64_tr_b16 v[190:191], v19 offset:61440
M v[68:71], v[108:111], a[236:239], v[68:71]
s_sub_u32 s39, s39, 1
s_cmp_eq_u32 s39, 0
s_cselect_b32 s3, s64, s65
M v[68:71], v[104:107], a[232:235], v[68:71]
ds_read_b64_tr_b16 v[192:193], v20 offset:49152
ds_read_b64_tr_b16 v[194:195], v20 offset:53248
M v[72:75], v[112:115], a[232:235], v[72:75]
s_add_u32 s25, s25, s3
s_lshl_b32 s3, s3, 3
s_add_u32 s26, s26, s3
M v[72:75], v[116:119], a[236:239], v[72:75]
ds_read_b64_tr_b16 v[196:197], v20 offset:57344
ds_read_b64_tr_b16 v[198:199], v20 offset:61440
M v[76:79], v[124:127], a[236:239], v[76:79]
M v[76:79], v[120:123], a[232:235], v[76:79]
ds_read_b64_tr_b16 v[200:201], v21 offset:49152
ds_read_b64_tr_b16 v[202:203], v21 offset:53248
M v[80:83], v[128:131], a[232:235], v[80:83]
ds_read_b64_tr_b16 v[204:205], v21 offset:57344
ds_read_b64_tr_b16 v[206:207], v21 offset:61440
M v[80:83], v[132:135], a[236:239], v[80:83]
ds_read_b64_tr_b16 v[208:209], v22 offset:49152
ds_read_b64_tr_b16 v[210:211], v22 offset:53248
M v[84:87], v[140:143], a[236:239], v[84:87]
ds_read_b64_tr_b16 v[212:213], v22 offset:57344
ds_read_b64_tr_b16 v[214:215], v22 offset:61440
M v[84:87], v[136:139], a[232:235], v[84:87]
ds_read_b64_tr_b16 v[216:217], v23 offset:49152
ds_read_b64_tr_b16 v[218:219], v23 offset:53248
M v[88:91], v[144:147], a[232:235], v[88:91]
ds_read_b64_tr_b16 v[220:221], v23 offset:57344
ds_read_b64_tr_b16 v[222:223], v23 offset:61440
M v[88:91], v[148:151], a[236:239], v[88:91]
M v[92:95], v[156:159], a[236:239], v[92:95]
M v[92:95], v[152:155], a[232:235], v[92:95]
s_waitcnt vmcnt(24) lgkmcnt(0)
s_barrier
M v[32:35], v[160:163], a[240:243], v[32:35]
s_add_u32 m0, s41, 65536
s_nop 0
buffer_load_dwordx4 v2, s[48:51], s26 offen offset:0 lds
M v[32:35], v[164:167], a[244:247], v[32:35]
ds_read_b64_tr_b16 v[96:97], v8 offset:0
ds_read_b64_tr_b16 v[98:99], v8 offset:4096
M v[36:39], v[172:175], a[244:247], v[36:39]
buffer_load_dwordx4 v3, s[48:51], s26 offen offset:1024 lds
M v[36:39], v[168:171], a[240:243], v[36:39]
ds_read_b64_tr_b16 v[100:101], v8 offset:8192
ds_read_b64_tr_b16 v[102:103], v8 offset:12288
M v[40:43], v[176:179], a[240:243], v[40:43]
buffer_load_dwordx4 v4, s[48:51], s26 offen offset:2048 lds
M v[40:43], v[180:183], a[244:247], v[40:43]
ds_read_b64_tr_b16 v[104:105], v9 offset:0
ds_read_b64_tr_b16 v[106:107], v9 offset:4096
M v[44:47], v[188:191], a[244:247], v[44:47]
buffer_load_dwordx4 v5, s[48:51], s26 offen offset:3072 lds
M v[44:47], v[184:187], a[240:243], v[44:47]
M v[48:51], v[192:195], a[240:243], v[48:51]
ds_read_b64_tr_b16 v[108:109], v9 offset:8192
ds_read_b64_tr_b16 v[110:111], v9 offset:12288
M v[48:51], v[196:199], a[244:247], v[48:51]
buffer_load_dwordx4 a[192:195], v1, s[44:47], s25 offen offset:0 sc1
M v[52:55], v[204:207], a[244:247], v[52:55]
ds_read_b64_tr_b16 v[112:113], v10 offset:0
ds_read_b64_tr_b16 v[114:115], v10 offset:4096
M v[52:55], v[200:203], a[240:243], v[52:55]
buffer_load_dwordx4 a[196:199], v1, s[44:47], s25 offen offset:1024 sc1
M v[56:59], v[208:211], a[240:243], v[56:59]
ds_read_b64_tr_b16 v[116:117], v10 offset:8192
ds_read_b64_tr_b16 v[118:119], v10 offset:12288
M v[56:59], v[212:215], a[244:247], v[56:59]
buffer_load_dwordx4 a[200:203], v1, s[44:47], s25 offen offset:2048 sc1
M v[60:63], v[220:223], a[244:247], v[60:63]
M v[60:63], v[216:219], a[240:243], v[60:63]
ds_read_b64_tr_b16 v[120:121], v11 offset:0
ds_read_b64_tr_b16 v[122:123], v11 offset:4096
M v[64:67], v[160:163], a[248:251], v[64:67]
buffer_load_dwordx4 a[204:207], v1, s[44:47], s25 offen offset:3072 sc1
M v[64:67], v[164:167], a[252:255], v[64:67]
ds_read_b64_tr_b16 v[124:125], v11 offset:8192
ds_read_b64_tr_b16 v[126:127], v11 offset:12288
M v[68:71], v[172:175], a[252:255], v[68:71]
s_sub_u32 s39, s39, 1
s_cmp_eq_u32 s39, 0
s_cselect_b32 s3, s64, s65
M v[68:71], v[168:171], a[248:251], v[68:71]
ds_read_b64_tr_b16 v[128:129], v12 offset:0
ds_read_b64_tr_b16 v[130:131], v12 offset:4096
M v[72:75], v[176:179], a[248:251], v[72:75]
s_add_u32 s25, s25, s3
s_lshl_b32 s3, s3, 3
s_add_u32 s26, s26, s3
M v[72:75], v[180:183], a[252:255], v[72:75]
ds_read_b64_tr_b16 v[132:133], v12 offset:8192
ds_read_b64_tr_b16 v[134:135], v12 offset:12288
M v[76:79], v[188:191], a[252:255], v[76:79]
M v[76:79], v[184:187], a[248:251], v[76:79]
ds_read_b64_tr_b16 v[136:137], v13 offset:0
ds_read_b64_tr_b16 v[138:139], v13 offset:4096
M v[80:83], v[192:195], a[248:251], v[80:83]
ds_read_b64_tr_b16 v[140:141], v13 offset:8192
ds_read_b64_tr_b16 v[142:143], v13 offset:12288
M v[80:83], v[196:199], a[252:255], v[80:83]
ds_read_b64_tr_b16 v[144:145], v14 offset:0
ds_read_b64_tr_b16 v[146:147], v14 offset:4096
M v[84:87], v[204:207], a[252:255], v[84:87]
ds_read_b64_tr_b16 v[148:149], v14 offset:8192
ds_read_b64_tr_b16 v[150:151], v14 offset:12288
M v[84:87], v[200:203], a[248:251], v[84:87]
ds_read_b64_tr_b16 v[152:153], v15 offset:0
ds_read_b64_tr_b16 v[154:155], v15 offset:4096
M v[88:91], v[208:211], a[248:251], v[88:91]
ds_read_b64_tr_b16 v[156:157], v15 offset:8192
ds_read_b64_tr_b16 v[158:159], v15 offset:12288
M v[88:91], v[212:215], a[252:255], v[88:91]
M v[92:95], v[220:223], a[252:255], v[92:95]
M v[92:95], v[216:219], a[248:251], v[92:95]
s_waitcnt vmcnt(24) lgkmcnt(0)
s_barrier
M v[32:35], v[96:99], a[128:131], v[32:35]
s_add_u32 m0, s41, 81920
s_nop 0
buffer_load_dwordx4 v2, s[48:51], s26 offen offset:0 lds
M v[32:35], v[100:103], a[132:135], v[32:35]
ds_read_b64_tr_b16 v[160:161], v8 offset:16384
ds_read_b64_tr_b16 v[162:163], v8 offset:20480
M v[36:39], v[108:111], a[132:135], v[36:39]
buffer_load_dwordx4 v3, s[48:51], s26 offen offset:1024 lds
M v[36:39], v[104:107], a[128:131], v[36:39]
ds_read_b64_tr_b16 v[164:165], v8 offset:24576
ds_read_b64_tr_b16 v[166:167], v8 offset:28672
M v[40:43], v[112:115], a[128:131], v[40:43]
buffer_load_dwordx4 v4, s[48:51], s26 offen offset:2048 lds
M v[40:43], v[116:119], a[132:135], v[40:43]
ds_read_b64_tr_b16 v[168:169], v9 offset:16384
ds_read_b64_tr_b16 v[170:171], v9 offset:20480
M v[44:47], v[124:127], a[132:135], v[44:47]
buffer_load_dwordx4 v5, s[48:51], s26 offen offset:3072 lds
M v[44:47], v[120:123], a[128:131], v[44:47]
M v[48:51], v[128:131], a[128:131], v[48:51]
ds_read_b64_tr_b16 v[172:173], v9 offset:24576
ds_read_b64_tr_b16 v[174:175], v9 offset:28672
M v[48:51], v[132:135], a[132:135], v[48:51]
buffer_load_dwordx4 a[208:211], v1, s[44:47], s25 offen offset:0 sc1
M v[52:55], v[140:143], a[132:135], v[52:55]
ds_read_b64_tr_b16 v[176:177], v10 offset:16384
ds_read_b64_tr_b16 v[178:179], v10 offset:20480
M v[52:55], v[136:139], a[128:131], v[52:55]
buffer_load_dwordx4 a[212:215], v1, s[44:47], s25 offen offset:1024 sc1
M v[56:59], v[144:147], a[128:131], v[56:59]
ds_read_b64_tr_b16 v[180:181], v10 offset:24576
ds_read_b64_tr_b16 v[182:183], v10 offset:28672
M v[56:59], v[148:151], a[132:135], v[56:59]
buffer_load_dwordx4 a[216:219], v1, s[44:47], s25 offen offset:2048 sc1
M v[60:63], v[156:159], a[132:135], v[60:63]
M v[60:63], v[152:155], a[128:131], v[60:63]
ds_read_b64_tr_b16 v[184:185], v11 offset:16384
ds_read_b64_tr_b16 v[186:187], v11 offset:20480
M v[64:67], v[96:99], a[136:139], v[64:67]
buffer_load_dwordx4 a[220:223], v1, s[44:47], s25 offen offset:3072 sc1
M v[64:67], v[100:103], a[140:143], v[64:67]
ds_read_b64_tr_b16 v[188:189], v11 offset:24576
ds_read_b64_tr_b16 v[190:191], v11 offset:28672
M v[68:71], v[108:111], a[140:143], v[68:71]
s_sub_u32 s39, s39, 1
s_cmp_eq_u32 s39, 0
s_cselect_b32 s3, s64, s65
M v[68:71], v[104:107], a[136:139], v[68:71]
ds_read_b64_tr_b16 v[192:193], v12 offset:16384
ds_read_b64_tr_b16 v[194:195], v12 offset:20480
M v[72:75], v[112:115], a[136:139], v[72:75]
s_add_u32 s25, s25, s3
s_lshl_b32 s3, s3, 3
s_add_u32 s26, s26, s3
M v[72:75], v[116:119], a[140:143], v[72:75]
ds_read_b64_tr_b16 v[196:197], v12 offset:24576
ds_read_b64_tr_b16 v[198:199], v12 offset:28672
M v[76:79], v[124:127], a[140:143], v[76:79]
M v[76:79], v[120:123], a[136:139], v[76:79]
ds_read_b64_tr_b16 v[200:201], v13 offset:16384
ds_read_b64_tr_b16 v[202:203], v13 offset:20480
M v[80:83], v[128:131], a[136:139], v[80:83]
ds_read_b64_tr_b16 v[204:205], v13 offset:24576
ds_read_b64_tr_b16 v[206:207], v13 offset:28672
M v[80:83], v[132:135], a[140:143], v[80:83]
ds_read_b64_tr_b16 v[208:209], v14 offset:16384
ds_read_b64_tr_b16 v[210:211], v14 offset:20480
M v[84:87], v[140:143], a[140:143], v[84:87]
ds_read_b64_tr_b16 v[212:213], v14 offset:24576
ds_read_b64_tr_b16 v[214:215], v14 offset:28672
M v[84:87], v[136:139], a[136:139], v[84:87]
ds_read_b64_tr_b16 v[216:217], v15 offset:16384
ds_read_b64_tr_b16 v[218:219], v15 offset:20480
M v[88:91], v[144:147], a[136:139], v[88:91]
ds_read_b64_tr_b16 v[220:221], v15 offset:24576
ds_read_b64_tr_b16 v[222:223], v15 offset:28672
M v[88:91], v[148:151], a[140:143], v[88:91]
M v[92:95], v[156:159], a[140:143], v[92:95]
M v[92:95], v[152:155], a[136:139], v[92:95]
s_waitcnt vmcnt(24) lgkmcnt(0)
s_barrier
M v[32:35], v[160:163], a[144:147], v[32:35]
s_add_u32 m0, s41, 98304
s_nop 0
buffer_load_dwordx4 v2, s[48:51], s26 offen offset:0 lds
M v[32:35], v[164:167], a[148:151], v[32:35]
ds_read_b64_tr_b16 v[96:97], v8 offset:32768
ds_read_b64_tr_b16 v[98:99], v8 offset:36864
M v[36:39], v[172:175], a[148:151], v[36:39]
buffer_load_dwordx4 v3, s[48:51], s26 offen offset:1024 lds
M v[36:39], v[168:171], a[144:147], v[36:39]
ds_read_b64_tr_b16 v[100:101], v8 offset:40960
ds_read_b64_tr_b16 v[102:103], v8 offset:45056
M v[40:43], v[176:179], a[144:147], v[40:43]
buffer_load_dwordx4 v4, s[48:51], s26 offen offset:2048 lds
M v[40:43], v[180:183], a[148:151], v[40:43]
ds_read_b64_tr_b16 v[104:105], v9 offset:32768
ds_read_b64_tr_b16 v[106:107], v9 offset:36864
M v[44:47], v[188:191], a[148:151], v[44:47]
buffer_load_dwordx4 v5, s[48:51], s26 offen offset:3072 lds
M v[44:47], v[184:187], a[144:147], v[44:47]
M v[48:51], v[192:195], a[144:147], v[48:51]
ds_read_b64_tr_b16 v[108:109], v9 offset:40960
ds_read_b64_tr_b16 v[110:111], v9 offset:45056
M v[48:51], v[196:199], a[148:151], v[48:51]
buffer_load_dwordx4 a[224:227], v1, s[44:47], s25 offen offset:0 sc1
M v[52:55], v[204:207], a[148:151], v[52:55]
ds_read_b64_tr_b16 v[112:113], v10 offset:32768
ds_read_b64_tr_b16 v[114:115], v10 offset:36864
M v[52:55], v[200:203], a[144:147], v[52:55]
buffer_load_dwordx4 a[228:231], v1, s[44:47], s25 offen offset:1024 sc1
M v[56:59], v[208:211], a[144:147], v[56:59]
ds_read_b64_tr_b16 v[116:117], v10 offset:40960
ds_read_b64_tr_b16 v[118:119], v10 offset:45056
M v[56:59], v[212:215], a[148:151], v[56:59]
buffer_load_dwordx4 a[232:235], v1, s[44:47], s25 offen offset:2048 sc1
M v[60:63], v[220:223], a[148:151], v[60:63]
M v[60:63], v[216:219], a[144:147], v[60:63]
ds_read_b64_tr_b16 v[120:121], v11 offset:32768
ds_read_b64_tr_b16 v[122:123], v11 offset:36864
M v[64:67], v[160:163], a[152:155], v[64:67]
buffer_load_dwordx4 a[236:239], v1, s[44:47], s25 offen offset:3072 sc1
M v[64:67], v[164:167], a[156:159], v[64:67]
ds_read_b64_tr_b16 v[124:125], v11 offset:40960
ds_read_b64_tr_b16 v[126:127], v11 offset:45056
M v[68:71], v[172:175], a[156:159], v[68:71]
s_sub_u32 s39, s39, 1
s_cmp_eq_u32 s39, 0
s_cselect_b32 s3, s64, s65
M v[68:71], v[168:171], a[152:155], v[68:71]
ds_read_b64_tr_b16 v[128:129], v12 offset:32768
ds_read_b64_tr_b16 v[130:131], v12 offset:36864
M v[72:75], v[176:179], a[152:155], v[72:75]
s_add_u32 s25, s25, s3
s_lshl_b32 s3, s3, 3
s_add_u32 s26, s26, s3
M v[72:75], v[180:183], a[156:159], v[72:75]
ds_read_b64_tr_b16 v[132:133], v12 offset:40960
ds_read_b64_tr_b16 v[134:135], v12 offset:45056
M v[76:79], v[188:191], a[156:159], v[76:79]
M v[76:79], v[184:187], a[152:155], v[76:79]
ds_read_b64_tr_b16 v[136:137], v13 offset:32768
ds_read_b64_tr_b16 v[138:139], v13 offset:36864
M v[80:83], v[192:195], a[152:155], v[80:83]
ds_read_b64_tr_b16 v[140:141], v13 offset:40960
ds_read_b64_tr_b16 v[142:143], v13 offset:45056
M v[80:83], v[196:199], a[156:159], v[80:83]
ds_read_b64_tr_b16 v[144:145], v14 offset:32768
ds_read_b64_tr_b16 v[146:147], v14 offset:36864
M v[84:87], v[204:207], a[156:159], v[84:87]
ds_read_b64_tr_b16 v[148:149], v14 offset:40960
ds_read_b64_tr_b16 v[150:151], v14 offset:45056
M v[84:87], v[200:203], a[152:155], v[84:87]
ds_read_b64_tr_b16 v[152:153], v15 offset:32768
ds_read_b64_tr_b16 v[154:155], v15 offset:36864
M v[88:91], v[208:211], a[152:155], v[88:91]
ds_read_b64_tr_b16 v[156:157], v15 offset:40960
ds_read_b64_tr_b16 v[158:159], v15 offset:45056
M v[88:91], v[212:215], a[156:159], v[88:91]
M v[92:95], v[220:223], a[156:159], v[92:95]
M v[92:95], v[216:219], a[152:155], v[92:95]
s_waitcnt vmcnt(24) lgkmcnt(0)
s_barrier
M v[32:35], v[96:99], a[160:163], v[32:35]
s_add_u32 m0, s41, 114688
s_nop 0
buffer_load_dwordx4 v2, s[48:51], s26 offen offset:0 lds
M v[32:35], v[100:103], a[164:167], v[32:35]
ds_read_b64_tr_b16 v[160:161], v8 offset:49152
ds_read_b64_tr_b16 v[162:163], v8 offset:53248
M v[36:39], v[108:111], a[164:167], v[36:39]
buffer_load_dwordx4 v3, s[48:51], s26 offen offset:1024 lds
M v[36:39], v[104:107], a[160:163], v[36:39]
ds_read_b64_tr_b16 v[164:165], v8 offset:57344
ds_read_b64_tr_b16 v[166:167], v8 offset:61440
M v[40:43], v[112:115], a[160:163], v[40:43]
buffer_load_dwordx4 v4, s[48:51], s26 offen offset:2048 lds
M v[40:43], v[116:119], a[164:167], v[40:43]
ds_read_b64_tr_b16 v[168:169], v9 offset:49152
ds_read_b64_tr_b16 v[170:171], v9 offset:53248
M v[44:47], v[124:127], a[164:167], v[44:47]
buffer_load_dwordx4 v5, s[48:51], s26 offen offset:3072 lds
M v[44:47], v[120:123], a[160:163], v[44:47]
M v[48:51], v[128:131], a[160:163], v[48:51]
ds_read_b64_tr_b16 v[172:173], v9 offset:57344
ds_read_b64_tr_b16 v[174:175], v9 offset:61440
M v[48:51], v[132:135], a[164:167], v[48:51]
buffer_load_dwordx4 a[240:243], v1, s[44:47], s25 offen offset:0 sc1
M v[52:55], v[140:143], a[164:167], v[52:55]
ds_read_b64_tr_b16 v[176:177], v10 offset:49152
ds_read_b64_tr_b16 v[178:179], v10 offset:53248
M v[52:55], v[136:139], a[160:163], v[52:55]
buffer_load_dwordx4 a[244:247], v1, s[44:47], s25 offen offset:1024 sc1
M v[56:59], v[144:147], a[160:163], v[56:59]
ds_read_b64_tr_b16 v[180:181], v10 offset:57344
ds_read_b64_tr_b16 v[182:183], v10 offset:61440
M v[56:59], v[148:151], a[164:167], v[56:59]
buffer_load_dwordx4 a[248:251], v1, s[44:47], s25 offen offset:2048 sc1
M v[60:63], v[156:159], a[164:167], v[60:63]
M v[60:63], v[152:155], a[160:163], v[60:63]
ds_read_b64_tr_b16 v[184:185], v11 offset:49152
ds_read_b64_tr_b16 v[186:187], v11 offset:53248
M v[64:67], v[96:99], a[168:171], v[64:67]
buffer_load_dwordx4 a[252:255], v1, s[44:47], s25 offen offset:3072 sc1
M v[64:67], v[100:103], a[172:175], v[64:67]
ds_read_b64_tr_b16 v[188:189], v11 offset:57344
ds_read_b64_tr_b16 v[190:191], v11 offset:61440
M v[68:71], v[108:111], a[172:175], v[68:71]
s_sub_u32 s39, s39, 1
s_cmp_eq_u32 s39, 0
s_cselect_b32 s3, s64, s65
M v[68:71], v[104:107], a[168:171], v[68:71]
ds_read_b64_tr_b16 v[192:193], v12 offset:49152
ds_read_b64_tr_b16 v[194:195], v12 offset:53248
M v[72:75], v[112:115], a[168:171], v[72:75]
s_add_u32 s25, s25, s3
s_lshl_b32 s3, s3, 3
s_add_u32 s26, s26, s3
M v[72:75], v[116:119], a[172:175], v[72:75]
ds_read_b64_tr_b16 v[196:197], v12 offset:57344
ds_read_b64_tr_b16 v[198:199], v12 offset:61440
M v[76:79], v[124:127], a[172:175], v[76:79]
M v[76:79], v[120:123], a[168:171], v[76:79]
ds_read_b64_tr_b16 v[200:201], v13 offset:49152
ds_read_b64_tr_b16 v[202:203], v13 offset:53248
M v[80:83], v[128:131], a[168:171], v[80:83]
ds_read_b64_tr_b16 v[204:205], v13 offset:57344
ds_read_b64_tr_b16 v[206:207], v13 offset:61440
M v[80:83], v[132:135], a[172:175], v[80:83]
ds_read_b64_tr_b16 v[208:209], v14 offset:49152
ds_read_b64_tr_b16 v[210:211], v14 offset:53248
M v[84:87], v[140:143], a[172:175], v[84:87]
ds_read_b64_tr_b16 v[212:213], v14 offset:57344
ds_read_b64_tr_b16 v[214:215], v14 offset:61440
M v[84:87], v[136:139], a[168:171], v[84:87]
ds_read_b64_tr_b16 v[216:217], v15 offset:49152
ds_read_b64_tr_b16 v[218:219], v15 offset:53248
M v[88:91], v[144:147], a[168:171], v[88:91]
ds_read_b64_tr_b16 v[220:221], v15 offset:57344
ds_read_b64_tr_b16 v[222:223], v15 offset:61440
M v[88:91], v[148:151], a[172:175], v[88:91]
M v[92:95], v[156:159], a[172:175], v[92:95]
M v[92:95], v[152:155], a[168:171], v[92:95]
s_waitcnt vmcnt(24) lgkmcnt(0)
s_barrier
M v[32:35], v[160:163], a[176:179], v[32:35]
s_add_u32 m0, s41, 0
s_nop 0
buffer_load_dwordx4 v2, s[48:51], s26 offen offset:0 lds
M v[32:35], v[164:167], a[180:183], v[32:35]
ds_read_b64_tr_b16 v[96:97], v16 offset:0
ds_read_b64_tr_b16 v[98:99], v16 offset:4096
M v[36:39], v[172:175], a[180:183], v[36:39]
buffer_load_dwordx4 v3, s[48:51], s26 offen offset:1024 lds
M v[36:39], v[168:171], a[176:179], v[36:39]
ds_read_b64_tr_b16 v[100:101], v16 offset:8192
ds_read_b64_tr_b16 v[102:103], v16 offset:12288
M v[40:43], v[176:179], a[176:179], v[40:43]
buffer_load_dwordx4 v4, s[48:51], s26 offen offset:2048 lds
M v[40:43], v[180:183], a[180:183], v[40:43]
ds_read_b64_tr_b16 v[104:105], v17 offset:0
ds_read_b64_tr_b16 v[106:107], v17 offset:4096
M v[44:47], v[188:191], a[180:183], v[44:47]
buffer_load_dwordx4 v5, s[48:51], s26 offen offset:3072 lds
M v[44:47], v[184:187], a[176:179], v[44:47]
M v[48:51], v[192:195], a[176:179], v[48:51]
ds_read_b64_tr_b16 v[108:109], v17 offset:8192
ds_read_b64_tr_b16 v[110:111], v17 offset:12288
M v[48:51], v[196:199], a[180:183], v[48:51]
buffer_load_dwordx4 a[128:131], v1, s[44:47], s25 offen offset:0 sc1
M v[52:55], v[204:207], a[180:183], v[52:55]
ds_read_b64_tr_b16 v[112:113], v18 offset:0
ds_read_b64_tr_b16 v[114:115], v18 offset:4096
M v[52:55], v[200:203], a[176:179], v[52:55]
buffer_load_dwordx4 a[132:135], v1, s[44:47], s25 offen offset:1024 sc1
M v[56:59], v[208:211], a[176:179], v[56:59]
ds_read_b64_tr_b16 v[116:117], v18 offset:8192
ds_read_b64_tr_b16 v[118:119], v18 offset:12288
M v[56:59], v[212:215], a[180:183], v[56:59]
buffer_load_dwordx4 a[136:139], v1, s[44:47], s25 offen offset:2048 sc1
M v[60:63], v[220:223], a[180:183], v[60:63]
M v[60:63], v[216:219], a[176:179], v[60:63]
ds_read_b64_tr_b16 v[120:121], v19 offset:0
ds_read_b64_tr_b16 v[122:123], v19 offset:4096
M v[64:67], v[160:163], a[184:187], v[64:67]
buffer_load_dwordx4 a[140:143], v1, s[44:47], s25 offen offset:3072 sc1
M v[64:67], v[164:167], a[188:191], v[64:67]
ds_read_b64_tr_b16 v[124:125], v19 offset:8192
ds_read_b64_tr_b16 v[126:127], v19 offset:12288
M v[68:71], v[172:175], a[188:191], v[68:71]
s_sub_u32 s39, s39, 1
s_cmp_eq_u32 s39, 0
s_cselect_b32 s3, s64, s65
M v[68:71], v[168:171], a[184:187], v[68:71]
ds_read_b64_tr_b16 v[128:129], v20 offset:0
ds_read_b64_tr_b16 v[130:131], v20 offset:4096
M v[72:75], v[176:179], a[184:187], v[72:75]
s_add_u32 s25, s25, s3
s_lshl_b32 s3, s3, 3
s_add_u32 s26, s26, s3
M v[72:75], v[180:183], a[188:191], v[72:75]
ds_read_b64_tr_b16 v[132:133], v20 offset:8192
ds_read_b64_tr_b16 v[134:135], v20 offset:12288
M v[76:79], v[188:191], a[188:191], v[76:79]
M v[76:79], v[184:187], a[184:187], v[76:79]
ds_read_b64_tr_b16 v[136:137], v21 offset:0
ds_read_b64_tr_b16 v[138:139], v21 offset:4096
M v[80:83], v[192:195], a[184:187], v[80:83]
ds_read_b64_tr_b16 v[140:141], v21 offset:8192
ds_read_b64_tr_b16 v[142:143], v21 offset:12288
M v[80:83], v[196:199], a[188:191], v[80:83]
ds_read_b64_tr_b16 v[144:145], v22 offset:0
ds_read_b64_tr_b16 v[146:147], v22 offset:4096
M v[84:87], v[204:207], a[188:191], v[84:87]
ds_read_b64_tr_b16 v[148:149], v22 offset:8192
ds_read_b64_tr_b16 v[150:151], v22 offset:12288
M v[84:87], v[200:203], a[184:187], v[84:87]
ds_read_b64_tr_b16 v[152:153], v23 offset:0
ds_read_b64_tr_b16 v[154:155], v23 offset:4096
M v[88:91], v[208:211], a[184:187], v[88:91]
ds_read_b64_tr_b16 v[156:157], v23 offset:8192
ds_read_b64_tr_b16 v[158:159], v23 offset:12288
M v[88:91], v[212:215], a[188:191], v[88:91]
M v[92:95], v[220:223], a[188:191], v[92:95]
M v[92:95], v[216:219], a[184:187], v[92:95]
s_waitcnt vmcnt(24) lgkmcnt(0)
s_barrier
M v[32:35], v[96:99], a[192:195], v[32:35]
s_add_u32 m0, s41, 16384
s_nop 0
buffer_load_dwordx4 v2, s[48:51], s26 offen offset:0 lds
M v[32:35], v[100:103], a[196:199], v[32:35]
ds_read_b64_tr_b16 v[160:161], v16 offset:16384
ds_read_b64_tr_b16 v[162:163], v16 offset:20480
M v[36:39], v[108:111], a[196:199], v[36:39]
buffer_load_dwordx4 v3, s[48:51], s26 offen offset:1024 lds
M v[36:39], v[104:107], a[192:195], v[36:39]
ds_read_b64_tr_b16 v[164:165], v16 offset:24576
ds_read_b64_tr_b16 v[166:167], v16 offset:28672
M v[40:43], v[112:115], a[192:195], v[40:43]
buffer_load_dwordx4 v4, s[48:51], s26 offen offset:2048 lds
M v[40:43], v[116:119], a[196:199], v[40:43]
ds_read_b64_tr_b16 v[168:169], v17 offset:16384
ds_read_b64_tr_b16 v[170:171], v17 offset:20480
M v[44:47], v[124:127], a[196:199], v[44:47]
buffer_load_dwordx4 v5, s[48:51], s26 offen offset:3072 lds
M v[44:47], v[120:123], a[192:195], v[44:47]
M v[48:51], v[128:131], a[192:195], v[48:51]
ds_read_b64_tr_b16 v[172:173], v17 offset:24576
ds_read_b64_tr_b16 v[174:175], v17 offset:28672
M v[48:51], v[132:135], a[196:199], v[48:51]
buffer_load_dwordx4 a[144:147], v1, s[44:47], s25 offen offset:0 sc1
M v[52:55], v[140:143], a[196:199], v[52:55]
ds_read_b64_tr_b16 v[176:177], v18 offset:16384
ds_read_b64_tr_b16 v[178:179], v18 offset:20480
M v[52:55], v[136:139], a[192:195], v[52:55]
buffer_load_dwordx4 a[148:151], v1, s[44:47], s25 offen offset:1024 sc1
M v[56:59], v[144:147], a[192:195], v[56:59]
ds_read_b64_tr_b16 v[180:181], v18 offset:24576
ds_read_b64_tr_b16 v[182:183], v18 offset:28672
M v[56:59], v[148:151], a[196:199], v[56:59]
buffer_load_dwordx4 a[152:155], v1, s[44:47], s25 offen offset:2048 sc1
M v[60:63], v[156:159], a[196:199], v[60:63]
M v[60:63], v[152:155], a[192:195], v[60:63]
ds_read_b64_tr_b16 v[184:185], v19 offset:16384
ds_read_b64_tr_b16 v[186:187], v19 offset:20480
M v[64:67], v[96:99], a[200:203], v[64:67]
buffer_load_dwordx4 a[156:159], v1, s[44:47], s25 offen offset:3072 sc1
M v[64:67], v[100:103], a[204:207], v[64:67]
ds_read_b64_tr_b16 v[188:189], v19 offset:24576
ds_read_b64_tr_b16 v[190:191], v19 offset:28672
M v[68:71], v[108:111], a[204:207], v[68:71]
s_sub_u32 s39, s39, 1
s_cmp_eq_u32 s39, 0
s_cselect_b32 s3, s64, s65
M v[68:71], v[104:107], a[200:203], v[68:71]
ds_read_b64_tr_b16 v[192:193], v20 offset:16384
ds_read_b64_tr_b16 v[194:195], v20 offset:20480
M v[72:75], v[112:115], a[200:203], v[72:75]
s_add_u32 s25, s25, s3
s_lshl_b32 s3, s3, 3
s_add_u32 s26, s26, s3
M v[72:75], v[116:119], a[204:207], v[72:75]
ds_read_b64_tr_b16 v[196:197], v20 offset:24576
ds_read_b64_tr_b16 v[198:199], v20 offset:28672
M v[76:79], v[124:127], a[204:207], v[76:79]
M v[76:79], v[120:123], a[200:203], v[76:79]
ds_read_b64_tr_b16 v[200:201], v21 offset:16384
ds_read_b64_tr_b16 v[202:203], v21 offset:20480
M v[80:83], v[128:131], a[200:203], v[80:83]
ds_read_b64_tr_b16 v[204:205], v21 offset:24576
ds_read_b64_tr_b16 v[206:207], v21 offset:28672
M v[80:83], v[132:135], a[204:207], v[80:83]
ds_read_b64_tr_b16 v[208:209], v22 offset:16384
ds_read_b64_tr_b16 v[210:211], v22 offset:20480
M v[84:87], v[140:143], a[204:207], v[84:87]
ds_read_b64_tr_b16 v[212:213], v22 offset:24576
ds_read_b64_tr_b16 v[214:215], v22 offset:28672
M v[84:87], v[136:139], a[200:203], v[84:87]
ds_read_b64_tr_b16 v[216:217], v23 offset:16384
ds_read_b64_tr_b16 v[218:219], v23 offset:20480
M v[88:91], v[144:147], a[200:203], v[88:91]
ds_read_b64_tr_b16 v[220:221], v23 offset:24576
ds_read_b64_tr_b16 v[222:223], v23 offset:28672
M v[88:91], v[148:151], a[204:207], v[88:91]
M v[92:95], v[156:159], a[204:207], v[92:95]
M v[92:95], v[152:155], a[200:203], v[92:95]
s_sub_u32 s28, s28, 1
s_cmp_lg_u32 s28, 0
s_cbranch_scc1 Lk3_la
s_waitcnt vmcnt(24) lgkmcnt(0)
s_barrier
M v[32:35], v[160:163], a[208:211], v[32:35]
s_add_u32 m0, s41, 32768
s_nop 0
buffer_load_dwordx4 v2, s[48:51], s26 offen offset:0 lds
M v[32:35], v[164:167], a[212:215], v[32:35]
ds_read_b64_tr_b16 v[96:97], v16 offset:32768
ds_read_b64_tr_b16 v[98:99], v16 offset:36864
M v[36:39], v[172:175], a[212:215], v[36:39]
buffer_load_dwordx4 v3, s[48:51], s26 offen offset:1024 lds
M v[36:39], v[168:171], a[208:211], v[36:39]
ds_read_b64_tr_b16 v[100:101], v16 offset:40960
ds_read_b64_tr_b16 v[102:103], v16 offset:45056
M v[40:43], v[176:179], a[208:211], v[40:43]
buffer_load_dwordx4 v4, s[48:51], s26 offen offset:2048 lds
M v[40:43], v[180:183], a[212:215], v[40:43]
ds_read_b64_tr_b16 v[104:105], v17 offset:32768
ds_read_b64_tr_b16 v[106:107], v17 offset:36864
M v[44:47], v[188:191], a[212:215], v[44:47]
buffer_load_dwordx4 v5, s[48:51], s26 offen offset:3072 lds
M v[44:47], v[184:187], a[208:211], v[44:47]
M v[48:51], v[192:195], a[208:211], v[48:51]
ds_read_b64_tr_b16 v[108:109], v17 offset:40960
ds_read_b64_tr_b16 v[110:111], v17 offset:45056
M v[48:51], v[196:199], a[212:215], v[48:51]
buffer_load_dwordx4 a[160:163], v1, s[44:47], s25 offen offset:0 sc1
M v[52:55], v[204:207], a[212:215], v[52:55]
ds_read_b64_tr_b16 v[112:113], v18 offset:32768
ds_read_b64_tr_b16 v[114:115], v18 offset:36864
M v[52:55], v[200:203], a[208:211], v[52:55]
buffer_load_dwordx4 a[164:167], v1, s[44:47], s25 offen offset:1024 sc1
M v[56:59], v[208:211], a[208:211], v[56:59]
ds_read_b64_tr_b16 v[116:117], v18 offset:40960
ds_read_b64_tr_b16 v[118:119], v18 offset:45056
M v[56:59], v[212:215], a[212:215], v[56:59]
buffer_load_dwordx4 a[168:171], v1, s[44:47], s25 offen offset:2048 sc1
M v[60:63], v[220:223], a[212:215], v[60:63]
M v[60:63], v[216:219], a[208:211], v[60:63]
ds_read_b64_tr_b16 v[120:121], v19 offset:32768
ds_read_b64_tr_b16 v[122:123], v19 offset:36864
M v[64:67], v[160:163], a[216:219], v[64:67]
buffer_load_dwordx4 a[172:175], v1, s[44:47], s25 offen offset:3072 sc1
M v[64:67], v[164:167], a[220:223], v[64:67]
ds_read_b64_tr_b16 v[124:125], v19 offset:40960
ds_read_b64_tr_b16 v[126:127], v19 offset:45056
M v[68:71], v[172:175], a[220:223], v[68:71]
s_sub_u32 s39, s39, 1
s_cmp_eq_u32 s39, 0
s_cselect_b32 s3, s64, s65
M v[68:71], v[168:171], a[216:219], v[68:71]
ds_read_b64_tr_b16 v[128:129], v20 offset:32768
ds_read_b64_tr_b16 v[130:131], v20 offset:36864
M v[72:75], v[176:179], a[216:219], v[72:75]
s_add_u32 s25, s25, s3
s_lshl_b32 s3, s3, 3
s_add_u32 s26, s26, s3
M v[72:75], v[180:183], a[220:223], v[72:75]
ds_read_b64_tr_b16 v[132:133], v20 offset:40960
ds_read_b64_tr_b16 v[134:135], v20 offset:45056
M v[76:79], v[188:191], a[220:223], v[76:79]
M v[76:79], v[184:187], a[216:219], v[76:79]
ds_read_b64_tr_b16 v[136:137], v21 offset:32768
ds_read_b64_tr_b16 v[138:139], v21 offset:36864
M v[80:83], v[192:195], a[216:219], v[80:83]
ds_read_b64_tr_b16 v[140:141], v21 offset:40960
ds_read_b64_tr_b16 v[142:143], v21 offset:45056
M v[80:83], v[196:199], a[220:223], v[80:83]
ds_read_b64_tr_b16 v[144:145], v22 offset:32768
ds_read_b64_tr_b16 v[146:147], v22 offset:36864
M v[84:87], v[204:207], a[220:223], v[84:87]
ds_read_b64_tr_b16 v[148:149], v22 offset:40960
ds_read_b64_tr_b16 v[150:151], v22 offset:45056
M v[84:87], v[200:203], a[216:219], v[84:87]
ds_read_b64_tr_b16 v[152:153], v23 offset:32768
ds_read_b64_tr_b16 v[154:155], v23 offset:36864
M v[88:91], v[208:211], a[216:219], v[88:91]
ds_read_b64_tr_b16 v[156:157], v23 offset:40960
ds_read_b64_tr_b16 v[158:159], v23 offset:45056
M v[88:91], v[212:215], a[220:223], v[88:91]
M v[92:95], v[220:223], a[220:223], v[92:95]
M v[92:95], v[216:219], a[216:219], v[92:95]
s_waitcnt vmcnt(24) lgkmcnt(0)
s_barrier
M v[32:35], v[96:99], a[224:227], v[32:35]
s_add_u32 m0, s41, 49152
s_nop 0
buffer_load_dwordx4 v2, s[48:51], s26 offen offset:0 lds
M v[32:35], v[100:103], a[228:231], v[32:35]
ds_read_b64_tr_b16 v[160:161], v16 offset:49152
ds_read_b64_tr_b16 v[162:163], v16 offset:53248
M v[36:39], v[108:111], a[228:231], v[36:39]
buffer_load_dwordx4 v3, s[48:51], s26 offen offset:1024 lds
M v[36:39], v[104:107], a[224:227], v[36:39]
ds_read_b64_tr_b16 v[164:165], v16 offset:57344
ds_read_b64_tr_b16 v[166:167], v16 offset:61440
M v[40:43], v[112:115], a[224:227], v[40:43]
buffer_load_dwordx4 v4, s[48:51], s26 offen offset:2048 lds
M v[40:43], v[116:119], a[228:231], v[40:43]
ds_read_b64_tr_b16 v[168:169], v17 offset:49152
ds_read_b64_tr_b16 v[170:171], v17 offset:53248
M v[44:47], v[124:127], a[228:231], v[44:47]
buffer_load_dwordx4 v5, s[48:51], s26 offen offset:3072 lds
M v[44:47], v[120:123], a[224:227], v[44:47]
M v[48:51], v[128:131], a[224:227], v[48:51]
ds_read_b64_tr_b16 v[172:173], v17 offset:57344
ds_read_b64_tr_b16 v[174:175], v17 offset:61440
M v[48:51], v[132:135], a[228:231], v[48:51]
buffer_load_dwordx4 a[176:179], v1, s[44:47], s25 offen offset:0 sc1
M v[52:55], v[140:143], a[228:231], v[52:55]
ds_read_b64_tr_b16 v[176:177], v18 offset:49152
ds_read_b64_tr_b16 v[178:179], v18 offset:53248
M v[52:55], v[136:139], a[224:227], v[52:55]
buffer_load_dwordx4 a[180:183], v1, s[44:47], s25 offen offset:1024 sc1
M v[56:59], v[144:147], a[224:227], v[56:59]
ds_read_b64_tr_b16 v[180:181], v18 offset:57344
ds_read_b64_tr_b16 v[182:183], v18 offset:61440
M v[56:59], v[148:151], a[228:231], v[56:59]
buffer_load_dwordx4 a[184:187], v1, s[44:47], s25 offen offset:2048 sc1
M v[60:63], v[156:159], a[228:231], v[60:63]
M v[60:63], v[152:155], a[224:227], v[60:63]
ds_read_b64_tr_b16 v[184:185], v19 offset:49152
ds_read_b64_tr_b16 v[186:187], v19 offset:53248
M v[64:67], v[96:99], a[232:235], v[64:67]
buffer_load_dwordx4 a[188:191], v1, s[44:47], s25 offen offset:3072 sc1
M v[64:67], v[100:103], a[236:239], v[64:67]
ds_read_b64_tr_b16 v[188:189], v19 offset:57344
ds_read_b64_tr_b16 v[190:191], v19 offset:61440
M v[68:71], v[108:111], a[236:239], v[68:71]
s_sub_u32 s39, s39, 1
s_cmp_eq_u32 s39, 0
s_cselect_b32 s3, s64, s65
M v[68:71], v[104:107], a[232:235], v[68:71]
ds_read_b64_tr_b16 v[192:193], v20 offset:49152
ds_read_b64_tr_b16 v[194:195], v20 offset:53248
M v[72:75], v[112:115], a[232:235], v[72:75]
s_add_u32 s25, s25, s3
s_lshl_b32 s3, s3, 3
s_add_u32 s26, s26, s3
M v[72:75], v[116:119], a[236:239], v[72:75]
ds_read_b64_tr_b16 v[196:197], v20 offset:57344
ds_read_b64_tr_b16 v[198:199], v20 offset:61440
M v[76:79], v[124:127], a[236:239], v[76:79]
M v[76:79], v[120:123], a[232:235], v[76:79]
ds_read_b64_tr_b16 v[200:201], v21 offset:49152
ds_read_b64_tr_b16 v[202:203], v21 offset:53248
M v[80:83], v[128:131], a[232:235], v[80:83]
ds_read_b64_tr_b16 v[204:205], v21 offset:57344
ds_read_b64_tr_b16 v[206:207], v21 offset:61440
M v[80:83], v[132:135], a[236:239], v[80:83]
ds_read_b64_tr_b16 v[208:209], v22 offset:49152
ds_read_b64_tr_b16 v[210:211], v22 offset:53248
M v[84:87], v[140:143], a[236:239], v[84:87]
ds_read_b64_tr_b16 v[212:213], v22 offset:57344
ds_read_b64_tr_b16 v[214:215], v22 offset:61440
M v[84:87], v[136:139], a[232:235], v[84:87]
ds_read_b64_tr_b16 v[216:217], v23 offset:49152
ds_read_b64_tr_b16 v[218:219], v23 offset:53248
M v[88:91], v[144:147], a[232:235], v[88:91]
ds_read_b64_tr_b16 v[220:221], v23 offset:57344
ds_read_b64_tr_b16 v[222:223], v23 offset:61440
M v[88:91], v[148:151], a[236:239], v[88:91]
M v[92:95], v[156:159], a[236:239], v[92:95]
M v[92:95], v[152:155], a[232:235], v[92:95]
s_waitcnt vmcnt(24) lgkmcnt(0)
s_barrier
M v[32:35], v[160:163], a[240:243], v[32:35]
s_mov_b64 s[44:45], s[34:35]
s_mov_b32 s46, 4194304
s_mov_b64 s[48:49], s[36:37]
s_mov_b32 s50, 2097152
s_mov_b32 s25, s32
s_mov_b32 s26, s33
s_add_u32 m0, s42, 65536
s_nop 0
buffer_load_dwordx4 v6, s[48:51], s26 offen offset:0 lds
M v[32:35], v[164:167], a[244:247], v[32:35]
ds_read_b64_tr_b16 v[96:97], v8 offset:0
ds_read_b64_tr_b16 v[98:99], v8 offset:4096
M v[36:39], v[172:175], a[244:247], v[36:39]
buffer_load_dwordx4 v7, s[48:51], s26 offen offset:1024 lds
M v[36:39], v[168:171], a[240:243], v[36:39]
ds_read_b64_tr_b16 v[100:101], v8 offset:8192
ds_read_b64_tr_b16 v[102:103], v8 offset:12288
M v[40:43], v[176:179], a[240:243], v[40:43]
M v[40:43], v[180:183], a[244:247], v[40:43]
buffer_load_dwordx4 a[192:195], v1, s[44:47], s25 offen offset:0 sc1
M v[44:47], v[188:191], a[244:247], v[44:47]
ds_read_b64_tr_b16 v[104:105], v9 offset:0
ds_read_b64_tr_b16 v[106:107], v9 offset:4096
M v[44:47], v[184:187], a[240:243], v[44:47]
buffer_load_dwordx4 a[196:199], v1, s[44:47], s25 offen offset:1024 sc1
M v[48:51], v[192:195], a[240:243], v[48:51]
M v[48:51], v[196:199], a[244:247], v[48:51]
ds_read_b64_tr_b16 v[108:109], v9 offset:8192
ds_read_b64_tr_b16 v[110:111], v9 offset:12288
M v[52:55], v[204:207], a[244:247], v[52:55]
buffer_load_dwordx4 a[200:203], v1, s[44:47], s25 offen offset:2048 sc1
M v[52:55], v[200:203], a[240:243], v[52:55]
ds_read_b64_tr_b16 v[112:113], v10 offset:0
ds_read_b64_tr_b16 v[114:115], v10 offset:4096
M v[56:59], v[208:211], a[240:243], v[56:59]
M v[56:59], v[212:215], a[244:247], v[56:59]
buffer_load_dwordx4 a[204:207], v1, s[44:47], s25 offen offset:3072 sc1
M v[60:63], v[220:223], a[244:247], v[60:63]
ds_read_b64_tr_b16 v[116:117], v10 offset:8192
ds_read_b64_tr_b16 v[118:119], v10 offset:12288
M v[60:63], v[216:219], a[240:243], v[60:63]
s_add_u32 s25, s25, 16384
s_add_u32 s26, s26, 131072
M v[64:67], v[160:163], a[248:251], v[64:67]
ds_read_b64_tr_b16 v[120:121], v11 offset:0
ds_read_b64_tr_b16 v[122:123], v11 offset:4096
M v[64:67], v[164:167], a[252:255], v[64:67]
M v[68:71], v[172:175], a[252:255], v[68:71]
ds_read_b64_tr_b16 v[124:125], v11 offset:8192
ds_read_b64_tr_b16 v[126:127], v11 offset:12288
M v[68:71], v[168:171], a[248:251], v[68:71]
ds_read_b64_tr_b16 v[128:129], v12 offset:0
ds_read_b64_tr_b16 v[130:131], v12 offset:4096
M v[72:75], v[176:179], a[248:251], v[72:75]
ds_read_b64_tr_b16 v[132:133], v12 offset:8192
ds_read_b64_tr_b16 v[134:135], v12 offset:12288
M v[72:75], v[180:183], a[252:255], v[72:75]
M v[76:79], v[188:191], a[252:255], v[76:79]
ds_read_b64_tr_b16 v[136:137], v13 offset:0
ds_read_b64_tr_b16 v[138:139], v13 offset:4096
M v[76:79], v[184:187], a[248:251], v[76:79]
ds_read_b64_tr_b16 v[140:141], v13 offset:8192
ds_read_b64_tr_b16 v[142:143], v13 offset:12288
M v[80:83], v[192:195], a[248:251], v[80:83]
ds_read_b64_tr_b16 v[144:145], v14 offset:0
ds_read_b64_tr_b16 v[146:147], v14 offset:4096
M v[80:83], v[196:199], a[252:255], v[80:83]
M v[84:87], v[204:207], a[252:255], v[84:87]
ds_read_b64_tr_b16 v[148:149], v14 offset:8192
ds_read_b64_tr_b16 v[150:151], v14 offset:12288
M v[84:87], v[200:203], a[248:251], v[84:87]
ds_read_b64_tr_b16 v[152:153], v15 offset:0
ds_read_b64_tr_b16 v[154:155], v15 offset:4096
M v[88:91], v[208:211], a[248:251], v[88:91]
ds_read_b64_tr_b16 v[156:157], v15 offset:8192
ds_read_b64_tr_b16 v[158:159], v15 offset:12288
M v[88:91], v[212:215], a[252:255], v[88:91]
M v[92:95], v[220:223], a[252:255], v[92:95]
M v[92:95], v[216:219], a[248:251], v[92:95]
s_waitcnt vmcnt(22) lgkmcnt(0)
s_barrier
M v[32:35], v[96:99], a[128:131], v[32:35]
s_add_u32 m0, s42, 81920
s_nop 0
buffer_load_dwordx4 v6, s[48:51], s26 offen offset:0 lds
M v[32:35], v[100:103], a[132:135], v[32:35]
ds_read_b64_tr_b16 v[160:161], v8 offset:16384
ds_read_b64_tr_b16 v[162:163], v8 offset:20480
M v[36:39], v[108:111], a[132:135], v[36:39]
buffer_load_dwordx4 v7, s[48:51], s26 offen offset:1024 lds
M v[36:39], v[104:107], a[128:131], v[36:39]
ds_read_b64_tr_b16 v[164:165], v8 offset:24576
ds_read_b64_tr_b16 v[166:167], v8 offset:28672
M v[40:43], v[112:115], a[128:131], v[40:43]
M v[40:43], v[116:119], a[132:135], v[40:43]
buffer_load_dwordx4 a[208:211], v1, s[44:47], s25 offen offset:0 sc1
M v[44:47], v[124:127], a[132:135], v[44:47]
ds_read_b64_tr_b16 v[168:169], v9 offset:16384
ds_read_b64_tr_b16 v[170:171], v9 offset:20480
M v[44:47], v[120:123], a[128:131], v[44:47]
buffer_load_dwordx4 a[212:215], v1, s[44:47], s25 offen offset:1024 sc1
M v[48:51], v[128:131], a[128:131], v[48:51]
M v[48:51], v[132:135], a[132:135], v[48:51]
ds_read_b64_tr_b16 v[172:173], v9 offset:24576
ds_read_b64_tr_b16 v[174:175], v9 offset:28672
M v[52:55], v[140:143], a[132:135], v[52:55]
buffer_load_dwordx4 a[216:219], v1, s[44:47], s25 offen offset:2048 sc1
M v[52:55], v[136:139], a[128:131], v[52:55]
ds_read_b64_tr_b16 v[176:177], v10 offset:16384
ds_read_b64_tr_b16 v[178:179], v10 offset:20480
M v[56:59], v[144:147], a[128:131], v[56:59]
M v[56:59], v[148:151], a[132:135], v[56:59]
buffer_load_dwordx4 a[220:223], v1, s[44:47], s25 offen offset:3072 sc1
M v[60:63], v[156:159], a[132:135], v[60:63]
ds_read_b64_tr_b16 v[180:181], v10 offset:24576
ds_read_b64_tr_b16 v[182:183], v10 offset:28672
M v[60:63], v[152:155], a[128:131], v[60:63]
s_add_u32 s25, s25, 16384
s_add_u32 s26, s26, 131072
M v[64:67], v[96:99], a[136:139], v[64:67]
ds_read_b64_tr_b16 v[184:185], v11 offset:16384
ds_read_b64_tr_b16 v[186:187], v11 offset:20480
M v[64:67], v[100:103], a[140:143], v[64:67]
M v[68:71], v[108:111], a[140:143], v[68:71]
ds_read_b64_tr_b16 v[188:189], v11 offset:24576
ds_read_b64_tr_b16 v[190:191], v11 offset:28672
M v[68:71], v[104:107], a[136:139], v[68:71]
ds_read_b64_tr_b16 v[192:193], v12 offset:16384
ds_read_b64_tr_b16 v[194:195], v12 offset:20480
M v[72:75], v[112:115], a[136:139], v[72:75]
ds_read_b64_tr_b16 v[196:197], v12 offset:24576
ds_read_b64_tr_b16 v[198:199], v12 offset:28672
M v[72:75], v[116:119], a[140:143], v[72:75]
M v[76:79], v[124:127], a[140:143], v[76:79]
ds_read_b64_tr_b16 v[200:201], v13 offset:16384
ds_read_b64_tr_b16 v[202:203], v13 offset:20480
M v[76:79], v[120:123], a[136:139], v[76:79]
ds_read_b64_tr_b16 v[204:205], v13 offset:24576
ds_read_b64_tr_b16 v[206:207], v13 offset:28672
M v[80:83], v[128:131], a[136:139], v[80:83]
ds_read_b64_tr_b16 v[208:209], v14 offset:16384
ds_read_b64_tr_b16 v[210:211], v14 offset:20480
M v[80:83], v[132:135], a[140:143], v[80:83]
M v[84:87], v[140:143], a[140:143], v[84:87]
ds_read_b64_tr_b16 v[212:213], v14 offset:24576
ds_read_b64_tr_b16 v[214:215], v14 offset:28672
M v[84:87], v[136:139], a[136:139], v[84:87]
ds_read_b64_tr_b16 v[216:217], v15 offset:16384
ds_read_b64_tr_b16 v[218:219], v15 offset:20480
M v[88:91], v[144:147], a[136:139], v[88:91]
ds_read_b64_tr_b16 v[220:221], v15 offset:24576
ds_read_b64_tr_b16 v[222:223], v15 offset:28672
M v[88:91], v[148:151], a[140:143], v[88:91]
M v[92:95], v[156:159], a[140:143], v[92:95]
M v[92:95], v[152:155], a[136:139], v[92:95]
s_waitcnt vmcnt(20) lgkmcnt(0)
s_barrier
M v[32:35], v[160:163], a[144:147], v[32:35]
s_add_u32 m0, s42, 98304
s_nop 0
buffer_load_dwordx4 v6, s[48:51], s26 offen offset:0 lds
M v[32:35], v[164:167], a[148:151], v[32:35]
ds_read_b64_tr_b16 v[96:97], v8 offset:32768
ds_read_b64_tr_b16 v[98:99], v8 offset:36864
M v[36:39], v[172:175], a[148:151], v[36:39]
buffer_load_dwordx4 v7, s[48:51], s26 offen offset:1024 lds
M v[36:39], v[168:171], a[144:147], v[36:39]
ds_read_b64_tr_b16 v[100:101], v8 offset:40960
ds_read_b64_tr_b16 v[102:103], v8 offset:45056
M v[40:43], v[176:179], a[144:147], v[40:43]
M v[40:43], v[180:183], a[148:151], v[40:43]
buffer_load_dwordx4 a[224:227], v1, s[44:47], s25 offen offset:0 sc1
M v[44:47], v[188:191], a[148:151], v[44:47]
ds_read_b64_tr_b16 v[104:105], v9 offset:32768
ds_read_b64_tr_b16 v[106:107], v9 offset:36864
M v[44:47], v[184:187], a[144:147], v[44:47]
buffer_load_dwordx4 a[228:231], v1, s[44:47], s25 offen offset:1024 sc1
M v[48:51], v[192:195], a[144:147], v[48:51]
M v[48:51], v[196:199], a[148:151], v[48:51]
ds_read_b64_tr_b16 v[108:109], v9 offset:40960
ds_read_b64_tr_b16 v[110:111], v9 offset:45056
M v[52:55], v[204:207], a[148:151], v[52:55]
buffer_load_dwordx4 a[232:235], v1, s[44:47], s25 offen offset:2048 sc1
M v[52:55], v[200:203], a[144:147], v[52:55]
ds_read_b64_tr_b16 v[112:113], v10 offset:32768
ds_read_b64_tr_b16 v[114:115], v10 offset:36864
M v[56:59], v[208:211], a[144:147], v[56:59]
M v[56:59], v[212:215], a[148:151], v[56:59]
buffer_load_dwordx4 a[236:239], v1, s[44:47], s25 offen offset:3072 sc1
M v[60:63], v[220:223], a[148:151], v[60:63]
ds_read_b64_tr_b16 v[116:117], v10 offset:40960
ds_read_b64_tr_b16 v[118:119], v10 offset:45056
M v[60:63], v[216:219], a[144:147], v[60:63]
s_add_u32 s25, s25, 16384
s_add_u32 s26, s26, 131072
M v[64:67], v[160:163], a[152:155], v[64:67]
ds_read_b64_tr_b16 v[120:121], v11 offset:32768
ds_read_b64_tr_b16 v[122:123], v11 offset:36864
M v[64:67], v[164:167], a[156:159], v[64:67]
M v[68:71], v[172:175], a[156:159], v[68:71]
ds_read_b64_tr_b16 v[124:125], v11 offset:40960
ds_read_b64_tr_b16 v[126:127], v11 offset:45056
M v[68:71], v[168:171], a[152:155], v[68:71]
ds_read_b64_tr_b16 v[128:129], v12 offset:32768
ds_read_b64_tr_b16 v[130:131], v12 offset:36864
M v[72:75], v[176:179], a[152:155], v[72:75]
ds_read_b64_tr_b16 v[132:133], v12 offset:40960
ds_read_b64_tr_b16 v[134:135], v12 offset:45056
M v[72:75], v[180:183], a[156:159], v[72:75]
M v[76:79], v[188:191], a[156:159], v[76:79]
ds_read_b64_tr_b16 v[136:137], v13 offset:32768
ds_read_b64_tr_b16 v[138:139], v13 offset:36864
M v[76:79], v[184:187], a[152:155], v[76:79]
ds_read_b64_tr_b16 v[140:141], v13 offset:40960
ds_read_b64_tr_b16 v[142:143], v13 offset:45056
M v[80:83], v[192:195], a[152:155], v[80:83]
ds_read_b64_tr_b16 v[144:145], v14 offset:32768
ds_read_b64_tr_b16 v[146:147], v14 offset:36864
M v[80:83], v[196:199], a[156:159], v[80:83]
M v[84:87], v[204:207], a[156:159], v[84:87]
ds_read_b64_tr_b16 v[148:149], v14 offset:40960
ds_read_b64_tr_b16 v[150:151], v14 offset:45056
M v[84:87], v[200:203], a[152:155], v[84:87]
ds_read_b64_tr_b16 v[152:153], v15 offset:32768
ds_read_b64_tr_b16 v[154:155], v15 offset:36864
M v[88:91], v[208:211], a[152:155], v[88:91]
ds_read_b64_tr_b16 v[156:157], v15 offset:40960
ds_read_b64_tr_b16 v[158:159], v15 offset:45056
M v[88:91], v[212:215], a[156:159], v[88:91]
M v[92:95], v[220:223], a[156:159], v[92:95]
M v[92:95], v[216:219], a[152:155], v[92:95]
s_waitcnt vmcnt(18) lgkmcnt(0)
s_barrier
M v[32:35], v[96:99], a[160:163], v[32:35]
s_add_u32 m0, s42, 114688
s_nop 0
buffer_load_dwordx4 v6, s[48:51], s26 offen offset:0 lds
M v[32:35], v[100:103], a[164:167], v[32:35]
ds_read_b64_tr_b16 v[160:161], v8 offset:49152
ds_read_b64_tr_b16 v[162:163], v8 offset:53248
M v[36:39], v[108:111], a[164:167], v[36:39]
buffer_load_dwordx4 v7, s[48:51], s26 offen offset:1024 lds
M v[36:39], v[104:107], a[160:163], v[36:39]
ds_read_b64_tr_b16 v[164:165], v8 offset:57344
ds_read_b64_tr_b16 v[166:167], v8 offset:61440
M v[40:43], v[112:115], a[160:163], v[40:43]
M v[40:43], v[116:119], a[164:167], v[40:43]
buffer_load_dwordx4 a[240:243], v1, s[44:47], s25 offen offset:0 sc1
M v[44:47], v[124:127], a[164:167], v[44:47]
ds_read_b64_tr_b16 v[168:169], v9 offset:49152
ds_read_b64_tr_b16 v[170:171], v9 offset:53248
M v[44:47], v[120:123], a[160:163], v[44:47]
buffer_load_dwordx4 a[244:247], v1, s[44:47], s25 offen offset:1024 sc1
M v[48:51], v[128:131], a[160:163], v[48:51]
M v[48:51], v[132:135], a[164:167], v[48:51]
ds_read_b64_tr_b16 v[172:173], v9 offset:57344
ds_read_b64_tr_b16 v[174:175], v9 offset:61440
M v[52:55], v[140:143], a[164:167], v[52:55]
buffer_load_dwordx4 a[248:251], v1, s[44:47], s25 offen offset:2048 sc1
M v[52:55], v[136:139], a[160:163], v[52:55]
ds_read_b64_tr_b16 v[176:177], v10 offset:49152
ds_read_b64_tr_b16 v[178:179], v10 offset:53248
M v[56:59], v[144:147], a[160:163], v[56:59]
M v[56:59], v[148:151], a[164:167], v[56:59]
buffer_load_dwordx4 a[252:255], v1, s[44:47], s25 offen offset:3072 sc1
M v[60:63], v[156:159], a[164:167], v[60:63]
ds_read_b64_tr_b16 v[180:181], v10 offset:57344
ds_read_b64_tr_b16 v[182:183], v10 offset:61440
M v[60:63], v[152:155], a[160:163], v[60:63]
s_add_u32 s25, s25, 16384
s_add_u32 s26, s26, 131072
M v[64:67], v[96:99], a[168:171], v[64:67]
ds_read_b64_tr_b16 v[184:185], v11 offset:49152
ds_read_b64_tr_b16 v[186:187], v11 offset:53248
M v[64:67], v[100:103], a[172:175], v[64:67]
M v[68:71], v[108:111], a[172:175], v[68:71]
ds_read_b64_tr_b16 v[188:189], v11 offset:57344
ds_read_b64_tr_b16 v[190:191], v11 offset:61440
M v[68:71], v[104:107], a[168:171], v[68:71]
ds_read_b64_tr_b16 v[192:193], v12 offset:49152
ds_read_b64_tr_b16 v[194:195], v12 offset:53248
M v[72:75], v[112:115], a[168:171], v[72:75]
ds_read_b64_tr_b16 v[196:197], v12 offset:57344
ds_read_b64_tr_b16 v[198:199], v12 offset:61440
M v[72:75], v[116:119], a[172:175], v[72:75]
M v[76:79], v[124:127], a[172:175], v[76:79]
ds_read_b64_tr_b16 v[200:201], v13 offset:49152
ds_read_b64_tr_b16 v[202:203], v13 offset:53248
M v[76:79], v[120:123], a[168:171], v[76:79]
ds_read_b64_tr_b16 v[204:205], v13 offset:57344
ds_read_b64_tr_b16 v[206:207], v13 offset:61440
M v[80:83], v[128:131], a[168:171], v[80:83]
ds_read_b64_tr_b16 v[208:209], v14 offset:49152
ds_read_b64_tr_b16 v[210:211], v14 offset:53248
M v[80:83], v[132:135], a[172:175], v[80:83]
M v[84:87], v[140:143], a[172:175], v[84:87]
ds_read_b64_tr_b16 v[212:213], v14 offset:57344
ds_read_b64_tr_b16 v[214:215], v14 offset:61440
M v[84:87], v[136:139], a[168:171], v[84:87]
ds_read_b64_tr_b16 v[216:217], v15 offset:49152
ds_read_b64_tr_b16 v[218:219], v15 offset:53248
M v[88:91], v[144:147], a[168:171], v[88:91]
ds_read_b64_tr_b16 v[220:221], v15 offset:57344
ds_read_b64_tr_b16 v[222:223], v15 offset:61440
M v[88:91], v[148:151], a[172:175], v[88:91]
M v[92:95], v[156:159], a[172:175], v[92:95]
M v[92:95], v[152:155], a[168:171], v[92:95]
s_waitcnt vmcnt(18) lgkmcnt(0)
s_barrier
M v[32:35], v[160:163], a[176:179], v[32:35]
s_add_u32 m0, s42, 0
s_nop 0
buffer_load_dwordx4 v6, s[48:51], s26 offen offset:0 lds
M v[32:35], v[164:167], a[180:183], v[32:35]
M v[36:39], v[172:175], a[180:183], v[36:39]
ds_read_b64_tr_b16 v[96:97], v28 offset:0
ds_read_b64_tr_b16 v[98:99], v28 offset:2048
M v[36:39], v[168:171], a[176:179], v[36:39]
M v[40:43], v[176:179], a[176:179], v[40:43]
buffer_load_dwordx4 v7, s[48:51], s26 offen offset:1024 lds
M v[40:43], v[180:183], a[180:183], v[40:43]
M v[44:47], v[188:191], a[180:183], v[44:47]
ds_read_b64_tr_b16 v[100:101], v28 offset:4096
ds_read_b64_tr_b16 v[102:103], v28 offset:6144
M v[44:47], v[184:187], a[176:179], v[44:47]
M v[48:51], v[192:195], a[176:179], v[48:51]
buffer_load_dwordx4 a[128:131], v1, s[44:47], s25 offen offset:0 sc1
M v[48:51], v[196:199], a[180:183], v[48:51]
M v[52:55], v[204:207], a[180:183], v[52:55]
ds_read_b64_tr_b16 v[104:105], v29 offset:0
ds_read_b64_tr_b16 v[106:107], v29 offset:2048
M v[52:55], v[200:203], a[176:179], v[52:55]
M v[56:59], v[208:211], a[176:179], v[56:59]
buffer_load_dwordx4 a[132:135], v1, s[44:47], s25 offen offset:1024 sc1
M v[56:59], v[212:215], a[180:183], v[56:59]
M v[60:63], v[220:223], a[180:183], v[60:63]
ds_read_b64_tr_b16 v[108:109], v29 offset:4096
ds_read_b64_tr_b16 v[110:111], v29 offset:6144
M v[60:63], v[216:219], a[176:179], v[60:63]
M v[64:67], v[160:163], a[184:187], v[64:67]
buffer_load_dwordx4 a[136:139], v1, s[44:47], s25 offen offset:2048 sc1
M v[64:67], v[164:167], a[188:191], v[64:67]
M v[68:71], v[172:175], a[188:191], v[68:71]
ds_read_b64_tr_b16 v[112:113], v30 offset:0
ds_read_b64_tr_b16 v[114:115], v30 offset:2048
M v[68:71], v[168:171], a[184:187], v[68:71]
M v[72:75], v[176:179], a[184:187], v[72:75]
buffer_load_dwordx4 a[140:143], v1, s[44:47], s25 offen offset:3072 sc1
M v[72:75], v[180:183], a[188:191], v[72:75]
M v[76:79], v[188:191], a[188:191], v[76:79]
ds_read_b64_tr_b16 v[116:117], v30 offset:4096
ds_read_b64_tr_b16 v[118:119], v30 offset:6144
M v[76:79], v[184:187], a[184:187], v[76:79]
M v[80:83], v[192:195], a[184:187], v[80:83]
s_add_u32 s25, s25, 16384
s_add_u32 s26, s26, 131072
M v[80:83], v[196:199], a[188:191], v[80:83]
M v[84:87], v[204:207], a[188:191], v[84:87]
ds_read_b64_tr_b16 v[120:121], v31 offset:0
ds_read_b64_tr_b16 v[122:123], v31 offset:2048
M v[84:87], v[200:203], a[184:187], v[84:87]
M v[88:91], v[208:211], a[184:187], v[88:91]
ds_read_b64_tr_b16 v[124:125], v31 offset:4096
ds_read_b64_tr_b16 v[126:127], v31 offset:6144
M v[88:91], v[212:215], a[188:191], v[88:91]
M v[92:95], v[220:223], a[188:191], v[92:95]
M v[92:95], v[216:219], a[184:187], v[92:95]
s_waitcnt vmcnt(18) lgkmcnt(0)
s_barrier
M a[0:3], v[96:99], a[192:195], a[0:3]
s_add_u32 m0, s42, 16384
s_nop 0
buffer_load_dwordx4 v6, s[48:51], s26 offen offset:0 lds
ds_read_b64_tr_b16 v[160:161], v28 offset:16384
ds_read_b64_tr_b16 v[162:163], v28 offset:18432
M a[0:3], v[100:103], a[196:199], a[0:3]
buffer_load_dwordx4 v7, s[48:51], s26 offen offset:1024 lds
ds_read_b64_tr_b16 v[164:165], v28 offset:20480
ds_read_b64_tr_b16 v[166:167], v28 offset:22528
M a[4:7], v[108:111], a[196:199], a[4:7]
buffer_load_dwordx4 a[144:147], v1, s[44:47], s25 offen offset:0 sc1
ds_read_b64_tr_b16 v[168:169], v29 offset:16384
ds_read_b64_tr_b16 v[170:171], v29 offset:18432
M a[4:7], v[104:107], a[192:195], a[4:7]
buffer_load_dwordx4 a[148:151], v1, s[44:47], s25 offen offset:1024 sc1
M a[8:11], v[112:115], a[192:195], a[8:11]
ds_read_b64_tr_b16 v[172:173], v29 offset:20480
ds_read_b64_tr_b16 v[174:175], v29 offset:22528
buffer_load_dwordx4 a[152:155], v1, s[44:47], s25 offen offset:2048 sc1
M a[8:11], v[116:119], a[196:199], a[8:11]
ds_read_b64_tr_b16 v[176:177], v30 offset:16384
ds_read_b64_tr_b16 v[178:179], v30 offset:18432
buffer_load_dwordx4 a[156:159], v1, s[44:47], s25 offen offset:3072 sc1
M a[12:15], v[124:127], a[196:199], a[12:15]
ds_read_b64_tr_b16 v[180:181], v30 offset:20480
ds_read_b64_tr_b16 v[182:183], v30 offset:22528
M a[12:15], v[120:123], a[192:195], a[12:15]
s_add_u32 s25, s25, 16384
s_add_u32 s26, s26, 131072
ds_read_b64_tr_b16 v[184:185], v31 offset:16384
ds_read_b64_tr_b16 v[186:187], v31 offset:18432
M a[16:19], v[96:99], a[200:203], a[16:19]
s_add_u32 s60, s56, 0
buffer_store_dwordx4 v[48:51], v1, s[52:55], s60 offen offset:0 sc1
ds_read_b64_tr_b16 v[188:189], v31 offset:20480
ds_read_b64_tr_b16 v[190:191], v31 offset:22528
M a[16:19], v[100:103], a[204:207], a[16:19]
buffer_store_dwordx4 v[52:55], v1, s[52:55], s60 offen offset:1024 sc1
buffer_store_dwordx4 v[56:59], v1, s[52:55], s60 offen offset:2048 sc1
M a[20:23], v[108:111], a[204:207], a[20:23]
buffer_store_dwordx4 v[60:63], v1, s[52:55], s60 offen offset:3072 sc1
M a[20:23], v[104:107], a[200:203], a[20:23]
s_add_u32 s60, s56, 4096
buffer_store_dwordx4 v[80:83], v1, s[52:55], s60 offen offset:0 sc1
buffer_store_dwordx4 v[84:87], v1, s[52:55], s60 offen offset:1024 sc1
M a[24:27], v[112:115], a[200:203], a[24:27]
buffer_store_dwordx4 v[88:91], v1, s[52:55], s60 offen offset:2048 sc1
buffer_store_dwordx4 v[92:95], v1, s[52:55], s60 offen offset:3072 sc1
M a[24:27], v[116:119], a[204:207], a[24:27]
v_mov_b32 v11, 0
M a[28:31], v[124:127], a[204:207], a[28:31]
M a[28:31], v[120:123], a[200:203], a[28:31]
s_waitcnt vmcnt(26) lgkmcnt(0)
s_barrier
M a[0:3], v[160:163], a[208:211], a[0:3]
s_add_u32 m0, s42, 32768
s_nop 0
buffer_load_dwordx4 v6, s[48:51], s26 offen offset:0 lds
ds_read_b64_tr_b16 v[96:97], v28 offset:32768
ds_read_b64_tr_b16 v[98:99], v28 offset:34816
M a[0:3], v[164:167], a[212:215], a[0:3]
buffer_load_dwordx4 v7, s[48:51], s26 offen offset:1024 lds
M a[4:7], v[172:175], a[212:215], a[4:7]
ds_read_b64_tr_b16 v[100:101], v28 offset:36864
ds_read_b64_tr_b16 v[102:103], v28 offset:38912
M a[4:7], v[168:171], a[208:211], a[4:7]
buffer_load_dwordx4 a[160:163], v1, s[44:47], s25 offen offset:0 sc1
M a[8:11], v[176:179], a[208:211], a[8:11]
ds_read_b64_tr_b16 v[104:105], v29 offset:32768
ds_read_b64_tr_b16 v[106:107], v29 offset:34816
M a[8:11], v[180:183], a[212:215], a[8:11]
buffer_load_dwordx4 a[164:167], v1, s[44:47], s25 offen offset:1024 sc1
M a[12:15], v[188:191], a[212:215], a[12:15]
ds_read_b64_tr_b16 v[108:109], v29 offset:36864
ds_read_b64_tr_b16 v[110:111], v29 offset:38912
M a[12:15], v[184:187], a[208:211], a[12:15]
buffer_load_dwordx4 a[168:171], v1, s[44:47], s25 offen offset:2048 sc1
M a[16:19], v[160:163], a[216:219], a[16:19]
ds_read_b64_tr_b16 v[112:113], v30 offset:32768
ds_read_b64_tr_b16 v[114:115], v30 offset:34816
M a[16:19], v[164:167], a[220:223], a[16:19]
buffer_load_dwordx4 a[172:175], v1, s[44:47], s25 offen offset:3072 sc1
M a[20:23], v[172:175], a[220:223], a[20:23]
ds_read_b64_tr_b16 v[116:117], v30 offset:36864
ds_read_b64_tr_b16 v[118:119], v30 offset:38912
M a[20:23], v[168:171], a[216:219], a[20:23]
s_add_u32 s25, s25, 16384
s_add_u32 s26, s26, 131072
M a[24:27], v[176:179], a[216:219], a[24:27]
ds_read_b64_tr_b16 v[120:121], v31 offset:32768
ds_read_b64_tr_b16 v[122:123], v31 offset:34816
M a[24:27], v[180:183], a[220:223], a[24:27]
ds_read_b64_tr_b16 v[124:125], v31 offset:36864
ds_read_b64_tr_b16 v[126:127], v31 offset:38912
M a[28:31], v[188:191], a[220:223], a[28:31]
M a[28:31], v[184:187], a[216:219], a[28:31]
s_waitcnt vmcnt(6) lgkmcnt(0)
s_barrier
s_cmp_lg_u32 s101, 0
s_cbranch_scc1 Lk3f_15
v_mov_b32 v9, 1
s_mov_b64 exec, 1
buffer_store_dword v9, v11, s[52:55], s58 offen sc1
s_mov_b64 exec, -1
Lk3f_15:
M a[0:3], v[96:99], a[224:227], a[0:3]
s_add_u32 m0, s42, 49152
s_nop 0
buffer_load_dwordx4 v6, s[48:51], s26 offen offset:0 lds
ds_read_b64_tr_b16 v[160:161], v28 offset:49152
ds_read_b64_tr_b16 v[162:163], v28 offset:51200
M a[0:3], v[100:103], a[228:231], a[0:3]
buffer_load_dwordx4 v7, s[48:51], s26 offen offset:1024 lds
M a[4:7], v[108:111], a[228:231], a[4:7]
ds_read_b64_tr_b16 v[164:165], v28 offset:53248
ds_read_b64_tr_b16 v[166:167], v28 offset:55296
M a[4:7], v[104:107], a[224:227], a[4:7]
buffer_load_dwordx4 a[176:179], v1, s[44:47], s25 offen offset:0 sc1
M a[8:11], v[112:115], a[224:227], a[8:11]
ds_read_b64_tr_b16 v[168:169], v29 offset:49152
ds_read_b64_tr_b16 v[170:171], v29 offset:51200
M a[8:11], v[116:119], a[228:231], a[8:11]
buffer_load_dwordx4 a[180:183], v1, s[44:47], s25 offen offset:1024 sc1
M a[12:15], v[124:127], a[228:231], a[12:15]
ds_read_b64_tr_b16 v[172:173], v29 offset:53248
ds_read_b64_tr_b16 v[174:175], v29 offset:55296
M a[12:15], v[120:123], a[224:227], a[12:15]
buffer_load_dwordx4 a[184:187], v1, s[44:47], s25 offen offset:2048 sc1
M a[16:19], v[96:99], a[232:235], a[16:19]
ds_read_b64_tr_b16 v[176:177], v30 offset:49152
ds_read_b64_tr_b16 v[178:179], v30 offset:51200
M a[16:19], v[100:103], a[236:239], a[16:19]
buffer_load_dwordx4 a[188:191], v1, s[44:47], s25 offen offset:3072 sc1
M a[20:23], v[108:111], a[236:239], a[20:23]
ds_read_b64_tr_b16 v[180:181], v30 offset:53248
ds_read_b64_tr_b16 v[182:183], v30 offset:55296
M a[20:23], v[104:107], a[232:235], a[20:23]
s_add_u32 s25, s25, 16384
s_add_u32 s26, s26, 131072
M a[24:27], v[112:115], a[232:235], a[24:27]
ds_read_b64_tr_b16 v[184:185], v31 offset:49152
ds_read_b64_tr_b16 v[186:187], v31 offset:51200
M a[24:27], v[116:119], a[236:239], a[24:27]
ds_read_b64_tr_b16 v[188:189], v31 offset:53248
ds_read_b64_tr_b16 v[190:191], v31 offset:55296
M a[28:31], v[124:127], a[236:239], a[28:31]
M a[28:31], v[120:123], a[232:235], a[28:31]
s_waitcnt vmcnt(26) lgkmcnt(0)
s_barrier
M a[0:3], v[160:163], a[240:243], a[0:3]
ds_read_b64_tr_b16 v[96:97], v24 offset:0
ds_read_b64_tr_b16 v[98:99], v24 offset:2048
M a[0:3], v[164:167], a[244:247], a[0:3]
ds_read_b64_tr_b16 v[100:101], v24 offset:4096
ds_read_b64_tr_b16 v[102:103], v24 offset:6144
M a[4:7], v[172:175], a[244:247], a[4:7]
M a[4:7], v[168:171], a[240:243], a[4:7]
ds_read_b64_tr_b16 v[104:105], v25 offset:0
ds_read_b64_tr_b16 v[106:107], v25 offset:2048
M a[8:11], v[176:179], a[240:243], a[8:11]
M a[8:11], v[180:183], a[244:247], a[8:11]
ds_read_b64_tr_b16 v[108:109], v25 offset:4096
ds_read_b64_tr_b16 v[110:111], v25 offset:6144
M a[12:15], v[188:191], a[244:247], a[12:15]
M a[12:15], v[184:187], a[240:243], a[12:15]
ds_read_b64_tr_b16 v[112:113], v26 offset:0
ds_read_b64_tr_b16 v[114:115], v26 offset:2048
M a[16:19], v[160:163], a[248:251], a[16:19]
ds_read_b64_tr_b16 v[116:117], v26 offset:4096
ds_read_b64_tr_b16 v[118:119], v26 offset:6144
M a[16:19], v[164:167], a[252:255], a[16:19]
M a[20:23], v[172:175], a[252:255], a[20:23]
ds_read_b64_tr_b16 v[120:121], v27 offset:0
ds_read_b64_tr_b16 v[122:123], v27 offset:2048
M a[20:23], v[168:171], a[248:251], a[20:23]
M a[24:27], v[176:179], a[248:251], a[24:27]
ds_read_b64_tr_b16 v[124:125], v27 offset:4096
ds_read_b64_tr_b16 v[126:127], v27 offset:6144
M a[24:27], v[180:183], a[252:255], a[24:27]
M a[28:31], v[188:191], a[252:255], a[28:31]
M a[28:31], v[184:187], a[248:251], a[28:31]
s_waitcnt vmcnt(20) lgkmcnt(0)
s_barrier
M a[0:3], v[96:99], a[128:131], a[0:3]
ds_read_b64_tr_b16 v[160:161], v24 offset:16384
ds_read_b64_tr_b16 v[162:163], v24 offset:18432
M a[0:3], v[100:103], a[132:135], a[0:3]
ds_read_b64_tr_b16 v[164:165], v24 offset:20480
ds_read_b64_tr_b16 v[166:167], v24 offset:22528
M a[4:7], v[108:111], a[132:135], a[4:7]
M a[4:7], v[104:107], a[128:131], a[4:7]
ds_read_b64_tr_b16 v[168:169], v25 offset:16384
ds_read_b64_tr_b16 v[170:171], v25 offset:18432
M a[8:11], v[112:115], a[128:131], a[8:11]
M a[8:11], v[116:119], a[132:135], a[8:11]
ds_read_b64_tr_b16 v[172:173], v25 offset:20480
ds_read_b64_tr_b16 v[174:175], v25 offset:22528
M a[12:15], v[124:127], a[132:135], a[12:15]
M a[12:15], v[120:123], a[128:131], a[12:15]
ds_read_b64_tr_b16 v[176:177], v26 offset:16384
ds_read_b64_tr_b16 v[178:179], v26 offset:18432
M a[16:19], v[96:99], a[136:139], a[16:19]
ds_read_b64_tr_b16 v[180:181], v26 offset:20480
ds_read_b64_tr_b16 v[182:183], v26 offset:22528
M a[16:19], v[100:103], a[140:143], a[16:19]
M a[20:23], v[108:111], a[140:143], a[20:23]
ds_read_b64_tr_b16 v[184:185], v27 offset:16384
ds_read_b64_tr_b16 v[186:187], v27 offset:18432
M a[20:23], v[104:107], a[136:139], a[20:23]
M a[24:27], v[112:115], a[136:139], a[24:27]
ds_read_b64_tr_b16 v[188:189], v27 offset:20480
ds_read_b64_tr_b16 v[190:191], v27 offset:22528
M a[24:27], v[116:119], a[140:143], a[24:27]
M a[28:31], v[124:127], a[140:143], a[28:31]
M a[28:31], v[120:123], a[136:139], a[28:31]
s_waitcnt vmcnt(6) lgkmcnt(0)
s_barrier
M a[0:3], v[160:163], a[144:147], a[0:3]
buffer_load_dword v8, v11, s[52:55], s59 offen sc1
M a[0:3], v[164:167], a[148:151], a[0:3]
ds_read_b64_tr_b16 v[96:97], v24 offset:32768
ds_read_b64_tr_b16 v[98:99], v24 offset:34816
M a[4:7], v[172:175], a[148:151], a[4:7]
M a[4:7], v[168:171], a[144:147], a[4:7]
ds_read_b64_tr_b16 v[100:101], v24 offset:36864
ds_read_b64_tr_b16 v[102:103], v24 offset:38912
M a[8:11], v[176:179], a[144:147], a[8:11]
ds_read_b64_tr_b16 v[104:105], v25 offset:32768
ds_read_b64_tr_b16 v[106:107], v25 offset:34816
M a[8:11], v[180:183], a[148:151], a[8:11]
M a[12:15], v[188:191], a[148:151], a[12:15]
ds_read_b64_tr_b16 v[108:109], v25 offset:36864
ds_read_b64_tr_b16 v[110:111], v25 offset:38912
M a[12:15], v[184:187], a[144:147], a[12:15]
ds_read_b64_tr_b16 v[112:113], v26 offset:32768
ds_read_b64_tr_b16 v[114:115], v26 offset:34816
M a[16:19], v[160:163], a[152:155], a[16:19]
M a[16:19], v[164:167], a[156:159], a[16:19]
ds_read_b64_tr_b16 v[116:117], v26 offset:36864
ds_read_b64_tr_b16 v[118:119], v26 offset:38912
M a[20:23], v[172:175], a[156:159], a[20:23]
ds_read_b64_tr_b16 v[120:121], v27 offset:32768
ds_read_b64_tr_b16 v[122:123], v27 offset:34816
M a[20:23], v[168:171], a[152:155], a[20:23]
M a[24:27], v[176:179], a[152:155], a[24:27]
ds_read_b64_tr_b16 v[124:125], v27 offset:36864
ds_read_b64_tr_b16 v[126:127], v27 offset:38912
M a[24:27], v[180:183], a[156:159], a[24:27]
M a[28:31], v[188:191], a[156:159], a[28:31]
M a[28:31], v[184:187], a[152:155], a[28:31]
s_waitcnt vmcnt(1) lgkmcnt(0)
s_barrier
s_waitcnt vmcnt(0)
v_cmp_ne_u32 vcc, 1, v8
s_nop 0
s_cbranch_vccnz Lk3_spinfl
Lk3_gotfl:
M a[0:3], v[96:99], a[160:163], a[0:3]
s_add_u32 s60, s57, 0
buffer_load_dwordx4 v[224:227], v1, s[52:55], s60 offen offset:0 sc1
ds_read_b64_tr_b16 v[160:161], v24 offset:49152
ds_read_b64_tr_b16 v[162:163], v24 offset:51200
M a[0:3], v[100:103], a[164:167], a[0:3]
buffer_load_dwordx4 v[228:231], v1, s[52:55], s60 offen offset:1024 sc1
M a[4:7], v[108:111], a[164:167], a[4:7]
ds_read_b64_tr_b16 v[164:165], v24 offset:53248
ds_read_b64_tr_b16 v[166:167], v24 offset:55296
M a[4:7], v[104:107], a[160:163], a[4:7]
buffer_load_dwordx4 v[232:235], v1, s[52:55], s60 offen offset:2048 sc1
M a[8:11], v[112:115], a[160:163], a[8:11]
ds_read_b64_tr_b16 v[168:169], v25 offset:49152
ds_read_b64_tr_b16 v[170:171], v25 offset:51200
M a[8:11], v[116:119], a[164:167], a[8:11]
buffer_load_dwordx4 v[236:239], v1, s[52:55], s60 offen offset:3072 sc1
M a[12:15], v[124:127], a[164:167], a[12:15]
ds_read_b64_tr_b16 v[172:173], v25 offset:53248
ds_read_b64_tr_b16 v[174:175], v25 offset:55296
M a[12:15], v[120:123], a[160:163], a[12:15]
s_add_u32 s60, s57, 4096
buffer_load_dwordx4 v[240:243], v1, s[52:55], s60 offen offset:0 sc1
ds_read_b64_tr_b16 v[176:177], v26 offset:49152
ds_read_b64_tr_b16 v[178:179], v26 offset:51200
M a[16:19], v[96:99], a[168:171], a[16:19]
buffer_load_dwordx4 v[244:247], v1, s[52:55], s60 offen offset:1024 sc1
M a[16:19], v[100:103], a[172:175], a[16:19]
ds_read_b64_tr_b16 v[180:181], v26 offset:53248
ds_read_b64_tr_b16 v[182:183], v26 offset:55296
M a[20:23], v[108:111], a[172:175], a[20:23]
buffer_load_dwordx4 v[248:251], v1, s[52:55], s60 offen offset:2048 sc1
M a[20:23], v[104:107], a[168:171], a[20:23]
ds_read_b64_tr_b16 v[184:185], v27 offset:49152
ds_read_b64_tr_b16 v[186:187], v27 offset:51200
M a[24:27], v[112:115], a[168:171], a[24:27]
buffer_load_dwordx4 v[252:255], v1, s[52:55], s60 offen offset:3072 sc1
M a[24:27], v[116:119], a[172:175], a[24:27]
ds_read_b64_tr_b16 v[188:189], v27 offset:53248
ds_read_b64_tr_b16 v[190:191], v27 offset:55296
M a[28:31], v[124:127], a[172:175], a[28:31]
M a[28:31], v[120:123], a[168:171], a[28:31]
s_waitcnt lgkmcnt(0)
M a[0:3], v[160:163], a[176:179], a[0:3]
M a[0:3], v[164:167], a[180:183], a[0:3]
M a[4:7], v[172:175], a[180:183], a[4:7]
M a[4:7], v[168:171], a[176:179], a[4:7]
M a[8:11], v[176:179], a[176:179], a[8:11]
M a[8:11], v[180:183], a[180:183], a[8:11]
M a[12:15], v[188:191], a[180:183], a[12:15]
M a[12:15], v[184:187], a[176:179], a[12:15]
M a[16:19], v[160:163], a[184:187], a[16:19]
M a[16:19], v[164:167], a[188:191], a[16:19]
M a[20:23], v[172:175], a[188:191], a[20:23]
M a[20:23], v[168:171], a[184:187], a[20:23]
M a[24:27], v[176:179], a[184:187], a[24:27]
M a[24:27], v[180:183], a[188:191], a[24:27]
M a[28:31], v[188:191], a[188:191], a[28:31]
M a[28:31], v[184:187], a[184:187], a[28:31]
v_bfe_u32 v96, v0, 4, 1
v_lshrrev_b32 v97, 5, v0
v_lshl_or_b32 v96, v96, 1, v97
v_and_b32 v97, 15, v0
v_lshlrev_b32 v97, 13, v97
v_lshl_add_u32 v96, v96, 4, v97
s_and_b32 s3, s101, 1
s_lshl_b32 s3, s3, 6
s_lshr_b32 s6, s101, 1
s_add_u32 s3, s3, s6
s_add_u32 s3, s3, s21
s_lshl_b32 s3, s3, 12
s_lshl_b32 s6, s22, 1
s_add_u32 s3, s3, s6
s_add_u32 s3, s3, 2048
v_accvgpr_read_b32 v108, a0
v_accvgpr_read_b32 v109, a1
v_accvgpr_read_b32 v110, a2
v_accvgpr_read_b32 v111, a3
v_accvgpr_read_b32 v112, a4
v_accvgpr_read_b32 v113, a5
v_accvgpr_read_b32 v114, a6
v_accvgpr_read_b32 v115, a7
v_cvt_pk_bf16_f32 v100, v108, v109
v_cvt_pk_bf16_f32 v101, v110, v111
v_cvt_pk_bf16_f32 v102, v112, v113
v_cvt_pk_bf16_f32 v103, v114, v115
s_nop 0
v_permlane16_swap_b32 v100, v102
v_permlane16_swap_b32 v101, v103
buffer_store_dwordx4 v[100:103], v96, s[16:19], s3 offen offset:0
v_accvgpr_read_b32 v108, a8
v_accvgpr_read_b32 v109, a9
v_accvgpr_read_b32 v110, a10
v_accvgpr_read_b32 v111, a11
v_accvgpr_read_b32 v112, a12
v_accvgpr_read_b32 v113, a13
v_accvgpr_read_b32 v114, a14
v_accvgpr_read_b32 v115, a15
v_cvt_pk_bf16_f32 v104, v108, v109
v_cvt_pk_bf16_f32 v105, v110, v111
v_cvt_pk_bf16_f32 v106, v112, v113
v_cvt_pk_bf16_f32 v107, v114, v115
s_nop 0
v_permlane16_swap_b32 v104, v106
v_permlane16_swap_b32 v105, v107
buffer_store_dwordx4 v[104:107], v96, s[16:19], s3 offen offset:64
s_add_u32 s3, s3, 131072
v_accvgpr_read_b32 v108, a16
v_accvgpr_read_b32 v109, a17
v_accvgpr_read_b32 v110, a18
v_accvgpr_read_b32 v111, a19
v_accvgpr_read_b32 v112, a20
v_accvgpr_read_b32 v113, a21
v_accvgpr_read_b32 v114, a22
v_accvgpr_read_b32 v115, a23
v_cvt_pk_bf16_f32 v100, v108, v109
v_cvt_pk_bf16_f32 v101, v110, v111
v_cvt_pk_bf16_f32 v102, v112, v113
v_cvt_pk_bf16_f32 v103, v114, v115
s_nop 0
v_permlane16_swap_b32 v100, v102
v_permlane16_swap_b32 v101, v103
buffer_store_dwordx4 v[100:103], v96, s[16:19], s3 offen offset:0
v_accvgpr_read_b32 v108, a24
v_accvgpr_read_b32 v109, a25
v_accvgpr_read_b32 v110, a26
v_accvgpr_read_b32 v111, a27
v_accvgpr_read_b32 v112, a28
v_accvgpr_read_b32 v113, a29
v_accvgpr_read_b32 v114, a30
v_accvgpr_read_b32 v115, a31
v_cvt_pk_bf16_f32 v104, v108, v109
v_cvt_pk_bf16_f32 v105, v110, v111
v_cvt_pk_bf16_f32 v106, v112, v113
v_cvt_pk_bf16_f32 v107, v114, v115
s_nop 0
v_permlane16_swap_b32 v104, v106
v_permlane16_swap_b32 v105, v107
buffer_store_dwordx4 v[104:107], v96, s[16:19], s3 offen offset:64
v_bfe_u32 v128, v0, 4, 1
v_lshrrev_b32 v129, 5, v0
v_lshl_or_b32 v128, v128, 1, v129
v_and_b32 v129, 15, v0
v_lshlrev_b32 v129, 12, v129
v_lshl_add_u32 v128, v128, 4, v129
s_lshl_b32 s3, s101, 5
s_add_u32 s3, s3, s29
s_lshl_b32 s3, s3, 12
s_lshl_b32 s6, s30, 1
s_add_u32 s3, s3, s6
s_waitcnt vmcnt(4)
v_pk_add_f32 v[32:33], v[32:33], v[224:225]
v_pk_add_f32 v[34:35], v[34:35], v[226:227]
v_pk_add_f32 v[36:37], v[36:37], v[228:229]
v_pk_add_f32 v[38:39], v[38:39], v[230:231]
v_cvt_pk_bf16_f32 v132, v32, v33
v_cvt_pk_bf16_f32 v133, v34, v35
v_cvt_pk_bf16_f32 v134, v36, v37
v_cvt_pk_bf16_f32 v135, v38, v39
s_nop 0
v_permlane16_swap_b32 v132, v134
v_permlane16_swap_b32 v133, v135
buffer_store_dwordx4 v[132:135], v128, s[16:19], s3 offen offset:0
v_pk_add_f32 v[40:41], v[40:41], v[232:233]
v_pk_add_f32 v[42:43], v[42:43], v[234:235]
v_pk_add_f32 v[44:45], v[44:45], v[236:237]
v_pk_add_f32 v[46:47], v[46:47], v[238:239]
v_cvt_pk_bf16_f32 v136, v40, v41
v_cvt_pk_bf16_f32 v137, v42, v43
v_cvt_pk_bf16_f32 v138, v44, v45
v_cvt_pk_bf16_f32 v139, v46, v47
s_nop 0
v_permlane16_swap_b32 v136, v138
v_permlane16_swap_b32 v137, v139
buffer_store_dwordx4 v[136:139], v128, s[16:19], s3 offen offset:64
s_add_u32 s3, s3, 65536
v_pk_add_f32 v[64:65], v[64:65], v[240:241]
v_pk_add_f32 v[66:67], v[66:67], v[242:243]
v_pk_add_f32 v[68:69], v[68:69], v[244:245]
v_pk_add_f32 v[70:71], v[70:71], v[246:247]
v_cvt_pk_bf16_f32 v132, v64, v65
v_cvt_pk_bf16_f32 v133, v66, v67
v_cvt_pk_bf16_f32 v134, v68, v69
v_cvt_pk_bf16_f32 v135, v70, v71
s_nop 0
v_permlane16_swap_b32 v132, v134
v_permlane16_swap_b32 v133, v135
buffer_store_dwordx4 v[132:135], v128, s[16:19], s3 offen offset:0
v_pk_add_f32 v[72:73], v[72:73], v[248:249]
v_pk_add_f32 v[74:75], v[74:75], v[250:251]
v_pk_add_f32 v[76:77], v[76:77], v[252:253]
v_pk_add_f32 v[78:79], v[78:79], v[254:255]
v_cvt_pk_bf16_f32 v136, v72, v73
v_cvt_pk_bf16_f32 v137, v74, v75
v_cvt_pk_bf16_f32 v138, v76, v77
v_cvt_pk_bf16_f32 v139, v78, v79
s_nop 0
v_permlane16_swap_b32 v136, v138
v_permlane16_swap_b32 v137, v139
buffer_store_dwordx4 v[136:139], v128, s[16:19], s3 offen offset:64
s_endpgm
Lk3_spinb0:
Lk3_spinb0_:
s_add_u32 s61, s61, 1
s_cmp_gt_u32 s61, 1048576
s_cbranch_scc1 Lk3_gotb0
s_sleep 2
buffer_load_dword v7, v15, s[52:55], s43 offen sc1
s_waitcnt vmcnt(0)
v_cmp_ne_u32 vcc, 1, v7
s_nop 0
s_cbranch_vccnz Lk3_spinb0_
s_branch Lk3_gotb0
Lk3_spinb1:
Lk3_spinb1_:
s_add_u32 s61, s61, 1
s_cmp_gt_u32 s61, 1048576
s_cbranch_scc1 Lk3_gotb1
s_sleep 2
buffer_load_dword v7, v15, s[52:55], s43 offen sc1
s_waitcnt vmcnt(0)
v_cmp_ne_u32 vcc, 1, v7
s_nop 0
s_cbranch_vccnz Lk3_spinb1_
s_branch Lk3_gotb1
Lk3_spinft:
s_add_u32 s61, s61, 1
s_cmp_gt_u32 s61, 1048576
s_cbranch_scc1 Lk3_gotft
s_sleep 2
buffer_load_dword v252, v255, s[52:55], s62 offen sc1
s_waitcnt vmcnt(0)
v_cmp_ne_u32 vcc, 1, v252
s_nop 0
s_cbranch_vccnz Lk3_spinft
s_branch Lk3_gotft
Lk3_spinfl:
s_add_u32 s61, s61, 1
s_cmp_gt_u32 s61, 1048576
s_cbranch_scc1 Lk3_gotfl
s_sleep 2
buffer_load_dword v8, v11, s[52:55], s59 offen sc1
s_waitcnt vmcnt(0)
v_cmp_ne_u32 vcc, 1, v8
s_nop 0
s_cbranch_vccnz Lk3_spinfl
s_branch Lk3_gotfl
Lc3:
.section .rodata,"a"
.p2align 6
.amdhsa_kernel concat_heads__compressed_kv_cla__sliding_local_dilated__prompt_kernel
  .amdhsa_next_free_vgpr 512
  .amdhsa_next_free_sgpr 102
  .amdhsa_accum_offset 256
  .amdhsa_group_segment_fixed_size 0
  .amdhsa_kernarg_size 96
  .amdhsa_user_sgpr_count 2
  .amdhsa_user_sgpr_kernarg_segment_ptr 1
  .amdhsa_system_sgpr_workgroup_id_x 1
.end_amdhsa_kernel
```

```asm
; @launch grid=(256,1,1) block=(256,1,1) lds=163840
.amdgcn_target "amdgcn-amd-amdhsa--gfx950"
.text
.macro M d, a, b, c
v_mfma_f32_16x16x32_bf16 \d, \a, \b, \c
.endm
.globl concat_heads__compressed_kv_cla__sliding_local_dilated__prompt_kernel
.p2align 8
.type concat_heads__compressed_kv_cla__sliding_local_dilated__prompt_kernel,@function
concat_heads__compressed_kv_cla__sliding_local_dilated__prompt_kernel:
s_cmp_lt_u32 s2, 256
s_cbranch_scc1 Lk1_go
s_endpgm
Lk1_go:
s_load_dwordx16 s[32:47], s[0:1], 0
s_load_dwordx2 s[48:49], s[0:1], 64
s_load_dwordx2 s[50:51], s[0:1], 88
s_load_dwordx2 s[90:91], s[0:1], 80
v_lshrrev_b32 v24, 6, v0
s_nop 0
v_readfirstlane_b32 s20, v24
v_and_b32 v0, 63, v0
v_lshlrev_b32 v1, 4, v0
s_mov_b32 s101, s20
s_lshr_b32 s21, s20, 1
s_and_b32 s22, s20, 1
s_lshl_b32 s29, s20, 12
s_and_b32 s3, s2, 1
s_lshl_b32 s3, s3, 2
s_bfe_u32 s6, s2, 0x20003
s_add_u32 s3, s3, s6
s_lshl_b32 s52, s3, 8
s_bfe_u32 s3, s2, 0x20001
s_lshl_b32 s3, s3, 2
s_bfe_u32 s7, s2, 0x20005
s_add_u32 s3, s3, s7
s_lshl_b32 s53, s3, 8
s_cmp_lt_u32 s2, 128
s_cselect_b32 s5, 11, 10
s_lshl_b32 s3, s21, 7
s_lshl_b32 s4, s22, 5
s_add_u32 s3, s3, s4
v_lshrrev_b32 v24, 3, v0
v_add_u32 v24, s3, v24
v_and_b32 v25, 7, v0
v_add_u32 v26, 0, v24
v_bfe_u32 v27, v26, 1, 3
v_xor_b32 v27, v27, v25
v_lshlrev_b32 v26, s5, v26
v_lshl_add_u32 v26, v27, 4, v26
v_subrev_u32 v2, 0, v26
v_add_u32 v26, 8, v24
v_bfe_u32 v27, v26, 1, 3
v_xor_b32 v27, v27, v25
v_lshlrev_b32 v26, s5, v26
v_lshl_add_u32 v26, v27, 4, v26
v_subrev_u32 v3, 1024, v26
v_add_u32 v26, 16, v24
v_bfe_u32 v27, v26, 1, 3
v_xor_b32 v27, v27, v25
v_lshlrev_b32 v26, s5, v26
v_lshl_add_u32 v26, v27, 4, v26
v_subrev_u32 v4, 2048, v26
v_add_u32 v26, 24, v24
v_bfe_u32 v27, v26, 1, 3
v_xor_b32 v27, v27, v25
v_lshlrev_b32 v26, s5, v26
v_lshl_add_u32 v26, v27, 4, v26
v_subrev_u32 v5, 3072, v26
s_lshl_b32 s3, s20, 3
v_lshrrev_b32 v24, 5, v0
v_add_u32 v24, s3, v24
v_and_b32 v25, 31, v0
v_add_u32 v26, 0, v24
v_and_b32 v27, 3, v26
v_lshlrev_b32 v27, 1, v27
v_and_or_b32 v27, v26, 8, v27
v_xor_b32 v27, v27, v25
v_lshlrev_b32 v26, 13, v26
v_lshl_add_u32 v26, v27, 4, v26
v_subrev_u32 v6, 0, v26
v_add_u32 v26, 2, v24
v_and_b32 v27, 3, v26
v_lshlrev_b32 v27, 1, v27
v_and_or_b32 v27, v26, 8, v27
v_xor_b32 v27, v27, v25
v_lshlrev_b32 v26, 13, v26
v_lshl_add_u32 v26, v27, 4, v26
v_subrev_u32 v7, 1024, v26
v_add_u32 v26, 4, v24
v_and_b32 v27, 3, v26
v_lshlrev_b32 v27, 1, v27
v_and_or_b32 v27, v26, 8, v27
v_xor_b32 v27, v27, v25
v_lshlrev_b32 v26, 13, v26
v_lshl_add_u32 v26, v27, 4, v26
v_subrev_u32 v8, 2048, v26
v_add_u32 v26, 6, v24
v_and_b32 v27, 3, v26
v_lshlrev_b32 v27, 1, v27
v_and_or_b32 v27, v26, 8, v27
v_xor_b32 v27, v27, v25
v_lshlrev_b32 v26, 13, v26
v_lshl_add_u32 v26, v27, 4, v26
v_subrev_u32 v9, 3072, v26
s_lshl_b32 s23, s52, s5
s_lshl_b32 s31, 64, s5
s_mov_b32 s26, s23
s_lshl_b32 s24, s53, 1
s_mov_b32 s28, s24
s_lshl_b32 s3, 1, s5
s_add_u32 s25, s23, s3
s_lshl_b32 s3, s3, 12
s_add_u32 s27, s24, s3
s_bfe_u32 s3, s2, 0x20001
s_and_b32 s4, s2, 1
s_lshl_b32 s4, s4, 1
s_add_u32 s3, s3, s4
s_and_b32 s3, s3, 3
s_sub_u32 s4, s5, 2
s_lshl_b32 s3, s3, s4
s_add_u32 s23, s23, s3
s_lshl_b32 s3, s3, 12
s_add_u32 s24, s24, s3
s_mov_b32 s95, s6
s_cmp_lt_u32 s2, 128
s_cselect_b32 s6, -1, 8
s_waitcnt lgkmcnt(0)
s_cmp_lt_u32 s2, 128
s_cselect_b64 s[8:9], s[32:33], s[34:35]
s_mov_b32 s10, 2097152
s_cselect_b32 s10, 4194304, s10
s_mov_b32 s11, 0x00020000
s_cselect_b64 s[12:13], s[36:37], s[38:39]
s_mov_b32 s14, 4194304
s_cselect_b32 s14, 8388608, s14
s_mov_b32 s15, 0x00020000
s_mov_b64 s[64:65], s[40:41]
s_add_u32 m0, s29, 65536
s_nop 0
buffer_load_dwordx4 v6, s[12:15], s24 offen offset:0 lds
buffer_load_dwordx4 v7, s[12:15], s24 offen offset:1024 lds
buffer_load_dwordx4 v8, s[12:15], s24 offen offset:2048 lds
buffer_load_dwordx4 v9, s[12:15], s24 offen offset:3072 lds
s_add_u32 s24, s24, 262144
s_add_u32 m0, s29, 0
s_nop 0
buffer_load_dwordx4 v2, s[8:11], s23 offen offset:0 lds
buffer_load_dwordx4 v3, s[8:11], s23 offen offset:1024 lds
buffer_load_dwordx4 v4, s[8:11], s23 offen offset:2048 lds
buffer_load_dwordx4 v5, s[8:11], s23 offen offset:3072 lds
s_add_u32 m0, s29, 81920
s_nop 0
buffer_load_dwordx4 v6, s[12:15], s24 offen offset:0 lds
buffer_load_dwordx4 v7, s[12:15], s24 offen offset:1024 lds
buffer_load_dwordx4 v8, s[12:15], s24 offen offset:2048 lds
buffer_load_dwordx4 v9, s[12:15], s24 offen offset:3072 lds
s_add_u32 s24, s24, 262144
s_cmp_eq_u32 s24, s27
s_cselect_b32 s24, s28, s24
s_sub_u32 s6, s6, 1
s_cmp_eq_u32 s6, 0
s_cselect_b64 s[12:13], s[64:65], s[12:13]
s_add_u32 s16, s50, 109051904
s_addc_u32 s17, s51, 0
s_mov_b32 s18, 16384
s_mov_b32 s19, 0x00020000
v_mov_b32 v24, 0
v_mov_b32 v25, 0
v_mov_b32 v26, 0
v_mov_b32 v27, 0
s_lshl_b32 s3, s2, 2
buffer_store_dword v24, v24, s[16:19], s3 offen sc1
s_and_b32 s3, s2, 7
s_lshr_b32 s4, s2, 6
s_lshl_b32 s4, s4, 3
s_add_u32 s3, s3, s4
s_lshl_b32 s3, s3, 4
s_add_u32 s3, s3, 4096
s_bfe_u32 s4, s2, 0x30003
s_lshl_b32 s4, s4, 9
s_add_u32 s92, s3, s4
s_sub_u32 s4, 7680, s4
s_add_u32 s93, s3, s4
buffer_store_dwordx4 v[24:27], v24, s[16:19], s92 offen sc1
buffer_store_dwordx4 v[24:27], v24, s[16:19], s93 offen sc1
s_and_b32 s3, s2, 1
s_lshl_b32 s3, s3, 3
s_bfe_u32 s4, s2, 0x30003
s_add_u32 s92, s3, s4
s_bfe_u32 s3, s2, 0x20001
s_lshl_b32 s3, s3, 2
s_lshr_b32 s4, s2, 6
s_xor_b32 s4, s4, 2
s_add_u32 s93, s3, s4
s_lshl_b32 s92, s92, 8
s_lshl_b32 s93, s93, 4
s_add_u32 s92, s92, s93
s_add_u32 s92, s92, 12288
buffer_store_dwordx4 v[24:27], v24, s[16:19], s92 offen sc1
v_lshlrev_b32 v20, 7, v0
s_lshl_b32 s54, s2, 13
s_mov_b64 s[60:61], s[40:41]
s_mov_b32 s62, 0
s_cmp_eq_u32 s20, 1
s_cselect_b64 s[60:61], s[46:47], s[60:61]
s_cselect_b32 s62, 6291456, s62
s_cmp_eq_u32 s20, 2
s_cselect_b64 s[60:61], s[44:45], s[60:61]
s_cselect_b32 s62, 4194304, s62
s_cmp_eq_u32 s20, 3
s_cselect_b32 s62, 0, s62
s_mov_b32 s63, 0x00020000
s_mov_b32 s3, 0
s_cmp_eq_u32 s20, 1
s_cselect_b32 s3, 6291456, s3
s_cmp_eq_u32 s20, 2
s_cselect_b32 s3, 6291456, s3
s_sub_u32 s54, s54, s3
Lc0:
s_add_u32 m0, s29, 98304
s_nop 0
buffer_load_dwordx4 v6, s[12:15], s24 offen offset:0 lds
buffer_load_dwordx4 v7, s[12:15], s24 offen offset:1024 lds
buffer_load_dwordx4 v8, s[12:15], s24 offen offset:2048 lds
buffer_load_dwordx4 v9, s[12:15], s24 offen offset:3072 lds
s_add_u32 s24, s24, 262144
s_lshl_b32 s4, s21, 13
v_and_b32 v24, 15, v0
v_lshlrev_b32 v24, 7, v24
v_add_u32 v24, s4, v24
v_bfe_u32 v25, v0, 1, 3
v_lshrrev_b32 v26, 4, v0
v_xor_b32 v25, v25, v26
v_lshl_add_u32 v10, v25, 4, v24
v_xor_b32 v11, 64, v10
v_bfe_u32 v24, v0, 2, 2
v_lshl_add_u32 v29, v26, 3, v24
v_lshlrev_b32 v25, 9, v29
v_and_b32 v27, 1, v0
v_lshl_add_u32 v25, v27, 3, v25
v_add_u32 v25, 65536, v25
v_lshlrev_b32 v24, 1, v24
v_and_or_b32 v24, v29, 8, v24
v_bfe_u32 v26, v0, 1, 1
s_lshl_b32 s4, s22, 4
s_add_u32 s3, s4, 0
v_add_u32 v27, s3, v26
v_xor_b32 v27, v27, v24
v_lshl_add_u32 v12, v27, 4, v25
s_add_u32 s3, s4, 2
v_add_u32 v27, s3, v26
v_xor_b32 v27, v27, v24
v_lshl_add_u32 v13, v27, 4, v25
s_add_u32 s3, s4, 4
v_add_u32 v27, s3, v26
v_xor_b32 v27, v27, v24
v_lshl_add_u32 v14, v27, 4, v25
s_add_u32 s3, s4, 6
v_add_u32 v27, s3, v26
v_xor_b32 v27, v27, v24
v_lshl_add_u32 v15, v27, 4, v25
s_add_u32 s3, s4, 8
v_add_u32 v27, s3, v26
v_xor_b32 v27, v27, v24
v_lshl_add_u32 v16, v27, 4, v25
s_add_u32 s3, s4, 10
v_add_u32 v27, s3, v26
v_xor_b32 v27, v27, v24
v_lshl_add_u32 v17, v27, 4, v25
s_add_u32 s3, s4, 12
v_add_u32 v27, s3, v26
v_xor_b32 v27, v27, v24
v_lshl_add_u32 v18, v27, 4, v25
s_add_u32 s3, s4, 14
v_add_u32 v27, s3, v26
v_xor_b32 v27, v27, v24
v_lshl_add_u32 v19, v27, 4, v25
s_waitcnt vmcnt(8)
s_barrier
ds_read_b64_tr_b16 a[32:33], v12 offset:0
ds_read_b64_tr_b16 a[34:35], v12 offset:2048
ds_read_b64_tr_b16 a[40:41], v13 offset:0
ds_read_b64_tr_b16 a[42:43], v13 offset:2048
ds_read_b64_tr_b16 a[48:49], v14 offset:0
ds_read_b64_tr_b16 a[50:51], v14 offset:2048
ds_read_b64_tr_b16 a[56:57], v15 offset:0
ds_read_b64_tr_b16 a[58:59], v15 offset:2048
ds_read_b64_tr_b16 a[64:65], v16 offset:0
ds_read_b64_tr_b16 a[66:67], v16 offset:2048
ds_read_b64_tr_b16 a[72:73], v17 offset:0
ds_read_b64_tr_b16 a[74:75], v17 offset:2048
ds_read_b64_tr_b16 a[80:81], v18 offset:0
ds_read_b64_tr_b16 a[82:83], v18 offset:2048
ds_read_b64_tr_b16 a[88:89], v19 offset:0
ds_read_b64_tr_b16 a[90:91], v19 offset:2048
ds_read_b64_tr_b16 a[36:37], v12 offset:16384
ds_read_b64_tr_b16 a[38:39], v12 offset:18432
ds_read_b64_tr_b16 a[44:45], v13 offset:16384
ds_read_b64_tr_b16 a[46:47], v13 offset:18432
ds_read_b64_tr_b16 a[52:53], v14 offset:16384
ds_read_b64_tr_b16 a[54:55], v14 offset:18432
ds_read_b64_tr_b16 a[60:61], v15 offset:16384
ds_read_b64_tr_b16 a[62:63], v15 offset:18432
ds_read_b64_tr_b16 a[68:69], v16 offset:16384
ds_read_b64_tr_b16 a[70:71], v16 offset:18432
ds_read_b64_tr_b16 a[76:77], v17 offset:16384
ds_read_b64_tr_b16 a[78:79], v17 offset:18432
ds_read_b64_tr_b16 a[84:85], v18 offset:16384
ds_read_b64_tr_b16 a[86:87], v18 offset:18432
ds_read_b64_tr_b16 a[92:93], v19 offset:16384
ds_read_b64_tr_b16 a[94:95], v19 offset:18432
ds_read_b128 a[160:163], v10 offset:0
ds_read_b128 a[164:167], v11 offset:0
ds_read_b128 a[168:171], v10 offset:2048
ds_read_b128 a[172:175], v11 offset:2048
s_add_u32 m0, s29, 16384
s_add_u32 s3, s23, s31
s_nop 0
buffer_load_dwordx4 v2, s[8:11], s3 offen offset:0 lds
buffer_load_dwordx4 v3, s[8:11], s3 offen offset:1024 lds
buffer_load_dwordx4 v4, s[8:11], s3 offen offset:2048 lds
buffer_load_dwordx4 v5, s[8:11], s3 offen offset:3072 lds
s_add_u32 s23, s23, 128
s_cmp_eq_u32 s23, s25
s_cselect_b32 s23, s26, s23
s_add_u32 m0, s29, 114688
s_nop 0
buffer_load_dwordx4 v6, s[12:15], s24 offen offset:0 lds
buffer_load_dwordx4 v7, s[12:15], s24 offen offset:1024 lds
buffer_load_dwordx4 v8, s[12:15], s24 offen offset:2048 lds
buffer_load_dwordx4 v9, s[12:15], s24 offen offset:3072 lds
s_add_u32 s24, s24, 262144
s_cmp_eq_u32 s24, s27
s_cselect_b32 s24, s28, s24
s_sub_u32 s6, s6, 1
s_cmp_eq_u32 s6, 0
s_cselect_b64 s[12:13], s[64:65], s[12:13]
s_waitcnt vmcnt(8) lgkmcnt(0)
s_barrier
s_getpc_b64 s[92:93]
Lpc_1:
s_add_u32 s92, s92, Lc1-Lpc_1
s_addc_u32 s93, s93, 0
s_lshr_b32 s94, s2, 3
s_mul_i32 s94, s94, ((Lc3-Lc1)/32+127)&~127
v_lshlrev_b32 v24, 7, v0
v_add_u32 v24, s94, v24
v_min_u32 v24, Lc3-Lc1-4, v24
global_load_dword v21, v24, s[92:93]
Lc1:
s_cmp_lt_u32 s2, 128
s_cbranch_scc0 Lk1_kv
M v[32:35], a[32:35], a[160:163], 0
s_add_u32 m0, s29, 32768
s_nop 0
buffer_load_dwordx4 v2, s[8:11], s23 offen offset:0 lds
M v[32:35], a[36:39], a[164:167], v[32:35]
ds_read_b128 a[176:179], v10 offset:4096
ds_read_b128 a[180:183], v11 offset:4096
M v[36:39], a[44:47], a[164:167], 0
buffer_load_dwordx4 v3, s[8:11], s23 offen offset:1024 lds
M v[36:39], a[40:43], a[160:163], v[36:39]
ds_read_b64_tr_b16 a[96:97], v12 offset:32768
ds_read_b64_tr_b16 a[98:99], v12 offset:34816
M v[40:43], a[48:51], a[160:163], 0
buffer_load_dwordx4 v4, s[8:11], s23 offen offset:2048 lds
M v[40:43], a[52:55], a[164:167], v[40:43]
M v[44:47], a[60:63], a[164:167], 0
buffer_load_dwordx4 v5, s[8:11], s23 offen offset:3072 lds
M v[44:47], a[56:59], a[160:163], v[44:47]
ds_read_b64_tr_b16 a[104:105], v13 offset:32768
ds_read_b64_tr_b16 a[106:107], v13 offset:34816
M v[48:51], a[64:67], a[160:163], 0
s_add_u32 m0, s29, 65536
s_nop 0
buffer_load_dwordx4 v6, s[12:15], s24 offen offset:0 lds
M v[48:51], a[68:71], a[164:167], v[48:51]
M v[52:55], a[76:79], a[164:167], 0
buffer_load_dwordx4 v7, s[12:15], s24 offen offset:1024 lds
M v[52:55], a[72:75], a[160:163], v[52:55]
ds_read_b64_tr_b16 a[112:113], v14 offset:32768
ds_read_b64_tr_b16 a[114:115], v14 offset:34816
M v[56:59], a[80:83], a[160:163], 0
buffer_load_dwordx4 v8, s[12:15], s24 offen offset:2048 lds
M v[56:59], a[84:87], a[164:167], v[56:59]
buffer_load_dwordx4 v9, s[12:15], s24 offen offset:3072 lds
M v[60:63], a[92:95], a[164:167], 0
M v[60:63], a[88:91], a[160:163], v[60:63]
ds_read_b64_tr_b16 a[120:121], v15 offset:32768
ds_read_b64_tr_b16 a[122:123], v15 offset:34816
M v[64:67], a[32:35], a[168:171], 0
s_add_u32 s24, s24, 262144
M v[64:67], a[36:39], a[172:175], v[64:67]
ds_read_b128 a[184:187], v10 offset:6144
ds_read_b128 a[188:191], v11 offset:6144
M v[68:71], a[44:47], a[172:175], 0
s_add_u32 m0, s29, 49152
s_add_u32 s3, s23, s31
buffer_load_dwordx4 v2, s[8:11], s3 offen offset:0 lds
M v[68:71], a[40:43], a[168:171], v[68:71]
ds_read_b64_tr_b16 a[128:129], v16 offset:32768
ds_read_b64_tr_b16 a[130:131], v16 offset:34816
M v[72:75], a[48:51], a[168:171], 0
M v[72:75], a[52:55], a[172:175], v[72:75]
buffer_load_dwordx4 v3, s[8:11], s3 offen offset:1024 lds
M v[76:79], a[60:63], a[172:175], 0
buffer_load_dwordx4 v4, s[8:11], s3 offen offset:2048 lds
M v[76:79], a[56:59], a[168:171], v[76:79]
ds_read_b64_tr_b16 a[136:137], v17 offset:32768
ds_read_b64_tr_b16 a[138:139], v17 offset:34816
M v[80:83], a[64:67], a[168:171], 0
M v[80:83], a[68:71], a[172:175], v[80:83]
buffer_load_dwordx4 v5, s[8:11], s3 offen offset:3072 lds
M v[84:87], a[76:79], a[172:175], 0
s_add_u32 s23, s23, 128
s_cmp_eq_u32 s23, s25
s_cselect_b32 s23, s26, s23
M v[84:87], a[72:75], a[168:171], v[84:87]
ds_read_b64_tr_b16 a[144:145], v18 offset:32768
ds_read_b64_tr_b16 a[146:147], v18 offset:34816
M v[88:91], a[80:83], a[168:171], 0
s_add_u32 m0, s29, 81920
s_nop 0
buffer_load_dwordx4 v6, s[12:15], s24 offen offset:0 lds
M v[88:91], a[84:87], a[172:175], v[88:91]
M v[92:95], a[92:95], a[172:175], 0
buffer_load_dwordx4 v7, s[12:15], s24 offen offset:1024 lds
M v[92:95], a[88:91], a[168:171], v[92:95]
s_waitcnt lgkmcnt(15)
ds_read_b64_tr_b16 a[152:153], v19 offset:32768
ds_read_b64_tr_b16 a[154:155], v19 offset:34816
M v[96:99], a[32:35], a[176:179], 0
buffer_load_dwordx4 v8, s[12:15], s24 offen offset:2048 lds
M v[96:99], a[36:39], a[180:183], v[96:99]
M v[100:103], a[44:47], a[180:183], 0
buffer_load_dwordx4 v9, s[12:15], s24 offen offset:3072 lds
M v[100:103], a[40:43], a[176:179], v[100:103]
s_add_u32 s24, s24, 262144
s_cmp_eq_u32 s24, s27
s_cselect_b32 s24, s28, s24
s_sub_u32 s6, s6, 1
s_cmp_eq_u32 s6, 0
s_cselect_b64 s[12:13], s[64:65], s[12:13]
M v[104:107], a[48:51], a[176:179], 0
M v[104:107], a[52:55], a[180:183], v[104:107]
M v[108:111], a[60:63], a[180:183], 0
M v[108:111], a[56:59], a[176:179], v[108:111]
s_waitcnt vmcnt(17) lgkmcnt(0)
s_barrier
ds_read_b128 a[160:163], v10 offset:16384
ds_read_b128 a[164:167], v11 offset:16384
M v[112:115], a[64:67], a[176:179], 0
s_add_u32 m0, s29, 0
s_nop 0
buffer_load_dwordx4 v2, s[8:11], s23 offen offset:0 lds
M v[112:115], a[68:71], a[180:183], v[112:115]
M v[116:119], a[76:79], a[180:183], 0
M v[116:119], a[72:75], a[176:179], v[116:119]
ds_read_b64_tr_b16 a[100:101], v12 offset:49152
ds_read_b64_tr_b16 a[102:103], v12 offset:51200
M v[120:123], a[80:83], a[176:179], 0
M v[120:123], a[84:87], a[180:183], v[120:123]
buffer_load_dwordx4 v3, s[8:11], s23 offen offset:1024 lds
M v[124:127], a[92:95], a[180:183], 0
M v[124:127], a[88:91], a[176:179], v[124:127]
M v[128:131], a[32:35], a[184:187], 0
M v[128:131], a[36:39], a[188:191], v[128:131]
ds_read_b128 a[168:171], v10 offset:18432
ds_read_b128 a[172:175], v11 offset:18432
ds_read_b64_tr_b16 a[108:109], v13 offset:49152
ds_read_b64_tr_b16 a[110:111], v13 offset:51200
M v[132:135], a[44:47], a[188:191], 0
M v[132:135], a[40:43], a[184:187], v[132:135]
M v[136:139], a[48:51], a[184:187], 0
buffer_load_dwordx4 v4, s[8:11], s23 offen offset:2048 lds
M v[136:139], a[52:55], a[188:191], v[136:139]
M v[140:143], a[60:63], a[188:191], 0
M v[140:143], a[56:59], a[184:187], v[140:143]
ds_read_b64_tr_b16 a[116:117], v14 offset:49152
ds_read_b64_tr_b16 a[118:119], v14 offset:51200
M v[144:147], a[64:67], a[184:187], 0
M v[144:147], a[68:71], a[188:191], v[144:147]
M v[148:151], a[76:79], a[188:191], 0
buffer_load_dwordx4 v5, s[8:11], s23 offen offset:3072 lds
M v[148:151], a[72:75], a[184:187], v[148:151]
M v[152:155], a[80:83], a[184:187], 0
M v[152:155], a[84:87], a[188:191], v[152:155]
ds_read_b64_tr_b16 a[124:125], v15 offset:49152
ds_read_b64_tr_b16 a[126:127], v15 offset:51200
M v[156:159], a[92:95], a[188:191], 0
M v[156:159], a[88:91], a[184:187], v[156:159]
s_waitcnt lgkmcnt(10)
M v[160:163], a[32:35], a[160:163], 0
M v[160:163], a[36:39], a[164:167], v[160:163]
ds_read_b128 a[176:179], v10 offset:20480
ds_read_b128 a[180:183], v11 offset:20480
M v[164:167], a[44:47], a[164:167], 0
s_add_u32 m0, s29, 98304
s_nop 0
buffer_load_dwordx4 v6, s[12:15], s24 offen offset:0 lds
M v[164:167], a[40:43], a[160:163], v[164:167]
ds_read_b64_tr_b16 a[132:133], v16 offset:49152
ds_read_b64_tr_b16 a[134:135], v16 offset:51200
M v[168:171], a[48:51], a[160:163], 0
M v[168:171], a[52:55], a[164:167], v[168:171]
M v[172:175], a[60:63], a[164:167], 0
M v[172:175], a[56:59], a[160:163], v[172:175]
M v[176:179], a[64:67], a[160:163], 0
buffer_load_dwordx4 v7, s[12:15], s24 offen offset:1024 lds
M v[176:179], a[68:71], a[164:167], v[176:179]
ds_read_b64_tr_b16 a[140:141], v17 offset:49152
ds_read_b64_tr_b16 a[142:143], v17 offset:51200
M v[180:183], a[76:79], a[164:167], 0
M v[180:183], a[72:75], a[160:163], v[180:183]
M v[184:187], a[80:83], a[160:163], 0
M v[184:187], a[84:87], a[164:167], v[184:187]
buffer_load_dwordx4 v8, s[12:15], s24 offen offset:2048 lds
M v[188:191], a[92:95], a[164:167], 0
M v[188:191], a[88:91], a[160:163], v[188:191]
s_waitcnt lgkmcnt(12)
ds_read_b64_tr_b16 a[148:149], v18 offset:49152
ds_read_b64_tr_b16 a[150:151], v18 offset:51200
M v[192:195], a[32:35], a[168:171], 0
M v[192:195], a[36:39], a[172:175], v[192:195]
ds_read_b128 a[184:187], v10 offset:22528
ds_read_b128 a[188:191], v11 offset:22528
M v[196:199], a[44:47], a[172:175], 0
M v[196:199], a[40:43], a[168:171], v[196:199]
M v[200:203], a[48:51], a[168:171], 0
buffer_load_dwordx4 v9, s[12:15], s24 offen offset:3072 lds
M v[200:203], a[52:55], a[172:175], v[200:203]
ds_read_b64_tr_b16 a[156:157], v19 offset:49152
ds_read_b64_tr_b16 a[158:159], v19 offset:51200
M v[204:207], a[60:63], a[172:175], 0
M v[204:207], a[56:59], a[168:171], v[204:207]
M v[208:211], a[64:67], a[168:171], 0
M v[208:211], a[68:71], a[172:175], v[208:211]
M v[212:215], a[76:79], a[172:175], 0
s_add_u32 s24, s24, 262144
M v[212:215], a[72:75], a[168:171], v[212:215]
M v[216:219], a[80:83], a[168:171], 0
M v[216:219], a[84:87], a[172:175], v[216:219]
M v[220:223], a[92:95], a[172:175], 0
M v[220:223], a[88:91], a[168:171], v[220:223]
s_waitcnt lgkmcnt(10)
M v[224:227], a[32:35], a[176:179], 0
buffer_load_dword v21, v20, s[60:63], s54 offen
s_add_u32 s54, s54, 1048576
M v[224:227], a[36:39], a[180:183], v[224:227]
M v[228:231], a[44:47], a[180:183], 0
M v[228:231], a[40:43], a[176:179], v[228:231]
M v[232:235], a[48:51], a[176:179], 0
M v[232:235], a[52:55], a[180:183], v[232:235]
M v[236:239], a[60:63], a[180:183], 0
M v[236:239], a[56:59], a[176:179], v[236:239]
s_waitcnt vmcnt(17) lgkmcnt(0)
s_barrier
ds_read_b128 a[160:163], v10 offset:32768
ds_read_b128 a[164:167], v11 offset:32768
M v[240:243], a[64:67], a[176:179], 0
s_add_u32 m0, s29, 16384
s_add_u32 s3, s23, s31
buffer_load_dwordx4 v2, s[8:11], s3 offen offset:0 lds
M v[240:243], a[68:71], a[180:183], v[240:243]
M v[244:247], a[76:79], a[180:183], 0
M v[244:247], a[72:75], a[176:179], v[244:247]
M v[248:251], a[80:83], a[176:179], 0
M v[248:251], a[84:87], a[180:183], v[248:251]
buffer_load_dwordx4 v3, s[8:11], s3 offen offset:1024 lds
M v[252:255], a[92:95], a[180:183], 0
M v[252:255], a[88:91], a[176:179], v[252:255]
M a[0:3], a[32:35], a[184:187], 0
M a[0:3], a[36:39], a[188:191], a[0:3]
ds_read_b128 a[168:171], v10 offset:34816
ds_read_b128 a[172:175], v11 offset:34816
M a[4:7], a[44:47], a[188:191], 0
M a[4:7], a[40:43], a[184:187], a[4:7]
M a[8:11], a[48:51], a[184:187], 0
buffer_load_dwordx4 v4, s[8:11], s3 offen offset:2048 lds
M a[8:11], a[52:55], a[188:191], a[8:11]
M a[12:15], a[60:63], a[188:191], 0
M a[12:15], a[56:59], a[184:187], a[12:15]
M a[16:19], a[64:67], a[184:187], 0
M a[16:19], a[68:71], a[188:191], a[16:19]
buffer_load_dwordx4 v5, s[8:11], s3 offen offset:3072 lds
M a[20:23], a[76:79], a[188:191], 0
M a[20:23], a[72:75], a[184:187], a[20:23]
M a[24:27], a[80:83], a[184:187], 0
M a[24:27], a[84:87], a[188:191], a[24:27]
M a[28:31], a[92:95], a[188:191], 0
M a[28:31], a[88:91], a[184:187], a[28:31]
s_waitcnt lgkmcnt(2)
M v[32:35], a[96:99], a[160:163], v[32:35]
s_add_u32 s23, s23, 128
s_cmp_eq_u32 s23, s25
s_cselect_b32 s23, s26, s23
M v[32:35], a[100:103], a[164:167], v[32:35]
ds_read_b128 a[176:179], v10 offset:36864
ds_read_b128 a[180:183], v11 offset:36864
M v[36:39], a[108:111], a[164:167], v[36:39]
M v[36:39], a[104:107], a[160:163], v[36:39]
ds_read_b64_tr_b16 a[32:33], v12 offset:0
ds_read_b64_tr_b16 a[34:35], v12 offset:2048
M v[40:43], a[112:115], a[160:163], v[40:43]
M v[40:43], a[116:119], a[164:167], v[40:43]
M v[44:47], a[124:127], a[164:167], v[44:47]
s_add_u32 m0, s29, 114688
s_nop 0
buffer_load_dwordx4 v6, s[12:15], s24 offen offset:0 lds
M v[44:47], a[120:123], a[160:163], v[44:47]
ds_read_b64_tr_b16 a[40:41], v13 offset:0
ds_read_b64_tr_b16 a[42:43], v13 offset:2048
M v[48:51], a[128:131], a[160:163], v[48:51]
M v[48:51], a[132:135], a[164:167], v[48:51]
M v[52:55], a[140:143], a[164:167], v[52:55]
M v[52:55], a[136:139], a[160:163], v[52:55]
ds_read_b64_tr_b16 a[48:49], v14 offset:0
ds_read_b64_tr_b16 a[50:51], v14 offset:2048
M v[56:59], a[144:147], a[160:163], v[56:59]
M v[56:59], a[148:151], a[164:167], v[56:59]
buffer_load_dwordx4 v7, s[12:15], s24 offen offset:1024 lds
M v[60:63], a[156:159], a[164:167], v[60:63]
M v[60:63], a[152:155], a[160:163], v[60:63]
s_waitcnt lgkmcnt(8)
ds_read_b64_tr_b16 a[56:57], v15 offset:0
ds_read_b64_tr_b16 a[58:59], v15 offset:2048
M v[64:67], a[96:99], a[168:171], v[64:67]
M v[64:67], a[100:103], a[172:175], v[64:67]
ds_read_b128 a[184:187], v10 offset:38912
ds_read_b128 a[188:191], v11 offset:38912
M v[68:71], a[108:111], a[172:175], v[68:71]
M v[68:71], a[104:107], a[168:171], v[68:71]
ds_read_b64_tr_b16 a[64:65], v16 offset:0
ds_read_b64_tr_b16 a[66:67], v16 offset:2048
M v[72:75], a[112:115], a[168:171], v[72:75]
buffer_load_dwordx4 v8, s[12:15], s24 offen offset:2048 lds
M v[72:75], a[116:119], a[172:175], v[72:75]
M v[76:79], a[124:127], a[172:175], v[76:79]
M v[76:79], a[120:123], a[168:171], v[76:79]
ds_read_b64_tr_b16 a[72:73], v17 offset:0
ds_read_b64_tr_b16 a[74:75], v17 offset:2048
M v[80:83], a[128:131], a[168:171], v[80:83]
M v[80:83], a[132:135], a[172:175], v[80:83]
M v[84:87], a[140:143], a[172:175], v[84:87]
buffer_load_dwordx4 v9, s[12:15], s24 offen offset:3072 lds
M v[84:87], a[136:139], a[168:171], v[84:87]
ds_read_b64_tr_b16 a[80:81], v18 offset:0
ds_read_b64_tr_b16 a[82:83], v18 offset:2048
M v[88:91], a[144:147], a[168:171], v[88:91]
M v[88:91], a[148:151], a[172:175], v[88:91]
M v[92:95], a[156:159], a[172:175], v[92:95]
M v[92:95], a[152:155], a[168:171], v[92:95]
s_waitcnt lgkmcnt(15)
ds_read_b64_tr_b16 a[88:89], v19 offset:0
ds_read_b64_tr_b16 a[90:91], v19 offset:2048
M v[96:99], a[96:99], a[176:179], v[96:99]
s_add_u32 s24, s24, 262144
s_cmp_eq_u32 s24, s27
s_cselect_b32 s24, s28, s24
s_sub_u32 s6, s6, 1
s_cmp_eq_u32 s6, 0
s_cselect_b64 s[12:13], s[64:65], s[12:13]
M v[96:99], a[100:103], a[180:183], v[96:99]
M v[100:103], a[108:111], a[180:183], v[100:103]
M v[100:103], a[104:107], a[176:179], v[100:103]
M v[104:107], a[112:115], a[176:179], v[104:107]
M v[104:107], a[116:119], a[180:183], v[104:107]
M v[108:111], a[124:127], a[180:183], v[108:111]
M v[108:111], a[120:123], a[176:179], v[108:111]
s_waitcnt vmcnt(17) lgkmcnt(0)
s_barrier
ds_read_b128 a[160:163], v10 offset:49152
ds_read_b128 a[164:167], v11 offset:49152
M v[112:115], a[128:131], a[176:179], v[112:115]
s_add_u32 m0, s29, 32768
s_nop 0
buffer_load_dwordx4 v2, s[8:11], s23 offen offset:0 lds
M v[112:115], a[132:135], a[180:183], v[112:115]
M v[116:119], a[140:143], a[180:183], v[116:119]
M v[116:119], a[136:139], a[176:179], v[116:119]
ds_read_b64_tr_b16 a[36:37], v12 offset:16384
ds_read_b64_tr_b16 a[38:39], v12 offset:18432
M v[120:123], a[144:147], a[176:179], v[120:123]
M v[120:123], a[148:151], a[180:183], v[120:123]
buffer_load_dwordx4 v3, s[8:11], s23 offen offset:1024 lds
M v[124:127], a[156:159], a[180:183], v[124:127]
M v[124:127], a[152:155], a[176:179], v[124:127]
M v[128:131], a[96:99], a[184:187], v[128:131]
M v[128:131], a[100:103], a[188:191], v[128:131]
ds_read_b128 a[168:171], v10 offset:51200
ds_read_b128 a[172:175], v11 offset:51200
ds_read_b64_tr_b16 a[44:45], v13 offset:16384
ds_read_b64_tr_b16 a[46:47], v13 offset:18432
M v[132:135], a[108:111], a[188:191], v[132:135]
M v[132:135], a[104:107], a[184:187], v[132:135]
M v[136:139], a[112:115], a[184:187], v[136:139]
buffer_load_dwordx4 v4, s[8:11], s23 offen offset:2048 lds
M v[136:139], a[116:119], a[188:191], v[136:139]
M v[140:143], a[124:127], a[188:191], v[140:143]
M v[140:143], a[120:123], a[184:187], v[140:143]
ds_read_b64_tr_b16 a[52:53], v14 offset:16384
ds_read_b64_tr_b16 a[54:55], v14 offset:18432
M v[144:147], a[128:131], a[184:187], v[144:147]
M v[144:147], a[132:135], a[188:191], v[144:147]
M v[148:151], a[140:143], a[188:191], v[148:151]
buffer_load_dwordx4 v5, s[8:11], s23 offen offset:3072 lds
M v[148:151], a[136:139], a[184:187], v[148:151]
M v[152:155], a[144:147], a[184:187], v[152:155]
M v[152:155], a[148:151], a[188:191], v[152:155]
ds_read_b64_tr_b16 a[60:61], v15 offset:16384
ds_read_b64_tr_b16 a[62:63], v15 offset:18432
M v[156:159], a[156:159], a[188:191], v[156:159]
M v[156:159], a[152:155], a[184:187], v[156:159]
s_waitcnt lgkmcnt(10)
M v[160:163], a[96:99], a[160:163], v[160:163]
M v[160:163], a[100:103], a[164:167], v[160:163]
ds_read_b128 a[176:179], v10 offset:53248
ds_read_b128 a[180:183], v11 offset:53248
M v[164:167], a[108:111], a[164:167], v[164:167]
s_add_u32 m0, s29, 65536
s_nop 0
buffer_load_dwordx4 v6, s[12:15], s24 offen offset:0 lds
M v[164:167], a[104:107], a[160:163], v[164:167]
ds_read_b64_tr_b16 a[68:69], v16 offset:16384
ds_read_b64_tr_b16 a[70:71], v16 offset:18432
M v[168:171], a[112:115], a[160:163], v[168:171]
M v[168:171], a[116:119], a[164:167], v[168:171]
M v[172:175], a[124:127], a[164:167], v[172:175]
M v[172:175], a[120:123], a[160:163], v[172:175]
M v[176:179], a[128:131], a[160:163], v[176:179]
buffer_load_dwordx4 v7, s[12:15], s24 offen offset:1024 lds
M v[176:179], a[132:135], a[164:167], v[176:179]
ds_read_b64_tr_b16 a[76:77], v17 offset:16384
ds_read_b64_tr_b16 a[78:79], v17 offset:18432
M v[180:183], a[140:143], a[164:167], v[180:183]
M v[180:183], a[136:139], a[160:163], v[180:183]
M v[184:187], a[144:147], a[160:163], v[184:187]
M v[184:187], a[148:151], a[164:167], v[184:187]
buffer_load_dwordx4 v8, s[12:15], s24 offen offset:2048 lds
M v[188:191], a[156:159], a[164:167], v[188:191]
M v[188:191], a[152:155], a[160:163], v[188:191]
s_waitcnt lgkmcnt(12)
ds_read_b64_tr_b16 a[84:85], v18 offset:16384
ds_read_b64_tr_b16 a[86:87], v18 offset:18432
M v[192:195], a[96:99], a[168:171], v[192:195]
M v[192:195], a[100:103], a[172:175], v[192:195]
ds_read_b128 a[184:187], v10 offset:55296
ds_read_b128 a[188:191], v11 offset:55296
M v[196:199], a[108:111], a[172:175], v[196:199]
M v[196:199], a[104:107], a[168:171], v[196:199]
M v[200:203], a[112:115], a[168:171], v[200:203]
buffer_load_dwordx4 v9, s[12:15], s24 offen offset:3072 lds
M v[200:203], a[116:119], a[172:175], v[200:203]
ds_read_b64_tr_b16 a[92:93], v19 offset:16384
ds_read_b64_tr_b16 a[94:95], v19 offset:18432
M v[204:207], a[124:127], a[172:175], v[204:207]
M v[204:207], a[120:123], a[168:171], v[204:207]
M v[208:211], a[128:131], a[168:171], v[208:211]
M v[208:211], a[132:135], a[172:175], v[208:211]
M v[212:215], a[140:143], a[172:175], v[212:215]
s_add_u32 s24, s24, 262144
M v[212:215], a[136:139], a[168:171], v[212:215]
M v[216:219], a[144:147], a[168:171], v[216:219]
M v[216:219], a[148:151], a[172:175], v[216:219]
M v[220:223], a[156:159], a[172:175], v[220:223]
M v[220:223], a[152:155], a[168:171], v[220:223]
s_waitcnt lgkmcnt(10)
M v[224:227], a[96:99], a[176:179], v[224:227]
buffer_load_dword v21, v20, s[60:63], s54 offen
s_add_u32 s54, s54, 1048576
M v[224:227], a[100:103], a[180:183], v[224:227]
M v[228:231], a[108:111], a[180:183], v[228:231]
M v[228:231], a[104:107], a[176:179], v[228:231]
M v[232:235], a[112:115], a[176:179], v[232:235]
M v[232:235], a[116:119], a[180:183], v[232:235]
M v[236:239], a[124:127], a[180:183], v[236:239]
M v[236:239], a[120:123], a[176:179], v[236:239]
s_waitcnt vmcnt(18) lgkmcnt(0)
s_barrier
ds_read_b128 a[160:163], v10 offset:0
ds_read_b128 a[164:167], v11 offset:0
M v[240:243], a[128:131], a[176:179], v[240:243]
s_add_u32 m0, s29, 49152
s_add_u32 s3, s23, s31
buffer_load_dwordx4 v2, s[8:11], s3 offen offset:0 lds
M v[240:243], a[132:135], a[180:183], v[240:243]
M v[244:247], a[140:143], a[180:183], v[244:247]
M v[244:247], a[136:139], a[176:179], v[244:247]
M v[248:251], a[144:147], a[176:179], v[248:251]
M v[248:251], a[148:151], a[180:183], v[248:251]
buffer_load_dwordx4 v3, s[8:11], s3 offen offset:1024 lds
M v[252:255], a[156:159], a[180:183], v[252:255]
M v[252:255], a[152:155], a[176:179], v[252:255]
M a[0:3], a[96:99], a[184:187], a[0:3]
M a[0:3], a[100:103], a[188:191], a[0:3]
ds_read_b128 a[168:171], v10 offset:2048
ds_read_b128 a[172:175], v11 offset:2048
M a[4:7], a[108:111], a[188:191], a[4:7]
M a[4:7], a[104:107], a[184:187], a[4:7]
M a[8:11], a[112:115], a[184:187], a[8:11]
buffer_load_dwordx4 v4, s[8:11], s3 offen offset:2048 lds
M a[8:11], a[116:119], a[188:191], a[8:11]
M a[12:15], a[124:127], a[188:191], a[12:15]
M a[12:15], a[120:123], a[184:187], a[12:15]
M a[16:19], a[128:131], a[184:187], a[16:19]
M a[16:19], a[132:135], a[188:191], a[16:19]
buffer_load_dwordx4 v5, s[8:11], s3 offen offset:3072 lds
M a[20:23], a[140:143], a[188:191], a[20:23]
M a[20:23], a[136:139], a[184:187], a[20:23]
M a[24:27], a[144:147], a[184:187], a[24:27]
M a[24:27], a[148:151], a[188:191], a[24:27]
M a[28:31], a[156:159], a[188:191], a[28:31]
M a[28:31], a[152:155], a[184:187], a[28:31]
s_waitcnt lgkmcnt(2)
s_mov_b32 s30, 5
Lk1_ql:
M v[32:35], a[32:35], a[160:163], v[32:35]
s_add_u32 s23, s23, 128
s_cmp_eq_u32 s23, s25
s_cselect_b32 s23, s26, s23
M v[32:35], a[36:39], a[164:167], v[32:35]
ds_read_b128 a[176:179], v10 offset:4096
ds_read_b128 a[180:183], v11 offset:4096
M v[36:39], a[44:47], a[164:167], v[36:39]
M v[36:39], a[40:43], a[160:163], v[36:39]
ds_read_b64_tr_b16 a[96:97], v12 offset:32768
ds_read_b64_tr_b16 a[98:99], v12 offset:34816
M v[40:43], a[48:51], a[160:163], v[40:43]
M v[40:43], a[52:55], a[164:167], v[40:43]
M v[44:47], a[60:63], a[164:167], v[44:47]
s_add_u32 m0, s29, 81920
s_nop 0
buffer_load_dwordx4 v6, s[12:15], s24 offen offset:0 lds
M v[44:47], a[56:59], a[160:163], v[44:47]
ds_read_b64_tr_b16 a[104:105], v13 offset:32768
ds_read_b64_tr_b16 a[106:107], v13 offset:34816
M v[48:51], a[64:67], a[160:163], v[48:51]
M v[48:51], a[68:71], a[164:167], v[48:51]
M v[52:55], a[76:79], a[164:167], v[52:55]
M v[52:55], a[72:75], a[160:163], v[52:55]
ds_read_b64_tr_b16 a[112:113], v14 offset:32768
ds_read_b64_tr_b16 a[114:115], v14 offset:34816
M v[56:59], a[80:83], a[160:163], v[56:59]
M v[56:59], a[84:87], a[164:167], v[56:59]
buffer_load_dwordx4 v7, s[12:15], s24 offen offset:1024 lds
M v[60:63], a[92:95], a[164:167], v[60:63]
M v[60:63], a[88:91], a[160:163], v[60:63]
s_waitcnt lgkmcnt(8)
ds_read_b64_tr_b16 a[120:121], v15 offset:32768
ds_read_b64_tr_b16 a[122:123], v15 offset:34816
M v[64:67], a[32:35], a[168:171], v[64:67]
M v[64:67], a[36:39], a[172:175], v[64:67]
ds_read_b128 a[184:187], v10 offset:6144
ds_read_b128 a[188:191], v11 offset:6144
M v[68:71], a[44:47], a[172:175], v[68:71]
M v[68:71], a[40:43], a[168:171], v[68:71]
ds_read_b64_tr_b16 a[128:129], v16 offset:32768
ds_read_b64_tr_b16 a[130:131], v16 offset:34816
M v[72:75], a[48:51], a[168:171], v[72:75]
buffer_load_dwordx4 v8, s[12:15], s24 offen offset:2048 lds
M v[72:75], a[52:55], a[172:175], v[72:75]
M v[76:79], a[60:63], a[172:175], v[76:79]
M v[76:79], a[56:59], a[168:171], v[76:79]
ds_read_b64_tr_b16 a[136:137], v17 offset:32768
ds_read_b64_tr_b16 a[138:139], v17 offset:34816
M v[80:83], a[64:67], a[168:171], v[80:83]
M v[80:83], a[68:71], a[172:175], v[80:83]
M v[84:87], a[76:79], a[172:175], v[84:87]
buffer_load_dwordx4 v9, s[12:15], s24 offen offset:3072 lds
M v[84:87], a[72:75], a[168:171], v[84:87]
ds_read_b64_tr_b16 a[144:145], v18 offset:32768
ds_read_b64_tr_b16 a[146:147], v18 offset:34816
M v[88:91], a[80:83], a[168:171], v[88:91]
M v[88:91], a[84:87], a[172:175], v[88:91]
M v[92:95], a[92:95], a[172:175], v[92:95]
M v[92:95], a[88:91], a[168:171], v[92:95]
s_waitcnt lgkmcnt(15)
ds_read_b64_tr_b16 a[152:153], v19 offset:32768
ds_read_b64_tr_b16 a[154:155], v19 offset:34816
M v[96:99], a[32:35], a[176:179], v[96:99]
s_add_u32 s24, s24, 262144
s_cmp_eq_u32 s24, s27
s_cselect_b32 s24, s28, s24
s_sub_u32 s6, s6, 1
s_cmp_eq_u32 s6, 0
s_cselect_b64 s[12:13], s[64:65], s[12:13]
M v[96:99], a[36:39], a[180:183], v[96:99]
M v[100:103], a[44:47], a[180:183], v[100:103]
M v[100:103], a[40:43], a[176:179], v[100:103]
M v[104:107], a[48:51], a[176:179], v[104:107]
M v[104:107], a[52:55], a[180:183], v[104:107]
M v[108:111], a[60:63], a[180:183], v[108:111]
M v[108:111], a[56:59], a[176:179], v[108:111]
s_waitcnt vmcnt(17) lgkmcnt(0)
s_barrier
ds_read_b128 a[160:163], v10 offset:16384
ds_read_b128 a[164:167], v11 offset:16384
M v[112:115], a[64:67], a[176:179], v[112:115]
s_add_u32 m0, s29, 0
s_nop 0
buffer_load_dwordx4 v2, s[8:11], s23 offen offset:0 lds
M v[112:115], a[68:71], a[180:183], v[112:115]
M v[116:119], a[76:79], a[180:183], v[116:119]
M v[116:119], a[72:75], a[176:179], v[116:119]
ds_read_b64_tr_b16 a[100:101], v12 offset:49152
ds_read_b64_tr_b16 a[102:103], v12 offset:51200
M v[120:123], a[80:83], a[176:179], v[120:123]
M v[120:123], a[84:87], a[180:183], v[120:123]
buffer_load_dwordx4 v3, s[8:11], s23 offen offset:1024 lds
M v[124:127], a[92:95], a[180:183], v[124:127]
M v[124:127], a[88:91], a[176:179], v[124:127]
M v[128:131], a[32:35], a[184:187], v[128:131]
M v[128:131], a[36:39], a[188:191], v[128:131]
ds_read_b128 a[168:171], v10 offset:18432
ds_read_b128 a[172:175], v11 offset:18432
ds_read_b64_tr_b16 a[108:109], v13 offset:49152
ds_read_b64_tr_b16 a[110:111], v13 offset:51200
M v[132:135], a[44:47], a[188:191], v[132:135]
M v[132:135], a[40:43], a[184:187], v[132:135]
M v[136:139], a[48:51], a[184:187], v[136:139]
buffer_load_dwordx4 v4, s[8:11], s23 offen offset:2048 lds
M v[136:139], a[52:55], a[188:191], v[136:139]
M v[140:143], a[60:63], a[188:191], v[140:143]
M v[140:143], a[56:59], a[184:187], v[140:143]
ds_read_b64_tr_b16 a[116:117], v14 offset:49152
ds_read_b64_tr_b16 a[118:119], v14 offset:51200
M v[144:147], a[64:67], a[184:187], v[144:147]
M v[144:147], a[68:71], a[188:191], v[144:147]
M v[148:151], a[76:79], a[188:191], v[148:151]
buffer_load_dwordx4 v5, s[8:11], s23 offen offset:3072 lds
M v[148:151], a[72:75], a[184:187], v[148:151]
M v[152:155], a[80:83], a[184:187], v[152:155]
M v[152:155], a[84:87], a[188:191], v[152:155]
ds_read_b64_tr_b16 a[124:125], v15 offset:49152
ds_read_b64_tr_b16 a[126:127], v15 offset:51200
M v[156:159], a[92:95], a[188:191], v[156:159]
M v[156:159], a[88:91], a[184:187], v[156:159]
s_waitcnt lgkmcnt(10)
M v[160:163], a[32:35], a[160:163], v[160:163]
M v[160:163], a[36:39], a[164:167], v[160:163]
ds_read_b128 a[176:179], v10 offset:20480
ds_read_b128 a[180:183], v11 offset:20480
M v[164:167], a[44:47], a[164:167], v[164:167]
s_add_u32 m0, s29, 98304
s_nop 0
buffer_load_dwordx4 v6, s[12:15], s24 offen offset:0 lds
M v[164:167], a[40:43], a[160:163], v[164:167]
ds_read_b64_tr_b16 a[132:133], v16 offset:49152
ds_read_b64_tr_b16 a[134:135], v16 offset:51200
M v[168:171], a[48:51], a[160:163], v[168:171]
M v[168:171], a[52:55], a[164:167], v[168:171]
M v[172:175], a[60:63], a[164:167], v[172:175]
M v[172:175], a[56:59], a[160:163], v[172:175]
M v[176:179], a[64:67], a[160:163], v[176:179]
buffer_load_dwordx4 v7, s[12:15], s24 offen offset:1024 lds
M v[176:179], a[68:71], a[164:167], v[176:179]
ds_read_b64_tr_b16 a[140:141], v17 offset:49152
ds_read_b64_tr_b16 a[142:143], v17 offset:51200
M v[180:183], a[76:79], a[164:167], v[180:183]
M v[180:183], a[72:75], a[160:163], v[180:183]
M v[184:187], a[80:83], a[160:163], v[184:187]
M v[184:187], a[84:87], a[164:167], v[184:187]
buffer_load_dwordx4 v8, s[12:15], s24 offen offset:2048 lds
M v[188:191], a[92:95], a[164:167], v[188:191]
M v[188:191], a[88:91], a[160:163], v[188:191]
s_waitcnt lgkmcnt(12)
ds_read_b64_tr_b16 a[148:149], v18 offset:49152
ds_read_b64_tr_b16 a[150:151], v18 offset:51200
M v[192:195], a[32:35], a[168:171], v[192:195]
M v[192:195], a[36:39], a[172:175], v[192:195]
ds_read_b128 a[184:187], v10 offset:22528
ds_read_b128 a[188:191], v11 offset:22528
M v[196:199], a[44:47], a[172:175], v[196:199]
M v[196:199], a[40:43], a[168:171], v[196:199]
M v[200:203], a[48:51], a[168:171], v[200:203]
buffer_load_dwordx4 v9, s[12:15], s24 offen offset:3072 lds
M v[200:203], a[52:55], a[172:175], v[200:203]
ds_read_b64_tr_b16 a[156:157], v19 offset:49152
ds_read_b64_tr_b16 a[158:159], v19 offset:51200
M v[204:207], a[60:63], a[172:175], v[204:207]
M v[204:207], a[56:59], a[168:171], v[204:207]
M v[208:211], a[64:67], a[168:171], v[208:211]
M v[208:211], a[68:71], a[172:175], v[208:211]
M v[212:215], a[76:79], a[172:175], v[212:215]
s_add_u32 s24, s24, 262144
M v[212:215], a[72:75], a[168:171], v[212:215]
M v[216:219], a[80:83], a[168:171], v[216:219]
M v[216:219], a[84:87], a[172:175], v[216:219]
M v[220:223], a[92:95], a[172:175], v[220:223]
M v[220:223], a[88:91], a[168:171], v[220:223]
s_waitcnt lgkmcnt(10)
M v[224:227], a[32:35], a[176:179], v[224:227]
buffer_load_dword v21, v20, s[60:63], s54 offen
s_add_u32 s54, s54, 1048576
M v[224:227], a[36:39], a[180:183], v[224:227]
M v[228:231], a[44:47], a[180:183], v[228:231]
M v[228:231], a[40:43], a[176:179], v[228:231]
M v[232:235], a[48:51], a[176:179], v[232:235]
M v[232:235], a[52:55], a[180:183], v[232:235]
M v[236:239], a[60:63], a[180:183], v[236:239]
M v[236:239], a[56:59], a[176:179], v[236:239]
s_waitcnt vmcnt(18) lgkmcnt(0)
s_barrier
ds_read_b128 a[160:163], v10 offset:32768
ds_read_b128 a[164:167], v11 offset:32768
M v[240:243], a[64:67], a[176:179], v[240:243]
s_add_u32 m0, s29, 16384
s_add_u32 s3, s23, s31
buffer_load_dwordx4 v2, s[8:11], s3 offen offset:0 lds
M v[240:243], a[68:71], a[180:183], v[240:243]
M v[244:247], a[76:79], a[180:183], v[244:247]
M v[244:247], a[72:75], a[176:179], v[244:247]
M v[248:251], a[80:83], a[176:179], v[248:251]
M v[248:251], a[84:87], a[180:183], v[248:251]
buffer_load_dwordx4 v3, s[8:11], s3 offen offset:1024 lds
M v[252:255], a[92:95], a[180:183], v[252:255]
M v[252:255], a[88:91], a[176:179], v[252:255]
M a[0:3], a[32:35], a[184:187], a[0:3]
M a[0:3], a[36:39], a[188:191], a[0:3]
ds_read_b128 a[168:171], v10 offset:34816
ds_read_b128 a[172:175], v11 offset:34816
M a[4:7], a[44:47], a[188:191], a[4:7]
M a[4:7], a[40:43], a[184:187], a[4:7]
M a[8:11], a[48:51], a[184:187], a[8:11]
buffer_load_dwordx4 v4, s[8:11], s3 offen offset:2048 lds
M a[8:11], a[52:55], a[188:191], a[8:11]
M a[12:15], a[60:63], a[188:191], a[12:15]
M a[12:15], a[56:59], a[184:187], a[12:15]
M a[16:19], a[64:67], a[184:187], a[16:19]
M a[16:19], a[68:71], a[188:191], a[16:19]
buffer_load_dwordx4 v5, s[8:11], s3 offen offset:3072 lds
M a[20:23], a[76:79], a[188:191], a[20:23]
M a[20:23], a[72:75], a[184:187], a[20:23]
M a[24:27], a[80:83], a[184:187], a[24:27]
M a[24:27], a[84:87], a[188:191], a[24:27]
M a[28:31], a[92:95], a[188:191], a[28:31]
M a[28:31], a[88:91], a[184:187], a[28:31]
s_waitcnt lgkmcnt(2)
M v[32:35], a[96:99], a[160:163], v[32:35]
s_add_u32 s23, s23, 128
s_cmp_eq_u32 s23, s25
s_cselect_b32 s23, s26, s23
M v[32:35], a[100:103], a[164:167], v[32:35]
ds_read_b128 a[176:179], v10 offset:36864
ds_read_b128 a[180:183], v11 offset:36864
M v[36:39], a[108:111], a[164:167], v[36:39]
M v[36:39], a[104:107], a[160:163], v[36:39]
ds_read_b64_tr_b16 a[32:33], v12 offset:0
ds_read_b64_tr_b16 a[34:35], v12 offset:2048
M v[40:43], a[112:115], a[160:163], v[40:43]
M v[40:43], a[116:119], a[164:167], v[40:43]
M v[44:47], a[124:127], a[164:167], v[44:47]
s_add_u32 m0, s29, 114688
s_nop 0
buffer_load_dwordx4 v6, s[12:15], s24 offen offset:0 lds
M v[44:47], a[120:123], a[160:163], v[44:47]
ds_read_b64_tr_b16 a[40:41], v13 offset:0
ds_read_b64_tr_b16 a[42:43], v13 offset:2048
M v[48:51], a[128:131], a[160:163], v[48:51]
M v[48:51], a[132:135], a[164:167], v[48:51]
M v[52:55], a[140:143], a[164:167], v[52:55]
M v[52:55], a[136:139], a[160:163], v[52:55]
ds_read_b64_tr_b16 a[48:49], v14 offset:0
ds_read_b64_tr_b16 a[50:51], v14 offset:2048
M v[56:59], a[144:147], a[160:163], v[56:59]
M v[56:59], a[148:151], a[164:167], v[56:59]
buffer_load_dwordx4 v7, s[12:15], s24 offen offset:1024 lds
M v[60:63], a[156:159], a[164:167], v[60:63]
M v[60:63], a[152:155], a[160:163], v[60:63]
s_waitcnt lgkmcnt(8)
ds_read_b64_tr_b16 a[56:57], v15 offset:0
ds_read_b64_tr_b16 a[58:59], v15 offset:2048
M v[64:67], a[96:99], a[168:171], v[64:67]
M v[64:67], a[100:103], a[172:175], v[64:67]
ds_read_b128 a[184:187], v10 offset:38912
ds_read_b128 a[188:191], v11 offset:38912
M v[68:71], a[108:111], a[172:175], v[68:71]
M v[68:71], a[104:107], a[168:171], v[68:71]
ds_read_b64_tr_b16 a[64:65], v16 offset:0
ds_read_b64_tr_b16 a[66:67], v16 offset:2048
M v[72:75], a[112:115], a[168:171], v[72:75]
buffer_load_dwordx4 v8, s[12:15], s24 offen offset:2048 lds
M v[72:75], a[116:119], a[172:175], v[72:75]
M v[76:79], a[124:127], a[172:175], v[76:79]
M v[76:79], a[120:123], a[168:171], v[76:79]
ds_read_b64_tr_b16 a[72:73], v17 offset:0
ds_read_b64_tr_b16 a[74:75], v17 offset:2048
M v[80:83], a[128:131], a[168:171], v[80:83]
M v[80:83], a[132:135], a[172:175], v[80:83]
M v[84:87], a[140:143], a[172:175], v[84:87]
buffer_load_dwordx4 v9, s[12:15], s24 offen offset:3072 lds
M v[84:87], a[136:139], a[168:171], v[84:87]
ds_read_b64_tr_b16 a[80:81], v18 offset:0
ds_read_b64_tr_b16 a[82:83], v18 offset:2048
M v[88:91], a[144:147], a[168:171], v[88:91]
M v[88:91], a[148:151], a[172:175], v[88:91]
M v[92:95], a[156:159], a[172:175], v[92:95]
M v[92:95], a[152:155], a[168:171], v[92:95]
s_waitcnt lgkmcnt(15)
ds_read_b64_tr_b16 a[88:89], v19 offset:0
ds_read_b64_tr_b16 a[90:91], v19 offset:2048
M v[96:99], a[96:99], a[176:179], v[96:99]
s_add_u32 s24, s24, 262144
s_cmp_eq_u32 s24, s27
s_cselect_b32 s24, s28, s24
s_sub_u32 s6, s6, 1
s_cmp_eq_u32 s6, 0
s_cselect_b64 s[12:13], s[64:65], s[12:13]
M v[96:99], a[100:103], a[180:183], v[96:99]
M v[100:103], a[108:111], a[180:183], v[100:103]
M v[100:103], a[104:107], a[176:179], v[100:103]
M v[104:107], a[112:115], a[176:179], v[104:107]
M v[104:107], a[116:119], a[180:183], v[104:107]
M v[108:111], a[124:127], a[180:183], v[108:111]
M v[108:111], a[120:123], a[176:179], v[108:111]
s_waitcnt vmcnt(17) lgkmcnt(0)
s_barrier
ds_read_b128 a[160:163], v10 offset:49152
ds_read_b128 a[164:167], v11 offset:49152
M v[112:115], a[128:131], a[176:179], v[112:115]
s_add_u32 m0, s29, 32768
s_nop 0
buffer_load_dwordx4 v2, s[8:11], s23 offen offset:0 lds
M v[112:115], a[132:135], a[180:183], v[112:115]
M v[116:119], a[140:143], a[180:183], v[116:119]
M v[116:119], a[136:139], a[176:179], v[116:119]
ds_read_b64_tr_b16 a[36:37], v12 offset:16384
ds_read_b64_tr_b16 a[38:39], v12 offset:18432
M v[120:123], a[144:147], a[176:179], v[120:123]
M v[120:123], a[148:151], a[180:183], v[120:123]
buffer_load_dwordx4 v3, s[8:11], s23 offen offset:1024 lds
M v[124:127], a[156:159], a[180:183], v[124:127]
M v[124:127], a[152:155], a[176:179], v[124:127]
M v[128:131], a[96:99], a[184:187], v[128:131]
M v[128:131], a[100:103], a[188:191], v[128:131]
ds_read_b128 a[168:171], v10 offset:51200
ds_read_b128 a[172:175], v11 offset:51200
ds_read_b64_tr_b16 a[44:45], v13 offset:16384
ds_read_b64_tr_b16 a[46:47], v13 offset:18432
M v[132:135], a[108:111], a[188:191], v[132:135]
M v[132:135], a[104:107], a[184:187], v[132:135]
M v[136:139], a[112:115], a[184:187], v[136:139]
buffer_load_dwordx4 v4, s[8:11], s23 offen offset:2048 lds
M v[136:139], a[116:119], a[188:191], v[136:139]
M v[140:143], a[124:127], a[188:191], v[140:143]
M v[140:143], a[120:123], a[184:187], v[140:143]
ds_read_b64_tr_b16 a[52:53], v14 offset:16384
ds_read_b64_tr_b16 a[54:55], v14 offset:18432
M v[144:147], a[128:131], a[184:187], v[144:147]
M v[144:147], a[132:135], a[188:191], v[144:147]
M v[148:151], a[140:143], a[188:191], v[148:151]
buffer_load_dwordx4 v5, s[8:11], s23 offen offset:3072 lds
M v[148:151], a[136:139], a[184:187], v[148:151]
M v[152:155], a[144:147], a[184:187], v[152:155]
M v[152:155], a[148:151], a[188:191], v[152:155]
ds_read_b64_tr_b16 a[60:61], v15 offset:16384
ds_read_b64_tr_b16 a[62:63], v15 offset:18432
M v[156:159], a[156:159], a[188:191], v[156:159]
M v[156:159], a[152:155], a[184:187], v[156:159]
s_waitcnt lgkmcnt(10)
M v[160:163], a[96:99], a[160:163], v[160:163]
M v[160:163], a[100:103], a[164:167], v[160:163]
ds_read_b128 a[176:179], v10 offset:53248
ds_read_b128 a[180:183], v11 offset:53248
M v[164:167], a[108:111], a[164:167], v[164:167]
s_add_u32 m0, s29, 65536
s_nop 0
buffer_load_dwordx4 v6, s[12:15], s24 offen offset:0 lds
M v[164:167], a[104:107], a[160:163], v[164:167]
ds_read_b64_tr_b16 a[68:69], v16 offset:16384
ds_read_b64_tr_b16 a[70:71], v16 offset:18432
M v[168:171], a[112:115], a[160:163], v[168:171]
M v[168:171], a[116:119], a[164:167], v[168:171]
M v[172:175], a[124:127], a[164:167], v[172:175]
M v[172:175], a[120:123], a[160:163], v[172:175]
M v[176:179], a[128:131], a[160:163], v[176:179]
buffer_load_dwordx4 v7, s[12:15], s24 offen offset:1024 lds
M v[176:179], a[132:135], a[164:167], v[176:179]
ds_read_b64_tr_b16 a[76:77], v17 offset:16384
ds_read_b64_tr_b16 a[78:79], v17 offset:18432
M v[180:183], a[140:143], a[164:167], v[180:183]
M v[180:183], a[136:139], a[160:163], v[180:183]
M v[184:187], a[144:147], a[160:163], v[184:187]
M v[184:187], a[148:151], a[164:167], v[184:187]
buffer_load_dwordx4 v8, s[12:15], s24 offen offset:2048 lds
M v[188:191], a[156:159], a[164:167], v[188:191]
M v[188:191], a[152:155], a[160:163], v[188:191]
s_waitcnt lgkmcnt(12)
ds_read_b64_tr_b16 a[84:85], v18 offset:16384
ds_read_b64_tr_b16 a[86:87], v18 offset:18432
M v[192:195], a[96:99], a[168:171], v[192:195]
M v[192:195], a[100:103], a[172:175], v[192:195]
ds_read_b128 a[184:187], v10 offset:55296
ds_read_b128 a[188:191], v11 offset:55296
M v[196:199], a[108:111], a[172:175], v[196:199]
M v[196:199], a[104:107], a[168:171], v[196:199]
M v[200:203], a[112:115], a[168:171], v[200:203]
buffer_load_dwordx4 v9, s[12:15], s24 offen offset:3072 lds
M v[200:203], a[116:119], a[172:175], v[200:203]
ds_read_b64_tr_b16 a[92:93], v19 offset:16384
ds_read_b64_tr_b16 a[94:95], v19 offset:18432
M v[204:207], a[124:127], a[172:175], v[204:207]
M v[204:207], a[120:123], a[168:171], v[204:207]
M v[208:211], a[128:131], a[168:171], v[208:211]
M v[208:211], a[132:135], a[172:175], v[208:211]
M v[212:215], a[140:143], a[172:175], v[212:215]
s_add_u32 s24, s24, 262144
M v[212:215], a[136:139], a[168:171], v[212:215]
M v[216:219], a[144:147], a[168:171], v[216:219]
M v[216:219], a[148:151], a[172:175], v[216:219]
M v[220:223], a[156:159], a[172:175], v[220:223]
M v[220:223], a[152:155], a[168:171], v[220:223]
s_waitcnt lgkmcnt(10)
M v[224:227], a[96:99], a[176:179], v[224:227]
buffer_load_dword v21, v20, s[60:63], s54 offen
s_add_u32 s54, s54, 1048576
M v[224:227], a[100:103], a[180:183], v[224:227]
M v[228:231], a[108:111], a[180:183], v[228:231]
M v[228:231], a[104:107], a[176:179], v[228:231]
M v[232:235], a[112:115], a[176:179], v[232:235]
M v[232:235], a[116:119], a[180:183], v[232:235]
M v[236:239], a[124:127], a[180:183], v[236:239]
M v[236:239], a[120:123], a[176:179], v[236:239]
s_waitcnt vmcnt(18) lgkmcnt(0)
s_barrier
ds_read_b128 a[160:163], v10 offset:0
ds_read_b128 a[164:167], v11 offset:0
M v[240:243], a[128:131], a[176:179], v[240:243]
s_add_u32 m0, s29, 49152
s_add_u32 s3, s23, s31
buffer_load_dwordx4 v2, s[8:11], s3 offen offset:0 lds
M v[240:243], a[132:135], a[180:183], v[240:243]
M v[244:247], a[140:143], a[180:183], v[244:247]
M v[244:247], a[136:139], a[176:179], v[244:247]
M v[248:251], a[144:147], a[176:179], v[248:251]
M v[248:251], a[148:151], a[180:183], v[248:251]
buffer_load_dwordx4 v3, s[8:11], s3 offen offset:1024 lds
M v[252:255], a[156:159], a[180:183], v[252:255]
M v[252:255], a[152:155], a[176:179], v[252:255]
M a[0:3], a[96:99], a[184:187], a[0:3]
M a[0:3], a[100:103], a[188:191], a[0:3]
ds_read_b128 a[168:171], v10 offset:2048
ds_read_b128 a[172:175], v11 offset:2048
M a[4:7], a[108:111], a[188:191], a[4:7]
M a[4:7], a[104:107], a[184:187], a[4:7]
M a[8:11], a[112:115], a[184:187], a[8:11]
buffer_load_dwordx4 v4, s[8:11], s3 offen offset:2048 lds
M a[8:11], a[116:119], a[188:191], a[8:11]
M a[12:15], a[124:127], a[188:191], a[12:15]
M a[12:15], a[120:123], a[184:187], a[12:15]
M a[16:19], a[128:131], a[184:187], a[16:19]
M a[16:19], a[132:135], a[188:191], a[16:19]
buffer_load_dwordx4 v5, s[8:11], s3 offen offset:3072 lds
M a[20:23], a[140:143], a[188:191], a[20:23]
M a[20:23], a[136:139], a[184:187], a[20:23]
M a[24:27], a[144:147], a[184:187], a[24:27]
M a[24:27], a[148:151], a[188:191], a[24:27]
M a[28:31], a[156:159], a[188:191], a[28:31]
M a[28:31], a[152:155], a[184:187], a[28:31]
s_waitcnt lgkmcnt(2)
s_sub_u32 s30, s30, 1
s_cmp_lg_u32 s30, 0
s_cbranch_scc1 Lk1_ql
M v[32:35], a[32:35], a[160:163], v[32:35]
s_add_u32 s23, s23, 128
s_cmp_eq_u32 s23, s25
s_cselect_b32 s23, s26, s23
M v[32:35], a[36:39], a[164:167], v[32:35]
ds_read_b128 a[176:179], v10 offset:4096
ds_read_b128 a[180:183], v11 offset:4096
M v[36:39], a[44:47], a[164:167], v[36:39]
M v[36:39], a[40:43], a[160:163], v[36:39]
ds_read_b64_tr_b16 a[96:97], v12 offset:32768
ds_read_b64_tr_b16 a[98:99], v12 offset:34816
M v[40:43], a[48:51], a[160:163], v[40:43]
M v[40:43], a[52:55], a[164:167], v[40:43]
M v[44:47], a[60:63], a[164:167], v[44:47]
s_add_u32 m0, s29, 81920
s_nop 0
buffer_load_dwordx4 v6, s[12:15], s24 offen offset:0 lds
M v[44:47], a[56:59], a[160:163], v[44:47]
ds_read_b64_tr_b16 a[104:105], v13 offset:32768
ds_read_b64_tr_b16 a[106:107], v13 offset:34816
M v[48:51], a[64:67], a[160:163], v[48:51]
M v[48:51], a[68:71], a[164:167], v[48:51]
M v[52:55], a[76:79], a[164:167], v[52:55]
M v[52:55], a[72:75], a[160:163], v[52:55]
ds_read_b64_tr_b16 a[112:113], v14 offset:32768
ds_read_b64_tr_b16 a[114:115], v14 offset:34816
M v[56:59], a[80:83], a[160:163], v[56:59]
M v[56:59], a[84:87], a[164:167], v[56:59]
buffer_load_dwordx4 v7, s[12:15], s24 offen offset:1024 lds
M v[60:63], a[92:95], a[164:167], v[60:63]
M v[60:63], a[88:91], a[160:163], v[60:63]
s_waitcnt lgkmcnt(8)
ds_read_b64_tr_b16 a[120:121], v15 offset:32768
ds_read_b64_tr_b16 a[122:123], v15 offset:34816
M v[64:67], a[32:35], a[168:171], v[64:67]
M v[64:67], a[36:39], a[172:175], v[64:67]
ds_read_b128 a[184:187], v10 offset:6144
ds_read_b128 a[188:191], v11 offset:6144
M v[68:71], a[44:47], a[172:175], v[68:71]
M v[68:71], a[40:43], a[168:171], v[68:71]
ds_read_b64_tr_b16 a[128:129], v16 offset:32768
ds_read_b64_tr_b16 a[130:131], v16 offset:34816
M v[72:75], a[48:51], a[168:171], v[72:75]
buffer_load_dwordx4 v8, s[12:15], s24 offen offset:2048 lds
M v[72:75], a[52:55], a[172:175], v[72:75]
M v[76:79], a[60:63], a[172:175], v[76:79]
M v[76:79], a[56:59], a[168:171], v[76:79]
ds_read_b64_tr_b16 a[136:137], v17 offset:32768
ds_read_b64_tr_b16 a[138:139], v17 offset:34816
M v[80:83], a[64:67], a[168:171], v[80:83]
M v[80:83], a[68:71], a[172:175], v[80:83]
M v[84:87], a[76:79], a[172:175], v[84:87]
buffer_load_dwordx4 v9, s[12:15], s24 offen offset:3072 lds
M v[84:87], a[72:75], a[168:171], v[84:87]
ds_read_b64_tr_b16 a[144:145], v18 offset:32768
ds_read_b64_tr_b16 a[146:147], v18 offset:34816
M v[88:91], a[80:83], a[168:171], v[88:91]
M v[88:91], a[84:87], a[172:175], v[88:91]
M v[92:95], a[92:95], a[172:175], v[92:95]
M v[92:95], a[88:91], a[168:171], v[92:95]
s_waitcnt lgkmcnt(15)
ds_read_b64_tr_b16 a[152:153], v19 offset:32768
ds_read_b64_tr_b16 a[154:155], v19 offset:34816
M v[96:99], a[32:35], a[176:179], v[96:99]
s_add_u32 s24, s24, 262144
s_cmp_eq_u32 s24, s27
s_cselect_b32 s24, s28, s24
s_sub_u32 s6, s6, 1
s_cmp_eq_u32 s6, 0
s_cselect_b64 s[12:13], s[64:65], s[12:13]
M v[96:99], a[36:39], a[180:183], v[96:99]
M v[100:103], a[44:47], a[180:183], v[100:103]
M v[100:103], a[40:43], a[176:179], v[100:103]
M v[104:107], a[48:51], a[176:179], v[104:107]
M v[104:107], a[52:55], a[180:183], v[104:107]
M v[108:111], a[60:63], a[180:183], v[108:111]
M v[108:111], a[56:59], a[176:179], v[108:111]
s_waitcnt vmcnt(17) lgkmcnt(0)
s_barrier
ds_read_b128 a[160:163], v10 offset:16384
ds_read_b128 a[164:167], v11 offset:16384
M v[112:115], a[64:67], a[176:179], v[112:115]
s_add_u32 m0, s29, 0
s_nop 0
buffer_load_dwordx4 v2, s[8:11], s23 offen offset:0 lds
M v[112:115], a[68:71], a[180:183], v[112:115]
M v[116:119], a[76:79], a[180:183], v[116:119]
M v[116:119], a[72:75], a[176:179], v[116:119]
ds_read_b64_tr_b16 a[100:101], v12 offset:49152
ds_read_b64_tr_b16 a[102:103], v12 offset:51200
M v[120:123], a[80:83], a[176:179], v[120:123]
M v[120:123], a[84:87], a[180:183], v[120:123]
M v[124:127], a[92:95], a[180:183], v[124:127]
buffer_load_dwordx4 v3, s[8:11], s23 offen offset:1024 lds
M v[124:127], a[88:91], a[176:179], v[124:127]
M v[128:131], a[32:35], a[184:187], v[128:131]
M v[128:131], a[36:39], a[188:191], v[128:131]
ds_read_b128 a[168:171], v10 offset:18432
ds_read_b128 a[172:175], v11 offset:18432
ds_read_b64_tr_b16 a[108:109], v13 offset:49152
ds_read_b64_tr_b16 a[110:111], v13 offset:51200
M v[132:135], a[44:47], a[188:191], v[132:135]
M v[132:135], a[40:43], a[184:187], v[132:135]
M v[136:139], a[48:51], a[184:187], v[136:139]
M v[136:139], a[52:55], a[188:191], v[136:139]
buffer_load_dwordx4 v4, s[8:11], s23 offen offset:2048 lds
M v[140:143], a[60:63], a[188:191], v[140:143]
M v[140:143], a[56:59], a[184:187], v[140:143]
ds_read_b64_tr_b16 a[116:117], v14 offset:49152
ds_read_b64_tr_b16 a[118:119], v14 offset:51200
M v[144:147], a[64:67], a[184:187], v[144:147]
M v[144:147], a[68:71], a[188:191], v[144:147]
M v[148:151], a[76:79], a[188:191], v[148:151]
M v[148:151], a[72:75], a[184:187], v[148:151]
M v[152:155], a[80:83], a[184:187], v[152:155]
buffer_load_dwordx4 v5, s[8:11], s23 offen offset:3072 lds
M v[152:155], a[84:87], a[188:191], v[152:155]
ds_read_b64_tr_b16 a[124:125], v15 offset:49152
ds_read_b64_tr_b16 a[126:127], v15 offset:51200
M v[156:159], a[92:95], a[188:191], v[156:159]
M v[156:159], a[88:91], a[184:187], v[156:159]
s_waitcnt lgkmcnt(10)
M v[160:163], a[32:35], a[160:163], v[160:163]
M v[160:163], a[36:39], a[164:167], v[160:163]
ds_read_b128 a[176:179], v10 offset:20480
ds_read_b128 a[180:183], v11 offset:20480
M v[164:167], a[44:47], a[164:167], v[164:167]
M v[164:167], a[40:43], a[160:163], v[164:167]
ds_read_b64_tr_b16 a[132:133], v16 offset:49152
ds_read_b64_tr_b16 a[134:135], v16 offset:51200
M v[168:171], a[48:51], a[160:163], v[168:171]
M v[168:171], a[52:55], a[164:167], v[168:171]
s_add_u32 m0, s29, 98304
s_nop 0
buffer_load_dwordx4 v6, s[12:15], s24 offen offset:0 lds
M v[172:175], a[60:63], a[164:167], v[172:175]
M v[172:175], a[56:59], a[160:163], v[172:175]
M v[176:179], a[64:67], a[160:163], v[176:179]
M v[176:179], a[68:71], a[164:167], v[176:179]
ds_read_b64_tr_b16 a[140:141], v17 offset:49152
ds_read_b64_tr_b16 a[142:143], v17 offset:51200
M v[180:183], a[76:79], a[164:167], v[180:183]
M v[180:183], a[72:75], a[160:163], v[180:183]
buffer_load_dwordx4 v7, s[12:15], s24 offen offset:1024 lds
M v[184:187], a[80:83], a[160:163], v[184:187]
M v[184:187], a[84:87], a[164:167], v[184:187]
M v[188:191], a[92:95], a[164:167], v[188:191]
M v[188:191], a[88:91], a[160:163], v[188:191]
s_waitcnt lgkmcnt(12)
ds_read_b64_tr_b16 a[148:149], v18 offset:49152
ds_read_b64_tr_b16 a[150:151], v18 offset:51200
M v[192:195], a[32:35], a[168:171], v[192:195]
M v[192:195], a[36:39], a[172:175], v[192:195]
ds_read_b128 a[184:187], v10 offset:22528
ds_read_b128 a[188:191], v11 offset:22528
M v[196:199], a[44:47], a[172:175], v[196:199]
M v[196:199], a[40:43], a[168:171], v[196:199]
buffer_load_dwordx4 v8, s[12:15], s24 offen offset:2048 lds
M v[200:203], a[48:51], a[168:171], v[200:203]
M v[200:203], a[52:55], a[172:175], v[200:203]
ds_read_b64_tr_b16 a[156:157], v19 offset:49152
ds_read_b64_tr_b16 a[158:159], v19 offset:51200
M v[204:207], a[60:63], a[172:175], v[204:207]
M v[204:207], a[56:59], a[168:171], v[204:207]
M v[208:211], a[64:67], a[168:171], v[208:211]
M v[208:211], a[68:71], a[172:175], v[208:211]
buffer_load_dwordx4 v9, s[12:15], s24 offen offset:3072 lds
M v[212:215], a[76:79], a[172:175], v[212:215]
M v[212:215], a[72:75], a[168:171], v[212:215]
M v[216:219], a[80:83], a[168:171], v[216:219]
M v[216:219], a[84:87], a[172:175], v[216:219]
M v[220:223], a[92:95], a[172:175], v[220:223]
s_add_u32 s24, s24, 262144
M v[220:223], a[88:91], a[168:171], v[220:223]
s_waitcnt lgkmcnt(10)
M v[224:227], a[32:35], a[176:179], v[224:227]
M v[224:227], a[36:39], a[180:183], v[224:227]
M v[228:231], a[44:47], a[180:183], v[228:231]
M v[228:231], a[40:43], a[176:179], v[228:231]
M v[232:235], a[48:51], a[176:179], v[232:235]
M v[232:235], a[52:55], a[180:183], v[232:235]
M v[236:239], a[60:63], a[180:183], v[236:239]
M v[236:239], a[56:59], a[176:179], v[236:239]
s_waitcnt vmcnt(17) lgkmcnt(0)
s_barrier
ds_read_b128 a[160:163], v10 offset:32768
ds_read_b128 a[164:167], v11 offset:32768
M v[240:243], a[64:67], a[176:179], v[240:243]
s_add_u32 m0, s29, 16384
s_add_u32 s3, s23, s31
buffer_load_dwordx4 v2, s[8:11], s3 offen offset:0 lds
M v[240:243], a[68:71], a[180:183], v[240:243]
M v[244:247], a[76:79], a[180:183], v[244:247]
M v[244:247], a[72:75], a[176:179], v[244:247]
M v[248:251], a[80:83], a[176:179], v[248:251]
M v[248:251], a[84:87], a[180:183], v[248:251]
buffer_load_dwordx4 v3, s[8:11], s3 offen offset:1024 lds
M v[252:255], a[92:95], a[180:183], v[252:255]
M v[252:255], a[88:91], a[176:179], v[252:255]
M a[0:3], a[32:35], a[184:187], a[0:3]
M a[0:3], a[36:39], a[188:191], a[0:3]
ds_read_b128 a[168:171], v10 offset:34816
ds_read_b128 a[172:175], v11 offset:34816
M a[4:7], a[44:47], a[188:191], a[4:7]
M a[4:7], a[40:43], a[184:187], a[4:7]
M a[8:11], a[48:51], a[184:187], a[8:11]
buffer_load_dwordx4 v4, s[8:11], s3 offen offset:2048 lds
M a[8:11], a[52:55], a[188:191], a[8:11]
M a[12:15], a[60:63], a[188:191], a[12:15]
M a[12:15], a[56:59], a[184:187], a[12:15]
M a[16:19], a[64:67], a[184:187], a[16:19]
M a[16:19], a[68:71], a[188:191], a[16:19]
buffer_load_dwordx4 v5, s[8:11], s3 offen offset:3072 lds
M a[20:23], a[76:79], a[188:191], a[20:23]
M a[20:23], a[72:75], a[184:187], a[20:23]
M a[24:27], a[80:83], a[184:187], a[24:27]
M a[24:27], a[84:87], a[188:191], a[24:27]
M a[28:31], a[92:95], a[188:191], a[28:31]
M a[28:31], a[88:91], a[184:187], a[28:31]
s_waitcnt lgkmcnt(2)
M v[32:35], a[96:99], a[160:163], v[32:35]
s_add_u32 s23, s23, 128
s_cmp_eq_u32 s23, s25
s_cselect_b32 s23, s26, s23
M v[32:35], a[100:103], a[164:167], v[32:35]
ds_read_b128 a[176:179], v10 offset:36864
ds_read_b128 a[180:183], v11 offset:36864
M v[36:39], a[108:111], a[164:167], v[36:39]
M v[36:39], a[104:107], a[160:163], v[36:39]
ds_read_b64_tr_b16 a[32:33], v12 offset:0
ds_read_b64_tr_b16 a[34:35], v12 offset:2048
M v[40:43], a[112:115], a[160:163], v[40:43]
M v[40:43], a[116:119], a[164:167], v[40:43]
M v[44:47], a[124:127], a[164:167], v[44:47]
s_add_u32 m0, s29, 114688
s_nop 0
buffer_load_dwordx4 v6, s[12:15], s24 offen offset:0 lds
M v[44:47], a[120:123], a[160:163], v[44:47]
ds_read_b64_tr_b16 a[40:41], v13 offset:0
ds_read_b64_tr_b16 a[42:43], v13 offset:2048
M v[48:51], a[128:131], a[160:163], v[48:51]
M v[48:51], a[132:135], a[164:167], v[48:51]
M v[52:55], a[140:143], a[164:167], v[52:55]
M v[52:55], a[136:139], a[160:163], v[52:55]
ds_read_b64_tr_b16 a[48:49], v14 offset:0
ds_read_b64_tr_b16 a[50:51], v14 offset:2048
M v[56:59], a[144:147], a[160:163], v[56:59]
M v[56:59], a[148:151], a[164:167], v[56:59]
buffer_load_dwordx4 v7, s[12:15], s24 offen offset:1024 lds
M v[60:63], a[156:159], a[164:167], v[60:63]
M v[60:63], a[152:155], a[160:163], v[60:63]
s_waitcnt lgkmcnt(8)
ds_read_b64_tr_b16 a[56:57], v15 offset:0
ds_read_b64_tr_b16 a[58:59], v15 offset:2048
M v[64:67], a[96:99], a[168:171], v[64:67]
M v[64:67], a[100:103], a[172:175], v[64:67]
ds_read_b128 a[184:187], v10 offset:38912
ds_read_b128 a[188:191], v11 offset:38912
M v[68:71], a[108:111], a[172:175], v[68:71]
M v[68:71], a[104:107], a[168:171], v[68:71]
ds_read_b64_tr_b16 a[64:65], v16 offset:0
ds_read_b64_tr_b16 a[66:67], v16 offset:2048
M v[72:75], a[112:115], a[168:171], v[72:75]
buffer_load_dwordx4 v8, s[12:15], s24 offen offset:2048 lds
M v[72:75], a[116:119], a[172:175], v[72:75]
M v[76:79], a[124:127], a[172:175], v[76:79]
M v[76:79], a[120:123], a[168:171], v[76:79]
ds_read_b64_tr_b16 a[72:73], v17 offset:0
ds_read_b64_tr_b16 a[74:75], v17 offset:2048
M v[80:83], a[128:131], a[168:171], v[80:83]
M v[80:83], a[132:135], a[172:175], v[80:83]
M v[84:87], a[140:143], a[172:175], v[84:87]
buffer_load_dwordx4 v9, s[12:15], s24 offen offset:3072 lds
M v[84:87], a[136:139], a[168:171], v[84:87]
ds_read_b64_tr_b16 a[80:81], v18 offset:0
ds_read_b64_tr_b16 a[82:83], v18 offset:2048
M v[88:91], a[144:147], a[168:171], v[88:91]
M v[88:91], a[148:151], a[172:175], v[88:91]
M v[92:95], a[156:159], a[172:175], v[92:95]
M v[92:95], a[152:155], a[168:171], v[92:95]
s_waitcnt lgkmcnt(15)
ds_read_b64_tr_b16 a[88:89], v19 offset:0
ds_read_b64_tr_b16 a[90:91], v19 offset:2048
M v[96:99], a[96:99], a[176:179], v[96:99]
s_add_u32 s24, s24, 262144
s_cmp_eq_u32 s24, s27
s_cselect_b32 s24, s28, s24
s_sub_u32 s6, s6, 1
s_cmp_eq_u32 s6, 0
s_cselect_b64 s[12:13], s[64:65], s[12:13]
M v[96:99], a[100:103], a[180:183], v[96:99]
M v[100:103], a[108:111], a[180:183], v[100:103]
M v[100:103], a[104:107], a[176:179], v[100:103]
M v[104:107], a[112:115], a[176:179], v[104:107]
M v[104:107], a[116:119], a[180:183], v[104:107]
M v[108:111], a[124:127], a[180:183], v[108:111]
M v[108:111], a[120:123], a[176:179], v[108:111]
s_waitcnt vmcnt(16) lgkmcnt(0)
s_barrier
ds_read_b128 a[160:163], v10 offset:49152
ds_read_b128 a[164:167], v11 offset:49152
M v[112:115], a[128:131], a[176:179], v[112:115]
s_add_u32 m0, s29, 32768
s_nop 0
buffer_load_dwordx4 v2, s[8:11], s23 offen offset:0 lds
M v[112:115], a[132:135], a[180:183], v[112:115]
M v[116:119], a[140:143], a[180:183], v[116:119]
M v[116:119], a[136:139], a[176:179], v[116:119]
ds_read_b64_tr_b16 a[36:37], v12 offset:16384
ds_read_b64_tr_b16 a[38:39], v12 offset:18432
M v[120:123], a[144:147], a[176:179], v[120:123]
M v[120:123], a[148:151], a[180:183], v[120:123]
M v[124:127], a[156:159], a[180:183], v[124:127]
M v[124:127], a[152:155], a[176:179], v[124:127]
M v[128:131], a[96:99], a[184:187], v[128:131]
M v[128:131], a[100:103], a[188:191], v[128:131]
ds_read_b128 a[168:171], v10 offset:51200
ds_read_b128 a[172:175], v11 offset:51200
ds_read_b64_tr_b16 a[44:45], v13 offset:16384
ds_read_b64_tr_b16 a[46:47], v13 offset:18432
M v[132:135], a[108:111], a[188:191], v[132:135]
M v[132:135], a[104:107], a[184:187], v[132:135]
M v[136:139], a[112:115], a[184:187], v[136:139]
M v[136:139], a[116:119], a[188:191], v[136:139]
M v[140:143], a[124:127], a[188:191], v[140:143]
M v[140:143], a[120:123], a[184:187], v[140:143]
ds_read_b64_tr_b16 a[52:53], v14 offset:16384
ds_read_b64_tr_b16 a[54:55], v14 offset:18432
M v[144:147], a[128:131], a[184:187], v[144:147]
buffer_load_dwordx4 v3, s[8:11], s23 offen offset:1024 lds
M v[144:147], a[132:135], a[188:191], v[144:147]
M v[148:151], a[140:143], a[188:191], v[148:151]
M v[148:151], a[136:139], a[184:187], v[148:151]
M v[152:155], a[144:147], a[184:187], v[152:155]
M v[152:155], a[148:151], a[188:191], v[152:155]
ds_read_b64_tr_b16 a[60:61], v15 offset:16384
ds_read_b64_tr_b16 a[62:63], v15 offset:18432
M v[156:159], a[156:159], a[188:191], v[156:159]
M v[156:159], a[152:155], a[184:187], v[156:159]
s_waitcnt lgkmcnt(10)
M v[160:163], a[96:99], a[160:163], v[160:163]
M v[160:163], a[100:103], a[164:167], v[160:163]
ds_read_b128 a[176:179], v10 offset:53248
ds_read_b128 a[180:183], v11 offset:53248
M v[164:167], a[108:111], a[164:167], v[164:167]
M v[164:167], a[104:107], a[160:163], v[164:167]
ds_read_b64_tr_b16 a[68:69], v16 offset:16384
ds_read_b64_tr_b16 a[70:71], v16 offset:18432
M v[168:171], a[112:115], a[160:163], v[168:171]
M v[168:171], a[116:119], a[164:167], v[168:171]
M v[172:175], a[124:127], a[164:167], v[172:175]
M v[172:175], a[120:123], a[160:163], v[172:175]
M v[176:179], a[128:131], a[160:163], v[176:179]
buffer_load_dwordx4 v4, s[8:11], s23 offen offset:2048 lds
M v[176:179], a[132:135], a[164:167], v[176:179]
ds_read_b64_tr_b16 a[76:77], v17 offset:16384
ds_read_b64_tr_b16 a[78:79], v17 offset:18432
M v[180:183], a[140:143], a[164:167], v[180:183]
M v[180:183], a[136:139], a[160:163], v[180:183]
M v[184:187], a[144:147], a[160:163], v[184:187]
M v[184:187], a[148:151], a[164:167], v[184:187]
M v[188:191], a[156:159], a[164:167], v[188:191]
M v[188:191], a[152:155], a[160:163], v[188:191]
s_waitcnt lgkmcnt(12)
ds_read_b64_tr_b16 a[84:85], v18 offset:16384
ds_read_b64_tr_b16 a[86:87], v18 offset:18432
M v[192:195], a[96:99], a[168:171], v[192:195]
M v[192:195], a[100:103], a[172:175], v[192:195]
ds_read_b128 a[184:187], v10 offset:55296
ds_read_b128 a[188:191], v11 offset:55296
M v[196:199], a[108:111], a[172:175], v[196:199]
M v[196:199], a[104:107], a[168:171], v[196:199]
M v[200:203], a[112:115], a[168:171], v[200:203]
M v[200:203], a[116:119], a[172:175], v[200:203]
ds_read_b64_tr_b16 a[92:93], v19 offset:16384
ds_read_b64_tr_b16 a[94:95], v19 offset:18432
M v[204:207], a[124:127], a[172:175], v[204:207]
M v[204:207], a[120:123], a[168:171], v[204:207]
M v[208:211], a[128:131], a[168:171], v[208:211]
buffer_load_dwordx4 v5, s[8:11], s23 offen offset:3072 lds
M v[208:211], a[132:135], a[172:175], v[208:211]
M v[212:215], a[140:143], a[172:175], v[212:215]
M v[212:215], a[136:139], a[168:171], v[212:215]
M v[216:219], a[144:147], a[168:171], v[216:219]
M v[216:219], a[148:151], a[172:175], v[216:219]
M v[220:223], a[156:159], a[172:175], v[220:223]
M v[220:223], a[152:155], a[168:171], v[220:223]
s_waitcnt lgkmcnt(10)
M v[224:227], a[96:99], a[176:179], v[224:227]
M v[224:227], a[100:103], a[180:183], v[224:227]
M v[228:231], a[108:111], a[180:183], v[228:231]
M v[228:231], a[104:107], a[176:179], v[228:231]
M v[232:235], a[112:115], a[176:179], v[232:235]
M v[232:235], a[116:119], a[180:183], v[232:235]
M v[236:239], a[124:127], a[180:183], v[236:239]
M v[236:239], a[120:123], a[176:179], v[236:239]
s_waitcnt vmcnt(12) lgkmcnt(0)
s_barrier
ds_read_b128 a[160:163], v10 offset:0
ds_read_b128 a[164:167], v11 offset:0
M v[240:243], a[128:131], a[176:179], v[240:243]
s_add_u32 m0, s29, 49152
s_add_u32 s3, s23, s31
buffer_load_dwordx4 v2, s[8:11], s3 offen offset:0 lds
M v[240:243], a[132:135], a[180:183], v[240:243]
M v[244:247], a[140:143], a[180:183], v[244:247]
M v[244:247], a[136:139], a[176:179], v[244:247]
M v[248:251], a[144:147], a[176:179], v[248:251]
M v[248:251], a[148:151], a[180:183], v[248:251]
M v[252:255], a[156:159], a[180:183], v[252:255]
M v[252:255], a[152:155], a[176:179], v[252:255]
M a[0:3], a[96:99], a[184:187], a[0:3]
M a[0:3], a[100:103], a[188:191], a[0:3]
ds_read_b128 a[168:171], v10 offset:2048
ds_read_b128 a[172:175], v11 offset:2048
M a[4:7], a[108:111], a[188:191], a[4:7]
M a[4:7], a[104:107], a[184:187], a[4:7]
M a[8:11], a[112:115], a[184:187], a[8:11]
buffer_load_dwordx4 v3, s[8:11], s3 offen offset:1024 lds
M a[8:11], a[116:119], a[188:191], a[8:11]
M a[12:15], a[124:127], a[188:191], a[12:15]
M a[12:15], a[120:123], a[184:187], a[12:15]
M a[16:19], a[128:131], a[184:187], a[16:19]
M a[16:19], a[132:135], a[188:191], a[16:19]
M a[20:23], a[140:143], a[188:191], a[20:23]
M a[20:23], a[136:139], a[184:187], a[20:23]
M a[24:27], a[144:147], a[184:187], a[24:27]
M a[24:27], a[148:151], a[188:191], a[24:27]
M a[28:31], a[156:159], a[188:191], a[28:31]
M a[28:31], a[152:155], a[184:187], a[28:31]
s_waitcnt lgkmcnt(2)
M v[32:35], a[32:35], a[160:163], v[32:35]
buffer_load_dwordx4 v4, s[8:11], s3 offen offset:2048 lds
M v[32:35], a[36:39], a[164:167], v[32:35]
ds_read_b128 a[176:179], v10 offset:4096
ds_read_b128 a[180:183], v11 offset:4096
M v[36:39], a[44:47], a[164:167], v[36:39]
M v[36:39], a[40:43], a[160:163], v[36:39]
ds_read_b64_tr_b16 a[96:97], v12 offset:32768
ds_read_b64_tr_b16 a[98:99], v12 offset:34816
M v[40:43], a[48:51], a[160:163], v[40:43]
M v[40:43], a[52:55], a[164:167], v[40:43]
M v[44:47], a[60:63], a[164:167], v[44:47]
M v[44:47], a[56:59], a[160:163], v[44:47]
ds_read_b64_tr_b16 a[104:105], v13 offset:32768
ds_read_b64_tr_b16 a[106:107], v13 offset:34816
M v[48:51], a[64:67], a[160:163], v[48:51]
M v[48:51], a[68:71], a[164:167], v[48:51]
M v[52:55], a[76:79], a[164:167], v[52:55]
M v[52:55], a[72:75], a[160:163], v[52:55]
ds_read_b64_tr_b16 a[112:113], v14 offset:32768
ds_read_b64_tr_b16 a[114:115], v14 offset:34816
M v[56:59], a[80:83], a[160:163], v[56:59]
M v[56:59], a[84:87], a[164:167], v[56:59]
buffer_load_dwordx4 v5, s[8:11], s3 offen offset:3072 lds
M v[60:63], a[92:95], a[164:167], v[60:63]
M v[60:63], a[88:91], a[160:163], v[60:63]
s_waitcnt lgkmcnt(8)
ds_read_b64_tr_b16 a[120:121], v15 offset:32768
ds_read_b64_tr_b16 a[122:123], v15 offset:34816
M v[64:67], a[32:35], a[168:171], v[64:67]
M v[64:67], a[36:39], a[172:175], v[64:67]
ds_read_b128 a[184:187], v10 offset:6144
ds_read_b128 a[188:191], v11 offset:6144
M v[68:71], a[44:47], a[172:175], v[68:71]
M v[68:71], a[40:43], a[168:171], v[68:71]
ds_read_b64_tr_b16 a[128:129], v16 offset:32768
ds_read_b64_tr_b16 a[130:131], v16 offset:34816
M v[72:75], a[48:51], a[168:171], v[72:75]
M v[72:75], a[52:55], a[172:175], v[72:75]
M v[76:79], a[60:63], a[172:175], v[76:79]
M v[76:79], a[56:59], a[168:171], v[76:79]
ds_read_b64_tr_b16 a[136:137], v17 offset:32768
ds_read_b64_tr_b16 a[138:139], v17 offset:34816
M v[80:83], a[64:67], a[168:171], v[80:83]
M v[80:83], a[68:71], a[172:175], v[80:83]
M v[84:87], a[76:79], a[172:175], v[84:87]
s_add_u32 s23, s23, 128
s_cmp_eq_u32 s23, s25
s_cselect_b32 s23, s26, s23
M v[84:87], a[72:75], a[168:171], v[84:87]
ds_read_b64_tr_b16 a[144:145], v18 offset:32768
ds_read_b64_tr_b16 a[146:147], v18 offset:34816
M v[88:91], a[80:83], a[168:171], v[88:91]
M v[88:91], a[84:87], a[172:175], v[88:91]
M v[92:95], a[92:95], a[172:175], v[92:95]
M v[92:95], a[88:91], a[168:171], v[92:95]
s_waitcnt lgkmcnt(15)
ds_read_b64_tr_b16 a[152:153], v19 offset:32768
ds_read_b64_tr_b16 a[154:155], v19 offset:34816
M v[96:99], a[32:35], a[176:179], v[96:99]
M v[96:99], a[36:39], a[180:183], v[96:99]
M v[100:103], a[44:47], a[180:183], v[100:103]
M v[100:103], a[40:43], a[176:179], v[100:103]
M v[104:107], a[48:51], a[176:179], v[104:107]
M v[104:107], a[52:55], a[180:183], v[104:107]
M v[108:111], a[60:63], a[180:183], v[108:111]
M v[108:111], a[56:59], a[176:179], v[108:111]
s_waitcnt vmcnt(8) lgkmcnt(0)
s_barrier
ds_read_b128 a[160:163], v10 offset:16384
ds_read_b128 a[164:167], v11 offset:16384
M v[112:115], a[64:67], a[176:179], v[112:115]
M v[112:115], a[68:71], a[180:183], v[112:115]
s_and_b32 s3, s2, 1
s_lshl_b32 s3, s3, 3
s_bfe_u32 s4, s2, 0x30003
M v[116:119], a[76:79], a[180:183], v[116:119]
s_add_u32 s26, s3, s4
s_bfe_u32 s3, s2, 0x20001
s_lshl_b32 s3, s3, 2
M v[116:119], a[72:75], a[176:179], v[116:119]
ds_read_b64_tr_b16 a[100:101], v12 offset:49152
ds_read_b64_tr_b16 a[102:103], v12 offset:51200
s_lshr_b32 s4, s2, 6
s_xor_b32 s4, s4, 2
s_add_u32 s27, s3, s4
M v[120:123], a[80:83], a[176:179], v[120:123]
s_lshl_b32 s23, s26, 18
s_sub_u32 s24, s23, 32768
M v[120:123], a[84:87], a[180:183], v[120:123]
s_max_i32 s24, s24, 0
s_lshl_b32 s25, s27, 7
s_add_u32 s3, s26, s27
M v[124:127], a[92:95], a[180:183], v[124:127]
s_and_b32 s3, s3, 0
s_mul_i32 s3, s3, 16
s_sub_u32 s31, 16, s3
M v[124:127], a[88:91], a[176:179], v[124:127]
s_mov_b32 s54, s31
s_movk_i32 s57, 128
s_mov_b32 s55, 4289069056
M v[128:131], a[32:35], a[184:187], v[128:131]
s_mov_b32 s56, 393216
s_lshl_b32 s4, s3, 7
M v[128:131], a[36:39], a[188:191], v[128:131]
ds_read_b128 a[168:171], v10 offset:18432
ds_read_b128 a[172:175], v11 offset:18432
ds_read_b64_tr_b16 a[108:109], v13 offset:49152
ds_read_b64_tr_b16 a[110:111], v13 offset:51200
s_add_u32 s23, s23, s4
s_add_u32 s24, s24, s4
s_mul_i32 s4, s3, 393216
M v[132:135], a[44:47], a[188:191], v[132:135]
s_add_u32 s25, s25, s4
s_mov_b64 s[8:9], s[44:45]
s_mov_b32 s10, 4194304
M v[132:135], a[40:43], a[184:187], v[132:135]
s_mov_b64 s[12:13], s[46:47]
s_mov_b32 s14, 6291456
M v[136:139], a[48:51], a[184:187], v[136:139]
s_mov_b64 s[36:37], s[90:91]
s_mov_b32 s38, 256
s_mov_b32 s39, 0x00020000
M v[136:139], a[52:55], a[188:191], v[136:139]
s_lshl_b32 s28, s20, 9
s_mul_i32 s30, s20, 6144
s_lshl_b32 s3, s20, 5
M v[140:143], a[60:63], a[188:191], v[140:143]
v_lshrrev_b32 v24, 3, v0
v_and_b32 v25, 7, v0
v_add_u32 v28, s3, v24
M v[140:143], a[56:59], a[184:187], v[140:143]
ds_read_b64_tr_b16 a[116:117], v14 offset:49152
ds_read_b64_tr_b16 a[118:119], v14 offset:51200
v_add_u32 v26, 0, v28
v_bfe_u32 v27, v26, 1, 3
M v[144:147], a[64:67], a[184:187], v[144:147]
v_xor_b32 v27, v27, v25
v_lshlrev_b32 v26, 11, v26
v_lshl_add_u32 v26, v27, 4, v26
M v[144:147], a[68:71], a[188:191], v[144:147]
v_subrev_u32 v2, 0, v26
v_add_u32 v26, 8, v28
v_bfe_u32 v27, v26, 1, 3
M v[148:151], a[76:79], a[188:191], v[148:151]
v_xor_b32 v27, v27, v25
v_lshlrev_b32 v26, 11, v26
v_lshl_add_u32 v26, v27, 4, v26
M v[148:151], a[72:75], a[184:187], v[148:151]
v_subrev_u32 v3, 1024, v26
v_add_u32 v26, 16, v28
M v[152:155], a[80:83], a[184:187], v[152:155]
v_bfe_u32 v27, v26, 1, 3
v_xor_b32 v27, v27, v25
v_lshlrev_b32 v26, 11, v26
M v[152:155], a[84:87], a[188:191], v[152:155]
ds_read_b64_tr_b16 a[124:125], v15 offset:49152
ds_read_b64_tr_b16 a[126:127], v15 offset:51200
v_lshl_add_u32 v26, v27, 4, v26
v_subrev_u32 v4, 2048, v26
v_add_u32 v26, 24, v28
M v[156:159], a[92:95], a[188:191], v[156:159]
v_bfe_u32 v27, v26, 1, 3
v_xor_b32 v27, v27, v25
M v[156:159], a[88:91], a[184:187], v[156:159]
s_waitcnt lgkmcnt(10)
v_lshlrev_b32 v26, 11, v26
v_lshl_add_u32 v26, v27, 4, v26
v_subrev_u32 v5, 3072, v26
M v[160:163], a[32:35], a[160:163], v[160:163]
s_lshl_b32 s3, s20, 2
v_lshrrev_b32 v26, 5, v0
v_add_u32 v26, s3, v26
M v[160:163], a[36:39], a[164:167], v[160:163]
ds_read_b128 a[176:179], v10 offset:20480
ds_read_b128 a[180:183], v11 offset:20480
v_bfe_u32 v29, v0, 2, 3
v_bfe_u32 v27, v26, 1, 3
v_xor_b32 v27, v27, v29
M v[164:167], a[44:47], a[164:167], v[164:167]
v_lshlrev_b32 v27, 4, v27
v_and_b32 v30, 3, v0
M v[164:167], a[40:43], a[160:163], v[164:167]
ds_read_b64_tr_b16 a[132:133], v16 offset:49152
ds_read_b64_tr_b16 a[134:135], v16 offset:51200
v_lshl_add_u32 v27, v30, 2, v27
v_lshl_add_u32 v20, v26, 11, v27
v_add_u32 v26, 2, v26
M v[168:171], a[48:51], a[160:163], v[168:171]
v_bfe_u32 v27, v26, 1, 3
v_xor_b32 v27, v27, v29
v_lshlrev_b32 v27, 4, v27
M v[168:171], a[52:55], a[164:167], v[168:171]
v_and_b32 v30, 3, v0
v_lshl_add_u32 v27, v30, 2, v27
M v[172:175], a[60:63], a[164:167], v[172:175]
v_lshl_add_u32 v23, v26, 11, v27
v_subrev_u32 v23, 256, v23
s_mul_i32 s3, s20, 48
M v[172:175], a[56:59], a[160:163], v[172:175]
v_add_u32 v28, s3, v24
v_add_u32 v26, 0, v28
v_mul_u32_u24 v27, 0xaaab, v26
M v[176:179], a[64:67], a[160:163], v[176:179]
v_lshrrev_b32 v27, 17, v27
v_lshrrev_b32 v29, 1, v27
v_and_b32 v29, 4, v29
M v[176:179], a[68:71], a[164:167], v[176:179]
ds_read_b64_tr_b16 a[140:141], v17 offset:49152
ds_read_b64_tr_b16 a[142:143], v17 offset:51200
v_and_or_b32 v27, v27, 2, v29
v_xor_b32 v27, v27, v25
M v[180:183], a[76:79], a[164:167], v[180:183]
v_lshlrev_b32 v26, 11, v26
v_lshl_add_u32 v26, v27, 4, v26
v_subrev_u32 v6, 0, v26
M v[180:183], a[72:75], a[160:163], v[180:183]
v_add_u32 v26, 8, v28
v_mul_u32_u24 v27, 0xaaab, v26
v_lshrrev_b32 v27, 17, v27
M v[184:187], a[80:83], a[160:163], v[184:187]
v_lshrrev_b32 v29, 1, v27
v_and_b32 v29, 4, v29
v_and_or_b32 v27, v27, 2, v29
M v[184:187], a[84:87], a[164:167], v[184:187]
v_xor_b32 v27, v27, v25
v_lshlrev_b32 v26, 11, v26
M v[188:191], a[92:95], a[164:167], v[188:191]
v_lshl_add_u32 v26, v27, 4, v26
v_subrev_u32 v7, 1024, v26
v_add_u32 v26, 16, v28
M v[188:191], a[88:91], a[160:163], v[188:191]
s_waitcnt lgkmcnt(12)
ds_read_b64_tr_b16 a[148:149], v18 offset:49152
ds_read_b64_tr_b16 a[150:151], v18 offset:51200
v_mul_u32_u24 v27, 0xaaab, v26
v_lshrrev_b32 v27, 17, v27
v_lshrrev_b32 v29, 1, v27
M v[192:195], a[32:35], a[168:171], v[192:195]
v_and_b32 v29, 4, v29
v_and_or_b32 v27, v27, 2, v29
M v[192:195], a[36:39], a[172:175], v[192:195]
ds_read_b128 a[184:187], v10 offset:22528
ds_read_b128 a[188:191], v11 offset:22528
v_xor_b32 v27, v27, v25
v_lshlrev_b32 v26, 11, v26
v_lshl_add_u32 v26, v27, 4, v26
M v[196:199], a[44:47], a[172:175], v[196:199]
v_subrev_u32 v8, 2048, v26
v_add_u32 v26, 24, v28
v_mul_u32_u24 v27, 0xaaab, v26
M v[196:199], a[40:43], a[168:171], v[196:199]
v_lshrrev_b32 v27, 17, v27
v_lshrrev_b32 v29, 1, v27
v_and_b32 v29, 4, v29
M v[200:203], a[48:51], a[168:171], v[200:203]
v_and_or_b32 v27, v27, 2, v29
v_xor_b32 v27, v27, v25
M v[200:203], a[52:55], a[172:175], v[200:203]
ds_read_b64_tr_b16 a[156:157], v19 offset:49152
ds_read_b64_tr_b16 a[158:159], v19 offset:51200
v_lshlrev_b32 v26, 11, v26
v_lshl_add_u32 v26, v27, 4, v26
v_subrev_u32 v9, 3072, v26
M v[204:207], a[60:63], a[172:175], v[204:207]
v_add_u32 v26, 32, v28
v_mul_u32_u24 v27, 0xaaab, v26
v_lshrrev_b32 v27, 17, v27
M v[204:207], a[56:59], a[168:171], v[204:207]
v_lshrrev_b32 v29, 1, v27
v_and_b32 v29, 4, v29
v_and_or_b32 v27, v27, 2, v29
M v[208:211], a[64:67], a[168:171], v[208:211]
v_xor_b32 v27, v27, v25
v_lshlrev_b32 v26, 11, v26
M v[208:211], a[68:71], a[172:175], v[208:211]
v_lshl_add_u32 v26, v27, 4, v26
v_subrev_u32 v21, 0, v26
v_add_u32 v26, 40, v28
M v[212:215], a[76:79], a[172:175], v[212:215]
v_mul_u32_u24 v27, 0xaaab, v26
v_lshrrev_b32 v27, 17, v27
v_lshrrev_b32 v29, 1, v27
M v[212:215], a[72:75], a[168:171], v[212:215]
v_and_b32 v29, 4, v29
v_and_or_b32 v27, v27, 2, v29
M v[216:219], a[80:83], a[168:171], v[216:219]
v_xor_b32 v27, v27, v25
v_lshlrev_b32 v26, 11, v26
v_lshl_add_u32 v26, v27, 4, v26
M v[216:219], a[84:87], a[172:175], v[216:219]
v_subrev_u32 v22, 1024, v26
s_lshr_b32 s3, s53, 7
s_add_u32 s3, s3, s22
M v[220:223], a[92:95], a[172:175], v[220:223]
s_lshl_b32 s3, s3, 5
s_lshr_b32 s19, s52, 6
s_add_u32 s3, s3, s19
M v[220:223], a[88:91], a[168:171], v[220:223]
s_waitcnt lgkmcnt(10)
s_lshl_b32 s19, s21, 1
s_add_u32 s3, s3, s19
M v[224:227], a[32:35], a[176:179], v[224:227]
s_lshl_b32 s92, s3, 14
s_add_u32 s93, s92, 16384
s_add_u32 s16, s50, 0
M v[224:227], a[36:39], a[180:183], v[224:227]
s_addc_u32 s17, s51, 0
s_mov_b32 s18, 16777216
s_mov_b32 s19, 0x00020000
M v[228:231], a[44:47], a[180:183], v[228:231]
s_mov_b32 s4, 0x3e0293ee
s_mov_b32 s5, 0x3e0293ee
M v[228:231], a[40:43], a[176:179], v[228:231]
M v[232:235], a[48:51], a[176:179], v[232:235]
M v[232:235], a[52:55], a[180:183], v[232:235]
M v[236:239], a[60:63], a[180:183], v[236:239]
M v[236:239], a[56:59], a[176:179], v[236:239]
s_waitcnt vmcnt(4) lgkmcnt(0)
s_barrier
ds_read_b128 a[160:163], v10 offset:32768
ds_read_b128 a[164:167], v11 offset:32768
M v[240:243], a[64:67], a[176:179], v[240:243]
s_add_u32 m0, s28, 131072
s_nop 0
buffer_load_dword v20, s[8:11], s24 offen lds
M v[240:243], a[68:71], a[180:183], v[240:243]
M v[244:247], a[76:79], a[180:183], v[244:247]
M v[244:247], a[72:75], a[176:179], v[244:247]
buffer_load_dword v23, s[8:11], s24 offen offset:256 lds
M v[248:251], a[80:83], a[176:179], v[248:251]
M v[248:251], a[84:87], a[180:183], v[248:251]
M v[252:255], a[92:95], a[180:183], v[252:255]
M v[252:255], a[88:91], a[176:179], v[252:255]
M a[0:3], a[32:35], a[184:187], a[0:3]
s_add_u32 m0, s29, 133120
s_nop 0
buffer_load_dwordx4 v2, s[8:11], s23 offen offset:0 lds
M a[0:3], a[36:39], a[188:191], a[0:3]
ds_read_b128 a[168:171], v10 offset:34816
ds_read_b128 a[172:175], v11 offset:34816
M a[4:7], a[44:47], a[188:191], a[4:7]
M a[4:7], a[40:43], a[184:187], a[4:7]
M a[8:11], a[48:51], a[184:187], a[8:11]
buffer_load_dwordx4 v3, s[8:11], s23 offen offset:1024 lds
M a[8:11], a[52:55], a[188:191], a[8:11]
M a[12:15], a[60:63], a[188:191], a[12:15]
M a[12:15], a[56:59], a[184:187], a[12:15]
M a[16:19], a[64:67], a[184:187], a[16:19]
buffer_load_dwordx4 v4, s[8:11], s23 offen offset:2048 lds
M a[16:19], a[68:71], a[188:191], a[16:19]
M a[20:23], a[76:79], a[188:191], a[20:23]
M a[20:23], a[72:75], a[184:187], a[20:23]
buffer_load_dwordx4 v5, s[8:11], s23 offen offset:3072 lds
M a[24:27], a[80:83], a[184:187], a[24:27]
M a[24:27], a[84:87], a[188:191], a[24:27]
M a[28:31], a[92:95], a[188:191], a[28:31]
M a[28:31], a[88:91], a[184:187], a[28:31]
s_waitcnt lgkmcnt(2)
M v[32:35], a[96:99], a[160:163], v[32:35]
s_sub_u32 s31, s31, 1
s_cmp_eq_u32 s31, 0
s_cselect_b32 s58, -1920, s57
s_add_u32 s23, s23, s58
s_add_u32 s24, s24, s58
M v[32:35], a[100:103], a[164:167], v[32:35]
ds_read_b128 a[176:179], v10 offset:36864
ds_read_b128 a[180:183], v11 offset:36864
M v[36:39], a[108:111], a[164:167], v[36:39]
M v[36:39], a[104:107], a[160:163], v[36:39]
M v[40:43], a[112:115], a[160:163], v[40:43]
M v[40:43], a[116:119], a[164:167], v[40:43]
s_add_u32 m0, s30, 65536
s_nop 0
buffer_load_dwordx4 v6, s[12:15], s25 offen offset:0 lds
M v[44:47], a[124:127], a[164:167], v[44:47]
M v[44:47], a[120:123], a[160:163], v[44:47]
M v[48:51], a[128:131], a[160:163], v[48:51]
M v[48:51], a[132:135], a[164:167], v[48:51]
buffer_load_dwordx4 v7, s[12:15], s25 offen offset:1024 lds
M v[52:55], a[140:143], a[164:167], v[52:55]
M v[52:55], a[136:139], a[160:163], v[52:55]
M v[56:59], a[144:147], a[160:163], v[56:59]
M v[56:59], a[148:151], a[164:167], v[56:59]
buffer_load_dwordx4 v8, s[12:15], s25 offen offset:2048 lds
M v[60:63], a[156:159], a[164:167], v[60:63]
M v[60:63], a[152:155], a[160:163], v[60:63]
s_waitcnt lgkmcnt(2)
M v[64:67], a[96:99], a[168:171], v[64:67]
M v[64:67], a[100:103], a[172:175], v[64:67]
ds_read_b128 a[184:187], v10 offset:38912
ds_read_b128 a[188:191], v11 offset:38912
M v[68:71], a[108:111], a[172:175], v[68:71]
M v[68:71], a[104:107], a[168:171], v[68:71]
buffer_load_dwordx4 v9, s[12:15], s25 offen offset:3072 lds
v_pk_mul_f32 v[32:33], v[32:33], s[4:5]
v_pk_mul_f32 v[34:35], v[34:35], s[4:5]
v_pk_mul_f32 v[36:37], v[36:37], s[4:5]
M v[72:75], a[112:115], a[168:171], v[72:75]
v_pk_mul_f32 v[38:39], v[38:39], s[4:5]
v_cvt_pk_bf16_f32 v32, v32, v33
M v[72:75], a[116:119], a[172:175], v[72:75]
v_cvt_pk_bf16_f32 v33, v34, v35
v_cvt_pk_bf16_f32 v34, v36, v37
M v[76:79], a[124:127], a[172:175], v[76:79]
v_cvt_pk_bf16_f32 v35, v38, v39
v_pk_mul_f32 v[40:41], v[40:41], s[4:5]
v_pk_mul_f32 v[42:43], v[42:43], s[4:5]
M v[76:79], a[120:123], a[168:171], v[76:79]
s_add_u32 m0, s30, 69632
s_nop 0
buffer_load_dwordx4 v21, s[12:15], s25 offen offset:0 lds
v_pk_mul_f32 v[44:45], v[44:45], s[4:5]
v_pk_mul_f32 v[46:47], v[46:47], s[4:5]
M v[80:83], a[128:131], a[168:171], v[80:83]
v_cvt_pk_bf16_f32 v40, v40, v41
v_cvt_pk_bf16_f32 v41, v42, v43
M v[80:83], a[132:135], a[172:175], v[80:83]
v_cvt_pk_bf16_f32 v42, v44, v45
v_cvt_pk_bf16_f32 v43, v46, v47
M v[84:87], a[140:143], a[172:175], v[84:87]
v_pk_mul_f32 v[48:49], v[48:49], s[4:5]
v_pk_mul_f32 v[50:51], v[50:51], s[4:5]
v_pk_mul_f32 v[52:53], v[52:53], s[4:5]
M v[84:87], a[136:139], a[168:171], v[84:87]
buffer_load_dwordx4 v22, s[12:15], s25 offen offset:1024 lds
v_pk_mul_f32 v[54:55], v[54:55], s[4:5]
v_cvt_pk_bf16_f32 v48, v48, v49
M v[88:91], a[144:147], a[168:171], v[88:91]
v_cvt_pk_bf16_f32 v49, v50, v51
v_cvt_pk_bf16_f32 v50, v52, v53
M v[88:91], a[148:151], a[172:175], v[88:91]
v_cvt_pk_bf16_f32 v51, v54, v55
v_pk_mul_f32 v[56:57], v[56:57], s[4:5]
v_pk_mul_f32 v[58:59], v[58:59], s[4:5]
M v[92:95], a[156:159], a[172:175], v[92:95]
v_pk_mul_f32 v[60:61], v[60:61], s[4:5]
v_pk_mul_f32 v[62:63], v[62:63], s[4:5]
M v[92:95], a[152:155], a[168:171], v[92:95]
s_waitcnt lgkmcnt(2)
v_cvt_pk_bf16_f32 v56, v56, v57
v_cvt_pk_bf16_f32 v57, v58, v59
M v[96:99], a[96:99], a[176:179], v[96:99]
s_sub_u32 s54, s54, 1
s_cmp_eq_u32 s54, 0
s_cselect_b32 s58, s55, s56
s_add_u32 s25, s25, s58
v_cvt_pk_bf16_f32 v58, v60, v61
v_cvt_pk_bf16_f32 v59, v62, v63
M v[96:99], a[100:103], a[180:183], v[96:99]
M v[100:103], a[108:111], a[180:183], v[100:103]
M v[100:103], a[104:107], a[176:179], v[100:103]
v_pk_mul_f32 v[64:65], v[64:65], s[4:5]
v_pk_mul_f32 v[66:67], v[66:67], s[4:5]
v_pk_mul_f32 v[68:69], v[68:69], s[4:5]
M v[104:107], a[112:115], a[176:179], v[104:107]
s_add_u32 s94, s92, 0
buffer_store_dwordx4 v[32:35], v1, s[16:19], s94 offen offset:0 sc1
v_pk_mul_f32 v[70:71], v[70:71], s[4:5]
v_cvt_pk_bf16_f32 v64, v64, v65
M v[104:107], a[116:119], a[180:183], v[104:107]
v_cvt_pk_bf16_f32 v65, v66, v67
v_cvt_pk_bf16_f32 v66, v68, v69
M v[108:111], a[124:127], a[180:183], v[108:111]
v_cvt_pk_bf16_f32 v67, v70, v71
v_pk_mul_f32 v[72:73], v[72:73], s[4:5]
v_pk_mul_f32 v[74:75], v[74:75], s[4:5]
M v[108:111], a[120:123], a[176:179], v[108:111]
s_waitcnt vmcnt(13) lgkmcnt(0)
s_barrier
ds_read_b128 a[160:163], v10 offset:49152
ds_read_b128 a[164:167], v11 offset:49152
v_pk_mul_f32 v[76:77], v[76:77], s[4:5]
v_pk_mul_f32 v[78:79], v[78:79], s[4:5]
M v[112:115], a[128:131], a[176:179], v[112:115]
s_add_u32 m0, s28, 0
s_nop 0
buffer_load_dword v20, s[8:11], s24 offen lds
v_cvt_pk_bf16_f32 v72, v72, v73
v_cvt_pk_bf16_f32 v73, v74, v75
M v[112:115], a[132:135], a[180:183], v[112:115]
v_cvt_pk_bf16_f32 v74, v76, v77
v_cvt_pk_bf16_f32 v75, v78, v79
M v[116:119], a[140:143], a[180:183], v[116:119]
s_add_u32 s94, s92, 0
buffer_store_dwordx4 v[40:43], v1, s[16:19], s94 offen offset:1024 sc1
v_pk_mul_f32 v[80:81], v[80:81], s[4:5]
v_pk_mul_f32 v[82:83], v[82:83], s[4:5]
v_pk_mul_f32 v[84:85], v[84:85], s[4:5]
M v[116:119], a[136:139], a[176:179], v[116:119]
v_pk_mul_f32 v[86:87], v[86:87], s[4:5]
v_cvt_pk_bf16_f32 v80, v80, v81
M v[120:123], a[144:147], a[176:179], v[120:123]
buffer_load_dword v23, s[8:11], s24 offen offset:256 lds
v_cvt_pk_bf16_f32 v81, v82, v83
v_cvt_pk_bf16_f32 v82, v84, v85
M v[120:123], a[148:151], a[180:183], v[120:123]
v_cvt_pk_bf16_f32 v83, v86, v87
v_pk_mul_f32 v[88:89], v[88:89], s[4:5]
v_pk_mul_f32 v[90:91], v[90:91], s[4:5]
M v[124:127], a[156:159], a[180:183], v[124:127]
v_pk_mul_f32 v[92:93], v[92:93], s[4:5]
v_pk_mul_f32 v[94:95], v[94:95], s[4:5]
M v[124:127], a[152:155], a[176:179], v[124:127]
v_cvt_pk_bf16_f32 v88, v88, v89
v_cvt_pk_bf16_f32 v89, v90, v91
M v[128:131], a[96:99], a[184:187], v[128:131]
s_add_u32 m0, s29, 2048
s_nop 0
buffer_load_dwordx4 v2, s[8:11], s23 offen offset:0 lds
v_cvt_pk_bf16_f32 v90, v92, v93
v_cvt_pk_bf16_f32 v91, v94, v95
M v[128:131], a[100:103], a[188:191], v[128:131]
ds_read_b128 a[168:171], v10 offset:51200
ds_read_b128 a[172:175], v11 offset:51200
M v[132:135], a[108:111], a[188:191], v[132:135]
s_add_u32 s94, s92, 0
buffer_store_dwordx4 v[48:51], v1, s[16:19], s94 offen offset:2048 sc1
M v[132:135], a[104:107], a[184:187], v[132:135]
v_pk_mul_f32 v[96:97], v[96:97], s[4:5]
v_pk_mul_f32 v[98:99], v[98:99], s[4:5]
v_pk_mul_f32 v[100:101], v[100:101], s[4:5]
M v[136:139], a[112:115], a[184:187], v[136:139]
v_pk_mul_f32 v[102:103], v[102:103], s[4:5]
v_cvt_pk_bf16_f32 v96, v96, v97
M v[136:139], a[116:119], a[188:191], v[136:139]
buffer_load_dwordx4 v3, s[8:11], s23 offen offset:1024 lds
v_cvt_pk_bf16_f32 v97, v98, v99
v_cvt_pk_bf16_f32 v98, v100, v101
M v[140:143], a[124:127], a[188:191], v[140:143]
v_cvt_pk_bf16_f32 v99, v102, v103
v_pk_mul_f32 v[104:105], v[104:105], s[4:5]
v_pk_mul_f32 v[106:107], v[106:107], s[4:5]
M v[140:143], a[120:123], a[184:187], v[140:143]
v_pk_mul_f32 v[108:109], v[108:109], s[4:5]
v_pk_mul_f32 v[110:111], v[110:111], s[4:5]
M v[144:147], a[128:131], a[184:187], v[144:147]
s_add_u32 s94, s92, 0
buffer_store_dwordx4 v[56:59], v1, s[16:19], s94 offen offset:3072 sc1
v_cvt_pk_bf16_f32 v104, v104, v105
v_cvt_pk_bf16_f32 v105, v106, v107
M v[144:147], a[132:135], a[188:191], v[144:147]
v_cvt_pk_bf16_f32 v106, v108, v109
v_cvt_pk_bf16_f32 v107, v110, v111
M v[148:151], a[140:143], a[188:191], v[148:151]
buffer_load_dwordx4 v4, s[8:11], s23 offen offset:2048 lds
v_pk_mul_f32 v[112:113], v[112:113], s[4:5]
v_pk_mul_f32 v[114:115], v[114:115], s[4:5]
v_pk_mul_f32 v[116:117], v[116:117], s[4:5]
M v[148:151], a[136:139], a[184:187], v[148:151]
v_pk_mul_f32 v[118:119], v[118:119], s[4:5]
v_cvt_pk_bf16_f32 v112, v112, v113
M v[152:155], a[144:147], a[184:187], v[152:155]
v_cvt_pk_bf16_f32 v113, v114, v115
v_cvt_pk_bf16_f32 v114, v116, v117
M v[152:155], a[148:151], a[188:191], v[152:155]
buffer_load_dwordx4 v5, s[8:11], s23 offen offset:3072 lds
v_cvt_pk_bf16_f32 v115, v118, v119
v_pk_mul_f32 v[120:121], v[120:121], s[4:5]
v_pk_mul_f32 v[122:123], v[122:123], s[4:5]
M v[156:159], a[156:159], a[188:191], v[156:159]
v_pk_mul_f32 v[124:125], v[124:125], s[4:5]
v_pk_mul_f32 v[126:127], v[126:127], s[4:5]
M v[156:159], a[152:155], a[184:187], v[156:159]
s_add_u32 s94, s92, 4096
buffer_store_dwordx4 v[64:67], v1, s[16:19], s94 offen offset:0 sc1
s_waitcnt lgkmcnt(2)
v_cvt_pk_bf16_f32 v120, v120, v121
v_cvt_pk_bf16_f32 v121, v122, v123
M v[160:163], a[96:99], a[160:163], v[160:163]
v_cvt_pk_bf16_f32 v122, v124, v125
v_cvt_pk_bf16_f32 v123, v126, v127
M v[160:163], a[100:103], a[164:167], v[160:163]
ds_read_b128 a[176:179], v10 offset:53248
ds_read_b128 a[180:183], v11 offset:53248
M v[164:167], a[108:111], a[164:167], v[164:167]
s_sub_u32 s31, s31, 1
s_cmp_eq_u32 s31, 0
s_cselect_b32 s58, -1920, s57
s_add_u32 s23, s23, s58
s_add_u32 s24, s24, s58
M v[164:167], a[104:107], a[160:163], v[164:167]
v_pk_mul_f32 v[128:129], v[128:129], s[4:5]
v_pk_mul_f32 v[130:131], v[130:131], s[4:5]
v_pk_mul_f32 v[132:133], v[132:133], s[4:5]
M v[168:171], a[112:115], a[160:163], v[168:171]
v_pk_mul_f32 v[134:135], v[134:135], s[4:5]
v_cvt_pk_bf16_f32 v128, v128, v129
M v[168:171], a[116:119], a[164:167], v[168:171]
s_add_u32 s94, s92, 4096
buffer_store_dwordx4 v[72:75], v1, s[16:19], s94 offen offset:1024 sc1
v_cvt_pk_bf16_f32 v129, v130, v131
v_cvt_pk_bf16_f32 v130, v132, v133
M v[172:175], a[124:127], a[164:167], v[172:175]
v_cvt_pk_bf16_f32 v131, v134, v135
v_pk_mul_f32 v[136:137], v[136:137], s[4:5]
v_pk_mul_f32 v[138:139], v[138:139], s[4:5]
M v[172:175], a[120:123], a[160:163], v[172:175]
s_add_u32 m0, s30, 98304
s_nop 0
buffer_load_dwordx4 v6, s[12:15], s25 offen offset:0 lds
v_pk_mul_f32 v[140:141], v[140:141], s[4:5]
v_pk_mul_f32 v[142:143], v[142:143], s[4:5]
M v[176:179], a[128:131], a[160:163], v[176:179]
v_cvt_pk_bf16_f32 v136, v136, v137
v_cvt_pk_bf16_f32 v137, v138, v139
M v[176:179], a[132:135], a[164:167], v[176:179]
v_cvt_pk_bf16_f32 v138, v140, v141
v_cvt_pk_bf16_f32 v139, v142, v143
M v[180:183], a[140:143], a[164:167], v[180:183]
buffer_load_dwordx4 v7, s[12:15], s25 offen offset:1024 lds
v_pk_mul_f32 v[144:145], v[144:145], s[4:5]
v_pk_mul_f32 v[146:147], v[146:147], s[4:5]
v_pk_mul_f32 v[148:149], v[148:149], s[4:5]
M v[180:183], a[136:139], a[160:163], v[180:183]
v_pk_mul_f32 v[150:151], v[150:151], s[4:5]
v_cvt_pk_bf16_f32 v144, v144, v145
M v[184:187], a[144:147], a[160:163], v[184:187]
s_add_u32 s94, s92, 4096
buffer_store_dwordx4 v[80:83], v1, s[16:19], s94 offen offset:2048 sc1
v_cvt_pk_bf16_f32 v145, v146, v147
v_cvt_pk_bf16_f32 v146, v148, v149
M v[184:187], a[148:151], a[164:167], v[184:187]
v_cvt_pk_bf16_f32 v147, v150, v151
v_pk_mul_f32 v[152:153], v[152:153], s[4:5]
v_pk_mul_f32 v[154:155], v[154:155], s[4:5]
M v[188:191], a[156:159], a[164:167], v[188:191]
buffer_load_dwordx4 v8, s[12:15], s25 offen offset:2048 lds
v_pk_mul_f32 v[156:157], v[156:157], s[4:5]
v_pk_mul_f32 v[158:159], v[158:159], s[4:5]
M v[188:191], a[152:155], a[160:163], v[188:191]
s_waitcnt lgkmcnt(2)
v_cvt_pk_bf16_f32 v152, v152, v153
v_cvt_pk_bf16_f32 v153, v154, v155
M v[192:195], a[96:99], a[168:171], v[192:195]
v_cvt_pk_bf16_f32 v154, v156, v157
v_cvt_pk_bf16_f32 v155, v158, v159
M v[192:195], a[100:103], a[172:175], v[192:195]
ds_read_b128 a[184:187], v10 offset:55296
ds_read_b128 a[188:191], v11 offset:55296
M v[196:199], a[108:111], a[172:175], v[196:199]
M v[196:199], a[104:107], a[168:171], v[196:199]
s_add_u32 s94, s92, 4096
buffer_store_dwordx4 v[88:91], v1, s[16:19], s94 offen offset:3072 sc1
v_pk_mul_f32 v[160:161], v[160:161], s[4:5]
v_pk_mul_f32 v[162:163], v[162:163], s[4:5]
v_pk_mul_f32 v[164:165], v[164:165], s[4:5]
M v[200:203], a[112:115], a[168:171], v[200:203]
buffer_load_dwordx4 v9, s[12:15], s25 offen offset:3072 lds
v_pk_mul_f32 v[166:167], v[166:167], s[4:5]
v_cvt_pk_bf16_f32 v160, v160, v161
M v[200:203], a[116:119], a[172:175], v[200:203]
v_cvt_pk_bf16_f32 v161, v162, v163
v_cvt_pk_bf16_f32 v162, v164, v165
M v[204:207], a[124:127], a[172:175], v[204:207]
v_cvt_pk_bf16_f32 v163, v166, v167
v_pk_mul_f32 v[168:169], v[168:169], s[4:5]
v_pk_mul_f32 v[170:171], v[170:171], s[4:5]
M v[204:207], a[120:123], a[168:171], v[204:207]
v_pk_mul_f32 v[172:173], v[172:173], s[4:5]
v_pk_mul_f32 v[174:175], v[174:175], s[4:5]
M v[208:211], a[128:131], a[168:171], v[208:211]
s_add_u32 m0, s30, 102400
s_nop 0
buffer_load_dwordx4 v21, s[12:15], s25 offen offset:0 lds
v_cvt_pk_bf16_f32 v168, v168, v169
v_cvt_pk_bf16_f32 v169, v170, v171
M v[208:211], a[132:135], a[172:175], v[208:211]
v_cvt_pk_bf16_f32 v170, v172, v173
v_cvt_pk_bf16_f32 v171, v174, v175
M v[212:215], a[140:143], a[172:175], v[212:215]
s_add_u32 s94, s92, 8192
buffer_store_dwordx4 v[96:99], v1, s[16:19], s94 offen offset:0 sc1
v_pk_mul_f32 v[176:177], v[176:177], s[4:5]
v_pk_mul_f32 v[178:179], v[178:179], s[4:5]
v_pk_mul_f32 v[180:181], v[180:181], s[4:5]
M v[212:215], a[136:139], a[168:171], v[212:215]
v_pk_mul_f32 v[182:183], v[182:183], s[4:5]
v_cvt_pk_bf16_f32 v176, v176, v177
M v[216:219], a[144:147], a[168:171], v[216:219]
buffer_load_dwordx4 v22, s[12:15], s25 offen offset:1024 lds
v_cvt_pk_bf16_f32 v177, v178, v179
v_cvt_pk_bf16_f32 v178, v180, v181
M v[216:219], a[148:151], a[172:175], v[216:219]
v_cvt_pk_bf16_f32 v179, v182, v183
v_pk_mul_f32 v[184:185], v[184:185], s[4:5]
v_pk_mul_f32 v[186:187], v[186:187], s[4:5]
M v[220:223], a[156:159], a[172:175], v[220:223]
v_pk_mul_f32 v[188:189], v[188:189], s[4:5]
v_pk_mul_f32 v[190:191], v[190:191], s[4:5]
M v[220:223], a[152:155], a[168:171], v[220:223]
s_waitcnt lgkmcnt(2)
v_cvt_pk_bf16_f32 v184, v184, v185
v_cvt_pk_bf16_f32 v185, v186, v187
M v[224:227], a[96:99], a[176:179], v[224:227]
s_add_u32 s94, s92, 8192
buffer_store_dwordx4 v[104:107], v1, s[16:19], s94 offen offset:1024 sc1
v_cvt_pk_bf16_f32 v186, v188, v189
v_cvt_pk_bf16_f32 v187, v190, v191
M v[224:227], a[100:103], a[180:183], v[224:227]
s_sub_u32 s54, s54, 1
s_cmp_eq_u32 s54, 0
s_cselect_b32 s58, s55, s56
s_add_u32 s25, s25, s58
M v[228:231], a[108:111], a[180:183], v[228:231]
M v[228:231], a[104:107], a[176:179], v[228:231]
v_pk_mul_f32 v[192:193], v[192:193], s[4:5]
v_pk_mul_f32 v[194:195], v[194:195], s[4:5]
v_pk_mul_f32 v[196:197], v[196:197], s[4:5]
M v[232:235], a[112:115], a[176:179], v[232:235]
v_pk_mul_f32 v[198:199], v[198:199], s[4:5]
v_cvt_pk_bf16_f32 v192, v192, v193
M v[232:235], a[116:119], a[180:183], v[232:235]
v_cvt_pk_bf16_f32 v193, v194, v195
v_cvt_pk_bf16_f32 v194, v196, v197
M v[236:239], a[124:127], a[180:183], v[236:239]
v_cvt_pk_bf16_f32 v195, v198, v199
v_pk_mul_f32 v[200:201], v[200:201], s[4:5]
v_pk_mul_f32 v[202:203], v[202:203], s[4:5]
M v[236:239], a[120:123], a[176:179], v[236:239]
s_waitcnt vmcnt(63) lgkmcnt(0)
s_barrier
v_pk_mul_f32 v[204:205], v[204:205], s[4:5]
v_pk_mul_f32 v[206:207], v[206:207], s[4:5]
M v[240:243], a[128:131], a[176:179], v[240:243]
s_add_u32 s94, s92, 8192
buffer_store_dwordx4 v[112:115], v1, s[16:19], s94 offen offset:2048 sc1
v_cvt_pk_bf16_f32 v200, v200, v201
v_cvt_pk_bf16_f32 v201, v202, v203
M v[240:243], a[132:135], a[180:183], v[240:243]
s_add_u32 m0, s28, 18432
s_nop 0
buffer_load_dword v20, s[8:11], s24 offen lds
v_cvt_pk_bf16_f32 v202, v204, v205
v_cvt_pk_bf16_f32 v203, v206, v207
M v[244:247], a[140:143], a[180:183], v[244:247]
v_pk_mul_f32 v[208:209], v[208:209], s[4:5]
v_pk_mul_f32 v[210:211], v[210:211], s[4:5]
v_pk_mul_f32 v[212:213], v[212:213], s[4:5]
M v[244:247], a[136:139], a[176:179], v[244:247]
v_pk_mul_f32 v[214:215], v[214:215], s[4:5]
v_cvt_pk_bf16_f32 v208, v208, v209
M v[248:251], a[144:147], a[176:179], v[248:251]
buffer_load_dword v23, s[8:11], s24 offen offset:256 lds
v_cvt_pk_bf16_f32 v209, v210, v211
v_cvt_pk_bf16_f32 v210, v212, v213
M v[248:251], a[148:151], a[180:183], v[248:251]
v_cvt_pk_bf16_f32 v211, v214, v215
v_pk_mul_f32 v[216:217], v[216:217], s[4:5]
v_pk_mul_f32 v[218:219], v[218:219], s[4:5]
M v[252:255], a[156:159], a[180:183], v[252:255]
s_add_u32 s94, s92, 8192
buffer_store_dwordx4 v[120:123], v1, s[16:19], s94 offen offset:3072 sc1
v_pk_mul_f32 v[220:221], v[220:221], s[4:5]
v_pk_mul_f32 v[222:223], v[222:223], s[4:5]
M v[252:255], a[152:155], a[176:179], v[252:255]
v_cvt_pk_bf16_f32 v216, v216, v217
v_cvt_pk_bf16_f32 v217, v218, v219
M a[0:3], a[96:99], a[184:187], a[0:3]
v_cvt_pk_bf16_f32 v218, v220, v221
v_cvt_pk_bf16_f32 v219, v222, v223
M a[0:3], a[100:103], a[188:191], a[0:3]
s_add_u32 m0, s29, 20480
s_nop 0
buffer_load_dwordx4 v2, s[8:11], s23 offen offset:0 lds
M a[4:7], a[108:111], a[188:191], a[4:7]
M a[4:7], a[104:107], a[184:187], a[4:7]
v_pk_mul_f32 v[224:225], v[224:225], s[4:5]
v_pk_mul_f32 v[226:227], v[226:227], s[4:5]
v_pk_mul_f32 v[228:229], v[228:229], s[4:5]
M a[8:11], a[112:115], a[184:187], a[8:11]
buffer_load_dwordx4 v3, s[8:11], s23 offen offset:1024 lds
v_pk_mul_f32 v[230:231], v[230:231], s[4:5]
v_cvt_pk_bf16_f32 v224, v224, v225
M a[8:11], a[116:119], a[188:191], a[8:11]
s_add_u32 s94, s92, 12288
buffer_store_dwordx4 v[128:131], v1, s[16:19], s94 offen offset:0 sc1
v_cvt_pk_bf16_f32 v225, v226, v227
v_cvt_pk_bf16_f32 v226, v228, v229
M a[12:15], a[124:127], a[188:191], a[12:15]
v_cvt_pk_bf16_f32 v227, v230, v231
v_pk_mul_f32 v[232:233], v[232:233], s[4:5]
v_pk_mul_f32 v[234:235], v[234:235], s[4:5]
M a[12:15], a[120:123], a[184:187], a[12:15]
v_pk_mul_f32 v[236:237], v[236:237], s[4:5]
v_pk_mul_f32 v[238:239], v[238:239], s[4:5]
M a[16:19], a[128:131], a[184:187], a[16:19]
buffer_load_dwordx4 v4, s[8:11], s23 offen offset:2048 lds
v_cvt_pk_bf16_f32 v232, v232, v233
v_cvt_pk_bf16_f32 v233, v234, v235
M a[16:19], a[132:135], a[188:191], a[16:19]
v_cvt_pk_bf16_f32 v234, v236, v237
v_cvt_pk_bf16_f32 v235, v238, v239
M a[20:23], a[140:143], a[188:191], a[20:23]
v_pk_mul_f32 v[240:241], v[240:241], s[4:5]
v_pk_mul_f32 v[242:243], v[242:243], s[4:5]
v_pk_mul_f32 v[244:245], v[244:245], s[4:5]
M a[20:23], a[136:139], a[184:187], a[20:23]
buffer_load_dwordx4 v5, s[8:11], s23 offen offset:3072 lds
v_pk_mul_f32 v[246:247], v[246:247], s[4:5]
v_cvt_pk_bf16_f32 v240, v240, v241
M a[24:27], a[144:147], a[184:187], a[24:27]
s_add_u32 s94, s92, 12288
buffer_store_dwordx4 v[136:139], v1, s[16:19], s94 offen offset:1024 sc1
v_cvt_pk_bf16_f32 v241, v242, v243
v_cvt_pk_bf16_f32 v242, v244, v245
M a[24:27], a[148:151], a[188:191], a[24:27]
v_cvt_pk_bf16_f32 v243, v246, v247
v_pk_mul_f32 v[248:249], v[248:249], s[4:5]
v_pk_mul_f32 v[250:251], v[250:251], s[4:5]
M a[28:31], a[156:159], a[188:191], a[28:31]
v_pk_mul_f32 v[252:253], v[252:253], s[4:5]
v_pk_mul_f32 v[254:255], v[254:255], s[4:5]
M a[28:31], a[152:155], a[184:187], a[28:31]
v_cvt_pk_bf16_f32 v248, v248, v249
v_cvt_pk_bf16_f32 v249, v250, v251
v_cvt_pk_bf16_f32 v250, v252, v253
v_cvt_pk_bf16_f32 v251, v254, v255
v_accvgpr_read_b32 v24, a0
v_accvgpr_read_b32 v25, a1
v_accvgpr_read_b32 v26, a2
v_accvgpr_read_b32 v27, a3
v_accvgpr_read_b32 v28, a4
v_accvgpr_read_b32 v29, a5
v_accvgpr_read_b32 v30, a6
v_accvgpr_read_b32 v31, a7
v_pk_mul_f32 v[24:25], v[24:25], s[4:5]
v_pk_mul_f32 v[26:27], v[26:27], s[4:5]
v_pk_mul_f32 v[28:29], v[28:29], s[4:5]
v_pk_mul_f32 v[30:31], v[30:31], s[4:5]
v_cvt_pk_bf16_f32 v36, v24, v25
v_cvt_pk_bf16_f32 v37, v26, v27
v_cvt_pk_bf16_f32 v38, v28, v29
v_cvt_pk_bf16_f32 v39, v30, v31
v_accvgpr_read_b32 v24, a8
v_accvgpr_read_b32 v25, a9
v_accvgpr_read_b32 v26, a10
v_accvgpr_read_b32 v27, a11
v_accvgpr_read_b32 v28, a12
v_accvgpr_read_b32 v29, a13
v_accvgpr_read_b32 v30, a14
v_accvgpr_read_b32 v31, a15
v_pk_mul_f32 v[24:25], v[24:25], s[4:5]
v_pk_mul_f32 v[26:27], v[26:27], s[4:5]
v_pk_mul_f32 v[28:29], v[28:29], s[4:5]
v_pk_mul_f32 v[30:31], v[30:31], s[4:5]
v_cvt_pk_bf16_f32 v44, v24, v25
v_cvt_pk_bf16_f32 v45, v26, v27
v_cvt_pk_bf16_f32 v46, v28, v29
v_cvt_pk_bf16_f32 v47, v30, v31
v_accvgpr_read_b32 v24, a16
v_accvgpr_read_b32 v25, a17
v_accvgpr_read_b32 v26, a18
v_accvgpr_read_b32 v27, a19
v_accvgpr_read_b32 v28, a20
v_accvgpr_read_b32 v29, a21
v_accvgpr_read_b32 v30, a22
v_accvgpr_read_b32 v31, a23
v_pk_mul_f32 v[24:25], v[24:25], s[4:5]
v_pk_mul_f32 v[26:27], v[26:27], s[4:5]
v_pk_mul_f32 v[28:29], v[28:29], s[4:5]
v_pk_mul_f32 v[30:31], v[30:31], s[4:5]
v_cvt_pk_bf16_f32 v52, v24, v25
v_cvt_pk_bf16_f32 v53, v26, v27
v_cvt_pk_bf16_f32 v54, v28, v29
v_cvt_pk_bf16_f32 v55, v30, v31
v_accvgpr_read_b32 v24, a24
v_accvgpr_read_b32 v25, a25
v_accvgpr_read_b32 v26, a26
v_accvgpr_read_b32 v27, a27
v_accvgpr_read_b32 v28, a28
v_accvgpr_read_b32 v29, a29
v_accvgpr_read_b32 v30, a30
v_accvgpr_read_b32 v31, a31
v_pk_mul_f32 v[24:25], v[24:25], s[4:5]
v_pk_mul_f32 v[26:27], v[26:27], s[4:5]
v_pk_mul_f32 v[28:29], v[28:29], s[4:5]
v_pk_mul_f32 v[30:31], v[30:31], s[4:5]
v_cvt_pk_bf16_f32 v60, v24, v25
v_cvt_pk_bf16_f32 v61, v26, v27
v_cvt_pk_bf16_f32 v62, v28, v29
v_cvt_pk_bf16_f32 v63, v30, v31
s_branch Lk1_b
Lk1_spin:
s_add_u32 s40, s40, 1
s_cmp_gt_u32 s40, 1048576
s_cbranch_scc1 Lk1_got
s_sleep 2
buffer_load_dword v126, v119, s[36:39], 0 offen offset:128 sc1
s_waitcnt vmcnt(0)
v_cmp_gt_u32 vcc, 0x80, v126
s_nop 0
s_cbranch_vccnz Lk1_spin
s_branch Lk1_got
Lk1_spinq:
s_add_u32 s40, s40, 1
s_cmp_gt_u32 s40, 1048576
s_cbranch_scc1 Lk1_gotq
s_sleep 2
buffer_load_dword v125, v119, s[36:39], 0 offen offset:0 sc1
s_waitcnt vmcnt(0)
v_cmp_gt_u32 vcc, 0x80, v125
s_nop 0
s_cbranch_vccnz Lk1_spinq
s_branch Lk1_gotq
Lk1_kv:
M v[32:35], a[32:35], a[160:163], 0
s_add_u32 m0, s29, 32768
s_nop 0
buffer_load_dwordx4 v2, s[8:11], s23 offen offset:0 lds
M v[32:35], a[36:39], a[164:167], v[32:35]
ds_read_b128 a[176:179], v10 offset:4096
ds_read_b128 a[180:183], v11 offset:4096
M v[36:39], a[44:47], a[164:167], 0
buffer_load_dwordx4 v3, s[8:11], s23 offen offset:1024 lds
M v[36:39], a[40:43], a[160:163], v[36:39]
ds_read_b64_tr_b16 a[96:97], v12 offset:32768
ds_read_b64_tr_b16 a[98:99], v12 offset:34816
M v[40:43], a[48:51], a[160:163], 0
buffer_load_dwordx4 v4, s[8:11], s23 offen offset:2048 lds
M v[40:43], a[52:55], a[164:167], v[40:43]
M v[44:47], a[60:63], a[164:167], 0
buffer_load_dwordx4 v5, s[8:11], s23 offen offset:3072 lds
M v[44:47], a[56:59], a[160:163], v[44:47]
ds_read_b64_tr_b16 a[104:105], v13 offset:32768
ds_read_b64_tr_b16 a[106:107], v13 offset:34816
M v[48:51], a[64:67], a[160:163], 0
s_add_u32 m0, s29, 65536
s_nop 0
buffer_load_dwordx4 v6, s[12:15], s24 offen offset:0 lds
M v[48:51], a[68:71], a[164:167], v[48:51]
M v[52:55], a[76:79], a[164:167], 0
buffer_load_dwordx4 v7, s[12:15], s24 offen offset:1024 lds
M v[52:55], a[72:75], a[160:163], v[52:55]
ds_read_b64_tr_b16 a[112:113], v14 offset:32768
ds_read_b64_tr_b16 a[114:115], v14 offset:34816
M v[56:59], a[80:83], a[160:163], 0
buffer_load_dwordx4 v8, s[12:15], s24 offen offset:2048 lds
M v[56:59], a[84:87], a[164:167], v[56:59]
buffer_load_dwordx4 v9, s[12:15], s24 offen offset:3072 lds
M v[60:63], a[92:95], a[164:167], 0
M v[60:63], a[88:91], a[160:163], v[60:63]
ds_read_b64_tr_b16 a[120:121], v15 offset:32768
ds_read_b64_tr_b16 a[122:123], v15 offset:34816
M v[64:67], a[32:35], a[168:171], 0
s_add_u32 s24, s24, 262144
M v[64:67], a[36:39], a[172:175], v[64:67]
ds_read_b128 a[184:187], v10 offset:6144
ds_read_b128 a[188:191], v11 offset:6144
M v[68:71], a[44:47], a[172:175], 0
s_add_u32 m0, s29, 49152
s_add_u32 s3, s23, s31
buffer_load_dwordx4 v2, s[8:11], s3 offen offset:0 lds
M v[68:71], a[40:43], a[168:171], v[68:71]
ds_read_b64_tr_b16 a[128:129], v16 offset:32768
ds_read_b64_tr_b16 a[130:131], v16 offset:34816
M v[72:75], a[48:51], a[168:171], 0
M v[72:75], a[52:55], a[172:175], v[72:75]
buffer_load_dwordx4 v3, s[8:11], s3 offen offset:1024 lds
M v[76:79], a[60:63], a[172:175], 0
buffer_load_dwordx4 v4, s[8:11], s3 offen offset:2048 lds
M v[76:79], a[56:59], a[168:171], v[76:79]
ds_read_b64_tr_b16 a[136:137], v17 offset:32768
ds_read_b64_tr_b16 a[138:139], v17 offset:34816
M v[80:83], a[64:67], a[168:171], 0
M v[80:83], a[68:71], a[172:175], v[80:83]
buffer_load_dwordx4 v5, s[8:11], s3 offen offset:3072 lds
M v[84:87], a[76:79], a[172:175], 0
s_add_u32 s23, s23, 128
s_cmp_eq_u32 s23, s25
s_cselect_b32 s23, s26, s23
M v[84:87], a[72:75], a[168:171], v[84:87]
ds_read_b64_tr_b16 a[144:145], v18 offset:32768
ds_read_b64_tr_b16 a[146:147], v18 offset:34816
M v[88:91], a[80:83], a[168:171], 0
s_add_u32 m0, s29, 81920
s_nop 0
buffer_load_dwordx4 v6, s[12:15], s24 offen offset:0 lds
M v[88:91], a[84:87], a[172:175], v[88:91]
M v[92:95], a[92:95], a[172:175], 0
buffer_load_dwordx4 v7, s[12:15], s24 offen offset:1024 lds
M v[92:95], a[88:91], a[168:171], v[92:95]
s_waitcnt lgkmcnt(15)
ds_read_b64_tr_b16 a[152:153], v19 offset:32768
ds_read_b64_tr_b16 a[154:155], v19 offset:34816
M v[96:99], a[32:35], a[176:179], 0
buffer_load_dwordx4 v8, s[12:15], s24 offen offset:2048 lds
M v[96:99], a[36:39], a[180:183], v[96:99]
M v[100:103], a[44:47], a[180:183], 0
buffer_load_dwordx4 v9, s[12:15], s24 offen offset:3072 lds
M v[100:103], a[40:43], a[176:179], v[100:103]
s_add_u32 s24, s24, 262144
s_cmp_eq_u32 s24, s27
s_cselect_b32 s24, s28, s24
s_sub_u32 s6, s6, 1
s_cmp_eq_u32 s6, 0
s_cselect_b64 s[12:13], s[64:65], s[12:13]
M v[104:107], a[48:51], a[176:179], 0
M v[104:107], a[52:55], a[180:183], v[104:107]
M v[108:111], a[60:63], a[180:183], 0
M v[108:111], a[56:59], a[176:179], v[108:111]
s_waitcnt vmcnt(17) lgkmcnt(0)
s_barrier
ds_read_b128 a[160:163], v10 offset:16384
ds_read_b128 a[164:167], v11 offset:16384
M v[112:115], a[64:67], a[176:179], 0
s_add_u32 m0, s29, 0
s_nop 0
buffer_load_dwordx4 v2, s[8:11], s23 offen offset:0 lds
M v[112:115], a[68:71], a[180:183], v[112:115]
M v[116:119], a[76:79], a[180:183], 0
M v[116:119], a[72:75], a[176:179], v[116:119]
ds_read_b64_tr_b16 a[100:101], v12 offset:49152
ds_read_b64_tr_b16 a[102:103], v12 offset:51200
M v[120:123], a[80:83], a[176:179], 0
M v[120:123], a[84:87], a[180:183], v[120:123]
M v[124:127], a[92:95], a[180:183], 0
buffer_load_dwordx4 v3, s[8:11], s23 offen offset:1024 lds
M v[124:127], a[88:91], a[176:179], v[124:127]
M v[128:131], a[32:35], a[184:187], 0
M v[128:131], a[36:39], a[188:191], v[128:131]
ds_read_b128 a[168:171], v10 offset:18432
ds_read_b128 a[172:175], v11 offset:18432
ds_read_b64_tr_b16 a[108:109], v13 offset:49152
ds_read_b64_tr_b16 a[110:111], v13 offset:51200
M v[132:135], a[44:47], a[188:191], 0
M v[132:135], a[40:43], a[184:187], v[132:135]
M v[136:139], a[48:51], a[184:187], 0
M v[136:139], a[52:55], a[188:191], v[136:139]
buffer_load_dwordx4 v4, s[8:11], s23 offen offset:2048 lds
M v[140:143], a[60:63], a[188:191], 0
M v[140:143], a[56:59], a[184:187], v[140:143]
ds_read_b64_tr_b16 a[116:117], v14 offset:49152
ds_read_b64_tr_b16 a[118:119], v14 offset:51200
M v[144:147], a[64:67], a[184:187], 0
M v[144:147], a[68:71], a[188:191], v[144:147]
M v[148:151], a[76:79], a[188:191], 0
M v[148:151], a[72:75], a[184:187], v[148:151]
M v[152:155], a[80:83], a[184:187], 0
buffer_load_dwordx4 v5, s[8:11], s23 offen offset:3072 lds
M v[152:155], a[84:87], a[188:191], v[152:155]
ds_read_b64_tr_b16 a[124:125], v15 offset:49152
ds_read_b64_tr_b16 a[126:127], v15 offset:51200
M v[156:159], a[92:95], a[188:191], 0
M v[156:159], a[88:91], a[184:187], v[156:159]
s_waitcnt lgkmcnt(10)
M v[160:163], a[32:35], a[160:163], 0
M v[160:163], a[36:39], a[164:167], v[160:163]
ds_read_b128 a[176:179], v10 offset:20480
ds_read_b128 a[180:183], v11 offset:20480
M v[164:167], a[44:47], a[164:167], 0
M v[164:167], a[40:43], a[160:163], v[164:167]
ds_read_b64_tr_b16 a[132:133], v16 offset:49152
ds_read_b64_tr_b16 a[134:135], v16 offset:51200
M v[168:171], a[48:51], a[160:163], 0
M v[168:171], a[52:55], a[164:167], v[168:171]
s_add_u32 m0, s29, 98304
s_nop 0
buffer_load_dwordx4 v6, s[12:15], s24 offen offset:0 lds
M v[172:175], a[60:63], a[164:167], 0
M v[172:175], a[56:59], a[160:163], v[172:175]
M v[176:179], a[64:67], a[160:163], 0
M v[176:179], a[68:71], a[164:167], v[176:179]
ds_read_b64_tr_b16 a[140:141], v17 offset:49152
ds_read_b64_tr_b16 a[142:143], v17 offset:51200
M v[180:183], a[76:79], a[164:167], 0
M v[180:183], a[72:75], a[160:163], v[180:183]
buffer_load_dwordx4 v7, s[12:15], s24 offen offset:1024 lds
M v[184:187], a[80:83], a[160:163], 0
M v[184:187], a[84:87], a[164:167], v[184:187]
M v[188:191], a[92:95], a[164:167], 0
M v[188:191], a[88:91], a[160:163], v[188:191]
s_waitcnt lgkmcnt(12)
ds_read_b64_tr_b16 a[148:149], v18 offset:49152
ds_read_b64_tr_b16 a[150:151], v18 offset:51200
M v[192:195], a[32:35], a[168:171], 0
M v[192:195], a[36:39], a[172:175], v[192:195]
ds_read_b128 a[184:187], v10 offset:22528
ds_read_b128 a[188:191], v11 offset:22528
M v[196:199], a[44:47], a[172:175], 0
M v[196:199], a[40:43], a[168:171], v[196:199]
buffer_load_dwordx4 v8, s[12:15], s24 offen offset:2048 lds
M v[200:203], a[48:51], a[168:171], 0
M v[200:203], a[52:55], a[172:175], v[200:203]
ds_read_b64_tr_b16 a[156:157], v19 offset:49152
ds_read_b64_tr_b16 a[158:159], v19 offset:51200
M v[204:207], a[60:63], a[172:175], 0
M v[204:207], a[56:59], a[168:171], v[204:207]
M v[208:211], a[64:67], a[168:171], 0
M v[208:211], a[68:71], a[172:175], v[208:211]
buffer_load_dwordx4 v9, s[12:15], s24 offen offset:3072 lds
M v[212:215], a[76:79], a[172:175], 0
M v[212:215], a[72:75], a[168:171], v[212:215]
M v[216:219], a[80:83], a[168:171], 0
M v[216:219], a[84:87], a[172:175], v[216:219]
M v[220:223], a[92:95], a[172:175], 0
s_add_u32 s24, s24, 262144
M v[220:223], a[88:91], a[168:171], v[220:223]
s_waitcnt lgkmcnt(10)
M v[224:227], a[32:35], a[176:179], 0
M v[224:227], a[36:39], a[180:183], v[224:227]
M v[228:231], a[44:47], a[180:183], 0
M v[228:231], a[40:43], a[176:179], v[228:231]
M v[232:235], a[48:51], a[176:179], 0
M v[232:235], a[52:55], a[180:183], v[232:235]
M v[236:239], a[60:63], a[180:183], 0
M v[236:239], a[56:59], a[176:179], v[236:239]
s_waitcnt vmcnt(16) lgkmcnt(0)
s_barrier
ds_read_b128 a[160:163], v10 offset:32768
ds_read_b128 a[164:167], v11 offset:32768
M v[240:243], a[64:67], a[176:179], 0
s_add_u32 m0, s29, 16384
s_add_u32 s3, s23, s31
buffer_load_dwordx4 v2, s[8:11], s3 offen offset:0 lds
M v[240:243], a[68:71], a[180:183], v[240:243]
M v[244:247], a[76:79], a[180:183], 0
M v[244:247], a[72:75], a[176:179], v[244:247]
M v[248:251], a[80:83], a[176:179], 0
M v[248:251], a[84:87], a[180:183], v[248:251]
buffer_load_dwordx4 v3, s[8:11], s3 offen offset:1024 lds
M v[252:255], a[92:95], a[180:183], 0
M v[252:255], a[88:91], a[176:179], v[252:255]
M a[0:3], a[32:35], a[184:187], 0
M a[0:3], a[36:39], a[188:191], a[0:3]
ds_read_b128 a[168:171], v10 offset:34816
ds_read_b128 a[172:175], v11 offset:34816
M a[4:7], a[44:47], a[188:191], 0
M a[4:7], a[40:43], a[184:187], a[4:7]
M a[8:11], a[48:51], a[184:187], 0
buffer_load_dwordx4 v4, s[8:11], s3 offen offset:2048 lds
M a[8:11], a[52:55], a[188:191], a[8:11]
M a[12:15], a[60:63], a[188:191], 0
M a[12:15], a[56:59], a[184:187], a[12:15]
M a[16:19], a[64:67], a[184:187], 0
M a[16:19], a[68:71], a[188:191], a[16:19]
buffer_load_dwordx4 v5, s[8:11], s3 offen offset:3072 lds
M a[20:23], a[76:79], a[188:191], 0
M a[20:23], a[72:75], a[184:187], a[20:23]
M a[24:27], a[80:83], a[184:187], 0
M a[24:27], a[84:87], a[188:191], a[24:27]
M a[28:31], a[92:95], a[188:191], 0
M a[28:31], a[88:91], a[184:187], a[28:31]
s_waitcnt lgkmcnt(2)
M v[32:35], a[96:99], a[160:163], v[32:35]
s_add_u32 s23, s23, 128
s_cmp_eq_u32 s23, s25
s_cselect_b32 s23, s26, s23
M v[32:35], a[100:103], a[164:167], v[32:35]
ds_read_b128 a[176:179], v10 offset:36864
ds_read_b128 a[180:183], v11 offset:36864
M v[36:39], a[108:111], a[164:167], v[36:39]
M v[36:39], a[104:107], a[160:163], v[36:39]
ds_read_b64_tr_b16 a[32:33], v12 offset:0
ds_read_b64_tr_b16 a[34:35], v12 offset:2048
M v[40:43], a[112:115], a[160:163], v[40:43]
M v[40:43], a[116:119], a[164:167], v[40:43]
M v[44:47], a[124:127], a[164:167], v[44:47]
s_add_u32 m0, s29, 114688
s_nop 0
buffer_load_dwordx4 v6, s[12:15], s24 offen offset:0 lds
M v[44:47], a[120:123], a[160:163], v[44:47]
ds_read_b64_tr_b16 a[40:41], v13 offset:0
ds_read_b64_tr_b16 a[42:43], v13 offset:2048
M v[48:51], a[128:131], a[160:163], v[48:51]
M v[48:51], a[132:135], a[164:167], v[48:51]
M v[52:55], a[140:143], a[164:167], v[52:55]
M v[52:55], a[136:139], a[160:163], v[52:55]
ds_read_b64_tr_b16 a[48:49], v14 offset:0
ds_read_b64_tr_b16 a[50:51], v14 offset:2048
M v[56:59], a[144:147], a[160:163], v[56:59]
M v[56:59], a[148:151], a[164:167], v[56:59]
buffer_load_dwordx4 v7, s[12:15], s24 offen offset:1024 lds
M v[60:63], a[156:159], a[164:167], v[60:63]
M v[60:63], a[152:155], a[160:163], v[60:63]
s_waitcnt lgkmcnt(8)
ds_read_b64_tr_b16 a[56:57], v15 offset:0
ds_read_b64_tr_b16 a[58:59], v15 offset:2048
M v[64:67], a[96:99], a[168:171], v[64:67]
M v[64:67], a[100:103], a[172:175], v[64:67]
ds_read_b128 a[184:187], v10 offset:38912
ds_read_b128 a[188:191], v11 offset:38912
M v[68:71], a[108:111], a[172:175], v[68:71]
M v[68:71], a[104:107], a[168:171], v[68:71]
ds_read_b64_tr_b16 a[64:65], v16 offset:0
ds_read_b64_tr_b16 a[66:67], v16 offset:2048
M v[72:75], a[112:115], a[168:171], v[72:75]
buffer_load_dwordx4 v8, s[12:15], s24 offen offset:2048 lds
M v[72:75], a[116:119], a[172:175], v[72:75]
M v[76:79], a[124:127], a[172:175], v[76:79]
M v[76:79], a[120:123], a[168:171], v[76:79]
ds_read_b64_tr_b16 a[72:73], v17 offset:0
ds_read_b64_tr_b16 a[74:75], v17 offset:2048
M v[80:83], a[128:131], a[168:171], v[80:83]
M v[80:83], a[132:135], a[172:175], v[80:83]
M v[84:87], a[140:143], a[172:175], v[84:87]
buffer_load_dwordx4 v9, s[12:15], s24 offen offset:3072 lds
M v[84:87], a[136:139], a[168:171], v[84:87]
ds_read_b64_tr_b16 a[80:81], v18 offset:0
ds_read_b64_tr_b16 a[82:83], v18 offset:2048
M v[88:91], a[144:147], a[168:171], v[88:91]
M v[88:91], a[148:151], a[172:175], v[88:91]
M v[92:95], a[156:159], a[172:175], v[92:95]
M v[92:95], a[152:155], a[168:171], v[92:95]
s_waitcnt lgkmcnt(15)
ds_read_b64_tr_b16 a[88:89], v19 offset:0
ds_read_b64_tr_b16 a[90:91], v19 offset:2048
M v[96:99], a[96:99], a[176:179], v[96:99]
s_add_u32 s24, s24, 262144
s_cmp_eq_u32 s24, s27
s_cselect_b32 s24, s28, s24
s_sub_u32 s6, s6, 1
s_cmp_eq_u32 s6, 0
s_cselect_b64 s[12:13], s[64:65], s[12:13]
M v[96:99], a[100:103], a[180:183], v[96:99]
M v[100:103], a[108:111], a[180:183], v[100:103]
M v[100:103], a[104:107], a[176:179], v[100:103]
M v[104:107], a[112:115], a[176:179], v[104:107]
M v[104:107], a[116:119], a[180:183], v[104:107]
M v[108:111], a[124:127], a[180:183], v[108:111]
M v[108:111], a[120:123], a[176:179], v[108:111]
s_waitcnt vmcnt(16) lgkmcnt(0)
s_barrier
ds_read_b128 a[160:163], v10 offset:49152
ds_read_b128 a[164:167], v11 offset:49152
M v[112:115], a[128:131], a[176:179], v[112:115]
s_add_u32 m0, s29, 32768
s_nop 0
buffer_load_dwordx4 v2, s[8:11], s23 offen offset:0 lds
M v[112:115], a[132:135], a[180:183], v[112:115]
M v[116:119], a[140:143], a[180:183], v[116:119]
M v[116:119], a[136:139], a[176:179], v[116:119]
ds_read_b64_tr_b16 a[36:37], v12 offset:16384
ds_read_b64_tr_b16 a[38:39], v12 offset:18432
M v[120:123], a[144:147], a[176:179], v[120:123]
M v[120:123], a[148:151], a[180:183], v[120:123]
M v[124:127], a[156:159], a[180:183], v[124:127]
buffer_load_dwordx4 v3, s[8:11], s23 offen offset:1024 lds
M v[124:127], a[152:155], a[176:179], v[124:127]
M v[128:131], a[96:99], a[184:187], v[128:131]
M v[128:131], a[100:103], a[188:191], v[128:131]
ds_read_b128 a[168:171], v10 offset:51200
ds_read_b128 a[172:175], v11 offset:51200
ds_read_b64_tr_b16 a[44:45], v13 offset:16384
ds_read_b64_tr_b16 a[46:47], v13 offset:18432
M v[132:135], a[108:111], a[188:191], v[132:135]
M v[132:135], a[104:107], a[184:187], v[132:135]
M v[136:139], a[112:115], a[184:187], v[136:139]
M v[136:139], a[116:119], a[188:191], v[136:139]
buffer_load_dwordx4 v4, s[8:11], s23 offen offset:2048 lds
M v[140:143], a[124:127], a[188:191], v[140:143]
M v[140:143], a[120:123], a[184:187], v[140:143]
ds_read_b64_tr_b16 a[52:53], v14 offset:16384
ds_read_b64_tr_b16 a[54:55], v14 offset:18432
M v[144:147], a[128:131], a[184:187], v[144:147]
M v[144:147], a[132:135], a[188:191], v[144:147]
M v[148:151], a[140:143], a[188:191], v[148:151]
M v[148:151], a[136:139], a[184:187], v[148:151]
M v[152:155], a[144:147], a[184:187], v[152:155]
buffer_load_dwordx4 v5, s[8:11], s23 offen offset:3072 lds
M v[152:155], a[148:151], a[188:191], v[152:155]
ds_read_b64_tr_b16 a[60:61], v15 offset:16384
ds_read_b64_tr_b16 a[62:63], v15 offset:18432
M v[156:159], a[156:159], a[188:191], v[156:159]
M v[156:159], a[152:155], a[184:187], v[156:159]
s_waitcnt lgkmcnt(10)
M v[160:163], a[96:99], a[160:163], v[160:163]
M v[160:163], a[100:103], a[164:167], v[160:163]
ds_read_b128 a[176:179], v10 offset:53248
ds_read_b128 a[180:183], v11 offset:53248
M v[164:167], a[108:111], a[164:167], v[164:167]
M v[164:167], a[104:107], a[160:163], v[164:167]
ds_read_b64_tr_b16 a[68:69], v16 offset:16384
ds_read_b64_tr_b16 a[70:71], v16 offset:18432
M v[168:171], a[112:115], a[160:163], v[168:171]
M v[168:171], a[116:119], a[164:167], v[168:171]
s_add_u32 m0, s29, 65536
s_nop 0
buffer_load_dwordx4 v6, s[12:15], s24 offen offset:0 lds
M v[172:175], a[124:127], a[164:167], v[172:175]
M v[172:175], a[120:123], a[160:163], v[172:175]
M v[176:179], a[128:131], a[160:163], v[176:179]
M v[176:179], a[132:135], a[164:167], v[176:179]
ds_read_b64_tr_b16 a[76:77], v17 offset:16384
ds_read_b64_tr_b16 a[78:79], v17 offset:18432
M v[180:183], a[140:143], a[164:167], v[180:183]
M v[180:183], a[136:139], a[160:163], v[180:183]
buffer_load_dwordx4 v7, s[12:15], s24 offen offset:1024 lds
M v[184:187], a[144:147], a[160:163], v[184:187]
M v[184:187], a[148:151], a[164:167], v[184:187]
M v[188:191], a[156:159], a[164:167], v[188:191]
M v[188:191], a[152:155], a[160:163], v[188:191]
s_waitcnt lgkmcnt(12)
ds_read_b64_tr_b16 a[84:85], v18 offset:16384
ds_read_b64_tr_b16 a[86:87], v18 offset:18432
M v[192:195], a[96:99], a[168:171], v[192:195]
M v[192:195], a[100:103], a[172:175], v[192:195]
ds_read_b128 a[184:187], v10 offset:55296
ds_read_b128 a[188:191], v11 offset:55296
M v[196:199], a[108:111], a[172:175], v[196:199]
M v[196:199], a[104:107], a[168:171], v[196:199]
buffer_load_dwordx4 v8, s[12:15], s24 offen offset:2048 lds
M v[200:203], a[112:115], a[168:171], v[200:203]
M v[200:203], a[116:119], a[172:175], v[200:203]
ds_read_b64_tr_b16 a[92:93], v19 offset:16384
ds_read_b64_tr_b16 a[94:95], v19 offset:18432
M v[204:207], a[124:127], a[172:175], v[204:207]
M v[204:207], a[120:123], a[168:171], v[204:207]
M v[208:211], a[128:131], a[168:171], v[208:211]
M v[208:211], a[132:135], a[172:175], v[208:211]
buffer_load_dwordx4 v9, s[12:15], s24 offen offset:3072 lds
M v[212:215], a[140:143], a[172:175], v[212:215]
M v[212:215], a[136:139], a[168:171], v[212:215]
M v[216:219], a[144:147], a[168:171], v[216:219]
M v[216:219], a[148:151], a[172:175], v[216:219]
M v[220:223], a[156:159], a[172:175], v[220:223]
s_add_u32 s24, s24, 262144
M v[220:223], a[152:155], a[168:171], v[220:223]
s_waitcnt lgkmcnt(10)
M v[224:227], a[96:99], a[176:179], v[224:227]
M v[224:227], a[100:103], a[180:183], v[224:227]
M v[228:231], a[108:111], a[180:183], v[228:231]
M v[228:231], a[104:107], a[176:179], v[228:231]
M v[232:235], a[112:115], a[176:179], v[232:235]
M v[232:235], a[116:119], a[180:183], v[232:235]
M v[236:239], a[124:127], a[180:183], v[236:239]
M v[236:239], a[120:123], a[176:179], v[236:239]
s_waitcnt vmcnt(16) lgkmcnt(0)
s_barrier
ds_read_b128 a[160:163], v10 offset:0
ds_read_b128 a[164:167], v11 offset:0
M v[240:243], a[128:131], a[176:179], v[240:243]
s_add_u32 m0, s29, 49152
s_add_u32 s3, s23, s31
buffer_load_dwordx4 v2, s[8:11], s3 offen offset:0 lds
M v[240:243], a[132:135], a[180:183], v[240:243]
M v[244:247], a[140:143], a[180:183], v[244:247]
M v[244:247], a[136:139], a[176:179], v[244:247]
M v[248:251], a[144:147], a[176:179], v[248:251]
M v[248:251], a[148:151], a[180:183], v[248:251]
buffer_load_dwordx4 v3, s[8:11], s3 offen offset:1024 lds
M v[252:255], a[156:159], a[180:183], v[252:255]
M v[252:255], a[152:155], a[176:179], v[252:255]
M a[0:3], a[96:99], a[184:187], a[0:3]
M a[0:3], a[100:103], a[188:191], a[0:3]
ds_read_b128 a[168:171], v10 offset:2048
ds_read_b128 a[172:175], v11 offset:2048
M a[4:7], a[108:111], a[188:191], a[4:7]
M a[4:7], a[104:107], a[184:187], a[4:7]
M a[8:11], a[112:115], a[184:187], a[8:11]
buffer_load_dwordx4 v4, s[8:11], s3 offen offset:2048 lds
M a[8:11], a[116:119], a[188:191], a[8:11]
M a[12:15], a[124:127], a[188:191], a[12:15]
M a[12:15], a[120:123], a[184:187], a[12:15]
M a[16:19], a[128:131], a[184:187], a[16:19]
M a[16:19], a[132:135], a[188:191], a[16:19]
buffer_load_dwordx4 v5, s[8:11], s3 offen offset:3072 lds
M a[20:23], a[140:143], a[188:191], a[20:23]
M a[20:23], a[136:139], a[184:187], a[20:23]
M a[24:27], a[144:147], a[184:187], a[24:27]
M a[24:27], a[148:151], a[188:191], a[24:27]
M a[28:31], a[156:159], a[188:191], a[28:31]
M a[28:31], a[152:155], a[184:187], a[28:31]
s_waitcnt lgkmcnt(2)
s_mov_b32 s30, 2
Lk1_kl:
M v[32:35], a[32:35], a[160:163], v[32:35]
s_add_u32 s23, s23, 128
s_cmp_eq_u32 s23, s25
s_cselect_b32 s23, s26, s23
M v[32:35], a[36:39], a[164:167], v[32:35]
ds_read_b128 a[176:179], v10 offset:4096
ds_read_b128 a[180:183], v11 offset:4096
M v[36:39], a[44:47], a[164:167], v[36:39]
M v[36:39], a[40:43], a[160:163], v[36:39]
ds_read_b64_tr_b16 a[96:97], v12 offset:32768
ds_read_b64_tr_b16 a[98:99], v12 offset:34816
M v[40:43], a[48:51], a[160:163], v[40:43]
M v[40:43], a[52:55], a[164:167], v[40:43]
M v[44:47], a[60:63], a[164:167], v[44:47]
s_add_u32 m0, s29, 81920
s_nop 0
buffer_load_dwordx4 v6, s[12:15], s24 offen offset:0 lds
M v[44:47], a[56:59], a[160:163], v[44:47]
ds_read_b64_tr_b16 a[104:105], v13 offset:32768
ds_read_b64_tr_b16 a[106:107], v13 offset:34816
M v[48:51], a[64:67], a[160:163], v[48:51]
M v[48:51], a[68:71], a[164:167], v[48:51]
M v[52:55], a[76:79], a[164:167], v[52:55]
M v[52:55], a[72:75], a[160:163], v[52:55]
ds_read_b64_tr_b16 a[112:113], v14 offset:32768
ds_read_b64_tr_b16 a[114:115], v14 offset:34816
M v[56:59], a[80:83], a[160:163], v[56:59]
M v[56:59], a[84:87], a[164:167], v[56:59]
buffer_load_dwordx4 v7, s[12:15], s24 offen offset:1024 lds
M v[60:63], a[92:95], a[164:167], v[60:63]
M v[60:63], a[88:91], a[160:163], v[60:63]
s_waitcnt lgkmcnt(8)
ds_read_b64_tr_b16 a[120:121], v15 offset:32768
ds_read_b64_tr_b16 a[122:123], v15 offset:34816
M v[64:67], a[32:35], a[168:171], v[64:67]
M v[64:67], a[36:39], a[172:175], v[64:67]
ds_read_b128 a[184:187], v10 offset:6144
ds_read_b128 a[188:191], v11 offset:6144
M v[68:71], a[44:47], a[172:175], v[68:71]
M v[68:71], a[40:43], a[168:171], v[68:71]
ds_read_b64_tr_b16 a[128:129], v16 offset:32768
ds_read_b64_tr_b16 a[130:131], v16 offset:34816
M v[72:75], a[48:51], a[168:171], v[72:75]
buffer_load_dwordx4 v8, s[12:15], s24 offen offset:2048 lds
M v[72:75], a[52:55], a[172:175], v[72:75]
M v[76:79], a[60:63], a[172:175], v[76:79]
M v[76:79], a[56:59], a[168:171], v[76:79]
ds_read_b64_tr_b16 a[136:137], v17 offset:32768
ds_read_b64_tr_b16 a[138:139], v17 offset:34816
M v[80:83], a[64:67], a[168:171], v[80:83]
M v[80:83], a[68:71], a[172:175], v[80:83]
M v[84:87], a[76:79], a[172:175], v[84:87]
buffer_load_dwordx4 v9, s[12:15], s24 offen offset:3072 lds
M v[84:87], a[72:75], a[168:171], v[84:87]
ds_read_b64_tr_b16 a[144:145], v18 offset:32768
ds_read_b64_tr_b16 a[146:147], v18 offset:34816
M v[88:91], a[80:83], a[168:171], v[88:91]
M v[88:91], a[84:87], a[172:175], v[88:91]
M v[92:95], a[92:95], a[172:175], v[92:95]
M v[92:95], a[88:91], a[168:171], v[92:95]
s_waitcnt lgkmcnt(15)
ds_read_b64_tr_b16 a[152:153], v19 offset:32768
ds_read_b64_tr_b16 a[154:155], v19 offset:34816
M v[96:99], a[32:35], a[176:179], v[96:99]
s_add_u32 s24, s24, 262144
s_cmp_eq_u32 s24, s27
s_cselect_b32 s24, s28, s24
s_sub_u32 s6, s6, 1
s_cmp_eq_u32 s6, 0
s_cselect_b64 s[12:13], s[64:65], s[12:13]
M v[96:99], a[36:39], a[180:183], v[96:99]
M v[100:103], a[44:47], a[180:183], v[100:103]
M v[100:103], a[40:43], a[176:179], v[100:103]
M v[104:107], a[48:51], a[176:179], v[104:107]
M v[104:107], a[52:55], a[180:183], v[104:107]
M v[108:111], a[60:63], a[180:183], v[108:111]
M v[108:111], a[56:59], a[176:179], v[108:111]
s_waitcnt vmcnt(16) lgkmcnt(0)
s_barrier
ds_read_b128 a[160:163], v10 offset:16384
ds_read_b128 a[164:167], v11 offset:16384
M v[112:115], a[64:67], a[176:179], v[112:115]
s_add_u32 m0, s29, 0
s_nop 0
buffer_load_dwordx4 v2, s[8:11], s23 offen offset:0 lds
M v[112:115], a[68:71], a[180:183], v[112:115]
M v[116:119], a[76:79], a[180:183], v[116:119]
M v[116:119], a[72:75], a[176:179], v[116:119]
ds_read_b64_tr_b16 a[100:101], v12 offset:49152
ds_read_b64_tr_b16 a[102:103], v12 offset:51200
M v[120:123], a[80:83], a[176:179], v[120:123]
M v[120:123], a[84:87], a[180:183], v[120:123]
M v[124:127], a[92:95], a[180:183], v[124:127]
buffer_load_dwordx4 v3, s[8:11], s23 offen offset:1024 lds
M v[124:127], a[88:91], a[176:179], v[124:127]
M v[128:131], a[32:35], a[184:187], v[128:131]
M v[128:131], a[36:39], a[188:191], v[128:131]
ds_read_b128 a[168:171], v10 offset:18432
ds_read_b128 a[172:175], v11 offset:18432
ds_read_b64_tr_b16 a[108:109], v13 offset:49152
ds_read_b64_tr_b16 a[110:111], v13 offset:51200
M v[132:135], a[44:47], a[188:191], v[132:135]
M v[132:135], a[40:43], a[184:187], v[132:135]
M v[136:139], a[48:51], a[184:187], v[136:139]
M v[136:139], a[52:55], a[188:191], v[136:139]
buffer_load_dwordx4 v4, s[8:11], s23 offen offset:2048 lds
M v[140:143], a[60:63], a[188:191], v[140:143]
M v[140:143], a[56:59], a[184:187], v[140:143]
ds_read_b64_tr_b16 a[116:117], v14 offset:49152
ds_read_b64_tr_b16 a[118:119], v14 offset:51200
M v[144:147], a[64:67], a[184:187], v[144:147]
M v[144:147], a[68:71], a[188:191], v[144:147]
M v[148:151], a[76:79], a[188:191], v[148:151]
M v[148:151], a[72:75], a[184:187], v[148:151]
M v[152:155], a[80:83], a[184:187], v[152:155]
buffer_load_dwordx4 v5, s[8:11], s23 offen offset:3072 lds
M v[152:155], a[84:87], a[188:191], v[152:155]
ds_read_b64_tr_b16 a[124:125], v15 offset:49152
ds_read_b64_tr_b16 a[126:127], v15 offset:51200
M v[156:159], a[92:95], a[188:191], v[156:159]
M v[156:159], a[88:91], a[184:187], v[156:159]
s_waitcnt lgkmcnt(10)
M v[160:163], a[32:35], a[160:163], v[160:163]
M v[160:163], a[36:39], a[164:167], v[160:163]
ds_read_b128 a[176:179], v10 offset:20480
ds_read_b128 a[180:183], v11 offset:20480
M v[164:167], a[44:47], a[164:167], v[164:167]
M v[164:167], a[40:43], a[160:163], v[164:167]
ds_read_b64_tr_b16 a[132:133], v16 offset:49152
ds_read_b64_tr_b16 a[134:135], v16 offset:51200
M v[168:171], a[48:51], a[160:163], v[168:171]
M v[168:171], a[52:55], a[164:167], v[168:171]
s_add_u32 m0, s29, 98304
s_nop 0
buffer_load_dwordx4 v6, s[12:15], s24 offen offset:0 lds
M v[172:175], a[60:63], a[164:167], v[172:175]
M v[172:175], a[56:59], a[160:163], v[172:175]
M v[176:179], a[64:67], a[160:163], v[176:179]
M v[176:179], a[68:71], a[164:167], v[176:179]
ds_read_b64_tr_b16 a[140:141], v17 offset:49152
ds_read_b64_tr_b16 a[142:143], v17 offset:51200
M v[180:183], a[76:79], a[164:167], v[180:183]
M v[180:183], a[72:75], a[160:163], v[180:183]
buffer_load_dwordx4 v7, s[12:15], s24 offen offset:1024 lds
M v[184:187], a[80:83], a[160:163], v[184:187]
M v[184:187], a[84:87], a[164:167], v[184:187]
M v[188:191], a[92:95], a[164:167], v[188:191]
M v[188:191], a[88:91], a[160:163], v[188:191]
s_waitcnt lgkmcnt(12)
ds_read_b64_tr_b16 a[148:149], v18 offset:49152
ds_read_b64_tr_b16 a[150:151], v18 offset:51200
M v[192:195], a[32:35], a[168:171], v[192:195]
M v[192:195], a[36:39], a[172:175], v[192:195]
ds_read_b128 a[184:187], v10 offset:22528
ds_read_b128 a[188:191], v11 offset:22528
M v[196:199], a[44:47], a[172:175], v[196:199]
M v[196:199], a[40:43], a[168:171], v[196:199]
buffer_load_dwordx4 v8, s[12:15], s24 offen offset:2048 lds
M v[200:203], a[48:51], a[168:171], v[200:203]
M v[200:203], a[52:55], a[172:175], v[200:203]
ds_read_b64_tr_b16 a[156:157], v19 offset:49152
ds_read_b64_tr_b16 a[158:159], v19 offset:51200
M v[204:207], a[60:63], a[172:175], v[204:207]
M v[204:207], a[56:59], a[168:171], v[204:207]
M v[208:211], a[64:67], a[168:171], v[208:211]
M v[208:211], a[68:71], a[172:175], v[208:211]
buffer_load_dwordx4 v9, s[12:15], s24 offen offset:3072 lds
M v[212:215], a[76:79], a[172:175], v[212:215]
M v[212:215], a[72:75], a[168:171], v[212:215]
M v[216:219], a[80:83], a[168:171], v[216:219]
M v[216:219], a[84:87], a[172:175], v[216:219]
M v[220:223], a[92:95], a[172:175], v[220:223]
s_add_u32 s24, s24, 262144
M v[220:223], a[88:91], a[168:171], v[220:223]
s_waitcnt lgkmcnt(10)
M v[224:227], a[32:35], a[176:179], v[224:227]
M v[224:227], a[36:39], a[180:183], v[224:227]
M v[228:231], a[44:47], a[180:183], v[228:231]
M v[228:231], a[40:43], a[176:179], v[228:231]
M v[232:235], a[48:51], a[176:179], v[232:235]
M v[232:235], a[52:55], a[180:183], v[232:235]
M v[236:239], a[60:63], a[180:183], v[236:239]
M v[236:239], a[56:59], a[176:179], v[236:239]
s_waitcnt vmcnt(16) lgkmcnt(0)
s_barrier
ds_read_b128 a[160:163], v10 offset:32768
ds_read_b128 a[164:167], v11 offset:32768
M v[240:243], a[64:67], a[176:179], v[240:243]
s_add_u32 m0, s29, 16384
s_add_u32 s3, s23, s31
buffer_load_dwordx4 v2, s[8:11], s3 offen offset:0 lds
M v[240:243], a[68:71], a[180:183], v[240:243]
M v[244:247], a[76:79], a[180:183], v[244:247]
M v[244:247], a[72:75], a[176:179], v[244:247]
M v[248:251], a[80:83], a[176:179], v[248:251]
M v[248:251], a[84:87], a[180:183], v[248:251]
buffer_load_dwordx4 v3, s[8:11], s3 offen offset:1024 lds
M v[252:255], a[92:95], a[180:183], v[252:255]
M v[252:255], a[88:91], a[176:179], v[252:255]
M a[0:3], a[32:35], a[184:187], a[0:3]
M a[0:3], a[36:39], a[188:191], a[0:3]
ds_read_b128 a[168:171], v10 offset:34816
ds_read_b128 a[172:175], v11 offset:34816
M a[4:7], a[44:47], a[188:191], a[4:7]
M a[4:7], a[40:43], a[184:187], a[4:7]
M a[8:11], a[48:51], a[184:187], a[8:11]
buffer_load_dwordx4 v4, s[8:11], s3 offen offset:2048 lds
M a[8:11], a[52:55], a[188:191], a[8:11]
M a[12:15], a[60:63], a[188:191], a[12:15]
M a[12:15], a[56:59], a[184:187], a[12:15]
M a[16:19], a[64:67], a[184:187], a[16:19]
M a[16:19], a[68:71], a[188:191], a[16:19]
buffer_load_dwordx4 v5, s[8:11], s3 offen offset:3072 lds
M a[20:23], a[76:79], a[188:191], a[20:23]
M a[20:23], a[72:75], a[184:187], a[20:23]
M a[24:27], a[80:83], a[184:187], a[24:27]
M a[24:27], a[84:87], a[188:191], a[24:27]
M a[28:31], a[92:95], a[188:191], a[28:31]
M a[28:31], a[88:91], a[184:187], a[28:31]
s_waitcnt lgkmcnt(2)
M v[32:35], a[96:99], a[160:163], v[32:35]
s_add_u32 s23, s23, 128
s_cmp_eq_u32 s23, s25
s_cselect_b32 s23, s26, s23
M v[32:35], a[100:103], a[164:167], v[32:35]
ds_read_b128 a[176:179], v10 offset:36864
ds_read_b128 a[180:183], v11 offset:36864
M v[36:39], a[108:111], a[164:167], v[36:39]
M v[36:39], a[104:107], a[160:163], v[36:39]
ds_read_b64_tr_b16 a[32:33], v12 offset:0
ds_read_b64_tr_b16 a[34:35], v12 offset:2048
M v[40:43], a[112:115], a[160:163], v[40:43]
M v[40:43], a[116:119], a[164:167], v[40:43]
M v[44:47], a[124:127], a[164:167], v[44:47]
s_add_u32 m0, s29, 114688
s_nop 0
buffer_load_dwordx4 v6, s[12:15], s24 offen offset:0 lds
M v[44:47], a[120:123], a[160:163], v[44:47]
ds_read_b64_tr_b16 a[40:41], v13 offset:0
ds_read_b64_tr_b16 a[42:43], v13 offset:2048
M v[48:51], a[128:131], a[160:163], v[48:51]
M v[48:51], a[132:135], a[164:167], v[48:51]
M v[52:55], a[140:143], a[164:167], v[52:55]
M v[52:55], a[136:139], a[160:163], v[52:55]
ds_read_b64_tr_b16 a[48:49], v14 offset:0
ds_read_b64_tr_b16 a[50:51], v14 offset:2048
M v[56:59], a[144:147], a[160:163], v[56:59]
M v[56:59], a[148:151], a[164:167], v[56:59]
buffer_load_dwordx4 v7, s[12:15], s24 offen offset:1024 lds
M v[60:63], a[156:159], a[164:167], v[60:63]
M v[60:63], a[152:155], a[160:163], v[60:63]
s_waitcnt lgkmcnt(8)
ds_read_b64_tr_b16 a[56:57], v15 offset:0
ds_read_b64_tr_b16 a[58:59], v15 offset:2048
M v[64:67], a[96:99], a[168:171], v[64:67]
M v[64:67], a[100:103], a[172:175], v[64:67]
ds_read_b128 a[184:187], v10 offset:38912
ds_read_b128 a[188:191], v11 offset:38912
M v[68:71], a[108:111], a[172:175], v[68:71]
M v[68:71], a[104:107], a[168:171], v[68:71]
ds_read_b64_tr_b16 a[64:65], v16 offset:0
ds_read_b64_tr_b16 a[66:67], v16 offset:2048
M v[72:75], a[112:115], a[168:171], v[72:75]
buffer_load_dwordx4 v8, s[12:15], s24 offen offset:2048 lds
M v[72:75], a[116:119], a[172:175], v[72:75]
M v[76:79], a[124:127], a[172:175], v[76:79]
M v[76:79], a[120:123], a[168:171], v[76:79]
ds_read_b64_tr_b16 a[72:73], v17 offset:0
ds_read_b64_tr_b16 a[74:75], v17 offset:2048
M v[80:83], a[128:131], a[168:171], v[80:83]
M v[80:83], a[132:135], a[172:175], v[80:83]
M v[84:87], a[140:143], a[172:175], v[84:87]
buffer_load_dwordx4 v9, s[12:15], s24 offen offset:3072 lds
M v[84:87], a[136:139], a[168:171], v[84:87]
ds_read_b64_tr_b16 a[80:81], v18 offset:0
ds_read_b64_tr_b16 a[82:83], v18 offset:2048
M v[88:91], a[144:147], a[168:171], v[88:91]
M v[88:91], a[148:151], a[172:175], v[88:91]
M v[92:95], a[156:159], a[172:175], v[92:95]
M v[92:95], a[152:155], a[168:171], v[92:95]
s_waitcnt lgkmcnt(15)
ds_read_b64_tr_b16 a[88:89], v19 offset:0
ds_read_b64_tr_b16 a[90:91], v19 offset:2048
M v[96:99], a[96:99], a[176:179], v[96:99]
s_add_u32 s24, s24, 262144
s_cmp_eq_u32 s24, s27
s_cselect_b32 s24, s28, s24
s_sub_u32 s6, s6, 1
s_cmp_eq_u32 s6, 0
s_cselect_b64 s[12:13], s[64:65], s[12:13]
M v[96:99], a[100:103], a[180:183], v[96:99]
M v[100:103], a[108:111], a[180:183], v[100:103]
M v[100:103], a[104:107], a[176:179], v[100:103]
M v[104:107], a[112:115], a[176:179], v[104:107]
M v[104:107], a[116:119], a[180:183], v[104:107]
M v[108:111], a[124:127], a[180:183], v[108:111]
M v[108:111], a[120:123], a[176:179], v[108:111]
s_waitcnt vmcnt(16) lgkmcnt(0)
s_barrier
ds_read_b128 a[160:163], v10 offset:49152
ds_read_b128 a[164:167], v11 offset:49152
M v[112:115], a[128:131], a[176:179], v[112:115]
s_add_u32 m0, s29, 32768
s_nop 0
buffer_load_dwordx4 v2, s[8:11], s23 offen offset:0 lds
M v[112:115], a[132:135], a[180:183], v[112:115]
M v[116:119], a[140:143], a[180:183], v[116:119]
M v[116:119], a[136:139], a[176:179], v[116:119]
ds_read_b64_tr_b16 a[36:37], v12 offset:16384
ds_read_b64_tr_b16 a[38:39], v12 offset:18432
M v[120:123], a[144:147], a[176:179], v[120:123]
M v[120:123], a[148:151], a[180:183], v[120:123]
M v[124:127], a[156:159], a[180:183], v[124:127]
buffer_load_dwordx4 v3, s[8:11], s23 offen offset:1024 lds
M v[124:127], a[152:155], a[176:179], v[124:127]
M v[128:131], a[96:99], a[184:187], v[128:131]
M v[128:131], a[100:103], a[188:191], v[128:131]
ds_read_b128 a[168:171], v10 offset:51200
ds_read_b128 a[172:175], v11 offset:51200
ds_read_b64_tr_b16 a[44:45], v13 offset:16384
ds_read_b64_tr_b16 a[46:47], v13 offset:18432
M v[132:135], a[108:111], a[188:191], v[132:135]
M v[132:135], a[104:107], a[184:187], v[132:135]
M v[136:139], a[112:115], a[184:187], v[136:139]
M v[136:139], a[116:119], a[188:191], v[136:139]
buffer_load_dwordx4 v4, s[8:11], s23 offen offset:2048 lds
M v[140:143], a[124:127], a[188:191], v[140:143]
M v[140:143], a[120:123], a[184:187], v[140:143]
ds_read_b64_tr_b16 a[52:53], v14 offset:16384
ds_read_b64_tr_b16 a[54:55], v14 offset:18432
M v[144:147], a[128:131], a[184:187], v[144:147]
M v[144:147], a[132:135], a[188:191], v[144:147]
M v[148:151], a[140:143], a[188:191], v[148:151]
M v[148:151], a[136:139], a[184:187], v[148:151]
M v[152:155], a[144:147], a[184:187], v[152:155]
buffer_load_dwordx4 v5, s[8:11], s23 offen offset:3072 lds
M v[152:155], a[148:151], a[188:191], v[152:155]
ds_read_b64_tr_b16 a[60:61], v15 offset:16384
ds_read_b64_tr_b16 a[62:63], v15 offset:18432
M v[156:159], a[156:159], a[188:191], v[156:159]
M v[156:159], a[152:155], a[184:187], v[156:159]
s_waitcnt lgkmcnt(10)
M v[160:163], a[96:99], a[160:163], v[160:163]
M v[160:163], a[100:103], a[164:167], v[160:163]
ds_read_b128 a[176:179], v10 offset:53248
ds_read_b128 a[180:183], v11 offset:53248
M v[164:167], a[108:111], a[164:167], v[164:167]
M v[164:167], a[104:107], a[160:163], v[164:167]
ds_read_b64_tr_b16 a[68:69], v16 offset:16384
ds_read_b64_tr_b16 a[70:71], v16 offset:18432
M v[168:171], a[112:115], a[160:163], v[168:171]
M v[168:171], a[116:119], a[164:167], v[168:171]
s_add_u32 m0, s29, 65536
s_nop 0
buffer_load_dwordx4 v6, s[12:15], s24 offen offset:0 lds
M v[172:175], a[124:127], a[164:167], v[172:175]
M v[172:175], a[120:123], a[160:163], v[172:175]
M v[176:179], a[128:131], a[160:163], v[176:179]
M v[176:179], a[132:135], a[164:167], v[176:179]
ds_read_b64_tr_b16 a[76:77], v17 offset:16384
ds_read_b64_tr_b16 a[78:79], v17 offset:18432
M v[180:183], a[140:143], a[164:167], v[180:183]
M v[180:183], a[136:139], a[160:163], v[180:183]
buffer_load_dwordx4 v7, s[12:15], s24 offen offset:1024 lds
M v[184:187], a[144:147], a[160:163], v[184:187]
M v[184:187], a[148:151], a[164:167], v[184:187]
M v[188:191], a[156:159], a[164:167], v[188:191]
M v[188:191], a[152:155], a[160:163], v[188:191]
s_waitcnt lgkmcnt(12)
ds_read_b64_tr_b16 a[84:85], v18 offset:16384
ds_read_b64_tr_b16 a[86:87], v18 offset:18432
M v[192:195], a[96:99], a[168:171], v[192:195]
M v[192:195], a[100:103], a[172:175], v[192:195]
ds_read_b128 a[184:187], v10 offset:55296
ds_read_b128 a[188:191], v11 offset:55296
M v[196:199], a[108:111], a[172:175], v[196:199]
M v[196:199], a[104:107], a[168:171], v[196:199]
buffer_load_dwordx4 v8, s[12:15], s24 offen offset:2048 lds
M v[200:203], a[112:115], a[168:171], v[200:203]
M v[200:203], a[116:119], a[172:175], v[200:203]
ds_read_b64_tr_b16 a[92:93], v19 offset:16384
ds_read_b64_tr_b16 a[94:95], v19 offset:18432
M v[204:207], a[124:127], a[172:175], v[204:207]
M v[204:207], a[120:123], a[168:171], v[204:207]
M v[208:211], a[128:131], a[168:171], v[208:211]
M v[208:211], a[132:135], a[172:175], v[208:211]
buffer_load_dwordx4 v9, s[12:15], s24 offen offset:3072 lds
M v[212:215], a[140:143], a[172:175], v[212:215]
M v[212:215], a[136:139], a[168:171], v[212:215]
M v[216:219], a[144:147], a[168:171], v[216:219]
M v[216:219], a[148:151], a[172:175], v[216:219]
M v[220:223], a[156:159], a[172:175], v[220:223]
s_add_u32 s24, s24, 262144
M v[220:223], a[152:155], a[168:171], v[220:223]
s_waitcnt lgkmcnt(10)
M v[224:227], a[96:99], a[176:179], v[224:227]
M v[224:227], a[100:103], a[180:183], v[224:227]
M v[228:231], a[108:111], a[180:183], v[228:231]
M v[228:231], a[104:107], a[176:179], v[228:231]
M v[232:235], a[112:115], a[176:179], v[232:235]
M v[232:235], a[116:119], a[180:183], v[232:235]
M v[236:239], a[124:127], a[180:183], v[236:239]
M v[236:239], a[120:123], a[176:179], v[236:239]
s_waitcnt vmcnt(16) lgkmcnt(0)
s_barrier
ds_read_b128 a[160:163], v10 offset:0
ds_read_b128 a[164:167], v11 offset:0
M v[240:243], a[128:131], a[176:179], v[240:243]
s_add_u32 m0, s29, 49152
s_add_u32 s3, s23, s31
buffer_load_dwordx4 v2, s[8:11], s3 offen offset:0 lds
M v[240:243], a[132:135], a[180:183], v[240:243]
M v[244:247], a[140:143], a[180:183], v[244:247]
M v[244:247], a[136:139], a[176:179], v[244:247]
M v[248:251], a[144:147], a[176:179], v[248:251]
M v[248:251], a[148:151], a[180:183], v[248:251]
buffer_load_dwordx4 v3, s[8:11], s3 offen offset:1024 lds
M v[252:255], a[156:159], a[180:183], v[252:255]
M v[252:255], a[152:155], a[176:179], v[252:255]
M a[0:3], a[96:99], a[184:187], a[0:3]
M a[0:3], a[100:103], a[188:191], a[0:3]
ds_read_b128 a[168:171], v10 offset:2048
ds_read_b128 a[172:175], v11 offset:2048
M a[4:7], a[108:111], a[188:191], a[4:7]
M a[4:7], a[104:107], a[184:187], a[4:7]
M a[8:11], a[112:115], a[184:187], a[8:11]
buffer_load_dwordx4 v4, s[8:11], s3 offen offset:2048 lds
M a[8:11], a[116:119], a[188:191], a[8:11]
M a[12:15], a[124:127], a[188:191], a[12:15]
M a[12:15], a[120:123], a[184:187], a[12:15]
M a[16:19], a[128:131], a[184:187], a[16:19]
M a[16:19], a[132:135], a[188:191], a[16:19]
buffer_load_dwordx4 v5, s[8:11], s3 offen offset:3072 lds
M a[20:23], a[140:143], a[188:191], a[20:23]
M a[20:23], a[136:139], a[184:187], a[20:23]
M a[24:27], a[144:147], a[184:187], a[24:27]
M a[24:27], a[148:151], a[188:191], a[24:27]
M a[28:31], a[156:159], a[188:191], a[28:31]
M a[28:31], a[152:155], a[184:187], a[28:31]
s_waitcnt lgkmcnt(2)
s_sub_u32 s30, s30, 1
s_cmp_lg_u32 s30, 0
s_cbranch_scc1 Lk1_kl
M v[32:35], a[32:35], a[160:163], v[32:35]
s_add_u32 s23, s23, 128
s_cmp_eq_u32 s23, s25
s_cselect_b32 s23, s26, s23
M v[32:35], a[36:39], a[164:167], v[32:35]
ds_read_b128 a[176:179], v10 offset:4096
ds_read_b128 a[180:183], v11 offset:4096
M v[36:39], a[44:47], a[164:167], v[36:39]
M v[36:39], a[40:43], a[160:163], v[36:39]
ds_read_b64_tr_b16 a[96:97], v12 offset:32768
ds_read_b64_tr_b16 a[98:99], v12 offset:34816
M v[40:43], a[48:51], a[160:163], v[40:43]
M v[40:43], a[52:55], a[164:167], v[40:43]
M v[44:47], a[60:63], a[164:167], v[44:47]
s_add_u32 m0, s29, 81920
s_nop 0
buffer_load_dwordx4 v6, s[12:15], s24 offen offset:0 lds
M v[44:47], a[56:59], a[160:163], v[44:47]
ds_read_b64_tr_b16 a[104:105], v13 offset:32768
ds_read_b64_tr_b16 a[106:107], v13 offset:34816
M v[48:51], a[64:67], a[160:163], v[48:51]
M v[48:51], a[68:71], a[164:167], v[48:51]
M v[52:55], a[76:79], a[164:167], v[52:55]
M v[52:55], a[72:75], a[160:163], v[52:55]
ds_read_b64_tr_b16 a[112:113], v14 offset:32768
ds_read_b64_tr_b16 a[114:115], v14 offset:34816
M v[56:59], a[80:83], a[160:163], v[56:59]
M v[56:59], a[84:87], a[164:167], v[56:59]
buffer_load_dwordx4 v7, s[12:15], s24 offen offset:1024 lds
M v[60:63], a[92:95], a[164:167], v[60:63]
M v[60:63], a[88:91], a[160:163], v[60:63]
s_waitcnt lgkmcnt(8)
ds_read_b64_tr_b16 a[120:121], v15 offset:32768
ds_read_b64_tr_b16 a[122:123], v15 offset:34816
M v[64:67], a[32:35], a[168:171], v[64:67]
M v[64:67], a[36:39], a[172:175], v[64:67]
ds_read_b128 a[184:187], v10 offset:6144
ds_read_b128 a[188:191], v11 offset:6144
M v[68:71], a[44:47], a[172:175], v[68:71]
M v[68:71], a[40:43], a[168:171], v[68:71]
ds_read_b64_tr_b16 a[128:129], v16 offset:32768
ds_read_b64_tr_b16 a[130:131], v16 offset:34816
M v[72:75], a[48:51], a[168:171], v[72:75]
buffer_load_dwordx4 v8, s[12:15], s24 offen offset:2048 lds
M v[72:75], a[52:55], a[172:175], v[72:75]
M v[76:79], a[60:63], a[172:175], v[76:79]
M v[76:79], a[56:59], a[168:171], v[76:79]
ds_read_b64_tr_b16 a[136:137], v17 offset:32768
ds_read_b64_tr_b16 a[138:139], v17 offset:34816
M v[80:83], a[64:67], a[168:171], v[80:83]
M v[80:83], a[68:71], a[172:175], v[80:83]
M v[84:87], a[76:79], a[172:175], v[84:87]
buffer_load_dwordx4 v9, s[12:15], s24 offen offset:3072 lds
M v[84:87], a[72:75], a[168:171], v[84:87]
ds_read_b64_tr_b16 a[144:145], v18 offset:32768
ds_read_b64_tr_b16 a[146:147], v18 offset:34816
M v[88:91], a[80:83], a[168:171], v[88:91]
M v[88:91], a[84:87], a[172:175], v[88:91]
M v[92:95], a[92:95], a[172:175], v[92:95]
M v[92:95], a[88:91], a[168:171], v[92:95]
s_waitcnt lgkmcnt(15)
ds_read_b64_tr_b16 a[152:153], v19 offset:32768
ds_read_b64_tr_b16 a[154:155], v19 offset:34816
M v[96:99], a[32:35], a[176:179], v[96:99]
s_add_u32 s24, s24, 262144
s_cmp_eq_u32 s24, s27
s_cselect_b32 s24, s28, s24
s_sub_u32 s6, s6, 1
s_cmp_eq_u32 s6, 0
s_cselect_b64 s[12:13], s[64:65], s[12:13]
M v[96:99], a[36:39], a[180:183], v[96:99]
M v[100:103], a[44:47], a[180:183], v[100:103]
M v[100:103], a[40:43], a[176:179], v[100:103]
M v[104:107], a[48:51], a[176:179], v[104:107]
M v[104:107], a[52:55], a[180:183], v[104:107]
M v[108:111], a[60:63], a[180:183], v[108:111]
M v[108:111], a[56:59], a[176:179], v[108:111]
s_waitcnt vmcnt(16) lgkmcnt(0)
s_barrier
ds_read_b128 a[160:163], v10 offset:16384
ds_read_b128 a[164:167], v11 offset:16384
M v[112:115], a[64:67], a[176:179], v[112:115]
s_add_u32 m0, s29, 0
s_nop 0
buffer_load_dwordx4 v2, s[8:11], s23 offen offset:0 lds
M v[112:115], a[68:71], a[180:183], v[112:115]
M v[116:119], a[76:79], a[180:183], v[116:119]
M v[116:119], a[72:75], a[176:179], v[116:119]
ds_read_b64_tr_b16 a[100:101], v12 offset:49152
ds_read_b64_tr_b16 a[102:103], v12 offset:51200
M v[120:123], a[80:83], a[176:179], v[120:123]
M v[120:123], a[84:87], a[180:183], v[120:123]
M v[124:127], a[92:95], a[180:183], v[124:127]
buffer_load_dwordx4 v3, s[8:11], s23 offen offset:1024 lds
M v[124:127], a[88:91], a[176:179], v[124:127]
M v[128:131], a[32:35], a[184:187], v[128:131]
M v[128:131], a[36:39], a[188:191], v[128:131]
ds_read_b128 a[168:171], v10 offset:18432
ds_read_b128 a[172:175], v11 offset:18432
ds_read_b64_tr_b16 a[108:109], v13 offset:49152
ds_read_b64_tr_b16 a[110:111], v13 offset:51200
M v[132:135], a[44:47], a[188:191], v[132:135]
M v[132:135], a[40:43], a[184:187], v[132:135]
M v[136:139], a[48:51], a[184:187], v[136:139]
M v[136:139], a[52:55], a[188:191], v[136:139]
buffer_load_dwordx4 v4, s[8:11], s23 offen offset:2048 lds
M v[140:143], a[60:63], a[188:191], v[140:143]
M v[140:143], a[56:59], a[184:187], v[140:143]
ds_read_b64_tr_b16 a[116:117], v14 offset:49152
ds_read_b64_tr_b16 a[118:119], v14 offset:51200
M v[144:147], a[64:67], a[184:187], v[144:147]
M v[144:147], a[68:71], a[188:191], v[144:147]
M v[148:151], a[76:79], a[188:191], v[148:151]
M v[148:151], a[72:75], a[184:187], v[148:151]
M v[152:155], a[80:83], a[184:187], v[152:155]
buffer_load_dwordx4 v5, s[8:11], s23 offen offset:3072 lds
s_lshr_b32 s3, s53, 7
s_add_u32 s3, s3, s22
M v[152:155], a[84:87], a[188:191], v[152:155]
ds_read_b64_tr_b16 a[124:125], v15 offset:49152
ds_read_b64_tr_b16 a[126:127], v15 offset:51200
s_lshl_b32 s3, s3, 5
s_lshr_b32 s19, s52, 6
M v[156:159], a[92:95], a[188:191], v[156:159]
s_add_u32 s3, s3, s19
s_lshl_b32 s19, s21, 1
M v[156:159], a[88:91], a[184:187], v[156:159]
s_waitcnt lgkmcnt(10)
s_add_u32 s3, s3, s19
s_lshl_b32 s92, s3, 15
M v[160:163], a[32:35], a[160:163], v[160:163]
s_add_u32 s93, s92, 32768
s_add_u32 s16, s50, 16777216
M v[160:163], a[36:39], a[164:167], v[160:163]
ds_read_b128 a[176:179], v10 offset:20480
ds_read_b128 a[180:183], v11 offset:20480
s_addc_u32 s17, s51, 0
s_mov_b32 s18, 33554432
M v[164:167], a[44:47], a[164:167], v[164:167]
s_mov_b32 s19, 0x00020000
M v[164:167], a[40:43], a[160:163], v[164:167]
ds_read_b64_tr_b16 a[132:133], v16 offset:49152
ds_read_b64_tr_b16 a[134:135], v16 offset:51200
M v[168:171], a[48:51], a[160:163], v[168:171]
M v[168:171], a[52:55], a[164:167], v[168:171]
s_add_u32 m0, s29, 98304
s_nop 0
buffer_load_dwordx4 v6, s[12:15], s24 offen offset:0 lds
M v[172:175], a[60:63], a[164:167], v[172:175]
M v[172:175], a[56:59], a[160:163], v[172:175]
M v[176:179], a[64:67], a[160:163], v[176:179]
M v[176:179], a[68:71], a[164:167], v[176:179]
ds_read_b64_tr_b16 a[140:141], v17 offset:49152
ds_read_b64_tr_b16 a[142:143], v17 offset:51200
M v[180:183], a[76:79], a[164:167], v[180:183]
M v[180:183], a[72:75], a[160:163], v[180:183]
buffer_load_dwordx4 v7, s[12:15], s24 offen offset:1024 lds
M v[184:187], a[80:83], a[160:163], v[184:187]
M v[184:187], a[84:87], a[164:167], v[184:187]
M v[188:191], a[92:95], a[164:167], v[188:191]
M v[188:191], a[88:91], a[160:163], v[188:191]
s_waitcnt lgkmcnt(12)
ds_read_b64_tr_b16 a[148:149], v18 offset:49152
ds_read_b64_tr_b16 a[150:151], v18 offset:51200
M v[192:195], a[32:35], a[168:171], v[192:195]
M v[192:195], a[36:39], a[172:175], v[192:195]
ds_read_b128 a[184:187], v10 offset:22528
ds_read_b128 a[188:191], v11 offset:22528
M v[196:199], a[44:47], a[172:175], v[196:199]
M v[196:199], a[40:43], a[168:171], v[196:199]
buffer_load_dwordx4 v8, s[12:15], s24 offen offset:2048 lds
M v[200:203], a[48:51], a[168:171], v[200:203]
M v[200:203], a[52:55], a[172:175], v[200:203]
ds_read_b64_tr_b16 a[156:157], v19 offset:49152
ds_read_b64_tr_b16 a[158:159], v19 offset:51200
M v[204:207], a[60:63], a[172:175], v[204:207]
M v[204:207], a[56:59], a[168:171], v[204:207]
M v[208:211], a[64:67], a[168:171], v[208:211]
M v[208:211], a[68:71], a[172:175], v[208:211]
buffer_load_dwordx4 v9, s[12:15], s24 offen offset:3072 lds
M v[212:215], a[76:79], a[172:175], v[212:215]
M v[212:215], a[72:75], a[168:171], v[212:215]
M v[216:219], a[80:83], a[168:171], v[216:219]
M v[216:219], a[84:87], a[172:175], v[216:219]
M v[220:223], a[92:95], a[172:175], v[220:223]
s_add_u32 s24, s24, 262144
M v[220:223], a[88:91], a[168:171], v[220:223]
s_waitcnt lgkmcnt(10)
M v[224:227], a[32:35], a[176:179], v[224:227]
M v[224:227], a[36:39], a[180:183], v[224:227]
M v[228:231], a[44:47], a[180:183], v[228:231]
M v[228:231], a[40:43], a[176:179], v[228:231]
M v[232:235], a[48:51], a[176:179], v[232:235]
M v[232:235], a[52:55], a[180:183], v[232:235]
M v[236:239], a[60:63], a[180:183], v[236:239]
M v[236:239], a[56:59], a[176:179], v[236:239]
s_waitcnt vmcnt(16) lgkmcnt(0)
s_barrier
ds_read_b128 a[160:163], v10 offset:32768
ds_read_b128 a[164:167], v11 offset:32768
M v[240:243], a[64:67], a[176:179], v[240:243]
s_add_u32 m0, s29, 16384
s_add_u32 s3, s23, s31
buffer_load_dwordx4 v2, s[8:11], s3 offen offset:0 lds
M v[240:243], a[68:71], a[180:183], v[240:243]
M v[244:247], a[76:79], a[180:183], v[244:247]
M v[244:247], a[72:75], a[176:179], v[244:247]
M v[248:251], a[80:83], a[176:179], v[248:251]
M v[248:251], a[84:87], a[180:183], v[248:251]
buffer_load_dwordx4 v3, s[8:11], s3 offen offset:1024 lds
M v[252:255], a[92:95], a[180:183], v[252:255]
M v[252:255], a[88:91], a[176:179], v[252:255]
M a[0:3], a[32:35], a[184:187], a[0:3]
M a[0:3], a[36:39], a[188:191], a[0:3]
ds_read_b128 a[168:171], v10 offset:34816
ds_read_b128 a[172:175], v11 offset:34816
M a[4:7], a[44:47], a[188:191], a[4:7]
M a[4:7], a[40:43], a[184:187], a[4:7]
M a[8:11], a[48:51], a[184:187], a[8:11]
buffer_load_dwordx4 v4, s[8:11], s3 offen offset:2048 lds
M a[8:11], a[52:55], a[188:191], a[8:11]
M a[12:15], a[60:63], a[188:191], a[12:15]
M a[12:15], a[56:59], a[184:187], a[12:15]
M a[16:19], a[64:67], a[184:187], a[16:19]
M a[16:19], a[68:71], a[188:191], a[16:19]
buffer_load_dwordx4 v5, s[8:11], s3 offen offset:3072 lds
M a[20:23], a[76:79], a[188:191], a[20:23]
M a[20:23], a[72:75], a[184:187], a[20:23]
M a[24:27], a[80:83], a[184:187], a[24:27]
M a[24:27], a[84:87], a[188:191], a[24:27]
M a[28:31], a[92:95], a[188:191], a[28:31]
M a[28:31], a[88:91], a[184:187], a[28:31]
s_waitcnt lgkmcnt(2)
M v[32:35], a[96:99], a[160:163], v[32:35]
s_add_u32 s23, s23, 128
s_cmp_eq_u32 s23, s25
s_cselect_b32 s23, s26, s23
M v[32:35], a[100:103], a[164:167], v[32:35]
ds_read_b128 a[176:179], v10 offset:36864
ds_read_b128 a[180:183], v11 offset:36864
M v[36:39], a[108:111], a[164:167], v[36:39]
M v[36:39], a[104:107], a[160:163], v[36:39]
ds_read_b64_tr_b16 a[32:33], v12 offset:0
ds_read_b64_tr_b16 a[34:35], v12 offset:2048
M v[40:43], a[112:115], a[160:163], v[40:43]
M v[40:43], a[116:119], a[164:167], v[40:43]
M v[44:47], a[124:127], a[164:167], v[44:47]
s_add_u32 m0, s29, 114688
s_nop 0
buffer_load_dwordx4 v6, s[12:15], s24 offen offset:0 lds
M v[44:47], a[120:123], a[160:163], v[44:47]
ds_read_b64_tr_b16 a[40:41], v13 offset:0
ds_read_b64_tr_b16 a[42:43], v13 offset:2048
M v[48:51], a[128:131], a[160:163], v[48:51]
M v[48:51], a[132:135], a[164:167], v[48:51]
M v[52:55], a[140:143], a[164:167], v[52:55]
M v[52:55], a[136:139], a[160:163], v[52:55]
ds_read_b64_tr_b16 a[48:49], v14 offset:0
ds_read_b64_tr_b16 a[50:51], v14 offset:2048
M v[56:59], a[144:147], a[160:163], v[56:59]
buffer_load_dwordx4 v7, s[12:15], s24 offen offset:1024 lds
M v[56:59], a[148:151], a[164:167], v[56:59]
M v[60:63], a[156:159], a[164:167], v[60:63]
M v[60:63], a[152:155], a[160:163], v[60:63]
s_waitcnt lgkmcnt(8)
ds_read_b64_tr_b16 a[56:57], v15 offset:0
ds_read_b64_tr_b16 a[58:59], v15 offset:2048
M v[64:67], a[96:99], a[168:171], v[64:67]
M v[64:67], a[100:103], a[172:175], v[64:67]
ds_read_b128 a[184:187], v10 offset:38912
ds_read_b128 a[188:191], v11 offset:38912
M v[68:71], a[108:111], a[172:175], v[68:71]
M v[68:71], a[104:107], a[168:171], v[68:71]
ds_read_b64_tr_b16 a[64:65], v16 offset:0
ds_read_b64_tr_b16 a[66:67], v16 offset:2048
v_cvt_pk_bf16_f32 v32, v32, v33
v_cvt_pk_bf16_f32 v33, v34, v35
M v[72:75], a[112:115], a[168:171], v[72:75]
buffer_load_dwordx4 v8, s[12:15], s24 offen offset:2048 lds
v_cvt_pk_bf16_f32 v34, v36, v37
v_cvt_pk_bf16_f32 v35, v38, v39
M v[72:75], a[116:119], a[172:175], v[72:75]
v_cvt_pk_bf16_f32 v40, v40, v41
v_cvt_pk_bf16_f32 v41, v42, v43
M v[76:79], a[124:127], a[172:175], v[76:79]
v_cvt_pk_bf16_f32 v42, v44, v45
v_cvt_pk_bf16_f32 v43, v46, v47
M v[76:79], a[120:123], a[168:171], v[76:79]
ds_read_b64_tr_b16 a[72:73], v17 offset:0
ds_read_b64_tr_b16 a[74:75], v17 offset:2048
v_cvt_pk_bf16_f32 v48, v48, v49
v_cvt_pk_bf16_f32 v49, v50, v51
M v[80:83], a[128:131], a[168:171], v[80:83]
v_cvt_pk_bf16_f32 v50, v52, v53
v_cvt_pk_bf16_f32 v51, v54, v55
M v[80:83], a[132:135], a[172:175], v[80:83]
buffer_load_dwordx4 v9, s[12:15], s24 offen offset:3072 lds
v_cvt_pk_bf16_f32 v56, v56, v57
v_cvt_pk_bf16_f32 v57, v58, v59
M v[84:87], a[140:143], a[172:175], v[84:87]
v_cvt_pk_bf16_f32 v58, v60, v61
v_cvt_pk_bf16_f32 v59, v62, v63
M v[84:87], a[136:139], a[168:171], v[84:87]
ds_read_b64_tr_b16 a[80:81], v18 offset:0
ds_read_b64_tr_b16 a[82:83], v18 offset:2048
M v[88:91], a[144:147], a[168:171], v[88:91]
M v[88:91], a[148:151], a[172:175], v[88:91]
M v[92:95], a[156:159], a[172:175], v[92:95]
s_add_u32 s94, s92, 0
buffer_store_dwordx4 v[32:35], v1, s[16:19], s94 offen offset:0 sc1
M v[92:95], a[152:155], a[168:171], v[92:95]
s_waitcnt lgkmcnt(15)
ds_read_b64_tr_b16 a[88:89], v19 offset:0
ds_read_b64_tr_b16 a[90:91], v19 offset:2048
M v[96:99], a[96:99], a[176:179], v[96:99]
s_add_u32 s24, s24, 262144
s_cmp_eq_u32 s24, s27
s_cselect_b32 s24, s28, s24
s_sub_u32 s6, s6, 1
s_cmp_eq_u32 s6, 0
s_cselect_b64 s[12:13], s[64:65], s[12:13]
M v[96:99], a[100:103], a[180:183], v[96:99]
M v[100:103], a[108:111], a[180:183], v[100:103]
M v[100:103], a[104:107], a[176:179], v[100:103]
v_cvt_pk_bf16_f32 v64, v64, v65
v_cvt_pk_bf16_f32 v65, v66, v67
M v[104:107], a[112:115], a[176:179], v[104:107]
v_cvt_pk_bf16_f32 v66, v68, v69
v_cvt_pk_bf16_f32 v67, v70, v71
M v[104:107], a[116:119], a[180:183], v[104:107]
v_cvt_pk_bf16_f32 v72, v72, v73
v_cvt_pk_bf16_f32 v73, v74, v75
M v[108:111], a[124:127], a[180:183], v[108:111]
v_cvt_pk_bf16_f32 v74, v76, v77
v_cvt_pk_bf16_f32 v75, v78, v79
M v[108:111], a[120:123], a[176:179], v[108:111]
s_waitcnt vmcnt(17) lgkmcnt(0)
s_barrier
ds_read_b128 a[160:163], v10 offset:49152
ds_read_b128 a[164:167], v11 offset:49152
v_cvt_pk_bf16_f32 v80, v80, v81
v_cvt_pk_bf16_f32 v81, v82, v83
M v[112:115], a[128:131], a[176:179], v[112:115]
s_add_u32 s94, s92, 0
buffer_store_dwordx4 v[40:43], v1, s[16:19], s94 offen offset:1024 sc1
v_cvt_pk_bf16_f32 v82, v84, v85
v_cvt_pk_bf16_f32 v83, v86, v87
M v[112:115], a[132:135], a[180:183], v[112:115]
s_add_u32 m0, s29, 32768
s_nop 0
buffer_load_dwordx4 v2, s[8:11], s23 offen offset:0 lds
v_cvt_pk_bf16_f32 v88, v88, v89
v_cvt_pk_bf16_f32 v89, v90, v91
M v[116:119], a[140:143], a[180:183], v[116:119]
v_cvt_pk_bf16_f32 v90, v92, v93
v_cvt_pk_bf16_f32 v91, v94, v95
M v[116:119], a[136:139], a[176:179], v[116:119]
ds_read_b64_tr_b16 a[36:37], v12 offset:16384
ds_read_b64_tr_b16 a[38:39], v12 offset:18432
M v[120:123], a[144:147], a[176:179], v[120:123]
M v[120:123], a[148:151], a[180:183], v[120:123]
M v[124:127], a[156:159], a[180:183], v[124:127]
buffer_load_dwordx4 v3, s[8:11], s23 offen offset:1024 lds
M v[124:127], a[152:155], a[176:179], v[124:127]
M v[128:131], a[96:99], a[184:187], v[128:131]
M v[128:131], a[100:103], a[188:191], v[128:131]
ds_read_b128 a[168:171], v10 offset:51200
ds_read_b128 a[172:175], v11 offset:51200
ds_read_b64_tr_b16 a[44:45], v13 offset:16384
ds_read_b64_tr_b16 a[46:47], v13 offset:18432
M v[132:135], a[108:111], a[188:191], v[132:135]
M v[132:135], a[104:107], a[184:187], v[132:135]
s_add_u32 s94, s92, 0
buffer_store_dwordx4 v[48:51], v1, s[16:19], s94 offen offset:2048 sc1
v_cvt_pk_bf16_f32 v96, v96, v97
v_cvt_pk_bf16_f32 v97, v98, v99
M v[136:139], a[112:115], a[184:187], v[136:139]
v_cvt_pk_bf16_f32 v98, v100, v101
v_cvt_pk_bf16_f32 v99, v102, v103
M v[136:139], a[116:119], a[188:191], v[136:139]
v_cvt_pk_bf16_f32 v104, v104, v105
v_cvt_pk_bf16_f32 v105, v106, v107
M v[140:143], a[124:127], a[188:191], v[140:143]
buffer_load_dwordx4 v4, s[8:11], s23 offen offset:2048 lds
v_cvt_pk_bf16_f32 v106, v108, v109
v_cvt_pk_bf16_f32 v107, v110, v111
M v[140:143], a[120:123], a[184:187], v[140:143]
ds_read_b64_tr_b16 a[52:53], v14 offset:16384
ds_read_b64_tr_b16 a[54:55], v14 offset:18432
v_cvt_pk_bf16_f32 v112, v112, v113
v_cvt_pk_bf16_f32 v113, v114, v115
M v[144:147], a[128:131], a[184:187], v[144:147]
v_cvt_pk_bf16_f32 v114, v116, v117
v_cvt_pk_bf16_f32 v115, v118, v119
M v[144:147], a[132:135], a[188:191], v[144:147]
v_cvt_pk_bf16_f32 v120, v120, v121
v_cvt_pk_bf16_f32 v121, v122, v123
M v[148:151], a[140:143], a[188:191], v[148:151]
v_cvt_pk_bf16_f32 v122, v124, v125
v_cvt_pk_bf16_f32 v123, v126, v127
M v[148:151], a[136:139], a[184:187], v[148:151]
M v[152:155], a[144:147], a[184:187], v[152:155]
buffer_load_dwordx4 v5, s[8:11], s23 offen offset:3072 lds
M v[152:155], a[148:151], a[188:191], v[152:155]
ds_read_b64_tr_b16 a[60:61], v15 offset:16384
ds_read_b64_tr_b16 a[62:63], v15 offset:18432
M v[156:159], a[156:159], a[188:191], v[156:159]
s_add_u32 s94, s92, 0
buffer_store_dwordx4 v[56:59], v1, s[16:19], s94 offen offset:3072 sc1
M v[156:159], a[152:155], a[184:187], v[156:159]
s_waitcnt lgkmcnt(10)
M v[160:163], a[96:99], a[160:163], v[160:163]
M v[160:163], a[100:103], a[164:167], v[160:163]
ds_read_b128 a[176:179], v10 offset:53248
ds_read_b128 a[180:183], v11 offset:53248
M v[164:167], a[108:111], a[164:167], v[164:167]
M v[164:167], a[104:107], a[160:163], v[164:167]
ds_read_b64_tr_b16 a[68:69], v16 offset:16384
ds_read_b64_tr_b16 a[70:71], v16 offset:18432
v_cvt_pk_bf16_f32 v128, v128, v129
v_cvt_pk_bf16_f32 v129, v130, v131
M v[168:171], a[112:115], a[160:163], v[168:171]
v_cvt_pk_bf16_f32 v130, v132, v133
v_cvt_pk_bf16_f32 v131, v134, v135
M v[168:171], a[116:119], a[164:167], v[168:171]
s_add_u32 m0, s29, 65536
s_nop 0
buffer_load_dwordx4 v6, s[12:15], s24 offen offset:0 lds
v_cvt_pk_bf16_f32 v136, v136, v137
v_cvt_pk_bf16_f32 v137, v138, v139
M v[172:175], a[124:127], a[164:167], v[172:175]
v_cvt_pk_bf16_f32 v138, v140, v141
v_cvt_pk_bf16_f32 v139, v142, v143
M v[172:175], a[120:123], a[160:163], v[172:175]
v_cvt_pk_bf16_f32 v144, v144, v145
v_cvt_pk_bf16_f32 v145, v146, v147
M v[176:179], a[128:131], a[160:163], v[176:179]
s_add_u32 s94, s92, 4096
buffer_store_dwordx4 v[64:67], v1, s[16:19], s94 offen offset:0 sc1
v_cvt_pk_bf16_f32 v146, v148, v149
v_cvt_pk_bf16_f32 v147, v150, v151
M v[176:179], a[132:135], a[164:167], v[176:179]
ds_read_b64_tr_b16 a[76:77], v17 offset:16384
ds_read_b64_tr_b16 a[78:79], v17 offset:18432
v_cvt_pk_bf16_f32 v152, v152, v153
v_cvt_pk_bf16_f32 v153, v154, v155
M v[180:183], a[140:143], a[164:167], v[180:183]
v_cvt_pk_bf16_f32 v154, v156, v157
v_cvt_pk_bf16_f32 v155, v158, v159
M v[180:183], a[136:139], a[160:163], v[180:183]
M v[184:187], a[144:147], a[160:163], v[184:187]
buffer_load_dwordx4 v7, s[12:15], s24 offen offset:1024 lds
v_accvgpr_write_b32 a192, v128
v_accvgpr_write_b32 a193, v129
v_accvgpr_write_b32 a194, v130
v_accvgpr_write_b32 a195, v131
M v[184:187], a[148:151], a[164:167], v[184:187]
v_accvgpr_write_b32 a196, v136
v_accvgpr_write_b32 a197, v137
v_accvgpr_write_b32 a198, v138
v_accvgpr_write_b32 a199, v139
M v[188:191], a[156:159], a[164:167], v[188:191]
v_accvgpr_write_b32 a200, v144
v_accvgpr_write_b32 a201, v145
v_accvgpr_write_b32 a202, v146
v_accvgpr_write_b32 a203, v147
M v[188:191], a[152:155], a[160:163], v[188:191]
s_waitcnt lgkmcnt(12)
ds_read_b64_tr_b16 a[84:85], v18 offset:16384
ds_read_b64_tr_b16 a[86:87], v18 offset:18432
v_accvgpr_write_b32 a204, v152
v_accvgpr_write_b32 a205, v153
v_accvgpr_write_b32 a206, v154
v_accvgpr_write_b32 a207, v155
M v[192:195], a[96:99], a[168:171], v[192:195]
M v[192:195], a[100:103], a[172:175], v[192:195]
ds_read_b128 a[184:187], v10 offset:55296
ds_read_b128 a[188:191], v11 offset:55296
M v[196:199], a[108:111], a[172:175], v[196:199]
s_add_u32 s94, s92, 4096
buffer_store_dwordx4 v[72:75], v1, s[16:19], s94 offen offset:1024 sc1
M v[196:199], a[104:107], a[168:171], v[196:199]
v_cvt_pk_bf16_f32 v160, v160, v161
v_cvt_pk_bf16_f32 v161, v162, v163
M v[200:203], a[112:115], a[168:171], v[200:203]
buffer_load_dwordx4 v8, s[12:15], s24 offen offset:2048 lds
v_cvt_pk_bf16_f32 v162, v164, v165
v_cvt_pk_bf16_f32 v163, v166, v167
M v[200:203], a[116:119], a[172:175], v[200:203]
ds_read_b64_tr_b16 a[92:93], v19 offset:16384
ds_read_b64_tr_b16 a[94:95], v19 offset:18432
v_cvt_pk_bf16_f32 v168, v168, v169
v_cvt_pk_bf16_f32 v169, v170, v171
M v[204:207], a[124:127], a[172:175], v[204:207]
v_cvt_pk_bf16_f32 v170, v172, v173
v_cvt_pk_bf16_f32 v171, v174, v175
M v[204:207], a[120:123], a[168:171], v[204:207]
v_cvt_pk_bf16_f32 v176, v176, v177
v_cvt_pk_bf16_f32 v177, v178, v179
M v[208:211], a[128:131], a[168:171], v[208:211]
v_cvt_pk_bf16_f32 v178, v180, v181
v_cvt_pk_bf16_f32 v179, v182, v183
M v[208:211], a[132:135], a[172:175], v[208:211]
buffer_load_dwordx4 v9, s[12:15], s24 offen offset:3072 lds
v_cvt_pk_bf16_f32 v184, v184, v185
v_cvt_pk_bf16_f32 v185, v186, v187
M v[212:215], a[140:143], a[172:175], v[212:215]
v_cvt_pk_bf16_f32 v186, v188, v189
v_cvt_pk_bf16_f32 v187, v190, v191
M v[212:215], a[136:139], a[168:171], v[212:215]
M v[216:219], a[144:147], a[168:171], v[216:219]
v_accvgpr_write_b32 a208, v160
v_accvgpr_write_b32 a209, v161
v_accvgpr_write_b32 a210, v162
v_accvgpr_write_b32 a211, v163
M v[216:219], a[148:151], a[172:175], v[216:219]
s_add_u32 s94, s92, 4096
buffer_store_dwordx4 v[80:83], v1, s[16:19], s94 offen offset:2048 sc1
v_accvgpr_write_b32 a212, v168
v_accvgpr_write_b32 a213, v169
v_accvgpr_write_b32 a214, v170
v_accvgpr_write_b32 a215, v171
M v[220:223], a[156:159], a[172:175], v[220:223]
v_accvgpr_write_b32 a216, v176
v_accvgpr_write_b32 a217, v177
v_accvgpr_write_b32 a218, v178
v_accvgpr_write_b32 a219, v179
M v[220:223], a[152:155], a[168:171], v[220:223]
s_waitcnt lgkmcnt(10)
v_accvgpr_write_b32 a220, v184
v_accvgpr_write_b32 a221, v185
v_accvgpr_write_b32 a222, v186
v_accvgpr_write_b32 a223, v187
M v[224:227], a[96:99], a[176:179], v[224:227]
s_add_u32 s24, s24, 262144
M v[224:227], a[100:103], a[180:183], v[224:227]
M v[228:231], a[108:111], a[180:183], v[228:231]
M v[228:231], a[104:107], a[176:179], v[228:231]
v_cvt_pk_bf16_f32 v192, v192, v193
v_cvt_pk_bf16_f32 v193, v194, v195
M v[232:235], a[112:115], a[176:179], v[232:235]
v_cvt_pk_bf16_f32 v194, v196, v197
v_cvt_pk_bf16_f32 v195, v198, v199
M v[232:235], a[116:119], a[180:183], v[232:235]
v_cvt_pk_bf16_f32 v200, v200, v201
v_cvt_pk_bf16_f32 v201, v202, v203
M v[236:239], a[124:127], a[180:183], v[236:239]
v_cvt_pk_bf16_f32 v202, v204, v205
v_cvt_pk_bf16_f32 v203, v206, v207
M v[236:239], a[120:123], a[176:179], v[236:239]
s_waitcnt vmcnt(23) lgkmcnt(0)
s_barrier
ds_read_b128 a[160:163], v10 offset:0
ds_read_b128 a[164:167], v11 offset:0
v_cvt_pk_bf16_f32 v208, v208, v209
v_cvt_pk_bf16_f32 v209, v210, v211
M v[240:243], a[128:131], a[176:179], v[240:243]
s_add_u32 s94, s92, 4096
buffer_store_dwordx4 v[88:91], v1, s[16:19], s94 offen offset:3072 sc1
v_cvt_pk_bf16_f32 v210, v212, v213
v_cvt_pk_bf16_f32 v211, v214, v215
M v[240:243], a[132:135], a[180:183], v[240:243]
s_add_u32 m0, s29, 49152
s_add_u32 s3, s23, s31
buffer_load_dwordx4 v2, s[8:11], s3 offen offset:0 lds
v_cvt_pk_bf16_f32 v216, v216, v217
v_cvt_pk_bf16_f32 v217, v218, v219
M v[244:247], a[140:143], a[180:183], v[244:247]
v_cvt_pk_bf16_f32 v218, v220, v221
v_cvt_pk_bf16_f32 v219, v222, v223
M v[244:247], a[136:139], a[176:179], v[244:247]
M v[248:251], a[144:147], a[176:179], v[248:251]
v_accvgpr_write_b32 a224, v192
v_accvgpr_write_b32 a225, v193
v_accvgpr_write_b32 a226, v194
v_accvgpr_write_b32 a227, v195
M v[248:251], a[148:151], a[180:183], v[248:251]
buffer_load_dwordx4 v3, s[8:11], s3 offen offset:1024 lds
v_accvgpr_write_b32 a228, v200
v_accvgpr_write_b32 a229, v201
v_accvgpr_write_b32 a230, v202
v_accvgpr_write_b32 a231, v203
M v[252:255], a[156:159], a[180:183], v[252:255]
v_accvgpr_write_b32 a232, v208
v_accvgpr_write_b32 a233, v209
v_accvgpr_write_b32 a234, v210
v_accvgpr_write_b32 a235, v211
M v[252:255], a[152:155], a[176:179], v[252:255]
v_accvgpr_write_b32 a236, v216
v_accvgpr_write_b32 a237, v217
v_accvgpr_write_b32 a238, v218
v_accvgpr_write_b32 a239, v219
M a[0:3], a[96:99], a[184:187], a[0:3]
M a[0:3], a[100:103], a[188:191], a[0:3]
ds_read_b128 a[168:171], v10 offset:2048
ds_read_b128 a[172:175], v11 offset:2048
M a[4:7], a[108:111], a[188:191], a[4:7]
s_add_u32 s94, s92, 8192
buffer_store_dwordx4 v[96:99], v1, s[16:19], s94 offen offset:0 sc1
M a[4:7], a[104:107], a[184:187], a[4:7]
v_cvt_pk_bf16_f32 v224, v224, v225
v_cvt_pk_bf16_f32 v225, v226, v227
M a[8:11], a[112:115], a[184:187], a[8:11]
v_cvt_pk_bf16_f32 v226, v228, v229
v_cvt_pk_bf16_f32 v227, v230, v231
M a[8:11], a[116:119], a[188:191], a[8:11]
buffer_load_dwordx4 v4, s[8:11], s3 offen offset:2048 lds
v_cvt_pk_bf16_f32 v232, v232, v233
v_cvt_pk_bf16_f32 v233, v234, v235
M a[12:15], a[124:127], a[188:191], a[12:15]
v_cvt_pk_bf16_f32 v234, v236, v237
v_cvt_pk_bf16_f32 v235, v238, v239
M a[12:15], a[120:123], a[184:187], a[12:15]
v_cvt_pk_bf16_f32 v240, v240, v241
v_cvt_pk_bf16_f32 v241, v242, v243
M a[16:19], a[128:131], a[184:187], a[16:19]
v_cvt_pk_bf16_f32 v242, v244, v245
v_cvt_pk_bf16_f32 v243, v246, v247
M a[16:19], a[132:135], a[188:191], a[16:19]
buffer_load_dwordx4 v5, s[8:11], s3 offen offset:3072 lds
v_cvt_pk_bf16_f32 v248, v248, v249
v_cvt_pk_bf16_f32 v249, v250, v251
M a[20:23], a[140:143], a[188:191], a[20:23]
v_cvt_pk_bf16_f32 v250, v252, v253
v_cvt_pk_bf16_f32 v251, v254, v255
M a[20:23], a[136:139], a[184:187], a[20:23]
M a[24:27], a[144:147], a[184:187], a[24:27]
s_add_u32 s94, s92, 8192
buffer_store_dwordx4 v[104:107], v1, s[16:19], s94 offen offset:1024 sc1
v_accvgpr_write_b32 a240, v224
v_accvgpr_write_b32 a241, v225
v_accvgpr_write_b32 a242, v226
v_accvgpr_write_b32 a243, v227
M a[24:27], a[148:151], a[188:191], a[24:27]
v_accvgpr_write_b32 a244, v232
v_accvgpr_write_b32 a245, v233
v_accvgpr_write_b32 a246, v234
v_accvgpr_write_b32 a247, v235
M a[28:31], a[156:159], a[188:191], a[28:31]
v_accvgpr_write_b32 a248, v240
v_accvgpr_write_b32 a249, v241
v_accvgpr_write_b32 a250, v242
v_accvgpr_write_b32 a251, v243
M a[28:31], a[152:155], a[184:187], a[28:31]
s_waitcnt lgkmcnt(2)
v_accvgpr_write_b32 a252, v248
v_accvgpr_write_b32 a253, v249
v_accvgpr_write_b32 a254, v250
v_accvgpr_write_b32 a255, v251
M v[32:35], a[160:163], a[32:35], 0
s_add_u32 s23, s23, 128
s_cmp_eq_u32 s23, s25
s_cselect_b32 s23, s26, s23
M v[32:35], a[164:167], a[36:39], v[32:35]
ds_read_b128 a[176:179], v10 offset:4096
ds_read_b128 a[180:183], v11 offset:4096
M v[36:39], a[164:167], a[44:47], 0
M v[36:39], a[160:163], a[40:43], v[36:39]
ds_read_b64_tr_b16 a[96:97], v12 offset:32768
ds_read_b64_tr_b16 a[98:99], v12 offset:34816
M v[40:43], a[160:163], a[48:51], 0
M v[40:43], a[164:167], a[52:55], v[40:43]
M v[44:47], a[164:167], a[60:63], 0
s_add_u32 m0, s29, 81920
s_nop 0
buffer_load_dwordx4 v6, s[12:15], s24 offen offset:0 lds
M v[44:47], a[160:163], a[56:59], v[44:47]
ds_read_b64_tr_b16 a[104:105], v13 offset:32768
ds_read_b64_tr_b16 a[106:107], v13 offset:34816
M v[48:51], a[160:163], a[64:67], 0
s_add_u32 s94, s92, 8192
buffer_store_dwordx4 v[112:115], v1, s[16:19], s94 offen offset:2048 sc1
M v[48:51], a[164:167], a[68:71], v[48:51]
M v[52:55], a[164:167], a[76:79], 0
M v[52:55], a[160:163], a[72:75], v[52:55]
ds_read_b64_tr_b16 a[112:113], v14 offset:32768
ds_read_b64_tr_b16 a[114:115], v14 offset:34816
M v[56:59], a[160:163], a[80:83], 0
M v[56:59], a[164:167], a[84:87], v[56:59]
buffer_load_dwordx4 v7, s[12:15], s24 offen offset:1024 lds
M v[60:63], a[164:167], a[92:95], 0
M v[60:63], a[160:163], a[88:91], v[60:63]
s_waitcnt lgkmcnt(8)
ds_read_b64_tr_b16 a[120:121], v15 offset:32768
ds_read_b64_tr_b16 a[122:123], v15 offset:34816
M v[64:67], a[168:171], a[32:35], 0
M v[64:67], a[172:175], a[36:39], v[64:67]
ds_read_b128 a[184:187], v10 offset:6144
ds_read_b128 a[188:191], v11 offset:6144
M v[68:71], a[172:175], a[44:47], 0
s_add_u32 s94, s92, 8192
buffer_store_dwordx4 v[120:123], v1, s[16:19], s94 offen offset:3072 sc1
M v[68:71], a[168:171], a[40:43], v[68:71]
ds_read_b64_tr_b16 a[128:129], v16 offset:32768
ds_read_b64_tr_b16 a[130:131], v16 offset:34816
M v[72:75], a[168:171], a[48:51], 0
v_accvgpr_read_b32 v24, a0
v_accvgpr_read_b32 v25, a1
M v[72:75], a[172:175], a[52:55], v[72:75]
buffer_load_dwordx4 v8, s[12:15], s24 offen offset:2048 lds
v_accvgpr_read_b32 v26, a2
v_accvgpr_read_b32 v27, a3
M v[76:79], a[172:175], a[60:63], 0
v_accvgpr_read_b32 v28, a4
v_accvgpr_read_b32 v29, a5
M v[76:79], a[168:171], a[56:59], v[76:79]
ds_read_b64_tr_b16 a[136:137], v17 offset:32768
ds_read_b64_tr_b16 a[138:139], v17 offset:34816
v_accvgpr_read_b32 v30, a6
v_accvgpr_read_b32 v31, a7
M v[80:83], a[168:171], a[64:67], 0
v_cvt_pk_bf16_f32 v24, v24, v25
v_cvt_pk_bf16_f32 v25, v26, v27
M v[80:83], a[172:175], a[68:71], v[80:83]
v_cvt_pk_bf16_f32 v26, v28, v29
v_cvt_pk_bf16_f32 v27, v30, v31
M v[84:87], a[172:175], a[76:79], 0
buffer_load_dwordx4 v9, s[12:15], s24 offen offset:3072 lds
M v[84:87], a[168:171], a[72:75], v[84:87]
ds_read_b64_tr_b16 a[144:145], v18 offset:32768
ds_read_b64_tr_b16 a[146:147], v18 offset:34816
M v[88:91], a[168:171], a[80:83], 0
M v[88:91], a[172:175], a[84:87], v[88:91]
s_add_u32 s94, s93, 12288
buffer_store_dwordx4 v[24:27], v1, s[16:19], s94 offen offset:0 sc1
M v[92:95], a[172:175], a[92:95], 0
M v[92:95], a[168:171], a[88:91], v[92:95]
s_waitcnt lgkmcnt(15)
ds_read_b64_tr_b16 a[152:153], v19 offset:32768
ds_read_b64_tr_b16 a[154:155], v19 offset:34816
M v[96:99], a[176:179], a[32:35], 0
M v[96:99], a[180:183], a[36:39], v[96:99]
s_add_u32 s24, s24, 262144
s_cmp_eq_u32 s24, s27
s_cselect_b32 s24, s28, s24
s_sub_u32 s6, s6, 1
s_cmp_eq_u32 s6, 0
s_cselect_b64 s[12:13], s[64:65], s[12:13]
M v[100:103], a[180:183], a[44:47], 0
M v[100:103], a[176:179], a[40:43], v[100:103]
M v[104:107], a[176:179], a[48:51], 0
M v[104:107], a[180:183], a[52:55], v[104:107]
M v[108:111], a[180:183], a[60:63], 0
M v[108:111], a[176:179], a[56:59], v[108:111]
s_waitcnt vmcnt(29) lgkmcnt(0)
s_barrier
ds_read_b128 a[160:163], v10 offset:16384
ds_read_b128 a[164:167], v11 offset:16384
M v[112:115], a[176:179], a[64:67], 0
s_add_u32 m0, s29, 0
s_nop 0
buffer_load_dwordx4 v2, s[8:11], s23 offen offset:0 lds
M v[112:115], a[180:183], a[68:71], v[112:115]
M v[116:119], a[180:183], a[76:79], 0
M v[116:119], a[176:179], a[72:75], v[116:119]
ds_read_b64_tr_b16 a[100:101], v12 offset:49152
ds_read_b64_tr_b16 a[102:103], v12 offset:51200
M v[120:123], a[176:179], a[80:83], 0
v_accvgpr_read_b32 v24, a8
v_accvgpr_read_b32 v25, a9
M v[120:123], a[180:183], a[84:87], v[120:123]
v_accvgpr_read_b32 v26, a10
v_accvgpr_read_b32 v27, a11
M v[124:127], a[180:183], a[92:95], 0
buffer_load_dwordx4 v3, s[8:11], s23 offen offset:1024 lds
v_accvgpr_read_b32 v28, a12
v_accvgpr_read_b32 v29, a13
M v[124:127], a[176:179], a[88:91], v[124:127]
v_accvgpr_read_b32 v30, a14
v_accvgpr_read_b32 v31, a15
M v[128:131], a[184:187], a[32:35], 0
v_cvt_pk_bf16_f32 v24, v24, v25
v_cvt_pk_bf16_f32 v25, v26, v27
M v[128:131], a[188:191], a[36:39], v[128:131]
ds_read_b128 a[168:171], v10 offset:18432
ds_read_b128 a[172:175], v11 offset:18432
ds_read_b64_tr_b16 a[108:109], v13 offset:49152
ds_read_b64_tr_b16 a[110:111], v13 offset:51200
v_cvt_pk_bf16_f32 v26, v28, v29
v_cvt_pk_bf16_f32 v27, v30, v31
M v[132:135], a[188:191], a[44:47], 0
M v[132:135], a[184:187], a[40:43], v[132:135]
M v[136:139], a[184:187], a[48:51], 0
M v[136:139], a[188:191], a[52:55], v[136:139]
s_add_u32 s94, s93, 12288
buffer_store_dwordx4 v[24:27], v1, s[16:19], s94 offen offset:1024 sc1
M v[140:143], a[188:191], a[60:63], 0
buffer_load_dwordx4 v4, s[8:11], s23 offen offset:2048 lds
M v[140:143], a[184:187], a[56:59], v[140:143]
ds_read_b64_tr_b16 a[116:117], v14 offset:49152
ds_read_b64_tr_b16 a[118:119], v14 offset:51200
M v[144:147], a[184:187], a[64:67], 0
M v[144:147], a[188:191], a[68:71], v[144:147]
M v[148:151], a[188:191], a[76:79], 0
M v[148:151], a[184:187], a[72:75], v[148:151]
M v[152:155], a[184:187], a[80:83], 0
buffer_load_dwordx4 v5, s[8:11], s23 offen offset:3072 lds
M v[152:155], a[188:191], a[84:87], v[152:155]
ds_read_b64_tr_b16 a[124:125], v15 offset:49152
ds_read_b64_tr_b16 a[126:127], v15 offset:51200
M v[156:159], a[188:191], a[92:95], 0
M v[156:159], a[184:187], a[88:91], v[156:159]
s_waitcnt lgkmcnt(10)
M v[160:163], a[160:163], a[32:35], 0
M v[160:163], a[164:167], a[36:39], v[160:163]
ds_read_b128 a[176:179], v10 offset:20480
ds_read_b128 a[180:183], v11 offset:20480
M v[164:167], a[164:167], a[44:47], 0
M v[164:167], a[160:163], a[40:43], v[164:167]
ds_read_b64_tr_b16 a[132:133], v16 offset:49152
ds_read_b64_tr_b16 a[134:135], v16 offset:51200
M v[168:171], a[160:163], a[48:51], 0
v_accvgpr_read_b32 v24, a16
v_accvgpr_read_b32 v25, a17
M v[168:171], a[164:167], a[52:55], v[168:171]
s_add_u32 m0, s29, 98304
s_nop 0
buffer_load_dwordx4 v6, s[12:15], s24 offen offset:0 lds
v_accvgpr_read_b32 v26, a18
v_accvgpr_read_b32 v27, a19
M v[172:175], a[164:167], a[60:63], 0
v_accvgpr_read_b32 v28, a20
v_accvgpr_read_b32 v29, a21
M v[172:175], a[160:163], a[56:59], v[172:175]
v_accvgpr_read_b32 v30, a22
v_accvgpr_read_b32 v31, a23
M v[176:179], a[160:163], a[64:67], 0
v_cvt_pk_bf16_f32 v24, v24, v25
v_cvt_pk_bf16_f32 v25, v26, v27
M v[176:179], a[164:167], a[68:71], v[176:179]
ds_read_b64_tr_b16 a[140:141], v17 offset:49152
ds_read_b64_tr_b16 a[142:143], v17 offset:51200
v_cvt_pk_bf16_f32 v26, v28, v29
v_cvt_pk_bf16_f32 v27, v30, v31
M v[180:183], a[164:167], a[76:79], 0
M v[180:183], a[160:163], a[72:75], v[180:183]
buffer_load_dwordx4 v7, s[12:15], s24 offen offset:1024 lds
M v[184:187], a[160:163], a[80:83], 0
M v[184:187], a[164:167], a[84:87], v[184:187]
s_add_u32 s94, s93, 12288
buffer_store_dwordx4 v[24:27], v1, s[16:19], s94 offen offset:2048 sc1
M v[188:191], a[164:167], a[92:95], 0
M v[188:191], a[160:163], a[88:91], v[188:191]
s_waitcnt lgkmcnt(12)
ds_read_b64_tr_b16 a[148:149], v18 offset:49152
ds_read_b64_tr_b16 a[150:151], v18 offset:51200
M v[192:195], a[168:171], a[32:35], 0
M v[192:195], a[172:175], a[36:39], v[192:195]
ds_read_b128 a[184:187], v10 offset:22528
ds_read_b128 a[188:191], v11 offset:22528
M v[196:199], a[172:175], a[44:47], 0
M v[196:199], a[168:171], a[40:43], v[196:199]
buffer_load_dwordx4 v8, s[12:15], s24 offen offset:2048 lds
M v[200:203], a[168:171], a[48:51], 0
M v[200:203], a[172:175], a[52:55], v[200:203]
ds_read_b64_tr_b16 a[156:157], v19 offset:49152
ds_read_b64_tr_b16 a[158:159], v19 offset:51200
M v[204:207], a[172:175], a[60:63], 0
M v[204:207], a[168:171], a[56:59], v[204:207]
M v[208:211], a[168:171], a[64:67], 0
M v[208:211], a[172:175], a[68:71], v[208:211]
buffer_load_dwordx4 v9, s[12:15], s24 offen offset:3072 lds
M v[212:215], a[172:175], a[76:79], 0
M v[212:215], a[168:171], a[72:75], v[212:215]
M v[216:219], a[168:171], a[80:83], 0
v_accvgpr_read_b32 v24, a24
v_accvgpr_read_b32 v25, a25
M v[216:219], a[172:175], a[84:87], v[216:219]
v_accvgpr_read_b32 v26, a26
v_accvgpr_read_b32 v27, a27
M v[220:223], a[172:175], a[92:95], 0
s_add_u32 s24, s24, 262144
v_accvgpr_read_b32 v28, a28
v_accvgpr_read_b32 v29, a29
M v[220:223], a[168:171], a[88:91], v[220:223]
s_waitcnt lgkmcnt(10)
v_accvgpr_read_b32 v30, a30
v_accvgpr_read_b32 v31, a31
M v[224:227], a[176:179], a[32:35], 0
v_cvt_pk_bf16_f32 v24, v24, v25
v_cvt_pk_bf16_f32 v25, v26, v27
M v[224:227], a[180:183], a[36:39], v[224:227]
v_cvt_pk_bf16_f32 v26, v28, v29
v_cvt_pk_bf16_f32 v27, v30, v31
M v[228:231], a[180:183], a[44:47], 0
M v[228:231], a[176:179], a[40:43], v[228:231]
M v[232:235], a[176:179], a[48:51], 0
M v[232:235], a[180:183], a[52:55], v[232:235]
s_add_u32 s94, s93, 12288
buffer_store_dwordx4 v[24:27], v1, s[16:19], s94 offen offset:3072 sc1
M v[236:239], a[180:183], a[60:63], 0
M v[236:239], a[176:179], a[56:59], v[236:239]
s_waitcnt vmcnt(26) lgkmcnt(0)
s_barrier
ds_read_b128 a[160:163], v10 offset:32768
ds_read_b128 a[164:167], v11 offset:32768
M v[240:243], a[176:179], a[64:67], 0
s_add_u32 m0, s29, 16384
s_add_u32 s3, s23, s31
buffer_load_dwordx4 v2, s[8:11], s3 offen offset:0 lds
M v[240:243], a[180:183], a[68:71], v[240:243]
M v[244:247], a[180:183], a[76:79], 0
M v[244:247], a[176:179], a[72:75], v[244:247]
M v[248:251], a[176:179], a[80:83], 0
M v[248:251], a[180:183], a[84:87], v[248:251]
buffer_load_dwordx4 v3, s[8:11], s3 offen offset:1024 lds
M v[252:255], a[180:183], a[92:95], 0
M v[252:255], a[176:179], a[88:91], v[252:255]
M a[0:3], a[184:187], a[32:35], 0
M a[0:3], a[188:191], a[36:39], a[0:3]
ds_read_b128 a[168:171], v10 offset:34816
ds_read_b128 a[172:175], v11 offset:34816
M a[4:7], a[188:191], a[44:47], 0
M a[4:7], a[184:187], a[40:43], a[4:7]
M a[8:11], a[184:187], a[48:51], 0
buffer_load_dwordx4 v4, s[8:11], s3 offen offset:2048 lds
M a[8:11], a[188:191], a[52:55], a[8:11]
M a[12:15], a[188:191], a[60:63], 0
M a[12:15], a[184:187], a[56:59], a[12:15]
M a[16:19], a[184:187], a[64:67], 0
M a[16:19], a[188:191], a[68:71], a[16:19]
buffer_load_dwordx4 v5, s[8:11], s3 offen offset:3072 lds
M a[20:23], a[188:191], a[76:79], 0
M a[20:23], a[184:187], a[72:75], a[20:23]
M a[24:27], a[184:187], a[80:83], 0
M a[24:27], a[188:191], a[84:87], a[24:27]
M a[28:31], a[188:191], a[92:95], 0
M a[28:31], a[184:187], a[88:91], a[28:31]
s_waitcnt lgkmcnt(2)
M v[32:35], a[160:163], a[96:99], v[32:35]
s_add_u32 s23, s23, 128
s_cmp_eq_u32 s23, s25
s_cselect_b32 s23, s26, s23
M v[32:35], a[164:167], a[100:103], v[32:35]
ds_read_b128 a[176:179], v10 offset:36864
ds_read_b128 a[180:183], v11 offset:36864
M v[36:39], a[164:167], a[108:111], v[36:39]
M v[36:39], a[160:163], a[104:107], v[36:39]
ds_read_b64_tr_b16 a[32:33], v12 offset:0
ds_read_b64_tr_b16 a[34:35], v12 offset:2048
M v[40:43], a[160:163], a[112:115], v[40:43]
M v[40:43], a[164:167], a[116:119], v[40:43]
M v[44:47], a[164:167], a[124:127], v[44:47]
s_add_u32 m0, s29, 114688
s_nop 0
buffer_load_dwordx4 v6, s[12:15], s24 offen offset:0 lds
M v[44:47], a[160:163], a[120:123], v[44:47]
ds_read_b64_tr_b16 a[40:41], v13 offset:0
ds_read_b64_tr_b16 a[42:43], v13 offset:2048
M v[48:51], a[160:163], a[128:131], v[48:51]
s_add_u32 s94, s92, 12288
buffer_store_dwordx4 a[192:195], v1, s[16:19], s94 offen offset:0 sc1
M v[48:51], a[164:167], a[132:135], v[48:51]
M v[52:55], a[164:167], a[140:143], v[52:55]
M v[52:55], a[160:163], a[136:139], v[52:55]
ds_read_b64_tr_b16 a[48:49], v14 offset:0
ds_read_b64_tr_b16 a[50:51], v14 offset:2048
M v[56:59], a[160:163], a[144:147], v[56:59]
M v[56:59], a[164:167], a[148:151], v[56:59]
buffer_load_dwordx4 v7, s[12:15], s24 offen offset:1024 lds
M v[60:63], a[164:167], a[156:159], v[60:63]
M v[60:63], a[160:163], a[152:155], v[60:63]
s_waitcnt lgkmcnt(8)
ds_read_b64_tr_b16 a[56:57], v15 offset:0
ds_read_b64_tr_b16 a[58:59], v15 offset:2048
M v[64:67], a[168:171], a[96:99], v[64:67]
M v[64:67], a[172:175], a[100:103], v[64:67]
ds_read_b128 a[184:187], v10 offset:38912
ds_read_b128 a[188:191], v11 offset:38912
M v[68:71], a[172:175], a[108:111], v[68:71]
M v[68:71], a[168:171], a[104:107], v[68:71]
ds_read_b64_tr_b16 a[64:65], v16 offset:0
ds_read_b64_tr_b16 a[66:67], v16 offset:2048
M v[72:75], a[168:171], a[112:115], v[72:75]
buffer_load_dwordx4 v8, s[12:15], s24 offen offset:2048 lds
M v[72:75], a[172:175], a[116:119], v[72:75]
M v[76:79], a[172:175], a[124:127], v[76:79]
M v[76:79], a[168:171], a[120:123], v[76:79]
ds_read_b64_tr_b16 a[72:73], v17 offset:0
ds_read_b64_tr_b16 a[74:75], v17 offset:2048
M v[80:83], a[168:171], a[128:131], v[80:83]
M v[80:83], a[172:175], a[132:135], v[80:83]
buffer_load_dwordx4 v9, s[12:15], s24 offen offset:3072 lds
M v[84:87], a[172:175], a[140:143], v[84:87]
M v[84:87], a[168:171], a[136:139], v[84:87]
ds_read_b64_tr_b16 a[80:81], v18 offset:0
ds_read_b64_tr_b16 a[82:83], v18 offset:2048
M v[88:91], a[168:171], a[144:147], v[88:91]
M v[88:91], a[172:175], a[148:151], v[88:91]
M v[92:95], a[172:175], a[156:159], v[92:95]
s_add_u32 s24, s24, 262144
s_cmp_eq_u32 s24, s27
s_cselect_b32 s24, s28, s24
s_sub_u32 s6, s6, 1
s_cmp_eq_u32 s6, 0
s_cselect_b64 s[12:13], s[64:65], s[12:13]
M v[92:95], a[168:171], a[152:155], v[92:95]
s_waitcnt lgkmcnt(15)
ds_read_b64_tr_b16 a[88:89], v19 offset:0
ds_read_b64_tr_b16 a[90:91], v19 offset:2048
M v[96:99], a[176:179], a[96:99], v[96:99]
M v[96:99], a[180:183], a[100:103], v[96:99]
M v[100:103], a[180:183], a[108:111], v[100:103]
M v[100:103], a[176:179], a[104:107], v[100:103]
M v[104:107], a[176:179], a[112:115], v[104:107]
s_add_u32 s94, s92, 12288
buffer_store_dwordx4 a[196:199], v1, s[16:19], s94 offen offset:1024 sc1
M v[104:107], a[180:183], a[116:119], v[104:107]
M v[108:111], a[180:183], a[124:127], v[108:111]
M v[108:111], a[176:179], a[120:123], v[108:111]
s_waitcnt vmcnt(22) lgkmcnt(0)
s_barrier
ds_read_b128 a[160:163], v10 offset:49152
ds_read_b128 a[164:167], v11 offset:49152
M v[112:115], a[176:179], a[128:131], v[112:115]
s_add_u32 m0, s29, 32768
s_nop 0
buffer_load_dwordx4 v2, s[8:11], s23 offen offset:0 lds
M v[112:115], a[180:183], a[132:135], v[112:115]
M v[116:119], a[180:183], a[140:143], v[116:119]
M v[116:119], a[176:179], a[136:139], v[116:119]
ds_read_b64_tr_b16 a[36:37], v12 offset:16384
ds_read_b64_tr_b16 a[38:39], v12 offset:18432
M v[120:123], a[176:179], a[144:147], v[120:123]
M v[120:123], a[180:183], a[148:151], v[120:123]
M v[124:127], a[180:183], a[156:159], v[124:127]
buffer_load_dwordx4 v3, s[8:11], s23 offen offset:1024 lds
M v[124:127], a[176:179], a[152:155], v[124:127]
M v[128:131], a[184:187], a[96:99], v[128:131]
M v[128:131], a[188:191], a[100:103], v[128:131]
ds_read_b128 a[168:171], v10 offset:51200
ds_read_b128 a[172:175], v11 offset:51200
ds_read_b64_tr_b16 a[44:45], v13 offset:16384
ds_read_b64_tr_b16 a[46:47], v13 offset:18432
M v[132:135], a[188:191], a[108:111], v[132:135]
M v[132:135], a[184:187], a[104:107], v[132:135]
M v[136:139], a[184:187], a[112:115], v[136:139]
M v[136:139], a[188:191], a[116:119], v[136:139]
buffer_load_dwordx4 v4, s[8:11], s23 offen offset:2048 lds
M v[140:143], a[188:191], a[124:127], v[140:143]
M v[140:143], a[184:187], a[120:123], v[140:143]
ds_read_b64_tr_b16 a[52:53], v14 offset:16384
ds_read_b64_tr_b16 a[54:55], v14 offset:18432
M v[144:147], a[184:187], a[128:131], v[144:147]
M v[144:147], a[188:191], a[132:135], v[144:147]
M v[148:151], a[188:191], a[140:143], v[148:151]
M v[148:151], a[184:187], a[136:139], v[148:151]
buffer_load_dwordx4 v5, s[8:11], s23 offen offset:3072 lds
M v[152:155], a[184:187], a[144:147], v[152:155]
M v[152:155], a[188:191], a[148:151], v[152:155]
ds_read_b64_tr_b16 a[60:61], v15 offset:16384
ds_read_b64_tr_b16 a[62:63], v15 offset:18432
M v[156:159], a[188:191], a[156:159], v[156:159]
M v[156:159], a[184:187], a[152:155], v[156:159]
s_waitcnt lgkmcnt(10)
M v[160:163], a[160:163], a[96:99], v[160:163]
s_add_u32 s94, s92, 12288
buffer_store_dwordx4 a[200:203], v1, s[16:19], s94 offen offset:2048 sc1
M v[160:163], a[164:167], a[100:103], v[160:163]
ds_read_b128 a[176:179], v10 offset:53248
ds_read_b128 a[180:183], v11 offset:53248
M v[164:167], a[164:167], a[108:111], v[164:167]
M v[164:167], a[160:163], a[104:107], v[164:167]
ds_read_b64_tr_b16 a[68:69], v16 offset:16384
ds_read_b64_tr_b16 a[70:71], v16 offset:18432
M v[168:171], a[160:163], a[112:115], v[168:171]
M v[168:171], a[164:167], a[116:119], v[168:171]
s_add_u32 m0, s29, 65536
s_nop 0
buffer_load_dwordx4 v6, s[12:15], s24 offen offset:0 lds
M v[172:175], a[164:167], a[124:127], v[172:175]
M v[172:175], a[160:163], a[120:123], v[172:175]
M v[176:179], a[160:163], a[128:131], v[176:179]
M v[176:179], a[164:167], a[132:135], v[176:179]
ds_read_b64_tr_b16 a[76:77], v17 offset:16384
ds_read_b64_tr_b16 a[78:79], v17 offset:18432
M v[180:183], a[164:167], a[140:143], v[180:183]
M v[180:183], a[160:163], a[136:139], v[180:183]
buffer_load_dwordx4 v7, s[12:15], s24 offen offset:1024 lds
M v[184:187], a[160:163], a[144:147], v[184:187]
M v[184:187], a[164:167], a[148:151], v[184:187]
M v[188:191], a[164:167], a[156:159], v[188:191]
M v[188:191], a[160:163], a[152:155], v[188:191]
s_waitcnt lgkmcnt(12)
ds_read_b64_tr_b16 a[84:85], v18 offset:16384
ds_read_b64_tr_b16 a[86:87], v18 offset:18432
M v[192:195], a[168:171], a[96:99], v[192:195]
M v[192:195], a[172:175], a[100:103], v[192:195]
ds_read_b128 a[184:187], v10 offset:55296
ds_read_b128 a[188:191], v11 offset:55296
M v[196:199], a[172:175], a[108:111], v[196:199]
buffer_load_dwordx4 v8, s[12:15], s24 offen offset:2048 lds
M v[196:199], a[168:171], a[104:107], v[196:199]
M v[200:203], a[168:171], a[112:115], v[200:203]
M v[200:203], a[172:175], a[116:119], v[200:203]
ds_read_b64_tr_b16 a[92:93], v19 offset:16384
ds_read_b64_tr_b16 a[94:95], v19 offset:18432
M v[204:207], a[172:175], a[124:127], v[204:207]
M v[204:207], a[168:171], a[120:123], v[204:207]
M v[208:211], a[168:171], a[128:131], v[208:211]
buffer_load_dwordx4 v9, s[12:15], s24 offen offset:3072 lds
M v[208:211], a[172:175], a[132:135], v[208:211]
M v[212:215], a[172:175], a[140:143], v[212:215]
M v[212:215], a[168:171], a[136:139], v[212:215]
M v[216:219], a[168:171], a[144:147], v[216:219]
s_add_u32 s94, s92, 12288
buffer_store_dwordx4 a[204:207], v1, s[16:19], s94 offen offset:3072 sc1
M v[216:219], a[172:175], a[148:151], v[216:219]
M v[220:223], a[172:175], a[156:159], v[220:223]
s_add_u32 s24, s24, 262144
M v[220:223], a[168:171], a[152:155], v[220:223]
s_waitcnt lgkmcnt(10)
M v[224:227], a[176:179], a[96:99], v[224:227]
M v[224:227], a[180:183], a[100:103], v[224:227]
M v[228:231], a[180:183], a[108:111], v[228:231]
M v[228:231], a[176:179], a[104:107], v[228:231]
M v[232:235], a[176:179], a[112:115], v[232:235]
M v[232:235], a[180:183], a[116:119], v[232:235]
M v[236:239], a[180:183], a[124:127], v[236:239]
M v[236:239], a[176:179], a[120:123], v[236:239]
s_waitcnt vmcnt(21) lgkmcnt(0)
s_barrier
ds_read_b128 a[160:163], v10 offset:0
ds_read_b128 a[164:167], v11 offset:0
M v[240:243], a[176:179], a[128:131], v[240:243]
s_add_u32 m0, s29, 49152
s_add_u32 s3, s23, s31
buffer_load_dwordx4 v2, s[8:11], s3 offen offset:0 lds
M v[240:243], a[180:183], a[132:135], v[240:243]
M v[244:247], a[180:183], a[140:143], v[244:247]
M v[244:247], a[176:179], a[136:139], v[244:247]
M v[248:251], a[176:179], a[144:147], v[248:251]
M v[248:251], a[180:183], a[148:151], v[248:251]
buffer_load_dwordx4 v3, s[8:11], s3 offen offset:1024 lds
M v[252:255], a[180:183], a[156:159], v[252:255]
M v[252:255], a[176:179], a[152:155], v[252:255]
M a[0:3], a[184:187], a[96:99], a[0:3]
M a[0:3], a[188:191], a[100:103], a[0:3]
ds_read_b128 a[168:171], v10 offset:2048
ds_read_b128 a[172:175], v11 offset:2048
M a[4:7], a[188:191], a[108:111], a[4:7]
M a[4:7], a[184:187], a[104:107], a[4:7]
M a[8:11], a[184:187], a[112:115], a[8:11]
buffer_load_dwordx4 v4, s[8:11], s3 offen offset:2048 lds
M a[8:11], a[188:191], a[116:119], a[8:11]
M a[12:15], a[188:191], a[124:127], a[12:15]
M a[12:15], a[184:187], a[120:123], a[12:15]
M a[16:19], a[184:187], a[128:131], a[16:19]
M a[16:19], a[188:191], a[132:135], a[16:19]
buffer_load_dwordx4 v5, s[8:11], s3 offen offset:3072 lds
M a[20:23], a[188:191], a[140:143], a[20:23]
M a[20:23], a[184:187], a[136:139], a[20:23]
M a[24:27], a[184:187], a[144:147], a[24:27]
M a[24:27], a[188:191], a[148:151], a[24:27]
M a[28:31], a[188:191], a[156:159], a[28:31]
M a[28:31], a[184:187], a[152:155], a[28:31]
s_waitcnt lgkmcnt(2)
M v[32:35], a[160:163], a[32:35], v[32:35]
s_add_u32 s23, s23, 128
s_cmp_eq_u32 s23, s25
s_cselect_b32 s23, s26, s23
M v[32:35], a[164:167], a[36:39], v[32:35]
ds_read_b128 a[176:179], v10 offset:4096
ds_read_b128 a[180:183], v11 offset:4096
M v[36:39], a[164:167], a[44:47], v[36:39]
M v[36:39], a[160:163], a[40:43], v[36:39]
ds_read_b64_tr_b16 a[96:97], v12 offset:32768
ds_read_b64_tr_b16 a[98:99], v12 offset:34816
M v[40:43], a[160:163], a[48:51], v[40:43]
M v[40:43], a[164:167], a[52:55], v[40:43]
M v[44:47], a[164:167], a[60:63], v[44:47]
s_add_u32 m0, s29, 81920
s_nop 0
buffer_load_dwordx4 v6, s[12:15], s24 offen offset:0 lds
M v[44:47], a[160:163], a[56:59], v[44:47]
ds_read_b64_tr_b16 a[104:105], v13 offset:32768
ds_read_b64_tr_b16 a[106:107], v13 offset:34816
M v[48:51], a[160:163], a[64:67], v[48:51]
s_add_u32 s94, s93, 0
buffer_store_dwordx4 a[208:211], v1, s[16:19], s94 offen offset:0 sc1
M v[48:51], a[164:167], a[68:71], v[48:51]
M v[52:55], a[164:167], a[76:79], v[52:55]
M v[52:55], a[160:163], a[72:75], v[52:55]
ds_read_b64_tr_b16 a[112:113], v14 offset:32768
ds_read_b64_tr_b16 a[114:115], v14 offset:34816
M v[56:59], a[160:163], a[80:83], v[56:59]
M v[56:59], a[164:167], a[84:87], v[56:59]
buffer_load_dwordx4 v7, s[12:15], s24 offen offset:1024 lds
M v[60:63], a[164:167], a[92:95], v[60:63]
M v[60:63], a[160:163], a[88:91], v[60:63]
s_waitcnt lgkmcnt(8)
ds_read_b64_tr_b16 a[120:121], v15 offset:32768
ds_read_b64_tr_b16 a[122:123], v15 offset:34816
M v[64:67], a[168:171], a[32:35], v[64:67]
M v[64:67], a[172:175], a[36:39], v[64:67]
ds_read_b128 a[184:187], v10 offset:6144
ds_read_b128 a[188:191], v11 offset:6144
M v[68:71], a[172:175], a[44:47], v[68:71]
M v[68:71], a[168:171], a[40:43], v[68:71]
ds_read_b64_tr_b16 a[128:129], v16 offset:32768
ds_read_b64_tr_b16 a[130:131], v16 offset:34816
M v[72:75], a[168:171], a[48:51], v[72:75]
buffer_load_dwordx4 v8, s[12:15], s24 offen offset:2048 lds
M v[72:75], a[172:175], a[52:55], v[72:75]
M v[76:79], a[172:175], a[60:63], v[76:79]
M v[76:79], a[168:171], a[56:59], v[76:79]
ds_read_b64_tr_b16 a[136:137], v17 offset:32768
ds_read_b64_tr_b16 a[138:139], v17 offset:34816
M v[80:83], a[168:171], a[64:67], v[80:83]
M v[80:83], a[172:175], a[68:71], v[80:83]
buffer_load_dwordx4 v9, s[12:15], s24 offen offset:3072 lds
M v[84:87], a[172:175], a[76:79], v[84:87]
M v[84:87], a[168:171], a[72:75], v[84:87]
ds_read_b64_tr_b16 a[144:145], v18 offset:32768
ds_read_b64_tr_b16 a[146:147], v18 offset:34816
M v[88:91], a[168:171], a[80:83], v[88:91]
M v[88:91], a[172:175], a[84:87], v[88:91]
M v[92:95], a[172:175], a[92:95], v[92:95]
s_add_u32 s24, s24, 262144
s_cmp_eq_u32 s24, s27
s_cselect_b32 s24, s28, s24
s_sub_u32 s6, s6, 1
s_cmp_eq_u32 s6, 0
s_cselect_b64 s[12:13], s[64:65], s[12:13]
M v[92:95], a[168:171], a[88:91], v[92:95]
s_waitcnt lgkmcnt(15)
ds_read_b64_tr_b16 a[152:153], v19 offset:32768
ds_read_b64_tr_b16 a[154:155], v19 offset:34816
M v[96:99], a[176:179], a[32:35], v[96:99]
M v[96:99], a[180:183], a[36:39], v[96:99]
M v[100:103], a[180:183], a[44:47], v[100:103]
M v[100:103], a[176:179], a[40:43], v[100:103]
M v[104:107], a[176:179], a[48:51], v[104:107]
s_add_u32 s94, s93, 0
buffer_store_dwordx4 a[212:215], v1, s[16:19], s94 offen offset:1024 sc1
M v[104:107], a[180:183], a[52:55], v[104:107]
M v[108:111], a[180:183], a[60:63], v[108:111]
M v[108:111], a[176:179], a[56:59], v[108:111]
s_waitcnt vmcnt(21) lgkmcnt(0)
s_barrier
ds_read_b128 a[160:163], v10 offset:16384
ds_read_b128 a[164:167], v11 offset:16384
M v[112:115], a[176:179], a[64:67], v[112:115]
s_add_u32 m0, s29, 0
s_nop 0
buffer_load_dwordx4 v2, s[8:11], s23 offen offset:0 lds
M v[112:115], a[180:183], a[68:71], v[112:115]
M v[116:119], a[180:183], a[76:79], v[116:119]
M v[116:119], a[176:179], a[72:75], v[116:119]
ds_read_b64_tr_b16 a[100:101], v12 offset:49152
ds_read_b64_tr_b16 a[102:103], v12 offset:51200
M v[120:123], a[176:179], a[80:83], v[120:123]
M v[120:123], a[180:183], a[84:87], v[120:123]
M v[124:127], a[180:183], a[92:95], v[124:127]
buffer_load_dwordx4 v3, s[8:11], s23 offen offset:1024 lds
M v[124:127], a[176:179], a[88:91], v[124:127]
M v[128:131], a[184:187], a[32:35], v[128:131]
M v[128:131], a[188:191], a[36:39], v[128:131]
ds_read_b128 a[168:171], v10 offset:18432
ds_read_b128 a[172:175], v11 offset:18432
ds_read_b64_tr_b16 a[108:109], v13 offset:49152
ds_read_b64_tr_b16 a[110:111], v13 offset:51200
M v[132:135], a[188:191], a[44:47], v[132:135]
M v[132:135], a[184:187], a[40:43], v[132:135]
M v[136:139], a[184:187], a[48:51], v[136:139]
M v[136:139], a[188:191], a[52:55], v[136:139]
buffer_load_dwordx4 v4, s[8:11], s23 offen offset:2048 lds
M v[140:143], a[188:191], a[60:63], v[140:143]
M v[140:143], a[184:187], a[56:59], v[140:143]
ds_read_b64_tr_b16 a[116:117], v14 offset:49152
ds_read_b64_tr_b16 a[118:119], v14 offset:51200
M v[144:147], a[184:187], a[64:67], v[144:147]
M v[144:147], a[188:191], a[68:71], v[144:147]
M v[148:151], a[188:191], a[76:79], v[148:151]
M v[148:151], a[184:187], a[72:75], v[148:151]
buffer_load_dwordx4 v5, s[8:11], s23 offen offset:3072 lds
M v[152:155], a[184:187], a[80:83], v[152:155]
M v[152:155], a[188:191], a[84:87], v[152:155]
ds_read_b64_tr_b16 a[124:125], v15 offset:49152
ds_read_b64_tr_b16 a[126:127], v15 offset:51200
M v[156:159], a[188:191], a[92:95], v[156:159]
M v[156:159], a[184:187], a[88:91], v[156:159]
s_waitcnt lgkmcnt(10)
M v[160:163], a[160:163], a[32:35], v[160:163]
s_add_u32 s94, s93, 0
buffer_store_dwordx4 a[216:219], v1, s[16:19], s94 offen offset:2048 sc1
M v[160:163], a[164:167], a[36:39], v[160:163]
ds_read_b128 a[176:179], v10 offset:20480
ds_read_b128 a[180:183], v11 offset:20480
M v[164:167], a[164:167], a[44:47], v[164:167]
M v[164:167], a[160:163], a[40:43], v[164:167]
ds_read_b64_tr_b16 a[132:133], v16 offset:49152
ds_read_b64_tr_b16 a[134:135], v16 offset:51200
M v[168:171], a[160:163], a[48:51], v[168:171]
M v[168:171], a[164:167], a[52:55], v[168:171]
s_add_u32 m0, s29, 98304
s_nop 0
buffer_load_dwordx4 v6, s[12:15], s24 offen offset:0 lds
M v[172:175], a[164:167], a[60:63], v[172:175]
M v[172:175], a[160:163], a[56:59], v[172:175]
M v[176:179], a[160:163], a[64:67], v[176:179]
M v[176:179], a[164:167], a[68:71], v[176:179]
ds_read_b64_tr_b16 a[140:141], v17 offset:49152
ds_read_b64_tr_b16 a[142:143], v17 offset:51200
M v[180:183], a[164:167], a[76:79], v[180:183]
M v[180:183], a[160:163], a[72:75], v[180:183]
buffer_load_dwordx4 v7, s[12:15], s24 offen offset:1024 lds
M v[184:187], a[160:163], a[80:83], v[184:187]
M v[184:187], a[164:167], a[84:87], v[184:187]
M v[188:191], a[164:167], a[92:95], v[188:191]
M v[188:191], a[160:163], a[88:91], v[188:191]
s_waitcnt lgkmcnt(12)
ds_read_b64_tr_b16 a[148:149], v18 offset:49152
ds_read_b64_tr_b16 a[150:151], v18 offset:51200
M v[192:195], a[168:171], a[32:35], v[192:195]
M v[192:195], a[172:175], a[36:39], v[192:195]
ds_read_b128 a[184:187], v10 offset:22528
ds_read_b128 a[188:191], v11 offset:22528
M v[196:199], a[172:175], a[44:47], v[196:199]
buffer_load_dwordx4 v8, s[12:15], s24 offen offset:2048 lds
M v[196:199], a[168:171], a[40:43], v[196:199]
M v[200:203], a[168:171], a[48:51], v[200:203]
M v[200:203], a[172:175], a[52:55], v[200:203]
ds_read_b64_tr_b16 a[156:157], v19 offset:49152
ds_read_b64_tr_b16 a[158:159], v19 offset:51200
M v[204:207], a[172:175], a[60:63], v[204:207]
M v[204:207], a[168:171], a[56:59], v[204:207]
M v[208:211], a[168:171], a[64:67], v[208:211]
buffer_load_dwordx4 v9, s[12:15], s24 offen offset:3072 lds
M v[208:211], a[172:175], a[68:71], v[208:211]
M v[212:215], a[172:175], a[76:79], v[212:215]
M v[212:215], a[168:171], a[72:75], v[212:215]
M v[216:219], a[168:171], a[80:83], v[216:219]
s_add_u32 s94, s93, 0
buffer_store_dwordx4 a[220:223], v1, s[16:19], s94 offen offset:3072 sc1
M v[216:219], a[172:175], a[84:87], v[216:219]
M v[220:223], a[172:175], a[92:95], v[220:223]
s_add_u32 s24, s24, 262144
M v[220:223], a[168:171], a[88:91], v[220:223]
s_waitcnt lgkmcnt(10)
M v[224:227], a[176:179], a[32:35], v[224:227]
M v[224:227], a[180:183], a[36:39], v[224:227]
M v[228:231], a[180:183], a[44:47], v[228:231]
M v[228:231], a[176:179], a[40:43], v[228:231]
M v[232:235], a[176:179], a[48:51], v[232:235]
M v[232:235], a[180:183], a[52:55], v[232:235]
M v[236:239], a[180:183], a[60:63], v[236:239]
M v[236:239], a[176:179], a[56:59], v[236:239]
s_waitcnt vmcnt(21) lgkmcnt(0)
s_barrier
ds_read_b128 a[160:163], v10 offset:32768
ds_read_b128 a[164:167], v11 offset:32768
M v[240:243], a[176:179], a[64:67], v[240:243]
s_add_u32 m0, s29, 16384
s_add_u32 s3, s23, s31
buffer_load_dwordx4 v2, s[8:11], s3 offen offset:0 lds
M v[240:243], a[180:183], a[68:71], v[240:243]
M v[244:247], a[180:183], a[76:79], v[244:247]
M v[244:247], a[176:179], a[72:75], v[244:247]
M v[248:251], a[176:179], a[80:83], v[248:251]
M v[248:251], a[180:183], a[84:87], v[248:251]
buffer_load_dwordx4 v3, s[8:11], s3 offen offset:1024 lds
M v[252:255], a[180:183], a[92:95], v[252:255]
M v[252:255], a[176:179], a[88:91], v[252:255]
M a[0:3], a[184:187], a[32:35], a[0:3]
M a[0:3], a[188:191], a[36:39], a[0:3]
ds_read_b128 a[168:171], v10 offset:34816
ds_read_b128 a[172:175], v11 offset:34816
M a[4:7], a[188:191], a[44:47], a[4:7]
M a[4:7], a[184:187], a[40:43], a[4:7]
M a[8:11], a[184:187], a[48:51], a[8:11]
buffer_load_dwordx4 v4, s[8:11], s3 offen offset:2048 lds
M a[8:11], a[188:191], a[52:55], a[8:11]
M a[12:15], a[188:191], a[60:63], a[12:15]
M a[12:15], a[184:187], a[56:59], a[12:15]
M a[16:19], a[184:187], a[64:67], a[16:19]
M a[16:19], a[188:191], a[68:71], a[16:19]
buffer_load_dwordx4 v5, s[8:11], s3 offen offset:3072 lds
M a[20:23], a[188:191], a[76:79], a[20:23]
M a[20:23], a[184:187], a[72:75], a[20:23]
M a[24:27], a[184:187], a[80:83], a[24:27]
M a[24:27], a[188:191], a[84:87], a[24:27]
M a[28:31], a[188:191], a[92:95], a[28:31]
M a[28:31], a[184:187], a[88:91], a[28:31]
s_waitcnt lgkmcnt(2)
M v[32:35], a[160:163], a[96:99], v[32:35]
s_add_u32 s23, s23, 128
s_cmp_eq_u32 s23, s25
s_cselect_b32 s23, s26, s23
M v[32:35], a[164:167], a[100:103], v[32:35]
ds_read_b128 a[176:179], v10 offset:36864
ds_read_b128 a[180:183], v11 offset:36864
M v[36:39], a[164:167], a[108:111], v[36:39]
M v[36:39], a[160:163], a[104:107], v[36:39]
ds_read_b64_tr_b16 a[32:33], v12 offset:0
ds_read_b64_tr_b16 a[34:35], v12 offset:2048
M v[40:43], a[160:163], a[112:115], v[40:43]
M v[40:43], a[164:167], a[116:119], v[40:43]
M v[44:47], a[164:167], a[124:127], v[44:47]
s_add_u32 m0, s29, 114688
s_nop 0
buffer_load_dwordx4 v6, s[12:15], s24 offen offset:0 lds
M v[44:47], a[160:163], a[120:123], v[44:47]
ds_read_b64_tr_b16 a[40:41], v13 offset:0
ds_read_b64_tr_b16 a[42:43], v13 offset:2048
M v[48:51], a[160:163], a[128:131], v[48:51]
s_add_u32 s94, s93, 4096
buffer_store_dwordx4 a[224:227], v1, s[16:19], s94 offen offset:0 sc1
M v[48:51], a[164:167], a[132:135], v[48:51]
M v[52:55], a[164:167], a[140:143], v[52:55]
M v[52:55], a[160:163], a[136:139], v[52:55]
ds_read_b64_tr_b16 a[48:49], v14 offset:0
ds_read_b64_tr_b16 a[50:51], v14 offset:2048
M v[56:59], a[160:163], a[144:147], v[56:59]
M v[56:59], a[164:167], a[148:151], v[56:59]
buffer_load_dwordx4 v7, s[12:15], s24 offen offset:1024 lds
M v[60:63], a[164:167], a[156:159], v[60:63]
M v[60:63], a[160:163], a[152:155], v[60:63]
s_waitcnt lgkmcnt(8)
ds_read_b64_tr_b16 a[56:57], v15 offset:0
ds_read_b64_tr_b16 a[58:59], v15 offset:2048
M v[64:67], a[168:171], a[96:99], v[64:67]
M v[64:67], a[172:175], a[100:103], v[64:67]
ds_read_b128 a[184:187], v10 offset:38912
ds_read_b128 a[188:191], v11 offset:38912
M v[68:71], a[172:175], a[108:111], v[68:71]
M v[68:71], a[168:171], a[104:107], v[68:71]
ds_read_b64_tr_b16 a[64:65], v16 offset:0
ds_read_b64_tr_b16 a[66:67], v16 offset:2048
M v[72:75], a[168:171], a[112:115], v[72:75]
buffer_load_dwordx4 v8, s[12:15], s24 offen offset:2048 lds
M v[72:75], a[172:175], a[116:119], v[72:75]
M v[76:79], a[172:175], a[124:127], v[76:79]
M v[76:79], a[168:171], a[120:123], v[76:79]
ds_read_b64_tr_b16 a[72:73], v17 offset:0
ds_read_b64_tr_b16 a[74:75], v17 offset:2048
M v[80:83], a[168:171], a[128:131], v[80:83]
M v[80:83], a[172:175], a[132:135], v[80:83]
buffer_load_dwordx4 v9, s[12:15], s24 offen offset:3072 lds
M v[84:87], a[172:175], a[140:143], v[84:87]
M v[84:87], a[168:171], a[136:139], v[84:87]
ds_read_b64_tr_b16 a[80:81], v18 offset:0
ds_read_b64_tr_b16 a[82:83], v18 offset:2048
M v[88:91], a[168:171], a[144:147], v[88:91]
M v[88:91], a[172:175], a[148:151], v[88:91]
M v[92:95], a[172:175], a[156:159], v[92:95]
s_add_u32 s24, s24, 262144
s_cmp_eq_u32 s24, s27
s_cselect_b32 s24, s28, s24
s_sub_u32 s6, s6, 1
s_cmp_eq_u32 s6, 0
s_cselect_b64 s[12:13], s[64:65], s[12:13]
M v[92:95], a[168:171], a[152:155], v[92:95]
s_waitcnt lgkmcnt(15)
ds_read_b64_tr_b16 a[88:89], v19 offset:0
ds_read_b64_tr_b16 a[90:91], v19 offset:2048
M v[96:99], a[176:179], a[96:99], v[96:99]
M v[96:99], a[180:183], a[100:103], v[96:99]
M v[100:103], a[180:183], a[108:111], v[100:103]
M v[100:103], a[176:179], a[104:107], v[100:103]
M v[104:107], a[176:179], a[112:115], v[104:107]
s_add_u32 s94, s93, 4096
buffer_store_dwordx4 a[228:231], v1, s[16:19], s94 offen offset:1024 sc1
M v[104:107], a[180:183], a[116:119], v[104:107]
M v[108:111], a[180:183], a[124:127], v[108:111]
M v[108:111], a[176:179], a[120:123], v[108:111]
s_waitcnt vmcnt(21) lgkmcnt(0)
s_barrier
ds_read_b128 a[160:163], v10 offset:49152
ds_read_b128 a[164:167], v11 offset:49152
M v[112:115], a[176:179], a[128:131], v[112:115]
s_add_u32 m0, s29, 32768
s_nop 0
buffer_load_dwordx4 v2, s[8:11], s23 offen offset:0 lds
M v[112:115], a[180:183], a[132:135], v[112:115]
M v[116:119], a[180:183], a[140:143], v[116:119]
M v[116:119], a[176:179], a[136:139], v[116:119]
ds_read_b64_tr_b16 a[36:37], v12 offset:16384
ds_read_b64_tr_b16 a[38:39], v12 offset:18432
M v[120:123], a[176:179], a[144:147], v[120:123]
M v[120:123], a[180:183], a[148:151], v[120:123]
M v[124:127], a[180:183], a[156:159], v[124:127]
buffer_load_dwordx4 v3, s[8:11], s23 offen offset:1024 lds
M v[124:127], a[176:179], a[152:155], v[124:127]
M v[128:131], a[184:187], a[96:99], v[128:131]
M v[128:131], a[188:191], a[100:103], v[128:131]
ds_read_b128 a[168:171], v10 offset:51200
ds_read_b128 a[172:175], v11 offset:51200
ds_read_b64_tr_b16 a[44:45], v13 offset:16384
ds_read_b64_tr_b16 a[46:47], v13 offset:18432
M v[132:135], a[188:191], a[108:111], v[132:135]
M v[132:135], a[184:187], a[104:107], v[132:135]
M v[136:139], a[184:187], a[112:115], v[136:139]
M v[136:139], a[188:191], a[116:119], v[136:139]
buffer_load_dwordx4 v4, s[8:11], s23 offen offset:2048 lds
M v[140:143], a[188:191], a[124:127], v[140:143]
M v[140:143], a[184:187], a[120:123], v[140:143]
ds_read_b64_tr_b16 a[52:53], v14 offset:16384
ds_read_b64_tr_b16 a[54:55], v14 offset:18432
M v[144:147], a[184:187], a[128:131], v[144:147]
M v[144:147], a[188:191], a[132:135], v[144:147]
M v[148:151], a[188:191], a[140:143], v[148:151]
M v[148:151], a[184:187], a[136:139], v[148:151]
buffer_load_dwordx4 v5, s[8:11], s23 offen offset:3072 lds
M v[152:155], a[184:187], a[144:147], v[152:155]
M v[152:155], a[188:191], a[148:151], v[152:155]
ds_read_b64_tr_b16 a[60:61], v15 offset:16384
ds_read_b64_tr_b16 a[62:63], v15 offset:18432
M v[156:159], a[188:191], a[156:159], v[156:159]
M v[156:159], a[184:187], a[152:155], v[156:159]
s_waitcnt lgkmcnt(10)
M v[160:163], a[160:163], a[96:99], v[160:163]
s_add_u32 s94, s93, 4096
buffer_store_dwordx4 a[232:235], v1, s[16:19], s94 offen offset:2048 sc1
M v[160:163], a[164:167], a[100:103], v[160:163]
ds_read_b128 a[176:179], v10 offset:53248
ds_read_b128 a[180:183], v11 offset:53248
M v[164:167], a[164:167], a[108:111], v[164:167]
M v[164:167], a[160:163], a[104:107], v[164:167]
ds_read_b64_tr_b16 a[68:69], v16 offset:16384
ds_read_b64_tr_b16 a[70:71], v16 offset:18432
M v[168:171], a[160:163], a[112:115], v[168:171]
M v[168:171], a[164:167], a[116:119], v[168:171]
s_add_u32 m0, s29, 65536
s_nop 0
buffer_load_dwordx4 v6, s[12:15], s24 offen offset:0 lds
M v[172:175], a[164:167], a[124:127], v[172:175]
M v[172:175], a[160:163], a[120:123], v[172:175]
M v[176:179], a[160:163], a[128:131], v[176:179]
M v[176:179], a[164:167], a[132:135], v[176:179]
ds_read_b64_tr_b16 a[76:77], v17 offset:16384
ds_read_b64_tr_b16 a[78:79], v17 offset:18432
M v[180:183], a[164:167], a[140:143], v[180:183]
M v[180:183], a[160:163], a[136:139], v[180:183]
buffer_load_dwordx4 v7, s[12:15], s24 offen offset:1024 lds
M v[184:187], a[160:163], a[144:147], v[184:187]
M v[184:187], a[164:167], a[148:151], v[184:187]
M v[188:191], a[164:167], a[156:159], v[188:191]
M v[188:191], a[160:163], a[152:155], v[188:191]
s_waitcnt lgkmcnt(12)
ds_read_b64_tr_b16 a[84:85], v18 offset:16384
ds_read_b64_tr_b16 a[86:87], v18 offset:18432
M v[192:195], a[168:171], a[96:99], v[192:195]
M v[192:195], a[172:175], a[100:103], v[192:195]
ds_read_b128 a[184:187], v10 offset:55296
ds_read_b128 a[188:191], v11 offset:55296
M v[196:199], a[172:175], a[108:111], v[196:199]
buffer_load_dwordx4 v8, s[12:15], s24 offen offset:2048 lds
M v[196:199], a[168:171], a[104:107], v[196:199]
M v[200:203], a[168:171], a[112:115], v[200:203]
M v[200:203], a[172:175], a[116:119], v[200:203]
ds_read_b64_tr_b16 a[92:93], v19 offset:16384
ds_read_b64_tr_b16 a[94:95], v19 offset:18432
M v[204:207], a[172:175], a[124:127], v[204:207]
M v[204:207], a[168:171], a[120:123], v[204:207]
M v[208:211], a[168:171], a[128:131], v[208:211]
buffer_load_dwordx4 v9, s[12:15], s24 offen offset:3072 lds
M v[208:211], a[172:175], a[132:135], v[208:211]
M v[212:215], a[172:175], a[140:143], v[212:215]
M v[212:215], a[168:171], a[136:139], v[212:215]
M v[216:219], a[168:171], a[144:147], v[216:219]
s_add_u32 s94, s93, 4096
buffer_store_dwordx4 a[236:239], v1, s[16:19], s94 offen offset:3072 sc1
M v[216:219], a[172:175], a[148:151], v[216:219]
M v[220:223], a[172:175], a[156:159], v[220:223]
s_add_u32 s24, s24, 262144
M v[220:223], a[168:171], a[152:155], v[220:223]
s_waitcnt lgkmcnt(10)
M v[224:227], a[176:179], a[96:99], v[224:227]
M v[224:227], a[180:183], a[100:103], v[224:227]
M v[228:231], a[180:183], a[108:111], v[228:231]
M v[228:231], a[176:179], a[104:107], v[228:231]
M v[232:235], a[176:179], a[112:115], v[232:235]
M v[232:235], a[180:183], a[116:119], v[232:235]
M v[236:239], a[180:183], a[124:127], v[236:239]
M v[236:239], a[176:179], a[120:123], v[236:239]
s_waitcnt vmcnt(21) lgkmcnt(0)
s_barrier
ds_read_b128 a[160:163], v10 offset:0
ds_read_b128 a[164:167], v11 offset:0
M v[240:243], a[176:179], a[128:131], v[240:243]
s_add_u32 m0, s29, 49152
s_add_u32 s3, s23, s31
buffer_load_dwordx4 v2, s[8:11], s3 offen offset:0 lds
M v[240:243], a[180:183], a[132:135], v[240:243]
M v[244:247], a[180:183], a[140:143], v[244:247]
M v[244:247], a[176:179], a[136:139], v[244:247]
M v[248:251], a[176:179], a[144:147], v[248:251]
M v[248:251], a[180:183], a[148:151], v[248:251]
buffer_load_dwordx4 v3, s[8:11], s3 offen offset:1024 lds
M v[252:255], a[180:183], a[156:159], v[252:255]
M v[252:255], a[176:179], a[152:155], v[252:255]
M a[0:3], a[184:187], a[96:99], a[0:3]
M a[0:3], a[188:191], a[100:103], a[0:3]
ds_read_b128 a[168:171], v10 offset:2048
ds_read_b128 a[172:175], v11 offset:2048
M a[4:7], a[188:191], a[108:111], a[4:7]
M a[4:7], a[184:187], a[104:107], a[4:7]
M a[8:11], a[184:187], a[112:115], a[8:11]
buffer_load_dwordx4 v4, s[8:11], s3 offen offset:2048 lds
M a[8:11], a[188:191], a[116:119], a[8:11]
M a[12:15], a[188:191], a[124:127], a[12:15]
M a[12:15], a[184:187], a[120:123], a[12:15]
M a[16:19], a[184:187], a[128:131], a[16:19]
M a[16:19], a[188:191], a[132:135], a[16:19]
buffer_load_dwordx4 v5, s[8:11], s3 offen offset:3072 lds
M a[20:23], a[188:191], a[140:143], a[20:23]
M a[20:23], a[184:187], a[136:139], a[20:23]
M a[24:27], a[184:187], a[144:147], a[24:27]
M a[24:27], a[188:191], a[148:151], a[24:27]
M a[28:31], a[188:191], a[156:159], a[28:31]
M a[28:31], a[184:187], a[152:155], a[28:31]
s_waitcnt lgkmcnt(2)
M v[32:35], a[160:163], a[32:35], v[32:35]
s_add_u32 s23, s23, 128
s_cmp_eq_u32 s23, s25
s_cselect_b32 s23, s26, s23
M v[32:35], a[164:167], a[36:39], v[32:35]
ds_read_b128 a[176:179], v10 offset:4096
ds_read_b128 a[180:183], v11 offset:4096
M v[36:39], a[164:167], a[44:47], v[36:39]
M v[36:39], a[160:163], a[40:43], v[36:39]
ds_read_b64_tr_b16 a[96:97], v12 offset:32768
ds_read_b64_tr_b16 a[98:99], v12 offset:34816
M v[40:43], a[160:163], a[48:51], v[40:43]
M v[40:43], a[164:167], a[52:55], v[40:43]
M v[44:47], a[164:167], a[60:63], v[44:47]
s_add_u32 m0, s29, 81920
s_nop 0
buffer_load_dwordx4 v6, s[12:15], s24 offen offset:0 lds
M v[44:47], a[160:163], a[56:59], v[44:47]
ds_read_b64_tr_b16 a[104:105], v13 offset:32768
ds_read_b64_tr_b16 a[106:107], v13 offset:34816
M v[48:51], a[160:163], a[64:67], v[48:51]
s_add_u32 s94, s93, 8192
buffer_store_dwordx4 a[240:243], v1, s[16:19], s94 offen offset:0 sc1
M v[48:51], a[164:167], a[68:71], v[48:51]
M v[52:55], a[164:167], a[76:79], v[52:55]
M v[52:55], a[160:163], a[72:75], v[52:55]
ds_read_b64_tr_b16 a[112:113], v14 offset:32768
ds_read_b64_tr_b16 a[114:115], v14 offset:34816
M v[56:59], a[160:163], a[80:83], v[56:59]
M v[56:59], a[164:167], a[84:87], v[56:59]
buffer_load_dwordx4 v7, s[12:15], s24 offen offset:1024 lds
M v[60:63], a[164:167], a[92:95], v[60:63]
M v[60:63], a[160:163], a[88:91], v[60:63]
s_waitcnt lgkmcnt(8)
ds_read_b64_tr_b16 a[120:121], v15 offset:32768
ds_read_b64_tr_b16 a[122:123], v15 offset:34816
M v[64:67], a[168:171], a[32:35], v[64:67]
M v[64:67], a[172:175], a[36:39], v[64:67]
ds_read_b128 a[184:187], v10 offset:6144
ds_read_b128 a[188:191], v11 offset:6144
M v[68:71], a[172:175], a[44:47], v[68:71]
M v[68:71], a[168:171], a[40:43], v[68:71]
ds_read_b64_tr_b16 a[128:129], v16 offset:32768
ds_read_b64_tr_b16 a[130:131], v16 offset:34816
M v[72:75], a[168:171], a[48:51], v[72:75]
buffer_load_dwordx4 v8, s[12:15], s24 offen offset:2048 lds
M v[72:75], a[172:175], a[52:55], v[72:75]
M v[76:79], a[172:175], a[60:63], v[76:79]
M v[76:79], a[168:171], a[56:59], v[76:79]
ds_read_b64_tr_b16 a[136:137], v17 offset:32768
ds_read_b64_tr_b16 a[138:139], v17 offset:34816
M v[80:83], a[168:171], a[64:67], v[80:83]
M v[80:83], a[172:175], a[68:71], v[80:83]
buffer_load_dwordx4 v9, s[12:15], s24 offen offset:3072 lds
M v[84:87], a[172:175], a[76:79], v[84:87]
M v[84:87], a[168:171], a[72:75], v[84:87]
ds_read_b64_tr_b16 a[144:145], v18 offset:32768
ds_read_b64_tr_b16 a[146:147], v18 offset:34816
M v[88:91], a[168:171], a[80:83], v[88:91]
M v[88:91], a[172:175], a[84:87], v[88:91]
M v[92:95], a[172:175], a[92:95], v[92:95]
s_add_u32 s24, s24, 262144
s_cmp_eq_u32 s24, s27
s_cselect_b32 s24, s28, s24
s_sub_u32 s6, s6, 1
s_cmp_eq_u32 s6, 0
s_cselect_b64 s[12:13], s[64:65], s[12:13]
M v[92:95], a[168:171], a[88:91], v[92:95]
s_waitcnt lgkmcnt(15)
ds_read_b64_tr_b16 a[152:153], v19 offset:32768
ds_read_b64_tr_b16 a[154:155], v19 offset:34816
M v[96:99], a[176:179], a[32:35], v[96:99]
M v[96:99], a[180:183], a[36:39], v[96:99]
M v[100:103], a[180:183], a[44:47], v[100:103]
M v[100:103], a[176:179], a[40:43], v[100:103]
M v[104:107], a[176:179], a[48:51], v[104:107]
s_add_u32 s94, s93, 8192
buffer_store_dwordx4 a[244:247], v1, s[16:19], s94 offen offset:1024 sc1
M v[104:107], a[180:183], a[52:55], v[104:107]
M v[108:111], a[180:183], a[60:63], v[108:111]
M v[108:111], a[176:179], a[56:59], v[108:111]
s_waitcnt vmcnt(21) lgkmcnt(0)
s_barrier
ds_read_b128 a[160:163], v10 offset:16384
ds_read_b128 a[164:167], v11 offset:16384
M v[112:115], a[176:179], a[64:67], v[112:115]
s_add_u32 m0, s29, 0
s_nop 0
buffer_load_dwordx4 v2, s[8:11], s23 offen offset:0 lds
M v[112:115], a[180:183], a[68:71], v[112:115]
M v[116:119], a[180:183], a[76:79], v[116:119]
M v[116:119], a[176:179], a[72:75], v[116:119]
ds_read_b64_tr_b16 a[100:101], v12 offset:49152
ds_read_b64_tr_b16 a[102:103], v12 offset:51200
M v[120:123], a[176:179], a[80:83], v[120:123]
M v[120:123], a[180:183], a[84:87], v[120:123]
M v[124:127], a[180:183], a[92:95], v[124:127]
buffer_load_dwordx4 v3, s[8:11], s23 offen offset:1024 lds
M v[124:127], a[176:179], a[88:91], v[124:127]
M v[128:131], a[184:187], a[32:35], v[128:131]
M v[128:131], a[188:191], a[36:39], v[128:131]
ds_read_b128 a[168:171], v10 offset:18432
ds_read_b128 a[172:175], v11 offset:18432
ds_read_b64_tr_b16 a[108:109], v13 offset:49152
ds_read_b64_tr_b16 a[110:111], v13 offset:51200
M v[132:135], a[188:191], a[44:47], v[132:135]
M v[132:135], a[184:187], a[40:43], v[132:135]
M v[136:139], a[184:187], a[48:51], v[136:139]
M v[136:139], a[188:191], a[52:55], v[136:139]
buffer_load_dwordx4 v4, s[8:11], s23 offen offset:2048 lds
M v[140:143], a[188:191], a[60:63], v[140:143]
M v[140:143], a[184:187], a[56:59], v[140:143]
ds_read_b64_tr_b16 a[116:117], v14 offset:49152
ds_read_b64_tr_b16 a[118:119], v14 offset:51200
M v[144:147], a[184:187], a[64:67], v[144:147]
M v[144:147], a[188:191], a[68:71], v[144:147]
M v[148:151], a[188:191], a[76:79], v[148:151]
M v[148:151], a[184:187], a[72:75], v[148:151]
buffer_load_dwordx4 v5, s[8:11], s23 offen offset:3072 lds
M v[152:155], a[184:187], a[80:83], v[152:155]
M v[152:155], a[188:191], a[84:87], v[152:155]
ds_read_b64_tr_b16 a[124:125], v15 offset:49152
ds_read_b64_tr_b16 a[126:127], v15 offset:51200
M v[156:159], a[188:191], a[92:95], v[156:159]
M v[156:159], a[184:187], a[88:91], v[156:159]
s_waitcnt lgkmcnt(10)
M v[160:163], a[160:163], a[32:35], v[160:163]
s_add_u32 s94, s93, 8192
buffer_store_dwordx4 a[248:251], v1, s[16:19], s94 offen offset:2048 sc1
M v[160:163], a[164:167], a[36:39], v[160:163]
ds_read_b128 a[176:179], v10 offset:20480
ds_read_b128 a[180:183], v11 offset:20480
M v[164:167], a[164:167], a[44:47], v[164:167]
M v[164:167], a[160:163], a[40:43], v[164:167]
ds_read_b64_tr_b16 a[132:133], v16 offset:49152
ds_read_b64_tr_b16 a[134:135], v16 offset:51200
M v[168:171], a[160:163], a[48:51], v[168:171]
M v[168:171], a[164:167], a[52:55], v[168:171]
s_add_u32 m0, s29, 98304
s_nop 0
buffer_load_dwordx4 v6, s[12:15], s24 offen offset:0 lds
M v[172:175], a[164:167], a[60:63], v[172:175]
M v[172:175], a[160:163], a[56:59], v[172:175]
M v[176:179], a[160:163], a[64:67], v[176:179]
M v[176:179], a[164:167], a[68:71], v[176:179]
ds_read_b64_tr_b16 a[140:141], v17 offset:49152
ds_read_b64_tr_b16 a[142:143], v17 offset:51200
M v[180:183], a[164:167], a[76:79], v[180:183]
M v[180:183], a[160:163], a[72:75], v[180:183]
buffer_load_dwordx4 v7, s[12:15], s24 offen offset:1024 lds
M v[184:187], a[160:163], a[80:83], v[184:187]
M v[184:187], a[164:167], a[84:87], v[184:187]
M v[188:191], a[164:167], a[92:95], v[188:191]
M v[188:191], a[160:163], a[88:91], v[188:191]
s_waitcnt lgkmcnt(12)
ds_read_b64_tr_b16 a[148:149], v18 offset:49152
ds_read_b64_tr_b16 a[150:151], v18 offset:51200
M v[192:195], a[168:171], a[32:35], v[192:195]
M v[192:195], a[172:175], a[36:39], v[192:195]
ds_read_b128 a[184:187], v10 offset:22528
ds_read_b128 a[188:191], v11 offset:22528
M v[196:199], a[172:175], a[44:47], v[196:199]
buffer_load_dwordx4 v8, s[12:15], s24 offen offset:2048 lds
M v[196:199], a[168:171], a[40:43], v[196:199]
M v[200:203], a[168:171], a[48:51], v[200:203]
M v[200:203], a[172:175], a[52:55], v[200:203]
ds_read_b64_tr_b16 a[156:157], v19 offset:49152
ds_read_b64_tr_b16 a[158:159], v19 offset:51200
M v[204:207], a[172:175], a[60:63], v[204:207]
M v[204:207], a[168:171], a[56:59], v[204:207]
M v[208:211], a[168:171], a[64:67], v[208:211]
buffer_load_dwordx4 v9, s[12:15], s24 offen offset:3072 lds
M v[208:211], a[172:175], a[68:71], v[208:211]
M v[212:215], a[172:175], a[76:79], v[212:215]
M v[212:215], a[168:171], a[72:75], v[212:215]
M v[216:219], a[168:171], a[80:83], v[216:219]
s_add_u32 s94, s93, 8192
buffer_store_dwordx4 a[252:255], v1, s[16:19], s94 offen offset:3072 sc1
M v[216:219], a[172:175], a[84:87], v[216:219]
M v[220:223], a[172:175], a[92:95], v[220:223]
s_add_u32 s24, s24, 262144
M v[220:223], a[168:171], a[88:91], v[220:223]
s_waitcnt lgkmcnt(10)
M v[224:227], a[176:179], a[32:35], v[224:227]
M v[224:227], a[180:183], a[36:39], v[224:227]
M v[228:231], a[180:183], a[44:47], v[228:231]
M v[228:231], a[176:179], a[40:43], v[228:231]
M v[232:235], a[176:179], a[48:51], v[232:235]
M v[232:235], a[180:183], a[52:55], v[232:235]
M v[236:239], a[180:183], a[60:63], v[236:239]
M v[236:239], a[176:179], a[56:59], v[236:239]
s_waitcnt vmcnt(21) lgkmcnt(0)
s_barrier
ds_read_b128 a[160:163], v10 offset:32768
ds_read_b128 a[164:167], v11 offset:32768
M v[240:243], a[176:179], a[64:67], v[240:243]
s_add_u32 m0, s29, 16384
s_add_u32 s3, s23, s31
buffer_load_dwordx4 v2, s[8:11], s3 offen offset:0 lds
M v[240:243], a[180:183], a[68:71], v[240:243]
M v[244:247], a[180:183], a[76:79], v[244:247]
M v[244:247], a[176:179], a[72:75], v[244:247]
M v[248:251], a[176:179], a[80:83], v[248:251]
M v[248:251], a[180:183], a[84:87], v[248:251]
buffer_load_dwordx4 v3, s[8:11], s3 offen offset:1024 lds
M v[252:255], a[180:183], a[92:95], v[252:255]
M v[252:255], a[176:179], a[88:91], v[252:255]
M a[0:3], a[184:187], a[32:35], a[0:3]
M a[0:3], a[188:191], a[36:39], a[0:3]
ds_read_b128 a[168:171], v10 offset:34816
ds_read_b128 a[172:175], v11 offset:34816
M a[4:7], a[188:191], a[44:47], a[4:7]
M a[4:7], a[184:187], a[40:43], a[4:7]
M a[8:11], a[184:187], a[48:51], a[8:11]
buffer_load_dwordx4 v4, s[8:11], s3 offen offset:2048 lds
M a[8:11], a[188:191], a[52:55], a[8:11]
M a[12:15], a[188:191], a[60:63], a[12:15]
M a[12:15], a[184:187], a[56:59], a[12:15]
M a[16:19], a[184:187], a[64:67], a[16:19]
M a[16:19], a[188:191], a[68:71], a[16:19]
buffer_load_dwordx4 v5, s[8:11], s3 offen offset:3072 lds
M a[20:23], a[188:191], a[76:79], a[20:23]
M a[20:23], a[184:187], a[72:75], a[20:23]
M a[24:27], a[184:187], a[80:83], a[24:27]
M a[24:27], a[188:191], a[84:87], a[24:27]
M a[28:31], a[188:191], a[92:95], a[28:31]
M a[28:31], a[184:187], a[88:91], a[28:31]
s_waitcnt lgkmcnt(2)
M v[32:35], a[160:163], a[96:99], v[32:35]
s_add_u32 s23, s23, 128
s_cmp_eq_u32 s23, s25
s_cselect_b32 s23, s26, s23
M v[32:35], a[164:167], a[100:103], v[32:35]
ds_read_b128 a[176:179], v10 offset:36864
ds_read_b128 a[180:183], v11 offset:36864
M v[36:39], a[164:167], a[108:111], v[36:39]
M v[36:39], a[160:163], a[104:107], v[36:39]
ds_read_b64_tr_b16 a[32:33], v12 offset:0
ds_read_b64_tr_b16 a[34:35], v12 offset:2048
M v[40:43], a[160:163], a[112:115], v[40:43]
M v[40:43], a[164:167], a[116:119], v[40:43]
M v[44:47], a[164:167], a[124:127], v[44:47]
s_add_u32 m0, s29, 114688
s_nop 0
buffer_load_dwordx4 v6, s[12:15], s24 offen offset:0 lds
M v[44:47], a[160:163], a[120:123], v[44:47]
ds_read_b64_tr_b16 a[40:41], v13 offset:0
ds_read_b64_tr_b16 a[42:43], v13 offset:2048
M v[48:51], a[160:163], a[128:131], v[48:51]
M v[48:51], a[164:167], a[132:135], v[48:51]
M v[52:55], a[164:167], a[140:143], v[52:55]
M v[52:55], a[160:163], a[136:139], v[52:55]
ds_read_b64_tr_b16 a[48:49], v14 offset:0
ds_read_b64_tr_b16 a[50:51], v14 offset:2048
M v[56:59], a[160:163], a[144:147], v[56:59]
M v[56:59], a[164:167], a[148:151], v[56:59]
buffer_load_dwordx4 v7, s[12:15], s24 offen offset:1024 lds
M v[60:63], a[164:167], a[156:159], v[60:63]
M v[60:63], a[160:163], a[152:155], v[60:63]
s_waitcnt lgkmcnt(8)
ds_read_b64_tr_b16 a[56:57], v15 offset:0
ds_read_b64_tr_b16 a[58:59], v15 offset:2048
M v[64:67], a[168:171], a[96:99], v[64:67]
M v[64:67], a[172:175], a[100:103], v[64:67]
ds_read_b128 a[184:187], v10 offset:38912
ds_read_b128 a[188:191], v11 offset:38912
M v[68:71], a[172:175], a[108:111], v[68:71]
M v[68:71], a[168:171], a[104:107], v[68:71]
ds_read_b64_tr_b16 a[64:65], v16 offset:0
ds_read_b64_tr_b16 a[66:67], v16 offset:2048
M v[72:75], a[168:171], a[112:115], v[72:75]
buffer_load_dwordx4 v8, s[12:15], s24 offen offset:2048 lds
M v[72:75], a[172:175], a[116:119], v[72:75]
M v[76:79], a[172:175], a[124:127], v[76:79]
M v[76:79], a[168:171], a[120:123], v[76:79]
ds_read_b64_tr_b16 a[72:73], v17 offset:0
ds_read_b64_tr_b16 a[74:75], v17 offset:2048
M v[80:83], a[168:171], a[128:131], v[80:83]
M v[80:83], a[172:175], a[132:135], v[80:83]
M v[84:87], a[172:175], a[140:143], v[84:87]
buffer_load_dwordx4 v9, s[12:15], s24 offen offset:3072 lds
M v[84:87], a[168:171], a[136:139], v[84:87]
ds_read_b64_tr_b16 a[80:81], v18 offset:0
ds_read_b64_tr_b16 a[82:83], v18 offset:2048
M v[88:91], a[168:171], a[144:147], v[88:91]
M v[88:91], a[172:175], a[148:151], v[88:91]
M v[92:95], a[172:175], a[156:159], v[92:95]
M v[92:95], a[168:171], a[152:155], v[92:95]
s_waitcnt lgkmcnt(15)
ds_read_b64_tr_b16 a[88:89], v19 offset:0
ds_read_b64_tr_b16 a[90:91], v19 offset:2048
M v[96:99], a[176:179], a[96:99], v[96:99]
s_add_u32 s24, s24, 262144
s_cmp_eq_u32 s24, s27
s_cselect_b32 s24, s28, s24
s_sub_u32 s6, s6, 1
s_cmp_eq_u32 s6, 0
s_cselect_b64 s[12:13], s[64:65], s[12:13]
M v[96:99], a[180:183], a[100:103], v[96:99]
M v[100:103], a[180:183], a[108:111], v[100:103]
M v[100:103], a[176:179], a[104:107], v[100:103]
M v[104:107], a[176:179], a[112:115], v[104:107]
M v[104:107], a[180:183], a[116:119], v[104:107]
M v[108:111], a[180:183], a[124:127], v[108:111]
M v[108:111], a[176:179], a[120:123], v[108:111]
s_waitcnt vmcnt(19) lgkmcnt(0)
s_barrier
ds_read_b128 a[160:163], v10 offset:49152
ds_read_b128 a[164:167], v11 offset:49152
M v[112:115], a[176:179], a[128:131], v[112:115]
s_add_u32 m0, s29, 32768
s_nop 0
buffer_load_dwordx4 v2, s[8:11], s23 offen offset:0 lds
M v[112:115], a[180:183], a[132:135], v[112:115]
M v[116:119], a[180:183], a[140:143], v[116:119]
M v[116:119], a[176:179], a[136:139], v[116:119]
ds_read_b64_tr_b16 a[36:37], v12 offset:16384
ds_read_b64_tr_b16 a[38:39], v12 offset:18432
M v[120:123], a[176:179], a[144:147], v[120:123]
M v[120:123], a[180:183], a[148:151], v[120:123]
M v[124:127], a[180:183], a[156:159], v[124:127]
M v[124:127], a[176:179], a[152:155], v[124:127]
M v[128:131], a[184:187], a[96:99], v[128:131]
M v[128:131], a[188:191], a[100:103], v[128:131]
ds_read_b128 a[168:171], v10 offset:51200
ds_read_b128 a[172:175], v11 offset:51200
ds_read_b64_tr_b16 a[44:45], v13 offset:16384
ds_read_b64_tr_b16 a[46:47], v13 offset:18432
M v[132:135], a[188:191], a[108:111], v[132:135]
M v[132:135], a[184:187], a[104:107], v[132:135]
M v[136:139], a[184:187], a[112:115], v[136:139]
M v[136:139], a[188:191], a[116:119], v[136:139]
M v[140:143], a[188:191], a[124:127], v[140:143]
M v[140:143], a[184:187], a[120:123], v[140:143]
ds_read_b64_tr_b16 a[52:53], v14 offset:16384
ds_read_b64_tr_b16 a[54:55], v14 offset:18432
M v[144:147], a[184:187], a[128:131], v[144:147]
buffer_load_dwordx4 v3, s[8:11], s23 offen offset:1024 lds
M v[144:147], a[188:191], a[132:135], v[144:147]
M v[148:151], a[188:191], a[140:143], v[148:151]
M v[148:151], a[184:187], a[136:139], v[148:151]
M v[152:155], a[184:187], a[144:147], v[152:155]
M v[152:155], a[188:191], a[148:151], v[152:155]
ds_read_b64_tr_b16 a[60:61], v15 offset:16384
ds_read_b64_tr_b16 a[62:63], v15 offset:18432
M v[156:159], a[188:191], a[156:159], v[156:159]
M v[156:159], a[184:187], a[152:155], v[156:159]
s_waitcnt lgkmcnt(10)
M v[160:163], a[160:163], a[96:99], v[160:163]
M v[160:163], a[164:167], a[100:103], v[160:163]
ds_read_b128 a[176:179], v10 offset:53248
ds_read_b128 a[180:183], v11 offset:53248
M v[164:167], a[164:167], a[108:111], v[164:167]
M v[164:167], a[160:163], a[104:107], v[164:167]
ds_read_b64_tr_b16 a[68:69], v16 offset:16384
ds_read_b64_tr_b16 a[70:71], v16 offset:18432
M v[168:171], a[160:163], a[112:115], v[168:171]
M v[168:171], a[164:167], a[116:119], v[168:171]
M v[172:175], a[164:167], a[124:127], v[172:175]
M v[172:175], a[160:163], a[120:123], v[172:175]
M v[176:179], a[160:163], a[128:131], v[176:179]
buffer_load_dwordx4 v4, s[8:11], s23 offen offset:2048 lds
M v[176:179], a[164:167], a[132:135], v[176:179]
ds_read_b64_tr_b16 a[76:77], v17 offset:16384
ds_read_b64_tr_b16 a[78:79], v17 offset:18432
M v[180:183], a[164:167], a[140:143], v[180:183]
M v[180:183], a[160:163], a[136:139], v[180:183]
M v[184:187], a[160:163], a[144:147], v[184:187]
M v[184:187], a[164:167], a[148:151], v[184:187]
M v[188:191], a[164:167], a[156:159], v[188:191]
M v[188:191], a[160:163], a[152:155], v[188:191]
s_waitcnt lgkmcnt(12)
ds_read_b64_tr_b16 a[84:85], v18 offset:16384
ds_read_b64_tr_b16 a[86:87], v18 offset:18432
M v[192:195], a[168:171], a[96:99], v[192:195]
M v[192:195], a[172:175], a[100:103], v[192:195]
ds_read_b128 a[184:187], v10 offset:55296
ds_read_b128 a[188:191], v11 offset:55296
M v[196:199], a[172:175], a[108:111], v[196:199]
M v[196:199], a[168:171], a[104:107], v[196:199]
M v[200:203], a[168:171], a[112:115], v[200:203]
M v[200:203], a[172:175], a[116:119], v[200:203]
ds_read_b64_tr_b16 a[92:93], v19 offset:16384
ds_read_b64_tr_b16 a[94:95], v19 offset:18432
M v[204:207], a[172:175], a[124:127], v[204:207]
M v[204:207], a[168:171], a[120:123], v[204:207]
M v[208:211], a[168:171], a[128:131], v[208:211]
buffer_load_dwordx4 v5, s[8:11], s23 offen offset:3072 lds
M v[208:211], a[172:175], a[132:135], v[208:211]
M v[212:215], a[172:175], a[140:143], v[212:215]
M v[212:215], a[168:171], a[136:139], v[212:215]
M v[216:219], a[168:171], a[144:147], v[216:219]
M v[216:219], a[172:175], a[148:151], v[216:219]
M v[220:223], a[172:175], a[156:159], v[220:223]
M v[220:223], a[168:171], a[152:155], v[220:223]
s_waitcnt lgkmcnt(10)
M v[224:227], a[176:179], a[96:99], v[224:227]
M v[224:227], a[180:183], a[100:103], v[224:227]
M v[228:231], a[180:183], a[108:111], v[228:231]
M v[228:231], a[176:179], a[104:107], v[228:231]
M v[232:235], a[176:179], a[112:115], v[232:235]
M v[232:235], a[180:183], a[116:119], v[232:235]
M v[236:239], a[180:183], a[124:127], v[236:239]
M v[236:239], a[176:179], a[120:123], v[236:239]
s_waitcnt vmcnt(13) lgkmcnt(0)
s_barrier
ds_read_b128 a[160:163], v10 offset:0
ds_read_b128 a[164:167], v11 offset:0
M v[240:243], a[176:179], a[128:131], v[240:243]
s_add_u32 m0, s29, 49152
s_add_u32 s3, s23, s31
buffer_load_dwordx4 v2, s[8:11], s3 offen offset:0 lds
M v[240:243], a[180:183], a[132:135], v[240:243]
M v[244:247], a[180:183], a[140:143], v[244:247]
M v[244:247], a[176:179], a[136:139], v[244:247]
M v[248:251], a[176:179], a[144:147], v[248:251]
M v[248:251], a[180:183], a[148:151], v[248:251]
M v[252:255], a[180:183], a[156:159], v[252:255]
M v[252:255], a[176:179], a[152:155], v[252:255]
M a[0:3], a[184:187], a[96:99], a[0:3]
M a[0:3], a[188:191], a[100:103], a[0:3]
ds_read_b128 a[168:171], v10 offset:2048
ds_read_b128 a[172:175], v11 offset:2048
M a[4:7], a[188:191], a[108:111], a[4:7]
M a[4:7], a[184:187], a[104:107], a[4:7]
M a[8:11], a[184:187], a[112:115], a[8:11]
buffer_load_dwordx4 v3, s[8:11], s3 offen offset:1024 lds
M a[8:11], a[188:191], a[116:119], a[8:11]
M a[12:15], a[188:191], a[124:127], a[12:15]
M a[12:15], a[184:187], a[120:123], a[12:15]
M a[16:19], a[184:187], a[128:131], a[16:19]
M a[16:19], a[188:191], a[132:135], a[16:19]
M a[20:23], a[188:191], a[140:143], a[20:23]
M a[20:23], a[184:187], a[136:139], a[20:23]
M a[24:27], a[184:187], a[144:147], a[24:27]
M a[24:27], a[188:191], a[148:151], a[24:27]
M a[28:31], a[188:191], a[156:159], a[28:31]
M a[28:31], a[184:187], a[152:155], a[28:31]
s_waitcnt lgkmcnt(2)
M v[32:35], a[160:163], a[32:35], v[32:35]
buffer_load_dwordx4 v4, s[8:11], s3 offen offset:2048 lds
M v[32:35], a[164:167], a[36:39], v[32:35]
ds_read_b128 a[176:179], v10 offset:4096
ds_read_b128 a[180:183], v11 offset:4096
M v[36:39], a[164:167], a[44:47], v[36:39]
M v[36:39], a[160:163], a[40:43], v[36:39]
ds_read_b64_tr_b16 a[96:97], v12 offset:32768
ds_read_b64_tr_b16 a[98:99], v12 offset:34816
M v[40:43], a[160:163], a[48:51], v[40:43]
M v[40:43], a[164:167], a[52:55], v[40:43]
M v[44:47], a[164:167], a[60:63], v[44:47]
M v[44:47], a[160:163], a[56:59], v[44:47]
ds_read_b64_tr_b16 a[104:105], v13 offset:32768
ds_read_b64_tr_b16 a[106:107], v13 offset:34816
M v[48:51], a[160:163], a[64:67], v[48:51]
M v[48:51], a[164:167], a[68:71], v[48:51]
M v[52:55], a[164:167], a[76:79], v[52:55]
M v[52:55], a[160:163], a[72:75], v[52:55]
ds_read_b64_tr_b16 a[112:113], v14 offset:32768
ds_read_b64_tr_b16 a[114:115], v14 offset:34816
M v[56:59], a[160:163], a[80:83], v[56:59]
M v[56:59], a[164:167], a[84:87], v[56:59]
buffer_load_dwordx4 v5, s[8:11], s3 offen offset:3072 lds
M v[60:63], a[164:167], a[92:95], v[60:63]
M v[60:63], a[160:163], a[88:91], v[60:63]
s_waitcnt lgkmcnt(8)
ds_read_b64_tr_b16 a[120:121], v15 offset:32768
ds_read_b64_tr_b16 a[122:123], v15 offset:34816
M v[64:67], a[168:171], a[32:35], v[64:67]
M v[64:67], a[172:175], a[36:39], v[64:67]
ds_read_b128 a[184:187], v10 offset:6144
ds_read_b128 a[188:191], v11 offset:6144
M v[68:71], a[172:175], a[44:47], v[68:71]
M v[68:71], a[168:171], a[40:43], v[68:71]
ds_read_b64_tr_b16 a[128:129], v16 offset:32768
ds_read_b64_tr_b16 a[130:131], v16 offset:34816
M v[72:75], a[168:171], a[48:51], v[72:75]
M v[72:75], a[172:175], a[52:55], v[72:75]
M v[76:79], a[172:175], a[60:63], v[76:79]
M v[76:79], a[168:171], a[56:59], v[76:79]
ds_read_b64_tr_b16 a[136:137], v17 offset:32768
ds_read_b64_tr_b16 a[138:139], v17 offset:34816
M v[80:83], a[168:171], a[64:67], v[80:83]
M v[80:83], a[172:175], a[68:71], v[80:83]
M v[84:87], a[172:175], a[76:79], v[84:87]
s_add_u32 s23, s23, 128
s_cmp_eq_u32 s23, s25
s_cselect_b32 s23, s26, s23
M v[84:87], a[168:171], a[72:75], v[84:87]
ds_read_b64_tr_b16 a[144:145], v18 offset:32768
ds_read_b64_tr_b16 a[146:147], v18 offset:34816
M v[88:91], a[168:171], a[80:83], v[88:91]
M v[88:91], a[172:175], a[84:87], v[88:91]
M v[92:95], a[172:175], a[92:95], v[92:95]
M v[92:95], a[168:171], a[88:91], v[92:95]
s_waitcnt lgkmcnt(15)
ds_read_b64_tr_b16 a[152:153], v19 offset:32768
ds_read_b64_tr_b16 a[154:155], v19 offset:34816
M v[96:99], a[176:179], a[32:35], v[96:99]
M v[96:99], a[180:183], a[36:39], v[96:99]
M v[100:103], a[180:183], a[44:47], v[100:103]
M v[100:103], a[176:179], a[40:43], v[100:103]
M v[104:107], a[176:179], a[48:51], v[104:107]
M v[104:107], a[180:183], a[52:55], v[104:107]
M v[108:111], a[180:183], a[60:63], v[108:111]
M v[108:111], a[176:179], a[56:59], v[108:111]
s_waitcnt vmcnt(8) lgkmcnt(0)
s_barrier
ds_read_b128 a[160:163], v10 offset:16384
ds_read_b128 a[164:167], v11 offset:16384
M v[112:115], a[176:179], a[64:67], v[112:115]
M v[112:115], a[180:183], a[68:71], v[112:115]
s_and_b32 s3, s2, 1
s_lshl_b32 s3, s3, 3
s_bfe_u32 s4, s2, 0x30003
M v[116:119], a[180:183], a[76:79], v[116:119]
s_add_u32 s26, s3, s4
s_bfe_u32 s3, s2, 0x20001
s_lshl_b32 s3, s3, 2
M v[116:119], a[176:179], a[72:75], v[116:119]
ds_read_b64_tr_b16 a[100:101], v12 offset:49152
ds_read_b64_tr_b16 a[102:103], v12 offset:51200
s_lshr_b32 s4, s2, 6
s_xor_b32 s4, s4, 2
s_add_u32 s27, s3, s4
M v[120:123], a[176:179], a[80:83], v[120:123]
s_lshl_b32 s23, s26, 18
s_sub_u32 s24, s23, 32768
M v[120:123], a[180:183], a[84:87], v[120:123]
s_max_i32 s24, s24, 0
s_lshl_b32 s25, s27, 7
s_add_u32 s3, s26, s27
M v[124:127], a[180:183], a[92:95], v[124:127]
s_and_b32 s3, s3, 0
s_mul_i32 s3, s3, 16
s_sub_u32 s31, 16, s3
M v[124:127], a[176:179], a[88:91], v[124:127]
s_mov_b32 s54, s31
s_movk_i32 s57, 128
M v[128:131], a[184:187], a[32:35], v[128:131]
s_mov_b32 s55, 4289069056
s_mov_b32 s56, 393216
s_lshl_b32 s4, s3, 7
M v[128:131], a[188:191], a[36:39], v[128:131]
ds_read_b128 a[168:171], v10 offset:18432
ds_read_b128 a[172:175], v11 offset:18432
ds_read_b64_tr_b16 a[108:109], v13 offset:49152
ds_read_b64_tr_b16 a[110:111], v13 offset:51200
s_add_u32 s23, s23, s4
s_add_u32 s24, s24, s4
s_mul_i32 s4, s3, 393216
M v[132:135], a[188:191], a[44:47], v[132:135]
s_add_u32 s25, s25, s4
s_mov_b64 s[8:9], s[44:45]
s_mov_b32 s10, 4194304
M v[132:135], a[184:187], a[40:43], v[132:135]
s_mov_b64 s[12:13], s[46:47]
s_mov_b32 s14, 6291456
M v[136:139], a[184:187], a[48:51], v[136:139]
s_mov_b64 s[36:37], s[90:91]
s_mov_b32 s38, 256
s_mov_b32 s39, 0x00020000
M v[136:139], a[188:191], a[52:55], v[136:139]
s_lshl_b32 s28, s20, 9
s_mul_i32 s30, s20, 6144
s_lshl_b32 s3, s20, 5
M v[140:143], a[188:191], a[60:63], v[140:143]
v_lshrrev_b32 v24, 3, v0
v_and_b32 v25, 7, v0
M v[140:143], a[184:187], a[56:59], v[140:143]
ds_read_b64_tr_b16 a[116:117], v14 offset:49152
ds_read_b64_tr_b16 a[118:119], v14 offset:51200
v_add_u32 v28, s3, v24
v_add_u32 v26, 0, v28
v_bfe_u32 v27, v26, 1, 3
M v[144:147], a[184:187], a[64:67], v[144:147]
v_xor_b32 v27, v27, v25
v_lshlrev_b32 v26, 11, v26
v_lshl_add_u32 v26, v27, 4, v26
M v[144:147], a[188:191], a[68:71], v[144:147]
v_subrev_u32 v2, 0, v26
v_add_u32 v26, 8, v28
v_bfe_u32 v27, v26, 1, 3
M v[148:151], a[188:191], a[76:79], v[148:151]
v_xor_b32 v27, v27, v25
v_lshlrev_b32 v26, 11, v26
M v[148:151], a[184:187], a[72:75], v[148:151]
v_lshl_add_u32 v26, v27, 4, v26
v_subrev_u32 v3, 1024, v26
v_add_u32 v26, 16, v28
M v[152:155], a[184:187], a[80:83], v[152:155]
v_bfe_u32 v27, v26, 1, 3
v_xor_b32 v27, v27, v25
v_lshlrev_b32 v26, 11, v26
M v[152:155], a[188:191], a[84:87], v[152:155]
ds_read_b64_tr_b16 a[124:125], v15 offset:49152
ds_read_b64_tr_b16 a[126:127], v15 offset:51200
v_lshl_add_u32 v26, v27, 4, v26
v_subrev_u32 v4, 2048, v26
M v[156:159], a[188:191], a[92:95], v[156:159]
v_add_u32 v26, 24, v28
v_bfe_u32 v27, v26, 1, 3
v_xor_b32 v27, v27, v25
M v[156:159], a[184:187], a[88:91], v[156:159]
s_waitcnt lgkmcnt(10)
v_lshlrev_b32 v26, 11, v26
v_lshl_add_u32 v26, v27, 4, v26
v_subrev_u32 v5, 3072, v26
M v[160:163], a[160:163], a[32:35], v[160:163]
s_lshl_b32 s3, s20, 2
v_lshrrev_b32 v26, 5, v0
M v[160:163], a[164:167], a[36:39], v[160:163]
ds_read_b128 a[176:179], v10 offset:20480
ds_read_b128 a[180:183], v11 offset:20480
v_add_u32 v26, s3, v26
v_bfe_u32 v29, v0, 2, 3
v_bfe_u32 v27, v26, 1, 3
M v[164:167], a[164:167], a[44:47], v[164:167]
v_xor_b32 v27, v27, v29
v_lshlrev_b32 v27, 4, v27
v_and_b32 v30, 3, v0
M v[164:167], a[160:163], a[40:43], v[164:167]
ds_read_b64_tr_b16 a[132:133], v16 offset:49152
ds_read_b64_tr_b16 a[134:135], v16 offset:51200
v_lshl_add_u32 v27, v30, 2, v27
v_lshl_add_u32 v20, v26, 11, v27
v_add_u32 v26, 2, v26
M v[168:171], a[160:163], a[48:51], v[168:171]
v_bfe_u32 v27, v26, 1, 3
v_xor_b32 v27, v27, v29
M v[168:171], a[164:167], a[52:55], v[168:171]
v_lshlrev_b32 v27, 4, v27
v_and_b32 v30, 3, v0
v_lshl_add_u32 v27, v30, 2, v27
M v[172:175], a[164:167], a[60:63], v[172:175]
v_lshl_add_u32 v23, v26, 11, v27
v_subrev_u32 v23, 256, v23
s_mul_i32 s3, s20, 48
M v[172:175], a[160:163], a[56:59], v[172:175]
v_add_u32 v28, s3, v24
v_add_u32 v26, 0, v28
M v[176:179], a[160:163], a[64:67], v[176:179]
v_mul_u32_u24 v27, 0xaaab, v26
v_lshrrev_b32 v27, 17, v27
v_lshrrev_b32 v29, 1, v27
M v[176:179], a[164:167], a[68:71], v[176:179]
ds_read_b64_tr_b16 a[140:141], v17 offset:49152
ds_read_b64_tr_b16 a[142:143], v17 offset:51200
v_and_b32 v29, 4, v29
v_and_or_b32 v27, v27, 2, v29
v_xor_b32 v27, v27, v25
M v[180:183], a[164:167], a[76:79], v[180:183]
v_lshlrev_b32 v26, 11, v26
v_lshl_add_u32 v26, v27, 4, v26
v_subrev_u32 v6, 0, v26
M v[180:183], a[160:163], a[72:75], v[180:183]
v_add_u32 v26, 8, v28
v_mul_u32_u24 v27, 0xaaab, v26
M v[184:187], a[160:163], a[80:83], v[184:187]
v_lshrrev_b32 v27, 17, v27
v_lshrrev_b32 v29, 1, v27
v_and_b32 v29, 4, v29
M v[184:187], a[164:167], a[84:87], v[184:187]
v_and_or_b32 v27, v27, 2, v29
v_xor_b32 v27, v27, v25
v_lshlrev_b32 v26, 11, v26
M v[188:191], a[164:167], a[92:95], v[188:191]
v_lshl_add_u32 v26, v27, 4, v26
v_subrev_u32 v7, 1024, v26
M v[188:191], a[160:163], a[88:91], v[188:191]
s_waitcnt lgkmcnt(12)
ds_read_b64_tr_b16 a[148:149], v18 offset:49152
ds_read_b64_tr_b16 a[150:151], v18 offset:51200
v_add_u32 v26, 16, v28
v_mul_u32_u24 v27, 0xaaab, v26
v_lshrrev_b32 v27, 17, v27
M v[192:195], a[168:171], a[32:35], v[192:195]
v_lshrrev_b32 v29, 1, v27
v_and_b32 v29, 4, v29
v_and_or_b32 v27, v27, 2, v29
M v[192:195], a[172:175], a[36:39], v[192:195]
ds_read_b128 a[184:187], v10 offset:22528
ds_read_b128 a[188:191], v11 offset:22528
v_xor_b32 v27, v27, v25
v_lshlrev_b32 v26, 11, v26
M v[196:199], a[172:175], a[44:47], v[196:199]
v_lshl_add_u32 v26, v27, 4, v26
v_subrev_u32 v8, 2048, v26
v_add_u32 v26, 24, v28
M v[196:199], a[168:171], a[40:43], v[196:199]
v_mul_u32_u24 v27, 0xaaab, v26
v_lshrrev_b32 v27, 17, v27
v_lshrrev_b32 v29, 1, v27
M v[200:203], a[168:171], a[48:51], v[200:203]
v_and_b32 v29, 4, v29
v_and_or_b32 v27, v27, 2, v29
v_xor_b32 v27, v27, v25
M v[200:203], a[172:175], a[52:55], v[200:203]
ds_read_b64_tr_b16 a[156:157], v19 offset:49152
ds_read_b64_tr_b16 a[158:159], v19 offset:51200
v_lshlrev_b32 v26, 11, v26
v_lshl_add_u32 v26, v27, 4, v26
M v[204:207], a[172:175], a[60:63], v[204:207]
v_subrev_u32 v9, 3072, v26
v_add_u32 v26, 32, v28
v_mul_u32_u24 v27, 0xaaab, v26
M v[204:207], a[168:171], a[56:59], v[204:207]
v_lshrrev_b32 v27, 17, v27
v_lshrrev_b32 v29, 1, v27
v_and_b32 v29, 4, v29
M v[208:211], a[168:171], a[64:67], v[208:211]
v_and_or_b32 v27, v27, 2, v29
v_xor_b32 v27, v27, v25
M v[208:211], a[172:175], a[68:71], v[208:211]
v_lshlrev_b32 v26, 11, v26
v_lshl_add_u32 v26, v27, 4, v26
v_subrev_u32 v21, 0, v26
M v[212:215], a[172:175], a[76:79], v[212:215]
v_add_u32 v26, 40, v28
v_mul_u32_u24 v27, 0xaaab, v26
v_lshrrev_b32 v27, 17, v27
M v[212:215], a[168:171], a[72:75], v[212:215]
v_lshrrev_b32 v29, 1, v27
v_and_b32 v29, 4, v29
v_and_or_b32 v27, v27, 2, v29
M v[216:219], a[168:171], a[80:83], v[216:219]
v_xor_b32 v27, v27, v25
v_lshlrev_b32 v26, 11, v26
M v[216:219], a[172:175], a[84:87], v[216:219]
v_lshl_add_u32 v26, v27, 4, v26
v_subrev_u32 v22, 1024, v26
s_lshr_b32 s3, s53, 7
M v[220:223], a[172:175], a[92:95], v[220:223]
s_add_u32 s3, s3, s22
s_lshl_b32 s3, s3, 5
s_lshr_b32 s19, s52, 6
M v[220:223], a[168:171], a[88:91], v[220:223]
s_waitcnt lgkmcnt(10)
s_add_u32 s3, s3, s19
s_lshl_b32 s19, s21, 1
M v[224:227], a[176:179], a[32:35], v[224:227]
s_add_u32 s3, s3, s19
s_lshl_b32 s92, s3, 15
s_add_u32 s92, s92, 16384
M v[224:227], a[180:183], a[36:39], v[224:227]
s_add_u32 s93, s92, 32768
s_add_u32 s16, s50, 16777216
s_addc_u32 s17, s51, 0
M v[228:231], a[180:183], a[44:47], v[228:231]
s_mov_b32 s18, 33554432
s_mov_b32 s19, 0x00020000
M v[228:231], a[176:179], a[40:43], v[228:231]
M v[232:235], a[176:179], a[48:51], v[232:235]
M v[232:235], a[180:183], a[52:55], v[232:235]
M v[236:239], a[180:183], a[60:63], v[236:239]
M v[236:239], a[176:179], a[56:59], v[236:239]
s_waitcnt vmcnt(4) lgkmcnt(0)
s_barrier
ds_read_b128 a[160:163], v10 offset:32768
ds_read_b128 a[164:167], v11 offset:32768
M v[240:243], a[176:179], a[64:67], v[240:243]
s_add_u32 m0, s28, 131072
s_nop 0
buffer_load_dword v20, s[8:11], s24 offen lds
M v[240:243], a[180:183], a[68:71], v[240:243]
M v[244:247], a[180:183], a[76:79], v[244:247]
M v[244:247], a[176:179], a[72:75], v[244:247]
buffer_load_dword v23, s[8:11], s24 offen offset:256 lds
M v[248:251], a[176:179], a[80:83], v[248:251]
M v[248:251], a[180:183], a[84:87], v[248:251]
M v[252:255], a[180:183], a[92:95], v[252:255]
M v[252:255], a[176:179], a[88:91], v[252:255]
M a[0:3], a[184:187], a[32:35], a[0:3]
s_add_u32 m0, s29, 133120
s_nop 0
buffer_load_dwordx4 v2, s[8:11], s23 offen offset:0 lds
M a[0:3], a[188:191], a[36:39], a[0:3]
ds_read_b128 a[168:171], v10 offset:34816
ds_read_b128 a[172:175], v11 offset:34816
M a[4:7], a[188:191], a[44:47], a[4:7]
M a[4:7], a[184:187], a[40:43], a[4:7]
M a[8:11], a[184:187], a[48:51], a[8:11]
buffer_load_dwordx4 v3, s[8:11], s23 offen offset:1024 lds
M a[8:11], a[188:191], a[52:55], a[8:11]
M a[12:15], a[188:191], a[60:63], a[12:15]
M a[12:15], a[184:187], a[56:59], a[12:15]
M a[16:19], a[184:187], a[64:67], a[16:19]
buffer_load_dwordx4 v4, s[8:11], s23 offen offset:2048 lds
M a[16:19], a[188:191], a[68:71], a[16:19]
M a[20:23], a[188:191], a[76:79], a[20:23]
M a[20:23], a[184:187], a[72:75], a[20:23]
buffer_load_dwordx4 v5, s[8:11], s23 offen offset:3072 lds
M a[24:27], a[184:187], a[80:83], a[24:27]
M a[24:27], a[188:191], a[84:87], a[24:27]
M a[28:31], a[188:191], a[92:95], a[28:31]
M a[28:31], a[184:187], a[88:91], a[28:31]
s_waitcnt lgkmcnt(2)
M v[32:35], a[160:163], a[96:99], v[32:35]
s_sub_u32 s31, s31, 1
s_cmp_eq_u32 s31, 0
s_cselect_b32 s58, -1920, s57
s_add_u32 s23, s23, s58
s_add_u32 s24, s24, s58
M v[32:35], a[164:167], a[100:103], v[32:35]
ds_read_b128 a[176:179], v10 offset:36864
ds_read_b128 a[180:183], v11 offset:36864
M v[36:39], a[164:167], a[108:111], v[36:39]
M v[36:39], a[160:163], a[104:107], v[36:39]
M v[40:43], a[160:163], a[112:115], v[40:43]
M v[40:43], a[164:167], a[116:119], v[40:43]
s_add_u32 m0, s30, 65536
s_nop 0
buffer_load_dwordx4 v6, s[12:15], s25 offen offset:0 lds
M v[44:47], a[164:167], a[124:127], v[44:47]
M v[44:47], a[160:163], a[120:123], v[44:47]
M v[48:51], a[160:163], a[128:131], v[48:51]
M v[48:51], a[164:167], a[132:135], v[48:51]
buffer_load_dwordx4 v7, s[12:15], s25 offen offset:1024 lds
M v[52:55], a[164:167], a[140:143], v[52:55]
M v[52:55], a[160:163], a[136:139], v[52:55]
M v[56:59], a[160:163], a[144:147], v[56:59]
M v[56:59], a[164:167], a[148:151], v[56:59]
buffer_load_dwordx4 v8, s[12:15], s25 offen offset:2048 lds
M v[60:63], a[164:167], a[156:159], v[60:63]
M v[60:63], a[160:163], a[152:155], v[60:63]
s_waitcnt lgkmcnt(2)
M v[64:67], a[168:171], a[96:99], v[64:67]
M v[64:67], a[172:175], a[100:103], v[64:67]
ds_read_b128 a[184:187], v10 offset:38912
ds_read_b128 a[188:191], v11 offset:38912
M v[68:71], a[172:175], a[108:111], v[68:71]
M v[68:71], a[168:171], a[104:107], v[68:71]
buffer_load_dwordx4 v9, s[12:15], s25 offen offset:3072 lds
M v[72:75], a[168:171], a[112:115], v[72:75]
M v[72:75], a[172:175], a[116:119], v[72:75]
M v[76:79], a[172:175], a[124:127], v[76:79]
M v[76:79], a[168:171], a[120:123], v[76:79]
s_add_u32 m0, s30, 69632
s_nop 0
buffer_load_dwordx4 v21, s[12:15], s25 offen offset:0 lds
M v[80:83], a[168:171], a[128:131], v[80:83]
M v[80:83], a[172:175], a[132:135], v[80:83]
M v[84:87], a[172:175], a[140:143], v[84:87]
M v[84:87], a[168:171], a[136:139], v[84:87]
buffer_load_dwordx4 v22, s[12:15], s25 offen offset:1024 lds
M v[88:91], a[168:171], a[144:147], v[88:91]
M v[88:91], a[172:175], a[148:151], v[88:91]
M v[92:95], a[172:175], a[156:159], v[92:95]
M v[92:95], a[168:171], a[152:155], v[92:95]
s_waitcnt lgkmcnt(2)
M v[96:99], a[176:179], a[96:99], v[96:99]
s_sub_u32 s54, s54, 1
s_cmp_eq_u32 s54, 0
s_cselect_b32 s58, s55, s56
s_add_u32 s25, s25, s58
M v[96:99], a[180:183], a[100:103], v[96:99]
M v[100:103], a[180:183], a[108:111], v[100:103]
M v[100:103], a[176:179], a[104:107], v[100:103]
v_cvt_pk_bf16_f32 v32, v32, v33
v_cvt_pk_bf16_f32 v33, v34, v35
M v[104:107], a[176:179], a[112:115], v[104:107]
v_cvt_pk_bf16_f32 v34, v64, v65
v_cvt_pk_bf16_f32 v35, v66, v67
M v[104:107], a[180:183], a[116:119], v[104:107]
v_cvt_pk_bf16_f32 v64, v48, v49
M v[108:111], a[180:183], a[124:127], v[108:111]
v_cvt_pk_bf16_f32 v65, v50, v51
v_cvt_pk_bf16_f32 v66, v80, v81
M v[108:111], a[176:179], a[120:123], v[108:111]
s_waitcnt vmcnt(12) lgkmcnt(0)
s_barrier
ds_read_b128 a[160:163], v10 offset:49152
ds_read_b128 a[164:167], v11 offset:49152
v_cvt_pk_bf16_f32 v67, v82, v83
M v[112:115], a[176:179], a[128:131], v[112:115]
s_add_u32 m0, s28, 0
s_nop 0
buffer_load_dword v20, s[8:11], s24 offen lds
v_cvt_pk_bf16_f32 v48, v40, v41
v_cvt_pk_bf16_f32 v49, v42, v43
M v[112:115], a[180:183], a[132:135], v[112:115]
v_cvt_pk_bf16_f32 v50, v72, v73
v_cvt_pk_bf16_f32 v51, v74, v75
M v[116:119], a[180:183], a[140:143], v[116:119]
v_cvt_pk_bf16_f32 v80, v56, v57
M v[116:119], a[176:179], a[136:139], v[116:119]
buffer_load_dword v23, s[8:11], s24 offen offset:256 lds
v_cvt_pk_bf16_f32 v81, v58, v59
v_cvt_pk_bf16_f32 v82, v88, v89
M v[120:123], a[176:179], a[144:147], v[120:123]
v_cvt_pk_bf16_f32 v83, v90, v91
M v[120:123], a[180:183], a[148:151], v[120:123]
v_cvt_pk_bf16_f32 v40, v36, v37
v_cvt_pk_bf16_f32 v41, v38, v39
M v[124:127], a[180:183], a[156:159], v[124:127]
s_add_u32 m0, s29, 2048
s_nop 0
buffer_load_dwordx4 v2, s[8:11], s23 offen offset:0 lds
v_cvt_pk_bf16_f32 v42, v68, v69
v_cvt_pk_bf16_f32 v43, v70, v71
M v[124:127], a[176:179], a[152:155], v[124:127]
v_cvt_pk_bf16_f32 v72, v52, v53
M v[128:131], a[184:187], a[96:99], v[128:131]
v_cvt_pk_bf16_f32 v73, v54, v55
v_cvt_pk_bf16_f32 v74, v84, v85
M v[128:131], a[188:191], a[100:103], v[128:131]
ds_read_b128 a[168:171], v10 offset:51200
ds_read_b128 a[172:175], v11 offset:51200
v_cvt_pk_bf16_f32 v75, v86, v87
M v[132:135], a[188:191], a[108:111], v[132:135]
v_cvt_pk_bf16_f32 v56, v44, v45
v_cvt_pk_bf16_f32 v57, v46, v47
M v[132:135], a[184:187], a[104:107], v[132:135]
buffer_load_dwordx4 v3, s[8:11], s23 offen offset:1024 lds
v_cvt_pk_bf16_f32 v58, v76, v77
v_cvt_pk_bf16_f32 v59, v78, v79
M v[136:139], a[184:187], a[112:115], v[136:139]
v_cvt_pk_bf16_f32 v88, v60, v61
M v[136:139], a[188:191], a[116:119], v[136:139]
v_cvt_pk_bf16_f32 v89, v62, v63
v_cvt_pk_bf16_f32 v90, v92, v93
M v[140:143], a[188:191], a[124:127], v[140:143]
buffer_load_dwordx4 v4, s[8:11], s23 offen offset:2048 lds
v_cvt_pk_bf16_f32 v91, v94, v95
M v[140:143], a[184:187], a[120:123], v[140:143]
M v[144:147], a[184:187], a[128:131], v[144:147]
M v[144:147], a[188:191], a[132:135], v[144:147]
buffer_load_dwordx4 v5, s[8:11], s23 offen offset:3072 lds
M v[148:151], a[188:191], a[140:143], v[148:151]
s_add_u32 s94, s92, 0
buffer_store_dwordx4 v[32:35], v1, s[16:19], s94 offen offset:0 sc1
M v[148:151], a[184:187], a[136:139], v[148:151]
M v[152:155], a[184:187], a[144:147], v[152:155]
M v[152:155], a[188:191], a[148:151], v[152:155]
s_sub_u32 s31, s31, 1
s_cmp_eq_u32 s31, 0
s_cselect_b32 s58, -1920, s57
s_add_u32 s23, s23, s58
s_add_u32 s24, s24, s58
M v[156:159], a[188:191], a[156:159], v[156:159]
s_add_u32 s94, s92, 0
buffer_store_dwordx4 v[40:43], v1, s[16:19], s94 offen offset:1024 sc1
M v[156:159], a[184:187], a[152:155], v[156:159]
s_waitcnt lgkmcnt(2)
M v[160:163], a[160:163], a[96:99], v[160:163]
M v[160:163], a[164:167], a[100:103], v[160:163]
ds_read_b128 a[176:179], v10 offset:53248
ds_read_b128 a[180:183], v11 offset:53248
M v[164:167], a[164:167], a[108:111], v[164:167]
s_add_u32 s94, s92, 0
buffer_store_dwordx4 v[48:51], v1, s[16:19], s94 offen offset:2048 sc1
M v[164:167], a[160:163], a[104:107], v[164:167]
v_cvt_pk_bf16_f32 v96, v96, v97
v_cvt_pk_bf16_f32 v97, v98, v99
M v[168:171], a[160:163], a[112:115], v[168:171]
v_cvt_pk_bf16_f32 v98, v128, v129
v_cvt_pk_bf16_f32 v99, v130, v131
M v[168:171], a[164:167], a[116:119], v[168:171]
s_add_u32 m0, s30, 98304
s_nop 0
buffer_load_dwordx4 v6, s[12:15], s25 offen offset:0 lds
v_cvt_pk_bf16_f32 v128, v112, v113
M v[172:175], a[164:167], a[124:127], v[172:175]
s_add_u32 s94, s92, 0
buffer_store_dwordx4 v[56:59], v1, s[16:19], s94 offen offset:3072 sc1
v_cvt_pk_bf16_f32 v129, v114, v115
v_cvt_pk_bf16_f32 v130, v144, v145
M v[172:175], a[160:163], a[120:123], v[172:175]
v_cvt_pk_bf16_f32 v131, v146, v147
M v[176:179], a[160:163], a[128:131], v[176:179]
v_cvt_pk_bf16_f32 v112, v104, v105
v_cvt_pk_bf16_f32 v113, v106, v107
M v[176:179], a[164:167], a[132:135], v[176:179]
buffer_load_dwordx4 v7, s[12:15], s25 offen offset:1024 lds
v_cvt_pk_bf16_f32 v114, v136, v137
v_cvt_pk_bf16_f32 v115, v138, v139
M v[180:183], a[164:167], a[140:143], v[180:183]
s_add_u32 s94, s92, 4096
buffer_store_dwordx4 v[64:67], v1, s[16:19], s94 offen offset:0 sc1
v_cvt_pk_bf16_f32 v144, v120, v121
M v[180:183], a[160:163], a[136:139], v[180:183]
v_cvt_pk_bf16_f32 v145, v122, v123
v_cvt_pk_bf16_f32 v146, v152, v153
M v[184:187], a[160:163], a[144:147], v[184:187]
v_cvt_pk_bf16_f32 v147, v154, v155
M v[184:187], a[164:167], a[148:151], v[184:187]
buffer_load_dwordx4 v8, s[12:15], s25 offen offset:2048 lds
v_cvt_pk_bf16_f32 v104, v100, v101
v_cvt_pk_bf16_f32 v105, v102, v103
M v[188:191], a[164:167], a[156:159], v[188:191]
s_add_u32 s94, s92, 4096
buffer_store_dwordx4 v[72:75], v1, s[16:19], s94 offen offset:1024 sc1
v_cvt_pk_bf16_f32 v106, v132, v133
v_cvt_pk_bf16_f32 v107, v134, v135
M v[188:191], a[160:163], a[152:155], v[188:191]
s_waitcnt lgkmcnt(2)
v_cvt_pk_bf16_f32 v136, v116, v117
M v[192:195], a[168:171], a[96:99], v[192:195]
v_cvt_pk_bf16_f32 v137, v118, v119
v_cvt_pk_bf16_f32 v138, v148, v149
M v[192:195], a[172:175], a[100:103], v[192:195]
ds_read_b128 a[184:187], v10 offset:55296
ds_read_b128 a[188:191], v11 offset:55296
v_cvt_pk_bf16_f32 v139, v150, v151
M v[196:199], a[172:175], a[108:111], v[196:199]
s_add_u32 s94, s92, 4096
buffer_store_dwordx4 v[80:83], v1, s[16:19], s94 offen offset:2048 sc1
v_cvt_pk_bf16_f32 v120, v108, v109
v_cvt_pk_bf16_f32 v121, v110, v111
M v[196:199], a[168:171], a[104:107], v[196:199]
v_cvt_pk_bf16_f32 v122, v140, v141
v_cvt_pk_bf16_f32 v123, v142, v143
M v[200:203], a[168:171], a[112:115], v[200:203]
buffer_load_dwordx4 v9, s[12:15], s25 offen offset:3072 lds
v_cvt_pk_bf16_f32 v152, v124, v125
M v[200:203], a[172:175], a[116:119], v[200:203]
v_cvt_pk_bf16_f32 v153, v126, v127
v_cvt_pk_bf16_f32 v154, v156, v157
M v[204:207], a[172:175], a[124:127], v[204:207]
s_add_u32 s94, s92, 4096
buffer_store_dwordx4 v[88:91], v1, s[16:19], s94 offen offset:3072 sc1
v_cvt_pk_bf16_f32 v155, v158, v159
M v[204:207], a[168:171], a[120:123], v[204:207]
M v[208:211], a[168:171], a[128:131], v[208:211]
s_add_u32 m0, s30, 102400
s_nop 0
buffer_load_dwordx4 v21, s[12:15], s25 offen offset:0 lds
M v[208:211], a[172:175], a[132:135], v[208:211]
M v[212:215], a[172:175], a[140:143], v[212:215]
M v[212:215], a[168:171], a[136:139], v[212:215]
buffer_load_dwordx4 v22, s[12:15], s25 offen offset:1024 lds
M v[216:219], a[168:171], a[144:147], v[216:219]
s_add_u32 s94, s92, 8192
buffer_store_dwordx4 v[96:99], v1, s[16:19], s94 offen offset:0 sc1
M v[216:219], a[172:175], a[148:151], v[216:219]
M v[220:223], a[172:175], a[156:159], v[220:223]
M v[220:223], a[168:171], a[152:155], v[220:223]
s_waitcnt lgkmcnt(2)
M v[224:227], a[176:179], a[96:99], v[224:227]
s_sub_u32 s54, s54, 1
s_cmp_eq_u32 s54, 0
s_cselect_b32 s58, s55, s56
s_add_u32 s25, s25, s58
M v[224:227], a[180:183], a[100:103], v[224:227]
M v[228:231], a[180:183], a[108:111], v[228:231]
s_add_u32 s94, s92, 8192
buffer_store_dwordx4 v[104:107], v1, s[16:19], s94 offen offset:1024 sc1
M v[228:231], a[176:179], a[104:107], v[228:231]
v_cvt_pk_bf16_f32 v160, v160, v161
v_cvt_pk_bf16_f32 v161, v162, v163
M v[232:235], a[176:179], a[112:115], v[232:235]
v_cvt_pk_bf16_f32 v162, v192, v193
v_cvt_pk_bf16_f32 v163, v194, v195
M v[232:235], a[180:183], a[116:119], v[232:235]
v_cvt_pk_bf16_f32 v192, v176, v177
M v[236:239], a[180:183], a[124:127], v[236:239]
v_cvt_pk_bf16_f32 v193, v178, v179
v_cvt_pk_bf16_f32 v194, v208, v209
M v[236:239], a[176:179], a[120:123], v[236:239]
s_waitcnt vmcnt(63) lgkmcnt(0)
s_barrier
v_cvt_pk_bf16_f32 v195, v210, v211
M v[240:243], a[176:179], a[128:131], v[240:243]
s_add_u32 s94, s92, 8192
buffer_store_dwordx4 v[112:115], v1, s[16:19], s94 offen offset:2048 sc1
v_cvt_pk_bf16_f32 v176, v168, v169
v_cvt_pk_bf16_f32 v177, v170, v171
M v[240:243], a[180:183], a[132:135], v[240:243]
s_add_u32 m0, s28, 18432
s_nop 0
buffer_load_dword v20, s[8:11], s24 offen lds
v_cvt_pk_bf16_f32 v178, v200, v201
v_cvt_pk_bf16_f32 v179, v202, v203
M v[244:247], a[180:183], a[140:143], v[244:247]
v_cvt_pk_bf16_f32 v208, v184, v185
M v[244:247], a[176:179], a[136:139], v[244:247]
v_cvt_pk_bf16_f32 v209, v186, v187
v_cvt_pk_bf16_f32 v210, v216, v217
M v[248:251], a[176:179], a[144:147], v[248:251]
buffer_load_dword v23, s[8:11], s24 offen offset:256 lds
v_cvt_pk_bf16_f32 v211, v218, v219
M v[248:251], a[180:183], a[148:151], v[248:251]
v_cvt_pk_bf16_f32 v168, v164, v165
v_cvt_pk_bf16_f32 v169, v166, v167
M v[252:255], a[180:183], a[156:159], v[252:255]
s_add_u32 s94, s92, 8192
buffer_store_dwordx4 v[120:123], v1, s[16:19], s94 offen offset:3072 sc1
v_cvt_pk_bf16_f32 v170, v196, v197
v_cvt_pk_bf16_f32 v171, v198, v199
M v[252:255], a[176:179], a[152:155], v[252:255]
v_cvt_pk_bf16_f32 v200, v180, v181
M a[0:3], a[184:187], a[96:99], a[0:3]
v_cvt_pk_bf16_f32 v201, v182, v183
v_cvt_pk_bf16_f32 v202, v212, v213
M a[0:3], a[188:191], a[100:103], a[0:3]
s_add_u32 m0, s29, 20480
s_nop 0
buffer_load_dwordx4 v2, s[8:11], s23 offen offset:0 lds
v_cvt_pk_bf16_f32 v203, v214, v215
M a[4:7], a[188:191], a[108:111], a[4:7]
v_cvt_pk_bf16_f32 v184, v172, v173
v_cvt_pk_bf16_f32 v185, v174, v175
M a[4:7], a[184:187], a[104:107], a[4:7]
v_cvt_pk_bf16_f32 v186, v204, v205
v_cvt_pk_bf16_f32 v187, v206, v207
M a[8:11], a[184:187], a[112:115], a[8:11]
s_add_u32 s94, s92, 12288
buffer_store_dwordx4 v[128:131], v1, s[16:19], s94 offen offset:0 sc1
v_cvt_pk_bf16_f32 v216, v188, v189
M a[8:11], a[188:191], a[116:119], a[8:11]
buffer_load_dwordx4 v3, s[8:11], s23 offen offset:1024 lds
v_cvt_pk_bf16_f32 v217, v190, v191
v_cvt_pk_bf16_f32 v218, v220, v221
M a[12:15], a[188:191], a[124:127], a[12:15]
v_cvt_pk_bf16_f32 v219, v222, v223
M a[12:15], a[184:187], a[120:123], a[12:15]
M a[16:19], a[184:187], a[128:131], a[16:19]
buffer_load_dwordx4 v4, s[8:11], s23 offen offset:2048 lds
M a[16:19], a[188:191], a[132:135], a[16:19]
M a[20:23], a[188:191], a[140:143], a[20:23]
s_add_u32 s94, s92, 12288
buffer_store_dwordx4 v[136:139], v1, s[16:19], s94 offen offset:1024 sc1
M a[20:23], a[184:187], a[136:139], a[20:23]
M a[24:27], a[184:187], a[144:147], a[24:27]
buffer_load_dwordx4 v5, s[8:11], s23 offen offset:3072 lds
M a[24:27], a[188:191], a[148:151], a[24:27]
M a[28:31], a[188:191], a[156:159], a[28:31]
M a[28:31], a[184:187], a[152:155], a[28:31]
v_accvgpr_read_b32 v24, a0
v_accvgpr_read_b32 v25, a1
v_accvgpr_read_b32 v26, a2
v_accvgpr_read_b32 v27, a3
v_cvt_pk_bf16_f32 v224, v224, v225
v_cvt_pk_bf16_f32 v225, v226, v227
v_cvt_pk_bf16_f32 v226, v24, v25
v_cvt_pk_bf16_f32 v227, v26, v27
v_accvgpr_read_b32 v24, a16
v_accvgpr_read_b32 v25, a17
v_accvgpr_read_b32 v26, a18
v_accvgpr_read_b32 v27, a19
v_cvt_pk_bf16_f32 v36, v240, v241
v_cvt_pk_bf16_f32 v37, v242, v243
v_cvt_pk_bf16_f32 v38, v24, v25
v_cvt_pk_bf16_f32 v39, v26, v27
v_accvgpr_read_b32 v24, a24
v_accvgpr_read_b32 v25, a25
v_accvgpr_read_b32 v26, a26
v_accvgpr_read_b32 v27, a27
v_cvt_pk_bf16_f32 v52, v248, v249
v_cvt_pk_bf16_f32 v53, v250, v251
v_cvt_pk_bf16_f32 v54, v24, v25
v_cvt_pk_bf16_f32 v55, v26, v27
v_accvgpr_read_b32 v24, a8
v_accvgpr_read_b32 v25, a9
v_accvgpr_read_b32 v26, a10
v_accvgpr_read_b32 v27, a11
v_cvt_pk_bf16_f32 v240, v232, v233
v_cvt_pk_bf16_f32 v241, v234, v235
v_cvt_pk_bf16_f32 v242, v24, v25
v_cvt_pk_bf16_f32 v243, v26, v27
v_accvgpr_read_b32 v28, a4
v_accvgpr_read_b32 v29, a5
v_accvgpr_read_b32 v30, a6
v_accvgpr_read_b32 v31, a7
v_cvt_pk_bf16_f32 v232, v228, v229
v_cvt_pk_bf16_f32 v233, v230, v231
v_cvt_pk_bf16_f32 v234, v28, v29
v_cvt_pk_bf16_f32 v235, v30, v31
v_accvgpr_read_b32 v28, a12
v_accvgpr_read_b32 v29, a13
v_accvgpr_read_b32 v30, a14
v_accvgpr_read_b32 v31, a15
v_cvt_pk_bf16_f32 v248, v236, v237
v_cvt_pk_bf16_f32 v249, v238, v239
v_cvt_pk_bf16_f32 v250, v28, v29
v_cvt_pk_bf16_f32 v251, v30, v31
v_accvgpr_read_b32 v28, a20
v_accvgpr_read_b32 v29, a21
v_accvgpr_read_b32 v30, a22
v_accvgpr_read_b32 v31, a23
v_cvt_pk_bf16_f32 v44, v244, v245
v_cvt_pk_bf16_f32 v45, v246, v247
v_cvt_pk_bf16_f32 v46, v28, v29
v_cvt_pk_bf16_f32 v47, v30, v31
v_accvgpr_read_b32 v28, a28
v_accvgpr_read_b32 v29, a29
v_accvgpr_read_b32 v30, a30
v_accvgpr_read_b32 v31, a31
v_cvt_pk_bf16_f32 v60, v252, v253
v_cvt_pk_bf16_f32 v61, v254, v255
v_cvt_pk_bf16_f32 v62, v28, v29
v_cvt_pk_bf16_f32 v63, v30, v31
Lk1_b:
v_and_b32 v24, 15, v0
v_lshlrev_b32 v24, 7, v24
v_bfe_u32 v25, v0, 1, 3
v_lshrrev_b32 v26, 4, v0
v_xor_b32 v25, v25, v26
v_lshl_add_u32 v10, v25, 4, v24
v_xor_b32 v11, 64, v10
v_add_u32 v12, 131072, v10
v_add_u32 v13, 131072, v11
v_bfe_u32 v24, v0, 2, 2
v_lshl_add_u32 v29, v26, 3, v24
v_mul_u32_u24 v25, 384, v29
v_and_b32 v27, 1, v0
v_lshl_add_u32 v25, v27, 3, v25
v_add_u32 v25, 36864, v25
v_lshrrev_b32 v24, 1, v29
v_and_b32 v24, 4, v24
v_and_or_b32 v24, v29, 2, v24
v_bfe_u32 v26, v0, 1, 1
s_mul_i32 s4, s20, 3
s_add_u32 s3, s4, 0
s_and_b32 s5, s3, 3
s_lshl_b32 s5, s5, 1
s_lshr_b32 s3, s3, 2
s_lshl_b32 s3, s3, 7
v_add_u32 v27, s5, v26
v_xor_b32 v27, v27, v24
v_lshl_add_u32 v27, v27, 4, v25
v_add_u32 v14, s3, v27
v_add_u32 v17, 61440, v14
s_add_u32 s3, s4, 1
s_and_b32 s5, s3, 3
s_lshl_b32 s5, s5, 1
s_lshr_b32 s3, s3, 2
s_lshl_b32 s3, s3, 7
v_add_u32 v27, s5, v26
v_xor_b32 v27, v27, v24
v_lshl_add_u32 v27, v27, 4, v25
v_add_u32 v15, s3, v27
v_add_u32 v18, 61440, v15
s_add_u32 s3, s4, 2
s_and_b32 s5, s3, 3
s_lshl_b32 s5, s5, 1
s_lshr_b32 s3, s3, 2
s_lshl_b32 s3, s3, 7
v_add_u32 v27, s5, v26
v_xor_b32 v27, v27, v24
v_lshl_add_u32 v27, v27, 4, v25
v_add_u32 v16, s3, v27
v_add_u32 v19, 61440, v16
s_waitcnt vmcnt(11)
s_barrier
ds_read_b64_tr_b16 a[176:177], v14 offset:28672
ds_read_b64_tr_b16 a[178:179], v14 offset:30208
ds_read_b64_tr_b16 a[184:185], v15 offset:28672
ds_read_b64_tr_b16 a[186:187], v15 offset:30208
ds_read_b64_tr_b16 a[192:193], v16 offset:28672
ds_read_b64_tr_b16 a[194:195], v16 offset:30208
ds_read_b64_tr_b16 a[180:181], v14 offset:40960
ds_read_b64_tr_b16 a[182:183], v14 offset:42496
ds_read_b64_tr_b16 a[188:189], v15 offset:40960
ds_read_b64_tr_b16 a[190:191], v15 offset:42496
ds_read_b64_tr_b16 a[196:197], v16 offset:40960
ds_read_b64_tr_b16 a[198:199], v16 offset:42496
ds_read_b128 a[224:227], v12 offset:0
ds_read_b128 a[228:231], v13 offset:0
ds_read_b128 a[232:235], v12 offset:2048
ds_read_b128 a[236:239], v13 offset:2048
ds_read_b128 a[240:243], v12 offset:4096
ds_read_b128 a[244:247], v13 offset:4096
s_waitcnt lgkmcnt(0)
s_barrier
M a[68:71], a[176:179], a[224:227], 0
ds_read_b128 a[248:251], v12 offset:6144
ds_read_b128 a[252:255], v13 offset:6144
M a[68:71], a[180:183], a[228:231], a[68:71]
s_sub_u32 s31, s31, 1
s_cmp_eq_u32 s31, 0
s_cselect_b32 s58, -1920, s57
s_add_u32 s23, s23, s58
s_add_u32 s24, s24, s58
M a[72:75], a[188:191], a[228:231], 0
ds_read_b64_tr_b16 a[200:201], v17 offset:0
ds_read_b64_tr_b16 a[202:203], v17 offset:1536
M a[72:75], a[184:187], a[224:227], a[72:75]
s_add_u32 m0, s30, 36864
s_nop 0
buffer_load_dwordx4 v6, s[12:15], s25 offen offset:0 lds
M a[76:79], a[192:195], a[224:227], 0
M a[76:79], a[196:199], a[228:231], a[76:79]
buffer_load_dwordx4 v7, s[12:15], s25 offen offset:1024 lds
M a[80:83], a[180:183], a[236:239], 0
ds_read_b128 a[224:227], v12 offset:8192
ds_read_b128 a[228:231], v13 offset:8192
M a[80:83], a[176:179], a[232:235], a[80:83]
M a[84:87], a[184:187], a[232:235], 0
ds_read_b64_tr_b16 a[208:209], v18 offset:0
ds_read_b64_tr_b16 a[210:211], v18 offset:1536
M a[84:87], a[188:191], a[236:239], a[84:87]
buffer_load_dwordx4 v8, s[12:15], s25 offen offset:2048 lds
M a[88:91], a[196:199], a[236:239], 0
M a[88:91], a[192:195], a[232:235], a[88:91]
buffer_load_dwordx4 v9, s[12:15], s25 offen offset:3072 lds
M a[92:95], a[176:179], a[240:243], 0
ds_read_b128 a[232:235], v12 offset:10240
ds_read_b128 a[236:239], v13 offset:10240
M a[92:95], a[180:183], a[244:247], a[92:95]
M a[96:99], a[188:191], a[244:247], 0
ds_read_b64_tr_b16 a[216:217], v19 offset:0
ds_read_b64_tr_b16 a[218:219], v19 offset:1536
M a[96:99], a[184:187], a[240:243], a[96:99]
s_add_u32 m0, s30, 40960
s_nop 0
buffer_load_dwordx4 v21, s[12:15], s25 offen offset:0 lds
M a[100:103], a[192:195], a[240:243], 0
buffer_load_dwordx4 v22, s[12:15], s25 offen offset:1024 lds
M a[100:103], a[196:199], a[244:247], a[100:103]
s_waitcnt lgkmcnt(10)
M a[104:107], a[180:183], a[252:255], 0
ds_read_b128 a[240:243], v12 offset:12288
ds_read_b128 a[244:247], v13 offset:12288
M a[104:107], a[176:179], a[248:251], a[104:107]
s_sub_u32 s54, s54, 1
s_cmp_eq_u32 s54, 0
s_cselect_b32 s58, s55, s56
s_add_u32 s25, s25, s58
M a[108:111], a[184:187], a[248:251], 0
ds_read_b64_tr_b16 a[204:205], v17 offset:12288
ds_read_b64_tr_b16 a[206:207], v17 offset:13824
M a[108:111], a[188:191], a[252:255], a[108:111]
M a[112:115], a[196:199], a[252:255], 0
s_add_u32 m0, s30, 65536
s_nop 0
buffer_load_dwordx4 v6, s[12:15], s25 offen offset:0 lds
M a[112:115], a[192:195], a[248:251], a[112:115]
s_waitcnt lgkmcnt(10)
M a[116:119], a[176:179], a[224:227], 0
ds_read_b128 a[248:251], v12 offset:14336
ds_read_b128 a[252:255], v13 offset:14336
M a[116:119], a[180:183], a[228:231], a[116:119]
buffer_load_dwordx4 v7, s[12:15], s25 offen offset:1024 lds
M a[120:123], a[188:191], a[228:231], 0
ds_read_b64_tr_b16 a[212:213], v18 offset:12288
ds_read_b64_tr_b16 a[214:215], v18 offset:13824
M a[120:123], a[184:187], a[224:227], a[120:123]
M a[124:127], a[192:195], a[224:227], 0
buffer_load_dwordx4 v8, s[12:15], s25 offen offset:2048 lds
M a[124:127], a[196:199], a[228:231], a[124:127]
buffer_load_dwordx4 v9, s[12:15], s25 offen offset:3072 lds
s_waitcnt lgkmcnt(10)
M a[128:131], a[180:183], a[236:239], 0
ds_read_b128 a[224:227], v12 offset:16384
ds_read_b128 a[228:231], v13 offset:16384
M a[128:131], a[176:179], a[232:235], a[128:131]
M a[132:135], a[184:187], a[232:235], 0
ds_read_b64_tr_b16 a[220:221], v19 offset:12288
ds_read_b64_tr_b16 a[222:223], v19 offset:13824
M a[132:135], a[188:191], a[236:239], a[132:135]
s_add_u32 m0, s30, 69632
s_nop 0
buffer_load_dwordx4 v21, s[12:15], s25 offen offset:0 lds
M a[136:139], a[196:199], a[236:239], 0
M a[136:139], a[192:195], a[232:235], a[136:139]
buffer_load_dwordx4 v22, s[12:15], s25 offen offset:1024 lds
s_waitcnt lgkmcnt(10)
M a[140:143], a[176:179], a[240:243], 0
M a[140:143], a[180:183], a[244:247], a[140:143]
s_sub_u32 s54, s54, 1
s_cmp_eq_u32 s54, 0
s_cselect_b32 s58, s55, s56
s_add_u32 s25, s25, s58
M a[144:147], a[188:191], a[244:247], 0
M a[144:147], a[184:187], a[240:243], a[144:147]
M a[148:151], a[192:195], a[240:243], 0
s_waitcnt vmcnt(6) lgkmcnt(0)
s_barrier
ds_read_b128 a[232:235], v10 offset:0
ds_read_b128 a[236:239], v11 offset:0
M a[148:151], a[196:199], a[244:247], a[148:151]
s_add_u32 m0, s28, 131072
s_nop 0
buffer_load_dword v20, s[8:11], s24 offen lds
M a[152:155], a[180:183], a[252:255], 0
ds_read_b128 a[240:243], v10 offset:2048
ds_read_b128 a[244:247], v11 offset:2048
M a[152:155], a[176:179], a[248:251], a[152:155]
M a[156:159], a[184:187], a[248:251], 0
buffer_load_dword v23, s[8:11], s24 offen offset:256 lds
M a[156:159], a[188:191], a[252:255], a[156:159]
M a[160:163], a[196:199], a[252:255], 0
M a[160:163], a[192:195], a[248:251], a[160:163]
s_add_u32 m0, s29, 133120
s_nop 0
buffer_load_dwordx4 v2, s[8:11], s23 offen offset:0 lds
M a[164:167], a[176:179], a[224:227], 0
ds_read_b128 a[248:251], v10 offset:4096
ds_read_b128 a[252:255], v11 offset:4096
M a[164:167], a[180:183], a[228:231], a[164:167]
M a[168:171], a[188:191], a[228:231], 0
M a[168:171], a[184:187], a[224:227], a[168:171]
buffer_load_dwordx4 v3, s[8:11], s23 offen offset:1024 lds
M a[172:175], a[192:195], a[224:227], 0
M a[172:175], a[196:199], a[228:231], a[172:175]
s_waitcnt lgkmcnt(4)
M a[68:71], a[200:203], a[232:235], a[68:71]
ds_read_b128 a[224:227], v10 offset:6144
ds_read_b128 a[228:231], v11 offset:6144
M a[68:71], a[204:207], a[236:239], a[68:71]
buffer_load_dwordx4 v4, s[8:11], s23 offen offset:2048 lds
M a[72:75], a[212:215], a[236:239], a[72:75]
ds_read_b64_tr_b16 a[176:177], v14 offset:0
ds_read_b64_tr_b16 a[178:179], v14 offset:1536
M a[72:75], a[208:211], a[232:235], a[72:75]
buffer_load_dwordx4 v5, s[8:11], s23 offen offset:3072 lds
M a[76:79], a[216:219], a[232:235], a[76:79]
M a[76:79], a[220:223], a[236:239], a[76:79]
s_sub_u32 s31, s31, 1
s_cmp_eq_u32 s31, 0
s_cselect_b32 s58, -1920, s57
s_add_u32 s23, s23, s58
s_add_u32 s24, s24, s58
s_waitcnt lgkmcnt(6)
M a[80:83], a[204:207], a[244:247], a[80:83]
ds_read_b128 a[232:235], v10 offset:8192
ds_read_b128 a[236:239], v11 offset:8192
M a[80:83], a[200:203], a[240:243], a[80:83]
M a[84:87], a[208:211], a[240:243], a[84:87]
ds_read_b64_tr_b16 a[184:185], v15 offset:0
ds_read_b64_tr_b16 a[186:187], v15 offset:1536
M a[84:87], a[212:215], a[244:247], a[84:87]
s_add_u32 m0, s30, 98304
s_nop 0
buffer_load_dwordx4 v6, s[12:15], s25 offen offset:0 lds
M a[88:91], a[220:223], a[244:247], a[88:91]
M a[88:91], a[216:219], a[240:243], a[88:91]
buffer_load_dwordx4 v7, s[12:15], s25 offen offset:1024 lds
s_waitcnt lgkmcnt(8)
M a[92:95], a[200:203], a[248:251], a[92:95]
ds_read_b128 a[240:243], v10 offset:10240
ds_read_b128 a[244:247], v11 offset:10240
M a[92:95], a[204:207], a[252:255], a[92:95]
M a[96:99], a[212:215], a[252:255], a[96:99]
ds_read_b64_tr_b16 a[192:193], v16 offset:0
ds_read_b64_tr_b16 a[194:195], v16 offset:1536
M a[96:99], a[208:211], a[248:251], a[96:99]
buffer_load_dwordx4 v8, s[12:15], s25 offen offset:2048 lds
M a[100:103], a[216:219], a[248:251], a[100:103]
M a[100:103], a[220:223], a[252:255], a[100:103]
buffer_load_dwordx4 v9, s[12:15], s25 offen offset:3072 lds
s_waitcnt lgkmcnt(10)
M a[104:107], a[204:207], a[228:231], a[104:107]
ds_read_b128 a[248:251], v10 offset:12288
ds_read_b128 a[252:255], v11 offset:12288
M a[104:107], a[200:203], a[224:227], a[104:107]
M a[108:111], a[208:211], a[224:227], a[108:111]
ds_read_b64_tr_b16 a[180:181], v14 offset:12288
ds_read_b64_tr_b16 a[182:183], v14 offset:13824
M a[108:111], a[212:215], a[228:231], a[108:111]
s_add_u32 m0, s30, 102400
s_nop 0
buffer_load_dwordx4 v21, s[12:15], s25 offen offset:0 lds
M a[112:115], a[220:223], a[228:231], a[112:115]
M a[112:115], a[216:219], a[224:227], a[112:115]
buffer_load_dwordx4 v22, s[12:15], s25 offen offset:1024 lds
s_waitcnt lgkmcnt(10)
M a[116:119], a[200:203], a[232:235], a[116:119]
ds_read_b128 a[224:227], v10 offset:14336
ds_read_b128 a[228:231], v11 offset:14336
M a[116:119], a[204:207], a[236:239], a[116:119]
M a[120:123], a[212:215], a[236:239], a[120:123]
ds_read_b64_tr_b16 a[188:189], v15 offset:12288
ds_read_b64_tr_b16 a[190:191], v15 offset:13824
M a[120:123], a[208:211], a[232:235], a[120:123]
s_sub_u32 s54, s54, 1
s_cmp_eq_u32 s54, 0
s_cselect_b32 s58, s55, s56
s_add_u32 s25, s25, s58
M a[124:127], a[216:219], a[232:235], a[124:127]
M a[124:127], a[220:223], a[236:239], a[124:127]
s_add_u32 s94, s92, 12288
buffer_store_dwordx4 v[144:147], v1, s[16:19], s94 offen offset:2048 sc1
s_waitcnt lgkmcnt(10)
M a[128:131], a[204:207], a[244:247], a[128:131]
ds_read_b128 a[232:235], v10 offset:16384
ds_read_b128 a[236:239], v11 offset:16384
M a[128:131], a[200:203], a[240:243], a[128:131]
M a[132:135], a[208:211], a[240:243], a[132:135]
ds_read_b64_tr_b16 a[196:197], v16 offset:12288
ds_read_b64_tr_b16 a[198:199], v16 offset:13824
M a[132:135], a[212:215], a[244:247], a[132:135]
s_add_u32 s94, s92, 12288
buffer_store_dwordx4 v[152:155], v1, s[16:19], s94 offen offset:3072 sc1
M a[136:139], a[220:223], a[244:247], a[136:139]
M a[136:139], a[216:219], a[240:243], a[136:139]
s_add_u32 s94, s93, 0
buffer_store_dwordx4 v[160:163], v1, s[16:19], s94 offen offset:0 sc1
s_waitcnt lgkmcnt(10)
M a[140:143], a[200:203], a[248:251], a[140:143]
M a[140:143], a[204:207], a[252:255], a[140:143]
s_add_u32 s94, s93, 0
buffer_store_dwordx4 v[168:171], v1, s[16:19], s94 offen offset:1024 sc1
M a[144:147], a[212:215], a[252:255], a[144:147]
M a[144:147], a[208:211], a[248:251], a[144:147]
M a[148:151], a[216:219], a[248:251], a[148:151]
s_waitcnt vmcnt(16) lgkmcnt(0)
s_barrier
ds_read_b128 a[240:243], v10 offset:18432
ds_read_b128 a[244:247], v11 offset:18432
M a[148:151], a[220:223], a[252:255], a[148:151]
s_add_u32 m0, s28, 0
s_nop 0
buffer_load_dword v20, s[8:11], s24 offen lds
M a[152:155], a[204:207], a[228:231], a[152:155]
ds_read_b128 a[248:251], v10 offset:20480
ds_read_b128 a[252:255], v11 offset:20480
M a[152:155], a[200:203], a[224:227], a[152:155]
M a[156:159], a[208:211], a[224:227], a[156:159]
buffer_load_dword v23, s[8:11], s24 offen offset:256 lds
M a[156:159], a[212:215], a[228:231], a[156:159]
M a[160:163], a[220:223], a[228:231], a[160:163]
M a[160:163], a[216:219], a[224:227], a[160:163]
s_add_u32 m0, s29, 2048
s_nop 0
buffer_load_dwordx4 v2, s[8:11], s23 offen offset:0 lds
M a[164:167], a[200:203], a[232:235], a[164:167]
ds_read_b128 a[224:227], v10 offset:22528
ds_read_b128 a[228:231], v11 offset:22528
M a[164:167], a[204:207], a[236:239], a[164:167]
M a[168:171], a[212:215], a[236:239], a[168:171]
M a[168:171], a[208:211], a[232:235], a[168:171]
buffer_load_dwordx4 v3, s[8:11], s23 offen offset:1024 lds
M a[172:175], a[216:219], a[232:235], a[172:175]
M a[172:175], a[220:223], a[236:239], a[172:175]
s_waitcnt lgkmcnt(4)
M a[68:71], a[176:179], a[240:243], a[68:71]
ds_read_b128 a[232:235], v10 offset:24576
ds_read_b128 a[236:239], v11 offset:24576
M a[68:71], a[180:183], a[244:247], a[68:71]
buffer_load_dwordx4 v4, s[8:11], s23 offen offset:2048 lds
M a[72:75], a[188:191], a[244:247], a[72:75]
ds_read_b64_tr_b16 a[200:201], v14 offset:28672
ds_read_b64_tr_b16 a[202:203], v14 offset:30208
M a[72:75], a[184:187], a[240:243], a[72:75]
buffer_load_dwordx4 v5, s[8:11], s23 offen offset:3072 lds
M a[76:79], a[192:195], a[240:243], a[76:79]
M a[76:79], a[196:199], a[244:247], a[76:79]
s_sub_u32 s31, s31, 1
s_cmp_eq_u32 s31, 0
s_cselect_b32 s58, -1920, s57
s_add_u32 s23, s23, s58
s_add_u32 s24, s24, s58
s_waitcnt lgkmcnt(6)
M a[80:83], a[180:183], a[252:255], a[80:83]
ds_read_b128 a[240:243], v10 offset:26624
ds_read_b128 a[244:247], v11 offset:26624
M a[80:83], a[176:179], a[248:251], a[80:83]
M a[84:87], a[184:187], a[248:251], a[84:87]
ds_read_b64_tr_b16 a[208:209], v15 offset:28672
ds_read_b64_tr_b16 a[210:211], v15 offset:30208
M a[84:87], a[188:191], a[252:255], a[84:87]
s_add_u32 m0, s30, 36864
s_nop 0
buffer_load_dwordx4 v6, s[12:15], s25 offen offset:0 lds
M a[88:91], a[196:199], a[252:255], a[88:91]
M a[88:91], a[192:195], a[248:251], a[88:91]
buffer_load_dwordx4 v7, s[12:15], s25 offen offset:1024 lds
s_waitcnt lgkmcnt(8)
M a[92:95], a[176:179], a[224:227], a[92:95]
ds_read_b128 a[248:251], v10 offset:28672
ds_read_b128 a[252:255], v11 offset:28672
M a[92:95], a[180:183], a[228:231], a[92:95]
M a[96:99], a[188:191], a[228:231], a[96:99]
ds_read_b64_tr_b16 a[216:217], v16 offset:28672
ds_read_b64_tr_b16 a[218:219], v16 offset:30208
M a[96:99], a[184:187], a[224:227], a[96:99]
buffer_load_dwordx4 v8, s[12:15], s25 offen offset:2048 lds
M a[100:103], a[192:195], a[224:227], a[100:103]
M a[100:103], a[196:199], a[228:231], a[100:103]
buffer_load_dwordx4 v9, s[12:15], s25 offen offset:3072 lds
s_waitcnt lgkmcnt(10)
M a[104:107], a[180:183], a[236:239], a[104:107]
ds_read_b128 a[224:227], v10 offset:30720
ds_read_b128 a[228:231], v11 offset:30720
M a[104:107], a[176:179], a[232:235], a[104:107]
M a[108:111], a[184:187], a[232:235], a[108:111]
ds_read_b64_tr_b16 a[204:205], v14 offset:40960
ds_read_b64_tr_b16 a[206:207], v14 offset:42496
M a[108:111], a[188:191], a[236:239], a[108:111]
s_add_u32 m0, s30, 40960
s_nop 0
buffer_load_dwordx4 v21, s[12:15], s25 offen offset:0 lds
M a[112:115], a[196:199], a[236:239], a[112:115]
M a[112:115], a[192:195], a[232:235], a[112:115]
buffer_load_dwordx4 v22, s[12:15], s25 offen offset:1024 lds
s_waitcnt lgkmcnt(10)
M a[116:119], a[176:179], a[240:243], a[116:119]
ds_read_b128 a[232:235], v10 offset:32768
ds_read_b128 a[236:239], v11 offset:32768
M a[116:119], a[180:183], a[244:247], a[116:119]
M a[120:123], a[188:191], a[244:247], a[120:123]
ds_read_b64_tr_b16 a[212:213], v15 offset:40960
ds_read_b64_tr_b16 a[214:215], v15 offset:42496
M a[120:123], a[184:187], a[240:243], a[120:123]
s_sub_u32 s54, s54, 1
s_cmp_eq_u32 s54, 0
s_cselect_b32 s58, s55, s56
s_add_u32 s25, s25, s58
M a[124:127], a[192:195], a[240:243], a[124:127]
M a[124:127], a[196:199], a[244:247], a[124:127]
s_add_u32 s94, s93, 0
buffer_store_dwordx4 v[176:179], v1, s[16:19], s94 offen offset:2048 sc1
s_waitcnt lgkmcnt(10)
M a[128:131], a[180:183], a[252:255], a[128:131]
ds_read_b128 a[240:243], v10 offset:34816
ds_read_b128 a[244:247], v11 offset:34816
M a[128:131], a[176:179], a[248:251], a[128:131]
M a[132:135], a[184:187], a[248:251], a[132:135]
ds_read_b64_tr_b16 a[220:221], v16 offset:40960
ds_read_b64_tr_b16 a[222:223], v16 offset:42496
M a[132:135], a[188:191], a[252:255], a[132:135]
s_add_u32 s94, s93, 0
buffer_store_dwordx4 v[184:187], v1, s[16:19], s94 offen offset:3072 sc1
M a[136:139], a[196:199], a[252:255], a[136:139]
M a[136:139], a[192:195], a[248:251], a[136:139]
s_add_u32 s94, s93, 4096
buffer_store_dwordx4 v[192:195], v1, s[16:19], s94 offen offset:0 sc1
s_waitcnt lgkmcnt(10)
M a[140:143], a[176:179], a[224:227], a[140:143]
M a[140:143], a[180:183], a[228:231], a[140:143]
s_add_u32 s94, s93, 4096
buffer_store_dwordx4 v[200:203], v1, s[16:19], s94 offen offset:1024 sc1
M a[144:147], a[188:191], a[228:231], a[144:147]
M a[144:147], a[184:187], a[224:227], a[144:147]
M a[148:151], a[192:195], a[224:227], a[148:151]
s_waitcnt vmcnt(20) lgkmcnt(0)
s_barrier
ds_read_b128 a[248:251], v12 offset:0
ds_read_b128 a[252:255], v13 offset:0
M a[148:151], a[196:199], a[228:231], a[148:151]
s_add_u32 m0, s28, 18432
s_nop 0
buffer_load_dword v20, s[8:11], s24 offen lds
M a[152:155], a[180:183], a[236:239], a[152:155]
ds_read_b128 a[224:227], v12 offset:2048
ds_read_b128 a[228:231], v13 offset:2048
M a[152:155], a[176:179], a[232:235], a[152:155]
M a[156:159], a[184:187], a[232:235], a[156:159]
buffer_load_dword v23, s[8:11], s24 offen offset:256 lds
M a[156:159], a[188:191], a[236:239], a[156:159]
M a[160:163], a[196:199], a[236:239], a[160:163]
M a[160:163], a[192:195], a[232:235], a[160:163]
s_add_u32 m0, s29, 20480
s_nop 0
buffer_load_dwordx4 v2, s[8:11], s23 offen offset:0 lds
M a[164:167], a[176:179], a[240:243], a[164:167]
ds_read_b128 a[232:235], v12 offset:4096
ds_read_b128 a[236:239], v13 offset:4096
M a[164:167], a[180:183], a[244:247], a[164:167]
M a[168:171], a[188:191], a[244:247], a[168:171]
M a[168:171], a[184:187], a[240:243], a[168:171]
buffer_load_dwordx4 v3, s[8:11], s23 offen offset:1024 lds
M a[172:175], a[192:195], a[240:243], a[172:175]
M a[172:175], a[196:199], a[244:247], a[172:175]
s_waitcnt lgkmcnt(4)
M a[68:71], a[200:203], a[248:251], a[68:71]
ds_read_b128 a[240:243], v12 offset:6144
ds_read_b128 a[244:247], v13 offset:6144
M a[68:71], a[204:207], a[252:255], a[68:71]
buffer_load_dwordx4 v4, s[8:11], s23 offen offset:2048 lds
M a[72:75], a[212:215], a[252:255], a[72:75]
ds_read_b64_tr_b16 a[176:177], v17 offset:0
ds_read_b64_tr_b16 a[178:179], v17 offset:1536
M a[72:75], a[208:211], a[248:251], a[72:75]
buffer_load_dwordx4 v5, s[8:11], s23 offen offset:3072 lds
M a[76:79], a[216:219], a[248:251], a[76:79]
M a[76:79], a[220:223], a[252:255], a[76:79]
s_sub_u32 s31, s31, 1
s_cmp_eq_u32 s31, 0
s_cselect_b32 s58, -1920, s57
s_add_u32 s23, s23, s58
s_add_u32 s24, s24, s58
s_waitcnt lgkmcnt(6)
M a[80:83], a[204:207], a[228:231], a[80:83]
ds_read_b128 a[248:251], v12 offset:8192
ds_read_b128 a[252:255], v13 offset:8192
M a[80:83], a[200:203], a[224:227], a[80:83]
M a[84:87], a[208:211], a[224:227], a[84:87]
ds_read_b64_tr_b16 a[184:185], v18 offset:0
ds_read_b64_tr_b16 a[186:187], v18 offset:1536
M a[84:87], a[212:215], a[228:231], a[84:87]
s_add_u32 m0, s30, 65536
s_nop 0
buffer_load_dwordx4 v6, s[12:15], s25 offen offset:0 lds
M a[88:91], a[220:223], a[228:231], a[88:91]
M a[88:91], a[216:219], a[224:227], a[88:91]
buffer_load_dwordx4 v7, s[12:15], s25 offen offset:1024 lds
s_waitcnt lgkmcnt(8)
M a[92:95], a[200:203], a[232:235], a[92:95]
ds_read_b128 a[224:227], v12 offset:10240
ds_read_b128 a[228:231], v13 offset:10240
M a[92:95], a[204:207], a[236:239], a[92:95]
M a[96:99], a[212:215], a[236:239], a[96:99]
ds_read_b64_tr_b16 a[192:193], v19 offset:0
ds_read_b64_tr_b16 a[194:195], v19 offset:1536
M a[96:99], a[208:211], a[232:235], a[96:99]
buffer_load_dwordx4 v8, s[12:15], s25 offen offset:2048 lds
M a[100:103], a[216:219], a[232:235], a[100:103]
M a[100:103], a[220:223], a[236:239], a[100:103]
buffer_load_dwordx4 v9, s[12:15], s25 offen offset:3072 lds
s_waitcnt lgkmcnt(10)
M a[104:107], a[204:207], a[244:247], a[104:107]
ds_read_b128 a[232:235], v12 offset:12288
ds_read_b128 a[236:239], v13 offset:12288
M a[104:107], a[200:203], a[240:243], a[104:107]
M a[108:111], a[208:211], a[240:243], a[108:111]
ds_read_b64_tr_b16 a[180:181], v17 offset:12288
ds_read_b64_tr_b16 a[182:183], v17 offset:13824
M a[108:111], a[212:215], a[244:247], a[108:111]
s_add_u32 m0, s30, 69632
s_nop 0
buffer_load_dwordx4 v21, s[12:15], s25 offen offset:0 lds
M a[112:115], a[220:223], a[244:247], a[112:115]
M a[112:115], a[216:219], a[240:243], a[112:115]
buffer_load_dwordx4 v22, s[12:15], s25 offen offset:1024 lds
s_waitcnt lgkmcnt(10)
M a[116:119], a[200:203], a[248:251], a[116:119]
ds_read_b128 a[240:243], v12 offset:14336
ds_read_b128 a[244:247], v13 offset:14336
M a[116:119], a[204:207], a[252:255], a[116:119]
M a[120:123], a[212:215], a[252:255], a[120:123]
ds_read_b64_tr_b16 a[188:189], v18 offset:12288
ds_read_b64_tr_b16 a[190:191], v18 offset:13824
M a[120:123], a[208:211], a[248:251], a[120:123]
s_sub_u32 s54, s54, 1
s_cmp_eq_u32 s54, 0
s_cselect_b32 s58, s55, s56
s_add_u32 s25, s25, s58
M a[124:127], a[216:219], a[248:251], a[124:127]
M a[124:127], a[220:223], a[252:255], a[124:127]
s_add_u32 s94, s93, 4096
buffer_store_dwordx4 v[208:211], v1, s[16:19], s94 offen offset:2048 sc1
s_waitcnt lgkmcnt(10)
M a[128:131], a[204:207], a[228:231], a[128:131]
ds_read_b128 a[248:251], v12 offset:16384
ds_read_b128 a[252:255], v13 offset:16384
M a[128:131], a[200:203], a[224:227], a[128:131]
M a[132:135], a[208:211], a[224:227], a[132:135]
ds_read_b64_tr_b16 a[196:197], v19 offset:12288
ds_read_b64_tr_b16 a[198:199], v19 offset:13824
M a[132:135], a[212:215], a[228:231], a[132:135]
s_add_u32 s94, s93, 4096
buffer_store_dwordx4 v[216:219], v1, s[16:19], s94 offen offset:3072 sc1
M a[136:139], a[220:223], a[228:231], a[136:139]
M a[136:139], a[216:219], a[224:227], a[136:139]
s_add_u32 s94, s93, 8192
buffer_store_dwordx4 v[224:227], v1, s[16:19], s94 offen offset:0 sc1
s_waitcnt lgkmcnt(10)
M a[140:143], a[200:203], a[232:235], a[140:143]
M a[140:143], a[204:207], a[236:239], a[140:143]
s_add_u32 s94, s93, 8192
buffer_store_dwordx4 v[232:235], v1, s[16:19], s94 offen offset:1024 sc1
M a[144:147], a[212:215], a[236:239], a[144:147]
M a[144:147], a[208:211], a[232:235], a[144:147]
M a[148:151], a[216:219], a[232:235], a[148:151]
s_waitcnt vmcnt(20) lgkmcnt(0)
s_barrier
ds_read_b128 a[224:227], v10 offset:0
ds_read_b128 a[228:231], v11 offset:0
M a[148:151], a[220:223], a[236:239], a[148:151]
s_add_u32 m0, s28, 131072
s_nop 0
buffer_load_dword v20, s[8:11], s24 offen lds
M a[152:155], a[204:207], a[244:247], a[152:155]
ds_read_b128 a[232:235], v10 offset:2048
ds_read_b128 a[236:239], v11 offset:2048
M a[152:155], a[200:203], a[240:243], a[152:155]
M a[156:159], a[208:211], a[240:243], a[156:159]
buffer_load_dword v23, s[8:11], s24 offen offset:256 lds
M a[156:159], a[212:215], a[244:247], a[156:159]
M a[160:163], a[220:223], a[244:247], a[160:163]
M a[160:163], a[216:219], a[240:243], a[160:163]
s_add_u32 m0, s29, 133120
s_nop 0
buffer_load_dwordx4 v2, s[8:11], s23 offen offset:0 lds
M a[164:167], a[200:203], a[248:251], a[164:167]
ds_read_b128 a[240:243], v10 offset:4096
ds_read_b128 a[244:247], v11 offset:4096
M a[164:167], a[204:207], a[252:255], a[164:167]
M a[168:171], a[212:215], a[252:255], a[168:171]
M a[168:171], a[208:211], a[248:251], a[168:171]
buffer_load_dwordx4 v3, s[8:11], s23 offen offset:1024 lds
M a[172:175], a[216:219], a[248:251], a[172:175]
M a[172:175], a[220:223], a[252:255], a[172:175]
s_waitcnt lgkmcnt(4)
M a[68:71], a[176:179], a[224:227], a[68:71]
ds_read_b128 a[248:251], v10 offset:6144
ds_read_b128 a[252:255], v11 offset:6144
M a[68:71], a[180:183], a[228:231], a[68:71]
buffer_load_dwordx4 v4, s[8:11], s23 offen offset:2048 lds
M a[72:75], a[188:191], a[228:231], a[72:75]
ds_read_b64_tr_b16 a[200:201], v14 offset:0
ds_read_b64_tr_b16 a[202:203], v14 offset:1536
M a[72:75], a[184:187], a[224:227], a[72:75]
buffer_load_dwordx4 v5, s[8:11], s23 offen offset:3072 lds
M a[76:79], a[192:195], a[224:227], a[76:79]
M a[76:79], a[196:199], a[228:231], a[76:79]
s_sub_u32 s31, s31, 1
s_cmp_eq_u32 s31, 0
s_cselect_b32 s58, -1920, s57
s_add_u32 s23, s23, s58
s_add_u32 s24, s24, s58
s_waitcnt lgkmcnt(6)
M a[80:83], a[180:183], a[236:239], a[80:83]
ds_read_b128 a[224:227], v10 offset:8192
ds_read_b128 a[228:231], v11 offset:8192
M a[80:83], a[176:179], a[232:235], a[80:83]
M a[84:87], a[184:187], a[232:235], a[84:87]
ds_read_b64_tr_b16 a[208:209], v15 offset:0
ds_read_b64_tr_b16 a[210:211], v15 offset:1536
M a[84:87], a[188:191], a[236:239], a[84:87]
s_add_u32 m0, s30, 98304
s_nop 0
buffer_load_dwordx4 v6, s[12:15], s25 offen offset:0 lds
M a[88:91], a[196:199], a[236:239], a[88:91]
M a[88:91], a[192:195], a[232:235], a[88:91]
buffer_load_dwordx4 v7, s[12:15], s25 offen offset:1024 lds
s_waitcnt lgkmcnt(8)
M a[92:95], a[176:179], a[240:243], a[92:95]
ds_read_b128 a[232:235], v10 offset:10240
ds_read_b128 a[236:239], v11 offset:10240
M a[92:95], a[180:183], a[244:247], a[92:95]
M a[96:99], a[188:191], a[244:247], a[96:99]
ds_read_b64_tr_b16 a[216:217], v16 offset:0
ds_read_b64_tr_b16 a[218:219], v16 offset:1536
M a[96:99], a[184:187], a[240:243], a[96:99]
buffer_load_dwordx4 v8, s[12:15], s25 offen offset:2048 lds
M a[100:103], a[192:195], a[240:243], a[100:103]
M a[100:103], a[196:199], a[244:247], a[100:103]
buffer_load_dwordx4 v9, s[12:15], s25 offen offset:3072 lds
s_waitcnt lgkmcnt(10)
M a[104:107], a[180:183], a[252:255], a[104:107]
ds_read_b128 a[240:243], v10 offset:12288
ds_read_b128 a[244:247], v11 offset:12288
M a[104:107], a[176:179], a[248:251], a[104:107]
M a[108:111], a[184:187], a[248:251], a[108:111]
ds_read_b64_tr_b16 a[204:205], v14 offset:12288
ds_read_b64_tr_b16 a[206:207], v14 offset:13824
M a[108:111], a[188:191], a[252:255], a[108:111]
s_add_u32 m0, s30, 102400
s_nop 0
buffer_load_dwordx4 v21, s[12:15], s25 offen offset:0 lds
M a[112:115], a[196:199], a[252:255], a[112:115]
M a[112:115], a[192:195], a[248:251], a[112:115]
buffer_load_dwordx4 v22, s[12:15], s25 offen offset:1024 lds
s_waitcnt lgkmcnt(10)
M a[116:119], a[176:179], a[224:227], a[116:119]
ds_read_b128 a[248:251], v10 offset:14336
ds_read_b128 a[252:255], v11 offset:14336
M a[116:119], a[180:183], a[228:231], a[116:119]
M a[120:123], a[188:191], a[228:231], a[120:123]
ds_read_b64_tr_b16 a[212:213], v15 offset:12288
ds_read_b64_tr_b16 a[214:215], v15 offset:13824
M a[120:123], a[184:187], a[224:227], a[120:123]
s_sub_u32 s54, s54, 1
s_cmp_eq_u32 s54, 0
s_cselect_b32 s58, s55, s56
s_add_u32 s25, s25, s58
M a[124:127], a[192:195], a[224:227], a[124:127]
M a[124:127], a[196:199], a[228:231], a[124:127]
s_add_u32 s94, s93, 8192
buffer_store_dwordx4 v[240:243], v1, s[16:19], s94 offen offset:2048 sc1
s_waitcnt lgkmcnt(10)
M a[128:131], a[180:183], a[236:239], a[128:131]
ds_read_b128 a[224:227], v10 offset:16384
ds_read_b128 a[228:231], v11 offset:16384
M a[128:131], a[176:179], a[232:235], a[128:131]
M a[132:135], a[184:187], a[232:235], a[132:135]
ds_read_b64_tr_b16 a[220:221], v16 offset:12288
ds_read_b64_tr_b16 a[222:223], v16 offset:13824
M a[132:135], a[188:191], a[236:239], a[132:135]
s_add_u32 s94, s93, 8192
buffer_store_dwordx4 v[248:251], v1, s[16:19], s94 offen offset:3072 sc1
M a[136:139], a[196:199], a[236:239], a[136:139]
M a[136:139], a[192:195], a[232:235], a[136:139]
s_add_u32 s94, s93, 12288
buffer_store_dwordx4 v[36:39], v1, s[16:19], s94 offen offset:0 sc1
s_waitcnt lgkmcnt(10)
M a[140:143], a[176:179], a[240:243], a[140:143]
M a[140:143], a[180:183], a[244:247], a[140:143]
s_add_u32 s94, s93, 12288
buffer_store_dwordx4 v[44:47], v1, s[16:19], s94 offen offset:1024 sc1
M a[144:147], a[188:191], a[244:247], a[144:147]
M a[144:147], a[184:187], a[240:243], a[144:147]
M a[148:151], a[192:195], a[240:243], a[148:151]
s_waitcnt vmcnt(20) lgkmcnt(0)
s_barrier
ds_read_b128 a[232:235], v10 offset:18432
ds_read_b128 a[236:239], v11 offset:18432
M a[148:151], a[196:199], a[244:247], a[148:151]
s_add_u32 m0, s28, 0
s_nop 0
buffer_load_dword v20, s[8:11], s24 offen lds
M a[152:155], a[180:183], a[252:255], a[152:155]
ds_read_b128 a[240:243], v10 offset:20480
ds_read_b128 a[244:247], v11 offset:20480
M a[152:155], a[176:179], a[248:251], a[152:155]
M a[156:159], a[184:187], a[248:251], a[156:159]
buffer_load_dword v23, s[8:11], s24 offen offset:256 lds
M a[156:159], a[188:191], a[252:255], a[156:159]
M a[160:163], a[196:199], a[252:255], a[160:163]
M a[160:163], a[192:195], a[248:251], a[160:163]
s_add_u32 m0, s29, 2048
s_nop 0
buffer_load_dwordx4 v2, s[8:11], s23 offen offset:0 lds
M a[164:167], a[176:179], a[224:227], a[164:167]
ds_read_b128 a[248:251], v10 offset:22528
ds_read_b128 a[252:255], v11 offset:22528
M a[164:167], a[180:183], a[228:231], a[164:167]
M a[168:171], a[188:191], a[228:231], a[168:171]
M a[168:171], a[184:187], a[224:227], a[168:171]
buffer_load_dwordx4 v3, s[8:11], s23 offen offset:1024 lds
M a[172:175], a[192:195], a[224:227], a[172:175]
M a[172:175], a[196:199], a[228:231], a[172:175]
s_waitcnt lgkmcnt(4)
M a[68:71], a[200:203], a[232:235], a[68:71]
ds_read_b128 a[224:227], v10 offset:24576
ds_read_b128 a[228:231], v11 offset:24576
M a[68:71], a[204:207], a[236:239], a[68:71]
buffer_load_dwordx4 v4, s[8:11], s23 offen offset:2048 lds
M a[72:75], a[212:215], a[236:239], a[72:75]
ds_read_b64_tr_b16 a[176:177], v14 offset:28672
ds_read_b64_tr_b16 a[178:179], v14 offset:30208
M a[72:75], a[208:211], a[232:235], a[72:75]
M a[76:79], a[216:219], a[232:235], a[76:79]
buffer_load_dwordx4 v5, s[8:11], s23 offen offset:3072 lds
M a[76:79], a[220:223], a[236:239], a[76:79]
s_waitcnt lgkmcnt(6)
M a[80:83], a[204:207], a[244:247], a[80:83]
ds_read_b128 a[232:235], v10 offset:26624
ds_read_b128 a[236:239], v11 offset:26624
M a[80:83], a[200:203], a[240:243], a[80:83]
s_sub_u32 s31, s31, 1
s_cmp_eq_u32 s31, 0
s_cselect_b32 s58, -1920, s57
s_add_u32 s23, s23, s58
s_add_u32 s24, s24, s58
M a[84:87], a[208:211], a[240:243], a[84:87]
ds_read_b64_tr_b16 a[184:185], v15 offset:28672
ds_read_b64_tr_b16 a[186:187], v15 offset:30208
M a[84:87], a[212:215], a[244:247], a[84:87]
M a[88:91], a[220:223], a[244:247], a[88:91]
s_add_u32 m0, s30, 36864
s_nop 0
buffer_load_dwordx4 v6, s[12:15], s25 offen offset:0 lds
M a[88:91], a[216:219], a[240:243], a[88:91]
s_waitcnt lgkmcnt(8)
M a[92:95], a[200:203], a[248:251], a[92:95]
ds_read_b128 a[240:243], v10 offset:28672
ds_read_b128 a[244:247], v11 offset:28672
M a[92:95], a[204:207], a[252:255], a[92:95]
M a[96:99], a[212:215], a[252:255], a[96:99]
ds_read_b64_tr_b16 a[192:193], v16 offset:28672
ds_read_b64_tr_b16 a[194:195], v16 offset:30208
M a[96:99], a[208:211], a[248:251], a[96:99]
buffer_load_dwordx4 v7, s[12:15], s25 offen offset:1024 lds
M a[100:103], a[216:219], a[248:251], a[100:103]
M a[100:103], a[220:223], a[252:255], a[100:103]
buffer_load_dwordx4 v8, s[12:15], s25 offen offset:2048 lds
s_waitcnt lgkmcnt(10)
M a[104:107], a[204:207], a[228:231], a[104:107]
ds_read_b128 a[248:251], v10 offset:30720
ds_read_b128 a[252:255], v11 offset:30720
M a[104:107], a[200:203], a[224:227], a[104:107]
M a[108:111], a[208:211], a[224:227], a[108:111]
ds_read_b64_tr_b16 a[180:181], v14 offset:40960
ds_read_b64_tr_b16 a[182:183], v14 offset:42496
M a[108:111], a[212:215], a[228:231], a[108:111]
buffer_load_dwordx4 v9, s[12:15], s25 offen offset:3072 lds
M a[112:115], a[220:223], a[228:231], a[112:115]
M a[112:115], a[216:219], a[224:227], a[112:115]
s_add_u32 m0, s30, 40960
s_nop 0
buffer_load_dwordx4 v21, s[12:15], s25 offen offset:0 lds
s_waitcnt lgkmcnt(10)
M a[116:119], a[200:203], a[232:235], a[116:119]
ds_read_b128 a[224:227], v10 offset:32768
ds_read_b128 a[228:231], v11 offset:32768
M a[116:119], a[204:207], a[236:239], a[116:119]
M a[120:123], a[212:215], a[236:239], a[120:123]
ds_read_b64_tr_b16 a[188:189], v15 offset:40960
ds_read_b64_tr_b16 a[190:191], v15 offset:42496
M a[120:123], a[208:211], a[232:235], a[120:123]
M a[124:127], a[216:219], a[232:235], a[124:127]
buffer_load_dwordx4 v22, s[12:15], s25 offen offset:1024 lds
M a[124:127], a[220:223], a[236:239], a[124:127]
s_waitcnt lgkmcnt(10)
M a[128:131], a[204:207], a[244:247], a[128:131]
ds_read_b128 a[232:235], v10 offset:34816
ds_read_b128 a[236:239], v11 offset:34816
M a[128:131], a[200:203], a[240:243], a[128:131]
s_sub_u32 s54, s54, 1
s_cmp_eq_u32 s54, 0
s_cselect_b32 s58, s55, s56
s_add_u32 s25, s25, s58
M a[132:135], a[208:211], a[240:243], a[132:135]
ds_read_b64_tr_b16 a[196:197], v16 offset:40960
ds_read_b64_tr_b16 a[198:199], v16 offset:42496
M a[132:135], a[212:215], a[244:247], a[132:135]
M a[136:139], a[220:223], a[244:247], a[136:139]
s_add_u32 s94, s93, 12288
buffer_store_dwordx4 v[52:55], v1, s[16:19], s94 offen offset:2048 sc1
M a[136:139], a[216:219], a[240:243], a[136:139]
s_waitcnt lgkmcnt(10)
M a[140:143], a[200:203], a[248:251], a[140:143]
s_add_u32 s94, s93, 12288
buffer_store_dwordx4 v[60:63], v1, s[16:19], s94 offen offset:3072 sc1
M a[140:143], a[204:207], a[252:255], a[140:143]
M a[144:147], a[212:215], a[252:255], a[144:147]
M a[144:147], a[208:211], a[248:251], a[144:147]
M a[148:151], a[216:219], a[248:251], a[148:151]
s_waitcnt vmcnt(18) lgkmcnt(0)
s_barrier
ds_read_b128 a[240:243], v12 offset:0
ds_read_b128 a[244:247], v13 offset:0
M a[148:151], a[220:223], a[252:255], a[148:151]
s_add_u32 m0, s28, 18432
s_nop 0
buffer_load_dword v20, s[8:11], s24 offen lds
M a[152:155], a[204:207], a[228:231], a[152:155]
ds_read_b128 a[248:251], v12 offset:2048
ds_read_b128 a[252:255], v13 offset:2048
M a[152:155], a[200:203], a[224:227], a[152:155]
M a[156:159], a[208:211], a[224:227], a[156:159]
buffer_load_dword v23, s[8:11], s24 offen offset:256 lds
M a[156:159], a[212:215], a[228:231], a[156:159]
M a[160:163], a[220:223], a[228:231], a[160:163]
M a[160:163], a[216:219], a[224:227], a[160:163]
s_add_u32 m0, s29, 20480
s_nop 0
buffer_load_dwordx4 v2, s[8:11], s23 offen offset:0 lds
M a[164:167], a[200:203], a[232:235], a[164:167]
ds_read_b128 a[224:227], v12 offset:4096
ds_read_b128 a[228:231], v13 offset:4096
M a[164:167], a[204:207], a[236:239], a[164:167]
M a[168:171], a[212:215], a[236:239], a[168:171]
M a[168:171], a[208:211], a[232:235], a[168:171]
buffer_load_dwordx4 v3, s[8:11], s23 offen offset:1024 lds
M a[172:175], a[216:219], a[232:235], a[172:175]
M a[172:175], a[220:223], a[236:239], a[172:175]
s_waitcnt lgkmcnt(4)
M a[68:71], a[176:179], a[240:243], a[68:71]
ds_read_b128 a[232:235], v12 offset:6144
ds_read_b128 a[236:239], v13 offset:6144
M a[68:71], a[180:183], a[244:247], a[68:71]
buffer_load_dwordx4 v4, s[8:11], s23 offen offset:2048 lds
M a[72:75], a[188:191], a[244:247], a[72:75]
ds_read_b64_tr_b16 a[200:201], v17 offset:0
ds_read_b64_tr_b16 a[202:203], v17 offset:1536
M a[72:75], a[184:187], a[240:243], a[72:75]
M a[76:79], a[192:195], a[240:243], a[76:79]
buffer_load_dwordx4 v5, s[8:11], s23 offen offset:3072 lds
M a[76:79], a[196:199], a[244:247], a[76:79]
s_waitcnt lgkmcnt(6)
M a[80:83], a[180:183], a[252:255], a[80:83]
ds_read_b128 a[240:243], v12 offset:8192
ds_read_b128 a[244:247], v13 offset:8192
M a[80:83], a[176:179], a[248:251], a[80:83]
M a[84:87], a[184:187], a[248:251], a[84:87]
ds_read_b64_tr_b16 a[208:209], v18 offset:0
ds_read_b64_tr_b16 a[210:211], v18 offset:1536
M a[84:87], a[188:191], a[252:255], a[84:87]
s_sub_u32 s31, s31, 1
s_cmp_eq_u32 s31, 0
s_cselect_b32 s58, -1920, s57
s_add_u32 s23, s23, s58
s_add_u32 s24, s24, s58
M a[88:91], a[196:199], a[252:255], a[88:91]
M a[88:91], a[192:195], a[248:251], a[88:91]
s_waitcnt lgkmcnt(8)
M a[92:95], a[176:179], a[224:227], a[92:95]
ds_read_b128 a[248:251], v12 offset:10240
ds_read_b128 a[252:255], v13 offset:10240
M a[92:95], a[180:183], a[228:231], a[92:95]
s_add_u32 m0, s30, 65536
s_nop 0
buffer_load_dwordx4 v6, s[12:15], s25 offen offset:0 lds
M a[96:99], a[188:191], a[228:231], a[96:99]
ds_read_b64_tr_b16 a[216:217], v19 offset:0
ds_read_b64_tr_b16 a[218:219], v19 offset:1536
M a[96:99], a[184:187], a[224:227], a[96:99]
M a[100:103], a[192:195], a[224:227], a[100:103]
buffer_load_dwordx4 v7, s[12:15], s25 offen offset:1024 lds
M a[100:103], a[196:199], a[228:231], a[100:103]
s_waitcnt lgkmcnt(10)
M a[104:107], a[180:183], a[236:239], a[104:107]
ds_read_b128 a[224:227], v12 offset:12288
ds_read_b128 a[228:231], v13 offset:12288
M a[104:107], a[176:179], a[232:235], a[104:107]
M a[108:111], a[184:187], a[232:235], a[108:111]
ds_read_b64_tr_b16 a[204:205], v17 offset:12288
ds_read_b64_tr_b16 a[206:207], v17 offset:13824
M a[108:111], a[188:191], a[236:239], a[108:111]
buffer_load_dwordx4 v8, s[12:15], s25 offen offset:2048 lds
M a[112:115], a[196:199], a[236:239], a[112:115]
M a[112:115], a[192:195], a[232:235], a[112:115]
s_waitcnt lgkmcnt(10)
M a[116:119], a[176:179], a[240:243], a[116:119]
ds_read_b128 a[232:235], v12 offset:14336
ds_read_b128 a[236:239], v13 offset:14336
M a[116:119], a[180:183], a[244:247], a[116:119]
buffer_load_dwordx4 v9, s[12:15], s25 offen offset:3072 lds
M a[120:123], a[188:191], a[244:247], a[120:123]
ds_read_b64_tr_b16 a[212:213], v18 offset:12288
ds_read_b64_tr_b16 a[214:215], v18 offset:13824
M a[120:123], a[184:187], a[240:243], a[120:123]
M a[124:127], a[192:195], a[240:243], a[124:127]
s_add_u32 m0, s30, 69632
s_nop 0
buffer_load_dwordx4 v21, s[12:15], s25 offen offset:0 lds
M a[124:127], a[196:199], a[244:247], a[124:127]
s_waitcnt lgkmcnt(10)
M a[128:131], a[180:183], a[252:255], a[128:131]
ds_read_b128 a[240:243], v12 offset:16384
ds_read_b128 a[244:247], v13 offset:16384
M a[128:131], a[176:179], a[248:251], a[128:131]
M a[132:135], a[184:187], a[248:251], a[132:135]
ds_read_b64_tr_b16 a[220:221], v19 offset:12288
ds_read_b64_tr_b16 a[222:223], v19 offset:13824
M a[132:135], a[188:191], a[252:255], a[132:135]
buffer_load_dwordx4 v22, s[12:15], s25 offen offset:1024 lds
M a[136:139], a[196:199], a[252:255], a[136:139]
M a[136:139], a[192:195], a[248:251], a[136:139]
s_waitcnt lgkmcnt(10)
M a[140:143], a[176:179], a[224:227], a[140:143]
s_sub_u32 s54, s54, 1
s_cmp_eq_u32 s54, 0
s_cselect_b32 s58, s55, s56
s_add_u32 s25, s25, s58
M a[140:143], a[180:183], a[228:231], a[140:143]
M a[144:147], a[188:191], a[228:231], a[144:147]
M a[144:147], a[184:187], a[224:227], a[144:147]
M a[148:151], a[192:195], a[224:227], a[148:151]
s_waitcnt vmcnt(12) lgkmcnt(0)
s_barrier
ds_read_b128 a[248:251], v10 offset:0
ds_read_b128 a[252:255], v11 offset:0
s_cmp_lg_u32 s101, 0
s_cbranch_scc1 Lk1_arr
v_mov_b32 v127, 1
s_and_b32 s41, s2, 128
s_mov_b64 exec, 1
buffer_atomic_add v127, off, s[36:39], s41 sc1
s_mov_b64 exec, -1
Lk1_arr:
M a[148:151], a[196:199], a[228:231], a[148:151]
s_add_u32 m0, s28, 131072
s_nop 0
buffer_load_dword v20, s[8:11], s24 offen lds
M a[152:155], a[180:183], a[236:239], a[152:155]
ds_read_b128 a[224:227], v10 offset:2048
ds_read_b128 a[228:231], v11 offset:2048
M a[152:155], a[176:179], a[232:235], a[152:155]
M a[156:159], a[184:187], a[232:235], a[156:159]
buffer_load_dword v23, s[8:11], s24 offen offset:256 lds
M a[156:159], a[188:191], a[236:239], a[156:159]
M a[160:163], a[196:199], a[236:239], a[160:163]
M a[160:163], a[192:195], a[232:235], a[160:163]
s_add_u32 m0, s29, 133120
s_nop 0
buffer_load_dwordx4 v2, s[8:11], s23 offen offset:0 lds
M a[164:167], a[176:179], a[240:243], a[164:167]
ds_read_b128 a[232:235], v10 offset:4096
ds_read_b128 a[236:239], v11 offset:4096
M a[164:167], a[180:183], a[244:247], a[164:167]
M a[168:171], a[188:191], a[244:247], a[168:171]
M a[168:171], a[184:187], a[240:243], a[168:171]
buffer_load_dwordx4 v3, s[8:11], s23 offen offset:1024 lds
M a[172:175], a[192:195], a[240:243], a[172:175]
M a[172:175], a[196:199], a[244:247], a[172:175]
s_waitcnt lgkmcnt(4)
M a[68:71], a[200:203], a[248:251], a[68:71]
ds_read_b128 a[240:243], v10 offset:6144
ds_read_b128 a[244:247], v11 offset:6144
M a[68:71], a[204:207], a[252:255], a[68:71]
buffer_load_dwordx4 v4, s[8:11], s23 offen offset:2048 lds
M a[72:75], a[212:215], a[252:255], a[72:75]
ds_read_b64_tr_b16 a[176:177], v14 offset:0
ds_read_b64_tr_b16 a[178:179], v14 offset:1536
M a[72:75], a[208:211], a[248:251], a[72:75]
M a[76:79], a[216:219], a[248:251], a[76:79]
buffer_load_dwordx4 v5, s[8:11], s23 offen offset:3072 lds
M a[76:79], a[220:223], a[252:255], a[76:79]
s_waitcnt lgkmcnt(6)
M a[80:83], a[204:207], a[228:231], a[80:83]
ds_read_b128 a[248:251], v10 offset:8192
ds_read_b128 a[252:255], v11 offset:8192
M a[80:83], a[200:203], a[224:227], a[80:83]
M a[84:87], a[208:211], a[224:227], a[84:87]
ds_read_b64_tr_b16 a[184:185], v15 offset:0
ds_read_b64_tr_b16 a[186:187], v15 offset:1536
M a[84:87], a[212:215], a[228:231], a[84:87]
s_sub_u32 s31, s31, 1
s_cmp_eq_u32 s31, 0
s_cselect_b32 s58, -1920, s57
s_add_u32 s23, s23, s58
s_add_u32 s24, s24, s58
M a[88:91], a[220:223], a[228:231], a[88:91]
M a[88:91], a[216:219], a[224:227], a[88:91]
s_waitcnt lgkmcnt(8)
M a[92:95], a[200:203], a[232:235], a[92:95]
ds_read_b128 a[224:227], v10 offset:10240
ds_read_b128 a[228:231], v11 offset:10240
M a[92:95], a[204:207], a[236:239], a[92:95]
s_add_u32 m0, s30, 98304
s_nop 0
buffer_load_dwordx4 v6, s[12:15], s25 offen offset:0 lds
M a[96:99], a[212:215], a[236:239], a[96:99]
ds_read_b64_tr_b16 a[192:193], v16 offset:0
ds_read_b64_tr_b16 a[194:195], v16 offset:1536
M a[96:99], a[208:211], a[232:235], a[96:99]
M a[100:103], a[216:219], a[232:235], a[100:103]
buffer_load_dwordx4 v7, s[12:15], s25 offen offset:1024 lds
M a[100:103], a[220:223], a[236:239], a[100:103]
s_waitcnt lgkmcnt(10)
M a[104:107], a[204:207], a[244:247], a[104:107]
ds_read_b128 a[232:235], v10 offset:12288
ds_read_b128 a[236:239], v11 offset:12288
M a[104:107], a[200:203], a[240:243], a[104:107]
M a[108:111], a[208:211], a[240:243], a[108:111]
ds_read_b64_tr_b16 a[180:181], v14 offset:12288
ds_read_b64_tr_b16 a[182:183], v14 offset:13824
M a[108:111], a[212:215], a[244:247], a[108:111]
buffer_load_dwordx4 v8, s[12:15], s25 offen offset:2048 lds
M a[112:115], a[220:223], a[244:247], a[112:115]
M a[112:115], a[216:219], a[240:243], a[112:115]
s_waitcnt lgkmcnt(10)
M a[116:119], a[200:203], a[248:251], a[116:119]
ds_read_b128 a[240:243], v10 offset:14336
ds_read_b128 a[244:247], v11 offset:14336
M a[116:119], a[204:207], a[252:255], a[116:119]
buffer_load_dwordx4 v9, s[12:15], s25 offen offset:3072 lds
M a[120:123], a[212:215], a[252:255], a[120:123]
ds_read_b64_tr_b16 a[188:189], v15 offset:12288
ds_read_b64_tr_b16 a[190:191], v15 offset:13824
M a[120:123], a[208:211], a[248:251], a[120:123]
M a[124:127], a[216:219], a[248:251], a[124:127]
s_add_u32 m0, s30, 102400
s_nop 0
buffer_load_dwordx4 v21, s[12:15], s25 offen offset:0 lds
M a[124:127], a[220:223], a[252:255], a[124:127]
s_waitcnt lgkmcnt(10)
M a[128:131], a[204:207], a[228:231], a[128:131]
ds_read_b128 a[248:251], v10 offset:16384
ds_read_b128 a[252:255], v11 offset:16384
M a[128:131], a[200:203], a[224:227], a[128:131]
M a[132:135], a[208:211], a[224:227], a[132:135]
ds_read_b64_tr_b16 a[196:197], v16 offset:12288
ds_read_b64_tr_b16 a[198:199], v16 offset:13824
M a[132:135], a[212:215], a[228:231], a[132:135]
buffer_load_dwordx4 v22, s[12:15], s25 offen offset:1024 lds
M a[136:139], a[220:223], a[228:231], a[136:139]
M a[136:139], a[216:219], a[224:227], a[136:139]
s_waitcnt lgkmcnt(10)
M a[140:143], a[200:203], a[232:235], a[140:143]
s_sub_u32 s54, s54, 1
s_cmp_eq_u32 s54, 0
s_cselect_b32 s58, s55, s56
s_add_u32 s25, s25, s58
M a[140:143], a[204:207], a[236:239], a[140:143]
M a[144:147], a[212:215], a[236:239], a[144:147]
M a[144:147], a[208:211], a[232:235], a[144:147]
M a[148:151], a[216:219], a[232:235], a[148:151]
s_waitcnt vmcnt(12) lgkmcnt(0)
s_barrier
ds_read_b128 a[224:227], v10 offset:18432
ds_read_b128 a[228:231], v11 offset:18432
M a[148:151], a[220:223], a[236:239], a[148:151]
s_add_u32 m0, s28, 0
s_nop 0
buffer_load_dword v20, s[8:11], s24 offen lds
M a[152:155], a[204:207], a[244:247], a[152:155]
ds_read_b128 a[232:235], v10 offset:20480
ds_read_b128 a[236:239], v11 offset:20480
M a[152:155], a[200:203], a[240:243], a[152:155]
M a[156:159], a[208:211], a[240:243], a[156:159]
buffer_load_dword v23, s[8:11], s24 offen offset:256 lds
M a[156:159], a[212:215], a[244:247], a[156:159]
M a[160:163], a[220:223], a[244:247], a[160:163]
M a[160:163], a[216:219], a[240:243], a[160:163]
s_add_u32 m0, s29, 2048
s_nop 0
buffer_load_dwordx4 v2, s[8:11], s23 offen offset:0 lds
M a[164:167], a[200:203], a[248:251], a[164:167]
ds_read_b128 a[240:243], v10 offset:22528
ds_read_b128 a[244:247], v11 offset:22528
M a[164:167], a[204:207], a[252:255], a[164:167]
M a[168:171], a[212:215], a[252:255], a[168:171]
M a[168:171], a[208:211], a[248:251], a[168:171]
buffer_load_dwordx4 v3, s[8:11], s23 offen offset:1024 lds
M a[172:175], a[216:219], a[248:251], a[172:175]
M a[172:175], a[220:223], a[252:255], a[172:175]
s_waitcnt lgkmcnt(4)
M a[68:71], a[176:179], a[224:227], a[68:71]
ds_read_b128 a[248:251], v10 offset:24576
ds_read_b128 a[252:255], v11 offset:24576
v_mov_b32 v160, 0
v_mov_b32 v161, 0
M a[68:71], a[180:183], a[228:231], a[68:71]
buffer_load_dwordx4 v4, s[8:11], s23 offen offset:2048 lds
M a[72:75], a[188:191], a[228:231], a[72:75]
ds_read_b64_tr_b16 a[200:201], v14 offset:28672
ds_read_b64_tr_b16 a[202:203], v14 offset:30208
v_mov_b32 v162, 0
v_mov_b32 v163, 0
M a[72:75], a[184:187], a[224:227], a[72:75]
M a[76:79], a[192:195], a[224:227], a[76:79]
buffer_load_dwordx4 v5, s[8:11], s23 offen offset:3072 lds
v_mov_b32 v164, 0
v_mov_b32 v165, 0
M a[76:79], a[196:199], a[228:231], a[76:79]
s_waitcnt lgkmcnt(6)
M a[80:83], a[180:183], a[236:239], a[80:83]
ds_read_b128 a[224:227], v10 offset:26624
ds_read_b128 a[228:231], v11 offset:26624
v_mov_b32 v166, 0
v_mov_b32 v167, 0
M a[80:83], a[176:179], a[232:235], a[80:83]
M a[84:87], a[184:187], a[232:235], a[84:87]
ds_read_b64_tr_b16 a[208:209], v15 offset:28672
ds_read_b64_tr_b16 a[210:211], v15 offset:30208
M a[84:87], a[188:191], a[236:239], a[84:87]
s_sub_u32 s31, s31, 1
s_cmp_eq_u32 s31, 0
s_cselect_b32 s58, -1920, s57
s_add_u32 s23, s23, s58
s_add_u32 s24, s24, s58
v_mov_b32 v168, 0
v_mov_b32 v169, 0
M a[88:91], a[196:199], a[236:239], a[88:91]
M a[88:91], a[192:195], a[232:235], a[88:91]
s_waitcnt lgkmcnt(8)
v_mov_b32 v170, 0
v_mov_b32 v171, 0
M a[92:95], a[176:179], a[240:243], a[92:95]
ds_read_b128 a[232:235], v10 offset:28672
ds_read_b128 a[236:239], v11 offset:28672
M a[92:95], a[180:183], a[244:247], a[92:95]
s_add_u32 m0, s30, 36864
s_nop 0
buffer_load_dwordx4 v6, s[12:15], s25 offen offset:0 lds
v_mov_b32 v172, 0
v_mov_b32 v173, 0
M a[96:99], a[188:191], a[244:247], a[96:99]
ds_read_b64_tr_b16 a[216:217], v16 offset:28672
ds_read_b64_tr_b16 a[218:219], v16 offset:30208
M a[96:99], a[184:187], a[240:243], a[96:99]
v_mov_b32 v174, 0
v_mov_b32 v175, 0
M a[100:103], a[192:195], a[240:243], a[100:103]
buffer_load_dwordx4 v7, s[12:15], s25 offen offset:1024 lds
M a[100:103], a[196:199], a[244:247], a[100:103]
s_waitcnt lgkmcnt(10)
M a[104:107], a[180:183], a[252:255], a[104:107]
ds_read_b128 a[240:243], v10 offset:30720
ds_read_b128 a[244:247], v11 offset:30720
v_mov_b32 v176, 0
v_mov_b32 v177, 0
M a[104:107], a[176:179], a[248:251], a[104:107]
M a[108:111], a[184:187], a[248:251], a[108:111]
ds_read_b64_tr_b16 a[204:205], v14 offset:40960
ds_read_b64_tr_b16 a[206:207], v14 offset:42496
v_mov_b32 v178, 0
v_mov_b32 v179, 0
M a[108:111], a[188:191], a[252:255], a[108:111]
buffer_load_dwordx4 v8, s[12:15], s25 offen offset:2048 lds
M a[112:115], a[196:199], a[252:255], a[112:115]
v_mov_b32 v180, 0
v_mov_b32 v181, 0
M a[112:115], a[192:195], a[248:251], a[112:115]
s_waitcnt lgkmcnt(10)
M a[116:119], a[176:179], a[224:227], a[116:119]
ds_read_b128 a[248:251], v10 offset:32768
ds_read_b128 a[252:255], v11 offset:32768
v_mov_b32 v182, 0
v_mov_b32 v183, 0
M a[116:119], a[180:183], a[228:231], a[116:119]
buffer_load_dwordx4 v9, s[12:15], s25 offen offset:3072 lds
M a[120:123], a[188:191], a[228:231], a[120:123]
ds_read_b64_tr_b16 a[212:213], v15 offset:40960
ds_read_b64_tr_b16 a[214:215], v15 offset:42496
M a[120:123], a[184:187], a[224:227], a[120:123]
v_mov_b32 v184, 0
v_mov_b32 v185, 0
M a[124:127], a[192:195], a[224:227], a[124:127]
s_add_u32 m0, s30, 40960
s_nop 0
buffer_load_dwordx4 v21, s[12:15], s25 offen offset:0 lds
M a[124:127], a[196:199], a[228:231], a[124:127]
s_waitcnt lgkmcnt(10)
v_mov_b32 v186, 0
v_mov_b32 v187, 0
M a[128:131], a[180:183], a[236:239], a[128:131]
ds_read_b128 a[224:227], v10 offset:34816
ds_read_b128 a[228:231], v11 offset:34816
M a[128:131], a[176:179], a[232:235], a[128:131]
v_mov_b32 v188, 0
v_mov_b32 v189, 0
M a[132:135], a[184:187], a[232:235], a[132:135]
ds_read_b64_tr_b16 a[220:221], v16 offset:40960
ds_read_b64_tr_b16 a[222:223], v16 offset:42496
M a[132:135], a[188:191], a[236:239], a[132:135]
buffer_load_dwordx4 v22, s[12:15], s25 offen offset:1024 lds
v_mov_b32 v190, 0
v_mov_b32 v191, 0
M a[136:139], a[196:199], a[236:239], a[136:139]
M a[136:139], a[192:195], a[232:235], a[136:139]
s_waitcnt lgkmcnt(10)
M a[140:143], a[176:179], a[240:243], a[140:143]
s_sub_u32 s54, s54, 1
s_cmp_eq_u32 s54, 0
s_cselect_b32 s58, s55, s56
s_add_u32 s25, s25, s58
v_mov_b32 v192, 0
v_mov_b32 v193, 0
M a[140:143], a[180:183], a[244:247], a[140:143]
M a[144:147], a[188:191], a[244:247], a[144:147]
v_mov_b32 v194, 0
v_mov_b32 v195, 0
M a[144:147], a[184:187], a[240:243], a[144:147]
M a[148:151], a[192:195], a[240:243], a[148:151]
s_waitcnt vmcnt(12) lgkmcnt(0)
s_barrier
ds_read_b128 a[232:235], v12 offset:0
ds_read_b128 a[236:239], v13 offset:0
v_mov_b32 v196, 0
v_mov_b32 v197, 0
M a[148:151], a[196:199], a[244:247], a[148:151]
s_add_u32 m0, s28, 18432
s_nop 0
buffer_load_dword v20, s[8:11], s24 offen lds
M a[152:155], a[180:183], a[252:255], a[152:155]
ds_read_b128 a[240:243], v12 offset:2048
ds_read_b128 a[244:247], v13 offset:2048
v_mov_b32 v198, 0
v_mov_b32 v199, 0
M a[152:155], a[176:179], a[248:251], a[152:155]
M a[156:159], a[184:187], a[248:251], a[156:159]
buffer_load_dword v23, s[8:11], s24 offen offset:256 lds
M a[156:159], a[188:191], a[252:255], a[156:159]
v_mov_b32 v200, 0
v_mov_b32 v201, 0
M a[160:163], a[196:199], a[252:255], a[160:163]
M a[160:163], a[192:195], a[248:251], a[160:163]
s_add_u32 m0, s29, 20480
s_nop 0
buffer_load_dwordx4 v2, s[8:11], s23 offen offset:0 lds
v_mov_b32 v202, 0
v_mov_b32 v203, 0
M a[164:167], a[176:179], a[224:227], a[164:167]
ds_read_b128 a[248:251], v12 offset:4096
ds_read_b128 a[252:255], v13 offset:4096
M a[164:167], a[180:183], a[228:231], a[164:167]
v_mov_b32 v204, 0
v_mov_b32 v205, 0
M a[168:171], a[188:191], a[228:231], a[168:171]
M a[168:171], a[184:187], a[224:227], a[168:171]
buffer_load_dwordx4 v3, s[8:11], s23 offen offset:1024 lds
v_mov_b32 v206, 0
v_mov_b32 v207, 0
M a[172:175], a[192:195], a[224:227], a[172:175]
M a[172:175], a[196:199], a[228:231], a[172:175]
s_waitcnt lgkmcnt(4)
M a[68:71], a[200:203], a[232:235], a[68:71]
ds_read_b128 a[224:227], v12 offset:6144
ds_read_b128 a[228:231], v13 offset:6144
v_and_b32 v128, 15, v0
v_mul_u32_u24 v128, 400, v128
M a[68:71], a[204:207], a[236:239], a[68:71]
buffer_load_dwordx4 v4, s[8:11], s23 offen offset:2048 lds
M a[72:75], a[212:215], a[236:239], a[72:75]
ds_read_b64_tr_b16 a[176:177], v17 offset:0
ds_read_b64_tr_b16 a[178:179], v17 offset:1536
v_lshrrev_b32 v129, 4, v0
v_lshl_add_u32 v128, v129, 3, v128
M a[72:75], a[208:211], a[232:235], a[72:75]
M a[76:79], a[216:219], a[232:235], a[76:79]
buffer_load_dwordx4 v5, s[8:11], s23 offen offset:3072 lds
s_mul_i32 s3, s20, 96
s_add_u32 s3, s3, 98304
M a[76:79], a[220:223], a[236:239], a[76:79]
s_waitcnt lgkmcnt(6)
M a[80:83], a[204:207], a[244:247], a[80:83]
ds_read_b128 a[232:235], v12 offset:8192
ds_read_b128 a[236:239], v13 offset:8192
v_add_u32 v124, s3, v128
v_and_b32 v128, 15, v0
M a[80:83], a[200:203], a[240:243], a[80:83]
M a[84:87], a[208:211], a[240:243], a[84:87]
ds_read_b64_tr_b16 a[184:185], v18 offset:0
ds_read_b64_tr_b16 a[186:187], v18 offset:1536
v_lshrrev_b32 v129, 4, v0
s_add_u32 s3, s21, 16
M a[84:87], a[212:215], a[244:247], a[84:87]
s_sub_u32 s31, s31, 1
s_cmp_eq_u32 s31, 0
s_cselect_b32 s58, -1920, s57
s_add_u32 s23, s23, s58
s_add_u32 s24, s24, s58
M a[88:91], a[220:223], a[244:247], a[88:91]
v_lshl_add_u32 v130, v128, 1, s3
s_lshl_b32 s4, s22, 6
M a[88:91], a[216:219], a[240:243], a[88:91]
s_waitcnt lgkmcnt(8)
M a[92:95], a[200:203], a[248:251], a[92:95]
ds_read_b128 a[240:243], v12 offset:10240
ds_read_b128 a[244:247], v13 offset:10240
s_add_u32 s4, s4, 98304
v_mul_u32_u24 v120, 400, v130
M a[92:95], a[204:207], a[252:255], a[92:95]
s_add_u32 m0, s30, 65536
s_nop 0
buffer_load_dwordx4 v6, s[12:15], s25 offen offset:0 lds
M a[96:99], a[212:215], a[252:255], a[96:99]
ds_read_b64_tr_b16 a[192:193], v19 offset:0
ds_read_b64_tr_b16 a[194:195], v19 offset:1536
M a[96:99], a[208:211], a[248:251], a[96:99]
v_lshl_add_u32 v120, v129, 4, v120
v_add_u32 v120, s4, v120
M a[100:103], a[216:219], a[248:251], a[100:103]
buffer_load_dwordx4 v7, s[12:15], s25 offen offset:1024 lds
M a[100:103], a[220:223], a[252:255], a[100:103]
s_waitcnt lgkmcnt(10)
v_subrev_u32 v130, 32, v130
v_max_i32 v130, 0, v130
M a[104:107], a[204:207], a[228:231], a[104:107]
ds_read_b128 a[248:251], v12 offset:12288
ds_read_b128 a[252:255], v13 offset:12288
M a[104:107], a[200:203], a[224:227], a[104:107]
v_mul_u32_u24 v121, 400, v130
v_lshl_add_u32 v121, v129, 4, v121
M a[108:111], a[208:211], a[224:227], a[108:111]
ds_read_b64_tr_b16 a[180:181], v17 offset:12288
ds_read_b64_tr_b16 a[182:183], v17 offset:13824
M a[108:111], a[212:215], a[228:231], a[108:111]
buffer_load_dwordx4 v8, s[12:15], s25 offen offset:2048 lds
v_add_u32 v121, s4, v121
v_bfe_u32 v131, v0, 2, 2
M a[112:115], a[220:223], a[228:231], a[112:115]
M a[112:115], a[216:219], a[224:227], a[112:115]
s_waitcnt lgkmcnt(10)
v_lshl_add_u32 v131, v129, 2, v131
v_lshl_add_u32 v131, v131, 1, s3
M a[116:119], a[200:203], a[232:235], a[116:119]
ds_read_b128 a[224:227], v12 offset:14336
ds_read_b128 a[228:231], v13 offset:14336
M a[116:119], a[204:207], a[236:239], a[116:119]
buffer_load_dwordx4 v9, s[12:15], s25 offen offset:3072 lds
v_and_b32 v132, 3, v0
v_lshlrev_b32 v132, 3, v132
M a[120:123], a[212:215], a[236:239], a[120:123]
ds_read_b64_tr_b16 a[188:189], v18 offset:12288
ds_read_b64_tr_b16 a[190:191], v18 offset:13824
M a[120:123], a[208:211], a[232:235], a[120:123]
M a[124:127], a[216:219], a[232:235], a[124:127]
s_add_u32 m0, s30, 69632
s_nop 0
buffer_load_dwordx4 v21, s[12:15], s25 offen offset:0 lds
v_add_u32 v132, s4, v132
s_movk_i32 s5, 400
M a[124:127], a[220:223], a[236:239], a[124:127]
s_waitcnt lgkmcnt(10)
M a[128:131], a[204:207], a[244:247], a[128:131]
ds_read_b128 a[232:235], v12 offset:16384
ds_read_b128 a[236:239], v13 offset:16384
v_mad_u32_u24 v122, v131, s5, v132
v_subrev_u32 v131, 32, v131
M a[128:131], a[200:203], a[240:243], a[128:131]
M a[132:135], a[208:211], a[240:243], a[132:135]
ds_read_b64_tr_b16 a[196:197], v19 offset:12288
ds_read_b64_tr_b16 a[198:199], v19 offset:13824
v_max_i32 v131, 0, v131
v_mad_u32_u24 v123, v131, s5, v132
M a[132:135], a[212:215], a[244:247], a[132:135]
buffer_load_dwordx4 v22, s[12:15], s25 offen offset:1024 lds
M a[136:139], a[220:223], a[244:247], a[136:139]
v_lshlrev_b32 v129, 2, v129
v_sub_u32 v128, v128, v129
M a[136:139], a[216:219], a[240:243], a[136:139]
s_waitcnt lgkmcnt(10)
M a[140:143], a[200:203], a[248:251], a[140:143]
s_sub_u32 s54, s54, 1
s_cmp_eq_u32 s54, 0
s_cselect_b32 s58, s55, s56
s_add_u32 s25, s25, s58
v_mov_b32 v129, 0xf149f2ca
s_cmp_eq_u32 s26, 0
s_cselect_b32 s3, 0xf149f2ca, 0
M a[140:143], a[204:207], a[252:255], a[140:143]
M a[144:147], a[212:215], a[252:255], a[144:147]
v_cmp_lt_i32 vcc, -9, v128
s_nop 1
v_cndmask_b32 v144, 0, v129, vcc
M a[144:147], a[208:211], a[248:251], a[144:147]
M a[148:151], a[216:219], a[248:251], a[148:151]
s_waitcnt vmcnt(12) lgkmcnt(0)
s_barrier
ds_read_b128 a[240:243], v10 offset:0
ds_read_b128 a[244:247], v11 offset:0
M a[148:151], a[220:223], a[252:255], a[148:151]
s_add_u32 m0, s28, 131072
s_nop 0
buffer_load_dword v20, s[8:11], s24 offen lds
v_subrev_u32 v130, 0, v128
v_cmp_lt_u32 vcc, 7, v130
s_nop 1
v_cndmask_b32 v148, 0, v129, vcc
M a[152:155], a[204:207], a[228:231], a[152:155]
ds_read_b128 a[248:251], v10 offset:2048
ds_read_b128 a[252:255], v11 offset:2048
M a[152:155], a[200:203], a[224:227], a[152:155]
v_min_f32 v152, s3, v144
v_mov_b32 v156, 0x3f803f80
M a[156:159], a[208:211], a[224:227], a[156:159]
buffer_load_dword v23, s[8:11], s24 offen offset:256 lds
M a[156:159], a[212:215], a[228:231], a[156:159]
v_cmp_lt_i32 vcc, -8, v128
s_nop 1
v_cndmask_b32 v145, 0, v129, vcc
M a[160:163], a[220:223], a[228:231], a[160:163]
M a[160:163], a[216:219], a[224:227], a[160:163]
s_add_u32 m0, s29, 133120
s_nop 0
buffer_load_dwordx4 v2, s[8:11], s23 offen offset:0 lds
v_subrev_u32 v130, 1, v128
v_cmp_lt_u32 vcc, 7, v130
s_nop 1
v_cndmask_b32 v149, 0, v129, vcc
M a[164:167], a[200:203], a[232:235], a[164:167]
ds_read_b128 a[224:227], v10 offset:4096
ds_read_b128 a[228:231], v11 offset:4096
M a[164:167], a[204:207], a[236:239], a[164:167]
v_min_f32 v153, s3, v145
v_mov_b32 v157, 0x3f803f80
M a[168:171], a[212:215], a[236:239], a[168:171]
M a[168:171], a[208:211], a[232:235], a[168:171]
buffer_load_dwordx4 v3, s[8:11], s23 offen offset:1024 lds
v_cmp_lt_i32 vcc, -7, v128
s_nop 1
v_cndmask_b32 v146, 0, v129, vcc
M a[172:175], a[216:219], a[232:235], a[172:175]
M a[172:175], a[220:223], a[236:239], a[172:175]
s_waitcnt lgkmcnt(4)
M a[68:71], a[176:179], a[240:243], a[68:71]
ds_read_b128 a[232:235], v10 offset:6144
ds_read_b128 a[236:239], v11 offset:6144
v_subrev_u32 v130, 2, v128
v_cmp_lt_u32 vcc, 7, v130
s_nop 1
v_cndmask_b32 v150, 0, v129, vcc
M a[68:71], a[180:183], a[244:247], a[68:71]
buffer_load_dwordx4 v4, s[8:11], s23 offen offset:2048 lds
v_min_f32 v154, s3, v146
v_mov_b32 v158, 0x3f803f80
M a[72:75], a[188:191], a[244:247], a[72:75]
ds_read_b64_tr_b16 a[200:201], v14 offset:0
ds_read_b64_tr_b16 a[202:203], v14 offset:1536
M a[72:75], a[184:187], a[240:243], a[72:75]
v_cmp_lt_i32 vcc, -6, v128
s_nop 1
v_cndmask_b32 v147, 0, v129, vcc
M a[76:79], a[192:195], a[240:243], a[76:79]
buffer_load_dwordx4 v5, s[8:11], s23 offen offset:3072 lds
v_subrev_u32 v130, 3, v128
v_cmp_lt_u32 vcc, 7, v130
s_nop 1
v_cndmask_b32 v151, 0, v129, vcc
M a[76:79], a[196:199], a[244:247], a[76:79]
s_waitcnt lgkmcnt(6)
M a[80:83], a[180:183], a[252:255], a[80:83]
ds_read_b128 a[240:243], v10 offset:8192
ds_read_b128 a[244:247], v11 offset:8192
v_min_f32 v155, s3, v147
v_mov_b32 v159, 0x3f803f80
M a[80:83], a[176:179], a[248:251], a[80:83]
s_add_u32 s16, s50, 83886080
s_addc_u32 s17, s51, 0
M a[84:87], a[184:187], a[248:251], a[84:87]
ds_read_b64_tr_b16 a[208:209], v15 offset:0
ds_read_b64_tr_b16 a[210:211], v15 offset:1536
M a[84:87], a[188:191], a[252:255], a[84:87]
s_sub_u32 s31, s31, 1
s_cmp_eq_u32 s31, 0
s_cselect_b32 s58, -1920, s57
s_add_u32 s23, s23, s58
s_add_u32 s24, s24, s58
s_mov_b32 s18, 4194304
s_mov_b32 s19, 0x00020000
M a[88:91], a[196:199], a[252:255], a[88:91]
s_lshl_b32 s3, s26, 18
s_lshl_b32 s4, s27, 14
M a[88:91], a[192:195], a[248:251], a[88:91]
s_waitcnt lgkmcnt(8)
M a[92:95], a[176:179], a[224:227], a[92:95]
ds_read_b128 a[248:251], v10 offset:10240
ds_read_b128 a[252:255], v11 offset:10240
s_add_u32 s3, s3, s4
s_lshl_b32 s4, s21, 13
M a[92:95], a[180:183], a[228:231], a[92:95]
s_add_u32 m0, s30, 98304
s_nop 0
buffer_load_dwordx4 v6, s[12:15], s25 offen offset:0 lds
s_add_u32 s3, s3, s4
s_lshl_b32 s4, s22, 10
M a[96:99], a[188:191], a[228:231], a[96:99]
ds_read_b64_tr_b16 a[216:217], v16 offset:0
ds_read_b64_tr_b16 a[218:219], v16 offset:1536
M a[96:99], a[184:187], a[224:227], a[96:99]
s_add_u32 s6, s3, s4
s_mov_b32 s7, 0x3e8293ee
M a[100:103], a[192:195], a[224:227], a[100:103]
buffer_load_dwordx4 v7, s[12:15], s25 offen offset:1024 lds
s_lshl_b32 s65, s26, 8
s_lshl_b32 s3, s27, 4
M a[100:103], a[196:199], a[228:231], a[100:103]
s_waitcnt lgkmcnt(10)
M a[104:107], a[180:183], a[236:239], a[104:107]
ds_read_b128 a[224:227], v10 offset:12288
ds_read_b128 a[228:231], v11 offset:12288
s_add_u32 s65, s65, s3
s_lshl_b32 s3, s101, 2
M a[104:107], a[176:179], a[232:235], a[104:107]
s_add_u32 s65, s65, s3
s_add_u32 s65, s65, 8400896
M a[108:111], a[184:187], a[232:235], a[108:111]
ds_read_b64_tr_b16 a[204:205], v14 offset:12288
ds_read_b64_tr_b16 a[206:207], v14 offset:13824
M a[108:111], a[188:191], a[236:239], a[108:111]
buffer_load_dwordx4 v8, s[12:15], s25 offen offset:2048 lds
s_mov_b32 s40, 0
v_mov_b32 v119, 0
M a[112:115], a[196:199], a[236:239], a[112:115]
s_mov_b64 s[4:5], s[50:51]
s_and_b32 s20, s2, 7
M a[112:115], a[192:195], a[232:235], a[112:115]
s_waitcnt lgkmcnt(10)
M a[116:119], a[176:179], a[240:243], a[116:119]
ds_read_b128 a[232:235], v10 offset:14336
ds_read_b128 a[236:239], v11 offset:14336
s_lshr_b32 s33, s2, 6
s_lshl_b32 s33, s33, 3
M a[116:119], a[180:183], a[244:247], a[116:119]
buffer_load_dwordx4 v9, s[12:15], s25 offen offset:3072 lds
s_add_u32 s20, s20, s33
s_bfe_u32 s21, s2, 0x30003
M a[120:123], a[188:191], a[244:247], a[120:123]
ds_read_b64_tr_b16 a[212:213], v15 offset:12288
ds_read_b64_tr_b16 a[214:215], v15 offset:13824
M a[120:123], a[184:187], a[240:243], a[120:123]
s_sub_u32 s35, 15, s21
s_cmp_lt_u32 s101, 2
s_cselect_b32 s35, s21, s35
M a[124:127], a[192:195], a[240:243], a[124:127]
s_add_u32 m0, s30, 102400
s_nop 0
buffer_load_dwordx4 v21, s[12:15], s25 offen offset:0 lds
s_lshl_b32 s33, s20, 7
s_lshl_b32 s34, s35, 3
M a[124:127], a[196:199], a[244:247], a[124:127]
s_waitcnt lgkmcnt(10)
M a[128:131], a[180:183], a[252:255], a[128:131]
ds_read_b128 a[240:243], v10 offset:16384
ds_read_b128 a[244:247], v11 offset:16384
s_add_u32 s33, s33, s34
s_and_b32 s34, s101, 1
M a[128:131], a[176:179], a[248:251], a[128:131]
s_lshl_b32 s34, s34, 2
s_add_u32 s33, s33, s34
M a[132:135], a[184:187], a[248:251], a[132:135]
ds_read_b64_tr_b16 a[220:221], v16 offset:12288
ds_read_b64_tr_b16 a[222:223], v16 offset:13824
M a[132:135], a[188:191], a[252:255], a[132:135]
buffer_load_dwordx4 v22, s[12:15], s25 offen offset:1024 lds
s_lshl_b32 s64, s33, 12
s_mov_b32 s44, s4
M a[136:139], a[196:199], a[252:255], a[136:139]
s_mov_b32 s45, s5
s_mov_b32 s46, 16777216
M a[136:139], a[192:195], a[248:251], a[136:139]
s_waitcnt lgkmcnt(10)
M a[140:143], a[176:179], a[224:227], a[140:143]
s_sub_u32 s54, s54, 1
s_cmp_eq_u32 s54, 0
s_cselect_b32 s58, s55, s56
s_add_u32 s25, s25, s58
s_mov_b32 s47, 0x00020000
M a[140:143], a[180:183], a[228:231], a[140:143]
M a[144:147], a[188:191], a[228:231], a[144:147]
M a[144:147], a[184:187], a[224:227], a[144:147]
M a[148:151], a[192:195], a[224:227], a[148:151]
s_waitcnt vmcnt(12) lgkmcnt(0)
s_barrier
ds_read_b128 a[248:251], v10 offset:18432
ds_read_b128 a[252:255], v11 offset:18432
M a[148:151], a[196:199], a[228:231], a[148:151]
s_add_u32 m0, s28, 0
s_nop 0
buffer_load_dword v20, s[8:11], s24 offen lds
M a[152:155], a[180:183], a[236:239], a[152:155]
ds_read_b128 a[224:227], v10 offset:20480
ds_read_b128 a[228:231], v11 offset:20480
M a[152:155], a[176:179], a[232:235], a[152:155]
M a[156:159], a[184:187], a[232:235], a[156:159]
buffer_load_dword v23, s[8:11], s24 offen offset:256 lds
M a[156:159], a[188:191], a[236:239], a[156:159]
M a[160:163], a[196:199], a[236:239], a[160:163]
M a[160:163], a[192:195], a[232:235], a[160:163]
s_add_u32 m0, s29, 2048
s_nop 0
buffer_load_dwordx4 v2, s[8:11], s23 offen offset:0 lds
M a[164:167], a[176:179], a[240:243], a[164:167]
ds_read_b128 a[232:235], v10 offset:22528
ds_read_b128 a[236:239], v11 offset:22528
M a[164:167], a[180:183], a[244:247], a[164:167]
M a[168:171], a[188:191], a[244:247], a[168:171]
M a[168:171], a[184:187], a[240:243], a[168:171]
buffer_load_dwordx4 v3, s[8:11], s23 offen offset:1024 lds
M a[172:175], a[192:195], a[240:243], a[172:175]
M a[172:175], a[196:199], a[244:247], a[172:175]
s_waitcnt lgkmcnt(4)
M a[68:71], a[200:203], a[248:251], a[68:71]
ds_read_b128 a[240:243], v10 offset:24576
ds_read_b128 a[244:247], v11 offset:24576
M a[68:71], a[204:207], a[252:255], a[68:71]
buffer_load_dwordx4 v4, s[8:11], s23 offen offset:2048 lds
M a[72:75], a[212:215], a[252:255], a[72:75]
ds_read_b64_tr_b16 a[176:177], v14 offset:28672
ds_read_b64_tr_b16 a[178:179], v14 offset:30208
M a[72:75], a[208:211], a[248:251], a[72:75]
M a[76:79], a[216:219], a[248:251], a[76:79]
buffer_load_dwordx4 v5, s[8:11], s23 offen offset:3072 lds
M a[76:79], a[220:223], a[252:255], a[76:79]
s_waitcnt lgkmcnt(6)
M a[80:83], a[204:207], a[228:231], a[80:83]
ds_read_b128 a[248:251], v10 offset:26624
ds_read_b128 a[252:255], v11 offset:26624
M a[80:83], a[200:203], a[224:227], a[80:83]
M a[84:87], a[208:211], a[224:227], a[84:87]
ds_read_b64_tr_b16 a[184:185], v15 offset:28672
ds_read_b64_tr_b16 a[186:187], v15 offset:30208
M a[84:87], a[212:215], a[228:231], a[84:87]
s_sub_u32 s31, s31, 1
s_cmp_eq_u32 s31, 0
s_cselect_b32 s58, -1920, s57
s_add_u32 s23, s23, s58
s_add_u32 s24, s24, s58
M a[88:91], a[220:223], a[228:231], a[88:91]
M a[88:91], a[216:219], a[224:227], a[88:91]
s_waitcnt lgkmcnt(8)
M a[92:95], a[200:203], a[232:235], a[92:95]
ds_read_b128 a[224:227], v10 offset:28672
ds_read_b128 a[228:231], v11 offset:28672
M a[92:95], a[204:207], a[236:239], a[92:95]
s_add_u32 m0, s30, 36864
s_nop 0
buffer_load_dwordx4 v6, s[12:15], s25 offen offset:0 lds
M a[96:99], a[212:215], a[236:239], a[96:99]
ds_read_b64_tr_b16 a[192:193], v16 offset:28672
ds_read_b64_tr_b16 a[194:195], v16 offset:30208
M a[96:99], a[208:211], a[232:235], a[96:99]
M a[100:103], a[216:219], a[232:235], a[100:103]
buffer_load_dwordx4 v7, s[12:15], s25 offen offset:1024 lds
M a[100:103], a[220:223], a[236:239], a[100:103]
s_waitcnt lgkmcnt(10)
M a[104:107], a[204:207], a[244:247], a[104:107]
ds_read_b128 a[232:235], v10 offset:30720
ds_read_b128 a[236:239], v11 offset:30720
M a[104:107], a[200:203], a[240:243], a[104:107]
M a[108:111], a[208:211], a[240:243], a[108:111]
ds_read_b64_tr_b16 a[180:181], v14 offset:40960
ds_read_b64_tr_b16 a[182:183], v14 offset:42496
M a[108:111], a[212:215], a[244:247], a[108:111]
buffer_load_dwordx4 v8, s[12:15], s25 offen offset:2048 lds
M a[112:115], a[220:223], a[244:247], a[112:115]
M a[112:115], a[216:219], a[240:243], a[112:115]
s_waitcnt lgkmcnt(10)
M a[116:119], a[200:203], a[248:251], a[116:119]
ds_read_b128 a[240:243], v10 offset:32768
ds_read_b128 a[244:247], v11 offset:32768
M a[116:119], a[204:207], a[252:255], a[116:119]
buffer_load_dwordx4 v9, s[12:15], s25 offen offset:3072 lds
M a[120:123], a[212:215], a[252:255], a[120:123]
ds_read_b64_tr_b16 a[188:189], v15 offset:40960
ds_read_b64_tr_b16 a[190:191], v15 offset:42496
M a[120:123], a[208:211], a[248:251], a[120:123]
M a[124:127], a[216:219], a[248:251], a[124:127]
s_add_u32 m0, s30, 40960
s_nop 0
buffer_load_dwordx4 v21, s[12:15], s25 offen offset:0 lds
M a[124:127], a[220:223], a[252:255], a[124:127]
s_waitcnt lgkmcnt(10)
M a[128:131], a[204:207], a[228:231], a[128:131]
ds_read_b128 a[248:251], v10 offset:34816
ds_read_b128 a[252:255], v11 offset:34816
M a[128:131], a[200:203], a[224:227], a[128:131]
M a[132:135], a[208:211], a[224:227], a[132:135]
ds_read_b64_tr_b16 a[196:197], v16 offset:40960
ds_read_b64_tr_b16 a[198:199], v16 offset:42496
M a[132:135], a[212:215], a[228:231], a[132:135]
buffer_load_dwordx4 v22, s[12:15], s25 offen offset:1024 lds
M a[136:139], a[220:223], a[228:231], a[136:139]
M a[136:139], a[216:219], a[224:227], a[136:139]
s_waitcnt lgkmcnt(10)
M a[140:143], a[200:203], a[232:235], a[140:143]
s_sub_u32 s54, s54, 1
s_cmp_eq_u32 s54, 0
s_cselect_b32 s58, s55, s56
s_add_u32 s25, s25, s58
M a[140:143], a[204:207], a[236:239], a[140:143]
M a[144:147], a[212:215], a[236:239], a[144:147]
M a[144:147], a[208:211], a[232:235], a[144:147]
M a[148:151], a[216:219], a[232:235], a[148:151]
s_waitcnt vmcnt(12) lgkmcnt(0)
s_barrier
ds_read_b128 a[224:227], v12 offset:0
ds_read_b128 a[228:231], v13 offset:0
M a[148:151], a[220:223], a[236:239], a[148:151]
s_add_u32 m0, s28, 18432
s_nop 0
buffer_load_dword v20, s[8:11], s24 offen lds
M a[152:155], a[204:207], a[244:247], a[152:155]
ds_read_b128 a[232:235], v12 offset:2048
ds_read_b128 a[236:239], v13 offset:2048
M a[152:155], a[200:203], a[240:243], a[152:155]
M a[156:159], a[208:211], a[240:243], a[156:159]
buffer_load_dword v23, s[8:11], s24 offen offset:256 lds
M a[156:159], a[212:215], a[244:247], a[156:159]
M a[160:163], a[220:223], a[244:247], a[160:163]
M a[160:163], a[216:219], a[240:243], a[160:163]
s_add_u32 m0, s29, 20480
s_nop 0
buffer_load_dwordx4 v2, s[8:11], s23 offen offset:0 lds
M a[164:167], a[200:203], a[248:251], a[164:167]
ds_read_b128 a[240:243], v12 offset:4096
ds_read_b128 a[244:247], v13 offset:4096
M a[164:167], a[204:207], a[252:255], a[164:167]
M a[168:171], a[212:215], a[252:255], a[168:171]
M a[168:171], a[208:211], a[248:251], a[168:171]
buffer_load_dwordx4 v3, s[8:11], s23 offen offset:1024 lds
M a[172:175], a[216:219], a[248:251], a[172:175]
M a[172:175], a[220:223], a[252:255], a[172:175]
s_waitcnt lgkmcnt(4)
M a[68:71], a[176:179], a[224:227], a[68:71]
ds_read_b128 a[248:251], v12 offset:6144
ds_read_b128 a[252:255], v13 offset:6144
M a[68:71], a[180:183], a[228:231], a[68:71]
buffer_load_dwordx4 v4, s[8:11], s23 offen offset:2048 lds
M a[72:75], a[188:191], a[228:231], a[72:75]
ds_read_b64_tr_b16 a[200:201], v17 offset:0
ds_read_b64_tr_b16 a[202:203], v17 offset:1536
M a[72:75], a[184:187], a[224:227], a[72:75]
M a[76:79], a[192:195], a[224:227], a[76:79]
buffer_load_dwordx4 v5, s[8:11], s23 offen offset:3072 lds
M a[76:79], a[196:199], a[228:231], a[76:79]
s_waitcnt lgkmcnt(6)
M a[80:83], a[180:183], a[236:239], a[80:83]
ds_read_b128 a[224:227], v12 offset:8192
ds_read_b128 a[228:231], v13 offset:8192
M a[80:83], a[176:179], a[232:235], a[80:83]
s_sub_u32 s31, s31, 1
s_cmp_eq_u32 s31, 0
s_cselect_b32 s58, -1920, s57
s_add_u32 s23, s23, s58
s_add_u32 s24, s24, s58
M a[84:87], a[184:187], a[232:235], a[84:87]
ds_read_b64_tr_b16 a[208:209], v18 offset:0
ds_read_b64_tr_b16 a[210:211], v18 offset:1536
M a[84:87], a[188:191], a[236:239], a[84:87]
M a[88:91], a[196:199], a[236:239], a[88:91]
M a[88:91], a[192:195], a[232:235], a[88:91]
s_add_u32 m0, s30, 65536
s_nop 0
buffer_load_dwordx4 v6, s[12:15], s25 offen offset:0 lds
s_waitcnt lgkmcnt(8)
M a[92:95], a[176:179], a[240:243], a[92:95]
ds_read_b128 a[232:235], v12 offset:10240
ds_read_b128 a[236:239], v13 offset:10240
M a[92:95], a[180:183], a[244:247], a[92:95]
M a[96:99], a[188:191], a[244:247], a[96:99]
ds_read_b64_tr_b16 a[216:217], v19 offset:0
ds_read_b64_tr_b16 a[218:219], v19 offset:1536
M a[96:99], a[184:187], a[240:243], a[96:99]
buffer_load_dwordx4 v7, s[12:15], s25 offen offset:1024 lds
M a[100:103], a[192:195], a[240:243], a[100:103]
M a[100:103], a[196:199], a[244:247], a[100:103]
s_waitcnt lgkmcnt(10)
M a[104:107], a[180:183], a[252:255], a[104:107]
ds_read_b128 a[240:243], v12 offset:12288
ds_read_b128 a[244:247], v13 offset:12288
M a[104:107], a[176:179], a[248:251], a[104:107]
buffer_load_dwordx4 v8, s[12:15], s25 offen offset:2048 lds
M a[108:111], a[184:187], a[248:251], a[108:111]
ds_read_b64_tr_b16 a[204:205], v17 offset:12288
ds_read_b64_tr_b16 a[206:207], v17 offset:13824
M a[108:111], a[188:191], a[252:255], a[108:111]
M a[112:115], a[196:199], a[252:255], a[112:115]
buffer_load_dwordx4 v9, s[12:15], s25 offen offset:3072 lds
M a[112:115], a[192:195], a[248:251], a[112:115]
s_waitcnt lgkmcnt(10)
M a[116:119], a[176:179], a[224:227], a[116:119]
ds_read_b128 a[248:251], v12 offset:14336
ds_read_b128 a[252:255], v13 offset:14336
M a[116:119], a[180:183], a[228:231], a[116:119]
M a[120:123], a[188:191], a[228:231], a[120:123]
ds_read_b64_tr_b16 a[212:213], v18 offset:12288
ds_read_b64_tr_b16 a[214:215], v18 offset:13824
M a[120:123], a[184:187], a[224:227], a[120:123]
s_add_u32 m0, s30, 69632
s_nop 0
buffer_load_dwordx4 v21, s[12:15], s25 offen offset:0 lds
M a[124:127], a[192:195], a[224:227], a[124:127]
M a[124:127], a[196:199], a[228:231], a[124:127]
buffer_load_dwordx4 v22, s[12:15], s25 offen offset:1024 lds
s_waitcnt lgkmcnt(10)
M a[128:131], a[180:183], a[236:239], a[128:131]
ds_read_b128 a[224:227], v12 offset:16384
ds_read_b128 a[228:231], v13 offset:16384
M a[128:131], a[176:179], a[232:235], a[128:131]
M a[132:135], a[184:187], a[232:235], a[132:135]
ds_read_b64_tr_b16 a[220:221], v19 offset:12288
ds_read_b64_tr_b16 a[222:223], v19 offset:13824
M a[132:135], a[188:191], a[236:239], a[132:135]
M a[136:139], a[196:199], a[236:239], a[136:139]
s_sub_u32 s54, s54, 1
s_cmp_eq_u32 s54, 0
s_cselect_b32 s58, s55, s56
s_add_u32 s25, s25, s58
M a[136:139], a[192:195], a[232:235], a[136:139]
s_waitcnt lgkmcnt(10)
M a[140:143], a[176:179], a[240:243], a[140:143]
buffer_load_dword v125, v119, s[36:39], 0 offen sc1
M a[140:143], a[180:183], a[244:247], a[140:143]
M a[144:147], a[188:191], a[244:247], a[144:147]
M a[144:147], a[184:187], a[240:243], a[144:147]
M a[148:151], a[192:195], a[240:243], a[148:151]
s_waitcnt vmcnt(13) lgkmcnt(0)
s_barrier
ds_read_b128 a[232:235], v10 offset:0
ds_read_b128 a[236:239], v11 offset:0
s_waitcnt vmcnt(0)
v_cmp_gt_u32 vcc, 0x80, v125
s_nop 0
s_cbranch_vccnz Lk1_spinq
Lk1_gotq:
M a[148:151], a[196:199], a[244:247], a[148:151]
s_add_u32 m0, s28, 131072
s_nop 0
buffer_load_dword v20, s[8:11], s24 offen lds
M a[152:155], a[180:183], a[252:255], a[152:155]
ds_read_b128 a[240:243], v10 offset:2048
ds_read_b128 a[244:247], v11 offset:2048
M a[152:155], a[176:179], a[248:251], a[152:155]
M a[156:159], a[184:187], a[248:251], a[156:159]
buffer_load_dword v23, s[8:11], s24 offen offset:256 lds
M a[156:159], a[188:191], a[252:255], a[156:159]
M a[160:163], a[196:199], a[252:255], a[160:163]
M a[160:163], a[192:195], a[248:251], a[160:163]
s_add_u32 m0, s29, 133120
s_nop 0
buffer_load_dwordx4 v2, s[8:11], s23 offen offset:0 lds
M a[164:167], a[176:179], a[224:227], a[164:167]
ds_read_b128 a[248:251], v10 offset:4096
ds_read_b128 a[252:255], v11 offset:4096
M a[164:167], a[180:183], a[228:231], a[164:167]
M a[168:171], a[188:191], a[228:231], a[168:171]
M a[168:171], a[184:187], a[224:227], a[168:171]
buffer_load_dwordx4 v3, s[8:11], s23 offen offset:1024 lds
M a[172:175], a[192:195], a[224:227], a[172:175]
M a[172:175], a[196:199], a[228:231], a[172:175]
s_waitcnt lgkmcnt(4)
M a[68:71], a[200:203], a[232:235], a[68:71]
ds_read_b128 a[224:227], v10 offset:6144
ds_read_b128 a[228:231], v11 offset:6144
v_mov_b32 v208, 0
v_mov_b32 v209, 0
M a[68:71], a[204:207], a[236:239], a[68:71]
buffer_load_dwordx4 v4, s[8:11], s23 offen offset:2048 lds
M a[72:75], a[212:215], a[236:239], a[72:75]
ds_read_b64_tr_b16 a[176:177], v14 offset:0
ds_read_b64_tr_b16 a[178:179], v14 offset:1536
v_mov_b32 v210, 0
v_mov_b32 v211, 0
M a[72:75], a[208:211], a[232:235], a[72:75]
M a[76:79], a[216:219], a[232:235], a[76:79]
buffer_load_dwordx4 v5, s[8:11], s23 offen offset:3072 lds
v_mov_b32 v212, 0
v_mov_b32 v213, 0
M a[76:79], a[220:223], a[236:239], a[76:79]
s_waitcnt lgkmcnt(6)
M a[80:83], a[204:207], a[244:247], a[80:83]
ds_read_b128 a[232:235], v10 offset:8192
ds_read_b128 a[236:239], v11 offset:8192
v_mov_b32 v214, 0
v_mov_b32 v215, 0
M a[80:83], a[200:203], a[240:243], a[80:83]
s_sub_u32 s31, s31, 1
s_cmp_eq_u32 s31, 0
s_cselect_b32 s58, -1920, s57
s_add_u32 s23, s23, s58
s_add_u32 s24, s24, s58
M a[84:87], a[208:211], a[240:243], a[84:87]
ds_read_b64_tr_b16 a[184:185], v15 offset:0
ds_read_b64_tr_b16 a[186:187], v15 offset:1536
M a[84:87], a[212:215], a[244:247], a[84:87]
v_mov_b32 v216, 0
v_mov_b32 v217, 0
M a[88:91], a[220:223], a[244:247], a[88:91]
M a[88:91], a[216:219], a[240:243], a[88:91]
buffer_load_dwordx4 a[0:3], v1, s[44:47], s64 offen offset:0 sc1
s_waitcnt lgkmcnt(8)
v_mov_b32 v218, 0
v_mov_b32 v219, 0
M a[92:95], a[200:203], a[248:251], a[92:95]
ds_read_b128 a[240:243], v10 offset:10240
ds_read_b128 a[244:247], v11 offset:10240
M a[92:95], a[204:207], a[252:255], a[92:95]
v_mov_b32 v220, 0
v_mov_b32 v221, 0
M a[96:99], a[212:215], a[252:255], a[96:99]
ds_read_b64_tr_b16 a[192:193], v16 offset:0
ds_read_b64_tr_b16 a[194:195], v16 offset:1536
M a[96:99], a[208:211], a[248:251], a[96:99]
buffer_load_dwordx4 a[4:7], v1, s[44:47], s64 offen offset:1024 sc1
v_mov_b32 v222, 0
v_mov_b32 v223, 0
M a[100:103], a[216:219], a[248:251], a[100:103]
M a[100:103], a[220:223], a[252:255], a[100:103]
s_waitcnt lgkmcnt(10)
M a[104:107], a[204:207], a[228:231], a[104:107]
ds_read_b128 a[248:251], v10 offset:12288
ds_read_b128 a[252:255], v11 offset:12288
v_mov_b32 v224, 0
v_mov_b32 v225, 0
M a[104:107], a[200:203], a[224:227], a[104:107]
buffer_load_dwordx4 a[8:11], v1, s[44:47], s64 offen offset:2048 sc1
M a[108:111], a[208:211], a[224:227], a[108:111]
ds_read_b64_tr_b16 a[180:181], v14 offset:12288
ds_read_b64_tr_b16 a[182:183], v14 offset:13824
v_mov_b32 v226, 0
v_mov_b32 v227, 0
M a[108:111], a[212:215], a[228:231], a[108:111]
M a[112:115], a[220:223], a[228:231], a[112:115]
buffer_load_dwordx4 a[12:15], v1, s[44:47], s64 offen offset:3072 sc1
s_add_u32 s64, s64, 4096
v_mov_b32 v228, 0
v_mov_b32 v229, 0
M a[112:115], a[216:219], a[224:227], a[112:115]
s_waitcnt lgkmcnt(10)
M a[116:119], a[200:203], a[232:235], a[116:119]
ds_read_b128 a[224:227], v10 offset:14336
ds_read_b128 a[228:231], v11 offset:14336
v_mov_b32 v230, 0
v_mov_b32 v231, 0
M a[116:119], a[204:207], a[236:239], a[116:119]
M a[120:123], a[212:215], a[236:239], a[120:123]
ds_read_b64_tr_b16 a[188:189], v15 offset:12288
ds_read_b64_tr_b16 a[190:191], v15 offset:13824
M a[120:123], a[208:211], a[232:235], a[120:123]
buffer_load_dwordx4 a[16:19], v1, s[44:47], s64 offen offset:0 sc1
v_mov_b32 v232, 0
v_mov_b32 v233, 0
M a[124:127], a[216:219], a[232:235], a[124:127]
M a[124:127], a[220:223], a[236:239], a[124:127]
buffer_load_dwordx4 a[20:23], v1, s[44:47], s64 offen offset:1024 sc1
s_waitcnt lgkmcnt(10)
v_mov_b32 v234, 0
v_mov_b32 v235, 0
M a[128:131], a[204:207], a[244:247], a[128:131]
ds_read_b128 a[232:235], v10 offset:16384
ds_read_b128 a[236:239], v11 offset:16384
M a[128:131], a[200:203], a[240:243], a[128:131]
v_mov_b32 v236, 0
v_mov_b32 v237, 0
M a[132:135], a[208:211], a[240:243], a[132:135]
ds_read_b64_tr_b16 a[196:197], v16 offset:12288
ds_read_b64_tr_b16 a[198:199], v16 offset:13824
M a[132:135], a[212:215], a[244:247], a[132:135]
v_mov_b32 v238, 0
v_mov_b32 v239, 0
M a[136:139], a[220:223], a[244:247], a[136:139]
buffer_load_dwordx4 a[24:27], v1, s[44:47], s64 offen offset:2048 sc1
M a[136:139], a[216:219], a[240:243], a[136:139]
s_waitcnt lgkmcnt(10)
M a[140:143], a[200:203], a[248:251], a[140:143]
buffer_load_dwordx4 a[28:31], v1, s[44:47], s64 offen offset:3072 sc1
s_add_u32 s64, s64, 4096
v_mov_b32 v240, 0
v_mov_b32 v241, 0
M a[140:143], a[204:207], a[252:255], a[140:143]
M a[144:147], a[212:215], a[252:255], a[144:147]
v_mov_b32 v242, 0
v_mov_b32 v243, 0
M a[144:147], a[208:211], a[248:251], a[144:147]
M a[148:151], a[216:219], a[248:251], a[148:151]
s_waitcnt vmcnt(15) lgkmcnt(0)
s_barrier
ds_read_b128 a[240:243], v10 offset:18432
ds_read_b128 a[244:247], v11 offset:18432
v_mov_b32 v244, 0
v_mov_b32 v245, 0
M a[148:151], a[220:223], a[252:255], a[148:151]
buffer_load_dwordx4 a[32:35], v1, s[44:47], s64 offen offset:0 sc1
M a[152:155], a[204:207], a[228:231], a[152:155]
ds_read_b128 a[248:251], v10 offset:20480
ds_read_b128 a[252:255], v11 offset:20480
v_mov_b32 v246, 0
v_mov_b32 v247, 0
M a[152:155], a[200:203], a[224:227], a[152:155]
M a[156:159], a[208:211], a[224:227], a[156:159]
buffer_load_dwordx4 a[36:39], v1, s[44:47], s64 offen offset:1024 sc1
M a[156:159], a[212:215], a[228:231], a[156:159]
v_mov_b32 v248, 0
v_mov_b32 v249, 0
M a[160:163], a[220:223], a[228:231], a[160:163]
M a[160:163], a[216:219], a[224:227], a[160:163]
buffer_load_dwordx4 a[40:43], v1, s[44:47], s64 offen offset:2048 sc1
v_mov_b32 v250, 0
v_mov_b32 v251, 0
M a[164:167], a[200:203], a[232:235], a[164:167]
ds_read_b128 a[224:227], v10 offset:22528
ds_read_b128 a[228:231], v11 offset:22528
M a[164:167], a[204:207], a[236:239], a[164:167]
v_mov_b32 v252, 0
v_mov_b32 v253, 0
M a[168:171], a[212:215], a[236:239], a[168:171]
M a[168:171], a[208:211], a[232:235], a[168:171]
buffer_load_dwordx4 a[44:47], v1, s[44:47], s64 offen offset:3072 sc1
s_add_u32 s64, s64, 4096
v_mov_b32 v254, 0
v_mov_b32 v255, 0
M a[172:175], a[216:219], a[232:235], a[172:175]
M a[172:175], a[220:223], a[236:239], a[172:175]
s_waitcnt lgkmcnt(4)
M a[68:71], a[176:179], a[240:243], a[68:71]
ds_read_b128 a[232:235], v10 offset:24576
ds_read_b128 a[236:239], v11 offset:24576
s_mov_b32 s22, s101
s_and_b32 s23, s22, 1
M a[68:71], a[180:183], a[244:247], a[68:71]
buffer_load_dwordx4 a[48:51], v1, s[44:47], s64 offen offset:0 sc1
M a[72:75], a[188:191], a[244:247], a[72:75]
ds_read_b64_tr_b16 a[200:201], v14 offset:28672
ds_read_b64_tr_b16 a[202:203], v14 offset:30208
s_lshr_b32 s24, s22, 1
s_lshl_b32 s33, s24, 14
M a[72:75], a[184:187], a[240:243], a[72:75]
M a[76:79], a[192:195], a[240:243], a[76:79]
M a[76:79], a[196:199], a[244:247], a[76:79]
s_waitcnt lgkmcnt(6)
s_lshl_b32 s34, s23, 13
s_add_u32 s29, s33, s34
M a[80:83], a[180:183], a[252:255], a[80:83]
ds_read_b128 a[240:243], v10 offset:26624
ds_read_b128 a[244:247], v11 offset:26624
M a[80:83], a[176:179], a[248:251], a[80:83]
s_lshl_b32 s28, s20, 20
s_add_u32 s28, s28, s34
M a[84:87], a[184:187], a[248:251], a[84:87]
ds_read_b64_tr_b16 a[208:209], v15 offset:28672
ds_read_b64_tr_b16 a[210:211], v15 offset:30208
M a[84:87], a[188:191], a[252:255], a[84:87]
buffer_load_dwordx4 a[52:55], v1, s[44:47], s64 offen offset:1024 sc1
M a[88:91], a[196:199], a[252:255], a[88:91]
s_mov_b32 s25, s28
s_lshl_b32 s33, s21, 16
M a[88:91], a[192:195], a[248:251], a[88:91]
s_waitcnt lgkmcnt(8)
M a[92:95], a[176:179], a[224:227], a[92:95]
ds_read_b128 a[248:251], v10 offset:28672
ds_read_b128 a[252:255], v11 offset:28672
s_add_u32 s34, s28, s33
s_add_u32 s34, s34, 65536
M a[92:95], a[180:183], a[228:231], a[92:95]
M a[96:99], a[188:191], a[228:231], a[96:99]
ds_read_b64_tr_b16 a[216:217], v16 offset:28672
ds_read_b64_tr_b16 a[218:219], v16 offset:30208
M a[96:99], a[184:187], a[224:227], a[96:99]
s_add_u32 s32, s28, 491520
s_sub_u32 s33, s32, s33
M a[100:103], a[192:195], a[224:227], a[100:103]
buffer_load_dwordx4 a[56:59], v1, s[44:47], s64 offen offset:2048 sc1
M a[100:103], a[196:199], a[228:231], a[100:103]
s_waitcnt lgkmcnt(10)
s_add_u32 s33, s33, 491520
s_cmp_eq_u32 s24, 0
s_cselect_b32 s27, s34, s32
s_cselect_b32 s28, s32, s33
M a[104:107], a[180:183], a[236:239], a[104:107]
ds_read_b128 a[224:227], v10 offset:30720
ds_read_b128 a[228:231], v11 offset:30720
M a[104:107], a[176:179], a[232:235], a[104:107]
M a[108:111], a[184:187], a[232:235], a[108:111]
ds_read_b64_tr_b16 a[204:205], v14 offset:40960
ds_read_b64_tr_b16 a[206:207], v14 offset:42496
s_add_u32 s26, s25, 16384
s_add_u32 s62, s27, 16384
M a[108:111], a[188:191], a[236:239], a[108:111]
M a[112:115], a[196:199], a[236:239], a[112:115]
s_add_u32 s63, s28, 16384
s_lshl_b32 s31, s21, 7
M a[112:115], a[192:195], a[232:235], a[112:115]
s_waitcnt lgkmcnt(10)
M a[116:119], a[176:179], a[240:243], a[116:119]
ds_read_b128 a[232:235], v10 offset:32768
ds_read_b128 a[236:239], v11 offset:32768
M a[116:119], a[180:183], a[244:247], a[116:119]
buffer_load_dwordx4 a[60:63], v1, s[44:47], s64 offen offset:3072 sc1
s_cmp_eq_u32 s24, 0
s_cselect_b32 s31, s31, 960
M a[120:123], a[188:191], a[244:247], a[120:123]
ds_read_b64_tr_b16 a[212:213], v15 offset:40960
ds_read_b64_tr_b16 a[214:215], v15 offset:42496
M a[120:123], a[184:187], a[240:243], a[120:123]
s_mov_b32 s60, 0
s_add_u32 s12, s4, 16777216
s_addc_u32 s13, s5, 0
M a[124:127], a[192:195], a[240:243], a[124:127]
M a[124:127], a[196:199], a[244:247], a[124:127]
s_waitcnt lgkmcnt(10)
M a[128:131], a[180:183], a[252:255], a[128:131]
ds_read_b128 a[240:243], v10 offset:34816
ds_read_b128 a[244:247], v11 offset:34816
s_mov_b32 s14, 33554432
s_mov_b32 s15, 0x00020000
M a[128:131], a[176:179], a[248:251], a[128:131]
M a[132:135], a[184:187], a[248:251], a[132:135]
ds_read_b64_tr_b16 a[220:221], v16 offset:40960
ds_read_b64_tr_b16 a[222:223], v16 offset:42496
s_mov_b32 s8, s4
s_mov_b32 s9, s5
M a[132:135], a[188:191], a[252:255], a[132:135]
buffer_load_dword v126, v119, s[36:39], 0 offen offset:128 sc1
M a[136:139], a[196:199], a[252:255], a[136:139]
M a[136:139], a[192:195], a[248:251], a[136:139]
s_waitcnt lgkmcnt(10)
s_mov_b32 s10, 16777216
s_mov_b32 s11, 0x00020000
M a[140:143], a[176:179], a[224:227], a[140:143]
M a[140:143], a[180:183], a[228:231], a[140:143]
M a[144:147], a[188:191], a[228:231], a[144:147]
M a[144:147], a[184:187], a[224:227], a[144:147]
M a[148:151], a[192:195], a[224:227], a[148:151]
s_waitcnt vmcnt(17) lgkmcnt(0)
s_barrier
ds_read_b128 a[248:251], v12 offset:0
ds_read_b128 a[252:255], v13 offset:0
s_waitcnt vmcnt(0)
v_cmp_gt_u32 vcc, 0x80, v126
s_nop 0
s_cbranch_vccnz Lk1_spin
Lk1_got:
M a[148:151], a[196:199], a[228:231], a[148:151]
s_add_u32 m0, s29, 65536
s_add_u32 s32, s25, 4096
buffer_load_dwordx4 v1, s[12:15], s25 offen offset:0 sc1 lds
M a[152:155], a[180:183], a[236:239], a[152:155]
ds_read_b128 a[224:227], v12 offset:2048
ds_read_b128 a[228:231], v13 offset:2048
M a[152:155], a[176:179], a[232:235], a[152:155]
buffer_load_dwordx4 v1, s[12:15], s25 offen offset:1024 sc1 lds
M a[156:159], a[184:187], a[232:235], a[156:159]
M a[156:159], a[188:191], a[236:239], a[156:159]
buffer_load_dwordx4 v1, s[12:15], s25 offen offset:2048 sc1 lds
M a[160:163], a[196:199], a[236:239], a[160:163]
buffer_load_dwordx4 v1, s[12:15], s25 offen offset:3072 sc1 lds
M a[160:163], a[192:195], a[232:235], a[160:163]
M a[164:167], a[176:179], a[240:243], a[164:167]
ds_read_b128 a[232:235], v12 offset:4096
ds_read_b128 a[236:239], v13 offset:4096
M a[164:167], a[180:183], a[244:247], a[164:167]
s_add_u32 m0, s29, 69632
s_nop 0
buffer_load_dwordx4 v1, s[12:15], s32 offen offset:0 sc1 lds
M a[168:171], a[188:191], a[244:247], a[168:171]
buffer_load_dwordx4 v1, s[12:15], s32 offen offset:1024 sc1 lds
M a[168:171], a[184:187], a[240:243], a[168:171]
M a[172:175], a[192:195], a[240:243], a[172:175]
buffer_load_dwordx4 v1, s[12:15], s32 offen offset:2048 sc1 lds
M a[172:175], a[196:199], a[244:247], a[172:175]
s_waitcnt lgkmcnt(4)
M a[68:71], a[200:203], a[248:251], a[68:71]
ds_read_b128 a[240:243], v12 offset:6144
ds_read_b128 a[244:247], v13 offset:6144
M a[68:71], a[204:207], a[252:255], a[68:71]
buffer_load_dwordx4 v1, s[12:15], s32 offen offset:3072 sc1 lds
M a[72:75], a[212:215], a[252:255], a[72:75]
M a[72:75], a[208:211], a[248:251], a[72:75]
M a[76:79], a[216:219], a[248:251], a[76:79]
M a[76:79], a[220:223], a[252:255], a[76:79]
s_waitcnt lgkmcnt(4)
M a[80:83], a[204:207], a[228:231], a[80:83]
ds_read_b128 a[248:251], v12 offset:8192
ds_read_b128 a[252:255], v13 offset:8192
M a[80:83], a[200:203], a[224:227], a[80:83]
M a[84:87], a[208:211], a[224:227], a[84:87]
M a[84:87], a[212:215], a[228:231], a[84:87]
M a[88:91], a[220:223], a[228:231], a[88:91]
M a[88:91], a[216:219], a[224:227], a[88:91]
s_waitcnt lgkmcnt(4)
M a[92:95], a[200:203], a[232:235], a[92:95]
ds_read_b128 a[224:227], v12 offset:10240
ds_read_b128 a[228:231], v13 offset:10240
v_accvgpr_read_b32 v24, a68
v_accvgpr_read_b32 v25, a69
v_accvgpr_read_b32 v26, a70
M a[92:95], a[204:207], a[236:239], a[92:95]
v_accvgpr_read_b32 v27, a71
v_cvt_pk_bf16_f32 v24, v24, v25
v_cvt_pk_bf16_f32 v25, v26, v27
ds_write_b64 v124, v[24:25] offset:0
M a[96:99], a[212:215], a[236:239], a[96:99]
v_accvgpr_read_b32 v28, a72
v_accvgpr_read_b32 v29, a73
v_accvgpr_read_b32 v30, a74
M a[96:99], a[208:211], a[232:235], a[96:99]
v_accvgpr_read_b32 v31, a75
v_cvt_pk_bf16_f32 v28, v28, v29
v_cvt_pk_bf16_f32 v29, v30, v31
ds_write_b64 v124, v[28:29] offset:32
M a[100:103], a[216:219], a[232:235], a[100:103]
v_accvgpr_read_b32 v24, a76
v_accvgpr_read_b32 v25, a77
v_accvgpr_read_b32 v26, a78
M a[100:103], a[220:223], a[236:239], a[100:103]
s_waitcnt lgkmcnt(6)
v_accvgpr_read_b32 v27, a79
v_cvt_pk_bf16_f32 v24, v24, v25
v_cvt_pk_bf16_f32 v25, v26, v27
ds_write_b64 v124, v[24:25] offset:64
M a[104:107], a[204:207], a[244:247], a[104:107]
ds_read_b128 a[232:235], v12 offset:12288
ds_read_b128 a[236:239], v13 offset:12288
v_accvgpr_read_b32 v24, a80
v_accvgpr_read_b32 v25, a81
v_accvgpr_read_b32 v26, a82
M a[104:107], a[200:203], a[240:243], a[104:107]
v_accvgpr_read_b32 v27, a83
v_cvt_pk_bf16_f32 v24, v24, v25
v_cvt_pk_bf16_f32 v25, v26, v27
ds_write_b64 v124, v[24:25] offset:6400
M a[108:111], a[208:211], a[240:243], a[108:111]
v_accvgpr_read_b32 v28, a84
v_accvgpr_read_b32 v29, a85
v_accvgpr_read_b32 v30, a86
M a[108:111], a[212:215], a[244:247], a[108:111]
v_accvgpr_read_b32 v31, a87
v_cvt_pk_bf16_f32 v28, v28, v29
v_cvt_pk_bf16_f32 v29, v30, v31
ds_write_b64 v124, v[28:29] offset:6432
M a[112:115], a[220:223], a[244:247], a[112:115]
v_accvgpr_read_b32 v24, a88
v_accvgpr_read_b32 v25, a89
v_accvgpr_read_b32 v26, a90
M a[112:115], a[216:219], a[240:243], a[112:115]
s_waitcnt lgkmcnt(9)
v_accvgpr_read_b32 v27, a91
v_cvt_pk_bf16_f32 v24, v24, v25
v_cvt_pk_bf16_f32 v25, v26, v27
ds_write_b64 v124, v[24:25] offset:6464
M a[116:119], a[200:203], a[248:251], a[116:119]
ds_read_b128 a[240:243], v12 offset:14336
ds_read_b128 a[244:247], v13 offset:14336
v_accvgpr_read_b32 v24, a92
v_accvgpr_read_b32 v25, a93
v_accvgpr_read_b32 v26, a94
M a[116:119], a[204:207], a[252:255], a[116:119]
v_accvgpr_read_b32 v27, a95
v_cvt_pk_bf16_f32 v24, v24, v25
v_cvt_pk_bf16_f32 v25, v26, v27
ds_write_b64 v124, v[24:25] offset:12800
M a[120:123], a[212:215], a[252:255], a[120:123]
v_accvgpr_read_b32 v28, a96
v_accvgpr_read_b32 v29, a97
v_accvgpr_read_b32 v30, a98
M a[120:123], a[208:211], a[248:251], a[120:123]
v_accvgpr_read_b32 v31, a99
v_cvt_pk_bf16_f32 v28, v28, v29
v_cvt_pk_bf16_f32 v29, v30, v31
ds_write_b64 v124, v[28:29] offset:12832
M a[124:127], a[216:219], a[248:251], a[124:127]
v_accvgpr_read_b32 v24, a100
v_accvgpr_read_b32 v25, a101
v_accvgpr_read_b32 v26, a102
M a[124:127], a[220:223], a[252:255], a[124:127]
s_add_u32 s25, s25, 32768
s_cmp_eq_u32 s25, s27
s_cselect_b32 s25, s28, s25
s_cselect_b32 s27, -1, s27
s_waitcnt lgkmcnt(12)
v_accvgpr_read_b32 v27, a103
v_cvt_pk_bf16_f32 v24, v24, v25
v_cvt_pk_bf16_f32 v25, v26, v27
ds_write_b64 v124, v[24:25] offset:12864
M a[128:131], a[204:207], a[228:231], a[128:131]
ds_read_b128 a[248:251], v12 offset:16384
ds_read_b128 a[252:255], v13 offset:16384
v_accvgpr_read_b32 v24, a104
v_accvgpr_read_b32 v25, a105
v_accvgpr_read_b32 v26, a106
M a[128:131], a[200:203], a[224:227], a[128:131]
v_accvgpr_read_b32 v27, a107
v_cvt_pk_bf16_f32 v24, v24, v25
v_cvt_pk_bf16_f32 v25, v26, v27
ds_write_b64 v124, v[24:25] offset:19200
M a[132:135], a[208:211], a[224:227], a[132:135]
v_accvgpr_read_b32 v28, a108
v_accvgpr_read_b32 v29, a109
v_accvgpr_read_b32 v30, a110
M a[132:135], a[212:215], a[228:231], a[132:135]
v_accvgpr_read_b32 v31, a111
v_cvt_pk_bf16_f32 v28, v28, v29
v_cvt_pk_bf16_f32 v29, v30, v31
ds_write_b64 v124, v[28:29] offset:19232
M a[136:139], a[220:223], a[228:231], a[136:139]
v_accvgpr_read_b32 v24, a112
v_accvgpr_read_b32 v25, a113
v_accvgpr_read_b32 v26, a114
M a[136:139], a[216:219], a[224:227], a[136:139]
s_waitcnt lgkmcnt(12)
v_accvgpr_read_b32 v27, a115
v_cvt_pk_bf16_f32 v24, v24, v25
v_cvt_pk_bf16_f32 v25, v26, v27
ds_write_b64 v124, v[24:25] offset:19264
M a[140:143], a[200:203], a[232:235], a[140:143]
v_accvgpr_read_b32 v24, a116
v_accvgpr_read_b32 v25, a117
v_accvgpr_read_b32 v26, a118
M a[140:143], a[204:207], a[236:239], a[140:143]
v_accvgpr_read_b32 v27, a119
v_cvt_pk_bf16_f32 v24, v24, v25
v_cvt_pk_bf16_f32 v25, v26, v27
ds_write_b64 v124, v[24:25] offset:25600
M a[144:147], a[212:215], a[236:239], a[144:147]
v_accvgpr_read_b32 v28, a120
v_accvgpr_read_b32 v29, a121
v_accvgpr_read_b32 v30, a122
M a[144:147], a[208:211], a[232:235], a[144:147]
v_accvgpr_read_b32 v31, a123
v_cvt_pk_bf16_f32 v28, v28, v29
v_cvt_pk_bf16_f32 v29, v30, v31
ds_write_b64 v124, v[28:29] offset:25632
M a[148:151], a[216:219], a[232:235], a[148:151]
s_waitcnt lgkmcnt(0)
s_barrier
v_accvgpr_read_b32 v24, a124
v_accvgpr_read_b32 v25, a125
v_accvgpr_read_b32 v26, a126
M a[148:151], a[220:223], a[236:239], a[148:151]
v_accvgpr_read_b32 v27, a127
v_cvt_pk_bf16_f32 v24, v24, v25
v_cvt_pk_bf16_f32 v25, v26, v27
ds_write_b64 v124, v[24:25] offset:25664
v_accvgpr_read_b32 v24, a128
v_accvgpr_read_b32 v25, a129
v_accvgpr_read_b32 v26, a130
M a[152:155], a[204:207], a[244:247], a[152:155]
v_accvgpr_read_b32 v27, a131
v_cvt_pk_bf16_f32 v24, v24, v25
v_cvt_pk_bf16_f32 v25, v26, v27
M a[152:155], a[200:203], a[240:243], a[152:155]
ds_write_b64 v124, v[24:25] offset:32000
v_accvgpr_read_b32 v28, a132
v_accvgpr_read_b32 v29, a133
M a[156:159], a[208:211], a[240:243], a[156:159]
v_accvgpr_read_b32 v30, a134
v_accvgpr_read_b32 v31, a135
v_cvt_pk_bf16_f32 v28, v28, v29
M a[156:159], a[212:215], a[244:247], a[156:159]
v_cvt_pk_bf16_f32 v29, v30, v31
ds_write_b64 v124, v[28:29] offset:32032
v_accvgpr_read_b32 v24, a136
M a[160:163], a[220:223], a[244:247], a[160:163]
v_accvgpr_read_b32 v25, a137
v_accvgpr_read_b32 v26, a138
v_accvgpr_read_b32 v27, a139
M a[160:163], a[216:219], a[240:243], a[160:163]
v_cvt_pk_bf16_f32 v24, v24, v25
v_cvt_pk_bf16_f32 v25, v26, v27
ds_write_b64 v124, v[24:25] offset:32064
M a[164:167], a[200:203], a[248:251], a[164:167]
v_accvgpr_read_b32 v24, a140
v_accvgpr_read_b32 v25, a141
v_accvgpr_read_b32 v26, a142
M a[164:167], a[204:207], a[252:255], a[164:167]
v_accvgpr_read_b32 v27, a143
v_cvt_pk_bf16_f32 v24, v24, v25
v_cvt_pk_bf16_f32 v25, v26, v27
ds_write_b64 v124, v[24:25] offset:38400
M a[168:171], a[212:215], a[252:255], a[168:171]
v_accvgpr_read_b32 v28, a144
v_accvgpr_read_b32 v29, a145
v_accvgpr_read_b32 v30, a146
M a[168:171], a[208:211], a[248:251], a[168:171]
v_accvgpr_read_b32 v31, a147
v_cvt_pk_bf16_f32 v28, v28, v29
v_cvt_pk_bf16_f32 v29, v30, v31
ds_write_b64 v124, v[28:29] offset:38432
M a[172:175], a[216:219], a[248:251], a[172:175]
v_accvgpr_read_b32 v24, a148
v_accvgpr_read_b32 v25, a149
v_accvgpr_read_b32 v26, a150
M a[172:175], a[220:223], a[252:255], a[172:175]
v_accvgpr_read_b32 v27, a151
v_cvt_pk_bf16_f32 v24, v24, v25
v_cvt_pk_bf16_f32 v25, v26, v27
ds_write_b64 v124, v[24:25] offset:38464
s_mov_b64 s[44:45], s[42:43]
v_accvgpr_read_b32 v24, a152
v_accvgpr_read_b32 v25, a153
v_accvgpr_read_b32 v26, a154
v_accvgpr_read_b32 v27, a155
v_cvt_pk_bf16_f32 v24, v24, v25
v_cvt_pk_bf16_f32 v25, v26, v27
ds_write_b64 v124, v[24:25] offset:44800
v_accvgpr_read_b32 v28, a156
v_accvgpr_read_b32 v29, a157
v_accvgpr_read_b32 v30, a158
v_accvgpr_read_b32 v31, a159
v_cvt_pk_bf16_f32 v28, v28, v29
v_cvt_pk_bf16_f32 v29, v30, v31
ds_write_b64 v124, v[28:29] offset:44832
v_accvgpr_read_b32 v24, a160
v_accvgpr_read_b32 v25, a161
v_accvgpr_read_b32 v26, a162
v_accvgpr_read_b32 v27, a163
v_cvt_pk_bf16_f32 v24, v24, v25
v_cvt_pk_bf16_f32 v25, v26, v27
ds_write_b64 v124, v[24:25] offset:44864
v_accvgpr_read_b32 v24, a164
v_accvgpr_read_b32 v25, a165
v_accvgpr_read_b32 v26, a166
v_accvgpr_read_b32 v27, a167
v_cvt_pk_bf16_f32 v24, v24, v25
v_cvt_pk_bf16_f32 v25, v26, v27
ds_write_b64 v124, v[24:25] offset:51200
v_accvgpr_read_b32 v28, a168
v_accvgpr_read_b32 v29, a169
v_accvgpr_read_b32 v30, a170
v_accvgpr_read_b32 v31, a171
v_cvt_pk_bf16_f32 v28, v28, v29
v_cvt_pk_bf16_f32 v29, v30, v31
ds_write_b64 v124, v[28:29] offset:51232
v_accvgpr_read_b32 v24, a172
v_accvgpr_read_b32 v25, a173
v_accvgpr_read_b32 v26, a174
v_accvgpr_read_b32 v27, a175
v_cvt_pk_bf16_f32 v24, v24, v25
v_cvt_pk_bf16_f32 v25, v26, v27
ds_write_b64 v124, v[24:25] offset:51264
s_waitcnt lgkmcnt(0)
s_barrier
ds_read_b128 v[48:51], v121 offset:128
ds_read_b128 v[32:35], v120 offset:0
ds_read_b128 v[52:55], v120 offset:128
ds_read_b128 v[36:39], v120 offset:12800
ds_read_b128 v[56:59], v120 offset:12928
ds_read_b128 v[40:43], v120 offset:25600
ds_read_b128 v[60:63], v120 offset:25728
ds_read_b128 v[44:47], v120 offset:38400
ds_read_b128 v[64:67], v120 offset:38528
ds_read_b64_tr_b16 v[68:69], v123 offset:256
ds_read_b64_tr_b16 v[70:71], v122 offset:256
ds_read_b64_tr_b16 v[72:73], v122 offset:13056
ds_read_b64_tr_b16 v[74:75], v122 offset:25856
ds_read_b64_tr_b16 v[76:77], v122 offset:38656
ds_read_b64_tr_b16 v[78:79], v123 offset:288
ds_read_b64_tr_b16 v[80:81], v122 offset:288
ds_read_b64_tr_b16 v[82:83], v122 offset:13088
ds_read_b64_tr_b16 v[84:85], v122 offset:25888
ds_read_b64_tr_b16 v[86:87], v122 offset:38688
v_accvgpr_write_b32 a64, 0
v_accvgpr_write_b32 a65, 0
v_accvgpr_write_b32 a66, 0
v_accvgpr_write_b32 a67, 0
v_accvgpr_write_b32 a68, 0
v_accvgpr_write_b32 a69, 0
v_accvgpr_write_b32 a70, 0
v_accvgpr_write_b32 a71, 0
v_accvgpr_write_b32 a72, 0
v_accvgpr_write_b32 a73, 0
v_accvgpr_write_b32 a74, 0
v_accvgpr_write_b32 a75, 0
s_add_u32 m0, s29, 0
s_add_u32 s32, s25, 4096
buffer_load_dwordx4 v1, s[12:15], s25 offen offset:0 sc1 lds
v_accvgpr_write_b32 a76, 0
v_accvgpr_write_b32 a77, 0
v_accvgpr_write_b32 a78, 0
v_accvgpr_write_b32 a79, 0
v_accvgpr_write_b32 a80, 0
v_accvgpr_write_b32 a81, 0
v_accvgpr_write_b32 a82, 0
v_accvgpr_write_b32 a83, 0
v_accvgpr_write_b32 a84, 0
v_accvgpr_write_b32 a85, 0
v_accvgpr_write_b32 a86, 0
buffer_load_dwordx4 v1, s[12:15], s25 offen offset:1024 sc1 lds
v_accvgpr_write_b32 a87, 0
v_accvgpr_write_b32 a88, 0
v_accvgpr_write_b32 a89, 0
v_accvgpr_write_b32 a90, 0
v_accvgpr_write_b32 a91, 0
v_accvgpr_write_b32 a92, 0
v_accvgpr_write_b32 a93, 0
v_accvgpr_write_b32 a94, 0
v_accvgpr_write_b32 a95, 0
v_accvgpr_write_b32 a96, 0
buffer_load_dwordx4 v1, s[12:15], s25 offen offset:2048 sc1 lds
v_accvgpr_write_b32 a97, 0
v_accvgpr_write_b32 a98, 0
v_accvgpr_write_b32 a99, 0
v_accvgpr_write_b32 a100, 0
v_accvgpr_write_b32 a101, 0
v_accvgpr_write_b32 a102, 0
v_accvgpr_write_b32 a103, 0
v_accvgpr_write_b32 a104, 0
v_accvgpr_write_b32 a105, 0
v_accvgpr_write_b32 a106, 0
v_accvgpr_write_b32 a107, 0
buffer_load_dwordx4 v1, s[12:15], s25 offen offset:3072 sc1 lds
v_accvgpr_write_b32 a108, 0
v_accvgpr_write_b32 a109, 0
v_accvgpr_write_b32 a110, 0
v_accvgpr_write_b32 a111, 0
s_waitcnt lgkmcnt(15)
M v[88:91], v[48:51], v[32:35], v[152:155]
M v[92:95], v[52:55], v[32:35], v[148:151]
M v[96:99], v[52:55], v[36:39], v[144:147]
s_waitcnt lgkmcnt(14)
M v[100:103], v[56:59], v[36:39], v[148:151]
s_waitcnt lgkmcnt(13)
M v[104:107], v[56:59], v[40:43], v[144:147]
s_waitcnt lgkmcnt(12)
M v[108:111], v[60:63], v[40:43], v[148:151]
s_add_u32 m0, s29, 4096
s_nop 0
buffer_load_dwordx4 v1, s[12:15], s32 offen offset:0 sc1 lds
s_waitcnt lgkmcnt(11)
M v[112:115], v[60:63], v[44:47], v[144:147]
s_waitcnt lgkmcnt(10)
M v[116:119], v[64:67], v[44:47], v[148:151]
v_max3_f32 v136, v88, v89, v90
v_max3_f32 v136, v136, v91, v92
v_max3_f32 v136, v136, v93, v94
v_max_f32 v136, v136, v95
v_max3_f32 v137, v96, v97, v98
v_max3_f32 v137, v137, v99, v100
v_max3_f32 v137, v137, v101, v102
v_max_f32 v137, v137, v103
v_max3_f32 v138, v104, v105, v106
buffer_load_dwordx4 v1, s[12:15], s32 offen offset:1024 sc1 lds
v_max3_f32 v138, v138, v107, v108
v_max3_f32 v138, v138, v109, v110
v_max_f32 v138, v138, v111
v_max3_f32 v139, v112, v113, v114
v_max3_f32 v139, v139, v115, v116
v_max3_f32 v139, v139, v117, v118
v_max_f32 v139, v139, v119
v_mov_b32 v140, v136
v_mov_b32 v141, v137
v_mov_b32 v142, v138
buffer_load_dwordx4 v1, s[12:15], s32 offen offset:2048 sc1 lds
v_mov_b32 v143, v139
v_permlane16_swap_b32 v136, v140
v_permlane16_swap_b32 v137, v141
v_permlane16_swap_b32 v138, v142
v_permlane16_swap_b32 v139, v143
v_max_f32 v136, v136, v140
v_max_f32 v137, v137, v141
v_max_f32 v138, v138, v142
v_max_f32 v139, v139, v143
v_mov_b32 v140, v136
v_mov_b32 v141, v137
buffer_load_dwordx4 v1, s[12:15], s32 offen offset:3072 sc1 lds
v_mov_b32 v142, v138
v_mov_b32 v143, v139
v_permlane32_swap_b32 v136, v140
v_permlane32_swap_b32 v137, v141
v_permlane32_swap_b32 v138, v142
v_permlane32_swap_b32 v139, v143
v_max_f32 v136, v136, v140
v_max_f32 v137, v137, v141
v_max_f32 v138, v138, v142
v_max_f32 v139, v139, v143
s_add_u32 s25, s25, 32768
s_cmp_eq_u32 s25, s27
s_cselect_b32 s25, s28, s25
s_cselect_b32 s27, -1, s27
v_mul_f32 v136, s7, v136
v_mul_f32 v137, s7, v137
v_mul_f32 v138, s7, v138
v_mul_f32 v139, s7, v139
v_fma_f32 v88, v88, s7, -v136
v_fma_f32 v89, v89, s7, -v136
v_fma_f32 v90, v90, s7, -v136
v_fma_f32 v91, v91, s7, -v136
v_fma_f32 v92, v92, s7, -v136
v_fma_f32 v93, v93, s7, -v136
v_fma_f32 v94, v94, s7, -v136
s_add_u32 m0, s29, 32768
s_add_u32 s32, s26, 4096
buffer_load_dwordx4 v1, s[12:15], s26 offen offset:0 sc1 lds
v_fma_f32 v95, v95, s7, -v136
v_exp_f32 v88, v88
v_exp_f32 v89, v89
v_exp_f32 v90, v90
v_exp_f32 v91, v91
v_exp_f32 v92, v92
v_exp_f32 v93, v93
v_exp_f32 v94, v94
v_exp_f32 v95, v95
v_fma_f32 v96, v96, s7, -v137
v_fma_f32 v97, v97, s7, -v137
buffer_load_dwordx4 v1, s[12:15], s26 offen offset:1024 sc1 lds
v_fma_f32 v98, v98, s7, -v137
v_fma_f32 v99, v99, s7, -v137
v_fma_f32 v100, v100, s7, -v137
v_fma_f32 v101, v101, s7, -v137
v_fma_f32 v102, v102, s7, -v137
v_fma_f32 v103, v103, s7, -v137
v_exp_f32 v96, v96
v_exp_f32 v97, v97
v_exp_f32 v98, v98
v_exp_f32 v99, v99
buffer_load_dwordx4 v1, s[12:15], s26 offen offset:2048 sc1 lds
v_exp_f32 v100, v100
v_exp_f32 v101, v101
v_exp_f32 v102, v102
v_exp_f32 v103, v103
v_fma_f32 v104, v104, s7, -v138
v_fma_f32 v105, v105, s7, -v138
v_fma_f32 v106, v106, s7, -v138
v_fma_f32 v107, v107, s7, -v138
v_fma_f32 v108, v108, s7, -v138
v_fma_f32 v109, v109, s7, -v138
v_fma_f32 v110, v110, s7, -v138
buffer_load_dwordx4 v1, s[12:15], s26 offen offset:3072 sc1 lds
v_fma_f32 v111, v111, s7, -v138
v_exp_f32 v104, v104
v_exp_f32 v105, v105
v_exp_f32 v106, v106
v_exp_f32 v107, v107
v_exp_f32 v108, v108
v_exp_f32 v109, v109
v_exp_f32 v110, v110
v_exp_f32 v111, v111
v_fma_f32 v112, v112, s7, -v139
s_add_u32 m0, s29, 36864
s_nop 0
buffer_load_dwordx4 v1, s[12:15], s32 offen offset:0 sc1 lds
v_fma_f32 v113, v113, s7, -v139
v_fma_f32 v114, v114, s7, -v139
v_fma_f32 v115, v115, s7, -v139
v_fma_f32 v116, v116, s7, -v139
v_fma_f32 v117, v117, s7, -v139
v_fma_f32 v118, v118, s7, -v139
v_fma_f32 v119, v119, s7, -v139
v_exp_f32 v112, v112
v_exp_f32 v113, v113
v_exp_f32 v114, v114
v_exp_f32 v115, v115
buffer_load_dwordx4 v1, s[12:15], s32 offen offset:1024 sc1 lds
v_exp_f32 v116, v116
v_exp_f32 v117, v117
v_exp_f32 v118, v118
v_exp_f32 v119, v119
v_cvt_pk_bf16_f32 v88, v88, v89
v_cvt_pk_bf16_f32 v89, v90, v91
v_cvt_pk_bf16_f32 v90, v92, v93
v_cvt_pk_bf16_f32 v91, v94, v95
v_cvt_pk_bf16_f32 v96, v96, v97
v_cvt_pk_bf16_f32 v97, v98, v99
buffer_load_dwordx4 v1, s[12:15], s32 offen offset:2048 sc1 lds
v_cvt_pk_bf16_f32 v98, v100, v101
v_cvt_pk_bf16_f32 v99, v102, v103
v_cvt_pk_bf16_f32 v104, v104, v105
v_cvt_pk_bf16_f32 v105, v106, v107
v_cvt_pk_bf16_f32 v106, v108, v109
v_cvt_pk_bf16_f32 v107, v110, v111
v_cvt_pk_bf16_f32 v112, v112, v113
v_cvt_pk_bf16_f32 v113, v114, v115
v_cvt_pk_bf16_f32 v114, v116, v117
v_cvt_pk_bf16_f32 v115, v118, v119
M v[120:123], v[156:159], v[88:91], 0
buffer_load_dwordx4 v1, s[12:15], s32 offen offset:3072 sc1 lds
s_waitcnt lgkmcnt(8)
M v[32:35], v[68:71], v[88:91], 0
s_waitcnt lgkmcnt(3)
M v[36:39], v[78:81], v[88:91], 0
M v[124:127], v[156:159], v[96:99], 0
M v[40:43], v[70:73], v[96:99], 0
s_waitcnt lgkmcnt(2)
M v[44:47], v[80:83], v[96:99], 0
M v[128:131], v[156:159], v[104:107], 0
M v[48:51], v[72:75], v[104:107], 0
s_waitcnt lgkmcnt(1)
M v[52:55], v[82:85], v[104:107], 0
M v[132:135], v[156:159], v[112:115], 0
M v[56:59], v[74:77], v[112:115], 0
s_add_u32 s26, s26, 32768
s_cmp_eq_u32 s26, s62
s_cselect_b32 s26, s63, s26
s_cselect_b32 s62, -1, s62
s_waitcnt lgkmcnt(0)
M v[60:63], v[84:87], v[112:115], 0
v_rcp_f32 v120, v120
v_rcp_f32 v124, v124
v_rcp_f32 v128, v128
v_rcp_f32 v132, v132
v_pk_mul_f32 v[32:33], v[32:33], v[120:121] op_sel_hi:[1,0]
v_pk_mul_f32 v[34:35], v[34:35], v[120:121] op_sel_hi:[1,0]
v_pk_mul_f32 v[36:37], v[36:37], v[120:121] op_sel_hi:[1,0]
v_pk_mul_f32 v[38:39], v[38:39], v[120:121] op_sel_hi:[1,0]
v_cvt_pk_bf16_f32 v32, v32, v33
v_cvt_pk_bf16_f32 v33, v34, v35
v_cvt_pk_bf16_f32 v34, v36, v37
v_cvt_pk_bf16_f32 v35, v38, v39
s_add_u32 s3, s6, 0
buffer_store_dwordx4 v[32:35], v1, s[16:19], s3 offen sc1
v_pk_mul_f32 v[40:41], v[40:41], v[124:125] op_sel_hi:[1,0]
v_pk_mul_f32 v[42:43], v[42:43], v[124:125] op_sel_hi:[1,0]
v_pk_mul_f32 v[44:45], v[44:45], v[124:125] op_sel_hi:[1,0]
v_pk_mul_f32 v[46:47], v[46:47], v[124:125] op_sel_hi:[1,0]
v_cvt_pk_bf16_f32 v40, v40, v41
v_cvt_pk_bf16_f32 v41, v42, v43
v_cvt_pk_bf16_f32 v42, v44, v45
v_cvt_pk_bf16_f32 v43, v46, v47
s_add_u32 s3, s6, 2048
buffer_store_dwordx4 v[40:43], v1, s[16:19], s3 offen sc1
v_pk_mul_f32 v[48:49], v[48:49], v[128:129] op_sel_hi:[1,0]
v_pk_mul_f32 v[50:51], v[50:51], v[128:129] op_sel_hi:[1,0]
v_pk_mul_f32 v[52:53], v[52:53], v[128:129] op_sel_hi:[1,0]
v_pk_mul_f32 v[54:55], v[54:55], v[128:129] op_sel_hi:[1,0]
v_cvt_pk_bf16_f32 v48, v48, v49
v_cvt_pk_bf16_f32 v49, v50, v51
v_cvt_pk_bf16_f32 v50, v52, v53
v_cvt_pk_bf16_f32 v51, v54, v55
s_add_u32 s3, s6, 4096
buffer_store_dwordx4 v[48:51], v1, s[16:19], s3 offen sc1
v_pk_mul_f32 v[56:57], v[56:57], v[132:133] op_sel_hi:[1,0]
v_pk_mul_f32 v[58:59], v[58:59], v[132:133] op_sel_hi:[1,0]
v_pk_mul_f32 v[60:61], v[60:61], v[132:133] op_sel_hi:[1,0]
v_pk_mul_f32 v[62:63], v[62:63], v[132:133] op_sel_hi:[1,0]
v_cvt_pk_bf16_f32 v56, v56, v57
v_cvt_pk_bf16_f32 v57, v58, v59
v_cvt_pk_bf16_f32 v58, v60, v61
v_cvt_pk_bf16_f32 v59, v62, v63
s_add_u32 s3, s6, 6144
buffer_store_dwordx4 v[56:59], v1, s[16:19], s3 offen sc1
Lc2:
s_add_u32 s16, s4, 67108864
s_addc_u32 s17, s5, 0
s_mov_b32 s18, 16777216
s_mov_b32 s19, 0x00020000
s_add_u32 s52, s4, 100663296
s_addc_u32 s53, s5, 0
s_mov_b32 s54, 8404992
s_mov_b32 s55, 0x00020000
s_mov_b32 s46, 8388608
s_mov_b32 s47, 0x00020000
s_mov_b32 s50, 2097152
s_mov_b32 s51, 0x00020000
s_lshl_b32 s33, s24, 14
v_add_u32 v2, s33, v1
v_add_u32 v3, 0x10000, v2
v_and_b32 v8, 15, v0
v_bfe_u32 v9, v0, 4, 2
v_lshlrev_b32 v9, 2, v9
v_sub_u32 v8, v8, v9
v_mov_b32 v4, 0xf149f2ca
v_cmp_gt_i32 vcc, 0, v8
s_nop 1
v_cndmask_b32 v16, 0, v4, vcc
v_cmp_gt_i32 vcc, 1, v8
s_nop 1
v_cndmask_b32 v17, 0, v4, vcc
v_cmp_gt_i32 vcc, 2, v8
s_nop 1
v_cndmask_b32 v18, 0, v4, vcc
v_cmp_gt_i32 vcc, 3, v8
s_nop 1
v_cndmask_b32 v19, 0, v4, vcc
v_mov_b32 v8, 0x3f803f80
v_accvgpr_write_b32 a112, v8
v_accvgpr_write_b32 a113, v8
v_accvgpr_write_b32 a114, v8
v_accvgpr_write_b32 a115, v8
s_lshl_b32 s33, s23, 6
s_add_i32 s33, s33, s31
s_cmp_gt_i32 s33, 0
s_cselect_b32 s34, 0, 0xf149f2ca
s_cmp_lt_i32 s33, 0
s_cselect_b32 s33, 0xf149f2ca, 0
v_mov_b32 v20, s34
v_mov_b32 v21, s34
v_mov_b32 v22, s34
v_mov_b32 v23, s34
v_mov_b32 v28, s33
v_mov_b32 v29, s33
v_mov_b32 v30, s33
v_mov_b32 v31, s33
v_med3_f32 v24, v16, v20, v28
v_med3_f32 v25, v17, v20, v28
v_med3_f32 v26, v18, v20, v28
v_med3_f32 v27, v19, v20, v28
v_mov_b32 v5, 0
v_mov_b32 v6, 1
s_waitcnt vmcnt(20)
s_barrier
ds_read_b128 a[116:119], v3 offset:0
ds_read_b128 a[120:123], v3 offset:1024
ds_read_b128 a[124:127], v3 offset:2048
ds_read_b128 a[128:131], v3 offset:3072
ds_read_b128 a[132:135], v3 offset:4096
ds_read_b128 a[136:139], v3 offset:5120
ds_read_b128 a[140:143], v3 offset:6144
ds_read_b128 a[144:147], v3 offset:7168
s_waitcnt lgkmcnt(4)
M v[32:35], a[116:119], a[0:3], v[24:27]
M v[32:35], a[120:123], a[4:7], v[32:35]
ds_read_b128 a[148:151], v3 offset:8192
ds_read_b128 a[152:155], v3 offset:9216
M v[32:35], a[124:127], a[8:11], v[32:35]
M v[32:35], a[128:131], a[12:15], v[32:35]
M v[36:39], a[128:131], a[28:31], v[28:31]
M v[36:39], a[124:127], a[24:27], v[36:39]
M v[36:39], a[120:123], a[20:23], v[36:39]
M v[36:39], a[116:119], a[16:19], v[36:39]
M v[40:43], a[116:119], a[32:35], v[28:31]
M v[40:43], a[120:123], a[36:39], v[40:43]
ds_read_b128 a[156:159], v3 offset:10240
ds_read_b128 a[160:163], v3 offset:11264
M v[40:43], a[124:127], a[40:43], v[40:43]
M v[40:43], a[128:131], a[44:47], v[40:43]
M v[44:47], a[128:131], a[60:63], v[28:31]
M v[44:47], a[124:127], a[56:59], v[44:47]
M v[44:47], a[120:123], a[52:55], v[44:47]
M v[44:47], a[116:119], a[48:51], v[44:47]
s_waitcnt lgkmcnt(4)
M v[48:51], a[132:135], a[0:3], v[20:23]
M v[48:51], a[136:139], a[4:7], v[48:51]
ds_read_b128 a[164:167], v3 offset:12288
ds_read_b128 a[168:171], v3 offset:13312
M v[48:51], a[140:143], a[8:11], v[48:51]
M v[48:51], a[144:147], a[12:15], v[48:51]
M v[52:55], a[144:147], a[28:31], v[24:27]
M v[52:55], a[140:143], a[24:27], v[52:55]
M v[52:55], a[136:139], a[20:23], v[52:55]
M v[52:55], a[132:135], a[16:19], v[52:55]
M v[56:59], a[132:135], a[32:35], v[28:31]
M v[56:59], a[136:139], a[36:39], v[56:59]
ds_read_b128 a[172:175], v3 offset:14336
ds_read_b128 a[176:179], v3 offset:15360
M v[56:59], a[140:143], a[40:43], v[56:59]
M v[56:59], a[144:147], a[44:47], v[56:59]
M v[60:63], a[144:147], a[60:63], v[28:31]
M v[60:63], a[140:143], a[56:59], v[60:63]
M v[60:63], a[136:139], a[52:55], v[60:63]
M v[60:63], a[132:135], a[48:51], v[60:63]
s_waitcnt lgkmcnt(4)
M v[64:67], a[148:151], a[0:3], v[20:23]
M v[64:67], a[152:155], a[4:7], v[64:67]
M v[64:67], a[156:159], a[8:11], v[64:67]
M v[64:67], a[160:163], a[12:15], v[64:67]
M v[68:71], a[160:163], a[28:31], v[20:23]
M v[68:71], a[156:159], a[24:27], v[68:71]
M v[68:71], a[152:155], a[20:23], v[68:71]
M v[68:71], a[148:151], a[16:19], v[68:71]
M v[72:75], a[148:151], a[32:35], v[24:27]
M v[72:75], a[152:155], a[36:39], v[72:75]
M v[72:75], a[156:159], a[40:43], v[72:75]
M v[72:75], a[160:163], a[44:47], v[72:75]
M v[76:79], a[160:163], a[60:63], v[28:31]
M v[76:79], a[156:159], a[56:59], v[76:79]
s_waitcnt vmcnt(4) lgkmcnt(0)
s_barrier
ds_read_b128 a[116:119], v2 offset:0
ds_read_b128 a[120:123], v2 offset:1024
M v[76:79], a[152:155], a[52:55], v[76:79]
M v[76:79], a[148:151], a[48:51], v[76:79]
M v[80:83], a[164:167], a[0:3], v[20:23]
M v[80:83], a[168:171], a[4:7], v[80:83]
ds_read_b128 a[124:127], v2 offset:2048
ds_read_b128 a[128:131], v2 offset:3072
M v[80:83], a[172:175], a[8:11], v[80:83]
M v[80:83], a[176:179], a[12:15], v[80:83]
M v[84:87], a[176:179], a[28:31], v[20:23]
M v[84:87], a[172:175], a[24:27], v[84:87]
ds_read_b128 a[132:135], v2 offset:4096
ds_read_b128 a[136:139], v2 offset:5120
M v[84:87], a[168:171], a[20:23], v[84:87]
M v[84:87], a[164:167], a[16:19], v[84:87]
M v[88:91], a[164:167], a[32:35], v[20:23]
M v[88:91], a[168:171], a[36:39], v[88:91]
ds_read_b128 a[140:143], v2 offset:6144
ds_read_b128 a[144:147], v2 offset:7168
M v[88:91], a[172:175], a[40:43], v[88:91]
M v[88:91], a[176:179], a[44:47], v[88:91]
M v[92:95], a[176:179], a[60:63], v[24:27]
M v[92:95], a[172:175], a[56:59], v[92:95]
M v[92:95], a[168:171], a[52:55], v[92:95]
M v[92:95], a[164:167], a[48:51], v[92:95]
s_waitcnt vmcnt(0)
s_mov_b64 exec, 1
buffer_store_dword v6, v5, s[52:55], s65 offen sc1
s_mov_b64 exec, -1
v_exp_f32 v32, v32
v_exp_f32 v33, v33
v_exp_f32 v34, v34
v_exp_f32 v35, v35
v_exp_f32 v48, v48
v_exp_f32 v49, v49
v_exp_f32 v50, v50
v_exp_f32 v51, v51
v_cvt_pk_bf16_f32 v32, v32, v33
v_cvt_pk_bf16_f32 v33, v34, v35
v_exp_f32 v36, v36
v_exp_f32 v37, v37
v_exp_f32 v38, v38
v_exp_f32 v39, v39
v_cvt_pk_bf16_f32 v34, v48, v49
v_cvt_pk_bf16_f32 v35, v50, v51
v_exp_f32 v52, v52
v_exp_f32 v53, v53
v_exp_f32 v54, v54
v_exp_f32 v55, v55
v_cvt_pk_bf16_f32 v36, v36, v37
v_cvt_pk_bf16_f32 v37, v38, v39
v_exp_f32 v40, v40
v_exp_f32 v41, v41
v_exp_f32 v42, v42
v_exp_f32 v43, v43
v_cvt_pk_bf16_f32 v38, v52, v53
v_cvt_pk_bf16_f32 v39, v54, v55
v_exp_f32 v56, v56
v_exp_f32 v57, v57
v_exp_f32 v58, v58
v_exp_f32 v59, v59
v_cvt_pk_bf16_f32 v40, v40, v41
v_cvt_pk_bf16_f32 v41, v42, v43
v_exp_f32 v44, v44
v_exp_f32 v45, v45
v_exp_f32 v46, v46
v_exp_f32 v47, v47
v_cvt_pk_bf16_f32 v42, v56, v57
v_cvt_pk_bf16_f32 v43, v58, v59
v_exp_f32 v60, v60
v_exp_f32 v61, v61
v_exp_f32 v62, v62
v_exp_f32 v63, v63
v_cvt_pk_bf16_f32 v44, v44, v45
v_cvt_pk_bf16_f32 v45, v46, v47
v_cvt_pk_bf16_f32 v46, v60, v61
v_cvt_pk_bf16_f32 v47, v62, v63
s_cmp_eq_u32 s24, 1
s_cbranch_scc1 Lk2_g1
s_mov_b32 s30, s21
s_cmp_eq_u32 s21, 0
s_cbranch_scc1 Lk2_m2
Lk2_l1:
s_add_u32 m0, s29, 65536
s_waitcnt lgkmcnt(4)
M v[96:99], a[116:119], a[0:3], 0
v_exp_f32 v64, v64
M v[96:99], a[120:123], a[4:7], v[96:99]
ds_read_b128 a[148:151], v2 offset:8192
ds_read_b128 a[152:155], v2 offset:9216
M v[96:99], a[124:127], a[8:11], v[96:99]
v_exp_f32 v65, v65
M v[96:99], a[128:131], a[12:15], v[96:99]
buffer_load_dwordx4 v1, s[12:15], s25 offen offset:0 sc1 lds
s_add_u32 s32, s25, 4096
M v[100:103], a[128:131], a[28:31], 0
v_exp_f32 v66, v66
M v[100:103], a[124:127], a[24:27], v[100:103]
v_cvt_pk_bf16_f32 v64, v64, v65
M v[100:103], a[120:123], a[20:23], v[100:103]
v_exp_f32 v67, v67
M v[100:103], a[116:119], a[16:19], v[100:103]
buffer_load_dwordx4 v1, s[12:15], s25 offen offset:1024 sc1 lds
M v[104:107], a[116:119], a[32:35], 0
v_exp_f32 v80, v80
M v[104:107], a[120:123], a[36:39], v[104:107]
ds_read_b128 a[156:159], v2 offset:10240
ds_read_b128 a[160:163], v2 offset:11264
M v[104:107], a[124:127], a[40:43], v[104:107]
v_exp_f32 v81, v81
M v[104:107], a[128:131], a[44:47], v[104:107]
buffer_load_dwordx4 v1, s[12:15], s25 offen offset:2048 sc1 lds
M v[108:111], a[128:131], a[60:63], 0
v_exp_f32 v82, v82
M v[108:111], a[124:127], a[56:59], v[108:111]
v_cvt_pk_bf16_f32 v65, v66, v67
v_cvt_pk_bf16_f32 v66, v80, v81
M v[108:111], a[120:123], a[52:55], v[108:111]
v_exp_f32 v83, v83
M v[108:111], a[116:119], a[48:51], v[108:111]
buffer_load_dwordx4 v1, s[12:15], s25 offen offset:3072 sc1 lds
s_add_u32 m0, s29, 69632
s_waitcnt lgkmcnt(4)
M v[112:115], a[132:135], a[0:3], 0
v_exp_f32 v68, v68
M v[112:115], a[136:139], a[4:7], v[112:115]
ds_read_b128 a[164:167], v2 offset:12288
ds_read_b128 a[168:171], v2 offset:13312
M v[112:115], a[140:143], a[8:11], v[112:115]
v_exp_f32 v69, v69
M v[112:115], a[144:147], a[12:15], v[112:115]
buffer_load_dwordx4 v1, s[12:15], s32 offen offset:0 sc1 lds
M v[116:119], a[144:147], a[28:31], 0
v_exp_f32 v70, v70
M v[116:119], a[140:143], a[24:27], v[116:119]
v_cvt_pk_bf16_f32 v67, v82, v83
v_cvt_pk_bf16_f32 v68, v68, v69
M v[116:119], a[136:139], a[20:23], v[116:119]
v_exp_f32 v71, v71
M v[116:119], a[132:135], a[16:19], v[116:119]
buffer_load_dwordx4 v1, s[12:15], s32 offen offset:1024 sc1 lds
M v[120:123], a[132:135], a[32:35], 0
v_exp_f32 v84, v84
M v[120:123], a[136:139], a[36:39], v[120:123]
ds_read_b128 a[172:175], v2 offset:14336
ds_read_b128 a[176:179], v2 offset:15360
M v[120:123], a[140:143], a[40:43], v[120:123]
v_exp_f32 v85, v85
M v[120:123], a[144:147], a[44:47], v[120:123]
buffer_load_dwordx4 v1, s[12:15], s32 offen offset:2048 sc1 lds
M v[124:127], a[144:147], a[60:63], 0
v_exp_f32 v86, v86
M v[124:127], a[140:143], a[56:59], v[124:127]
v_cvt_pk_bf16_f32 v69, v70, v71
v_cvt_pk_bf16_f32 v70, v84, v85
M v[124:127], a[136:139], a[52:55], v[124:127]
v_exp_f32 v87, v87
M v[124:127], a[132:135], a[48:51], v[124:127]
buffer_load_dwordx4 v1, s[12:15], s32 offen offset:3072 sc1 lds
s_add_u32 m0, s29, 98304
s_waitcnt lgkmcnt(4)
M v[128:131], a[148:151], a[0:3], 0
v_exp_f32 v72, v72
M v[128:131], a[152:155], a[4:7], v[128:131]
ds_read_b128 a[116:119], v2 offset:32768
ds_read_b128 a[120:123], v2 offset:40960
M v[128:131], a[156:159], a[8:11], v[128:131]
v_exp_f32 v73, v73
M v[128:131], a[160:163], a[12:15], v[128:131]
buffer_load_dwordx4 v1, s[12:15], s26 offen offset:0 sc1 lds
s_add_u32 s43, s26, 4096
M v[132:135], a[160:163], a[28:31], 0
v_exp_f32 v74, v74
M v[132:135], a[156:159], a[24:27], v[132:135]
v_cvt_pk_bf16_f32 v71, v86, v87
v_cvt_pk_bf16_f32 v72, v72, v73
M v[132:135], a[152:155], a[20:23], v[132:135]
v_exp_f32 v75, v75
M v[132:135], a[148:151], a[16:19], v[132:135]
buffer_load_dwordx4 v1, s[12:15], s26 offen offset:1024 sc1 lds
M v[136:139], a[148:151], a[32:35], 0
v_exp_f32 v88, v88
M v[136:139], a[152:155], a[36:39], v[136:139]
ds_read_b128 a[124:127], v2 offset:33792
ds_read_b128 a[128:131], v2 offset:41984
M v[136:139], a[156:159], a[40:43], v[136:139]
v_exp_f32 v89, v89
M v[136:139], a[160:163], a[44:47], v[136:139]
buffer_load_dwordx4 v1, s[12:15], s26 offen offset:2048 sc1 lds
M v[140:143], a[160:163], a[60:63], 0
v_exp_f32 v90, v90
M v[140:143], a[156:159], a[56:59], v[140:143]
v_cvt_pk_bf16_f32 v73, v74, v75
v_cvt_pk_bf16_f32 v74, v88, v89
M v[140:143], a[152:155], a[52:55], v[140:143]
v_exp_f32 v91, v91
M v[140:143], a[148:151], a[48:51], v[140:143]
buffer_load_dwordx4 v1, s[12:15], s26 offen offset:3072 sc1 lds
s_add_u32 m0, s29, 102400
s_waitcnt lgkmcnt(4)
M v[144:147], a[164:167], a[0:3], 0
v_exp_f32 v76, v76
M v[144:147], a[168:171], a[4:7], v[144:147]
ds_read_b128 a[132:135], v2 offset:34816
ds_read_b128 a[136:139], v2 offset:43008
M v[144:147], a[172:175], a[8:11], v[144:147]
v_exp_f32 v77, v77
M v[144:147], a[176:179], a[12:15], v[144:147]
buffer_load_dwordx4 v1, s[12:15], s43 offen offset:0 sc1 lds
M v[148:151], a[176:179], a[28:31], 0
v_exp_f32 v78, v78
M v[148:151], a[172:175], a[24:27], v[148:151]
v_cvt_pk_bf16_f32 v75, v90, v91
v_cvt_pk_bf16_f32 v76, v76, v77
M v[148:151], a[168:171], a[20:23], v[148:151]
v_exp_f32 v79, v79
M v[148:151], a[164:167], a[16:19], v[148:151]
buffer_load_dwordx4 v1, s[12:15], s43 offen offset:1024 sc1 lds
M v[152:155], a[164:167], a[32:35], 0
v_exp_f32 v92, v92
M v[152:155], a[168:171], a[36:39], v[152:155]
ds_read_b128 a[140:143], v2 offset:35840
ds_read_b128 a[144:147], v2 offset:44032
M v[152:155], a[172:175], a[40:43], v[152:155]
v_exp_f32 v93, v93
M v[152:155], a[176:179], a[44:47], v[152:155]
buffer_load_dwordx4 v1, s[12:15], s43 offen offset:2048 sc1 lds
M v[156:159], a[176:179], a[60:63], 0
v_exp_f32 v94, v94
M v[156:159], a[172:175], a[56:59], v[156:159]
v_cvt_pk_bf16_f32 v77, v78, v79
v_cvt_pk_bf16_f32 v78, v92, v93
M v[156:159], a[168:171], a[52:55], v[156:159]
v_exp_f32 v95, v95
M v[156:159], a[164:167], a[48:51], v[156:159]
buffer_load_dwordx4 v1, s[12:15], s43 offen offset:3072 sc1 lds
v_cvt_pk_bf16_f32 v79, v94, v95
s_waitcnt lgkmcnt(6)
M v[160:163], a[116:119], v[32:35], v[160:163]
v_exp_f32 v96, v96
M v[160:163], a[120:123], v[64:67], v[160:163]
ds_read_b128 a[148:151], v2 offset:36864
ds_read_b128 a[152:155], v2 offset:45056
M v[164:167], a[120:123], v[68:71], v[164:167]
v_exp_f32 v97, v97
M v[164:167], a[116:119], v[36:39], v[164:167]
v_cvt_pk_bf16_f32 v96, v96, v97
M v[168:171], a[116:119], v[40:43], v[168:171]
v_exp_f32 v98, v98
M v[168:171], a[120:123], v[72:75], v[168:171]
s_add_u32 s25, s25, 32768
s_cmp_eq_u32 s25, s27
M v[172:175], a[120:123], v[76:79], v[172:175]
v_exp_f32 v99, v99
M v[172:175], a[116:119], v[44:47], v[172:175]
v_cvt_pk_bf16_f32 v97, v98, v99
s_waitcnt lgkmcnt(6)
M a[96:99], a[112:115], v[32:35], a[96:99]
s_cselect_b32 s25, s28, s25
s_cselect_b32 s27, -1, s27
M a[96:99], a[112:115], v[64:67], a[96:99]
s_add_u32 s26, s26, 32768
s_cmp_eq_u32 s26, s62
M v[176:179], a[124:127], v[32:35], v[176:179]
v_exp_f32 v112, v112
M v[176:179], a[128:131], v[64:67], v[176:179]
ds_read_b128 a[156:159], v2 offset:37888
ds_read_b128 a[160:163], v2 offset:46080
M v[180:183], a[128:131], v[68:71], v[180:183]
v_exp_f32 v113, v113
M v[180:183], a[124:127], v[36:39], v[180:183]
v_cvt_pk_bf16_f32 v98, v112, v113
M v[184:187], a[124:127], v[40:43], v[184:187]
v_exp_f32 v114, v114
M v[184:187], a[128:131], v[72:75], v[184:187]
s_cselect_b32 s26, s63, s26
s_cselect_b32 s62, -1, s62
M v[188:191], a[128:131], v[76:79], v[188:191]
v_exp_f32 v115, v115
M v[188:191], a[124:127], v[44:47], v[188:191]
v_cvt_pk_bf16_f32 v99, v114, v115
s_waitcnt lgkmcnt(6)
M a[100:103], a[112:115], v[36:39], a[100:103]
M a[100:103], a[112:115], v[68:71], a[100:103]
M v[192:195], a[132:135], v[32:35], v[192:195]
v_exp_f32 v100, v100
M v[192:195], a[136:139], v[64:67], v[192:195]
ds_read_b128 a[164:167], v2 offset:38912
ds_read_b128 a[168:171], v2 offset:47104
M v[196:199], a[136:139], v[68:71], v[196:199]
v_exp_f32 v101, v101
M v[196:199], a[132:135], v[36:39], v[196:199]
v_cvt_pk_bf16_f32 v100, v100, v101
M v[200:203], a[132:135], v[40:43], v[200:203]
v_exp_f32 v102, v102
M v[200:203], a[136:139], v[72:75], v[200:203]
M v[204:207], a[136:139], v[76:79], v[204:207]
v_exp_f32 v103, v103
M v[204:207], a[132:135], v[44:47], v[204:207]
v_cvt_pk_bf16_f32 v101, v102, v103
s_waitcnt lgkmcnt(6)
M a[104:107], a[112:115], v[40:43], a[104:107]
M a[104:107], a[112:115], v[72:75], a[104:107]
M v[208:211], a[140:143], v[32:35], v[208:211]
v_exp_f32 v116, v116
M v[208:211], a[144:147], v[64:67], v[208:211]
ds_read_b128 a[172:175], v2 offset:39936
ds_read_b128 a[176:179], v2 offset:48128
M v[212:215], a[144:147], v[68:71], v[212:215]
v_exp_f32 v117, v117
M v[212:215], a[140:143], v[36:39], v[212:215]
v_cvt_pk_bf16_f32 v102, v116, v117
M v[216:219], a[140:143], v[40:43], v[216:219]
v_exp_f32 v118, v118
M v[216:219], a[144:147], v[72:75], v[216:219]
M v[220:223], a[144:147], v[76:79], v[220:223]
v_exp_f32 v119, v119
M v[220:223], a[140:143], v[44:47], v[220:223]
v_cvt_pk_bf16_f32 v103, v118, v119
s_waitcnt lgkmcnt(6)
M a[108:111], a[112:115], v[44:47], a[108:111]
M a[108:111], a[112:115], v[76:79], a[108:111]
M v[224:227], a[148:151], v[32:35], v[224:227]
v_exp_f32 v104, v104
M v[224:227], a[152:155], v[64:67], v[224:227]
M v[228:231], a[152:155], v[68:71], v[228:231]
v_exp_f32 v105, v105
M v[228:231], a[148:151], v[36:39], v[228:231]
v_cvt_pk_bf16_f32 v104, v104, v105
M v[232:235], a[148:151], v[40:43], v[232:235]
v_exp_f32 v106, v106
M v[232:235], a[152:155], v[72:75], v[232:235]
M v[236:239], a[152:155], v[76:79], v[236:239]
v_exp_f32 v107, v107
M v[236:239], a[148:151], v[44:47], v[236:239]
v_cvt_pk_bf16_f32 v105, v106, v107
s_waitcnt lgkmcnt(4)
M v[240:243], a[156:159], v[32:35], v[240:243]
v_exp_f32 v120, v120
M v[240:243], a[160:163], v[64:67], v[240:243]
M v[244:247], a[160:163], v[68:71], v[244:247]
v_exp_f32 v121, v121
M v[244:247], a[156:159], v[36:39], v[244:247]
v_cvt_pk_bf16_f32 v106, v120, v121
M v[248:251], a[156:159], v[40:43], v[248:251]
v_exp_f32 v122, v122
M v[248:251], a[160:163], v[72:75], v[248:251]
s_waitcnt vmcnt(0) lgkmcnt(0)
s_barrier
ds_read_b128 a[116:119], v3 offset:0
ds_read_b128 a[120:123], v3 offset:1024
M v[252:255], a[160:163], v[76:79], v[252:255]
v_exp_f32 v123, v123
M v[252:255], a[156:159], v[44:47], v[252:255]
v_cvt_pk_bf16_f32 v107, v122, v123
M a[64:67], a[164:167], v[32:35], a[64:67]
v_exp_f32 v108, v108
M a[64:67], a[168:171], v[64:67], a[64:67]
ds_read_b128 a[124:127], v3 offset:2048
ds_read_b128 a[128:131], v3 offset:3072
M a[68:71], a[168:171], v[68:71], a[68:71]
v_exp_f32 v109, v109
M a[68:71], a[164:167], v[36:39], a[68:71]
v_cvt_pk_bf16_f32 v108, v108, v109
M a[72:75], a[164:167], v[40:43], a[72:75]
v_exp_f32 v110, v110
M a[72:75], a[168:171], v[72:75], a[72:75]
ds_read_b128 a[132:135], v3 offset:4096
ds_read_b128 a[136:139], v3 offset:5120
M a[76:79], a[168:171], v[76:79], a[76:79]
v_exp_f32 v111, v111
M a[76:79], a[164:167], v[44:47], a[76:79]
v_cvt_pk_bf16_f32 v109, v110, v111
M a[80:83], a[172:175], v[32:35], a[80:83]
v_exp_f32 v124, v124
M a[80:83], a[176:179], v[64:67], a[80:83]
ds_read_b128 a[140:143], v3 offset:6144
ds_read_b128 a[144:147], v3 offset:7168
M a[84:87], a[176:179], v[68:71], a[84:87]
v_exp_f32 v125, v125
M a[84:87], a[172:175], v[36:39], a[84:87]
v_cvt_pk_bf16_f32 v110, v124, v125
M a[88:91], a[172:175], v[40:43], a[88:91]
v_exp_f32 v126, v126
M a[88:91], a[176:179], v[72:75], a[88:91]
M a[92:95], a[176:179], v[76:79], a[92:95]
v_exp_f32 v127, v127
M a[92:95], a[172:175], v[44:47], a[92:95]
v_cvt_pk_bf16_f32 v111, v126, v127
s_sub_u32 s30, s30, 1
s_cmp_eq_u32 s30, 0
s_cbranch_scc1 Lk2_m1
s_add_u32 m0, s29, 0
s_waitcnt lgkmcnt(4)
M v[32:35], a[116:119], a[0:3], 0
v_exp_f32 v128, v128
M v[32:35], a[120:123], a[4:7], v[32:35]
ds_read_b128 a[148:151], v3 offset:8192
ds_read_b128 a[152:155], v3 offset:9216
M v[32:35], a[124:127], a[8:11], v[32:35]
v_exp_f32 v129, v129
M v[32:35], a[128:131], a[12:15], v[32:35]
buffer_load_dwordx4 v1, s[12:15], s25 offen offset:0 sc1 lds
s_add_u32 s32, s25, 4096
M v[36:39], a[128:131], a[28:31], 0
v_exp_f32 v130, v130
M v[36:39], a[124:127], a[24:27], v[36:39]
v_cvt_pk_bf16_f32 v128, v128, v129
M v[36:39], a[120:123], a[20:23], v[36:39]
v_exp_f32 v131, v131
M v[36:39], a[116:119], a[16:19], v[36:39]
buffer_load_dwordx4 v1, s[12:15], s25 offen offset:1024 sc1 lds
M v[40:43], a[116:119], a[32:35], 0
v_exp_f32 v144, v144
M v[40:43], a[120:123], a[36:39], v[40:43]
ds_read_b128 a[156:159], v3 offset:10240
ds_read_b128 a[160:163], v3 offset:11264
M v[40:43], a[124:127], a[40:43], v[40:43]
v_exp_f32 v145, v145
M v[40:43], a[128:131], a[44:47], v[40:43]
buffer_load_dwordx4 v1, s[12:15], s25 offen offset:2048 sc1 lds
M v[44:47], a[128:131], a[60:63], 0
v_exp_f32 v146, v146
M v[44:47], a[124:127], a[56:59], v[44:47]
v_cvt_pk_bf16_f32 v129, v130, v131
v_cvt_pk_bf16_f32 v130, v144, v145
M v[44:47], a[120:123], a[52:55], v[44:47]
v_exp_f32 v147, v147
M v[44:47], a[116:119], a[48:51], v[44:47]
buffer_load_dwordx4 v1, s[12:15], s25 offen offset:3072 sc1 lds
s_add_u32 m0, s29, 4096
s_waitcnt lgkmcnt(4)
M v[48:51], a[132:135], a[0:3], 0
v_exp_f32 v132, v132
M v[48:51], a[136:139], a[4:7], v[48:51]
ds_read_b128 a[164:167], v3 offset:12288
ds_read_b128 a[168:171], v3 offset:13312
M v[48:51], a[140:143], a[8:11], v[48:51]
v_exp_f32 v133, v133
M v[48:51], a[144:147], a[12:15], v[48:51]
buffer_load_dwordx4 v1, s[12:15], s32 offen offset:0 sc1 lds
M v[52:55], a[144:147], a[28:31], 0
v_exp_f32 v134, v134
M v[52:55], a[140:143], a[24:27], v[52:55]
v_cvt_pk_bf16_f32 v131, v146, v147
v_cvt_pk_bf16_f32 v132, v132, v133
M v[52:55], a[136:139], a[20:23], v[52:55]
v_exp_f32 v135, v135
M v[52:55], a[132:135], a[16:19], v[52:55]
buffer_load_dwordx4 v1, s[12:15], s32 offen offset:1024 sc1 lds
M v[56:59], a[132:135], a[32:35], 0
v_exp_f32 v148, v148
M v[56:59], a[136:139], a[36:39], v[56:59]
ds_read_b128 a[172:175], v3 offset:14336
ds_read_b128 a[176:179], v3 offset:15360
M v[56:59], a[140:143], a[40:43], v[56:59]
v_exp_f32 v149, v149
M v[56:59], a[144:147], a[44:47], v[56:59]
buffer_load_dwordx4 v1, s[12:15], s32 offen offset:2048 sc1 lds
M v[60:63], a[144:147], a[60:63], 0
v_exp_f32 v150, v150
M v[60:63], a[140:143], a[56:59], v[60:63]
v_cvt_pk_bf16_f32 v133, v134, v135
v_cvt_pk_bf16_f32 v134, v148, v149
M v[60:63], a[136:139], a[52:55], v[60:63]
v_exp_f32 v151, v151
M v[60:63], a[132:135], a[48:51], v[60:63]
buffer_load_dwordx4 v1, s[12:15], s32 offen offset:3072 sc1 lds
s_add_u32 m0, s29, 32768
s_waitcnt lgkmcnt(4)
M v[64:67], a[148:151], a[0:3], 0
v_exp_f32 v136, v136
M v[64:67], a[152:155], a[4:7], v[64:67]
ds_read_b128 a[116:119], v3 offset:32768
ds_read_b128 a[120:123], v3 offset:40960
M v[64:67], a[156:159], a[8:11], v[64:67]
v_exp_f32 v137, v137
M v[64:67], a[160:163], a[12:15], v[64:67]
buffer_load_dwordx4 v1, s[12:15], s26 offen offset:0 sc1 lds
s_add_u32 s43, s26, 4096
M v[68:71], a[160:163], a[28:31], 0
v_exp_f32 v138, v138
M v[68:71], a[156:159], a[24:27], v[68:71]
v_cvt_pk_bf16_f32 v135, v150, v151
v_cvt_pk_bf16_f32 v136, v136, v137
M v[68:71], a[152:155], a[20:23], v[68:71]
v_exp_f32 v139, v139
M v[68:71], a[148:151], a[16:19], v[68:71]
buffer_load_dwordx4 v1, s[12:15], s26 offen offset:1024 sc1 lds
M v[72:75], a[148:151], a[32:35], 0
v_exp_f32 v152, v152
M v[72:75], a[152:155], a[36:39], v[72:75]
ds_read_b128 a[124:127], v3 offset:33792
ds_read_b128 a[128:131], v3 offset:41984
M v[72:75], a[156:159], a[40:43], v[72:75]
v_exp_f32 v153, v153
M v[72:75], a[160:163], a[44:47], v[72:75]
buffer_load_dwordx4 v1, s[12:15], s26 offen offset:2048 sc1 lds
M v[76:79], a[160:163], a[60:63], 0
v_exp_f32 v154, v154
M v[76:79], a[156:159], a[56:59], v[76:79]
v_cvt_pk_bf16_f32 v137, v138, v139
v_cvt_pk_bf16_f32 v138, v152, v153
M v[76:79], a[152:155], a[52:55], v[76:79]
v_exp_f32 v155, v155
M v[76:79], a[148:151], a[48:51], v[76:79]
buffer_load_dwordx4 v1, s[12:15], s26 offen offset:3072 sc1 lds
s_add_u32 m0, s29, 36864
s_waitcnt lgkmcnt(4)
M v[80:83], a[164:167], a[0:3], 0
v_exp_f32 v140, v140
M v[80:83], a[168:171], a[4:7], v[80:83]
ds_read_b128 a[132:135], v3 offset:34816
ds_read_b128 a[136:139], v3 offset:43008
M v[80:83], a[172:175], a[8:11], v[80:83]
v_exp_f32 v141, v141
M v[80:83], a[176:179], a[12:15], v[80:83]
buffer_load_dwordx4 v1, s[12:15], s43 offen offset:0 sc1 lds
M v[84:87], a[176:179], a[28:31], 0
v_exp_f32 v142, v142
M v[84:87], a[172:175], a[24:27], v[84:87]
v_cvt_pk_bf16_f32 v139, v154, v155
v_cvt_pk_bf16_f32 v140, v140, v141
M v[84:87], a[168:171], a[20:23], v[84:87]
v_exp_f32 v143, v143
M v[84:87], a[164:167], a[16:19], v[84:87]
buffer_load_dwordx4 v1, s[12:15], s43 offen offset:1024 sc1 lds
M v[88:91], a[164:167], a[32:35], 0
v_exp_f32 v156, v156
M v[88:91], a[168:171], a[36:39], v[88:91]
ds_read_b128 a[140:143], v3 offset:35840
ds_read_b128 a[144:147], v3 offset:44032
M v[88:91], a[172:175], a[40:43], v[88:91]
v_exp_f32 v157, v157
M v[88:91], a[176:179], a[44:47], v[88:91]
buffer_load_dwordx4 v1, s[12:15], s43 offen offset:2048 sc1 lds
M v[92:95], a[176:179], a[60:63], 0
v_exp_f32 v158, v158
M v[92:95], a[172:175], a[56:59], v[92:95]
v_cvt_pk_bf16_f32 v141, v142, v143
v_cvt_pk_bf16_f32 v142, v156, v157
M v[92:95], a[168:171], a[52:55], v[92:95]
v_exp_f32 v159, v159
M v[92:95], a[164:167], a[48:51], v[92:95]
buffer_load_dwordx4 v1, s[12:15], s43 offen offset:3072 sc1 lds
v_cvt_pk_bf16_f32 v143, v158, v159
s_waitcnt lgkmcnt(6)
M v[160:163], a[116:119], v[96:99], v[160:163]
v_exp_f32 v32, v32
M v[160:163], a[120:123], v[128:131], v[160:163]
ds_read_b128 a[148:151], v3 offset:36864
ds_read_b128 a[152:155], v3 offset:45056
M v[164:167], a[120:123], v[132:135], v[164:167]
v_exp_f32 v33, v33
M v[164:167], a[116:119], v[100:103], v[164:167]
v_cvt_pk_bf16_f32 v32, v32, v33
M v[168:171], a[116:119], v[104:107], v[168:171]
v_exp_f32 v34, v34
M v[168:171], a[120:123], v[136:139], v[168:171]
s_add_u32 s25, s25, 32768
s_cmp_eq_u32 s25, s27
M v[172:175], a[120:123], v[140:143], v[172:175]
v_exp_f32 v35, v35
M v[172:175], a[116:119], v[108:111], v[172:175]
v_cvt_pk_bf16_f32 v33, v34, v35
s_waitcnt lgkmcnt(6)
M a[96:99], a[112:115], v[96:99], a[96:99]
s_cselect_b32 s25, s28, s25
s_cselect_b32 s27, -1, s27
M a[96:99], a[112:115], v[128:131], a[96:99]
s_add_u32 s26, s26, 32768
s_cmp_eq_u32 s26, s62
M v[176:179], a[124:127], v[96:99], v[176:179]
v_exp_f32 v48, v48
M v[176:179], a[128:131], v[128:131], v[176:179]
ds_read_b128 a[156:159], v3 offset:37888
ds_read_b128 a[160:163], v3 offset:46080
M v[180:183], a[128:131], v[132:135], v[180:183]
v_exp_f32 v49, v49
M v[180:183], a[124:127], v[100:103], v[180:183]
v_cvt_pk_bf16_f32 v34, v48, v49
M v[184:187], a[124:127], v[104:107], v[184:187]
v_exp_f32 v50, v50
M v[184:187], a[128:131], v[136:139], v[184:187]
s_cselect_b32 s26, s63, s26
s_cselect_b32 s62, -1, s62
M v[188:191], a[128:131], v[140:143], v[188:191]
v_exp_f32 v51, v51
M v[188:191], a[124:127], v[108:111], v[188:191]
v_cvt_pk_bf16_f32 v35, v50, v51
s_waitcnt lgkmcnt(6)
M a[100:103], a[112:115], v[100:103], a[100:103]
M a[100:103], a[112:115], v[132:135], a[100:103]
M v[192:195], a[132:135], v[96:99], v[192:195]
v_exp_f32 v36, v36
M v[192:195], a[136:139], v[128:131], v[192:195]
ds_read_b128 a[164:167], v3 offset:38912
ds_read_b128 a[168:171], v3 offset:47104
M v[196:199], a[136:139], v[132:135], v[196:199]
v_exp_f32 v37, v37
M v[196:199], a[132:135], v[100:103], v[196:199]
v_cvt_pk_bf16_f32 v36, v36, v37
M v[200:203], a[132:135], v[104:107], v[200:203]
v_exp_f32 v38, v38
M v[200:203], a[136:139], v[136:139], v[200:203]
M v[204:207], a[136:139], v[140:143], v[204:207]
v_exp_f32 v39, v39
M v[204:207], a[132:135], v[108:111], v[204:207]
v_cvt_pk_bf16_f32 v37, v38, v39
s_waitcnt lgkmcnt(6)
M a[104:107], a[112:115], v[104:107], a[104:107]
M a[104:107], a[112:115], v[136:139], a[104:107]
M v[208:211], a[140:143], v[96:99], v[208:211]
v_exp_f32 v52, v52
M v[208:211], a[144:147], v[128:131], v[208:211]
ds_read_b128 a[172:175], v3 offset:39936
ds_read_b128 a[176:179], v3 offset:48128
M v[212:215], a[144:147], v[132:135], v[212:215]
v_exp_f32 v53, v53
M v[212:215], a[140:143], v[100:103], v[212:215]
v_cvt_pk_bf16_f32 v38, v52, v53
M v[216:219], a[140:143], v[104:107], v[216:219]
v_exp_f32 v54, v54
M v[216:219], a[144:147], v[136:139], v[216:219]
M v[220:223], a[144:147], v[140:143], v[220:223]
v_exp_f32 v55, v55
M v[220:223], a[140:143], v[108:111], v[220:223]
v_cvt_pk_bf16_f32 v39, v54, v55
s_waitcnt lgkmcnt(6)
M a[108:111], a[112:115], v[108:111], a[108:111]
M a[108:111], a[112:115], v[140:143], a[108:111]
M v[224:227], a[148:151], v[96:99], v[224:227]
v_exp_f32 v40, v40
M v[224:227], a[152:155], v[128:131], v[224:227]
M v[228:231], a[152:155], v[132:135], v[228:231]
v_exp_f32 v41, v41
M v[228:231], a[148:151], v[100:103], v[228:231]
v_cvt_pk_bf16_f32 v40, v40, v41
M v[232:235], a[148:151], v[104:107], v[232:235]
v_exp_f32 v42, v42
M v[232:235], a[152:155], v[136:139], v[232:235]
M v[236:239], a[152:155], v[140:143], v[236:239]
v_exp_f32 v43, v43
M v[236:239], a[148:151], v[108:111], v[236:239]
v_cvt_pk_bf16_f32 v41, v42, v43
s_waitcnt lgkmcnt(4)
M v[240:243], a[156:159], v[96:99], v[240:243]
v_exp_f32 v56, v56
M v[240:243], a[160:163], v[128:131], v[240:243]
M v[244:247], a[160:163], v[132:135], v[244:247]
v_exp_f32 v57, v57
M v[244:247], a[156:159], v[100:103], v[244:247]
v_cvt_pk_bf16_f32 v42, v56, v57
M v[248:251], a[156:159], v[104:107], v[248:251]
v_exp_f32 v58, v58
M v[248:251], a[160:163], v[136:139], v[248:251]
s_waitcnt vmcnt(0) lgkmcnt(0)
s_barrier
ds_read_b128 a[116:119], v2 offset:0
ds_read_b128 a[120:123], v2 offset:1024
M v[252:255], a[160:163], v[140:143], v[252:255]
v_exp_f32 v59, v59
M v[252:255], a[156:159], v[108:111], v[252:255]
v_cvt_pk_bf16_f32 v43, v58, v59
M a[64:67], a[164:167], v[96:99], a[64:67]
v_exp_f32 v44, v44
M a[64:67], a[168:171], v[128:131], a[64:67]
ds_read_b128 a[124:127], v2 offset:2048
ds_read_b128 a[128:131], v2 offset:3072
M a[68:71], a[168:171], v[132:135], a[68:71]
v_exp_f32 v45, v45
M a[68:71], a[164:167], v[100:103], a[68:71]
v_cvt_pk_bf16_f32 v44, v44, v45
M a[72:75], a[164:167], v[104:107], a[72:75]
v_exp_f32 v46, v46
M a[72:75], a[168:171], v[136:139], a[72:75]
ds_read_b128 a[132:135], v2 offset:4096
ds_read_b128 a[136:139], v2 offset:5120
M a[76:79], a[168:171], v[140:143], a[76:79]
v_exp_f32 v47, v47
M a[76:79], a[164:167], v[108:111], a[76:79]
v_cvt_pk_bf16_f32 v45, v46, v47
M a[80:83], a[172:175], v[96:99], a[80:83]
v_exp_f32 v60, v60
M a[80:83], a[176:179], v[128:131], a[80:83]
ds_read_b128 a[140:143], v2 offset:6144
ds_read_b128 a[144:147], v2 offset:7168
M a[84:87], a[176:179], v[132:135], a[84:87]
v_exp_f32 v61, v61
M a[84:87], a[172:175], v[100:103], a[84:87]
v_cvt_pk_bf16_f32 v46, v60, v61
M a[88:91], a[172:175], v[104:107], a[88:91]
v_exp_f32 v62, v62
M a[88:91], a[176:179], v[136:139], a[88:91]
M a[92:95], a[176:179], v[140:143], a[92:95]
v_exp_f32 v63, v63
M a[92:95], a[172:175], v[108:111], a[92:95]
v_cvt_pk_bf16_f32 v47, v62, v63
s_branch Lk2_l1
Lk2_m1:
s_lshl_b32 s33, s23, 6
s_add_i32 s33, s33, 0
s_cmp_gt_i32 s33, 0
s_cselect_b32 s34, 0, 0xf149f2ca
s_cmp_lt_i32 s33, 0
s_cselect_b32 s33, 0xf149f2ca, 0
v_mov_b32 v20, s34
v_mov_b32 v21, s34
v_mov_b32 v22, s34
v_mov_b32 v23, s34
v_mov_b32 v28, s33
v_mov_b32 v29, s33
v_mov_b32 v30, s33
v_mov_b32 v31, s33
v_med3_f32 v24, v16, v20, v28
v_med3_f32 v25, v17, v20, v28
v_med3_f32 v26, v18, v20, v28
v_med3_f32 v27, v19, v20, v28
s_add_u32 m0, s29, 0
s_waitcnt lgkmcnt(4)
M v[32:35], a[116:119], a[0:3], v[24:27]
v_exp_f32 v128, v128
M v[32:35], a[120:123], a[4:7], v[32:35]
ds_read_b128 a[148:151], v3 offset:8192
ds_read_b128 a[152:155], v3 offset:9216
M v[32:35], a[124:127], a[8:11], v[32:35]
v_exp_f32 v129, v129
M v[32:35], a[128:131], a[12:15], v[32:35]
buffer_load_dwordx4 v1, s[12:15], s25 offen offset:0 sc1 lds
s_add_u32 s32, s25, 4096
M v[36:39], a[128:131], a[28:31], v[28:31]
v_exp_f32 v130, v130
M v[36:39], a[124:127], a[24:27], v[36:39]
v_cvt_pk_bf16_f32 v128, v128, v129
M v[36:39], a[120:123], a[20:23], v[36:39]
v_exp_f32 v131, v131
M v[36:39], a[116:119], a[16:19], v[36:39]
buffer_load_dwordx4 v1, s[12:15], s25 offen offset:1024 sc1 lds
M v[40:43], a[116:119], a[32:35], v[28:31]
v_exp_f32 v144, v144
M v[40:43], a[120:123], a[36:39], v[40:43]
ds_read_b128 a[156:159], v3 offset:10240
ds_read_b128 a[160:163], v3 offset:11264
M v[40:43], a[124:127], a[40:43], v[40:43]
v_exp_f32 v145, v145
M v[40:43], a[128:131], a[44:47], v[40:43]
buffer_load_dwordx4 v1, s[12:15], s25 offen offset:2048 sc1 lds
M v[44:47], a[128:131], a[60:63], v[28:31]
v_exp_f32 v146, v146
M v[44:47], a[124:127], a[56:59], v[44:47]
v_cvt_pk_bf16_f32 v129, v130, v131
v_cvt_pk_bf16_f32 v130, v144, v145
M v[44:47], a[120:123], a[52:55], v[44:47]
v_exp_f32 v147, v147
M v[44:47], a[116:119], a[48:51], v[44:47]
buffer_load_dwordx4 v1, s[12:15], s25 offen offset:3072 sc1 lds
s_add_u32 m0, s29, 4096
s_waitcnt lgkmcnt(4)
M v[48:51], a[132:135], a[0:3], v[20:23]
v_exp_f32 v132, v132
M v[48:51], a[136:139], a[4:7], v[48:51]
ds_read_b128 a[164:167], v3 offset:12288
ds_read_b128 a[168:171], v3 offset:13312
M v[48:51], a[140:143], a[8:11], v[48:51]
v_exp_f32 v133, v133
M v[48:51], a[144:147], a[12:15], v[48:51]
buffer_load_dwordx4 v1, s[12:15], s32 offen offset:0 sc1 lds
M v[52:55], a[144:147], a[28:31], v[24:27]
v_exp_f32 v134, v134
M v[52:55], a[140:143], a[24:27], v[52:55]
v_cvt_pk_bf16_f32 v131, v146, v147
v_cvt_pk_bf16_f32 v132, v132, v133
M v[52:55], a[136:139], a[20:23], v[52:55]
v_exp_f32 v135, v135
M v[52:55], a[132:135], a[16:19], v[52:55]
buffer_load_dwordx4 v1, s[12:15], s32 offen offset:1024 sc1 lds
M v[56:59], a[132:135], a[32:35], v[28:31]
v_exp_f32 v148, v148
M v[56:59], a[136:139], a[36:39], v[56:59]
ds_read_b128 a[172:175], v3 offset:14336
ds_read_b128 a[176:179], v3 offset:15360
M v[56:59], a[140:143], a[40:43], v[56:59]
v_exp_f32 v149, v149
M v[56:59], a[144:147], a[44:47], v[56:59]
buffer_load_dwordx4 v1, s[12:15], s32 offen offset:2048 sc1 lds
M v[60:63], a[144:147], a[60:63], v[28:31]
v_exp_f32 v150, v150
M v[60:63], a[140:143], a[56:59], v[60:63]
v_cvt_pk_bf16_f32 v133, v134, v135
v_cvt_pk_bf16_f32 v134, v148, v149
M v[60:63], a[136:139], a[52:55], v[60:63]
v_exp_f32 v151, v151
M v[60:63], a[132:135], a[48:51], v[60:63]
buffer_load_dwordx4 v1, s[12:15], s32 offen offset:3072 sc1 lds
s_add_u32 m0, s29, 32768
s_waitcnt lgkmcnt(4)
M v[64:67], a[148:151], a[0:3], v[20:23]
v_exp_f32 v136, v136
M v[64:67], a[152:155], a[4:7], v[64:67]
ds_read_b128 a[116:119], v3 offset:32768
ds_read_b128 a[120:123], v3 offset:40960
M v[64:67], a[156:159], a[8:11], v[64:67]
v_exp_f32 v137, v137
M v[64:67], a[160:163], a[12:15], v[64:67]
buffer_load_dwordx4 v1, s[12:15], s26 offen offset:0 sc1 lds
s_add_u32 s43, s26, 4096
M v[68:71], a[160:163], a[28:31], v[20:23]
v_exp_f32 v138, v138
M v[68:71], a[156:159], a[24:27], v[68:71]
v_cvt_pk_bf16_f32 v135, v150, v151
v_cvt_pk_bf16_f32 v136, v136, v137
M v[68:71], a[152:155], a[20:23], v[68:71]
v_exp_f32 v139, v139
M v[68:71], a[148:151], a[16:19], v[68:71]
buffer_load_dwordx4 v1, s[12:15], s26 offen offset:1024 sc1 lds
M v[72:75], a[148:151], a[32:35], v[24:27]
v_exp_f32 v152, v152
M v[72:75], a[152:155], a[36:39], v[72:75]
ds_read_b128 a[124:127], v3 offset:33792
ds_read_b128 a[128:131], v3 offset:41984
M v[72:75], a[156:159], a[40:43], v[72:75]
v_exp_f32 v153, v153
M v[72:75], a[160:163], a[44:47], v[72:75]
buffer_load_dwordx4 v1, s[12:15], s26 offen offset:2048 sc1 lds
M v[76:79], a[160:163], a[60:63], v[28:31]
v_exp_f32 v154, v154
M v[76:79], a[156:159], a[56:59], v[76:79]
v_cvt_pk_bf16_f32 v137, v138, v139
v_cvt_pk_bf16_f32 v138, v152, v153
M v[76:79], a[152:155], a[52:55], v[76:79]
v_exp_f32 v155, v155
M v[76:79], a[148:151], a[48:51], v[76:79]
buffer_load_dwordx4 v1, s[12:15], s26 offen offset:3072 sc1 lds
s_add_u32 m0, s29, 36864
s_waitcnt lgkmcnt(4)
M v[80:83], a[164:167], a[0:3], v[20:23]
v_exp_f32 v140, v140
M v[80:83], a[168:171], a[4:7], v[80:83]
ds_read_b128 a[132:135], v3 offset:34816
ds_read_b128 a[136:139], v3 offset:43008
M v[80:83], a[172:175], a[8:11], v[80:83]
v_exp_f32 v141, v141
M v[80:83], a[176:179], a[12:15], v[80:83]
buffer_load_dwordx4 v1, s[12:15], s43 offen offset:0 sc1 lds
M v[84:87], a[176:179], a[28:31], v[20:23]
v_exp_f32 v142, v142
M v[84:87], a[172:175], a[24:27], v[84:87]
v_cvt_pk_bf16_f32 v139, v154, v155
v_cvt_pk_bf16_f32 v140, v140, v141
M v[84:87], a[168:171], a[20:23], v[84:87]
v_exp_f32 v143, v143
M v[84:87], a[164:167], a[16:19], v[84:87]
buffer_load_dwordx4 v1, s[12:15], s43 offen offset:1024 sc1 lds
M v[88:91], a[164:167], a[32:35], v[20:23]
v_exp_f32 v156, v156
M v[88:91], a[168:171], a[36:39], v[88:91]
ds_read_b128 a[140:143], v3 offset:35840
ds_read_b128 a[144:147], v3 offset:44032
M v[88:91], a[172:175], a[40:43], v[88:91]
v_exp_f32 v157, v157
M v[88:91], a[176:179], a[44:47], v[88:91]
buffer_load_dwordx4 v1, s[12:15], s43 offen offset:2048 sc1 lds
M v[92:95], a[176:179], a[60:63], v[24:27]
v_exp_f32 v158, v158
M v[92:95], a[172:175], a[56:59], v[92:95]
v_cvt_pk_bf16_f32 v141, v142, v143
v_cvt_pk_bf16_f32 v142, v156, v157
M v[92:95], a[168:171], a[52:55], v[92:95]
v_exp_f32 v159, v159
M v[92:95], a[164:167], a[48:51], v[92:95]
buffer_load_dwordx4 v1, s[12:15], s43 offen offset:3072 sc1 lds
v_cvt_pk_bf16_f32 v143, v158, v159
s_waitcnt lgkmcnt(6)
M v[160:163], a[116:119], v[96:99], v[160:163]
v_exp_f32 v32, v32
M v[160:163], a[120:123], v[128:131], v[160:163]
ds_read_b128 a[148:151], v3 offset:36864
ds_read_b128 a[152:155], v3 offset:45056
M v[164:167], a[120:123], v[132:135], v[164:167]
v_exp_f32 v33, v33
M v[164:167], a[116:119], v[100:103], v[164:167]
v_cvt_pk_bf16_f32 v32, v32, v33
M v[168:171], a[116:119], v[104:107], v[168:171]
v_exp_f32 v34, v34
M v[168:171], a[120:123], v[136:139], v[168:171]
s_add_u32 s25, s25, 32768
s_cmp_eq_u32 s25, s27
M v[172:175], a[120:123], v[140:143], v[172:175]
v_exp_f32 v35, v35
M v[172:175], a[116:119], v[108:111], v[172:175]
v_cvt_pk_bf16_f32 v33, v34, v35
s_waitcnt lgkmcnt(6)
M a[96:99], a[112:115], v[96:99], a[96:99]
s_cselect_b32 s25, s28, s25
s_cselect_b32 s27, -1, s27
M a[96:99], a[112:115], v[128:131], a[96:99]
s_add_u32 s26, s26, 32768
s_cmp_eq_u32 s26, s62
M v[176:179], a[124:127], v[96:99], v[176:179]
v_exp_f32 v48, v48
M v[176:179], a[128:131], v[128:131], v[176:179]
ds_read_b128 a[156:159], v3 offset:37888
ds_read_b128 a[160:163], v3 offset:46080
M v[180:183], a[128:131], v[132:135], v[180:183]
v_exp_f32 v49, v49
M v[180:183], a[124:127], v[100:103], v[180:183]
v_cvt_pk_bf16_f32 v34, v48, v49
M v[184:187], a[124:127], v[104:107], v[184:187]
v_exp_f32 v50, v50
M v[184:187], a[128:131], v[136:139], v[184:187]
s_cselect_b32 s26, s63, s26
s_cselect_b32 s62, -1, s62
M v[188:191], a[128:131], v[140:143], v[188:191]
v_exp_f32 v51, v51
M v[188:191], a[124:127], v[108:111], v[188:191]
v_cvt_pk_bf16_f32 v35, v50, v51
s_waitcnt lgkmcnt(6)
M a[100:103], a[112:115], v[100:103], a[100:103]
M a[100:103], a[112:115], v[132:135], a[100:103]
M v[192:195], a[132:135], v[96:99], v[192:195]
v_exp_f32 v36, v36
M v[192:195], a[136:139], v[128:131], v[192:195]
ds_read_b128 a[164:167], v3 offset:38912
ds_read_b128 a[168:171], v3 offset:47104
M v[196:199], a[136:139], v[132:135], v[196:199]
v_exp_f32 v37, v37
M v[196:199], a[132:135], v[100:103], v[196:199]
v_cvt_pk_bf16_f32 v36, v36, v37
M v[200:203], a[132:135], v[104:107], v[200:203]
v_exp_f32 v38, v38
M v[200:203], a[136:139], v[136:139], v[200:203]
M v[204:207], a[136:139], v[140:143], v[204:207]
v_exp_f32 v39, v39
M v[204:207], a[132:135], v[108:111], v[204:207]
v_cvt_pk_bf16_f32 v37, v38, v39
s_waitcnt lgkmcnt(6)
M a[104:107], a[112:115], v[104:107], a[104:107]
M a[104:107], a[112:115], v[136:139], a[104:107]
M v[208:211], a[140:143], v[96:99], v[208:211]
v_exp_f32 v52, v52
M v[208:211], a[144:147], v[128:131], v[208:211]
ds_read_b128 a[172:175], v3 offset:39936
ds_read_b128 a[176:179], v3 offset:48128
M v[212:215], a[144:147], v[132:135], v[212:215]
v_exp_f32 v53, v53
M v[212:215], a[140:143], v[100:103], v[212:215]
v_cvt_pk_bf16_f32 v38, v52, v53
M v[216:219], a[140:143], v[104:107], v[216:219]
v_exp_f32 v54, v54
M v[216:219], a[144:147], v[136:139], v[216:219]
M v[220:223], a[144:147], v[140:143], v[220:223]
v_exp_f32 v55, v55
M v[220:223], a[140:143], v[108:111], v[220:223]
v_cvt_pk_bf16_f32 v39, v54, v55
s_waitcnt lgkmcnt(6)
M a[108:111], a[112:115], v[108:111], a[108:111]
M a[108:111], a[112:115], v[140:143], a[108:111]
M v[224:227], a[148:151], v[96:99], v[224:227]
v_exp_f32 v40, v40
M v[224:227], a[152:155], v[128:131], v[224:227]
M v[228:231], a[152:155], v[132:135], v[228:231]
v_exp_f32 v41, v41
M v[228:231], a[148:151], v[100:103], v[228:231]
v_cvt_pk_bf16_f32 v40, v40, v41
M v[232:235], a[148:151], v[104:107], v[232:235]
v_exp_f32 v42, v42
M v[232:235], a[152:155], v[136:139], v[232:235]
M v[236:239], a[152:155], v[140:143], v[236:239]
v_exp_f32 v43, v43
M v[236:239], a[148:151], v[108:111], v[236:239]
v_cvt_pk_bf16_f32 v41, v42, v43
s_waitcnt lgkmcnt(4)
M v[240:243], a[156:159], v[96:99], v[240:243]
v_exp_f32 v56, v56
M v[240:243], a[160:163], v[128:131], v[240:243]
M v[244:247], a[160:163], v[132:135], v[244:247]
v_exp_f32 v57, v57
M v[244:247], a[156:159], v[100:103], v[244:247]
v_cvt_pk_bf16_f32 v42, v56, v57
M v[248:251], a[156:159], v[104:107], v[248:251]
v_exp_f32 v58, v58
M v[248:251], a[160:163], v[136:139], v[248:251]
s_waitcnt vmcnt(0) lgkmcnt(0)
s_barrier
ds_read_b128 a[116:119], v2 offset:0
ds_read_b128 a[120:123], v2 offset:1024
M v[252:255], a[160:163], v[140:143], v[252:255]
v_exp_f32 v59, v59
M v[252:255], a[156:159], v[108:111], v[252:255]
v_cvt_pk_bf16_f32 v43, v58, v59
M a[64:67], a[164:167], v[96:99], a[64:67]
v_exp_f32 v44, v44
M a[64:67], a[168:171], v[128:131], a[64:67]
ds_read_b128 a[124:127], v2 offset:2048
ds_read_b128 a[128:131], v2 offset:3072
M a[68:71], a[168:171], v[132:135], a[68:71]
v_exp_f32 v45, v45
M a[68:71], a[164:167], v[100:103], a[68:71]
v_cvt_pk_bf16_f32 v44, v44, v45
M a[72:75], a[164:167], v[104:107], a[72:75]
v_exp_f32 v46, v46
M a[72:75], a[168:171], v[136:139], a[72:75]
ds_read_b128 a[132:135], v2 offset:4096
ds_read_b128 a[136:139], v2 offset:5120
M a[76:79], a[168:171], v[140:143], a[76:79]
v_exp_f32 v47, v47
M a[76:79], a[164:167], v[108:111], a[76:79]
v_cvt_pk_bf16_f32 v45, v46, v47
M a[80:83], a[172:175], v[96:99], a[80:83]
v_exp_f32 v60, v60
M a[80:83], a[176:179], v[128:131], a[80:83]
ds_read_b128 a[140:143], v2 offset:6144
ds_read_b128 a[144:147], v2 offset:7168
M a[84:87], a[176:179], v[132:135], a[84:87]
v_exp_f32 v61, v61
M a[84:87], a[172:175], v[100:103], a[84:87]
v_cvt_pk_bf16_f32 v46, v60, v61
M a[88:91], a[172:175], v[104:107], a[88:91]
v_exp_f32 v62, v62
M a[88:91], a[176:179], v[136:139], a[88:91]
M a[92:95], a[176:179], v[140:143], a[92:95]
v_exp_f32 v63, v63
M a[92:95], a[172:175], v[108:111], a[92:95]
v_cvt_pk_bf16_f32 v47, v62, v63
Lk2_m2:
s_sub_u32 s35, 15, s21
s_lshl_b32 s33, s20, 7
s_lshl_b32 s34, s35, 3
s_add_u32 s33, s33, s34
s_lshl_b32 s34, s23, 2
s_add_u32 s33, s33, s34
s_lshl_b32 s33, s33, 12
buffer_load_dwordx4 a[180:183], v1, s[8:11], s33 offen offset:0 sc1
buffer_load_dwordx4 a[184:187], v1, s[8:11], s33 offen offset:1024 sc1
buffer_load_dwordx4 a[188:191], v1, s[8:11], s33 offen offset:2048 sc1
buffer_load_dwordx4 a[192:195], v1, s[8:11], s33 offen offset:3072 sc1
s_add_u32 s33, s33, 4096
buffer_load_dwordx4 a[196:199], v1, s[8:11], s33 offen offset:0 sc1
buffer_load_dwordx4 a[200:203], v1, s[8:11], s33 offen offset:1024 sc1
buffer_load_dwordx4 a[204:207], v1, s[8:11], s33 offen offset:2048 sc1
buffer_load_dwordx4 a[208:211], v1, s[8:11], s33 offen offset:3072 sc1
s_add_u32 s33, s33, 4096
buffer_load_dwordx4 a[212:215], v1, s[8:11], s33 offen offset:0 sc1
buffer_load_dwordx4 a[216:219], v1, s[8:11], s33 offen offset:1024 sc1
buffer_load_dwordx4 a[220:223], v1, s[8:11], s33 offen offset:2048 sc1
buffer_load_dwordx4 a[224:227], v1, s[8:11], s33 offen offset:3072 sc1
s_add_u32 s33, s33, 4096
buffer_load_dwordx4 a[228:231], v1, s[8:11], s33 offen offset:0 sc1
buffer_load_dwordx4 a[232:235], v1, s[8:11], s33 offen offset:1024 sc1
buffer_load_dwordx4 a[236:239], v1, s[8:11], s33 offen offset:2048 sc1
buffer_load_dwordx4 a[240:243], v1, s[8:11], s33 offen offset:3072 sc1
s_lshl_b32 s33, s23, 6
s_add_i32 s33, s33, -64
s_cmp_gt_i32 s33, 0
s_cselect_b32 s34, 0, 0xf149f2ca
s_cmp_lt_i32 s33, 0
s_cselect_b32 s33, 0xf149f2ca, 0
v_mov_b32 v20, s34
v_mov_b32 v21, s34
v_mov_b32 v22, s34
v_mov_b32 v23, s34
v_mov_b32 v28, s33
v_mov_b32 v29, s33
v_mov_b32 v30, s33
v_mov_b32 v31, s33
v_med3_f32 v24, v16, v20, v28
v_med3_f32 v25, v17, v20, v28
v_med3_f32 v26, v18, v20, v28
v_med3_f32 v27, v19, v20, v28
s_add_u32 m0, s29, 65536
s_waitcnt lgkmcnt(4)
M v[96:99], a[116:119], a[0:3], v[24:27]
v_exp_f32 v64, v64
M v[96:99], a[120:123], a[4:7], v[96:99]
ds_read_b128 a[148:151], v2 offset:8192
ds_read_b128 a[152:155], v2 offset:9216
M v[96:99], a[124:127], a[8:11], v[96:99]
v_exp_f32 v65, v65
M v[96:99], a[128:131], a[12:15], v[96:99]
buffer_load_dwordx4 v1, s[12:15], s25 offen offset:0 sc1 lds
s_add_u32 s32, s25, 4096
M v[100:103], a[128:131], a[28:31], v[28:31]
v_exp_f32 v66, v66
M v[100:103], a[124:127], a[24:27], v[100:103]
v_cvt_pk_bf16_f32 v64, v64, v65
M v[100:103], a[120:123], a[20:23], v[100:103]
v_exp_f32 v67, v67
M v[100:103], a[116:119], a[16:19], v[100:103]
buffer_load_dwordx4 v1, s[12:15], s25 offen offset:1024 sc1 lds
M v[104:107], a[116:119], a[32:35], v[28:31]
v_exp_f32 v80, v80
M v[104:107], a[120:123], a[36:39], v[104:107]
ds_read_b128 a[156:159], v2 offset:10240
ds_read_b128 a[160:163], v2 offset:11264
M v[104:107], a[124:127], a[40:43], v[104:107]
v_exp_f32 v81, v81
M v[104:107], a[128:131], a[44:47], v[104:107]
buffer_load_dwordx4 v1, s[12:15], s25 offen offset:2048 sc1 lds
M v[108:111], a[128:131], a[60:63], v[28:31]
v_exp_f32 v82, v82
M v[108:111], a[124:127], a[56:59], v[108:111]
v_cvt_pk_bf16_f32 v65, v66, v67
v_cvt_pk_bf16_f32 v66, v80, v81
M v[108:111], a[120:123], a[52:55], v[108:111]
v_exp_f32 v83, v83
M v[108:111], a[116:119], a[48:51], v[108:111]
buffer_load_dwordx4 v1, s[12:15], s25 offen offset:3072 sc1 lds
s_add_u32 m0, s29, 69632
s_waitcnt lgkmcnt(4)
M v[112:115], a[132:135], a[0:3], v[20:23]
v_exp_f32 v68, v68
M v[112:115], a[136:139], a[4:7], v[112:115]
ds_read_b128 a[164:167], v2 offset:12288
ds_read_b128 a[168:171], v2 offset:13312
M v[112:115], a[140:143], a[8:11], v[112:115]
v_exp_f32 v69, v69
M v[112:115], a[144:147], a[12:15], v[112:115]
buffer_load_dwordx4 v1, s[12:15], s32 offen offset:0 sc1 lds
M v[116:119], a[144:147], a[28:31], v[24:27]
v_exp_f32 v70, v70
M v[116:119], a[140:143], a[24:27], v[116:119]
v_cvt_pk_bf16_f32 v67, v82, v83
v_cvt_pk_bf16_f32 v68, v68, v69
M v[116:119], a[136:139], a[20:23], v[116:119]
v_exp_f32 v71, v71
M v[116:119], a[132:135], a[16:19], v[116:119]
buffer_load_dwordx4 v1, s[12:15], s32 offen offset:1024 sc1 lds
M v[120:123], a[132:135], a[32:35], v[28:31]
v_exp_f32 v84, v84
M v[120:123], a[136:139], a[36:39], v[120:123]
ds_read_b128 a[172:175], v2 offset:14336
ds_read_b128 a[176:179], v2 offset:15360
M v[120:123], a[140:143], a[40:43], v[120:123]
v_exp_f32 v85, v85
M v[120:123], a[144:147], a[44:47], v[120:123]
buffer_load_dwordx4 v1, s[12:15], s32 offen offset:2048 sc1 lds
M v[124:127], a[144:147], a[60:63], v[28:31]
v_exp_f32 v86, v86
M v[124:127], a[140:143], a[56:59], v[124:127]
v_cvt_pk_bf16_f32 v69, v70, v71
v_cvt_pk_bf16_f32 v70, v84, v85
M v[124:127], a[136:139], a[52:55], v[124:127]
v_exp_f32 v87, v87
M v[124:127], a[132:135], a[48:51], v[124:127]
buffer_load_dwordx4 v1, s[12:15], s32 offen offset:3072 sc1 lds
s_add_u32 m0, s29, 98304
s_waitcnt lgkmcnt(4)
M v[128:131], a[148:151], a[0:3], v[20:23]
v_exp_f32 v72, v72
M v[128:131], a[152:155], a[4:7], v[128:131]
ds_read_b128 a[116:119], v2 offset:32768
ds_read_b128 a[120:123], v2 offset:40960
M v[128:131], a[156:159], a[8:11], v[128:131]
v_exp_f32 v73, v73
M v[128:131], a[160:163], a[12:15], v[128:131]
buffer_load_dwordx4 v1, s[12:15], s26 offen offset:0 sc1 lds
s_add_u32 s43, s26, 4096
M v[132:135], a[160:163], a[28:31], v[20:23]
v_exp_f32 v74, v74
M v[132:135], a[156:159], a[24:27], v[132:135]
v_cvt_pk_bf16_f32 v71, v86, v87
v_cvt_pk_bf16_f32 v72, v72, v73
M v[132:135], a[152:155], a[20:23], v[132:135]
v_exp_f32 v75, v75
M v[132:135], a[148:151], a[16:19], v[132:135]
buffer_load_dwordx4 v1, s[12:15], s26 offen offset:1024 sc1 lds
M v[136:139], a[148:151], a[32:35], v[24:27]
v_exp_f32 v88, v88
M v[136:139], a[152:155], a[36:39], v[136:139]
ds_read_b128 a[124:127], v2 offset:33792
ds_read_b128 a[128:131], v2 offset:41984
M v[136:139], a[156:159], a[40:43], v[136:139]
v_exp_f32 v89, v89
M v[136:139], a[160:163], a[44:47], v[136:139]
buffer_load_dwordx4 v1, s[12:15], s26 offen offset:2048 sc1 lds
M v[140:143], a[160:163], a[60:63], v[28:31]
v_exp_f32 v90, v90
M v[140:143], a[156:159], a[56:59], v[140:143]
v_cvt_pk_bf16_f32 v73, v74, v75
v_cvt_pk_bf16_f32 v74, v88, v89
M v[140:143], a[152:155], a[52:55], v[140:143]
v_exp_f32 v91, v91
M v[140:143], a[148:151], a[48:51], v[140:143]
buffer_load_dwordx4 v1, s[12:15], s26 offen offset:3072 sc1 lds
s_add_u32 m0, s29, 102400
s_waitcnt lgkmcnt(4)
M v[144:147], a[164:167], a[0:3], v[20:23]
v_exp_f32 v76, v76
M v[144:147], a[168:171], a[4:7], v[144:147]
ds_read_b128 a[132:135], v2 offset:34816
ds_read_b128 a[136:139], v2 offset:43008
M v[144:147], a[172:175], a[8:11], v[144:147]
v_exp_f32 v77, v77
M v[144:147], a[176:179], a[12:15], v[144:147]
buffer_load_dwordx4 v1, s[12:15], s43 offen offset:0 sc1 lds
M v[148:151], a[176:179], a[28:31], v[20:23]
v_exp_f32 v78, v78
M v[148:151], a[172:175], a[24:27], v[148:151]
v_cvt_pk_bf16_f32 v75, v90, v91
v_cvt_pk_bf16_f32 v76, v76, v77
M v[148:151], a[168:171], a[20:23], v[148:151]
v_exp_f32 v79, v79
M v[148:151], a[164:167], a[16:19], v[148:151]
buffer_load_dwordx4 v1, s[12:15], s43 offen offset:1024 sc1 lds
M v[152:155], a[164:167], a[32:35], v[20:23]
v_exp_f32 v92, v92
M v[152:155], a[168:171], a[36:39], v[152:155]
ds_read_b128 a[140:143], v2 offset:35840
ds_read_b128 a[144:147], v2 offset:44032
M v[152:155], a[172:175], a[40:43], v[152:155]
v_exp_f32 v93, v93
M v[152:155], a[176:179], a[44:47], v[152:155]
buffer_load_dwordx4 v1, s[12:15], s43 offen offset:2048 sc1 lds
M v[156:159], a[176:179], a[60:63], v[24:27]
v_exp_f32 v94, v94
M v[156:159], a[172:175], a[56:59], v[156:159]
v_cvt_pk_bf16_f32 v77, v78, v79
v_cvt_pk_bf16_f32 v78, v92, v93
M v[156:159], a[168:171], a[52:55], v[156:159]
v_exp_f32 v95, v95
M v[156:159], a[164:167], a[48:51], v[156:159]
buffer_load_dwordx4 v1, s[12:15], s43 offen offset:3072 sc1 lds
v_cvt_pk_bf16_f32 v79, v94, v95
s_waitcnt lgkmcnt(6)
M v[160:163], a[116:119], v[32:35], v[160:163]
v_exp_f32 v96, v96
M v[160:163], a[120:123], v[64:67], v[160:163]
ds_read_b128 a[148:151], v2 offset:36864
ds_read_b128 a[152:155], v2 offset:45056
M v[164:167], a[120:123], v[68:71], v[164:167]
v_exp_f32 v97, v97
M v[164:167], a[116:119], v[36:39], v[164:167]
v_cvt_pk_bf16_f32 v96, v96, v97
M v[168:171], a[116:119], v[40:43], v[168:171]
v_exp_f32 v98, v98
M v[168:171], a[120:123], v[72:75], v[168:171]
s_add_u32 s25, s25, 32768
s_cmp_eq_u32 s25, s27
M v[172:175], a[120:123], v[76:79], v[172:175]
v_exp_f32 v99, v99
M v[172:175], a[116:119], v[44:47], v[172:175]
v_cvt_pk_bf16_f32 v97, v98, v99
s_waitcnt lgkmcnt(6)
M a[96:99], a[112:115], v[32:35], a[96:99]
s_cselect_b32 s25, s28, s25
s_cselect_b32 s27, -1, s27
M a[96:99], a[112:115], v[64:67], a[96:99]
s_add_u32 s26, s26, 32768
s_cmp_eq_u32 s26, s62
M v[176:179], a[124:127], v[32:35], v[176:179]
v_exp_f32 v112, v112
M v[176:179], a[128:131], v[64:67], v[176:179]
ds_read_b128 a[156:159], v2 offset:37888
ds_read_b128 a[160:163], v2 offset:46080
M v[180:183], a[128:131], v[68:71], v[180:183]
v_exp_f32 v113, v113
M v[180:183], a[124:127], v[36:39], v[180:183]
v_cvt_pk_bf16_f32 v98, v112, v113
M v[184:187], a[124:127], v[40:43], v[184:187]
v_exp_f32 v114, v114
M v[184:187], a[128:131], v[72:75], v[184:187]
s_cselect_b32 s26, s63, s26
s_cselect_b32 s62, -1, s62
M v[188:191], a[128:131], v[76:79], v[188:191]
v_exp_f32 v115, v115
M v[188:191], a[124:127], v[44:47], v[188:191]
v_cvt_pk_bf16_f32 v99, v114, v115
s_waitcnt lgkmcnt(6)
M a[100:103], a[112:115], v[36:39], a[100:103]
M a[100:103], a[112:115], v[68:71], a[100:103]
M v[192:195], a[132:135], v[32:35], v[192:195]
v_exp_f32 v100, v100
M v[192:195], a[136:139], v[64:67], v[192:195]
ds_read_b128 a[164:167], v2 offset:38912
ds_read_b128 a[168:171], v2 offset:47104
M v[196:199], a[136:139], v[68:71], v[196:199]
v_exp_f32 v101, v101
M v[196:199], a[132:135], v[36:39], v[196:199]
v_cvt_pk_bf16_f32 v100, v100, v101
M v[200:203], a[132:135], v[40:43], v[200:203]
v_exp_f32 v102, v102
M v[200:203], a[136:139], v[72:75], v[200:203]
M v[204:207], a[136:139], v[76:79], v[204:207]
v_exp_f32 v103, v103
M v[204:207], a[132:135], v[44:47], v[204:207]
v_cvt_pk_bf16_f32 v101, v102, v103
s_waitcnt lgkmcnt(6)
M a[104:107], a[112:115], v[40:43], a[104:107]
M a[104:107], a[112:115], v[72:75], a[104:107]
M v[208:211], a[140:143], v[32:35], v[208:211]
v_exp_f32 v116, v116
M v[208:211], a[144:147], v[64:67], v[208:211]
ds_read_b128 a[172:175], v2 offset:39936
ds_read_b128 a[176:179], v2 offset:48128
M v[212:215], a[144:147], v[68:71], v[212:215]
v_exp_f32 v117, v117
M v[212:215], a[140:143], v[36:39], v[212:215]
v_cvt_pk_bf16_f32 v102, v116, v117
M v[216:219], a[140:143], v[40:43], v[216:219]
v_exp_f32 v118, v118
M v[216:219], a[144:147], v[72:75], v[216:219]
M v[220:223], a[144:147], v[76:79], v[220:223]
v_exp_f32 v119, v119
M v[220:223], a[140:143], v[44:47], v[220:223]
v_cvt_pk_bf16_f32 v103, v118, v119
s_waitcnt lgkmcnt(6)
M a[108:111], a[112:115], v[44:47], a[108:111]
M a[108:111], a[112:115], v[76:79], a[108:111]
M v[224:227], a[148:151], v[32:35], v[224:227]
v_exp_f32 v104, v104
M v[224:227], a[152:155], v[64:67], v[224:227]
M v[228:231], a[152:155], v[68:71], v[228:231]
v_exp_f32 v105, v105
M v[228:231], a[148:151], v[36:39], v[228:231]
v_cvt_pk_bf16_f32 v104, v104, v105
M v[232:235], a[148:151], v[40:43], v[232:235]
v_exp_f32 v106, v106
M v[232:235], a[152:155], v[72:75], v[232:235]
M v[236:239], a[152:155], v[76:79], v[236:239]
v_exp_f32 v107, v107
M v[236:239], a[148:151], v[44:47], v[236:239]
v_cvt_pk_bf16_f32 v105, v106, v107
s_waitcnt lgkmcnt(4)
M v[240:243], a[156:159], v[32:35], v[240:243]
v_exp_f32 v120, v120
M v[240:243], a[160:163], v[64:67], v[240:243]
M v[244:247], a[160:163], v[68:71], v[244:247]
v_exp_f32 v121, v121
M v[244:247], a[156:159], v[36:39], v[244:247]
v_cvt_pk_bf16_f32 v106, v120, v121
M v[248:251], a[156:159], v[40:43], v[248:251]
v_exp_f32 v122, v122
M v[248:251], a[160:163], v[72:75], v[248:251]
s_waitcnt vmcnt(0) lgkmcnt(0)
s_barrier
ds_read_b128 a[116:119], v3 offset:0
ds_read_b128 a[120:123], v3 offset:1024
M v[252:255], a[160:163], v[76:79], v[252:255]
v_exp_f32 v123, v123
M v[252:255], a[156:159], v[44:47], v[252:255]
v_cvt_pk_bf16_f32 v107, v122, v123
M a[64:67], a[164:167], v[32:35], a[64:67]
v_exp_f32 v108, v108
M a[64:67], a[168:171], v[64:67], a[64:67]
ds_read_b128 a[124:127], v3 offset:2048
ds_read_b128 a[128:131], v3 offset:3072
M a[68:71], a[168:171], v[68:71], a[68:71]
v_exp_f32 v109, v109
M a[68:71], a[164:167], v[36:39], a[68:71]
v_cvt_pk_bf16_f32 v108, v108, v109
M a[72:75], a[164:167], v[40:43], a[72:75]
v_exp_f32 v110, v110
M a[72:75], a[168:171], v[72:75], a[72:75]
ds_read_b128 a[132:135], v3 offset:4096
ds_read_b128 a[136:139], v3 offset:5120
M a[76:79], a[168:171], v[76:79], a[76:79]
v_exp_f32 v111, v111
M a[76:79], a[164:167], v[44:47], a[76:79]
v_cvt_pk_bf16_f32 v109, v110, v111
M a[80:83], a[172:175], v[32:35], a[80:83]
v_exp_f32 v124, v124
M a[80:83], a[176:179], v[64:67], a[80:83]
ds_read_b128 a[140:143], v3 offset:6144
ds_read_b128 a[144:147], v3 offset:7168
M a[84:87], a[176:179], v[68:71], a[84:87]
v_exp_f32 v125, v125
M a[84:87], a[172:175], v[36:39], a[84:87]
v_cvt_pk_bf16_f32 v110, v124, v125
M a[88:91], a[172:175], v[40:43], a[88:91]
v_exp_f32 v126, v126
M a[88:91], a[176:179], v[72:75], a[88:91]
M a[92:95], a[176:179], v[76:79], a[92:95]
v_exp_f32 v127, v127
M a[92:95], a[172:175], v[44:47], a[92:95]
v_cvt_pk_bf16_f32 v111, v126, v127
s_waitcnt vmcnt(16)
s_add_u32 m0, s29, 0
s_waitcnt lgkmcnt(4)
M v[32:35], a[116:119], a[180:183], 0
v_exp_f32 v128, v128
M v[32:35], a[120:123], a[184:187], v[32:35]
ds_read_b128 a[148:151], v3 offset:8192
ds_read_b128 a[152:155], v3 offset:9216
M v[32:35], a[124:127], a[188:191], v[32:35]
v_exp_f32 v129, v129
M v[32:35], a[128:131], a[192:195], v[32:35]
buffer_load_dwordx4 v1, s[12:15], s25 offen offset:0 sc1 lds
s_add_u32 s32, s25, 4096
M v[36:39], a[128:131], a[208:211], 0
v_exp_f32 v130, v130
M v[36:39], a[124:127], a[204:207], v[36:39]
v_cvt_pk_bf16_f32 v128, v128, v129
M v[36:39], a[120:123], a[200:203], v[36:39]
v_exp_f32 v131, v131
M v[36:39], a[116:119], a[196:199], v[36:39]
buffer_load_dwordx4 v1, s[12:15], s25 offen offset:1024 sc1 lds
M v[40:43], a[116:119], a[212:215], 0
v_exp_f32 v144, v144
M v[40:43], a[120:123], a[216:219], v[40:43]
ds_read_b128 a[156:159], v3 offset:10240
ds_read_b128 a[160:163], v3 offset:11264
M v[40:43], a[124:127], a[220:223], v[40:43]
v_exp_f32 v145, v145
M v[40:43], a[128:131], a[224:227], v[40:43]
buffer_load_dwordx4 v1, s[12:15], s25 offen offset:2048 sc1 lds
M v[44:47], a[128:131], a[240:243], 0
v_exp_f32 v146, v146
M v[44:47], a[124:127], a[236:239], v[44:47]
v_cvt_pk_bf16_f32 v129, v130, v131
v_cvt_pk_bf16_f32 v130, v144, v145
M v[44:47], a[120:123], a[232:235], v[44:47]
v_exp_f32 v147, v147
M v[44:47], a[116:119], a[228:231], v[44:47]
buffer_load_dwordx4 v1, s[12:15], s25 offen offset:3072 sc1 lds
s_add_u32 m0, s29, 4096
s_waitcnt lgkmcnt(4)
M v[48:51], a[132:135], a[180:183], 0
v_exp_f32 v132, v132
M v[48:51], a[136:139], a[184:187], v[48:51]
ds_read_b128 a[164:167], v3 offset:12288
ds_read_b128 a[168:171], v3 offset:13312
M v[48:51], a[140:143], a[188:191], v[48:51]
v_exp_f32 v133, v133
M v[48:51], a[144:147], a[192:195], v[48:51]
buffer_load_dwordx4 v1, s[12:15], s32 offen offset:0 sc1 lds
M v[52:55], a[144:147], a[208:211], 0
v_exp_f32 v134, v134
M v[52:55], a[140:143], a[204:207], v[52:55]
v_cvt_pk_bf16_f32 v131, v146, v147
v_cvt_pk_bf16_f32 v132, v132, v133
M v[52:55], a[136:139], a[200:203], v[52:55]
v_exp_f32 v135, v135
M v[52:55], a[132:135], a[196:199], v[52:55]
buffer_load_dwordx4 v1, s[12:15], s32 offen offset:1024 sc1 lds
M v[56:59], a[132:135], a[212:215], 0
v_exp_f32 v148, v148
M v[56:59], a[136:139], a[216:219], v[56:59]
ds_read_b128 a[172:175], v3 offset:14336
ds_read_b128 a[176:179], v3 offset:15360
M v[56:59], a[140:143], a[220:223], v[56:59]
v_exp_f32 v149, v149
M v[56:59], a[144:147], a[224:227], v[56:59]
buffer_load_dwordx4 v1, s[12:15], s32 offen offset:2048 sc1 lds
M v[60:63], a[144:147], a[240:243], 0
v_exp_f32 v150, v150
M v[60:63], a[140:143], a[236:239], v[60:63]
v_cvt_pk_bf16_f32 v133, v134, v135
v_cvt_pk_bf16_f32 v134, v148, v149
M v[60:63], a[136:139], a[232:235], v[60:63]
v_exp_f32 v151, v151
M v[60:63], a[132:135], a[228:231], v[60:63]
buffer_load_dwordx4 v1, s[12:15], s32 offen offset:3072 sc1 lds
s_add_u32 m0, s29, 32768
s_waitcnt lgkmcnt(4)
M v[64:67], a[148:151], a[180:183], 0
v_exp_f32 v136, v136
M v[64:67], a[152:155], a[184:187], v[64:67]
ds_read_b128 a[116:119], v3 offset:32768
ds_read_b128 a[120:123], v3 offset:40960
M v[64:67], a[156:159], a[188:191], v[64:67]
v_exp_f32 v137, v137
M v[64:67], a[160:163], a[192:195], v[64:67]
buffer_load_dwordx4 v1, s[12:15], s26 offen offset:0 sc1 lds
s_add_u32 s43, s26, 4096
M v[68:71], a[160:163], a[208:211], 0
v_exp_f32 v138, v138
M v[68:71], a[156:159], a[204:207], v[68:71]
v_cvt_pk_bf16_f32 v135, v150, v151
v_cvt_pk_bf16_f32 v136, v136, v137
M v[68:71], a[152:155], a[200:203], v[68:71]
v_exp_f32 v139, v139
M v[68:71], a[148:151], a[196:199], v[68:71]
buffer_load_dwordx4 v1, s[12:15], s26 offen offset:1024 sc1 lds
M v[72:75], a[148:151], a[212:215], 0
v_exp_f32 v152, v152
M v[72:75], a[152:155], a[216:219], v[72:75]
ds_read_b128 a[124:127], v3 offset:33792
ds_read_b128 a[128:131], v3 offset:41984
M v[72:75], a[156:159], a[220:223], v[72:75]
v_exp_f32 v153, v153
M v[72:75], a[160:163], a[224:227], v[72:75]
buffer_load_dwordx4 v1, s[12:15], s26 offen offset:2048 sc1 lds
M v[76:79], a[160:163], a[240:243], 0
v_exp_f32 v154, v154
M v[76:79], a[156:159], a[236:239], v[76:79]
v_cvt_pk_bf16_f32 v137, v138, v139
v_cvt_pk_bf16_f32 v138, v152, v153
M v[76:79], a[152:155], a[232:235], v[76:79]
v_exp_f32 v155, v155
M v[76:79], a[148:151], a[228:231], v[76:79]
buffer_load_dwordx4 v1, s[12:15], s26 offen offset:3072 sc1 lds
s_add_u32 m0, s29, 36864
s_waitcnt lgkmcnt(4)
M v[80:83], a[164:167], a[180:183], 0
v_exp_f32 v140, v140
M v[80:83], a[168:171], a[184:187], v[80:83]
ds_read_b128 a[132:135], v3 offset:34816
ds_read_b128 a[136:139], v3 offset:43008
M v[80:83], a[172:175], a[188:191], v[80:83]
v_exp_f32 v141, v141
M v[80:83], a[176:179], a[192:195], v[80:83]
buffer_load_dwordx4 v1, s[12:15], s43 offen offset:0 sc1 lds
M v[84:87], a[176:179], a[208:211], 0
v_exp_f32 v142, v142
M v[84:87], a[172:175], a[204:207], v[84:87]
v_cvt_pk_bf16_f32 v139, v154, v155
v_cvt_pk_bf16_f32 v140, v140, v141
M v[84:87], a[168:171], a[200:203], v[84:87]
v_exp_f32 v143, v143
M v[84:87], a[164:167], a[196:199], v[84:87]
buffer_load_dwordx4 v1, s[12:15], s43 offen offset:1024 sc1 lds
M v[88:91], a[164:167], a[212:215], 0
v_exp_f32 v156, v156
M v[88:91], a[168:171], a[216:219], v[88:91]
ds_read_b128 a[140:143], v3 offset:35840
ds_read_b128 a[144:147], v3 offset:44032
M v[88:91], a[172:175], a[220:223], v[88:91]
v_exp_f32 v157, v157
M v[88:91], a[176:179], a[224:227], v[88:91]
buffer_load_dwordx4 v1, s[12:15], s43 offen offset:2048 sc1 lds
M v[92:95], a[176:179], a[240:243], 0
v_exp_f32 v158, v158
M v[92:95], a[172:175], a[236:239], v[92:95]
v_cvt_pk_bf16_f32 v141, v142, v143
v_cvt_pk_bf16_f32 v142, v156, v157
M v[92:95], a[168:171], a[232:235], v[92:95]
v_exp_f32 v159, v159
M v[92:95], a[164:167], a[228:231], v[92:95]
buffer_load_dwordx4 v1, s[12:15], s43 offen offset:3072 sc1 lds
v_cvt_pk_bf16_f32 v143, v158, v159
s_waitcnt lgkmcnt(6)
M v[160:163], a[116:119], v[96:99], v[160:163]
v_exp_f32 v32, v32
M v[160:163], a[120:123], v[128:131], v[160:163]
ds_read_b128 a[148:151], v3 offset:36864
ds_read_b128 a[152:155], v3 offset:45056
M v[164:167], a[120:123], v[132:135], v[164:167]
v_exp_f32 v33, v33
M v[164:167], a[116:119], v[100:103], v[164:167]
v_cvt_pk_bf16_f32 v32, v32, v33
M v[168:171], a[116:119], v[104:107], v[168:171]
v_exp_f32 v34, v34
M v[168:171], a[120:123], v[136:139], v[168:171]
s_add_u32 s25, s25, 32768
s_cmp_eq_u32 s25, s27
M v[172:175], a[120:123], v[140:143], v[172:175]
v_exp_f32 v35, v35
M v[172:175], a[116:119], v[108:111], v[172:175]
v_cvt_pk_bf16_f32 v33, v34, v35
s_waitcnt lgkmcnt(6)
M a[96:99], a[112:115], v[96:99], a[96:99]
s_cselect_b32 s25, s28, s25
s_cselect_b32 s27, -1, s27
M a[96:99], a[112:115], v[128:131], a[96:99]
s_add_u32 s26, s26, 32768
s_cmp_eq_u32 s26, s62
M v[176:179], a[124:127], v[96:99], v[176:179]
v_exp_f32 v48, v48
M v[176:179], a[128:131], v[128:131], v[176:179]
ds_read_b128 a[156:159], v3 offset:37888
ds_read_b128 a[160:163], v3 offset:46080
M v[180:183], a[128:131], v[132:135], v[180:183]
v_exp_f32 v49, v49
M v[180:183], a[124:127], v[100:103], v[180:183]
v_cvt_pk_bf16_f32 v34, v48, v49
M v[184:187], a[124:127], v[104:107], v[184:187]
v_exp_f32 v50, v50
M v[184:187], a[128:131], v[136:139], v[184:187]
s_cselect_b32 s26, s63, s26
s_cselect_b32 s62, -1, s62
M v[188:191], a[128:131], v[140:143], v[188:191]
v_exp_f32 v51, v51
M v[188:191], a[124:127], v[108:111], v[188:191]
v_cvt_pk_bf16_f32 v35, v50, v51
s_waitcnt lgkmcnt(6)
M a[100:103], a[112:115], v[100:103], a[100:103]
M a[100:103], a[112:115], v[132:135], a[100:103]
M v[192:195], a[132:135], v[96:99], v[192:195]
v_exp_f32 v36, v36
M v[192:195], a[136:139], v[128:131], v[192:195]
ds_read_b128 a[164:167], v3 offset:38912
ds_read_b128 a[168:171], v3 offset:47104
M v[196:199], a[136:139], v[132:135], v[196:199]
v_exp_f32 v37, v37
M v[196:199], a[132:135], v[100:103], v[196:199]
v_cvt_pk_bf16_f32 v36, v36, v37
M v[200:203], a[132:135], v[104:107], v[200:203]
v_exp_f32 v38, v38
M v[200:203], a[136:139], v[136:139], v[200:203]
M v[204:207], a[136:139], v[140:143], v[204:207]
v_exp_f32 v39, v39
M v[204:207], a[132:135], v[108:111], v[204:207]
v_cvt_pk_bf16_f32 v37, v38, v39
s_waitcnt lgkmcnt(6)
M a[104:107], a[112:115], v[104:107], a[104:107]
M a[104:107], a[112:115], v[136:139], a[104:107]
M v[208:211], a[140:143], v[96:99], v[208:211]
v_exp_f32 v52, v52
M v[208:211], a[144:147], v[128:131], v[208:211]
ds_read_b128 a[172:175], v3 offset:39936
ds_read_b128 a[176:179], v3 offset:48128
M v[212:215], a[144:147], v[132:135], v[212:215]
v_exp_f32 v53, v53
M v[212:215], a[140:143], v[100:103], v[212:215]
v_cvt_pk_bf16_f32 v38, v52, v53
M v[216:219], a[140:143], v[104:107], v[216:219]
v_exp_f32 v54, v54
M v[216:219], a[144:147], v[136:139], v[216:219]
M v[220:223], a[144:147], v[140:143], v[220:223]
v_exp_f32 v55, v55
M v[220:223], a[140:143], v[108:111], v[220:223]
v_cvt_pk_bf16_f32 v39, v54, v55
s_waitcnt lgkmcnt(6)
M a[108:111], a[112:115], v[108:111], a[108:111]
M a[108:111], a[112:115], v[140:143], a[108:111]
M v[224:227], a[148:151], v[96:99], v[224:227]
v_exp_f32 v40, v40
M v[224:227], a[152:155], v[128:131], v[224:227]
M v[228:231], a[152:155], v[132:135], v[228:231]
v_exp_f32 v41, v41
M v[228:231], a[148:151], v[100:103], v[228:231]
v_cvt_pk_bf16_f32 v40, v40, v41
M v[232:235], a[148:151], v[104:107], v[232:235]
v_exp_f32 v42, v42
M v[232:235], a[152:155], v[136:139], v[232:235]
M v[236:239], a[152:155], v[140:143], v[236:239]
v_exp_f32 v43, v43
M v[236:239], a[148:151], v[108:111], v[236:239]
v_cvt_pk_bf16_f32 v41, v42, v43
s_waitcnt lgkmcnt(4)
M v[240:243], a[156:159], v[96:99], v[240:243]
v_exp_f32 v56, v56
M v[240:243], a[160:163], v[128:131], v[240:243]
M v[244:247], a[160:163], v[132:135], v[244:247]
v_exp_f32 v57, v57
M v[244:247], a[156:159], v[100:103], v[244:247]
v_cvt_pk_bf16_f32 v42, v56, v57
M v[248:251], a[156:159], v[104:107], v[248:251]
v_exp_f32 v58, v58
M v[248:251], a[160:163], v[136:139], v[248:251]
s_waitcnt vmcnt(0) lgkmcnt(0)
s_barrier
ds_read_b128 a[116:119], v2 offset:0
ds_read_b128 a[120:123], v2 offset:1024
M v[252:255], a[160:163], v[140:143], v[252:255]
v_exp_f32 v59, v59
M v[252:255], a[156:159], v[108:111], v[252:255]
v_cvt_pk_bf16_f32 v43, v58, v59
M a[64:67], a[164:167], v[96:99], a[64:67]
v_exp_f32 v44, v44
M a[64:67], a[168:171], v[128:131], a[64:67]
ds_read_b128 a[124:127], v2 offset:2048
ds_read_b128 a[128:131], v2 offset:3072
M a[68:71], a[168:171], v[132:135], a[68:71]
v_exp_f32 v45, v45
M a[68:71], a[164:167], v[100:103], a[68:71]
v_cvt_pk_bf16_f32 v44, v44, v45
M a[72:75], a[164:167], v[104:107], a[72:75]
v_exp_f32 v46, v46
M a[72:75], a[168:171], v[136:139], a[72:75]
ds_read_b128 a[132:135], v2 offset:4096
ds_read_b128 a[136:139], v2 offset:5120
M a[76:79], a[168:171], v[140:143], a[76:79]
v_exp_f32 v47, v47
M a[76:79], a[164:167], v[108:111], a[76:79]
v_cvt_pk_bf16_f32 v45, v46, v47
M a[80:83], a[172:175], v[96:99], a[80:83]
v_exp_f32 v60, v60
M a[80:83], a[176:179], v[128:131], a[80:83]
ds_read_b128 a[140:143], v2 offset:6144
ds_read_b128 a[144:147], v2 offset:7168
M a[84:87], a[176:179], v[132:135], a[84:87]
v_exp_f32 v61, v61
M a[84:87], a[172:175], v[100:103], a[84:87]
v_cvt_pk_bf16_f32 v46, v60, v61
M a[88:91], a[172:175], v[104:107], a[88:91]
v_exp_f32 v62, v62
M a[88:91], a[176:179], v[136:139], a[88:91]
M a[92:95], a[176:179], v[140:143], a[92:95]
v_exp_f32 v63, v63
M a[92:95], a[172:175], v[108:111], a[92:95]
v_cvt_pk_bf16_f32 v47, v62, v63
v_accvgpr_read_b32 v20, a96
v_accvgpr_read_b32 v21, a100
v_accvgpr_read_b32 v22, a104
v_accvgpr_read_b32 v23, a108
v_rcp_f32 v8, v20
v_rcp_f32 v9, v21
v_rcp_f32 v10, v22
v_rcp_f32 v11, v23
v_subrev_u32 v20, 0x21800000, v20
v_subrev_u32 v21, 0x21800000, v21
v_subrev_u32 v22, 0x21800000, v22
v_subrev_u32 v23, 0x21800000, v23
v_max_u32 v12, v20, v21
v_max3_u32 v12, v12, v22, v23
s_mov_b32 s64, 0x207
s_lshl_b32 s33, s21, 20
s_lshl_b32 s34, s20, 15
s_add_u32 s33, s33, s34
s_lshl_b32 s34, s23, 13
s_add_u32 s36, s33, s34
s_add_u32 s37, s36, 4096
s_add_u32 s38, s36, 16384
s_add_u32 s39, s36, 20480
v_pk_mul_f32 v[160:161], v[160:161], v[8:9] op_sel:[0,0] op_sel_hi:[1,0]
v_pk_mul_f32 v[162:163], v[162:163], v[8:9] op_sel:[0,0] op_sel_hi:[1,0]
v_pk_mul_f32 v[176:177], v[176:177], v[8:9] op_sel:[0,0] op_sel_hi:[1,0]
v_pk_mul_f32 v[178:179], v[178:179], v[8:9] op_sel:[0,0] op_sel_hi:[1,0]
v_cvt_pk_bf16_f32 v160, v160, v161
v_cvt_pk_bf16_f32 v161, v162, v163
v_cvt_pk_bf16_f32 v162, v176, v177
v_cvt_pk_bf16_f32 v163, v178, v179
s_nop 1
M v[24:27], a[112:115], v[160:163], 0
buffer_store_dwordx4 v[160:163], v1, s[16:19], s36 offen offset:0 sc1
v_pk_mul_f32 v[164:165], v[164:165], v[8:9] op_sel:[0,1] op_sel_hi:[1,1]
v_pk_mul_f32 v[166:167], v[166:167], v[8:9] op_sel:[0,1] op_sel_hi:[1,1]
v_pk_mul_f32 v[180:181], v[180:181], v[8:9] op_sel:[0,1] op_sel_hi:[1,1]
v_pk_mul_f32 v[182:183], v[182:183], v[8:9] op_sel:[0,1] op_sel_hi:[1,1]
v_cvt_pk_bf16_f32 v164, v164, v165
v_cvt_pk_bf16_f32 v165, v166, v167
v_cvt_pk_bf16_f32 v166, v180, v181
v_cvt_pk_bf16_f32 v167, v182, v183
s_nop 1
M v[24:27], a[112:115], v[164:167], v[24:27]
buffer_store_dwordx4 v[164:167], v1, s[16:19], s36 offen offset:2048 sc1
v_pk_mul_f32 v[168:169], v[168:169], v[10:11] op_sel:[0,0] op_sel_hi:[1,0]
v_pk_mul_f32 v[170:171], v[170:171], v[10:11] op_sel:[0,0] op_sel_hi:[1,0]
v_pk_mul_f32 v[184:185], v[184:185], v[10:11] op_sel:[0,0] op_sel_hi:[1,0]
v_pk_mul_f32 v[186:187], v[186:187], v[10:11] op_sel:[0,0] op_sel_hi:[1,0]
v_cvt_pk_bf16_f32 v168, v168, v169
v_cvt_pk_bf16_f32 v169, v170, v171
v_cvt_pk_bf16_f32 v170, v184, v185
v_cvt_pk_bf16_f32 v171, v186, v187
s_nop 1
M v[24:27], a[112:115], v[168:171], v[24:27]
buffer_store_dwordx4 v[168:171], v1, s[16:19], s37 offen offset:0 sc1
v_pk_mul_f32 v[172:173], v[172:173], v[10:11] op_sel:[0,1] op_sel_hi:[1,1]
v_pk_mul_f32 v[174:175], v[174:175], v[10:11] op_sel:[0,1] op_sel_hi:[1,1]
v_pk_mul_f32 v[188:189], v[188:189], v[10:11] op_sel:[0,1] op_sel_hi:[1,1]
v_pk_mul_f32 v[190:191], v[190:191], v[10:11] op_sel:[0,1] op_sel_hi:[1,1]
v_cvt_pk_bf16_f32 v172, v172, v173
v_cvt_pk_bf16_f32 v173, v174, v175
v_cvt_pk_bf16_f32 v174, v188, v189
v_cvt_pk_bf16_f32 v175, v190, v191
s_nop 1
M v[24:27], a[112:115], v[172:175], v[24:27]
buffer_store_dwordx4 v[172:175], v1, s[16:19], s37 offen offset:2048 sc1
v_pk_mul_f32 v[192:193], v[192:193], v[8:9] op_sel:[0,0] op_sel_hi:[1,0]
v_pk_mul_f32 v[194:195], v[194:195], v[8:9] op_sel:[0,0] op_sel_hi:[1,0]
v_pk_mul_f32 v[208:209], v[208:209], v[8:9] op_sel:[0,0] op_sel_hi:[1,0]
v_pk_mul_f32 v[210:211], v[210:211], v[8:9] op_sel:[0,0] op_sel_hi:[1,0]
v_cvt_pk_bf16_f32 v192, v192, v193
v_cvt_pk_bf16_f32 v193, v194, v195
v_cvt_pk_bf16_f32 v194, v208, v209
v_cvt_pk_bf16_f32 v195, v210, v211
s_nop 1
M v[24:27], a[112:115], v[192:195], v[24:27]
buffer_store_dwordx4 v[192:195], v1, s[16:19], s36 offen offset:1024 sc1
v_pk_mul_f32 v[196:197], v[196:197], v[8:9] op_sel:[0,1] op_sel_hi:[1,1]
v_pk_mul_f32 v[198:199], v[198:199], v[8:9] op_sel:[0,1] op_sel_hi:[1,1]
v_pk_mul_f32 v[212:213], v[212:213], v[8:9] op_sel:[0,1] op_sel_hi:[1,1]
v_pk_mul_f32 v[214:215], v[214:215], v[8:9] op_sel:[0,1] op_sel_hi:[1,1]
v_cvt_pk_bf16_f32 v196, v196, v197
v_cvt_pk_bf16_f32 v197, v198, v199
v_cvt_pk_bf16_f32 v198, v212, v213
v_cvt_pk_bf16_f32 v199, v214, v215
s_nop 1
M v[24:27], a[112:115], v[196:199], v[24:27]
buffer_store_dwordx4 v[196:199], v1, s[16:19], s36 offen offset:3072 sc1
v_pk_mul_f32 v[200:201], v[200:201], v[10:11] op_sel:[0,0] op_sel_hi:[1,0]
v_pk_mul_f32 v[202:203], v[202:203], v[10:11] op_sel:[0,0] op_sel_hi:[1,0]
v_pk_mul_f32 v[216:217], v[216:217], v[10:11] op_sel:[0,0] op_sel_hi:[1,0]
v_pk_mul_f32 v[218:219], v[218:219], v[10:11] op_sel:[0,0] op_sel_hi:[1,0]
v_cvt_pk_bf16_f32 v200, v200, v201
v_cvt_pk_bf16_f32 v201, v202, v203
v_cvt_pk_bf16_f32 v202, v216, v217
v_cvt_pk_bf16_f32 v203, v218, v219
s_nop 1
M v[24:27], a[112:115], v[200:203], v[24:27]
buffer_store_dwordx4 v[200:203], v1, s[16:19], s37 offen offset:1024 sc1
v_pk_mul_f32 v[204:205], v[204:205], v[10:11] op_sel:[0,1] op_sel_hi:[1,1]
v_pk_mul_f32 v[206:207], v[206:207], v[10:11] op_sel:[0,1] op_sel_hi:[1,1]
v_pk_mul_f32 v[220:221], v[220:221], v[10:11] op_sel:[0,1] op_sel_hi:[1,1]
v_pk_mul_f32 v[222:223], v[222:223], v[10:11] op_sel:[0,1] op_sel_hi:[1,1]
v_cvt_pk_bf16_f32 v204, v204, v205
v_cvt_pk_bf16_f32 v205, v206, v207
v_cvt_pk_bf16_f32 v206, v220, v221
v_cvt_pk_bf16_f32 v207, v222, v223
s_nop 1
M v[24:27], a[112:115], v[204:207], v[24:27]
buffer_store_dwordx4 v[204:207], v1, s[16:19], s37 offen offset:3072 sc1
v_pk_mul_f32 v[224:225], v[224:225], v[8:9] op_sel:[0,0] op_sel_hi:[1,0]
v_pk_mul_f32 v[226:227], v[226:227], v[8:9] op_sel:[0,0] op_sel_hi:[1,0]
v_pk_mul_f32 v[240:241], v[240:241], v[8:9] op_sel:[0,0] op_sel_hi:[1,0]
v_pk_mul_f32 v[242:243], v[242:243], v[8:9] op_sel:[0,0] op_sel_hi:[1,0]
v_cvt_pk_bf16_f32 v224, v224, v225
v_cvt_pk_bf16_f32 v225, v226, v227
v_cvt_pk_bf16_f32 v226, v240, v241
v_cvt_pk_bf16_f32 v227, v242, v243
s_nop 1
M v[24:27], a[112:115], v[224:227], v[24:27]
buffer_store_dwordx4 v[224:227], v1, s[16:19], s38 offen offset:0 sc1
v_pk_mul_f32 v[228:229], v[228:229], v[8:9] op_sel:[0,1] op_sel_hi:[1,1]
v_pk_mul_f32 v[230:231], v[230:231], v[8:9] op_sel:[0,1] op_sel_hi:[1,1]
v_pk_mul_f32 v[244:245], v[244:245], v[8:9] op_sel:[0,1] op_sel_hi:[1,1]
v_pk_mul_f32 v[246:247], v[246:247], v[8:9] op_sel:[0,1] op_sel_hi:[1,1]
v_cvt_pk_bf16_f32 v228, v228, v229
v_cvt_pk_bf16_f32 v229, v230, v231
v_cvt_pk_bf16_f32 v230, v244, v245
v_cvt_pk_bf16_f32 v231, v246, v247
s_nop 1
M v[24:27], a[112:115], v[228:231], v[24:27]
buffer_store_dwordx4 v[228:231], v1, s[16:19], s38 offen offset:2048 sc1
v_pk_mul_f32 v[232:233], v[232:233], v[10:11] op_sel:[0,0] op_sel_hi:[1,0]
v_pk_mul_f32 v[234:235], v[234:235], v[10:11] op_sel:[0,0] op_sel_hi:[1,0]
v_pk_mul_f32 v[248:249], v[248:249], v[10:11] op_sel:[0,0] op_sel_hi:[1,0]
v_pk_mul_f32 v[250:251], v[250:251], v[10:11] op_sel:[0,0] op_sel_hi:[1,0]
v_cvt_pk_bf16_f32 v232, v232, v233
v_cvt_pk_bf16_f32 v233, v234, v235
v_cvt_pk_bf16_f32 v234, v248, v249
v_cvt_pk_bf16_f32 v235, v250, v251
s_nop 1
M v[24:27], a[112:115], v[232:235], v[24:27]
buffer_store_dwordx4 v[232:235], v1, s[16:19], s39 offen offset:0 sc1
v_pk_mul_f32 v[236:237], v[236:237], v[10:11] op_sel:[0,1] op_sel_hi:[1,1]
v_pk_mul_f32 v[238:239], v[238:239], v[10:11] op_sel:[0,1] op_sel_hi:[1,1]
v_pk_mul_f32 v[252:253], v[252:253], v[10:11] op_sel:[0,1] op_sel_hi:[1,1]
v_pk_mul_f32 v[254:255], v[254:255], v[10:11] op_sel:[0,1] op_sel_hi:[1,1]
v_cvt_pk_bf16_f32 v236, v236, v237
v_cvt_pk_bf16_f32 v237, v238, v239
v_cvt_pk_bf16_f32 v238, v252, v253
v_cvt_pk_bf16_f32 v239, v254, v255
v_accvgpr_read_b32 v176, a64
v_accvgpr_read_b32 v177, a65
v_accvgpr_read_b32 v178, a66
v_accvgpr_read_b32 v179, a67
v_accvgpr_read_b32 v180, a80
v_accvgpr_read_b32 v181, a81
v_accvgpr_read_b32 v182, a82
v_accvgpr_read_b32 v183, a83
M v[24:27], a[112:115], v[236:239], v[24:27]
buffer_store_dwordx4 v[236:239], v1, s[16:19], s39 offen offset:2048 sc1
v_pk_mul_f32 v[176:177], v[176:177], v[8:9] op_sel:[0,0] op_sel_hi:[1,0]
v_pk_mul_f32 v[178:179], v[178:179], v[8:9] op_sel:[0,0] op_sel_hi:[1,0]
v_pk_mul_f32 v[180:181], v[180:181], v[8:9] op_sel:[0,0] op_sel_hi:[1,0]
v_pk_mul_f32 v[182:183], v[182:183], v[8:9] op_sel:[0,0] op_sel_hi:[1,0]
v_cvt_pk_bf16_f32 v176, v176, v177
v_cvt_pk_bf16_f32 v177, v178, v179
v_cvt_pk_bf16_f32 v178, v180, v181
v_cvt_pk_bf16_f32 v179, v182, v183
v_accvgpr_read_b32 v184, a68
v_accvgpr_read_b32 v185, a69
v_accvgpr_read_b32 v186, a70
v_accvgpr_read_b32 v187, a71
v_accvgpr_read_b32 v188, a84
v_accvgpr_read_b32 v189, a85
v_accvgpr_read_b32 v190, a86
v_accvgpr_read_b32 v191, a87
M v[24:27], a[112:115], v[176:179], v[24:27]
buffer_store_dwordx4 v[176:179], v1, s[16:19], s38 offen offset:1024 sc1
v_pk_mul_f32 v[184:185], v[184:185], v[8:9] op_sel:[0,1] op_sel_hi:[1,1]
v_pk_mul_f32 v[186:187], v[186:187], v[8:9] op_sel:[0,1] op_sel_hi:[1,1]
v_pk_mul_f32 v[188:189], v[188:189], v[8:9] op_sel:[0,1] op_sel_hi:[1,1]
v_pk_mul_f32 v[190:191], v[190:191], v[8:9] op_sel:[0,1] op_sel_hi:[1,1]
v_cvt_pk_bf16_f32 v184, v184, v185
v_cvt_pk_bf16_f32 v185, v186, v187
v_cvt_pk_bf16_f32 v186, v188, v189
v_cvt_pk_bf16_f32 v187, v190, v191
v_accvgpr_read_b32 v208, a72
v_accvgpr_read_b32 v209, a73
v_accvgpr_read_b32 v210, a74
v_accvgpr_read_b32 v211, a75
v_accvgpr_read_b32 v212, a88
v_accvgpr_read_b32 v213, a89
v_accvgpr_read_b32 v214, a90
v_accvgpr_read_b32 v215, a91
M v[24:27], a[112:115], v[184:187], v[24:27]
buffer_store_dwordx4 v[184:187], v1, s[16:19], s38 offen offset:3072 sc1
v_pk_mul_f32 v[208:209], v[208:209], v[10:11] op_sel:[0,0] op_sel_hi:[1,0]
v_pk_mul_f32 v[210:211], v[210:211], v[10:11] op_sel:[0,0] op_sel_hi:[1,0]
v_pk_mul_f32 v[212:213], v[212:213], v[10:11] op_sel:[0,0] op_sel_hi:[1,0]
v_pk_mul_f32 v[214:215], v[214:215], v[10:11] op_sel:[0,0] op_sel_hi:[1,0]
v_cvt_pk_bf16_f32 v208, v208, v209
v_cvt_pk_bf16_f32 v209, v210, v211
v_cvt_pk_bf16_f32 v210, v212, v213
v_cvt_pk_bf16_f32 v211, v214, v215
v_accvgpr_read_b32 v216, a76
v_accvgpr_read_b32 v217, a77
v_accvgpr_read_b32 v218, a78
v_accvgpr_read_b32 v219, a79
v_accvgpr_read_b32 v220, a92
v_accvgpr_read_b32 v221, a93
v_accvgpr_read_b32 v222, a94
v_accvgpr_read_b32 v223, a95
M v[24:27], a[112:115], v[208:211], v[24:27]
buffer_store_dwordx4 v[208:211], v1, s[16:19], s39 offen offset:1024 sc1
v_pk_mul_f32 v[216:217], v[216:217], v[10:11] op_sel:[0,1] op_sel_hi:[1,1]
v_pk_mul_f32 v[218:219], v[218:219], v[10:11] op_sel:[0,1] op_sel_hi:[1,1]
v_pk_mul_f32 v[220:221], v[220:221], v[10:11] op_sel:[0,1] op_sel_hi:[1,1]
v_pk_mul_f32 v[222:223], v[222:223], v[10:11] op_sel:[0,1] op_sel_hi:[1,1]
v_cvt_pk_bf16_f32 v216, v216, v217
v_cvt_pk_bf16_f32 v217, v218, v219
v_cvt_pk_bf16_f32 v218, v220, v221
v_cvt_pk_bf16_f32 v219, v222, v223
s_nop 1
M v[24:27], a[112:115], v[216:219], v[24:27]
buffer_store_dwordx4 v[216:219], v1, s[16:19], s39 offen offset:3072 sc1
v_cmp_lt_u32 vcc, 0x3c000000, v12
s_nop 5
v_cmp_class_f32 s[40:41], v24, s64
s_nop 0
s_or_b64 vcc, vcc, s[40:41]
s_cmp_lg_u64 vcc, 0
s_cselect_b32 s33, 1, 0
s_or_b32 s60, s60, s33
s_sub_u32 s30, 7, s21
s_cmp_lg_u32 s30, 0
s_cbranch_scc1 Lk2_b0
s_and_b32 s3, s2, 3
s_lshl_b32 s3, s3, 2
s_bfe_u32 s27, s2, 0x20003
s_add_u32 s27, s3, s27
s_lshl_b32 s43, s27, 8
s_add_u32 s43, s43, 8400896
v_lshlrev_b32 v15, 2, v0
buffer_load_dword v7, v15, s[52:55], s43 offen sc1
s_waitcnt lgkmcnt(7)
ds_read_b128 a[116:119], v2 offset:32768
s_waitcnt lgkmcnt(7)
ds_read_b128 a[120:123], v2 offset:40960
s_waitcnt lgkmcnt(7)
ds_read_b128 a[124:127], v2 offset:33792
s_waitcnt lgkmcnt(7)
ds_read_b128 a[128:131], v2 offset:41984
s_waitcnt lgkmcnt(7)
ds_read_b128 a[132:135], v2 offset:34816
s_waitcnt lgkmcnt(7)
ds_read_b128 a[136:139], v2 offset:43008
s_waitcnt lgkmcnt(7)
ds_read_b128 a[140:143], v2 offset:35840
s_waitcnt lgkmcnt(7)
ds_read_b128 a[144:147], v2 offset:44032
v_exp_f32 v64, v64
v_exp_f32 v65, v65
v_exp_f32 v66, v66
v_exp_f32 v67, v67
v_exp_f32 v80, v80
v_exp_f32 v81, v81
v_exp_f32 v82, v82
v_exp_f32 v83, v83
v_cvt_pk_bf16_f32 v64, v64, v65
v_cvt_pk_bf16_f32 v65, v66, v67
v_exp_f32 v68, v68
v_exp_f32 v69, v69
v_exp_f32 v70, v70
v_exp_f32 v71, v71
v_cvt_pk_bf16_f32 v66, v80, v81
v_cvt_pk_bf16_f32 v67, v82, v83
v_exp_f32 v84, v84
v_exp_f32 v85, v85
v_exp_f32 v86, v86
v_exp_f32 v87, v87
v_cvt_pk_bf16_f32 v68, v68, v69
v_cvt_pk_bf16_f32 v69, v70, v71
v_exp_f32 v72, v72
v_exp_f32 v73, v73
v_exp_f32 v74, v74
v_exp_f32 v75, v75
v_cvt_pk_bf16_f32 v70, v84, v85
v_cvt_pk_bf16_f32 v71, v86, v87
v_exp_f32 v88, v88
v_exp_f32 v89, v89
v_exp_f32 v90, v90
v_exp_f32 v91, v91
v_cvt_pk_bf16_f32 v72, v72, v73
v_cvt_pk_bf16_f32 v73, v74, v75
v_exp_f32 v76, v76
v_exp_f32 v77, v77
v_exp_f32 v78, v78
v_exp_f32 v79, v79
v_cvt_pk_bf16_f32 v74, v88, v89
v_cvt_pk_bf16_f32 v75, v90, v91
v_exp_f32 v92, v92
v_exp_f32 v93, v93
v_exp_f32 v94, v94
v_exp_f32 v95, v95
v_cvt_pk_bf16_f32 v76, v76, v77
v_cvt_pk_bf16_f32 v77, v78, v79
v_cvt_pk_bf16_f32 v78, v92, v93
v_cvt_pk_bf16_f32 v79, v94, v95
s_waitcnt lgkmcnt(6)
M v[160:163], a[116:119], v[32:35], 0
M v[160:163], a[120:123], v[64:67], v[160:163]
ds_read_b128 a[148:151], v2 offset:36864
ds_read_b128 a[152:155], v2 offset:45056
s_mov_b32 s61, 0
M v[164:167], a[120:123], v[68:71], 0
M v[164:167], a[116:119], v[36:39], v[164:167]
s_bfe_u32 s3, s2, 0x10002
M v[168:171], a[116:119], v[40:43], 0
M v[168:171], a[120:123], v[72:75], v[168:171]
s_lshl_b32 s3, s3, 3
M v[172:175], a[120:123], v[76:79], 0
M v[172:175], a[116:119], v[44:47], v[172:175]
s_waitcnt lgkmcnt(6)
s_lshr_b32 s28, s2, 5
M a[96:99], a[112:115], v[32:35], 0
M a[96:99], a[112:115], v[64:67], a[96:99]
M v[176:179], a[124:127], v[32:35], 0
M v[176:179], a[128:131], v[64:67], v[176:179]
ds_read_b128 a[156:159], v2 offset:37888
ds_read_b128 a[160:163], v2 offset:46080
s_add_u32 s28, s3, s28
M v[180:183], a[128:131], v[68:71], 0
s_lshl_b32 s25, s27, 18
M v[180:183], a[124:127], v[36:39], v[180:183]
M v[184:187], a[124:127], v[40:43], 0
s_lshl_b32 s3, s101, 12
M v[184:187], a[128:131], v[72:75], v[184:187]
M v[188:191], a[128:131], v[76:79], 0
s_add_u32 s25, s25, s3
M v[188:191], a[124:127], v[44:47], v[188:191]
s_waitcnt lgkmcnt(6)
M a[100:103], a[112:115], v[36:39], 0
M a[100:103], a[112:115], v[68:71], a[100:103]
M v[192:195], a[132:135], v[32:35], 0
s_lshl_b32 s26, s28, 7
M v[192:195], a[136:139], v[64:67], v[192:195]
ds_read_b128 a[164:167], v2 offset:38912
ds_read_b128 a[168:171], v2 offset:47104
M v[196:199], a[136:139], v[68:71], 0
s_lshl_b32 s42, s101, 11
M v[196:199], a[132:135], v[36:39], v[196:199]
M v[200:203], a[132:135], v[40:43], 0
s_add_u32 s44, s4, 83886080
s_addc_u32 s45, s5, 0
M v[200:203], a[136:139], v[72:75], v[200:203]
s_mov_b32 s46, 4194304
M v[204:207], a[136:139], v[76:79], 0
M v[204:207], a[132:135], v[44:47], v[204:207]
s_waitcnt lgkmcnt(6)
s_mov_b32 s47, 0x00020000
M a[104:107], a[112:115], v[40:43], 0
M a[104:107], a[112:115], v[72:75], a[104:107]
M v[208:211], a[140:143], v[32:35], 0
M v[208:211], a[144:147], v[64:67], v[208:211]
ds_read_b128 a[172:175], v2 offset:39936
ds_read_b128 a[176:179], v2 offset:48128
s_mov_b32 s50, 2097152
M v[212:215], a[144:147], v[68:71], 0
M v[212:215], a[140:143], v[36:39], v[212:215]
s_mov_b32 s51, 0x00020000
M v[216:219], a[140:143], v[40:43], 0
M v[216:219], a[144:147], v[72:75], v[216:219]
s_lshl_b32 s3, s101, 4
M v[220:223], a[144:147], v[76:79], 0
M v[220:223], a[140:143], v[44:47], v[220:223]
s_waitcnt lgkmcnt(6)
v_lshrrev_b32 v96, 3, v0
M a[108:111], a[112:115], v[44:47], 0
M a[108:111], a[112:115], v[76:79], a[108:111]
M v[224:227], a[148:151], v[32:35], 0
v_and_b32 v97, 6, v96
M v[224:227], a[152:155], v[64:67], v[224:227]
M v[228:231], a[152:155], v[68:71], 0
v_and_b32 v98, 7, v0
M v[228:231], a[148:151], v[36:39], v[228:231]
M v[232:235], a[148:151], v[40:43], 0
v_xor_b32 v97, v97, v98
M v[232:235], a[152:155], v[72:75], v[232:235]
M v[236:239], a[152:155], v[76:79], 0
v_add_u32 v96, s3, v96
M v[236:239], a[148:151], v[44:47], v[236:239]
s_waitcnt lgkmcnt(4)
M v[240:243], a[156:159], v[32:35], 0
v_lshlrev_b32 v96, 11, v96
M v[240:243], a[160:163], v[64:67], v[240:243]
M v[244:247], a[160:163], v[68:71], 0
v_lshl_add_u32 v99, v97, 4, v96
M v[244:247], a[156:159], v[36:39], v[244:247]
v_add_u32 v100, 15360, v99
M v[248:251], a[156:159], v[40:43], 0
M v[248:251], a[160:163], v[72:75], v[248:251]
s_waitcnt vmcnt(0) lgkmcnt(0)
s_barrier
v_cmp_ne_u32 vcc, 1, v7
s_nop 0
s_cbranch_vccnz Lk3_spinb1
Lk3_gotb1:
M v[252:255], a[160:163], v[76:79], 0
s_add_u32 m0, s42, 65536
s_nop 0
buffer_load_dwordx4 v99, s[48:51], s26 offen offset:0 lds
buffer_load_dwordx4 v100, s[48:51], s26 offen offset:1024 lds
M v[252:255], a[156:159], v[44:47], v[252:255]
buffer_load_dwordx4 a[192:195], v1, s[44:47], s25 offen offset:0 sc1
buffer_load_dwordx4 a[196:199], v1, s[44:47], s25 offen offset:1024 sc1
M a[64:67], a[164:167], v[32:35], 0
buffer_load_dwordx4 a[200:203], v1, s[44:47], s25 offen offset:2048 sc1
buffer_load_dwordx4 a[204:207], v1, s[44:47], s25 offen offset:3072 sc1
M a[64:67], a[168:171], v[64:67], a[64:67]
s_add_u32 s25, s25, 16384
s_add_u32 s26, s26, 131072
s_add_u32 m0, s42, 81920
s_nop 0
buffer_load_dwordx4 v99, s[48:51], s26 offen offset:0 lds
M a[68:71], a[168:171], v[68:71], 0
buffer_load_dwordx4 v100, s[48:51], s26 offen offset:1024 lds
buffer_load_dwordx4 a[208:211], v1, s[44:47], s25 offen offset:0 sc1
M a[68:71], a[164:167], v[36:39], a[68:71]
buffer_load_dwordx4 a[212:215], v1, s[44:47], s25 offen offset:1024 sc1
buffer_load_dwordx4 a[216:219], v1, s[44:47], s25 offen offset:2048 sc1
M a[72:75], a[164:167], v[40:43], 0
buffer_load_dwordx4 a[220:223], v1, s[44:47], s25 offen offset:3072 sc1
s_add_u32 s25, s25, 16384
s_add_u32 s26, s26, 131072
M a[72:75], a[168:171], v[72:75], a[72:75]
s_add_u32 m0, s42, 98304
s_nop 0
buffer_load_dwordx4 v99, s[48:51], s26 offen offset:0 lds
buffer_load_dwordx4 v100, s[48:51], s26 offen offset:1024 lds
M a[76:79], a[168:171], v[76:79], 0
buffer_load_dwordx4 a[224:227], v1, s[44:47], s25 offen offset:0 sc1
M a[76:79], a[164:167], v[44:47], a[76:79]
buffer_load_dwordx4 a[228:231], v1, s[44:47], s25 offen offset:1024 sc1
buffer_load_dwordx4 a[232:235], v1, s[44:47], s25 offen offset:2048 sc1
M a[80:83], a[172:175], v[32:35], 0
buffer_load_dwordx4 a[236:239], v1, s[44:47], s25 offen offset:3072 sc1
s_add_u32 s25, s25, 16384
s_add_u32 s26, s26, 131072
M a[80:83], a[176:179], v[64:67], a[80:83]
s_add_u32 m0, s42, 114688
s_nop 0
buffer_load_dwordx4 v99, s[48:51], s26 offen offset:0 lds
buffer_load_dwordx4 v100, s[48:51], s26 offen offset:1024 lds
M a[84:87], a[176:179], v[68:71], 0
buffer_load_dwordx4 a[240:243], v1, s[44:47], s25 offen offset:0 sc1
buffer_load_dwordx4 a[244:247], v1, s[44:47], s25 offen offset:1024 sc1
M a[84:87], a[172:175], v[36:39], a[84:87]
buffer_load_dwordx4 a[248:251], v1, s[44:47], s25 offen offset:2048 sc1
buffer_load_dwordx4 a[252:255], v1, s[44:47], s25 offen offset:3072 sc1
M a[88:91], a[172:175], v[40:43], 0
s_add_u32 s25, s25, 16384
s_add_u32 s26, s26, 131072
s_add_u32 m0, s42, 0
s_nop 0
buffer_load_dwordx4 v99, s[48:51], s26 offen offset:0 lds
M a[88:91], a[176:179], v[72:75], a[88:91]
buffer_load_dwordx4 v100, s[48:51], s26 offen offset:1024 lds
buffer_load_dwordx4 a[128:131], v1, s[44:47], s25 offen offset:0 sc1
M a[92:95], a[176:179], v[76:79], 0
buffer_load_dwordx4 a[132:135], v1, s[44:47], s25 offen offset:1024 sc1
buffer_load_dwordx4 a[136:139], v1, s[44:47], s25 offen offset:2048 sc1
M a[92:95], a[172:175], v[44:47], a[92:95]
buffer_load_dwordx4 a[140:143], v1, s[44:47], s25 offen offset:3072 sc1
s_add_u32 s25, s25, 16384
s_add_u32 s26, s26, 131072
s_branch Lk2_merge
Lk2_b0:
s_add_u32 m0, s29, 65536
s_waitcnt lgkmcnt(4)
M v[96:99], a[116:119], a[180:183], 0
v_exp_f32 v64, v64
M v[96:99], a[120:123], a[184:187], v[96:99]
ds_read_b128 a[148:151], v2 offset:8192
ds_read_b128 a[152:155], v2 offset:9216
M v[96:99], a[124:127], a[188:191], v[96:99]
v_exp_f32 v65, v65
M v[96:99], a[128:131], a[192:195], v[96:99]
buffer_load_dwordx4 v1, s[12:15], s25 offen offset:0 sc1 lds
s_add_u32 s32, s25, 4096
M v[100:103], a[128:131], a[208:211], 0
v_exp_f32 v66, v66
M v[100:103], a[124:127], a[204:207], v[100:103]
v_cvt_pk_bf16_f32 v64, v64, v65
M v[100:103], a[120:123], a[200:203], v[100:103]
v_exp_f32 v67, v67
M v[100:103], a[116:119], a[196:199], v[100:103]
buffer_load_dwordx4 v1, s[12:15], s25 offen offset:1024 sc1 lds
M v[104:107], a[116:119], a[212:215], 0
v_exp_f32 v80, v80
M v[104:107], a[120:123], a[216:219], v[104:107]
ds_read_b128 a[156:159], v2 offset:10240
ds_read_b128 a[160:163], v2 offset:11264
M v[104:107], a[124:127], a[220:223], v[104:107]
v_exp_f32 v81, v81
M v[104:107], a[128:131], a[224:227], v[104:107]
buffer_load_dwordx4 v1, s[12:15], s25 offen offset:2048 sc1 lds
M v[108:111], a[128:131], a[240:243], 0
v_exp_f32 v82, v82
M v[108:111], a[124:127], a[236:239], v[108:111]
v_cvt_pk_bf16_f32 v65, v66, v67
v_cvt_pk_bf16_f32 v66, v80, v81
M v[108:111], a[120:123], a[232:235], v[108:111]
v_exp_f32 v83, v83
M v[108:111], a[116:119], a[228:231], v[108:111]
buffer_load_dwordx4 v1, s[12:15], s25 offen offset:3072 sc1 lds
s_add_u32 m0, s29, 69632
s_waitcnt lgkmcnt(4)
M v[112:115], a[132:135], a[180:183], 0
v_exp_f32 v68, v68
M v[112:115], a[136:139], a[184:187], v[112:115]
ds_read_b128 a[164:167], v2 offset:12288
ds_read_b128 a[168:171], v2 offset:13312
M v[112:115], a[140:143], a[188:191], v[112:115]
v_exp_f32 v69, v69
M v[112:115], a[144:147], a[192:195], v[112:115]
buffer_load_dwordx4 v1, s[12:15], s32 offen offset:0 sc1 lds
M v[116:119], a[144:147], a[208:211], 0
v_exp_f32 v70, v70
M v[116:119], a[140:143], a[204:207], v[116:119]
v_cvt_pk_bf16_f32 v67, v82, v83
v_cvt_pk_bf16_f32 v68, v68, v69
M v[116:119], a[136:139], a[200:203], v[116:119]
v_exp_f32 v71, v71
M v[116:119], a[132:135], a[196:199], v[116:119]
buffer_load_dwordx4 v1, s[12:15], s32 offen offset:1024 sc1 lds
M v[120:123], a[132:135], a[212:215], 0
v_exp_f32 v84, v84
M v[120:123], a[136:139], a[216:219], v[120:123]
ds_read_b128 a[172:175], v2 offset:14336
ds_read_b128 a[176:179], v2 offset:15360
M v[120:123], a[140:143], a[220:223], v[120:123]
v_exp_f32 v85, v85
M v[120:123], a[144:147], a[224:227], v[120:123]
buffer_load_dwordx4 v1, s[12:15], s32 offen offset:2048 sc1 lds
M v[124:127], a[144:147], a[240:243], 0
v_exp_f32 v86, v86
M v[124:127], a[140:143], a[236:239], v[124:127]
v_cvt_pk_bf16_f32 v69, v70, v71
v_cvt_pk_bf16_f32 v70, v84, v85
M v[124:127], a[136:139], a[232:235], v[124:127]
v_exp_f32 v87, v87
M v[124:127], a[132:135], a[228:231], v[124:127]
buffer_load_dwordx4 v1, s[12:15], s32 offen offset:3072 sc1 lds
s_add_u32 m0, s29, 98304
s_waitcnt lgkmcnt(4)
M v[128:131], a[148:151], a[180:183], 0
v_exp_f32 v72, v72
M v[128:131], a[152:155], a[184:187], v[128:131]
ds_read_b128 a[116:119], v2 offset:32768
ds_read_b128 a[120:123], v2 offset:40960
M v[128:131], a[156:159], a[188:191], v[128:131]
v_exp_f32 v73, v73
M v[128:131], a[160:163], a[192:195], v[128:131]
buffer_load_dwordx4 v1, s[12:15], s26 offen offset:0 sc1 lds
s_add_u32 s43, s26, 4096
M v[132:135], a[160:163], a[208:211], 0
v_exp_f32 v74, v74
M v[132:135], a[156:159], a[204:207], v[132:135]
v_cvt_pk_bf16_f32 v71, v86, v87
v_cvt_pk_bf16_f32 v72, v72, v73
M v[132:135], a[152:155], a[200:203], v[132:135]
v_exp_f32 v75, v75
M v[132:135], a[148:151], a[196:199], v[132:135]
buffer_load_dwordx4 v1, s[12:15], s26 offen offset:1024 sc1 lds
M v[136:139], a[148:151], a[212:215], 0
v_exp_f32 v88, v88
M v[136:139], a[152:155], a[216:219], v[136:139]
ds_read_b128 a[124:127], v2 offset:33792
ds_read_b128 a[128:131], v2 offset:41984
M v[136:139], a[156:159], a[220:223], v[136:139]
v_exp_f32 v89, v89
M v[136:139], a[160:163], a[224:227], v[136:139]
buffer_load_dwordx4 v1, s[12:15], s26 offen offset:2048 sc1 lds
M v[140:143], a[160:163], a[240:243], 0
v_exp_f32 v90, v90
M v[140:143], a[156:159], a[236:239], v[140:143]
v_cvt_pk_bf16_f32 v73, v74, v75
v_cvt_pk_bf16_f32 v74, v88, v89
M v[140:143], a[152:155], a[232:235], v[140:143]
v_exp_f32 v91, v91
M v[140:143], a[148:151], a[228:231], v[140:143]
buffer_load_dwordx4 v1, s[12:15], s26 offen offset:3072 sc1 lds
s_add_u32 m0, s29, 102400
s_waitcnt lgkmcnt(4)
M v[144:147], a[164:167], a[180:183], 0
v_exp_f32 v76, v76
M v[144:147], a[168:171], a[184:187], v[144:147]
ds_read_b128 a[132:135], v2 offset:34816
ds_read_b128 a[136:139], v2 offset:43008
M v[144:147], a[172:175], a[188:191], v[144:147]
v_exp_f32 v77, v77
M v[144:147], a[176:179], a[192:195], v[144:147]
buffer_load_dwordx4 v1, s[12:15], s43 offen offset:0 sc1 lds
M v[148:151], a[176:179], a[208:211], 0
v_exp_f32 v78, v78
M v[148:151], a[172:175], a[204:207], v[148:151]
v_cvt_pk_bf16_f32 v75, v90, v91
v_cvt_pk_bf16_f32 v76, v76, v77
M v[148:151], a[168:171], a[200:203], v[148:151]
v_exp_f32 v79, v79
M v[148:151], a[164:167], a[196:199], v[148:151]
buffer_load_dwordx4 v1, s[12:15], s43 offen offset:1024 sc1 lds
M v[152:155], a[164:167], a[212:215], 0
v_exp_f32 v92, v92
M v[152:155], a[168:171], a[216:219], v[152:155]
ds_read_b128 a[140:143], v2 offset:35840
ds_read_b128 a[144:147], v2 offset:44032
M v[152:155], a[172:175], a[220:223], v[152:155]
v_exp_f32 v93, v93
M v[152:155], a[176:179], a[224:227], v[152:155]
buffer_load_dwordx4 v1, s[12:15], s43 offen offset:2048 sc1 lds
M v[156:159], a[176:179], a[240:243], 0
v_exp_f32 v94, v94
M v[156:159], a[172:175], a[236:239], v[156:159]
v_cvt_pk_bf16_f32 v77, v78, v79
v_cvt_pk_bf16_f32 v78, v92, v93
M v[156:159], a[168:171], a[232:235], v[156:159]
v_exp_f32 v95, v95
M v[156:159], a[164:167], a[228:231], v[156:159]
buffer_load_dwordx4 v1, s[12:15], s43 offen offset:3072 sc1 lds
v_cvt_pk_bf16_f32 v79, v94, v95
s_waitcnt lgkmcnt(6)
M v[160:163], a[116:119], v[32:35], 0
v_exp_f32 v96, v96
M v[160:163], a[120:123], v[64:67], v[160:163]
ds_read_b128 a[148:151], v2 offset:36864
ds_read_b128 a[152:155], v2 offset:45056
M v[164:167], a[120:123], v[68:71], 0
v_exp_f32 v97, v97
M v[164:167], a[116:119], v[36:39], v[164:167]
v_cvt_pk_bf16_f32 v96, v96, v97
M v[168:171], a[116:119], v[40:43], 0
v_exp_f32 v98, v98
M v[168:171], a[120:123], v[72:75], v[168:171]
s_add_u32 s25, s25, 32768
s_cmp_eq_u32 s25, s27
M v[172:175], a[120:123], v[76:79], 0
v_exp_f32 v99, v99
M v[172:175], a[116:119], v[44:47], v[172:175]
v_cvt_pk_bf16_f32 v97, v98, v99
s_waitcnt lgkmcnt(6)
M a[96:99], a[112:115], v[32:35], 0
s_cselect_b32 s25, s28, s25
s_cselect_b32 s27, -1, s27
M a[96:99], a[112:115], v[64:67], a[96:99]
s_add_u32 s26, s26, 32768
s_cmp_eq_u32 s26, s62
M v[176:179], a[124:127], v[32:35], 0
v_exp_f32 v112, v112
M v[176:179], a[128:131], v[64:67], v[176:179]
ds_read_b128 a[156:159], v2 offset:37888
ds_read_b128 a[160:163], v2 offset:46080
M v[180:183], a[128:131], v[68:71], 0
v_exp_f32 v113, v113
M v[180:183], a[124:127], v[36:39], v[180:183]
v_cvt_pk_bf16_f32 v98, v112, v113
M v[184:187], a[124:127], v[40:43], 0
v_exp_f32 v114, v114
M v[184:187], a[128:131], v[72:75], v[184:187]
s_cselect_b32 s26, s63, s26
s_cselect_b32 s62, -1, s62
M v[188:191], a[128:131], v[76:79], 0
v_exp_f32 v115, v115
M v[188:191], a[124:127], v[44:47], v[188:191]
v_cvt_pk_bf16_f32 v99, v114, v115
s_waitcnt lgkmcnt(6)
M a[100:103], a[112:115], v[36:39], 0
M a[100:103], a[112:115], v[68:71], a[100:103]
M v[192:195], a[132:135], v[32:35], 0
v_exp_f32 v100, v100
M v[192:195], a[136:139], v[64:67], v[192:195]
ds_read_b128 a[164:167], v2 offset:38912
ds_read_b128 a[168:171], v2 offset:47104
M v[196:199], a[136:139], v[68:71], 0
v_exp_f32 v101, v101
M v[196:199], a[132:135], v[36:39], v[196:199]
v_cvt_pk_bf16_f32 v100, v100, v101
M v[200:203], a[132:135], v[40:43], 0
v_exp_f32 v102, v102
M v[200:203], a[136:139], v[72:75], v[200:203]
M v[204:207], a[136:139], v[76:79], 0
v_exp_f32 v103, v103
M v[204:207], a[132:135], v[44:47], v[204:207]
v_cvt_pk_bf16_f32 v101, v102, v103
s_waitcnt lgkmcnt(6)
M a[104:107], a[112:115], v[40:43], 0
M a[104:107], a[112:115], v[72:75], a[104:107]
M v[208:211], a[140:143], v[32:35], 0
v_exp_f32 v116, v116
M v[208:211], a[144:147], v[64:67], v[208:211]
ds_read_b128 a[172:175], v2 offset:39936
ds_read_b128 a[176:179], v2 offset:48128
M v[212:215], a[144:147], v[68:71], 0
v_exp_f32 v117, v117
M v[212:215], a[140:143], v[36:39], v[212:215]
v_cvt_pk_bf16_f32 v102, v116, v117
M v[216:219], a[140:143], v[40:43], 0
v_exp_f32 v118, v118
M v[216:219], a[144:147], v[72:75], v[216:219]
M v[220:223], a[144:147], v[76:79], 0
v_exp_f32 v119, v119
M v[220:223], a[140:143], v[44:47], v[220:223]
v_cvt_pk_bf16_f32 v103, v118, v119
s_waitcnt lgkmcnt(6)
M a[108:111], a[112:115], v[44:47], 0
M a[108:111], a[112:115], v[76:79], a[108:111]
M v[224:227], a[148:151], v[32:35], 0
v_exp_f32 v104, v104
M v[224:227], a[152:155], v[64:67], v[224:227]
M v[228:231], a[152:155], v[68:71], 0
v_exp_f32 v105, v105
M v[228:231], a[148:151], v[36:39], v[228:231]
v_cvt_pk_bf16_f32 v104, v104, v105
M v[232:235], a[148:151], v[40:43], 0
v_exp_f32 v106, v106
M v[232:235], a[152:155], v[72:75], v[232:235]
M v[236:239], a[152:155], v[76:79], 0
v_exp_f32 v107, v107
M v[236:239], a[148:151], v[44:47], v[236:239]
v_cvt_pk_bf16_f32 v105, v106, v107
s_waitcnt lgkmcnt(4)
M v[240:243], a[156:159], v[32:35], 0
v_exp_f32 v120, v120
M v[240:243], a[160:163], v[64:67], v[240:243]
M v[244:247], a[160:163], v[68:71], 0
v_exp_f32 v121, v121
M v[244:247], a[156:159], v[36:39], v[244:247]
v_cvt_pk_bf16_f32 v106, v120, v121
M v[248:251], a[156:159], v[40:43], 0
v_exp_f32 v122, v122
M v[248:251], a[160:163], v[72:75], v[248:251]
s_waitcnt vmcnt(0) lgkmcnt(0)
s_barrier
ds_read_b128 a[116:119], v3 offset:0
ds_read_b128 a[120:123], v3 offset:1024
M v[252:255], a[160:163], v[76:79], 0
v_exp_f32 v123, v123
M v[252:255], a[156:159], v[44:47], v[252:255]
v_cvt_pk_bf16_f32 v107, v122, v123
M a[64:67], a[164:167], v[32:35], 0
v_exp_f32 v108, v108
M a[64:67], a[168:171], v[64:67], a[64:67]
ds_read_b128 a[124:127], v3 offset:2048
ds_read_b128 a[128:131], v3 offset:3072
M a[68:71], a[168:171], v[68:71], 0
v_exp_f32 v109, v109
M a[68:71], a[164:167], v[36:39], a[68:71]
v_cvt_pk_bf16_f32 v108, v108, v109
M a[72:75], a[164:167], v[40:43], 0
v_exp_f32 v110, v110
M a[72:75], a[168:171], v[72:75], a[72:75]
ds_read_b128 a[132:135], v3 offset:4096
ds_read_b128 a[136:139], v3 offset:5120
M a[76:79], a[168:171], v[76:79], 0
v_exp_f32 v111, v111
M a[76:79], a[164:167], v[44:47], a[76:79]
v_cvt_pk_bf16_f32 v109, v110, v111
M a[80:83], a[172:175], v[32:35], 0
v_exp_f32 v124, v124
M a[80:83], a[176:179], v[64:67], a[80:83]
ds_read_b128 a[140:143], v3 offset:6144
ds_read_b128 a[144:147], v3 offset:7168
M a[84:87], a[176:179], v[68:71], 0
v_exp_f32 v125, v125
M a[84:87], a[172:175], v[36:39], a[84:87]
v_cvt_pk_bf16_f32 v110, v124, v125
M a[88:91], a[172:175], v[40:43], 0
v_exp_f32 v126, v126
M a[88:91], a[176:179], v[72:75], a[88:91]
M a[92:95], a[176:179], v[76:79], 0
v_exp_f32 v127, v127
M a[92:95], a[172:175], v[44:47], a[92:95]
v_cvt_pk_bf16_f32 v111, v126, v127
s_branch Lk2_l2b
Lk2_l2:
s_add_u32 m0, s29, 65536
s_waitcnt lgkmcnt(4)
M v[96:99], a[116:119], a[180:183], 0
v_exp_f32 v64, v64
M v[96:99], a[120:123], a[184:187], v[96:99]
ds_read_b128 a[148:151], v2 offset:8192
ds_read_b128 a[152:155], v2 offset:9216
M v[96:99], a[124:127], a[188:191], v[96:99]
v_exp_f32 v65, v65
M v[96:99], a[128:131], a[192:195], v[96:99]
buffer_load_dwordx4 v1, s[12:15], s25 offen offset:0 sc1 lds
s_add_u32 s32, s25, 4096
M v[100:103], a[128:131], a[208:211], 0
v_exp_f32 v66, v66
M v[100:103], a[124:127], a[204:207], v[100:103]
v_cvt_pk_bf16_f32 v64, v64, v65
M v[100:103], a[120:123], a[200:203], v[100:103]
v_exp_f32 v67, v67
M v[100:103], a[116:119], a[196:199], v[100:103]
buffer_load_dwordx4 v1, s[12:15], s25 offen offset:1024 sc1 lds
M v[104:107], a[116:119], a[212:215], 0
v_exp_f32 v80, v80
M v[104:107], a[120:123], a[216:219], v[104:107]
ds_read_b128 a[156:159], v2 offset:10240
ds_read_b128 a[160:163], v2 offset:11264
M v[104:107], a[124:127], a[220:223], v[104:107]
v_exp_f32 v81, v81
M v[104:107], a[128:131], a[224:227], v[104:107]
buffer_load_dwordx4 v1, s[12:15], s25 offen offset:2048 sc1 lds
M v[108:111], a[128:131], a[240:243], 0
v_exp_f32 v82, v82
M v[108:111], a[124:127], a[236:239], v[108:111]
v_cvt_pk_bf16_f32 v65, v66, v67
v_cvt_pk_bf16_f32 v66, v80, v81
M v[108:111], a[120:123], a[232:235], v[108:111]
v_exp_f32 v83, v83
M v[108:111], a[116:119], a[228:231], v[108:111]
buffer_load_dwordx4 v1, s[12:15], s25 offen offset:3072 sc1 lds
s_add_u32 m0, s29, 69632
s_waitcnt lgkmcnt(4)
M v[112:115], a[132:135], a[180:183], 0
v_exp_f32 v68, v68
M v[112:115], a[136:139], a[184:187], v[112:115]
ds_read_b128 a[164:167], v2 offset:12288
ds_read_b128 a[168:171], v2 offset:13312
M v[112:115], a[140:143], a[188:191], v[112:115]
v_exp_f32 v69, v69
M v[112:115], a[144:147], a[192:195], v[112:115]
buffer_load_dwordx4 v1, s[12:15], s32 offen offset:0 sc1 lds
M v[116:119], a[144:147], a[208:211], 0
v_exp_f32 v70, v70
M v[116:119], a[140:143], a[204:207], v[116:119]
v_cvt_pk_bf16_f32 v67, v82, v83
v_cvt_pk_bf16_f32 v68, v68, v69
M v[116:119], a[136:139], a[200:203], v[116:119]
v_exp_f32 v71, v71
M v[116:119], a[132:135], a[196:199], v[116:119]
buffer_load_dwordx4 v1, s[12:15], s32 offen offset:1024 sc1 lds
M v[120:123], a[132:135], a[212:215], 0
v_exp_f32 v84, v84
M v[120:123], a[136:139], a[216:219], v[120:123]
ds_read_b128 a[172:175], v2 offset:14336
ds_read_b128 a[176:179], v2 offset:15360
M v[120:123], a[140:143], a[220:223], v[120:123]
v_exp_f32 v85, v85
M v[120:123], a[144:147], a[224:227], v[120:123]
buffer_load_dwordx4 v1, s[12:15], s32 offen offset:2048 sc1 lds
M v[124:127], a[144:147], a[240:243], 0
v_exp_f32 v86, v86
M v[124:127], a[140:143], a[236:239], v[124:127]
v_cvt_pk_bf16_f32 v69, v70, v71
v_cvt_pk_bf16_f32 v70, v84, v85
M v[124:127], a[136:139], a[232:235], v[124:127]
v_exp_f32 v87, v87
M v[124:127], a[132:135], a[228:231], v[124:127]
buffer_load_dwordx4 v1, s[12:15], s32 offen offset:3072 sc1 lds
s_add_u32 m0, s29, 98304
s_waitcnt lgkmcnt(4)
M v[128:131], a[148:151], a[180:183], 0
v_exp_f32 v72, v72
M v[128:131], a[152:155], a[184:187], v[128:131]
ds_read_b128 a[116:119], v2 offset:32768
ds_read_b128 a[120:123], v2 offset:40960
M v[128:131], a[156:159], a[188:191], v[128:131]
v_exp_f32 v73, v73
M v[128:131], a[160:163], a[192:195], v[128:131]
buffer_load_dwordx4 v1, s[12:15], s26 offen offset:0 sc1 lds
s_add_u32 s43, s26, 4096
M v[132:135], a[160:163], a[208:211], 0
v_exp_f32 v74, v74
M v[132:135], a[156:159], a[204:207], v[132:135]
v_cvt_pk_bf16_f32 v71, v86, v87
v_cvt_pk_bf16_f32 v72, v72, v73
M v[132:135], a[152:155], a[200:203], v[132:135]
v_exp_f32 v75, v75
M v[132:135], a[148:151], a[196:199], v[132:135]
buffer_load_dwordx4 v1, s[12:15], s26 offen offset:1024 sc1 lds
M v[136:139], a[148:151], a[212:215], 0
v_exp_f32 v88, v88
M v[136:139], a[152:155], a[216:219], v[136:139]
ds_read_b128 a[124:127], v2 offset:33792
ds_read_b128 a[128:131], v2 offset:41984
M v[136:139], a[156:159], a[220:223], v[136:139]
v_exp_f32 v89, v89
M v[136:139], a[160:163], a[224:227], v[136:139]
buffer_load_dwordx4 v1, s[12:15], s26 offen offset:2048 sc1 lds
M v[140:143], a[160:163], a[240:243], 0
v_exp_f32 v90, v90
M v[140:143], a[156:159], a[236:239], v[140:143]
v_cvt_pk_bf16_f32 v73, v74, v75
v_cvt_pk_bf16_f32 v74, v88, v89
M v[140:143], a[152:155], a[232:235], v[140:143]
v_exp_f32 v91, v91
M v[140:143], a[148:151], a[228:231], v[140:143]
buffer_load_dwordx4 v1, s[12:15], s26 offen offset:3072 sc1 lds
s_add_u32 m0, s29, 102400
s_waitcnt lgkmcnt(4)
M v[144:147], a[164:167], a[180:183], 0
v_exp_f32 v76, v76
M v[144:147], a[168:171], a[184:187], v[144:147]
ds_read_b128 a[132:135], v2 offset:34816
ds_read_b128 a[136:139], v2 offset:43008
M v[144:147], a[172:175], a[188:191], v[144:147]
v_exp_f32 v77, v77
M v[144:147], a[176:179], a[192:195], v[144:147]
buffer_load_dwordx4 v1, s[12:15], s43 offen offset:0 sc1 lds
M v[148:151], a[176:179], a[208:211], 0
v_exp_f32 v78, v78
M v[148:151], a[172:175], a[204:207], v[148:151]
v_cvt_pk_bf16_f32 v75, v90, v91
v_cvt_pk_bf16_f32 v76, v76, v77
M v[148:151], a[168:171], a[200:203], v[148:151]
v_exp_f32 v79, v79
M v[148:151], a[164:167], a[196:199], v[148:151]
buffer_load_dwordx4 v1, s[12:15], s43 offen offset:1024 sc1 lds
M v[152:155], a[164:167], a[212:215], 0
v_exp_f32 v92, v92
M v[152:155], a[168:171], a[216:219], v[152:155]
ds_read_b128 a[140:143], v2 offset:35840
ds_read_b128 a[144:147], v2 offset:44032
M v[152:155], a[172:175], a[220:223], v[152:155]
v_exp_f32 v93, v93
M v[152:155], a[176:179], a[224:227], v[152:155]
buffer_load_dwordx4 v1, s[12:15], s43 offen offset:2048 sc1 lds
M v[156:159], a[176:179], a[240:243], 0
v_exp_f32 v94, v94
M v[156:159], a[172:175], a[236:239], v[156:159]
v_cvt_pk_bf16_f32 v77, v78, v79
v_cvt_pk_bf16_f32 v78, v92, v93
M v[156:159], a[168:171], a[232:235], v[156:159]
v_exp_f32 v95, v95
M v[156:159], a[164:167], a[228:231], v[156:159]
buffer_load_dwordx4 v1, s[12:15], s43 offen offset:3072 sc1 lds
v_cvt_pk_bf16_f32 v79, v94, v95
s_waitcnt lgkmcnt(6)
M v[160:163], a[116:119], v[32:35], v[160:163]
v_exp_f32 v96, v96
M v[160:163], a[120:123], v[64:67], v[160:163]
ds_read_b128 a[148:151], v2 offset:36864
ds_read_b128 a[152:155], v2 offset:45056
M v[164:167], a[120:123], v[68:71], v[164:167]
v_exp_f32 v97, v97
M v[164:167], a[116:119], v[36:39], v[164:167]
v_cvt_pk_bf16_f32 v96, v96, v97
M v[168:171], a[116:119], v[40:43], v[168:171]
v_exp_f32 v98, v98
M v[168:171], a[120:123], v[72:75], v[168:171]
s_add_u32 s25, s25, 32768
s_cmp_eq_u32 s25, s27
M v[172:175], a[120:123], v[76:79], v[172:175]
v_exp_f32 v99, v99
M v[172:175], a[116:119], v[44:47], v[172:175]
v_cvt_pk_bf16_f32 v97, v98, v99
s_waitcnt lgkmcnt(6)
M a[96:99], a[112:115], v[32:35], a[96:99]
s_cselect_b32 s25, s28, s25
s_cselect_b32 s27, -1, s27
M a[96:99], a[112:115], v[64:67], a[96:99]
s_add_u32 s26, s26, 32768
s_cmp_eq_u32 s26, s62
M v[176:179], a[124:127], v[32:35], v[176:179]
v_exp_f32 v112, v112
M v[176:179], a[128:131], v[64:67], v[176:179]
ds_read_b128 a[156:159], v2 offset:37888
ds_read_b128 a[160:163], v2 offset:46080
M v[180:183], a[128:131], v[68:71], v[180:183]
v_exp_f32 v113, v113
M v[180:183], a[124:127], v[36:39], v[180:183]
v_cvt_pk_bf16_f32 v98, v112, v113
M v[184:187], a[124:127], v[40:43], v[184:187]
v_exp_f32 v114, v114
M v[184:187], a[128:131], v[72:75], v[184:187]
s_cselect_b32 s26, s63, s26
s_cselect_b32 s62, -1, s62
M v[188:191], a[128:131], v[76:79], v[188:191]
v_exp_f32 v115, v115
M v[188:191], a[124:127], v[44:47], v[188:191]
v_cvt_pk_bf16_f32 v99, v114, v115
s_waitcnt lgkmcnt(6)
M a[100:103], a[112:115], v[36:39], a[100:103]
M a[100:103], a[112:115], v[68:71], a[100:103]
M v[192:195], a[132:135], v[32:35], v[192:195]
v_exp_f32 v100, v100
M v[192:195], a[136:139], v[64:67], v[192:195]
ds_read_b128 a[164:167], v2 offset:38912
ds_read_b128 a[168:171], v2 offset:47104
M v[196:199], a[136:139], v[68:71], v[196:199]
v_exp_f32 v101, v101
M v[196:199], a[132:135], v[36:39], v[196:199]
v_cvt_pk_bf16_f32 v100, v100, v101
M v[200:203], a[132:135], v[40:43], v[200:203]
v_exp_f32 v102, v102
M v[200:203], a[136:139], v[72:75], v[200:203]
M v[204:207], a[136:139], v[76:79], v[204:207]
v_exp_f32 v103, v103
M v[204:207], a[132:135], v[44:47], v[204:207]
v_cvt_pk_bf16_f32 v101, v102, v103
s_waitcnt lgkmcnt(6)
M a[104:107], a[112:115], v[40:43], a[104:107]
M a[104:107], a[112:115], v[72:75], a[104:107]
M v[208:211], a[140:143], v[32:35], v[208:211]
v_exp_f32 v116, v116
M v[208:211], a[144:147], v[64:67], v[208:211]
ds_read_b128 a[172:175], v2 offset:39936
ds_read_b128 a[176:179], v2 offset:48128
M v[212:215], a[144:147], v[68:71], v[212:215]
v_exp_f32 v117, v117
M v[212:215], a[140:143], v[36:39], v[212:215]
v_cvt_pk_bf16_f32 v102, v116, v117
M v[216:219], a[140:143], v[40:43], v[216:219]
v_exp_f32 v118, v118
M v[216:219], a[144:147], v[72:75], v[216:219]
M v[220:223], a[144:147], v[76:79], v[220:223]
v_exp_f32 v119, v119
M v[220:223], a[140:143], v[44:47], v[220:223]
v_cvt_pk_bf16_f32 v103, v118, v119
s_waitcnt lgkmcnt(6)
M a[108:111], a[112:115], v[44:47], a[108:111]
M a[108:111], a[112:115], v[76:79], a[108:111]
M v[224:227], a[148:151], v[32:35], v[224:227]
v_exp_f32 v104, v104
M v[224:227], a[152:155], v[64:67], v[224:227]
M v[228:231], a[152:155], v[68:71], v[228:231]
v_exp_f32 v105, v105
M v[228:231], a[148:151], v[36:39], v[228:231]
v_cvt_pk_bf16_f32 v104, v104, v105
M v[232:235], a[148:151], v[40:43], v[232:235]
v_exp_f32 v106, v106
M v[232:235], a[152:155], v[72:75], v[232:235]
M v[236:239], a[152:155], v[76:79], v[236:239]
v_exp_f32 v107, v107
M v[236:239], a[148:151], v[44:47], v[236:239]
v_cvt_pk_bf16_f32 v105, v106, v107
s_waitcnt lgkmcnt(4)
M v[240:243], a[156:159], v[32:35], v[240:243]
v_exp_f32 v120, v120
M v[240:243], a[160:163], v[64:67], v[240:243]
M v[244:247], a[160:163], v[68:71], v[244:247]
v_exp_f32 v121, v121
M v[244:247], a[156:159], v[36:39], v[244:247]
v_cvt_pk_bf16_f32 v106, v120, v121
M v[248:251], a[156:159], v[40:43], v[248:251]
v_exp_f32 v122, v122
M v[248:251], a[160:163], v[72:75], v[248:251]
s_waitcnt vmcnt(0) lgkmcnt(0)
s_barrier
ds_read_b128 a[116:119], v3 offset:0
ds_read_b128 a[120:123], v3 offset:1024
M v[252:255], a[160:163], v[76:79], v[252:255]
v_exp_f32 v123, v123
M v[252:255], a[156:159], v[44:47], v[252:255]
v_cvt_pk_bf16_f32 v107, v122, v123
M a[64:67], a[164:167], v[32:35], a[64:67]
v_exp_f32 v108, v108
M a[64:67], a[168:171], v[64:67], a[64:67]
ds_read_b128 a[124:127], v3 offset:2048
ds_read_b128 a[128:131], v3 offset:3072
M a[68:71], a[168:171], v[68:71], a[68:71]
v_exp_f32 v109, v109
M a[68:71], a[164:167], v[36:39], a[68:71]
v_cvt_pk_bf16_f32 v108, v108, v109
M a[72:75], a[164:167], v[40:43], a[72:75]
v_exp_f32 v110, v110
M a[72:75], a[168:171], v[72:75], a[72:75]
ds_read_b128 a[132:135], v3 offset:4096
ds_read_b128 a[136:139], v3 offset:5120
M a[76:79], a[168:171], v[76:79], a[76:79]
v_exp_f32 v111, v111
M a[76:79], a[164:167], v[44:47], a[76:79]
v_cvt_pk_bf16_f32 v109, v110, v111
M a[80:83], a[172:175], v[32:35], a[80:83]
v_exp_f32 v124, v124
M a[80:83], a[176:179], v[64:67], a[80:83]
ds_read_b128 a[140:143], v3 offset:6144
ds_read_b128 a[144:147], v3 offset:7168
M a[84:87], a[176:179], v[68:71], a[84:87]
v_exp_f32 v125, v125
M a[84:87], a[172:175], v[36:39], a[84:87]
v_cvt_pk_bf16_f32 v110, v124, v125
M a[88:91], a[172:175], v[40:43], a[88:91]
v_exp_f32 v126, v126
M a[88:91], a[176:179], v[72:75], a[88:91]
M a[92:95], a[176:179], v[76:79], a[92:95]
v_exp_f32 v127, v127
M a[92:95], a[172:175], v[44:47], a[92:95]
v_cvt_pk_bf16_f32 v111, v126, v127
Lk2_l2b:
s_add_u32 m0, s29, 0
s_waitcnt lgkmcnt(4)
M v[32:35], a[116:119], a[180:183], 0
v_exp_f32 v128, v128
M v[32:35], a[120:123], a[184:187], v[32:35]
ds_read_b128 a[148:151], v3 offset:8192
ds_read_b128 a[152:155], v3 offset:9216
M v[32:35], a[124:127], a[188:191], v[32:35]
v_exp_f32 v129, v129
M v[32:35], a[128:131], a[192:195], v[32:35]
buffer_load_dwordx4 v1, s[12:15], s25 offen offset:0 sc1 lds
s_add_u32 s32, s25, 4096
M v[36:39], a[128:131], a[208:211], 0
v_exp_f32 v130, v130
M v[36:39], a[124:127], a[204:207], v[36:39]
v_cvt_pk_bf16_f32 v128, v128, v129
M v[36:39], a[120:123], a[200:203], v[36:39]
v_exp_f32 v131, v131
M v[36:39], a[116:119], a[196:199], v[36:39]
buffer_load_dwordx4 v1, s[12:15], s25 offen offset:1024 sc1 lds
M v[40:43], a[116:119], a[212:215], 0
v_exp_f32 v144, v144
M v[40:43], a[120:123], a[216:219], v[40:43]
ds_read_b128 a[156:159], v3 offset:10240
ds_read_b128 a[160:163], v3 offset:11264
M v[40:43], a[124:127], a[220:223], v[40:43]
v_exp_f32 v145, v145
M v[40:43], a[128:131], a[224:227], v[40:43]
buffer_load_dwordx4 v1, s[12:15], s25 offen offset:2048 sc1 lds
M v[44:47], a[128:131], a[240:243], 0
v_exp_f32 v146, v146
M v[44:47], a[124:127], a[236:239], v[44:47]
v_cvt_pk_bf16_f32 v129, v130, v131
v_cvt_pk_bf16_f32 v130, v144, v145
M v[44:47], a[120:123], a[232:235], v[44:47]
v_exp_f32 v147, v147
M v[44:47], a[116:119], a[228:231], v[44:47]
buffer_load_dwordx4 v1, s[12:15], s25 offen offset:3072 sc1 lds
s_add_u32 m0, s29, 4096
s_waitcnt lgkmcnt(4)
M v[48:51], a[132:135], a[180:183], 0
v_exp_f32 v132, v132
M v[48:51], a[136:139], a[184:187], v[48:51]
ds_read_b128 a[164:167], v3 offset:12288
ds_read_b128 a[168:171], v3 offset:13312
M v[48:51], a[140:143], a[188:191], v[48:51]
v_exp_f32 v133, v133
M v[48:51], a[144:147], a[192:195], v[48:51]
buffer_load_dwordx4 v1, s[12:15], s32 offen offset:0 sc1 lds
M v[52:55], a[144:147], a[208:211], 0
v_exp_f32 v134, v134
M v[52:55], a[140:143], a[204:207], v[52:55]
v_cvt_pk_bf16_f32 v131, v146, v147
v_cvt_pk_bf16_f32 v132, v132, v133
M v[52:55], a[136:139], a[200:203], v[52:55]
v_exp_f32 v135, v135
M v[52:55], a[132:135], a[196:199], v[52:55]
buffer_load_dwordx4 v1, s[12:15], s32 offen offset:1024 sc1 lds
M v[56:59], a[132:135], a[212:215], 0
v_exp_f32 v148, v148
M v[56:59], a[136:139], a[216:219], v[56:59]
ds_read_b128 a[172:175], v3 offset:14336
ds_read_b128 a[176:179], v3 offset:15360
M v[56:59], a[140:143], a[220:223], v[56:59]
v_exp_f32 v149, v149
M v[56:59], a[144:147], a[224:227], v[56:59]
buffer_load_dwordx4 v1, s[12:15], s32 offen offset:2048 sc1 lds
M v[60:63], a[144:147], a[240:243], 0
v_exp_f32 v150, v150
M v[60:63], a[140:143], a[236:239], v[60:63]
v_cvt_pk_bf16_f32 v133, v134, v135
v_cvt_pk_bf16_f32 v134, v148, v149
M v[60:63], a[136:139], a[232:235], v[60:63]
v_exp_f32 v151, v151
M v[60:63], a[132:135], a[228:231], v[60:63]
buffer_load_dwordx4 v1, s[12:15], s32 offen offset:3072 sc1 lds
s_add_u32 m0, s29, 32768
s_waitcnt lgkmcnt(4)
M v[64:67], a[148:151], a[180:183], 0
v_exp_f32 v136, v136
M v[64:67], a[152:155], a[184:187], v[64:67]
ds_read_b128 a[116:119], v3 offset:32768
ds_read_b128 a[120:123], v3 offset:40960
M v[64:67], a[156:159], a[188:191], v[64:67]
v_exp_f32 v137, v137
M v[64:67], a[160:163], a[192:195], v[64:67]
buffer_load_dwordx4 v1, s[12:15], s26 offen offset:0 sc1 lds
s_add_u32 s43, s26, 4096
M v[68:71], a[160:163], a[208:211], 0
v_exp_f32 v138, v138
M v[68:71], a[156:159], a[204:207], v[68:71]
v_cvt_pk_bf16_f32 v135, v150, v151
v_cvt_pk_bf16_f32 v136, v136, v137
M v[68:71], a[152:155], a[200:203], v[68:71]
v_exp_f32 v139, v139
M v[68:71], a[148:151], a[196:199], v[68:71]
buffer_load_dwordx4 v1, s[12:15], s26 offen offset:1024 sc1 lds
M v[72:75], a[148:151], a[212:215], 0
v_exp_f32 v152, v152
M v[72:75], a[152:155], a[216:219], v[72:75]
ds_read_b128 a[124:127], v3 offset:33792
ds_read_b128 a[128:131], v3 offset:41984
M v[72:75], a[156:159], a[220:223], v[72:75]
v_exp_f32 v153, v153
M v[72:75], a[160:163], a[224:227], v[72:75]
buffer_load_dwordx4 v1, s[12:15], s26 offen offset:2048 sc1 lds
M v[76:79], a[160:163], a[240:243], 0
v_exp_f32 v154, v154
M v[76:79], a[156:159], a[236:239], v[76:79]
v_cvt_pk_bf16_f32 v137, v138, v139
v_cvt_pk_bf16_f32 v138, v152, v153
M v[76:79], a[152:155], a[232:235], v[76:79]
v_exp_f32 v155, v155
M v[76:79], a[148:151], a[228:231], v[76:79]
buffer_load_dwordx4 v1, s[12:15], s26 offen offset:3072 sc1 lds
s_add_u32 m0, s29, 36864
s_waitcnt lgkmcnt(4)
M v[80:83], a[164:167], a[180:183], 0
v_exp_f32 v140, v140
M v[80:83], a[168:171], a[184:187], v[80:83]
ds_read_b128 a[132:135], v3 offset:34816
ds_read_b128 a[136:139], v3 offset:43008
M v[80:83], a[172:175], a[188:191], v[80:83]
v_exp_f32 v141, v141
M v[80:83], a[176:179], a[192:195], v[80:83]
buffer_load_dwordx4 v1, s[12:15], s43 offen offset:0 sc1 lds
M v[84:87], a[176:179], a[208:211], 0
v_exp_f32 v142, v142
M v[84:87], a[172:175], a[204:207], v[84:87]
v_cvt_pk_bf16_f32 v139, v154, v155
v_cvt_pk_bf16_f32 v140, v140, v141
M v[84:87], a[168:171], a[200:203], v[84:87]
v_exp_f32 v143, v143
M v[84:87], a[164:167], a[196:199], v[84:87]
buffer_load_dwordx4 v1, s[12:15], s43 offen offset:1024 sc1 lds
M v[88:91], a[164:167], a[212:215], 0
v_exp_f32 v156, v156
M v[88:91], a[168:171], a[216:219], v[88:91]
ds_read_b128 a[140:143], v3 offset:35840
ds_read_b128 a[144:147], v3 offset:44032
M v[88:91], a[172:175], a[220:223], v[88:91]
v_exp_f32 v157, v157
M v[88:91], a[176:179], a[224:227], v[88:91]
buffer_load_dwordx4 v1, s[12:15], s43 offen offset:2048 sc1 lds
M v[92:95], a[176:179], a[240:243], 0
v_exp_f32 v158, v158
M v[92:95], a[172:175], a[236:239], v[92:95]
v_cvt_pk_bf16_f32 v141, v142, v143
v_cvt_pk_bf16_f32 v142, v156, v157
M v[92:95], a[168:171], a[232:235], v[92:95]
v_exp_f32 v159, v159
M v[92:95], a[164:167], a[228:231], v[92:95]
buffer_load_dwordx4 v1, s[12:15], s43 offen offset:3072 sc1 lds
v_cvt_pk_bf16_f32 v143, v158, v159
s_waitcnt lgkmcnt(6)
M v[160:163], a[116:119], v[96:99], v[160:163]
v_exp_f32 v32, v32
M v[160:163], a[120:123], v[128:131], v[160:163]
ds_read_b128 a[148:151], v3 offset:36864
ds_read_b128 a[152:155], v3 offset:45056
M v[164:167], a[120:123], v[132:135], v[164:167]
v_exp_f32 v33, v33
M v[164:167], a[116:119], v[100:103], v[164:167]
v_cvt_pk_bf16_f32 v32, v32, v33
M v[168:171], a[116:119], v[104:107], v[168:171]
v_exp_f32 v34, v34
M v[168:171], a[120:123], v[136:139], v[168:171]
s_add_u32 s25, s25, 32768
s_cmp_eq_u32 s25, s27
M v[172:175], a[120:123], v[140:143], v[172:175]
v_exp_f32 v35, v35
M v[172:175], a[116:119], v[108:111], v[172:175]
v_cvt_pk_bf16_f32 v33, v34, v35
s_waitcnt lgkmcnt(6)
M a[96:99], a[112:115], v[96:99], a[96:99]
s_cselect_b32 s25, s28, s25
s_cselect_b32 s27, -1, s27
M a[96:99], a[112:115], v[128:131], a[96:99]
s_add_u32 s26, s26, 32768
s_cmp_eq_u32 s26, s62
M v[176:179], a[124:127], v[96:99], v[176:179]
v_exp_f32 v48, v48
M v[176:179], a[128:131], v[128:131], v[176:179]
ds_read_b128 a[156:159], v3 offset:37888
ds_read_b128 a[160:163], v3 offset:46080
M v[180:183], a[128:131], v[132:135], v[180:183]
v_exp_f32 v49, v49
M v[180:183], a[124:127], v[100:103], v[180:183]
v_cvt_pk_bf16_f32 v34, v48, v49
M v[184:187], a[124:127], v[104:107], v[184:187]
v_exp_f32 v50, v50
M v[184:187], a[128:131], v[136:139], v[184:187]
s_cselect_b32 s26, s63, s26
s_cselect_b32 s62, -1, s62
M v[188:191], a[128:131], v[140:143], v[188:191]
v_exp_f32 v51, v51
M v[188:191], a[124:127], v[108:111], v[188:191]
v_cvt_pk_bf16_f32 v35, v50, v51
s_waitcnt lgkmcnt(6)
M a[100:103], a[112:115], v[100:103], a[100:103]
M a[100:103], a[112:115], v[132:135], a[100:103]
M v[192:195], a[132:135], v[96:99], v[192:195]
v_exp_f32 v36, v36
M v[192:195], a[136:139], v[128:131], v[192:195]
ds_read_b128 a[164:167], v3 offset:38912
ds_read_b128 a[168:171], v3 offset:47104
M v[196:199], a[136:139], v[132:135], v[196:199]
v_exp_f32 v37, v37
M v[196:199], a[132:135], v[100:103], v[196:199]
v_cvt_pk_bf16_f32 v36, v36, v37
M v[200:203], a[132:135], v[104:107], v[200:203]
v_exp_f32 v38, v38
M v[200:203], a[136:139], v[136:139], v[200:203]
M v[204:207], a[136:139], v[140:143], v[204:207]
v_exp_f32 v39, v39
M v[204:207], a[132:135], v[108:111], v[204:207]
v_cvt_pk_bf16_f32 v37, v38, v39
s_waitcnt lgkmcnt(6)
M a[104:107], a[112:115], v[104:107], a[104:107]
M a[104:107], a[112:115], v[136:139], a[104:107]
M v[208:211], a[140:143], v[96:99], v[208:211]
v_exp_f32 v52, v52
M v[208:211], a[144:147], v[128:131], v[208:211]
ds_read_b128 a[172:175], v3 offset:39936
ds_read_b128 a[176:179], v3 offset:48128
M v[212:215], a[144:147], v[132:135], v[212:215]
v_exp_f32 v53, v53
M v[212:215], a[140:143], v[100:103], v[212:215]
v_cvt_pk_bf16_f32 v38, v52, v53
M v[216:219], a[140:143], v[104:107], v[216:219]
v_exp_f32 v54, v54
M v[216:219], a[144:147], v[136:139], v[216:219]
M v[220:223], a[144:147], v[140:143], v[220:223]
v_exp_f32 v55, v55
M v[220:223], a[140:143], v[108:111], v[220:223]
v_cvt_pk_bf16_f32 v39, v54, v55
s_waitcnt lgkmcnt(6)
M a[108:111], a[112:115], v[108:111], a[108:111]
M a[108:111], a[112:115], v[140:143], a[108:111]
M v[224:227], a[148:151], v[96:99], v[224:227]
v_exp_f32 v40, v40
M v[224:227], a[152:155], v[128:131], v[224:227]
M v[228:231], a[152:155], v[132:135], v[228:231]
v_exp_f32 v41, v41
M v[228:231], a[148:151], v[100:103], v[228:231]
v_cvt_pk_bf16_f32 v40, v40, v41
M v[232:235], a[148:151], v[104:107], v[232:235]
v_exp_f32 v42, v42
M v[232:235], a[152:155], v[136:139], v[232:235]
M v[236:239], a[152:155], v[140:143], v[236:239]
v_exp_f32 v43, v43
M v[236:239], a[148:151], v[108:111], v[236:239]
v_cvt_pk_bf16_f32 v41, v42, v43
s_waitcnt lgkmcnt(4)
M v[240:243], a[156:159], v[96:99], v[240:243]
v_exp_f32 v56, v56
M v[240:243], a[160:163], v[128:131], v[240:243]
M v[244:247], a[160:163], v[132:135], v[244:247]
v_exp_f32 v57, v57
M v[244:247], a[156:159], v[100:103], v[244:247]
v_cvt_pk_bf16_f32 v42, v56, v57
M v[248:251], a[156:159], v[104:107], v[248:251]
v_exp_f32 v58, v58
M v[248:251], a[160:163], v[136:139], v[248:251]
s_waitcnt vmcnt(0) lgkmcnt(0)
s_barrier
ds_read_b128 a[116:119], v2 offset:0
ds_read_b128 a[120:123], v2 offset:1024
M v[252:255], a[160:163], v[140:143], v[252:255]
v_exp_f32 v59, v59
M v[252:255], a[156:159], v[108:111], v[252:255]
v_cvt_pk_bf16_f32 v43, v58, v59
M a[64:67], a[164:167], v[96:99], a[64:67]
v_exp_f32 v44, v44
M a[64:67], a[168:171], v[128:131], a[64:67]
ds_read_b128 a[124:127], v2 offset:2048
ds_read_b128 a[128:131], v2 offset:3072
M a[68:71], a[168:171], v[132:135], a[68:71]
v_exp_f32 v45, v45
M a[68:71], a[164:167], v[100:103], a[68:71]
v_cvt_pk_bf16_f32 v44, v44, v45
M a[72:75], a[164:167], v[104:107], a[72:75]
v_exp_f32 v46, v46
M a[72:75], a[168:171], v[136:139], a[72:75]
ds_read_b128 a[132:135], v2 offset:4096
ds_read_b128 a[136:139], v2 offset:5120
M a[76:79], a[168:171], v[140:143], a[76:79]
v_exp_f32 v47, v47
M a[76:79], a[164:167], v[108:111], a[76:79]
v_cvt_pk_bf16_f32 v45, v46, v47
M a[80:83], a[172:175], v[96:99], a[80:83]
v_exp_f32 v60, v60
M a[80:83], a[176:179], v[128:131], a[80:83]
ds_read_b128 a[140:143], v2 offset:6144
ds_read_b128 a[144:147], v2 offset:7168
M a[84:87], a[176:179], v[132:135], a[84:87]
v_exp_f32 v61, v61
M a[84:87], a[172:175], v[100:103], a[84:87]
v_cvt_pk_bf16_f32 v46, v60, v61
M a[88:91], a[172:175], v[104:107], a[88:91]
v_exp_f32 v62, v62
M a[88:91], a[176:179], v[136:139], a[88:91]
M a[92:95], a[176:179], v[140:143], a[92:95]
v_exp_f32 v63, v63
M a[92:95], a[172:175], v[108:111], a[92:95]
v_cvt_pk_bf16_f32 v47, v62, v63
s_sub_u32 s30, s30, 1
s_cmp_lg_u32 s30, 0
s_cbranch_scc1 Lk2_l2
s_branch Lk2_fin
s_waitcnt lgkmcnt(0)
Lk2_wm:
s_lshl_b32 s33, s2, 1
s_add_u32 s33, s33, s23
s_lshl_b32 s34, s33, 12
s_lshl_b32 s33, s33, 14
v_lshlrev_b32 v8, 3, v1
v_lshlrev_b32 v9, 2, v1
buffer_load_dword a244, v8, s[44:47], s33 offen
s_add_u32 s33, s33, 8192
buffer_load_dword a245, v8, s[44:47], s33 offen
buffer_load_dword a246, v9, s[48:51], s34 offen
s_branch Lk2_l3b
Lk2_g1:
s_mov_b32 s30, 7
s_bfe_u32 s42, s2, 0x20003
s_add_u32 s42, s42, 2
Lk2_l3:
s_cmp_eq_u32 s30, s42
s_cbranch_scc1 Lk2_wm
Lk2_l3b:
s_add_u32 m0, s29, 65536
s_waitcnt lgkmcnt(4)
M v[96:99], a[116:119], a[0:3], 0
v_exp_f32 v64, v64
M v[96:99], a[120:123], a[4:7], v[96:99]
ds_read_b128 a[148:151], v2 offset:8192
ds_read_b128 a[152:155], v2 offset:9216
M v[96:99], a[124:127], a[8:11], v[96:99]
v_exp_f32 v65, v65
M v[96:99], a[128:131], a[12:15], v[96:99]
buffer_load_dwordx4 v1, s[12:15], s25 offen offset:0 sc1 lds
s_add_u32 s32, s25, 4096
M v[100:103], a[128:131], a[28:31], 0
v_exp_f32 v66, v66
M v[100:103], a[124:127], a[24:27], v[100:103]
v_cvt_pk_bf16_f32 v64, v64, v65
M v[100:103], a[120:123], a[20:23], v[100:103]
v_exp_f32 v67, v67
M v[100:103], a[116:119], a[16:19], v[100:103]
buffer_load_dwordx4 v1, s[12:15], s25 offen offset:1024 sc1 lds
M v[104:107], a[116:119], a[32:35], 0
v_exp_f32 v80, v80
M v[104:107], a[120:123], a[36:39], v[104:107]
ds_read_b128 a[156:159], v2 offset:10240
ds_read_b128 a[160:163], v2 offset:11264
M v[104:107], a[124:127], a[40:43], v[104:107]
v_exp_f32 v81, v81
M v[104:107], a[128:131], a[44:47], v[104:107]
buffer_load_dwordx4 v1, s[12:15], s25 offen offset:2048 sc1 lds
M v[108:111], a[128:131], a[60:63], 0
v_exp_f32 v82, v82
M v[108:111], a[124:127], a[56:59], v[108:111]
v_cvt_pk_bf16_f32 v65, v66, v67
v_cvt_pk_bf16_f32 v66, v80, v81
M v[108:111], a[120:123], a[52:55], v[108:111]
v_exp_f32 v83, v83
M v[108:111], a[116:119], a[48:51], v[108:111]
buffer_load_dwordx4 v1, s[12:15], s25 offen offset:3072 sc1 lds
s_add_u32 m0, s29, 69632
s_waitcnt lgkmcnt(4)
M v[112:115], a[132:135], a[0:3], 0
v_exp_f32 v68, v68
M v[112:115], a[136:139], a[4:7], v[112:115]
ds_read_b128 a[164:167], v2 offset:12288
ds_read_b128 a[168:171], v2 offset:13312
M v[112:115], a[140:143], a[8:11], v[112:115]
v_exp_f32 v69, v69
M v[112:115], a[144:147], a[12:15], v[112:115]
buffer_load_dwordx4 v1, s[12:15], s32 offen offset:0 sc1 lds
M v[116:119], a[144:147], a[28:31], 0
v_exp_f32 v70, v70
M v[116:119], a[140:143], a[24:27], v[116:119]
v_cvt_pk_bf16_f32 v67, v82, v83
v_cvt_pk_bf16_f32 v68, v68, v69
M v[116:119], a[136:139], a[20:23], v[116:119]
v_exp_f32 v71, v71
M v[116:119], a[132:135], a[16:19], v[116:119]
buffer_load_dwordx4 v1, s[12:15], s32 offen offset:1024 sc1 lds
M v[120:123], a[132:135], a[32:35], 0
v_exp_f32 v84, v84
M v[120:123], a[136:139], a[36:39], v[120:123]
ds_read_b128 a[172:175], v2 offset:14336
ds_read_b128 a[176:179], v2 offset:15360
M v[120:123], a[140:143], a[40:43], v[120:123]
v_exp_f32 v85, v85
M v[120:123], a[144:147], a[44:47], v[120:123]
buffer_load_dwordx4 v1, s[12:15], s32 offen offset:2048 sc1 lds
M v[124:127], a[144:147], a[60:63], 0
v_exp_f32 v86, v86
M v[124:127], a[140:143], a[56:59], v[124:127]
v_cvt_pk_bf16_f32 v69, v70, v71
v_cvt_pk_bf16_f32 v70, v84, v85
M v[124:127], a[136:139], a[52:55], v[124:127]
v_exp_f32 v87, v87
M v[124:127], a[132:135], a[48:51], v[124:127]
buffer_load_dwordx4 v1, s[12:15], s32 offen offset:3072 sc1 lds
s_add_u32 m0, s29, 98304
s_waitcnt lgkmcnt(4)
M v[128:131], a[148:151], a[0:3], 0
v_exp_f32 v72, v72
M v[128:131], a[152:155], a[4:7], v[128:131]
ds_read_b128 a[116:119], v2 offset:32768
ds_read_b128 a[120:123], v2 offset:40960
M v[128:131], a[156:159], a[8:11], v[128:131]
v_exp_f32 v73, v73
M v[128:131], a[160:163], a[12:15], v[128:131]
buffer_load_dwordx4 v1, s[12:15], s26 offen offset:0 sc1 lds
s_add_u32 s43, s26, 4096
M v[132:135], a[160:163], a[28:31], 0
v_exp_f32 v74, v74
M v[132:135], a[156:159], a[24:27], v[132:135]
v_cvt_pk_bf16_f32 v71, v86, v87
v_cvt_pk_bf16_f32 v72, v72, v73
M v[132:135], a[152:155], a[20:23], v[132:135]
v_exp_f32 v75, v75
M v[132:135], a[148:151], a[16:19], v[132:135]
buffer_load_dwordx4 v1, s[12:15], s26 offen offset:1024 sc1 lds
M v[136:139], a[148:151], a[32:35], 0
v_exp_f32 v88, v88
M v[136:139], a[152:155], a[36:39], v[136:139]
ds_read_b128 a[124:127], v2 offset:33792
ds_read_b128 a[128:131], v2 offset:41984
M v[136:139], a[156:159], a[40:43], v[136:139]
v_exp_f32 v89, v89
M v[136:139], a[160:163], a[44:47], v[136:139]
buffer_load_dwordx4 v1, s[12:15], s26 offen offset:2048 sc1 lds
M v[140:143], a[160:163], a[60:63], 0
v_exp_f32 v90, v90
M v[140:143], a[156:159], a[56:59], v[140:143]
v_cvt_pk_bf16_f32 v73, v74, v75
v_cvt_pk_bf16_f32 v74, v88, v89
M v[140:143], a[152:155], a[52:55], v[140:143]
v_exp_f32 v91, v91
M v[140:143], a[148:151], a[48:51], v[140:143]
buffer_load_dwordx4 v1, s[12:15], s26 offen offset:3072 sc1 lds
s_add_u32 m0, s29, 102400
s_waitcnt lgkmcnt(4)
M v[144:147], a[164:167], a[0:3], 0
v_exp_f32 v76, v76
M v[144:147], a[168:171], a[4:7], v[144:147]
ds_read_b128 a[132:135], v2 offset:34816
ds_read_b128 a[136:139], v2 offset:43008
M v[144:147], a[172:175], a[8:11], v[144:147]
v_exp_f32 v77, v77
M v[144:147], a[176:179], a[12:15], v[144:147]
buffer_load_dwordx4 v1, s[12:15], s43 offen offset:0 sc1 lds
M v[148:151], a[176:179], a[28:31], 0
v_exp_f32 v78, v78
M v[148:151], a[172:175], a[24:27], v[148:151]
v_cvt_pk_bf16_f32 v75, v90, v91
v_cvt_pk_bf16_f32 v76, v76, v77
M v[148:151], a[168:171], a[20:23], v[148:151]
v_exp_f32 v79, v79
M v[148:151], a[164:167], a[16:19], v[148:151]
buffer_load_dwordx4 v1, s[12:15], s43 offen offset:1024 sc1 lds
M v[152:155], a[164:167], a[32:35], 0
v_exp_f32 v92, v92
M v[152:155], a[168:171], a[36:39], v[152:155]
ds_read_b128 a[140:143], v2 offset:35840
ds_read_b128 a[144:147], v2 offset:44032
M v[152:155], a[172:175], a[40:43], v[152:155]
v_exp_f32 v93, v93
M v[152:155], a[176:179], a[44:47], v[152:155]
buffer_load_dwordx4 v1, s[12:15], s43 offen offset:2048 sc1 lds
M v[156:159], a[176:179], a[60:63], 0
v_exp_f32 v94, v94
M v[156:159], a[172:175], a[56:59], v[156:159]
v_cvt_pk_bf16_f32 v77, v78, v79
v_cvt_pk_bf16_f32 v78, v92, v93
M v[156:159], a[168:171], a[52:55], v[156:159]
v_exp_f32 v95, v95
M v[156:159], a[164:167], a[48:51], v[156:159]
buffer_load_dwordx4 v1, s[12:15], s43 offen offset:3072 sc1 lds
v_cvt_pk_bf16_f32 v79, v94, v95
s_waitcnt lgkmcnt(6)
M v[160:163], a[116:119], v[32:35], v[160:163]
v_exp_f32 v96, v96
M v[160:163], a[120:123], v[64:67], v[160:163]
ds_read_b128 a[148:151], v2 offset:36864
ds_read_b128 a[152:155], v2 offset:45056
M v[164:167], a[120:123], v[68:71], v[164:167]
v_exp_f32 v97, v97
M v[164:167], a[116:119], v[36:39], v[164:167]
v_cvt_pk_bf16_f32 v96, v96, v97
M v[168:171], a[116:119], v[40:43], v[168:171]
v_exp_f32 v98, v98
M v[168:171], a[120:123], v[72:75], v[168:171]
s_add_u32 s25, s25, 32768
s_cmp_eq_u32 s25, s27
M v[172:175], a[120:123], v[76:79], v[172:175]
v_exp_f32 v99, v99
M v[172:175], a[116:119], v[44:47], v[172:175]
v_cvt_pk_bf16_f32 v97, v98, v99
s_waitcnt lgkmcnt(6)
M a[96:99], a[112:115], v[32:35], a[96:99]
s_cselect_b32 s25, s28, s25
s_cselect_b32 s27, -1, s27
M a[96:99], a[112:115], v[64:67], a[96:99]
s_add_u32 s26, s26, 32768
s_cmp_eq_u32 s26, s62
M v[176:179], a[124:127], v[32:35], v[176:179]
v_exp_f32 v112, v112
M v[176:179], a[128:131], v[64:67], v[176:179]
ds_read_b128 a[156:159], v2 offset:37888
ds_read_b128 a[160:163], v2 offset:46080
M v[180:183], a[128:131], v[68:71], v[180:183]
v_exp_f32 v113, v113
M v[180:183], a[124:127], v[36:39], v[180:183]
v_cvt_pk_bf16_f32 v98, v112, v113
M v[184:187], a[124:127], v[40:43], v[184:187]
v_exp_f32 v114, v114
M v[184:187], a[128:131], v[72:75], v[184:187]
s_cselect_b32 s26, s63, s26
s_cselect_b32 s62, -1, s62
M v[188:191], a[128:131], v[76:79], v[188:191]
v_exp_f32 v115, v115
M v[188:191], a[124:127], v[44:47], v[188:191]
v_cvt_pk_bf16_f32 v99, v114, v115
s_waitcnt lgkmcnt(6)
M a[100:103], a[112:115], v[36:39], a[100:103]
M a[100:103], a[112:115], v[68:71], a[100:103]
M v[192:195], a[132:135], v[32:35], v[192:195]
v_exp_f32 v100, v100
M v[192:195], a[136:139], v[64:67], v[192:195]
ds_read_b128 a[164:167], v2 offset:38912
ds_read_b128 a[168:171], v2 offset:47104
M v[196:199], a[136:139], v[68:71], v[196:199]
v_exp_f32 v101, v101
M v[196:199], a[132:135], v[36:39], v[196:199]
v_cvt_pk_bf16_f32 v100, v100, v101
M v[200:203], a[132:135], v[40:43], v[200:203]
v_exp_f32 v102, v102
M v[200:203], a[136:139], v[72:75], v[200:203]
M v[204:207], a[136:139], v[76:79], v[204:207]
v_exp_f32 v103, v103
M v[204:207], a[132:135], v[44:47], v[204:207]
v_cvt_pk_bf16_f32 v101, v102, v103
s_waitcnt lgkmcnt(6)
M a[104:107], a[112:115], v[40:43], a[104:107]
M a[104:107], a[112:115], v[72:75], a[104:107]
M v[208:211], a[140:143], v[32:35], v[208:211]
v_exp_f32 v116, v116
M v[208:211], a[144:147], v[64:67], v[208:211]
ds_read_b128 a[172:175], v2 offset:39936
ds_read_b128 a[176:179], v2 offset:48128
M v[212:215], a[144:147], v[68:71], v[212:215]
v_exp_f32 v117, v117
M v[212:215], a[140:143], v[36:39], v[212:215]
v_cvt_pk_bf16_f32 v102, v116, v117
M v[216:219], a[140:143], v[40:43], v[216:219]
v_exp_f32 v118, v118
M v[216:219], a[144:147], v[72:75], v[216:219]
M v[220:223], a[144:147], v[76:79], v[220:223]
v_exp_f32 v119, v119
M v[220:223], a[140:143], v[44:47], v[220:223]
v_cvt_pk_bf16_f32 v103, v118, v119
s_waitcnt lgkmcnt(6)
M a[108:111], a[112:115], v[44:47], a[108:111]
M a[108:111], a[112:115], v[76:79], a[108:111]
M v[224:227], a[148:151], v[32:35], v[224:227]
v_exp_f32 v104, v104
M v[224:227], a[152:155], v[64:67], v[224:227]
M v[228:231], a[152:155], v[68:71], v[228:231]
v_exp_f32 v105, v105
M v[228:231], a[148:151], v[36:39], v[228:231]
v_cvt_pk_bf16_f32 v104, v104, v105
M v[232:235], a[148:151], v[40:43], v[232:235]
v_exp_f32 v106, v106
M v[232:235], a[152:155], v[72:75], v[232:235]
M v[236:239], a[152:155], v[76:79], v[236:239]
v_exp_f32 v107, v107
M v[236:239], a[148:151], v[44:47], v[236:239]
v_cvt_pk_bf16_f32 v105, v106, v107
s_waitcnt lgkmcnt(4)
M v[240:243], a[156:159], v[32:35], v[240:243]
v_exp_f32 v120, v120
M v[240:243], a[160:163], v[64:67], v[240:243]
M v[244:247], a[160:163], v[68:71], v[244:247]
v_exp_f32 v121, v121
M v[244:247], a[156:159], v[36:39], v[244:247]
v_cvt_pk_bf16_f32 v106, v120, v121
M v[248:251], a[156:159], v[40:43], v[248:251]
v_exp_f32 v122, v122
M v[248:251], a[160:163], v[72:75], v[248:251]
s_waitcnt vmcnt(0) lgkmcnt(0)
s_barrier
ds_read_b128 a[116:119], v3 offset:0
ds_read_b128 a[120:123], v3 offset:1024
M v[252:255], a[160:163], v[76:79], v[252:255]
v_exp_f32 v123, v123
M v[252:255], a[156:159], v[44:47], v[252:255]
v_cvt_pk_bf16_f32 v107, v122, v123
M a[64:67], a[164:167], v[32:35], a[64:67]
v_exp_f32 v108, v108
M a[64:67], a[168:171], v[64:67], a[64:67]
ds_read_b128 a[124:127], v3 offset:2048
ds_read_b128 a[128:131], v3 offset:3072
M a[68:71], a[168:171], v[68:71], a[68:71]
v_exp_f32 v109, v109
M a[68:71], a[164:167], v[36:39], a[68:71]
v_cvt_pk_bf16_f32 v108, v108, v109
M a[72:75], a[164:167], v[40:43], a[72:75]
v_exp_f32 v110, v110
M a[72:75], a[168:171], v[72:75], a[72:75]
ds_read_b128 a[132:135], v3 offset:4096
ds_read_b128 a[136:139], v3 offset:5120
M a[76:79], a[168:171], v[76:79], a[76:79]
v_exp_f32 v111, v111
M a[76:79], a[164:167], v[44:47], a[76:79]
v_cvt_pk_bf16_f32 v109, v110, v111
M a[80:83], a[172:175], v[32:35], a[80:83]
v_exp_f32 v124, v124
M a[80:83], a[176:179], v[64:67], a[80:83]
ds_read_b128 a[140:143], v3 offset:6144
ds_read_b128 a[144:147], v3 offset:7168
M a[84:87], a[176:179], v[68:71], a[84:87]
v_exp_f32 v125, v125
M a[84:87], a[172:175], v[36:39], a[84:87]
v_cvt_pk_bf16_f32 v110, v124, v125
M a[88:91], a[172:175], v[40:43], a[88:91]
v_exp_f32 v126, v126
M a[88:91], a[176:179], v[72:75], a[88:91]
M a[92:95], a[176:179], v[76:79], a[92:95]
v_exp_f32 v127, v127
M a[92:95], a[172:175], v[44:47], a[92:95]
v_cvt_pk_bf16_f32 v111, v126, v127
s_add_u32 m0, s29, 0
s_waitcnt lgkmcnt(4)
M v[32:35], a[116:119], a[0:3], 0
v_exp_f32 v128, v128
M v[32:35], a[120:123], a[4:7], v[32:35]
ds_read_b128 a[148:151], v3 offset:8192
ds_read_b128 a[152:155], v3 offset:9216
M v[32:35], a[124:127], a[8:11], v[32:35]
v_exp_f32 v129, v129
M v[32:35], a[128:131], a[12:15], v[32:35]
buffer_load_dwordx4 v1, s[12:15], s25 offen offset:0 sc1 lds
s_add_u32 s32, s25, 4096
M v[36:39], a[128:131], a[28:31], 0
v_exp_f32 v130, v130
M v[36:39], a[124:127], a[24:27], v[36:39]
v_cvt_pk_bf16_f32 v128, v128, v129
M v[36:39], a[120:123], a[20:23], v[36:39]
v_exp_f32 v131, v131
M v[36:39], a[116:119], a[16:19], v[36:39]
buffer_load_dwordx4 v1, s[12:15], s25 offen offset:1024 sc1 lds
M v[40:43], a[116:119], a[32:35], 0
v_exp_f32 v144, v144
M v[40:43], a[120:123], a[36:39], v[40:43]
ds_read_b128 a[156:159], v3 offset:10240
ds_read_b128 a[160:163], v3 offset:11264
M v[40:43], a[124:127], a[40:43], v[40:43]
v_exp_f32 v145, v145
M v[40:43], a[128:131], a[44:47], v[40:43]
buffer_load_dwordx4 v1, s[12:15], s25 offen offset:2048 sc1 lds
M v[44:47], a[128:131], a[60:63], 0
v_exp_f32 v146, v146
M v[44:47], a[124:127], a[56:59], v[44:47]
v_cvt_pk_bf16_f32 v129, v130, v131
v_cvt_pk_bf16_f32 v130, v144, v145
M v[44:47], a[120:123], a[52:55], v[44:47]
v_exp_f32 v147, v147
M v[44:47], a[116:119], a[48:51], v[44:47]
buffer_load_dwordx4 v1, s[12:15], s25 offen offset:3072 sc1 lds
s_add_u32 m0, s29, 4096
s_waitcnt lgkmcnt(4)
M v[48:51], a[132:135], a[0:3], 0
v_exp_f32 v132, v132
M v[48:51], a[136:139], a[4:7], v[48:51]
ds_read_b128 a[164:167], v3 offset:12288
ds_read_b128 a[168:171], v3 offset:13312
M v[48:51], a[140:143], a[8:11], v[48:51]
v_exp_f32 v133, v133
M v[48:51], a[144:147], a[12:15], v[48:51]
buffer_load_dwordx4 v1, s[12:15], s32 offen offset:0 sc1 lds
M v[52:55], a[144:147], a[28:31], 0
v_exp_f32 v134, v134
M v[52:55], a[140:143], a[24:27], v[52:55]
v_cvt_pk_bf16_f32 v131, v146, v147
v_cvt_pk_bf16_f32 v132, v132, v133
M v[52:55], a[136:139], a[20:23], v[52:55]
v_exp_f32 v135, v135
M v[52:55], a[132:135], a[16:19], v[52:55]
buffer_load_dwordx4 v1, s[12:15], s32 offen offset:1024 sc1 lds
M v[56:59], a[132:135], a[32:35], 0
v_exp_f32 v148, v148
M v[56:59], a[136:139], a[36:39], v[56:59]
ds_read_b128 a[172:175], v3 offset:14336
ds_read_b128 a[176:179], v3 offset:15360
M v[56:59], a[140:143], a[40:43], v[56:59]
v_exp_f32 v149, v149
M v[56:59], a[144:147], a[44:47], v[56:59]
buffer_load_dwordx4 v1, s[12:15], s32 offen offset:2048 sc1 lds
M v[60:63], a[144:147], a[60:63], 0
v_exp_f32 v150, v150
M v[60:63], a[140:143], a[56:59], v[60:63]
v_cvt_pk_bf16_f32 v133, v134, v135
v_cvt_pk_bf16_f32 v134, v148, v149
M v[60:63], a[136:139], a[52:55], v[60:63]
v_exp_f32 v151, v151
M v[60:63], a[132:135], a[48:51], v[60:63]
buffer_load_dwordx4 v1, s[12:15], s32 offen offset:3072 sc1 lds
s_add_u32 m0, s29, 32768
s_waitcnt lgkmcnt(4)
M v[64:67], a[148:151], a[0:3], 0
v_exp_f32 v136, v136
M v[64:67], a[152:155], a[4:7], v[64:67]
ds_read_b128 a[116:119], v3 offset:32768
ds_read_b128 a[120:123], v3 offset:40960
M v[64:67], a[156:159], a[8:11], v[64:67]
v_exp_f32 v137, v137
M v[64:67], a[160:163], a[12:15], v[64:67]
buffer_load_dwordx4 v1, s[12:15], s26 offen offset:0 sc1 lds
s_add_u32 s43, s26, 4096
M v[68:71], a[160:163], a[28:31], 0
v_exp_f32 v138, v138
M v[68:71], a[156:159], a[24:27], v[68:71]
v_cvt_pk_bf16_f32 v135, v150, v151
v_cvt_pk_bf16_f32 v136, v136, v137
M v[68:71], a[152:155], a[20:23], v[68:71]
v_exp_f32 v139, v139
M v[68:71], a[148:151], a[16:19], v[68:71]
buffer_load_dwordx4 v1, s[12:15], s26 offen offset:1024 sc1 lds
M v[72:75], a[148:151], a[32:35], 0
v_exp_f32 v152, v152
M v[72:75], a[152:155], a[36:39], v[72:75]
ds_read_b128 a[124:127], v3 offset:33792
ds_read_b128 a[128:131], v3 offset:41984
M v[72:75], a[156:159], a[40:43], v[72:75]
v_exp_f32 v153, v153
M v[72:75], a[160:163], a[44:47], v[72:75]
buffer_load_dwordx4 v1, s[12:15], s26 offen offset:2048 sc1 lds
M v[76:79], a[160:163], a[60:63], 0
v_exp_f32 v154, v154
M v[76:79], a[156:159], a[56:59], v[76:79]
v_cvt_pk_bf16_f32 v137, v138, v139
v_cvt_pk_bf16_f32 v138, v152, v153
M v[76:79], a[152:155], a[52:55], v[76:79]
v_exp_f32 v155, v155
M v[76:79], a[148:151], a[48:51], v[76:79]
buffer_load_dwordx4 v1, s[12:15], s26 offen offset:3072 sc1 lds
s_add_u32 m0, s29, 36864
s_waitcnt lgkmcnt(4)
M v[80:83], a[164:167], a[0:3], 0
v_exp_f32 v140, v140
M v[80:83], a[168:171], a[4:7], v[80:83]
ds_read_b128 a[132:135], v3 offset:34816
ds_read_b128 a[136:139], v3 offset:43008
M v[80:83], a[172:175], a[8:11], v[80:83]
v_exp_f32 v141, v141
M v[80:83], a[176:179], a[12:15], v[80:83]
buffer_load_dwordx4 v1, s[12:15], s43 offen offset:0 sc1 lds
M v[84:87], a[176:179], a[28:31], 0
v_exp_f32 v142, v142
M v[84:87], a[172:175], a[24:27], v[84:87]
v_cvt_pk_bf16_f32 v139, v154, v155
v_cvt_pk_bf16_f32 v140, v140, v141
M v[84:87], a[168:171], a[20:23], v[84:87]
v_exp_f32 v143, v143
M v[84:87], a[164:167], a[16:19], v[84:87]
buffer_load_dwordx4 v1, s[12:15], s43 offen offset:1024 sc1 lds
M v[88:91], a[164:167], a[32:35], 0
v_exp_f32 v156, v156
M v[88:91], a[168:171], a[36:39], v[88:91]
ds_read_b128 a[140:143], v3 offset:35840
ds_read_b128 a[144:147], v3 offset:44032
M v[88:91], a[172:175], a[40:43], v[88:91]
v_exp_f32 v157, v157
M v[88:91], a[176:179], a[44:47], v[88:91]
buffer_load_dwordx4 v1, s[12:15], s43 offen offset:2048 sc1 lds
M v[92:95], a[176:179], a[60:63], 0
v_exp_f32 v158, v158
M v[92:95], a[172:175], a[56:59], v[92:95]
v_cvt_pk_bf16_f32 v141, v142, v143
v_cvt_pk_bf16_f32 v142, v156, v157
M v[92:95], a[168:171], a[52:55], v[92:95]
v_exp_f32 v159, v159
M v[92:95], a[164:167], a[48:51], v[92:95]
buffer_load_dwordx4 v1, s[12:15], s43 offen offset:3072 sc1 lds
v_cvt_pk_bf16_f32 v143, v158, v159
s_waitcnt lgkmcnt(6)
M v[160:163], a[116:119], v[96:99], v[160:163]
v_exp_f32 v32, v32
M v[160:163], a[120:123], v[128:131], v[160:163]
ds_read_b128 a[148:151], v3 offset:36864
ds_read_b128 a[152:155], v3 offset:45056
M v[164:167], a[120:123], v[132:135], v[164:167]
v_exp_f32 v33, v33
M v[164:167], a[116:119], v[100:103], v[164:167]
v_cvt_pk_bf16_f32 v32, v32, v33
M v[168:171], a[116:119], v[104:107], v[168:171]
v_exp_f32 v34, v34
M v[168:171], a[120:123], v[136:139], v[168:171]
s_add_u32 s25, s25, 32768
s_cmp_eq_u32 s25, s27
M v[172:175], a[120:123], v[140:143], v[172:175]
v_exp_f32 v35, v35
M v[172:175], a[116:119], v[108:111], v[172:175]
v_cvt_pk_bf16_f32 v33, v34, v35
s_waitcnt lgkmcnt(6)
M a[96:99], a[112:115], v[96:99], a[96:99]
s_cselect_b32 s25, s28, s25
s_cselect_b32 s27, -1, s27
M a[96:99], a[112:115], v[128:131], a[96:99]
s_add_u32 s26, s26, 32768
s_cmp_eq_u32 s26, s62
M v[176:179], a[124:127], v[96:99], v[176:179]
v_exp_f32 v48, v48
M v[176:179], a[128:131], v[128:131], v[176:179]
ds_read_b128 a[156:159], v3 offset:37888
ds_read_b128 a[160:163], v3 offset:46080
M v[180:183], a[128:131], v[132:135], v[180:183]
v_exp_f32 v49, v49
M v[180:183], a[124:127], v[100:103], v[180:183]
v_cvt_pk_bf16_f32 v34, v48, v49
M v[184:187], a[124:127], v[104:107], v[184:187]
v_exp_f32 v50, v50
M v[184:187], a[128:131], v[136:139], v[184:187]
s_cselect_b32 s26, s63, s26
s_cselect_b32 s62, -1, s62
M v[188:191], a[128:131], v[140:143], v[188:191]
v_exp_f32 v51, v51
M v[188:191], a[124:127], v[108:111], v[188:191]
v_cvt_pk_bf16_f32 v35, v50, v51
s_waitcnt lgkmcnt(6)
M a[100:103], a[112:115], v[100:103], a[100:103]
M a[100:103], a[112:115], v[132:135], a[100:103]
M v[192:195], a[132:135], v[96:99], v[192:195]
v_exp_f32 v36, v36
M v[192:195], a[136:139], v[128:131], v[192:195]
ds_read_b128 a[164:167], v3 offset:38912
ds_read_b128 a[168:171], v3 offset:47104
M v[196:199], a[136:139], v[132:135], v[196:199]
v_exp_f32 v37, v37
M v[196:199], a[132:135], v[100:103], v[196:199]
v_cvt_pk_bf16_f32 v36, v36, v37
M v[200:203], a[132:135], v[104:107], v[200:203]
v_exp_f32 v38, v38
M v[200:203], a[136:139], v[136:139], v[200:203]
M v[204:207], a[136:139], v[140:143], v[204:207]
v_exp_f32 v39, v39
M v[204:207], a[132:135], v[108:111], v[204:207]
v_cvt_pk_bf16_f32 v37, v38, v39
s_waitcnt lgkmcnt(6)
M a[104:107], a[112:115], v[104:107], a[104:107]
M a[104:107], a[112:115], v[136:139], a[104:107]
M v[208:211], a[140:143], v[96:99], v[208:211]
v_exp_f32 v52, v52
M v[208:211], a[144:147], v[128:131], v[208:211]
ds_read_b128 a[172:175], v3 offset:39936
ds_read_b128 a[176:179], v3 offset:48128
M v[212:215], a[144:147], v[132:135], v[212:215]
v_exp_f32 v53, v53
M v[212:215], a[140:143], v[100:103], v[212:215]
v_cvt_pk_bf16_f32 v38, v52, v53
M v[216:219], a[140:143], v[104:107], v[216:219]
v_exp_f32 v54, v54
M v[216:219], a[144:147], v[136:139], v[216:219]
M v[220:223], a[144:147], v[140:143], v[220:223]
v_exp_f32 v55, v55
M v[220:223], a[140:143], v[108:111], v[220:223]
v_cvt_pk_bf16_f32 v39, v54, v55
s_waitcnt lgkmcnt(6)
M a[108:111], a[112:115], v[108:111], a[108:111]
M a[108:111], a[112:115], v[140:143], a[108:111]
M v[224:227], a[148:151], v[96:99], v[224:227]
v_exp_f32 v40, v40
M v[224:227], a[152:155], v[128:131], v[224:227]
M v[228:231], a[152:155], v[132:135], v[228:231]
v_exp_f32 v41, v41
M v[228:231], a[148:151], v[100:103], v[228:231]
v_cvt_pk_bf16_f32 v40, v40, v41
M v[232:235], a[148:151], v[104:107], v[232:235]
v_exp_f32 v42, v42
M v[232:235], a[152:155], v[136:139], v[232:235]
M v[236:239], a[152:155], v[140:143], v[236:239]
v_exp_f32 v43, v43
M v[236:239], a[148:151], v[108:111], v[236:239]
v_cvt_pk_bf16_f32 v41, v42, v43
s_waitcnt lgkmcnt(4)
M v[240:243], a[156:159], v[96:99], v[240:243]
v_exp_f32 v56, v56
M v[240:243], a[160:163], v[128:131], v[240:243]
M v[244:247], a[160:163], v[132:135], v[244:247]
v_exp_f32 v57, v57
M v[244:247], a[156:159], v[100:103], v[244:247]
v_cvt_pk_bf16_f32 v42, v56, v57
M v[248:251], a[156:159], v[104:107], v[248:251]
v_exp_f32 v58, v58
M v[248:251], a[160:163], v[136:139], v[248:251]
s_waitcnt vmcnt(0) lgkmcnt(0)
s_barrier
ds_read_b128 a[116:119], v2 offset:0
ds_read_b128 a[120:123], v2 offset:1024
M v[252:255], a[160:163], v[140:143], v[252:255]
v_exp_f32 v59, v59
M v[252:255], a[156:159], v[108:111], v[252:255]
v_cvt_pk_bf16_f32 v43, v58, v59
M a[64:67], a[164:167], v[96:99], a[64:67]
v_exp_f32 v44, v44
M a[64:67], a[168:171], v[128:131], a[64:67]
ds_read_b128 a[124:127], v2 offset:2048
ds_read_b128 a[128:131], v2 offset:3072
M a[68:71], a[168:171], v[132:135], a[68:71]
v_exp_f32 v45, v45
M a[68:71], a[164:167], v[100:103], a[68:71]
v_cvt_pk_bf16_f32 v44, v44, v45
M a[72:75], a[164:167], v[104:107], a[72:75]
v_exp_f32 v46, v46
M a[72:75], a[168:171], v[136:139], a[72:75]
ds_read_b128 a[132:135], v2 offset:4096
ds_read_b128 a[136:139], v2 offset:5120
M a[76:79], a[168:171], v[140:143], a[76:79]
v_exp_f32 v47, v47
M a[76:79], a[164:167], v[108:111], a[76:79]
v_cvt_pk_bf16_f32 v45, v46, v47
M a[80:83], a[172:175], v[96:99], a[80:83]
v_exp_f32 v60, v60
M a[80:83], a[176:179], v[128:131], a[80:83]
ds_read_b128 a[140:143], v2 offset:6144
ds_read_b128 a[144:147], v2 offset:7168
M a[84:87], a[176:179], v[132:135], a[84:87]
v_exp_f32 v61, v61
M a[84:87], a[172:175], v[100:103], a[84:87]
v_cvt_pk_bf16_f32 v46, v60, v61
M a[88:91], a[172:175], v[104:107], a[88:91]
v_exp_f32 v62, v62
M a[88:91], a[176:179], v[136:139], a[88:91]
M a[92:95], a[176:179], v[140:143], a[92:95]
v_exp_f32 v63, v63
M a[92:95], a[172:175], v[108:111], a[92:95]
v_cvt_pk_bf16_f32 v47, v62, v63
s_sub_u32 s30, s30, 1
s_cmp_lg_u32 s30, 0
s_cbranch_scc1 Lk2_l3
s_lshl_b32 s33, s23, 6
s_add_i32 s33, s33, 0
s_cmp_gt_i32 s33, 0
s_cselect_b32 s34, 0, 0xf149f2ca
s_cmp_lt_i32 s33, 0
s_cselect_b32 s33, 0xf149f2ca, 0
v_mov_b32 v20, s34
v_mov_b32 v21, s34
v_mov_b32 v22, s34
v_mov_b32 v23, s34
v_mov_b32 v28, s33
v_mov_b32 v29, s33
v_mov_b32 v30, s33
v_mov_b32 v31, s33
v_med3_f32 v24, v16, v20, v28
v_med3_f32 v25, v17, v20, v28
v_med3_f32 v26, v18, v20, v28
v_med3_f32 v27, v19, v20, v28
s_add_u32 m0, s29, 65536
s_waitcnt lgkmcnt(4)
M v[96:99], a[116:119], a[0:3], v[24:27]
v_exp_f32 v64, v64
M v[96:99], a[120:123], a[4:7], v[96:99]
ds_read_b128 a[148:151], v2 offset:8192
ds_read_b128 a[152:155], v2 offset:9216
M v[96:99], a[124:127], a[8:11], v[96:99]
v_exp_f32 v65, v65
M v[96:99], a[128:131], a[12:15], v[96:99]
buffer_load_dwordx4 v1, s[12:15], s25 offen offset:0 sc1 lds
s_add_u32 s32, s25, 4096
M v[100:103], a[128:131], a[28:31], v[28:31]
v_exp_f32 v66, v66
M v[100:103], a[124:127], a[24:27], v[100:103]
v_cvt_pk_bf16_f32 v64, v64, v65
M v[100:103], a[120:123], a[20:23], v[100:103]
v_exp_f32 v67, v67
M v[100:103], a[116:119], a[16:19], v[100:103]
buffer_load_dwordx4 v1, s[12:15], s25 offen offset:1024 sc1 lds
M v[104:107], a[116:119], a[32:35], v[28:31]
v_exp_f32 v80, v80
M v[104:107], a[120:123], a[36:39], v[104:107]
ds_read_b128 a[156:159], v2 offset:10240
ds_read_b128 a[160:163], v2 offset:11264
M v[104:107], a[124:127], a[40:43], v[104:107]
v_exp_f32 v81, v81
M v[104:107], a[128:131], a[44:47], v[104:107]
buffer_load_dwordx4 v1, s[12:15], s25 offen offset:2048 sc1 lds
M v[108:111], a[128:131], a[60:63], v[28:31]
v_exp_f32 v82, v82
M v[108:111], a[124:127], a[56:59], v[108:111]
v_cvt_pk_bf16_f32 v65, v66, v67
v_cvt_pk_bf16_f32 v66, v80, v81
M v[108:111], a[120:123], a[52:55], v[108:111]
v_exp_f32 v83, v83
M v[108:111], a[116:119], a[48:51], v[108:111]
buffer_load_dwordx4 v1, s[12:15], s25 offen offset:3072 sc1 lds
s_add_u32 m0, s29, 69632
s_waitcnt lgkmcnt(4)
M v[112:115], a[132:135], a[0:3], v[20:23]
v_exp_f32 v68, v68
M v[112:115], a[136:139], a[4:7], v[112:115]
ds_read_b128 a[164:167], v2 offset:12288
ds_read_b128 a[168:171], v2 offset:13312
M v[112:115], a[140:143], a[8:11], v[112:115]
v_exp_f32 v69, v69
M v[112:115], a[144:147], a[12:15], v[112:115]
buffer_load_dwordx4 v1, s[12:15], s32 offen offset:0 sc1 lds
M v[116:119], a[144:147], a[28:31], v[24:27]
v_exp_f32 v70, v70
M v[116:119], a[140:143], a[24:27], v[116:119]
v_cvt_pk_bf16_f32 v67, v82, v83
v_cvt_pk_bf16_f32 v68, v68, v69
M v[116:119], a[136:139], a[20:23], v[116:119]
v_exp_f32 v71, v71
M v[116:119], a[132:135], a[16:19], v[116:119]
buffer_load_dwordx4 v1, s[12:15], s32 offen offset:1024 sc1 lds
M v[120:123], a[132:135], a[32:35], v[28:31]
v_exp_f32 v84, v84
M v[120:123], a[136:139], a[36:39], v[120:123]
ds_read_b128 a[172:175], v2 offset:14336
ds_read_b128 a[176:179], v2 offset:15360
M v[120:123], a[140:143], a[40:43], v[120:123]
v_exp_f32 v85, v85
M v[120:123], a[144:147], a[44:47], v[120:123]
buffer_load_dwordx4 v1, s[12:15], s32 offen offset:2048 sc1 lds
M v[124:127], a[144:147], a[60:63], v[28:31]
v_exp_f32 v86, v86
M v[124:127], a[140:143], a[56:59], v[124:127]
v_cvt_pk_bf16_f32 v69, v70, v71
v_cvt_pk_bf16_f32 v70, v84, v85
M v[124:127], a[136:139], a[52:55], v[124:127]
v_exp_f32 v87, v87
M v[124:127], a[132:135], a[48:51], v[124:127]
buffer_load_dwordx4 v1, s[12:15], s32 offen offset:3072 sc1 lds
s_add_u32 m0, s29, 98304
s_waitcnt lgkmcnt(4)
M v[128:131], a[148:151], a[0:3], v[20:23]
v_exp_f32 v72, v72
M v[128:131], a[152:155], a[4:7], v[128:131]
ds_read_b128 a[116:119], v2 offset:32768
ds_read_b128 a[120:123], v2 offset:40960
M v[128:131], a[156:159], a[8:11], v[128:131]
v_exp_f32 v73, v73
M v[128:131], a[160:163], a[12:15], v[128:131]
buffer_load_dwordx4 v1, s[12:15], s26 offen offset:0 sc1 lds
s_add_u32 s43, s26, 4096
M v[132:135], a[160:163], a[28:31], v[20:23]
v_exp_f32 v74, v74
M v[132:135], a[156:159], a[24:27], v[132:135]
v_cvt_pk_bf16_f32 v71, v86, v87
v_cvt_pk_bf16_f32 v72, v72, v73
M v[132:135], a[152:155], a[20:23], v[132:135]
v_exp_f32 v75, v75
M v[132:135], a[148:151], a[16:19], v[132:135]
buffer_load_dwordx4 v1, s[12:15], s26 offen offset:1024 sc1 lds
M v[136:139], a[148:151], a[32:35], v[24:27]
v_exp_f32 v88, v88
M v[136:139], a[152:155], a[36:39], v[136:139]
ds_read_b128 a[124:127], v2 offset:33792
ds_read_b128 a[128:131], v2 offset:41984
M v[136:139], a[156:159], a[40:43], v[136:139]
v_exp_f32 v89, v89
M v[136:139], a[160:163], a[44:47], v[136:139]
buffer_load_dwordx4 v1, s[12:15], s26 offen offset:2048 sc1 lds
M v[140:143], a[160:163], a[60:63], v[28:31]
v_exp_f32 v90, v90
M v[140:143], a[156:159], a[56:59], v[140:143]
v_cvt_pk_bf16_f32 v73, v74, v75
v_cvt_pk_bf16_f32 v74, v88, v89
M v[140:143], a[152:155], a[52:55], v[140:143]
v_exp_f32 v91, v91
M v[140:143], a[148:151], a[48:51], v[140:143]
buffer_load_dwordx4 v1, s[12:15], s26 offen offset:3072 sc1 lds
s_add_u32 m0, s29, 102400
s_waitcnt lgkmcnt(4)
M v[144:147], a[164:167], a[0:3], v[20:23]
v_exp_f32 v76, v76
M v[144:147], a[168:171], a[4:7], v[144:147]
ds_read_b128 a[132:135], v2 offset:34816
ds_read_b128 a[136:139], v2 offset:43008
M v[144:147], a[172:175], a[8:11], v[144:147]
v_exp_f32 v77, v77
M v[144:147], a[176:179], a[12:15], v[144:147]
buffer_load_dwordx4 v1, s[12:15], s43 offen offset:0 sc1 lds
M v[148:151], a[176:179], a[28:31], v[20:23]
v_exp_f32 v78, v78
M v[148:151], a[172:175], a[24:27], v[148:151]
v_cvt_pk_bf16_f32 v75, v90, v91
v_cvt_pk_bf16_f32 v76, v76, v77
M v[148:151], a[168:171], a[20:23], v[148:151]
v_exp_f32 v79, v79
M v[148:151], a[164:167], a[16:19], v[148:151]
buffer_load_dwordx4 v1, s[12:15], s43 offen offset:1024 sc1 lds
M v[152:155], a[164:167], a[32:35], v[20:23]
v_exp_f32 v92, v92
M v[152:155], a[168:171], a[36:39], v[152:155]
ds_read_b128 a[140:143], v2 offset:35840
ds_read_b128 a[144:147], v2 offset:44032
M v[152:155], a[172:175], a[40:43], v[152:155]
v_exp_f32 v93, v93
M v[152:155], a[176:179], a[44:47], v[152:155]
buffer_load_dwordx4 v1, s[12:15], s43 offen offset:2048 sc1 lds
M v[156:159], a[176:179], a[60:63], v[24:27]
v_exp_f32 v94, v94
M v[156:159], a[172:175], a[56:59], v[156:159]
v_cvt_pk_bf16_f32 v77, v78, v79
v_cvt_pk_bf16_f32 v78, v92, v93
M v[156:159], a[168:171], a[52:55], v[156:159]
v_exp_f32 v95, v95
M v[156:159], a[164:167], a[48:51], v[156:159]
buffer_load_dwordx4 v1, s[12:15], s43 offen offset:3072 sc1 lds
v_cvt_pk_bf16_f32 v79, v94, v95
s_waitcnt lgkmcnt(6)
M v[160:163], a[116:119], v[32:35], v[160:163]
v_exp_f32 v96, v96
M v[160:163], a[120:123], v[64:67], v[160:163]
ds_read_b128 a[148:151], v2 offset:36864
ds_read_b128 a[152:155], v2 offset:45056
M v[164:167], a[120:123], v[68:71], v[164:167]
v_exp_f32 v97, v97
M v[164:167], a[116:119], v[36:39], v[164:167]
v_cvt_pk_bf16_f32 v96, v96, v97
M v[168:171], a[116:119], v[40:43], v[168:171]
v_exp_f32 v98, v98
M v[168:171], a[120:123], v[72:75], v[168:171]
s_add_u32 s25, s25, 32768
s_cmp_eq_u32 s25, s27
M v[172:175], a[120:123], v[76:79], v[172:175]
v_exp_f32 v99, v99
M v[172:175], a[116:119], v[44:47], v[172:175]
v_cvt_pk_bf16_f32 v97, v98, v99
s_waitcnt lgkmcnt(6)
M a[96:99], a[112:115], v[32:35], a[96:99]
s_cselect_b32 s25, s28, s25
s_cselect_b32 s27, -1, s27
M a[96:99], a[112:115], v[64:67], a[96:99]
s_add_u32 s26, s26, 32768
s_cmp_eq_u32 s26, s62
M v[176:179], a[124:127], v[32:35], v[176:179]
v_exp_f32 v112, v112
M v[176:179], a[128:131], v[64:67], v[176:179]
ds_read_b128 a[156:159], v2 offset:37888
ds_read_b128 a[160:163], v2 offset:46080
M v[180:183], a[128:131], v[68:71], v[180:183]
v_exp_f32 v113, v113
M v[180:183], a[124:127], v[36:39], v[180:183]
v_cvt_pk_bf16_f32 v98, v112, v113
M v[184:187], a[124:127], v[40:43], v[184:187]
v_exp_f32 v114, v114
M v[184:187], a[128:131], v[72:75], v[184:187]
s_cselect_b32 s26, s63, s26
s_cselect_b32 s62, -1, s62
M v[188:191], a[128:131], v[76:79], v[188:191]
v_exp_f32 v115, v115
M v[188:191], a[124:127], v[44:47], v[188:191]
v_cvt_pk_bf16_f32 v99, v114, v115
s_waitcnt lgkmcnt(6)
M a[100:103], a[112:115], v[36:39], a[100:103]
M a[100:103], a[112:115], v[68:71], a[100:103]
M v[192:195], a[132:135], v[32:35], v[192:195]
v_exp_f32 v100, v100
M v[192:195], a[136:139], v[64:67], v[192:195]
ds_read_b128 a[164:167], v2 offset:38912
ds_read_b128 a[168:171], v2 offset:47104
M v[196:199], a[136:139], v[68:71], v[196:199]
v_exp_f32 v101, v101
M v[196:199], a[132:135], v[36:39], v[196:199]
v_cvt_pk_bf16_f32 v100, v100, v101
M v[200:203], a[132:135], v[40:43], v[200:203]
v_exp_f32 v102, v102
M v[200:203], a[136:139], v[72:75], v[200:203]
M v[204:207], a[136:139], v[76:79], v[204:207]
v_exp_f32 v103, v103
M v[204:207], a[132:135], v[44:47], v[204:207]
v_cvt_pk_bf16_f32 v101, v102, v103
s_waitcnt lgkmcnt(6)
M a[104:107], a[112:115], v[40:43], a[104:107]
M a[104:107], a[112:115], v[72:75], a[104:107]
M v[208:211], a[140:143], v[32:35], v[208:211]
v_exp_f32 v116, v116
M v[208:211], a[144:147], v[64:67], v[208:211]
ds_read_b128 a[172:175], v2 offset:39936
ds_read_b128 a[176:179], v2 offset:48128
M v[212:215], a[144:147], v[68:71], v[212:215]
v_exp_f32 v117, v117
M v[212:215], a[140:143], v[36:39], v[212:215]
v_cvt_pk_bf16_f32 v102, v116, v117
M v[216:219], a[140:143], v[40:43], v[216:219]
v_exp_f32 v118, v118
M v[216:219], a[144:147], v[72:75], v[216:219]
M v[220:223], a[144:147], v[76:79], v[220:223]
v_exp_f32 v119, v119
M v[220:223], a[140:143], v[44:47], v[220:223]
v_cvt_pk_bf16_f32 v103, v118, v119
s_waitcnt lgkmcnt(6)
M a[108:111], a[112:115], v[44:47], a[108:111]
M a[108:111], a[112:115], v[76:79], a[108:111]
M v[224:227], a[148:151], v[32:35], v[224:227]
v_exp_f32 v104, v104
M v[224:227], a[152:155], v[64:67], v[224:227]
M v[228:231], a[152:155], v[68:71], v[228:231]
v_exp_f32 v105, v105
M v[228:231], a[148:151], v[36:39], v[228:231]
v_cvt_pk_bf16_f32 v104, v104, v105
M v[232:235], a[148:151], v[40:43], v[232:235]
v_exp_f32 v106, v106
M v[232:235], a[152:155], v[72:75], v[232:235]
M v[236:239], a[152:155], v[76:79], v[236:239]
v_exp_f32 v107, v107
M v[236:239], a[148:151], v[44:47], v[236:239]
v_cvt_pk_bf16_f32 v105, v106, v107
s_waitcnt lgkmcnt(4)
M v[240:243], a[156:159], v[32:35], v[240:243]
v_exp_f32 v120, v120
M v[240:243], a[160:163], v[64:67], v[240:243]
M v[244:247], a[160:163], v[68:71], v[244:247]
v_exp_f32 v121, v121
M v[244:247], a[156:159], v[36:39], v[244:247]
v_cvt_pk_bf16_f32 v106, v120, v121
M v[248:251], a[156:159], v[40:43], v[248:251]
v_exp_f32 v122, v122
M v[248:251], a[160:163], v[72:75], v[248:251]
s_waitcnt vmcnt(0) lgkmcnt(0)
s_barrier
ds_read_b128 a[116:119], v3 offset:0
ds_read_b128 a[120:123], v3 offset:1024
M v[252:255], a[160:163], v[76:79], v[252:255]
v_exp_f32 v123, v123
M v[252:255], a[156:159], v[44:47], v[252:255]
v_cvt_pk_bf16_f32 v107, v122, v123
M a[64:67], a[164:167], v[32:35], a[64:67]
v_exp_f32 v108, v108
M a[64:67], a[168:171], v[64:67], a[64:67]
ds_read_b128 a[124:127], v3 offset:2048
ds_read_b128 a[128:131], v3 offset:3072
M a[68:71], a[168:171], v[68:71], a[68:71]
v_exp_f32 v109, v109
M a[68:71], a[164:167], v[36:39], a[68:71]
v_cvt_pk_bf16_f32 v108, v108, v109
M a[72:75], a[164:167], v[40:43], a[72:75]
v_exp_f32 v110, v110
M a[72:75], a[168:171], v[72:75], a[72:75]
ds_read_b128 a[132:135], v3 offset:4096
ds_read_b128 a[136:139], v3 offset:5120
M a[76:79], a[168:171], v[76:79], a[76:79]
v_exp_f32 v111, v111
M a[76:79], a[164:167], v[44:47], a[76:79]
v_cvt_pk_bf16_f32 v109, v110, v111
M a[80:83], a[172:175], v[32:35], a[80:83]
v_exp_f32 v124, v124
M a[80:83], a[176:179], v[64:67], a[80:83]
ds_read_b128 a[140:143], v3 offset:6144
ds_read_b128 a[144:147], v3 offset:7168
M a[84:87], a[176:179], v[68:71], a[84:87]
v_exp_f32 v125, v125
M a[84:87], a[172:175], v[36:39], a[84:87]
v_cvt_pk_bf16_f32 v110, v124, v125
M a[88:91], a[172:175], v[40:43], a[88:91]
v_exp_f32 v126, v126
M a[88:91], a[176:179], v[72:75], a[88:91]
M a[92:95], a[176:179], v[76:79], a[92:95]
v_exp_f32 v127, v127
M a[92:95], a[172:175], v[44:47], a[92:95]
v_cvt_pk_bf16_f32 v111, v126, v127
s_lshl_b32 s33, s23, 6
s_add_i32 s33, s33, -64
s_cmp_gt_i32 s33, 0
s_cselect_b32 s34, 0, 0xf149f2ca
s_cmp_lt_i32 s33, 0
s_cselect_b32 s33, 0xf149f2ca, 0
v_mov_b32 v20, s34
v_mov_b32 v21, s34
v_mov_b32 v22, s34
v_mov_b32 v23, s34
v_mov_b32 v28, s33
v_mov_b32 v29, s33
v_mov_b32 v30, s33
v_mov_b32 v31, s33
v_med3_f32 v24, v16, v20, v28
v_med3_f32 v25, v17, v20, v28
v_med3_f32 v26, v18, v20, v28
v_med3_f32 v27, v19, v20, v28
s_add_u32 m0, s29, 0
s_waitcnt lgkmcnt(4)
M v[32:35], a[116:119], a[0:3], v[24:27]
v_exp_f32 v128, v128
M v[32:35], a[120:123], a[4:7], v[32:35]
ds_read_b128 a[148:151], v3 offset:8192
ds_read_b128 a[152:155], v3 offset:9216
M v[32:35], a[124:127], a[8:11], v[32:35]
v_exp_f32 v129, v129
M v[32:35], a[128:131], a[12:15], v[32:35]
buffer_load_dwordx4 v1, s[12:15], s25 offen offset:0 sc1 lds
s_add_u32 s32, s25, 4096
M v[36:39], a[128:131], a[28:31], v[28:31]
v_exp_f32 v130, v130
M v[36:39], a[124:127], a[24:27], v[36:39]
v_cvt_pk_bf16_f32 v128, v128, v129
M v[36:39], a[120:123], a[20:23], v[36:39]
v_exp_f32 v131, v131
M v[36:39], a[116:119], a[16:19], v[36:39]
buffer_load_dwordx4 v1, s[12:15], s25 offen offset:1024 sc1 lds
M v[40:43], a[116:119], a[32:35], v[28:31]
v_exp_f32 v144, v144
M v[40:43], a[120:123], a[36:39], v[40:43]
ds_read_b128 a[156:159], v3 offset:10240
ds_read_b128 a[160:163], v3 offset:11264
M v[40:43], a[124:127], a[40:43], v[40:43]
v_exp_f32 v145, v145
M v[40:43], a[128:131], a[44:47], v[40:43]
buffer_load_dwordx4 v1, s[12:15], s25 offen offset:2048 sc1 lds
M v[44:47], a[128:131], a[60:63], v[28:31]
v_exp_f32 v146, v146
M v[44:47], a[124:127], a[56:59], v[44:47]
v_cvt_pk_bf16_f32 v129, v130, v131
v_cvt_pk_bf16_f32 v130, v144, v145
M v[44:47], a[120:123], a[52:55], v[44:47]
v_exp_f32 v147, v147
M v[44:47], a[116:119], a[48:51], v[44:47]
buffer_load_dwordx4 v1, s[12:15], s25 offen offset:3072 sc1 lds
s_add_u32 m0, s29, 4096
s_waitcnt lgkmcnt(4)
M v[48:51], a[132:135], a[0:3], v[20:23]
v_exp_f32 v132, v132
M v[48:51], a[136:139], a[4:7], v[48:51]
ds_read_b128 a[164:167], v3 offset:12288
ds_read_b128 a[168:171], v3 offset:13312
M v[48:51], a[140:143], a[8:11], v[48:51]
v_exp_f32 v133, v133
M v[48:51], a[144:147], a[12:15], v[48:51]
buffer_load_dwordx4 v1, s[12:15], s32 offen offset:0 sc1 lds
M v[52:55], a[144:147], a[28:31], v[24:27]
v_exp_f32 v134, v134
M v[52:55], a[140:143], a[24:27], v[52:55]
v_cvt_pk_bf16_f32 v131, v146, v147
v_cvt_pk_bf16_f32 v132, v132, v133
M v[52:55], a[136:139], a[20:23], v[52:55]
v_exp_f32 v135, v135
M v[52:55], a[132:135], a[16:19], v[52:55]
buffer_load_dwordx4 v1, s[12:15], s32 offen offset:1024 sc1 lds
M v[56:59], a[132:135], a[32:35], v[28:31]
v_exp_f32 v148, v148
M v[56:59], a[136:139], a[36:39], v[56:59]
ds_read_b128 a[172:175], v3 offset:14336
ds_read_b128 a[176:179], v3 offset:15360
M v[56:59], a[140:143], a[40:43], v[56:59]
v_exp_f32 v149, v149
M v[56:59], a[144:147], a[44:47], v[56:59]
buffer_load_dwordx4 v1, s[12:15], s32 offen offset:2048 sc1 lds
M v[60:63], a[144:147], a[60:63], v[28:31]
v_exp_f32 v150, v150
M v[60:63], a[140:143], a[56:59], v[60:63]
v_cvt_pk_bf16_f32 v133, v134, v135
v_cvt_pk_bf16_f32 v134, v148, v149
M v[60:63], a[136:139], a[52:55], v[60:63]
v_exp_f32 v151, v151
M v[60:63], a[132:135], a[48:51], v[60:63]
buffer_load_dwordx4 v1, s[12:15], s32 offen offset:3072 sc1 lds
s_add_u32 m0, s29, 32768
s_waitcnt lgkmcnt(4)
M v[64:67], a[148:151], a[0:3], v[20:23]
v_exp_f32 v136, v136
M v[64:67], a[152:155], a[4:7], v[64:67]
ds_read_b128 a[116:119], v3 offset:32768
ds_read_b128 a[120:123], v3 offset:40960
M v[64:67], a[156:159], a[8:11], v[64:67]
v_exp_f32 v137, v137
M v[64:67], a[160:163], a[12:15], v[64:67]
buffer_load_dwordx4 v1, s[12:15], s26 offen offset:0 sc1 lds
s_add_u32 s43, s26, 4096
M v[68:71], a[160:163], a[28:31], v[20:23]
v_exp_f32 v138, v138
M v[68:71], a[156:159], a[24:27], v[68:71]
v_cvt_pk_bf16_f32 v135, v150, v151
v_cvt_pk_bf16_f32 v136, v136, v137
M v[68:71], a[152:155], a[20:23], v[68:71]
v_exp_f32 v139, v139
M v[68:71], a[148:151], a[16:19], v[68:71]
buffer_load_dwordx4 v1, s[12:15], s26 offen offset:1024 sc1 lds
M v[72:75], a[148:151], a[32:35], v[24:27]
v_exp_f32 v152, v152
M v[72:75], a[152:155], a[36:39], v[72:75]
ds_read_b128 a[124:127], v3 offset:33792
ds_read_b128 a[128:131], v3 offset:41984
M v[72:75], a[156:159], a[40:43], v[72:75]
v_exp_f32 v153, v153
M v[72:75], a[160:163], a[44:47], v[72:75]
buffer_load_dwordx4 v1, s[12:15], s26 offen offset:2048 sc1 lds
M v[76:79], a[160:163], a[60:63], v[28:31]
v_exp_f32 v154, v154
M v[76:79], a[156:159], a[56:59], v[76:79]
v_cvt_pk_bf16_f32 v137, v138, v139
v_cvt_pk_bf16_f32 v138, v152, v153
M v[76:79], a[152:155], a[52:55], v[76:79]
v_exp_f32 v155, v155
M v[76:79], a[148:151], a[48:51], v[76:79]
buffer_load_dwordx4 v1, s[12:15], s26 offen offset:3072 sc1 lds
s_add_u32 m0, s29, 36864
s_waitcnt lgkmcnt(4)
M v[80:83], a[164:167], a[0:3], v[20:23]
v_exp_f32 v140, v140
M v[80:83], a[168:171], a[4:7], v[80:83]
ds_read_b128 a[132:135], v3 offset:34816
ds_read_b128 a[136:139], v3 offset:43008
M v[80:83], a[172:175], a[8:11], v[80:83]
v_exp_f32 v141, v141
M v[80:83], a[176:179], a[12:15], v[80:83]
buffer_load_dwordx4 v1, s[12:15], s43 offen offset:0 sc1 lds
M v[84:87], a[176:179], a[28:31], v[20:23]
v_exp_f32 v142, v142
M v[84:87], a[172:175], a[24:27], v[84:87]
v_cvt_pk_bf16_f32 v139, v154, v155
v_cvt_pk_bf16_f32 v140, v140, v141
M v[84:87], a[168:171], a[20:23], v[84:87]
v_exp_f32 v143, v143
M v[84:87], a[164:167], a[16:19], v[84:87]
buffer_load_dwordx4 v1, s[12:15], s43 offen offset:1024 sc1 lds
M v[88:91], a[164:167], a[32:35], v[20:23]
v_exp_f32 v156, v156
M v[88:91], a[168:171], a[36:39], v[88:91]
ds_read_b128 a[140:143], v3 offset:35840
ds_read_b128 a[144:147], v3 offset:44032
M v[88:91], a[172:175], a[40:43], v[88:91]
v_exp_f32 v157, v157
M v[88:91], a[176:179], a[44:47], v[88:91]
buffer_load_dwordx4 v1, s[12:15], s43 offen offset:2048 sc1 lds
M v[92:95], a[176:179], a[60:63], v[24:27]
v_exp_f32 v158, v158
M v[92:95], a[172:175], a[56:59], v[92:95]
v_cvt_pk_bf16_f32 v141, v142, v143
v_cvt_pk_bf16_f32 v142, v156, v157
M v[92:95], a[168:171], a[52:55], v[92:95]
v_exp_f32 v159, v159
M v[92:95], a[164:167], a[48:51], v[92:95]
buffer_load_dwordx4 v1, s[12:15], s43 offen offset:3072 sc1 lds
v_cvt_pk_bf16_f32 v143, v158, v159
s_waitcnt lgkmcnt(6)
M v[160:163], a[116:119], v[96:99], v[160:163]
v_exp_f32 v32, v32
M v[160:163], a[120:123], v[128:131], v[160:163]
ds_read_b128 a[148:151], v3 offset:36864
ds_read_b128 a[152:155], v3 offset:45056
M v[164:167], a[120:123], v[132:135], v[164:167]
v_exp_f32 v33, v33
M v[164:167], a[116:119], v[100:103], v[164:167]
v_cvt_pk_bf16_f32 v32, v32, v33
M v[168:171], a[116:119], v[104:107], v[168:171]
v_exp_f32 v34, v34
M v[168:171], a[120:123], v[136:139], v[168:171]
s_add_u32 s25, s25, 32768
s_cmp_eq_u32 s25, s27
M v[172:175], a[120:123], v[140:143], v[172:175]
v_exp_f32 v35, v35
M v[172:175], a[116:119], v[108:111], v[172:175]
v_cvt_pk_bf16_f32 v33, v34, v35
s_waitcnt lgkmcnt(6)
M a[96:99], a[112:115], v[96:99], a[96:99]
s_cselect_b32 s25, s28, s25
s_cselect_b32 s27, -1, s27
M a[96:99], a[112:115], v[128:131], a[96:99]
s_add_u32 s26, s26, 32768
s_cmp_eq_u32 s26, s62
M v[176:179], a[124:127], v[96:99], v[176:179]
v_exp_f32 v48, v48
M v[176:179], a[128:131], v[128:131], v[176:179]
ds_read_b128 a[156:159], v3 offset:37888
ds_read_b128 a[160:163], v3 offset:46080
M v[180:183], a[128:131], v[132:135], v[180:183]
v_exp_f32 v49, v49
M v[180:183], a[124:127], v[100:103], v[180:183]
v_cvt_pk_bf16_f32 v34, v48, v49
M v[184:187], a[124:127], v[104:107], v[184:187]
v_exp_f32 v50, v50
M v[184:187], a[128:131], v[136:139], v[184:187]
s_cselect_b32 s26, s63, s26
s_cselect_b32 s62, -1, s62
M v[188:191], a[128:131], v[140:143], v[188:191]
v_exp_f32 v51, v51
M v[188:191], a[124:127], v[108:111], v[188:191]
v_cvt_pk_bf16_f32 v35, v50, v51
s_waitcnt lgkmcnt(6)
M a[100:103], a[112:115], v[100:103], a[100:103]
M a[100:103], a[112:115], v[132:135], a[100:103]
M v[192:195], a[132:135], v[96:99], v[192:195]
v_exp_f32 v36, v36
M v[192:195], a[136:139], v[128:131], v[192:195]
ds_read_b128 a[164:167], v3 offset:38912
ds_read_b128 a[168:171], v3 offset:47104
M v[196:199], a[136:139], v[132:135], v[196:199]
v_exp_f32 v37, v37
M v[196:199], a[132:135], v[100:103], v[196:199]
v_cvt_pk_bf16_f32 v36, v36, v37
M v[200:203], a[132:135], v[104:107], v[200:203]
v_exp_f32 v38, v38
M v[200:203], a[136:139], v[136:139], v[200:203]
M v[204:207], a[136:139], v[140:143], v[204:207]
v_exp_f32 v39, v39
M v[204:207], a[132:135], v[108:111], v[204:207]
v_cvt_pk_bf16_f32 v37, v38, v39
s_waitcnt lgkmcnt(6)
M a[104:107], a[112:115], v[104:107], a[104:107]
M a[104:107], a[112:115], v[136:139], a[104:107]
M v[208:211], a[140:143], v[96:99], v[208:211]
v_exp_f32 v52, v52
M v[208:211], a[144:147], v[128:131], v[208:211]
ds_read_b128 a[172:175], v3 offset:39936
ds_read_b128 a[176:179], v3 offset:48128
M v[212:215], a[144:147], v[132:135], v[212:215]
v_exp_f32 v53, v53
M v[212:215], a[140:143], v[100:103], v[212:215]
v_cvt_pk_bf16_f32 v38, v52, v53
M v[216:219], a[140:143], v[104:107], v[216:219]
v_exp_f32 v54, v54
M v[216:219], a[144:147], v[136:139], v[216:219]
M v[220:223], a[144:147], v[140:143], v[220:223]
v_exp_f32 v55, v55
M v[220:223], a[140:143], v[108:111], v[220:223]
v_cvt_pk_bf16_f32 v39, v54, v55
s_waitcnt lgkmcnt(6)
M a[108:111], a[112:115], v[108:111], a[108:111]
M a[108:111], a[112:115], v[140:143], a[108:111]
M v[224:227], a[148:151], v[96:99], v[224:227]
v_exp_f32 v40, v40
M v[224:227], a[152:155], v[128:131], v[224:227]
M v[228:231], a[152:155], v[132:135], v[228:231]
v_exp_f32 v41, v41
M v[228:231], a[148:151], v[100:103], v[228:231]
v_cvt_pk_bf16_f32 v40, v40, v41
M v[232:235], a[148:151], v[104:107], v[232:235]
v_exp_f32 v42, v42
M v[232:235], a[152:155], v[136:139], v[232:235]
M v[236:239], a[152:155], v[140:143], v[236:239]
v_exp_f32 v43, v43
M v[236:239], a[148:151], v[108:111], v[236:239]
v_cvt_pk_bf16_f32 v41, v42, v43
s_waitcnt lgkmcnt(4)
M v[240:243], a[156:159], v[96:99], v[240:243]
v_exp_f32 v56, v56
M v[240:243], a[160:163], v[128:131], v[240:243]
M v[244:247], a[160:163], v[132:135], v[244:247]
v_exp_f32 v57, v57
M v[244:247], a[156:159], v[100:103], v[244:247]
v_cvt_pk_bf16_f32 v42, v56, v57
M v[248:251], a[156:159], v[104:107], v[248:251]
v_exp_f32 v58, v58
M v[248:251], a[160:163], v[136:139], v[248:251]
s_waitcnt vmcnt(0) lgkmcnt(0)
s_barrier
ds_read_b128 a[116:119], v2 offset:0
ds_read_b128 a[120:123], v2 offset:1024
M v[252:255], a[160:163], v[140:143], v[252:255]
v_exp_f32 v59, v59
M v[252:255], a[156:159], v[108:111], v[252:255]
v_cvt_pk_bf16_f32 v43, v58, v59
M a[64:67], a[164:167], v[96:99], a[64:67]
v_exp_f32 v44, v44
M a[64:67], a[168:171], v[128:131], a[64:67]
ds_read_b128 a[124:127], v2 offset:2048
ds_read_b128 a[128:131], v2 offset:3072
M a[68:71], a[168:171], v[132:135], a[68:71]
v_exp_f32 v45, v45
M a[68:71], a[164:167], v[100:103], a[68:71]
v_cvt_pk_bf16_f32 v44, v44, v45
M a[72:75], a[164:167], v[104:107], a[72:75]
v_exp_f32 v46, v46
M a[72:75], a[168:171], v[136:139], a[72:75]
ds_read_b128 a[132:135], v2 offset:4096
ds_read_b128 a[136:139], v2 offset:5120
M a[76:79], a[168:171], v[140:143], a[76:79]
v_exp_f32 v47, v47
M a[76:79], a[164:167], v[108:111], a[76:79]
v_cvt_pk_bf16_f32 v45, v46, v47
M a[80:83], a[172:175], v[96:99], a[80:83]
v_exp_f32 v60, v60
M a[80:83], a[176:179], v[128:131], a[80:83]
ds_read_b128 a[140:143], v2 offset:6144
ds_read_b128 a[144:147], v2 offset:7168
M a[84:87], a[176:179], v[132:135], a[84:87]
v_exp_f32 v61, v61
M a[84:87], a[172:175], v[100:103], a[84:87]
v_cvt_pk_bf16_f32 v46, v60, v61
M a[88:91], a[172:175], v[104:107], a[88:91]
v_exp_f32 v62, v62
M a[88:91], a[176:179], v[136:139], a[88:91]
M a[92:95], a[176:179], v[140:143], a[92:95]
v_exp_f32 v63, v63
M a[92:95], a[172:175], v[108:111], a[92:95]
v_cvt_pk_bf16_f32 v47, v62, v63
s_waitcnt lgkmcnt(0)
Lk2_fin:
s_and_b32 s3, s2, 3
s_lshl_b32 s3, s3, 2
s_bfe_u32 s27, s2, 0x20003
s_add_u32 s27, s3, s27
s_lshl_b32 s43, s27, 8
s_add_u32 s43, s43, 8400896
v_lshlrev_b32 v15, 2, v0
buffer_load_dword v7, v15, s[52:55], s43 offen sc1
ds_read_b128 a[116:119], v2 offset:32768
ds_read_b128 a[120:123], v2 offset:40960
ds_read_b128 a[124:127], v2 offset:33792
ds_read_b128 a[128:131], v2 offset:41984
ds_read_b128 a[132:135], v2 offset:34816
ds_read_b128 a[136:139], v2 offset:43008
ds_read_b128 a[140:143], v2 offset:35840
ds_read_b128 a[144:147], v2 offset:44032
v_exp_f32 v64, v64
v_exp_f32 v65, v65
v_exp_f32 v66, v66
v_exp_f32 v67, v67
v_exp_f32 v80, v80
v_exp_f32 v81, v81
v_exp_f32 v82, v82
v_exp_f32 v83, v83
v_cvt_pk_bf16_f32 v64, v64, v65
v_cvt_pk_bf16_f32 v65, v66, v67
v_exp_f32 v68, v68
v_exp_f32 v69, v69
v_exp_f32 v70, v70
v_exp_f32 v71, v71
v_cvt_pk_bf16_f32 v66, v80, v81
v_cvt_pk_bf16_f32 v67, v82, v83
v_exp_f32 v84, v84
v_exp_f32 v85, v85
v_exp_f32 v86, v86
v_exp_f32 v87, v87
v_cvt_pk_bf16_f32 v68, v68, v69
v_cvt_pk_bf16_f32 v69, v70, v71
v_exp_f32 v72, v72
v_exp_f32 v73, v73
v_exp_f32 v74, v74
v_exp_f32 v75, v75
v_cvt_pk_bf16_f32 v70, v84, v85
v_cvt_pk_bf16_f32 v71, v86, v87
v_exp_f32 v88, v88
v_exp_f32 v89, v89
v_exp_f32 v90, v90
v_exp_f32 v91, v91
v_cvt_pk_bf16_f32 v72, v72, v73
v_cvt_pk_bf16_f32 v73, v74, v75
v_exp_f32 v76, v76
v_exp_f32 v77, v77
v_exp_f32 v78, v78
v_exp_f32 v79, v79
v_cvt_pk_bf16_f32 v74, v88, v89
v_cvt_pk_bf16_f32 v75, v90, v91
v_exp_f32 v92, v92
v_exp_f32 v93, v93
v_exp_f32 v94, v94
v_exp_f32 v95, v95
v_cvt_pk_bf16_f32 v76, v76, v77
v_cvt_pk_bf16_f32 v77, v78, v79
v_cvt_pk_bf16_f32 v78, v92, v93
v_cvt_pk_bf16_f32 v79, v94, v95
s_waitcnt lgkmcnt(6)
M v[160:163], a[116:119], v[32:35], v[160:163]
M v[160:163], a[120:123], v[64:67], v[160:163]
ds_read_b128 a[148:151], v2 offset:36864
ds_read_b128 a[152:155], v2 offset:45056
s_mov_b32 s61, 0
M v[164:167], a[120:123], v[68:71], v[164:167]
M v[164:167], a[116:119], v[36:39], v[164:167]
s_bfe_u32 s3, s2, 0x10002
M v[168:171], a[116:119], v[40:43], v[168:171]
M v[168:171], a[120:123], v[72:75], v[168:171]
s_lshl_b32 s3, s3, 3
M v[172:175], a[120:123], v[76:79], v[172:175]
M v[172:175], a[116:119], v[44:47], v[172:175]
s_waitcnt lgkmcnt(6)
s_lshr_b32 s28, s2, 5
M a[96:99], a[112:115], v[32:35], a[96:99]
M a[96:99], a[112:115], v[64:67], a[96:99]
M v[176:179], a[124:127], v[32:35], v[176:179]
M v[176:179], a[128:131], v[64:67], v[176:179]
ds_read_b128 a[156:159], v2 offset:37888
ds_read_b128 a[160:163], v2 offset:46080
s_add_u32 s28, s3, s28
M v[180:183], a[128:131], v[68:71], v[180:183]
s_lshl_b32 s25, s27, 18
M v[180:183], a[124:127], v[36:39], v[180:183]
M v[184:187], a[124:127], v[40:43], v[184:187]
s_lshl_b32 s3, s101, 12
M v[184:187], a[128:131], v[72:75], v[184:187]
M v[188:191], a[128:131], v[76:79], v[188:191]
s_add_u32 s25, s25, s3
M v[188:191], a[124:127], v[44:47], v[188:191]
s_waitcnt lgkmcnt(6)
M a[100:103], a[112:115], v[36:39], a[100:103]
M a[100:103], a[112:115], v[68:71], a[100:103]
M v[192:195], a[132:135], v[32:35], v[192:195]
s_lshl_b32 s26, s28, 7
M v[192:195], a[136:139], v[64:67], v[192:195]
ds_read_b128 a[164:167], v2 offset:38912
ds_read_b128 a[168:171], v2 offset:47104
M v[196:199], a[136:139], v[68:71], v[196:199]
s_lshl_b32 s42, s101, 11
M v[196:199], a[132:135], v[36:39], v[196:199]
M v[200:203], a[132:135], v[40:43], v[200:203]
s_add_u32 s44, s4, 83886080
s_addc_u32 s45, s5, 0
M v[200:203], a[136:139], v[72:75], v[200:203]
s_mov_b32 s46, 4194304
M v[204:207], a[136:139], v[76:79], v[204:207]
M v[204:207], a[132:135], v[44:47], v[204:207]
s_waitcnt lgkmcnt(6)
s_mov_b32 s47, 0x00020000
M a[104:107], a[112:115], v[40:43], a[104:107]
M a[104:107], a[112:115], v[72:75], a[104:107]
M v[208:211], a[140:143], v[32:35], v[208:211]
M v[208:211], a[144:147], v[64:67], v[208:211]
ds_read_b128 a[172:175], v2 offset:39936
ds_read_b128 a[176:179], v2 offset:48128
s_mov_b32 s50, 2097152
M v[212:215], a[144:147], v[68:71], v[212:215]
M v[212:215], a[140:143], v[36:39], v[212:215]
s_mov_b32 s51, 0x00020000
M v[216:219], a[140:143], v[40:43], v[216:219]
M v[216:219], a[144:147], v[72:75], v[216:219]
s_lshl_b32 s3, s101, 4
M v[220:223], a[144:147], v[76:79], v[220:223]
M v[220:223], a[140:143], v[44:47], v[220:223]
s_waitcnt lgkmcnt(6)
v_lshrrev_b32 v96, 3, v0
M a[108:111], a[112:115], v[44:47], a[108:111]
M a[108:111], a[112:115], v[76:79], a[108:111]
M v[224:227], a[148:151], v[32:35], v[224:227]
v_and_b32 v97, 6, v96
M v[224:227], a[152:155], v[64:67], v[224:227]
M v[228:231], a[152:155], v[68:71], v[228:231]
v_and_b32 v98, 7, v0
M v[228:231], a[148:151], v[36:39], v[228:231]
M v[232:235], a[148:151], v[40:43], v[232:235]
v_xor_b32 v97, v97, v98
M v[232:235], a[152:155], v[72:75], v[232:235]
M v[236:239], a[152:155], v[76:79], v[236:239]
v_add_u32 v96, s3, v96
M v[236:239], a[148:151], v[44:47], v[236:239]
s_waitcnt lgkmcnt(4)
M v[240:243], a[156:159], v[32:35], v[240:243]
v_lshlrev_b32 v96, 11, v96
M v[240:243], a[160:163], v[64:67], v[240:243]
M v[244:247], a[160:163], v[68:71], v[244:247]
v_lshl_add_u32 v99, v97, 4, v96
M v[244:247], a[156:159], v[36:39], v[244:247]
v_add_u32 v100, 15360, v99
M v[248:251], a[156:159], v[40:43], v[248:251]
M v[248:251], a[160:163], v[72:75], v[248:251]
s_waitcnt vmcnt(0) lgkmcnt(0)
s_barrier
v_cmp_ne_u32 vcc, 1, v7
s_nop 0
s_cbranch_vccnz Lk3_spinb0
Lk3_gotb0:
M v[252:255], a[160:163], v[76:79], v[252:255]
s_add_u32 m0, s42, 65536
s_nop 0
buffer_load_dwordx4 v99, s[48:51], s26 offen offset:0 lds
buffer_load_dwordx4 v100, s[48:51], s26 offen offset:1024 lds
M v[252:255], a[156:159], v[44:47], v[252:255]
buffer_load_dwordx4 a[192:195], v1, s[44:47], s25 offen offset:0 sc1
buffer_load_dwordx4 a[196:199], v1, s[44:47], s25 offen offset:1024 sc1
M a[64:67], a[164:167], v[32:35], a[64:67]
buffer_load_dwordx4 a[200:203], v1, s[44:47], s25 offen offset:2048 sc1
buffer_load_dwordx4 a[204:207], v1, s[44:47], s25 offen offset:3072 sc1
M a[64:67], a[168:171], v[64:67], a[64:67]
s_add_u32 s25, s25, 16384
s_add_u32 s26, s26, 131072
s_add_u32 m0, s42, 81920
s_nop 0
buffer_load_dwordx4 v99, s[48:51], s26 offen offset:0 lds
M a[68:71], a[168:171], v[68:71], a[68:71]
buffer_load_dwordx4 v100, s[48:51], s26 offen offset:1024 lds
buffer_load_dwordx4 a[208:211], v1, s[44:47], s25 offen offset:0 sc1
M a[68:71], a[164:167], v[36:39], a[68:71]
buffer_load_dwordx4 a[212:215], v1, s[44:47], s25 offen offset:1024 sc1
buffer_load_dwordx4 a[216:219], v1, s[44:47], s25 offen offset:2048 sc1
M a[72:75], a[164:167], v[40:43], a[72:75]
buffer_load_dwordx4 a[220:223], v1, s[44:47], s25 offen offset:3072 sc1
s_add_u32 s25, s25, 16384
s_add_u32 s26, s26, 131072
M a[72:75], a[168:171], v[72:75], a[72:75]
s_add_u32 m0, s42, 98304
s_nop 0
buffer_load_dwordx4 v99, s[48:51], s26 offen offset:0 lds
buffer_load_dwordx4 v100, s[48:51], s26 offen offset:1024 lds
M a[76:79], a[168:171], v[76:79], a[76:79]
buffer_load_dwordx4 a[224:227], v1, s[44:47], s25 offen offset:0 sc1
M a[76:79], a[164:167], v[44:47], a[76:79]
buffer_load_dwordx4 a[228:231], v1, s[44:47], s25 offen offset:1024 sc1
buffer_load_dwordx4 a[232:235], v1, s[44:47], s25 offen offset:2048 sc1
M a[80:83], a[172:175], v[32:35], a[80:83]
buffer_load_dwordx4 a[236:239], v1, s[44:47], s25 offen offset:3072 sc1
s_add_u32 s25, s25, 16384
s_add_u32 s26, s26, 131072
M a[80:83], a[176:179], v[64:67], a[80:83]
s_add_u32 m0, s42, 114688
s_nop 0
buffer_load_dwordx4 v99, s[48:51], s26 offen offset:0 lds
buffer_load_dwordx4 v100, s[48:51], s26 offen offset:1024 lds
M a[84:87], a[176:179], v[68:71], a[84:87]
buffer_load_dwordx4 a[240:243], v1, s[44:47], s25 offen offset:0 sc1
buffer_load_dwordx4 a[244:247], v1, s[44:47], s25 offen offset:1024 sc1
M a[84:87], a[172:175], v[36:39], a[84:87]
buffer_load_dwordx4 a[248:251], v1, s[44:47], s25 offen offset:2048 sc1
buffer_load_dwordx4 a[252:255], v1, s[44:47], s25 offen offset:3072 sc1
M a[88:91], a[172:175], v[40:43], a[88:91]
s_add_u32 s25, s25, 16384
s_add_u32 s26, s26, 131072
s_add_u32 m0, s42, 0
s_nop 0
buffer_load_dwordx4 v99, s[48:51], s26 offen offset:0 lds
M a[88:91], a[176:179], v[72:75], a[88:91]
buffer_load_dwordx4 v100, s[48:51], s26 offen offset:1024 lds
buffer_load_dwordx4 a[128:131], v1, s[44:47], s25 offen offset:0 sc1
M a[92:95], a[176:179], v[76:79], a[92:95]
buffer_load_dwordx4 a[132:135], v1, s[44:47], s25 offen offset:1024 sc1
buffer_load_dwordx4 a[136:139], v1, s[44:47], s25 offen offset:2048 sc1
M a[92:95], a[172:175], v[44:47], a[92:95]
buffer_load_dwordx4 a[140:143], v1, s[44:47], s25 offen offset:3072 sc1
s_add_u32 s25, s25, 16384
s_add_u32 s26, s26, 131072
Lk2_merge:
s_lshl_b32 s33, s23, 14
s_add_u32 s34, s33, 131072
s_add_u32 s33, s33, 32768
s_cmp_eq_u32 s24, 0
s_cselect_b32 s35, s34, s33
s_cselect_b32 s36, s33, s34
v_add_u32 v2, s35, v1
v_add_u32 v3, s36, v1
s_lshl_b32 s33, s22, 10
s_add_u32 s33, s33, 28672
s_xor_b32 s34, s33, 2048
v_add_u32 v14, s33, v1
v_add_u32 v15, s34, v1
v_accvgpr_read_b32 v20, a96
v_accvgpr_read_b32 v21, a100
v_accvgpr_read_b32 v22, a104
v_accvgpr_read_b32 v23, a108
ds_write_b128 v14, v[20:23]
s_cmp_eq_u32 s24, 1
s_waitcnt lgkmcnt(0)
s_cbranch_scc1 Lk2_mg1
ds_write_b128 v2, v[224:227] offset:0
ds_write_b128 v2, v[228:231] offset:1024
ds_write_b128 v2, v[232:235] offset:2048
ds_write_b128 v2, v[236:239] offset:3072
ds_write_b128 v2, v[240:243] offset:4096
ds_write_b128 v2, v[244:247] offset:5120
ds_write_b128 v2, v[248:251] offset:6144
ds_write_b128 v2, v[252:255] offset:7168
ds_write_b128 v2, a[64:67] offset:8192
ds_write_b128 v2, a[68:71] offset:9216
ds_write_b128 v2, a[72:75] offset:10240
ds_write_b128 v2, a[76:79] offset:11264
ds_write_b128 v2, a[80:83] offset:12288
ds_write_b128 v2, a[84:87] offset:13312
ds_write_b128 v2, a[88:91] offset:14336
ds_write_b128 v2, a[92:95] offset:15360
s_waitcnt lgkmcnt(0)
s_barrier
ds_read_b128 v[28:31], v15
ds_read_b128 v[32:35], v3 offset:0
ds_read_b128 v[36:39], v3 offset:1024
ds_read_b128 v[40:43], v3 offset:2048
ds_read_b128 v[44:47], v3 offset:3072
ds_read_b128 v[48:51], v3 offset:4096
ds_read_b128 v[52:55], v3 offset:5120
ds_read_b128 v[56:59], v3 offset:6144
ds_read_b128 v[60:63], v3 offset:7168
ds_read_b128 v[64:67], v3 offset:8192
ds_read_b128 v[68:71], v3 offset:9216
ds_read_b128 v[72:75], v3 offset:10240
ds_read_b128 v[76:79], v3 offset:11264
ds_read_b128 v[80:83], v3 offset:12288
ds_read_b128 v[84:87], v3 offset:13312
ds_read_b128 v[88:91], v3 offset:14336
ds_read_b128 v[92:95], v3 offset:15360
s_waitcnt lgkmcnt(15)
v_add_f32 v20, v20, v28
v_add_f32 v21, v21, v29
v_add_f32 v22, v22, v30
v_add_f32 v23, v23, v31
s_sub_u32 s35, 15, s21
v_rcp_f32 v8, v20
v_rcp_f32 v9, v21
v_rcp_f32 v10, v22
v_rcp_f32 v11, v23
v_subrev_u32 v20, 0x21800000, v20
v_subrev_u32 v21, 0x21800000, v21
v_subrev_u32 v22, 0x21800000, v22
v_subrev_u32 v23, 0x21800000, v23
v_max_u32 v12, v20, v21
v_max3_u32 v12, v12, v22, v23
s_mov_b32 s64, 0x207
s_lshl_b32 s33, s35, 20
s_lshl_b32 s34, s20, 15
s_add_u32 s33, s33, s34
s_lshl_b32 s34, s23, 13
s_add_u32 s36, s33, s34
s_add_u32 s37, s36, 4096
s_add_u32 s38, s36, 16384
s_add_u32 s39, s36, 20480
v_pk_add_f32 v[160:161], v[160:161], v[32:33]
v_pk_add_f32 v[162:163], v[162:163], v[34:35]
s_waitcnt lgkmcnt(11)
v_pk_add_f32 v[176:177], v[176:177], v[48:49]
v_pk_add_f32 v[178:179], v[178:179], v[50:51]
v_pk_mul_f32 v[160:161], v[160:161], v[8:9] op_sel:[0,0] op_sel_hi:[1,0]
v_pk_mul_f32 v[162:163], v[162:163], v[8:9] op_sel:[0,0] op_sel_hi:[1,0]
v_pk_mul_f32 v[176:177], v[176:177], v[8:9] op_sel:[0,0] op_sel_hi:[1,0]
v_pk_mul_f32 v[178:179], v[178:179], v[8:9] op_sel:[0,0] op_sel_hi:[1,0]
v_cvt_pk_bf16_f32 v160, v160, v161
v_cvt_pk_bf16_f32 v161, v162, v163
v_cvt_pk_bf16_f32 v162, v176, v177
v_cvt_pk_bf16_f32 v163, v178, v179
v_pk_add_f32 v[164:165], v[164:165], v[36:37]
v_pk_add_f32 v[166:167], v[166:167], v[38:39]
s_waitcnt lgkmcnt(10)
v_pk_add_f32 v[180:181], v[180:181], v[52:53]
v_pk_add_f32 v[182:183], v[182:183], v[54:55]
M v[24:27], a[112:115], v[160:163], 0
buffer_store_dwordx4 v[160:163], v1, s[16:19], s36 offen offset:0 sc1
v_pk_mul_f32 v[164:165], v[164:165], v[8:9] op_sel:[0,1] op_sel_hi:[1,1]
v_pk_mul_f32 v[166:167], v[166:167], v[8:9] op_sel:[0,1] op_sel_hi:[1,1]
v_pk_mul_f32 v[180:181], v[180:181], v[8:9] op_sel:[0,1] op_sel_hi:[1,1]
v_pk_mul_f32 v[182:183], v[182:183], v[8:9] op_sel:[0,1] op_sel_hi:[1,1]
v_cvt_pk_bf16_f32 v164, v164, v165
v_cvt_pk_bf16_f32 v165, v166, v167
v_cvt_pk_bf16_f32 v166, v180, v181
v_cvt_pk_bf16_f32 v167, v182, v183
v_pk_add_f32 v[168:169], v[168:169], v[40:41]
v_pk_add_f32 v[170:171], v[170:171], v[42:43]
s_waitcnt lgkmcnt(9)
v_pk_add_f32 v[184:185], v[184:185], v[56:57]
v_pk_add_f32 v[186:187], v[186:187], v[58:59]
M v[24:27], a[112:115], v[164:167], v[24:27]
buffer_store_dwordx4 v[164:167], v1, s[16:19], s36 offen offset:2048 sc1
v_pk_mul_f32 v[168:169], v[168:169], v[10:11] op_sel:[0,0] op_sel_hi:[1,0]
v_pk_mul_f32 v[170:171], v[170:171], v[10:11] op_sel:[0,0] op_sel_hi:[1,0]
v_pk_mul_f32 v[184:185], v[184:185], v[10:11] op_sel:[0,0] op_sel_hi:[1,0]
v_pk_mul_f32 v[186:187], v[186:187], v[10:11] op_sel:[0,0] op_sel_hi:[1,0]
v_cvt_pk_bf16_f32 v168, v168, v169
v_cvt_pk_bf16_f32 v169, v170, v171
v_cvt_pk_bf16_f32 v170, v184, v185
v_cvt_pk_bf16_f32 v171, v186, v187
v_pk_add_f32 v[172:173], v[172:173], v[44:45]
v_pk_add_f32 v[174:175], v[174:175], v[46:47]
s_waitcnt lgkmcnt(8)
v_pk_add_f32 v[188:189], v[188:189], v[60:61]
v_pk_add_f32 v[190:191], v[190:191], v[62:63]
M v[24:27], a[112:115], v[168:171], v[24:27]
buffer_store_dwordx4 v[168:171], v1, s[16:19], s37 offen offset:0 sc1
v_pk_mul_f32 v[172:173], v[172:173], v[10:11] op_sel:[0,1] op_sel_hi:[1,1]
v_pk_mul_f32 v[174:175], v[174:175], v[10:11] op_sel:[0,1] op_sel_hi:[1,1]
v_pk_mul_f32 v[188:189], v[188:189], v[10:11] op_sel:[0,1] op_sel_hi:[1,1]
v_pk_mul_f32 v[190:191], v[190:191], v[10:11] op_sel:[0,1] op_sel_hi:[1,1]
v_cvt_pk_bf16_f32 v172, v172, v173
v_cvt_pk_bf16_f32 v173, v174, v175
v_cvt_pk_bf16_f32 v174, v188, v189
v_cvt_pk_bf16_f32 v175, v190, v191
s_waitcnt lgkmcnt(7)
v_pk_add_f32 v[192:193], v[192:193], v[64:65]
v_pk_add_f32 v[194:195], v[194:195], v[66:67]
s_waitcnt lgkmcnt(3)
v_pk_add_f32 v[208:209], v[208:209], v[80:81]
v_pk_add_f32 v[210:211], v[210:211], v[82:83]
M v[24:27], a[112:115], v[172:175], v[24:27]
buffer_store_dwordx4 v[172:175], v1, s[16:19], s37 offen offset:2048 sc1
v_pk_mul_f32 v[192:193], v[192:193], v[8:9] op_sel:[0,0] op_sel_hi:[1,0]
v_pk_mul_f32 v[194:195], v[194:195], v[8:9] op_sel:[0,0] op_sel_hi:[1,0]
v_pk_mul_f32 v[208:209], v[208:209], v[8:9] op_sel:[0,0] op_sel_hi:[1,0]
v_pk_mul_f32 v[210:211], v[210:211], v[8:9] op_sel:[0,0] op_sel_hi:[1,0]
v_cvt_pk_bf16_f32 v192, v192, v193
v_cvt_pk_bf16_f32 v193, v194, v195
v_cvt_pk_bf16_f32 v194, v208, v209
v_cvt_pk_bf16_f32 v195, v210, v211
v_pk_add_f32 v[196:197], v[196:197], v[68:69]
v_pk_add_f32 v[198:199], v[198:199], v[70:71]
s_waitcnt lgkmcnt(2)
v_pk_add_f32 v[212:213], v[212:213], v[84:85]
v_pk_add_f32 v[214:215], v[214:215], v[86:87]
M v[24:27], a[112:115], v[192:195], v[24:27]
buffer_store_dwordx4 v[192:195], v1, s[16:19], s36 offen offset:1024 sc1
v_pk_mul_f32 v[196:197], v[196:197], v[8:9] op_sel:[0,1] op_sel_hi:[1,1]
v_pk_mul_f32 v[198:199], v[198:199], v[8:9] op_sel:[0,1] op_sel_hi:[1,1]
v_pk_mul_f32 v[212:213], v[212:213], v[8:9] op_sel:[0,1] op_sel_hi:[1,1]
v_pk_mul_f32 v[214:215], v[214:215], v[8:9] op_sel:[0,1] op_sel_hi:[1,1]
v_cvt_pk_bf16_f32 v196, v196, v197
v_cvt_pk_bf16_f32 v197, v198, v199
v_cvt_pk_bf16_f32 v198, v212, v213
v_cvt_pk_bf16_f32 v199, v214, v215
v_pk_add_f32 v[200:201], v[200:201], v[72:73]
v_pk_add_f32 v[202:203], v[202:203], v[74:75]
s_waitcnt lgkmcnt(1)
v_pk_add_f32 v[216:217], v[216:217], v[88:89]
v_pk_add_f32 v[218:219], v[218:219], v[90:91]
M v[24:27], a[112:115], v[196:199], v[24:27]
buffer_store_dwordx4 v[196:199], v1, s[16:19], s36 offen offset:3072 sc1
v_pk_mul_f32 v[200:201], v[200:201], v[10:11] op_sel:[0,0] op_sel_hi:[1,0]
v_pk_mul_f32 v[202:203], v[202:203], v[10:11] op_sel:[0,0] op_sel_hi:[1,0]
v_pk_mul_f32 v[216:217], v[216:217], v[10:11] op_sel:[0,0] op_sel_hi:[1,0]
v_pk_mul_f32 v[218:219], v[218:219], v[10:11] op_sel:[0,0] op_sel_hi:[1,0]
v_cvt_pk_bf16_f32 v200, v200, v201
v_cvt_pk_bf16_f32 v201, v202, v203
v_cvt_pk_bf16_f32 v202, v216, v217
v_cvt_pk_bf16_f32 v203, v218, v219
v_pk_add_f32 v[204:205], v[204:205], v[76:77]
v_pk_add_f32 v[206:207], v[206:207], v[78:79]
s_waitcnt lgkmcnt(0)
v_pk_add_f32 v[220:221], v[220:221], v[92:93]
v_pk_add_f32 v[222:223], v[222:223], v[94:95]
M v[24:27], a[112:115], v[200:203], v[24:27]
buffer_store_dwordx4 v[200:203], v1, s[16:19], s37 offen offset:1024 sc1
v_pk_mul_f32 v[204:205], v[204:205], v[10:11] op_sel:[0,1] op_sel_hi:[1,1]
v_pk_mul_f32 v[206:207], v[206:207], v[10:11] op_sel:[0,1] op_sel_hi:[1,1]
v_pk_mul_f32 v[220:221], v[220:221], v[10:11] op_sel:[0,1] op_sel_hi:[1,1]
v_pk_mul_f32 v[222:223], v[222:223], v[10:11] op_sel:[0,1] op_sel_hi:[1,1]
v_cvt_pk_bf16_f32 v204, v204, v205
v_cvt_pk_bf16_f32 v205, v206, v207
v_cvt_pk_bf16_f32 v206, v220, v221
v_cvt_pk_bf16_f32 v207, v222, v223
s_nop 1
M v[24:27], a[112:115], v[204:207], v[24:27]
buffer_store_dwordx4 v[204:207], v1, s[16:19], s37 offen offset:3072 sc1
v_cmp_lt_u32 vcc, 0x3c000000, v12
s_nop 5
v_cmp_class_f32 s[40:41], v24, s64
s_nop 0
s_or_b64 vcc, vcc, s[40:41]
s_cmp_lg_u64 vcc, 0
s_cselect_b32 s33, 2, 0
s_or_b32 s60, s60, s33
s_branch Lk2_chk
Lk2_mg1:
ds_write_b128 v2, v[160:163] offset:0
ds_write_b128 v2, v[164:167] offset:1024
ds_write_b128 v2, v[168:171] offset:2048
ds_write_b128 v2, v[172:175] offset:3072
ds_write_b128 v2, v[176:179] offset:4096
ds_write_b128 v2, v[180:183] offset:5120
ds_write_b128 v2, v[184:187] offset:6144
ds_write_b128 v2, v[188:191] offset:7168
ds_write_b128 v2, v[192:195] offset:8192
ds_write_b128 v2, v[196:199] offset:9216
ds_write_b128 v2, v[200:203] offset:10240
ds_write_b128 v2, v[204:207] offset:11264
ds_write_b128 v2, v[208:211] offset:12288
ds_write_b128 v2, v[212:215] offset:13312
ds_write_b128 v2, v[216:219] offset:14336
ds_write_b128 v2, v[220:223] offset:15360
s_waitcnt lgkmcnt(0)
s_barrier
ds_read_b128 v[28:31], v15
ds_read_b128 v[32:35], v3 offset:0
ds_read_b128 v[36:39], v3 offset:1024
ds_read_b128 v[40:43], v3 offset:2048
ds_read_b128 v[44:47], v3 offset:3072
ds_read_b128 v[48:51], v3 offset:4096
ds_read_b128 v[52:55], v3 offset:5120
ds_read_b128 v[56:59], v3 offset:6144
ds_read_b128 v[60:63], v3 offset:7168
ds_read_b128 v[64:67], v3 offset:8192
ds_read_b128 v[68:71], v3 offset:9216
ds_read_b128 v[72:75], v3 offset:10240
ds_read_b128 v[76:79], v3 offset:11264
ds_read_b128 v[80:83], v3 offset:12288
ds_read_b128 v[84:87], v3 offset:13312
ds_read_b128 v[88:91], v3 offset:14336
ds_read_b128 v[92:95], v3 offset:15360
s_waitcnt lgkmcnt(15)
v_add_f32 v20, v20, v28
v_add_f32 v21, v21, v29
v_add_f32 v22, v22, v30
v_add_f32 v23, v23, v31
s_sub_u32 s35, 15, s21
v_rcp_f32 v8, v20
v_rcp_f32 v9, v21
v_rcp_f32 v10, v22
v_rcp_f32 v11, v23
v_subrev_u32 v20, 0x21800000, v20
v_subrev_u32 v21, 0x21800000, v21
v_subrev_u32 v22, 0x21800000, v22
v_subrev_u32 v23, 0x21800000, v23
v_max_u32 v12, v20, v21
v_max3_u32 v12, v12, v22, v23
s_mov_b32 s64, 0x207
s_lshl_b32 s33, s35, 20
s_lshl_b32 s34, s20, 15
s_add_u32 s33, s33, s34
s_lshl_b32 s34, s23, 13
s_add_u32 s36, s33, s34
s_add_u32 s37, s36, 4096
s_add_u32 s38, s36, 16384
s_add_u32 s39, s36, 20480
v_pk_add_f32 v[224:225], v[224:225], v[32:33]
v_pk_add_f32 v[226:227], v[226:227], v[34:35]
s_waitcnt lgkmcnt(11)
v_pk_add_f32 v[240:241], v[240:241], v[48:49]
v_pk_add_f32 v[242:243], v[242:243], v[50:51]
v_pk_mul_f32 v[224:225], v[224:225], v[8:9] op_sel:[0,0] op_sel_hi:[1,0]
v_pk_mul_f32 v[226:227], v[226:227], v[8:9] op_sel:[0,0] op_sel_hi:[1,0]
v_pk_mul_f32 v[240:241], v[240:241], v[8:9] op_sel:[0,0] op_sel_hi:[1,0]
v_pk_mul_f32 v[242:243], v[242:243], v[8:9] op_sel:[0,0] op_sel_hi:[1,0]
v_cvt_pk_bf16_f32 v224, v224, v225
v_cvt_pk_bf16_f32 v225, v226, v227
v_cvt_pk_bf16_f32 v226, v240, v241
v_cvt_pk_bf16_f32 v227, v242, v243
v_pk_add_f32 v[228:229], v[228:229], v[36:37]
v_pk_add_f32 v[230:231], v[230:231], v[38:39]
s_waitcnt lgkmcnt(10)
v_pk_add_f32 v[244:245], v[244:245], v[52:53]
v_pk_add_f32 v[246:247], v[246:247], v[54:55]
M v[24:27], a[112:115], v[224:227], 0
buffer_store_dwordx4 v[224:227], v1, s[16:19], s38 offen offset:0 sc1
v_pk_mul_f32 v[228:229], v[228:229], v[8:9] op_sel:[0,1] op_sel_hi:[1,1]
v_pk_mul_f32 v[230:231], v[230:231], v[8:9] op_sel:[0,1] op_sel_hi:[1,1]
v_pk_mul_f32 v[244:245], v[244:245], v[8:9] op_sel:[0,1] op_sel_hi:[1,1]
v_pk_mul_f32 v[246:247], v[246:247], v[8:9] op_sel:[0,1] op_sel_hi:[1,1]
v_cvt_pk_bf16_f32 v228, v228, v229
v_cvt_pk_bf16_f32 v229, v230, v231
v_cvt_pk_bf16_f32 v230, v244, v245
v_cvt_pk_bf16_f32 v231, v246, v247
v_pk_add_f32 v[232:233], v[232:233], v[40:41]
v_pk_add_f32 v[234:235], v[234:235], v[42:43]
s_waitcnt lgkmcnt(9)
v_pk_add_f32 v[248:249], v[248:249], v[56:57]
v_pk_add_f32 v[250:251], v[250:251], v[58:59]
M v[24:27], a[112:115], v[228:231], v[24:27]
buffer_store_dwordx4 v[228:231], v1, s[16:19], s38 offen offset:2048 sc1
v_pk_mul_f32 v[232:233], v[232:233], v[10:11] op_sel:[0,0] op_sel_hi:[1,0]
v_pk_mul_f32 v[234:235], v[234:235], v[10:11] op_sel:[0,0] op_sel_hi:[1,0]
v_pk_mul_f32 v[248:249], v[248:249], v[10:11] op_sel:[0,0] op_sel_hi:[1,0]
v_pk_mul_f32 v[250:251], v[250:251], v[10:11] op_sel:[0,0] op_sel_hi:[1,0]
v_cvt_pk_bf16_f32 v232, v232, v233
v_cvt_pk_bf16_f32 v233, v234, v235
v_cvt_pk_bf16_f32 v234, v248, v249
v_cvt_pk_bf16_f32 v235, v250, v251
v_pk_add_f32 v[236:237], v[236:237], v[44:45]
v_pk_add_f32 v[238:239], v[238:239], v[46:47]
s_waitcnt lgkmcnt(8)
v_pk_add_f32 v[252:253], v[252:253], v[60:61]
v_pk_add_f32 v[254:255], v[254:255], v[62:63]
M v[24:27], a[112:115], v[232:235], v[24:27]
buffer_store_dwordx4 v[232:235], v1, s[16:19], s39 offen offset:0 sc1
v_pk_mul_f32 v[236:237], v[236:237], v[10:11] op_sel:[0,1] op_sel_hi:[1,1]
v_pk_mul_f32 v[238:239], v[238:239], v[10:11] op_sel:[0,1] op_sel_hi:[1,1]
v_pk_mul_f32 v[252:253], v[252:253], v[10:11] op_sel:[0,1] op_sel_hi:[1,1]
v_pk_mul_f32 v[254:255], v[254:255], v[10:11] op_sel:[0,1] op_sel_hi:[1,1]
v_cvt_pk_bf16_f32 v236, v236, v237
v_cvt_pk_bf16_f32 v237, v238, v239
v_cvt_pk_bf16_f32 v238, v252, v253
v_cvt_pk_bf16_f32 v239, v254, v255
v_accvgpr_read_b32 v32, a64
v_accvgpr_read_b32 v33, a65
v_accvgpr_read_b32 v34, a66
v_accvgpr_read_b32 v35, a67
s_waitcnt lgkmcnt(7)
v_pk_add_f32 v[32:33], v[32:33], v[64:65]
v_pk_add_f32 v[34:35], v[34:35], v[66:67]
v_accvgpr_read_b32 v48, a80
v_accvgpr_read_b32 v49, a81
v_accvgpr_read_b32 v50, a82
v_accvgpr_read_b32 v51, a83
s_waitcnt lgkmcnt(3)
v_pk_add_f32 v[48:49], v[48:49], v[80:81]
v_pk_add_f32 v[50:51], v[50:51], v[82:83]
M v[24:27], a[112:115], v[236:239], v[24:27]
buffer_store_dwordx4 v[236:239], v1, s[16:19], s39 offen offset:2048 sc1
v_pk_mul_f32 v[32:33], v[32:33], v[8:9] op_sel:[0,0] op_sel_hi:[1,0]
v_pk_mul_f32 v[34:35], v[34:35], v[8:9] op_sel:[0,0] op_sel_hi:[1,0]
v_pk_mul_f32 v[48:49], v[48:49], v[8:9] op_sel:[0,0] op_sel_hi:[1,0]
v_pk_mul_f32 v[50:51], v[50:51], v[8:9] op_sel:[0,0] op_sel_hi:[1,0]
v_cvt_pk_bf16_f32 v32, v32, v33
v_cvt_pk_bf16_f32 v33, v34, v35
v_cvt_pk_bf16_f32 v34, v48, v49
v_cvt_pk_bf16_f32 v35, v50, v51
v_accvgpr_read_b32 v240, a68
v_accvgpr_read_b32 v241, a69
v_accvgpr_read_b32 v242, a70
v_accvgpr_read_b32 v243, a71
v_pk_add_f32 v[240:241], v[240:241], v[68:69]
v_pk_add_f32 v[242:243], v[242:243], v[70:71]
v_accvgpr_read_b32 v36, a84
v_accvgpr_read_b32 v37, a85
v_accvgpr_read_b32 v38, a86
v_accvgpr_read_b32 v39, a87
s_waitcnt lgkmcnt(2)
v_pk_add_f32 v[36:37], v[36:37], v[84:85]
v_pk_add_f32 v[38:39], v[38:39], v[86:87]
M v[24:27], a[112:115], v[32:35], v[24:27]
buffer_store_dwordx4 v[32:35], v1, s[16:19], s38 offen offset:1024 sc1
v_pk_mul_f32 v[240:241], v[240:241], v[8:9] op_sel:[0,1] op_sel_hi:[1,1]
v_pk_mul_f32 v[242:243], v[242:243], v[8:9] op_sel:[0,1] op_sel_hi:[1,1]
v_pk_mul_f32 v[36:37], v[36:37], v[8:9] op_sel:[0,1] op_sel_hi:[1,1]
v_pk_mul_f32 v[38:39], v[38:39], v[8:9] op_sel:[0,1] op_sel_hi:[1,1]
v_cvt_pk_bf16_f32 v240, v240, v241
v_cvt_pk_bf16_f32 v241, v242, v243
v_cvt_pk_bf16_f32 v242, v36, v37
v_cvt_pk_bf16_f32 v243, v38, v39
v_accvgpr_read_b32 v52, a72
v_accvgpr_read_b32 v53, a73
v_accvgpr_read_b32 v54, a74
v_accvgpr_read_b32 v55, a75
v_pk_add_f32 v[52:53], v[52:53], v[72:73]
v_pk_add_f32 v[54:55], v[54:55], v[74:75]
v_accvgpr_read_b32 v244, a88
v_accvgpr_read_b32 v245, a89
v_accvgpr_read_b32 v246, a90
v_accvgpr_read_b32 v247, a91
s_waitcnt lgkmcnt(1)
v_pk_add_f32 v[244:245], v[244:245], v[88:89]
v_pk_add_f32 v[246:247], v[246:247], v[90:91]
M v[24:27], a[112:115], v[240:243], v[24:27]
buffer_store_dwordx4 v[240:243], v1, s[16:19], s38 offen offset:3072 sc1
v_pk_mul_f32 v[52:53], v[52:53], v[10:11] op_sel:[0,0] op_sel_hi:[1,0]
v_pk_mul_f32 v[54:55], v[54:55], v[10:11] op_sel:[0,0] op_sel_hi:[1,0]
v_pk_mul_f32 v[244:245], v[244:245], v[10:11] op_sel:[0,0] op_sel_hi:[1,0]
v_pk_mul_f32 v[246:247], v[246:247], v[10:11] op_sel:[0,0] op_sel_hi:[1,0]
v_cvt_pk_bf16_f32 v52, v52, v53
v_cvt_pk_bf16_f32 v53, v54, v55
v_cvt_pk_bf16_f32 v54, v244, v245
v_cvt_pk_bf16_f32 v55, v246, v247
v_accvgpr_read_b32 v40, a76
v_accvgpr_read_b32 v41, a77
v_accvgpr_read_b32 v42, a78
v_accvgpr_read_b32 v43, a79
v_pk_add_f32 v[40:41], v[40:41], v[76:77]
v_pk_add_f32 v[42:43], v[42:43], v[78:79]
v_accvgpr_read_b32 v56, a92
v_accvgpr_read_b32 v57, a93
v_accvgpr_read_b32 v58, a94
v_accvgpr_read_b32 v59, a95
s_waitcnt lgkmcnt(0)
v_pk_add_f32 v[56:57], v[56:57], v[92:93]
v_pk_add_f32 v[58:59], v[58:59], v[94:95]
M v[24:27], a[112:115], v[52:55], v[24:27]
buffer_store_dwordx4 v[52:55], v1, s[16:19], s39 offen offset:1024 sc1
v_pk_mul_f32 v[40:41], v[40:41], v[10:11] op_sel:[0,1] op_sel_hi:[1,1]
v_pk_mul_f32 v[42:43], v[42:43], v[10:11] op_sel:[0,1] op_sel_hi:[1,1]
v_pk_mul_f32 v[56:57], v[56:57], v[10:11] op_sel:[0,1] op_sel_hi:[1,1]
v_pk_mul_f32 v[58:59], v[58:59], v[10:11] op_sel:[0,1] op_sel_hi:[1,1]
v_cvt_pk_bf16_f32 v40, v40, v41
v_cvt_pk_bf16_f32 v41, v42, v43
v_cvt_pk_bf16_f32 v42, v56, v57
v_cvt_pk_bf16_f32 v43, v58, v59
s_nop 1
M v[24:27], a[112:115], v[40:43], v[24:27]
buffer_store_dwordx4 v[40:43], v1, s[16:19], s39 offen offset:3072 sc1
v_cmp_lt_u32 vcc, 0x3c000000, v12
s_nop 5
v_cmp_class_f32 s[40:41], v24, s64
s_nop 0
s_or_b64 vcc, vcc, s[40:41]
s_cmp_lg_u64 vcc, 0
s_cselect_b32 s33, 2, 0
s_or_b32 s60, s60, s33
Lk2_chk:
s_cmp_eq_u32 s60, 0
s_cbranch_scc1 Lk2_done
s_sub_u32 s56, 15, s21
s_lshl_b32 s33, s24, 1
s_lshl_b32 s61, 3, s33
s_and_b32 s34, s60, 2
s_bitcmp1_b32 s60, 0
s_cselect_b32 s56, s21, s56
s_cselect_b32 s61, 15, s61
s_cselect_b32 s60, s34, 0
s_waitcnt vmcnt(0)
s_lshl_b32 s33, s20, 7
s_lshl_b32 s34, s56, 3
s_add_u32 s33, s33, s34
s_lshl_b32 s34, s23, 2
s_add_u32 s33, s33, s34
s_lshl_b32 s33, s33, 12
buffer_load_dwordx4 a[0:3], v1, s[8:11], s33 offen offset:0 sc1
buffer_load_dwordx4 a[4:7], v1, s[8:11], s33 offen offset:1024 sc1
buffer_load_dwordx4 a[8:11], v1, s[8:11], s33 offen offset:2048 sc1
buffer_load_dwordx4 a[12:15], v1, s[8:11], s33 offen offset:3072 sc1
s_add_u32 s33, s33, 4096
buffer_load_dwordx4 a[16:19], v1, s[8:11], s33 offen offset:0 sc1
buffer_load_dwordx4 a[20:23], v1, s[8:11], s33 offen offset:1024 sc1
buffer_load_dwordx4 a[24:27], v1, s[8:11], s33 offen offset:2048 sc1
buffer_load_dwordx4 a[28:31], v1, s[8:11], s33 offen offset:3072 sc1
s_add_u32 s33, s33, 4096
buffer_load_dwordx4 a[32:35], v1, s[8:11], s33 offen offset:0 sc1
buffer_load_dwordx4 a[36:39], v1, s[8:11], s33 offen offset:1024 sc1
buffer_load_dwordx4 a[40:43], v1, s[8:11], s33 offen offset:2048 sc1
buffer_load_dwordx4 a[44:47], v1, s[8:11], s33 offen offset:3072 sc1
s_add_u32 s33, s33, 4096
buffer_load_dwordx4 a[48:51], v1, s[8:11], s33 offen offset:0 sc1
buffer_load_dwordx4 a[52:55], v1, s[8:11], s33 offen offset:1024 sc1
buffer_load_dwordx4 a[56:59], v1, s[8:11], s33 offen offset:2048 sc1
buffer_load_dwordx4 a[60:63], v1, s[8:11], s33 offen offset:3072 sc1
v_accvgpr_write_b32 a64, 0
v_accvgpr_write_b32 a65, 0
v_accvgpr_write_b32 a66, 0
v_accvgpr_write_b32 a67, 0
v_accvgpr_write_b32 a68, 0
v_accvgpr_write_b32 a69, 0
v_accvgpr_write_b32 a70, 0
v_accvgpr_write_b32 a71, 0
v_accvgpr_write_b32 a72, 0
v_accvgpr_write_b32 a73, 0
v_accvgpr_write_b32 a74, 0
v_accvgpr_write_b32 a75, 0
v_accvgpr_write_b32 a76, 0
v_accvgpr_write_b32 a77, 0
v_accvgpr_write_b32 a78, 0
v_accvgpr_write_b32 a79, 0
v_accvgpr_write_b32 a80, 0
v_accvgpr_write_b32 a81, 0
v_accvgpr_write_b32 a82, 0
v_accvgpr_write_b32 a83, 0
v_accvgpr_write_b32 a84, 0
v_accvgpr_write_b32 a85, 0
v_accvgpr_write_b32 a86, 0
v_accvgpr_write_b32 a87, 0
v_accvgpr_write_b32 a88, 0
v_accvgpr_write_b32 a89, 0
v_accvgpr_write_b32 a90, 0
v_accvgpr_write_b32 a91, 0
v_accvgpr_write_b32 a92, 0
v_accvgpr_write_b32 a93, 0
v_accvgpr_write_b32 a94, 0
v_accvgpr_write_b32 a95, 0
v_accvgpr_write_b32 a96, 0
v_accvgpr_write_b32 a97, 0
v_accvgpr_write_b32 a98, 0
v_accvgpr_write_b32 a99, 0
v_accvgpr_write_b32 a100, 0
v_accvgpr_write_b32 a101, 0
v_accvgpr_write_b32 a102, 0
v_accvgpr_write_b32 a103, 0
v_accvgpr_write_b32 a104, 0
v_accvgpr_write_b32 a105, 0
v_accvgpr_write_b32 a106, 0
v_accvgpr_write_b32 a107, 0
v_accvgpr_write_b32 a108, 0
v_accvgpr_write_b32 a109, 0
v_accvgpr_write_b32 a110, 0
v_accvgpr_write_b32 a111, 0
v_mov_b32 v160, 0
v_mov_b32 v161, 0
v_mov_b32 v162, 0
v_mov_b32 v163, 0
v_mov_b32 v164, 0
v_mov_b32 v165, 0
v_mov_b32 v166, 0
v_mov_b32 v167, 0
v_mov_b32 v168, 0
v_mov_b32 v169, 0
v_mov_b32 v170, 0
v_mov_b32 v171, 0
v_mov_b32 v172, 0
v_mov_b32 v173, 0
v_mov_b32 v174, 0
v_mov_b32 v175, 0
v_mov_b32 v176, 0
v_mov_b32 v177, 0
v_mov_b32 v178, 0
v_mov_b32 v179, 0
v_mov_b32 v180, 0
v_mov_b32 v181, 0
v_mov_b32 v182, 0
v_mov_b32 v183, 0
v_mov_b32 v184, 0
v_mov_b32 v185, 0
v_mov_b32 v186, 0
v_mov_b32 v187, 0
v_mov_b32 v188, 0
v_mov_b32 v189, 0
v_mov_b32 v190, 0
v_mov_b32 v191, 0
v_mov_b32 v192, 0
v_mov_b32 v193, 0
v_mov_b32 v194, 0
v_mov_b32 v195, 0
v_mov_b32 v196, 0
v_mov_b32 v197, 0
v_mov_b32 v198, 0
v_mov_b32 v199, 0
v_mov_b32 v200, 0
v_mov_b32 v201, 0
v_mov_b32 v202, 0
v_mov_b32 v203, 0
v_mov_b32 v204, 0
v_mov_b32 v205, 0
v_mov_b32 v206, 0
v_mov_b32 v207, 0
v_mov_b32 v208, 0
v_mov_b32 v209, 0
v_mov_b32 v210, 0
v_mov_b32 v211, 0
v_mov_b32 v212, 0
v_mov_b32 v213, 0
v_mov_b32 v214, 0
v_mov_b32 v215, 0
v_mov_b32 v216, 0
v_mov_b32 v217, 0
v_mov_b32 v218, 0
v_mov_b32 v219, 0
v_mov_b32 v220, 0
v_mov_b32 v221, 0
v_mov_b32 v222, 0
v_mov_b32 v223, 0
v_mov_b32 v224, 0
v_mov_b32 v225, 0
v_mov_b32 v226, 0
v_mov_b32 v227, 0
v_mov_b32 v228, 0
v_mov_b32 v229, 0
v_mov_b32 v230, 0
v_mov_b32 v231, 0
v_mov_b32 v232, 0
v_mov_b32 v233, 0
v_mov_b32 v234, 0
v_mov_b32 v235, 0
v_mov_b32 v236, 0
v_mov_b32 v237, 0
v_mov_b32 v238, 0
v_mov_b32 v239, 0
v_mov_b32 v240, 0
v_mov_b32 v241, 0
v_mov_b32 v242, 0
v_mov_b32 v243, 0
v_mov_b32 v244, 0
v_mov_b32 v245, 0
v_mov_b32 v246, 0
v_mov_b32 v247, 0
v_mov_b32 v248, 0
v_mov_b32 v249, 0
v_mov_b32 v250, 0
v_mov_b32 v251, 0
v_mov_b32 v252, 0
v_mov_b32 v253, 0
v_mov_b32 v254, 0
v_mov_b32 v255, 0
v_mov_b32 v8, v4
v_mov_b32 v9, v4
v_mov_b32 v10, v4
v_mov_b32 v11, v4
s_lshl_b32 s57, s20, 20
s_lshl_b32 s58, s56, 7
s_lshl_b32 s59, s56, 1
s_add_u32 s59, s59, 2
Lslow_2:
s_add_u32 s35, s57, 0
buffer_load_dwordx4 v[96:99], v1, s[12:15], s35 offen offset:0 sc1
buffer_load_dwordx4 v[100:103], v1, s[12:15], s35 offen offset:1024 sc1
buffer_load_dwordx4 v[104:107], v1, s[12:15], s35 offen offset:2048 sc1
buffer_load_dwordx4 v[108:111], v1, s[12:15], s35 offen offset:3072 sc1
s_add_u32 s35, s57, 4096
buffer_load_dwordx4 v[112:115], v1, s[12:15], s35 offen offset:0 sc1
buffer_load_dwordx4 v[116:119], v1, s[12:15], s35 offen offset:1024 sc1
buffer_load_dwordx4 v[120:123], v1, s[12:15], s35 offen offset:2048 sc1
buffer_load_dwordx4 v[124:127], v1, s[12:15], s35 offen offset:3072 sc1
s_add_u32 s35, s57, 8192
buffer_load_dwordx4 v[128:131], v1, s[12:15], s35 offen offset:0 sc1
buffer_load_dwordx4 v[132:135], v1, s[12:15], s35 offen offset:1024 sc1
buffer_load_dwordx4 v[136:139], v1, s[12:15], s35 offen offset:2048 sc1
buffer_load_dwordx4 v[140:143], v1, s[12:15], s35 offen offset:3072 sc1
s_add_u32 s35, s57, 12288
buffer_load_dwordx4 v[144:147], v1, s[12:15], s35 offen offset:0 sc1
buffer_load_dwordx4 v[148:151], v1, s[12:15], s35 offen offset:1024 sc1
buffer_load_dwordx4 v[152:155], v1, s[12:15], s35 offen offset:2048 sc1
buffer_load_dwordx4 v[156:159], v1, s[12:15], s35 offen offset:3072 sc1
s_lshl_b32 s33, s23, 6
s_add_i32 s33, s33, s58
s_cmp_gt_i32 s33, 0
s_cselect_b32 s34, 0, 0xf149f2ca
s_cmp_lt_i32 s33, 0
s_cselect_b32 s33, 0xf149f2ca, 0
v_mov_b32 v20, s34
v_mov_b32 v21, s34
v_mov_b32 v22, s34
v_mov_b32 v23, s34
v_mov_b32 v28, s33
v_mov_b32 v29, s33
v_mov_b32 v30, s33
v_mov_b32 v31, s33
v_med3_f32 v24, v16, v20, v28
v_med3_f32 v25, v17, v20, v28
v_med3_f32 v26, v18, v20, v28
v_med3_f32 v27, v19, v20, v28
s_waitcnt vmcnt(0)
s_nop 0
M v[32:35], v[96:99], a[0:3], v[24:27]
M v[32:35], v[100:103], a[4:7], v[32:35]
M v[32:35], v[104:107], a[8:11], v[32:35]
M v[32:35], v[108:111], a[12:15], v[32:35]
M v[36:39], v[96:99], a[16:19], v[28:31]
M v[36:39], v[100:103], a[20:23], v[36:39]
M v[36:39], v[104:107], a[24:27], v[36:39]
M v[36:39], v[108:111], a[28:31], v[36:39]
M v[40:43], v[96:99], a[32:35], v[28:31]
M v[40:43], v[100:103], a[36:39], v[40:43]
M v[40:43], v[104:107], a[40:43], v[40:43]
M v[40:43], v[108:111], a[44:47], v[40:43]
M v[44:47], v[96:99], a[48:51], v[28:31]
M v[44:47], v[100:103], a[52:55], v[44:47]
M v[44:47], v[104:107], a[56:59], v[44:47]
M v[44:47], v[108:111], a[60:63], v[44:47]
M v[48:51], v[112:115], a[0:3], v[20:23]
M v[48:51], v[116:119], a[4:7], v[48:51]
M v[48:51], v[120:123], a[8:11], v[48:51]
M v[48:51], v[124:127], a[12:15], v[48:51]
M v[52:55], v[112:115], a[16:19], v[24:27]
M v[52:55], v[116:119], a[20:23], v[52:55]
M v[52:55], v[120:123], a[24:27], v[52:55]
M v[52:55], v[124:127], a[28:31], v[52:55]
M v[56:59], v[112:115], a[32:35], v[28:31]
M v[56:59], v[116:119], a[36:39], v[56:59]
M v[56:59], v[120:123], a[40:43], v[56:59]
M v[56:59], v[124:127], a[44:47], v[56:59]
M v[60:63], v[112:115], a[48:51], v[28:31]
M v[60:63], v[116:119], a[52:55], v[60:63]
M v[60:63], v[120:123], a[56:59], v[60:63]
M v[60:63], v[124:127], a[60:63], v[60:63]
M v[64:67], v[128:131], a[0:3], v[20:23]
M v[64:67], v[132:135], a[4:7], v[64:67]
M v[64:67], v[136:139], a[8:11], v[64:67]
M v[64:67], v[140:143], a[12:15], v[64:67]
M v[68:71], v[128:131], a[16:19], v[20:23]
M v[68:71], v[132:135], a[20:23], v[68:71]
M v[68:71], v[136:139], a[24:27], v[68:71]
M v[68:71], v[140:143], a[28:31], v[68:71]
M v[72:75], v[128:131], a[32:35], v[24:27]
M v[72:75], v[132:135], a[36:39], v[72:75]
M v[72:75], v[136:139], a[40:43], v[72:75]
M v[72:75], v[140:143], a[44:47], v[72:75]
M v[76:79], v[128:131], a[48:51], v[28:31]
M v[76:79], v[132:135], a[52:55], v[76:79]
M v[76:79], v[136:139], a[56:59], v[76:79]
M v[76:79], v[140:143], a[60:63], v[76:79]
M v[80:83], v[144:147], a[0:3], v[20:23]
M v[80:83], v[148:151], a[4:7], v[80:83]
M v[80:83], v[152:155], a[8:11], v[80:83]
M v[80:83], v[156:159], a[12:15], v[80:83]
M v[84:87], v[144:147], a[16:19], v[20:23]
M v[84:87], v[148:151], a[20:23], v[84:87]
M v[84:87], v[152:155], a[24:27], v[84:87]
M v[84:87], v[156:159], a[28:31], v[84:87]
M v[88:91], v[144:147], a[32:35], v[20:23]
M v[88:91], v[148:151], a[36:39], v[88:91]
M v[88:91], v[152:155], a[40:43], v[88:91]
M v[88:91], v[156:159], a[44:47], v[88:91]
M v[92:95], v[144:147], a[48:51], v[24:27]
M v[92:95], v[148:151], a[52:55], v[92:95]
M v[92:95], v[152:155], a[56:59], v[92:95]
M v[92:95], v[156:159], a[60:63], v[92:95]
s_nop 7
s_add_u32 s35, s57, 16384
buffer_load_dwordx4 v[96:99], v1, s[12:15], s35 offen offset:0 sc1
buffer_load_dwordx4 v[100:103], v1, s[12:15], s35 offen offset:1024 sc1
buffer_load_dwordx4 v[104:107], v1, s[12:15], s35 offen offset:2048 sc1
buffer_load_dwordx4 v[108:111], v1, s[12:15], s35 offen offset:3072 sc1
s_add_u32 s35, s57, 20480
buffer_load_dwordx4 v[112:115], v1, s[12:15], s35 offen offset:0 sc1
buffer_load_dwordx4 v[116:119], v1, s[12:15], s35 offen offset:1024 sc1
buffer_load_dwordx4 v[120:123], v1, s[12:15], s35 offen offset:2048 sc1
buffer_load_dwordx4 v[124:127], v1, s[12:15], s35 offen offset:3072 sc1
s_add_u32 s35, s57, 24576
buffer_load_dwordx4 v[128:131], v1, s[12:15], s35 offen offset:0 sc1
buffer_load_dwordx4 v[132:135], v1, s[12:15], s35 offen offset:1024 sc1
buffer_load_dwordx4 v[136:139], v1, s[12:15], s35 offen offset:2048 sc1
buffer_load_dwordx4 v[140:143], v1, s[12:15], s35 offen offset:3072 sc1
s_add_u32 s35, s57, 28672
buffer_load_dwordx4 v[144:147], v1, s[12:15], s35 offen offset:0 sc1
buffer_load_dwordx4 v[148:151], v1, s[12:15], s35 offen offset:1024 sc1
buffer_load_dwordx4 v[152:155], v1, s[12:15], s35 offen offset:2048 sc1
buffer_load_dwordx4 v[156:159], v1, s[12:15], s35 offen offset:3072 sc1
v_max3_f32 v13, v32, v33, v8
v_max3_f32 v13, v13, v34, v35
v_max3_f32 v13, v13, v48, v49
v_max3_f32 v13, v13, v50, v51
v_max3_f32 v13, v13, v64, v65
v_max3_f32 v13, v13, v66, v67
v_max3_f32 v13, v13, v80, v81
v_max3_f32 v13, v13, v82, v83
v_mov_b32 v14, v13
s_nop 1
v_permlane16_swap_b32 v13, v14
v_max_f32 v13, v13, v14
v_mov_b32 v14, v13
s_nop 1
v_permlane32_swap_b32 v13, v14
v_max_f32 v13, v13, v14
v_sub_f32 v12, v8, v13
v_exp_f32 v12, v12
v_mov_b32 v8, v13
v_sub_f32 v32, v32, v13
v_sub_f32 v33, v33, v13
v_sub_f32 v34, v34, v13
v_sub_f32 v35, v35, v13
v_sub_f32 v48, v48, v13
v_sub_f32 v49, v49, v13
v_sub_f32 v50, v50, v13
v_sub_f32 v51, v51, v13
v_sub_f32 v64, v64, v13
v_sub_f32 v65, v65, v13
v_sub_f32 v66, v66, v13
v_sub_f32 v67, v67, v13
v_sub_f32 v80, v80, v13
v_sub_f32 v81, v81, v13
v_sub_f32 v82, v82, v13
v_sub_f32 v83, v83, v13
v_mul_f32 v160, v160, v12
v_mul_f32 v161, v161, v12
v_mul_f32 v162, v162, v12
v_mul_f32 v163, v163, v12
v_mul_f32 v176, v176, v12
v_mul_f32 v177, v177, v12
v_mul_f32 v178, v178, v12
v_mul_f32 v179, v179, v12
v_mul_f32 v192, v192, v12
v_mul_f32 v193, v193, v12
v_mul_f32 v194, v194, v12
v_mul_f32 v195, v195, v12
v_mul_f32 v208, v208, v12
v_mul_f32 v209, v209, v12
v_mul_f32 v210, v210, v12
v_mul_f32 v211, v211, v12
v_mul_f32 v224, v224, v12
v_mul_f32 v225, v225, v12
v_mul_f32 v226, v226, v12
v_mul_f32 v227, v227, v12
v_mul_f32 v240, v240, v12
v_mul_f32 v241, v241, v12
v_mul_f32 v242, v242, v12
v_mul_f32 v243, v243, v12
v_accvgpr_read_b32 v14, a64
v_mul_f32 v14, v14, v12
v_accvgpr_write_b32 a64, v14
v_accvgpr_read_b32 v14, a65
v_mul_f32 v14, v14, v12
v_accvgpr_write_b32 a65, v14
v_accvgpr_read_b32 v14, a66
v_mul_f32 v14, v14, v12
v_accvgpr_write_b32 a66, v14
v_accvgpr_read_b32 v14, a67
v_mul_f32 v14, v14, v12
v_accvgpr_write_b32 a67, v14
v_accvgpr_read_b32 v14, a80
v_mul_f32 v14, v14, v12
v_accvgpr_write_b32 a80, v14
v_accvgpr_read_b32 v14, a81
v_mul_f32 v14, v14, v12
v_accvgpr_write_b32 a81, v14
v_accvgpr_read_b32 v14, a82
v_mul_f32 v14, v14, v12
v_accvgpr_write_b32 a82, v14
v_accvgpr_read_b32 v14, a83
v_mul_f32 v14, v14, v12
v_accvgpr_write_b32 a83, v14
v_accvgpr_read_b32 v14, a96
v_mul_f32 v14, v14, v12
v_accvgpr_write_b32 a96, v14
v_accvgpr_read_b32 v14, a97
v_mul_f32 v14, v14, v12
v_accvgpr_write_b32 a97, v14
v_accvgpr_read_b32 v14, a98
v_mul_f32 v14, v14, v12
v_accvgpr_write_b32 a98, v14
v_accvgpr_read_b32 v14, a99
v_mul_f32 v14, v14, v12
v_accvgpr_write_b32 a99, v14
v_max3_f32 v13, v36, v37, v9
v_max3_f32 v13, v13, v38, v39
v_max3_f32 v13, v13, v52, v53
v_max3_f32 v13, v13, v54, v55
v_max3_f32 v13, v13, v68, v69
v_max3_f32 v13, v13, v70, v71
v_max3_f32 v13, v13, v84, v85
v_max3_f32 v13, v13, v86, v87
v_mov_b32 v14, v13
s_nop 1
v_permlane16_swap_b32 v13, v14
v_max_f32 v13, v13, v14
v_mov_b32 v14, v13
s_nop 1
v_permlane32_swap_b32 v13, v14
v_max_f32 v13, v13, v14
v_sub_f32 v12, v9, v13
v_exp_f32 v12, v12
v_mov_b32 v9, v13
v_sub_f32 v36, v36, v13
v_sub_f32 v37, v37, v13
v_sub_f32 v38, v38, v13
v_sub_f32 v39, v39, v13
v_sub_f32 v52, v52, v13
v_sub_f32 v53, v53, v13
v_sub_f32 v54, v54, v13
v_sub_f32 v55, v55, v13
v_sub_f32 v68, v68, v13
v_sub_f32 v69, v69, v13
v_sub_f32 v70, v70, v13
v_sub_f32 v71, v71, v13
v_sub_f32 v84, v84, v13
v_sub_f32 v85, v85, v13
v_sub_f32 v86, v86, v13
v_sub_f32 v87, v87, v13
v_mul_f32 v164, v164, v12
v_mul_f32 v165, v165, v12
v_mul_f32 v166, v166, v12
v_mul_f32 v167, v167, v12
v_mul_f32 v180, v180, v12
v_mul_f32 v181, v181, v12
v_mul_f32 v182, v182, v12
v_mul_f32 v183, v183, v12
v_mul_f32 v196, v196, v12
v_mul_f32 v197, v197, v12
v_mul_f32 v198, v198, v12
v_mul_f32 v199, v199, v12
v_mul_f32 v212, v212, v12
v_mul_f32 v213, v213, v12
v_mul_f32 v214, v214, v12
v_mul_f32 v215, v215, v12
v_mul_f32 v228, v228, v12
v_mul_f32 v229, v229, v12
v_mul_f32 v230, v230, v12
v_mul_f32 v231, v231, v12
v_mul_f32 v244, v244, v12
v_mul_f32 v245, v245, v12
v_mul_f32 v246, v246, v12
v_mul_f32 v247, v247, v12
v_accvgpr_read_b32 v14, a68
v_mul_f32 v14, v14, v12
v_accvgpr_write_b32 a68, v14
v_accvgpr_read_b32 v14, a69
v_mul_f32 v14, v14, v12
v_accvgpr_write_b32 a69, v14
v_accvgpr_read_b32 v14, a70
v_mul_f32 v14, v14, v12
v_accvgpr_write_b32 a70, v14
v_accvgpr_read_b32 v14, a71
v_mul_f32 v14, v14, v12
v_accvgpr_write_b32 a71, v14
v_accvgpr_read_b32 v14, a84
v_mul_f32 v14, v14, v12
v_accvgpr_write_b32 a84, v14
v_accvgpr_read_b32 v14, a85
v_mul_f32 v14, v14, v12
v_accvgpr_write_b32 a85, v14
v_accvgpr_read_b32 v14, a86
v_mul_f32 v14, v14, v12
v_accvgpr_write_b32 a86, v14
v_accvgpr_read_b32 v14, a87
v_mul_f32 v14, v14, v12
v_accvgpr_write_b32 a87, v14
v_accvgpr_read_b32 v14, a100
v_mul_f32 v14, v14, v12
v_accvgpr_write_b32 a100, v14
v_accvgpr_read_b32 v14, a101
v_mul_f32 v14, v14, v12
v_accvgpr_write_b32 a101, v14
v_accvgpr_read_b32 v14, a102
v_mul_f32 v14, v14, v12
v_accvgpr_write_b32 a102, v14
v_accvgpr_read_b32 v14, a103
v_mul_f32 v14, v14, v12
v_accvgpr_write_b32 a103, v14
v_max3_f32 v13, v40, v41, v10
v_max3_f32 v13, v13, v42, v43
v_max3_f32 v13, v13, v56, v57
v_max3_f32 v13, v13, v58, v59
v_max3_f32 v13, v13, v72, v73
v_max3_f32 v13, v13, v74, v75
v_max3_f32 v13, v13, v88, v89
v_max3_f32 v13, v13, v90, v91
v_mov_b32 v14, v13
s_nop 1
v_permlane16_swap_b32 v13, v14
v_max_f32 v13, v13, v14
v_mov_b32 v14, v13
s_nop 1
v_permlane32_swap_b32 v13, v14
v_max_f32 v13, v13, v14
v_sub_f32 v12, v10, v13
v_exp_f32 v12, v12
v_mov_b32 v10, v13
v_sub_f32 v40, v40, v13
v_sub_f32 v41, v41, v13
v_sub_f32 v42, v42, v13
v_sub_f32 v43, v43, v13
v_sub_f32 v56, v56, v13
v_sub_f32 v57, v57, v13
v_sub_f32 v58, v58, v13
v_sub_f32 v59, v59, v13
v_sub_f32 v72, v72, v13
v_sub_f32 v73, v73, v13
v_sub_f32 v74, v74, v13
v_sub_f32 v75, v75, v13
v_sub_f32 v88, v88, v13
v_sub_f32 v89, v89, v13
v_sub_f32 v90, v90, v13
v_sub_f32 v91, v91, v13
v_mul_f32 v168, v168, v12
v_mul_f32 v169, v169, v12
v_mul_f32 v170, v170, v12
v_mul_f32 v171, v171, v12
v_mul_f32 v184, v184, v12
v_mul_f32 v185, v185, v12
v_mul_f32 v186, v186, v12
v_mul_f32 v187, v187, v12
v_mul_f32 v200, v200, v12
v_mul_f32 v201, v201, v12
v_mul_f32 v202, v202, v12
v_mul_f32 v203, v203, v12
v_mul_f32 v216, v216, v12
v_mul_f32 v217, v217, v12
v_mul_f32 v218, v218, v12
v_mul_f32 v219, v219, v12
v_mul_f32 v232, v232, v12
v_mul_f32 v233, v233, v12
v_mul_f32 v234, v234, v12
v_mul_f32 v235, v235, v12
v_mul_f32 v248, v248, v12
v_mul_f32 v249, v249, v12
v_mul_f32 v250, v250, v12
v_mul_f32 v251, v251, v12
v_accvgpr_read_b32 v14, a72
v_mul_f32 v14, v14, v12
v_accvgpr_write_b32 a72, v14
v_accvgpr_read_b32 v14, a73
v_mul_f32 v14, v14, v12
v_accvgpr_write_b32 a73, v14
v_accvgpr_read_b32 v14, a74
v_mul_f32 v14, v14, v12
v_accvgpr_write_b32 a74, v14
v_accvgpr_read_b32 v14, a75
v_mul_f32 v14, v14, v12
v_accvgpr_write_b32 a75, v14
v_accvgpr_read_b32 v14, a88
v_mul_f32 v14, v14, v12
v_accvgpr_write_b32 a88, v14
v_accvgpr_read_b32 v14, a89
v_mul_f32 v14, v14, v12
v_accvgpr_write_b32 a89, v14
v_accvgpr_read_b32 v14, a90
v_mul_f32 v14, v14, v12
v_accvgpr_write_b32 a90, v14
v_accvgpr_read_b32 v14, a91
v_mul_f32 v14, v14, v12
v_accvgpr_write_b32 a91, v14
v_accvgpr_read_b32 v14, a104
v_mul_f32 v14, v14, v12
v_accvgpr_write_b32 a104, v14
v_accvgpr_read_b32 v14, a105
v_mul_f32 v14, v14, v12
v_accvgpr_write_b32 a105, v14
v_accvgpr_read_b32 v14, a106
v_mul_f32 v14, v14, v12
v_accvgpr_write_b32 a106, v14
v_accvgpr_read_b32 v14, a107
v_mul_f32 v14, v14, v12
v_accvgpr_write_b32 a107, v14
v_max3_f32 v13, v44, v45, v11
v_max3_f32 v13, v13, v46, v47
v_max3_f32 v13, v13, v60, v61
v_max3_f32 v13, v13, v62, v63
v_max3_f32 v13, v13, v76, v77
v_max3_f32 v13, v13, v78, v79
v_max3_f32 v13, v13, v92, v93
v_max3_f32 v13, v13, v94, v95
v_mov_b32 v14, v13
s_nop 1
v_permlane16_swap_b32 v13, v14
v_max_f32 v13, v13, v14
v_mov_b32 v14, v13
s_nop 1
v_permlane32_swap_b32 v13, v14
v_max_f32 v13, v13, v14
v_sub_f32 v12, v11, v13
v_exp_f32 v12, v12
v_mov_b32 v11, v13
v_sub_f32 v44, v44, v13
v_sub_f32 v45, v45, v13
v_sub_f32 v46, v46, v13
v_sub_f32 v47, v47, v13
v_sub_f32 v60, v60, v13
v_sub_f32 v61, v61, v13
v_sub_f32 v62, v62, v13
v_sub_f32 v63, v63, v13
v_sub_f32 v76, v76, v13
v_sub_f32 v77, v77, v13
v_sub_f32 v78, v78, v13
v_sub_f32 v79, v79, v13
v_sub_f32 v92, v92, v13
v_sub_f32 v93, v93, v13
v_sub_f32 v94, v94, v13
v_sub_f32 v95, v95, v13
v_mul_f32 v172, v172, v12
v_mul_f32 v173, v173, v12
v_mul_f32 v174, v174, v12
v_mul_f32 v175, v175, v12
v_mul_f32 v188, v188, v12
v_mul_f32 v189, v189, v12
v_mul_f32 v190, v190, v12
v_mul_f32 v191, v191, v12
v_mul_f32 v204, v204, v12
v_mul_f32 v205, v205, v12
v_mul_f32 v206, v206, v12
v_mul_f32 v207, v207, v12
v_mul_f32 v220, v220, v12
v_mul_f32 v221, v221, v12
v_mul_f32 v222, v222, v12
v_mul_f32 v223, v223, v12
v_mul_f32 v236, v236, v12
v_mul_f32 v237, v237, v12
v_mul_f32 v238, v238, v12
v_mul_f32 v239, v239, v12
v_mul_f32 v252, v252, v12
v_mul_f32 v253, v253, v12
v_mul_f32 v254, v254, v12
v_mul_f32 v255, v255, v12
v_accvgpr_read_b32 v14, a76
v_mul_f32 v14, v14, v12
v_accvgpr_write_b32 a76, v14
v_accvgpr_read_b32 v14, a77
v_mul_f32 v14, v14, v12
v_accvgpr_write_b32 a77, v14
v_accvgpr_read_b32 v14, a78
v_mul_f32 v14, v14, v12
v_accvgpr_write_b32 a78, v14
v_accvgpr_read_b32 v14, a79
v_mul_f32 v14, v14, v12
v_accvgpr_write_b32 a79, v14
v_accvgpr_read_b32 v14, a92
v_mul_f32 v14, v14, v12
v_accvgpr_write_b32 a92, v14
v_accvgpr_read_b32 v14, a93
v_mul_f32 v14, v14, v12
v_accvgpr_write_b32 a93, v14
v_accvgpr_read_b32 v14, a94
v_mul_f32 v14, v14, v12
v_accvgpr_write_b32 a94, v14
v_accvgpr_read_b32 v14, a95
v_mul_f32 v14, v14, v12
v_accvgpr_write_b32 a95, v14
v_accvgpr_read_b32 v14, a108
v_mul_f32 v14, v14, v12
v_accvgpr_write_b32 a108, v14
v_accvgpr_read_b32 v14, a109
v_mul_f32 v14, v14, v12
v_accvgpr_write_b32 a109, v14
v_accvgpr_read_b32 v14, a110
v_mul_f32 v14, v14, v12
v_accvgpr_write_b32 a110, v14
v_accvgpr_read_b32 v14, a111
v_mul_f32 v14, v14, v12
v_accvgpr_write_b32 a111, v14
v_exp_f32 v32, v32
v_exp_f32 v33, v33
v_exp_f32 v34, v34
v_exp_f32 v35, v35
v_exp_f32 v48, v48
v_exp_f32 v49, v49
v_exp_f32 v50, v50
v_exp_f32 v51, v51
v_cvt_pk_bf16_f32 v32, v32, v33
v_cvt_pk_bf16_f32 v33, v34, v35
v_exp_f32 v36, v36
v_exp_f32 v37, v37
v_exp_f32 v38, v38
v_exp_f32 v39, v39
v_cvt_pk_bf16_f32 v34, v48, v49
v_cvt_pk_bf16_f32 v35, v50, v51
v_exp_f32 v52, v52
v_exp_f32 v53, v53
v_exp_f32 v54, v54
v_exp_f32 v55, v55
v_cvt_pk_bf16_f32 v36, v36, v37
v_cvt_pk_bf16_f32 v37, v38, v39
v_exp_f32 v40, v40
v_exp_f32 v41, v41
v_exp_f32 v42, v42
v_exp_f32 v43, v43
v_cvt_pk_bf16_f32 v38, v52, v53
v_cvt_pk_bf16_f32 v39, v54, v55
v_exp_f32 v56, v56
v_exp_f32 v57, v57
v_exp_f32 v58, v58
v_exp_f32 v59, v59
v_cvt_pk_bf16_f32 v40, v40, v41
v_cvt_pk_bf16_f32 v41, v42, v43
v_exp_f32 v44, v44
v_exp_f32 v45, v45
v_exp_f32 v46, v46
v_exp_f32 v47, v47
v_cvt_pk_bf16_f32 v42, v56, v57
v_cvt_pk_bf16_f32 v43, v58, v59
v_exp_f32 v60, v60
v_exp_f32 v61, v61
v_exp_f32 v62, v62
v_exp_f32 v63, v63
v_cvt_pk_bf16_f32 v44, v44, v45
v_cvt_pk_bf16_f32 v45, v46, v47
v_cvt_pk_bf16_f32 v46, v60, v61
v_cvt_pk_bf16_f32 v47, v62, v63
v_exp_f32 v64, v64
v_exp_f32 v65, v65
v_exp_f32 v66, v66
v_exp_f32 v67, v67
v_exp_f32 v80, v80
v_exp_f32 v81, v81
v_exp_f32 v82, v82
v_exp_f32 v83, v83
v_cvt_pk_bf16_f32 v64, v64, v65
v_cvt_pk_bf16_f32 v65, v66, v67
v_exp_f32 v68, v68
v_exp_f32 v69, v69
v_exp_f32 v70, v70
v_exp_f32 v71, v71
v_cvt_pk_bf16_f32 v66, v80, v81
v_cvt_pk_bf16_f32 v67, v82, v83
v_exp_f32 v84, v84
v_exp_f32 v85, v85
v_exp_f32 v86, v86
v_exp_f32 v87, v87
v_cvt_pk_bf16_f32 v68, v68, v69
v_cvt_pk_bf16_f32 v69, v70, v71
v_exp_f32 v72, v72
v_exp_f32 v73, v73
v_exp_f32 v74, v74
v_exp_f32 v75, v75
v_cvt_pk_bf16_f32 v70, v84, v85
v_cvt_pk_bf16_f32 v71, v86, v87
v_exp_f32 v88, v88
v_exp_f32 v89, v89
v_exp_f32 v90, v90
v_exp_f32 v91, v91
v_cvt_pk_bf16_f32 v72, v72, v73
v_cvt_pk_bf16_f32 v73, v74, v75
v_exp_f32 v76, v76
v_exp_f32 v77, v77
v_exp_f32 v78, v78
v_exp_f32 v79, v79
v_cvt_pk_bf16_f32 v74, v88, v89
v_cvt_pk_bf16_f32 v75, v90, v91
v_exp_f32 v92, v92
v_exp_f32 v93, v93
v_exp_f32 v94, v94
v_exp_f32 v95, v95
v_cvt_pk_bf16_f32 v76, v76, v77
v_cvt_pk_bf16_f32 v77, v78, v79
v_cvt_pk_bf16_f32 v78, v92, v93
v_cvt_pk_bf16_f32 v79, v94, v95
s_waitcnt vmcnt(0)
M a[96:99], a[112:115], v[32:35], a[96:99]
M a[100:103], a[112:115], v[36:39], a[100:103]
M a[104:107], a[112:115], v[40:43], a[104:107]
M a[108:111], a[112:115], v[44:47], a[108:111]
M v[160:163], v[96:99], v[32:35], v[160:163]
M v[164:167], v[96:99], v[36:39], v[164:167]
M v[168:171], v[96:99], v[40:43], v[168:171]
M v[172:175], v[96:99], v[44:47], v[172:175]
M v[176:179], v[100:103], v[32:35], v[176:179]
M v[180:183], v[100:103], v[36:39], v[180:183]
M v[184:187], v[100:103], v[40:43], v[184:187]
M v[188:191], v[100:103], v[44:47], v[188:191]
M v[192:195], v[104:107], v[32:35], v[192:195]
M v[196:199], v[104:107], v[36:39], v[196:199]
M v[200:203], v[104:107], v[40:43], v[200:203]
M v[204:207], v[104:107], v[44:47], v[204:207]
M v[208:211], v[108:111], v[32:35], v[208:211]
M v[212:215], v[108:111], v[36:39], v[212:215]
M v[216:219], v[108:111], v[40:43], v[216:219]
M v[220:223], v[108:111], v[44:47], v[220:223]
M v[224:227], v[112:115], v[32:35], v[224:227]
M v[228:231], v[112:115], v[36:39], v[228:231]
M v[232:235], v[112:115], v[40:43], v[232:235]
M v[236:239], v[112:115], v[44:47], v[236:239]
M v[240:243], v[116:119], v[32:35], v[240:243]
M v[244:247], v[116:119], v[36:39], v[244:247]
M v[248:251], v[116:119], v[40:43], v[248:251]
M v[252:255], v[116:119], v[44:47], v[252:255]
M a[64:67], v[120:123], v[32:35], a[64:67]
M a[68:71], v[120:123], v[36:39], a[68:71]
M a[72:75], v[120:123], v[40:43], a[72:75]
M a[76:79], v[120:123], v[44:47], a[76:79]
M a[80:83], v[124:127], v[32:35], a[80:83]
M a[84:87], v[124:127], v[36:39], a[84:87]
M a[88:91], v[124:127], v[40:43], a[88:91]
M a[92:95], v[124:127], v[44:47], a[92:95]
M a[96:99], a[112:115], v[64:67], a[96:99]
M a[100:103], a[112:115], v[68:71], a[100:103]
M a[104:107], a[112:115], v[72:75], a[104:107]
M a[108:111], a[112:115], v[76:79], a[108:111]
M v[160:163], v[128:131], v[64:67], v[160:163]
M v[164:167], v[128:131], v[68:71], v[164:167]
M v[168:171], v[128:131], v[72:75], v[168:171]
M v[172:175], v[128:131], v[76:79], v[172:175]
M v[176:179], v[132:135], v[64:67], v[176:179]
M v[180:183], v[132:135], v[68:71], v[180:183]
M v[184:187], v[132:135], v[72:75], v[184:187]
M v[188:191], v[132:135], v[76:79], v[188:191]
M v[192:195], v[136:139], v[64:67], v[192:195]
M v[196:199], v[136:139], v[68:71], v[196:199]
M v[200:203], v[136:139], v[72:75], v[200:203]
M v[204:207], v[136:139], v[76:79], v[204:207]
M v[208:211], v[140:143], v[64:67], v[208:211]
M v[212:215], v[140:143], v[68:71], v[212:215]
M v[216:219], v[140:143], v[72:75], v[216:219]
M v[220:223], v[140:143], v[76:79], v[220:223]
M v[224:227], v[144:147], v[64:67], v[224:227]
M v[228:231], v[144:147], v[68:71], v[228:231]
M v[232:235], v[144:147], v[72:75], v[232:235]
M v[236:239], v[144:147], v[76:79], v[236:239]
M v[240:243], v[148:151], v[64:67], v[240:243]
M v[244:247], v[148:151], v[68:71], v[244:247]
M v[248:251], v[148:151], v[72:75], v[248:251]
M v[252:255], v[148:151], v[76:79], v[252:255]
M a[64:67], v[152:155], v[64:67], a[64:67]
M a[68:71], v[152:155], v[68:71], a[68:71]
M a[72:75], v[152:155], v[72:75], a[72:75]
M a[76:79], v[152:155], v[76:79], a[76:79]
M a[80:83], v[156:159], v[64:67], a[80:83]
M a[84:87], v[156:159], v[68:71], a[84:87]
M a[88:91], v[156:159], v[72:75], a[88:91]
M a[92:95], v[156:159], v[76:79], a[92:95]
s_nop 7
s_add_u32 s57, s57, 32768
s_sub_u32 s58, s58, 64
s_sub_u32 s59, s59, 1
s_cmp_lg_u32 s59, 0
s_cbranch_scc1 Lslow_2
v_accvgpr_read_b32 v20, a96
v_accvgpr_read_b32 v21, a100
v_accvgpr_read_b32 v22, a104
v_accvgpr_read_b32 v23, a108
v_rcp_f32 v8, v20
v_rcp_f32 v9, v21
v_rcp_f32 v10, v22
v_rcp_f32 v11, v23
s_lshl_b32 s33, s56, 20
s_lshl_b32 s34, s20, 15
s_add_u32 s33, s33, s34
s_lshl_b32 s34, s23, 13
s_add_u32 s36, s33, s34
s_add_u32 s37, s36, 4096
s_add_u32 s38, s36, 16384
s_add_u32 s39, s36, 20480
v_pk_mul_f32 v[160:161], v[160:161], v[8:9] op_sel:[0,0] op_sel_hi:[1,0]
v_pk_mul_f32 v[162:163], v[162:163], v[8:9] op_sel:[0,0] op_sel_hi:[1,0]
v_pk_mul_f32 v[176:177], v[176:177], v[8:9] op_sel:[0,0] op_sel_hi:[1,0]
v_pk_mul_f32 v[178:179], v[178:179], v[8:9] op_sel:[0,0] op_sel_hi:[1,0]
v_cvt_pk_bf16_f32 v160, v160, v161
v_cvt_pk_bf16_f32 v161, v162, v163
v_cvt_pk_bf16_f32 v162, v176, v177
v_cvt_pk_bf16_f32 v163, v178, v179
v_pk_mul_f32 v[164:165], v[164:165], v[8:9] op_sel:[0,1] op_sel_hi:[1,1]
v_pk_mul_f32 v[166:167], v[166:167], v[8:9] op_sel:[0,1] op_sel_hi:[1,1]
v_pk_mul_f32 v[180:181], v[180:181], v[8:9] op_sel:[0,1] op_sel_hi:[1,1]
v_pk_mul_f32 v[182:183], v[182:183], v[8:9] op_sel:[0,1] op_sel_hi:[1,1]
v_cvt_pk_bf16_f32 v164, v164, v165
v_cvt_pk_bf16_f32 v165, v166, v167
v_cvt_pk_bf16_f32 v166, v180, v181
v_cvt_pk_bf16_f32 v167, v182, v183
v_pk_mul_f32 v[168:169], v[168:169], v[10:11] op_sel:[0,0] op_sel_hi:[1,0]
v_pk_mul_f32 v[170:171], v[170:171], v[10:11] op_sel:[0,0] op_sel_hi:[1,0]
v_pk_mul_f32 v[184:185], v[184:185], v[10:11] op_sel:[0,0] op_sel_hi:[1,0]
v_pk_mul_f32 v[186:187], v[186:187], v[10:11] op_sel:[0,0] op_sel_hi:[1,0]
v_cvt_pk_bf16_f32 v168, v168, v169
v_cvt_pk_bf16_f32 v169, v170, v171
v_cvt_pk_bf16_f32 v170, v184, v185
v_cvt_pk_bf16_f32 v171, v186, v187
v_pk_mul_f32 v[172:173], v[172:173], v[10:11] op_sel:[0,1] op_sel_hi:[1,1]
v_pk_mul_f32 v[174:175], v[174:175], v[10:11] op_sel:[0,1] op_sel_hi:[1,1]
v_pk_mul_f32 v[188:189], v[188:189], v[10:11] op_sel:[0,1] op_sel_hi:[1,1]
v_pk_mul_f32 v[190:191], v[190:191], v[10:11] op_sel:[0,1] op_sel_hi:[1,1]
v_cvt_pk_bf16_f32 v172, v172, v173
v_cvt_pk_bf16_f32 v173, v174, v175
v_cvt_pk_bf16_f32 v174, v188, v189
v_cvt_pk_bf16_f32 v175, v190, v191
v_pk_mul_f32 v[192:193], v[192:193], v[8:9] op_sel:[0,0] op_sel_hi:[1,0]
v_pk_mul_f32 v[194:195], v[194:195], v[8:9] op_sel:[0,0] op_sel_hi:[1,0]
v_pk_mul_f32 v[208:209], v[208:209], v[8:9] op_sel:[0,0] op_sel_hi:[1,0]
v_pk_mul_f32 v[210:211], v[210:211], v[8:9] op_sel:[0,0] op_sel_hi:[1,0]
v_cvt_pk_bf16_f32 v192, v192, v193
v_cvt_pk_bf16_f32 v193, v194, v195
v_cvt_pk_bf16_f32 v194, v208, v209
v_cvt_pk_bf16_f32 v195, v210, v211
v_pk_mul_f32 v[196:197], v[196:197], v[8:9] op_sel:[0,1] op_sel_hi:[1,1]
v_pk_mul_f32 v[198:199], v[198:199], v[8:9] op_sel:[0,1] op_sel_hi:[1,1]
v_pk_mul_f32 v[212:213], v[212:213], v[8:9] op_sel:[0,1] op_sel_hi:[1,1]
v_pk_mul_f32 v[214:215], v[214:215], v[8:9] op_sel:[0,1] op_sel_hi:[1,1]
v_cvt_pk_bf16_f32 v196, v196, v197
v_cvt_pk_bf16_f32 v197, v198, v199
v_cvt_pk_bf16_f32 v198, v212, v213
v_cvt_pk_bf16_f32 v199, v214, v215
v_pk_mul_f32 v[200:201], v[200:201], v[10:11] op_sel:[0,0] op_sel_hi:[1,0]
v_pk_mul_f32 v[202:203], v[202:203], v[10:11] op_sel:[0,0] op_sel_hi:[1,0]
v_pk_mul_f32 v[216:217], v[216:217], v[10:11] op_sel:[0,0] op_sel_hi:[1,0]
v_pk_mul_f32 v[218:219], v[218:219], v[10:11] op_sel:[0,0] op_sel_hi:[1,0]
v_cvt_pk_bf16_f32 v200, v200, v201
v_cvt_pk_bf16_f32 v201, v202, v203
v_cvt_pk_bf16_f32 v202, v216, v217
v_cvt_pk_bf16_f32 v203, v218, v219
v_pk_mul_f32 v[204:205], v[204:205], v[10:11] op_sel:[0,1] op_sel_hi:[1,1]
v_pk_mul_f32 v[206:207], v[206:207], v[10:11] op_sel:[0,1] op_sel_hi:[1,1]
v_pk_mul_f32 v[220:221], v[220:221], v[10:11] op_sel:[0,1] op_sel_hi:[1,1]
v_pk_mul_f32 v[222:223], v[222:223], v[10:11] op_sel:[0,1] op_sel_hi:[1,1]
v_cvt_pk_bf16_f32 v204, v204, v205
v_cvt_pk_bf16_f32 v205, v206, v207
v_cvt_pk_bf16_f32 v206, v220, v221
v_cvt_pk_bf16_f32 v207, v222, v223
v_pk_mul_f32 v[224:225], v[224:225], v[8:9] op_sel:[0,0] op_sel_hi:[1,0]
v_pk_mul_f32 v[226:227], v[226:227], v[8:9] op_sel:[0,0] op_sel_hi:[1,0]
v_pk_mul_f32 v[240:241], v[240:241], v[8:9] op_sel:[0,0] op_sel_hi:[1,0]
v_pk_mul_f32 v[242:243], v[242:243], v[8:9] op_sel:[0,0] op_sel_hi:[1,0]
v_cvt_pk_bf16_f32 v224, v224, v225
v_cvt_pk_bf16_f32 v225, v226, v227
v_cvt_pk_bf16_f32 v226, v240, v241
v_cvt_pk_bf16_f32 v227, v242, v243
v_pk_mul_f32 v[228:229], v[228:229], v[8:9] op_sel:[0,1] op_sel_hi:[1,1]
v_pk_mul_f32 v[230:231], v[230:231], v[8:9] op_sel:[0,1] op_sel_hi:[1,1]
v_pk_mul_f32 v[244:245], v[244:245], v[8:9] op_sel:[0,1] op_sel_hi:[1,1]
v_pk_mul_f32 v[246:247], v[246:247], v[8:9] op_sel:[0,1] op_sel_hi:[1,1]
v_cvt_pk_bf16_f32 v228, v228, v229
v_cvt_pk_bf16_f32 v229, v230, v231
v_cvt_pk_bf16_f32 v230, v244, v245
v_cvt_pk_bf16_f32 v231, v246, v247
v_pk_mul_f32 v[232:233], v[232:233], v[10:11] op_sel:[0,0] op_sel_hi:[1,0]
v_pk_mul_f32 v[234:235], v[234:235], v[10:11] op_sel:[0,0] op_sel_hi:[1,0]
v_pk_mul_f32 v[248:249], v[248:249], v[10:11] op_sel:[0,0] op_sel_hi:[1,0]
v_pk_mul_f32 v[250:251], v[250:251], v[10:11] op_sel:[0,0] op_sel_hi:[1,0]
v_cvt_pk_bf16_f32 v232, v232, v233
v_cvt_pk_bf16_f32 v233, v234, v235
v_cvt_pk_bf16_f32 v234, v248, v249
v_cvt_pk_bf16_f32 v235, v250, v251
v_pk_mul_f32 v[236:237], v[236:237], v[10:11] op_sel:[0,1] op_sel_hi:[1,1]
v_pk_mul_f32 v[238:239], v[238:239], v[10:11] op_sel:[0,1] op_sel_hi:[1,1]
v_pk_mul_f32 v[252:253], v[252:253], v[10:11] op_sel:[0,1] op_sel_hi:[1,1]
v_pk_mul_f32 v[254:255], v[254:255], v[10:11] op_sel:[0,1] op_sel_hi:[1,1]
v_cvt_pk_bf16_f32 v236, v236, v237
v_cvt_pk_bf16_f32 v237, v238, v239
v_cvt_pk_bf16_f32 v238, v252, v253
v_cvt_pk_bf16_f32 v239, v254, v255
v_accvgpr_read_b32 v176, a64
v_accvgpr_read_b32 v177, a65
v_accvgpr_read_b32 v178, a66
v_accvgpr_read_b32 v179, a67
v_accvgpr_read_b32 v180, a80
v_accvgpr_read_b32 v181, a81
v_accvgpr_read_b32 v182, a82
v_accvgpr_read_b32 v183, a83
v_pk_mul_f32 v[176:177], v[176:177], v[8:9] op_sel:[0,0] op_sel_hi:[1,0]
v_pk_mul_f32 v[178:179], v[178:179], v[8:9] op_sel:[0,0] op_sel_hi:[1,0]
v_pk_mul_f32 v[180:181], v[180:181], v[8:9] op_sel:[0,0] op_sel_hi:[1,0]
v_pk_mul_f32 v[182:183], v[182:183], v[8:9] op_sel:[0,0] op_sel_hi:[1,0]
v_cvt_pk_bf16_f32 v176, v176, v177
v_cvt_pk_bf16_f32 v177, v178, v179
v_cvt_pk_bf16_f32 v178, v180, v181
v_cvt_pk_bf16_f32 v179, v182, v183
v_accvgpr_read_b32 v184, a68
v_accvgpr_read_b32 v185, a69
v_accvgpr_read_b32 v186, a70
v_accvgpr_read_b32 v187, a71
v_accvgpr_read_b32 v188, a84
v_accvgpr_read_b32 v189, a85
v_accvgpr_read_b32 v190, a86
v_accvgpr_read_b32 v191, a87
v_pk_mul_f32 v[184:185], v[184:185], v[8:9] op_sel:[0,1] op_sel_hi:[1,1]
v_pk_mul_f32 v[186:187], v[186:187], v[8:9] op_sel:[0,1] op_sel_hi:[1,1]
v_pk_mul_f32 v[188:189], v[188:189], v[8:9] op_sel:[0,1] op_sel_hi:[1,1]
v_pk_mul_f32 v[190:191], v[190:191], v[8:9] op_sel:[0,1] op_sel_hi:[1,1]
v_cvt_pk_bf16_f32 v184, v184, v185
v_cvt_pk_bf16_f32 v185, v186, v187
v_cvt_pk_bf16_f32 v186, v188, v189
v_cvt_pk_bf16_f32 v187, v190, v191
v_accvgpr_read_b32 v208, a72
v_accvgpr_read_b32 v209, a73
v_accvgpr_read_b32 v210, a74
v_accvgpr_read_b32 v211, a75
v_accvgpr_read_b32 v212, a88
v_accvgpr_read_b32 v213, a89
v_accvgpr_read_b32 v214, a90
v_accvgpr_read_b32 v215, a91
v_pk_mul_f32 v[208:209], v[208:209], v[10:11] op_sel:[0,0] op_sel_hi:[1,0]
v_pk_mul_f32 v[210:211], v[210:211], v[10:11] op_sel:[0,0] op_sel_hi:[1,0]
v_pk_mul_f32 v[212:213], v[212:213], v[10:11] op_sel:[0,0] op_sel_hi:[1,0]
v_pk_mul_f32 v[214:215], v[214:215], v[10:11] op_sel:[0,0] op_sel_hi:[1,0]
v_cvt_pk_bf16_f32 v208, v208, v209
v_cvt_pk_bf16_f32 v209, v210, v211
v_cvt_pk_bf16_f32 v210, v212, v213
v_cvt_pk_bf16_f32 v211, v214, v215
v_accvgpr_read_b32 v216, a76
v_accvgpr_read_b32 v217, a77
v_accvgpr_read_b32 v218, a78
v_accvgpr_read_b32 v219, a79
v_accvgpr_read_b32 v220, a92
v_accvgpr_read_b32 v221, a93
v_accvgpr_read_b32 v222, a94
v_accvgpr_read_b32 v223, a95
v_pk_mul_f32 v[216:217], v[216:217], v[10:11] op_sel:[0,1] op_sel_hi:[1,1]
v_pk_mul_f32 v[218:219], v[218:219], v[10:11] op_sel:[0,1] op_sel_hi:[1,1]
v_pk_mul_f32 v[220:221], v[220:221], v[10:11] op_sel:[0,1] op_sel_hi:[1,1]
v_pk_mul_f32 v[222:223], v[222:223], v[10:11] op_sel:[0,1] op_sel_hi:[1,1]
v_cvt_pk_bf16_f32 v216, v216, v217
v_cvt_pk_bf16_f32 v217, v218, v219
v_cvt_pk_bf16_f32 v218, v220, v221
v_cvt_pk_bf16_f32 v219, v222, v223
s_bitcmp1_b32 s61, 0
s_cbranch_scc0 Lss_3
buffer_store_dwordx4 v[160:163], v1, s[16:19], s36 offen offset:0 sc1
buffer_store_dwordx4 v[164:167], v1, s[16:19], s36 offen offset:2048 sc1
buffer_store_dwordx4 v[168:171], v1, s[16:19], s37 offen offset:0 sc1
buffer_store_dwordx4 v[172:175], v1, s[16:19], s37 offen offset:2048 sc1
Lss_3:
s_bitcmp1_b32 s61, 1
s_cbranch_scc0 Lss_4
buffer_store_dwordx4 v[192:195], v1, s[16:19], s36 offen offset:1024 sc1
buffer_store_dwordx4 v[196:199], v1, s[16:19], s36 offen offset:3072 sc1
buffer_store_dwordx4 v[200:203], v1, s[16:19], s37 offen offset:1024 sc1
buffer_store_dwordx4 v[204:207], v1, s[16:19], s37 offen offset:3072 sc1
Lss_4:
s_bitcmp1_b32 s61, 2
s_cbranch_scc0 Lss_5
buffer_store_dwordx4 v[224:227], v1, s[16:19], s38 offen offset:0 sc1
buffer_store_dwordx4 v[228:231], v1, s[16:19], s38 offen offset:2048 sc1
buffer_store_dwordx4 v[232:235], v1, s[16:19], s39 offen offset:0 sc1
buffer_store_dwordx4 v[236:239], v1, s[16:19], s39 offen offset:2048 sc1
Lss_5:
s_bitcmp1_b32 s61, 3
s_cbranch_scc0 Lss_6
buffer_store_dwordx4 v[176:179], v1, s[16:19], s38 offen offset:1024 sc1
buffer_store_dwordx4 v[184:187], v1, s[16:19], s38 offen offset:3072 sc1
buffer_store_dwordx4 v[208:211], v1, s[16:19], s39 offen offset:1024 sc1
buffer_store_dwordx4 v[216:219], v1, s[16:19], s39 offen offset:3072 sc1
Lss_6:
s_branch Lk2_chk
Lk2_done:
s_lshl_b32 s33, s20, 4
s_add_u32 s33, s33, 8392704
s_sub_u32 s34, 15, s21
s_lshl_b32 s34, s34, 9
s_add_u32 s92, s33, s34
s_lshl_b32 s34, s22, 2
s_add_u32 s92, s92, s34
s_lshl_b32 s34, s21, 9
s_add_u32 s93, s33, s34
s_lshl_b32 s34, s23, 3
s_add_u32 s93, s93, s34
s_cmp_eq_u32 s24, 0
s_cselect_b32 s93, s93, s92
s_cselect_b32 s94, 4, 0
s_add_u32 s94, s94, s93
s_load_dwordx2 s[10:11], s[0:1], 40
s_load_dwordx2 s[14:15], s[0:1], 72
s_lshl_b32 s21, s27, 7
s_lshl_b32 s22, s28, 6
s_lshl_b32 s3, s101, 4
v_lshrrev_b32 v224, 3, v0
v_and_b32 v225, 6, v224
v_and_b32 v226, 7, v0
v_xor_b32 v225, v225, v226
v_add_u32 v224, s3, v224
v_lshlrev_b32 v224, 11, v224
v_lshl_add_u32 v6, v225, 4, v224
v_add_u32 v7, 15360, v6
v_lshrrev_b32 v224, 2, v0
v_and_b32 v226, 1, v0
v_bfe_u32 v229, v0, 1, 1
v_lshlrev_b32 v225, 7, v224
v_lshl_add_u32 v225, v226, 3, v225
v_and_b32 v228, 6, v224
v_add_u32 v227, 0, v229
v_xor_b32 v227, v227, v228
v_lshl_add_u32 v24, v227, 4, v225
v_add_u32 v28, 0x10000, v24
v_add_u32 v227, 2, v229
v_xor_b32 v227, v227, v228
v_lshl_add_u32 v25, v227, 4, v225
v_add_u32 v29, 0x10000, v25
v_add_u32 v227, 4, v229
v_xor_b32 v227, v227, v228
v_lshl_add_u32 v26, v227, 4, v225
v_add_u32 v30, 0x10000, v26
v_add_u32 v227, 6, v229
v_xor_b32 v227, v227, v228
v_lshl_add_u32 v27, v227, 4, v225
v_add_u32 v31, 0x10000, v27
s_waitcnt vmcnt(32)
s_barrier
ds_read_b64_tr_b16 v[96:97], v28 offset:0
ds_read_b64_tr_b16 v[98:99], v28 offset:2048
ds_read_b64_tr_b16 v[100:101], v28 offset:4096
ds_read_b64_tr_b16 v[102:103], v28 offset:6144
ds_read_b64_tr_b16 v[104:105], v29 offset:0
ds_read_b64_tr_b16 v[106:107], v29 offset:2048
ds_read_b64_tr_b16 v[108:109], v29 offset:4096
ds_read_b64_tr_b16 v[110:111], v29 offset:6144
ds_read_b64_tr_b16 v[112:113], v30 offset:0
ds_read_b64_tr_b16 v[114:115], v30 offset:2048
ds_read_b64_tr_b16 v[116:117], v30 offset:4096
ds_read_b64_tr_b16 v[118:119], v30 offset:6144
ds_read_b64_tr_b16 v[120:121], v31 offset:0
ds_read_b64_tr_b16 v[122:123], v31 offset:2048
ds_read_b64_tr_b16 v[124:125], v31 offset:4096
ds_read_b64_tr_b16 v[126:127], v31 offset:6144
s_and_b32 s40, s2, 1
s_bfe_u32 s3, s2, 0x10001
s_lshl_b32 s3, s3, 3
s_bfe_u32 s36, s2, 0x30003
s_add_u32 s36, s3, s36
s_lshl_b32 s29, s36, 7
s_bfe_u32 s3, s2, 0x10002
s_lshl_b32 s3, s3, 2
s_lshr_b32 s37, s2, 6
s_add_u32 s3, s3, s37
s_lshl_b32 s13, s3, 8
s_lshl_b32 s30, s3, 7
s_lshl_b32 s3, s40, 6
s_add_u32 s30, s30, s3
s_lshl_b32 s41, s101, 12
s_lshl_b32 s12, s36, 20
s_add_u32 s12, s12, s41
s_lshl_b32 s62, s36, 9
s_lshl_b32 s3, s40, 8
s_add_u32 s62, s62, s3
s_add_u32 s62, s62, 8392704
s_lshr_b32 s3, s2, 1
s_lshr_b32 s38, s2, 2
s_xor_b32 s3, s3, s38
s_and_b32 s3, s3, 1
s_lshl_b32 s3, s3, 4
s_sub_u32 s39, 32, s3
s_lshl_b32 s38, s40, 5
s_add_u32 s3, s3, s38
s_lshl_b32 s3, s3, 14
s_add_u32 s12, s12, s3
s_lshl_b32 s3, s3, 3
s_add_u32 s13, s13, s3
s_mov_b32 s64, 4294459392
s_mov_b32 s65, 16384
s_add_u32 s8, s4, 67108864
s_addc_u32 s9, s5, 0
s_lshl_b32 s56, s2, 15
s_lshl_b32 s38, s101, 13
s_add_u32 s56, s56, s38
s_xor_b32 s57, s56, 32768
s_lshl_b32 s58, s2, 2
s_add_u32 s58, s58, 8388608
s_xor_b32 s59, s58, 4
s_mov_b32 s61, 0
s_lshl_b32 s3, s101, 4
v_lshrrev_b32 v232, 4, v0
v_and_b32 v234, 15, v0
v_add_u32 v233, 0, v232
v_lshlrev_b32 v233, 1, v233
v_xor_b32 v233, v233, v234
v_add_u32 v235, s3, v232
v_lshlrev_b32 v235, 11, v235
v_lshl_add_u32 v235, v233, 4, v235
v_add_u32 v2, 0, v235
v_add_u32 v233, 4, v232
v_lshlrev_b32 v233, 1, v233
v_xor_b32 v233, v233, v234
v_add_u32 v235, s3, v232
v_lshlrev_b32 v235, 11, v235
v_lshl_add_u32 v235, v233, 4, v235
v_add_u32 v3, 7168, v235
v_add_u32 v233, 0, v232
v_lshlrev_b32 v233, 1, v233
v_xor_b32 v233, v233, v234
v_add_u32 v235, s3, v232
v_lshlrev_b32 v235, 11, v235
v_lshl_add_u32 v235, v233, 4, v235
v_add_u32 v4, 14336, v235
v_add_u32 v233, 4, v232
v_lshlrev_b32 v233, 1, v233
v_xor_b32 v233, v233, v234
v_add_u32 v235, s3, v232
v_lshlrev_b32 v235, 11, v235
v_lshl_add_u32 v235, v233, 4, v235
v_add_u32 v5, 21504, v235
v_lshlrev_b32 v225, 8, v224
v_lshl_add_u32 v225, v226, 3, v225
v_and_b32 v228, 7, v224
v_lshlrev_b32 v228, 1, v228
s_lshl_b32 s38, s40, 3
v_xor_b32 v228, s38, v228
v_add_u32 v227, 0, v229
v_xor_b32 v227, v227, v228
v_lshl_add_u32 v8, v227, 4, v225
v_add_u32 v16, 0x10000, v8
v_add_u32 v227, 2, v229
v_xor_b32 v227, v227, v228
v_lshl_add_u32 v9, v227, 4, v225
v_add_u32 v17, 0x10000, v9
v_add_u32 v227, 4, v229
v_xor_b32 v227, v227, v228
v_lshl_add_u32 v10, v227, 4, v225
v_add_u32 v18, 0x10000, v10
v_add_u32 v227, 6, v229
v_xor_b32 v227, v227, v228
v_lshl_add_u32 v11, v227, 4, v225
v_add_u32 v19, 0x10000, v11
v_add_u32 v227, 8, v229
v_xor_b32 v227, v227, v228
v_lshl_add_u32 v12, v227, 4, v225
v_add_u32 v20, 0x10000, v12
v_add_u32 v227, 10, v229
v_xor_b32 v227, v227, v228
v_lshl_add_u32 v13, v227, 4, v225
v_add_u32 v21, 0x10000, v13
v_add_u32 v227, 12, v229
v_xor_b32 v227, v227, v228
v_lshl_add_u32 v14, v227, 4, v225
v_add_u32 v22, 0x10000, v14
v_add_u32 v227, 14, v229
v_xor_b32 v227, v227, v228
v_lshl_add_u32 v15, v227, 4, v225
v_add_u32 v23, 0x10000, v15
v_mov_b32 v253, 0
v_mov_b32 v254, 1
v_lshlrev_b32 v255, 2, v0
s_waitcnt lgkmcnt(0)
s_mov_b32 s16, s14
s_mov_b32 s17, s15
s_mov_b32 s18, 8388608
s_mov_b32 s19, 0x00020000
s_waitcnt vmcnt(26) lgkmcnt(0)
s_barrier
M a[0:3], v[96:99], a[192:195], 0
s_add_u32 m0, s42, 16384
s_nop 0
buffer_load_dwordx4 v6, s[48:51], s26 offen offset:0 lds
ds_read_b64_tr_b16 v[160:161], v28 offset:16384
ds_read_b64_tr_b16 v[162:163], v28 offset:18432
M a[0:3], v[100:103], a[196:199], a[0:3]
buffer_load_dwordx4 v7, s[48:51], s26 offen offset:1024 lds
M a[4:7], v[108:111], a[196:199], 0
ds_read_b64_tr_b16 v[164:165], v28 offset:20480
ds_read_b64_tr_b16 v[166:167], v28 offset:22528
M a[4:7], v[104:107], a[192:195], a[4:7]
buffer_load_dwordx4 a[144:147], v1, s[44:47], s25 offen offset:0 sc1
M a[8:11], v[112:115], a[192:195], 0
ds_read_b64_tr_b16 v[168:169], v29 offset:16384
ds_read_b64_tr_b16 v[170:171], v29 offset:18432
M a[8:11], v[116:119], a[196:199], a[8:11]
buffer_load_dwordx4 a[148:151], v1, s[44:47], s25 offen offset:1024 sc1
M a[12:15], v[124:127], a[196:199], 0
ds_read_b64_tr_b16 v[172:173], v29 offset:20480
ds_read_b64_tr_b16 v[174:175], v29 offset:22528
M a[12:15], v[120:123], a[192:195], a[12:15]
buffer_load_dwordx4 a[152:155], v1, s[44:47], s25 offen offset:2048 sc1
M a[16:19], v[96:99], a[200:203], 0
ds_read_b64_tr_b16 v[176:177], v30 offset:16384
ds_read_b64_tr_b16 v[178:179], v30 offset:18432
M a[16:19], v[100:103], a[204:207], a[16:19]
buffer_load_dwordx4 a[156:159], v1, s[44:47], s25 offen offset:3072 sc1
M a[20:23], v[108:111], a[204:207], 0
ds_read_b64_tr_b16 v[180:181], v30 offset:20480
ds_read_b64_tr_b16 v[182:183], v30 offset:22528
M a[20:23], v[104:107], a[200:203], a[20:23]
s_add_u32 s25, s25, 16384
s_add_u32 s26, s26, 131072
M a[24:27], v[112:115], a[200:203], 0
ds_read_b64_tr_b16 v[184:185], v31 offset:16384
ds_read_b64_tr_b16 v[186:187], v31 offset:18432
M a[24:27], v[116:119], a[204:207], a[24:27]
ds_read_b64_tr_b16 v[188:189], v31 offset:20480
ds_read_b64_tr_b16 v[190:191], v31 offset:22528
M a[28:31], v[124:127], a[204:207], 0
M a[28:31], v[120:123], a[200:203], a[28:31]
s_waitcnt vmcnt(6) lgkmcnt(0)
s_barrier
s_mov_b64 exec, 1
buffer_store_dword v254, v253, s[52:55], s92 offen sc1
buffer_store_dword v254, v253, s[52:55], s93 offen sc1
buffer_store_dword v254, v253, s[52:55], s94 offen sc1
s_mov_b64 exec, -1
M a[0:3], v[160:163], a[208:211], a[0:3]
s_add_u32 m0, s42, 32768
s_nop 0
buffer_load_dwordx4 v6, s[48:51], s26 offen offset:0 lds
ds_read_b64_tr_b16 v[96:97], v28 offset:32768
ds_read_b64_tr_b16 v[98:99], v28 offset:34816
M a[0:3], v[164:167], a[212:215], a[0:3]
buffer_load_dwordx4 v7, s[48:51], s26 offen offset:1024 lds
M a[4:7], v[172:175], a[212:215], a[4:7]
ds_read_b64_tr_b16 v[100:101], v28 offset:36864
ds_read_b64_tr_b16 v[102:103], v28 offset:38912
M a[4:7], v[168:171], a[208:211], a[4:7]
buffer_load_dwordx4 a[160:163], v1, s[44:47], s25 offen offset:0 sc1
M a[8:11], v[176:179], a[208:211], a[8:11]
ds_read_b64_tr_b16 v[104:105], v29 offset:32768
ds_read_b64_tr_b16 v[106:107], v29 offset:34816
M a[8:11], v[180:183], a[212:215], a[8:11]
buffer_load_dwordx4 a[164:167], v1, s[44:47], s25 offen offset:1024 sc1
M a[12:15], v[188:191], a[212:215], a[12:15]
ds_read_b64_tr_b16 v[108:109], v29 offset:36864
ds_read_b64_tr_b16 v[110:111], v29 offset:38912
M a[12:15], v[184:187], a[208:211], a[12:15]
buffer_load_dwordx4 a[168:171], v1, s[44:47], s25 offen offset:2048 sc1
M a[16:19], v[160:163], a[216:219], a[16:19]
ds_read_b64_tr_b16 v[112:113], v30 offset:32768
ds_read_b64_tr_b16 v[114:115], v30 offset:34816
M a[16:19], v[164:167], a[220:223], a[16:19]
buffer_load_dwordx4 a[172:175], v1, s[44:47], s25 offen offset:3072 sc1
M a[20:23], v[172:175], a[220:223], a[20:23]
ds_read_b64_tr_b16 v[116:117], v30 offset:36864
ds_read_b64_tr_b16 v[118:119], v30 offset:38912
M a[20:23], v[168:171], a[216:219], a[20:23]
s_add_u32 s25, s25, 16384
s_add_u32 s26, s26, 131072
M a[24:27], v[176:179], a[216:219], a[24:27]
ds_read_b64_tr_b16 v[120:121], v31 offset:32768
ds_read_b64_tr_b16 v[122:123], v31 offset:34816
M a[24:27], v[180:183], a[220:223], a[24:27]
ds_read_b64_tr_b16 v[124:125], v31 offset:36864
ds_read_b64_tr_b16 v[126:127], v31 offset:38912
M a[28:31], v[188:191], a[220:223], a[28:31]
M a[28:31], v[184:187], a[216:219], a[28:31]
s_waitcnt vmcnt(29) lgkmcnt(0)
s_barrier
M a[0:3], v[96:99], a[224:227], a[0:3]
s_add_u32 m0, s42, 49152
s_nop 0
buffer_load_dwordx4 v6, s[48:51], s26 offen offset:0 lds
ds_read_b64_tr_b16 v[160:161], v28 offset:49152
ds_read_b64_tr_b16 v[162:163], v28 offset:51200
M a[0:3], v[100:103], a[228:231], a[0:3]
buffer_load_dwordx4 v7, s[48:51], s26 offen offset:1024 lds
M a[4:7], v[108:111], a[228:231], a[4:7]
ds_read_b64_tr_b16 v[164:165], v28 offset:53248
ds_read_b64_tr_b16 v[166:167], v28 offset:55296
M a[4:7], v[104:107], a[224:227], a[4:7]
buffer_load_dwordx4 a[176:179], v1, s[44:47], s25 offen offset:0 sc1
M a[8:11], v[112:115], a[224:227], a[8:11]
ds_read_b64_tr_b16 v[168:169], v29 offset:49152
ds_read_b64_tr_b16 v[170:171], v29 offset:51200
M a[8:11], v[116:119], a[228:231], a[8:11]
buffer_load_dwordx4 a[180:183], v1, s[44:47], s25 offen offset:1024 sc1
M a[12:15], v[124:127], a[228:231], a[12:15]
ds_read_b64_tr_b16 v[172:173], v29 offset:53248
ds_read_b64_tr_b16 v[174:175], v29 offset:55296
M a[12:15], v[120:123], a[224:227], a[12:15]
buffer_load_dwordx4 a[184:187], v1, s[44:47], s25 offen offset:2048 sc1
ds_read_b64_tr_b16 v[176:177], v30 offset:49152
ds_read_b64_tr_b16 v[178:179], v30 offset:51200
M a[16:19], v[96:99], a[232:235], a[16:19]
buffer_load_dwordx4 a[188:191], v1, s[44:47], s25 offen offset:3072 sc1
M a[16:19], v[100:103], a[236:239], a[16:19]
ds_read_b64_tr_b16 v[180:181], v30 offset:53248
ds_read_b64_tr_b16 v[182:183], v30 offset:55296
M a[20:23], v[108:111], a[236:239], a[20:23]
s_add_u32 s25, s25, 16384
s_add_u32 s26, s26, 131072
M a[20:23], v[104:107], a[232:235], a[20:23]
ds_read_b64_tr_b16 v[184:185], v31 offset:49152
ds_read_b64_tr_b16 v[186:187], v31 offset:51200
M a[24:27], v[112:115], a[232:235], a[24:27]
buffer_load_dword v252, v255, s[52:55], s62 offen sc1
M a[24:27], v[116:119], a[236:239], a[24:27]
ds_read_b64_tr_b16 v[188:189], v31 offset:53248
ds_read_b64_tr_b16 v[190:191], v31 offset:55296
M a[28:31], v[124:127], a[236:239], a[28:31]
M a[28:31], v[120:123], a[232:235], a[28:31]
s_waitcnt vmcnt(30) lgkmcnt(0)
s_barrier
s_waitcnt vmcnt(0)
v_cmp_ne_u32 vcc, 1, v252
s_nop 0
s_cbranch_vccnz Lk3_spinft
Lk3_gotft:
M a[0:3], v[160:163], a[240:243], a[0:3]
s_mov_b32 s32, s25
s_mov_b32 s33, s26
s_mov_b64 s[34:35], s[44:45]
s_mov_b64 s[36:37], s[48:49]
s_mov_b64 s[44:45], s[8:9]
s_mov_b32 s46, 16777216
s_mov_b64 s[48:49], s[10:11]
s_mov_b32 s50, 8388608
s_mov_b32 s25, s12
s_mov_b32 s26, s13
s_add_u32 m0, s41, 65536
s_nop 0
buffer_load_dwordx4 v2, s[48:51], s26 offen offset:0 lds
ds_read_b64_tr_b16 v[96:97], v24 offset:0
ds_read_b64_tr_b16 v[98:99], v24 offset:2048
M a[0:3], v[164:167], a[244:247], a[0:3]
buffer_load_dwordx4 v3, s[48:51], s26 offen offset:1024 lds
M a[4:7], v[172:175], a[244:247], a[4:7]
ds_read_b64_tr_b16 v[100:101], v24 offset:4096
ds_read_b64_tr_b16 v[102:103], v24 offset:6144
M a[4:7], v[168:171], a[240:243], a[4:7]
buffer_load_dwordx4 v4, s[48:51], s26 offen offset:2048 lds
ds_read_b64_tr_b16 v[104:105], v25 offset:0
ds_read_b64_tr_b16 v[106:107], v25 offset:2048
M a[8:11], v[176:179], a[240:243], a[8:11]
buffer_load_dwordx4 v5, s[48:51], s26 offen offset:3072 lds
M a[8:11], v[180:183], a[244:247], a[8:11]
ds_read_b64_tr_b16 v[108:109], v25 offset:4096
ds_read_b64_tr_b16 v[110:111], v25 offset:6144
M a[12:15], v[188:191], a[244:247], a[12:15]
buffer_load_dwordx4 a[192:195], v1, s[44:47], s25 offen offset:0 sc1
M a[12:15], v[184:187], a[240:243], a[12:15]
ds_read_b64_tr_b16 v[112:113], v26 offset:0
ds_read_b64_tr_b16 v[114:115], v26 offset:2048
buffer_load_dwordx4 a[196:199], v1, s[44:47], s25 offen offset:1024 sc1
M a[16:19], v[160:163], a[248:251], a[16:19]
ds_read_b64_tr_b16 v[116:117], v26 offset:4096
ds_read_b64_tr_b16 v[118:119], v26 offset:6144
M a[16:19], v[164:167], a[252:255], a[16:19]
buffer_load_dwordx4 a[200:203], v1, s[44:47], s25 offen offset:2048 sc1
M a[20:23], v[172:175], a[252:255], a[20:23]
ds_read_b64_tr_b16 v[120:121], v27 offset:0
ds_read_b64_tr_b16 v[122:123], v27 offset:2048
buffer_load_dwordx4 a[204:207], v1, s[44:47], s25 offen offset:3072 sc1
M a[20:23], v[168:171], a[248:251], a[20:23]
ds_read_b64_tr_b16 v[124:125], v27 offset:4096
ds_read_b64_tr_b16 v[126:127], v27 offset:6144
M a[24:27], v[176:179], a[248:251], a[24:27]
s_sub_u32 s39, s39, 1
s_cmp_eq_u32 s39, 0
s_cselect_b32 s3, s64, s65
M a[24:27], v[180:183], a[252:255], a[24:27]
s_add_u32 s25, s25, s3
s_lshl_b32 s3, s3, 3
s_add_u32 s26, s26, s3
M a[28:31], v[188:191], a[252:255], a[28:31]
M a[28:31], v[184:187], a[248:251], a[28:31]
s_waitcnt vmcnt(24) lgkmcnt(0)
s_barrier
M a[0:3], v[96:99], a[128:131], a[0:3]
s_add_u32 m0, s41, 81920
s_nop 0
buffer_load_dwordx4 v2, s[48:51], s26 offen offset:0 lds
ds_read_b64_tr_b16 v[160:161], v24 offset:16384
ds_read_b64_tr_b16 v[162:163], v24 offset:18432
M a[0:3], v[100:103], a[132:135], a[0:3]
buffer_load_dwordx4 v3, s[48:51], s26 offen offset:1024 lds
M a[4:7], v[108:111], a[132:135], a[4:7]
ds_read_b64_tr_b16 v[164:165], v24 offset:20480
ds_read_b64_tr_b16 v[166:167], v24 offset:22528
M a[4:7], v[104:107], a[128:131], a[4:7]
buffer_load_dwordx4 v4, s[48:51], s26 offen offset:2048 lds
ds_read_b64_tr_b16 v[168:169], v25 offset:16384
ds_read_b64_tr_b16 v[170:171], v25 offset:18432
M a[8:11], v[112:115], a[128:131], a[8:11]
buffer_load_dwordx4 v5, s[48:51], s26 offen offset:3072 lds
M a[8:11], v[116:119], a[132:135], a[8:11]
ds_read_b64_tr_b16 v[172:173], v25 offset:20480
ds_read_b64_tr_b16 v[174:175], v25 offset:22528
M a[12:15], v[124:127], a[132:135], a[12:15]
buffer_load_dwordx4 a[208:211], v1, s[44:47], s25 offen offset:0 sc1
M a[12:15], v[120:123], a[128:131], a[12:15]
ds_read_b64_tr_b16 v[176:177], v26 offset:16384
ds_read_b64_tr_b16 v[178:179], v26 offset:18432
buffer_load_dwordx4 a[212:215], v1, s[44:47], s25 offen offset:1024 sc1
M a[16:19], v[96:99], a[136:139], a[16:19]
ds_read_b64_tr_b16 v[180:181], v26 offset:20480
ds_read_b64_tr_b16 v[182:183], v26 offset:22528
M a[16:19], v[100:103], a[140:143], a[16:19]
buffer_load_dwordx4 a[216:219], v1, s[44:47], s25 offen offset:2048 sc1
M a[20:23], v[108:111], a[140:143], a[20:23]
ds_read_b64_tr_b16 v[184:185], v27 offset:16384
ds_read_b64_tr_b16 v[186:187], v27 offset:18432
buffer_load_dwordx4 a[220:223], v1, s[44:47], s25 offen offset:3072 sc1
M a[20:23], v[104:107], a[136:139], a[20:23]
ds_read_b64_tr_b16 v[188:189], v27 offset:20480
ds_read_b64_tr_b16 v[190:191], v27 offset:22528
M a[24:27], v[112:115], a[136:139], a[24:27]
s_sub_u32 s39, s39, 1
s_cmp_eq_u32 s39, 0
s_cselect_b32 s3, s64, s65
M a[24:27], v[116:119], a[140:143], a[24:27]
s_add_u32 s25, s25, s3
s_lshl_b32 s3, s3, 3
s_add_u32 s26, s26, s3
M a[28:31], v[124:127], a[140:143], a[28:31]
M a[28:31], v[120:123], a[136:139], a[28:31]
s_waitcnt vmcnt(23) lgkmcnt(0)
s_barrier
M a[0:3], v[160:163], a[144:147], a[0:3]
s_add_u32 m0, s41, 98304
s_nop 0
buffer_load_dwordx4 v2, s[48:51], s26 offen offset:0 lds
ds_read_b64_tr_b16 v[96:97], v24 offset:32768
ds_read_b64_tr_b16 v[98:99], v24 offset:34816
M a[0:3], v[164:167], a[148:151], a[0:3]
buffer_load_dwordx4 v3, s[48:51], s26 offen offset:1024 lds
M a[4:7], v[172:175], a[148:151], a[4:7]
ds_read_b64_tr_b16 v[100:101], v24 offset:36864
ds_read_b64_tr_b16 v[102:103], v24 offset:38912
M a[4:7], v[168:171], a[144:147], a[4:7]
buffer_load_dwordx4 v4, s[48:51], s26 offen offset:2048 lds
ds_read_b64_tr_b16 v[104:105], v25 offset:32768
ds_read_b64_tr_b16 v[106:107], v25 offset:34816
M a[8:11], v[176:179], a[144:147], a[8:11]
buffer_load_dwordx4 v5, s[48:51], s26 offen offset:3072 lds
M a[8:11], v[180:183], a[148:151], a[8:11]
ds_read_b64_tr_b16 v[108:109], v25 offset:36864
ds_read_b64_tr_b16 v[110:111], v25 offset:38912
M a[12:15], v[188:191], a[148:151], a[12:15]
buffer_load_dwordx4 a[224:227], v1, s[44:47], s25 offen offset:0 sc1
M a[12:15], v[184:187], a[144:147], a[12:15]
ds_read_b64_tr_b16 v[112:113], v26 offset:32768
ds_read_b64_tr_b16 v[114:115], v26 offset:34816
buffer_load_dwordx4 a[228:231], v1, s[44:47], s25 offen offset:1024 sc1
M a[16:19], v[160:163], a[152:155], a[16:19]
ds_read_b64_tr_b16 v[116:117], v26 offset:36864
ds_read_b64_tr_b16 v[118:119], v26 offset:38912
M a[16:19], v[164:167], a[156:159], a[16:19]
buffer_load_dwordx4 a[232:235], v1, s[44:47], s25 offen offset:2048 sc1
M a[20:23], v[172:175], a[156:159], a[20:23]
ds_read_b64_tr_b16 v[120:121], v27 offset:32768
ds_read_b64_tr_b16 v[122:123], v27 offset:34816
buffer_load_dwordx4 a[236:239], v1, s[44:47], s25 offen offset:3072 sc1
M a[20:23], v[168:171], a[152:155], a[20:23]
ds_read_b64_tr_b16 v[124:125], v27 offset:36864
ds_read_b64_tr_b16 v[126:127], v27 offset:38912
M a[24:27], v[176:179], a[152:155], a[24:27]
s_sub_u32 s39, s39, 1
s_cmp_eq_u32 s39, 0
s_cselect_b32 s3, s64, s65
M a[24:27], v[180:183], a[156:159], a[24:27]
s_add_u32 s25, s25, s3
s_lshl_b32 s3, s3, 3
s_add_u32 s26, s26, s3
M a[28:31], v[188:191], a[156:159], a[28:31]
M a[28:31], v[184:187], a[152:155], a[28:31]
s_waitcnt vmcnt(25) lgkmcnt(0)
s_barrier
M a[0:3], v[96:99], a[160:163], a[0:3]
s_add_u32 m0, s41, 114688
s_nop 0
buffer_load_dwordx4 v2, s[48:51], s26 offen offset:0 lds
ds_read_b64_tr_b16 v[160:161], v24 offset:49152
ds_read_b64_tr_b16 v[162:163], v24 offset:51200
M a[0:3], v[100:103], a[164:167], a[0:3]
buffer_load_dwordx4 v3, s[48:51], s26 offen offset:1024 lds
M a[4:7], v[108:111], a[164:167], a[4:7]
ds_read_b64_tr_b16 v[164:165], v24 offset:53248
ds_read_b64_tr_b16 v[166:167], v24 offset:55296
M a[4:7], v[104:107], a[160:163], a[4:7]
buffer_load_dwordx4 v4, s[48:51], s26 offen offset:2048 lds
ds_read_b64_tr_b16 v[168:169], v25 offset:49152
ds_read_b64_tr_b16 v[170:171], v25 offset:51200
M a[8:11], v[112:115], a[160:163], a[8:11]
buffer_load_dwordx4 v5, s[48:51], s26 offen offset:3072 lds
M a[8:11], v[116:119], a[164:167], a[8:11]
ds_read_b64_tr_b16 v[172:173], v25 offset:53248
ds_read_b64_tr_b16 v[174:175], v25 offset:55296
M a[12:15], v[124:127], a[164:167], a[12:15]
buffer_load_dwordx4 a[240:243], v1, s[44:47], s25 offen offset:0 sc1
M a[12:15], v[120:123], a[160:163], a[12:15]
ds_read_b64_tr_b16 v[176:177], v26 offset:49152
ds_read_b64_tr_b16 v[178:179], v26 offset:51200
buffer_load_dwordx4 a[244:247], v1, s[44:47], s25 offen offset:1024 sc1
M a[16:19], v[96:99], a[168:171], a[16:19]
ds_read_b64_tr_b16 v[180:181], v26 offset:53248
ds_read_b64_tr_b16 v[182:183], v26 offset:55296
M a[16:19], v[100:103], a[172:175], a[16:19]
buffer_load_dwordx4 a[248:251], v1, s[44:47], s25 offen offset:2048 sc1
M a[20:23], v[108:111], a[172:175], a[20:23]
ds_read_b64_tr_b16 v[184:185], v27 offset:49152
ds_read_b64_tr_b16 v[186:187], v27 offset:51200
buffer_load_dwordx4 a[252:255], v1, s[44:47], s25 offen offset:3072 sc1
M a[20:23], v[104:107], a[168:171], a[20:23]
ds_read_b64_tr_b16 v[188:189], v27 offset:53248
ds_read_b64_tr_b16 v[190:191], v27 offset:55296
M a[24:27], v[112:115], a[168:171], a[24:27]
s_sub_u32 s39, s39, 1
s_cmp_eq_u32 s39, 0
s_cselect_b32 s3, s64, s65
M a[24:27], v[116:119], a[172:175], a[24:27]
s_add_u32 s25, s25, s3
s_lshl_b32 s3, s3, 3
s_add_u32 s26, s26, s3
M a[28:31], v[124:127], a[172:175], a[28:31]
M a[28:31], v[120:123], a[168:171], a[28:31]
s_waitcnt vmcnt(24) lgkmcnt(0)
s_barrier
M a[0:3], v[160:163], a[176:179], a[0:3]
s_add_u32 m0, s41, 0
s_nop 0
buffer_load_dwordx4 v2, s[48:51], s26 offen offset:0 lds
ds_read_b64_tr_b16 v[96:97], v16 offset:0
ds_read_b64_tr_b16 v[98:99], v16 offset:4096
M a[0:3], v[164:167], a[180:183], a[0:3]
buffer_load_dwordx4 v3, s[48:51], s26 offen offset:1024 lds
ds_read_b64_tr_b16 v[100:101], v16 offset:8192
ds_read_b64_tr_b16 v[102:103], v16 offset:12288
M a[4:7], v[172:175], a[180:183], a[4:7]
buffer_load_dwordx4 v4, s[48:51], s26 offen offset:2048 lds
ds_read_b64_tr_b16 v[104:105], v17 offset:0
ds_read_b64_tr_b16 v[106:107], v17 offset:4096
M a[4:7], v[168:171], a[176:179], a[4:7]
buffer_load_dwordx4 v5, s[48:51], s26 offen offset:3072 lds
ds_read_b64_tr_b16 v[108:109], v17 offset:8192
ds_read_b64_tr_b16 v[110:111], v17 offset:12288
M a[8:11], v[176:179], a[176:179], a[8:11]
buffer_load_dwordx4 a[128:131], v1, s[44:47], s25 offen offset:0 sc1
ds_read_b64_tr_b16 v[112:113], v18 offset:0
ds_read_b64_tr_b16 v[114:115], v18 offset:4096
M a[8:11], v[180:183], a[180:183], a[8:11]
buffer_load_dwordx4 a[132:135], v1, s[44:47], s25 offen offset:1024 sc1
ds_read_b64_tr_b16 v[116:117], v18 offset:8192
ds_read_b64_tr_b16 v[118:119], v18 offset:12288
M a[12:15], v[188:191], a[180:183], a[12:15]
buffer_load_dwordx4 a[136:139], v1, s[44:47], s25 offen offset:2048 sc1
M a[12:15], v[184:187], a[176:179], a[12:15]
ds_read_b64_tr_b16 v[120:121], v19 offset:0
ds_read_b64_tr_b16 v[122:123], v19 offset:4096
buffer_load_dwordx4 a[140:143], v1, s[44:47], s25 offen offset:3072 sc1
M a[16:19], v[160:163], a[184:187], a[16:19]
ds_read_b64_tr_b16 v[124:125], v19 offset:8192
ds_read_b64_tr_b16 v[126:127], v19 offset:12288
s_sub_u32 s39, s39, 1
s_cmp_eq_u32 s39, 0
s_cselect_b32 s3, s64, s65
M a[16:19], v[164:167], a[188:191], a[16:19]
ds_read_b64_tr_b16 v[128:129], v20 offset:0
ds_read_b64_tr_b16 v[130:131], v20 offset:4096
s_add_u32 s25, s25, s3
s_lshl_b32 s3, s3, 3
s_add_u32 s26, s26, s3
M a[20:23], v[172:175], a[188:191], a[20:23]
ds_read_b64_tr_b16 v[132:133], v20 offset:8192
ds_read_b64_tr_b16 v[134:135], v20 offset:12288
ds_read_b64_tr_b16 v[136:137], v21 offset:0
ds_read_b64_tr_b16 v[138:139], v21 offset:4096
M a[20:23], v[168:171], a[184:187], a[20:23]
ds_read_b64_tr_b16 v[140:141], v21 offset:8192
ds_read_b64_tr_b16 v[142:143], v21 offset:12288
ds_read_b64_tr_b16 v[144:145], v22 offset:0
ds_read_b64_tr_b16 v[146:147], v22 offset:4096
M a[24:27], v[176:179], a[184:187], a[24:27]
ds_read_b64_tr_b16 v[148:149], v22 offset:8192
ds_read_b64_tr_b16 v[150:151], v22 offset:12288
ds_read_b64_tr_b16 v[152:153], v23 offset:0
ds_read_b64_tr_b16 v[154:155], v23 offset:4096
M a[24:27], v[180:183], a[188:191], a[24:27]
ds_read_b64_tr_b16 v[156:157], v23 offset:8192
ds_read_b64_tr_b16 v[158:159], v23 offset:12288
M a[28:31], v[188:191], a[188:191], a[28:31]
M a[28:31], v[184:187], a[184:187], a[28:31]
s_waitcnt vmcnt(24) lgkmcnt(0)
s_barrier
M v[32:35], v[96:99], a[192:195], 0
s_add_u32 m0, s41, 16384
s_nop 0
buffer_load_dwordx4 v2, s[48:51], s26 offen offset:0 lds
M v[32:35], v[100:103], a[196:199], v[32:35]
ds_read_b64_tr_b16 v[160:161], v16 offset:16384
ds_read_b64_tr_b16 v[162:163], v16 offset:20480
M v[36:39], v[108:111], a[196:199], 0
buffer_load_dwordx4 v3, s[48:51], s26 offen offset:1024 lds
M v[36:39], v[104:107], a[192:195], v[36:39]
ds_read_b64_tr_b16 v[164:165], v16 offset:24576
ds_read_b64_tr_b16 v[166:167], v16 offset:28672
M v[40:43], v[112:115], a[192:195], 0
buffer_load_dwordx4 v4, s[48:51], s26 offen offset:2048 lds
M v[40:43], v[116:119], a[196:199], v[40:43]
ds_read_b64_tr_b16 v[168:169], v17 offset:16384
ds_read_b64_tr_b16 v[170:171], v17 offset:20480
M v[44:47], v[124:127], a[196:199], 0
buffer_load_dwordx4 v5, s[48:51], s26 offen offset:3072 lds
M v[44:47], v[120:123], a[192:195], v[44:47]
M v[48:51], v[128:131], a[192:195], 0
ds_read_b64_tr_b16 v[172:173], v17 offset:24576
ds_read_b64_tr_b16 v[174:175], v17 offset:28672
M v[48:51], v[132:135], a[196:199], v[48:51]
buffer_load_dwordx4 a[144:147], v1, s[44:47], s25 offen offset:0 sc1
M v[52:55], v[140:143], a[196:199], 0
ds_read_b64_tr_b16 v[176:177], v18 offset:16384
ds_read_b64_tr_b16 v[178:179], v18 offset:20480
M v[52:55], v[136:139], a[192:195], v[52:55]
buffer_load_dwordx4 a[148:151], v1, s[44:47], s25 offen offset:1024 sc1
M v[56:59], v[144:147], a[192:195], 0
ds_read_b64_tr_b16 v[180:181], v18 offset:24576
ds_read_b64_tr_b16 v[182:183], v18 offset:28672
M v[56:59], v[148:151], a[196:199], v[56:59]
buffer_load_dwordx4 a[152:155], v1, s[44:47], s25 offen offset:2048 sc1
M v[60:63], v[156:159], a[196:199], 0
M v[60:63], v[152:155], a[192:195], v[60:63]
ds_read_b64_tr_b16 v[184:185], v19 offset:16384
ds_read_b64_tr_b16 v[186:187], v19 offset:20480
M v[64:67], v[96:99], a[200:203], 0
buffer_load_dwordx4 a[156:159], v1, s[44:47], s25 offen offset:3072 sc1
M v[64:67], v[100:103], a[204:207], v[64:67]
ds_read_b64_tr_b16 v[188:189], v19 offset:24576
ds_read_b64_tr_b16 v[190:191], v19 offset:28672
M v[68:71], v[108:111], a[204:207], 0
s_sub_u32 s39, s39, 1
s_cmp_eq_u32 s39, 0
s_cselect_b32 s3, s64, s65
M v[68:71], v[104:107], a[200:203], v[68:71]
ds_read_b64_tr_b16 v[192:193], v20 offset:16384
ds_read_b64_tr_b16 v[194:195], v20 offset:20480
M v[72:75], v[112:115], a[200:203], 0
s_add_u32 s25, s25, s3
s_lshl_b32 s3, s3, 3
s_add_u32 s26, s26, s3
M v[72:75], v[116:119], a[204:207], v[72:75]
ds_read_b64_tr_b16 v[196:197], v20 offset:24576
ds_read_b64_tr_b16 v[198:199], v20 offset:28672
M v[76:79], v[124:127], a[204:207], 0
M v[76:79], v[120:123], a[200:203], v[76:79]
ds_read_b64_tr_b16 v[200:201], v21 offset:16384
ds_read_b64_tr_b16 v[202:203], v21 offset:20480
M v[80:83], v[128:131], a[200:203], 0
ds_read_b64_tr_b16 v[204:205], v21 offset:24576
ds_read_b64_tr_b16 v[206:207], v21 offset:28672
M v[80:83], v[132:135], a[204:207], v[80:83]
ds_read_b64_tr_b16 v[208:209], v22 offset:16384
ds_read_b64_tr_b16 v[210:211], v22 offset:20480
M v[84:87], v[140:143], a[204:207], 0
ds_read_b64_tr_b16 v[212:213], v22 offset:24576
ds_read_b64_tr_b16 v[214:215], v22 offset:28672
M v[84:87], v[136:139], a[200:203], v[84:87]
ds_read_b64_tr_b16 v[216:217], v23 offset:16384
ds_read_b64_tr_b16 v[218:219], v23 offset:20480
M v[88:91], v[144:147], a[200:203], 0
ds_read_b64_tr_b16 v[220:221], v23 offset:24576
ds_read_b64_tr_b16 v[222:223], v23 offset:28672
M v[88:91], v[148:151], a[204:207], v[88:91]
M v[92:95], v[156:159], a[204:207], 0
M v[92:95], v[152:155], a[200:203], v[92:95]
s_mov_b32 s28, 3
Lk3_la:
s_waitcnt vmcnt(24) lgkmcnt(0)
s_barrier
M v[32:35], v[160:163], a[208:211], v[32:35]
s_add_u32 m0, s41, 32768
s_nop 0
buffer_load_dwordx4 v2, s[48:51], s26 offen offset:0 lds
M v[32:35], v[164:167], a[212:215], v[32:35]
ds_read_b64_tr_b16 v[96:97], v16 offset:32768
ds_read_b64_tr_b16 v[98:99], v16 offset:36864
M v[36:39], v[172:175], a[212:215], v[36:39]
buffer_load_dwordx4 v3, s[48:51], s26 offen offset:1024 lds
M v[36:39], v[168:171], a[208:211], v[36:39]
ds_read_b64_tr_b16 v[100:101], v16 offset:40960
ds_read_b64_tr_b16 v[102:103], v16 offset:45056
M v[40:43], v[176:179], a[208:211], v[40:43]
buffer_load_dwordx4 v4, s[48:51], s26 offen offset:2048 lds
M v[40:43], v[180:183], a[212:215], v[40:43]
ds_read_b64_tr_b16 v[104:105], v17 offset:32768
ds_read_b64_tr_b16 v[106:107], v17 offset:36864
M v[44:47], v[188:191], a[212:215], v[44:47]
buffer_load_dwordx4 v5, s[48:51], s26 offen offset:3072 lds
M v[44:47], v[184:187], a[208:211], v[44:47]
M v[48:51], v[192:195], a[208:211], v[48:51]
ds_read_b64_tr_b16 v[108:109], v17 offset:40960
ds_read_b64_tr_b16 v[110:111], v17 offset:45056
M v[48:51], v[196:199], a[212:215], v[48:51]
buffer_load_dwordx4 a[160:163], v1, s[44:47], s25 offen offset:0 sc1
M v[52:55], v[204:207], a[212:215], v[52:55]
ds_read_b64_tr_b16 v[112:113], v18 offset:32768
ds_read_b64_tr_b16 v[114:115], v18 offset:36864
M v[52:55], v[200:203], a[208:211], v[52:55]
buffer_load_dwordx4 a[164:167], v1, s[44:47], s25 offen offset:1024 sc1
M v[56:59], v[208:211], a[208:211], v[56:59]
ds_read_b64_tr_b16 v[116:117], v18 offset:40960
ds_read_b64_tr_b16 v[118:119], v18 offset:45056
M v[56:59], v[212:215], a[212:215], v[56:59]
buffer_load_dwordx4 a[168:171], v1, s[44:47], s25 offen offset:2048 sc1
M v[60:63], v[220:223], a[212:215], v[60:63]
M v[60:63], v[216:219], a[208:211], v[60:63]
ds_read_b64_tr_b16 v[120:121], v19 offset:32768
ds_read_b64_tr_b16 v[122:123], v19 offset:36864
M v[64:67], v[160:163], a[216:219], v[64:67]
buffer_load_dwordx4 a[172:175], v1, s[44:47], s25 offen offset:3072 sc1
M v[64:67], v[164:167], a[220:223], v[64:67]
ds_read_b64_tr_b16 v[124:125], v19 offset:40960
ds_read_b64_tr_b16 v[126:127], v19 offset:45056
M v[68:71], v[172:175], a[220:223], v[68:71]
s_sub_u32 s39, s39, 1
s_cmp_eq_u32 s39, 0
s_cselect_b32 s3, s64, s65
M v[68:71], v[168:171], a[216:219], v[68:71]
ds_read_b64_tr_b16 v[128:129], v20 offset:32768
ds_read_b64_tr_b16 v[130:131], v20 offset:36864
M v[72:75], v[176:179], a[216:219], v[72:75]
s_add_u32 s25, s25, s3
s_lshl_b32 s3, s3, 3
s_add_u32 s26, s26, s3
M v[72:75], v[180:183], a[220:223], v[72:75]
ds_read_b64_tr_b16 v[132:133], v20 offset:40960
ds_read_b64_tr_b16 v[134:135], v20 offset:45056
M v[76:79], v[188:191], a[220:223], v[76:79]
M v[76:79], v[184:187], a[216:219], v[76:79]
ds_read_b64_tr_b16 v[136:137], v21 offset:32768
ds_read_b64_tr_b16 v[138:139], v21 offset:36864
M v[80:83], v[192:195], a[216:219], v[80:83]
ds_read_b64_tr_b16 v[140:141], v21 offset:40960
ds_read_b64_tr_b16 v[142:143], v21 offset:45056
M v[80:83], v[196:199], a[220:223], v[80:83]
ds_read_b64_tr_b16 v[144:145], v22 offset:32768
ds_read_b64_tr_b16 v[146:147], v22 offset:36864
M v[84:87], v[204:207], a[220:223], v[84:87]
ds_read_b64_tr_b16 v[148:149], v22 offset:40960
ds_read_b64_tr_b16 v[150:151], v22 offset:45056
M v[84:87], v[200:203], a[216:219], v[84:87]
ds_read_b64_tr_b16 v[152:153], v23 offset:32768
ds_read_b64_tr_b16 v[154:155], v23 offset:36864
M v[88:91], v[208:211], a[216:219], v[88:91]
ds_read_b64_tr_b16 v[156:157], v23 offset:40960
ds_read_b64_tr_b16 v[158:159], v23 offset:45056
M v[88:91], v[212:215], a[220:223], v[88:91]
M v[92:95], v[220:223], a[220:223], v[92:95]
M v[92:95], v[216:219], a[216:219], v[92:95]
s_waitcnt vmcnt(24) lgkmcnt(0)
s_barrier
M v[32:35], v[96:99], a[224:227], v[32:35]
s_add_u32 m0, s41, 49152
s_nop 0
buffer_load_dwordx4 v2, s[48:51], s26 offen offset:0 lds
M v[32:35], v[100:103], a[228:231], v[32:35]
ds_read_b64_tr_b16 v[160:161], v16 offset:49152
ds_read_b64_tr_b16 v[162:163], v16 offset:53248
M v[36:39], v[108:111], a[228:231], v[36:39]
buffer_load_dwordx4 v3, s[48:51], s26 offen offset:1024 lds
M v[36:39], v[104:107], a[224:227], v[36:39]
ds_read_b64_tr_b16 v[164:165], v16 offset:57344
ds_read_b64_tr_b16 v[166:167], v16 offset:61440
M v[40:43], v[112:115], a[224:227], v[40:43]
buffer_load_dwordx4 v4, s[48:51], s26 offen offset:2048 lds
M v[40:43], v[116:119], a[228:231], v[40:43]
ds_read_b64_tr_b16 v[168:169], v17 offset:49152
ds_read_b64_tr_b16 v[170:171], v17 offset:53248
M v[44:47], v[124:127], a[228:231], v[44:47]
buffer_load_dwordx4 v5, s[48:51], s26 offen offset:3072 lds
M v[44:47], v[120:123], a[224:227], v[44:47]
M v[48:51], v[128:131], a[224:227], v[48:51]
ds_read_b64_tr_b16 v[172:173], v17 offset:57344
ds_read_b64_tr_b16 v[174:175], v17 offset:61440
M v[48:51], v[132:135], a[228:231], v[48:51]
buffer_load_dwordx4 a[176:179], v1, s[44:47], s25 offen offset:0 sc1
M v[52:55], v[140:143], a[228:231], v[52:55]
ds_read_b64_tr_b16 v[176:177], v18 offset:49152
ds_read_b64_tr_b16 v[178:179], v18 offset:53248
M v[52:55], v[136:139], a[224:227], v[52:55]
buffer_load_dwordx4 a[180:183], v1, s[44:47], s25 offen offset:1024 sc1
M v[56:59], v[144:147], a[224:227], v[56:59]
ds_read_b64_tr_b16 v[180:181], v18 offset:57344
ds_read_b64_tr_b16 v[182:183], v18 offset:61440
M v[56:59], v[148:151], a[228:231], v[56:59]
buffer_load_dwordx4 a[184:187], v1, s[44:47], s25 offen offset:2048 sc1
M v[60:63], v[156:159], a[228:231], v[60:63]
M v[60:63], v[152:155], a[224:227], v[60:63]
ds_read_b64_tr_b16 v[184:185], v19 offset:49152
ds_read_b64_tr_b16 v[186:187], v19 offset:53248
M v[64:67], v[96:99], a[232:235], v[64:67]
buffer_load_dwordx4 a[188:191], v1, s[44:47], s25 offen offset:3072 sc1
M v[64:67], v[100:103], a[236:239], v[64:67]
ds_read_b64_tr_b16 v[188:189], v19 offset:57344
ds_read_b64_tr_b16 v[190:191], v19 offset:61440
M v[68:71], v[108:111], a[236:239], v[68:71]
s_sub_u32 s39, s39, 1
s_cmp_eq_u32 s39, 0
s_cselect_b32 s3, s64, s65
M v[68:71], v[104:107], a[232:235], v[68:71]
ds_read_b64_tr_b16 v[192:193], v20 offset:49152
ds_read_b64_tr_b16 v[194:195], v20 offset:53248
M v[72:75], v[112:115], a[232:235], v[72:75]
s_add_u32 s25, s25, s3
s_lshl_b32 s3, s3, 3
s_add_u32 s26, s26, s3
M v[72:75], v[116:119], a[236:239], v[72:75]
ds_read_b64_tr_b16 v[196:197], v20 offset:57344
ds_read_b64_tr_b16 v[198:199], v20 offset:61440
M v[76:79], v[124:127], a[236:239], v[76:79]
M v[76:79], v[120:123], a[232:235], v[76:79]
ds_read_b64_tr_b16 v[200:201], v21 offset:49152
ds_read_b64_tr_b16 v[202:203], v21 offset:53248
M v[80:83], v[128:131], a[232:235], v[80:83]
ds_read_b64_tr_b16 v[204:205], v21 offset:57344
ds_read_b64_tr_b16 v[206:207], v21 offset:61440
M v[80:83], v[132:135], a[236:239], v[80:83]
ds_read_b64_tr_b16 v[208:209], v22 offset:49152
ds_read_b64_tr_b16 v[210:211], v22 offset:53248
M v[84:87], v[140:143], a[236:239], v[84:87]
ds_read_b64_tr_b16 v[212:213], v22 offset:57344
ds_read_b64_tr_b16 v[214:215], v22 offset:61440
M v[84:87], v[136:139], a[232:235], v[84:87]
ds_read_b64_tr_b16 v[216:217], v23 offset:49152
ds_read_b64_tr_b16 v[218:219], v23 offset:53248
M v[88:91], v[144:147], a[232:235], v[88:91]
ds_read_b64_tr_b16 v[220:221], v23 offset:57344
ds_read_b64_tr_b16 v[222:223], v23 offset:61440
M v[88:91], v[148:151], a[236:239], v[88:91]
M v[92:95], v[156:159], a[236:239], v[92:95]
M v[92:95], v[152:155], a[232:235], v[92:95]
s_waitcnt vmcnt(24) lgkmcnt(0)
s_barrier
M v[32:35], v[160:163], a[240:243], v[32:35]
s_add_u32 m0, s41, 65536
s_nop 0
buffer_load_dwordx4 v2, s[48:51], s26 offen offset:0 lds
M v[32:35], v[164:167], a[244:247], v[32:35]
ds_read_b64_tr_b16 v[96:97], v8 offset:0
ds_read_b64_tr_b16 v[98:99], v8 offset:4096
M v[36:39], v[172:175], a[244:247], v[36:39]
buffer_load_dwordx4 v3, s[48:51], s26 offen offset:1024 lds
M v[36:39], v[168:171], a[240:243], v[36:39]
ds_read_b64_tr_b16 v[100:101], v8 offset:8192
ds_read_b64_tr_b16 v[102:103], v8 offset:12288
M v[40:43], v[176:179], a[240:243], v[40:43]
buffer_load_dwordx4 v4, s[48:51], s26 offen offset:2048 lds
M v[40:43], v[180:183], a[244:247], v[40:43]
ds_read_b64_tr_b16 v[104:105], v9 offset:0
ds_read_b64_tr_b16 v[106:107], v9 offset:4096
M v[44:47], v[188:191], a[244:247], v[44:47]
buffer_load_dwordx4 v5, s[48:51], s26 offen offset:3072 lds
M v[44:47], v[184:187], a[240:243], v[44:47]
M v[48:51], v[192:195], a[240:243], v[48:51]
ds_read_b64_tr_b16 v[108:109], v9 offset:8192
ds_read_b64_tr_b16 v[110:111], v9 offset:12288
M v[48:51], v[196:199], a[244:247], v[48:51]
buffer_load_dwordx4 a[192:195], v1, s[44:47], s25 offen offset:0 sc1
M v[52:55], v[204:207], a[244:247], v[52:55]
ds_read_b64_tr_b16 v[112:113], v10 offset:0
ds_read_b64_tr_b16 v[114:115], v10 offset:4096
M v[52:55], v[200:203], a[240:243], v[52:55]
buffer_load_dwordx4 a[196:199], v1, s[44:47], s25 offen offset:1024 sc1
M v[56:59], v[208:211], a[240:243], v[56:59]
ds_read_b64_tr_b16 v[116:117], v10 offset:8192
ds_read_b64_tr_b16 v[118:119], v10 offset:12288
M v[56:59], v[212:215], a[244:247], v[56:59]
buffer_load_dwordx4 a[200:203], v1, s[44:47], s25 offen offset:2048 sc1
M v[60:63], v[220:223], a[244:247], v[60:63]
M v[60:63], v[216:219], a[240:243], v[60:63]
ds_read_b64_tr_b16 v[120:121], v11 offset:0
ds_read_b64_tr_b16 v[122:123], v11 offset:4096
M v[64:67], v[160:163], a[248:251], v[64:67]
buffer_load_dwordx4 a[204:207], v1, s[44:47], s25 offen offset:3072 sc1
M v[64:67], v[164:167], a[252:255], v[64:67]
ds_read_b64_tr_b16 v[124:125], v11 offset:8192
ds_read_b64_tr_b16 v[126:127], v11 offset:12288
M v[68:71], v[172:175], a[252:255], v[68:71]
s_sub_u32 s39, s39, 1
s_cmp_eq_u32 s39, 0
s_cselect_b32 s3, s64, s65
M v[68:71], v[168:171], a[248:251], v[68:71]
ds_read_b64_tr_b16 v[128:129], v12 offset:0
ds_read_b64_tr_b16 v[130:131], v12 offset:4096
M v[72:75], v[176:179], a[248:251], v[72:75]
s_add_u32 s25, s25, s3
s_lshl_b32 s3, s3, 3
s_add_u32 s26, s26, s3
M v[72:75], v[180:183], a[252:255], v[72:75]
ds_read_b64_tr_b16 v[132:133], v12 offset:8192
ds_read_b64_tr_b16 v[134:135], v12 offset:12288
M v[76:79], v[188:191], a[252:255], v[76:79]
M v[76:79], v[184:187], a[248:251], v[76:79]
ds_read_b64_tr_b16 v[136:137], v13 offset:0
ds_read_b64_tr_b16 v[138:139], v13 offset:4096
M v[80:83], v[192:195], a[248:251], v[80:83]
ds_read_b64_tr_b16 v[140:141], v13 offset:8192
ds_read_b64_tr_b16 v[142:143], v13 offset:12288
M v[80:83], v[196:199], a[252:255], v[80:83]
ds_read_b64_tr_b16 v[144:145], v14 offset:0
ds_read_b64_tr_b16 v[146:147], v14 offset:4096
M v[84:87], v[204:207], a[252:255], v[84:87]
ds_read_b64_tr_b16 v[148:149], v14 offset:8192
ds_read_b64_tr_b16 v[150:151], v14 offset:12288
M v[84:87], v[200:203], a[248:251], v[84:87]
ds_read_b64_tr_b16 v[152:153], v15 offset:0
ds_read_b64_tr_b16 v[154:155], v15 offset:4096
M v[88:91], v[208:211], a[248:251], v[88:91]
ds_read_b64_tr_b16 v[156:157], v15 offset:8192
ds_read_b64_tr_b16 v[158:159], v15 offset:12288
M v[88:91], v[212:215], a[252:255], v[88:91]
M v[92:95], v[220:223], a[252:255], v[92:95]
M v[92:95], v[216:219], a[248:251], v[92:95]
s_waitcnt vmcnt(24) lgkmcnt(0)
s_barrier
M v[32:35], v[96:99], a[128:131], v[32:35]
s_add_u32 m0, s41, 81920
s_nop 0
buffer_load_dwordx4 v2, s[48:51], s26 offen offset:0 lds
M v[32:35], v[100:103], a[132:135], v[32:35]
ds_read_b64_tr_b16 v[160:161], v8 offset:16384
ds_read_b64_tr_b16 v[162:163], v8 offset:20480
M v[36:39], v[108:111], a[132:135], v[36:39]
buffer_load_dwordx4 v3, s[48:51], s26 offen offset:1024 lds
M v[36:39], v[104:107], a[128:131], v[36:39]
ds_read_b64_tr_b16 v[164:165], v8 offset:24576
ds_read_b64_tr_b16 v[166:167], v8 offset:28672
M v[40:43], v[112:115], a[128:131], v[40:43]
buffer_load_dwordx4 v4, s[48:51], s26 offen offset:2048 lds
M v[40:43], v[116:119], a[132:135], v[40:43]
ds_read_b64_tr_b16 v[168:169], v9 offset:16384
ds_read_b64_tr_b16 v[170:171], v9 offset:20480
M v[44:47], v[124:127], a[132:135], v[44:47]
buffer_load_dwordx4 v5, s[48:51], s26 offen offset:3072 lds
M v[44:47], v[120:123], a[128:131], v[44:47]
M v[48:51], v[128:131], a[128:131], v[48:51]
ds_read_b64_tr_b16 v[172:173], v9 offset:24576
ds_read_b64_tr_b16 v[174:175], v9 offset:28672
M v[48:51], v[132:135], a[132:135], v[48:51]
buffer_load_dwordx4 a[208:211], v1, s[44:47], s25 offen offset:0 sc1
M v[52:55], v[140:143], a[132:135], v[52:55]
ds_read_b64_tr_b16 v[176:177], v10 offset:16384
ds_read_b64_tr_b16 v[178:179], v10 offset:20480
M v[52:55], v[136:139], a[128:131], v[52:55]
buffer_load_dwordx4 a[212:215], v1, s[44:47], s25 offen offset:1024 sc1
M v[56:59], v[144:147], a[128:131], v[56:59]
ds_read_b64_tr_b16 v[180:181], v10 offset:24576
ds_read_b64_tr_b16 v[182:183], v10 offset:28672
M v[56:59], v[148:151], a[132:135], v[56:59]
buffer_load_dwordx4 a[216:219], v1, s[44:47], s25 offen offset:2048 sc1
M v[60:63], v[156:159], a[132:135], v[60:63]
M v[60:63], v[152:155], a[128:131], v[60:63]
ds_read_b64_tr_b16 v[184:185], v11 offset:16384
ds_read_b64_tr_b16 v[186:187], v11 offset:20480
M v[64:67], v[96:99], a[136:139], v[64:67]
buffer_load_dwordx4 a[220:223], v1, s[44:47], s25 offen offset:3072 sc1
M v[64:67], v[100:103], a[140:143], v[64:67]
ds_read_b64_tr_b16 v[188:189], v11 offset:24576
ds_read_b64_tr_b16 v[190:191], v11 offset:28672
M v[68:71], v[108:111], a[140:143], v[68:71]
s_sub_u32 s39, s39, 1
s_cmp_eq_u32 s39, 0
s_cselect_b32 s3, s64, s65
M v[68:71], v[104:107], a[136:139], v[68:71]
ds_read_b64_tr_b16 v[192:193], v12 offset:16384
ds_read_b64_tr_b16 v[194:195], v12 offset:20480
M v[72:75], v[112:115], a[136:139], v[72:75]
s_add_u32 s25, s25, s3
s_lshl_b32 s3, s3, 3
s_add_u32 s26, s26, s3
M v[72:75], v[116:119], a[140:143], v[72:75]
ds_read_b64_tr_b16 v[196:197], v12 offset:24576
ds_read_b64_tr_b16 v[198:199], v12 offset:28672
M v[76:79], v[124:127], a[140:143], v[76:79]
M v[76:79], v[120:123], a[136:139], v[76:79]
ds_read_b64_tr_b16 v[200:201], v13 offset:16384
ds_read_b64_tr_b16 v[202:203], v13 offset:20480
M v[80:83], v[128:131], a[136:139], v[80:83]
ds_read_b64_tr_b16 v[204:205], v13 offset:24576
ds_read_b64_tr_b16 v[206:207], v13 offset:28672
M v[80:83], v[132:135], a[140:143], v[80:83]
ds_read_b64_tr_b16 v[208:209], v14 offset:16384
ds_read_b64_tr_b16 v[210:211], v14 offset:20480
M v[84:87], v[140:143], a[140:143], v[84:87]
ds_read_b64_tr_b16 v[212:213], v14 offset:24576
ds_read_b64_tr_b16 v[214:215], v14 offset:28672
M v[84:87], v[136:139], a[136:139], v[84:87]
ds_read_b64_tr_b16 v[216:217], v15 offset:16384
ds_read_b64_tr_b16 v[218:219], v15 offset:20480
M v[88:91], v[144:147], a[136:139], v[88:91]
ds_read_b64_tr_b16 v[220:221], v15 offset:24576
ds_read_b64_tr_b16 v[222:223], v15 offset:28672
M v[88:91], v[148:151], a[140:143], v[88:91]
M v[92:95], v[156:159], a[140:143], v[92:95]
M v[92:95], v[152:155], a[136:139], v[92:95]
s_waitcnt vmcnt(24) lgkmcnt(0)
s_barrier
M v[32:35], v[160:163], a[144:147], v[32:35]
s_add_u32 m0, s41, 98304
s_nop 0
buffer_load_dwordx4 v2, s[48:51], s26 offen offset:0 lds
M v[32:35], v[164:167], a[148:151], v[32:35]
ds_read_b64_tr_b16 v[96:97], v8 offset:32768
ds_read_b64_tr_b16 v[98:99], v8 offset:36864
M v[36:39], v[172:175], a[148:151], v[36:39]
buffer_load_dwordx4 v3, s[48:51], s26 offen offset:1024 lds
M v[36:39], v[168:171], a[144:147], v[36:39]
ds_read_b64_tr_b16 v[100:101], v8 offset:40960
ds_read_b64_tr_b16 v[102:103], v8 offset:45056
M v[40:43], v[176:179], a[144:147], v[40:43]
buffer_load_dwordx4 v4, s[48:51], s26 offen offset:2048 lds
M v[40:43], v[180:183], a[148:151], v[40:43]
ds_read_b64_tr_b16 v[104:105], v9 offset:32768
ds_read_b64_tr_b16 v[106:107], v9 offset:36864
M v[44:47], v[188:191], a[148:151], v[44:47]
buffer_load_dwordx4 v5, s[48:51], s26 offen offset:3072 lds
M v[44:47], v[184:187], a[144:147], v[44:47]
M v[48:51], v[192:195], a[144:147], v[48:51]
ds_read_b64_tr_b16 v[108:109], v9 offset:40960
ds_read_b64_tr_b16 v[110:111], v9 offset:45056
M v[48:51], v[196:199], a[148:151], v[48:51]
buffer_load_dwordx4 a[224:227], v1, s[44:47], s25 offen offset:0 sc1
M v[52:55], v[204:207], a[148:151], v[52:55]
ds_read_b64_tr_b16 v[112:113], v10 offset:32768
ds_read_b64_tr_b16 v[114:115], v10 offset:36864
M v[52:55], v[200:203], a[144:147], v[52:55]
buffer_load_dwordx4 a[228:231], v1, s[44:47], s25 offen offset:1024 sc1
M v[56:59], v[208:211], a[144:147], v[56:59]
ds_read_b64_tr_b16 v[116:117], v10 offset:40960
ds_read_b64_tr_b16 v[118:119], v10 offset:45056
M v[56:59], v[212:215], a[148:151], v[56:59]
buffer_load_dwordx4 a[232:235], v1, s[44:47], s25 offen offset:2048 sc1
M v[60:63], v[220:223], a[148:151], v[60:63]
M v[60:63], v[216:219], a[144:147], v[60:63]
ds_read_b64_tr_b16 v[120:121], v11 offset:32768
ds_read_b64_tr_b16 v[122:123], v11 offset:36864
M v[64:67], v[160:163], a[152:155], v[64:67]
buffer_load_dwordx4 a[236:239], v1, s[44:47], s25 offen offset:3072 sc1
M v[64:67], v[164:167], a[156:159], v[64:67]
ds_read_b64_tr_b16 v[124:125], v11 offset:40960
ds_read_b64_tr_b16 v[126:127], v11 offset:45056
M v[68:71], v[172:175], a[156:159], v[68:71]
s_sub_u32 s39, s39, 1
s_cmp_eq_u32 s39, 0
s_cselect_b32 s3, s64, s65
M v[68:71], v[168:171], a[152:155], v[68:71]
ds_read_b64_tr_b16 v[128:129], v12 offset:32768
ds_read_b64_tr_b16 v[130:131], v12 offset:36864
M v[72:75], v[176:179], a[152:155], v[72:75]
s_add_u32 s25, s25, s3
s_lshl_b32 s3, s3, 3
s_add_u32 s26, s26, s3
M v[72:75], v[180:183], a[156:159], v[72:75]
ds_read_b64_tr_b16 v[132:133], v12 offset:40960
ds_read_b64_tr_b16 v[134:135], v12 offset:45056
M v[76:79], v[188:191], a[156:159], v[76:79]
M v[76:79], v[184:187], a[152:155], v[76:79]
ds_read_b64_tr_b16 v[136:137], v13 offset:32768
ds_read_b64_tr_b16 v[138:139], v13 offset:36864
M v[80:83], v[192:195], a[152:155], v[80:83]
ds_read_b64_tr_b16 v[140:141], v13 offset:40960
ds_read_b64_tr_b16 v[142:143], v13 offset:45056
M v[80:83], v[196:199], a[156:159], v[80:83]
ds_read_b64_tr_b16 v[144:145], v14 offset:32768
ds_read_b64_tr_b16 v[146:147], v14 offset:36864
M v[84:87], v[204:207], a[156:159], v[84:87]
ds_read_b64_tr_b16 v[148:149], v14 offset:40960
ds_read_b64_tr_b16 v[150:151], v14 offset:45056
M v[84:87], v[200:203], a[152:155], v[84:87]
ds_read_b64_tr_b16 v[152:153], v15 offset:32768
ds_read_b64_tr_b16 v[154:155], v15 offset:36864
M v[88:91], v[208:211], a[152:155], v[88:91]
ds_read_b64_tr_b16 v[156:157], v15 offset:40960
ds_read_b64_tr_b16 v[158:159], v15 offset:45056
M v[88:91], v[212:215], a[156:159], v[88:91]
M v[92:95], v[220:223], a[156:159], v[92:95]
M v[92:95], v[216:219], a[152:155], v[92:95]
s_waitcnt vmcnt(24) lgkmcnt(0)
s_barrier
M v[32:35], v[96:99], a[160:163], v[32:35]
s_add_u32 m0, s41, 114688
s_nop 0
buffer_load_dwordx4 v2, s[48:51], s26 offen offset:0 lds
M v[32:35], v[100:103], a[164:167], v[32:35]
ds_read_b64_tr_b16 v[160:161], v8 offset:49152
ds_read_b64_tr_b16 v[162:163], v8 offset:53248
M v[36:39], v[108:111], a[164:167], v[36:39]
buffer_load_dwordx4 v3, s[48:51], s26 offen offset:1024 lds
M v[36:39], v[104:107], a[160:163], v[36:39]
ds_read_b64_tr_b16 v[164:165], v8 offset:57344
ds_read_b64_tr_b16 v[166:167], v8 offset:61440
M v[40:43], v[112:115], a[160:163], v[40:43]
buffer_load_dwordx4 v4, s[48:51], s26 offen offset:2048 lds
M v[40:43], v[116:119], a[164:167], v[40:43]
ds_read_b64_tr_b16 v[168:169], v9 offset:49152
ds_read_b64_tr_b16 v[170:171], v9 offset:53248
M v[44:47], v[124:127], a[164:167], v[44:47]
buffer_load_dwordx4 v5, s[48:51], s26 offen offset:3072 lds
M v[44:47], v[120:123], a[160:163], v[44:47]
M v[48:51], v[128:131], a[160:163], v[48:51]
ds_read_b64_tr_b16 v[172:173], v9 offset:57344
ds_read_b64_tr_b16 v[174:175], v9 offset:61440
M v[48:51], v[132:135], a[164:167], v[48:51]
buffer_load_dwordx4 a[240:243], v1, s[44:47], s25 offen offset:0 sc1
M v[52:55], v[140:143], a[164:167], v[52:55]
ds_read_b64_tr_b16 v[176:177], v10 offset:49152
ds_read_b64_tr_b16 v[178:179], v10 offset:53248
M v[52:55], v[136:139], a[160:163], v[52:55]
buffer_load_dwordx4 a[244:247], v1, s[44:47], s25 offen offset:1024 sc1
M v[56:59], v[144:147], a[160:163], v[56:59]
ds_read_b64_tr_b16 v[180:181], v10 offset:57344
ds_read_b64_tr_b16 v[182:183], v10 offset:61440
M v[56:59], v[148:151], a[164:167], v[56:59]
buffer_load_dwordx4 a[248:251], v1, s[44:47], s25 offen offset:2048 sc1
M v[60:63], v[156:159], a[164:167], v[60:63]
M v[60:63], v[152:155], a[160:163], v[60:63]
ds_read_b64_tr_b16 v[184:185], v11 offset:49152
ds_read_b64_tr_b16 v[186:187], v11 offset:53248
M v[64:67], v[96:99], a[168:171], v[64:67]
buffer_load_dwordx4 a[252:255], v1, s[44:47], s25 offen offset:3072 sc1
M v[64:67], v[100:103], a[172:175], v[64:67]
ds_read_b64_tr_b16 v[188:189], v11 offset:57344
ds_read_b64_tr_b16 v[190:191], v11 offset:61440
M v[68:71], v[108:111], a[172:175], v[68:71]
s_sub_u32 s39, s39, 1
s_cmp_eq_u32 s39, 0
s_cselect_b32 s3, s64, s65
M v[68:71], v[104:107], a[168:171], v[68:71]
ds_read_b64_tr_b16 v[192:193], v12 offset:49152
ds_read_b64_tr_b16 v[194:195], v12 offset:53248
M v[72:75], v[112:115], a[168:171], v[72:75]
s_add_u32 s25, s25, s3
s_lshl_b32 s3, s3, 3
s_add_u32 s26, s26, s3
M v[72:75], v[116:119], a[172:175], v[72:75]
ds_read_b64_tr_b16 v[196:197], v12 offset:57344
ds_read_b64_tr_b16 v[198:199], v12 offset:61440
M v[76:79], v[124:127], a[172:175], v[76:79]
M v[76:79], v[120:123], a[168:171], v[76:79]
ds_read_b64_tr_b16 v[200:201], v13 offset:49152
ds_read_b64_tr_b16 v[202:203], v13 offset:53248
M v[80:83], v[128:131], a[168:171], v[80:83]
ds_read_b64_tr_b16 v[204:205], v13 offset:57344
ds_read_b64_tr_b16 v[206:207], v13 offset:61440
M v[80:83], v[132:135], a[172:175], v[80:83]
ds_read_b64_tr_b16 v[208:209], v14 offset:49152
ds_read_b64_tr_b16 v[210:211], v14 offset:53248
M v[84:87], v[140:143], a[172:175], v[84:87]
ds_read_b64_tr_b16 v[212:213], v14 offset:57344
ds_read_b64_tr_b16 v[214:215], v14 offset:61440
M v[84:87], v[136:139], a[168:171], v[84:87]
ds_read_b64_tr_b16 v[216:217], v15 offset:49152
ds_read_b64_tr_b16 v[218:219], v15 offset:53248
M v[88:91], v[144:147], a[168:171], v[88:91]
ds_read_b64_tr_b16 v[220:221], v15 offset:57344
ds_read_b64_tr_b16 v[222:223], v15 offset:61440
M v[88:91], v[148:151], a[172:175], v[88:91]
M v[92:95], v[156:159], a[172:175], v[92:95]
M v[92:95], v[152:155], a[168:171], v[92:95]
s_waitcnt vmcnt(24) lgkmcnt(0)
s_barrier
M v[32:35], v[160:163], a[176:179], v[32:35]
s_add_u32 m0, s41, 0
s_nop 0
buffer_load_dwordx4 v2, s[48:51], s26 offen offset:0 lds
M v[32:35], v[164:167], a[180:183], v[32:35]
ds_read_b64_tr_b16 v[96:97], v16 offset:0
ds_read_b64_tr_b16 v[98:99], v16 offset:4096
M v[36:39], v[172:175], a[180:183], v[36:39]
buffer_load_dwordx4 v3, s[48:51], s26 offen offset:1024 lds
M v[36:39], v[168:171], a[176:179], v[36:39]
ds_read_b64_tr_b16 v[100:101], v16 offset:8192
ds_read_b64_tr_b16 v[102:103], v16 offset:12288
M v[40:43], v[176:179], a[176:179], v[40:43]
buffer_load_dwordx4 v4, s[48:51], s26 offen offset:2048 lds
M v[40:43], v[180:183], a[180:183], v[40:43]
ds_read_b64_tr_b16 v[104:105], v17 offset:0
ds_read_b64_tr_b16 v[106:107], v17 offset:4096
M v[44:47], v[188:191], a[180:183], v[44:47]
buffer_load_dwordx4 v5, s[48:51], s26 offen offset:3072 lds
M v[44:47], v[184:187], a[176:179], v[44:47]
M v[48:51], v[192:195], a[176:179], v[48:51]
ds_read_b64_tr_b16 v[108:109], v17 offset:8192
ds_read_b64_tr_b16 v[110:111], v17 offset:12288
M v[48:51], v[196:199], a[180:183], v[48:51]
buffer_load_dwordx4 a[128:131], v1, s[44:47], s25 offen offset:0 sc1
M v[52:55], v[204:207], a[180:183], v[52:55]
ds_read_b64_tr_b16 v[112:113], v18 offset:0
ds_read_b64_tr_b16 v[114:115], v18 offset:4096
M v[52:55], v[200:203], a[176:179], v[52:55]
buffer_load_dwordx4 a[132:135], v1, s[44:47], s25 offen offset:1024 sc1
M v[56:59], v[208:211], a[176:179], v[56:59]
ds_read_b64_tr_b16 v[116:117], v18 offset:8192
ds_read_b64_tr_b16 v[118:119], v18 offset:12288
M v[56:59], v[212:215], a[180:183], v[56:59]
buffer_load_dwordx4 a[136:139], v1, s[44:47], s25 offen offset:2048 sc1
M v[60:63], v[220:223], a[180:183], v[60:63]
M v[60:63], v[216:219], a[176:179], v[60:63]
ds_read_b64_tr_b16 v[120:121], v19 offset:0
ds_read_b64_tr_b16 v[122:123], v19 offset:4096
M v[64:67], v[160:163], a[184:187], v[64:67]
buffer_load_dwordx4 a[140:143], v1, s[44:47], s25 offen offset:3072 sc1
M v[64:67], v[164:167], a[188:191], v[64:67]
ds_read_b64_tr_b16 v[124:125], v19 offset:8192
ds_read_b64_tr_b16 v[126:127], v19 offset:12288
M v[68:71], v[172:175], a[188:191], v[68:71]
s_sub_u32 s39, s39, 1
s_cmp_eq_u32 s39, 0
s_cselect_b32 s3, s64, s65
M v[68:71], v[168:171], a[184:187], v[68:71]
ds_read_b64_tr_b16 v[128:129], v20 offset:0
ds_read_b64_tr_b16 v[130:131], v20 offset:4096
M v[72:75], v[176:179], a[184:187], v[72:75]
s_add_u32 s25, s25, s3
s_lshl_b32 s3, s3, 3
s_add_u32 s26, s26, s3
M v[72:75], v[180:183], a[188:191], v[72:75]
ds_read_b64_tr_b16 v[132:133], v20 offset:8192
ds_read_b64_tr_b16 v[134:135], v20 offset:12288
M v[76:79], v[188:191], a[188:191], v[76:79]
M v[76:79], v[184:187], a[184:187], v[76:79]
ds_read_b64_tr_b16 v[136:137], v21 offset:0
ds_read_b64_tr_b16 v[138:139], v21 offset:4096
M v[80:83], v[192:195], a[184:187], v[80:83]
ds_read_b64_tr_b16 v[140:141], v21 offset:8192
ds_read_b64_tr_b16 v[142:143], v21 offset:12288
M v[80:83], v[196:199], a[188:191], v[80:83]
ds_read_b64_tr_b16 v[144:145], v22 offset:0
ds_read_b64_tr_b16 v[146:147], v22 offset:4096
M v[84:87], v[204:207], a[188:191], v[84:87]
ds_read_b64_tr_b16 v[148:149], v22 offset:8192
ds_read_b64_tr_b16 v[150:151], v22 offset:12288
M v[84:87], v[200:203], a[184:187], v[84:87]
ds_read_b64_tr_b16 v[152:153], v23 offset:0
ds_read_b64_tr_b16 v[154:155], v23 offset:4096
M v[88:91], v[208:211], a[184:187], v[88:91]
ds_read_b64_tr_b16 v[156:157], v23 offset:8192
ds_read_b64_tr_b16 v[158:159], v23 offset:12288
M v[88:91], v[212:215], a[188:191], v[88:91]
M v[92:95], v[220:223], a[188:191], v[92:95]
M v[92:95], v[216:219], a[184:187], v[92:95]
s_waitcnt vmcnt(24) lgkmcnt(0)
s_barrier
M v[32:35], v[96:99], a[192:195], v[32:35]
s_add_u32 m0, s41, 16384
s_nop 0
buffer_load_dwordx4 v2, s[48:51], s26 offen offset:0 lds
M v[32:35], v[100:103], a[196:199], v[32:35]
ds_read_b64_tr_b16 v[160:161], v16 offset:16384
ds_read_b64_tr_b16 v[162:163], v16 offset:20480
M v[36:39], v[108:111], a[196:199], v[36:39]
buffer_load_dwordx4 v3, s[48:51], s26 offen offset:1024 lds
M v[36:39], v[104:107], a[192:195], v[36:39]
ds_read_b64_tr_b16 v[164:165], v16 offset:24576
ds_read_b64_tr_b16 v[166:167], v16 offset:28672
M v[40:43], v[112:115], a[192:195], v[40:43]
buffer_load_dwordx4 v4, s[48:51], s26 offen offset:2048 lds
M v[40:43], v[116:119], a[196:199], v[40:43]
ds_read_b64_tr_b16 v[168:169], v17 offset:16384
ds_read_b64_tr_b16 v[170:171], v17 offset:20480
M v[44:47], v[124:127], a[196:199], v[44:47]
buffer_load_dwordx4 v5, s[48:51], s26 offen offset:3072 lds
M v[44:47], v[120:123], a[192:195], v[44:47]
M v[48:51], v[128:131], a[192:195], v[48:51]
ds_read_b64_tr_b16 v[172:173], v17 offset:24576
ds_read_b64_tr_b16 v[174:175], v17 offset:28672
M v[48:51], v[132:135], a[196:199], v[48:51]
buffer_load_dwordx4 a[144:147], v1, s[44:47], s25 offen offset:0 sc1
M v[52:55], v[140:143], a[196:199], v[52:55]
ds_read_b64_tr_b16 v[176:177], v18 offset:16384
ds_read_b64_tr_b16 v[178:179], v18 offset:20480
M v[52:55], v[136:139], a[192:195], v[52:55]
buffer_load_dwordx4 a[148:151], v1, s[44:47], s25 offen offset:1024 sc1
M v[56:59], v[144:147], a[192:195], v[56:59]
ds_read_b64_tr_b16 v[180:181], v18 offset:24576
ds_read_b64_tr_b16 v[182:183], v18 offset:28672
M v[56:59], v[148:151], a[196:199], v[56:59]
buffer_load_dwordx4 a[152:155], v1, s[44:47], s25 offen offset:2048 sc1
M v[60:63], v[156:159], a[196:199], v[60:63]
M v[60:63], v[152:155], a[192:195], v[60:63]
ds_read_b64_tr_b16 v[184:185], v19 offset:16384
ds_read_b64_tr_b16 v[186:187], v19 offset:20480
M v[64:67], v[96:99], a[200:203], v[64:67]
buffer_load_dwordx4 a[156:159], v1, s[44:47], s25 offen offset:3072 sc1
M v[64:67], v[100:103], a[204:207], v[64:67]
ds_read_b64_tr_b16 v[188:189], v19 offset:24576
ds_read_b64_tr_b16 v[190:191], v19 offset:28672
M v[68:71], v[108:111], a[204:207], v[68:71]
s_sub_u32 s39, s39, 1
s_cmp_eq_u32 s39, 0
s_cselect_b32 s3, s64, s65
M v[68:71], v[104:107], a[200:203], v[68:71]
ds_read_b64_tr_b16 v[192:193], v20 offset:16384
ds_read_b64_tr_b16 v[194:195], v20 offset:20480
M v[72:75], v[112:115], a[200:203], v[72:75]
s_add_u32 s25, s25, s3
s_lshl_b32 s3, s3, 3
s_add_u32 s26, s26, s3
M v[72:75], v[116:119], a[204:207], v[72:75]
ds_read_b64_tr_b16 v[196:197], v20 offset:24576
ds_read_b64_tr_b16 v[198:199], v20 offset:28672
M v[76:79], v[124:127], a[204:207], v[76:79]
M v[76:79], v[120:123], a[200:203], v[76:79]
ds_read_b64_tr_b16 v[200:201], v21 offset:16384
ds_read_b64_tr_b16 v[202:203], v21 offset:20480
M v[80:83], v[128:131], a[200:203], v[80:83]
ds_read_b64_tr_b16 v[204:205], v21 offset:24576
ds_read_b64_tr_b16 v[206:207], v21 offset:28672
M v[80:83], v[132:135], a[204:207], v[80:83]
ds_read_b64_tr_b16 v[208:209], v22 offset:16384
ds_read_b64_tr_b16 v[210:211], v22 offset:20480
M v[84:87], v[140:143], a[204:207], v[84:87]
ds_read_b64_tr_b16 v[212:213], v22 offset:24576
ds_read_b64_tr_b16 v[214:215], v22 offset:28672
M v[84:87], v[136:139], a[200:203], v[84:87]
ds_read_b64_tr_b16 v[216:217], v23 offset:16384
ds_read_b64_tr_b16 v[218:219], v23 offset:20480
M v[88:91], v[144:147], a[200:203], v[88:91]
ds_read_b64_tr_b16 v[220:221], v23 offset:24576
ds_read_b64_tr_b16 v[222:223], v23 offset:28672
M v[88:91], v[148:151], a[204:207], v[88:91]
M v[92:95], v[156:159], a[204:207], v[92:95]
M v[92:95], v[152:155], a[200:203], v[92:95]
s_sub_u32 s28, s28, 1
s_cmp_lg_u32 s28, 0
s_cbranch_scc1 Lk3_la
s_waitcnt vmcnt(24) lgkmcnt(0)
s_barrier
M v[32:35], v[160:163], a[208:211], v[32:35]
s_add_u32 m0, s41, 32768
s_nop 0
buffer_load_dwordx4 v2, s[48:51], s26 offen offset:0 lds
M v[32:35], v[164:167], a[212:215], v[32:35]
ds_read_b64_tr_b16 v[96:97], v16 offset:32768
ds_read_b64_tr_b16 v[98:99], v16 offset:36864
M v[36:39], v[172:175], a[212:215], v[36:39]
buffer_load_dwordx4 v3, s[48:51], s26 offen offset:1024 lds
M v[36:39], v[168:171], a[208:211], v[36:39]
ds_read_b64_tr_b16 v[100:101], v16 offset:40960
ds_read_b64_tr_b16 v[102:103], v16 offset:45056
M v[40:43], v[176:179], a[208:211], v[40:43]
buffer_load_dwordx4 v4, s[48:51], s26 offen offset:2048 lds
M v[40:43], v[180:183], a[212:215], v[40:43]
ds_read_b64_tr_b16 v[104:105], v17 offset:32768
ds_read_b64_tr_b16 v[106:107], v17 offset:36864
M v[44:47], v[188:191], a[212:215], v[44:47]
buffer_load_dwordx4 v5, s[48:51], s26 offen offset:3072 lds
M v[44:47], v[184:187], a[208:211], v[44:47]
M v[48:51], v[192:195], a[208:211], v[48:51]
ds_read_b64_tr_b16 v[108:109], v17 offset:40960
ds_read_b64_tr_b16 v[110:111], v17 offset:45056
M v[48:51], v[196:199], a[212:215], v[48:51]
buffer_load_dwordx4 a[160:163], v1, s[44:47], s25 offen offset:0 sc1
M v[52:55], v[204:207], a[212:215], v[52:55]
ds_read_b64_tr_b16 v[112:113], v18 offset:32768
ds_read_b64_tr_b16 v[114:115], v18 offset:36864
M v[52:55], v[200:203], a[208:211], v[52:55]
buffer_load_dwordx4 a[164:167], v1, s[44:47], s25 offen offset:1024 sc1
M v[56:59], v[208:211], a[208:211], v[56:59]
ds_read_b64_tr_b16 v[116:117], v18 offset:40960
ds_read_b64_tr_b16 v[118:119], v18 offset:45056
M v[56:59], v[212:215], a[212:215], v[56:59]
buffer_load_dwordx4 a[168:171], v1, s[44:47], s25 offen offset:2048 sc1
M v[60:63], v[220:223], a[212:215], v[60:63]
M v[60:63], v[216:219], a[208:211], v[60:63]
ds_read_b64_tr_b16 v[120:121], v19 offset:32768
ds_read_b64_tr_b16 v[122:123], v19 offset:36864
M v[64:67], v[160:163], a[216:219], v[64:67]
buffer_load_dwordx4 a[172:175], v1, s[44:47], s25 offen offset:3072 sc1
M v[64:67], v[164:167], a[220:223], v[64:67]
ds_read_b64_tr_b16 v[124:125], v19 offset:40960
ds_read_b64_tr_b16 v[126:127], v19 offset:45056
M v[68:71], v[172:175], a[220:223], v[68:71]
s_sub_u32 s39, s39, 1
s_cmp_eq_u32 s39, 0
s_cselect_b32 s3, s64, s65
M v[68:71], v[168:171], a[216:219], v[68:71]
ds_read_b64_tr_b16 v[128:129], v20 offset:32768
ds_read_b64_tr_b16 v[130:131], v20 offset:36864
M v[72:75], v[176:179], a[216:219], v[72:75]
s_add_u32 s25, s25, s3
s_lshl_b32 s3, s3, 3
s_add_u32 s26, s26, s3
M v[72:75], v[180:183], a[220:223], v[72:75]
ds_read_b64_tr_b16 v[132:133], v20 offset:40960
ds_read_b64_tr_b16 v[134:135], v20 offset:45056
M v[76:79], v[188:191], a[220:223], v[76:79]
M v[76:79], v[184:187], a[216:219], v[76:79]
ds_read_b64_tr_b16 v[136:137], v21 offset:32768
ds_read_b64_tr_b16 v[138:139], v21 offset:36864
M v[80:83], v[192:195], a[216:219], v[80:83]
ds_read_b64_tr_b16 v[140:141], v21 offset:40960
ds_read_b64_tr_b16 v[142:143], v21 offset:45056
M v[80:83], v[196:199], a[220:223], v[80:83]
ds_read_b64_tr_b16 v[144:145], v22 offset:32768
ds_read_b64_tr_b16 v[146:147], v22 offset:36864
M v[84:87], v[204:207], a[220:223], v[84:87]
ds_read_b64_tr_b16 v[148:149], v22 offset:40960
ds_read_b64_tr_b16 v[150:151], v22 offset:45056
M v[84:87], v[200:203], a[216:219], v[84:87]
ds_read_b64_tr_b16 v[152:153], v23 offset:32768
ds_read_b64_tr_b16 v[154:155], v23 offset:36864
M v[88:91], v[208:211], a[216:219], v[88:91]
ds_read_b64_tr_b16 v[156:157], v23 offset:40960
ds_read_b64_tr_b16 v[158:159], v23 offset:45056
M v[88:91], v[212:215], a[220:223], v[88:91]
M v[92:95], v[220:223], a[220:223], v[92:95]
M v[92:95], v[216:219], a[216:219], v[92:95]
s_waitcnt vmcnt(24) lgkmcnt(0)
s_barrier
M v[32:35], v[96:99], a[224:227], v[32:35]
s_add_u32 m0, s41, 49152
s_nop 0
buffer_load_dwordx4 v2, s[48:51], s26 offen offset:0 lds
M v[32:35], v[100:103], a[228:231], v[32:35]
ds_read_b64_tr_b16 v[160:161], v16 offset:49152
ds_read_b64_tr_b16 v[162:163], v16 offset:53248
M v[36:39], v[108:111], a[228:231], v[36:39]
buffer_load_dwordx4 v3, s[48:51], s26 offen offset:1024 lds
M v[36:39], v[104:107], a[224:227], v[36:39]
ds_read_b64_tr_b16 v[164:165], v16 offset:57344
ds_read_b64_tr_b16 v[166:167], v16 offset:61440
M v[40:43], v[112:115], a[224:227], v[40:43]
buffer_load_dwordx4 v4, s[48:51], s26 offen offset:2048 lds
M v[40:43], v[116:119], a[228:231], v[40:43]
ds_read_b64_tr_b16 v[168:169], v17 offset:49152
ds_read_b64_tr_b16 v[170:171], v17 offset:53248
M v[44:47], v[124:127], a[228:231], v[44:47]
buffer_load_dwordx4 v5, s[48:51], s26 offen offset:3072 lds
M v[44:47], v[120:123], a[224:227], v[44:47]
M v[48:51], v[128:131], a[224:227], v[48:51]
ds_read_b64_tr_b16 v[172:173], v17 offset:57344
ds_read_b64_tr_b16 v[174:175], v17 offset:61440
M v[48:51], v[132:135], a[228:231], v[48:51]
buffer_load_dwordx4 a[176:179], v1, s[44:47], s25 offen offset:0 sc1
M v[52:55], v[140:143], a[228:231], v[52:55]
ds_read_b64_tr_b16 v[176:177], v18 offset:49152
ds_read_b64_tr_b16 v[178:179], v18 offset:53248
M v[52:55], v[136:139], a[224:227], v[52:55]
buffer_load_dwordx4 a[180:183], v1, s[44:47], s25 offen offset:1024 sc1
M v[56:59], v[144:147], a[224:227], v[56:59]
ds_read_b64_tr_b16 v[180:181], v18 offset:57344
ds_read_b64_tr_b16 v[182:183], v18 offset:61440
M v[56:59], v[148:151], a[228:231], v[56:59]
buffer_load_dwordx4 a[184:187], v1, s[44:47], s25 offen offset:2048 sc1
M v[60:63], v[156:159], a[228:231], v[60:63]
M v[60:63], v[152:155], a[224:227], v[60:63]
ds_read_b64_tr_b16 v[184:185], v19 offset:49152
ds_read_b64_tr_b16 v[186:187], v19 offset:53248
M v[64:67], v[96:99], a[232:235], v[64:67]
buffer_load_dwordx4 a[188:191], v1, s[44:47], s25 offen offset:3072 sc1
M v[64:67], v[100:103], a[236:239], v[64:67]
ds_read_b64_tr_b16 v[188:189], v19 offset:57344
ds_read_b64_tr_b16 v[190:191], v19 offset:61440
M v[68:71], v[108:111], a[236:239], v[68:71]
s_sub_u32 s39, s39, 1
s_cmp_eq_u32 s39, 0
s_cselect_b32 s3, s64, s65
M v[68:71], v[104:107], a[232:235], v[68:71]
ds_read_b64_tr_b16 v[192:193], v20 offset:49152
ds_read_b64_tr_b16 v[194:195], v20 offset:53248
M v[72:75], v[112:115], a[232:235], v[72:75]
s_add_u32 s25, s25, s3
s_lshl_b32 s3, s3, 3
s_add_u32 s26, s26, s3
M v[72:75], v[116:119], a[236:239], v[72:75]
ds_read_b64_tr_b16 v[196:197], v20 offset:57344
ds_read_b64_tr_b16 v[198:199], v20 offset:61440
M v[76:79], v[124:127], a[236:239], v[76:79]
M v[76:79], v[120:123], a[232:235], v[76:79]
ds_read_b64_tr_b16 v[200:201], v21 offset:49152
ds_read_b64_tr_b16 v[202:203], v21 offset:53248
M v[80:83], v[128:131], a[232:235], v[80:83]
ds_read_b64_tr_b16 v[204:205], v21 offset:57344
ds_read_b64_tr_b16 v[206:207], v21 offset:61440
M v[80:83], v[132:135], a[236:239], v[80:83]
ds_read_b64_tr_b16 v[208:209], v22 offset:49152
ds_read_b64_tr_b16 v[210:211], v22 offset:53248
M v[84:87], v[140:143], a[236:239], v[84:87]
ds_read_b64_tr_b16 v[212:213], v22 offset:57344
ds_read_b64_tr_b16 v[214:215], v22 offset:61440
M v[84:87], v[136:139], a[232:235], v[84:87]
ds_read_b64_tr_b16 v[216:217], v23 offset:49152
ds_read_b64_tr_b16 v[218:219], v23 offset:53248
M v[88:91], v[144:147], a[232:235], v[88:91]
ds_read_b64_tr_b16 v[220:221], v23 offset:57344
ds_read_b64_tr_b16 v[222:223], v23 offset:61440
M v[88:91], v[148:151], a[236:239], v[88:91]
M v[92:95], v[156:159], a[236:239], v[92:95]
M v[92:95], v[152:155], a[232:235], v[92:95]
s_waitcnt vmcnt(24) lgkmcnt(0)
s_barrier
M v[32:35], v[160:163], a[240:243], v[32:35]
s_mov_b64 s[44:45], s[34:35]
s_mov_b32 s46, 4194304
s_mov_b64 s[48:49], s[36:37]
s_mov_b32 s50, 2097152
s_mov_b32 s25, s32
s_mov_b32 s26, s33
s_add_u32 m0, s42, 65536
s_nop 0
buffer_load_dwordx4 v6, s[48:51], s26 offen offset:0 lds
M v[32:35], v[164:167], a[244:247], v[32:35]
ds_read_b64_tr_b16 v[96:97], v8 offset:0
ds_read_b64_tr_b16 v[98:99], v8 offset:4096
M v[36:39], v[172:175], a[244:247], v[36:39]
buffer_load_dwordx4 v7, s[48:51], s26 offen offset:1024 lds
M v[36:39], v[168:171], a[240:243], v[36:39]
ds_read_b64_tr_b16 v[100:101], v8 offset:8192
ds_read_b64_tr_b16 v[102:103], v8 offset:12288
M v[40:43], v[176:179], a[240:243], v[40:43]
M v[40:43], v[180:183], a[244:247], v[40:43]
buffer_load_dwordx4 a[192:195], v1, s[44:47], s25 offen offset:0 sc1
M v[44:47], v[188:191], a[244:247], v[44:47]
ds_read_b64_tr_b16 v[104:105], v9 offset:0
ds_read_b64_tr_b16 v[106:107], v9 offset:4096
M v[44:47], v[184:187], a[240:243], v[44:47]
buffer_load_dwordx4 a[196:199], v1, s[44:47], s25 offen offset:1024 sc1
M v[48:51], v[192:195], a[240:243], v[48:51]
M v[48:51], v[196:199], a[244:247], v[48:51]
ds_read_b64_tr_b16 v[108:109], v9 offset:8192
ds_read_b64_tr_b16 v[110:111], v9 offset:12288
M v[52:55], v[204:207], a[244:247], v[52:55]
buffer_load_dwordx4 a[200:203], v1, s[44:47], s25 offen offset:2048 sc1
M v[52:55], v[200:203], a[240:243], v[52:55]
ds_read_b64_tr_b16 v[112:113], v10 offset:0
ds_read_b64_tr_b16 v[114:115], v10 offset:4096
M v[56:59], v[208:211], a[240:243], v[56:59]
M v[56:59], v[212:215], a[244:247], v[56:59]
buffer_load_dwordx4 a[204:207], v1, s[44:47], s25 offen offset:3072 sc1
M v[60:63], v[220:223], a[244:247], v[60:63]
ds_read_b64_tr_b16 v[116:117], v10 offset:8192
ds_read_b64_tr_b16 v[118:119], v10 offset:12288
M v[60:63], v[216:219], a[240:243], v[60:63]
s_add_u32 s25, s25, 16384
s_add_u32 s26, s26, 131072
M v[64:67], v[160:163], a[248:251], v[64:67]
ds_read_b64_tr_b16 v[120:121], v11 offset:0
ds_read_b64_tr_b16 v[122:123], v11 offset:4096
M v[64:67], v[164:167], a[252:255], v[64:67]
M v[68:71], v[172:175], a[252:255], v[68:71]
ds_read_b64_tr_b16 v[124:125], v11 offset:8192
ds_read_b64_tr_b16 v[126:127], v11 offset:12288
M v[68:71], v[168:171], a[248:251], v[68:71]
ds_read_b64_tr_b16 v[128:129], v12 offset:0
ds_read_b64_tr_b16 v[130:131], v12 offset:4096
M v[72:75], v[176:179], a[248:251], v[72:75]
ds_read_b64_tr_b16 v[132:133], v12 offset:8192
ds_read_b64_tr_b16 v[134:135], v12 offset:12288
M v[72:75], v[180:183], a[252:255], v[72:75]
M v[76:79], v[188:191], a[252:255], v[76:79]
ds_read_b64_tr_b16 v[136:137], v13 offset:0
ds_read_b64_tr_b16 v[138:139], v13 offset:4096
M v[76:79], v[184:187], a[248:251], v[76:79]
ds_read_b64_tr_b16 v[140:141], v13 offset:8192
ds_read_b64_tr_b16 v[142:143], v13 offset:12288
M v[80:83], v[192:195], a[248:251], v[80:83]
ds_read_b64_tr_b16 v[144:145], v14 offset:0
ds_read_b64_tr_b16 v[146:147], v14 offset:4096
M v[80:83], v[196:199], a[252:255], v[80:83]
M v[84:87], v[204:207], a[252:255], v[84:87]
ds_read_b64_tr_b16 v[148:149], v14 offset:8192
ds_read_b64_tr_b16 v[150:151], v14 offset:12288
M v[84:87], v[200:203], a[248:251], v[84:87]
ds_read_b64_tr_b16 v[152:153], v15 offset:0
ds_read_b64_tr_b16 v[154:155], v15 offset:4096
M v[88:91], v[208:211], a[248:251], v[88:91]
ds_read_b64_tr_b16 v[156:157], v15 offset:8192
ds_read_b64_tr_b16 v[158:159], v15 offset:12288
M v[88:91], v[212:215], a[252:255], v[88:91]
M v[92:95], v[220:223], a[252:255], v[92:95]
M v[92:95], v[216:219], a[248:251], v[92:95]
s_waitcnt vmcnt(22) lgkmcnt(0)
s_barrier
M v[32:35], v[96:99], a[128:131], v[32:35]
s_add_u32 m0, s42, 81920
s_nop 0
buffer_load_dwordx4 v6, s[48:51], s26 offen offset:0 lds
M v[32:35], v[100:103], a[132:135], v[32:35]
ds_read_b64_tr_b16 v[160:161], v8 offset:16384
ds_read_b64_tr_b16 v[162:163], v8 offset:20480
M v[36:39], v[108:111], a[132:135], v[36:39]
buffer_load_dwordx4 v7, s[48:51], s26 offen offset:1024 lds
M v[36:39], v[104:107], a[128:131], v[36:39]
ds_read_b64_tr_b16 v[164:165], v8 offset:24576
ds_read_b64_tr_b16 v[166:167], v8 offset:28672
M v[40:43], v[112:115], a[128:131], v[40:43]
M v[40:43], v[116:119], a[132:135], v[40:43]
buffer_load_dwordx4 a[208:211], v1, s[44:47], s25 offen offset:0 sc1
M v[44:47], v[124:127], a[132:135], v[44:47]
ds_read_b64_tr_b16 v[168:169], v9 offset:16384
ds_read_b64_tr_b16 v[170:171], v9 offset:20480
M v[44:47], v[120:123], a[128:131], v[44:47]
buffer_load_dwordx4 a[212:215], v1, s[44:47], s25 offen offset:1024 sc1
M v[48:51], v[128:131], a[128:131], v[48:51]
M v[48:51], v[132:135], a[132:135], v[48:51]
ds_read_b64_tr_b16 v[172:173], v9 offset:24576
ds_read_b64_tr_b16 v[174:175], v9 offset:28672
M v[52:55], v[140:143], a[132:135], v[52:55]
buffer_load_dwordx4 a[216:219], v1, s[44:47], s25 offen offset:2048 sc1
M v[52:55], v[136:139], a[128:131], v[52:55]
ds_read_b64_tr_b16 v[176:177], v10 offset:16384
ds_read_b64_tr_b16 v[178:179], v10 offset:20480
M v[56:59], v[144:147], a[128:131], v[56:59]
M v[56:59], v[148:151], a[132:135], v[56:59]
buffer_load_dwordx4 a[220:223], v1, s[44:47], s25 offen offset:3072 sc1
M v[60:63], v[156:159], a[132:135], v[60:63]
ds_read_b64_tr_b16 v[180:181], v10 offset:24576
ds_read_b64_tr_b16 v[182:183], v10 offset:28672
M v[60:63], v[152:155], a[128:131], v[60:63]
s_add_u32 s25, s25, 16384
s_add_u32 s26, s26, 131072
M v[64:67], v[96:99], a[136:139], v[64:67]
ds_read_b64_tr_b16 v[184:185], v11 offset:16384
ds_read_b64_tr_b16 v[186:187], v11 offset:20480
M v[64:67], v[100:103], a[140:143], v[64:67]
M v[68:71], v[108:111], a[140:143], v[68:71]
ds_read_b64_tr_b16 v[188:189], v11 offset:24576
ds_read_b64_tr_b16 v[190:191], v11 offset:28672
M v[68:71], v[104:107], a[136:139], v[68:71]
ds_read_b64_tr_b16 v[192:193], v12 offset:16384
ds_read_b64_tr_b16 v[194:195], v12 offset:20480
M v[72:75], v[112:115], a[136:139], v[72:75]
ds_read_b64_tr_b16 v[196:197], v12 offset:24576
ds_read_b64_tr_b16 v[198:199], v12 offset:28672
M v[72:75], v[116:119], a[140:143], v[72:75]
M v[76:79], v[124:127], a[140:143], v[76:79]
ds_read_b64_tr_b16 v[200:201], v13 offset:16384
ds_read_b64_tr_b16 v[202:203], v13 offset:20480
M v[76:79], v[120:123], a[136:139], v[76:79]
ds_read_b64_tr_b16 v[204:205], v13 offset:24576
ds_read_b64_tr_b16 v[206:207], v13 offset:28672
M v[80:83], v[128:131], a[136:139], v[80:83]
ds_read_b64_tr_b16 v[208:209], v14 offset:16384
ds_read_b64_tr_b16 v[210:211], v14 offset:20480
M v[80:83], v[132:135], a[140:143], v[80:83]
M v[84:87], v[140:143], a[140:143], v[84:87]
ds_read_b64_tr_b16 v[212:213], v14 offset:24576
ds_read_b64_tr_b16 v[214:215], v14 offset:28672
M v[84:87], v[136:139], a[136:139], v[84:87]
ds_read_b64_tr_b16 v[216:217], v15 offset:16384
ds_read_b64_tr_b16 v[218:219], v15 offset:20480
M v[88:91], v[144:147], a[136:139], v[88:91]
ds_read_b64_tr_b16 v[220:221], v15 offset:24576
ds_read_b64_tr_b16 v[222:223], v15 offset:28672
M v[88:91], v[148:151], a[140:143], v[88:91]
M v[92:95], v[156:159], a[140:143], v[92:95]
M v[92:95], v[152:155], a[136:139], v[92:95]
s_waitcnt vmcnt(20) lgkmcnt(0)
s_barrier
M v[32:35], v[160:163], a[144:147], v[32:35]
s_add_u32 m0, s42, 98304
s_nop 0
buffer_load_dwordx4 v6, s[48:51], s26 offen offset:0 lds
M v[32:35], v[164:167], a[148:151], v[32:35]
ds_read_b64_tr_b16 v[96:97], v8 offset:32768
ds_read_b64_tr_b16 v[98:99], v8 offset:36864
M v[36:39], v[172:175], a[148:151], v[36:39]
buffer_load_dwordx4 v7, s[48:51], s26 offen offset:1024 lds
M v[36:39], v[168:171], a[144:147], v[36:39]
ds_read_b64_tr_b16 v[100:101], v8 offset:40960
ds_read_b64_tr_b16 v[102:103], v8 offset:45056
M v[40:43], v[176:179], a[144:147], v[40:43]
M v[40:43], v[180:183], a[148:151], v[40:43]
buffer_load_dwordx4 a[224:227], v1, s[44:47], s25 offen offset:0 sc1
M v[44:47], v[188:191], a[148:151], v[44:47]
ds_read_b64_tr_b16 v[104:105], v9 offset:32768
ds_read_b64_tr_b16 v[106:107], v9 offset:36864
M v[44:47], v[184:187], a[144:147], v[44:47]
buffer_load_dwordx4 a[228:231], v1, s[44:47], s25 offen offset:1024 sc1
M v[48:51], v[192:195], a[144:147], v[48:51]
M v[48:51], v[196:199], a[148:151], v[48:51]
ds_read_b64_tr_b16 v[108:109], v9 offset:40960
ds_read_b64_tr_b16 v[110:111], v9 offset:45056
M v[52:55], v[204:207], a[148:151], v[52:55]
buffer_load_dwordx4 a[232:235], v1, s[44:47], s25 offen offset:2048 sc1
M v[52:55], v[200:203], a[144:147], v[52:55]
ds_read_b64_tr_b16 v[112:113], v10 offset:32768
ds_read_b64_tr_b16 v[114:115], v10 offset:36864
M v[56:59], v[208:211], a[144:147], v[56:59]
M v[56:59], v[212:215], a[148:151], v[56:59]
buffer_load_dwordx4 a[236:239], v1, s[44:47], s25 offen offset:3072 sc1
M v[60:63], v[220:223], a[148:151], v[60:63]
ds_read_b64_tr_b16 v[116:117], v10 offset:40960
ds_read_b64_tr_b16 v[118:119], v10 offset:45056
M v[60:63], v[216:219], a[144:147], v[60:63]
s_add_u32 s25, s25, 16384
s_add_u32 s26, s26, 131072
M v[64:67], v[160:163], a[152:155], v[64:67]
ds_read_b64_tr_b16 v[120:121], v11 offset:32768
ds_read_b64_tr_b16 v[122:123], v11 offset:36864
M v[64:67], v[164:167], a[156:159], v[64:67]
M v[68:71], v[172:175], a[156:159], v[68:71]
ds_read_b64_tr_b16 v[124:125], v11 offset:40960
ds_read_b64_tr_b16 v[126:127], v11 offset:45056
M v[68:71], v[168:171], a[152:155], v[68:71]
ds_read_b64_tr_b16 v[128:129], v12 offset:32768
ds_read_b64_tr_b16 v[130:131], v12 offset:36864
M v[72:75], v[176:179], a[152:155], v[72:75]
ds_read_b64_tr_b16 v[132:133], v12 offset:40960
ds_read_b64_tr_b16 v[134:135], v12 offset:45056
M v[72:75], v[180:183], a[156:159], v[72:75]
M v[76:79], v[188:191], a[156:159], v[76:79]
ds_read_b64_tr_b16 v[136:137], v13 offset:32768
ds_read_b64_tr_b16 v[138:139], v13 offset:36864
M v[76:79], v[184:187], a[152:155], v[76:79]
ds_read_b64_tr_b16 v[140:141], v13 offset:40960
ds_read_b64_tr_b16 v[142:143], v13 offset:45056
M v[80:83], v[192:195], a[152:155], v[80:83]
ds_read_b64_tr_b16 v[144:145], v14 offset:32768
ds_read_b64_tr_b16 v[146:147], v14 offset:36864
M v[80:83], v[196:199], a[156:159], v[80:83]
M v[84:87], v[204:207], a[156:159], v[84:87]
ds_read_b64_tr_b16 v[148:149], v14 offset:40960
ds_read_b64_tr_b16 v[150:151], v14 offset:45056
M v[84:87], v[200:203], a[152:155], v[84:87]
ds_read_b64_tr_b16 v[152:153], v15 offset:32768
ds_read_b64_tr_b16 v[154:155], v15 offset:36864
M v[88:91], v[208:211], a[152:155], v[88:91]
ds_read_b64_tr_b16 v[156:157], v15 offset:40960
ds_read_b64_tr_b16 v[158:159], v15 offset:45056
M v[88:91], v[212:215], a[156:159], v[88:91]
M v[92:95], v[220:223], a[156:159], v[92:95]
M v[92:95], v[216:219], a[152:155], v[92:95]
s_waitcnt vmcnt(18) lgkmcnt(0)
s_barrier
M v[32:35], v[96:99], a[160:163], v[32:35]
s_add_u32 m0, s42, 114688
s_nop 0
buffer_load_dwordx4 v6, s[48:51], s26 offen offset:0 lds
M v[32:35], v[100:103], a[164:167], v[32:35]
ds_read_b64_tr_b16 v[160:161], v8 offset:49152
ds_read_b64_tr_b16 v[162:163], v8 offset:53248
M v[36:39], v[108:111], a[164:167], v[36:39]
buffer_load_dwordx4 v7, s[48:51], s26 offen offset:1024 lds
M v[36:39], v[104:107], a[160:163], v[36:39]
ds_read_b64_tr_b16 v[164:165], v8 offset:57344
ds_read_b64_tr_b16 v[166:167], v8 offset:61440
M v[40:43], v[112:115], a[160:163], v[40:43]
M v[40:43], v[116:119], a[164:167], v[40:43]
buffer_load_dwordx4 a[240:243], v1, s[44:47], s25 offen offset:0 sc1
M v[44:47], v[124:127], a[164:167], v[44:47]
ds_read_b64_tr_b16 v[168:169], v9 offset:49152
ds_read_b64_tr_b16 v[170:171], v9 offset:53248
M v[44:47], v[120:123], a[160:163], v[44:47]
buffer_load_dwordx4 a[244:247], v1, s[44:47], s25 offen offset:1024 sc1
M v[48:51], v[128:131], a[160:163], v[48:51]
M v[48:51], v[132:135], a[164:167], v[48:51]
ds_read_b64_tr_b16 v[172:173], v9 offset:57344
ds_read_b64_tr_b16 v[174:175], v9 offset:61440
M v[52:55], v[140:143], a[164:167], v[52:55]
buffer_load_dwordx4 a[248:251], v1, s[44:47], s25 offen offset:2048 sc1
M v[52:55], v[136:139], a[160:163], v[52:55]
ds_read_b64_tr_b16 v[176:177], v10 offset:49152
ds_read_b64_tr_b16 v[178:179], v10 offset:53248
M v[56:59], v[144:147], a[160:163], v[56:59]
M v[56:59], v[148:151], a[164:167], v[56:59]
buffer_load_dwordx4 a[252:255], v1, s[44:47], s25 offen offset:3072 sc1
M v[60:63], v[156:159], a[164:167], v[60:63]
ds_read_b64_tr_b16 v[180:181], v10 offset:57344
ds_read_b64_tr_b16 v[182:183], v10 offset:61440
M v[60:63], v[152:155], a[160:163], v[60:63]
s_add_u32 s25, s25, 16384
s_add_u32 s26, s26, 131072
M v[64:67], v[96:99], a[168:171], v[64:67]
ds_read_b64_tr_b16 v[184:185], v11 offset:49152
ds_read_b64_tr_b16 v[186:187], v11 offset:53248
M v[64:67], v[100:103], a[172:175], v[64:67]
M v[68:71], v[108:111], a[172:175], v[68:71]
ds_read_b64_tr_b16 v[188:189], v11 offset:57344
ds_read_b64_tr_b16 v[190:191], v11 offset:61440
M v[68:71], v[104:107], a[168:171], v[68:71]
ds_read_b64_tr_b16 v[192:193], v12 offset:49152
ds_read_b64_tr_b16 v[194:195], v12 offset:53248
M v[72:75], v[112:115], a[168:171], v[72:75]
ds_read_b64_tr_b16 v[196:197], v12 offset:57344
ds_read_b64_tr_b16 v[198:199], v12 offset:61440
M v[72:75], v[116:119], a[172:175], v[72:75]
M v[76:79], v[124:127], a[172:175], v[76:79]
ds_read_b64_tr_b16 v[200:201], v13 offset:49152
ds_read_b64_tr_b16 v[202:203], v13 offset:53248
M v[76:79], v[120:123], a[168:171], v[76:79]
ds_read_b64_tr_b16 v[204:205], v13 offset:57344
ds_read_b64_tr_b16 v[206:207], v13 offset:61440
M v[80:83], v[128:131], a[168:171], v[80:83]
ds_read_b64_tr_b16 v[208:209], v14 offset:49152
ds_read_b64_tr_b16 v[210:211], v14 offset:53248
M v[80:83], v[132:135], a[172:175], v[80:83]
M v[84:87], v[140:143], a[172:175], v[84:87]
ds_read_b64_tr_b16 v[212:213], v14 offset:57344
ds_read_b64_tr_b16 v[214:215], v14 offset:61440
M v[84:87], v[136:139], a[168:171], v[84:87]
ds_read_b64_tr_b16 v[216:217], v15 offset:49152
ds_read_b64_tr_b16 v[218:219], v15 offset:53248
M v[88:91], v[144:147], a[168:171], v[88:91]
ds_read_b64_tr_b16 v[220:221], v15 offset:57344
ds_read_b64_tr_b16 v[222:223], v15 offset:61440
M v[88:91], v[148:151], a[172:175], v[88:91]
M v[92:95], v[156:159], a[172:175], v[92:95]
M v[92:95], v[152:155], a[168:171], v[92:95]
s_waitcnt vmcnt(18) lgkmcnt(0)
s_barrier
M v[32:35], v[160:163], a[176:179], v[32:35]
s_add_u32 m0, s42, 0
s_nop 0
buffer_load_dwordx4 v6, s[48:51], s26 offen offset:0 lds
M v[32:35], v[164:167], a[180:183], v[32:35]
M v[36:39], v[172:175], a[180:183], v[36:39]
ds_read_b64_tr_b16 v[96:97], v28 offset:0
ds_read_b64_tr_b16 v[98:99], v28 offset:2048
M v[36:39], v[168:171], a[176:179], v[36:39]
M v[40:43], v[176:179], a[176:179], v[40:43]
buffer_load_dwordx4 v7, s[48:51], s26 offen offset:1024 lds
M v[40:43], v[180:183], a[180:183], v[40:43]
M v[44:47], v[188:191], a[180:183], v[44:47]
ds_read_b64_tr_b16 v[100:101], v28 offset:4096
ds_read_b64_tr_b16 v[102:103], v28 offset:6144
M v[44:47], v[184:187], a[176:179], v[44:47]
M v[48:51], v[192:195], a[176:179], v[48:51]
buffer_load_dwordx4 a[128:131], v1, s[44:47], s25 offen offset:0 sc1
M v[48:51], v[196:199], a[180:183], v[48:51]
M v[52:55], v[204:207], a[180:183], v[52:55]
ds_read_b64_tr_b16 v[104:105], v29 offset:0
ds_read_b64_tr_b16 v[106:107], v29 offset:2048
M v[52:55], v[200:203], a[176:179], v[52:55]
M v[56:59], v[208:211], a[176:179], v[56:59]
buffer_load_dwordx4 a[132:135], v1, s[44:47], s25 offen offset:1024 sc1
M v[56:59], v[212:215], a[180:183], v[56:59]
M v[60:63], v[220:223], a[180:183], v[60:63]
ds_read_b64_tr_b16 v[108:109], v29 offset:4096
ds_read_b64_tr_b16 v[110:111], v29 offset:6144
M v[60:63], v[216:219], a[176:179], v[60:63]
M v[64:67], v[160:163], a[184:187], v[64:67]
buffer_load_dwordx4 a[136:139], v1, s[44:47], s25 offen offset:2048 sc1
M v[64:67], v[164:167], a[188:191], v[64:67]
M v[68:71], v[172:175], a[188:191], v[68:71]
ds_read_b64_tr_b16 v[112:113], v30 offset:0
ds_read_b64_tr_b16 v[114:115], v30 offset:2048
M v[68:71], v[168:171], a[184:187], v[68:71]
M v[72:75], v[176:179], a[184:187], v[72:75]
buffer_load_dwordx4 a[140:143], v1, s[44:47], s25 offen offset:3072 sc1
M v[72:75], v[180:183], a[188:191], v[72:75]
M v[76:79], v[188:191], a[188:191], v[76:79]
ds_read_b64_tr_b16 v[116:117], v30 offset:4096
ds_read_b64_tr_b16 v[118:119], v30 offset:6144
M v[76:79], v[184:187], a[184:187], v[76:79]
M v[80:83], v[192:195], a[184:187], v[80:83]
s_add_u32 s25, s25, 16384
s_add_u32 s26, s26, 131072
M v[80:83], v[196:199], a[188:191], v[80:83]
M v[84:87], v[204:207], a[188:191], v[84:87]
ds_read_b64_tr_b16 v[120:121], v31 offset:0
ds_read_b64_tr_b16 v[122:123], v31 offset:2048
M v[84:87], v[200:203], a[184:187], v[84:87]
M v[88:91], v[208:211], a[184:187], v[88:91]
ds_read_b64_tr_b16 v[124:125], v31 offset:4096
ds_read_b64_tr_b16 v[126:127], v31 offset:6144
M v[88:91], v[212:215], a[188:191], v[88:91]
M v[92:95], v[220:223], a[188:191], v[92:95]
M v[92:95], v[216:219], a[184:187], v[92:95]
s_waitcnt vmcnt(18) lgkmcnt(0)
s_barrier
M a[0:3], v[96:99], a[192:195], a[0:3]
s_add_u32 m0, s42, 16384
s_nop 0
buffer_load_dwordx4 v6, s[48:51], s26 offen offset:0 lds
ds_read_b64_tr_b16 v[160:161], v28 offset:16384
ds_read_b64_tr_b16 v[162:163], v28 offset:18432
M a[0:3], v[100:103], a[196:199], a[0:3]
buffer_load_dwordx4 v7, s[48:51], s26 offen offset:1024 lds
ds_read_b64_tr_b16 v[164:165], v28 offset:20480
ds_read_b64_tr_b16 v[166:167], v28 offset:22528
M a[4:7], v[108:111], a[196:199], a[4:7]
buffer_load_dwordx4 a[144:147], v1, s[44:47], s25 offen offset:0 sc1
ds_read_b64_tr_b16 v[168:169], v29 offset:16384
ds_read_b64_tr_b16 v[170:171], v29 offset:18432
M a[4:7], v[104:107], a[192:195], a[4:7]
buffer_load_dwordx4 a[148:151], v1, s[44:47], s25 offen offset:1024 sc1
M a[8:11], v[112:115], a[192:195], a[8:11]
ds_read_b64_tr_b16 v[172:173], v29 offset:20480
ds_read_b64_tr_b16 v[174:175], v29 offset:22528
buffer_load_dwordx4 a[152:155], v1, s[44:47], s25 offen offset:2048 sc1
M a[8:11], v[116:119], a[196:199], a[8:11]
ds_read_b64_tr_b16 v[176:177], v30 offset:16384
ds_read_b64_tr_b16 v[178:179], v30 offset:18432
buffer_load_dwordx4 a[156:159], v1, s[44:47], s25 offen offset:3072 sc1
M a[12:15], v[124:127], a[196:199], a[12:15]
ds_read_b64_tr_b16 v[180:181], v30 offset:20480
ds_read_b64_tr_b16 v[182:183], v30 offset:22528
M a[12:15], v[120:123], a[192:195], a[12:15]
s_add_u32 s25, s25, 16384
s_add_u32 s26, s26, 131072
ds_read_b64_tr_b16 v[184:185], v31 offset:16384
ds_read_b64_tr_b16 v[186:187], v31 offset:18432
M a[16:19], v[96:99], a[200:203], a[16:19]
s_add_u32 s60, s56, 0
buffer_store_dwordx4 v[48:51], v1, s[52:55], s60 offen offset:0 sc1
ds_read_b64_tr_b16 v[188:189], v31 offset:20480
ds_read_b64_tr_b16 v[190:191], v31 offset:22528
M a[16:19], v[100:103], a[204:207], a[16:19]
buffer_store_dwordx4 v[52:55], v1, s[52:55], s60 offen offset:1024 sc1
buffer_store_dwordx4 v[56:59], v1, s[52:55], s60 offen offset:2048 sc1
M a[20:23], v[108:111], a[204:207], a[20:23]
buffer_store_dwordx4 v[60:63], v1, s[52:55], s60 offen offset:3072 sc1
M a[20:23], v[104:107], a[200:203], a[20:23]
s_add_u32 s60, s56, 4096
buffer_store_dwordx4 v[80:83], v1, s[52:55], s60 offen offset:0 sc1
buffer_store_dwordx4 v[84:87], v1, s[52:55], s60 offen offset:1024 sc1
M a[24:27], v[112:115], a[200:203], a[24:27]
buffer_store_dwordx4 v[88:91], v1, s[52:55], s60 offen offset:2048 sc1
buffer_store_dwordx4 v[92:95], v1, s[52:55], s60 offen offset:3072 sc1
M a[24:27], v[116:119], a[204:207], a[24:27]
v_mov_b32 v11, 0
M a[28:31], v[124:127], a[204:207], a[28:31]
M a[28:31], v[120:123], a[200:203], a[28:31]
s_waitcnt vmcnt(26) lgkmcnt(0)
s_barrier
M a[0:3], v[160:163], a[208:211], a[0:3]
s_add_u32 m0, s42, 32768
s_nop 0
buffer_load_dwordx4 v6, s[48:51], s26 offen offset:0 lds
ds_read_b64_tr_b16 v[96:97], v28 offset:32768
ds_read_b64_tr_b16 v[98:99], v28 offset:34816
M a[0:3], v[164:167], a[212:215], a[0:3]
buffer_load_dwordx4 v7, s[48:51], s26 offen offset:1024 lds
M a[4:7], v[172:175], a[212:215], a[4:7]
ds_read_b64_tr_b16 v[100:101], v28 offset:36864
ds_read_b64_tr_b16 v[102:103], v28 offset:38912
M a[4:7], v[168:171], a[208:211], a[4:7]
buffer_load_dwordx4 a[160:163], v1, s[44:47], s25 offen offset:0 sc1
M a[8:11], v[176:179], a[208:211], a[8:11]
ds_read_b64_tr_b16 v[104:105], v29 offset:32768
ds_read_b64_tr_b16 v[106:107], v29 offset:34816
M a[8:11], v[180:183], a[212:215], a[8:11]
buffer_load_dwordx4 a[164:167], v1, s[44:47], s25 offen offset:1024 sc1
M a[12:15], v[188:191], a[212:215], a[12:15]
ds_read_b64_tr_b16 v[108:109], v29 offset:36864
ds_read_b64_tr_b16 v[110:111], v29 offset:38912
M a[12:15], v[184:187], a[208:211], a[12:15]
buffer_load_dwordx4 a[168:171], v1, s[44:47], s25 offen offset:2048 sc1
M a[16:19], v[160:163], a[216:219], a[16:19]
ds_read_b64_tr_b16 v[112:113], v30 offset:32768
ds_read_b64_tr_b16 v[114:115], v30 offset:34816
M a[16:19], v[164:167], a[220:223], a[16:19]
buffer_load_dwordx4 a[172:175], v1, s[44:47], s25 offen offset:3072 sc1
M a[20:23], v[172:175], a[220:223], a[20:23]
ds_read_b64_tr_b16 v[116:117], v30 offset:36864
ds_read_b64_tr_b16 v[118:119], v30 offset:38912
M a[20:23], v[168:171], a[216:219], a[20:23]
s_add_u32 s25, s25, 16384
s_add_u32 s26, s26, 131072
M a[24:27], v[176:179], a[216:219], a[24:27]
ds_read_b64_tr_b16 v[120:121], v31 offset:32768
ds_read_b64_tr_b16 v[122:123], v31 offset:34816
M a[24:27], v[180:183], a[220:223], a[24:27]
ds_read_b64_tr_b16 v[124:125], v31 offset:36864
ds_read_b64_tr_b16 v[126:127], v31 offset:38912
M a[28:31], v[188:191], a[220:223], a[28:31]
M a[28:31], v[184:187], a[216:219], a[28:31]
s_waitcnt vmcnt(6) lgkmcnt(0)
s_barrier
s_cmp_lg_u32 s101, 0
s_cbranch_scc1 Lk3f_7
v_mov_b32 v9, 1
s_mov_b64 exec, 1
buffer_store_dword v9, v11, s[52:55], s58 offen sc1
s_mov_b64 exec, -1
Lk3f_7:
M a[0:3], v[96:99], a[224:227], a[0:3]
s_add_u32 m0, s42, 49152
s_nop 0
buffer_load_dwordx4 v6, s[48:51], s26 offen offset:0 lds
ds_read_b64_tr_b16 v[160:161], v28 offset:49152
ds_read_b64_tr_b16 v[162:163], v28 offset:51200
M a[0:3], v[100:103], a[228:231], a[0:3]
buffer_load_dwordx4 v7, s[48:51], s26 offen offset:1024 lds
M a[4:7], v[108:111], a[228:231], a[4:7]
ds_read_b64_tr_b16 v[164:165], v28 offset:53248
ds_read_b64_tr_b16 v[166:167], v28 offset:55296
M a[4:7], v[104:107], a[224:227], a[4:7]
buffer_load_dwordx4 a[176:179], v1, s[44:47], s25 offen offset:0 sc1
M a[8:11], v[112:115], a[224:227], a[8:11]
ds_read_b64_tr_b16 v[168:169], v29 offset:49152
ds_read_b64_tr_b16 v[170:171], v29 offset:51200
M a[8:11], v[116:119], a[228:231], a[8:11]
buffer_load_dwordx4 a[180:183], v1, s[44:47], s25 offen offset:1024 sc1
M a[12:15], v[124:127], a[228:231], a[12:15]
ds_read_b64_tr_b16 v[172:173], v29 offset:53248
ds_read_b64_tr_b16 v[174:175], v29 offset:55296
M a[12:15], v[120:123], a[224:227], a[12:15]
buffer_load_dwordx4 a[184:187], v1, s[44:47], s25 offen offset:2048 sc1
M a[16:19], v[96:99], a[232:235], a[16:19]
ds_read_b64_tr_b16 v[176:177], v30 offset:49152
ds_read_b64_tr_b16 v[178:179], v30 offset:51200
M a[16:19], v[100:103], a[236:239], a[16:19]
buffer_load_dwordx4 a[188:191], v1, s[44:47], s25 offen offset:3072 sc1
M a[20:23], v[108:111], a[236:239], a[20:23]
ds_read_b64_tr_b16 v[180:181], v30 offset:53248
ds_read_b64_tr_b16 v[182:183], v30 offset:55296
M a[20:23], v[104:107], a[232:235], a[20:23]
s_add_u32 s25, s25, 16384
s_add_u32 s26, s26, 131072
M a[24:27], v[112:115], a[232:235], a[24:27]
ds_read_b64_tr_b16 v[184:185], v31 offset:49152
ds_read_b64_tr_b16 v[186:187], v31 offset:51200
M a[24:27], v[116:119], a[236:239], a[24:27]
ds_read_b64_tr_b16 v[188:189], v31 offset:53248
ds_read_b64_tr_b16 v[190:191], v31 offset:55296
M a[28:31], v[124:127], a[236:239], a[28:31]
M a[28:31], v[120:123], a[232:235], a[28:31]
s_waitcnt vmcnt(26) lgkmcnt(0)
s_barrier
M a[0:3], v[160:163], a[240:243], a[0:3]
ds_read_b64_tr_b16 v[96:97], v24 offset:0
ds_read_b64_tr_b16 v[98:99], v24 offset:2048
M a[0:3], v[164:167], a[244:247], a[0:3]
ds_read_b64_tr_b16 v[100:101], v24 offset:4096
ds_read_b64_tr_b16 v[102:103], v24 offset:6144
M a[4:7], v[172:175], a[244:247], a[4:7]
M a[4:7], v[168:171], a[240:243], a[4:7]
ds_read_b64_tr_b16 v[104:105], v25 offset:0
ds_read_b64_tr_b16 v[106:107], v25 offset:2048
M a[8:11], v[176:179], a[240:243], a[8:11]
M a[8:11], v[180:183], a[244:247], a[8:11]
ds_read_b64_tr_b16 v[108:109], v25 offset:4096
ds_read_b64_tr_b16 v[110:111], v25 offset:6144
M a[12:15], v[188:191], a[244:247], a[12:15]
M a[12:15], v[184:187], a[240:243], a[12:15]
ds_read_b64_tr_b16 v[112:113], v26 offset:0
ds_read_b64_tr_b16 v[114:115], v26 offset:2048
M a[16:19], v[160:163], a[248:251], a[16:19]
ds_read_b64_tr_b16 v[116:117], v26 offset:4096
ds_read_b64_tr_b16 v[118:119], v26 offset:6144
M a[16:19], v[164:167], a[252:255], a[16:19]
M a[20:23], v[172:175], a[252:255], a[20:23]
ds_read_b64_tr_b16 v[120:121], v27 offset:0
ds_read_b64_tr_b16 v[122:123], v27 offset:2048
M a[20:23], v[168:171], a[248:251], a[20:23]
M a[24:27], v[176:179], a[248:251], a[24:27]
ds_read_b64_tr_b16 v[124:125], v27 offset:4096
ds_read_b64_tr_b16 v[126:127], v27 offset:6144
M a[24:27], v[180:183], a[252:255], a[24:27]
M a[28:31], v[188:191], a[252:255], a[28:31]
M a[28:31], v[184:187], a[248:251], a[28:31]
s_waitcnt vmcnt(20) lgkmcnt(0)
s_barrier
M a[0:3], v[96:99], a[128:131], a[0:3]
ds_read_b64_tr_b16 v[160:161], v24 offset:16384
ds_read_b64_tr_b16 v[162:163], v24 offset:18432
M a[0:3], v[100:103], a[132:135], a[0:3]
ds_read_b64_tr_b16 v[164:165], v24 offset:20480
ds_read_b64_tr_b16 v[166:167], v24 offset:22528
M a[4:7], v[108:111], a[132:135], a[4:7]
M a[4:7], v[104:107], a[128:131], a[4:7]
ds_read_b64_tr_b16 v[168:169], v25 offset:16384
ds_read_b64_tr_b16 v[170:171], v25 offset:18432
M a[8:11], v[112:115], a[128:131], a[8:11]
M a[8:11], v[116:119], a[132:135], a[8:11]
ds_read_b64_tr_b16 v[172:173], v25 offset:20480
ds_read_b64_tr_b16 v[174:175], v25 offset:22528
M a[12:15], v[124:127], a[132:135], a[12:15]
M a[12:15], v[120:123], a[128:131], a[12:15]
ds_read_b64_tr_b16 v[176:177], v26 offset:16384
ds_read_b64_tr_b16 v[178:179], v26 offset:18432
M a[16:19], v[96:99], a[136:139], a[16:19]
ds_read_b64_tr_b16 v[180:181], v26 offset:20480
ds_read_b64_tr_b16 v[182:183], v26 offset:22528
M a[16:19], v[100:103], a[140:143], a[16:19]
M a[20:23], v[108:111], a[140:143], a[20:23]
ds_read_b64_tr_b16 v[184:185], v27 offset:16384
ds_read_b64_tr_b16 v[186:187], v27 offset:18432
M a[20:23], v[104:107], a[136:139], a[20:23]
M a[24:27], v[112:115], a[136:139], a[24:27]
ds_read_b64_tr_b16 v[188:189], v27 offset:20480
ds_read_b64_tr_b16 v[190:191], v27 offset:22528
M a[24:27], v[116:119], a[140:143], a[24:27]
M a[28:31], v[124:127], a[140:143], a[28:31]
M a[28:31], v[120:123], a[136:139], a[28:31]
s_waitcnt vmcnt(6) lgkmcnt(0)
s_barrier
M a[0:3], v[160:163], a[144:147], a[0:3]
buffer_load_dword v8, v11, s[52:55], s59 offen sc1
M a[0:3], v[164:167], a[148:151], a[0:3]
ds_read_b64_tr_b16 v[96:97], v24 offset:32768
ds_read_b64_tr_b16 v[98:99], v24 offset:34816
M a[4:7], v[172:175], a[148:151], a[4:7]
M a[4:7], v[168:171], a[144:147], a[4:7]
ds_read_b64_tr_b16 v[100:101], v24 offset:36864
ds_read_b64_tr_b16 v[102:103], v24 offset:38912
M a[8:11], v[176:179], a[144:147], a[8:11]
ds_read_b64_tr_b16 v[104:105], v25 offset:32768
ds_read_b64_tr_b16 v[106:107], v25 offset:34816
M a[8:11], v[180:183], a[148:151], a[8:11]
M a[12:15], v[188:191], a[148:151], a[12:15]
ds_read_b64_tr_b16 v[108:109], v25 offset:36864
ds_read_b64_tr_b16 v[110:111], v25 offset:38912
M a[12:15], v[184:187], a[144:147], a[12:15]
ds_read_b64_tr_b16 v[112:113], v26 offset:32768
ds_read_b64_tr_b16 v[114:115], v26 offset:34816
M a[16:19], v[160:163], a[152:155], a[16:19]
M a[16:19], v[164:167], a[156:159], a[16:19]
ds_read_b64_tr_b16 v[116:117], v26 offset:36864
ds_read_b64_tr_b16 v[118:119], v26 offset:38912
M a[20:23], v[172:175], a[156:159], a[20:23]
ds_read_b64_tr_b16 v[120:121], v27 offset:32768
ds_read_b64_tr_b16 v[122:123], v27 offset:34816
M a[20:23], v[168:171], a[152:155], a[20:23]
M a[24:27], v[176:179], a[152:155], a[24:27]
ds_read_b64_tr_b16 v[124:125], v27 offset:36864
ds_read_b64_tr_b16 v[126:127], v27 offset:38912
M a[24:27], v[180:183], a[156:159], a[24:27]
M a[28:31], v[188:191], a[156:159], a[28:31]
M a[28:31], v[184:187], a[152:155], a[28:31]
s_waitcnt vmcnt(1) lgkmcnt(0)
s_barrier
s_waitcnt vmcnt(0)
v_cmp_ne_u32 vcc, 1, v8
s_nop 0
s_cbranch_vccnz Lk3_spinfl
Lk3_gotfl:
M a[0:3], v[96:99], a[160:163], a[0:3]
s_add_u32 s60, s57, 0
buffer_load_dwordx4 v[224:227], v1, s[52:55], s60 offen offset:0 sc1
ds_read_b64_tr_b16 v[160:161], v24 offset:49152
ds_read_b64_tr_b16 v[162:163], v24 offset:51200
M a[0:3], v[100:103], a[164:167], a[0:3]
buffer_load_dwordx4 v[228:231], v1, s[52:55], s60 offen offset:1024 sc1
M a[4:7], v[108:111], a[164:167], a[4:7]
ds_read_b64_tr_b16 v[164:165], v24 offset:53248
ds_read_b64_tr_b16 v[166:167], v24 offset:55296
M a[4:7], v[104:107], a[160:163], a[4:7]
buffer_load_dwordx4 v[232:235], v1, s[52:55], s60 offen offset:2048 sc1
M a[8:11], v[112:115], a[160:163], a[8:11]
ds_read_b64_tr_b16 v[168:169], v25 offset:49152
ds_read_b64_tr_b16 v[170:171], v25 offset:51200
M a[8:11], v[116:119], a[164:167], a[8:11]
buffer_load_dwordx4 v[236:239], v1, s[52:55], s60 offen offset:3072 sc1
M a[12:15], v[124:127], a[164:167], a[12:15]
ds_read_b64_tr_b16 v[172:173], v25 offset:53248
ds_read_b64_tr_b16 v[174:175], v25 offset:55296
M a[12:15], v[120:123], a[160:163], a[12:15]
s_add_u32 s60, s57, 4096
buffer_load_dwordx4 v[240:243], v1, s[52:55], s60 offen offset:0 sc1
ds_read_b64_tr_b16 v[176:177], v26 offset:49152
ds_read_b64_tr_b16 v[178:179], v26 offset:51200
M a[16:19], v[96:99], a[168:171], a[16:19]
buffer_load_dwordx4 v[244:247], v1, s[52:55], s60 offen offset:1024 sc1
M a[16:19], v[100:103], a[172:175], a[16:19]
ds_read_b64_tr_b16 v[180:181], v26 offset:53248
ds_read_b64_tr_b16 v[182:183], v26 offset:55296
M a[20:23], v[108:111], a[172:175], a[20:23]
buffer_load_dwordx4 v[248:251], v1, s[52:55], s60 offen offset:2048 sc1
M a[20:23], v[104:107], a[168:171], a[20:23]
ds_read_b64_tr_b16 v[184:185], v27 offset:49152
ds_read_b64_tr_b16 v[186:187], v27 offset:51200
M a[24:27], v[112:115], a[168:171], a[24:27]
buffer_load_dwordx4 v[252:255], v1, s[52:55], s60 offen offset:3072 sc1
M a[24:27], v[116:119], a[172:175], a[24:27]
ds_read_b64_tr_b16 v[188:189], v27 offset:53248
ds_read_b64_tr_b16 v[190:191], v27 offset:55296
M a[28:31], v[124:127], a[172:175], a[28:31]
M a[28:31], v[120:123], a[168:171], a[28:31]
s_waitcnt lgkmcnt(0)
M a[0:3], v[160:163], a[176:179], a[0:3]
M a[0:3], v[164:167], a[180:183], a[0:3]
M a[4:7], v[172:175], a[180:183], a[4:7]
M a[4:7], v[168:171], a[176:179], a[4:7]
M a[8:11], v[176:179], a[176:179], a[8:11]
M a[8:11], v[180:183], a[180:183], a[8:11]
M a[12:15], v[188:191], a[180:183], a[12:15]
M a[12:15], v[184:187], a[176:179], a[12:15]
M a[16:19], v[160:163], a[184:187], a[16:19]
M a[16:19], v[164:167], a[188:191], a[16:19]
M a[20:23], v[172:175], a[188:191], a[20:23]
M a[20:23], v[168:171], a[184:187], a[20:23]
M a[24:27], v[176:179], a[184:187], a[24:27]
M a[24:27], v[180:183], a[188:191], a[24:27]
M a[28:31], v[188:191], a[188:191], a[28:31]
M a[28:31], v[184:187], a[184:187], a[28:31]
v_bfe_u32 v96, v0, 4, 1
v_lshrrev_b32 v97, 5, v0
v_lshl_or_b32 v96, v96, 1, v97
v_and_b32 v97, 15, v0
v_lshlrev_b32 v97, 13, v97
v_lshl_add_u32 v96, v96, 4, v97
s_and_b32 s3, s101, 1
s_lshl_b32 s3, s3, 6
s_lshr_b32 s6, s101, 1
s_add_u32 s3, s3, s6
s_add_u32 s3, s3, s21
s_lshl_b32 s3, s3, 12
s_lshl_b32 s6, s22, 1
s_add_u32 s3, s3, s6
s_add_u32 s3, s3, 2048
v_accvgpr_read_b32 v108, a0
v_accvgpr_read_b32 v109, a1
v_accvgpr_read_b32 v110, a2
v_accvgpr_read_b32 v111, a3
v_accvgpr_read_b32 v112, a4
v_accvgpr_read_b32 v113, a5
v_accvgpr_read_b32 v114, a6
v_accvgpr_read_b32 v115, a7
v_cvt_pk_bf16_f32 v100, v108, v109
v_cvt_pk_bf16_f32 v101, v110, v111
v_cvt_pk_bf16_f32 v102, v112, v113
v_cvt_pk_bf16_f32 v103, v114, v115
s_nop 0
v_permlane16_swap_b32 v100, v102
v_permlane16_swap_b32 v101, v103
buffer_store_dwordx4 v[100:103], v96, s[16:19], s3 offen offset:0
v_accvgpr_read_b32 v108, a8
v_accvgpr_read_b32 v109, a9
v_accvgpr_read_b32 v110, a10
v_accvgpr_read_b32 v111, a11
v_accvgpr_read_b32 v112, a12
v_accvgpr_read_b32 v113, a13
v_accvgpr_read_b32 v114, a14
v_accvgpr_read_b32 v115, a15
v_cvt_pk_bf16_f32 v104, v108, v109
v_cvt_pk_bf16_f32 v105, v110, v111
v_cvt_pk_bf16_f32 v106, v112, v113
v_cvt_pk_bf16_f32 v107, v114, v115
s_nop 0
v_permlane16_swap_b32 v104, v106
v_permlane16_swap_b32 v105, v107
buffer_store_dwordx4 v[104:107], v96, s[16:19], s3 offen offset:64
s_add_u32 s3, s3, 131072
v_accvgpr_read_b32 v108, a16
v_accvgpr_read_b32 v109, a17
v_accvgpr_read_b32 v110, a18
v_accvgpr_read_b32 v111, a19
v_accvgpr_read_b32 v112, a20
v_accvgpr_read_b32 v113, a21
v_accvgpr_read_b32 v114, a22
v_accvgpr_read_b32 v115, a23
v_cvt_pk_bf16_f32 v100, v108, v109
v_cvt_pk_bf16_f32 v101, v110, v111
v_cvt_pk_bf16_f32 v102, v112, v113
v_cvt_pk_bf16_f32 v103, v114, v115
s_nop 0
v_permlane16_swap_b32 v100, v102
v_permlane16_swap_b32 v101, v103
buffer_store_dwordx4 v[100:103], v96, s[16:19], s3 offen offset:0
v_accvgpr_read_b32 v108, a24
v_accvgpr_read_b32 v109, a25
v_accvgpr_read_b32 v110, a26
v_accvgpr_read_b32 v111, a27
v_accvgpr_read_b32 v112, a28
v_accvgpr_read_b32 v113, a29
v_accvgpr_read_b32 v114, a30
v_accvgpr_read_b32 v115, a31
v_cvt_pk_bf16_f32 v104, v108, v109
v_cvt_pk_bf16_f32 v105, v110, v111
v_cvt_pk_bf16_f32 v106, v112, v113
v_cvt_pk_bf16_f32 v107, v114, v115
s_nop 0
v_permlane16_swap_b32 v104, v106
v_permlane16_swap_b32 v105, v107
buffer_store_dwordx4 v[104:107], v96, s[16:19], s3 offen offset:64
v_bfe_u32 v128, v0, 4, 1
v_lshrrev_b32 v129, 5, v0
v_lshl_or_b32 v128, v128, 1, v129
v_and_b32 v129, 15, v0
v_lshlrev_b32 v129, 12, v129
v_lshl_add_u32 v128, v128, 4, v129
s_lshl_b32 s3, s101, 5
s_add_u32 s3, s3, s29
s_lshl_b32 s3, s3, 12
s_lshl_b32 s6, s30, 1
s_add_u32 s3, s3, s6
s_waitcnt vmcnt(4)
v_pk_add_f32 v[32:33], v[32:33], v[224:225]
v_pk_add_f32 v[34:35], v[34:35], v[226:227]
v_pk_add_f32 v[36:37], v[36:37], v[228:229]
v_pk_add_f32 v[38:39], v[38:39], v[230:231]
v_cvt_pk_bf16_f32 v132, v32, v33
v_cvt_pk_bf16_f32 v133, v34, v35
v_cvt_pk_bf16_f32 v134, v36, v37
v_cvt_pk_bf16_f32 v135, v38, v39
s_nop 0
v_permlane16_swap_b32 v132, v134
v_permlane16_swap_b32 v133, v135
buffer_store_dwordx4 v[132:135], v128, s[16:19], s3 offen offset:0
v_pk_add_f32 v[40:41], v[40:41], v[232:233]
v_pk_add_f32 v[42:43], v[42:43], v[234:235]
v_pk_add_f32 v[44:45], v[44:45], v[236:237]
v_pk_add_f32 v[46:47], v[46:47], v[238:239]
v_cvt_pk_bf16_f32 v136, v40, v41
v_cvt_pk_bf16_f32 v137, v42, v43
v_cvt_pk_bf16_f32 v138, v44, v45
v_cvt_pk_bf16_f32 v139, v46, v47
s_nop 0
v_permlane16_swap_b32 v136, v138
v_permlane16_swap_b32 v137, v139
buffer_store_dwordx4 v[136:139], v128, s[16:19], s3 offen offset:64
s_add_u32 s3, s3, 65536
v_pk_add_f32 v[64:65], v[64:65], v[240:241]
v_pk_add_f32 v[66:67], v[66:67], v[242:243]
v_pk_add_f32 v[68:69], v[68:69], v[244:245]
v_pk_add_f32 v[70:71], v[70:71], v[246:247]
v_cvt_pk_bf16_f32 v132, v64, v65
v_cvt_pk_bf16_f32 v133, v66, v67
v_cvt_pk_bf16_f32 v134, v68, v69
v_cvt_pk_bf16_f32 v135, v70, v71
s_nop 0
v_permlane16_swap_b32 v132, v134
v_permlane16_swap_b32 v133, v135
buffer_store_dwordx4 v[132:135], v128, s[16:19], s3 offen offset:0
v_pk_add_f32 v[72:73], v[72:73], v[248:249]
v_pk_add_f32 v[74:75], v[74:75], v[250:251]
v_pk_add_f32 v[76:77], v[76:77], v[252:253]
v_pk_add_f32 v[78:79], v[78:79], v[254:255]
v_cvt_pk_bf16_f32 v136, v72, v73
v_cvt_pk_bf16_f32 v137, v74, v75
v_cvt_pk_bf16_f32 v138, v76, v77
v_cvt_pk_bf16_f32 v139, v78, v79
s_nop 0
v_permlane16_swap_b32 v136, v138
v_permlane16_swap_b32 v137, v139
buffer_store_dwordx4 v[136:139], v128, s[16:19], s3 offen offset:64
s_endpgm
Lk3_spinb0:
Lk3_spinb0_:
s_add_u32 s61, s61, 1
s_cmp_gt_u32 s61, 1048576
s_cbranch_scc1 Lk3_gotb0
s_sleep 2
buffer_load_dword v7, v15, s[52:55], s43 offen sc1
s_waitcnt vmcnt(0)
v_cmp_ne_u32 vcc, 1, v7
s_nop 0
s_cbranch_vccnz Lk3_spinb0_
s_branch Lk3_gotb0
Lk3_spinb1:
Lk3_spinb1_:
s_add_u32 s61, s61, 1
s_cmp_gt_u32 s61, 1048576
s_cbranch_scc1 Lk3_gotb1
s_sleep 2
buffer_load_dword v7, v15, s[52:55], s43 offen sc1
s_waitcnt vmcnt(0)
v_cmp_ne_u32 vcc, 1, v7
s_nop 0
s_cbranch_vccnz Lk3_spinb1_
s_branch Lk3_gotb1
Lk3_spinft:
s_add_u32 s61, s61, 1
s_cmp_gt_u32 s61, 1048576
s_cbranch_scc1 Lk3_gotft
s_sleep 2
buffer_load_dword v252, v255, s[52:55], s62 offen sc1
s_waitcnt vmcnt(0)
v_cmp_ne_u32 vcc, 1, v252
s_nop 0
s_cbranch_vccnz Lk3_spinft
s_branch Lk3_gotft
Lk3_spinfl:
s_add_u32 s61, s61, 1
s_cmp_gt_u32 s61, 1048576
s_cbranch_scc1 Lk3_gotfl
s_sleep 2
buffer_load_dword v8, v11, s[52:55], s59 offen sc1
s_waitcnt vmcnt(0)
v_cmp_ne_u32 vcc, 1, v8
s_nop 0
s_cbranch_vccnz Lk3_spinfl
s_branch Lk3_gotfl
Lc3:
.section .rodata,"a"
.p2align 6
.amdhsa_kernel concat_heads__compressed_kv_cla__sliding_local_dilated__prompt_kernel
  .amdhsa_next_free_vgpr 512
  .amdhsa_next_free_sgpr 102
  .amdhsa_accum_offset 256
  .amdhsa_group_segment_fixed_size 0
  .amdhsa_kernarg_size 96
  .amdhsa_user_sgpr_count 2
  .amdhsa_user_sgpr_kernarg_segment_ptr 1
  .amdhsa_system_sgpr_workgroup_id_x 1
.end_amdhsa_kernel
```

```asm
; @launch grid=(256,1,1) block=(256,1,1) lds=163840
.amdgcn_target "amdgcn-amd-amdhsa--gfx950"
.text
.macro M d, a, b, c
v_mfma_f32_16x16x32_bf16 \d, \a, \b, \c
.endm
.globl concat_heads__compressed_kv_cla__sliding_local_dilated__prompt_kernel
.p2align 8
.type concat_heads__compressed_kv_cla__sliding_local_dilated__prompt_kernel,@function
concat_heads__compressed_kv_cla__sliding_local_dilated__prompt_kernel:
s_cmp_lt_u32 s2, 256
s_cbranch_scc1 Lk1_go
s_endpgm
Lk1_go:
s_load_dwordx16 s[32:47], s[0:1], 0
s_load_dwordx2 s[48:49], s[0:1], 64
s_load_dwordx2 s[50:51], s[0:1], 88
s_load_dwordx2 s[90:91], s[0:1], 80
v_lshrrev_b32 v24, 6, v0
s_nop 0
v_readfirstlane_b32 s20, v24
v_and_b32 v0, 63, v0
v_lshlrev_b32 v1, 4, v0
s_mov_b32 s101, s20
s_lshr_b32 s21, s20, 1
s_and_b32 s22, s20, 1
s_lshl_b32 s29, s20, 12
s_and_b32 s3, s2, 1
s_lshl_b32 s3, s3, 2
s_bfe_u32 s6, s2, 0x20003
s_add_u32 s3, s3, s6
s_lshl_b32 s52, s3, 8
s_bfe_u32 s3, s2, 0x20001
s_lshl_b32 s3, s3, 2
s_bfe_u32 s7, s2, 0x20005
s_add_u32 s3, s3, s7
s_lshl_b32 s53, s3, 8
s_cmp_lt_u32 s2, 128
s_cselect_b32 s5, 11, 10
s_lshl_b32 s3, s21, 7
s_lshl_b32 s4, s22, 5
s_add_u32 s3, s3, s4
v_lshrrev_b32 v24, 3, v0
v_add_u32 v24, s3, v24
v_and_b32 v25, 7, v0
v_add_u32 v26, 0, v24
v_bfe_u32 v27, v26, 1, 3
v_xor_b32 v27, v27, v25
v_lshlrev_b32 v26, s5, v26
v_lshl_add_u32 v26, v27, 4, v26
v_subrev_u32 v2, 0, v26
v_add_u32 v26, 8, v24
v_bfe_u32 v27, v26, 1, 3
v_xor_b32 v27, v27, v25
v_lshlrev_b32 v26, s5, v26
v_lshl_add_u32 v26, v27, 4, v26
v_subrev_u32 v3, 1024, v26
v_add_u32 v26, 16, v24
v_bfe_u32 v27, v26, 1, 3
v_xor_b32 v27, v27, v25
v_lshlrev_b32 v26, s5, v26
v_lshl_add_u32 v26, v27, 4, v26
v_subrev_u32 v4, 2048, v26
v_add_u32 v26, 24, v24
v_bfe_u32 v27, v26, 1, 3
v_xor_b32 v27, v27, v25
v_lshlrev_b32 v26, s5, v26
v_lshl_add_u32 v26, v27, 4, v26
v_subrev_u32 v5, 3072, v26
s_lshl_b32 s3, s20, 3
v_lshrrev_b32 v24, 5, v0
v_add_u32 v24, s3, v24
v_and_b32 v25, 31, v0
v_add_u32 v26, 0, v24
v_and_b32 v27, 3, v26
v_lshlrev_b32 v27, 1, v27
v_and_or_b32 v27, v26, 8, v27
v_xor_b32 v27, v27, v25
v_lshlrev_b32 v26, 13, v26
v_lshl_add_u32 v26, v27, 4, v26
v_subrev_u32 v6, 0, v26
v_add_u32 v26, 2, v24
v_and_b32 v27, 3, v26
v_lshlrev_b32 v27, 1, v27
v_and_or_b32 v27, v26, 8, v27
v_xor_b32 v27, v27, v25
v_lshlrev_b32 v26, 13, v26
v_lshl_add_u32 v26, v27, 4, v26
v_subrev_u32 v7, 1024, v26
v_add_u32 v26, 4, v24
v_and_b32 v27, 3, v26
v_lshlrev_b32 v27, 1, v27
v_and_or_b32 v27, v26, 8, v27
v_xor_b32 v27, v27, v25
v_lshlrev_b32 v26, 13, v26
v_lshl_add_u32 v26, v27, 4, v26
v_subrev_u32 v8, 2048, v26
v_add_u32 v26, 6, v24
v_and_b32 v27, 3, v26
v_lshlrev_b32 v27, 1, v27
v_and_or_b32 v27, v26, 8, v27
v_xor_b32 v27, v27, v25
v_lshlrev_b32 v26, 13, v26
v_lshl_add_u32 v26, v27, 4, v26
v_subrev_u32 v9, 3072, v26
s_lshl_b32 s23, s52, s5
s_lshl_b32 s31, 64, s5
s_mov_b32 s26, s23
s_lshl_b32 s24, s53, 1
s_mov_b32 s28, s24
s_lshl_b32 s3, 1, s5
s_add_u32 s25, s23, s3
s_lshl_b32 s3, s3, 12
s_add_u32 s27, s24, s3
s_bfe_u32 s3, s2, 0x20001
s_and_b32 s4, s2, 1
s_lshl_b32 s4, s4, 1
s_add_u32 s3, s3, s4
s_and_b32 s3, s3, 3
s_sub_u32 s4, s5, 2
s_lshl_b32 s3, s3, s4
s_add_u32 s23, s23, s3
s_lshl_b32 s3, s3, 12
s_add_u32 s24, s24, s3
s_mov_b32 s95, s6
s_cmp_lt_u32 s2, 128
s_cselect_b32 s6, -1, 8
s_waitcnt lgkmcnt(0)
s_cmp_lt_u32 s2, 128
s_cselect_b64 s[8:9], s[32:33], s[34:35]
s_mov_b32 s10, 2097152
s_cselect_b32 s10, 4194304, s10
s_mov_b32 s11, 0x00020000
s_cselect_b64 s[12:13], s[36:37], s[38:39]
s_mov_b32 s14, 4194304
s_cselect_b32 s14, 8388608, s14
s_mov_b32 s15, 0x00020000
s_mov_b64 s[64:65], s[40:41]
s_add_u32 m0, s29, 65536
s_nop 0
buffer_load_dwordx4 v6, s[12:15], s24 offen offset:0 lds
buffer_load_dwordx4 v7, s[12:15], s24 offen offset:1024 lds
buffer_load_dwordx4 v8, s[12:15], s24 offen offset:2048 lds
buffer_load_dwordx4 v9, s[12:15], s24 offen offset:3072 lds
s_add_u32 s24, s24, 262144
s_add_u32 m0, s29, 0
s_nop 0
buffer_load_dwordx4 v2, s[8:11], s23 offen offset:0 lds
buffer_load_dwordx4 v3, s[8:11], s23 offen offset:1024 lds
buffer_load_dwordx4 v4, s[8:11], s23 offen offset:2048 lds
buffer_load_dwordx4 v5, s[8:11], s23 offen offset:3072 lds
s_add_u32 m0, s29, 81920
s_nop 0
buffer_load_dwordx4 v6, s[12:15], s24 offen offset:0 lds
buffer_load_dwordx4 v7, s[12:15], s24 offen offset:1024 lds
buffer_load_dwordx4 v8, s[12:15], s24 offen offset:2048 lds
buffer_load_dwordx4 v9, s[12:15], s24 offen offset:3072 lds
s_add_u32 s24, s24, 262144
s_cmp_eq_u32 s24, s27
s_cselect_b32 s24, s28, s24
s_sub_u32 s6, s6, 1
s_cmp_eq_u32 s6, 0
s_cselect_b64 s[12:13], s[64:65], s[12:13]
s_add_u32 s16, s50, 109051904
s_addc_u32 s17, s51, 0
s_mov_b32 s18, 16384
s_mov_b32 s19, 0x00020000
v_mov_b32 v24, 0
v_mov_b32 v25, 0
v_mov_b32 v26, 0
v_mov_b32 v27, 0
s_lshl_b32 s3, s2, 2
buffer_store_dword v24, v24, s[16:19], s3 offen sc1
s_and_b32 s3, s2, 7
s_lshr_b32 s4, s2, 6
s_lshl_b32 s4, s4, 3
s_add_u32 s3, s3, s4
s_lshl_b32 s3, s3, 4
s_add_u32 s3, s3, 4096
s_bfe_u32 s4, s2, 0x30003
s_lshl_b32 s4, s4, 9
s_add_u32 s92, s3, s4
s_sub_u32 s4, 7680, s4
s_add_u32 s93, s3, s4
buffer_store_dwordx4 v[24:27], v24, s[16:19], s92 offen sc1
buffer_store_dwordx4 v[24:27], v24, s[16:19], s93 offen sc1
s_and_b32 s3, s2, 1
s_lshl_b32 s3, s3, 3
s_bfe_u32 s4, s2, 0x30003
s_add_u32 s92, s3, s4
s_bfe_u32 s3, s2, 0x20001
s_lshl_b32 s3, s3, 2
s_lshr_b32 s4, s2, 6
s_xor_b32 s4, s4, 2
s_add_u32 s93, s3, s4
s_lshl_b32 s92, s92, 8
s_lshl_b32 s93, s93, 4
s_add_u32 s92, s92, s93
s_add_u32 s92, s92, 12288
buffer_store_dwordx4 v[24:27], v24, s[16:19], s92 offen sc1
v_lshlrev_b32 v20, 7, v0
s_lshl_b32 s54, s2, 13
s_mov_b64 s[60:61], s[40:41]
s_mov_b32 s62, 0
s_cmp_eq_u32 s20, 1
s_cselect_b64 s[60:61], s[46:47], s[60:61]
s_cselect_b32 s62, 6291456, s62
s_cmp_eq_u32 s20, 2
s_cselect_b64 s[60:61], s[44:45], s[60:61]
s_cselect_b32 s62, 4194304, s62
s_cmp_eq_u32 s20, 3
s_cselect_b32 s62, 0, s62
s_mov_b32 s63, 0x00020000
s_mov_b32 s3, 0
s_cmp_eq_u32 s20, 1
s_cselect_b32 s3, 6291456, s3
s_cmp_eq_u32 s20, 2
s_cselect_b32 s3, 6291456, s3
s_sub_u32 s54, s54, s3
Lc0:
s_add_u32 m0, s29, 98304
s_nop 0
buffer_load_dwordx4 v6, s[12:15], s24 offen offset:0 lds
buffer_load_dwordx4 v7, s[12:15], s24 offen offset:1024 lds
buffer_load_dwordx4 v8, s[12:15], s24 offen offset:2048 lds
buffer_load_dwordx4 v9, s[12:15], s24 offen offset:3072 lds
s_add_u32 s24, s24, 262144
s_lshl_b32 s4, s21, 13
v_and_b32 v24, 15, v0
v_lshlrev_b32 v24, 7, v24
v_add_u32 v24, s4, v24
v_bfe_u32 v25, v0, 1, 3
v_lshrrev_b32 v26, 4, v0
v_xor_b32 v25, v25, v26
v_lshl_add_u32 v10, v25, 4, v24
v_xor_b32 v11, 64, v10
v_bfe_u32 v24, v0, 2, 2
v_lshl_add_u32 v29, v26, 3, v24
v_lshlrev_b32 v25, 9, v29
v_and_b32 v27, 1, v0
v_lshl_add_u32 v25, v27, 3, v25
v_add_u32 v25, 65536, v25
v_lshlrev_b32 v24, 1, v24
v_and_or_b32 v24, v29, 8, v24
v_bfe_u32 v26, v0, 1, 1
s_lshl_b32 s4, s22, 4
s_add_u32 s3, s4, 0
v_add_u32 v27, s3, v26
v_xor_b32 v27, v27, v24
v_lshl_add_u32 v12, v27, 4, v25
s_add_u32 s3, s4, 2
v_add_u32 v27, s3, v26
v_xor_b32 v27, v27, v24
v_lshl_add_u32 v13, v27, 4, v25
s_add_u32 s3, s4, 4
v_add_u32 v27, s3, v26
v_xor_b32 v27, v27, v24
v_lshl_add_u32 v14, v27, 4, v25
s_add_u32 s3, s4, 6
v_add_u32 v27, s3, v26
v_xor_b32 v27, v27, v24
v_lshl_add_u32 v15, v27, 4, v25
s_add_u32 s3, s4, 8
v_add_u32 v27, s3, v26
v_xor_b32 v27, v27, v24
v_lshl_add_u32 v16, v27, 4, v25
s_add_u32 s3, s4, 10
v_add_u32 v27, s3, v26
v_xor_b32 v27, v27, v24
v_lshl_add_u32 v17, v27, 4, v25
s_add_u32 s3, s4, 12
v_add_u32 v27, s3, v26
v_xor_b32 v27, v27, v24
v_lshl_add_u32 v18, v27, 4, v25
s_add_u32 s3, s4, 14
v_add_u32 v27, s3, v26
v_xor_b32 v27, v27, v24
v_lshl_add_u32 v19, v27, 4, v25
s_waitcnt vmcnt(8)
s_barrier
ds_read_b64_tr_b16 a[32:33], v12 offset:0
ds_read_b64_tr_b16 a[34:35], v12 offset:2048
ds_read_b64_tr_b16 a[40:41], v13 offset:0
ds_read_b64_tr_b16 a[42:43], v13 offset:2048
ds_read_b64_tr_b16 a[48:49], v14 offset:0
ds_read_b64_tr_b16 a[50:51], v14 offset:2048
ds_read_b64_tr_b16 a[56:57], v15 offset:0
ds_read_b64_tr_b16 a[58:59], v15 offset:2048
ds_read_b64_tr_b16 a[64:65], v16 offset:0
ds_read_b64_tr_b16 a[66:67], v16 offset:2048
ds_read_b64_tr_b16 a[72:73], v17 offset:0
ds_read_b64_tr_b16 a[74:75], v17 offset:2048
ds_read_b64_tr_b16 a[80:81], v18 offset:0
ds_read_b64_tr_b16 a[82:83], v18 offset:2048
ds_read_b64_tr_b16 a[88:89], v19 offset:0
ds_read_b64_tr_b16 a[90:91], v19 offset:2048
ds_read_b64_tr_b16 a[36:37], v12 offset:16384
ds_read_b64_tr_b16 a[38:39], v12 offset:18432
ds_read_b64_tr_b16 a[44:45], v13 offset:16384
ds_read_b64_tr_b16 a[46:47], v13 offset:18432
ds_read_b64_tr_b16 a[52:53], v14 offset:16384
ds_read_b64_tr_b16 a[54:55], v14 offset:18432
ds_read_b64_tr_b16 a[60:61], v15 offset:16384
ds_read_b64_tr_b16 a[62:63], v15 offset:18432
ds_read_b64_tr_b16 a[68:69], v16 offset:16384
ds_read_b64_tr_b16 a[70:71], v16 offset:18432
ds_read_b64_tr_b16 a[76:77], v17 offset:16384
ds_read_b64_tr_b16 a[78:79], v17 offset:18432
ds_read_b64_tr_b16 a[84:85], v18 offset:16384
ds_read_b64_tr_b16 a[86:87], v18 offset:18432
ds_read_b64_tr_b16 a[92:93], v19 offset:16384
ds_read_b64_tr_b16 a[94:95], v19 offset:18432
ds_read_b128 a[160:163], v10 offset:0
ds_read_b128 a[164:167], v11 offset:0
ds_read_b128 a[168:171], v10 offset:2048
ds_read_b128 a[172:175], v11 offset:2048
s_add_u32 m0, s29, 16384
s_add_u32 s3, s23, s31
s_nop 0
buffer_load_dwordx4 v2, s[8:11], s3 offen offset:0 lds
buffer_load_dwordx4 v3, s[8:11], s3 offen offset:1024 lds
buffer_load_dwordx4 v4, s[8:11], s3 offen offset:2048 lds
buffer_load_dwordx4 v5, s[8:11], s3 offen offset:3072 lds
s_add_u32 s23, s23, 128
s_cmp_eq_u32 s23, s25
s_cselect_b32 s23, s26, s23
s_add_u32 m0, s29, 114688
s_nop 0
buffer_load_dwordx4 v6, s[12:15], s24 offen offset:0 lds
buffer_load_dwordx4 v7, s[12:15], s24 offen offset:1024 lds
buffer_load_dwordx4 v8, s[12:15], s24 offen offset:2048 lds
buffer_load_dwordx4 v9, s[12:15], s24 offen offset:3072 lds
s_add_u32 s24, s24, 262144
s_cmp_eq_u32 s24, s27
s_cselect_b32 s24, s28, s24
s_sub_u32 s6, s6, 1
s_cmp_eq_u32 s6, 0
s_cselect_b64 s[12:13], s[64:65], s[12:13]
s_waitcnt vmcnt(8) lgkmcnt(0)
s_barrier
s_getpc_b64 s[92:93]
Lpc_1:
s_add_u32 s92, s92, Lc1-Lpc_1
s_addc_u32 s93, s93, 0
s_lshr_b32 s94, s2, 3
s_mul_i32 s94, s94, ((Lc3-Lc1)/32+127)&~127
v_lshlrev_b32 v24, 7, v0
v_add_u32 v24, s94, v24
v_min_u32 v24, Lc3-Lc1-4, v24
global_load_dword v21, v24, s[92:93]
Lc1:
s_cmp_lt_u32 s2, 128
s_cbranch_scc0 Lk1_kv
M v[32:35], a[32:35], a[160:163], 0
s_add_u32 m0, s29, 32768
s_nop 0
buffer_load_dwordx4 v2, s[8:11], s23 offen offset:0 lds
M v[32:35], a[36:39], a[164:167], v[32:35]
ds_read_b128 a[176:179], v10 offset:4096
ds_read_b128 a[180:183], v11 offset:4096
M v[36:39], a[44:47], a[164:167], 0
M v[36:39], a[40:43], a[160:163], v[36:39]
ds_read_b64_tr_b16 a[96:97], v12 offset:32768
ds_read_b64_tr_b16 a[98:99], v12 offset:34816
M v[40:43], a[48:51], a[160:163], 0
M v[40:43], a[52:55], a[164:167], v[40:43]
buffer_load_dwordx4 v3, s[8:11], s23 offen offset:1024 lds
M v[44:47], a[60:63], a[164:167], 0
M v[44:47], a[56:59], a[160:163], v[44:47]
ds_read_b64_tr_b16 a[104:105], v13 offset:32768
ds_read_b64_tr_b16 a[106:107], v13 offset:34816
M v[48:51], a[64:67], a[160:163], 0
M v[48:51], a[68:71], a[164:167], v[48:51]
buffer_load_dwordx4 v4, s[8:11], s23 offen offset:2048 lds
M v[52:55], a[76:79], a[164:167], 0
M v[52:55], a[72:75], a[160:163], v[52:55]
ds_read_b64_tr_b16 a[112:113], v14 offset:32768
ds_read_b64_tr_b16 a[114:115], v14 offset:34816
M v[56:59], a[80:83], a[160:163], 0
M v[56:59], a[84:87], a[164:167], v[56:59]
buffer_load_dwordx4 v5, s[8:11], s23 offen offset:3072 lds
M v[60:63], a[92:95], a[164:167], 0
M v[60:63], a[88:91], a[160:163], v[60:63]
ds_read_b64_tr_b16 a[120:121], v15 offset:32768
ds_read_b64_tr_b16 a[122:123], v15 offset:34816
M v[64:67], a[32:35], a[168:171], 0
M v[64:67], a[36:39], a[172:175], v[64:67]
ds_read_b128 a[184:187], v10 offset:6144
ds_read_b128 a[188:191], v11 offset:6144
M v[68:71], a[44:47], a[172:175], 0
s_add_u32 m0, s29, 65536
s_nop 0
buffer_load_dwordx4 v6, s[12:15], s24 offen offset:0 lds
M v[68:71], a[40:43], a[168:171], v[68:71]
ds_read_b64_tr_b16 a[128:129], v16 offset:32768
ds_read_b64_tr_b16 a[130:131], v16 offset:34816
M v[72:75], a[48:51], a[168:171], 0
M v[72:75], a[52:55], a[172:175], v[72:75]
M v[76:79], a[60:63], a[172:175], 0
buffer_load_dwordx4 v7, s[12:15], s24 offen offset:1024 lds
M v[76:79], a[56:59], a[168:171], v[76:79]
ds_read_b64_tr_b16 a[136:137], v17 offset:32768
ds_read_b64_tr_b16 a[138:139], v17 offset:34816
M v[80:83], a[64:67], a[168:171], 0
M v[80:83], a[68:71], a[172:175], v[80:83]
M v[84:87], a[76:79], a[172:175], 0
buffer_load_dwordx4 v8, s[12:15], s24 offen offset:2048 lds
M v[84:87], a[72:75], a[168:171], v[84:87]
ds_read_b64_tr_b16 a[144:145], v18 offset:32768
ds_read_b64_tr_b16 a[146:147], v18 offset:34816
M v[88:91], a[80:83], a[168:171], 0
M v[88:91], a[84:87], a[172:175], v[88:91]
M v[92:95], a[92:95], a[172:175], 0
buffer_load_dwordx4 v9, s[12:15], s24 offen offset:3072 lds
M v[92:95], a[88:91], a[168:171], v[92:95]
s_waitcnt lgkmcnt(15)
ds_read_b64_tr_b16 a[152:153], v19 offset:32768
ds_read_b64_tr_b16 a[154:155], v19 offset:34816
M v[96:99], a[32:35], a[176:179], 0
M v[96:99], a[36:39], a[180:183], v[96:99]
M v[100:103], a[44:47], a[180:183], 0
s_add_u32 s24, s24, 262144
M v[100:103], a[40:43], a[176:179], v[100:103]
M v[104:107], a[48:51], a[176:179], 0
M v[104:107], a[52:55], a[180:183], v[104:107]
M v[108:111], a[60:63], a[180:183], 0
M v[108:111], a[56:59], a[176:179], v[108:111]
s_waitcnt vmcnt(9) lgkmcnt(0)
s_barrier
ds_read_b128 a[160:163], v10 offset:16384
ds_read_b128 a[164:167], v11 offset:16384
M v[112:115], a[64:67], a[176:179], 0
s_add_u32 m0, s29, 49152
s_add_u32 s3, s23, s31
buffer_load_dwordx4 v2, s[8:11], s3 offen offset:0 lds
M v[112:115], a[68:71], a[180:183], v[112:115]
M v[116:119], a[76:79], a[180:183], 0
M v[116:119], a[72:75], a[176:179], v[116:119]
ds_read_b64_tr_b16 a[100:101], v12 offset:49152
ds_read_b64_tr_b16 a[102:103], v12 offset:51200
M v[120:123], a[80:83], a[176:179], 0
M v[120:123], a[84:87], a[180:183], v[120:123]
buffer_load_dwordx4 v3, s[8:11], s3 offen offset:1024 lds
M v[124:127], a[92:95], a[180:183], 0
M v[124:127], a[88:91], a[176:179], v[124:127]
M v[128:131], a[32:35], a[184:187], 0
M v[128:131], a[36:39], a[188:191], v[128:131]
ds_read_b128 a[168:171], v10 offset:18432
ds_read_b128 a[172:175], v11 offset:18432
ds_read_b64_tr_b16 a[108:109], v13 offset:49152
ds_read_b64_tr_b16 a[110:111], v13 offset:51200
M v[132:135], a[44:47], a[188:191], 0
M v[132:135], a[40:43], a[184:187], v[132:135]
buffer_load_dwordx4 v4, s[8:11], s3 offen offset:2048 lds
M v[136:139], a[48:51], a[184:187], 0
M v[136:139], a[52:55], a[188:191], v[136:139]
M v[140:143], a[60:63], a[188:191], 0
M v[140:143], a[56:59], a[184:187], v[140:143]
ds_read_b64_tr_b16 a[116:117], v14 offset:49152
ds_read_b64_tr_b16 a[118:119], v14 offset:51200
M v[144:147], a[64:67], a[184:187], 0
M v[144:147], a[68:71], a[188:191], v[144:147]
buffer_load_dwordx4 v5, s[8:11], s3 offen offset:3072 lds
M v[148:151], a[76:79], a[188:191], 0
M v[148:151], a[72:75], a[184:187], v[148:151]
M v[152:155], a[80:83], a[184:187], 0
M v[152:155], a[84:87], a[188:191], v[152:155]
ds_read_b64_tr_b16 a[124:125], v15 offset:49152
ds_read_b64_tr_b16 a[126:127], v15 offset:51200
M v[156:159], a[92:95], a[188:191], 0
s_add_u32 s23, s23, 128
s_cmp_eq_u32 s23, s25
s_cselect_b32 s23, s26, s23
M v[156:159], a[88:91], a[184:187], v[156:159]
s_waitcnt lgkmcnt(10)
M v[160:163], a[32:35], a[160:163], 0
M v[160:163], a[36:39], a[164:167], v[160:163]
ds_read_b128 a[176:179], v10 offset:20480
ds_read_b128 a[180:183], v11 offset:20480
M v[164:167], a[44:47], a[164:167], 0
M v[164:167], a[40:43], a[160:163], v[164:167]
ds_read_b64_tr_b16 a[132:133], v16 offset:49152
ds_read_b64_tr_b16 a[134:135], v16 offset:51200
M v[168:171], a[48:51], a[160:163], 0
M v[168:171], a[52:55], a[164:167], v[168:171]
s_add_u32 m0, s29, 81920
s_nop 0
buffer_load_dwordx4 v6, s[12:15], s24 offen offset:0 lds
M v[172:175], a[60:63], a[164:167], 0
M v[172:175], a[56:59], a[160:163], v[172:175]
M v[176:179], a[64:67], a[160:163], 0
M v[176:179], a[68:71], a[164:167], v[176:179]
ds_read_b64_tr_b16 a[140:141], v17 offset:49152
ds_read_b64_tr_b16 a[142:143], v17 offset:51200
M v[180:183], a[76:79], a[164:167], 0
M v[180:183], a[72:75], a[160:163], v[180:183]
buffer_load_dwordx4 v7, s[12:15], s24 offen offset:1024 lds
M v[184:187], a[80:83], a[160:163], 0
M v[184:187], a[84:87], a[164:167], v[184:187]
M v[188:191], a[92:95], a[164:167], 0
M v[188:191], a[88:91], a[160:163], v[188:191]
s_waitcnt lgkmcnt(12)
ds_read_b64_tr_b16 a[148:149], v18 offset:49152
ds_read_b64_tr_b16 a[150:151], v18 offset:51200
M v[192:195], a[32:35], a[168:171], 0
buffer_load_dwordx4 v8, s[12:15], s24 offen offset:2048 lds
M v[192:195], a[36:39], a[172:175], v[192:195]
ds_read_b128 a[184:187], v10 offset:22528
ds_read_b128 a[188:191], v11 offset:22528
M v[196:199], a[44:47], a[172:175], 0
M v[196:199], a[40:43], a[168:171], v[196:199]
M v[200:203], a[48:51], a[168:171], 0
M v[200:203], a[52:55], a[172:175], v[200:203]
ds_read_b64_tr_b16 a[156:157], v19 offset:49152
ds_read_b64_tr_b16 a[158:159], v19 offset:51200
M v[204:207], a[60:63], a[172:175], 0
buffer_load_dwordx4 v9, s[12:15], s24 offen offset:3072 lds
M v[204:207], a[56:59], a[168:171], v[204:207]
M v[208:211], a[64:67], a[168:171], 0
M v[208:211], a[68:71], a[172:175], v[208:211]
M v[212:215], a[76:79], a[172:175], 0
M v[212:215], a[72:75], a[168:171], v[212:215]
s_add_u32 s24, s24, 262144
s_cmp_eq_u32 s24, s27
s_cselect_b32 s24, s28, s24
s_sub_u32 s6, s6, 1
s_cmp_eq_u32 s6, 0
s_cselect_b64 s[12:13], s[64:65], s[12:13]
M v[216:219], a[80:83], a[168:171], 0
M v[216:219], a[84:87], a[172:175], v[216:219]
M v[220:223], a[92:95], a[172:175], 0
M v[220:223], a[88:91], a[168:171], v[220:223]
s_waitcnt lgkmcnt(10)
M v[224:227], a[32:35], a[176:179], 0
buffer_load_dword v21, v20, s[60:63], s54 offen
s_add_u32 s54, s54, 1048576
M v[224:227], a[36:39], a[180:183], v[224:227]
M v[228:231], a[44:47], a[180:183], 0
M v[228:231], a[40:43], a[176:179], v[228:231]
M v[232:235], a[48:51], a[176:179], 0
M v[232:235], a[52:55], a[180:183], v[232:235]
M v[236:239], a[60:63], a[180:183], 0
M v[236:239], a[56:59], a[176:179], v[236:239]
s_waitcnt vmcnt(9) lgkmcnt(0)
s_barrier
ds_read_b128 a[160:163], v10 offset:32768
ds_read_b128 a[164:167], v11 offset:32768
M v[240:243], a[64:67], a[176:179], 0
s_add_u32 m0, s29, 0
s_nop 0
buffer_load_dwordx4 v2, s[8:11], s23 offen offset:0 lds
M v[240:243], a[68:71], a[180:183], v[240:243]
M v[244:247], a[76:79], a[180:183], 0
M v[244:247], a[72:75], a[176:179], v[244:247]
M v[248:251], a[80:83], a[176:179], 0
M v[248:251], a[84:87], a[180:183], v[248:251]
buffer_load_dwordx4 v3, s[8:11], s23 offen offset:1024 lds
M v[252:255], a[92:95], a[180:183], 0
M v[252:255], a[88:91], a[176:179], v[252:255]
M a[0:3], a[32:35], a[184:187], 0
M a[0:3], a[36:39], a[188:191], a[0:3]
ds_read_b128 a[168:171], v10 offset:34816
ds_read_b128 a[172:175], v11 offset:34816
M a[4:7], a[44:47], a[188:191], 0
M a[4:7], a[40:43], a[184:187], a[4:7]
M a[8:11], a[48:51], a[184:187], 0
buffer_load_dwordx4 v4, s[8:11], s23 offen offset:2048 lds
M a[8:11], a[52:55], a[188:191], a[8:11]
M a[12:15], a[60:63], a[188:191], 0
M a[12:15], a[56:59], a[184:187], a[12:15]
M a[16:19], a[64:67], a[184:187], 0
M a[16:19], a[68:71], a[188:191], a[16:19]
buffer_load_dwordx4 v5, s[8:11], s23 offen offset:3072 lds
M a[20:23], a[76:79], a[188:191], 0
M a[20:23], a[72:75], a[184:187], a[20:23]
M a[24:27], a[80:83], a[184:187], 0
M a[24:27], a[84:87], a[188:191], a[24:27]
M a[28:31], a[92:95], a[188:191], 0
M a[28:31], a[88:91], a[184:187], a[28:31]
s_waitcnt lgkmcnt(2)
M v[32:35], a[96:99], a[160:163], v[32:35]
s_add_u32 m0, s29, 98304
s_nop 0
buffer_load_dwordx4 v6, s[12:15], s24 offen offset:0 lds
M v[32:35], a[100:103], a[164:167], v[32:35]
ds_read_b128 a[176:179], v10 offset:36864
ds_read_b128 a[180:183], v11 offset:36864
M v[36:39], a[108:111], a[164:167], v[36:39]
M v[36:39], a[104:107], a[160:163], v[36:39]
ds_read_b64_tr_b16 a[32:33], v12 offset:0
ds_read_b64_tr_b16 a[34:35], v12 offset:2048
M v[40:43], a[112:115], a[160:163], v[40:43]
M v[40:43], a[116:119], a[164:167], v[40:43]
M v[44:47], a[124:127], a[164:167], v[44:47]
M v[44:47], a[120:123], a[160:163], v[44:47]
ds_read_b64_tr_b16 a[40:41], v13 offset:0
ds_read_b64_tr_b16 a[42:43], v13 offset:2048
M v[48:51], a[128:131], a[160:163], v[48:51]
buffer_load_dwordx4 v7, s[12:15], s24 offen offset:1024 lds
M v[48:51], a[132:135], a[164:167], v[48:51]
M v[52:55], a[140:143], a[164:167], v[52:55]
M v[52:55], a[136:139], a[160:163], v[52:55]
ds_read_b64_tr_b16 a[48:49], v14 offset:0
ds_read_b64_tr_b16 a[50:51], v14 offset:2048
M v[56:59], a[144:147], a[160:163], v[56:59]
M v[56:59], a[148:151], a[164:167], v[56:59]
M v[60:63], a[156:159], a[164:167], v[60:63]
buffer_load_dwordx4 v8, s[12:15], s24 offen offset:2048 lds
M v[60:63], a[152:155], a[160:163], v[60:63]
s_waitcnt lgkmcnt(8)
ds_read_b64_tr_b16 a[56:57], v15 offset:0
ds_read_b64_tr_b16 a[58:59], v15 offset:2048
M v[64:67], a[96:99], a[168:171], v[64:67]
M v[64:67], a[100:103], a[172:175], v[64:67]
ds_read_b128 a[184:187], v10 offset:38912
ds_read_b128 a[188:191], v11 offset:38912
M v[68:71], a[108:111], a[172:175], v[68:71]
M v[68:71], a[104:107], a[168:171], v[68:71]
ds_read_b64_tr_b16 a[64:65], v16 offset:0
ds_read_b64_tr_b16 a[66:67], v16 offset:2048
M v[72:75], a[112:115], a[168:171], v[72:75]
M v[72:75], a[116:119], a[172:175], v[72:75]
M v[76:79], a[124:127], a[172:175], v[76:79]
M v[76:79], a[120:123], a[168:171], v[76:79]
ds_read_b64_tr_b16 a[72:73], v17 offset:0
ds_read_b64_tr_b16 a[74:75], v17 offset:2048
M v[80:83], a[128:131], a[168:171], v[80:83]
buffer_load_dwordx4 v9, s[12:15], s24 offen offset:3072 lds
M v[80:83], a[132:135], a[172:175], v[80:83]
M v[84:87], a[140:143], a[172:175], v[84:87]
M v[84:87], a[136:139], a[168:171], v[84:87]
ds_read_b64_tr_b16 a[80:81], v18 offset:0
ds_read_b64_tr_b16 a[82:83], v18 offset:2048
M v[88:91], a[144:147], a[168:171], v[88:91]
M v[88:91], a[148:151], a[172:175], v[88:91]
M v[92:95], a[156:159], a[172:175], v[92:95]
s_add_u32 s24, s24, 262144
M v[92:95], a[152:155], a[168:171], v[92:95]
s_waitcnt lgkmcnt(15)
ds_read_b64_tr_b16 a[88:89], v19 offset:0
ds_read_b64_tr_b16 a[90:91], v19 offset:2048
M v[96:99], a[96:99], a[176:179], v[96:99]
M v[96:99], a[100:103], a[180:183], v[96:99]
M v[100:103], a[108:111], a[180:183], v[100:103]
M v[100:103], a[104:107], a[176:179], v[100:103]
M v[104:107], a[112:115], a[176:179], v[104:107]
M v[104:107], a[116:119], a[180:183], v[104:107]
M v[108:111], a[124:127], a[180:183], v[108:111]
M v[108:111], a[120:123], a[176:179], v[108:111]
s_waitcnt vmcnt(9) lgkmcnt(0)
s_barrier
ds_read_b128 a[160:163], v10 offset:49152
ds_read_b128 a[164:167], v11 offset:49152
M v[112:115], a[128:131], a[176:179], v[112:115]
s_add_u32 m0, s29, 16384
s_add_u32 s3, s23, s31
buffer_load_dwordx4 v2, s[8:11], s3 offen offset:0 lds
M v[112:115], a[132:135], a[180:183], v[112:115]
M v[116:119], a[140:143], a[180:183], v[116:119]
M v[116:119], a[136:139], a[176:179], v[116:119]
ds_read_b64_tr_b16 a[36:37], v12 offset:16384
ds_read_b64_tr_b16 a[38:39], v12 offset:18432
M v[120:123], a[144:147], a[176:179], v[120:123]
M v[120:123], a[148:151], a[180:183], v[120:123]
buffer_load_dwordx4 v3, s[8:11], s3 offen offset:1024 lds
M v[124:127], a[156:159], a[180:183], v[124:127]
M v[124:127], a[152:155], a[176:179], v[124:127]
M v[128:131], a[96:99], a[184:187], v[128:131]
M v[128:131], a[100:103], a[188:191], v[128:131]
ds_read_b128 a[168:171], v10 offset:51200
ds_read_b128 a[172:175], v11 offset:51200
ds_read_b64_tr_b16 a[44:45], v13 offset:16384
ds_read_b64_tr_b16 a[46:47], v13 offset:18432
M v[132:135], a[108:111], a[188:191], v[132:135]
M v[132:135], a[104:107], a[184:187], v[132:135]
buffer_load_dwordx4 v4, s[8:11], s3 offen offset:2048 lds
M v[136:139], a[112:115], a[184:187], v[136:139]
M v[136:139], a[116:119], a[188:191], v[136:139]
M v[140:143], a[124:127], a[188:191], v[140:143]
M v[140:143], a[120:123], a[184:187], v[140:143]
ds_read_b64_tr_b16 a[52:53], v14 offset:16384
ds_read_b64_tr_b16 a[54:55], v14 offset:18432
M v[144:147], a[128:131], a[184:187], v[144:147]
M v[144:147], a[132:135], a[188:191], v[144:147]
buffer_load_dwordx4 v5, s[8:11], s3 offen offset:3072 lds
M v[148:151], a[140:143], a[188:191], v[148:151]
M v[148:151], a[136:139], a[184:187], v[148:151]
M v[152:155], a[144:147], a[184:187], v[152:155]
M v[152:155], a[148:151], a[188:191], v[152:155]
ds_read_b64_tr_b16 a[60:61], v15 offset:16384
ds_read_b64_tr_b16 a[62:63], v15 offset:18432
M v[156:159], a[156:159], a[188:191], v[156:159]
s_add_u32 s23, s23, 128
s_cmp_eq_u32 s23, s25
s_cselect_b32 s23, s26, s23
M v[156:159], a[152:155], a[184:187], v[156:159]
s_waitcnt lgkmcnt(10)
M v[160:163], a[96:99], a[160:163], v[160:163]
M v[160:163], a[100:103], a[164:167], v[160:163]
ds_read_b128 a[176:179], v10 offset:53248
ds_read_b128 a[180:183], v11 offset:53248
M v[164:167], a[108:111], a[164:167], v[164:167]
M v[164:167], a[104:107], a[160:163], v[164:167]
ds_read_b64_tr_b16 a[68:69], v16 offset:16384
ds_read_b64_tr_b16 a[70:71], v16 offset:18432
M v[168:171], a[112:115], a[160:163], v[168:171]
M v[168:171], a[116:119], a[164:167], v[168:171]
s_add_u32 m0, s29, 114688
s_nop 0
buffer_load_dwordx4 v6, s[12:15], s24 offen offset:0 lds
M v[172:175], a[124:127], a[164:167], v[172:175]
M v[172:175], a[120:123], a[160:163], v[172:175]
M v[176:179], a[128:131], a[160:163], v[176:179]
M v[176:179], a[132:135], a[164:167], v[176:179]
ds_read_b64_tr_b16 a[76:77], v17 offset:16384
ds_read_b64_tr_b16 a[78:79], v17 offset:18432
M v[180:183], a[140:143], a[164:167], v[180:183]
M v[180:183], a[136:139], a[160:163], v[180:183]
buffer_load_dwordx4 v7, s[12:15], s24 offen offset:1024 lds
M v[184:187], a[144:147], a[160:163], v[184:187]
M v[184:187], a[148:151], a[164:167], v[184:187]
M v[188:191], a[156:159], a[164:167], v[188:191]
M v[188:191], a[152:155], a[160:163], v[188:191]
s_waitcnt lgkmcnt(12)
ds_read_b64_tr_b16 a[84:85], v18 offset:16384
ds_read_b64_tr_b16 a[86:87], v18 offset:18432
M v[192:195], a[96:99], a[168:171], v[192:195]
buffer_load_dwordx4 v8, s[12:15], s24 offen offset:2048 lds
M v[192:195], a[100:103], a[172:175], v[192:195]
ds_read_b128 a[184:187], v10 offset:55296
ds_read_b128 a[188:191], v11 offset:55296
M v[196:199], a[108:111], a[172:175], v[196:199]
M v[196:199], a[104:107], a[168:171], v[196:199]
M v[200:203], a[112:115], a[168:171], v[200:203]
M v[200:203], a[116:119], a[172:175], v[200:203]
ds_read_b64_tr_b16 a[92:93], v19 offset:16384
ds_read_b64_tr_b16 a[94:95], v19 offset:18432
M v[204:207], a[124:127], a[172:175], v[204:207]
buffer_load_dwordx4 v9, s[12:15], s24 offen offset:3072 lds
M v[204:207], a[120:123], a[168:171], v[204:207]
M v[208:211], a[128:131], a[168:171], v[208:211]
M v[208:211], a[132:135], a[172:175], v[208:211]
M v[212:215], a[140:143], a[172:175], v[212:215]
M v[212:215], a[136:139], a[168:171], v[212:215]
s_add_u32 s24, s24, 262144
s_cmp_eq_u32 s24, s27
s_cselect_b32 s24, s28, s24
s_sub_u32 s6, s6, 1
s_cmp_eq_u32 s6, 0
s_cselect_b64 s[12:13], s[64:65], s[12:13]
M v[216:219], a[144:147], a[168:171], v[216:219]
M v[216:219], a[148:151], a[172:175], v[216:219]
M v[220:223], a[156:159], a[172:175], v[220:223]
M v[220:223], a[152:155], a[168:171], v[220:223]
s_waitcnt lgkmcnt(10)
M v[224:227], a[96:99], a[176:179], v[224:227]
buffer_load_dword v21, v20, s[60:63], s54 offen
s_add_u32 s54, s54, 1048576
M v[224:227], a[100:103], a[180:183], v[224:227]
M v[228:231], a[108:111], a[180:183], v[228:231]
M v[228:231], a[104:107], a[176:179], v[228:231]
M v[232:235], a[112:115], a[176:179], v[232:235]
M v[232:235], a[116:119], a[180:183], v[232:235]
M v[236:239], a[124:127], a[180:183], v[236:239]
M v[236:239], a[120:123], a[176:179], v[236:239]
s_waitcnt vmcnt(9) lgkmcnt(0)
s_barrier
ds_read_b128 a[160:163], v10 offset:0
ds_read_b128 a[164:167], v11 offset:0
M v[240:243], a[128:131], a[176:179], v[240:243]
s_add_u32 m0, s29, 32768
s_nop 0
buffer_load_dwordx4 v2, s[8:11], s23 offen offset:0 lds
M v[240:243], a[132:135], a[180:183], v[240:243]
M v[244:247], a[140:143], a[180:183], v[244:247]
M v[244:247], a[136:139], a[176:179], v[244:247]
M v[248:251], a[144:147], a[176:179], v[248:251]
M v[248:251], a[148:151], a[180:183], v[248:251]
buffer_load_dwordx4 v3, s[8:11], s23 offen offset:1024 lds
M v[252:255], a[156:159], a[180:183], v[252:255]
M v[252:255], a[152:155], a[176:179], v[252:255]
M a[0:3], a[96:99], a[184:187], a[0:3]
M a[0:3], a[100:103], a[188:191], a[0:3]
ds_read_b128 a[168:171], v10 offset:2048
ds_read_b128 a[172:175], v11 offset:2048
M a[4:7], a[108:111], a[188:191], a[4:7]
M a[4:7], a[104:107], a[184:187], a[4:7]
M a[8:11], a[112:115], a[184:187], a[8:11]
buffer_load_dwordx4 v4, s[8:11], s23 offen offset:2048 lds
M a[8:11], a[116:119], a[188:191], a[8:11]
M a[12:15], a[124:127], a[188:191], a[12:15]
M a[12:15], a[120:123], a[184:187], a[12:15]
M a[16:19], a[128:131], a[184:187], a[16:19]
M a[16:19], a[132:135], a[188:191], a[16:19]
buffer_load_dwordx4 v5, s[8:11], s23 offen offset:3072 lds
M a[20:23], a[140:143], a[188:191], a[20:23]
M a[20:23], a[136:139], a[184:187], a[20:23]
M a[24:27], a[144:147], a[184:187], a[24:27]
M a[24:27], a[148:151], a[188:191], a[24:27]
M a[28:31], a[156:159], a[188:191], a[28:31]
M a[28:31], a[152:155], a[184:187], a[28:31]
s_waitcnt lgkmcnt(2)
s_mov_b32 s30, 5
Lk1_ql:
M v[32:35], a[32:35], a[160:163], v[32:35]
s_add_u32 m0, s29, 65536
s_nop 0
buffer_load_dwordx4 v6, s[12:15], s24 offen offset:0 lds
M v[32:35], a[36:39], a[164:167], v[32:35]
ds_read_b128 a[176:179], v10 offset:4096
ds_read_b128 a[180:183], v11 offset:4096
M v[36:39], a[44:47], a[164:167], v[36:39]
M v[36:39], a[40:43], a[160:163], v[36:39]
ds_read_b64_tr_b16 a[96:97], v12 offset:32768
ds_read_b64_tr_b16 a[98:99], v12 offset:34816
M v[40:43], a[48:51], a[160:163], v[40:43]
M v[40:43], a[52:55], a[164:167], v[40:43]
M v[44:47], a[60:63], a[164:167], v[44:47]
M v[44:47], a[56:59], a[160:163], v[44:47]
ds_read_b64_tr_b16 a[104:105], v13 offset:32768
ds_read_b64_tr_b16 a[106:107], v13 offset:34816
M v[48:51], a[64:67], a[160:163], v[48:51]
buffer_load_dwordx4 v7, s[12:15], s24 offen offset:1024 lds
M v[48:51], a[68:71], a[164:167], v[48:51]
M v[52:55], a[76:79], a[164:167], v[52:55]
M v[52:55], a[72:75], a[160:163], v[52:55]
ds_read_b64_tr_b16 a[112:113], v14 offset:32768
ds_read_b64_tr_b16 a[114:115], v14 offset:34816
M v[56:59], a[80:83], a[160:163], v[56:59]
M v[56:59], a[84:87], a[164:167], v[56:59]
M v[60:63], a[92:95], a[164:167], v[60:63]
buffer_load_dwordx4 v8, s[12:15], s24 offen offset:2048 lds
M v[60:63], a[88:91], a[160:163], v[60:63]
s_waitcnt lgkmcnt(8)
ds_read_b64_tr_b16 a[120:121], v15 offset:32768
ds_read_b64_tr_b16 a[122:123], v15 offset:34816
M v[64:67], a[32:35], a[168:171], v[64:67]
M v[64:67], a[36:39], a[172:175], v[64:67]
ds_read_b128 a[184:187], v10 offset:6144
ds_read_b128 a[188:191], v11 offset:6144
M v[68:71], a[44:47], a[172:175], v[68:71]
M v[68:71], a[40:43], a[168:171], v[68:71]
ds_read_b64_tr_b16 a[128:129], v16 offset:32768
ds_read_b64_tr_b16 a[130:131], v16 offset:34816
M v[72:75], a[48:51], a[168:171], v[72:75]
M v[72:75], a[52:55], a[172:175], v[72:75]
M v[76:79], a[60:63], a[172:175], v[76:79]
M v[76:79], a[56:59], a[168:171], v[76:79]
ds_read_b64_tr_b16 a[136:137], v17 offset:32768
ds_read_b64_tr_b16 a[138:139], v17 offset:34816
M v[80:83], a[64:67], a[168:171], v[80:83]
buffer_load_dwordx4 v9, s[12:15], s24 offen offset:3072 lds
M v[80:83], a[68:71], a[172:175], v[80:83]
M v[84:87], a[76:79], a[172:175], v[84:87]
M v[84:87], a[72:75], a[168:171], v[84:87]
ds_read_b64_tr_b16 a[144:145], v18 offset:32768
ds_read_b64_tr_b16 a[146:147], v18 offset:34816
M v[88:91], a[80:83], a[168:171], v[88:91]
M v[88:91], a[84:87], a[172:175], v[88:91]
M v[92:95], a[92:95], a[172:175], v[92:95]
s_add_u32 s24, s24, 262144
M v[92:95], a[88:91], a[168:171], v[92:95]
s_waitcnt lgkmcnt(15)
ds_read_b64_tr_b16 a[152:153], v19 offset:32768
ds_read_b64_tr_b16 a[154:155], v19 offset:34816
M v[96:99], a[32:35], a[176:179], v[96:99]
M v[96:99], a[36:39], a[180:183], v[96:99]
M v[100:103], a[44:47], a[180:183], v[100:103]
M v[100:103], a[40:43], a[176:179], v[100:103]
M v[104:107], a[48:51], a[176:179], v[104:107]
M v[104:107], a[52:55], a[180:183], v[104:107]
M v[108:111], a[60:63], a[180:183], v[108:111]
M v[108:111], a[56:59], a[176:179], v[108:111]
s_waitcnt vmcnt(9) lgkmcnt(0)
s_barrier
ds_read_b128 a[160:163], v10 offset:16384
ds_read_b128 a[164:167], v11 offset:16384
M v[112:115], a[64:67], a[176:179], v[112:115]
s_add_u32 m0, s29, 49152
s_add_u32 s3, s23, s31
buffer_load_dwordx4 v2, s[8:11], s3 offen offset:0 lds
M v[112:115], a[68:71], a[180:183], v[112:115]
M v[116:119], a[76:79], a[180:183], v[116:119]
M v[116:119], a[72:75], a[176:179], v[116:119]
ds_read_b64_tr_b16 a[100:101], v12 offset:49152
ds_read_b64_tr_b16 a[102:103], v12 offset:51200
M v[120:123], a[80:83], a[176:179], v[120:123]
M v[120:123], a[84:87], a[180:183], v[120:123]
buffer_load_dwordx4 v3, s[8:11], s3 offen offset:1024 lds
M v[124:127], a[92:95], a[180:183], v[124:127]
M v[124:127], a[88:91], a[176:179], v[124:127]
M v[128:131], a[32:35], a[184:187], v[128:131]
M v[128:131], a[36:39], a[188:191], v[128:131]
ds_read_b128 a[168:171], v10 offset:18432
ds_read_b128 a[172:175], v11 offset:18432
ds_read_b64_tr_b16 a[108:109], v13 offset:49152
ds_read_b64_tr_b16 a[110:111], v13 offset:51200
M v[132:135], a[44:47], a[188:191], v[132:135]
M v[132:135], a[40:43], a[184:187], v[132:135]
buffer_load_dwordx4 v4, s[8:11], s3 offen offset:2048 lds
M v[136:139], a[48:51], a[184:187], v[136:139]
M v[136:139], a[52:55], a[188:191], v[136:139]
M v[140:143], a[60:63], a[188:191], v[140:143]
M v[140:143], a[56:59], a[184:187], v[140:143]
ds_read_b64_tr_b16 a[116:117], v14 offset:49152
ds_read_b64_tr_b16 a[118:119], v14 offset:51200
M v[144:147], a[64:67], a[184:187], v[144:147]
M v[144:147], a[68:71], a[188:191], v[144:147]
buffer_load_dwordx4 v5, s[8:11], s3 offen offset:3072 lds
M v[148:151], a[76:79], a[188:191], v[148:151]
M v[148:151], a[72:75], a[184:187], v[148:151]
M v[152:155], a[80:83], a[184:187], v[152:155]
M v[152:155], a[84:87], a[188:191], v[152:155]
ds_read_b64_tr_b16 a[124:125], v15 offset:49152
ds_read_b64_tr_b16 a[126:127], v15 offset:51200
M v[156:159], a[92:95], a[188:191], v[156:159]
s_add_u32 s23, s23, 128
s_cmp_eq_u32 s23, s25
s_cselect_b32 s23, s26, s23
M v[156:159], a[88:91], a[184:187], v[156:159]
s_waitcnt lgkmcnt(10)
M v[160:163], a[32:35], a[160:163], v[160:163]
M v[160:163], a[36:39], a[164:167], v[160:163]
ds_read_b128 a[176:179], v10 offset:20480
ds_read_b128 a[180:183], v11 offset:20480
M v[164:167], a[44:47], a[164:167], v[164:167]
M v[164:167], a[40:43], a[160:163], v[164:167]
ds_read_b64_tr_b16 a[132:133], v16 offset:49152
ds_read_b64_tr_b16 a[134:135], v16 offset:51200
M v[168:171], a[48:51], a[160:163], v[168:171]
M v[168:171], a[52:55], a[164:167], v[168:171]
s_add_u32 m0, s29, 81920
s_nop 0
buffer_load_dwordx4 v6, s[12:15], s24 offen offset:0 lds
M v[172:175], a[60:63], a[164:167], v[172:175]
M v[172:175], a[56:59], a[160:163], v[172:175]
M v[176:179], a[64:67], a[160:163], v[176:179]
M v[176:179], a[68:71], a[164:167], v[176:179]
ds_read_b64_tr_b16 a[140:141], v17 offset:49152
ds_read_b64_tr_b16 a[142:143], v17 offset:51200
M v[180:183], a[76:79], a[164:167], v[180:183]
M v[180:183], a[72:75], a[160:163], v[180:183]
buffer_load_dwordx4 v7, s[12:15], s24 offen offset:1024 lds
M v[184:187], a[80:83], a[160:163], v[184:187]
M v[184:187], a[84:87], a[164:167], v[184:187]
M v[188:191], a[92:95], a[164:167], v[188:191]
M v[188:191], a[88:91], a[160:163], v[188:191]
s_waitcnt lgkmcnt(12)
ds_read_b64_tr_b16 a[148:149], v18 offset:49152
ds_read_b64_tr_b16 a[150:151], v18 offset:51200
M v[192:195], a[32:35], a[168:171], v[192:195]
buffer_load_dwordx4 v8, s[12:15], s24 offen offset:2048 lds
M v[192:195], a[36:39], a[172:175], v[192:195]
ds_read_b128 a[184:187], v10 offset:22528
ds_read_b128 a[188:191], v11 offset:22528
M v[196:199], a[44:47], a[172:175], v[196:199]
M v[196:199], a[40:43], a[168:171], v[196:199]
M v[200:203], a[48:51], a[168:171], v[200:203]
M v[200:203], a[52:55], a[172:175], v[200:203]
ds_read_b64_tr_b16 a[156:157], v19 offset:49152
ds_read_b64_tr_b16 a[158:159], v19 offset:51200
M v[204:207], a[60:63], a[172:175], v[204:207]
buffer_load_dwordx4 v9, s[12:15], s24 offen offset:3072 lds
M v[204:207], a[56:59], a[168:171], v[204:207]
M v[208:211], a[64:67], a[168:171], v[208:211]
M v[208:211], a[68:71], a[172:175], v[208:211]
M v[212:215], a[76:79], a[172:175], v[212:215]
M v[212:215], a[72:75], a[168:171], v[212:215]
s_add_u32 s24, s24, 262144
s_cmp_eq_u32 s24, s27
s_cselect_b32 s24, s28, s24
s_sub_u32 s6, s6, 1
s_cmp_eq_u32 s6, 0
s_cselect_b64 s[12:13], s[64:65], s[12:13]
M v[216:219], a[80:83], a[168:171], v[216:219]
M v[216:219], a[84:87], a[172:175], v[216:219]
M v[220:223], a[92:95], a[172:175], v[220:223]
M v[220:223], a[88:91], a[168:171], v[220:223]
s_waitcnt lgkmcnt(10)
M v[224:227], a[32:35], a[176:179], v[224:227]
buffer_load_dword v21, v20, s[60:63], s54 offen
s_add_u32 s54, s54, 1048576
M v[224:227], a[36:39], a[180:183], v[224:227]
M v[228:231], a[44:47], a[180:183], v[228:231]
M v[228:231], a[40:43], a[176:179], v[228:231]
M v[232:235], a[48:51], a[176:179], v[232:235]
M v[232:235], a[52:55], a[180:183], v[232:235]
M v[236:239], a[60:63], a[180:183], v[236:239]
M v[236:239], a[56:59], a[176:179], v[236:239]
s_waitcnt vmcnt(9) lgkmcnt(0)
s_barrier
ds_read_b128 a[160:163], v10 offset:32768
ds_read_b128 a[164:167], v11 offset:32768
M v[240:243], a[64:67], a[176:179], v[240:243]
s_add_u32 m0, s29, 0
s_nop 0
buffer_load_dwordx4 v2, s[8:11], s23 offen offset:0 lds
M v[240:243], a[68:71], a[180:183], v[240:243]
M v[244:247], a[76:79], a[180:183], v[244:247]
M v[244:247], a[72:75], a[176:179], v[244:247]
M v[248:251], a[80:83], a[176:179], v[248:251]
M v[248:251], a[84:87], a[180:183], v[248:251]
buffer_load_dwordx4 v3, s[8:11], s23 offen offset:1024 lds
M v[252:255], a[92:95], a[180:183], v[252:255]
M v[252:255], a[88:91], a[176:179], v[252:255]
M a[0:3], a[32:35], a[184:187], a[0:3]
M a[0:3], a[36:39], a[188:191], a[0:3]
ds_read_b128 a[168:171], v10 offset:34816
ds_read_b128 a[172:175], v11 offset:34816
M a[4:7], a[44:47], a[188:191], a[4:7]
M a[4:7], a[40:43], a[184:187], a[4:7]
M a[8:11], a[48:51], a[184:187], a[8:11]
buffer_load_dwordx4 v4, s[8:11], s23 offen offset:2048 lds
M a[8:11], a[52:55], a[188:191], a[8:11]
M a[12:15], a[60:63], a[188:191], a[12:15]
M a[12:15], a[56:59], a[184:187], a[12:15]
M a[16:19], a[64:67], a[184:187], a[16:19]
M a[16:19], a[68:71], a[188:191], a[16:19]
buffer_load_dwordx4 v5, s[8:11], s23 offen offset:3072 lds
M a[20:23], a[76:79], a[188:191], a[20:23]
M a[20:23], a[72:75], a[184:187], a[20:23]
M a[24:27], a[80:83], a[184:187], a[24:27]
M a[24:27], a[84:87], a[188:191], a[24:27]
M a[28:31], a[92:95], a[188:191], a[28:31]
M a[28:31], a[88:91], a[184:187], a[28:31]
s_waitcnt lgkmcnt(2)
M v[32:35], a[96:99], a[160:163], v[32:35]
s_add_u32 m0, s29, 98304
s_nop 0
buffer_load_dwordx4 v6, s[12:15], s24 offen offset:0 lds
M v[32:35], a[100:103], a[164:167], v[32:35]
ds_read_b128 a[176:179], v10 offset:36864
ds_read_b128 a[180:183], v11 offset:36864
M v[36:39], a[108:111], a[164:167], v[36:39]
M v[36:39], a[104:107], a[160:163], v[36:39]
ds_read_b64_tr_b16 a[32:33], v12 offset:0
ds_read_b64_tr_b16 a[34:35], v12 offset:2048
M v[40:43], a[112:115], a[160:163], v[40:43]
M v[40:43], a[116:119], a[164:167], v[40:43]
M v[44:47], a[124:127], a[164:167], v[44:47]
M v[44:47], a[120:123], a[160:163], v[44:47]
ds_read_b64_tr_b16 a[40:41], v13 offset:0
ds_read_b64_tr_b16 a[42:43], v13 offset:2048
M v[48:51], a[128:131], a[160:163], v[48:51]
buffer_load_dwordx4 v7, s[12:15], s24 offen offset:1024 lds
M v[48:51], a[132:135], a[164:167], v[48:51]
M v[52:55], a[140:143], a[164:167], v[52:55]
M v[52:55], a[136:139], a[160:163], v[52:55]
ds_read_b64_tr_b16 a[48:49], v14 offset:0
ds_read_b64_tr_b16 a[50:51], v14 offset:2048
M v[56:59], a[144:147], a[160:163], v[56:59]
M v[56:59], a[148:151], a[164:167], v[56:59]
M v[60:63], a[156:159], a[164:167], v[60:63]
buffer_load_dwordx4 v8, s[12:15], s24 offen offset:2048 lds
M v[60:63], a[152:155], a[160:163], v[60:63]
s_waitcnt lgkmcnt(8)
ds_read_b64_tr_b16 a[56:57], v15 offset:0
ds_read_b64_tr_b16 a[58:59], v15 offset:2048
M v[64:67], a[96:99], a[168:171], v[64:67]
M v[64:67], a[100:103], a[172:175], v[64:67]
ds_read_b128 a[184:187], v10 offset:38912
ds_read_b128 a[188:191], v11 offset:38912
M v[68:71], a[108:111], a[172:175], v[68:71]
M v[68:71], a[104:107], a[168:171], v[68:71]
ds_read_b64_tr_b16 a[64:65], v16 offset:0
ds_read_b64_tr_b16 a[66:67], v16 offset:2048
M v[72:75], a[112:115], a[168:171], v[72:75]
M v[72:75], a[116:119], a[172:175], v[72:75]
M v[76:79], a[124:127], a[172:175], v[76:79]
M v[76:79], a[120:123], a[168:171], v[76:79]
ds_read_b64_tr_b16 a[72:73], v17 offset:0
ds_read_b64_tr_b16 a[74:75], v17 offset:2048
M v[80:83], a[128:131], a[168:171], v[80:83]
buffer_load_dwordx4 v9, s[12:15], s24 offen offset:3072 lds
M v[80:83], a[132:135], a[172:175], v[80:83]
M v[84:87], a[140:143], a[172:175], v[84:87]
M v[84:87], a[136:139], a[168:171], v[84:87]
ds_read_b64_tr_b16 a[80:81], v18 offset:0
ds_read_b64_tr_b16 a[82:83], v18 offset:2048
M v[88:91], a[144:147], a[168:171], v[88:91]
M v[88:91], a[148:151], a[172:175], v[88:91]
M v[92:95], a[156:159], a[172:175], v[92:95]
s_add_u32 s24, s24, 262144
M v[92:95], a[152:155], a[168:171], v[92:95]
s_waitcnt lgkmcnt(15)
ds_read_b64_tr_b16 a[88:89], v19 offset:0
ds_read_b64_tr_b16 a[90:91], v19 offset:2048
M v[96:99], a[96:99], a[176:179], v[96:99]
M v[96:99], a[100:103], a[180:183], v[96:99]
M v[100:103], a[108:111], a[180:183], v[100:103]
M v[100:103], a[104:107], a[176:179], v[100:103]
M v[104:107], a[112:115], a[176:179], v[104:107]
M v[104:107], a[116:119], a[180:183], v[104:107]
M v[108:111], a[124:127], a[180:183], v[108:111]
M v[108:111], a[120:123], a[176:179], v[108:111]
s_waitcnt vmcnt(9) lgkmcnt(0)
s_barrier
ds_read_b128 a[160:163], v10 offset:49152
ds_read_b128 a[164:167], v11 offset:49152
M v[112:115], a[128:131], a[176:179], v[112:115]
s_add_u32 m0, s29, 16384
s_add_u32 s3, s23, s31
buffer_load_dwordx4 v2, s[8:11], s3 offen offset:0 lds
M v[112:115], a[132:135], a[180:183], v[112:115]
M v[116:119], a[140:143], a[180:183], v[116:119]
M v[116:119], a[136:139], a[176:179], v[116:119]
ds_read_b64_tr_b16 a[36:37], v12 offset:16384
ds_read_b64_tr_b16 a[38:39], v12 offset:18432
M v[120:123], a[144:147], a[176:179], v[120:123]
M v[120:123], a[148:151], a[180:183], v[120:123]
buffer_load_dwordx4 v3, s[8:11], s3 offen offset:1024 lds
M v[124:127], a[156:159], a[180:183], v[124:127]
M v[124:127], a[152:155], a[176:179], v[124:127]
M v[128:131], a[96:99], a[184:187], v[128:131]
M v[128:131], a[100:103], a[188:191], v[128:131]
ds_read_b128 a[168:171], v10 offset:51200
ds_read_b128 a[172:175], v11 offset:51200
ds_read_b64_tr_b16 a[44:45], v13 offset:16384
ds_read_b64_tr_b16 a[46:47], v13 offset:18432
M v[132:135], a[108:111], a[188:191], v[132:135]
M v[132:135], a[104:107], a[184:187], v[132:135]
buffer_load_dwordx4 v4, s[8:11], s3 offen offset:2048 lds
M v[136:139], a[112:115], a[184:187], v[136:139]
M v[136:139], a[116:119], a[188:191], v[136:139]
M v[140:143], a[124:127], a[188:191], v[140:143]
M v[140:143], a[120:123], a[184:187], v[140:143]
ds_read_b64_tr_b16 a[52:53], v14 offset:16384
ds_read_b64_tr_b16 a[54:55], v14 offset:18432
M v[144:147], a[128:131], a[184:187], v[144:147]
M v[144:147], a[132:135], a[188:191], v[144:147]
buffer_load_dwordx4 v5, s[8:11], s3 offen offset:3072 lds
M v[148:151], a[140:143], a[188:191], v[148:151]
M v[148:151], a[136:139], a[184:187], v[148:151]
M v[152:155], a[144:147], a[184:187], v[152:155]
M v[152:155], a[148:151], a[188:191], v[152:155]
ds_read_b64_tr_b16 a[60:61], v15 offset:16384
ds_read_b64_tr_b16 a[62:63], v15 offset:18432
M v[156:159], a[156:159], a[188:191], v[156:159]
s_add_u32 s23, s23, 128
s_cmp_eq_u32 s23, s25
s_cselect_b32 s23, s26, s23
M v[156:159], a[152:155], a[184:187], v[156:159]
s_waitcnt lgkmcnt(10)
M v[160:163], a[96:99], a[160:163], v[160:163]
M v[160:163], a[100:103], a[164:167], v[160:163]
ds_read_b128 a[176:179], v10 offset:53248
ds_read_b128 a[180:183], v11 offset:53248
M v[164:167], a[108:111], a[164:167], v[164:167]
M v[164:167], a[104:107], a[160:163], v[164:167]
ds_read_b64_tr_b16 a[68:69], v16 offset:16384
ds_read_b64_tr_b16 a[70:71], v16 offset:18432
M v[168:171], a[112:115], a[160:163], v[168:171]
M v[168:171], a[116:119], a[164:167], v[168:171]
s_add_u32 m0, s29, 114688
s_nop 0
buffer_load_dwordx4 v6, s[12:15], s24 offen offset:0 lds
M v[172:175], a[124:127], a[164:167], v[172:175]
M v[172:175], a[120:123], a[160:163], v[172:175]
M v[176:179], a[128:131], a[160:163], v[176:179]
M v[176:179], a[132:135], a[164:167], v[176:179]
ds_read_b64_tr_b16 a[76:77], v17 offset:16384
ds_read_b64_tr_b16 a[78:79], v17 offset:18432
M v[180:183], a[140:143], a[164:167], v[180:183]
M v[180:183], a[136:139], a[160:163], v[180:183]
buffer_load_dwordx4 v7, s[12:15], s24 offen offset:1024 lds
M v[184:187], a[144:147], a[160:163], v[184:187]
M v[184:187], a[148:151], a[164:167], v[184:187]
M v[188:191], a[156:159], a[164:167], v[188:191]
M v[188:191], a[152:155], a[160:163], v[188:191]
s_waitcnt lgkmcnt(12)
ds_read_b64_tr_b16 a[84:85], v18 offset:16384
ds_read_b64_tr_b16 a[86:87], v18 offset:18432
M v[192:195], a[96:99], a[168:171], v[192:195]
buffer_load_dwordx4 v8, s[12:15], s24 offen offset:2048 lds
M v[192:195], a[100:103], a[172:175], v[192:195]
ds_read_b128 a[184:187], v10 offset:55296
ds_read_b128 a[188:191], v11 offset:55296
M v[196:199], a[108:111], a[172:175], v[196:199]
M v[196:199], a[104:107], a[168:171], v[196:199]
M v[200:203], a[112:115], a[168:171], v[200:203]
M v[200:203], a[116:119], a[172:175], v[200:203]
ds_read_b64_tr_b16 a[92:93], v19 offset:16384
ds_read_b64_tr_b16 a[94:95], v19 offset:18432
M v[204:207], a[124:127], a[172:175], v[204:207]
buffer_load_dwordx4 v9, s[12:15], s24 offen offset:3072 lds
M v[204:207], a[120:123], a[168:171], v[204:207]
M v[208:211], a[128:131], a[168:171], v[208:211]
M v[208:211], a[132:135], a[172:175], v[208:211]
M v[212:215], a[140:143], a[172:175], v[212:215]
M v[212:215], a[136:139], a[168:171], v[212:215]
s_add_u32 s24, s24, 262144
s_cmp_eq_u32 s24, s27
s_cselect_b32 s24, s28, s24
s_sub_u32 s6, s6, 1
s_cmp_eq_u32 s6, 0
s_cselect_b64 s[12:13], s[64:65], s[12:13]
M v[216:219], a[144:147], a[168:171], v[216:219]
M v[216:219], a[148:151], a[172:175], v[216:219]
M v[220:223], a[156:159], a[172:175], v[220:223]
M v[220:223], a[152:155], a[168:171], v[220:223]
s_waitcnt lgkmcnt(10)
M v[224:227], a[96:99], a[176:179], v[224:227]
buffer_load_dword v21, v20, s[60:63], s54 offen
s_add_u32 s54, s54, 1048576
M v[224:227], a[100:103], a[180:183], v[224:227]
M v[228:231], a[108:111], a[180:183], v[228:231]
M v[228:231], a[104:107], a[176:179], v[228:231]
M v[232:235], a[112:115], a[176:179], v[232:235]
M v[232:235], a[116:119], a[180:183], v[232:235]
M v[236:239], a[124:127], a[180:183], v[236:239]
M v[236:239], a[120:123], a[176:179], v[236:239]
s_waitcnt vmcnt(9) lgkmcnt(0)
s_barrier
ds_read_b128 a[160:163], v10 offset:0
ds_read_b128 a[164:167], v11 offset:0
M v[240:243], a[128:131], a[176:179], v[240:243]
s_add_u32 m0, s29, 32768
s_nop 0
buffer_load_dwordx4 v2, s[8:11], s23 offen offset:0 lds
M v[240:243], a[132:135], a[180:183], v[240:243]
M v[244:247], a[140:143], a[180:183], v[244:247]
M v[244:247], a[136:139], a[176:179], v[244:247]
M v[248:251], a[144:147], a[176:179], v[248:251]
M v[248:251], a[148:151], a[180:183], v[248:251]
buffer_load_dwordx4 v3, s[8:11], s23 offen offset:1024 lds
M v[252:255], a[156:159], a[180:183], v[252:255]
M v[252:255], a[152:155], a[176:179], v[252:255]
M a[0:3], a[96:99], a[184:187], a[0:3]
M a[0:3], a[100:103], a[188:191], a[0:3]
ds_read_b128 a[168:171], v10 offset:2048
ds_read_b128 a[172:175], v11 offset:2048
M a[4:7], a[108:111], a[188:191], a[4:7]
M a[4:7], a[104:107], a[184:187], a[4:7]
M a[8:11], a[112:115], a[184:187], a[8:11]
buffer_load_dwordx4 v4, s[8:11], s23 offen offset:2048 lds
M a[8:11], a[116:119], a[188:191], a[8:11]
M a[12:15], a[124:127], a[188:191], a[12:15]
M a[12:15], a[120:123], a[184:187], a[12:15]
M a[16:19], a[128:131], a[184:187], a[16:19]
M a[16:19], a[132:135], a[188:191], a[16:19]
buffer_load_dwordx4 v5, s[8:11], s23 offen offset:3072 lds
M a[20:23], a[140:143], a[188:191], a[20:23]
M a[20:23], a[136:139], a[184:187], a[20:23]
M a[24:27], a[144:147], a[184:187], a[24:27]
M a[24:27], a[148:151], a[188:191], a[24:27]
M a[28:31], a[156:159], a[188:191], a[28:31]
M a[28:31], a[152:155], a[184:187], a[28:31]
s_waitcnt lgkmcnt(2)
s_sub_u32 s30, s30, 1
s_cmp_lg_u32 s30, 0
s_cbranch_scc1 Lk1_ql
M v[32:35], a[32:35], a[160:163], v[32:35]
s_add_u32 m0, s29, 65536
s_nop 0
buffer_load_dwordx4 v6, s[12:15], s24 offen offset:0 lds
M v[32:35], a[36:39], a[164:167], v[32:35]
ds_read_b128 a[176:179], v10 offset:4096
ds_read_b128 a[180:183], v11 offset:4096
M v[36:39], a[44:47], a[164:167], v[36:39]
M v[36:39], a[40:43], a[160:163], v[36:39]
ds_read_b64_tr_b16 a[96:97], v12 offset:32768
ds_read_b64_tr_b16 a[98:99], v12 offset:34816
M v[40:43], a[48:51], a[160:163], v[40:43]
M v[40:43], a[52:55], a[164:167], v[40:43]
M v[44:47], a[60:63], a[164:167], v[44:47]
M v[44:47], a[56:59], a[160:163], v[44:47]
ds_read_b64_tr_b16 a[104:105], v13 offset:32768
ds_read_b64_tr_b16 a[106:107], v13 offset:34816
M v[48:51], a[64:67], a[160:163], v[48:51]
buffer_load_dwordx4 v7, s[12:15], s24 offen offset:1024 lds
M v[48:51], a[68:71], a[164:167], v[48:51]
M v[52:55], a[76:79], a[164:167], v[52:55]
M v[52:55], a[72:75], a[160:163], v[52:55]
ds_read_b64_tr_b16 a[112:113], v14 offset:32768
ds_read_b64_tr_b16 a[114:115], v14 offset:34816
M v[56:59], a[80:83], a[160:163], v[56:59]
M v[56:59], a[84:87], a[164:167], v[56:59]
M v[60:63], a[92:95], a[164:167], v[60:63]
buffer_load_dwordx4 v8, s[12:15], s24 offen offset:2048 lds
M v[60:63], a[88:91], a[160:163], v[60:63]
s_waitcnt lgkmcnt(8)
ds_read_b64_tr_b16 a[120:121], v15 offset:32768
ds_read_b64_tr_b16 a[122:123], v15 offset:34816
M v[64:67], a[32:35], a[168:171], v[64:67]
M v[64:67], a[36:39], a[172:175], v[64:67]
ds_read_b128 a[184:187], v10 offset:6144
ds_read_b128 a[188:191], v11 offset:6144
M v[68:71], a[44:47], a[172:175], v[68:71]
M v[68:71], a[40:43], a[168:171], v[68:71]
ds_read_b64_tr_b16 a[128:129], v16 offset:32768
ds_read_b64_tr_b16 a[130:131], v16 offset:34816
M v[72:75], a[48:51], a[168:171], v[72:75]
M v[72:75], a[52:55], a[172:175], v[72:75]
M v[76:79], a[60:63], a[172:175], v[76:79]
M v[76:79], a[56:59], a[168:171], v[76:79]
ds_read_b64_tr_b16 a[136:137], v17 offset:32768
ds_read_b64_tr_b16 a[138:139], v17 offset:34816
M v[80:83], a[64:67], a[168:171], v[80:83]
buffer_load_dwordx4 v9, s[12:15], s24 offen offset:3072 lds
M v[80:83], a[68:71], a[172:175], v[80:83]
M v[84:87], a[76:79], a[172:175], v[84:87]
M v[84:87], a[72:75], a[168:171], v[84:87]
ds_read_b64_tr_b16 a[144:145], v18 offset:32768
ds_read_b64_tr_b16 a[146:147], v18 offset:34816
M v[88:91], a[80:83], a[168:171], v[88:91]
M v[88:91], a[84:87], a[172:175], v[88:91]
M v[92:95], a[92:95], a[172:175], v[92:95]
s_add_u32 s24, s24, 262144
M v[92:95], a[88:91], a[168:171], v[92:95]
s_waitcnt lgkmcnt(15)
ds_read_b64_tr_b16 a[152:153], v19 offset:32768
ds_read_b64_tr_b16 a[154:155], v19 offset:34816
M v[96:99], a[32:35], a[176:179], v[96:99]
M v[96:99], a[36:39], a[180:183], v[96:99]
M v[100:103], a[44:47], a[180:183], v[100:103]
M v[100:103], a[40:43], a[176:179], v[100:103]
M v[104:107], a[48:51], a[176:179], v[104:107]
M v[104:107], a[52:55], a[180:183], v[104:107]
M v[108:111], a[60:63], a[180:183], v[108:111]
M v[108:111], a[56:59], a[176:179], v[108:111]
s_waitcnt vmcnt(9) lgkmcnt(0)
s_barrier
ds_read_b128 a[160:163], v10 offset:16384
ds_read_b128 a[164:167], v11 offset:16384
M v[112:115], a[64:67], a[176:179], v[112:115]
s_add_u32 m0, s29, 49152
s_add_u32 s3, s23, s31
buffer_load_dwordx4 v2, s[8:11], s3 offen offset:0 lds
M v[112:115], a[68:71], a[180:183], v[112:115]
M v[116:119], a[76:79], a[180:183], v[116:119]
M v[116:119], a[72:75], a[176:179], v[116:119]
ds_read_b64_tr_b16 a[100:101], v12 offset:49152
ds_read_b64_tr_b16 a[102:103], v12 offset:51200
M v[120:123], a[80:83], a[176:179], v[120:123]
M v[120:123], a[84:87], a[180:183], v[120:123]
buffer_load_dwordx4 v3, s[8:11], s3 offen offset:1024 lds
M v[124:127], a[92:95], a[180:183], v[124:127]
M v[124:127], a[88:91], a[176:179], v[124:127]
M v[128:131], a[32:35], a[184:187], v[128:131]
M v[128:131], a[36:39], a[188:191], v[128:131]
ds_read_b128 a[168:171], v10 offset:18432
ds_read_b128 a[172:175], v11 offset:18432
ds_read_b64_tr_b16 a[108:109], v13 offset:49152
ds_read_b64_tr_b16 a[110:111], v13 offset:51200
M v[132:135], a[44:47], a[188:191], v[132:135]
M v[132:135], a[40:43], a[184:187], v[132:135]
M v[136:139], a[48:51], a[184:187], v[136:139]
buffer_load_dwordx4 v4, s[8:11], s3 offen offset:2048 lds
M v[136:139], a[52:55], a[188:191], v[136:139]
M v[140:143], a[60:63], a[188:191], v[140:143]
M v[140:143], a[56:59], a[184:187], v[140:143]
ds_read_b64_tr_b16 a[116:117], v14 offset:49152
ds_read_b64_tr_b16 a[118:119], v14 offset:51200
M v[144:147], a[64:67], a[184:187], v[144:147]
M v[144:147], a[68:71], a[188:191], v[144:147]
M v[148:151], a[76:79], a[188:191], v[148:151]
buffer_load_dwordx4 v5, s[8:11], s3 offen offset:3072 lds
M v[148:151], a[72:75], a[184:187], v[148:151]
M v[152:155], a[80:83], a[184:187], v[152:155]
M v[152:155], a[84:87], a[188:191], v[152:155]
ds_read_b64_tr_b16 a[124:125], v15 offset:49152
ds_read_b64_tr_b16 a[126:127], v15 offset:51200
M v[156:159], a[92:95], a[188:191], v[156:159]
M v[156:159], a[88:91], a[184:187], v[156:159]
s_waitcnt lgkmcnt(10)
M v[160:163], a[32:35], a[160:163], v[160:163]
M v[160:163], a[36:39], a[164:167], v[160:163]
ds_read_b128 a[176:179], v10 offset:20480
ds_read_b128 a[180:183], v11 offset:20480
M v[164:167], a[44:47], a[164:167], v[164:167]
s_add_u32 s23, s23, 128
s_cmp_eq_u32 s23, s25
s_cselect_b32 s23, s26, s23
M v[164:167], a[40:43], a[160:163], v[164:167]
ds_read_b64_tr_b16 a[132:133], v16 offset:49152
ds_read_b64_tr_b16 a[134:135], v16 offset:51200
M v[168:171], a[48:51], a[160:163], v[168:171]
M v[168:171], a[52:55], a[164:167], v[168:171]
M v[172:175], a[60:63], a[164:167], v[172:175]
M v[172:175], a[56:59], a[160:163], v[172:175]
M v[176:179], a[64:67], a[160:163], v[176:179]
s_add_u32 m0, s29, 81920
s_nop 0
buffer_load_dwordx4 v6, s[12:15], s24 offen offset:0 lds
M v[176:179], a[68:71], a[164:167], v[176:179]
ds_read_b64_tr_b16 a[140:141], v17 offset:49152
ds_read_b64_tr_b16 a[142:143], v17 offset:51200
M v[180:183], a[76:79], a[164:167], v[180:183]
M v[180:183], a[72:75], a[160:163], v[180:183]
M v[184:187], a[80:83], a[160:163], v[184:187]
M v[184:187], a[84:87], a[164:167], v[184:187]
buffer_load_dwordx4 v7, s[12:15], s24 offen offset:1024 lds
M v[188:191], a[92:95], a[164:167], v[188:191]
M v[188:191], a[88:91], a[160:163], v[188:191]
s_waitcnt lgkmcnt(12)
ds_read_b64_tr_b16 a[148:149], v18 offset:49152
ds_read_b64_tr_b16 a[150:151], v18 offset:51200
M v[192:195], a[32:35], a[168:171], v[192:195]
M v[192:195], a[36:39], a[172:175], v[192:195]
ds_read_b128 a[184:187], v10 offset:22528
ds_read_b128 a[188:191], v11 offset:22528
M v[196:199], a[44:47], a[172:175], v[196:199]
M v[196:199], a[40:43], a[168:171], v[196:199]
M v[200:203], a[48:51], a[168:171], v[200:203]
buffer_load_dwordx4 v8, s[12:15], s24 offen offset:2048 lds
M v[200:203], a[52:55], a[172:175], v[200:203]
ds_read_b64_tr_b16 a[156:157], v19 offset:49152
ds_read_b64_tr_b16 a[158:159], v19 offset:51200
M v[204:207], a[60:63], a[172:175], v[204:207]
M v[204:207], a[56:59], a[168:171], v[204:207]
M v[208:211], a[64:67], a[168:171], v[208:211]
M v[208:211], a[68:71], a[172:175], v[208:211]
M v[212:215], a[76:79], a[172:175], v[212:215]
buffer_load_dwordx4 v9, s[12:15], s24 offen offset:3072 lds
M v[212:215], a[72:75], a[168:171], v[212:215]
M v[216:219], a[80:83], a[168:171], v[216:219]
M v[216:219], a[84:87], a[172:175], v[216:219]
M v[220:223], a[92:95], a[172:175], v[220:223]
M v[220:223], a[88:91], a[168:171], v[220:223]
s_waitcnt lgkmcnt(10)
M v[224:227], a[32:35], a[176:179], v[224:227]
s_add_u32 s24, s24, 262144
s_cmp_eq_u32 s24, s27
s_cselect_b32 s24, s28, s24
s_sub_u32 s6, s6, 1
s_cmp_eq_u32 s6, 0
s_cselect_b64 s[12:13], s[64:65], s[12:13]
M v[224:227], a[36:39], a[180:183], v[224:227]
M v[228:231], a[44:47], a[180:183], v[228:231]
M v[228:231], a[40:43], a[176:179], v[228:231]
M v[232:235], a[48:51], a[176:179], v[232:235]
M v[232:235], a[52:55], a[180:183], v[232:235]
M v[236:239], a[60:63], a[180:183], v[236:239]
M v[236:239], a[56:59], a[176:179], v[236:239]
s_waitcnt vmcnt(8) lgkmcnt(0)
s_barrier
ds_read_b128 a[160:163], v10 offset:32768
ds_read_b128 a[164:167], v11 offset:32768
M v[240:243], a[64:67], a[176:179], v[240:243]
s_add_u32 m0, s29, 0
s_nop 0
buffer_load_dwordx4 v2, s[8:11], s23 offen offset:0 lds
M v[240:243], a[68:71], a[180:183], v[240:243]
M v[244:247], a[76:79], a[180:183], v[244:247]
M v[244:247], a[72:75], a[176:179], v[244:247]
M v[248:251], a[80:83], a[176:179], v[248:251]
M v[248:251], a[84:87], a[180:183], v[248:251]
buffer_load_dwordx4 v3, s[8:11], s23 offen offset:1024 lds
M v[252:255], a[92:95], a[180:183], v[252:255]
M v[252:255], a[88:91], a[176:179], v[252:255]
M a[0:3], a[32:35], a[184:187], a[0:3]
M a[0:3], a[36:39], a[188:191], a[0:3]
ds_read_b128 a[168:171], v10 offset:34816
ds_read_b128 a[172:175], v11 offset:34816
M a[4:7], a[44:47], a[188:191], a[4:7]
M a[4:7], a[40:43], a[184:187], a[4:7]
M a[8:11], a[48:51], a[184:187], a[8:11]
buffer_load_dwordx4 v4, s[8:11], s23 offen offset:2048 lds
M a[8:11], a[52:55], a[188:191], a[8:11]
M a[12:15], a[60:63], a[188:191], a[12:15]
M a[12:15], a[56:59], a[184:187], a[12:15]
M a[16:19], a[64:67], a[184:187], a[16:19]
M a[16:19], a[68:71], a[188:191], a[16:19]
buffer_load_dwordx4 v5, s[8:11], s23 offen offset:3072 lds
M a[20:23], a[76:79], a[188:191], a[20:23]
M a[20:23], a[72:75], a[184:187], a[20:23]
M a[24:27], a[80:83], a[184:187], a[24:27]
M a[24:27], a[84:87], a[188:191], a[24:27]
M a[28:31], a[92:95], a[188:191], a[28:31]
M a[28:31], a[88:91], a[184:187], a[28:31]
s_waitcnt lgkmcnt(2)
M v[32:35], a[96:99], a[160:163], v[32:35]
s_add_u32 m0, s29, 98304
s_nop 0
buffer_load_dwordx4 v6, s[12:15], s24 offen offset:0 lds
M v[32:35], a[100:103], a[164:167], v[32:35]
ds_read_b128 a[176:179], v10 offset:36864
ds_read_b128 a[180:183], v11 offset:36864
M v[36:39], a[108:111], a[164:167], v[36:39]
M v[36:39], a[104:107], a[160:163], v[36:39]
ds_read_b64_tr_b16 a[32:33], v12 offset:0
ds_read_b64_tr_b16 a[34:35], v12 offset:2048
M v[40:43], a[112:115], a[160:163], v[40:43]
M v[40:43], a[116:119], a[164:167], v[40:43]
M v[44:47], a[124:127], a[164:167], v[44:47]
M v[44:47], a[120:123], a[160:163], v[44:47]
ds_read_b64_tr_b16 a[40:41], v13 offset:0
ds_read_b64_tr_b16 a[42:43], v13 offset:2048
M v[48:51], a[128:131], a[160:163], v[48:51]
buffer_load_dwordx4 v7, s[12:15], s24 offen offset:1024 lds
M v[48:51], a[132:135], a[164:167], v[48:51]
M v[52:55], a[140:143], a[164:167], v[52:55]
M v[52:55], a[136:139], a[160:163], v[52:55]
ds_read_b64_tr_b16 a[48:49], v14 offset:0
ds_read_b64_tr_b16 a[50:51], v14 offset:2048
M v[56:59], a[144:147], a[160:163], v[56:59]
M v[56:59], a[148:151], a[164:167], v[56:59]
M v[60:63], a[156:159], a[164:167], v[60:63]
buffer_load_dwordx4 v8, s[12:15], s24 offen offset:2048 lds
M v[60:63], a[152:155], a[160:163], v[60:63]
s_waitcnt lgkmcnt(8)
ds_read_b64_tr_b16 a[56:57], v15 offset:0
ds_read_b64_tr_b16 a[58:59], v15 offset:2048
M v[64:67], a[96:99], a[168:171], v[64:67]
M v[64:67], a[100:103], a[172:175], v[64:67]
ds_read_b128 a[184:187], v10 offset:38912
ds_read_b128 a[188:191], v11 offset:38912
M v[68:71], a[108:111], a[172:175], v[68:71]
M v[68:71], a[104:107], a[168:171], v[68:71]
ds_read_b64_tr_b16 a[64:65], v16 offset:0
ds_read_b64_tr_b16 a[66:67], v16 offset:2048
M v[72:75], a[112:115], a[168:171], v[72:75]
M v[72:75], a[116:119], a[172:175], v[72:75]
M v[76:79], a[124:127], a[172:175], v[76:79]
M v[76:79], a[120:123], a[168:171], v[76:79]
ds_read_b64_tr_b16 a[72:73], v17 offset:0
ds_read_b64_tr_b16 a[74:75], v17 offset:2048
M v[80:83], a[128:131], a[168:171], v[80:83]
buffer_load_dwordx4 v9, s[12:15], s24 offen offset:3072 lds
M v[80:83], a[132:135], a[172:175], v[80:83]
M v[84:87], a[140:143], a[172:175], v[84:87]
M v[84:87], a[136:139], a[168:171], v[84:87]
ds_read_b64_tr_b16 a[80:81], v18 offset:0
ds_read_b64_tr_b16 a[82:83], v18 offset:2048
M v[88:91], a[144:147], a[168:171], v[88:91]
M v[88:91], a[148:151], a[172:175], v[88:91]
M v[92:95], a[156:159], a[172:175], v[92:95]
s_add_u32 s24, s24, 262144
M v[92:95], a[152:155], a[168:171], v[92:95]
s_waitcnt lgkmcnt(15)
ds_read_b64_tr_b16 a[88:89], v19 offset:0
ds_read_b64_tr_b16 a[90:91], v19 offset:2048
M v[96:99], a[96:99], a[176:179], v[96:99]
M v[96:99], a[100:103], a[180:183], v[96:99]
M v[100:103], a[108:111], a[180:183], v[100:103]
M v[100:103], a[104:107], a[176:179], v[100:103]
M v[104:107], a[112:115], a[176:179], v[104:107]
M v[104:107], a[116:119], a[180:183], v[104:107]
M v[108:111], a[124:127], a[180:183], v[108:111]
M v[108:111], a[120:123], a[176:179], v[108:111]
s_waitcnt vmcnt(8) lgkmcnt(0)
s_barrier
ds_read_b128 a[160:163], v10 offset:49152
ds_read_b128 a[164:167], v11 offset:49152
M v[112:115], a[128:131], a[176:179], v[112:115]
s_add_u32 m0, s29, 16384
s_add_u32 s3, s23, s31
buffer_load_dwordx4 v2, s[8:11], s3 offen offset:0 lds
M v[112:115], a[132:135], a[180:183], v[112:115]
M v[116:119], a[140:143], a[180:183], v[116:119]
M v[116:119], a[136:139], a[176:179], v[116:119]
ds_read_b64_tr_b16 a[36:37], v12 offset:16384
ds_read_b64_tr_b16 a[38:39], v12 offset:18432
M v[120:123], a[144:147], a[176:179], v[120:123]
M v[120:123], a[148:151], a[180:183], v[120:123]
buffer_load_dwordx4 v3, s[8:11], s3 offen offset:1024 lds
M v[124:127], a[156:159], a[180:183], v[124:127]
M v[124:127], a[152:155], a[176:179], v[124:127]
M v[128:131], a[96:99], a[184:187], v[128:131]
M v[128:131], a[100:103], a[188:191], v[128:131]
ds_read_b128 a[168:171], v10 offset:51200
ds_read_b128 a[172:175], v11 offset:51200
ds_read_b64_tr_b16 a[44:45], v13 offset:16384
ds_read_b64_tr_b16 a[46:47], v13 offset:18432
M v[132:135], a[108:111], a[188:191], v[132:135]
M v[132:135], a[104:107], a[184:187], v[132:135]
M v[136:139], a[112:115], a[184:187], v[136:139]
buffer_load_dwordx4 v4, s[8:11], s3 offen offset:2048 lds
M v[136:139], a[116:119], a[188:191], v[136:139]
M v[140:143], a[124:127], a[188:191], v[140:143]
M v[140:143], a[120:123], a[184:187], v[140:143]
ds_read_b64_tr_b16 a[52:53], v14 offset:16384
ds_read_b64_tr_b16 a[54:55], v14 offset:18432
M v[144:147], a[128:131], a[184:187], v[144:147]
M v[144:147], a[132:135], a[188:191], v[144:147]
M v[148:151], a[140:143], a[188:191], v[148:151]
buffer_load_dwordx4 v5, s[8:11], s3 offen offset:3072 lds
M v[148:151], a[136:139], a[184:187], v[148:151]
M v[152:155], a[144:147], a[184:187], v[152:155]
M v[152:155], a[148:151], a[188:191], v[152:155]
ds_read_b64_tr_b16 a[60:61], v15 offset:16384
ds_read_b64_tr_b16 a[62:63], v15 offset:18432
M v[156:159], a[156:159], a[188:191], v[156:159]
M v[156:159], a[152:155], a[184:187], v[156:159]
s_waitcnt lgkmcnt(10)
M v[160:163], a[96:99], a[160:163], v[160:163]
M v[160:163], a[100:103], a[164:167], v[160:163]
ds_read_b128 a[176:179], v10 offset:53248
ds_read_b128 a[180:183], v11 offset:53248
M v[164:167], a[108:111], a[164:167], v[164:167]
s_add_u32 s23, s23, 128
s_cmp_eq_u32 s23, s25
s_cselect_b32 s23, s26, s23
M v[164:167], a[104:107], a[160:163], v[164:167]
ds_read_b64_tr_b16 a[68:69], v16 offset:16384
ds_read_b64_tr_b16 a[70:71], v16 offset:18432
M v[168:171], a[112:115], a[160:163], v[168:171]
M v[168:171], a[116:119], a[164:167], v[168:171]
M v[172:175], a[124:127], a[164:167], v[172:175]
M v[172:175], a[120:123], a[160:163], v[172:175]
M v[176:179], a[128:131], a[160:163], v[176:179]
s_add_u32 m0, s29, 114688
s_nop 0
buffer_load_dwordx4 v6, s[12:15], s24 offen offset:0 lds
M v[176:179], a[132:135], a[164:167], v[176:179]
ds_read_b64_tr_b16 a[76:77], v17 offset:16384
ds_read_b64_tr_b16 a[78:79], v17 offset:18432
M v[180:183], a[140:143], a[164:167], v[180:183]
M v[180:183], a[136:139], a[160:163], v[180:183]
M v[184:187], a[144:147], a[160:163], v[184:187]
M v[184:187], a[148:151], a[164:167], v[184:187]
buffer_load_dwordx4 v7, s[12:15], s24 offen offset:1024 lds
M v[188:191], a[156:159], a[164:167], v[188:191]
M v[188:191], a[152:155], a[160:163], v[188:191]
s_waitcnt lgkmcnt(12)
ds_read_b64_tr_b16 a[84:85], v18 offset:16384
ds_read_b64_tr_b16 a[86:87], v18 offset:18432
M v[192:195], a[96:99], a[168:171], v[192:195]
M v[192:195], a[100:103], a[172:175], v[192:195]
ds_read_b128 a[184:187], v10 offset:55296
ds_read_b128 a[188:191], v11 offset:55296
M v[196:199], a[108:111], a[172:175], v[196:199]
M v[196:199], a[104:107], a[168:171], v[196:199]
M v[200:203], a[112:115], a[168:171], v[200:203]
buffer_load_dwordx4 v8, s[12:15], s24 offen offset:2048 lds
M v[200:203], a[116:119], a[172:175], v[200:203]
ds_read_b64_tr_b16 a[92:93], v19 offset:16384
ds_read_b64_tr_b16 a[94:95], v19 offset:18432
M v[204:207], a[124:127], a[172:175], v[204:207]
M v[204:207], a[120:123], a[168:171], v[204:207]
M v[208:211], a[128:131], a[168:171], v[208:211]
M v[208:211], a[132:135], a[172:175], v[208:211]
M v[212:215], a[140:143], a[172:175], v[212:215]
buffer_load_dwordx4 v9, s[12:15], s24 offen offset:3072 lds
M v[212:215], a[136:139], a[168:171], v[212:215]
M v[216:219], a[144:147], a[168:171], v[216:219]
M v[216:219], a[148:151], a[172:175], v[216:219]
M v[220:223], a[156:159], a[172:175], v[220:223]
M v[220:223], a[152:155], a[168:171], v[220:223]
s_waitcnt lgkmcnt(10)
M v[224:227], a[96:99], a[176:179], v[224:227]
s_add_u32 s24, s24, 262144
s_cmp_eq_u32 s24, s27
s_cselect_b32 s24, s28, s24
s_sub_u32 s6, s6, 1
s_cmp_eq_u32 s6, 0
s_cselect_b64 s[12:13], s[64:65], s[12:13]
M v[224:227], a[100:103], a[180:183], v[224:227]
M v[228:231], a[108:111], a[180:183], v[228:231]
M v[228:231], a[104:107], a[176:179], v[228:231]
M v[232:235], a[112:115], a[176:179], v[232:235]
M v[232:235], a[116:119], a[180:183], v[232:235]
M v[236:239], a[124:127], a[180:183], v[236:239]
M v[236:239], a[120:123], a[176:179], v[236:239]
s_waitcnt vmcnt(8) lgkmcnt(0)
s_barrier
ds_read_b128 a[160:163], v10 offset:0
ds_read_b128 a[164:167], v11 offset:0
M v[240:243], a[128:131], a[176:179], v[240:243]
s_add_u32 m0, s29, 32768
s_nop 0
buffer_load_dwordx4 v2, s[8:11], s23 offen offset:0 lds
M v[240:243], a[132:135], a[180:183], v[240:243]
M v[244:247], a[140:143], a[180:183], v[244:247]
M v[244:247], a[136:139], a[176:179], v[244:247]
M v[248:251], a[144:147], a[176:179], v[248:251]
M v[248:251], a[148:151], a[180:183], v[248:251]
M v[252:255], a[156:159], a[180:183], v[252:255]
M v[252:255], a[152:155], a[176:179], v[252:255]
M a[0:3], a[96:99], a[184:187], a[0:3]
M a[0:3], a[100:103], a[188:191], a[0:3]
ds_read_b128 a[168:171], v10 offset:2048
ds_read_b128 a[172:175], v11 offset:2048
M a[4:7], a[108:111], a[188:191], a[4:7]
M a[4:7], a[104:107], a[184:187], a[4:7]
M a[8:11], a[112:115], a[184:187], a[8:11]
buffer_load_dwordx4 v3, s[8:11], s23 offen offset:1024 lds
M a[8:11], a[116:119], a[188:191], a[8:11]
M a[12:15], a[124:127], a[188:191], a[12:15]
M a[12:15], a[120:123], a[184:187], a[12:15]
M a[16:19], a[128:131], a[184:187], a[16:19]
M a[16:19], a[132:135], a[188:191], a[16:19]
M a[20:23], a[140:143], a[188:191], a[20:23]
M a[20:23], a[136:139], a[184:187], a[20:23]
M a[24:27], a[144:147], a[184:187], a[24:27]
M a[24:27], a[148:151], a[188:191], a[24:27]
M a[28:31], a[156:159], a[188:191], a[28:31]
M a[28:31], a[152:155], a[184:187], a[28:31]
s_waitcnt lgkmcnt(2)
M v[32:35], a[32:35], a[160:163], v[32:35]
buffer_load_dwordx4 v4, s[8:11], s23 offen offset:2048 lds
M v[32:35], a[36:39], a[164:167], v[32:35]
ds_read_b128 a[176:179], v10 offset:4096
ds_read_b128 a[180:183], v11 offset:4096
M v[36:39], a[44:47], a[164:167], v[36:39]
M v[36:39], a[40:43], a[160:163], v[36:39]
ds_read_b64_tr_b16 a[96:97], v12 offset:32768
ds_read_b64_tr_b16 a[98:99], v12 offset:34816
M v[40:43], a[48:51], a[160:163], v[40:43]
M v[40:43], a[52:55], a[164:167], v[40:43]
M v[44:47], a[60:63], a[164:167], v[44:47]
M v[44:47], a[56:59], a[160:163], v[44:47]
ds_read_b64_tr_b16 a[104:105], v13 offset:32768
ds_read_b64_tr_b16 a[106:107], v13 offset:34816
M v[48:51], a[64:67], a[160:163], v[48:51]
M v[48:51], a[68:71], a[164:167], v[48:51]
M v[52:55], a[76:79], a[164:167], v[52:55]
M v[52:55], a[72:75], a[160:163], v[52:55]
ds_read_b64_tr_b16 a[112:113], v14 offset:32768
ds_read_b64_tr_b16 a[114:115], v14 offset:34816
M v[56:59], a[80:83], a[160:163], v[56:59]
M v[56:59], a[84:87], a[164:167], v[56:59]
M v[60:63], a[92:95], a[164:167], v[60:63]
M v[60:63], a[88:91], a[160:163], v[60:63]
s_waitcnt lgkmcnt(8)
ds_read_b64_tr_b16 a[120:121], v15 offset:32768
ds_read_b64_tr_b16 a[122:123], v15 offset:34816
M v[64:67], a[32:35], a[168:171], v[64:67]
M v[64:67], a[36:39], a[172:175], v[64:67]
ds_read_b128 a[184:187], v10 offset:6144
ds_read_b128 a[188:191], v11 offset:6144
M v[68:71], a[44:47], a[172:175], v[68:71]
M v[68:71], a[40:43], a[168:171], v[68:71]
ds_read_b64_tr_b16 a[128:129], v16 offset:32768
ds_read_b64_tr_b16 a[130:131], v16 offset:34816
M v[72:75], a[48:51], a[168:171], v[72:75]
buffer_load_dwordx4 v5, s[8:11], s23 offen offset:3072 lds
M v[72:75], a[52:55], a[172:175], v[72:75]
M v[76:79], a[60:63], a[172:175], v[76:79]
M v[76:79], a[56:59], a[168:171], v[76:79]
ds_read_b64_tr_b16 a[136:137], v17 offset:32768
ds_read_b64_tr_b16 a[138:139], v17 offset:34816
M v[80:83], a[64:67], a[168:171], v[80:83]
M v[80:83], a[68:71], a[172:175], v[80:83]
M v[84:87], a[76:79], a[172:175], v[84:87]
M v[84:87], a[72:75], a[168:171], v[84:87]
ds_read_b64_tr_b16 a[144:145], v18 offset:32768
ds_read_b64_tr_b16 a[146:147], v18 offset:34816
M v[88:91], a[80:83], a[168:171], v[88:91]
M v[88:91], a[84:87], a[172:175], v[88:91]
M v[92:95], a[92:95], a[172:175], v[92:95]
M v[92:95], a[88:91], a[168:171], v[92:95]
s_waitcnt lgkmcnt(15)
ds_read_b64_tr_b16 a[152:153], v19 offset:32768
ds_read_b64_tr_b16 a[154:155], v19 offset:34816
M v[96:99], a[32:35], a[176:179], v[96:99]
M v[96:99], a[36:39], a[180:183], v[96:99]
M v[100:103], a[44:47], a[180:183], v[100:103]
M v[100:103], a[40:43], a[176:179], v[100:103]
M v[104:107], a[48:51], a[176:179], v[104:107]
M v[104:107], a[52:55], a[180:183], v[104:107]
M v[108:111], a[60:63], a[180:183], v[108:111]
M v[108:111], a[56:59], a[176:179], v[108:111]
s_waitcnt vmcnt(4) lgkmcnt(0)
s_barrier
ds_read_b128 a[160:163], v10 offset:16384
ds_read_b128 a[164:167], v11 offset:16384
M v[112:115], a[64:67], a[176:179], v[112:115]
s_add_u32 m0, s29, 49152
s_add_u32 s3, s23, s31
buffer_load_dwordx4 v2, s[8:11], s3 offen offset:0 lds
M v[112:115], a[68:71], a[180:183], v[112:115]
M v[116:119], a[76:79], a[180:183], v[116:119]
buffer_load_dwordx4 v3, s[8:11], s3 offen offset:1024 lds
M v[116:119], a[72:75], a[176:179], v[116:119]
ds_read_b64_tr_b16 a[100:101], v12 offset:49152
ds_read_b64_tr_b16 a[102:103], v12 offset:51200
M v[120:123], a[80:83], a[176:179], v[120:123]
buffer_load_dwordx4 v4, s[8:11], s3 offen offset:2048 lds
M v[120:123], a[84:87], a[180:183], v[120:123]
M v[124:127], a[92:95], a[180:183], v[124:127]
buffer_load_dwordx4 v5, s[8:11], s3 offen offset:3072 lds
M v[124:127], a[88:91], a[176:179], v[124:127]
M v[128:131], a[32:35], a[184:187], v[128:131]
M v[128:131], a[36:39], a[188:191], v[128:131]
ds_read_b128 a[168:171], v10 offset:18432
ds_read_b128 a[172:175], v11 offset:18432
ds_read_b64_tr_b16 a[108:109], v13 offset:49152
ds_read_b64_tr_b16 a[110:111], v13 offset:51200
M v[132:135], a[44:47], a[188:191], v[132:135]
M v[132:135], a[40:43], a[184:187], v[132:135]
M v[136:139], a[48:51], a[184:187], v[136:139]
s_and_b32 s3, s2, 1
s_lshl_b32 s3, s3, 3
s_bfe_u32 s4, s2, 0x30003
s_add_u32 s26, s3, s4
M v[136:139], a[52:55], a[188:191], v[136:139]
s_bfe_u32 s3, s2, 0x20001
s_lshl_b32 s3, s3, 2
s_lshr_b32 s4, s2, 6
M v[140:143], a[60:63], a[188:191], v[140:143]
s_xor_b32 s4, s4, 2
s_add_u32 s27, s3, s4
s_lshl_b32 s23, s26, 18
M v[140:143], a[56:59], a[184:187], v[140:143]
ds_read_b64_tr_b16 a[116:117], v14 offset:49152
ds_read_b64_tr_b16 a[118:119], v14 offset:51200
s_sub_u32 s24, s23, 32768
s_max_i32 s24, s24, 0
s_lshl_b32 s25, s27, 7
s_add_u32 s3, s26, s27
M v[144:147], a[64:67], a[184:187], v[144:147]
s_and_b32 s3, s3, 0
s_mul_i32 s3, s3, 16
s_sub_u32 s31, 16, s3
M v[144:147], a[68:71], a[188:191], v[144:147]
s_mov_b32 s54, s31
s_movk_i32 s57, 128
s_mov_b32 s55, 4289069056
M v[148:151], a[76:79], a[188:191], v[148:151]
s_mov_b32 s56, 393216
s_lshl_b32 s4, s3, 7
s_add_u32 s23, s23, s4
s_add_u32 s24, s24, s4
M v[148:151], a[72:75], a[184:187], v[148:151]
s_mul_i32 s4, s3, 393216
s_add_u32 s25, s25, s4
s_mov_b64 s[8:9], s[44:45]
M v[152:155], a[80:83], a[184:187], v[152:155]
s_mov_b32 s10, 4194304
s_mov_b64 s[12:13], s[46:47]
s_mov_b32 s14, 6291456
M v[152:155], a[84:87], a[188:191], v[152:155]
ds_read_b64_tr_b16 a[124:125], v15 offset:49152
ds_read_b64_tr_b16 a[126:127], v15 offset:51200
s_mov_b64 s[36:37], s[90:91]
s_mov_b32 s38, 256
s_mov_b32 s39, 0x00020000
M v[156:159], a[92:95], a[188:191], v[156:159]
s_lshl_b32 s28, s20, 9
s_mul_i32 s30, s20, 6144
s_lshl_b32 s3, s20, 5
v_lshrrev_b32 v24, 3, v0
M v[156:159], a[88:91], a[184:187], v[156:159]
s_waitcnt lgkmcnt(10)
v_and_b32 v25, 7, v0
v_add_u32 v28, s3, v24
v_add_u32 v26, 0, v28
M v[160:163], a[32:35], a[160:163], v[160:163]
v_bfe_u32 v27, v26, 1, 3
v_xor_b32 v27, v27, v25
v_lshlrev_b32 v26, 11, v26
M v[160:163], a[36:39], a[164:167], v[160:163]
ds_read_b128 a[176:179], v10 offset:20480
ds_read_b128 a[180:183], v11 offset:20480
v_lshl_add_u32 v26, v27, 4, v26
v_subrev_u32 v2, 0, v26
v_add_u32 v26, 8, v28
v_bfe_u32 v27, v26, 1, 3
M v[164:167], a[44:47], a[164:167], v[164:167]
v_xor_b32 v27, v27, v25
v_lshlrev_b32 v26, 11, v26
v_lshl_add_u32 v26, v27, 4, v26
M v[164:167], a[40:43], a[160:163], v[164:167]
ds_read_b64_tr_b16 a[132:133], v16 offset:49152
ds_read_b64_tr_b16 a[134:135], v16 offset:51200
v_subrev_u32 v3, 1024, v26
v_add_u32 v26, 16, v28
v_bfe_u32 v27, v26, 1, 3
M v[168:171], a[48:51], a[160:163], v[168:171]
v_xor_b32 v27, v27, v25
v_lshlrev_b32 v26, 11, v26
v_lshl_add_u32 v26, v27, 4, v26
M v[168:171], a[52:55], a[164:167], v[168:171]
v_subrev_u32 v4, 2048, v26
v_add_u32 v26, 24, v28
v_bfe_u32 v27, v26, 1, 3
v_xor_b32 v27, v27, v25
M v[172:175], a[60:63], a[164:167], v[172:175]
v_lshlrev_b32 v26, 11, v26
v_lshl_add_u32 v26, v27, 4, v26
v_subrev_u32 v5, 3072, v26
M v[172:175], a[56:59], a[160:163], v[172:175]
s_lshl_b32 s3, s20, 2
v_lshrrev_b32 v26, 5, v0
v_add_u32 v26, s3, v26
M v[176:179], a[64:67], a[160:163], v[176:179]
v_bfe_u32 v29, v0, 2, 3
v_bfe_u32 v27, v26, 1, 3
v_xor_b32 v27, v27, v29
v_lshlrev_b32 v27, 4, v27
M v[176:179], a[68:71], a[164:167], v[176:179]
ds_read_b64_tr_b16 a[140:141], v17 offset:49152
ds_read_b64_tr_b16 a[142:143], v17 offset:51200
v_and_b32 v30, 3, v0
v_lshl_add_u32 v27, v30, 2, v27
v_lshl_add_u32 v20, v26, 11, v27
M v[180:183], a[76:79], a[164:167], v[180:183]
v_add_u32 v26, 2, v26
v_bfe_u32 v27, v26, 1, 3
v_xor_b32 v27, v27, v29
M v[180:183], a[72:75], a[160:163], v[180:183]
v_lshlrev_b32 v27, 4, v27
v_and_b32 v30, 3, v0
v_lshl_add_u32 v27, v30, 2, v27
M v[184:187], a[80:83], a[160:163], v[184:187]
v_lshl_add_u32 v23, v26, 11, v27
v_subrev_u32 v23, 256, v23
s_mul_i32 s3, s20, 48
v_add_u32 v28, s3, v24
M v[184:187], a[84:87], a[164:167], v[184:187]
v_add_u32 v26, 0, v28
v_mul_u32_u24 v27, 0xaaab, v26
v_lshrrev_b32 v27, 17, v27
M v[188:191], a[92:95], a[164:167], v[188:191]
v_lshrrev_b32 v29, 1, v27
v_and_b32 v29, 4, v29
v_and_or_b32 v27, v27, 2, v29
M v[188:191], a[88:91], a[160:163], v[188:191]
s_waitcnt lgkmcnt(12)
ds_read_b64_tr_b16 a[148:149], v18 offset:49152
ds_read_b64_tr_b16 a[150:151], v18 offset:51200
v_xor_b32 v27, v27, v25
v_lshlrev_b32 v26, 11, v26
v_lshl_add_u32 v26, v27, 4, v26
v_subrev_u32 v6, 0, v26
M v[192:195], a[32:35], a[168:171], v[192:195]
v_add_u32 v26, 8, v28
v_mul_u32_u24 v27, 0xaaab, v26
v_lshrrev_b32 v27, 17, v27
M v[192:195], a[36:39], a[172:175], v[192:195]
ds_read_b128 a[184:187], v10 offset:22528
ds_read_b128 a[188:191], v11 offset:22528
v_lshrrev_b32 v29, 1, v27
v_and_b32 v29, 4, v29
v_and_or_b32 v27, v27, 2, v29
M v[196:199], a[44:47], a[172:175], v[196:199]
v_xor_b32 v27, v27, v25
v_lshlrev_b32 v26, 11, v26
v_lshl_add_u32 v26, v27, 4, v26
v_subrev_u32 v7, 1024, v26
M v[196:199], a[40:43], a[168:171], v[196:199]
v_add_u32 v26, 16, v28
v_mul_u32_u24 v27, 0xaaab, v26
v_lshrrev_b32 v27, 17, v27
M v[200:203], a[48:51], a[168:171], v[200:203]
v_lshrrev_b32 v29, 1, v27
v_and_b32 v29, 4, v29
v_and_or_b32 v27, v27, 2, v29
M v[200:203], a[52:55], a[172:175], v[200:203]
ds_read_b64_tr_b16 a[156:157], v19 offset:49152
ds_read_b64_tr_b16 a[158:159], v19 offset:51200
v_xor_b32 v27, v27, v25
v_lshlrev_b32 v26, 11, v26
v_lshl_add_u32 v26, v27, 4, v26
M v[204:207], a[60:63], a[172:175], v[204:207]
v_subrev_u32 v8, 2048, v26
v_add_u32 v26, 24, v28
v_mul_u32_u24 v27, 0xaaab, v26
v_lshrrev_b32 v27, 17, v27
M v[204:207], a[56:59], a[168:171], v[204:207]
v_lshrrev_b32 v29, 1, v27
v_and_b32 v29, 4, v29
v_and_or_b32 v27, v27, 2, v29
M v[208:211], a[64:67], a[168:171], v[208:211]
v_xor_b32 v27, v27, v25
v_lshlrev_b32 v26, 11, v26
v_lshl_add_u32 v26, v27, 4, v26
M v[208:211], a[68:71], a[172:175], v[208:211]
v_subrev_u32 v9, 3072, v26
v_add_u32 v26, 32, v28
v_mul_u32_u24 v27, 0xaaab, v26
v_lshrrev_b32 v27, 17, v27
M v[212:215], a[76:79], a[172:175], v[212:215]
v_lshrrev_b32 v29, 1, v27
v_and_b32 v29, 4, v29
v_and_or_b32 v27, v27, 2, v29
M v[212:215], a[72:75], a[168:171], v[212:215]
v_xor_b32 v27, v27, v25
v_lshlrev_b32 v26, 11, v26
v_lshl_add_u32 v26, v27, 4, v26
M v[216:219], a[80:83], a[168:171], v[216:219]
v_subrev_u32 v21, 0, v26
v_add_u32 v26, 40, v28
v_mul_u32_u24 v27, 0xaaab, v26
M v[216:219], a[84:87], a[172:175], v[216:219]
v_lshrrev_b32 v27, 17, v27
v_lshrrev_b32 v29, 1, v27
v_and_b32 v29, 4, v29
v_and_or_b32 v27, v27, 2, v29
M v[220:223], a[92:95], a[172:175], v[220:223]
v_xor_b32 v27, v27, v25
v_lshlrev_b32 v26, 11, v26
v_lshl_add_u32 v26, v27, 4, v26
M v[220:223], a[88:91], a[168:171], v[220:223]
s_waitcnt lgkmcnt(10)
v_subrev_u32 v22, 1024, v26
s_lshr_b32 s3, s53, 7
s_add_u32 s3, s3, s22
M v[224:227], a[32:35], a[176:179], v[224:227]
s_lshl_b32 s3, s3, 5
s_lshr_b32 s19, s52, 6
s_add_u32 s3, s3, s19
s_lshl_b32 s19, s21, 1
M v[224:227], a[36:39], a[180:183], v[224:227]
s_add_u32 s3, s3, s19
s_lshl_b32 s92, s3, 14
s_add_u32 s93, s92, 16384
M v[228:231], a[44:47], a[180:183], v[228:231]
s_add_u32 s16, s50, 0
s_addc_u32 s17, s51, 0
s_mov_b32 s18, 16777216
M v[228:231], a[40:43], a[176:179], v[228:231]
s_mov_b32 s19, 0x00020000
s_mov_b32 s4, 0x3e0293ee
s_mov_b32 s5, 0x3e0293ee
M v[232:235], a[48:51], a[176:179], v[232:235]
M v[232:235], a[52:55], a[180:183], v[232:235]
M v[236:239], a[60:63], a[180:183], v[236:239]
M v[236:239], a[56:59], a[176:179], v[236:239]
s_waitcnt vmcnt(4) lgkmcnt(0)
s_barrier
ds_read_b128 a[160:163], v10 offset:32768
ds_read_b128 a[164:167], v11 offset:32768
M v[240:243], a[64:67], a[176:179], v[240:243]
s_add_u32 m0, s28, 131072
s_nop 0
buffer_load_dword v20, s[8:11], s24 offen lds
M v[240:243], a[68:71], a[180:183], v[240:243]
M v[244:247], a[76:79], a[180:183], v[244:247]
M v[244:247], a[72:75], a[176:179], v[244:247]
buffer_load_dword v23, s[8:11], s24 offen offset:256 lds
M v[248:251], a[80:83], a[176:179], v[248:251]
M v[248:251], a[84:87], a[180:183], v[248:251]
M v[252:255], a[92:95], a[180:183], v[252:255]
M v[252:255], a[88:91], a[176:179], v[252:255]
M a[0:3], a[32:35], a[184:187], a[0:3]
s_add_u32 m0, s29, 133120
s_nop 0
buffer_load_dwordx4 v2, s[8:11], s23 offen offset:0 lds
M a[0:3], a[36:39], a[188:191], a[0:3]
ds_read_b128 a[168:171], v10 offset:34816
ds_read_b128 a[172:175], v11 offset:34816
M a[4:7], a[44:47], a[188:191], a[4:7]
M a[4:7], a[40:43], a[184:187], a[4:7]
M a[8:11], a[48:51], a[184:187], a[8:11]
buffer_load_dwordx4 v3, s[8:11], s23 offen offset:1024 lds
M a[8:11], a[52:55], a[188:191], a[8:11]
M a[12:15], a[60:63], a[188:191], a[12:15]
M a[12:15], a[56:59], a[184:187], a[12:15]
M a[16:19], a[64:67], a[184:187], a[16:19]
buffer_load_dwordx4 v4, s[8:11], s23 offen offset:2048 lds
M a[16:19], a[68:71], a[188:191], a[16:19]
M a[20:23], a[76:79], a[188:191], a[20:23]
M a[20:23], a[72:75], a[184:187], a[20:23]
buffer_load_dwordx4 v5, s[8:11], s23 offen offset:3072 lds
M a[24:27], a[80:83], a[184:187], a[24:27]
M a[24:27], a[84:87], a[188:191], a[24:27]
M a[28:31], a[92:95], a[188:191], a[28:31]
M a[28:31], a[88:91], a[184:187], a[28:31]
s_waitcnt lgkmcnt(2)
M v[32:35], a[96:99], a[160:163], v[32:35]
s_sub_u32 s31, s31, 1
s_cmp_eq_u32 s31, 0
s_cselect_b32 s58, -1920, s57
s_add_u32 s23, s23, s58
s_add_u32 s24, s24, s58
M v[32:35], a[100:103], a[164:167], v[32:35]
ds_read_b128 a[176:179], v10 offset:36864
ds_read_b128 a[180:183], v11 offset:36864
M v[36:39], a[108:111], a[164:167], v[36:39]
M v[36:39], a[104:107], a[160:163], v[36:39]
M v[40:43], a[112:115], a[160:163], v[40:43]
M v[40:43], a[116:119], a[164:167], v[40:43]
s_add_u32 m0, s30, 65536
s_nop 0
buffer_load_dwordx4 v6, s[12:15], s25 offen offset:0 lds
M v[44:47], a[124:127], a[164:167], v[44:47]
M v[44:47], a[120:123], a[160:163], v[44:47]
M v[48:51], a[128:131], a[160:163], v[48:51]
M v[48:51], a[132:135], a[164:167], v[48:51]
buffer_load_dwordx4 v7, s[12:15], s25 offen offset:1024 lds
M v[52:55], a[140:143], a[164:167], v[52:55]
M v[52:55], a[136:139], a[160:163], v[52:55]
M v[56:59], a[144:147], a[160:163], v[56:59]
M v[56:59], a[148:151], a[164:167], v[56:59]
buffer_load_dwordx4 v8, s[12:15], s25 offen offset:2048 lds
M v[60:63], a[156:159], a[164:167], v[60:63]
M v[60:63], a[152:155], a[160:163], v[60:63]
s_waitcnt lgkmcnt(2)
M v[64:67], a[96:99], a[168:171], v[64:67]
M v[64:67], a[100:103], a[172:175], v[64:67]
ds_read_b128 a[184:187], v10 offset:38912
ds_read_b128 a[188:191], v11 offset:38912
M v[68:71], a[108:111], a[172:175], v[68:71]
M v[68:71], a[104:107], a[168:171], v[68:71]
buffer_load_dwordx4 v9, s[12:15], s25 offen offset:3072 lds
v_pk_mul_f32 v[32:33], v[32:33], s[4:5]
v_pk_mul_f32 v[34:35], v[34:35], s[4:5]
v_pk_mul_f32 v[36:37], v[36:37], s[4:5]
M v[72:75], a[112:115], a[168:171], v[72:75]
v_pk_mul_f32 v[38:39], v[38:39], s[4:5]
v_cvt_pk_bf16_f32 v32, v32, v33
M v[72:75], a[116:119], a[172:175], v[72:75]
v_cvt_pk_bf16_f32 v33, v34, v35
v_cvt_pk_bf16_f32 v34, v36, v37
M v[76:79], a[124:127], a[172:175], v[76:79]
v_cvt_pk_bf16_f32 v35, v38, v39
v_pk_mul_f32 v[40:41], v[40:41], s[4:5]
v_pk_mul_f32 v[42:43], v[42:43], s[4:5]
M v[76:79], a[120:123], a[168:171], v[76:79]
s_add_u32 m0, s30, 69632
s_nop 0
buffer_load_dwordx4 v21, s[12:15], s25 offen offset:0 lds
v_pk_mul_f32 v[44:45], v[44:45], s[4:5]
v_pk_mul_f32 v[46:47], v[46:47], s[4:5]
M v[80:83], a[128:131], a[168:171], v[80:83]
v_cvt_pk_bf16_f32 v40, v40, v41
v_cvt_pk_bf16_f32 v41, v42, v43
M v[80:83], a[132:135], a[172:175], v[80:83]
v_cvt_pk_bf16_f32 v42, v44, v45
v_cvt_pk_bf16_f32 v43, v46, v47
M v[84:87], a[140:143], a[172:175], v[84:87]
v_pk_mul_f32 v[48:49], v[48:49], s[4:5]
v_pk_mul_f32 v[50:51], v[50:51], s[4:5]
v_pk_mul_f32 v[52:53], v[52:53], s[4:5]
M v[84:87], a[136:139], a[168:171], v[84:87]
buffer_load_dwordx4 v22, s[12:15], s25 offen offset:1024 lds
v_pk_mul_f32 v[54:55], v[54:55], s[4:5]
v_cvt_pk_bf16_f32 v48, v48, v49
M v[88:91], a[144:147], a[168:171], v[88:91]
v_cvt_pk_bf16_f32 v49, v50, v51
v_cvt_pk_bf16_f32 v50, v52, v53
M v[88:91], a[148:151], a[172:175], v[88:91]
v_cvt_pk_bf16_f32 v51, v54, v55
v_pk_mul_f32 v[56:57], v[56:57], s[4:5]
v_pk_mul_f32 v[58:59], v[58:59], s[4:5]
M v[92:95], a[156:159], a[172:175], v[92:95]
v_pk_mul_f32 v[60:61], v[60:61], s[4:5]
v_pk_mul_f32 v[62:63], v[62:63], s[4:5]
M v[92:95], a[152:155], a[168:171], v[92:95]
s_waitcnt lgkmcnt(2)
v_cvt_pk_bf16_f32 v56, v56, v57
v_cvt_pk_bf16_f32 v57, v58, v59
M v[96:99], a[96:99], a[176:179], v[96:99]
s_sub_u32 s54, s54, 1
s_cmp_eq_u32 s54, 0
s_cselect_b32 s58, s55, s56
s_add_u32 s25, s25, s58
v_cvt_pk_bf16_f32 v58, v60, v61
v_cvt_pk_bf16_f32 v59, v62, v63
M v[96:99], a[100:103], a[180:183], v[96:99]
M v[100:103], a[108:111], a[180:183], v[100:103]
M v[100:103], a[104:107], a[176:179], v[100:103]
v_pk_mul_f32 v[64:65], v[64:65], s[4:5]
v_pk_mul_f32 v[66:67], v[66:67], s[4:5]
v_pk_mul_f32 v[68:69], v[68:69], s[4:5]
M v[104:107], a[112:115], a[176:179], v[104:107]
s_add_u32 s94, s92, 0
buffer_store_dwordx4 v[32:35], v1, s[16:19], s94 offen offset:0 sc1
v_pk_mul_f32 v[70:71], v[70:71], s[4:5]
v_cvt_pk_bf16_f32 v64, v64, v65
M v[104:107], a[116:119], a[180:183], v[104:107]
v_cvt_pk_bf16_f32 v65, v66, v67
v_cvt_pk_bf16_f32 v66, v68, v69
M v[108:111], a[124:127], a[180:183], v[108:111]
v_cvt_pk_bf16_f32 v67, v70, v71
v_pk_mul_f32 v[72:73], v[72:73], s[4:5]
v_pk_mul_f32 v[74:75], v[74:75], s[4:5]
M v[108:111], a[120:123], a[176:179], v[108:111]
s_waitcnt vmcnt(13) lgkmcnt(0)
s_barrier
ds_read_b128 a[160:163], v10 offset:49152
ds_read_b128 a[164:167], v11 offset:49152
v_pk_mul_f32 v[76:77], v[76:77], s[4:5]
v_pk_mul_f32 v[78:79], v[78:79], s[4:5]
M v[112:115], a[128:131], a[176:179], v[112:115]
s_add_u32 m0, s28, 0
s_nop 0
buffer_load_dword v20, s[8:11], s24 offen lds
v_cvt_pk_bf16_f32 v72, v72, v73
v_cvt_pk_bf16_f32 v73, v74, v75
M v[112:115], a[132:135], a[180:183], v[112:115]
v_cvt_pk_bf16_f32 v74, v76, v77
v_cvt_pk_bf16_f32 v75, v78, v79
M v[116:119], a[140:143], a[180:183], v[116:119]
s_add_u32 s94, s92, 0
buffer_store_dwordx4 v[40:43], v1, s[16:19], s94 offen offset:1024 sc1
v_pk_mul_f32 v[80:81], v[80:81], s[4:5]
v_pk_mul_f32 v[82:83], v[82:83], s[4:5]
v_pk_mul_f32 v[84:85], v[84:85], s[4:5]
M v[116:119], a[136:139], a[176:179], v[116:119]
v_pk_mul_f32 v[86:87], v[86:87], s[4:5]
v_cvt_pk_bf16_f32 v80, v80, v81
M v[120:123], a[144:147], a[176:179], v[120:123]
buffer_load_dword v23, s[8:11], s24 offen offset:256 lds
v_cvt_pk_bf16_f32 v81, v82, v83
v_cvt_pk_bf16_f32 v82, v84, v85
M v[120:123], a[148:151], a[180:183], v[120:123]
v_cvt_pk_bf16_f32 v83, v86, v87
v_pk_mul_f32 v[88:89], v[88:89], s[4:5]
v_pk_mul_f32 v[90:91], v[90:91], s[4:5]
M v[124:127], a[156:159], a[180:183], v[124:127]
v_pk_mul_f32 v[92:93], v[92:93], s[4:5]
v_pk_mul_f32 v[94:95], v[94:95], s[4:5]
M v[124:127], a[152:155], a[176:179], v[124:127]
v_cvt_pk_bf16_f32 v88, v88, v89
v_cvt_pk_bf16_f32 v89, v90, v91
M v[128:131], a[96:99], a[184:187], v[128:131]
s_add_u32 m0, s29, 2048
s_nop 0
buffer_load_dwordx4 v2, s[8:11], s23 offen offset:0 lds
v_cvt_pk_bf16_f32 v90, v92, v93
v_cvt_pk_bf16_f32 v91, v94, v95
M v[128:131], a[100:103], a[188:191], v[128:131]
ds_read_b128 a[168:171], v10 offset:51200
ds_read_b128 a[172:175], v11 offset:51200
M v[132:135], a[108:111], a[188:191], v[132:135]
s_add_u32 s94, s92, 0
buffer_store_dwordx4 v[48:51], v1, s[16:19], s94 offen offset:2048 sc1
M v[132:135], a[104:107], a[184:187], v[132:135]
v_pk_mul_f32 v[96:97], v[96:97], s[4:5]
v_pk_mul_f32 v[98:99], v[98:99], s[4:5]
v_pk_mul_f32 v[100:101], v[100:101], s[4:5]
M v[136:139], a[112:115], a[184:187], v[136:139]
v_pk_mul_f32 v[102:103], v[102:103], s[4:5]
v_cvt_pk_bf16_f32 v96, v96, v97
M v[136:139], a[116:119], a[188:191], v[136:139]
buffer_load_dwordx4 v3, s[8:11], s23 offen offset:1024 lds
v_cvt_pk_bf16_f32 v97, v98, v99
v_cvt_pk_bf16_f32 v98, v100, v101
M v[140:143], a[124:127], a[188:191], v[140:143]
v_cvt_pk_bf16_f32 v99, v102, v103
v_pk_mul_f32 v[104:105], v[104:105], s[4:5]
v_pk_mul_f32 v[106:107], v[106:107], s[4:5]
M v[140:143], a[120:123], a[184:187], v[140:143]
v_pk_mul_f32 v[108:109], v[108:109], s[4:5]
v_pk_mul_f32 v[110:111], v[110:111], s[4:5]
M v[144:147], a[128:131], a[184:187], v[144:147]
s_add_u32 s94, s92, 0
buffer_store_dwordx4 v[56:59], v1, s[16:19], s94 offen offset:3072 sc1
v_cvt_pk_bf16_f32 v104, v104, v105
v_cvt_pk_bf16_f32 v105, v106, v107
M v[144:147], a[132:135], a[188:191], v[144:147]
v_cvt_pk_bf16_f32 v106, v108, v109
v_cvt_pk_bf16_f32 v107, v110, v111
M v[148:151], a[140:143], a[188:191], v[148:151]
buffer_load_dwordx4 v4, s[8:11], s23 offen offset:2048 lds
v_pk_mul_f32 v[112:113], v[112:113], s[4:5]
v_pk_mul_f32 v[114:115], v[114:115], s[4:5]
v_pk_mul_f32 v[116:117], v[116:117], s[4:5]
M v[148:151], a[136:139], a[184:187], v[148:151]
v_pk_mul_f32 v[118:119], v[118:119], s[4:5]
v_cvt_pk_bf16_f32 v112, v112, v113
M v[152:155], a[144:147], a[184:187], v[152:155]
v_cvt_pk_bf16_f32 v113, v114, v115
v_cvt_pk_bf16_f32 v114, v116, v117
M v[152:155], a[148:151], a[188:191], v[152:155]
buffer_load_dwordx4 v5, s[8:11], s23 offen offset:3072 lds
v_cvt_pk_bf16_f32 v115, v118, v119
v_pk_mul_f32 v[120:121], v[120:121], s[4:5]
v_pk_mul_f32 v[122:123], v[122:123], s[4:5]
M v[156:159], a[156:159], a[188:191], v[156:159]
v_pk_mul_f32 v[124:125], v[124:125], s[4:5]
v_pk_mul_f32 v[126:127], v[126:127], s[4:5]
M v[156:159], a[152:155], a[184:187], v[156:159]
s_add_u32 s94, s92, 4096
buffer_store_dwordx4 v[64:67], v1, s[16:19], s94 offen offset:0 sc1
s_waitcnt lgkmcnt(2)
v_cvt_pk_bf16_f32 v120, v120, v121
v_cvt_pk_bf16_f32 v121, v122, v123
M v[160:163], a[96:99], a[160:163], v[160:163]
v_cvt_pk_bf16_f32 v122, v124, v125
v_cvt_pk_bf16_f32 v123, v126, v127
M v[160:163], a[100:103], a[164:167], v[160:163]
ds_read_b128 a[176:179], v10 offset:53248
ds_read_b128 a[180:183], v11 offset:53248
M v[164:167], a[108:111], a[164:167], v[164:167]
s_sub_u32 s31, s31, 1
s_cmp_eq_u32 s31, 0
s_cselect_b32 s58, -1920, s57
s_add_u32 s23, s23, s58
s_add_u32 s24, s24, s58
M v[164:167], a[104:107], a[160:163], v[164:167]
v_pk_mul_f32 v[128:129], v[128:129], s[4:5]
v_pk_mul_f32 v[130:131], v[130:131], s[4:5]
v_pk_mul_f32 v[132:133], v[132:133], s[4:5]
M v[168:171], a[112:115], a[160:163], v[168:171]
v_pk_mul_f32 v[134:135], v[134:135], s[4:5]
v_cvt_pk_bf16_f32 v128, v128, v129
M v[168:171], a[116:119], a[164:167], v[168:171]
s_add_u32 s94, s92, 4096
buffer_store_dwordx4 v[72:75], v1, s[16:19], s94 offen offset:1024 sc1
v_cvt_pk_bf16_f32 v129, v130, v131
v_cvt_pk_bf16_f32 v130, v132, v133
M v[172:175], a[124:127], a[164:167], v[172:175]
v_cvt_pk_bf16_f32 v131, v134, v135
v_pk_mul_f32 v[136:137], v[136:137], s[4:5]
v_pk_mul_f32 v[138:139], v[138:139], s[4:5]
M v[172:175], a[120:123], a[160:163], v[172:175]
s_add_u32 m0, s30, 98304
s_nop 0
buffer_load_dwordx4 v6, s[12:15], s25 offen offset:0 lds
v_pk_mul_f32 v[140:141], v[140:141], s[4:5]
v_pk_mul_f32 v[142:143], v[142:143], s[4:5]
M v[176:179], a[128:131], a[160:163], v[176:179]
v_cvt_pk_bf16_f32 v136, v136, v137
v_cvt_pk_bf16_f32 v137, v138, v139
M v[176:179], a[132:135], a[164:167], v[176:179]
v_cvt_pk_bf16_f32 v138, v140, v141
v_cvt_pk_bf16_f32 v139, v142, v143
M v[180:183], a[140:143], a[164:167], v[180:183]
buffer_load_dwordx4 v7, s[12:15], s25 offen offset:1024 lds
v_pk_mul_f32 v[144:145], v[144:145], s[4:5]
v_pk_mul_f32 v[146:147], v[146:147], s[4:5]
v_pk_mul_f32 v[148:149], v[148:149], s[4:5]
M v[180:183], a[136:139], a[160:163], v[180:183]
v_pk_mul_f32 v[150:151], v[150:151], s[4:5]
v_cvt_pk_bf16_f32 v144, v144, v145
M v[184:187], a[144:147], a[160:163], v[184:187]
s_add_u32 s94, s92, 4096
buffer_store_dwordx4 v[80:83], v1, s[16:19], s94 offen offset:2048 sc1
v_cvt_pk_bf16_f32 v145, v146, v147
v_cvt_pk_bf16_f32 v146, v148, v149
M v[184:187], a[148:151], a[164:167], v[184:187]
v_cvt_pk_bf16_f32 v147, v150, v151
v_pk_mul_f32 v[152:153], v[152:153], s[4:5]
v_pk_mul_f32 v[154:155], v[154:155], s[4:5]
M v[188:191], a[156:159], a[164:167], v[188:191]
buffer_load_dwordx4 v8, s[12:15], s25 offen offset:2048 lds
v_pk_mul_f32 v[156:157], v[156:157], s[4:5]
v_pk_mul_f32 v[158:159], v[158:159], s[4:5]
M v[188:191], a[152:155], a[160:163], v[188:191]
s_waitcnt lgkmcnt(2)
v_cvt_pk_bf16_f32 v152, v152, v153
v_cvt_pk_bf16_f32 v153, v154, v155
M v[192:195], a[96:99], a[168:171], v[192:195]
v_cvt_pk_bf16_f32 v154, v156, v157
v_cvt_pk_bf16_f32 v155, v158, v159
M v[192:195], a[100:103], a[172:175], v[192:195]
ds_read_b128 a[184:187], v10 offset:55296
ds_read_b128 a[188:191], v11 offset:55296
M v[196:199], a[108:111], a[172:175], v[196:199]
M v[196:199], a[104:107], a[168:171], v[196:199]
s_add_u32 s94, s92, 4096
buffer_store_dwordx4 v[88:91], v1, s[16:19], s94 offen offset:3072 sc1
v_pk_mul_f32 v[160:161], v[160:161], s[4:5]
v_pk_mul_f32 v[162:163], v[162:163], s[4:5]
v_pk_mul_f32 v[164:165], v[164:165], s[4:5]
M v[200:203], a[112:115], a[168:171], v[200:203]
buffer_load_dwordx4 v9, s[12:15], s25 offen offset:3072 lds
v_pk_mul_f32 v[166:167], v[166:167], s[4:5]
v_cvt_pk_bf16_f32 v160, v160, v161
M v[200:203], a[116:119], a[172:175], v[200:203]
v_cvt_pk_bf16_f32 v161, v162, v163
v_cvt_pk_bf16_f32 v162, v164, v165
M v[204:207], a[124:127], a[172:175], v[204:207]
v_cvt_pk_bf16_f32 v163, v166, v167
v_pk_mul_f32 v[168:169], v[168:169], s[4:5]
v_pk_mul_f32 v[170:171], v[170:171], s[4:5]
M v[204:207], a[120:123], a[168:171], v[204:207]
v_pk_mul_f32 v[172:173], v[172:173], s[4:5]
v_pk_mul_f32 v[174:175], v[174:175], s[4:5]
M v[208:211], a[128:131], a[168:171], v[208:211]
s_add_u32 m0, s30, 102400
s_nop 0
buffer_load_dwordx4 v21, s[12:15], s25 offen offset:0 lds
v_cvt_pk_bf16_f32 v168, v168, v169
v_cvt_pk_bf16_f32 v169, v170, v171
M v[208:211], a[132:135], a[172:175], v[208:211]
v_cvt_pk_bf16_f32 v170, v172, v173
v_cvt_pk_bf16_f32 v171, v174, v175
M v[212:215], a[140:143], a[172:175], v[212:215]
s_add_u32 s94, s92, 8192
buffer_store_dwordx4 v[96:99], v1, s[16:19], s94 offen offset:0 sc1
v_pk_mul_f32 v[176:177], v[176:177], s[4:5]
v_pk_mul_f32 v[178:179], v[178:179], s[4:5]
v_pk_mul_f32 v[180:181], v[180:181], s[4:5]
M v[212:215], a[136:139], a[168:171], v[212:215]
v_pk_mul_f32 v[182:183], v[182:183], s[4:5]
v_cvt_pk_bf16_f32 v176, v176, v177
M v[216:219], a[144:147], a[168:171], v[216:219]
buffer_load_dwordx4 v22, s[12:15], s25 offen offset:1024 lds
v_cvt_pk_bf16_f32 v177, v178, v179
v_cvt_pk_bf16_f32 v178, v180, v181
M v[216:219], a[148:151], a[172:175], v[216:219]
v_cvt_pk_bf16_f32 v179, v182, v183
v_pk_mul_f32 v[184:185], v[184:185], s[4:5]
v_pk_mul_f32 v[186:187], v[186:187], s[4:5]
M v[220:223], a[156:159], a[172:175], v[220:223]
v_pk_mul_f32 v[188:189], v[188:189], s[4:5]
v_pk_mul_f32 v[190:191], v[190:191], s[4:5]
M v[220:223], a[152:155], a[168:171], v[220:223]
s_waitcnt lgkmcnt(2)
v_cvt_pk_bf16_f32 v184, v184, v185
v_cvt_pk_bf16_f32 v185, v186, v187
M v[224:227], a[96:99], a[176:179], v[224:227]
s_add_u32 s94, s92, 8192
buffer_store_dwordx4 v[104:107], v1, s[16:19], s94 offen offset:1024 sc1
v_cvt_pk_bf16_f32 v186, v188, v189
v_cvt_pk_bf16_f32 v187, v190, v191
M v[224:227], a[100:103], a[180:183], v[224:227]
s_sub_u32 s54, s54, 1
s_cmp_eq_u32 s54, 0
s_cselect_b32 s58, s55, s56
s_add_u32 s25, s25, s58
M v[228:231], a[108:111], a[180:183], v[228:231]
M v[228:231], a[104:107], a[176:179], v[228:231]
v_pk_mul_f32 v[192:193], v[192:193], s[4:5]
v_pk_mul_f32 v[194:195], v[194:195], s[4:5]
v_pk_mul_f32 v[196:197], v[196:197], s[4:5]
M v[232:235], a[112:115], a[176:179], v[232:235]
v_pk_mul_f32 v[198:199], v[198:199], s[4:5]
v_cvt_pk_bf16_f32 v192, v192, v193
M v[232:235], a[116:119], a[180:183], v[232:235]
v_cvt_pk_bf16_f32 v193, v194, v195
v_cvt_pk_bf16_f32 v194, v196, v197
M v[236:239], a[124:127], a[180:183], v[236:239]
v_cvt_pk_bf16_f32 v195, v198, v199
v_pk_mul_f32 v[200:201], v[200:201], s[4:5]
v_pk_mul_f32 v[202:203], v[202:203], s[4:5]
M v[236:239], a[120:123], a[176:179], v[236:239]
s_waitcnt vmcnt(63) lgkmcnt(0)
s_barrier
v_pk_mul_f32 v[204:205], v[204:205], s[4:5]
v_pk_mul_f32 v[206:207], v[206:207], s[4:5]
M v[240:243], a[128:131], a[176:179], v[240:243]
s_add_u32 s94, s92, 8192
buffer_store_dwordx4 v[112:115], v1, s[16:19], s94 offen offset:2048 sc1
v_cvt_pk_bf16_f32 v200, v200, v201
v_cvt_pk_bf16_f32 v201, v202, v203
M v[240:243], a[132:135], a[180:183], v[240:243]
s_add_u32 m0, s28, 18432
s_nop 0
buffer_load_dword v20, s[8:11], s24 offen lds
v_cvt_pk_bf16_f32 v202, v204, v205
v_cvt_pk_bf16_f32 v203, v206, v207
M v[244:247], a[140:143], a[180:183], v[244:247]
v_pk_mul_f32 v[208:209], v[208:209], s[4:5]
v_pk_mul_f32 v[210:211], v[210:211], s[4:5]
v_pk_mul_f32 v[212:213], v[212:213], s[4:5]
M v[244:247], a[136:139], a[176:179], v[244:247]
v_pk_mul_f32 v[214:215], v[214:215], s[4:5]
v_cvt_pk_bf16_f32 v208, v208, v209
M v[248:251], a[144:147], a[176:179], v[248:251]
buffer_load_dword v23, s[8:11], s24 offen offset:256 lds
v_cvt_pk_bf16_f32 v209, v210, v211
v_cvt_pk_bf16_f32 v210, v212, v213
M v[248:251], a[148:151], a[180:183], v[248:251]
v_cvt_pk_bf16_f32 v211, v214, v215
v_pk_mul_f32 v[216:217], v[216:217], s[4:5]
v_pk_mul_f32 v[218:219], v[218:219], s[4:5]
M v[252:255], a[156:159], a[180:183], v[252:255]
s_add_u32 s94, s92, 8192
buffer_store_dwordx4 v[120:123], v1, s[16:19], s94 offen offset:3072 sc1
v_pk_mul_f32 v[220:221], v[220:221], s[4:5]
v_pk_mul_f32 v[222:223], v[222:223], s[4:5]
M v[252:255], a[152:155], a[176:179], v[252:255]
v_cvt_pk_bf16_f32 v216, v216, v217
v_cvt_pk_bf16_f32 v217, v218, v219
M a[0:3], a[96:99], a[184:187], a[0:3]
v_cvt_pk_bf16_f32 v218, v220, v221
v_cvt_pk_bf16_f32 v219, v222, v223
M a[0:3], a[100:103], a[188:191], a[0:3]
s_add_u32 m0, s29, 20480
s_nop 0
buffer_load_dwordx4 v2, s[8:11], s23 offen offset:0 lds
M a[4:7], a[108:111], a[188:191], a[4:7]
M a[4:7], a[104:107], a[184:187], a[4:7]
v_pk_mul_f32 v[224:225], v[224:225], s[4:5]
v_pk_mul_f32 v[226:227], v[226:227], s[4:5]
v_pk_mul_f32 v[228:229], v[228:229], s[4:5]
M a[8:11], a[112:115], a[184:187], a[8:11]
buffer_load_dwordx4 v3, s[8:11], s23 offen offset:1024 lds
v_pk_mul_f32 v[230:231], v[230:231], s[4:5]
v_cvt_pk_bf16_f32 v224, v224, v225
M a[8:11], a[116:119], a[188:191], a[8:11]
s_add_u32 s94, s92, 12288
buffer_store_dwordx4 v[128:131], v1, s[16:19], s94 offen offset:0 sc1
v_cvt_pk_bf16_f32 v225, v226, v227
v_cvt_pk_bf16_f32 v226, v228, v229
M a[12:15], a[124:127], a[188:191], a[12:15]
v_cvt_pk_bf16_f32 v227, v230, v231
v_pk_mul_f32 v[232:233], v[232:233], s[4:5]
v_pk_mul_f32 v[234:235], v[234:235], s[4:5]
M a[12:15], a[120:123], a[184:187], a[12:15]
v_pk_mul_f32 v[236:237], v[236:237], s[4:5]
v_pk_mul_f32 v[238:239], v[238:239], s[4:5]
M a[16:19], a[128:131], a[184:187], a[16:19]
buffer_load_dwordx4 v4, s[8:11], s23 offen offset:2048 lds
v_cvt_pk_bf16_f32 v232, v232, v233
v_cvt_pk_bf16_f32 v233, v234, v235
M a[16:19], a[132:135], a[188:191], a[16:19]
v_cvt_pk_bf16_f32 v234, v236, v237
v_cvt_pk_bf16_f32 v235, v238, v239
M a[20:23], a[140:143], a[188:191], a[20:23]
v_pk_mul_f32 v[240:241], v[240:241], s[4:5]
v_pk_mul_f32 v[242:243], v[242:243], s[4:5]
v_pk_mul_f32 v[244:245], v[244:245], s[4:5]
M a[20:23], a[136:139], a[184:187], a[20:23]
buffer_load_dwordx4 v5, s[8:11], s23 offen offset:3072 lds
v_pk_mul_f32 v[246:247], v[246:247], s[4:5]
v_cvt_pk_bf16_f32 v240, v240, v241
M a[24:27], a[144:147], a[184:187], a[24:27]
s_add_u32 s94, s92, 12288
buffer_store_dwordx4 v[136:139], v1, s[16:19], s94 offen offset:1024 sc1
v_cvt_pk_bf16_f32 v241, v242, v243
v_cvt_pk_bf16_f32 v242, v244, v245
M a[24:27], a[148:151], a[188:191], a[24:27]
v_cvt_pk_bf16_f32 v243, v246, v247
v_pk_mul_f32 v[248:249], v[248:249], s[4:5]
v_pk_mul_f32 v[250:251], v[250:251], s[4:5]
M a[28:31], a[156:159], a[188:191], a[28:31]
v_pk_mul_f32 v[252:253], v[252:253], s[4:5]
v_pk_mul_f32 v[254:255], v[254:255], s[4:5]
M a[28:31], a[152:155], a[184:187], a[28:31]
v_cvt_pk_bf16_f32 v248, v248, v249
v_cvt_pk_bf16_f32 v249, v250, v251
v_cvt_pk_bf16_f32 v250, v252, v253
v_cvt_pk_bf16_f32 v251, v254, v255
v_accvgpr_read_b32 v24, a0
v_accvgpr_read_b32 v25, a1
v_accvgpr_read_b32 v26, a2
v_accvgpr_read_b32 v27, a3
v_accvgpr_read_b32 v28, a4
v_accvgpr_read_b32 v29, a5
v_accvgpr_read_b32 v30, a6
v_accvgpr_read_b32 v31, a7
v_pk_mul_f32 v[24:25], v[24:25], s[4:5]
v_pk_mul_f32 v[26:27], v[26:27], s[4:5]
v_pk_mul_f32 v[28:29], v[28:29], s[4:5]
v_pk_mul_f32 v[30:31], v[30:31], s[4:5]
v_cvt_pk_bf16_f32 v36, v24, v25
v_cvt_pk_bf16_f32 v37, v26, v27
v_cvt_pk_bf16_f32 v38, v28, v29
v_cvt_pk_bf16_f32 v39, v30, v31
v_accvgpr_read_b32 v24, a8
v_accvgpr_read_b32 v25, a9
v_accvgpr_read_b32 v26, a10
v_accvgpr_read_b32 v27, a11
v_accvgpr_read_b32 v28, a12
v_accvgpr_read_b32 v29, a13
v_accvgpr_read_b32 v30, a14
v_accvgpr_read_b32 v31, a15
v_pk_mul_f32 v[24:25], v[24:25], s[4:5]
v_pk_mul_f32 v[26:27], v[26:27], s[4:5]
v_pk_mul_f32 v[28:29], v[28:29], s[4:5]
v_pk_mul_f32 v[30:31], v[30:31], s[4:5]
v_cvt_pk_bf16_f32 v44, v24, v25
v_cvt_pk_bf16_f32 v45, v26, v27
v_cvt_pk_bf16_f32 v46, v28, v29
v_cvt_pk_bf16_f32 v47, v30, v31
v_accvgpr_read_b32 v24, a16
v_accvgpr_read_b32 v25, a17
v_accvgpr_read_b32 v26, a18
v_accvgpr_read_b32 v27, a19
v_accvgpr_read_b32 v28, a20
v_accvgpr_read_b32 v29, a21
v_accvgpr_read_b32 v30, a22
v_accvgpr_read_b32 v31, a23
v_pk_mul_f32 v[24:25], v[24:25], s[4:5]
v_pk_mul_f32 v[26:27], v[26:27], s[4:5]
v_pk_mul_f32 v[28:29], v[28:29], s[4:5]
v_pk_mul_f32 v[30:31], v[30:31], s[4:5]
v_cvt_pk_bf16_f32 v52, v24, v25
v_cvt_pk_bf16_f32 v53, v26, v27
v_cvt_pk_bf16_f32 v54, v28, v29
v_cvt_pk_bf16_f32 v55, v30, v31
v_accvgpr_read_b32 v24, a24
v_accvgpr_read_b32 v25, a25
v_accvgpr_read_b32 v26, a26
v_accvgpr_read_b32 v27, a27
v_accvgpr_read_b32 v28, a28
v_accvgpr_read_b32 v29, a29
v_accvgpr_read_b32 v30, a30
v_accvgpr_read_b32 v31, a31
v_pk_mul_f32 v[24:25], v[24:25], s[4:5]
v_pk_mul_f32 v[26:27], v[26:27], s[4:5]
v_pk_mul_f32 v[28:29], v[28:29], s[4:5]
v_pk_mul_f32 v[30:31], v[30:31], s[4:5]
v_cvt_pk_bf16_f32 v60, v24, v25
v_cvt_pk_bf16_f32 v61, v26, v27
v_cvt_pk_bf16_f32 v62, v28, v29
v_cvt_pk_bf16_f32 v63, v30, v31
s_branch Lk1_b
Lk1_spin:
s_add_u32 s40, s40, 1
s_cmp_gt_u32 s40, 1048576
s_cbranch_scc1 Lk1_got
s_sleep 2
buffer_load_dword v126, v119, s[36:39], 0 offen offset:128 sc1
s_waitcnt vmcnt(0)
v_cmp_gt_u32 vcc, 0x80, v126
s_nop 0
s_cbranch_vccnz Lk1_spin
s_branch Lk1_got
Lk1_spinq:
s_add_u32 s40, s40, 1
s_cmp_gt_u32 s40, 1048576
s_cbranch_scc1 Lk1_gotq
s_sleep 2
buffer_load_dword v125, v119, s[36:39], 0 offen offset:0 sc1
s_waitcnt vmcnt(0)
v_cmp_gt_u32 vcc, 0x80, v125
s_nop 0
s_cbranch_vccnz Lk1_spinq
s_branch Lk1_gotq
Lk1_kv:
s_mov_b64 s[60:61], s[40:41]
s_mov_b32 s62, 4194304
s_and_b32 s3, s2, 127
s_lshl_b32 s3, s3, 2
s_add_u32 s3, s3, s20
s_mul_i32 s54, s3, 1024
M v[32:35], a[32:35], a[160:163], 0
s_add_u32 m0, s29, 32768
s_nop 0
buffer_load_dwordx4 v2, s[8:11], s23 offen offset:0 lds
M v[32:35], a[36:39], a[164:167], v[32:35]
ds_read_b128 a[176:179], v10 offset:4096
ds_read_b128 a[180:183], v11 offset:4096
M v[36:39], a[44:47], a[164:167], 0
M v[36:39], a[40:43], a[160:163], v[36:39]
ds_read_b64_tr_b16 a[96:97], v12 offset:32768
ds_read_b64_tr_b16 a[98:99], v12 offset:34816
M v[40:43], a[48:51], a[160:163], 0
M v[40:43], a[52:55], a[164:167], v[40:43]
buffer_load_dwordx4 v3, s[8:11], s23 offen offset:1024 lds
M v[44:47], a[60:63], a[164:167], 0
M v[44:47], a[56:59], a[160:163], v[44:47]
ds_read_b64_tr_b16 a[104:105], v13 offset:32768
ds_read_b64_tr_b16 a[106:107], v13 offset:34816
M v[48:51], a[64:67], a[160:163], 0
M v[48:51], a[68:71], a[164:167], v[48:51]
buffer_load_dwordx4 v4, s[8:11], s23 offen offset:2048 lds
M v[52:55], a[76:79], a[164:167], 0
M v[52:55], a[72:75], a[160:163], v[52:55]
ds_read_b64_tr_b16 a[112:113], v14 offset:32768
ds_read_b64_tr_b16 a[114:115], v14 offset:34816
M v[56:59], a[80:83], a[160:163], 0
M v[56:59], a[84:87], a[164:167], v[56:59]
buffer_load_dwordx4 v5, s[8:11], s23 offen offset:3072 lds
M v[60:63], a[92:95], a[164:167], 0
M v[60:63], a[88:91], a[160:163], v[60:63]
ds_read_b64_tr_b16 a[120:121], v15 offset:32768
ds_read_b64_tr_b16 a[122:123], v15 offset:34816
M v[64:67], a[32:35], a[168:171], 0
M v[64:67], a[36:39], a[172:175], v[64:67]
ds_read_b128 a[184:187], v10 offset:6144
ds_read_b128 a[188:191], v11 offset:6144
M v[68:71], a[44:47], a[172:175], 0
s_add_u32 m0, s29, 65536
s_nop 0
buffer_load_dwordx4 v6, s[12:15], s24 offen offset:0 lds
M v[68:71], a[40:43], a[168:171], v[68:71]
ds_read_b64_tr_b16 a[128:129], v16 offset:32768
ds_read_b64_tr_b16 a[130:131], v16 offset:34816
M v[72:75], a[48:51], a[168:171], 0
M v[72:75], a[52:55], a[172:175], v[72:75]
M v[76:79], a[60:63], a[172:175], 0
buffer_load_dwordx4 v7, s[12:15], s24 offen offset:1024 lds
M v[76:79], a[56:59], a[168:171], v[76:79]
ds_read_b64_tr_b16 a[136:137], v17 offset:32768
ds_read_b64_tr_b16 a[138:139], v17 offset:34816
M v[80:83], a[64:67], a[168:171], 0
M v[80:83], a[68:71], a[172:175], v[80:83]
M v[84:87], a[76:79], a[172:175], 0
buffer_load_dwordx4 v8, s[12:15], s24 offen offset:2048 lds
M v[84:87], a[72:75], a[168:171], v[84:87]
ds_read_b64_tr_b16 a[144:145], v18 offset:32768
ds_read_b64_tr_b16 a[146:147], v18 offset:34816
M v[88:91], a[80:83], a[168:171], 0
M v[88:91], a[84:87], a[172:175], v[88:91]
M v[92:95], a[92:95], a[172:175], 0
buffer_load_dwordx4 v9, s[12:15], s24 offen offset:3072 lds
M v[92:95], a[88:91], a[168:171], v[92:95]
s_waitcnt lgkmcnt(15)
ds_read_b64_tr_b16 a[152:153], v19 offset:32768
ds_read_b64_tr_b16 a[154:155], v19 offset:34816
M v[96:99], a[32:35], a[176:179], 0
M v[96:99], a[36:39], a[180:183], v[96:99]
M v[100:103], a[44:47], a[180:183], 0
s_add_u32 s24, s24, 262144
M v[100:103], a[40:43], a[176:179], v[100:103]
M v[104:107], a[48:51], a[176:179], 0
M v[104:107], a[52:55], a[180:183], v[104:107]
M v[108:111], a[60:63], a[180:183], 0
M v[108:111], a[56:59], a[176:179], v[108:111]
s_waitcnt vmcnt(9) lgkmcnt(0)
s_barrier
ds_read_b128 a[160:163], v10 offset:16384
ds_read_b128 a[164:167], v11 offset:16384
M v[112:115], a[64:67], a[176:179], 0
s_add_u32 m0, s29, 49152
s_add_u32 s3, s23, s31
buffer_load_dwordx4 v2, s[8:11], s3 offen offset:0 lds
M v[112:115], a[68:71], a[180:183], v[112:115]
M v[116:119], a[76:79], a[180:183], 0
M v[116:119], a[72:75], a[176:179], v[116:119]
ds_read_b64_tr_b16 a[100:101], v12 offset:49152
ds_read_b64_tr_b16 a[102:103], v12 offset:51200
M v[120:123], a[80:83], a[176:179], 0
M v[120:123], a[84:87], a[180:183], v[120:123]
buffer_load_dwordx4 v3, s[8:11], s3 offen offset:1024 lds
M v[124:127], a[92:95], a[180:183], 0
M v[124:127], a[88:91], a[176:179], v[124:127]
M v[128:131], a[32:35], a[184:187], 0
M v[128:131], a[36:39], a[188:191], v[128:131]
ds_read_b128 a[168:171], v10 offset:18432
ds_read_b128 a[172:175], v11 offset:18432
ds_read_b64_tr_b16 a[108:109], v13 offset:49152
ds_read_b64_tr_b16 a[110:111], v13 offset:51200
M v[132:135], a[44:47], a[188:191], 0
M v[132:135], a[40:43], a[184:187], v[132:135]
M v[136:139], a[48:51], a[184:187], 0
buffer_load_dwordx4 v4, s[8:11], s3 offen offset:2048 lds
M v[136:139], a[52:55], a[188:191], v[136:139]
M v[140:143], a[60:63], a[188:191], 0
M v[140:143], a[56:59], a[184:187], v[140:143]
ds_read_b64_tr_b16 a[116:117], v14 offset:49152
ds_read_b64_tr_b16 a[118:119], v14 offset:51200
M v[144:147], a[64:67], a[184:187], 0
M v[144:147], a[68:71], a[188:191], v[144:147]
M v[148:151], a[76:79], a[188:191], 0
buffer_load_dwordx4 v5, s[8:11], s3 offen offset:3072 lds
M v[148:151], a[72:75], a[184:187], v[148:151]
M v[152:155], a[80:83], a[184:187], 0
M v[152:155], a[84:87], a[188:191], v[152:155]
ds_read_b64_tr_b16 a[124:125], v15 offset:49152
ds_read_b64_tr_b16 a[126:127], v15 offset:51200
M v[156:159], a[92:95], a[188:191], 0
M v[156:159], a[88:91], a[184:187], v[156:159]
s_waitcnt lgkmcnt(10)
M v[160:163], a[32:35], a[160:163], 0
M v[160:163], a[36:39], a[164:167], v[160:163]
ds_read_b128 a[176:179], v10 offset:20480
ds_read_b128 a[180:183], v11 offset:20480
M v[164:167], a[44:47], a[164:167], 0
s_add_u32 s23, s23, 128
s_cmp_eq_u32 s23, s25
s_cselect_b32 s23, s26, s23
M v[164:167], a[40:43], a[160:163], v[164:167]
ds_read_b64_tr_b16 a[132:133], v16 offset:49152
ds_read_b64_tr_b16 a[134:135], v16 offset:51200
M v[168:171], a[48:51], a[160:163], 0
M v[168:171], a[52:55], a[164:167], v[168:171]
M v[172:175], a[60:63], a[164:167], 0
M v[172:175], a[56:59], a[160:163], v[172:175]
M v[176:179], a[64:67], a[160:163], 0
s_add_u32 m0, s29, 81920
s_nop 0
buffer_load_dwordx4 v6, s[12:15], s24 offen offset:0 lds
M v[176:179], a[68:71], a[164:167], v[176:179]
ds_read_b64_tr_b16 a[140:141], v17 offset:49152
ds_read_b64_tr_b16 a[142:143], v17 offset:51200
M v[180:183], a[76:79], a[164:167], 0
M v[180:183], a[72:75], a[160:163], v[180:183]
M v[184:187], a[80:83], a[160:163], 0
M v[184:187], a[84:87], a[164:167], v[184:187]
buffer_load_dwordx4 v7, s[12:15], s24 offen offset:1024 lds
M v[188:191], a[92:95], a[164:167], 0
M v[188:191], a[88:91], a[160:163], v[188:191]
s_waitcnt lgkmcnt(12)
ds_read_b64_tr_b16 a[148:149], v18 offset:49152
ds_read_b64_tr_b16 a[150:151], v18 offset:51200
M v[192:195], a[32:35], a[168:171], 0
M v[192:195], a[36:39], a[172:175], v[192:195]
ds_read_b128 a[184:187], v10 offset:22528
ds_read_b128 a[188:191], v11 offset:22528
M v[196:199], a[44:47], a[172:175], 0
M v[196:199], a[40:43], a[168:171], v[196:199]
M v[200:203], a[48:51], a[168:171], 0
buffer_load_dwordx4 v8, s[12:15], s24 offen offset:2048 lds
M v[200:203], a[52:55], a[172:175], v[200:203]
ds_read_b64_tr_b16 a[156:157], v19 offset:49152
ds_read_b64_tr_b16 a[158:159], v19 offset:51200
M v[204:207], a[60:63], a[172:175], 0
M v[204:207], a[56:59], a[168:171], v[204:207]
M v[208:211], a[64:67], a[168:171], 0
M v[208:211], a[68:71], a[172:175], v[208:211]
M v[212:215], a[76:79], a[172:175], 0
buffer_load_dwordx4 v9, s[12:15], s24 offen offset:3072 lds
M v[212:215], a[72:75], a[168:171], v[212:215]
M v[216:219], a[80:83], a[168:171], 0
M v[216:219], a[84:87], a[172:175], v[216:219]
M v[220:223], a[92:95], a[172:175], 0
M v[220:223], a[88:91], a[168:171], v[220:223]
s_waitcnt lgkmcnt(10)
M v[224:227], a[32:35], a[176:179], 0
s_add_u32 s24, s24, 262144
s_cmp_eq_u32 s24, s27
s_cselect_b32 s24, s28, s24
s_sub_u32 s6, s6, 1
s_cmp_eq_u32 s6, 0
s_cselect_b64 s[12:13], s[64:65], s[12:13]
M v[224:227], a[36:39], a[180:183], v[224:227]
M v[228:231], a[44:47], a[180:183], 0
M v[228:231], a[40:43], a[176:179], v[228:231]
M v[232:235], a[48:51], a[176:179], 0
M v[232:235], a[52:55], a[180:183], v[232:235]
M v[236:239], a[60:63], a[180:183], 0
M v[236:239], a[56:59], a[176:179], v[236:239]
s_waitcnt vmcnt(8) lgkmcnt(0)
s_barrier
ds_read_b128 a[160:163], v10 offset:32768
ds_read_b128 a[164:167], v11 offset:32768
M v[240:243], a[64:67], a[176:179], 0
s_add_u32 m0, s29, 0
s_nop 0
buffer_load_dwordx4 v2, s[8:11], s23 offen offset:0 lds
M v[240:243], a[68:71], a[180:183], v[240:243]
M v[244:247], a[76:79], a[180:183], 0
M v[244:247], a[72:75], a[176:179], v[244:247]
M v[248:251], a[80:83], a[176:179], 0
M v[248:251], a[84:87], a[180:183], v[248:251]
buffer_load_dwordx4 v3, s[8:11], s23 offen offset:1024 lds
M v[252:255], a[92:95], a[180:183], 0
M v[252:255], a[88:91], a[176:179], v[252:255]
M a[0:3], a[32:35], a[184:187], 0
M a[0:3], a[36:39], a[188:191], a[0:3]
ds_read_b128 a[168:171], v10 offset:34816
ds_read_b128 a[172:175], v11 offset:34816
M a[4:7], a[44:47], a[188:191], 0
M a[4:7], a[40:43], a[184:187], a[4:7]
M a[8:11], a[48:51], a[184:187], 0
buffer_load_dwordx4 v4, s[8:11], s23 offen offset:2048 lds
M a[8:11], a[52:55], a[188:191], a[8:11]
M a[12:15], a[60:63], a[188:191], 0
M a[12:15], a[56:59], a[184:187], a[12:15]
M a[16:19], a[64:67], a[184:187], 0
M a[16:19], a[68:71], a[188:191], a[16:19]
buffer_load_dwordx4 v5, s[8:11], s23 offen offset:3072 lds
M a[20:23], a[76:79], a[188:191], 0
M a[20:23], a[72:75], a[184:187], a[20:23]
M a[24:27], a[80:83], a[184:187], 0
M a[24:27], a[84:87], a[188:191], a[24:27]
M a[28:31], a[92:95], a[188:191], 0
M a[28:31], a[88:91], a[184:187], a[28:31]
s_waitcnt lgkmcnt(2)
M v[32:35], a[96:99], a[160:163], v[32:35]
s_add_u32 m0, s29, 98304
s_nop 0
buffer_load_dwordx4 v6, s[12:15], s24 offen offset:0 lds
M v[32:35], a[100:103], a[164:167], v[32:35]
ds_read_b128 a[176:179], v10 offset:36864
ds_read_b128 a[180:183], v11 offset:36864
M v[36:39], a[108:111], a[164:167], v[36:39]
M v[36:39], a[104:107], a[160:163], v[36:39]
ds_read_b64_tr_b16 a[32:33], v12 offset:0
ds_read_b64_tr_b16 a[34:35], v12 offset:2048
M v[40:43], a[112:115], a[160:163], v[40:43]
M v[40:43], a[116:119], a[164:167], v[40:43]
M v[44:47], a[124:127], a[164:167], v[44:47]
M v[44:47], a[120:123], a[160:163], v[44:47]
ds_read_b64_tr_b16 a[40:41], v13 offset:0
ds_read_b64_tr_b16 a[42:43], v13 offset:2048
M v[48:51], a[128:131], a[160:163], v[48:51]
buffer_load_dwordx4 v7, s[12:15], s24 offen offset:1024 lds
M v[48:51], a[132:135], a[164:167], v[48:51]
M v[52:55], a[140:143], a[164:167], v[52:55]
M v[52:55], a[136:139], a[160:163], v[52:55]
ds_read_b64_tr_b16 a[48:49], v14 offset:0
ds_read_b64_tr_b16 a[50:51], v14 offset:2048
M v[56:59], a[144:147], a[160:163], v[56:59]
M v[56:59], a[148:151], a[164:167], v[56:59]
M v[60:63], a[156:159], a[164:167], v[60:63]
buffer_load_dwordx4 v8, s[12:15], s24 offen offset:2048 lds
M v[60:63], a[152:155], a[160:163], v[60:63]
s_waitcnt lgkmcnt(8)
ds_read_b64_tr_b16 a[56:57], v15 offset:0
ds_read_b64_tr_b16 a[58:59], v15 offset:2048
M v[64:67], a[96:99], a[168:171], v[64:67]
M v[64:67], a[100:103], a[172:175], v[64:67]
ds_read_b128 a[184:187], v10 offset:38912
ds_read_b128 a[188:191], v11 offset:38912
M v[68:71], a[108:111], a[172:175], v[68:71]
M v[68:71], a[104:107], a[168:171], v[68:71]
ds_read_b64_tr_b16 a[64:65], v16 offset:0
ds_read_b64_tr_b16 a[66:67], v16 offset:2048
M v[72:75], a[112:115], a[168:171], v[72:75]
M v[72:75], a[116:119], a[172:175], v[72:75]
M v[76:79], a[124:127], a[172:175], v[76:79]
M v[76:79], a[120:123], a[168:171], v[76:79]
ds_read_b64_tr_b16 a[72:73], v17 offset:0
ds_read_b64_tr_b16 a[74:75], v17 offset:2048
M v[80:83], a[128:131], a[168:171], v[80:83]
buffer_load_dwordx4 v9, s[12:15], s24 offen offset:3072 lds
M v[80:83], a[132:135], a[172:175], v[80:83]
M v[84:87], a[140:143], a[172:175], v[84:87]
M v[84:87], a[136:139], a[168:171], v[84:87]
ds_read_b64_tr_b16 a[80:81], v18 offset:0
ds_read_b64_tr_b16 a[82:83], v18 offset:2048
M v[88:91], a[144:147], a[168:171], v[88:91]
M v[88:91], a[148:151], a[172:175], v[88:91]
M v[92:95], a[156:159], a[172:175], v[92:95]
s_add_u32 s24, s24, 262144
M v[92:95], a[152:155], a[168:171], v[92:95]
s_waitcnt lgkmcnt(15)
ds_read_b64_tr_b16 a[88:89], v19 offset:0
ds_read_b64_tr_b16 a[90:91], v19 offset:2048
M v[96:99], a[96:99], a[176:179], v[96:99]
M v[96:99], a[100:103], a[180:183], v[96:99]
M v[100:103], a[108:111], a[180:183], v[100:103]
M v[100:103], a[104:107], a[176:179], v[100:103]
M v[104:107], a[112:115], a[176:179], v[104:107]
M v[104:107], a[116:119], a[180:183], v[104:107]
M v[108:111], a[124:127], a[180:183], v[108:111]
M v[108:111], a[120:123], a[176:179], v[108:111]
s_waitcnt vmcnt(8) lgkmcnt(0)
s_barrier
ds_read_b128 a[160:163], v10 offset:49152
ds_read_b128 a[164:167], v11 offset:49152
M v[112:115], a[128:131], a[176:179], v[112:115]
s_add_u32 m0, s29, 16384
s_add_u32 s3, s23, s31
buffer_load_dwordx4 v2, s[8:11], s3 offen offset:0 lds
M v[112:115], a[132:135], a[180:183], v[112:115]
M v[116:119], a[140:143], a[180:183], v[116:119]
M v[116:119], a[136:139], a[176:179], v[116:119]
ds_read_b64_tr_b16 a[36:37], v12 offset:16384
ds_read_b64_tr_b16 a[38:39], v12 offset:18432
M v[120:123], a[144:147], a[176:179], v[120:123]
M v[120:123], a[148:151], a[180:183], v[120:123]
buffer_load_dwordx4 v3, s[8:11], s3 offen offset:1024 lds
M v[124:127], a[156:159], a[180:183], v[124:127]
M v[124:127], a[152:155], a[176:179], v[124:127]
M v[128:131], a[96:99], a[184:187], v[128:131]
M v[128:131], a[100:103], a[188:191], v[128:131]
ds_read_b128 a[168:171], v10 offset:51200
ds_read_b128 a[172:175], v11 offset:51200
ds_read_b64_tr_b16 a[44:45], v13 offset:16384
ds_read_b64_tr_b16 a[46:47], v13 offset:18432
M v[132:135], a[108:111], a[188:191], v[132:135]
M v[132:135], a[104:107], a[184:187], v[132:135]
M v[136:139], a[112:115], a[184:187], v[136:139]
buffer_load_dwordx4 v4, s[8:11], s3 offen offset:2048 lds
M v[136:139], a[116:119], a[188:191], v[136:139]
M v[140:143], a[124:127], a[188:191], v[140:143]
M v[140:143], a[120:123], a[184:187], v[140:143]
ds_read_b64_tr_b16 a[52:53], v14 offset:16384
ds_read_b64_tr_b16 a[54:55], v14 offset:18432
M v[144:147], a[128:131], a[184:187], v[144:147]
M v[144:147], a[132:135], a[188:191], v[144:147]
M v[148:151], a[140:143], a[188:191], v[148:151]
buffer_load_dwordx4 v5, s[8:11], s3 offen offset:3072 lds
M v[148:151], a[136:139], a[184:187], v[148:151]
M v[152:155], a[144:147], a[184:187], v[152:155]
M v[152:155], a[148:151], a[188:191], v[152:155]
ds_read_b64_tr_b16 a[60:61], v15 offset:16384
ds_read_b64_tr_b16 a[62:63], v15 offset:18432
M v[156:159], a[156:159], a[188:191], v[156:159]
M v[156:159], a[152:155], a[184:187], v[156:159]
s_waitcnt lgkmcnt(10)
M v[160:163], a[96:99], a[160:163], v[160:163]
M v[160:163], a[100:103], a[164:167], v[160:163]
ds_read_b128 a[176:179], v10 offset:53248
ds_read_b128 a[180:183], v11 offset:53248
M v[164:167], a[108:111], a[164:167], v[164:167]
s_add_u32 s23, s23, 128
s_cmp_eq_u32 s23, s25
s_cselect_b32 s23, s26, s23
M v[164:167], a[104:107], a[160:163], v[164:167]
ds_read_b64_tr_b16 a[68:69], v16 offset:16384
ds_read_b64_tr_b16 a[70:71], v16 offset:18432
M v[168:171], a[112:115], a[160:163], v[168:171]
M v[168:171], a[116:119], a[164:167], v[168:171]
M v[172:175], a[124:127], a[164:167], v[172:175]
M v[172:175], a[120:123], a[160:163], v[172:175]
M v[176:179], a[128:131], a[160:163], v[176:179]
s_add_u32 m0, s29, 114688
s_nop 0
buffer_load_dwordx4 v6, s[12:15], s24 offen offset:0 lds
M v[176:179], a[132:135], a[164:167], v[176:179]
ds_read_b64_tr_b16 a[76:77], v17 offset:16384
ds_read_b64_tr_b16 a[78:79], v17 offset:18432
M v[180:183], a[140:143], a[164:167], v[180:183]
M v[180:183], a[136:139], a[160:163], v[180:183]
M v[184:187], a[144:147], a[160:163], v[184:187]
M v[184:187], a[148:151], a[164:167], v[184:187]
buffer_load_dwordx4 v7, s[12:15], s24 offen offset:1024 lds
M v[188:191], a[156:159], a[164:167], v[188:191]
M v[188:191], a[152:155], a[160:163], v[188:191]
s_waitcnt lgkmcnt(12)
ds_read_b64_tr_b16 a[84:85], v18 offset:16384
ds_read_b64_tr_b16 a[86:87], v18 offset:18432
M v[192:195], a[96:99], a[168:171], v[192:195]
M v[192:195], a[100:103], a[172:175], v[192:195]
ds_read_b128 a[184:187], v10 offset:55296
ds_read_b128 a[188:191], v11 offset:55296
M v[196:199], a[108:111], a[172:175], v[196:199]
M v[196:199], a[104:107], a[168:171], v[196:199]
M v[200:203], a[112:115], a[168:171], v[200:203]
buffer_load_dwordx4 v8, s[12:15], s24 offen offset:2048 lds
M v[200:203], a[116:119], a[172:175], v[200:203]
ds_read_b64_tr_b16 a[92:93], v19 offset:16384
ds_read_b64_tr_b16 a[94:95], v19 offset:18432
M v[204:207], a[124:127], a[172:175], v[204:207]
M v[204:207], a[120:123], a[168:171], v[204:207]
M v[208:211], a[128:131], a[168:171], v[208:211]
M v[208:211], a[132:135], a[172:175], v[208:211]
M v[212:215], a[140:143], a[172:175], v[212:215]
buffer_load_dwordx4 v9, s[12:15], s24 offen offset:3072 lds
M v[212:215], a[136:139], a[168:171], v[212:215]
M v[216:219], a[144:147], a[168:171], v[216:219]
M v[216:219], a[148:151], a[172:175], v[216:219]
M v[220:223], a[156:159], a[172:175], v[220:223]
M v[220:223], a[152:155], a[168:171], v[220:223]
s_waitcnt lgkmcnt(10)
M v[224:227], a[96:99], a[176:179], v[224:227]
s_add_u32 s24, s24, 262144
s_cmp_eq_u32 s24, s27
s_cselect_b32 s24, s28, s24
s_sub_u32 s6, s6, 1
s_cmp_eq_u32 s6, 0
s_cselect_b64 s[12:13], s[64:65], s[12:13]
M v[224:227], a[100:103], a[180:183], v[224:227]
M v[228:231], a[108:111], a[180:183], v[228:231]
M v[228:231], a[104:107], a[176:179], v[228:231]
M v[232:235], a[112:115], a[176:179], v[232:235]
M v[232:235], a[116:119], a[180:183], v[232:235]
M v[236:239], a[124:127], a[180:183], v[236:239]
M v[236:239], a[120:123], a[176:179], v[236:239]
s_waitcnt vmcnt(8) lgkmcnt(0)
s_barrier
ds_read_b128 a[160:163], v10 offset:0
ds_read_b128 a[164:167], v11 offset:0
M v[240:243], a[128:131], a[176:179], v[240:243]
s_add_u32 m0, s29, 32768
s_nop 0
buffer_load_dwordx4 v2, s[8:11], s23 offen offset:0 lds
M v[240:243], a[132:135], a[180:183], v[240:243]
M v[244:247], a[140:143], a[180:183], v[244:247]
M v[244:247], a[136:139], a[176:179], v[244:247]
M v[248:251], a[144:147], a[176:179], v[248:251]
M v[248:251], a[148:151], a[180:183], v[248:251]
buffer_load_dwordx4 v3, s[8:11], s23 offen offset:1024 lds
M v[252:255], a[156:159], a[180:183], v[252:255]
M v[252:255], a[152:155], a[176:179], v[252:255]
M a[0:3], a[96:99], a[184:187], a[0:3]
M a[0:3], a[100:103], a[188:191], a[0:3]
ds_read_b128 a[168:171], v10 offset:2048
ds_read_b128 a[172:175], v11 offset:2048
M a[4:7], a[108:111], a[188:191], a[4:7]
M a[4:7], a[104:107], a[184:187], a[4:7]
M a[8:11], a[112:115], a[184:187], a[8:11]
buffer_load_dwordx4 v4, s[8:11], s23 offen offset:2048 lds
M a[8:11], a[116:119], a[188:191], a[8:11]
M a[12:15], a[124:127], a[188:191], a[12:15]
M a[12:15], a[120:123], a[184:187], a[12:15]
M a[16:19], a[128:131], a[184:187], a[16:19]
M a[16:19], a[132:135], a[188:191], a[16:19]
buffer_load_dwordx4 v5, s[8:11], s23 offen offset:3072 lds
M a[20:23], a[140:143], a[188:191], a[20:23]
M a[20:23], a[136:139], a[184:187], a[20:23]
M a[24:27], a[144:147], a[184:187], a[24:27]
M a[24:27], a[148:151], a[188:191], a[24:27]
M a[28:31], a[156:159], a[188:191], a[28:31]
M a[28:31], a[152:155], a[184:187], a[28:31]
s_waitcnt lgkmcnt(2)
s_mov_b32 s30, 2
Lk1_kl:
M v[32:35], a[32:35], a[160:163], v[32:35]
s_add_u32 m0, s29, 65536
s_nop 0
buffer_load_dwordx4 v6, s[12:15], s24 offen offset:0 lds
M v[32:35], a[36:39], a[164:167], v[32:35]
ds_read_b128 a[176:179], v10 offset:4096
ds_read_b128 a[180:183], v11 offset:4096
M v[36:39], a[44:47], a[164:167], v[36:39]
M v[36:39], a[40:43], a[160:163], v[36:39]
ds_read_b64_tr_b16 a[96:97], v12 offset:32768
ds_read_b64_tr_b16 a[98:99], v12 offset:34816
M v[40:43], a[48:51], a[160:163], v[40:43]
M v[40:43], a[52:55], a[164:167], v[40:43]
M v[44:47], a[60:63], a[164:167], v[44:47]
M v[44:47], a[56:59], a[160:163], v[44:47]
ds_read_b64_tr_b16 a[104:105], v13 offset:32768
ds_read_b64_tr_b16 a[106:107], v13 offset:34816
M v[48:51], a[64:67], a[160:163], v[48:51]
buffer_load_dwordx4 v7, s[12:15], s24 offen offset:1024 lds
M v[48:51], a[68:71], a[164:167], v[48:51]
M v[52:55], a[76:79], a[164:167], v[52:55]
M v[52:55], a[72:75], a[160:163], v[52:55]
ds_read_b64_tr_b16 a[112:113], v14 offset:32768
ds_read_b64_tr_b16 a[114:115], v14 offset:34816
M v[56:59], a[80:83], a[160:163], v[56:59]
M v[56:59], a[84:87], a[164:167], v[56:59]
M v[60:63], a[92:95], a[164:167], v[60:63]
buffer_load_dwordx4 v8, s[12:15], s24 offen offset:2048 lds
M v[60:63], a[88:91], a[160:163], v[60:63]
s_waitcnt lgkmcnt(8)
ds_read_b64_tr_b16 a[120:121], v15 offset:32768
ds_read_b64_tr_b16 a[122:123], v15 offset:34816
M v[64:67], a[32:35], a[168:171], v[64:67]
M v[64:67], a[36:39], a[172:175], v[64:67]
ds_read_b128 a[184:187], v10 offset:6144
ds_read_b128 a[188:191], v11 offset:6144
M v[68:71], a[44:47], a[172:175], v[68:71]
M v[68:71], a[40:43], a[168:171], v[68:71]
ds_read_b64_tr_b16 a[128:129], v16 offset:32768
ds_read_b64_tr_b16 a[130:131], v16 offset:34816
M v[72:75], a[48:51], a[168:171], v[72:75]
M v[72:75], a[52:55], a[172:175], v[72:75]
M v[76:79], a[60:63], a[172:175], v[76:79]
M v[76:79], a[56:59], a[168:171], v[76:79]
ds_read_b64_tr_b16 a[136:137], v17 offset:32768
ds_read_b64_tr_b16 a[138:139], v17 offset:34816
M v[80:83], a[64:67], a[168:171], v[80:83]
buffer_load_dwordx4 v9, s[12:15], s24 offen offset:3072 lds
M v[80:83], a[68:71], a[172:175], v[80:83]
M v[84:87], a[76:79], a[172:175], v[84:87]
M v[84:87], a[72:75], a[168:171], v[84:87]
ds_read_b64_tr_b16 a[144:145], v18 offset:32768
ds_read_b64_tr_b16 a[146:147], v18 offset:34816
M v[88:91], a[80:83], a[168:171], v[88:91]
M v[88:91], a[84:87], a[172:175], v[88:91]
M v[92:95], a[92:95], a[172:175], v[92:95]
s_add_u32 s24, s24, 262144
M v[92:95], a[88:91], a[168:171], v[92:95]
s_waitcnt lgkmcnt(15)
ds_read_b64_tr_b16 a[152:153], v19 offset:32768
ds_read_b64_tr_b16 a[154:155], v19 offset:34816
M v[96:99], a[32:35], a[176:179], v[96:99]
M v[96:99], a[36:39], a[180:183], v[96:99]
M v[100:103], a[44:47], a[180:183], v[100:103]
M v[100:103], a[40:43], a[176:179], v[100:103]
M v[104:107], a[48:51], a[176:179], v[104:107]
M v[104:107], a[52:55], a[180:183], v[104:107]
M v[108:111], a[60:63], a[180:183], v[108:111]
M v[108:111], a[56:59], a[176:179], v[108:111]
s_waitcnt vmcnt(8) lgkmcnt(0)
s_barrier
ds_read_b128 a[160:163], v10 offset:16384
ds_read_b128 a[164:167], v11 offset:16384
M v[112:115], a[64:67], a[176:179], v[112:115]
s_add_u32 m0, s29, 49152
s_add_u32 s3, s23, s31
buffer_load_dwordx4 v2, s[8:11], s3 offen offset:0 lds
M v[112:115], a[68:71], a[180:183], v[112:115]
M v[116:119], a[76:79], a[180:183], v[116:119]
M v[116:119], a[72:75], a[176:179], v[116:119]
ds_read_b64_tr_b16 a[100:101], v12 offset:49152
ds_read_b64_tr_b16 a[102:103], v12 offset:51200
M v[120:123], a[80:83], a[176:179], v[120:123]
M v[120:123], a[84:87], a[180:183], v[120:123]
buffer_load_dwordx4 v3, s[8:11], s3 offen offset:1024 lds
M v[124:127], a[92:95], a[180:183], v[124:127]
M v[124:127], a[88:91], a[176:179], v[124:127]
M v[128:131], a[32:35], a[184:187], v[128:131]
M v[128:131], a[36:39], a[188:191], v[128:131]
ds_read_b128 a[168:171], v10 offset:18432
ds_read_b128 a[172:175], v11 offset:18432
ds_read_b64_tr_b16 a[108:109], v13 offset:49152
ds_read_b64_tr_b16 a[110:111], v13 offset:51200
M v[132:135], a[44:47], a[188:191], v[132:135]
M v[132:135], a[40:43], a[184:187], v[132:135]
M v[136:139], a[48:51], a[184:187], v[136:139]
buffer_load_dwordx4 v4, s[8:11], s3 offen offset:2048 lds
M v[136:139], a[52:55], a[188:191], v[136:139]
M v[140:143], a[60:63], a[188:191], v[140:143]
M v[140:143], a[56:59], a[184:187], v[140:143]
ds_read_b64_tr_b16 a[116:117], v14 offset:49152
ds_read_b64_tr_b16 a[118:119], v14 offset:51200
M v[144:147], a[64:67], a[184:187], v[144:147]
M v[144:147], a[68:71], a[188:191], v[144:147]
M v[148:151], a[76:79], a[188:191], v[148:151]
buffer_load_dwordx4 v5, s[8:11], s3 offen offset:3072 lds
M v[148:151], a[72:75], a[184:187], v[148:151]
M v[152:155], a[80:83], a[184:187], v[152:155]
M v[152:155], a[84:87], a[188:191], v[152:155]
ds_read_b64_tr_b16 a[124:125], v15 offset:49152
ds_read_b64_tr_b16 a[126:127], v15 offset:51200
M v[156:159], a[92:95], a[188:191], v[156:159]
M v[156:159], a[88:91], a[184:187], v[156:159]
s_waitcnt lgkmcnt(10)
M v[160:163], a[32:35], a[160:163], v[160:163]
M v[160:163], a[36:39], a[164:167], v[160:163]
ds_read_b128 a[176:179], v10 offset:20480
ds_read_b128 a[180:183], v11 offset:20480
M v[164:167], a[44:47], a[164:167], v[164:167]
s_add_u32 s23, s23, 128
s_cmp_eq_u32 s23, s25
s_cselect_b32 s23, s26, s23
M v[164:167], a[40:43], a[160:163], v[164:167]
ds_read_b64_tr_b16 a[132:133], v16 offset:49152
ds_read_b64_tr_b16 a[134:135], v16 offset:51200
M v[168:171], a[48:51], a[160:163], v[168:171]
M v[168:171], a[52:55], a[164:167], v[168:171]
M v[172:175], a[60:63], a[164:167], v[172:175]
M v[172:175], a[56:59], a[160:163], v[172:175]
M v[176:179], a[64:67], a[160:163], v[176:179]
s_add_u32 m0, s29, 81920
s_nop 0
buffer_load_dwordx4 v6, s[12:15], s24 offen offset:0 lds
M v[176:179], a[68:71], a[164:167], v[176:179]
ds_read_b64_tr_b16 a[140:141], v17 offset:49152
ds_read_b64_tr_b16 a[142:143], v17 offset:51200
M v[180:183], a[76:79], a[164:167], v[180:183]
M v[180:183], a[72:75], a[160:163], v[180:183]
M v[184:187], a[80:83], a[160:163], v[184:187]
M v[184:187], a[84:87], a[164:167], v[184:187]
buffer_load_dwordx4 v7, s[12:15], s24 offen offset:1024 lds
M v[188:191], a[92:95], a[164:167], v[188:191]
M v[188:191], a[88:91], a[160:163], v[188:191]
s_waitcnt lgkmcnt(12)
ds_read_b64_tr_b16 a[148:149], v18 offset:49152
ds_read_b64_tr_b16 a[150:151], v18 offset:51200
M v[192:195], a[32:35], a[168:171], v[192:195]
M v[192:195], a[36:39], a[172:175], v[192:195]
ds_read_b128 a[184:187], v10 offset:22528
ds_read_b128 a[188:191], v11 offset:22528
M v[196:199], a[44:47], a[172:175], v[196:199]
M v[196:199], a[40:43], a[168:171], v[196:199]
M v[200:203], a[48:51], a[168:171], v[200:203]
buffer_load_dwordx4 v8, s[12:15], s24 offen offset:2048 lds
M v[200:203], a[52:55], a[172:175], v[200:203]
ds_read_b64_tr_b16 a[156:157], v19 offset:49152
ds_read_b64_tr_b16 a[158:159], v19 offset:51200
M v[204:207], a[60:63], a[172:175], v[204:207]
M v[204:207], a[56:59], a[168:171], v[204:207]
M v[208:211], a[64:67], a[168:171], v[208:211]
M v[208:211], a[68:71], a[172:175], v[208:211]
M v[212:215], a[76:79], a[172:175], v[212:215]
buffer_load_dwordx4 v9, s[12:15], s24 offen offset:3072 lds
M v[212:215], a[72:75], a[168:171], v[212:215]
M v[216:219], a[80:83], a[168:171], v[216:219]
M v[216:219], a[84:87], a[172:175], v[216:219]
M v[220:223], a[92:95], a[172:175], v[220:223]
M v[220:223], a[88:91], a[168:171], v[220:223]
s_waitcnt lgkmcnt(10)
M v[224:227], a[32:35], a[176:179], v[224:227]
s_add_u32 s24, s24, 262144
s_cmp_eq_u32 s24, s27
s_cselect_b32 s24, s28, s24
s_sub_u32 s6, s6, 1
s_cmp_eq_u32 s6, 0
s_cselect_b64 s[12:13], s[64:65], s[12:13]
M v[224:227], a[36:39], a[180:183], v[224:227]
M v[228:231], a[44:47], a[180:183], v[228:231]
M v[228:231], a[40:43], a[176:179], v[228:231]
M v[232:235], a[48:51], a[176:179], v[232:235]
M v[232:235], a[52:55], a[180:183], v[232:235]
M v[236:239], a[60:63], a[180:183], v[236:239]
M v[236:239], a[56:59], a[176:179], v[236:239]
s_waitcnt vmcnt(8) lgkmcnt(0)
s_barrier
ds_read_b128 a[160:163], v10 offset:32768
ds_read_b128 a[164:167], v11 offset:32768
M v[240:243], a[64:67], a[176:179], v[240:243]
s_add_u32 m0, s29, 0
s_nop 0
buffer_load_dwordx4 v2, s[8:11], s23 offen offset:0 lds
M v[240:243], a[68:71], a[180:183], v[240:243]
M v[244:247], a[76:79], a[180:183], v[244:247]
M v[244:247], a[72:75], a[176:179], v[244:247]
M v[248:251], a[80:83], a[176:179], v[248:251]
M v[248:251], a[84:87], a[180:183], v[248:251]
buffer_load_dwordx4 v3, s[8:11], s23 offen offset:1024 lds
M v[252:255], a[92:95], a[180:183], v[252:255]
M v[252:255], a[88:91], a[176:179], v[252:255]
M a[0:3], a[32:35], a[184:187], a[0:3]
M a[0:3], a[36:39], a[188:191], a[0:3]
ds_read_b128 a[168:171], v10 offset:34816
ds_read_b128 a[172:175], v11 offset:34816
M a[4:7], a[44:47], a[188:191], a[4:7]
M a[4:7], a[40:43], a[184:187], a[4:7]
M a[8:11], a[48:51], a[184:187], a[8:11]
buffer_load_dwordx4 v4, s[8:11], s23 offen offset:2048 lds
M a[8:11], a[52:55], a[188:191], a[8:11]
M a[12:15], a[60:63], a[188:191], a[12:15]
M a[12:15], a[56:59], a[184:187], a[12:15]
M a[16:19], a[64:67], a[184:187], a[16:19]
M a[16:19], a[68:71], a[188:191], a[16:19]
buffer_load_dwordx4 v5, s[8:11], s23 offen offset:3072 lds
M a[20:23], a[76:79], a[188:191], a[20:23]
M a[20:23], a[72:75], a[184:187], a[20:23]
M a[24:27], a[80:83], a[184:187], a[24:27]
M a[24:27], a[84:87], a[188:191], a[24:27]
M a[28:31], a[92:95], a[188:191], a[28:31]
M a[28:31], a[88:91], a[184:187], a[28:31]
s_waitcnt lgkmcnt(2)
M v[32:35], a[96:99], a[160:163], v[32:35]
s_add_u32 m0, s29, 98304
s_nop 0
buffer_load_dwordx4 v6, s[12:15], s24 offen offset:0 lds
M v[32:35], a[100:103], a[164:167], v[32:35]
ds_read_b128 a[176:179], v10 offset:36864
ds_read_b128 a[180:183], v11 offset:36864
M v[36:39], a[108:111], a[164:167], v[36:39]
M v[36:39], a[104:107], a[160:163], v[36:39]
ds_read_b64_tr_b16 a[32:33], v12 offset:0
ds_read_b64_tr_b16 a[34:35], v12 offset:2048
M v[40:43], a[112:115], a[160:163], v[40:43]
M v[40:43], a[116:119], a[164:167], v[40:43]
M v[44:47], a[124:127], a[164:167], v[44:47]
M v[44:47], a[120:123], a[160:163], v[44:47]
ds_read_b64_tr_b16 a[40:41], v13 offset:0
ds_read_b64_tr_b16 a[42:43], v13 offset:2048
M v[48:51], a[128:131], a[160:163], v[48:51]
buffer_load_dwordx4 v7, s[12:15], s24 offen offset:1024 lds
M v[48:51], a[132:135], a[164:167], v[48:51]
M v[52:55], a[140:143], a[164:167], v[52:55]
M v[52:55], a[136:139], a[160:163], v[52:55]
ds_read_b64_tr_b16 a[48:49], v14 offset:0
ds_read_b64_tr_b16 a[50:51], v14 offset:2048
M v[56:59], a[144:147], a[160:163], v[56:59]
M v[56:59], a[148:151], a[164:167], v[56:59]
M v[60:63], a[156:159], a[164:167], v[60:63]
buffer_load_dwordx4 v8, s[12:15], s24 offen offset:2048 lds
M v[60:63], a[152:155], a[160:163], v[60:63]
s_waitcnt lgkmcnt(8)
ds_read_b64_tr_b16 a[56:57], v15 offset:0
ds_read_b64_tr_b16 a[58:59], v15 offset:2048
M v[64:67], a[96:99], a[168:171], v[64:67]
M v[64:67], a[100:103], a[172:175], v[64:67]
ds_read_b128 a[184:187], v10 offset:38912
ds_read_b128 a[188:191], v11 offset:38912
M v[68:71], a[108:111], a[172:175], v[68:71]
M v[68:71], a[104:107], a[168:171], v[68:71]
ds_read_b64_tr_b16 a[64:65], v16 offset:0
ds_read_b64_tr_b16 a[66:67], v16 offset:2048
M v[72:75], a[112:115], a[168:171], v[72:75]
M v[72:75], a[116:119], a[172:175], v[72:75]
M v[76:79], a[124:127], a[172:175], v[76:79]
M v[76:79], a[120:123], a[168:171], v[76:79]
ds_read_b64_tr_b16 a[72:73], v17 offset:0
ds_read_b64_tr_b16 a[74:75], v17 offset:2048
M v[80:83], a[128:131], a[168:171], v[80:83]
buffer_load_dwordx4 v9, s[12:15], s24 offen offset:3072 lds
M v[80:83], a[132:135], a[172:175], v[80:83]
M v[84:87], a[140:143], a[172:175], v[84:87]
M v[84:87], a[136:139], a[168:171], v[84:87]
ds_read_b64_tr_b16 a[80:81], v18 offset:0
ds_read_b64_tr_b16 a[82:83], v18 offset:2048
M v[88:91], a[144:147], a[168:171], v[88:91]
M v[88:91], a[148:151], a[172:175], v[88:91]
M v[92:95], a[156:159], a[172:175], v[92:95]
s_add_u32 s24, s24, 262144
M v[92:95], a[152:155], a[168:171], v[92:95]
s_waitcnt lgkmcnt(15)
ds_read_b64_tr_b16 a[88:89], v19 offset:0
ds_read_b64_tr_b16 a[90:91], v19 offset:2048
M v[96:99], a[96:99], a[176:179], v[96:99]
M v[96:99], a[100:103], a[180:183], v[96:99]
M v[100:103], a[108:111], a[180:183], v[100:103]
M v[100:103], a[104:107], a[176:179], v[100:103]
M v[104:107], a[112:115], a[176:179], v[104:107]
M v[104:107], a[116:119], a[180:183], v[104:107]
M v[108:111], a[124:127], a[180:183], v[108:111]
M v[108:111], a[120:123], a[176:179], v[108:111]
s_waitcnt vmcnt(8) lgkmcnt(0)
s_barrier
ds_read_b128 a[160:163], v10 offset:49152
ds_read_b128 a[164:167], v11 offset:49152
M v[112:115], a[128:131], a[176:179], v[112:115]
s_add_u32 m0, s29, 16384
s_add_u32 s3, s23, s31
buffer_load_dwordx4 v2, s[8:11], s3 offen offset:0 lds
M v[112:115], a[132:135], a[180:183], v[112:115]
M v[116:119], a[140:143], a[180:183], v[116:119]
M v[116:119], a[136:139], a[176:179], v[116:119]
ds_read_b64_tr_b16 a[36:37], v12 offset:16384
ds_read_b64_tr_b16 a[38:39], v12 offset:18432
M v[120:123], a[144:147], a[176:179], v[120:123]
M v[120:123], a[148:151], a[180:183], v[120:123]
buffer_load_dwordx4 v3, s[8:11], s3 offen offset:1024 lds
M v[124:127], a[156:159], a[180:183], v[124:127]
M v[124:127], a[152:155], a[176:179], v[124:127]
M v[128:131], a[96:99], a[184:187], v[128:131]
M v[128:131], a[100:103], a[188:191], v[128:131]
ds_read_b128 a[168:171], v10 offset:51200
ds_read_b128 a[172:175], v11 offset:51200
ds_read_b64_tr_b16 a[44:45], v13 offset:16384
ds_read_b64_tr_b16 a[46:47], v13 offset:18432
M v[132:135], a[108:111], a[188:191], v[132:135]
M v[132:135], a[104:107], a[184:187], v[132:135]
M v[136:139], a[112:115], a[184:187], v[136:139]
buffer_load_dwordx4 v4, s[8:11], s3 offen offset:2048 lds
M v[136:139], a[116:119], a[188:191], v[136:139]
M v[140:143], a[124:127], a[188:191], v[140:143]
M v[140:143], a[120:123], a[184:187], v[140:143]
ds_read_b64_tr_b16 a[52:53], v14 offset:16384
ds_read_b64_tr_b16 a[54:55], v14 offset:18432
M v[144:147], a[128:131], a[184:187], v[144:147]
M v[144:147], a[132:135], a[188:191], v[144:147]
M v[148:151], a[140:143], a[188:191], v[148:151]
buffer_load_dwordx4 v5, s[8:11], s3 offen offset:3072 lds
M v[148:151], a[136:139], a[184:187], v[148:151]
M v[152:155], a[144:147], a[184:187], v[152:155]
M v[152:155], a[148:151], a[188:191], v[152:155]
ds_read_b64_tr_b16 a[60:61], v15 offset:16384
ds_read_b64_tr_b16 a[62:63], v15 offset:18432
M v[156:159], a[156:159], a[188:191], v[156:159]
M v[156:159], a[152:155], a[184:187], v[156:159]
s_waitcnt lgkmcnt(10)
M v[160:163], a[96:99], a[160:163], v[160:163]
M v[160:163], a[100:103], a[164:167], v[160:163]
ds_read_b128 a[176:179], v10 offset:53248
ds_read_b128 a[180:183], v11 offset:53248
M v[164:167], a[108:111], a[164:167], v[164:167]
s_add_u32 s23, s23, 128
s_cmp_eq_u32 s23, s25
s_cselect_b32 s23, s26, s23
M v[164:167], a[104:107], a[160:163], v[164:167]
ds_read_b64_tr_b16 a[68:69], v16 offset:16384
ds_read_b64_tr_b16 a[70:71], v16 offset:18432
M v[168:171], a[112:115], a[160:163], v[168:171]
M v[168:171], a[116:119], a[164:167], v[168:171]
M v[172:175], a[124:127], a[164:167], v[172:175]
M v[172:175], a[120:123], a[160:163], v[172:175]
M v[176:179], a[128:131], a[160:163], v[176:179]
s_add_u32 m0, s29, 114688
s_nop 0
buffer_load_dwordx4 v6, s[12:15], s24 offen offset:0 lds
M v[176:179], a[132:135], a[164:167], v[176:179]
ds_read_b64_tr_b16 a[76:77], v17 offset:16384
ds_read_b64_tr_b16 a[78:79], v17 offset:18432
M v[180:183], a[140:143], a[164:167], v[180:183]
M v[180:183], a[136:139], a[160:163], v[180:183]
M v[184:187], a[144:147], a[160:163], v[184:187]
M v[184:187], a[148:151], a[164:167], v[184:187]
buffer_load_dwordx4 v7, s[12:15], s24 offen offset:1024 lds
M v[188:191], a[156:159], a[164:167], v[188:191]
M v[188:191], a[152:155], a[160:163], v[188:191]
s_waitcnt lgkmcnt(12)
ds_read_b64_tr_b16 a[84:85], v18 offset:16384
ds_read_b64_tr_b16 a[86:87], v18 offset:18432
M v[192:195], a[96:99], a[168:171], v[192:195]
M v[192:195], a[100:103], a[172:175], v[192:195]
ds_read_b128 a[184:187], v10 offset:55296
ds_read_b128 a[188:191], v11 offset:55296
M v[196:199], a[108:111], a[172:175], v[196:199]
M v[196:199], a[104:107], a[168:171], v[196:199]
M v[200:203], a[112:115], a[168:171], v[200:203]
buffer_load_dwordx4 v8, s[12:15], s24 offen offset:2048 lds
M v[200:203], a[116:119], a[172:175], v[200:203]
ds_read_b64_tr_b16 a[92:93], v19 offset:16384
ds_read_b64_tr_b16 a[94:95], v19 offset:18432
M v[204:207], a[124:127], a[172:175], v[204:207]
M v[204:207], a[120:123], a[168:171], v[204:207]
M v[208:211], a[128:131], a[168:171], v[208:211]
M v[208:211], a[132:135], a[172:175], v[208:211]
M v[212:215], a[140:143], a[172:175], v[212:215]
buffer_load_dwordx4 v9, s[12:15], s24 offen offset:3072 lds
M v[212:215], a[136:139], a[168:171], v[212:215]
M v[216:219], a[144:147], a[168:171], v[216:219]
M v[216:219], a[148:151], a[172:175], v[216:219]
M v[220:223], a[156:159], a[172:175], v[220:223]
M v[220:223], a[152:155], a[168:171], v[220:223]
s_waitcnt lgkmcnt(10)
M v[224:227], a[96:99], a[176:179], v[224:227]
s_add_u32 s24, s24, 262144
s_cmp_eq_u32 s24, s27
s_cselect_b32 s24, s28, s24
s_sub_u32 s6, s6, 1
s_cmp_eq_u32 s6, 0
s_cselect_b64 s[12:13], s[64:65], s[12:13]
M v[224:227], a[100:103], a[180:183], v[224:227]
M v[228:231], a[108:111], a[180:183], v[228:231]
M v[228:231], a[104:107], a[176:179], v[228:231]
M v[232:235], a[112:115], a[176:179], v[232:235]
M v[232:235], a[116:119], a[180:183], v[232:235]
M v[236:239], a[124:127], a[180:183], v[236:239]
M v[236:239], a[120:123], a[176:179], v[236:239]
s_waitcnt vmcnt(8) lgkmcnt(0)
s_barrier
ds_read_b128 a[160:163], v10 offset:0
ds_read_b128 a[164:167], v11 offset:0
M v[240:243], a[128:131], a[176:179], v[240:243]
s_add_u32 m0, s29, 32768
s_nop 0
buffer_load_dwordx4 v2, s[8:11], s23 offen offset:0 lds
M v[240:243], a[132:135], a[180:183], v[240:243]
M v[244:247], a[140:143], a[180:183], v[244:247]
M v[244:247], a[136:139], a[176:179], v[244:247]
M v[248:251], a[144:147], a[176:179], v[248:251]
M v[248:251], a[148:151], a[180:183], v[248:251]
buffer_load_dwordx4 v3, s[8:11], s23 offen offset:1024 lds
M v[252:255], a[156:159], a[180:183], v[252:255]
M v[252:255], a[152:155], a[176:179], v[252:255]
M a[0:3], a[96:99], a[184:187], a[0:3]
M a[0:3], a[100:103], a[188:191], a[0:3]
ds_read_b128 a[168:171], v10 offset:2048
ds_read_b128 a[172:175], v11 offset:2048
M a[4:7], a[108:111], a[188:191], a[4:7]
M a[4:7], a[104:107], a[184:187], a[4:7]
M a[8:11], a[112:115], a[184:187], a[8:11]
buffer_load_dwordx4 v4, s[8:11], s23 offen offset:2048 lds
M a[8:11], a[116:119], a[188:191], a[8:11]
M a[12:15], a[124:127], a[188:191], a[12:15]
M a[12:15], a[120:123], a[184:187], a[12:15]
M a[16:19], a[128:131], a[184:187], a[16:19]
M a[16:19], a[132:135], a[188:191], a[16:19]
buffer_load_dwordx4 v5, s[8:11], s23 offen offset:3072 lds
M a[20:23], a[140:143], a[188:191], a[20:23]
M a[20:23], a[136:139], a[184:187], a[20:23]
M a[24:27], a[144:147], a[184:187], a[24:27]
M a[24:27], a[148:151], a[188:191], a[24:27]
M a[28:31], a[156:159], a[188:191], a[28:31]
M a[28:31], a[152:155], a[184:187], a[28:31]
s_waitcnt lgkmcnt(2)
s_sub_u32 s30, s30, 1
s_cmp_lg_u32 s30, 0
s_cbranch_scc1 Lk1_kl
M v[32:35], a[32:35], a[160:163], v[32:35]
s_add_u32 m0, s29, 65536
s_nop 0
buffer_load_dwordx4 v6, s[12:15], s24 offen offset:0 lds
M v[32:35], a[36:39], a[164:167], v[32:35]
ds_read_b128 a[176:179], v10 offset:4096
ds_read_b128 a[180:183], v11 offset:4096
M v[36:39], a[44:47], a[164:167], v[36:39]
M v[36:39], a[40:43], a[160:163], v[36:39]
ds_read_b64_tr_b16 a[96:97], v12 offset:32768
ds_read_b64_tr_b16 a[98:99], v12 offset:34816
M v[40:43], a[48:51], a[160:163], v[40:43]
M v[40:43], a[52:55], a[164:167], v[40:43]
M v[44:47], a[60:63], a[164:167], v[44:47]
M v[44:47], a[56:59], a[160:163], v[44:47]
ds_read_b64_tr_b16 a[104:105], v13 offset:32768
ds_read_b64_tr_b16 a[106:107], v13 offset:34816
M v[48:51], a[64:67], a[160:163], v[48:51]
buffer_load_dwordx4 v7, s[12:15], s24 offen offset:1024 lds
M v[48:51], a[68:71], a[164:167], v[48:51]
M v[52:55], a[76:79], a[164:167], v[52:55]
M v[52:55], a[72:75], a[160:163], v[52:55]
ds_read_b64_tr_b16 a[112:113], v14 offset:32768
ds_read_b64_tr_b16 a[114:115], v14 offset:34816
M v[56:59], a[80:83], a[160:163], v[56:59]
M v[56:59], a[84:87], a[164:167], v[56:59]
M v[60:63], a[92:95], a[164:167], v[60:63]
buffer_load_dwordx4 v8, s[12:15], s24 offen offset:2048 lds
M v[60:63], a[88:91], a[160:163], v[60:63]
s_waitcnt lgkmcnt(8)
ds_read_b64_tr_b16 a[120:121], v15 offset:32768
ds_read_b64_tr_b16 a[122:123], v15 offset:34816
M v[64:67], a[32:35], a[168:171], v[64:67]
M v[64:67], a[36:39], a[172:175], v[64:67]
ds_read_b128 a[184:187], v10 offset:6144
ds_read_b128 a[188:191], v11 offset:6144
M v[68:71], a[44:47], a[172:175], v[68:71]
M v[68:71], a[40:43], a[168:171], v[68:71]
ds_read_b64_tr_b16 a[128:129], v16 offset:32768
ds_read_b64_tr_b16 a[130:131], v16 offset:34816
M v[72:75], a[48:51], a[168:171], v[72:75]
M v[72:75], a[52:55], a[172:175], v[72:75]
M v[76:79], a[60:63], a[172:175], v[76:79]
M v[76:79], a[56:59], a[168:171], v[76:79]
ds_read_b64_tr_b16 a[136:137], v17 offset:32768
ds_read_b64_tr_b16 a[138:139], v17 offset:34816
M v[80:83], a[64:67], a[168:171], v[80:83]
buffer_load_dwordx4 v9, s[12:15], s24 offen offset:3072 lds
M v[80:83], a[68:71], a[172:175], v[80:83]
M v[84:87], a[76:79], a[172:175], v[84:87]
M v[84:87], a[72:75], a[168:171], v[84:87]
ds_read_b64_tr_b16 a[144:145], v18 offset:32768
ds_read_b64_tr_b16 a[146:147], v18 offset:34816
M v[88:91], a[80:83], a[168:171], v[88:91]
M v[88:91], a[84:87], a[172:175], v[88:91]
M v[92:95], a[92:95], a[172:175], v[92:95]
s_add_u32 s24, s24, 262144
M v[92:95], a[88:91], a[168:171], v[92:95]
s_waitcnt lgkmcnt(15)
ds_read_b64_tr_b16 a[152:153], v19 offset:32768
ds_read_b64_tr_b16 a[154:155], v19 offset:34816
M v[96:99], a[32:35], a[176:179], v[96:99]
M v[96:99], a[36:39], a[180:183], v[96:99]
M v[100:103], a[44:47], a[180:183], v[100:103]
M v[100:103], a[40:43], a[176:179], v[100:103]
M v[104:107], a[48:51], a[176:179], v[104:107]
M v[104:107], a[52:55], a[180:183], v[104:107]
M v[108:111], a[60:63], a[180:183], v[108:111]
M v[108:111], a[56:59], a[176:179], v[108:111]
s_waitcnt vmcnt(8) lgkmcnt(0)
s_barrier
ds_read_b128 a[160:163], v10 offset:16384
ds_read_b128 a[164:167], v11 offset:16384
M v[112:115], a[64:67], a[176:179], v[112:115]
s_add_u32 m0, s29, 49152
s_add_u32 s3, s23, s31
buffer_load_dwordx4 v2, s[8:11], s3 offen offset:0 lds
M v[112:115], a[68:71], a[180:183], v[112:115]
M v[116:119], a[76:79], a[180:183], v[116:119]
M v[116:119], a[72:75], a[176:179], v[116:119]
ds_read_b64_tr_b16 a[100:101], v12 offset:49152
ds_read_b64_tr_b16 a[102:103], v12 offset:51200
M v[120:123], a[80:83], a[176:179], v[120:123]
M v[120:123], a[84:87], a[180:183], v[120:123]
buffer_load_dwordx4 v3, s[8:11], s3 offen offset:1024 lds
M v[124:127], a[92:95], a[180:183], v[124:127]
M v[124:127], a[88:91], a[176:179], v[124:127]
M v[128:131], a[32:35], a[184:187], v[128:131]
M v[128:131], a[36:39], a[188:191], v[128:131]
ds_read_b128 a[168:171], v10 offset:18432
ds_read_b128 a[172:175], v11 offset:18432
ds_read_b64_tr_b16 a[108:109], v13 offset:49152
ds_read_b64_tr_b16 a[110:111], v13 offset:51200
M v[132:135], a[44:47], a[188:191], v[132:135]
M v[132:135], a[40:43], a[184:187], v[132:135]
M v[136:139], a[48:51], a[184:187], v[136:139]
buffer_load_dwordx4 v4, s[8:11], s3 offen offset:2048 lds
M v[136:139], a[52:55], a[188:191], v[136:139]
M v[140:143], a[60:63], a[188:191], v[140:143]
M v[140:143], a[56:59], a[184:187], v[140:143]
ds_read_b64_tr_b16 a[116:117], v14 offset:49152
ds_read_b64_tr_b16 a[118:119], v14 offset:51200
M v[144:147], a[64:67], a[184:187], v[144:147]
M v[144:147], a[68:71], a[188:191], v[144:147]
M v[148:151], a[76:79], a[188:191], v[148:151]
buffer_load_dwordx4 v5, s[8:11], s3 offen offset:3072 lds
M v[148:151], a[72:75], a[184:187], v[148:151]
M v[152:155], a[80:83], a[184:187], v[152:155]
s_lshr_b32 s95, s53, 7
s_add_u32 s95, s95, s22
M v[152:155], a[84:87], a[188:191], v[152:155]
ds_read_b64_tr_b16 a[124:125], v15 offset:49152
ds_read_b64_tr_b16 a[126:127], v15 offset:51200
s_lshl_b32 s95, s95, 5
s_lshr_b32 s19, s52, 6
M v[156:159], a[92:95], a[188:191], v[156:159]
s_add_u32 s95, s95, s19
s_lshl_b32 s19, s21, 1
M v[156:159], a[88:91], a[184:187], v[156:159]
s_waitcnt lgkmcnt(10)
s_add_u32 s95, s95, s19
s_lshl_b32 s92, s95, 15
M v[160:163], a[32:35], a[160:163], v[160:163]
s_add_u32 s93, s92, 32768
s_add_u32 s16, s50, 16777216
M v[160:163], a[36:39], a[164:167], v[160:163]
ds_read_b128 a[176:179], v10 offset:20480
ds_read_b128 a[180:183], v11 offset:20480
s_addc_u32 s17, s51, 0
s_mov_b32 s18, 33554432
M v[164:167], a[44:47], a[164:167], v[164:167]
s_add_u32 s23, s23, 128
s_cmp_eq_u32 s23, s25
s_cselect_b32 s23, s26, s23
s_mov_b32 s19, 0x00020000
M v[164:167], a[40:43], a[160:163], v[164:167]
ds_read_b64_tr_b16 a[132:133], v16 offset:49152
ds_read_b64_tr_b16 a[134:135], v16 offset:51200
M v[168:171], a[48:51], a[160:163], v[168:171]
M v[168:171], a[52:55], a[164:167], v[168:171]
M v[172:175], a[60:63], a[164:167], v[172:175]
M v[172:175], a[56:59], a[160:163], v[172:175]
M v[176:179], a[64:67], a[160:163], v[176:179]
s_add_u32 m0, s29, 81920
s_nop 0
buffer_load_dwordx4 v6, s[12:15], s24 offen offset:0 lds
M v[176:179], a[68:71], a[164:167], v[176:179]
ds_read_b64_tr_b16 a[140:141], v17 offset:49152
ds_read_b64_tr_b16 a[142:143], v17 offset:51200
M v[180:183], a[76:79], a[164:167], v[180:183]
M v[180:183], a[72:75], a[160:163], v[180:183]
M v[184:187], a[80:83], a[160:163], v[184:187]
M v[184:187], a[84:87], a[164:167], v[184:187]
buffer_load_dwordx4 v7, s[12:15], s24 offen offset:1024 lds
M v[188:191], a[92:95], a[164:167], v[188:191]
M v[188:191], a[88:91], a[160:163], v[188:191]
s_waitcnt lgkmcnt(12)
ds_read_b64_tr_b16 a[148:149], v18 offset:49152
ds_read_b64_tr_b16 a[150:151], v18 offset:51200
M v[192:195], a[32:35], a[168:171], v[192:195]
M v[192:195], a[36:39], a[172:175], v[192:195]
ds_read_b128 a[184:187], v10 offset:22528
ds_read_b128 a[188:191], v11 offset:22528
M v[196:199], a[44:47], a[172:175], v[196:199]
M v[196:199], a[40:43], a[168:171], v[196:199]
M v[200:203], a[48:51], a[168:171], v[200:203]
buffer_load_dwordx4 v8, s[12:15], s24 offen offset:2048 lds
M v[200:203], a[52:55], a[172:175], v[200:203]
ds_read_b64_tr_b16 a[156:157], v19 offset:49152
ds_read_b64_tr_b16 a[158:159], v19 offset:51200
M v[204:207], a[60:63], a[172:175], v[204:207]
M v[204:207], a[56:59], a[168:171], v[204:207]
M v[208:211], a[64:67], a[168:171], v[208:211]
M v[208:211], a[68:71], a[172:175], v[208:211]
M v[212:215], a[76:79], a[172:175], v[212:215]
buffer_load_dwordx4 v9, s[12:15], s24 offen offset:3072 lds
M v[212:215], a[72:75], a[168:171], v[212:215]
M v[216:219], a[80:83], a[168:171], v[216:219]
M v[216:219], a[84:87], a[172:175], v[216:219]
M v[220:223], a[92:95], a[172:175], v[220:223]
M v[220:223], a[88:91], a[168:171], v[220:223]
s_waitcnt lgkmcnt(10)
M v[224:227], a[32:35], a[176:179], v[224:227]
s_add_u32 s24, s24, 262144
s_cmp_eq_u32 s24, s27
s_cselect_b32 s24, s28, s24
s_sub_u32 s6, s6, 1
s_cmp_eq_u32 s6, 0
s_cselect_b64 s[12:13], s[64:65], s[12:13]
M v[224:227], a[36:39], a[180:183], v[224:227]
M v[228:231], a[44:47], a[180:183], v[228:231]
M v[228:231], a[40:43], a[176:179], v[228:231]
M v[232:235], a[48:51], a[176:179], v[232:235]
M v[232:235], a[52:55], a[180:183], v[232:235]
M v[236:239], a[60:63], a[180:183], v[236:239]
M v[236:239], a[56:59], a[176:179], v[236:239]
s_waitcnt vmcnt(8) lgkmcnt(0)
s_barrier
ds_read_b128 a[160:163], v10 offset:32768
ds_read_b128 a[164:167], v11 offset:32768
M v[240:243], a[64:67], a[176:179], v[240:243]
s_add_u32 m0, s29, 0
s_nop 0
buffer_load_dwordx4 v2, s[8:11], s23 offen offset:0 lds
M v[240:243], a[68:71], a[180:183], v[240:243]
M v[244:247], a[76:79], a[180:183], v[244:247]
M v[244:247], a[72:75], a[176:179], v[244:247]
M v[248:251], a[80:83], a[176:179], v[248:251]
M v[248:251], a[84:87], a[180:183], v[248:251]
buffer_load_dwordx4 v3, s[8:11], s23 offen offset:1024 lds
M v[252:255], a[92:95], a[180:183], v[252:255]
M v[252:255], a[88:91], a[176:179], v[252:255]
M a[0:3], a[32:35], a[184:187], a[0:3]
M a[0:3], a[36:39], a[188:191], a[0:3]
ds_read_b128 a[168:171], v10 offset:34816
ds_read_b128 a[172:175], v11 offset:34816
M a[4:7], a[44:47], a[188:191], a[4:7]
M a[4:7], a[40:43], a[184:187], a[4:7]
M a[8:11], a[48:51], a[184:187], a[8:11]
buffer_load_dwordx4 v4, s[8:11], s23 offen offset:2048 lds
M a[8:11], a[52:55], a[188:191], a[8:11]
M a[12:15], a[60:63], a[188:191], a[12:15]
M a[12:15], a[56:59], a[184:187], a[12:15]
M a[16:19], a[64:67], a[184:187], a[16:19]
M a[16:19], a[68:71], a[188:191], a[16:19]
buffer_load_dwordx4 v5, s[8:11], s23 offen offset:3072 lds
M a[20:23], a[76:79], a[188:191], a[20:23]
M a[20:23], a[72:75], a[184:187], a[20:23]
M a[24:27], a[80:83], a[184:187], a[24:27]
M a[24:27], a[84:87], a[188:191], a[24:27]
M a[28:31], a[92:95], a[188:191], a[28:31]
M a[28:31], a[88:91], a[184:187], a[28:31]
s_waitcnt lgkmcnt(2)
M v[32:35], a[96:99], a[160:163], v[32:35]
s_add_u32 m0, s29, 98304
s_nop 0
buffer_load_dwordx4 v6, s[12:15], s24 offen offset:0 lds
M v[32:35], a[100:103], a[164:167], v[32:35]
ds_read_b128 a[176:179], v10 offset:36864
ds_read_b128 a[180:183], v11 offset:36864
M v[36:39], a[108:111], a[164:167], v[36:39]
M v[36:39], a[104:107], a[160:163], v[36:39]
ds_read_b64_tr_b16 a[32:33], v12 offset:0
ds_read_b64_tr_b16 a[34:35], v12 offset:2048
M v[40:43], a[112:115], a[160:163], v[40:43]
M v[40:43], a[116:119], a[164:167], v[40:43]
M v[44:47], a[124:127], a[164:167], v[44:47]
M v[44:47], a[120:123], a[160:163], v[44:47]
ds_read_b64_tr_b16 a[40:41], v13 offset:0
ds_read_b64_tr_b16 a[42:43], v13 offset:2048
M v[48:51], a[128:131], a[160:163], v[48:51]
buffer_load_dwordx4 v7, s[12:15], s24 offen offset:1024 lds
M v[48:51], a[132:135], a[164:167], v[48:51]
M v[52:55], a[140:143], a[164:167], v[52:55]
M v[52:55], a[136:139], a[160:163], v[52:55]
ds_read_b64_tr_b16 a[48:49], v14 offset:0
ds_read_b64_tr_b16 a[50:51], v14 offset:2048
M v[56:59], a[144:147], a[160:163], v[56:59]
M v[56:59], a[148:151], a[164:167], v[56:59]
M v[60:63], a[156:159], a[164:167], v[60:63]
buffer_load_dwordx4 v8, s[12:15], s24 offen offset:2048 lds
M v[60:63], a[152:155], a[160:163], v[60:63]
s_waitcnt lgkmcnt(8)
ds_read_b64_tr_b16 a[56:57], v15 offset:0
ds_read_b64_tr_b16 a[58:59], v15 offset:2048
M v[64:67], a[96:99], a[168:171], v[64:67]
M v[64:67], a[100:103], a[172:175], v[64:67]
ds_read_b128 a[184:187], v10 offset:38912
ds_read_b128 a[188:191], v11 offset:38912
M v[68:71], a[108:111], a[172:175], v[68:71]
M v[68:71], a[104:107], a[168:171], v[68:71]
ds_read_b64_tr_b16 a[64:65], v16 offset:0
ds_read_b64_tr_b16 a[66:67], v16 offset:2048
v_cvt_pk_bf16_f32 v32, v32, v33
v_cvt_pk_bf16_f32 v33, v34, v35
M v[72:75], a[112:115], a[168:171], v[72:75]
v_cvt_pk_bf16_f32 v34, v36, v37
v_cvt_pk_bf16_f32 v35, v38, v39
M v[72:75], a[116:119], a[172:175], v[72:75]
v_cvt_pk_bf16_f32 v40, v40, v41
v_cvt_pk_bf16_f32 v41, v42, v43
M v[76:79], a[124:127], a[172:175], v[76:79]
buffer_load_dwordx4 v9, s[12:15], s24 offen offset:3072 lds
v_cvt_pk_bf16_f32 v42, v44, v45
v_cvt_pk_bf16_f32 v43, v46, v47
M v[76:79], a[120:123], a[168:171], v[76:79]
ds_read_b64_tr_b16 a[72:73], v17 offset:0
ds_read_b64_tr_b16 a[74:75], v17 offset:2048
v_cvt_pk_bf16_f32 v48, v48, v49
v_cvt_pk_bf16_f32 v49, v50, v51
M v[80:83], a[128:131], a[168:171], v[80:83]
v_cvt_pk_bf16_f32 v50, v52, v53
v_cvt_pk_bf16_f32 v51, v54, v55
M v[80:83], a[132:135], a[172:175], v[80:83]
v_cvt_pk_bf16_f32 v56, v56, v57
v_cvt_pk_bf16_f32 v57, v58, v59
M v[84:87], a[140:143], a[172:175], v[84:87]
v_cvt_pk_bf16_f32 v58, v60, v61
v_cvt_pk_bf16_f32 v59, v62, v63
M v[84:87], a[136:139], a[168:171], v[84:87]
ds_read_b64_tr_b16 a[80:81], v18 offset:0
ds_read_b64_tr_b16 a[82:83], v18 offset:2048
M v[88:91], a[144:147], a[168:171], v[88:91]
M v[88:91], a[148:151], a[172:175], v[88:91]
s_add_u32 s24, s24, 262144
M v[92:95], a[156:159], a[172:175], v[92:95]
s_add_u32 s94, s92, 0
buffer_store_dwordx4 v[32:35], v1, s[16:19], s94 offen offset:0 sc1
M v[92:95], a[152:155], a[168:171], v[92:95]
s_waitcnt lgkmcnt(15)
ds_read_b64_tr_b16 a[88:89], v19 offset:0
ds_read_b64_tr_b16 a[90:91], v19 offset:2048
M v[96:99], a[96:99], a[176:179], v[96:99]
M v[96:99], a[100:103], a[180:183], v[96:99]
M v[100:103], a[108:111], a[180:183], v[100:103]
M v[100:103], a[104:107], a[176:179], v[100:103]
v_cvt_pk_bf16_f32 v64, v64, v65
v_cvt_pk_bf16_f32 v65, v66, v67
M v[104:107], a[112:115], a[176:179], v[104:107]
v_cvt_pk_bf16_f32 v66, v68, v69
v_cvt_pk_bf16_f32 v67, v70, v71
M v[104:107], a[116:119], a[180:183], v[104:107]
v_cvt_pk_bf16_f32 v72, v72, v73
v_cvt_pk_bf16_f32 v73, v74, v75
M v[108:111], a[124:127], a[180:183], v[108:111]
v_cvt_pk_bf16_f32 v74, v76, v77
v_cvt_pk_bf16_f32 v75, v78, v79
M v[108:111], a[120:123], a[176:179], v[108:111]
s_waitcnt vmcnt(9) lgkmcnt(0)
s_barrier
ds_read_b128 a[160:163], v10 offset:49152
ds_read_b128 a[164:167], v11 offset:49152
v_cvt_pk_bf16_f32 v80, v80, v81
v_cvt_pk_bf16_f32 v81, v82, v83
M v[112:115], a[128:131], a[176:179], v[112:115]
s_add_u32 s94, s92, 0
buffer_store_dwordx4 v[40:43], v1, s[16:19], s94 offen offset:1024 sc1
v_cvt_pk_bf16_f32 v82, v84, v85
v_cvt_pk_bf16_f32 v83, v86, v87
M v[112:115], a[132:135], a[180:183], v[112:115]
s_add_u32 m0, s29, 16384
s_add_u32 s3, s23, s31
buffer_load_dwordx4 v2, s[8:11], s3 offen offset:0 lds
v_cvt_pk_bf16_f32 v88, v88, v89
v_cvt_pk_bf16_f32 v89, v90, v91
M v[116:119], a[140:143], a[180:183], v[116:119]
v_cvt_pk_bf16_f32 v90, v92, v93
v_cvt_pk_bf16_f32 v91, v94, v95
M v[116:119], a[136:139], a[176:179], v[116:119]
ds_read_b64_tr_b16 a[36:37], v12 offset:16384
ds_read_b64_tr_b16 a[38:39], v12 offset:18432
M v[120:123], a[144:147], a[176:179], v[120:123]
M v[120:123], a[148:151], a[180:183], v[120:123]
M v[124:127], a[156:159], a[180:183], v[124:127]
buffer_load_dwordx4 v3, s[8:11], s3 offen offset:1024 lds
M v[124:127], a[152:155], a[176:179], v[124:127]
M v[128:131], a[96:99], a[184:187], v[128:131]
M v[128:131], a[100:103], a[188:191], v[128:131]
ds_read_b128 a[168:171], v10 offset:51200
ds_read_b128 a[172:175], v11 offset:51200
ds_read_b64_tr_b16 a[44:45], v13 offset:16384
ds_read_b64_tr_b16 a[46:47], v13 offset:18432
M v[132:135], a[108:111], a[188:191], v[132:135]
M v[132:135], a[104:107], a[184:187], v[132:135]
s_add_u32 s94, s92, 0
buffer_store_dwordx4 v[48:51], v1, s[16:19], s94 offen offset:2048 sc1
v_cvt_pk_bf16_f32 v96, v96, v97
v_cvt_pk_bf16_f32 v97, v98, v99
M v[136:139], a[112:115], a[184:187], v[136:139]
v_cvt_pk_bf16_f32 v98, v100, v101
v_cvt_pk_bf16_f32 v99, v102, v103
M v[136:139], a[116:119], a[188:191], v[136:139]
buffer_load_dwordx4 v4, s[8:11], s3 offen offset:2048 lds
v_cvt_pk_bf16_f32 v104, v104, v105
v_cvt_pk_bf16_f32 v105, v106, v107
M v[140:143], a[124:127], a[188:191], v[140:143]
v_cvt_pk_bf16_f32 v106, v108, v109
v_cvt_pk_bf16_f32 v107, v110, v111
M v[140:143], a[120:123], a[184:187], v[140:143]
ds_read_b64_tr_b16 a[52:53], v14 offset:16384
ds_read_b64_tr_b16 a[54:55], v14 offset:18432
v_cvt_pk_bf16_f32 v112, v112, v113
v_cvt_pk_bf16_f32 v113, v114, v115
M v[144:147], a[128:131], a[184:187], v[144:147]
v_cvt_pk_bf16_f32 v114, v116, v117
v_cvt_pk_bf16_f32 v115, v118, v119
M v[144:147], a[132:135], a[188:191], v[144:147]
v_cvt_pk_bf16_f32 v120, v120, v121
v_cvt_pk_bf16_f32 v121, v122, v123
M v[148:151], a[140:143], a[188:191], v[148:151]
buffer_load_dwordx4 v5, s[8:11], s3 offen offset:3072 lds
v_cvt_pk_bf16_f32 v122, v124, v125
v_cvt_pk_bf16_f32 v123, v126, v127
M v[148:151], a[136:139], a[184:187], v[148:151]
M v[152:155], a[144:147], a[184:187], v[152:155]
M v[152:155], a[148:151], a[188:191], v[152:155]
ds_read_b64_tr_b16 a[60:61], v15 offset:16384
ds_read_b64_tr_b16 a[62:63], v15 offset:18432
M v[156:159], a[156:159], a[188:191], v[156:159]
s_add_u32 s94, s92, 0
buffer_store_dwordx4 v[56:59], v1, s[16:19], s94 offen offset:3072 sc1
M v[156:159], a[152:155], a[184:187], v[156:159]
s_waitcnt lgkmcnt(10)
M v[160:163], a[96:99], a[160:163], v[160:163]
M v[160:163], a[100:103], a[164:167], v[160:163]
ds_read_b128 a[176:179], v10 offset:53248
ds_read_b128 a[180:183], v11 offset:53248
M v[164:167], a[108:111], a[164:167], v[164:167]
s_add_u32 s23, s23, 128
s_cmp_eq_u32 s23, s25
s_cselect_b32 s23, s26, s23
M v[164:167], a[104:107], a[160:163], v[164:167]
ds_read_b64_tr_b16 a[68:69], v16 offset:16384
ds_read_b64_tr_b16 a[70:71], v16 offset:18432
v_cvt_pk_bf16_f32 v128, v128, v129
v_cvt_pk_bf16_f32 v129, v130, v131
M v[168:171], a[112:115], a[160:163], v[168:171]
v_cvt_pk_bf16_f32 v130, v132, v133
v_cvt_pk_bf16_f32 v131, v134, v135
M v[168:171], a[116:119], a[164:167], v[168:171]
v_cvt_pk_bf16_f32 v136, v136, v137
v_cvt_pk_bf16_f32 v137, v138, v139
M v[172:175], a[124:127], a[164:167], v[172:175]
v_cvt_pk_bf16_f32 v138, v140, v141
v_cvt_pk_bf16_f32 v139, v142, v143
M v[172:175], a[120:123], a[160:163], v[172:175]
v_cvt_pk_bf16_f32 v144, v144, v145
v_cvt_pk_bf16_f32 v145, v146, v147
M v[176:179], a[128:131], a[160:163], v[176:179]
s_add_u32 s94, s92, 4096
buffer_store_dwordx4 v[64:67], v1, s[16:19], s94 offen offset:0 sc1
v_cvt_pk_bf16_f32 v146, v148, v149
v_cvt_pk_bf16_f32 v147, v150, v151
M v[176:179], a[132:135], a[164:167], v[176:179]
ds_read_b64_tr_b16 a[76:77], v17 offset:16384
ds_read_b64_tr_b16 a[78:79], v17 offset:18432
v_cvt_pk_bf16_f32 v152, v152, v153
v_cvt_pk_bf16_f32 v153, v154, v155
M v[180:183], a[140:143], a[164:167], v[180:183]
s_add_u32 m0, s29, 114688
s_nop 0
buffer_load_dwordx4 v6, s[12:15], s24 offen offset:0 lds
v_cvt_pk_bf16_f32 v154, v156, v157
v_cvt_pk_bf16_f32 v155, v158, v159
M v[180:183], a[136:139], a[160:163], v[180:183]
M v[184:187], a[144:147], a[160:163], v[184:187]
v_accvgpr_write_b32 a192, v128
v_accvgpr_write_b32 a193, v129
v_accvgpr_write_b32 a194, v130
v_accvgpr_write_b32 a195, v131
M v[184:187], a[148:151], a[164:167], v[184:187]
v_accvgpr_write_b32 a196, v136
v_accvgpr_write_b32 a197, v137
v_accvgpr_write_b32 a198, v138
v_accvgpr_write_b32 a199, v139
M v[188:191], a[156:159], a[164:167], v[188:191]
buffer_load_dwordx4 v7, s[12:15], s24 offen offset:1024 lds
v_accvgpr_write_b32 a200, v144
v_accvgpr_write_b32 a201, v145
v_accvgpr_write_b32 a202, v146
v_accvgpr_write_b32 a203, v147
M v[188:191], a[152:155], a[160:163], v[188:191]
s_waitcnt lgkmcnt(12)
ds_read_b64_tr_b16 a[84:85], v18 offset:16384
ds_read_b64_tr_b16 a[86:87], v18 offset:18432
v_accvgpr_write_b32 a204, v152
v_accvgpr_write_b32 a205, v153
v_accvgpr_write_b32 a206, v154
v_accvgpr_write_b32 a207, v155
M v[192:195], a[96:99], a[168:171], v[192:195]
M v[192:195], a[100:103], a[172:175], v[192:195]
ds_read_b128 a[184:187], v10 offset:55296
ds_read_b128 a[188:191], v11 offset:55296
M v[196:199], a[108:111], a[172:175], v[196:199]
s_add_u32 s94, s92, 4096
buffer_store_dwordx4 v[72:75], v1, s[16:19], s94 offen offset:1024 sc1
M v[196:199], a[104:107], a[168:171], v[196:199]
v_cvt_pk_bf16_f32 v160, v160, v161
v_cvt_pk_bf16_f32 v161, v162, v163
M v[200:203], a[112:115], a[168:171], v[200:203]
v_cvt_pk_bf16_f32 v162, v164, v165
v_cvt_pk_bf16_f32 v163, v166, v167
M v[200:203], a[116:119], a[172:175], v[200:203]
ds_read_b64_tr_b16 a[92:93], v19 offset:16384
ds_read_b64_tr_b16 a[94:95], v19 offset:18432
v_cvt_pk_bf16_f32 v168, v168, v169
v_cvt_pk_bf16_f32 v169, v170, v171
M v[204:207], a[124:127], a[172:175], v[204:207]
buffer_load_dwordx4 v8, s[12:15], s24 offen offset:2048 lds
v_cvt_pk_bf16_f32 v170, v172, v173
v_cvt_pk_bf16_f32 v171, v174, v175
M v[204:207], a[120:123], a[168:171], v[204:207]
v_cvt_pk_bf16_f32 v176, v176, v177
v_cvt_pk_bf16_f32 v177, v178, v179
M v[208:211], a[128:131], a[168:171], v[208:211]
v_cvt_pk_bf16_f32 v178, v180, v181
v_cvt_pk_bf16_f32 v179, v182, v183
M v[208:211], a[132:135], a[172:175], v[208:211]
v_cvt_pk_bf16_f32 v184, v184, v185
v_cvt_pk_bf16_f32 v185, v186, v187
M v[212:215], a[140:143], a[172:175], v[212:215]
buffer_load_dwordx4 v9, s[12:15], s24 offen offset:3072 lds
v_cvt_pk_bf16_f32 v186, v188, v189
v_cvt_pk_bf16_f32 v187, v190, v191
M v[212:215], a[136:139], a[168:171], v[212:215]
M v[216:219], a[144:147], a[168:171], v[216:219]
v_accvgpr_write_b32 a208, v160
v_accvgpr_write_b32 a209, v161
v_accvgpr_write_b32 a210, v162
v_accvgpr_write_b32 a211, v163
M v[216:219], a[148:151], a[172:175], v[216:219]
s_add_u32 s94, s92, 4096
buffer_store_dwordx4 v[80:83], v1, s[16:19], s94 offen offset:2048 sc1
v_accvgpr_write_b32 a212, v168
v_accvgpr_write_b32 a213, v169
v_accvgpr_write_b32 a214, v170
v_accvgpr_write_b32 a215, v171
M v[220:223], a[156:159], a[172:175], v[220:223]
v_accvgpr_write_b32 a216, v176
v_accvgpr_write_b32 a217, v177
v_accvgpr_write_b32 a218, v178
v_accvgpr_write_b32 a219, v179
M v[220:223], a[152:155], a[168:171], v[220:223]
s_waitcnt lgkmcnt(10)
v_accvgpr_write_b32 a220, v184
v_accvgpr_write_b32 a221, v185
v_accvgpr_write_b32 a222, v186
v_accvgpr_write_b32 a223, v187
M v[224:227], a[96:99], a[176:179], v[224:227]
s_add_u32 s24, s24, 262144
s_cmp_eq_u32 s24, s27
s_cselect_b32 s24, s28, s24
s_sub_u32 s6, s6, 1
s_cmp_eq_u32 s6, 0
s_cselect_b64 s[12:13], s[64:65], s[12:13]
M v[224:227], a[100:103], a[180:183], v[224:227]
M v[228:231], a[108:111], a[180:183], v[228:231]
M v[228:231], a[104:107], a[176:179], v[228:231]
v_cvt_pk_bf16_f32 v192, v192, v193
v_cvt_pk_bf16_f32 v193, v194, v195
M v[232:235], a[112:115], a[176:179], v[232:235]
v_cvt_pk_bf16_f32 v194, v196, v197
v_cvt_pk_bf16_f32 v195, v198, v199
M v[232:235], a[116:119], a[180:183], v[232:235]
v_cvt_pk_bf16_f32 v200, v200, v201
v_cvt_pk_bf16_f32 v201, v202, v203
M v[236:239], a[124:127], a[180:183], v[236:239]
v_cvt_pk_bf16_f32 v202, v204, v205
v_cvt_pk_bf16_f32 v203, v206, v207
M v[236:239], a[120:123], a[176:179], v[236:239]
s_waitcnt vmcnt(15) lgkmcnt(0)
s_barrier
ds_read_b128 a[160:163], v10 offset:0
ds_read_b128 a[164:167], v11 offset:0
v_cvt_pk_bf16_f32 v208, v208, v209
v_cvt_pk_bf16_f32 v209, v210, v211
M v[240:243], a[128:131], a[176:179], v[240:243]
s_add_u32 s94, s92, 4096
buffer_store_dwordx4 v[88:91], v1, s[16:19], s94 offen offset:3072 sc1
v_cvt_pk_bf16_f32 v210, v212, v213
v_cvt_pk_bf16_f32 v211, v214, v215
M v[240:243], a[132:135], a[180:183], v[240:243]
s_add_u32 m0, s29, 32768
s_nop 0
buffer_load_dwordx4 v2, s[8:11], s23 offen offset:0 lds
v_cvt_pk_bf16_f32 v216, v216, v217
v_cvt_pk_bf16_f32 v217, v218, v219
M v[244:247], a[140:143], a[180:183], v[244:247]
v_cvt_pk_bf16_f32 v218, v220, v221
v_cvt_pk_bf16_f32 v219, v222, v223
M v[244:247], a[136:139], a[176:179], v[244:247]
M v[248:251], a[144:147], a[176:179], v[248:251]
v_accvgpr_write_b32 a224, v192
v_accvgpr_write_b32 a225, v193
v_accvgpr_write_b32 a226, v194
v_accvgpr_write_b32 a227, v195
M v[248:251], a[148:151], a[180:183], v[248:251]
buffer_load_dwordx4 v3, s[8:11], s23 offen offset:1024 lds
v_accvgpr_write_b32 a228, v200
v_accvgpr_write_b32 a229, v201
v_accvgpr_write_b32 a230, v202
v_accvgpr_write_b32 a231, v203
M v[252:255], a[156:159], a[180:183], v[252:255]
v_accvgpr_write_b32 a232, v208
v_accvgpr_write_b32 a233, v209
v_accvgpr_write_b32 a234, v210
v_accvgpr_write_b32 a235, v211
M v[252:255], a[152:155], a[176:179], v[252:255]
v_accvgpr_write_b32 a236, v216
v_accvgpr_write_b32 a237, v217
v_accvgpr_write_b32 a238, v218
v_accvgpr_write_b32 a239, v219
M a[0:3], a[96:99], a[184:187], a[0:3]
M a[0:3], a[100:103], a[188:191], a[0:3]
ds_read_b128 a[168:171], v10 offset:2048
ds_read_b128 a[172:175], v11 offset:2048
M a[4:7], a[108:111], a[188:191], a[4:7]
s_add_u32 s94, s92, 8192
buffer_store_dwordx4 v[96:99], v1, s[16:19], s94 offen offset:0 sc1
M a[4:7], a[104:107], a[184:187], a[4:7]
v_cvt_pk_bf16_f32 v224, v224, v225
v_cvt_pk_bf16_f32 v225, v226, v227
M a[8:11], a[112:115], a[184:187], a[8:11]
v_cvt_pk_bf16_f32 v226, v228, v229
v_cvt_pk_bf16_f32 v227, v230, v231
M a[8:11], a[116:119], a[188:191], a[8:11]
buffer_load_dwordx4 v4, s[8:11], s23 offen offset:2048 lds
v_cvt_pk_bf16_f32 v232, v232, v233
v_cvt_pk_bf16_f32 v233, v234, v235
M a[12:15], a[124:127], a[188:191], a[12:15]
v_cvt_pk_bf16_f32 v234, v236, v237
v_cvt_pk_bf16_f32 v235, v238, v239
M a[12:15], a[120:123], a[184:187], a[12:15]
v_cvt_pk_bf16_f32 v240, v240, v241
v_cvt_pk_bf16_f32 v241, v242, v243
M a[16:19], a[128:131], a[184:187], a[16:19]
v_cvt_pk_bf16_f32 v242, v244, v245
v_cvt_pk_bf16_f32 v243, v246, v247
M a[16:19], a[132:135], a[188:191], a[16:19]
buffer_load_dwordx4 v5, s[8:11], s23 offen offset:3072 lds
v_cvt_pk_bf16_f32 v248, v248, v249
v_cvt_pk_bf16_f32 v249, v250, v251
M a[20:23], a[140:143], a[188:191], a[20:23]
v_cvt_pk_bf16_f32 v250, v252, v253
v_cvt_pk_bf16_f32 v251, v254, v255
M a[20:23], a[136:139], a[184:187], a[20:23]
M a[24:27], a[144:147], a[184:187], a[24:27]
s_add_u32 s94, s92, 8192
buffer_store_dwordx4 v[104:107], v1, s[16:19], s94 offen offset:1024 sc1
v_accvgpr_write_b32 a240, v224
v_accvgpr_write_b32 a241, v225
v_accvgpr_write_b32 a242, v226
v_accvgpr_write_b32 a243, v227
M a[24:27], a[148:151], a[188:191], a[24:27]
v_accvgpr_write_b32 a244, v232
v_accvgpr_write_b32 a245, v233
v_accvgpr_write_b32 a246, v234
v_accvgpr_write_b32 a247, v235
M a[28:31], a[156:159], a[188:191], a[28:31]
v_accvgpr_write_b32 a248, v240
v_accvgpr_write_b32 a249, v241
v_accvgpr_write_b32 a250, v242
v_accvgpr_write_b32 a251, v243
M a[28:31], a[152:155], a[184:187], a[28:31]
s_waitcnt lgkmcnt(2)
v_accvgpr_write_b32 a252, v248
v_accvgpr_write_b32 a253, v249
v_accvgpr_write_b32 a254, v250
v_accvgpr_write_b32 a255, v251
M v[32:35], a[160:163], a[32:35], 0
s_add_u32 m0, s29, 65536
s_nop 0
buffer_load_dwordx4 v6, s[12:15], s24 offen offset:0 lds
M v[32:35], a[164:167], a[36:39], v[32:35]
ds_read_b128 a[176:179], v10 offset:4096
ds_read_b128 a[180:183], v11 offset:4096
M v[36:39], a[164:167], a[44:47], 0
M v[36:39], a[160:163], a[40:43], v[36:39]
ds_read_b64_tr_b16 a[96:97], v12 offset:32768
ds_read_b64_tr_b16 a[98:99], v12 offset:34816
M v[40:43], a[160:163], a[48:51], 0
M v[40:43], a[164:167], a[52:55], v[40:43]
M v[44:47], a[164:167], a[60:63], 0
buffer_load_dwordx4 v7, s[12:15], s24 offen offset:1024 lds
M v[44:47], a[160:163], a[56:59], v[44:47]
ds_read_b64_tr_b16 a[104:105], v13 offset:32768
ds_read_b64_tr_b16 a[106:107], v13 offset:34816
M v[48:51], a[160:163], a[64:67], 0
s_add_u32 s94, s92, 8192
buffer_store_dwordx4 v[112:115], v1, s[16:19], s94 offen offset:2048 sc1
M v[48:51], a[164:167], a[68:71], v[48:51]
M v[52:55], a[164:167], a[76:79], 0
M v[52:55], a[160:163], a[72:75], v[52:55]
ds_read_b64_tr_b16 a[112:113], v14 offset:32768
ds_read_b64_tr_b16 a[114:115], v14 offset:34816
M v[56:59], a[160:163], a[80:83], 0
M v[56:59], a[164:167], a[84:87], v[56:59]
M v[60:63], a[164:167], a[92:95], 0
buffer_load_dwordx4 v8, s[12:15], s24 offen offset:2048 lds
M v[60:63], a[160:163], a[88:91], v[60:63]
s_waitcnt lgkmcnt(8)
ds_read_b64_tr_b16 a[120:121], v15 offset:32768
ds_read_b64_tr_b16 a[122:123], v15 offset:34816
M v[64:67], a[168:171], a[32:35], 0
M v[64:67], a[172:175], a[36:39], v[64:67]
ds_read_b128 a[184:187], v10 offset:6144
ds_read_b128 a[188:191], v11 offset:6144
M v[68:71], a[172:175], a[44:47], 0
s_add_u32 s94, s92, 8192
buffer_store_dwordx4 v[120:123], v1, s[16:19], s94 offen offset:3072 sc1
M v[68:71], a[168:171], a[40:43], v[68:71]
ds_read_b64_tr_b16 a[128:129], v16 offset:32768
ds_read_b64_tr_b16 a[130:131], v16 offset:34816
M v[72:75], a[168:171], a[48:51], 0
v_accvgpr_read_b32 v24, a0
v_accvgpr_read_b32 v25, a1
M v[72:75], a[172:175], a[52:55], v[72:75]
v_accvgpr_read_b32 v26, a2
v_accvgpr_read_b32 v27, a3
M v[76:79], a[172:175], a[60:63], 0
v_accvgpr_read_b32 v28, a4
v_accvgpr_read_b32 v29, a5
M v[76:79], a[168:171], a[56:59], v[76:79]
ds_read_b64_tr_b16 a[136:137], v17 offset:32768
ds_read_b64_tr_b16 a[138:139], v17 offset:34816
v_accvgpr_read_b32 v30, a6
v_accvgpr_read_b32 v31, a7
M v[80:83], a[168:171], a[64:67], 0
buffer_load_dwordx4 v9, s[12:15], s24 offen offset:3072 lds
v_cvt_pk_bf16_f32 v24, v24, v25
v_cvt_pk_bf16_f32 v25, v26, v27
M v[80:83], a[172:175], a[68:71], v[80:83]
v_cvt_pk_bf16_f32 v26, v28, v29
v_cvt_pk_bf16_f32 v27, v30, v31
M v[84:87], a[172:175], a[76:79], 0
M v[84:87], a[168:171], a[72:75], v[84:87]
ds_read_b64_tr_b16 a[144:145], v18 offset:32768
ds_read_b64_tr_b16 a[146:147], v18 offset:34816
M v[88:91], a[168:171], a[80:83], 0
M v[88:91], a[172:175], a[84:87], v[88:91]
s_add_u32 s94, s93, 12288
buffer_store_dwordx4 v[24:27], v1, s[16:19], s94 offen offset:0 sc1
M v[92:95], a[172:175], a[92:95], 0
M v[92:95], a[168:171], a[88:91], v[92:95]
s_waitcnt lgkmcnt(15)
ds_read_b64_tr_b16 a[152:153], v19 offset:32768
ds_read_b64_tr_b16 a[154:155], v19 offset:34816
M v[96:99], a[176:179], a[32:35], 0
s_add_u32 s24, s24, 262144
M v[96:99], a[180:183], a[36:39], v[96:99]
M v[100:103], a[180:183], a[44:47], 0
M v[100:103], a[176:179], a[40:43], v[100:103]
M v[104:107], a[176:179], a[48:51], 0
M v[104:107], a[180:183], a[52:55], v[104:107]
M v[108:111], a[180:183], a[60:63], 0
M v[108:111], a[176:179], a[56:59], v[108:111]
s_waitcnt vmcnt(15) lgkmcnt(0)
s_barrier
ds_read_b128 a[160:163], v10 offset:16384
ds_read_b128 a[164:167], v11 offset:16384
M v[112:115], a[176:179], a[64:67], 0
s_add_u32 m0, s29, 49152
s_add_u32 s3, s23, s31
buffer_load_dwordx4 v2, s[8:11], s3 offen offset:0 lds
M v[112:115], a[180:183], a[68:71], v[112:115]
M v[116:119], a[180:183], a[76:79], 0
M v[116:119], a[176:179], a[72:75], v[116:119]
ds_read_b64_tr_b16 a[100:101], v12 offset:49152
ds_read_b64_tr_b16 a[102:103], v12 offset:51200
M v[120:123], a[176:179], a[80:83], 0
v_accvgpr_read_b32 v24, a8
v_accvgpr_read_b32 v25, a9
M v[120:123], a[180:183], a[84:87], v[120:123]
buffer_load_dwordx4 v3, s[8:11], s3 offen offset:1024 lds
v_accvgpr_read_b32 v26, a10
v_accvgpr_read_b32 v27, a11
M v[124:127], a[180:183], a[92:95], 0
v_accvgpr_read_b32 v28, a12
v_accvgpr_read_b32 v29, a13
M v[124:127], a[176:179], a[88:91], v[124:127]
v_accvgpr_read_b32 v30, a14
v_accvgpr_read_b32 v31, a15
M v[128:131], a[184:187], a[32:35], 0
v_cvt_pk_bf16_f32 v24, v24, v25
v_cvt_pk_bf16_f32 v25, v26, v27
M v[128:131], a[188:191], a[36:39], v[128:131]
ds_read_b128 a[168:171], v10 offset:18432
ds_read_b128 a[172:175], v11 offset:18432
ds_read_b64_tr_b16 a[108:109], v13 offset:49152
ds_read_b64_tr_b16 a[110:111], v13 offset:51200
v_cvt_pk_bf16_f32 v26, v28, v29
v_cvt_pk_bf16_f32 v27, v30, v31
M v[132:135], a[188:191], a[44:47], 0
M v[132:135], a[184:187], a[40:43], v[132:135]
M v[136:139], a[184:187], a[48:51], 0
buffer_load_dwordx4 v4, s[8:11], s3 offen offset:2048 lds
M v[136:139], a[188:191], a[52:55], v[136:139]
s_add_u32 s94, s93, 12288
buffer_store_dwordx4 v[24:27], v1, s[16:19], s94 offen offset:1024 sc1
M v[140:143], a[188:191], a[60:63], 0
M v[140:143], a[184:187], a[56:59], v[140:143]
ds_read_b64_tr_b16 a[116:117], v14 offset:49152
ds_read_b64_tr_b16 a[118:119], v14 offset:51200
M v[144:147], a[184:187], a[64:67], 0
M v[144:147], a[188:191], a[68:71], v[144:147]
M v[148:151], a[188:191], a[76:79], 0
buffer_load_dwordx4 v5, s[8:11], s3 offen offset:3072 lds
M v[148:151], a[184:187], a[72:75], v[148:151]
M v[152:155], a[184:187], a[80:83], 0
M v[152:155], a[188:191], a[84:87], v[152:155]
ds_read_b64_tr_b16 a[124:125], v15 offset:49152
ds_read_b64_tr_b16 a[126:127], v15 offset:51200
M v[156:159], a[188:191], a[92:95], 0
M v[156:159], a[184:187], a[88:91], v[156:159]
s_waitcnt lgkmcnt(10)
M v[160:163], a[160:163], a[32:35], 0
M v[160:163], a[164:167], a[36:39], v[160:163]
ds_read_b128 a[176:179], v10 offset:20480
ds_read_b128 a[180:183], v11 offset:20480
M v[164:167], a[164:167], a[44:47], 0
s_add_u32 s23, s23, 128
s_cmp_eq_u32 s23, s25
s_cselect_b32 s23, s26, s23
M v[164:167], a[160:163], a[40:43], v[164:167]
ds_read_b64_tr_b16 a[132:133], v16 offset:49152
ds_read_b64_tr_b16 a[134:135], v16 offset:51200
M v[168:171], a[160:163], a[48:51], 0
v_accvgpr_read_b32 v24, a16
v_accvgpr_read_b32 v25, a17
M v[168:171], a[164:167], a[52:55], v[168:171]
v_accvgpr_read_b32 v26, a18
v_accvgpr_read_b32 v27, a19
M v[172:175], a[164:167], a[60:63], 0
v_accvgpr_read_b32 v28, a20
v_accvgpr_read_b32 v29, a21
M v[172:175], a[160:163], a[56:59], v[172:175]
v_accvgpr_read_b32 v30, a22
v_accvgpr_read_b32 v31, a23
M v[176:179], a[160:163], a[64:67], 0
s_add_u32 m0, s29, 81920
s_nop 0
buffer_load_dwordx4 v6, s[12:15], s24 offen offset:0 lds
v_cvt_pk_bf16_f32 v24, v24, v25
v_cvt_pk_bf16_f32 v25, v26, v27
M v[176:179], a[164:167], a[68:71], v[176:179]
ds_read_b64_tr_b16 a[140:141], v17 offset:49152
ds_read_b64_tr_b16 a[142:143], v17 offset:51200
v_cvt_pk_bf16_f32 v26, v28, v29
v_cvt_pk_bf16_f32 v27, v30, v31
M v[180:183], a[164:167], a[76:79], 0
M v[180:183], a[160:163], a[72:75], v[180:183]
M v[184:187], a[160:163], a[80:83], 0
M v[184:187], a[164:167], a[84:87], v[184:187]
s_add_u32 s94, s93, 12288
buffer_store_dwordx4 v[24:27], v1, s[16:19], s94 offen offset:2048 sc1
M v[188:191], a[164:167], a[92:95], 0
buffer_load_dwordx4 v7, s[12:15], s24 offen offset:1024 lds
M v[188:191], a[160:163], a[88:91], v[188:191]
s_waitcnt lgkmcnt(12)
ds_read_b64_tr_b16 a[148:149], v18 offset:49152
ds_read_b64_tr_b16 a[150:151], v18 offset:51200
M v[192:195], a[168:171], a[32:35], 0
M v[192:195], a[172:175], a[36:39], v[192:195]
ds_read_b128 a[184:187], v10 offset:22528
ds_read_b128 a[188:191], v11 offset:22528
M v[196:199], a[172:175], a[44:47], 0
M v[196:199], a[168:171], a[40:43], v[196:199]
M v[200:203], a[168:171], a[48:51], 0
M v[200:203], a[172:175], a[52:55], v[200:203]
ds_read_b64_tr_b16 a[156:157], v19 offset:49152
ds_read_b64_tr_b16 a[158:159], v19 offset:51200
M v[204:207], a[172:175], a[60:63], 0
buffer_load_dwordx4 v8, s[12:15], s24 offen offset:2048 lds
M v[204:207], a[168:171], a[56:59], v[204:207]
M v[208:211], a[168:171], a[64:67], 0
M v[208:211], a[172:175], a[68:71], v[208:211]
M v[212:215], a[172:175], a[76:79], 0
buffer_load_dwordx4 v9, s[12:15], s24 offen offset:3072 lds
M v[212:215], a[168:171], a[72:75], v[212:215]
M v[216:219], a[168:171], a[80:83], 0
v_accvgpr_read_b32 v24, a24
v_accvgpr_read_b32 v25, a25
M v[216:219], a[172:175], a[84:87], v[216:219]
v_accvgpr_read_b32 v26, a26
v_accvgpr_read_b32 v27, a27
M v[220:223], a[172:175], a[92:95], 0
v_accvgpr_read_b32 v28, a28
v_accvgpr_read_b32 v29, a29
M v[220:223], a[168:171], a[88:91], v[220:223]
s_waitcnt lgkmcnt(10)
v_accvgpr_read_b32 v30, a30
v_accvgpr_read_b32 v31, a31
M v[224:227], a[176:179], a[32:35], 0
s_add_u32 s24, s24, 262144
s_cmp_eq_u32 s24, s27
s_cselect_b32 s24, s28, s24
s_sub_u32 s6, s6, 1
s_cmp_eq_u32 s6, 0
s_cselect_b64 s[12:13], s[64:65], s[12:13]
v_cvt_pk_bf16_f32 v24, v24, v25
v_cvt_pk_bf16_f32 v25, v26, v27
M v[224:227], a[180:183], a[36:39], v[224:227]
v_cvt_pk_bf16_f32 v26, v28, v29
v_cvt_pk_bf16_f32 v27, v30, v31
M v[228:231], a[180:183], a[44:47], 0
M v[228:231], a[176:179], a[40:43], v[228:231]
M v[232:235], a[176:179], a[48:51], 0
M v[232:235], a[180:183], a[52:55], v[232:235]
s_add_u32 s94, s93, 12288
buffer_store_dwordx4 v[24:27], v1, s[16:19], s94 offen offset:3072 sc1
M v[236:239], a[180:183], a[60:63], 0
M v[236:239], a[176:179], a[56:59], v[236:239]
s_waitcnt vmcnt(12) lgkmcnt(0)
s_barrier
ds_read_b128 a[160:163], v10 offset:32768
ds_read_b128 a[164:167], v11 offset:32768
M v[240:243], a[176:179], a[64:67], 0
s_add_u32 m0, s29, 0
s_nop 0
buffer_load_dwordx4 v2, s[8:11], s23 offen offset:0 lds
M v[240:243], a[180:183], a[68:71], v[240:243]
M v[244:247], a[180:183], a[76:79], 0
M v[244:247], a[176:179], a[72:75], v[244:247]
M v[248:251], a[176:179], a[80:83], 0
M v[248:251], a[180:183], a[84:87], v[248:251]
buffer_load_dwordx4 v3, s[8:11], s23 offen offset:1024 lds
M v[252:255], a[180:183], a[92:95], 0
M v[252:255], a[176:179], a[88:91], v[252:255]
M a[0:3], a[184:187], a[32:35], 0
M a[0:3], a[188:191], a[36:39], a[0:3]
ds_read_b128 a[168:171], v10 offset:34816
ds_read_b128 a[172:175], v11 offset:34816
M a[4:7], a[188:191], a[44:47], 0
M a[4:7], a[184:187], a[40:43], a[4:7]
M a[8:11], a[184:187], a[48:51], 0
buffer_load_dwordx4 v4, s[8:11], s23 offen offset:2048 lds
M a[8:11], a[188:191], a[52:55], a[8:11]
M a[12:15], a[188:191], a[60:63], 0
M a[12:15], a[184:187], a[56:59], a[12:15]
M a[16:19], a[184:187], a[64:67], 0
M a[16:19], a[188:191], a[68:71], a[16:19]
buffer_load_dwordx4 v5, s[8:11], s23 offen offset:3072 lds
M a[20:23], a[188:191], a[76:79], 0
M a[20:23], a[184:187], a[72:75], a[20:23]
M a[24:27], a[184:187], a[80:83], 0
M a[24:27], a[188:191], a[84:87], a[24:27]
M a[28:31], a[188:191], a[92:95], 0
M a[28:31], a[184:187], a[88:91], a[28:31]
s_waitcnt lgkmcnt(2)
M v[32:35], a[160:163], a[96:99], v[32:35]
s_add_u32 m0, s29, 98304
s_nop 0
buffer_load_dwordx4 v6, s[12:15], s24 offen offset:0 lds
M v[32:35], a[164:167], a[100:103], v[32:35]
ds_read_b128 a[176:179], v10 offset:36864
ds_read_b128 a[180:183], v11 offset:36864
M v[36:39], a[164:167], a[108:111], v[36:39]
M v[36:39], a[160:163], a[104:107], v[36:39]
ds_read_b64_tr_b16 a[32:33], v12 offset:0
ds_read_b64_tr_b16 a[34:35], v12 offset:2048
M v[40:43], a[160:163], a[112:115], v[40:43]
M v[40:43], a[164:167], a[116:119], v[40:43]
M v[44:47], a[164:167], a[124:127], v[44:47]
M v[44:47], a[160:163], a[120:123], v[44:47]
ds_read_b64_tr_b16 a[40:41], v13 offset:0
ds_read_b64_tr_b16 a[42:43], v13 offset:2048
M v[48:51], a[160:163], a[128:131], v[48:51]
s_add_u32 s94, s92, 12288
buffer_store_dwordx4 a[192:195], v1, s[16:19], s94 offen offset:0 sc1
M v[48:51], a[164:167], a[132:135], v[48:51]
buffer_load_dwordx4 v7, s[12:15], s24 offen offset:1024 lds
M v[52:55], a[164:167], a[140:143], v[52:55]
M v[52:55], a[160:163], a[136:139], v[52:55]
ds_read_b64_tr_b16 a[48:49], v14 offset:0
ds_read_b64_tr_b16 a[50:51], v14 offset:2048
M v[56:59], a[160:163], a[144:147], v[56:59]
M v[56:59], a[164:167], a[148:151], v[56:59]
M v[60:63], a[164:167], a[156:159], v[60:63]
M v[60:63], a[160:163], a[152:155], v[60:63]
s_waitcnt lgkmcnt(8)
ds_read_b64_tr_b16 a[56:57], v15 offset:0
ds_read_b64_tr_b16 a[58:59], v15 offset:2048
M v[64:67], a[168:171], a[96:99], v[64:67]
buffer_load_dwordx4 v8, s[12:15], s24 offen offset:2048 lds
M v[64:67], a[172:175], a[100:103], v[64:67]
ds_read_b128 a[184:187], v10 offset:38912
ds_read_b128 a[188:191], v11 offset:38912
M v[68:71], a[172:175], a[108:111], v[68:71]
M v[68:71], a[168:171], a[104:107], v[68:71]
ds_read_b64_tr_b16 a[64:65], v16 offset:0
ds_read_b64_tr_b16 a[66:67], v16 offset:2048
M v[72:75], a[168:171], a[112:115], v[72:75]
M v[72:75], a[172:175], a[116:119], v[72:75]
M v[76:79], a[172:175], a[124:127], v[76:79]
M v[76:79], a[168:171], a[120:123], v[76:79]
ds_read_b64_tr_b16 a[72:73], v17 offset:0
ds_read_b64_tr_b16 a[74:75], v17 offset:2048
M v[80:83], a[168:171], a[128:131], v[80:83]
buffer_load_dwordx4 v9, s[12:15], s24 offen offset:3072 lds
M v[80:83], a[172:175], a[132:135], v[80:83]
M v[84:87], a[172:175], a[140:143], v[84:87]
M v[84:87], a[168:171], a[136:139], v[84:87]
ds_read_b64_tr_b16 a[80:81], v18 offset:0
ds_read_b64_tr_b16 a[82:83], v18 offset:2048
M v[88:91], a[168:171], a[144:147], v[88:91]
M v[88:91], a[172:175], a[148:151], v[88:91]
M v[92:95], a[172:175], a[156:159], v[92:95]
s_add_u32 s24, s24, 262144
M v[92:95], a[168:171], a[152:155], v[92:95]
s_waitcnt lgkmcnt(15)
ds_read_b64_tr_b16 a[88:89], v19 offset:0
ds_read_b64_tr_b16 a[90:91], v19 offset:2048
M v[96:99], a[176:179], a[96:99], v[96:99]
M v[96:99], a[180:183], a[100:103], v[96:99]
M v[100:103], a[180:183], a[108:111], v[100:103]
M v[100:103], a[176:179], a[104:107], v[100:103]
M v[104:107], a[176:179], a[112:115], v[104:107]
s_add_u32 s94, s92, 12288
buffer_store_dwordx4 a[196:199], v1, s[16:19], s94 offen offset:1024 sc1
M v[104:107], a[180:183], a[116:119], v[104:107]
M v[108:111], a[180:183], a[124:127], v[108:111]
M v[108:111], a[176:179], a[120:123], v[108:111]
s_waitcnt vmcnt(11) lgkmcnt(0)
s_barrier
ds_read_b128 a[160:163], v10 offset:49152
ds_read_b128 a[164:167], v11 offset:49152
M v[112:115], a[176:179], a[128:131], v[112:115]
s_add_u32 m0, s29, 16384
s_add_u32 s3, s23, s31
buffer_load_dwordx4 v2, s[8:11], s3 offen offset:0 lds
M v[112:115], a[180:183], a[132:135], v[112:115]
M v[116:119], a[180:183], a[140:143], v[116:119]
M v[116:119], a[176:179], a[136:139], v[116:119]
ds_read_b64_tr_b16 a[36:37], v12 offset:16384
ds_read_b64_tr_b16 a[38:39], v12 offset:18432
M v[120:123], a[176:179], a[144:147], v[120:123]
M v[120:123], a[180:183], a[148:151], v[120:123]
buffer_load_dwordx4 v3, s[8:11], s3 offen offset:1024 lds
M v[124:127], a[180:183], a[156:159], v[124:127]
M v[124:127], a[176:179], a[152:155], v[124:127]
M v[128:131], a[184:187], a[96:99], v[128:131]
M v[128:131], a[188:191], a[100:103], v[128:131]
ds_read_b128 a[168:171], v10 offset:51200
ds_read_b128 a[172:175], v11 offset:51200
ds_read_b64_tr_b16 a[44:45], v13 offset:16384
ds_read_b64_tr_b16 a[46:47], v13 offset:18432
M v[132:135], a[188:191], a[108:111], v[132:135]
M v[132:135], a[184:187], a[104:107], v[132:135]
M v[136:139], a[184:187], a[112:115], v[136:139]
buffer_load_dwordx4 v4, s[8:11], s3 offen offset:2048 lds
M v[136:139], a[188:191], a[116:119], v[136:139]
M v[140:143], a[188:191], a[124:127], v[140:143]
M v[140:143], a[184:187], a[120:123], v[140:143]
ds_read_b64_tr_b16 a[52:53], v14 offset:16384
ds_read_b64_tr_b16 a[54:55], v14 offset:18432
M v[144:147], a[184:187], a[128:131], v[144:147]
M v[144:147], a[188:191], a[132:135], v[144:147]
buffer_load_dwordx4 v5, s[8:11], s3 offen offset:3072 lds
M v[148:151], a[188:191], a[140:143], v[148:151]
M v[148:151], a[184:187], a[136:139], v[148:151]
M v[152:155], a[184:187], a[144:147], v[152:155]
M v[152:155], a[188:191], a[148:151], v[152:155]
ds_read_b64_tr_b16 a[60:61], v15 offset:16384
ds_read_b64_tr_b16 a[62:63], v15 offset:18432
M v[156:159], a[188:191], a[156:159], v[156:159]
M v[156:159], a[184:187], a[152:155], v[156:159]
s_waitcnt lgkmcnt(10)
M v[160:163], a[160:163], a[96:99], v[160:163]
s_add_u32 s94, s92, 12288
buffer_store_dwordx4 a[200:203], v1, s[16:19], s94 offen offset:2048 sc1
M v[160:163], a[164:167], a[100:103], v[160:163]
ds_read_b128 a[176:179], v10 offset:53248
ds_read_b128 a[180:183], v11 offset:53248
M v[164:167], a[164:167], a[108:111], v[164:167]
s_add_u32 s23, s23, 128
s_cmp_eq_u32 s23, s25
s_cselect_b32 s23, s26, s23
M v[164:167], a[160:163], a[104:107], v[164:167]
ds_read_b64_tr_b16 a[68:69], v16 offset:16384
ds_read_b64_tr_b16 a[70:71], v16 offset:18432
M v[168:171], a[160:163], a[112:115], v[168:171]
M v[168:171], a[164:167], a[116:119], v[168:171]
M v[172:175], a[164:167], a[124:127], v[172:175]
M v[172:175], a[160:163], a[120:123], v[172:175]
M v[176:179], a[160:163], a[128:131], v[176:179]
s_add_u32 m0, s29, 114688
s_nop 0
buffer_load_dwordx4 v6, s[12:15], s24 offen offset:0 lds
M v[176:179], a[164:167], a[132:135], v[176:179]
ds_read_b64_tr_b16 a[76:77], v17 offset:16384
ds_read_b64_tr_b16 a[78:79], v17 offset:18432
M v[180:183], a[164:167], a[140:143], v[180:183]
M v[180:183], a[160:163], a[136:139], v[180:183]
M v[184:187], a[160:163], a[144:147], v[184:187]
M v[184:187], a[164:167], a[148:151], v[184:187]
buffer_load_dwordx4 v7, s[12:15], s24 offen offset:1024 lds
M v[188:191], a[164:167], a[156:159], v[188:191]
M v[188:191], a[160:163], a[152:155], v[188:191]
s_waitcnt lgkmcnt(12)
ds_read_b64_tr_b16 a[84:85], v18 offset:16384
ds_read_b64_tr_b16 a[86:87], v18 offset:18432
M v[192:195], a[168:171], a[96:99], v[192:195]
M v[192:195], a[172:175], a[100:103], v[192:195]
ds_read_b128 a[184:187], v10 offset:55296
ds_read_b128 a[188:191], v11 offset:55296
M v[196:199], a[172:175], a[108:111], v[196:199]
M v[196:199], a[168:171], a[104:107], v[196:199]
M v[200:203], a[168:171], a[112:115], v[200:203]
buffer_load_dwordx4 v8, s[12:15], s24 offen offset:2048 lds
M v[200:203], a[172:175], a[116:119], v[200:203]
ds_read_b64_tr_b16 a[92:93], v19 offset:16384
ds_read_b64_tr_b16 a[94:95], v19 offset:18432
M v[204:207], a[172:175], a[124:127], v[204:207]
M v[204:207], a[168:171], a[120:123], v[204:207]
M v[208:211], a[168:171], a[128:131], v[208:211]
M v[208:211], a[172:175], a[132:135], v[208:211]
buffer_load_dwordx4 v9, s[12:15], s24 offen offset:3072 lds
M v[212:215], a[172:175], a[140:143], v[212:215]
M v[212:215], a[168:171], a[136:139], v[212:215]
M v[216:219], a[168:171], a[144:147], v[216:219]
s_add_u32 s94, s92, 12288
buffer_store_dwordx4 a[204:207], v1, s[16:19], s94 offen offset:3072 sc1
M v[216:219], a[172:175], a[148:151], v[216:219]
M v[220:223], a[172:175], a[156:159], v[220:223]
M v[220:223], a[168:171], a[152:155], v[220:223]
s_waitcnt lgkmcnt(10)
M v[224:227], a[176:179], a[96:99], v[224:227]
s_add_u32 s24, s24, 262144
s_cmp_eq_u32 s24, s27
s_cselect_b32 s24, s28, s24
s_sub_u32 s6, s6, 1
s_cmp_eq_u32 s6, 0
s_cselect_b64 s[12:13], s[64:65], s[12:13]
M v[224:227], a[180:183], a[100:103], v[224:227]
M v[228:231], a[180:183], a[108:111], v[228:231]
M v[228:231], a[176:179], a[104:107], v[228:231]
M v[232:235], a[176:179], a[112:115], v[232:235]
M v[232:235], a[180:183], a[116:119], v[232:235]
M v[236:239], a[180:183], a[124:127], v[236:239]
M v[236:239], a[176:179], a[120:123], v[236:239]
s_waitcnt vmcnt(11) lgkmcnt(0)
s_barrier
ds_read_b128 a[160:163], v10 offset:0
ds_read_b128 a[164:167], v11 offset:0
M v[240:243], a[176:179], a[128:131], v[240:243]
s_add_u32 m0, s29, 32768
s_nop 0
buffer_load_dwordx4 v2, s[8:11], s23 offen offset:0 lds
M v[240:243], a[180:183], a[132:135], v[240:243]
M v[244:247], a[180:183], a[140:143], v[244:247]
M v[244:247], a[176:179], a[136:139], v[244:247]
M v[248:251], a[176:179], a[144:147], v[248:251]
M v[248:251], a[180:183], a[148:151], v[248:251]
buffer_load_dwordx4 v3, s[8:11], s23 offen offset:1024 lds
M v[252:255], a[180:183], a[156:159], v[252:255]
M v[252:255], a[176:179], a[152:155], v[252:255]
M a[0:3], a[184:187], a[96:99], a[0:3]
M a[0:3], a[188:191], a[100:103], a[0:3]
ds_read_b128 a[168:171], v10 offset:2048
ds_read_b128 a[172:175], v11 offset:2048
M a[4:7], a[188:191], a[108:111], a[4:7]
M a[4:7], a[184:187], a[104:107], a[4:7]
M a[8:11], a[184:187], a[112:115], a[8:11]
buffer_load_dwordx4 v4, s[8:11], s23 offen offset:2048 lds
M a[8:11], a[188:191], a[116:119], a[8:11]
M a[12:15], a[188:191], a[124:127], a[12:15]
M a[12:15], a[184:187], a[120:123], a[12:15]
M a[16:19], a[184:187], a[128:131], a[16:19]
M a[16:19], a[188:191], a[132:135], a[16:19]
buffer_load_dwordx4 v5, s[8:11], s23 offen offset:3072 lds
M a[20:23], a[188:191], a[140:143], a[20:23]
M a[20:23], a[184:187], a[136:139], a[20:23]
M a[24:27], a[184:187], a[144:147], a[24:27]
M a[24:27], a[188:191], a[148:151], a[24:27]
M a[28:31], a[188:191], a[156:159], a[28:31]
M a[28:31], a[184:187], a[152:155], a[28:31]
s_waitcnt lgkmcnt(2)
M v[32:35], a[160:163], a[32:35], v[32:35]
s_add_u32 m0, s29, 65536
s_nop 0
buffer_load_dwordx4 v6, s[12:15], s24 offen offset:0 lds
M v[32:35], a[164:167], a[36:39], v[32:35]
ds_read_b128 a[176:179], v10 offset:4096
ds_read_b128 a[180:183], v11 offset:4096
M v[36:39], a[164:167], a[44:47], v[36:39]
M v[36:39], a[160:163], a[40:43], v[36:39]
ds_read_b64_tr_b16 a[96:97], v12 offset:32768
ds_read_b64_tr_b16 a[98:99], v12 offset:34816
M v[40:43], a[160:163], a[48:51], v[40:43]
M v[40:43], a[164:167], a[52:55], v[40:43]
M v[44:47], a[164:167], a[60:63], v[44:47]
M v[44:47], a[160:163], a[56:59], v[44:47]
ds_read_b64_tr_b16 a[104:105], v13 offset:32768
ds_read_b64_tr_b16 a[106:107], v13 offset:34816
M v[48:51], a[160:163], a[64:67], v[48:51]
s_add_u32 s94, s93, 0
buffer_store_dwordx4 a[208:211], v1, s[16:19], s94 offen offset:0 sc1
M v[48:51], a[164:167], a[68:71], v[48:51]
buffer_load_dwordx4 v7, s[12:15], s24 offen offset:1024 lds
M v[52:55], a[164:167], a[76:79], v[52:55]
M v[52:55], a[160:163], a[72:75], v[52:55]
ds_read_b64_tr_b16 a[112:113], v14 offset:32768
ds_read_b64_tr_b16 a[114:115], v14 offset:34816
M v[56:59], a[160:163], a[80:83], v[56:59]
M v[56:59], a[164:167], a[84:87], v[56:59]
M v[60:63], a[164:167], a[92:95], v[60:63]
M v[60:63], a[160:163], a[88:91], v[60:63]
s_waitcnt lgkmcnt(8)
ds_read_b64_tr_b16 a[120:121], v15 offset:32768
ds_read_b64_tr_b16 a[122:123], v15 offset:34816
M v[64:67], a[168:171], a[32:35], v[64:67]
buffer_load_dwordx4 v8, s[12:15], s24 offen offset:2048 lds
M v[64:67], a[172:175], a[36:39], v[64:67]
ds_read_b128 a[184:187], v10 offset:6144
ds_read_b128 a[188:191], v11 offset:6144
M v[68:71], a[172:175], a[44:47], v[68:71]
M v[68:71], a[168:171], a[40:43], v[68:71]
ds_read_b64_tr_b16 a[128:129], v16 offset:32768
ds_read_b64_tr_b16 a[130:131], v16 offset:34816
M v[72:75], a[168:171], a[48:51], v[72:75]
M v[72:75], a[172:175], a[52:55], v[72:75]
M v[76:79], a[172:175], a[60:63], v[76:79]
M v[76:79], a[168:171], a[56:59], v[76:79]
ds_read_b64_tr_b16 a[136:137], v17 offset:32768
ds_read_b64_tr_b16 a[138:139], v17 offset:34816
M v[80:83], a[168:171], a[64:67], v[80:83]
buffer_load_dwordx4 v9, s[12:15], s24 offen offset:3072 lds
M v[80:83], a[172:175], a[68:71], v[80:83]
M v[84:87], a[172:175], a[76:79], v[84:87]
M v[84:87], a[168:171], a[72:75], v[84:87]
ds_read_b64_tr_b16 a[144:145], v18 offset:32768
ds_read_b64_tr_b16 a[146:147], v18 offset:34816
M v[88:91], a[168:171], a[80:83], v[88:91]
M v[88:91], a[172:175], a[84:87], v[88:91]
M v[92:95], a[172:175], a[92:95], v[92:95]
s_add_u32 s24, s24, 262144
M v[92:95], a[168:171], a[88:91], v[92:95]
s_waitcnt lgkmcnt(15)
ds_read_b64_tr_b16 a[152:153], v19 offset:32768
ds_read_b64_tr_b16 a[154:155], v19 offset:34816
M v[96:99], a[176:179], a[32:35], v[96:99]
M v[96:99], a[180:183], a[36:39], v[96:99]
M v[100:103], a[180:183], a[44:47], v[100:103]
M v[100:103], a[176:179], a[40:43], v[100:103]
M v[104:107], a[176:179], a[48:51], v[104:107]
s_add_u32 s94, s93, 0
buffer_store_dwordx4 a[212:215], v1, s[16:19], s94 offen offset:1024 sc1
M v[104:107], a[180:183], a[52:55], v[104:107]
M v[108:111], a[180:183], a[60:63], v[108:111]
M v[108:111], a[176:179], a[56:59], v[108:111]
s_waitcnt vmcnt(11) lgkmcnt(0)
s_barrier
ds_read_b128 a[160:163], v10 offset:16384
ds_read_b128 a[164:167], v11 offset:16384
M v[112:115], a[176:179], a[64:67], v[112:115]
s_add_u32 m0, s29, 49152
s_add_u32 s3, s23, s31
buffer_load_dwordx4 v2, s[8:11], s3 offen offset:0 lds
M v[112:115], a[180:183], a[68:71], v[112:115]
M v[116:119], a[180:183], a[76:79], v[116:119]
M v[116:119], a[176:179], a[72:75], v[116:119]
ds_read_b64_tr_b16 a[100:101], v12 offset:49152
ds_read_b64_tr_b16 a[102:103], v12 offset:51200
M v[120:123], a[176:179], a[80:83], v[120:123]
M v[120:123], a[180:183], a[84:87], v[120:123]
buffer_load_dwordx4 v3, s[8:11], s3 offen offset:1024 lds
M v[124:127], a[180:183], a[92:95], v[124:127]
M v[124:127], a[176:179], a[88:91], v[124:127]
M v[128:131], a[184:187], a[32:35], v[128:131]
M v[128:131], a[188:191], a[36:39], v[128:131]
ds_read_b128 a[168:171], v10 offset:18432
ds_read_b128 a[172:175], v11 offset:18432
ds_read_b64_tr_b16 a[108:109], v13 offset:49152
ds_read_b64_tr_b16 a[110:111], v13 offset:51200
M v[132:135], a[188:191], a[44:47], v[132:135]
M v[132:135], a[184:187], a[40:43], v[132:135]
M v[136:139], a[184:187], a[48:51], v[136:139]
buffer_load_dwordx4 v4, s[8:11], s3 offen offset:2048 lds
M v[136:139], a[188:191], a[52:55], v[136:139]
M v[140:143], a[188:191], a[60:63], v[140:143]
M v[140:143], a[184:187], a[56:59], v[140:143]
ds_read_b64_tr_b16 a[116:117], v14 offset:49152
ds_read_b64_tr_b16 a[118:119], v14 offset:51200
M v[144:147], a[184:187], a[64:67], v[144:147]
M v[144:147], a[188:191], a[68:71], v[144:147]
buffer_load_dwordx4 v5, s[8:11], s3 offen offset:3072 lds
M v[148:151], a[188:191], a[76:79], v[148:151]
M v[148:151], a[184:187], a[72:75], v[148:151]
M v[152:155], a[184:187], a[80:83], v[152:155]
M v[152:155], a[188:191], a[84:87], v[152:155]
ds_read_b64_tr_b16 a[124:125], v15 offset:49152
ds_read_b64_tr_b16 a[126:127], v15 offset:51200
M v[156:159], a[188:191], a[92:95], v[156:159]
M v[156:159], a[184:187], a[88:91], v[156:159]
s_waitcnt lgkmcnt(10)
M v[160:163], a[160:163], a[32:35], v[160:163]
s_add_u32 s94, s93, 0
buffer_store_dwordx4 a[216:219], v1, s[16:19], s94 offen offset:2048 sc1
M v[160:163], a[164:167], a[36:39], v[160:163]
ds_read_b128 a[176:179], v10 offset:20480
ds_read_b128 a[180:183], v11 offset:20480
M v[164:167], a[164:167], a[44:47], v[164:167]
s_add_u32 s23, s23, 128
s_cmp_eq_u32 s23, s25
s_cselect_b32 s23, s26, s23
M v[164:167], a[160:163], a[40:43], v[164:167]
ds_read_b64_tr_b16 a[132:133], v16 offset:49152
ds_read_b64_tr_b16 a[134:135], v16 offset:51200
M v[168:171], a[160:163], a[48:51], v[168:171]
M v[168:171], a[164:167], a[52:55], v[168:171]
M v[172:175], a[164:167], a[60:63], v[172:175]
M v[172:175], a[160:163], a[56:59], v[172:175]
M v[176:179], a[160:163], a[64:67], v[176:179]
s_add_u32 m0, s29, 81920
s_nop 0
buffer_load_dwordx4 v6, s[12:15], s24 offen offset:0 lds
M v[176:179], a[164:167], a[68:71], v[176:179]
ds_read_b64_tr_b16 a[140:141], v17 offset:49152
ds_read_b64_tr_b16 a[142:143], v17 offset:51200
M v[180:183], a[164:167], a[76:79], v[180:183]
M v[180:183], a[160:163], a[72:75], v[180:183]
M v[184:187], a[160:163], a[80:83], v[184:187]
M v[184:187], a[164:167], a[84:87], v[184:187]
buffer_load_dwordx4 v7, s[12:15], s24 offen offset:1024 lds
M v[188:191], a[164:167], a[92:95], v[188:191]
M v[188:191], a[160:163], a[88:91], v[188:191]
s_waitcnt lgkmcnt(12)
ds_read_b64_tr_b16 a[148:149], v18 offset:49152
ds_read_b64_tr_b16 a[150:151], v18 offset:51200
M v[192:195], a[168:171], a[32:35], v[192:195]
M v[192:195], a[172:175], a[36:39], v[192:195]
ds_read_b128 a[184:187], v10 offset:22528
ds_read_b128 a[188:191], v11 offset:22528
M v[196:199], a[172:175], a[44:47], v[196:199]
M v[196:199], a[168:171], a[40:43], v[196:199]
M v[200:203], a[168:171], a[48:51], v[200:203]
buffer_load_dwordx4 v8, s[12:15], s24 offen offset:2048 lds
M v[200:203], a[172:175], a[52:55], v[200:203]
ds_read_b64_tr_b16 a[156:157], v19 offset:49152
ds_read_b64_tr_b16 a[158:159], v19 offset:51200
M v[204:207], a[172:175], a[60:63], v[204:207]
M v[204:207], a[168:171], a[56:59], v[204:207]
M v[208:211], a[168:171], a[64:67], v[208:211]
M v[208:211], a[172:175], a[68:71], v[208:211]
buffer_load_dwordx4 v9, s[12:15], s24 offen offset:3072 lds
M v[212:215], a[172:175], a[76:79], v[212:215]
M v[212:215], a[168:171], a[72:75], v[212:215]
M v[216:219], a[168:171], a[80:83], v[216:219]
s_add_u32 s94, s93, 0
buffer_store_dwordx4 a[220:223], v1, s[16:19], s94 offen offset:3072 sc1
M v[216:219], a[172:175], a[84:87], v[216:219]
M v[220:223], a[172:175], a[92:95], v[220:223]
M v[220:223], a[168:171], a[88:91], v[220:223]
s_waitcnt lgkmcnt(10)
M v[224:227], a[176:179], a[32:35], v[224:227]
s_add_u32 s24, s24, 262144
s_cmp_eq_u32 s24, s27
s_cselect_b32 s24, s28, s24
s_sub_u32 s6, s6, 1
s_cmp_eq_u32 s6, 0
s_cselect_b64 s[12:13], s[64:65], s[12:13]
M v[224:227], a[180:183], a[36:39], v[224:227]
M v[228:231], a[180:183], a[44:47], v[228:231]
M v[228:231], a[176:179], a[40:43], v[228:231]
M v[232:235], a[176:179], a[48:51], v[232:235]
M v[232:235], a[180:183], a[52:55], v[232:235]
M v[236:239], a[180:183], a[60:63], v[236:239]
M v[236:239], a[176:179], a[56:59], v[236:239]
s_waitcnt vmcnt(11) lgkmcnt(0)
s_barrier
ds_read_b128 a[160:163], v10 offset:32768
ds_read_b128 a[164:167], v11 offset:32768
M v[240:243], a[176:179], a[64:67], v[240:243]
s_add_u32 m0, s29, 0
s_nop 0
buffer_load_dwordx4 v2, s[8:11], s23 offen offset:0 lds
M v[240:243], a[180:183], a[68:71], v[240:243]
M v[244:247], a[180:183], a[76:79], v[244:247]
M v[244:247], a[176:179], a[72:75], v[244:247]
M v[248:251], a[176:179], a[80:83], v[248:251]
M v[248:251], a[180:183], a[84:87], v[248:251]
buffer_load_dwordx4 v3, s[8:11], s23 offen offset:1024 lds
M v[252:255], a[180:183], a[92:95], v[252:255]
M v[252:255], a[176:179], a[88:91], v[252:255]
M a[0:3], a[184:187], a[32:35], a[0:3]
M a[0:3], a[188:191], a[36:39], a[0:3]
ds_read_b128 a[168:171], v10 offset:34816
ds_read_b128 a[172:175], v11 offset:34816
M a[4:7], a[188:191], a[44:47], a[4:7]
M a[4:7], a[184:187], a[40:43], a[4:7]
M a[8:11], a[184:187], a[48:51], a[8:11]
buffer_load_dwordx4 v4, s[8:11], s23 offen offset:2048 lds
M a[8:11], a[188:191], a[52:55], a[8:11]
M a[12:15], a[188:191], a[60:63], a[12:15]
M a[12:15], a[184:187], a[56:59], a[12:15]
M a[16:19], a[184:187], a[64:67], a[16:19]
M a[16:19], a[188:191], a[68:71], a[16:19]
buffer_load_dwordx4 v5, s[8:11], s23 offen offset:3072 lds
M a[20:23], a[188:191], a[76:79], a[20:23]
M a[20:23], a[184:187], a[72:75], a[20:23]
M a[24:27], a[184:187], a[80:83], a[24:27]
M a[24:27], a[188:191], a[84:87], a[24:27]
M a[28:31], a[188:191], a[92:95], a[28:31]
M a[28:31], a[184:187], a[88:91], a[28:31]
s_waitcnt lgkmcnt(2)
M v[32:35], a[160:163], a[96:99], v[32:35]
s_add_u32 m0, s29, 98304
s_nop 0
buffer_load_dwordx4 v6, s[12:15], s24 offen offset:0 lds
M v[32:35], a[164:167], a[100:103], v[32:35]
ds_read_b128 a[176:179], v10 offset:36864
ds_read_b128 a[180:183], v11 offset:36864
M v[36:39], a[164:167], a[108:111], v[36:39]
M v[36:39], a[160:163], a[104:107], v[36:39]
ds_read_b64_tr_b16 a[32:33], v12 offset:0
ds_read_b64_tr_b16 a[34:35], v12 offset:2048
M v[40:43], a[160:163], a[112:115], v[40:43]
M v[40:43], a[164:167], a[116:119], v[40:43]
M v[44:47], a[164:167], a[124:127], v[44:47]
M v[44:47], a[160:163], a[120:123], v[44:47]
ds_read_b64_tr_b16 a[40:41], v13 offset:0
ds_read_b64_tr_b16 a[42:43], v13 offset:2048
M v[48:51], a[160:163], a[128:131], v[48:51]
s_add_u32 s94, s93, 4096
buffer_store_dwordx4 a[224:227], v1, s[16:19], s94 offen offset:0 sc1
M v[48:51], a[164:167], a[132:135], v[48:51]
buffer_load_dwordx4 v7, s[12:15], s24 offen offset:1024 lds
M v[52:55], a[164:167], a[140:143], v[52:55]
M v[52:55], a[160:163], a[136:139], v[52:55]
ds_read_b64_tr_b16 a[48:49], v14 offset:0
ds_read_b64_tr_b16 a[50:51], v14 offset:2048
M v[56:59], a[160:163], a[144:147], v[56:59]
M v[56:59], a[164:167], a[148:151], v[56:59]
M v[60:63], a[164:167], a[156:159], v[60:63]
M v[60:63], a[160:163], a[152:155], v[60:63]
s_waitcnt lgkmcnt(8)
ds_read_b64_tr_b16 a[56:57], v15 offset:0
ds_read_b64_tr_b16 a[58:59], v15 offset:2048
M v[64:67], a[168:171], a[96:99], v[64:67]
buffer_load_dwordx4 v8, s[12:15], s24 offen offset:2048 lds
M v[64:67], a[172:175], a[100:103], v[64:67]
ds_read_b128 a[184:187], v10 offset:38912
ds_read_b128 a[188:191], v11 offset:38912
M v[68:71], a[172:175], a[108:111], v[68:71]
M v[68:71], a[168:171], a[104:107], v[68:71]
ds_read_b64_tr_b16 a[64:65], v16 offset:0
ds_read_b64_tr_b16 a[66:67], v16 offset:2048
M v[72:75], a[168:171], a[112:115], v[72:75]
M v[72:75], a[172:175], a[116:119], v[72:75]
M v[76:79], a[172:175], a[124:127], v[76:79]
M v[76:79], a[168:171], a[120:123], v[76:79]
ds_read_b64_tr_b16 a[72:73], v17 offset:0
ds_read_b64_tr_b16 a[74:75], v17 offset:2048
M v[80:83], a[168:171], a[128:131], v[80:83]
buffer_load_dwordx4 v9, s[12:15], s24 offen offset:3072 lds
M v[80:83], a[172:175], a[132:135], v[80:83]
M v[84:87], a[172:175], a[140:143], v[84:87]
M v[84:87], a[168:171], a[136:139], v[84:87]
ds_read_b64_tr_b16 a[80:81], v18 offset:0
ds_read_b64_tr_b16 a[82:83], v18 offset:2048
M v[88:91], a[168:171], a[144:147], v[88:91]
M v[88:91], a[172:175], a[148:151], v[88:91]
M v[92:95], a[172:175], a[156:159], v[92:95]
s_add_u32 s24, s24, 262144
M v[92:95], a[168:171], a[152:155], v[92:95]
s_waitcnt lgkmcnt(15)
ds_read_b64_tr_b16 a[88:89], v19 offset:0
ds_read_b64_tr_b16 a[90:91], v19 offset:2048
M v[96:99], a[176:179], a[96:99], v[96:99]
M v[96:99], a[180:183], a[100:103], v[96:99]
M v[100:103], a[180:183], a[108:111], v[100:103]
M v[100:103], a[176:179], a[104:107], v[100:103]
M v[104:107], a[176:179], a[112:115], v[104:107]
s_add_u32 s94, s93, 4096
buffer_store_dwordx4 a[228:231], v1, s[16:19], s94 offen offset:1024 sc1
M v[104:107], a[180:183], a[116:119], v[104:107]
M v[108:111], a[180:183], a[124:127], v[108:111]
M v[108:111], a[176:179], a[120:123], v[108:111]
s_waitcnt vmcnt(11) lgkmcnt(0)
s_barrier
ds_read_b128 a[160:163], v10 offset:49152
ds_read_b128 a[164:167], v11 offset:49152
M v[112:115], a[176:179], a[128:131], v[112:115]
s_add_u32 m0, s29, 16384
s_add_u32 s3, s23, s31
buffer_load_dwordx4 v2, s[8:11], s3 offen offset:0 lds
M v[112:115], a[180:183], a[132:135], v[112:115]
M v[116:119], a[180:183], a[140:143], v[116:119]
M v[116:119], a[176:179], a[136:139], v[116:119]
ds_read_b64_tr_b16 a[36:37], v12 offset:16384
ds_read_b64_tr_b16 a[38:39], v12 offset:18432
M v[120:123], a[176:179], a[144:147], v[120:123]
M v[120:123], a[180:183], a[148:151], v[120:123]
buffer_load_dwordx4 v3, s[8:11], s3 offen offset:1024 lds
M v[124:127], a[180:183], a[156:159], v[124:127]
M v[124:127], a[176:179], a[152:155], v[124:127]
M v[128:131], a[184:187], a[96:99], v[128:131]
M v[128:131], a[188:191], a[100:103], v[128:131]
ds_read_b128 a[168:171], v10 offset:51200
ds_read_b128 a[172:175], v11 offset:51200
ds_read_b64_tr_b16 a[44:45], v13 offset:16384
ds_read_b64_tr_b16 a[46:47], v13 offset:18432
M v[132:135], a[188:191], a[108:111], v[132:135]
M v[132:135], a[184:187], a[104:107], v[132:135]
M v[136:139], a[184:187], a[112:115], v[136:139]
buffer_load_dwordx4 v4, s[8:11], s3 offen offset:2048 lds
M v[136:139], a[188:191], a[116:119], v[136:139]
M v[140:143], a[188:191], a[124:127], v[140:143]
M v[140:143], a[184:187], a[120:123], v[140:143]
ds_read_b64_tr_b16 a[52:53], v14 offset:16384
ds_read_b64_tr_b16 a[54:55], v14 offset:18432
M v[144:147], a[184:187], a[128:131], v[144:147]
M v[144:147], a[188:191], a[132:135], v[144:147]
buffer_load_dwordx4 v5, s[8:11], s3 offen offset:3072 lds
M v[148:151], a[188:191], a[140:143], v[148:151]
M v[148:151], a[184:187], a[136:139], v[148:151]
M v[152:155], a[184:187], a[144:147], v[152:155]
M v[152:155], a[188:191], a[148:151], v[152:155]
ds_read_b64_tr_b16 a[60:61], v15 offset:16384
ds_read_b64_tr_b16 a[62:63], v15 offset:18432
M v[156:159], a[188:191], a[156:159], v[156:159]
M v[156:159], a[184:187], a[152:155], v[156:159]
s_waitcnt lgkmcnt(10)
M v[160:163], a[160:163], a[96:99], v[160:163]
s_add_u32 s94, s93, 4096
buffer_store_dwordx4 a[232:235], v1, s[16:19], s94 offen offset:2048 sc1
M v[160:163], a[164:167], a[100:103], v[160:163]
ds_read_b128 a[176:179], v10 offset:53248
ds_read_b128 a[180:183], v11 offset:53248
M v[164:167], a[164:167], a[108:111], v[164:167]
s_add_u32 s23, s23, 128
s_cmp_eq_u32 s23, s25
s_cselect_b32 s23, s26, s23
M v[164:167], a[160:163], a[104:107], v[164:167]
ds_read_b64_tr_b16 a[68:69], v16 offset:16384
ds_read_b64_tr_b16 a[70:71], v16 offset:18432
M v[168:171], a[160:163], a[112:115], v[168:171]
M v[168:171], a[164:167], a[116:119], v[168:171]
M v[172:175], a[164:167], a[124:127], v[172:175]
M v[172:175], a[160:163], a[120:123], v[172:175]
M v[176:179], a[160:163], a[128:131], v[176:179]
s_add_u32 m0, s29, 114688
s_nop 0
buffer_load_dwordx4 v6, s[12:15], s24 offen offset:0 lds
M v[176:179], a[164:167], a[132:135], v[176:179]
ds_read_b64_tr_b16 a[76:77], v17 offset:16384
ds_read_b64_tr_b16 a[78:79], v17 offset:18432
M v[180:183], a[164:167], a[140:143], v[180:183]
M v[180:183], a[160:163], a[136:139], v[180:183]
M v[184:187], a[160:163], a[144:147], v[184:187]
M v[184:187], a[164:167], a[148:151], v[184:187]
buffer_load_dwordx4 v7, s[12:15], s24 offen offset:1024 lds
M v[188:191], a[164:167], a[156:159], v[188:191]
M v[188:191], a[160:163], a[152:155], v[188:191]
s_waitcnt lgkmcnt(12)
ds_read_b64_tr_b16 a[84:85], v18 offset:16384
ds_read_b64_tr_b16 a[86:87], v18 offset:18432
M v[192:195], a[168:171], a[96:99], v[192:195]
M v[192:195], a[172:175], a[100:103], v[192:195]
ds_read_b128 a[184:187], v10 offset:55296
ds_read_b128 a[188:191], v11 offset:55296
M v[196:199], a[172:175], a[108:111], v[196:199]
M v[196:199], a[168:171], a[104:107], v[196:199]
M v[200:203], a[168:171], a[112:115], v[200:203]
buffer_load_dwordx4 v8, s[12:15], s24 offen offset:2048 lds
M v[200:203], a[172:175], a[116:119], v[200:203]
ds_read_b64_tr_b16 a[92:93], v19 offset:16384
ds_read_b64_tr_b16 a[94:95], v19 offset:18432
M v[204:207], a[172:175], a[124:127], v[204:207]
M v[204:207], a[168:171], a[120:123], v[204:207]
M v[208:211], a[168:171], a[128:131], v[208:211]
M v[208:211], a[172:175], a[132:135], v[208:211]
buffer_load_dwordx4 v9, s[12:15], s24 offen offset:3072 lds
M v[212:215], a[172:175], a[140:143], v[212:215]
M v[212:215], a[168:171], a[136:139], v[212:215]
M v[216:219], a[168:171], a[144:147], v[216:219]
s_add_u32 s94, s93, 4096
buffer_store_dwordx4 a[236:239], v1, s[16:19], s94 offen offset:3072 sc1
M v[216:219], a[172:175], a[148:151], v[216:219]
M v[220:223], a[172:175], a[156:159], v[220:223]
M v[220:223], a[168:171], a[152:155], v[220:223]
s_waitcnt lgkmcnt(10)
M v[224:227], a[176:179], a[96:99], v[224:227]
s_add_u32 s24, s24, 262144
s_cmp_eq_u32 s24, s27
s_cselect_b32 s24, s28, s24
s_sub_u32 s6, s6, 1
s_cmp_eq_u32 s6, 0
s_cselect_b64 s[12:13], s[64:65], s[12:13]
M v[224:227], a[180:183], a[100:103], v[224:227]
M v[228:231], a[180:183], a[108:111], v[228:231]
M v[228:231], a[176:179], a[104:107], v[228:231]
M v[232:235], a[176:179], a[112:115], v[232:235]
M v[232:235], a[180:183], a[116:119], v[232:235]
M v[236:239], a[180:183], a[124:127], v[236:239]
M v[236:239], a[176:179], a[120:123], v[236:239]
s_waitcnt vmcnt(11) lgkmcnt(0)
s_barrier
ds_read_b128 a[160:163], v10 offset:0
ds_read_b128 a[164:167], v11 offset:0
M v[240:243], a[176:179], a[128:131], v[240:243]
s_add_u32 m0, s29, 32768
s_nop 0
buffer_load_dwordx4 v2, s[8:11], s23 offen offset:0 lds
M v[240:243], a[180:183], a[132:135], v[240:243]
M v[244:247], a[180:183], a[140:143], v[244:247]
M v[244:247], a[176:179], a[136:139], v[244:247]
M v[248:251], a[176:179], a[144:147], v[248:251]
M v[248:251], a[180:183], a[148:151], v[248:251]
buffer_load_dwordx4 v3, s[8:11], s23 offen offset:1024 lds
M v[252:255], a[180:183], a[156:159], v[252:255]
M v[252:255], a[176:179], a[152:155], v[252:255]
M a[0:3], a[184:187], a[96:99], a[0:3]
M a[0:3], a[188:191], a[100:103], a[0:3]
ds_read_b128 a[168:171], v10 offset:2048
ds_read_b128 a[172:175], v11 offset:2048
M a[4:7], a[188:191], a[108:111], a[4:7]
M a[4:7], a[184:187], a[104:107], a[4:7]
M a[8:11], a[184:187], a[112:115], a[8:11]
buffer_load_dwordx4 v4, s[8:11], s23 offen offset:2048 lds
M a[8:11], a[188:191], a[116:119], a[8:11]
M a[12:15], a[188:191], a[124:127], a[12:15]
M a[12:15], a[184:187], a[120:123], a[12:15]
M a[16:19], a[184:187], a[128:131], a[16:19]
M a[16:19], a[188:191], a[132:135], a[16:19]
buffer_load_dwordx4 v5, s[8:11], s23 offen offset:3072 lds
M a[20:23], a[188:191], a[140:143], a[20:23]
M a[20:23], a[184:187], a[136:139], a[20:23]
M a[24:27], a[184:187], a[144:147], a[24:27]
M a[24:27], a[188:191], a[148:151], a[24:27]
M a[28:31], a[188:191], a[156:159], a[28:31]
M a[28:31], a[184:187], a[152:155], a[28:31]
s_waitcnt lgkmcnt(2)
M v[32:35], a[160:163], a[32:35], v[32:35]
s_add_u32 m0, s29, 65536
s_nop 0
buffer_load_dwordx4 v6, s[12:15], s24 offen offset:0 lds
M v[32:35], a[164:167], a[36:39], v[32:35]
ds_read_b128 a[176:179], v10 offset:4096
ds_read_b128 a[180:183], v11 offset:4096
M v[36:39], a[164:167], a[44:47], v[36:39]
M v[36:39], a[160:163], a[40:43], v[36:39]
ds_read_b64_tr_b16 a[96:97], v12 offset:32768
ds_read_b64_tr_b16 a[98:99], v12 offset:34816
M v[40:43], a[160:163], a[48:51], v[40:43]
M v[40:43], a[164:167], a[52:55], v[40:43]
M v[44:47], a[164:167], a[60:63], v[44:47]
M v[44:47], a[160:163], a[56:59], v[44:47]
ds_read_b64_tr_b16 a[104:105], v13 offset:32768
ds_read_b64_tr_b16 a[106:107], v13 offset:34816
M v[48:51], a[160:163], a[64:67], v[48:51]
s_add_u32 s94, s93, 8192
buffer_store_dwordx4 a[240:243], v1, s[16:19], s94 offen offset:0 sc1
M v[48:51], a[164:167], a[68:71], v[48:51]
buffer_load_dwordx4 v7, s[12:15], s24 offen offset:1024 lds
M v[52:55], a[164:167], a[76:79], v[52:55]
M v[52:55], a[160:163], a[72:75], v[52:55]
ds_read_b64_tr_b16 a[112:113], v14 offset:32768
ds_read_b64_tr_b16 a[114:115], v14 offset:34816
M v[56:59], a[160:163], a[80:83], v[56:59]
M v[56:59], a[164:167], a[84:87], v[56:59]
M v[60:63], a[164:167], a[92:95], v[60:63]
M v[60:63], a[160:163], a[88:91], v[60:63]
s_waitcnt lgkmcnt(8)
ds_read_b64_tr_b16 a[120:121], v15 offset:32768
ds_read_b64_tr_b16 a[122:123], v15 offset:34816
M v[64:67], a[168:171], a[32:35], v[64:67]
buffer_load_dwordx4 v8, s[12:15], s24 offen offset:2048 lds
M v[64:67], a[172:175], a[36:39], v[64:67]
ds_read_b128 a[184:187], v10 offset:6144
ds_read_b128 a[188:191], v11 offset:6144
M v[68:71], a[172:175], a[44:47], v[68:71]
M v[68:71], a[168:171], a[40:43], v[68:71]
ds_read_b64_tr_b16 a[128:129], v16 offset:32768
ds_read_b64_tr_b16 a[130:131], v16 offset:34816
M v[72:75], a[168:171], a[48:51], v[72:75]
M v[72:75], a[172:175], a[52:55], v[72:75]
M v[76:79], a[172:175], a[60:63], v[76:79]
M v[76:79], a[168:171], a[56:59], v[76:79]
ds_read_b64_tr_b16 a[136:137], v17 offset:32768
ds_read_b64_tr_b16 a[138:139], v17 offset:34816
M v[80:83], a[168:171], a[64:67], v[80:83]
buffer_load_dwordx4 v9, s[12:15], s24 offen offset:3072 lds
M v[80:83], a[172:175], a[68:71], v[80:83]
M v[84:87], a[172:175], a[76:79], v[84:87]
M v[84:87], a[168:171], a[72:75], v[84:87]
ds_read_b64_tr_b16 a[144:145], v18 offset:32768
ds_read_b64_tr_b16 a[146:147], v18 offset:34816
M v[88:91], a[168:171], a[80:83], v[88:91]
M v[88:91], a[172:175], a[84:87], v[88:91]
M v[92:95], a[172:175], a[92:95], v[92:95]
s_add_u32 s24, s24, 262144
M v[92:95], a[168:171], a[88:91], v[92:95]
s_waitcnt lgkmcnt(15)
ds_read_b64_tr_b16 a[152:153], v19 offset:32768
ds_read_b64_tr_b16 a[154:155], v19 offset:34816
M v[96:99], a[176:179], a[32:35], v[96:99]
M v[96:99], a[180:183], a[36:39], v[96:99]
M v[100:103], a[180:183], a[44:47], v[100:103]
M v[100:103], a[176:179], a[40:43], v[100:103]
M v[104:107], a[176:179], a[48:51], v[104:107]
s_add_u32 s94, s93, 8192
buffer_store_dwordx4 a[244:247], v1, s[16:19], s94 offen offset:1024 sc1
M v[104:107], a[180:183], a[52:55], v[104:107]
M v[108:111], a[180:183], a[60:63], v[108:111]
M v[108:111], a[176:179], a[56:59], v[108:111]
s_waitcnt vmcnt(11) lgkmcnt(0)
s_barrier
ds_read_b128 a[160:163], v10 offset:16384
ds_read_b128 a[164:167], v11 offset:16384
M v[112:115], a[176:179], a[64:67], v[112:115]
s_add_u32 m0, s29, 49152
s_add_u32 s3, s23, s31
buffer_load_dwordx4 v2, s[8:11], s3 offen offset:0 lds
M v[112:115], a[180:183], a[68:71], v[112:115]
M v[116:119], a[180:183], a[76:79], v[116:119]
M v[116:119], a[176:179], a[72:75], v[116:119]
ds_read_b64_tr_b16 a[100:101], v12 offset:49152
ds_read_b64_tr_b16 a[102:103], v12 offset:51200
M v[120:123], a[176:179], a[80:83], v[120:123]
M v[120:123], a[180:183], a[84:87], v[120:123]
buffer_load_dwordx4 v3, s[8:11], s3 offen offset:1024 lds
M v[124:127], a[180:183], a[92:95], v[124:127]
M v[124:127], a[176:179], a[88:91], v[124:127]
M v[128:131], a[184:187], a[32:35], v[128:131]
M v[128:131], a[188:191], a[36:39], v[128:131]
ds_read_b128 a[168:171], v10 offset:18432
ds_read_b128 a[172:175], v11 offset:18432
ds_read_b64_tr_b16 a[108:109], v13 offset:49152
ds_read_b64_tr_b16 a[110:111], v13 offset:51200
M v[132:135], a[188:191], a[44:47], v[132:135]
M v[132:135], a[184:187], a[40:43], v[132:135]
M v[136:139], a[184:187], a[48:51], v[136:139]
buffer_load_dwordx4 v4, s[8:11], s3 offen offset:2048 lds
M v[136:139], a[188:191], a[52:55], v[136:139]
M v[140:143], a[188:191], a[60:63], v[140:143]
M v[140:143], a[184:187], a[56:59], v[140:143]
ds_read_b64_tr_b16 a[116:117], v14 offset:49152
ds_read_b64_tr_b16 a[118:119], v14 offset:51200
M v[144:147], a[184:187], a[64:67], v[144:147]
M v[144:147], a[188:191], a[68:71], v[144:147]
buffer_load_dwordx4 v5, s[8:11], s3 offen offset:3072 lds
M v[148:151], a[188:191], a[76:79], v[148:151]
M v[148:151], a[184:187], a[72:75], v[148:151]
M v[152:155], a[184:187], a[80:83], v[152:155]
M v[152:155], a[188:191], a[84:87], v[152:155]
ds_read_b64_tr_b16 a[124:125], v15 offset:49152
ds_read_b64_tr_b16 a[126:127], v15 offset:51200
M v[156:159], a[188:191], a[92:95], v[156:159]
M v[156:159], a[184:187], a[88:91], v[156:159]
s_waitcnt lgkmcnt(10)
M v[160:163], a[160:163], a[32:35], v[160:163]
s_add_u32 s94, s93, 8192
buffer_store_dwordx4 a[248:251], v1, s[16:19], s94 offen offset:2048 sc1
M v[160:163], a[164:167], a[36:39], v[160:163]
ds_read_b128 a[176:179], v10 offset:20480
ds_read_b128 a[180:183], v11 offset:20480
M v[164:167], a[164:167], a[44:47], v[164:167]
s_add_u32 s23, s23, 128
s_cmp_eq_u32 s23, s25
s_cselect_b32 s23, s26, s23
M v[164:167], a[160:163], a[40:43], v[164:167]
ds_read_b64_tr_b16 a[132:133], v16 offset:49152
ds_read_b64_tr_b16 a[134:135], v16 offset:51200
M v[168:171], a[160:163], a[48:51], v[168:171]
M v[168:171], a[164:167], a[52:55], v[168:171]
M v[172:175], a[164:167], a[60:63], v[172:175]
M v[172:175], a[160:163], a[56:59], v[172:175]
M v[176:179], a[160:163], a[64:67], v[176:179]
s_add_u32 m0, s29, 81920
s_nop 0
buffer_load_dwordx4 v6, s[12:15], s24 offen offset:0 lds
M v[176:179], a[164:167], a[68:71], v[176:179]
ds_read_b64_tr_b16 a[140:141], v17 offset:49152
ds_read_b64_tr_b16 a[142:143], v17 offset:51200
M v[180:183], a[164:167], a[76:79], v[180:183]
M v[180:183], a[160:163], a[72:75], v[180:183]
M v[184:187], a[160:163], a[80:83], v[184:187]
M v[184:187], a[164:167], a[84:87], v[184:187]
buffer_load_dwordx4 v7, s[12:15], s24 offen offset:1024 lds
M v[188:191], a[164:167], a[92:95], v[188:191]
M v[188:191], a[160:163], a[88:91], v[188:191]
s_waitcnt lgkmcnt(12)
ds_read_b64_tr_b16 a[148:149], v18 offset:49152
ds_read_b64_tr_b16 a[150:151], v18 offset:51200
M v[192:195], a[168:171], a[32:35], v[192:195]
M v[192:195], a[172:175], a[36:39], v[192:195]
ds_read_b128 a[184:187], v10 offset:22528
ds_read_b128 a[188:191], v11 offset:22528
M v[196:199], a[172:175], a[44:47], v[196:199]
M v[196:199], a[168:171], a[40:43], v[196:199]
M v[200:203], a[168:171], a[48:51], v[200:203]
buffer_load_dwordx4 v8, s[12:15], s24 offen offset:2048 lds
M v[200:203], a[172:175], a[52:55], v[200:203]
ds_read_b64_tr_b16 a[156:157], v19 offset:49152
ds_read_b64_tr_b16 a[158:159], v19 offset:51200
M v[204:207], a[172:175], a[60:63], v[204:207]
M v[204:207], a[168:171], a[56:59], v[204:207]
M v[208:211], a[168:171], a[64:67], v[208:211]
M v[208:211], a[172:175], a[68:71], v[208:211]
buffer_load_dwordx4 v9, s[12:15], s24 offen offset:3072 lds
M v[212:215], a[172:175], a[76:79], v[212:215]
M v[212:215], a[168:171], a[72:75], v[212:215]
M v[216:219], a[168:171], a[80:83], v[216:219]
s_add_u32 s94, s93, 8192
buffer_store_dwordx4 a[252:255], v1, s[16:19], s94 offen offset:3072 sc1
M v[216:219], a[172:175], a[84:87], v[216:219]
M v[220:223], a[172:175], a[92:95], v[220:223]
M v[220:223], a[168:171], a[88:91], v[220:223]
s_waitcnt lgkmcnt(10)
M v[224:227], a[176:179], a[32:35], v[224:227]
s_add_u32 s24, s24, 262144
s_cmp_eq_u32 s24, s27
s_cselect_b32 s24, s28, s24
s_sub_u32 s6, s6, 1
s_cmp_eq_u32 s6, 0
s_cselect_b64 s[12:13], s[64:65], s[12:13]
M v[224:227], a[180:183], a[36:39], v[224:227]
M v[228:231], a[180:183], a[44:47], v[228:231]
M v[228:231], a[176:179], a[40:43], v[228:231]
M v[232:235], a[176:179], a[48:51], v[232:235]
M v[232:235], a[180:183], a[52:55], v[232:235]
M v[236:239], a[180:183], a[60:63], v[236:239]
M v[236:239], a[176:179], a[56:59], v[236:239]
s_waitcnt vmcnt(11) lgkmcnt(0)
s_barrier
ds_read_b128 a[160:163], v10 offset:32768
ds_read_b128 a[164:167], v11 offset:32768
M v[240:243], a[176:179], a[64:67], v[240:243]
s_add_u32 m0, s29, 0
s_nop 0
buffer_load_dwordx4 v2, s[8:11], s23 offen offset:0 lds
M v[240:243], a[180:183], a[68:71], v[240:243]
M v[244:247], a[180:183], a[76:79], v[244:247]
M v[244:247], a[176:179], a[72:75], v[244:247]
M v[248:251], a[176:179], a[80:83], v[248:251]
M v[248:251], a[180:183], a[84:87], v[248:251]
buffer_load_dwordx4 v3, s[8:11], s23 offen offset:1024 lds
M v[252:255], a[180:183], a[92:95], v[252:255]
M v[252:255], a[176:179], a[88:91], v[252:255]
M a[0:3], a[184:187], a[32:35], a[0:3]
M a[0:3], a[188:191], a[36:39], a[0:3]
ds_read_b128 a[168:171], v10 offset:34816
ds_read_b128 a[172:175], v11 offset:34816
M a[4:7], a[188:191], a[44:47], a[4:7]
M a[4:7], a[184:187], a[40:43], a[4:7]
M a[8:11], a[184:187], a[48:51], a[8:11]
buffer_load_dwordx4 v4, s[8:11], s23 offen offset:2048 lds
M a[8:11], a[188:191], a[52:55], a[8:11]
M a[12:15], a[188:191], a[60:63], a[12:15]
M a[12:15], a[184:187], a[56:59], a[12:15]
M a[16:19], a[184:187], a[64:67], a[16:19]
M a[16:19], a[188:191], a[68:71], a[16:19]
buffer_load_dwordx4 v5, s[8:11], s23 offen offset:3072 lds
M a[20:23], a[188:191], a[76:79], a[20:23]
M a[20:23], a[184:187], a[72:75], a[20:23]
M a[24:27], a[184:187], a[80:83], a[24:27]
M a[24:27], a[188:191], a[84:87], a[24:27]
M a[28:31], a[188:191], a[92:95], a[28:31]
M a[28:31], a[184:187], a[88:91], a[28:31]
s_waitcnt lgkmcnt(2)
M v[32:35], a[160:163], a[96:99], v[32:35]
s_add_u32 m0, s29, 98304
s_nop 0
buffer_load_dwordx4 v6, s[12:15], s24 offen offset:0 lds
M v[32:35], a[164:167], a[100:103], v[32:35]
ds_read_b128 a[176:179], v10 offset:36864
ds_read_b128 a[180:183], v11 offset:36864
M v[36:39], a[164:167], a[108:111], v[36:39]
M v[36:39], a[160:163], a[104:107], v[36:39]
ds_read_b64_tr_b16 a[32:33], v12 offset:0
ds_read_b64_tr_b16 a[34:35], v12 offset:2048
M v[40:43], a[160:163], a[112:115], v[40:43]
M v[40:43], a[164:167], a[116:119], v[40:43]
M v[44:47], a[164:167], a[124:127], v[44:47]
M v[44:47], a[160:163], a[120:123], v[44:47]
ds_read_b64_tr_b16 a[40:41], v13 offset:0
ds_read_b64_tr_b16 a[42:43], v13 offset:2048
M v[48:51], a[160:163], a[128:131], v[48:51]
buffer_load_dwordx4 v7, s[12:15], s24 offen offset:1024 lds
M v[48:51], a[164:167], a[132:135], v[48:51]
M v[52:55], a[164:167], a[140:143], v[52:55]
M v[52:55], a[160:163], a[136:139], v[52:55]
ds_read_b64_tr_b16 a[48:49], v14 offset:0
ds_read_b64_tr_b16 a[50:51], v14 offset:2048
M v[56:59], a[160:163], a[144:147], v[56:59]
M v[56:59], a[164:167], a[148:151], v[56:59]
M v[60:63], a[164:167], a[156:159], v[60:63]
buffer_load_dwordx4 v8, s[12:15], s24 offen offset:2048 lds
M v[60:63], a[160:163], a[152:155], v[60:63]
s_waitcnt lgkmcnt(8)
ds_read_b64_tr_b16 a[56:57], v15 offset:0
ds_read_b64_tr_b16 a[58:59], v15 offset:2048
M v[64:67], a[168:171], a[96:99], v[64:67]
M v[64:67], a[172:175], a[100:103], v[64:67]
ds_read_b128 a[184:187], v10 offset:38912
ds_read_b128 a[188:191], v11 offset:38912
M v[68:71], a[172:175], a[108:111], v[68:71]
M v[68:71], a[168:171], a[104:107], v[68:71]
ds_read_b64_tr_b16 a[64:65], v16 offset:0
ds_read_b64_tr_b16 a[66:67], v16 offset:2048
M v[72:75], a[168:171], a[112:115], v[72:75]
M v[72:75], a[172:175], a[116:119], v[72:75]
M v[76:79], a[172:175], a[124:127], v[76:79]
M v[76:79], a[168:171], a[120:123], v[76:79]
ds_read_b64_tr_b16 a[72:73], v17 offset:0
ds_read_b64_tr_b16 a[74:75], v17 offset:2048
M v[80:83], a[168:171], a[128:131], v[80:83]
buffer_load_dwordx4 v9, s[12:15], s24 offen offset:3072 lds
M v[80:83], a[172:175], a[132:135], v[80:83]
M v[84:87], a[172:175], a[140:143], v[84:87]
M v[84:87], a[168:171], a[136:139], v[84:87]
ds_read_b64_tr_b16 a[80:81], v18 offset:0
ds_read_b64_tr_b16 a[82:83], v18 offset:2048
M v[88:91], a[168:171], a[144:147], v[88:91]
M v[88:91], a[172:175], a[148:151], v[88:91]
M v[92:95], a[172:175], a[156:159], v[92:95]
s_add_u32 s24, s24, 262144
M v[92:95], a[168:171], a[152:155], v[92:95]
s_waitcnt lgkmcnt(15)
ds_read_b64_tr_b16 a[88:89], v19 offset:0
ds_read_b64_tr_b16 a[90:91], v19 offset:2048
M v[96:99], a[176:179], a[96:99], v[96:99]
M v[96:99], a[180:183], a[100:103], v[96:99]
M v[100:103], a[180:183], a[108:111], v[100:103]
M v[100:103], a[176:179], a[104:107], v[100:103]
M v[104:107], a[176:179], a[112:115], v[104:107]
M v[104:107], a[180:183], a[116:119], v[104:107]
M v[108:111], a[180:183], a[124:127], v[108:111]
M v[108:111], a[176:179], a[120:123], v[108:111]
s_waitcnt vmcnt(9) lgkmcnt(0)
s_barrier
ds_read_b128 a[160:163], v10 offset:49152
ds_read_b128 a[164:167], v11 offset:49152
M v[112:115], a[176:179], a[128:131], v[112:115]
s_add_u32 m0, s29, 16384
s_add_u32 s3, s23, s31
buffer_load_dwordx4 v2, s[8:11], s3 offen offset:0 lds
M v[112:115], a[180:183], a[132:135], v[112:115]
M v[116:119], a[180:183], a[140:143], v[116:119]
M v[116:119], a[176:179], a[136:139], v[116:119]
ds_read_b64_tr_b16 a[36:37], v12 offset:16384
ds_read_b64_tr_b16 a[38:39], v12 offset:18432
M v[120:123], a[176:179], a[144:147], v[120:123]
M v[120:123], a[180:183], a[148:151], v[120:123]
buffer_load_dwordx4 v3, s[8:11], s3 offen offset:1024 lds
M v[124:127], a[180:183], a[156:159], v[124:127]
M v[124:127], a[176:179], a[152:155], v[124:127]
M v[128:131], a[184:187], a[96:99], v[128:131]
M v[128:131], a[188:191], a[100:103], v[128:131]
ds_read_b128 a[168:171], v10 offset:51200
ds_read_b128 a[172:175], v11 offset:51200
ds_read_b64_tr_b16 a[44:45], v13 offset:16384
ds_read_b64_tr_b16 a[46:47], v13 offset:18432
M v[132:135], a[188:191], a[108:111], v[132:135]
M v[132:135], a[184:187], a[104:107], v[132:135]
M v[136:139], a[184:187], a[112:115], v[136:139]
buffer_load_dwordx4 v4, s[8:11], s3 offen offset:2048 lds
M v[136:139], a[188:191], a[116:119], v[136:139]
M v[140:143], a[188:191], a[124:127], v[140:143]
M v[140:143], a[184:187], a[120:123], v[140:143]
ds_read_b64_tr_b16 a[52:53], v14 offset:16384
ds_read_b64_tr_b16 a[54:55], v14 offset:18432
M v[144:147], a[184:187], a[128:131], v[144:147]
M v[144:147], a[188:191], a[132:135], v[144:147]
M v[148:151], a[188:191], a[140:143], v[148:151]
buffer_load_dwordx4 v5, s[8:11], s3 offen offset:3072 lds
M v[148:151], a[184:187], a[136:139], v[148:151]
M v[152:155], a[184:187], a[144:147], v[152:155]
M v[152:155], a[188:191], a[148:151], v[152:155]
ds_read_b64_tr_b16 a[60:61], v15 offset:16384
ds_read_b64_tr_b16 a[62:63], v15 offset:18432
M v[156:159], a[188:191], a[156:159], v[156:159]
M v[156:159], a[184:187], a[152:155], v[156:159]
s_waitcnt lgkmcnt(10)
M v[160:163], a[160:163], a[96:99], v[160:163]
M v[160:163], a[164:167], a[100:103], v[160:163]
ds_read_b128 a[176:179], v10 offset:53248
ds_read_b128 a[180:183], v11 offset:53248
M v[164:167], a[164:167], a[108:111], v[164:167]
s_add_u32 s23, s23, 128
s_cmp_eq_u32 s23, s25
s_cselect_b32 s23, s26, s23
M v[164:167], a[160:163], a[104:107], v[164:167]
ds_read_b64_tr_b16 a[68:69], v16 offset:16384
ds_read_b64_tr_b16 a[70:71], v16 offset:18432
M v[168:171], a[160:163], a[112:115], v[168:171]
M v[168:171], a[164:167], a[116:119], v[168:171]
M v[172:175], a[164:167], a[124:127], v[172:175]
M v[172:175], a[160:163], a[120:123], v[172:175]
M v[176:179], a[160:163], a[128:131], v[176:179]
s_add_u32 m0, s29, 114688
s_nop 0
buffer_load_dwordx4 v6, s[12:15], s24 offen offset:0 lds
M v[176:179], a[164:167], a[132:135], v[176:179]
ds_read_b64_tr_b16 a[76:77], v17 offset:16384
ds_read_b64_tr_b16 a[78:79], v17 offset:18432
M v[180:183], a[164:167], a[140:143], v[180:183]
M v[180:183], a[160:163], a[136:139], v[180:183]
M v[184:187], a[160:163], a[144:147], v[184:187]
M v[184:187], a[164:167], a[148:151], v[184:187]
buffer_load_dwordx4 v7, s[12:15], s24 offen offset:1024 lds
M v[188:191], a[164:167], a[156:159], v[188:191]
M v[188:191], a[160:163], a[152:155], v[188:191]
s_waitcnt lgkmcnt(12)
ds_read_b64_tr_b16 a[84:85], v18 offset:16384
ds_read_b64_tr_b16 a[86:87], v18 offset:18432
M v[192:195], a[168:171], a[96:99], v[192:195]
M v[192:195], a[172:175], a[100:103], v[192:195]
ds_read_b128 a[184:187], v10 offset:55296
ds_read_b128 a[188:191], v11 offset:55296
M v[196:199], a[172:175], a[108:111], v[196:199]
M v[196:199], a[168:171], a[104:107], v[196:199]
M v[200:203], a[168:171], a[112:115], v[200:203]
buffer_load_dwordx4 v8, s[12:15], s24 offen offset:2048 lds
M v[200:203], a[172:175], a[116:119], v[200:203]
ds_read_b64_tr_b16 a[92:93], v19 offset:16384
ds_read_b64_tr_b16 a[94:95], v19 offset:18432
M v[204:207], a[172:175], a[124:127], v[204:207]
M v[204:207], a[168:171], a[120:123], v[204:207]
M v[208:211], a[168:171], a[128:131], v[208:211]
M v[208:211], a[172:175], a[132:135], v[208:211]
M v[212:215], a[172:175], a[140:143], v[212:215]
buffer_load_dwordx4 v9, s[12:15], s24 offen offset:3072 lds
M v[212:215], a[168:171], a[136:139], v[212:215]
M v[216:219], a[168:171], a[144:147], v[216:219]
M v[216:219], a[172:175], a[148:151], v[216:219]
M v[220:223], a[172:175], a[156:159], v[220:223]
M v[220:223], a[168:171], a[152:155], v[220:223]
s_waitcnt lgkmcnt(10)
M v[224:227], a[176:179], a[96:99], v[224:227]
s_add_u32 s24, s24, 262144
s_cmp_eq_u32 s24, s27
s_cselect_b32 s24, s28, s24
s_sub_u32 s6, s6, 1
s_cmp_eq_u32 s6, 0
s_cselect_b64 s[12:13], s[64:65], s[12:13]
M v[224:227], a[180:183], a[100:103], v[224:227]
M v[228:231], a[180:183], a[108:111], v[228:231]
M v[228:231], a[176:179], a[104:107], v[228:231]
M v[232:235], a[176:179], a[112:115], v[232:235]
M v[232:235], a[180:183], a[116:119], v[232:235]
M v[236:239], a[180:183], a[124:127], v[236:239]
M v[236:239], a[176:179], a[120:123], v[236:239]
s_waitcnt vmcnt(8) lgkmcnt(0)
s_barrier
ds_read_b128 a[160:163], v10 offset:0
ds_read_b128 a[164:167], v11 offset:0
M v[240:243], a[176:179], a[128:131], v[240:243]
s_add_u32 m0, s29, 32768
s_nop 0
buffer_load_dwordx4 v2, s[8:11], s23 offen offset:0 lds
M v[240:243], a[180:183], a[132:135], v[240:243]
M v[244:247], a[180:183], a[140:143], v[244:247]
M v[244:247], a[176:179], a[136:139], v[244:247]
M v[248:251], a[176:179], a[144:147], v[248:251]
M v[248:251], a[180:183], a[148:151], v[248:251]
M v[252:255], a[180:183], a[156:159], v[252:255]
M v[252:255], a[176:179], a[152:155], v[252:255]
M a[0:3], a[184:187], a[96:99], a[0:3]
M a[0:3], a[188:191], a[100:103], a[0:3]
ds_read_b128 a[168:171], v10 offset:2048
ds_read_b128 a[172:175], v11 offset:2048
M a[4:7], a[188:191], a[108:111], a[4:7]
M a[4:7], a[184:187], a[104:107], a[4:7]
M a[8:11], a[184:187], a[112:115], a[8:11]
buffer_load_dwordx4 v3, s[8:11], s23 offen offset:1024 lds
M a[8:11], a[188:191], a[116:119], a[8:11]
M a[12:15], a[188:191], a[124:127], a[12:15]
M a[12:15], a[184:187], a[120:123], a[12:15]
M a[16:19], a[184:187], a[128:131], a[16:19]
M a[16:19], a[188:191], a[132:135], a[16:19]
M a[20:23], a[188:191], a[140:143], a[20:23]
M a[20:23], a[184:187], a[136:139], a[20:23]
M a[24:27], a[184:187], a[144:147], a[24:27]
M a[24:27], a[188:191], a[148:151], a[24:27]
M a[28:31], a[188:191], a[156:159], a[28:31]
M a[28:31], a[184:187], a[152:155], a[28:31]
s_waitcnt lgkmcnt(2)
M v[32:35], a[160:163], a[32:35], v[32:35]
buffer_load_dwordx4 v4, s[8:11], s23 offen offset:2048 lds
M v[32:35], a[164:167], a[36:39], v[32:35]
ds_read_b128 a[176:179], v10 offset:4096
ds_read_b128 a[180:183], v11 offset:4096
M v[36:39], a[164:167], a[44:47], v[36:39]
M v[36:39], a[160:163], a[40:43], v[36:39]
ds_read_b64_tr_b16 a[96:97], v12 offset:32768
ds_read_b64_tr_b16 a[98:99], v12 offset:34816
M v[40:43], a[160:163], a[48:51], v[40:43]
M v[40:43], a[164:167], a[52:55], v[40:43]
M v[44:47], a[164:167], a[60:63], v[44:47]
M v[44:47], a[160:163], a[56:59], v[44:47]
ds_read_b64_tr_b16 a[104:105], v13 offset:32768
ds_read_b64_tr_b16 a[106:107], v13 offset:34816
M v[48:51], a[160:163], a[64:67], v[48:51]
M v[48:51], a[164:167], a[68:71], v[48:51]
M v[52:55], a[164:167], a[76:79], v[52:55]
M v[52:55], a[160:163], a[72:75], v[52:55]
ds_read_b64_tr_b16 a[112:113], v14 offset:32768
ds_read_b64_tr_b16 a[114:115], v14 offset:34816
M v[56:59], a[160:163], a[80:83], v[56:59]
M v[56:59], a[164:167], a[84:87], v[56:59]
M v[60:63], a[164:167], a[92:95], v[60:63]
M v[60:63], a[160:163], a[88:91], v[60:63]
s_waitcnt lgkmcnt(8)
ds_read_b64_tr_b16 a[120:121], v15 offset:32768
ds_read_b64_tr_b16 a[122:123], v15 offset:34816
M v[64:67], a[168:171], a[32:35], v[64:67]
M v[64:67], a[172:175], a[36:39], v[64:67]
ds_read_b128 a[184:187], v10 offset:6144
ds_read_b128 a[188:191], v11 offset:6144
M v[68:71], a[172:175], a[44:47], v[68:71]
M v[68:71], a[168:171], a[40:43], v[68:71]
ds_read_b64_tr_b16 a[128:129], v16 offset:32768
ds_read_b64_tr_b16 a[130:131], v16 offset:34816
M v[72:75], a[168:171], a[48:51], v[72:75]
buffer_load_dwordx4 v5, s[8:11], s23 offen offset:3072 lds
M v[72:75], a[172:175], a[52:55], v[72:75]
M v[76:79], a[172:175], a[60:63], v[76:79]
M v[76:79], a[168:171], a[56:59], v[76:79]
ds_read_b64_tr_b16 a[136:137], v17 offset:32768
ds_read_b64_tr_b16 a[138:139], v17 offset:34816
M v[80:83], a[168:171], a[64:67], v[80:83]
M v[80:83], a[172:175], a[68:71], v[80:83]
M v[84:87], a[172:175], a[76:79], v[84:87]
M v[84:87], a[168:171], a[72:75], v[84:87]
ds_read_b64_tr_b16 a[144:145], v18 offset:32768
ds_read_b64_tr_b16 a[146:147], v18 offset:34816
M v[88:91], a[168:171], a[80:83], v[88:91]
M v[88:91], a[172:175], a[84:87], v[88:91]
M v[92:95], a[172:175], a[92:95], v[92:95]
M v[92:95], a[168:171], a[88:91], v[92:95]
s_waitcnt lgkmcnt(15)
ds_read_b64_tr_b16 a[152:153], v19 offset:32768
ds_read_b64_tr_b16 a[154:155], v19 offset:34816
M v[96:99], a[176:179], a[32:35], v[96:99]
M v[96:99], a[180:183], a[36:39], v[96:99]
M v[100:103], a[180:183], a[44:47], v[100:103]
M v[100:103], a[176:179], a[40:43], v[100:103]
M v[104:107], a[176:179], a[48:51], v[104:107]
M v[104:107], a[180:183], a[52:55], v[104:107]
M v[108:111], a[180:183], a[60:63], v[108:111]
M v[108:111], a[176:179], a[56:59], v[108:111]
s_waitcnt vmcnt(4) lgkmcnt(0)
s_barrier
ds_read_b128 a[160:163], v10 offset:16384
ds_read_b128 a[164:167], v11 offset:16384
M v[112:115], a[176:179], a[64:67], v[112:115]
s_add_u32 m0, s29, 49152
s_add_u32 s3, s23, s31
buffer_load_dwordx4 v2, s[8:11], s3 offen offset:0 lds
M v[112:115], a[180:183], a[68:71], v[112:115]
M v[116:119], a[180:183], a[76:79], v[116:119]
buffer_load_dwordx4 v3, s[8:11], s3 offen offset:1024 lds
M v[116:119], a[176:179], a[72:75], v[116:119]
ds_read_b64_tr_b16 a[100:101], v12 offset:49152
ds_read_b64_tr_b16 a[102:103], v12 offset:51200
M v[120:123], a[176:179], a[80:83], v[120:123]
buffer_load_dwordx4 v4, s[8:11], s3 offen offset:2048 lds
M v[120:123], a[180:183], a[84:87], v[120:123]
M v[124:127], a[180:183], a[92:95], v[124:127]
buffer_load_dwordx4 v5, s[8:11], s3 offen offset:3072 lds
M v[124:127], a[176:179], a[88:91], v[124:127]
M v[128:131], a[184:187], a[32:35], v[128:131]
M v[128:131], a[188:191], a[36:39], v[128:131]
ds_read_b128 a[168:171], v10 offset:18432
ds_read_b128 a[172:175], v11 offset:18432
ds_read_b64_tr_b16 a[108:109], v13 offset:49152
ds_read_b64_tr_b16 a[110:111], v13 offset:51200
M v[132:135], a[188:191], a[44:47], v[132:135]
M v[132:135], a[184:187], a[40:43], v[132:135]
M v[136:139], a[184:187], a[48:51], v[136:139]
s_and_b32 s3, s2, 1
s_lshl_b32 s3, s3, 3
s_bfe_u32 s4, s2, 0x30003
s_add_u32 s26, s3, s4
M v[136:139], a[188:191], a[52:55], v[136:139]
s_bfe_u32 s3, s2, 0x20001
s_lshl_b32 s3, s3, 2
s_lshr_b32 s4, s2, 6
M v[140:143], a[188:191], a[60:63], v[140:143]
s_xor_b32 s4, s4, 2
s_add_u32 s27, s3, s4
s_lshl_b32 s23, s26, 18
M v[140:143], a[184:187], a[56:59], v[140:143]
ds_read_b64_tr_b16 a[116:117], v14 offset:49152
ds_read_b64_tr_b16 a[118:119], v14 offset:51200
s_sub_u32 s24, s23, 32768
s_max_i32 s24, s24, 0
s_lshl_b32 s25, s27, 7
s_add_u32 s3, s26, s27
M v[144:147], a[184:187], a[64:67], v[144:147]
s_and_b32 s3, s3, 0
s_mul_i32 s3, s3, 16
s_sub_u32 s31, 16, s3
M v[144:147], a[188:191], a[68:71], v[144:147]
s_mov_b32 s54, s31
s_movk_i32 s57, 128
s_mov_b32 s55, 4289069056
M v[148:151], a[188:191], a[76:79], v[148:151]
s_mov_b32 s56, 393216
s_lshl_b32 s4, s3, 7
s_add_u32 s23, s23, s4
M v[148:151], a[184:187], a[72:75], v[148:151]
s_add_u32 s24, s24, s4
s_mul_i32 s4, s3, 393216
s_add_u32 s25, s25, s4
s_mov_b64 s[8:9], s[44:45]
M v[152:155], a[184:187], a[80:83], v[152:155]
s_mov_b32 s10, 4194304
s_mov_b64 s[12:13], s[46:47]
s_mov_b32 s14, 6291456
M v[152:155], a[188:191], a[84:87], v[152:155]
ds_read_b64_tr_b16 a[124:125], v15 offset:49152
ds_read_b64_tr_b16 a[126:127], v15 offset:51200
s_mov_b64 s[36:37], s[90:91]
s_mov_b32 s38, 256
s_mov_b32 s39, 0x00020000
M v[156:159], a[188:191], a[92:95], v[156:159]
s_lshl_b32 s28, s20, 9
s_mul_i32 s30, s20, 6144
s_lshl_b32 s3, s20, 5
M v[156:159], a[184:187], a[88:91], v[156:159]
s_waitcnt lgkmcnt(10)
v_lshrrev_b32 v24, 3, v0
v_and_b32 v25, 7, v0
v_add_u32 v28, s3, v24
v_add_u32 v26, 0, v28
M v[160:163], a[160:163], a[32:35], v[160:163]
v_bfe_u32 v27, v26, 1, 3
v_xor_b32 v27, v27, v25
v_lshlrev_b32 v26, 11, v26
M v[160:163], a[164:167], a[36:39], v[160:163]
ds_read_b128 a[176:179], v10 offset:20480
ds_read_b128 a[180:183], v11 offset:20480
v_lshl_add_u32 v26, v27, 4, v26
v_subrev_u32 v2, 0, v26
v_add_u32 v26, 8, v28
M v[164:167], a[164:167], a[44:47], v[164:167]
v_bfe_u32 v27, v26, 1, 3
v_xor_b32 v27, v27, v25
v_lshlrev_b32 v26, 11, v26
v_lshl_add_u32 v26, v27, 4, v26
M v[164:167], a[160:163], a[40:43], v[164:167]
ds_read_b64_tr_b16 a[132:133], v16 offset:49152
ds_read_b64_tr_b16 a[134:135], v16 offset:51200
v_subrev_u32 v3, 1024, v26
v_add_u32 v26, 16, v28
v_bfe_u32 v27, v26, 1, 3
M v[168:171], a[160:163], a[48:51], v[168:171]
v_xor_b32 v27, v27, v25
v_lshlrev_b32 v26, 11, v26
v_lshl_add_u32 v26, v27, 4, v26
M v[168:171], a[164:167], a[52:55], v[168:171]
v_subrev_u32 v4, 2048, v26
v_add_u32 v26, 24, v28
v_bfe_u32 v27, v26, 1, 3
M v[172:175], a[164:167], a[60:63], v[172:175]
v_xor_b32 v27, v27, v25
v_lshlrev_b32 v26, 11, v26
v_lshl_add_u32 v26, v27, 4, v26
v_subrev_u32 v5, 3072, v26
M v[172:175], a[160:163], a[56:59], v[172:175]
s_lshl_b32 s3, s20, 2
v_lshrrev_b32 v26, 5, v0
v_add_u32 v26, s3, v26
M v[176:179], a[160:163], a[64:67], v[176:179]
v_bfe_u32 v29, v0, 2, 3
v_bfe_u32 v27, v26, 1, 3
v_xor_b32 v27, v27, v29
M v[176:179], a[164:167], a[68:71], v[176:179]
ds_read_b64_tr_b16 a[140:141], v17 offset:49152
ds_read_b64_tr_b16 a[142:143], v17 offset:51200
v_lshlrev_b32 v27, 4, v27
v_and_b32 v30, 3, v0
v_lshl_add_u32 v27, v30, 2, v27
M v[180:183], a[164:167], a[76:79], v[180:183]
v_lshl_add_u32 v20, v26, 11, v27
v_add_u32 v26, 2, v26
v_bfe_u32 v27, v26, 1, 3
v_xor_b32 v27, v27, v29
M v[180:183], a[160:163], a[72:75], v[180:183]
v_lshlrev_b32 v27, 4, v27
v_and_b32 v30, 3, v0
v_lshl_add_u32 v27, v30, 2, v27
M v[184:187], a[160:163], a[80:83], v[184:187]
v_lshl_add_u32 v23, v26, 11, v27
v_subrev_u32 v23, 256, v23
s_mul_i32 s3, s20, 48
M v[184:187], a[164:167], a[84:87], v[184:187]
v_add_u32 v28, s3, v24
v_add_u32 v26, 0, v28
v_mul_u32_u24 v27, 0xaaab, v26
v_lshrrev_b32 v27, 17, v27
M v[188:191], a[164:167], a[92:95], v[188:191]
v_lshrrev_b32 v29, 1, v27
v_and_b32 v29, 4, v29
v_and_or_b32 v27, v27, 2, v29
M v[188:191], a[160:163], a[88:91], v[188:191]
s_waitcnt lgkmcnt(12)
ds_read_b64_tr_b16 a[148:149], v18 offset:49152
ds_read_b64_tr_b16 a[150:151], v18 offset:51200
v_xor_b32 v27, v27, v25
v_lshlrev_b32 v26, 11, v26
v_lshl_add_u32 v26, v27, 4, v26
M v[192:195], a[168:171], a[32:35], v[192:195]
v_subrev_u32 v6, 0, v26
v_add_u32 v26, 8, v28
v_mul_u32_u24 v27, 0xaaab, v26
M v[192:195], a[172:175], a[36:39], v[192:195]
ds_read_b128 a[184:187], v10 offset:22528
ds_read_b128 a[188:191], v11 offset:22528
v_lshrrev_b32 v27, 17, v27
v_lshrrev_b32 v29, 1, v27
v_and_b32 v29, 4, v29
v_and_or_b32 v27, v27, 2, v29
M v[196:199], a[172:175], a[44:47], v[196:199]
v_xor_b32 v27, v27, v25
v_lshlrev_b32 v26, 11, v26
v_lshl_add_u32 v26, v27, 4, v26
M v[196:199], a[168:171], a[40:43], v[196:199]
v_subrev_u32 v7, 1024, v26
v_add_u32 v26, 16, v28
v_mul_u32_u24 v27, 0xaaab, v26
M v[200:203], a[168:171], a[48:51], v[200:203]
v_lshrrev_b32 v27, 17, v27
v_lshrrev_b32 v29, 1, v27
v_and_b32 v29, 4, v29
M v[200:203], a[172:175], a[52:55], v[200:203]
ds_read_b64_tr_b16 a[156:157], v19 offset:49152
ds_read_b64_tr_b16 a[158:159], v19 offset:51200
v_and_or_b32 v27, v27, 2, v29
v_xor_b32 v27, v27, v25
v_lshlrev_b32 v26, 11, v26
v_lshl_add_u32 v26, v27, 4, v26
M v[204:207], a[172:175], a[60:63], v[204:207]
v_subrev_u32 v8, 2048, v26
v_add_u32 v26, 24, v28
v_mul_u32_u24 v27, 0xaaab, v26
M v[204:207], a[168:171], a[56:59], v[204:207]
v_lshrrev_b32 v27, 17, v27
v_lshrrev_b32 v29, 1, v27
v_and_b32 v29, 4, v29
M v[208:211], a[168:171], a[64:67], v[208:211]
v_and_or_b32 v27, v27, 2, v29
v_xor_b32 v27, v27, v25
v_lshlrev_b32 v26, 11, v26
v_lshl_add_u32 v26, v27, 4, v26
M v[208:211], a[172:175], a[68:71], v[208:211]
v_subrev_u32 v9, 3072, v26
v_add_u32 v26, 32, v28
v_mul_u32_u24 v27, 0xaaab, v26
M v[212:215], a[172:175], a[76:79], v[212:215]
v_lshrrev_b32 v27, 17, v27
v_lshrrev_b32 v29, 1, v27
v_and_b32 v29, 4, v29
M v[212:215], a[168:171], a[72:75], v[212:215]
v_and_or_b32 v27, v27, 2, v29
v_xor_b32 v27, v27, v25
v_lshlrev_b32 v26, 11, v26
M v[216:219], a[168:171], a[80:83], v[216:219]
v_lshl_add_u32 v26, v27, 4, v26
v_subrev_u32 v21, 0, v26
v_add_u32 v26, 40, v28
v_mul_u32_u24 v27, 0xaaab, v26
M v[216:219], a[172:175], a[84:87], v[216:219]
v_lshrrev_b32 v27, 17, v27
v_lshrrev_b32 v29, 1, v27
v_and_b32 v29, 4, v29
M v[220:223], a[172:175], a[92:95], v[220:223]
v_and_or_b32 v27, v27, 2, v29
v_xor_b32 v27, v27, v25
v_lshlrev_b32 v26, 11, v26
M v[220:223], a[168:171], a[88:91], v[220:223]
s_waitcnt lgkmcnt(10)
v_lshl_add_u32 v26, v27, 4, v26
v_subrev_u32 v22, 1024, v26
s_lshr_b32 s3, s53, 7
M v[224:227], a[176:179], a[32:35], v[224:227]
s_add_u32 s3, s3, s22
s_lshl_b32 s3, s3, 5
s_lshr_b32 s19, s52, 6
s_add_u32 s3, s3, s19
M v[224:227], a[180:183], a[36:39], v[224:227]
s_lshl_b32 s19, s21, 1
s_add_u32 s3, s3, s19
s_lshl_b32 s92, s3, 15
M v[228:231], a[180:183], a[44:47], v[228:231]
s_add_u32 s92, s92, 16384
s_add_u32 s93, s92, 32768
s_add_u32 s16, s50, 16777216
M v[228:231], a[176:179], a[40:43], v[228:231]
s_addc_u32 s17, s51, 0
s_mov_b32 s18, 33554432
s_mov_b32 s19, 0x00020000
M v[232:235], a[176:179], a[48:51], v[232:235]
M v[232:235], a[180:183], a[52:55], v[232:235]
M v[236:239], a[180:183], a[60:63], v[236:239]
M v[236:239], a[176:179], a[56:59], v[236:239]
s_waitcnt vmcnt(4) lgkmcnt(0)
s_barrier
ds_read_b128 a[160:163], v10 offset:32768
ds_read_b128 a[164:167], v11 offset:32768
M v[240:243], a[176:179], a[64:67], v[240:243]
s_add_u32 m0, s28, 131072
s_nop 0
buffer_load_dword v20, s[8:11], s24 offen lds
M v[240:243], a[180:183], a[68:71], v[240:243]
M v[244:247], a[180:183], a[76:79], v[244:247]
M v[244:247], a[176:179], a[72:75], v[244:247]
buffer_load_dword v23, s[8:11], s24 offen offset:256 lds
M v[248:251], a[176:179], a[80:83], v[248:251]
M v[248:251], a[180:183], a[84:87], v[248:251]
M v[252:255], a[180:183], a[92:95], v[252:255]
M v[252:255], a[176:179], a[88:91], v[252:255]
M a[0:3], a[184:187], a[32:35], a[0:3]
s_add_u32 m0, s29, 133120
s_nop 0
buffer_load_dwordx4 v2, s[8:11], s23 offen offset:0 lds
M a[0:3], a[188:191], a[36:39], a[0:3]
ds_read_b128 a[168:171], v10 offset:34816
ds_read_b128 a[172:175], v11 offset:34816
M a[4:7], a[188:191], a[44:47], a[4:7]
M a[4:7], a[184:187], a[40:43], a[4:7]
M a[8:11], a[184:187], a[48:51], a[8:11]
buffer_load_dwordx4 v3, s[8:11], s23 offen offset:1024 lds
M a[8:11], a[188:191], a[52:55], a[8:11]
M a[12:15], a[188:191], a[60:63], a[12:15]
M a[12:15], a[184:187], a[56:59], a[12:15]
M a[16:19], a[184:187], a[64:67], a[16:19]
buffer_load_dwordx4 v4, s[8:11], s23 offen offset:2048 lds
M a[16:19], a[188:191], a[68:71], a[16:19]
M a[20:23], a[188:191], a[76:79], a[20:23]
M a[20:23], a[184:187], a[72:75], a[20:23]
buffer_load_dwordx4 v5, s[8:11], s23 offen offset:3072 lds
M a[24:27], a[184:187], a[80:83], a[24:27]
M a[24:27], a[188:191], a[84:87], a[24:27]
M a[28:31], a[188:191], a[92:95], a[28:31]
M a[28:31], a[184:187], a[88:91], a[28:31]
s_waitcnt lgkmcnt(2)
M v[32:35], a[160:163], a[96:99], v[32:35]
s_sub_u32 s31, s31, 1
s_cmp_eq_u32 s31, 0
s_cselect_b32 s58, -1920, s57
s_add_u32 s23, s23, s58
s_add_u32 s24, s24, s58
M v[32:35], a[164:167], a[100:103], v[32:35]
ds_read_b128 a[176:179], v10 offset:36864
ds_read_b128 a[180:183], v11 offset:36864
M v[36:39], a[164:167], a[108:111], v[36:39]
M v[36:39], a[160:163], a[104:107], v[36:39]
M v[40:43], a[160:163], a[112:115], v[40:43]
M v[40:43], a[164:167], a[116:119], v[40:43]
s_add_u32 m0, s30, 65536
s_nop 0
buffer_load_dwordx4 v6, s[12:15], s25 offen offset:0 lds
M v[44:47], a[164:167], a[124:127], v[44:47]
M v[44:47], a[160:163], a[120:123], v[44:47]
M v[48:51], a[160:163], a[128:131], v[48:51]
M v[48:51], a[164:167], a[132:135], v[48:51]
buffer_load_dwordx4 v7, s[12:15], s25 offen offset:1024 lds
M v[52:55], a[164:167], a[140:143], v[52:55]
M v[52:55], a[160:163], a[136:139], v[52:55]
M v[56:59], a[160:163], a[144:147], v[56:59]
M v[56:59], a[164:167], a[148:151], v[56:59]
buffer_load_dwordx4 v8, s[12:15], s25 offen offset:2048 lds
M v[60:63], a[164:167], a[156:159], v[60:63]
M v[60:63], a[160:163], a[152:155], v[60:63]
s_waitcnt lgkmcnt(2)
M v[64:67], a[168:171], a[96:99], v[64:67]
M v[64:67], a[172:175], a[100:103], v[64:67]
ds_read_b128 a[184:187], v10 offset:38912
ds_read_b128 a[188:191], v11 offset:38912
M v[68:71], a[172:175], a[108:111], v[68:71]
M v[68:71], a[168:171], a[104:107], v[68:71]
buffer_load_dwordx4 v9, s[12:15], s25 offen offset:3072 lds
M v[72:75], a[168:171], a[112:115], v[72:75]
M v[72:75], a[172:175], a[116:119], v[72:75]
M v[76:79], a[172:175], a[124:127], v[76:79]
M v[76:79], a[168:171], a[120:123], v[76:79]
s_add_u32 m0, s30, 69632
s_nop 0
buffer_load_dwordx4 v21, s[12:15], s25 offen offset:0 lds
M v[80:83], a[168:171], a[128:131], v[80:83]
M v[80:83], a[172:175], a[132:135], v[80:83]
M v[84:87], a[172:175], a[140:143], v[84:87]
M v[84:87], a[168:171], a[136:139], v[84:87]
buffer_load_dwordx4 v22, s[12:15], s25 offen offset:1024 lds
M v[88:91], a[168:171], a[144:147], v[88:91]
M v[88:91], a[172:175], a[148:151], v[88:91]
M v[92:95], a[172:175], a[156:159], v[92:95]
M v[92:95], a[168:171], a[152:155], v[92:95]
s_waitcnt lgkmcnt(2)
M v[96:99], a[176:179], a[96:99], v[96:99]
s_sub_u32 s54, s54, 1
s_cmp_eq_u32 s54, 0
s_cselect_b32 s58, s55, s56
s_add_u32 s25, s25, s58
M v[96:99], a[180:183], a[100:103], v[96:99]
M v[100:103], a[180:183], a[108:111], v[100:103]
M v[100:103], a[176:179], a[104:107], v[100:103]
v_cvt_pk_bf16_f32 v32, v32, v33
v_cvt_pk_bf16_f32 v33, v34, v35
M v[104:107], a[176:179], a[112:115], v[104:107]
v_cvt_pk_bf16_f32 v34, v64, v65
v_cvt_pk_bf16_f32 v35, v66, v67
M v[104:107], a[180:183], a[116:119], v[104:107]
v_cvt_pk_bf16_f32 v64, v48, v49
M v[108:111], a[180:183], a[124:127], v[108:111]
v_cvt_pk_bf16_f32 v65, v50, v51
v_cvt_pk_bf16_f32 v66, v80, v81
M v[108:111], a[176:179], a[120:123], v[108:111]
s_waitcnt vmcnt(12) lgkmcnt(0)
s_barrier
ds_read_b128 a[160:163], v10 offset:49152
ds_read_b128 a[164:167], v11 offset:49152
v_cvt_pk_bf16_f32 v67, v82, v83
M v[112:115], a[176:179], a[128:131], v[112:115]
s_add_u32 m0, s28, 0
s_nop 0
buffer_load_dword v20, s[8:11], s24 offen lds
v_cvt_pk_bf16_f32 v48, v40, v41
v_cvt_pk_bf16_f32 v49, v42, v43
M v[112:115], a[180:183], a[132:135], v[112:115]
v_cvt_pk_bf16_f32 v50, v72, v73
v_cvt_pk_bf16_f32 v51, v74, v75
M v[116:119], a[180:183], a[140:143], v[116:119]
v_cvt_pk_bf16_f32 v80, v56, v57
M v[116:119], a[176:179], a[136:139], v[116:119]
buffer_load_dword v23, s[8:11], s24 offen offset:256 lds
v_cvt_pk_bf16_f32 v81, v58, v59
v_cvt_pk_bf16_f32 v82, v88, v89
M v[120:123], a[176:179], a[144:147], v[120:123]
v_cvt_pk_bf16_f32 v83, v90, v91
M v[120:123], a[180:183], a[148:151], v[120:123]
v_cvt_pk_bf16_f32 v40, v36, v37
v_cvt_pk_bf16_f32 v41, v38, v39
M v[124:127], a[180:183], a[156:159], v[124:127]
s_add_u32 m0, s29, 2048
s_nop 0
buffer_load_dwordx4 v2, s[8:11], s23 offen offset:0 lds
v_cvt_pk_bf16_f32 v42, v68, v69
v_cvt_pk_bf16_f32 v43, v70, v71
M v[124:127], a[176:179], a[152:155], v[124:127]
v_cvt_pk_bf16_f32 v72, v52, v53
M v[128:131], a[184:187], a[96:99], v[128:131]
v_cvt_pk_bf16_f32 v73, v54, v55
v_cvt_pk_bf16_f32 v74, v84, v85
M v[128:131], a[188:191], a[100:103], v[128:131]
ds_read_b128 a[168:171], v10 offset:51200
ds_read_b128 a[172:175], v11 offset:51200
v_cvt_pk_bf16_f32 v75, v86, v87
M v[132:135], a[188:191], a[108:111], v[132:135]
v_cvt_pk_bf16_f32 v56, v44, v45
v_cvt_pk_bf16_f32 v57, v46, v47
M v[132:135], a[184:187], a[104:107], v[132:135]
buffer_load_dwordx4 v3, s[8:11], s23 offen offset:1024 lds
v_cvt_pk_bf16_f32 v58, v76, v77
v_cvt_pk_bf16_f32 v59, v78, v79
M v[136:139], a[184:187], a[112:115], v[136:139]
v_cvt_pk_bf16_f32 v88, v60, v61
M v[136:139], a[188:191], a[116:119], v[136:139]
v_cvt_pk_bf16_f32 v89, v62, v63
v_cvt_pk_bf16_f32 v90, v92, v93
M v[140:143], a[188:191], a[124:127], v[140:143]
buffer_load_dwordx4 v4, s[8:11], s23 offen offset:2048 lds
v_cvt_pk_bf16_f32 v91, v94, v95
M v[140:143], a[184:187], a[120:123], v[140:143]
M v[144:147], a[184:187], a[128:131], v[144:147]
M v[144:147], a[188:191], a[132:135], v[144:147]
buffer_load_dwordx4 v5, s[8:11], s23 offen offset:3072 lds
M v[148:151], a[188:191], a[140:143], v[148:151]
s_add_u32 s94, s92, 0
buffer_store_dwordx4 v[32:35], v1, s[16:19], s94 offen offset:0 sc1
M v[148:151], a[184:187], a[136:139], v[148:151]
M v[152:155], a[184:187], a[144:147], v[152:155]
M v[152:155], a[188:191], a[148:151], v[152:155]
s_sub_u32 s31, s31, 1
s_cmp_eq_u32 s31, 0
s_cselect_b32 s58, -1920, s57
s_add_u32 s23, s23, s58
s_add_u32 s24, s24, s58
M v[156:159], a[188:191], a[156:159], v[156:159]
s_add_u32 s94, s92, 0
buffer_store_dwordx4 v[40:43], v1, s[16:19], s94 offen offset:1024 sc1
M v[156:159], a[184:187], a[152:155], v[156:159]
s_waitcnt lgkmcnt(2)
M v[160:163], a[160:163], a[96:99], v[160:163]
M v[160:163], a[164:167], a[100:103], v[160:163]
ds_read_b128 a[176:179], v10 offset:53248
ds_read_b128 a[180:183], v11 offset:53248
M v[164:167], a[164:167], a[108:111], v[164:167]
s_add_u32 s94, s92, 0
buffer_store_dwordx4 v[48:51], v1, s[16:19], s94 offen offset:2048 sc1
M v[164:167], a[160:163], a[104:107], v[164:167]
v_cvt_pk_bf16_f32 v96, v96, v97
v_cvt_pk_bf16_f32 v97, v98, v99
M v[168:171], a[160:163], a[112:115], v[168:171]
v_cvt_pk_bf16_f32 v98, v128, v129
v_cvt_pk_bf16_f32 v99, v130, v131
M v[168:171], a[164:167], a[116:119], v[168:171]
s_add_u32 m0, s30, 98304
s_nop 0
buffer_load_dwordx4 v6, s[12:15], s25 offen offset:0 lds
v_cvt_pk_bf16_f32 v128, v112, v113
M v[172:175], a[164:167], a[124:127], v[172:175]
s_add_u32 s94, s92, 0
buffer_store_dwordx4 v[56:59], v1, s[16:19], s94 offen offset:3072 sc1
v_cvt_pk_bf16_f32 v129, v114, v115
v_cvt_pk_bf16_f32 v130, v144, v145
M v[172:175], a[160:163], a[120:123], v[172:175]
v_cvt_pk_bf16_f32 v131, v146, v147
M v[176:179], a[160:163], a[128:131], v[176:179]
v_cvt_pk_bf16_f32 v112, v104, v105
v_cvt_pk_bf16_f32 v113, v106, v107
M v[176:179], a[164:167], a[132:135], v[176:179]
buffer_load_dwordx4 v7, s[12:15], s25 offen offset:1024 lds
v_cvt_pk_bf16_f32 v114, v136, v137
v_cvt_pk_bf16_f32 v115, v138, v139
M v[180:183], a[164:167], a[140:143], v[180:183]
s_add_u32 s94, s92, 4096
buffer_store_dwordx4 v[64:67], v1, s[16:19], s94 offen offset:0 sc1
v_cvt_pk_bf16_f32 v144, v120, v121
M v[180:183], a[160:163], a[136:139], v[180:183]
v_cvt_pk_bf16_f32 v145, v122, v123
v_cvt_pk_bf16_f32 v146, v152, v153
M v[184:187], a[160:163], a[144:147], v[184:187]
v_cvt_pk_bf16_f32 v147, v154, v155
M v[184:187], a[164:167], a[148:151], v[184:187]
buffer_load_dwordx4 v8, s[12:15], s25 offen offset:2048 lds
v_cvt_pk_bf16_f32 v104, v100, v101
v_cvt_pk_bf16_f32 v105, v102, v103
M v[188:191], a[164:167], a[156:159], v[188:191]
s_add_u32 s94, s92, 4096
buffer_store_dwordx4 v[72:75], v1, s[16:19], s94 offen offset:1024 sc1
v_cvt_pk_bf16_f32 v106, v132, v133
v_cvt_pk_bf16_f32 v107, v134, v135
M v[188:191], a[160:163], a[152:155], v[188:191]
s_waitcnt lgkmcnt(2)
v_cvt_pk_bf16_f32 v136, v116, v117
M v[192:195], a[168:171], a[96:99], v[192:195]
v_cvt_pk_bf16_f32 v137, v118, v119
v_cvt_pk_bf16_f32 v138, v148, v149
M v[192:195], a[172:175], a[100:103], v[192:195]
ds_read_b128 a[184:187], v10 offset:55296
ds_read_b128 a[188:191], v11 offset:55296
v_cvt_pk_bf16_f32 v139, v150, v151
M v[196:199], a[172:175], a[108:111], v[196:199]
s_add_u32 s94, s92, 4096
buffer_store_dwordx4 v[80:83], v1, s[16:19], s94 offen offset:2048 sc1
v_cvt_pk_bf16_f32 v120, v108, v109
v_cvt_pk_bf16_f32 v121, v110, v111
M v[196:199], a[168:171], a[104:107], v[196:199]
v_cvt_pk_bf16_f32 v122, v140, v141
v_cvt_pk_bf16_f32 v123, v142, v143
M v[200:203], a[168:171], a[112:115], v[200:203]
buffer_load_dwordx4 v9, s[12:15], s25 offen offset:3072 lds
v_cvt_pk_bf16_f32 v152, v124, v125
M v[200:203], a[172:175], a[116:119], v[200:203]
v_cvt_pk_bf16_f32 v153, v126, v127
v_cvt_pk_bf16_f32 v154, v156, v157
M v[204:207], a[172:175], a[124:127], v[204:207]
s_add_u32 s94, s92, 4096
buffer_store_dwordx4 v[88:91], v1, s[16:19], s94 offen offset:3072 sc1
v_cvt_pk_bf16_f32 v155, v158, v159
M v[204:207], a[168:171], a[120:123], v[204:207]
M v[208:211], a[168:171], a[128:131], v[208:211]
s_add_u32 m0, s30, 102400
s_nop 0
buffer_load_dwordx4 v21, s[12:15], s25 offen offset:0 lds
M v[208:211], a[172:175], a[132:135], v[208:211]
M v[212:215], a[172:175], a[140:143], v[212:215]
M v[212:215], a[168:171], a[136:139], v[212:215]
buffer_load_dwordx4 v22, s[12:15], s25 offen offset:1024 lds
M v[216:219], a[168:171], a[144:147], v[216:219]
s_add_u32 s94, s92, 8192
buffer_store_dwordx4 v[96:99], v1, s[16:19], s94 offen offset:0 sc1
M v[216:219], a[172:175], a[148:151], v[216:219]
M v[220:223], a[172:175], a[156:159], v[220:223]
M v[220:223], a[168:171], a[152:155], v[220:223]
s_waitcnt lgkmcnt(2)
M v[224:227], a[176:179], a[96:99], v[224:227]
s_sub_u32 s54, s54, 1
s_cmp_eq_u32 s54, 0
s_cselect_b32 s58, s55, s56
s_add_u32 s25, s25, s58
M v[224:227], a[180:183], a[100:103], v[224:227]
M v[228:231], a[180:183], a[108:111], v[228:231]
s_add_u32 s94, s92, 8192
buffer_store_dwordx4 v[104:107], v1, s[16:19], s94 offen offset:1024 sc1
M v[228:231], a[176:179], a[104:107], v[228:231]
v_cvt_pk_bf16_f32 v160, v160, v161
v_cvt_pk_bf16_f32 v161, v162, v163
M v[232:235], a[176:179], a[112:115], v[232:235]
v_cvt_pk_bf16_f32 v162, v192, v193
v_cvt_pk_bf16_f32 v163, v194, v195
M v[232:235], a[180:183], a[116:119], v[232:235]
v_cvt_pk_bf16_f32 v192, v176, v177
M v[236:239], a[180:183], a[124:127], v[236:239]
v_cvt_pk_bf16_f32 v193, v178, v179
v_cvt_pk_bf16_f32 v194, v208, v209
M v[236:239], a[176:179], a[120:123], v[236:239]
s_waitcnt vmcnt(63) lgkmcnt(0)
s_barrier
v_cvt_pk_bf16_f32 v195, v210, v211
M v[240:243], a[176:179], a[128:131], v[240:243]
s_add_u32 s94, s92, 8192
buffer_store_dwordx4 v[112:115], v1, s[16:19], s94 offen offset:2048 sc1
v_cvt_pk_bf16_f32 v176, v168, v169
v_cvt_pk_bf16_f32 v177, v170, v171
M v[240:243], a[180:183], a[132:135], v[240:243]
s_add_u32 m0, s28, 18432
s_nop 0
buffer_load_dword v20, s[8:11], s24 offen lds
v_cvt_pk_bf16_f32 v178, v200, v201
v_cvt_pk_bf16_f32 v179, v202, v203
M v[244:247], a[180:183], a[140:143], v[244:247]
v_cvt_pk_bf16_f32 v208, v184, v185
M v[244:247], a[176:179], a[136:139], v[244:247]
v_cvt_pk_bf16_f32 v209, v186, v187
v_cvt_pk_bf16_f32 v210, v216, v217
M v[248:251], a[176:179], a[144:147], v[248:251]
buffer_load_dword v23, s[8:11], s24 offen offset:256 lds
v_cvt_pk_bf16_f32 v211, v218, v219
M v[248:251], a[180:183], a[148:151], v[248:251]
v_cvt_pk_bf16_f32 v168, v164, v165
v_cvt_pk_bf16_f32 v169, v166, v167
M v[252:255], a[180:183], a[156:159], v[252:255]
s_add_u32 s94, s92, 8192
buffer_store_dwordx4 v[120:123], v1, s[16:19], s94 offen offset:3072 sc1
v_cvt_pk_bf16_f32 v170, v196, v197
v_cvt_pk_bf16_f32 v171, v198, v199
M v[252:255], a[176:179], a[152:155], v[252:255]
v_cvt_pk_bf16_f32 v200, v180, v181
M a[0:3], a[184:187], a[96:99], a[0:3]
v_cvt_pk_bf16_f32 v201, v182, v183
v_cvt_pk_bf16_f32 v202, v212, v213
M a[0:3], a[188:191], a[100:103], a[0:3]
s_add_u32 m0, s29, 20480
s_nop 0
buffer_load_dwordx4 v2, s[8:11], s23 offen offset:0 lds
v_cvt_pk_bf16_f32 v203, v214, v215
M a[4:7], a[188:191], a[108:111], a[4:7]
v_cvt_pk_bf16_f32 v184, v172, v173
v_cvt_pk_bf16_f32 v185, v174, v175
M a[4:7], a[184:187], a[104:107], a[4:7]
v_cvt_pk_bf16_f32 v186, v204, v205
v_cvt_pk_bf16_f32 v187, v206, v207
M a[8:11], a[184:187], a[112:115], a[8:11]
s_add_u32 s94, s92, 12288
buffer_store_dwordx4 v[128:131], v1, s[16:19], s94 offen offset:0 sc1
v_cvt_pk_bf16_f32 v216, v188, v189
M a[8:11], a[188:191], a[116:119], a[8:11]
buffer_load_dwordx4 v3, s[8:11], s23 offen offset:1024 lds
v_cvt_pk_bf16_f32 v217, v190, v191
v_cvt_pk_bf16_f32 v218, v220, v221
M a[12:15], a[188:191], a[124:127], a[12:15]
v_cvt_pk_bf16_f32 v219, v222, v223
M a[12:15], a[184:187], a[120:123], a[12:15]
M a[16:19], a[184:187], a[128:131], a[16:19]
buffer_load_dwordx4 v4, s[8:11], s23 offen offset:2048 lds
M a[16:19], a[188:191], a[132:135], a[16:19]
M a[20:23], a[188:191], a[140:143], a[20:23]
s_add_u32 s94, s92, 12288
buffer_store_dwordx4 v[136:139], v1, s[16:19], s94 offen offset:1024 sc1
M a[20:23], a[184:187], a[136:139], a[20:23]
M a[24:27], a[184:187], a[144:147], a[24:27]
buffer_load_dwordx4 v5, s[8:11], s23 offen offset:3072 lds
M a[24:27], a[188:191], a[148:151], a[24:27]
M a[28:31], a[188:191], a[156:159], a[28:31]
M a[28:31], a[184:187], a[152:155], a[28:31]
v_accvgpr_read_b32 v24, a0
v_accvgpr_read_b32 v25, a1
v_accvgpr_read_b32 v26, a2
v_accvgpr_read_b32 v27, a3
v_cvt_pk_bf16_f32 v224, v224, v225
v_cvt_pk_bf16_f32 v225, v226, v227
v_cvt_pk_bf16_f32 v226, v24, v25
v_cvt_pk_bf16_f32 v227, v26, v27
v_accvgpr_read_b32 v24, a16
v_accvgpr_read_b32 v25, a17
v_accvgpr_read_b32 v26, a18
v_accvgpr_read_b32 v27, a19
v_cvt_pk_bf16_f32 v36, v240, v241
v_cvt_pk_bf16_f32 v37, v242, v243
v_cvt_pk_bf16_f32 v38, v24, v25
v_cvt_pk_bf16_f32 v39, v26, v27
v_accvgpr_read_b32 v24, a24
v_accvgpr_read_b32 v25, a25
v_accvgpr_read_b32 v26, a26
v_accvgpr_read_b32 v27, a27
v_cvt_pk_bf16_f32 v52, v248, v249
v_cvt_pk_bf16_f32 v53, v250, v251
v_cvt_pk_bf16_f32 v54, v24, v25
v_cvt_pk_bf16_f32 v55, v26, v27
v_accvgpr_read_b32 v24, a8
v_accvgpr_read_b32 v25, a9
v_accvgpr_read_b32 v26, a10
v_accvgpr_read_b32 v27, a11
v_cvt_pk_bf16_f32 v240, v232, v233
v_cvt_pk_bf16_f32 v241, v234, v235
v_cvt_pk_bf16_f32 v242, v24, v25
v_cvt_pk_bf16_f32 v243, v26, v27
v_accvgpr_read_b32 v28, a4
v_accvgpr_read_b32 v29, a5
v_accvgpr_read_b32 v30, a6
v_accvgpr_read_b32 v31, a7
v_cvt_pk_bf16_f32 v232, v228, v229
v_cvt_pk_bf16_f32 v233, v230, v231
v_cvt_pk_bf16_f32 v234, v28, v29
v_cvt_pk_bf16_f32 v235, v30, v31
v_accvgpr_read_b32 v28, a12
v_accvgpr_read_b32 v29, a13
v_accvgpr_read_b32 v30, a14
v_accvgpr_read_b32 v31, a15
v_cvt_pk_bf16_f32 v248, v236, v237
v_cvt_pk_bf16_f32 v249, v238, v239
v_cvt_pk_bf16_f32 v250, v28, v29
v_cvt_pk_bf16_f32 v251, v30, v31
v_accvgpr_read_b32 v28, a20
v_accvgpr_read_b32 v29, a21
v_accvgpr_read_b32 v30, a22
v_accvgpr_read_b32 v31, a23
v_cvt_pk_bf16_f32 v44, v244, v245
v_cvt_pk_bf16_f32 v45, v246, v247
v_cvt_pk_bf16_f32 v46, v28, v29
v_cvt_pk_bf16_f32 v47, v30, v31
v_accvgpr_read_b32 v28, a28
v_accvgpr_read_b32 v29, a29
v_accvgpr_read_b32 v30, a30
v_accvgpr_read_b32 v31, a31
v_cvt_pk_bf16_f32 v60, v252, v253
v_cvt_pk_bf16_f32 v61, v254, v255
v_cvt_pk_bf16_f32 v62, v28, v29
v_cvt_pk_bf16_f32 v63, v30, v31
Lk1_b:
v_and_b32 v24, 15, v0
v_lshlrev_b32 v24, 7, v24
v_bfe_u32 v25, v0, 1, 3
v_lshrrev_b32 v26, 4, v0
v_xor_b32 v25, v25, v26
v_lshl_add_u32 v10, v25, 4, v24
v_xor_b32 v11, 64, v10
v_add_u32 v12, 131072, v10
v_add_u32 v13, 131072, v11
v_bfe_u32 v24, v0, 2, 2
v_lshl_add_u32 v29, v26, 3, v24
v_mul_u32_u24 v25, 384, v29
v_and_b32 v27, 1, v0
v_lshl_add_u32 v25, v27, 3, v25
v_add_u32 v25, 36864, v25
v_lshrrev_b32 v24, 1, v29
v_and_b32 v24, 4, v24
v_and_or_b32 v24, v29, 2, v24
v_bfe_u32 v26, v0, 1, 1
s_mul_i32 s4, s20, 3
s_add_u32 s3, s4, 0
s_and_b32 s5, s3, 3
s_lshl_b32 s5, s5, 1
s_lshr_b32 s3, s3, 2
s_lshl_b32 s3, s3, 7
v_add_u32 v27, s5, v26
v_xor_b32 v27, v27, v24
v_lshl_add_u32 v27, v27, 4, v25
v_add_u32 v14, s3, v27
v_add_u32 v17, 61440, v14
s_add_u32 s3, s4, 1
s_and_b32 s5, s3, 3
s_lshl_b32 s5, s5, 1
s_lshr_b32 s3, s3, 2
s_lshl_b32 s3, s3, 7
v_add_u32 v27, s5, v26
v_xor_b32 v27, v27, v24
v_lshl_add_u32 v27, v27, 4, v25
v_add_u32 v15, s3, v27
v_add_u32 v18, 61440, v15
s_add_u32 s3, s4, 2
s_and_b32 s5, s3, 3
s_lshl_b32 s5, s5, 1
s_lshr_b32 s3, s3, 2
s_lshl_b32 s3, s3, 7
v_add_u32 v27, s5, v26
v_xor_b32 v27, v27, v24
v_lshl_add_u32 v27, v27, 4, v25
v_add_u32 v16, s3, v27
v_add_u32 v19, 61440, v16
s_waitcnt vmcnt(11)
s_barrier
ds_read_b64_tr_b16 a[176:177], v14 offset:28672
ds_read_b64_tr_b16 a[178:179], v14 offset:30208
ds_read_b64_tr_b16 a[184:185], v15 offset:28672
ds_read_b64_tr_b16 a[186:187], v15 offset:30208
ds_read_b64_tr_b16 a[192:193], v16 offset:28672
ds_read_b64_tr_b16 a[194:195], v16 offset:30208
ds_read_b64_tr_b16 a[180:181], v14 offset:40960
ds_read_b64_tr_b16 a[182:183], v14 offset:42496
ds_read_b64_tr_b16 a[188:189], v15 offset:40960
ds_read_b64_tr_b16 a[190:191], v15 offset:42496
ds_read_b64_tr_b16 a[196:197], v16 offset:40960
ds_read_b64_tr_b16 a[198:199], v16 offset:42496
ds_read_b128 a[224:227], v12 offset:0
ds_read_b128 a[228:231], v13 offset:0
ds_read_b128 a[232:235], v12 offset:2048
ds_read_b128 a[236:239], v13 offset:2048
ds_read_b128 a[240:243], v12 offset:4096
ds_read_b128 a[244:247], v13 offset:4096
s_waitcnt lgkmcnt(0)
s_barrier
M a[68:71], a[176:179], a[224:227], 0
ds_read_b128 a[248:251], v12 offset:6144
ds_read_b128 a[252:255], v13 offset:6144
M a[68:71], a[180:183], a[228:231], a[68:71]
s_sub_u32 s31, s31, 1
s_cmp_eq_u32 s31, 0
s_cselect_b32 s58, -1920, s57
s_add_u32 s23, s23, s58
s_add_u32 s24, s24, s58
M a[72:75], a[188:191], a[228:231], 0
ds_read_b64_tr_b16 a[200:201], v17 offset:0
ds_read_b64_tr_b16 a[202:203], v17 offset:1536
M a[72:75], a[184:187], a[224:227], a[72:75]
s_add_u32 m0, s30, 36864
s_nop 0
buffer_load_dwordx4 v6, s[12:15], s25 offen offset:0 lds
M a[76:79], a[192:195], a[224:227], 0
M a[76:79], a[196:199], a[228:231], a[76:79]
buffer_load_dwordx4 v7, s[12:15], s25 offen offset:1024 lds
M a[80:83], a[180:183], a[236:239], 0
ds_read_b128 a[224:227], v12 offset:8192
ds_read_b128 a[228:231], v13 offset:8192
M a[80:83], a[176:179], a[232:235], a[80:83]
M a[84:87], a[184:187], a[232:235], 0
ds_read_b64_tr_b16 a[208:209], v18 offset:0
ds_read_b64_tr_b16 a[210:211], v18 offset:1536
M a[84:87], a[188:191], a[236:239], a[84:87]
buffer_load_dwordx4 v8, s[12:15], s25 offen offset:2048 lds
M a[88:91], a[196:199], a[236:239], 0
M a[88:91], a[192:195], a[232:235], a[88:91]
buffer_load_dwordx4 v9, s[12:15], s25 offen offset:3072 lds
M a[92:95], a[176:179], a[240:243], 0
ds_read_b128 a[232:235], v12 offset:10240
ds_read_b128 a[236:239], v13 offset:10240
M a[92:95], a[180:183], a[244:247], a[92:95]
M a[96:99], a[188:191], a[244:247], 0
ds_read_b64_tr_b16 a[216:217], v19 offset:0
ds_read_b64_tr_b16 a[218:219], v19 offset:1536
M a[96:99], a[184:187], a[240:243], a[96:99]
s_add_u32 m0, s30, 40960
s_nop 0
buffer_load_dwordx4 v21, s[12:15], s25 offen offset:0 lds
M a[100:103], a[192:195], a[240:243], 0
buffer_load_dwordx4 v22, s[12:15], s25 offen offset:1024 lds
M a[100:103], a[196:199], a[244:247], a[100:103]
s_waitcnt lgkmcnt(10)
M a[104:107], a[180:183], a[252:255], 0
ds_read_b128 a[240:243], v12 offset:12288
ds_read_b128 a[244:247], v13 offset:12288
M a[104:107], a[176:179], a[248:251], a[104:107]
s_sub_u32 s54, s54, 1
s_cmp_eq_u32 s54, 0
s_cselect_b32 s58, s55, s56
s_add_u32 s25, s25, s58
M a[108:111], a[184:187], a[248:251], 0
ds_read_b64_tr_b16 a[204:205], v17 offset:12288
ds_read_b64_tr_b16 a[206:207], v17 offset:13824
M a[108:111], a[188:191], a[252:255], a[108:111]
M a[112:115], a[196:199], a[252:255], 0
s_add_u32 m0, s30, 65536
s_nop 0
buffer_load_dwordx4 v6, s[12:15], s25 offen offset:0 lds
M a[112:115], a[192:195], a[248:251], a[112:115]
s_waitcnt lgkmcnt(10)
M a[116:119], a[176:179], a[224:227], 0
ds_read_b128 a[248:251], v12 offset:14336
ds_read_b128 a[252:255], v13 offset:14336
M a[116:119], a[180:183], a[228:231], a[116:119]
buffer_load_dwordx4 v7, s[12:15], s25 offen offset:1024 lds
M a[120:123], a[188:191], a[228:231], 0
ds_read_b64_tr_b16 a[212:213], v18 offset:12288
ds_read_b64_tr_b16 a[214:215], v18 offset:13824
M a[120:123], a[184:187], a[224:227], a[120:123]
M a[124:127], a[192:195], a[224:227], 0
buffer_load_dwordx4 v8, s[12:15], s25 offen offset:2048 lds
M a[124:127], a[196:199], a[228:231], a[124:127]
buffer_load_dwordx4 v9, s[12:15], s25 offen offset:3072 lds
s_waitcnt lgkmcnt(10)
M a[128:131], a[180:183], a[236:239], 0
ds_read_b128 a[224:227], v12 offset:16384
ds_read_b128 a[228:231], v13 offset:16384
M a[128:131], a[176:179], a[232:235], a[128:131]
M a[132:135], a[184:187], a[232:235], 0
ds_read_b64_tr_b16 a[220:221], v19 offset:12288
ds_read_b64_tr_b16 a[222:223], v19 offset:13824
M a[132:135], a[188:191], a[236:239], a[132:135]
s_add_u32 m0, s30, 69632
s_nop 0
buffer_load_dwordx4 v21, s[12:15], s25 offen offset:0 lds
M a[136:139], a[196:199], a[236:239], 0
M a[136:139], a[192:195], a[232:235], a[136:139]
buffer_load_dwordx4 v22, s[12:15], s25 offen offset:1024 lds
s_waitcnt lgkmcnt(10)
M a[140:143], a[176:179], a[240:243], 0
M a[140:143], a[180:183], a[244:247], a[140:143]
s_sub_u32 s54, s54, 1
s_cmp_eq_u32 s54, 0
s_cselect_b32 s58, s55, s56
s_add_u32 s25, s25, s58
M a[144:147], a[188:191], a[244:247], 0
M a[144:147], a[184:187], a[240:243], a[144:147]
M a[148:151], a[192:195], a[240:243], 0
s_waitcnt vmcnt(6) lgkmcnt(0)
s_barrier
ds_read_b128 a[232:235], v10 offset:0
ds_read_b128 a[236:239], v11 offset:0
M a[148:151], a[196:199], a[244:247], a[148:151]
s_add_u32 m0, s28, 131072
s_nop 0
buffer_load_dword v20, s[8:11], s24 offen lds
M a[152:155], a[180:183], a[252:255], 0
ds_read_b128 a[240:243], v10 offset:2048
ds_read_b128 a[244:247], v11 offset:2048
M a[152:155], a[176:179], a[248:251], a[152:155]
M a[156:159], a[184:187], a[248:251], 0
buffer_load_dword v23, s[8:11], s24 offen offset:256 lds
M a[156:159], a[188:191], a[252:255], a[156:159]
M a[160:163], a[196:199], a[252:255], 0
M a[160:163], a[192:195], a[248:251], a[160:163]
s_add_u32 m0, s29, 133120
s_nop 0
buffer_load_dwordx4 v2, s[8:11], s23 offen offset:0 lds
M a[164:167], a[176:179], a[224:227], 0
ds_read_b128 a[248:251], v10 offset:4096
ds_read_b128 a[252:255], v11 offset:4096
M a[164:167], a[180:183], a[228:231], a[164:167]
M a[168:171], a[188:191], a[228:231], 0
M a[168:171], a[184:187], a[224:227], a[168:171]
buffer_load_dwordx4 v3, s[8:11], s23 offen offset:1024 lds
M a[172:175], a[192:195], a[224:227], 0
M a[172:175], a[196:199], a[228:231], a[172:175]
s_waitcnt lgkmcnt(4)
M a[68:71], a[200:203], a[232:235], a[68:71]
ds_read_b128 a[224:227], v10 offset:6144
ds_read_b128 a[228:231], v11 offset:6144
M a[68:71], a[204:207], a[236:239], a[68:71]
buffer_load_dwordx4 v4, s[8:11], s23 offen offset:2048 lds
M a[72:75], a[212:215], a[236:239], a[72:75]
ds_read_b64_tr_b16 a[176:177], v14 offset:0
ds_read_b64_tr_b16 a[178:179], v14 offset:1536
M a[72:75], a[208:211], a[232:235], a[72:75]
buffer_load_dwordx4 v5, s[8:11], s23 offen offset:3072 lds
M a[76:79], a[216:219], a[232:235], a[76:79]
M a[76:79], a[220:223], a[236:239], a[76:79]
s_sub_u32 s31, s31, 1
s_cmp_eq_u32 s31, 0
s_cselect_b32 s58, -1920, s57
s_add_u32 s23, s23, s58
s_add_u32 s24, s24, s58
s_waitcnt lgkmcnt(6)
M a[80:83], a[204:207], a[244:247], a[80:83]
ds_read_b128 a[232:235], v10 offset:8192
ds_read_b128 a[236:239], v11 offset:8192
M a[80:83], a[200:203], a[240:243], a[80:83]
M a[84:87], a[208:211], a[240:243], a[84:87]
ds_read_b64_tr_b16 a[184:185], v15 offset:0
ds_read_b64_tr_b16 a[186:187], v15 offset:1536
M a[84:87], a[212:215], a[244:247], a[84:87]
s_add_u32 m0, s30, 98304
s_nop 0
buffer_load_dwordx4 v6, s[12:15], s25 offen offset:0 lds
M a[88:91], a[220:223], a[244:247], a[88:91]
M a[88:91], a[216:219], a[240:243], a[88:91]
buffer_load_dwordx4 v7, s[12:15], s25 offen offset:1024 lds
s_waitcnt lgkmcnt(8)
M a[92:95], a[200:203], a[248:251], a[92:95]
ds_read_b128 a[240:243], v10 offset:10240
ds_read_b128 a[244:247], v11 offset:10240
M a[92:95], a[204:207], a[252:255], a[92:95]
M a[96:99], a[212:215], a[252:255], a[96:99]
ds_read_b64_tr_b16 a[192:193], v16 offset:0
ds_read_b64_tr_b16 a[194:195], v16 offset:1536
M a[96:99], a[208:211], a[248:251], a[96:99]
buffer_load_dwordx4 v8, s[12:15], s25 offen offset:2048 lds
M a[100:103], a[216:219], a[248:251], a[100:103]
M a[100:103], a[220:223], a[252:255], a[100:103]
buffer_load_dwordx4 v9, s[12:15], s25 offen offset:3072 lds
s_waitcnt lgkmcnt(10)
M a[104:107], a[204:207], a[228:231], a[104:107]
ds_read_b128 a[248:251], v10 offset:12288
ds_read_b128 a[252:255], v11 offset:12288
M a[104:107], a[200:203], a[224:227], a[104:107]
M a[108:111], a[208:211], a[224:227], a[108:111]
ds_read_b64_tr_b16 a[180:181], v14 offset:12288
ds_read_b64_tr_b16 a[182:183], v14 offset:13824
M a[108:111], a[212:215], a[228:231], a[108:111]
s_add_u32 m0, s30, 102400
s_nop 0
buffer_load_dwordx4 v21, s[12:15], s25 offen offset:0 lds
M a[112:115], a[220:223], a[228:231], a[112:115]
M a[112:115], a[216:219], a[224:227], a[112:115]
buffer_load_dwordx4 v22, s[12:15], s25 offen offset:1024 lds
s_waitcnt lgkmcnt(10)
M a[116:119], a[200:203], a[232:235], a[116:119]
ds_read_b128 a[224:227], v10 offset:14336
ds_read_b128 a[228:231], v11 offset:14336
M a[116:119], a[204:207], a[236:239], a[116:119]
M a[120:123], a[212:215], a[236:239], a[120:123]
ds_read_b64_tr_b16 a[188:189], v15 offset:12288
ds_read_b64_tr_b16 a[190:191], v15 offset:13824
M a[120:123], a[208:211], a[232:235], a[120:123]
s_sub_u32 s54, s54, 1
s_cmp_eq_u32 s54, 0
s_cselect_b32 s58, s55, s56
s_add_u32 s25, s25, s58
M a[124:127], a[216:219], a[232:235], a[124:127]
M a[124:127], a[220:223], a[236:239], a[124:127]
s_add_u32 s94, s92, 12288
buffer_store_dwordx4 v[144:147], v1, s[16:19], s94 offen offset:2048 sc1
s_waitcnt lgkmcnt(10)
M a[128:131], a[204:207], a[244:247], a[128:131]
ds_read_b128 a[232:235], v10 offset:16384
ds_read_b128 a[236:239], v11 offset:16384
M a[128:131], a[200:203], a[240:243], a[128:131]
M a[132:135], a[208:211], a[240:243], a[132:135]
ds_read_b64_tr_b16 a[196:197], v16 offset:12288
ds_read_b64_tr_b16 a[198:199], v16 offset:13824
M a[132:135], a[212:215], a[244:247], a[132:135]
s_add_u32 s94, s92, 12288
buffer_store_dwordx4 v[152:155], v1, s[16:19], s94 offen offset:3072 sc1
M a[136:139], a[220:223], a[244:247], a[136:139]
M a[136:139], a[216:219], a[240:243], a[136:139]
s_add_u32 s94, s93, 0
buffer_store_dwordx4 v[160:163], v1, s[16:19], s94 offen offset:0 sc1
s_waitcnt lgkmcnt(10)
M a[140:143], a[200:203], a[248:251], a[140:143]
M a[140:143], a[204:207], a[252:255], a[140:143]
s_add_u32 s94, s93, 0
buffer_store_dwordx4 v[168:171], v1, s[16:19], s94 offen offset:1024 sc1
M a[144:147], a[212:215], a[252:255], a[144:147]
M a[144:147], a[208:211], a[248:251], a[144:147]
M a[148:151], a[216:219], a[248:251], a[148:151]
s_waitcnt vmcnt(16) lgkmcnt(0)
s_barrier
ds_read_b128 a[240:243], v10 offset:18432
ds_read_b128 a[244:247], v11 offset:18432
M a[148:151], a[220:223], a[252:255], a[148:151]
s_add_u32 m0, s28, 0
s_nop 0
buffer_load_dword v20, s[8:11], s24 offen lds
M a[152:155], a[204:207], a[228:231], a[152:155]
ds_read_b128 a[248:251], v10 offset:20480
ds_read_b128 a[252:255], v11 offset:20480
M a[152:155], a[200:203], a[224:227], a[152:155]
M a[156:159], a[208:211], a[224:227], a[156:159]
buffer_load_dword v23, s[8:11], s24 offen offset:256 lds
M a[156:159], a[212:215], a[228:231], a[156:159]
M a[160:163], a[220:223], a[228:231], a[160:163]
M a[160:163], a[216:219], a[224:227], a[160:163]
s_add_u32 m0, s29, 2048
s_nop 0
buffer_load_dwordx4 v2, s[8:11], s23 offen offset:0 lds
M a[164:167], a[200:203], a[232:235], a[164:167]
ds_read_b128 a[224:227], v10 offset:22528
ds_read_b128 a[228:231], v11 offset:22528
M a[164:167], a[204:207], a[236:239], a[164:167]
M a[168:171], a[212:215], a[236:239], a[168:171]
M a[168:171], a[208:211], a[232:235], a[168:171]
buffer_load_dwordx4 v3, s[8:11], s23 offen offset:1024 lds
M a[172:175], a[216:219], a[232:235], a[172:175]
M a[172:175], a[220:223], a[236:239], a[172:175]
s_waitcnt lgkmcnt(4)
M a[68:71], a[176:179], a[240:243], a[68:71]
ds_read_b128 a[232:235], v10 offset:24576
ds_read_b128 a[236:239], v11 offset:24576
M a[68:71], a[180:183], a[244:247], a[68:71]
buffer_load_dwordx4 v4, s[8:11], s23 offen offset:2048 lds
M a[72:75], a[188:191], a[244:247], a[72:75]
ds_read_b64_tr_b16 a[200:201], v14 offset:28672
ds_read_b64_tr_b16 a[202:203], v14 offset:30208
M a[72:75], a[184:187], a[240:243], a[72:75]
buffer_load_dwordx4 v5, s[8:11], s23 offen offset:3072 lds
M a[76:79], a[192:195], a[240:243], a[76:79]
M a[76:79], a[196:199], a[244:247], a[76:79]
s_sub_u32 s31, s31, 1
s_cmp_eq_u32 s31, 0
s_cselect_b32 s58, -1920, s57
s_add_u32 s23, s23, s58
s_add_u32 s24, s24, s58
s_waitcnt lgkmcnt(6)
M a[80:83], a[180:183], a[252:255], a[80:83]
ds_read_b128 a[240:243], v10 offset:26624
ds_read_b128 a[244:247], v11 offset:26624
M a[80:83], a[176:179], a[248:251], a[80:83]
M a[84:87], a[184:187], a[248:251], a[84:87]
ds_read_b64_tr_b16 a[208:209], v15 offset:28672
ds_read_b64_tr_b16 a[210:211], v15 offset:30208
M a[84:87], a[188:191], a[252:255], a[84:87]
s_add_u32 m0, s30, 36864
s_nop 0
buffer_load_dwordx4 v6, s[12:15], s25 offen offset:0 lds
M a[88:91], a[196:199], a[252:255], a[88:91]
M a[88:91], a[192:195], a[248:251], a[88:91]
buffer_load_dwordx4 v7, s[12:15], s25 offen offset:1024 lds
s_waitcnt lgkmcnt(8)
M a[92:95], a[176:179], a[224:227], a[92:95]
ds_read_b128 a[248:251], v10 offset:28672
ds_read_b128 a[252:255], v11 offset:28672
M a[92:95], a[180:183], a[228:231], a[92:95]
M a[96:99], a[188:191], a[228:231], a[96:99]
ds_read_b64_tr_b16 a[216:217], v16 offset:28672
ds_read_b64_tr_b16 a[218:219], v16 offset:30208
M a[96:99], a[184:187], a[224:227], a[96:99]
buffer_load_dwordx4 v8, s[12:15], s25 offen offset:2048 lds
M a[100:103], a[192:195], a[224:227], a[100:103]
M a[100:103], a[196:199], a[228:231], a[100:103]
buffer_load_dwordx4 v9, s[12:15], s25 offen offset:3072 lds
s_waitcnt lgkmcnt(10)
M a[104:107], a[180:183], a[236:239], a[104:107]
ds_read_b128 a[224:227], v10 offset:30720
ds_read_b128 a[228:231], v11 offset:30720
M a[104:107], a[176:179], a[232:235], a[104:107]
M a[108:111], a[184:187], a[232:235], a[108:111]
ds_read_b64_tr_b16 a[204:205], v14 offset:40960
ds_read_b64_tr_b16 a[206:207], v14 offset:42496
M a[108:111], a[188:191], a[236:239], a[108:111]
s_add_u32 m0, s30, 40960
s_nop 0
buffer_load_dwordx4 v21, s[12:15], s25 offen offset:0 lds
M a[112:115], a[196:199], a[236:239], a[112:115]
M a[112:115], a[192:195], a[232:235], a[112:115]
buffer_load_dwordx4 v22, s[12:15], s25 offen offset:1024 lds
s_waitcnt lgkmcnt(10)
M a[116:119], a[176:179], a[240:243], a[116:119]
ds_read_b128 a[232:235], v10 offset:32768
ds_read_b128 a[236:239], v11 offset:32768
M a[116:119], a[180:183], a[244:247], a[116:119]
M a[120:123], a[188:191], a[244:247], a[120:123]
ds_read_b64_tr_b16 a[212:213], v15 offset:40960
ds_read_b64_tr_b16 a[214:215], v15 offset:42496
M a[120:123], a[184:187], a[240:243], a[120:123]
s_sub_u32 s54, s54, 1
s_cmp_eq_u32 s54, 0
s_cselect_b32 s58, s55, s56
s_add_u32 s25, s25, s58
M a[124:127], a[192:195], a[240:243], a[124:127]
M a[124:127], a[196:199], a[244:247], a[124:127]
s_add_u32 s94, s93, 0
buffer_store_dwordx4 v[176:179], v1, s[16:19], s94 offen offset:2048 sc1
s_waitcnt lgkmcnt(10)
M a[128:131], a[180:183], a[252:255], a[128:131]
ds_read_b128 a[240:243], v10 offset:34816
ds_read_b128 a[244:247], v11 offset:34816
M a[128:131], a[176:179], a[248:251], a[128:131]
M a[132:135], a[184:187], a[248:251], a[132:135]
ds_read_b64_tr_b16 a[220:221], v16 offset:40960
ds_read_b64_tr_b16 a[222:223], v16 offset:42496
M a[132:135], a[188:191], a[252:255], a[132:135]
s_add_u32 s94, s93, 0
buffer_store_dwordx4 v[184:187], v1, s[16:19], s94 offen offset:3072 sc1
M a[136:139], a[196:199], a[252:255], a[136:139]
M a[136:139], a[192:195], a[248:251], a[136:139]
s_add_u32 s94, s93, 4096
buffer_store_dwordx4 v[192:195], v1, s[16:19], s94 offen offset:0 sc1
s_waitcnt lgkmcnt(10)
M a[140:143], a[176:179], a[224:227], a[140:143]
M a[140:143], a[180:183], a[228:231], a[140:143]
s_add_u32 s94, s93, 4096
buffer_store_dwordx4 v[200:203], v1, s[16:19], s94 offen offset:1024 sc1
M a[144:147], a[188:191], a[228:231], a[144:147]
M a[144:147], a[184:187], a[224:227], a[144:147]
M a[148:151], a[192:195], a[224:227], a[148:151]
s_waitcnt vmcnt(20) lgkmcnt(0)
s_barrier
ds_read_b128 a[248:251], v12 offset:0
ds_read_b128 a[252:255], v13 offset:0
M a[148:151], a[196:199], a[228:231], a[148:151]
s_add_u32 m0, s28, 18432
s_nop 0
buffer_load_dword v20, s[8:11], s24 offen lds
M a[152:155], a[180:183], a[236:239], a[152:155]
ds_read_b128 a[224:227], v12 offset:2048
ds_read_b128 a[228:231], v13 offset:2048
M a[152:155], a[176:179], a[232:235], a[152:155]
M a[156:159], a[184:187], a[232:235], a[156:159]
buffer_load_dword v23, s[8:11], s24 offen offset:256 lds
M a[156:159], a[188:191], a[236:239], a[156:159]
M a[160:163], a[196:199], a[236:239], a[160:163]
M a[160:163], a[192:195], a[232:235], a[160:163]
s_add_u32 m0, s29, 20480
s_nop 0
buffer_load_dwordx4 v2, s[8:11], s23 offen offset:0 lds
M a[164:167], a[176:179], a[240:243], a[164:167]
ds_read_b128 a[232:235], v12 offset:4096
ds_read_b128 a[236:239], v13 offset:4096
M a[164:167], a[180:183], a[244:247], a[164:167]
M a[168:171], a[188:191], a[244:247], a[168:171]
M a[168:171], a[184:187], a[240:243], a[168:171]
buffer_load_dwordx4 v3, s[8:11], s23 offen offset:1024 lds
M a[172:175], a[192:195], a[240:243], a[172:175]
M a[172:175], a[196:199], a[244:247], a[172:175]
s_waitcnt lgkmcnt(4)
M a[68:71], a[200:203], a[248:251], a[68:71]
ds_read_b128 a[240:243], v12 offset:6144
ds_read_b128 a[244:247], v13 offset:6144
M a[68:71], a[204:207], a[252:255], a[68:71]
buffer_load_dwordx4 v4, s[8:11], s23 offen offset:2048 lds
M a[72:75], a[212:215], a[252:255], a[72:75]
ds_read_b64_tr_b16 a[176:177], v17 offset:0
ds_read_b64_tr_b16 a[178:179], v17 offset:1536
M a[72:75], a[208:211], a[248:251], a[72:75]
buffer_load_dwordx4 v5, s[8:11], s23 offen offset:3072 lds
M a[76:79], a[216:219], a[248:251], a[76:79]
M a[76:79], a[220:223], a[252:255], a[76:79]
s_sub_u32 s31, s31, 1
s_cmp_eq_u32 s31, 0
s_cselect_b32 s58, -1920, s57
s_add_u32 s23, s23, s58
s_add_u32 s24, s24, s58
s_waitcnt lgkmcnt(6)
M a[80:83], a[204:207], a[228:231], a[80:83]
ds_read_b128 a[248:251], v12 offset:8192
ds_read_b128 a[252:255], v13 offset:8192
M a[80:83], a[200:203], a[224:227], a[80:83]
M a[84:87], a[208:211], a[224:227], a[84:87]
ds_read_b64_tr_b16 a[184:185], v18 offset:0
ds_read_b64_tr_b16 a[186:187], v18 offset:1536
M a[84:87], a[212:215], a[228:231], a[84:87]
s_add_u32 m0, s30, 65536
s_nop 0
buffer_load_dwordx4 v6, s[12:15], s25 offen offset:0 lds
M a[88:91], a[220:223], a[228:231], a[88:91]
M a[88:91], a[216:219], a[224:227], a[88:91]
buffer_load_dwordx4 v7, s[12:15], s25 offen offset:1024 lds
s_waitcnt lgkmcnt(8)
M a[92:95], a[200:203], a[232:235], a[92:95]
ds_read_b128 a[224:227], v12 offset:10240
ds_read_b128 a[228:231], v13 offset:10240
M a[92:95], a[204:207], a[236:239], a[92:95]
M a[96:99], a[212:215], a[236:239], a[96:99]
ds_read_b64_tr_b16 a[192:193], v19 offset:0
ds_read_b64_tr_b16 a[194:195], v19 offset:1536
M a[96:99], a[208:211], a[232:235], a[96:99]
buffer_load_dwordx4 v8, s[12:15], s25 offen offset:2048 lds
M a[100:103], a[216:219], a[232:235], a[100:103]
M a[100:103], a[220:223], a[236:239], a[100:103]
buffer_load_dwordx4 v9, s[12:15], s25 offen offset:3072 lds
s_waitcnt lgkmcnt(10)
M a[104:107], a[204:207], a[244:247], a[104:107]
ds_read_b128 a[232:235], v12 offset:12288
ds_read_b128 a[236:239], v13 offset:12288
M a[104:107], a[200:203], a[240:243], a[104:107]
M a[108:111], a[208:211], a[240:243], a[108:111]
ds_read_b64_tr_b16 a[180:181], v17 offset:12288
ds_read_b64_tr_b16 a[182:183], v17 offset:13824
M a[108:111], a[212:215], a[244:247], a[108:111]
s_add_u32 m0, s30, 69632
s_nop 0
buffer_load_dwordx4 v21, s[12:15], s25 offen offset:0 lds
M a[112:115], a[220:223], a[244:247], a[112:115]
M a[112:115], a[216:219], a[240:243], a[112:115]
buffer_load_dwordx4 v22, s[12:15], s25 offen offset:1024 lds
s_waitcnt lgkmcnt(10)
M a[116:119], a[200:203], a[248:251], a[116:119]
ds_read_b128 a[240:243], v12 offset:14336
ds_read_b128 a[244:247], v13 offset:14336
M a[116:119], a[204:207], a[252:255], a[116:119]
M a[120:123], a[212:215], a[252:255], a[120:123]
ds_read_b64_tr_b16 a[188:189], v18 offset:12288
ds_read_b64_tr_b16 a[190:191], v18 offset:13824
M a[120:123], a[208:211], a[248:251], a[120:123]
s_sub_u32 s54, s54, 1
s_cmp_eq_u32 s54, 0
s_cselect_b32 s58, s55, s56
s_add_u32 s25, s25, s58
M a[124:127], a[216:219], a[248:251], a[124:127]
M a[124:127], a[220:223], a[252:255], a[124:127]
s_add_u32 s94, s93, 4096
buffer_store_dwordx4 v[208:211], v1, s[16:19], s94 offen offset:2048 sc1
s_waitcnt lgkmcnt(10)
M a[128:131], a[204:207], a[228:231], a[128:131]
ds_read_b128 a[248:251], v12 offset:16384
ds_read_b128 a[252:255], v13 offset:16384
M a[128:131], a[200:203], a[224:227], a[128:131]
M a[132:135], a[208:211], a[224:227], a[132:135]
ds_read_b64_tr_b16 a[196:197], v19 offset:12288
ds_read_b64_tr_b16 a[198:199], v19 offset:13824
M a[132:135], a[212:215], a[228:231], a[132:135]
s_add_u32 s94, s93, 4096
buffer_store_dwordx4 v[216:219], v1, s[16:19], s94 offen offset:3072 sc1
M a[136:139], a[220:223], a[228:231], a[136:139]
M a[136:139], a[216:219], a[224:227], a[136:139]
s_add_u32 s94, s93, 8192
buffer_store_dwordx4 v[224:227], v1, s[16:19], s94 offen offset:0 sc1
s_waitcnt lgkmcnt(10)
M a[140:143], a[200:203], a[232:235], a[140:143]
M a[140:143], a[204:207], a[236:239], a[140:143]
s_add_u32 s94, s93, 8192
buffer_store_dwordx4 v[232:235], v1, s[16:19], s94 offen offset:1024 sc1
M a[144:147], a[212:215], a[236:239], a[144:147]
M a[144:147], a[208:211], a[232:235], a[144:147]
M a[148:151], a[216:219], a[232:235], a[148:151]
s_waitcnt vmcnt(20) lgkmcnt(0)
s_barrier
ds_read_b128 a[224:227], v10 offset:0
ds_read_b128 a[228:231], v11 offset:0
M a[148:151], a[220:223], a[236:239], a[148:151]
s_add_u32 m0, s28, 131072
s_nop 0
buffer_load_dword v20, s[8:11], s24 offen lds
M a[152:155], a[204:207], a[244:247], a[152:155]
ds_read_b128 a[232:235], v10 offset:2048
ds_read_b128 a[236:239], v11 offset:2048
M a[152:155], a[200:203], a[240:243], a[152:155]
M a[156:159], a[208:211], a[240:243], a[156:159]
buffer_load_dword v23, s[8:11], s24 offen offset:256 lds
M a[156:159], a[212:215], a[244:247], a[156:159]
M a[160:163], a[220:223], a[244:247], a[160:163]
M a[160:163], a[216:219], a[240:243], a[160:163]
s_add_u32 m0, s29, 133120
s_nop 0
buffer_load_dwordx4 v2, s[8:11], s23 offen offset:0 lds
M a[164:167], a[200:203], a[248:251], a[164:167]
ds_read_b128 a[240:243], v10 offset:4096
ds_read_b128 a[244:247], v11 offset:4096
M a[164:167], a[204:207], a[252:255], a[164:167]
M a[168:171], a[212:215], a[252:255], a[168:171]
M a[168:171], a[208:211], a[248:251], a[168:171]
buffer_load_dwordx4 v3, s[8:11], s23 offen offset:1024 lds
M a[172:175], a[216:219], a[248:251], a[172:175]
M a[172:175], a[220:223], a[252:255], a[172:175]
s_waitcnt lgkmcnt(4)
M a[68:71], a[176:179], a[224:227], a[68:71]
ds_read_b128 a[248:251], v10 offset:6144
ds_read_b128 a[252:255], v11 offset:6144
M a[68:71], a[180:183], a[228:231], a[68:71]
buffer_load_dwordx4 v4, s[8:11], s23 offen offset:2048 lds
M a[72:75], a[188:191], a[228:231], a[72:75]
ds_read_b64_tr_b16 a[200:201], v14 offset:0
ds_read_b64_tr_b16 a[202:203], v14 offset:1536
M a[72:75], a[184:187], a[224:227], a[72:75]
buffer_load_dwordx4 v5, s[8:11], s23 offen offset:3072 lds
M a[76:79], a[192:195], a[224:227], a[76:79]
M a[76:79], a[196:199], a[228:231], a[76:79]
s_sub_u32 s31, s31, 1
s_cmp_eq_u32 s31, 0
s_cselect_b32 s58, -1920, s57
s_add_u32 s23, s23, s58
s_add_u32 s24, s24, s58
s_waitcnt lgkmcnt(6)
M a[80:83], a[180:183], a[236:239], a[80:83]
ds_read_b128 a[224:227], v10 offset:8192
ds_read_b128 a[228:231], v11 offset:8192
M a[80:83], a[176:179], a[232:235], a[80:83]
M a[84:87], a[184:187], a[232:235], a[84:87]
ds_read_b64_tr_b16 a[208:209], v15 offset:0
ds_read_b64_tr_b16 a[210:211], v15 offset:1536
M a[84:87], a[188:191], a[236:239], a[84:87]
s_add_u32 m0, s30, 98304
s_nop 0
buffer_load_dwordx4 v6, s[12:15], s25 offen offset:0 lds
M a[88:91], a[196:199], a[236:239], a[88:91]
M a[88:91], a[192:195], a[232:235], a[88:91]
buffer_load_dwordx4 v7, s[12:15], s25 offen offset:1024 lds
s_waitcnt lgkmcnt(8)
M a[92:95], a[176:179], a[240:243], a[92:95]
ds_read_b128 a[232:235], v10 offset:10240
ds_read_b128 a[236:239], v11 offset:10240
M a[92:95], a[180:183], a[244:247], a[92:95]
M a[96:99], a[188:191], a[244:247], a[96:99]
ds_read_b64_tr_b16 a[216:217], v16 offset:0
ds_read_b64_tr_b16 a[218:219], v16 offset:1536
M a[96:99], a[184:187], a[240:243], a[96:99]
buffer_load_dwordx4 v8, s[12:15], s25 offen offset:2048 lds
M a[100:103], a[192:195], a[240:243], a[100:103]
M a[100:103], a[196:199], a[244:247], a[100:103]
buffer_load_dwordx4 v9, s[12:15], s25 offen offset:3072 lds
s_waitcnt lgkmcnt(10)
M a[104:107], a[180:183], a[252:255], a[104:107]
ds_read_b128 a[240:243], v10 offset:12288
ds_read_b128 a[244:247], v11 offset:12288
M a[104:107], a[176:179], a[248:251], a[104:107]
M a[108:111], a[184:187], a[248:251], a[108:111]
ds_read_b64_tr_b16 a[204:205], v14 offset:12288
ds_read_b64_tr_b16 a[206:207], v14 offset:13824
M a[108:111], a[188:191], a[252:255], a[108:111]
s_add_u32 m0, s30, 102400
s_nop 0
buffer_load_dwordx4 v21, s[12:15], s25 offen offset:0 lds
M a[112:115], a[196:199], a[252:255], a[112:115]
M a[112:115], a[192:195], a[248:251], a[112:115]
buffer_load_dwordx4 v22, s[12:15], s25 offen offset:1024 lds
s_waitcnt lgkmcnt(10)
M a[116:119], a[176:179], a[224:227], a[116:119]
ds_read_b128 a[248:251], v10 offset:14336
ds_read_b128 a[252:255], v11 offset:14336
M a[116:119], a[180:183], a[228:231], a[116:119]
M a[120:123], a[188:191], a[228:231], a[120:123]
ds_read_b64_tr_b16 a[212:213], v15 offset:12288
ds_read_b64_tr_b16 a[214:215], v15 offset:13824
M a[120:123], a[184:187], a[224:227], a[120:123]
s_sub_u32 s54, s54, 1
s_cmp_eq_u32 s54, 0
s_cselect_b32 s58, s55, s56
s_add_u32 s25, s25, s58
M a[124:127], a[192:195], a[224:227], a[124:127]
M a[124:127], a[196:199], a[228:231], a[124:127]
s_add_u32 s94, s93, 8192
buffer_store_dwordx4 v[240:243], v1, s[16:19], s94 offen offset:2048 sc1
s_waitcnt lgkmcnt(10)
M a[128:131], a[180:183], a[236:239], a[128:131]
ds_read_b128 a[224:227], v10 offset:16384
ds_read_b128 a[228:231], v11 offset:16384
M a[128:131], a[176:179], a[232:235], a[128:131]
M a[132:135], a[184:187], a[232:235], a[132:135]
ds_read_b64_tr_b16 a[220:221], v16 offset:12288
ds_read_b64_tr_b16 a[222:223], v16 offset:13824
M a[132:135], a[188:191], a[236:239], a[132:135]
s_add_u32 s94, s93, 8192
buffer_store_dwordx4 v[248:251], v1, s[16:19], s94 offen offset:3072 sc1
M a[136:139], a[196:199], a[236:239], a[136:139]
M a[136:139], a[192:195], a[232:235], a[136:139]
s_add_u32 s94, s93, 12288
buffer_store_dwordx4 v[36:39], v1, s[16:19], s94 offen offset:0 sc1
s_waitcnt lgkmcnt(10)
M a[140:143], a[176:179], a[240:243], a[140:143]
M a[140:143], a[180:183], a[244:247], a[140:143]
s_add_u32 s94, s93, 12288
buffer_store_dwordx4 v[44:47], v1, s[16:19], s94 offen offset:1024 sc1
M a[144:147], a[188:191], a[244:247], a[144:147]
M a[144:147], a[184:187], a[240:243], a[144:147]
M a[148:151], a[192:195], a[240:243], a[148:151]
s_waitcnt vmcnt(20) lgkmcnt(0)
s_barrier
ds_read_b128 a[232:235], v10 offset:18432
ds_read_b128 a[236:239], v11 offset:18432
M a[148:151], a[196:199], a[244:247], a[148:151]
s_add_u32 m0, s28, 0
s_nop 0
buffer_load_dword v20, s[8:11], s24 offen lds
M a[152:155], a[180:183], a[252:255], a[152:155]
ds_read_b128 a[240:243], v10 offset:20480
ds_read_b128 a[244:247], v11 offset:20480
M a[152:155], a[176:179], a[248:251], a[152:155]
M a[156:159], a[184:187], a[248:251], a[156:159]
buffer_load_dword v23, s[8:11], s24 offen offset:256 lds
M a[156:159], a[188:191], a[252:255], a[156:159]
M a[160:163], a[196:199], a[252:255], a[160:163]
M a[160:163], a[192:195], a[248:251], a[160:163]
s_add_u32 m0, s29, 2048
s_nop 0
buffer_load_dwordx4 v2, s[8:11], s23 offen offset:0 lds
M a[164:167], a[176:179], a[224:227], a[164:167]
ds_read_b128 a[248:251], v10 offset:22528
ds_read_b128 a[252:255], v11 offset:22528
M a[164:167], a[180:183], a[228:231], a[164:167]
M a[168:171], a[188:191], a[228:231], a[168:171]
M a[168:171], a[184:187], a[224:227], a[168:171]
buffer_load_dwordx4 v3, s[8:11], s23 offen offset:1024 lds
M a[172:175], a[192:195], a[224:227], a[172:175]
M a[172:175], a[196:199], a[228:231], a[172:175]
s_waitcnt lgkmcnt(4)
M a[68:71], a[200:203], a[232:235], a[68:71]
ds_read_b128 a[224:227], v10 offset:24576
ds_read_b128 a[228:231], v11 offset:24576
M a[68:71], a[204:207], a[236:239], a[68:71]
buffer_load_dwordx4 v4, s[8:11], s23 offen offset:2048 lds
M a[72:75], a[212:215], a[236:239], a[72:75]
ds_read_b64_tr_b16 a[176:177], v14 offset:28672
ds_read_b64_tr_b16 a[178:179], v14 offset:30208
M a[72:75], a[208:211], a[232:235], a[72:75]
M a[76:79], a[216:219], a[232:235], a[76:79]
buffer_load_dwordx4 v5, s[8:11], s23 offen offset:3072 lds
M a[76:79], a[220:223], a[236:239], a[76:79]
s_waitcnt lgkmcnt(6)
M a[80:83], a[204:207], a[244:247], a[80:83]
ds_read_b128 a[232:235], v10 offset:26624
ds_read_b128 a[236:239], v11 offset:26624
M a[80:83], a[200:203], a[240:243], a[80:83]
s_sub_u32 s31, s31, 1
s_cmp_eq_u32 s31, 0
s_cselect_b32 s58, -1920, s57
s_add_u32 s23, s23, s58
s_add_u32 s24, s24, s58
M a[84:87], a[208:211], a[240:243], a[84:87]
ds_read_b64_tr_b16 a[184:185], v15 offset:28672
ds_read_b64_tr_b16 a[186:187], v15 offset:30208
M a[84:87], a[212:215], a[244:247], a[84:87]
M a[88:91], a[220:223], a[244:247], a[88:91]
s_add_u32 m0, s30, 36864
s_nop 0
buffer_load_dwordx4 v6, s[12:15], s25 offen offset:0 lds
M a[88:91], a[216:219], a[240:243], a[88:91]
s_waitcnt lgkmcnt(8)
M a[92:95], a[200:203], a[248:251], a[92:95]
ds_read_b128 a[240:243], v10 offset:28672
ds_read_b128 a[244:247], v11 offset:28672
M a[92:95], a[204:207], a[252:255], a[92:95]
M a[96:99], a[212:215], a[252:255], a[96:99]
ds_read_b64_tr_b16 a[192:193], v16 offset:28672
ds_read_b64_tr_b16 a[194:195], v16 offset:30208
M a[96:99], a[208:211], a[248:251], a[96:99]
buffer_load_dwordx4 v7, s[12:15], s25 offen offset:1024 lds
M a[100:103], a[216:219], a[248:251], a[100:103]
M a[100:103], a[220:223], a[252:255], a[100:103]
buffer_load_dwordx4 v8, s[12:15], s25 offen offset:2048 lds
s_waitcnt lgkmcnt(10)
M a[104:107], a[204:207], a[228:231], a[104:107]
ds_read_b128 a[248:251], v10 offset:30720
ds_read_b128 a[252:255], v11 offset:30720
M a[104:107], a[200:203], a[224:227], a[104:107]
M a[108:111], a[208:211], a[224:227], a[108:111]
ds_read_b64_tr_b16 a[180:181], v14 offset:40960
ds_read_b64_tr_b16 a[182:183], v14 offset:42496
M a[108:111], a[212:215], a[228:231], a[108:111]
buffer_load_dwordx4 v9, s[12:15], s25 offen offset:3072 lds
M a[112:115], a[220:223], a[228:231], a[112:115]
M a[112:115], a[216:219], a[224:227], a[112:115]
s_add_u32 m0, s30, 40960
s_nop 0
buffer_load_dwordx4 v21, s[12:15], s25 offen offset:0 lds
s_waitcnt lgkmcnt(10)
M a[116:119], a[200:203], a[232:235], a[116:119]
ds_read_b128 a[224:227], v10 offset:32768
ds_read_b128 a[228:231], v11 offset:32768
M a[116:119], a[204:207], a[236:239], a[116:119]
M a[120:123], a[212:215], a[236:239], a[120:123]
ds_read_b64_tr_b16 a[188:189], v15 offset:40960
ds_read_b64_tr_b16 a[190:191], v15 offset:42496
M a[120:123], a[208:211], a[232:235], a[120:123]
M a[124:127], a[216:219], a[232:235], a[124:127]
buffer_load_dwordx4 v22, s[12:15], s25 offen offset:1024 lds
M a[124:127], a[220:223], a[236:239], a[124:127]
s_waitcnt lgkmcnt(10)
M a[128:131], a[204:207], a[244:247], a[128:131]
ds_read_b128 a[232:235], v10 offset:34816
ds_read_b128 a[236:239], v11 offset:34816
M a[128:131], a[200:203], a[240:243], a[128:131]
s_sub_u32 s54, s54, 1
s_cmp_eq_u32 s54, 0
s_cselect_b32 s58, s55, s56
s_add_u32 s25, s25, s58
M a[132:135], a[208:211], a[240:243], a[132:135]
ds_read_b64_tr_b16 a[196:197], v16 offset:40960
ds_read_b64_tr_b16 a[198:199], v16 offset:42496
M a[132:135], a[212:215], a[244:247], a[132:135]
M a[136:139], a[220:223], a[244:247], a[136:139]
s_add_u32 s94, s93, 12288
buffer_store_dwordx4 v[52:55], v1, s[16:19], s94 offen offset:2048 sc1
M a[136:139], a[216:219], a[240:243], a[136:139]
s_waitcnt lgkmcnt(10)
M a[140:143], a[200:203], a[248:251], a[140:143]
s_add_u32 s94, s93, 12288
buffer_store_dwordx4 v[60:63], v1, s[16:19], s94 offen offset:3072 sc1
M a[140:143], a[204:207], a[252:255], a[140:143]
M a[144:147], a[212:215], a[252:255], a[144:147]
M a[144:147], a[208:211], a[248:251], a[144:147]
M a[148:151], a[216:219], a[248:251], a[148:151]
s_waitcnt vmcnt(18) lgkmcnt(0)
s_barrier
ds_read_b128 a[240:243], v12 offset:0
ds_read_b128 a[244:247], v13 offset:0
M a[148:151], a[220:223], a[252:255], a[148:151]
s_add_u32 m0, s28, 18432
s_nop 0
buffer_load_dword v20, s[8:11], s24 offen lds
M a[152:155], a[204:207], a[228:231], a[152:155]
ds_read_b128 a[248:251], v12 offset:2048
ds_read_b128 a[252:255], v13 offset:2048
M a[152:155], a[200:203], a[224:227], a[152:155]
M a[156:159], a[208:211], a[224:227], a[156:159]
buffer_load_dword v23, s[8:11], s24 offen offset:256 lds
M a[156:159], a[212:215], a[228:231], a[156:159]
M a[160:163], a[220:223], a[228:231], a[160:163]
M a[160:163], a[216:219], a[224:227], a[160:163]
s_add_u32 m0, s29, 20480
s_nop 0
buffer_load_dwordx4 v2, s[8:11], s23 offen offset:0 lds
M a[164:167], a[200:203], a[232:235], a[164:167]
ds_read_b128 a[224:227], v12 offset:4096
ds_read_b128 a[228:231], v13 offset:4096
M a[164:167], a[204:207], a[236:239], a[164:167]
M a[168:171], a[212:215], a[236:239], a[168:171]
M a[168:171], a[208:211], a[232:235], a[168:171]
buffer_load_dwordx4 v3, s[8:11], s23 offen offset:1024 lds
M a[172:175], a[216:219], a[232:235], a[172:175]
M a[172:175], a[220:223], a[236:239], a[172:175]
s_waitcnt lgkmcnt(4)
M a[68:71], a[176:179], a[240:243], a[68:71]
ds_read_b128 a[232:235], v12 offset:6144
ds_read_b128 a[236:239], v13 offset:6144
M a[68:71], a[180:183], a[244:247], a[68:71]
buffer_load_dwordx4 v4, s[8:11], s23 offen offset:2048 lds
M a[72:75], a[188:191], a[244:247], a[72:75]
ds_read_b64_tr_b16 a[200:201], v17 offset:0
ds_read_b64_tr_b16 a[202:203], v17 offset:1536
M a[72:75], a[184:187], a[240:243], a[72:75]
M a[76:79], a[192:195], a[240:243], a[76:79]
buffer_load_dwordx4 v5, s[8:11], s23 offen offset:3072 lds
M a[76:79], a[196:199], a[244:247], a[76:79]
s_waitcnt lgkmcnt(6)
M a[80:83], a[180:183], a[252:255], a[80:83]
ds_read_b128 a[240:243], v12 offset:8192
ds_read_b128 a[244:247], v13 offset:8192
M a[80:83], a[176:179], a[248:251], a[80:83]
M a[84:87], a[184:187], a[248:251], a[84:87]
ds_read_b64_tr_b16 a[208:209], v18 offset:0
ds_read_b64_tr_b16 a[210:211], v18 offset:1536
M a[84:87], a[188:191], a[252:255], a[84:87]
s_sub_u32 s31, s31, 1
s_cmp_eq_u32 s31, 0
s_cselect_b32 s58, -1920, s57
s_add_u32 s23, s23, s58
s_add_u32 s24, s24, s58
M a[88:91], a[196:199], a[252:255], a[88:91]
M a[88:91], a[192:195], a[248:251], a[88:91]
s_waitcnt lgkmcnt(8)
M a[92:95], a[176:179], a[224:227], a[92:95]
ds_read_b128 a[248:251], v12 offset:10240
ds_read_b128 a[252:255], v13 offset:10240
M a[92:95], a[180:183], a[228:231], a[92:95]
s_add_u32 m0, s30, 65536
s_nop 0
buffer_load_dwordx4 v6, s[12:15], s25 offen offset:0 lds
M a[96:99], a[188:191], a[228:231], a[96:99]
ds_read_b64_tr_b16 a[216:217], v19 offset:0
ds_read_b64_tr_b16 a[218:219], v19 offset:1536
M a[96:99], a[184:187], a[224:227], a[96:99]
M a[100:103], a[192:195], a[224:227], a[100:103]
buffer_load_dwordx4 v7, s[12:15], s25 offen offset:1024 lds
M a[100:103], a[196:199], a[228:231], a[100:103]
s_waitcnt lgkmcnt(10)
M a[104:107], a[180:183], a[236:239], a[104:107]
ds_read_b128 a[224:227], v12 offset:12288
ds_read_b128 a[228:231], v13 offset:12288
M a[104:107], a[176:179], a[232:235], a[104:107]
M a[108:111], a[184:187], a[232:235], a[108:111]
ds_read_b64_tr_b16 a[204:205], v17 offset:12288
ds_read_b64_tr_b16 a[206:207], v17 offset:13824
M a[108:111], a[188:191], a[236:239], a[108:111]
buffer_load_dwordx4 v8, s[12:15], s25 offen offset:2048 lds
M a[112:115], a[196:199], a[236:239], a[112:115]
M a[112:115], a[192:195], a[232:235], a[112:115]
s_waitcnt lgkmcnt(10)
M a[116:119], a[176:179], a[240:243], a[116:119]
ds_read_b128 a[232:235], v12 offset:14336
ds_read_b128 a[236:239], v13 offset:14336
M a[116:119], a[180:183], a[244:247], a[116:119]
buffer_load_dwordx4 v9, s[12:15], s25 offen offset:3072 lds
M a[120:123], a[188:191], a[244:247], a[120:123]
ds_read_b64_tr_b16 a[212:213], v18 offset:12288
ds_read_b64_tr_b16 a[214:215], v18 offset:13824
M a[120:123], a[184:187], a[240:243], a[120:123]
M a[124:127], a[192:195], a[240:243], a[124:127]
s_add_u32 m0, s30, 69632
s_nop 0
buffer_load_dwordx4 v21, s[12:15], s25 offen offset:0 lds
M a[124:127], a[196:199], a[244:247], a[124:127]
s_waitcnt lgkmcnt(10)
M a[128:131], a[180:183], a[252:255], a[128:131]
ds_read_b128 a[240:243], v12 offset:16384
ds_read_b128 a[244:247], v13 offset:16384
M a[128:131], a[176:179], a[248:251], a[128:131]
M a[132:135], a[184:187], a[248:251], a[132:135]
ds_read_b64_tr_b16 a[220:221], v19 offset:12288
ds_read_b64_tr_b16 a[222:223], v19 offset:13824
M a[132:135], a[188:191], a[252:255], a[132:135]
buffer_load_dwordx4 v22, s[12:15], s25 offen offset:1024 lds
M a[136:139], a[196:199], a[252:255], a[136:139]
M a[136:139], a[192:195], a[248:251], a[136:139]
s_waitcnt lgkmcnt(10)
M a[140:143], a[176:179], a[224:227], a[140:143]
s_sub_u32 s54, s54, 1
s_cmp_eq_u32 s54, 0
s_cselect_b32 s58, s55, s56
s_add_u32 s25, s25, s58
M a[140:143], a[180:183], a[228:231], a[140:143]
M a[144:147], a[188:191], a[228:231], a[144:147]
M a[144:147], a[184:187], a[224:227], a[144:147]
M a[148:151], a[192:195], a[224:227], a[148:151]
s_waitcnt vmcnt(12) lgkmcnt(0)
s_barrier
ds_read_b128 a[248:251], v10 offset:0
ds_read_b128 a[252:255], v11 offset:0
s_cmp_lg_u32 s101, 0
s_cbranch_scc1 Lk1_arr
v_mov_b32 v127, 1
s_and_b32 s41, s2, 128
s_mov_b64 exec, 1
buffer_atomic_add v127, off, s[36:39], s41 sc1
s_mov_b64 exec, -1
Lk1_arr:
M a[148:151], a[196:199], a[228:231], a[148:151]
s_add_u32 m0, s28, 131072
s_nop 0
buffer_load_dword v20, s[8:11], s24 offen lds
M a[152:155], a[180:183], a[236:239], a[152:155]
ds_read_b128 a[224:227], v10 offset:2048
ds_read_b128 a[228:231], v11 offset:2048
M a[152:155], a[176:179], a[232:235], a[152:155]
M a[156:159], a[184:187], a[232:235], a[156:159]
buffer_load_dword v23, s[8:11], s24 offen offset:256 lds
M a[156:159], a[188:191], a[236:239], a[156:159]
M a[160:163], a[196:199], a[236:239], a[160:163]
M a[160:163], a[192:195], a[232:235], a[160:163]
s_add_u32 m0, s29, 133120
s_nop 0
buffer_load_dwordx4 v2, s[8:11], s23 offen offset:0 lds
M a[164:167], a[176:179], a[240:243], a[164:167]
ds_read_b128 a[232:235], v10 offset:4096
ds_read_b128 a[236:239], v11 offset:4096
M a[164:167], a[180:183], a[244:247], a[164:167]
M a[168:171], a[188:191], a[244:247], a[168:171]
M a[168:171], a[184:187], a[240:243], a[168:171]
buffer_load_dwordx4 v3, s[8:11], s23 offen offset:1024 lds
M a[172:175], a[192:195], a[240:243], a[172:175]
M a[172:175], a[196:199], a[244:247], a[172:175]
s_waitcnt lgkmcnt(4)
M a[68:71], a[200:203], a[248:251], a[68:71]
ds_read_b128 a[240:243], v10 offset:6144
ds_read_b128 a[244:247], v11 offset:6144
M a[68:71], a[204:207], a[252:255], a[68:71]
buffer_load_dwordx4 v4, s[8:11], s23 offen offset:2048 lds
M a[72:75], a[212:215], a[252:255], a[72:75]
ds_read_b64_tr_b16 a[176:177], v14 offset:0
ds_read_b64_tr_b16 a[178:179], v14 offset:1536
M a[72:75], a[208:211], a[248:251], a[72:75]
M a[76:79], a[216:219], a[248:251], a[76:79]
buffer_load_dwordx4 v5, s[8:11], s23 offen offset:3072 lds
M a[76:79], a[220:223], a[252:255], a[76:79]
s_waitcnt lgkmcnt(6)
M a[80:83], a[204:207], a[228:231], a[80:83]
ds_read_b128 a[248:251], v10 offset:8192
ds_read_b128 a[252:255], v11 offset:8192
M a[80:83], a[200:203], a[224:227], a[80:83]
M a[84:87], a[208:211], a[224:227], a[84:87]
ds_read_b64_tr_b16 a[184:185], v15 offset:0
ds_read_b64_tr_b16 a[186:187], v15 offset:1536
M a[84:87], a[212:215], a[228:231], a[84:87]
s_sub_u32 s31, s31, 1
s_cmp_eq_u32 s31, 0
s_cselect_b32 s58, -1920, s57
s_add_u32 s23, s23, s58
s_add_u32 s24, s24, s58
M a[88:91], a[220:223], a[228:231], a[88:91]
M a[88:91], a[216:219], a[224:227], a[88:91]
s_waitcnt lgkmcnt(8)
M a[92:95], a[200:203], a[232:235], a[92:95]
ds_read_b128 a[224:227], v10 offset:10240
ds_read_b128 a[228:231], v11 offset:10240
M a[92:95], a[204:207], a[236:239], a[92:95]
s_add_u32 m0, s30, 98304
s_nop 0
buffer_load_dwordx4 v6, s[12:15], s25 offen offset:0 lds
M a[96:99], a[212:215], a[236:239], a[96:99]
ds_read_b64_tr_b16 a[192:193], v16 offset:0
ds_read_b64_tr_b16 a[194:195], v16 offset:1536
M a[96:99], a[208:211], a[232:235], a[96:99]
M a[100:103], a[216:219], a[232:235], a[100:103]
buffer_load_dwordx4 v7, s[12:15], s25 offen offset:1024 lds
M a[100:103], a[220:223], a[236:239], a[100:103]
s_waitcnt lgkmcnt(10)
M a[104:107], a[204:207], a[244:247], a[104:107]
ds_read_b128 a[232:235], v10 offset:12288
ds_read_b128 a[236:239], v11 offset:12288
M a[104:107], a[200:203], a[240:243], a[104:107]
M a[108:111], a[208:211], a[240:243], a[108:111]
ds_read_b64_tr_b16 a[180:181], v14 offset:12288
ds_read_b64_tr_b16 a[182:183], v14 offset:13824
M a[108:111], a[212:215], a[244:247], a[108:111]
buffer_load_dwordx4 v8, s[12:15], s25 offen offset:2048 lds
M a[112:115], a[220:223], a[244:247], a[112:115]
M a[112:115], a[216:219], a[240:243], a[112:115]
s_waitcnt lgkmcnt(10)
M a[116:119], a[200:203], a[248:251], a[116:119]
ds_read_b128 a[240:243], v10 offset:14336
ds_read_b128 a[244:247], v11 offset:14336
M a[116:119], a[204:207], a[252:255], a[116:119]
buffer_load_dwordx4 v9, s[12:15], s25 offen offset:3072 lds
M a[120:123], a[212:215], a[252:255], a[120:123]
ds_read_b64_tr_b16 a[188:189], v15 offset:12288
ds_read_b64_tr_b16 a[190:191], v15 offset:13824
M a[120:123], a[208:211], a[248:251], a[120:123]
M a[124:127], a[216:219], a[248:251], a[124:127]
s_add_u32 m0, s30, 102400
s_nop 0
buffer_load_dwordx4 v21, s[12:15], s25 offen offset:0 lds
M a[124:127], a[220:223], a[252:255], a[124:127]
s_waitcnt lgkmcnt(10)
M a[128:131], a[204:207], a[228:231], a[128:131]
ds_read_b128 a[248:251], v10 offset:16384
ds_read_b128 a[252:255], v11 offset:16384
M a[128:131], a[200:203], a[224:227], a[128:131]
M a[132:135], a[208:211], a[224:227], a[132:135]
ds_read_b64_tr_b16 a[196:197], v16 offset:12288
ds_read_b64_tr_b16 a[198:199], v16 offset:13824
M a[132:135], a[212:215], a[228:231], a[132:135]
buffer_load_dwordx4 v22, s[12:15], s25 offen offset:1024 lds
M a[136:139], a[220:223], a[228:231], a[136:139]
M a[136:139], a[216:219], a[224:227], a[136:139]
s_waitcnt lgkmcnt(10)
M a[140:143], a[200:203], a[232:235], a[140:143]
s_sub_u32 s54, s54, 1
s_cmp_eq_u32 s54, 0
s_cselect_b32 s58, s55, s56
s_add_u32 s25, s25, s58
M a[140:143], a[204:207], a[236:239], a[140:143]
M a[144:147], a[212:215], a[236:239], a[144:147]
M a[144:147], a[208:211], a[232:235], a[144:147]
M a[148:151], a[216:219], a[232:235], a[148:151]
s_waitcnt vmcnt(12) lgkmcnt(0)
s_barrier
ds_read_b128 a[224:227], v10 offset:18432
ds_read_b128 a[228:231], v11 offset:18432
M a[148:151], a[220:223], a[236:239], a[148:151]
s_add_u32 m0, s28, 0
s_nop 0
buffer_load_dword v20, s[8:11], s24 offen lds
M a[152:155], a[204:207], a[244:247], a[152:155]
ds_read_b128 a[232:235], v10 offset:20480
ds_read_b128 a[236:239], v11 offset:20480
M a[152:155], a[200:203], a[240:243], a[152:155]
M a[156:159], a[208:211], a[240:243], a[156:159]
buffer_load_dword v23, s[8:11], s24 offen offset:256 lds
M a[156:159], a[212:215], a[244:247], a[156:159]
M a[160:163], a[220:223], a[244:247], a[160:163]
M a[160:163], a[216:219], a[240:243], a[160:163]
s_add_u32 m0, s29, 2048
s_nop 0
buffer_load_dwordx4 v2, s[8:11], s23 offen offset:0 lds
M a[164:167], a[200:203], a[248:251], a[164:167]
ds_read_b128 a[240:243], v10 offset:22528
ds_read_b128 a[244:247], v11 offset:22528
M a[164:167], a[204:207], a[252:255], a[164:167]
M a[168:171], a[212:215], a[252:255], a[168:171]
M a[168:171], a[208:211], a[248:251], a[168:171]
buffer_load_dwordx4 v3, s[8:11], s23 offen offset:1024 lds
M a[172:175], a[216:219], a[248:251], a[172:175]
M a[172:175], a[220:223], a[252:255], a[172:175]
s_waitcnt lgkmcnt(4)
M a[68:71], a[176:179], a[224:227], a[68:71]
ds_read_b128 a[248:251], v10 offset:24576
ds_read_b128 a[252:255], v11 offset:24576
v_mov_b32 v160, 0
v_mov_b32 v161, 0
M a[68:71], a[180:183], a[228:231], a[68:71]
buffer_load_dwordx4 v4, s[8:11], s23 offen offset:2048 lds
M a[72:75], a[188:191], a[228:231], a[72:75]
ds_read_b64_tr_b16 a[200:201], v14 offset:28672
ds_read_b64_tr_b16 a[202:203], v14 offset:30208
v_mov_b32 v162, 0
v_mov_b32 v163, 0
M a[72:75], a[184:187], a[224:227], a[72:75]
M a[76:79], a[192:195], a[224:227], a[76:79]
buffer_load_dwordx4 v5, s[8:11], s23 offen offset:3072 lds
v_mov_b32 v164, 0
v_mov_b32 v165, 0
M a[76:79], a[196:199], a[228:231], a[76:79]
s_waitcnt lgkmcnt(6)
M a[80:83], a[180:183], a[236:239], a[80:83]
ds_read_b128 a[224:227], v10 offset:26624
ds_read_b128 a[228:231], v11 offset:26624
v_mov_b32 v166, 0
v_mov_b32 v167, 0
M a[80:83], a[176:179], a[232:235], a[80:83]
M a[84:87], a[184:187], a[232:235], a[84:87]
ds_read_b64_tr_b16 a[208:209], v15 offset:28672
ds_read_b64_tr_b16 a[210:211], v15 offset:30208
M a[84:87], a[188:191], a[236:239], a[84:87]
s_sub_u32 s31, s31, 1
s_cmp_eq_u32 s31, 0
s_cselect_b32 s58, -1920, s57
s_add_u32 s23, s23, s58
s_add_u32 s24, s24, s58
v_mov_b32 v168, 0
v_mov_b32 v169, 0
M a[88:91], a[196:199], a[236:239], a[88:91]
M a[88:91], a[192:195], a[232:235], a[88:91]
s_waitcnt lgkmcnt(8)
v_mov_b32 v170, 0
v_mov_b32 v171, 0
M a[92:95], a[176:179], a[240:243], a[92:95]
ds_read_b128 a[232:235], v10 offset:28672
ds_read_b128 a[236:239], v11 offset:28672
M a[92:95], a[180:183], a[244:247], a[92:95]
s_add_u32 m0, s30, 36864
s_nop 0
buffer_load_dwordx4 v6, s[12:15], s25 offen offset:0 lds
v_mov_b32 v172, 0
v_mov_b32 v173, 0
M a[96:99], a[188:191], a[244:247], a[96:99]
ds_read_b64_tr_b16 a[216:217], v16 offset:28672
ds_read_b64_tr_b16 a[218:219], v16 offset:30208
M a[96:99], a[184:187], a[240:243], a[96:99]
v_mov_b32 v174, 0
v_mov_b32 v175, 0
M a[100:103], a[192:195], a[240:243], a[100:103]
buffer_load_dwordx4 v7, s[12:15], s25 offen offset:1024 lds
M a[100:103], a[196:199], a[244:247], a[100:103]
s_waitcnt lgkmcnt(10)
M a[104:107], a[180:183], a[252:255], a[104:107]
ds_read_b128 a[240:243], v10 offset:30720
ds_read_b128 a[244:247], v11 offset:30720
v_mov_b32 v176, 0
v_mov_b32 v177, 0
M a[104:107], a[176:179], a[248:251], a[104:107]
M a[108:111], a[184:187], a[248:251], a[108:111]
ds_read_b64_tr_b16 a[204:205], v14 offset:40960
ds_read_b64_tr_b16 a[206:207], v14 offset:42496
v_mov_b32 v178, 0
v_mov_b32 v179, 0
M a[108:111], a[188:191], a[252:255], a[108:111]
buffer_load_dwordx4 v8, s[12:15], s25 offen offset:2048 lds
M a[112:115], a[196:199], a[252:255], a[112:115]
v_mov_b32 v180, 0
v_mov_b32 v181, 0
M a[112:115], a[192:195], a[248:251], a[112:115]
s_waitcnt lgkmcnt(10)
M a[116:119], a[176:179], a[224:227], a[116:119]
ds_read_b128 a[248:251], v10 offset:32768
ds_read_b128 a[252:255], v11 offset:32768
v_mov_b32 v182, 0
v_mov_b32 v183, 0
M a[116:119], a[180:183], a[228:231], a[116:119]
buffer_load_dwordx4 v9, s[12:15], s25 offen offset:3072 lds
M a[120:123], a[188:191], a[228:231], a[120:123]
ds_read_b64_tr_b16 a[212:213], v15 offset:40960
ds_read_b64_tr_b16 a[214:215], v15 offset:42496
M a[120:123], a[184:187], a[224:227], a[120:123]
v_mov_b32 v184, 0
v_mov_b32 v185, 0
M a[124:127], a[192:195], a[224:227], a[124:127]
s_add_u32 m0, s30, 40960
s_nop 0
buffer_load_dwordx4 v21, s[12:15], s25 offen offset:0 lds
M a[124:127], a[196:199], a[228:231], a[124:127]
s_waitcnt lgkmcnt(10)
v_mov_b32 v186, 0
v_mov_b32 v187, 0
M a[128:131], a[180:183], a[236:239], a[128:131]
ds_read_b128 a[224:227], v10 offset:34816
ds_read_b128 a[228:231], v11 offset:34816
M a[128:131], a[176:179], a[232:235], a[128:131]
v_mov_b32 v188, 0
v_mov_b32 v189, 0
M a[132:135], a[184:187], a[232:235], a[132:135]
ds_read_b64_tr_b16 a[220:221], v16 offset:40960
ds_read_b64_tr_b16 a[222:223], v16 offset:42496
M a[132:135], a[188:191], a[236:239], a[132:135]
buffer_load_dwordx4 v22, s[12:15], s25 offen offset:1024 lds
v_mov_b32 v190, 0
v_mov_b32 v191, 0
M a[136:139], a[196:199], a[236:239], a[136:139]
M a[136:139], a[192:195], a[232:235], a[136:139]
s_waitcnt lgkmcnt(10)
M a[140:143], a[176:179], a[240:243], a[140:143]
s_sub_u32 s54, s54, 1
s_cmp_eq_u32 s54, 0
s_cselect_b32 s58, s55, s56
s_add_u32 s25, s25, s58
v_mov_b32 v192, 0
v_mov_b32 v193, 0
M a[140:143], a[180:183], a[244:247], a[140:143]
M a[144:147], a[188:191], a[244:247], a[144:147]
v_mov_b32 v194, 0
v_mov_b32 v195, 0
M a[144:147], a[184:187], a[240:243], a[144:147]
M a[148:151], a[192:195], a[240:243], a[148:151]
s_waitcnt vmcnt(12) lgkmcnt(0)
s_barrier
ds_read_b128 a[232:235], v12 offset:0
ds_read_b128 a[236:239], v13 offset:0
v_mov_b32 v196, 0
v_mov_b32 v197, 0
M a[148:151], a[196:199], a[244:247], a[148:151]
s_add_u32 m0, s28, 18432
s_nop 0
buffer_load_dword v20, s[8:11], s24 offen lds
M a[152:155], a[180:183], a[252:255], a[152:155]
ds_read_b128 a[240:243], v12 offset:2048
ds_read_b128 a[244:247], v13 offset:2048
v_mov_b32 v198, 0
v_mov_b32 v199, 0
M a[152:155], a[176:179], a[248:251], a[152:155]
M a[156:159], a[184:187], a[248:251], a[156:159]
buffer_load_dword v23, s[8:11], s24 offen offset:256 lds
M a[156:159], a[188:191], a[252:255], a[156:159]
v_mov_b32 v200, 0
v_mov_b32 v201, 0
M a[160:163], a[196:199], a[252:255], a[160:163]
M a[160:163], a[192:195], a[248:251], a[160:163]
s_add_u32 m0, s29, 20480
s_nop 0
buffer_load_dwordx4 v2, s[8:11], s23 offen offset:0 lds
v_mov_b32 v202, 0
v_mov_b32 v203, 0
M a[164:167], a[176:179], a[224:227], a[164:167]
ds_read_b128 a[248:251], v12 offset:4096
ds_read_b128 a[252:255], v13 offset:4096
M a[164:167], a[180:183], a[228:231], a[164:167]
v_mov_b32 v204, 0
v_mov_b32 v205, 0
M a[168:171], a[188:191], a[228:231], a[168:171]
M a[168:171], a[184:187], a[224:227], a[168:171]
buffer_load_dwordx4 v3, s[8:11], s23 offen offset:1024 lds
v_mov_b32 v206, 0
v_mov_b32 v207, 0
M a[172:175], a[192:195], a[224:227], a[172:175]
M a[172:175], a[196:199], a[228:231], a[172:175]
s_waitcnt lgkmcnt(4)
M a[68:71], a[200:203], a[232:235], a[68:71]
ds_read_b128 a[224:227], v12 offset:6144
ds_read_b128 a[228:231], v13 offset:6144
v_and_b32 v128, 15, v0
v_mul_u32_u24 v128, 400, v128
M a[68:71], a[204:207], a[236:239], a[68:71]
buffer_load_dwordx4 v4, s[8:11], s23 offen offset:2048 lds
M a[72:75], a[212:215], a[236:239], a[72:75]
ds_read_b64_tr_b16 a[176:177], v17 offset:0
ds_read_b64_tr_b16 a[178:179], v17 offset:1536
v_lshrrev_b32 v129, 4, v0
v_lshl_add_u32 v128, v129, 3, v128
M a[72:75], a[208:211], a[232:235], a[72:75]
M a[76:79], a[216:219], a[232:235], a[76:79]
buffer_load_dwordx4 v5, s[8:11], s23 offen offset:3072 lds
s_mul_i32 s3, s20, 96
s_add_u32 s3, s3, 98304
M a[76:79], a[220:223], a[236:239], a[76:79]
s_waitcnt lgkmcnt(6)
M a[80:83], a[204:207], a[244:247], a[80:83]
ds_read_b128 a[232:235], v12 offset:8192
ds_read_b128 a[236:239], v13 offset:8192
v_add_u32 v124, s3, v128
v_and_b32 v128, 15, v0
M a[80:83], a[200:203], a[240:243], a[80:83]
M a[84:87], a[208:211], a[240:243], a[84:87]
ds_read_b64_tr_b16 a[184:185], v18 offset:0
ds_read_b64_tr_b16 a[186:187], v18 offset:1536
v_lshrrev_b32 v129, 4, v0
s_add_u32 s3, s21, 16
M a[84:87], a[212:215], a[244:247], a[84:87]
s_sub_u32 s31, s31, 1
s_cmp_eq_u32 s31, 0
s_cselect_b32 s58, -1920, s57
s_add_u32 s23, s23, s58
s_add_u32 s24, s24, s58
M a[88:91], a[220:223], a[244:247], a[88:91]
v_lshl_add_u32 v130, v128, 1, s3
s_lshl_b32 s4, s22, 6
M a[88:91], a[216:219], a[240:243], a[88:91]
s_waitcnt lgkmcnt(8)
M a[92:95], a[200:203], a[248:251], a[92:95]
ds_read_b128 a[240:243], v12 offset:10240
ds_read_b128 a[244:247], v13 offset:10240
s_add_u32 s4, s4, 98304
v_mul_u32_u24 v120, 400, v130
M a[92:95], a[204:207], a[252:255], a[92:95]
s_add_u32 m0, s30, 65536
s_nop 0
buffer_load_dwordx4 v6, s[12:15], s25 offen offset:0 lds
M a[96:99], a[212:215], a[252:255], a[96:99]
ds_read_b64_tr_b16 a[192:193], v19 offset:0
ds_read_b64_tr_b16 a[194:195], v19 offset:1536
M a[96:99], a[208:211], a[248:251], a[96:99]
v_lshl_add_u32 v120, v129, 4, v120
v_add_u32 v120, s4, v120
M a[100:103], a[216:219], a[248:251], a[100:103]
buffer_load_dwordx4 v7, s[12:15], s25 offen offset:1024 lds
M a[100:103], a[220:223], a[252:255], a[100:103]
s_waitcnt lgkmcnt(10)
v_subrev_u32 v130, 32, v130
v_max_i32 v130, 0, v130
M a[104:107], a[204:207], a[228:231], a[104:107]
ds_read_b128 a[248:251], v12 offset:12288
ds_read_b128 a[252:255], v13 offset:12288
M a[104:107], a[200:203], a[224:227], a[104:107]
v_mul_u32_u24 v121, 400, v130
v_lshl_add_u32 v121, v129, 4, v121
M a[108:111], a[208:211], a[224:227], a[108:111]
ds_read_b64_tr_b16 a[180:181], v17 offset:12288
ds_read_b64_tr_b16 a[182:183], v17 offset:13824
M a[108:111], a[212:215], a[228:231], a[108:111]
buffer_load_dwordx4 v8, s[12:15], s25 offen offset:2048 lds
v_add_u32 v121, s4, v121
v_bfe_u32 v131, v0, 2, 2
M a[112:115], a[220:223], a[228:231], a[112:115]
M a[112:115], a[216:219], a[224:227], a[112:115]
s_waitcnt lgkmcnt(10)
v_lshl_add_u32 v131, v129, 2, v131
v_lshl_add_u32 v131, v131, 1, s3
M a[116:119], a[200:203], a[232:235], a[116:119]
ds_read_b128 a[224:227], v12 offset:14336
ds_read_b128 a[228:231], v13 offset:14336
M a[116:119], a[204:207], a[236:239], a[116:119]
buffer_load_dwordx4 v9, s[12:15], s25 offen offset:3072 lds
v_and_b32 v132, 3, v0
v_lshlrev_b32 v132, 3, v132
M a[120:123], a[212:215], a[236:239], a[120:123]
ds_read_b64_tr_b16 a[188:189], v18 offset:12288
ds_read_b64_tr_b16 a[190:191], v18 offset:13824
M a[120:123], a[208:211], a[232:235], a[120:123]
M a[124:127], a[216:219], a[232:235], a[124:127]
s_add_u32 m0, s30, 69632
s_nop 0
buffer_load_dwordx4 v21, s[12:15], s25 offen offset:0 lds
v_add_u32 v132, s4, v132
s_movk_i32 s5, 400
M a[124:127], a[220:223], a[236:239], a[124:127]
s_waitcnt lgkmcnt(10)
M a[128:131], a[204:207], a[244:247], a[128:131]
ds_read_b128 a[232:235], v12 offset:16384
ds_read_b128 a[236:239], v13 offset:16384
v_mad_u32_u24 v122, v131, s5, v132
v_subrev_u32 v131, 32, v131
M a[128:131], a[200:203], a[240:243], a[128:131]
M a[132:135], a[208:211], a[240:243], a[132:135]
ds_read_b64_tr_b16 a[196:197], v19 offset:12288
ds_read_b64_tr_b16 a[198:199], v19 offset:13824
v_max_i32 v131, 0, v131
v_mad_u32_u24 v123, v131, s5, v132
M a[132:135], a[212:215], a[244:247], a[132:135]
buffer_load_dwordx4 v22, s[12:15], s25 offen offset:1024 lds
M a[136:139], a[220:223], a[244:247], a[136:139]
v_lshlrev_b32 v129, 2, v129
v_sub_u32 v128, v128, v129
M a[136:139], a[216:219], a[240:243], a[136:139]
s_waitcnt lgkmcnt(10)
M a[140:143], a[200:203], a[248:251], a[140:143]
s_sub_u32 s54, s54, 1
s_cmp_eq_u32 s54, 0
s_cselect_b32 s58, s55, s56
s_add_u32 s25, s25, s58
v_mov_b32 v129, 0xf149f2ca
s_cmp_eq_u32 s26, 0
s_cselect_b32 s3, 0xf149f2ca, 0
M a[140:143], a[204:207], a[252:255], a[140:143]
M a[144:147], a[212:215], a[252:255], a[144:147]
v_cmp_lt_i32 vcc, -9, v128
s_nop 1
v_cndmask_b32 v144, 0, v129, vcc
M a[144:147], a[208:211], a[248:251], a[144:147]
M a[148:151], a[216:219], a[248:251], a[148:151]
s_waitcnt vmcnt(12) lgkmcnt(0)
s_barrier
ds_read_b128 a[240:243], v10 offset:0
ds_read_b128 a[244:247], v11 offset:0
M a[148:151], a[220:223], a[252:255], a[148:151]
s_add_u32 m0, s28, 131072
s_nop 0
buffer_load_dword v20, s[8:11], s24 offen lds
v_subrev_u32 v130, 0, v128
v_cmp_lt_u32 vcc, 7, v130
s_nop 1
v_cndmask_b32 v148, 0, v129, vcc
M a[152:155], a[204:207], a[228:231], a[152:155]
ds_read_b128 a[248:251], v10 offset:2048
ds_read_b128 a[252:255], v11 offset:2048
M a[152:155], a[200:203], a[224:227], a[152:155]
v_min_f32 v152, s3, v144
v_mov_b32 v156, 0x3f803f80
M a[156:159], a[208:211], a[224:227], a[156:159]
buffer_load_dword v23, s[8:11], s24 offen offset:256 lds
M a[156:159], a[212:215], a[228:231], a[156:159]
v_cmp_lt_i32 vcc, -8, v128
s_nop 1
v_cndmask_b32 v145, 0, v129, vcc
M a[160:163], a[220:223], a[228:231], a[160:163]
M a[160:163], a[216:219], a[224:227], a[160:163]
s_add_u32 m0, s29, 133120
s_nop 0
buffer_load_dwordx4 v2, s[8:11], s23 offen offset:0 lds
v_subrev_u32 v130, 1, v128
v_cmp_lt_u32 vcc, 7, v130
s_nop 1
v_cndmask_b32 v149, 0, v129, vcc
M a[164:167], a[200:203], a[232:235], a[164:167]
ds_read_b128 a[224:227], v10 offset:4096
ds_read_b128 a[228:231], v11 offset:4096
M a[164:167], a[204:207], a[236:239], a[164:167]
v_min_f32 v153, s3, v145
v_mov_b32 v157, 0x3f803f80
M a[168:171], a[212:215], a[236:239], a[168:171]
M a[168:171], a[208:211], a[232:235], a[168:171]
buffer_load_dwordx4 v3, s[8:11], s23 offen offset:1024 lds
v_cmp_lt_i32 vcc, -7, v128
s_nop 1
v_cndmask_b32 v146, 0, v129, vcc
M a[172:175], a[216:219], a[232:235], a[172:175]
M a[172:175], a[220:223], a[236:239], a[172:175]
s_waitcnt lgkmcnt(4)
M a[68:71], a[176:179], a[240:243], a[68:71]
ds_read_b128 a[232:235], v10 offset:6144
ds_read_b128 a[236:239], v11 offset:6144
v_subrev_u32 v130, 2, v128
v_cmp_lt_u32 vcc, 7, v130
s_nop 1
v_cndmask_b32 v150, 0, v129, vcc
M a[68:71], a[180:183], a[244:247], a[68:71]
buffer_load_dwordx4 v4, s[8:11], s23 offen offset:2048 lds
v_min_f32 v154, s3, v146
v_mov_b32 v158, 0x3f803f80
M a[72:75], a[188:191], a[244:247], a[72:75]
ds_read_b64_tr_b16 a[200:201], v14 offset:0
ds_read_b64_tr_b16 a[202:203], v14 offset:1536
M a[72:75], a[184:187], a[240:243], a[72:75]
v_cmp_lt_i32 vcc, -6, v128
s_nop 1
v_cndmask_b32 v147, 0, v129, vcc
M a[76:79], a[192:195], a[240:243], a[76:79]
buffer_load_dwordx4 v5, s[8:11], s23 offen offset:3072 lds
v_subrev_u32 v130, 3, v128
v_cmp_lt_u32 vcc, 7, v130
s_nop 1
v_cndmask_b32 v151, 0, v129, vcc
M a[76:79], a[196:199], a[244:247], a[76:79]
s_waitcnt lgkmcnt(6)
M a[80:83], a[180:183], a[252:255], a[80:83]
ds_read_b128 a[240:243], v10 offset:8192
ds_read_b128 a[244:247], v11 offset:8192
v_min_f32 v155, s3, v147
v_mov_b32 v159, 0x3f803f80
M a[80:83], a[176:179], a[248:251], a[80:83]
s_add_u32 s16, s50, 83886080
s_addc_u32 s17, s51, 0
M a[84:87], a[184:187], a[248:251], a[84:87]
ds_read_b64_tr_b16 a[208:209], v15 offset:0
ds_read_b64_tr_b16 a[210:211], v15 offset:1536
M a[84:87], a[188:191], a[252:255], a[84:87]
s_sub_u32 s31, s31, 1
s_cmp_eq_u32 s31, 0
s_cselect_b32 s58, -1920, s57
s_add_u32 s23, s23, s58
s_add_u32 s24, s24, s58
s_mov_b32 s18, 4194304
s_mov_b32 s19, 0x00020000
M a[88:91], a[196:199], a[252:255], a[88:91]
s_lshl_b32 s3, s26, 18
s_lshl_b32 s4, s27, 14
M a[88:91], a[192:195], a[248:251], a[88:91]
s_waitcnt lgkmcnt(8)
M a[92:95], a[176:179], a[224:227], a[92:95]
ds_read_b128 a[248:251], v10 offset:10240
ds_read_b128 a[252:255], v11 offset:10240
s_add_u32 s3, s3, s4
s_lshl_b32 s4, s21, 13
M a[92:95], a[180:183], a[228:231], a[92:95]
s_add_u32 m0, s30, 98304
s_nop 0
buffer_load_dwordx4 v6, s[12:15], s25 offen offset:0 lds
s_add_u32 s3, s3, s4
s_lshl_b32 s4, s22, 10
M a[96:99], a[188:191], a[228:231], a[96:99]
ds_read_b64_tr_b16 a[216:217], v16 offset:0
ds_read_b64_tr_b16 a[218:219], v16 offset:1536
M a[96:99], a[184:187], a[224:227], a[96:99]
s_add_u32 s6, s3, s4
s_mov_b32 s7, 0x3e8293ee
M a[100:103], a[192:195], a[224:227], a[100:103]
buffer_load_dwordx4 v7, s[12:15], s25 offen offset:1024 lds
s_lshl_b32 s65, s26, 8
s_lshl_b32 s3, s27, 4
M a[100:103], a[196:199], a[228:231], a[100:103]
s_waitcnt lgkmcnt(10)
M a[104:107], a[180:183], a[236:239], a[104:107]
ds_read_b128 a[224:227], v10 offset:12288
ds_read_b128 a[228:231], v11 offset:12288
s_add_u32 s65, s65, s3
s_lshl_b32 s3, s101, 2
M a[104:107], a[176:179], a[232:235], a[104:107]
s_add_u32 s65, s65, s3
s_add_u32 s65, s65, 8400896
M a[108:111], a[184:187], a[232:235], a[108:111]
ds_read_b64_tr_b16 a[204:205], v14 offset:12288
ds_read_b64_tr_b16 a[206:207], v14 offset:13824
M a[108:111], a[188:191], a[236:239], a[108:111]
buffer_load_dwordx4 v8, s[12:15], s25 offen offset:2048 lds
s_mov_b32 s40, 0
v_mov_b32 v119, 0
M a[112:115], a[196:199], a[236:239], a[112:115]
s_mov_b64 s[4:5], s[50:51]
s_and_b32 s20, s2, 7
M a[112:115], a[192:195], a[232:235], a[112:115]
s_waitcnt lgkmcnt(10)
M a[116:119], a[176:179], a[240:243], a[116:119]
ds_read_b128 a[232:235], v10 offset:14336
ds_read_b128 a[236:239], v11 offset:14336
s_lshr_b32 s33, s2, 6
s_lshl_b32 s33, s33, 3
M a[116:119], a[180:183], a[244:247], a[116:119]
buffer_load_dwordx4 v9, s[12:15], s25 offen offset:3072 lds
s_add_u32 s20, s20, s33
s_bfe_u32 s21, s2, 0x30003
M a[120:123], a[188:191], a[244:247], a[120:123]
ds_read_b64_tr_b16 a[212:213], v15 offset:12288
ds_read_b64_tr_b16 a[214:215], v15 offset:13824
M a[120:123], a[184:187], a[240:243], a[120:123]
s_sub_u32 s35, 15, s21
s_cmp_lt_u32 s101, 2
s_cselect_b32 s35, s21, s35
M a[124:127], a[192:195], a[240:243], a[124:127]
s_add_u32 m0, s30, 102400
s_nop 0
buffer_load_dwordx4 v21, s[12:15], s25 offen offset:0 lds
s_lshl_b32 s33, s20, 7
s_lshl_b32 s34, s35, 3
M a[124:127], a[196:199], a[244:247], a[124:127]
s_waitcnt lgkmcnt(10)
M a[128:131], a[180:183], a[252:255], a[128:131]
ds_read_b128 a[240:243], v10 offset:16384
ds_read_b128 a[244:247], v11 offset:16384
s_add_u32 s33, s33, s34
s_and_b32 s34, s101, 1
M a[128:131], a[176:179], a[248:251], a[128:131]
s_lshl_b32 s34, s34, 2
s_add_u32 s33, s33, s34
M a[132:135], a[184:187], a[248:251], a[132:135]
ds_read_b64_tr_b16 a[220:221], v16 offset:12288
ds_read_b64_tr_b16 a[222:223], v16 offset:13824
M a[132:135], a[188:191], a[252:255], a[132:135]
buffer_load_dwordx4 v22, s[12:15], s25 offen offset:1024 lds
s_lshl_b32 s64, s33, 12
s_mov_b32 s44, s4
M a[136:139], a[196:199], a[252:255], a[136:139]
s_mov_b32 s45, s5
s_mov_b32 s46, 16777216
M a[136:139], a[192:195], a[248:251], a[136:139]
s_waitcnt lgkmcnt(10)
M a[140:143], a[176:179], a[224:227], a[140:143]
s_sub_u32 s54, s54, 1
s_cmp_eq_u32 s54, 0
s_cselect_b32 s58, s55, s56
s_add_u32 s25, s25, s58
s_mov_b32 s47, 0x00020000
M a[140:143], a[180:183], a[228:231], a[140:143]
M a[144:147], a[188:191], a[228:231], a[144:147]
M a[144:147], a[184:187], a[224:227], a[144:147]
M a[148:151], a[192:195], a[224:227], a[148:151]
s_waitcnt vmcnt(12) lgkmcnt(0)
s_barrier
ds_read_b128 a[248:251], v10 offset:18432
ds_read_b128 a[252:255], v11 offset:18432
M a[148:151], a[196:199], a[228:231], a[148:151]
s_add_u32 m0, s28, 0
s_nop 0
buffer_load_dword v20, s[8:11], s24 offen lds
M a[152:155], a[180:183], a[236:239], a[152:155]
ds_read_b128 a[224:227], v10 offset:20480
ds_read_b128 a[228:231], v11 offset:20480
M a[152:155], a[176:179], a[232:235], a[152:155]
M a[156:159], a[184:187], a[232:235], a[156:159]
buffer_load_dword v23, s[8:11], s24 offen offset:256 lds
M a[156:159], a[188:191], a[236:239], a[156:159]
M a[160:163], a[196:199], a[236:239], a[160:163]
M a[160:163], a[192:195], a[232:235], a[160:163]
s_add_u32 m0, s29, 2048
s_nop 0
buffer_load_dwordx4 v2, s[8:11], s23 offen offset:0 lds
M a[164:167], a[176:179], a[240:243], a[164:167]
ds_read_b128 a[232:235], v10 offset:22528
ds_read_b128 a[236:239], v11 offset:22528
M a[164:167], a[180:183], a[244:247], a[164:167]
M a[168:171], a[188:191], a[244:247], a[168:171]
M a[168:171], a[184:187], a[240:243], a[168:171]
buffer_load_dwordx4 v3, s[8:11], s23 offen offset:1024 lds
M a[172:175], a[192:195], a[240:243], a[172:175]
M a[172:175], a[196:199], a[244:247], a[172:175]
s_waitcnt lgkmcnt(4)
M a[68:71], a[200:203], a[248:251], a[68:71]
ds_read_b128 a[240:243], v10 offset:24576
ds_read_b128 a[244:247], v11 offset:24576
M a[68:71], a[204:207], a[252:255], a[68:71]
buffer_load_dwordx4 v4, s[8:11], s23 offen offset:2048 lds
M a[72:75], a[212:215], a[252:255], a[72:75]
ds_read_b64_tr_b16 a[176:177], v14 offset:28672
ds_read_b64_tr_b16 a[178:179], v14 offset:30208
M a[72:75], a[208:211], a[248:251], a[72:75]
M a[76:79], a[216:219], a[248:251], a[76:79]
buffer_load_dwordx4 v5, s[8:11], s23 offen offset:3072 lds
M a[76:79], a[220:223], a[252:255], a[76:79]
s_waitcnt lgkmcnt(6)
M a[80:83], a[204:207], a[228:231], a[80:83]
ds_read_b128 a[248:251], v10 offset:26624
ds_read_b128 a[252:255], v11 offset:26624
M a[80:83], a[200:203], a[224:227], a[80:83]
M a[84:87], a[208:211], a[224:227], a[84:87]
ds_read_b64_tr_b16 a[184:185], v15 offset:28672
ds_read_b64_tr_b16 a[186:187], v15 offset:30208
M a[84:87], a[212:215], a[228:231], a[84:87]
s_sub_u32 s31, s31, 1
s_cmp_eq_u32 s31, 0
s_cselect_b32 s58, -1920, s57
s_add_u32 s23, s23, s58
s_add_u32 s24, s24, s58
M a[88:91], a[220:223], a[228:231], a[88:91]
M a[88:91], a[216:219], a[224:227], a[88:91]
s_waitcnt lgkmcnt(8)
M a[92:95], a[200:203], a[232:235], a[92:95]
ds_read_b128 a[224:227], v10 offset:28672
ds_read_b128 a[228:231], v11 offset:28672
M a[92:95], a[204:207], a[236:239], a[92:95]
s_add_u32 m0, s30, 36864
s_nop 0
buffer_load_dwordx4 v6, s[12:15], s25 offen offset:0 lds
M a[96:99], a[212:215], a[236:239], a[96:99]
ds_read_b64_tr_b16 a[192:193], v16 offset:28672
ds_read_b64_tr_b16 a[194:195], v16 offset:30208
M a[96:99], a[208:211], a[232:235], a[96:99]
M a[100:103], a[216:219], a[232:235], a[100:103]
buffer_load_dwordx4 v7, s[12:15], s25 offen offset:1024 lds
M a[100:103], a[220:223], a[236:239], a[100:103]
s_waitcnt lgkmcnt(10)
M a[104:107], a[204:207], a[244:247], a[104:107]
ds_read_b128 a[232:235], v10 offset:30720
ds_read_b128 a[236:239], v11 offset:30720
M a[104:107], a[200:203], a[240:243], a[104:107]
M a[108:111], a[208:211], a[240:243], a[108:111]
ds_read_b64_tr_b16 a[180:181], v14 offset:40960
ds_read_b64_tr_b16 a[182:183], v14 offset:42496
M a[108:111], a[212:215], a[244:247], a[108:111]
buffer_load_dwordx4 v8, s[12:15], s25 offen offset:2048 lds
M a[112:115], a[220:223], a[244:247], a[112:115]
M a[112:115], a[216:219], a[240:243], a[112:115]
s_waitcnt lgkmcnt(10)
M a[116:119], a[200:203], a[248:251], a[116:119]
ds_read_b128 a[240:243], v10 offset:32768
ds_read_b128 a[244:247], v11 offset:32768
M a[116:119], a[204:207], a[252:255], a[116:119]
buffer_load_dwordx4 v9, s[12:15], s25 offen offset:3072 lds
M a[120:123], a[212:215], a[252:255], a[120:123]
ds_read_b64_tr_b16 a[188:189], v15 offset:40960
ds_read_b64_tr_b16 a[190:191], v15 offset:42496
M a[120:123], a[208:211], a[248:251], a[120:123]
M a[124:127], a[216:219], a[248:251], a[124:127]
s_add_u32 m0, s30, 40960
s_nop 0
buffer_load_dwordx4 v21, s[12:15], s25 offen offset:0 lds
M a[124:127], a[220:223], a[252:255], a[124:127]
s_waitcnt lgkmcnt(10)
M a[128:131], a[204:207], a[228:231], a[128:131]
ds_read_b128 a[248:251], v10 offset:34816
ds_read_b128 a[252:255], v11 offset:34816
M a[128:131], a[200:203], a[224:227], a[128:131]
M a[132:135], a[208:211], a[224:227], a[132:135]
ds_read_b64_tr_b16 a[196:197], v16 offset:40960
ds_read_b64_tr_b16 a[198:199], v16 offset:42496
M a[132:135], a[212:215], a[228:231], a[132:135]
buffer_load_dwordx4 v22, s[12:15], s25 offen offset:1024 lds
M a[136:139], a[220:223], a[228:231], a[136:139]
M a[136:139], a[216:219], a[224:227], a[136:139]
s_waitcnt lgkmcnt(10)
M a[140:143], a[200:203], a[232:235], a[140:143]
s_sub_u32 s54, s54, 1
s_cmp_eq_u32 s54, 0
s_cselect_b32 s58, s55, s56
s_add_u32 s25, s25, s58
M a[140:143], a[204:207], a[236:239], a[140:143]
M a[144:147], a[212:215], a[236:239], a[144:147]
M a[144:147], a[208:211], a[232:235], a[144:147]
M a[148:151], a[216:219], a[232:235], a[148:151]
s_waitcnt vmcnt(12) lgkmcnt(0)
s_barrier
ds_read_b128 a[224:227], v12 offset:0
ds_read_b128 a[228:231], v13 offset:0
M a[148:151], a[220:223], a[236:239], a[148:151]
s_add_u32 m0, s28, 18432
s_nop 0
buffer_load_dword v20, s[8:11], s24 offen lds
M a[152:155], a[204:207], a[244:247], a[152:155]
ds_read_b128 a[232:235], v12 offset:2048
ds_read_b128 a[236:239], v13 offset:2048
M a[152:155], a[200:203], a[240:243], a[152:155]
M a[156:159], a[208:211], a[240:243], a[156:159]
buffer_load_dword v23, s[8:11], s24 offen offset:256 lds
M a[156:159], a[212:215], a[244:247], a[156:159]
M a[160:163], a[220:223], a[244:247], a[160:163]
M a[160:163], a[216:219], a[240:243], a[160:163]
s_add_u32 m0, s29, 20480
s_nop 0
buffer_load_dwordx4 v2, s[8:11], s23 offen offset:0 lds
M a[164:167], a[200:203], a[248:251], a[164:167]
ds_read_b128 a[240:243], v12 offset:4096
ds_read_b128 a[244:247], v13 offset:4096
M a[164:167], a[204:207], a[252:255], a[164:167]
M a[168:171], a[212:215], a[252:255], a[168:171]
M a[168:171], a[208:211], a[248:251], a[168:171]
buffer_load_dwordx4 v3, s[8:11], s23 offen offset:1024 lds
M a[172:175], a[216:219], a[248:251], a[172:175]
M a[172:175], a[220:223], a[252:255], a[172:175]
s_waitcnt lgkmcnt(4)
M a[68:71], a[176:179], a[224:227], a[68:71]
ds_read_b128 a[248:251], v12 offset:6144
ds_read_b128 a[252:255], v13 offset:6144
M a[68:71], a[180:183], a[228:231], a[68:71]
buffer_load_dwordx4 v4, s[8:11], s23 offen offset:2048 lds
M a[72:75], a[188:191], a[228:231], a[72:75]
ds_read_b64_tr_b16 a[200:201], v17 offset:0
ds_read_b64_tr_b16 a[202:203], v17 offset:1536
M a[72:75], a[184:187], a[224:227], a[72:75]
M a[76:79], a[192:195], a[224:227], a[76:79]
buffer_load_dwordx4 v5, s[8:11], s23 offen offset:3072 lds
M a[76:79], a[196:199], a[228:231], a[76:79]
s_waitcnt lgkmcnt(6)
M a[80:83], a[180:183], a[236:239], a[80:83]
ds_read_b128 a[224:227], v12 offset:8192
ds_read_b128 a[228:231], v13 offset:8192
M a[80:83], a[176:179], a[232:235], a[80:83]
s_sub_u32 s31, s31, 1
s_cmp_eq_u32 s31, 0
s_cselect_b32 s58, -1920, s57
s_add_u32 s23, s23, s58
s_add_u32 s24, s24, s58
M a[84:87], a[184:187], a[232:235], a[84:87]
ds_read_b64_tr_b16 a[208:209], v18 offset:0
ds_read_b64_tr_b16 a[210:211], v18 offset:1536
M a[84:87], a[188:191], a[236:239], a[84:87]
M a[88:91], a[196:199], a[236:239], a[88:91]
M a[88:91], a[192:195], a[232:235], a[88:91]
s_add_u32 m0, s30, 65536
s_nop 0
buffer_load_dwordx4 v6, s[12:15], s25 offen offset:0 lds
s_waitcnt lgkmcnt(8)
M a[92:95], a[176:179], a[240:243], a[92:95]
ds_read_b128 a[232:235], v12 offset:10240
ds_read_b128 a[236:239], v13 offset:10240
M a[92:95], a[180:183], a[244:247], a[92:95]
M a[96:99], a[188:191], a[244:247], a[96:99]
ds_read_b64_tr_b16 a[216:217], v19 offset:0
ds_read_b64_tr_b16 a[218:219], v19 offset:1536
M a[96:99], a[184:187], a[240:243], a[96:99]
buffer_load_dwordx4 v7, s[12:15], s25 offen offset:1024 lds
M a[100:103], a[192:195], a[240:243], a[100:103]
M a[100:103], a[196:199], a[244:247], a[100:103]
s_waitcnt lgkmcnt(10)
M a[104:107], a[180:183], a[252:255], a[104:107]
ds_read_b128 a[240:243], v12 offset:12288
ds_read_b128 a[244:247], v13 offset:12288
M a[104:107], a[176:179], a[248:251], a[104:107]
buffer_load_dwordx4 v8, s[12:15], s25 offen offset:2048 lds
M a[108:111], a[184:187], a[248:251], a[108:111]
ds_read_b64_tr_b16 a[204:205], v17 offset:12288
ds_read_b64_tr_b16 a[206:207], v17 offset:13824
M a[108:111], a[188:191], a[252:255], a[108:111]
M a[112:115], a[196:199], a[252:255], a[112:115]
buffer_load_dwordx4 v9, s[12:15], s25 offen offset:3072 lds
M a[112:115], a[192:195], a[248:251], a[112:115]
s_waitcnt lgkmcnt(10)
M a[116:119], a[176:179], a[224:227], a[116:119]
ds_read_b128 a[248:251], v12 offset:14336
ds_read_b128 a[252:255], v13 offset:14336
M a[116:119], a[180:183], a[228:231], a[116:119]
M a[120:123], a[188:191], a[228:231], a[120:123]
ds_read_b64_tr_b16 a[212:213], v18 offset:12288
ds_read_b64_tr_b16 a[214:215], v18 offset:13824
M a[120:123], a[184:187], a[224:227], a[120:123]
s_add_u32 m0, s30, 69632
s_nop 0
buffer_load_dwordx4 v21, s[12:15], s25 offen offset:0 lds
M a[124:127], a[192:195], a[224:227], a[124:127]
M a[124:127], a[196:199], a[228:231], a[124:127]
buffer_load_dwordx4 v22, s[12:15], s25 offen offset:1024 lds
s_waitcnt lgkmcnt(10)
M a[128:131], a[180:183], a[236:239], a[128:131]
ds_read_b128 a[224:227], v12 offset:16384
ds_read_b128 a[228:231], v13 offset:16384
M a[128:131], a[176:179], a[232:235], a[128:131]
M a[132:135], a[184:187], a[232:235], a[132:135]
ds_read_b64_tr_b16 a[220:221], v19 offset:12288
ds_read_b64_tr_b16 a[222:223], v19 offset:13824
M a[132:135], a[188:191], a[236:239], a[132:135]
M a[136:139], a[196:199], a[236:239], a[136:139]
s_sub_u32 s54, s54, 1
s_cmp_eq_u32 s54, 0
s_cselect_b32 s58, s55, s56
s_add_u32 s25, s25, s58
M a[136:139], a[192:195], a[232:235], a[136:139]
s_waitcnt lgkmcnt(10)
M a[140:143], a[176:179], a[240:243], a[140:143]
buffer_load_dword v125, v119, s[36:39], 0 offen sc1
M a[140:143], a[180:183], a[244:247], a[140:143]
M a[144:147], a[188:191], a[244:247], a[144:147]
M a[144:147], a[184:187], a[240:243], a[144:147]
M a[148:151], a[192:195], a[240:243], a[148:151]
s_waitcnt vmcnt(13) lgkmcnt(0)
s_barrier
ds_read_b128 a[232:235], v10 offset:0
ds_read_b128 a[236:239], v11 offset:0
s_waitcnt vmcnt(0)
v_cmp_gt_u32 vcc, 0x80, v125
s_nop 0
s_cbranch_vccnz Lk1_spinq
Lk1_gotq:
M a[148:151], a[196:199], a[244:247], a[148:151]
s_add_u32 m0, s28, 131072
s_nop 0
buffer_load_dword v20, s[8:11], s24 offen lds
M a[152:155], a[180:183], a[252:255], a[152:155]
ds_read_b128 a[240:243], v10 offset:2048
ds_read_b128 a[244:247], v11 offset:2048
M a[152:155], a[176:179], a[248:251], a[152:155]
M a[156:159], a[184:187], a[248:251], a[156:159]
buffer_load_dword v23, s[8:11], s24 offen offset:256 lds
M a[156:159], a[188:191], a[252:255], a[156:159]
M a[160:163], a[196:199], a[252:255], a[160:163]
M a[160:163], a[192:195], a[248:251], a[160:163]
s_add_u32 m0, s29, 133120
s_nop 0
buffer_load_dwordx4 v2, s[8:11], s23 offen offset:0 lds
M a[164:167], a[176:179], a[224:227], a[164:167]
ds_read_b128 a[248:251], v10 offset:4096
ds_read_b128 a[252:255], v11 offset:4096
M a[164:167], a[180:183], a[228:231], a[164:167]
M a[168:171], a[188:191], a[228:231], a[168:171]
M a[168:171], a[184:187], a[224:227], a[168:171]
buffer_load_dwordx4 v3, s[8:11], s23 offen offset:1024 lds
M a[172:175], a[192:195], a[224:227], a[172:175]
M a[172:175], a[196:199], a[228:231], a[172:175]
s_waitcnt lgkmcnt(4)
M a[68:71], a[200:203], a[232:235], a[68:71]
ds_read_b128 a[224:227], v10 offset:6144
ds_read_b128 a[228:231], v11 offset:6144
v_mov_b32 v208, 0
v_mov_b32 v209, 0
M a[68:71], a[204:207], a[236:239], a[68:71]
buffer_load_dwordx4 v4, s[8:11], s23 offen offset:2048 lds
M a[72:75], a[212:215], a[236:239], a[72:75]
ds_read_b64_tr_b16 a[176:177], v14 offset:0
ds_read_b64_tr_b16 a[178:179], v14 offset:1536
v_mov_b32 v210, 0
v_mov_b32 v211, 0
M a[72:75], a[208:211], a[232:235], a[72:75]
M a[76:79], a[216:219], a[232:235], a[76:79]
buffer_load_dwordx4 v5, s[8:11], s23 offen offset:3072 lds
v_mov_b32 v212, 0
v_mov_b32 v213, 0
M a[76:79], a[220:223], a[236:239], a[76:79]
s_waitcnt lgkmcnt(6)
M a[80:83], a[204:207], a[244:247], a[80:83]
ds_read_b128 a[232:235], v10 offset:8192
ds_read_b128 a[236:239], v11 offset:8192
v_mov_b32 v214, 0
v_mov_b32 v215, 0
M a[80:83], a[200:203], a[240:243], a[80:83]
s_sub_u32 s31, s31, 1
s_cmp_eq_u32 s31, 0
s_cselect_b32 s58, -1920, s57
s_add_u32 s23, s23, s58
s_add_u32 s24, s24, s58
M a[84:87], a[208:211], a[240:243], a[84:87]
ds_read_b64_tr_b16 a[184:185], v15 offset:0
ds_read_b64_tr_b16 a[186:187], v15 offset:1536
M a[84:87], a[212:215], a[244:247], a[84:87]
v_mov_b32 v216, 0
v_mov_b32 v217, 0
M a[88:91], a[220:223], a[244:247], a[88:91]
M a[88:91], a[216:219], a[240:243], a[88:91]
buffer_load_dwordx4 a[0:3], v1, s[44:47], s64 offen offset:0 sc1
s_waitcnt lgkmcnt(8)
v_mov_b32 v218, 0
v_mov_b32 v219, 0
M a[92:95], a[200:203], a[248:251], a[92:95]
ds_read_b128 a[240:243], v10 offset:10240
ds_read_b128 a[244:247], v11 offset:10240
M a[92:95], a[204:207], a[252:255], a[92:95]
v_mov_b32 v220, 0
v_mov_b32 v221, 0
M a[96:99], a[212:215], a[252:255], a[96:99]
ds_read_b64_tr_b16 a[192:193], v16 offset:0
ds_read_b64_tr_b16 a[194:195], v16 offset:1536
M a[96:99], a[208:211], a[248:251], a[96:99]
buffer_load_dwordx4 a[4:7], v1, s[44:47], s64 offen offset:1024 sc1
v_mov_b32 v222, 0
v_mov_b32 v223, 0
M a[100:103], a[216:219], a[248:251], a[100:103]
M a[100:103], a[220:223], a[252:255], a[100:103]
s_waitcnt lgkmcnt(10)
M a[104:107], a[204:207], a[228:231], a[104:107]
ds_read_b128 a[248:251], v10 offset:12288
ds_read_b128 a[252:255], v11 offset:12288
v_mov_b32 v224, 0
v_mov_b32 v225, 0
M a[104:107], a[200:203], a[224:227], a[104:107]
buffer_load_dwordx4 a[8:11], v1, s[44:47], s64 offen offset:2048 sc1
M a[108:111], a[208:211], a[224:227], a[108:111]
ds_read_b64_tr_b16 a[180:181], v14 offset:12288
ds_read_b64_tr_b16 a[182:183], v14 offset:13824
v_mov_b32 v226, 0
v_mov_b32 v227, 0
M a[108:111], a[212:215], a[228:231], a[108:111]
M a[112:115], a[220:223], a[228:231], a[112:115]
buffer_load_dwordx4 a[12:15], v1, s[44:47], s64 offen offset:3072 sc1
s_add_u32 s64, s64, 4096
v_mov_b32 v228, 0
v_mov_b32 v229, 0
M a[112:115], a[216:219], a[224:227], a[112:115]
s_waitcnt lgkmcnt(10)
M a[116:119], a[200:203], a[232:235], a[116:119]
ds_read_b128 a[224:227], v10 offset:14336
ds_read_b128 a[228:231], v11 offset:14336
v_mov_b32 v230, 0
v_mov_b32 v231, 0
M a[116:119], a[204:207], a[236:239], a[116:119]
M a[120:123], a[212:215], a[236:239], a[120:123]
ds_read_b64_tr_b16 a[188:189], v15 offset:12288
ds_read_b64_tr_b16 a[190:191], v15 offset:13824
M a[120:123], a[208:211], a[232:235], a[120:123]
buffer_load_dwordx4 a[16:19], v1, s[44:47], s64 offen offset:0 sc1
v_mov_b32 v232, 0
v_mov_b32 v233, 0
M a[124:127], a[216:219], a[232:235], a[124:127]
M a[124:127], a[220:223], a[236:239], a[124:127]
buffer_load_dwordx4 a[20:23], v1, s[44:47], s64 offen offset:1024 sc1
s_waitcnt lgkmcnt(10)
v_mov_b32 v234, 0
v_mov_b32 v235, 0
M a[128:131], a[204:207], a[244:247], a[128:131]
ds_read_b128 a[232:235], v10 offset:16384
ds_read_b128 a[236:239], v11 offset:16384
M a[128:131], a[200:203], a[240:243], a[128:131]
v_mov_b32 v236, 0
v_mov_b32 v237, 0
M a[132:135], a[208:211], a[240:243], a[132:135]
ds_read_b64_tr_b16 a[196:197], v16 offset:12288
ds_read_b64_tr_b16 a[198:199], v16 offset:13824
M a[132:135], a[212:215], a[244:247], a[132:135]
v_mov_b32 v238, 0
v_mov_b32 v239, 0
M a[136:139], a[220:223], a[244:247], a[136:139]
buffer_load_dwordx4 a[24:27], v1, s[44:47], s64 offen offset:2048 sc1
M a[136:139], a[216:219], a[240:243], a[136:139]
s_waitcnt lgkmcnt(10)
M a[140:143], a[200:203], a[248:251], a[140:143]
buffer_load_dwordx4 a[28:31], v1, s[44:47], s64 offen offset:3072 sc1
s_add_u32 s64, s64, 4096
v_mov_b32 v240, 0
v_mov_b32 v241, 0
M a[140:143], a[204:207], a[252:255], a[140:143]
M a[144:147], a[212:215], a[252:255], a[144:147]
v_mov_b32 v242, 0
v_mov_b32 v243, 0
M a[144:147], a[208:211], a[248:251], a[144:147]
M a[148:151], a[216:219], a[248:251], a[148:151]
s_waitcnt vmcnt(15) lgkmcnt(0)
s_barrier
ds_read_b128 a[240:243], v10 offset:18432
ds_read_b128 a[244:247], v11 offset:18432
v_mov_b32 v244, 0
v_mov_b32 v245, 0
M a[148:151], a[220:223], a[252:255], a[148:151]
buffer_load_dwordx4 a[32:35], v1, s[44:47], s64 offen offset:0 sc1
M a[152:155], a[204:207], a[228:231], a[152:155]
ds_read_b128 a[248:251], v10 offset:20480
ds_read_b128 a[252:255], v11 offset:20480
v_mov_b32 v246, 0
v_mov_b32 v247, 0
M a[152:155], a[200:203], a[224:227], a[152:155]
M a[156:159], a[208:211], a[224:227], a[156:159]
buffer_load_dwordx4 a[36:39], v1, s[44:47], s64 offen offset:1024 sc1
M a[156:159], a[212:215], a[228:231], a[156:159]
v_mov_b32 v248, 0
v_mov_b32 v249, 0
M a[160:163], a[220:223], a[228:231], a[160:163]
M a[160:163], a[216:219], a[224:227], a[160:163]
buffer_load_dwordx4 a[40:43], v1, s[44:47], s64 offen offset:2048 sc1
v_mov_b32 v250, 0
v_mov_b32 v251, 0
M a[164:167], a[200:203], a[232:235], a[164:167]
ds_read_b128 a[224:227], v10 offset:22528
ds_read_b128 a[228:231], v11 offset:22528
M a[164:167], a[204:207], a[236:239], a[164:167]
v_mov_b32 v252, 0
v_mov_b32 v253, 0
M a[168:171], a[212:215], a[236:239], a[168:171]
M a[168:171], a[208:211], a[232:235], a[168:171]
buffer_load_dwordx4 a[44:47], v1, s[44:47], s64 offen offset:3072 sc1
s_add_u32 s64, s64, 4096
v_mov_b32 v254, 0
v_mov_b32 v255, 0
M a[172:175], a[216:219], a[232:235], a[172:175]
M a[172:175], a[220:223], a[236:239], a[172:175]
s_waitcnt lgkmcnt(4)
M a[68:71], a[176:179], a[240:243], a[68:71]
ds_read_b128 a[232:235], v10 offset:24576
ds_read_b128 a[236:239], v11 offset:24576
s_mov_b32 s22, s101
s_and_b32 s23, s22, 1
M a[68:71], a[180:183], a[244:247], a[68:71]
buffer_load_dwordx4 a[48:51], v1, s[44:47], s64 offen offset:0 sc1
M a[72:75], a[188:191], a[244:247], a[72:75]
ds_read_b64_tr_b16 a[200:201], v14 offset:28672
ds_read_b64_tr_b16 a[202:203], v14 offset:30208
s_lshr_b32 s24, s22, 1
s_lshl_b32 s33, s24, 14
M a[72:75], a[184:187], a[240:243], a[72:75]
M a[76:79], a[192:195], a[240:243], a[76:79]
M a[76:79], a[196:199], a[244:247], a[76:79]
s_waitcnt lgkmcnt(6)
s_lshl_b32 s34, s23, 13
s_add_u32 s29, s33, s34
M a[80:83], a[180:183], a[252:255], a[80:83]
ds_read_b128 a[240:243], v10 offset:26624
ds_read_b128 a[244:247], v11 offset:26624
M a[80:83], a[176:179], a[248:251], a[80:83]
s_lshl_b32 s28, s20, 20
s_add_u32 s28, s28, s34
M a[84:87], a[184:187], a[248:251], a[84:87]
ds_read_b64_tr_b16 a[208:209], v15 offset:28672
ds_read_b64_tr_b16 a[210:211], v15 offset:30208
M a[84:87], a[188:191], a[252:255], a[84:87]
buffer_load_dwordx4 a[52:55], v1, s[44:47], s64 offen offset:1024 sc1
M a[88:91], a[196:199], a[252:255], a[88:91]
s_mov_b32 s25, s28
s_lshl_b32 s33, s21, 16
M a[88:91], a[192:195], a[248:251], a[88:91]
s_waitcnt lgkmcnt(8)
M a[92:95], a[176:179], a[224:227], a[92:95]
ds_read_b128 a[248:251], v10 offset:28672
ds_read_b128 a[252:255], v11 offset:28672
s_add_u32 s34, s28, s33
s_add_u32 s34, s34, 65536
M a[92:95], a[180:183], a[228:231], a[92:95]
M a[96:99], a[188:191], a[228:231], a[96:99]
ds_read_b64_tr_b16 a[216:217], v16 offset:28672
ds_read_b64_tr_b16 a[218:219], v16 offset:30208
M a[96:99], a[184:187], a[224:227], a[96:99]
s_add_u32 s32, s28, 491520
s_sub_u32 s33, s32, s33
M a[100:103], a[192:195], a[224:227], a[100:103]
buffer_load_dwordx4 a[56:59], v1, s[44:47], s64 offen offset:2048 sc1
M a[100:103], a[196:199], a[228:231], a[100:103]
s_waitcnt lgkmcnt(10)
s_add_u32 s33, s33, 491520
s_cmp_eq_u32 s24, 0
s_cselect_b32 s27, s34, s32
s_cselect_b32 s28, s32, s33
M a[104:107], a[180:183], a[236:239], a[104:107]
ds_read_b128 a[224:227], v10 offset:30720
ds_read_b128 a[228:231], v11 offset:30720
M a[104:107], a[176:179], a[232:235], a[104:107]
M a[108:111], a[184:187], a[232:235], a[108:111]
ds_read_b64_tr_b16 a[204:205], v14 offset:40960
ds_read_b64_tr_b16 a[206:207], v14 offset:42496
s_add_u32 s26, s25, 16384
s_add_u32 s62, s27, 16384
M a[108:111], a[188:191], a[236:239], a[108:111]
M a[112:115], a[196:199], a[236:239], a[112:115]
s_add_u32 s63, s28, 16384
s_lshl_b32 s31, s21, 7
M a[112:115], a[192:195], a[232:235], a[112:115]
s_waitcnt lgkmcnt(10)
M a[116:119], a[176:179], a[240:243], a[116:119]
ds_read_b128 a[232:235], v10 offset:32768
ds_read_b128 a[236:239], v11 offset:32768
M a[116:119], a[180:183], a[244:247], a[116:119]
buffer_load_dwordx4 a[60:63], v1, s[44:47], s64 offen offset:3072 sc1
s_cmp_eq_u32 s24, 0
s_cselect_b32 s31, s31, 960
M a[120:123], a[188:191], a[244:247], a[120:123]
ds_read_b64_tr_b16 a[212:213], v15 offset:40960
ds_read_b64_tr_b16 a[214:215], v15 offset:42496
M a[120:123], a[184:187], a[240:243], a[120:123]
s_mov_b32 s60, 0
s_add_u32 s12, s4, 16777216
s_addc_u32 s13, s5, 0
M a[124:127], a[192:195], a[240:243], a[124:127]
M a[124:127], a[196:199], a[244:247], a[124:127]
s_waitcnt lgkmcnt(10)
M a[128:131], a[180:183], a[252:255], a[128:131]
ds_read_b128 a[240:243], v10 offset:34816
ds_read_b128 a[244:247], v11 offset:34816
s_mov_b32 s14, 33554432
s_mov_b32 s15, 0x00020000
M a[128:131], a[176:179], a[248:251], a[128:131]
M a[132:135], a[184:187], a[248:251], a[132:135]
ds_read_b64_tr_b16 a[220:221], v16 offset:40960
ds_read_b64_tr_b16 a[222:223], v16 offset:42496
s_mov_b32 s8, s4
s_mov_b32 s9, s5
M a[132:135], a[188:191], a[252:255], a[132:135]
buffer_load_dword v126, v119, s[36:39], 0 offen offset:128 sc1
M a[136:139], a[196:199], a[252:255], a[136:139]
M a[136:139], a[192:195], a[248:251], a[136:139]
s_waitcnt lgkmcnt(10)
s_mov_b32 s10, 16777216
s_mov_b32 s11, 0x00020000
M a[140:143], a[176:179], a[224:227], a[140:143]
M a[140:143], a[180:183], a[228:231], a[140:143]
M a[144:147], a[188:191], a[228:231], a[144:147]
M a[144:147], a[184:187], a[224:227], a[144:147]
M a[148:151], a[192:195], a[224:227], a[148:151]
s_waitcnt vmcnt(17) lgkmcnt(0)
s_barrier
ds_read_b128 a[248:251], v12 offset:0
ds_read_b128 a[252:255], v13 offset:0
s_waitcnt vmcnt(0)
v_cmp_gt_u32 vcc, 0x80, v126
s_nop 0
s_cbranch_vccnz Lk1_spin
Lk1_got:
M a[148:151], a[196:199], a[228:231], a[148:151]
s_add_u32 m0, s29, 65536
s_add_u32 s32, s25, 4096
buffer_load_dwordx4 v1, s[12:15], s25 offen offset:0 sc1 lds
M a[152:155], a[180:183], a[236:239], a[152:155]
ds_read_b128 a[224:227], v12 offset:2048
ds_read_b128 a[228:231], v13 offset:2048
M a[152:155], a[176:179], a[232:235], a[152:155]
buffer_load_dwordx4 v1, s[12:15], s25 offen offset:1024 sc1 lds
M a[156:159], a[184:187], a[232:235], a[156:159]
M a[156:159], a[188:191], a[236:239], a[156:159]
buffer_load_dwordx4 v1, s[12:15], s25 offen offset:2048 sc1 lds
M a[160:163], a[196:199], a[236:239], a[160:163]
buffer_load_dwordx4 v1, s[12:15], s25 offen offset:3072 sc1 lds
M a[160:163], a[192:195], a[232:235], a[160:163]
M a[164:167], a[176:179], a[240:243], a[164:167]
ds_read_b128 a[232:235], v12 offset:4096
ds_read_b128 a[236:239], v13 offset:4096
M a[164:167], a[180:183], a[244:247], a[164:167]
s_add_u32 m0, s29, 69632
s_nop 0
buffer_load_dwordx4 v1, s[12:15], s32 offen offset:0 sc1 lds
M a[168:171], a[188:191], a[244:247], a[168:171]
buffer_load_dwordx4 v1, s[12:15], s32 offen offset:1024 sc1 lds
M a[168:171], a[184:187], a[240:243], a[168:171]
M a[172:175], a[192:195], a[240:243], a[172:175]
buffer_load_dwordx4 v1, s[12:15], s32 offen offset:2048 sc1 lds
M a[172:175], a[196:199], a[244:247], a[172:175]
s_waitcnt lgkmcnt(4)
M a[68:71], a[200:203], a[248:251], a[68:71]
ds_read_b128 a[240:243], v12 offset:6144
ds_read_b128 a[244:247], v13 offset:6144
M a[68:71], a[204:207], a[252:255], a[68:71]
buffer_load_dwordx4 v1, s[12:15], s32 offen offset:3072 sc1 lds
M a[72:75], a[212:215], a[252:255], a[72:75]
M a[72:75], a[208:211], a[248:251], a[72:75]
M a[76:79], a[216:219], a[248:251], a[76:79]
M a[76:79], a[220:223], a[252:255], a[76:79]
s_waitcnt lgkmcnt(4)
M a[80:83], a[204:207], a[228:231], a[80:83]
ds_read_b128 a[248:251], v12 offset:8192
ds_read_b128 a[252:255], v13 offset:8192
M a[80:83], a[200:203], a[224:227], a[80:83]
M a[84:87], a[208:211], a[224:227], a[84:87]
M a[84:87], a[212:215], a[228:231], a[84:87]
M a[88:91], a[220:223], a[228:231], a[88:91]
M a[88:91], a[216:219], a[224:227], a[88:91]
s_waitcnt lgkmcnt(4)
M a[92:95], a[200:203], a[232:235], a[92:95]
ds_read_b128 a[224:227], v12 offset:10240
ds_read_b128 a[228:231], v13 offset:10240
v_accvgpr_read_b32 v24, a68
v_accvgpr_read_b32 v25, a69
v_accvgpr_read_b32 v26, a70
M a[92:95], a[204:207], a[236:239], a[92:95]
v_accvgpr_read_b32 v27, a71
v_cvt_pk_bf16_f32 v24, v24, v25
v_cvt_pk_bf16_f32 v25, v26, v27
ds_write_b64 v124, v[24:25] offset:0
M a[96:99], a[212:215], a[236:239], a[96:99]
v_accvgpr_read_b32 v28, a72
v_accvgpr_read_b32 v29, a73
v_accvgpr_read_b32 v30, a74
M a[96:99], a[208:211], a[232:235], a[96:99]
v_accvgpr_read_b32 v31, a75
v_cvt_pk_bf16_f32 v28, v28, v29
v_cvt_pk_bf16_f32 v29, v30, v31
ds_write_b64 v124, v[28:29] offset:32
M a[100:103], a[216:219], a[232:235], a[100:103]
v_accvgpr_read_b32 v24, a76
v_accvgpr_read_b32 v25, a77
v_accvgpr_read_b32 v26, a78
M a[100:103], a[220:223], a[236:239], a[100:103]
s_waitcnt lgkmcnt(6)
v_accvgpr_read_b32 v27, a79
v_cvt_pk_bf16_f32 v24, v24, v25
v_cvt_pk_bf16_f32 v25, v26, v27
ds_write_b64 v124, v[24:25] offset:64
M a[104:107], a[204:207], a[244:247], a[104:107]
ds_read_b128 a[232:235], v12 offset:12288
ds_read_b128 a[236:239], v13 offset:12288
v_accvgpr_read_b32 v24, a80
v_accvgpr_read_b32 v25, a81
v_accvgpr_read_b32 v26, a82
M a[104:107], a[200:203], a[240:243], a[104:107]
v_accvgpr_read_b32 v27, a83
v_cvt_pk_bf16_f32 v24, v24, v25
v_cvt_pk_bf16_f32 v25, v26, v27
ds_write_b64 v124, v[24:25] offset:6400
M a[108:111], a[208:211], a[240:243], a[108:111]
v_accvgpr_read_b32 v28, a84
v_accvgpr_read_b32 v29, a85
v_accvgpr_read_b32 v30, a86
M a[108:111], a[212:215], a[244:247], a[108:111]
v_accvgpr_read_b32 v31, a87
v_cvt_pk_bf16_f32 v28, v28, v29
v_cvt_pk_bf16_f32 v29, v30, v31
ds_write_b64 v124, v[28:29] offset:6432
M a[112:115], a[220:223], a[244:247], a[112:115]
v_accvgpr_read_b32 v24, a88
v_accvgpr_read_b32 v25, a89
v_accvgpr_read_b32 v26, a90
M a[112:115], a[216:219], a[240:243], a[112:115]
s_waitcnt lgkmcnt(9)
v_accvgpr_read_b32 v27, a91
v_cvt_pk_bf16_f32 v24, v24, v25
v_cvt_pk_bf16_f32 v25, v26, v27
ds_write_b64 v124, v[24:25] offset:6464
M a[116:119], a[200:203], a[248:251], a[116:119]
ds_read_b128 a[240:243], v12 offset:14336
ds_read_b128 a[244:247], v13 offset:14336
v_accvgpr_read_b32 v24, a92
v_accvgpr_read_b32 v25, a93
v_accvgpr_read_b32 v26, a94
M a[116:119], a[204:207], a[252:255], a[116:119]
v_accvgpr_read_b32 v27, a95
v_cvt_pk_bf16_f32 v24, v24, v25
v_cvt_pk_bf16_f32 v25, v26, v27
ds_write_b64 v124, v[24:25] offset:12800
M a[120:123], a[212:215], a[252:255], a[120:123]
v_accvgpr_read_b32 v28, a96
v_accvgpr_read_b32 v29, a97
v_accvgpr_read_b32 v30, a98
M a[120:123], a[208:211], a[248:251], a[120:123]
v_accvgpr_read_b32 v31, a99
v_cvt_pk_bf16_f32 v28, v28, v29
v_cvt_pk_bf16_f32 v29, v30, v31
ds_write_b64 v124, v[28:29] offset:12832
M a[124:127], a[216:219], a[248:251], a[124:127]
v_accvgpr_read_b32 v24, a100
v_accvgpr_read_b32 v25, a101
v_accvgpr_read_b32 v26, a102
M a[124:127], a[220:223], a[252:255], a[124:127]
s_add_u32 s25, s25, 32768
s_cmp_eq_u32 s25, s27
s_cselect_b32 s25, s28, s25
s_cselect_b32 s27, -1, s27
s_waitcnt lgkmcnt(12)
v_accvgpr_read_b32 v27, a103
v_cvt_pk_bf16_f32 v24, v24, v25
v_cvt_pk_bf16_f32 v25, v26, v27
ds_write_b64 v124, v[24:25] offset:12864
M a[128:131], a[204:207], a[228:231], a[128:131]
ds_read_b128 a[248:251], v12 offset:16384
ds_read_b128 a[252:255], v13 offset:16384
v_accvgpr_read_b32 v24, a104
v_accvgpr_read_b32 v25, a105
v_accvgpr_read_b32 v26, a106
M a[128:131], a[200:203], a[224:227], a[128:131]
v_accvgpr_read_b32 v27, a107
v_cvt_pk_bf16_f32 v24, v24, v25
v_cvt_pk_bf16_f32 v25, v26, v27
ds_write_b64 v124, v[24:25] offset:19200
M a[132:135], a[208:211], a[224:227], a[132:135]
v_accvgpr_read_b32 v28, a108
v_accvgpr_read_b32 v29, a109
v_accvgpr_read_b32 v30, a110
M a[132:135], a[212:215], a[228:231], a[132:135]
v_accvgpr_read_b32 v31, a111
v_cvt_pk_bf16_f32 v28, v28, v29
v_cvt_pk_bf16_f32 v29, v30, v31
ds_write_b64 v124, v[28:29] offset:19232
M a[136:139], a[220:223], a[228:231], a[136:139]
v_accvgpr_read_b32 v24, a112
v_accvgpr_read_b32 v25, a113
v_accvgpr_read_b32 v26, a114
M a[136:139], a[216:219], a[224:227], a[136:139]
s_waitcnt lgkmcnt(12)
v_accvgpr_read_b32 v27, a115
v_cvt_pk_bf16_f32 v24, v24, v25
v_cvt_pk_bf16_f32 v25, v26, v27
ds_write_b64 v124, v[24:25] offset:19264
M a[140:143], a[200:203], a[232:235], a[140:143]
v_accvgpr_read_b32 v24, a116
v_accvgpr_read_b32 v25, a117
v_accvgpr_read_b32 v26, a118
M a[140:143], a[204:207], a[236:239], a[140:143]
v_accvgpr_read_b32 v27, a119
v_cvt_pk_bf16_f32 v24, v24, v25
v_cvt_pk_bf16_f32 v25, v26, v27
ds_write_b64 v124, v[24:25] offset:25600
M a[144:147], a[212:215], a[236:239], a[144:147]
v_accvgpr_read_b32 v28, a120
v_accvgpr_read_b32 v29, a121
v_accvgpr_read_b32 v30, a122
M a[144:147], a[208:211], a[232:235], a[144:147]
v_accvgpr_read_b32 v31, a123
v_cvt_pk_bf16_f32 v28, v28, v29
v_cvt_pk_bf16_f32 v29, v30, v31
ds_write_b64 v124, v[28:29] offset:25632
M a[148:151], a[216:219], a[232:235], a[148:151]
s_waitcnt lgkmcnt(0)
s_barrier
v_accvgpr_read_b32 v24, a124
v_accvgpr_read_b32 v25, a125
v_accvgpr_read_b32 v26, a126
M a[148:151], a[220:223], a[236:239], a[148:151]
v_accvgpr_read_b32 v27, a127
v_cvt_pk_bf16_f32 v24, v24, v25
v_cvt_pk_bf16_f32 v25, v26, v27
ds_write_b64 v124, v[24:25] offset:25664
v_accvgpr_read_b32 v24, a128
v_accvgpr_read_b32 v25, a129
v_accvgpr_read_b32 v26, a130
M a[152:155], a[204:207], a[244:247], a[152:155]
v_accvgpr_read_b32 v27, a131
v_cvt_pk_bf16_f32 v24, v24, v25
v_cvt_pk_bf16_f32 v25, v26, v27
M a[152:155], a[200:203], a[240:243], a[152:155]
ds_write_b64 v124, v[24:25] offset:32000
v_accvgpr_read_b32 v28, a132
v_accvgpr_read_b32 v29, a133
M a[156:159], a[208:211], a[240:243], a[156:159]
v_accvgpr_read_b32 v30, a134
v_accvgpr_read_b32 v31, a135
v_cvt_pk_bf16_f32 v28, v28, v29
M a[156:159], a[212:215], a[244:247], a[156:159]
v_cvt_pk_bf16_f32 v29, v30, v31
ds_write_b64 v124, v[28:29] offset:32032
v_accvgpr_read_b32 v24, a136
M a[160:163], a[220:223], a[244:247], a[160:163]
v_accvgpr_read_b32 v25, a137
v_accvgpr_read_b32 v26, a138
v_accvgpr_read_b32 v27, a139
M a[160:163], a[216:219], a[240:243], a[160:163]
v_cvt_pk_bf16_f32 v24, v24, v25
v_cvt_pk_bf16_f32 v25, v26, v27
ds_write_b64 v124, v[24:25] offset:32064
M a[164:167], a[200:203], a[248:251], a[164:167]
v_accvgpr_read_b32 v24, a140
v_accvgpr_read_b32 v25, a141
v_accvgpr_read_b32 v26, a142
M a[164:167], a[204:207], a[252:255], a[164:167]
v_accvgpr_read_b32 v27, a143
v_cvt_pk_bf16_f32 v24, v24, v25
v_cvt_pk_bf16_f32 v25, v26, v27
ds_write_b64 v124, v[24:25] offset:38400
M a[168:171], a[212:215], a[252:255], a[168:171]
v_accvgpr_read_b32 v28, a144
v_accvgpr_read_b32 v29, a145
v_accvgpr_read_b32 v30, a146
M a[168:171], a[208:211], a[248:251], a[168:171]
v_accvgpr_read_b32 v31, a147
v_cvt_pk_bf16_f32 v28, v28, v29
v_cvt_pk_bf16_f32 v29, v30, v31
ds_write_b64 v124, v[28:29] offset:38432
M a[172:175], a[216:219], a[248:251], a[172:175]
v_accvgpr_read_b32 v24, a148
v_accvgpr_read_b32 v25, a149
v_accvgpr_read_b32 v26, a150
M a[172:175], a[220:223], a[252:255], a[172:175]
v_accvgpr_read_b32 v27, a151
v_cvt_pk_bf16_f32 v24, v24, v25
v_cvt_pk_bf16_f32 v25, v26, v27
ds_write_b64 v124, v[24:25] offset:38464
s_mov_b64 s[44:45], s[42:43]
v_accvgpr_read_b32 v24, a152
v_accvgpr_read_b32 v25, a153
v_accvgpr_read_b32 v26, a154
v_accvgpr_read_b32 v27, a155
v_cvt_pk_bf16_f32 v24, v24, v25
v_cvt_pk_bf16_f32 v25, v26, v27
ds_write_b64 v124, v[24:25] offset:44800
v_accvgpr_read_b32 v28, a156
v_accvgpr_read_b32 v29, a157
v_accvgpr_read_b32 v30, a158
v_accvgpr_read_b32 v31, a159
v_cvt_pk_bf16_f32 v28, v28, v29
v_cvt_pk_bf16_f32 v29, v30, v31
ds_write_b64 v124, v[28:29] offset:44832
v_accvgpr_read_b32 v24, a160
v_accvgpr_read_b32 v25, a161
v_accvgpr_read_b32 v26, a162
v_accvgpr_read_b32 v27, a163
v_cvt_pk_bf16_f32 v24, v24, v25
v_cvt_pk_bf16_f32 v25, v26, v27
ds_write_b64 v124, v[24:25] offset:44864
v_accvgpr_read_b32 v24, a164
v_accvgpr_read_b32 v25, a165
v_accvgpr_read_b32 v26, a166
v_accvgpr_read_b32 v27, a167
v_cvt_pk_bf16_f32 v24, v24, v25
v_cvt_pk_bf16_f32 v25, v26, v27
ds_write_b64 v124, v[24:25] offset:51200
v_accvgpr_read_b32 v28, a168
v_accvgpr_read_b32 v29, a169
v_accvgpr_read_b32 v30, a170
v_accvgpr_read_b32 v31, a171
v_cvt_pk_bf16_f32 v28, v28, v29
v_cvt_pk_bf16_f32 v29, v30, v31
ds_write_b64 v124, v[28:29] offset:51232
v_accvgpr_read_b32 v24, a172
v_accvgpr_read_b32 v25, a173
v_accvgpr_read_b32 v26, a174
v_accvgpr_read_b32 v27, a175
v_cvt_pk_bf16_f32 v24, v24, v25
v_cvt_pk_bf16_f32 v25, v26, v27
ds_write_b64 v124, v[24:25] offset:51264
s_waitcnt lgkmcnt(0)
s_barrier
ds_read_b128 v[48:51], v121 offset:128
ds_read_b128 v[32:35], v120 offset:0
ds_read_b128 v[52:55], v120 offset:128
ds_read_b128 v[36:39], v120 offset:12800
ds_read_b128 v[56:59], v120 offset:12928
ds_read_b128 v[40:43], v120 offset:25600
ds_read_b128 v[60:63], v120 offset:25728
ds_read_b128 v[44:47], v120 offset:38400
ds_read_b128 v[64:67], v120 offset:38528
ds_read_b64_tr_b16 v[68:69], v123 offset:256
ds_read_b64_tr_b16 v[70:71], v122 offset:256
ds_read_b64_tr_b16 v[72:73], v122 offset:13056
ds_read_b64_tr_b16 v[74:75], v122 offset:25856
ds_read_b64_tr_b16 v[76:77], v122 offset:38656
ds_read_b64_tr_b16 v[78:79], v123 offset:288
ds_read_b64_tr_b16 v[80:81], v122 offset:288
ds_read_b64_tr_b16 v[82:83], v122 offset:13088
ds_read_b64_tr_b16 v[84:85], v122 offset:25888
ds_read_b64_tr_b16 v[86:87], v122 offset:38688
v_accvgpr_write_b32 a64, 0
v_accvgpr_write_b32 a65, 0
v_accvgpr_write_b32 a66, 0
v_accvgpr_write_b32 a67, 0
v_accvgpr_write_b32 a68, 0
v_accvgpr_write_b32 a69, 0
v_accvgpr_write_b32 a70, 0
v_accvgpr_write_b32 a71, 0
v_accvgpr_write_b32 a72, 0
v_accvgpr_write_b32 a73, 0
v_accvgpr_write_b32 a74, 0
v_accvgpr_write_b32 a75, 0
s_add_u32 m0, s29, 0
s_add_u32 s32, s25, 4096
buffer_load_dwordx4 v1, s[12:15], s25 offen offset:0 sc1 lds
v_accvgpr_write_b32 a76, 0
v_accvgpr_write_b32 a77, 0
v_accvgpr_write_b32 a78, 0
v_accvgpr_write_b32 a79, 0
v_accvgpr_write_b32 a80, 0
v_accvgpr_write_b32 a81, 0
v_accvgpr_write_b32 a82, 0
v_accvgpr_write_b32 a83, 0
v_accvgpr_write_b32 a84, 0
v_accvgpr_write_b32 a85, 0
v_accvgpr_write_b32 a86, 0
buffer_load_dwordx4 v1, s[12:15], s25 offen offset:1024 sc1 lds
v_accvgpr_write_b32 a87, 0
v_accvgpr_write_b32 a88, 0
v_accvgpr_write_b32 a89, 0
v_accvgpr_write_b32 a90, 0
v_accvgpr_write_b32 a91, 0
v_accvgpr_write_b32 a92, 0
v_accvgpr_write_b32 a93, 0
v_accvgpr_write_b32 a94, 0
v_accvgpr_write_b32 a95, 0
v_accvgpr_write_b32 a96, 0
buffer_load_dwordx4 v1, s[12:15], s25 offen offset:2048 sc1 lds
v_accvgpr_write_b32 a97, 0
v_accvgpr_write_b32 a98, 0
v_accvgpr_write_b32 a99, 0
v_accvgpr_write_b32 a100, 0
v_accvgpr_write_b32 a101, 0
v_accvgpr_write_b32 a102, 0
v_accvgpr_write_b32 a103, 0
v_accvgpr_write_b32 a104, 0
v_accvgpr_write_b32 a105, 0
v_accvgpr_write_b32 a106, 0
v_accvgpr_write_b32 a107, 0
buffer_load_dwordx4 v1, s[12:15], s25 offen offset:3072 sc1 lds
v_accvgpr_write_b32 a108, 0
v_accvgpr_write_b32 a109, 0
v_accvgpr_write_b32 a110, 0
v_accvgpr_write_b32 a111, 0
s_waitcnt lgkmcnt(15)
M v[88:91], v[48:51], v[32:35], v[152:155]
M v[92:95], v[52:55], v[32:35], v[148:151]
M v[96:99], v[52:55], v[36:39], v[144:147]
s_waitcnt lgkmcnt(14)
M v[100:103], v[56:59], v[36:39], v[148:151]
s_waitcnt lgkmcnt(13)
M v[104:107], v[56:59], v[40:43], v[144:147]
s_waitcnt lgkmcnt(12)
M v[108:111], v[60:63], v[40:43], v[148:151]
s_add_u32 m0, s29, 4096
s_nop 0
buffer_load_dwordx4 v1, s[12:15], s32 offen offset:0 sc1 lds
s_waitcnt lgkmcnt(11)
M v[112:115], v[60:63], v[44:47], v[144:147]
s_waitcnt lgkmcnt(10)
M v[116:119], v[64:67], v[44:47], v[148:151]
v_max3_f32 v136, v88, v89, v90
v_max3_f32 v136, v136, v91, v92
v_max3_f32 v136, v136, v93, v94
v_max_f32 v136, v136, v95
v_max3_f32 v137, v96, v97, v98
v_max3_f32 v137, v137, v99, v100
v_max3_f32 v137, v137, v101, v102
v_max_f32 v137, v137, v103
v_max3_f32 v138, v104, v105, v106
buffer_load_dwordx4 v1, s[12:15], s32 offen offset:1024 sc1 lds
v_max3_f32 v138, v138, v107, v108
v_max3_f32 v138, v138, v109, v110
v_max_f32 v138, v138, v111
v_max3_f32 v139, v112, v113, v114
v_max3_f32 v139, v139, v115, v116
v_max3_f32 v139, v139, v117, v118
v_max_f32 v139, v139, v119
v_mov_b32 v140, v136
v_mov_b32 v141, v137
v_mov_b32 v142, v138
buffer_load_dwordx4 v1, s[12:15], s32 offen offset:2048 sc1 lds
v_mov_b32 v143, v139
v_permlane16_swap_b32 v136, v140
v_permlane16_swap_b32 v137, v141
v_permlane16_swap_b32 v138, v142
v_permlane16_swap_b32 v139, v143
v_max_f32 v136, v136, v140
v_max_f32 v137, v137, v141
v_max_f32 v138, v138, v142
v_max_f32 v139, v139, v143
v_mov_b32 v140, v136
v_mov_b32 v141, v137
buffer_load_dwordx4 v1, s[12:15], s32 offen offset:3072 sc1 lds
v_mov_b32 v142, v138
v_mov_b32 v143, v139
v_permlane32_swap_b32 v136, v140
v_permlane32_swap_b32 v137, v141
v_permlane32_swap_b32 v138, v142
v_permlane32_swap_b32 v139, v143
v_max_f32 v136, v136, v140
v_max_f32 v137, v137, v141
v_max_f32 v138, v138, v142
v_max_f32 v139, v139, v143
s_add_u32 s25, s25, 32768
s_cmp_eq_u32 s25, s27
s_cselect_b32 s25, s28, s25
s_cselect_b32 s27, -1, s27
v_mul_f32 v136, s7, v136
v_mul_f32 v137, s7, v137
v_mul_f32 v138, s7, v138
v_mul_f32 v139, s7, v139
v_fma_f32 v88, v88, s7, -v136
v_fma_f32 v89, v89, s7, -v136
v_fma_f32 v90, v90, s7, -v136
v_fma_f32 v91, v91, s7, -v136
v_fma_f32 v92, v92, s7, -v136
v_fma_f32 v93, v93, s7, -v136
v_fma_f32 v94, v94, s7, -v136
s_add_u32 m0, s29, 32768
s_add_u32 s32, s26, 4096
buffer_load_dwordx4 v1, s[12:15], s26 offen offset:0 sc1 lds
v_fma_f32 v95, v95, s7, -v136
v_exp_f32 v88, v88
v_exp_f32 v89, v89
v_exp_f32 v90, v90
v_exp_f32 v91, v91
v_exp_f32 v92, v92
v_exp_f32 v93, v93
v_exp_f32 v94, v94
v_exp_f32 v95, v95
v_fma_f32 v96, v96, s7, -v137
v_fma_f32 v97, v97, s7, -v137
buffer_load_dwordx4 v1, s[12:15], s26 offen offset:1024 sc1 lds
v_fma_f32 v98, v98, s7, -v137
v_fma_f32 v99, v99, s7, -v137
v_fma_f32 v100, v100, s7, -v137
v_fma_f32 v101, v101, s7, -v137
v_fma_f32 v102, v102, s7, -v137
v_fma_f32 v103, v103, s7, -v137
v_exp_f32 v96, v96
v_exp_f32 v97, v97
v_exp_f32 v98, v98
v_exp_f32 v99, v99
buffer_load_dwordx4 v1, s[12:15], s26 offen offset:2048 sc1 lds
v_exp_f32 v100, v100
v_exp_f32 v101, v101
v_exp_f32 v102, v102
v_exp_f32 v103, v103
v_fma_f32 v104, v104, s7, -v138
v_fma_f32 v105, v105, s7, -v138
v_fma_f32 v106, v106, s7, -v138
v_fma_f32 v107, v107, s7, -v138
v_fma_f32 v108, v108, s7, -v138
v_fma_f32 v109, v109, s7, -v138
v_fma_f32 v110, v110, s7, -v138
buffer_load_dwordx4 v1, s[12:15], s26 offen offset:3072 sc1 lds
v_fma_f32 v111, v111, s7, -v138
v_exp_f32 v104, v104
v_exp_f32 v105, v105
v_exp_f32 v106, v106
v_exp_f32 v107, v107
v_exp_f32 v108, v108
v_exp_f32 v109, v109
v_exp_f32 v110, v110
v_exp_f32 v111, v111
v_fma_f32 v112, v112, s7, -v139
s_add_u32 m0, s29, 36864
s_nop 0
buffer_load_dwordx4 v1, s[12:15], s32 offen offset:0 sc1 lds
v_fma_f32 v113, v113, s7, -v139
v_fma_f32 v114, v114, s7, -v139
v_fma_f32 v115, v115, s7, -v139
v_fma_f32 v116, v116, s7, -v139
v_fma_f32 v117, v117, s7, -v139
v_fma_f32 v118, v118, s7, -v139
v_fma_f32 v119, v119, s7, -v139
v_exp_f32 v112, v112
v_exp_f32 v113, v113
v_exp_f32 v114, v114
v_exp_f32 v115, v115
buffer_load_dwordx4 v1, s[12:15], s32 offen offset:1024 sc1 lds
v_exp_f32 v116, v116
v_exp_f32 v117, v117
v_exp_f32 v118, v118
v_exp_f32 v119, v119
v_cvt_pk_bf16_f32 v88, v88, v89
v_cvt_pk_bf16_f32 v89, v90, v91
v_cvt_pk_bf16_f32 v90, v92, v93
v_cvt_pk_bf16_f32 v91, v94, v95
v_cvt_pk_bf16_f32 v96, v96, v97
v_cvt_pk_bf16_f32 v97, v98, v99
buffer_load_dwordx4 v1, s[12:15], s32 offen offset:2048 sc1 lds
v_cvt_pk_bf16_f32 v98, v100, v101
v_cvt_pk_bf16_f32 v99, v102, v103
v_cvt_pk_bf16_f32 v104, v104, v105
v_cvt_pk_bf16_f32 v105, v106, v107
v_cvt_pk_bf16_f32 v106, v108, v109
v_cvt_pk_bf16_f32 v107, v110, v111
v_cvt_pk_bf16_f32 v112, v112, v113
v_cvt_pk_bf16_f32 v113, v114, v115
v_cvt_pk_bf16_f32 v114, v116, v117
v_cvt_pk_bf16_f32 v115, v118, v119
M v[120:123], v[156:159], v[88:91], 0
buffer_load_dwordx4 v1, s[12:15], s32 offen offset:3072 sc1 lds
s_waitcnt lgkmcnt(8)
M v[32:35], v[68:71], v[88:91], 0
s_waitcnt lgkmcnt(3)
M v[36:39], v[78:81], v[88:91], 0
M v[124:127], v[156:159], v[96:99], 0
M v[40:43], v[70:73], v[96:99], 0
s_waitcnt lgkmcnt(2)
M v[44:47], v[80:83], v[96:99], 0
M v[128:131], v[156:159], v[104:107], 0
M v[48:51], v[72:75], v[104:107], 0
s_waitcnt lgkmcnt(1)
M v[52:55], v[82:85], v[104:107], 0
M v[132:135], v[156:159], v[112:115], 0
M v[56:59], v[74:77], v[112:115], 0
s_add_u32 s26, s26, 32768
s_cmp_eq_u32 s26, s62
s_cselect_b32 s26, s63, s26
s_cselect_b32 s62, -1, s62
s_waitcnt lgkmcnt(0)
M v[60:63], v[84:87], v[112:115], 0
v_rcp_f32 v120, v120
v_rcp_f32 v124, v124
v_rcp_f32 v128, v128
v_rcp_f32 v132, v132
v_pk_mul_f32 v[32:33], v[32:33], v[120:121] op_sel_hi:[1,0]
v_pk_mul_f32 v[34:35], v[34:35], v[120:121] op_sel_hi:[1,0]
v_pk_mul_f32 v[36:37], v[36:37], v[120:121] op_sel_hi:[1,0]
v_pk_mul_f32 v[38:39], v[38:39], v[120:121] op_sel_hi:[1,0]
v_cvt_pk_bf16_f32 v32, v32, v33
v_cvt_pk_bf16_f32 v33, v34, v35
v_cvt_pk_bf16_f32 v34, v36, v37
v_cvt_pk_bf16_f32 v35, v38, v39
s_add_u32 s3, s6, 0
buffer_store_dwordx4 v[32:35], v1, s[16:19], s3 offen sc1
v_pk_mul_f32 v[40:41], v[40:41], v[124:125] op_sel_hi:[1,0]
v_pk_mul_f32 v[42:43], v[42:43], v[124:125] op_sel_hi:[1,0]
v_pk_mul_f32 v[44:45], v[44:45], v[124:125] op_sel_hi:[1,0]
v_pk_mul_f32 v[46:47], v[46:47], v[124:125] op_sel_hi:[1,0]
v_cvt_pk_bf16_f32 v40, v40, v41
v_cvt_pk_bf16_f32 v41, v42, v43
v_cvt_pk_bf16_f32 v42, v44, v45
v_cvt_pk_bf16_f32 v43, v46, v47
s_add_u32 s3, s6, 2048
buffer_store_dwordx4 v[40:43], v1, s[16:19], s3 offen sc1
v_pk_mul_f32 v[48:49], v[48:49], v[128:129] op_sel_hi:[1,0]
v_pk_mul_f32 v[50:51], v[50:51], v[128:129] op_sel_hi:[1,0]
v_pk_mul_f32 v[52:53], v[52:53], v[128:129] op_sel_hi:[1,0]
v_pk_mul_f32 v[54:55], v[54:55], v[128:129] op_sel_hi:[1,0]
v_cvt_pk_bf16_f32 v48, v48, v49
v_cvt_pk_bf16_f32 v49, v50, v51
v_cvt_pk_bf16_f32 v50, v52, v53
v_cvt_pk_bf16_f32 v51, v54, v55
s_add_u32 s3, s6, 4096
buffer_store_dwordx4 v[48:51], v1, s[16:19], s3 offen sc1
v_pk_mul_f32 v[56:57], v[56:57], v[132:133] op_sel_hi:[1,0]
v_pk_mul_f32 v[58:59], v[58:59], v[132:133] op_sel_hi:[1,0]
v_pk_mul_f32 v[60:61], v[60:61], v[132:133] op_sel_hi:[1,0]
v_pk_mul_f32 v[62:63], v[62:63], v[132:133] op_sel_hi:[1,0]
v_cvt_pk_bf16_f32 v56, v56, v57
v_cvt_pk_bf16_f32 v57, v58, v59
v_cvt_pk_bf16_f32 v58, v60, v61
v_cvt_pk_bf16_f32 v59, v62, v63
s_add_u32 s3, s6, 6144
buffer_store_dwordx4 v[56:59], v1, s[16:19], s3 offen sc1
Lc2:
s_add_u32 s16, s4, 67108864
s_addc_u32 s17, s5, 0
s_mov_b32 s18, 16777216
s_mov_b32 s19, 0x00020000
s_add_u32 s52, s4, 100663296
s_addc_u32 s53, s5, 0
s_mov_b32 s54, 8404992
s_mov_b32 s55, 0x00020000
s_mov_b32 s46, 8388608
s_mov_b32 s47, 0x00020000
s_mov_b32 s50, 2097152
s_mov_b32 s51, 0x00020000
s_lshl_b32 s33, s24, 14
v_add_u32 v2, s33, v1
v_add_u32 v3, 0x10000, v2
v_and_b32 v8, 15, v0
v_bfe_u32 v9, v0, 4, 2
v_lshlrev_b32 v9, 2, v9
v_sub_u32 v8, v8, v9
v_mov_b32 v4, 0xf149f2ca
v_cmp_gt_i32 vcc, 0, v8
s_nop 1
v_cndmask_b32 v16, 0, v4, vcc
v_cmp_gt_i32 vcc, 1, v8
s_nop 1
v_cndmask_b32 v17, 0, v4, vcc
v_cmp_gt_i32 vcc, 2, v8
s_nop 1
v_cndmask_b32 v18, 0, v4, vcc
v_cmp_gt_i32 vcc, 3, v8
s_nop 1
v_cndmask_b32 v19, 0, v4, vcc
v_mov_b32 v8, 0x3f803f80
v_accvgpr_write_b32 a112, v8
v_accvgpr_write_b32 a113, v8
v_accvgpr_write_b32 a114, v8
v_accvgpr_write_b32 a115, v8
s_lshl_b32 s33, s23, 6
s_add_i32 s33, s33, s31
s_cmp_gt_i32 s33, 0
s_cselect_b32 s34, 0, 0xf149f2ca
s_cmp_lt_i32 s33, 0
s_cselect_b32 s33, 0xf149f2ca, 0
v_mov_b32 v20, s34
v_mov_b32 v21, s34
v_mov_b32 v22, s34
v_mov_b32 v23, s34
v_mov_b32 v28, s33
v_mov_b32 v29, s33
v_mov_b32 v30, s33
v_mov_b32 v31, s33
v_med3_f32 v24, v16, v20, v28
v_med3_f32 v25, v17, v20, v28
v_med3_f32 v26, v18, v20, v28
v_med3_f32 v27, v19, v20, v28
v_mov_b32 v5, 0
v_mov_b32 v6, 1
s_waitcnt vmcnt(20)
s_barrier
ds_read_b128 a[116:119], v3 offset:0
ds_read_b128 a[120:123], v3 offset:1024
ds_read_b128 a[124:127], v3 offset:2048
ds_read_b128 a[128:131], v3 offset:3072
ds_read_b128 a[132:135], v3 offset:4096
ds_read_b128 a[136:139], v3 offset:5120
ds_read_b128 a[140:143], v3 offset:6144
ds_read_b128 a[144:147], v3 offset:7168
s_waitcnt lgkmcnt(4)
M v[32:35], a[116:119], a[0:3], v[24:27]
M v[32:35], a[120:123], a[4:7], v[32:35]
ds_read_b128 a[148:151], v3 offset:8192
ds_read_b128 a[152:155], v3 offset:9216
M v[32:35], a[124:127], a[8:11], v[32:35]
M v[32:35], a[128:131], a[12:15], v[32:35]
M v[36:39], a[128:131], a[28:31], v[28:31]
M v[36:39], a[124:127], a[24:27], v[36:39]
M v[36:39], a[120:123], a[20:23], v[36:39]
M v[36:39], a[116:119], a[16:19], v[36:39]
M v[40:43], a[116:119], a[32:35], v[28:31]
M v[40:43], a[120:123], a[36:39], v[40:43]
ds_read_b128 a[156:159], v3 offset:10240
ds_read_b128 a[160:163], v3 offset:11264
M v[40:43], a[124:127], a[40:43], v[40:43]
M v[40:43], a[128:131], a[44:47], v[40:43]
M v[44:47], a[128:131], a[60:63], v[28:31]
M v[44:47], a[124:127], a[56:59], v[44:47]
M v[44:47], a[120:123], a[52:55], v[44:47]
M v[44:47], a[116:119], a[48:51], v[44:47]
s_waitcnt lgkmcnt(4)
M v[48:51], a[132:135], a[0:3], v[20:23]
M v[48:51], a[136:139], a[4:7], v[48:51]
ds_read_b128 a[164:167], v3 offset:12288
ds_read_b128 a[168:171], v3 offset:13312
M v[48:51], a[140:143], a[8:11], v[48:51]
M v[48:51], a[144:147], a[12:15], v[48:51]
M v[52:55], a[144:147], a[28:31], v[24:27]
M v[52:55], a[140:143], a[24:27], v[52:55]
M v[52:55], a[136:139], a[20:23], v[52:55]
M v[52:55], a[132:135], a[16:19], v[52:55]
M v[56:59], a[132:135], a[32:35], v[28:31]
M v[56:59], a[136:139], a[36:39], v[56:59]
ds_read_b128 a[172:175], v3 offset:14336
ds_read_b128 a[176:179], v3 offset:15360
M v[56:59], a[140:143], a[40:43], v[56:59]
M v[56:59], a[144:147], a[44:47], v[56:59]
M v[60:63], a[144:147], a[60:63], v[28:31]
M v[60:63], a[140:143], a[56:59], v[60:63]
M v[60:63], a[136:139], a[52:55], v[60:63]
M v[60:63], a[132:135], a[48:51], v[60:63]
s_waitcnt lgkmcnt(4)
M v[64:67], a[148:151], a[0:3], v[20:23]
M v[64:67], a[152:155], a[4:7], v[64:67]
M v[64:67], a[156:159], a[8:11], v[64:67]
M v[64:67], a[160:163], a[12:15], v[64:67]
M v[68:71], a[160:163], a[28:31], v[20:23]
M v[68:71], a[156:159], a[24:27], v[68:71]
M v[68:71], a[152:155], a[20:23], v[68:71]
M v[68:71], a[148:151], a[16:19], v[68:71]
M v[72:75], a[148:151], a[32:35], v[24:27]
M v[72:75], a[152:155], a[36:39], v[72:75]
M v[72:75], a[156:159], a[40:43], v[72:75]
M v[72:75], a[160:163], a[44:47], v[72:75]
M v[76:79], a[160:163], a[60:63], v[28:31]
M v[76:79], a[156:159], a[56:59], v[76:79]
s_waitcnt vmcnt(4) lgkmcnt(0)
s_barrier
ds_read_b128 a[116:119], v2 offset:0
ds_read_b128 a[120:123], v2 offset:1024
M v[76:79], a[152:155], a[52:55], v[76:79]
M v[76:79], a[148:151], a[48:51], v[76:79]
M v[80:83], a[164:167], a[0:3], v[20:23]
M v[80:83], a[168:171], a[4:7], v[80:83]
ds_read_b128 a[124:127], v2 offset:2048
ds_read_b128 a[128:131], v2 offset:3072
M v[80:83], a[172:175], a[8:11], v[80:83]
M v[80:83], a[176:179], a[12:15], v[80:83]
M v[84:87], a[176:179], a[28:31], v[20:23]
M v[84:87], a[172:175], a[24:27], v[84:87]
ds_read_b128 a[132:135], v2 offset:4096
ds_read_b128 a[136:139], v2 offset:5120
M v[84:87], a[168:171], a[20:23], v[84:87]
M v[84:87], a[164:167], a[16:19], v[84:87]
M v[88:91], a[164:167], a[32:35], v[20:23]
M v[88:91], a[168:171], a[36:39], v[88:91]
ds_read_b128 a[140:143], v2 offset:6144
ds_read_b128 a[144:147], v2 offset:7168
M v[88:91], a[172:175], a[40:43], v[88:91]
M v[88:91], a[176:179], a[44:47], v[88:91]
M v[92:95], a[176:179], a[60:63], v[24:27]
M v[92:95], a[172:175], a[56:59], v[92:95]
M v[92:95], a[168:171], a[52:55], v[92:95]
M v[92:95], a[164:167], a[48:51], v[92:95]
s_waitcnt vmcnt(0)
s_mov_b64 exec, 1
buffer_store_dword v6, v5, s[52:55], s65 offen sc1
s_mov_b64 exec, -1
v_exp_f32 v32, v32
v_exp_f32 v33, v33
v_exp_f32 v34, v34
v_exp_f32 v35, v35
v_exp_f32 v48, v48
v_exp_f32 v49, v49
v_exp_f32 v50, v50
v_exp_f32 v51, v51
v_cvt_pk_bf16_f32 v32, v32, v33
v_cvt_pk_bf16_f32 v33, v34, v35
v_exp_f32 v36, v36
v_exp_f32 v37, v37
v_exp_f32 v38, v38
v_exp_f32 v39, v39
v_cvt_pk_bf16_f32 v34, v48, v49
v_cvt_pk_bf16_f32 v35, v50, v51
v_exp_f32 v52, v52
v_exp_f32 v53, v53
v_exp_f32 v54, v54
v_exp_f32 v55, v55
v_cvt_pk_bf16_f32 v36, v36, v37
v_cvt_pk_bf16_f32 v37, v38, v39
v_exp_f32 v40, v40
v_exp_f32 v41, v41
v_exp_f32 v42, v42
v_exp_f32 v43, v43
v_cvt_pk_bf16_f32 v38, v52, v53
v_cvt_pk_bf16_f32 v39, v54, v55
v_exp_f32 v56, v56
v_exp_f32 v57, v57
v_exp_f32 v58, v58
v_exp_f32 v59, v59
v_cvt_pk_bf16_f32 v40, v40, v41
v_cvt_pk_bf16_f32 v41, v42, v43
v_exp_f32 v44, v44
v_exp_f32 v45, v45
v_exp_f32 v46, v46
v_exp_f32 v47, v47
v_cvt_pk_bf16_f32 v42, v56, v57
v_cvt_pk_bf16_f32 v43, v58, v59
v_exp_f32 v60, v60
v_exp_f32 v61, v61
v_exp_f32 v62, v62
v_exp_f32 v63, v63
v_cvt_pk_bf16_f32 v44, v44, v45
v_cvt_pk_bf16_f32 v45, v46, v47
v_cvt_pk_bf16_f32 v46, v60, v61
v_cvt_pk_bf16_f32 v47, v62, v63
s_cmp_eq_u32 s24, 1
s_cbranch_scc1 Lk2_g1
s_mov_b32 s30, s21
s_cmp_eq_u32 s21, 0
s_cbranch_scc1 Lk2_m2
Lk2_l1:
s_add_u32 m0, s29, 65536
s_waitcnt lgkmcnt(4)
M v[96:99], a[116:119], a[0:3], 0
v_exp_f32 v64, v64
M v[96:99], a[120:123], a[4:7], v[96:99]
ds_read_b128 a[148:151], v2 offset:8192
ds_read_b128 a[152:155], v2 offset:9216
M v[96:99], a[124:127], a[8:11], v[96:99]
v_exp_f32 v65, v65
M v[96:99], a[128:131], a[12:15], v[96:99]
buffer_load_dwordx4 v1, s[12:15], s25 offen offset:0 sc1 lds
s_add_u32 s32, s25, 4096
M v[100:103], a[128:131], a[28:31], 0
v_exp_f32 v66, v66
M v[100:103], a[124:127], a[24:27], v[100:103]
v_cvt_pk_bf16_f32 v64, v64, v65
M v[100:103], a[120:123], a[20:23], v[100:103]
v_exp_f32 v67, v67
M v[100:103], a[116:119], a[16:19], v[100:103]
buffer_load_dwordx4 v1, s[12:15], s25 offen offset:1024 sc1 lds
M v[104:107], a[116:119], a[32:35], 0
v_exp_f32 v80, v80
M v[104:107], a[120:123], a[36:39], v[104:107]
ds_read_b128 a[156:159], v2 offset:10240
ds_read_b128 a[160:163], v2 offset:11264
M v[104:107], a[124:127], a[40:43], v[104:107]
v_exp_f32 v81, v81
M v[104:107], a[128:131], a[44:47], v[104:107]
buffer_load_dwordx4 v1, s[12:15], s25 offen offset:2048 sc1 lds
M v[108:111], a[128:131], a[60:63], 0
v_exp_f32 v82, v82
M v[108:111], a[124:127], a[56:59], v[108:111]
v_cvt_pk_bf16_f32 v65, v66, v67
v_cvt_pk_bf16_f32 v66, v80, v81
M v[108:111], a[120:123], a[52:55], v[108:111]
v_exp_f32 v83, v83
M v[108:111], a[116:119], a[48:51], v[108:111]
buffer_load_dwordx4 v1, s[12:15], s25 offen offset:3072 sc1 lds
s_add_u32 m0, s29, 69632
s_waitcnt lgkmcnt(4)
M v[112:115], a[132:135], a[0:3], 0
v_exp_f32 v68, v68
M v[112:115], a[136:139], a[4:7], v[112:115]
ds_read_b128 a[164:167], v2 offset:12288
ds_read_b128 a[168:171], v2 offset:13312
M v[112:115], a[140:143], a[8:11], v[112:115]
v_exp_f32 v69, v69
M v[112:115], a[144:147], a[12:15], v[112:115]
buffer_load_dwordx4 v1, s[12:15], s32 offen offset:0 sc1 lds
M v[116:119], a[144:147], a[28:31], 0
v_exp_f32 v70, v70
M v[116:119], a[140:143], a[24:27], v[116:119]
v_cvt_pk_bf16_f32 v67, v82, v83
v_cvt_pk_bf16_f32 v68, v68, v69
M v[116:119], a[136:139], a[20:23], v[116:119]
v_exp_f32 v71, v71
M v[116:119], a[132:135], a[16:19], v[116:119]
buffer_load_dwordx4 v1, s[12:15], s32 offen offset:1024 sc1 lds
M v[120:123], a[132:135], a[32:35], 0
v_exp_f32 v84, v84
M v[120:123], a[136:139], a[36:39], v[120:123]
ds_read_b128 a[172:175], v2 offset:14336
ds_read_b128 a[176:179], v2 offset:15360
M v[120:123], a[140:143], a[40:43], v[120:123]
v_exp_f32 v85, v85
M v[120:123], a[144:147], a[44:47], v[120:123]
buffer_load_dwordx4 v1, s[12:15], s32 offen offset:2048 sc1 lds
M v[124:127], a[144:147], a[60:63], 0
v_exp_f32 v86, v86
M v[124:127], a[140:143], a[56:59], v[124:127]
v_cvt_pk_bf16_f32 v69, v70, v71
v_cvt_pk_bf16_f32 v70, v84, v85
M v[124:127], a[136:139], a[52:55], v[124:127]
v_exp_f32 v87, v87
M v[124:127], a[132:135], a[48:51], v[124:127]
buffer_load_dwordx4 v1, s[12:15], s32 offen offset:3072 sc1 lds
s_add_u32 m0, s29, 98304
s_waitcnt lgkmcnt(4)
M v[128:131], a[148:151], a[0:3], 0
v_exp_f32 v72, v72
M v[128:131], a[152:155], a[4:7], v[128:131]
ds_read_b128 a[116:119], v2 offset:32768
ds_read_b128 a[120:123], v2 offset:40960
M v[128:131], a[156:159], a[8:11], v[128:131]
v_exp_f32 v73, v73
M v[128:131], a[160:163], a[12:15], v[128:131]
buffer_load_dwordx4 v1, s[12:15], s26 offen offset:0 sc1 lds
s_add_u32 s43, s26, 4096
M v[132:135], a[160:163], a[28:31], 0
v_exp_f32 v74, v74
M v[132:135], a[156:159], a[24:27], v[132:135]
v_cvt_pk_bf16_f32 v71, v86, v87
v_cvt_pk_bf16_f32 v72, v72, v73
M v[132:135], a[152:155], a[20:23], v[132:135]
v_exp_f32 v75, v75
M v[132:135], a[148:151], a[16:19], v[132:135]
buffer_load_dwordx4 v1, s[12:15], s26 offen offset:1024 sc1 lds
M v[136:139], a[148:151], a[32:35], 0
v_exp_f32 v88, v88
M v[136:139], a[152:155], a[36:39], v[136:139]
ds_read_b128 a[124:127], v2 offset:33792
ds_read_b128 a[128:131], v2 offset:41984
M v[136:139], a[156:159], a[40:43], v[136:139]
v_exp_f32 v89, v89
M v[136:139], a[160:163], a[44:47], v[136:139]
buffer_load_dwordx4 v1, s[12:15], s26 offen offset:2048 sc1 lds
M v[140:143], a[160:163], a[60:63], 0
v_exp_f32 v90, v90
M v[140:143], a[156:159], a[56:59], v[140:143]
v_cvt_pk_bf16_f32 v73, v74, v75
v_cvt_pk_bf16_f32 v74, v88, v89
M v[140:143], a[152:155], a[52:55], v[140:143]
v_exp_f32 v91, v91
M v[140:143], a[148:151], a[48:51], v[140:143]
buffer_load_dwordx4 v1, s[12:15], s26 offen offset:3072 sc1 lds
s_add_u32 m0, s29, 102400
s_waitcnt lgkmcnt(4)
M v[144:147], a[164:167], a[0:3], 0
v_exp_f32 v76, v76
M v[144:147], a[168:171], a[4:7], v[144:147]
ds_read_b128 a[132:135], v2 offset:34816
ds_read_b128 a[136:139], v2 offset:43008
M v[144:147], a[172:175], a[8:11], v[144:147]
v_exp_f32 v77, v77
M v[144:147], a[176:179], a[12:15], v[144:147]
buffer_load_dwordx4 v1, s[12:15], s43 offen offset:0 sc1 lds
M v[148:151], a[176:179], a[28:31], 0
v_exp_f32 v78, v78
M v[148:151], a[172:175], a[24:27], v[148:151]
v_cvt_pk_bf16_f32 v75, v90, v91
v_cvt_pk_bf16_f32 v76, v76, v77
M v[148:151], a[168:171], a[20:23], v[148:151]
v_exp_f32 v79, v79
M v[148:151], a[164:167], a[16:19], v[148:151]
buffer_load_dwordx4 v1, s[12:15], s43 offen offset:1024 sc1 lds
M v[152:155], a[164:167], a[32:35], 0
v_exp_f32 v92, v92
M v[152:155], a[168:171], a[36:39], v[152:155]
ds_read_b128 a[140:143], v2 offset:35840
ds_read_b128 a[144:147], v2 offset:44032
M v[152:155], a[172:175], a[40:43], v[152:155]
v_exp_f32 v93, v93
M v[152:155], a[176:179], a[44:47], v[152:155]
buffer_load_dwordx4 v1, s[12:15], s43 offen offset:2048 sc1 lds
M v[156:159], a[176:179], a[60:63], 0
v_exp_f32 v94, v94
M v[156:159], a[172:175], a[56:59], v[156:159]
v_cvt_pk_bf16_f32 v77, v78, v79
v_cvt_pk_bf16_f32 v78, v92, v93
M v[156:159], a[168:171], a[52:55], v[156:159]
v_exp_f32 v95, v95
M v[156:159], a[164:167], a[48:51], v[156:159]
buffer_load_dwordx4 v1, s[12:15], s43 offen offset:3072 sc1 lds
v_cvt_pk_bf16_f32 v79, v94, v95
s_waitcnt lgkmcnt(6)
M v[160:163], a[116:119], v[32:35], v[160:163]
v_exp_f32 v96, v96
M v[160:163], a[120:123], v[64:67], v[160:163]
ds_read_b128 a[148:151], v2 offset:36864
ds_read_b128 a[152:155], v2 offset:45056
M v[164:167], a[120:123], v[68:71], v[164:167]
v_exp_f32 v97, v97
M v[164:167], a[116:119], v[36:39], v[164:167]
v_cvt_pk_bf16_f32 v96, v96, v97
M v[168:171], a[116:119], v[40:43], v[168:171]
v_exp_f32 v98, v98
M v[168:171], a[120:123], v[72:75], v[168:171]
s_add_u32 s25, s25, 32768
s_cmp_eq_u32 s25, s27
M v[172:175], a[120:123], v[76:79], v[172:175]
v_exp_f32 v99, v99
M v[172:175], a[116:119], v[44:47], v[172:175]
v_cvt_pk_bf16_f32 v97, v98, v99
s_waitcnt lgkmcnt(6)
M a[96:99], a[112:115], v[32:35], a[96:99]
s_cselect_b32 s25, s28, s25
s_cselect_b32 s27, -1, s27
M a[96:99], a[112:115], v[64:67], a[96:99]
s_add_u32 s26, s26, 32768
s_cmp_eq_u32 s26, s62
M v[176:179], a[124:127], v[32:35], v[176:179]
v_exp_f32 v112, v112
M v[176:179], a[128:131], v[64:67], v[176:179]
ds_read_b128 a[156:159], v2 offset:37888
ds_read_b128 a[160:163], v2 offset:46080
M v[180:183], a[128:131], v[68:71], v[180:183]
v_exp_f32 v113, v113
M v[180:183], a[124:127], v[36:39], v[180:183]
v_cvt_pk_bf16_f32 v98, v112, v113
M v[184:187], a[124:127], v[40:43], v[184:187]
v_exp_f32 v114, v114
M v[184:187], a[128:131], v[72:75], v[184:187]
s_cselect_b32 s26, s63, s26
s_cselect_b32 s62, -1, s62
M v[188:191], a[128:131], v[76:79], v[188:191]
v_exp_f32 v115, v115
M v[188:191], a[124:127], v[44:47], v[188:191]
v_cvt_pk_bf16_f32 v99, v114, v115
s_waitcnt lgkmcnt(6)
M a[100:103], a[112:115], v[36:39], a[100:103]
M a[100:103], a[112:115], v[68:71], a[100:103]
M v[192:195], a[132:135], v[32:35], v[192:195]
v_exp_f32 v100, v100
M v[192:195], a[136:139], v[64:67], v[192:195]
ds_read_b128 a[164:167], v2 offset:38912
ds_read_b128 a[168:171], v2 offset:47104
M v[196:199], a[136:139], v[68:71], v[196:199]
v_exp_f32 v101, v101
M v[196:199], a[132:135], v[36:39], v[196:199]
v_cvt_pk_bf16_f32 v100, v100, v101
M v[200:203], a[132:135], v[40:43], v[200:203]
v_exp_f32 v102, v102
M v[200:203], a[136:139], v[72:75], v[200:203]
M v[204:207], a[136:139], v[76:79], v[204:207]
v_exp_f32 v103, v103
M v[204:207], a[132:135], v[44:47], v[204:207]
v_cvt_pk_bf16_f32 v101, v102, v103
s_waitcnt lgkmcnt(6)
M a[104:107], a[112:115], v[40:43], a[104:107]
M a[104:107], a[112:115], v[72:75], a[104:107]
M v[208:211], a[140:143], v[32:35], v[208:211]
v_exp_f32 v116, v116
M v[208:211], a[144:147], v[64:67], v[208:211]
ds_read_b128 a[172:175], v2 offset:39936
ds_read_b128 a[176:179], v2 offset:48128
M v[212:215], a[144:147], v[68:71], v[212:215]
v_exp_f32 v117, v117
M v[212:215], a[140:143], v[36:39], v[212:215]
v_cvt_pk_bf16_f32 v102, v116, v117
M v[216:219], a[140:143], v[40:43], v[216:219]
v_exp_f32 v118, v118
M v[216:219], a[144:147], v[72:75], v[216:219]
M v[220:223], a[144:147], v[76:79], v[220:223]
v_exp_f32 v119, v119
M v[220:223], a[140:143], v[44:47], v[220:223]
v_cvt_pk_bf16_f32 v103, v118, v119
s_waitcnt lgkmcnt(6)
M a[108:111], a[112:115], v[44:47], a[108:111]
M a[108:111], a[112:115], v[76:79], a[108:111]
M v[224:227], a[148:151], v[32:35], v[224:227]
v_exp_f32 v104, v104
M v[224:227], a[152:155], v[64:67], v[224:227]
M v[228:231], a[152:155], v[68:71], v[228:231]
v_exp_f32 v105, v105
M v[228:231], a[148:151], v[36:39], v[228:231]
v_cvt_pk_bf16_f32 v104, v104, v105
M v[232:235], a[148:151], v[40:43], v[232:235]
v_exp_f32 v106, v106
M v[232:235], a[152:155], v[72:75], v[232:235]
M v[236:239], a[152:155], v[76:79], v[236:239]
v_exp_f32 v107, v107
M v[236:239], a[148:151], v[44:47], v[236:239]
v_cvt_pk_bf16_f32 v105, v106, v107
s_waitcnt lgkmcnt(4)
M v[240:243], a[156:159], v[32:35], v[240:243]
v_exp_f32 v120, v120
M v[240:243], a[160:163], v[64:67], v[240:243]
M v[244:247], a[160:163], v[68:71], v[244:247]
v_exp_f32 v121, v121
M v[244:247], a[156:159], v[36:39], v[244:247]
v_cvt_pk_bf16_f32 v106, v120, v121
M v[248:251], a[156:159], v[40:43], v[248:251]
v_exp_f32 v122, v122
M v[248:251], a[160:163], v[72:75], v[248:251]
s_waitcnt vmcnt(0) lgkmcnt(0)
s_barrier
ds_read_b128 a[116:119], v3 offset:0
ds_read_b128 a[120:123], v3 offset:1024
M v[252:255], a[160:163], v[76:79], v[252:255]
v_exp_f32 v123, v123
M v[252:255], a[156:159], v[44:47], v[252:255]
v_cvt_pk_bf16_f32 v107, v122, v123
M a[64:67], a[164:167], v[32:35], a[64:67]
v_exp_f32 v108, v108
M a[64:67], a[168:171], v[64:67], a[64:67]
ds_read_b128 a[124:127], v3 offset:2048
ds_read_b128 a[128:131], v3 offset:3072
M a[68:71], a[168:171], v[68:71], a[68:71]
v_exp_f32 v109, v109
M a[68:71], a[164:167], v[36:39], a[68:71]
v_cvt_pk_bf16_f32 v108, v108, v109
M a[72:75], a[164:167], v[40:43], a[72:75]
v_exp_f32 v110, v110
M a[72:75], a[168:171], v[72:75], a[72:75]
ds_read_b128 a[132:135], v3 offset:4096
ds_read_b128 a[136:139], v3 offset:5120
M a[76:79], a[168:171], v[76:79], a[76:79]
v_exp_f32 v111, v111
M a[76:79], a[164:167], v[44:47], a[76:79]
v_cvt_pk_bf16_f32 v109, v110, v111
M a[80:83], a[172:175], v[32:35], a[80:83]
v_exp_f32 v124, v124
M a[80:83], a[176:179], v[64:67], a[80:83]
ds_read_b128 a[140:143], v3 offset:6144
ds_read_b128 a[144:147], v3 offset:7168
M a[84:87], a[176:179], v[68:71], a[84:87]
v_exp_f32 v125, v125
M a[84:87], a[172:175], v[36:39], a[84:87]
v_cvt_pk_bf16_f32 v110, v124, v125
M a[88:91], a[172:175], v[40:43], a[88:91]
v_exp_f32 v126, v126
M a[88:91], a[176:179], v[72:75], a[88:91]
M a[92:95], a[176:179], v[76:79], a[92:95]
v_exp_f32 v127, v127
M a[92:95], a[172:175], v[44:47], a[92:95]
v_cvt_pk_bf16_f32 v111, v126, v127
s_sub_u32 s30, s30, 1
s_cmp_eq_u32 s30, 0
s_cbranch_scc1 Lk2_m1
s_add_u32 m0, s29, 0
s_waitcnt lgkmcnt(4)
M v[32:35], a[116:119], a[0:3], 0
v_exp_f32 v128, v128
M v[32:35], a[120:123], a[4:7], v[32:35]
ds_read_b128 a[148:151], v3 offset:8192
ds_read_b128 a[152:155], v3 offset:9216
M v[32:35], a[124:127], a[8:11], v[32:35]
v_exp_f32 v129, v129
M v[32:35], a[128:131], a[12:15], v[32:35]
buffer_load_dwordx4 v1, s[12:15], s25 offen offset:0 sc1 lds
s_add_u32 s32, s25, 4096
M v[36:39], a[128:131], a[28:31], 0
v_exp_f32 v130, v130
M v[36:39], a[124:127], a[24:27], v[36:39]
v_cvt_pk_bf16_f32 v128, v128, v129
M v[36:39], a[120:123], a[20:23], v[36:39]
v_exp_f32 v131, v131
M v[36:39], a[116:119], a[16:19], v[36:39]
buffer_load_dwordx4 v1, s[12:15], s25 offen offset:1024 sc1 lds
M v[40:43], a[116:119], a[32:35], 0
v_exp_f32 v144, v144
M v[40:43], a[120:123], a[36:39], v[40:43]
ds_read_b128 a[156:159], v3 offset:10240
ds_read_b128 a[160:163], v3 offset:11264
M v[40:43], a[124:127], a[40:43], v[40:43]
v_exp_f32 v145, v145
M v[40:43], a[128:131], a[44:47], v[40:43]
buffer_load_dwordx4 v1, s[12:15], s25 offen offset:2048 sc1 lds
M v[44:47], a[128:131], a[60:63], 0
v_exp_f32 v146, v146
M v[44:47], a[124:127], a[56:59], v[44:47]
v_cvt_pk_bf16_f32 v129, v130, v131
v_cvt_pk_bf16_f32 v130, v144, v145
M v[44:47], a[120:123], a[52:55], v[44:47]
v_exp_f32 v147, v147
M v[44:47], a[116:119], a[48:51], v[44:47]
buffer_load_dwordx4 v1, s[12:15], s25 offen offset:3072 sc1 lds
s_add_u32 m0, s29, 4096
s_waitcnt lgkmcnt(4)
M v[48:51], a[132:135], a[0:3], 0
v_exp_f32 v132, v132
M v[48:51], a[136:139], a[4:7], v[48:51]
ds_read_b128 a[164:167], v3 offset:12288
ds_read_b128 a[168:171], v3 offset:13312
M v[48:51], a[140:143], a[8:11], v[48:51]
v_exp_f32 v133, v133
M v[48:51], a[144:147], a[12:15], v[48:51]
buffer_load_dwordx4 v1, s[12:15], s32 offen offset:0 sc1 lds
M v[52:55], a[144:147], a[28:31], 0
v_exp_f32 v134, v134
M v[52:55], a[140:143], a[24:27], v[52:55]
v_cvt_pk_bf16_f32 v131, v146, v147
v_cvt_pk_bf16_f32 v132, v132, v133
M v[52:55], a[136:139], a[20:23], v[52:55]
v_exp_f32 v135, v135
M v[52:55], a[132:135], a[16:19], v[52:55]
buffer_load_dwordx4 v1, s[12:15], s32 offen offset:1024 sc1 lds
M v[56:59], a[132:135], a[32:35], 0
v_exp_f32 v148, v148
M v[56:59], a[136:139], a[36:39], v[56:59]
ds_read_b128 a[172:175], v3 offset:14336
ds_read_b128 a[176:179], v3 offset:15360
M v[56:59], a[140:143], a[40:43], v[56:59]
v_exp_f32 v149, v149
M v[56:59], a[144:147], a[44:47], v[56:59]
buffer_load_dwordx4 v1, s[12:15], s32 offen offset:2048 sc1 lds
M v[60:63], a[144:147], a[60:63], 0
v_exp_f32 v150, v150
M v[60:63], a[140:143], a[56:59], v[60:63]
v_cvt_pk_bf16_f32 v133, v134, v135
v_cvt_pk_bf16_f32 v134, v148, v149
M v[60:63], a[136:139], a[52:55], v[60:63]
v_exp_f32 v151, v151
M v[60:63], a[132:135], a[48:51], v[60:63]
buffer_load_dwordx4 v1, s[12:15], s32 offen offset:3072 sc1 lds
s_add_u32 m0, s29, 32768
s_waitcnt lgkmcnt(4)
M v[64:67], a[148:151], a[0:3], 0
v_exp_f32 v136, v136
M v[64:67], a[152:155], a[4:7], v[64:67]
ds_read_b128 a[116:119], v3 offset:32768
ds_read_b128 a[120:123], v3 offset:40960
M v[64:67], a[156:159], a[8:11], v[64:67]
v_exp_f32 v137, v137
M v[64:67], a[160:163], a[12:15], v[64:67]
buffer_load_dwordx4 v1, s[12:15], s26 offen offset:0 sc1 lds
s_add_u32 s43, s26, 4096
M v[68:71], a[160:163], a[28:31], 0
v_exp_f32 v138, v138
M v[68:71], a[156:159], a[24:27], v[68:71]
v_cvt_pk_bf16_f32 v135, v150, v151
v_cvt_pk_bf16_f32 v136, v136, v137
M v[68:71], a[152:155], a[20:23], v[68:71]
v_exp_f32 v139, v139
M v[68:71], a[148:151], a[16:19], v[68:71]
buffer_load_dwordx4 v1, s[12:15], s26 offen offset:1024 sc1 lds
M v[72:75], a[148:151], a[32:35], 0
v_exp_f32 v152, v152
M v[72:75], a[152:155], a[36:39], v[72:75]
ds_read_b128 a[124:127], v3 offset:33792
ds_read_b128 a[128:131], v3 offset:41984
M v[72:75], a[156:159], a[40:43], v[72:75]
v_exp_f32 v153, v153
M v[72:75], a[160:163], a[44:47], v[72:75]
buffer_load_dwordx4 v1, s[12:15], s26 offen offset:2048 sc1 lds
M v[76:79], a[160:163], a[60:63], 0
v_exp_f32 v154, v154
M v[76:79], a[156:159], a[56:59], v[76:79]
v_cvt_pk_bf16_f32 v137, v138, v139
v_cvt_pk_bf16_f32 v138, v152, v153
M v[76:79], a[152:155], a[52:55], v[76:79]
v_exp_f32 v155, v155
M v[76:79], a[148:151], a[48:51], v[76:79]
buffer_load_dwordx4 v1, s[12:15], s26 offen offset:3072 sc1 lds
s_add_u32 m0, s29, 36864
s_waitcnt lgkmcnt(4)
M v[80:83], a[164:167], a[0:3], 0
v_exp_f32 v140, v140
M v[80:83], a[168:171], a[4:7], v[80:83]
ds_read_b128 a[132:135], v3 offset:34816
ds_read_b128 a[136:139], v3 offset:43008
M v[80:83], a[172:175], a[8:11], v[80:83]
v_exp_f32 v141, v141
M v[80:83], a[176:179], a[12:15], v[80:83]
buffer_load_dwordx4 v1, s[12:15], s43 offen offset:0 sc1 lds
M v[84:87], a[176:179], a[28:31], 0
v_exp_f32 v142, v142
M v[84:87], a[172:175], a[24:27], v[84:87]
v_cvt_pk_bf16_f32 v139, v154, v155
v_cvt_pk_bf16_f32 v140, v140, v141
M v[84:87], a[168:171], a[20:23], v[84:87]
v_exp_f32 v143, v143
M v[84:87], a[164:167], a[16:19], v[84:87]
buffer_load_dwordx4 v1, s[12:15], s43 offen offset:1024 sc1 lds
M v[88:91], a[164:167], a[32:35], 0
v_exp_f32 v156, v156
M v[88:91], a[168:171], a[36:39], v[88:91]
ds_read_b128 a[140:143], v3 offset:35840
ds_read_b128 a[144:147], v3 offset:44032
M v[88:91], a[172:175], a[40:43], v[88:91]
v_exp_f32 v157, v157
M v[88:91], a[176:179], a[44:47], v[88:91]
buffer_load_dwordx4 v1, s[12:15], s43 offen offset:2048 sc1 lds
M v[92:95], a[176:179], a[60:63], 0
v_exp_f32 v158, v158
M v[92:95], a[172:175], a[56:59], v[92:95]
v_cvt_pk_bf16_f32 v141, v142, v143
v_cvt_pk_bf16_f32 v142, v156, v157
M v[92:95], a[168:171], a[52:55], v[92:95]
v_exp_f32 v159, v159
M v[92:95], a[164:167], a[48:51], v[92:95]
buffer_load_dwordx4 v1, s[12:15], s43 offen offset:3072 sc1 lds
v_cvt_pk_bf16_f32 v143, v158, v159
s_waitcnt lgkmcnt(6)
M v[160:163], a[116:119], v[96:99], v[160:163]
v_exp_f32 v32, v32
M v[160:163], a[120:123], v[128:131], v[160:163]
ds_read_b128 a[148:151], v3 offset:36864
ds_read_b128 a[152:155], v3 offset:45056
M v[164:167], a[120:123], v[132:135], v[164:167]
v_exp_f32 v33, v33
M v[164:167], a[116:119], v[100:103], v[164:167]
v_cvt_pk_bf16_f32 v32, v32, v33
M v[168:171], a[116:119], v[104:107], v[168:171]
v_exp_f32 v34, v34
M v[168:171], a[120:123], v[136:139], v[168:171]
s_add_u32 s25, s25, 32768
s_cmp_eq_u32 s25, s27
M v[172:175], a[120:123], v[140:143], v[172:175]
v_exp_f32 v35, v35
M v[172:175], a[116:119], v[108:111], v[172:175]
v_cvt_pk_bf16_f32 v33, v34, v35
s_waitcnt lgkmcnt(6)
M a[96:99], a[112:115], v[96:99], a[96:99]
s_cselect_b32 s25, s28, s25
s_cselect_b32 s27, -1, s27
M a[96:99], a[112:115], v[128:131], a[96:99]
s_add_u32 s26, s26, 32768
s_cmp_eq_u32 s26, s62
M v[176:179], a[124:127], v[96:99], v[176:179]
v_exp_f32 v48, v48
M v[176:179], a[128:131], v[128:131], v[176:179]
ds_read_b128 a[156:159], v3 offset:37888
ds_read_b128 a[160:163], v3 offset:46080
M v[180:183], a[128:131], v[132:135], v[180:183]
v_exp_f32 v49, v49
M v[180:183], a[124:127], v[100:103], v[180:183]
v_cvt_pk_bf16_f32 v34, v48, v49
M v[184:187], a[124:127], v[104:107], v[184:187]
v_exp_f32 v50, v50
M v[184:187], a[128:131], v[136:139], v[184:187]
s_cselect_b32 s26, s63, s26
s_cselect_b32 s62, -1, s62
M v[188:191], a[128:131], v[140:143], v[188:191]
v_exp_f32 v51, v51
M v[188:191], a[124:127], v[108:111], v[188:191]
v_cvt_pk_bf16_f32 v35, v50, v51
s_waitcnt lgkmcnt(6)
M a[100:103], a[112:115], v[100:103], a[100:103]
M a[100:103], a[112:115], v[132:135], a[100:103]
M v[192:195], a[132:135], v[96:99], v[192:195]
v_exp_f32 v36, v36
M v[192:195], a[136:139], v[128:131], v[192:195]
ds_read_b128 a[164:167], v3 offset:38912
ds_read_b128 a[168:171], v3 offset:47104
M v[196:199], a[136:139], v[132:135], v[196:199]
v_exp_f32 v37, v37
M v[196:199], a[132:135], v[100:103], v[196:199]
v_cvt_pk_bf16_f32 v36, v36, v37
M v[200:203], a[132:135], v[104:107], v[200:203]
v_exp_f32 v38, v38
M v[200:203], a[136:139], v[136:139], v[200:203]
M v[204:207], a[136:139], v[140:143], v[204:207]
v_exp_f32 v39, v39
M v[204:207], a[132:135], v[108:111], v[204:207]
v_cvt_pk_bf16_f32 v37, v38, v39
s_waitcnt lgkmcnt(6)
M a[104:107], a[112:115], v[104:107], a[104:107]
M a[104:107], a[112:115], v[136:139], a[104:107]
M v[208:211], a[140:143], v[96:99], v[208:211]
v_exp_f32 v52, v52
M v[208:211], a[144:147], v[128:131], v[208:211]
ds_read_b128 a[172:175], v3 offset:39936
ds_read_b128 a[176:179], v3 offset:48128
M v[212:215], a[144:147], v[132:135], v[212:215]
v_exp_f32 v53, v53
M v[212:215], a[140:143], v[100:103], v[212:215]
v_cvt_pk_bf16_f32 v38, v52, v53
M v[216:219], a[140:143], v[104:107], v[216:219]
v_exp_f32 v54, v54
M v[216:219], a[144:147], v[136:139], v[216:219]
M v[220:223], a[144:147], v[140:143], v[220:223]
v_exp_f32 v55, v55
M v[220:223], a[140:143], v[108:111], v[220:223]
v_cvt_pk_bf16_f32 v39, v54, v55
s_waitcnt lgkmcnt(6)
M a[108:111], a[112:115], v[108:111], a[108:111]
M a[108:111], a[112:115], v[140:143], a[108:111]
M v[224:227], a[148:151], v[96:99], v[224:227]
v_exp_f32 v40, v40
M v[224:227], a[152:155], v[128:131], v[224:227]
M v[228:231], a[152:155], v[132:135], v[228:231]
v_exp_f32 v41, v41
M v[228:231], a[148:151], v[100:103], v[228:231]
v_cvt_pk_bf16_f32 v40, v40, v41
M v[232:235], a[148:151], v[104:107], v[232:235]
v_exp_f32 v42, v42
M v[232:235], a[152:155], v[136:139], v[232:235]
M v[236:239], a[152:155], v[140:143], v[236:239]
v_exp_f32 v43, v43
M v[236:239], a[148:151], v[108:111], v[236:239]
v_cvt_pk_bf16_f32 v41, v42, v43
s_waitcnt lgkmcnt(4)
M v[240:243], a[156:159], v[96:99], v[240:243]
v_exp_f32 v56, v56
M v[240:243], a[160:163], v[128:131], v[240:243]
M v[244:247], a[160:163], v[132:135], v[244:247]
v_exp_f32 v57, v57
M v[244:247], a[156:159], v[100:103], v[244:247]
v_cvt_pk_bf16_f32 v42, v56, v57
M v[248:251], a[156:159], v[104:107], v[248:251]
v_exp_f32 v58, v58
M v[248:251], a[160:163], v[136:139], v[248:251]
s_waitcnt vmcnt(0) lgkmcnt(0)
s_barrier
ds_read_b128 a[116:119], v2 offset:0
ds_read_b128 a[120:123], v2 offset:1024
M v[252:255], a[160:163], v[140:143], v[252:255]
v_exp_f32 v59, v59
M v[252:255], a[156:159], v[108:111], v[252:255]
v_cvt_pk_bf16_f32 v43, v58, v59
M a[64:67], a[164:167], v[96:99], a[64:67]
v_exp_f32 v44, v44
M a[64:67], a[168:171], v[128:131], a[64:67]
ds_read_b128 a[124:127], v2 offset:2048
ds_read_b128 a[128:131], v2 offset:3072
M a[68:71], a[168:171], v[132:135], a[68:71]
v_exp_f32 v45, v45
M a[68:71], a[164:167], v[100:103], a[68:71]
v_cvt_pk_bf16_f32 v44, v44, v45
M a[72:75], a[164:167], v[104:107], a[72:75]
v_exp_f32 v46, v46
M a[72:75], a[168:171], v[136:139], a[72:75]
ds_read_b128 a[132:135], v2 offset:4096
ds_read_b128 a[136:139], v2 offset:5120
M a[76:79], a[168:171], v[140:143], a[76:79]
v_exp_f32 v47, v47
M a[76:79], a[164:167], v[108:111], a[76:79]
v_cvt_pk_bf16_f32 v45, v46, v47
M a[80:83], a[172:175], v[96:99], a[80:83]
v_exp_f32 v60, v60
M a[80:83], a[176:179], v[128:131], a[80:83]
ds_read_b128 a[140:143], v2 offset:6144
ds_read_b128 a[144:147], v2 offset:7168
M a[84:87], a[176:179], v[132:135], a[84:87]
v_exp_f32 v61, v61
M a[84:87], a[172:175], v[100:103], a[84:87]
v_cvt_pk_bf16_f32 v46, v60, v61
M a[88:91], a[172:175], v[104:107], a[88:91]
v_exp_f32 v62, v62
M a[88:91], a[176:179], v[136:139], a[88:91]
M a[92:95], a[176:179], v[140:143], a[92:95]
v_exp_f32 v63, v63
M a[92:95], a[172:175], v[108:111], a[92:95]
v_cvt_pk_bf16_f32 v47, v62, v63
s_branch Lk2_l1
Lk2_m1:
s_lshl_b32 s33, s23, 6
s_add_i32 s33, s33, 0
s_cmp_gt_i32 s33, 0
s_cselect_b32 s34, 0, 0xf149f2ca
s_cmp_lt_i32 s33, 0
s_cselect_b32 s33, 0xf149f2ca, 0
v_mov_b32 v20, s34
v_mov_b32 v21, s34
v_mov_b32 v22, s34
v_mov_b32 v23, s34
v_mov_b32 v28, s33
v_mov_b32 v29, s33
v_mov_b32 v30, s33
v_mov_b32 v31, s33
v_med3_f32 v24, v16, v20, v28
v_med3_f32 v25, v17, v20, v28
v_med3_f32 v26, v18, v20, v28
v_med3_f32 v27, v19, v20, v28
s_add_u32 m0, s29, 0
s_waitcnt lgkmcnt(4)
M v[32:35], a[116:119], a[0:3], v[24:27]
v_exp_f32 v128, v128
M v[32:35], a[120:123], a[4:7], v[32:35]
ds_read_b128 a[148:151], v3 offset:8192
ds_read_b128 a[152:155], v3 offset:9216
M v[32:35], a[124:127], a[8:11], v[32:35]
v_exp_f32 v129, v129
M v[32:35], a[128:131], a[12:15], v[32:35]
buffer_load_dwordx4 v1, s[12:15], s25 offen offset:0 sc1 lds
s_add_u32 s32, s25, 4096
M v[36:39], a[128:131], a[28:31], v[28:31]
v_exp_f32 v130, v130
M v[36:39], a[124:127], a[24:27], v[36:39]
v_cvt_pk_bf16_f32 v128, v128, v129
M v[36:39], a[120:123], a[20:23], v[36:39]
v_exp_f32 v131, v131
M v[36:39], a[116:119], a[16:19], v[36:39]
buffer_load_dwordx4 v1, s[12:15], s25 offen offset:1024 sc1 lds
M v[40:43], a[116:119], a[32:35], v[28:31]
v_exp_f32 v144, v144
M v[40:43], a[120:123], a[36:39], v[40:43]
ds_read_b128 a[156:159], v3 offset:10240
ds_read_b128 a[160:163], v3 offset:11264
M v[40:43], a[124:127], a[40:43], v[40:43]
v_exp_f32 v145, v145
M v[40:43], a[128:131], a[44:47], v[40:43]
buffer_load_dwordx4 v1, s[12:15], s25 offen offset:2048 sc1 lds
M v[44:47], a[128:131], a[60:63], v[28:31]
v_exp_f32 v146, v146
M v[44:47], a[124:127], a[56:59], v[44:47]
v_cvt_pk_bf16_f32 v129, v130, v131
v_cvt_pk_bf16_f32 v130, v144, v145
M v[44:47], a[120:123], a[52:55], v[44:47]
v_exp_f32 v147, v147
M v[44:47], a[116:119], a[48:51], v[44:47]
buffer_load_dwordx4 v1, s[12:15], s25 offen offset:3072 sc1 lds
s_add_u32 m0, s29, 4096
s_waitcnt lgkmcnt(4)
M v[48:51], a[132:135], a[0:3], v[20:23]
v_exp_f32 v132, v132
M v[48:51], a[136:139], a[4:7], v[48:51]
ds_read_b128 a[164:167], v3 offset:12288
ds_read_b128 a[168:171], v3 offset:13312
M v[48:51], a[140:143], a[8:11], v[48:51]
v_exp_f32 v133, v133
M v[48:51], a[144:147], a[12:15], v[48:51]
buffer_load_dwordx4 v1, s[12:15], s32 offen offset:0 sc1 lds
M v[52:55], a[144:147], a[28:31], v[24:27]
v_exp_f32 v134, v134
M v[52:55], a[140:143], a[24:27], v[52:55]
v_cvt_pk_bf16_f32 v131, v146, v147
v_cvt_pk_bf16_f32 v132, v132, v133
M v[52:55], a[136:139], a[20:23], v[52:55]
v_exp_f32 v135, v135
M v[52:55], a[132:135], a[16:19], v[52:55]
buffer_load_dwordx4 v1, s[12:15], s32 offen offset:1024 sc1 lds
M v[56:59], a[132:135], a[32:35], v[28:31]
v_exp_f32 v148, v148
M v[56:59], a[136:139], a[36:39], v[56:59]
ds_read_b128 a[172:175], v3 offset:14336
ds_read_b128 a[176:179], v3 offset:15360
M v[56:59], a[140:143], a[40:43], v[56:59]
v_exp_f32 v149, v149
M v[56:59], a[144:147], a[44:47], v[56:59]
buffer_load_dwordx4 v1, s[12:15], s32 offen offset:2048 sc1 lds
M v[60:63], a[144:147], a[60:63], v[28:31]
v_exp_f32 v150, v150
M v[60:63], a[140:143], a[56:59], v[60:63]
v_cvt_pk_bf16_f32 v133, v134, v135
v_cvt_pk_bf16_f32 v134, v148, v149
M v[60:63], a[136:139], a[52:55], v[60:63]
v_exp_f32 v151, v151
M v[60:63], a[132:135], a[48:51], v[60:63]
buffer_load_dwordx4 v1, s[12:15], s32 offen offset:3072 sc1 lds
s_add_u32 m0, s29, 32768
s_waitcnt lgkmcnt(4)
M v[64:67], a[148:151], a[0:3], v[20:23]
v_exp_f32 v136, v136
M v[64:67], a[152:155], a[4:7], v[64:67]
ds_read_b128 a[116:119], v3 offset:32768
ds_read_b128 a[120:123], v3 offset:40960
M v[64:67], a[156:159], a[8:11], v[64:67]
v_exp_f32 v137, v137
M v[64:67], a[160:163], a[12:15], v[64:67]
buffer_load_dwordx4 v1, s[12:15], s26 offen offset:0 sc1 lds
s_add_u32 s43, s26, 4096
M v[68:71], a[160:163], a[28:31], v[20:23]
v_exp_f32 v138, v138
M v[68:71], a[156:159], a[24:27], v[68:71]
v_cvt_pk_bf16_f32 v135, v150, v151
v_cvt_pk_bf16_f32 v136, v136, v137
M v[68:71], a[152:155], a[20:23], v[68:71]
v_exp_f32 v139, v139
M v[68:71], a[148:151], a[16:19], v[68:71]
buffer_load_dwordx4 v1, s[12:15], s26 offen offset:1024 sc1 lds
M v[72:75], a[148:151], a[32:35], v[24:27]
v_exp_f32 v152, v152
M v[72:75], a[152:155], a[36:39], v[72:75]
ds_read_b128 a[124:127], v3 offset:33792
ds_read_b128 a[128:131], v3 offset:41984
M v[72:75], a[156:159], a[40:43], v[72:75]
v_exp_f32 v153, v153
M v[72:75], a[160:163], a[44:47], v[72:75]
buffer_load_dwordx4 v1, s[12:15], s26 offen offset:2048 sc1 lds
M v[76:79], a[160:163], a[60:63], v[28:31]
v_exp_f32 v154, v154
M v[76:79], a[156:159], a[56:59], v[76:79]
v_cvt_pk_bf16_f32 v137, v138, v139
v_cvt_pk_bf16_f32 v138, v152, v153
M v[76:79], a[152:155], a[52:55], v[76:79]
v_exp_f32 v155, v155
M v[76:79], a[148:151], a[48:51], v[76:79]
buffer_load_dwordx4 v1, s[12:15], s26 offen offset:3072 sc1 lds
s_add_u32 m0, s29, 36864
s_waitcnt lgkmcnt(4)
M v[80:83], a[164:167], a[0:3], v[20:23]
v_exp_f32 v140, v140
M v[80:83], a[168:171], a[4:7], v[80:83]
ds_read_b128 a[132:135], v3 offset:34816
ds_read_b128 a[136:139], v3 offset:43008
M v[80:83], a[172:175], a[8:11], v[80:83]
v_exp_f32 v141, v141
M v[80:83], a[176:179], a[12:15], v[80:83]
buffer_load_dwordx4 v1, s[12:15], s43 offen offset:0 sc1 lds
M v[84:87], a[176:179], a[28:31], v[20:23]
v_exp_f32 v142, v142
M v[84:87], a[172:175], a[24:27], v[84:87]
v_cvt_pk_bf16_f32 v139, v154, v155
v_cvt_pk_bf16_f32 v140, v140, v141
M v[84:87], a[168:171], a[20:23], v[84:87]
v_exp_f32 v143, v143
M v[84:87], a[164:167], a[16:19], v[84:87]
buffer_load_dwordx4 v1, s[12:15], s43 offen offset:1024 sc1 lds
M v[88:91], a[164:167], a[32:35], v[20:23]
v_exp_f32 v156, v156
M v[88:91], a[168:171], a[36:39], v[88:91]
ds_read_b128 a[140:143], v3 offset:35840
ds_read_b128 a[144:147], v3 offset:44032
M v[88:91], a[172:175], a[40:43], v[88:91]
v_exp_f32 v157, v157
M v[88:91], a[176:179], a[44:47], v[88:91]
buffer_load_dwordx4 v1, s[12:15], s43 offen offset:2048 sc1 lds
M v[92:95], a[176:179], a[60:63], v[24:27]
v_exp_f32 v158, v158
M v[92:95], a[172:175], a[56:59], v[92:95]
v_cvt_pk_bf16_f32 v141, v142, v143
v_cvt_pk_bf16_f32 v142, v156, v157
M v[92:95], a[168:171], a[52:55], v[92:95]
v_exp_f32 v159, v159
M v[92:95], a[164:167], a[48:51], v[92:95]
buffer_load_dwordx4 v1, s[12:15], s43 offen offset:3072 sc1 lds
v_cvt_pk_bf16_f32 v143, v158, v159
s_waitcnt lgkmcnt(6)
M v[160:163], a[116:119], v[96:99], v[160:163]
v_exp_f32 v32, v32
M v[160:163], a[120:123], v[128:131], v[160:163]
ds_read_b128 a[148:151], v3 offset:36864
ds_read_b128 a[152:155], v3 offset:45056
M v[164:167], a[120:123], v[132:135], v[164:167]
v_exp_f32 v33, v33
M v[164:167], a[116:119], v[100:103], v[164:167]
v_cvt_pk_bf16_f32 v32, v32, v33
M v[168:171], a[116:119], v[104:107], v[168:171]
v_exp_f32 v34, v34
M v[168:171], a[120:123], v[136:139], v[168:171]
s_add_u32 s25, s25, 32768
s_cmp_eq_u32 s25, s27
M v[172:175], a[120:123], v[140:143], v[172:175]
v_exp_f32 v35, v35
M v[172:175], a[116:119], v[108:111], v[172:175]
v_cvt_pk_bf16_f32 v33, v34, v35
s_waitcnt lgkmcnt(6)
M a[96:99], a[112:115], v[96:99], a[96:99]
s_cselect_b32 s25, s28, s25
s_cselect_b32 s27, -1, s27
M a[96:99], a[112:115], v[128:131], a[96:99]
s_add_u32 s26, s26, 32768
s_cmp_eq_u32 s26, s62
M v[176:179], a[124:127], v[96:99], v[176:179]
v_exp_f32 v48, v48
M v[176:179], a[128:131], v[128:131], v[176:179]
ds_read_b128 a[156:159], v3 offset:37888
ds_read_b128 a[160:163], v3 offset:46080
M v[180:183], a[128:131], v[132:135], v[180:183]
v_exp_f32 v49, v49
M v[180:183], a[124:127], v[100:103], v[180:183]
v_cvt_pk_bf16_f32 v34, v48, v49
M v[184:187], a[124:127], v[104:107], v[184:187]
v_exp_f32 v50, v50
M v[184:187], a[128:131], v[136:139], v[184:187]
s_cselect_b32 s26, s63, s26
s_cselect_b32 s62, -1, s62
M v[188:191], a[128:131], v[140:143], v[188:191]
v_exp_f32 v51, v51
M v[188:191], a[124:127], v[108:111], v[188:191]
v_cvt_pk_bf16_f32 v35, v50, v51
s_waitcnt lgkmcnt(6)
M a[100:103], a[112:115], v[100:103], a[100:103]
M a[100:103], a[112:115], v[132:135], a[100:103]
M v[192:195], a[132:135], v[96:99], v[192:195]
v_exp_f32 v36, v36
M v[192:195], a[136:139], v[128:131], v[192:195]
ds_read_b128 a[164:167], v3 offset:38912
ds_read_b128 a[168:171], v3 offset:47104
M v[196:199], a[136:139], v[132:135], v[196:199]
v_exp_f32 v37, v37
M v[196:199], a[132:135], v[100:103], v[196:199]
v_cvt_pk_bf16_f32 v36, v36, v37
M v[200:203], a[132:135], v[104:107], v[200:203]
v_exp_f32 v38, v38
M v[200:203], a[136:139], v[136:139], v[200:203]
M v[204:207], a[136:139], v[140:143], v[204:207]
v_exp_f32 v39, v39
M v[204:207], a[132:135], v[108:111], v[204:207]
v_cvt_pk_bf16_f32 v37, v38, v39
s_waitcnt lgkmcnt(6)
M a[104:107], a[112:115], v[104:107], a[104:107]
M a[104:107], a[112:115], v[136:139], a[104:107]
M v[208:211], a[140:143], v[96:99], v[208:211]
v_exp_f32 v52, v52
M v[208:211], a[144:147], v[128:131], v[208:211]
ds_read_b128 a[172:175], v3 offset:39936
ds_read_b128 a[176:179], v3 offset:48128
M v[212:215], a[144:147], v[132:135], v[212:215]
v_exp_f32 v53, v53
M v[212:215], a[140:143], v[100:103], v[212:215]
v_cvt_pk_bf16_f32 v38, v52, v53
M v[216:219], a[140:143], v[104:107], v[216:219]
v_exp_f32 v54, v54
M v[216:219], a[144:147], v[136:139], v[216:219]
M v[220:223], a[144:147], v[140:143], v[220:223]
v_exp_f32 v55, v55
M v[220:223], a[140:143], v[108:111], v[220:223]
v_cvt_pk_bf16_f32 v39, v54, v55
s_waitcnt lgkmcnt(6)
M a[108:111], a[112:115], v[108:111], a[108:111]
M a[108:111], a[112:115], v[140:143], a[108:111]
M v[224:227], a[148:151], v[96:99], v[224:227]
v_exp_f32 v40, v40
M v[224:227], a[152:155], v[128:131], v[224:227]
M v[228:231], a[152:155], v[132:135], v[228:231]
v_exp_f32 v41, v41
M v[228:231], a[148:151], v[100:103], v[228:231]
v_cvt_pk_bf16_f32 v40, v40, v41
M v[232:235], a[148:151], v[104:107], v[232:235]
v_exp_f32 v42, v42
M v[232:235], a[152:155], v[136:139], v[232:235]
M v[236:239], a[152:155], v[140:143], v[236:239]
v_exp_f32 v43, v43
M v[236:239], a[148:151], v[108:111], v[236:239]
v_cvt_pk_bf16_f32 v41, v42, v43
s_waitcnt lgkmcnt(4)
M v[240:243], a[156:159], v[96:99], v[240:243]
v_exp_f32 v56, v56
M v[240:243], a[160:163], v[128:131], v[240:243]
M v[244:247], a[160:163], v[132:135], v[244:247]
v_exp_f32 v57, v57
M v[244:247], a[156:159], v[100:103], v[244:247]
v_cvt_pk_bf16_f32 v42, v56, v57
M v[248:251], a[156:159], v[104:107], v[248:251]
v_exp_f32 v58, v58
M v[248:251], a[160:163], v[136:139], v[248:251]
s_waitcnt vmcnt(0) lgkmcnt(0)
s_barrier
ds_read_b128 a[116:119], v2 offset:0
ds_read_b128 a[120:123], v2 offset:1024
M v[252:255], a[160:163], v[140:143], v[252:255]
v_exp_f32 v59, v59
M v[252:255], a[156:159], v[108:111], v[252:255]
v_cvt_pk_bf16_f32 v43, v58, v59
M a[64:67], a[164:167], v[96:99], a[64:67]
v_exp_f32 v44, v44
M a[64:67], a[168:171], v[128:131], a[64:67]
ds_read_b128 a[124:127], v2 offset:2048
ds_read_b128 a[128:131], v2 offset:3072
M a[68:71], a[168:171], v[132:135], a[68:71]
v_exp_f32 v45, v45
M a[68:71], a[164:167], v[100:103], a[68:71]
v_cvt_pk_bf16_f32 v44, v44, v45
M a[72:75], a[164:167], v[104:107], a[72:75]
v_exp_f32 v46, v46
M a[72:75], a[168:171], v[136:139], a[72:75]
ds_read_b128 a[132:135], v2 offset:4096
ds_read_b128 a[136:139], v2 offset:5120
M a[76:79], a[168:171], v[140:143], a[76:79]
v_exp_f32 v47, v47
M a[76:79], a[164:167], v[108:111], a[76:79]
v_cvt_pk_bf16_f32 v45, v46, v47
M a[80:83], a[172:175], v[96:99], a[80:83]
v_exp_f32 v60, v60
M a[80:83], a[176:179], v[128:131], a[80:83]
ds_read_b128 a[140:143], v2 offset:6144
ds_read_b128 a[144:147], v2 offset:7168
M a[84:87], a[176:179], v[132:135], a[84:87]
v_exp_f32 v61, v61
M a[84:87], a[172:175], v[100:103], a[84:87]
v_cvt_pk_bf16_f32 v46, v60, v61
M a[88:91], a[172:175], v[104:107], a[88:91]
v_exp_f32 v62, v62
M a[88:91], a[176:179], v[136:139], a[88:91]
M a[92:95], a[176:179], v[140:143], a[92:95]
v_exp_f32 v63, v63
M a[92:95], a[172:175], v[108:111], a[92:95]
v_cvt_pk_bf16_f32 v47, v62, v63
Lk2_m2:
s_sub_u32 s35, 15, s21
s_lshl_b32 s33, s20, 7
s_lshl_b32 s34, s35, 3
s_add_u32 s33, s33, s34
s_lshl_b32 s34, s23, 2
s_add_u32 s33, s33, s34
s_lshl_b32 s33, s33, 12
buffer_load_dwordx4 a[180:183], v1, s[8:11], s33 offen offset:0 sc1
buffer_load_dwordx4 a[184:187], v1, s[8:11], s33 offen offset:1024 sc1
buffer_load_dwordx4 a[188:191], v1, s[8:11], s33 offen offset:2048 sc1
buffer_load_dwordx4 a[192:195], v1, s[8:11], s33 offen offset:3072 sc1
s_add_u32 s33, s33, 4096
buffer_load_dwordx4 a[196:199], v1, s[8:11], s33 offen offset:0 sc1
buffer_load_dwordx4 a[200:203], v1, s[8:11], s33 offen offset:1024 sc1
buffer_load_dwordx4 a[204:207], v1, s[8:11], s33 offen offset:2048 sc1
buffer_load_dwordx4 a[208:211], v1, s[8:11], s33 offen offset:3072 sc1
s_add_u32 s33, s33, 4096
buffer_load_dwordx4 a[212:215], v1, s[8:11], s33 offen offset:0 sc1
buffer_load_dwordx4 a[216:219], v1, s[8:11], s33 offen offset:1024 sc1
buffer_load_dwordx4 a[220:223], v1, s[8:11], s33 offen offset:2048 sc1
buffer_load_dwordx4 a[224:227], v1, s[8:11], s33 offen offset:3072 sc1
s_add_u32 s33, s33, 4096
buffer_load_dwordx4 a[228:231], v1, s[8:11], s33 offen offset:0 sc1
buffer_load_dwordx4 a[232:235], v1, s[8:11], s33 offen offset:1024 sc1
buffer_load_dwordx4 a[236:239], v1, s[8:11], s33 offen offset:2048 sc1
buffer_load_dwordx4 a[240:243], v1, s[8:11], s33 offen offset:3072 sc1
s_lshl_b32 s33, s23, 6
s_add_i32 s33, s33, -64
s_cmp_gt_i32 s33, 0
s_cselect_b32 s34, 0, 0xf149f2ca
s_cmp_lt_i32 s33, 0
s_cselect_b32 s33, 0xf149f2ca, 0
v_mov_b32 v20, s34
v_mov_b32 v21, s34
v_mov_b32 v22, s34
v_mov_b32 v23, s34
v_mov_b32 v28, s33
v_mov_b32 v29, s33
v_mov_b32 v30, s33
v_mov_b32 v31, s33
v_med3_f32 v24, v16, v20, v28
v_med3_f32 v25, v17, v20, v28
v_med3_f32 v26, v18, v20, v28
v_med3_f32 v27, v19, v20, v28
s_add_u32 m0, s29, 65536
s_waitcnt lgkmcnt(4)
M v[96:99], a[116:119], a[0:3], v[24:27]
v_exp_f32 v64, v64
M v[96:99], a[120:123], a[4:7], v[96:99]
ds_read_b128 a[148:151], v2 offset:8192
ds_read_b128 a[152:155], v2 offset:9216
M v[96:99], a[124:127], a[8:11], v[96:99]
v_exp_f32 v65, v65
M v[96:99], a[128:131], a[12:15], v[96:99]
buffer_load_dwordx4 v1, s[12:15], s25 offen offset:0 sc1 lds
s_add_u32 s32, s25, 4096
M v[100:103], a[128:131], a[28:31], v[28:31]
v_exp_f32 v66, v66
M v[100:103], a[124:127], a[24:27], v[100:103]
v_cvt_pk_bf16_f32 v64, v64, v65
M v[100:103], a[120:123], a[20:23], v[100:103]
v_exp_f32 v67, v67
M v[100:103], a[116:119], a[16:19], v[100:103]
buffer_load_dwordx4 v1, s[12:15], s25 offen offset:1024 sc1 lds
M v[104:107], a[116:119], a[32:35], v[28:31]
v_exp_f32 v80, v80
M v[104:107], a[120:123], a[36:39], v[104:107]
ds_read_b128 a[156:159], v2 offset:10240
ds_read_b128 a[160:163], v2 offset:11264
M v[104:107], a[124:127], a[40:43], v[104:107]
v_exp_f32 v81, v81
M v[104:107], a[128:131], a[44:47], v[104:107]
buffer_load_dwordx4 v1, s[12:15], s25 offen offset:2048 sc1 lds
M v[108:111], a[128:131], a[60:63], v[28:31]
v_exp_f32 v82, v82
M v[108:111], a[124:127], a[56:59], v[108:111]
v_cvt_pk_bf16_f32 v65, v66, v67
v_cvt_pk_bf16_f32 v66, v80, v81
M v[108:111], a[120:123], a[52:55], v[108:111]
v_exp_f32 v83, v83
M v[108:111], a[116:119], a[48:51], v[108:111]
buffer_load_dwordx4 v1, s[12:15], s25 offen offset:3072 sc1 lds
s_add_u32 m0, s29, 69632
s_waitcnt lgkmcnt(4)
M v[112:115], a[132:135], a[0:3], v[20:23]
v_exp_f32 v68, v68
M v[112:115], a[136:139], a[4:7], v[112:115]
ds_read_b128 a[164:167], v2 offset:12288
ds_read_b128 a[168:171], v2 offset:13312
M v[112:115], a[140:143], a[8:11], v[112:115]
v_exp_f32 v69, v69
M v[112:115], a[144:147], a[12:15], v[112:115]
buffer_load_dwordx4 v1, s[12:15], s32 offen offset:0 sc1 lds
M v[116:119], a[144:147], a[28:31], v[24:27]
v_exp_f32 v70, v70
M v[116:119], a[140:143], a[24:27], v[116:119]
v_cvt_pk_bf16_f32 v67, v82, v83
v_cvt_pk_bf16_f32 v68, v68, v69
M v[116:119], a[136:139], a[20:23], v[116:119]
v_exp_f32 v71, v71
M v[116:119], a[132:135], a[16:19], v[116:119]
buffer_load_dwordx4 v1, s[12:15], s32 offen offset:1024 sc1 lds
M v[120:123], a[132:135], a[32:35], v[28:31]
v_exp_f32 v84, v84
M v[120:123], a[136:139], a[36:39], v[120:123]
ds_read_b128 a[172:175], v2 offset:14336
ds_read_b128 a[176:179], v2 offset:15360
M v[120:123], a[140:143], a[40:43], v[120:123]
v_exp_f32 v85, v85
M v[120:123], a[144:147], a[44:47], v[120:123]
buffer_load_dwordx4 v1, s[12:15], s32 offen offset:2048 sc1 lds
M v[124:127], a[144:147], a[60:63], v[28:31]
v_exp_f32 v86, v86
M v[124:127], a[140:143], a[56:59], v[124:127]
v_cvt_pk_bf16_f32 v69, v70, v71
v_cvt_pk_bf16_f32 v70, v84, v85
M v[124:127], a[136:139], a[52:55], v[124:127]
v_exp_f32 v87, v87
M v[124:127], a[132:135], a[48:51], v[124:127]
buffer_load_dwordx4 v1, s[12:15], s32 offen offset:3072 sc1 lds
s_add_u32 m0, s29, 98304
s_waitcnt lgkmcnt(4)
M v[128:131], a[148:151], a[0:3], v[20:23]
v_exp_f32 v72, v72
M v[128:131], a[152:155], a[4:7], v[128:131]
ds_read_b128 a[116:119], v2 offset:32768
ds_read_b128 a[120:123], v2 offset:40960
M v[128:131], a[156:159], a[8:11], v[128:131]
v_exp_f32 v73, v73
M v[128:131], a[160:163], a[12:15], v[128:131]
buffer_load_dwordx4 v1, s[12:15], s26 offen offset:0 sc1 lds
s_add_u32 s43, s26, 4096
M v[132:135], a[160:163], a[28:31], v[20:23]
v_exp_f32 v74, v74
M v[132:135], a[156:159], a[24:27], v[132:135]
v_cvt_pk_bf16_f32 v71, v86, v87
v_cvt_pk_bf16_f32 v72, v72, v73
M v[132:135], a[152:155], a[20:23], v[132:135]
v_exp_f32 v75, v75
M v[132:135], a[148:151], a[16:19], v[132:135]
buffer_load_dwordx4 v1, s[12:15], s26 offen offset:1024 sc1 lds
M v[136:139], a[148:151], a[32:35], v[24:27]
v_exp_f32 v88, v88
M v[136:139], a[152:155], a[36:39], v[136:139]
ds_read_b128 a[124:127], v2 offset:33792
ds_read_b128 a[128:131], v2 offset:41984
M v[136:139], a[156:159], a[40:43], v[136:139]
v_exp_f32 v89, v89
M v[136:139], a[160:163], a[44:47], v[136:139]
buffer_load_dwordx4 v1, s[12:15], s26 offen offset:2048 sc1 lds
M v[140:143], a[160:163], a[60:63], v[28:31]
v_exp_f32 v90, v90
M v[140:143], a[156:159], a[56:59], v[140:143]
v_cvt_pk_bf16_f32 v73, v74, v75
v_cvt_pk_bf16_f32 v74, v88, v89
M v[140:143], a[152:155], a[52:55], v[140:143]
v_exp_f32 v91, v91
M v[140:143], a[148:151], a[48:51], v[140:143]
buffer_load_dwordx4 v1, s[12:15], s26 offen offset:3072 sc1 lds
s_add_u32 m0, s29, 102400
s_waitcnt lgkmcnt(4)
M v[144:147], a[164:167], a[0:3], v[20:23]
v_exp_f32 v76, v76
M v[144:147], a[168:171], a[4:7], v[144:147]
ds_read_b128 a[132:135], v2 offset:34816
ds_read_b128 a[136:139], v2 offset:43008
M v[144:147], a[172:175], a[8:11], v[144:147]
v_exp_f32 v77, v77
M v[144:147], a[176:179], a[12:15], v[144:147]
buffer_load_dwordx4 v1, s[12:15], s43 offen offset:0 sc1 lds
M v[148:151], a[176:179], a[28:31], v[20:23]
v_exp_f32 v78, v78
M v[148:151], a[172:175], a[24:27], v[148:151]
v_cvt_pk_bf16_f32 v75, v90, v91
v_cvt_pk_bf16_f32 v76, v76, v77
M v[148:151], a[168:171], a[20:23], v[148:151]
v_exp_f32 v79, v79
M v[148:151], a[164:167], a[16:19], v[148:151]
buffer_load_dwordx4 v1, s[12:15], s43 offen offset:1024 sc1 lds
M v[152:155], a[164:167], a[32:35], v[20:23]
v_exp_f32 v92, v92
M v[152:155], a[168:171], a[36:39], v[152:155]
ds_read_b128 a[140:143], v2 offset:35840
ds_read_b128 a[144:147], v2 offset:44032
M v[152:155], a[172:175], a[40:43], v[152:155]
v_exp_f32 v93, v93
M v[152:155], a[176:179], a[44:47], v[152:155]
buffer_load_dwordx4 v1, s[12:15], s43 offen offset:2048 sc1 lds
M v[156:159], a[176:179], a[60:63], v[24:27]
v_exp_f32 v94, v94
M v[156:159], a[172:175], a[56:59], v[156:159]
v_cvt_pk_bf16_f32 v77, v78, v79
v_cvt_pk_bf16_f32 v78, v92, v93
M v[156:159], a[168:171], a[52:55], v[156:159]
v_exp_f32 v95, v95
M v[156:159], a[164:167], a[48:51], v[156:159]
buffer_load_dwordx4 v1, s[12:15], s43 offen offset:3072 sc1 lds
v_cvt_pk_bf16_f32 v79, v94, v95
s_waitcnt lgkmcnt(6)
M v[160:163], a[116:119], v[32:35], v[160:163]
v_exp_f32 v96, v96
M v[160:163], a[120:123], v[64:67], v[160:163]
ds_read_b128 a[148:151], v2 offset:36864
ds_read_b128 a[152:155], v2 offset:45056
M v[164:167], a[120:123], v[68:71], v[164:167]
v_exp_f32 v97, v97
M v[164:167], a[116:119], v[36:39], v[164:167]
v_cvt_pk_bf16_f32 v96, v96, v97
M v[168:171], a[116:119], v[40:43], v[168:171]
v_exp_f32 v98, v98
M v[168:171], a[120:123], v[72:75], v[168:171]
s_add_u32 s25, s25, 32768
s_cmp_eq_u32 s25, s27
M v[172:175], a[120:123], v[76:79], v[172:175]
v_exp_f32 v99, v99
M v[172:175], a[116:119], v[44:47], v[172:175]
v_cvt_pk_bf16_f32 v97, v98, v99
s_waitcnt lgkmcnt(6)
M a[96:99], a[112:115], v[32:35], a[96:99]
s_cselect_b32 s25, s28, s25
s_cselect_b32 s27, -1, s27
M a[96:99], a[112:115], v[64:67], a[96:99]
s_add_u32 s26, s26, 32768
s_cmp_eq_u32 s26, s62
M v[176:179], a[124:127], v[32:35], v[176:179]
v_exp_f32 v112, v112
M v[176:179], a[128:131], v[64:67], v[176:179]
ds_read_b128 a[156:159], v2 offset:37888
ds_read_b128 a[160:163], v2 offset:46080
M v[180:183], a[128:131], v[68:71], v[180:183]
v_exp_f32 v113, v113
M v[180:183], a[124:127], v[36:39], v[180:183]
v_cvt_pk_bf16_f32 v98, v112, v113
M v[184:187], a[124:127], v[40:43], v[184:187]
v_exp_f32 v114, v114
M v[184:187], a[128:131], v[72:75], v[184:187]
s_cselect_b32 s26, s63, s26
s_cselect_b32 s62, -1, s62
M v[188:191], a[128:131], v[76:79], v[188:191]
v_exp_f32 v115, v115
M v[188:191], a[124:127], v[44:47], v[188:191]
v_cvt_pk_bf16_f32 v99, v114, v115
s_waitcnt lgkmcnt(6)
M a[100:103], a[112:115], v[36:39], a[100:103]
M a[100:103], a[112:115], v[68:71], a[100:103]
M v[192:195], a[132:135], v[32:35], v[192:195]
v_exp_f32 v100, v100
M v[192:195], a[136:139], v[64:67], v[192:195]
ds_read_b128 a[164:167], v2 offset:38912
ds_read_b128 a[168:171], v2 offset:47104
M v[196:199], a[136:139], v[68:71], v[196:199]
v_exp_f32 v101, v101
M v[196:199], a[132:135], v[36:39], v[196:199]
v_cvt_pk_bf16_f32 v100, v100, v101
M v[200:203], a[132:135], v[40:43], v[200:203]
v_exp_f32 v102, v102
M v[200:203], a[136:139], v[72:75], v[200:203]
M v[204:207], a[136:139], v[76:79], v[204:207]
v_exp_f32 v103, v103
M v[204:207], a[132:135], v[44:47], v[204:207]
v_cvt_pk_bf16_f32 v101, v102, v103
s_waitcnt lgkmcnt(6)
M a[104:107], a[112:115], v[40:43], a[104:107]
M a[104:107], a[112:115], v[72:75], a[104:107]
M v[208:211], a[140:143], v[32:35], v[208:211]
v_exp_f32 v116, v116
M v[208:211], a[144:147], v[64:67], v[208:211]
ds_read_b128 a[172:175], v2 offset:39936
ds_read_b128 a[176:179], v2 offset:48128
M v[212:215], a[144:147], v[68:71], v[212:215]
v_exp_f32 v117, v117
M v[212:215], a[140:143], v[36:39], v[212:215]
v_cvt_pk_bf16_f32 v102, v116, v117
M v[216:219], a[140:143], v[40:43], v[216:219]
v_exp_f32 v118, v118
M v[216:219], a[144:147], v[72:75], v[216:219]
M v[220:223], a[144:147], v[76:79], v[220:223]
v_exp_f32 v119, v119
M v[220:223], a[140:143], v[44:47], v[220:223]
v_cvt_pk_bf16_f32 v103, v118, v119
s_waitcnt lgkmcnt(6)
M a[108:111], a[112:115], v[44:47], a[108:111]
M a[108:111], a[112:115], v[76:79], a[108:111]
M v[224:227], a[148:151], v[32:35], v[224:227]
v_exp_f32 v104, v104
M v[224:227], a[152:155], v[64:67], v[224:227]
M v[228:231], a[152:155], v[68:71], v[228:231]
v_exp_f32 v105, v105
M v[228:231], a[148:151], v[36:39], v[228:231]
v_cvt_pk_bf16_f32 v104, v104, v105
M v[232:235], a[148:151], v[40:43], v[232:235]
v_exp_f32 v106, v106
M v[232:235], a[152:155], v[72:75], v[232:235]
M v[236:239], a[152:155], v[76:79], v[236:239]
v_exp_f32 v107, v107
M v[236:239], a[148:151], v[44:47], v[236:239]
v_cvt_pk_bf16_f32 v105, v106, v107
s_waitcnt lgkmcnt(4)
M v[240:243], a[156:159], v[32:35], v[240:243]
v_exp_f32 v120, v120
M v[240:243], a[160:163], v[64:67], v[240:243]
M v[244:247], a[160:163], v[68:71], v[244:247]
v_exp_f32 v121, v121
M v[244:247], a[156:159], v[36:39], v[244:247]
v_cvt_pk_bf16_f32 v106, v120, v121
M v[248:251], a[156:159], v[40:43], v[248:251]
v_exp_f32 v122, v122
M v[248:251], a[160:163], v[72:75], v[248:251]
s_waitcnt vmcnt(0) lgkmcnt(0)
s_barrier
ds_read_b128 a[116:119], v3 offset:0
ds_read_b128 a[120:123], v3 offset:1024
M v[252:255], a[160:163], v[76:79], v[252:255]
v_exp_f32 v123, v123
M v[252:255], a[156:159], v[44:47], v[252:255]
v_cvt_pk_bf16_f32 v107, v122, v123
M a[64:67], a[164:167], v[32:35], a[64:67]
v_exp_f32 v108, v108
M a[64:67], a[168:171], v[64:67], a[64:67]
ds_read_b128 a[124:127], v3 offset:2048
ds_read_b128 a[128:131], v3 offset:3072
M a[68:71], a[168:171], v[68:71], a[68:71]
v_exp_f32 v109, v109
M a[68:71], a[164:167], v[36:39], a[68:71]
v_cvt_pk_bf16_f32 v108, v108, v109
M a[72:75], a[164:167], v[40:43], a[72:75]
v_exp_f32 v110, v110
M a[72:75], a[168:171], v[72:75], a[72:75]
ds_read_b128 a[132:135], v3 offset:4096
ds_read_b128 a[136:139], v3 offset:5120
M a[76:79], a[168:171], v[76:79], a[76:79]
v_exp_f32 v111, v111
M a[76:79], a[164:167], v[44:47], a[76:79]
v_cvt_pk_bf16_f32 v109, v110, v111
M a[80:83], a[172:175], v[32:35], a[80:83]
v_exp_f32 v124, v124
M a[80:83], a[176:179], v[64:67], a[80:83]
ds_read_b128 a[140:143], v3 offset:6144
ds_read_b128 a[144:147], v3 offset:7168
M a[84:87], a[176:179], v[68:71], a[84:87]
v_exp_f32 v125, v125
M a[84:87], a[172:175], v[36:39], a[84:87]
v_cvt_pk_bf16_f32 v110, v124, v125
M a[88:91], a[172:175], v[40:43], a[88:91]
v_exp_f32 v126, v126
M a[88:91], a[176:179], v[72:75], a[88:91]
M a[92:95], a[176:179], v[76:79], a[92:95]
v_exp_f32 v127, v127
M a[92:95], a[172:175], v[44:47], a[92:95]
v_cvt_pk_bf16_f32 v111, v126, v127
s_waitcnt vmcnt(16)
s_add_u32 m0, s29, 0
s_waitcnt lgkmcnt(4)
M v[32:35], a[116:119], a[180:183], 0
v_exp_f32 v128, v128
M v[32:35], a[120:123], a[184:187], v[32:35]
ds_read_b128 a[148:151], v3 offset:8192
ds_read_b128 a[152:155], v3 offset:9216
M v[32:35], a[124:127], a[188:191], v[32:35]
v_exp_f32 v129, v129
M v[32:35], a[128:131], a[192:195], v[32:35]
buffer_load_dwordx4 v1, s[12:15], s25 offen offset:0 sc1 lds
s_add_u32 s32, s25, 4096
M v[36:39], a[128:131], a[208:211], 0
v_exp_f32 v130, v130
M v[36:39], a[124:127], a[204:207], v[36:39]
v_cvt_pk_bf16_f32 v128, v128, v129
M v[36:39], a[120:123], a[200:203], v[36:39]
v_exp_f32 v131, v131
M v[36:39], a[116:119], a[196:199], v[36:39]
buffer_load_dwordx4 v1, s[12:15], s25 offen offset:1024 sc1 lds
M v[40:43], a[116:119], a[212:215], 0
v_exp_f32 v144, v144
M v[40:43], a[120:123], a[216:219], v[40:43]
ds_read_b128 a[156:159], v3 offset:10240
ds_read_b128 a[160:163], v3 offset:11264
M v[40:43], a[124:127], a[220:223], v[40:43]
v_exp_f32 v145, v145
M v[40:43], a[128:131], a[224:227], v[40:43]
buffer_load_dwordx4 v1, s[12:15], s25 offen offset:2048 sc1 lds
M v[44:47], a[128:131], a[240:243], 0
v_exp_f32 v146, v146
M v[44:47], a[124:127], a[236:239], v[44:47]
v_cvt_pk_bf16_f32 v129, v130, v131
v_cvt_pk_bf16_f32 v130, v144, v145
M v[44:47], a[120:123], a[232:235], v[44:47]
v_exp_f32 v147, v147
M v[44:47], a[116:119], a[228:231], v[44:47]
buffer_load_dwordx4 v1, s[12:15], s25 offen offset:3072 sc1 lds
s_add_u32 m0, s29, 4096
s_waitcnt lgkmcnt(4)
M v[48:51], a[132:135], a[180:183], 0
v_exp_f32 v132, v132
M v[48:51], a[136:139], a[184:187], v[48:51]
ds_read_b128 a[164:167], v3 offset:12288
ds_read_b128 a[168:171], v3 offset:13312
M v[48:51], a[140:143], a[188:191], v[48:51]
v_exp_f32 v133, v133
M v[48:51], a[144:147], a[192:195], v[48:51]
buffer_load_dwordx4 v1, s[12:15], s32 offen offset:0 sc1 lds
M v[52:55], a[144:147], a[208:211], 0
v_exp_f32 v134, v134
M v[52:55], a[140:143], a[204:207], v[52:55]
v_cvt_pk_bf16_f32 v131, v146, v147
v_cvt_pk_bf16_f32 v132, v132, v133
M v[52:55], a[136:139], a[200:203], v[52:55]
v_exp_f32 v135, v135
M v[52:55], a[132:135], a[196:199], v[52:55]
buffer_load_dwordx4 v1, s[12:15], s32 offen offset:1024 sc1 lds
M v[56:59], a[132:135], a[212:215], 0
v_exp_f32 v148, v148
M v[56:59], a[136:139], a[216:219], v[56:59]
ds_read_b128 a[172:175], v3 offset:14336
ds_read_b128 a[176:179], v3 offset:15360
M v[56:59], a[140:143], a[220:223], v[56:59]
v_exp_f32 v149, v149
M v[56:59], a[144:147], a[224:227], v[56:59]
buffer_load_dwordx4 v1, s[12:15], s32 offen offset:2048 sc1 lds
M v[60:63], a[144:147], a[240:243], 0
v_exp_f32 v150, v150
M v[60:63], a[140:143], a[236:239], v[60:63]
v_cvt_pk_bf16_f32 v133, v134, v135
v_cvt_pk_bf16_f32 v134, v148, v149
M v[60:63], a[136:139], a[232:235], v[60:63]
v_exp_f32 v151, v151
M v[60:63], a[132:135], a[228:231], v[60:63]
buffer_load_dwordx4 v1, s[12:15], s32 offen offset:3072 sc1 lds
s_add_u32 m0, s29, 32768
s_waitcnt lgkmcnt(4)
M v[64:67], a[148:151], a[180:183], 0
v_exp_f32 v136, v136
M v[64:67], a[152:155], a[184:187], v[64:67]
ds_read_b128 a[116:119], v3 offset:32768
ds_read_b128 a[120:123], v3 offset:40960
M v[64:67], a[156:159], a[188:191], v[64:67]
v_exp_f32 v137, v137
M v[64:67], a[160:163], a[192:195], v[64:67]
buffer_load_dwordx4 v1, s[12:15], s26 offen offset:0 sc1 lds
s_add_u32 s43, s26, 4096
M v[68:71], a[160:163], a[208:211], 0
v_exp_f32 v138, v138
M v[68:71], a[156:159], a[204:207], v[68:71]
v_cvt_pk_bf16_f32 v135, v150, v151
v_cvt_pk_bf16_f32 v136, v136, v137
M v[68:71], a[152:155], a[200:203], v[68:71]
v_exp_f32 v139, v139
M v[68:71], a[148:151], a[196:199], v[68:71]
buffer_load_dwordx4 v1, s[12:15], s26 offen offset:1024 sc1 lds
M v[72:75], a[148:151], a[212:215], 0
v_exp_f32 v152, v152
M v[72:75], a[152:155], a[216:219], v[72:75]
ds_read_b128 a[124:127], v3 offset:33792
ds_read_b128 a[128:131], v3 offset:41984
M v[72:75], a[156:159], a[220:223], v[72:75]
v_exp_f32 v153, v153
M v[72:75], a[160:163], a[224:227], v[72:75]
buffer_load_dwordx4 v1, s[12:15], s26 offen offset:2048 sc1 lds
M v[76:79], a[160:163], a[240:243], 0
v_exp_f32 v154, v154
M v[76:79], a[156:159], a[236:239], v[76:79]
v_cvt_pk_bf16_f32 v137, v138, v139
v_cvt_pk_bf16_f32 v138, v152, v153
M v[76:79], a[152:155], a[232:235], v[76:79]
v_exp_f32 v155, v155
M v[76:79], a[148:151], a[228:231], v[76:79]
buffer_load_dwordx4 v1, s[12:15], s26 offen offset:3072 sc1 lds
s_add_u32 m0, s29, 36864
s_waitcnt lgkmcnt(4)
M v[80:83], a[164:167], a[180:183], 0
v_exp_f32 v140, v140
M v[80:83], a[168:171], a[184:187], v[80:83]
ds_read_b128 a[132:135], v3 offset:34816
ds_read_b128 a[136:139], v3 offset:43008
M v[80:83], a[172:175], a[188:191], v[80:83]
v_exp_f32 v141, v141
M v[80:83], a[176:179], a[192:195], v[80:83]
buffer_load_dwordx4 v1, s[12:15], s43 offen offset:0 sc1 lds
M v[84:87], a[176:179], a[208:211], 0
v_exp_f32 v142, v142
M v[84:87], a[172:175], a[204:207], v[84:87]
v_cvt_pk_bf16_f32 v139, v154, v155
v_cvt_pk_bf16_f32 v140, v140, v141
M v[84:87], a[168:171], a[200:203], v[84:87]
v_exp_f32 v143, v143
M v[84:87], a[164:167], a[196:199], v[84:87]
buffer_load_dwordx4 v1, s[12:15], s43 offen offset:1024 sc1 lds
M v[88:91], a[164:167], a[212:215], 0
v_exp_f32 v156, v156
M v[88:91], a[168:171], a[216:219], v[88:91]
ds_read_b128 a[140:143], v3 offset:35840
ds_read_b128 a[144:147], v3 offset:44032
M v[88:91], a[172:175], a[220:223], v[88:91]
v_exp_f32 v157, v157
M v[88:91], a[176:179], a[224:227], v[88:91]
buffer_load_dwordx4 v1, s[12:15], s43 offen offset:2048 sc1 lds
M v[92:95], a[176:179], a[240:243], 0
v_exp_f32 v158, v158
M v[92:95], a[172:175], a[236:239], v[92:95]
v_cvt_pk_bf16_f32 v141, v142, v143
v_cvt_pk_bf16_f32 v142, v156, v157
M v[92:95], a[168:171], a[232:235], v[92:95]
v_exp_f32 v159, v159
M v[92:95], a[164:167], a[228:231], v[92:95]
buffer_load_dwordx4 v1, s[12:15], s43 offen offset:3072 sc1 lds
v_cvt_pk_bf16_f32 v143, v158, v159
s_waitcnt lgkmcnt(6)
M v[160:163], a[116:119], v[96:99], v[160:163]
v_exp_f32 v32, v32
M v[160:163], a[120:123], v[128:131], v[160:163]
ds_read_b128 a[148:151], v3 offset:36864
ds_read_b128 a[152:155], v3 offset:45056
M v[164:167], a[120:123], v[132:135], v[164:167]
v_exp_f32 v33, v33
M v[164:167], a[116:119], v[100:103], v[164:167]
v_cvt_pk_bf16_f32 v32, v32, v33
M v[168:171], a[116:119], v[104:107], v[168:171]
v_exp_f32 v34, v34
M v[168:171], a[120:123], v[136:139], v[168:171]
s_add_u32 s25, s25, 32768
s_cmp_eq_u32 s25, s27
M v[172:175], a[120:123], v[140:143], v[172:175]
v_exp_f32 v35, v35
M v[172:175], a[116:119], v[108:111], v[172:175]
v_cvt_pk_bf16_f32 v33, v34, v35
s_waitcnt lgkmcnt(6)
M a[96:99], a[112:115], v[96:99], a[96:99]
s_cselect_b32 s25, s28, s25
s_cselect_b32 s27, -1, s27
M a[96:99], a[112:115], v[128:131], a[96:99]
s_add_u32 s26, s26, 32768
s_cmp_eq_u32 s26, s62
M v[176:179], a[124:127], v[96:99], v[176:179]
v_exp_f32 v48, v48
M v[176:179], a[128:131], v[128:131], v[176:179]
ds_read_b128 a[156:159], v3 offset:37888
ds_read_b128 a[160:163], v3 offset:46080
M v[180:183], a[128:131], v[132:135], v[180:183]
v_exp_f32 v49, v49
M v[180:183], a[124:127], v[100:103], v[180:183]
v_cvt_pk_bf16_f32 v34, v48, v49
M v[184:187], a[124:127], v[104:107], v[184:187]
v_exp_f32 v50, v50
M v[184:187], a[128:131], v[136:139], v[184:187]
s_cselect_b32 s26, s63, s26
s_cselect_b32 s62, -1, s62
M v[188:191], a[128:131], v[140:143], v[188:191]
v_exp_f32 v51, v51
M v[188:191], a[124:127], v[108:111], v[188:191]
v_cvt_pk_bf16_f32 v35, v50, v51
s_waitcnt lgkmcnt(6)
M a[100:103], a[112:115], v[100:103], a[100:103]
M a[100:103], a[112:115], v[132:135], a[100:103]
M v[192:195], a[132:135], v[96:99], v[192:195]
v_exp_f32 v36, v36
M v[192:195], a[136:139], v[128:131], v[192:195]
ds_read_b128 a[164:167], v3 offset:38912
ds_read_b128 a[168:171], v3 offset:47104
M v[196:199], a[136:139], v[132:135], v[196:199]
v_exp_f32 v37, v37
M v[196:199], a[132:135], v[100:103], v[196:199]
v_cvt_pk_bf16_f32 v36, v36, v37
M v[200:203], a[132:135], v[104:107], v[200:203]
v_exp_f32 v38, v38
M v[200:203], a[136:139], v[136:139], v[200:203]
M v[204:207], a[136:139], v[140:143], v[204:207]
v_exp_f32 v39, v39
M v[204:207], a[132:135], v[108:111], v[204:207]
v_cvt_pk_bf16_f32 v37, v38, v39
s_waitcnt lgkmcnt(6)
M a[104:107], a[112:115], v[104:107], a[104:107]
M a[104:107], a[112:115], v[136:139], a[104:107]
M v[208:211], a[140:143], v[96:99], v[208:211]
v_exp_f32 v52, v52
M v[208:211], a[144:147], v[128:131], v[208:211]
ds_read_b128 a[172:175], v3 offset:39936
ds_read_b128 a[176:179], v3 offset:48128
M v[212:215], a[144:147], v[132:135], v[212:215]
v_exp_f32 v53, v53
M v[212:215], a[140:143], v[100:103], v[212:215]
v_cvt_pk_bf16_f32 v38, v52, v53
M v[216:219], a[140:143], v[104:107], v[216:219]
v_exp_f32 v54, v54
M v[216:219], a[144:147], v[136:139], v[216:219]
M v[220:223], a[144:147], v[140:143], v[220:223]
v_exp_f32 v55, v55
M v[220:223], a[140:143], v[108:111], v[220:223]
v_cvt_pk_bf16_f32 v39, v54, v55
s_waitcnt lgkmcnt(6)
M a[108:111], a[112:115], v[108:111], a[108:111]
M a[108:111], a[112:115], v[140:143], a[108:111]
M v[224:227], a[148:151], v[96:99], v[224:227]
v_exp_f32 v40, v40
M v[224:227], a[152:155], v[128:131], v[224:227]
M v[228:231], a[152:155], v[132:135], v[228:231]
v_exp_f32 v41, v41
M v[228:231], a[148:151], v[100:103], v[228:231]
v_cvt_pk_bf16_f32 v40, v40, v41
M v[232:235], a[148:151], v[104:107], v[232:235]
v_exp_f32 v42, v42
M v[232:235], a[152:155], v[136:139], v[232:235]
M v[236:239], a[152:155], v[140:143], v[236:239]
v_exp_f32 v43, v43
M v[236:239], a[148:151], v[108:111], v[236:239]
v_cvt_pk_bf16_f32 v41, v42, v43
s_waitcnt lgkmcnt(4)
M v[240:243], a[156:159], v[96:99], v[240:243]
v_exp_f32 v56, v56
M v[240:243], a[160:163], v[128:131], v[240:243]
M v[244:247], a[160:163], v[132:135], v[244:247]
v_exp_f32 v57, v57
M v[244:247], a[156:159], v[100:103], v[244:247]
v_cvt_pk_bf16_f32 v42, v56, v57
M v[248:251], a[156:159], v[104:107], v[248:251]
v_exp_f32 v58, v58
M v[248:251], a[160:163], v[136:139], v[248:251]
s_waitcnt vmcnt(0) lgkmcnt(0)
s_barrier
ds_read_b128 a[116:119], v2 offset:0
ds_read_b128 a[120:123], v2 offset:1024
M v[252:255], a[160:163], v[140:143], v[252:255]
v_exp_f32 v59, v59
M v[252:255], a[156:159], v[108:111], v[252:255]
v_cvt_pk_bf16_f32 v43, v58, v59
M a[64:67], a[164:167], v[96:99], a[64:67]
v_exp_f32 v44, v44
M a[64:67], a[168:171], v[128:131], a[64:67]
ds_read_b128 a[124:127], v2 offset:2048
ds_read_b128 a[128:131], v2 offset:3072
M a[68:71], a[168:171], v[132:135], a[68:71]
v_exp_f32 v45, v45
M a[68:71], a[164:167], v[100:103], a[68:71]
v_cvt_pk_bf16_f32 v44, v44, v45
M a[72:75], a[164:167], v[104:107], a[72:75]
v_exp_f32 v46, v46
M a[72:75], a[168:171], v[136:139], a[72:75]
ds_read_b128 a[132:135], v2 offset:4096
ds_read_b128 a[136:139], v2 offset:5120
M a[76:79], a[168:171], v[140:143], a[76:79]
v_exp_f32 v47, v47
M a[76:79], a[164:167], v[108:111], a[76:79]
v_cvt_pk_bf16_f32 v45, v46, v47
M a[80:83], a[172:175], v[96:99], a[80:83]
v_exp_f32 v60, v60
M a[80:83], a[176:179], v[128:131], a[80:83]
ds_read_b128 a[140:143], v2 offset:6144
ds_read_b128 a[144:147], v2 offset:7168
M a[84:87], a[176:179], v[132:135], a[84:87]
v_exp_f32 v61, v61
M a[84:87], a[172:175], v[100:103], a[84:87]
v_cvt_pk_bf16_f32 v46, v60, v61
M a[88:91], a[172:175], v[104:107], a[88:91]
v_exp_f32 v62, v62
M a[88:91], a[176:179], v[136:139], a[88:91]
M a[92:95], a[176:179], v[140:143], a[92:95]
v_exp_f32 v63, v63
M a[92:95], a[172:175], v[108:111], a[92:95]
v_cvt_pk_bf16_f32 v47, v62, v63
v_accvgpr_read_b32 v20, a96
v_accvgpr_read_b32 v21, a100
v_accvgpr_read_b32 v22, a104
v_accvgpr_read_b32 v23, a108
v_rcp_f32 v8, v20
v_rcp_f32 v9, v21
v_rcp_f32 v10, v22
v_rcp_f32 v11, v23
v_subrev_u32 v20, 0x21800000, v20
v_subrev_u32 v21, 0x21800000, v21
v_subrev_u32 v22, 0x21800000, v22
v_subrev_u32 v23, 0x21800000, v23
v_max_u32 v12, v20, v21
v_max3_u32 v12, v12, v22, v23
s_mov_b32 s64, 0x207
s_lshl_b32 s33, s21, 20
s_lshl_b32 s34, s20, 15
s_add_u32 s33, s33, s34
s_lshl_b32 s34, s23, 13
s_add_u32 s36, s33, s34
s_add_u32 s37, s36, 4096
s_add_u32 s38, s36, 16384
s_add_u32 s39, s36, 20480
v_pk_mul_f32 v[160:161], v[160:161], v[8:9] op_sel:[0,0] op_sel_hi:[1,0]
v_pk_mul_f32 v[162:163], v[162:163], v[8:9] op_sel:[0,0] op_sel_hi:[1,0]
v_pk_mul_f32 v[176:177], v[176:177], v[8:9] op_sel:[0,0] op_sel_hi:[1,0]
v_pk_mul_f32 v[178:179], v[178:179], v[8:9] op_sel:[0,0] op_sel_hi:[1,0]
v_cvt_pk_bf16_f32 v160, v160, v161
v_cvt_pk_bf16_f32 v161, v162, v163
v_cvt_pk_bf16_f32 v162, v176, v177
v_cvt_pk_bf16_f32 v163, v178, v179
s_nop 1
M v[24:27], a[112:115], v[160:163], 0
buffer_store_dwordx4 v[160:163], v1, s[16:19], s36 offen offset:0 sc1
v_pk_mul_f32 v[164:165], v[164:165], v[8:9] op_sel:[0,1] op_sel_hi:[1,1]
v_pk_mul_f32 v[166:167], v[166:167], v[8:9] op_sel:[0,1] op_sel_hi:[1,1]
v_pk_mul_f32 v[180:181], v[180:181], v[8:9] op_sel:[0,1] op_sel_hi:[1,1]
v_pk_mul_f32 v[182:183], v[182:183], v[8:9] op_sel:[0,1] op_sel_hi:[1,1]
v_cvt_pk_bf16_f32 v164, v164, v165
v_cvt_pk_bf16_f32 v165, v166, v167
v_cvt_pk_bf16_f32 v166, v180, v181
v_cvt_pk_bf16_f32 v167, v182, v183
s_nop 1
M v[24:27], a[112:115], v[164:167], v[24:27]
buffer_store_dwordx4 v[164:167], v1, s[16:19], s36 offen offset:2048 sc1
v_pk_mul_f32 v[168:169], v[168:169], v[10:11] op_sel:[0,0] op_sel_hi:[1,0]
v_pk_mul_f32 v[170:171], v[170:171], v[10:11] op_sel:[0,0] op_sel_hi:[1,0]
v_pk_mul_f32 v[184:185], v[184:185], v[10:11] op_sel:[0,0] op_sel_hi:[1,0]
v_pk_mul_f32 v[186:187], v[186:187], v[10:11] op_sel:[0,0] op_sel_hi:[1,0]
v_cvt_pk_bf16_f32 v168, v168, v169
v_cvt_pk_bf16_f32 v169, v170, v171
v_cvt_pk_bf16_f32 v170, v184, v185
v_cvt_pk_bf16_f32 v171, v186, v187
s_nop 1
M v[24:27], a[112:115], v[168:171], v[24:27]
buffer_store_dwordx4 v[168:171], v1, s[16:19], s37 offen offset:0 sc1
v_pk_mul_f32 v[172:173], v[172:173], v[10:11] op_sel:[0,1] op_sel_hi:[1,1]
v_pk_mul_f32 v[174:175], v[174:175], v[10:11] op_sel:[0,1] op_sel_hi:[1,1]
v_pk_mul_f32 v[188:189], v[188:189], v[10:11] op_sel:[0,1] op_sel_hi:[1,1]
v_pk_mul_f32 v[190:191], v[190:191], v[10:11] op_sel:[0,1] op_sel_hi:[1,1]
v_cvt_pk_bf16_f32 v172, v172, v173
v_cvt_pk_bf16_f32 v173, v174, v175
v_cvt_pk_bf16_f32 v174, v188, v189
v_cvt_pk_bf16_f32 v175, v190, v191
s_nop 1
M v[24:27], a[112:115], v[172:175], v[24:27]
buffer_store_dwordx4 v[172:175], v1, s[16:19], s37 offen offset:2048 sc1
v_pk_mul_f32 v[192:193], v[192:193], v[8:9] op_sel:[0,0] op_sel_hi:[1,0]
v_pk_mul_f32 v[194:195], v[194:195], v[8:9] op_sel:[0,0] op_sel_hi:[1,0]
v_pk_mul_f32 v[208:209], v[208:209], v[8:9] op_sel:[0,0] op_sel_hi:[1,0]
v_pk_mul_f32 v[210:211], v[210:211], v[8:9] op_sel:[0,0] op_sel_hi:[1,0]
v_cvt_pk_bf16_f32 v192, v192, v193
v_cvt_pk_bf16_f32 v193, v194, v195
v_cvt_pk_bf16_f32 v194, v208, v209
v_cvt_pk_bf16_f32 v195, v210, v211
s_nop 1
M v[24:27], a[112:115], v[192:195], v[24:27]
buffer_store_dwordx4 v[192:195], v1, s[16:19], s36 offen offset:1024 sc1
v_pk_mul_f32 v[196:197], v[196:197], v[8:9] op_sel:[0,1] op_sel_hi:[1,1]
v_pk_mul_f32 v[198:199], v[198:199], v[8:9] op_sel:[0,1] op_sel_hi:[1,1]
v_pk_mul_f32 v[212:213], v[212:213], v[8:9] op_sel:[0,1] op_sel_hi:[1,1]
v_pk_mul_f32 v[214:215], v[214:215], v[8:9] op_sel:[0,1] op_sel_hi:[1,1]
v_cvt_pk_bf16_f32 v196, v196, v197
v_cvt_pk_bf16_f32 v197, v198, v199
v_cvt_pk_bf16_f32 v198, v212, v213
v_cvt_pk_bf16_f32 v199, v214, v215
s_nop 1
M v[24:27], a[112:115], v[196:199], v[24:27]
buffer_store_dwordx4 v[196:199], v1, s[16:19], s36 offen offset:3072 sc1
v_pk_mul_f32 v[200:201], v[200:201], v[10:11] op_sel:[0,0] op_sel_hi:[1,0]
v_pk_mul_f32 v[202:203], v[202:203], v[10:11] op_sel:[0,0] op_sel_hi:[1,0]
v_pk_mul_f32 v[216:217], v[216:217], v[10:11] op_sel:[0,0] op_sel_hi:[1,0]
v_pk_mul_f32 v[218:219], v[218:219], v[10:11] op_sel:[0,0] op_sel_hi:[1,0]
v_cvt_pk_bf16_f32 v200, v200, v201
v_cvt_pk_bf16_f32 v201, v202, v203
v_cvt_pk_bf16_f32 v202, v216, v217
v_cvt_pk_bf16_f32 v203, v218, v219
s_nop 1
M v[24:27], a[112:115], v[200:203], v[24:27]
buffer_store_dwordx4 v[200:203], v1, s[16:19], s37 offen offset:1024 sc1
v_pk_mul_f32 v[204:205], v[204:205], v[10:11] op_sel:[0,1] op_sel_hi:[1,1]
v_pk_mul_f32 v[206:207], v[206:207], v[10:11] op_sel:[0,1] op_sel_hi:[1,1]
v_pk_mul_f32 v[220:221], v[220:221], v[10:11] op_sel:[0,1] op_sel_hi:[1,1]
v_pk_mul_f32 v[222:223], v[222:223], v[10:11] op_sel:[0,1] op_sel_hi:[1,1]
v_cvt_pk_bf16_f32 v204, v204, v205
v_cvt_pk_bf16_f32 v205, v206, v207
v_cvt_pk_bf16_f32 v206, v220, v221
v_cvt_pk_bf16_f32 v207, v222, v223
s_nop 1
M v[24:27], a[112:115], v[204:207], v[24:27]
buffer_store_dwordx4 v[204:207], v1, s[16:19], s37 offen offset:3072 sc1
v_pk_mul_f32 v[224:225], v[224:225], v[8:9] op_sel:[0,0] op_sel_hi:[1,0]
v_pk_mul_f32 v[226:227], v[226:227], v[8:9] op_sel:[0,0] op_sel_hi:[1,0]
v_pk_mul_f32 v[240:241], v[240:241], v[8:9] op_sel:[0,0] op_sel_hi:[1,0]
v_pk_mul_f32 v[242:243], v[242:243], v[8:9] op_sel:[0,0] op_sel_hi:[1,0]
v_cvt_pk_bf16_f32 v224, v224, v225
v_cvt_pk_bf16_f32 v225, v226, v227
v_cvt_pk_bf16_f32 v226, v240, v241
v_cvt_pk_bf16_f32 v227, v242, v243
s_nop 1
M v[24:27], a[112:115], v[224:227], v[24:27]
buffer_store_dwordx4 v[224:227], v1, s[16:19], s38 offen offset:0 sc1
v_pk_mul_f32 v[228:229], v[228:229], v[8:9] op_sel:[0,1] op_sel_hi:[1,1]
v_pk_mul_f32 v[230:231], v[230:231], v[8:9] op_sel:[0,1] op_sel_hi:[1,1]
v_pk_mul_f32 v[244:245], v[244:245], v[8:9] op_sel:[0,1] op_sel_hi:[1,1]
v_pk_mul_f32 v[246:247], v[246:247], v[8:9] op_sel:[0,1] op_sel_hi:[1,1]
v_cvt_pk_bf16_f32 v228, v228, v229
v_cvt_pk_bf16_f32 v229, v230, v231
v_cvt_pk_bf16_f32 v230, v244, v245
v_cvt_pk_bf16_f32 v231, v246, v247
s_nop 1
M v[24:27], a[112:115], v[228:231], v[24:27]
buffer_store_dwordx4 v[228:231], v1, s[16:19], s38 offen offset:2048 sc1
v_pk_mul_f32 v[232:233], v[232:233], v[10:11] op_sel:[0,0] op_sel_hi:[1,0]
v_pk_mul_f32 v[234:235], v[234:235], v[10:11] op_sel:[0,0] op_sel_hi:[1,0]
v_pk_mul_f32 v[248:249], v[248:249], v[10:11] op_sel:[0,0] op_sel_hi:[1,0]
v_pk_mul_f32 v[250:251], v[250:251], v[10:11] op_sel:[0,0] op_sel_hi:[1,0]
v_cvt_pk_bf16_f32 v232, v232, v233
v_cvt_pk_bf16_f32 v233, v234, v235
v_cvt_pk_bf16_f32 v234, v248, v249
v_cvt_pk_bf16_f32 v235, v250, v251
s_nop 1
M v[24:27], a[112:115], v[232:235], v[24:27]
buffer_store_dwordx4 v[232:235], v1, s[16:19], s39 offen offset:0 sc1
v_pk_mul_f32 v[236:237], v[236:237], v[10:11] op_sel:[0,1] op_sel_hi:[1,1]
v_pk_mul_f32 v[238:239], v[238:239], v[10:11] op_sel:[0,1] op_sel_hi:[1,1]
v_pk_mul_f32 v[252:253], v[252:253], v[10:11] op_sel:[0,1] op_sel_hi:[1,1]
v_pk_mul_f32 v[254:255], v[254:255], v[10:11] op_sel:[0,1] op_sel_hi:[1,1]
v_cvt_pk_bf16_f32 v236, v236, v237
v_cvt_pk_bf16_f32 v237, v238, v239
v_cvt_pk_bf16_f32 v238, v252, v253
v_cvt_pk_bf16_f32 v239, v254, v255
v_accvgpr_read_b32 v176, a64
v_accvgpr_read_b32 v177, a65
v_accvgpr_read_b32 v178, a66
v_accvgpr_read_b32 v179, a67
v_accvgpr_read_b32 v180, a80
v_accvgpr_read_b32 v181, a81
v_accvgpr_read_b32 v182, a82
v_accvgpr_read_b32 v183, a83
M v[24:27], a[112:115], v[236:239], v[24:27]
buffer_store_dwordx4 v[236:239], v1, s[16:19], s39 offen offset:2048 sc1
v_pk_mul_f32 v[176:177], v[176:177], v[8:9] op_sel:[0,0] op_sel_hi:[1,0]
v_pk_mul_f32 v[178:179], v[178:179], v[8:9] op_sel:[0,0] op_sel_hi:[1,0]
v_pk_mul_f32 v[180:181], v[180:181], v[8:9] op_sel:[0,0] op_sel_hi:[1,0]
v_pk_mul_f32 v[182:183], v[182:183], v[8:9] op_sel:[0,0] op_sel_hi:[1,0]
v_cvt_pk_bf16_f32 v176, v176, v177
v_cvt_pk_bf16_f32 v177, v178, v179
v_cvt_pk_bf16_f32 v178, v180, v181
v_cvt_pk_bf16_f32 v179, v182, v183
v_accvgpr_read_b32 v184, a68
v_accvgpr_read_b32 v185, a69
v_accvgpr_read_b32 v186, a70
v_accvgpr_read_b32 v187, a71
v_accvgpr_read_b32 v188, a84
v_accvgpr_read_b32 v189, a85
v_accvgpr_read_b32 v190, a86
v_accvgpr_read_b32 v191, a87
M v[24:27], a[112:115], v[176:179], v[24:27]
buffer_store_dwordx4 v[176:179], v1, s[16:19], s38 offen offset:1024 sc1
v_pk_mul_f32 v[184:185], v[184:185], v[8:9] op_sel:[0,1] op_sel_hi:[1,1]
v_pk_mul_f32 v[186:187], v[186:187], v[8:9] op_sel:[0,1] op_sel_hi:[1,1]
v_pk_mul_f32 v[188:189], v[188:189], v[8:9] op_sel:[0,1] op_sel_hi:[1,1]
v_pk_mul_f32 v[190:191], v[190:191], v[8:9] op_sel:[0,1] op_sel_hi:[1,1]
v_cvt_pk_bf16_f32 v184, v184, v185
v_cvt_pk_bf16_f32 v185, v186, v187
v_cvt_pk_bf16_f32 v186, v188, v189
v_cvt_pk_bf16_f32 v187, v190, v191
v_accvgpr_read_b32 v208, a72
v_accvgpr_read_b32 v209, a73
v_accvgpr_read_b32 v210, a74
v_accvgpr_read_b32 v211, a75
v_accvgpr_read_b32 v212, a88
v_accvgpr_read_b32 v213, a89
v_accvgpr_read_b32 v214, a90
v_accvgpr_read_b32 v215, a91
M v[24:27], a[112:115], v[184:187], v[24:27]
buffer_store_dwordx4 v[184:187], v1, s[16:19], s38 offen offset:3072 sc1
v_pk_mul_f32 v[208:209], v[208:209], v[10:11] op_sel:[0,0] op_sel_hi:[1,0]
v_pk_mul_f32 v[210:211], v[210:211], v[10:11] op_sel:[0,0] op_sel_hi:[1,0]
v_pk_mul_f32 v[212:213], v[212:213], v[10:11] op_sel:[0,0] op_sel_hi:[1,0]
v_pk_mul_f32 v[214:215], v[214:215], v[10:11] op_sel:[0,0] op_sel_hi:[1,0]
v_cvt_pk_bf16_f32 v208, v208, v209
v_cvt_pk_bf16_f32 v209, v210, v211
v_cvt_pk_bf16_f32 v210, v212, v213
v_cvt_pk_bf16_f32 v211, v214, v215
v_accvgpr_read_b32 v216, a76
v_accvgpr_read_b32 v217, a77
v_accvgpr_read_b32 v218, a78
v_accvgpr_read_b32 v219, a79
v_accvgpr_read_b32 v220, a92
v_accvgpr_read_b32 v221, a93
v_accvgpr_read_b32 v222, a94
v_accvgpr_read_b32 v223, a95
M v[24:27], a[112:115], v[208:211], v[24:27]
buffer_store_dwordx4 v[208:211], v1, s[16:19], s39 offen offset:1024 sc1
v_pk_mul_f32 v[216:217], v[216:217], v[10:11] op_sel:[0,1] op_sel_hi:[1,1]
v_pk_mul_f32 v[218:219], v[218:219], v[10:11] op_sel:[0,1] op_sel_hi:[1,1]
v_pk_mul_f32 v[220:221], v[220:221], v[10:11] op_sel:[0,1] op_sel_hi:[1,1]
v_pk_mul_f32 v[222:223], v[222:223], v[10:11] op_sel:[0,1] op_sel_hi:[1,1]
v_cvt_pk_bf16_f32 v216, v216, v217
v_cvt_pk_bf16_f32 v217, v218, v219
v_cvt_pk_bf16_f32 v218, v220, v221
v_cvt_pk_bf16_f32 v219, v222, v223
s_nop 1
M v[24:27], a[112:115], v[216:219], v[24:27]
buffer_store_dwordx4 v[216:219], v1, s[16:19], s39 offen offset:3072 sc1
v_cmp_lt_u32 vcc, 0x3c000000, v12
s_nop 5
v_cmp_class_f32 s[40:41], v24, s64
s_nop 0
s_or_b64 vcc, vcc, s[40:41]
s_cmp_lg_u64 vcc, 0
s_cselect_b32 s33, 1, 0
s_or_b32 s60, s60, s33
s_sub_u32 s30, 7, s21
s_cmp_lg_u32 s30, 0
s_cbranch_scc1 Lk2_b0
s_and_b32 s3, s2, 3
s_lshl_b32 s3, s3, 2
s_bfe_u32 s27, s2, 0x20003
s_add_u32 s27, s3, s27
s_lshl_b32 s43, s27, 8
s_add_u32 s43, s43, 8400896
v_lshlrev_b32 v15, 2, v0
buffer_load_dword v7, v15, s[52:55], s43 offen sc1
s_waitcnt lgkmcnt(7)
ds_read_b128 a[116:119], v2 offset:32768
s_waitcnt lgkmcnt(7)
ds_read_b128 a[120:123], v2 offset:40960
s_waitcnt lgkmcnt(7)
ds_read_b128 a[124:127], v2 offset:33792
s_waitcnt lgkmcnt(7)
ds_read_b128 a[128:131], v2 offset:41984
s_waitcnt lgkmcnt(7)
ds_read_b128 a[132:135], v2 offset:34816
s_waitcnt lgkmcnt(7)
ds_read_b128 a[136:139], v2 offset:43008
s_waitcnt lgkmcnt(7)
ds_read_b128 a[140:143], v2 offset:35840
s_waitcnt lgkmcnt(7)
ds_read_b128 a[144:147], v2 offset:44032
v_exp_f32 v64, v64
v_exp_f32 v65, v65
v_exp_f32 v66, v66
v_exp_f32 v67, v67
v_exp_f32 v80, v80
v_exp_f32 v81, v81
v_exp_f32 v82, v82
v_exp_f32 v83, v83
v_cvt_pk_bf16_f32 v64, v64, v65
v_cvt_pk_bf16_f32 v65, v66, v67
v_exp_f32 v68, v68
v_exp_f32 v69, v69
v_exp_f32 v70, v70
v_exp_f32 v71, v71
v_cvt_pk_bf16_f32 v66, v80, v81
v_cvt_pk_bf16_f32 v67, v82, v83
v_exp_f32 v84, v84
v_exp_f32 v85, v85
v_exp_f32 v86, v86
v_exp_f32 v87, v87
v_cvt_pk_bf16_f32 v68, v68, v69
v_cvt_pk_bf16_f32 v69, v70, v71
v_exp_f32 v72, v72
v_exp_f32 v73, v73
v_exp_f32 v74, v74
v_exp_f32 v75, v75
v_cvt_pk_bf16_f32 v70, v84, v85
v_cvt_pk_bf16_f32 v71, v86, v87
v_exp_f32 v88, v88
v_exp_f32 v89, v89
v_exp_f32 v90, v90
v_exp_f32 v91, v91
v_cvt_pk_bf16_f32 v72, v72, v73
v_cvt_pk_bf16_f32 v73, v74, v75
v_exp_f32 v76, v76
v_exp_f32 v77, v77
v_exp_f32 v78, v78
v_exp_f32 v79, v79
v_cvt_pk_bf16_f32 v74, v88, v89
v_cvt_pk_bf16_f32 v75, v90, v91
v_exp_f32 v92, v92
v_exp_f32 v93, v93
v_exp_f32 v94, v94
v_exp_f32 v95, v95
v_cvt_pk_bf16_f32 v76, v76, v77
v_cvt_pk_bf16_f32 v77, v78, v79
v_cvt_pk_bf16_f32 v78, v92, v93
v_cvt_pk_bf16_f32 v79, v94, v95
s_waitcnt lgkmcnt(6)
M v[160:163], a[116:119], v[32:35], 0
M v[160:163], a[120:123], v[64:67], v[160:163]
ds_read_b128 a[148:151], v2 offset:36864
ds_read_b128 a[152:155], v2 offset:45056
s_mov_b32 s61, 0
M v[164:167], a[120:123], v[68:71], 0
M v[164:167], a[116:119], v[36:39], v[164:167]
s_bfe_u32 s3, s2, 0x10002
M v[168:171], a[116:119], v[40:43], 0
M v[168:171], a[120:123], v[72:75], v[168:171]
s_lshl_b32 s3, s3, 3
M v[172:175], a[120:123], v[76:79], 0
M v[172:175], a[116:119], v[44:47], v[172:175]
s_waitcnt lgkmcnt(6)
s_lshr_b32 s28, s2, 5
M a[96:99], a[112:115], v[32:35], 0
M a[96:99], a[112:115], v[64:67], a[96:99]
M v[176:179], a[124:127], v[32:35], 0
M v[176:179], a[128:131], v[64:67], v[176:179]
ds_read_b128 a[156:159], v2 offset:37888
ds_read_b128 a[160:163], v2 offset:46080
s_add_u32 s28, s3, s28
M v[180:183], a[128:131], v[68:71], 0
s_lshl_b32 s25, s27, 18
M v[180:183], a[124:127], v[36:39], v[180:183]
M v[184:187], a[124:127], v[40:43], 0
s_lshl_b32 s3, s101, 12
M v[184:187], a[128:131], v[72:75], v[184:187]
M v[188:191], a[128:131], v[76:79], 0
s_add_u32 s25, s25, s3
M v[188:191], a[124:127], v[44:47], v[188:191]
s_waitcnt lgkmcnt(6)
M a[100:103], a[112:115], v[36:39], 0
M a[100:103], a[112:115], v[68:71], a[100:103]
M v[192:195], a[132:135], v[32:35], 0
s_lshl_b32 s26, s28, 7
M v[192:195], a[136:139], v[64:67], v[192:195]
ds_read_b128 a[164:167], v2 offset:38912
ds_read_b128 a[168:171], v2 offset:47104
M v[196:199], a[136:139], v[68:71], 0
s_lshl_b32 s42, s101, 11
M v[196:199], a[132:135], v[36:39], v[196:199]
M v[200:203], a[132:135], v[40:43], 0
s_add_u32 s44, s4, 83886080
s_addc_u32 s45, s5, 0
M v[200:203], a[136:139], v[72:75], v[200:203]
s_mov_b32 s46, 4194304
M v[204:207], a[136:139], v[76:79], 0
M v[204:207], a[132:135], v[44:47], v[204:207]
s_waitcnt lgkmcnt(6)
s_mov_b32 s47, 0x00020000
M a[104:107], a[112:115], v[40:43], 0
M a[104:107], a[112:115], v[72:75], a[104:107]
M v[208:211], a[140:143], v[32:35], 0
M v[208:211], a[144:147], v[64:67], v[208:211]
ds_read_b128 a[172:175], v2 offset:39936
ds_read_b128 a[176:179], v2 offset:48128
s_mov_b32 s50, 2097152
M v[212:215], a[144:147], v[68:71], 0
M v[212:215], a[140:143], v[36:39], v[212:215]
s_mov_b32 s51, 0x00020000
M v[216:219], a[140:143], v[40:43], 0
M v[216:219], a[144:147], v[72:75], v[216:219]
s_lshl_b32 s3, s101, 4
M v[220:223], a[144:147], v[76:79], 0
M v[220:223], a[140:143], v[44:47], v[220:223]
s_waitcnt lgkmcnt(6)
v_lshrrev_b32 v96, 3, v0
M a[108:111], a[112:115], v[44:47], 0
M a[108:111], a[112:115], v[76:79], a[108:111]
M v[224:227], a[148:151], v[32:35], 0
v_and_b32 v97, 6, v96
M v[224:227], a[152:155], v[64:67], v[224:227]
M v[228:231], a[152:155], v[68:71], 0
v_and_b32 v98, 7, v0
M v[228:231], a[148:151], v[36:39], v[228:231]
M v[232:235], a[148:151], v[40:43], 0
v_xor_b32 v97, v97, v98
M v[232:235], a[152:155], v[72:75], v[232:235]
M v[236:239], a[152:155], v[76:79], 0
v_add_u32 v96, s3, v96
M v[236:239], a[148:151], v[44:47], v[236:239]
s_waitcnt lgkmcnt(4)
M v[240:243], a[156:159], v[32:35], 0
v_lshlrev_b32 v96, 11, v96
M v[240:243], a[160:163], v[64:67], v[240:243]
M v[244:247], a[160:163], v[68:71], 0
v_lshl_add_u32 v99, v97, 4, v96
M v[244:247], a[156:159], v[36:39], v[244:247]
v_add_u32 v100, 15360, v99
M v[248:251], a[156:159], v[40:43], 0
M v[248:251], a[160:163], v[72:75], v[248:251]
s_waitcnt vmcnt(0) lgkmcnt(0)
s_barrier
v_cmp_ne_u32 vcc, 1, v7
s_nop 0
s_cbranch_vccnz Lk3_spinb1
Lk3_gotb1:
M v[252:255], a[160:163], v[76:79], 0
s_add_u32 m0, s42, 65536
s_nop 0
buffer_load_dwordx4 v99, s[48:51], s26 offen offset:0 lds
buffer_load_dwordx4 v100, s[48:51], s26 offen offset:1024 lds
M v[252:255], a[156:159], v[44:47], v[252:255]
buffer_load_dwordx4 a[192:195], v1, s[44:47], s25 offen offset:0 sc1
buffer_load_dwordx4 a[196:199], v1, s[44:47], s25 offen offset:1024 sc1
M a[64:67], a[164:167], v[32:35], 0
buffer_load_dwordx4 a[200:203], v1, s[44:47], s25 offen offset:2048 sc1
buffer_load_dwordx4 a[204:207], v1, s[44:47], s25 offen offset:3072 sc1
M a[64:67], a[168:171], v[64:67], a[64:67]
s_add_u32 s25, s25, 16384
s_add_u32 s26, s26, 131072
s_add_u32 m0, s42, 81920
s_nop 0
buffer_load_dwordx4 v99, s[48:51], s26 offen offset:0 lds
M a[68:71], a[168:171], v[68:71], 0
buffer_load_dwordx4 v100, s[48:51], s26 offen offset:1024 lds
buffer_load_dwordx4 a[208:211], v1, s[44:47], s25 offen offset:0 sc1
M a[68:71], a[164:167], v[36:39], a[68:71]
buffer_load_dwordx4 a[212:215], v1, s[44:47], s25 offen offset:1024 sc1
buffer_load_dwordx4 a[216:219], v1, s[44:47], s25 offen offset:2048 sc1
M a[72:75], a[164:167], v[40:43], 0
buffer_load_dwordx4 a[220:223], v1, s[44:47], s25 offen offset:3072 sc1
s_add_u32 s25, s25, 16384
s_add_u32 s26, s26, 131072
M a[72:75], a[168:171], v[72:75], a[72:75]
s_add_u32 m0, s42, 98304
s_nop 0
buffer_load_dwordx4 v99, s[48:51], s26 offen offset:0 lds
buffer_load_dwordx4 v100, s[48:51], s26 offen offset:1024 lds
M a[76:79], a[168:171], v[76:79], 0
buffer_load_dwordx4 a[224:227], v1, s[44:47], s25 offen offset:0 sc1
M a[76:79], a[164:167], v[44:47], a[76:79]
buffer_load_dwordx4 a[228:231], v1, s[44:47], s25 offen offset:1024 sc1
buffer_load_dwordx4 a[232:235], v1, s[44:47], s25 offen offset:2048 sc1
M a[80:83], a[172:175], v[32:35], 0
buffer_load_dwordx4 a[236:239], v1, s[44:47], s25 offen offset:3072 sc1
s_add_u32 s25, s25, 16384
s_add_u32 s26, s26, 131072
M a[80:83], a[176:179], v[64:67], a[80:83]
s_add_u32 m0, s42, 114688
s_nop 0
buffer_load_dwordx4 v99, s[48:51], s26 offen offset:0 lds
buffer_load_dwordx4 v100, s[48:51], s26 offen offset:1024 lds
M a[84:87], a[176:179], v[68:71], 0
buffer_load_dwordx4 a[240:243], v1, s[44:47], s25 offen offset:0 sc1
buffer_load_dwordx4 a[244:247], v1, s[44:47], s25 offen offset:1024 sc1
M a[84:87], a[172:175], v[36:39], a[84:87]
buffer_load_dwordx4 a[248:251], v1, s[44:47], s25 offen offset:2048 sc1
buffer_load_dwordx4 a[252:255], v1, s[44:47], s25 offen offset:3072 sc1
M a[88:91], a[172:175], v[40:43], 0
s_add_u32 s25, s25, 16384
s_add_u32 s26, s26, 131072
s_add_u32 m0, s42, 0
s_nop 0
buffer_load_dwordx4 v99, s[48:51], s26 offen offset:0 lds
M a[88:91], a[176:179], v[72:75], a[88:91]
buffer_load_dwordx4 v100, s[48:51], s26 offen offset:1024 lds
buffer_load_dwordx4 a[128:131], v1, s[44:47], s25 offen offset:0 sc1
M a[92:95], a[176:179], v[76:79], 0
buffer_load_dwordx4 a[132:135], v1, s[44:47], s25 offen offset:1024 sc1
buffer_load_dwordx4 a[136:139], v1, s[44:47], s25 offen offset:2048 sc1
M a[92:95], a[172:175], v[44:47], a[92:95]
buffer_load_dwordx4 a[140:143], v1, s[44:47], s25 offen offset:3072 sc1
s_add_u32 s25, s25, 16384
s_add_u32 s26, s26, 131072
s_branch Lk2_merge
Lk2_b0:
s_add_u32 m0, s29, 65536
s_waitcnt lgkmcnt(4)
M v[96:99], a[116:119], a[180:183], 0
v_exp_f32 v64, v64
M v[96:99], a[120:123], a[184:187], v[96:99]
ds_read_b128 a[148:151], v2 offset:8192
ds_read_b128 a[152:155], v2 offset:9216
M v[96:99], a[124:127], a[188:191], v[96:99]
v_exp_f32 v65, v65
M v[96:99], a[128:131], a[192:195], v[96:99]
buffer_load_dwordx4 v1, s[12:15], s25 offen offset:0 sc1 lds
s_add_u32 s32, s25, 4096
M v[100:103], a[128:131], a[208:211], 0
v_exp_f32 v66, v66
M v[100:103], a[124:127], a[204:207], v[100:103]
v_cvt_pk_bf16_f32 v64, v64, v65
M v[100:103], a[120:123], a[200:203], v[100:103]
v_exp_f32 v67, v67
M v[100:103], a[116:119], a[196:199], v[100:103]
buffer_load_dwordx4 v1, s[12:15], s25 offen offset:1024 sc1 lds
M v[104:107], a[116:119], a[212:215], 0
v_exp_f32 v80, v80
M v[104:107], a[120:123], a[216:219], v[104:107]
ds_read_b128 a[156:159], v2 offset:10240
ds_read_b128 a[160:163], v2 offset:11264
M v[104:107], a[124:127], a[220:223], v[104:107]
v_exp_f32 v81, v81
M v[104:107], a[128:131], a[224:227], v[104:107]
buffer_load_dwordx4 v1, s[12:15], s25 offen offset:2048 sc1 lds
M v[108:111], a[128:131], a[240:243], 0
v_exp_f32 v82, v82
M v[108:111], a[124:127], a[236:239], v[108:111]
v_cvt_pk_bf16_f32 v65, v66, v67
v_cvt_pk_bf16_f32 v66, v80, v81
M v[108:111], a[120:123], a[232:235], v[108:111]
v_exp_f32 v83, v83
M v[108:111], a[116:119], a[228:231], v[108:111]
buffer_load_dwordx4 v1, s[12:15], s25 offen offset:3072 sc1 lds
s_add_u32 m0, s29, 69632
s_waitcnt lgkmcnt(4)
M v[112:115], a[132:135], a[180:183], 0
v_exp_f32 v68, v68
M v[112:115], a[136:139], a[184:187], v[112:115]
ds_read_b128 a[164:167], v2 offset:12288
ds_read_b128 a[168:171], v2 offset:13312
M v[112:115], a[140:143], a[188:191], v[112:115]
v_exp_f32 v69, v69
M v[112:115], a[144:147], a[192:195], v[112:115]
buffer_load_dwordx4 v1, s[12:15], s32 offen offset:0 sc1 lds
M v[116:119], a[144:147], a[208:211], 0
v_exp_f32 v70, v70
M v[116:119], a[140:143], a[204:207], v[116:119]
v_cvt_pk_bf16_f32 v67, v82, v83
v_cvt_pk_bf16_f32 v68, v68, v69
M v[116:119], a[136:139], a[200:203], v[116:119]
v_exp_f32 v71, v71
M v[116:119], a[132:135], a[196:199], v[116:119]
buffer_load_dwordx4 v1, s[12:15], s32 offen offset:1024 sc1 lds
M v[120:123], a[132:135], a[212:215], 0
v_exp_f32 v84, v84
M v[120:123], a[136:139], a[216:219], v[120:123]
ds_read_b128 a[172:175], v2 offset:14336
ds_read_b128 a[176:179], v2 offset:15360
M v[120:123], a[140:143], a[220:223], v[120:123]
v_exp_f32 v85, v85
M v[120:123], a[144:147], a[224:227], v[120:123]
buffer_load_dwordx4 v1, s[12:15], s32 offen offset:2048 sc1 lds
M v[124:127], a[144:147], a[240:243], 0
v_exp_f32 v86, v86
M v[124:127], a[140:143], a[236:239], v[124:127]
v_cvt_pk_bf16_f32 v69, v70, v71
v_cvt_pk_bf16_f32 v70, v84, v85
M v[124:127], a[136:139], a[232:235], v[124:127]
v_exp_f32 v87, v87
M v[124:127], a[132:135], a[228:231], v[124:127]
buffer_load_dwordx4 v1, s[12:15], s32 offen offset:3072 sc1 lds
s_add_u32 m0, s29, 98304
s_waitcnt lgkmcnt(4)
M v[128:131], a[148:151], a[180:183], 0
v_exp_f32 v72, v72
M v[128:131], a[152:155], a[184:187], v[128:131]
ds_read_b128 a[116:119], v2 offset:32768
ds_read_b128 a[120:123], v2 offset:40960
M v[128:131], a[156:159], a[188:191], v[128:131]
v_exp_f32 v73, v73
M v[128:131], a[160:163], a[192:195], v[128:131]
buffer_load_dwordx4 v1, s[12:15], s26 offen offset:0 sc1 lds
s_add_u32 s43, s26, 4096
M v[132:135], a[160:163], a[208:211], 0
v_exp_f32 v74, v74
M v[132:135], a[156:159], a[204:207], v[132:135]
v_cvt_pk_bf16_f32 v71, v86, v87
v_cvt_pk_bf16_f32 v72, v72, v73
M v[132:135], a[152:155], a[200:203], v[132:135]
v_exp_f32 v75, v75
M v[132:135], a[148:151], a[196:199], v[132:135]
buffer_load_dwordx4 v1, s[12:15], s26 offen offset:1024 sc1 lds
M v[136:139], a[148:151], a[212:215], 0
v_exp_f32 v88, v88
M v[136:139], a[152:155], a[216:219], v[136:139]
ds_read_b128 a[124:127], v2 offset:33792
ds_read_b128 a[128:131], v2 offset:41984
M v[136:139], a[156:159], a[220:223], v[136:139]
v_exp_f32 v89, v89
M v[136:139], a[160:163], a[224:227], v[136:139]
buffer_load_dwordx4 v1, s[12:15], s26 offen offset:2048 sc1 lds
M v[140:143], a[160:163], a[240:243], 0
v_exp_f32 v90, v90
M v[140:143], a[156:159], a[236:239], v[140:143]
v_cvt_pk_bf16_f32 v73, v74, v75
v_cvt_pk_bf16_f32 v74, v88, v89
M v[140:143], a[152:155], a[232:235], v[140:143]
v_exp_f32 v91, v91
M v[140:143], a[148:151], a[228:231], v[140:143]
buffer_load_dwordx4 v1, s[12:15], s26 offen offset:3072 sc1 lds
s_add_u32 m0, s29, 102400
s_waitcnt lgkmcnt(4)
M v[144:147], a[164:167], a[180:183], 0
v_exp_f32 v76, v76
M v[144:147], a[168:171], a[184:187], v[144:147]
ds_read_b128 a[132:135], v2 offset:34816
ds_read_b128 a[136:139], v2 offset:43008
M v[144:147], a[172:175], a[188:191], v[144:147]
v_exp_f32 v77, v77
M v[144:147], a[176:179], a[192:195], v[144:147]
buffer_load_dwordx4 v1, s[12:15], s43 offen offset:0 sc1 lds
M v[148:151], a[176:179], a[208:211], 0
v_exp_f32 v78, v78
M v[148:151], a[172:175], a[204:207], v[148:151]
v_cvt_pk_bf16_f32 v75, v90, v91
v_cvt_pk_bf16_f32 v76, v76, v77
M v[148:151], a[168:171], a[200:203], v[148:151]
v_exp_f32 v79, v79
M v[148:151], a[164:167], a[196:199], v[148:151]
buffer_load_dwordx4 v1, s[12:15], s43 offen offset:1024 sc1 lds
M v[152:155], a[164:167], a[212:215], 0
v_exp_f32 v92, v92
M v[152:155], a[168:171], a[216:219], v[152:155]
ds_read_b128 a[140:143], v2 offset:35840
ds_read_b128 a[144:147], v2 offset:44032
M v[152:155], a[172:175], a[220:223], v[152:155]
v_exp_f32 v93, v93
M v[152:155], a[176:179], a[224:227], v[152:155]
buffer_load_dwordx4 v1, s[12:15], s43 offen offset:2048 sc1 lds
M v[156:159], a[176:179], a[240:243], 0
v_exp_f32 v94, v94
M v[156:159], a[172:175], a[236:239], v[156:159]
v_cvt_pk_bf16_f32 v77, v78, v79
v_cvt_pk_bf16_f32 v78, v92, v93
M v[156:159], a[168:171], a[232:235], v[156:159]
v_exp_f32 v95, v95
M v[156:159], a[164:167], a[228:231], v[156:159]
buffer_load_dwordx4 v1, s[12:15], s43 offen offset:3072 sc1 lds
v_cvt_pk_bf16_f32 v79, v94, v95
s_waitcnt lgkmcnt(6)
M v[160:163], a[116:119], v[32:35], 0
v_exp_f32 v96, v96
M v[160:163], a[120:123], v[64:67], v[160:163]
ds_read_b128 a[148:151], v2 offset:36864
ds_read_b128 a[152:155], v2 offset:45056
M v[164:167], a[120:123], v[68:71], 0
v_exp_f32 v97, v97
M v[164:167], a[116:119], v[36:39], v[164:167]
v_cvt_pk_bf16_f32 v96, v96, v97
M v[168:171], a[116:119], v[40:43], 0
v_exp_f32 v98, v98
M v[168:171], a[120:123], v[72:75], v[168:171]
s_add_u32 s25, s25, 32768
s_cmp_eq_u32 s25, s27
M v[172:175], a[120:123], v[76:79], 0
v_exp_f32 v99, v99
M v[172:175], a[116:119], v[44:47], v[172:175]
v_cvt_pk_bf16_f32 v97, v98, v99
s_waitcnt lgkmcnt(6)
M a[96:99], a[112:115], v[32:35], 0
s_cselect_b32 s25, s28, s25
s_cselect_b32 s27, -1, s27
M a[96:99], a[112:115], v[64:67], a[96:99]
s_add_u32 s26, s26, 32768
s_cmp_eq_u32 s26, s62
M v[176:179], a[124:127], v[32:35], 0
v_exp_f32 v112, v112
M v[176:179], a[128:131], v[64:67], v[176:179]
ds_read_b128 a[156:159], v2 offset:37888
ds_read_b128 a[160:163], v2 offset:46080
M v[180:183], a[128:131], v[68:71], 0
v_exp_f32 v113, v113
M v[180:183], a[124:127], v[36:39], v[180:183]
v_cvt_pk_bf16_f32 v98, v112, v113
M v[184:187], a[124:127], v[40:43], 0
v_exp_f32 v114, v114
M v[184:187], a[128:131], v[72:75], v[184:187]
s_cselect_b32 s26, s63, s26
s_cselect_b32 s62, -1, s62
M v[188:191], a[128:131], v[76:79], 0
v_exp_f32 v115, v115
M v[188:191], a[124:127], v[44:47], v[188:191]
v_cvt_pk_bf16_f32 v99, v114, v115
s_waitcnt lgkmcnt(6)
M a[100:103], a[112:115], v[36:39], 0
M a[100:103], a[112:115], v[68:71], a[100:103]
M v[192:195], a[132:135], v[32:35], 0
v_exp_f32 v100, v100
M v[192:195], a[136:139], v[64:67], v[192:195]
ds_read_b128 a[164:167], v2 offset:38912
ds_read_b128 a[168:171], v2 offset:47104
M v[196:199], a[136:139], v[68:71], 0
v_exp_f32 v101, v101
M v[196:199], a[132:135], v[36:39], v[196:199]
v_cvt_pk_bf16_f32 v100, v100, v101
M v[200:203], a[132:135], v[40:43], 0
v_exp_f32 v102, v102
M v[200:203], a[136:139], v[72:75], v[200:203]
M v[204:207], a[136:139], v[76:79], 0
v_exp_f32 v103, v103
M v[204:207], a[132:135], v[44:47], v[204:207]
v_cvt_pk_bf16_f32 v101, v102, v103
s_waitcnt lgkmcnt(6)
M a[104:107], a[112:115], v[40:43], 0
M a[104:107], a[112:115], v[72:75], a[104:107]
M v[208:211], a[140:143], v[32:35], 0
v_exp_f32 v116, v116
M v[208:211], a[144:147], v[64:67], v[208:211]
ds_read_b128 a[172:175], v2 offset:39936
ds_read_b128 a[176:179], v2 offset:48128
M v[212:215], a[144:147], v[68:71], 0
v_exp_f32 v117, v117
M v[212:215], a[140:143], v[36:39], v[212:215]
v_cvt_pk_bf16_f32 v102, v116, v117
M v[216:219], a[140:143], v[40:43], 0
v_exp_f32 v118, v118
M v[216:219], a[144:147], v[72:75], v[216:219]
M v[220:223], a[144:147], v[76:79], 0
v_exp_f32 v119, v119
M v[220:223], a[140:143], v[44:47], v[220:223]
v_cvt_pk_bf16_f32 v103, v118, v119
s_waitcnt lgkmcnt(6)
M a[108:111], a[112:115], v[44:47], 0
M a[108:111], a[112:115], v[76:79], a[108:111]
M v[224:227], a[148:151], v[32:35], 0
v_exp_f32 v104, v104
M v[224:227], a[152:155], v[64:67], v[224:227]
M v[228:231], a[152:155], v[68:71], 0
v_exp_f32 v105, v105
M v[228:231], a[148:151], v[36:39], v[228:231]
v_cvt_pk_bf16_f32 v104, v104, v105
M v[232:235], a[148:151], v[40:43], 0
v_exp_f32 v106, v106
M v[232:235], a[152:155], v[72:75], v[232:235]
M v[236:239], a[152:155], v[76:79], 0
v_exp_f32 v107, v107
M v[236:239], a[148:151], v[44:47], v[236:239]
v_cvt_pk_bf16_f32 v105, v106, v107
s_waitcnt lgkmcnt(4)
M v[240:243], a[156:159], v[32:35], 0
v_exp_f32 v120, v120
M v[240:243], a[160:163], v[64:67], v[240:243]
M v[244:247], a[160:163], v[68:71], 0
v_exp_f32 v121, v121
M v[244:247], a[156:159], v[36:39], v[244:247]
v_cvt_pk_bf16_f32 v106, v120, v121
M v[248:251], a[156:159], v[40:43], 0
v_exp_f32 v122, v122
M v[248:251], a[160:163], v[72:75], v[248:251]
s_waitcnt vmcnt(0) lgkmcnt(0)
s_barrier
ds_read_b128 a[116:119], v3 offset:0
ds_read_b128 a[120:123], v3 offset:1024
M v[252:255], a[160:163], v[76:79], 0
v_exp_f32 v123, v123
M v[252:255], a[156:159], v[44:47], v[252:255]
v_cvt_pk_bf16_f32 v107, v122, v123
M a[64:67], a[164:167], v[32:35], 0
v_exp_f32 v108, v108
M a[64:67], a[168:171], v[64:67], a[64:67]
ds_read_b128 a[124:127], v3 offset:2048
ds_read_b128 a[128:131], v3 offset:3072
M a[68:71], a[168:171], v[68:71], 0
v_exp_f32 v109, v109
M a[68:71], a[164:167], v[36:39], a[68:71]
v_cvt_pk_bf16_f32 v108, v108, v109
M a[72:75], a[164:167], v[40:43], 0
v_exp_f32 v110, v110
M a[72:75], a[168:171], v[72:75], a[72:75]
ds_read_b128 a[132:135], v3 offset:4096
ds_read_b128 a[136:139], v3 offset:5120
M a[76:79], a[168:171], v[76:79], 0
v_exp_f32 v111, v111
M a[76:79], a[164:167], v[44:47], a[76:79]
v_cvt_pk_bf16_f32 v109, v110, v111
M a[80:83], a[172:175], v[32:35], 0
v_exp_f32 v124, v124
M a[80:83], a[176:179], v[64:67], a[80:83]
ds_read_b128 a[140:143], v3 offset:6144
ds_read_b128 a[144:147], v3 offset:7168
M a[84:87], a[176:179], v[68:71], 0
v_exp_f32 v125, v125
M a[84:87], a[172:175], v[36:39], a[84:87]
v_cvt_pk_bf16_f32 v110, v124, v125
M a[88:91], a[172:175], v[40:43], 0
v_exp_f32 v126, v126
M a[88:91], a[176:179], v[72:75], a[88:91]
M a[92:95], a[176:179], v[76:79], 0
v_exp_f32 v127, v127
M a[92:95], a[172:175], v[44:47], a[92:95]
v_cvt_pk_bf16_f32 v111, v126, v127
s_branch Lk2_l2b
Lk2_l2:
s_add_u32 m0, s29, 65536
s_waitcnt lgkmcnt(4)
M v[96:99], a[116:119], a[180:183], 0
v_exp_f32 v64, v64
M v[96:99], a[120:123], a[184:187], v[96:99]
ds_read_b128 a[148:151], v2 offset:8192
ds_read_b128 a[152:155], v2 offset:9216
M v[96:99], a[124:127], a[188:191], v[96:99]
v_exp_f32 v65, v65
M v[96:99], a[128:131], a[192:195], v[96:99]
buffer_load_dwordx4 v1, s[12:15], s25 offen offset:0 sc1 lds
s_add_u32 s32, s25, 4096
M v[100:103], a[128:131], a[208:211], 0
v_exp_f32 v66, v66
M v[100:103], a[124:127], a[204:207], v[100:103]
v_cvt_pk_bf16_f32 v64, v64, v65
M v[100:103], a[120:123], a[200:203], v[100:103]
v_exp_f32 v67, v67
M v[100:103], a[116:119], a[196:199], v[100:103]
buffer_load_dwordx4 v1, s[12:15], s25 offen offset:1024 sc1 lds
M v[104:107], a[116:119], a[212:215], 0
v_exp_f32 v80, v80
M v[104:107], a[120:123], a[216:219], v[104:107]
ds_read_b128 a[156:159], v2 offset:10240
ds_read_b128 a[160:163], v2 offset:11264
M v[104:107], a[124:127], a[220:223], v[104:107]
v_exp_f32 v81, v81
M v[104:107], a[128:131], a[224:227], v[104:107]
buffer_load_dwordx4 v1, s[12:15], s25 offen offset:2048 sc1 lds
M v[108:111], a[128:131], a[240:243], 0
v_exp_f32 v82, v82
M v[108:111], a[124:127], a[236:239], v[108:111]
v_cvt_pk_bf16_f32 v65, v66, v67
v_cvt_pk_bf16_f32 v66, v80, v81
M v[108:111], a[120:123], a[232:235], v[108:111]
v_exp_f32 v83, v83
M v[108:111], a[116:119], a[228:231], v[108:111]
buffer_load_dwordx4 v1, s[12:15], s25 offen offset:3072 sc1 lds
s_add_u32 m0, s29, 69632
s_waitcnt lgkmcnt(4)
M v[112:115], a[132:135], a[180:183], 0
v_exp_f32 v68, v68
M v[112:115], a[136:139], a[184:187], v[112:115]
ds_read_b128 a[164:167], v2 offset:12288
ds_read_b128 a[168:171], v2 offset:13312
M v[112:115], a[140:143], a[188:191], v[112:115]
v_exp_f32 v69, v69
M v[112:115], a[144:147], a[192:195], v[112:115]
buffer_load_dwordx4 v1, s[12:15], s32 offen offset:0 sc1 lds
M v[116:119], a[144:147], a[208:211], 0
v_exp_f32 v70, v70
M v[116:119], a[140:143], a[204:207], v[116:119]
v_cvt_pk_bf16_f32 v67, v82, v83
v_cvt_pk_bf16_f32 v68, v68, v69
M v[116:119], a[136:139], a[200:203], v[116:119]
v_exp_f32 v71, v71
M v[116:119], a[132:135], a[196:199], v[116:119]
buffer_load_dwordx4 v1, s[12:15], s32 offen offset:1024 sc1 lds
M v[120:123], a[132:135], a[212:215], 0
v_exp_f32 v84, v84
M v[120:123], a[136:139], a[216:219], v[120:123]
ds_read_b128 a[172:175], v2 offset:14336
ds_read_b128 a[176:179], v2 offset:15360
M v[120:123], a[140:143], a[220:223], v[120:123]
v_exp_f32 v85, v85
M v[120:123], a[144:147], a[224:227], v[120:123]
buffer_load_dwordx4 v1, s[12:15], s32 offen offset:2048 sc1 lds
M v[124:127], a[144:147], a[240:243], 0
v_exp_f32 v86, v86
M v[124:127], a[140:143], a[236:239], v[124:127]
v_cvt_pk_bf16_f32 v69, v70, v71
v_cvt_pk_bf16_f32 v70, v84, v85
M v[124:127], a[136:139], a[232:235], v[124:127]
v_exp_f32 v87, v87
M v[124:127], a[132:135], a[228:231], v[124:127]
buffer_load_dwordx4 v1, s[12:15], s32 offen offset:3072 sc1 lds
s_add_u32 m0, s29, 98304
s_waitcnt lgkmcnt(4)
M v[128:131], a[148:151], a[180:183], 0
v_exp_f32 v72, v72
M v[128:131], a[152:155], a[184:187], v[128:131]
ds_read_b128 a[116:119], v2 offset:32768
ds_read_b128 a[120:123], v2 offset:40960
M v[128:131], a[156:159], a[188:191], v[128:131]
v_exp_f32 v73, v73
M v[128:131], a[160:163], a[192:195], v[128:131]
buffer_load_dwordx4 v1, s[12:15], s26 offen offset:0 sc1 lds
s_add_u32 s43, s26, 4096
M v[132:135], a[160:163], a[208:211], 0
v_exp_f32 v74, v74
M v[132:135], a[156:159], a[204:207], v[132:135]
v_cvt_pk_bf16_f32 v71, v86, v87
v_cvt_pk_bf16_f32 v72, v72, v73
M v[132:135], a[152:155], a[200:203], v[132:135]
v_exp_f32 v75, v75
M v[132:135], a[148:151], a[196:199], v[132:135]
buffer_load_dwordx4 v1, s[12:15], s26 offen offset:1024 sc1 lds
M v[136:139], a[148:151], a[212:215], 0
v_exp_f32 v88, v88
M v[136:139], a[152:155], a[216:219], v[136:139]
ds_read_b128 a[124:127], v2 offset:33792
ds_read_b128 a[128:131], v2 offset:41984
M v[136:139], a[156:159], a[220:223], v[136:139]
v_exp_f32 v89, v89
M v[136:139], a[160:163], a[224:227], v[136:139]
buffer_load_dwordx4 v1, s[12:15], s26 offen offset:2048 sc1 lds
M v[140:143], a[160:163], a[240:243], 0
v_exp_f32 v90, v90
M v[140:143], a[156:159], a[236:239], v[140:143]
v_cvt_pk_bf16_f32 v73, v74, v75
v_cvt_pk_bf16_f32 v74, v88, v89
M v[140:143], a[152:155], a[232:235], v[140:143]
v_exp_f32 v91, v91
M v[140:143], a[148:151], a[228:231], v[140:143]
buffer_load_dwordx4 v1, s[12:15], s26 offen offset:3072 sc1 lds
s_add_u32 m0, s29, 102400
s_waitcnt lgkmcnt(4)
M v[144:147], a[164:167], a[180:183], 0
v_exp_f32 v76, v76
M v[144:147], a[168:171], a[184:187], v[144:147]
ds_read_b128 a[132:135], v2 offset:34816
ds_read_b128 a[136:139], v2 offset:43008
M v[144:147], a[172:175], a[188:191], v[144:147]
v_exp_f32 v77, v77
M v[144:147], a[176:179], a[192:195], v[144:147]
buffer_load_dwordx4 v1, s[12:15], s43 offen offset:0 sc1 lds
M v[148:151], a[176:179], a[208:211], 0
v_exp_f32 v78, v78
M v[148:151], a[172:175], a[204:207], v[148:151]
v_cvt_pk_bf16_f32 v75, v90, v91
v_cvt_pk_bf16_f32 v76, v76, v77
M v[148:151], a[168:171], a[200:203], v[148:151]
v_exp_f32 v79, v79
M v[148:151], a[164:167], a[196:199], v[148:151]
buffer_load_dwordx4 v1, s[12:15], s43 offen offset:1024 sc1 lds
M v[152:155], a[164:167], a[212:215], 0
v_exp_f32 v92, v92
M v[152:155], a[168:171], a[216:219], v[152:155]
ds_read_b128 a[140:143], v2 offset:35840
ds_read_b128 a[144:147], v2 offset:44032
M v[152:155], a[172:175], a[220:223], v[152:155]
v_exp_f32 v93, v93
M v[152:155], a[176:179], a[224:227], v[152:155]
buffer_load_dwordx4 v1, s[12:15], s43 offen offset:2048 sc1 lds
M v[156:159], a[176:179], a[240:243], 0
v_exp_f32 v94, v94
M v[156:159], a[172:175], a[236:239], v[156:159]
v_cvt_pk_bf16_f32 v77, v78, v79
v_cvt_pk_bf16_f32 v78, v92, v93
M v[156:159], a[168:171], a[232:235], v[156:159]
v_exp_f32 v95, v95
M v[156:159], a[164:167], a[228:231], v[156:159]
buffer_load_dwordx4 v1, s[12:15], s43 offen offset:3072 sc1 lds
v_cvt_pk_bf16_f32 v79, v94, v95
s_waitcnt lgkmcnt(6)
M v[160:163], a[116:119], v[32:35], v[160:163]
v_exp_f32 v96, v96
M v[160:163], a[120:123], v[64:67], v[160:163]
ds_read_b128 a[148:151], v2 offset:36864
ds_read_b128 a[152:155], v2 offset:45056
M v[164:167], a[120:123], v[68:71], v[164:167]
v_exp_f32 v97, v97
M v[164:167], a[116:119], v[36:39], v[164:167]
v_cvt_pk_bf16_f32 v96, v96, v97
M v[168:171], a[116:119], v[40:43], v[168:171]
v_exp_f32 v98, v98
M v[168:171], a[120:123], v[72:75], v[168:171]
s_add_u32 s25, s25, 32768
s_cmp_eq_u32 s25, s27
M v[172:175], a[120:123], v[76:79], v[172:175]
v_exp_f32 v99, v99
M v[172:175], a[116:119], v[44:47], v[172:175]
v_cvt_pk_bf16_f32 v97, v98, v99
s_waitcnt lgkmcnt(6)
M a[96:99], a[112:115], v[32:35], a[96:99]
s_cselect_b32 s25, s28, s25
s_cselect_b32 s27, -1, s27
M a[96:99], a[112:115], v[64:67], a[96:99]
s_add_u32 s26, s26, 32768
s_cmp_eq_u32 s26, s62
M v[176:179], a[124:127], v[32:35], v[176:179]
v_exp_f32 v112, v112
M v[176:179], a[128:131], v[64:67], v[176:179]
ds_read_b128 a[156:159], v2 offset:37888
ds_read_b128 a[160:163], v2 offset:46080
M v[180:183], a[128:131], v[68:71], v[180:183]
v_exp_f32 v113, v113
M v[180:183], a[124:127], v[36:39], v[180:183]
v_cvt_pk_bf16_f32 v98, v112, v113
M v[184:187], a[124:127], v[40:43], v[184:187]
v_exp_f32 v114, v114
M v[184:187], a[128:131], v[72:75], v[184:187]
s_cselect_b32 s26, s63, s26
s_cselect_b32 s62, -1, s62
M v[188:191], a[128:131], v[76:79], v[188:191]
v_exp_f32 v115, v115
M v[188:191], a[124:127], v[44:47], v[188:191]
v_cvt_pk_bf16_f32 v99, v114, v115
s_waitcnt lgkmcnt(6)
M a[100:103], a[112:115], v[36:39], a[100:103]
M a[100:103], a[112:115], v[68:71], a[100:103]
M v[192:195], a[132:135], v[32:35], v[192:195]
v_exp_f32 v100, v100
M v[192:195], a[136:139], v[64:67], v[192:195]
ds_read_b128 a[164:167], v2 offset:38912
ds_read_b128 a[168:171], v2 offset:47104
M v[196:199], a[136:139], v[68:71], v[196:199]
v_exp_f32 v101, v101
M v[196:199], a[132:135], v[36:39], v[196:199]
v_cvt_pk_bf16_f32 v100, v100, v101
M v[200:203], a[132:135], v[40:43], v[200:203]
v_exp_f32 v102, v102
M v[200:203], a[136:139], v[72:75], v[200:203]
M v[204:207], a[136:139], v[76:79], v[204:207]
v_exp_f32 v103, v103
M v[204:207], a[132:135], v[44:47], v[204:207]
v_cvt_pk_bf16_f32 v101, v102, v103
s_waitcnt lgkmcnt(6)
M a[104:107], a[112:115], v[40:43], a[104:107]
M a[104:107], a[112:115], v[72:75], a[104:107]
M v[208:211], a[140:143], v[32:35], v[208:211]
v_exp_f32 v116, v116
M v[208:211], a[144:147], v[64:67], v[208:211]
ds_read_b128 a[172:175], v2 offset:39936
ds_read_b128 a[176:179], v2 offset:48128
M v[212:215], a[144:147], v[68:71], v[212:215]
v_exp_f32 v117, v117
M v[212:215], a[140:143], v[36:39], v[212:215]
v_cvt_pk_bf16_f32 v102, v116, v117
M v[216:219], a[140:143], v[40:43], v[216:219]
v_exp_f32 v118, v118
M v[216:219], a[144:147], v[72:75], v[216:219]
M v[220:223], a[144:147], v[76:79], v[220:223]
v_exp_f32 v119, v119
M v[220:223], a[140:143], v[44:47], v[220:223]
v_cvt_pk_bf16_f32 v103, v118, v119
s_waitcnt lgkmcnt(6)
M a[108:111], a[112:115], v[44:47], a[108:111]
M a[108:111], a[112:115], v[76:79], a[108:111]
M v[224:227], a[148:151], v[32:35], v[224:227]
v_exp_f32 v104, v104
M v[224:227], a[152:155], v[64:67], v[224:227]
M v[228:231], a[152:155], v[68:71], v[228:231]
v_exp_f32 v105, v105
M v[228:231], a[148:151], v[36:39], v[228:231]
v_cvt_pk_bf16_f32 v104, v104, v105
M v[232:235], a[148:151], v[40:43], v[232:235]
v_exp_f32 v106, v106
M v[232:235], a[152:155], v[72:75], v[232:235]
M v[236:239], a[152:155], v[76:79], v[236:239]
v_exp_f32 v107, v107
M v[236:239], a[148:151], v[44:47], v[236:239]
v_cvt_pk_bf16_f32 v105, v106, v107
s_waitcnt lgkmcnt(4)
M v[240:243], a[156:159], v[32:35], v[240:243]
v_exp_f32 v120, v120
M v[240:243], a[160:163], v[64:67], v[240:243]
M v[244:247], a[160:163], v[68:71], v[244:247]
v_exp_f32 v121, v121
M v[244:247], a[156:159], v[36:39], v[244:247]
v_cvt_pk_bf16_f32 v106, v120, v121
M v[248:251], a[156:159], v[40:43], v[248:251]
v_exp_f32 v122, v122
M v[248:251], a[160:163], v[72:75], v[248:251]
s_waitcnt vmcnt(0) lgkmcnt(0)
s_barrier
ds_read_b128 a[116:119], v3 offset:0
ds_read_b128 a[120:123], v3 offset:1024
M v[252:255], a[160:163], v[76:79], v[252:255]
v_exp_f32 v123, v123
M v[252:255], a[156:159], v[44:47], v[252:255]
v_cvt_pk_bf16_f32 v107, v122, v123
M a[64:67], a[164:167], v[32:35], a[64:67]
v_exp_f32 v108, v108
M a[64:67], a[168:171], v[64:67], a[64:67]
ds_read_b128 a[124:127], v3 offset:2048
ds_read_b128 a[128:131], v3 offset:3072
M a[68:71], a[168:171], v[68:71], a[68:71]
v_exp_f32 v109, v109
M a[68:71], a[164:167], v[36:39], a[68:71]
v_cvt_pk_bf16_f32 v108, v108, v109
M a[72:75], a[164:167], v[40:43], a[72:75]
v_exp_f32 v110, v110
M a[72:75], a[168:171], v[72:75], a[72:75]
ds_read_b128 a[132:135], v3 offset:4096
ds_read_b128 a[136:139], v3 offset:5120
M a[76:79], a[168:171], v[76:79], a[76:79]
v_exp_f32 v111, v111
M a[76:79], a[164:167], v[44:47], a[76:79]
v_cvt_pk_bf16_f32 v109, v110, v111
M a[80:83], a[172:175], v[32:35], a[80:83]
v_exp_f32 v124, v124
M a[80:83], a[176:179], v[64:67], a[80:83]
ds_read_b128 a[140:143], v3 offset:6144
ds_read_b128 a[144:147], v3 offset:7168
M a[84:87], a[176:179], v[68:71], a[84:87]
v_exp_f32 v125, v125
M a[84:87], a[172:175], v[36:39], a[84:87]
v_cvt_pk_bf16_f32 v110, v124, v125
M a[88:91], a[172:175], v[40:43], a[88:91]
v_exp_f32 v126, v126
M a[88:91], a[176:179], v[72:75], a[88:91]
M a[92:95], a[176:179], v[76:79], a[92:95]
v_exp_f32 v127, v127
M a[92:95], a[172:175], v[44:47], a[92:95]
v_cvt_pk_bf16_f32 v111, v126, v127
Lk2_l2b:
s_add_u32 m0, s29, 0
s_waitcnt lgkmcnt(4)
M v[32:35], a[116:119], a[180:183], 0
v_exp_f32 v128, v128
M v[32:35], a[120:123], a[184:187], v[32:35]
ds_read_b128 a[148:151], v3 offset:8192
ds_read_b128 a[152:155], v3 offset:9216
M v[32:35], a[124:127], a[188:191], v[32:35]
v_exp_f32 v129, v129
M v[32:35], a[128:131], a[192:195], v[32:35]
buffer_load_dwordx4 v1, s[12:15], s25 offen offset:0 sc1 lds
s_add_u32 s32, s25, 4096
M v[36:39], a[128:131], a[208:211], 0
v_exp_f32 v130, v130
M v[36:39], a[124:127], a[204:207], v[36:39]
v_cvt_pk_bf16_f32 v128, v128, v129
M v[36:39], a[120:123], a[200:203], v[36:39]
v_exp_f32 v131, v131
M v[36:39], a[116:119], a[196:199], v[36:39]
buffer_load_dwordx4 v1, s[12:15], s25 offen offset:1024 sc1 lds
M v[40:43], a[116:119], a[212:215], 0
v_exp_f32 v144, v144
M v[40:43], a[120:123], a[216:219], v[40:43]
ds_read_b128 a[156:159], v3 offset:10240
ds_read_b128 a[160:163], v3 offset:11264
M v[40:43], a[124:127], a[220:223], v[40:43]
v_exp_f32 v145, v145
M v[40:43], a[128:131], a[224:227], v[40:43]
buffer_load_dwordx4 v1, s[12:15], s25 offen offset:2048 sc1 lds
M v[44:47], a[128:131], a[240:243], 0
v_exp_f32 v146, v146
M v[44:47], a[124:127], a[236:239], v[44:47]
v_cvt_pk_bf16_f32 v129, v130, v131
v_cvt_pk_bf16_f32 v130, v144, v145
M v[44:47], a[120:123], a[232:235], v[44:47]
v_exp_f32 v147, v147
M v[44:47], a[116:119], a[228:231], v[44:47]
buffer_load_dwordx4 v1, s[12:15], s25 offen offset:3072 sc1 lds
s_add_u32 m0, s29, 4096
s_waitcnt lgkmcnt(4)
M v[48:51], a[132:135], a[180:183], 0
v_exp_f32 v132, v132
M v[48:51], a[136:139], a[184:187], v[48:51]
ds_read_b128 a[164:167], v3 offset:12288
ds_read_b128 a[168:171], v3 offset:13312
M v[48:51], a[140:143], a[188:191], v[48:51]
v_exp_f32 v133, v133
M v[48:51], a[144:147], a[192:195], v[48:51]
buffer_load_dwordx4 v1, s[12:15], s32 offen offset:0 sc1 lds
M v[52:55], a[144:147], a[208:211], 0
v_exp_f32 v134, v134
M v[52:55], a[140:143], a[204:207], v[52:55]
v_cvt_pk_bf16_f32 v131, v146, v147
v_cvt_pk_bf16_f32 v132, v132, v133
M v[52:55], a[136:139], a[200:203], v[52:55]
v_exp_f32 v135, v135
M v[52:55], a[132:135], a[196:199], v[52:55]
buffer_load_dwordx4 v1, s[12:15], s32 offen offset:1024 sc1 lds
M v[56:59], a[132:135], a[212:215], 0
v_exp_f32 v148, v148
M v[56:59], a[136:139], a[216:219], v[56:59]
ds_read_b128 a[172:175], v3 offset:14336
ds_read_b128 a[176:179], v3 offset:15360
M v[56:59], a[140:143], a[220:223], v[56:59]
v_exp_f32 v149, v149
M v[56:59], a[144:147], a[224:227], v[56:59]
buffer_load_dwordx4 v1, s[12:15], s32 offen offset:2048 sc1 lds
M v[60:63], a[144:147], a[240:243], 0
v_exp_f32 v150, v150
M v[60:63], a[140:143], a[236:239], v[60:63]
v_cvt_pk_bf16_f32 v133, v134, v135
v_cvt_pk_bf16_f32 v134, v148, v149
M v[60:63], a[136:139], a[232:235], v[60:63]
v_exp_f32 v151, v151
M v[60:63], a[132:135], a[228:231], v[60:63]
buffer_load_dwordx4 v1, s[12:15], s32 offen offset:3072 sc1 lds
s_add_u32 m0, s29, 32768
s_waitcnt lgkmcnt(4)
M v[64:67], a[148:151], a[180:183], 0
v_exp_f32 v136, v136
M v[64:67], a[152:155], a[184:187], v[64:67]
ds_read_b128 a[116:119], v3 offset:32768
ds_read_b128 a[120:123], v3 offset:40960
M v[64:67], a[156:159], a[188:191], v[64:67]
v_exp_f32 v137, v137
M v[64:67], a[160:163], a[192:195], v[64:67]
buffer_load_dwordx4 v1, s[12:15], s26 offen offset:0 sc1 lds
s_add_u32 s43, s26, 4096
M v[68:71], a[160:163], a[208:211], 0
v_exp_f32 v138, v138
M v[68:71], a[156:159], a[204:207], v[68:71]
v_cvt_pk_bf16_f32 v135, v150, v151
v_cvt_pk_bf16_f32 v136, v136, v137
M v[68:71], a[152:155], a[200:203], v[68:71]
v_exp_f32 v139, v139
M v[68:71], a[148:151], a[196:199], v[68:71]
buffer_load_dwordx4 v1, s[12:15], s26 offen offset:1024 sc1 lds
M v[72:75], a[148:151], a[212:215], 0
v_exp_f32 v152, v152
M v[72:75], a[152:155], a[216:219], v[72:75]
ds_read_b128 a[124:127], v3 offset:33792
ds_read_b128 a[128:131], v3 offset:41984
M v[72:75], a[156:159], a[220:223], v[72:75]
v_exp_f32 v153, v153
M v[72:75], a[160:163], a[224:227], v[72:75]
buffer_load_dwordx4 v1, s[12:15], s26 offen offset:2048 sc1 lds
M v[76:79], a[160:163], a[240:243], 0
v_exp_f32 v154, v154
M v[76:79], a[156:159], a[236:239], v[76:79]
v_cvt_pk_bf16_f32 v137, v138, v139
v_cvt_pk_bf16_f32 v138, v152, v153
M v[76:79], a[152:155], a[232:235], v[76:79]
v_exp_f32 v155, v155
M v[76:79], a[148:151], a[228:231], v[76:79]
buffer_load_dwordx4 v1, s[12:15], s26 offen offset:3072 sc1 lds
s_add_u32 m0, s29, 36864
s_waitcnt lgkmcnt(4)
M v[80:83], a[164:167], a[180:183], 0
v_exp_f32 v140, v140
M v[80:83], a[168:171], a[184:187], v[80:83]
ds_read_b128 a[132:135], v3 offset:34816
ds_read_b128 a[136:139], v3 offset:43008
M v[80:83], a[172:175], a[188:191], v[80:83]
v_exp_f32 v141, v141
M v[80:83], a[176:179], a[192:195], v[80:83]
buffer_load_dwordx4 v1, s[12:15], s43 offen offset:0 sc1 lds
M v[84:87], a[176:179], a[208:211], 0
v_exp_f32 v142, v142
M v[84:87], a[172:175], a[204:207], v[84:87]
v_cvt_pk_bf16_f32 v139, v154, v155
v_cvt_pk_bf16_f32 v140, v140, v141
M v[84:87], a[168:171], a[200:203], v[84:87]
v_exp_f32 v143, v143
M v[84:87], a[164:167], a[196:199], v[84:87]
buffer_load_dwordx4 v1, s[12:15], s43 offen offset:1024 sc1 lds
M v[88:91], a[164:167], a[212:215], 0
v_exp_f32 v156, v156
M v[88:91], a[168:171], a[216:219], v[88:91]
ds_read_b128 a[140:143], v3 offset:35840
ds_read_b128 a[144:147], v3 offset:44032
M v[88:91], a[172:175], a[220:223], v[88:91]
v_exp_f32 v157, v157
M v[88:91], a[176:179], a[224:227], v[88:91]
buffer_load_dwordx4 v1, s[12:15], s43 offen offset:2048 sc1 lds
M v[92:95], a[176:179], a[240:243], 0
v_exp_f32 v158, v158
M v[92:95], a[172:175], a[236:239], v[92:95]
v_cvt_pk_bf16_f32 v141, v142, v143
v_cvt_pk_bf16_f32 v142, v156, v157
M v[92:95], a[168:171], a[232:235], v[92:95]
v_exp_f32 v159, v159
M v[92:95], a[164:167], a[228:231], v[92:95]
buffer_load_dwordx4 v1, s[12:15], s43 offen offset:3072 sc1 lds
v_cvt_pk_bf16_f32 v143, v158, v159
s_waitcnt lgkmcnt(6)
M v[160:163], a[116:119], v[96:99], v[160:163]
v_exp_f32 v32, v32
M v[160:163], a[120:123], v[128:131], v[160:163]
ds_read_b128 a[148:151], v3 offset:36864
ds_read_b128 a[152:155], v3 offset:45056
M v[164:167], a[120:123], v[132:135], v[164:167]
v_exp_f32 v33, v33
M v[164:167], a[116:119], v[100:103], v[164:167]
v_cvt_pk_bf16_f32 v32, v32, v33
M v[168:171], a[116:119], v[104:107], v[168:171]
v_exp_f32 v34, v34
M v[168:171], a[120:123], v[136:139], v[168:171]
s_add_u32 s25, s25, 32768
s_cmp_eq_u32 s25, s27
M v[172:175], a[120:123], v[140:143], v[172:175]
v_exp_f32 v35, v35
M v[172:175], a[116:119], v[108:111], v[172:175]
v_cvt_pk_bf16_f32 v33, v34, v35
s_waitcnt lgkmcnt(6)
M a[96:99], a[112:115], v[96:99], a[96:99]
s_cselect_b32 s25, s28, s25
s_cselect_b32 s27, -1, s27
M a[96:99], a[112:115], v[128:131], a[96:99]
s_add_u32 s26, s26, 32768
s_cmp_eq_u32 s26, s62
M v[176:179], a[124:127], v[96:99], v[176:179]
v_exp_f32 v48, v48
M v[176:179], a[128:131], v[128:131], v[176:179]
ds_read_b128 a[156:159], v3 offset:37888
ds_read_b128 a[160:163], v3 offset:46080
M v[180:183], a[128:131], v[132:135], v[180:183]
v_exp_f32 v49, v49
M v[180:183], a[124:127], v[100:103], v[180:183]
v_cvt_pk_bf16_f32 v34, v48, v49
M v[184:187], a[124:127], v[104:107], v[184:187]
v_exp_f32 v50, v50
M v[184:187], a[128:131], v[136:139], v[184:187]
s_cselect_b32 s26, s63, s26
s_cselect_b32 s62, -1, s62
M v[188:191], a[128:131], v[140:143], v[188:191]
v_exp_f32 v51, v51
M v[188:191], a[124:127], v[108:111], v[188:191]
v_cvt_pk_bf16_f32 v35, v50, v51
s_waitcnt lgkmcnt(6)
M a[100:103], a[112:115], v[100:103], a[100:103]
M a[100:103], a[112:115], v[132:135], a[100:103]
M v[192:195], a[132:135], v[96:99], v[192:195]
v_exp_f32 v36, v36
M v[192:195], a[136:139], v[128:131], v[192:195]
ds_read_b128 a[164:167], v3 offset:38912
ds_read_b128 a[168:171], v3 offset:47104
M v[196:199], a[136:139], v[132:135], v[196:199]
v_exp_f32 v37, v37
M v[196:199], a[132:135], v[100:103], v[196:199]
v_cvt_pk_bf16_f32 v36, v36, v37
M v[200:203], a[132:135], v[104:107], v[200:203]
v_exp_f32 v38, v38
M v[200:203], a[136:139], v[136:139], v[200:203]
M v[204:207], a[136:139], v[140:143], v[204:207]
v_exp_f32 v39, v39
M v[204:207], a[132:135], v[108:111], v[204:207]
v_cvt_pk_bf16_f32 v37, v38, v39
s_waitcnt lgkmcnt(6)
M a[104:107], a[112:115], v[104:107], a[104:107]
M a[104:107], a[112:115], v[136:139], a[104:107]
M v[208:211], a[140:143], v[96:99], v[208:211]
v_exp_f32 v52, v52
M v[208:211], a[144:147], v[128:131], v[208:211]
ds_read_b128 a[172:175], v3 offset:39936
ds_read_b128 a[176:179], v3 offset:48128
M v[212:215], a[144:147], v[132:135], v[212:215]
v_exp_f32 v53, v53
M v[212:215], a[140:143], v[100:103], v[212:215]
v_cvt_pk_bf16_f32 v38, v52, v53
M v[216:219], a[140:143], v[104:107], v[216:219]
v_exp_f32 v54, v54
M v[216:219], a[144:147], v[136:139], v[216:219]
M v[220:223], a[144:147], v[140:143], v[220:223]
v_exp_f32 v55, v55
M v[220:223], a[140:143], v[108:111], v[220:223]
v_cvt_pk_bf16_f32 v39, v54, v55
s_waitcnt lgkmcnt(6)
M a[108:111], a[112:115], v[108:111], a[108:111]
M a[108:111], a[112:115], v[140:143], a[108:111]
M v[224:227], a[148:151], v[96:99], v[224:227]
v_exp_f32 v40, v40
M v[224:227], a[152:155], v[128:131], v[224:227]
M v[228:231], a[152:155], v[132:135], v[228:231]
v_exp_f32 v41, v41
M v[228:231], a[148:151], v[100:103], v[228:231]
v_cvt_pk_bf16_f32 v40, v40, v41
M v[232:235], a[148:151], v[104:107], v[232:235]
v_exp_f32 v42, v42
M v[232:235], a[152:155], v[136:139], v[232:235]
M v[236:239], a[152:155], v[140:143], v[236:239]
v_exp_f32 v43, v43
M v[236:239], a[148:151], v[108:111], v[236:239]
v_cvt_pk_bf16_f32 v41, v42, v43
s_waitcnt lgkmcnt(4)
M v[240:243], a[156:159], v[96:99], v[240:243]
v_exp_f32 v56, v56
M v[240:243], a[160:163], v[128:131], v[240:243]
M v[244:247], a[160:163], v[132:135], v[244:247]
v_exp_f32 v57, v57
M v[244:247], a[156:159], v[100:103], v[244:247]
v_cvt_pk_bf16_f32 v42, v56, v57
M v[248:251], a[156:159], v[104:107], v[248:251]
v_exp_f32 v58, v58
M v[248:251], a[160:163], v[136:139], v[248:251]
s_waitcnt vmcnt(0) lgkmcnt(0)
s_barrier
ds_read_b128 a[116:119], v2 offset:0
ds_read_b128 a[120:123], v2 offset:1024
M v[252:255], a[160:163], v[140:143], v[252:255]
v_exp_f32 v59, v59
M v[252:255], a[156:159], v[108:111], v[252:255]
v_cvt_pk_bf16_f32 v43, v58, v59
M a[64:67], a[164:167], v[96:99], a[64:67]
v_exp_f32 v44, v44
M a[64:67], a[168:171], v[128:131], a[64:67]
ds_read_b128 a[124:127], v2 offset:2048
ds_read_b128 a[128:131], v2 offset:3072
M a[68:71], a[168:171], v[132:135], a[68:71]
v_exp_f32 v45, v45
M a[68:71], a[164:167], v[100:103], a[68:71]
v_cvt_pk_bf16_f32 v44, v44, v45
M a[72:75], a[164:167], v[104:107], a[72:75]
v_exp_f32 v46, v46
M a[72:75], a[168:171], v[136:139], a[72:75]
ds_read_b128 a[132:135], v2 offset:4096
ds_read_b128 a[136:139], v2 offset:5120
M a[76:79], a[168:171], v[140:143], a[76:79]
v_exp_f32 v47, v47
M a[76:79], a[164:167], v[108:111], a[76:79]
v_cvt_pk_bf16_f32 v45, v46, v47
M a[80:83], a[172:175], v[96:99], a[80:83]
v_exp_f32 v60, v60
M a[80:83], a[176:179], v[128:131], a[80:83]
ds_read_b128 a[140:143], v2 offset:6144
ds_read_b128 a[144:147], v2 offset:7168
M a[84:87], a[176:179], v[132:135], a[84:87]
v_exp_f32 v61, v61
M a[84:87], a[172:175], v[100:103], a[84:87]
v_cvt_pk_bf16_f32 v46, v60, v61
M a[88:91], a[172:175], v[104:107], a[88:91]
v_exp_f32 v62, v62
M a[88:91], a[176:179], v[136:139], a[88:91]
M a[92:95], a[176:179], v[140:143], a[92:95]
v_exp_f32 v63, v63
M a[92:95], a[172:175], v[108:111], a[92:95]
v_cvt_pk_bf16_f32 v47, v62, v63
s_sub_u32 s30, s30, 1
s_cmp_lg_u32 s30, 0
s_cbranch_scc1 Lk2_l2
s_branch Lk2_fin
s_waitcnt lgkmcnt(0)
Lk2_wm:
s_lshl_b32 s33, s2, 1
s_add_u32 s33, s33, s23
s_lshl_b32 s34, s33, 12
s_lshl_b32 s33, s33, 14
v_lshlrev_b32 v8, 3, v1
v_lshlrev_b32 v9, 2, v1
buffer_load_dword a244, v8, s[44:47], s33 offen
s_add_u32 s33, s33, 8192
buffer_load_dword a245, v8, s[44:47], s33 offen
buffer_load_dword a246, v9, s[48:51], s34 offen
s_branch Lk2_l3b
Lk2_g1:
s_mov_b32 s30, 7
s_bfe_u32 s42, s2, 0x20003
s_add_u32 s42, s42, 2
Lk2_l3:
s_cmp_eq_u32 s30, s42
s_cbranch_scc1 Lk2_wm
Lk2_l3b:
s_add_u32 m0, s29, 65536
s_waitcnt lgkmcnt(4)
M v[96:99], a[116:119], a[0:3], 0
v_exp_f32 v64, v64
M v[96:99], a[120:123], a[4:7], v[96:99]
ds_read_b128 a[148:151], v2 offset:8192
ds_read_b128 a[152:155], v2 offset:9216
M v[96:99], a[124:127], a[8:11], v[96:99]
v_exp_f32 v65, v65
M v[96:99], a[128:131], a[12:15], v[96:99]
buffer_load_dwordx4 v1, s[12:15], s25 offen offset:0 sc1 lds
s_add_u32 s32, s25, 4096
M v[100:103], a[128:131], a[28:31], 0
v_exp_f32 v66, v66
M v[100:103], a[124:127], a[24:27], v[100:103]
v_cvt_pk_bf16_f32 v64, v64, v65
M v[100:103], a[120:123], a[20:23], v[100:103]
v_exp_f32 v67, v67
M v[100:103], a[116:119], a[16:19], v[100:103]
buffer_load_dwordx4 v1, s[12:15], s25 offen offset:1024 sc1 lds
M v[104:107], a[116:119], a[32:35], 0
v_exp_f32 v80, v80
M v[104:107], a[120:123], a[36:39], v[104:107]
ds_read_b128 a[156:159], v2 offset:10240
ds_read_b128 a[160:163], v2 offset:11264
M v[104:107], a[124:127], a[40:43], v[104:107]
v_exp_f32 v81, v81
M v[104:107], a[128:131], a[44:47], v[104:107]
buffer_load_dwordx4 v1, s[12:15], s25 offen offset:2048 sc1 lds
M v[108:111], a[128:131], a[60:63], 0
v_exp_f32 v82, v82
M v[108:111], a[124:127], a[56:59], v[108:111]
v_cvt_pk_bf16_f32 v65, v66, v67
v_cvt_pk_bf16_f32 v66, v80, v81
M v[108:111], a[120:123], a[52:55], v[108:111]
v_exp_f32 v83, v83
M v[108:111], a[116:119], a[48:51], v[108:111]
buffer_load_dwordx4 v1, s[12:15], s25 offen offset:3072 sc1 lds
s_add_u32 m0, s29, 69632
s_waitcnt lgkmcnt(4)
M v[112:115], a[132:135], a[0:3], 0
v_exp_f32 v68, v68
M v[112:115], a[136:139], a[4:7], v[112:115]
ds_read_b128 a[164:167], v2 offset:12288
ds_read_b128 a[168:171], v2 offset:13312
M v[112:115], a[140:143], a[8:11], v[112:115]
v_exp_f32 v69, v69
M v[112:115], a[144:147], a[12:15], v[112:115]
buffer_load_dwordx4 v1, s[12:15], s32 offen offset:0 sc1 lds
M v[116:119], a[144:147], a[28:31], 0
v_exp_f32 v70, v70
M v[116:119], a[140:143], a[24:27], v[116:119]
v_cvt_pk_bf16_f32 v67, v82, v83
v_cvt_pk_bf16_f32 v68, v68, v69
M v[116:119], a[136:139], a[20:23], v[116:119]
v_exp_f32 v71, v71
M v[116:119], a[132:135], a[16:19], v[116:119]
buffer_load_dwordx4 v1, s[12:15], s32 offen offset:1024 sc1 lds
M v[120:123], a[132:135], a[32:35], 0
v_exp_f32 v84, v84
M v[120:123], a[136:139], a[36:39], v[120:123]
ds_read_b128 a[172:175], v2 offset:14336
ds_read_b128 a[176:179], v2 offset:15360
M v[120:123], a[140:143], a[40:43], v[120:123]
v_exp_f32 v85, v85
M v[120:123], a[144:147], a[44:47], v[120:123]
buffer_load_dwordx4 v1, s[12:15], s32 offen offset:2048 sc1 lds
M v[124:127], a[144:147], a[60:63], 0
v_exp_f32 v86, v86
M v[124:127], a[140:143], a[56:59], v[124:127]
v_cvt_pk_bf16_f32 v69, v70, v71
v_cvt_pk_bf16_f32 v70, v84, v85
M v[124:127], a[136:139], a[52:55], v[124:127]
v_exp_f32 v87, v87
M v[124:127], a[132:135], a[48:51], v[124:127]
buffer_load_dwordx4 v1, s[12:15], s32 offen offset:3072 sc1 lds
s_add_u32 m0, s29, 98304
s_waitcnt lgkmcnt(4)
M v[128:131], a[148:151], a[0:3], 0
v_exp_f32 v72, v72
M v[128:131], a[152:155], a[4:7], v[128:131]
ds_read_b128 a[116:119], v2 offset:32768
ds_read_b128 a[120:123], v2 offset:40960
M v[128:131], a[156:159], a[8:11], v[128:131]
v_exp_f32 v73, v73
M v[128:131], a[160:163], a[12:15], v[128:131]
buffer_load_dwordx4 v1, s[12:15], s26 offen offset:0 sc1 lds
s_add_u32 s43, s26, 4096
M v[132:135], a[160:163], a[28:31], 0
v_exp_f32 v74, v74
M v[132:135], a[156:159], a[24:27], v[132:135]
v_cvt_pk_bf16_f32 v71, v86, v87
v_cvt_pk_bf16_f32 v72, v72, v73
M v[132:135], a[152:155], a[20:23], v[132:135]
v_exp_f32 v75, v75
M v[132:135], a[148:151], a[16:19], v[132:135]
buffer_load_dwordx4 v1, s[12:15], s26 offen offset:1024 sc1 lds
M v[136:139], a[148:151], a[32:35], 0
v_exp_f32 v88, v88
M v[136:139], a[152:155], a[36:39], v[136:139]
ds_read_b128 a[124:127], v2 offset:33792
ds_read_b128 a[128:131], v2 offset:41984
M v[136:139], a[156:159], a[40:43], v[136:139]
v_exp_f32 v89, v89
M v[136:139], a[160:163], a[44:47], v[136:139]
buffer_load_dwordx4 v1, s[12:15], s26 offen offset:2048 sc1 lds
M v[140:143], a[160:163], a[60:63], 0
v_exp_f32 v90, v90
M v[140:143], a[156:159], a[56:59], v[140:143]
v_cvt_pk_bf16_f32 v73, v74, v75
v_cvt_pk_bf16_f32 v74, v88, v89
M v[140:143], a[152:155], a[52:55], v[140:143]
v_exp_f32 v91, v91
M v[140:143], a[148:151], a[48:51], v[140:143]
buffer_load_dwordx4 v1, s[12:15], s26 offen offset:3072 sc1 lds
s_add_u32 m0, s29, 102400
s_waitcnt lgkmcnt(4)
M v[144:147], a[164:167], a[0:3], 0
v_exp_f32 v76, v76
M v[144:147], a[168:171], a[4:7], v[144:147]
ds_read_b128 a[132:135], v2 offset:34816
ds_read_b128 a[136:139], v2 offset:43008
M v[144:147], a[172:175], a[8:11], v[144:147]
v_exp_f32 v77, v77
M v[144:147], a[176:179], a[12:15], v[144:147]
buffer_load_dwordx4 v1, s[12:15], s43 offen offset:0 sc1 lds
M v[148:151], a[176:179], a[28:31], 0
v_exp_f32 v78, v78
M v[148:151], a[172:175], a[24:27], v[148:151]
v_cvt_pk_bf16_f32 v75, v90, v91
v_cvt_pk_bf16_f32 v76, v76, v77
M v[148:151], a[168:171], a[20:23], v[148:151]
v_exp_f32 v79, v79
M v[148:151], a[164:167], a[16:19], v[148:151]
buffer_load_dwordx4 v1, s[12:15], s43 offen offset:1024 sc1 lds
M v[152:155], a[164:167], a[32:35], 0
v_exp_f32 v92, v92
M v[152:155], a[168:171], a[36:39], v[152:155]
ds_read_b128 a[140:143], v2 offset:35840
ds_read_b128 a[144:147], v2 offset:44032
M v[152:155], a[172:175], a[40:43], v[152:155]
v_exp_f32 v93, v93
M v[152:155], a[176:179], a[44:47], v[152:155]
buffer_load_dwordx4 v1, s[12:15], s43 offen offset:2048 sc1 lds
M v[156:159], a[176:179], a[60:63], 0
v_exp_f32 v94, v94
M v[156:159], a[172:175], a[56:59], v[156:159]
v_cvt_pk_bf16_f32 v77, v78, v79
v_cvt_pk_bf16_f32 v78, v92, v93
M v[156:159], a[168:171], a[52:55], v[156:159]
v_exp_f32 v95, v95
M v[156:159], a[164:167], a[48:51], v[156:159]
buffer_load_dwordx4 v1, s[12:15], s43 offen offset:3072 sc1 lds
v_cvt_pk_bf16_f32 v79, v94, v95
s_waitcnt lgkmcnt(6)
M v[160:163], a[116:119], v[32:35], v[160:163]
v_exp_f32 v96, v96
M v[160:163], a[120:123], v[64:67], v[160:163]
ds_read_b128 a[148:151], v2 offset:36864
ds_read_b128 a[152:155], v2 offset:45056
M v[164:167], a[120:123], v[68:71], v[164:167]
v_exp_f32 v97, v97
M v[164:167], a[116:119], v[36:39], v[164:167]
v_cvt_pk_bf16_f32 v96, v96, v97
M v[168:171], a[116:119], v[40:43], v[168:171]
v_exp_f32 v98, v98
M v[168:171], a[120:123], v[72:75], v[168:171]
s_add_u32 s25, s25, 32768
s_cmp_eq_u32 s25, s27
M v[172:175], a[120:123], v[76:79], v[172:175]
v_exp_f32 v99, v99
M v[172:175], a[116:119], v[44:47], v[172:175]
v_cvt_pk_bf16_f32 v97, v98, v99
s_waitcnt lgkmcnt(6)
M a[96:99], a[112:115], v[32:35], a[96:99]
s_cselect_b32 s25, s28, s25
s_cselect_b32 s27, -1, s27
M a[96:99], a[112:115], v[64:67], a[96:99]
s_add_u32 s26, s26, 32768
s_cmp_eq_u32 s26, s62
M v[176:179], a[124:127], v[32:35], v[176:179]
v_exp_f32 v112, v112
M v[176:179], a[128:131], v[64:67], v[176:179]
ds_read_b128 a[156:159], v2 offset:37888
ds_read_b128 a[160:163], v2 offset:46080
M v[180:183], a[128:131], v[68:71], v[180:183]
v_exp_f32 v113, v113
M v[180:183], a[124:127], v[36:39], v[180:183]
v_cvt_pk_bf16_f32 v98, v112, v113
M v[184:187], a[124:127], v[40:43], v[184:187]
v_exp_f32 v114, v114
M v[184:187], a[128:131], v[72:75], v[184:187]
s_cselect_b32 s26, s63, s26
s_cselect_b32 s62, -1, s62
M v[188:191], a[128:131], v[76:79], v[188:191]
v_exp_f32 v115, v115
M v[188:191], a[124:127], v[44:47], v[188:191]
v_cvt_pk_bf16_f32 v99, v114, v115
s_waitcnt lgkmcnt(6)
M a[100:103], a[112:115], v[36:39], a[100:103]
M a[100:103], a[112:115], v[68:71], a[100:103]
M v[192:195], a[132:135], v[32:35], v[192:195]
v_exp_f32 v100, v100
M v[192:195], a[136:139], v[64:67], v[192:195]
ds_read_b128 a[164:167], v2 offset:38912
ds_read_b128 a[168:171], v2 offset:47104
M v[196:199], a[136:139], v[68:71], v[196:199]
v_exp_f32 v101, v101
M v[196:199], a[132:135], v[36:39], v[196:199]
v_cvt_pk_bf16_f32 v100, v100, v101
M v[200:203], a[132:135], v[40:43], v[200:203]
v_exp_f32 v102, v102
M v[200:203], a[136:139], v[72:75], v[200:203]
M v[204:207], a[136:139], v[76:79], v[204:207]
v_exp_f32 v103, v103
M v[204:207], a[132:135], v[44:47], v[204:207]
v_cvt_pk_bf16_f32 v101, v102, v103
s_waitcnt lgkmcnt(6)
M a[104:107], a[112:115], v[40:43], a[104:107]
M a[104:107], a[112:115], v[72:75], a[104:107]
M v[208:211], a[140:143], v[32:35], v[208:211]
v_exp_f32 v116, v116
M v[208:211], a[144:147], v[64:67], v[208:211]
ds_read_b128 a[172:175], v2 offset:39936
ds_read_b128 a[176:179], v2 offset:48128
M v[212:215], a[144:147], v[68:71], v[212:215]
v_exp_f32 v117, v117
M v[212:215], a[140:143], v[36:39], v[212:215]
v_cvt_pk_bf16_f32 v102, v116, v117
M v[216:219], a[140:143], v[40:43], v[216:219]
v_exp_f32 v118, v118
M v[216:219], a[144:147], v[72:75], v[216:219]
M v[220:223], a[144:147], v[76:79], v[220:223]
v_exp_f32 v119, v119
M v[220:223], a[140:143], v[44:47], v[220:223]
v_cvt_pk_bf16_f32 v103, v118, v119
s_waitcnt lgkmcnt(6)
M a[108:111], a[112:115], v[44:47], a[108:111]
M a[108:111], a[112:115], v[76:79], a[108:111]
M v[224:227], a[148:151], v[32:35], v[224:227]
v_exp_f32 v104, v104
M v[224:227], a[152:155], v[64:67], v[224:227]
M v[228:231], a[152:155], v[68:71], v[228:231]
v_exp_f32 v105, v105
M v[228:231], a[148:151], v[36:39], v[228:231]
v_cvt_pk_bf16_f32 v104, v104, v105
M v[232:235], a[148:151], v[40:43], v[232:235]
v_exp_f32 v106, v106
M v[232:235], a[152:155], v[72:75], v[232:235]
M v[236:239], a[152:155], v[76:79], v[236:239]
v_exp_f32 v107, v107
M v[236:239], a[148:151], v[44:47], v[236:239]
v_cvt_pk_bf16_f32 v105, v106, v107
s_waitcnt lgkmcnt(4)
M v[240:243], a[156:159], v[32:35], v[240:243]
v_exp_f32 v120, v120
M v[240:243], a[160:163], v[64:67], v[240:243]
M v[244:247], a[160:163], v[68:71], v[244:247]
v_exp_f32 v121, v121
M v[244:247], a[156:159], v[36:39], v[244:247]
v_cvt_pk_bf16_f32 v106, v120, v121
M v[248:251], a[156:159], v[40:43], v[248:251]
v_exp_f32 v122, v122
M v[248:251], a[160:163], v[72:75], v[248:251]
s_waitcnt vmcnt(0) lgkmcnt(0)
s_barrier
ds_read_b128 a[116:119], v3 offset:0
ds_read_b128 a[120:123], v3 offset:1024
M v[252:255], a[160:163], v[76:79], v[252:255]
v_exp_f32 v123, v123
M v[252:255], a[156:159], v[44:47], v[252:255]
v_cvt_pk_bf16_f32 v107, v122, v123
M a[64:67], a[164:167], v[32:35], a[64:67]
v_exp_f32 v108, v108
M a[64:67], a[168:171], v[64:67], a[64:67]
ds_read_b128 a[124:127], v3 offset:2048
ds_read_b128 a[128:131], v3 offset:3072
M a[68:71], a[168:171], v[68:71], a[68:71]
v_exp_f32 v109, v109
M a[68:71], a[164:167], v[36:39], a[68:71]
v_cvt_pk_bf16_f32 v108, v108, v109
M a[72:75], a[164:167], v[40:43], a[72:75]
v_exp_f32 v110, v110
M a[72:75], a[168:171], v[72:75], a[72:75]
ds_read_b128 a[132:135], v3 offset:4096
ds_read_b128 a[136:139], v3 offset:5120
M a[76:79], a[168:171], v[76:79], a[76:79]
v_exp_f32 v111, v111
M a[76:79], a[164:167], v[44:47], a[76:79]
v_cvt_pk_bf16_f32 v109, v110, v111
M a[80:83], a[172:175], v[32:35], a[80:83]
v_exp_f32 v124, v124
M a[80:83], a[176:179], v[64:67], a[80:83]
ds_read_b128 a[140:143], v3 offset:6144
ds_read_b128 a[144:147], v3 offset:7168
M a[84:87], a[176:179], v[68:71], a[84:87]
v_exp_f32 v125, v125
M a[84:87], a[172:175], v[36:39], a[84:87]
v_cvt_pk_bf16_f32 v110, v124, v125
M a[88:91], a[172:175], v[40:43], a[88:91]
v_exp_f32 v126, v126
M a[88:91], a[176:179], v[72:75], a[88:91]
M a[92:95], a[176:179], v[76:79], a[92:95]
v_exp_f32 v127, v127
M a[92:95], a[172:175], v[44:47], a[92:95]
v_cvt_pk_bf16_f32 v111, v126, v127
s_add_u32 m0, s29, 0
s_waitcnt lgkmcnt(4)
M v[32:35], a[116:119], a[0:3], 0
v_exp_f32 v128, v128
M v[32:35], a[120:123], a[4:7], v[32:35]
ds_read_b128 a[148:151], v3 offset:8192
ds_read_b128 a[152:155], v3 offset:9216
M v[32:35], a[124:127], a[8:11], v[32:35]
v_exp_f32 v129, v129
M v[32:35], a[128:131], a[12:15], v[32:35]
buffer_load_dwordx4 v1, s[12:15], s25 offen offset:0 sc1 lds
s_add_u32 s32, s25, 4096
M v[36:39], a[128:131], a[28:31], 0
v_exp_f32 v130, v130
M v[36:39], a[124:127], a[24:27], v[36:39]
v_cvt_pk_bf16_f32 v128, v128, v129
M v[36:39], a[120:123], a[20:23], v[36:39]
v_exp_f32 v131, v131
M v[36:39], a[116:119], a[16:19], v[36:39]
buffer_load_dwordx4 v1, s[12:15], s25 offen offset:1024 sc1 lds
M v[40:43], a[116:119], a[32:35], 0
v_exp_f32 v144, v144
M v[40:43], a[120:123], a[36:39], v[40:43]
ds_read_b128 a[156:159], v3 offset:10240
ds_read_b128 a[160:163], v3 offset:11264
M v[40:43], a[124:127], a[40:43], v[40:43]
v_exp_f32 v145, v145
M v[40:43], a[128:131], a[44:47], v[40:43]
buffer_load_dwordx4 v1, s[12:15], s25 offen offset:2048 sc1 lds
M v[44:47], a[128:131], a[60:63], 0
v_exp_f32 v146, v146
M v[44:47], a[124:127], a[56:59], v[44:47]
v_cvt_pk_bf16_f32 v129, v130, v131
v_cvt_pk_bf16_f32 v130, v144, v145
M v[44:47], a[120:123], a[52:55], v[44:47]
v_exp_f32 v147, v147
M v[44:47], a[116:119], a[48:51], v[44:47]
buffer_load_dwordx4 v1, s[12:15], s25 offen offset:3072 sc1 lds
s_add_u32 m0, s29, 4096
s_waitcnt lgkmcnt(4)
M v[48:51], a[132:135], a[0:3], 0
v_exp_f32 v132, v132
M v[48:51], a[136:139], a[4:7], v[48:51]
ds_read_b128 a[164:167], v3 offset:12288
ds_read_b128 a[168:171], v3 offset:13312
M v[48:51], a[140:143], a[8:11], v[48:51]
v_exp_f32 v133, v133
M v[48:51], a[144:147], a[12:15], v[48:51]
buffer_load_dwordx4 v1, s[12:15], s32 offen offset:0 sc1 lds
M v[52:55], a[144:147], a[28:31], 0
v_exp_f32 v134, v134
M v[52:55], a[140:143], a[24:27], v[52:55]
v_cvt_pk_bf16_f32 v131, v146, v147
v_cvt_pk_bf16_f32 v132, v132, v133
M v[52:55], a[136:139], a[20:23], v[52:55]
v_exp_f32 v135, v135
M v[52:55], a[132:135], a[16:19], v[52:55]
buffer_load_dwordx4 v1, s[12:15], s32 offen offset:1024 sc1 lds
M v[56:59], a[132:135], a[32:35], 0
v_exp_f32 v148, v148
M v[56:59], a[136:139], a[36:39], v[56:59]
ds_read_b128 a[172:175], v3 offset:14336
ds_read_b128 a[176:179], v3 offset:15360
M v[56:59], a[140:143], a[40:43], v[56:59]
v_exp_f32 v149, v149
M v[56:59], a[144:147], a[44:47], v[56:59]
buffer_load_dwordx4 v1, s[12:15], s32 offen offset:2048 sc1 lds
M v[60:63], a[144:147], a[60:63], 0
v_exp_f32 v150, v150
M v[60:63], a[140:143], a[56:59], v[60:63]
v_cvt_pk_bf16_f32 v133, v134, v135
v_cvt_pk_bf16_f32 v134, v148, v149
M v[60:63], a[136:139], a[52:55], v[60:63]
v_exp_f32 v151, v151
M v[60:63], a[132:135], a[48:51], v[60:63]
buffer_load_dwordx4 v1, s[12:15], s32 offen offset:3072 sc1 lds
s_add_u32 m0, s29, 32768
s_waitcnt lgkmcnt(4)
M v[64:67], a[148:151], a[0:3], 0
v_exp_f32 v136, v136
M v[64:67], a[152:155], a[4:7], v[64:67]
ds_read_b128 a[116:119], v3 offset:32768
ds_read_b128 a[120:123], v3 offset:40960
M v[64:67], a[156:159], a[8:11], v[64:67]
v_exp_f32 v137, v137
M v[64:67], a[160:163], a[12:15], v[64:67]
buffer_load_dwordx4 v1, s[12:15], s26 offen offset:0 sc1 lds
s_add_u32 s43, s26, 4096
M v[68:71], a[160:163], a[28:31], 0
v_exp_f32 v138, v138
M v[68:71], a[156:159], a[24:27], v[68:71]
v_cvt_pk_bf16_f32 v135, v150, v151
v_cvt_pk_bf16_f32 v136, v136, v137
M v[68:71], a[152:155], a[20:23], v[68:71]
v_exp_f32 v139, v139
M v[68:71], a[148:151], a[16:19], v[68:71]
buffer_load_dwordx4 v1, s[12:15], s26 offen offset:1024 sc1 lds
M v[72:75], a[148:151], a[32:35], 0
v_exp_f32 v152, v152
M v[72:75], a[152:155], a[36:39], v[72:75]
ds_read_b128 a[124:127], v3 offset:33792
ds_read_b128 a[128:131], v3 offset:41984
M v[72:75], a[156:159], a[40:43], v[72:75]
v_exp_f32 v153, v153
M v[72:75], a[160:163], a[44:47], v[72:75]
buffer_load_dwordx4 v1, s[12:15], s26 offen offset:2048 sc1 lds
M v[76:79], a[160:163], a[60:63], 0
v_exp_f32 v154, v154
M v[76:79], a[156:159], a[56:59], v[76:79]
v_cvt_pk_bf16_f32 v137, v138, v139
v_cvt_pk_bf16_f32 v138, v152, v153
M v[76:79], a[152:155], a[52:55], v[76:79]
v_exp_f32 v155, v155
M v[76:79], a[148:151], a[48:51], v[76:79]
buffer_load_dwordx4 v1, s[12:15], s26 offen offset:3072 sc1 lds
s_add_u32 m0, s29, 36864
s_waitcnt lgkmcnt(4)
M v[80:83], a[164:167], a[0:3], 0
v_exp_f32 v140, v140
M v[80:83], a[168:171], a[4:7], v[80:83]
ds_read_b128 a[132:135], v3 offset:34816
ds_read_b128 a[136:139], v3 offset:43008
M v[80:83], a[172:175], a[8:11], v[80:83]
v_exp_f32 v141, v141
M v[80:83], a[176:179], a[12:15], v[80:83]
buffer_load_dwordx4 v1, s[12:15], s43 offen offset:0 sc1 lds
M v[84:87], a[176:179], a[28:31], 0
v_exp_f32 v142, v142
M v[84:87], a[172:175], a[24:27], v[84:87]
v_cvt_pk_bf16_f32 v139, v154, v155
v_cvt_pk_bf16_f32 v140, v140, v141
M v[84:87], a[168:171], a[20:23], v[84:87]
v_exp_f32 v143, v143
M v[84:87], a[164:167], a[16:19], v[84:87]
buffer_load_dwordx4 v1, s[12:15], s43 offen offset:1024 sc1 lds
M v[88:91], a[164:167], a[32:35], 0
v_exp_f32 v156, v156
M v[88:91], a[168:171], a[36:39], v[88:91]
ds_read_b128 a[140:143], v3 offset:35840
ds_read_b128 a[144:147], v3 offset:44032
M v[88:91], a[172:175], a[40:43], v[88:91]
v_exp_f32 v157, v157
M v[88:91], a[176:179], a[44:47], v[88:91]
buffer_load_dwordx4 v1, s[12:15], s43 offen offset:2048 sc1 lds
M v[92:95], a[176:179], a[60:63], 0
v_exp_f32 v158, v158
M v[92:95], a[172:175], a[56:59], v[92:95]
v_cvt_pk_bf16_f32 v141, v142, v143
v_cvt_pk_bf16_f32 v142, v156, v157
M v[92:95], a[168:171], a[52:55], v[92:95]
v_exp_f32 v159, v159
M v[92:95], a[164:167], a[48:51], v[92:95]
buffer_load_dwordx4 v1, s[12:15], s43 offen offset:3072 sc1 lds
v_cvt_pk_bf16_f32 v143, v158, v159
s_waitcnt lgkmcnt(6)
M v[160:163], a[116:119], v[96:99], v[160:163]
v_exp_f32 v32, v32
M v[160:163], a[120:123], v[128:131], v[160:163]
ds_read_b128 a[148:151], v3 offset:36864
ds_read_b128 a[152:155], v3 offset:45056
M v[164:167], a[120:123], v[132:135], v[164:167]
v_exp_f32 v33, v33
M v[164:167], a[116:119], v[100:103], v[164:167]
v_cvt_pk_bf16_f32 v32, v32, v33
M v[168:171], a[116:119], v[104:107], v[168:171]
v_exp_f32 v34, v34
M v[168:171], a[120:123], v[136:139], v[168:171]
s_add_u32 s25, s25, 32768
s_cmp_eq_u32 s25, s27
M v[172:175], a[120:123], v[140:143], v[172:175]
v_exp_f32 v35, v35
M v[172:175], a[116:119], v[108:111], v[172:175]
v_cvt_pk_bf16_f32 v33, v34, v35
s_waitcnt lgkmcnt(6)
M a[96:99], a[112:115], v[96:99], a[96:99]
s_cselect_b32 s25, s28, s25
s_cselect_b32 s27, -1, s27
M a[96:99], a[112:115], v[128:131], a[96:99]
s_add_u32 s26, s26, 32768
s_cmp_eq_u32 s26, s62
M v[176:179], a[124:127], v[96:99], v[176:179]
v_exp_f32 v48, v48
M v[176:179], a[128:131], v[128:131], v[176:179]
ds_read_b128 a[156:159], v3 offset:37888
ds_read_b128 a[160:163], v3 offset:46080
M v[180:183], a[128:131], v[132:135], v[180:183]
v_exp_f32 v49, v49
M v[180:183], a[124:127], v[100:103], v[180:183]
v_cvt_pk_bf16_f32 v34, v48, v49
M v[184:187], a[124:127], v[104:107], v[184:187]
v_exp_f32 v50, v50
M v[184:187], a[128:131], v[136:139], v[184:187]
s_cselect_b32 s26, s63, s26
s_cselect_b32 s62, -1, s62
M v[188:191], a[128:131], v[140:143], v[188:191]
v_exp_f32 v51, v51
M v[188:191], a[124:127], v[108:111], v[188:191]
v_cvt_pk_bf16_f32 v35, v50, v51
s_waitcnt lgkmcnt(6)
M a[100:103], a[112:115], v[100:103], a[100:103]
M a[100:103], a[112:115], v[132:135], a[100:103]
M v[192:195], a[132:135], v[96:99], v[192:195]
v_exp_f32 v36, v36
M v[192:195], a[136:139], v[128:131], v[192:195]
ds_read_b128 a[164:167], v3 offset:38912
ds_read_b128 a[168:171], v3 offset:47104
M v[196:199], a[136:139], v[132:135], v[196:199]
v_exp_f32 v37, v37
M v[196:199], a[132:135], v[100:103], v[196:199]
v_cvt_pk_bf16_f32 v36, v36, v37
M v[200:203], a[132:135], v[104:107], v[200:203]
v_exp_f32 v38, v38
M v[200:203], a[136:139], v[136:139], v[200:203]
M v[204:207], a[136:139], v[140:143], v[204:207]
v_exp_f32 v39, v39
M v[204:207], a[132:135], v[108:111], v[204:207]
v_cvt_pk_bf16_f32 v37, v38, v39
s_waitcnt lgkmcnt(6)
M a[104:107], a[112:115], v[104:107], a[104:107]
M a[104:107], a[112:115], v[136:139], a[104:107]
M v[208:211], a[140:143], v[96:99], v[208:211]
v_exp_f32 v52, v52
M v[208:211], a[144:147], v[128:131], v[208:211]
ds_read_b128 a[172:175], v3 offset:39936
ds_read_b128 a[176:179], v3 offset:48128
M v[212:215], a[144:147], v[132:135], v[212:215]
v_exp_f32 v53, v53
M v[212:215], a[140:143], v[100:103], v[212:215]
v_cvt_pk_bf16_f32 v38, v52, v53
M v[216:219], a[140:143], v[104:107], v[216:219]
v_exp_f32 v54, v54
M v[216:219], a[144:147], v[136:139], v[216:219]
M v[220:223], a[144:147], v[140:143], v[220:223]
v_exp_f32 v55, v55
M v[220:223], a[140:143], v[108:111], v[220:223]
v_cvt_pk_bf16_f32 v39, v54, v55
s_waitcnt lgkmcnt(6)
M a[108:111], a[112:115], v[108:111], a[108:111]
M a[108:111], a[112:115], v[140:143], a[108:111]
M v[224:227], a[148:151], v[96:99], v[224:227]
v_exp_f32 v40, v40
M v[224:227], a[152:155], v[128:131], v[224:227]
M v[228:231], a[152:155], v[132:135], v[228:231]
v_exp_f32 v41, v41
M v[228:231], a[148:151], v[100:103], v[228:231]
v_cvt_pk_bf16_f32 v40, v40, v41
M v[232:235], a[148:151], v[104:107], v[232:235]
v_exp_f32 v42, v42
M v[232:235], a[152:155], v[136:139], v[232:235]
M v[236:239], a[152:155], v[140:143], v[236:239]
v_exp_f32 v43, v43
M v[236:239], a[148:151], v[108:111], v[236:239]
v_cvt_pk_bf16_f32 v41, v42, v43
s_waitcnt lgkmcnt(4)
M v[240:243], a[156:159], v[96:99], v[240:243]
v_exp_f32 v56, v56
M v[240:243], a[160:163], v[128:131], v[240:243]
M v[244:247], a[160:163], v[132:135], v[244:247]
v_exp_f32 v57, v57
M v[244:247], a[156:159], v[100:103], v[244:247]
v_cvt_pk_bf16_f32 v42, v56, v57
M v[248:251], a[156:159], v[104:107], v[248:251]
v_exp_f32 v58, v58
M v[248:251], a[160:163], v[136:139], v[248:251]
s_waitcnt vmcnt(0) lgkmcnt(0)
s_barrier
ds_read_b128 a[116:119], v2 offset:0
ds_read_b128 a[120:123], v2 offset:1024
M v[252:255], a[160:163], v[140:143], v[252:255]
v_exp_f32 v59, v59
M v[252:255], a[156:159], v[108:111], v[252:255]
v_cvt_pk_bf16_f32 v43, v58, v59
M a[64:67], a[164:167], v[96:99], a[64:67]
v_exp_f32 v44, v44
M a[64:67], a[168:171], v[128:131], a[64:67]
ds_read_b128 a[124:127], v2 offset:2048
ds_read_b128 a[128:131], v2 offset:3072
M a[68:71], a[168:171], v[132:135], a[68:71]
v_exp_f32 v45, v45
M a[68:71], a[164:167], v[100:103], a[68:71]
v_cvt_pk_bf16_f32 v44, v44, v45
M a[72:75], a[164:167], v[104:107], a[72:75]
v_exp_f32 v46, v46
M a[72:75], a[168:171], v[136:139], a[72:75]
ds_read_b128 a[132:135], v2 offset:4096
ds_read_b128 a[136:139], v2 offset:5120
M a[76:79], a[168:171], v[140:143], a[76:79]
v_exp_f32 v47, v47
M a[76:79], a[164:167], v[108:111], a[76:79]
v_cvt_pk_bf16_f32 v45, v46, v47
M a[80:83], a[172:175], v[96:99], a[80:83]
v_exp_f32 v60, v60
M a[80:83], a[176:179], v[128:131], a[80:83]
ds_read_b128 a[140:143], v2 offset:6144
ds_read_b128 a[144:147], v2 offset:7168
M a[84:87], a[176:179], v[132:135], a[84:87]
v_exp_f32 v61, v61
M a[84:87], a[172:175], v[100:103], a[84:87]
v_cvt_pk_bf16_f32 v46, v60, v61
M a[88:91], a[172:175], v[104:107], a[88:91]
v_exp_f32 v62, v62
M a[88:91], a[176:179], v[136:139], a[88:91]
M a[92:95], a[176:179], v[140:143], a[92:95]
v_exp_f32 v63, v63
M a[92:95], a[172:175], v[108:111], a[92:95]
v_cvt_pk_bf16_f32 v47, v62, v63
s_sub_u32 s30, s30, 1
s_cmp_lg_u32 s30, 0
s_cbranch_scc1 Lk2_l3
s_lshl_b32 s33, s23, 6
s_add_i32 s33, s33, 0
s_cmp_gt_i32 s33, 0
s_cselect_b32 s34, 0, 0xf149f2ca
s_cmp_lt_i32 s33, 0
s_cselect_b32 s33, 0xf149f2ca, 0
v_mov_b32 v20, s34
v_mov_b32 v21, s34
v_mov_b32 v22, s34
v_mov_b32 v23, s34
v_mov_b32 v28, s33
v_mov_b32 v29, s33
v_mov_b32 v30, s33
v_mov_b32 v31, s33
v_med3_f32 v24, v16, v20, v28
v_med3_f32 v25, v17, v20, v28
v_med3_f32 v26, v18, v20, v28
v_med3_f32 v27, v19, v20, v28
s_add_u32 m0, s29, 65536
s_waitcnt lgkmcnt(4)
M v[96:99], a[116:119], a[0:3], v[24:27]
v_exp_f32 v64, v64
M v[96:99], a[120:123], a[4:7], v[96:99]
ds_read_b128 a[148:151], v2 offset:8192
ds_read_b128 a[152:155], v2 offset:9216
M v[96:99], a[124:127], a[8:11], v[96:99]
v_exp_f32 v65, v65
M v[96:99], a[128:131], a[12:15], v[96:99]
buffer_load_dwordx4 v1, s[12:15], s25 offen offset:0 sc1 lds
s_add_u32 s32, s25, 4096
M v[100:103], a[128:131], a[28:31], v[28:31]
v_exp_f32 v66, v66
M v[100:103], a[124:127], a[24:27], v[100:103]
v_cvt_pk_bf16_f32 v64, v64, v65
M v[100:103], a[120:123], a[20:23], v[100:103]
v_exp_f32 v67, v67
M v[100:103], a[116:119], a[16:19], v[100:103]
buffer_load_dwordx4 v1, s[12:15], s25 offen offset:1024 sc1 lds
M v[104:107], a[116:119], a[32:35], v[28:31]
v_exp_f32 v80, v80
M v[104:107], a[120:123], a[36:39], v[104:107]
ds_read_b128 a[156:159], v2 offset:10240
ds_read_b128 a[160:163], v2 offset:11264
M v[104:107], a[124:127], a[40:43], v[104:107]
v_exp_f32 v81, v81
M v[104:107], a[128:131], a[44:47], v[104:107]
buffer_load_dwordx4 v1, s[12:15], s25 offen offset:2048 sc1 lds
M v[108:111], a[128:131], a[60:63], v[28:31]
v_exp_f32 v82, v82
M v[108:111], a[124:127], a[56:59], v[108:111]
v_cvt_pk_bf16_f32 v65, v66, v67
v_cvt_pk_bf16_f32 v66, v80, v81
M v[108:111], a[120:123], a[52:55], v[108:111]
v_exp_f32 v83, v83
M v[108:111], a[116:119], a[48:51], v[108:111]
buffer_load_dwordx4 v1, s[12:15], s25 offen offset:3072 sc1 lds
s_add_u32 m0, s29, 69632
s_waitcnt lgkmcnt(4)
M v[112:115], a[132:135], a[0:3], v[20:23]
v_exp_f32 v68, v68
M v[112:115], a[136:139], a[4:7], v[112:115]
ds_read_b128 a[164:167], v2 offset:12288
ds_read_b128 a[168:171], v2 offset:13312
M v[112:115], a[140:143], a[8:11], v[112:115]
v_exp_f32 v69, v69
M v[112:115], a[144:147], a[12:15], v[112:115]
buffer_load_dwordx4 v1, s[12:15], s32 offen offset:0 sc1 lds
M v[116:119], a[144:147], a[28:31], v[24:27]
v_exp_f32 v70, v70
M v[116:119], a[140:143], a[24:27], v[116:119]
v_cvt_pk_bf16_f32 v67, v82, v83
v_cvt_pk_bf16_f32 v68, v68, v69
M v[116:119], a[136:139], a[20:23], v[116:119]
v_exp_f32 v71, v71
M v[116:119], a[132:135], a[16:19], v[116:119]
buffer_load_dwordx4 v1, s[12:15], s32 offen offset:1024 sc1 lds
M v[120:123], a[132:135], a[32:35], v[28:31]
v_exp_f32 v84, v84
M v[120:123], a[136:139], a[36:39], v[120:123]
ds_read_b128 a[172:175], v2 offset:14336
ds_read_b128 a[176:179], v2 offset:15360
M v[120:123], a[140:143], a[40:43], v[120:123]
v_exp_f32 v85, v85
M v[120:123], a[144:147], a[44:47], v[120:123]
buffer_load_dwordx4 v1, s[12:15], s32 offen offset:2048 sc1 lds
M v[124:127], a[144:147], a[60:63], v[28:31]
v_exp_f32 v86, v86
M v[124:127], a[140:143], a[56:59], v[124:127]
v_cvt_pk_bf16_f32 v69, v70, v71
v_cvt_pk_bf16_f32 v70, v84, v85
M v[124:127], a[136:139], a[52:55], v[124:127]
v_exp_f32 v87, v87
M v[124:127], a[132:135], a[48:51], v[124:127]
buffer_load_dwordx4 v1, s[12:15], s32 offen offset:3072 sc1 lds
s_add_u32 m0, s29, 98304
s_waitcnt lgkmcnt(4)
M v[128:131], a[148:151], a[0:3], v[20:23]
v_exp_f32 v72, v72
M v[128:131], a[152:155], a[4:7], v[128:131]
ds_read_b128 a[116:119], v2 offset:32768
ds_read_b128 a[120:123], v2 offset:40960
M v[128:131], a[156:159], a[8:11], v[128:131]
v_exp_f32 v73, v73
M v[128:131], a[160:163], a[12:15], v[128:131]
buffer_load_dwordx4 v1, s[12:15], s26 offen offset:0 sc1 lds
s_add_u32 s43, s26, 4096
M v[132:135], a[160:163], a[28:31], v[20:23]
v_exp_f32 v74, v74
M v[132:135], a[156:159], a[24:27], v[132:135]
v_cvt_pk_bf16_f32 v71, v86, v87
v_cvt_pk_bf16_f32 v72, v72, v73
M v[132:135], a[152:155], a[20:23], v[132:135]
v_exp_f32 v75, v75
M v[132:135], a[148:151], a[16:19], v[132:135]
buffer_load_dwordx4 v1, s[12:15], s26 offen offset:1024 sc1 lds
M v[136:139], a[148:151], a[32:35], v[24:27]
v_exp_f32 v88, v88
M v[136:139], a[152:155], a[36:39], v[136:139]
ds_read_b128 a[124:127], v2 offset:33792
ds_read_b128 a[128:131], v2 offset:41984
M v[136:139], a[156:159], a[40:43], v[136:139]
v_exp_f32 v89, v89
M v[136:139], a[160:163], a[44:47], v[136:139]
buffer_load_dwordx4 v1, s[12:15], s26 offen offset:2048 sc1 lds
M v[140:143], a[160:163], a[60:63], v[28:31]
v_exp_f32 v90, v90
M v[140:143], a[156:159], a[56:59], v[140:143]
v_cvt_pk_bf16_f32 v73, v74, v75
v_cvt_pk_bf16_f32 v74, v88, v89
M v[140:143], a[152:155], a[52:55], v[140:143]
v_exp_f32 v91, v91
M v[140:143], a[148:151], a[48:51], v[140:143]
buffer_load_dwordx4 v1, s[12:15], s26 offen offset:3072 sc1 lds
s_add_u32 m0, s29, 102400
s_waitcnt lgkmcnt(4)
M v[144:147], a[164:167], a[0:3], v[20:23]
v_exp_f32 v76, v76
M v[144:147], a[168:171], a[4:7], v[144:147]
ds_read_b128 a[132:135], v2 offset:34816
ds_read_b128 a[136:139], v2 offset:43008
M v[144:147], a[172:175], a[8:11], v[144:147]
v_exp_f32 v77, v77
M v[144:147], a[176:179], a[12:15], v[144:147]
buffer_load_dwordx4 v1, s[12:15], s43 offen offset:0 sc1 lds
M v[148:151], a[176:179], a[28:31], v[20:23]
v_exp_f32 v78, v78
M v[148:151], a[172:175], a[24:27], v[148:151]
v_cvt_pk_bf16_f32 v75, v90, v91
v_cvt_pk_bf16_f32 v76, v76, v77
M v[148:151], a[168:171], a[20:23], v[148:151]
v_exp_f32 v79, v79
M v[148:151], a[164:167], a[16:19], v[148:151]
buffer_load_dwordx4 v1, s[12:15], s43 offen offset:1024 sc1 lds
M v[152:155], a[164:167], a[32:35], v[20:23]
v_exp_f32 v92, v92
M v[152:155], a[168:171], a[36:39], v[152:155]
ds_read_b128 a[140:143], v2 offset:35840
ds_read_b128 a[144:147], v2 offset:44032
M v[152:155], a[172:175], a[40:43], v[152:155]
v_exp_f32 v93, v93
M v[152:155], a[176:179], a[44:47], v[152:155]
buffer_load_dwordx4 v1, s[12:15], s43 offen offset:2048 sc1 lds
M v[156:159], a[176:179], a[60:63], v[24:27]
v_exp_f32 v94, v94
M v[156:159], a[172:175], a[56:59], v[156:159]
v_cvt_pk_bf16_f32 v77, v78, v79
v_cvt_pk_bf16_f32 v78, v92, v93
M v[156:159], a[168:171], a[52:55], v[156:159]
v_exp_f32 v95, v95
M v[156:159], a[164:167], a[48:51], v[156:159]
buffer_load_dwordx4 v1, s[12:15], s43 offen offset:3072 sc1 lds
v_cvt_pk_bf16_f32 v79, v94, v95
s_waitcnt lgkmcnt(6)
M v[160:163], a[116:119], v[32:35], v[160:163]
v_exp_f32 v96, v96
M v[160:163], a[120:123], v[64:67], v[160:163]
ds_read_b128 a[148:151], v2 offset:36864
ds_read_b128 a[152:155], v2 offset:45056
M v[164:167], a[120:123], v[68:71], v[164:167]
v_exp_f32 v97, v97
M v[164:167], a[116:119], v[36:39], v[164:167]
v_cvt_pk_bf16_f32 v96, v96, v97
M v[168:171], a[116:119], v[40:43], v[168:171]
v_exp_f32 v98, v98
M v[168:171], a[120:123], v[72:75], v[168:171]
s_add_u32 s25, s25, 32768
s_cmp_eq_u32 s25, s27
M v[172:175], a[120:123], v[76:79], v[172:175]
v_exp_f32 v99, v99
M v[172:175], a[116:119], v[44:47], v[172:175]
v_cvt_pk_bf16_f32 v97, v98, v99
s_waitcnt lgkmcnt(6)
M a[96:99], a[112:115], v[32:35], a[96:99]
s_cselect_b32 s25, s28, s25
s_cselect_b32 s27, -1, s27
M a[96:99], a[112:115], v[64:67], a[96:99]
s_add_u32 s26, s26, 32768
s_cmp_eq_u32 s26, s62
M v[176:179], a[124:127], v[32:35], v[176:179]
v_exp_f32 v112, v112
M v[176:179], a[128:131], v[64:67], v[176:179]
ds_read_b128 a[156:159], v2 offset:37888
ds_read_b128 a[160:163], v2 offset:46080
M v[180:183], a[128:131], v[68:71], v[180:183]
v_exp_f32 v113, v113
M v[180:183], a[124:127], v[36:39], v[180:183]
v_cvt_pk_bf16_f32 v98, v112, v113
M v[184:187], a[124:127], v[40:43], v[184:187]
v_exp_f32 v114, v114
M v[184:187], a[128:131], v[72:75], v[184:187]
s_cselect_b32 s26, s63, s26
s_cselect_b32 s62, -1, s62
M v[188:191], a[128:131], v[76:79], v[188:191]
v_exp_f32 v115, v115
M v[188:191], a[124:127], v[44:47], v[188:191]
v_cvt_pk_bf16_f32 v99, v114, v115
s_waitcnt lgkmcnt(6)
M a[100:103], a[112:115], v[36:39], a[100:103]
M a[100:103], a[112:115], v[68:71], a[100:103]
M v[192:195], a[132:135], v[32:35], v[192:195]
v_exp_f32 v100, v100
M v[192:195], a[136:139], v[64:67], v[192:195]
ds_read_b128 a[164:167], v2 offset:38912
ds_read_b128 a[168:171], v2 offset:47104
M v[196:199], a[136:139], v[68:71], v[196:199]
v_exp_f32 v101, v101
M v[196:199], a[132:135], v[36:39], v[196:199]
v_cvt_pk_bf16_f32 v100, v100, v101
M v[200:203], a[132:135], v[40:43], v[200:203]
v_exp_f32 v102, v102
M v[200:203], a[136:139], v[72:75], v[200:203]
M v[204:207], a[136:139], v[76:79], v[204:207]
v_exp_f32 v103, v103
M v[204:207], a[132:135], v[44:47], v[204:207]
v_cvt_pk_bf16_f32 v101, v102, v103
s_waitcnt lgkmcnt(6)
M a[104:107], a[112:115], v[40:43], a[104:107]
M a[104:107], a[112:115], v[72:75], a[104:107]
M v[208:211], a[140:143], v[32:35], v[208:211]
v_exp_f32 v116, v116
M v[208:211], a[144:147], v[64:67], v[208:211]
ds_read_b128 a[172:175], v2 offset:39936
ds_read_b128 a[176:179], v2 offset:48128
M v[212:215], a[144:147], v[68:71], v[212:215]
v_exp_f32 v117, v117
M v[212:215], a[140:143], v[36:39], v[212:215]
v_cvt_pk_bf16_f32 v102, v116, v117
M v[216:219], a[140:143], v[40:43], v[216:219]
v_exp_f32 v118, v118
M v[216:219], a[144:147], v[72:75], v[216:219]
M v[220:223], a[144:147], v[76:79], v[220:223]
v_exp_f32 v119, v119
M v[220:223], a[140:143], v[44:47], v[220:223]
v_cvt_pk_bf16_f32 v103, v118, v119
s_waitcnt lgkmcnt(6)
M a[108:111], a[112:115], v[44:47], a[108:111]
M a[108:111], a[112:115], v[76:79], a[108:111]
M v[224:227], a[148:151], v[32:35], v[224:227]
v_exp_f32 v104, v104
M v[224:227], a[152:155], v[64:67], v[224:227]
M v[228:231], a[152:155], v[68:71], v[228:231]
v_exp_f32 v105, v105
M v[228:231], a[148:151], v[36:39], v[228:231]
v_cvt_pk_bf16_f32 v104, v104, v105
M v[232:235], a[148:151], v[40:43], v[232:235]
v_exp_f32 v106, v106
M v[232:235], a[152:155], v[72:75], v[232:235]
M v[236:239], a[152:155], v[76:79], v[236:239]
v_exp_f32 v107, v107
M v[236:239], a[148:151], v[44:47], v[236:239]
v_cvt_pk_bf16_f32 v105, v106, v107
s_waitcnt lgkmcnt(4)
M v[240:243], a[156:159], v[32:35], v[240:243]
v_exp_f32 v120, v120
M v[240:243], a[160:163], v[64:67], v[240:243]
M v[244:247], a[160:163], v[68:71], v[244:247]
v_exp_f32 v121, v121
M v[244:247], a[156:159], v[36:39], v[244:247]
v_cvt_pk_bf16_f32 v106, v120, v121
M v[248:251], a[156:159], v[40:43], v[248:251]
v_exp_f32 v122, v122
M v[248:251], a[160:163], v[72:75], v[248:251]
s_waitcnt vmcnt(0) lgkmcnt(0)
s_barrier
ds_read_b128 a[116:119], v3 offset:0
ds_read_b128 a[120:123], v3 offset:1024
M v[252:255], a[160:163], v[76:79], v[252:255]
v_exp_f32 v123, v123
M v[252:255], a[156:159], v[44:47], v[252:255]
v_cvt_pk_bf16_f32 v107, v122, v123
M a[64:67], a[164:167], v[32:35], a[64:67]
v_exp_f32 v108, v108
M a[64:67], a[168:171], v[64:67], a[64:67]
ds_read_b128 a[124:127], v3 offset:2048
ds_read_b128 a[128:131], v3 offset:3072
M a[68:71], a[168:171], v[68:71], a[68:71]
v_exp_f32 v109, v109
M a[68:71], a[164:167], v[36:39], a[68:71]
v_cvt_pk_bf16_f32 v108, v108, v109
M a[72:75], a[164:167], v[40:43], a[72:75]
v_exp_f32 v110, v110
M a[72:75], a[168:171], v[72:75], a[72:75]
ds_read_b128 a[132:135], v3 offset:4096
ds_read_b128 a[136:139], v3 offset:5120
M a[76:79], a[168:171], v[76:79], a[76:79]
v_exp_f32 v111, v111
M a[76:79], a[164:167], v[44:47], a[76:79]
v_cvt_pk_bf16_f32 v109, v110, v111
M a[80:83], a[172:175], v[32:35], a[80:83]
v_exp_f32 v124, v124
M a[80:83], a[176:179], v[64:67], a[80:83]
ds_read_b128 a[140:143], v3 offset:6144
ds_read_b128 a[144:147], v3 offset:7168
M a[84:87], a[176:179], v[68:71], a[84:87]
v_exp_f32 v125, v125
M a[84:87], a[172:175], v[36:39], a[84:87]
v_cvt_pk_bf16_f32 v110, v124, v125
M a[88:91], a[172:175], v[40:43], a[88:91]
v_exp_f32 v126, v126
M a[88:91], a[176:179], v[72:75], a[88:91]
M a[92:95], a[176:179], v[76:79], a[92:95]
v_exp_f32 v127, v127
M a[92:95], a[172:175], v[44:47], a[92:95]
v_cvt_pk_bf16_f32 v111, v126, v127
s_lshl_b32 s33, s23, 6
s_add_i32 s33, s33, -64
s_cmp_gt_i32 s33, 0
s_cselect_b32 s34, 0, 0xf149f2ca
s_cmp_lt_i32 s33, 0
s_cselect_b32 s33, 0xf149f2ca, 0
v_mov_b32 v20, s34
v_mov_b32 v21, s34
v_mov_b32 v22, s34
v_mov_b32 v23, s34
v_mov_b32 v28, s33
v_mov_b32 v29, s33
v_mov_b32 v30, s33
v_mov_b32 v31, s33
v_med3_f32 v24, v16, v20, v28
v_med3_f32 v25, v17, v20, v28
v_med3_f32 v26, v18, v20, v28
v_med3_f32 v27, v19, v20, v28
s_add_u32 m0, s29, 0
s_waitcnt lgkmcnt(4)
M v[32:35], a[116:119], a[0:3], v[24:27]
v_exp_f32 v128, v128
M v[32:35], a[120:123], a[4:7], v[32:35]
ds_read_b128 a[148:151], v3 offset:8192
ds_read_b128 a[152:155], v3 offset:9216
M v[32:35], a[124:127], a[8:11], v[32:35]
v_exp_f32 v129, v129
M v[32:35], a[128:131], a[12:15], v[32:35]
buffer_load_dwordx4 v1, s[12:15], s25 offen offset:0 sc1 lds
s_add_u32 s32, s25, 4096
M v[36:39], a[128:131], a[28:31], v[28:31]
v_exp_f32 v130, v130
M v[36:39], a[124:127], a[24:27], v[36:39]
v_cvt_pk_bf16_f32 v128, v128, v129
M v[36:39], a[120:123], a[20:23], v[36:39]
v_exp_f32 v131, v131
M v[36:39], a[116:119], a[16:19], v[36:39]
buffer_load_dwordx4 v1, s[12:15], s25 offen offset:1024 sc1 lds
M v[40:43], a[116:119], a[32:35], v[28:31]
v_exp_f32 v144, v144
M v[40:43], a[120:123], a[36:39], v[40:43]
ds_read_b128 a[156:159], v3 offset:10240
ds_read_b128 a[160:163], v3 offset:11264
M v[40:43], a[124:127], a[40:43], v[40:43]
v_exp_f32 v145, v145
M v[40:43], a[128:131], a[44:47], v[40:43]
buffer_load_dwordx4 v1, s[12:15], s25 offen offset:2048 sc1 lds
M v[44:47], a[128:131], a[60:63], v[28:31]
v_exp_f32 v146, v146
M v[44:47], a[124:127], a[56:59], v[44:47]
v_cvt_pk_bf16_f32 v129, v130, v131
v_cvt_pk_bf16_f32 v130, v144, v145
M v[44:47], a[120:123], a[52:55], v[44:47]
v_exp_f32 v147, v147
M v[44:47], a[116:119], a[48:51], v[44:47]
buffer_load_dwordx4 v1, s[12:15], s25 offen offset:3072 sc1 lds
s_add_u32 m0, s29, 4096
s_waitcnt lgkmcnt(4)
M v[48:51], a[132:135], a[0:3], v[20:23]
v_exp_f32 v132, v132
M v[48:51], a[136:139], a[4:7], v[48:51]
ds_read_b128 a[164:167], v3 offset:12288
ds_read_b128 a[168:171], v3 offset:13312
M v[48:51], a[140:143], a[8:11], v[48:51]
v_exp_f32 v133, v133
M v[48:51], a[144:147], a[12:15], v[48:51]
buffer_load_dwordx4 v1, s[12:15], s32 offen offset:0 sc1 lds
M v[52:55], a[144:147], a[28:31], v[24:27]
v_exp_f32 v134, v134
M v[52:55], a[140:143], a[24:27], v[52:55]
v_cvt_pk_bf16_f32 v131, v146, v147
v_cvt_pk_bf16_f32 v132, v132, v133
M v[52:55], a[136:139], a[20:23], v[52:55]
v_exp_f32 v135, v135
M v[52:55], a[132:135], a[16:19], v[52:55]
buffer_load_dwordx4 v1, s[12:15], s32 offen offset:1024 sc1 lds
M v[56:59], a[132:135], a[32:35], v[28:31]
v_exp_f32 v148, v148
M v[56:59], a[136:139], a[36:39], v[56:59]
ds_read_b128 a[172:175], v3 offset:14336
ds_read_b128 a[176:179], v3 offset:15360
M v[56:59], a[140:143], a[40:43], v[56:59]
v_exp_f32 v149, v149
M v[56:59], a[144:147], a[44:47], v[56:59]
buffer_load_dwordx4 v1, s[12:15], s32 offen offset:2048 sc1 lds
M v[60:63], a[144:147], a[60:63], v[28:31]
v_exp_f32 v150, v150
M v[60:63], a[140:143], a[56:59], v[60:63]
v_cvt_pk_bf16_f32 v133, v134, v135
v_cvt_pk_bf16_f32 v134, v148, v149
M v[60:63], a[136:139], a[52:55], v[60:63]
v_exp_f32 v151, v151
M v[60:63], a[132:135], a[48:51], v[60:63]
buffer_load_dwordx4 v1, s[12:15], s32 offen offset:3072 sc1 lds
s_add_u32 m0, s29, 32768
s_waitcnt lgkmcnt(4)
M v[64:67], a[148:151], a[0:3], v[20:23]
v_exp_f32 v136, v136
M v[64:67], a[152:155], a[4:7], v[64:67]
ds_read_b128 a[116:119], v3 offset:32768
ds_read_b128 a[120:123], v3 offset:40960
M v[64:67], a[156:159], a[8:11], v[64:67]
v_exp_f32 v137, v137
M v[64:67], a[160:163], a[12:15], v[64:67]
buffer_load_dwordx4 v1, s[12:15], s26 offen offset:0 sc1 lds
s_add_u32 s43, s26, 4096
M v[68:71], a[160:163], a[28:31], v[20:23]
v_exp_f32 v138, v138
M v[68:71], a[156:159], a[24:27], v[68:71]
v_cvt_pk_bf16_f32 v135, v150, v151
v_cvt_pk_bf16_f32 v136, v136, v137
M v[68:71], a[152:155], a[20:23], v[68:71]
v_exp_f32 v139, v139
M v[68:71], a[148:151], a[16:19], v[68:71]
buffer_load_dwordx4 v1, s[12:15], s26 offen offset:1024 sc1 lds
M v[72:75], a[148:151], a[32:35], v[24:27]
v_exp_f32 v152, v152
M v[72:75], a[152:155], a[36:39], v[72:75]
ds_read_b128 a[124:127], v3 offset:33792
ds_read_b128 a[128:131], v3 offset:41984
M v[72:75], a[156:159], a[40:43], v[72:75]
v_exp_f32 v153, v153
M v[72:75], a[160:163], a[44:47], v[72:75]
buffer_load_dwordx4 v1, s[12:15], s26 offen offset:2048 sc1 lds
M v[76:79], a[160:163], a[60:63], v[28:31]
v_exp_f32 v154, v154
M v[76:79], a[156:159], a[56:59], v[76:79]
v_cvt_pk_bf16_f32 v137, v138, v139
v_cvt_pk_bf16_f32 v138, v152, v153
M v[76:79], a[152:155], a[52:55], v[76:79]
v_exp_f32 v155, v155
M v[76:79], a[148:151], a[48:51], v[76:79]
buffer_load_dwordx4 v1, s[12:15], s26 offen offset:3072 sc1 lds
s_add_u32 m0, s29, 36864
s_waitcnt lgkmcnt(4)
M v[80:83], a[164:167], a[0:3], v[20:23]
v_exp_f32 v140, v140
M v[80:83], a[168:171], a[4:7], v[80:83]
ds_read_b128 a[132:135], v3 offset:34816
ds_read_b128 a[136:139], v3 offset:43008
M v[80:83], a[172:175], a[8:11], v[80:83]
v_exp_f32 v141, v141
M v[80:83], a[176:179], a[12:15], v[80:83]
buffer_load_dwordx4 v1, s[12:15], s43 offen offset:0 sc1 lds
M v[84:87], a[176:179], a[28:31], v[20:23]
v_exp_f32 v142, v142
M v[84:87], a[172:175], a[24:27], v[84:87]
v_cvt_pk_bf16_f32 v139, v154, v155
v_cvt_pk_bf16_f32 v140, v140, v141
M v[84:87], a[168:171], a[20:23], v[84:87]
v_exp_f32 v143, v143
M v[84:87], a[164:167], a[16:19], v[84:87]
buffer_load_dwordx4 v1, s[12:15], s43 offen offset:1024 sc1 lds
M v[88:91], a[164:167], a[32:35], v[20:23]
v_exp_f32 v156, v156
M v[88:91], a[168:171], a[36:39], v[88:91]
ds_read_b128 a[140:143], v3 offset:35840
ds_read_b128 a[144:147], v3 offset:44032
M v[88:91], a[172:175], a[40:43], v[88:91]
v_exp_f32 v157, v157
M v[88:91], a[176:179], a[44:47], v[88:91]
buffer_load_dwordx4 v1, s[12:15], s43 offen offset:2048 sc1 lds
M v[92:95], a[176:179], a[60:63], v[24:27]
v_exp_f32 v158, v158
M v[92:95], a[172:175], a[56:59], v[92:95]
v_cvt_pk_bf16_f32 v141, v142, v143
v_cvt_pk_bf16_f32 v142, v156, v157
M v[92:95], a[168:171], a[52:55], v[92:95]
v_exp_f32 v159, v159
M v[92:95], a[164:167], a[48:51], v[92:95]
buffer_load_dwordx4 v1, s[12:15], s43 offen offset:3072 sc1 lds
v_cvt_pk_bf16_f32 v143, v158, v159
s_waitcnt lgkmcnt(6)
M v[160:163], a[116:119], v[96:99], v[160:163]
v_exp_f32 v32, v32
M v[160:163], a[120:123], v[128:131], v[160:163]
ds_read_b128 a[148:151], v3 offset:36864
ds_read_b128 a[152:155], v3 offset:45056
M v[164:167], a[120:123], v[132:135], v[164:167]
v_exp_f32 v33, v33
M v[164:167], a[116:119], v[100:103], v[164:167]
v_cvt_pk_bf16_f32 v32, v32, v33
M v[168:171], a[116:119], v[104:107], v[168:171]
v_exp_f32 v34, v34
M v[168:171], a[120:123], v[136:139], v[168:171]
s_add_u32 s25, s25, 32768
s_cmp_eq_u32 s25, s27
M v[172:175], a[120:123], v[140:143], v[172:175]
v_exp_f32 v35, v35
M v[172:175], a[116:119], v[108:111], v[172:175]
v_cvt_pk_bf16_f32 v33, v34, v35
s_waitcnt lgkmcnt(6)
M a[96:99], a[112:115], v[96:99], a[96:99]
s_cselect_b32 s25, s28, s25
s_cselect_b32 s27, -1, s27
M a[96:99], a[112:115], v[128:131], a[96:99]
s_add_u32 s26, s26, 32768
s_cmp_eq_u32 s26, s62
M v[176:179], a[124:127], v[96:99], v[176:179]
v_exp_f32 v48, v48
M v[176:179], a[128:131], v[128:131], v[176:179]
ds_read_b128 a[156:159], v3 offset:37888
ds_read_b128 a[160:163], v3 offset:46080
M v[180:183], a[128:131], v[132:135], v[180:183]
v_exp_f32 v49, v49
M v[180:183], a[124:127], v[100:103], v[180:183]
v_cvt_pk_bf16_f32 v34, v48, v49
M v[184:187], a[124:127], v[104:107], v[184:187]
v_exp_f32 v50, v50
M v[184:187], a[128:131], v[136:139], v[184:187]
s_cselect_b32 s26, s63, s26
s_cselect_b32 s62, -1, s62
M v[188:191], a[128:131], v[140:143], v[188:191]
v_exp_f32 v51, v51
M v[188:191], a[124:127], v[108:111], v[188:191]
v_cvt_pk_bf16_f32 v35, v50, v51
s_waitcnt lgkmcnt(6)
M a[100:103], a[112:115], v[100:103], a[100:103]
M a[100:103], a[112:115], v[132:135], a[100:103]
M v[192:195], a[132:135], v[96:99], v[192:195]
v_exp_f32 v36, v36
M v[192:195], a[136:139], v[128:131], v[192:195]
ds_read_b128 a[164:167], v3 offset:38912
ds_read_b128 a[168:171], v3 offset:47104
M v[196:199], a[136:139], v[132:135], v[196:199]
v_exp_f32 v37, v37
M v[196:199], a[132:135], v[100:103], v[196:199]
v_cvt_pk_bf16_f32 v36, v36, v37
M v[200:203], a[132:135], v[104:107], v[200:203]
v_exp_f32 v38, v38
M v[200:203], a[136:139], v[136:139], v[200:203]
M v[204:207], a[136:139], v[140:143], v[204:207]
v_exp_f32 v39, v39
M v[204:207], a[132:135], v[108:111], v[204:207]
v_cvt_pk_bf16_f32 v37, v38, v39
s_waitcnt lgkmcnt(6)
M a[104:107], a[112:115], v[104:107], a[104:107]
M a[104:107], a[112:115], v[136:139], a[104:107]
M v[208:211], a[140:143], v[96:99], v[208:211]
v_exp_f32 v52, v52
M v[208:211], a[144:147], v[128:131], v[208:211]
ds_read_b128 a[172:175], v3 offset:39936
ds_read_b128 a[176:179], v3 offset:48128
M v[212:215], a[144:147], v[132:135], v[212:215]
v_exp_f32 v53, v53
M v[212:215], a[140:143], v[100:103], v[212:215]
v_cvt_pk_bf16_f32 v38, v52, v53
M v[216:219], a[140:143], v[104:107], v[216:219]
v_exp_f32 v54, v54
M v[216:219], a[144:147], v[136:139], v[216:219]
M v[220:223], a[144:147], v[140:143], v[220:223]
v_exp_f32 v55, v55
M v[220:223], a[140:143], v[108:111], v[220:223]
v_cvt_pk_bf16_f32 v39, v54, v55
s_waitcnt lgkmcnt(6)
M a[108:111], a[112:115], v[108:111], a[108:111]
M a[108:111], a[112:115], v[140:143], a[108:111]
M v[224:227], a[148:151], v[96:99], v[224:227]
v_exp_f32 v40, v40
M v[224:227], a[152:155], v[128:131], v[224:227]
M v[228:231], a[152:155], v[132:135], v[228:231]
v_exp_f32 v41, v41
M v[228:231], a[148:151], v[100:103], v[228:231]
v_cvt_pk_bf16_f32 v40, v40, v41
M v[232:235], a[148:151], v[104:107], v[232:235]
v_exp_f32 v42, v42
M v[232:235], a[152:155], v[136:139], v[232:235]
M v[236:239], a[152:155], v[140:143], v[236:239]
v_exp_f32 v43, v43
M v[236:239], a[148:151], v[108:111], v[236:239]
v_cvt_pk_bf16_f32 v41, v42, v43
s_waitcnt lgkmcnt(4)
M v[240:243], a[156:159], v[96:99], v[240:243]
v_exp_f32 v56, v56
M v[240:243], a[160:163], v[128:131], v[240:243]
M v[244:247], a[160:163], v[132:135], v[244:247]
v_exp_f32 v57, v57
M v[244:247], a[156:159], v[100:103], v[244:247]
v_cvt_pk_bf16_f32 v42, v56, v57
M v[248:251], a[156:159], v[104:107], v[248:251]
v_exp_f32 v58, v58
M v[248:251], a[160:163], v[136:139], v[248:251]
s_waitcnt vmcnt(0) lgkmcnt(0)
s_barrier
ds_read_b128 a[116:119], v2 offset:0
ds_read_b128 a[120:123], v2 offset:1024
M v[252:255], a[160:163], v[140:143], v[252:255]
v_exp_f32 v59, v59
M v[252:255], a[156:159], v[108:111], v[252:255]
v_cvt_pk_bf16_f32 v43, v58, v59
M a[64:67], a[164:167], v[96:99], a[64:67]
v_exp_f32 v44, v44
M a[64:67], a[168:171], v[128:131], a[64:67]
ds_read_b128 a[124:127], v2 offset:2048
ds_read_b128 a[128:131], v2 offset:3072
M a[68:71], a[168:171], v[132:135], a[68:71]
v_exp_f32 v45, v45
M a[68:71], a[164:167], v[100:103], a[68:71]
v_cvt_pk_bf16_f32 v44, v44, v45
M a[72:75], a[164:167], v[104:107], a[72:75]
v_exp_f32 v46, v46
M a[72:75], a[168:171], v[136:139], a[72:75]
ds_read_b128 a[132:135], v2 offset:4096
ds_read_b128 a[136:139], v2 offset:5120
M a[76:79], a[168:171], v[140:143], a[76:79]
v_exp_f32 v47, v47
M a[76:79], a[164:167], v[108:111], a[76:79]
v_cvt_pk_bf16_f32 v45, v46, v47
M a[80:83], a[172:175], v[96:99], a[80:83]
v_exp_f32 v60, v60
M a[80:83], a[176:179], v[128:131], a[80:83]
ds_read_b128 a[140:143], v2 offset:6144
ds_read_b128 a[144:147], v2 offset:7168
M a[84:87], a[176:179], v[132:135], a[84:87]
v_exp_f32 v61, v61
M a[84:87], a[172:175], v[100:103], a[84:87]
v_cvt_pk_bf16_f32 v46, v60, v61
M a[88:91], a[172:175], v[104:107], a[88:91]
v_exp_f32 v62, v62
M a[88:91], a[176:179], v[136:139], a[88:91]
M a[92:95], a[176:179], v[140:143], a[92:95]
v_exp_f32 v63, v63
M a[92:95], a[172:175], v[108:111], a[92:95]
v_cvt_pk_bf16_f32 v47, v62, v63
s_waitcnt lgkmcnt(0)
Lk2_fin:
s_and_b32 s3, s2, 3
s_lshl_b32 s3, s3, 2
s_bfe_u32 s27, s2, 0x20003
s_add_u32 s27, s3, s27
s_lshl_b32 s43, s27, 8
s_add_u32 s43, s43, 8400896
v_lshlrev_b32 v15, 2, v0
buffer_load_dword v7, v15, s[52:55], s43 offen sc1
ds_read_b128 a[116:119], v2 offset:32768
ds_read_b128 a[120:123], v2 offset:40960
ds_read_b128 a[124:127], v2 offset:33792
ds_read_b128 a[128:131], v2 offset:41984
ds_read_b128 a[132:135], v2 offset:34816
ds_read_b128 a[136:139], v2 offset:43008
ds_read_b128 a[140:143], v2 offset:35840
ds_read_b128 a[144:147], v2 offset:44032
v_exp_f32 v64, v64
v_exp_f32 v65, v65
v_exp_f32 v66, v66
v_exp_f32 v67, v67
v_exp_f32 v80, v80
v_exp_f32 v81, v81
v_exp_f32 v82, v82
v_exp_f32 v83, v83
v_cvt_pk_bf16_f32 v64, v64, v65
v_cvt_pk_bf16_f32 v65, v66, v67
v_exp_f32 v68, v68
v_exp_f32 v69, v69
v_exp_f32 v70, v70
v_exp_f32 v71, v71
v_cvt_pk_bf16_f32 v66, v80, v81
v_cvt_pk_bf16_f32 v67, v82, v83
v_exp_f32 v84, v84
v_exp_f32 v85, v85
v_exp_f32 v86, v86
v_exp_f32 v87, v87
v_cvt_pk_bf16_f32 v68, v68, v69
v_cvt_pk_bf16_f32 v69, v70, v71
v_exp_f32 v72, v72
v_exp_f32 v73, v73
v_exp_f32 v74, v74
v_exp_f32 v75, v75
v_cvt_pk_bf16_f32 v70, v84, v85
v_cvt_pk_bf16_f32 v71, v86, v87
v_exp_f32 v88, v88
v_exp_f32 v89, v89
v_exp_f32 v90, v90
v_exp_f32 v91, v91
v_cvt_pk_bf16_f32 v72, v72, v73
v_cvt_pk_bf16_f32 v73, v74, v75
v_exp_f32 v76, v76
v_exp_f32 v77, v77
v_exp_f32 v78, v78
v_exp_f32 v79, v79
v_cvt_pk_bf16_f32 v74, v88, v89
v_cvt_pk_bf16_f32 v75, v90, v91
v_exp_f32 v92, v92
v_exp_f32 v93, v93
v_exp_f32 v94, v94
v_exp_f32 v95, v95
v_cvt_pk_bf16_f32 v76, v76, v77
v_cvt_pk_bf16_f32 v77, v78, v79
v_cvt_pk_bf16_f32 v78, v92, v93
v_cvt_pk_bf16_f32 v79, v94, v95
s_waitcnt lgkmcnt(6)
M v[160:163], a[116:119], v[32:35], v[160:163]
M v[160:163], a[120:123], v[64:67], v[160:163]
ds_read_b128 a[148:151], v2 offset:36864
ds_read_b128 a[152:155], v2 offset:45056
s_mov_b32 s61, 0
M v[164:167], a[120:123], v[68:71], v[164:167]
M v[164:167], a[116:119], v[36:39], v[164:167]
s_bfe_u32 s3, s2, 0x10002
M v[168:171], a[116:119], v[40:43], v[168:171]
M v[168:171], a[120:123], v[72:75], v[168:171]
s_lshl_b32 s3, s3, 3
M v[172:175], a[120:123], v[76:79], v[172:175]
M v[172:175], a[116:119], v[44:47], v[172:175]
s_waitcnt lgkmcnt(6)
s_lshr_b32 s28, s2, 5
M a[96:99], a[112:115], v[32:35], a[96:99]
M a[96:99], a[112:115], v[64:67], a[96:99]
M v[176:179], a[124:127], v[32:35], v[176:179]
M v[176:179], a[128:131], v[64:67], v[176:179]
ds_read_b128 a[156:159], v2 offset:37888
ds_read_b128 a[160:163], v2 offset:46080
s_add_u32 s28, s3, s28
M v[180:183], a[128:131], v[68:71], v[180:183]
s_lshl_b32 s25, s27, 18
M v[180:183], a[124:127], v[36:39], v[180:183]
M v[184:187], a[124:127], v[40:43], v[184:187]
s_lshl_b32 s3, s101, 12
M v[184:187], a[128:131], v[72:75], v[184:187]
M v[188:191], a[128:131], v[76:79], v[188:191]
s_add_u32 s25, s25, s3
M v[188:191], a[124:127], v[44:47], v[188:191]
s_waitcnt lgkmcnt(6)
M a[100:103], a[112:115], v[36:39], a[100:103]
M a[100:103], a[112:115], v[68:71], a[100:103]
M v[192:195], a[132:135], v[32:35], v[192:195]
s_lshl_b32 s26, s28, 7
M v[192:195], a[136:139], v[64:67], v[192:195]
ds_read_b128 a[164:167], v2 offset:38912
ds_read_b128 a[168:171], v2 offset:47104
M v[196:199], a[136:139], v[68:71], v[196:199]
s_lshl_b32 s42, s101, 11
M v[196:199], a[132:135], v[36:39], v[196:199]
M v[200:203], a[132:135], v[40:43], v[200:203]
s_add_u32 s44, s4, 83886080
s_addc_u32 s45, s5, 0
M v[200:203], a[136:139], v[72:75], v[200:203]
s_mov_b32 s46, 4194304
M v[204:207], a[136:139], v[76:79], v[204:207]
M v[204:207], a[132:135], v[44:47], v[204:207]
s_waitcnt lgkmcnt(6)
s_mov_b32 s47, 0x00020000
M a[104:107], a[112:115], v[40:43], a[104:107]
M a[104:107], a[112:115], v[72:75], a[104:107]
M v[208:211], a[140:143], v[32:35], v[208:211]
M v[208:211], a[144:147], v[64:67], v[208:211]
ds_read_b128 a[172:175], v2 offset:39936
ds_read_b128 a[176:179], v2 offset:48128
s_mov_b32 s50, 2097152
M v[212:215], a[144:147], v[68:71], v[212:215]
M v[212:215], a[140:143], v[36:39], v[212:215]
s_mov_b32 s51, 0x00020000
M v[216:219], a[140:143], v[40:43], v[216:219]
M v[216:219], a[144:147], v[72:75], v[216:219]
s_lshl_b32 s3, s101, 4
M v[220:223], a[144:147], v[76:79], v[220:223]
M v[220:223], a[140:143], v[44:47], v[220:223]
s_waitcnt lgkmcnt(6)
v_lshrrev_b32 v96, 3, v0
M a[108:111], a[112:115], v[44:47], a[108:111]
M a[108:111], a[112:115], v[76:79], a[108:111]
M v[224:227], a[148:151], v[32:35], v[224:227]
v_and_b32 v97, 6, v96
M v[224:227], a[152:155], v[64:67], v[224:227]
M v[228:231], a[152:155], v[68:71], v[228:231]
v_and_b32 v98, 7, v0
M v[228:231], a[148:151], v[36:39], v[228:231]
M v[232:235], a[148:151], v[40:43], v[232:235]
v_xor_b32 v97, v97, v98
M v[232:235], a[152:155], v[72:75], v[232:235]
M v[236:239], a[152:155], v[76:79], v[236:239]
v_add_u32 v96, s3, v96
M v[236:239], a[148:151], v[44:47], v[236:239]
s_waitcnt lgkmcnt(4)
M v[240:243], a[156:159], v[32:35], v[240:243]
v_lshlrev_b32 v96, 11, v96
M v[240:243], a[160:163], v[64:67], v[240:243]
M v[244:247], a[160:163], v[68:71], v[244:247]
v_lshl_add_u32 v99, v97, 4, v96
M v[244:247], a[156:159], v[36:39], v[244:247]
v_add_u32 v100, 15360, v99
M v[248:251], a[156:159], v[40:43], v[248:251]
M v[248:251], a[160:163], v[72:75], v[248:251]
s_waitcnt vmcnt(0) lgkmcnt(0)
s_barrier
v_cmp_ne_u32 vcc, 1, v7
s_nop 0
s_cbranch_vccnz Lk3_spinb0
Lk3_gotb0:
M v[252:255], a[160:163], v[76:79], v[252:255]
s_add_u32 m0, s42, 65536
s_nop 0
buffer_load_dwordx4 v99, s[48:51], s26 offen offset:0 lds
buffer_load_dwordx4 v100, s[48:51], s26 offen offset:1024 lds
M v[252:255], a[156:159], v[44:47], v[252:255]
buffer_load_dwordx4 a[192:195], v1, s[44:47], s25 offen offset:0 sc1
buffer_load_dwordx4 a[196:199], v1, s[44:47], s25 offen offset:1024 sc1
M a[64:67], a[164:167], v[32:35], a[64:67]
buffer_load_dwordx4 a[200:203], v1, s[44:47], s25 offen offset:2048 sc1
buffer_load_dwordx4 a[204:207], v1, s[44:47], s25 offen offset:3072 sc1
M a[64:67], a[168:171], v[64:67], a[64:67]
s_add_u32 s25, s25, 16384
s_add_u32 s26, s26, 131072
s_add_u32 m0, s42, 81920
s_nop 0
buffer_load_dwordx4 v99, s[48:51], s26 offen offset:0 lds
M a[68:71], a[168:171], v[68:71], a[68:71]
buffer_load_dwordx4 v100, s[48:51], s26 offen offset:1024 lds
buffer_load_dwordx4 a[208:211], v1, s[44:47], s25 offen offset:0 sc1
M a[68:71], a[164:167], v[36:39], a[68:71]
buffer_load_dwordx4 a[212:215], v1, s[44:47], s25 offen offset:1024 sc1
buffer_load_dwordx4 a[216:219], v1, s[44:47], s25 offen offset:2048 sc1
M a[72:75], a[164:167], v[40:43], a[72:75]
buffer_load_dwordx4 a[220:223], v1, s[44:47], s25 offen offset:3072 sc1
s_add_u32 s25, s25, 16384
s_add_u32 s26, s26, 131072
M a[72:75], a[168:171], v[72:75], a[72:75]
s_add_u32 m0, s42, 98304
s_nop 0
buffer_load_dwordx4 v99, s[48:51], s26 offen offset:0 lds
buffer_load_dwordx4 v100, s[48:51], s26 offen offset:1024 lds
M a[76:79], a[168:171], v[76:79], a[76:79]
buffer_load_dwordx4 a[224:227], v1, s[44:47], s25 offen offset:0 sc1
M a[76:79], a[164:167], v[44:47], a[76:79]
buffer_load_dwordx4 a[228:231], v1, s[44:47], s25 offen offset:1024 sc1
buffer_load_dwordx4 a[232:235], v1, s[44:47], s25 offen offset:2048 sc1
M a[80:83], a[172:175], v[32:35], a[80:83]
buffer_load_dwordx4 a[236:239], v1, s[44:47], s25 offen offset:3072 sc1
s_add_u32 s25, s25, 16384
s_add_u32 s26, s26, 131072
M a[80:83], a[176:179], v[64:67], a[80:83]
s_add_u32 m0, s42, 114688
s_nop 0
buffer_load_dwordx4 v99, s[48:51], s26 offen offset:0 lds
buffer_load_dwordx4 v100, s[48:51], s26 offen offset:1024 lds
M a[84:87], a[176:179], v[68:71], a[84:87]
buffer_load_dwordx4 a[240:243], v1, s[44:47], s25 offen offset:0 sc1
buffer_load_dwordx4 a[244:247], v1, s[44:47], s25 offen offset:1024 sc1
M a[84:87], a[172:175], v[36:39], a[84:87]
buffer_load_dwordx4 a[248:251], v1, s[44:47], s25 offen offset:2048 sc1
buffer_load_dwordx4 a[252:255], v1, s[44:47], s25 offen offset:3072 sc1
M a[88:91], a[172:175], v[40:43], a[88:91]
s_add_u32 s25, s25, 16384
s_add_u32 s26, s26, 131072
s_add_u32 m0, s42, 0
s_nop 0
buffer_load_dwordx4 v99, s[48:51], s26 offen offset:0 lds
M a[88:91], a[176:179], v[72:75], a[88:91]
buffer_load_dwordx4 v100, s[48:51], s26 offen offset:1024 lds
buffer_load_dwordx4 a[128:131], v1, s[44:47], s25 offen offset:0 sc1
M a[92:95], a[176:179], v[76:79], a[92:95]
buffer_load_dwordx4 a[132:135], v1, s[44:47], s25 offen offset:1024 sc1
buffer_load_dwordx4 a[136:139], v1, s[44:47], s25 offen offset:2048 sc1
M a[92:95], a[172:175], v[44:47], a[92:95]
buffer_load_dwordx4 a[140:143], v1, s[44:47], s25 offen offset:3072 sc1
s_add_u32 s25, s25, 16384
s_add_u32 s26, s26, 131072
Lk2_merge:
s_lshl_b32 s33, s23, 14
s_add_u32 s34, s33, 131072
s_add_u32 s33, s33, 32768
s_cmp_eq_u32 s24, 0
s_cselect_b32 s35, s34, s33
s_cselect_b32 s36, s33, s34
v_add_u32 v2, s35, v1
v_add_u32 v3, s36, v1
s_lshl_b32 s33, s22, 10
s_add_u32 s33, s33, 28672
s_xor_b32 s34, s33, 2048
v_add_u32 v14, s33, v1
v_add_u32 v15, s34, v1
v_accvgpr_read_b32 v20, a96
v_accvgpr_read_b32 v21, a100
v_accvgpr_read_b32 v22, a104
v_accvgpr_read_b32 v23, a108
ds_write_b128 v14, v[20:23]
s_cmp_eq_u32 s24, 1
s_waitcnt lgkmcnt(0)
s_cbranch_scc1 Lk2_mg1
ds_write_b128 v2, v[224:227] offset:0
ds_write_b128 v2, v[228:231] offset:1024
ds_write_b128 v2, v[232:235] offset:2048
ds_write_b128 v2, v[236:239] offset:3072
ds_write_b128 v2, v[240:243] offset:4096
ds_write_b128 v2, v[244:247] offset:5120
ds_write_b128 v2, v[248:251] offset:6144
ds_write_b128 v2, v[252:255] offset:7168
ds_write_b128 v2, a[64:67] offset:8192
ds_write_b128 v2, a[68:71] offset:9216
ds_write_b128 v2, a[72:75] offset:10240
ds_write_b128 v2, a[76:79] offset:11264
ds_write_b128 v2, a[80:83] offset:12288
ds_write_b128 v2, a[84:87] offset:13312
ds_write_b128 v2, a[88:91] offset:14336
ds_write_b128 v2, a[92:95] offset:15360
s_waitcnt lgkmcnt(0)
s_barrier
ds_read_b128 v[28:31], v15
ds_read_b128 v[32:35], v3 offset:0
ds_read_b128 v[36:39], v3 offset:1024
ds_read_b128 v[40:43], v3 offset:2048
ds_read_b128 v[44:47], v3 offset:3072
ds_read_b128 v[48:51], v3 offset:4096
ds_read_b128 v[52:55], v3 offset:5120
ds_read_b128 v[56:59], v3 offset:6144
ds_read_b128 v[60:63], v3 offset:7168
ds_read_b128 v[64:67], v3 offset:8192
ds_read_b128 v[68:71], v3 offset:9216
ds_read_b128 v[72:75], v3 offset:10240
ds_read_b128 v[76:79], v3 offset:11264
ds_read_b128 v[80:83], v3 offset:12288
ds_read_b128 v[84:87], v3 offset:13312
ds_read_b128 v[88:91], v3 offset:14336
ds_read_b128 v[92:95], v3 offset:15360
s_waitcnt lgkmcnt(15)
v_add_f32 v20, v20, v28
v_add_f32 v21, v21, v29
v_add_f32 v22, v22, v30
v_add_f32 v23, v23, v31
s_sub_u32 s35, 15, s21
v_rcp_f32 v8, v20
v_rcp_f32 v9, v21
v_rcp_f32 v10, v22
v_rcp_f32 v11, v23
v_subrev_u32 v20, 0x21800000, v20
v_subrev_u32 v21, 0x21800000, v21
v_subrev_u32 v22, 0x21800000, v22
v_subrev_u32 v23, 0x21800000, v23
v_max_u32 v12, v20, v21
v_max3_u32 v12, v12, v22, v23
s_mov_b32 s64, 0x207
s_lshl_b32 s33, s35, 20
s_lshl_b32 s34, s20, 15
s_add_u32 s33, s33, s34
s_lshl_b32 s34, s23, 13
s_add_u32 s36, s33, s34
s_add_u32 s37, s36, 4096
s_add_u32 s38, s36, 16384
s_add_u32 s39, s36, 20480
v_pk_add_f32 v[160:161], v[160:161], v[32:33]
v_pk_add_f32 v[162:163], v[162:163], v[34:35]
s_waitcnt lgkmcnt(11)
v_pk_add_f32 v[176:177], v[176:177], v[48:49]
v_pk_add_f32 v[178:179], v[178:179], v[50:51]
v_pk_mul_f32 v[160:161], v[160:161], v[8:9] op_sel:[0,0] op_sel_hi:[1,0]
v_pk_mul_f32 v[162:163], v[162:163], v[8:9] op_sel:[0,0] op_sel_hi:[1,0]
v_pk_mul_f32 v[176:177], v[176:177], v[8:9] op_sel:[0,0] op_sel_hi:[1,0]
v_pk_mul_f32 v[178:179], v[178:179], v[8:9] op_sel:[0,0] op_sel_hi:[1,0]
v_cvt_pk_bf16_f32 v160, v160, v161
v_cvt_pk_bf16_f32 v161, v162, v163
v_cvt_pk_bf16_f32 v162, v176, v177
v_cvt_pk_bf16_f32 v163, v178, v179
v_pk_add_f32 v[164:165], v[164:165], v[36:37]
v_pk_add_f32 v[166:167], v[166:167], v[38:39]
s_waitcnt lgkmcnt(10)
v_pk_add_f32 v[180:181], v[180:181], v[52:53]
v_pk_add_f32 v[182:183], v[182:183], v[54:55]
M v[24:27], a[112:115], v[160:163], 0
buffer_store_dwordx4 v[160:163], v1, s[16:19], s36 offen offset:0 sc1
v_pk_mul_f32 v[164:165], v[164:165], v[8:9] op_sel:[0,1] op_sel_hi:[1,1]
v_pk_mul_f32 v[166:167], v[166:167], v[8:9] op_sel:[0,1] op_sel_hi:[1,1]
v_pk_mul_f32 v[180:181], v[180:181], v[8:9] op_sel:[0,1] op_sel_hi:[1,1]
v_pk_mul_f32 v[182:183], v[182:183], v[8:9] op_sel:[0,1] op_sel_hi:[1,1]
v_cvt_pk_bf16_f32 v164, v164, v165
v_cvt_pk_bf16_f32 v165, v166, v167
v_cvt_pk_bf16_f32 v166, v180, v181
v_cvt_pk_bf16_f32 v167, v182, v183
v_pk_add_f32 v[168:169], v[168:169], v[40:41]
v_pk_add_f32 v[170:171], v[170:171], v[42:43]
s_waitcnt lgkmcnt(9)
v_pk_add_f32 v[184:185], v[184:185], v[56:57]
v_pk_add_f32 v[186:187], v[186:187], v[58:59]
M v[24:27], a[112:115], v[164:167], v[24:27]
buffer_store_dwordx4 v[164:167], v1, s[16:19], s36 offen offset:2048 sc1
v_pk_mul_f32 v[168:169], v[168:169], v[10:11] op_sel:[0,0] op_sel_hi:[1,0]
v_pk_mul_f32 v[170:171], v[170:171], v[10:11] op_sel:[0,0] op_sel_hi:[1,0]
v_pk_mul_f32 v[184:185], v[184:185], v[10:11] op_sel:[0,0] op_sel_hi:[1,0]
v_pk_mul_f32 v[186:187], v[186:187], v[10:11] op_sel:[0,0] op_sel_hi:[1,0]
v_cvt_pk_bf16_f32 v168, v168, v169
v_cvt_pk_bf16_f32 v169, v170, v171
v_cvt_pk_bf16_f32 v170, v184, v185
v_cvt_pk_bf16_f32 v171, v186, v187
v_pk_add_f32 v[172:173], v[172:173], v[44:45]
v_pk_add_f32 v[174:175], v[174:175], v[46:47]
s_waitcnt lgkmcnt(8)
v_pk_add_f32 v[188:189], v[188:189], v[60:61]
v_pk_add_f32 v[190:191], v[190:191], v[62:63]
M v[24:27], a[112:115], v[168:171], v[24:27]
buffer_store_dwordx4 v[168:171], v1, s[16:19], s37 offen offset:0 sc1
v_pk_mul_f32 v[172:173], v[172:173], v[10:11] op_sel:[0,1] op_sel_hi:[1,1]
v_pk_mul_f32 v[174:175], v[174:175], v[10:11] op_sel:[0,1] op_sel_hi:[1,1]
v_pk_mul_f32 v[188:189], v[188:189], v[10:11] op_sel:[0,1] op_sel_hi:[1,1]
v_pk_mul_f32 v[190:191], v[190:191], v[10:11] op_sel:[0,1] op_sel_hi:[1,1]
v_cvt_pk_bf16_f32 v172, v172, v173
v_cvt_pk_bf16_f32 v173, v174, v175
v_cvt_pk_bf16_f32 v174, v188, v189
v_cvt_pk_bf16_f32 v175, v190, v191
s_waitcnt lgkmcnt(7)
v_pk_add_f32 v[192:193], v[192:193], v[64:65]
v_pk_add_f32 v[194:195], v[194:195], v[66:67]
s_waitcnt lgkmcnt(3)
v_pk_add_f32 v[208:209], v[208:209], v[80:81]
v_pk_add_f32 v[210:211], v[210:211], v[82:83]
M v[24:27], a[112:115], v[172:175], v[24:27]
buffer_store_dwordx4 v[172:175], v1, s[16:19], s37 offen offset:2048 sc1
v_pk_mul_f32 v[192:193], v[192:193], v[8:9] op_sel:[0,0] op_sel_hi:[1,0]
v_pk_mul_f32 v[194:195], v[194:195], v[8:9] op_sel:[0,0] op_sel_hi:[1,0]
v_pk_mul_f32 v[208:209], v[208:209], v[8:9] op_sel:[0,0] op_sel_hi:[1,0]
v_pk_mul_f32 v[210:211], v[210:211], v[8:9] op_sel:[0,0] op_sel_hi:[1,0]
v_cvt_pk_bf16_f32 v192, v192, v193
v_cvt_pk_bf16_f32 v193, v194, v195
v_cvt_pk_bf16_f32 v194, v208, v209
v_cvt_pk_bf16_f32 v195, v210, v211
v_pk_add_f32 v[196:197], v[196:197], v[68:69]
v_pk_add_f32 v[198:199], v[198:199], v[70:71]
s_waitcnt lgkmcnt(2)
v_pk_add_f32 v[212:213], v[212:213], v[84:85]
v_pk_add_f32 v[214:215], v[214:215], v[86:87]
M v[24:27], a[112:115], v[192:195], v[24:27]
buffer_store_dwordx4 v[192:195], v1, s[16:19], s36 offen offset:1024 sc1
v_pk_mul_f32 v[196:197], v[196:197], v[8:9] op_sel:[0,1] op_sel_hi:[1,1]
v_pk_mul_f32 v[198:199], v[198:199], v[8:9] op_sel:[0,1] op_sel_hi:[1,1]
v_pk_mul_f32 v[212:213], v[212:213], v[8:9] op_sel:[0,1] op_sel_hi:[1,1]
v_pk_mul_f32 v[214:215], v[214:215], v[8:9] op_sel:[0,1] op_sel_hi:[1,1]
v_cvt_pk_bf16_f32 v196, v196, v197
v_cvt_pk_bf16_f32 v197, v198, v199
v_cvt_pk_bf16_f32 v198, v212, v213
v_cvt_pk_bf16_f32 v199, v214, v215
v_pk_add_f32 v[200:201], v[200:201], v[72:73]
v_pk_add_f32 v[202:203], v[202:203], v[74:75]
s_waitcnt lgkmcnt(1)
v_pk_add_f32 v[216:217], v[216:217], v[88:89]
v_pk_add_f32 v[218:219], v[218:219], v[90:91]
M v[24:27], a[112:115], v[196:199], v[24:27]
buffer_store_dwordx4 v[196:199], v1, s[16:19], s36 offen offset:3072 sc1
v_pk_mul_f32 v[200:201], v[200:201], v[10:11] op_sel:[0,0] op_sel_hi:[1,0]
v_pk_mul_f32 v[202:203], v[202:203], v[10:11] op_sel:[0,0] op_sel_hi:[1,0]
v_pk_mul_f32 v[216:217], v[216:217], v[10:11] op_sel:[0,0] op_sel_hi:[1,0]
v_pk_mul_f32 v[218:219], v[218:219], v[10:11] op_sel:[0,0] op_sel_hi:[1,0]
v_cvt_pk_bf16_f32 v200, v200, v201
v_cvt_pk_bf16_f32 v201, v202, v203
v_cvt_pk_bf16_f32 v202, v216, v217
v_cvt_pk_bf16_f32 v203, v218, v219
v_pk_add_f32 v[204:205], v[204:205], v[76:77]
v_pk_add_f32 v[206:207], v[206:207], v[78:79]
s_waitcnt lgkmcnt(0)
v_pk_add_f32 v[220:221], v[220:221], v[92:93]
v_pk_add_f32 v[222:223], v[222:223], v[94:95]
M v[24:27], a[112:115], v[200:203], v[24:27]
buffer_store_dwordx4 v[200:203], v1, s[16:19], s37 offen offset:1024 sc1
v_pk_mul_f32 v[204:205], v[204:205], v[10:11] op_sel:[0,1] op_sel_hi:[1,1]
v_pk_mul_f32 v[206:207], v[206:207], v[10:11] op_sel:[0,1] op_sel_hi:[1,1]
v_pk_mul_f32 v[220:221], v[220:221], v[10:11] op_sel:[0,1] op_sel_hi:[1,1]
v_pk_mul_f32 v[222:223], v[222:223], v[10:11] op_sel:[0,1] op_sel_hi:[1,1]
v_cvt_pk_bf16_f32 v204, v204, v205
v_cvt_pk_bf16_f32 v205, v206, v207
v_cvt_pk_bf16_f32 v206, v220, v221
v_cvt_pk_bf16_f32 v207, v222, v223
s_nop 1
M v[24:27], a[112:115], v[204:207], v[24:27]
buffer_store_dwordx4 v[204:207], v1, s[16:19], s37 offen offset:3072 sc1
v_cmp_lt_u32 vcc, 0x3c000000, v12
s_nop 5
v_cmp_class_f32 s[40:41], v24, s64
s_nop 0
s_or_b64 vcc, vcc, s[40:41]
s_cmp_lg_u64 vcc, 0
s_cselect_b32 s33, 2, 0
s_or_b32 s60, s60, s33
s_branch Lk2_chk
Lk2_mg1:
ds_write_b128 v2, v[160:163] offset:0
ds_write_b128 v2, v[164:167] offset:1024
ds_write_b128 v2, v[168:171] offset:2048
ds_write_b128 v2, v[172:175] offset:3072
ds_write_b128 v2, v[176:179] offset:4096
ds_write_b128 v2, v[180:183] offset:5120
ds_write_b128 v2, v[184:187] offset:6144
ds_write_b128 v2, v[188:191] offset:7168
ds_write_b128 v2, v[192:195] offset:8192
ds_write_b128 v2, v[196:199] offset:9216
ds_write_b128 v2, v[200:203] offset:10240
ds_write_b128 v2, v[204:207] offset:11264
ds_write_b128 v2, v[208:211] offset:12288
ds_write_b128 v2, v[212:215] offset:13312
ds_write_b128 v2, v[216:219] offset:14336
ds_write_b128 v2, v[220:223] offset:15360
s_waitcnt lgkmcnt(0)
s_barrier
ds_read_b128 v[28:31], v15
ds_read_b128 v[32:35], v3 offset:0
ds_read_b128 v[36:39], v3 offset:1024
ds_read_b128 v[40:43], v3 offset:2048
ds_read_b128 v[44:47], v3 offset:3072
ds_read_b128 v[48:51], v3 offset:4096
ds_read_b128 v[52:55], v3 offset:5120
ds_read_b128 v[56:59], v3 offset:6144
ds_read_b128 v[60:63], v3 offset:7168
ds_read_b128 v[64:67], v3 offset:8192
ds_read_b128 v[68:71], v3 offset:9216
ds_read_b128 v[72:75], v3 offset:10240
ds_read_b128 v[76:79], v3 offset:11264
ds_read_b128 v[80:83], v3 offset:12288
ds_read_b128 v[84:87], v3 offset:13312
ds_read_b128 v[88:91], v3 offset:14336
ds_read_b128 v[92:95], v3 offset:15360
s_waitcnt lgkmcnt(15)
v_add_f32 v20, v20, v28
v_add_f32 v21, v21, v29
v_add_f32 v22, v22, v30
v_add_f32 v23, v23, v31
s_sub_u32 s35, 15, s21
v_rcp_f32 v8, v20
v_rcp_f32 v9, v21
v_rcp_f32 v10, v22
v_rcp_f32 v11, v23
v_subrev_u32 v20, 0x21800000, v20
v_subrev_u32 v21, 0x21800000, v21
v_subrev_u32 v22, 0x21800000, v22
v_subrev_u32 v23, 0x21800000, v23
v_max_u32 v12, v20, v21
v_max3_u32 v12, v12, v22, v23
s_mov_b32 s64, 0x207
s_lshl_b32 s33, s35, 20
s_lshl_b32 s34, s20, 15
s_add_u32 s33, s33, s34
s_lshl_b32 s34, s23, 13
s_add_u32 s36, s33, s34
s_add_u32 s37, s36, 4096
s_add_u32 s38, s36, 16384
s_add_u32 s39, s36, 20480
v_pk_add_f32 v[224:225], v[224:225], v[32:33]
v_pk_add_f32 v[226:227], v[226:227], v[34:35]
s_waitcnt lgkmcnt(11)
v_pk_add_f32 v[240:241], v[240:241], v[48:49]
v_pk_add_f32 v[242:243], v[242:243], v[50:51]
v_pk_mul_f32 v[224:225], v[224:225], v[8:9] op_sel:[0,0] op_sel_hi:[1,0]
v_pk_mul_f32 v[226:227], v[226:227], v[8:9] op_sel:[0,0] op_sel_hi:[1,0]
v_pk_mul_f32 v[240:241], v[240:241], v[8:9] op_sel:[0,0] op_sel_hi:[1,0]
v_pk_mul_f32 v[242:243], v[242:243], v[8:9] op_sel:[0,0] op_sel_hi:[1,0]
v_cvt_pk_bf16_f32 v224, v224, v225
v_cvt_pk_bf16_f32 v225, v226, v227
v_cvt_pk_bf16_f32 v226, v240, v241
v_cvt_pk_bf16_f32 v227, v242, v243
v_pk_add_f32 v[228:229], v[228:229], v[36:37]
v_pk_add_f32 v[230:231], v[230:231], v[38:39]
s_waitcnt lgkmcnt(10)
v_pk_add_f32 v[244:245], v[244:245], v[52:53]
v_pk_add_f32 v[246:247], v[246:247], v[54:55]
M v[24:27], a[112:115], v[224:227], 0
buffer_store_dwordx4 v[224:227], v1, s[16:19], s38 offen offset:0 sc1
v_pk_mul_f32 v[228:229], v[228:229], v[8:9] op_sel:[0,1] op_sel_hi:[1,1]
v_pk_mul_f32 v[230:231], v[230:231], v[8:9] op_sel:[0,1] op_sel_hi:[1,1]
v_pk_mul_f32 v[244:245], v[244:245], v[8:9] op_sel:[0,1] op_sel_hi:[1,1]
v_pk_mul_f32 v[246:247], v[246:247], v[8:9] op_sel:[0,1] op_sel_hi:[1,1]
v_cvt_pk_bf16_f32 v228, v228, v229
v_cvt_pk_bf16_f32 v229, v230, v231
v_cvt_pk_bf16_f32 v230, v244, v245
v_cvt_pk_bf16_f32 v231, v246, v247
v_pk_add_f32 v[232:233], v[232:233], v[40:41]
v_pk_add_f32 v[234:235], v[234:235], v[42:43]
s_waitcnt lgkmcnt(9)
v_pk_add_f32 v[248:249], v[248:249], v[56:57]
v_pk_add_f32 v[250:251], v[250:251], v[58:59]
M v[24:27], a[112:115], v[228:231], v[24:27]
buffer_store_dwordx4 v[228:231], v1, s[16:19], s38 offen offset:2048 sc1
v_pk_mul_f32 v[232:233], v[232:233], v[10:11] op_sel:[0,0] op_sel_hi:[1,0]
v_pk_mul_f32 v[234:235], v[234:235], v[10:11] op_sel:[0,0] op_sel_hi:[1,0]
v_pk_mul_f32 v[248:249], v[248:249], v[10:11] op_sel:[0,0] op_sel_hi:[1,0]
v_pk_mul_f32 v[250:251], v[250:251], v[10:11] op_sel:[0,0] op_sel_hi:[1,0]
v_cvt_pk_bf16_f32 v232, v232, v233
v_cvt_pk_bf16_f32 v233, v234, v235
v_cvt_pk_bf16_f32 v234, v248, v249
v_cvt_pk_bf16_f32 v235, v250, v251
v_pk_add_f32 v[236:237], v[236:237], v[44:45]
v_pk_add_f32 v[238:239], v[238:239], v[46:47]
s_waitcnt lgkmcnt(8)
v_pk_add_f32 v[252:253], v[252:253], v[60:61]
v_pk_add_f32 v[254:255], v[254:255], v[62:63]
M v[24:27], a[112:115], v[232:235], v[24:27]
buffer_store_dwordx4 v[232:235], v1, s[16:19], s39 offen offset:0 sc1
v_pk_mul_f32 v[236:237], v[236:237], v[10:11] op_sel:[0,1] op_sel_hi:[1,1]
v_pk_mul_f32 v[238:239], v[238:239], v[10:11] op_sel:[0,1] op_sel_hi:[1,1]
v_pk_mul_f32 v[252:253], v[252:253], v[10:11] op_sel:[0,1] op_sel_hi:[1,1]
v_pk_mul_f32 v[254:255], v[254:255], v[10:11] op_sel:[0,1] op_sel_hi:[1,1]
v_cvt_pk_bf16_f32 v236, v236, v237
v_cvt_pk_bf16_f32 v237, v238, v239
v_cvt_pk_bf16_f32 v238, v252, v253
v_cvt_pk_bf16_f32 v239, v254, v255
v_accvgpr_read_b32 v32, a64
v_accvgpr_read_b32 v33, a65
v_accvgpr_read_b32 v34, a66
v_accvgpr_read_b32 v35, a67
s_waitcnt lgkmcnt(7)
v_pk_add_f32 v[32:33], v[32:33], v[64:65]
v_pk_add_f32 v[34:35], v[34:35], v[66:67]
v_accvgpr_read_b32 v48, a80
v_accvgpr_read_b32 v49, a81
v_accvgpr_read_b32 v50, a82
v_accvgpr_read_b32 v51, a83
s_waitcnt lgkmcnt(3)
v_pk_add_f32 v[48:49], v[48:49], v[80:81]
v_pk_add_f32 v[50:51], v[50:51], v[82:83]
M v[24:27], a[112:115], v[236:239], v[24:27]
buffer_store_dwordx4 v[236:239], v1, s[16:19], s39 offen offset:2048 sc1
v_pk_mul_f32 v[32:33], v[32:33], v[8:9] op_sel:[0,0] op_sel_hi:[1,0]
v_pk_mul_f32 v[34:35], v[34:35], v[8:9] op_sel:[0,0] op_sel_hi:[1,0]
v_pk_mul_f32 v[48:49], v[48:49], v[8:9] op_sel:[0,0] op_sel_hi:[1,0]
v_pk_mul_f32 v[50:51], v[50:51], v[8:9] op_sel:[0,0] op_sel_hi:[1,0]
v_cvt_pk_bf16_f32 v32, v32, v33
v_cvt_pk_bf16_f32 v33, v34, v35
v_cvt_pk_bf16_f32 v34, v48, v49
v_cvt_pk_bf16_f32 v35, v50, v51
v_accvgpr_read_b32 v240, a68
v_accvgpr_read_b32 v241, a69
v_accvgpr_read_b32 v242, a70
v_accvgpr_read_b32 v243, a71
v_pk_add_f32 v[240:241], v[240:241], v[68:69]
v_pk_add_f32 v[242:243], v[242:243], v[70:71]
v_accvgpr_read_b32 v36, a84
v_accvgpr_read_b32 v37, a85
v_accvgpr_read_b32 v38, a86
v_accvgpr_read_b32 v39, a87
s_waitcnt lgkmcnt(2)
v_pk_add_f32 v[36:37], v[36:37], v[84:85]
v_pk_add_f32 v[38:39], v[38:39], v[86:87]
M v[24:27], a[112:115], v[32:35], v[24:27]
buffer_store_dwordx4 v[32:35], v1, s[16:19], s38 offen offset:1024 sc1
v_pk_mul_f32 v[240:241], v[240:241], v[8:9] op_sel:[0,1] op_sel_hi:[1,1]
v_pk_mul_f32 v[242:243], v[242:243], v[8:9] op_sel:[0,1] op_sel_hi:[1,1]
v_pk_mul_f32 v[36:37], v[36:37], v[8:9] op_sel:[0,1] op_sel_hi:[1,1]
v_pk_mul_f32 v[38:39], v[38:39], v[8:9] op_sel:[0,1] op_sel_hi:[1,1]
v_cvt_pk_bf16_f32 v240, v240, v241
v_cvt_pk_bf16_f32 v241, v242, v243
v_cvt_pk_bf16_f32 v242, v36, v37
v_cvt_pk_bf16_f32 v243, v38, v39
v_accvgpr_read_b32 v52, a72
v_accvgpr_read_b32 v53, a73
v_accvgpr_read_b32 v54, a74
v_accvgpr_read_b32 v55, a75
v_pk_add_f32 v[52:53], v[52:53], v[72:73]
v_pk_add_f32 v[54:55], v[54:55], v[74:75]
v_accvgpr_read_b32 v244, a88
v_accvgpr_read_b32 v245, a89
v_accvgpr_read_b32 v246, a90
v_accvgpr_read_b32 v247, a91
s_waitcnt lgkmcnt(1)
v_pk_add_f32 v[244:245], v[244:245], v[88:89]
v_pk_add_f32 v[246:247], v[246:247], v[90:91]
M v[24:27], a[112:115], v[240:243], v[24:27]
buffer_store_dwordx4 v[240:243], v1, s[16:19], s38 offen offset:3072 sc1
v_pk_mul_f32 v[52:53], v[52:53], v[10:11] op_sel:[0,0] op_sel_hi:[1,0]
v_pk_mul_f32 v[54:55], v[54:55], v[10:11] op_sel:[0,0] op_sel_hi:[1,0]
v_pk_mul_f32 v[244:245], v[244:245], v[10:11] op_sel:[0,0] op_sel_hi:[1,0]
v_pk_mul_f32 v[246:247], v[246:247], v[10:11] op_sel:[0,0] op_sel_hi:[1,0]
v_cvt_pk_bf16_f32 v52, v52, v53
v_cvt_pk_bf16_f32 v53, v54, v55
v_cvt_pk_bf16_f32 v54, v244, v245
v_cvt_pk_bf16_f32 v55, v246, v247
v_accvgpr_read_b32 v40, a76
v_accvgpr_read_b32 v41, a77
v_accvgpr_read_b32 v42, a78
v_accvgpr_read_b32 v43, a79
v_pk_add_f32 v[40:41], v[40:41], v[76:77]
v_pk_add_f32 v[42:43], v[42:43], v[78:79]
v_accvgpr_read_b32 v56, a92
v_accvgpr_read_b32 v57, a93
v_accvgpr_read_b32 v58, a94
v_accvgpr_read_b32 v59, a95
s_waitcnt lgkmcnt(0)
v_pk_add_f32 v[56:57], v[56:57], v[92:93]
v_pk_add_f32 v[58:59], v[58:59], v[94:95]
M v[24:27], a[112:115], v[52:55], v[24:27]
buffer_store_dwordx4 v[52:55], v1, s[16:19], s39 offen offset:1024 sc1
v_pk_mul_f32 v[40:41], v[40:41], v[10:11] op_sel:[0,1] op_sel_hi:[1,1]
v_pk_mul_f32 v[42:43], v[42:43], v[10:11] op_sel:[0,1] op_sel_hi:[1,1]
v_pk_mul_f32 v[56:57], v[56:57], v[10:11] op_sel:[0,1] op_sel_hi:[1,1]
v_pk_mul_f32 v[58:59], v[58:59], v[10:11] op_sel:[0,1] op_sel_hi:[1,1]
v_cvt_pk_bf16_f32 v40, v40, v41
v_cvt_pk_bf16_f32 v41, v42, v43
v_cvt_pk_bf16_f32 v42, v56, v57
v_cvt_pk_bf16_f32 v43, v58, v59
s_nop 1
M v[24:27], a[112:115], v[40:43], v[24:27]
buffer_store_dwordx4 v[40:43], v1, s[16:19], s39 offen offset:3072 sc1
v_cmp_lt_u32 vcc, 0x3c000000, v12
s_nop 5
v_cmp_class_f32 s[40:41], v24, s64
s_nop 0
s_or_b64 vcc, vcc, s[40:41]
s_cmp_lg_u64 vcc, 0
s_cselect_b32 s33, 2, 0
s_or_b32 s60, s60, s33
Lk2_chk:
s_cmp_eq_u32 s60, 0
s_cbranch_scc1 Lk2_done
s_sub_u32 s56, 15, s21
s_lshl_b32 s33, s24, 1
s_lshl_b32 s61, 3, s33
s_and_b32 s34, s60, 2
s_bitcmp1_b32 s60, 0
s_cselect_b32 s56, s21, s56
s_cselect_b32 s61, 15, s61
s_cselect_b32 s60, s34, 0
s_waitcnt vmcnt(0)
s_lshl_b32 s33, s20, 7
s_lshl_b32 s34, s56, 3
s_add_u32 s33, s33, s34
s_lshl_b32 s34, s23, 2
s_add_u32 s33, s33, s34
s_lshl_b32 s33, s33, 12
buffer_load_dwordx4 a[0:3], v1, s[8:11], s33 offen offset:0 sc1
buffer_load_dwordx4 a[4:7], v1, s[8:11], s33 offen offset:1024 sc1
buffer_load_dwordx4 a[8:11], v1, s[8:11], s33 offen offset:2048 sc1
buffer_load_dwordx4 a[12:15], v1, s[8:11], s33 offen offset:3072 sc1
s_add_u32 s33, s33, 4096
buffer_load_dwordx4 a[16:19], v1, s[8:11], s33 offen offset:0 sc1
buffer_load_dwordx4 a[20:23], v1, s[8:11], s33 offen offset:1024 sc1
buffer_load_dwordx4 a[24:27], v1, s[8:11], s33 offen offset:2048 sc1
buffer_load_dwordx4 a[28:31], v1, s[8:11], s33 offen offset:3072 sc1
s_add_u32 s33, s33, 4096
buffer_load_dwordx4 a[32:35], v1, s[8:11], s33 offen offset:0 sc1
buffer_load_dwordx4 a[36:39], v1, s[8:11], s33 offen offset:1024 sc1
buffer_load_dwordx4 a[40:43], v1, s[8:11], s33 offen offset:2048 sc1
buffer_load_dwordx4 a[44:47], v1, s[8:11], s33 offen offset:3072 sc1
s_add_u32 s33, s33, 4096
buffer_load_dwordx4 a[48:51], v1, s[8:11], s33 offen offset:0 sc1
buffer_load_dwordx4 a[52:55], v1, s[8:11], s33 offen offset:1024 sc1
buffer_load_dwordx4 a[56:59], v1, s[8:11], s33 offen offset:2048 sc1
buffer_load_dwordx4 a[60:63], v1, s[8:11], s33 offen offset:3072 sc1
v_accvgpr_write_b32 a64, 0
v_accvgpr_write_b32 a65, 0
v_accvgpr_write_b32 a66, 0
v_accvgpr_write_b32 a67, 0
v_accvgpr_write_b32 a68, 0
v_accvgpr_write_b32 a69, 0
v_accvgpr_write_b32 a70, 0
v_accvgpr_write_b32 a71, 0
v_accvgpr_write_b32 a72, 0
v_accvgpr_write_b32 a73, 0
v_accvgpr_write_b32 a74, 0
v_accvgpr_write_b32 a75, 0
v_accvgpr_write_b32 a76, 0
v_accvgpr_write_b32 a77, 0
v_accvgpr_write_b32 a78, 0
v_accvgpr_write_b32 a79, 0
v_accvgpr_write_b32 a80, 0
v_accvgpr_write_b32 a81, 0
v_accvgpr_write_b32 a82, 0
v_accvgpr_write_b32 a83, 0
v_accvgpr_write_b32 a84, 0
v_accvgpr_write_b32 a85, 0
v_accvgpr_write_b32 a86, 0
v_accvgpr_write_b32 a87, 0
v_accvgpr_write_b32 a88, 0
v_accvgpr_write_b32 a89, 0
v_accvgpr_write_b32 a90, 0
v_accvgpr_write_b32 a91, 0
v_accvgpr_write_b32 a92, 0
v_accvgpr_write_b32 a93, 0
v_accvgpr_write_b32 a94, 0
v_accvgpr_write_b32 a95, 0
v_accvgpr_write_b32 a96, 0
v_accvgpr_write_b32 a97, 0
v_accvgpr_write_b32 a98, 0
v_accvgpr_write_b32 a99, 0
v_accvgpr_write_b32 a100, 0
v_accvgpr_write_b32 a101, 0
v_accvgpr_write_b32 a102, 0
v_accvgpr_write_b32 a103, 0
v_accvgpr_write_b32 a104, 0
v_accvgpr_write_b32 a105, 0
v_accvgpr_write_b32 a106, 0
v_accvgpr_write_b32 a107, 0
v_accvgpr_write_b32 a108, 0
v_accvgpr_write_b32 a109, 0
v_accvgpr_write_b32 a110, 0
v_accvgpr_write_b32 a111, 0
v_mov_b32 v160, 0
v_mov_b32 v161, 0
v_mov_b32 v162, 0
v_mov_b32 v163, 0
v_mov_b32 v164, 0
v_mov_b32 v165, 0
v_mov_b32 v166, 0
v_mov_b32 v167, 0
v_mov_b32 v168, 0
v_mov_b32 v169, 0
v_mov_b32 v170, 0
v_mov_b32 v171, 0
v_mov_b32 v172, 0
v_mov_b32 v173, 0
v_mov_b32 v174, 0
v_mov_b32 v175, 0
v_mov_b32 v176, 0
v_mov_b32 v177, 0
v_mov_b32 v178, 0
v_mov_b32 v179, 0
v_mov_b32 v180, 0
v_mov_b32 v181, 0
v_mov_b32 v182, 0
v_mov_b32 v183, 0
v_mov_b32 v184, 0
v_mov_b32 v185, 0
v_mov_b32 v186, 0
v_mov_b32 v187, 0
v_mov_b32 v188, 0
v_mov_b32 v189, 0
v_mov_b32 v190, 0
v_mov_b32 v191, 0
v_mov_b32 v192, 0
v_mov_b32 v193, 0
v_mov_b32 v194, 0
v_mov_b32 v195, 0
v_mov_b32 v196, 0
v_mov_b32 v197, 0
v_mov_b32 v198, 0
v_mov_b32 v199, 0
v_mov_b32 v200, 0
v_mov_b32 v201, 0
v_mov_b32 v202, 0
v_mov_b32 v203, 0
v_mov_b32 v204, 0
v_mov_b32 v205, 0
v_mov_b32 v206, 0
v_mov_b32 v207, 0
v_mov_b32 v208, 0
v_mov_b32 v209, 0
v_mov_b32 v210, 0
v_mov_b32 v211, 0
v_mov_b32 v212, 0
v_mov_b32 v213, 0
v_mov_b32 v214, 0
v_mov_b32 v215, 0
v_mov_b32 v216, 0
v_mov_b32 v217, 0
v_mov_b32 v218, 0
v_mov_b32 v219, 0
v_mov_b32 v220, 0
v_mov_b32 v221, 0
v_mov_b32 v222, 0
v_mov_b32 v223, 0
v_mov_b32 v224, 0
v_mov_b32 v225, 0
v_mov_b32 v226, 0
v_mov_b32 v227, 0
v_mov_b32 v228, 0
v_mov_b32 v229, 0
v_mov_b32 v230, 0
v_mov_b32 v231, 0
v_mov_b32 v232, 0
v_mov_b32 v233, 0
v_mov_b32 v234, 0
v_mov_b32 v235, 0
v_mov_b32 v236, 0
v_mov_b32 v237, 0
v_mov_b32 v238, 0
v_mov_b32 v239, 0
v_mov_b32 v240, 0
v_mov_b32 v241, 0
v_mov_b32 v242, 0
v_mov_b32 v243, 0
v_mov_b32 v244, 0
v_mov_b32 v245, 0
v_mov_b32 v246, 0
v_mov_b32 v247, 0
v_mov_b32 v248, 0
v_mov_b32 v249, 0
v_mov_b32 v250, 0
v_mov_b32 v251, 0
v_mov_b32 v252, 0
v_mov_b32 v253, 0
v_mov_b32 v254, 0
v_mov_b32 v255, 0
v_mov_b32 v8, v4
v_mov_b32 v9, v4
v_mov_b32 v10, v4
v_mov_b32 v11, v4
s_lshl_b32 s57, s20, 20
s_lshl_b32 s58, s56, 7
s_lshl_b32 s59, s56, 1
s_add_u32 s59, s59, 2
Lslow_2:
s_add_u32 s35, s57, 0
buffer_load_dwordx4 v[96:99], v1, s[12:15], s35 offen offset:0 sc1
buffer_load_dwordx4 v[100:103], v1, s[12:15], s35 offen offset:1024 sc1
buffer_load_dwordx4 v[104:107], v1, s[12:15], s35 offen offset:2048 sc1
buffer_load_dwordx4 v[108:111], v1, s[12:15], s35 offen offset:3072 sc1
s_add_u32 s35, s57, 4096
buffer_load_dwordx4 v[112:115], v1, s[12:15], s35 offen offset:0 sc1
buffer_load_dwordx4 v[116:119], v1, s[12:15], s35 offen offset:1024 sc1
buffer_load_dwordx4 v[120:123], v1, s[12:15], s35 offen offset:2048 sc1
buffer_load_dwordx4 v[124:127], v1, s[12:15], s35 offen offset:3072 sc1
s_add_u32 s35, s57, 8192
buffer_load_dwordx4 v[128:131], v1, s[12:15], s35 offen offset:0 sc1
buffer_load_dwordx4 v[132:135], v1, s[12:15], s35 offen offset:1024 sc1
buffer_load_dwordx4 v[136:139], v1, s[12:15], s35 offen offset:2048 sc1
buffer_load_dwordx4 v[140:143], v1, s[12:15], s35 offen offset:3072 sc1
s_add_u32 s35, s57, 12288
buffer_load_dwordx4 v[144:147], v1, s[12:15], s35 offen offset:0 sc1
buffer_load_dwordx4 v[148:151], v1, s[12:15], s35 offen offset:1024 sc1
buffer_load_dwordx4 v[152:155], v1, s[12:15], s35 offen offset:2048 sc1
buffer_load_dwordx4 v[156:159], v1, s[12:15], s35 offen offset:3072 sc1
s_lshl_b32 s33, s23, 6
s_add_i32 s33, s33, s58
s_cmp_gt_i32 s33, 0
s_cselect_b32 s34, 0, 0xf149f2ca
s_cmp_lt_i32 s33, 0
s_cselect_b32 s33, 0xf149f2ca, 0
v_mov_b32 v20, s34
v_mov_b32 v21, s34
v_mov_b32 v22, s34
v_mov_b32 v23, s34
v_mov_b32 v28, s33
v_mov_b32 v29, s33
v_mov_b32 v30, s33
v_mov_b32 v31, s33
v_med3_f32 v24, v16, v20, v28
v_med3_f32 v25, v17, v20, v28
v_med3_f32 v26, v18, v20, v28
v_med3_f32 v27, v19, v20, v28
s_waitcnt vmcnt(0)
s_nop 0
M v[32:35], v[96:99], a[0:3], v[24:27]
M v[32:35], v[100:103], a[4:7], v[32:35]
M v[32:35], v[104:107], a[8:11], v[32:35]
M v[32:35], v[108:111], a[12:15], v[32:35]
M v[36:39], v[96:99], a[16:19], v[28:31]
M v[36:39], v[100:103], a[20:23], v[36:39]
M v[36:39], v[104:107], a[24:27], v[36:39]
M v[36:39], v[108:111], a[28:31], v[36:39]
M v[40:43], v[96:99], a[32:35], v[28:31]
M v[40:43], v[100:103], a[36:39], v[40:43]
M v[40:43], v[104:107], a[40:43], v[40:43]
M v[40:43], v[108:111], a[44:47], v[40:43]
M v[44:47], v[96:99], a[48:51], v[28:31]
M v[44:47], v[100:103], a[52:55], v[44:47]
M v[44:47], v[104:107], a[56:59], v[44:47]
M v[44:47], v[108:111], a[60:63], v[44:47]
M v[48:51], v[112:115], a[0:3], v[20:23]
M v[48:51], v[116:119], a[4:7], v[48:51]
M v[48:51], v[120:123], a[8:11], v[48:51]
M v[48:51], v[124:127], a[12:15], v[48:51]
M v[52:55], v[112:115], a[16:19], v[24:27]
M v[52:55], v[116:119], a[20:23], v[52:55]
M v[52:55], v[120:123], a[24:27], v[52:55]
M v[52:55], v[124:127], a[28:31], v[52:55]
M v[56:59], v[112:115], a[32:35], v[28:31]
M v[56:59], v[116:119], a[36:39], v[56:59]
M v[56:59], v[120:123], a[40:43], v[56:59]
M v[56:59], v[124:127], a[44:47], v[56:59]
M v[60:63], v[112:115], a[48:51], v[28:31]
M v[60:63], v[116:119], a[52:55], v[60:63]
M v[60:63], v[120:123], a[56:59], v[60:63]
M v[60:63], v[124:127], a[60:63], v[60:63]
M v[64:67], v[128:131], a[0:3], v[20:23]
M v[64:67], v[132:135], a[4:7], v[64:67]
M v[64:67], v[136:139], a[8:11], v[64:67]
M v[64:67], v[140:143], a[12:15], v[64:67]
M v[68:71], v[128:131], a[16:19], v[20:23]
M v[68:71], v[132:135], a[20:23], v[68:71]
M v[68:71], v[136:139], a[24:27], v[68:71]
M v[68:71], v[140:143], a[28:31], v[68:71]
M v[72:75], v[128:131], a[32:35], v[24:27]
M v[72:75], v[132:135], a[36:39], v[72:75]
M v[72:75], v[136:139], a[40:43], v[72:75]
M v[72:75], v[140:143], a[44:47], v[72:75]
M v[76:79], v[128:131], a[48:51], v[28:31]
M v[76:79], v[132:135], a[52:55], v[76:79]
M v[76:79], v[136:139], a[56:59], v[76:79]
M v[76:79], v[140:143], a[60:63], v[76:79]
M v[80:83], v[144:147], a[0:3], v[20:23]
M v[80:83], v[148:151], a[4:7], v[80:83]
M v[80:83], v[152:155], a[8:11], v[80:83]
M v[80:83], v[156:159], a[12:15], v[80:83]
M v[84:87], v[144:147], a[16:19], v[20:23]
M v[84:87], v[148:151], a[20:23], v[84:87]
M v[84:87], v[152:155], a[24:27], v[84:87]
M v[84:87], v[156:159], a[28:31], v[84:87]
M v[88:91], v[144:147], a[32:35], v[20:23]
M v[88:91], v[148:151], a[36:39], v[88:91]
M v[88:91], v[152:155], a[40:43], v[88:91]
M v[88:91], v[156:159], a[44:47], v[88:91]
M v[92:95], v[144:147], a[48:51], v[24:27]
M v[92:95], v[148:151], a[52:55], v[92:95]
M v[92:95], v[152:155], a[56:59], v[92:95]
M v[92:95], v[156:159], a[60:63], v[92:95]
s_nop 7
s_add_u32 s35, s57, 16384
buffer_load_dwordx4 v[96:99], v1, s[12:15], s35 offen offset:0 sc1
buffer_load_dwordx4 v[100:103], v1, s[12:15], s35 offen offset:1024 sc1
buffer_load_dwordx4 v[104:107], v1, s[12:15], s35 offen offset:2048 sc1
buffer_load_dwordx4 v[108:111], v1, s[12:15], s35 offen offset:3072 sc1
s_add_u32 s35, s57, 20480
buffer_load_dwordx4 v[112:115], v1, s[12:15], s35 offen offset:0 sc1
buffer_load_dwordx4 v[116:119], v1, s[12:15], s35 offen offset:1024 sc1
buffer_load_dwordx4 v[120:123], v1, s[12:15], s35 offen offset:2048 sc1
buffer_load_dwordx4 v[124:127], v1, s[12:15], s35 offen offset:3072 sc1
s_add_u32 s35, s57, 24576
buffer_load_dwordx4 v[128:131], v1, s[12:15], s35 offen offset:0 sc1
buffer_load_dwordx4 v[132:135], v1, s[12:15], s35 offen offset:1024 sc1
buffer_load_dwordx4 v[136:139], v1, s[12:15], s35 offen offset:2048 sc1
buffer_load_dwordx4 v[140:143], v1, s[12:15], s35 offen offset:3072 sc1
s_add_u32 s35, s57, 28672
buffer_load_dwordx4 v[144:147], v1, s[12:15], s35 offen offset:0 sc1
buffer_load_dwordx4 v[148:151], v1, s[12:15], s35 offen offset:1024 sc1
buffer_load_dwordx4 v[152:155], v1, s[12:15], s35 offen offset:2048 sc1
buffer_load_dwordx4 v[156:159], v1, s[12:15], s35 offen offset:3072 sc1
v_max3_f32 v13, v32, v33, v8
v_max3_f32 v13, v13, v34, v35
v_max3_f32 v13, v13, v48, v49
v_max3_f32 v13, v13, v50, v51
v_max3_f32 v13, v13, v64, v65
v_max3_f32 v13, v13, v66, v67
v_max3_f32 v13, v13, v80, v81
v_max3_f32 v13, v13, v82, v83
v_mov_b32 v14, v13
s_nop 1
v_permlane16_swap_b32 v13, v14
v_max_f32 v13, v13, v14
v_mov_b32 v14, v13
s_nop 1
v_permlane32_swap_b32 v13, v14
v_max_f32 v13, v13, v14
v_sub_f32 v12, v8, v13
v_exp_f32 v12, v12
v_mov_b32 v8, v13
v_sub_f32 v32, v32, v13
v_sub_f32 v33, v33, v13
v_sub_f32 v34, v34, v13
v_sub_f32 v35, v35, v13
v_sub_f32 v48, v48, v13
v_sub_f32 v49, v49, v13
v_sub_f32 v50, v50, v13
v_sub_f32 v51, v51, v13
v_sub_f32 v64, v64, v13
v_sub_f32 v65, v65, v13
v_sub_f32 v66, v66, v13
v_sub_f32 v67, v67, v13
v_sub_f32 v80, v80, v13
v_sub_f32 v81, v81, v13
v_sub_f32 v82, v82, v13
v_sub_f32 v83, v83, v13
v_mul_f32 v160, v160, v12
v_mul_f32 v161, v161, v12
v_mul_f32 v162, v162, v12
v_mul_f32 v163, v163, v12
v_mul_f32 v176, v176, v12
v_mul_f32 v177, v177, v12
v_mul_f32 v178, v178, v12
v_mul_f32 v179, v179, v12
v_mul_f32 v192, v192, v12
v_mul_f32 v193, v193, v12
v_mul_f32 v194, v194, v12
v_mul_f32 v195, v195, v12
v_mul_f32 v208, v208, v12
v_mul_f32 v209, v209, v12
v_mul_f32 v210, v210, v12
v_mul_f32 v211, v211, v12
v_mul_f32 v224, v224, v12
v_mul_f32 v225, v225, v12
v_mul_f32 v226, v226, v12
v_mul_f32 v227, v227, v12
v_mul_f32 v240, v240, v12
v_mul_f32 v241, v241, v12
v_mul_f32 v242, v242, v12
v_mul_f32 v243, v243, v12
v_accvgpr_read_b32 v14, a64
v_mul_f32 v14, v14, v12
v_accvgpr_write_b32 a64, v14
v_accvgpr_read_b32 v14, a65
v_mul_f32 v14, v14, v12
v_accvgpr_write_b32 a65, v14
v_accvgpr_read_b32 v14, a66
v_mul_f32 v14, v14, v12
v_accvgpr_write_b32 a66, v14
v_accvgpr_read_b32 v14, a67
v_mul_f32 v14, v14, v12
v_accvgpr_write_b32 a67, v14
v_accvgpr_read_b32 v14, a80
v_mul_f32 v14, v14, v12
v_accvgpr_write_b32 a80, v14
v_accvgpr_read_b32 v14, a81
v_mul_f32 v14, v14, v12
v_accvgpr_write_b32 a81, v14
v_accvgpr_read_b32 v14, a82
v_mul_f32 v14, v14, v12
v_accvgpr_write_b32 a82, v14
v_accvgpr_read_b32 v14, a83
v_mul_f32 v14, v14, v12
v_accvgpr_write_b32 a83, v14
v_accvgpr_read_b32 v14, a96
v_mul_f32 v14, v14, v12
v_accvgpr_write_b32 a96, v14
v_accvgpr_read_b32 v14, a97
v_mul_f32 v14, v14, v12
v_accvgpr_write_b32 a97, v14
v_accvgpr_read_b32 v14, a98
v_mul_f32 v14, v14, v12
v_accvgpr_write_b32 a98, v14
v_accvgpr_read_b32 v14, a99
v_mul_f32 v14, v14, v12
v_accvgpr_write_b32 a99, v14
v_max3_f32 v13, v36, v37, v9
v_max3_f32 v13, v13, v38, v39
v_max3_f32 v13, v13, v52, v53
v_max3_f32 v13, v13, v54, v55
v_max3_f32 v13, v13, v68, v69
v_max3_f32 v13, v13, v70, v71
v_max3_f32 v13, v13, v84, v85
v_max3_f32 v13, v13, v86, v87
v_mov_b32 v14, v13
s_nop 1
v_permlane16_swap_b32 v13, v14
v_max_f32 v13, v13, v14
v_mov_b32 v14, v13
s_nop 1
v_permlane32_swap_b32 v13, v14
v_max_f32 v13, v13, v14
v_sub_f32 v12, v9, v13
v_exp_f32 v12, v12
v_mov_b32 v9, v13
v_sub_f32 v36, v36, v13
v_sub_f32 v37, v37, v13
v_sub_f32 v38, v38, v13
v_sub_f32 v39, v39, v13
v_sub_f32 v52, v52, v13
v_sub_f32 v53, v53, v13
v_sub_f32 v54, v54, v13
v_sub_f32 v55, v55, v13
v_sub_f32 v68, v68, v13
v_sub_f32 v69, v69, v13
v_sub_f32 v70, v70, v13
v_sub_f32 v71, v71, v13
v_sub_f32 v84, v84, v13
v_sub_f32 v85, v85, v13
v_sub_f32 v86, v86, v13
v_sub_f32 v87, v87, v13
v_mul_f32 v164, v164, v12
v_mul_f32 v165, v165, v12
v_mul_f32 v166, v166, v12
v_mul_f32 v167, v167, v12
v_mul_f32 v180, v180, v12
v_mul_f32 v181, v181, v12
v_mul_f32 v182, v182, v12
v_mul_f32 v183, v183, v12
v_mul_f32 v196, v196, v12
v_mul_f32 v197, v197, v12
v_mul_f32 v198, v198, v12
v_mul_f32 v199, v199, v12
v_mul_f32 v212, v212, v12
v_mul_f32 v213, v213, v12
v_mul_f32 v214, v214, v12
v_mul_f32 v215, v215, v12
v_mul_f32 v228, v228, v12
v_mul_f32 v229, v229, v12
v_mul_f32 v230, v230, v12
v_mul_f32 v231, v231, v12
v_mul_f32 v244, v244, v12
v_mul_f32 v245, v245, v12
v_mul_f32 v246, v246, v12
v_mul_f32 v247, v247, v12
v_accvgpr_read_b32 v14, a68
v_mul_f32 v14, v14, v12
v_accvgpr_write_b32 a68, v14
v_accvgpr_read_b32 v14, a69
v_mul_f32 v14, v14, v12
v_accvgpr_write_b32 a69, v14
v_accvgpr_read_b32 v14, a70
v_mul_f32 v14, v14, v12
v_accvgpr_write_b32 a70, v14
v_accvgpr_read_b32 v14, a71
v_mul_f32 v14, v14, v12
v_accvgpr_write_b32 a71, v14
v_accvgpr_read_b32 v14, a84
v_mul_f32 v14, v14, v12
v_accvgpr_write_b32 a84, v14
v_accvgpr_read_b32 v14, a85
v_mul_f32 v14, v14, v12
v_accvgpr_write_b32 a85, v14
v_accvgpr_read_b32 v14, a86
v_mul_f32 v14, v14, v12
v_accvgpr_write_b32 a86, v14
v_accvgpr_read_b32 v14, a87
v_mul_f32 v14, v14, v12
v_accvgpr_write_b32 a87, v14
v_accvgpr_read_b32 v14, a100
v_mul_f32 v14, v14, v12
v_accvgpr_write_b32 a100, v14
v_accvgpr_read_b32 v14, a101
v_mul_f32 v14, v14, v12
v_accvgpr_write_b32 a101, v14
v_accvgpr_read_b32 v14, a102
v_mul_f32 v14, v14, v12
v_accvgpr_write_b32 a102, v14
v_accvgpr_read_b32 v14, a103
v_mul_f32 v14, v14, v12
v_accvgpr_write_b32 a103, v14
v_max3_f32 v13, v40, v41, v10
v_max3_f32 v13, v13, v42, v43
v_max3_f32 v13, v13, v56, v57
v_max3_f32 v13, v13, v58, v59
v_max3_f32 v13, v13, v72, v73
v_max3_f32 v13, v13, v74, v75
v_max3_f32 v13, v13, v88, v89
v_max3_f32 v13, v13, v90, v91
v_mov_b32 v14, v13
s_nop 1
v_permlane16_swap_b32 v13, v14
v_max_f32 v13, v13, v14
v_mov_b32 v14, v13
s_nop 1
v_permlane32_swap_b32 v13, v14
v_max_f32 v13, v13, v14
v_sub_f32 v12, v10, v13
v_exp_f32 v12, v12
v_mov_b32 v10, v13
v_sub_f32 v40, v40, v13
v_sub_f32 v41, v41, v13
v_sub_f32 v42, v42, v13
v_sub_f32 v43, v43, v13
v_sub_f32 v56, v56, v13
v_sub_f32 v57, v57, v13
v_sub_f32 v58, v58, v13
v_sub_f32 v59, v59, v13
v_sub_f32 v72, v72, v13
v_sub_f32 v73, v73, v13
v_sub_f32 v74, v74, v13
v_sub_f32 v75, v75, v13
v_sub_f32 v88, v88, v13
v_sub_f32 v89, v89, v13
v_sub_f32 v90, v90, v13
v_sub_f32 v91, v91, v13
v_mul_f32 v168, v168, v12
v_mul_f32 v169, v169, v12
v_mul_f32 v170, v170, v12
v_mul_f32 v171, v171, v12
v_mul_f32 v184, v184, v12
v_mul_f32 v185, v185, v12
v_mul_f32 v186, v186, v12
v_mul_f32 v187, v187, v12
v_mul_f32 v200, v200, v12
v_mul_f32 v201, v201, v12
v_mul_f32 v202, v202, v12
v_mul_f32 v203, v203, v12
v_mul_f32 v216, v216, v12
v_mul_f32 v217, v217, v12
v_mul_f32 v218, v218, v12
v_mul_f32 v219, v219, v12
v_mul_f32 v232, v232, v12
v_mul_f32 v233, v233, v12
v_mul_f32 v234, v234, v12
v_mul_f32 v235, v235, v12
v_mul_f32 v248, v248, v12
v_mul_f32 v249, v249, v12
v_mul_f32 v250, v250, v12
v_mul_f32 v251, v251, v12
v_accvgpr_read_b32 v14, a72
v_mul_f32 v14, v14, v12
v_accvgpr_write_b32 a72, v14
v_accvgpr_read_b32 v14, a73
v_mul_f32 v14, v14, v12
v_accvgpr_write_b32 a73, v14
v_accvgpr_read_b32 v14, a74
v_mul_f32 v14, v14, v12
v_accvgpr_write_b32 a74, v14
v_accvgpr_read_b32 v14, a75
v_mul_f32 v14, v14, v12
v_accvgpr_write_b32 a75, v14
v_accvgpr_read_b32 v14, a88
v_mul_f32 v14, v14, v12
v_accvgpr_write_b32 a88, v14
v_accvgpr_read_b32 v14, a89
v_mul_f32 v14, v14, v12
v_accvgpr_write_b32 a89, v14
v_accvgpr_read_b32 v14, a90
v_mul_f32 v14, v14, v12
v_accvgpr_write_b32 a90, v14
v_accvgpr_read_b32 v14, a91
v_mul_f32 v14, v14, v12
v_accvgpr_write_b32 a91, v14
v_accvgpr_read_b32 v14, a104
v_mul_f32 v14, v14, v12
v_accvgpr_write_b32 a104, v14
v_accvgpr_read_b32 v14, a105
v_mul_f32 v14, v14, v12
v_accvgpr_write_b32 a105, v14
v_accvgpr_read_b32 v14, a106
v_mul_f32 v14, v14, v12
v_accvgpr_write_b32 a106, v14
v_accvgpr_read_b32 v14, a107
v_mul_f32 v14, v14, v12
v_accvgpr_write_b32 a107, v14
v_max3_f32 v13, v44, v45, v11
v_max3_f32 v13, v13, v46, v47
v_max3_f32 v13, v13, v60, v61
v_max3_f32 v13, v13, v62, v63
v_max3_f32 v13, v13, v76, v77
v_max3_f32 v13, v13, v78, v79
v_max3_f32 v13, v13, v92, v93
v_max3_f32 v13, v13, v94, v95
v_mov_b32 v14, v13
s_nop 1
v_permlane16_swap_b32 v13, v14
v_max_f32 v13, v13, v14
v_mov_b32 v14, v13
s_nop 1
v_permlane32_swap_b32 v13, v14
v_max_f32 v13, v13, v14
v_sub_f32 v12, v11, v13
v_exp_f32 v12, v12
v_mov_b32 v11, v13
v_sub_f32 v44, v44, v13
v_sub_f32 v45, v45, v13
v_sub_f32 v46, v46, v13
v_sub_f32 v47, v47, v13
v_sub_f32 v60, v60, v13
v_sub_f32 v61, v61, v13
v_sub_f32 v62, v62, v13
v_sub_f32 v63, v63, v13
v_sub_f32 v76, v76, v13
v_sub_f32 v77, v77, v13
v_sub_f32 v78, v78, v13
v_sub_f32 v79, v79, v13
v_sub_f32 v92, v92, v13
v_sub_f32 v93, v93, v13
v_sub_f32 v94, v94, v13
v_sub_f32 v95, v95, v13
v_mul_f32 v172, v172, v12
v_mul_f32 v173, v173, v12
v_mul_f32 v174, v174, v12
v_mul_f32 v175, v175, v12
v_mul_f32 v188, v188, v12
v_mul_f32 v189, v189, v12
v_mul_f32 v190, v190, v12
v_mul_f32 v191, v191, v12
v_mul_f32 v204, v204, v12
v_mul_f32 v205, v205, v12
v_mul_f32 v206, v206, v12
v_mul_f32 v207, v207, v12
v_mul_f32 v220, v220, v12
v_mul_f32 v221, v221, v12
v_mul_f32 v222, v222, v12
v_mul_f32 v223, v223, v12
v_mul_f32 v236, v236, v12
v_mul_f32 v237, v237, v12
v_mul_f32 v238, v238, v12
v_mul_f32 v239, v239, v12
v_mul_f32 v252, v252, v12
v_mul_f32 v253, v253, v12
v_mul_f32 v254, v254, v12
v_mul_f32 v255, v255, v12
v_accvgpr_read_b32 v14, a76
v_mul_f32 v14, v14, v12
v_accvgpr_write_b32 a76, v14
v_accvgpr_read_b32 v14, a77
v_mul_f32 v14, v14, v12
v_accvgpr_write_b32 a77, v14
v_accvgpr_read_b32 v14, a78
v_mul_f32 v14, v14, v12
v_accvgpr_write_b32 a78, v14
v_accvgpr_read_b32 v14, a79
v_mul_f32 v14, v14, v12
v_accvgpr_write_b32 a79, v14
v_accvgpr_read_b32 v14, a92
v_mul_f32 v14, v14, v12
v_accvgpr_write_b32 a92, v14
v_accvgpr_read_b32 v14, a93
v_mul_f32 v14, v14, v12
v_accvgpr_write_b32 a93, v14
v_accvgpr_read_b32 v14, a94
v_mul_f32 v14, v14, v12
v_accvgpr_write_b32 a94, v14
v_accvgpr_read_b32 v14, a95
v_mul_f32 v14, v14, v12
v_accvgpr_write_b32 a95, v14
v_accvgpr_read_b32 v14, a108
v_mul_f32 v14, v14, v12
v_accvgpr_write_b32 a108, v14
v_accvgpr_read_b32 v14, a109
v_mul_f32 v14, v14, v12
v_accvgpr_write_b32 a109, v14
v_accvgpr_read_b32 v14, a110
v_mul_f32 v14, v14, v12
v_accvgpr_write_b32 a110, v14
v_accvgpr_read_b32 v14, a111
v_mul_f32 v14, v14, v12
v_accvgpr_write_b32 a111, v14
v_exp_f32 v32, v32
v_exp_f32 v33, v33
v_exp_f32 v34, v34
v_exp_f32 v35, v35
v_exp_f32 v48, v48
v_exp_f32 v49, v49
v_exp_f32 v50, v50
v_exp_f32 v51, v51
v_cvt_pk_bf16_f32 v32, v32, v33
v_cvt_pk_bf16_f32 v33, v34, v35
v_exp_f32 v36, v36
v_exp_f32 v37, v37
v_exp_f32 v38, v38
v_exp_f32 v39, v39
v_cvt_pk_bf16_f32 v34, v48, v49
v_cvt_pk_bf16_f32 v35, v50, v51
v_exp_f32 v52, v52
v_exp_f32 v53, v53
v_exp_f32 v54, v54
v_exp_f32 v55, v55
v_cvt_pk_bf16_f32 v36, v36, v37
v_cvt_pk_bf16_f32 v37, v38, v39
v_exp_f32 v40, v40
v_exp_f32 v41, v41
v_exp_f32 v42, v42
v_exp_f32 v43, v43
v_cvt_pk_bf16_f32 v38, v52, v53
v_cvt_pk_bf16_f32 v39, v54, v55
v_exp_f32 v56, v56
v_exp_f32 v57, v57
v_exp_f32 v58, v58
v_exp_f32 v59, v59
v_cvt_pk_bf16_f32 v40, v40, v41
v_cvt_pk_bf16_f32 v41, v42, v43
v_exp_f32 v44, v44
v_exp_f32 v45, v45
v_exp_f32 v46, v46
v_exp_f32 v47, v47
v_cvt_pk_bf16_f32 v42, v56, v57
v_cvt_pk_bf16_f32 v43, v58, v59
v_exp_f32 v60, v60
v_exp_f32 v61, v61
v_exp_f32 v62, v62
v_exp_f32 v63, v63
v_cvt_pk_bf16_f32 v44, v44, v45
v_cvt_pk_bf16_f32 v45, v46, v47
v_cvt_pk_bf16_f32 v46, v60, v61
v_cvt_pk_bf16_f32 v47, v62, v63
v_exp_f32 v64, v64
v_exp_f32 v65, v65
v_exp_f32 v66, v66
v_exp_f32 v67, v67
v_exp_f32 v80, v80
v_exp_f32 v81, v81
v_exp_f32 v82, v82
v_exp_f32 v83, v83
v_cvt_pk_bf16_f32 v64, v64, v65
v_cvt_pk_bf16_f32 v65, v66, v67
v_exp_f32 v68, v68
v_exp_f32 v69, v69
v_exp_f32 v70, v70
v_exp_f32 v71, v71
v_cvt_pk_bf16_f32 v66, v80, v81
v_cvt_pk_bf16_f32 v67, v82, v83
v_exp_f32 v84, v84
v_exp_f32 v85, v85
v_exp_f32 v86, v86
v_exp_f32 v87, v87
v_cvt_pk_bf16_f32 v68, v68, v69
v_cvt_pk_bf16_f32 v69, v70, v71
v_exp_f32 v72, v72
v_exp_f32 v73, v73
v_exp_f32 v74, v74
v_exp_f32 v75, v75
v_cvt_pk_bf16_f32 v70, v84, v85
v_cvt_pk_bf16_f32 v71, v86, v87
v_exp_f32 v88, v88
v_exp_f32 v89, v89
v_exp_f32 v90, v90
v_exp_f32 v91, v91
v_cvt_pk_bf16_f32 v72, v72, v73
v_cvt_pk_bf16_f32 v73, v74, v75
v_exp_f32 v76, v76
v_exp_f32 v77, v77
v_exp_f32 v78, v78
v_exp_f32 v79, v79
v_cvt_pk_bf16_f32 v74, v88, v89
v_cvt_pk_bf16_f32 v75, v90, v91
v_exp_f32 v92, v92
v_exp_f32 v93, v93
v_exp_f32 v94, v94
v_exp_f32 v95, v95
v_cvt_pk_bf16_f32 v76, v76, v77
v_cvt_pk_bf16_f32 v77, v78, v79
v_cvt_pk_bf16_f32 v78, v92, v93
v_cvt_pk_bf16_f32 v79, v94, v95
s_waitcnt vmcnt(0)
M a[96:99], a[112:115], v[32:35], a[96:99]
M a[100:103], a[112:115], v[36:39], a[100:103]
M a[104:107], a[112:115], v[40:43], a[104:107]
M a[108:111], a[112:115], v[44:47], a[108:111]
M v[160:163], v[96:99], v[32:35], v[160:163]
M v[164:167], v[96:99], v[36:39], v[164:167]
M v[168:171], v[96:99], v[40:43], v[168:171]
M v[172:175], v[96:99], v[44:47], v[172:175]
M v[176:179], v[100:103], v[32:35], v[176:179]
M v[180:183], v[100:103], v[36:39], v[180:183]
M v[184:187], v[100:103], v[40:43], v[184:187]
M v[188:191], v[100:103], v[44:47], v[188:191]
M v[192:195], v[104:107], v[32:35], v[192:195]
M v[196:199], v[104:107], v[36:39], v[196:199]
M v[200:203], v[104:107], v[40:43], v[200:203]
M v[204:207], v[104:107], v[44:47], v[204:207]
M v[208:211], v[108:111], v[32:35], v[208:211]
M v[212:215], v[108:111], v[36:39], v[212:215]
M v[216:219], v[108:111], v[40:43], v[216:219]
M v[220:223], v[108:111], v[44:47], v[220:223]
M v[224:227], v[112:115], v[32:35], v[224:227]
M v[228:231], v[112:115], v[36:39], v[228:231]
M v[232:235], v[112:115], v[40:43], v[232:235]
M v[236:239], v[112:115], v[44:47], v[236:239]
M v[240:243], v[116:119], v[32:35], v[240:243]
M v[244:247], v[116:119], v[36:39], v[244:247]
M v[248:251], v[116:119], v[40:43], v[248:251]
M v[252:255], v[116:119], v[44:47], v[252:255]
M a[64:67], v[120:123], v[32:35], a[64:67]
M a[68:71], v[120:123], v[36:39], a[68:71]
M a[72:75], v[120:123], v[40:43], a[72:75]
M a[76:79], v[120:123], v[44:47], a[76:79]
M a[80:83], v[124:127], v[32:35], a[80:83]
M a[84:87], v[124:127], v[36:39], a[84:87]
M a[88:91], v[124:127], v[40:43], a[88:91]
M a[92:95], v[124:127], v[44:47], a[92:95]
M a[96:99], a[112:115], v[64:67], a[96:99]
M a[100:103], a[112:115], v[68:71], a[100:103]
M a[104:107], a[112:115], v[72:75], a[104:107]
M a[108:111], a[112:115], v[76:79], a[108:111]
M v[160:163], v[128:131], v[64:67], v[160:163]
M v[164:167], v[128:131], v[68:71], v[164:167]
M v[168:171], v[128:131], v[72:75], v[168:171]
M v[172:175], v[128:131], v[76:79], v[172:175]
M v[176:179], v[132:135], v[64:67], v[176:179]
M v[180:183], v[132:135], v[68:71], v[180:183]
M v[184:187], v[132:135], v[72:75], v[184:187]
M v[188:191], v[132:135], v[76:79], v[188:191]
M v[192:195], v[136:139], v[64:67], v[192:195]
M v[196:199], v[136:139], v[68:71], v[196:199]
M v[200:203], v[136:139], v[72:75], v[200:203]
M v[204:207], v[136:139], v[76:79], v[204:207]
M v[208:211], v[140:143], v[64:67], v[208:211]
M v[212:215], v[140:143], v[68:71], v[212:215]
M v[216:219], v[140:143], v[72:75], v[216:219]
M v[220:223], v[140:143], v[76:79], v[220:223]
M v[224:227], v[144:147], v[64:67], v[224:227]
M v[228:231], v[144:147], v[68:71], v[228:231]
M v[232:235], v[144:147], v[72:75], v[232:235]
M v[236:239], v[144:147], v[76:79], v[236:239]
M v[240:243], v[148:151], v[64:67], v[240:243]
M v[244:247], v[148:151], v[68:71], v[244:247]
M v[248:251], v[148:151], v[72:75], v[248:251]
M v[252:255], v[148:151], v[76:79], v[252:255]
M a[64:67], v[152:155], v[64:67], a[64:67]
M a[68:71], v[152:155], v[68:71], a[68:71]
M a[72:75], v[152:155], v[72:75], a[72:75]
M a[76:79], v[152:155], v[76:79], a[76:79]
M a[80:83], v[156:159], v[64:67], a[80:83]
M a[84:87], v[156:159], v[68:71], a[84:87]
M a[88:91], v[156:159], v[72:75], a[88:91]
M a[92:95], v[156:159], v[76:79], a[92:95]
s_nop 7
s_add_u32 s57, s57, 32768
s_sub_u32 s58, s58, 64
s_sub_u32 s59, s59, 1
s_cmp_lg_u32 s59, 0
s_cbranch_scc1 Lslow_2
v_accvgpr_read_b32 v20, a96
v_accvgpr_read_b32 v21, a100
v_accvgpr_read_b32 v22, a104
v_accvgpr_read_b32 v23, a108
v_rcp_f32 v8, v20
v_rcp_f32 v9, v21
v_rcp_f32 v10, v22
v_rcp_f32 v11, v23
s_lshl_b32 s33, s56, 20
s_lshl_b32 s34, s20, 15
s_add_u32 s33, s33, s34
s_lshl_b32 s34, s23, 13
s_add_u32 s36, s33, s34
s_add_u32 s37, s36, 4096
s_add_u32 s38, s36, 16384
s_add_u32 s39, s36, 20480
v_pk_mul_f32 v[160:161], v[160:161], v[8:9] op_sel:[0,0] op_sel_hi:[1,0]
v_pk_mul_f32 v[162:163], v[162:163], v[8:9] op_sel:[0,0] op_sel_hi:[1,0]
v_pk_mul_f32 v[176:177], v[176:177], v[8:9] op_sel:[0,0] op_sel_hi:[1,0]
v_pk_mul_f32 v[178:179], v[178:179], v[8:9] op_sel:[0,0] op_sel_hi:[1,0]
v_cvt_pk_bf16_f32 v160, v160, v161
v_cvt_pk_bf16_f32 v161, v162, v163
v_cvt_pk_bf16_f32 v162, v176, v177
v_cvt_pk_bf16_f32 v163, v178, v179
v_pk_mul_f32 v[164:165], v[164:165], v[8:9] op_sel:[0,1] op_sel_hi:[1,1]
v_pk_mul_f32 v[166:167], v[166:167], v[8:9] op_sel:[0,1] op_sel_hi:[1,1]
v_pk_mul_f32 v[180:181], v[180:181], v[8:9] op_sel:[0,1] op_sel_hi:[1,1]
v_pk_mul_f32 v[182:183], v[182:183], v[8:9] op_sel:[0,1] op_sel_hi:[1,1]
v_cvt_pk_bf16_f32 v164, v164, v165
v_cvt_pk_bf16_f32 v165, v166, v167
v_cvt_pk_bf16_f32 v166, v180, v181
v_cvt_pk_bf16_f32 v167, v182, v183
v_pk_mul_f32 v[168:169], v[168:169], v[10:11] op_sel:[0,0] op_sel_hi:[1,0]
v_pk_mul_f32 v[170:171], v[170:171], v[10:11] op_sel:[0,0] op_sel_hi:[1,0]
v_pk_mul_f32 v[184:185], v[184:185], v[10:11] op_sel:[0,0] op_sel_hi:[1,0]
v_pk_mul_f32 v[186:187], v[186:187], v[10:11] op_sel:[0,0] op_sel_hi:[1,0]
v_cvt_pk_bf16_f32 v168, v168, v169
v_cvt_pk_bf16_f32 v169, v170, v171
v_cvt_pk_bf16_f32 v170, v184, v185
v_cvt_pk_bf16_f32 v171, v186, v187
v_pk_mul_f32 v[172:173], v[172:173], v[10:11] op_sel:[0,1] op_sel_hi:[1,1]
v_pk_mul_f32 v[174:175], v[174:175], v[10:11] op_sel:[0,1] op_sel_hi:[1,1]
v_pk_mul_f32 v[188:189], v[188:189], v[10:11] op_sel:[0,1] op_sel_hi:[1,1]
v_pk_mul_f32 v[190:191], v[190:191], v[10:11] op_sel:[0,1] op_sel_hi:[1,1]
v_cvt_pk_bf16_f32 v172, v172, v173
v_cvt_pk_bf16_f32 v173, v174, v175
v_cvt_pk_bf16_f32 v174, v188, v189
v_cvt_pk_bf16_f32 v175, v190, v191
v_pk_mul_f32 v[192:193], v[192:193], v[8:9] op_sel:[0,0] op_sel_hi:[1,0]
v_pk_mul_f32 v[194:195], v[194:195], v[8:9] op_sel:[0,0] op_sel_hi:[1,0]
v_pk_mul_f32 v[208:209], v[208:209], v[8:9] op_sel:[0,0] op_sel_hi:[1,0]
v_pk_mul_f32 v[210:211], v[210:211], v[8:9] op_sel:[0,0] op_sel_hi:[1,0]
v_cvt_pk_bf16_f32 v192, v192, v193
v_cvt_pk_bf16_f32 v193, v194, v195
v_cvt_pk_bf16_f32 v194, v208, v209
v_cvt_pk_bf16_f32 v195, v210, v211
v_pk_mul_f32 v[196:197], v[196:197], v[8:9] op_sel:[0,1] op_sel_hi:[1,1]
v_pk_mul_f32 v[198:199], v[198:199], v[8:9] op_sel:[0,1] op_sel_hi:[1,1]
v_pk_mul_f32 v[212:213], v[212:213], v[8:9] op_sel:[0,1] op_sel_hi:[1,1]
v_pk_mul_f32 v[214:215], v[214:215], v[8:9] op_sel:[0,1] op_sel_hi:[1,1]
v_cvt_pk_bf16_f32 v196, v196, v197
v_cvt_pk_bf16_f32 v197, v198, v199
v_cvt_pk_bf16_f32 v198, v212, v213
v_cvt_pk_bf16_f32 v199, v214, v215
v_pk_mul_f32 v[200:201], v[200:201], v[10:11] op_sel:[0,0] op_sel_hi:[1,0]
v_pk_mul_f32 v[202:203], v[202:203], v[10:11] op_sel:[0,0] op_sel_hi:[1,0]
v_pk_mul_f32 v[216:217], v[216:217], v[10:11] op_sel:[0,0] op_sel_hi:[1,0]
v_pk_mul_f32 v[218:219], v[218:219], v[10:11] op_sel:[0,0] op_sel_hi:[1,0]
v_cvt_pk_bf16_f32 v200, v200, v201
v_cvt_pk_bf16_f32 v201, v202, v203
v_cvt_pk_bf16_f32 v202, v216, v217
v_cvt_pk_bf16_f32 v203, v218, v219
v_pk_mul_f32 v[204:205], v[204:205], v[10:11] op_sel:[0,1] op_sel_hi:[1,1]
v_pk_mul_f32 v[206:207], v[206:207], v[10:11] op_sel:[0,1] op_sel_hi:[1,1]
v_pk_mul_f32 v[220:221], v[220:221], v[10:11] op_sel:[0,1] op_sel_hi:[1,1]
v_pk_mul_f32 v[222:223], v[222:223], v[10:11] op_sel:[0,1] op_sel_hi:[1,1]
v_cvt_pk_bf16_f32 v204, v204, v205
v_cvt_pk_bf16_f32 v205, v206, v207
v_cvt_pk_bf16_f32 v206, v220, v221
v_cvt_pk_bf16_f32 v207, v222, v223
v_pk_mul_f32 v[224:225], v[224:225], v[8:9] op_sel:[0,0] op_sel_hi:[1,0]
v_pk_mul_f32 v[226:227], v[226:227], v[8:9] op_sel:[0,0] op_sel_hi:[1,0]
v_pk_mul_f32 v[240:241], v[240:241], v[8:9] op_sel:[0,0] op_sel_hi:[1,0]
v_pk_mul_f32 v[242:243], v[242:243], v[8:9] op_sel:[0,0] op_sel_hi:[1,0]
v_cvt_pk_bf16_f32 v224, v224, v225
v_cvt_pk_bf16_f32 v225, v226, v227
v_cvt_pk_bf16_f32 v226, v240, v241
v_cvt_pk_bf16_f32 v227, v242, v243
v_pk_mul_f32 v[228:229], v[228:229], v[8:9] op_sel:[0,1] op_sel_hi:[1,1]
v_pk_mul_f32 v[230:231], v[230:231], v[8:9] op_sel:[0,1] op_sel_hi:[1,1]
v_pk_mul_f32 v[244:245], v[244:245], v[8:9] op_sel:[0,1] op_sel_hi:[1,1]
v_pk_mul_f32 v[246:247], v[246:247], v[8:9] op_sel:[0,1] op_sel_hi:[1,1]
v_cvt_pk_bf16_f32 v228, v228, v229
v_cvt_pk_bf16_f32 v229, v230, v231
v_cvt_pk_bf16_f32 v230, v244, v245
v_cvt_pk_bf16_f32 v231, v246, v247
v_pk_mul_f32 v[232:233], v[232:233], v[10:11] op_sel:[0,0] op_sel_hi:[1,0]
v_pk_mul_f32 v[234:235], v[234:235], v[10:11] op_sel:[0,0] op_sel_hi:[1,0]
v_pk_mul_f32 v[248:249], v[248:249], v[10:11] op_sel:[0,0] op_sel_hi:[1,0]
v_pk_mul_f32 v[250:251], v[250:251], v[10:11] op_sel:[0,0] op_sel_hi:[1,0]
v_cvt_pk_bf16_f32 v232, v232, v233
v_cvt_pk_bf16_f32 v233, v234, v235
v_cvt_pk_bf16_f32 v234, v248, v249
v_cvt_pk_bf16_f32 v235, v250, v251
v_pk_mul_f32 v[236:237], v[236:237], v[10:11] op_sel:[0,1] op_sel_hi:[1,1]
v_pk_mul_f32 v[238:239], v[238:239], v[10:11] op_sel:[0,1] op_sel_hi:[1,1]
v_pk_mul_f32 v[252:253], v[252:253], v[10:11] op_sel:[0,1] op_sel_hi:[1,1]
v_pk_mul_f32 v[254:255], v[254:255], v[10:11] op_sel:[0,1] op_sel_hi:[1,1]
v_cvt_pk_bf16_f32 v236, v236, v237
v_cvt_pk_bf16_f32 v237, v238, v239
v_cvt_pk_bf16_f32 v238, v252, v253
v_cvt_pk_bf16_f32 v239, v254, v255
v_accvgpr_read_b32 v176, a64
v_accvgpr_read_b32 v177, a65
v_accvgpr_read_b32 v178, a66
v_accvgpr_read_b32 v179, a67
v_accvgpr_read_b32 v180, a80
v_accvgpr_read_b32 v181, a81
v_accvgpr_read_b32 v182, a82
v_accvgpr_read_b32 v183, a83
v_pk_mul_f32 v[176:177], v[176:177], v[8:9] op_sel:[0,0] op_sel_hi:[1,0]
v_pk_mul_f32 v[178:179], v[178:179], v[8:9] op_sel:[0,0] op_sel_hi:[1,0]
v_pk_mul_f32 v[180:181], v[180:181], v[8:9] op_sel:[0,0] op_sel_hi:[1,0]
v_pk_mul_f32 v[182:183], v[182:183], v[8:9] op_sel:[0,0] op_sel_hi:[1,0]
v_cvt_pk_bf16_f32 v176, v176, v177
v_cvt_pk_bf16_f32 v177, v178, v179
v_cvt_pk_bf16_f32 v178, v180, v181
v_cvt_pk_bf16_f32 v179, v182, v183
v_accvgpr_read_b32 v184, a68
v_accvgpr_read_b32 v185, a69
v_accvgpr_read_b32 v186, a70
v_accvgpr_read_b32 v187, a71
v_accvgpr_read_b32 v188, a84
v_accvgpr_read_b32 v189, a85
v_accvgpr_read_b32 v190, a86
v_accvgpr_read_b32 v191, a87
v_pk_mul_f32 v[184:185], v[184:185], v[8:9] op_sel:[0,1] op_sel_hi:[1,1]
v_pk_mul_f32 v[186:187], v[186:187], v[8:9] op_sel:[0,1] op_sel_hi:[1,1]
v_pk_mul_f32 v[188:189], v[188:189], v[8:9] op_sel:[0,1] op_sel_hi:[1,1]
v_pk_mul_f32 v[190:191], v[190:191], v[8:9] op_sel:[0,1] op_sel_hi:[1,1]
v_cvt_pk_bf16_f32 v184, v184, v185
v_cvt_pk_bf16_f32 v185, v186, v187
v_cvt_pk_bf16_f32 v186, v188, v189
v_cvt_pk_bf16_f32 v187, v190, v191
v_accvgpr_read_b32 v208, a72
v_accvgpr_read_b32 v209, a73
v_accvgpr_read_b32 v210, a74
v_accvgpr_read_b32 v211, a75
v_accvgpr_read_b32 v212, a88
v_accvgpr_read_b32 v213, a89
v_accvgpr_read_b32 v214, a90
v_accvgpr_read_b32 v215, a91
v_pk_mul_f32 v[208:209], v[208:209], v[10:11] op_sel:[0,0] op_sel_hi:[1,0]
v_pk_mul_f32 v[210:211], v[210:211], v[10:11] op_sel:[0,0] op_sel_hi:[1,0]
v_pk_mul_f32 v[212:213], v[212:213], v[10:11] op_sel:[0,0] op_sel_hi:[1,0]
v_pk_mul_f32 v[214:215], v[214:215], v[10:11] op_sel:[0,0] op_sel_hi:[1,0]
v_cvt_pk_bf16_f32 v208, v208, v209
v_cvt_pk_bf16_f32 v209, v210, v211
v_cvt_pk_bf16_f32 v210, v212, v213
v_cvt_pk_bf16_f32 v211, v214, v215
v_accvgpr_read_b32 v216, a76
v_accvgpr_read_b32 v217, a77
v_accvgpr_read_b32 v218, a78
v_accvgpr_read_b32 v219, a79
v_accvgpr_read_b32 v220, a92
v_accvgpr_read_b32 v221, a93
v_accvgpr_read_b32 v222, a94
v_accvgpr_read_b32 v223, a95
v_pk_mul_f32 v[216:217], v[216:217], v[10:11] op_sel:[0,1] op_sel_hi:[1,1]
v_pk_mul_f32 v[218:219], v[218:219], v[10:11] op_sel:[0,1] op_sel_hi:[1,1]
v_pk_mul_f32 v[220:221], v[220:221], v[10:11] op_sel:[0,1] op_sel_hi:[1,1]
v_pk_mul_f32 v[222:223], v[222:223], v[10:11] op_sel:[0,1] op_sel_hi:[1,1]
v_cvt_pk_bf16_f32 v216, v216, v217
v_cvt_pk_bf16_f32 v217, v218, v219
v_cvt_pk_bf16_f32 v218, v220, v221
v_cvt_pk_bf16_f32 v219, v222, v223
s_bitcmp1_b32 s61, 0
s_cbranch_scc0 Lss_3
buffer_store_dwordx4 v[160:163], v1, s[16:19], s36 offen offset:0 sc1
buffer_store_dwordx4 v[164:167], v1, s[16:19], s36 offen offset:2048 sc1
buffer_store_dwordx4 v[168:171], v1, s[16:19], s37 offen offset:0 sc1
buffer_store_dwordx4 v[172:175], v1, s[16:19], s37 offen offset:2048 sc1
Lss_3:
s_bitcmp1_b32 s61, 1
s_cbranch_scc0 Lss_4
buffer_store_dwordx4 v[192:195], v1, s[16:19], s36 offen offset:1024 sc1
buffer_store_dwordx4 v[196:199], v1, s[16:19], s36 offen offset:3072 sc1
buffer_store_dwordx4 v[200:203], v1, s[16:19], s37 offen offset:1024 sc1
buffer_store_dwordx4 v[204:207], v1, s[16:19], s37 offen offset:3072 sc1
Lss_4:
s_bitcmp1_b32 s61, 2
s_cbranch_scc0 Lss_5
buffer_store_dwordx4 v[224:227], v1, s[16:19], s38 offen offset:0 sc1
buffer_store_dwordx4 v[228:231], v1, s[16:19], s38 offen offset:2048 sc1
buffer_store_dwordx4 v[232:235], v1, s[16:19], s39 offen offset:0 sc1
buffer_store_dwordx4 v[236:239], v1, s[16:19], s39 offen offset:2048 sc1
Lss_5:
s_bitcmp1_b32 s61, 3
s_cbranch_scc0 Lss_6
buffer_store_dwordx4 v[176:179], v1, s[16:19], s38 offen offset:1024 sc1
buffer_store_dwordx4 v[184:187], v1, s[16:19], s38 offen offset:3072 sc1
buffer_store_dwordx4 v[208:211], v1, s[16:19], s39 offen offset:1024 sc1
buffer_store_dwordx4 v[216:219], v1, s[16:19], s39 offen offset:3072 sc1
Lss_6:
s_branch Lk2_chk
Lk2_done:
s_lshl_b32 s33, s20, 4
s_add_u32 s33, s33, 8392704
s_sub_u32 s34, 15, s21
s_lshl_b32 s34, s34, 9
s_add_u32 s92, s33, s34
s_lshl_b32 s34, s22, 2
s_add_u32 s92, s92, s34
s_lshl_b32 s34, s21, 9
s_add_u32 s93, s33, s34
s_lshl_b32 s34, s23, 3
s_add_u32 s93, s93, s34
s_cmp_eq_u32 s24, 0
s_cselect_b32 s93, s93, s92
s_cselect_b32 s94, 4, 0
s_add_u32 s94, s94, s93
s_load_dwordx2 s[10:11], s[0:1], 40
s_load_dwordx2 s[14:15], s[0:1], 72
s_lshl_b32 s21, s27, 7
s_lshl_b32 s22, s28, 6
s_lshl_b32 s3, s101, 4
v_lshrrev_b32 v224, 3, v0
v_and_b32 v225, 6, v224
v_and_b32 v226, 7, v0
v_xor_b32 v225, v225, v226
v_add_u32 v224, s3, v224
v_lshlrev_b32 v224, 11, v224
v_lshl_add_u32 v6, v225, 4, v224
v_add_u32 v7, 15360, v6
v_lshrrev_b32 v224, 2, v0
v_and_b32 v226, 1, v0
v_bfe_u32 v229, v0, 1, 1
v_lshlrev_b32 v225, 7, v224
v_lshl_add_u32 v225, v226, 3, v225
v_and_b32 v228, 6, v224
v_add_u32 v227, 0, v229
v_xor_b32 v227, v227, v228
v_lshl_add_u32 v24, v227, 4, v225
v_add_u32 v28, 0x10000, v24
v_add_u32 v227, 2, v229
v_xor_b32 v227, v227, v228
v_lshl_add_u32 v25, v227, 4, v225
v_add_u32 v29, 0x10000, v25
v_add_u32 v227, 4, v229
v_xor_b32 v227, v227, v228
v_lshl_add_u32 v26, v227, 4, v225
v_add_u32 v30, 0x10000, v26
v_add_u32 v227, 6, v229
v_xor_b32 v227, v227, v228
v_lshl_add_u32 v27, v227, 4, v225
v_add_u32 v31, 0x10000, v27
s_waitcnt vmcnt(32)
s_barrier
ds_read_b64_tr_b16 v[96:97], v28 offset:0
ds_read_b64_tr_b16 v[98:99], v28 offset:2048
ds_read_b64_tr_b16 v[100:101], v28 offset:4096
ds_read_b64_tr_b16 v[102:103], v28 offset:6144
ds_read_b64_tr_b16 v[104:105], v29 offset:0
ds_read_b64_tr_b16 v[106:107], v29 offset:2048
ds_read_b64_tr_b16 v[108:109], v29 offset:4096
ds_read_b64_tr_b16 v[110:111], v29 offset:6144
ds_read_b64_tr_b16 v[112:113], v30 offset:0
ds_read_b64_tr_b16 v[114:115], v30 offset:2048
ds_read_b64_tr_b16 v[116:117], v30 offset:4096
ds_read_b64_tr_b16 v[118:119], v30 offset:6144
ds_read_b64_tr_b16 v[120:121], v31 offset:0
ds_read_b64_tr_b16 v[122:123], v31 offset:2048
ds_read_b64_tr_b16 v[124:125], v31 offset:4096
ds_read_b64_tr_b16 v[126:127], v31 offset:6144
s_and_b32 s40, s2, 1
s_bfe_u32 s3, s2, 0x10001
s_lshl_b32 s3, s3, 3
s_bfe_u32 s36, s2, 0x30003
s_add_u32 s36, s3, s36
s_lshl_b32 s29, s36, 7
s_bfe_u32 s3, s2, 0x10002
s_lshl_b32 s3, s3, 2
s_lshr_b32 s37, s2, 6
s_add_u32 s3, s3, s37
s_lshl_b32 s13, s3, 8
s_lshl_b32 s30, s3, 7
s_lshl_b32 s3, s40, 6
s_add_u32 s30, s30, s3
s_lshl_b32 s41, s101, 12
s_lshl_b32 s12, s36, 20
s_add_u32 s12, s12, s41
s_lshl_b32 s62, s36, 9
s_lshl_b32 s3, s40, 8
s_add_u32 s62, s62, s3
s_add_u32 s62, s62, 8392704
s_lshr_b32 s3, s2, 1
s_lshr_b32 s38, s2, 2
s_xor_b32 s3, s3, s38
s_and_b32 s3, s3, 1
s_lshl_b32 s3, s3, 4
s_sub_u32 s39, 32, s3
s_lshl_b32 s38, s40, 5
s_add_u32 s3, s3, s38
s_lshl_b32 s3, s3, 14
s_add_u32 s12, s12, s3
s_lshl_b32 s3, s3, 3
s_add_u32 s13, s13, s3
s_mov_b32 s64, 4294459392
s_mov_b32 s65, 16384
s_add_u32 s8, s4, 67108864
s_addc_u32 s9, s5, 0
s_lshl_b32 s56, s2, 15
s_lshl_b32 s38, s101, 13
s_add_u32 s56, s56, s38
s_xor_b32 s57, s56, 32768
s_lshl_b32 s58, s2, 2
s_add_u32 s58, s58, 8388608
s_xor_b32 s59, s58, 4
s_mov_b32 s61, 0
s_lshl_b32 s3, s101, 4
v_lshrrev_b32 v232, 4, v0
v_and_b32 v234, 15, v0
v_add_u32 v233, 0, v232
v_lshlrev_b32 v233, 1, v233
v_xor_b32 v233, v233, v234
v_add_u32 v235, s3, v232
v_lshlrev_b32 v235, 11, v235
v_lshl_add_u32 v235, v233, 4, v235
v_add_u32 v2, 0, v235
v_add_u32 v233, 4, v232
v_lshlrev_b32 v233, 1, v233
v_xor_b32 v233, v233, v234
v_add_u32 v235, s3, v232
v_lshlrev_b32 v235, 11, v235
v_lshl_add_u32 v235, v233, 4, v235
v_add_u32 v3, 7168, v235
v_add_u32 v233, 0, v232
v_lshlrev_b32 v233, 1, v233
v_xor_b32 v233, v233, v234
v_add_u32 v235, s3, v232
v_lshlrev_b32 v235, 11, v235
v_lshl_add_u32 v235, v233, 4, v235
v_add_u32 v4, 14336, v235
v_add_u32 v233, 4, v232
v_lshlrev_b32 v233, 1, v233
v_xor_b32 v233, v233, v234
v_add_u32 v235, s3, v232
v_lshlrev_b32 v235, 11, v235
v_lshl_add_u32 v235, v233, 4, v235
v_add_u32 v5, 21504, v235
v_lshlrev_b32 v225, 8, v224
v_lshl_add_u32 v225, v226, 3, v225
v_and_b32 v228, 7, v224
v_lshlrev_b32 v228, 1, v228
s_lshl_b32 s38, s40, 3
v_xor_b32 v228, s38, v228
v_add_u32 v227, 0, v229
v_xor_b32 v227, v227, v228
v_lshl_add_u32 v8, v227, 4, v225
v_add_u32 v16, 0x10000, v8
v_add_u32 v227, 2, v229
v_xor_b32 v227, v227, v228
v_lshl_add_u32 v9, v227, 4, v225
v_add_u32 v17, 0x10000, v9
v_add_u32 v227, 4, v229
v_xor_b32 v227, v227, v228
v_lshl_add_u32 v10, v227, 4, v225
v_add_u32 v18, 0x10000, v10
v_add_u32 v227, 6, v229
v_xor_b32 v227, v227, v228
v_lshl_add_u32 v11, v227, 4, v225
v_add_u32 v19, 0x10000, v11
v_add_u32 v227, 8, v229
v_xor_b32 v227, v227, v228
v_lshl_add_u32 v12, v227, 4, v225
v_add_u32 v20, 0x10000, v12
v_add_u32 v227, 10, v229
v_xor_b32 v227, v227, v228
v_lshl_add_u32 v13, v227, 4, v225
v_add_u32 v21, 0x10000, v13
v_add_u32 v227, 12, v229
v_xor_b32 v227, v227, v228
v_lshl_add_u32 v14, v227, 4, v225
v_add_u32 v22, 0x10000, v14
v_add_u32 v227, 14, v229
v_xor_b32 v227, v227, v228
v_lshl_add_u32 v15, v227, 4, v225
v_add_u32 v23, 0x10000, v15
v_mov_b32 v253, 0
v_mov_b32 v254, 1
v_lshlrev_b32 v255, 2, v0
s_waitcnt lgkmcnt(0)
s_mov_b32 s16, s14
s_mov_b32 s17, s15
s_mov_b32 s18, 8388608
s_mov_b32 s19, 0x00020000
s_waitcnt vmcnt(26) lgkmcnt(0)
s_barrier
M a[0:3], v[96:99], a[192:195], 0
s_add_u32 m0, s42, 16384
s_nop 0
buffer_load_dwordx4 v6, s[48:51], s26 offen offset:0 lds
ds_read_b64_tr_b16 v[160:161], v28 offset:16384
ds_read_b64_tr_b16 v[162:163], v28 offset:18432
M a[0:3], v[100:103], a[196:199], a[0:3]
buffer_load_dwordx4 v7, s[48:51], s26 offen offset:1024 lds
M a[4:7], v[108:111], a[196:199], 0
ds_read_b64_tr_b16 v[164:165], v28 offset:20480
ds_read_b64_tr_b16 v[166:167], v28 offset:22528
M a[4:7], v[104:107], a[192:195], a[4:7]
buffer_load_dwordx4 a[144:147], v1, s[44:47], s25 offen offset:0 sc1
M a[8:11], v[112:115], a[192:195], 0
ds_read_b64_tr_b16 v[168:169], v29 offset:16384
ds_read_b64_tr_b16 v[170:171], v29 offset:18432
M a[8:11], v[116:119], a[196:199], a[8:11]
buffer_load_dwordx4 a[148:151], v1, s[44:47], s25 offen offset:1024 sc1
M a[12:15], v[124:127], a[196:199], 0
ds_read_b64_tr_b16 v[172:173], v29 offset:20480
ds_read_b64_tr_b16 v[174:175], v29 offset:22528
M a[12:15], v[120:123], a[192:195], a[12:15]
buffer_load_dwordx4 a[152:155], v1, s[44:47], s25 offen offset:2048 sc1
M a[16:19], v[96:99], a[200:203], 0
ds_read_b64_tr_b16 v[176:177], v30 offset:16384
ds_read_b64_tr_b16 v[178:179], v30 offset:18432
M a[16:19], v[100:103], a[204:207], a[16:19]
buffer_load_dwordx4 a[156:159], v1, s[44:47], s25 offen offset:3072 sc1
M a[20:23], v[108:111], a[204:207], 0
ds_read_b64_tr_b16 v[180:181], v30 offset:20480
ds_read_b64_tr_b16 v[182:183], v30 offset:22528
M a[20:23], v[104:107], a[200:203], a[20:23]
s_add_u32 s25, s25, 16384
s_add_u32 s26, s26, 131072
M a[24:27], v[112:115], a[200:203], 0
ds_read_b64_tr_b16 v[184:185], v31 offset:16384
ds_read_b64_tr_b16 v[186:187], v31 offset:18432
M a[24:27], v[116:119], a[204:207], a[24:27]
ds_read_b64_tr_b16 v[188:189], v31 offset:20480
ds_read_b64_tr_b16 v[190:191], v31 offset:22528
M a[28:31], v[124:127], a[204:207], 0
M a[28:31], v[120:123], a[200:203], a[28:31]
s_waitcnt vmcnt(6) lgkmcnt(0)
s_barrier
s_mov_b64 exec, 1
buffer_store_dword v254, v253, s[52:55], s92 offen sc1
buffer_store_dword v254, v253, s[52:55], s93 offen sc1
buffer_store_dword v254, v253, s[52:55], s94 offen sc1
s_mov_b64 exec, -1
M a[0:3], v[160:163], a[208:211], a[0:3]
s_add_u32 m0, s42, 32768
s_nop 0
buffer_load_dwordx4 v6, s[48:51], s26 offen offset:0 lds
ds_read_b64_tr_b16 v[96:97], v28 offset:32768
ds_read_b64_tr_b16 v[98:99], v28 offset:34816
M a[0:3], v[164:167], a[212:215], a[0:3]
buffer_load_dwordx4 v7, s[48:51], s26 offen offset:1024 lds
M a[4:7], v[172:175], a[212:215], a[4:7]
ds_read_b64_tr_b16 v[100:101], v28 offset:36864
ds_read_b64_tr_b16 v[102:103], v28 offset:38912
M a[4:7], v[168:171], a[208:211], a[4:7]
buffer_load_dwordx4 a[160:163], v1, s[44:47], s25 offen offset:0 sc1
M a[8:11], v[176:179], a[208:211], a[8:11]
ds_read_b64_tr_b16 v[104:105], v29 offset:32768
ds_read_b64_tr_b16 v[106:107], v29 offset:34816
M a[8:11], v[180:183], a[212:215], a[8:11]
buffer_load_dwordx4 a[164:167], v1, s[44:47], s25 offen offset:1024 sc1
M a[12:15], v[188:191], a[212:215], a[12:15]
ds_read_b64_tr_b16 v[108:109], v29 offset:36864
ds_read_b64_tr_b16 v[110:111], v29 offset:38912
M a[12:15], v[184:187], a[208:211], a[12:15]
buffer_load_dwordx4 a[168:171], v1, s[44:47], s25 offen offset:2048 sc1
M a[16:19], v[160:163], a[216:219], a[16:19]
ds_read_b64_tr_b16 v[112:113], v30 offset:32768
ds_read_b64_tr_b16 v[114:115], v30 offset:34816
M a[16:19], v[164:167], a[220:223], a[16:19]
buffer_load_dwordx4 a[172:175], v1, s[44:47], s25 offen offset:3072 sc1
M a[20:23], v[172:175], a[220:223], a[20:23]
ds_read_b64_tr_b16 v[116:117], v30 offset:36864
ds_read_b64_tr_b16 v[118:119], v30 offset:38912
M a[20:23], v[168:171], a[216:219], a[20:23]
s_add_u32 s25, s25, 16384
s_add_u32 s26, s26, 131072
M a[24:27], v[176:179], a[216:219], a[24:27]
ds_read_b64_tr_b16 v[120:121], v31 offset:32768
ds_read_b64_tr_b16 v[122:123], v31 offset:34816
M a[24:27], v[180:183], a[220:223], a[24:27]
ds_read_b64_tr_b16 v[124:125], v31 offset:36864
ds_read_b64_tr_b16 v[126:127], v31 offset:38912
M a[28:31], v[188:191], a[220:223], a[28:31]
M a[28:31], v[184:187], a[216:219], a[28:31]
s_waitcnt vmcnt(29) lgkmcnt(0)
s_barrier
M a[0:3], v[96:99], a[224:227], a[0:3]
s_add_u32 m0, s42, 49152
s_nop 0
buffer_load_dwordx4 v6, s[48:51], s26 offen offset:0 lds
ds_read_b64_tr_b16 v[160:161], v28 offset:49152
ds_read_b64_tr_b16 v[162:163], v28 offset:51200
M a[0:3], v[100:103], a[228:231], a[0:3]
buffer_load_dwordx4 v7, s[48:51], s26 offen offset:1024 lds
M a[4:7], v[108:111], a[228:231], a[4:7]
ds_read_b64_tr_b16 v[164:165], v28 offset:53248
ds_read_b64_tr_b16 v[166:167], v28 offset:55296
M a[4:7], v[104:107], a[224:227], a[4:7]
buffer_load_dwordx4 a[176:179], v1, s[44:47], s25 offen offset:0 sc1
M a[8:11], v[112:115], a[224:227], a[8:11]
ds_read_b64_tr_b16 v[168:169], v29 offset:49152
ds_read_b64_tr_b16 v[170:171], v29 offset:51200
M a[8:11], v[116:119], a[228:231], a[8:11]
buffer_load_dwordx4 a[180:183], v1, s[44:47], s25 offen offset:1024 sc1
M a[12:15], v[124:127], a[228:231], a[12:15]
ds_read_b64_tr_b16 v[172:173], v29 offset:53248
ds_read_b64_tr_b16 v[174:175], v29 offset:55296
M a[12:15], v[120:123], a[224:227], a[12:15]
buffer_load_dwordx4 a[184:187], v1, s[44:47], s25 offen offset:2048 sc1
ds_read_b64_tr_b16 v[176:177], v30 offset:49152
ds_read_b64_tr_b16 v[178:179], v30 offset:51200
M a[16:19], v[96:99], a[232:235], a[16:19]
buffer_load_dwordx4 a[188:191], v1, s[44:47], s25 offen offset:3072 sc1
M a[16:19], v[100:103], a[236:239], a[16:19]
ds_read_b64_tr_b16 v[180:181], v30 offset:53248
ds_read_b64_tr_b16 v[182:183], v30 offset:55296
M a[20:23], v[108:111], a[236:239], a[20:23]
s_add_u32 s25, s25, 16384
s_add_u32 s26, s26, 131072
M a[20:23], v[104:107], a[232:235], a[20:23]
ds_read_b64_tr_b16 v[184:185], v31 offset:49152
ds_read_b64_tr_b16 v[186:187], v31 offset:51200
M a[24:27], v[112:115], a[232:235], a[24:27]
buffer_load_dword v252, v255, s[52:55], s62 offen sc1
M a[24:27], v[116:119], a[236:239], a[24:27]
ds_read_b64_tr_b16 v[188:189], v31 offset:53248
ds_read_b64_tr_b16 v[190:191], v31 offset:55296
M a[28:31], v[124:127], a[236:239], a[28:31]
M a[28:31], v[120:123], a[232:235], a[28:31]
s_waitcnt vmcnt(30) lgkmcnt(0)
s_barrier
s_waitcnt vmcnt(0)
v_cmp_ne_u32 vcc, 1, v252
s_nop 0
s_cbranch_vccnz Lk3_spinft
Lk3_gotft:
M a[0:3], v[160:163], a[240:243], a[0:3]
s_mov_b32 s32, s25
s_mov_b32 s33, s26
s_mov_b64 s[34:35], s[44:45]
s_mov_b64 s[36:37], s[48:49]
s_mov_b64 s[44:45], s[8:9]
s_mov_b32 s46, 16777216
s_mov_b64 s[48:49], s[10:11]
s_mov_b32 s50, 8388608
s_mov_b32 s25, s12
s_mov_b32 s26, s13
s_add_u32 m0, s41, 65536
s_nop 0
buffer_load_dwordx4 v2, s[48:51], s26 offen offset:0 lds
ds_read_b64_tr_b16 v[96:97], v24 offset:0
ds_read_b64_tr_b16 v[98:99], v24 offset:2048
M a[0:3], v[164:167], a[244:247], a[0:3]
buffer_load_dwordx4 v3, s[48:51], s26 offen offset:1024 lds
M a[4:7], v[172:175], a[244:247], a[4:7]
ds_read_b64_tr_b16 v[100:101], v24 offset:4096
ds_read_b64_tr_b16 v[102:103], v24 offset:6144
M a[4:7], v[168:171], a[240:243], a[4:7]
buffer_load_dwordx4 v4, s[48:51], s26 offen offset:2048 lds
ds_read_b64_tr_b16 v[104:105], v25 offset:0
ds_read_b64_tr_b16 v[106:107], v25 offset:2048
M a[8:11], v[176:179], a[240:243], a[8:11]
buffer_load_dwordx4 v5, s[48:51], s26 offen offset:3072 lds
M a[8:11], v[180:183], a[244:247], a[8:11]
ds_read_b64_tr_b16 v[108:109], v25 offset:4096
ds_read_b64_tr_b16 v[110:111], v25 offset:6144
M a[12:15], v[188:191], a[244:247], a[12:15]
buffer_load_dwordx4 a[192:195], v1, s[44:47], s25 offen offset:0 sc1
M a[12:15], v[184:187], a[240:243], a[12:15]
ds_read_b64_tr_b16 v[112:113], v26 offset:0
ds_read_b64_tr_b16 v[114:115], v26 offset:2048
buffer_load_dwordx4 a[196:199], v1, s[44:47], s25 offen offset:1024 sc1
M a[16:19], v[160:163], a[248:251], a[16:19]
ds_read_b64_tr_b16 v[116:117], v26 offset:4096
ds_read_b64_tr_b16 v[118:119], v26 offset:6144
M a[16:19], v[164:167], a[252:255], a[16:19]
buffer_load_dwordx4 a[200:203], v1, s[44:47], s25 offen offset:2048 sc1
M a[20:23], v[172:175], a[252:255], a[20:23]
ds_read_b64_tr_b16 v[120:121], v27 offset:0
ds_read_b64_tr_b16 v[122:123], v27 offset:2048
buffer_load_dwordx4 a[204:207], v1, s[44:47], s25 offen offset:3072 sc1
M a[20:23], v[168:171], a[248:251], a[20:23]
ds_read_b64_tr_b16 v[124:125], v27 offset:4096
ds_read_b64_tr_b16 v[126:127], v27 offset:6144
M a[24:27], v[176:179], a[248:251], a[24:27]
s_sub_u32 s39, s39, 1
s_cmp_eq_u32 s39, 0
s_cselect_b32 s3, s64, s65
M a[24:27], v[180:183], a[252:255], a[24:27]
s_add_u32 s25, s25, s3
s_lshl_b32 s3, s3, 3
s_add_u32 s26, s26, s3
M a[28:31], v[188:191], a[252:255], a[28:31]
M a[28:31], v[184:187], a[248:251], a[28:31]
s_waitcnt vmcnt(24) lgkmcnt(0)
s_barrier
M a[0:3], v[96:99], a[128:131], a[0:3]
s_add_u32 m0, s41, 81920
s_nop 0
buffer_load_dwordx4 v2, s[48:51], s26 offen offset:0 lds
ds_read_b64_tr_b16 v[160:161], v24 offset:16384
ds_read_b64_tr_b16 v[162:163], v24 offset:18432
M a[0:3], v[100:103], a[132:135], a[0:3]
buffer_load_dwordx4 v3, s[48:51], s26 offen offset:1024 lds
M a[4:7], v[108:111], a[132:135], a[4:7]
ds_read_b64_tr_b16 v[164:165], v24 offset:20480
ds_read_b64_tr_b16 v[166:167], v24 offset:22528
M a[4:7], v[104:107], a[128:131], a[4:7]
buffer_load_dwordx4 v4, s[48:51], s26 offen offset:2048 lds
ds_read_b64_tr_b16 v[168:169], v25 offset:16384
ds_read_b64_tr_b16 v[170:171], v25 offset:18432
M a[8:11], v[112:115], a[128:131], a[8:11]
buffer_load_dwordx4 v5, s[48:51], s26 offen offset:3072 lds
M a[8:11], v[116:119], a[132:135], a[8:11]
ds_read_b64_tr_b16 v[172:173], v25 offset:20480
ds_read_b64_tr_b16 v[174:175], v25 offset:22528
M a[12:15], v[124:127], a[132:135], a[12:15]
buffer_load_dwordx4 a[208:211], v1, s[44:47], s25 offen offset:0 sc1
M a[12:15], v[120:123], a[128:131], a[12:15]
ds_read_b64_tr_b16 v[176:177], v26 offset:16384
ds_read_b64_tr_b16 v[178:179], v26 offset:18432
buffer_load_dwordx4 a[212:215], v1, s[44:47], s25 offen offset:1024 sc1
M a[16:19], v[96:99], a[136:139], a[16:19]
ds_read_b64_tr_b16 v[180:181], v26 offset:20480
ds_read_b64_tr_b16 v[182:183], v26 offset:22528
M a[16:19], v[100:103], a[140:143], a[16:19]
buffer_load_dwordx4 a[216:219], v1, s[44:47], s25 offen offset:2048 sc1
M a[20:23], v[108:111], a[140:143], a[20:23]
ds_read_b64_tr_b16 v[184:185], v27 offset:16384
ds_read_b64_tr_b16 v[186:187], v27 offset:18432
buffer_load_dwordx4 a[220:223], v1, s[44:47], s25 offen offset:3072 sc1
M a[20:23], v[104:107], a[136:139], a[20:23]
ds_read_b64_tr_b16 v[188:189], v27 offset:20480
ds_read_b64_tr_b16 v[190:191], v27 offset:22528
M a[24:27], v[112:115], a[136:139], a[24:27]
s_sub_u32 s39, s39, 1
s_cmp_eq_u32 s39, 0
s_cselect_b32 s3, s64, s65
M a[24:27], v[116:119], a[140:143], a[24:27]
s_add_u32 s25, s25, s3
s_lshl_b32 s3, s3, 3
s_add_u32 s26, s26, s3
M a[28:31], v[124:127], a[140:143], a[28:31]
M a[28:31], v[120:123], a[136:139], a[28:31]
s_waitcnt vmcnt(23) lgkmcnt(0)
s_barrier
M a[0:3], v[160:163], a[144:147], a[0:3]
s_add_u32 m0, s41, 98304
s_nop 0
buffer_load_dwordx4 v2, s[48:51], s26 offen offset:0 lds
ds_read_b64_tr_b16 v[96:97], v24 offset:32768
ds_read_b64_tr_b16 v[98:99], v24 offset:34816
M a[0:3], v[164:167], a[148:151], a[0:3]
buffer_load_dwordx4 v3, s[48:51], s26 offen offset:1024 lds
M a[4:7], v[172:175], a[148:151], a[4:7]
ds_read_b64_tr_b16 v[100:101], v24 offset:36864
ds_read_b64_tr_b16 v[102:103], v24 offset:38912
M a[4:7], v[168:171], a[144:147], a[4:7]
buffer_load_dwordx4 v4, s[48:51], s26 offen offset:2048 lds
ds_read_b64_tr_b16 v[104:105], v25 offset:32768
ds_read_b64_tr_b16 v[106:107], v25 offset:34816
M a[8:11], v[176:179], a[144:147], a[8:11]
buffer_load_dwordx4 v5, s[48:51], s26 offen offset:3072 lds
M a[8:11], v[180:183], a[148:151], a[8:11]
ds_read_b64_tr_b16 v[108:109], v25 offset:36864
ds_read_b64_tr_b16 v[110:111], v25 offset:38912
M a[12:15], v[188:191], a[148:151], a[12:15]
buffer_load_dwordx4 a[224:227], v1, s[44:47], s25 offen offset:0 sc1
M a[12:15], v[184:187], a[144:147], a[12:15]
ds_read_b64_tr_b16 v[112:113], v26 offset:32768
ds_read_b64_tr_b16 v[114:115], v26 offset:34816
buffer_load_dwordx4 a[228:231], v1, s[44:47], s25 offen offset:1024 sc1
M a[16:19], v[160:163], a[152:155], a[16:19]
ds_read_b64_tr_b16 v[116:117], v26 offset:36864
ds_read_b64_tr_b16 v[118:119], v26 offset:38912
M a[16:19], v[164:167], a[156:159], a[16:19]
buffer_load_dwordx4 a[232:235], v1, s[44:47], s25 offen offset:2048 sc1
M a[20:23], v[172:175], a[156:159], a[20:23]
ds_read_b64_tr_b16 v[120:121], v27 offset:32768
ds_read_b64_tr_b16 v[122:123], v27 offset:34816
buffer_load_dwordx4 a[236:239], v1, s[44:47], s25 offen offset:3072 sc1
M a[20:23], v[168:171], a[152:155], a[20:23]
ds_read_b64_tr_b16 v[124:125], v27 offset:36864
ds_read_b64_tr_b16 v[126:127], v27 offset:38912
M a[24:27], v[176:179], a[152:155], a[24:27]
s_sub_u32 s39, s39, 1
s_cmp_eq_u32 s39, 0
s_cselect_b32 s3, s64, s65
M a[24:27], v[180:183], a[156:159], a[24:27]
s_add_u32 s25, s25, s3
s_lshl_b32 s3, s3, 3
s_add_u32 s26, s26, s3
M a[28:31], v[188:191], a[156:159], a[28:31]
M a[28:31], v[184:187], a[152:155], a[28:31]
s_waitcnt vmcnt(25) lgkmcnt(0)
s_barrier
M a[0:3], v[96:99], a[160:163], a[0:3]
s_add_u32 m0, s41, 114688
s_nop 0
buffer_load_dwordx4 v2, s[48:51], s26 offen offset:0 lds
ds_read_b64_tr_b16 v[160:161], v24 offset:49152
ds_read_b64_tr_b16 v[162:163], v24 offset:51200
M a[0:3], v[100:103], a[164:167], a[0:3]
buffer_load_dwordx4 v3, s[48:51], s26 offen offset:1024 lds
M a[4:7], v[108:111], a[164:167], a[4:7]
ds_read_b64_tr_b16 v[164:165], v24 offset:53248
ds_read_b64_tr_b16 v[166:167], v24 offset:55296
M a[4:7], v[104:107], a[160:163], a[4:7]
buffer_load_dwordx4 v4, s[48:51], s26 offen offset:2048 lds
ds_read_b64_tr_b16 v[168:169], v25 offset:49152
ds_read_b64_tr_b16 v[170:171], v25 offset:51200
M a[8:11], v[112:115], a[160:163], a[8:11]
buffer_load_dwordx4 v5, s[48:51], s26 offen offset:3072 lds
M a[8:11], v[116:119], a[164:167], a[8:11]
ds_read_b64_tr_b16 v[172:173], v25 offset:53248
ds_read_b64_tr_b16 v[174:175], v25 offset:55296
M a[12:15], v[124:127], a[164:167], a[12:15]
buffer_load_dwordx4 a[240:243], v1, s[44:47], s25 offen offset:0 sc1
M a[12:15], v[120:123], a[160:163], a[12:15]
ds_read_b64_tr_b16 v[176:177], v26 offset:49152
ds_read_b64_tr_b16 v[178:179], v26 offset:51200
buffer_load_dwordx4 a[244:247], v1, s[44:47], s25 offen offset:1024 sc1
M a[16:19], v[96:99], a[168:171], a[16:19]
ds_read_b64_tr_b16 v[180:181], v26 offset:53248
ds_read_b64_tr_b16 v[182:183], v26 offset:55296
M a[16:19], v[100:103], a[172:175], a[16:19]
buffer_load_dwordx4 a[248:251], v1, s[44:47], s25 offen offset:2048 sc1
M a[20:23], v[108:111], a[172:175], a[20:23]
ds_read_b64_tr_b16 v[184:185], v27 offset:49152
ds_read_b64_tr_b16 v[186:187], v27 offset:51200
buffer_load_dwordx4 a[252:255], v1, s[44:47], s25 offen offset:3072 sc1
M a[20:23], v[104:107], a[168:171], a[20:23]
ds_read_b64_tr_b16 v[188:189], v27 offset:53248
ds_read_b64_tr_b16 v[190:191], v27 offset:55296
M a[24:27], v[112:115], a[168:171], a[24:27]
s_sub_u32 s39, s39, 1
s_cmp_eq_u32 s39, 0
s_cselect_b32 s3, s64, s65
M a[24:27], v[116:119], a[172:175], a[24:27]
s_add_u32 s25, s25, s3
s_lshl_b32 s3, s3, 3
s_add_u32 s26, s26, s3
M a[28:31], v[124:127], a[172:175], a[28:31]
M a[28:31], v[120:123], a[168:171], a[28:31]
s_waitcnt vmcnt(24) lgkmcnt(0)
s_barrier
M a[0:3], v[160:163], a[176:179], a[0:3]
s_add_u32 m0, s41, 0
s_nop 0
buffer_load_dwordx4 v2, s[48:51], s26 offen offset:0 lds
ds_read_b64_tr_b16 v[96:97], v16 offset:0
ds_read_b64_tr_b16 v[98:99], v16 offset:4096
M a[0:3], v[164:167], a[180:183], a[0:3]
buffer_load_dwordx4 v3, s[48:51], s26 offen offset:1024 lds
ds_read_b64_tr_b16 v[100:101], v16 offset:8192
ds_read_b64_tr_b16 v[102:103], v16 offset:12288
M a[4:7], v[172:175], a[180:183], a[4:7]
buffer_load_dwordx4 v4, s[48:51], s26 offen offset:2048 lds
ds_read_b64_tr_b16 v[104:105], v17 offset:0
ds_read_b64_tr_b16 v[106:107], v17 offset:4096
M a[4:7], v[168:171], a[176:179], a[4:7]
buffer_load_dwordx4 v5, s[48:51], s26 offen offset:3072 lds
ds_read_b64_tr_b16 v[108:109], v17 offset:8192
ds_read_b64_tr_b16 v[110:111], v17 offset:12288
M a[8:11], v[176:179], a[176:179], a[8:11]
buffer_load_dwordx4 a[128:131], v1, s[44:47], s25 offen offset:0 sc1
ds_read_b64_tr_b16 v[112:113], v18 offset:0
ds_read_b64_tr_b16 v[114:115], v18 offset:4096
M a[8:11], v[180:183], a[180:183], a[8:11]
buffer_load_dwordx4 a[132:135], v1, s[44:47], s25 offen offset:1024 sc1
ds_read_b64_tr_b16 v[116:117], v18 offset:8192
ds_read_b64_tr_b16 v[118:119], v18 offset:12288
M a[12:15], v[188:191], a[180:183], a[12:15]
buffer_load_dwordx4 a[136:139], v1, s[44:47], s25 offen offset:2048 sc1
M a[12:15], v[184:187], a[176:179], a[12:15]
ds_read_b64_tr_b16 v[120:121], v19 offset:0
ds_read_b64_tr_b16 v[122:123], v19 offset:4096
buffer_load_dwordx4 a[140:143], v1, s[44:47], s25 offen offset:3072 sc1
M a[16:19], v[160:163], a[184:187], a[16:19]
ds_read_b64_tr_b16 v[124:125], v19 offset:8192
ds_read_b64_tr_b16 v[126:127], v19 offset:12288
s_sub_u32 s39, s39, 1
s_cmp_eq_u32 s39, 0
s_cselect_b32 s3, s64, s65
M a[16:19], v[164:167], a[188:191], a[16:19]
ds_read_b64_tr_b16 v[128:129], v20 offset:0
ds_read_b64_tr_b16 v[130:131], v20 offset:4096
s_add_u32 s25, s25, s3
s_lshl_b32 s3, s3, 3
s_add_u32 s26, s26, s3
M a[20:23], v[172:175], a[188:191], a[20:23]
ds_read_b64_tr_b16 v[132:133], v20 offset:8192
ds_read_b64_tr_b16 v[134:135], v20 offset:12288
ds_read_b64_tr_b16 v[136:137], v21 offset:0
ds_read_b64_tr_b16 v[138:139], v21 offset:4096
M a[20:23], v[168:171], a[184:187], a[20:23]
ds_read_b64_tr_b16 v[140:141], v21 offset:8192
ds_read_b64_tr_b16 v[142:143], v21 offset:12288
ds_read_b64_tr_b16 v[144:145], v22 offset:0
ds_read_b64_tr_b16 v[146:147], v22 offset:4096
M a[24:27], v[176:179], a[184:187], a[24:27]
ds_read_b64_tr_b16 v[148:149], v22 offset:8192
ds_read_b64_tr_b16 v[150:151], v22 offset:12288
ds_read_b64_tr_b16 v[152:153], v23 offset:0
ds_read_b64_tr_b16 v[154:155], v23 offset:4096
M a[24:27], v[180:183], a[188:191], a[24:27]
ds_read_b64_tr_b16 v[156:157], v23 offset:8192
ds_read_b64_tr_b16 v[158:159], v23 offset:12288
M a[28:31], v[188:191], a[188:191], a[28:31]
M a[28:31], v[184:187], a[184:187], a[28:31]
s_waitcnt vmcnt(24) lgkmcnt(0)
s_barrier
M v[32:35], v[96:99], a[192:195], 0
s_add_u32 m0, s41, 16384
s_nop 0
buffer_load_dwordx4 v2, s[48:51], s26 offen offset:0 lds
M v[32:35], v[100:103], a[196:199], v[32:35]
ds_read_b64_tr_b16 v[160:161], v16 offset:16384
ds_read_b64_tr_b16 v[162:163], v16 offset:20480
M v[36:39], v[108:111], a[196:199], 0
buffer_load_dwordx4 v3, s[48:51], s26 offen offset:1024 lds
M v[36:39], v[104:107], a[192:195], v[36:39]
ds_read_b64_tr_b16 v[164:165], v16 offset:24576
ds_read_b64_tr_b16 v[166:167], v16 offset:28672
M v[40:43], v[112:115], a[192:195], 0
buffer_load_dwordx4 v4, s[48:51], s26 offen offset:2048 lds
M v[40:43], v[116:119], a[196:199], v[40:43]
ds_read_b64_tr_b16 v[168:169], v17 offset:16384
ds_read_b64_tr_b16 v[170:171], v17 offset:20480
M v[44:47], v[124:127], a[196:199], 0
buffer_load_dwordx4 v5, s[48:51], s26 offen offset:3072 lds
M v[44:47], v[120:123], a[192:195], v[44:47]
M v[48:51], v[128:131], a[192:195], 0
ds_read_b64_tr_b16 v[172:173], v17 offset:24576
ds_read_b64_tr_b16 v[174:175], v17 offset:28672
M v[48:51], v[132:135], a[196:199], v[48:51]
buffer_load_dwordx4 a[144:147], v1, s[44:47], s25 offen offset:0 sc1
M v[52:55], v[140:143], a[196:199], 0
ds_read_b64_tr_b16 v[176:177], v18 offset:16384
ds_read_b64_tr_b16 v[178:179], v18 offset:20480
M v[52:55], v[136:139], a[192:195], v[52:55]
buffer_load_dwordx4 a[148:151], v1, s[44:47], s25 offen offset:1024 sc1
M v[56:59], v[144:147], a[192:195], 0
ds_read_b64_tr_b16 v[180:181], v18 offset:24576
ds_read_b64_tr_b16 v[182:183], v18 offset:28672
M v[56:59], v[148:151], a[196:199], v[56:59]
buffer_load_dwordx4 a[152:155], v1, s[44:47], s25 offen offset:2048 sc1
M v[60:63], v[156:159], a[196:199], 0
M v[60:63], v[152:155], a[192:195], v[60:63]
ds_read_b64_tr_b16 v[184:185], v19 offset:16384
ds_read_b64_tr_b16 v[186:187], v19 offset:20480
M v[64:67], v[96:99], a[200:203], 0
buffer_load_dwordx4 a[156:159], v1, s[44:47], s25 offen offset:3072 sc1
M v[64:67], v[100:103], a[204:207], v[64:67]
ds_read_b64_tr_b16 v[188:189], v19 offset:24576
ds_read_b64_tr_b16 v[190:191], v19 offset:28672
M v[68:71], v[108:111], a[204:207], 0
s_sub_u32 s39, s39, 1
s_cmp_eq_u32 s39, 0
s_cselect_b32 s3, s64, s65
M v[68:71], v[104:107], a[200:203], v[68:71]
ds_read_b64_tr_b16 v[192:193], v20 offset:16384
ds_read_b64_tr_b16 v[194:195], v20 offset:20480
M v[72:75], v[112:115], a[200:203], 0
s_add_u32 s25, s25, s3
s_lshl_b32 s3, s3, 3
s_add_u32 s26, s26, s3
M v[72:75], v[116:119], a[204:207], v[72:75]
ds_read_b64_tr_b16 v[196:197], v20 offset:24576
ds_read_b64_tr_b16 v[198:199], v20 offset:28672
M v[76:79], v[124:127], a[204:207], 0
M v[76:79], v[120:123], a[200:203], v[76:79]
ds_read_b64_tr_b16 v[200:201], v21 offset:16384
ds_read_b64_tr_b16 v[202:203], v21 offset:20480
M v[80:83], v[128:131], a[200:203], 0
ds_read_b64_tr_b16 v[204:205], v21 offset:24576
ds_read_b64_tr_b16 v[206:207], v21 offset:28672
M v[80:83], v[132:135], a[204:207], v[80:83]
ds_read_b64_tr_b16 v[208:209], v22 offset:16384
ds_read_b64_tr_b16 v[210:211], v22 offset:20480
M v[84:87], v[140:143], a[204:207], 0
ds_read_b64_tr_b16 v[212:213], v22 offset:24576
ds_read_b64_tr_b16 v[214:215], v22 offset:28672
M v[84:87], v[136:139], a[200:203], v[84:87]
ds_read_b64_tr_b16 v[216:217], v23 offset:16384
ds_read_b64_tr_b16 v[218:219], v23 offset:20480
M v[88:91], v[144:147], a[200:203], 0
ds_read_b64_tr_b16 v[220:221], v23 offset:24576
ds_read_b64_tr_b16 v[222:223], v23 offset:28672
M v[88:91], v[148:151], a[204:207], v[88:91]
M v[92:95], v[156:159], a[204:207], 0
M v[92:95], v[152:155], a[200:203], v[92:95]
s_mov_b32 s28, 3
Lk3_la:
s_waitcnt vmcnt(24) lgkmcnt(0)
s_barrier
M v[32:35], v[160:163], a[208:211], v[32:35]
s_add_u32 m0, s41, 32768
s_nop 0
buffer_load_dwordx4 v2, s[48:51], s26 offen offset:0 lds
M v[32:35], v[164:167], a[212:215], v[32:35]
ds_read_b64_tr_b16 v[96:97], v16 offset:32768
ds_read_b64_tr_b16 v[98:99], v16 offset:36864
M v[36:39], v[172:175], a[212:215], v[36:39]
buffer_load_dwordx4 v3, s[48:51], s26 offen offset:1024 lds
M v[36:39], v[168:171], a[208:211], v[36:39]
ds_read_b64_tr_b16 v[100:101], v16 offset:40960
ds_read_b64_tr_b16 v[102:103], v16 offset:45056
M v[40:43], v[176:179], a[208:211], v[40:43]
buffer_load_dwordx4 v4, s[48:51], s26 offen offset:2048 lds
M v[40:43], v[180:183], a[212:215], v[40:43]
ds_read_b64_tr_b16 v[104:105], v17 offset:32768
ds_read_b64_tr_b16 v[106:107], v17 offset:36864
M v[44:47], v[188:191], a[212:215], v[44:47]
buffer_load_dwordx4 v5, s[48:51], s26 offen offset:3072 lds
M v[44:47], v[184:187], a[208:211], v[44:47]
M v[48:51], v[192:195], a[208:211], v[48:51]
ds_read_b64_tr_b16 v[108:109], v17 offset:40960
ds_read_b64_tr_b16 v[110:111], v17 offset:45056
M v[48:51], v[196:199], a[212:215], v[48:51]
buffer_load_dwordx4 a[160:163], v1, s[44:47], s25 offen offset:0 sc1
M v[52:55], v[204:207], a[212:215], v[52:55]
ds_read_b64_tr_b16 v[112:113], v18 offset:32768
ds_read_b64_tr_b16 v[114:115], v18 offset:36864
M v[52:55], v[200:203], a[208:211], v[52:55]
buffer_load_dwordx4 a[164:167], v1, s[44:47], s25 offen offset:1024 sc1
M v[56:59], v[208:211], a[208:211], v[56:59]
ds_read_b64_tr_b16 v[116:117], v18 offset:40960
ds_read_b64_tr_b16 v[118:119], v18 offset:45056
M v[56:59], v[212:215], a[212:215], v[56:59]
buffer_load_dwordx4 a[168:171], v1, s[44:47], s25 offen offset:2048 sc1
M v[60:63], v[220:223], a[212:215], v[60:63]
M v[60:63], v[216:219], a[208:211], v[60:63]
ds_read_b64_tr_b16 v[120:121], v19 offset:32768
ds_read_b64_tr_b16 v[122:123], v19 offset:36864
M v[64:67], v[160:163], a[216:219], v[64:67]
buffer_load_dwordx4 a[172:175], v1, s[44:47], s25 offen offset:3072 sc1
M v[64:67], v[164:167], a[220:223], v[64:67]
ds_read_b64_tr_b16 v[124:125], v19 offset:40960
ds_read_b64_tr_b16 v[126:127], v19 offset:45056
M v[68:71], v[172:175], a[220:223], v[68:71]
s_sub_u32 s39, s39, 1
s_cmp_eq_u32 s39, 0
s_cselect_b32 s3, s64, s65
M v[68:71], v[168:171], a[216:219], v[68:71]
ds_read_b64_tr_b16 v[128:129], v20 offset:32768
ds_read_b64_tr_b16 v[130:131], v20 offset:36864
M v[72:75], v[176:179], a[216:219], v[72:75]
s_add_u32 s25, s25, s3
s_lshl_b32 s3, s3, 3
s_add_u32 s26, s26, s3
M v[72:75], v[180:183], a[220:223], v[72:75]
ds_read_b64_tr_b16 v[132:133], v20 offset:40960
ds_read_b64_tr_b16 v[134:135], v20 offset:45056
M v[76:79], v[188:191], a[220:223], v[76:79]
M v[76:79], v[184:187], a[216:219], v[76:79]
ds_read_b64_tr_b16 v[136:137], v21 offset:32768
ds_read_b64_tr_b16 v[138:139], v21 offset:36864
M v[80:83], v[192:195], a[216:219], v[80:83]
ds_read_b64_tr_b16 v[140:141], v21 offset:40960
ds_read_b64_tr_b16 v[142:143], v21 offset:45056
M v[80:83], v[196:199], a[220:223], v[80:83]
ds_read_b64_tr_b16 v[144:145], v22 offset:32768
ds_read_b64_tr_b16 v[146:147], v22 offset:36864
M v[84:87], v[204:207], a[220:223], v[84:87]
ds_read_b64_tr_b16 v[148:149], v22 offset:40960
ds_read_b64_tr_b16 v[150:151], v22 offset:45056
M v[84:87], v[200:203], a[216:219], v[84:87]
ds_read_b64_tr_b16 v[152:153], v23 offset:32768
ds_read_b64_tr_b16 v[154:155], v23 offset:36864
M v[88:91], v[208:211], a[216:219], v[88:91]
ds_read_b64_tr_b16 v[156:157], v23 offset:40960
ds_read_b64_tr_b16 v[158:159], v23 offset:45056
M v[88:91], v[212:215], a[220:223], v[88:91]
M v[92:95], v[220:223], a[220:223], v[92:95]
M v[92:95], v[216:219], a[216:219], v[92:95]
s_waitcnt vmcnt(24) lgkmcnt(0)
s_barrier
M v[32:35], v[96:99], a[224:227], v[32:35]
s_add_u32 m0, s41, 49152
s_nop 0
buffer_load_dwordx4 v2, s[48:51], s26 offen offset:0 lds
M v[32:35], v[100:103], a[228:231], v[32:35]
ds_read_b64_tr_b16 v[160:161], v16 offset:49152
ds_read_b64_tr_b16 v[162:163], v16 offset:53248
M v[36:39], v[108:111], a[228:231], v[36:39]
buffer_load_dwordx4 v3, s[48:51], s26 offen offset:1024 lds
M v[36:39], v[104:107], a[224:227], v[36:39]
ds_read_b64_tr_b16 v[164:165], v16 offset:57344
ds_read_b64_tr_b16 v[166:167], v16 offset:61440
M v[40:43], v[112:115], a[224:227], v[40:43]
buffer_load_dwordx4 v4, s[48:51], s26 offen offset:2048 lds
M v[40:43], v[116:119], a[228:231], v[40:43]
ds_read_b64_tr_b16 v[168:169], v17 offset:49152
ds_read_b64_tr_b16 v[170:171], v17 offset:53248
M v[44:47], v[124:127], a[228:231], v[44:47]
buffer_load_dwordx4 v5, s[48:51], s26 offen offset:3072 lds
M v[44:47], v[120:123], a[224:227], v[44:47]
M v[48:51], v[128:131], a[224:227], v[48:51]
ds_read_b64_tr_b16 v[172:173], v17 offset:57344
ds_read_b64_tr_b16 v[174:175], v17 offset:61440
M v[48:51], v[132:135], a[228:231], v[48:51]
buffer_load_dwordx4 a[176:179], v1, s[44:47], s25 offen offset:0 sc1
M v[52:55], v[140:143], a[228:231], v[52:55]
ds_read_b64_tr_b16 v[176:177], v18 offset:49152
ds_read_b64_tr_b16 v[178:179], v18 offset:53248
M v[52:55], v[136:139], a[224:227], v[52:55]
buffer_load_dwordx4 a[180:183], v1, s[44:47], s25 offen offset:1024 sc1
M v[56:59], v[144:147], a[224:227], v[56:59]
ds_read_b64_tr_b16 v[180:181], v18 offset:57344
ds_read_b64_tr_b16 v[182:183], v18 offset:61440
M v[56:59], v[148:151], a[228:231], v[56:59]
buffer_load_dwordx4 a[184:187], v1, s[44:47], s25 offen offset:2048 sc1
M v[60:63], v[156:159], a[228:231], v[60:63]
M v[60:63], v[152:155], a[224:227], v[60:63]
ds_read_b64_tr_b16 v[184:185], v19 offset:49152
ds_read_b64_tr_b16 v[186:187], v19 offset:53248
M v[64:67], v[96:99], a[232:235], v[64:67]
buffer_load_dwordx4 a[188:191], v1, s[44:47], s25 offen offset:3072 sc1
M v[64:67], v[100:103], a[236:239], v[64:67]
ds_read_b64_tr_b16 v[188:189], v19 offset:57344
ds_read_b64_tr_b16 v[190:191], v19 offset:61440
M v[68:71], v[108:111], a[236:239], v[68:71]
s_sub_u32 s39, s39, 1
s_cmp_eq_u32 s39, 0
s_cselect_b32 s3, s64, s65
M v[68:71], v[104:107], a[232:235], v[68:71]
ds_read_b64_tr_b16 v[192:193], v20 offset:49152
ds_read_b64_tr_b16 v[194:195], v20 offset:53248
M v[72:75], v[112:115], a[232:235], v[72:75]
s_add_u32 s25, s25, s3
s_lshl_b32 s3, s3, 3
s_add_u32 s26, s26, s3
M v[72:75], v[116:119], a[236:239], v[72:75]
ds_read_b64_tr_b16 v[196:197], v20 offset:57344
ds_read_b64_tr_b16 v[198:199], v20 offset:61440
M v[76:79], v[124:127], a[236:239], v[76:79]
M v[76:79], v[120:123], a[232:235], v[76:79]
ds_read_b64_tr_b16 v[200:201], v21 offset:49152
ds_read_b64_tr_b16 v[202:203], v21 offset:53248
M v[80:83], v[128:131], a[232:235], v[80:83]
ds_read_b64_tr_b16 v[204:205], v21 offset:57344
ds_read_b64_tr_b16 v[206:207], v21 offset:61440
M v[80:83], v[132:135], a[236:239], v[80:83]
ds_read_b64_tr_b16 v[208:209], v22 offset:49152
ds_read_b64_tr_b16 v[210:211], v22 offset:53248
M v[84:87], v[140:143], a[236:239], v[84:87]
ds_read_b64_tr_b16 v[212:213], v22 offset:57344
ds_read_b64_tr_b16 v[214:215], v22 offset:61440
M v[84:87], v[136:139], a[232:235], v[84:87]
ds_read_b64_tr_b16 v[216:217], v23 offset:49152
ds_read_b64_tr_b16 v[218:219], v23 offset:53248
M v[88:91], v[144:147], a[232:235], v[88:91]
ds_read_b64_tr_b16 v[220:221], v23 offset:57344
ds_read_b64_tr_b16 v[222:223], v23 offset:61440
M v[88:91], v[148:151], a[236:239], v[88:91]
M v[92:95], v[156:159], a[236:239], v[92:95]
M v[92:95], v[152:155], a[232:235], v[92:95]
s_waitcnt vmcnt(24) lgkmcnt(0)
s_barrier
M v[32:35], v[160:163], a[240:243], v[32:35]
s_add_u32 m0, s41, 65536
s_nop 0
buffer_load_dwordx4 v2, s[48:51], s26 offen offset:0 lds
M v[32:35], v[164:167], a[244:247], v[32:35]
ds_read_b64_tr_b16 v[96:97], v8 offset:0
ds_read_b64_tr_b16 v[98:99], v8 offset:4096
M v[36:39], v[172:175], a[244:247], v[36:39]
buffer_load_dwordx4 v3, s[48:51], s26 offen offset:1024 lds
M v[36:39], v[168:171], a[240:243], v[36:39]
ds_read_b64_tr_b16 v[100:101], v8 offset:8192
ds_read_b64_tr_b16 v[102:103], v8 offset:12288
M v[40:43], v[176:179], a[240:243], v[40:43]
buffer_load_dwordx4 v4, s[48:51], s26 offen offset:2048 lds
M v[40:43], v[180:183], a[244:247], v[40:43]
ds_read_b64_tr_b16 v[104:105], v9 offset:0
ds_read_b64_tr_b16 v[106:107], v9 offset:4096
M v[44:47], v[188:191], a[244:247], v[44:47]
buffer_load_dwordx4 v5, s[48:51], s26 offen offset:3072 lds
M v[44:47], v[184:187], a[240:243], v[44:47]
M v[48:51], v[192:195], a[240:243], v[48:51]
ds_read_b64_tr_b16 v[108:109], v9 offset:8192
ds_read_b64_tr_b16 v[110:111], v9 offset:12288
M v[48:51], v[196:199], a[244:247], v[48:51]
buffer_load_dwordx4 a[192:195], v1, s[44:47], s25 offen offset:0 sc1
M v[52:55], v[204:207], a[244:247], v[52:55]
ds_read_b64_tr_b16 v[112:113], v10 offset:0
ds_read_b64_tr_b16 v[114:115], v10 offset:4096
M v[52:55], v[200:203], a[240:243], v[52:55]
buffer_load_dwordx4 a[196:199], v1, s[44:47], s25 offen offset:1024 sc1
M v[56:59], v[208:211], a[240:243], v[56:59]
ds_read_b64_tr_b16 v[116:117], v10 offset:8192
ds_read_b64_tr_b16 v[118:119], v10 offset:12288
M v[56:59], v[212:215], a[244:247], v[56:59]
buffer_load_dwordx4 a[200:203], v1, s[44:47], s25 offen offset:2048 sc1
M v[60:63], v[220:223], a[244:247], v[60:63]
M v[60:63], v[216:219], a[240:243], v[60:63]
ds_read_b64_tr_b16 v[120:121], v11 offset:0
ds_read_b64_tr_b16 v[122:123], v11 offset:4096
M v[64:67], v[160:163], a[248:251], v[64:67]
buffer_load_dwordx4 a[204:207], v1, s[44:47], s25 offen offset:3072 sc1
M v[64:67], v[164:167], a[252:255], v[64:67]
ds_read_b64_tr_b16 v[124:125], v11 offset:8192
ds_read_b64_tr_b16 v[126:127], v11 offset:12288
M v[68:71], v[172:175], a[252:255], v[68:71]
s_sub_u32 s39, s39, 1
s_cmp_eq_u32 s39, 0
s_cselect_b32 s3, s64, s65
M v[68:71], v[168:171], a[248:251], v[68:71]
ds_read_b64_tr_b16 v[128:129], v12 offset:0
ds_read_b64_tr_b16 v[130:131], v12 offset:4096
M v[72:75], v[176:179], a[248:251], v[72:75]
s_add_u32 s25, s25, s3
s_lshl_b32 s3, s3, 3
s_add_u32 s26, s26, s3
M v[72:75], v[180:183], a[252:255], v[72:75]
ds_read_b64_tr_b16 v[132:133], v12 offset:8192
ds_read_b64_tr_b16 v[134:135], v12 offset:12288
M v[76:79], v[188:191], a[252:255], v[76:79]
M v[76:79], v[184:187], a[248:251], v[76:79]
ds_read_b64_tr_b16 v[136:137], v13 offset:0
ds_read_b64_tr_b16 v[138:139], v13 offset:4096
M v[80:83], v[192:195], a[248:251], v[80:83]
ds_read_b64_tr_b16 v[140:141], v13 offset:8192
ds_read_b64_tr_b16 v[142:143], v13 offset:12288
M v[80:83], v[196:199], a[252:255], v[80:83]
ds_read_b64_tr_b16 v[144:145], v14 offset:0
ds_read_b64_tr_b16 v[146:147], v14 offset:4096
M v[84:87], v[204:207], a[252:255], v[84:87]
ds_read_b64_tr_b16 v[148:149], v14 offset:8192
ds_read_b64_tr_b16 v[150:151], v14 offset:12288
M v[84:87], v[200:203], a[248:251], v[84:87]
ds_read_b64_tr_b16 v[152:153], v15 offset:0
ds_read_b64_tr_b16 v[154:155], v15 offset:4096
M v[88:91], v[208:211], a[248:251], v[88:91]
ds_read_b64_tr_b16 v[156:157], v15 offset:8192
ds_read_b64_tr_b16 v[158:159], v15 offset:12288
M v[88:91], v[212:215], a[252:255], v[88:91]
M v[92:95], v[220:223], a[252:255], v[92:95]
M v[92:95], v[216:219], a[248:251], v[92:95]
s_waitcnt vmcnt(24) lgkmcnt(0)
s_barrier
M v[32:35], v[96:99], a[128:131], v[32:35]
s_add_u32 m0, s41, 81920
s_nop 0
buffer_load_dwordx4 v2, s[48:51], s26 offen offset:0 lds
M v[32:35], v[100:103], a[132:135], v[32:35]
ds_read_b64_tr_b16 v[160:161], v8 offset:16384
ds_read_b64_tr_b16 v[162:163], v8 offset:20480
M v[36:39], v[108:111], a[132:135], v[36:39]
buffer_load_dwordx4 v3, s[48:51], s26 offen offset:1024 lds
M v[36:39], v[104:107], a[128:131], v[36:39]
ds_read_b64_tr_b16 v[164:165], v8 offset:24576
ds_read_b64_tr_b16 v[166:167], v8 offset:28672
M v[40:43], v[112:115], a[128:131], v[40:43]
buffer_load_dwordx4 v4, s[48:51], s26 offen offset:2048 lds
M v[40:43], v[116:119], a[132:135], v[40:43]
ds_read_b64_tr_b16 v[168:169], v9 offset:16384
ds_read_b64_tr_b16 v[170:171], v9 offset:20480
M v[44:47], v[124:127], a[132:135], v[44:47]
buffer_load_dwordx4 v5, s[48:51], s26 offen offset:3072 lds
M v[44:47], v[120:123], a[128:131], v[44:47]
M v[48:51], v[128:131], a[128:131], v[48:51]
ds_read_b64_tr_b16 v[172:173], v9 offset:24576
ds_read_b64_tr_b16 v[174:175], v9 offset:28672
M v[48:51], v[132:135], a[132:135], v[48:51]
buffer_load_dwordx4 a[208:211], v1, s[44:47], s25 offen offset:0 sc1
M v[52:55], v[140:143], a[132:135], v[52:55]
ds_read_b64_tr_b16 v[176:177], v10 offset:16384
ds_read_b64_tr_b16 v[178:179], v10 offset:20480
M v[52:55], v[136:139], a[128:131], v[52:55]
buffer_load_dwordx4 a[212:215], v1, s[44:47], s25 offen offset:1024 sc1
M v[56:59], v[144:147], a[128:131], v[56:59]
ds_read_b64_tr_b16 v[180:181], v10 offset:24576
ds_read_b64_tr_b16 v[182:183], v10 offset:28672
M v[56:59], v[148:151], a[132:135], v[56:59]
buffer_load_dwordx4 a[216:219], v1, s[44:47], s25 offen offset:2048 sc1
M v[60:63], v[156:159], a[132:135], v[60:63]
M v[60:63], v[152:155], a[128:131], v[60:63]
ds_read_b64_tr_b16 v[184:185], v11 offset:16384
ds_read_b64_tr_b16 v[186:187], v11 offset:20480
M v[64:67], v[96:99], a[136:139], v[64:67]
buffer_load_dwordx4 a[220:223], v1, s[44:47], s25 offen offset:3072 sc1
M v[64:67], v[100:103], a[140:143], v[64:67]
ds_read_b64_tr_b16 v[188:189], v11 offset:24576
ds_read_b64_tr_b16 v[190:191], v11 offset:28672
M v[68:71], v[108:111], a[140:143], v[68:71]
s_sub_u32 s39, s39, 1
s_cmp_eq_u32 s39, 0
s_cselect_b32 s3, s64, s65
M v[68:71], v[104:107], a[136:139], v[68:71]
ds_read_b64_tr_b16 v[192:193], v12 offset:16384
ds_read_b64_tr_b16 v[194:195], v12 offset:20480
M v[72:75], v[112:115], a[136:139], v[72:75]
s_add_u32 s25, s25, s3
s_lshl_b32 s3, s3, 3
s_add_u32 s26, s26, s3
M v[72:75], v[116:119], a[140:143], v[72:75]
ds_read_b64_tr_b16 v[196:197], v12 offset:24576
ds_read_b64_tr_b16 v[198:199], v12 offset:28672
M v[76:79], v[124:127], a[140:143], v[76:79]
M v[76:79], v[120:123], a[136:139], v[76:79]
ds_read_b64_tr_b16 v[200:201], v13 offset:16384
ds_read_b64_tr_b16 v[202:203], v13 offset:20480
M v[80:83], v[128:131], a[136:139], v[80:83]
ds_read_b64_tr_b16 v[204:205], v13 offset:24576
ds_read_b64_tr_b16 v[206:207], v13 offset:28672
M v[80:83], v[132:135], a[140:143], v[80:83]
ds_read_b64_tr_b16 v[208:209], v14 offset:16384
ds_read_b64_tr_b16 v[210:211], v14 offset:20480
M v[84:87], v[140:143], a[140:143], v[84:87]
ds_read_b64_tr_b16 v[212:213], v14 offset:24576
ds_read_b64_tr_b16 v[214:215], v14 offset:28672
M v[84:87], v[136:139], a[136:139], v[84:87]
ds_read_b64_tr_b16 v[216:217], v15 offset:16384
ds_read_b64_tr_b16 v[218:219], v15 offset:20480
M v[88:91], v[144:147], a[136:139], v[88:91]
ds_read_b64_tr_b16 v[220:221], v15 offset:24576
ds_read_b64_tr_b16 v[222:223], v15 offset:28672
M v[88:91], v[148:151], a[140:143], v[88:91]
M v[92:95], v[156:159], a[140:143], v[92:95]
M v[92:95], v[152:155], a[136:139], v[92:95]
s_waitcnt vmcnt(24) lgkmcnt(0)
s_barrier
M v[32:35], v[160:163], a[144:147], v[32:35]
s_add_u32 m0, s41, 98304
s_nop 0
buffer_load_dwordx4 v2, s[48:51], s26 offen offset:0 lds
M v[32:35], v[164:167], a[148:151], v[32:35]
ds_read_b64_tr_b16 v[96:97], v8 offset:32768
ds_read_b64_tr_b16 v[98:99], v8 offset:36864
M v[36:39], v[172:175], a[148:151], v[36:39]
buffer_load_dwordx4 v3, s[48:51], s26 offen offset:1024 lds
M v[36:39], v[168:171], a[144:147], v[36:39]
ds_read_b64_tr_b16 v[100:101], v8 offset:40960
ds_read_b64_tr_b16 v[102:103], v8 offset:45056
M v[40:43], v[176:179], a[144:147], v[40:43]
buffer_load_dwordx4 v4, s[48:51], s26 offen offset:2048 lds
M v[40:43], v[180:183], a[148:151], v[40:43]
ds_read_b64_tr_b16 v[104:105], v9 offset:32768
ds_read_b64_tr_b16 v[106:107], v9 offset:36864
M v[44:47], v[188:191], a[148:151], v[44:47]
buffer_load_dwordx4 v5, s[48:51], s26 offen offset:3072 lds
M v[44:47], v[184:187], a[144:147], v[44:47]
M v[48:51], v[192:195], a[144:147], v[48:51]
ds_read_b64_tr_b16 v[108:109], v9 offset:40960
ds_read_b64_tr_b16 v[110:111], v9 offset:45056
M v[48:51], v[196:199], a[148:151], v[48:51]
buffer_load_dwordx4 a[224:227], v1, s[44:47], s25 offen offset:0 sc1
M v[52:55], v[204:207], a[148:151], v[52:55]
ds_read_b64_tr_b16 v[112:113], v10 offset:32768
ds_read_b64_tr_b16 v[114:115], v10 offset:36864
M v[52:55], v[200:203], a[144:147], v[52:55]
buffer_load_dwordx4 a[228:231], v1, s[44:47], s25 offen offset:1024 sc1
M v[56:59], v[208:211], a[144:147], v[56:59]
ds_read_b64_tr_b16 v[116:117], v10 offset:40960
ds_read_b64_tr_b16 v[118:119], v10 offset:45056
M v[56:59], v[212:215], a[148:151], v[56:59]
buffer_load_dwordx4 a[232:235], v1, s[44:47], s25 offen offset:2048 sc1
M v[60:63], v[220:223], a[148:151], v[60:63]
M v[60:63], v[216:219], a[144:147], v[60:63]
ds_read_b64_tr_b16 v[120:121], v11 offset:32768
ds_read_b64_tr_b16 v[122:123], v11 offset:36864
M v[64:67], v[160:163], a[152:155], v[64:67]
buffer_load_dwordx4 a[236:239], v1, s[44:47], s25 offen offset:3072 sc1
M v[64:67], v[164:167], a[156:159], v[64:67]
ds_read_b64_tr_b16 v[124:125], v11 offset:40960
ds_read_b64_tr_b16 v[126:127], v11 offset:45056
M v[68:71], v[172:175], a[156:159], v[68:71]
s_sub_u32 s39, s39, 1
s_cmp_eq_u32 s39, 0
s_cselect_b32 s3, s64, s65
M v[68:71], v[168:171], a[152:155], v[68:71]
ds_read_b64_tr_b16 v[128:129], v12 offset:32768
ds_read_b64_tr_b16 v[130:131], v12 offset:36864
M v[72:75], v[176:179], a[152:155], v[72:75]
s_add_u32 s25, s25, s3
s_lshl_b32 s3, s3, 3
s_add_u32 s26, s26, s3
M v[72:75], v[180:183], a[156:159], v[72:75]
ds_read_b64_tr_b16 v[132:133], v12 offset:40960
ds_read_b64_tr_b16 v[134:135], v12 offset:45056
M v[76:79], v[188:191], a[156:159], v[76:79]
M v[76:79], v[184:187], a[152:155], v[76:79]
ds_read_b64_tr_b16 v[136:137], v13 offset:32768
ds_read_b64_tr_b16 v[138:139], v13 offset:36864
M v[80:83], v[192:195], a[152:155], v[80:83]
ds_read_b64_tr_b16 v[140:141], v13 offset:40960
ds_read_b64_tr_b16 v[142:143], v13 offset:45056
M v[80:83], v[196:199], a[156:159], v[80:83]
ds_read_b64_tr_b16 v[144:145], v14 offset:32768
ds_read_b64_tr_b16 v[146:147], v14 offset:36864
M v[84:87], v[204:207], a[156:159], v[84:87]
ds_read_b64_tr_b16 v[148:149], v14 offset:40960
ds_read_b64_tr_b16 v[150:151], v14 offset:45056
M v[84:87], v[200:203], a[152:155], v[84:87]
ds_read_b64_tr_b16 v[152:153], v15 offset:32768
ds_read_b64_tr_b16 v[154:155], v15 offset:36864
M v[88:91], v[208:211], a[152:155], v[88:91]
ds_read_b64_tr_b16 v[156:157], v15 offset:40960
ds_read_b64_tr_b16 v[158:159], v15 offset:45056
M v[88:91], v[212:215], a[156:159], v[88:91]
M v[92:95], v[220:223], a[156:159], v[92:95]
M v[92:95], v[216:219], a[152:155], v[92:95]
s_waitcnt vmcnt(24) lgkmcnt(0)
s_barrier
M v[32:35], v[96:99], a[160:163], v[32:35]
s_add_u32 m0, s41, 114688
s_nop 0
buffer_load_dwordx4 v2, s[48:51], s26 offen offset:0 lds
M v[32:35], v[100:103], a[164:167], v[32:35]
ds_read_b64_tr_b16 v[160:161], v8 offset:49152
ds_read_b64_tr_b16 v[162:163], v8 offset:53248
M v[36:39], v[108:111], a[164:167], v[36:39]
buffer_load_dwordx4 v3, s[48:51], s26 offen offset:1024 lds
M v[36:39], v[104:107], a[160:163], v[36:39]
ds_read_b64_tr_b16 v[164:165], v8 offset:57344
ds_read_b64_tr_b16 v[166:167], v8 offset:61440
M v[40:43], v[112:115], a[160:163], v[40:43]
buffer_load_dwordx4 v4, s[48:51], s26 offen offset:2048 lds
M v[40:43], v[116:119], a[164:167], v[40:43]
ds_read_b64_tr_b16 v[168:169], v9 offset:49152
ds_read_b64_tr_b16 v[170:171], v9 offset:53248
M v[44:47], v[124:127], a[164:167], v[44:47]
buffer_load_dwordx4 v5, s[48:51], s26 offen offset:3072 lds
M v[44:47], v[120:123], a[160:163], v[44:47]
M v[48:51], v[128:131], a[160:163], v[48:51]
ds_read_b64_tr_b16 v[172:173], v9 offset:57344
ds_read_b64_tr_b16 v[174:175], v9 offset:61440
M v[48:51], v[132:135], a[164:167], v[48:51]
buffer_load_dwordx4 a[240:243], v1, s[44:47], s25 offen offset:0 sc1
M v[52:55], v[140:143], a[164:167], v[52:55]
ds_read_b64_tr_b16 v[176:177], v10 offset:49152
ds_read_b64_tr_b16 v[178:179], v10 offset:53248
M v[52:55], v[136:139], a[160:163], v[52:55]
buffer_load_dwordx4 a[244:247], v1, s[44:47], s25 offen offset:1024 sc1
M v[56:59], v[144:147], a[160:163], v[56:59]
ds_read_b64_tr_b16 v[180:181], v10 offset:57344
ds_read_b64_tr_b16 v[182:183], v10 offset:61440
M v[56:59], v[148:151], a[164:167], v[56:59]
buffer_load_dwordx4 a[248:251], v1, s[44:47], s25 offen offset:2048 sc1
M v[60:63], v[156:159], a[164:167], v[60:63]
M v[60:63], v[152:155], a[160:163], v[60:63]
ds_read_b64_tr_b16 v[184:185], v11 offset:49152
ds_read_b64_tr_b16 v[186:187], v11 offset:53248
M v[64:67], v[96:99], a[168:171], v[64:67]
buffer_load_dwordx4 a[252:255], v1, s[44:47], s25 offen offset:3072 sc1
M v[64:67], v[100:103], a[172:175], v[64:67]
ds_read_b64_tr_b16 v[188:189], v11 offset:57344
ds_read_b64_tr_b16 v[190:191], v11 offset:61440
M v[68:71], v[108:111], a[172:175], v[68:71]
s_sub_u32 s39, s39, 1
s_cmp_eq_u32 s39, 0
s_cselect_b32 s3, s64, s65
M v[68:71], v[104:107], a[168:171], v[68:71]
ds_read_b64_tr_b16 v[192:193], v12 offset:49152
ds_read_b64_tr_b16 v[194:195], v12 offset:53248
M v[72:75], v[112:115], a[168:171], v[72:75]
s_add_u32 s25, s25, s3
s_lshl_b32 s3, s3, 3
s_add_u32 s26, s26, s3
M v[72:75], v[116:119], a[172:175], v[72:75]
ds_read_b64_tr_b16 v[196:197], v12 offset:57344
ds_read_b64_tr_b16 v[198:199], v12 offset:61440
M v[76:79], v[124:127], a[172:175], v[76:79]
M v[76:79], v[120:123], a[168:171], v[76:79]
ds_read_b64_tr_b16 v[200:201], v13 offset:49152
ds_read_b64_tr_b16 v[202:203], v13 offset:53248
M v[80:83], v[128:131], a[168:171], v[80:83]
ds_read_b64_tr_b16 v[204:205], v13 offset:57344
ds_read_b64_tr_b16 v[206:207], v13 offset:61440
M v[80:83], v[132:135], a[172:175], v[80:83]
ds_read_b64_tr_b16 v[208:209], v14 offset:49152
ds_read_b64_tr_b16 v[210:211], v14 offset:53248
M v[84:87], v[140:143], a[172:175], v[84:87]
ds_read_b64_tr_b16 v[212:213], v14 offset:57344
ds_read_b64_tr_b16 v[214:215], v14 offset:61440
M v[84:87], v[136:139], a[168:171], v[84:87]
ds_read_b64_tr_b16 v[216:217], v15 offset:49152
ds_read_b64_tr_b16 v[218:219], v15 offset:53248
M v[88:91], v[144:147], a[168:171], v[88:91]
ds_read_b64_tr_b16 v[220:221], v15 offset:57344
ds_read_b64_tr_b16 v[222:223], v15 offset:61440
M v[88:91], v[148:151], a[172:175], v[88:91]
M v[92:95], v[156:159], a[172:175], v[92:95]
M v[92:95], v[152:155], a[168:171], v[92:95]
s_waitcnt vmcnt(24) lgkmcnt(0)
s_barrier
M v[32:35], v[160:163], a[176:179], v[32:35]
s_add_u32 m0, s41, 0
s_nop 0
buffer_load_dwordx4 v2, s[48:51], s26 offen offset:0 lds
M v[32:35], v[164:167], a[180:183], v[32:35]
ds_read_b64_tr_b16 v[96:97], v16 offset:0
ds_read_b64_tr_b16 v[98:99], v16 offset:4096
M v[36:39], v[172:175], a[180:183], v[36:39]
buffer_load_dwordx4 v3, s[48:51], s26 offen offset:1024 lds
M v[36:39], v[168:171], a[176:179], v[36:39]
ds_read_b64_tr_b16 v[100:101], v16 offset:8192
ds_read_b64_tr_b16 v[102:103], v16 offset:12288
M v[40:43], v[176:179], a[176:179], v[40:43]
buffer_load_dwordx4 v4, s[48:51], s26 offen offset:2048 lds
M v[40:43], v[180:183], a[180:183], v[40:43]
ds_read_b64_tr_b16 v[104:105], v17 offset:0
ds_read_b64_tr_b16 v[106:107], v17 offset:4096
M v[44:47], v[188:191], a[180:183], v[44:47]
buffer_load_dwordx4 v5, s[48:51], s26 offen offset:3072 lds
M v[44:47], v[184:187], a[176:179], v[44:47]
M v[48:51], v[192:195], a[176:179], v[48:51]
ds_read_b64_tr_b16 v[108:109], v17 offset:8192
ds_read_b64_tr_b16 v[110:111], v17 offset:12288
M v[48:51], v[196:199], a[180:183], v[48:51]
buffer_load_dwordx4 a[128:131], v1, s[44:47], s25 offen offset:0 sc1
M v[52:55], v[204:207], a[180:183], v[52:55]
ds_read_b64_tr_b16 v[112:113], v18 offset:0
ds_read_b64_tr_b16 v[114:115], v18 offset:4096
M v[52:55], v[200:203], a[176:179], v[52:55]
buffer_load_dwordx4 a[132:135], v1, s[44:47], s25 offen offset:1024 sc1
M v[56:59], v[208:211], a[176:179], v[56:59]
ds_read_b64_tr_b16 v[116:117], v18 offset:8192
ds_read_b64_tr_b16 v[118:119], v18 offset:12288
M v[56:59], v[212:215], a[180:183], v[56:59]
buffer_load_dwordx4 a[136:139], v1, s[44:47], s25 offen offset:2048 sc1
M v[60:63], v[220:223], a[180:183], v[60:63]
M v[60:63], v[216:219], a[176:179], v[60:63]
ds_read_b64_tr_b16 v[120:121], v19 offset:0
ds_read_b64_tr_b16 v[122:123], v19 offset:4096
M v[64:67], v[160:163], a[184:187], v[64:67]
buffer_load_dwordx4 a[140:143], v1, s[44:47], s25 offen offset:3072 sc1
M v[64:67], v[164:167], a[188:191], v[64:67]
ds_read_b64_tr_b16 v[124:125], v19 offset:8192
ds_read_b64_tr_b16 v[126:127], v19 offset:12288
M v[68:71], v[172:175], a[188:191], v[68:71]
s_sub_u32 s39, s39, 1
s_cmp_eq_u32 s39, 0
s_cselect_b32 s3, s64, s65
M v[68:71], v[168:171], a[184:187], v[68:71]
ds_read_b64_tr_b16 v[128:129], v20 offset:0
ds_read_b64_tr_b16 v[130:131], v20 offset:4096
M v[72:75], v[176:179], a[184:187], v[72:75]
s_add_u32 s25, s25, s3
s_lshl_b32 s3, s3, 3
s_add_u32 s26, s26, s3
M v[72:75], v[180:183], a[188:191], v[72:75]
ds_read_b64_tr_b16 v[132:133], v20 offset:8192
ds_read_b64_tr_b16 v[134:135], v20 offset:12288
M v[76:79], v[188:191], a[188:191], v[76:79]
M v[76:79], v[184:187], a[184:187], v[76:79]
ds_read_b64_tr_b16 v[136:137], v21 offset:0
ds_read_b64_tr_b16 v[138:139], v21 offset:4096
M v[80:83], v[192:195], a[184:187], v[80:83]
ds_read_b64_tr_b16 v[140:141], v21 offset:8192
ds_read_b64_tr_b16 v[142:143], v21 offset:12288
M v[80:83], v[196:199], a[188:191], v[80:83]
ds_read_b64_tr_b16 v[144:145], v22 offset:0
ds_read_b64_tr_b16 v[146:147], v22 offset:4096
M v[84:87], v[204:207], a[188:191], v[84:87]
ds_read_b64_tr_b16 v[148:149], v22 offset:8192
ds_read_b64_tr_b16 v[150:151], v22 offset:12288
M v[84:87], v[200:203], a[184:187], v[84:87]
ds_read_b64_tr_b16 v[152:153], v23 offset:0
ds_read_b64_tr_b16 v[154:155], v23 offset:4096
M v[88:91], v[208:211], a[184:187], v[88:91]
ds_read_b64_tr_b16 v[156:157], v23 offset:8192
ds_read_b64_tr_b16 v[158:159], v23 offset:12288
M v[88:91], v[212:215], a[188:191], v[88:91]
M v[92:95], v[220:223], a[188:191], v[92:95]
M v[92:95], v[216:219], a[184:187], v[92:95]
s_waitcnt vmcnt(24) lgkmcnt(0)
s_barrier
M v[32:35], v[96:99], a[192:195], v[32:35]
s_add_u32 m0, s41, 16384
s_nop 0
buffer_load_dwordx4 v2, s[48:51], s26 offen offset:0 lds
M v[32:35], v[100:103], a[196:199], v[32:35]
ds_read_b64_tr_b16 v[160:161], v16 offset:16384
ds_read_b64_tr_b16 v[162:163], v16 offset:20480
M v[36:39], v[108:111], a[196:199], v[36:39]
buffer_load_dwordx4 v3, s[48:51], s26 offen offset:1024 lds
M v[36:39], v[104:107], a[192:195], v[36:39]
ds_read_b64_tr_b16 v[164:165], v16 offset:24576
ds_read_b64_tr_b16 v[166:167], v16 offset:28672
M v[40:43], v[112:115], a[192:195], v[40:43]
buffer_load_dwordx4 v4, s[48:51], s26 offen offset:2048 lds
M v[40:43], v[116:119], a[196:199], v[40:43]
ds_read_b64_tr_b16 v[168:169], v17 offset:16384
ds_read_b64_tr_b16 v[170:171], v17 offset:20480
M v[44:47], v[124:127], a[196:199], v[44:47]
buffer_load_dwordx4 v5, s[48:51], s26 offen offset:3072 lds
M v[44:47], v[120:123], a[192:195], v[44:47]
M v[48:51], v[128:131], a[192:195], v[48:51]
ds_read_b64_tr_b16 v[172:173], v17 offset:24576
ds_read_b64_tr_b16 v[174:175], v17 offset:28672
M v[48:51], v[132:135], a[196:199], v[48:51]
buffer_load_dwordx4 a[144:147], v1, s[44:47], s25 offen offset:0 sc1
M v[52:55], v[140:143], a[196:199], v[52:55]
ds_read_b64_tr_b16 v[176:177], v18 offset:16384
ds_read_b64_tr_b16 v[178:179], v18 offset:20480
M v[52:55], v[136:139], a[192:195], v[52:55]
buffer_load_dwordx4 a[148:151], v1, s[44:47], s25 offen offset:1024 sc1
M v[56:59], v[144:147], a[192:195], v[56:59]
ds_read_b64_tr_b16 v[180:181], v18 offset:24576
ds_read_b64_tr_b16 v[182:183], v18 offset:28672
M v[56:59], v[148:151], a[196:199], v[56:59]
buffer_load_dwordx4 a[152:155], v1, s[44:47], s25 offen offset:2048 sc1
M v[60:63], v[156:159], a[196:199], v[60:63]
M v[60:63], v[152:155], a[192:195], v[60:63]
ds_read_b64_tr_b16 v[184:185], v19 offset:16384
ds_read_b64_tr_b16 v[186:187], v19 offset:20480
M v[64:67], v[96:99], a[200:203], v[64:67]
buffer_load_dwordx4 a[156:159], v1, s[44:47], s25 offen offset:3072 sc1
M v[64:67], v[100:103], a[204:207], v[64:67]
ds_read_b64_tr_b16 v[188:189], v19 offset:24576
ds_read_b64_tr_b16 v[190:191], v19 offset:28672
M v[68:71], v[108:111], a[204:207], v[68:71]
s_sub_u32 s39, s39, 1
s_cmp_eq_u32 s39, 0
s_cselect_b32 s3, s64, s65
M v[68:71], v[104:107], a[200:203], v[68:71]
ds_read_b64_tr_b16 v[192:193], v20 offset:16384
ds_read_b64_tr_b16 v[194:195], v20 offset:20480
M v[72:75], v[112:115], a[200:203], v[72:75]
s_add_u32 s25, s25, s3
s_lshl_b32 s3, s3, 3
s_add_u32 s26, s26, s3
M v[72:75], v[116:119], a[204:207], v[72:75]
ds_read_b64_tr_b16 v[196:197], v20 offset:24576
ds_read_b64_tr_b16 v[198:199], v20 offset:28672
M v[76:79], v[124:127], a[204:207], v[76:79]
M v[76:79], v[120:123], a[200:203], v[76:79]
ds_read_b64_tr_b16 v[200:201], v21 offset:16384
ds_read_b64_tr_b16 v[202:203], v21 offset:20480
M v[80:83], v[128:131], a[200:203], v[80:83]
ds_read_b64_tr_b16 v[204:205], v21 offset:24576
ds_read_b64_tr_b16 v[206:207], v21 offset:28672
M v[80:83], v[132:135], a[204:207], v[80:83]
ds_read_b64_tr_b16 v[208:209], v22 offset:16384
ds_read_b64_tr_b16 v[210:211], v22 offset:20480
M v[84:87], v[140:143], a[204:207], v[84:87]
ds_read_b64_tr_b16 v[212:213], v22 offset:24576
ds_read_b64_tr_b16 v[214:215], v22 offset:28672
M v[84:87], v[136:139], a[200:203], v[84:87]
ds_read_b64_tr_b16 v[216:217], v23 offset:16384
ds_read_b64_tr_b16 v[218:219], v23 offset:20480
M v[88:91], v[144:147], a[200:203], v[88:91]
ds_read_b64_tr_b16 v[220:221], v23 offset:24576
ds_read_b64_tr_b16 v[222:223], v23 offset:28672
M v[88:91], v[148:151], a[204:207], v[88:91]
M v[92:95], v[156:159], a[204:207], v[92:95]
M v[92:95], v[152:155], a[200:203], v[92:95]
s_sub_u32 s28, s28, 1
s_cmp_lg_u32 s28, 0
s_cbranch_scc1 Lk3_la
s_waitcnt vmcnt(24) lgkmcnt(0)
s_barrier
M v[32:35], v[160:163], a[208:211], v[32:35]
s_add_u32 m0, s41, 32768
s_nop 0
buffer_load_dwordx4 v2, s[48:51], s26 offen offset:0 lds
M v[32:35], v[164:167], a[212:215], v[32:35]
ds_read_b64_tr_b16 v[96:97], v16 offset:32768
ds_read_b64_tr_b16 v[98:99], v16 offset:36864
M v[36:39], v[172:175], a[212:215], v[36:39]
buffer_load_dwordx4 v3, s[48:51], s26 offen offset:1024 lds
M v[36:39], v[168:171], a[208:211], v[36:39]
ds_read_b64_tr_b16 v[100:101], v16 offset:40960
ds_read_b64_tr_b16 v[102:103], v16 offset:45056
M v[40:43], v[176:179], a[208:211], v[40:43]
buffer_load_dwordx4 v4, s[48:51], s26 offen offset:2048 lds
M v[40:43], v[180:183], a[212:215], v[40:43]
ds_read_b64_tr_b16 v[104:105], v17 offset:32768
ds_read_b64_tr_b16 v[106:107], v17 offset:36864
M v[44:47], v[188:191], a[212:215], v[44:47]
buffer_load_dwordx4 v5, s[48:51], s26 offen offset:3072 lds
M v[44:47], v[184:187], a[208:211], v[44:47]
M v[48:51], v[192:195], a[208:211], v[48:51]
ds_read_b64_tr_b16 v[108:109], v17 offset:40960
ds_read_b64_tr_b16 v[110:111], v17 offset:45056
M v[48:51], v[196:199], a[212:215], v[48:51]
buffer_load_dwordx4 a[160:163], v1, s[44:47], s25 offen offset:0 sc1
M v[52:55], v[204:207], a[212:215], v[52:55]
ds_read_b64_tr_b16 v[112:113], v18 offset:32768
ds_read_b64_tr_b16 v[114:115], v18 offset:36864
M v[52:55], v[200:203], a[208:211], v[52:55]
buffer_load_dwordx4 a[164:167], v1, s[44:47], s25 offen offset:1024 sc1
M v[56:59], v[208:211], a[208:211], v[56:59]
ds_read_b64_tr_b16 v[116:117], v18 offset:40960
ds_read_b64_tr_b16 v[118:119], v18 offset:45056
M v[56:59], v[212:215], a[212:215], v[56:59]
buffer_load_dwordx4 a[168:171], v1, s[44:47], s25 offen offset:2048 sc1
M v[60:63], v[220:223], a[212:215], v[60:63]
M v[60:63], v[216:219], a[208:211], v[60:63]
ds_read_b64_tr_b16 v[120:121], v19 offset:32768
ds_read_b64_tr_b16 v[122:123], v19 offset:36864
M v[64:67], v[160:163], a[216:219], v[64:67]
buffer_load_dwordx4 a[172:175], v1, s[44:47], s25 offen offset:3072 sc1
M v[64:67], v[164:167], a[220:223], v[64:67]
ds_read_b64_tr_b16 v[124:125], v19 offset:40960
ds_read_b64_tr_b16 v[126:127], v19 offset:45056
M v[68:71], v[172:175], a[220:223], v[68:71]
s_sub_u32 s39, s39, 1
s_cmp_eq_u32 s39, 0
s_cselect_b32 s3, s64, s65
M v[68:71], v[168:171], a[216:219], v[68:71]
ds_read_b64_tr_b16 v[128:129], v20 offset:32768
ds_read_b64_tr_b16 v[130:131], v20 offset:36864
M v[72:75], v[176:179], a[216:219], v[72:75]
s_add_u32 s25, s25, s3
s_lshl_b32 s3, s3, 3
s_add_u32 s26, s26, s3
M v[72:75], v[180:183], a[220:223], v[72:75]
ds_read_b64_tr_b16 v[132:133], v20 offset:40960
ds_read_b64_tr_b16 v[134:135], v20 offset:45056
M v[76:79], v[188:191], a[220:223], v[76:79]
M v[76:79], v[184:187], a[216:219], v[76:79]
ds_read_b64_tr_b16 v[136:137], v21 offset:32768
ds_read_b64_tr_b16 v[138:139], v21 offset:36864
M v[80:83], v[192:195], a[216:219], v[80:83]
ds_read_b64_tr_b16 v[140:141], v21 offset:40960
ds_read_b64_tr_b16 v[142:143], v21 offset:45056
M v[80:83], v[196:199], a[220:223], v[80:83]
ds_read_b64_tr_b16 v[144:145], v22 offset:32768
ds_read_b64_tr_b16 v[146:147], v22 offset:36864
M v[84:87], v[204:207], a[220:223], v[84:87]
ds_read_b64_tr_b16 v[148:149], v22 offset:40960
ds_read_b64_tr_b16 v[150:151], v22 offset:45056
M v[84:87], v[200:203], a[216:219], v[84:87]
ds_read_b64_tr_b16 v[152:153], v23 offset:32768
ds_read_b64_tr_b16 v[154:155], v23 offset:36864
M v[88:91], v[208:211], a[216:219], v[88:91]
ds_read_b64_tr_b16 v[156:157], v23 offset:40960
ds_read_b64_tr_b16 v[158:159], v23 offset:45056
M v[88:91], v[212:215], a[220:223], v[88:91]
M v[92:95], v[220:223], a[220:223], v[92:95]
M v[92:95], v[216:219], a[216:219], v[92:95]
s_waitcnt vmcnt(24) lgkmcnt(0)
s_barrier
M v[32:35], v[96:99], a[224:227], v[32:35]
s_add_u32 m0, s41, 49152
s_nop 0
buffer_load_dwordx4 v2, s[48:51], s26 offen offset:0 lds
M v[32:35], v[100:103], a[228:231], v[32:35]
ds_read_b64_tr_b16 v[160:161], v16 offset:49152
ds_read_b64_tr_b16 v[162:163], v16 offset:53248
M v[36:39], v[108:111], a[228:231], v[36:39]
buffer_load_dwordx4 v3, s[48:51], s26 offen offset:1024 lds
M v[36:39], v[104:107], a[224:227], v[36:39]
ds_read_b64_tr_b16 v[164:165], v16 offset:57344
ds_read_b64_tr_b16 v[166:167], v16 offset:61440
M v[40:43], v[112:115], a[224:227], v[40:43]
buffer_load_dwordx4 v4, s[48:51], s26 offen offset:2048 lds
M v[40:43], v[116:119], a[228:231], v[40:43]
ds_read_b64_tr_b16 v[168:169], v17 offset:49152
ds_read_b64_tr_b16 v[170:171], v17 offset:53248
M v[44:47], v[124:127], a[228:231], v[44:47]
buffer_load_dwordx4 v5, s[48:51], s26 offen offset:3072 lds
M v[44:47], v[120:123], a[224:227], v[44:47]
M v[48:51], v[128:131], a[224:227], v[48:51]
ds_read_b64_tr_b16 v[172:173], v17 offset:57344
ds_read_b64_tr_b16 v[174:175], v17 offset:61440
M v[48:51], v[132:135], a[228:231], v[48:51]
buffer_load_dwordx4 a[176:179], v1, s[44:47], s25 offen offset:0 sc1
M v[52:55], v[140:143], a[228:231], v[52:55]
ds_read_b64_tr_b16 v[176:177], v18 offset:49152
ds_read_b64_tr_b16 v[178:179], v18 offset:53248
M v[52:55], v[136:139], a[224:227], v[52:55]
buffer_load_dwordx4 a[180:183], v1, s[44:47], s25 offen offset:1024 sc1
M v[56:59], v[144:147], a[224:227], v[56:59]
ds_read_b64_tr_b16 v[180:181], v18 offset:57344
ds_read_b64_tr_b16 v[182:183], v18 offset:61440
M v[56:59], v[148:151], a[228:231], v[56:59]
buffer_load_dwordx4 a[184:187], v1, s[44:47], s25 offen offset:2048 sc1
M v[60:63], v[156:159], a[228:231], v[60:63]
M v[60:63], v[152:155], a[224:227], v[60:63]
ds_read_b64_tr_b16 v[184:185], v19 offset:49152
ds_read_b64_tr_b16 v[186:187], v19 offset:53248
M v[64:67], v[96:99], a[232:235], v[64:67]
buffer_load_dwordx4 a[188:191], v1, s[44:47], s25 offen offset:3072 sc1
M v[64:67], v[100:103], a[236:239], v[64:67]
ds_read_b64_tr_b16 v[188:189], v19 offset:57344
ds_read_b64_tr_b16 v[190:191], v19 offset:61440
M v[68:71], v[108:111], a[236:239], v[68:71]
s_sub_u32 s39, s39, 1
s_cmp_eq_u32 s39, 0
s_cselect_b32 s3, s64, s65
M v[68:71], v[104:107], a[232:235], v[68:71]
ds_read_b64_tr_b16 v[192:193], v20 offset:49152
ds_read_b64_tr_b16 v[194:195], v20 offset:53248
M v[72:75], v[112:115], a[232:235], v[72:75]
s_add_u32 s25, s25, s3
s_lshl_b32 s3, s3, 3
s_add_u32 s26, s26, s3
M v[72:75], v[116:119], a[236:239], v[72:75]
ds_read_b64_tr_b16 v[196:197], v20 offset:57344
ds_read_b64_tr_b16 v[198:199], v20 offset:61440
M v[76:79], v[124:127], a[236:239], v[76:79]
M v[76:79], v[120:123], a[232:235], v[76:79]
ds_read_b64_tr_b16 v[200:201], v21 offset:49152
ds_read_b64_tr_b16 v[202:203], v21 offset:53248
M v[80:83], v[128:131], a[232:235], v[80:83]
ds_read_b64_tr_b16 v[204:205], v21 offset:57344
ds_read_b64_tr_b16 v[206:207], v21 offset:61440
M v[80:83], v[132:135], a[236:239], v[80:83]
ds_read_b64_tr_b16 v[208:209], v22 offset:49152
ds_read_b64_tr_b16 v[210:211], v22 offset:53248
M v[84:87], v[140:143], a[236:239], v[84:87]
ds_read_b64_tr_b16 v[212:213], v22 offset:57344
ds_read_b64_tr_b16 v[214:215], v22 offset:61440
M v[84:87], v[136:139], a[232:235], v[84:87]
ds_read_b64_tr_b16 v[216:217], v23 offset:49152
ds_read_b64_tr_b16 v[218:219], v23 offset:53248
M v[88:91], v[144:147], a[232:235], v[88:91]
ds_read_b64_tr_b16 v[220:221], v23 offset:57344
ds_read_b64_tr_b16 v[222:223], v23 offset:61440
M v[88:91], v[148:151], a[236:239], v[88:91]
M v[92:95], v[156:159], a[236:239], v[92:95]
M v[92:95], v[152:155], a[232:235], v[92:95]
s_waitcnt vmcnt(24) lgkmcnt(0)
s_barrier
M v[32:35], v[160:163], a[240:243], v[32:35]
s_mov_b64 s[44:45], s[34:35]
s_mov_b32 s46, 4194304
s_mov_b64 s[48:49], s[36:37]
s_mov_b32 s50, 2097152
s_mov_b32 s25, s32
s_mov_b32 s26, s33
s_add_u32 m0, s42, 65536
s_nop 0
buffer_load_dwordx4 v6, s[48:51], s26 offen offset:0 lds
M v[32:35], v[164:167], a[244:247], v[32:35]
ds_read_b64_tr_b16 v[96:97], v8 offset:0
ds_read_b64_tr_b16 v[98:99], v8 offset:4096
M v[36:39], v[172:175], a[244:247], v[36:39]
buffer_load_dwordx4 v7, s[48:51], s26 offen offset:1024 lds
M v[36:39], v[168:171], a[240:243], v[36:39]
ds_read_b64_tr_b16 v[100:101], v8 offset:8192
ds_read_b64_tr_b16 v[102:103], v8 offset:12288
M v[40:43], v[176:179], a[240:243], v[40:43]
M v[40:43], v[180:183], a[244:247], v[40:43]
buffer_load_dwordx4 a[192:195], v1, s[44:47], s25 offen offset:0 sc1
M v[44:47], v[188:191], a[244:247], v[44:47]
ds_read_b64_tr_b16 v[104:105], v9 offset:0
ds_read_b64_tr_b16 v[106:107], v9 offset:4096
M v[44:47], v[184:187], a[240:243], v[44:47]
buffer_load_dwordx4 a[196:199], v1, s[44:47], s25 offen offset:1024 sc1
M v[48:51], v[192:195], a[240:243], v[48:51]
M v[48:51], v[196:199], a[244:247], v[48:51]
ds_read_b64_tr_b16 v[108:109], v9 offset:8192
ds_read_b64_tr_b16 v[110:111], v9 offset:12288
M v[52:55], v[204:207], a[244:247], v[52:55]
buffer_load_dwordx4 a[200:203], v1, s[44:47], s25 offen offset:2048 sc1
M v[52:55], v[200:203], a[240:243], v[52:55]
ds_read_b64_tr_b16 v[112:113], v10 offset:0
ds_read_b64_tr_b16 v[114:115], v10 offset:4096
M v[56:59], v[208:211], a[240:243], v[56:59]
M v[56:59], v[212:215], a[244:247], v[56:59]
buffer_load_dwordx4 a[204:207], v1, s[44:47], s25 offen offset:3072 sc1
M v[60:63], v[220:223], a[244:247], v[60:63]
ds_read_b64_tr_b16 v[116:117], v10 offset:8192
ds_read_b64_tr_b16 v[118:119], v10 offset:12288
M v[60:63], v[216:219], a[240:243], v[60:63]
s_add_u32 s25, s25, 16384
s_add_u32 s26, s26, 131072
M v[64:67], v[160:163], a[248:251], v[64:67]
ds_read_b64_tr_b16 v[120:121], v11 offset:0
ds_read_b64_tr_b16 v[122:123], v11 offset:4096
M v[64:67], v[164:167], a[252:255], v[64:67]
M v[68:71], v[172:175], a[252:255], v[68:71]
ds_read_b64_tr_b16 v[124:125], v11 offset:8192
ds_read_b64_tr_b16 v[126:127], v11 offset:12288
M v[68:71], v[168:171], a[248:251], v[68:71]
ds_read_b64_tr_b16 v[128:129], v12 offset:0
ds_read_b64_tr_b16 v[130:131], v12 offset:4096
M v[72:75], v[176:179], a[248:251], v[72:75]
ds_read_b64_tr_b16 v[132:133], v12 offset:8192
ds_read_b64_tr_b16 v[134:135], v12 offset:12288
M v[72:75], v[180:183], a[252:255], v[72:75]
M v[76:79], v[188:191], a[252:255], v[76:79]
ds_read_b64_tr_b16 v[136:137], v13 offset:0
ds_read_b64_tr_b16 v[138:139], v13 offset:4096
M v[76:79], v[184:187], a[248:251], v[76:79]
ds_read_b64_tr_b16 v[140:141], v13 offset:8192
ds_read_b64_tr_b16 v[142:143], v13 offset:12288
M v[80:83], v[192:195], a[248:251], v[80:83]
ds_read_b64_tr_b16 v[144:145], v14 offset:0
ds_read_b64_tr_b16 v[146:147], v14 offset:4096
M v[80:83], v[196:199], a[252:255], v[80:83]
M v[84:87], v[204:207], a[252:255], v[84:87]
ds_read_b64_tr_b16 v[148:149], v14 offset:8192
ds_read_b64_tr_b16 v[150:151], v14 offset:12288
M v[84:87], v[200:203], a[248:251], v[84:87]
ds_read_b64_tr_b16 v[152:153], v15 offset:0
ds_read_b64_tr_b16 v[154:155], v15 offset:4096
M v[88:91], v[208:211], a[248:251], v[88:91]
ds_read_b64_tr_b16 v[156:157], v15 offset:8192
ds_read_b64_tr_b16 v[158:159], v15 offset:12288
M v[88:91], v[212:215], a[252:255], v[88:91]
M v[92:95], v[220:223], a[252:255], v[92:95]
M v[92:95], v[216:219], a[248:251], v[92:95]
s_waitcnt vmcnt(22) lgkmcnt(0)
s_barrier
M v[32:35], v[96:99], a[128:131], v[32:35]
s_add_u32 m0, s42, 81920
s_nop 0
buffer_load_dwordx4 v6, s[48:51], s26 offen offset:0 lds
M v[32:35], v[100:103], a[132:135], v[32:35]
ds_read_b64_tr_b16 v[160:161], v8 offset:16384
ds_read_b64_tr_b16 v[162:163], v8 offset:20480
M v[36:39], v[108:111], a[132:135], v[36:39]
buffer_load_dwordx4 v7, s[48:51], s26 offen offset:1024 lds
M v[36:39], v[104:107], a[128:131], v[36:39]
ds_read_b64_tr_b16 v[164:165], v8 offset:24576
ds_read_b64_tr_b16 v[166:167], v8 offset:28672
M v[40:43], v[112:115], a[128:131], v[40:43]
M v[40:43], v[116:119], a[132:135], v[40:43]
buffer_load_dwordx4 a[208:211], v1, s[44:47], s25 offen offset:0 sc1
M v[44:47], v[124:127], a[132:135], v[44:47]
ds_read_b64_tr_b16 v[168:169], v9 offset:16384
ds_read_b64_tr_b16 v[170:171], v9 offset:20480
M v[44:47], v[120:123], a[128:131], v[44:47]
buffer_load_dwordx4 a[212:215], v1, s[44:47], s25 offen offset:1024 sc1
M v[48:51], v[128:131], a[128:131], v[48:51]
M v[48:51], v[132:135], a[132:135], v[48:51]
ds_read_b64_tr_b16 v[172:173], v9 offset:24576
ds_read_b64_tr_b16 v[174:175], v9 offset:28672
M v[52:55], v[140:143], a[132:135], v[52:55]
buffer_load_dwordx4 a[216:219], v1, s[44:47], s25 offen offset:2048 sc1
M v[52:55], v[136:139], a[128:131], v[52:55]
ds_read_b64_tr_b16 v[176:177], v10 offset:16384
ds_read_b64_tr_b16 v[178:179], v10 offset:20480
M v[56:59], v[144:147], a[128:131], v[56:59]
M v[56:59], v[148:151], a[132:135], v[56:59]
buffer_load_dwordx4 a[220:223], v1, s[44:47], s25 offen offset:3072 sc1
M v[60:63], v[156:159], a[132:135], v[60:63]
ds_read_b64_tr_b16 v[180:181], v10 offset:24576
ds_read_b64_tr_b16 v[182:183], v10 offset:28672
M v[60:63], v[152:155], a[128:131], v[60:63]
s_add_u32 s25, s25, 16384
s_add_u32 s26, s26, 131072
M v[64:67], v[96:99], a[136:139], v[64:67]
ds_read_b64_tr_b16 v[184:185], v11 offset:16384
ds_read_b64_tr_b16 v[186:187], v11 offset:20480
M v[64:67], v[100:103], a[140:143], v[64:67]
M v[68:71], v[108:111], a[140:143], v[68:71]
ds_read_b64_tr_b16 v[188:189], v11 offset:24576
ds_read_b64_tr_b16 v[190:191], v11 offset:28672
M v[68:71], v[104:107], a[136:139], v[68:71]
ds_read_b64_tr_b16 v[192:193], v12 offset:16384
ds_read_b64_tr_b16 v[194:195], v12 offset:20480
M v[72:75], v[112:115], a[136:139], v[72:75]
ds_read_b64_tr_b16 v[196:197], v12 offset:24576
ds_read_b64_tr_b16 v[198:199], v12 offset:28672
M v[72:75], v[116:119], a[140:143], v[72:75]
M v[76:79], v[124:127], a[140:143], v[76:79]
ds_read_b64_tr_b16 v[200:201], v13 offset:16384
ds_read_b64_tr_b16 v[202:203], v13 offset:20480
M v[76:79], v[120:123], a[136:139], v[76:79]
ds_read_b64_tr_b16 v[204:205], v13 offset:24576
ds_read_b64_tr_b16 v[206:207], v13 offset:28672
M v[80:83], v[128:131], a[136:139], v[80:83]
ds_read_b64_tr_b16 v[208:209], v14 offset:16384
ds_read_b64_tr_b16 v[210:211], v14 offset:20480
M v[80:83], v[132:135], a[140:143], v[80:83]
M v[84:87], v[140:143], a[140:143], v[84:87]
ds_read_b64_tr_b16 v[212:213], v14 offset:24576
ds_read_b64_tr_b16 v[214:215], v14 offset:28672
M v[84:87], v[136:139], a[136:139], v[84:87]
ds_read_b64_tr_b16 v[216:217], v15 offset:16384
ds_read_b64_tr_b16 v[218:219], v15 offset:20480
M v[88:91], v[144:147], a[136:139], v[88:91]
ds_read_b64_tr_b16 v[220:221], v15 offset:24576
ds_read_b64_tr_b16 v[222:223], v15 offset:28672
M v[88:91], v[148:151], a[140:143], v[88:91]
M v[92:95], v[156:159], a[140:143], v[92:95]
M v[92:95], v[152:155], a[136:139], v[92:95]
s_waitcnt vmcnt(20) lgkmcnt(0)
s_barrier
M v[32:35], v[160:163], a[144:147], v[32:35]
s_add_u32 m0, s42, 98304
s_nop 0
buffer_load_dwordx4 v6, s[48:51], s26 offen offset:0 lds
M v[32:35], v[164:167], a[148:151], v[32:35]
ds_read_b64_tr_b16 v[96:97], v8 offset:32768
ds_read_b64_tr_b16 v[98:99], v8 offset:36864
M v[36:39], v[172:175], a[148:151], v[36:39]
buffer_load_dwordx4 v7, s[48:51], s26 offen offset:1024 lds
M v[36:39], v[168:171], a[144:147], v[36:39]
ds_read_b64_tr_b16 v[100:101], v8 offset:40960
ds_read_b64_tr_b16 v[102:103], v8 offset:45056
M v[40:43], v[176:179], a[144:147], v[40:43]
M v[40:43], v[180:183], a[148:151], v[40:43]
buffer_load_dwordx4 a[224:227], v1, s[44:47], s25 offen offset:0 sc1
M v[44:47], v[188:191], a[148:151], v[44:47]
ds_read_b64_tr_b16 v[104:105], v9 offset:32768
ds_read_b64_tr_b16 v[106:107], v9 offset:36864
M v[44:47], v[184:187], a[144:147], v[44:47]
buffer_load_dwordx4 a[228:231], v1, s[44:47], s25 offen offset:1024 sc1
M v[48:51], v[192:195], a[144:147], v[48:51]
M v[48:51], v[196:199], a[148:151], v[48:51]
ds_read_b64_tr_b16 v[108:109], v9 offset:40960
ds_read_b64_tr_b16 v[110:111], v9 offset:45056
M v[52:55], v[204:207], a[148:151], v[52:55]
buffer_load_dwordx4 a[232:235], v1, s[44:47], s25 offen offset:2048 sc1
M v[52:55], v[200:203], a[144:147], v[52:55]
ds_read_b64_tr_b16 v[112:113], v10 offset:32768
ds_read_b64_tr_b16 v[114:115], v10 offset:36864
M v[56:59], v[208:211], a[144:147], v[56:59]
M v[56:59], v[212:215], a[148:151], v[56:59]
buffer_load_dwordx4 a[236:239], v1, s[44:47], s25 offen offset:3072 sc1
M v[60:63], v[220:223], a[148:151], v[60:63]
ds_read_b64_tr_b16 v[116:117], v10 offset:40960
ds_read_b64_tr_b16 v[118:119], v10 offset:45056
M v[60:63], v[216:219], a[144:147], v[60:63]
s_add_u32 s25, s25, 16384
s_add_u32 s26, s26, 131072
M v[64:67], v[160:163], a[152:155], v[64:67]
ds_read_b64_tr_b16 v[120:121], v11 offset:32768
ds_read_b64_tr_b16 v[122:123], v11 offset:36864
M v[64:67], v[164:167], a[156:159], v[64:67]
M v[68:71], v[172:175], a[156:159], v[68:71]
ds_read_b64_tr_b16 v[124:125], v11 offset:40960
ds_read_b64_tr_b16 v[126:127], v11 offset:45056
M v[68:71], v[168:171], a[152:155], v[68:71]
ds_read_b64_tr_b16 v[128:129], v12 offset:32768
ds_read_b64_tr_b16 v[130:131], v12 offset:36864
M v[72:75], v[176:179], a[152:155], v[72:75]
ds_read_b64_tr_b16 v[132:133], v12 offset:40960
ds_read_b64_tr_b16 v[134:135], v12 offset:45056
M v[72:75], v[180:183], a[156:159], v[72:75]
M v[76:79], v[188:191], a[156:159], v[76:79]
ds_read_b64_tr_b16 v[136:137], v13 offset:32768
ds_read_b64_tr_b16 v[138:139], v13 offset:36864
M v[76:79], v[184:187], a[152:155], v[76:79]
ds_read_b64_tr_b16 v[140:141], v13 offset:40960
ds_read_b64_tr_b16 v[142:143], v13 offset:45056
M v[80:83], v[192:195], a[152:155], v[80:83]
ds_read_b64_tr_b16 v[144:145], v14 offset:32768
ds_read_b64_tr_b16 v[146:147], v14 offset:36864
M v[80:83], v[196:199], a[156:159], v[80:83]
M v[84:87], v[204:207], a[156:159], v[84:87]
ds_read_b64_tr_b16 v[148:149], v14 offset:40960
ds_read_b64_tr_b16 v[150:151], v14 offset:45056
M v[84:87], v[200:203], a[152:155], v[84:87]
ds_read_b64_tr_b16 v[152:153], v15 offset:32768
ds_read_b64_tr_b16 v[154:155], v15 offset:36864
M v[88:91], v[208:211], a[152:155], v[88:91]
ds_read_b64_tr_b16 v[156:157], v15 offset:40960
ds_read_b64_tr_b16 v[158:159], v15 offset:45056
M v[88:91], v[212:215], a[156:159], v[88:91]
M v[92:95], v[220:223], a[156:159], v[92:95]
M v[92:95], v[216:219], a[152:155], v[92:95]
s_waitcnt vmcnt(18) lgkmcnt(0)
s_barrier
M v[32:35], v[96:99], a[160:163], v[32:35]
s_add_u32 m0, s42, 114688
s_nop 0
buffer_load_dwordx4 v6, s[48:51], s26 offen offset:0 lds
M v[32:35], v[100:103], a[164:167], v[32:35]
ds_read_b64_tr_b16 v[160:161], v8 offset:49152
ds_read_b64_tr_b16 v[162:163], v8 offset:53248
M v[36:39], v[108:111], a[164:167], v[36:39]
buffer_load_dwordx4 v7, s[48:51], s26 offen offset:1024 lds
M v[36:39], v[104:107], a[160:163], v[36:39]
ds_read_b64_tr_b16 v[164:165], v8 offset:57344
ds_read_b64_tr_b16 v[166:167], v8 offset:61440
M v[40:43], v[112:115], a[160:163], v[40:43]
M v[40:43], v[116:119], a[164:167], v[40:43]
buffer_load_dwordx4 a[240:243], v1, s[44:47], s25 offen offset:0 sc1
M v[44:47], v[124:127], a[164:167], v[44:47]
ds_read_b64_tr_b16 v[168:169], v9 offset:49152
ds_read_b64_tr_b16 v[170:171], v9 offset:53248
M v[44:47], v[120:123], a[160:163], v[44:47]
buffer_load_dwordx4 a[244:247], v1, s[44:47], s25 offen offset:1024 sc1
M v[48:51], v[128:131], a[160:163], v[48:51]
M v[48:51], v[132:135], a[164:167], v[48:51]
ds_read_b64_tr_b16 v[172:173], v9 offset:57344
ds_read_b64_tr_b16 v[174:175], v9 offset:61440
M v[52:55], v[140:143], a[164:167], v[52:55]
buffer_load_dwordx4 a[248:251], v1, s[44:47], s25 offen offset:2048 sc1
M v[52:55], v[136:139], a[160:163], v[52:55]
ds_read_b64_tr_b16 v[176:177], v10 offset:49152
ds_read_b64_tr_b16 v[178:179], v10 offset:53248
M v[56:59], v[144:147], a[160:163], v[56:59]
M v[56:59], v[148:151], a[164:167], v[56:59]
buffer_load_dwordx4 a[252:255], v1, s[44:47], s25 offen offset:3072 sc1
M v[60:63], v[156:159], a[164:167], v[60:63]
ds_read_b64_tr_b16 v[180:181], v10 offset:57344
ds_read_b64_tr_b16 v[182:183], v10 offset:61440
M v[60:63], v[152:155], a[160:163], v[60:63]
s_add_u32 s25, s25, 16384
s_add_u32 s26, s26, 131072
M v[64:67], v[96:99], a[168:171], v[64:67]
ds_read_b64_tr_b16 v[184:185], v11 offset:49152
ds_read_b64_tr_b16 v[186:187], v11 offset:53248
M v[64:67], v[100:103], a[172:175], v[64:67]
M v[68:71], v[108:111], a[172:175], v[68:71]
ds_read_b64_tr_b16 v[188:189], v11 offset:57344
ds_read_b64_tr_b16 v[190:191], v11 offset:61440
M v[68:71], v[104:107], a[168:171], v[68:71]
ds_read_b64_tr_b16 v[192:193], v12 offset:49152
ds_read_b64_tr_b16 v[194:195], v12 offset:53248
M v[72:75], v[112:115], a[168:171], v[72:75]
ds_read_b64_tr_b16 v[196:197], v12 offset:57344
ds_read_b64_tr_b16 v[198:199], v12 offset:61440
M v[72:75], v[116:119], a[172:175], v[72:75]
M v[76:79], v[124:127], a[172:175], v[76:79]
ds_read_b64_tr_b16 v[200:201], v13 offset:49152
ds_read_b64_tr_b16 v[202:203], v13 offset:53248
M v[76:79], v[120:123], a[168:171], v[76:79]
ds_read_b64_tr_b16 v[204:205], v13 offset:57344
ds_read_b64_tr_b16 v[206:207], v13 offset:61440
M v[80:83], v[128:131], a[168:171], v[80:83]
ds_read_b64_tr_b16 v[208:209], v14 offset:49152
ds_read_b64_tr_b16 v[210:211], v14 offset:53248
M v[80:83], v[132:135], a[172:175], v[80:83]
M v[84:87], v[140:143], a[172:175], v[84:87]
ds_read_b64_tr_b16 v[212:213], v14 offset:57344
ds_read_b64_tr_b16 v[214:215], v14 offset:61440
M v[84:87], v[136:139], a[168:171], v[84:87]
ds_read_b64_tr_b16 v[216:217], v15 offset:49152
ds_read_b64_tr_b16 v[218:219], v15 offset:53248
M v[88:91], v[144:147], a[168:171], v[88:91]
ds_read_b64_tr_b16 v[220:221], v15 offset:57344
ds_read_b64_tr_b16 v[222:223], v15 offset:61440
M v[88:91], v[148:151], a[172:175], v[88:91]
M v[92:95], v[156:159], a[172:175], v[92:95]
M v[92:95], v[152:155], a[168:171], v[92:95]
s_waitcnt vmcnt(18) lgkmcnt(0)
s_barrier
M v[32:35], v[160:163], a[176:179], v[32:35]
s_add_u32 m0, s42, 0
s_nop 0
buffer_load_dwordx4 v6, s[48:51], s26 offen offset:0 lds
M v[32:35], v[164:167], a[180:183], v[32:35]
M v[36:39], v[172:175], a[180:183], v[36:39]
ds_read_b64_tr_b16 v[96:97], v28 offset:0
ds_read_b64_tr_b16 v[98:99], v28 offset:2048
M v[36:39], v[168:171], a[176:179], v[36:39]
M v[40:43], v[176:179], a[176:179], v[40:43]
buffer_load_dwordx4 v7, s[48:51], s26 offen offset:1024 lds
M v[40:43], v[180:183], a[180:183], v[40:43]
M v[44:47], v[188:191], a[180:183], v[44:47]
ds_read_b64_tr_b16 v[100:101], v28 offset:4096
ds_read_b64_tr_b16 v[102:103], v28 offset:6144
M v[44:47], v[184:187], a[176:179], v[44:47]
M v[48:51], v[192:195], a[176:179], v[48:51]
buffer_load_dwordx4 a[128:131], v1, s[44:47], s25 offen offset:0 sc1
M v[48:51], v[196:199], a[180:183], v[48:51]
M v[52:55], v[204:207], a[180:183], v[52:55]
ds_read_b64_tr_b16 v[104:105], v29 offset:0
ds_read_b64_tr_b16 v[106:107], v29 offset:2048
M v[52:55], v[200:203], a[176:179], v[52:55]
M v[56:59], v[208:211], a[176:179], v[56:59]
buffer_load_dwordx4 a[132:135], v1, s[44:47], s25 offen offset:1024 sc1
M v[56:59], v[212:215], a[180:183], v[56:59]
M v[60:63], v[220:223], a[180:183], v[60:63]
ds_read_b64_tr_b16 v[108:109], v29 offset:4096
ds_read_b64_tr_b16 v[110:111], v29 offset:6144
M v[60:63], v[216:219], a[176:179], v[60:63]
M v[64:67], v[160:163], a[184:187], v[64:67]
buffer_load_dwordx4 a[136:139], v1, s[44:47], s25 offen offset:2048 sc1
M v[64:67], v[164:167], a[188:191], v[64:67]
M v[68:71], v[172:175], a[188:191], v[68:71]
ds_read_b64_tr_b16 v[112:113], v30 offset:0
ds_read_b64_tr_b16 v[114:115], v30 offset:2048
M v[68:71], v[168:171], a[184:187], v[68:71]
M v[72:75], v[176:179], a[184:187], v[72:75]
buffer_load_dwordx4 a[140:143], v1, s[44:47], s25 offen offset:3072 sc1
M v[72:75], v[180:183], a[188:191], v[72:75]
M v[76:79], v[188:191], a[188:191], v[76:79]
ds_read_b64_tr_b16 v[116:117], v30 offset:4096
ds_read_b64_tr_b16 v[118:119], v30 offset:6144
M v[76:79], v[184:187], a[184:187], v[76:79]
M v[80:83], v[192:195], a[184:187], v[80:83]
s_add_u32 s25, s25, 16384
s_add_u32 s26, s26, 131072
M v[80:83], v[196:199], a[188:191], v[80:83]
M v[84:87], v[204:207], a[188:191], v[84:87]
ds_read_b64_tr_b16 v[120:121], v31 offset:0
ds_read_b64_tr_b16 v[122:123], v31 offset:2048
M v[84:87], v[200:203], a[184:187], v[84:87]
M v[88:91], v[208:211], a[184:187], v[88:91]
ds_read_b64_tr_b16 v[124:125], v31 offset:4096
ds_read_b64_tr_b16 v[126:127], v31 offset:6144
M v[88:91], v[212:215], a[188:191], v[88:91]
M v[92:95], v[220:223], a[188:191], v[92:95]
M v[92:95], v[216:219], a[184:187], v[92:95]
s_waitcnt vmcnt(18) lgkmcnt(0)
s_barrier
M a[0:3], v[96:99], a[192:195], a[0:3]
s_add_u32 m0, s42, 16384
s_nop 0
buffer_load_dwordx4 v6, s[48:51], s26 offen offset:0 lds
ds_read_b64_tr_b16 v[160:161], v28 offset:16384
ds_read_b64_tr_b16 v[162:163], v28 offset:18432
M a[0:3], v[100:103], a[196:199], a[0:3]
buffer_load_dwordx4 v7, s[48:51], s26 offen offset:1024 lds
ds_read_b64_tr_b16 v[164:165], v28 offset:20480
ds_read_b64_tr_b16 v[166:167], v28 offset:22528
M a[4:7], v[108:111], a[196:199], a[4:7]
buffer_load_dwordx4 a[144:147], v1, s[44:47], s25 offen offset:0 sc1
ds_read_b64_tr_b16 v[168:169], v29 offset:16384
ds_read_b64_tr_b16 v[170:171], v29 offset:18432
M a[4:7], v[104:107], a[192:195], a[4:7]
buffer_load_dwordx4 a[148:151], v1, s[44:47], s25 offen offset:1024 sc1
M a[8:11], v[112:115], a[192:195], a[8:11]
ds_read_b64_tr_b16 v[172:173], v29 offset:20480
ds_read_b64_tr_b16 v[174:175], v29 offset:22528
buffer_load_dwordx4 a[152:155], v1, s[44:47], s25 offen offset:2048 sc1
M a[8:11], v[116:119], a[196:199], a[8:11]
ds_read_b64_tr_b16 v[176:177], v30 offset:16384
ds_read_b64_tr_b16 v[178:179], v30 offset:18432
buffer_load_dwordx4 a[156:159], v1, s[44:47], s25 offen offset:3072 sc1
M a[12:15], v[124:127], a[196:199], a[12:15]
ds_read_b64_tr_b16 v[180:181], v30 offset:20480
ds_read_b64_tr_b16 v[182:183], v30 offset:22528
M a[12:15], v[120:123], a[192:195], a[12:15]
s_add_u32 s25, s25, 16384
s_add_u32 s26, s26, 131072
ds_read_b64_tr_b16 v[184:185], v31 offset:16384
ds_read_b64_tr_b16 v[186:187], v31 offset:18432
M a[16:19], v[96:99], a[200:203], a[16:19]
s_add_u32 s60, s56, 0
buffer_store_dwordx4 v[48:51], v1, s[52:55], s60 offen offset:0 sc1
ds_read_b64_tr_b16 v[188:189], v31 offset:20480
ds_read_b64_tr_b16 v[190:191], v31 offset:22528
M a[16:19], v[100:103], a[204:207], a[16:19]
buffer_store_dwordx4 v[52:55], v1, s[52:55], s60 offen offset:1024 sc1
buffer_store_dwordx4 v[56:59], v1, s[52:55], s60 offen offset:2048 sc1
M a[20:23], v[108:111], a[204:207], a[20:23]
buffer_store_dwordx4 v[60:63], v1, s[52:55], s60 offen offset:3072 sc1
M a[20:23], v[104:107], a[200:203], a[20:23]
s_add_u32 s60, s56, 4096
buffer_store_dwordx4 v[80:83], v1, s[52:55], s60 offen offset:0 sc1
buffer_store_dwordx4 v[84:87], v1, s[52:55], s60 offen offset:1024 sc1
M a[24:27], v[112:115], a[200:203], a[24:27]
buffer_store_dwordx4 v[88:91], v1, s[52:55], s60 offen offset:2048 sc1
buffer_store_dwordx4 v[92:95], v1, s[52:55], s60 offen offset:3072 sc1
M a[24:27], v[116:119], a[204:207], a[24:27]
v_mov_b32 v11, 0
M a[28:31], v[124:127], a[204:207], a[28:31]
M a[28:31], v[120:123], a[200:203], a[28:31]
s_waitcnt vmcnt(26) lgkmcnt(0)
s_barrier
M a[0:3], v[160:163], a[208:211], a[0:3]
s_add_u32 m0, s42, 32768
s_nop 0
buffer_load_dwordx4 v6, s[48:51], s26 offen offset:0 lds
ds_read_b64_tr_b16 v[96:97], v28 offset:32768
ds_read_b64_tr_b16 v[98:99], v28 offset:34816
M a[0:3], v[164:167], a[212:215], a[0:3]
buffer_load_dwordx4 v7, s[48:51], s26 offen offset:1024 lds
M a[4:7], v[172:175], a[212:215], a[4:7]
ds_read_b64_tr_b16 v[100:101], v28 offset:36864
ds_read_b64_tr_b16 v[102:103], v28 offset:38912
M a[4:7], v[168:171], a[208:211], a[4:7]
buffer_load_dwordx4 a[160:163], v1, s[44:47], s25 offen offset:0 sc1
M a[8:11], v[176:179], a[208:211], a[8:11]
ds_read_b64_tr_b16 v[104:105], v29 offset:32768
ds_read_b64_tr_b16 v[106:107], v29 offset:34816
M a[8:11], v[180:183], a[212:215], a[8:11]
buffer_load_dwordx4 a[164:167], v1, s[44:47], s25 offen offset:1024 sc1
M a[12:15], v[188:191], a[212:215], a[12:15]
ds_read_b64_tr_b16 v[108:109], v29 offset:36864
ds_read_b64_tr_b16 v[110:111], v29 offset:38912
M a[12:15], v[184:187], a[208:211], a[12:15]
buffer_load_dwordx4 a[168:171], v1, s[44:47], s25 offen offset:2048 sc1
M a[16:19], v[160:163], a[216:219], a[16:19]
ds_read_b64_tr_b16 v[112:113], v30 offset:32768
ds_read_b64_tr_b16 v[114:115], v30 offset:34816
M a[16:19], v[164:167], a[220:223], a[16:19]
buffer_load_dwordx4 a[172:175], v1, s[44:47], s25 offen offset:3072 sc1
M a[20:23], v[172:175], a[220:223], a[20:23]
ds_read_b64_tr_b16 v[116:117], v30 offset:36864
ds_read_b64_tr_b16 v[118:119], v30 offset:38912
M a[20:23], v[168:171], a[216:219], a[20:23]
s_add_u32 s25, s25, 16384
s_add_u32 s26, s26, 131072
M a[24:27], v[176:179], a[216:219], a[24:27]
ds_read_b64_tr_b16 v[120:121], v31 offset:32768
ds_read_b64_tr_b16 v[122:123], v31 offset:34816
M a[24:27], v[180:183], a[220:223], a[24:27]
ds_read_b64_tr_b16 v[124:125], v31 offset:36864
ds_read_b64_tr_b16 v[126:127], v31 offset:38912
M a[28:31], v[188:191], a[220:223], a[28:31]
M a[28:31], v[184:187], a[216:219], a[28:31]
s_waitcnt vmcnt(6) lgkmcnt(0)
s_barrier
s_cmp_lg_u32 s101, 0
s_cbranch_scc1 Lk3f_7
v_mov_b32 v9, 1
s_mov_b64 exec, 1
buffer_store_dword v9, v11, s[52:55], s58 offen sc1
s_mov_b64 exec, -1
Lk3f_7:
M a[0:3], v[96:99], a[224:227], a[0:3]
s_add_u32 m0, s42, 49152
s_nop 0
buffer_load_dwordx4 v6, s[48:51], s26 offen offset:0 lds
ds_read_b64_tr_b16 v[160:161], v28 offset:49152
ds_read_b64_tr_b16 v[162:163], v28 offset:51200
M a[0:3], v[100:103], a[228:231], a[0:3]
buffer_load_dwordx4 v7, s[48:51], s26 offen offset:1024 lds
M a[4:7], v[108:111], a[228:231], a[4:7]
ds_read_b64_tr_b16 v[164:165], v28 offset:53248
ds_read_b64_tr_b16 v[166:167], v28 offset:55296
M a[4:7], v[104:107], a[224:227], a[4:7]
buffer_load_dwordx4 a[176:179], v1, s[44:47], s25 offen offset:0 sc1
M a[8:11], v[112:115], a[224:227], a[8:11]
ds_read_b64_tr_b16 v[168:169], v29 offset:49152
ds_read_b64_tr_b16 v[170:171], v29 offset:51200
M a[8:11], v[116:119], a[228:231], a[8:11]
buffer_load_dwordx4 a[180:183], v1, s[44:47], s25 offen offset:1024 sc1
M a[12:15], v[124:127], a[228:231], a[12:15]
ds_read_b64_tr_b16 v[172:173], v29 offset:53248
ds_read_b64_tr_b16 v[174:175], v29 offset:55296
M a[12:15], v[120:123], a[224:227], a[12:15]
buffer_load_dwordx4 a[184:187], v1, s[44:47], s25 offen offset:2048 sc1
M a[16:19], v[96:99], a[232:235], a[16:19]
ds_read_b64_tr_b16 v[176:177], v30 offset:49152
ds_read_b64_tr_b16 v[178:179], v30 offset:51200
M a[16:19], v[100:103], a[236:239], a[16:19]
buffer_load_dwordx4 a[188:191], v1, s[44:47], s25 offen offset:3072 sc1
M a[20:23], v[108:111], a[236:239], a[20:23]
ds_read_b64_tr_b16 v[180:181], v30 offset:53248
ds_read_b64_tr_b16 v[182:183], v30 offset:55296
M a[20:23], v[104:107], a[232:235], a[20:23]
s_add_u32 s25, s25, 16384
s_add_u32 s26, s26, 131072
M a[24:27], v[112:115], a[232:235], a[24:27]
ds_read_b64_tr_b16 v[184:185], v31 offset:49152
ds_read_b64_tr_b16 v[186:187], v31 offset:51200
M a[24:27], v[116:119], a[236:239], a[24:27]
ds_read_b64_tr_b16 v[188:189], v31 offset:53248
ds_read_b64_tr_b16 v[190:191], v31 offset:55296
M a[28:31], v[124:127], a[236:239], a[28:31]
M a[28:31], v[120:123], a[232:235], a[28:31]
s_waitcnt vmcnt(26) lgkmcnt(0)
s_barrier
M a[0:3], v[160:163], a[240:243], a[0:3]
ds_read_b64_tr_b16 v[96:97], v24 offset:0
ds_read_b64_tr_b16 v[98:99], v24 offset:2048
M a[0:3], v[164:167], a[244:247], a[0:3]
ds_read_b64_tr_b16 v[100:101], v24 offset:4096
ds_read_b64_tr_b16 v[102:103], v24 offset:6144
M a[4:7], v[172:175], a[244:247], a[4:7]
M a[4:7], v[168:171], a[240:243], a[4:7]
ds_read_b64_tr_b16 v[104:105], v25 offset:0
ds_read_b64_tr_b16 v[106:107], v25 offset:2048
M a[8:11], v[176:179], a[240:243], a[8:11]
M a[8:11], v[180:183], a[244:247], a[8:11]
ds_read_b64_tr_b16 v[108:109], v25 offset:4096
ds_read_b64_tr_b16 v[110:111], v25 offset:6144
M a[12:15], v[188:191], a[244:247], a[12:15]
M a[12:15], v[184:187], a[240:243], a[12:15]
ds_read_b64_tr_b16 v[112:113], v26 offset:0
ds_read_b64_tr_b16 v[114:115], v26 offset:2048
M a[16:19], v[160:163], a[248:251], a[16:19]
ds_read_b64_tr_b16 v[116:117], v26 offset:4096
ds_read_b64_tr_b16 v[118:119], v26 offset:6144
M a[16:19], v[164:167], a[252:255], a[16:19]
M a[20:23], v[172:175], a[252:255], a[20:23]
ds_read_b64_tr_b16 v[120:121], v27 offset:0
ds_read_b64_tr_b16 v[122:123], v27 offset:2048
M a[20:23], v[168:171], a[248:251], a[20:23]
M a[24:27], v[176:179], a[248:251], a[24:27]
ds_read_b64_tr_b16 v[124:125], v27 offset:4096
ds_read_b64_tr_b16 v[126:127], v27 offset:6144
M a[24:27], v[180:183], a[252:255], a[24:27]
M a[28:31], v[188:191], a[252:255], a[28:31]
M a[28:31], v[184:187], a[248:251], a[28:31]
s_waitcnt vmcnt(20) lgkmcnt(0)
s_barrier
M a[0:3], v[96:99], a[128:131], a[0:3]
ds_read_b64_tr_b16 v[160:161], v24 offset:16384
ds_read_b64_tr_b16 v[162:163], v24 offset:18432
M a[0:3], v[100:103], a[132:135], a[0:3]
ds_read_b64_tr_b16 v[164:165], v24 offset:20480
ds_read_b64_tr_b16 v[166:167], v24 offset:22528
M a[4:7], v[108:111], a[132:135], a[4:7]
M a[4:7], v[104:107], a[128:131], a[4:7]
ds_read_b64_tr_b16 v[168:169], v25 offset:16384
ds_read_b64_tr_b16 v[170:171], v25 offset:18432
M a[8:11], v[112:115], a[128:131], a[8:11]
M a[8:11], v[116:119], a[132:135], a[8:11]
ds_read_b64_tr_b16 v[172:173], v25 offset:20480
ds_read_b64_tr_b16 v[174:175], v25 offset:22528
M a[12:15], v[124:127], a[132:135], a[12:15]
M a[12:15], v[120:123], a[128:131], a[12:15]
ds_read_b64_tr_b16 v[176:177], v26 offset:16384
ds_read_b64_tr_b16 v[178:179], v26 offset:18432
M a[16:19], v[96:99], a[136:139], a[16:19]
ds_read_b64_tr_b16 v[180:181], v26 offset:20480
ds_read_b64_tr_b16 v[182:183], v26 offset:22528
M a[16:19], v[100:103], a[140:143], a[16:19]
M a[20:23], v[108:111], a[140:143], a[20:23]
ds_read_b64_tr_b16 v[184:185], v27 offset:16384
ds_read_b64_tr_b16 v[186:187], v27 offset:18432
M a[20:23], v[104:107], a[136:139], a[20:23]
M a[24:27], v[112:115], a[136:139], a[24:27]
ds_read_b64_tr_b16 v[188:189], v27 offset:20480
ds_read_b64_tr_b16 v[190:191], v27 offset:22528
M a[24:27], v[116:119], a[140:143], a[24:27]
M a[28:31], v[124:127], a[140:143], a[28:31]
M a[28:31], v[120:123], a[136:139], a[28:31]
s_waitcnt vmcnt(6) lgkmcnt(0)
s_barrier
M a[0:3], v[160:163], a[144:147], a[0:3]
buffer_load_dword v8, v11, s[52:55], s59 offen sc1
M a[0:3], v[164:167], a[148:151], a[0:3]
ds_read_b64_tr_b16 v[96:97], v24 offset:32768
ds_read_b64_tr_b16 v[98:99], v24 offset:34816
M a[4:7], v[172:175], a[148:151], a[4:7]
M a[4:7], v[168:171], a[144:147], a[4:7]
ds_read_b64_tr_b16 v[100:101], v24 offset:36864
ds_read_b64_tr_b16 v[102:103], v24 offset:38912
M a[8:11], v[176:179], a[144:147], a[8:11]
ds_read_b64_tr_b16 v[104:105], v25 offset:32768
ds_read_b64_tr_b16 v[106:107], v25 offset:34816
M a[8:11], v[180:183], a[148:151], a[8:11]
M a[12:15], v[188:191], a[148:151], a[12:15]
ds_read_b64_tr_b16 v[108:109], v25 offset:36864
ds_read_b64_tr_b16 v[110:111], v25 offset:38912
M a[12:15], v[184:187], a[144:147], a[12:15]
ds_read_b64_tr_b16 v[112:113], v26 offset:32768
ds_read_b64_tr_b16 v[114:115], v26 offset:34816
M a[16:19], v[160:163], a[152:155], a[16:19]
M a[16:19], v[164:167], a[156:159], a[16:19]
ds_read_b64_tr_b16 v[116:117], v26 offset:36864
ds_read_b64_tr_b16 v[118:119], v26 offset:38912
M a[20:23], v[172:175], a[156:159], a[20:23]
ds_read_b64_tr_b16 v[120:121], v27 offset:32768
ds_read_b64_tr_b16 v[122:123], v27 offset:34816
M a[20:23], v[168:171], a[152:155], a[20:23]
M a[24:27], v[176:179], a[152:155], a[24:27]
ds_read_b64_tr_b16 v[124:125], v27 offset:36864
ds_read_b64_tr_b16 v[126:127], v27 offset:38912
M a[24:27], v[180:183], a[156:159], a[24:27]
M a[28:31], v[188:191], a[156:159], a[28:31]
M a[28:31], v[184:187], a[152:155], a[28:31]
s_waitcnt vmcnt(1) lgkmcnt(0)
s_barrier
s_waitcnt vmcnt(0)
v_cmp_ne_u32 vcc, 1, v8
s_nop 0
s_cbranch_vccnz Lk3_spinfl
Lk3_gotfl:
M a[0:3], v[96:99], a[160:163], a[0:3]
s_add_u32 s60, s57, 0
buffer_load_dwordx4 v[224:227], v1, s[52:55], s60 offen offset:0 sc1
ds_read_b64_tr_b16 v[160:161], v24 offset:49152
ds_read_b64_tr_b16 v[162:163], v24 offset:51200
M a[0:3], v[100:103], a[164:167], a[0:3]
buffer_load_dwordx4 v[228:231], v1, s[52:55], s60 offen offset:1024 sc1
M a[4:7], v[108:111], a[164:167], a[4:7]
ds_read_b64_tr_b16 v[164:165], v24 offset:53248
ds_read_b64_tr_b16 v[166:167], v24 offset:55296
M a[4:7], v[104:107], a[160:163], a[4:7]
buffer_load_dwordx4 v[232:235], v1, s[52:55], s60 offen offset:2048 sc1
M a[8:11], v[112:115], a[160:163], a[8:11]
ds_read_b64_tr_b16 v[168:169], v25 offset:49152
ds_read_b64_tr_b16 v[170:171], v25 offset:51200
M a[8:11], v[116:119], a[164:167], a[8:11]
buffer_load_dwordx4 v[236:239], v1, s[52:55], s60 offen offset:3072 sc1
M a[12:15], v[124:127], a[164:167], a[12:15]
ds_read_b64_tr_b16 v[172:173], v25 offset:53248
ds_read_b64_tr_b16 v[174:175], v25 offset:55296
M a[12:15], v[120:123], a[160:163], a[12:15]
s_add_u32 s60, s57, 4096
buffer_load_dwordx4 v[240:243], v1, s[52:55], s60 offen offset:0 sc1
ds_read_b64_tr_b16 v[176:177], v26 offset:49152
ds_read_b64_tr_b16 v[178:179], v26 offset:51200
M a[16:19], v[96:99], a[168:171], a[16:19]
buffer_load_dwordx4 v[244:247], v1, s[52:55], s60 offen offset:1024 sc1
M a[16:19], v[100:103], a[172:175], a[16:19]
ds_read_b64_tr_b16 v[180:181], v26 offset:53248
ds_read_b64_tr_b16 v[182:183], v26 offset:55296
M a[20:23], v[108:111], a[172:175], a[20:23]
buffer_load_dwordx4 v[248:251], v1, s[52:55], s60 offen offset:2048 sc1
M a[20:23], v[104:107], a[168:171], a[20:23]
ds_read_b64_tr_b16 v[184:185], v27 offset:49152
ds_read_b64_tr_b16 v[186:187], v27 offset:51200
M a[24:27], v[112:115], a[168:171], a[24:27]
buffer_load_dwordx4 v[252:255], v1, s[52:55], s60 offen offset:3072 sc1
M a[24:27], v[116:119], a[172:175], a[24:27]
ds_read_b64_tr_b16 v[188:189], v27 offset:53248
ds_read_b64_tr_b16 v[190:191], v27 offset:55296
M a[28:31], v[124:127], a[172:175], a[28:31]
M a[28:31], v[120:123], a[168:171], a[28:31]
s_waitcnt lgkmcnt(0)
M a[0:3], v[160:163], a[176:179], a[0:3]
M a[0:3], v[164:167], a[180:183], a[0:3]
M a[4:7], v[172:175], a[180:183], a[4:7]
M a[4:7], v[168:171], a[176:179], a[4:7]
M a[8:11], v[176:179], a[176:179], a[8:11]
M a[8:11], v[180:183], a[180:183], a[8:11]
M a[12:15], v[188:191], a[180:183], a[12:15]
M a[12:15], v[184:187], a[176:179], a[12:15]
M a[16:19], v[160:163], a[184:187], a[16:19]
M a[16:19], v[164:167], a[188:191], a[16:19]
M a[20:23], v[172:175], a[188:191], a[20:23]
M a[20:23], v[168:171], a[184:187], a[20:23]
M a[24:27], v[176:179], a[184:187], a[24:27]
M a[24:27], v[180:183], a[188:191], a[24:27]
M a[28:31], v[188:191], a[188:191], a[28:31]
M a[28:31], v[184:187], a[184:187], a[28:31]
v_bfe_u32 v96, v0, 4, 1
v_lshrrev_b32 v97, 5, v0
v_lshl_or_b32 v96, v96, 1, v97
v_and_b32 v97, 15, v0
v_lshlrev_b32 v97, 13, v97
v_lshl_add_u32 v96, v96, 4, v97
s_and_b32 s3, s101, 1
s_lshl_b32 s3, s3, 6
s_lshr_b32 s6, s101, 1
s_add_u32 s3, s3, s6
s_add_u32 s3, s3, s21
s_lshl_b32 s3, s3, 12
s_lshl_b32 s6, s22, 1
s_add_u32 s3, s3, s6
s_add_u32 s3, s3, 2048
v_accvgpr_read_b32 v108, a0
v_accvgpr_read_b32 v109, a1
v_accvgpr_read_b32 v110, a2
v_accvgpr_read_b32 v111, a3
v_accvgpr_read_b32 v112, a4
v_accvgpr_read_b32 v113, a5
v_accvgpr_read_b32 v114, a6
v_accvgpr_read_b32 v115, a7
v_cvt_pk_bf16_f32 v100, v108, v109
v_cvt_pk_bf16_f32 v101, v110, v111
v_cvt_pk_bf16_f32 v102, v112, v113
v_cvt_pk_bf16_f32 v103, v114, v115
s_nop 0
v_permlane16_swap_b32 v100, v102
v_permlane16_swap_b32 v101, v103
buffer_store_dwordx4 v[100:103], v96, s[16:19], s3 offen offset:0
v_accvgpr_read_b32 v108, a8
v_accvgpr_read_b32 v109, a9
v_accvgpr_read_b32 v110, a10
v_accvgpr_read_b32 v111, a11
v_accvgpr_read_b32 v112, a12
v_accvgpr_read_b32 v113, a13
v_accvgpr_read_b32 v114, a14
v_accvgpr_read_b32 v115, a15
v_cvt_pk_bf16_f32 v104, v108, v109
v_cvt_pk_bf16_f32 v105, v110, v111
v_cvt_pk_bf16_f32 v106, v112, v113
v_cvt_pk_bf16_f32 v107, v114, v115
s_nop 0
v_permlane16_swap_b32 v104, v106
v_permlane16_swap_b32 v105, v107
buffer_store_dwordx4 v[104:107], v96, s[16:19], s3 offen offset:64
s_add_u32 s3, s3, 131072
v_accvgpr_read_b32 v108, a16
v_accvgpr_read_b32 v109, a17
v_accvgpr_read_b32 v110, a18
v_accvgpr_read_b32 v111, a19
v_accvgpr_read_b32 v112, a20
v_accvgpr_read_b32 v113, a21
v_accvgpr_read_b32 v114, a22
v_accvgpr_read_b32 v115, a23
v_cvt_pk_bf16_f32 v100, v108, v109
v_cvt_pk_bf16_f32 v101, v110, v111
v_cvt_pk_bf16_f32 v102, v112, v113
v_cvt_pk_bf16_f32 v103, v114, v115
s_nop 0
v_permlane16_swap_b32 v100, v102
v_permlane16_swap_b32 v101, v103
buffer_store_dwordx4 v[100:103], v96, s[16:19], s3 offen offset:0
v_accvgpr_read_b32 v108, a24
v_accvgpr_read_b32 v109, a25
v_accvgpr_read_b32 v110, a26
v_accvgpr_read_b32 v111, a27
v_accvgpr_read_b32 v112, a28
v_accvgpr_read_b32 v113, a29
v_accvgpr_read_b32 v114, a30
v_accvgpr_read_b32 v115, a31
v_cvt_pk_bf16_f32 v104, v108, v109
v_cvt_pk_bf16_f32 v105, v110, v111
v_cvt_pk_bf16_f32 v106, v112, v113
v_cvt_pk_bf16_f32 v107, v114, v115
s_nop 0
v_permlane16_swap_b32 v104, v106
v_permlane16_swap_b32 v105, v107
buffer_store_dwordx4 v[104:107], v96, s[16:19], s3 offen offset:64
v_bfe_u32 v128, v0, 4, 1
v_lshrrev_b32 v129, 5, v0
v_lshl_or_b32 v128, v128, 1, v129
v_and_b32 v129, 15, v0
v_lshlrev_b32 v129, 12, v129
v_lshl_add_u32 v128, v128, 4, v129
s_lshl_b32 s3, s101, 5
s_add_u32 s3, s3, s29
s_lshl_b32 s3, s3, 12
s_lshl_b32 s6, s30, 1
s_add_u32 s3, s3, s6
s_waitcnt vmcnt(4)
v_pk_add_f32 v[32:33], v[32:33], v[224:225]
v_pk_add_f32 v[34:35], v[34:35], v[226:227]
v_pk_add_f32 v[36:37], v[36:37], v[228:229]
v_pk_add_f32 v[38:39], v[38:39], v[230:231]
v_cvt_pk_bf16_f32 v132, v32, v33
v_cvt_pk_bf16_f32 v133, v34, v35
v_cvt_pk_bf16_f32 v134, v36, v37
v_cvt_pk_bf16_f32 v135, v38, v39
s_nop 0
v_permlane16_swap_b32 v132, v134
v_permlane16_swap_b32 v133, v135
buffer_store_dwordx4 v[132:135], v128, s[16:19], s3 offen offset:0
v_pk_add_f32 v[40:41], v[40:41], v[232:233]
v_pk_add_f32 v[42:43], v[42:43], v[234:235]
v_pk_add_f32 v[44:45], v[44:45], v[236:237]
v_pk_add_f32 v[46:47], v[46:47], v[238:239]
v_cvt_pk_bf16_f32 v136, v40, v41
v_cvt_pk_bf16_f32 v137, v42, v43
v_cvt_pk_bf16_f32 v138, v44, v45
v_cvt_pk_bf16_f32 v139, v46, v47
s_nop 0
v_permlane16_swap_b32 v136, v138
v_permlane16_swap_b32 v137, v139
buffer_store_dwordx4 v[136:139], v128, s[16:19], s3 offen offset:64
s_add_u32 s3, s3, 65536
v_pk_add_f32 v[64:65], v[64:65], v[240:241]
v_pk_add_f32 v[66:67], v[66:67], v[242:243]
v_pk_add_f32 v[68:69], v[68:69], v[244:245]
v_pk_add_f32 v[70:71], v[70:71], v[246:247]
v_cvt_pk_bf16_f32 v132, v64, v65
v_cvt_pk_bf16_f32 v133, v66, v67
v_cvt_pk_bf16_f32 v134, v68, v69
v_cvt_pk_bf16_f32 v135, v70, v71
s_nop 0
v_permlane16_swap_b32 v132, v134
v_permlane16_swap_b32 v133, v135
buffer_store_dwordx4 v[132:135], v128, s[16:19], s3 offen offset:0
v_pk_add_f32 v[72:73], v[72:73], v[248:249]
v_pk_add_f32 v[74:75], v[74:75], v[250:251]
v_pk_add_f32 v[76:77], v[76:77], v[252:253]
v_pk_add_f32 v[78:79], v[78:79], v[254:255]
v_cvt_pk_bf16_f32 v136, v72, v73
v_cvt_pk_bf16_f32 v137, v74, v75
v_cvt_pk_bf16_f32 v138, v76, v77
v_cvt_pk_bf16_f32 v139, v78, v79
s_nop 0
v_permlane16_swap_b32 v136, v138
v_permlane16_swap_b32 v137, v139
buffer_store_dwordx4 v[136:139], v128, s[16:19], s3 offen offset:64
s_endpgm
Lk3_spinb0:
Lk3_spinb0_:
s_add_u32 s61, s61, 1
s_cmp_gt_u32 s61, 1048576
s_cbranch_scc1 Lk3_gotb0
s_sleep 2
buffer_load_dword v7, v15, s[52:55], s43 offen sc1
s_waitcnt vmcnt(0)
v_cmp_ne_u32 vcc, 1, v7
s_nop 0
s_cbranch_vccnz Lk3_spinb0_
s_branch Lk3_gotb0
Lk3_spinb1:
Lk3_spinb1_:
s_add_u32 s61, s61, 1
s_cmp_gt_u32 s61, 1048576
s_cbranch_scc1 Lk3_gotb1
s_sleep 2
buffer_load_dword v7, v15, s[52:55], s43 offen sc1
s_waitcnt vmcnt(0)
v_cmp_ne_u32 vcc, 1, v7
s_nop 0
s_cbranch_vccnz Lk3_spinb1_
s_branch Lk3_gotb1
Lk3_spinft:
s_add_u32 s61, s61, 1
s_cmp_gt_u32 s61, 1048576
s_cbranch_scc1 Lk3_gotft
s_sleep 2
buffer_load_dword v252, v255, s[52:55], s62 offen sc1
s_waitcnt vmcnt(0)
v_cmp_ne_u32 vcc, 1, v252
s_nop 0
s_cbranch_vccnz Lk3_spinft
s_branch Lk3_gotft
Lk3_spinfl:
s_add_u32 s61, s61, 1
s_cmp_gt_u32 s61, 1048576
s_cbranch_scc1 Lk3_gotfl
s_sleep 2
buffer_load_dword v8, v11, s[52:55], s59 offen sc1
s_waitcnt vmcnt(0)
v_cmp_ne_u32 vcc, 1, v8
s_nop 0
s_cbranch_vccnz Lk3_spinfl
s_branch Lk3_gotfl
Lc3:
.section .rodata,"a"
.p2align 6
.amdhsa_kernel concat_heads__compressed_kv_cla__sliding_local_dilated__prompt_kernel
  .amdhsa_next_free_vgpr 512
  .amdhsa_next_free_sgpr 102
  .amdhsa_accum_offset 256
  .amdhsa_group_segment_fixed_size 0
  .amdhsa_kernarg_size 96
  .amdhsa_user_sgpr_count 2
  .amdhsa_user_sgpr_kernarg_segment_ptr 1
  .amdhsa_system_sgpr_workgroup_id_x 1
.end_amdhsa_kernel
```

```asm
; @launch grid=(256,1,1) block=(256,1,1) lds=163840
.amdgcn_target "amdgcn-amd-amdhsa--gfx950"
.text
.macro M d, a, b, c
v_mfma_f32_16x16x32_bf16 \d, \a, \b, \c
.endm
.globl concat_heads__compressed_kv_cla__sliding_local_dilated__prompt_kernel
.p2align 8
.type concat_heads__compressed_kv_cla__sliding_local_dilated__prompt_kernel,@function
concat_heads__compressed_kv_cla__sliding_local_dilated__prompt_kernel:
s_cmp_lt_u32 s2, 256
s_cbranch_scc1 Lk1_go
s_endpgm
Lk1_go:
s_load_dwordx16 s[32:47], s[0:1], 0
s_load_dwordx2 s[48:49], s[0:1], 64
s_load_dwordx2 s[50:51], s[0:1], 88
s_load_dwordx2 s[90:91], s[0:1], 80
v_lshrrev_b32 v24, 6, v0
s_nop 0
v_readfirstlane_b32 s20, v24
v_and_b32 v0, 63, v0
v_lshlrev_b32 v1, 4, v0
s_mov_b32 s101, s20
s_lshr_b32 s21, s20, 1
s_and_b32 s22, s20, 1
s_lshl_b32 s29, s20, 12
s_and_b32 s3, s2, 1
s_lshl_b32 s3, s3, 2
s_bfe_u32 s6, s2, 0x20003
s_add_u32 s3, s3, s6
s_lshl_b32 s52, s3, 8
s_bfe_u32 s3, s2, 0x20001
s_lshl_b32 s3, s3, 2
s_bfe_u32 s7, s2, 0x20005
s_add_u32 s3, s3, s7
s_lshl_b32 s53, s3, 8
s_cmp_lt_u32 s2, 128
s_cselect_b32 s5, 11, 10
s_lshl_b32 s3, s21, 7
s_lshl_b32 s4, s22, 5
s_add_u32 s3, s3, s4
v_lshrrev_b32 v24, 3, v0
v_add_u32 v24, s3, v24
v_and_b32 v25, 7, v0
v_add_u32 v26, 0, v24
v_bfe_u32 v27, v26, 1, 3
v_xor_b32 v27, v27, v25
v_lshlrev_b32 v26, s5, v26
v_lshl_add_u32 v26, v27, 4, v26
v_subrev_u32 v2, 0, v26
v_add_u32 v26, 8, v24
v_bfe_u32 v27, v26, 1, 3
v_xor_b32 v27, v27, v25
v_lshlrev_b32 v26, s5, v26
v_lshl_add_u32 v26, v27, 4, v26
v_subrev_u32 v3, 1024, v26
v_add_u32 v26, 16, v24
v_bfe_u32 v27, v26, 1, 3
v_xor_b32 v27, v27, v25
v_lshlrev_b32 v26, s5, v26
v_lshl_add_u32 v26, v27, 4, v26
v_subrev_u32 v4, 2048, v26
v_add_u32 v26, 24, v24
v_bfe_u32 v27, v26, 1, 3
v_xor_b32 v27, v27, v25
v_lshlrev_b32 v26, s5, v26
v_lshl_add_u32 v26, v27, 4, v26
v_subrev_u32 v5, 3072, v26
s_lshl_b32 s3, s20, 3
v_lshrrev_b32 v24, 5, v0
v_add_u32 v24, s3, v24
v_and_b32 v25, 31, v0
v_add_u32 v26, 0, v24
v_and_b32 v27, 3, v26
v_lshlrev_b32 v27, 1, v27
v_and_or_b32 v27, v26, 8, v27
v_xor_b32 v27, v27, v25
v_lshlrev_b32 v26, 13, v26
v_lshl_add_u32 v26, v27, 4, v26
v_subrev_u32 v6, 0, v26
v_add_u32 v26, 2, v24
v_and_b32 v27, 3, v26
v_lshlrev_b32 v27, 1, v27
v_and_or_b32 v27, v26, 8, v27
v_xor_b32 v27, v27, v25
v_lshlrev_b32 v26, 13, v26
v_lshl_add_u32 v26, v27, 4, v26
v_subrev_u32 v7, 1024, v26
v_add_u32 v26, 4, v24
v_and_b32 v27, 3, v26
v_lshlrev_b32 v27, 1, v27
v_and_or_b32 v27, v26, 8, v27
v_xor_b32 v27, v27, v25
v_lshlrev_b32 v26, 13, v26
v_lshl_add_u32 v26, v27, 4, v26
v_subrev_u32 v8, 2048, v26
v_add_u32 v26, 6, v24
v_and_b32 v27, 3, v26
v_lshlrev_b32 v27, 1, v27
v_and_or_b32 v27, v26, 8, v27
v_xor_b32 v27, v27, v25
v_lshlrev_b32 v26, 13, v26
v_lshl_add_u32 v26, v27, 4, v26
v_subrev_u32 v9, 3072, v26
s_lshl_b32 s23, s52, s5
s_lshl_b32 s31, 64, s5
s_mov_b32 s26, s23
s_lshl_b32 s24, s53, 1
s_mov_b32 s28, s24
s_lshl_b32 s3, 1, s5
s_add_u32 s25, s23, s3
s_lshl_b32 s3, s3, 12
s_add_u32 s27, s24, s3
s_bfe_u32 s3, s2, 0x20001
s_and_b32 s4, s2, 1
s_lshl_b32 s4, s4, 1
s_add_u32 s3, s3, s4
s_and_b32 s3, s3, 3
s_sub_u32 s4, s5, 2
s_lshl_b32 s3, s3, s4
s_add_u32 s23, s23, s3
s_lshl_b32 s3, s3, 12
s_add_u32 s24, s24, s3
s_mov_b32 s95, s6
s_cmp_lt_u32 s2, 128
s_cselect_b32 s6, -1, 8
s_waitcnt lgkmcnt(0)
s_cmp_lt_u32 s2, 128
s_cselect_b64 s[8:9], s[32:33], s[34:35]
s_mov_b32 s10, 2097152
s_cselect_b32 s10, 4194304, s10
s_mov_b32 s11, 0x00020000
s_cselect_b64 s[12:13], s[36:37], s[38:39]
s_mov_b32 s14, 4194304
s_cselect_b32 s14, 8388608, s14
s_mov_b32 s15, 0x00020000
s_mov_b64 s[64:65], s[40:41]
s_add_u32 m0, s29, 65536
s_nop 0
buffer_load_dwordx4 v6, s[12:15], s24 offen offset:0 lds
buffer_load_dwordx4 v7, s[12:15], s24 offen offset:1024 lds
buffer_load_dwordx4 v8, s[12:15], s24 offen offset:2048 lds
buffer_load_dwordx4 v9, s[12:15], s24 offen offset:3072 lds
s_add_u32 s24, s24, 262144
s_add_u32 m0, s29, 0
s_nop 0
buffer_load_dwordx4 v2, s[8:11], s23 offen offset:0 lds
buffer_load_dwordx4 v3, s[8:11], s23 offen offset:1024 lds
buffer_load_dwordx4 v4, s[8:11], s23 offen offset:2048 lds
buffer_load_dwordx4 v5, s[8:11], s23 offen offset:3072 lds
s_add_u32 m0, s29, 81920
s_nop 0
buffer_load_dwordx4 v6, s[12:15], s24 offen offset:0 lds
buffer_load_dwordx4 v7, s[12:15], s24 offen offset:1024 lds
buffer_load_dwordx4 v8, s[12:15], s24 offen offset:2048 lds
buffer_load_dwordx4 v9, s[12:15], s24 offen offset:3072 lds
s_add_u32 s24, s24, 262144
s_cmp_eq_u32 s24, s27
s_cselect_b32 s24, s28, s24
s_sub_u32 s6, s6, 1
s_cmp_eq_u32 s6, 0
s_cselect_b64 s[12:13], s[64:65], s[12:13]
s_add_u32 s16, s50, 109051904
s_addc_u32 s17, s51, 0
s_mov_b32 s18, 16384
s_mov_b32 s19, 0x00020000
v_mov_b32 v24, 0
v_mov_b32 v25, 0
v_mov_b32 v26, 0
v_mov_b32 v27, 0
s_lshl_b32 s3, s2, 2
buffer_store_dword v24, v24, s[16:19], s3 offen sc1
s_and_b32 s3, s2, 7
s_lshr_b32 s4, s2, 6
s_lshl_b32 s4, s4, 3
s_add_u32 s3, s3, s4
s_lshl_b32 s3, s3, 4
s_add_u32 s3, s3, 4096
s_bfe_u32 s4, s2, 0x30003
s_lshl_b32 s4, s4, 9
s_add_u32 s92, s3, s4
s_sub_u32 s4, 7680, s4
s_add_u32 s93, s3, s4
buffer_store_dwordx4 v[24:27], v24, s[16:19], s92 offen sc1
buffer_store_dwordx4 v[24:27], v24, s[16:19], s93 offen sc1
s_and_b32 s3, s2, 1
s_lshl_b32 s3, s3, 3
s_bfe_u32 s4, s2, 0x30003
s_add_u32 s92, s3, s4
s_bfe_u32 s3, s2, 0x20001
s_lshl_b32 s3, s3, 2
s_lshr_b32 s4, s2, 6
s_xor_b32 s4, s4, 2
s_add_u32 s93, s3, s4
s_lshl_b32 s92, s92, 8
s_lshl_b32 s93, s93, 4
s_add_u32 s92, s92, s93
s_add_u32 s92, s92, 12288
buffer_store_dwordx4 v[24:27], v24, s[16:19], s92 offen sc1
v_lshlrev_b32 v20, 7, v0
s_lshl_b32 s54, s2, 13
s_mov_b64 s[60:61], s[40:41]
s_mov_b32 s62, 0
s_cmp_eq_u32 s20, 1
s_cselect_b64 s[60:61], s[46:47], s[60:61]
s_cselect_b32 s62, 6291456, s62
s_cmp_eq_u32 s20, 2
s_cselect_b64 s[60:61], s[44:45], s[60:61]
s_cselect_b32 s62, 4194304, s62
s_cmp_eq_u32 s20, 3
s_cselect_b32 s62, 0, s62
s_mov_b32 s63, 0x00020000
s_mov_b32 s3, 0
s_cmp_eq_u32 s20, 1
s_cselect_b32 s3, 6291456, s3
s_cmp_eq_u32 s20, 2
s_cselect_b32 s3, 6291456, s3
s_sub_u32 s54, s54, s3
Lc0:
s_add_u32 m0, s29, 98304
s_nop 0
buffer_load_dwordx4 v6, s[12:15], s24 offen offset:0 lds
buffer_load_dwordx4 v7, s[12:15], s24 offen offset:1024 lds
buffer_load_dwordx4 v8, s[12:15], s24 offen offset:2048 lds
buffer_load_dwordx4 v9, s[12:15], s24 offen offset:3072 lds
s_add_u32 s24, s24, 262144
s_lshl_b32 s4, s21, 13
v_and_b32 v24, 15, v0
v_lshlrev_b32 v24, 7, v24
v_add_u32 v24, s4, v24
v_bfe_u32 v25, v0, 1, 3
v_lshrrev_b32 v26, 4, v0
v_xor_b32 v25, v25, v26
v_lshl_add_u32 v10, v25, 4, v24
v_xor_b32 v11, 64, v10
v_bfe_u32 v24, v0, 2, 2
v_lshl_add_u32 v29, v26, 3, v24
v_lshlrev_b32 v25, 9, v29
v_and_b32 v27, 1, v0
v_lshl_add_u32 v25, v27, 3, v25
v_add_u32 v25, 65536, v25
v_lshlrev_b32 v24, 1, v24
v_and_or_b32 v24, v29, 8, v24
v_bfe_u32 v26, v0, 1, 1
s_lshl_b32 s4, s22, 4
s_add_u32 s3, s4, 0
v_add_u32 v27, s3, v26
v_xor_b32 v27, v27, v24
v_lshl_add_u32 v12, v27, 4, v25
s_add_u32 s3, s4, 2
v_add_u32 v27, s3, v26
v_xor_b32 v27, v27, v24
v_lshl_add_u32 v13, v27, 4, v25
s_add_u32 s3, s4, 4
v_add_u32 v27, s3, v26
v_xor_b32 v27, v27, v24
v_lshl_add_u32 v14, v27, 4, v25
s_add_u32 s3, s4, 6
v_add_u32 v27, s3, v26
v_xor_b32 v27, v27, v24
v_lshl_add_u32 v15, v27, 4, v25
s_add_u32 s3, s4, 8
v_add_u32 v27, s3, v26
v_xor_b32 v27, v27, v24
v_lshl_add_u32 v16, v27, 4, v25
s_add_u32 s3, s4, 10
v_add_u32 v27, s3, v26
v_xor_b32 v27, v27, v24
v_lshl_add_u32 v17, v27, 4, v25
s_add_u32 s3, s4, 12
v_add_u32 v27, s3, v26
v_xor_b32 v27, v27, v24
v_lshl_add_u32 v18, v27, 4, v25
s_add_u32 s3, s4, 14
v_add_u32 v27, s3, v26
v_xor_b32 v27, v27, v24
v_lshl_add_u32 v19, v27, 4, v25
s_waitcnt vmcnt(8)
s_barrier
ds_read_b64_tr_b16 a[32:33], v12 offset:0
ds_read_b64_tr_b16 a[34:35], v12 offset:2048
ds_read_b64_tr_b16 a[40:41], v13 offset:0
ds_read_b64_tr_b16 a[42:43], v13 offset:2048
ds_read_b64_tr_b16 a[48:49], v14 offset:0
ds_read_b64_tr_b16 a[50:51], v14 offset:2048
ds_read_b64_tr_b16 a[56:57], v15 offset:0
ds_read_b64_tr_b16 a[58:59], v15 offset:2048
ds_read_b64_tr_b16 a[64:65], v16 offset:0
ds_read_b64_tr_b16 a[66:67], v16 offset:2048
ds_read_b64_tr_b16 a[72:73], v17 offset:0
ds_read_b64_tr_b16 a[74:75], v17 offset:2048
ds_read_b64_tr_b16 a[80:81], v18 offset:0
ds_read_b64_tr_b16 a[82:83], v18 offset:2048
ds_read_b64_tr_b16 a[88:89], v19 offset:0
ds_read_b64_tr_b16 a[90:91], v19 offset:2048
ds_read_b64_tr_b16 a[36:37], v12 offset:16384
ds_read_b64_tr_b16 a[38:39], v12 offset:18432
ds_read_b64_tr_b16 a[44:45], v13 offset:16384
ds_read_b64_tr_b16 a[46:47], v13 offset:18432
ds_read_b64_tr_b16 a[52:53], v14 offset:16384
ds_read_b64_tr_b16 a[54:55], v14 offset:18432
ds_read_b64_tr_b16 a[60:61], v15 offset:16384
ds_read_b64_tr_b16 a[62:63], v15 offset:18432
ds_read_b64_tr_b16 a[68:69], v16 offset:16384
ds_read_b64_tr_b16 a[70:71], v16 offset:18432
ds_read_b64_tr_b16 a[76:77], v17 offset:16384
ds_read_b64_tr_b16 a[78:79], v17 offset:18432
ds_read_b64_tr_b16 a[84:85], v18 offset:16384
ds_read_b64_tr_b16 a[86:87], v18 offset:18432
ds_read_b64_tr_b16 a[92:93], v19 offset:16384
ds_read_b64_tr_b16 a[94:95], v19 offset:18432
ds_read_b128 a[160:163], v10 offset:0
ds_read_b128 a[164:167], v11 offset:0
ds_read_b128 a[168:171], v10 offset:2048
ds_read_b128 a[172:175], v11 offset:2048
s_add_u32 m0, s29, 16384
s_add_u32 s3, s23, s31
s_nop 0
buffer_load_dwordx4 v2, s[8:11], s3 offen offset:0 lds
buffer_load_dwordx4 v3, s[8:11], s3 offen offset:1024 lds
buffer_load_dwordx4 v4, s[8:11], s3 offen offset:2048 lds
buffer_load_dwordx4 v5, s[8:11], s3 offen offset:3072 lds
s_add_u32 s23, s23, 128
s_cmp_eq_u32 s23, s25
s_cselect_b32 s23, s26, s23
s_add_u32 m0, s29, 114688
s_nop 0
buffer_load_dwordx4 v6, s[12:15], s24 offen offset:0 lds
buffer_load_dwordx4 v7, s[12:15], s24 offen offset:1024 lds
buffer_load_dwordx4 v8, s[12:15], s24 offen offset:2048 lds
buffer_load_dwordx4 v9, s[12:15], s24 offen offset:3072 lds
s_add_u32 s24, s24, 262144
s_cmp_eq_u32 s24, s27
s_cselect_b32 s24, s28, s24
s_sub_u32 s6, s6, 1
s_cmp_eq_u32 s6, 0
s_cselect_b64 s[12:13], s[64:65], s[12:13]
s_waitcnt vmcnt(8) lgkmcnt(0)
s_barrier
s_getpc_b64 s[92:93]
Lpc_1:
s_add_u32 s92, s92, Lc1-Lpc_1
s_addc_u32 s93, s93, 0
s_lshr_b32 s94, s2, 3
s_mul_i32 s94, s94, ((Lc3-Lc1)/32+127)&~127
v_lshlrev_b32 v24, 7, v0
v_add_u32 v24, s94, v24
v_min_u32 v24, Lc3-Lc1-4, v24
global_load_dword v21, v24, s[92:93]
Lc1:
s_cmp_lt_u32 s2, 128
s_cbranch_scc0 Lk1_kv
M v[32:35], a[32:35], a[160:163], 0
s_add_u32 m0, s29, 32768
s_nop 0
buffer_load_dwordx4 v2, s[8:11], s23 offen offset:0 lds
M v[32:35], a[36:39], a[164:167], v[32:35]
ds_read_b128 a[176:179], v10 offset:4096
ds_read_b128 a[180:183], v11 offset:4096
M v[36:39], a[44:47], a[164:167], 0
M v[36:39], a[40:43], a[160:163], v[36:39]
ds_read_b64_tr_b16 a[96:97], v12 offset:32768
ds_read_b64_tr_b16 a[98:99], v12 offset:34816
M v[40:43], a[48:51], a[160:163], 0
M v[40:43], a[52:55], a[164:167], v[40:43]
buffer_load_dwordx4 v3, s[8:11], s23 offen offset:1024 lds
M v[44:47], a[60:63], a[164:167], 0
M v[44:47], a[56:59], a[160:163], v[44:47]
ds_read_b64_tr_b16 a[104:105], v13 offset:32768
ds_read_b64_tr_b16 a[106:107], v13 offset:34816
M v[48:51], a[64:67], a[160:163], 0
M v[48:51], a[68:71], a[164:167], v[48:51]
buffer_load_dwordx4 v4, s[8:11], s23 offen offset:2048 lds
M v[52:55], a[76:79], a[164:167], 0
M v[52:55], a[72:75], a[160:163], v[52:55]
ds_read_b64_tr_b16 a[112:113], v14 offset:32768
ds_read_b64_tr_b16 a[114:115], v14 offset:34816
M v[56:59], a[80:83], a[160:163], 0
M v[56:59], a[84:87], a[164:167], v[56:59]
buffer_load_dwordx4 v5, s[8:11], s23 offen offset:3072 lds
M v[60:63], a[92:95], a[164:167], 0
M v[60:63], a[88:91], a[160:163], v[60:63]
ds_read_b64_tr_b16 a[120:121], v15 offset:32768
ds_read_b64_tr_b16 a[122:123], v15 offset:34816
M v[64:67], a[32:35], a[168:171], 0
M v[64:67], a[36:39], a[172:175], v[64:67]
ds_read_b128 a[184:187], v10 offset:6144
ds_read_b128 a[188:191], v11 offset:6144
M v[68:71], a[44:47], a[172:175], 0
s_add_u32 m0, s29, 65536
s_nop 0
buffer_load_dwordx4 v6, s[12:15], s24 offen offset:0 lds
M v[68:71], a[40:43], a[168:171], v[68:71]
ds_read_b64_tr_b16 a[128:129], v16 offset:32768
ds_read_b64_tr_b16 a[130:131], v16 offset:34816
M v[72:75], a[48:51], a[168:171], 0
M v[72:75], a[52:55], a[172:175], v[72:75]
M v[76:79], a[60:63], a[172:175], 0
buffer_load_dwordx4 v7, s[12:15], s24 offen offset:1024 lds
M v[76:79], a[56:59], a[168:171], v[76:79]
ds_read_b64_tr_b16 a[136:137], v17 offset:32768
ds_read_b64_tr_b16 a[138:139], v17 offset:34816
M v[80:83], a[64:67], a[168:171], 0
M v[80:83], a[68:71], a[172:175], v[80:83]
M v[84:87], a[76:79], a[172:175], 0
buffer_load_dwordx4 v8, s[12:15], s24 offen offset:2048 lds
M v[84:87], a[72:75], a[168:171], v[84:87]
ds_read_b64_tr_b16 a[144:145], v18 offset:32768
ds_read_b64_tr_b16 a[146:147], v18 offset:34816
M v[88:91], a[80:83], a[168:171], 0
M v[88:91], a[84:87], a[172:175], v[88:91]
M v[92:95], a[92:95], a[172:175], 0
buffer_load_dwordx4 v9, s[12:15], s24 offen offset:3072 lds
M v[92:95], a[88:91], a[168:171], v[92:95]
s_waitcnt lgkmcnt(15)
ds_read_b64_tr_b16 a[152:153], v19 offset:32768
ds_read_b64_tr_b16 a[154:155], v19 offset:34816
M v[96:99], a[32:35], a[176:179], 0
M v[96:99], a[36:39], a[180:183], v[96:99]
M v[100:103], a[44:47], a[180:183], 0
s_add_u32 s24, s24, 262144
M v[100:103], a[40:43], a[176:179], v[100:103]
M v[104:107], a[48:51], a[176:179], 0
M v[104:107], a[52:55], a[180:183], v[104:107]
M v[108:111], a[60:63], a[180:183], 0
M v[108:111], a[56:59], a[176:179], v[108:111]
s_waitcnt vmcnt(9) lgkmcnt(0)
s_barrier
ds_read_b128 a[160:163], v10 offset:16384
ds_read_b128 a[164:167], v11 offset:16384
M v[112:115], a[64:67], a[176:179], 0
s_add_u32 m0, s29, 49152
s_add_u32 s3, s23, s31
buffer_load_dwordx4 v2, s[8:11], s3 offen offset:0 lds
M v[112:115], a[68:71], a[180:183], v[112:115]
M v[116:119], a[76:79], a[180:183], 0
M v[116:119], a[72:75], a[176:179], v[116:119]
ds_read_b64_tr_b16 a[100:101], v12 offset:49152
ds_read_b64_tr_b16 a[102:103], v12 offset:51200
M v[120:123], a[80:83], a[176:179], 0
M v[120:123], a[84:87], a[180:183], v[120:123]
buffer_load_dwordx4 v3, s[8:11], s3 offen offset:1024 lds
M v[124:127], a[92:95], a[180:183], 0
M v[124:127], a[88:91], a[176:179], v[124:127]
M v[128:131], a[32:35], a[184:187], 0
M v[128:131], a[36:39], a[188:191], v[128:131]
ds_read_b128 a[168:171], v10 offset:18432
ds_read_b128 a[172:175], v11 offset:18432
ds_read_b64_tr_b16 a[108:109], v13 offset:49152
ds_read_b64_tr_b16 a[110:111], v13 offset:51200
M v[132:135], a[44:47], a[188:191], 0
M v[132:135], a[40:43], a[184:187], v[132:135]
buffer_load_dwordx4 v4, s[8:11], s3 offen offset:2048 lds
M v[136:139], a[48:51], a[184:187], 0
M v[136:139], a[52:55], a[188:191], v[136:139]
M v[140:143], a[60:63], a[188:191], 0
M v[140:143], a[56:59], a[184:187], v[140:143]
ds_read_b64_tr_b16 a[116:117], v14 offset:49152
ds_read_b64_tr_b16 a[118:119], v14 offset:51200
M v[144:147], a[64:67], a[184:187], 0
M v[144:147], a[68:71], a[188:191], v[144:147]
buffer_load_dwordx4 v5, s[8:11], s3 offen offset:3072 lds
M v[148:151], a[76:79], a[188:191], 0
M v[148:151], a[72:75], a[184:187], v[148:151]
M v[152:155], a[80:83], a[184:187], 0
M v[152:155], a[84:87], a[188:191], v[152:155]
ds_read_b64_tr_b16 a[124:125], v15 offset:49152
ds_read_b64_tr_b16 a[126:127], v15 offset:51200
M v[156:159], a[92:95], a[188:191], 0
s_add_u32 s23, s23, 128
s_cmp_eq_u32 s23, s25
s_cselect_b32 s23, s26, s23
M v[156:159], a[88:91], a[184:187], v[156:159]
s_waitcnt lgkmcnt(10)
M v[160:163], a[32:35], a[160:163], 0
M v[160:163], a[36:39], a[164:167], v[160:163]
ds_read_b128 a[176:179], v10 offset:20480
ds_read_b128 a[180:183], v11 offset:20480
M v[164:167], a[44:47], a[164:167], 0
M v[164:167], a[40:43], a[160:163], v[164:167]
ds_read_b64_tr_b16 a[132:133], v16 offset:49152
ds_read_b64_tr_b16 a[134:135], v16 offset:51200
M v[168:171], a[48:51], a[160:163], 0
M v[168:171], a[52:55], a[164:167], v[168:171]
s_add_u32 m0, s29, 81920
s_nop 0
buffer_load_dwordx4 v6, s[12:15], s24 offen offset:0 lds
M v[172:175], a[60:63], a[164:167], 0
M v[172:175], a[56:59], a[160:163], v[172:175]
M v[176:179], a[64:67], a[160:163], 0
M v[176:179], a[68:71], a[164:167], v[176:179]
ds_read_b64_tr_b16 a[140:141], v17 offset:49152
ds_read_b64_tr_b16 a[142:143], v17 offset:51200
M v[180:183], a[76:79], a[164:167], 0
M v[180:183], a[72:75], a[160:163], v[180:183]
buffer_load_dwordx4 v7, s[12:15], s24 offen offset:1024 lds
M v[184:187], a[80:83], a[160:163], 0
M v[184:187], a[84:87], a[164:167], v[184:187]
M v[188:191], a[92:95], a[164:167], 0
M v[188:191], a[88:91], a[160:163], v[188:191]
s_waitcnt lgkmcnt(12)
ds_read_b64_tr_b16 a[148:149], v18 offset:49152
ds_read_b64_tr_b16 a[150:151], v18 offset:51200
M v[192:195], a[32:35], a[168:171], 0
buffer_load_dwordx4 v8, s[12:15], s24 offen offset:2048 lds
M v[192:195], a[36:39], a[172:175], v[192:195]
ds_read_b128 a[184:187], v10 offset:22528
ds_read_b128 a[188:191], v11 offset:22528
M v[196:199], a[44:47], a[172:175], 0
M v[196:199], a[40:43], a[168:171], v[196:199]
M v[200:203], a[48:51], a[168:171], 0
M v[200:203], a[52:55], a[172:175], v[200:203]
ds_read_b64_tr_b16 a[156:157], v19 offset:49152
ds_read_b64_tr_b16 a[158:159], v19 offset:51200
M v[204:207], a[60:63], a[172:175], 0
buffer_load_dwordx4 v9, s[12:15], s24 offen offset:3072 lds
M v[204:207], a[56:59], a[168:171], v[204:207]
M v[208:211], a[64:67], a[168:171], 0
M v[208:211], a[68:71], a[172:175], v[208:211]
M v[212:215], a[76:79], a[172:175], 0
M v[212:215], a[72:75], a[168:171], v[212:215]
s_add_u32 s24, s24, 262144
s_cmp_eq_u32 s24, s27
s_cselect_b32 s24, s28, s24
s_sub_u32 s6, s6, 1
s_cmp_eq_u32 s6, 0
s_cselect_b64 s[12:13], s[64:65], s[12:13]
M v[216:219], a[80:83], a[168:171], 0
M v[216:219], a[84:87], a[172:175], v[216:219]
M v[220:223], a[92:95], a[172:175], 0
M v[220:223], a[88:91], a[168:171], v[220:223]
s_waitcnt lgkmcnt(10)
M v[224:227], a[32:35], a[176:179], 0
buffer_load_dword v21, v20, s[60:63], s54 offen
s_add_u32 s54, s54, 1048576
M v[224:227], a[36:39], a[180:183], v[224:227]
M v[228:231], a[44:47], a[180:183], 0
M v[228:231], a[40:43], a[176:179], v[228:231]
M v[232:235], a[48:51], a[176:179], 0
M v[232:235], a[52:55], a[180:183], v[232:235]
M v[236:239], a[60:63], a[180:183], 0
M v[236:239], a[56:59], a[176:179], v[236:239]
s_waitcnt vmcnt(9) lgkmcnt(0)
s_barrier
ds_read_b128 a[160:163], v10 offset:32768
ds_read_b128 a[164:167], v11 offset:32768
M v[240:243], a[64:67], a[176:179], 0
s_add_u32 m0, s29, 0
s_nop 0
buffer_load_dwordx4 v2, s[8:11], s23 offen offset:0 lds
M v[240:243], a[68:71], a[180:183], v[240:243]
M v[244:247], a[76:79], a[180:183], 0
M v[244:247], a[72:75], a[176:179], v[244:247]
M v[248:251], a[80:83], a[176:179], 0
M v[248:251], a[84:87], a[180:183], v[248:251]
buffer_load_dwordx4 v3, s[8:11], s23 offen offset:1024 lds
M v[252:255], a[92:95], a[180:183], 0
M v[252:255], a[88:91], a[176:179], v[252:255]
M a[0:3], a[32:35], a[184:187], 0
M a[0:3], a[36:39], a[188:191], a[0:3]
ds_read_b128 a[168:171], v10 offset:34816
ds_read_b128 a[172:175], v11 offset:34816
M a[4:7], a[44:47], a[188:191], 0
M a[4:7], a[40:43], a[184:187], a[4:7]
M a[8:11], a[48:51], a[184:187], 0
buffer_load_dwordx4 v4, s[8:11], s23 offen offset:2048 lds
M a[8:11], a[52:55], a[188:191], a[8:11]
M a[12:15], a[60:63], a[188:191], 0
M a[12:15], a[56:59], a[184:187], a[12:15]
M a[16:19], a[64:67], a[184:187], 0
M a[16:19], a[68:71], a[188:191], a[16:19]
buffer_load_dwordx4 v5, s[8:11], s23 offen offset:3072 lds
M a[20:23], a[76:79], a[188:191], 0
M a[20:23], a[72:75], a[184:187], a[20:23]
M a[24:27], a[80:83], a[184:187], 0
M a[24:27], a[84:87], a[188:191], a[24:27]
M a[28:31], a[92:95], a[188:191], 0
M a[28:31], a[88:91], a[184:187], a[28:31]
s_waitcnt lgkmcnt(2)
M v[32:35], a[96:99], a[160:163], v[32:35]
s_add_u32 m0, s29, 98304
s_nop 0
buffer_load_dwordx4 v6, s[12:15], s24 offen offset:0 lds
M v[32:35], a[100:103], a[164:167], v[32:35]
ds_read_b128 a[176:179], v10 offset:36864
ds_read_b128 a[180:183], v11 offset:36864
M v[36:39], a[108:111], a[164:167], v[36:39]
M v[36:39], a[104:107], a[160:163], v[36:39]
ds_read_b64_tr_b16 a[32:33], v12 offset:0
ds_read_b64_tr_b16 a[34:35], v12 offset:2048
M v[40:43], a[112:115], a[160:163], v[40:43]
M v[40:43], a[116:119], a[164:167], v[40:43]
M v[44:47], a[124:127], a[164:167], v[44:47]
M v[44:47], a[120:123], a[160:163], v[44:47]
ds_read_b64_tr_b16 a[40:41], v13 offset:0
ds_read_b64_tr_b16 a[42:43], v13 offset:2048
M v[48:51], a[128:131], a[160:163], v[48:51]
buffer_load_dwordx4 v7, s[12:15], s24 offen offset:1024 lds
M v[48:51], a[132:135], a[164:167], v[48:51]
M v[52:55], a[140:143], a[164:167], v[52:55]
M v[52:55], a[136:139], a[160:163], v[52:55]
ds_read_b64_tr_b16 a[48:49], v14 offset:0
ds_read_b64_tr_b16 a[50:51], v14 offset:2048
M v[56:59], a[144:147], a[160:163], v[56:59]
M v[56:59], a[148:151], a[164:167], v[56:59]
M v[60:63], a[156:159], a[164:167], v[60:63]
buffer_load_dwordx4 v8, s[12:15], s24 offen offset:2048 lds
M v[60:63], a[152:155], a[160:163], v[60:63]
s_waitcnt lgkmcnt(8)
ds_read_b64_tr_b16 a[56:57], v15 offset:0
ds_read_b64_tr_b16 a[58:59], v15 offset:2048
M v[64:67], a[96:99], a[168:171], v[64:67]
M v[64:67], a[100:103], a[172:175], v[64:67]
ds_read_b128 a[184:187], v10 offset:38912
ds_read_b128 a[188:191], v11 offset:38912
M v[68:71], a[108:111], a[172:175], v[68:71]
M v[68:71], a[104:107], a[168:171], v[68:71]
ds_read_b64_tr_b16 a[64:65], v16 offset:0
ds_read_b64_tr_b16 a[66:67], v16 offset:2048
M v[72:75], a[112:115], a[168:171], v[72:75]
M v[72:75], a[116:119], a[172:175], v[72:75]
M v[76:79], a[124:127], a[172:175], v[76:79]
M v[76:79], a[120:123], a[168:171], v[76:79]
ds_read_b64_tr_b16 a[72:73], v17 offset:0
ds_read_b64_tr_b16 a[74:75], v17 offset:2048
M v[80:83], a[128:131], a[168:171], v[80:83]
buffer_load_dwordx4 v9, s[12:15], s24 offen offset:3072 lds
M v[80:83], a[132:135], a[172:175], v[80:83]
M v[84:87], a[140:143], a[172:175], v[84:87]
M v[84:87], a[136:139], a[168:171], v[84:87]
ds_read_b64_tr_b16 a[80:81], v18 offset:0
ds_read_b64_tr_b16 a[82:83], v18 offset:2048
M v[88:91], a[144:147], a[168:171], v[88:91]
M v[88:91], a[148:151], a[172:175], v[88:91]
M v[92:95], a[156:159], a[172:175], v[92:95]
s_add_u32 s24, s24, 262144
M v[92:95], a[152:155], a[168:171], v[92:95]
s_waitcnt lgkmcnt(15)
ds_read_b64_tr_b16 a[88:89], v19 offset:0
ds_read_b64_tr_b16 a[90:91], v19 offset:2048
M v[96:99], a[96:99], a[176:179], v[96:99]
M v[96:99], a[100:103], a[180:183], v[96:99]
M v[100:103], a[108:111], a[180:183], v[100:103]
M v[100:103], a[104:107], a[176:179], v[100:103]
M v[104:107], a[112:115], a[176:179], v[104:107]
M v[104:107], a[116:119], a[180:183], v[104:107]
M v[108:111], a[124:127], a[180:183], v[108:111]
M v[108:111], a[120:123], a[176:179], v[108:111]
s_waitcnt vmcnt(9) lgkmcnt(0)
s_barrier
ds_read_b128 a[160:163], v10 offset:49152
ds_read_b128 a[164:167], v11 offset:49152
M v[112:115], a[128:131], a[176:179], v[112:115]
s_add_u32 m0, s29, 16384
s_add_u32 s3, s23, s31
buffer_load_dwordx4 v2, s[8:11], s3 offen offset:0 lds
M v[112:115], a[132:135], a[180:183], v[112:115]
M v[116:119], a[140:143], a[180:183], v[116:119]
M v[116:119], a[136:139], a[176:179], v[116:119]
ds_read_b64_tr_b16 a[36:37], v12 offset:16384
ds_read_b64_tr_b16 a[38:39], v12 offset:18432
M v[120:123], a[144:147], a[176:179], v[120:123]
M v[120:123], a[148:151], a[180:183], v[120:123]
buffer_load_dwordx4 v3, s[8:11], s3 offen offset:1024 lds
M v[124:127], a[156:159], a[180:183], v[124:127]
M v[124:127], a[152:155], a[176:179], v[124:127]
M v[128:131], a[96:99], a[184:187], v[128:131]
M v[128:131], a[100:103], a[188:191], v[128:131]
ds_read_b128 a[168:171], v10 offset:51200
ds_read_b128 a[172:175], v11 offset:51200
ds_read_b64_tr_b16 a[44:45], v13 offset:16384
ds_read_b64_tr_b16 a[46:47], v13 offset:18432
M v[132:135], a[108:111], a[188:191], v[132:135]
M v[132:135], a[104:107], a[184:187], v[132:135]
buffer_load_dwordx4 v4, s[8:11], s3 offen offset:2048 lds
M v[136:139], a[112:115], a[184:187], v[136:139]
M v[136:139], a[116:119], a[188:191], v[136:139]
M v[140:143], a[124:127], a[188:191], v[140:143]
M v[140:143], a[120:123], a[184:187], v[140:143]
ds_read_b64_tr_b16 a[52:53], v14 offset:16384
ds_read_b64_tr_b16 a[54:55], v14 offset:18432
M v[144:147], a[128:131], a[184:187], v[144:147]
M v[144:147], a[132:135], a[188:191], v[144:147]
buffer_load_dwordx4 v5, s[8:11], s3 offen offset:3072 lds
M v[148:151], a[140:143], a[188:191], v[148:151]
M v[148:151], a[136:139], a[184:187], v[148:151]
M v[152:155], a[144:147], a[184:187], v[152:155]
M v[152:155], a[148:151], a[188:191], v[152:155]
ds_read_b64_tr_b16 a[60:61], v15 offset:16384
ds_read_b64_tr_b16 a[62:63], v15 offset:18432
M v[156:159], a[156:159], a[188:191], v[156:159]
s_add_u32 s23, s23, 128
s_cmp_eq_u32 s23, s25
s_cselect_b32 s23, s26, s23
M v[156:159], a[152:155], a[184:187], v[156:159]
s_waitcnt lgkmcnt(10)
M v[160:163], a[96:99], a[160:163], v[160:163]
M v[160:163], a[100:103], a[164:167], v[160:163]
ds_read_b128 a[176:179], v10 offset:53248
ds_read_b128 a[180:183], v11 offset:53248
M v[164:167], a[108:111], a[164:167], v[164:167]
M v[164:167], a[104:107], a[160:163], v[164:167]
ds_read_b64_tr_b16 a[68:69], v16 offset:16384
ds_read_b64_tr_b16 a[70:71], v16 offset:18432
M v[168:171], a[112:115], a[160:163], v[168:171]
M v[168:171], a[116:119], a[164:167], v[168:171]
s_add_u32 m0, s29, 114688
s_nop 0
buffer_load_dwordx4 v6, s[12:15], s24 offen offset:0 lds
M v[172:175], a[124:127], a[164:167], v[172:175]
M v[172:175], a[120:123], a[160:163], v[172:175]
M v[176:179], a[128:131], a[160:163], v[176:179]
M v[176:179], a[132:135], a[164:167], v[176:179]
ds_read_b64_tr_b16 a[76:77], v17 offset:16384
ds_read_b64_tr_b16 a[78:79], v17 offset:18432
M v[180:183], a[140:143], a[164:167], v[180:183]
M v[180:183], a[136:139], a[160:163], v[180:183]
buffer_load_dwordx4 v7, s[12:15], s24 offen offset:1024 lds
M v[184:187], a[144:147], a[160:163], v[184:187]
M v[184:187], a[148:151], a[164:167], v[184:187]
M v[188:191], a[156:159], a[164:167], v[188:191]
M v[188:191], a[152:155], a[160:163], v[188:191]
s_waitcnt lgkmcnt(12)
ds_read_b64_tr_b16 a[84:85], v18 offset:16384
ds_read_b64_tr_b16 a[86:87], v18 offset:18432
M v[192:195], a[96:99], a[168:171], v[192:195]
buffer_load_dwordx4 v8, s[12:15], s24 offen offset:2048 lds
M v[192:195], a[100:103], a[172:175], v[192:195]
ds_read_b128 a[184:187], v10 offset:55296
ds_read_b128 a[188:191], v11 offset:55296
M v[196:199], a[108:111], a[172:175], v[196:199]
M v[196:199], a[104:107], a[168:171], v[196:199]
M v[200:203], a[112:115], a[168:171], v[200:203]
M v[200:203], a[116:119], a[172:175], v[200:203]
ds_read_b64_tr_b16 a[92:93], v19 offset:16384
ds_read_b64_tr_b16 a[94:95], v19 offset:18432
M v[204:207], a[124:127], a[172:175], v[204:207]
buffer_load_dwordx4 v9, s[12:15], s24 offen offset:3072 lds
M v[204:207], a[120:123], a[168:171], v[204:207]
M v[208:211], a[128:131], a[168:171], v[208:211]
M v[208:211], a[132:135], a[172:175], v[208:211]
M v[212:215], a[140:143], a[172:175], v[212:215]
M v[212:215], a[136:139], a[168:171], v[212:215]
s_add_u32 s24, s24, 262144
s_cmp_eq_u32 s24, s27
s_cselect_b32 s24, s28, s24
s_sub_u32 s6, s6, 1
s_cmp_eq_u32 s6, 0
s_cselect_b64 s[12:13], s[64:65], s[12:13]
M v[216:219], a[144:147], a[168:171], v[216:219]
M v[216:219], a[148:151], a[172:175], v[216:219]
M v[220:223], a[156:159], a[172:175], v[220:223]
M v[220:223], a[152:155], a[168:171], v[220:223]
s_waitcnt lgkmcnt(10)
M v[224:227], a[96:99], a[176:179], v[224:227]
buffer_load_dword v21, v20, s[60:63], s54 offen
s_add_u32 s54, s54, 1048576
M v[224:227], a[100:103], a[180:183], v[224:227]
M v[228:231], a[108:111], a[180:183], v[228:231]
M v[228:231], a[104:107], a[176:179], v[228:231]
M v[232:235], a[112:115], a[176:179], v[232:235]
M v[232:235], a[116:119], a[180:183], v[232:235]
M v[236:239], a[124:127], a[180:183], v[236:239]
M v[236:239], a[120:123], a[176:179], v[236:239]
s_waitcnt vmcnt(9) lgkmcnt(0)
s_barrier
ds_read_b128 a[160:163], v10 offset:0
ds_read_b128 a[164:167], v11 offset:0
M v[240:243], a[128:131], a[176:179], v[240:243]
s_add_u32 m0, s29, 32768
s_nop 0
buffer_load_dwordx4 v2, s[8:11], s23 offen offset:0 lds
M v[240:243], a[132:135], a[180:183], v[240:243]
M v[244:247], a[140:143], a[180:183], v[244:247]
M v[244:247], a[136:139], a[176:179], v[244:247]
M v[248:251], a[144:147], a[176:179], v[248:251]
M v[248:251], a[148:151], a[180:183], v[248:251]
buffer_load_dwordx4 v3, s[8:11], s23 offen offset:1024 lds
M v[252:255], a[156:159], a[180:183], v[252:255]
M v[252:255], a[152:155], a[176:179], v[252:255]
M a[0:3], a[96:99], a[184:187], a[0:3]
M a[0:3], a[100:103], a[188:191], a[0:3]
ds_read_b128 a[168:171], v10 offset:2048
ds_read_b128 a[172:175], v11 offset:2048
M a[4:7], a[108:111], a[188:191], a[4:7]
M a[4:7], a[104:107], a[184:187], a[4:7]
M a[8:11], a[112:115], a[184:187], a[8:11]
buffer_load_dwordx4 v4, s[8:11], s23 offen offset:2048 lds
M a[8:11], a[116:119], a[188:191], a[8:11]
M a[12:15], a[124:127], a[188:191], a[12:15]
M a[12:15], a[120:123], a[184:187], a[12:15]
M a[16:19], a[128:131], a[184:187], a[16:19]
M a[16:19], a[132:135], a[188:191], a[16:19]
buffer_load_dwordx4 v5, s[8:11], s23 offen offset:3072 lds
M a[20:23], a[140:143], a[188:191], a[20:23]
M a[20:23], a[136:139], a[184:187], a[20:23]
M a[24:27], a[144:147], a[184:187], a[24:27]
M a[24:27], a[148:151], a[188:191], a[24:27]
M a[28:31], a[156:159], a[188:191], a[28:31]
M a[28:31], a[152:155], a[184:187], a[28:31]
s_waitcnt lgkmcnt(2)
s_mov_b32 s30, 5
Lk1_ql:
M v[32:35], a[32:35], a[160:163], v[32:35]
s_add_u32 m0, s29, 65536
s_nop 0
buffer_load_dwordx4 v6, s[12:15], s24 offen offset:0 lds
M v[32:35], a[36:39], a[164:167], v[32:35]
ds_read_b128 a[176:179], v10 offset:4096
ds_read_b128 a[180:183], v11 offset:4096
M v[36:39], a[44:47], a[164:167], v[36:39]
M v[36:39], a[40:43], a[160:163], v[36:39]
ds_read_b64_tr_b16 a[96:97], v12 offset:32768
ds_read_b64_tr_b16 a[98:99], v12 offset:34816
M v[40:43], a[48:51], a[160:163], v[40:43]
M v[40:43], a[52:55], a[164:167], v[40:43]
M v[44:47], a[60:63], a[164:167], v[44:47]
M v[44:47], a[56:59], a[160:163], v[44:47]
ds_read_b64_tr_b16 a[104:105], v13 offset:32768
ds_read_b64_tr_b16 a[106:107], v13 offset:34816
M v[48:51], a[64:67], a[160:163], v[48:51]
buffer_load_dwordx4 v7, s[12:15], s24 offen offset:1024 lds
M v[48:51], a[68:71], a[164:167], v[48:51]
M v[52:55], a[76:79], a[164:167], v[52:55]
M v[52:55], a[72:75], a[160:163], v[52:55]
ds_read_b64_tr_b16 a[112:113], v14 offset:32768
ds_read_b64_tr_b16 a[114:115], v14 offset:34816
M v[56:59], a[80:83], a[160:163], v[56:59]
M v[56:59], a[84:87], a[164:167], v[56:59]
M v[60:63], a[92:95], a[164:167], v[60:63]
buffer_load_dwordx4 v8, s[12:15], s24 offen offset:2048 lds
M v[60:63], a[88:91], a[160:163], v[60:63]
s_waitcnt lgkmcnt(8)
ds_read_b64_tr_b16 a[120:121], v15 offset:32768
ds_read_b64_tr_b16 a[122:123], v15 offset:34816
M v[64:67], a[32:35], a[168:171], v[64:67]
M v[64:67], a[36:39], a[172:175], v[64:67]
ds_read_b128 a[184:187], v10 offset:6144
ds_read_b128 a[188:191], v11 offset:6144
M v[68:71], a[44:47], a[172:175], v[68:71]
M v[68:71], a[40:43], a[168:171], v[68:71]
ds_read_b64_tr_b16 a[128:129], v16 offset:32768
ds_read_b64_tr_b16 a[130:131], v16 offset:34816
M v[72:75], a[48:51], a[168:171], v[72:75]
M v[72:75], a[52:55], a[172:175], v[72:75]
M v[76:79], a[60:63], a[172:175], v[76:79]
M v[76:79], a[56:59], a[168:171], v[76:79]
ds_read_b64_tr_b16 a[136:137], v17 offset:32768
ds_read_b64_tr_b16 a[138:139], v17 offset:34816
M v[80:83], a[64:67], a[168:171], v[80:83]
buffer_load_dwordx4 v9, s[12:15], s24 offen offset:3072 lds
M v[80:83], a[68:71], a[172:175], v[80:83]
M v[84:87], a[76:79], a[172:175], v[84:87]
M v[84:87], a[72:75], a[168:171], v[84:87]
ds_read_b64_tr_b16 a[144:145], v18 offset:32768
ds_read_b64_tr_b16 a[146:147], v18 offset:34816
M v[88:91], a[80:83], a[168:171], v[88:91]
M v[88:91], a[84:87], a[172:175], v[88:91]
M v[92:95], a[92:95], a[172:175], v[92:95]
s_add_u32 s24, s24, 262144
M v[92:95], a[88:91], a[168:171], v[92:95]
s_waitcnt lgkmcnt(15)
ds_read_b64_tr_b16 a[152:153], v19 offset:32768
ds_read_b64_tr_b16 a[154:155], v19 offset:34816
M v[96:99], a[32:35], a[176:179], v[96:99]
M v[96:99], a[36:39], a[180:183], v[96:99]
M v[100:103], a[44:47], a[180:183], v[100:103]
M v[100:103], a[40:43], a[176:179], v[100:103]
M v[104:107], a[48:51], a[176:179], v[104:107]
M v[104:107], a[52:55], a[180:183], v[104:107]
M v[108:111], a[60:63], a[180:183], v[108:111]
M v[108:111], a[56:59], a[176:179], v[108:111]
s_waitcnt vmcnt(9) lgkmcnt(0)
s_barrier
ds_read_b128 a[160:163], v10 offset:16384
ds_read_b128 a[164:167], v11 offset:16384
M v[112:115], a[64:67], a[176:179], v[112:115]
s_add_u32 m0, s29, 49152
s_add_u32 s3, s23, s31
buffer_load_dwordx4 v2, s[8:11], s3 offen offset:0 lds
M v[112:115], a[68:71], a[180:183], v[112:115]
M v[116:119], a[76:79], a[180:183], v[116:119]
M v[116:119], a[72:75], a[176:179], v[116:119]
ds_read_b64_tr_b16 a[100:101], v12 offset:49152
ds_read_b64_tr_b16 a[102:103], v12 offset:51200
M v[120:123], a[80:83], a[176:179], v[120:123]
M v[120:123], a[84:87], a[180:183], v[120:123]
buffer_load_dwordx4 v3, s[8:11], s3 offen offset:1024 lds
M v[124:127], a[92:95], a[180:183], v[124:127]
M v[124:127], a[88:91], a[176:179], v[124:127]
M v[128:131], a[32:35], a[184:187], v[128:131]
M v[128:131], a[36:39], a[188:191], v[128:131]
ds_read_b128 a[168:171], v10 offset:18432
ds_read_b128 a[172:175], v11 offset:18432
ds_read_b64_tr_b16 a[108:109], v13 offset:49152
ds_read_b64_tr_b16 a[110:111], v13 offset:51200
M v[132:135], a[44:47], a[188:191], v[132:135]
M v[132:135], a[40:43], a[184:187], v[132:135]
buffer_load_dwordx4 v4, s[8:11], s3 offen offset:2048 lds
M v[136:139], a[48:51], a[184:187], v[136:139]
M v[136:139], a[52:55], a[188:191], v[136:139]
M v[140:143], a[60:63], a[188:191], v[140:143]
M v[140:143], a[56:59], a[184:187], v[140:143]
ds_read_b64_tr_b16 a[116:117], v14 offset:49152
ds_read_b64_tr_b16 a[118:119], v14 offset:51200
M v[144:147], a[64:67], a[184:187], v[144:147]
M v[144:147], a[68:71], a[188:191], v[144:147]
buffer_load_dwordx4 v5, s[8:11], s3 offen offset:3072 lds
M v[148:151], a[76:79], a[188:191], v[148:151]
M v[148:151], a[72:75], a[184:187], v[148:151]
M v[152:155], a[80:83], a[184:187], v[152:155]
M v[152:155], a[84:87], a[188:191], v[152:155]
ds_read_b64_tr_b16 a[124:125], v15 offset:49152
ds_read_b64_tr_b16 a[126:127], v15 offset:51200
M v[156:159], a[92:95], a[188:191], v[156:159]
s_add_u32 s23, s23, 128
s_cmp_eq_u32 s23, s25
s_cselect_b32 s23, s26, s23
M v[156:159], a[88:91], a[184:187], v[156:159]
s_waitcnt lgkmcnt(10)
M v[160:163], a[32:35], a[160:163], v[160:163]
M v[160:163], a[36:39], a[164:167], v[160:163]
ds_read_b128 a[176:179], v10 offset:20480
ds_read_b128 a[180:183], v11 offset:20480
M v[164:167], a[44:47], a[164:167], v[164:167]
M v[164:167], a[40:43], a[160:163], v[164:167]
ds_read_b64_tr_b16 a[132:133], v16 offset:49152
ds_read_b64_tr_b16 a[134:135], v16 offset:51200
M v[168:171], a[48:51], a[160:163], v[168:171]
M v[168:171], a[52:55], a[164:167], v[168:171]
s_add_u32 m0, s29, 81920
s_nop 0
buffer_load_dwordx4 v6, s[12:15], s24 offen offset:0 lds
M v[172:175], a[60:63], a[164:167], v[172:175]
M v[172:175], a[56:59], a[160:163], v[172:175]
M v[176:179], a[64:67], a[160:163], v[176:179]
M v[176:179], a[68:71], a[164:167], v[176:179]
ds_read_b64_tr_b16 a[140:141], v17 offset:49152
ds_read_b64_tr_b16 a[142:143], v17 offset:51200
M v[180:183], a[76:79], a[164:167], v[180:183]
M v[180:183], a[72:75], a[160:163], v[180:183]
buffer_load_dwordx4 v7, s[12:15], s24 offen offset:1024 lds
M v[184:187], a[80:83], a[160:163], v[184:187]
M v[184:187], a[84:87], a[164:167], v[184:187]
M v[188:191], a[92:95], a[164:167], v[188:191]
M v[188:191], a[88:91], a[160:163], v[188:191]
s_waitcnt lgkmcnt(12)
ds_read_b64_tr_b16 a[148:149], v18 offset:49152
ds_read_b64_tr_b16 a[150:151], v18 offset:51200
M v[192:195], a[32:35], a[168:171], v[192:195]
buffer_load_dwordx4 v8, s[12:15], s24 offen offset:2048 lds
M v[192:195], a[36:39], a[172:175], v[192:195]
ds_read_b128 a[184:187], v10 offset:22528
ds_read_b128 a[188:191], v11 offset:22528
M v[196:199], a[44:47], a[172:175], v[196:199]
M v[196:199], a[40:43], a[168:171], v[196:199]
M v[200:203], a[48:51], a[168:171], v[200:203]
M v[200:203], a[52:55], a[172:175], v[200:203]
ds_read_b64_tr_b16 a[156:157], v19 offset:49152
ds_read_b64_tr_b16 a[158:159], v19 offset:51200
M v[204:207], a[60:63], a[172:175], v[204:207]
buffer_load_dwordx4 v9, s[12:15], s24 offen offset:3072 lds
M v[204:207], a[56:59], a[168:171], v[204:207]
M v[208:211], a[64:67], a[168:171], v[208:211]
M v[208:211], a[68:71], a[172:175], v[208:211]
M v[212:215], a[76:79], a[172:175], v[212:215]
M v[212:215], a[72:75], a[168:171], v[212:215]
s_add_u32 s24, s24, 262144
s_cmp_eq_u32 s24, s27
s_cselect_b32 s24, s28, s24
s_sub_u32 s6, s6, 1
s_cmp_eq_u32 s6, 0
s_cselect_b64 s[12:13], s[64:65], s[12:13]
M v[216:219], a[80:83], a[168:171], v[216:219]
M v[216:219], a[84:87], a[172:175], v[216:219]
M v[220:223], a[92:95], a[172:175], v[220:223]
M v[220:223], a[88:91], a[168:171], v[220:223]
s_waitcnt lgkmcnt(10)
M v[224:227], a[32:35], a[176:179], v[224:227]
buffer_load_dword v21, v20, s[60:63], s54 offen
s_add_u32 s54, s54, 1048576
M v[224:227], a[36:39], a[180:183], v[224:227]
M v[228:231], a[44:47], a[180:183], v[228:231]
M v[228:231], a[40:43], a[176:179], v[228:231]
M v[232:235], a[48:51], a[176:179], v[232:235]
M v[232:235], a[52:55], a[180:183], v[232:235]
M v[236:239], a[60:63], a[180:183], v[236:239]
M v[236:239], a[56:59], a[176:179], v[236:239]
s_waitcnt vmcnt(9) lgkmcnt(0)
s_barrier
ds_read_b128 a[160:163], v10 offset:32768
ds_read_b128 a[164:167], v11 offset:32768
M v[240:243], a[64:67], a[176:179], v[240:243]
s_add_u32 m0, s29, 0
s_nop 0
buffer_load_dwordx4 v2, s[8:11], s23 offen offset:0 lds
M v[240:243], a[68:71], a[180:183], v[240:243]
M v[244:247], a[76:79], a[180:183], v[244:247]
M v[244:247], a[72:75], a[176:179], v[244:247]
M v[248:251], a[80:83], a[176:179], v[248:251]
M v[248:251], a[84:87], a[180:183], v[248:251]
buffer_load_dwordx4 v3, s[8:11], s23 offen offset:1024 lds
M v[252:255], a[92:95], a[180:183], v[252:255]
M v[252:255], a[88:91], a[176:179], v[252:255]
M a[0:3], a[32:35], a[184:187], a[0:3]
M a[0:3], a[36:39], a[188:191], a[0:3]
ds_read_b128 a[168:171], v10 offset:34816
ds_read_b128 a[172:175], v11 offset:34816
M a[4:7], a[44:47], a[188:191], a[4:7]
M a[4:7], a[40:43], a[184:187], a[4:7]
M a[8:11], a[48:51], a[184:187], a[8:11]
buffer_load_dwordx4 v4, s[8:11], s23 offen offset:2048 lds
M a[8:11], a[52:55], a[188:191], a[8:11]
M a[12:15], a[60:63], a[188:191], a[12:15]
M a[12:15], a[56:59], a[184:187], a[12:15]
M a[16:19], a[64:67], a[184:187], a[16:19]
M a[16:19], a[68:71], a[188:191], a[16:19]
buffer_load_dwordx4 v5, s[8:11], s23 offen offset:3072 lds
M a[20:23], a[76:79], a[188:191], a[20:23]
M a[20:23], a[72:75], a[184:187], a[20:23]
M a[24:27], a[80:83], a[184:187], a[24:27]
M a[24:27], a[84:87], a[188:191], a[24:27]
M a[28:31], a[92:95], a[188:191], a[28:31]
M a[28:31], a[88:91], a[184:187], a[28:31]
s_waitcnt lgkmcnt(2)
M v[32:35], a[96:99], a[160:163], v[32:35]
s_add_u32 m0, s29, 98304
s_nop 0
buffer_load_dwordx4 v6, s[12:15], s24 offen offset:0 lds
M v[32:35], a[100:103], a[164:167], v[32:35]
ds_read_b128 a[176:179], v10 offset:36864
ds_read_b128 a[180:183], v11 offset:36864
M v[36:39], a[108:111], a[164:167], v[36:39]
M v[36:39], a[104:107], a[160:163], v[36:39]
ds_read_b64_tr_b16 a[32:33], v12 offset:0
ds_read_b64_tr_b16 a[34:35], v12 offset:2048
M v[40:43], a[112:115], a[160:163], v[40:43]
M v[40:43], a[116:119], a[164:167], v[40:43]
M v[44:47], a[124:127], a[164:167], v[44:47]
M v[44:47], a[120:123], a[160:163], v[44:47]
ds_read_b64_tr_b16 a[40:41], v13 offset:0
ds_read_b64_tr_b16 a[42:43], v13 offset:2048
M v[48:51], a[128:131], a[160:163], v[48:51]
buffer_load_dwordx4 v7, s[12:15], s24 offen offset:1024 lds
M v[48:51], a[132:135], a[164:167], v[48:51]
M v[52:55], a[140:143], a[164:167], v[52:55]
M v[52:55], a[136:139], a[160:163], v[52:55]
ds_read_b64_tr_b16 a[48:49], v14 offset:0
ds_read_b64_tr_b16 a[50:51], v14 offset:2048
M v[56:59], a[144:147], a[160:163], v[56:59]
M v[56:59], a[148:151], a[164:167], v[56:59]
M v[60:63], a[156:159], a[164:167], v[60:63]
buffer_load_dwordx4 v8, s[12:15], s24 offen offset:2048 lds
M v[60:63], a[152:155], a[160:163], v[60:63]
s_waitcnt lgkmcnt(8)
ds_read_b64_tr_b16 a[56:57], v15 offset:0
ds_read_b64_tr_b16 a[58:59], v15 offset:2048
M v[64:67], a[96:99], a[168:171], v[64:67]
M v[64:67], a[100:103], a[172:175], v[64:67]
ds_read_b128 a[184:187], v10 offset:38912
ds_read_b128 a[188:191], v11 offset:38912
M v[68:71], a[108:111], a[172:175], v[68:71]
M v[68:71], a[104:107], a[168:171], v[68:71]
ds_read_b64_tr_b16 a[64:65], v16 offset:0
ds_read_b64_tr_b16 a[66:67], v16 offset:2048
M v[72:75], a[112:115], a[168:171], v[72:75]
M v[72:75], a[116:119], a[172:175], v[72:75]
M v[76:79], a[124:127], a[172:175], v[76:79]
M v[76:79], a[120:123], a[168:171], v[76:79]
ds_read_b64_tr_b16 a[72:73], v17 offset:0
ds_read_b64_tr_b16 a[74:75], v17 offset:2048
M v[80:83], a[128:131], a[168:171], v[80:83]
buffer_load_dwordx4 v9, s[12:15], s24 offen offset:3072 lds
M v[80:83], a[132:135], a[172:175], v[80:83]
M v[84:87], a[140:143], a[172:175], v[84:87]
M v[84:87], a[136:139], a[168:171], v[84:87]
ds_read_b64_tr_b16 a[80:81], v18 offset:0
ds_read_b64_tr_b16 a[82:83], v18 offset:2048
M v[88:91], a[144:147], a[168:171], v[88:91]
M v[88:91], a[148:151], a[172:175], v[88:91]
M v[92:95], a[156:159], a[172:175], v[92:95]
s_add_u32 s24, s24, 262144
M v[92:95], a[152:155], a[168:171], v[92:95]
s_waitcnt lgkmcnt(15)
ds_read_b64_tr_b16 a[88:89], v19 offset:0
ds_read_b64_tr_b16 a[90:91], v19 offset:2048
M v[96:99], a[96:99], a[176:179], v[96:99]
M v[96:99], a[100:103], a[180:183], v[96:99]
M v[100:103], a[108:111], a[180:183], v[100:103]
M v[100:103], a[104:107], a[176:179], v[100:103]
M v[104:107], a[112:115], a[176:179], v[104:107]
M v[104:107], a[116:119], a[180:183], v[104:107]
M v[108:111], a[124:127], a[180:183], v[108:111]
M v[108:111], a[120:123], a[176:179], v[108:111]
s_waitcnt vmcnt(9) lgkmcnt(0)
s_barrier
ds_read_b128 a[160:163], v10 offset:49152
ds_read_b128 a[164:167], v11 offset:49152
M v[112:115], a[128:131], a[176:179], v[112:115]
s_add_u32 m0, s29, 16384
s_add_u32 s3, s23, s31
buffer_load_dwordx4 v2, s[8:11], s3 offen offset:0 lds
M v[112:115], a[132:135], a[180:183], v[112:115]
M v[116:119], a[140:143], a[180:183], v[116:119]
M v[116:119], a[136:139], a[176:179], v[116:119]
ds_read_b64_tr_b16 a[36:37], v12 offset:16384
ds_read_b64_tr_b16 a[38:39], v12 offset:18432
M v[120:123], a[144:147], a[176:179], v[120:123]
M v[120:123], a[148:151], a[180:183], v[120:123]
buffer_load_dwordx4 v3, s[8:11], s3 offen offset:1024 lds
M v[124:127], a[156:159], a[180:183], v[124:127]
M v[124:127], a[152:155], a[176:179], v[124:127]
M v[128:131], a[96:99], a[184:187], v[128:131]
M v[128:131], a[100:103], a[188:191], v[128:131]
ds_read_b128 a[168:171], v10 offset:51200
ds_read_b128 a[172:175], v11 offset:51200
ds_read_b64_tr_b16 a[44:45], v13 offset:16384
ds_read_b64_tr_b16 a[46:47], v13 offset:18432
M v[132:135], a[108:111], a[188:191], v[132:135]
M v[132:135], a[104:107], a[184:187], v[132:135]
buffer_load_dwordx4 v4, s[8:11], s3 offen offset:2048 lds
M v[136:139], a[112:115], a[184:187], v[136:139]
M v[136:139], a[116:119], a[188:191], v[136:139]
M v[140:143], a[124:127], a[188:191], v[140:143]
M v[140:143], a[120:123], a[184:187], v[140:143]
ds_read_b64_tr_b16 a[52:53], v14 offset:16384
ds_read_b64_tr_b16 a[54:55], v14 offset:18432
M v[144:147], a[128:131], a[184:187], v[144:147]
M v[144:147], a[132:135], a[188:191], v[144:147]
buffer_load_dwordx4 v5, s[8:11], s3 offen offset:3072 lds
M v[148:151], a[140:143], a[188:191], v[148:151]
M v[148:151], a[136:139], a[184:187], v[148:151]
M v[152:155], a[144:147], a[184:187], v[152:155]
M v[152:155], a[148:151], a[188:191], v[152:155]
ds_read_b64_tr_b16 a[60:61], v15 offset:16384
ds_read_b64_tr_b16 a[62:63], v15 offset:18432
M v[156:159], a[156:159], a[188:191], v[156:159]
s_add_u32 s23, s23, 128
s_cmp_eq_u32 s23, s25
s_cselect_b32 s23, s26, s23
M v[156:159], a[152:155], a[184:187], v[156:159]
s_waitcnt lgkmcnt(10)
M v[160:163], a[96:99], a[160:163], v[160:163]
M v[160:163], a[100:103], a[164:167], v[160:163]
ds_read_b128 a[176:179], v10 offset:53248
ds_read_b128 a[180:183], v11 offset:53248
M v[164:167], a[108:111], a[164:167], v[164:167]
M v[164:167], a[104:107], a[160:163], v[164:167]
ds_read_b64_tr_b16 a[68:69], v16 offset:16384
ds_read_b64_tr_b16 a[70:71], v16 offset:18432
M v[168:171], a[112:115], a[160:163], v[168:171]
M v[168:171], a[116:119], a[164:167], v[168:171]
s_add_u32 m0, s29, 114688
s_nop 0
buffer_load_dwordx4 v6, s[12:15], s24 offen offset:0 lds
M v[172:175], a[124:127], a[164:167], v[172:175]
M v[172:175], a[120:123], a[160:163], v[172:175]
M v[176:179], a[128:131], a[160:163], v[176:179]
M v[176:179], a[132:135], a[164:167], v[176:179]
ds_read_b64_tr_b16 a[76:77], v17 offset:16384
ds_read_b64_tr_b16 a[78:79], v17 offset:18432
M v[180:183], a[140:143], a[164:167], v[180:183]
M v[180:183], a[136:139], a[160:163], v[180:183]
buffer_load_dwordx4 v7, s[12:15], s24 offen offset:1024 lds
M v[184:187], a[144:147], a[160:163], v[184:187]
M v[184:187], a[148:151], a[164:167], v[184:187]
M v[188:191], a[156:159], a[164:167], v[188:191]
M v[188:191], a[152:155], a[160:163], v[188:191]
s_waitcnt lgkmcnt(12)
ds_read_b64_tr_b16 a[84:85], v18 offset:16384
ds_read_b64_tr_b16 a[86:87], v18 offset:18432
M v[192:195], a[96:99], a[168:171], v[192:195]
buffer_load_dwordx4 v8, s[12:15], s24 offen offset:2048 lds
M v[192:195], a[100:103], a[172:175], v[192:195]
ds_read_b128 a[184:187], v10 offset:55296
ds_read_b128 a[188:191], v11 offset:55296
M v[196:199], a[108:111], a[172:175], v[196:199]
M v[196:199], a[104:107], a[168:171], v[196:199]
M v[200:203], a[112:115], a[168:171], v[200:203]
M v[200:203], a[116:119], a[172:175], v[200:203]
ds_read_b64_tr_b16 a[92:93], v19 offset:16384
ds_read_b64_tr_b16 a[94:95], v19 offset:18432
M v[204:207], a[124:127], a[172:175], v[204:207]
buffer_load_dwordx4 v9, s[12:15], s24 offen offset:3072 lds
M v[204:207], a[120:123], a[168:171], v[204:207]
M v[208:211], a[128:131], a[168:171], v[208:211]
M v[208:211], a[132:135], a[172:175], v[208:211]
M v[212:215], a[140:143], a[172:175], v[212:215]
M v[212:215], a[136:139], a[168:171], v[212:215]
s_add_u32 s24, s24, 262144
s_cmp_eq_u32 s24, s27
s_cselect_b32 s24, s28, s24
s_sub_u32 s6, s6, 1
s_cmp_eq_u32 s6, 0
s_cselect_b64 s[12:13], s[64:65], s[12:13]
M v[216:219], a[144:147], a[168:171], v[216:219]
M v[216:219], a[148:151], a[172:175], v[216:219]
M v[220:223], a[156:159], a[172:175], v[220:223]
M v[220:223], a[152:155], a[168:171], v[220:223]
s_waitcnt lgkmcnt(10)
M v[224:227], a[96:99], a[176:179], v[224:227]
buffer_load_dword v21, v20, s[60:63], s54 offen
s_add_u32 s54, s54, 1048576
M v[224:227], a[100:103], a[180:183], v[224:227]
M v[228:231], a[108:111], a[180:183], v[228:231]
M v[228:231], a[104:107], a[176:179], v[228:231]
M v[232:235], a[112:115], a[176:179], v[232:235]
M v[232:235], a[116:119], a[180:183], v[232:235]
M v[236:239], a[124:127], a[180:183], v[236:239]
M v[236:239], a[120:123], a[176:179], v[236:239]
s_waitcnt vmcnt(9) lgkmcnt(0)
s_barrier
ds_read_b128 a[160:163], v10 offset:0
ds_read_b128 a[164:167], v11 offset:0
M v[240:243], a[128:131], a[176:179], v[240:243]
s_add_u32 m0, s29, 32768
s_nop 0
buffer_load_dwordx4 v2, s[8:11], s23 offen offset:0 lds
M v[240:243], a[132:135], a[180:183], v[240:243]
M v[244:247], a[140:143], a[180:183], v[244:247]
M v[244:247], a[136:139], a[176:179], v[244:247]
M v[248:251], a[144:147], a[176:179], v[248:251]
M v[248:251], a[148:151], a[180:183], v[248:251]
buffer_load_dwordx4 v3, s[8:11], s23 offen offset:1024 lds
M v[252:255], a[156:159], a[180:183], v[252:255]
M v[252:255], a[152:155], a[176:179], v[252:255]
M a[0:3], a[96:99], a[184:187], a[0:3]
M a[0:3], a[100:103], a[188:191], a[0:3]
ds_read_b128 a[168:171], v10 offset:2048
ds_read_b128 a[172:175], v11 offset:2048
M a[4:7], a[108:111], a[188:191], a[4:7]
M a[4:7], a[104:107], a[184:187], a[4:7]
M a[8:11], a[112:115], a[184:187], a[8:11]
buffer_load_dwordx4 v4, s[8:11], s23 offen offset:2048 lds
M a[8:11], a[116:119], a[188:191], a[8:11]
M a[12:15], a[124:127], a[188:191], a[12:15]
M a[12:15], a[120:123], a[184:187], a[12:15]
M a[16:19], a[128:131], a[184:187], a[16:19]
M a[16:19], a[132:135], a[188:191], a[16:19]
buffer_load_dwordx4 v5, s[8:11], s23 offen offset:3072 lds
M a[20:23], a[140:143], a[188:191], a[20:23]
M a[20:23], a[136:139], a[184:187], a[20:23]
M a[24:27], a[144:147], a[184:187], a[24:27]
M a[24:27], a[148:151], a[188:191], a[24:27]
M a[28:31], a[156:159], a[188:191], a[28:31]
M a[28:31], a[152:155], a[184:187], a[28:31]
s_waitcnt lgkmcnt(2)
s_sub_u32 s30, s30, 1
s_cmp_lg_u32 s30, 0
s_cbranch_scc1 Lk1_ql
M v[32:35], a[32:35], a[160:163], v[32:35]
s_add_u32 m0, s29, 65536
s_nop 0
buffer_load_dwordx4 v6, s[12:15], s24 offen offset:0 lds
M v[32:35], a[36:39], a[164:167], v[32:35]
ds_read_b128 a[176:179], v10 offset:4096
ds_read_b128 a[180:183], v11 offset:4096
M v[36:39], a[44:47], a[164:167], v[36:39]
M v[36:39], a[40:43], a[160:163], v[36:39]
ds_read_b64_tr_b16 a[96:97], v12 offset:32768
ds_read_b64_tr_b16 a[98:99], v12 offset:34816
M v[40:43], a[48:51], a[160:163], v[40:43]
M v[40:43], a[52:55], a[164:167], v[40:43]
M v[44:47], a[60:63], a[164:167], v[44:47]
M v[44:47], a[56:59], a[160:163], v[44:47]
ds_read_b64_tr_b16 a[104:105], v13 offset:32768
ds_read_b64_tr_b16 a[106:107], v13 offset:34816
M v[48:51], a[64:67], a[160:163], v[48:51]
buffer_load_dwordx4 v7, s[12:15], s24 offen offset:1024 lds
M v[48:51], a[68:71], a[164:167], v[48:51]
M v[52:55], a[76:79], a[164:167], v[52:55]
M v[52:55], a[72:75], a[160:163], v[52:55]
ds_read_b64_tr_b16 a[112:113], v14 offset:32768
ds_read_b64_tr_b16 a[114:115], v14 offset:34816
M v[56:59], a[80:83], a[160:163], v[56:59]
M v[56:59], a[84:87], a[164:167], v[56:59]
M v[60:63], a[92:95], a[164:167], v[60:63]
buffer_load_dwordx4 v8, s[12:15], s24 offen offset:2048 lds
M v[60:63], a[88:91], a[160:163], v[60:63]
s_waitcnt lgkmcnt(8)
ds_read_b64_tr_b16 a[120:121], v15 offset:32768
ds_read_b64_tr_b16 a[122:123], v15 offset:34816
M v[64:67], a[32:35], a[168:171], v[64:67]
M v[64:67], a[36:39], a[172:175], v[64:67]
ds_read_b128 a[184:187], v10 offset:6144
ds_read_b128 a[188:191], v11 offset:6144
M v[68:71], a[44:47], a[172:175], v[68:71]
M v[68:71], a[40:43], a[168:171], v[68:71]
ds_read_b64_tr_b16 a[128:129], v16 offset:32768
ds_read_b64_tr_b16 a[130:131], v16 offset:34816
M v[72:75], a[48:51], a[168:171], v[72:75]
M v[72:75], a[52:55], a[172:175], v[72:75]
M v[76:79], a[60:63], a[172:175], v[76:79]
M v[76:79], a[56:59], a[168:171], v[76:79]
ds_read_b64_tr_b16 a[136:137], v17 offset:32768
ds_read_b64_tr_b16 a[138:139], v17 offset:34816
M v[80:83], a[64:67], a[168:171], v[80:83]
buffer_load_dwordx4 v9, s[12:15], s24 offen offset:3072 lds
M v[80:83], a[68:71], a[172:175], v[80:83]
M v[84:87], a[76:79], a[172:175], v[84:87]
M v[84:87], a[72:75], a[168:171], v[84:87]
ds_read_b64_tr_b16 a[144:145], v18 offset:32768
ds_read_b64_tr_b16 a[146:147], v18 offset:34816
M v[88:91], a[80:83], a[168:171], v[88:91]
M v[88:91], a[84:87], a[172:175], v[88:91]
M v[92:95], a[92:95], a[172:175], v[92:95]
s_add_u32 s24, s24, 262144
M v[92:95], a[88:91], a[168:171], v[92:95]
s_waitcnt lgkmcnt(15)
ds_read_b64_tr_b16 a[152:153], v19 offset:32768
ds_read_b64_tr_b16 a[154:155], v19 offset:34816
M v[96:99], a[32:35], a[176:179], v[96:99]
M v[96:99], a[36:39], a[180:183], v[96:99]
M v[100:103], a[44:47], a[180:183], v[100:103]
M v[100:103], a[40:43], a[176:179], v[100:103]
M v[104:107], a[48:51], a[176:179], v[104:107]
M v[104:107], a[52:55], a[180:183], v[104:107]
M v[108:111], a[60:63], a[180:183], v[108:111]
M v[108:111], a[56:59], a[176:179], v[108:111]
s_waitcnt vmcnt(9) lgkmcnt(0)
s_barrier
ds_read_b128 a[160:163], v10 offset:16384
ds_read_b128 a[164:167], v11 offset:16384
M v[112:115], a[64:67], a[176:179], v[112:115]
s_add_u32 m0, s29, 49152
s_add_u32 s3, s23, s31
buffer_load_dwordx4 v2, s[8:11], s3 offen offset:0 lds
M v[112:115], a[68:71], a[180:183], v[112:115]
M v[116:119], a[76:79], a[180:183], v[116:119]
M v[116:119], a[72:75], a[176:179], v[116:119]
ds_read_b64_tr_b16 a[100:101], v12 offset:49152
ds_read_b64_tr_b16 a[102:103], v12 offset:51200
M v[120:123], a[80:83], a[176:179], v[120:123]
M v[120:123], a[84:87], a[180:183], v[120:123]
buffer_load_dwordx4 v3, s[8:11], s3 offen offset:1024 lds
M v[124:127], a[92:95], a[180:183], v[124:127]
M v[124:127], a[88:91], a[176:179], v[124:127]
M v[128:131], a[32:35], a[184:187], v[128:131]
M v[128:131], a[36:39], a[188:191], v[128:131]
ds_read_b128 a[168:171], v10 offset:18432
ds_read_b128 a[172:175], v11 offset:18432
ds_read_b64_tr_b16 a[108:109], v13 offset:49152
ds_read_b64_tr_b16 a[110:111], v13 offset:51200
M v[132:135], a[44:47], a[188:191], v[132:135]
M v[132:135], a[40:43], a[184:187], v[132:135]
M v[136:139], a[48:51], a[184:187], v[136:139]
buffer_load_dwordx4 v4, s[8:11], s3 offen offset:2048 lds
M v[136:139], a[52:55], a[188:191], v[136:139]
M v[140:143], a[60:63], a[188:191], v[140:143]
M v[140:143], a[56:59], a[184:187], v[140:143]
ds_read_b64_tr_b16 a[116:117], v14 offset:49152
ds_read_b64_tr_b16 a[118:119], v14 offset:51200
M v[144:147], a[64:67], a[184:187], v[144:147]
M v[144:147], a[68:71], a[188:191], v[144:147]
M v[148:151], a[76:79], a[188:191], v[148:151]
buffer_load_dwordx4 v5, s[8:11], s3 offen offset:3072 lds
M v[148:151], a[72:75], a[184:187], v[148:151]
M v[152:155], a[80:83], a[184:187], v[152:155]
M v[152:155], a[84:87], a[188:191], v[152:155]
ds_read_b64_tr_b16 a[124:125], v15 offset:49152
ds_read_b64_tr_b16 a[126:127], v15 offset:51200
M v[156:159], a[92:95], a[188:191], v[156:159]
M v[156:159], a[88:91], a[184:187], v[156:159]
s_waitcnt lgkmcnt(10)
M v[160:163], a[32:35], a[160:163], v[160:163]
M v[160:163], a[36:39], a[164:167], v[160:163]
ds_read_b128 a[176:179], v10 offset:20480
ds_read_b128 a[180:183], v11 offset:20480
M v[164:167], a[44:47], a[164:167], v[164:167]
s_add_u32 s23, s23, 128
s_cmp_eq_u32 s23, s25
s_cselect_b32 s23, s26, s23
M v[164:167], a[40:43], a[160:163], v[164:167]
ds_read_b64_tr_b16 a[132:133], v16 offset:49152
ds_read_b64_tr_b16 a[134:135], v16 offset:51200
M v[168:171], a[48:51], a[160:163], v[168:171]
M v[168:171], a[52:55], a[164:167], v[168:171]
M v[172:175], a[60:63], a[164:167], v[172:175]
M v[172:175], a[56:59], a[160:163], v[172:175]
M v[176:179], a[64:67], a[160:163], v[176:179]
s_add_u32 m0, s29, 81920
s_nop 0
buffer_load_dwordx4 v6, s[12:15], s24 offen offset:0 lds
M v[176:179], a[68:71], a[164:167], v[176:179]
ds_read_b64_tr_b16 a[140:141], v17 offset:49152
ds_read_b64_tr_b16 a[142:143], v17 offset:51200
M v[180:183], a[76:79], a[164:167], v[180:183]
M v[180:183], a[72:75], a[160:163], v[180:183]
M v[184:187], a[80:83], a[160:163], v[184:187]
M v[184:187], a[84:87], a[164:167], v[184:187]
buffer_load_dwordx4 v7, s[12:15], s24 offen offset:1024 lds
M v[188:191], a[92:95], a[164:167], v[188:191]
M v[188:191], a[88:91], a[160:163], v[188:191]
s_waitcnt lgkmcnt(12)
ds_read_b64_tr_b16 a[148:149], v18 offset:49152
ds_read_b64_tr_b16 a[150:151], v18 offset:51200
M v[192:195], a[32:35], a[168:171], v[192:195]
M v[192:195], a[36:39], a[172:175], v[192:195]
ds_read_b128 a[184:187], v10 offset:22528
ds_read_b128 a[188:191], v11 offset:22528
M v[196:199], a[44:47], a[172:175], v[196:199]
M v[196:199], a[40:43], a[168:171], v[196:199]
M v[200:203], a[48:51], a[168:171], v[200:203]
buffer_load_dwordx4 v8, s[12:15], s24 offen offset:2048 lds
M v[200:203], a[52:55], a[172:175], v[200:203]
ds_read_b64_tr_b16 a[156:157], v19 offset:49152
ds_read_b64_tr_b16 a[158:159], v19 offset:51200
M v[204:207], a[60:63], a[172:175], v[204:207]
M v[204:207], a[56:59], a[168:171], v[204:207]
M v[208:211], a[64:67], a[168:171], v[208:211]
M v[208:211], a[68:71], a[172:175], v[208:211]
M v[212:215], a[76:79], a[172:175], v[212:215]
buffer_load_dwordx4 v9, s[12:15], s24 offen offset:3072 lds
M v[212:215], a[72:75], a[168:171], v[212:215]
M v[216:219], a[80:83], a[168:171], v[216:219]
M v[216:219], a[84:87], a[172:175], v[216:219]
M v[220:223], a[92:95], a[172:175], v[220:223]
M v[220:223], a[88:91], a[168:171], v[220:223]
s_waitcnt lgkmcnt(10)
M v[224:227], a[32:35], a[176:179], v[224:227]
s_add_u32 s24, s24, 262144
s_cmp_eq_u32 s24, s27
s_cselect_b32 s24, s28, s24
s_sub_u32 s6, s6, 1
s_cmp_eq_u32 s6, 0
s_cselect_b64 s[12:13], s[64:65], s[12:13]
M v[224:227], a[36:39], a[180:183], v[224:227]
M v[228:231], a[44:47], a[180:183], v[228:231]
M v[228:231], a[40:43], a[176:179], v[228:231]
M v[232:235], a[48:51], a[176:179], v[232:235]
M v[232:235], a[52:55], a[180:183], v[232:235]
M v[236:239], a[60:63], a[180:183], v[236:239]
M v[236:239], a[56:59], a[176:179], v[236:239]
s_waitcnt vmcnt(8) lgkmcnt(0)
s_barrier
ds_read_b128 a[160:163], v10 offset:32768
ds_read_b128 a[164:167], v11 offset:32768
M v[240:243], a[64:67], a[176:179], v[240:243]
s_add_u32 m0, s29, 0
s_nop 0
buffer_load_dwordx4 v2, s[8:11], s23 offen offset:0 lds
M v[240:243], a[68:71], a[180:183], v[240:243]
M v[244:247], a[76:79], a[180:183], v[244:247]
M v[244:247], a[72:75], a[176:179], v[244:247]
M v[248:251], a[80:83], a[176:179], v[248:251]
M v[248:251], a[84:87], a[180:183], v[248:251]
buffer_load_dwordx4 v3, s[8:11], s23 offen offset:1024 lds
M v[252:255], a[92:95], a[180:183], v[252:255]
M v[252:255], a[88:91], a[176:179], v[252:255]
M a[0:3], a[32:35], a[184:187], a[0:3]
M a[0:3], a[36:39], a[188:191], a[0:3]
ds_read_b128 a[168:171], v10 offset:34816
ds_read_b128 a[172:175], v11 offset:34816
M a[4:7], a[44:47], a[188:191], a[4:7]
M a[4:7], a[40:43], a[184:187], a[4:7]
M a[8:11], a[48:51], a[184:187], a[8:11]
buffer_load_dwordx4 v4, s[8:11], s23 offen offset:2048 lds
M a[8:11], a[52:55], a[188:191], a[8:11]
M a[12:15], a[60:63], a[188:191], a[12:15]
M a[12:15], a[56:59], a[184:187], a[12:15]
M a[16:19], a[64:67], a[184:187], a[16:19]
M a[16:19], a[68:71], a[188:191], a[16:19]
buffer_load_dwordx4 v5, s[8:11], s23 offen offset:3072 lds
M a[20:23], a[76:79], a[188:191], a[20:23]
M a[20:23], a[72:75], a[184:187], a[20:23]
M a[24:27], a[80:83], a[184:187], a[24:27]
M a[24:27], a[84:87], a[188:191], a[24:27]
M a[28:31], a[92:95], a[188:191], a[28:31]
M a[28:31], a[88:91], a[184:187], a[28:31]
s_waitcnt lgkmcnt(2)
M v[32:35], a[96:99], a[160:163], v[32:35]
s_add_u32 m0, s29, 98304
s_nop 0
buffer_load_dwordx4 v6, s[12:15], s24 offen offset:0 lds
M v[32:35], a[100:103], a[164:167], v[32:35]
ds_read_b128 a[176:179], v10 offset:36864
ds_read_b128 a[180:183], v11 offset:36864
M v[36:39], a[108:111], a[164:167], v[36:39]
M v[36:39], a[104:107], a[160:163], v[36:39]
ds_read_b64_tr_b16 a[32:33], v12 offset:0
ds_read_b64_tr_b16 a[34:35], v12 offset:2048
M v[40:43], a[112:115], a[160:163], v[40:43]
M v[40:43], a[116:119], a[164:167], v[40:43]
M v[44:47], a[124:127], a[164:167], v[44:47]
M v[44:47], a[120:123], a[160:163], v[44:47]
ds_read_b64_tr_b16 a[40:41], v13 offset:0
ds_read_b64_tr_b16 a[42:43], v13 offset:2048
M v[48:51], a[128:131], a[160:163], v[48:51]
buffer_load_dwordx4 v7, s[12:15], s24 offen offset:1024 lds
M v[48:51], a[132:135], a[164:167], v[48:51]
M v[52:55], a[140:143], a[164:167], v[52:55]
M v[52:55], a[136:139], a[160:163], v[52:55]
ds_read_b64_tr_b16 a[48:49], v14 offset:0
ds_read_b64_tr_b16 a[50:51], v14 offset:2048
M v[56:59], a[144:147], a[160:163], v[56:59]
M v[56:59], a[148:151], a[164:167], v[56:59]
M v[60:63], a[156:159], a[164:167], v[60:63]
buffer_load_dwordx4 v8, s[12:15], s24 offen offset:2048 lds
M v[60:63], a[152:155], a[160:163], v[60:63]
s_waitcnt lgkmcnt(8)
ds_read_b64_tr_b16 a[56:57], v15 offset:0
ds_read_b64_tr_b16 a[58:59], v15 offset:2048
M v[64:67], a[96:99], a[168:171], v[64:67]
M v[64:67], a[100:103], a[172:175], v[64:67]
ds_read_b128 a[184:187], v10 offset:38912
ds_read_b128 a[188:191], v11 offset:38912
M v[68:71], a[108:111], a[172:175], v[68:71]
M v[68:71], a[104:107], a[168:171], v[68:71]
ds_read_b64_tr_b16 a[64:65], v16 offset:0
ds_read_b64_tr_b16 a[66:67], v16 offset:2048
M v[72:75], a[112:115], a[168:171], v[72:75]
M v[72:75], a[116:119], a[172:175], v[72:75]
M v[76:79], a[124:127], a[172:175], v[76:79]
M v[76:79], a[120:123], a[168:171], v[76:79]
ds_read_b64_tr_b16 a[72:73], v17 offset:0
ds_read_b64_tr_b16 a[74:75], v17 offset:2048
M v[80:83], a[128:131], a[168:171], v[80:83]
buffer_load_dwordx4 v9, s[12:15], s24 offen offset:3072 lds
M v[80:83], a[132:135], a[172:175], v[80:83]
M v[84:87], a[140:143], a[172:175], v[84:87]
M v[84:87], a[136:139], a[168:171], v[84:87]
ds_read_b64_tr_b16 a[80:81], v18 offset:0
ds_read_b64_tr_b16 a[82:83], v18 offset:2048
M v[88:91], a[144:147], a[168:171], v[88:91]
M v[88:91], a[148:151], a[172:175], v[88:91]
M v[92:95], a[156:159], a[172:175], v[92:95]
s_add_u32 s24, s24, 262144
M v[92:95], a[152:155], a[168:171], v[92:95]
s_waitcnt lgkmcnt(15)
ds_read_b64_tr_b16 a[88:89], v19 offset:0
ds_read_b64_tr_b16 a[90:91], v19 offset:2048
M v[96:99], a[96:99], a[176:179], v[96:99]
M v[96:99], a[100:103], a[180:183], v[96:99]
M v[100:103], a[108:111], a[180:183], v[100:103]
M v[100:103], a[104:107], a[176:179], v[100:103]
M v[104:107], a[112:115], a[176:179], v[104:107]
M v[104:107], a[116:119], a[180:183], v[104:107]
M v[108:111], a[124:127], a[180:183], v[108:111]
M v[108:111], a[120:123], a[176:179], v[108:111]
s_waitcnt vmcnt(8) lgkmcnt(0)
s_barrier
ds_read_b128 a[160:163], v10 offset:49152
ds_read_b128 a[164:167], v11 offset:49152
M v[112:115], a[128:131], a[176:179], v[112:115]
s_add_u32 m0, s29, 16384
s_add_u32 s3, s23, s31
buffer_load_dwordx4 v2, s[8:11], s3 offen offset:0 lds
M v[112:115], a[132:135], a[180:183], v[112:115]
M v[116:119], a[140:143], a[180:183], v[116:119]
M v[116:119], a[136:139], a[176:179], v[116:119]
ds_read_b64_tr_b16 a[36:37], v12 offset:16384
ds_read_b64_tr_b16 a[38:39], v12 offset:18432
M v[120:123], a[144:147], a[176:179], v[120:123]
M v[120:123], a[148:151], a[180:183], v[120:123]
buffer_load_dwordx4 v3, s[8:11], s3 offen offset:1024 lds
M v[124:127], a[156:159], a[180:183], v[124:127]
M v[124:127], a[152:155], a[176:179], v[124:127]
M v[128:131], a[96:99], a[184:187], v[128:131]
M v[128:131], a[100:103], a[188:191], v[128:131]
ds_read_b128 a[168:171], v10 offset:51200
ds_read_b128 a[172:175], v11 offset:51200
ds_read_b64_tr_b16 a[44:45], v13 offset:16384
ds_read_b64_tr_b16 a[46:47], v13 offset:18432
M v[132:135], a[108:111], a[188:191], v[132:135]
M v[132:135], a[104:107], a[184:187], v[132:135]
M v[136:139], a[112:115], a[184:187], v[136:139]
buffer_load_dwordx4 v4, s[8:11], s3 offen offset:2048 lds
M v[136:139], a[116:119], a[188:191], v[136:139]
M v[140:143], a[124:127], a[188:191], v[140:143]
M v[140:143], a[120:123], a[184:187], v[140:143]
ds_read_b64_tr_b16 a[52:53], v14 offset:16384
ds_read_b64_tr_b16 a[54:55], v14 offset:18432
M v[144:147], a[128:131], a[184:187], v[144:147]
M v[144:147], a[132:135], a[188:191], v[144:147]
M v[148:151], a[140:143], a[188:191], v[148:151]
buffer_load_dwordx4 v5, s[8:11], s3 offen offset:3072 lds
M v[148:151], a[136:139], a[184:187], v[148:151]
M v[152:155], a[144:147], a[184:187], v[152:155]
M v[152:155], a[148:151], a[188:191], v[152:155]
ds_read_b64_tr_b16 a[60:61], v15 offset:16384
ds_read_b64_tr_b16 a[62:63], v15 offset:18432
M v[156:159], a[156:159], a[188:191], v[156:159]
M v[156:159], a[152:155], a[184:187], v[156:159]
s_waitcnt lgkmcnt(10)
M v[160:163], a[96:99], a[160:163], v[160:163]
M v[160:163], a[100:103], a[164:167], v[160:163]
ds_read_b128 a[176:179], v10 offset:53248
ds_read_b128 a[180:183], v11 offset:53248
M v[164:167], a[108:111], a[164:167], v[164:167]
s_add_u32 s23, s23, 128
s_cmp_eq_u32 s23, s25
s_cselect_b32 s23, s26, s23
M v[164:167], a[104:107], a[160:163], v[164:167]
ds_read_b64_tr_b16 a[68:69], v16 offset:16384
ds_read_b64_tr_b16 a[70:71], v16 offset:18432
M v[168:171], a[112:115], a[160:163], v[168:171]
M v[168:171], a[116:119], a[164:167], v[168:171]
M v[172:175], a[124:127], a[164:167], v[172:175]
M v[172:175], a[120:123], a[160:163], v[172:175]
M v[176:179], a[128:131], a[160:163], v[176:179]
s_add_u32 m0, s29, 114688
s_nop 0
buffer_load_dwordx4 v6, s[12:15], s24 offen offset:0 lds
M v[176:179], a[132:135], a[164:167], v[176:179]
ds_read_b64_tr_b16 a[76:77], v17 offset:16384
ds_read_b64_tr_b16 a[78:79], v17 offset:18432
M v[180:183], a[140:143], a[164:167], v[180:183]
M v[180:183], a[136:139], a[160:163], v[180:183]
M v[184:187], a[144:147], a[160:163], v[184:187]
M v[184:187], a[148:151], a[164:167], v[184:187]
buffer_load_dwordx4 v7, s[12:15], s24 offen offset:1024 lds
M v[188:191], a[156:159], a[164:167], v[188:191]
M v[188:191], a[152:155], a[160:163], v[188:191]
s_waitcnt lgkmcnt(12)
ds_read_b64_tr_b16 a[84:85], v18 offset:16384
ds_read_b64_tr_b16 a[86:87], v18 offset:18432
M v[192:195], a[96:99], a[168:171], v[192:195]
M v[192:195], a[100:103], a[172:175], v[192:195]
ds_read_b128 a[184:187], v10 offset:55296
ds_read_b128 a[188:191], v11 offset:55296
M v[196:199], a[108:111], a[172:175], v[196:199]
M v[196:199], a[104:107], a[168:171], v[196:199]
M v[200:203], a[112:115], a[168:171], v[200:203]
buffer_load_dwordx4 v8, s[12:15], s24 offen offset:2048 lds
M v[200:203], a[116:119], a[172:175], v[200:203]
ds_read_b64_tr_b16 a[92:93], v19 offset:16384
ds_read_b64_tr_b16 a[94:95], v19 offset:18432
M v[204:207], a[124:127], a[172:175], v[204:207]
M v[204:207], a[120:123], a[168:171], v[204:207]
M v[208:211], a[128:131], a[168:171], v[208:211]
M v[208:211], a[132:135], a[172:175], v[208:211]
M v[212:215], a[140:143], a[172:175], v[212:215]
buffer_load_dwordx4 v9, s[12:15], s24 offen offset:3072 lds
M v[212:215], a[136:139], a[168:171], v[212:215]
M v[216:219], a[144:147], a[168:171], v[216:219]
M v[216:219], a[148:151], a[172:175], v[216:219]
M v[220:223], a[156:159], a[172:175], v[220:223]
M v[220:223], a[152:155], a[168:171], v[220:223]
s_waitcnt lgkmcnt(10)
M v[224:227], a[96:99], a[176:179], v[224:227]
s_add_u32 s24, s24, 262144
s_cmp_eq_u32 s24, s27
s_cselect_b32 s24, s28, s24
s_sub_u32 s6, s6, 1
s_cmp_eq_u32 s6, 0
s_cselect_b64 s[12:13], s[64:65], s[12:13]
M v[224:227], a[100:103], a[180:183], v[224:227]
M v[228:231], a[108:111], a[180:183], v[228:231]
M v[228:231], a[104:107], a[176:179], v[228:231]
M v[232:235], a[112:115], a[176:179], v[232:235]
M v[232:235], a[116:119], a[180:183], v[232:235]
M v[236:239], a[124:127], a[180:183], v[236:239]
M v[236:239], a[120:123], a[176:179], v[236:239]
s_waitcnt vmcnt(8) lgkmcnt(0)
s_barrier
ds_read_b128 a[160:163], v10 offset:0
ds_read_b128 a[164:167], v11 offset:0
M v[240:243], a[128:131], a[176:179], v[240:243]
s_add_u32 m0, s29, 32768
s_nop 0
buffer_load_dwordx4 v2, s[8:11], s23 offen offset:0 lds
M v[240:243], a[132:135], a[180:183], v[240:243]
M v[244:247], a[140:143], a[180:183], v[244:247]
M v[244:247], a[136:139], a[176:179], v[244:247]
M v[248:251], a[144:147], a[176:179], v[248:251]
M v[248:251], a[148:151], a[180:183], v[248:251]
M v[252:255], a[156:159], a[180:183], v[252:255]
M v[252:255], a[152:155], a[176:179], v[252:255]
M a[0:3], a[96:99], a[184:187], a[0:3]
M a[0:3], a[100:103], a[188:191], a[0:3]
ds_read_b128 a[168:171], v10 offset:2048
ds_read_b128 a[172:175], v11 offset:2048
M a[4:7], a[108:111], a[188:191], a[4:7]
M a[4:7], a[104:107], a[184:187], a[4:7]
M a[8:11], a[112:115], a[184:187], a[8:11]
buffer_load_dwordx4 v3, s[8:11], s23 offen offset:1024 lds
M a[8:11], a[116:119], a[188:191], a[8:11]
M a[12:15], a[124:127], a[188:191], a[12:15]
M a[12:15], a[120:123], a[184:187], a[12:15]
M a[16:19], a[128:131], a[184:187], a[16:19]
M a[16:19], a[132:135], a[188:191], a[16:19]
M a[20:23], a[140:143], a[188:191], a[20:23]
M a[20:23], a[136:139], a[184:187], a[20:23]
M a[24:27], a[144:147], a[184:187], a[24:27]
M a[24:27], a[148:151], a[188:191], a[24:27]
M a[28:31], a[156:159], a[188:191], a[28:31]
M a[28:31], a[152:155], a[184:187], a[28:31]
s_waitcnt lgkmcnt(2)
M v[32:35], a[32:35], a[160:163], v[32:35]
buffer_load_dwordx4 v4, s[8:11], s23 offen offset:2048 lds
M v[32:35], a[36:39], a[164:167], v[32:35]
ds_read_b128 a[176:179], v10 offset:4096
ds_read_b128 a[180:183], v11 offset:4096
M v[36:39], a[44:47], a[164:167], v[36:39]
M v[36:39], a[40:43], a[160:163], v[36:39]
ds_read_b64_tr_b16 a[96:97], v12 offset:32768
ds_read_b64_tr_b16 a[98:99], v12 offset:34816
M v[40:43], a[48:51], a[160:163], v[40:43]
M v[40:43], a[52:55], a[164:167], v[40:43]
M v[44:47], a[60:63], a[164:167], v[44:47]
M v[44:47], a[56:59], a[160:163], v[44:47]
ds_read_b64_tr_b16 a[104:105], v13 offset:32768
ds_read_b64_tr_b16 a[106:107], v13 offset:34816
M v[48:51], a[64:67], a[160:163], v[48:51]
M v[48:51], a[68:71], a[164:167], v[48:51]
M v[52:55], a[76:79], a[164:167], v[52:55]
M v[52:55], a[72:75], a[160:163], v[52:55]
ds_read_b64_tr_b16 a[112:113], v14 offset:32768
ds_read_b64_tr_b16 a[114:115], v14 offset:34816
M v[56:59], a[80:83], a[160:163], v[56:59]
M v[56:59], a[84:87], a[164:167], v[56:59]
M v[60:63], a[92:95], a[164:167], v[60:63]
M v[60:63], a[88:91], a[160:163], v[60:63]
s_waitcnt lgkmcnt(8)
ds_read_b64_tr_b16 a[120:121], v15 offset:32768
ds_read_b64_tr_b16 a[122:123], v15 offset:34816
M v[64:67], a[32:35], a[168:171], v[64:67]
M v[64:67], a[36:39], a[172:175], v[64:67]
ds_read_b128 a[184:187], v10 offset:6144
ds_read_b128 a[188:191], v11 offset:6144
M v[68:71], a[44:47], a[172:175], v[68:71]
M v[68:71], a[40:43], a[168:171], v[68:71]
ds_read_b64_tr_b16 a[128:129], v16 offset:32768
ds_read_b64_tr_b16 a[130:131], v16 offset:34816
M v[72:75], a[48:51], a[168:171], v[72:75]
buffer_load_dwordx4 v5, s[8:11], s23 offen offset:3072 lds
M v[72:75], a[52:55], a[172:175], v[72:75]
M v[76:79], a[60:63], a[172:175], v[76:79]
M v[76:79], a[56:59], a[168:171], v[76:79]
ds_read_b64_tr_b16 a[136:137], v17 offset:32768
ds_read_b64_tr_b16 a[138:139], v17 offset:34816
M v[80:83], a[64:67], a[168:171], v[80:83]
M v[80:83], a[68:71], a[172:175], v[80:83]
M v[84:87], a[76:79], a[172:175], v[84:87]
M v[84:87], a[72:75], a[168:171], v[84:87]
ds_read_b64_tr_b16 a[144:145], v18 offset:32768
ds_read_b64_tr_b16 a[146:147], v18 offset:34816
M v[88:91], a[80:83], a[168:171], v[88:91]
M v[88:91], a[84:87], a[172:175], v[88:91]
M v[92:95], a[92:95], a[172:175], v[92:95]
M v[92:95], a[88:91], a[168:171], v[92:95]
s_waitcnt lgkmcnt(15)
ds_read_b64_tr_b16 a[152:153], v19 offset:32768
ds_read_b64_tr_b16 a[154:155], v19 offset:34816
M v[96:99], a[32:35], a[176:179], v[96:99]
M v[96:99], a[36:39], a[180:183], v[96:99]
M v[100:103], a[44:47], a[180:183], v[100:103]
M v[100:103], a[40:43], a[176:179], v[100:103]
M v[104:107], a[48:51], a[176:179], v[104:107]
M v[104:107], a[52:55], a[180:183], v[104:107]
M v[108:111], a[60:63], a[180:183], v[108:111]
M v[108:111], a[56:59], a[176:179], v[108:111]
s_waitcnt vmcnt(4) lgkmcnt(0)
s_barrier
ds_read_b128 a[160:163], v10 offset:16384
ds_read_b128 a[164:167], v11 offset:16384
M v[112:115], a[64:67], a[176:179], v[112:115]
s_add_u32 m0, s29, 49152
s_add_u32 s3, s23, s31
buffer_load_dwordx4 v2, s[8:11], s3 offen offset:0 lds
M v[112:115], a[68:71], a[180:183], v[112:115]
M v[116:119], a[76:79], a[180:183], v[116:119]
buffer_load_dwordx4 v3, s[8:11], s3 offen offset:1024 lds
M v[116:119], a[72:75], a[176:179], v[116:119]
ds_read_b64_tr_b16 a[100:101], v12 offset:49152
ds_read_b64_tr_b16 a[102:103], v12 offset:51200
M v[120:123], a[80:83], a[176:179], v[120:123]
buffer_load_dwordx4 v4, s[8:11], s3 offen offset:2048 lds
M v[120:123], a[84:87], a[180:183], v[120:123]
M v[124:127], a[92:95], a[180:183], v[124:127]
buffer_load_dwordx4 v5, s[8:11], s3 offen offset:3072 lds
M v[124:127], a[88:91], a[176:179], v[124:127]
M v[128:131], a[32:35], a[184:187], v[128:131]
M v[128:131], a[36:39], a[188:191], v[128:131]
ds_read_b128 a[168:171], v10 offset:18432
ds_read_b128 a[172:175], v11 offset:18432
ds_read_b64_tr_b16 a[108:109], v13 offset:49152
ds_read_b64_tr_b16 a[110:111], v13 offset:51200
M v[132:135], a[44:47], a[188:191], v[132:135]
M v[132:135], a[40:43], a[184:187], v[132:135]
M v[136:139], a[48:51], a[184:187], v[136:139]
s_and_b32 s3, s2, 1
s_lshl_b32 s3, s3, 3
s_bfe_u32 s4, s2, 0x30003
s_add_u32 s26, s3, s4
M v[136:139], a[52:55], a[188:191], v[136:139]
s_bfe_u32 s3, s2, 0x20001
s_lshl_b32 s3, s3, 2
s_lshr_b32 s4, s2, 6
M v[140:143], a[60:63], a[188:191], v[140:143]
s_xor_b32 s4, s4, 2
s_add_u32 s27, s3, s4
s_lshl_b32 s23, s26, 18
M v[140:143], a[56:59], a[184:187], v[140:143]
ds_read_b64_tr_b16 a[116:117], v14 offset:49152
ds_read_b64_tr_b16 a[118:119], v14 offset:51200
s_sub_u32 s24, s23, 32768
s_max_i32 s24, s24, 0
s_lshl_b32 s25, s27, 7
s_add_u32 s3, s26, s27
M v[144:147], a[64:67], a[184:187], v[144:147]
s_and_b32 s3, s3, 0
s_mul_i32 s3, s3, 16
s_sub_u32 s31, 16, s3
M v[144:147], a[68:71], a[188:191], v[144:147]
s_mov_b32 s54, s31
s_movk_i32 s57, 128
s_mov_b32 s55, 4289069056
M v[148:151], a[76:79], a[188:191], v[148:151]
s_mov_b32 s56, 393216
s_lshl_b32 s4, s3, 7
s_add_u32 s23, s23, s4
s_add_u32 s24, s24, s4
M v[148:151], a[72:75], a[184:187], v[148:151]
s_mul_i32 s4, s3, 393216
s_add_u32 s25, s25, s4
s_mov_b64 s[8:9], s[44:45]
M v[152:155], a[80:83], a[184:187], v[152:155]
s_mov_b32 s10, 4194304
s_mov_b64 s[12:13], s[46:47]
s_mov_b32 s14, 6291456
M v[152:155], a[84:87], a[188:191], v[152:155]
ds_read_b64_tr_b16 a[124:125], v15 offset:49152
ds_read_b64_tr_b16 a[126:127], v15 offset:51200
s_mov_b64 s[36:37], s[90:91]
s_mov_b32 s38, 256
s_mov_b32 s39, 0x00020000
M v[156:159], a[92:95], a[188:191], v[156:159]
s_lshl_b32 s28, s20, 9
s_mul_i32 s30, s20, 6144
s_lshl_b32 s3, s20, 5
v_lshrrev_b32 v24, 3, v0
M v[156:159], a[88:91], a[184:187], v[156:159]
s_waitcnt lgkmcnt(10)
v_and_b32 v25, 7, v0
v_add_u32 v28, s3, v24
v_add_u32 v26, 0, v28
M v[160:163], a[32:35], a[160:163], v[160:163]
v_bfe_u32 v27, v26, 1, 3
v_xor_b32 v27, v27, v25
v_lshlrev_b32 v26, 11, v26
M v[160:163], a[36:39], a[164:167], v[160:163]
ds_read_b128 a[176:179], v10 offset:20480
ds_read_b128 a[180:183], v11 offset:20480
v_lshl_add_u32 v26, v27, 4, v26
v_subrev_u32 v2, 0, v26
v_add_u32 v26, 8, v28
v_bfe_u32 v27, v26, 1, 3
M v[164:167], a[44:47], a[164:167], v[164:167]
v_xor_b32 v27, v27, v25
v_lshlrev_b32 v26, 11, v26
v_lshl_add_u32 v26, v27, 4, v26
M v[164:167], a[40:43], a[160:163], v[164:167]
ds_read_b64_tr_b16 a[132:133], v16 offset:49152
ds_read_b64_tr_b16 a[134:135], v16 offset:51200
v_subrev_u32 v3, 1024, v26
v_add_u32 v26, 16, v28
v_bfe_u32 v27, v26, 1, 3
M v[168:171], a[48:51], a[160:163], v[168:171]
v_xor_b32 v27, v27, v25
v_lshlrev_b32 v26, 11, v26
v_lshl_add_u32 v26, v27, 4, v26
M v[168:171], a[52:55], a[164:167], v[168:171]
v_subrev_u32 v4, 2048, v26
v_add_u32 v26, 24, v28
v_bfe_u32 v27, v26, 1, 3
v_xor_b32 v27, v27, v25
M v[172:175], a[60:63], a[164:167], v[172:175]
v_lshlrev_b32 v26, 11, v26
v_lshl_add_u32 v26, v27, 4, v26
v_subrev_u32 v5, 3072, v26
M v[172:175], a[56:59], a[160:163], v[172:175]
s_lshl_b32 s3, s20, 2
v_lshrrev_b32 v26, 5, v0
v_add_u32 v26, s3, v26
M v[176:179], a[64:67], a[160:163], v[176:179]
v_bfe_u32 v29, v0, 2, 3
v_bfe_u32 v27, v26, 1, 3
v_xor_b32 v27, v27, v29
v_lshlrev_b32 v27, 4, v27
M v[176:179], a[68:71], a[164:167], v[176:179]
ds_read_b64_tr_b16 a[140:141], v17 offset:49152
ds_read_b64_tr_b16 a[142:143], v17 offset:51200
v_and_b32 v30, 3, v0
v_lshl_add_u32 v27, v30, 2, v27
v_lshl_add_u32 v20, v26, 11, v27
M v[180:183], a[76:79], a[164:167], v[180:183]
v_add_u32 v26, 2, v26
v_bfe_u32 v27, v26, 1, 3
v_xor_b32 v27, v27, v29
M v[180:183], a[72:75], a[160:163], v[180:183]
v_lshlrev_b32 v27, 4, v27
v_and_b32 v30, 3, v0
v_lshl_add_u32 v27, v30, 2, v27
M v[184:187], a[80:83], a[160:163], v[184:187]
v_lshl_add_u32 v23, v26, 11, v27
v_subrev_u32 v23, 256, v23
s_mul_i32 s3, s20, 48
v_add_u32 v28, s3, v24
M v[184:187], a[84:87], a[164:167], v[184:187]
v_add_u32 v26, 0, v28
v_mul_u32_u24 v27, 0xaaab, v26
v_lshrrev_b32 v27, 17, v27
M v[188:191], a[92:95], a[164:167], v[188:191]
v_lshrrev_b32 v29, 1, v27
v_and_b32 v29, 4, v29
v_and_or_b32 v27, v27, 2, v29
M v[188:191], a[88:91], a[160:163], v[188:191]
s_waitcnt lgkmcnt(12)
ds_read_b64_tr_b16 a[148:149], v18 offset:49152
ds_read_b64_tr_b16 a[150:151], v18 offset:51200
v_xor_b32 v27, v27, v25
v_lshlrev_b32 v26, 11, v26
v_lshl_add_u32 v26, v27, 4, v26
v_subrev_u32 v6, 0, v26
M v[192:195], a[32:35], a[168:171], v[192:195]
v_add_u32 v26, 8, v28
v_mul_u32_u24 v27, 0xaaab, v26
v_lshrrev_b32 v27, 17, v27
M v[192:195], a[36:39], a[172:175], v[192:195]
ds_read_b128 a[184:187], v10 offset:22528
ds_read_b128 a[188:191], v11 offset:22528
v_lshrrev_b32 v29, 1, v27
v_and_b32 v29, 4, v29
v_and_or_b32 v27, v27, 2, v29
M v[196:199], a[44:47], a[172:175], v[196:199]
v_xor_b32 v27, v27, v25
v_lshlrev_b32 v26, 11, v26
v_lshl_add_u32 v26, v27, 4, v26
v_subrev_u32 v7, 1024, v26
M v[196:199], a[40:43], a[168:171], v[196:199]
v_add_u32 v26, 16, v28
v_mul_u32_u24 v27, 0xaaab, v26
v_lshrrev_b32 v27, 17, v27
M v[200:203], a[48:51], a[168:171], v[200:203]
v_lshrrev_b32 v29, 1, v27
v_and_b32 v29, 4, v29
v_and_or_b32 v27, v27, 2, v29
M v[200:203], a[52:55], a[172:175], v[200:203]
ds_read_b64_tr_b16 a[156:157], v19 offset:49152
ds_read_b64_tr_b16 a[158:159], v19 offset:51200
v_xor_b32 v27, v27, v25
v_lshlrev_b32 v26, 11, v26
v_lshl_add_u32 v26, v27, 4, v26
M v[204:207], a[60:63], a[172:175], v[204:207]
v_subrev_u32 v8, 2048, v26
v_add_u32 v26, 24, v28
v_mul_u32_u24 v27, 0xaaab, v26
v_lshrrev_b32 v27, 17, v27
M v[204:207], a[56:59], a[168:171], v[204:207]
v_lshrrev_b32 v29, 1, v27
v_and_b32 v29, 4, v29
v_and_or_b32 v27, v27, 2, v29
M v[208:211], a[64:67], a[168:171], v[208:211]
v_xor_b32 v27, v27, v25
v_lshlrev_b32 v26, 11, v26
v_lshl_add_u32 v26, v27, 4, v26
M v[208:211], a[68:71], a[172:175], v[208:211]
v_subrev_u32 v9, 3072, v26
v_add_u32 v26, 32, v28
v_mul_u32_u24 v27, 0xaaab, v26
v_lshrrev_b32 v27, 17, v27
M v[212:215], a[76:79], a[172:175], v[212:215]
v_lshrrev_b32 v29, 1, v27
v_and_b32 v29, 4, v29
v_and_or_b32 v27, v27, 2, v29
M v[212:215], a[72:75], a[168:171], v[212:215]
v_xor_b32 v27, v27, v25
v_lshlrev_b32 v26, 11, v26
v_lshl_add_u32 v26, v27, 4, v26
M v[216:219], a[80:83], a[168:171], v[216:219]
v_subrev_u32 v21, 0, v26
v_add_u32 v26, 40, v28
v_mul_u32_u24 v27, 0xaaab, v26
M v[216:219], a[84:87], a[172:175], v[216:219]
v_lshrrev_b32 v27, 17, v27
v_lshrrev_b32 v29, 1, v27
v_and_b32 v29, 4, v29
v_and_or_b32 v27, v27, 2, v29
M v[220:223], a[92:95], a[172:175], v[220:223]
v_xor_b32 v27, v27, v25
v_lshlrev_b32 v26, 11, v26
v_lshl_add_u32 v26, v27, 4, v26
M v[220:223], a[88:91], a[168:171], v[220:223]
s_waitcnt lgkmcnt(10)
v_subrev_u32 v22, 1024, v26
s_lshr_b32 s3, s53, 7
s_add_u32 s3, s3, s22
M v[224:227], a[32:35], a[176:179], v[224:227]
s_lshl_b32 s3, s3, 5
s_lshr_b32 s19, s52, 6
s_add_u32 s3, s3, s19
s_lshl_b32 s19, s21, 1
M v[224:227], a[36:39], a[180:183], v[224:227]
s_add_u32 s3, s3, s19
s_lshl_b32 s92, s3, 14
s_add_u32 s93, s92, 16384
M v[228:231], a[44:47], a[180:183], v[228:231]
s_add_u32 s16, s50, 0
s_addc_u32 s17, s51, 0
s_mov_b32 s18, 16777216
M v[228:231], a[40:43], a[176:179], v[228:231]
s_mov_b32 s19, 0x00020000
s_mov_b32 s4, 0x3e0293ee
s_mov_b32 s5, 0x3e0293ee
M v[232:235], a[48:51], a[176:179], v[232:235]
M v[232:235], a[52:55], a[180:183], v[232:235]
M v[236:239], a[60:63], a[180:183], v[236:239]
M v[236:239], a[56:59], a[176:179], v[236:239]
s_waitcnt vmcnt(4) lgkmcnt(0)
s_barrier
ds_read_b128 a[160:163], v10 offset:32768
ds_read_b128 a[164:167], v11 offset:32768
M v[240:243], a[64:67], a[176:179], v[240:243]
s_add_u32 m0, s28, 131072
s_nop 0
buffer_load_dword v20, s[8:11], s24 offen lds
M v[240:243], a[68:71], a[180:183], v[240:243]
M v[244:247], a[76:79], a[180:183], v[244:247]
M v[244:247], a[72:75], a[176:179], v[244:247]
buffer_load_dword v23, s[8:11], s24 offen offset:256 lds
M v[248:251], a[80:83], a[176:179], v[248:251]
M v[248:251], a[84:87], a[180:183], v[248:251]
M v[252:255], a[92:95], a[180:183], v[252:255]
M v[252:255], a[88:91], a[176:179], v[252:255]
M a[0:3], a[32:35], a[184:187], a[0:3]
s_add_u32 m0, s29, 133120
s_nop 0
buffer_load_dwordx4 v2, s[8:11], s23 offen offset:0 lds
M a[0:3], a[36:39], a[188:191], a[0:3]
ds_read_b128 a[168:171], v10 offset:34816
ds_read_b128 a[172:175], v11 offset:34816
M a[4:7], a[44:47], a[188:191], a[4:7]
M a[4:7], a[40:43], a[184:187], a[4:7]
M a[8:11], a[48:51], a[184:187], a[8:11]
buffer_load_dwordx4 v3, s[8:11], s23 offen offset:1024 lds
M a[8:11], a[52:55], a[188:191], a[8:11]
M a[12:15], a[60:63], a[188:191], a[12:15]
M a[12:15], a[56:59], a[184:187], a[12:15]
M a[16:19], a[64:67], a[184:187], a[16:19]
buffer_load_dwordx4 v4, s[8:11], s23 offen offset:2048 lds
M a[16:19], a[68:71], a[188:191], a[16:19]
M a[20:23], a[76:79], a[188:191], a[20:23]
M a[20:23], a[72:75], a[184:187], a[20:23]
buffer_load_dwordx4 v5, s[8:11], s23 offen offset:3072 lds
M a[24:27], a[80:83], a[184:187], a[24:27]
M a[24:27], a[84:87], a[188:191], a[24:27]
M a[28:31], a[92:95], a[188:191], a[28:31]
M a[28:31], a[88:91], a[184:187], a[28:31]
s_waitcnt lgkmcnt(2)
M v[32:35], a[96:99], a[160:163], v[32:35]
s_sub_u32 s31, s31, 1
s_cmp_eq_u32 s31, 0
s_cselect_b32 s58, -1920, s57
s_add_u32 s23, s23, s58
s_add_u32 s24, s24, s58
M v[32:35], a[100:103], a[164:167], v[32:35]
ds_read_b128 a[176:179], v10 offset:36864
ds_read_b128 a[180:183], v11 offset:36864
M v[36:39], a[108:111], a[164:167], v[36:39]
M v[36:39], a[104:107], a[160:163], v[36:39]
M v[40:43], a[112:115], a[160:163], v[40:43]
M v[40:43], a[116:119], a[164:167], v[40:43]
s_add_u32 m0, s30, 65536
s_nop 0
buffer_load_dwordx4 v6, s[12:15], s25 offen offset:0 lds
M v[44:47], a[124:127], a[164:167], v[44:47]
M v[44:47], a[120:123], a[160:163], v[44:47]
M v[48:51], a[128:131], a[160:163], v[48:51]
M v[48:51], a[132:135], a[164:167], v[48:51]
buffer_load_dwordx4 v7, s[12:15], s25 offen offset:1024 lds
M v[52:55], a[140:143], a[164:167], v[52:55]
M v[52:55], a[136:139], a[160:163], v[52:55]
M v[56:59], a[144:147], a[160:163], v[56:59]
M v[56:59], a[148:151], a[164:167], v[56:59]
buffer_load_dwordx4 v8, s[12:15], s25 offen offset:2048 lds
M v[60:63], a[156:159], a[164:167], v[60:63]
M v[60:63], a[152:155], a[160:163], v[60:63]
s_waitcnt lgkmcnt(2)
M v[64:67], a[96:99], a[168:171], v[64:67]
M v[64:67], a[100:103], a[172:175], v[64:67]
ds_read_b128 a[184:187], v10 offset:38912
ds_read_b128 a[188:191], v11 offset:38912
M v[68:71], a[108:111], a[172:175], v[68:71]
M v[68:71], a[104:107], a[168:171], v[68:71]
buffer_load_dwordx4 v9, s[12:15], s25 offen offset:3072 lds
v_pk_mul_f32 v[32:33], v[32:33], s[4:5]
v_pk_mul_f32 v[34:35], v[34:35], s[4:5]
v_pk_mul_f32 v[36:37], v[36:37], s[4:5]
M v[72:75], a[112:115], a[168:171], v[72:75]
v_pk_mul_f32 v[38:39], v[38:39], s[4:5]
v_cvt_pk_bf16_f32 v32, v32, v33
M v[72:75], a[116:119], a[172:175], v[72:75]
v_cvt_pk_bf16_f32 v33, v34, v35
v_cvt_pk_bf16_f32 v34, v36, v37
M v[76:79], a[124:127], a[172:175], v[76:79]
v_cvt_pk_bf16_f32 v35, v38, v39
v_pk_mul_f32 v[40:41], v[40:41], s[4:5]
v_pk_mul_f32 v[42:43], v[42:43], s[4:5]
M v[76:79], a[120:123], a[168:171], v[76:79]
s_add_u32 m0, s30, 69632
s_nop 0
buffer_load_dwordx4 v21, s[12:15], s25 offen offset:0 lds
v_pk_mul_f32 v[44:45], v[44:45], s[4:5]
v_pk_mul_f32 v[46:47], v[46:47], s[4:5]
M v[80:83], a[128:131], a[168:171], v[80:83]
v_cvt_pk_bf16_f32 v40, v40, v41
v_cvt_pk_bf16_f32 v41, v42, v43
M v[80:83], a[132:135], a[172:175], v[80:83]
v_cvt_pk_bf16_f32 v42, v44, v45
v_cvt_pk_bf16_f32 v43, v46, v47
M v[84:87], a[140:143], a[172:175], v[84:87]
v_pk_mul_f32 v[48:49], v[48:49], s[4:5]
v_pk_mul_f32 v[50:51], v[50:51], s[4:5]
v_pk_mul_f32 v[52:53], v[52:53], s[4:5]
M v[84:87], a[136:139], a[168:171], v[84:87]
buffer_load_dwordx4 v22, s[12:15], s25 offen offset:1024 lds
v_pk_mul_f32 v[54:55], v[54:55], s[4:5]
v_cvt_pk_bf16_f32 v48, v48, v49
M v[88:91], a[144:147], a[168:171], v[88:91]
v_cvt_pk_bf16_f32 v49, v50, v51
v_cvt_pk_bf16_f32 v50, v52, v53
M v[88:91], a[148:151], a[172:175], v[88:91]
v_cvt_pk_bf16_f32 v51, v54, v55
v_pk_mul_f32 v[56:57], v[56:57], s[4:5]
v_pk_mul_f32 v[58:59], v[58:59], s[4:5]
M v[92:95], a[156:159], a[172:175], v[92:95]
v_pk_mul_f32 v[60:61], v[60:61], s[4:5]
v_pk_mul_f32 v[62:63], v[62:63], s[4:5]
M v[92:95], a[152:155], a[168:171], v[92:95]
s_waitcnt lgkmcnt(2)
v_cvt_pk_bf16_f32 v56, v56, v57
v_cvt_pk_bf16_f32 v57, v58, v59
M v[96:99], a[96:99], a[176:179], v[96:99]
s_sub_u32 s54, s54, 1
s_cmp_eq_u32 s54, 0
s_cselect_b32 s58, s55, s56
s_add_u32 s25, s25, s58
v_cvt_pk_bf16_f32 v58, v60, v61
v_cvt_pk_bf16_f32 v59, v62, v63
M v[96:99], a[100:103], a[180:183], v[96:99]
M v[100:103], a[108:111], a[180:183], v[100:103]
M v[100:103], a[104:107], a[176:179], v[100:103]
v_pk_mul_f32 v[64:65], v[64:65], s[4:5]
v_pk_mul_f32 v[66:67], v[66:67], s[4:5]
v_pk_mul_f32 v[68:69], v[68:69], s[4:5]
M v[104:107], a[112:115], a[176:179], v[104:107]
s_add_u32 s94, s92, 0
buffer_store_dwordx4 v[32:35], v1, s[16:19], s94 offen offset:0 sc1
v_pk_mul_f32 v[70:71], v[70:71], s[4:5]
v_cvt_pk_bf16_f32 v64, v64, v65
M v[104:107], a[116:119], a[180:183], v[104:107]
v_cvt_pk_bf16_f32 v65, v66, v67
v_cvt_pk_bf16_f32 v66, v68, v69
M v[108:111], a[124:127], a[180:183], v[108:111]
v_cvt_pk_bf16_f32 v67, v70, v71
v_pk_mul_f32 v[72:73], v[72:73], s[4:5]
v_pk_mul_f32 v[74:75], v[74:75], s[4:5]
M v[108:111], a[120:123], a[176:179], v[108:111]
s_waitcnt vmcnt(13) lgkmcnt(0)
s_barrier
ds_read_b128 a[160:163], v10 offset:49152
ds_read_b128 a[164:167], v11 offset:49152
v_pk_mul_f32 v[76:77], v[76:77], s[4:5]
v_pk_mul_f32 v[78:79], v[78:79], s[4:5]
M v[112:115], a[128:131], a[176:179], v[112:115]
s_add_u32 m0, s28, 0
s_nop 0
buffer_load_dword v20, s[8:11], s24 offen lds
v_cvt_pk_bf16_f32 v72, v72, v73
v_cvt_pk_bf16_f32 v73, v74, v75
M v[112:115], a[132:135], a[180:183], v[112:115]
v_cvt_pk_bf16_f32 v74, v76, v77
v_cvt_pk_bf16_f32 v75, v78, v79
M v[116:119], a[140:143], a[180:183], v[116:119]
s_add_u32 s94, s92, 0
buffer_store_dwordx4 v[40:43], v1, s[16:19], s94 offen offset:1024 sc1
v_pk_mul_f32 v[80:81], v[80:81], s[4:5]
v_pk_mul_f32 v[82:83], v[82:83], s[4:5]
v_pk_mul_f32 v[84:85], v[84:85], s[4:5]
M v[116:119], a[136:139], a[176:179], v[116:119]
v_pk_mul_f32 v[86:87], v[86:87], s[4:5]
v_cvt_pk_bf16_f32 v80, v80, v81
M v[120:123], a[144:147], a[176:179], v[120:123]
buffer_load_dword v23, s[8:11], s24 offen offset:256 lds
v_cvt_pk_bf16_f32 v81, v82, v83
v_cvt_pk_bf16_f32 v82, v84, v85
M v[120:123], a[148:151], a[180:183], v[120:123]
v_cvt_pk_bf16_f32 v83, v86, v87
v_pk_mul_f32 v[88:89], v[88:89], s[4:5]
v_pk_mul_f32 v[90:91], v[90:91], s[4:5]
M v[124:127], a[156:159], a[180:183], v[124:127]
v_pk_mul_f32 v[92:93], v[92:93], s[4:5]
v_pk_mul_f32 v[94:95], v[94:95], s[4:5]
M v[124:127], a[152:155], a[176:179], v[124:127]
v_cvt_pk_bf16_f32 v88, v88, v89
v_cvt_pk_bf16_f32 v89, v90, v91
M v[128:131], a[96:99], a[184:187], v[128:131]
s_add_u32 m0, s29, 2048
s_nop 0
buffer_load_dwordx4 v2, s[8:11], s23 offen offset:0 lds
v_cvt_pk_bf16_f32 v90, v92, v93
v_cvt_pk_bf16_f32 v91, v94, v95
M v[128:131], a[100:103], a[188:191], v[128:131]
ds_read_b128 a[168:171], v10 offset:51200
ds_read_b128 a[172:175], v11 offset:51200
M v[132:135], a[108:111], a[188:191], v[132:135]
s_add_u32 s94, s92, 0
buffer_store_dwordx4 v[48:51], v1, s[16:19], s94 offen offset:2048 sc1
M v[132:135], a[104:107], a[184:187], v[132:135]
v_pk_mul_f32 v[96:97], v[96:97], s[4:5]
v_pk_mul_f32 v[98:99], v[98:99], s[4:5]
v_pk_mul_f32 v[100:101], v[100:101], s[4:5]
M v[136:139], a[112:115], a[184:187], v[136:139]
v_pk_mul_f32 v[102:103], v[102:103], s[4:5]
v_cvt_pk_bf16_f32 v96, v96, v97
M v[136:139], a[116:119], a[188:191], v[136:139]
buffer_load_dwordx4 v3, s[8:11], s23 offen offset:1024 lds
v_cvt_pk_bf16_f32 v97, v98, v99
v_cvt_pk_bf16_f32 v98, v100, v101
M v[140:143], a[124:127], a[188:191], v[140:143]
v_cvt_pk_bf16_f32 v99, v102, v103
v_pk_mul_f32 v[104:105], v[104:105], s[4:5]
v_pk_mul_f32 v[106:107], v[106:107], s[4:5]
M v[140:143], a[120:123], a[184:187], v[140:143]
v_pk_mul_f32 v[108:109], v[108:109], s[4:5]
v_pk_mul_f32 v[110:111], v[110:111], s[4:5]
M v[144:147], a[128:131], a[184:187], v[144:147]
s_add_u32 s94, s92, 0
buffer_store_dwordx4 v[56:59], v1, s[16:19], s94 offen offset:3072 sc1
v_cvt_pk_bf16_f32 v104, v104, v105
v_cvt_pk_bf16_f32 v105, v106, v107
M v[144:147], a[132:135], a[188:191], v[144:147]
v_cvt_pk_bf16_f32 v106, v108, v109
v_cvt_pk_bf16_f32 v107, v110, v111
M v[148:151], a[140:143], a[188:191], v[148:151]
buffer_load_dwordx4 v4, s[8:11], s23 offen offset:2048 lds
v_pk_mul_f32 v[112:113], v[112:113], s[4:5]
v_pk_mul_f32 v[114:115], v[114:115], s[4:5]
v_pk_mul_f32 v[116:117], v[116:117], s[4:5]
M v[148:151], a[136:139], a[184:187], v[148:151]
v_pk_mul_f32 v[118:119], v[118:119], s[4:5]
v_cvt_pk_bf16_f32 v112, v112, v113
M v[152:155], a[144:147], a[184:187], v[152:155]
v_cvt_pk_bf16_f32 v113, v114, v115
v_cvt_pk_bf16_f32 v114, v116, v117
M v[152:155], a[148:151], a[188:191], v[152:155]
buffer_load_dwordx4 v5, s[8:11], s23 offen offset:3072 lds
v_cvt_pk_bf16_f32 v115, v118, v119
v_pk_mul_f32 v[120:121], v[120:121], s[4:5]
v_pk_mul_f32 v[122:123], v[122:123], s[4:5]
M v[156:159], a[156:159], a[188:191], v[156:159]
v_pk_mul_f32 v[124:125], v[124:125], s[4:5]
v_pk_mul_f32 v[126:127], v[126:127], s[4:5]
M v[156:159], a[152:155], a[184:187], v[156:159]
s_add_u32 s94, s92, 4096
buffer_store_dwordx4 v[64:67], v1, s[16:19], s94 offen offset:0 sc1
s_waitcnt lgkmcnt(2)
v_cvt_pk_bf16_f32 v120, v120, v121
v_cvt_pk_bf16_f32 v121, v122, v123
M v[160:163], a[96:99], a[160:163], v[160:163]
v_cvt_pk_bf16_f32 v122, v124, v125
v_cvt_pk_bf16_f32 v123, v126, v127
M v[160:163], a[100:103], a[164:167], v[160:163]
ds_read_b128 a[176:179], v10 offset:53248
ds_read_b128 a[180:183], v11 offset:53248
M v[164:167], a[108:111], a[164:167], v[164:167]
s_sub_u32 s31, s31, 1
s_cmp_eq_u32 s31, 0
s_cselect_b32 s58, -1920, s57
s_add_u32 s23, s23, s58
s_add_u32 s24, s24, s58
M v[164:167], a[104:107], a[160:163], v[164:167]
v_pk_mul_f32 v[128:129], v[128:129], s[4:5]
v_pk_mul_f32 v[130:131], v[130:131], s[4:5]
v_pk_mul_f32 v[132:133], v[132:133], s[4:5]
M v[168:171], a[112:115], a[160:163], v[168:171]
v_pk_mul_f32 v[134:135], v[134:135], s[4:5]
v_cvt_pk_bf16_f32 v128, v128, v129
M v[168:171], a[116:119], a[164:167], v[168:171]
s_add_u32 s94, s92, 4096
buffer_store_dwordx4 v[72:75], v1, s[16:19], s94 offen offset:1024 sc1
v_cvt_pk_bf16_f32 v129, v130, v131
v_cvt_pk_bf16_f32 v130, v132, v133
M v[172:175], a[124:127], a[164:167], v[172:175]
v_cvt_pk_bf16_f32 v131, v134, v135
v_pk_mul_f32 v[136:137], v[136:137], s[4:5]
v_pk_mul_f32 v[138:139], v[138:139], s[4:5]
M v[172:175], a[120:123], a[160:163], v[172:175]
s_add_u32 m0, s30, 98304
s_nop 0
buffer_load_dwordx4 v6, s[12:15], s25 offen offset:0 lds
v_pk_mul_f32 v[140:141], v[140:141], s[4:5]
v_pk_mul_f32 v[142:143], v[142:143], s[4:5]
M v[176:179], a[128:131], a[160:163], v[176:179]
v_cvt_pk_bf16_f32 v136, v136, v137
v_cvt_pk_bf16_f32 v137, v138, v139
M v[176:179], a[132:135], a[164:167], v[176:179]
v_cvt_pk_bf16_f32 v138, v140, v141
v_cvt_pk_bf16_f32 v139, v142, v143
M v[180:183], a[140:143], a[164:167], v[180:183]
buffer_load_dwordx4 v7, s[12:15], s25 offen offset:1024 lds
v_pk_mul_f32 v[144:145], v[144:145], s[4:5]
v_pk_mul_f32 v[146:147], v[146:147], s[4:5]
v_pk_mul_f32 v[148:149], v[148:149], s[4:5]
M v[180:183], a[136:139], a[160:163], v[180:183]
v_pk_mul_f32 v[150:151], v[150:151], s[4:5]
v_cvt_pk_bf16_f32 v144, v144, v145
M v[184:187], a[144:147], a[160:163], v[184:187]
s_add_u32 s94, s92, 4096
buffer_store_dwordx4 v[80:83], v1, s[16:19], s94 offen offset:2048 sc1
v_cvt_pk_bf16_f32 v145, v146, v147
v_cvt_pk_bf16_f32 v146, v148, v149
M v[184:187], a[148:151], a[164:167], v[184:187]
v_cvt_pk_bf16_f32 v147, v150, v151
v_pk_mul_f32 v[152:153], v[152:153], s[4:5]
v_pk_mul_f32 v[154:155], v[154:155], s[4:5]
M v[188:191], a[156:159], a[164:167], v[188:191]
buffer_load_dwordx4 v8, s[12:15], s25 offen offset:2048 lds
v_pk_mul_f32 v[156:157], v[156:157], s[4:5]
v_pk_mul_f32 v[158:159], v[158:159], s[4:5]
M v[188:191], a[152:155], a[160:163], v[188:191]
s_waitcnt lgkmcnt(2)
v_cvt_pk_bf16_f32 v152, v152, v153
v_cvt_pk_bf16_f32 v153, v154, v155
M v[192:195], a[96:99], a[168:171], v[192:195]
v_cvt_pk_bf16_f32 v154, v156, v157
v_cvt_pk_bf16_f32 v155, v158, v159
M v[192:195], a[100:103], a[172:175], v[192:195]
ds_read_b128 a[184:187], v10 offset:55296
ds_read_b128 a[188:191], v11 offset:55296
M v[196:199], a[108:111], a[172:175], v[196:199]
M v[196:199], a[104:107], a[168:171], v[196:199]
s_add_u32 s94, s92, 4096
buffer_store_dwordx4 v[88:91], v1, s[16:19], s94 offen offset:3072 sc1
v_pk_mul_f32 v[160:161], v[160:161], s[4:5]
v_pk_mul_f32 v[162:163], v[162:163], s[4:5]
v_pk_mul_f32 v[164:165], v[164:165], s[4:5]
M v[200:203], a[112:115], a[168:171], v[200:203]
buffer_load_dwordx4 v9, s[12:15], s25 offen offset:3072 lds
v_pk_mul_f32 v[166:167], v[166:167], s[4:5]
v_cvt_pk_bf16_f32 v160, v160, v161
M v[200:203], a[116:119], a[172:175], v[200:203]
v_cvt_pk_bf16_f32 v161, v162, v163
v_cvt_pk_bf16_f32 v162, v164, v165
M v[204:207], a[124:127], a[172:175], v[204:207]
v_cvt_pk_bf16_f32 v163, v166, v167
v_pk_mul_f32 v[168:169], v[168:169], s[4:5]
v_pk_mul_f32 v[170:171], v[170:171], s[4:5]
M v[204:207], a[120:123], a[168:171], v[204:207]
v_pk_mul_f32 v[172:173], v[172:173], s[4:5]
v_pk_mul_f32 v[174:175], v[174:175], s[4:5]
M v[208:211], a[128:131], a[168:171], v[208:211]
s_add_u32 m0, s30, 102400
s_nop 0
buffer_load_dwordx4 v21, s[12:15], s25 offen offset:0 lds
v_cvt_pk_bf16_f32 v168, v168, v169
v_cvt_pk_bf16_f32 v169, v170, v171
M v[208:211], a[132:135], a[172:175], v[208:211]
v_cvt_pk_bf16_f32 v170, v172, v173
v_cvt_pk_bf16_f32 v171, v174, v175
M v[212:215], a[140:143], a[172:175], v[212:215]
s_add_u32 s94, s92, 8192
buffer_store_dwordx4 v[96:99], v1, s[16:19], s94 offen offset:0 sc1
v_pk_mul_f32 v[176:177], v[176:177], s[4:5]
v_pk_mul_f32 v[178:179], v[178:179], s[4:5]
v_pk_mul_f32 v[180:181], v[180:181], s[4:5]
M v[212:215], a[136:139], a[168:171], v[212:215]
v_pk_mul_f32 v[182:183], v[182:183], s[4:5]
v_cvt_pk_bf16_f32 v176, v176, v177
M v[216:219], a[144:147], a[168:171], v[216:219]
buffer_load_dwordx4 v22, s[12:15], s25 offen offset:1024 lds
v_cvt_pk_bf16_f32 v177, v178, v179
v_cvt_pk_bf16_f32 v178, v180, v181
M v[216:219], a[148:151], a[172:175], v[216:219]
v_cvt_pk_bf16_f32 v179, v182, v183
v_pk_mul_f32 v[184:185], v[184:185], s[4:5]
v_pk_mul_f32 v[186:187], v[186:187], s[4:5]
M v[220:223], a[156:159], a[172:175], v[220:223]
v_pk_mul_f32 v[188:189], v[188:189], s[4:5]
v_pk_mul_f32 v[190:191], v[190:191], s[4:5]
M v[220:223], a[152:155], a[168:171], v[220:223]
s_waitcnt lgkmcnt(2)
v_cvt_pk_bf16_f32 v184, v184, v185
v_cvt_pk_bf16_f32 v185, v186, v187
M v[224:227], a[96:99], a[176:179], v[224:227]
s_add_u32 s94, s92, 8192
buffer_store_dwordx4 v[104:107], v1, s[16:19], s94 offen offset:1024 sc1
v_cvt_pk_bf16_f32 v186, v188, v189
v_cvt_pk_bf16_f32 v187, v190, v191
M v[224:227], a[100:103], a[180:183], v[224:227]
s_sub_u32 s54, s54, 1
s_cmp_eq_u32 s54, 0
s_cselect_b32 s58, s55, s56
s_add_u32 s25, s25, s58
M v[228:231], a[108:111], a[180:183], v[228:231]
M v[228:231], a[104:107], a[176:179], v[228:231]
v_pk_mul_f32 v[192:193], v[192:193], s[4:5]
v_pk_mul_f32 v[194:195], v[194:195], s[4:5]
v_pk_mul_f32 v[196:197], v[196:197], s[4:5]
M v[232:235], a[112:115], a[176:179], v[232:235]
v_pk_mul_f32 v[198:199], v[198:199], s[4:5]
v_cvt_pk_bf16_f32 v192, v192, v193
M v[232:235], a[116:119], a[180:183], v[232:235]
v_cvt_pk_bf16_f32 v193, v194, v195
v_cvt_pk_bf16_f32 v194, v196, v197
M v[236:239], a[124:127], a[180:183], v[236:239]
v_cvt_pk_bf16_f32 v195, v198, v199
v_pk_mul_f32 v[200:201], v[200:201], s[4:5]
v_pk_mul_f32 v[202:203], v[202:203], s[4:5]
M v[236:239], a[120:123], a[176:179], v[236:239]
s_waitcnt vmcnt(63) lgkmcnt(0)
s_barrier
v_pk_mul_f32 v[204:205], v[204:205], s[4:5]
v_pk_mul_f32 v[206:207], v[206:207], s[4:5]
M v[240:243], a[128:131], a[176:179], v[240:243]
s_add_u32 s94, s92, 8192
buffer_store_dwordx4 v[112:115], v1, s[16:19], s94 offen offset:2048 sc1
v_cvt_pk_bf16_f32 v200, v200, v201
v_cvt_pk_bf16_f32 v201, v202, v203
M v[240:243], a[132:135], a[180:183], v[240:243]
s_add_u32 m0, s28, 18432
s_nop 0
buffer_load_dword v20, s[8:11], s24 offen lds
v_cvt_pk_bf16_f32 v202, v204, v205
v_cvt_pk_bf16_f32 v203, v206, v207
M v[244:247], a[140:143], a[180:183], v[244:247]
v_pk_mul_f32 v[208:209], v[208:209], s[4:5]
v_pk_mul_f32 v[210:211], v[210:211], s[4:5]
v_pk_mul_f32 v[212:213], v[212:213], s[4:5]
M v[244:247], a[136:139], a[176:179], v[244:247]
v_pk_mul_f32 v[214:215], v[214:215], s[4:5]
v_cvt_pk_bf16_f32 v208, v208, v209
M v[248:251], a[144:147], a[176:179], v[248:251]
buffer_load_dword v23, s[8:11], s24 offen offset:256 lds
v_cvt_pk_bf16_f32 v209, v210, v211
v_cvt_pk_bf16_f32 v210, v212, v213
M v[248:251], a[148:151], a[180:183], v[248:251]
v_cvt_pk_bf16_f32 v211, v214, v215
v_pk_mul_f32 v[216:217], v[216:217], s[4:5]
v_pk_mul_f32 v[218:219], v[218:219], s[4:5]
M v[252:255], a[156:159], a[180:183], v[252:255]
s_add_u32 s94, s92, 8192
buffer_store_dwordx4 v[120:123], v1, s[16:19], s94 offen offset:3072 sc1
v_pk_mul_f32 v[220:221], v[220:221], s[4:5]
v_pk_mul_f32 v[222:223], v[222:223], s[4:5]
M v[252:255], a[152:155], a[176:179], v[252:255]
v_cvt_pk_bf16_f32 v216, v216, v217
v_cvt_pk_bf16_f32 v217, v218, v219
M a[0:3], a[96:99], a[184:187], a[0:3]
v_cvt_pk_bf16_f32 v218, v220, v221
v_cvt_pk_bf16_f32 v219, v222, v223
M a[0:3], a[100:103], a[188:191], a[0:3]
s_add_u32 m0, s29, 20480
s_nop 0
buffer_load_dwordx4 v2, s[8:11], s23 offen offset:0 lds
M a[4:7], a[108:111], a[188:191], a[4:7]
M a[4:7], a[104:107], a[184:187], a[4:7]
v_pk_mul_f32 v[224:225], v[224:225], s[4:5]
v_pk_mul_f32 v[226:227], v[226:227], s[4:5]
v_pk_mul_f32 v[228:229], v[228:229], s[4:5]
M a[8:11], a[112:115], a[184:187], a[8:11]
buffer_load_dwordx4 v3, s[8:11], s23 offen offset:1024 lds
v_pk_mul_f32 v[230:231], v[230:231], s[4:5]
v_cvt_pk_bf16_f32 v224, v224, v225
M a[8:11], a[116:119], a[188:191], a[8:11]
s_add_u32 s94, s92, 12288
buffer_store_dwordx4 v[128:131], v1, s[16:19], s94 offen offset:0 sc1
v_cvt_pk_bf16_f32 v225, v226, v227
v_cvt_pk_bf16_f32 v226, v228, v229
M a[12:15], a[124:127], a[188:191], a[12:15]
v_cvt_pk_bf16_f32 v227, v230, v231
v_pk_mul_f32 v[232:233], v[232:233], s[4:5]
v_pk_mul_f32 v[234:235], v[234:235], s[4:5]
M a[12:15], a[120:123], a[184:187], a[12:15]
v_pk_mul_f32 v[236:237], v[236:237], s[4:5]
v_pk_mul_f32 v[238:239], v[238:239], s[4:5]
M a[16:19], a[128:131], a[184:187], a[16:19]
buffer_load_dwordx4 v4, s[8:11], s23 offen offset:2048 lds
v_cvt_pk_bf16_f32 v232, v232, v233
v_cvt_pk_bf16_f32 v233, v234, v235
M a[16:19], a[132:135], a[188:191], a[16:19]
v_cvt_pk_bf16_f32 v234, v236, v237
v_cvt_pk_bf16_f32 v235, v238, v239
M a[20:23], a[140:143], a[188:191], a[20:23]
v_pk_mul_f32 v[240:241], v[240:241], s[4:5]
v_pk_mul_f32 v[242:243], v[242:243], s[4:5]
v_pk_mul_f32 v[244:245], v[244:245], s[4:5]
M a[20:23], a[136:139], a[184:187], a[20:23]
buffer_load_dwordx4 v5, s[8:11], s23 offen offset:3072 lds
v_pk_mul_f32 v[246:247], v[246:247], s[4:5]
v_cvt_pk_bf16_f32 v240, v240, v241
M a[24:27], a[144:147], a[184:187], a[24:27]
s_add_u32 s94, s92, 12288
buffer_store_dwordx4 v[136:139], v1, s[16:19], s94 offen offset:1024 sc1
v_cvt_pk_bf16_f32 v241, v242, v243
v_cvt_pk_bf16_f32 v242, v244, v245
M a[24:27], a[148:151], a[188:191], a[24:27]
v_cvt_pk_bf16_f32 v243, v246, v247
v_pk_mul_f32 v[248:249], v[248:249], s[4:5]
v_pk_mul_f32 v[250:251], v[250:251], s[4:5]
M a[28:31], a[156:159], a[188:191], a[28:31]
v_pk_mul_f32 v[252:253], v[252:253], s[4:5]
v_pk_mul_f32 v[254:255], v[254:255], s[4:5]
M a[28:31], a[152:155], a[184:187], a[28:31]
v_cvt_pk_bf16_f32 v248, v248, v249
v_cvt_pk_bf16_f32 v249, v250, v251
v_cvt_pk_bf16_f32 v250, v252, v253
v_cvt_pk_bf16_f32 v251, v254, v255
v_accvgpr_read_b32 v24, a0
v_accvgpr_read_b32 v25, a1
v_accvgpr_read_b32 v26, a2
v_accvgpr_read_b32 v27, a3
v_accvgpr_read_b32 v28, a4
v_accvgpr_read_b32 v29, a5
v_accvgpr_read_b32 v30, a6
v_accvgpr_read_b32 v31, a7
v_pk_mul_f32 v[24:25], v[24:25], s[4:5]
v_pk_mul_f32 v[26:27], v[26:27], s[4:5]
v_pk_mul_f32 v[28:29], v[28:29], s[4:5]
v_pk_mul_f32 v[30:31], v[30:31], s[4:5]
v_cvt_pk_bf16_f32 v36, v24, v25
v_cvt_pk_bf16_f32 v37, v26, v27
v_cvt_pk_bf16_f32 v38, v28, v29
v_cvt_pk_bf16_f32 v39, v30, v31
v_accvgpr_read_b32 v24, a8
v_accvgpr_read_b32 v25, a9
v_accvgpr_read_b32 v26, a10
v_accvgpr_read_b32 v27, a11
v_accvgpr_read_b32 v28, a12
v_accvgpr_read_b32 v29, a13
v_accvgpr_read_b32 v30, a14
v_accvgpr_read_b32 v31, a15
v_pk_mul_f32 v[24:25], v[24:25], s[4:5]
v_pk_mul_f32 v[26:27], v[26:27], s[4:5]
v_pk_mul_f32 v[28:29], v[28:29], s[4:5]
v_pk_mul_f32 v[30:31], v[30:31], s[4:5]
v_cvt_pk_bf16_f32 v44, v24, v25
v_cvt_pk_bf16_f32 v45, v26, v27
v_cvt_pk_bf16_f32 v46, v28, v29
v_cvt_pk_bf16_f32 v47, v30, v31
v_accvgpr_read_b32 v24, a16
v_accvgpr_read_b32 v25, a17
v_accvgpr_read_b32 v26, a18
v_accvgpr_read_b32 v27, a19
v_accvgpr_read_b32 v28, a20
v_accvgpr_read_b32 v29, a21
v_accvgpr_read_b32 v30, a22
v_accvgpr_read_b32 v31, a23
v_pk_mul_f32 v[24:25], v[24:25], s[4:5]
v_pk_mul_f32 v[26:27], v[26:27], s[4:5]
v_pk_mul_f32 v[28:29], v[28:29], s[4:5]
v_pk_mul_f32 v[30:31], v[30:31], s[4:5]
v_cvt_pk_bf16_f32 v52, v24, v25
v_cvt_pk_bf16_f32 v53, v26, v27
v_cvt_pk_bf16_f32 v54, v28, v29
v_cvt_pk_bf16_f32 v55, v30, v31
v_accvgpr_read_b32 v24, a24
v_accvgpr_read_b32 v25, a25
v_accvgpr_read_b32 v26, a26
v_accvgpr_read_b32 v27, a27
v_accvgpr_read_b32 v28, a28
v_accvgpr_read_b32 v29, a29
v_accvgpr_read_b32 v30, a30
v_accvgpr_read_b32 v31, a31
v_pk_mul_f32 v[24:25], v[24:25], s[4:5]
v_pk_mul_f32 v[26:27], v[26:27], s[4:5]
v_pk_mul_f32 v[28:29], v[28:29], s[4:5]
v_pk_mul_f32 v[30:31], v[30:31], s[4:5]
v_cvt_pk_bf16_f32 v60, v24, v25
v_cvt_pk_bf16_f32 v61, v26, v27
v_cvt_pk_bf16_f32 v62, v28, v29
v_cvt_pk_bf16_f32 v63, v30, v31
s_branch Lk1_b
Lk1_spin:
s_add_u32 s40, s40, 1
s_cmp_gt_u32 s40, 1048576
s_cbranch_scc1 Lk1_got
s_sleep 2
buffer_load_dword v126, v119, s[36:39], 0 offen offset:128 sc1
s_waitcnt vmcnt(0)
v_cmp_gt_u32 vcc, 0x80, v126
s_nop 0
s_cbranch_vccnz Lk1_spin
s_branch Lk1_got
Lk1_spinq:
s_add_u32 s40, s40, 1
s_cmp_gt_u32 s40, 1048576
s_cbranch_scc1 Lk1_gotq
s_sleep 2
buffer_load_dword v125, v119, s[36:39], 0 offen offset:0 sc1
s_waitcnt vmcnt(0)
v_cmp_gt_u32 vcc, 0x80, v125
s_nop 0
s_cbranch_vccnz Lk1_spinq
s_branch Lk1_gotq
Lk1_kv:
s_mov_b64 s[60:61], s[40:41]
s_mov_b32 s62, 4194304
s_and_b32 s3, s2, 127
s_lshl_b32 s3, s3, 2
s_add_u32 s3, s3, s20
s_mul_i32 s54, s3, 1024
M v[32:35], a[32:35], a[160:163], 0
s_add_u32 m0, s29, 32768
s_nop 0
buffer_load_dwordx4 v2, s[8:11], s23 offen offset:0 lds
M v[32:35], a[36:39], a[164:167], v[32:35]
ds_read_b128 a[176:179], v10 offset:4096
ds_read_b128 a[180:183], v11 offset:4096
M v[36:39], a[44:47], a[164:167], 0
M v[36:39], a[40:43], a[160:163], v[36:39]
ds_read_b64_tr_b16 a[96:97], v12 offset:32768
ds_read_b64_tr_b16 a[98:99], v12 offset:34816
M v[40:43], a[48:51], a[160:163], 0
M v[40:43], a[52:55], a[164:167], v[40:43]
buffer_load_dwordx4 v3, s[8:11], s23 offen offset:1024 lds
M v[44:47], a[60:63], a[164:167], 0
M v[44:47], a[56:59], a[160:163], v[44:47]
ds_read_b64_tr_b16 a[104:105], v13 offset:32768
ds_read_b64_tr_b16 a[106:107], v13 offset:34816
M v[48:51], a[64:67], a[160:163], 0
M v[48:51], a[68:71], a[164:167], v[48:51]
buffer_load_dwordx4 v4, s[8:11], s23 offen offset:2048 lds
M v[52:55], a[76:79], a[164:167], 0
M v[52:55], a[72:75], a[160:163], v[52:55]
ds_read_b64_tr_b16 a[112:113], v14 offset:32768
ds_read_b64_tr_b16 a[114:115], v14 offset:34816
M v[56:59], a[80:83], a[160:163], 0
M v[56:59], a[84:87], a[164:167], v[56:59]
buffer_load_dwordx4 v5, s[8:11], s23 offen offset:3072 lds
M v[60:63], a[92:95], a[164:167], 0
M v[60:63], a[88:91], a[160:163], v[60:63]
ds_read_b64_tr_b16 a[120:121], v15 offset:32768
ds_read_b64_tr_b16 a[122:123], v15 offset:34816
M v[64:67], a[32:35], a[168:171], 0
M v[64:67], a[36:39], a[172:175], v[64:67]
ds_read_b128 a[184:187], v10 offset:6144
ds_read_b128 a[188:191], v11 offset:6144
M v[68:71], a[44:47], a[172:175], 0
s_add_u32 m0, s29, 65536
s_nop 0
buffer_load_dwordx4 v6, s[12:15], s24 offen offset:0 lds
M v[68:71], a[40:43], a[168:171], v[68:71]
ds_read_b64_tr_b16 a[128:129], v16 offset:32768
ds_read_b64_tr_b16 a[130:131], v16 offset:34816
M v[72:75], a[48:51], a[168:171], 0
M v[72:75], a[52:55], a[172:175], v[72:75]
M v[76:79], a[60:63], a[172:175], 0
buffer_load_dwordx4 v7, s[12:15], s24 offen offset:1024 lds
M v[76:79], a[56:59], a[168:171], v[76:79]
ds_read_b64_tr_b16 a[136:137], v17 offset:32768
ds_read_b64_tr_b16 a[138:139], v17 offset:34816
M v[80:83], a[64:67], a[168:171], 0
M v[80:83], a[68:71], a[172:175], v[80:83]
M v[84:87], a[76:79], a[172:175], 0
buffer_load_dwordx4 v8, s[12:15], s24 offen offset:2048 lds
M v[84:87], a[72:75], a[168:171], v[84:87]
ds_read_b64_tr_b16 a[144:145], v18 offset:32768
ds_read_b64_tr_b16 a[146:147], v18 offset:34816
M v[88:91], a[80:83], a[168:171], 0
M v[88:91], a[84:87], a[172:175], v[88:91]
M v[92:95], a[92:95], a[172:175], 0
buffer_load_dwordx4 v9, s[12:15], s24 offen offset:3072 lds
M v[92:95], a[88:91], a[168:171], v[92:95]
s_waitcnt lgkmcnt(15)
ds_read_b64_tr_b16 a[152:153], v19 offset:32768
ds_read_b64_tr_b16 a[154:155], v19 offset:34816
M v[96:99], a[32:35], a[176:179], 0
M v[96:99], a[36:39], a[180:183], v[96:99]
M v[100:103], a[44:47], a[180:183], 0
s_add_u32 s24, s24, 262144
M v[100:103], a[40:43], a[176:179], v[100:103]
M v[104:107], a[48:51], a[176:179], 0
M v[104:107], a[52:55], a[180:183], v[104:107]
M v[108:111], a[60:63], a[180:183], 0
M v[108:111], a[56:59], a[176:179], v[108:111]
s_waitcnt vmcnt(9) lgkmcnt(0)
s_barrier
ds_read_b128 a[160:163], v10 offset:16384
ds_read_b128 a[164:167], v11 offset:16384
M v[112:115], a[64:67], a[176:179], 0
s_add_u32 m0, s29, 49152
s_add_u32 s3, s23, s31
buffer_load_dwordx4 v2, s[8:11], s3 offen offset:0 lds
M v[112:115], a[68:71], a[180:183], v[112:115]
M v[116:119], a[76:79], a[180:183], 0
M v[116:119], a[72:75], a[176:179], v[116:119]
ds_read_b64_tr_b16 a[100:101], v12 offset:49152
ds_read_b64_tr_b16 a[102:103], v12 offset:51200
M v[120:123], a[80:83], a[176:179], 0
M v[120:123], a[84:87], a[180:183], v[120:123]
buffer_load_dwordx4 v3, s[8:11], s3 offen offset:1024 lds
M v[124:127], a[92:95], a[180:183], 0
M v[124:127], a[88:91], a[176:179], v[124:127]
M v[128:131], a[32:35], a[184:187], 0
M v[128:131], a[36:39], a[188:191], v[128:131]
ds_read_b128 a[168:171], v10 offset:18432
ds_read_b128 a[172:175], v11 offset:18432
ds_read_b64_tr_b16 a[108:109], v13 offset:49152
ds_read_b64_tr_b16 a[110:111], v13 offset:51200
M v[132:135], a[44:47], a[188:191], 0
M v[132:135], a[40:43], a[184:187], v[132:135]
M v[136:139], a[48:51], a[184:187], 0
buffer_load_dwordx4 v4, s[8:11], s3 offen offset:2048 lds
M v[136:139], a[52:55], a[188:191], v[136:139]
M v[140:143], a[60:63], a[188:191], 0
M v[140:143], a[56:59], a[184:187], v[140:143]
ds_read_b64_tr_b16 a[116:117], v14 offset:49152
ds_read_b64_tr_b16 a[118:119], v14 offset:51200
M v[144:147], a[64:67], a[184:187], 0
M v[144:147], a[68:71], a[188:191], v[144:147]
M v[148:151], a[76:79], a[188:191], 0
buffer_load_dwordx4 v5, s[8:11], s3 offen offset:3072 lds
M v[148:151], a[72:75], a[184:187], v[148:151]
M v[152:155], a[80:83], a[184:187], 0
M v[152:155], a[84:87], a[188:191], v[152:155]
ds_read_b64_tr_b16 a[124:125], v15 offset:49152
ds_read_b64_tr_b16 a[126:127], v15 offset:51200
M v[156:159], a[92:95], a[188:191], 0
M v[156:159], a[88:91], a[184:187], v[156:159]
s_waitcnt lgkmcnt(10)
M v[160:163], a[32:35], a[160:163], 0
M v[160:163], a[36:39], a[164:167], v[160:163]
ds_read_b128 a[176:179], v10 offset:20480
ds_read_b128 a[180:183], v11 offset:20480
M v[164:167], a[44:47], a[164:167], 0
s_add_u32 s23, s23, 128
s_cmp_eq_u32 s23, s25
s_cselect_b32 s23, s26, s23
M v[164:167], a[40:43], a[160:163], v[164:167]
ds_read_b64_tr_b16 a[132:133], v16 offset:49152
ds_read_b64_tr_b16 a[134:135], v16 offset:51200
M v[168:171], a[48:51], a[160:163], 0
M v[168:171], a[52:55], a[164:167], v[168:171]
M v[172:175], a[60:63], a[164:167], 0
M v[172:175], a[56:59], a[160:163], v[172:175]
M v[176:179], a[64:67], a[160:163], 0
s_add_u32 m0, s29, 81920
s_nop 0
buffer_load_dwordx4 v6, s[12:15], s24 offen offset:0 lds
M v[176:179], a[68:71], a[164:167], v[176:179]
ds_read_b64_tr_b16 a[140:141], v17 offset:49152
ds_read_b64_tr_b16 a[142:143], v17 offset:51200
M v[180:183], a[76:79], a[164:167], 0
M v[180:183], a[72:75], a[160:163], v[180:183]
M v[184:187], a[80:83], a[160:163], 0
M v[184:187], a[84:87], a[164:167], v[184:187]
buffer_load_dwordx4 v7, s[12:15], s24 offen offset:1024 lds
M v[188:191], a[92:95], a[164:167], 0
M v[188:191], a[88:91], a[160:163], v[188:191]
s_waitcnt lgkmcnt(12)
ds_read_b64_tr_b16 a[148:149], v18 offset:49152
ds_read_b64_tr_b16 a[150:151], v18 offset:51200
M v[192:195], a[32:35], a[168:171], 0
M v[192:195], a[36:39], a[172:175], v[192:195]
ds_read_b128 a[184:187], v10 offset:22528
ds_read_b128 a[188:191], v11 offset:22528
M v[196:199], a[44:47], a[172:175], 0
M v[196:199], a[40:43], a[168:171], v[196:199]
M v[200:203], a[48:51], a[168:171], 0
buffer_load_dwordx4 v8, s[12:15], s24 offen offset:2048 lds
M v[200:203], a[52:55], a[172:175], v[200:203]
ds_read_b64_tr_b16 a[156:157], v19 offset:49152
ds_read_b64_tr_b16 a[158:159], v19 offset:51200
M v[204:207], a[60:63], a[172:175], 0
M v[204:207], a[56:59], a[168:171], v[204:207]
M v[208:211], a[64:67], a[168:171], 0
M v[208:211], a[68:71], a[172:175], v[208:211]
M v[212:215], a[76:79], a[172:175], 0
buffer_load_dwordx4 v9, s[12:15], s24 offen offset:3072 lds
M v[212:215], a[72:75], a[168:171], v[212:215]
M v[216:219], a[80:83], a[168:171], 0
M v[216:219], a[84:87], a[172:175], v[216:219]
M v[220:223], a[92:95], a[172:175], 0
M v[220:223], a[88:91], a[168:171], v[220:223]
s_waitcnt lgkmcnt(10)
M v[224:227], a[32:35], a[176:179], 0
s_add_u32 s24, s24, 262144
s_cmp_eq_u32 s24, s27
s_cselect_b32 s24, s28, s24
s_sub_u32 s6, s6, 1
s_cmp_eq_u32 s6, 0
s_cselect_b64 s[12:13], s[64:65], s[12:13]
M v[224:227], a[36:39], a[180:183], v[224:227]
M v[228:231], a[44:47], a[180:183], 0
M v[228:231], a[40:43], a[176:179], v[228:231]
M v[232:235], a[48:51], a[176:179], 0
M v[232:235], a[52:55], a[180:183], v[232:235]
M v[236:239], a[60:63], a[180:183], 0
M v[236:239], a[56:59], a[176:179], v[236:239]
s_waitcnt vmcnt(8) lgkmcnt(0)
s_barrier
ds_read_b128 a[160:163], v10 offset:32768
ds_read_b128 a[164:167], v11 offset:32768
M v[240:243], a[64:67], a[176:179], 0
s_add_u32 m0, s29, 0
s_nop 0
buffer_load_dwordx4 v2, s[8:11], s23 offen offset:0 lds
M v[240:243], a[68:71], a[180:183], v[240:243]
M v[244:247], a[76:79], a[180:183], 0
M v[244:247], a[72:75], a[176:179], v[244:247]
M v[248:251], a[80:83], a[176:179], 0
M v[248:251], a[84:87], a[180:183], v[248:251]
buffer_load_dwordx4 v3, s[8:11], s23 offen offset:1024 lds
M v[252:255], a[92:95], a[180:183], 0
M v[252:255], a[88:91], a[176:179], v[252:255]
M a[0:3], a[32:35], a[184:187], 0
M a[0:3], a[36:39], a[188:191], a[0:3]
ds_read_b128 a[168:171], v10 offset:34816
ds_read_b128 a[172:175], v11 offset:34816
M a[4:7], a[44:47], a[188:191], 0
M a[4:7], a[40:43], a[184:187], a[4:7]
M a[8:11], a[48:51], a[184:187], 0
buffer_load_dwordx4 v4, s[8:11], s23 offen offset:2048 lds
M a[8:11], a[52:55], a[188:191], a[8:11]
M a[12:15], a[60:63], a[188:191], 0
M a[12:15], a[56:59], a[184:187], a[12:15]
M a[16:19], a[64:67], a[184:187], 0
M a[16:19], a[68:71], a[188:191], a[16:19]
buffer_load_dwordx4 v5, s[8:11], s23 offen offset:3072 lds
M a[20:23], a[76:79], a[188:191], 0
M a[20:23], a[72:75], a[184:187], a[20:23]
M a[24:27], a[80:83], a[184:187], 0
M a[24:27], a[84:87], a[188:191], a[24:27]
M a[28:31], a[92:95], a[188:191], 0
M a[28:31], a[88:91], a[184:187], a[28:31]
s_waitcnt lgkmcnt(2)
M v[32:35], a[96:99], a[160:163], v[32:35]
s_add_u32 m0, s29, 98304
s_nop 0
buffer_load_dwordx4 v6, s[12:15], s24 offen offset:0 lds
M v[32:35], a[100:103], a[164:167], v[32:35]
ds_read_b128 a[176:179], v10 offset:36864
ds_read_b128 a[180:183], v11 offset:36864
M v[36:39], a[108:111], a[164:167], v[36:39]
M v[36:39], a[104:107], a[160:163], v[36:39]
ds_read_b64_tr_b16 a[32:33], v12 offset:0
ds_read_b64_tr_b16 a[34:35], v12 offset:2048
M v[40:43], a[112:115], a[160:163], v[40:43]
M v[40:43], a[116:119], a[164:167], v[40:43]
M v[44:47], a[124:127], a[164:167], v[44:47]
M v[44:47], a[120:123], a[160:163], v[44:47]
ds_read_b64_tr_b16 a[40:41], v13 offset:0
ds_read_b64_tr_b16 a[42:43], v13 offset:2048
M v[48:51], a[128:131], a[160:163], v[48:51]
buffer_load_dwordx4 v7, s[12:15], s24 offen offset:1024 lds
M v[48:51], a[132:135], a[164:167], v[48:51]
M v[52:55], a[140:143], a[164:167], v[52:55]
M v[52:55], a[136:139], a[160:163], v[52:55]
ds_read_b64_tr_b16 a[48:49], v14 offset:0
ds_read_b64_tr_b16 a[50:51], v14 offset:2048
M v[56:59], a[144:147], a[160:163], v[56:59]
M v[56:59], a[148:151], a[164:167], v[56:59]
M v[60:63], a[156:159], a[164:167], v[60:63]
buffer_load_dwordx4 v8, s[12:15], s24 offen offset:2048 lds
M v[60:63], a[152:155], a[160:163], v[60:63]
s_waitcnt lgkmcnt(8)
ds_read_b64_tr_b16 a[56:57], v15 offset:0
ds_read_b64_tr_b16 a[58:59], v15 offset:2048
M v[64:67], a[96:99], a[168:171], v[64:67]
M v[64:67], a[100:103], a[172:175], v[64:67]
ds_read_b128 a[184:187], v10 offset:38912
ds_read_b128 a[188:191], v11 offset:38912
M v[68:71], a[108:111], a[172:175], v[68:71]
M v[68:71], a[104:107], a[168:171], v[68:71]
ds_read_b64_tr_b16 a[64:65], v16 offset:0
ds_read_b64_tr_b16 a[66:67], v16 offset:2048
M v[72:75], a[112:115], a[168:171], v[72:75]
M v[72:75], a[116:119], a[172:175], v[72:75]
M v[76:79], a[124:127], a[172:175], v[76:79]
M v[76:79], a[120:123], a[168:171], v[76:79]
ds_read_b64_tr_b16 a[72:73], v17 offset:0
ds_read_b64_tr_b16 a[74:75], v17 offset:2048
M v[80:83], a[128:131], a[168:171], v[80:83]
buffer_load_dwordx4 v9, s[12:15], s24 offen offset:3072 lds
M v[80:83], a[132:135], a[172:175], v[80:83]
M v[84:87], a[140:143], a[172:175], v[84:87]
M v[84:87], a[136:139], a[168:171], v[84:87]
ds_read_b64_tr_b16 a[80:81], v18 offset:0
ds_read_b64_tr_b16 a[82:83], v18 offset:2048
M v[88:91], a[144:147], a[168:171], v[88:91]
M v[88:91], a[148:151], a[172:175], v[88:91]
M v[92:95], a[156:159], a[172:175], v[92:95]
s_add_u32 s24, s24, 262144
M v[92:95], a[152:155], a[168:171], v[92:95]
s_waitcnt lgkmcnt(15)
ds_read_b64_tr_b16 a[88:89], v19 offset:0
ds_read_b64_tr_b16 a[90:91], v19 offset:2048
M v[96:99], a[96:99], a[176:179], v[96:99]
M v[96:99], a[100:103], a[180:183], v[96:99]
M v[100:103], a[108:111], a[180:183], v[100:103]
M v[100:103], a[104:107], a[176:179], v[100:103]
M v[104:107], a[112:115], a[176:179], v[104:107]
M v[104:107], a[116:119], a[180:183], v[104:107]
M v[108:111], a[124:127], a[180:183], v[108:111]
M v[108:111], a[120:123], a[176:179], v[108:111]
s_waitcnt vmcnt(8) lgkmcnt(0)
s_barrier
ds_read_b128 a[160:163], v10 offset:49152
ds_read_b128 a[164:167], v11 offset:49152
M v[112:115], a[128:131], a[176:179], v[112:115]
s_add_u32 m0, s29, 16384
s_add_u32 s3, s23, s31
buffer_load_dwordx4 v2, s[8:11], s3 offen offset:0 lds
M v[112:115], a[132:135], a[180:183], v[112:115]
M v[116:119], a[140:143], a[180:183], v[116:119]
M v[116:119], a[136:139], a[176:179], v[116:119]
ds_read_b64_tr_b16 a[36:37], v12 offset:16384
ds_read_b64_tr_b16 a[38:39], v12 offset:18432
M v[120:123], a[144:147], a[176:179], v[120:123]
M v[120:123], a[148:151], a[180:183], v[120:123]
buffer_load_dwordx4 v3, s[8:11], s3 offen offset:1024 lds
M v[124:127], a[156:159], a[180:183], v[124:127]
M v[124:127], a[152:155], a[176:179], v[124:127]
M v[128:131], a[96:99], a[184:187], v[128:131]
M v[128:131], a[100:103], a[188:191], v[128:131]
ds_read_b128 a[168:171], v10 offset:51200
ds_read_b128 a[172:175], v11 offset:51200
ds_read_b64_tr_b16 a[44:45], v13 offset:16384
ds_read_b64_tr_b16 a[46:47], v13 offset:18432
M v[132:135], a[108:111], a[188:191], v[132:135]
M v[132:135], a[104:107], a[184:187], v[132:135]
M v[136:139], a[112:115], a[184:187], v[136:139]
buffer_load_dwordx4 v4, s[8:11], s3 offen offset:2048 lds
M v[136:139], a[116:119], a[188:191], v[136:139]
M v[140:143], a[124:127], a[188:191], v[140:143]
M v[140:143], a[120:123], a[184:187], v[140:143]
ds_read_b64_tr_b16 a[52:53], v14 offset:16384
ds_read_b64_tr_b16 a[54:55], v14 offset:18432
M v[144:147], a[128:131], a[184:187], v[144:147]
M v[144:147], a[132:135], a[188:191], v[144:147]
M v[148:151], a[140:143], a[188:191], v[148:151]
buffer_load_dwordx4 v5, s[8:11], s3 offen offset:3072 lds
M v[148:151], a[136:139], a[184:187], v[148:151]
M v[152:155], a[144:147], a[184:187], v[152:155]
M v[152:155], a[148:151], a[188:191], v[152:155]
ds_read_b64_tr_b16 a[60:61], v15 offset:16384
ds_read_b64_tr_b16 a[62:63], v15 offset:18432
M v[156:159], a[156:159], a[188:191], v[156:159]
M v[156:159], a[152:155], a[184:187], v[156:159]
s_waitcnt lgkmcnt(10)
M v[160:163], a[96:99], a[160:163], v[160:163]
M v[160:163], a[100:103], a[164:167], v[160:163]
ds_read_b128 a[176:179], v10 offset:53248
ds_read_b128 a[180:183], v11 offset:53248
M v[164:167], a[108:111], a[164:167], v[164:167]
s_add_u32 s23, s23, 128
s_cmp_eq_u32 s23, s25
s_cselect_b32 s23, s26, s23
M v[164:167], a[104:107], a[160:163], v[164:167]
ds_read_b64_tr_b16 a[68:69], v16 offset:16384
ds_read_b64_tr_b16 a[70:71], v16 offset:18432
M v[168:171], a[112:115], a[160:163], v[168:171]
M v[168:171], a[116:119], a[164:167], v[168:171]
M v[172:175], a[124:127], a[164:167], v[172:175]
M v[172:175], a[120:123], a[160:163], v[172:175]
M v[176:179], a[128:131], a[160:163], v[176:179]
s_add_u32 m0, s29, 114688
s_nop 0
buffer_load_dwordx4 v6, s[12:15], s24 offen offset:0 lds
M v[176:179], a[132:135], a[164:167], v[176:179]
ds_read_b64_tr_b16 a[76:77], v17 offset:16384
ds_read_b64_tr_b16 a[78:79], v17 offset:18432
M v[180:183], a[140:143], a[164:167], v[180:183]
M v[180:183], a[136:139], a[160:163], v[180:183]
M v[184:187], a[144:147], a[160:163], v[184:187]
M v[184:187], a[148:151], a[164:167], v[184:187]
buffer_load_dwordx4 v7, s[12:15], s24 offen offset:1024 lds
M v[188:191], a[156:159], a[164:167], v[188:191]
M v[188:191], a[152:155], a[160:163], v[188:191]
s_waitcnt lgkmcnt(12)
ds_read_b64_tr_b16 a[84:85], v18 offset:16384
ds_read_b64_tr_b16 a[86:87], v18 offset:18432
M v[192:195], a[96:99], a[168:171], v[192:195]
M v[192:195], a[100:103], a[172:175], v[192:195]
ds_read_b128 a[184:187], v10 offset:55296
ds_read_b128 a[188:191], v11 offset:55296
M v[196:199], a[108:111], a[172:175], v[196:199]
M v[196:199], a[104:107], a[168:171], v[196:199]
M v[200:203], a[112:115], a[168:171], v[200:203]
buffer_load_dwordx4 v8, s[12:15], s24 offen offset:2048 lds
M v[200:203], a[116:119], a[172:175], v[200:203]
ds_read_b64_tr_b16 a[92:93], v19 offset:16384
ds_read_b64_tr_b16 a[94:95], v19 offset:18432
M v[204:207], a[124:127], a[172:175], v[204:207]
M v[204:207], a[120:123], a[168:171], v[204:207]
M v[208:211], a[128:131], a[168:171], v[208:211]
M v[208:211], a[132:135], a[172:175], v[208:211]
M v[212:215], a[140:143], a[172:175], v[212:215]
buffer_load_dwordx4 v9, s[12:15], s24 offen offset:3072 lds
M v[212:215], a[136:139], a[168:171], v[212:215]
M v[216:219], a[144:147], a[168:171], v[216:219]
M v[216:219], a[148:151], a[172:175], v[216:219]
M v[220:223], a[156:159], a[172:175], v[220:223]
M v[220:223], a[152:155], a[168:171], v[220:223]
s_waitcnt lgkmcnt(10)
M v[224:227], a[96:99], a[176:179], v[224:227]
s_add_u32 s24, s24, 262144
s_cmp_eq_u32 s24, s27
s_cselect_b32 s24, s28, s24
s_sub_u32 s6, s6, 1
s_cmp_eq_u32 s6, 0
s_cselect_b64 s[12:13], s[64:65], s[12:13]
M v[224:227], a[100:103], a[180:183], v[224:227]
M v[228:231], a[108:111], a[180:183], v[228:231]
M v[228:231], a[104:107], a[176:179], v[228:231]
M v[232:235], a[112:115], a[176:179], v[232:235]
M v[232:235], a[116:119], a[180:183], v[232:235]
M v[236:239], a[124:127], a[180:183], v[236:239]
M v[236:239], a[120:123], a[176:179], v[236:239]
s_waitcnt vmcnt(8) lgkmcnt(0)
s_barrier
ds_read_b128 a[160:163], v10 offset:0
ds_read_b128 a[164:167], v11 offset:0
M v[240:243], a[128:131], a[176:179], v[240:243]
s_add_u32 m0, s29, 32768
s_nop 0
buffer_load_dwordx4 v2, s[8:11], s23 offen offset:0 lds
M v[240:243], a[132:135], a[180:183], v[240:243]
M v[244:247], a[140:143], a[180:183], v[244:247]
M v[244:247], a[136:139], a[176:179], v[244:247]
M v[248:251], a[144:147], a[176:179], v[248:251]
M v[248:251], a[148:151], a[180:183], v[248:251]
buffer_load_dwordx4 v3, s[8:11], s23 offen offset:1024 lds
M v[252:255], a[156:159], a[180:183], v[252:255]
M v[252:255], a[152:155], a[176:179], v[252:255]
M a[0:3], a[96:99], a[184:187], a[0:3]
M a[0:3], a[100:103], a[188:191], a[0:3]
ds_read_b128 a[168:171], v10 offset:2048
ds_read_b128 a[172:175], v11 offset:2048
M a[4:7], a[108:111], a[188:191], a[4:7]
M a[4:7], a[104:107], a[184:187], a[4:7]
M a[8:11], a[112:115], a[184:187], a[8:11]
buffer_load_dwordx4 v4, s[8:11], s23 offen offset:2048 lds
M a[8:11], a[116:119], a[188:191], a[8:11]
M a[12:15], a[124:127], a[188:191], a[12:15]
M a[12:15], a[120:123], a[184:187], a[12:15]
M a[16:19], a[128:131], a[184:187], a[16:19]
M a[16:19], a[132:135], a[188:191], a[16:19]
buffer_load_dwordx4 v5, s[8:11], s23 offen offset:3072 lds
M a[20:23], a[140:143], a[188:191], a[20:23]
M a[20:23], a[136:139], a[184:187], a[20:23]
M a[24:27], a[144:147], a[184:187], a[24:27]
M a[24:27], a[148:151], a[188:191], a[24:27]
M a[28:31], a[156:159], a[188:191], a[28:31]
M a[28:31], a[152:155], a[184:187], a[28:31]
s_waitcnt lgkmcnt(2)
s_mov_b32 s30, 2
Lk1_kl:
M v[32:35], a[32:35], a[160:163], v[32:35]
s_add_u32 m0, s29, 65536
s_nop 0
buffer_load_dwordx4 v6, s[12:15], s24 offen offset:0 lds
M v[32:35], a[36:39], a[164:167], v[32:35]
ds_read_b128 a[176:179], v10 offset:4096
ds_read_b128 a[180:183], v11 offset:4096
M v[36:39], a[44:47], a[164:167], v[36:39]
M v[36:39], a[40:43], a[160:163], v[36:39]
ds_read_b64_tr_b16 a[96:97], v12 offset:32768
ds_read_b64_tr_b16 a[98:99], v12 offset:34816
M v[40:43], a[48:51], a[160:163], v[40:43]
M v[40:43], a[52:55], a[164:167], v[40:43]
M v[44:47], a[60:63], a[164:167], v[44:47]
M v[44:47], a[56:59], a[160:163], v[44:47]
ds_read_b64_tr_b16 a[104:105], v13 offset:32768
ds_read_b64_tr_b16 a[106:107], v13 offset:34816
M v[48:51], a[64:67], a[160:163], v[48:51]
buffer_load_dwordx4 v7, s[12:15], s24 offen offset:1024 lds
M v[48:51], a[68:71], a[164:167], v[48:51]
M v[52:55], a[76:79], a[164:167], v[52:55]
M v[52:55], a[72:75], a[160:163], v[52:55]
ds_read_b64_tr_b16 a[112:113], v14 offset:32768
ds_read_b64_tr_b16 a[114:115], v14 offset:34816
M v[56:59], a[80:83], a[160:163], v[56:59]
M v[56:59], a[84:87], a[164:167], v[56:59]
M v[60:63], a[92:95], a[164:167], v[60:63]
buffer_load_dwordx4 v8, s[12:15], s24 offen offset:2048 lds
M v[60:63], a[88:91], a[160:163], v[60:63]
s_waitcnt lgkmcnt(8)
ds_read_b64_tr_b16 a[120:121], v15 offset:32768
ds_read_b64_tr_b16 a[122:123], v15 offset:34816
M v[64:67], a[32:35], a[168:171], v[64:67]
M v[64:67], a[36:39], a[172:175], v[64:67]
ds_read_b128 a[184:187], v10 offset:6144
ds_read_b128 a[188:191], v11 offset:6144
M v[68:71], a[44:47], a[172:175], v[68:71]
M v[68:71], a[40:43], a[168:171], v[68:71]
ds_read_b64_tr_b16 a[128:129], v16 offset:32768
ds_read_b64_tr_b16 a[130:131], v16 offset:34816
M v[72:75], a[48:51], a[168:171], v[72:75]
M v[72:75], a[52:55], a[172:175], v[72:75]
M v[76:79], a[60:63], a[172:175], v[76:79]
M v[76:79], a[56:59], a[168:171], v[76:79]
ds_read_b64_tr_b16 a[136:137], v17 offset:32768
ds_read_b64_tr_b16 a[138:139], v17 offset:34816
M v[80:83], a[64:67], a[168:171], v[80:83]
buffer_load_dwordx4 v9, s[12:15], s24 offen offset:3072 lds
M v[80:83], a[68:71], a[172:175], v[80:83]
M v[84:87], a[76:79], a[172:175], v[84:87]
M v[84:87], a[72:75], a[168:171], v[84:87]
ds_read_b64_tr_b16 a[144:145], v18 offset:32768
ds_read_b64_tr_b16 a[146:147], v18 offset:34816
M v[88:91], a[80:83], a[168:171], v[88:91]
M v[88:91], a[84:87], a[172:175], v[88:91]
M v[92:95], a[92:95], a[172:175], v[92:95]
s_add_u32 s24, s24, 262144
M v[92:95], a[88:91], a[168:171], v[92:95]
s_waitcnt lgkmcnt(15)
ds_read_b64_tr_b16 a[152:153], v19 offset:32768
ds_read_b64_tr_b16 a[154:155], v19 offset:34816
M v[96:99], a[32:35], a[176:179], v[96:99]
M v[96:99], a[36:39], a[180:183], v[96:99]
M v[100:103], a[44:47], a[180:183], v[100:103]
M v[100:103], a[40:43], a[176:179], v[100:103]
M v[104:107], a[48:51], a[176:179], v[104:107]
M v[104:107], a[52:55], a[180:183], v[104:107]
M v[108:111], a[60:63], a[180:183], v[108:111]
M v[108:111], a[56:59], a[176:179], v[108:111]
s_waitcnt vmcnt(8) lgkmcnt(0)
s_barrier
ds_read_b128 a[160:163], v10 offset:16384
ds_read_b128 a[164:167], v11 offset:16384
M v[112:115], a[64:67], a[176:179], v[112:115]
s_add_u32 m0, s29, 49152
s_add_u32 s3, s23, s31
buffer_load_dwordx4 v2, s[8:11], s3 offen offset:0 lds
M v[112:115], a[68:71], a[180:183], v[112:115]
M v[116:119], a[76:79], a[180:183], v[116:119]
M v[116:119], a[72:75], a[176:179], v[116:119]
ds_read_b64_tr_b16 a[100:101], v12 offset:49152
ds_read_b64_tr_b16 a[102:103], v12 offset:51200
M v[120:123], a[80:83], a[176:179], v[120:123]
M v[120:123], a[84:87], a[180:183], v[120:123]
buffer_load_dwordx4 v3, s[8:11], s3 offen offset:1024 lds
M v[124:127], a[92:95], a[180:183], v[124:127]
M v[124:127], a[88:91], a[176:179], v[124:127]
M v[128:131], a[32:35], a[184:187], v[128:131]
M v[128:131], a[36:39], a[188:191], v[128:131]
ds_read_b128 a[168:171], v10 offset:18432
ds_read_b128 a[172:175], v11 offset:18432
ds_read_b64_tr_b16 a[108:109], v13 offset:49152
ds_read_b64_tr_b16 a[110:111], v13 offset:51200
M v[132:135], a[44:47], a[188:191], v[132:135]
M v[132:135], a[40:43], a[184:187], v[132:135]
M v[136:139], a[48:51], a[184:187], v[136:139]
buffer_load_dwordx4 v4, s[8:11], s3 offen offset:2048 lds
M v[136:139], a[52:55], a[188:191], v[136:139]
M v[140:143], a[60:63], a[188:191], v[140:143]
M v[140:143], a[56:59], a[184:187], v[140:143]
ds_read_b64_tr_b16 a[116:117], v14 offset:49152
ds_read_b64_tr_b16 a[118:119], v14 offset:51200
M v[144:147], a[64:67], a[184:187], v[144:147]
M v[144:147], a[68:71], a[188:191], v[144:147]
M v[148:151], a[76:79], a[188:191], v[148:151]
buffer_load_dwordx4 v5, s[8:11], s3 offen offset:3072 lds
M v[148:151], a[72:75], a[184:187], v[148:151]
M v[152:155], a[80:83], a[184:187], v[152:155]
M v[152:155], a[84:87], a[188:191], v[152:155]
ds_read_b64_tr_b16 a[124:125], v15 offset:49152
ds_read_b64_tr_b16 a[126:127], v15 offset:51200
M v[156:159], a[92:95], a[188:191], v[156:159]
M v[156:159], a[88:91], a[184:187], v[156:159]
s_waitcnt lgkmcnt(10)
M v[160:163], a[32:35], a[160:163], v[160:163]
M v[160:163], a[36:39], a[164:167], v[160:163]
ds_read_b128 a[176:179], v10 offset:20480
ds_read_b128 a[180:183], v11 offset:20480
M v[164:167], a[44:47], a[164:167], v[164:167]
s_add_u32 s23, s23, 128
s_cmp_eq_u32 s23, s25
s_cselect_b32 s23, s26, s23
M v[164:167], a[40:43], a[160:163], v[164:167]
ds_read_b64_tr_b16 a[132:133], v16 offset:49152
ds_read_b64_tr_b16 a[134:135], v16 offset:51200
M v[168:171], a[48:51], a[160:163], v[168:171]
M v[168:171], a[52:55], a[164:167], v[168:171]
M v[172:175], a[60:63], a[164:167], v[172:175]
M v[172:175], a[56:59], a[160:163], v[172:175]
M v[176:179], a[64:67], a[160:163], v[176:179]
s_add_u32 m0, s29, 81920
s_nop 0
buffer_load_dwordx4 v6, s[12:15], s24 offen offset:0 lds
M v[176:179], a[68:71], a[164:167], v[176:179]
ds_read_b64_tr_b16 a[140:141], v17 offset:49152
ds_read_b64_tr_b16 a[142:143], v17 offset:51200
M v[180:183], a[76:79], a[164:167], v[180:183]
M v[180:183], a[72:75], a[160:163], v[180:183]
M v[184:187], a[80:83], a[160:163], v[184:187]
M v[184:187], a[84:87], a[164:167], v[184:187]
buffer_load_dwordx4 v7, s[12:15], s24 offen offset:1024 lds
M v[188:191], a[92:95], a[164:167], v[188:191]
M v[188:191], a[88:91], a[160:163], v[188:191]
s_waitcnt lgkmcnt(12)
ds_read_b64_tr_b16 a[148:149], v18 offset:49152
ds_read_b64_tr_b16 a[150:151], v18 offset:51200
M v[192:195], a[32:35], a[168:171], v[192:195]
M v[192:195], a[36:39], a[172:175], v[192:195]
ds_read_b128 a[184:187], v10 offset:22528
ds_read_b128 a[188:191], v11 offset:22528
M v[196:199], a[44:47], a[172:175], v[196:199]
M v[196:199], a[40:43], a[168:171], v[196:199]
M v[200:203], a[48:51], a[168:171], v[200:203]
buffer_load_dwordx4 v8, s[12:15], s24 offen offset:2048 lds
M v[200:203], a[52:55], a[172:175], v[200:203]
ds_read_b64_tr_b16 a[156:157], v19 offset:49152
ds_read_b64_tr_b16 a[158:159], v19 offset:51200
M v[204:207], a[60:63], a[172:175], v[204:207]
M v[204:207], a[56:59], a[168:171], v[204:207]
M v[208:211], a[64:67], a[168:171], v[208:211]
M v[208:211], a[68:71], a[172:175], v[208:211]
M v[212:215], a[76:79], a[172:175], v[212:215]
buffer_load_dwordx4 v9, s[12:15], s24 offen offset:3072 lds
M v[212:215], a[72:75], a[168:171], v[212:215]
M v[216:219], a[80:83], a[168:171], v[216:219]
M v[216:219], a[84:87], a[172:175], v[216:219]
M v[220:223], a[92:95], a[172:175], v[220:223]
M v[220:223], a[88:91], a[168:171], v[220:223]
s_waitcnt lgkmcnt(10)
M v[224:227], a[32:35], a[176:179], v[224:227]
s_add_u32 s24, s24, 262144
s_cmp_eq_u32 s24, s27
s_cselect_b32 s24, s28, s24
s_sub_u32 s6, s6, 1
s_cmp_eq_u32 s6, 0
s_cselect_b64 s[12:13], s[64:65], s[12:13]
M v[224:227], a[36:39], a[180:183], v[224:227]
M v[228:231], a[44:47], a[180:183], v[228:231]
M v[228:231], a[40:43], a[176:179], v[228:231]
M v[232:235], a[48:51], a[176:179], v[232:235]
M v[232:235], a[52:55], a[180:183], v[232:235]
M v[236:239], a[60:63], a[180:183], v[236:239]
M v[236:239], a[56:59], a[176:179], v[236:239]
s_waitcnt vmcnt(8) lgkmcnt(0)
s_barrier
ds_read_b128 a[160:163], v10 offset:32768
ds_read_b128 a[164:167], v11 offset:32768
M v[240:243], a[64:67], a[176:179], v[240:243]
s_add_u32 m0, s29, 0
s_nop 0
buffer_load_dwordx4 v2, s[8:11], s23 offen offset:0 lds
M v[240:243], a[68:71], a[180:183], v[240:243]
M v[244:247], a[76:79], a[180:183], v[244:247]
M v[244:247], a[72:75], a[176:179], v[244:247]
M v[248:251], a[80:83], a[176:179], v[248:251]
M v[248:251], a[84:87], a[180:183], v[248:251]
buffer_load_dwordx4 v3, s[8:11], s23 offen offset:1024 lds
M v[252:255], a[92:95], a[180:183], v[252:255]
M v[252:255], a[88:91], a[176:179], v[252:255]
M a[0:3], a[32:35], a[184:187], a[0:3]
M a[0:3], a[36:39], a[188:191], a[0:3]
ds_read_b128 a[168:171], v10 offset:34816
ds_read_b128 a[172:175], v11 offset:34816
M a[4:7], a[44:47], a[188:191], a[4:7]
M a[4:7], a[40:43], a[184:187], a[4:7]
M a[8:11], a[48:51], a[184:187], a[8:11]
buffer_load_dwordx4 v4, s[8:11], s23 offen offset:2048 lds
M a[8:11], a[52:55], a[188:191], a[8:11]
M a[12:15], a[60:63], a[188:191], a[12:15]
M a[12:15], a[56:59], a[184:187], a[12:15]
M a[16:19], a[64:67], a[184:187], a[16:19]
M a[16:19], a[68:71], a[188:191], a[16:19]
buffer_load_dwordx4 v5, s[8:11], s23 offen offset:3072 lds
M a[20:23], a[76:79], a[188:191], a[20:23]
M a[20:23], a[72:75], a[184:187], a[20:23]
M a[24:27], a[80:83], a[184:187], a[24:27]
M a[24:27], a[84:87], a[188:191], a[24:27]
M a[28:31], a[92:95], a[188:191], a[28:31]
M a[28:31], a[88:91], a[184:187], a[28:31]
s_waitcnt lgkmcnt(2)
M v[32:35], a[96:99], a[160:163], v[32:35]
s_add_u32 m0, s29, 98304
s_nop 0
buffer_load_dwordx4 v6, s[12:15], s24 offen offset:0 lds
M v[32:35], a[100:103], a[164:167], v[32:35]
ds_read_b128 a[176:179], v10 offset:36864
ds_read_b128 a[180:183], v11 offset:36864
M v[36:39], a[108:111], a[164:167], v[36:39]
M v[36:39], a[104:107], a[160:163], v[36:39]
ds_read_b64_tr_b16 a[32:33], v12 offset:0
ds_read_b64_tr_b16 a[34:35], v12 offset:2048
M v[40:43], a[112:115], a[160:163], v[40:43]
M v[40:43], a[116:119], a[164:167], v[40:43]
M v[44:47], a[124:127], a[164:167], v[44:47]
M v[44:47], a[120:123], a[160:163], v[44:47]
ds_read_b64_tr_b16 a[40:41], v13 offset:0
ds_read_b64_tr_b16 a[42:43], v13 offset:2048
M v[48:51], a[128:131], a[160:163], v[48:51]
buffer_load_dwordx4 v7, s[12:15], s24 offen offset:1024 lds
M v[48:51], a[132:135], a[164:167], v[48:51]
M v[52:55], a[140:143], a[164:167], v[52:55]
M v[52:55], a[136:139], a[160:163], v[52:55]
ds_read_b64_tr_b16 a[48:49], v14 offset:0
ds_read_b64_tr_b16 a[50:51], v14 offset:2048
M v[56:59], a[144:147], a[160:163], v[56:59]
M v[56:59], a[148:151], a[164:167], v[56:59]
M v[60:63], a[156:159], a[164:167], v[60:63]
buffer_load_dwordx4 v8, s[12:15], s24 offen offset:2048 lds
M v[60:63], a[152:155], a[160:163], v[60:63]
s_waitcnt lgkmcnt(8)
ds_read_b64_tr_b16 a[56:57], v15 offset:0
ds_read_b64_tr_b16 a[58:59], v15 offset:2048
M v[64:67], a[96:99], a[168:171], v[64:67]
M v[64:67], a[100:103], a[172:175], v[64:67]
ds_read_b128 a[184:187], v10 offset:38912
ds_read_b128 a[188:191], v11 offset:38912
M v[68:71], a[108:111], a[172:175], v[68:71]
M v[68:71], a[104:107], a[168:171], v[68:71]
ds_read_b64_tr_b16 a[64:65], v16 offset:0
ds_read_b64_tr_b16 a[66:67], v16 offset:2048
M v[72:75], a[112:115], a[168:171], v[72:75]
M v[72:75], a[116:119], a[172:175], v[72:75]
M v[76:79], a[124:127], a[172:175], v[76:79]
M v[76:79], a[120:123], a[168:171], v[76:79]
ds_read_b64_tr_b16 a[72:73], v17 offset:0
ds_read_b64_tr_b16 a[74:75], v17 offset:2048
M v[80:83], a[128:131], a[168:171], v[80:83]
buffer_load_dwordx4 v9, s[12:15], s24 offen offset:3072 lds
M v[80:83], a[132:135], a[172:175], v[80:83]
M v[84:87], a[140:143], a[172:175], v[84:87]
M v[84:87], a[136:139], a[168:171], v[84:87]
ds_read_b64_tr_b16 a[80:81], v18 offset:0
ds_read_b64_tr_b16 a[82:83], v18 offset:2048
M v[88:91], a[144:147], a[168:171], v[88:91]
M v[88:91], a[148:151], a[172:175], v[88:91]
M v[92:95], a[156:159], a[172:175], v[92:95]
s_add_u32 s24, s24, 262144
M v[92:95], a[152:155], a[168:171], v[92:95]
s_waitcnt lgkmcnt(15)
ds_read_b64_tr_b16 a[88:89], v19 offset:0
ds_read_b64_tr_b16 a[90:91], v19 offset:2048
M v[96:99], a[96:99], a[176:179], v[96:99]
M v[96:99], a[100:103], a[180:183], v[96:99]
M v[100:103], a[108:111], a[180:183], v[100:103]
M v[100:103], a[104:107], a[176:179], v[100:103]
M v[104:107], a[112:115], a[176:179], v[104:107]
M v[104:107], a[116:119], a[180:183], v[104:107]
M v[108:111], a[124:127], a[180:183], v[108:111]
M v[108:111], a[120:123], a[176:179], v[108:111]
s_waitcnt vmcnt(8) lgkmcnt(0)
s_barrier
ds_read_b128 a[160:163], v10 offset:49152
ds_read_b128 a[164:167], v11 offset:49152
M v[112:115], a[128:131], a[176:179], v[112:115]
s_add_u32 m0, s29, 16384
s_add_u32 s3, s23, s31
buffer_load_dwordx4 v2, s[8:11], s3 offen offset:0 lds
M v[112:115], a[132:135], a[180:183], v[112:115]
M v[116:119], a[140:143], a[180:183], v[116:119]
M v[116:119], a[136:139], a[176:179], v[116:119]
ds_read_b64_tr_b16 a[36:37], v12 offset:16384
ds_read_b64_tr_b16 a[38:39], v12 offset:18432
M v[120:123], a[144:147], a[176:179], v[120:123]
M v[120:123], a[148:151], a[180:183], v[120:123]
buffer_load_dwordx4 v3, s[8:11], s3 offen offset:1024 lds
M v[124:127], a[156:159], a[180:183], v[124:127]
M v[124:127], a[152:155], a[176:179], v[124:127]
M v[128:131], a[96:99], a[184:187], v[128:131]
M v[128:131], a[100:103], a[188:191], v[128:131]
ds_read_b128 a[168:171], v10 offset:51200
ds_read_b128 a[172:175], v11 offset:51200
ds_read_b64_tr_b16 a[44:45], v13 offset:16384
ds_read_b64_tr_b16 a[46:47], v13 offset:18432
M v[132:135], a[108:111], a[188:191], v[132:135]
M v[132:135], a[104:107], a[184:187], v[132:135]
M v[136:139], a[112:115], a[184:187], v[136:139]
buffer_load_dwordx4 v4, s[8:11], s3 offen offset:2048 lds
M v[136:139], a[116:119], a[188:191], v[136:139]
M v[140:143], a[124:127], a[188:191], v[140:143]
M v[140:143], a[120:123], a[184:187], v[140:143]
ds_read_b64_tr_b16 a[52:53], v14 offset:16384
ds_read_b64_tr_b16 a[54:55], v14 offset:18432
M v[144:147], a[128:131], a[184:187], v[144:147]
M v[144:147], a[132:135], a[188:191], v[144:147]
M v[148:151], a[140:143], a[188:191], v[148:151]
buffer_load_dwordx4 v5, s[8:11], s3 offen offset:3072 lds
M v[148:151], a[136:139], a[184:187], v[148:151]
M v[152:155], a[144:147], a[184:187], v[152:155]
M v[152:155], a[148:151], a[188:191], v[152:155]
ds_read_b64_tr_b16 a[60:61], v15 offset:16384
ds_read_b64_tr_b16 a[62:63], v15 offset:18432
M v[156:159], a[156:159], a[188:191], v[156:159]
M v[156:159], a[152:155], a[184:187], v[156:159]
s_waitcnt lgkmcnt(10)
M v[160:163], a[96:99], a[160:163], v[160:163]
M v[160:163], a[100:103], a[164:167], v[160:163]
ds_read_b128 a[176:179], v10 offset:53248
ds_read_b128 a[180:183], v11 offset:53248
M v[164:167], a[108:111], a[164:167], v[164:167]
s_add_u32 s23, s23, 128
s_cmp_eq_u32 s23, s25
s_cselect_b32 s23, s26, s23
M v[164:167], a[104:107], a[160:163], v[164:167]
ds_read_b64_tr_b16 a[68:69], v16 offset:16384
ds_read_b64_tr_b16 a[70:71], v16 offset:18432
M v[168:171], a[112:115], a[160:163], v[168:171]
M v[168:171], a[116:119], a[164:167], v[168:171]
M v[172:175], a[124:127], a[164:167], v[172:175]
M v[172:175], a[120:123], a[160:163], v[172:175]
M v[176:179], a[128:131], a[160:163], v[176:179]
s_add_u32 m0, s29, 114688
s_nop 0
buffer_load_dwordx4 v6, s[12:15], s24 offen offset:0 lds
M v[176:179], a[132:135], a[164:167], v[176:179]
ds_read_b64_tr_b16 a[76:77], v17 offset:16384
ds_read_b64_tr_b16 a[78:79], v17 offset:18432
M v[180:183], a[140:143], a[164:167], v[180:183]
M v[180:183], a[136:139], a[160:163], v[180:183]
M v[184:187], a[144:147], a[160:163], v[184:187]
M v[184:187], a[148:151], a[164:167], v[184:187]
buffer_load_dwordx4 v7, s[12:15], s24 offen offset:1024 lds
M v[188:191], a[156:159], a[164:167], v[188:191]
M v[188:191], a[152:155], a[160:163], v[188:191]
s_waitcnt lgkmcnt(12)
ds_read_b64_tr_b16 a[84:85], v18 offset:16384
ds_read_b64_tr_b16 a[86:87], v18 offset:18432
M v[192:195], a[96:99], a[168:171], v[192:195]
M v[192:195], a[100:103], a[172:175], v[192:195]
ds_read_b128 a[184:187], v10 offset:55296
ds_read_b128 a[188:191], v11 offset:55296
M v[196:199], a[108:111], a[172:175], v[196:199]
M v[196:199], a[104:107], a[168:171], v[196:199]
M v[200:203], a[112:115], a[168:171], v[200:203]
buffer_load_dwordx4 v8, s[12:15], s24 offen offset:2048 lds
M v[200:203], a[116:119], a[172:175], v[200:203]
ds_read_b64_tr_b16 a[92:93], v19 offset:16384
ds_read_b64_tr_b16 a[94:95], v19 offset:18432
M v[204:207], a[124:127], a[172:175], v[204:207]
M v[204:207], a[120:123], a[168:171], v[204:207]
M v[208:211], a[128:131], a[168:171], v[208:211]
M v[208:211], a[132:135], a[172:175], v[208:211]
M v[212:215], a[140:143], a[172:175], v[212:215]
buffer_load_dwordx4 v9, s[12:15], s24 offen offset:3072 lds
M v[212:215], a[136:139], a[168:171], v[212:215]
M v[216:219], a[144:147], a[168:171], v[216:219]
M v[216:219], a[148:151], a[172:175], v[216:219]
M v[220:223], a[156:159], a[172:175], v[220:223]
M v[220:223], a[152:155], a[168:171], v[220:223]
s_waitcnt lgkmcnt(10)
M v[224:227], a[96:99], a[176:179], v[224:227]
s_add_u32 s24, s24, 262144
s_cmp_eq_u32 s24, s27
s_cselect_b32 s24, s28, s24
s_sub_u32 s6, s6, 1
s_cmp_eq_u32 s6, 0
s_cselect_b64 s[12:13], s[64:65], s[12:13]
M v[224:227], a[100:103], a[180:183], v[224:227]
M v[228:231], a[108:111], a[180:183], v[228:231]
M v[228:231], a[104:107], a[176:179], v[228:231]
M v[232:235], a[112:115], a[176:179], v[232:235]
M v[232:235], a[116:119], a[180:183], v[232:235]
M v[236:239], a[124:127], a[180:183], v[236:239]
M v[236:239], a[120:123], a[176:179], v[236:239]
s_waitcnt vmcnt(8) lgkmcnt(0)
s_barrier
ds_read_b128 a[160:163], v10 offset:0
ds_read_b128 a[164:167], v11 offset:0
M v[240:243], a[128:131], a[176:179], v[240:243]
s_add_u32 m0, s29, 32768
s_nop 0
buffer_load_dwordx4 v2, s[8:11], s23 offen offset:0 lds
M v[240:243], a[132:135], a[180:183], v[240:243]
M v[244:247], a[140:143], a[180:183], v[244:247]
M v[244:247], a[136:139], a[176:179], v[244:247]
M v[248:251], a[144:147], a[176:179], v[248:251]
M v[248:251], a[148:151], a[180:183], v[248:251]
buffer_load_dwordx4 v3, s[8:11], s23 offen offset:1024 lds
M v[252:255], a[156:159], a[180:183], v[252:255]
M v[252:255], a[152:155], a[176:179], v[252:255]
M a[0:3], a[96:99], a[184:187], a[0:3]
M a[0:3], a[100:103], a[188:191], a[0:3]
ds_read_b128 a[168:171], v10 offset:2048
ds_read_b128 a[172:175], v11 offset:2048
M a[4:7], a[108:111], a[188:191], a[4:7]
M a[4:7], a[104:107], a[184:187], a[4:7]
M a[8:11], a[112:115], a[184:187], a[8:11]
buffer_load_dwordx4 v4, s[8:11], s23 offen offset:2048 lds
M a[8:11], a[116:119], a[188:191], a[8:11]
M a[12:15], a[124:127], a[188:191], a[12:15]
M a[12:15], a[120:123], a[184:187], a[12:15]
M a[16:19], a[128:131], a[184:187], a[16:19]
M a[16:19], a[132:135], a[188:191], a[16:19]
buffer_load_dwordx4 v5, s[8:11], s23 offen offset:3072 lds
M a[20:23], a[140:143], a[188:191], a[20:23]
M a[20:23], a[136:139], a[184:187], a[20:23]
M a[24:27], a[144:147], a[184:187], a[24:27]
M a[24:27], a[148:151], a[188:191], a[24:27]
M a[28:31], a[156:159], a[188:191], a[28:31]
M a[28:31], a[152:155], a[184:187], a[28:31]
s_waitcnt lgkmcnt(2)
s_sub_u32 s30, s30, 1
s_cmp_lg_u32 s30, 0
s_cbranch_scc1 Lk1_kl
M v[32:35], a[32:35], a[160:163], v[32:35]
s_add_u32 m0, s29, 65536
s_nop 0
buffer_load_dwordx4 v6, s[12:15], s24 offen offset:0 lds
M v[32:35], a[36:39], a[164:167], v[32:35]
ds_read_b128 a[176:179], v10 offset:4096
ds_read_b128 a[180:183], v11 offset:4096
M v[36:39], a[44:47], a[164:167], v[36:39]
M v[36:39], a[40:43], a[160:163], v[36:39]
ds_read_b64_tr_b16 a[96:97], v12 offset:32768
ds_read_b64_tr_b16 a[98:99], v12 offset:34816
M v[40:43], a[48:51], a[160:163], v[40:43]
M v[40:43], a[52:55], a[164:167], v[40:43]
M v[44:47], a[60:63], a[164:167], v[44:47]
M v[44:47], a[56:59], a[160:163], v[44:47]
ds_read_b64_tr_b16 a[104:105], v13 offset:32768
ds_read_b64_tr_b16 a[106:107], v13 offset:34816
M v[48:51], a[64:67], a[160:163], v[48:51]
buffer_load_dwordx4 v7, s[12:15], s24 offen offset:1024 lds
M v[48:51], a[68:71], a[164:167], v[48:51]
M v[52:55], a[76:79], a[164:167], v[52:55]
M v[52:55], a[72:75], a[160:163], v[52:55]
ds_read_b64_tr_b16 a[112:113], v14 offset:32768
ds_read_b64_tr_b16 a[114:115], v14 offset:34816
M v[56:59], a[80:83], a[160:163], v[56:59]
M v[56:59], a[84:87], a[164:167], v[56:59]
M v[60:63], a[92:95], a[164:167], v[60:63]
buffer_load_dwordx4 v8, s[12:15], s24 offen offset:2048 lds
M v[60:63], a[88:91], a[160:163], v[60:63]
s_waitcnt lgkmcnt(8)
ds_read_b64_tr_b16 a[120:121], v15 offset:32768
ds_read_b64_tr_b16 a[122:123], v15 offset:34816
M v[64:67], a[32:35], a[168:171], v[64:67]
M v[64:67], a[36:39], a[172:175], v[64:67]
ds_read_b128 a[184:187], v10 offset:6144
ds_read_b128 a[188:191], v11 offset:6144
M v[68:71], a[44:47], a[172:175], v[68:71]
M v[68:71], a[40:43], a[168:171], v[68:71]
ds_read_b64_tr_b16 a[128:129], v16 offset:32768
ds_read_b64_tr_b16 a[130:131], v16 offset:34816
M v[72:75], a[48:51], a[168:171], v[72:75]
M v[72:75], a[52:55], a[172:175], v[72:75]
M v[76:79], a[60:63], a[172:175], v[76:79]
M v[76:79], a[56:59], a[168:171], v[76:79]
ds_read_b64_tr_b16 a[136:137], v17 offset:32768
ds_read_b64_tr_b16 a[138:139], v17 offset:34816
M v[80:83], a[64:67], a[168:171], v[80:83]
buffer_load_dwordx4 v9, s[12:15], s24 offen offset:3072 lds
M v[80:83], a[68:71], a[172:175], v[80:83]
M v[84:87], a[76:79], a[172:175], v[84:87]
M v[84:87], a[72:75], a[168:171], v[84:87]
ds_read_b64_tr_b16 a[144:145], v18 offset:32768
ds_read_b64_tr_b16 a[146:147], v18 offset:34816
M v[88:91], a[80:83], a[168:171], v[88:91]
M v[88:91], a[84:87], a[172:175], v[88:91]
M v[92:95], a[92:95], a[172:175], v[92:95]
s_add_u32 s24, s24, 262144
M v[92:95], a[88:91], a[168:171], v[92:95]
s_waitcnt lgkmcnt(15)
ds_read_b64_tr_b16 a[152:153], v19 offset:32768
ds_read_b64_tr_b16 a[154:155], v19 offset:34816
M v[96:99], a[32:35], a[176:179], v[96:99]
M v[96:99], a[36:39], a[180:183], v[96:99]
M v[100:103], a[44:47], a[180:183], v[100:103]
M v[100:103], a[40:43], a[176:179], v[100:103]
M v[104:107], a[48:51], a[176:179], v[104:107]
M v[104:107], a[52:55], a[180:183], v[104:107]
M v[108:111], a[60:63], a[180:183], v[108:111]
M v[108:111], a[56:59], a[176:179], v[108:111]
s_waitcnt vmcnt(8) lgkmcnt(0)
s_barrier
ds_read_b128 a[160:163], v10 offset:16384
ds_read_b128 a[164:167], v11 offset:16384
M v[112:115], a[64:67], a[176:179], v[112:115]
s_add_u32 m0, s29, 49152
s_add_u32 s3, s23, s31
buffer_load_dwordx4 v2, s[8:11], s3 offen offset:0 lds
M v[112:115], a[68:71], a[180:183], v[112:115]
M v[116:119], a[76:79], a[180:183], v[116:119]
M v[116:119], a[72:75], a[176:179], v[116:119]
ds_read_b64_tr_b16 a[100:101], v12 offset:49152
ds_read_b64_tr_b16 a[102:103], v12 offset:51200
M v[120:123], a[80:83], a[176:179], v[120:123]
M v[120:123], a[84:87], a[180:183], v[120:123]
buffer_load_dwordx4 v3, s[8:11], s3 offen offset:1024 lds
M v[124:127], a[92:95], a[180:183], v[124:127]
M v[124:127], a[88:91], a[176:179], v[124:127]
M v[128:131], a[32:35], a[184:187], v[128:131]
M v[128:131], a[36:39], a[188:191], v[128:131]
ds_read_b128 a[168:171], v10 offset:18432
ds_read_b128 a[172:175], v11 offset:18432
ds_read_b64_tr_b16 a[108:109], v13 offset:49152
ds_read_b64_tr_b16 a[110:111], v13 offset:51200
M v[132:135], a[44:47], a[188:191], v[132:135]
M v[132:135], a[40:43], a[184:187], v[132:135]
M v[136:139], a[48:51], a[184:187], v[136:139]
buffer_load_dwordx4 v4, s[8:11], s3 offen offset:2048 lds
M v[136:139], a[52:55], a[188:191], v[136:139]
M v[140:143], a[60:63], a[188:191], v[140:143]
M v[140:143], a[56:59], a[184:187], v[140:143]
ds_read_b64_tr_b16 a[116:117], v14 offset:49152
ds_read_b64_tr_b16 a[118:119], v14 offset:51200
M v[144:147], a[64:67], a[184:187], v[144:147]
M v[144:147], a[68:71], a[188:191], v[144:147]
M v[148:151], a[76:79], a[188:191], v[148:151]
buffer_load_dwordx4 v5, s[8:11], s3 offen offset:3072 lds
M v[148:151], a[72:75], a[184:187], v[148:151]
M v[152:155], a[80:83], a[184:187], v[152:155]
s_lshr_b32 s95, s53, 7
s_add_u32 s95, s95, s22
M v[152:155], a[84:87], a[188:191], v[152:155]
ds_read_b64_tr_b16 a[124:125], v15 offset:49152
ds_read_b64_tr_b16 a[126:127], v15 offset:51200
s_lshl_b32 s95, s95, 5
s_lshr_b32 s19, s52, 6
M v[156:159], a[92:95], a[188:191], v[156:159]
s_add_u32 s95, s95, s19
s_lshl_b32 s19, s21, 1
M v[156:159], a[88:91], a[184:187], v[156:159]
s_waitcnt lgkmcnt(10)
s_add_u32 s95, s95, s19
s_lshl_b32 s92, s95, 15
M v[160:163], a[32:35], a[160:163], v[160:163]
s_add_u32 s93, s92, 32768
s_add_u32 s16, s50, 16777216
M v[160:163], a[36:39], a[164:167], v[160:163]
ds_read_b128 a[176:179], v10 offset:20480
ds_read_b128 a[180:183], v11 offset:20480
s_addc_u32 s17, s51, 0
s_mov_b32 s18, 33554432
M v[164:167], a[44:47], a[164:167], v[164:167]
s_add_u32 s23, s23, 128
s_cmp_eq_u32 s23, s25
s_cselect_b32 s23, s26, s23
s_mov_b32 s19, 0x00020000
M v[164:167], a[40:43], a[160:163], v[164:167]
ds_read_b64_tr_b16 a[132:133], v16 offset:49152
ds_read_b64_tr_b16 a[134:135], v16 offset:51200
M v[168:171], a[48:51], a[160:163], v[168:171]
M v[168:171], a[52:55], a[164:167], v[168:171]
M v[172:175], a[60:63], a[164:167], v[172:175]
M v[172:175], a[56:59], a[160:163], v[172:175]
M v[176:179], a[64:67], a[160:163], v[176:179]
s_add_u32 m0, s29, 81920
s_nop 0
buffer_load_dwordx4 v6, s[12:15], s24 offen offset:0 lds
M v[176:179], a[68:71], a[164:167], v[176:179]
ds_read_b64_tr_b16 a[140:141], v17 offset:49152
ds_read_b64_tr_b16 a[142:143], v17 offset:51200
M v[180:183], a[76:79], a[164:167], v[180:183]
M v[180:183], a[72:75], a[160:163], v[180:183]
M v[184:187], a[80:83], a[160:163], v[184:187]
M v[184:187], a[84:87], a[164:167], v[184:187]
buffer_load_dwordx4 v7, s[12:15], s24 offen offset:1024 lds
M v[188:191], a[92:95], a[164:167], v[188:191]
M v[188:191], a[88:91], a[160:163], v[188:191]
s_waitcnt lgkmcnt(12)
ds_read_b64_tr_b16 a[148:149], v18 offset:49152
ds_read_b64_tr_b16 a[150:151], v18 offset:51200
M v[192:195], a[32:35], a[168:171], v[192:195]
M v[192:195], a[36:39], a[172:175], v[192:195]
ds_read_b128 a[184:187], v10 offset:22528
ds_read_b128 a[188:191], v11 offset:22528
M v[196:199], a[44:47], a[172:175], v[196:199]
M v[196:199], a[40:43], a[168:171], v[196:199]
M v[200:203], a[48:51], a[168:171], v[200:203]
buffer_load_dwordx4 v8, s[12:15], s24 offen offset:2048 lds
M v[200:203], a[52:55], a[172:175], v[200:203]
ds_read_b64_tr_b16 a[156:157], v19 offset:49152
ds_read_b64_tr_b16 a[158:159], v19 offset:51200
M v[204:207], a[60:63], a[172:175], v[204:207]
M v[204:207], a[56:59], a[168:171], v[204:207]
M v[208:211], a[64:67], a[168:171], v[208:211]
M v[208:211], a[68:71], a[172:175], v[208:211]
M v[212:215], a[76:79], a[172:175], v[212:215]
buffer_load_dwordx4 v9, s[12:15], s24 offen offset:3072 lds
M v[212:215], a[72:75], a[168:171], v[212:215]
M v[216:219], a[80:83], a[168:171], v[216:219]
M v[216:219], a[84:87], a[172:175], v[216:219]
M v[220:223], a[92:95], a[172:175], v[220:223]
M v[220:223], a[88:91], a[168:171], v[220:223]
s_waitcnt lgkmcnt(10)
M v[224:227], a[32:35], a[176:179], v[224:227]
s_add_u32 s24, s24, 262144
s_cmp_eq_u32 s24, s27
s_cselect_b32 s24, s28, s24
s_sub_u32 s6, s6, 1
s_cmp_eq_u32 s6, 0
s_cselect_b64 s[12:13], s[64:65], s[12:13]
M v[224:227], a[36:39], a[180:183], v[224:227]
M v[228:231], a[44:47], a[180:183], v[228:231]
M v[228:231], a[40:43], a[176:179], v[228:231]
M v[232:235], a[48:51], a[176:179], v[232:235]
M v[232:235], a[52:55], a[180:183], v[232:235]
M v[236:239], a[60:63], a[180:183], v[236:239]
M v[236:239], a[56:59], a[176:179], v[236:239]
s_waitcnt vmcnt(8) lgkmcnt(0)
s_barrier
ds_read_b128 a[160:163], v10 offset:32768
ds_read_b128 a[164:167], v11 offset:32768
M v[240:243], a[64:67], a[176:179], v[240:243]
s_add_u32 m0, s29, 0
s_nop 0
buffer_load_dwordx4 v2, s[8:11], s23 offen offset:0 lds
M v[240:243], a[68:71], a[180:183], v[240:243]
M v[244:247], a[76:79], a[180:183], v[244:247]
M v[244:247], a[72:75], a[176:179], v[244:247]
M v[248:251], a[80:83], a[176:179], v[248:251]
M v[248:251], a[84:87], a[180:183], v[248:251]
buffer_load_dwordx4 v3, s[8:11], s23 offen offset:1024 lds
M v[252:255], a[92:95], a[180:183], v[252:255]
M v[252:255], a[88:91], a[176:179], v[252:255]
M a[0:3], a[32:35], a[184:187], a[0:3]
M a[0:3], a[36:39], a[188:191], a[0:3]
ds_read_b128 a[168:171], v10 offset:34816
ds_read_b128 a[172:175], v11 offset:34816
M a[4:7], a[44:47], a[188:191], a[4:7]
M a[4:7], a[40:43], a[184:187], a[4:7]
M a[8:11], a[48:51], a[184:187], a[8:11]
buffer_load_dwordx4 v4, s[8:11], s23 offen offset:2048 lds
M a[8:11], a[52:55], a[188:191], a[8:11]
M a[12:15], a[60:63], a[188:191], a[12:15]
M a[12:15], a[56:59], a[184:187], a[12:15]
M a[16:19], a[64:67], a[184:187], a[16:19]
M a[16:19], a[68:71], a[188:191], a[16:19]
buffer_load_dwordx4 v5, s[8:11], s23 offen offset:3072 lds
M a[20:23], a[76:79], a[188:191], a[20:23]
M a[20:23], a[72:75], a[184:187], a[20:23]
M a[24:27], a[80:83], a[184:187], a[24:27]
M a[24:27], a[84:87], a[188:191], a[24:27]
M a[28:31], a[92:95], a[188:191], a[28:31]
M a[28:31], a[88:91], a[184:187], a[28:31]
s_waitcnt lgkmcnt(2)
M v[32:35], a[96:99], a[160:163], v[32:35]
s_add_u32 m0, s29, 98304
s_nop 0
buffer_load_dwordx4 v6, s[12:15], s24 offen offset:0 lds
M v[32:35], a[100:103], a[164:167], v[32:35]
ds_read_b128 a[176:179], v10 offset:36864
ds_read_b128 a[180:183], v11 offset:36864
M v[36:39], a[108:111], a[164:167], v[36:39]
M v[36:39], a[104:107], a[160:163], v[36:39]
ds_read_b64_tr_b16 a[32:33], v12 offset:0
ds_read_b64_tr_b16 a[34:35], v12 offset:2048
M v[40:43], a[112:115], a[160:163], v[40:43]
M v[40:43], a[116:119], a[164:167], v[40:43]
M v[44:47], a[124:127], a[164:167], v[44:47]
M v[44:47], a[120:123], a[160:163], v[44:47]
ds_read_b64_tr_b16 a[40:41], v13 offset:0
ds_read_b64_tr_b16 a[42:43], v13 offset:2048
M v[48:51], a[128:131], a[160:163], v[48:51]
buffer_load_dwordx4 v7, s[12:15], s24 offen offset:1024 lds
M v[48:51], a[132:135], a[164:167], v[48:51]
M v[52:55], a[140:143], a[164:167], v[52:55]
M v[52:55], a[136:139], a[160:163], v[52:55]
ds_read_b64_tr_b16 a[48:49], v14 offset:0
ds_read_b64_tr_b16 a[50:51], v14 offset:2048
M v[56:59], a[144:147], a[160:163], v[56:59]
M v[56:59], a[148:151], a[164:167], v[56:59]
M v[60:63], a[156:159], a[164:167], v[60:63]
buffer_load_dwordx4 v8, s[12:15], s24 offen offset:2048 lds
M v[60:63], a[152:155], a[160:163], v[60:63]
s_waitcnt lgkmcnt(8)
ds_read_b64_tr_b16 a[56:57], v15 offset:0
ds_read_b64_tr_b16 a[58:59], v15 offset:2048
M v[64:67], a[96:99], a[168:171], v[64:67]
M v[64:67], a[100:103], a[172:175], v[64:67]
ds_read_b128 a[184:187], v10 offset:38912
ds_read_b128 a[188:191], v11 offset:38912
M v[68:71], a[108:111], a[172:175], v[68:71]
M v[68:71], a[104:107], a[168:171], v[68:71]
ds_read_b64_tr_b16 a[64:65], v16 offset:0
ds_read_b64_tr_b16 a[66:67], v16 offset:2048
v_cvt_pk_bf16_f32 v32, v32, v33
v_cvt_pk_bf16_f32 v33, v34, v35
M v[72:75], a[112:115], a[168:171], v[72:75]
v_cvt_pk_bf16_f32 v34, v36, v37
v_cvt_pk_bf16_f32 v35, v38, v39
M v[72:75], a[116:119], a[172:175], v[72:75]
v_cvt_pk_bf16_f32 v40, v40, v41
v_cvt_pk_bf16_f32 v41, v42, v43
M v[76:79], a[124:127], a[172:175], v[76:79]
buffer_load_dwordx4 v9, s[12:15], s24 offen offset:3072 lds
v_cvt_pk_bf16_f32 v42, v44, v45
v_cvt_pk_bf16_f32 v43, v46, v47
M v[76:79], a[120:123], a[168:171], v[76:79]
ds_read_b64_tr_b16 a[72:73], v17 offset:0
ds_read_b64_tr_b16 a[74:75], v17 offset:2048
v_cvt_pk_bf16_f32 v48, v48, v49
v_cvt_pk_bf16_f32 v49, v50, v51
M v[80:83], a[128:131], a[168:171], v[80:83]
v_cvt_pk_bf16_f32 v50, v52, v53
v_cvt_pk_bf16_f32 v51, v54, v55
M v[80:83], a[132:135], a[172:175], v[80:83]
v_cvt_pk_bf16_f32 v56, v56, v57
v_cvt_pk_bf16_f32 v57, v58, v59
M v[84:87], a[140:143], a[172:175], v[84:87]
v_cvt_pk_bf16_f32 v58, v60, v61
v_cvt_pk_bf16_f32 v59, v62, v63
M v[84:87], a[136:139], a[168:171], v[84:87]
ds_read_b64_tr_b16 a[80:81], v18 offset:0
ds_read_b64_tr_b16 a[82:83], v18 offset:2048
M v[88:91], a[144:147], a[168:171], v[88:91]
M v[88:91], a[148:151], a[172:175], v[88:91]
s_add_u32 s24, s24, 262144
M v[92:95], a[156:159], a[172:175], v[92:95]
s_add_u32 s94, s92, 0
buffer_store_dwordx4 v[32:35], v1, s[16:19], s94 offen offset:0 sc1
M v[92:95], a[152:155], a[168:171], v[92:95]
s_waitcnt lgkmcnt(15)
ds_read_b64_tr_b16 a[88:89], v19 offset:0
ds_read_b64_tr_b16 a[90:91], v19 offset:2048
M v[96:99], a[96:99], a[176:179], v[96:99]
M v[96:99], a[100:103], a[180:183], v[96:99]
M v[100:103], a[108:111], a[180:183], v[100:103]
M v[100:103], a[104:107], a[176:179], v[100:103]
v_cvt_pk_bf16_f32 v64, v64, v65
v_cvt_pk_bf16_f32 v65, v66, v67
M v[104:107], a[112:115], a[176:179], v[104:107]
v_cvt_pk_bf16_f32 v66, v68, v69
v_cvt_pk_bf16_f32 v67, v70, v71
M v[104:107], a[116:119], a[180:183], v[104:107]
v_cvt_pk_bf16_f32 v72, v72, v73
v_cvt_pk_bf16_f32 v73, v74, v75
M v[108:111], a[124:127], a[180:183], v[108:111]
v_cvt_pk_bf16_f32 v74, v76, v77
v_cvt_pk_bf16_f32 v75, v78, v79
M v[108:111], a[120:123], a[176:179], v[108:111]
s_waitcnt vmcnt(9) lgkmcnt(0)
s_barrier
ds_read_b128 a[160:163], v10 offset:49152
ds_read_b128 a[164:167], v11 offset:49152
v_cvt_pk_bf16_f32 v80, v80, v81
v_cvt_pk_bf16_f32 v81, v82, v83
M v[112:115], a[128:131], a[176:179], v[112:115]
s_add_u32 s94, s92, 0
buffer_store_dwordx4 v[40:43], v1, s[16:19], s94 offen offset:1024 sc1
v_cvt_pk_bf16_f32 v82, v84, v85
v_cvt_pk_bf16_f32 v83, v86, v87
M v[112:115], a[132:135], a[180:183], v[112:115]
s_add_u32 m0, s29, 16384
s_add_u32 s3, s23, s31
buffer_load_dwordx4 v2, s[8:11], s3 offen offset:0 lds
v_cvt_pk_bf16_f32 v88, v88, v89
v_cvt_pk_bf16_f32 v89, v90, v91
M v[116:119], a[140:143], a[180:183], v[116:119]
v_cvt_pk_bf16_f32 v90, v92, v93
v_cvt_pk_bf16_f32 v91, v94, v95
M v[116:119], a[136:139], a[176:179], v[116:119]
ds_read_b64_tr_b16 a[36:37], v12 offset:16384
ds_read_b64_tr_b16 a[38:39], v12 offset:18432
M v[120:123], a[144:147], a[176:179], v[120:123]
M v[120:123], a[148:151], a[180:183], v[120:123]
M v[124:127], a[156:159], a[180:183], v[124:127]
buffer_load_dwordx4 v3, s[8:11], s3 offen offset:1024 lds
M v[124:127], a[152:155], a[176:179], v[124:127]
M v[128:131], a[96:99], a[184:187], v[128:131]
M v[128:131], a[100:103], a[188:191], v[128:131]
ds_read_b128 a[168:171], v10 offset:51200
ds_read_b128 a[172:175], v11 offset:51200
ds_read_b64_tr_b16 a[44:45], v13 offset:16384
ds_read_b64_tr_b16 a[46:47], v13 offset:18432
M v[132:135], a[108:111], a[188:191], v[132:135]
M v[132:135], a[104:107], a[184:187], v[132:135]
s_add_u32 s94, s92, 0
buffer_store_dwordx4 v[48:51], v1, s[16:19], s94 offen offset:2048 sc1
v_cvt_pk_bf16_f32 v96, v96, v97
v_cvt_pk_bf16_f32 v97, v98, v99
M v[136:139], a[112:115], a[184:187], v[136:139]
v_cvt_pk_bf16_f32 v98, v100, v101
v_cvt_pk_bf16_f32 v99, v102, v103
M v[136:139], a[116:119], a[188:191], v[136:139]
buffer_load_dwordx4 v4, s[8:11], s3 offen offset:2048 lds
v_cvt_pk_bf16_f32 v104, v104, v105
v_cvt_pk_bf16_f32 v105, v106, v107
M v[140:143], a[124:127], a[188:191], v[140:143]
v_cvt_pk_bf16_f32 v106, v108, v109
v_cvt_pk_bf16_f32 v107, v110, v111
M v[140:143], a[120:123], a[184:187], v[140:143]
ds_read_b64_tr_b16 a[52:53], v14 offset:16384
ds_read_b64_tr_b16 a[54:55], v14 offset:18432
v_cvt_pk_bf16_f32 v112, v112, v113
v_cvt_pk_bf16_f32 v113, v114, v115
M v[144:147], a[128:131], a[184:187], v[144:147]
v_cvt_pk_bf16_f32 v114, v116, v117
v_cvt_pk_bf16_f32 v115, v118, v119
M v[144:147], a[132:135], a[188:191], v[144:147]
v_cvt_pk_bf16_f32 v120, v120, v121
v_cvt_pk_bf16_f32 v121, v122, v123
M v[148:151], a[140:143], a[188:191], v[148:151]
buffer_load_dwordx4 v5, s[8:11], s3 offen offset:3072 lds
v_cvt_pk_bf16_f32 v122, v124, v125
v_cvt_pk_bf16_f32 v123, v126, v127
M v[148:151], a[136:139], a[184:187], v[148:151]
M v[152:155], a[144:147], a[184:187], v[152:155]
M v[152:155], a[148:151], a[188:191], v[152:155]
ds_read_b64_tr_b16 a[60:61], v15 offset:16384
ds_read_b64_tr_b16 a[62:63], v15 offset:18432
M v[156:159], a[156:159], a[188:191], v[156:159]
s_add_u32 s94, s92, 0
buffer_store_dwordx4 v[56:59], v1, s[16:19], s94 offen offset:3072 sc1
M v[156:159], a[152:155], a[184:187], v[156:159]
s_waitcnt lgkmcnt(10)
M v[160:163], a[96:99], a[160:163], v[160:163]
M v[160:163], a[100:103], a[164:167], v[160:163]
ds_read_b128 a[176:179], v10 offset:53248
ds_read_b128 a[180:183], v11 offset:53248
M v[164:167], a[108:111], a[164:167], v[164:167]
s_add_u32 s23, s23, 128
s_cmp_eq_u32 s23, s25
s_cselect_b32 s23, s26, s23
M v[164:167], a[104:107], a[160:163], v[164:167]
ds_read_b64_tr_b16 a[68:69], v16 offset:16384
ds_read_b64_tr_b16 a[70:71], v16 offset:18432
v_cvt_pk_bf16_f32 v128, v128, v129
v_cvt_pk_bf16_f32 v129, v130, v131
M v[168:171], a[112:115], a[160:163], v[168:171]
v_cvt_pk_bf16_f32 v130, v132, v133
v_cvt_pk_bf16_f32 v131, v134, v135
M v[168:171], a[116:119], a[164:167], v[168:171]
v_cvt_pk_bf16_f32 v136, v136, v137
v_cvt_pk_bf16_f32 v137, v138, v139
M v[172:175], a[124:127], a[164:167], v[172:175]
v_cvt_pk_bf16_f32 v138, v140, v141
v_cvt_pk_bf16_f32 v139, v142, v143
M v[172:175], a[120:123], a[160:163], v[172:175]
v_cvt_pk_bf16_f32 v144, v144, v145
v_cvt_pk_bf16_f32 v145, v146, v147
M v[176:179], a[128:131], a[160:163], v[176:179]
s_add_u32 s94, s92, 4096
buffer_store_dwordx4 v[64:67], v1, s[16:19], s94 offen offset:0 sc1
v_cvt_pk_bf16_f32 v146, v148, v149
v_cvt_pk_bf16_f32 v147, v150, v151
M v[176:179], a[132:135], a[164:167], v[176:179]
ds_read_b64_tr_b16 a[76:77], v17 offset:16384
ds_read_b64_tr_b16 a[78:79], v17 offset:18432
v_cvt_pk_bf16_f32 v152, v152, v153
v_cvt_pk_bf16_f32 v153, v154, v155
M v[180:183], a[140:143], a[164:167], v[180:183]
s_add_u32 m0, s29, 114688
s_nop 0
buffer_load_dwordx4 v6, s[12:15], s24 offen offset:0 lds
v_cvt_pk_bf16_f32 v154, v156, v157
v_cvt_pk_bf16_f32 v155, v158, v159
M v[180:183], a[136:139], a[160:163], v[180:183]
M v[184:187], a[144:147], a[160:163], v[184:187]
v_accvgpr_write_b32 a192, v128
v_accvgpr_write_b32 a193, v129
v_accvgpr_write_b32 a194, v130
v_accvgpr_write_b32 a195, v131
M v[184:187], a[148:151], a[164:167], v[184:187]
v_accvgpr_write_b32 a196, v136
v_accvgpr_write_b32 a197, v137
v_accvgpr_write_b32 a198, v138
v_accvgpr_write_b32 a199, v139
M v[188:191], a[156:159], a[164:167], v[188:191]
buffer_load_dwordx4 v7, s[12:15], s24 offen offset:1024 lds
v_accvgpr_write_b32 a200, v144
v_accvgpr_write_b32 a201, v145
v_accvgpr_write_b32 a202, v146
v_accvgpr_write_b32 a203, v147
M v[188:191], a[152:155], a[160:163], v[188:191]
s_waitcnt lgkmcnt(12)
ds_read_b64_tr_b16 a[84:85], v18 offset:16384
ds_read_b64_tr_b16 a[86:87], v18 offset:18432
v_accvgpr_write_b32 a204, v152
v_accvgpr_write_b32 a205, v153
v_accvgpr_write_b32 a206, v154
v_accvgpr_write_b32 a207, v155
M v[192:195], a[96:99], a[168:171], v[192:195]
M v[192:195], a[100:103], a[172:175], v[192:195]
ds_read_b128 a[184:187], v10 offset:55296
ds_read_b128 a[188:191], v11 offset:55296
M v[196:199], a[108:111], a[172:175], v[196:199]
s_add_u32 s94, s92, 4096
buffer_store_dwordx4 v[72:75], v1, s[16:19], s94 offen offset:1024 sc1
M v[196:199], a[104:107], a[168:171], v[196:199]
v_cvt_pk_bf16_f32 v160, v160, v161
v_cvt_pk_bf16_f32 v161, v162, v163
M v[200:203], a[112:115], a[168:171], v[200:203]
v_cvt_pk_bf16_f32 v162, v164, v165
v_cvt_pk_bf16_f32 v163, v166, v167
M v[200:203], a[116:119], a[172:175], v[200:203]
ds_read_b64_tr_b16 a[92:93], v19 offset:16384
ds_read_b64_tr_b16 a[94:95], v19 offset:18432
v_cvt_pk_bf16_f32 v168, v168, v169
v_cvt_pk_bf16_f32 v169, v170, v171
M v[204:207], a[124:127], a[172:175], v[204:207]
buffer_load_dwordx4 v8, s[12:15], s24 offen offset:2048 lds
v_cvt_pk_bf16_f32 v170, v172, v173
v_cvt_pk_bf16_f32 v171, v174, v175
M v[204:207], a[120:123], a[168:171], v[204:207]
v_cvt_pk_bf16_f32 v176, v176, v177
v_cvt_pk_bf16_f32 v177, v178, v179
M v[208:211], a[128:131], a[168:171], v[208:211]
v_cvt_pk_bf16_f32 v178, v180, v181
v_cvt_pk_bf16_f32 v179, v182, v183
M v[208:211], a[132:135], a[172:175], v[208:211]
v_cvt_pk_bf16_f32 v184, v184, v185
v_cvt_pk_bf16_f32 v185, v186, v187
M v[212:215], a[140:143], a[172:175], v[212:215]
buffer_load_dwordx4 v9, s[12:15], s24 offen offset:3072 lds
v_cvt_pk_bf16_f32 v186, v188, v189
v_cvt_pk_bf16_f32 v187, v190, v191
M v[212:215], a[136:139], a[168:171], v[212:215]
M v[216:219], a[144:147], a[168:171], v[216:219]
v_accvgpr_write_b32 a208, v160
v_accvgpr_write_b32 a209, v161
v_accvgpr_write_b32 a210, v162
v_accvgpr_write_b32 a211, v163
M v[216:219], a[148:151], a[172:175], v[216:219]
s_add_u32 s94, s92, 4096
buffer_store_dwordx4 v[80:83], v1, s[16:19], s94 offen offset:2048 sc1
v_accvgpr_write_b32 a212, v168
v_accvgpr_write_b32 a213, v169
v_accvgpr_write_b32 a214, v170
v_accvgpr_write_b32 a215, v171
M v[220:223], a[156:159], a[172:175], v[220:223]
v_accvgpr_write_b32 a216, v176
v_accvgpr_write_b32 a217, v177
v_accvgpr_write_b32 a218, v178
v_accvgpr_write_b32 a219, v179
M v[220:223], a[152:155], a[168:171], v[220:223]
s_waitcnt lgkmcnt(10)
v_accvgpr_write_b32 a220, v184
v_accvgpr_write_b32 a221, v185
v_accvgpr_write_b32 a222, v186
v_accvgpr_write_b32 a223, v187
M v[224:227], a[96:99], a[176:179], v[224:227]
s_add_u32 s24, s24, 262144
s_cmp_eq_u32 s24, s27
s_cselect_b32 s24, s28, s24
s_sub_u32 s6, s6, 1
s_cmp_eq_u32 s6, 0
s_cselect_b64 s[12:13], s[64:65], s[12:13]
M v[224:227], a[100:103], a[180:183], v[224:227]
M v[228:231], a[108:111], a[180:183], v[228:231]
M v[228:231], a[104:107], a[176:179], v[228:231]
v_cvt_pk_bf16_f32 v192, v192, v193
v_cvt_pk_bf16_f32 v193, v194, v195
M v[232:235], a[112:115], a[176:179], v[232:235]
v_cvt_pk_bf16_f32 v194, v196, v197
v_cvt_pk_bf16_f32 v195, v198, v199
M v[232:235], a[116:119], a[180:183], v[232:235]
v_cvt_pk_bf16_f32 v200, v200, v201
v_cvt_pk_bf16_f32 v201, v202, v203
M v[236:239], a[124:127], a[180:183], v[236:239]
v_cvt_pk_bf16_f32 v202, v204, v205
v_cvt_pk_bf16_f32 v203, v206, v207
M v[236:239], a[120:123], a[176:179], v[236:239]
s_waitcnt vmcnt(15) lgkmcnt(0)
s_barrier
ds_read_b128 a[160:163], v10 offset:0
ds_read_b128 a[164:167], v11 offset:0
v_cvt_pk_bf16_f32 v208, v208, v209
v_cvt_pk_bf16_f32 v209, v210, v211
M v[240:243], a[128:131], a[176:179], v[240:243]
s_add_u32 s94, s92, 4096
buffer_store_dwordx4 v[88:91], v1, s[16:19], s94 offen offset:3072 sc1
v_cvt_pk_bf16_f32 v210, v212, v213
v_cvt_pk_bf16_f32 v211, v214, v215
M v[240:243], a[132:135], a[180:183], v[240:243]
s_add_u32 m0, s29, 32768
s_nop 0
buffer_load_dwordx4 v2, s[8:11], s23 offen offset:0 lds
v_cvt_pk_bf16_f32 v216, v216, v217
v_cvt_pk_bf16_f32 v217, v218, v219
M v[244:247], a[140:143], a[180:183], v[244:247]
v_cvt_pk_bf16_f32 v218, v220, v221
v_cvt_pk_bf16_f32 v219, v222, v223
M v[244:247], a[136:139], a[176:179], v[244:247]
M v[248:251], a[144:147], a[176:179], v[248:251]
v_accvgpr_write_b32 a224, v192
v_accvgpr_write_b32 a225, v193
v_accvgpr_write_b32 a226, v194
v_accvgpr_write_b32 a227, v195
M v[248:251], a[148:151], a[180:183], v[248:251]
buffer_load_dwordx4 v3, s[8:11], s23 offen offset:1024 lds
v_accvgpr_write_b32 a228, v200
v_accvgpr_write_b32 a229, v201
v_accvgpr_write_b32 a230, v202
v_accvgpr_write_b32 a231, v203
M v[252:255], a[156:159], a[180:183], v[252:255]
v_accvgpr_write_b32 a232, v208
v_accvgpr_write_b32 a233, v209
v_accvgpr_write_b32 a234, v210
v_accvgpr_write_b32 a235, v211
M v[252:255], a[152:155], a[176:179], v[252:255]
v_accvgpr_write_b32 a236, v216
v_accvgpr_write_b32 a237, v217
v_accvgpr_write_b32 a238, v218
v_accvgpr_write_b32 a239, v219
M a[0:3], a[96:99], a[184:187], a[0:3]
M a[0:3], a[100:103], a[188:191], a[0:3]
ds_read_b128 a[168:171], v10 offset:2048
ds_read_b128 a[172:175], v11 offset:2048
M a[4:7], a[108:111], a[188:191], a[4:7]
s_add_u32 s94, s92, 8192
buffer_store_dwordx4 v[96:99], v1, s[16:19], s94 offen offset:0 sc1
M a[4:7], a[104:107], a[184:187], a[4:7]
v_cvt_pk_bf16_f32 v224, v224, v225
v_cvt_pk_bf16_f32 v225, v226, v227
M a[8:11], a[112:115], a[184:187], a[8:11]
v_cvt_pk_bf16_f32 v226, v228, v229
v_cvt_pk_bf16_f32 v227, v230, v231
M a[8:11], a[116:119], a[188:191], a[8:11]
buffer_load_dwordx4 v4, s[8:11], s23 offen offset:2048 lds
v_cvt_pk_bf16_f32 v232, v232, v233
v_cvt_pk_bf16_f32 v233, v234, v235
M a[12:15], a[124:127], a[188:191], a[12:15]
v_cvt_pk_bf16_f32 v234, v236, v237
v_cvt_pk_bf16_f32 v235, v238, v239
M a[12:15], a[120:123], a[184:187], a[12:15]
v_cvt_pk_bf16_f32 v240, v240, v241
v_cvt_pk_bf16_f32 v241, v242, v243
M a[16:19], a[128:131], a[184:187], a[16:19]
v_cvt_pk_bf16_f32 v242, v244, v245
v_cvt_pk_bf16_f32 v243, v246, v247
M a[16:19], a[132:135], a[188:191], a[16:19]
buffer_load_dwordx4 v5, s[8:11], s23 offen offset:3072 lds
v_cvt_pk_bf16_f32 v248, v248, v249
v_cvt_pk_bf16_f32 v249, v250, v251
M a[20:23], a[140:143], a[188:191], a[20:23]
v_cvt_pk_bf16_f32 v250, v252, v253
v_cvt_pk_bf16_f32 v251, v254, v255
M a[20:23], a[136:139], a[184:187], a[20:23]
M a[24:27], a[144:147], a[184:187], a[24:27]
s_add_u32 s94, s92, 8192
buffer_store_dwordx4 v[104:107], v1, s[16:19], s94 offen offset:1024 sc1
v_accvgpr_write_b32 a240, v224
v_accvgpr_write_b32 a241, v225
v_accvgpr_write_b32 a242, v226
v_accvgpr_write_b32 a243, v227
M a[24:27], a[148:151], a[188:191], a[24:27]
v_accvgpr_write_b32 a244, v232
v_accvgpr_write_b32 a245, v233
v_accvgpr_write_b32 a246, v234
v_accvgpr_write_b32 a247, v235
M a[28:31], a[156:159], a[188:191], a[28:31]
v_accvgpr_write_b32 a248, v240
v_accvgpr_write_b32 a249, v241
v_accvgpr_write_b32 a250, v242
v_accvgpr_write_b32 a251, v243
M a[28:31], a[152:155], a[184:187], a[28:31]
s_waitcnt lgkmcnt(2)
v_accvgpr_write_b32 a252, v248
v_accvgpr_write_b32 a253, v249
v_accvgpr_write_b32 a254, v250
v_accvgpr_write_b32 a255, v251
M v[32:35], a[160:163], a[32:35], 0
s_add_u32 m0, s29, 65536
s_nop 0
buffer_load_dwordx4 v6, s[12:15], s24 offen offset:0 lds
M v[32:35], a[164:167], a[36:39], v[32:35]
ds_read_b128 a[176:179], v10 offset:4096
ds_read_b128 a[180:183], v11 offset:4096
M v[36:39], a[164:167], a[44:47], 0
M v[36:39], a[160:163], a[40:43], v[36:39]
ds_read_b64_tr_b16 a[96:97], v12 offset:32768
ds_read_b64_tr_b16 a[98:99], v12 offset:34816
M v[40:43], a[160:163], a[48:51], 0
M v[40:43], a[164:167], a[52:55], v[40:43]
M v[44:47], a[164:167], a[60:63], 0
buffer_load_dwordx4 v7, s[12:15], s24 offen offset:1024 lds
M v[44:47], a[160:163], a[56:59], v[44:47]
ds_read_b64_tr_b16 a[104:105], v13 offset:32768
ds_read_b64_tr_b16 a[106:107], v13 offset:34816
M v[48:51], a[160:163], a[64:67], 0
s_add_u32 s94, s92, 8192
buffer_store_dwordx4 v[112:115], v1, s[16:19], s94 offen offset:2048 sc1
M v[48:51], a[164:167], a[68:71], v[48:51]
M v[52:55], a[164:167], a[76:79], 0
M v[52:55], a[160:163], a[72:75], v[52:55]
ds_read_b64_tr_b16 a[112:113], v14 offset:32768
ds_read_b64_tr_b16 a[114:115], v14 offset:34816
M v[56:59], a[160:163], a[80:83], 0
M v[56:59], a[164:167], a[84:87], v[56:59]
M v[60:63], a[164:167], a[92:95], 0
buffer_load_dwordx4 v8, s[12:15], s24 offen offset:2048 lds
M v[60:63], a[160:163], a[88:91], v[60:63]
s_waitcnt lgkmcnt(8)
ds_read_b64_tr_b16 a[120:121], v15 offset:32768
ds_read_b64_tr_b16 a[122:123], v15 offset:34816
M v[64:67], a[168:171], a[32:35], 0
M v[64:67], a[172:175], a[36:39], v[64:67]
ds_read_b128 a[184:187], v10 offset:6144
ds_read_b128 a[188:191], v11 offset:6144
M v[68:71], a[172:175], a[44:47], 0
s_add_u32 s94, s92, 8192
buffer_store_dwordx4 v[120:123], v1, s[16:19], s94 offen offset:3072 sc1
M v[68:71], a[168:171], a[40:43], v[68:71]
ds_read_b64_tr_b16 a[128:129], v16 offset:32768
ds_read_b64_tr_b16 a[130:131], v16 offset:34816
M v[72:75], a[168:171], a[48:51], 0
v_accvgpr_read_b32 v24, a0
v_accvgpr_read_b32 v25, a1
M v[72:75], a[172:175], a[52:55], v[72:75]
v_accvgpr_read_b32 v26, a2
v_accvgpr_read_b32 v27, a3
M v[76:79], a[172:175], a[60:63], 0
v_accvgpr_read_b32 v28, a4
v_accvgpr_read_b32 v29, a5
M v[76:79], a[168:171], a[56:59], v[76:79]
ds_read_b64_tr_b16 a[136:137], v17 offset:32768
ds_read_b64_tr_b16 a[138:139], v17 offset:34816
v_accvgpr_read_b32 v30, a6
v_accvgpr_read_b32 v31, a7
M v[80:83], a[168:171], a[64:67], 0
buffer_load_dwordx4 v9, s[12:15], s24 offen offset:3072 lds
v_cvt_pk_bf16_f32 v24, v24, v25
v_cvt_pk_bf16_f32 v25, v26, v27
M v[80:83], a[172:175], a[68:71], v[80:83]
v_cvt_pk_bf16_f32 v26, v28, v29
v_cvt_pk_bf16_f32 v27, v30, v31
M v[84:87], a[172:175], a[76:79], 0
M v[84:87], a[168:171], a[72:75], v[84:87]
ds_read_b64_tr_b16 a[144:145], v18 offset:32768
ds_read_b64_tr_b16 a[146:147], v18 offset:34816
M v[88:91], a[168:171], a[80:83], 0
M v[88:91], a[172:175], a[84:87], v[88:91]
s_add_u32 s94, s93, 12288
buffer_store_dwordx4 v[24:27], v1, s[16:19], s94 offen offset:0 sc1
M v[92:95], a[172:175], a[92:95], 0
M v[92:95], a[168:171], a[88:91], v[92:95]
s_waitcnt lgkmcnt(15)
ds_read_b64_tr_b16 a[152:153], v19 offset:32768
ds_read_b64_tr_b16 a[154:155], v19 offset:34816
M v[96:99], a[176:179], a[32:35], 0
s_add_u32 s24, s24, 262144
M v[96:99], a[180:183], a[36:39], v[96:99]
M v[100:103], a[180:183], a[44:47], 0
M v[100:103], a[176:179], a[40:43], v[100:103]
M v[104:107], a[176:179], a[48:51], 0
M v[104:107], a[180:183], a[52:55], v[104:107]
M v[108:111], a[180:183], a[60:63], 0
M v[108:111], a[176:179], a[56:59], v[108:111]
s_waitcnt vmcnt(15) lgkmcnt(0)
s_barrier
ds_read_b128 a[160:163], v10 offset:16384
ds_read_b128 a[164:167], v11 offset:16384
M v[112:115], a[176:179], a[64:67], 0
s_add_u32 m0, s29, 49152
s_add_u32 s3, s23, s31
buffer_load_dwordx4 v2, s[8:11], s3 offen offset:0 lds
M v[112:115], a[180:183], a[68:71], v[112:115]
M v[116:119], a[180:183], a[76:79], 0
M v[116:119], a[176:179], a[72:75], v[116:119]
ds_read_b64_tr_b16 a[100:101], v12 offset:49152
ds_read_b64_tr_b16 a[102:103], v12 offset:51200
M v[120:123], a[176:179], a[80:83], 0
v_accvgpr_read_b32 v24, a8
v_accvgpr_read_b32 v25, a9
M v[120:123], a[180:183], a[84:87], v[120:123]
buffer_load_dwordx4 v3, s[8:11], s3 offen offset:1024 lds
v_accvgpr_read_b32 v26, a10
v_accvgpr_read_b32 v27, a11
M v[124:127], a[180:183], a[92:95], 0
v_accvgpr_read_b32 v28, a12
v_accvgpr_read_b32 v29, a13
M v[124:127], a[176:179], a[88:91], v[124:127]
v_accvgpr_read_b32 v30, a14
v_accvgpr_read_b32 v31, a15
M v[128:131], a[184:187], a[32:35], 0
v_cvt_pk_bf16_f32 v24, v24, v25
v_cvt_pk_bf16_f32 v25, v26, v27
M v[128:131], a[188:191], a[36:39], v[128:131]
ds_read_b128 a[168:171], v10 offset:18432
ds_read_b128 a[172:175], v11 offset:18432
ds_read_b64_tr_b16 a[108:109], v13 offset:49152
ds_read_b64_tr_b16 a[110:111], v13 offset:51200
v_cvt_pk_bf16_f32 v26, v28, v29
v_cvt_pk_bf16_f32 v27, v30, v31
M v[132:135], a[188:191], a[44:47], 0
M v[132:135], a[184:187], a[40:43], v[132:135]
M v[136:139], a[184:187], a[48:51], 0
buffer_load_dwordx4 v4, s[8:11], s3 offen offset:2048 lds
M v[136:139], a[188:191], a[52:55], v[136:139]
s_add_u32 s94, s93, 12288
buffer_store_dwordx4 v[24:27], v1, s[16:19], s94 offen offset:1024 sc1
M v[140:143], a[188:191], a[60:63], 0
M v[140:143], a[184:187], a[56:59], v[140:143]
ds_read_b64_tr_b16 a[116:117], v14 offset:49152
ds_read_b64_tr_b16 a[118:119], v14 offset:51200
M v[144:147], a[184:187], a[64:67], 0
M v[144:147], a[188:191], a[68:71], v[144:147]
M v[148:151], a[188:191], a[76:79], 0
buffer_load_dwordx4 v5, s[8:11], s3 offen offset:3072 lds
M v[148:151], a[184:187], a[72:75], v[148:151]
M v[152:155], a[184:187], a[80:83], 0
M v[152:155], a[188:191], a[84:87], v[152:155]
ds_read_b64_tr_b16 a[124:125], v15 offset:49152
ds_read_b64_tr_b16 a[126:127], v15 offset:51200
M v[156:159], a[188:191], a[92:95], 0
M v[156:159], a[184:187], a[88:91], v[156:159]
s_waitcnt lgkmcnt(10)
M v[160:163], a[160:163], a[32:35], 0
M v[160:163], a[164:167], a[36:39], v[160:163]
ds_read_b128 a[176:179], v10 offset:20480
ds_read_b128 a[180:183], v11 offset:20480
M v[164:167], a[164:167], a[44:47], 0
s_add_u32 s23, s23, 128
s_cmp_eq_u32 s23, s25
s_cselect_b32 s23, s26, s23
M v[164:167], a[160:163], a[40:43], v[164:167]
ds_read_b64_tr_b16 a[132:133], v16 offset:49152
ds_read_b64_tr_b16 a[134:135], v16 offset:51200
M v[168:171], a[160:163], a[48:51], 0
v_accvgpr_read_b32 v24, a16
v_accvgpr_read_b32 v25, a17
M v[168:171], a[164:167], a[52:55], v[168:171]
v_accvgpr_read_b32 v26, a18
v_accvgpr_read_b32 v27, a19
M v[172:175], a[164:167], a[60:63], 0
v_accvgpr_read_b32 v28, a20
v_accvgpr_read_b32 v29, a21
M v[172:175], a[160:163], a[56:59], v[172:175]
v_accvgpr_read_b32 v30, a22
v_accvgpr_read_b32 v31, a23
M v[176:179], a[160:163], a[64:67], 0
s_add_u32 m0, s29, 81920
s_nop 0
buffer_load_dwordx4 v6, s[12:15], s24 offen offset:0 lds
v_cvt_pk_bf16_f32 v24, v24, v25
v_cvt_pk_bf16_f32 v25, v26, v27
M v[176:179], a[164:167], a[68:71], v[176:179]
ds_read_b64_tr_b16 a[140:141], v17 offset:49152
ds_read_b64_tr_b16 a[142:143], v17 offset:51200
v_cvt_pk_bf16_f32 v26, v28, v29
v_cvt_pk_bf16_f32 v27, v30, v31
M v[180:183], a[164:167], a[76:79], 0
M v[180:183], a[160:163], a[72:75], v[180:183]
M v[184:187], a[160:163], a[80:83], 0
M v[184:187], a[164:167], a[84:87], v[184:187]
s_add_u32 s94, s93, 12288
buffer_store_dwordx4 v[24:27], v1, s[16:19], s94 offen offset:2048 sc1
M v[188:191], a[164:167], a[92:95], 0
buffer_load_dwordx4 v7, s[12:15], s24 offen offset:1024 lds
M v[188:191], a[160:163], a[88:91], v[188:191]
s_waitcnt lgkmcnt(12)
ds_read_b64_tr_b16 a[148:149], v18 offset:49152
ds_read_b64_tr_b16 a[150:151], v18 offset:51200
M v[192:195], a[168:171], a[32:35], 0
M v[192:195], a[172:175], a[36:39], v[192:195]
ds_read_b128 a[184:187], v10 offset:22528
ds_read_b128 a[188:191], v11 offset:22528
M v[196:199], a[172:175], a[44:47], 0
M v[196:199], a[168:171], a[40:43], v[196:199]
M v[200:203], a[168:171], a[48:51], 0
M v[200:203], a[172:175], a[52:55], v[200:203]
ds_read_b64_tr_b16 a[156:157], v19 offset:49152
ds_read_b64_tr_b16 a[158:159], v19 offset:51200
M v[204:207], a[172:175], a[60:63], 0
buffer_load_dwordx4 v8, s[12:15], s24 offen offset:2048 lds
M v[204:207], a[168:171], a[56:59], v[204:207]
M v[208:211], a[168:171], a[64:67], 0
M v[208:211], a[172:175], a[68:71], v[208:211]
M v[212:215], a[172:175], a[76:79], 0
buffer_load_dwordx4 v9, s[12:15], s24 offen offset:3072 lds
M v[212:215], a[168:171], a[72:75], v[212:215]
M v[216:219], a[168:171], a[80:83], 0
v_accvgpr_read_b32 v24, a24
v_accvgpr_read_b32 v25, a25
M v[216:219], a[172:175], a[84:87], v[216:219]
v_accvgpr_read_b32 v26, a26
v_accvgpr_read_b32 v27, a27
M v[220:223], a[172:175], a[92:95], 0
v_accvgpr_read_b32 v28, a28
v_accvgpr_read_b32 v29, a29
M v[220:223], a[168:171], a[88:91], v[220:223]
s_waitcnt lgkmcnt(10)
v_accvgpr_read_b32 v30, a30
v_accvgpr_read_b32 v31, a31
M v[224:227], a[176:179], a[32:35], 0
s_add_u32 s24, s24, 262144
s_cmp_eq_u32 s24, s27
s_cselect_b32 s24, s28, s24
s_sub_u32 s6, s6, 1
s_cmp_eq_u32 s6, 0
s_cselect_b64 s[12:13], s[64:65], s[12:13]
v_cvt_pk_bf16_f32 v24, v24, v25
v_cvt_pk_bf16_f32 v25, v26, v27
M v[224:227], a[180:183], a[36:39], v[224:227]
v_cvt_pk_bf16_f32 v26, v28, v29
v_cvt_pk_bf16_f32 v27, v30, v31
M v[228:231], a[180:183], a[44:47], 0
M v[228:231], a[176:179], a[40:43], v[228:231]
M v[232:235], a[176:179], a[48:51], 0
M v[232:235], a[180:183], a[52:55], v[232:235]
s_add_u32 s94, s93, 12288
buffer_store_dwordx4 v[24:27], v1, s[16:19], s94 offen offset:3072 sc1
M v[236:239], a[180:183], a[60:63], 0
M v[236:239], a[176:179], a[56:59], v[236:239]
s_waitcnt vmcnt(12) lgkmcnt(0)
s_barrier
ds_read_b128 a[160:163], v10 offset:32768
ds_read_b128 a[164:167], v11 offset:32768
M v[240:243], a[176:179], a[64:67], 0
s_add_u32 m0, s29, 0
s_nop 0
buffer_load_dwordx4 v2, s[8:11], s23 offen offset:0 lds
M v[240:243], a[180:183], a[68:71], v[240:243]
M v[244:247], a[180:183], a[76:79], 0
M v[244:247], a[176:179], a[72:75], v[244:247]
M v[248:251], a[176:179], a[80:83], 0
M v[248:251], a[180:183], a[84:87], v[248:251]
buffer_load_dwordx4 v3, s[8:11], s23 offen offset:1024 lds
M v[252:255], a[180:183], a[92:95], 0
M v[252:255], a[176:179], a[88:91], v[252:255]
M a[0:3], a[184:187], a[32:35], 0
M a[0:3], a[188:191], a[36:39], a[0:3]
ds_read_b128 a[168:171], v10 offset:34816
ds_read_b128 a[172:175], v11 offset:34816
M a[4:7], a[188:191], a[44:47], 0
M a[4:7], a[184:187], a[40:43], a[4:7]
M a[8:11], a[184:187], a[48:51], 0
buffer_load_dwordx4 v4, s[8:11], s23 offen offset:2048 lds
M a[8:11], a[188:191], a[52:55], a[8:11]
M a[12:15], a[188:191], a[60:63], 0
M a[12:15], a[184:187], a[56:59], a[12:15]
M a[16:19], a[184:187], a[64:67], 0
M a[16:19], a[188:191], a[68:71], a[16:19]
buffer_load_dwordx4 v5, s[8:11], s23 offen offset:3072 lds
M a[20:23], a[188:191], a[76:79], 0
M a[20:23], a[184:187], a[72:75], a[20:23]
M a[24:27], a[184:187], a[80:83], 0
M a[24:27], a[188:191], a[84:87], a[24:27]
M a[28:31], a[188:191], a[92:95], 0
M a[28:31], a[184:187], a[88:91], a[28:31]
s_waitcnt lgkmcnt(2)
M v[32:35], a[160:163], a[96:99], v[32:35]
s_add_u32 m0, s29, 98304
s_nop 0
buffer_load_dwordx4 v6, s[12:15], s24 offen offset:0 lds
M v[32:35], a[164:167], a[100:103], v[32:35]
ds_read_b128 a[176:179], v10 offset:36864
ds_read_b128 a[180:183], v11 offset:36864
M v[36:39], a[164:167], a[108:111], v[36:39]
M v[36:39], a[160:163], a[104:107], v[36:39]
ds_read_b64_tr_b16 a[32:33], v12 offset:0
ds_read_b64_tr_b16 a[34:35], v12 offset:2048
M v[40:43], a[160:163], a[112:115], v[40:43]
M v[40:43], a[164:167], a[116:119], v[40:43]
M v[44:47], a[164:167], a[124:127], v[44:47]
M v[44:47], a[160:163], a[120:123], v[44:47]
ds_read_b64_tr_b16 a[40:41], v13 offset:0
ds_read_b64_tr_b16 a[42:43], v13 offset:2048
M v[48:51], a[160:163], a[128:131], v[48:51]
s_add_u32 s94, s92, 12288
buffer_store_dwordx4 a[192:195], v1, s[16:19], s94 offen offset:0 sc1
M v[48:51], a[164:167], a[132:135], v[48:51]
buffer_load_dwordx4 v7, s[12:15], s24 offen offset:1024 lds
M v[52:55], a[164:167], a[140:143], v[52:55]
M v[52:55], a[160:163], a[136:139], v[52:55]
ds_read_b64_tr_b16 a[48:49], v14 offset:0
ds_read_b64_tr_b16 a[50:51], v14 offset:2048
M v[56:59], a[160:163], a[144:147], v[56:59]
M v[56:59], a[164:167], a[148:151], v[56:59]
M v[60:63], a[164:167], a[156:159], v[60:63]
M v[60:63], a[160:163], a[152:155], v[60:63]
s_waitcnt lgkmcnt(8)
ds_read_b64_tr_b16 a[56:57], v15 offset:0
ds_read_b64_tr_b16 a[58:59], v15 offset:2048
M v[64:67], a[168:171], a[96:99], v[64:67]
buffer_load_dwordx4 v8, s[12:15], s24 offen offset:2048 lds
M v[64:67], a[172:175], a[100:103], v[64:67]
ds_read_b128 a[184:187], v10 offset:38912
ds_read_b128 a[188:191], v11 offset:38912
M v[68:71], a[172:175], a[108:111], v[68:71]
M v[68:71], a[168:171], a[104:107], v[68:71]
ds_read_b64_tr_b16 a[64:65], v16 offset:0
ds_read_b64_tr_b16 a[66:67], v16 offset:2048
M v[72:75], a[168:171], a[112:115], v[72:75]
M v[72:75], a[172:175], a[116:119], v[72:75]
M v[76:79], a[172:175], a[124:127], v[76:79]
M v[76:79], a[168:171], a[120:123], v[76:79]
ds_read_b64_tr_b16 a[72:73], v17 offset:0
ds_read_b64_tr_b16 a[74:75], v17 offset:2048
M v[80:83], a[168:171], a[128:131], v[80:83]
buffer_load_dwordx4 v9, s[12:15], s24 offen offset:3072 lds
M v[80:83], a[172:175], a[132:135], v[80:83]
M v[84:87], a[172:175], a[140:143], v[84:87]
M v[84:87], a[168:171], a[136:139], v[84:87]
ds_read_b64_tr_b16 a[80:81], v18 offset:0
ds_read_b64_tr_b16 a[82:83], v18 offset:2048
M v[88:91], a[168:171], a[144:147], v[88:91]
M v[88:91], a[172:175], a[148:151], v[88:91]
M v[92:95], a[172:175], a[156:159], v[92:95]
s_add_u32 s24, s24, 262144
M v[92:95], a[168:171], a[152:155], v[92:95]
s_waitcnt lgkmcnt(15)
ds_read_b64_tr_b16 a[88:89], v19 offset:0
ds_read_b64_tr_b16 a[90:91], v19 offset:2048
M v[96:99], a[176:179], a[96:99], v[96:99]
M v[96:99], a[180:183], a[100:103], v[96:99]
M v[100:103], a[180:183], a[108:111], v[100:103]
M v[100:103], a[176:179], a[104:107], v[100:103]
M v[104:107], a[176:179], a[112:115], v[104:107]
s_add_u32 s94, s92, 12288
buffer_store_dwordx4 a[196:199], v1, s[16:19], s94 offen offset:1024 sc1
M v[104:107], a[180:183], a[116:119], v[104:107]
M v[108:111], a[180:183], a[124:127], v[108:111]
M v[108:111], a[176:179], a[120:123], v[108:111]
s_waitcnt vmcnt(11) lgkmcnt(0)
s_barrier
ds_read_b128 a[160:163], v10 offset:49152
ds_read_b128 a[164:167], v11 offset:49152
M v[112:115], a[176:179], a[128:131], v[112:115]
s_add_u32 m0, s29, 16384
s_add_u32 s3, s23, s31
buffer_load_dwordx4 v2, s[8:11], s3 offen offset:0 lds
M v[112:115], a[180:183], a[132:135], v[112:115]
M v[116:119], a[180:183], a[140:143], v[116:119]
M v[116:119], a[176:179], a[136:139], v[116:119]
ds_read_b64_tr_b16 a[36:37], v12 offset:16384
ds_read_b64_tr_b16 a[38:39], v12 offset:18432
M v[120:123], a[176:179], a[144:147], v[120:123]
M v[120:123], a[180:183], a[148:151], v[120:123]
buffer_load_dwordx4 v3, s[8:11], s3 offen offset:1024 lds
M v[124:127], a[180:183], a[156:159], v[124:127]
M v[124:127], a[176:179], a[152:155], v[124:127]
M v[128:131], a[184:187], a[96:99], v[128:131]
M v[128:131], a[188:191], a[100:103], v[128:131]
ds_read_b128 a[168:171], v10 offset:51200
ds_read_b128 a[172:175], v11 offset:51200
ds_read_b64_tr_b16 a[44:45], v13 offset:16384
ds_read_b64_tr_b16 a[46:47], v13 offset:18432
M v[132:135], a[188:191], a[108:111], v[132:135]
M v[132:135], a[184:187], a[104:107], v[132:135]
M v[136:139], a[184:187], a[112:115], v[136:139]
buffer_load_dwordx4 v4, s[8:11], s3 offen offset:2048 lds
M v[136:139], a[188:191], a[116:119], v[136:139]
M v[140:143], a[188:191], a[124:127], v[140:143]
M v[140:143], a[184:187], a[120:123], v[140:143]
ds_read_b64_tr_b16 a[52:53], v14 offset:16384
ds_read_b64_tr_b16 a[54:55], v14 offset:18432
M v[144:147], a[184:187], a[128:131], v[144:147]
M v[144:147], a[188:191], a[132:135], v[144:147]
buffer_load_dwordx4 v5, s[8:11], s3 offen offset:3072 lds
M v[148:151], a[188:191], a[140:143], v[148:151]
M v[148:151], a[184:187], a[136:139], v[148:151]
M v[152:155], a[184:187], a[144:147], v[152:155]
M v[152:155], a[188:191], a[148:151], v[152:155]
ds_read_b64_tr_b16 a[60:61], v15 offset:16384
ds_read_b64_tr_b16 a[62:63], v15 offset:18432
M v[156:159], a[188:191], a[156:159], v[156:159]
M v[156:159], a[184:187], a[152:155], v[156:159]
s_waitcnt lgkmcnt(10)
M v[160:163], a[160:163], a[96:99], v[160:163]
s_add_u32 s94, s92, 12288
buffer_store_dwordx4 a[200:203], v1, s[16:19], s94 offen offset:2048 sc1
M v[160:163], a[164:167], a[100:103], v[160:163]
ds_read_b128 a[176:179], v10 offset:53248
ds_read_b128 a[180:183], v11 offset:53248
M v[164:167], a[164:167], a[108:111], v[164:167]
s_add_u32 s23, s23, 128
s_cmp_eq_u32 s23, s25
s_cselect_b32 s23, s26, s23
M v[164:167], a[160:163], a[104:107], v[164:167]
ds_read_b64_tr_b16 a[68:69], v16 offset:16384
ds_read_b64_tr_b16 a[70:71], v16 offset:18432
M v[168:171], a[160:163], a[112:115], v[168:171]
M v[168:171], a[164:167], a[116:119], v[168:171]
M v[172:175], a[164:167], a[124:127], v[172:175]
M v[172:175], a[160:163], a[120:123], v[172:175]
M v[176:179], a[160:163], a[128:131], v[176:179]
s_add_u32 m0, s29, 114688
s_nop 0
buffer_load_dwordx4 v6, s[12:15], s24 offen offset:0 lds
M v[176:179], a[164:167], a[132:135], v[176:179]
ds_read_b64_tr_b16 a[76:77], v17 offset:16384
ds_read_b64_tr_b16 a[78:79], v17 offset:18432
M v[180:183], a[164:167], a[140:143], v[180:183]
M v[180:183], a[160:163], a[136:139], v[180:183]
M v[184:187], a[160:163], a[144:147], v[184:187]
M v[184:187], a[164:167], a[148:151], v[184:187]
buffer_load_dwordx4 v7, s[12:15], s24 offen offset:1024 lds
M v[188:191], a[164:167], a[156:159], v[188:191]
M v[188:191], a[160:163], a[152:155], v[188:191]
s_waitcnt lgkmcnt(12)
ds_read_b64_tr_b16 a[84:85], v18 offset:16384
ds_read_b64_tr_b16 a[86:87], v18 offset:18432
M v[192:195], a[168:171], a[96:99], v[192:195]
M v[192:195], a[172:175], a[100:103], v[192:195]
ds_read_b128 a[184:187], v10 offset:55296
ds_read_b128 a[188:191], v11 offset:55296
M v[196:199], a[172:175], a[108:111], v[196:199]
M v[196:199], a[168:171], a[104:107], v[196:199]
M v[200:203], a[168:171], a[112:115], v[200:203]
buffer_load_dwordx4 v8, s[12:15], s24 offen offset:2048 lds
M v[200:203], a[172:175], a[116:119], v[200:203]
ds_read_b64_tr_b16 a[92:93], v19 offset:16384
ds_read_b64_tr_b16 a[94:95], v19 offset:18432
M v[204:207], a[172:175], a[124:127], v[204:207]
M v[204:207], a[168:171], a[120:123], v[204:207]
M v[208:211], a[168:171], a[128:131], v[208:211]
M v[208:211], a[172:175], a[132:135], v[208:211]
buffer_load_dwordx4 v9, s[12:15], s24 offen offset:3072 lds
M v[212:215], a[172:175], a[140:143], v[212:215]
M v[212:215], a[168:171], a[136:139], v[212:215]
M v[216:219], a[168:171], a[144:147], v[216:219]
s_add_u32 s94, s92, 12288
buffer_store_dwordx4 a[204:207], v1, s[16:19], s94 offen offset:3072 sc1
M v[216:219], a[172:175], a[148:151], v[216:219]
M v[220:223], a[172:175], a[156:159], v[220:223]
M v[220:223], a[168:171], a[152:155], v[220:223]
s_waitcnt lgkmcnt(10)
M v[224:227], a[176:179], a[96:99], v[224:227]
s_add_u32 s24, s24, 262144
s_cmp_eq_u32 s24, s27
s_cselect_b32 s24, s28, s24
s_sub_u32 s6, s6, 1
s_cmp_eq_u32 s6, 0
s_cselect_b64 s[12:13], s[64:65], s[12:13]
M v[224:227], a[180:183], a[100:103], v[224:227]
M v[228:231], a[180:183], a[108:111], v[228:231]
M v[228:231], a[176:179], a[104:107], v[228:231]
M v[232:235], a[176:179], a[112:115], v[232:235]
M v[232:235], a[180:183], a[116:119], v[232:235]
M v[236:239], a[180:183], a[124:127], v[236:239]
M v[236:239], a[176:179], a[120:123], v[236:239]
s_waitcnt vmcnt(11) lgkmcnt(0)
s_barrier
ds_read_b128 a[160:163], v10 offset:0
ds_read_b128 a[164:167], v11 offset:0
M v[240:243], a[176:179], a[128:131], v[240:243]
s_add_u32 m0, s29, 32768
s_nop 0
buffer_load_dwordx4 v2, s[8:11], s23 offen offset:0 lds
M v[240:243], a[180:183], a[132:135], v[240:243]
M v[244:247], a[180:183], a[140:143], v[244:247]
M v[244:247], a[176:179], a[136:139], v[244:247]
M v[248:251], a[176:179], a[144:147], v[248:251]
M v[248:251], a[180:183], a[148:151], v[248:251]
buffer_load_dwordx4 v3, s[8:11], s23 offen offset:1024 lds
M v[252:255], a[180:183], a[156:159], v[252:255]
M v[252:255], a[176:179], a[152:155], v[252:255]
M a[0:3], a[184:187], a[96:99], a[0:3]
M a[0:3], a[188:191], a[100:103], a[0:3]
ds_read_b128 a[168:171], v10 offset:2048
ds_read_b128 a[172:175], v11 offset:2048
M a[4:7], a[188:191], a[108:111], a[4:7]
M a[4:7], a[184:187], a[104:107], a[4:7]
M a[8:11], a[184:187], a[112:115], a[8:11]
buffer_load_dwordx4 v4, s[8:11], s23 offen offset:2048 lds
M a[8:11], a[188:191], a[116:119], a[8:11]
M a[12:15], a[188:191], a[124:127], a[12:15]
M a[12:15], a[184:187], a[120:123], a[12:15]
M a[16:19], a[184:187], a[128:131], a[16:19]
M a[16:19], a[188:191], a[132:135], a[16:19]
buffer_load_dwordx4 v5, s[8:11], s23 offen offset:3072 lds
M a[20:23], a[188:191], a[140:143], a[20:23]
M a[20:23], a[184:187], a[136:139], a[20:23]
M a[24:27], a[184:187], a[144:147], a[24:27]
M a[24:27], a[188:191], a[148:151], a[24:27]
M a[28:31], a[188:191], a[156:159], a[28:31]
M a[28:31], a[184:187], a[152:155], a[28:31]
s_waitcnt lgkmcnt(2)
M v[32:35], a[160:163], a[32:35], v[32:35]
s_add_u32 m0, s29, 65536
s_nop 0
buffer_load_dwordx4 v6, s[12:15], s24 offen offset:0 lds
M v[32:35], a[164:167], a[36:39], v[32:35]
ds_read_b128 a[176:179], v10 offset:4096
ds_read_b128 a[180:183], v11 offset:4096
M v[36:39], a[164:167], a[44:47], v[36:39]
M v[36:39], a[160:163], a[40:43], v[36:39]
ds_read_b64_tr_b16 a[96:97], v12 offset:32768
ds_read_b64_tr_b16 a[98:99], v12 offset:34816
M v[40:43], a[160:163], a[48:51], v[40:43]
M v[40:43], a[164:167], a[52:55], v[40:43]
M v[44:47], a[164:167], a[60:63], v[44:47]
M v[44:47], a[160:163], a[56:59], v[44:47]
ds_read_b64_tr_b16 a[104:105], v13 offset:32768
ds_read_b64_tr_b16 a[106:107], v13 offset:34816
M v[48:51], a[160:163], a[64:67], v[48:51]
s_add_u32 s94, s93, 0
buffer_store_dwordx4 a[208:211], v1, s[16:19], s94 offen offset:0 sc1
M v[48:51], a[164:167], a[68:71], v[48:51]
buffer_load_dwordx4 v7, s[12:15], s24 offen offset:1024 lds
M v[52:55], a[164:167], a[76:79], v[52:55]
M v[52:55], a[160:163], a[72:75], v[52:55]
ds_read_b64_tr_b16 a[112:113], v14 offset:32768
ds_read_b64_tr_b16 a[114:115], v14 offset:34816
M v[56:59], a[160:163], a[80:83], v[56:59]
M v[56:59], a[164:167], a[84:87], v[56:59]
M v[60:63], a[164:167], a[92:95], v[60:63]
M v[60:63], a[160:163], a[88:91], v[60:63]
s_waitcnt lgkmcnt(8)
ds_read_b64_tr_b16 a[120:121], v15 offset:32768
ds_read_b64_tr_b16 a[122:123], v15 offset:34816
M v[64:67], a[168:171], a[32:35], v[64:67]
buffer_load_dwordx4 v8, s[12:15], s24 offen offset:2048 lds
M v[64:67], a[172:175], a[36:39], v[64:67]
ds_read_b128 a[184:187], v10 offset:6144
ds_read_b128 a[188:191], v11 offset:6144
M v[68:71], a[172:175], a[44:47], v[68:71]
M v[68:71], a[168:171], a[40:43], v[68:71]
ds_read_b64_tr_b16 a[128:129], v16 offset:32768
ds_read_b64_tr_b16 a[130:131], v16 offset:34816
M v[72:75], a[168:171], a[48:51], v[72:75]
M v[72:75], a[172:175], a[52:55], v[72:75]
M v[76:79], a[172:175], a[60:63], v[76:79]
M v[76:79], a[168:171], a[56:59], v[76:79]
ds_read_b64_tr_b16 a[136:137], v17 offset:32768
ds_read_b64_tr_b16 a[138:139], v17 offset:34816
M v[80:83], a[168:171], a[64:67], v[80:83]
buffer_load_dwordx4 v9, s[12:15], s24 offen offset:3072 lds
M v[80:83], a[172:175], a[68:71], v[80:83]
M v[84:87], a[172:175], a[76:79], v[84:87]
M v[84:87], a[168:171], a[72:75], v[84:87]
ds_read_b64_tr_b16 a[144:145], v18 offset:32768
ds_read_b64_tr_b16 a[146:147], v18 offset:34816
M v[88:91], a[168:171], a[80:83], v[88:91]
M v[88:91], a[172:175], a[84:87], v[88:91]
M v[92:95], a[172:175], a[92:95], v[92:95]
s_add_u32 s24, s24, 262144
M v[92:95], a[168:171], a[88:91], v[92:95]
s_waitcnt lgkmcnt(15)
ds_read_b64_tr_b16 a[152:153], v19 offset:32768
ds_read_b64_tr_b16 a[154:155], v19 offset:34816
M v[96:99], a[176:179], a[32:35], v[96:99]
M v[96:99], a[180:183], a[36:39], v[96:99]
M v[100:103], a[180:183], a[44:47], v[100:103]
M v[100:103], a[176:179], a[40:43], v[100:103]
M v[104:107], a[176:179], a[48:51], v[104:107]
s_add_u32 s94, s93, 0
buffer_store_dwordx4 a[212:215], v1, s[16:19], s94 offen offset:1024 sc1
M v[104:107], a[180:183], a[52:55], v[104:107]
M v[108:111], a[180:183], a[60:63], v[108:111]
M v[108:111], a[176:179], a[56:59], v[108:111]
s_waitcnt vmcnt(11) lgkmcnt(0)
s_barrier
ds_read_b128 a[160:163], v10 offset:16384
ds_read_b128 a[164:167], v11 offset:16384
M v[112:115], a[176:179], a[64:67], v[112:115]
s_add_u32 m0, s29, 49152
s_add_u32 s3, s23, s31
buffer_load_dwordx4 v2, s[8:11], s3 offen offset:0 lds
M v[112:115], a[180:183], a[68:71], v[112:115]
M v[116:119], a[180:183], a[76:79], v[116:119]
M v[116:119], a[176:179], a[72:75], v[116:119]
ds_read_b64_tr_b16 a[100:101], v12 offset:49152
ds_read_b64_tr_b16 a[102:103], v12 offset:51200
M v[120:123], a[176:179], a[80:83], v[120:123]
M v[120:123], a[180:183], a[84:87], v[120:123]
buffer_load_dwordx4 v3, s[8:11], s3 offen offset:1024 lds
M v[124:127], a[180:183], a[92:95], v[124:127]
M v[124:127], a[176:179], a[88:91], v[124:127]
M v[128:131], a[184:187], a[32:35], v[128:131]
M v[128:131], a[188:191], a[36:39], v[128:131]
ds_read_b128 a[168:171], v10 offset:18432
ds_read_b128 a[172:175], v11 offset:18432
ds_read_b64_tr_b16 a[108:109], v13 offset:49152
ds_read_b64_tr_b16 a[110:111], v13 offset:51200
M v[132:135], a[188:191], a[44:47], v[132:135]
M v[132:135], a[184:187], a[40:43], v[132:135]
M v[136:139], a[184:187], a[48:51], v[136:139]
buffer_load_dwordx4 v4, s[8:11], s3 offen offset:2048 lds
M v[136:139], a[188:191], a[52:55], v[136:139]
M v[140:143], a[188:191], a[60:63], v[140:143]
M v[140:143], a[184:187], a[56:59], v[140:143]
ds_read_b64_tr_b16 a[116:117], v14 offset:49152
ds_read_b64_tr_b16 a[118:119], v14 offset:51200
M v[144:147], a[184:187], a[64:67], v[144:147]
M v[144:147], a[188:191], a[68:71], v[144:147]
buffer_load_dwordx4 v5, s[8:11], s3 offen offset:3072 lds
M v[148:151], a[188:191], a[76:79], v[148:151]
M v[148:151], a[184:187], a[72:75], v[148:151]
M v[152:155], a[184:187], a[80:83], v[152:155]
M v[152:155], a[188:191], a[84:87], v[152:155]
ds_read_b64_tr_b16 a[124:125], v15 offset:49152
ds_read_b64_tr_b16 a[126:127], v15 offset:51200
M v[156:159], a[188:191], a[92:95], v[156:159]
M v[156:159], a[184:187], a[88:91], v[156:159]
s_waitcnt lgkmcnt(10)
M v[160:163], a[160:163], a[32:35], v[160:163]
s_add_u32 s94, s93, 0
buffer_store_dwordx4 a[216:219], v1, s[16:19], s94 offen offset:2048 sc1
M v[160:163], a[164:167], a[36:39], v[160:163]
ds_read_b128 a[176:179], v10 offset:20480
ds_read_b128 a[180:183], v11 offset:20480
M v[164:167], a[164:167], a[44:47], v[164:167]
s_add_u32 s23, s23, 128
s_cmp_eq_u32 s23, s25
s_cselect_b32 s23, s26, s23
M v[164:167], a[160:163], a[40:43], v[164:167]
ds_read_b64_tr_b16 a[132:133], v16 offset:49152
ds_read_b64_tr_b16 a[134:135], v16 offset:51200
M v[168:171], a[160:163], a[48:51], v[168:171]
M v[168:171], a[164:167], a[52:55], v[168:171]
M v[172:175], a[164:167], a[60:63], v[172:175]
M v[172:175], a[160:163], a[56:59], v[172:175]
M v[176:179], a[160:163], a[64:67], v[176:179]
s_add_u32 m0, s29, 81920
s_nop 0
buffer_load_dwordx4 v6, s[12:15], s24 offen offset:0 lds
M v[176:179], a[164:167], a[68:71], v[176:179]
ds_read_b64_tr_b16 a[140:141], v17 offset:49152
ds_read_b64_tr_b16 a[142:143], v17 offset:51200
M v[180:183], a[164:167], a[76:79], v[180:183]
M v[180:183], a[160:163], a[72:75], v[180:183]
M v[184:187], a[160:163], a[80:83], v[184:187]
M v[184:187], a[164:167], a[84:87], v[184:187]
buffer_load_dwordx4 v7, s[12:15], s24 offen offset:1024 lds
M v[188:191], a[164:167], a[92:95], v[188:191]
M v[188:191], a[160:163], a[88:91], v[188:191]
s_waitcnt lgkmcnt(12)
ds_read_b64_tr_b16 a[148:149], v18 offset:49152
ds_read_b64_tr_b16 a[150:151], v18 offset:51200
M v[192:195], a[168:171], a[32:35], v[192:195]
M v[192:195], a[172:175], a[36:39], v[192:195]
ds_read_b128 a[184:187], v10 offset:22528
ds_read_b128 a[188:191], v11 offset:22528
M v[196:199], a[172:175], a[44:47], v[196:199]
M v[196:199], a[168:171], a[40:43], v[196:199]
M v[200:203], a[168:171], a[48:51], v[200:203]
buffer_load_dwordx4 v8, s[12:15], s24 offen offset:2048 lds
M v[200:203], a[172:175], a[52:55], v[200:203]
ds_read_b64_tr_b16 a[156:157], v19 offset:49152
ds_read_b64_tr_b16 a[158:159], v19 offset:51200
M v[204:207], a[172:175], a[60:63], v[204:207]
M v[204:207], a[168:171], a[56:59], v[204:207]
M v[208:211], a[168:171], a[64:67], v[208:211]
M v[208:211], a[172:175], a[68:71], v[208:211]
buffer_load_dwordx4 v9, s[12:15], s24 offen offset:3072 lds
M v[212:215], a[172:175], a[76:79], v[212:215]
M v[212:215], a[168:171], a[72:75], v[212:215]
M v[216:219], a[168:171], a[80:83], v[216:219]
s_add_u32 s94, s93, 0
buffer_store_dwordx4 a[220:223], v1, s[16:19], s94 offen offset:3072 sc1
M v[216:219], a[172:175], a[84:87], v[216:219]
M v[220:223], a[172:175], a[92:95], v[220:223]
M v[220:223], a[168:171], a[88:91], v[220:223]
s_waitcnt lgkmcnt(10)
M v[224:227], a[176:179], a[32:35], v[224:227]
s_add_u32 s24, s24, 262144
s_cmp_eq_u32 s24, s27
s_cselect_b32 s24, s28, s24
s_sub_u32 s6, s6, 1
s_cmp_eq_u32 s6, 0
s_cselect_b64 s[12:13], s[64:65], s[12:13]
M v[224:227], a[180:183], a[36:39], v[224:227]
M v[228:231], a[180:183], a[44:47], v[228:231]
M v[228:231], a[176:179], a[40:43], v[228:231]
M v[232:235], a[176:179], a[48:51], v[232:235]
M v[232:235], a[180:183], a[52:55], v[232:235]
M v[236:239], a[180:183], a[60:63], v[236:239]
M v[236:239], a[176:179], a[56:59], v[236:239]
s_waitcnt vmcnt(11) lgkmcnt(0)
s_barrier
ds_read_b128 a[160:163], v10 offset:32768
ds_read_b128 a[164:167], v11 offset:32768
M v[240:243], a[176:179], a[64:67], v[240:243]
s_add_u32 m0, s29, 0
s_nop 0
buffer_load_dwordx4 v2, s[8:11], s23 offen offset:0 lds
M v[240:243], a[180:183], a[68:71], v[240:243]
M v[244:247], a[180:183], a[76:79], v[244:247]
M v[244:247], a[176:179], a[72:75], v[244:247]
M v[248:251], a[176:179], a[80:83], v[248:251]
M v[248:251], a[180:183], a[84:87], v[248:251]
buffer_load_dwordx4 v3, s[8:11], s23 offen offset:1024 lds
M v[252:255], a[180:183], a[92:95], v[252:255]
M v[252:255], a[176:179], a[88:91], v[252:255]
M a[0:3], a[184:187], a[32:35], a[0:3]
M a[0:3], a[188:191], a[36:39], a[0:3]
ds_read_b128 a[168:171], v10 offset:34816
ds_read_b128 a[172:175], v11 offset:34816
M a[4:7], a[188:191], a[44:47], a[4:7]
M a[4:7], a[184:187], a[40:43], a[4:7]
M a[8:11], a[184:187], a[48:51], a[8:11]
buffer_load_dwordx4 v4, s[8:11], s23 offen offset:2048 lds
M a[8:11], a[188:191], a[52:55], a[8:11]
M a[12:15], a[188:191], a[60:63], a[12:15]
M a[12:15], a[184:187], a[56:59], a[12:15]
M a[16:19], a[184:187], a[64:67], a[16:19]
M a[16:19], a[188:191], a[68:71], a[16:19]
buffer_load_dwordx4 v5, s[8:11], s23 offen offset:3072 lds
M a[20:23], a[188:191], a[76:79], a[20:23]
M a[20:23], a[184:187], a[72:75], a[20:23]
M a[24:27], a[184:187], a[80:83], a[24:27]
M a[24:27], a[188:191], a[84:87], a[24:27]
M a[28:31], a[188:191], a[92:95], a[28:31]
M a[28:31], a[184:187], a[88:91], a[28:31]
s_waitcnt lgkmcnt(2)
M v[32:35], a[160:163], a[96:99], v[32:35]
s_add_u32 m0, s29, 98304
s_nop 0
buffer_load_dwordx4 v6, s[12:15], s24 offen offset:0 lds
M v[32:35], a[164:167], a[100:103], v[32:35]
ds_read_b128 a[176:179], v10 offset:36864
ds_read_b128 a[180:183], v11 offset:36864
M v[36:39], a[164:167], a[108:111], v[36:39]
M v[36:39], a[160:163], a[104:107], v[36:39]
ds_read_b64_tr_b16 a[32:33], v12 offset:0
ds_read_b64_tr_b16 a[34:35], v12 offset:2048
M v[40:43], a[160:163], a[112:115], v[40:43]
M v[40:43], a[164:167], a[116:119], v[40:43]
M v[44:47], a[164:167], a[124:127], v[44:47]
M v[44:47], a[160:163], a[120:123], v[44:47]
ds_read_b64_tr_b16 a[40:41], v13 offset:0
ds_read_b64_tr_b16 a[42:43], v13 offset:2048
M v[48:51], a[160:163], a[128:131], v[48:51]
s_add_u32 s94, s93, 4096
buffer_store_dwordx4 a[224:227], v1, s[16:19], s94 offen offset:0 sc1
M v[48:51], a[164:167], a[132:135], v[48:51]
buffer_load_dwordx4 v7, s[12:15], s24 offen offset:1024 lds
M v[52:55], a[164:167], a[140:143], v[52:55]
M v[52:55], a[160:163], a[136:139], v[52:55]
ds_read_b64_tr_b16 a[48:49], v14 offset:0
ds_read_b64_tr_b16 a[50:51], v14 offset:2048
M v[56:59], a[160:163], a[144:147], v[56:59]
M v[56:59], a[164:167], a[148:151], v[56:59]
M v[60:63], a[164:167], a[156:159], v[60:63]
M v[60:63], a[160:163], a[152:155], v[60:63]
s_waitcnt lgkmcnt(8)
ds_read_b64_tr_b16 a[56:57], v15 offset:0
ds_read_b64_tr_b16 a[58:59], v15 offset:2048
M v[64:67], a[168:171], a[96:99], v[64:67]
buffer_load_dwordx4 v8, s[12:15], s24 offen offset:2048 lds
M v[64:67], a[172:175], a[100:103], v[64:67]
ds_read_b128 a[184:187], v10 offset:38912
ds_read_b128 a[188:191], v11 offset:38912
M v[68:71], a[172:175], a[108:111], v[68:71]
M v[68:71], a[168:171], a[104:107], v[68:71]
ds_read_b64_tr_b16 a[64:65], v16 offset:0
ds_read_b64_tr_b16 a[66:67], v16 offset:2048
M v[72:75], a[168:171], a[112:115], v[72:75]
M v[72:75], a[172:175], a[116:119], v[72:75]
M v[76:79], a[172:175], a[124:127], v[76:79]
M v[76:79], a[168:171], a[120:123], v[76:79]
ds_read_b64_tr_b16 a[72:73], v17 offset:0
ds_read_b64_tr_b16 a[74:75], v17 offset:2048
M v[80:83], a[168:171], a[128:131], v[80:83]
buffer_load_dwordx4 v9, s[12:15], s24 offen offset:3072 lds
M v[80:83], a[172:175], a[132:135], v[80:83]
M v[84:87], a[172:175], a[140:143], v[84:87]
M v[84:87], a[168:171], a[136:139], v[84:87]
ds_read_b64_tr_b16 a[80:81], v18 offset:0
ds_read_b64_tr_b16 a[82:83], v18 offset:2048
M v[88:91], a[168:171], a[144:147], v[88:91]
M v[88:91], a[172:175], a[148:151], v[88:91]
M v[92:95], a[172:175], a[156:159], v[92:95]
s_add_u32 s24, s24, 262144
M v[92:95], a[168:171], a[152:155], v[92:95]
s_waitcnt lgkmcnt(15)
ds_read_b64_tr_b16 a[88:89], v19 offset:0
ds_read_b64_tr_b16 a[90:91], v19 offset:2048
M v[96:99], a[176:179], a[96:99], v[96:99]
M v[96:99], a[180:183], a[100:103], v[96:99]
M v[100:103], a[180:183], a[108:111], v[100:103]
M v[100:103], a[176:179], a[104:107], v[100:103]
M v[104:107], a[176:179], a[112:115], v[104:107]
s_add_u32 s94, s93, 4096
buffer_store_dwordx4 a[228:231], v1, s[16:19], s94 offen offset:1024 sc1
M v[104:107], a[180:183], a[116:119], v[104:107]
M v[108:111], a[180:183], a[124:127], v[108:111]
M v[108:111], a[176:179], a[120:123], v[108:111]
s_waitcnt vmcnt(11) lgkmcnt(0)
s_barrier
ds_read_b128 a[160:163], v10 offset:49152
ds_read_b128 a[164:167], v11 offset:49152
M v[112:115], a[176:179], a[128:131], v[112:115]
s_add_u32 m0, s29, 16384
s_add_u32 s3, s23, s31
buffer_load_dwordx4 v2, s[8:11], s3 offen offset:0 lds
M v[112:115], a[180:183], a[132:135], v[112:115]
M v[116:119], a[180:183], a[140:143], v[116:119]
M v[116:119], a[176:179], a[136:139], v[116:119]
ds_read_b64_tr_b16 a[36:37], v12 offset:16384
ds_read_b64_tr_b16 a[38:39], v12 offset:18432
M v[120:123], a[176:179], a[144:147], v[120:123]
M v[120:123], a[180:183], a[148:151], v[120:123]
buffer_load_dwordx4 v3, s[8:11], s3 offen offset:1024 lds
M v[124:127], a[180:183], a[156:159], v[124:127]
M v[124:127], a[176:179], a[152:155], v[124:127]
M v[128:131], a[184:187], a[96:99], v[128:131]
M v[128:131], a[188:191], a[100:103], v[128:131]
ds_read_b128 a[168:171], v10 offset:51200
ds_read_b128 a[172:175], v11 offset:51200
ds_read_b64_tr_b16 a[44:45], v13 offset:16384
ds_read_b64_tr_b16 a[46:47], v13 offset:18432
M v[132:135], a[188:191], a[108:111], v[132:135]
M v[132:135], a[184:187], a[104:107], v[132:135]
M v[136:139], a[184:187], a[112:115], v[136:139]
buffer_load_dwordx4 v4, s[8:11], s3 offen offset:2048 lds
M v[136:139], a[188:191], a[116:119], v[136:139]
M v[140:143], a[188:191], a[124:127], v[140:143]
M v[140:143], a[184:187], a[120:123], v[140:143]
ds_read_b64_tr_b16 a[52:53], v14 offset:16384
ds_read_b64_tr_b16 a[54:55], v14 offset:18432
M v[144:147], a[184:187], a[128:131], v[144:147]
M v[144:147], a[188:191], a[132:135], v[144:147]
buffer_load_dwordx4 v5, s[8:11], s3 offen offset:3072 lds
M v[148:151], a[188:191], a[140:143], v[148:151]
M v[148:151], a[184:187], a[136:139], v[148:151]
M v[152:155], a[184:187], a[144:147], v[152:155]
M v[152:155], a[188:191], a[148:151], v[152:155]
ds_read_b64_tr_b16 a[60:61], v15 offset:16384
ds_read_b64_tr_b16 a[62:63], v15 offset:18432
M v[156:159], a[188:191], a[156:159], v[156:159]
M v[156:159], a[184:187], a[152:155], v[156:159]
s_waitcnt lgkmcnt(10)
M v[160:163], a[160:163], a[96:99], v[160:163]
s_add_u32 s94, s93, 4096
buffer_store_dwordx4 a[232:235], v1, s[16:19], s94 offen offset:2048 sc1
M v[160:163], a[164:167], a[100:103], v[160:163]
ds_read_b128 a[176:179], v10 offset:53248
ds_read_b128 a[180:183], v11 offset:53248
M v[164:167], a[164:167], a[108:111], v[164:167]
s_add_u32 s23, s23, 128
s_cmp_eq_u32 s23, s25
s_cselect_b32 s23, s26, s23
M v[164:167], a[160:163], a[104:107], v[164:167]
ds_read_b64_tr_b16 a[68:69], v16 offset:16384
ds_read_b64_tr_b16 a[70:71], v16 offset:18432
M v[168:171], a[160:163], a[112:115], v[168:171]
M v[168:171], a[164:167], a[116:119], v[168:171]
M v[172:175], a[164:167], a[124:127], v[172:175]
M v[172:175], a[160:163], a[120:123], v[172:175]
M v[176:179], a[160:163], a[128:131], v[176:179]
s_add_u32 m0, s29, 114688
s_nop 0
buffer_load_dwordx4 v6, s[12:15], s24 offen offset:0 lds
M v[176:179], a[164:167], a[132:135], v[176:179]
ds_read_b64_tr_b16 a[76:77], v17 offset:16384
ds_read_b64_tr_b16 a[78:79], v17 offset:18432
M v[180:183], a[164:167], a[140:143], v[180:183]
M v[180:183], a[160:163], a[136:139], v[180:183]
M v[184:187], a[160:163], a[144:147], v[184:187]
M v[184:187], a[164:167], a[148:151], v[184:187]
buffer_load_dwordx4 v7, s[12:15], s24 offen offset:1024 lds
M v[188:191], a[164:167], a[156:159], v[188:191]
M v[188:191], a[160:163], a[152:155], v[188:191]
s_waitcnt lgkmcnt(12)
ds_read_b64_tr_b16 a[84:85], v18 offset:16384
ds_read_b64_tr_b16 a[86:87], v18 offset:18432
M v[192:195], a[168:171], a[96:99], v[192:195]
M v[192:195], a[172:175], a[100:103], v[192:195]
ds_read_b128 a[184:187], v10 offset:55296
ds_read_b128 a[188:191], v11 offset:55296
M v[196:199], a[172:175], a[108:111], v[196:199]
M v[196:199], a[168:171], a[104:107], v[196:199]
M v[200:203], a[168:171], a[112:115], v[200:203]
buffer_load_dwordx4 v8, s[12:15], s24 offen offset:2048 lds
M v[200:203], a[172:175], a[116:119], v[200:203]
ds_read_b64_tr_b16 a[92:93], v19 offset:16384
ds_read_b64_tr_b16 a[94:95], v19 offset:18432
M v[204:207], a[172:175], a[124:127], v[204:207]
M v[204:207], a[168:171], a[120:123], v[204:207]
M v[208:211], a[168:171], a[128:131], v[208:211]
M v[208:211], a[172:175], a[132:135], v[208:211]
buffer_load_dwordx4 v9, s[12:15], s24 offen offset:3072 lds
M v[212:215], a[172:175], a[140:143], v[212:215]
M v[212:215], a[168:171], a[136:139], v[212:215]
M v[216:219], a[168:171], a[144:147], v[216:219]
s_add_u32 s94, s93, 4096
buffer_store_dwordx4 a[236:239], v1, s[16:19], s94 offen offset:3072 sc1
M v[216:219], a[172:175], a[148:151], v[216:219]
M v[220:223], a[172:175], a[156:159], v[220:223]
M v[220:223], a[168:171], a[152:155], v[220:223]
s_waitcnt lgkmcnt(10)
M v[224:227], a[176:179], a[96:99], v[224:227]
s_add_u32 s24, s24, 262144
s_cmp_eq_u32 s24, s27
s_cselect_b32 s24, s28, s24
s_sub_u32 s6, s6, 1
s_cmp_eq_u32 s6, 0
s_cselect_b64 s[12:13], s[64:65], s[12:13]
M v[224:227], a[180:183], a[100:103], v[224:227]
M v[228:231], a[180:183], a[108:111], v[228:231]
M v[228:231], a[176:179], a[104:107], v[228:231]
M v[232:235], a[176:179], a[112:115], v[232:235]
M v[232:235], a[180:183], a[116:119], v[232:235]
M v[236:239], a[180:183], a[124:127], v[236:239]
M v[236:239], a[176:179], a[120:123], v[236:239]
s_waitcnt vmcnt(11) lgkmcnt(0)
s_barrier
ds_read_b128 a[160:163], v10 offset:0
ds_read_b128 a[164:167], v11 offset:0
M v[240:243], a[176:179], a[128:131], v[240:243]
s_add_u32 m0, s29, 32768
s_nop 0
buffer_load_dwordx4 v2, s[8:11], s23 offen offset:0 lds
M v[240:243], a[180:183], a[132:135], v[240:243]
M v[244:247], a[180:183], a[140:143], v[244:247]
M v[244:247], a[176:179], a[136:139], v[244:247]
M v[248:251], a[176:179], a[144:147], v[248:251]
M v[248:251], a[180:183], a[148:151], v[248:251]
buffer_load_dwordx4 v3, s[8:11], s23 offen offset:1024 lds
M v[252:255], a[180:183], a[156:159], v[252:255]
M v[252:255], a[176:179], a[152:155], v[252:255]
M a[0:3], a[184:187], a[96:99], a[0:3]
M a[0:3], a[188:191], a[100:103], a[0:3]
ds_read_b128 a[168:171], v10 offset:2048
ds_read_b128 a[172:175], v11 offset:2048
M a[4:7], a[188:191], a[108:111], a[4:7]
M a[4:7], a[184:187], a[104:107], a[4:7]
M a[8:11], a[184:187], a[112:115], a[8:11]
buffer_load_dwordx4 v4, s[8:11], s23 offen offset:2048 lds
M a[8:11], a[188:191], a[116:119], a[8:11]
M a[12:15], a[188:191], a[124:127], a[12:15]
M a[12:15], a[184:187], a[120:123], a[12:15]
M a[16:19], a[184:187], a[128:131], a[16:19]
M a[16:19], a[188:191], a[132:135], a[16:19]
buffer_load_dwordx4 v5, s[8:11], s23 offen offset:3072 lds
M a[20:23], a[188:191], a[140:143], a[20:23]
M a[20:23], a[184:187], a[136:139], a[20:23]
M a[24:27], a[184:187], a[144:147], a[24:27]
M a[24:27], a[188:191], a[148:151], a[24:27]
M a[28:31], a[188:191], a[156:159], a[28:31]
M a[28:31], a[184:187], a[152:155], a[28:31]
s_waitcnt lgkmcnt(2)
M v[32:35], a[160:163], a[32:35], v[32:35]
s_add_u32 m0, s29, 65536
s_nop 0
buffer_load_dwordx4 v6, s[12:15], s24 offen offset:0 lds
M v[32:35], a[164:167], a[36:39], v[32:35]
ds_read_b128 a[176:179], v10 offset:4096
ds_read_b128 a[180:183], v11 offset:4096
M v[36:39], a[164:167], a[44:47], v[36:39]
M v[36:39], a[160:163], a[40:43], v[36:39]
ds_read_b64_tr_b16 a[96:97], v12 offset:32768
ds_read_b64_tr_b16 a[98:99], v12 offset:34816
M v[40:43], a[160:163], a[48:51], v[40:43]
M v[40:43], a[164:167], a[52:55], v[40:43]
M v[44:47], a[164:167], a[60:63], v[44:47]
M v[44:47], a[160:163], a[56:59], v[44:47]
ds_read_b64_tr_b16 a[104:105], v13 offset:32768
ds_read_b64_tr_b16 a[106:107], v13 offset:34816
M v[48:51], a[160:163], a[64:67], v[48:51]
s_add_u32 s94, s93, 8192
buffer_store_dwordx4 a[240:243], v1, s[16:19], s94 offen offset:0 sc1
M v[48:51], a[164:167], a[68:71], v[48:51]
buffer_load_dwordx4 v7, s[12:15], s24 offen offset:1024 lds
M v[52:55], a[164:167], a[76:79], v[52:55]
M v[52:55], a[160:163], a[72:75], v[52:55]
ds_read_b64_tr_b16 a[112:113], v14 offset:32768
ds_read_b64_tr_b16 a[114:115], v14 offset:34816
M v[56:59], a[160:163], a[80:83], v[56:59]
M v[56:59], a[164:167], a[84:87], v[56:59]
M v[60:63], a[164:167], a[92:95], v[60:63]
M v[60:63], a[160:163], a[88:91], v[60:63]
s_waitcnt lgkmcnt(8)
ds_read_b64_tr_b16 a[120:121], v15 offset:32768
ds_read_b64_tr_b16 a[122:123], v15 offset:34816
M v[64:67], a[168:171], a[32:35], v[64:67]
buffer_load_dwordx4 v8, s[12:15], s24 offen offset:2048 lds
M v[64:67], a[172:175], a[36:39], v[64:67]
ds_read_b128 a[184:187], v10 offset:6144
ds_read_b128 a[188:191], v11 offset:6144
M v[68:71], a[172:175], a[44:47], v[68:71]
M v[68:71], a[168:171], a[40:43], v[68:71]
ds_read_b64_tr_b16 a[128:129], v16 offset:32768
ds_read_b64_tr_b16 a[130:131], v16 offset:34816
M v[72:75], a[168:171], a[48:51], v[72:75]
M v[72:75], a[172:175], a[52:55], v[72:75]
M v[76:79], a[172:175], a[60:63], v[76:79]
M v[76:79], a[168:171], a[56:59], v[76:79]
ds_read_b64_tr_b16 a[136:137], v17 offset:32768
ds_read_b64_tr_b16 a[138:139], v17 offset:34816
M v[80:83], a[168:171], a[64:67], v[80:83]
buffer_load_dwordx4 v9, s[12:15], s24 offen offset:3072 lds
M v[80:83], a[172:175], a[68:71], v[80:83]
M v[84:87], a[172:175], a[76:79], v[84:87]
M v[84:87], a[168:171], a[72:75], v[84:87]
ds_read_b64_tr_b16 a[144:145], v18 offset:32768
ds_read_b64_tr_b16 a[146:147], v18 offset:34816
M v[88:91], a[168:171], a[80:83], v[88:91]
M v[88:91], a[172:175], a[84:87], v[88:91]
M v[92:95], a[172:175], a[92:95], v[92:95]
s_add_u32 s24, s24, 262144
M v[92:95], a[168:171], a[88:91], v[92:95]
s_waitcnt lgkmcnt(15)
ds_read_b64_tr_b16 a[152:153], v19 offset:32768
ds_read_b64_tr_b16 a[154:155], v19 offset:34816
M v[96:99], a[176:179], a[32:35], v[96:99]
M v[96:99], a[180:183], a[36:39], v[96:99]
M v[100:103], a[180:183], a[44:47], v[100:103]
M v[100:103], a[176:179], a[40:43], v[100:103]
M v[104:107], a[176:179], a[48:51], v[104:107]
s_add_u32 s94, s93, 8192
buffer_store_dwordx4 a[244:247], v1, s[16:19], s94 offen offset:1024 sc1
M v[104:107], a[180:183], a[52:55], v[104:107]
M v[108:111], a[180:183], a[60:63], v[108:111]
M v[108:111], a[176:179], a[56:59], v[108:111]
s_waitcnt vmcnt(11) lgkmcnt(0)
s_barrier
ds_read_b128 a[160:163], v10 offset:16384
ds_read_b128 a[164:167], v11 offset:16384
M v[112:115], a[176:179], a[64:67], v[112:115]
s_add_u32 m0, s29, 49152
s_add_u32 s3, s23, s31
buffer_load_dwordx4 v2, s[8:11], s3 offen offset:0 lds
M v[112:115], a[180:183], a[68:71], v[112:115]
M v[116:119], a[180:183], a[76:79], v[116:119]
M v[116:119], a[176:179], a[72:75], v[116:119]
ds_read_b64_tr_b16 a[100:101], v12 offset:49152
ds_read_b64_tr_b16 a[102:103], v12 offset:51200
M v[120:123], a[176:179], a[80:83], v[120:123]
M v[120:123], a[180:183], a[84:87], v[120:123]
buffer_load_dwordx4 v3, s[8:11], s3 offen offset:1024 lds
M v[124:127], a[180:183], a[92:95], v[124:127]
M v[124:127], a[176:179], a[88:91], v[124:127]
M v[128:131], a[184:187], a[32:35], v[128:131]
M v[128:131], a[188:191], a[36:39], v[128:131]
ds_read_b128 a[168:171], v10 offset:18432
ds_read_b128 a[172:175], v11 offset:18432
ds_read_b64_tr_b16 a[108:109], v13 offset:49152
ds_read_b64_tr_b16 a[110:111], v13 offset:51200
M v[132:135], a[188:191], a[44:47], v[132:135]
M v[132:135], a[184:187], a[40:43], v[132:135]
M v[136:139], a[184:187], a[48:51], v[136:139]
buffer_load_dwordx4 v4, s[8:11], s3 offen offset:2048 lds
M v[136:139], a[188:191], a[52:55], v[136:139]
M v[140:143], a[188:191], a[60:63], v[140:143]
M v[140:143], a[184:187], a[56:59], v[140:143]
ds_read_b64_tr_b16 a[116:117], v14 offset:49152
ds_read_b64_tr_b16 a[118:119], v14 offset:51200
M v[144:147], a[184:187], a[64:67], v[144:147]
M v[144:147], a[188:191], a[68:71], v[144:147]
buffer_load_dwordx4 v5, s[8:11], s3 offen offset:3072 lds
M v[148:151], a[188:191], a[76:79], v[148:151]
M v[148:151], a[184:187], a[72:75], v[148:151]
M v[152:155], a[184:187], a[80:83], v[152:155]
M v[152:155], a[188:191], a[84:87], v[152:155]
ds_read_b64_tr_b16 a[124:125], v15 offset:49152
ds_read_b64_tr_b16 a[126:127], v15 offset:51200
M v[156:159], a[188:191], a[92:95], v[156:159]
M v[156:159], a[184:187], a[88:91], v[156:159]
s_waitcnt lgkmcnt(10)
M v[160:163], a[160:163], a[32:35], v[160:163]
s_add_u32 s94, s93, 8192
buffer_store_dwordx4 a[248:251], v1, s[16:19], s94 offen offset:2048 sc1
M v[160:163], a[164:167], a[36:39], v[160:163]
ds_read_b128 a[176:179], v10 offset:20480
ds_read_b128 a[180:183], v11 offset:20480
M v[164:167], a[164:167], a[44:47], v[164:167]
s_add_u32 s23, s23, 128
s_cmp_eq_u32 s23, s25
s_cselect_b32 s23, s26, s23
M v[164:167], a[160:163], a[40:43], v[164:167]
ds_read_b64_tr_b16 a[132:133], v16 offset:49152
ds_read_b64_tr_b16 a[134:135], v16 offset:51200
M v[168:171], a[160:163], a[48:51], v[168:171]
M v[168:171], a[164:167], a[52:55], v[168:171]
M v[172:175], a[164:167], a[60:63], v[172:175]
M v[172:175], a[160:163], a[56:59], v[172:175]
M v[176:179], a[160:163], a[64:67], v[176:179]
s_add_u32 m0, s29, 81920
s_nop 0
buffer_load_dwordx4 v6, s[12:15], s24 offen offset:0 lds
M v[176:179], a[164:167], a[68:71], v[176:179]
ds_read_b64_tr_b16 a[140:141], v17 offset:49152
ds_read_b64_tr_b16 a[142:143], v17 offset:51200
M v[180:183], a[164:167], a[76:79], v[180:183]
M v[180:183], a[160:163], a[72:75], v[180:183]
M v[184:187], a[160:163], a[80:83], v[184:187]
M v[184:187], a[164:167], a[84:87], v[184:187]
buffer_load_dwordx4 v7, s[12:15], s24 offen offset:1024 lds
M v[188:191], a[164:167], a[92:95], v[188:191]
M v[188:191], a[160:163], a[88:91], v[188:191]
s_waitcnt lgkmcnt(12)
ds_read_b64_tr_b16 a[148:149], v18 offset:49152
ds_read_b64_tr_b16 a[150:151], v18 offset:51200
M v[192:195], a[168:171], a[32:35], v[192:195]
M v[192:195], a[172:175], a[36:39], v[192:195]
ds_read_b128 a[184:187], v10 offset:22528
ds_read_b128 a[188:191], v11 offset:22528
M v[196:199], a[172:175], a[44:47], v[196:199]
M v[196:199], a[168:171], a[40:43], v[196:199]
M v[200:203], a[168:171], a[48:51], v[200:203]
buffer_load_dwordx4 v8, s[12:15], s24 offen offset:2048 lds
M v[200:203], a[172:175], a[52:55], v[200:203]
ds_read_b64_tr_b16 a[156:157], v19 offset:49152
ds_read_b64_tr_b16 a[158:159], v19 offset:51200
M v[204:207], a[172:175], a[60:63], v[204:207]
M v[204:207], a[168:171], a[56:59], v[204:207]
M v[208:211], a[168:171], a[64:67], v[208:211]
M v[208:211], a[172:175], a[68:71], v[208:211]
buffer_load_dwordx4 v9, s[12:15], s24 offen offset:3072 lds
M v[212:215], a[172:175], a[76:79], v[212:215]
M v[212:215], a[168:171], a[72:75], v[212:215]
M v[216:219], a[168:171], a[80:83], v[216:219]
s_add_u32 s94, s93, 8192
buffer_store_dwordx4 a[252:255], v1, s[16:19], s94 offen offset:3072 sc1
M v[216:219], a[172:175], a[84:87], v[216:219]
M v[220:223], a[172:175], a[92:95], v[220:223]
M v[220:223], a[168:171], a[88:91], v[220:223]
s_waitcnt lgkmcnt(10)
M v[224:227], a[176:179], a[32:35], v[224:227]
s_add_u32 s24, s24, 262144
s_cmp_eq_u32 s24, s27
s_cselect_b32 s24, s28, s24
s_sub_u32 s6, s6, 1
s_cmp_eq_u32 s6, 0
s_cselect_b64 s[12:13], s[64:65], s[12:13]
M v[224:227], a[180:183], a[36:39], v[224:227]
M v[228:231], a[180:183], a[44:47], v[228:231]
M v[228:231], a[176:179], a[40:43], v[228:231]
M v[232:235], a[176:179], a[48:51], v[232:235]
M v[232:235], a[180:183], a[52:55], v[232:235]
M v[236:239], a[180:183], a[60:63], v[236:239]
M v[236:239], a[176:179], a[56:59], v[236:239]
s_waitcnt vmcnt(11) lgkmcnt(0)
s_barrier
ds_read_b128 a[160:163], v10 offset:32768
ds_read_b128 a[164:167], v11 offset:32768
M v[240:243], a[176:179], a[64:67], v[240:243]
s_add_u32 m0, s29, 0
s_nop 0
buffer_load_dwordx4 v2, s[8:11], s23 offen offset:0 lds
M v[240:243], a[180:183], a[68:71], v[240:243]
M v[244:247], a[180:183], a[76:79], v[244:247]
M v[244:247], a[176:179], a[72:75], v[244:247]
M v[248:251], a[176:179], a[80:83], v[248:251]
M v[248:251], a[180:183], a[84:87], v[248:251]
buffer_load_dwordx4 v3, s[8:11], s23 offen offset:1024 lds
M v[252:255], a[180:183], a[92:95], v[252:255]
M v[252:255], a[176:179], a[88:91], v[252:255]
M a[0:3], a[184:187], a[32:35], a[0:3]
M a[0:3], a[188:191], a[36:39], a[0:3]
ds_read_b128 a[168:171], v10 offset:34816
ds_read_b128 a[172:175], v11 offset:34816
M a[4:7], a[188:191], a[44:47], a[4:7]
M a[4:7], a[184:187], a[40:43], a[4:7]
M a[8:11], a[184:187], a[48:51], a[8:11]
buffer_load_dwordx4 v4, s[8:11], s23 offen offset:2048 lds
M a[8:11], a[188:191], a[52:55], a[8:11]
M a[12:15], a[188:191], a[60:63], a[12:15]
M a[12:15], a[184:187], a[56:59], a[12:15]
M a[16:19], a[184:187], a[64:67], a[16:19]
M a[16:19], a[188:191], a[68:71], a[16:19]
buffer_load_dwordx4 v5, s[8:11], s23 offen offset:3072 lds
M a[20:23], a[188:191], a[76:79], a[20:23]
M a[20:23], a[184:187], a[72:75], a[20:23]
M a[24:27], a[184:187], a[80:83], a[24:27]
M a[24:27], a[188:191], a[84:87], a[24:27]
M a[28:31], a[188:191], a[92:95], a[28:31]
M a[28:31], a[184:187], a[88:91], a[28:31]
s_waitcnt lgkmcnt(2)
M v[32:35], a[160:163], a[96:99], v[32:35]
s_add_u32 m0, s29, 98304
s_nop 0
buffer_load_dwordx4 v6, s[12:15], s24 offen offset:0 lds
M v[32:35], a[164:167], a[100:103], v[32:35]
ds_read_b128 a[176:179], v10 offset:36864
ds_read_b128 a[180:183], v11 offset:36864
M v[36:39], a[164:167], a[108:111], v[36:39]
M v[36:39], a[160:163], a[104:107], v[36:39]
ds_read_b64_tr_b16 a[32:33], v12 offset:0
ds_read_b64_tr_b16 a[34:35], v12 offset:2048
M v[40:43], a[160:163], a[112:115], v[40:43]
M v[40:43], a[164:167], a[116:119], v[40:43]
M v[44:47], a[164:167], a[124:127], v[44:47]
M v[44:47], a[160:163], a[120:123], v[44:47]
ds_read_b64_tr_b16 a[40:41], v13 offset:0
ds_read_b64_tr_b16 a[42:43], v13 offset:2048
M v[48:51], a[160:163], a[128:131], v[48:51]
buffer_load_dwordx4 v7, s[12:15], s24 offen offset:1024 lds
M v[48:51], a[164:167], a[132:135], v[48:51]
M v[52:55], a[164:167], a[140:143], v[52:55]
M v[52:55], a[160:163], a[136:139], v[52:55]
ds_read_b64_tr_b16 a[48:49], v14 offset:0
ds_read_b64_tr_b16 a[50:51], v14 offset:2048
M v[56:59], a[160:163], a[144:147], v[56:59]
M v[56:59], a[164:167], a[148:151], v[56:59]
M v[60:63], a[164:167], a[156:159], v[60:63]
buffer_load_dwordx4 v8, s[12:15], s24 offen offset:2048 lds
M v[60:63], a[160:163], a[152:155], v[60:63]
s_waitcnt lgkmcnt(8)
ds_read_b64_tr_b16 a[56:57], v15 offset:0
ds_read_b64_tr_b16 a[58:59], v15 offset:2048
M v[64:67], a[168:171], a[96:99], v[64:67]
M v[64:67], a[172:175], a[100:103], v[64:67]
ds_read_b128 a[184:187], v10 offset:38912
ds_read_b128 a[188:191], v11 offset:38912
M v[68:71], a[172:175], a[108:111], v[68:71]
M v[68:71], a[168:171], a[104:107], v[68:71]
ds_read_b64_tr_b16 a[64:65], v16 offset:0
ds_read_b64_tr_b16 a[66:67], v16 offset:2048
M v[72:75], a[168:171], a[112:115], v[72:75]
M v[72:75], a[172:175], a[116:119], v[72:75]
M v[76:79], a[172:175], a[124:127], v[76:79]
M v[76:79], a[168:171], a[120:123], v[76:79]
ds_read_b64_tr_b16 a[72:73], v17 offset:0
ds_read_b64_tr_b16 a[74:75], v17 offset:2048
M v[80:83], a[168:171], a[128:131], v[80:83]
buffer_load_dwordx4 v9, s[12:15], s24 offen offset:3072 lds
M v[80:83], a[172:175], a[132:135], v[80:83]
M v[84:87], a[172:175], a[140:143], v[84:87]
M v[84:87], a[168:171], a[136:139], v[84:87]
ds_read_b64_tr_b16 a[80:81], v18 offset:0
ds_read_b64_tr_b16 a[82:83], v18 offset:2048
M v[88:91], a[168:171], a[144:147], v[88:91]
M v[88:91], a[172:175], a[148:151], v[88:91]
M v[92:95], a[172:175], a[156:159], v[92:95]
s_add_u32 s24, s24, 262144
M v[92:95], a[168:171], a[152:155], v[92:95]
s_waitcnt lgkmcnt(15)
ds_read_b64_tr_b16 a[88:89], v19 offset:0
ds_read_b64_tr_b16 a[90:91], v19 offset:2048
M v[96:99], a[176:179], a[96:99], v[96:99]
M v[96:99], a[180:183], a[100:103], v[96:99]
M v[100:103], a[180:183], a[108:111], v[100:103]
M v[100:103], a[176:179], a[104:107], v[100:103]
M v[104:107], a[176:179], a[112:115], v[104:107]
M v[104:107], a[180:183], a[116:119], v[104:107]
M v[108:111], a[180:183], a[124:127], v[108:111]
M v[108:111], a[176:179], a[120:123], v[108:111]
s_waitcnt vmcnt(9) lgkmcnt(0)
s_barrier
ds_read_b128 a[160:163], v10 offset:49152
ds_read_b128 a[164:167], v11 offset:49152
M v[112:115], a[176:179], a[128:131], v[112:115]
s_add_u32 m0, s29, 16384
s_add_u32 s3, s23, s31
buffer_load_dwordx4 v2, s[8:11], s3 offen offset:0 lds
M v[112:115], a[180:183], a[132:135], v[112:115]
M v[116:119], a[180:183], a[140:143], v[116:119]
M v[116:119], a[176:179], a[136:139], v[116:119]
ds_read_b64_tr_b16 a[36:37], v12 offset:16384
ds_read_b64_tr_b16 a[38:39], v12 offset:18432
M v[120:123], a[176:179], a[144:147], v[120:123]
M v[120:123], a[180:183], a[148:151], v[120:123]
buffer_load_dwordx4 v3, s[8:11], s3 offen offset:1024 lds
M v[124:127], a[180:183], a[156:159], v[124:127]
M v[124:127], a[176:179], a[152:155], v[124:127]
M v[128:131], a[184:187], a[96:99], v[128:131]
M v[128:131], a[188:191], a[100:103], v[128:131]
ds_read_b128 a[168:171], v10 offset:51200
ds_read_b128 a[172:175], v11 offset:51200
ds_read_b64_tr_b16 a[44:45], v13 offset:16384
ds_read_b64_tr_b16 a[46:47], v13 offset:18432
M v[132:135], a[188:191], a[108:111], v[132:135]
M v[132:135], a[184:187], a[104:107], v[132:135]
M v[136:139], a[184:187], a[112:115], v[136:139]
buffer_load_dwordx4 v4, s[8:11], s3 offen offset:2048 lds
M v[136:139], a[188:191], a[116:119], v[136:139]
M v[140:143], a[188:191], a[124:127], v[140:143]
M v[140:143], a[184:187], a[120:123], v[140:143]
ds_read_b64_tr_b16 a[52:53], v14 offset:16384
ds_read_b64_tr_b16 a[54:55], v14 offset:18432
M v[144:147], a[184:187], a[128:131], v[144:147]
M v[144:147], a[188:191], a[132:135], v[144:147]
M v[148:151], a[188:191], a[140:143], v[148:151]
buffer_load_dwordx4 v5, s[8:11], s3 offen offset:3072 lds
M v[148:151], a[184:187], a[136:139], v[148:151]
M v[152:155], a[184:187], a[144:147], v[152:155]
M v[152:155], a[188:191], a[148:151], v[152:155]
ds_read_b64_tr_b16 a[60:61], v15 offset:16384
ds_read_b64_tr_b16 a[62:63], v15 offset:18432
M v[156:159], a[188:191], a[156:159], v[156:159]
M v[156:159], a[184:187], a[152:155], v[156:159]
s_waitcnt lgkmcnt(10)
M v[160:163], a[160:163], a[96:99], v[160:163]
M v[160:163], a[164:167], a[100:103], v[160:163]
ds_read_b128 a[176:179], v10 offset:53248
ds_read_b128 a[180:183], v11 offset:53248
M v[164:167], a[164:167], a[108:111], v[164:167]
s_add_u32 s23, s23, 128
s_cmp_eq_u32 s23, s25
s_cselect_b32 s23, s26, s23
M v[164:167], a[160:163], a[104:107], v[164:167]
ds_read_b64_tr_b16 a[68:69], v16 offset:16384
ds_read_b64_tr_b16 a[70:71], v16 offset:18432
M v[168:171], a[160:163], a[112:115], v[168:171]
M v[168:171], a[164:167], a[116:119], v[168:171]
M v[172:175], a[164:167], a[124:127], v[172:175]
M v[172:175], a[160:163], a[120:123], v[172:175]
M v[176:179], a[160:163], a[128:131], v[176:179]
s_add_u32 m0, s29, 114688
s_nop 0
buffer_load_dwordx4 v6, s[12:15], s24 offen offset:0 lds
M v[176:179], a[164:167], a[132:135], v[176:179]
ds_read_b64_tr_b16 a[76:77], v17 offset:16384
ds_read_b64_tr_b16 a[78:79], v17 offset:18432
M v[180:183], a[164:167], a[140:143], v[180:183]
M v[180:183], a[160:163], a[136:139], v[180:183]
M v[184:187], a[160:163], a[144:147], v[184:187]
M v[184:187], a[164:167], a[148:151], v[184:187]
buffer_load_dwordx4 v7, s[12:15], s24 offen offset:1024 lds
M v[188:191], a[164:167], a[156:159], v[188:191]
M v[188:191], a[160:163], a[152:155], v[188:191]
s_waitcnt lgkmcnt(12)
ds_read_b64_tr_b16 a[84:85], v18 offset:16384
ds_read_b64_tr_b16 a[86:87], v18 offset:18432
M v[192:195], a[168:171], a[96:99], v[192:195]
M v[192:195], a[172:175], a[100:103], v[192:195]
ds_read_b128 a[184:187], v10 offset:55296
ds_read_b128 a[188:191], v11 offset:55296
M v[196:199], a[172:175], a[108:111], v[196:199]
M v[196:199], a[168:171], a[104:107], v[196:199]
M v[200:203], a[168:171], a[112:115], v[200:203]
buffer_load_dwordx4 v8, s[12:15], s24 offen offset:2048 lds
M v[200:203], a[172:175], a[116:119], v[200:203]
ds_read_b64_tr_b16 a[92:93], v19 offset:16384
ds_read_b64_tr_b16 a[94:95], v19 offset:18432
M v[204:207], a[172:175], a[124:127], v[204:207]
M v[204:207], a[168:171], a[120:123], v[204:207]
M v[208:211], a[168:171], a[128:131], v[208:211]
M v[208:211], a[172:175], a[132:135], v[208:211]
M v[212:215], a[172:175], a[140:143], v[212:215]
buffer_load_dwordx4 v9, s[12:15], s24 offen offset:3072 lds
M v[212:215], a[168:171], a[136:139], v[212:215]
M v[216:219], a[168:171], a[144:147], v[216:219]
M v[216:219], a[172:175], a[148:151], v[216:219]
M v[220:223], a[172:175], a[156:159], v[220:223]
M v[220:223], a[168:171], a[152:155], v[220:223]
s_waitcnt lgkmcnt(10)
M v[224:227], a[176:179], a[96:99], v[224:227]
s_add_u32 s24, s24, 262144
s_cmp_eq_u32 s24, s27
s_cselect_b32 s24, s28, s24
s_sub_u32 s6, s6, 1
s_cmp_eq_u32 s6, 0
s_cselect_b64 s[12:13], s[64:65], s[12:13]
M v[224:227], a[180:183], a[100:103], v[224:227]
M v[228:231], a[180:183], a[108:111], v[228:231]
M v[228:231], a[176:179], a[104:107], v[228:231]
M v[232:235], a[176:179], a[112:115], v[232:235]
M v[232:235], a[180:183], a[116:119], v[232:235]
M v[236:239], a[180:183], a[124:127], v[236:239]
M v[236:239], a[176:179], a[120:123], v[236:239]
s_waitcnt vmcnt(8) lgkmcnt(0)
s_barrier
ds_read_b128 a[160:163], v10 offset:0
ds_read_b128 a[164:167], v11 offset:0
M v[240:243], a[176:179], a[128:131], v[240:243]
s_add_u32 m0, s29, 32768
s_nop 0
buffer_load_dwordx4 v2, s[8:11], s23 offen offset:0 lds
M v[240:243], a[180:183], a[132:135], v[240:243]
M v[244:247], a[180:183], a[140:143], v[244:247]
M v[244:247], a[176:179], a[136:139], v[244:247]
M v[248:251], a[176:179], a[144:147], v[248:251]
M v[248:251], a[180:183], a[148:151], v[248:251]
M v[252:255], a[180:183], a[156:159], v[252:255]
M v[252:255], a[176:179], a[152:155], v[252:255]
M a[0:3], a[184:187], a[96:99], a[0:3]
M a[0:3], a[188:191], a[100:103], a[0:3]
ds_read_b128 a[168:171], v10 offset:2048
ds_read_b128 a[172:175], v11 offset:2048
M a[4:7], a[188:191], a[108:111], a[4:7]
M a[4:7], a[184:187], a[104:107], a[4:7]
M a[8:11], a[184:187], a[112:115], a[8:11]
buffer_load_dwordx4 v3, s[8:11], s23 offen offset:1024 lds
M a[8:11], a[188:191], a[116:119], a[8:11]
M a[12:15], a[188:191], a[124:127], a[12:15]
M a[12:15], a[184:187], a[120:123], a[12:15]
M a[16:19], a[184:187], a[128:131], a[16:19]
M a[16:19], a[188:191], a[132:135], a[16:19]
M a[20:23], a[188:191], a[140:143], a[20:23]
M a[20:23], a[184:187], a[136:139], a[20:23]
M a[24:27], a[184:187], a[144:147], a[24:27]
M a[24:27], a[188:191], a[148:151], a[24:27]
M a[28:31], a[188:191], a[156:159], a[28:31]
M a[28:31], a[184:187], a[152:155], a[28:31]
s_waitcnt lgkmcnt(2)
M v[32:35], a[160:163], a[32:35], v[32:35]
buffer_load_dwordx4 v4, s[8:11], s23 offen offset:2048 lds
M v[32:35], a[164:167], a[36:39], v[32:35]
ds_read_b128 a[176:179], v10 offset:4096
ds_read_b128 a[180:183], v11 offset:4096
M v[36:39], a[164:167], a[44:47], v[36:39]
M v[36:39], a[160:163], a[40:43], v[36:39]
ds_read_b64_tr_b16 a[96:97], v12 offset:32768
ds_read_b64_tr_b16 a[98:99], v12 offset:34816
M v[40:43], a[160:163], a[48:51], v[40:43]
M v[40:43], a[164:167], a[52:55], v[40:43]
M v[44:47], a[164:167], a[60:63], v[44:47]
M v[44:47], a[160:163], a[56:59], v[44:47]
ds_read_b64_tr_b16 a[104:105], v13 offset:32768
ds_read_b64_tr_b16 a[106:107], v13 offset:34816
M v[48:51], a[160:163], a[64:67], v[48:51]
M v[48:51], a[164:167], a[68:71], v[48:51]
M v[52:55], a[164:167], a[76:79], v[52:55]
M v[52:55], a[160:163], a[72:75], v[52:55]
ds_read_b64_tr_b16 a[112:113], v14 offset:32768
ds_read_b64_tr_b16 a[114:115], v14 offset:34816
M v[56:59], a[160:163], a[80:83], v[56:59]
M v[56:59], a[164:167], a[84:87], v[56:59]
M v[60:63], a[164:167], a[92:95], v[60:63]
M v[60:63], a[160:163], a[88:91], v[60:63]
s_waitcnt lgkmcnt(8)
ds_read_b64_tr_b16 a[120:121], v15 offset:32768
ds_read_b64_tr_b16 a[122:123], v15 offset:34816
M v[64:67], a[168:171], a[32:35], v[64:67]
M v[64:67], a[172:175], a[36:39], v[64:67]
ds_read_b128 a[184:187], v10 offset:6144
ds_read_b128 a[188:191], v11 offset:6144
M v[68:71], a[172:175], a[44:47], v[68:71]
M v[68:71], a[168:171], a[40:43], v[68:71]
ds_read_b64_tr_b16 a[128:129], v16 offset:32768
ds_read_b64_tr_b16 a[130:131], v16 offset:34816
M v[72:75], a[168:171], a[48:51], v[72:75]
buffer_load_dwordx4 v5, s[8:11], s23 offen offset:3072 lds
M v[72:75], a[172:175], a[52:55], v[72:75]
M v[76:79], a[172:175], a[60:63], v[76:79]
M v[76:79], a[168:171], a[56:59], v[76:79]
ds_read_b64_tr_b16 a[136:137], v17 offset:32768
ds_read_b64_tr_b16 a[138:139], v17 offset:34816
M v[80:83], a[168:171], a[64:67], v[80:83]
M v[80:83], a[172:175], a[68:71], v[80:83]
M v[84:87], a[172:175], a[76:79], v[84:87]
M v[84:87], a[168:171], a[72:75], v[84:87]
ds_read_b64_tr_b16 a[144:145], v18 offset:32768
ds_read_b64_tr_b16 a[146:147], v18 offset:34816
M v[88:91], a[168:171], a[80:83], v[88:91]
M v[88:91], a[172:175], a[84:87], v[88:91]
M v[92:95], a[172:175], a[92:95], v[92:95]
M v[92:95], a[168:171], a[88:91], v[92:95]
s_waitcnt lgkmcnt(15)
ds_read_b64_tr_b16 a[152:153], v19 offset:32768
ds_read_b64_tr_b16 a[154:155], v19 offset:34816
M v[96:99], a[176:179], a[32:35], v[96:99]
M v[96:99], a[180:183], a[36:39], v[96:99]
M v[100:103], a[180:183], a[44:47], v[100:103]
M v[100:103], a[176:179], a[40:43], v[100:103]
M v[104:107], a[176:179], a[48:51], v[104:107]
M v[104:107], a[180:183], a[52:55], v[104:107]
M v[108:111], a[180:183], a[60:63], v[108:111]
M v[108:111], a[176:179], a[56:59], v[108:111]
s_waitcnt vmcnt(4) lgkmcnt(0)
s_barrier
ds_read_b128 a[160:163], v10 offset:16384
ds_read_b128 a[164:167], v11 offset:16384
M v[112:115], a[176:179], a[64:67], v[112:115]
s_add_u32 m0, s29, 49152
s_add_u32 s3, s23, s31
buffer_load_dwordx4 v2, s[8:11], s3 offen offset:0 lds
M v[112:115], a[180:183], a[68:71], v[112:115]
M v[116:119], a[180:183], a[76:79], v[116:119]
buffer_load_dwordx4 v3, s[8:11], s3 offen offset:1024 lds
M v[116:119], a[176:179], a[72:75], v[116:119]
ds_read_b64_tr_b16 a[100:101], v12 offset:49152
ds_read_b64_tr_b16 a[102:103], v12 offset:51200
M v[120:123], a[176:179], a[80:83], v[120:123]
buffer_load_dwordx4 v4, s[8:11], s3 offen offset:2048 lds
M v[120:123], a[180:183], a[84:87], v[120:123]
M v[124:127], a[180:183], a[92:95], v[124:127]
buffer_load_dwordx4 v5, s[8:11], s3 offen offset:3072 lds
M v[124:127], a[176:179], a[88:91], v[124:127]
M v[128:131], a[184:187], a[32:35], v[128:131]
M v[128:131], a[188:191], a[36:39], v[128:131]
ds_read_b128 a[168:171], v10 offset:18432
ds_read_b128 a[172:175], v11 offset:18432
ds_read_b64_tr_b16 a[108:109], v13 offset:49152
ds_read_b64_tr_b16 a[110:111], v13 offset:51200
M v[132:135], a[188:191], a[44:47], v[132:135]
M v[132:135], a[184:187], a[40:43], v[132:135]
M v[136:139], a[184:187], a[48:51], v[136:139]
s_and_b32 s3, s2, 1
s_lshl_b32 s3, s3, 3
s_bfe_u32 s4, s2, 0x30003
s_add_u32 s26, s3, s4
M v[136:139], a[188:191], a[52:55], v[136:139]
s_bfe_u32 s3, s2, 0x20001
s_lshl_b32 s3, s3, 2
s_lshr_b32 s4, s2, 6
M v[140:143], a[188:191], a[60:63], v[140:143]
s_xor_b32 s4, s4, 2
s_add_u32 s27, s3, s4
s_lshl_b32 s23, s26, 18
M v[140:143], a[184:187], a[56:59], v[140:143]
ds_read_b64_tr_b16 a[116:117], v14 offset:49152
ds_read_b64_tr_b16 a[118:119], v14 offset:51200
s_sub_u32 s24, s23, 32768
s_max_i32 s24, s24, 0
s_lshl_b32 s25, s27, 7
s_add_u32 s3, s26, s27
M v[144:147], a[184:187], a[64:67], v[144:147]
s_and_b32 s3, s3, 0
s_mul_i32 s3, s3, 16
s_sub_u32 s31, 16, s3
M v[144:147], a[188:191], a[68:71], v[144:147]
s_mov_b32 s54, s31
s_movk_i32 s57, 128
s_mov_b32 s55, 4289069056
M v[148:151], a[188:191], a[76:79], v[148:151]
s_mov_b32 s56, 393216
s_lshl_b32 s4, s3, 7
s_add_u32 s23, s23, s4
M v[148:151], a[184:187], a[72:75], v[148:151]
s_add_u32 s24, s24, s4
s_mul_i32 s4, s3, 393216
s_add_u32 s25, s25, s4
s_mov_b64 s[8:9], s[44:45]
M v[152:155], a[184:187], a[80:83], v[152:155]
s_mov_b32 s10, 4194304
s_mov_b64 s[12:13], s[46:47]
s_mov_b32 s14, 6291456
M v[152:155], a[188:191], a[84:87], v[152:155]
ds_read_b64_tr_b16 a[124:125], v15 offset:49152
ds_read_b64_tr_b16 a[126:127], v15 offset:51200
s_mov_b64 s[36:37], s[90:91]
s_mov_b32 s38, 256
s_mov_b32 s39, 0x00020000
M v[156:159], a[188:191], a[92:95], v[156:159]
s_lshl_b32 s28, s20, 9
s_mul_i32 s30, s20, 6144
s_lshl_b32 s3, s20, 5
M v[156:159], a[184:187], a[88:91], v[156:159]
s_waitcnt lgkmcnt(10)
v_lshrrev_b32 v24, 3, v0
v_and_b32 v25, 7, v0
v_add_u32 v28, s3, v24
v_add_u32 v26, 0, v28
M v[160:163], a[160:163], a[32:35], v[160:163]
v_bfe_u32 v27, v26, 1, 3
v_xor_b32 v27, v27, v25
v_lshlrev_b32 v26, 11, v26
M v[160:163], a[164:167], a[36:39], v[160:163]
ds_read_b128 a[176:179], v10 offset:20480
ds_read_b128 a[180:183], v11 offset:20480
v_lshl_add_u32 v26, v27, 4, v26
v_subrev_u32 v2, 0, v26
v_add_u32 v26, 8, v28
M v[164:167], a[164:167], a[44:47], v[164:167]
v_bfe_u32 v27, v26, 1, 3
v_xor_b32 v27, v27, v25
v_lshlrev_b32 v26, 11, v26
v_lshl_add_u32 v26, v27, 4, v26
M v[164:167], a[160:163], a[40:43], v[164:167]
ds_read_b64_tr_b16 a[132:133], v16 offset:49152
ds_read_b64_tr_b16 a[134:135], v16 offset:51200
v_subrev_u32 v3, 1024, v26
v_add_u32 v26, 16, v28
v_bfe_u32 v27, v26, 1, 3
M v[168:171], a[160:163], a[48:51], v[168:171]
v_xor_b32 v27, v27, v25
v_lshlrev_b32 v26, 11, v26
v_lshl_add_u32 v26, v27, 4, v26
M v[168:171], a[164:167], a[52:55], v[168:171]
v_subrev_u32 v4, 2048, v26
v_add_u32 v26, 24, v28
v_bfe_u32 v27, v26, 1, 3
M v[172:175], a[164:167], a[60:63], v[172:175]
v_xor_b32 v27, v27, v25
v_lshlrev_b32 v26, 11, v26
v_lshl_add_u32 v26, v27, 4, v26
v_subrev_u32 v5, 3072, v26
M v[172:175], a[160:163], a[56:59], v[172:175]
s_lshl_b32 s3, s20, 2
v_lshrrev_b32 v26, 5, v0
v_add_u32 v26, s3, v26
M v[176:179], a[160:163], a[64:67], v[176:179]
v_bfe_u32 v29, v0, 2, 3
v_bfe_u32 v27, v26, 1, 3
v_xor_b32 v27, v27, v29
M v[176:179], a[164:167], a[68:71], v[176:179]
ds_read_b64_tr_b16 a[140:141], v17 offset:49152
ds_read_b64_tr_b16 a[142:143], v17 offset:51200
v_lshlrev_b32 v27, 4, v27
v_and_b32 v30, 3, v0
v_lshl_add_u32 v27, v30, 2, v27
M v[180:183], a[164:167], a[76:79], v[180:183]
v_lshl_add_u32 v20, v26, 11, v27
v_add_u32 v26, 2, v26
v_bfe_u32 v27, v26, 1, 3
v_xor_b32 v27, v27, v29
M v[180:183], a[160:163], a[72:75], v[180:183]
v_lshlrev_b32 v27, 4, v27
v_and_b32 v30, 3, v0
v_lshl_add_u32 v27, v30, 2, v27
M v[184:187], a[160:163], a[80:83], v[184:187]
v_lshl_add_u32 v23, v26, 11, v27
v_subrev_u32 v23, 256, v23
s_mul_i32 s3, s20, 48
M v[184:187], a[164:167], a[84:87], v[184:187]
v_add_u32 v28, s3, v24
v_add_u32 v26, 0, v28
v_mul_u32_u24 v27, 0xaaab, v26
v_lshrrev_b32 v27, 17, v27
M v[188:191], a[164:167], a[92:95], v[188:191]
v_lshrrev_b32 v29, 1, v27
v_and_b32 v29, 4, v29
v_and_or_b32 v27, v27, 2, v29
M v[188:191], a[160:163], a[88:91], v[188:191]
s_waitcnt lgkmcnt(12)
ds_read_b64_tr_b16 a[148:149], v18 offset:49152
ds_read_b64_tr_b16 a[150:151], v18 offset:51200
v_xor_b32 v27, v27, v25
v_lshlrev_b32 v26, 11, v26
v_lshl_add_u32 v26, v27, 4, v26
M v[192:195], a[168:171], a[32:35], v[192:195]
v_subrev_u32 v6, 0, v26
v_add_u32 v26, 8, v28
v_mul_u32_u24 v27, 0xaaab, v26
M v[192:195], a[172:175], a[36:39], v[192:195]
ds_read_b128 a[184:187], v10 offset:22528
ds_read_b128 a[188:191], v11 offset:22528
v_lshrrev_b32 v27, 17, v27
v_lshrrev_b32 v29, 1, v27
v_and_b32 v29, 4, v29
v_and_or_b32 v27, v27, 2, v29
M v[196:199], a[172:175], a[44:47], v[196:199]
v_xor_b32 v27, v27, v25
v_lshlrev_b32 v26, 11, v26
v_lshl_add_u32 v26, v27, 4, v26
M v[196:199], a[168:171], a[40:43], v[196:199]
v_subrev_u32 v7, 1024, v26
v_add_u32 v26, 16, v28
v_mul_u32_u24 v27, 0xaaab, v26
M v[200:203], a[168:171], a[48:51], v[200:203]
v_lshrrev_b32 v27, 17, v27
v_lshrrev_b32 v29, 1, v27
v_and_b32 v29, 4, v29
M v[200:203], a[172:175], a[52:55], v[200:203]
ds_read_b64_tr_b16 a[156:157], v19 offset:49152
ds_read_b64_tr_b16 a[158:159], v19 offset:51200
v_and_or_b32 v27, v27, 2, v29
v_xor_b32 v27, v27, v25
v_lshlrev_b32 v26, 11, v26
v_lshl_add_u32 v26, v27, 4, v26
M v[204:207], a[172:175], a[60:63], v[204:207]
v_subrev_u32 v8, 2048, v26
v_add_u32 v26, 24, v28
v_mul_u32_u24 v27, 0xaaab, v26
M v[204:207], a[168:171], a[56:59], v[204:207]
v_lshrrev_b32 v27, 17, v27
v_lshrrev_b32 v29, 1, v27
v_and_b32 v29, 4, v29
M v[208:211], a[168:171], a[64:67], v[208:211]
v_and_or_b32 v27, v27, 2, v29
v_xor_b32 v27, v27, v25
v_lshlrev_b32 v26, 11, v26
v_lshl_add_u32 v26, v27, 4, v26
M v[208:211], a[172:175], a[68:71], v[208:211]
v_subrev_u32 v9, 3072, v26
v_add_u32 v26, 32, v28
v_mul_u32_u24 v27, 0xaaab, v26
M v[212:215], a[172:175], a[76:79], v[212:215]
v_lshrrev_b32 v27, 17, v27
v_lshrrev_b32 v29, 1, v27
v_and_b32 v29, 4, v29
M v[212:215], a[168:171], a[72:75], v[212:215]
v_and_or_b32 v27, v27, 2, v29
v_xor_b32 v27, v27, v25
v_lshlrev_b32 v26, 11, v26
M v[216:219], a[168:171], a[80:83], v[216:219]
v_lshl_add_u32 v26, v27, 4, v26
v_subrev_u32 v21, 0, v26
v_add_u32 v26, 40, v28
v_mul_u32_u24 v27, 0xaaab, v26
M v[216:219], a[172:175], a[84:87], v[216:219]
v_lshrrev_b32 v27, 17, v27
v_lshrrev_b32 v29, 1, v27
v_and_b32 v29, 4, v29
M v[220:223], a[172:175], a[92:95], v[220:223]
v_and_or_b32 v27, v27, 2, v29
v_xor_b32 v27, v27, v25
v_lshlrev_b32 v26, 11, v26
M v[220:223], a[168:171], a[88:91], v[220:223]
s_waitcnt lgkmcnt(10)
v_lshl_add_u32 v26, v27, 4, v26
v_subrev_u32 v22, 1024, v26
s_lshr_b32 s3, s53, 7
M v[224:227], a[176:179], a[32:35], v[224:227]
s_add_u32 s3, s3, s22
s_lshl_b32 s3, s3, 5
s_lshr_b32 s19, s52, 6
s_add_u32 s3, s3, s19
M v[224:227], a[180:183], a[36:39], v[224:227]
s_lshl_b32 s19, s21, 1
s_add_u32 s3, s3, s19
s_lshl_b32 s92, s3, 15
M v[228:231], a[180:183], a[44:47], v[228:231]
s_add_u32 s92, s92, 16384
s_add_u32 s93, s92, 32768
s_add_u32 s16, s50, 16777216
M v[228:231], a[176:179], a[40:43], v[228:231]
s_addc_u32 s17, s51, 0
s_mov_b32 s18, 33554432
s_mov_b32 s19, 0x00020000
M v[232:235], a[176:179], a[48:51], v[232:235]
M v[232:235], a[180:183], a[52:55], v[232:235]
M v[236:239], a[180:183], a[60:63], v[236:239]
M v[236:239], a[176:179], a[56:59], v[236:239]
s_waitcnt vmcnt(4) lgkmcnt(0)
s_barrier
ds_read_b128 a[160:163], v10 offset:32768
ds_read_b128 a[164:167], v11 offset:32768
M v[240:243], a[176:179], a[64:67], v[240:243]
s_add_u32 m0, s28, 131072
s_nop 0
buffer_load_dword v20, s[8:11], s24 offen lds
M v[240:243], a[180:183], a[68:71], v[240:243]
M v[244:247], a[180:183], a[76:79], v[244:247]
M v[244:247], a[176:179], a[72:75], v[244:247]
buffer_load_dword v23, s[8:11], s24 offen offset:256 lds
M v[248:251], a[176:179], a[80:83], v[248:251]
M v[248:251], a[180:183], a[84:87], v[248:251]
M v[252:255], a[180:183], a[92:95], v[252:255]
M v[252:255], a[176:179], a[88:91], v[252:255]
M a[0:3], a[184:187], a[32:35], a[0:3]
s_add_u32 m0, s29, 133120
s_nop 0
buffer_load_dwordx4 v2, s[8:11], s23 offen offset:0 lds
M a[0:3], a[188:191], a[36:39], a[0:3]
ds_read_b128 a[168:171], v10 offset:34816
ds_read_b128 a[172:175], v11 offset:34816
M a[4:7], a[188:191], a[44:47], a[4:7]
M a[4:7], a[184:187], a[40:43], a[4:7]
M a[8:11], a[184:187], a[48:51], a[8:11]
buffer_load_dwordx4 v3, s[8:11], s23 offen offset:1024 lds
M a[8:11], a[188:191], a[52:55], a[8:11]
M a[12:15], a[188:191], a[60:63], a[12:15]
M a[12:15], a[184:187], a[56:59], a[12:15]
M a[16:19], a[184:187], a[64:67], a[16:19]
buffer_load_dwordx4 v4, s[8:11], s23 offen offset:2048 lds
M a[16:19], a[188:191], a[68:71], a[16:19]
M a[20:23], a[188:191], a[76:79], a[20:23]
M a[20:23], a[184:187], a[72:75], a[20:23]
buffer_load_dwordx4 v5, s[8:11], s23 offen offset:3072 lds
M a[24:27], a[184:187], a[80:83], a[24:27]
M a[24:27], a[188:191], a[84:87], a[24:27]
M a[28:31], a[188:191], a[92:95], a[28:31]
M a[28:31], a[184:187], a[88:91], a[28:31]
s_waitcnt lgkmcnt(2)
M v[32:35], a[160:163], a[96:99], v[32:35]
s_sub_u32 s31, s31, 1
s_cmp_eq_u32 s31, 0
s_cselect_b32 s58, -1920, s57
s_add_u32 s23, s23, s58
s_add_u32 s24, s24, s58
M v[32:35], a[164:167], a[100:103], v[32:35]
ds_read_b128 a[176:179], v10 offset:36864
ds_read_b128 a[180:183], v11 offset:36864
M v[36:39], a[164:167], a[108:111], v[36:39]
M v[36:39], a[160:163], a[104:107], v[36:39]
M v[40:43], a[160:163], a[112:115], v[40:43]
M v[40:43], a[164:167], a[116:119], v[40:43]
s_add_u32 m0, s30, 65536
s_nop 0
buffer_load_dwordx4 v6, s[12:15], s25 offen offset:0 lds
M v[44:47], a[164:167], a[124:127], v[44:47]
M v[44:47], a[160:163], a[120:123], v[44:47]
M v[48:51], a[160:163], a[128:131], v[48:51]
M v[48:51], a[164:167], a[132:135], v[48:51]
buffer_load_dwordx4 v7, s[12:15], s25 offen offset:1024 lds
M v[52:55], a[164:167], a[140:143], v[52:55]
M v[52:55], a[160:163], a[136:139], v[52:55]
M v[56:59], a[160:163], a[144:147], v[56:59]
M v[56:59], a[164:167], a[148:151], v[56:59]
buffer_load_dwordx4 v8, s[12:15], s25 offen offset:2048 lds
M v[60:63], a[164:167], a[156:159], v[60:63]
M v[60:63], a[160:163], a[152:155], v[60:63]
s_waitcnt lgkmcnt(2)
M v[64:67], a[168:171], a[96:99], v[64:67]
M v[64:67], a[172:175], a[100:103], v[64:67]
ds_read_b128 a[184:187], v10 offset:38912
ds_read_b128 a[188:191], v11 offset:38912
M v[68:71], a[172:175], a[108:111], v[68:71]
M v[68:71], a[168:171], a[104:107], v[68:71]
buffer_load_dwordx4 v9, s[12:15], s25 offen offset:3072 lds
M v[72:75], a[168:171], a[112:115], v[72:75]
M v[72:75], a[172:175], a[116:119], v[72:75]
M v[76:79], a[172:175], a[124:127], v[76:79]
M v[76:79], a[168:171], a[120:123], v[76:79]
s_add_u32 m0, s30, 69632
s_nop 0
buffer_load_dwordx4 v21, s[12:15], s25 offen offset:0 lds
M v[80:83], a[168:171], a[128:131], v[80:83]
M v[80:83], a[172:175], a[132:135], v[80:83]
M v[84:87], a[172:175], a[140:143], v[84:87]
M v[84:87], a[168:171], a[136:139], v[84:87]
buffer_load_dwordx4 v22, s[12:15], s25 offen offset:1024 lds
M v[88:91], a[168:171], a[144:147], v[88:91]
M v[88:91], a[172:175], a[148:151], v[88:91]
M v[92:95], a[172:175], a[156:159], v[92:95]
M v[92:95], a[168:171], a[152:155], v[92:95]
s_waitcnt lgkmcnt(2)
M v[96:99], a[176:179], a[96:99], v[96:99]
s_sub_u32 s54, s54, 1
s_cmp_eq_u32 s54, 0
s_cselect_b32 s58, s55, s56
s_add_u32 s25, s25, s58
M v[96:99], a[180:183], a[100:103], v[96:99]
M v[100:103], a[180:183], a[108:111], v[100:103]
M v[100:103], a[176:179], a[104:107], v[100:103]
v_cvt_pk_bf16_f32 v32, v32, v33
v_cvt_pk_bf16_f32 v33, v34, v35
M v[104:107], a[176:179], a[112:115], v[104:107]
v_cvt_pk_bf16_f32 v34, v64, v65
v_cvt_pk_bf16_f32 v35, v66, v67
M v[104:107], a[180:183], a[116:119], v[104:107]
v_cvt_pk_bf16_f32 v64, v48, v49
M v[108:111], a[180:183], a[124:127], v[108:111]
v_cvt_pk_bf16_f32 v65, v50, v51
v_cvt_pk_bf16_f32 v66, v80, v81
M v[108:111], a[176:179], a[120:123], v[108:111]
s_waitcnt vmcnt(12) lgkmcnt(0)
s_barrier
ds_read_b128 a[160:163], v10 offset:49152
ds_read_b128 a[164:167], v11 offset:49152
v_cvt_pk_bf16_f32 v67, v82, v83
M v[112:115], a[176:179], a[128:131], v[112:115]
s_add_u32 m0, s28, 0
s_nop 0
buffer_load_dword v20, s[8:11], s24 offen lds
v_cvt_pk_bf16_f32 v48, v40, v41
v_cvt_pk_bf16_f32 v49, v42, v43
M v[112:115], a[180:183], a[132:135], v[112:115]
v_cvt_pk_bf16_f32 v50, v72, v73
v_cvt_pk_bf16_f32 v51, v74, v75
M v[116:119], a[180:183], a[140:143], v[116:119]
v_cvt_pk_bf16_f32 v80, v56, v57
M v[116:119], a[176:179], a[136:139], v[116:119]
buffer_load_dword v23, s[8:11], s24 offen offset:256 lds
v_cvt_pk_bf16_f32 v81, v58, v59
v_cvt_pk_bf16_f32 v82, v88, v89
M v[120:123], a[176:179], a[144:147], v[120:123]
v_cvt_pk_bf16_f32 v83, v90, v91
M v[120:123], a[180:183], a[148:151], v[120:123]
v_cvt_pk_bf16_f32 v40, v36, v37
v_cvt_pk_bf16_f32 v41, v38, v39
M v[124:127], a[180:183], a[156:159], v[124:127]
s_add_u32 m0, s29, 2048
s_nop 0
buffer_load_dwordx4 v2, s[8:11], s23 offen offset:0 lds
v_cvt_pk_bf16_f32 v42, v68, v69
v_cvt_pk_bf16_f32 v43, v70, v71
M v[124:127], a[176:179], a[152:155], v[124:127]
v_cvt_pk_bf16_f32 v72, v52, v53
M v[128:131], a[184:187], a[96:99], v[128:131]
v_cvt_pk_bf16_f32 v73, v54, v55
v_cvt_pk_bf16_f32 v74, v84, v85
M v[128:131], a[188:191], a[100:103], v[128:131]
ds_read_b128 a[168:171], v10 offset:51200
ds_read_b128 a[172:175], v11 offset:51200
v_cvt_pk_bf16_f32 v75, v86, v87
M v[132:135], a[188:191], a[108:111], v[132:135]
v_cvt_pk_bf16_f32 v56, v44, v45
v_cvt_pk_bf16_f32 v57, v46, v47
M v[132:135], a[184:187], a[104:107], v[132:135]
buffer_load_dwordx4 v3, s[8:11], s23 offen offset:1024 lds
v_cvt_pk_bf16_f32 v58, v76, v77
v_cvt_pk_bf16_f32 v59, v78, v79
M v[136:139], a[184:187], a[112:115], v[136:139]
v_cvt_pk_bf16_f32 v88, v60, v61
M v[136:139], a[188:191], a[116:119], v[136:139]
v_cvt_pk_bf16_f32 v89, v62, v63
v_cvt_pk_bf16_f32 v90, v92, v93
M v[140:143], a[188:191], a[124:127], v[140:143]
buffer_load_dwordx4 v4, s[8:11], s23 offen offset:2048 lds
v_cvt_pk_bf16_f32 v91, v94, v95
M v[140:143], a[184:187], a[120:123], v[140:143]
M v[144:147], a[184:187], a[128:131], v[144:147]
M v[144:147], a[188:191], a[132:135], v[144:147]
buffer_load_dwordx4 v5, s[8:11], s23 offen offset:3072 lds
M v[148:151], a[188:191], a[140:143], v[148:151]
s_add_u32 s94, s92, 0
buffer_store_dwordx4 v[32:35], v1, s[16:19], s94 offen offset:0 sc1
M v[148:151], a[184:187], a[136:139], v[148:151]
M v[152:155], a[184:187], a[144:147], v[152:155]
M v[152:155], a[188:191], a[148:151], v[152:155]
s_sub_u32 s31, s31, 1
s_cmp_eq_u32 s31, 0
s_cselect_b32 s58, -1920, s57
s_add_u32 s23, s23, s58
s_add_u32 s24, s24, s58
M v[156:159], a[188:191], a[156:159], v[156:159]
s_add_u32 s94, s92, 0
buffer_store_dwordx4 v[40:43], v1, s[16:19], s94 offen offset:1024 sc1
M v[156:159], a[184:187], a[152:155], v[156:159]
s_waitcnt lgkmcnt(2)
M v[160:163], a[160:163], a[96:99], v[160:163]
M v[160:163], a[164:167], a[100:103], v[160:163]
ds_read_b128 a[176:179], v10 offset:53248
ds_read_b128 a[180:183], v11 offset:53248
M v[164:167], a[164:167], a[108:111], v[164:167]
s_add_u32 s94, s92, 0
buffer_store_dwordx4 v[48:51], v1, s[16:19], s94 offen offset:2048 sc1
M v[164:167], a[160:163], a[104:107], v[164:167]
v_cvt_pk_bf16_f32 v96, v96, v97
v_cvt_pk_bf16_f32 v97, v98, v99
M v[168:171], a[160:163], a[112:115], v[168:171]
v_cvt_pk_bf16_f32 v98, v128, v129
v_cvt_pk_bf16_f32 v99, v130, v131
M v[168:171], a[164:167], a[116:119], v[168:171]
s_add_u32 m0, s30, 98304
s_nop 0
buffer_load_dwordx4 v6, s[12:15], s25 offen offset:0 lds
v_cvt_pk_bf16_f32 v128, v112, v113
M v[172:175], a[164:167], a[124:127], v[172:175]
s_add_u32 s94, s92, 0
buffer_store_dwordx4 v[56:59], v1, s[16:19], s94 offen offset:3072 sc1
v_cvt_pk_bf16_f32 v129, v114, v115
v_cvt_pk_bf16_f32 v130, v144, v145
M v[172:175], a[160:163], a[120:123], v[172:175]
v_cvt_pk_bf16_f32 v131, v146, v147
M v[176:179], a[160:163], a[128:131], v[176:179]
v_cvt_pk_bf16_f32 v112, v104, v105
v_cvt_pk_bf16_f32 v113, v106, v107
M v[176:179], a[164:167], a[132:135], v[176:179]
buffer_load_dwordx4 v7, s[12:15], s25 offen offset:1024 lds
v_cvt_pk_bf16_f32 v114, v136, v137
v_cvt_pk_bf16_f32 v115, v138, v139
M v[180:183], a[164:167], a[140:143], v[180:183]
s_add_u32 s94, s92, 4096
buffer_store_dwordx4 v[64:67], v1, s[16:19], s94 offen offset:0 sc1
v_cvt_pk_bf16_f32 v144, v120, v121
M v[180:183], a[160:163], a[136:139], v[180:183]
v_cvt_pk_bf16_f32 v145, v122, v123
v_cvt_pk_bf16_f32 v146, v152, v153
M v[184:187], a[160:163], a[144:147], v[184:187]
v_cvt_pk_bf16_f32 v147, v154, v155
M v[184:187], a[164:167], a[148:151], v[184:187]
buffer_load_dwordx4 v8, s[12:15], s25 offen offset:2048 lds
v_cvt_pk_bf16_f32 v104, v100, v101
v_cvt_pk_bf16_f32 v105, v102, v103
M v[188:191], a[164:167], a[156:159], v[188:191]
s_add_u32 s94, s92, 4096
buffer_store_dwordx4 v[72:75], v1, s[16:19], s94 offen offset:1024 sc1
v_cvt_pk_bf16_f32 v106, v132, v133
v_cvt_pk_bf16_f32 v107, v134, v135
M v[188:191], a[160:163], a[152:155], v[188:191]
s_waitcnt lgkmcnt(2)
v_cvt_pk_bf16_f32 v136, v116, v117
M v[192:195], a[168:171], a[96:99], v[192:195]
v_cvt_pk_bf16_f32 v137, v118, v119
v_cvt_pk_bf16_f32 v138, v148, v149
M v[192:195], a[172:175], a[100:103], v[192:195]
ds_read_b128 a[184:187], v10 offset:55296
ds_read_b128 a[188:191], v11 offset:55296
v_cvt_pk_bf16_f32 v139, v150, v151
M v[196:199], a[172:175], a[108:111], v[196:199]
s_add_u32 s94, s92, 4096
buffer_store_dwordx4 v[80:83], v1, s[16:19], s94 offen offset:2048 sc1
v_cvt_pk_bf16_f32 v120, v108, v109
v_cvt_pk_bf16_f32 v121, v110, v111
M v[196:199], a[168:171], a[104:107], v[196:199]
v_cvt_pk_bf16_f32 v122, v140, v141
v_cvt_pk_bf16_f32 v123, v142, v143
M v[200:203], a[168:171], a[112:115], v[200:203]
buffer_load_dwordx4 v9, s[12:15], s25 offen offset:3072 lds
v_cvt_pk_bf16_f32 v152, v124, v125
M v[200:203], a[172:175], a[116:119], v[200:203]
v_cvt_pk_bf16_f32 v153, v126, v127
v_cvt_pk_bf16_f32 v154, v156, v157
M v[204:207], a[172:175], a[124:127], v[204:207]
s_add_u32 s94, s92, 4096
buffer_store_dwordx4 v[88:91], v1, s[16:19], s94 offen offset:3072 sc1
v_cvt_pk_bf16_f32 v155, v158, v159
M v[204:207], a[168:171], a[120:123], v[204:207]
M v[208:211], a[168:171], a[128:131], v[208:211]
s_add_u32 m0, s30, 102400
s_nop 0
buffer_load_dwordx4 v21, s[12:15], s25 offen offset:0 lds
M v[208:211], a[172:175], a[132:135], v[208:211]
M v[212:215], a[172:175], a[140:143], v[212:215]
M v[212:215], a[168:171], a[136:139], v[212:215]
buffer_load_dwordx4 v22, s[12:15], s25 offen offset:1024 lds
M v[216:219], a[168:171], a[144:147], v[216:219]
s_add_u32 s94, s92, 8192
buffer_store_dwordx4 v[96:99], v1, s[16:19], s94 offen offset:0 sc1
M v[216:219], a[172:175], a[148:151], v[216:219]
M v[220:223], a[172:175], a[156:159], v[220:223]
M v[220:223], a[168:171], a[152:155], v[220:223]
s_waitcnt lgkmcnt(2)
M v[224:227], a[176:179], a[96:99], v[224:227]
s_sub_u32 s54, s54, 1
s_cmp_eq_u32 s54, 0
s_cselect_b32 s58, s55, s56
s_add_u32 s25, s25, s58
M v[224:227], a[180:183], a[100:103], v[224:227]
M v[228:231], a[180:183], a[108:111], v[228:231]
s_add_u32 s94, s92, 8192
buffer_store_dwordx4 v[104:107], v1, s[16:19], s94 offen offset:1024 sc1
M v[228:231], a[176:179], a[104:107], v[228:231]
v_cvt_pk_bf16_f32 v160, v160, v161
v_cvt_pk_bf16_f32 v161, v162, v163
M v[232:235], a[176:179], a[112:115], v[232:235]
v_cvt_pk_bf16_f32 v162, v192, v193
v_cvt_pk_bf16_f32 v163, v194, v195
M v[232:235], a[180:183], a[116:119], v[232:235]
v_cvt_pk_bf16_f32 v192, v176, v177
M v[236:239], a[180:183], a[124:127], v[236:239]
v_cvt_pk_bf16_f32 v193, v178, v179
v_cvt_pk_bf16_f32 v194, v208, v209
M v[236:239], a[176:179], a[120:123], v[236:239]
s_waitcnt vmcnt(63) lgkmcnt(0)
s_barrier
v_cvt_pk_bf16_f32 v195, v210, v211
M v[240:243], a[176:179], a[128:131], v[240:243]
s_add_u32 s94, s92, 8192
buffer_store_dwordx4 v[112:115], v1, s[16:19], s94 offen offset:2048 sc1
v_cvt_pk_bf16_f32 v176, v168, v169
v_cvt_pk_bf16_f32 v177, v170, v171
M v[240:243], a[180:183], a[132:135], v[240:243]
s_add_u32 m0, s28, 18432
s_nop 0
buffer_load_dword v20, s[8:11], s24 offen lds
v_cvt_pk_bf16_f32 v178, v200, v201
v_cvt_pk_bf16_f32 v179, v202, v203
M v[244:247], a[180:183], a[140:143], v[244:247]
v_cvt_pk_bf16_f32 v208, v184, v185
M v[244:247], a[176:179], a[136:139], v[244:247]
v_cvt_pk_bf16_f32 v209, v186, v187
v_cvt_pk_bf16_f32 v210, v216, v217
M v[248:251], a[176:179], a[144:147], v[248:251]
buffer_load_dword v23, s[8:11], s24 offen offset:256 lds
v_cvt_pk_bf16_f32 v211, v218, v219
M v[248:251], a[180:183], a[148:151], v[248:251]
v_cvt_pk_bf16_f32 v168, v164, v165
v_cvt_pk_bf16_f32 v169, v166, v167
M v[252:255], a[180:183], a[156:159], v[252:255]
s_add_u32 s94, s92, 8192
buffer_store_dwordx4 v[120:123], v1, s[16:19], s94 offen offset:3072 sc1
v_cvt_pk_bf16_f32 v170, v196, v197
v_cvt_pk_bf16_f32 v171, v198, v199
M v[252:255], a[176:179], a[152:155], v[252:255]
v_cvt_pk_bf16_f32 v200, v180, v181
M a[0:3], a[184:187], a[96:99], a[0:3]
v_cvt_pk_bf16_f32 v201, v182, v183
v_cvt_pk_bf16_f32 v202, v212, v213
M a[0:3], a[188:191], a[100:103], a[0:3]
s_add_u32 m0, s29, 20480
s_nop 0
buffer_load_dwordx4 v2, s[8:11], s23 offen offset:0 lds
v_cvt_pk_bf16_f32 v203, v214, v215
M a[4:7], a[188:191], a[108:111], a[4:7]
v_cvt_pk_bf16_f32 v184, v172, v173
v_cvt_pk_bf16_f32 v185, v174, v175
M a[4:7], a[184:187], a[104:107], a[4:7]
v_cvt_pk_bf16_f32 v186, v204, v205
v_cvt_pk_bf16_f32 v187, v206, v207
M a[8:11], a[184:187], a[112:115], a[8:11]
s_add_u32 s94, s92, 12288
buffer_store_dwordx4 v[128:131], v1, s[16:19], s94 offen offset:0 sc1
v_cvt_pk_bf16_f32 v216, v188, v189
M a[8:11], a[188:191], a[116:119], a[8:11]
buffer_load_dwordx4 v3, s[8:11], s23 offen offset:1024 lds
v_cvt_pk_bf16_f32 v217, v190, v191
v_cvt_pk_bf16_f32 v218, v220, v221
M a[12:15], a[188:191], a[124:127], a[12:15]
v_cvt_pk_bf16_f32 v219, v222, v223
M a[12:15], a[184:187], a[120:123], a[12:15]
M a[16:19], a[184:187], a[128:131], a[16:19]
buffer_load_dwordx4 v4, s[8:11], s23 offen offset:2048 lds
M a[16:19], a[188:191], a[132:135], a[16:19]
M a[20:23], a[188:191], a[140:143], a[20:23]
s_add_u32 s94, s92, 12288
buffer_store_dwordx4 v[136:139], v1, s[16:19], s94 offen offset:1024 sc1
M a[20:23], a[184:187], a[136:139], a[20:23]
M a[24:27], a[184:187], a[144:147], a[24:27]
buffer_load_dwordx4 v5, s[8:11], s23 offen offset:3072 lds
M a[24:27], a[188:191], a[148:151], a[24:27]
M a[28:31], a[188:191], a[156:159], a[28:31]
M a[28:31], a[184:187], a[152:155], a[28:31]
v_accvgpr_read_b32 v24, a0
v_accvgpr_read_b32 v25, a1
v_accvgpr_read_b32 v26, a2
v_accvgpr_read_b32 v27, a3
v_cvt_pk_bf16_f32 v224, v224, v225
v_cvt_pk_bf16_f32 v225, v226, v227
v_cvt_pk_bf16_f32 v226, v24, v25
v_cvt_pk_bf16_f32 v227, v26, v27
v_accvgpr_read_b32 v24, a16
v_accvgpr_read_b32 v25, a17
v_accvgpr_read_b32 v26, a18
v_accvgpr_read_b32 v27, a19
v_cvt_pk_bf16_f32 v36, v240, v241
v_cvt_pk_bf16_f32 v37, v242, v243
v_cvt_pk_bf16_f32 v38, v24, v25
v_cvt_pk_bf16_f32 v39, v26, v27
v_accvgpr_read_b32 v24, a24
v_accvgpr_read_b32 v25, a25
v_accvgpr_read_b32 v26, a26
v_accvgpr_read_b32 v27, a27
v_cvt_pk_bf16_f32 v52, v248, v249
v_cvt_pk_bf16_f32 v53, v250, v251
v_cvt_pk_bf16_f32 v54, v24, v25
v_cvt_pk_bf16_f32 v55, v26, v27
v_accvgpr_read_b32 v24, a8
v_accvgpr_read_b32 v25, a9
v_accvgpr_read_b32 v26, a10
v_accvgpr_read_b32 v27, a11
v_cvt_pk_bf16_f32 v240, v232, v233
v_cvt_pk_bf16_f32 v241, v234, v235
v_cvt_pk_bf16_f32 v242, v24, v25
v_cvt_pk_bf16_f32 v243, v26, v27
v_accvgpr_read_b32 v28, a4
v_accvgpr_read_b32 v29, a5
v_accvgpr_read_b32 v30, a6
v_accvgpr_read_b32 v31, a7
v_cvt_pk_bf16_f32 v232, v228, v229
v_cvt_pk_bf16_f32 v233, v230, v231
v_cvt_pk_bf16_f32 v234, v28, v29
v_cvt_pk_bf16_f32 v235, v30, v31
v_accvgpr_read_b32 v28, a12
v_accvgpr_read_b32 v29, a13
v_accvgpr_read_b32 v30, a14
v_accvgpr_read_b32 v31, a15
v_cvt_pk_bf16_f32 v248, v236, v237
v_cvt_pk_bf16_f32 v249, v238, v239
v_cvt_pk_bf16_f32 v250, v28, v29
v_cvt_pk_bf16_f32 v251, v30, v31
v_accvgpr_read_b32 v28, a20
v_accvgpr_read_b32 v29, a21
v_accvgpr_read_b32 v30, a22
v_accvgpr_read_b32 v31, a23
v_cvt_pk_bf16_f32 v44, v244, v245
v_cvt_pk_bf16_f32 v45, v246, v247
v_cvt_pk_bf16_f32 v46, v28, v29
v_cvt_pk_bf16_f32 v47, v30, v31
v_accvgpr_read_b32 v28, a28
v_accvgpr_read_b32 v29, a29
v_accvgpr_read_b32 v30, a30
v_accvgpr_read_b32 v31, a31
v_cvt_pk_bf16_f32 v60, v252, v253
v_cvt_pk_bf16_f32 v61, v254, v255
v_cvt_pk_bf16_f32 v62, v28, v29
v_cvt_pk_bf16_f32 v63, v30, v31
Lk1_b:
v_and_b32 v24, 15, v0
v_lshlrev_b32 v24, 7, v24
v_bfe_u32 v25, v0, 1, 3
v_lshrrev_b32 v26, 4, v0
v_xor_b32 v25, v25, v26
v_lshl_add_u32 v10, v25, 4, v24
v_xor_b32 v11, 64, v10
v_add_u32 v12, 131072, v10
v_add_u32 v13, 131072, v11
v_bfe_u32 v24, v0, 2, 2
v_lshl_add_u32 v29, v26, 3, v24
v_mul_u32_u24 v25, 384, v29
v_and_b32 v27, 1, v0
v_lshl_add_u32 v25, v27, 3, v25
v_add_u32 v25, 36864, v25
v_lshrrev_b32 v24, 1, v29
v_and_b32 v24, 4, v24
v_and_or_b32 v24, v29, 2, v24
v_bfe_u32 v26, v0, 1, 1
s_mul_i32 s4, s20, 3
s_add_u32 s3, s4, 0
s_and_b32 s5, s3, 3
s_lshl_b32 s5, s5, 1
s_lshr_b32 s3, s3, 2
s_lshl_b32 s3, s3, 7
v_add_u32 v27, s5, v26
v_xor_b32 v27, v27, v24
v_lshl_add_u32 v27, v27, 4, v25
v_add_u32 v14, s3, v27
v_add_u32 v17, 61440, v14
s_add_u32 s3, s4, 1
s_and_b32 s5, s3, 3
s_lshl_b32 s5, s5, 1
s_lshr_b32 s3, s3, 2
s_lshl_b32 s3, s3, 7
v_add_u32 v27, s5, v26
v_xor_b32 v27, v27, v24
v_lshl_add_u32 v27, v27, 4, v25
v_add_u32 v15, s3, v27
v_add_u32 v18, 61440, v15
s_add_u32 s3, s4, 2
s_and_b32 s5, s3, 3
s_lshl_b32 s5, s5, 1
s_lshr_b32 s3, s3, 2
s_lshl_b32 s3, s3, 7
v_add_u32 v27, s5, v26
v_xor_b32 v27, v27, v24
v_lshl_add_u32 v27, v27, 4, v25
v_add_u32 v16, s3, v27
v_add_u32 v19, 61440, v16
s_waitcnt vmcnt(11)
s_barrier
ds_read_b64_tr_b16 a[176:177], v14 offset:28672
ds_read_b64_tr_b16 a[178:179], v14 offset:30208
ds_read_b64_tr_b16 a[184:185], v15 offset:28672
ds_read_b64_tr_b16 a[186:187], v15 offset:30208
ds_read_b64_tr_b16 a[192:193], v16 offset:28672
ds_read_b64_tr_b16 a[194:195], v16 offset:30208
ds_read_b64_tr_b16 a[180:181], v14 offset:40960
ds_read_b64_tr_b16 a[182:183], v14 offset:42496
ds_read_b64_tr_b16 a[188:189], v15 offset:40960
ds_read_b64_tr_b16 a[190:191], v15 offset:42496
ds_read_b64_tr_b16 a[196:197], v16 offset:40960
ds_read_b64_tr_b16 a[198:199], v16 offset:42496
ds_read_b128 a[224:227], v12 offset:0
ds_read_b128 a[228:231], v13 offset:0
ds_read_b128 a[232:235], v12 offset:2048
ds_read_b128 a[236:239], v13 offset:2048
ds_read_b128 a[240:243], v12 offset:4096
ds_read_b128 a[244:247], v13 offset:4096
s_waitcnt lgkmcnt(0)
s_barrier
M a[68:71], a[176:179], a[224:227], 0
ds_read_b128 a[248:251], v12 offset:6144
ds_read_b128 a[252:255], v13 offset:6144
M a[68:71], a[180:183], a[228:231], a[68:71]
s_sub_u32 s31, s31, 1
s_cmp_eq_u32 s31, 0
s_cselect_b32 s58, -1920, s57
s_add_u32 s23, s23, s58
s_add_u32 s24, s24, s58
M a[72:75], a[188:191], a[228:231], 0
ds_read_b64_tr_b16 a[200:201], v17 offset:0
ds_read_b64_tr_b16 a[202:203], v17 offset:1536
M a[72:75], a[184:187], a[224:227], a[72:75]
s_add_u32 m0, s30, 36864
s_nop 0
buffer_load_dwordx4 v6, s[12:15], s25 offen offset:0 lds
M a[76:79], a[192:195], a[224:227], 0
M a[76:79], a[196:199], a[228:231], a[76:79]
buffer_load_dwordx4 v7, s[12:15], s25 offen offset:1024 lds
M a[80:83], a[180:183], a[236:239], 0
ds_read_b128 a[224:227], v12 offset:8192
ds_read_b128 a[228:231], v13 offset:8192
M a[80:83], a[176:179], a[232:235], a[80:83]
M a[84:87], a[184:187], a[232:235], 0
ds_read_b64_tr_b16 a[208:209], v18 offset:0
ds_read_b64_tr_b16 a[210:211], v18 offset:1536
M a[84:87], a[188:191], a[236:239], a[84:87]
buffer_load_dwordx4 v8, s[12:15], s25 offen offset:2048 lds
M a[88:91], a[196:199], a[236:239], 0
M a[88:91], a[192:195], a[232:235], a[88:91]
buffer_load_dwordx4 v9, s[12:15], s25 offen offset:3072 lds
M a[92:95], a[176:179], a[240:243], 0
ds_read_b128 a[232:235], v12 offset:10240
ds_read_b128 a[236:239], v13 offset:10240
M a[92:95], a[180:183], a[244:247], a[92:95]
M a[96:99], a[188:191], a[244:247], 0
ds_read_b64_tr_b16 a[216:217], v19 offset:0
ds_read_b64_tr_b16 a[218:219], v19 offset:1536
M a[96:99], a[184:187], a[240:243], a[96:99]
s_add_u32 m0, s30, 40960
s_nop 0
buffer_load_dwordx4 v21, s[12:15], s25 offen offset:0 lds
M a[100:103], a[192:195], a[240:243], 0
buffer_load_dwordx4 v22, s[12:15], s25 offen offset:1024 lds
M a[100:103], a[196:199], a[244:247], a[100:103]
s_waitcnt lgkmcnt(10)
M a[104:107], a[180:183], a[252:255], 0
ds_read_b128 a[240:243], v12 offset:12288
ds_read_b128 a[244:247], v13 offset:12288
M a[104:107], a[176:179], a[248:251], a[104:107]
s_sub_u32 s54, s54, 1
s_cmp_eq_u32 s54, 0
s_cselect_b32 s58, s55, s56
s_add_u32 s25, s25, s58
M a[108:111], a[184:187], a[248:251], 0
ds_read_b64_tr_b16 a[204:205], v17 offset:12288
ds_read_b64_tr_b16 a[206:207], v17 offset:13824
M a[108:111], a[188:191], a[252:255], a[108:111]
M a[112:115], a[196:199], a[252:255], 0
s_add_u32 m0, s30, 65536
s_nop 0
buffer_load_dwordx4 v6, s[12:15], s25 offen offset:0 lds
M a[112:115], a[192:195], a[248:251], a[112:115]
s_waitcnt lgkmcnt(10)
M a[116:119], a[176:179], a[224:227], 0
ds_read_b128 a[248:251], v12 offset:14336
ds_read_b128 a[252:255], v13 offset:14336
M a[116:119], a[180:183], a[228:231], a[116:119]
buffer_load_dwordx4 v7, s[12:15], s25 offen offset:1024 lds
M a[120:123], a[188:191], a[228:231], 0
ds_read_b64_tr_b16 a[212:213], v18 offset:12288
ds_read_b64_tr_b16 a[214:215], v18 offset:13824
M a[120:123], a[184:187], a[224:227], a[120:123]
M a[124:127], a[192:195], a[224:227], 0
buffer_load_dwordx4 v8, s[12:15], s25 offen offset:2048 lds
M a[124:127], a[196:199], a[228:231], a[124:127]
buffer_load_dwordx4 v9, s[12:15], s25 offen offset:3072 lds
s_waitcnt lgkmcnt(10)
M a[128:131], a[180:183], a[236:239], 0
ds_read_b128 a[224:227], v12 offset:16384
ds_read_b128 a[228:231], v13 offset:16384
M a[128:131], a[176:179], a[232:235], a[128:131]
M a[132:135], a[184:187], a[232:235], 0
ds_read_b64_tr_b16 a[220:221], v19 offset:12288
ds_read_b64_tr_b16 a[222:223], v19 offset:13824
M a[132:135], a[188:191], a[236:239], a[132:135]
s_add_u32 m0, s30, 69632
s_nop 0
buffer_load_dwordx4 v21, s[12:15], s25 offen offset:0 lds
M a[136:139], a[196:199], a[236:239], 0
M a[136:139], a[192:195], a[232:235], a[136:139]
buffer_load_dwordx4 v22, s[12:15], s25 offen offset:1024 lds
s_waitcnt lgkmcnt(10)
M a[140:143], a[176:179], a[240:243], 0
M a[140:143], a[180:183], a[244:247], a[140:143]
s_sub_u32 s54, s54, 1
s_cmp_eq_u32 s54, 0
s_cselect_b32 s58, s55, s56
s_add_u32 s25, s25, s58
M a[144:147], a[188:191], a[244:247], 0
M a[144:147], a[184:187], a[240:243], a[144:147]
M a[148:151], a[192:195], a[240:243], 0
s_waitcnt vmcnt(6) lgkmcnt(0)
s_barrier
ds_read_b128 a[232:235], v10 offset:0
ds_read_b128 a[236:239], v11 offset:0
M a[148:151], a[196:199], a[244:247], a[148:151]
s_add_u32 m0, s28, 131072
s_nop 0
buffer_load_dword v20, s[8:11], s24 offen lds
M a[152:155], a[180:183], a[252:255], 0
ds_read_b128 a[240:243], v10 offset:2048
ds_read_b128 a[244:247], v11 offset:2048
M a[152:155], a[176:179], a[248:251], a[152:155]
M a[156:159], a[184:187], a[248:251], 0
buffer_load_dword v23, s[8:11], s24 offen offset:256 lds
M a[156:159], a[188:191], a[252:255], a[156:159]
M a[160:163], a[196:199], a[252:255], 0
M a[160:163], a[192:195], a[248:251], a[160:163]
s_add_u32 m0, s29, 133120
s_nop 0
buffer_load_dwordx4 v2, s[8:11], s23 offen offset:0 lds
M a[164:167], a[176:179], a[224:227], 0
ds_read_b128 a[248:251], v10 offset:4096
ds_read_b128 a[252:255], v11 offset:4096
M a[164:167], a[180:183], a[228:231], a[164:167]
M a[168:171], a[188:191], a[228:231], 0
M a[168:171], a[184:187], a[224:227], a[168:171]
buffer_load_dwordx4 v3, s[8:11], s23 offen offset:1024 lds
M a[172:175], a[192:195], a[224:227], 0
M a[172:175], a[196:199], a[228:231], a[172:175]
s_waitcnt lgkmcnt(4)
M a[68:71], a[200:203], a[232:235], a[68:71]
ds_read_b128 a[224:227], v10 offset:6144
ds_read_b128 a[228:231], v11 offset:6144
M a[68:71], a[204:207], a[236:239], a[68:71]
buffer_load_dwordx4 v4, s[8:11], s23 offen offset:2048 lds
M a[72:75], a[212:215], a[236:239], a[72:75]
ds_read_b64_tr_b16 a[176:177], v14 offset:0
ds_read_b64_tr_b16 a[178:179], v14 offset:1536
M a[72:75], a[208:211], a[232:235], a[72:75]
buffer_load_dwordx4 v5, s[8:11], s23 offen offset:3072 lds
M a[76:79], a[216:219], a[232:235], a[76:79]
M a[76:79], a[220:223], a[236:239], a[76:79]
s_sub_u32 s31, s31, 1
s_cmp_eq_u32 s31, 0
s_cselect_b32 s58, -1920, s57
s_add_u32 s23, s23, s58
s_add_u32 s24, s24, s58
s_waitcnt lgkmcnt(6)
M a[80:83], a[204:207], a[244:247], a[80:83]
ds_read_b128 a[232:235], v10 offset:8192
ds_read_b128 a[236:239], v11 offset:8192
M a[80:83], a[200:203], a[240:243], a[80:83]
M a[84:87], a[208:211], a[240:243], a[84:87]
ds_read_b64_tr_b16 a[184:185], v15 offset:0
ds_read_b64_tr_b16 a[186:187], v15 offset:1536
M a[84:87], a[212:215], a[244:247], a[84:87]
s_add_u32 m0, s30, 98304
s_nop 0
buffer_load_dwordx4 v6, s[12:15], s25 offen offset:0 lds
M a[88:91], a[220:223], a[244:247], a[88:91]
M a[88:91], a[216:219], a[240:243], a[88:91]
buffer_load_dwordx4 v7, s[12:15], s25 offen offset:1024 lds
s_waitcnt lgkmcnt(8)
M a[92:95], a[200:203], a[248:251], a[92:95]
ds_read_b128 a[240:243], v10 offset:10240
ds_read_b128 a[244:247], v11 offset:10240
M a[92:95], a[204:207], a[252:255], a[92:95]
M a[96:99], a[212:215], a[252:255], a[96:99]
ds_read_b64_tr_b16 a[192:193], v16 offset:0
ds_read_b64_tr_b16 a[194:195], v16 offset:1536
M a[96:99], a[208:211], a[248:251], a[96:99]
buffer_load_dwordx4 v8, s[12:15], s25 offen offset:2048 lds
M a[100:103], a[216:219], a[248:251], a[100:103]
M a[100:103], a[220:223], a[252:255], a[100:103]
buffer_load_dwordx4 v9, s[12:15], s25 offen offset:3072 lds
s_waitcnt lgkmcnt(10)
M a[104:107], a[204:207], a[228:231], a[104:107]
ds_read_b128 a[248:251], v10 offset:12288
ds_read_b128 a[252:255], v11 offset:12288
M a[104:107], a[200:203], a[224:227], a[104:107]
M a[108:111], a[208:211], a[224:227], a[108:111]
ds_read_b64_tr_b16 a[180:181], v14 offset:12288
ds_read_b64_tr_b16 a[182:183], v14 offset:13824
M a[108:111], a[212:215], a[228:231], a[108:111]
s_add_u32 m0, s30, 102400
s_nop 0
buffer_load_dwordx4 v21, s[12:15], s25 offen offset:0 lds
M a[112:115], a[220:223], a[228:231], a[112:115]
M a[112:115], a[216:219], a[224:227], a[112:115]
buffer_load_dwordx4 v22, s[12:15], s25 offen offset:1024 lds
s_waitcnt lgkmcnt(10)
M a[116:119], a[200:203], a[232:235], a[116:119]
ds_read_b128 a[224:227], v10 offset:14336
ds_read_b128 a[228:231], v11 offset:14336
M a[116:119], a[204:207], a[236:239], a[116:119]
M a[120:123], a[212:215], a[236:239], a[120:123]
ds_read_b64_tr_b16 a[188:189], v15 offset:12288
ds_read_b64_tr_b16 a[190:191], v15 offset:13824
M a[120:123], a[208:211], a[232:235], a[120:123]
s_sub_u32 s54, s54, 1
s_cmp_eq_u32 s54, 0
s_cselect_b32 s58, s55, s56
s_add_u32 s25, s25, s58
M a[124:127], a[216:219], a[232:235], a[124:127]
M a[124:127], a[220:223], a[236:239], a[124:127]
s_add_u32 s94, s92, 12288
buffer_store_dwordx4 v[144:147], v1, s[16:19], s94 offen offset:2048 sc1
s_waitcnt lgkmcnt(10)
M a[128:131], a[204:207], a[244:247], a[128:131]
ds_read_b128 a[232:235], v10 offset:16384
ds_read_b128 a[236:239], v11 offset:16384
M a[128:131], a[200:203], a[240:243], a[128:131]
M a[132:135], a[208:211], a[240:243], a[132:135]
ds_read_b64_tr_b16 a[196:197], v16 offset:12288
ds_read_b64_tr_b16 a[198:199], v16 offset:13824
M a[132:135], a[212:215], a[244:247], a[132:135]
s_add_u32 s94, s92, 12288
buffer_store_dwordx4 v[152:155], v1, s[16:19], s94 offen offset:3072 sc1
M a[136:139], a[220:223], a[244:247], a[136:139]
M a[136:139], a[216:219], a[240:243], a[136:139]
s_add_u32 s94, s93, 0
buffer_store_dwordx4 v[160:163], v1, s[16:19], s94 offen offset:0 sc1
s_waitcnt lgkmcnt(10)
M a[140:143], a[200:203], a[248:251], a[140:143]
M a[140:143], a[204:207], a[252:255], a[140:143]
s_add_u32 s94, s93, 0
buffer_store_dwordx4 v[168:171], v1, s[16:19], s94 offen offset:1024 sc1
M a[144:147], a[212:215], a[252:255], a[144:147]
M a[144:147], a[208:211], a[248:251], a[144:147]
M a[148:151], a[216:219], a[248:251], a[148:151]
s_waitcnt vmcnt(16) lgkmcnt(0)
s_barrier
ds_read_b128 a[240:243], v10 offset:18432
ds_read_b128 a[244:247], v11 offset:18432
M a[148:151], a[220:223], a[252:255], a[148:151]
s_add_u32 m0, s28, 0
s_nop 0
buffer_load_dword v20, s[8:11], s24 offen lds
M a[152:155], a[204:207], a[228:231], a[152:155]
ds_read_b128 a[248:251], v10 offset:20480
ds_read_b128 a[252:255], v11 offset:20480
M a[152:155], a[200:203], a[224:227], a[152:155]
M a[156:159], a[208:211], a[224:227], a[156:159]
buffer_load_dword v23, s[8:11], s24 offen offset:256 lds
M a[156:159], a[212:215], a[228:231], a[156:159]
M a[160:163], a[220:223], a[228:231], a[160:163]
M a[160:163], a[216:219], a[224:227], a[160:163]
s_add_u32 m0, s29, 2048
s_nop 0
buffer_load_dwordx4 v2, s[8:11], s23 offen offset:0 lds
M a[164:167], a[200:203], a[232:235], a[164:167]
ds_read_b128 a[224:227], v10 offset:22528
ds_read_b128 a[228:231], v11 offset:22528
M a[164:167], a[204:207], a[236:239], a[164:167]
M a[168:171], a[212:215], a[236:239], a[168:171]
M a[168:171], a[208:211], a[232:235], a[168:171]
buffer_load_dwordx4 v3, s[8:11], s23 offen offset:1024 lds
M a[172:175], a[216:219], a[232:235], a[172:175]
M a[172:175], a[220:223], a[236:239], a[172:175]
s_waitcnt lgkmcnt(4)
M a[68:71], a[176:179], a[240:243], a[68:71]
ds_read_b128 a[232:235], v10 offset:24576
ds_read_b128 a[236:239], v11 offset:24576
M a[68:71], a[180:183], a[244:247], a[68:71]
buffer_load_dwordx4 v4, s[8:11], s23 offen offset:2048 lds
M a[72:75], a[188:191], a[244:247], a[72:75]
ds_read_b64_tr_b16 a[200:201], v14 offset:28672
ds_read_b64_tr_b16 a[202:203], v14 offset:30208
M a[72:75], a[184:187], a[240:243], a[72:75]
buffer_load_dwordx4 v5, s[8:11], s23 offen offset:3072 lds
M a[76:79], a[192:195], a[240:243], a[76:79]
M a[76:79], a[196:199], a[244:247], a[76:79]
s_sub_u32 s31, s31, 1
s_cmp_eq_u32 s31, 0
s_cselect_b32 s58, -1920, s57
s_add_u32 s23, s23, s58
s_add_u32 s24, s24, s58
s_waitcnt lgkmcnt(6)
M a[80:83], a[180:183], a[252:255], a[80:83]
ds_read_b128 a[240:243], v10 offset:26624
ds_read_b128 a[244:247], v11 offset:26624
M a[80:83], a[176:179], a[248:251], a[80:83]
M a[84:87], a[184:187], a[248:251], a[84:87]
ds_read_b64_tr_b16 a[208:209], v15 offset:28672
ds_read_b64_tr_b16 a[210:211], v15 offset:30208
M a[84:87], a[188:191], a[252:255], a[84:87]
s_add_u32 m0, s30, 36864
s_nop 0
buffer_load_dwordx4 v6, s[12:15], s25 offen offset:0 lds
M a[88:91], a[196:199], a[252:255], a[88:91]
M a[88:91], a[192:195], a[248:251], a[88:91]
buffer_load_dwordx4 v7, s[12:15], s25 offen offset:1024 lds
s_waitcnt lgkmcnt(8)
M a[92:95], a[176:179], a[224:227], a[92:95]
ds_read_b128 a[248:251], v10 offset:28672
ds_read_b128 a[252:255], v11 offset:28672
M a[92:95], a[180:183], a[228:231], a[92:95]
M a[96:99], a[188:191], a[228:231], a[96:99]
ds_read_b64_tr_b16 a[216:217], v16 offset:28672
ds_read_b64_tr_b16 a[218:219], v16 offset:30208
M a[96:99], a[184:187], a[224:227], a[96:99]
buffer_load_dwordx4 v8, s[12:15], s25 offen offset:2048 lds
M a[100:103], a[192:195], a[224:227], a[100:103]
M a[100:103], a[196:199], a[228:231], a[100:103]
buffer_load_dwordx4 v9, s[12:15], s25 offen offset:3072 lds
s_waitcnt lgkmcnt(10)
M a[104:107], a[180:183], a[236:239], a[104:107]
ds_read_b128 a[224:227], v10 offset:30720
ds_read_b128 a[228:231], v11 offset:30720
M a[104:107], a[176:179], a[232:235], a[104:107]
M a[108:111], a[184:187], a[232:235], a[108:111]
ds_read_b64_tr_b16 a[204:205], v14 offset:40960
ds_read_b64_tr_b16 a[206:207], v14 offset:42496
M a[108:111], a[188:191], a[236:239], a[108:111]
s_add_u32 m0, s30, 40960
s_nop 0
buffer_load_dwordx4 v21, s[12:15], s25 offen offset:0 lds
M a[112:115], a[196:199], a[236:239], a[112:115]
M a[112:115], a[192:195], a[232:235], a[112:115]
buffer_load_dwordx4 v22, s[12:15], s25 offen offset:1024 lds
s_waitcnt lgkmcnt(10)
M a[116:119], a[176:179], a[240:243], a[116:119]
ds_read_b128 a[232:235], v10 offset:32768
ds_read_b128 a[236:239], v11 offset:32768
M a[116:119], a[180:183], a[244:247], a[116:119]
M a[120:123], a[188:191], a[244:247], a[120:123]
ds_read_b64_tr_b16 a[212:213], v15 offset:40960
ds_read_b64_tr_b16 a[214:215], v15 offset:42496
M a[120:123], a[184:187], a[240:243], a[120:123]
s_sub_u32 s54, s54, 1
s_cmp_eq_u32 s54, 0
s_cselect_b32 s58, s55, s56
s_add_u32 s25, s25, s58
M a[124:127], a[192:195], a[240:243], a[124:127]
M a[124:127], a[196:199], a[244:247], a[124:127]
s_add_u32 s94, s93, 0
buffer_store_dwordx4 v[176:179], v1, s[16:19], s94 offen offset:2048 sc1
s_waitcnt lgkmcnt(10)
M a[128:131], a[180:183], a[252:255], a[128:131]
ds_read_b128 a[240:243], v10 offset:34816
ds_read_b128 a[244:247], v11 offset:34816
M a[128:131], a[176:179], a[248:251], a[128:131]
M a[132:135], a[184:187], a[248:251], a[132:135]
ds_read_b64_tr_b16 a[220:221], v16 offset:40960
ds_read_b64_tr_b16 a[222:223], v16 offset:42496
M a[132:135], a[188:191], a[252:255], a[132:135]
s_add_u32 s94, s93, 0
buffer_store_dwordx4 v[184:187], v1, s[16:19], s94 offen offset:3072 sc1
M a[136:139], a[196:199], a[252:255], a[136:139]
M a[136:139], a[192:195], a[248:251], a[136:139]
s_add_u32 s94, s93, 4096
buffer_store_dwordx4 v[192:195], v1, s[16:19], s94 offen offset:0 sc1
s_waitcnt lgkmcnt(10)
M a[140:143], a[176:179], a[224:227], a[140:143]
M a[140:143], a[180:183], a[228:231], a[140:143]
s_add_u32 s94, s93, 4096
buffer_store_dwordx4 v[200:203], v1, s[16:19], s94 offen offset:1024 sc1
M a[144:147], a[188:191], a[228:231], a[144:147]
M a[144:147], a[184:187], a[224:227], a[144:147]
M a[148:151], a[192:195], a[224:227], a[148:151]
s_waitcnt vmcnt(20) lgkmcnt(0)
s_barrier
ds_read_b128 a[248:251], v12 offset:0
ds_read_b128 a[252:255], v13 offset:0
M a[148:151], a[196:199], a[228:231], a[148:151]
s_add_u32 m0, s28, 18432
s_nop 0
buffer_load_dword v20, s[8:11], s24 offen lds
M a[152:155], a[180:183], a[236:239], a[152:155]
ds_read_b128 a[224:227], v12 offset:2048
ds_read_b128 a[228:231], v13 offset:2048
M a[152:155], a[176:179], a[232:235], a[152:155]
M a[156:159], a[184:187], a[232:235], a[156:159]
buffer_load_dword v23, s[8:11], s24 offen offset:256 lds
M a[156:159], a[188:191], a[236:239], a[156:159]
M a[160:163], a[196:199], a[236:239], a[160:163]
M a[160:163], a[192:195], a[232:235], a[160:163]
s_add_u32 m0, s29, 20480
s_nop 0
buffer_load_dwordx4 v2, s[8:11], s23 offen offset:0 lds
M a[164:167], a[176:179], a[240:243], a[164:167]
ds_read_b128 a[232:235], v12 offset:4096
ds_read_b128 a[236:239], v13 offset:4096
M a[164:167], a[180:183], a[244:247], a[164:167]
M a[168:171], a[188:191], a[244:247], a[168:171]
M a[168:171], a[184:187], a[240:243], a[168:171]
buffer_load_dwordx4 v3, s[8:11], s23 offen offset:1024 lds
M a[172:175], a[192:195], a[240:243], a[172:175]
M a[172:175], a[196:199], a[244:247], a[172:175]
s_waitcnt lgkmcnt(4)
M a[68:71], a[200:203], a[248:251], a[68:71]
ds_read_b128 a[240:243], v12 offset:6144
ds_read_b128 a[244:247], v13 offset:6144
M a[68:71], a[204:207], a[252:255], a[68:71]
buffer_load_dwordx4 v4, s[8:11], s23 offen offset:2048 lds
M a[72:75], a[212:215], a[252:255], a[72:75]
ds_read_b64_tr_b16 a[176:177], v17 offset:0
ds_read_b64_tr_b16 a[178:179], v17 offset:1536
M a[72:75], a[208:211], a[248:251], a[72:75]
buffer_load_dwordx4 v5, s[8:11], s23 offen offset:3072 lds
M a[76:79], a[216:219], a[248:251], a[76:79]
M a[76:79], a[220:223], a[252:255], a[76:79]
s_sub_u32 s31, s31, 1
s_cmp_eq_u32 s31, 0
s_cselect_b32 s58, -1920, s57
s_add_u32 s23, s23, s58
s_add_u32 s24, s24, s58
s_waitcnt lgkmcnt(6)
M a[80:83], a[204:207], a[228:231], a[80:83]
ds_read_b128 a[248:251], v12 offset:8192
ds_read_b128 a[252:255], v13 offset:8192
M a[80:83], a[200:203], a[224:227], a[80:83]
M a[84:87], a[208:211], a[224:227], a[84:87]
ds_read_b64_tr_b16 a[184:185], v18 offset:0
ds_read_b64_tr_b16 a[186:187], v18 offset:1536
M a[84:87], a[212:215], a[228:231], a[84:87]
s_add_u32 m0, s30, 65536
s_nop 0
buffer_load_dwordx4 v6, s[12:15], s25 offen offset:0 lds
M a[88:91], a[220:223], a[228:231], a[88:91]
M a[88:91], a[216:219], a[224:227], a[88:91]
buffer_load_dwordx4 v7, s[12:15], s25 offen offset:1024 lds
s_waitcnt lgkmcnt(8)
M a[92:95], a[200:203], a[232:235], a[92:95]
ds_read_b128 a[224:227], v12 offset:10240
ds_read_b128 a[228:231], v13 offset:10240
M a[92:95], a[204:207], a[236:239], a[92:95]
M a[96:99], a[212:215], a[236:239], a[96:99]
ds_read_b64_tr_b16 a[192:193], v19 offset:0
ds_read_b64_tr_b16 a[194:195], v19 offset:1536
M a[96:99], a[208:211], a[232:235], a[96:99]
buffer_load_dwordx4 v8, s[12:15], s25 offen offset:2048 lds
M a[100:103], a[216:219], a[232:235], a[100:103]
M a[100:103], a[220:223], a[236:239], a[100:103]
buffer_load_dwordx4 v9, s[12:15], s25 offen offset:3072 lds
s_waitcnt lgkmcnt(10)
M a[104:107], a[204:207], a[244:247], a[104:107]
ds_read_b128 a[232:235], v12 offset:12288
ds_read_b128 a[236:239], v13 offset:12288
M a[104:107], a[200:203], a[240:243], a[104:107]
M a[108:111], a[208:211], a[240:243], a[108:111]
ds_read_b64_tr_b16 a[180:181], v17 offset:12288
ds_read_b64_tr_b16 a[182:183], v17 offset:13824
M a[108:111], a[212:215], a[244:247], a[108:111]
s_add_u32 m0, s30, 69632
s_nop 0
buffer_load_dwordx4 v21, s[12:15], s25 offen offset:0 lds
M a[112:115], a[220:223], a[244:247], a[112:115]
M a[112:115], a[216:219], a[240:243], a[112:115]
buffer_load_dwordx4 v22, s[12:15], s25 offen offset:1024 lds
s_waitcnt lgkmcnt(10)
M a[116:119], a[200:203], a[248:251], a[116:119]
ds_read_b128 a[240:243], v12 offset:14336
ds_read_b128 a[244:247], v13 offset:14336
M a[116:119], a[204:207], a[252:255], a[116:119]
M a[120:123], a[212:215], a[252:255], a[120:123]
ds_read_b64_tr_b16 a[188:189], v18 offset:12288
ds_read_b64_tr_b16 a[190:191], v18 offset:13824
M a[120:123], a[208:211], a[248:251], a[120:123]
s_sub_u32 s54, s54, 1
s_cmp_eq_u32 s54, 0
s_cselect_b32 s58, s55, s56
s_add_u32 s25, s25, s58
M a[124:127], a[216:219], a[248:251], a[124:127]
M a[124:127], a[220:223], a[252:255], a[124:127]
s_add_u32 s94, s93, 4096
buffer_store_dwordx4 v[208:211], v1, s[16:19], s94 offen offset:2048 sc1
s_waitcnt lgkmcnt(10)
M a[128:131], a[204:207], a[228:231], a[128:131]
ds_read_b128 a[248:251], v12 offset:16384
ds_read_b128 a[252:255], v13 offset:16384
M a[128:131], a[200:203], a[224:227], a[128:131]
M a[132:135], a[208:211], a[224:227], a[132:135]
ds_read_b64_tr_b16 a[196:197], v19 offset:12288
ds_read_b64_tr_b16 a[198:199], v19 offset:13824
M a[132:135], a[212:215], a[228:231], a[132:135]
s_add_u32 s94, s93, 4096
buffer_store_dwordx4 v[216:219], v1, s[16:19], s94 offen offset:3072 sc1
M a[136:139], a[220:223], a[228:231], a[136:139]
M a[136:139], a[216:219], a[224:227], a[136:139]
s_add_u32 s94, s93, 8192
buffer_store_dwordx4 v[224:227], v1, s[16:19], s94 offen offset:0 sc1
s_waitcnt lgkmcnt(10)
M a[140:143], a[200:203], a[232:235], a[140:143]
M a[140:143], a[204:207], a[236:239], a[140:143]
s_add_u32 s94, s93, 8192
buffer_store_dwordx4 v[232:235], v1, s[16:19], s94 offen offset:1024 sc1
M a[144:147], a[212:215], a[236:239], a[144:147]
M a[144:147], a[208:211], a[232:235], a[144:147]
M a[148:151], a[216:219], a[232:235], a[148:151]
s_waitcnt vmcnt(20) lgkmcnt(0)
s_barrier
ds_read_b128 a[224:227], v10 offset:0
ds_read_b128 a[228:231], v11 offset:0
M a[148:151], a[220:223], a[236:239], a[148:151]
s_add_u32 m0, s28, 131072
s_nop 0
buffer_load_dword v20, s[8:11], s24 offen lds
M a[152:155], a[204:207], a[244:247], a[152:155]
ds_read_b128 a[232:235], v10 offset:2048
ds_read_b128 a[236:239], v11 offset:2048
M a[152:155], a[200:203], a[240:243], a[152:155]
M a[156:159], a[208:211], a[240:243], a[156:159]
buffer_load_dword v23, s[8:11], s24 offen offset:256 lds
M a[156:159], a[212:215], a[244:247], a[156:159]
M a[160:163], a[220:223], a[244:247], a[160:163]
M a[160:163], a[216:219], a[240:243], a[160:163]
s_add_u32 m0, s29, 133120
s_nop 0
buffer_load_dwordx4 v2, s[8:11], s23 offen offset:0 lds
M a[164:167], a[200:203], a[248:251], a[164:167]
ds_read_b128 a[240:243], v10 offset:4096
ds_read_b128 a[244:247], v11 offset:4096
M a[164:167], a[204:207], a[252:255], a[164:167]
M a[168:171], a[212:215], a[252:255], a[168:171]
M a[168:171], a[208:211], a[248:251], a[168:171]
buffer_load_dwordx4 v3, s[8:11], s23 offen offset:1024 lds
M a[172:175], a[216:219], a[248:251], a[172:175]
M a[172:175], a[220:223], a[252:255], a[172:175]
s_waitcnt lgkmcnt(4)
M a[68:71], a[176:179], a[224:227], a[68:71]
ds_read_b128 a[248:251], v10 offset:6144
ds_read_b128 a[252:255], v11 offset:6144
M a[68:71], a[180:183], a[228:231], a[68:71]
buffer_load_dwordx4 v4, s[8:11], s23 offen offset:2048 lds
M a[72:75], a[188:191], a[228:231], a[72:75]
ds_read_b64_tr_b16 a[200:201], v14 offset:0
ds_read_b64_tr_b16 a[202:203], v14 offset:1536
M a[72:75], a[184:187], a[224:227], a[72:75]
buffer_load_dwordx4 v5, s[8:11], s23 offen offset:3072 lds
M a[76:79], a[192:195], a[224:227], a[76:79]
M a[76:79], a[196:199], a[228:231], a[76:79]
s_sub_u32 s31, s31, 1
s_cmp_eq_u32 s31, 0
s_cselect_b32 s58, -1920, s57
s_add_u32 s23, s23, s58
s_add_u32 s24, s24, s58
s_waitcnt lgkmcnt(6)
M a[80:83], a[180:183], a[236:239], a[80:83]
ds_read_b128 a[224:227], v10 offset:8192
ds_read_b128 a[228:231], v11 offset:8192
M a[80:83], a[176:179], a[232:235], a[80:83]
M a[84:87], a[184:187], a[232:235], a[84:87]
ds_read_b64_tr_b16 a[208:209], v15 offset:0
ds_read_b64_tr_b16 a[210:211], v15 offset:1536
M a[84:87], a[188:191], a[236:239], a[84:87]
s_add_u32 m0, s30, 98304
s_nop 0
buffer_load_dwordx4 v6, s[12:15], s25 offen offset:0 lds
M a[88:91], a[196:199], a[236:239], a[88:91]
M a[88:91], a[192:195], a[232:235], a[88:91]
buffer_load_dwordx4 v7, s[12:15], s25 offen offset:1024 lds
s_waitcnt lgkmcnt(8)
M a[92:95], a[176:179], a[240:243], a[92:95]
ds_read_b128 a[232:235], v10 offset:10240
ds_read_b128 a[236:239], v11 offset:10240
M a[92:95], a[180:183], a[244:247], a[92:95]
M a[96:99], a[188:191], a[244:247], a[96:99]
ds_read_b64_tr_b16 a[216:217], v16 offset:0
ds_read_b64_tr_b16 a[218:219], v16 offset:1536
M a[96:99], a[184:187], a[240:243], a[96:99]
buffer_load_dwordx4 v8, s[12:15], s25 offen offset:2048 lds
M a[100:103], a[192:195], a[240:243], a[100:103]
M a[100:103], a[196:199], a[244:247], a[100:103]
buffer_load_dwordx4 v9, s[12:15], s25 offen offset:3072 lds
s_waitcnt lgkmcnt(10)
M a[104:107], a[180:183], a[252:255], a[104:107]
ds_read_b128 a[240:243], v10 offset:12288
ds_read_b128 a[244:247], v11 offset:12288
M a[104:107], a[176:179], a[248:251], a[104:107]
M a[108:111], a[184:187], a[248:251], a[108:111]
ds_read_b64_tr_b16 a[204:205], v14 offset:12288
ds_read_b64_tr_b16 a[206:207], v14 offset:13824
M a[108:111], a[188:191], a[252:255], a[108:111]
s_add_u32 m0, s30, 102400
s_nop 0
buffer_load_dwordx4 v21, s[12:15], s25 offen offset:0 lds
M a[112:115], a[196:199], a[252:255], a[112:115]
M a[112:115], a[192:195], a[248:251], a[112:115]
buffer_load_dwordx4 v22, s[12:15], s25 offen offset:1024 lds
s_waitcnt lgkmcnt(10)
M a[116:119], a[176:179], a[224:227], a[116:119]
ds_read_b128 a[248:251], v10 offset:14336
ds_read_b128 a[252:255], v11 offset:14336
M a[116:119], a[180:183], a[228:231], a[116:119]
M a[120:123], a[188:191], a[228:231], a[120:123]
ds_read_b64_tr_b16 a[212:213], v15 offset:12288
ds_read_b64_tr_b16 a[214:215], v15 offset:13824
M a[120:123], a[184:187], a[224:227], a[120:123]
s_sub_u32 s54, s54, 1
s_cmp_eq_u32 s54, 0
s_cselect_b32 s58, s55, s56
s_add_u32 s25, s25, s58
M a[124:127], a[192:195], a[224:227], a[124:127]
M a[124:127], a[196:199], a[228:231], a[124:127]
s_add_u32 s94, s93, 8192
buffer_store_dwordx4 v[240:243], v1, s[16:19], s94 offen offset:2048 sc1
s_waitcnt lgkmcnt(10)
M a[128:131], a[180:183], a[236:239], a[128:131]
ds_read_b128 a[224:227], v10 offset:16384
ds_read_b128 a[228:231], v11 offset:16384
M a[128:131], a[176:179], a[232:235], a[128:131]
M a[132:135], a[184:187], a[232:235], a[132:135]
ds_read_b64_tr_b16 a[220:221], v16 offset:12288
ds_read_b64_tr_b16 a[222:223], v16 offset:13824
M a[132:135], a[188:191], a[236:239], a[132:135]
s_add_u32 s94, s93, 8192
buffer_store_dwordx4 v[248:251], v1, s[16:19], s94 offen offset:3072 sc1
M a[136:139], a[196:199], a[236:239], a[136:139]
M a[136:139], a[192:195], a[232:235], a[136:139]
s_add_u32 s94, s93, 12288
buffer_store_dwordx4 v[36:39], v1, s[16:19], s94 offen offset:0 sc1
s_waitcnt lgkmcnt(10)
M a[140:143], a[176:179], a[240:243], a[140:143]
M a[140:143], a[180:183], a[244:247], a[140:143]
s_add_u32 s94, s93, 12288
buffer_store_dwordx4 v[44:47], v1, s[16:19], s94 offen offset:1024 sc1
M a[144:147], a[188:191], a[244:247], a[144:147]
M a[144:147], a[184:187], a[240:243], a[144:147]
M a[148:151], a[192:195], a[240:243], a[148:151]
s_waitcnt vmcnt(20) lgkmcnt(0)
s_barrier
ds_read_b128 a[232:235], v10 offset:18432
ds_read_b128 a[236:239], v11 offset:18432
M a[148:151], a[196:199], a[244:247], a[148:151]
s_add_u32 m0, s28, 0
s_nop 0
buffer_load_dword v20, s[8:11], s24 offen lds
M a[152:155], a[180:183], a[252:255], a[152:155]
ds_read_b128 a[240:243], v10 offset:20480
ds_read_b128 a[244:247], v11 offset:20480
M a[152:155], a[176:179], a[248:251], a[152:155]
M a[156:159], a[184:187], a[248:251], a[156:159]
buffer_load_dword v23, s[8:11], s24 offen offset:256 lds
M a[156:159], a[188:191], a[252:255], a[156:159]
M a[160:163], a[196:199], a[252:255], a[160:163]
M a[160:163], a[192:195], a[248:251], a[160:163]
s_add_u32 m0, s29, 2048
s_nop 0
buffer_load_dwordx4 v2, s[8:11], s23 offen offset:0 lds
M a[164:167], a[176:179], a[224:227], a[164:167]
ds_read_b128 a[248:251], v10 offset:22528
ds_read_b128 a[252:255], v11 offset:22528
M a[164:167], a[180:183], a[228:231], a[164:167]
M a[168:171], a[188:191], a[228:231], a[168:171]
M a[168:171], a[184:187], a[224:227], a[168:171]
buffer_load_dwordx4 v3, s[8:11], s23 offen offset:1024 lds
M a[172:175], a[192:195], a[224:227], a[172:175]
M a[172:175], a[196:199], a[228:231], a[172:175]
s_waitcnt lgkmcnt(4)
M a[68:71], a[200:203], a[232:235], a[68:71]
ds_read_b128 a[224:227], v10 offset:24576
ds_read_b128 a[228:231], v11 offset:24576
M a[68:71], a[204:207], a[236:239], a[68:71]
buffer_load_dwordx4 v4, s[8:11], s23 offen offset:2048 lds
M a[72:75], a[212:215], a[236:239], a[72:75]
ds_read_b64_tr_b16 a[176:177], v14 offset:28672
ds_read_b64_tr_b16 a[178:179], v14 offset:30208
M a[72:75], a[208:211], a[232:235], a[72:75]
M a[76:79], a[216:219], a[232:235], a[76:79]
buffer_load_dwordx4 v5, s[8:11], s23 offen offset:3072 lds
M a[76:79], a[220:223], a[236:239], a[76:79]
s_waitcnt lgkmcnt(6)
M a[80:83], a[204:207], a[244:247], a[80:83]
ds_read_b128 a[232:235], v10 offset:26624
ds_read_b128 a[236:239], v11 offset:26624
M a[80:83], a[200:203], a[240:243], a[80:83]
s_sub_u32 s31, s31, 1
s_cmp_eq_u32 s31, 0
s_cselect_b32 s58, -1920, s57
s_add_u32 s23, s23, s58
s_add_u32 s24, s24, s58
M a[84:87], a[208:211], a[240:243], a[84:87]
ds_read_b64_tr_b16 a[184:185], v15 offset:28672
ds_read_b64_tr_b16 a[186:187], v15 offset:30208
M a[84:87], a[212:215], a[244:247], a[84:87]
M a[88:91], a[220:223], a[244:247], a[88:91]
s_add_u32 m0, s30, 36864
s_nop 0
buffer_load_dwordx4 v6, s[12:15], s25 offen offset:0 lds
M a[88:91], a[216:219], a[240:243], a[88:91]
s_waitcnt lgkmcnt(8)
M a[92:95], a[200:203], a[248:251], a[92:95]
ds_read_b128 a[240:243], v10 offset:28672
ds_read_b128 a[244:247], v11 offset:28672
M a[92:95], a[204:207], a[252:255], a[92:95]
M a[96:99], a[212:215], a[252:255], a[96:99]
ds_read_b64_tr_b16 a[192:193], v16 offset:28672
ds_read_b64_tr_b16 a[194:195], v16 offset:30208
M a[96:99], a[208:211], a[248:251], a[96:99]
buffer_load_dwordx4 v7, s[12:15], s25 offen offset:1024 lds
M a[100:103], a[216:219], a[248:251], a[100:103]
M a[100:103], a[220:223], a[252:255], a[100:103]
buffer_load_dwordx4 v8, s[12:15], s25 offen offset:2048 lds
s_waitcnt lgkmcnt(10)
M a[104:107], a[204:207], a[228:231], a[104:107]
ds_read_b128 a[248:251], v10 offset:30720
ds_read_b128 a[252:255], v11 offset:30720
M a[104:107], a[200:203], a[224:227], a[104:107]
M a[108:111], a[208:211], a[224:227], a[108:111]
ds_read_b64_tr_b16 a[180:181], v14 offset:40960
ds_read_b64_tr_b16 a[182:183], v14 offset:42496
M a[108:111], a[212:215], a[228:231], a[108:111]
buffer_load_dwordx4 v9, s[12:15], s25 offen offset:3072 lds
M a[112:115], a[220:223], a[228:231], a[112:115]
M a[112:115], a[216:219], a[224:227], a[112:115]
s_add_u32 m0, s30, 40960
s_nop 0
buffer_load_dwordx4 v21, s[12:15], s25 offen offset:0 lds
s_waitcnt lgkmcnt(10)
M a[116:119], a[200:203], a[232:235], a[116:119]
ds_read_b128 a[224:227], v10 offset:32768
ds_read_b128 a[228:231], v11 offset:32768
M a[116:119], a[204:207], a[236:239], a[116:119]
M a[120:123], a[212:215], a[236:239], a[120:123]
ds_read_b64_tr_b16 a[188:189], v15 offset:40960
ds_read_b64_tr_b16 a[190:191], v15 offset:42496
M a[120:123], a[208:211], a[232:235], a[120:123]
M a[124:127], a[216:219], a[232:235], a[124:127]
buffer_load_dwordx4 v22, s[12:15], s25 offen offset:1024 lds
M a[124:127], a[220:223], a[236:239], a[124:127]
s_waitcnt lgkmcnt(10)
M a[128:131], a[204:207], a[244:247], a[128:131]
ds_read_b128 a[232:235], v10 offset:34816
ds_read_b128 a[236:239], v11 offset:34816
M a[128:131], a[200:203], a[240:243], a[128:131]
s_sub_u32 s54, s54, 1
s_cmp_eq_u32 s54, 0
s_cselect_b32 s58, s55, s56
s_add_u32 s25, s25, s58
M a[132:135], a[208:211], a[240:243], a[132:135]
ds_read_b64_tr_b16 a[196:197], v16 offset:40960
ds_read_b64_tr_b16 a[198:199], v16 offset:42496
M a[132:135], a[212:215], a[244:247], a[132:135]
M a[136:139], a[220:223], a[244:247], a[136:139]
s_add_u32 s94, s93, 12288
buffer_store_dwordx4 v[52:55], v1, s[16:19], s94 offen offset:2048 sc1
M a[136:139], a[216:219], a[240:243], a[136:139]
s_waitcnt lgkmcnt(10)
M a[140:143], a[200:203], a[248:251], a[140:143]
s_add_u32 s94, s93, 12288
buffer_store_dwordx4 v[60:63], v1, s[16:19], s94 offen offset:3072 sc1
M a[140:143], a[204:207], a[252:255], a[140:143]
M a[144:147], a[212:215], a[252:255], a[144:147]
M a[144:147], a[208:211], a[248:251], a[144:147]
M a[148:151], a[216:219], a[248:251], a[148:151]
s_waitcnt vmcnt(18) lgkmcnt(0)
s_barrier
ds_read_b128 a[240:243], v12 offset:0
ds_read_b128 a[244:247], v13 offset:0
M a[148:151], a[220:223], a[252:255], a[148:151]
s_add_u32 m0, s28, 18432
s_nop 0
buffer_load_dword v20, s[8:11], s24 offen lds
M a[152:155], a[204:207], a[228:231], a[152:155]
ds_read_b128 a[248:251], v12 offset:2048
ds_read_b128 a[252:255], v13 offset:2048
M a[152:155], a[200:203], a[224:227], a[152:155]
M a[156:159], a[208:211], a[224:227], a[156:159]
buffer_load_dword v23, s[8:11], s24 offen offset:256 lds
M a[156:159], a[212:215], a[228:231], a[156:159]
M a[160:163], a[220:223], a[228:231], a[160:163]
M a[160:163], a[216:219], a[224:227], a[160:163]
s_add_u32 m0, s29, 20480
s_nop 0
buffer_load_dwordx4 v2, s[8:11], s23 offen offset:0 lds
M a[164:167], a[200:203], a[232:235], a[164:167]
ds_read_b128 a[224:227], v12 offset:4096
ds_read_b128 a[228:231], v13 offset:4096
M a[164:167], a[204:207], a[236:239], a[164:167]
M a[168:171], a[212:215], a[236:239], a[168:171]
M a[168:171], a[208:211], a[232:235], a[168:171]
buffer_load_dwordx4 v3, s[8:11], s23 offen offset:1024 lds
M a[172:175], a[216:219], a[232:235], a[172:175]
M a[172:175], a[220:223], a[236:239], a[172:175]
s_waitcnt lgkmcnt(4)
M a[68:71], a[176:179], a[240:243], a[68:71]
ds_read_b128 a[232:235], v12 offset:6144
ds_read_b128 a[236:239], v13 offset:6144
M a[68:71], a[180:183], a[244:247], a[68:71]
buffer_load_dwordx4 v4, s[8:11], s23 offen offset:2048 lds
M a[72:75], a[188:191], a[244:247], a[72:75]
ds_read_b64_tr_b16 a[200:201], v17 offset:0
ds_read_b64_tr_b16 a[202:203], v17 offset:1536
M a[72:75], a[184:187], a[240:243], a[72:75]
M a[76:79], a[192:195], a[240:243], a[76:79]
buffer_load_dwordx4 v5, s[8:11], s23 offen offset:3072 lds
M a[76:79], a[196:199], a[244:247], a[76:79]
s_waitcnt lgkmcnt(6)
M a[80:83], a[180:183], a[252:255], a[80:83]
ds_read_b128 a[240:243], v12 offset:8192
ds_read_b128 a[244:247], v13 offset:8192
M a[80:83], a[176:179], a[248:251], a[80:83]
M a[84:87], a[184:187], a[248:251], a[84:87]
ds_read_b64_tr_b16 a[208:209], v18 offset:0
ds_read_b64_tr_b16 a[210:211], v18 offset:1536
M a[84:87], a[188:191], a[252:255], a[84:87]
s_sub_u32 s31, s31, 1
s_cmp_eq_u32 s31, 0
s_cselect_b32 s58, -1920, s57
s_add_u32 s23, s23, s58
s_add_u32 s24, s24, s58
M a[88:91], a[196:199], a[252:255], a[88:91]
M a[88:91], a[192:195], a[248:251], a[88:91]
s_waitcnt lgkmcnt(8)
M a[92:95], a[176:179], a[224:227], a[92:95]
ds_read_b128 a[248:251], v12 offset:10240
ds_read_b128 a[252:255], v13 offset:10240
M a[92:95], a[180:183], a[228:231], a[92:95]
s_add_u32 m0, s30, 65536
s_nop 0
buffer_load_dwordx4 v6, s[12:15], s25 offen offset:0 lds
M a[96:99], a[188:191], a[228:231], a[96:99]
ds_read_b64_tr_b16 a[216:217], v19 offset:0
ds_read_b64_tr_b16 a[218:219], v19 offset:1536
M a[96:99], a[184:187], a[224:227], a[96:99]
M a[100:103], a[192:195], a[224:227], a[100:103]
buffer_load_dwordx4 v7, s[12:15], s25 offen offset:1024 lds
M a[100:103], a[196:199], a[228:231], a[100:103]
s_waitcnt lgkmcnt(10)
M a[104:107], a[180:183], a[236:239], a[104:107]
ds_read_b128 a[224:227], v12 offset:12288
ds_read_b128 a[228:231], v13 offset:12288
M a[104:107], a[176:179], a[232:235], a[104:107]
M a[108:111], a[184:187], a[232:235], a[108:111]
ds_read_b64_tr_b16 a[204:205], v17 offset:12288
ds_read_b64_tr_b16 a[206:207], v17 offset:13824
M a[108:111], a[188:191], a[236:239], a[108:111]
buffer_load_dwordx4 v8, s[12:15], s25 offen offset:2048 lds
M a[112:115], a[196:199], a[236:239], a[112:115]
M a[112:115], a[192:195], a[232:235], a[112:115]
s_waitcnt lgkmcnt(10)
M a[116:119], a[176:179], a[240:243], a[116:119]
ds_read_b128 a[232:235], v12 offset:14336
ds_read_b128 a[236:239], v13 offset:14336
M a[116:119], a[180:183], a[244:247], a[116:119]
buffer_load_dwordx4 v9, s[12:15], s25 offen offset:3072 lds
M a[120:123], a[188:191], a[244:247], a[120:123]
ds_read_b64_tr_b16 a[212:213], v18 offset:12288
ds_read_b64_tr_b16 a[214:215], v18 offset:13824
M a[120:123], a[184:187], a[240:243], a[120:123]
M a[124:127], a[192:195], a[240:243], a[124:127]
s_add_u32 m0, s30, 69632
s_nop 0
buffer_load_dwordx4 v21, s[12:15], s25 offen offset:0 lds
M a[124:127], a[196:199], a[244:247], a[124:127]
s_waitcnt lgkmcnt(10)
M a[128:131], a[180:183], a[252:255], a[128:131]
ds_read_b128 a[240:243], v12 offset:16384
ds_read_b128 a[244:247], v13 offset:16384
M a[128:131], a[176:179], a[248:251], a[128:131]
M a[132:135], a[184:187], a[248:251], a[132:135]
ds_read_b64_tr_b16 a[220:221], v19 offset:12288
ds_read_b64_tr_b16 a[222:223], v19 offset:13824
M a[132:135], a[188:191], a[252:255], a[132:135]
buffer_load_dwordx4 v22, s[12:15], s25 offen offset:1024 lds
M a[136:139], a[196:199], a[252:255], a[136:139]
M a[136:139], a[192:195], a[248:251], a[136:139]
s_waitcnt lgkmcnt(10)
M a[140:143], a[176:179], a[224:227], a[140:143]
s_sub_u32 s54, s54, 1
s_cmp_eq_u32 s54, 0
s_cselect_b32 s58, s55, s56
s_add_u32 s25, s25, s58
M a[140:143], a[180:183], a[228:231], a[140:143]
M a[144:147], a[188:191], a[228:231], a[144:147]
M a[144:147], a[184:187], a[224:227], a[144:147]
M a[148:151], a[192:195], a[224:227], a[148:151]
s_waitcnt vmcnt(12) lgkmcnt(0)
s_barrier
ds_read_b128 a[248:251], v10 offset:0
ds_read_b128 a[252:255], v11 offset:0
s_cmp_lg_u32 s101, 0
s_cbranch_scc1 Lk1_arr
v_mov_b32 v127, 1
s_and_b32 s41, s2, 128
s_mov_b64 exec, 1
buffer_atomic_add v127, off, s[36:39], s41 sc1
s_mov_b64 exec, -1
Lk1_arr:
M a[148:151], a[196:199], a[228:231], a[148:151]
s_add_u32 m0, s28, 131072
s_nop 0
buffer_load_dword v20, s[8:11], s24 offen lds
M a[152:155], a[180:183], a[236:239], a[152:155]
ds_read_b128 a[224:227], v10 offset:2048
ds_read_b128 a[228:231], v11 offset:2048
M a[152:155], a[176:179], a[232:235], a[152:155]
M a[156:159], a[184:187], a[232:235], a[156:159]
buffer_load_dword v23, s[8:11], s24 offen offset:256 lds
M a[156:159], a[188:191], a[236:239], a[156:159]
M a[160:163], a[196:199], a[236:239], a[160:163]
M a[160:163], a[192:195], a[232:235], a[160:163]
s_add_u32 m0, s29, 133120
s_nop 0
buffer_load_dwordx4 v2, s[8:11], s23 offen offset:0 lds
M a[164:167], a[176:179], a[240:243], a[164:167]
ds_read_b128 a[232:235], v10 offset:4096
ds_read_b128 a[236:239], v11 offset:4096
M a[164:167], a[180:183], a[244:247], a[164:167]
M a[168:171], a[188:191], a[244:247], a[168:171]
M a[168:171], a[184:187], a[240:243], a[168:171]
buffer_load_dwordx4 v3, s[8:11], s23 offen offset:1024 lds
M a[172:175], a[192:195], a[240:243], a[172:175]
M a[172:175], a[196:199], a[244:247], a[172:175]
s_waitcnt lgkmcnt(4)
M a[68:71], a[200:203], a[248:251], a[68:71]
ds_read_b128 a[240:243], v10 offset:6144
ds_read_b128 a[244:247], v11 offset:6144
M a[68:71], a[204:207], a[252:255], a[68:71]
buffer_load_dwordx4 v4, s[8:11], s23 offen offset:2048 lds
M a[72:75], a[212:215], a[252:255], a[72:75]
ds_read_b64_tr_b16 a[176:177], v14 offset:0
ds_read_b64_tr_b16 a[178:179], v14 offset:1536
M a[72:75], a[208:211], a[248:251], a[72:75]
M a[76:79], a[216:219], a[248:251], a[76:79]
buffer_load_dwordx4 v5, s[8:11], s23 offen offset:3072 lds
M a[76:79], a[220:223], a[252:255], a[76:79]
s_waitcnt lgkmcnt(6)
M a[80:83], a[204:207], a[228:231], a[80:83]
ds_read_b128 a[248:251], v10 offset:8192
ds_read_b128 a[252:255], v11 offset:8192
M a[80:83], a[200:203], a[224:227], a[80:83]
M a[84:87], a[208:211], a[224:227], a[84:87]
ds_read_b64_tr_b16 a[184:185], v15 offset:0
ds_read_b64_tr_b16 a[186:187], v15 offset:1536
M a[84:87], a[212:215], a[228:231], a[84:87]
s_sub_u32 s31, s31, 1
s_cmp_eq_u32 s31, 0
s_cselect_b32 s58, -1920, s57
s_add_u32 s23, s23, s58
s_add_u32 s24, s24, s58
M a[88:91], a[220:223], a[228:231], a[88:91]
M a[88:91], a[216:219], a[224:227], a[88:91]
s_waitcnt lgkmcnt(8)
M a[92:95], a[200:203], a[232:235], a[92:95]
ds_read_b128 a[224:227], v10 offset:10240
ds_read_b128 a[228:231], v11 offset:10240
M a[92:95], a[204:207], a[236:239], a[92:95]
s_add_u32 m0, s30, 98304
s_nop 0
buffer_load_dwordx4 v6, s[12:15], s25 offen offset:0 lds
M a[96:99], a[212:215], a[236:239], a[96:99]
ds_read_b64_tr_b16 a[192:193], v16 offset:0
ds_read_b64_tr_b16 a[194:195], v16 offset:1536
M a[96:99], a[208:211], a[232:235], a[96:99]
M a[100:103], a[216:219], a[232:235], a[100:103]
buffer_load_dwordx4 v7, s[12:15], s25 offen offset:1024 lds
M a[100:103], a[220:223], a[236:239], a[100:103]
s_waitcnt lgkmcnt(10)
M a[104:107], a[204:207], a[244:247], a[104:107]
ds_read_b128 a[232:235], v10 offset:12288
ds_read_b128 a[236:239], v11 offset:12288
M a[104:107], a[200:203], a[240:243], a[104:107]
M a[108:111], a[208:211], a[240:243], a[108:111]
ds_read_b64_tr_b16 a[180:181], v14 offset:12288
ds_read_b64_tr_b16 a[182:183], v14 offset:13824
M a[108:111], a[212:215], a[244:247], a[108:111]
buffer_load_dwordx4 v8, s[12:15], s25 offen offset:2048 lds
M a[112:115], a[220:223], a[244:247], a[112:115]
M a[112:115], a[216:219], a[240:243], a[112:115]
s_waitcnt lgkmcnt(10)
M a[116:119], a[200:203], a[248:251], a[116:119]
ds_read_b128 a[240:243], v10 offset:14336
ds_read_b128 a[244:247], v11 offset:14336
M a[116:119], a[204:207], a[252:255], a[116:119]
buffer_load_dwordx4 v9, s[12:15], s25 offen offset:3072 lds
M a[120:123], a[212:215], a[252:255], a[120:123]
ds_read_b64_tr_b16 a[188:189], v15 offset:12288
ds_read_b64_tr_b16 a[190:191], v15 offset:13824
M a[120:123], a[208:211], a[248:251], a[120:123]
M a[124:127], a[216:219], a[248:251], a[124:127]
s_add_u32 m0, s30, 102400
s_nop 0
buffer_load_dwordx4 v21, s[12:15], s25 offen offset:0 lds
M a[124:127], a[220:223], a[252:255], a[124:127]
s_waitcnt lgkmcnt(10)
M a[128:131], a[204:207], a[228:231], a[128:131]
ds_read_b128 a[248:251], v10 offset:16384
ds_read_b128 a[252:255], v11 offset:16384
M a[128:131], a[200:203], a[224:227], a[128:131]
M a[132:135], a[208:211], a[224:227], a[132:135]
ds_read_b64_tr_b16 a[196:197], v16 offset:12288
ds_read_b64_tr_b16 a[198:199], v16 offset:13824
M a[132:135], a[212:215], a[228:231], a[132:135]
buffer_load_dwordx4 v22, s[12:15], s25 offen offset:1024 lds
M a[136:139], a[220:223], a[228:231], a[136:139]
M a[136:139], a[216:219], a[224:227], a[136:139]
s_waitcnt lgkmcnt(10)
M a[140:143], a[200:203], a[232:235], a[140:143]
s_sub_u32 s54, s54, 1
s_cmp_eq_u32 s54, 0
s_cselect_b32 s58, s55, s56
s_add_u32 s25, s25, s58
M a[140:143], a[204:207], a[236:239], a[140:143]
M a[144:147], a[212:215], a[236:239], a[144:147]
M a[144:147], a[208:211], a[232:235], a[144:147]
M a[148:151], a[216:219], a[232:235], a[148:151]
s_waitcnt vmcnt(12) lgkmcnt(0)
s_barrier
ds_read_b128 a[224:227], v10 offset:18432
ds_read_b128 a[228:231], v11 offset:18432
M a[148:151], a[220:223], a[236:239], a[148:151]
s_add_u32 m0, s28, 0
s_nop 0
buffer_load_dword v20, s[8:11], s24 offen lds
M a[152:155], a[204:207], a[244:247], a[152:155]
ds_read_b128 a[232:235], v10 offset:20480
ds_read_b128 a[236:239], v11 offset:20480
M a[152:155], a[200:203], a[240:243], a[152:155]
M a[156:159], a[208:211], a[240:243], a[156:159]
buffer_load_dword v23, s[8:11], s24 offen offset:256 lds
M a[156:159], a[212:215], a[244:247], a[156:159]
M a[160:163], a[220:223], a[244:247], a[160:163]
M a[160:163], a[216:219], a[240:243], a[160:163]
s_add_u32 m0, s29, 2048
s_nop 0
buffer_load_dwordx4 v2, s[8:11], s23 offen offset:0 lds
M a[164:167], a[200:203], a[248:251], a[164:167]
ds_read_b128 a[240:243], v10 offset:22528
ds_read_b128 a[244:247], v11 offset:22528
M a[164:167], a[204:207], a[252:255], a[164:167]
M a[168:171], a[212:215], a[252:255], a[168:171]
M a[168:171], a[208:211], a[248:251], a[168:171]
buffer_load_dwordx4 v3, s[8:11], s23 offen offset:1024 lds
M a[172:175], a[216:219], a[248:251], a[172:175]
M a[172:175], a[220:223], a[252:255], a[172:175]
s_waitcnt lgkmcnt(4)
M a[68:71], a[176:179], a[224:227], a[68:71]
ds_read_b128 a[248:251], v10 offset:24576
ds_read_b128 a[252:255], v11 offset:24576
v_mov_b32 v160, 0
v_mov_b32 v161, 0
M a[68:71], a[180:183], a[228:231], a[68:71]
buffer_load_dwordx4 v4, s[8:11], s23 offen offset:2048 lds
M a[72:75], a[188:191], a[228:231], a[72:75]
ds_read_b64_tr_b16 a[200:201], v14 offset:28672
ds_read_b64_tr_b16 a[202:203], v14 offset:30208
v_mov_b32 v162, 0
v_mov_b32 v163, 0
M a[72:75], a[184:187], a[224:227], a[72:75]
M a[76:79], a[192:195], a[224:227], a[76:79]
buffer_load_dwordx4 v5, s[8:11], s23 offen offset:3072 lds
v_mov_b32 v164, 0
v_mov_b32 v165, 0
M a[76:79], a[196:199], a[228:231], a[76:79]
s_waitcnt lgkmcnt(6)
M a[80:83], a[180:183], a[236:239], a[80:83]
ds_read_b128 a[224:227], v10 offset:26624
ds_read_b128 a[228:231], v11 offset:26624
v_mov_b32 v166, 0
v_mov_b32 v167, 0
M a[80:83], a[176:179], a[232:235], a[80:83]
M a[84:87], a[184:187], a[232:235], a[84:87]
ds_read_b64_tr_b16 a[208:209], v15 offset:28672
ds_read_b64_tr_b16 a[210:211], v15 offset:30208
M a[84:87], a[188:191], a[236:239], a[84:87]
s_sub_u32 s31, s31, 1
s_cmp_eq_u32 s31, 0
s_cselect_b32 s58, -1920, s57
s_add_u32 s23, s23, s58
s_add_u32 s24, s24, s58
v_mov_b32 v168, 0
v_mov_b32 v169, 0
M a[88:91], a[196:199], a[236:239], a[88:91]
M a[88:91], a[192:195], a[232:235], a[88:91]
s_waitcnt lgkmcnt(8)
v_mov_b32 v170, 0
v_mov_b32 v171, 0
M a[92:95], a[176:179], a[240:243], a[92:95]
ds_read_b128 a[232:235], v10 offset:28672
ds_read_b128 a[236:239], v11 offset:28672
M a[92:95], a[180:183], a[244:247], a[92:95]
s_add_u32 m0, s30, 36864
s_nop 0
buffer_load_dwordx4 v6, s[12:15], s25 offen offset:0 lds
v_mov_b32 v172, 0
v_mov_b32 v173, 0
M a[96:99], a[188:191], a[244:247], a[96:99]
ds_read_b64_tr_b16 a[216:217], v16 offset:28672
ds_read_b64_tr_b16 a[218:219], v16 offset:30208
M a[96:99], a[184:187], a[240:243], a[96:99]
v_mov_b32 v174, 0
v_mov_b32 v175, 0
M a[100:103], a[192:195], a[240:243], a[100:103]
buffer_load_dwordx4 v7, s[12:15], s25 offen offset:1024 lds
M a[100:103], a[196:199], a[244:247], a[100:103]
s_waitcnt lgkmcnt(10)
M a[104:107], a[180:183], a[252:255], a[104:107]
ds_read_b128 a[240:243], v10 offset:30720
ds_read_b128 a[244:247], v11 offset:30720
v_mov_b32 v176, 0
v_mov_b32 v177, 0
M a[104:107], a[176:179], a[248:251], a[104:107]
M a[108:111], a[184:187], a[248:251], a[108:111]
ds_read_b64_tr_b16 a[204:205], v14 offset:40960
ds_read_b64_tr_b16 a[206:207], v14 offset:42496
v_mov_b32 v178, 0
v_mov_b32 v179, 0
M a[108:111], a[188:191], a[252:255], a[108:111]
buffer_load_dwordx4 v8, s[12:15], s25 offen offset:2048 lds
M a[112:115], a[196:199], a[252:255], a[112:115]
v_mov_b32 v180, 0
v_mov_b32 v181, 0
M a[112:115], a[192:195], a[248:251], a[112:115]
s_waitcnt lgkmcnt(10)
M a[116:119], a[176:179], a[224:227], a[116:119]
ds_read_b128 a[248:251], v10 offset:32768
ds_read_b128 a[252:255], v11 offset:32768
v_mov_b32 v182, 0
v_mov_b32 v183, 0
M a[116:119], a[180:183], a[228:231], a[116:119]
buffer_load_dwordx4 v9, s[12:15], s25 offen offset:3072 lds
M a[120:123], a[188:191], a[228:231], a[120:123]
ds_read_b64_tr_b16 a[212:213], v15 offset:40960
ds_read_b64_tr_b16 a[214:215], v15 offset:42496
M a[120:123], a[184:187], a[224:227], a[120:123]
v_mov_b32 v184, 0
v_mov_b32 v185, 0
M a[124:127], a[192:195], a[224:227], a[124:127]
s_add_u32 m0, s30, 40960
s_nop 0
buffer_load_dwordx4 v21, s[12:15], s25 offen offset:0 lds
M a[124:127], a[196:199], a[228:231], a[124:127]
s_waitcnt lgkmcnt(10)
v_mov_b32 v186, 0
v_mov_b32 v187, 0
M a[128:131], a[180:183], a[236:239], a[128:131]
ds_read_b128 a[224:227], v10 offset:34816
ds_read_b128 a[228:231], v11 offset:34816
M a[128:131], a[176:179], a[232:235], a[128:131]
v_mov_b32 v188, 0
v_mov_b32 v189, 0
M a[132:135], a[184:187], a[232:235], a[132:135]
ds_read_b64_tr_b16 a[220:221], v16 offset:40960
ds_read_b64_tr_b16 a[222:223], v16 offset:42496
M a[132:135], a[188:191], a[236:239], a[132:135]
buffer_load_dwordx4 v22, s[12:15], s25 offen offset:1024 lds
v_mov_b32 v190, 0
v_mov_b32 v191, 0
M a[136:139], a[196:199], a[236:239], a[136:139]
M a[136:139], a[192:195], a[232:235], a[136:139]
s_waitcnt lgkmcnt(10)
M a[140:143], a[176:179], a[240:243], a[140:143]
s_sub_u32 s54, s54, 1
s_cmp_eq_u32 s54, 0
s_cselect_b32 s58, s55, s56
s_add_u32 s25, s25, s58
v_mov_b32 v192, 0
v_mov_b32 v193, 0
M a[140:143], a[180:183], a[244:247], a[140:143]
M a[144:147], a[188:191], a[244:247], a[144:147]
v_mov_b32 v194, 0
v_mov_b32 v195, 0
M a[144:147], a[184:187], a[240:243], a[144:147]
M a[148:151], a[192:195], a[240:243], a[148:151]
s_waitcnt vmcnt(12) lgkmcnt(0)
s_barrier
ds_read_b128 a[232:235], v12 offset:0
ds_read_b128 a[236:239], v13 offset:0
v_mov_b32 v196, 0
v_mov_b32 v197, 0
M a[148:151], a[196:199], a[244:247], a[148:151]
s_add_u32 m0, s28, 18432
s_nop 0
buffer_load_dword v20, s[8:11], s24 offen lds
M a[152:155], a[180:183], a[252:255], a[152:155]
ds_read_b128 a[240:243], v12 offset:2048
ds_read_b128 a[244:247], v13 offset:2048
v_mov_b32 v198, 0
v_mov_b32 v199, 0
M a[152:155], a[176:179], a[248:251], a[152:155]
M a[156:159], a[184:187], a[248:251], a[156:159]
buffer_load_dword v23, s[8:11], s24 offen offset:256 lds
M a[156:159], a[188:191], a[252:255], a[156:159]
v_mov_b32 v200, 0
v_mov_b32 v201, 0
M a[160:163], a[196:199], a[252:255], a[160:163]
M a[160:163], a[192:195], a[248:251], a[160:163]
s_add_u32 m0, s29, 20480
s_nop 0
buffer_load_dwordx4 v2, s[8:11], s23 offen offset:0 lds
v_mov_b32 v202, 0
v_mov_b32 v203, 0
M a[164:167], a[176:179], a[224:227], a[164:167]
ds_read_b128 a[248:251], v12 offset:4096
ds_read_b128 a[252:255], v13 offset:4096
M a[164:167], a[180:183], a[228:231], a[164:167]
v_mov_b32 v204, 0
v_mov_b32 v205, 0
M a[168:171], a[188:191], a[228:231], a[168:171]
M a[168:171], a[184:187], a[224:227], a[168:171]
buffer_load_dwordx4 v3, s[8:11], s23 offen offset:1024 lds
v_mov_b32 v206, 0
v_mov_b32 v207, 0
M a[172:175], a[192:195], a[224:227], a[172:175]
M a[172:175], a[196:199], a[228:231], a[172:175]
s_waitcnt lgkmcnt(4)
M a[68:71], a[200:203], a[232:235], a[68:71]
ds_read_b128 a[224:227], v12 offset:6144
ds_read_b128 a[228:231], v13 offset:6144
v_and_b32 v128, 15, v0
v_mul_u32_u24 v128, 400, v128
M a[68:71], a[204:207], a[236:239], a[68:71]
buffer_load_dwordx4 v4, s[8:11], s23 offen offset:2048 lds
M a[72:75], a[212:215], a[236:239], a[72:75]
ds_read_b64_tr_b16 a[176:177], v17 offset:0
ds_read_b64_tr_b16 a[178:179], v17 offset:1536
v_lshrrev_b32 v129, 4, v0
v_lshl_add_u32 v128, v129, 3, v128
M a[72:75], a[208:211], a[232:235], a[72:75]
M a[76:79], a[216:219], a[232:235], a[76:79]
buffer_load_dwordx4 v5, s[8:11], s23 offen offset:3072 lds
s_mul_i32 s3, s20, 96
s_add_u32 s3, s3, 98304
M a[76:79], a[220:223], a[236:239], a[76:79]
s_waitcnt lgkmcnt(6)
M a[80:83], a[204:207], a[244:247], a[80:83]
ds_read_b128 a[232:235], v12 offset:8192
ds_read_b128 a[236:239], v13 offset:8192
v_add_u32 v124, s3, v128
v_and_b32 v128, 15, v0
M a[80:83], a[200:203], a[240:243], a[80:83]
M a[84:87], a[208:211], a[240:243], a[84:87]
ds_read_b64_tr_b16 a[184:185], v18 offset:0
ds_read_b64_tr_b16 a[186:187], v18 offset:1536
v_lshrrev_b32 v129, 4, v0
s_add_u32 s3, s21, 16
M a[84:87], a[212:215], a[244:247], a[84:87]
s_sub_u32 s31, s31, 1
s_cmp_eq_u32 s31, 0
s_cselect_b32 s58, -1920, s57
s_add_u32 s23, s23, s58
s_add_u32 s24, s24, s58
M a[88:91], a[220:223], a[244:247], a[88:91]
v_lshl_add_u32 v130, v128, 1, s3
s_lshl_b32 s4, s22, 6
M a[88:91], a[216:219], a[240:243], a[88:91]
s_waitcnt lgkmcnt(8)
M a[92:95], a[200:203], a[248:251], a[92:95]
ds_read_b128 a[240:243], v12 offset:10240
ds_read_b128 a[244:247], v13 offset:10240
s_add_u32 s4, s4, 98304
v_mul_u32_u24 v120, 400, v130
M a[92:95], a[204:207], a[252:255], a[92:95]
s_add_u32 m0, s30, 65536
s_nop 0
buffer_load_dwordx4 v6, s[12:15], s25 offen offset:0 lds
M a[96:99], a[212:215], a[252:255], a[96:99]
ds_read_b64_tr_b16 a[192:193], v19 offset:0
ds_read_b64_tr_b16 a[194:195], v19 offset:1536
M a[96:99], a[208:211], a[248:251], a[96:99]
v_lshl_add_u32 v120, v129, 4, v120
v_add_u32 v120, s4, v120
M a[100:103], a[216:219], a[248:251], a[100:103]
buffer_load_dwordx4 v7, s[12:15], s25 offen offset:1024 lds
M a[100:103], a[220:223], a[252:255], a[100:103]
s_waitcnt lgkmcnt(10)
v_subrev_u32 v130, 32, v130
v_max_i32 v130, 0, v130
M a[104:107], a[204:207], a[228:231], a[104:107]
ds_read_b128 a[248:251], v12 offset:12288
ds_read_b128 a[252:255], v13 offset:12288
M a[104:107], a[200:203], a[224:227], a[104:107]
v_mul_u32_u24 v121, 400, v130
v_lshl_add_u32 v121, v129, 4, v121
M a[108:111], a[208:211], a[224:227], a[108:111]
ds_read_b64_tr_b16 a[180:181], v17 offset:12288
ds_read_b64_tr_b16 a[182:183], v17 offset:13824
M a[108:111], a[212:215], a[228:231], a[108:111]
buffer_load_dwordx4 v8, s[12:15], s25 offen offset:2048 lds
v_add_u32 v121, s4, v121
v_bfe_u32 v131, v0, 2, 2
M a[112:115], a[220:223], a[228:231], a[112:115]
M a[112:115], a[216:219], a[224:227], a[112:115]
s_waitcnt lgkmcnt(10)
v_lshl_add_u32 v131, v129, 2, v131
v_lshl_add_u32 v131, v131, 1, s3
M a[116:119], a[200:203], a[232:235], a[116:119]
ds_read_b128 a[224:227], v12 offset:14336
ds_read_b128 a[228:231], v13 offset:14336
M a[116:119], a[204:207], a[236:239], a[116:119]
buffer_load_dwordx4 v9, s[12:15], s25 offen offset:3072 lds
v_and_b32 v132, 3, v0
v_lshlrev_b32 v132, 3, v132
M a[120:123], a[212:215], a[236:239], a[120:123]
ds_read_b64_tr_b16 a[188:189], v18 offset:12288
ds_read_b64_tr_b16 a[190:191], v18 offset:13824
M a[120:123], a[208:211], a[232:235], a[120:123]
M a[124:127], a[216:219], a[232:235], a[124:127]
s_add_u32 m0, s30, 69632
s_nop 0
buffer_load_dwordx4 v21, s[12:15], s25 offen offset:0 lds
v_add_u32 v132, s4, v132
s_movk_i32 s5, 400
M a[124:127], a[220:223], a[236:239], a[124:127]
s_waitcnt lgkmcnt(10)
M a[128:131], a[204:207], a[244:247], a[128:131]
ds_read_b128 a[232:235], v12 offset:16384
ds_read_b128 a[236:239], v13 offset:16384
v_mad_u32_u24 v122, v131, s5, v132
v_subrev_u32 v131, 32, v131
M a[128:131], a[200:203], a[240:243], a[128:131]
M a[132:135], a[208:211], a[240:243], a[132:135]
ds_read_b64_tr_b16 a[196:197], v19 offset:12288
ds_read_b64_tr_b16 a[198:199], v19 offset:13824
v_max_i32 v131, 0, v131
v_mad_u32_u24 v123, v131, s5, v132
M a[132:135], a[212:215], a[244:247], a[132:135]
buffer_load_dwordx4 v22, s[12:15], s25 offen offset:1024 lds
M a[136:139], a[220:223], a[244:247], a[136:139]
v_lshlrev_b32 v129, 2, v129
v_sub_u32 v128, v128, v129
M a[136:139], a[216:219], a[240:243], a[136:139]
s_waitcnt lgkmcnt(10)
M a[140:143], a[200:203], a[248:251], a[140:143]
s_sub_u32 s54, s54, 1
s_cmp_eq_u32 s54, 0
s_cselect_b32 s58, s55, s56
s_add_u32 s25, s25, s58
v_mov_b32 v129, 0xf149f2ca
s_cmp_eq_u32 s26, 0
s_cselect_b32 s3, 0xf149f2ca, 0
M a[140:143], a[204:207], a[252:255], a[140:143]
M a[144:147], a[212:215], a[252:255], a[144:147]
v_cmp_lt_i32 vcc, -9, v128
s_nop 1
v_cndmask_b32 v144, 0, v129, vcc
M a[144:147], a[208:211], a[248:251], a[144:147]
M a[148:151], a[216:219], a[248:251], a[148:151]
s_waitcnt vmcnt(12) lgkmcnt(0)
s_barrier
ds_read_b128 a[240:243], v10 offset:0
ds_read_b128 a[244:247], v11 offset:0
M a[148:151], a[220:223], a[252:255], a[148:151]
s_add_u32 m0, s28, 131072
s_nop 0
buffer_load_dword v20, s[8:11], s24 offen lds
v_subrev_u32 v130, 0, v128
v_cmp_lt_u32 vcc, 7, v130
s_nop 1
v_cndmask_b32 v148, 0, v129, vcc
M a[152:155], a[204:207], a[228:231], a[152:155]
ds_read_b128 a[248:251], v10 offset:2048
ds_read_b128 a[252:255], v11 offset:2048
M a[152:155], a[200:203], a[224:227], a[152:155]
v_min_f32 v152, s3, v144
v_mov_b32 v156, 0x3f803f80
M a[156:159], a[208:211], a[224:227], a[156:159]
buffer_load_dword v23, s[8:11], s24 offen offset:256 lds
M a[156:159], a[212:215], a[228:231], a[156:159]
v_cmp_lt_i32 vcc, -8, v128
s_nop 1
v_cndmask_b32 v145, 0, v129, vcc
M a[160:163], a[220:223], a[228:231], a[160:163]
M a[160:163], a[216:219], a[224:227], a[160:163]
s_add_u32 m0, s29, 133120
s_nop 0
buffer_load_dwordx4 v2, s[8:11], s23 offen offset:0 lds
v_subrev_u32 v130, 1, v128
v_cmp_lt_u32 vcc, 7, v130
s_nop 1
v_cndmask_b32 v149, 0, v129, vcc
M a[164:167], a[200:203], a[232:235], a[164:167]
ds_read_b128 a[224:227], v10 offset:4096
ds_read_b128 a[228:231], v11 offset:4096
M a[164:167], a[204:207], a[236:239], a[164:167]
v_min_f32 v153, s3, v145
v_mov_b32 v157, 0x3f803f80
M a[168:171], a[212:215], a[236:239], a[168:171]
M a[168:171], a[208:211], a[232:235], a[168:171]
buffer_load_dwordx4 v3, s[8:11], s23 offen offset:1024 lds
v_cmp_lt_i32 vcc, -7, v128
s_nop 1
v_cndmask_b32 v146, 0, v129, vcc
M a[172:175], a[216:219], a[232:235], a[172:175]
M a[172:175], a[220:223], a[236:239], a[172:175]
s_waitcnt lgkmcnt(4)
M a[68:71], a[176:179], a[240:243], a[68:71]
ds_read_b128 a[232:235], v10 offset:6144
ds_read_b128 a[236:239], v11 offset:6144
v_subrev_u32 v130, 2, v128
v_cmp_lt_u32 vcc, 7, v130
s_nop 1
v_cndmask_b32 v150, 0, v129, vcc
M a[68:71], a[180:183], a[244:247], a[68:71]
buffer_load_dwordx4 v4, s[8:11], s23 offen offset:2048 lds
v_min_f32 v154, s3, v146
v_mov_b32 v158, 0x3f803f80
M a[72:75], a[188:191], a[244:247], a[72:75]
ds_read_b64_tr_b16 a[200:201], v14 offset:0
ds_read_b64_tr_b16 a[202:203], v14 offset:1536
M a[72:75], a[184:187], a[240:243], a[72:75]
v_cmp_lt_i32 vcc, -6, v128
s_nop 1
v_cndmask_b32 v147, 0, v129, vcc
M a[76:79], a[192:195], a[240:243], a[76:79]
buffer_load_dwordx4 v5, s[8:11], s23 offen offset:3072 lds
v_subrev_u32 v130, 3, v128
v_cmp_lt_u32 vcc, 7, v130
s_nop 1
v_cndmask_b32 v151, 0, v129, vcc
M a[76:79], a[196:199], a[244:247], a[76:79]
s_waitcnt lgkmcnt(6)
M a[80:83], a[180:183], a[252:255], a[80:83]
ds_read_b128 a[240:243], v10 offset:8192
ds_read_b128 a[244:247], v11 offset:8192
v_min_f32 v155, s3, v147
v_mov_b32 v159, 0x3f803f80
M a[80:83], a[176:179], a[248:251], a[80:83]
s_add_u32 s16, s50, 83886080
s_addc_u32 s17, s51, 0
M a[84:87], a[184:187], a[248:251], a[84:87]
ds_read_b64_tr_b16 a[208:209], v15 offset:0
ds_read_b64_tr_b16 a[210:211], v15 offset:1536
M a[84:87], a[188:191], a[252:255], a[84:87]
s_sub_u32 s31, s31, 1
s_cmp_eq_u32 s31, 0
s_cselect_b32 s58, -1920, s57
s_add_u32 s23, s23, s58
s_add_u32 s24, s24, s58
s_mov_b32 s18, 4194304
s_mov_b32 s19, 0x00020000
M a[88:91], a[196:199], a[252:255], a[88:91]
s_lshl_b32 s3, s26, 18
s_lshl_b32 s4, s27, 14
M a[88:91], a[192:195], a[248:251], a[88:91]
s_waitcnt lgkmcnt(8)
M a[92:95], a[176:179], a[224:227], a[92:95]
ds_read_b128 a[248:251], v10 offset:10240
ds_read_b128 a[252:255], v11 offset:10240
s_add_u32 s3, s3, s4
s_lshl_b32 s4, s21, 13
M a[92:95], a[180:183], a[228:231], a[92:95]
s_add_u32 m0, s30, 98304
s_nop 0
buffer_load_dwordx4 v6, s[12:15], s25 offen offset:0 lds
s_add_u32 s3, s3, s4
s_lshl_b32 s4, s22, 10
M a[96:99], a[188:191], a[228:231], a[96:99]
ds_read_b64_tr_b16 a[216:217], v16 offset:0
ds_read_b64_tr_b16 a[218:219], v16 offset:1536
M a[96:99], a[184:187], a[224:227], a[96:99]
s_add_u32 s6, s3, s4
s_mov_b32 s7, 0x3e8293ee
M a[100:103], a[192:195], a[224:227], a[100:103]
buffer_load_dwordx4 v7, s[12:15], s25 offen offset:1024 lds
s_lshl_b32 s65, s26, 8
s_lshl_b32 s3, s27, 4
M a[100:103], a[196:199], a[228:231], a[100:103]
s_waitcnt lgkmcnt(10)
M a[104:107], a[180:183], a[236:239], a[104:107]
ds_read_b128 a[224:227], v10 offset:12288
ds_read_b128 a[228:231], v11 offset:12288
s_add_u32 s65, s65, s3
s_lshl_b32 s3, s101, 2
M a[104:107], a[176:179], a[232:235], a[104:107]
s_add_u32 s65, s65, s3
s_add_u32 s65, s65, 8400896
M a[108:111], a[184:187], a[232:235], a[108:111]
ds_read_b64_tr_b16 a[204:205], v14 offset:12288
ds_read_b64_tr_b16 a[206:207], v14 offset:13824
M a[108:111], a[188:191], a[236:239], a[108:111]
buffer_load_dwordx4 v8, s[12:15], s25 offen offset:2048 lds
s_mov_b32 s40, 0
v_mov_b32 v119, 0
M a[112:115], a[196:199], a[236:239], a[112:115]
s_mov_b64 s[4:5], s[50:51]
s_and_b32 s20, s2, 7
M a[112:115], a[192:195], a[232:235], a[112:115]
s_waitcnt lgkmcnt(10)
M a[116:119], a[176:179], a[240:243], a[116:119]
ds_read_b128 a[232:235], v10 offset:14336
ds_read_b128 a[236:239], v11 offset:14336
s_lshr_b32 s33, s2, 6
s_lshl_b32 s33, s33, 3
M a[116:119], a[180:183], a[244:247], a[116:119]
buffer_load_dwordx4 v9, s[12:15], s25 offen offset:3072 lds
s_add_u32 s20, s20, s33
s_bfe_u32 s21, s2, 0x30003
M a[120:123], a[188:191], a[244:247], a[120:123]
ds_read_b64_tr_b16 a[212:213], v15 offset:12288
ds_read_b64_tr_b16 a[214:215], v15 offset:13824
M a[120:123], a[184:187], a[240:243], a[120:123]
s_sub_u32 s35, 15, s21
s_cmp_lt_u32 s101, 2
s_cselect_b32 s35, s21, s35
M a[124:127], a[192:195], a[240:243], a[124:127]
s_add_u32 m0, s30, 102400
s_nop 0
buffer_load_dwordx4 v21, s[12:15], s25 offen offset:0 lds
s_lshl_b32 s33, s20, 7
s_lshl_b32 s34, s35, 3
M a[124:127], a[196:199], a[244:247], a[124:127]
s_waitcnt lgkmcnt(10)
M a[128:131], a[180:183], a[252:255], a[128:131]
ds_read_b128 a[240:243], v10 offset:16384
ds_read_b128 a[244:247], v11 offset:16384
s_add_u32 s33, s33, s34
s_and_b32 s34, s101, 1
M a[128:131], a[176:179], a[248:251], a[128:131]
s_lshl_b32 s34, s34, 2
s_add_u32 s33, s33, s34
M a[132:135], a[184:187], a[248:251], a[132:135]
ds_read_b64_tr_b16 a[220:221], v16 offset:12288
ds_read_b64_tr_b16 a[222:223], v16 offset:13824
M a[132:135], a[188:191], a[252:255], a[132:135]
buffer_load_dwordx4 v22, s[12:15], s25 offen offset:1024 lds
s_lshl_b32 s64, s33, 12
s_mov_b32 s44, s4
M a[136:139], a[196:199], a[252:255], a[136:139]
s_mov_b32 s45, s5
s_mov_b32 s46, 16777216
M a[136:139], a[192:195], a[248:251], a[136:139]
s_waitcnt lgkmcnt(10)
M a[140:143], a[176:179], a[224:227], a[140:143]
s_sub_u32 s54, s54, 1
s_cmp_eq_u32 s54, 0
s_cselect_b32 s58, s55, s56
s_add_u32 s25, s25, s58
s_mov_b32 s47, 0x00020000
M a[140:143], a[180:183], a[228:231], a[140:143]
M a[144:147], a[188:191], a[228:231], a[144:147]
M a[144:147], a[184:187], a[224:227], a[144:147]
M a[148:151], a[192:195], a[224:227], a[148:151]
s_waitcnt vmcnt(12) lgkmcnt(0)
s_barrier
ds_read_b128 a[248:251], v10 offset:18432
ds_read_b128 a[252:255], v11 offset:18432
M a[148:151], a[196:199], a[228:231], a[148:151]
s_add_u32 m0, s28, 0
s_nop 0
buffer_load_dword v20, s[8:11], s24 offen lds
M a[152:155], a[180:183], a[236:239], a[152:155]
ds_read_b128 a[224:227], v10 offset:20480
ds_read_b128 a[228:231], v11 offset:20480
M a[152:155], a[176:179], a[232:235], a[152:155]
M a[156:159], a[184:187], a[232:235], a[156:159]
buffer_load_dword v23, s[8:11], s24 offen offset:256 lds
M a[156:159], a[188:191], a[236:239], a[156:159]
M a[160:163], a[196:199], a[236:239], a[160:163]
M a[160:163], a[192:195], a[232:235], a[160:163]
s_add_u32 m0, s29, 2048
s_nop 0
buffer_load_dwordx4 v2, s[8:11], s23 offen offset:0 lds
M a[164:167], a[176:179], a[240:243], a[164:167]
ds_read_b128 a[232:235], v10 offset:22528
ds_read_b128 a[236:239], v11 offset:22528
M a[164:167], a[180:183], a[244:247], a[164:167]
M a[168:171], a[188:191], a[244:247], a[168:171]
M a[168:171], a[184:187], a[240:243], a[168:171]
buffer_load_dwordx4 v3, s[8:11], s23 offen offset:1024 lds
M a[172:175], a[192:195], a[240:243], a[172:175]
M a[172:175], a[196:199], a[244:247], a[172:175]
s_waitcnt lgkmcnt(4)
M a[68:71], a[200:203], a[248:251], a[68:71]
ds_read_b128 a[240:243], v10 offset:24576
ds_read_b128 a[244:247], v11 offset:24576
M a[68:71], a[204:207], a[252:255], a[68:71]
buffer_load_dwordx4 v4, s[8:11], s23 offen offset:2048 lds
M a[72:75], a[212:215], a[252:255], a[72:75]
ds_read_b64_tr_b16 a[176:177], v14 offset:28672
ds_read_b64_tr_b16 a[178:179], v14 offset:30208
M a[72:75], a[208:211], a[248:251], a[72:75]
M a[76:79], a[216:219], a[248:251], a[76:79]
buffer_load_dwordx4 v5, s[8:11], s23 offen offset:3072 lds
M a[76:79], a[220:223], a[252:255], a[76:79]
s_waitcnt lgkmcnt(6)
M a[80:83], a[204:207], a[228:231], a[80:83]
ds_read_b128 a[248:251], v10 offset:26624
ds_read_b128 a[252:255], v11 offset:26624
M a[80:83], a[200:203], a[224:227], a[80:83]
M a[84:87], a[208:211], a[224:227], a[84:87]
ds_read_b64_tr_b16 a[184:185], v15 offset:28672
ds_read_b64_tr_b16 a[186:187], v15 offset:30208
M a[84:87], a[212:215], a[228:231], a[84:87]
s_sub_u32 s31, s31, 1
s_cmp_eq_u32 s31, 0
s_cselect_b32 s58, -1920, s57
s_add_u32 s23, s23, s58
s_add_u32 s24, s24, s58
M a[88:91], a[220:223], a[228:231], a[88:91]
M a[88:91], a[216:219], a[224:227], a[88:91]
s_waitcnt lgkmcnt(8)
M a[92:95], a[200:203], a[232:235], a[92:95]
ds_read_b128 a[224:227], v10 offset:28672
ds_read_b128 a[228:231], v11 offset:28672
M a[92:95], a[204:207], a[236:239], a[92:95]
s_add_u32 m0, s30, 36864
s_nop 0
buffer_load_dwordx4 v6, s[12:15], s25 offen offset:0 lds
M a[96:99], a[212:215], a[236:239], a[96:99]
ds_read_b64_tr_b16 a[192:193], v16 offset:28672
ds_read_b64_tr_b16 a[194:195], v16 offset:30208
M a[96:99], a[208:211], a[232:235], a[96:99]
M a[100:103], a[216:219], a[232:235], a[100:103]
buffer_load_dwordx4 v7, s[12:15], s25 offen offset:1024 lds
M a[100:103], a[220:223], a[236:239], a[100:103]
s_waitcnt lgkmcnt(10)
M a[104:107], a[204:207], a[244:247], a[104:107]
ds_read_b128 a[232:235], v10 offset:30720
ds_read_b128 a[236:239], v11 offset:30720
M a[104:107], a[200:203], a[240:243], a[104:107]
M a[108:111], a[208:211], a[240:243], a[108:111]
ds_read_b64_tr_b16 a[180:181], v14 offset:40960
ds_read_b64_tr_b16 a[182:183], v14 offset:42496
M a[108:111], a[212:215], a[244:247], a[108:111]
buffer_load_dwordx4 v8, s[12:15], s25 offen offset:2048 lds
M a[112:115], a[220:223], a[244:247], a[112:115]
M a[112:115], a[216:219], a[240:243], a[112:115]
s_waitcnt lgkmcnt(10)
M a[116:119], a[200:203], a[248:251], a[116:119]
ds_read_b128 a[240:243], v10 offset:32768
ds_read_b128 a[244:247], v11 offset:32768
M a[116:119], a[204:207], a[252:255], a[116:119]
buffer_load_dwordx4 v9, s[12:15], s25 offen offset:3072 lds
M a[120:123], a[212:215], a[252:255], a[120:123]
ds_read_b64_tr_b16 a[188:189], v15 offset:40960
ds_read_b64_tr_b16 a[190:191], v15 offset:42496
M a[120:123], a[208:211], a[248:251], a[120:123]
M a[124:127], a[216:219], a[248:251], a[124:127]
s_add_u32 m0, s30, 40960
s_nop 0
buffer_load_dwordx4 v21, s[12:15], s25 offen offset:0 lds
M a[124:127], a[220:223], a[252:255], a[124:127]
s_waitcnt lgkmcnt(10)
M a[128:131], a[204:207], a[228:231], a[128:131]
ds_read_b128 a[248:251], v10 offset:34816
ds_read_b128 a[252:255], v11 offset:34816
M a[128:131], a[200:203], a[224:227], a[128:131]
M a[132:135], a[208:211], a[224:227], a[132:135]
ds_read_b64_tr_b16 a[196:197], v16 offset:40960
ds_read_b64_tr_b16 a[198:199], v16 offset:42496
M a[132:135], a[212:215], a[228:231], a[132:135]
buffer_load_dwordx4 v22, s[12:15], s25 offen offset:1024 lds
M a[136:139], a[220:223], a[228:231], a[136:139]
M a[136:139], a[216:219], a[224:227], a[136:139]
s_waitcnt lgkmcnt(10)
M a[140:143], a[200:203], a[232:235], a[140:143]
s_sub_u32 s54, s54, 1
s_cmp_eq_u32 s54, 0
s_cselect_b32 s58, s55, s56
s_add_u32 s25, s25, s58
M a[140:143], a[204:207], a[236:239], a[140:143]
M a[144:147], a[212:215], a[236:239], a[144:147]
M a[144:147], a[208:211], a[232:235], a[144:147]
M a[148:151], a[216:219], a[232:235], a[148:151]
s_waitcnt vmcnt(12) lgkmcnt(0)
s_barrier
ds_read_b128 a[224:227], v12 offset:0
ds_read_b128 a[228:231], v13 offset:0
M a[148:151], a[220:223], a[236:239], a[148:151]
s_add_u32 m0, s28, 18432
s_nop 0
buffer_load_dword v20, s[8:11], s24 offen lds
M a[152:155], a[204:207], a[244:247], a[152:155]
ds_read_b128 a[232:235], v12 offset:2048
ds_read_b128 a[236:239], v13 offset:2048
M a[152:155], a[200:203], a[240:243], a[152:155]
M a[156:159], a[208:211], a[240:243], a[156:159]
buffer_load_dword v23, s[8:11], s24 offen offset:256 lds
M a[156:159], a[212:215], a[244:247], a[156:159]
M a[160:163], a[220:223], a[244:247], a[160:163]
M a[160:163], a[216:219], a[240:243], a[160:163]
s_add_u32 m0, s29, 20480
s_nop 0
buffer_load_dwordx4 v2, s[8:11], s23 offen offset:0 lds
M a[164:167], a[200:203], a[248:251], a[164:167]
ds_read_b128 a[240:243], v12 offset:4096
ds_read_b128 a[244:247], v13 offset:4096
M a[164:167], a[204:207], a[252:255], a[164:167]
M a[168:171], a[212:215], a[252:255], a[168:171]
M a[168:171], a[208:211], a[248:251], a[168:171]
buffer_load_dwordx4 v3, s[8:11], s23 offen offset:1024 lds
M a[172:175], a[216:219], a[248:251], a[172:175]
M a[172:175], a[220:223], a[252:255], a[172:175]
s_waitcnt lgkmcnt(4)
M a[68:71], a[176:179], a[224:227], a[68:71]
ds_read_b128 a[248:251], v12 offset:6144
ds_read_b128 a[252:255], v13 offset:6144
M a[68:71], a[180:183], a[228:231], a[68:71]
buffer_load_dwordx4 v4, s[8:11], s23 offen offset:2048 lds
M a[72:75], a[188:191], a[228:231], a[72:75]
ds_read_b64_tr_b16 a[200:201], v17 offset:0
ds_read_b64_tr_b16 a[202:203], v17 offset:1536
M a[72:75], a[184:187], a[224:227], a[72:75]
M a[76:79], a[192:195], a[224:227], a[76:79]
buffer_load_dwordx4 v5, s[8:11], s23 offen offset:3072 lds
M a[76:79], a[196:199], a[228:231], a[76:79]
s_waitcnt lgkmcnt(6)
M a[80:83], a[180:183], a[236:239], a[80:83]
ds_read_b128 a[224:227], v12 offset:8192
ds_read_b128 a[228:231], v13 offset:8192
M a[80:83], a[176:179], a[232:235], a[80:83]
s_sub_u32 s31, s31, 1
s_cmp_eq_u32 s31, 0
s_cselect_b32 s58, -1920, s57
s_add_u32 s23, s23, s58
s_add_u32 s24, s24, s58
M a[84:87], a[184:187], a[232:235], a[84:87]
ds_read_b64_tr_b16 a[208:209], v18 offset:0
ds_read_b64_tr_b16 a[210:211], v18 offset:1536
M a[84:87], a[188:191], a[236:239], a[84:87]
M a[88:91], a[196:199], a[236:239], a[88:91]
M a[88:91], a[192:195], a[232:235], a[88:91]
s_add_u32 m0, s30, 65536
s_nop 0
buffer_load_dwordx4 v6, s[12:15], s25 offen offset:0 lds
s_waitcnt lgkmcnt(8)
M a[92:95], a[176:179], a[240:243], a[92:95]
ds_read_b128 a[232:235], v12 offset:10240
ds_read_b128 a[236:239], v13 offset:10240
M a[92:95], a[180:183], a[244:247], a[92:95]
M a[96:99], a[188:191], a[244:247], a[96:99]
ds_read_b64_tr_b16 a[216:217], v19 offset:0
ds_read_b64_tr_b16 a[218:219], v19 offset:1536
M a[96:99], a[184:187], a[240:243], a[96:99]
buffer_load_dwordx4 v7, s[12:15], s25 offen offset:1024 lds
M a[100:103], a[192:195], a[240:243], a[100:103]
M a[100:103], a[196:199], a[244:247], a[100:103]
s_waitcnt lgkmcnt(10)
M a[104:107], a[180:183], a[252:255], a[104:107]
ds_read_b128 a[240:243], v12 offset:12288
ds_read_b128 a[244:247], v13 offset:12288
M a[104:107], a[176:179], a[248:251], a[104:107]
buffer_load_dwordx4 v8, s[12:15], s25 offen offset:2048 lds
M a[108:111], a[184:187], a[248:251], a[108:111]
ds_read_b64_tr_b16 a[204:205], v17 offset:12288
ds_read_b64_tr_b16 a[206:207], v17 offset:13824
M a[108:111], a[188:191], a[252:255], a[108:111]
M a[112:115], a[196:199], a[252:255], a[112:115]
buffer_load_dwordx4 v9, s[12:15], s25 offen offset:3072 lds
M a[112:115], a[192:195], a[248:251], a[112:115]
s_waitcnt lgkmcnt(10)
M a[116:119], a[176:179], a[224:227], a[116:119]
ds_read_b128 a[248:251], v12 offset:14336
ds_read_b128 a[252:255], v13 offset:14336
M a[116:119], a[180:183], a[228:231], a[116:119]
M a[120:123], a[188:191], a[228:231], a[120:123]
ds_read_b64_tr_b16 a[212:213], v18 offset:12288
ds_read_b64_tr_b16 a[214:215], v18 offset:13824
M a[120:123], a[184:187], a[224:227], a[120:123]
s_add_u32 m0, s30, 69632
s_nop 0
buffer_load_dwordx4 v21, s[12:15], s25 offen offset:0 lds
M a[124:127], a[192:195], a[224:227], a[124:127]
M a[124:127], a[196:199], a[228:231], a[124:127]
buffer_load_dwordx4 v22, s[12:15], s25 offen offset:1024 lds
s_waitcnt lgkmcnt(10)
M a[128:131], a[180:183], a[236:239], a[128:131]
ds_read_b128 a[224:227], v12 offset:16384
ds_read_b128 a[228:231], v13 offset:16384
M a[128:131], a[176:179], a[232:235], a[128:131]
M a[132:135], a[184:187], a[232:235], a[132:135]
ds_read_b64_tr_b16 a[220:221], v19 offset:12288
ds_read_b64_tr_b16 a[222:223], v19 offset:13824
M a[132:135], a[188:191], a[236:239], a[132:135]
M a[136:139], a[196:199], a[236:239], a[136:139]
s_sub_u32 s54, s54, 1
s_cmp_eq_u32 s54, 0
s_cselect_b32 s58, s55, s56
s_add_u32 s25, s25, s58
M a[136:139], a[192:195], a[232:235], a[136:139]
s_waitcnt lgkmcnt(10)
M a[140:143], a[176:179], a[240:243], a[140:143]
buffer_load_dword v125, v119, s[36:39], 0 offen sc1
M a[140:143], a[180:183], a[244:247], a[140:143]
M a[144:147], a[188:191], a[244:247], a[144:147]
M a[144:147], a[184:187], a[240:243], a[144:147]
M a[148:151], a[192:195], a[240:243], a[148:151]
s_waitcnt vmcnt(13) lgkmcnt(0)
s_barrier
ds_read_b128 a[232:235], v10 offset:0
ds_read_b128 a[236:239], v11 offset:0
s_waitcnt vmcnt(0)
v_cmp_gt_u32 vcc, 0x80, v125
s_nop 0
s_cbranch_vccnz Lk1_spinq
Lk1_gotq:
M a[148:151], a[196:199], a[244:247], a[148:151]
s_add_u32 m0, s28, 131072
s_nop 0
buffer_load_dword v20, s[8:11], s24 offen lds
M a[152:155], a[180:183], a[252:255], a[152:155]
ds_read_b128 a[240:243], v10 offset:2048
ds_read_b128 a[244:247], v11 offset:2048
M a[152:155], a[176:179], a[248:251], a[152:155]
M a[156:159], a[184:187], a[248:251], a[156:159]
buffer_load_dword v23, s[8:11], s24 offen offset:256 lds
M a[156:159], a[188:191], a[252:255], a[156:159]
M a[160:163], a[196:199], a[252:255], a[160:163]
M a[160:163], a[192:195], a[248:251], a[160:163]
s_add_u32 m0, s29, 133120
s_nop 0
buffer_load_dwordx4 v2, s[8:11], s23 offen offset:0 lds
M a[164:167], a[176:179], a[224:227], a[164:167]
ds_read_b128 a[248:251], v10 offset:4096
ds_read_b128 a[252:255], v11 offset:4096
M a[164:167], a[180:183], a[228:231], a[164:167]
M a[168:171], a[188:191], a[228:231], a[168:171]
M a[168:171], a[184:187], a[224:227], a[168:171]
buffer_load_dwordx4 v3, s[8:11], s23 offen offset:1024 lds
M a[172:175], a[192:195], a[224:227], a[172:175]
M a[172:175], a[196:199], a[228:231], a[172:175]
s_waitcnt lgkmcnt(4)
M a[68:71], a[200:203], a[232:235], a[68:71]
ds_read_b128 a[224:227], v10 offset:6144
ds_read_b128 a[228:231], v11 offset:6144
v_mov_b32 v208, 0
v_mov_b32 v209, 0
M a[68:71], a[204:207], a[236:239], a[68:71]
buffer_load_dwordx4 v4, s[8:11], s23 offen offset:2048 lds
M a[72:75], a[212:215], a[236:239], a[72:75]
ds_read_b64_tr_b16 a[176:177], v14 offset:0
ds_read_b64_tr_b16 a[178:179], v14 offset:1536
v_mov_b32 v210, 0
v_mov_b32 v211, 0
M a[72:75], a[208:211], a[232:235], a[72:75]
M a[76:79], a[216:219], a[232:235], a[76:79]
buffer_load_dwordx4 v5, s[8:11], s23 offen offset:3072 lds
v_mov_b32 v212, 0
v_mov_b32 v213, 0
M a[76:79], a[220:223], a[236:239], a[76:79]
s_waitcnt lgkmcnt(6)
M a[80:83], a[204:207], a[244:247], a[80:83]
ds_read_b128 a[232:235], v10 offset:8192
ds_read_b128 a[236:239], v11 offset:8192
v_mov_b32 v214, 0
v_mov_b32 v215, 0
M a[80:83], a[200:203], a[240:243], a[80:83]
s_sub_u32 s31, s31, 1
s_cmp_eq_u32 s31, 0
s_cselect_b32 s58, -1920, s57
s_add_u32 s23, s23, s58
s_add_u32 s24, s24, s58
M a[84:87], a[208:211], a[240:243], a[84:87]
ds_read_b64_tr_b16 a[184:185], v15 offset:0
ds_read_b64_tr_b16 a[186:187], v15 offset:1536
M a[84:87], a[212:215], a[244:247], a[84:87]
v_mov_b32 v216, 0
v_mov_b32 v217, 0
M a[88:91], a[220:223], a[244:247], a[88:91]
M a[88:91], a[216:219], a[240:243], a[88:91]
buffer_load_dwordx4 a[0:3], v1, s[44:47], s64 offen offset:0 sc1
s_waitcnt lgkmcnt(8)
v_mov_b32 v218, 0
v_mov_b32 v219, 0
M a[92:95], a[200:203], a[248:251], a[92:95]
ds_read_b128 a[240:243], v10 offset:10240
ds_read_b128 a[244:247], v11 offset:10240
M a[92:95], a[204:207], a[252:255], a[92:95]
v_mov_b32 v220, 0
v_mov_b32 v221, 0
M a[96:99], a[212:215], a[252:255], a[96:99]
ds_read_b64_tr_b16 a[192:193], v16 offset:0
ds_read_b64_tr_b16 a[194:195], v16 offset:1536
M a[96:99], a[208:211], a[248:251], a[96:99]
buffer_load_dwordx4 a[4:7], v1, s[44:47], s64 offen offset:1024 sc1
v_mov_b32 v222, 0
v_mov_b32 v223, 0
M a[100:103], a[216:219], a[248:251], a[100:103]
M a[100:103], a[220:223], a[252:255], a[100:103]
s_waitcnt lgkmcnt(10)
M a[104:107], a[204:207], a[228:231], a[104:107]
ds_read_b128 a[248:251], v10 offset:12288
ds_read_b128 a[252:255], v11 offset:12288
v_mov_b32 v224, 0
v_mov_b32 v225, 0
M a[104:107], a[200:203], a[224:227], a[104:107]
buffer_load_dwordx4 a[8:11], v1, s[44:47], s64 offen offset:2048 sc1
M a[108:111], a[208:211], a[224:227], a[108:111]
ds_read_b64_tr_b16 a[180:181], v14 offset:12288
ds_read_b64_tr_b16 a[182:183], v14 offset:13824
v_mov_b32 v226, 0
v_mov_b32 v227, 0
M a[108:111], a[212:215], a[228:231], a[108:111]
M a[112:115], a[220:223], a[228:231], a[112:115]
buffer_load_dwordx4 a[12:15], v1, s[44:47], s64 offen offset:3072 sc1
s_add_u32 s64, s64, 4096
v_mov_b32 v228, 0
v_mov_b32 v229, 0
M a[112:115], a[216:219], a[224:227], a[112:115]
s_waitcnt lgkmcnt(10)
M a[116:119], a[200:203], a[232:235], a[116:119]
ds_read_b128 a[224:227], v10 offset:14336
ds_read_b128 a[228:231], v11 offset:14336
v_mov_b32 v230, 0
v_mov_b32 v231, 0
M a[116:119], a[204:207], a[236:239], a[116:119]
M a[120:123], a[212:215], a[236:239], a[120:123]
ds_read_b64_tr_b16 a[188:189], v15 offset:12288
ds_read_b64_tr_b16 a[190:191], v15 offset:13824
M a[120:123], a[208:211], a[232:235], a[120:123]
buffer_load_dwordx4 a[16:19], v1, s[44:47], s64 offen offset:0 sc1
v_mov_b32 v232, 0
v_mov_b32 v233, 0
M a[124:127], a[216:219], a[232:235], a[124:127]
M a[124:127], a[220:223], a[236:239], a[124:127]
buffer_load_dwordx4 a[20:23], v1, s[44:47], s64 offen offset:1024 sc1
s_waitcnt lgkmcnt(10)
v_mov_b32 v234, 0
v_mov_b32 v235, 0
M a[128:131], a[204:207], a[244:247], a[128:131]
ds_read_b128 a[232:235], v10 offset:16384
ds_read_b128 a[236:239], v11 offset:16384
M a[128:131], a[200:203], a[240:243], a[128:131]
v_mov_b32 v236, 0
v_mov_b32 v237, 0
M a[132:135], a[208:211], a[240:243], a[132:135]
ds_read_b64_tr_b16 a[196:197], v16 offset:12288
ds_read_b64_tr_b16 a[198:199], v16 offset:13824
M a[132:135], a[212:215], a[244:247], a[132:135]
v_mov_b32 v238, 0
v_mov_b32 v239, 0
M a[136:139], a[220:223], a[244:247], a[136:139]
buffer_load_dwordx4 a[24:27], v1, s[44:47], s64 offen offset:2048 sc1
M a[136:139], a[216:219], a[240:243], a[136:139]
s_waitcnt lgkmcnt(10)
M a[140:143], a[200:203], a[248:251], a[140:143]
buffer_load_dwordx4 a[28:31], v1, s[44:47], s64 offen offset:3072 sc1
s_add_u32 s64, s64, 4096
v_mov_b32 v240, 0
v_mov_b32 v241, 0
M a[140:143], a[204:207], a[252:255], a[140:143]
M a[144:147], a[212:215], a[252:255], a[144:147]
v_mov_b32 v242, 0
v_mov_b32 v243, 0
M a[144:147], a[208:211], a[248:251], a[144:147]
M a[148:151], a[216:219], a[248:251], a[148:151]
s_waitcnt vmcnt(15) lgkmcnt(0)
s_barrier
ds_read_b128 a[240:243], v10 offset:18432
ds_read_b128 a[244:247], v11 offset:18432
v_mov_b32 v244, 0
v_mov_b32 v245, 0
M a[148:151], a[220:223], a[252:255], a[148:151]
buffer_load_dwordx4 a[32:35], v1, s[44:47], s64 offen offset:0 sc1
M a[152:155], a[204:207], a[228:231], a[152:155]
ds_read_b128 a[248:251], v10 offset:20480
ds_read_b128 a[252:255], v11 offset:20480
v_mov_b32 v246, 0
v_mov_b32 v247, 0
M a[152:155], a[200:203], a[224:227], a[152:155]
M a[156:159], a[208:211], a[224:227], a[156:159]
buffer_load_dwordx4 a[36:39], v1, s[44:47], s64 offen offset:1024 sc1
M a[156:159], a[212:215], a[228:231], a[156:159]
v_mov_b32 v248, 0
v_mov_b32 v249, 0
M a[160:163], a[220:223], a[228:231], a[160:163]
M a[160:163], a[216:219], a[224:227], a[160:163]
buffer_load_dwordx4 a[40:43], v1, s[44:47], s64 offen offset:2048 sc1
v_mov_b32 v250, 0
v_mov_b32 v251, 0
M a[164:167], a[200:203], a[232:235], a[164:167]
ds_read_b128 a[224:227], v10 offset:22528
ds_read_b128 a[228:231], v11 offset:22528
M a[164:167], a[204:207], a[236:239], a[164:167]
v_mov_b32 v252, 0
v_mov_b32 v253, 0
M a[168:171], a[212:215], a[236:239], a[168:171]
M a[168:171], a[208:211], a[232:235], a[168:171]
buffer_load_dwordx4 a[44:47], v1, s[44:47], s64 offen offset:3072 sc1
s_add_u32 s64, s64, 4096
v_mov_b32 v254, 0
v_mov_b32 v255, 0
M a[172:175], a[216:219], a[232:235], a[172:175]
M a[172:175], a[220:223], a[236:239], a[172:175]
s_waitcnt lgkmcnt(4)
M a[68:71], a[176:179], a[240:243], a[68:71]
ds_read_b128 a[232:235], v10 offset:24576
ds_read_b128 a[236:239], v11 offset:24576
s_mov_b32 s22, s101
s_and_b32 s23, s22, 1
M a[68:71], a[180:183], a[244:247], a[68:71]
buffer_load_dwordx4 a[48:51], v1, s[44:47], s64 offen offset:0 sc1
s_lshr_b32 s24, s22, 1
s_lshl_b32 s33, s24, 14
M a[72:75], a[188:191], a[244:247], a[72:75]
ds_read_b64_tr_b16 a[200:201], v14 offset:28672
ds_read_b64_tr_b16 a[202:203], v14 offset:30208
M a[72:75], a[184:187], a[240:243], a[72:75]
s_lshl_b32 s34, s23, 13
s_add_u32 s29, s33, s34
M a[76:79], a[192:195], a[240:243], a[76:79]
M a[76:79], a[196:199], a[244:247], a[76:79]
s_waitcnt lgkmcnt(6)
s_lshl_b32 s28, s20, 20
s_add_u32 s28, s28, s34
M a[80:83], a[180:183], a[252:255], a[80:83]
ds_read_b128 a[240:243], v10 offset:26624
ds_read_b128 a[244:247], v11 offset:26624
M a[80:83], a[176:179], a[248:251], a[80:83]
s_mov_b32 s25, s28
s_lshl_b32 s33, s21, 16
M a[84:87], a[184:187], a[248:251], a[84:87]
ds_read_b64_tr_b16 a[208:209], v15 offset:28672
ds_read_b64_tr_b16 a[210:211], v15 offset:30208
M a[84:87], a[188:191], a[252:255], a[84:87]
buffer_load_dwordx4 a[52:55], v1, s[44:47], s64 offen offset:1024 sc1
s_add_u32 s34, s28, s33
s_add_u32 s34, s34, 65536
M a[88:91], a[196:199], a[252:255], a[88:91]
M a[88:91], a[192:195], a[248:251], a[88:91]
s_waitcnt lgkmcnt(8)
s_add_u32 s32, s28, 491520
s_sub_u32 s33, s32, s33
M a[92:95], a[176:179], a[224:227], a[92:95]
ds_read_b128 a[248:251], v10 offset:28672
ds_read_b128 a[252:255], v11 offset:28672
M a[92:95], a[180:183], a[228:231], a[92:95]
s_add_u32 s33, s33, 491520
s_cmp_eq_u32 s24, 0
s_cselect_b32 s27, s34, s32
s_cselect_b32 s28, s32, s33
M a[96:99], a[188:191], a[228:231], a[96:99]
ds_read_b64_tr_b16 a[216:217], v16 offset:28672
ds_read_b64_tr_b16 a[218:219], v16 offset:30208
M a[96:99], a[184:187], a[224:227], a[96:99]
s_mov_b32 s56, s27
s_mov_b32 s57, s28
M a[100:103], a[192:195], a[224:227], a[100:103]
buffer_load_dwordx4 a[56:59], v1, s[44:47], s64 offen offset:2048 sc1
M a[100:103], a[196:199], a[228:231], a[100:103]
s_waitcnt lgkmcnt(10)
s_min_u32 s34, s34, s32
s_cmp_eq_u32 s34, s32
s_cselect_b32 s33, s33, s34
M a[104:107], a[180:183], a[236:239], a[104:107]
ds_read_b128 a[224:227], v10 offset:30720
ds_read_b128 a[228:231], v11 offset:30720
M a[104:107], a[176:179], a[232:235], a[104:107]
s_or_b32 s34, s34, 0x40000000
s_or_b32 s32, s25, 0x40000000
M a[108:111], a[184:187], a[232:235], a[108:111]
ds_read_b64_tr_b16 a[204:205], v14 offset:40960
ds_read_b64_tr_b16 a[206:207], v14 offset:42496
s_cmp_eq_u32 s24, 1
s_cselect_b32 s25, s32, s25
s_cselect_b32 s27, s34, s27
s_cselect_b32 s28, s33, s28
s_cselect_b32 s56, s56, -1
M a[108:111], a[188:191], a[236:239], a[108:111]
M a[112:115], a[196:199], a[236:239], a[112:115]
s_add_u32 s58, s56, 16384
s_add_u32 s59, s57, 16384
M a[112:115], a[192:195], a[232:235], a[112:115]
s_waitcnt lgkmcnt(10)
M a[116:119], a[176:179], a[240:243], a[116:119]
ds_read_b128 a[232:235], v10 offset:32768
ds_read_b128 a[236:239], v11 offset:32768
s_add_u32 s26, s25, 16384
s_add_u32 s62, s27, 16384
M a[116:119], a[180:183], a[244:247], a[116:119]
buffer_load_dwordx4 a[60:63], v1, s[44:47], s64 offen offset:3072 sc1
M a[120:123], a[188:191], a[244:247], a[120:123]
ds_read_b64_tr_b16 a[212:213], v15 offset:40960
ds_read_b64_tr_b16 a[214:215], v15 offset:42496
s_add_u32 s63, s28, 16384
s_lshl_b32 s31, s21, 7
M a[120:123], a[184:187], a[240:243], a[120:123]
M a[124:127], a[192:195], a[240:243], a[124:127]
s_cmp_eq_u32 s24, 0
s_cselect_b32 s31, s31, 960
M a[124:127], a[196:199], a[244:247], a[124:127]
s_waitcnt lgkmcnt(10)
M a[128:131], a[180:183], a[252:255], a[128:131]
ds_read_b128 a[240:243], v10 offset:34816
ds_read_b128 a[244:247], v11 offset:34816
s_mov_b32 s60, 0
s_add_u32 s12, s4, 16777216
s_addc_u32 s13, s5, 0
M a[128:131], a[176:179], a[248:251], a[128:131]
M a[132:135], a[184:187], a[248:251], a[132:135]
ds_read_b64_tr_b16 a[220:221], v16 offset:40960
ds_read_b64_tr_b16 a[222:223], v16 offset:42496
s_mov_b32 s14, 33554432
s_mov_b32 s15, 0x00020000
M a[132:135], a[188:191], a[252:255], a[132:135]
buffer_load_dword v126, v119, s[36:39], 0 offen offset:128 sc1
M a[136:139], a[196:199], a[252:255], a[136:139]
s_mov_b32 s8, s4
s_mov_b32 s9, s5
M a[136:139], a[192:195], a[248:251], a[136:139]
s_waitcnt lgkmcnt(10)
M a[140:143], a[176:179], a[224:227], a[140:143]
s_mov_b32 s10, 16777216
s_mov_b32 s11, 0x00020000
M a[140:143], a[180:183], a[228:231], a[140:143]
M a[144:147], a[188:191], a[228:231], a[144:147]
M a[144:147], a[184:187], a[224:227], a[144:147]
M a[148:151], a[192:195], a[224:227], a[148:151]
s_waitcnt vmcnt(17) lgkmcnt(0)
s_barrier
ds_read_b128 a[248:251], v12 offset:0
ds_read_b128 a[252:255], v13 offset:0
s_waitcnt vmcnt(0)
v_cmp_gt_u32 vcc, 0x80, v126
s_nop 0
s_cbranch_vccnz Lk1_spin
Lk1_got:
M a[148:151], a[196:199], a[228:231], a[148:151]
s_add_u32 m0, s29, 65536
s_add_u32 s32, s25, 4096
buffer_load_dwordx4 v1, s[12:15], s25 offen offset:0 sc1 lds
M a[152:155], a[180:183], a[236:239], a[152:155]
ds_read_b128 a[224:227], v12 offset:2048
ds_read_b128 a[228:231], v13 offset:2048
M a[152:155], a[176:179], a[232:235], a[152:155]
buffer_load_dwordx4 v1, s[12:15], s25 offen offset:1024 sc1 lds
M a[156:159], a[184:187], a[232:235], a[156:159]
M a[156:159], a[188:191], a[236:239], a[156:159]
buffer_load_dwordx4 v1, s[12:15], s25 offen offset:2048 sc1 lds
M a[160:163], a[196:199], a[236:239], a[160:163]
buffer_load_dwordx4 v1, s[12:15], s25 offen offset:3072 sc1 lds
M a[160:163], a[192:195], a[232:235], a[160:163]
M a[164:167], a[176:179], a[240:243], a[164:167]
ds_read_b128 a[232:235], v12 offset:4096
ds_read_b128 a[236:239], v13 offset:4096
M a[164:167], a[180:183], a[244:247], a[164:167]
s_add_u32 m0, s29, 69632
s_nop 0
buffer_load_dwordx4 v1, s[12:15], s32 offen offset:0 sc1 lds
M a[168:171], a[188:191], a[244:247], a[168:171]
buffer_load_dwordx4 v1, s[12:15], s32 offen offset:1024 sc1 lds
M a[168:171], a[184:187], a[240:243], a[168:171]
M a[172:175], a[192:195], a[240:243], a[172:175]
buffer_load_dwordx4 v1, s[12:15], s32 offen offset:2048 sc1 lds
M a[172:175], a[196:199], a[244:247], a[172:175]
s_waitcnt lgkmcnt(4)
M a[68:71], a[200:203], a[248:251], a[68:71]
ds_read_b128 a[240:243], v12 offset:6144
ds_read_b128 a[244:247], v13 offset:6144
M a[68:71], a[204:207], a[252:255], a[68:71]
buffer_load_dwordx4 v1, s[12:15], s32 offen offset:3072 sc1 lds
M a[72:75], a[212:215], a[252:255], a[72:75]
M a[72:75], a[208:211], a[248:251], a[72:75]
M a[76:79], a[216:219], a[248:251], a[76:79]
M a[76:79], a[220:223], a[252:255], a[76:79]
s_waitcnt lgkmcnt(4)
M a[80:83], a[204:207], a[228:231], a[80:83]
ds_read_b128 a[248:251], v12 offset:8192
ds_read_b128 a[252:255], v13 offset:8192
M a[80:83], a[200:203], a[224:227], a[80:83]
M a[84:87], a[208:211], a[224:227], a[84:87]
M a[84:87], a[212:215], a[228:231], a[84:87]
M a[88:91], a[220:223], a[228:231], a[88:91]
M a[88:91], a[216:219], a[224:227], a[88:91]
s_waitcnt lgkmcnt(4)
M a[92:95], a[200:203], a[232:235], a[92:95]
ds_read_b128 a[224:227], v12 offset:10240
ds_read_b128 a[228:231], v13 offset:10240
v_accvgpr_read_b32 v24, a68
v_accvgpr_read_b32 v25, a69
v_accvgpr_read_b32 v26, a70
M a[92:95], a[204:207], a[236:239], a[92:95]
v_accvgpr_read_b32 v27, a71
v_cvt_pk_bf16_f32 v24, v24, v25
v_cvt_pk_bf16_f32 v25, v26, v27
ds_write_b64 v124, v[24:25] offset:0
M a[96:99], a[212:215], a[236:239], a[96:99]
v_accvgpr_read_b32 v28, a72
v_accvgpr_read_b32 v29, a73
v_accvgpr_read_b32 v30, a74
M a[96:99], a[208:211], a[232:235], a[96:99]
v_accvgpr_read_b32 v31, a75
v_cvt_pk_bf16_f32 v28, v28, v29
v_cvt_pk_bf16_f32 v29, v30, v31
ds_write_b64 v124, v[28:29] offset:32
M a[100:103], a[216:219], a[232:235], a[100:103]
v_accvgpr_read_b32 v24, a76
v_accvgpr_read_b32 v25, a77
v_accvgpr_read_b32 v26, a78
M a[100:103], a[220:223], a[236:239], a[100:103]
s_waitcnt lgkmcnt(6)
v_accvgpr_read_b32 v27, a79
v_cvt_pk_bf16_f32 v24, v24, v25
v_cvt_pk_bf16_f32 v25, v26, v27
ds_write_b64 v124, v[24:25] offset:64
M a[104:107], a[204:207], a[244:247], a[104:107]
ds_read_b128 a[232:235], v12 offset:12288
ds_read_b128 a[236:239], v13 offset:12288
v_accvgpr_read_b32 v24, a80
v_accvgpr_read_b32 v25, a81
v_accvgpr_read_b32 v26, a82
M a[104:107], a[200:203], a[240:243], a[104:107]
v_accvgpr_read_b32 v27, a83
v_cvt_pk_bf16_f32 v24, v24, v25
v_cvt_pk_bf16_f32 v25, v26, v27
ds_write_b64 v124, v[24:25] offset:6400
M a[108:111], a[208:211], a[240:243], a[108:111]
v_accvgpr_read_b32 v28, a84
v_accvgpr_read_b32 v29, a85
v_accvgpr_read_b32 v30, a86
M a[108:111], a[212:215], a[244:247], a[108:111]
v_accvgpr_read_b32 v31, a87
v_cvt_pk_bf16_f32 v28, v28, v29
v_cvt_pk_bf16_f32 v29, v30, v31
ds_write_b64 v124, v[28:29] offset:6432
M a[112:115], a[220:223], a[244:247], a[112:115]
v_accvgpr_read_b32 v24, a88
v_accvgpr_read_b32 v25, a89
v_accvgpr_read_b32 v26, a90
M a[112:115], a[216:219], a[240:243], a[112:115]
s_waitcnt lgkmcnt(9)
v_accvgpr_read_b32 v27, a91
v_cvt_pk_bf16_f32 v24, v24, v25
v_cvt_pk_bf16_f32 v25, v26, v27
ds_write_b64 v124, v[24:25] offset:6464
M a[116:119], a[200:203], a[248:251], a[116:119]
ds_read_b128 a[240:243], v12 offset:14336
ds_read_b128 a[244:247], v13 offset:14336
v_accvgpr_read_b32 v24, a92
v_accvgpr_read_b32 v25, a93
v_accvgpr_read_b32 v26, a94
M a[116:119], a[204:207], a[252:255], a[116:119]
v_accvgpr_read_b32 v27, a95
v_cvt_pk_bf16_f32 v24, v24, v25
v_cvt_pk_bf16_f32 v25, v26, v27
ds_write_b64 v124, v[24:25] offset:12800
M a[120:123], a[212:215], a[252:255], a[120:123]
v_accvgpr_read_b32 v28, a96
v_accvgpr_read_b32 v29, a97
v_accvgpr_read_b32 v30, a98
M a[120:123], a[208:211], a[248:251], a[120:123]
v_accvgpr_read_b32 v31, a99
v_cvt_pk_bf16_f32 v28, v28, v29
v_cvt_pk_bf16_f32 v29, v30, v31
ds_write_b64 v124, v[28:29] offset:12832
M a[124:127], a[216:219], a[248:251], a[124:127]
v_accvgpr_read_b32 v24, a100
v_accvgpr_read_b32 v25, a101
v_accvgpr_read_b32 v26, a102
M a[124:127], a[220:223], a[252:255], a[124:127]
s_add_u32 s25, s25, 32768
s_cmp_eq_u32 s25, s27
s_cselect_b32 s25, s28, s25
s_cselect_b32 s27, s56, s27
s_cselect_b32 s28, s57, s28
s_cselect_b32 s56, -1, s56
s_waitcnt lgkmcnt(12)
v_accvgpr_read_b32 v27, a103
v_cvt_pk_bf16_f32 v24, v24, v25
v_cvt_pk_bf16_f32 v25, v26, v27
ds_write_b64 v124, v[24:25] offset:12864
M a[128:131], a[204:207], a[228:231], a[128:131]
ds_read_b128 a[248:251], v12 offset:16384
ds_read_b128 a[252:255], v13 offset:16384
v_accvgpr_read_b32 v24, a104
v_accvgpr_read_b32 v25, a105
v_accvgpr_read_b32 v26, a106
M a[128:131], a[200:203], a[224:227], a[128:131]
v_accvgpr_read_b32 v27, a107
v_cvt_pk_bf16_f32 v24, v24, v25
v_cvt_pk_bf16_f32 v25, v26, v27
ds_write_b64 v124, v[24:25] offset:19200
M a[132:135], a[208:211], a[224:227], a[132:135]
v_accvgpr_read_b32 v28, a108
v_accvgpr_read_b32 v29, a109
v_accvgpr_read_b32 v30, a110
M a[132:135], a[212:215], a[228:231], a[132:135]
v_accvgpr_read_b32 v31, a111
v_cvt_pk_bf16_f32 v28, v28, v29
v_cvt_pk_bf16_f32 v29, v30, v31
ds_write_b64 v124, v[28:29] offset:19232
M a[136:139], a[220:223], a[228:231], a[136:139]
v_accvgpr_read_b32 v24, a112
v_accvgpr_read_b32 v25, a113
v_accvgpr_read_b32 v26, a114
M a[136:139], a[216:219], a[224:227], a[136:139]
s_waitcnt lgkmcnt(12)
v_accvgpr_read_b32 v27, a115
v_cvt_pk_bf16_f32 v24, v24, v25
v_cvt_pk_bf16_f32 v25, v26, v27
ds_write_b64 v124, v[24:25] offset:19264
M a[140:143], a[200:203], a[232:235], a[140:143]
v_accvgpr_read_b32 v24, a116
v_accvgpr_read_b32 v25, a117
v_accvgpr_read_b32 v26, a118
M a[140:143], a[204:207], a[236:239], a[140:143]
v_accvgpr_read_b32 v27, a119
v_cvt_pk_bf16_f32 v24, v24, v25
v_cvt_pk_bf16_f32 v25, v26, v27
ds_write_b64 v124, v[24:25] offset:25600
M a[144:147], a[212:215], a[236:239], a[144:147]
v_accvgpr_read_b32 v28, a120
v_accvgpr_read_b32 v29, a121
v_accvgpr_read_b32 v30, a122
M a[144:147], a[208:211], a[232:235], a[144:147]
v_accvgpr_read_b32 v31, a123
v_cvt_pk_bf16_f32 v28, v28, v29
v_cvt_pk_bf16_f32 v29, v30, v31
ds_write_b64 v124, v[28:29] offset:25632
M a[148:151], a[216:219], a[232:235], a[148:151]
s_waitcnt lgkmcnt(0)
s_barrier
v_accvgpr_read_b32 v24, a124
v_accvgpr_read_b32 v25, a125
v_accvgpr_read_b32 v26, a126
M a[148:151], a[220:223], a[236:239], a[148:151]
v_accvgpr_read_b32 v27, a127
v_cvt_pk_bf16_f32 v24, v24, v25
v_cvt_pk_bf16_f32 v25, v26, v27
ds_write_b64 v124, v[24:25] offset:25664
v_accvgpr_read_b32 v24, a128
v_accvgpr_read_b32 v25, a129
v_accvgpr_read_b32 v26, a130
M a[152:155], a[204:207], a[244:247], a[152:155]
v_accvgpr_read_b32 v27, a131
v_cvt_pk_bf16_f32 v24, v24, v25
v_cvt_pk_bf16_f32 v25, v26, v27
M a[152:155], a[200:203], a[240:243], a[152:155]
ds_write_b64 v124, v[24:25] offset:32000
v_accvgpr_read_b32 v28, a132
v_accvgpr_read_b32 v29, a133
M a[156:159], a[208:211], a[240:243], a[156:159]
v_accvgpr_read_b32 v30, a134
v_accvgpr_read_b32 v31, a135
v_cvt_pk_bf16_f32 v28, v28, v29
M a[156:159], a[212:215], a[244:247], a[156:159]
v_cvt_pk_bf16_f32 v29, v30, v31
ds_write_b64 v124, v[28:29] offset:32032
v_accvgpr_read_b32 v24, a136
M a[160:163], a[220:223], a[244:247], a[160:163]
v_accvgpr_read_b32 v25, a137
v_accvgpr_read_b32 v26, a138
v_accvgpr_read_b32 v27, a139
M a[160:163], a[216:219], a[240:243], a[160:163]
v_cvt_pk_bf16_f32 v24, v24, v25
v_cvt_pk_bf16_f32 v25, v26, v27
ds_write_b64 v124, v[24:25] offset:32064
M a[164:167], a[200:203], a[248:251], a[164:167]
v_accvgpr_read_b32 v24, a140
v_accvgpr_read_b32 v25, a141
v_accvgpr_read_b32 v26, a142
M a[164:167], a[204:207], a[252:255], a[164:167]
v_accvgpr_read_b32 v27, a143
v_cvt_pk_bf16_f32 v24, v24, v25
v_cvt_pk_bf16_f32 v25, v26, v27
ds_write_b64 v124, v[24:25] offset:38400
M a[168:171], a[212:215], a[252:255], a[168:171]
v_accvgpr_read_b32 v28, a144
v_accvgpr_read_b32 v29, a145
v_accvgpr_read_b32 v30, a146
M a[168:171], a[208:211], a[248:251], a[168:171]
v_accvgpr_read_b32 v31, a147
v_cvt_pk_bf16_f32 v28, v28, v29
v_cvt_pk_bf16_f32 v29, v30, v31
ds_write_b64 v124, v[28:29] offset:38432
M a[172:175], a[216:219], a[248:251], a[172:175]
v_accvgpr_read_b32 v24, a148
v_accvgpr_read_b32 v25, a149
v_accvgpr_read_b32 v26, a150
M a[172:175], a[220:223], a[252:255], a[172:175]
v_accvgpr_read_b32 v27, a151
v_cvt_pk_bf16_f32 v24, v24, v25
v_cvt_pk_bf16_f32 v25, v26, v27
ds_write_b64 v124, v[24:25] offset:38464
s_mov_b64 s[44:45], s[42:43]
v_accvgpr_read_b32 v24, a152
v_accvgpr_read_b32 v25, a153
v_accvgpr_read_b32 v26, a154
v_accvgpr_read_b32 v27, a155
v_cvt_pk_bf16_f32 v24, v24, v25
v_cvt_pk_bf16_f32 v25, v26, v27
ds_write_b64 v124, v[24:25] offset:44800
v_accvgpr_read_b32 v28, a156
v_accvgpr_read_b32 v29, a157
v_accvgpr_read_b32 v30, a158
v_accvgpr_read_b32 v31, a159
v_cvt_pk_bf16_f32 v28, v28, v29
v_cvt_pk_bf16_f32 v29, v30, v31
ds_write_b64 v124, v[28:29] offset:44832
v_accvgpr_read_b32 v24, a160
v_accvgpr_read_b32 v25, a161
v_accvgpr_read_b32 v26, a162
v_accvgpr_read_b32 v27, a163
v_cvt_pk_bf16_f32 v24, v24, v25
v_cvt_pk_bf16_f32 v25, v26, v27
ds_write_b64 v124, v[24:25] offset:44864
v_accvgpr_read_b32 v24, a164
v_accvgpr_read_b32 v25, a165
v_accvgpr_read_b32 v26, a166
v_accvgpr_read_b32 v27, a167
v_cvt_pk_bf16_f32 v24, v24, v25
v_cvt_pk_bf16_f32 v25, v26, v27
ds_write_b64 v124, v[24:25] offset:51200
v_accvgpr_read_b32 v28, a168
v_accvgpr_read_b32 v29, a169
v_accvgpr_read_b32 v30, a170
v_accvgpr_read_b32 v31, a171
v_cvt_pk_bf16_f32 v28, v28, v29
v_cvt_pk_bf16_f32 v29, v30, v31
ds_write_b64 v124, v[28:29] offset:51232
v_accvgpr_read_b32 v24, a172
v_accvgpr_read_b32 v25, a173
v_accvgpr_read_b32 v26, a174
v_accvgpr_read_b32 v27, a175
v_cvt_pk_bf16_f32 v24, v24, v25
v_cvt_pk_bf16_f32 v25, v26, v27
ds_write_b64 v124, v[24:25] offset:51264
s_waitcnt lgkmcnt(0)
s_barrier
ds_read_b128 v[48:51], v121 offset:128
ds_read_b128 v[32:35], v120 offset:0
ds_read_b128 v[52:55], v120 offset:128
ds_read_b128 v[36:39], v120 offset:12800
ds_read_b128 v[56:59], v120 offset:12928
ds_read_b128 v[40:43], v120 offset:25600
ds_read_b128 v[60:63], v120 offset:25728
ds_read_b128 v[44:47], v120 offset:38400
ds_read_b128 v[64:67], v120 offset:38528
ds_read_b64_tr_b16 v[68:69], v123 offset:256
ds_read_b64_tr_b16 v[70:71], v122 offset:256
ds_read_b64_tr_b16 v[72:73], v122 offset:13056
ds_read_b64_tr_b16 v[74:75], v122 offset:25856
ds_read_b64_tr_b16 v[76:77], v122 offset:38656
ds_read_b64_tr_b16 v[78:79], v123 offset:288
ds_read_b64_tr_b16 v[80:81], v122 offset:288
ds_read_b64_tr_b16 v[82:83], v122 offset:13088
ds_read_b64_tr_b16 v[84:85], v122 offset:25888
ds_read_b64_tr_b16 v[86:87], v122 offset:38688
v_accvgpr_write_b32 a64, 0
v_accvgpr_write_b32 a65, 0
v_accvgpr_write_b32 a66, 0
v_accvgpr_write_b32 a67, 0
v_accvgpr_write_b32 a68, 0
v_accvgpr_write_b32 a69, 0
v_accvgpr_write_b32 a70, 0
v_accvgpr_write_b32 a71, 0
v_accvgpr_write_b32 a72, 0
v_accvgpr_write_b32 a73, 0
v_accvgpr_write_b32 a74, 0
v_accvgpr_write_b32 a75, 0
s_add_u32 m0, s29, 0
s_add_u32 s32, s25, 4096
buffer_load_dwordx4 v1, s[12:15], s25 offen offset:0 sc1 lds
v_accvgpr_write_b32 a76, 0
v_accvgpr_write_b32 a77, 0
v_accvgpr_write_b32 a78, 0
v_accvgpr_write_b32 a79, 0
v_accvgpr_write_b32 a80, 0
v_accvgpr_write_b32 a81, 0
v_accvgpr_write_b32 a82, 0
v_accvgpr_write_b32 a83, 0
v_accvgpr_write_b32 a84, 0
v_accvgpr_write_b32 a85, 0
v_accvgpr_write_b32 a86, 0
buffer_load_dwordx4 v1, s[12:15], s25 offen offset:1024 sc1 lds
v_accvgpr_write_b32 a87, 0
v_accvgpr_write_b32 a88, 0
v_accvgpr_write_b32 a89, 0
v_accvgpr_write_b32 a90, 0
v_accvgpr_write_b32 a91, 0
v_accvgpr_write_b32 a92, 0
v_accvgpr_write_b32 a93, 0
v_accvgpr_write_b32 a94, 0
v_accvgpr_write_b32 a95, 0
v_accvgpr_write_b32 a96, 0
buffer_load_dwordx4 v1, s[12:15], s25 offen offset:2048 sc1 lds
v_accvgpr_write_b32 a97, 0
v_accvgpr_write_b32 a98, 0
v_accvgpr_write_b32 a99, 0
v_accvgpr_write_b32 a100, 0
v_accvgpr_write_b32 a101, 0
v_accvgpr_write_b32 a102, 0
v_accvgpr_write_b32 a103, 0
v_accvgpr_write_b32 a104, 0
v_accvgpr_write_b32 a105, 0
v_accvgpr_write_b32 a106, 0
v_accvgpr_write_b32 a107, 0
buffer_load_dwordx4 v1, s[12:15], s25 offen offset:3072 sc1 lds
v_accvgpr_write_b32 a108, 0
v_accvgpr_write_b32 a109, 0
v_accvgpr_write_b32 a110, 0
v_accvgpr_write_b32 a111, 0
s_waitcnt lgkmcnt(15)
M v[88:91], v[48:51], v[32:35], v[152:155]
M v[92:95], v[52:55], v[32:35], v[148:151]
M v[96:99], v[52:55], v[36:39], v[144:147]
s_waitcnt lgkmcnt(14)
M v[100:103], v[56:59], v[36:39], v[148:151]
s_waitcnt lgkmcnt(13)
M v[104:107], v[56:59], v[40:43], v[144:147]
s_waitcnt lgkmcnt(12)
M v[108:111], v[60:63], v[40:43], v[148:151]
s_add_u32 m0, s29, 4096
s_nop 0
buffer_load_dwordx4 v1, s[12:15], s32 offen offset:0 sc1 lds
s_waitcnt lgkmcnt(11)
M v[112:115], v[60:63], v[44:47], v[144:147]
s_waitcnt lgkmcnt(10)
M v[116:119], v[64:67], v[44:47], v[148:151]
v_max3_f32 v136, v88, v89, v90
v_max3_f32 v136, v136, v91, v92
v_max3_f32 v136, v136, v93, v94
v_max_f32 v136, v136, v95
v_max3_f32 v137, v96, v97, v98
v_max3_f32 v137, v137, v99, v100
v_max3_f32 v137, v137, v101, v102
v_max_f32 v137, v137, v103
v_max3_f32 v138, v104, v105, v106
buffer_load_dwordx4 v1, s[12:15], s32 offen offset:1024 sc1 lds
v_max3_f32 v138, v138, v107, v108
v_max3_f32 v138, v138, v109, v110
v_max_f32 v138, v138, v111
v_max3_f32 v139, v112, v113, v114
v_max3_f32 v139, v139, v115, v116
v_max3_f32 v139, v139, v117, v118
v_max_f32 v139, v139, v119
v_mov_b32 v140, v136
v_mov_b32 v141, v137
v_mov_b32 v142, v138
buffer_load_dwordx4 v1, s[12:15], s32 offen offset:2048 sc1 lds
v_mov_b32 v143, v139
v_permlane16_swap_b32 v136, v140
v_permlane16_swap_b32 v137, v141
v_permlane16_swap_b32 v138, v142
v_permlane16_swap_b32 v139, v143
v_max_f32 v136, v136, v140
v_max_f32 v137, v137, v141
v_max_f32 v138, v138, v142
v_max_f32 v139, v139, v143
v_mov_b32 v140, v136
v_mov_b32 v141, v137
buffer_load_dwordx4 v1, s[12:15], s32 offen offset:3072 sc1 lds
v_mov_b32 v142, v138
v_mov_b32 v143, v139
v_permlane32_swap_b32 v136, v140
v_permlane32_swap_b32 v137, v141
v_permlane32_swap_b32 v138, v142
v_permlane32_swap_b32 v139, v143
v_max_f32 v136, v136, v140
v_max_f32 v137, v137, v141
v_max_f32 v138, v138, v142
v_max_f32 v139, v139, v143
s_add_u32 s25, s25, 32768
s_cmp_eq_u32 s25, s27
s_cselect_b32 s25, s28, s25
s_cselect_b32 s27, s56, s27
s_cselect_b32 s28, s57, s28
s_cselect_b32 s56, -1, s56
v_mul_f32 v136, s7, v136
v_mul_f32 v137, s7, v137
v_mul_f32 v138, s7, v138
v_mul_f32 v139, s7, v139
v_fma_f32 v88, v88, s7, -v136
v_fma_f32 v89, v89, s7, -v136
v_fma_f32 v90, v90, s7, -v136
v_fma_f32 v91, v91, s7, -v136
v_fma_f32 v92, v92, s7, -v136
v_fma_f32 v93, v93, s7, -v136
v_fma_f32 v94, v94, s7, -v136
s_add_u32 m0, s29, 32768
s_add_u32 s32, s26, 4096
buffer_load_dwordx4 v1, s[12:15], s26 offen offset:0 sc1 lds
v_fma_f32 v95, v95, s7, -v136
v_exp_f32 v88, v88
v_exp_f32 v89, v89
v_exp_f32 v90, v90
v_exp_f32 v91, v91
v_exp_f32 v92, v92
v_exp_f32 v93, v93
v_exp_f32 v94, v94
v_exp_f32 v95, v95
v_fma_f32 v96, v96, s7, -v137
v_fma_f32 v97, v97, s7, -v137
buffer_load_dwordx4 v1, s[12:15], s26 offen offset:1024 sc1 lds
v_fma_f32 v98, v98, s7, -v137
v_fma_f32 v99, v99, s7, -v137
v_fma_f32 v100, v100, s7, -v137
v_fma_f32 v101, v101, s7, -v137
v_fma_f32 v102, v102, s7, -v137
v_fma_f32 v103, v103, s7, -v137
v_exp_f32 v96, v96
v_exp_f32 v97, v97
v_exp_f32 v98, v98
v_exp_f32 v99, v99
buffer_load_dwordx4 v1, s[12:15], s26 offen offset:2048 sc1 lds
v_exp_f32 v100, v100
v_exp_f32 v101, v101
v_exp_f32 v102, v102
v_exp_f32 v103, v103
v_fma_f32 v104, v104, s7, -v138
v_fma_f32 v105, v105, s7, -v138
v_fma_f32 v106, v106, s7, -v138
v_fma_f32 v107, v107, s7, -v138
v_fma_f32 v108, v108, s7, -v138
v_fma_f32 v109, v109, s7, -v138
v_fma_f32 v110, v110, s7, -v138
buffer_load_dwordx4 v1, s[12:15], s26 offen offset:3072 sc1 lds
v_fma_f32 v111, v111, s7, -v138
v_exp_f32 v104, v104
v_exp_f32 v105, v105
v_exp_f32 v106, v106
v_exp_f32 v107, v107
v_exp_f32 v108, v108
v_exp_f32 v109, v109
v_exp_f32 v110, v110
v_exp_f32 v111, v111
v_fma_f32 v112, v112, s7, -v139
s_add_u32 m0, s29, 36864
s_nop 0
buffer_load_dwordx4 v1, s[12:15], s32 offen offset:0 sc1 lds
v_fma_f32 v113, v113, s7, -v139
v_fma_f32 v114, v114, s7, -v139
v_fma_f32 v115, v115, s7, -v139
v_fma_f32 v116, v116, s7, -v139
v_fma_f32 v117, v117, s7, -v139
v_fma_f32 v118, v118, s7, -v139
v_fma_f32 v119, v119, s7, -v139
v_exp_f32 v112, v112
v_exp_f32 v113, v113
v_exp_f32 v114, v114
v_exp_f32 v115, v115
buffer_load_dwordx4 v1, s[12:15], s32 offen offset:1024 sc1 lds
v_exp_f32 v116, v116
v_exp_f32 v117, v117
v_exp_f32 v118, v118
v_exp_f32 v119, v119
v_cvt_pk_bf16_f32 v88, v88, v89
v_cvt_pk_bf16_f32 v89, v90, v91
v_cvt_pk_bf16_f32 v90, v92, v93
v_cvt_pk_bf16_f32 v91, v94, v95
v_cvt_pk_bf16_f32 v96, v96, v97
v_cvt_pk_bf16_f32 v97, v98, v99
buffer_load_dwordx4 v1, s[12:15], s32 offen offset:2048 sc1 lds
v_cvt_pk_bf16_f32 v98, v100, v101
v_cvt_pk_bf16_f32 v99, v102, v103
v_cvt_pk_bf16_f32 v104, v104, v105
v_cvt_pk_bf16_f32 v105, v106, v107
v_cvt_pk_bf16_f32 v106, v108, v109
v_cvt_pk_bf16_f32 v107, v110, v111
v_cvt_pk_bf16_f32 v112, v112, v113
v_cvt_pk_bf16_f32 v113, v114, v115
v_cvt_pk_bf16_f32 v114, v116, v117
v_cvt_pk_bf16_f32 v115, v118, v119
M v[120:123], v[156:159], v[88:91], 0
buffer_load_dwordx4 v1, s[12:15], s32 offen offset:3072 sc1 lds
s_waitcnt lgkmcnt(8)
M v[32:35], v[68:71], v[88:91], 0
s_waitcnt lgkmcnt(3)
M v[36:39], v[78:81], v[88:91], 0
M v[124:127], v[156:159], v[96:99], 0
M v[40:43], v[70:73], v[96:99], 0
s_waitcnt lgkmcnt(2)
M v[44:47], v[80:83], v[96:99], 0
M v[128:131], v[156:159], v[104:107], 0
M v[48:51], v[72:75], v[104:107], 0
s_waitcnt lgkmcnt(1)
M v[52:55], v[82:85], v[104:107], 0
M v[132:135], v[156:159], v[112:115], 0
M v[56:59], v[74:77], v[112:115], 0
s_add_u32 s26, s26, 32768
s_cmp_eq_u32 s26, s62
s_cselect_b32 s26, s63, s26
s_cselect_b32 s62, s58, s62
s_cselect_b32 s63, s59, s63
s_cselect_b32 s58, -1, s58
s_waitcnt lgkmcnt(0)
M v[60:63], v[84:87], v[112:115], 0
v_rcp_f32 v120, v120
v_rcp_f32 v124, v124
v_rcp_f32 v128, v128
v_rcp_f32 v132, v132
v_pk_mul_f32 v[32:33], v[32:33], v[120:121] op_sel_hi:[1,0]
v_pk_mul_f32 v[34:35], v[34:35], v[120:121] op_sel_hi:[1,0]
v_pk_mul_f32 v[36:37], v[36:37], v[120:121] op_sel_hi:[1,0]
v_pk_mul_f32 v[38:39], v[38:39], v[120:121] op_sel_hi:[1,0]
v_cvt_pk_bf16_f32 v32, v32, v33
v_cvt_pk_bf16_f32 v33, v34, v35
v_cvt_pk_bf16_f32 v34, v36, v37
v_cvt_pk_bf16_f32 v35, v38, v39
s_add_u32 s3, s6, 0
buffer_store_dwordx4 v[32:35], v1, s[16:19], s3 offen sc1
v_pk_mul_f32 v[40:41], v[40:41], v[124:125] op_sel_hi:[1,0]
v_pk_mul_f32 v[42:43], v[42:43], v[124:125] op_sel_hi:[1,0]
v_pk_mul_f32 v[44:45], v[44:45], v[124:125] op_sel_hi:[1,0]
v_pk_mul_f32 v[46:47], v[46:47], v[124:125] op_sel_hi:[1,0]
v_cvt_pk_bf16_f32 v40, v40, v41
v_cvt_pk_bf16_f32 v41, v42, v43
v_cvt_pk_bf16_f32 v42, v44, v45
v_cvt_pk_bf16_f32 v43, v46, v47
s_add_u32 s3, s6, 2048
buffer_store_dwordx4 v[40:43], v1, s[16:19], s3 offen sc1
v_pk_mul_f32 v[48:49], v[48:49], v[128:129] op_sel_hi:[1,0]
v_pk_mul_f32 v[50:51], v[50:51], v[128:129] op_sel_hi:[1,0]
v_pk_mul_f32 v[52:53], v[52:53], v[128:129] op_sel_hi:[1,0]
v_pk_mul_f32 v[54:55], v[54:55], v[128:129] op_sel_hi:[1,0]
v_cvt_pk_bf16_f32 v48, v48, v49
v_cvt_pk_bf16_f32 v49, v50, v51
v_cvt_pk_bf16_f32 v50, v52, v53
v_cvt_pk_bf16_f32 v51, v54, v55
s_add_u32 s3, s6, 4096
buffer_store_dwordx4 v[48:51], v1, s[16:19], s3 offen sc1
v_pk_mul_f32 v[56:57], v[56:57], v[132:133] op_sel_hi:[1,0]
v_pk_mul_f32 v[58:59], v[58:59], v[132:133] op_sel_hi:[1,0]
v_pk_mul_f32 v[60:61], v[60:61], v[132:133] op_sel_hi:[1,0]
v_pk_mul_f32 v[62:63], v[62:63], v[132:133] op_sel_hi:[1,0]
v_cvt_pk_bf16_f32 v56, v56, v57
v_cvt_pk_bf16_f32 v57, v58, v59
v_cvt_pk_bf16_f32 v58, v60, v61
v_cvt_pk_bf16_f32 v59, v62, v63
s_add_u32 s3, s6, 6144
buffer_store_dwordx4 v[56:59], v1, s[16:19], s3 offen sc1
Lc2:
s_add_u32 s16, s4, 67108864
s_addc_u32 s17, s5, 0
s_mov_b32 s18, 16777216
s_mov_b32 s19, 0x00020000
s_add_u32 s52, s4, 100663296
s_addc_u32 s53, s5, 0
s_mov_b32 s54, 8404992
s_mov_b32 s55, 0x00020000
s_mov_b32 s46, 8388608
s_mov_b32 s47, 0x00020000
s_mov_b32 s50, 2097152
s_mov_b32 s51, 0x00020000
s_lshl_b32 s33, s24, 14
v_add_u32 v2, 0, v1
v_add_u32 v3, 0x10000, v2
v_mov_b32 v5, v2
v_mov_b32 v6, v3
v_and_b32 v8, 15, v0
v_bfe_u32 v9, v0, 4, 2
v_lshlrev_b32 v9, 2, v9
v_sub_u32 v8, v8, v9
v_mov_b32 v4, 0xf149f2ca
v_cmp_gt_i32 vcc, 0, v8
s_nop 1
v_cndmask_b32 v16, 0, v4, vcc
v_cmp_gt_i32 vcc, 1, v8
s_nop 1
v_cndmask_b32 v17, 0, v4, vcc
v_cmp_gt_i32 vcc, 2, v8
s_nop 1
v_cndmask_b32 v18, 0, v4, vcc
v_cmp_gt_i32 vcc, 3, v8
s_nop 1
v_cndmask_b32 v19, 0, v4, vcc
v_mov_b32 v8, 0x3f803f80
v_accvgpr_write_b32 a112, v8
v_accvgpr_write_b32 a113, v8
v_accvgpr_write_b32 a114, v8
v_accvgpr_write_b32 a115, v8
s_lshl_b32 s33, s23, 6
s_add_i32 s33, s33, s31
s_cmp_gt_i32 s33, 0
s_cselect_b32 s34, 0, 0xf149f2ca
s_cmp_lt_i32 s33, 0
s_cselect_b32 s33, 0xf149f2ca, 0
v_mov_b32 v20, s34
v_mov_b32 v21, s34
v_mov_b32 v22, s34
v_mov_b32 v23, s34
v_mov_b32 v28, s33
v_mov_b32 v29, s33
v_mov_b32 v30, s33
v_mov_b32 v31, s33
v_med3_f32 v24, v16, v20, v28
v_med3_f32 v25, v17, v20, v28
v_med3_f32 v26, v18, v20, v28
v_med3_f32 v27, v19, v20, v28
v_mov_b32 v12, 0
v_mov_b32 v13, 1
s_waitcnt vmcnt(20)
s_barrier
ds_read_b128 a[116:119], v3 offset:0
ds_read_b128 a[120:123], v3 offset:1024
ds_read_b128 a[124:127], v3 offset:2048
ds_read_b128 a[128:131], v3 offset:3072
ds_read_b128 a[132:135], v3 offset:4096
ds_read_b128 a[136:139], v3 offset:5120
ds_read_b128 a[140:143], v3 offset:6144
ds_read_b128 a[144:147], v3 offset:7168
s_waitcnt lgkmcnt(4)
M v[32:35], a[116:119], a[0:3], v[24:27]
M v[32:35], a[120:123], a[4:7], v[32:35]
ds_read_b128 a[148:151], v3 offset:8192
ds_read_b128 a[152:155], v3 offset:9216
M v[32:35], a[124:127], a[8:11], v[32:35]
M v[32:35], a[128:131], a[12:15], v[32:35]
M v[36:39], a[128:131], a[28:31], v[28:31]
M v[36:39], a[124:127], a[24:27], v[36:39]
M v[36:39], a[120:123], a[20:23], v[36:39]
M v[36:39], a[116:119], a[16:19], v[36:39]
M v[40:43], a[116:119], a[32:35], v[28:31]
M v[40:43], a[120:123], a[36:39], v[40:43]
ds_read_b128 a[156:159], v3 offset:10240
ds_read_b128 a[160:163], v3 offset:11264
M v[40:43], a[124:127], a[40:43], v[40:43]
M v[40:43], a[128:131], a[44:47], v[40:43]
M v[44:47], a[128:131], a[60:63], v[28:31]
M v[44:47], a[124:127], a[56:59], v[44:47]
M v[44:47], a[120:123], a[52:55], v[44:47]
M v[44:47], a[116:119], a[48:51], v[44:47]
s_waitcnt lgkmcnt(4)
M v[48:51], a[132:135], a[0:3], v[20:23]
M v[48:51], a[136:139], a[4:7], v[48:51]
ds_read_b128 a[164:167], v3 offset:12288
ds_read_b128 a[168:171], v3 offset:13312
M v[48:51], a[140:143], a[8:11], v[48:51]
M v[48:51], a[144:147], a[12:15], v[48:51]
M v[52:55], a[144:147], a[28:31], v[24:27]
M v[52:55], a[140:143], a[24:27], v[52:55]
M v[52:55], a[136:139], a[20:23], v[52:55]
M v[52:55], a[132:135], a[16:19], v[52:55]
M v[56:59], a[132:135], a[32:35], v[28:31]
M v[56:59], a[136:139], a[36:39], v[56:59]
ds_read_b128 a[172:175], v3 offset:14336
ds_read_b128 a[176:179], v3 offset:15360
M v[56:59], a[140:143], a[40:43], v[56:59]
M v[56:59], a[144:147], a[44:47], v[56:59]
M v[60:63], a[144:147], a[60:63], v[28:31]
M v[60:63], a[140:143], a[56:59], v[60:63]
M v[60:63], a[136:139], a[52:55], v[60:63]
M v[60:63], a[132:135], a[48:51], v[60:63]
s_waitcnt lgkmcnt(4)
M v[64:67], a[148:151], a[0:3], v[20:23]
M v[64:67], a[152:155], a[4:7], v[64:67]
M v[64:67], a[156:159], a[8:11], v[64:67]
M v[64:67], a[160:163], a[12:15], v[64:67]
M v[68:71], a[160:163], a[28:31], v[20:23]
M v[68:71], a[156:159], a[24:27], v[68:71]
M v[68:71], a[152:155], a[20:23], v[68:71]
M v[68:71], a[148:151], a[16:19], v[68:71]
M v[72:75], a[148:151], a[32:35], v[24:27]
M v[72:75], a[152:155], a[36:39], v[72:75]
M v[72:75], a[156:159], a[40:43], v[72:75]
M v[72:75], a[160:163], a[44:47], v[72:75]
M v[76:79], a[160:163], a[60:63], v[28:31]
M v[76:79], a[156:159], a[56:59], v[76:79]
s_waitcnt vmcnt(4) lgkmcnt(0)
s_barrier
ds_read_b128 a[116:119], v2 offset:0
ds_read_b128 a[120:123], v2 offset:1024
M v[76:79], a[152:155], a[52:55], v[76:79]
M v[76:79], a[148:151], a[48:51], v[76:79]
M v[80:83], a[164:167], a[0:3], v[20:23]
M v[80:83], a[168:171], a[4:7], v[80:83]
ds_read_b128 a[124:127], v2 offset:2048
ds_read_b128 a[128:131], v2 offset:3072
M v[80:83], a[172:175], a[8:11], v[80:83]
M v[80:83], a[176:179], a[12:15], v[80:83]
M v[84:87], a[176:179], a[28:31], v[20:23]
M v[84:87], a[172:175], a[24:27], v[84:87]
ds_read_b128 a[132:135], v2 offset:4096
ds_read_b128 a[136:139], v2 offset:5120
M v[84:87], a[168:171], a[20:23], v[84:87]
M v[84:87], a[164:167], a[16:19], v[84:87]
M v[88:91], a[164:167], a[32:35], v[20:23]
M v[88:91], a[168:171], a[36:39], v[88:91]
ds_read_b128 a[140:143], v2 offset:6144
ds_read_b128 a[144:147], v2 offset:7168
M v[88:91], a[172:175], a[40:43], v[88:91]
M v[88:91], a[176:179], a[44:47], v[88:91]
M v[92:95], a[176:179], a[60:63], v[24:27]
M v[92:95], a[172:175], a[56:59], v[92:95]
M v[92:95], a[168:171], a[52:55], v[92:95]
M v[92:95], a[164:167], a[48:51], v[92:95]
s_waitcnt vmcnt(0)
s_mov_b64 exec, 1
buffer_store_dword v13, v12, s[52:55], s65 offen sc1
s_mov_b64 exec, -1
v_exp_f32 v32, v32
v_exp_f32 v33, v33
v_exp_f32 v34, v34
v_exp_f32 v35, v35
v_exp_f32 v48, v48
v_exp_f32 v49, v49
v_exp_f32 v50, v50
v_exp_f32 v51, v51
v_cvt_pk_bf16_f32 v32, v32, v33
v_cvt_pk_bf16_f32 v33, v34, v35
v_exp_f32 v36, v36
v_exp_f32 v37, v37
v_exp_f32 v38, v38
v_exp_f32 v39, v39
v_cvt_pk_bf16_f32 v34, v48, v49
v_cvt_pk_bf16_f32 v35, v50, v51
v_exp_f32 v52, v52
v_exp_f32 v53, v53
v_exp_f32 v54, v54
v_exp_f32 v55, v55
v_cvt_pk_bf16_f32 v36, v36, v37
v_cvt_pk_bf16_f32 v37, v38, v39
v_exp_f32 v40, v40
v_exp_f32 v41, v41
v_exp_f32 v42, v42
v_exp_f32 v43, v43
v_cvt_pk_bf16_f32 v38, v52, v53
v_cvt_pk_bf16_f32 v39, v54, v55
v_exp_f32 v56, v56
v_exp_f32 v57, v57
v_exp_f32 v58, v58
v_exp_f32 v59, v59
v_cvt_pk_bf16_f32 v40, v40, v41
v_cvt_pk_bf16_f32 v41, v42, v43
v_exp_f32 v44, v44
v_exp_f32 v45, v45
v_exp_f32 v46, v46
v_exp_f32 v47, v47
v_cvt_pk_bf16_f32 v42, v56, v57
v_cvt_pk_bf16_f32 v43, v58, v59
v_exp_f32 v60, v60
v_exp_f32 v61, v61
v_exp_f32 v62, v62
v_exp_f32 v63, v63
v_cvt_pk_bf16_f32 v44, v44, v45
v_cvt_pk_bf16_f32 v45, v46, v47
v_cvt_pk_bf16_f32 v46, v60, v61
v_cvt_pk_bf16_f32 v47, v62, v63
s_cmp_eq_u32 s24, 1
s_cbranch_scc1 Lk2_g1
s_mov_b32 s30, s21
s_cmp_eq_u32 s21, 0
s_cbranch_scc1 Lk2_m2
Lk2_l1:
s_add_u32 m0, s29, 65536
s_waitcnt lgkmcnt(4)
M v[96:99], a[116:119], a[0:3], 0
v_exp_f32 v64, v64
M v[96:99], a[120:123], a[4:7], v[96:99]
ds_read_b128 a[148:151], v2 offset:8192
ds_read_b128 a[152:155], v2 offset:9216
M v[96:99], a[124:127], a[8:11], v[96:99]
v_exp_f32 v65, v65
M v[96:99], a[128:131], a[12:15], v[96:99]
buffer_load_dwordx4 v1, s[12:15], s25 offen offset:0 sc1 lds
s_add_u32 s32, s25, 4096
M v[100:103], a[128:131], a[28:31], 0
v_exp_f32 v66, v66
M v[100:103], a[124:127], a[24:27], v[100:103]
v_cvt_pk_bf16_f32 v64, v64, v65
M v[100:103], a[120:123], a[20:23], v[100:103]
v_exp_f32 v67, v67
M v[100:103], a[116:119], a[16:19], v[100:103]
buffer_load_dwordx4 v1, s[12:15], s25 offen offset:1024 sc1 lds
M v[104:107], a[116:119], a[32:35], 0
v_exp_f32 v80, v80
M v[104:107], a[120:123], a[36:39], v[104:107]
ds_read_b128 a[156:159], v2 offset:10240
ds_read_b128 a[160:163], v2 offset:11264
M v[104:107], a[124:127], a[40:43], v[104:107]
v_exp_f32 v81, v81
M v[104:107], a[128:131], a[44:47], v[104:107]
buffer_load_dwordx4 v1, s[12:15], s25 offen offset:2048 sc1 lds
M v[108:111], a[128:131], a[60:63], 0
v_exp_f32 v82, v82
M v[108:111], a[124:127], a[56:59], v[108:111]
v_cvt_pk_bf16_f32 v65, v66, v67
v_cvt_pk_bf16_f32 v66, v80, v81
M v[108:111], a[120:123], a[52:55], v[108:111]
v_exp_f32 v83, v83
M v[108:111], a[116:119], a[48:51], v[108:111]
buffer_load_dwordx4 v1, s[12:15], s25 offen offset:3072 sc1 lds
s_add_u32 m0, s29, 69632
s_waitcnt lgkmcnt(4)
M v[112:115], a[132:135], a[0:3], 0
v_exp_f32 v68, v68
M v[112:115], a[136:139], a[4:7], v[112:115]
ds_read_b128 a[164:167], v2 offset:12288
ds_read_b128 a[168:171], v2 offset:13312
M v[112:115], a[140:143], a[8:11], v[112:115]
v_exp_f32 v69, v69
M v[112:115], a[144:147], a[12:15], v[112:115]
buffer_load_dwordx4 v1, s[12:15], s32 offen offset:0 sc1 lds
M v[116:119], a[144:147], a[28:31], 0
v_exp_f32 v70, v70
M v[116:119], a[140:143], a[24:27], v[116:119]
v_cvt_pk_bf16_f32 v67, v82, v83
v_cvt_pk_bf16_f32 v68, v68, v69
M v[116:119], a[136:139], a[20:23], v[116:119]
v_exp_f32 v71, v71
M v[116:119], a[132:135], a[16:19], v[116:119]
buffer_load_dwordx4 v1, s[12:15], s32 offen offset:1024 sc1 lds
M v[120:123], a[132:135], a[32:35], 0
v_exp_f32 v84, v84
M v[120:123], a[136:139], a[36:39], v[120:123]
ds_read_b128 a[172:175], v2 offset:14336
ds_read_b128 a[176:179], v2 offset:15360
M v[120:123], a[140:143], a[40:43], v[120:123]
v_exp_f32 v85, v85
M v[120:123], a[144:147], a[44:47], v[120:123]
buffer_load_dwordx4 v1, s[12:15], s32 offen offset:2048 sc1 lds
M v[124:127], a[144:147], a[60:63], 0
v_exp_f32 v86, v86
M v[124:127], a[140:143], a[56:59], v[124:127]
v_cvt_pk_bf16_f32 v69, v70, v71
v_cvt_pk_bf16_f32 v70, v84, v85
M v[124:127], a[136:139], a[52:55], v[124:127]
v_exp_f32 v87, v87
M v[124:127], a[132:135], a[48:51], v[124:127]
buffer_load_dwordx4 v1, s[12:15], s32 offen offset:3072 sc1 lds
s_add_u32 m0, s29, 98304
s_waitcnt lgkmcnt(4)
M v[128:131], a[148:151], a[0:3], 0
v_exp_f32 v72, v72
M v[128:131], a[152:155], a[4:7], v[128:131]
ds_read_b128 a[116:119], v5 offset:32768
ds_read_b128 a[120:123], v5 offset:40960
M v[128:131], a[156:159], a[8:11], v[128:131]
v_exp_f32 v73, v73
M v[128:131], a[160:163], a[12:15], v[128:131]
buffer_load_dwordx4 v1, s[12:15], s26 offen offset:0 sc1 lds
s_add_u32 s43, s26, 4096
M v[132:135], a[160:163], a[28:31], 0
v_exp_f32 v74, v74
M v[132:135], a[156:159], a[24:27], v[132:135]
v_cvt_pk_bf16_f32 v71, v86, v87
v_cvt_pk_bf16_f32 v72, v72, v73
M v[132:135], a[152:155], a[20:23], v[132:135]
v_exp_f32 v75, v75
M v[132:135], a[148:151], a[16:19], v[132:135]
buffer_load_dwordx4 v1, s[12:15], s26 offen offset:1024 sc1 lds
M v[136:139], a[148:151], a[32:35], 0
v_exp_f32 v88, v88
M v[136:139], a[152:155], a[36:39], v[136:139]
ds_read_b128 a[124:127], v5 offset:33792
ds_read_b128 a[128:131], v5 offset:41984
M v[136:139], a[156:159], a[40:43], v[136:139]
v_exp_f32 v89, v89
M v[136:139], a[160:163], a[44:47], v[136:139]
buffer_load_dwordx4 v1, s[12:15], s26 offen offset:2048 sc1 lds
M v[140:143], a[160:163], a[60:63], 0
v_exp_f32 v90, v90
M v[140:143], a[156:159], a[56:59], v[140:143]
v_cvt_pk_bf16_f32 v73, v74, v75
v_cvt_pk_bf16_f32 v74, v88, v89
M v[140:143], a[152:155], a[52:55], v[140:143]
v_exp_f32 v91, v91
M v[140:143], a[148:151], a[48:51], v[140:143]
buffer_load_dwordx4 v1, s[12:15], s26 offen offset:3072 sc1 lds
s_add_u32 m0, s29, 102400
s_waitcnt lgkmcnt(4)
M v[144:147], a[164:167], a[0:3], 0
v_exp_f32 v76, v76
M v[144:147], a[168:171], a[4:7], v[144:147]
ds_read_b128 a[132:135], v5 offset:34816
ds_read_b128 a[136:139], v5 offset:43008
M v[144:147], a[172:175], a[8:11], v[144:147]
v_exp_f32 v77, v77
M v[144:147], a[176:179], a[12:15], v[144:147]
buffer_load_dwordx4 v1, s[12:15], s43 offen offset:0 sc1 lds
M v[148:151], a[176:179], a[28:31], 0
v_exp_f32 v78, v78
M v[148:151], a[172:175], a[24:27], v[148:151]
v_cvt_pk_bf16_f32 v75, v90, v91
v_cvt_pk_bf16_f32 v76, v76, v77
M v[148:151], a[168:171], a[20:23], v[148:151]
v_exp_f32 v79, v79
M v[148:151], a[164:167], a[16:19], v[148:151]
buffer_load_dwordx4 v1, s[12:15], s43 offen offset:1024 sc1 lds
M v[152:155], a[164:167], a[32:35], 0
v_exp_f32 v92, v92
M v[152:155], a[168:171], a[36:39], v[152:155]
ds_read_b128 a[140:143], v5 offset:35840
ds_read_b128 a[144:147], v5 offset:44032
M v[152:155], a[172:175], a[40:43], v[152:155]
v_exp_f32 v93, v93
M v[152:155], a[176:179], a[44:47], v[152:155]
buffer_load_dwordx4 v1, s[12:15], s43 offen offset:2048 sc1 lds
M v[156:159], a[176:179], a[60:63], 0
v_exp_f32 v94, v94
M v[156:159], a[172:175], a[56:59], v[156:159]
v_cvt_pk_bf16_f32 v77, v78, v79
v_cvt_pk_bf16_f32 v78, v92, v93
M v[156:159], a[168:171], a[52:55], v[156:159]
v_exp_f32 v95, v95
M v[156:159], a[164:167], a[48:51], v[156:159]
buffer_load_dwordx4 v1, s[12:15], s43 offen offset:3072 sc1 lds
v_cvt_pk_bf16_f32 v79, v94, v95
s_waitcnt lgkmcnt(6)
M v[160:163], a[116:119], v[32:35], v[160:163]
v_exp_f32 v96, v96
M v[160:163], a[120:123], v[64:67], v[160:163]
ds_read_b128 a[148:151], v5 offset:36864
ds_read_b128 a[152:155], v5 offset:45056
M v[164:167], a[120:123], v[68:71], v[164:167]
v_exp_f32 v97, v97
M v[164:167], a[116:119], v[36:39], v[164:167]
v_cvt_pk_bf16_f32 v96, v96, v97
M v[168:171], a[116:119], v[40:43], v[168:171]
v_exp_f32 v98, v98
M v[168:171], a[120:123], v[72:75], v[168:171]
s_add_u32 s25, s25, 32768
s_cmp_eq_u32 s25, s27
M v[172:175], a[120:123], v[76:79], v[172:175]
v_exp_f32 v99, v99
M v[172:175], a[116:119], v[44:47], v[172:175]
v_cvt_pk_bf16_f32 v97, v98, v99
s_waitcnt lgkmcnt(6)
M a[96:99], a[112:115], v[32:35], a[96:99]
s_cselect_b32 s25, s28, s25
s_cselect_b32 s27, -1, s27
M a[96:99], a[112:115], v[64:67], a[96:99]
s_add_u32 s26, s26, 32768
s_cmp_eq_u32 s26, s62
M v[176:179], a[124:127], v[32:35], v[176:179]
v_exp_f32 v112, v112
M v[176:179], a[128:131], v[64:67], v[176:179]
ds_read_b128 a[156:159], v5 offset:37888
ds_read_b128 a[160:163], v5 offset:46080
M v[180:183], a[128:131], v[68:71], v[180:183]
v_exp_f32 v113, v113
M v[180:183], a[124:127], v[36:39], v[180:183]
v_cvt_pk_bf16_f32 v98, v112, v113
M v[184:187], a[124:127], v[40:43], v[184:187]
v_exp_f32 v114, v114
M v[184:187], a[128:131], v[72:75], v[184:187]
s_cselect_b32 s26, s63, s26
s_cselect_b32 s62, -1, s62
M v[188:191], a[128:131], v[76:79], v[188:191]
v_exp_f32 v115, v115
M v[188:191], a[124:127], v[44:47], v[188:191]
v_cvt_pk_bf16_f32 v99, v114, v115
s_waitcnt lgkmcnt(6)
M a[100:103], a[112:115], v[36:39], a[100:103]
M a[100:103], a[112:115], v[68:71], a[100:103]
M v[192:195], a[132:135], v[32:35], v[192:195]
v_exp_f32 v100, v100
M v[192:195], a[136:139], v[64:67], v[192:195]
ds_read_b128 a[164:167], v5 offset:38912
ds_read_b128 a[168:171], v5 offset:47104
M v[196:199], a[136:139], v[68:71], v[196:199]
v_exp_f32 v101, v101
M v[196:199], a[132:135], v[36:39], v[196:199]
v_cvt_pk_bf16_f32 v100, v100, v101
M v[200:203], a[132:135], v[40:43], v[200:203]
v_exp_f32 v102, v102
M v[200:203], a[136:139], v[72:75], v[200:203]
M v[204:207], a[136:139], v[76:79], v[204:207]
v_exp_f32 v103, v103
M v[204:207], a[132:135], v[44:47], v[204:207]
v_cvt_pk_bf16_f32 v101, v102, v103
s_waitcnt lgkmcnt(6)
M a[104:107], a[112:115], v[40:43], a[104:107]
M a[104:107], a[112:115], v[72:75], a[104:107]
M v[208:211], a[140:143], v[32:35], v[208:211]
v_exp_f32 v116, v116
M v[208:211], a[144:147], v[64:67], v[208:211]
ds_read_b128 a[172:175], v5 offset:39936
ds_read_b128 a[176:179], v5 offset:48128
M v[212:215], a[144:147], v[68:71], v[212:215]
v_exp_f32 v117, v117
M v[212:215], a[140:143], v[36:39], v[212:215]
v_cvt_pk_bf16_f32 v102, v116, v117
M v[216:219], a[140:143], v[40:43], v[216:219]
v_exp_f32 v118, v118
M v[216:219], a[144:147], v[72:75], v[216:219]
M v[220:223], a[144:147], v[76:79], v[220:223]
v_exp_f32 v119, v119
M v[220:223], a[140:143], v[44:47], v[220:223]
v_cvt_pk_bf16_f32 v103, v118, v119
s_waitcnt lgkmcnt(6)
M a[108:111], a[112:115], v[44:47], a[108:111]
M a[108:111], a[112:115], v[76:79], a[108:111]
M v[224:227], a[148:151], v[32:35], v[224:227]
v_exp_f32 v104, v104
M v[224:227], a[152:155], v[64:67], v[224:227]
M v[228:231], a[152:155], v[68:71], v[228:231]
v_exp_f32 v105, v105
M v[228:231], a[148:151], v[36:39], v[228:231]
v_cvt_pk_bf16_f32 v104, v104, v105
M v[232:235], a[148:151], v[40:43], v[232:235]
v_exp_f32 v106, v106
M v[232:235], a[152:155], v[72:75], v[232:235]
M v[236:239], a[152:155], v[76:79], v[236:239]
v_exp_f32 v107, v107
M v[236:239], a[148:151], v[44:47], v[236:239]
v_cvt_pk_bf16_f32 v105, v106, v107
s_waitcnt lgkmcnt(4)
M v[240:243], a[156:159], v[32:35], v[240:243]
v_exp_f32 v120, v120
M v[240:243], a[160:163], v[64:67], v[240:243]
M v[244:247], a[160:163], v[68:71], v[244:247]
v_exp_f32 v121, v121
M v[244:247], a[156:159], v[36:39], v[244:247]
v_cvt_pk_bf16_f32 v106, v120, v121
M v[248:251], a[156:159], v[40:43], v[248:251]
v_exp_f32 v122, v122
M v[248:251], a[160:163], v[72:75], v[248:251]
s_waitcnt vmcnt(0) lgkmcnt(0)
s_barrier
ds_read_b128 a[116:119], v3 offset:0
ds_read_b128 a[120:123], v3 offset:1024
M v[252:255], a[160:163], v[76:79], v[252:255]
v_exp_f32 v123, v123
M v[252:255], a[156:159], v[44:47], v[252:255]
v_cvt_pk_bf16_f32 v107, v122, v123
M a[64:67], a[164:167], v[32:35], a[64:67]
v_exp_f32 v108, v108
M a[64:67], a[168:171], v[64:67], a[64:67]
ds_read_b128 a[124:127], v3 offset:2048
ds_read_b128 a[128:131], v3 offset:3072
M a[68:71], a[168:171], v[68:71], a[68:71]
v_exp_f32 v109, v109
M a[68:71], a[164:167], v[36:39], a[68:71]
v_cvt_pk_bf16_f32 v108, v108, v109
M a[72:75], a[164:167], v[40:43], a[72:75]
v_exp_f32 v110, v110
M a[72:75], a[168:171], v[72:75], a[72:75]
ds_read_b128 a[132:135], v3 offset:4096
ds_read_b128 a[136:139], v3 offset:5120
M a[76:79], a[168:171], v[76:79], a[76:79]
v_exp_f32 v111, v111
M a[76:79], a[164:167], v[44:47], a[76:79]
v_cvt_pk_bf16_f32 v109, v110, v111
M a[80:83], a[172:175], v[32:35], a[80:83]
v_exp_f32 v124, v124
M a[80:83], a[176:179], v[64:67], a[80:83]
ds_read_b128 a[140:143], v3 offset:6144
ds_read_b128 a[144:147], v3 offset:7168
M a[84:87], a[176:179], v[68:71], a[84:87]
v_exp_f32 v125, v125
M a[84:87], a[172:175], v[36:39], a[84:87]
v_cvt_pk_bf16_f32 v110, v124, v125
M a[88:91], a[172:175], v[40:43], a[88:91]
v_exp_f32 v126, v126
M a[88:91], a[176:179], v[72:75], a[88:91]
M a[92:95], a[176:179], v[76:79], a[92:95]
v_exp_f32 v127, v127
M a[92:95], a[172:175], v[44:47], a[92:95]
v_cvt_pk_bf16_f32 v111, v126, v127
s_sub_u32 s30, s30, 1
s_cmp_eq_u32 s30, 0
s_cbranch_scc1 Lk2_m1
s_add_u32 m0, s29, 0
s_waitcnt lgkmcnt(4)
M v[32:35], a[116:119], a[0:3], 0
v_exp_f32 v128, v128
M v[32:35], a[120:123], a[4:7], v[32:35]
ds_read_b128 a[148:151], v3 offset:8192
ds_read_b128 a[152:155], v3 offset:9216
M v[32:35], a[124:127], a[8:11], v[32:35]
v_exp_f32 v129, v129
M v[32:35], a[128:131], a[12:15], v[32:35]
buffer_load_dwordx4 v1, s[12:15], s25 offen offset:0 sc1 lds
s_add_u32 s32, s25, 4096
M v[36:39], a[128:131], a[28:31], 0
v_exp_f32 v130, v130
M v[36:39], a[124:127], a[24:27], v[36:39]
v_cvt_pk_bf16_f32 v128, v128, v129
M v[36:39], a[120:123], a[20:23], v[36:39]
v_exp_f32 v131, v131
M v[36:39], a[116:119], a[16:19], v[36:39]
buffer_load_dwordx4 v1, s[12:15], s25 offen offset:1024 sc1 lds
M v[40:43], a[116:119], a[32:35], 0
v_exp_f32 v144, v144
M v[40:43], a[120:123], a[36:39], v[40:43]
ds_read_b128 a[156:159], v3 offset:10240
ds_read_b128 a[160:163], v3 offset:11264
M v[40:43], a[124:127], a[40:43], v[40:43]
v_exp_f32 v145, v145
M v[40:43], a[128:131], a[44:47], v[40:43]
buffer_load_dwordx4 v1, s[12:15], s25 offen offset:2048 sc1 lds
M v[44:47], a[128:131], a[60:63], 0
v_exp_f32 v146, v146
M v[44:47], a[124:127], a[56:59], v[44:47]
v_cvt_pk_bf16_f32 v129, v130, v131
v_cvt_pk_bf16_f32 v130, v144, v145
M v[44:47], a[120:123], a[52:55], v[44:47]
v_exp_f32 v147, v147
M v[44:47], a[116:119], a[48:51], v[44:47]
buffer_load_dwordx4 v1, s[12:15], s25 offen offset:3072 sc1 lds
s_add_u32 m0, s29, 4096
s_waitcnt lgkmcnt(4)
M v[48:51], a[132:135], a[0:3], 0
v_exp_f32 v132, v132
M v[48:51], a[136:139], a[4:7], v[48:51]
ds_read_b128 a[164:167], v3 offset:12288
ds_read_b128 a[168:171], v3 offset:13312
M v[48:51], a[140:143], a[8:11], v[48:51]
v_exp_f32 v133, v133
M v[48:51], a[144:147], a[12:15], v[48:51]
buffer_load_dwordx4 v1, s[12:15], s32 offen offset:0 sc1 lds
M v[52:55], a[144:147], a[28:31], 0
v_exp_f32 v134, v134
M v[52:55], a[140:143], a[24:27], v[52:55]
v_cvt_pk_bf16_f32 v131, v146, v147
v_cvt_pk_bf16_f32 v132, v132, v133
M v[52:55], a[136:139], a[20:23], v[52:55]
v_exp_f32 v135, v135
M v[52:55], a[132:135], a[16:19], v[52:55]
buffer_load_dwordx4 v1, s[12:15], s32 offen offset:1024 sc1 lds
M v[56:59], a[132:135], a[32:35], 0
v_exp_f32 v148, v148
M v[56:59], a[136:139], a[36:39], v[56:59]
ds_read_b128 a[172:175], v3 offset:14336
ds_read_b128 a[176:179], v3 offset:15360
M v[56:59], a[140:143], a[40:43], v[56:59]
v_exp_f32 v149, v149
M v[56:59], a[144:147], a[44:47], v[56:59]
buffer_load_dwordx4 v1, s[12:15], s32 offen offset:2048 sc1 lds
M v[60:63], a[144:147], a[60:63], 0
v_exp_f32 v150, v150
M v[60:63], a[140:143], a[56:59], v[60:63]
v_cvt_pk_bf16_f32 v133, v134, v135
v_cvt_pk_bf16_f32 v134, v148, v149
M v[60:63], a[136:139], a[52:55], v[60:63]
v_exp_f32 v151, v151
M v[60:63], a[132:135], a[48:51], v[60:63]
buffer_load_dwordx4 v1, s[12:15], s32 offen offset:3072 sc1 lds
s_add_u32 m0, s29, 32768
s_waitcnt lgkmcnt(4)
M v[64:67], a[148:151], a[0:3], 0
v_exp_f32 v136, v136
M v[64:67], a[152:155], a[4:7], v[64:67]
ds_read_b128 a[116:119], v6 offset:32768
ds_read_b128 a[120:123], v6 offset:40960
M v[64:67], a[156:159], a[8:11], v[64:67]
v_exp_f32 v137, v137
M v[64:67], a[160:163], a[12:15], v[64:67]
buffer_load_dwordx4 v1, s[12:15], s26 offen offset:0 sc1 lds
s_add_u32 s43, s26, 4096
M v[68:71], a[160:163], a[28:31], 0
v_exp_f32 v138, v138
M v[68:71], a[156:159], a[24:27], v[68:71]
v_cvt_pk_bf16_f32 v135, v150, v151
v_cvt_pk_bf16_f32 v136, v136, v137
M v[68:71], a[152:155], a[20:23], v[68:71]
v_exp_f32 v139, v139
M v[68:71], a[148:151], a[16:19], v[68:71]
buffer_load_dwordx4 v1, s[12:15], s26 offen offset:1024 sc1 lds
M v[72:75], a[148:151], a[32:35], 0
v_exp_f32 v152, v152
M v[72:75], a[152:155], a[36:39], v[72:75]
ds_read_b128 a[124:127], v6 offset:33792
ds_read_b128 a[128:131], v6 offset:41984
M v[72:75], a[156:159], a[40:43], v[72:75]
v_exp_f32 v153, v153
M v[72:75], a[160:163], a[44:47], v[72:75]
buffer_load_dwordx4 v1, s[12:15], s26 offen offset:2048 sc1 lds
M v[76:79], a[160:163], a[60:63], 0
v_exp_f32 v154, v154
M v[76:79], a[156:159], a[56:59], v[76:79]
v_cvt_pk_bf16_f32 v137, v138, v139
v_cvt_pk_bf16_f32 v138, v152, v153
M v[76:79], a[152:155], a[52:55], v[76:79]
v_exp_f32 v155, v155
M v[76:79], a[148:151], a[48:51], v[76:79]
buffer_load_dwordx4 v1, s[12:15], s26 offen offset:3072 sc1 lds
s_add_u32 m0, s29, 36864
s_waitcnt lgkmcnt(4)
M v[80:83], a[164:167], a[0:3], 0
v_exp_f32 v140, v140
M v[80:83], a[168:171], a[4:7], v[80:83]
ds_read_b128 a[132:135], v6 offset:34816
ds_read_b128 a[136:139], v6 offset:43008
M v[80:83], a[172:175], a[8:11], v[80:83]
v_exp_f32 v141, v141
M v[80:83], a[176:179], a[12:15], v[80:83]
buffer_load_dwordx4 v1, s[12:15], s43 offen offset:0 sc1 lds
M v[84:87], a[176:179], a[28:31], 0
v_exp_f32 v142, v142
M v[84:87], a[172:175], a[24:27], v[84:87]
v_cvt_pk_bf16_f32 v139, v154, v155
v_cvt_pk_bf16_f32 v140, v140, v141
M v[84:87], a[168:171], a[20:23], v[84:87]
v_exp_f32 v143, v143
M v[84:87], a[164:167], a[16:19], v[84:87]
buffer_load_dwordx4 v1, s[12:15], s43 offen offset:1024 sc1 lds
M v[88:91], a[164:167], a[32:35], 0
v_exp_f32 v156, v156
M v[88:91], a[168:171], a[36:39], v[88:91]
ds_read_b128 a[140:143], v6 offset:35840
ds_read_b128 a[144:147], v6 offset:44032
M v[88:91], a[172:175], a[40:43], v[88:91]
v_exp_f32 v157, v157
M v[88:91], a[176:179], a[44:47], v[88:91]
buffer_load_dwordx4 v1, s[12:15], s43 offen offset:2048 sc1 lds
M v[92:95], a[176:179], a[60:63], 0
v_exp_f32 v158, v158
M v[92:95], a[172:175], a[56:59], v[92:95]
v_cvt_pk_bf16_f32 v141, v142, v143
v_cvt_pk_bf16_f32 v142, v156, v157
M v[92:95], a[168:171], a[52:55], v[92:95]
v_exp_f32 v159, v159
M v[92:95], a[164:167], a[48:51], v[92:95]
buffer_load_dwordx4 v1, s[12:15], s43 offen offset:3072 sc1 lds
v_cvt_pk_bf16_f32 v143, v158, v159
s_waitcnt lgkmcnt(6)
M v[160:163], a[116:119], v[96:99], v[160:163]
v_exp_f32 v32, v32
M v[160:163], a[120:123], v[128:131], v[160:163]
ds_read_b128 a[148:151], v6 offset:36864
ds_read_b128 a[152:155], v6 offset:45056
M v[164:167], a[120:123], v[132:135], v[164:167]
v_exp_f32 v33, v33
M v[164:167], a[116:119], v[100:103], v[164:167]
v_cvt_pk_bf16_f32 v32, v32, v33
M v[168:171], a[116:119], v[104:107], v[168:171]
v_exp_f32 v34, v34
M v[168:171], a[120:123], v[136:139], v[168:171]
s_add_u32 s25, s25, 32768
s_cmp_eq_u32 s25, s27
M v[172:175], a[120:123], v[140:143], v[172:175]
v_exp_f32 v35, v35
M v[172:175], a[116:119], v[108:111], v[172:175]
v_cvt_pk_bf16_f32 v33, v34, v35
s_waitcnt lgkmcnt(6)
M a[96:99], a[112:115], v[96:99], a[96:99]
s_cselect_b32 s25, s28, s25
s_cselect_b32 s27, -1, s27
M a[96:99], a[112:115], v[128:131], a[96:99]
s_add_u32 s26, s26, 32768
s_cmp_eq_u32 s26, s62
M v[176:179], a[124:127], v[96:99], v[176:179]
v_exp_f32 v48, v48
M v[176:179], a[128:131], v[128:131], v[176:179]
ds_read_b128 a[156:159], v6 offset:37888
ds_read_b128 a[160:163], v6 offset:46080
M v[180:183], a[128:131], v[132:135], v[180:183]
v_exp_f32 v49, v49
M v[180:183], a[124:127], v[100:103], v[180:183]
v_cvt_pk_bf16_f32 v34, v48, v49
M v[184:187], a[124:127], v[104:107], v[184:187]
v_exp_f32 v50, v50
M v[184:187], a[128:131], v[136:139], v[184:187]
s_cselect_b32 s26, s63, s26
s_cselect_b32 s62, -1, s62
M v[188:191], a[128:131], v[140:143], v[188:191]
v_exp_f32 v51, v51
M v[188:191], a[124:127], v[108:111], v[188:191]
v_cvt_pk_bf16_f32 v35, v50, v51
s_waitcnt lgkmcnt(6)
M a[100:103], a[112:115], v[100:103], a[100:103]
M a[100:103], a[112:115], v[132:135], a[100:103]
M v[192:195], a[132:135], v[96:99], v[192:195]
v_exp_f32 v36, v36
M v[192:195], a[136:139], v[128:131], v[192:195]
ds_read_b128 a[164:167], v6 offset:38912
ds_read_b128 a[168:171], v6 offset:47104
M v[196:199], a[136:139], v[132:135], v[196:199]
v_exp_f32 v37, v37
M v[196:199], a[132:135], v[100:103], v[196:199]
v_cvt_pk_bf16_f32 v36, v36, v37
M v[200:203], a[132:135], v[104:107], v[200:203]
v_exp_f32 v38, v38
M v[200:203], a[136:139], v[136:139], v[200:203]
M v[204:207], a[136:139], v[140:143], v[204:207]
v_exp_f32 v39, v39
M v[204:207], a[132:135], v[108:111], v[204:207]
v_cvt_pk_bf16_f32 v37, v38, v39
s_waitcnt lgkmcnt(6)
M a[104:107], a[112:115], v[104:107], a[104:107]
M a[104:107], a[112:115], v[136:139], a[104:107]
M v[208:211], a[140:143], v[96:99], v[208:211]
v_exp_f32 v52, v52
M v[208:211], a[144:147], v[128:131], v[208:211]
ds_read_b128 a[172:175], v6 offset:39936
ds_read_b128 a[176:179], v6 offset:48128
M v[212:215], a[144:147], v[132:135], v[212:215]
v_exp_f32 v53, v53
M v[212:215], a[140:143], v[100:103], v[212:215]
v_cvt_pk_bf16_f32 v38, v52, v53
M v[216:219], a[140:143], v[104:107], v[216:219]
v_exp_f32 v54, v54
M v[216:219], a[144:147], v[136:139], v[216:219]
M v[220:223], a[144:147], v[140:143], v[220:223]
v_exp_f32 v55, v55
M v[220:223], a[140:143], v[108:111], v[220:223]
v_cvt_pk_bf16_f32 v39, v54, v55
s_waitcnt lgkmcnt(6)
M a[108:111], a[112:115], v[108:111], a[108:111]
M a[108:111], a[112:115], v[140:143], a[108:111]
M v[224:227], a[148:151], v[96:99], v[224:227]
v_exp_f32 v40, v40
M v[224:227], a[152:155], v[128:131], v[224:227]
M v[228:231], a[152:155], v[132:135], v[228:231]
v_exp_f32 v41, v41
M v[228:231], a[148:151], v[100:103], v[228:231]
v_cvt_pk_bf16_f32 v40, v40, v41
M v[232:235], a[148:151], v[104:107], v[232:235]
v_exp_f32 v42, v42
M v[232:235], a[152:155], v[136:139], v[232:235]
M v[236:239], a[152:155], v[140:143], v[236:239]
v_exp_f32 v43, v43
M v[236:239], a[148:151], v[108:111], v[236:239]
v_cvt_pk_bf16_f32 v41, v42, v43
s_waitcnt lgkmcnt(4)
M v[240:243], a[156:159], v[96:99], v[240:243]
v_exp_f32 v56, v56
M v[240:243], a[160:163], v[128:131], v[240:243]
M v[244:247], a[160:163], v[132:135], v[244:247]
v_exp_f32 v57, v57
M v[244:247], a[156:159], v[100:103], v[244:247]
v_cvt_pk_bf16_f32 v42, v56, v57
M v[248:251], a[156:159], v[104:107], v[248:251]
v_exp_f32 v58, v58
M v[248:251], a[160:163], v[136:139], v[248:251]
s_waitcnt vmcnt(0) lgkmcnt(0)
s_barrier
ds_read_b128 a[116:119], v2 offset:0
ds_read_b128 a[120:123], v2 offset:1024
M v[252:255], a[160:163], v[140:143], v[252:255]
v_exp_f32 v59, v59
M v[252:255], a[156:159], v[108:111], v[252:255]
v_cvt_pk_bf16_f32 v43, v58, v59
M a[64:67], a[164:167], v[96:99], a[64:67]
v_exp_f32 v44, v44
M a[64:67], a[168:171], v[128:131], a[64:67]
ds_read_b128 a[124:127], v2 offset:2048
ds_read_b128 a[128:131], v2 offset:3072
M a[68:71], a[168:171], v[132:135], a[68:71]
v_exp_f32 v45, v45
M a[68:71], a[164:167], v[100:103], a[68:71]
v_cvt_pk_bf16_f32 v44, v44, v45
M a[72:75], a[164:167], v[104:107], a[72:75]
v_exp_f32 v46, v46
M a[72:75], a[168:171], v[136:139], a[72:75]
ds_read_b128 a[132:135], v2 offset:4096
ds_read_b128 a[136:139], v2 offset:5120
M a[76:79], a[168:171], v[140:143], a[76:79]
v_exp_f32 v47, v47
M a[76:79], a[164:167], v[108:111], a[76:79]
v_cvt_pk_bf16_f32 v45, v46, v47
M a[80:83], a[172:175], v[96:99], a[80:83]
v_exp_f32 v60, v60
M a[80:83], a[176:179], v[128:131], a[80:83]
ds_read_b128 a[140:143], v2 offset:6144
ds_read_b128 a[144:147], v2 offset:7168
M a[84:87], a[176:179], v[132:135], a[84:87]
v_exp_f32 v61, v61
M a[84:87], a[172:175], v[100:103], a[84:87]
v_cvt_pk_bf16_f32 v46, v60, v61
M a[88:91], a[172:175], v[104:107], a[88:91]
v_exp_f32 v62, v62
M a[88:91], a[176:179], v[136:139], a[88:91]
M a[92:95], a[176:179], v[140:143], a[92:95]
v_exp_f32 v63, v63
M a[92:95], a[172:175], v[108:111], a[92:95]
v_cvt_pk_bf16_f32 v47, v62, v63
s_branch Lk2_l1
Lk2_m1:
s_lshl_b32 s33, s23, 6
s_add_i32 s33, s33, 0
s_cmp_gt_i32 s33, 0
s_cselect_b32 s34, 0, 0xf149f2ca
s_cmp_lt_i32 s33, 0
s_cselect_b32 s33, 0xf149f2ca, 0
v_mov_b32 v20, s34
v_mov_b32 v21, s34
v_mov_b32 v22, s34
v_mov_b32 v23, s34
v_mov_b32 v28, s33
v_mov_b32 v29, s33
v_mov_b32 v30, s33
v_mov_b32 v31, s33
v_med3_f32 v24, v16, v20, v28
v_med3_f32 v25, v17, v20, v28
v_med3_f32 v26, v18, v20, v28
v_med3_f32 v27, v19, v20, v28
s_add_u32 m0, s29, 0
s_waitcnt lgkmcnt(4)
M v[32:35], a[116:119], a[0:3], v[24:27]
v_exp_f32 v128, v128
M v[32:35], a[120:123], a[4:7], v[32:35]
ds_read_b128 a[148:151], v3 offset:8192
ds_read_b128 a[152:155], v3 offset:9216
M v[32:35], a[124:127], a[8:11], v[32:35]
v_exp_f32 v129, v129
M v[32:35], a[128:131], a[12:15], v[32:35]
buffer_load_dwordx4 v1, s[12:15], s25 offen offset:0 sc1 lds
s_add_u32 s32, s25, 4096
M v[36:39], a[128:131], a[28:31], v[28:31]
v_exp_f32 v130, v130
M v[36:39], a[124:127], a[24:27], v[36:39]
v_cvt_pk_bf16_f32 v128, v128, v129
M v[36:39], a[120:123], a[20:23], v[36:39]
v_exp_f32 v131, v131
M v[36:39], a[116:119], a[16:19], v[36:39]
buffer_load_dwordx4 v1, s[12:15], s25 offen offset:1024 sc1 lds
M v[40:43], a[116:119], a[32:35], v[28:31]
v_exp_f32 v144, v144
M v[40:43], a[120:123], a[36:39], v[40:43]
ds_read_b128 a[156:159], v3 offset:10240
ds_read_b128 a[160:163], v3 offset:11264
M v[40:43], a[124:127], a[40:43], v[40:43]
v_exp_f32 v145, v145
M v[40:43], a[128:131], a[44:47], v[40:43]
buffer_load_dwordx4 v1, s[12:15], s25 offen offset:2048 sc1 lds
M v[44:47], a[128:131], a[60:63], v[28:31]
v_exp_f32 v146, v146
M v[44:47], a[124:127], a[56:59], v[44:47]
v_cvt_pk_bf16_f32 v129, v130, v131
v_cvt_pk_bf16_f32 v130, v144, v145
M v[44:47], a[120:123], a[52:55], v[44:47]
v_exp_f32 v147, v147
M v[44:47], a[116:119], a[48:51], v[44:47]
buffer_load_dwordx4 v1, s[12:15], s25 offen offset:3072 sc1 lds
s_add_u32 m0, s29, 4096
s_waitcnt lgkmcnt(4)
M v[48:51], a[132:135], a[0:3], v[20:23]
v_exp_f32 v132, v132
M v[48:51], a[136:139], a[4:7], v[48:51]
ds_read_b128 a[164:167], v3 offset:12288
ds_read_b128 a[168:171], v3 offset:13312
M v[48:51], a[140:143], a[8:11], v[48:51]
v_exp_f32 v133, v133
M v[48:51], a[144:147], a[12:15], v[48:51]
buffer_load_dwordx4 v1, s[12:15], s32 offen offset:0 sc1 lds
M v[52:55], a[144:147], a[28:31], v[24:27]
v_exp_f32 v134, v134
M v[52:55], a[140:143], a[24:27], v[52:55]
v_cvt_pk_bf16_f32 v131, v146, v147
v_cvt_pk_bf16_f32 v132, v132, v133
M v[52:55], a[136:139], a[20:23], v[52:55]
v_exp_f32 v135, v135
M v[52:55], a[132:135], a[16:19], v[52:55]
buffer_load_dwordx4 v1, s[12:15], s32 offen offset:1024 sc1 lds
M v[56:59], a[132:135], a[32:35], v[28:31]
v_exp_f32 v148, v148
M v[56:59], a[136:139], a[36:39], v[56:59]
ds_read_b128 a[172:175], v3 offset:14336
ds_read_b128 a[176:179], v3 offset:15360
M v[56:59], a[140:143], a[40:43], v[56:59]
v_exp_f32 v149, v149
M v[56:59], a[144:147], a[44:47], v[56:59]
buffer_load_dwordx4 v1, s[12:15], s32 offen offset:2048 sc1 lds
M v[60:63], a[144:147], a[60:63], v[28:31]
v_exp_f32 v150, v150
M v[60:63], a[140:143], a[56:59], v[60:63]
v_cvt_pk_bf16_f32 v133, v134, v135
v_cvt_pk_bf16_f32 v134, v148, v149
M v[60:63], a[136:139], a[52:55], v[60:63]
v_exp_f32 v151, v151
M v[60:63], a[132:135], a[48:51], v[60:63]
buffer_load_dwordx4 v1, s[12:15], s32 offen offset:3072 sc1 lds
s_add_u32 m0, s29, 32768
s_waitcnt lgkmcnt(4)
M v[64:67], a[148:151], a[0:3], v[20:23]
v_exp_f32 v136, v136
M v[64:67], a[152:155], a[4:7], v[64:67]
ds_read_b128 a[116:119], v6 offset:32768
ds_read_b128 a[120:123], v6 offset:40960
M v[64:67], a[156:159], a[8:11], v[64:67]
v_exp_f32 v137, v137
M v[64:67], a[160:163], a[12:15], v[64:67]
buffer_load_dwordx4 v1, s[12:15], s26 offen offset:0 sc1 lds
s_add_u32 s43, s26, 4096
M v[68:71], a[160:163], a[28:31], v[20:23]
v_exp_f32 v138, v138
M v[68:71], a[156:159], a[24:27], v[68:71]
v_cvt_pk_bf16_f32 v135, v150, v151
v_cvt_pk_bf16_f32 v136, v136, v137
M v[68:71], a[152:155], a[20:23], v[68:71]
v_exp_f32 v139, v139
M v[68:71], a[148:151], a[16:19], v[68:71]
buffer_load_dwordx4 v1, s[12:15], s26 offen offset:1024 sc1 lds
M v[72:75], a[148:151], a[32:35], v[24:27]
v_exp_f32 v152, v152
M v[72:75], a[152:155], a[36:39], v[72:75]
ds_read_b128 a[124:127], v6 offset:33792
ds_read_b128 a[128:131], v6 offset:41984
M v[72:75], a[156:159], a[40:43], v[72:75]
v_exp_f32 v153, v153
M v[72:75], a[160:163], a[44:47], v[72:75]
buffer_load_dwordx4 v1, s[12:15], s26 offen offset:2048 sc1 lds
M v[76:79], a[160:163], a[60:63], v[28:31]
v_exp_f32 v154, v154
M v[76:79], a[156:159], a[56:59], v[76:79]
v_cvt_pk_bf16_f32 v137, v138, v139
v_cvt_pk_bf16_f32 v138, v152, v153
M v[76:79], a[152:155], a[52:55], v[76:79]
v_exp_f32 v155, v155
M v[76:79], a[148:151], a[48:51], v[76:79]
buffer_load_dwordx4 v1, s[12:15], s26 offen offset:3072 sc1 lds
s_add_u32 m0, s29, 36864
s_waitcnt lgkmcnt(4)
M v[80:83], a[164:167], a[0:3], v[20:23]
v_exp_f32 v140, v140
M v[80:83], a[168:171], a[4:7], v[80:83]
ds_read_b128 a[132:135], v6 offset:34816
ds_read_b128 a[136:139], v6 offset:43008
M v[80:83], a[172:175], a[8:11], v[80:83]
v_exp_f32 v141, v141
M v[80:83], a[176:179], a[12:15], v[80:83]
buffer_load_dwordx4 v1, s[12:15], s43 offen offset:0 sc1 lds
M v[84:87], a[176:179], a[28:31], v[20:23]
v_exp_f32 v142, v142
M v[84:87], a[172:175], a[24:27], v[84:87]
v_cvt_pk_bf16_f32 v139, v154, v155
v_cvt_pk_bf16_f32 v140, v140, v141
M v[84:87], a[168:171], a[20:23], v[84:87]
v_exp_f32 v143, v143
M v[84:87], a[164:167], a[16:19], v[84:87]
buffer_load_dwordx4 v1, s[12:15], s43 offen offset:1024 sc1 lds
M v[88:91], a[164:167], a[32:35], v[20:23]
v_exp_f32 v156, v156
M v[88:91], a[168:171], a[36:39], v[88:91]
ds_read_b128 a[140:143], v6 offset:35840
ds_read_b128 a[144:147], v6 offset:44032
M v[88:91], a[172:175], a[40:43], v[88:91]
v_exp_f32 v157, v157
M v[88:91], a[176:179], a[44:47], v[88:91]
buffer_load_dwordx4 v1, s[12:15], s43 offen offset:2048 sc1 lds
M v[92:95], a[176:179], a[60:63], v[24:27]
v_exp_f32 v158, v158
M v[92:95], a[172:175], a[56:59], v[92:95]
v_cvt_pk_bf16_f32 v141, v142, v143
v_cvt_pk_bf16_f32 v142, v156, v157
M v[92:95], a[168:171], a[52:55], v[92:95]
v_exp_f32 v159, v159
M v[92:95], a[164:167], a[48:51], v[92:95]
buffer_load_dwordx4 v1, s[12:15], s43 offen offset:3072 sc1 lds
v_cvt_pk_bf16_f32 v143, v158, v159
s_waitcnt lgkmcnt(6)
M v[160:163], a[116:119], v[96:99], v[160:163]
v_exp_f32 v32, v32
M v[160:163], a[120:123], v[128:131], v[160:163]
ds_read_b128 a[148:151], v6 offset:36864
ds_read_b128 a[152:155], v6 offset:45056
M v[164:167], a[120:123], v[132:135], v[164:167]
v_exp_f32 v33, v33
M v[164:167], a[116:119], v[100:103], v[164:167]
v_cvt_pk_bf16_f32 v32, v32, v33
M v[168:171], a[116:119], v[104:107], v[168:171]
v_exp_f32 v34, v34
M v[168:171], a[120:123], v[136:139], v[168:171]
s_add_u32 s25, s25, 32768
s_cmp_eq_u32 s25, s27
M v[172:175], a[120:123], v[140:143], v[172:175]
v_exp_f32 v35, v35
M v[172:175], a[116:119], v[108:111], v[172:175]
v_cvt_pk_bf16_f32 v33, v34, v35
s_waitcnt lgkmcnt(6)
M a[96:99], a[112:115], v[96:99], a[96:99]
s_cselect_b32 s25, s28, s25
s_cselect_b32 s27, -1, s27
M a[96:99], a[112:115], v[128:131], a[96:99]
s_add_u32 s26, s26, 32768
s_cmp_eq_u32 s26, s62
M v[176:179], a[124:127], v[96:99], v[176:179]
v_exp_f32 v48, v48
M v[176:179], a[128:131], v[128:131], v[176:179]
ds_read_b128 a[156:159], v6 offset:37888
ds_read_b128 a[160:163], v6 offset:46080
M v[180:183], a[128:131], v[132:135], v[180:183]
v_exp_f32 v49, v49
M v[180:183], a[124:127], v[100:103], v[180:183]
v_cvt_pk_bf16_f32 v34, v48, v49
M v[184:187], a[124:127], v[104:107], v[184:187]
v_exp_f32 v50, v50
M v[184:187], a[128:131], v[136:139], v[184:187]
s_cselect_b32 s26, s63, s26
s_cselect_b32 s62, -1, s62
M v[188:191], a[128:131], v[140:143], v[188:191]
v_exp_f32 v51, v51
M v[188:191], a[124:127], v[108:111], v[188:191]
v_cvt_pk_bf16_f32 v35, v50, v51
s_waitcnt lgkmcnt(6)
M a[100:103], a[112:115], v[100:103], a[100:103]
M a[100:103], a[112:115], v[132:135], a[100:103]
M v[192:195], a[132:135], v[96:99], v[192:195]
v_exp_f32 v36, v36
M v[192:195], a[136:139], v[128:131], v[192:195]
ds_read_b128 a[164:167], v6 offset:38912
ds_read_b128 a[168:171], v6 offset:47104
M v[196:199], a[136:139], v[132:135], v[196:199]
v_exp_f32 v37, v37
M v[196:199], a[132:135], v[100:103], v[196:199]
v_cvt_pk_bf16_f32 v36, v36, v37
M v[200:203], a[132:135], v[104:107], v[200:203]
v_exp_f32 v38, v38
M v[200:203], a[136:139], v[136:139], v[200:203]
M v[204:207], a[136:139], v[140:143], v[204:207]
v_exp_f32 v39, v39
M v[204:207], a[132:135], v[108:111], v[204:207]
v_cvt_pk_bf16_f32 v37, v38, v39
s_waitcnt lgkmcnt(6)
M a[104:107], a[112:115], v[104:107], a[104:107]
M a[104:107], a[112:115], v[136:139], a[104:107]
M v[208:211], a[140:143], v[96:99], v[208:211]
v_exp_f32 v52, v52
M v[208:211], a[144:147], v[128:131], v[208:211]
ds_read_b128 a[172:175], v6 offset:39936
ds_read_b128 a[176:179], v6 offset:48128
M v[212:215], a[144:147], v[132:135], v[212:215]
v_exp_f32 v53, v53
M v[212:215], a[140:143], v[100:103], v[212:215]
v_cvt_pk_bf16_f32 v38, v52, v53
M v[216:219], a[140:143], v[104:107], v[216:219]
v_exp_f32 v54, v54
M v[216:219], a[144:147], v[136:139], v[216:219]
M v[220:223], a[144:147], v[140:143], v[220:223]
v_exp_f32 v55, v55
M v[220:223], a[140:143], v[108:111], v[220:223]
v_cvt_pk_bf16_f32 v39, v54, v55
s_waitcnt lgkmcnt(6)
M a[108:111], a[112:115], v[108:111], a[108:111]
M a[108:111], a[112:115], v[140:143], a[108:111]
M v[224:227], a[148:151], v[96:99], v[224:227]
v_exp_f32 v40, v40
M v[224:227], a[152:155], v[128:131], v[224:227]
M v[228:231], a[152:155], v[132:135], v[228:231]
v_exp_f32 v41, v41
M v[228:231], a[148:151], v[100:103], v[228:231]
v_cvt_pk_bf16_f32 v40, v40, v41
M v[232:235], a[148:151], v[104:107], v[232:235]
v_exp_f32 v42, v42
M v[232:235], a[152:155], v[136:139], v[232:235]
M v[236:239], a[152:155], v[140:143], v[236:239]
v_exp_f32 v43, v43
M v[236:239], a[148:151], v[108:111], v[236:239]
v_cvt_pk_bf16_f32 v41, v42, v43
s_waitcnt lgkmcnt(4)
M v[240:243], a[156:159], v[96:99], v[240:243]
v_exp_f32 v56, v56
M v[240:243], a[160:163], v[128:131], v[240:243]
M v[244:247], a[160:163], v[132:135], v[244:247]
v_exp_f32 v57, v57
M v[244:247], a[156:159], v[100:103], v[244:247]
v_cvt_pk_bf16_f32 v42, v56, v57
M v[248:251], a[156:159], v[104:107], v[248:251]
v_exp_f32 v58, v58
M v[248:251], a[160:163], v[136:139], v[248:251]
s_waitcnt vmcnt(0) lgkmcnt(0)
s_barrier
ds_read_b128 a[116:119], v2 offset:0
ds_read_b128 a[120:123], v2 offset:1024
M v[252:255], a[160:163], v[140:143], v[252:255]
v_exp_f32 v59, v59
M v[252:255], a[156:159], v[108:111], v[252:255]
v_cvt_pk_bf16_f32 v43, v58, v59
M a[64:67], a[164:167], v[96:99], a[64:67]
v_exp_f32 v44, v44
M a[64:67], a[168:171], v[128:131], a[64:67]
ds_read_b128 a[124:127], v2 offset:2048
ds_read_b128 a[128:131], v2 offset:3072
M a[68:71], a[168:171], v[132:135], a[68:71]
v_exp_f32 v45, v45
M a[68:71], a[164:167], v[100:103], a[68:71]
v_cvt_pk_bf16_f32 v44, v44, v45
M a[72:75], a[164:167], v[104:107], a[72:75]
v_exp_f32 v46, v46
M a[72:75], a[168:171], v[136:139], a[72:75]
ds_read_b128 a[132:135], v2 offset:4096
ds_read_b128 a[136:139], v2 offset:5120
M a[76:79], a[168:171], v[140:143], a[76:79]
v_exp_f32 v47, v47
M a[76:79], a[164:167], v[108:111], a[76:79]
v_cvt_pk_bf16_f32 v45, v46, v47
M a[80:83], a[172:175], v[96:99], a[80:83]
v_exp_f32 v60, v60
M a[80:83], a[176:179], v[128:131], a[80:83]
ds_read_b128 a[140:143], v2 offset:6144
ds_read_b128 a[144:147], v2 offset:7168
M a[84:87], a[176:179], v[132:135], a[84:87]
v_exp_f32 v61, v61
M a[84:87], a[172:175], v[100:103], a[84:87]
v_cvt_pk_bf16_f32 v46, v60, v61
M a[88:91], a[172:175], v[104:107], a[88:91]
v_exp_f32 v62, v62
M a[88:91], a[176:179], v[136:139], a[88:91]
M a[92:95], a[176:179], v[140:143], a[92:95]
v_exp_f32 v63, v63
M a[92:95], a[172:175], v[108:111], a[92:95]
v_cvt_pk_bf16_f32 v47, v62, v63
Lk2_m2:
s_sub_u32 s35, 15, s21
s_lshl_b32 s33, s20, 7
s_lshl_b32 s34, s35, 3
s_add_u32 s33, s33, s34
s_lshl_b32 s34, s23, 2
s_add_u32 s33, s33, s34
s_lshl_b32 s33, s33, 12
buffer_load_dwordx4 a[180:183], v1, s[8:11], s33 offen offset:0 sc1
buffer_load_dwordx4 a[184:187], v1, s[8:11], s33 offen offset:1024 sc1
buffer_load_dwordx4 a[188:191], v1, s[8:11], s33 offen offset:2048 sc1
buffer_load_dwordx4 a[192:195], v1, s[8:11], s33 offen offset:3072 sc1
s_add_u32 s33, s33, 4096
buffer_load_dwordx4 a[196:199], v1, s[8:11], s33 offen offset:0 sc1
buffer_load_dwordx4 a[200:203], v1, s[8:11], s33 offen offset:1024 sc1
buffer_load_dwordx4 a[204:207], v1, s[8:11], s33 offen offset:2048 sc1
buffer_load_dwordx4 a[208:211], v1, s[8:11], s33 offen offset:3072 sc1
s_add_u32 s33, s33, 4096
buffer_load_dwordx4 a[212:215], v1, s[8:11], s33 offen offset:0 sc1
buffer_load_dwordx4 a[216:219], v1, s[8:11], s33 offen offset:1024 sc1
buffer_load_dwordx4 a[220:223], v1, s[8:11], s33 offen offset:2048 sc1
buffer_load_dwordx4 a[224:227], v1, s[8:11], s33 offen offset:3072 sc1
s_add_u32 s33, s33, 4096
buffer_load_dwordx4 a[228:231], v1, s[8:11], s33 offen offset:0 sc1
buffer_load_dwordx4 a[232:235], v1, s[8:11], s33 offen offset:1024 sc1
buffer_load_dwordx4 a[236:239], v1, s[8:11], s33 offen offset:2048 sc1
buffer_load_dwordx4 a[240:243], v1, s[8:11], s33 offen offset:3072 sc1
s_lshl_b32 s33, s23, 6
s_add_i32 s33, s33, -64
s_cmp_gt_i32 s33, 0
s_cselect_b32 s34, 0, 0xf149f2ca
s_cmp_lt_i32 s33, 0
s_cselect_b32 s33, 0xf149f2ca, 0
v_mov_b32 v20, s34
v_mov_b32 v21, s34
v_mov_b32 v22, s34
v_mov_b32 v23, s34
v_mov_b32 v28, s33
v_mov_b32 v29, s33
v_mov_b32 v30, s33
v_mov_b32 v31, s33
v_med3_f32 v24, v16, v20, v28
v_med3_f32 v25, v17, v20, v28
v_med3_f32 v26, v18, v20, v28
v_med3_f32 v27, v19, v20, v28
s_add_u32 m0, s29, 65536
s_waitcnt lgkmcnt(4)
M v[96:99], a[116:119], a[0:3], v[24:27]
v_exp_f32 v64, v64
M v[96:99], a[120:123], a[4:7], v[96:99]
ds_read_b128 a[148:151], v2 offset:8192
ds_read_b128 a[152:155], v2 offset:9216
M v[96:99], a[124:127], a[8:11], v[96:99]
v_exp_f32 v65, v65
M v[96:99], a[128:131], a[12:15], v[96:99]
buffer_load_dwordx4 v1, s[12:15], s25 offen offset:0 sc1 lds
s_add_u32 s32, s25, 4096
M v[100:103], a[128:131], a[28:31], v[28:31]
v_exp_f32 v66, v66
M v[100:103], a[124:127], a[24:27], v[100:103]
v_cvt_pk_bf16_f32 v64, v64, v65
M v[100:103], a[120:123], a[20:23], v[100:103]
v_exp_f32 v67, v67
M v[100:103], a[116:119], a[16:19], v[100:103]
buffer_load_dwordx4 v1, s[12:15], s25 offen offset:1024 sc1 lds
M v[104:107], a[116:119], a[32:35], v[28:31]
v_exp_f32 v80, v80
M v[104:107], a[120:123], a[36:39], v[104:107]
ds_read_b128 a[156:159], v2 offset:10240
ds_read_b128 a[160:163], v2 offset:11264
M v[104:107], a[124:127], a[40:43], v[104:107]
v_exp_f32 v81, v81
M v[104:107], a[128:131], a[44:47], v[104:107]
buffer_load_dwordx4 v1, s[12:15], s25 offen offset:2048 sc1 lds
M v[108:111], a[128:131], a[60:63], v[28:31]
v_exp_f32 v82, v82
M v[108:111], a[124:127], a[56:59], v[108:111]
v_cvt_pk_bf16_f32 v65, v66, v67
v_cvt_pk_bf16_f32 v66, v80, v81
M v[108:111], a[120:123], a[52:55], v[108:111]
v_exp_f32 v83, v83
M v[108:111], a[116:119], a[48:51], v[108:111]
buffer_load_dwordx4 v1, s[12:15], s25 offen offset:3072 sc1 lds
s_add_u32 m0, s29, 69632
s_waitcnt lgkmcnt(4)
M v[112:115], a[132:135], a[0:3], v[20:23]
v_exp_f32 v68, v68
M v[112:115], a[136:139], a[4:7], v[112:115]
ds_read_b128 a[164:167], v2 offset:12288
ds_read_b128 a[168:171], v2 offset:13312
M v[112:115], a[140:143], a[8:11], v[112:115]
v_exp_f32 v69, v69
M v[112:115], a[144:147], a[12:15], v[112:115]
buffer_load_dwordx4 v1, s[12:15], s32 offen offset:0 sc1 lds
M v[116:119], a[144:147], a[28:31], v[24:27]
v_exp_f32 v70, v70
M v[116:119], a[140:143], a[24:27], v[116:119]
v_cvt_pk_bf16_f32 v67, v82, v83
v_cvt_pk_bf16_f32 v68, v68, v69
M v[116:119], a[136:139], a[20:23], v[116:119]
v_exp_f32 v71, v71
M v[116:119], a[132:135], a[16:19], v[116:119]
buffer_load_dwordx4 v1, s[12:15], s32 offen offset:1024 sc1 lds
M v[120:123], a[132:135], a[32:35], v[28:31]
v_exp_f32 v84, v84
M v[120:123], a[136:139], a[36:39], v[120:123]
ds_read_b128 a[172:175], v2 offset:14336
ds_read_b128 a[176:179], v2 offset:15360
M v[120:123], a[140:143], a[40:43], v[120:123]
v_exp_f32 v85, v85
M v[120:123], a[144:147], a[44:47], v[120:123]
buffer_load_dwordx4 v1, s[12:15], s32 offen offset:2048 sc1 lds
M v[124:127], a[144:147], a[60:63], v[28:31]
v_exp_f32 v86, v86
M v[124:127], a[140:143], a[56:59], v[124:127]
v_cvt_pk_bf16_f32 v69, v70, v71
v_cvt_pk_bf16_f32 v70, v84, v85
M v[124:127], a[136:139], a[52:55], v[124:127]
v_exp_f32 v87, v87
M v[124:127], a[132:135], a[48:51], v[124:127]
buffer_load_dwordx4 v1, s[12:15], s32 offen offset:3072 sc1 lds
s_add_u32 m0, s29, 98304
s_waitcnt lgkmcnt(4)
M v[128:131], a[148:151], a[0:3], v[20:23]
v_exp_f32 v72, v72
M v[128:131], a[152:155], a[4:7], v[128:131]
ds_read_b128 a[116:119], v5 offset:32768
ds_read_b128 a[120:123], v5 offset:40960
M v[128:131], a[156:159], a[8:11], v[128:131]
v_exp_f32 v73, v73
M v[128:131], a[160:163], a[12:15], v[128:131]
buffer_load_dwordx4 v1, s[12:15], s26 offen offset:0 sc1 lds
s_add_u32 s43, s26, 4096
M v[132:135], a[160:163], a[28:31], v[20:23]
v_exp_f32 v74, v74
M v[132:135], a[156:159], a[24:27], v[132:135]
v_cvt_pk_bf16_f32 v71, v86, v87
v_cvt_pk_bf16_f32 v72, v72, v73
M v[132:135], a[152:155], a[20:23], v[132:135]
v_exp_f32 v75, v75
M v[132:135], a[148:151], a[16:19], v[132:135]
buffer_load_dwordx4 v1, s[12:15], s26 offen offset:1024 sc1 lds
M v[136:139], a[148:151], a[32:35], v[24:27]
v_exp_f32 v88, v88
M v[136:139], a[152:155], a[36:39], v[136:139]
ds_read_b128 a[124:127], v5 offset:33792
ds_read_b128 a[128:131], v5 offset:41984
M v[136:139], a[156:159], a[40:43], v[136:139]
v_exp_f32 v89, v89
M v[136:139], a[160:163], a[44:47], v[136:139]
buffer_load_dwordx4 v1, s[12:15], s26 offen offset:2048 sc1 lds
M v[140:143], a[160:163], a[60:63], v[28:31]
v_exp_f32 v90, v90
M v[140:143], a[156:159], a[56:59], v[140:143]
v_cvt_pk_bf16_f32 v73, v74, v75
v_cvt_pk_bf16_f32 v74, v88, v89
M v[140:143], a[152:155], a[52:55], v[140:143]
v_exp_f32 v91, v91
M v[140:143], a[148:151], a[48:51], v[140:143]
buffer_load_dwordx4 v1, s[12:15], s26 offen offset:3072 sc1 lds
s_add_u32 m0, s29, 102400
s_waitcnt lgkmcnt(4)
M v[144:147], a[164:167], a[0:3], v[20:23]
v_exp_f32 v76, v76
M v[144:147], a[168:171], a[4:7], v[144:147]
ds_read_b128 a[132:135], v5 offset:34816
ds_read_b128 a[136:139], v5 offset:43008
M v[144:147], a[172:175], a[8:11], v[144:147]
v_exp_f32 v77, v77
M v[144:147], a[176:179], a[12:15], v[144:147]
buffer_load_dwordx4 v1, s[12:15], s43 offen offset:0 sc1 lds
M v[148:151], a[176:179], a[28:31], v[20:23]
v_exp_f32 v78, v78
M v[148:151], a[172:175], a[24:27], v[148:151]
v_cvt_pk_bf16_f32 v75, v90, v91
v_cvt_pk_bf16_f32 v76, v76, v77
M v[148:151], a[168:171], a[20:23], v[148:151]
v_exp_f32 v79, v79
M v[148:151], a[164:167], a[16:19], v[148:151]
buffer_load_dwordx4 v1, s[12:15], s43 offen offset:1024 sc1 lds
M v[152:155], a[164:167], a[32:35], v[20:23]
v_exp_f32 v92, v92
M v[152:155], a[168:171], a[36:39], v[152:155]
ds_read_b128 a[140:143], v5 offset:35840
ds_read_b128 a[144:147], v5 offset:44032
M v[152:155], a[172:175], a[40:43], v[152:155]
v_exp_f32 v93, v93
M v[152:155], a[176:179], a[44:47], v[152:155]
buffer_load_dwordx4 v1, s[12:15], s43 offen offset:2048 sc1 lds
M v[156:159], a[176:179], a[60:63], v[24:27]
v_exp_f32 v94, v94
M v[156:159], a[172:175], a[56:59], v[156:159]
v_cvt_pk_bf16_f32 v77, v78, v79
v_cvt_pk_bf16_f32 v78, v92, v93
M v[156:159], a[168:171], a[52:55], v[156:159]
v_exp_f32 v95, v95
M v[156:159], a[164:167], a[48:51], v[156:159]
buffer_load_dwordx4 v1, s[12:15], s43 offen offset:3072 sc1 lds
v_cvt_pk_bf16_f32 v79, v94, v95
s_waitcnt lgkmcnt(6)
M v[160:163], a[116:119], v[32:35], v[160:163]
v_exp_f32 v96, v96
M v[160:163], a[120:123], v[64:67], v[160:163]
ds_read_b128 a[148:151], v5 offset:36864
ds_read_b128 a[152:155], v5 offset:45056
M v[164:167], a[120:123], v[68:71], v[164:167]
v_exp_f32 v97, v97
M v[164:167], a[116:119], v[36:39], v[164:167]
v_cvt_pk_bf16_f32 v96, v96, v97
M v[168:171], a[116:119], v[40:43], v[168:171]
v_exp_f32 v98, v98
M v[168:171], a[120:123], v[72:75], v[168:171]
s_add_u32 s25, s25, 32768
s_cmp_eq_u32 s25, s27
M v[172:175], a[120:123], v[76:79], v[172:175]
v_exp_f32 v99, v99
M v[172:175], a[116:119], v[44:47], v[172:175]
v_cvt_pk_bf16_f32 v97, v98, v99
s_waitcnt lgkmcnt(6)
M a[96:99], a[112:115], v[32:35], a[96:99]
s_cselect_b32 s25, s28, s25
s_cselect_b32 s27, -1, s27
M a[96:99], a[112:115], v[64:67], a[96:99]
s_add_u32 s26, s26, 32768
s_cmp_eq_u32 s26, s62
M v[176:179], a[124:127], v[32:35], v[176:179]
v_exp_f32 v112, v112
M v[176:179], a[128:131], v[64:67], v[176:179]
ds_read_b128 a[156:159], v5 offset:37888
ds_read_b128 a[160:163], v5 offset:46080
M v[180:183], a[128:131], v[68:71], v[180:183]
v_exp_f32 v113, v113
M v[180:183], a[124:127], v[36:39], v[180:183]
v_cvt_pk_bf16_f32 v98, v112, v113
M v[184:187], a[124:127], v[40:43], v[184:187]
v_exp_f32 v114, v114
M v[184:187], a[128:131], v[72:75], v[184:187]
s_cselect_b32 s26, s63, s26
s_cselect_b32 s62, -1, s62
M v[188:191], a[128:131], v[76:79], v[188:191]
v_exp_f32 v115, v115
M v[188:191], a[124:127], v[44:47], v[188:191]
v_cvt_pk_bf16_f32 v99, v114, v115
s_waitcnt lgkmcnt(6)
M a[100:103], a[112:115], v[36:39], a[100:103]
M a[100:103], a[112:115], v[68:71], a[100:103]
M v[192:195], a[132:135], v[32:35], v[192:195]
v_exp_f32 v100, v100
M v[192:195], a[136:139], v[64:67], v[192:195]
ds_read_b128 a[164:167], v5 offset:38912
ds_read_b128 a[168:171], v5 offset:47104
M v[196:199], a[136:139], v[68:71], v[196:199]
v_exp_f32 v101, v101
M v[196:199], a[132:135], v[36:39], v[196:199]
v_cvt_pk_bf16_f32 v100, v100, v101
M v[200:203], a[132:135], v[40:43], v[200:203]
v_exp_f32 v102, v102
M v[200:203], a[136:139], v[72:75], v[200:203]
M v[204:207], a[136:139], v[76:79], v[204:207]
v_exp_f32 v103, v103
M v[204:207], a[132:135], v[44:47], v[204:207]
v_cvt_pk_bf16_f32 v101, v102, v103
s_waitcnt lgkmcnt(6)
M a[104:107], a[112:115], v[40:43], a[104:107]
M a[104:107], a[112:115], v[72:75], a[104:107]
M v[208:211], a[140:143], v[32:35], v[208:211]
v_exp_f32 v116, v116
M v[208:211], a[144:147], v[64:67], v[208:211]
ds_read_b128 a[172:175], v5 offset:39936
ds_read_b128 a[176:179], v5 offset:48128
M v[212:215], a[144:147], v[68:71], v[212:215]
v_exp_f32 v117, v117
M v[212:215], a[140:143], v[36:39], v[212:215]
v_cvt_pk_bf16_f32 v102, v116, v117
M v[216:219], a[140:143], v[40:43], v[216:219]
v_exp_f32 v118, v118
M v[216:219], a[144:147], v[72:75], v[216:219]
M v[220:223], a[144:147], v[76:79], v[220:223]
v_exp_f32 v119, v119
M v[220:223], a[140:143], v[44:47], v[220:223]
v_cvt_pk_bf16_f32 v103, v118, v119
s_waitcnt lgkmcnt(6)
M a[108:111], a[112:115], v[44:47], a[108:111]
M a[108:111], a[112:115], v[76:79], a[108:111]
M v[224:227], a[148:151], v[32:35], v[224:227]
v_exp_f32 v104, v104
M v[224:227], a[152:155], v[64:67], v[224:227]
M v[228:231], a[152:155], v[68:71], v[228:231]
v_exp_f32 v105, v105
M v[228:231], a[148:151], v[36:39], v[228:231]
v_cvt_pk_bf16_f32 v104, v104, v105
M v[232:235], a[148:151], v[40:43], v[232:235]
v_exp_f32 v106, v106
M v[232:235], a[152:155], v[72:75], v[232:235]
M v[236:239], a[152:155], v[76:79], v[236:239]
v_exp_f32 v107, v107
M v[236:239], a[148:151], v[44:47], v[236:239]
v_cvt_pk_bf16_f32 v105, v106, v107
s_waitcnt lgkmcnt(4)
M v[240:243], a[156:159], v[32:35], v[240:243]
v_exp_f32 v120, v120
M v[240:243], a[160:163], v[64:67], v[240:243]
M v[244:247], a[160:163], v[68:71], v[244:247]
v_exp_f32 v121, v121
M v[244:247], a[156:159], v[36:39], v[244:247]
v_cvt_pk_bf16_f32 v106, v120, v121
M v[248:251], a[156:159], v[40:43], v[248:251]
v_exp_f32 v122, v122
M v[248:251], a[160:163], v[72:75], v[248:251]
s_waitcnt vmcnt(0) lgkmcnt(0)
s_barrier
ds_read_b128 a[116:119], v3 offset:0
ds_read_b128 a[120:123], v3 offset:1024
M v[252:255], a[160:163], v[76:79], v[252:255]
v_exp_f32 v123, v123
M v[252:255], a[156:159], v[44:47], v[252:255]
v_cvt_pk_bf16_f32 v107, v122, v123
M a[64:67], a[164:167], v[32:35], a[64:67]
v_exp_f32 v108, v108
M a[64:67], a[168:171], v[64:67], a[64:67]
ds_read_b128 a[124:127], v3 offset:2048
ds_read_b128 a[128:131], v3 offset:3072
M a[68:71], a[168:171], v[68:71], a[68:71]
v_exp_f32 v109, v109
M a[68:71], a[164:167], v[36:39], a[68:71]
v_cvt_pk_bf16_f32 v108, v108, v109
M a[72:75], a[164:167], v[40:43], a[72:75]
v_exp_f32 v110, v110
M a[72:75], a[168:171], v[72:75], a[72:75]
ds_read_b128 a[132:135], v3 offset:4096
ds_read_b128 a[136:139], v3 offset:5120
M a[76:79], a[168:171], v[76:79], a[76:79]
v_exp_f32 v111, v111
M a[76:79], a[164:167], v[44:47], a[76:79]
v_cvt_pk_bf16_f32 v109, v110, v111
M a[80:83], a[172:175], v[32:35], a[80:83]
v_exp_f32 v124, v124
M a[80:83], a[176:179], v[64:67], a[80:83]
ds_read_b128 a[140:143], v3 offset:6144
ds_read_b128 a[144:147], v3 offset:7168
M a[84:87], a[176:179], v[68:71], a[84:87]
v_exp_f32 v125, v125
M a[84:87], a[172:175], v[36:39], a[84:87]
v_cvt_pk_bf16_f32 v110, v124, v125
M a[88:91], a[172:175], v[40:43], a[88:91]
v_exp_f32 v126, v126
M a[88:91], a[176:179], v[72:75], a[88:91]
M a[92:95], a[176:179], v[76:79], a[92:95]
v_exp_f32 v127, v127
M a[92:95], a[172:175], v[44:47], a[92:95]
v_cvt_pk_bf16_f32 v111, v126, v127
s_waitcnt vmcnt(16)
s_add_u32 m0, s29, 0
s_waitcnt lgkmcnt(4)
M v[32:35], a[116:119], a[180:183], 0
v_exp_f32 v128, v128
M v[32:35], a[120:123], a[184:187], v[32:35]
ds_read_b128 a[148:151], v3 offset:8192
ds_read_b128 a[152:155], v3 offset:9216
M v[32:35], a[124:127], a[188:191], v[32:35]
v_exp_f32 v129, v129
M v[32:35], a[128:131], a[192:195], v[32:35]
buffer_load_dwordx4 v1, s[12:15], s25 offen offset:0 sc1 lds
s_add_u32 s32, s25, 4096
M v[36:39], a[128:131], a[208:211], 0
v_exp_f32 v130, v130
M v[36:39], a[124:127], a[204:207], v[36:39]
v_cvt_pk_bf16_f32 v128, v128, v129
M v[36:39], a[120:123], a[200:203], v[36:39]
v_exp_f32 v131, v131
M v[36:39], a[116:119], a[196:199], v[36:39]
buffer_load_dwordx4 v1, s[12:15], s25 offen offset:1024 sc1 lds
M v[40:43], a[116:119], a[212:215], 0
v_exp_f32 v144, v144
M v[40:43], a[120:123], a[216:219], v[40:43]
ds_read_b128 a[156:159], v3 offset:10240
ds_read_b128 a[160:163], v3 offset:11264
M v[40:43], a[124:127], a[220:223], v[40:43]
v_exp_f32 v145, v145
M v[40:43], a[128:131], a[224:227], v[40:43]
buffer_load_dwordx4 v1, s[12:15], s25 offen offset:2048 sc1 lds
M v[44:47], a[128:131], a[240:243], 0
v_exp_f32 v146, v146
M v[44:47], a[124:127], a[236:239], v[44:47]
v_cvt_pk_bf16_f32 v129, v130, v131
v_cvt_pk_bf16_f32 v130, v144, v145
M v[44:47], a[120:123], a[232:235], v[44:47]
v_exp_f32 v147, v147
M v[44:47], a[116:119], a[228:231], v[44:47]
buffer_load_dwordx4 v1, s[12:15], s25 offen offset:3072 sc1 lds
s_add_u32 m0, s29, 4096
s_waitcnt lgkmcnt(4)
M v[48:51], a[132:135], a[180:183], 0
v_exp_f32 v132, v132
M v[48:51], a[136:139], a[184:187], v[48:51]
ds_read_b128 a[164:167], v3 offset:12288
ds_read_b128 a[168:171], v3 offset:13312
M v[48:51], a[140:143], a[188:191], v[48:51]
v_exp_f32 v133, v133
M v[48:51], a[144:147], a[192:195], v[48:51]
buffer_load_dwordx4 v1, s[12:15], s32 offen offset:0 sc1 lds
M v[52:55], a[144:147], a[208:211], 0
v_exp_f32 v134, v134
M v[52:55], a[140:143], a[204:207], v[52:55]
v_cvt_pk_bf16_f32 v131, v146, v147
v_cvt_pk_bf16_f32 v132, v132, v133
M v[52:55], a[136:139], a[200:203], v[52:55]
v_exp_f32 v135, v135
M v[52:55], a[132:135], a[196:199], v[52:55]
buffer_load_dwordx4 v1, s[12:15], s32 offen offset:1024 sc1 lds
M v[56:59], a[132:135], a[212:215], 0
v_exp_f32 v148, v148
M v[56:59], a[136:139], a[216:219], v[56:59]
ds_read_b128 a[172:175], v3 offset:14336
ds_read_b128 a[176:179], v3 offset:15360
M v[56:59], a[140:143], a[220:223], v[56:59]
v_exp_f32 v149, v149
M v[56:59], a[144:147], a[224:227], v[56:59]
buffer_load_dwordx4 v1, s[12:15], s32 offen offset:2048 sc1 lds
M v[60:63], a[144:147], a[240:243], 0
v_exp_f32 v150, v150
M v[60:63], a[140:143], a[236:239], v[60:63]
v_cvt_pk_bf16_f32 v133, v134, v135
v_cvt_pk_bf16_f32 v134, v148, v149
M v[60:63], a[136:139], a[232:235], v[60:63]
v_exp_f32 v151, v151
M v[60:63], a[132:135], a[228:231], v[60:63]
buffer_load_dwordx4 v1, s[12:15], s32 offen offset:3072 sc1 lds
s_add_u32 m0, s29, 32768
s_waitcnt lgkmcnt(4)
M v[64:67], a[148:151], a[180:183], 0
v_exp_f32 v136, v136
M v[64:67], a[152:155], a[184:187], v[64:67]
ds_read_b128 a[116:119], v6 offset:32768
ds_read_b128 a[120:123], v6 offset:40960
M v[64:67], a[156:159], a[188:191], v[64:67]
v_exp_f32 v137, v137
M v[64:67], a[160:163], a[192:195], v[64:67]
buffer_load_dwordx4 v1, s[12:15], s26 offen offset:0 sc1 lds
s_add_u32 s43, s26, 4096
M v[68:71], a[160:163], a[208:211], 0
v_exp_f32 v138, v138
M v[68:71], a[156:159], a[204:207], v[68:71]
v_cvt_pk_bf16_f32 v135, v150, v151
v_cvt_pk_bf16_f32 v136, v136, v137
M v[68:71], a[152:155], a[200:203], v[68:71]
v_exp_f32 v139, v139
M v[68:71], a[148:151], a[196:199], v[68:71]
buffer_load_dwordx4 v1, s[12:15], s26 offen offset:1024 sc1 lds
M v[72:75], a[148:151], a[212:215], 0
v_exp_f32 v152, v152
M v[72:75], a[152:155], a[216:219], v[72:75]
ds_read_b128 a[124:127], v6 offset:33792
ds_read_b128 a[128:131], v6 offset:41984
M v[72:75], a[156:159], a[220:223], v[72:75]
v_exp_f32 v153, v153
M v[72:75], a[160:163], a[224:227], v[72:75]
buffer_load_dwordx4 v1, s[12:15], s26 offen offset:2048 sc1 lds
M v[76:79], a[160:163], a[240:243], 0
v_exp_f32 v154, v154
M v[76:79], a[156:159], a[236:239], v[76:79]
v_cvt_pk_bf16_f32 v137, v138, v139
v_cvt_pk_bf16_f32 v138, v152, v153
M v[76:79], a[152:155], a[232:235], v[76:79]
v_exp_f32 v155, v155
M v[76:79], a[148:151], a[228:231], v[76:79]
buffer_load_dwordx4 v1, s[12:15], s26 offen offset:3072 sc1 lds
s_add_u32 m0, s29, 36864
s_waitcnt lgkmcnt(4)
M v[80:83], a[164:167], a[180:183], 0
v_exp_f32 v140, v140
M v[80:83], a[168:171], a[184:187], v[80:83]
ds_read_b128 a[132:135], v6 offset:34816
ds_read_b128 a[136:139], v6 offset:43008
M v[80:83], a[172:175], a[188:191], v[80:83]
v_exp_f32 v141, v141
M v[80:83], a[176:179], a[192:195], v[80:83]
buffer_load_dwordx4 v1, s[12:15], s43 offen offset:0 sc1 lds
M v[84:87], a[176:179], a[208:211], 0
v_exp_f32 v142, v142
M v[84:87], a[172:175], a[204:207], v[84:87]
v_cvt_pk_bf16_f32 v139, v154, v155
v_cvt_pk_bf16_f32 v140, v140, v141
M v[84:87], a[168:171], a[200:203], v[84:87]
v_exp_f32 v143, v143
M v[84:87], a[164:167], a[196:199], v[84:87]
buffer_load_dwordx4 v1, s[12:15], s43 offen offset:1024 sc1 lds
M v[88:91], a[164:167], a[212:215], 0
v_exp_f32 v156, v156
M v[88:91], a[168:171], a[216:219], v[88:91]
ds_read_b128 a[140:143], v6 offset:35840
ds_read_b128 a[144:147], v6 offset:44032
M v[88:91], a[172:175], a[220:223], v[88:91]
v_exp_f32 v157, v157
M v[88:91], a[176:179], a[224:227], v[88:91]
buffer_load_dwordx4 v1, s[12:15], s43 offen offset:2048 sc1 lds
M v[92:95], a[176:179], a[240:243], 0
v_exp_f32 v158, v158
M v[92:95], a[172:175], a[236:239], v[92:95]
v_cvt_pk_bf16_f32 v141, v142, v143
v_cvt_pk_bf16_f32 v142, v156, v157
M v[92:95], a[168:171], a[232:235], v[92:95]
v_exp_f32 v159, v159
M v[92:95], a[164:167], a[228:231], v[92:95]
buffer_load_dwordx4 v1, s[12:15], s43 offen offset:3072 sc1 lds
v_cvt_pk_bf16_f32 v143, v158, v159
s_waitcnt lgkmcnt(6)
M v[160:163], a[116:119], v[96:99], v[160:163]
v_exp_f32 v32, v32
M v[160:163], a[120:123], v[128:131], v[160:163]
ds_read_b128 a[148:151], v6 offset:36864
ds_read_b128 a[152:155], v6 offset:45056
M v[164:167], a[120:123], v[132:135], v[164:167]
v_exp_f32 v33, v33
M v[164:167], a[116:119], v[100:103], v[164:167]
v_cvt_pk_bf16_f32 v32, v32, v33
M v[168:171], a[116:119], v[104:107], v[168:171]
v_exp_f32 v34, v34
M v[168:171], a[120:123], v[136:139], v[168:171]
s_add_u32 s25, s25, 32768
s_cmp_eq_u32 s25, s27
M v[172:175], a[120:123], v[140:143], v[172:175]
v_exp_f32 v35, v35
M v[172:175], a[116:119], v[108:111], v[172:175]
v_cvt_pk_bf16_f32 v33, v34, v35
s_waitcnt lgkmcnt(6)
M a[96:99], a[112:115], v[96:99], a[96:99]
s_cselect_b32 s25, s28, s25
s_cselect_b32 s27, -1, s27
M a[96:99], a[112:115], v[128:131], a[96:99]
s_add_u32 s26, s26, 32768
s_cmp_eq_u32 s26, s62
M v[176:179], a[124:127], v[96:99], v[176:179]
v_exp_f32 v48, v48
M v[176:179], a[128:131], v[128:131], v[176:179]
ds_read_b128 a[156:159], v6 offset:37888
ds_read_b128 a[160:163], v6 offset:46080
M v[180:183], a[128:131], v[132:135], v[180:183]
v_exp_f32 v49, v49
M v[180:183], a[124:127], v[100:103], v[180:183]
v_cvt_pk_bf16_f32 v34, v48, v49
M v[184:187], a[124:127], v[104:107], v[184:187]
v_exp_f32 v50, v50
M v[184:187], a[128:131], v[136:139], v[184:187]
s_cselect_b32 s26, s63, s26
s_cselect_b32 s62, -1, s62
M v[188:191], a[128:131], v[140:143], v[188:191]
v_exp_f32 v51, v51
M v[188:191], a[124:127], v[108:111], v[188:191]
v_cvt_pk_bf16_f32 v35, v50, v51
s_waitcnt lgkmcnt(6)
M a[100:103], a[112:115], v[100:103], a[100:103]
M a[100:103], a[112:115], v[132:135], a[100:103]
M v[192:195], a[132:135], v[96:99], v[192:195]
v_exp_f32 v36, v36
M v[192:195], a[136:139], v[128:131], v[192:195]
ds_read_b128 a[164:167], v6 offset:38912
ds_read_b128 a[168:171], v6 offset:47104
M v[196:199], a[136:139], v[132:135], v[196:199]
v_exp_f32 v37, v37
M v[196:199], a[132:135], v[100:103], v[196:199]
v_cvt_pk_bf16_f32 v36, v36, v37
M v[200:203], a[132:135], v[104:107], v[200:203]
v_exp_f32 v38, v38
M v[200:203], a[136:139], v[136:139], v[200:203]
M v[204:207], a[136:139], v[140:143], v[204:207]
v_exp_f32 v39, v39
M v[204:207], a[132:135], v[108:111], v[204:207]
v_cvt_pk_bf16_f32 v37, v38, v39
s_waitcnt lgkmcnt(6)
M a[104:107], a[112:115], v[104:107], a[104:107]
M a[104:107], a[112:115], v[136:139], a[104:107]
M v[208:211], a[140:143], v[96:99], v[208:211]
v_exp_f32 v52, v52
M v[208:211], a[144:147], v[128:131], v[208:211]
ds_read_b128 a[172:175], v6 offset:39936
ds_read_b128 a[176:179], v6 offset:48128
M v[212:215], a[144:147], v[132:135], v[212:215]
v_exp_f32 v53, v53
M v[212:215], a[140:143], v[100:103], v[212:215]
v_cvt_pk_bf16_f32 v38, v52, v53
M v[216:219], a[140:143], v[104:107], v[216:219]
v_exp_f32 v54, v54
M v[216:219], a[144:147], v[136:139], v[216:219]
M v[220:223], a[144:147], v[140:143], v[220:223]
v_exp_f32 v55, v55
M v[220:223], a[140:143], v[108:111], v[220:223]
v_cvt_pk_bf16_f32 v39, v54, v55
s_waitcnt lgkmcnt(6)
M a[108:111], a[112:115], v[108:111], a[108:111]
M a[108:111], a[112:115], v[140:143], a[108:111]
M v[224:227], a[148:151], v[96:99], v[224:227]
v_exp_f32 v40, v40
M v[224:227], a[152:155], v[128:131], v[224:227]
M v[228:231], a[152:155], v[132:135], v[228:231]
v_exp_f32 v41, v41
M v[228:231], a[148:151], v[100:103], v[228:231]
v_cvt_pk_bf16_f32 v40, v40, v41
M v[232:235], a[148:151], v[104:107], v[232:235]
v_exp_f32 v42, v42
M v[232:235], a[152:155], v[136:139], v[232:235]
M v[236:239], a[152:155], v[140:143], v[236:239]
v_exp_f32 v43, v43
M v[236:239], a[148:151], v[108:111], v[236:239]
v_cvt_pk_bf16_f32 v41, v42, v43
s_waitcnt lgkmcnt(4)
M v[240:243], a[156:159], v[96:99], v[240:243]
v_exp_f32 v56, v56
M v[240:243], a[160:163], v[128:131], v[240:243]
M v[244:247], a[160:163], v[132:135], v[244:247]
v_exp_f32 v57, v57
M v[244:247], a[156:159], v[100:103], v[244:247]
v_cvt_pk_bf16_f32 v42, v56, v57
M v[248:251], a[156:159], v[104:107], v[248:251]
v_exp_f32 v58, v58
M v[248:251], a[160:163], v[136:139], v[248:251]
s_waitcnt vmcnt(0) lgkmcnt(0)
s_barrier
ds_read_b128 a[116:119], v2 offset:0
ds_read_b128 a[120:123], v2 offset:1024
M v[252:255], a[160:163], v[140:143], v[252:255]
v_exp_f32 v59, v59
M v[252:255], a[156:159], v[108:111], v[252:255]
v_cvt_pk_bf16_f32 v43, v58, v59
M a[64:67], a[164:167], v[96:99], a[64:67]
v_exp_f32 v44, v44
M a[64:67], a[168:171], v[128:131], a[64:67]
ds_read_b128 a[124:127], v2 offset:2048
ds_read_b128 a[128:131], v2 offset:3072
M a[68:71], a[168:171], v[132:135], a[68:71]
v_exp_f32 v45, v45
M a[68:71], a[164:167], v[100:103], a[68:71]
v_cvt_pk_bf16_f32 v44, v44, v45
M a[72:75], a[164:167], v[104:107], a[72:75]
v_exp_f32 v46, v46
M a[72:75], a[168:171], v[136:139], a[72:75]
ds_read_b128 a[132:135], v2 offset:4096
ds_read_b128 a[136:139], v2 offset:5120
M a[76:79], a[168:171], v[140:143], a[76:79]
v_exp_f32 v47, v47
M a[76:79], a[164:167], v[108:111], a[76:79]
v_cvt_pk_bf16_f32 v45, v46, v47
M a[80:83], a[172:175], v[96:99], a[80:83]
v_exp_f32 v60, v60
M a[80:83], a[176:179], v[128:131], a[80:83]
ds_read_b128 a[140:143], v2 offset:6144
ds_read_b128 a[144:147], v2 offset:7168
M a[84:87], a[176:179], v[132:135], a[84:87]
v_exp_f32 v61, v61
M a[84:87], a[172:175], v[100:103], a[84:87]
v_cvt_pk_bf16_f32 v46, v60, v61
M a[88:91], a[172:175], v[104:107], a[88:91]
v_exp_f32 v62, v62
M a[88:91], a[176:179], v[136:139], a[88:91]
M a[92:95], a[176:179], v[140:143], a[92:95]
v_exp_f32 v63, v63
M a[92:95], a[172:175], v[108:111], a[92:95]
v_cvt_pk_bf16_f32 v47, v62, v63
v_accvgpr_read_b32 v20, a96
v_accvgpr_read_b32 v21, a100
v_accvgpr_read_b32 v22, a104
v_accvgpr_read_b32 v23, a108
v_rcp_f32 v8, v20
v_rcp_f32 v9, v21
v_rcp_f32 v10, v22
v_rcp_f32 v11, v23
v_subrev_u32 v20, 0x21800000, v20
v_subrev_u32 v21, 0x21800000, v21
v_subrev_u32 v22, 0x21800000, v22
v_subrev_u32 v23, 0x21800000, v23
v_max_u32 v12, v20, v21
v_max3_u32 v12, v12, v22, v23
s_mov_b32 s64, 0x207
s_lshl_b32 s33, s21, 20
s_lshl_b32 s34, s20, 15
s_add_u32 s33, s33, s34
s_lshl_b32 s34, s23, 13
s_add_u32 s36, s33, s34
s_add_u32 s37, s36, 4096
s_add_u32 s38, s36, 16384
s_add_u32 s39, s36, 20480
v_pk_mul_f32 v[160:161], v[160:161], v[8:9] op_sel:[0,0] op_sel_hi:[1,0]
v_pk_mul_f32 v[162:163], v[162:163], v[8:9] op_sel:[0,0] op_sel_hi:[1,0]
v_pk_mul_f32 v[176:177], v[176:177], v[8:9] op_sel:[0,0] op_sel_hi:[1,0]
v_pk_mul_f32 v[178:179], v[178:179], v[8:9] op_sel:[0,0] op_sel_hi:[1,0]
v_cvt_pk_bf16_f32 v160, v160, v161
v_cvt_pk_bf16_f32 v161, v162, v163
v_cvt_pk_bf16_f32 v162, v176, v177
v_cvt_pk_bf16_f32 v163, v178, v179
s_nop 1
M v[24:27], a[112:115], v[160:163], 0
buffer_store_dwordx4 v[160:163], v1, s[16:19], s36 offen offset:0 sc1
v_pk_mul_f32 v[164:165], v[164:165], v[8:9] op_sel:[0,1] op_sel_hi:[1,1]
v_pk_mul_f32 v[166:167], v[166:167], v[8:9] op_sel:[0,1] op_sel_hi:[1,1]
v_pk_mul_f32 v[180:181], v[180:181], v[8:9] op_sel:[0,1] op_sel_hi:[1,1]
v_pk_mul_f32 v[182:183], v[182:183], v[8:9] op_sel:[0,1] op_sel_hi:[1,1]
v_cvt_pk_bf16_f32 v164, v164, v165
v_cvt_pk_bf16_f32 v165, v166, v167
v_cvt_pk_bf16_f32 v166, v180, v181
v_cvt_pk_bf16_f32 v167, v182, v183
s_nop 1
M v[24:27], a[112:115], v[164:167], v[24:27]
buffer_store_dwordx4 v[164:167], v1, s[16:19], s36 offen offset:2048 sc1
v_pk_mul_f32 v[168:169], v[168:169], v[10:11] op_sel:[0,0] op_sel_hi:[1,0]
v_pk_mul_f32 v[170:171], v[170:171], v[10:11] op_sel:[0,0] op_sel_hi:[1,0]
v_pk_mul_f32 v[184:185], v[184:185], v[10:11] op_sel:[0,0] op_sel_hi:[1,0]
v_pk_mul_f32 v[186:187], v[186:187], v[10:11] op_sel:[0,0] op_sel_hi:[1,0]
v_cvt_pk_bf16_f32 v168, v168, v169
v_cvt_pk_bf16_f32 v169, v170, v171
v_cvt_pk_bf16_f32 v170, v184, v185
v_cvt_pk_bf16_f32 v171, v186, v187
s_nop 1
M v[24:27], a[112:115], v[168:171], v[24:27]
buffer_store_dwordx4 v[168:171], v1, s[16:19], s37 offen offset:0 sc1
v_pk_mul_f32 v[172:173], v[172:173], v[10:11] op_sel:[0,1] op_sel_hi:[1,1]
v_pk_mul_f32 v[174:175], v[174:175], v[10:11] op_sel:[0,1] op_sel_hi:[1,1]
v_pk_mul_f32 v[188:189], v[188:189], v[10:11] op_sel:[0,1] op_sel_hi:[1,1]
v_pk_mul_f32 v[190:191], v[190:191], v[10:11] op_sel:[0,1] op_sel_hi:[1,1]
v_cvt_pk_bf16_f32 v172, v172, v173
v_cvt_pk_bf16_f32 v173, v174, v175
v_cvt_pk_bf16_f32 v174, v188, v189
v_cvt_pk_bf16_f32 v175, v190, v191
s_nop 1
M v[24:27], a[112:115], v[172:175], v[24:27]
buffer_store_dwordx4 v[172:175], v1, s[16:19], s37 offen offset:2048 sc1
v_pk_mul_f32 v[192:193], v[192:193], v[8:9] op_sel:[0,0] op_sel_hi:[1,0]
v_pk_mul_f32 v[194:195], v[194:195], v[8:9] op_sel:[0,0] op_sel_hi:[1,0]
v_pk_mul_f32 v[208:209], v[208:209], v[8:9] op_sel:[0,0] op_sel_hi:[1,0]
v_pk_mul_f32 v[210:211], v[210:211], v[8:9] op_sel:[0,0] op_sel_hi:[1,0]
v_cvt_pk_bf16_f32 v192, v192, v193
v_cvt_pk_bf16_f32 v193, v194, v195
v_cvt_pk_bf16_f32 v194, v208, v209
v_cvt_pk_bf16_f32 v195, v210, v211
s_nop 1
M v[24:27], a[112:115], v[192:195], v[24:27]
buffer_store_dwordx4 v[192:195], v1, s[16:19], s36 offen offset:1024 sc1
v_pk_mul_f32 v[196:197], v[196:197], v[8:9] op_sel:[0,1] op_sel_hi:[1,1]
v_pk_mul_f32 v[198:199], v[198:199], v[8:9] op_sel:[0,1] op_sel_hi:[1,1]
v_pk_mul_f32 v[212:213], v[212:213], v[8:9] op_sel:[0,1] op_sel_hi:[1,1]
v_pk_mul_f32 v[214:215], v[214:215], v[8:9] op_sel:[0,1] op_sel_hi:[1,1]
v_cvt_pk_bf16_f32 v196, v196, v197
v_cvt_pk_bf16_f32 v197, v198, v199
v_cvt_pk_bf16_f32 v198, v212, v213
v_cvt_pk_bf16_f32 v199, v214, v215
s_nop 1
M v[24:27], a[112:115], v[196:199], v[24:27]
buffer_store_dwordx4 v[196:199], v1, s[16:19], s36 offen offset:3072 sc1
v_pk_mul_f32 v[200:201], v[200:201], v[10:11] op_sel:[0,0] op_sel_hi:[1,0]
v_pk_mul_f32 v[202:203], v[202:203], v[10:11] op_sel:[0,0] op_sel_hi:[1,0]
v_pk_mul_f32 v[216:217], v[216:217], v[10:11] op_sel:[0,0] op_sel_hi:[1,0]
v_pk_mul_f32 v[218:219], v[218:219], v[10:11] op_sel:[0,0] op_sel_hi:[1,0]
v_cvt_pk_bf16_f32 v200, v200, v201
v_cvt_pk_bf16_f32 v201, v202, v203
v_cvt_pk_bf16_f32 v202, v216, v217
v_cvt_pk_bf16_f32 v203, v218, v219
s_nop 1
M v[24:27], a[112:115], v[200:203], v[24:27]
buffer_store_dwordx4 v[200:203], v1, s[16:19], s37 offen offset:1024 sc1
v_pk_mul_f32 v[204:205], v[204:205], v[10:11] op_sel:[0,1] op_sel_hi:[1,1]
v_pk_mul_f32 v[206:207], v[206:207], v[10:11] op_sel:[0,1] op_sel_hi:[1,1]
v_pk_mul_f32 v[220:221], v[220:221], v[10:11] op_sel:[0,1] op_sel_hi:[1,1]
v_pk_mul_f32 v[222:223], v[222:223], v[10:11] op_sel:[0,1] op_sel_hi:[1,1]
v_cvt_pk_bf16_f32 v204, v204, v205
v_cvt_pk_bf16_f32 v205, v206, v207
v_cvt_pk_bf16_f32 v206, v220, v221
v_cvt_pk_bf16_f32 v207, v222, v223
s_nop 1
M v[24:27], a[112:115], v[204:207], v[24:27]
buffer_store_dwordx4 v[204:207], v1, s[16:19], s37 offen offset:3072 sc1
v_pk_mul_f32 v[224:225], v[224:225], v[8:9] op_sel:[0,0] op_sel_hi:[1,0]
v_pk_mul_f32 v[226:227], v[226:227], v[8:9] op_sel:[0,0] op_sel_hi:[1,0]
v_pk_mul_f32 v[240:241], v[240:241], v[8:9] op_sel:[0,0] op_sel_hi:[1,0]
v_pk_mul_f32 v[242:243], v[242:243], v[8:9] op_sel:[0,0] op_sel_hi:[1,0]
v_cvt_pk_bf16_f32 v224, v224, v225
v_cvt_pk_bf16_f32 v225, v226, v227
v_cvt_pk_bf16_f32 v226, v240, v241
v_cvt_pk_bf16_f32 v227, v242, v243
s_nop 1
M v[24:27], a[112:115], v[224:227], v[24:27]
buffer_store_dwordx4 v[224:227], v1, s[16:19], s38 offen offset:0 sc1
v_pk_mul_f32 v[228:229], v[228:229], v[8:9] op_sel:[0,1] op_sel_hi:[1,1]
v_pk_mul_f32 v[230:231], v[230:231], v[8:9] op_sel:[0,1] op_sel_hi:[1,1]
v_pk_mul_f32 v[244:245], v[244:245], v[8:9] op_sel:[0,1] op_sel_hi:[1,1]
v_pk_mul_f32 v[246:247], v[246:247], v[8:9] op_sel:[0,1] op_sel_hi:[1,1]
v_cvt_pk_bf16_f32 v228, v228, v229
v_cvt_pk_bf16_f32 v229, v230, v231
v_cvt_pk_bf16_f32 v230, v244, v245
v_cvt_pk_bf16_f32 v231, v246, v247
s_nop 1
M v[24:27], a[112:115], v[228:231], v[24:27]
buffer_store_dwordx4 v[228:231], v1, s[16:19], s38 offen offset:2048 sc1
v_pk_mul_f32 v[232:233], v[232:233], v[10:11] op_sel:[0,0] op_sel_hi:[1,0]
v_pk_mul_f32 v[234:235], v[234:235], v[10:11] op_sel:[0,0] op_sel_hi:[1,0]
v_pk_mul_f32 v[248:249], v[248:249], v[10:11] op_sel:[0,0] op_sel_hi:[1,0]
v_pk_mul_f32 v[250:251], v[250:251], v[10:11] op_sel:[0,0] op_sel_hi:[1,0]
v_cvt_pk_bf16_f32 v232, v232, v233
v_cvt_pk_bf16_f32 v233, v234, v235
v_cvt_pk_bf16_f32 v234, v248, v249
v_cvt_pk_bf16_f32 v235, v250, v251
s_nop 1
M v[24:27], a[112:115], v[232:235], v[24:27]
buffer_store_dwordx4 v[232:235], v1, s[16:19], s39 offen offset:0 sc1
v_pk_mul_f32 v[236:237], v[236:237], v[10:11] op_sel:[0,1] op_sel_hi:[1,1]
v_pk_mul_f32 v[238:239], v[238:239], v[10:11] op_sel:[0,1] op_sel_hi:[1,1]
v_pk_mul_f32 v[252:253], v[252:253], v[10:11] op_sel:[0,1] op_sel_hi:[1,1]
v_pk_mul_f32 v[254:255], v[254:255], v[10:11] op_sel:[0,1] op_sel_hi:[1,1]
v_cvt_pk_bf16_f32 v236, v236, v237
v_cvt_pk_bf16_f32 v237, v238, v239
v_cvt_pk_bf16_f32 v238, v252, v253
v_cvt_pk_bf16_f32 v239, v254, v255
v_accvgpr_read_b32 v176, a64
v_accvgpr_read_b32 v177, a65
v_accvgpr_read_b32 v178, a66
v_accvgpr_read_b32 v179, a67
v_accvgpr_read_b32 v180, a80
v_accvgpr_read_b32 v181, a81
v_accvgpr_read_b32 v182, a82
v_accvgpr_read_b32 v183, a83
M v[24:27], a[112:115], v[236:239], v[24:27]
buffer_store_dwordx4 v[236:239], v1, s[16:19], s39 offen offset:2048 sc1
v_pk_mul_f32 v[176:177], v[176:177], v[8:9] op_sel:[0,0] op_sel_hi:[1,0]
v_pk_mul_f32 v[178:179], v[178:179], v[8:9] op_sel:[0,0] op_sel_hi:[1,0]
v_pk_mul_f32 v[180:181], v[180:181], v[8:9] op_sel:[0,0] op_sel_hi:[1,0]
v_pk_mul_f32 v[182:183], v[182:183], v[8:9] op_sel:[0,0] op_sel_hi:[1,0]
v_cvt_pk_bf16_f32 v176, v176, v177
v_cvt_pk_bf16_f32 v177, v178, v179
v_cvt_pk_bf16_f32 v178, v180, v181
v_cvt_pk_bf16_f32 v179, v182, v183
v_accvgpr_read_b32 v184, a68
v_accvgpr_read_b32 v185, a69
v_accvgpr_read_b32 v186, a70
v_accvgpr_read_b32 v187, a71
v_accvgpr_read_b32 v188, a84
v_accvgpr_read_b32 v189, a85
v_accvgpr_read_b32 v190, a86
v_accvgpr_read_b32 v191, a87
M v[24:27], a[112:115], v[176:179], v[24:27]
buffer_store_dwordx4 v[176:179], v1, s[16:19], s38 offen offset:1024 sc1
v_pk_mul_f32 v[184:185], v[184:185], v[8:9] op_sel:[0,1] op_sel_hi:[1,1]
v_pk_mul_f32 v[186:187], v[186:187], v[8:9] op_sel:[0,1] op_sel_hi:[1,1]
v_pk_mul_f32 v[188:189], v[188:189], v[8:9] op_sel:[0,1] op_sel_hi:[1,1]
v_pk_mul_f32 v[190:191], v[190:191], v[8:9] op_sel:[0,1] op_sel_hi:[1,1]
v_cvt_pk_bf16_f32 v184, v184, v185
v_cvt_pk_bf16_f32 v185, v186, v187
v_cvt_pk_bf16_f32 v186, v188, v189
v_cvt_pk_bf16_f32 v187, v190, v191
v_accvgpr_read_b32 v208, a72
v_accvgpr_read_b32 v209, a73
v_accvgpr_read_b32 v210, a74
v_accvgpr_read_b32 v211, a75
v_accvgpr_read_b32 v212, a88
v_accvgpr_read_b32 v213, a89
v_accvgpr_read_b32 v214, a90
v_accvgpr_read_b32 v215, a91
M v[24:27], a[112:115], v[184:187], v[24:27]
buffer_store_dwordx4 v[184:187], v1, s[16:19], s38 offen offset:3072 sc1
v_pk_mul_f32 v[208:209], v[208:209], v[10:11] op_sel:[0,0] op_sel_hi:[1,0]
v_pk_mul_f32 v[210:211], v[210:211], v[10:11] op_sel:[0,0] op_sel_hi:[1,0]
v_pk_mul_f32 v[212:213], v[212:213], v[10:11] op_sel:[0,0] op_sel_hi:[1,0]
v_pk_mul_f32 v[214:215], v[214:215], v[10:11] op_sel:[0,0] op_sel_hi:[1,0]
v_cvt_pk_bf16_f32 v208, v208, v209
v_cvt_pk_bf16_f32 v209, v210, v211
v_cvt_pk_bf16_f32 v210, v212, v213
v_cvt_pk_bf16_f32 v211, v214, v215
v_accvgpr_read_b32 v216, a76
v_accvgpr_read_b32 v217, a77
v_accvgpr_read_b32 v218, a78
v_accvgpr_read_b32 v219, a79
v_accvgpr_read_b32 v220, a92
v_accvgpr_read_b32 v221, a93
v_accvgpr_read_b32 v222, a94
v_accvgpr_read_b32 v223, a95
M v[24:27], a[112:115], v[208:211], v[24:27]
buffer_store_dwordx4 v[208:211], v1, s[16:19], s39 offen offset:1024 sc1
v_pk_mul_f32 v[216:217], v[216:217], v[10:11] op_sel:[0,1] op_sel_hi:[1,1]
v_pk_mul_f32 v[218:219], v[218:219], v[10:11] op_sel:[0,1] op_sel_hi:[1,1]
v_pk_mul_f32 v[220:221], v[220:221], v[10:11] op_sel:[0,1] op_sel_hi:[1,1]
v_pk_mul_f32 v[222:223], v[222:223], v[10:11] op_sel:[0,1] op_sel_hi:[1,1]
v_cvt_pk_bf16_f32 v216, v216, v217
v_cvt_pk_bf16_f32 v217, v218, v219
v_cvt_pk_bf16_f32 v218, v220, v221
v_cvt_pk_bf16_f32 v219, v222, v223
s_nop 1
M v[24:27], a[112:115], v[216:219], v[24:27]
buffer_store_dwordx4 v[216:219], v1, s[16:19], s39 offen offset:3072 sc1
v_cmp_lt_u32 vcc, 0x3c000000, v12
s_nop 5
v_cmp_class_f32 s[40:41], v24, s64
s_nop 0
s_or_b64 vcc, vcc, s[40:41]
s_cmp_lg_u64 vcc, 0
s_cselect_b32 s33, 1, 0
s_or_b32 s60, s60, s33
s_sub_u32 s30, 7, s21
s_cmp_lg_u32 s30, 0
s_cbranch_scc1 Lk2_b0
s_and_b32 s3, s2, 3
s_lshl_b32 s3, s3, 2
s_bfe_u32 s27, s2, 0x20003
s_add_u32 s27, s3, s27
s_lshl_b32 s43, s27, 8
s_add_u32 s43, s43, 8400896
v_lshlrev_b32 v15, 2, v0
buffer_load_dword v7, v15, s[52:55], s43 offen sc1
s_waitcnt lgkmcnt(7)
ds_read_b128 a[116:119], v5 offset:32768
s_waitcnt lgkmcnt(7)
ds_read_b128 a[120:123], v5 offset:40960
s_waitcnt lgkmcnt(7)
ds_read_b128 a[124:127], v5 offset:33792
s_waitcnt lgkmcnt(7)
ds_read_b128 a[128:131], v5 offset:41984
s_waitcnt lgkmcnt(7)
ds_read_b128 a[132:135], v5 offset:34816
s_waitcnt lgkmcnt(7)
ds_read_b128 a[136:139], v5 offset:43008
s_waitcnt lgkmcnt(7)
ds_read_b128 a[140:143], v5 offset:35840
s_waitcnt lgkmcnt(7)
ds_read_b128 a[144:147], v5 offset:44032
v_exp_f32 v64, v64
v_exp_f32 v65, v65
v_exp_f32 v66, v66
v_exp_f32 v67, v67
v_exp_f32 v80, v80
v_exp_f32 v81, v81
v_exp_f32 v82, v82
v_exp_f32 v83, v83
v_cvt_pk_bf16_f32 v64, v64, v65
v_cvt_pk_bf16_f32 v65, v66, v67
v_exp_f32 v68, v68
v_exp_f32 v69, v69
v_exp_f32 v70, v70
v_exp_f32 v71, v71
v_cvt_pk_bf16_f32 v66, v80, v81
v_cvt_pk_bf16_f32 v67, v82, v83
v_exp_f32 v84, v84
v_exp_f32 v85, v85
v_exp_f32 v86, v86
v_exp_f32 v87, v87
v_cvt_pk_bf16_f32 v68, v68, v69
v_cvt_pk_bf16_f32 v69, v70, v71
v_exp_f32 v72, v72
v_exp_f32 v73, v73
v_exp_f32 v74, v74
v_exp_f32 v75, v75
v_cvt_pk_bf16_f32 v70, v84, v85
v_cvt_pk_bf16_f32 v71, v86, v87
v_exp_f32 v88, v88
v_exp_f32 v89, v89
v_exp_f32 v90, v90
v_exp_f32 v91, v91
v_cvt_pk_bf16_f32 v72, v72, v73
v_cvt_pk_bf16_f32 v73, v74, v75
v_exp_f32 v76, v76
v_exp_f32 v77, v77
v_exp_f32 v78, v78
v_exp_f32 v79, v79
v_cvt_pk_bf16_f32 v74, v88, v89
v_cvt_pk_bf16_f32 v75, v90, v91
v_exp_f32 v92, v92
v_exp_f32 v93, v93
v_exp_f32 v94, v94
v_exp_f32 v95, v95
v_cvt_pk_bf16_f32 v76, v76, v77
v_cvt_pk_bf16_f32 v77, v78, v79
v_cvt_pk_bf16_f32 v78, v92, v93
v_cvt_pk_bf16_f32 v79, v94, v95
s_waitcnt lgkmcnt(6)
M v[160:163], a[116:119], v[32:35], 0
M v[160:163], a[120:123], v[64:67], v[160:163]
ds_read_b128 a[148:151], v5 offset:36864
ds_read_b128 a[152:155], v5 offset:45056
s_mov_b32 s61, 0
M v[164:167], a[120:123], v[68:71], 0
M v[164:167], a[116:119], v[36:39], v[164:167]
s_bfe_u32 s3, s2, 0x10002
M v[168:171], a[116:119], v[40:43], 0
M v[168:171], a[120:123], v[72:75], v[168:171]
s_lshl_b32 s3, s3, 3
M v[172:175], a[120:123], v[76:79], 0
M v[172:175], a[116:119], v[44:47], v[172:175]
s_waitcnt lgkmcnt(6)
s_lshr_b32 s28, s2, 5
M a[96:99], a[112:115], v[32:35], 0
M a[96:99], a[112:115], v[64:67], a[96:99]
M v[176:179], a[124:127], v[32:35], 0
M v[176:179], a[128:131], v[64:67], v[176:179]
ds_read_b128 a[156:159], v5 offset:37888
ds_read_b128 a[160:163], v5 offset:46080
s_add_u32 s28, s3, s28
M v[180:183], a[128:131], v[68:71], 0
s_lshl_b32 s25, s27, 18
M v[180:183], a[124:127], v[36:39], v[180:183]
M v[184:187], a[124:127], v[40:43], 0
s_lshl_b32 s3, s101, 12
M v[184:187], a[128:131], v[72:75], v[184:187]
M v[188:191], a[128:131], v[76:79], 0
s_add_u32 s25, s25, s3
M v[188:191], a[124:127], v[44:47], v[188:191]
s_waitcnt lgkmcnt(6)
M a[100:103], a[112:115], v[36:39], 0
M a[100:103], a[112:115], v[68:71], a[100:103]
M v[192:195], a[132:135], v[32:35], 0
s_lshl_b32 s26, s28, 7
M v[192:195], a[136:139], v[64:67], v[192:195]
ds_read_b128 a[164:167], v5 offset:38912
ds_read_b128 a[168:171], v5 offset:47104
M v[196:199], a[136:139], v[68:71], 0
s_lshl_b32 s42, s101, 11
M v[196:199], a[132:135], v[36:39], v[196:199]
M v[200:203], a[132:135], v[40:43], 0
s_add_u32 s44, s4, 83886080
s_addc_u32 s45, s5, 0
M v[200:203], a[136:139], v[72:75], v[200:203]
s_mov_b32 s46, 4194304
M v[204:207], a[136:139], v[76:79], 0
M v[204:207], a[132:135], v[44:47], v[204:207]
s_waitcnt lgkmcnt(6)
s_mov_b32 s47, 0x00020000
M a[104:107], a[112:115], v[40:43], 0
M a[104:107], a[112:115], v[72:75], a[104:107]
M v[208:211], a[140:143], v[32:35], 0
M v[208:211], a[144:147], v[64:67], v[208:211]
ds_read_b128 a[172:175], v5 offset:39936
ds_read_b128 a[176:179], v5 offset:48128
s_mov_b32 s50, 2097152
M v[212:215], a[144:147], v[68:71], 0
M v[212:215], a[140:143], v[36:39], v[212:215]
s_mov_b32 s51, 0x00020000
M v[216:219], a[140:143], v[40:43], 0
M v[216:219], a[144:147], v[72:75], v[216:219]
s_lshl_b32 s3, s101, 4
M v[220:223], a[144:147], v[76:79], 0
M v[220:223], a[140:143], v[44:47], v[220:223]
s_waitcnt lgkmcnt(6)
v_lshrrev_b32 v96, 3, v0
M a[108:111], a[112:115], v[44:47], 0
M a[108:111], a[112:115], v[76:79], a[108:111]
M v[224:227], a[148:151], v[32:35], 0
v_and_b32 v97, 6, v96
M v[224:227], a[152:155], v[64:67], v[224:227]
M v[228:231], a[152:155], v[68:71], 0
v_and_b32 v98, 7, v0
M v[228:231], a[148:151], v[36:39], v[228:231]
M v[232:235], a[148:151], v[40:43], 0
v_xor_b32 v97, v97, v98
M v[232:235], a[152:155], v[72:75], v[232:235]
M v[236:239], a[152:155], v[76:79], 0
v_add_u32 v96, s3, v96
M v[236:239], a[148:151], v[44:47], v[236:239]
s_waitcnt lgkmcnt(4)
M v[240:243], a[156:159], v[32:35], 0
v_lshlrev_b32 v96, 11, v96
M v[240:243], a[160:163], v[64:67], v[240:243]
M v[244:247], a[160:163], v[68:71], 0
v_lshl_add_u32 v99, v97, 4, v96
M v[244:247], a[156:159], v[36:39], v[244:247]
v_add_u32 v100, 15360, v99
M v[248:251], a[156:159], v[40:43], 0
M v[248:251], a[160:163], v[72:75], v[248:251]
s_waitcnt vmcnt(0) lgkmcnt(0)
s_barrier
v_cmp_ne_u32 vcc, 1, v7
s_nop 0
s_cbranch_vccnz Lk3_spinb1
Lk3_gotb1:
M v[252:255], a[160:163], v[76:79], 0
s_add_u32 m0, s42, 65536
s_nop 0
buffer_load_dwordx4 v99, s[48:51], s26 offen offset:0 lds
buffer_load_dwordx4 v100, s[48:51], s26 offen offset:1024 lds
M v[252:255], a[156:159], v[44:47], v[252:255]
buffer_load_dwordx4 a[192:195], v1, s[44:47], s25 offen offset:0 sc1
buffer_load_dwordx4 a[196:199], v1, s[44:47], s25 offen offset:1024 sc1
M a[64:67], a[164:167], v[32:35], 0
buffer_load_dwordx4 a[200:203], v1, s[44:47], s25 offen offset:2048 sc1
buffer_load_dwordx4 a[204:207], v1, s[44:47], s25 offen offset:3072 sc1
M a[64:67], a[168:171], v[64:67], a[64:67]
s_add_u32 s25, s25, 16384
s_add_u32 s26, s26, 131072
s_add_u32 m0, s42, 81920
s_nop 0
buffer_load_dwordx4 v99, s[48:51], s26 offen offset:0 lds
M a[68:71], a[168:171], v[68:71], 0
buffer_load_dwordx4 v100, s[48:51], s26 offen offset:1024 lds
buffer_load_dwordx4 a[208:211], v1, s[44:47], s25 offen offset:0 sc1
M a[68:71], a[164:167], v[36:39], a[68:71]
buffer_load_dwordx4 a[212:215], v1, s[44:47], s25 offen offset:1024 sc1
buffer_load_dwordx4 a[216:219], v1, s[44:47], s25 offen offset:2048 sc1
M a[72:75], a[164:167], v[40:43], 0
buffer_load_dwordx4 a[220:223], v1, s[44:47], s25 offen offset:3072 sc1
s_add_u32 s25, s25, 16384
s_add_u32 s26, s26, 131072
M a[72:75], a[168:171], v[72:75], a[72:75]
s_add_u32 m0, s42, 98304
s_nop 0
buffer_load_dwordx4 v99, s[48:51], s26 offen offset:0 lds
buffer_load_dwordx4 v100, s[48:51], s26 offen offset:1024 lds
M a[76:79], a[168:171], v[76:79], 0
buffer_load_dwordx4 a[224:227], v1, s[44:47], s25 offen offset:0 sc1
M a[76:79], a[164:167], v[44:47], a[76:79]
buffer_load_dwordx4 a[228:231], v1, s[44:47], s25 offen offset:1024 sc1
buffer_load_dwordx4 a[232:235], v1, s[44:47], s25 offen offset:2048 sc1
M a[80:83], a[172:175], v[32:35], 0
buffer_load_dwordx4 a[236:239], v1, s[44:47], s25 offen offset:3072 sc1
s_add_u32 s25, s25, 16384
s_add_u32 s26, s26, 131072
M a[80:83], a[176:179], v[64:67], a[80:83]
s_add_u32 m0, s42, 114688
s_nop 0
buffer_load_dwordx4 v99, s[48:51], s26 offen offset:0 lds
buffer_load_dwordx4 v100, s[48:51], s26 offen offset:1024 lds
M a[84:87], a[176:179], v[68:71], 0
buffer_load_dwordx4 a[240:243], v1, s[44:47], s25 offen offset:0 sc1
buffer_load_dwordx4 a[244:247], v1, s[44:47], s25 offen offset:1024 sc1
M a[84:87], a[172:175], v[36:39], a[84:87]
buffer_load_dwordx4 a[248:251], v1, s[44:47], s25 offen offset:2048 sc1
buffer_load_dwordx4 a[252:255], v1, s[44:47], s25 offen offset:3072 sc1
M a[88:91], a[172:175], v[40:43], 0
s_add_u32 s25, s25, 16384
s_add_u32 s26, s26, 131072
s_add_u32 m0, s42, 0
s_nop 0
buffer_load_dwordx4 v99, s[48:51], s26 offen offset:0 lds
M a[88:91], a[176:179], v[72:75], a[88:91]
buffer_load_dwordx4 v100, s[48:51], s26 offen offset:1024 lds
buffer_load_dwordx4 a[128:131], v1, s[44:47], s25 offen offset:0 sc1
M a[92:95], a[176:179], v[76:79], 0
buffer_load_dwordx4 a[132:135], v1, s[44:47], s25 offen offset:1024 sc1
buffer_load_dwordx4 a[136:139], v1, s[44:47], s25 offen offset:2048 sc1
M a[92:95], a[172:175], v[44:47], a[92:95]
buffer_load_dwordx4 a[140:143], v1, s[44:47], s25 offen offset:3072 sc1
s_add_u32 s25, s25, 16384
s_add_u32 s26, s26, 131072
s_branch Lk2_merge
Lk2_b0:
s_add_u32 m0, s29, 65536
s_waitcnt lgkmcnt(4)
M v[96:99], a[116:119], a[180:183], 0
v_exp_f32 v64, v64
M v[96:99], a[120:123], a[184:187], v[96:99]
ds_read_b128 a[148:151], v2 offset:8192
ds_read_b128 a[152:155], v2 offset:9216
M v[96:99], a[124:127], a[188:191], v[96:99]
v_exp_f32 v65, v65
M v[96:99], a[128:131], a[192:195], v[96:99]
buffer_load_dwordx4 v1, s[12:15], s25 offen offset:0 sc1 lds
s_add_u32 s32, s25, 4096
M v[100:103], a[128:131], a[208:211], 0
v_exp_f32 v66, v66
M v[100:103], a[124:127], a[204:207], v[100:103]
v_cvt_pk_bf16_f32 v64, v64, v65
M v[100:103], a[120:123], a[200:203], v[100:103]
v_exp_f32 v67, v67
M v[100:103], a[116:119], a[196:199], v[100:103]
buffer_load_dwordx4 v1, s[12:15], s25 offen offset:1024 sc1 lds
M v[104:107], a[116:119], a[212:215], 0
v_exp_f32 v80, v80
M v[104:107], a[120:123], a[216:219], v[104:107]
ds_read_b128 a[156:159], v2 offset:10240
ds_read_b128 a[160:163], v2 offset:11264
M v[104:107], a[124:127], a[220:223], v[104:107]
v_exp_f32 v81, v81
M v[104:107], a[128:131], a[224:227], v[104:107]
buffer_load_dwordx4 v1, s[12:15], s25 offen offset:2048 sc1 lds
M v[108:111], a[128:131], a[240:243], 0
v_exp_f32 v82, v82
M v[108:111], a[124:127], a[236:239], v[108:111]
v_cvt_pk_bf16_f32 v65, v66, v67
v_cvt_pk_bf16_f32 v66, v80, v81
M v[108:111], a[120:123], a[232:235], v[108:111]
v_exp_f32 v83, v83
M v[108:111], a[116:119], a[228:231], v[108:111]
buffer_load_dwordx4 v1, s[12:15], s25 offen offset:3072 sc1 lds
s_add_u32 m0, s29, 69632
s_waitcnt lgkmcnt(4)
M v[112:115], a[132:135], a[180:183], 0
v_exp_f32 v68, v68
M v[112:115], a[136:139], a[184:187], v[112:115]
ds_read_b128 a[164:167], v2 offset:12288
ds_read_b128 a[168:171], v2 offset:13312
M v[112:115], a[140:143], a[188:191], v[112:115]
v_exp_f32 v69, v69
M v[112:115], a[144:147], a[192:195], v[112:115]
buffer_load_dwordx4 v1, s[12:15], s32 offen offset:0 sc1 lds
M v[116:119], a[144:147], a[208:211], 0
v_exp_f32 v70, v70
M v[116:119], a[140:143], a[204:207], v[116:119]
v_cvt_pk_bf16_f32 v67, v82, v83
v_cvt_pk_bf16_f32 v68, v68, v69
M v[116:119], a[136:139], a[200:203], v[116:119]
v_exp_f32 v71, v71
M v[116:119], a[132:135], a[196:199], v[116:119]
buffer_load_dwordx4 v1, s[12:15], s32 offen offset:1024 sc1 lds
M v[120:123], a[132:135], a[212:215], 0
v_exp_f32 v84, v84
M v[120:123], a[136:139], a[216:219], v[120:123]
ds_read_b128 a[172:175], v2 offset:14336
ds_read_b128 a[176:179], v2 offset:15360
M v[120:123], a[140:143], a[220:223], v[120:123]
v_exp_f32 v85, v85
M v[120:123], a[144:147], a[224:227], v[120:123]
buffer_load_dwordx4 v1, s[12:15], s32 offen offset:2048 sc1 lds
M v[124:127], a[144:147], a[240:243], 0
v_exp_f32 v86, v86
M v[124:127], a[140:143], a[236:239], v[124:127]
v_cvt_pk_bf16_f32 v69, v70, v71
v_cvt_pk_bf16_f32 v70, v84, v85
M v[124:127], a[136:139], a[232:235], v[124:127]
v_exp_f32 v87, v87
M v[124:127], a[132:135], a[228:231], v[124:127]
buffer_load_dwordx4 v1, s[12:15], s32 offen offset:3072 sc1 lds
s_add_u32 m0, s29, 98304
s_waitcnt lgkmcnt(4)
M v[128:131], a[148:151], a[180:183], 0
v_exp_f32 v72, v72
M v[128:131], a[152:155], a[184:187], v[128:131]
ds_read_b128 a[116:119], v5 offset:32768
ds_read_b128 a[120:123], v5 offset:40960
M v[128:131], a[156:159], a[188:191], v[128:131]
v_exp_f32 v73, v73
M v[128:131], a[160:163], a[192:195], v[128:131]
buffer_load_dwordx4 v1, s[12:15], s26 offen offset:0 sc1 lds
s_add_u32 s43, s26, 4096
M v[132:135], a[160:163], a[208:211], 0
v_exp_f32 v74, v74
M v[132:135], a[156:159], a[204:207], v[132:135]
v_cvt_pk_bf16_f32 v71, v86, v87
v_cvt_pk_bf16_f32 v72, v72, v73
M v[132:135], a[152:155], a[200:203], v[132:135]
v_exp_f32 v75, v75
M v[132:135], a[148:151], a[196:199], v[132:135]
buffer_load_dwordx4 v1, s[12:15], s26 offen offset:1024 sc1 lds
M v[136:139], a[148:151], a[212:215], 0
v_exp_f32 v88, v88
M v[136:139], a[152:155], a[216:219], v[136:139]
ds_read_b128 a[124:127], v5 offset:33792
ds_read_b128 a[128:131], v5 offset:41984
M v[136:139], a[156:159], a[220:223], v[136:139]
v_exp_f32 v89, v89
M v[136:139], a[160:163], a[224:227], v[136:139]
buffer_load_dwordx4 v1, s[12:15], s26 offen offset:2048 sc1 lds
M v[140:143], a[160:163], a[240:243], 0
v_exp_f32 v90, v90
M v[140:143], a[156:159], a[236:239], v[140:143]
v_cvt_pk_bf16_f32 v73, v74, v75
v_cvt_pk_bf16_f32 v74, v88, v89
M v[140:143], a[152:155], a[232:235], v[140:143]
v_exp_f32 v91, v91
M v[140:143], a[148:151], a[228:231], v[140:143]
buffer_load_dwordx4 v1, s[12:15], s26 offen offset:3072 sc1 lds
s_add_u32 m0, s29, 102400
s_waitcnt lgkmcnt(4)
M v[144:147], a[164:167], a[180:183], 0
v_exp_f32 v76, v76
M v[144:147], a[168:171], a[184:187], v[144:147]
ds_read_b128 a[132:135], v5 offset:34816
ds_read_b128 a[136:139], v5 offset:43008
M v[144:147], a[172:175], a[188:191], v[144:147]
v_exp_f32 v77, v77
M v[144:147], a[176:179], a[192:195], v[144:147]
buffer_load_dwordx4 v1, s[12:15], s43 offen offset:0 sc1 lds
M v[148:151], a[176:179], a[208:211], 0
v_exp_f32 v78, v78
M v[148:151], a[172:175], a[204:207], v[148:151]
v_cvt_pk_bf16_f32 v75, v90, v91
v_cvt_pk_bf16_f32 v76, v76, v77
M v[148:151], a[168:171], a[200:203], v[148:151]
v_exp_f32 v79, v79
M v[148:151], a[164:167], a[196:199], v[148:151]
buffer_load_dwordx4 v1, s[12:15], s43 offen offset:1024 sc1 lds
M v[152:155], a[164:167], a[212:215], 0
v_exp_f32 v92, v92
M v[152:155], a[168:171], a[216:219], v[152:155]
ds_read_b128 a[140:143], v5 offset:35840
ds_read_b128 a[144:147], v5 offset:44032
M v[152:155], a[172:175], a[220:223], v[152:155]
v_exp_f32 v93, v93
M v[152:155], a[176:179], a[224:227], v[152:155]
buffer_load_dwordx4 v1, s[12:15], s43 offen offset:2048 sc1 lds
M v[156:159], a[176:179], a[240:243], 0
v_exp_f32 v94, v94
M v[156:159], a[172:175], a[236:239], v[156:159]
v_cvt_pk_bf16_f32 v77, v78, v79
v_cvt_pk_bf16_f32 v78, v92, v93
M v[156:159], a[168:171], a[232:235], v[156:159]
v_exp_f32 v95, v95
M v[156:159], a[164:167], a[228:231], v[156:159]
buffer_load_dwordx4 v1, s[12:15], s43 offen offset:3072 sc1 lds
v_cvt_pk_bf16_f32 v79, v94, v95
s_waitcnt lgkmcnt(6)
M v[160:163], a[116:119], v[32:35], 0
v_exp_f32 v96, v96
M v[160:163], a[120:123], v[64:67], v[160:163]
ds_read_b128 a[148:151], v5 offset:36864
ds_read_b128 a[152:155], v5 offset:45056
M v[164:167], a[120:123], v[68:71], 0
v_exp_f32 v97, v97
M v[164:167], a[116:119], v[36:39], v[164:167]
v_cvt_pk_bf16_f32 v96, v96, v97
M v[168:171], a[116:119], v[40:43], 0
v_exp_f32 v98, v98
M v[168:171], a[120:123], v[72:75], v[168:171]
s_add_u32 s25, s25, 32768
s_cmp_eq_u32 s25, s27
M v[172:175], a[120:123], v[76:79], 0
v_exp_f32 v99, v99
M v[172:175], a[116:119], v[44:47], v[172:175]
v_cvt_pk_bf16_f32 v97, v98, v99
s_waitcnt lgkmcnt(6)
M a[96:99], a[112:115], v[32:35], 0
s_cselect_b32 s25, s28, s25
s_cselect_b32 s27, -1, s27
M a[96:99], a[112:115], v[64:67], a[96:99]
s_add_u32 s26, s26, 32768
s_cmp_eq_u32 s26, s62
M v[176:179], a[124:127], v[32:35], 0
v_exp_f32 v112, v112
M v[176:179], a[128:131], v[64:67], v[176:179]
ds_read_b128 a[156:159], v5 offset:37888
ds_read_b128 a[160:163], v5 offset:46080
M v[180:183], a[128:131], v[68:71], 0
v_exp_f32 v113, v113
M v[180:183], a[124:127], v[36:39], v[180:183]
v_cvt_pk_bf16_f32 v98, v112, v113
M v[184:187], a[124:127], v[40:43], 0
v_exp_f32 v114, v114
M v[184:187], a[128:131], v[72:75], v[184:187]
s_cselect_b32 s26, s63, s26
s_cselect_b32 s62, -1, s62
M v[188:191], a[128:131], v[76:79], 0
v_exp_f32 v115, v115
M v[188:191], a[124:127], v[44:47], v[188:191]
v_cvt_pk_bf16_f32 v99, v114, v115
s_waitcnt lgkmcnt(6)
M a[100:103], a[112:115], v[36:39], 0
M a[100:103], a[112:115], v[68:71], a[100:103]
M v[192:195], a[132:135], v[32:35], 0
v_exp_f32 v100, v100
M v[192:195], a[136:139], v[64:67], v[192:195]
ds_read_b128 a[164:167], v5 offset:38912
ds_read_b128 a[168:171], v5 offset:47104
M v[196:199], a[136:139], v[68:71], 0
v_exp_f32 v101, v101
M v[196:199], a[132:135], v[36:39], v[196:199]
v_cvt_pk_bf16_f32 v100, v100, v101
M v[200:203], a[132:135], v[40:43], 0
v_exp_f32 v102, v102
M v[200:203], a[136:139], v[72:75], v[200:203]
M v[204:207], a[136:139], v[76:79], 0
v_exp_f32 v103, v103
M v[204:207], a[132:135], v[44:47], v[204:207]
v_cvt_pk_bf16_f32 v101, v102, v103
s_waitcnt lgkmcnt(6)
M a[104:107], a[112:115], v[40:43], 0
M a[104:107], a[112:115], v[72:75], a[104:107]
M v[208:211], a[140:143], v[32:35], 0
v_exp_f32 v116, v116
M v[208:211], a[144:147], v[64:67], v[208:211]
ds_read_b128 a[172:175], v5 offset:39936
ds_read_b128 a[176:179], v5 offset:48128
M v[212:215], a[144:147], v[68:71], 0
v_exp_f32 v117, v117
M v[212:215], a[140:143], v[36:39], v[212:215]
v_cvt_pk_bf16_f32 v102, v116, v117
M v[216:219], a[140:143], v[40:43], 0
v_exp_f32 v118, v118
M v[216:219], a[144:147], v[72:75], v[216:219]
M v[220:223], a[144:147], v[76:79], 0
v_exp_f32 v119, v119
M v[220:223], a[140:143], v[44:47], v[220:223]
v_cvt_pk_bf16_f32 v103, v118, v119
s_waitcnt lgkmcnt(6)
M a[108:111], a[112:115], v[44:47], 0
M a[108:111], a[112:115], v[76:79], a[108:111]
M v[224:227], a[148:151], v[32:35], 0
v_exp_f32 v104, v104
M v[224:227], a[152:155], v[64:67], v[224:227]
M v[228:231], a[152:155], v[68:71], 0
v_exp_f32 v105, v105
M v[228:231], a[148:151], v[36:39], v[228:231]
v_cvt_pk_bf16_f32 v104, v104, v105
M v[232:235], a[148:151], v[40:43], 0
v_exp_f32 v106, v106
M v[232:235], a[152:155], v[72:75], v[232:235]
M v[236:239], a[152:155], v[76:79], 0
v_exp_f32 v107, v107
M v[236:239], a[148:151], v[44:47], v[236:239]
v_cvt_pk_bf16_f32 v105, v106, v107
s_waitcnt lgkmcnt(4)
M v[240:243], a[156:159], v[32:35], 0
v_exp_f32 v120, v120
M v[240:243], a[160:163], v[64:67], v[240:243]
M v[244:247], a[160:163], v[68:71], 0
v_exp_f32 v121, v121
M v[244:247], a[156:159], v[36:39], v[244:247]
v_cvt_pk_bf16_f32 v106, v120, v121
M v[248:251], a[156:159], v[40:43], 0
v_exp_f32 v122, v122
M v[248:251], a[160:163], v[72:75], v[248:251]
s_waitcnt vmcnt(0) lgkmcnt(0)
s_barrier
ds_read_b128 a[116:119], v3 offset:0
ds_read_b128 a[120:123], v3 offset:1024
M v[252:255], a[160:163], v[76:79], 0
v_exp_f32 v123, v123
M v[252:255], a[156:159], v[44:47], v[252:255]
v_cvt_pk_bf16_f32 v107, v122, v123
M a[64:67], a[164:167], v[32:35], 0
v_exp_f32 v108, v108
M a[64:67], a[168:171], v[64:67], a[64:67]
ds_read_b128 a[124:127], v3 offset:2048
ds_read_b128 a[128:131], v3 offset:3072
M a[68:71], a[168:171], v[68:71], 0
v_exp_f32 v109, v109
M a[68:71], a[164:167], v[36:39], a[68:71]
v_cvt_pk_bf16_f32 v108, v108, v109
M a[72:75], a[164:167], v[40:43], 0
v_exp_f32 v110, v110
M a[72:75], a[168:171], v[72:75], a[72:75]
ds_read_b128 a[132:135], v3 offset:4096
ds_read_b128 a[136:139], v3 offset:5120
M a[76:79], a[168:171], v[76:79], 0
v_exp_f32 v111, v111
M a[76:79], a[164:167], v[44:47], a[76:79]
v_cvt_pk_bf16_f32 v109, v110, v111
M a[80:83], a[172:175], v[32:35], 0
v_exp_f32 v124, v124
M a[80:83], a[176:179], v[64:67], a[80:83]
ds_read_b128 a[140:143], v3 offset:6144
ds_read_b128 a[144:147], v3 offset:7168
M a[84:87], a[176:179], v[68:71], 0
v_exp_f32 v125, v125
M a[84:87], a[172:175], v[36:39], a[84:87]
v_cvt_pk_bf16_f32 v110, v124, v125
M a[88:91], a[172:175], v[40:43], 0
v_exp_f32 v126, v126
M a[88:91], a[176:179], v[72:75], a[88:91]
M a[92:95], a[176:179], v[76:79], 0
v_exp_f32 v127, v127
M a[92:95], a[172:175], v[44:47], a[92:95]
v_cvt_pk_bf16_f32 v111, v126, v127
s_branch Lk2_l2b
Lk2_l2:
s_add_u32 m0, s29, 65536
s_waitcnt lgkmcnt(4)
M v[96:99], a[116:119], a[180:183], 0
v_exp_f32 v64, v64
M v[96:99], a[120:123], a[184:187], v[96:99]
ds_read_b128 a[148:151], v2 offset:8192
ds_read_b128 a[152:155], v2 offset:9216
M v[96:99], a[124:127], a[188:191], v[96:99]
v_exp_f32 v65, v65
M v[96:99], a[128:131], a[192:195], v[96:99]
buffer_load_dwordx4 v1, s[12:15], s25 offen offset:0 sc1 lds
s_add_u32 s32, s25, 4096
M v[100:103], a[128:131], a[208:211], 0
v_exp_f32 v66, v66
M v[100:103], a[124:127], a[204:207], v[100:103]
v_cvt_pk_bf16_f32 v64, v64, v65
M v[100:103], a[120:123], a[200:203], v[100:103]
v_exp_f32 v67, v67
M v[100:103], a[116:119], a[196:199], v[100:103]
buffer_load_dwordx4 v1, s[12:15], s25 offen offset:1024 sc1 lds
M v[104:107], a[116:119], a[212:215], 0
v_exp_f32 v80, v80
M v[104:107], a[120:123], a[216:219], v[104:107]
ds_read_b128 a[156:159], v2 offset:10240
ds_read_b128 a[160:163], v2 offset:11264
M v[104:107], a[124:127], a[220:223], v[104:107]
v_exp_f32 v81, v81
M v[104:107], a[128:131], a[224:227], v[104:107]
buffer_load_dwordx4 v1, s[12:15], s25 offen offset:2048 sc1 lds
M v[108:111], a[128:131], a[240:243], 0
v_exp_f32 v82, v82
M v[108:111], a[124:127], a[236:239], v[108:111]
v_cvt_pk_bf16_f32 v65, v66, v67
v_cvt_pk_bf16_f32 v66, v80, v81
M v[108:111], a[120:123], a[232:235], v[108:111]
v_exp_f32 v83, v83
M v[108:111], a[116:119], a[228:231], v[108:111]
buffer_load_dwordx4 v1, s[12:15], s25 offen offset:3072 sc1 lds
s_add_u32 m0, s29, 69632
s_waitcnt lgkmcnt(4)
M v[112:115], a[132:135], a[180:183], 0
v_exp_f32 v68, v68
M v[112:115], a[136:139], a[184:187], v[112:115]
ds_read_b128 a[164:167], v2 offset:12288
ds_read_b128 a[168:171], v2 offset:13312
M v[112:115], a[140:143], a[188:191], v[112:115]
v_exp_f32 v69, v69
M v[112:115], a[144:147], a[192:195], v[112:115]
buffer_load_dwordx4 v1, s[12:15], s32 offen offset:0 sc1 lds
M v[116:119], a[144:147], a[208:211], 0
v_exp_f32 v70, v70
M v[116:119], a[140:143], a[204:207], v[116:119]
v_cvt_pk_bf16_f32 v67, v82, v83
v_cvt_pk_bf16_f32 v68, v68, v69
M v[116:119], a[136:139], a[200:203], v[116:119]
v_exp_f32 v71, v71
M v[116:119], a[132:135], a[196:199], v[116:119]
buffer_load_dwordx4 v1, s[12:15], s32 offen offset:1024 sc1 lds
M v[120:123], a[132:135], a[212:215], 0
v_exp_f32 v84, v84
M v[120:123], a[136:139], a[216:219], v[120:123]
ds_read_b128 a[172:175], v2 offset:14336
ds_read_b128 a[176:179], v2 offset:15360
M v[120:123], a[140:143], a[220:223], v[120:123]
v_exp_f32 v85, v85
M v[120:123], a[144:147], a[224:227], v[120:123]
buffer_load_dwordx4 v1, s[12:15], s32 offen offset:2048 sc1 lds
M v[124:127], a[144:147], a[240:243], 0
v_exp_f32 v86, v86
M v[124:127], a[140:143], a[236:239], v[124:127]
v_cvt_pk_bf16_f32 v69, v70, v71
v_cvt_pk_bf16_f32 v70, v84, v85
M v[124:127], a[136:139], a[232:235], v[124:127]
v_exp_f32 v87, v87
M v[124:127], a[132:135], a[228:231], v[124:127]
buffer_load_dwordx4 v1, s[12:15], s32 offen offset:3072 sc1 lds
s_add_u32 m0, s29, 98304
s_waitcnt lgkmcnt(4)
M v[128:131], a[148:151], a[180:183], 0
v_exp_f32 v72, v72
M v[128:131], a[152:155], a[184:187], v[128:131]
ds_read_b128 a[116:119], v5 offset:32768
ds_read_b128 a[120:123], v5 offset:40960
M v[128:131], a[156:159], a[188:191], v[128:131]
v_exp_f32 v73, v73
M v[128:131], a[160:163], a[192:195], v[128:131]
buffer_load_dwordx4 v1, s[12:15], s26 offen offset:0 sc1 lds
s_add_u32 s43, s26, 4096
M v[132:135], a[160:163], a[208:211], 0
v_exp_f32 v74, v74
M v[132:135], a[156:159], a[204:207], v[132:135]
v_cvt_pk_bf16_f32 v71, v86, v87
v_cvt_pk_bf16_f32 v72, v72, v73
M v[132:135], a[152:155], a[200:203], v[132:135]
v_exp_f32 v75, v75
M v[132:135], a[148:151], a[196:199], v[132:135]
buffer_load_dwordx4 v1, s[12:15], s26 offen offset:1024 sc1 lds
M v[136:139], a[148:151], a[212:215], 0
v_exp_f32 v88, v88
M v[136:139], a[152:155], a[216:219], v[136:139]
ds_read_b128 a[124:127], v5 offset:33792
ds_read_b128 a[128:131], v5 offset:41984
M v[136:139], a[156:159], a[220:223], v[136:139]
v_exp_f32 v89, v89
M v[136:139], a[160:163], a[224:227], v[136:139]
buffer_load_dwordx4 v1, s[12:15], s26 offen offset:2048 sc1 lds
M v[140:143], a[160:163], a[240:243], 0
v_exp_f32 v90, v90
M v[140:143], a[156:159], a[236:239], v[140:143]
v_cvt_pk_bf16_f32 v73, v74, v75
v_cvt_pk_bf16_f32 v74, v88, v89
M v[140:143], a[152:155], a[232:235], v[140:143]
v_exp_f32 v91, v91
M v[140:143], a[148:151], a[228:231], v[140:143]
buffer_load_dwordx4 v1, s[12:15], s26 offen offset:3072 sc1 lds
s_add_u32 m0, s29, 102400
s_waitcnt lgkmcnt(4)
M v[144:147], a[164:167], a[180:183], 0
v_exp_f32 v76, v76
M v[144:147], a[168:171], a[184:187], v[144:147]
ds_read_b128 a[132:135], v5 offset:34816
ds_read_b128 a[136:139], v5 offset:43008
M v[144:147], a[172:175], a[188:191], v[144:147]
v_exp_f32 v77, v77
M v[144:147], a[176:179], a[192:195], v[144:147]
buffer_load_dwordx4 v1, s[12:15], s43 offen offset:0 sc1 lds
M v[148:151], a[176:179], a[208:211], 0
v_exp_f32 v78, v78
M v[148:151], a[172:175], a[204:207], v[148:151]
v_cvt_pk_bf16_f32 v75, v90, v91
v_cvt_pk_bf16_f32 v76, v76, v77
M v[148:151], a[168:171], a[200:203], v[148:151]
v_exp_f32 v79, v79
M v[148:151], a[164:167], a[196:199], v[148:151]
buffer_load_dwordx4 v1, s[12:15], s43 offen offset:1024 sc1 lds
M v[152:155], a[164:167], a[212:215], 0
v_exp_f32 v92, v92
M v[152:155], a[168:171], a[216:219], v[152:155]
ds_read_b128 a[140:143], v5 offset:35840
ds_read_b128 a[144:147], v5 offset:44032
M v[152:155], a[172:175], a[220:223], v[152:155]
v_exp_f32 v93, v93
M v[152:155], a[176:179], a[224:227], v[152:155]
buffer_load_dwordx4 v1, s[12:15], s43 offen offset:2048 sc1 lds
M v[156:159], a[176:179], a[240:243], 0
v_exp_f32 v94, v94
M v[156:159], a[172:175], a[236:239], v[156:159]
v_cvt_pk_bf16_f32 v77, v78, v79
v_cvt_pk_bf16_f32 v78, v92, v93
M v[156:159], a[168:171], a[232:235], v[156:159]
v_exp_f32 v95, v95
M v[156:159], a[164:167], a[228:231], v[156:159]
buffer_load_dwordx4 v1, s[12:15], s43 offen offset:3072 sc1 lds
v_cvt_pk_bf16_f32 v79, v94, v95
s_waitcnt lgkmcnt(6)
M v[160:163], a[116:119], v[32:35], v[160:163]
v_exp_f32 v96, v96
M v[160:163], a[120:123], v[64:67], v[160:163]
ds_read_b128 a[148:151], v5 offset:36864
ds_read_b128 a[152:155], v5 offset:45056
M v[164:167], a[120:123], v[68:71], v[164:167]
v_exp_f32 v97, v97
M v[164:167], a[116:119], v[36:39], v[164:167]
v_cvt_pk_bf16_f32 v96, v96, v97
M v[168:171], a[116:119], v[40:43], v[168:171]
v_exp_f32 v98, v98
M v[168:171], a[120:123], v[72:75], v[168:171]
s_add_u32 s25, s25, 32768
s_cmp_eq_u32 s25, s27
M v[172:175], a[120:123], v[76:79], v[172:175]
v_exp_f32 v99, v99
M v[172:175], a[116:119], v[44:47], v[172:175]
v_cvt_pk_bf16_f32 v97, v98, v99
s_waitcnt lgkmcnt(6)
M a[96:99], a[112:115], v[32:35], a[96:99]
s_cselect_b32 s25, s28, s25
s_cselect_b32 s27, -1, s27
M a[96:99], a[112:115], v[64:67], a[96:99]
s_add_u32 s26, s26, 32768
s_cmp_eq_u32 s26, s62
M v[176:179], a[124:127], v[32:35], v[176:179]
v_exp_f32 v112, v112
M v[176:179], a[128:131], v[64:67], v[176:179]
ds_read_b128 a[156:159], v5 offset:37888
ds_read_b128 a[160:163], v5 offset:46080
M v[180:183], a[128:131], v[68:71], v[180:183]
v_exp_f32 v113, v113
M v[180:183], a[124:127], v[36:39], v[180:183]
v_cvt_pk_bf16_f32 v98, v112, v113
M v[184:187], a[124:127], v[40:43], v[184:187]
v_exp_f32 v114, v114
M v[184:187], a[128:131], v[72:75], v[184:187]
s_cselect_b32 s26, s63, s26
s_cselect_b32 s62, -1, s62
M v[188:191], a[128:131], v[76:79], v[188:191]
v_exp_f32 v115, v115
M v[188:191], a[124:127], v[44:47], v[188:191]
v_cvt_pk_bf16_f32 v99, v114, v115
s_waitcnt lgkmcnt(6)
M a[100:103], a[112:115], v[36:39], a[100:103]
M a[100:103], a[112:115], v[68:71], a[100:103]
M v[192:195], a[132:135], v[32:35], v[192:195]
v_exp_f32 v100, v100
M v[192:195], a[136:139], v[64:67], v[192:195]
ds_read_b128 a[164:167], v5 offset:38912
ds_read_b128 a[168:171], v5 offset:47104
M v[196:199], a[136:139], v[68:71], v[196:199]
v_exp_f32 v101, v101
M v[196:199], a[132:135], v[36:39], v[196:199]
v_cvt_pk_bf16_f32 v100, v100, v101
M v[200:203], a[132:135], v[40:43], v[200:203]
v_exp_f32 v102, v102
M v[200:203], a[136:139], v[72:75], v[200:203]
M v[204:207], a[136:139], v[76:79], v[204:207]
v_exp_f32 v103, v103
M v[204:207], a[132:135], v[44:47], v[204:207]
v_cvt_pk_bf16_f32 v101, v102, v103
s_waitcnt lgkmcnt(6)
M a[104:107], a[112:115], v[40:43], a[104:107]
M a[104:107], a[112:115], v[72:75], a[104:107]
M v[208:211], a[140:143], v[32:35], v[208:211]
v_exp_f32 v116, v116
M v[208:211], a[144:147], v[64:67], v[208:211]
ds_read_b128 a[172:175], v5 offset:39936
ds_read_b128 a[176:179], v5 offset:48128
M v[212:215], a[144:147], v[68:71], v[212:215]
v_exp_f32 v117, v117
M v[212:215], a[140:143], v[36:39], v[212:215]
v_cvt_pk_bf16_f32 v102, v116, v117
M v[216:219], a[140:143], v[40:43], v[216:219]
v_exp_f32 v118, v118
M v[216:219], a[144:147], v[72:75], v[216:219]
M v[220:223], a[144:147], v[76:79], v[220:223]
v_exp_f32 v119, v119
M v[220:223], a[140:143], v[44:47], v[220:223]
v_cvt_pk_bf16_f32 v103, v118, v119
s_waitcnt lgkmcnt(6)
M a[108:111], a[112:115], v[44:47], a[108:111]
M a[108:111], a[112:115], v[76:79], a[108:111]
M v[224:227], a[148:151], v[32:35], v[224:227]
v_exp_f32 v104, v104
M v[224:227], a[152:155], v[64:67], v[224:227]
M v[228:231], a[152:155], v[68:71], v[228:231]
v_exp_f32 v105, v105
M v[228:231], a[148:151], v[36:39], v[228:231]
v_cvt_pk_bf16_f32 v104, v104, v105
M v[232:235], a[148:151], v[40:43], v[232:235]
v_exp_f32 v106, v106
M v[232:235], a[152:155], v[72:75], v[232:235]
M v[236:239], a[152:155], v[76:79], v[236:239]
v_exp_f32 v107, v107
M v[236:239], a[148:151], v[44:47], v[236:239]
v_cvt_pk_bf16_f32 v105, v106, v107
s_waitcnt lgkmcnt(4)
M v[240:243], a[156:159], v[32:35], v[240:243]
v_exp_f32 v120, v120
M v[240:243], a[160:163], v[64:67], v[240:243]
M v[244:247], a[160:163], v[68:71], v[244:247]
v_exp_f32 v121, v121
M v[244:247], a[156:159], v[36:39], v[244:247]
v_cvt_pk_bf16_f32 v106, v120, v121
M v[248:251], a[156:159], v[40:43], v[248:251]
v_exp_f32 v122, v122
M v[248:251], a[160:163], v[72:75], v[248:251]
s_waitcnt vmcnt(0) lgkmcnt(0)
s_barrier
ds_read_b128 a[116:119], v3 offset:0
ds_read_b128 a[120:123], v3 offset:1024
M v[252:255], a[160:163], v[76:79], v[252:255]
v_exp_f32 v123, v123
M v[252:255], a[156:159], v[44:47], v[252:255]
v_cvt_pk_bf16_f32 v107, v122, v123
M a[64:67], a[164:167], v[32:35], a[64:67]
v_exp_f32 v108, v108
M a[64:67], a[168:171], v[64:67], a[64:67]
ds_read_b128 a[124:127], v3 offset:2048
ds_read_b128 a[128:131], v3 offset:3072
M a[68:71], a[168:171], v[68:71], a[68:71]
v_exp_f32 v109, v109
M a[68:71], a[164:167], v[36:39], a[68:71]
v_cvt_pk_bf16_f32 v108, v108, v109
M a[72:75], a[164:167], v[40:43], a[72:75]
v_exp_f32 v110, v110
M a[72:75], a[168:171], v[72:75], a[72:75]
ds_read_b128 a[132:135], v3 offset:4096
ds_read_b128 a[136:139], v3 offset:5120
M a[76:79], a[168:171], v[76:79], a[76:79]
v_exp_f32 v111, v111
M a[76:79], a[164:167], v[44:47], a[76:79]
v_cvt_pk_bf16_f32 v109, v110, v111
M a[80:83], a[172:175], v[32:35], a[80:83]
v_exp_f32 v124, v124
M a[80:83], a[176:179], v[64:67], a[80:83]
ds_read_b128 a[140:143], v3 offset:6144
ds_read_b128 a[144:147], v3 offset:7168
M a[84:87], a[176:179], v[68:71], a[84:87]
v_exp_f32 v125, v125
M a[84:87], a[172:175], v[36:39], a[84:87]
v_cvt_pk_bf16_f32 v110, v124, v125
M a[88:91], a[172:175], v[40:43], a[88:91]
v_exp_f32 v126, v126
M a[88:91], a[176:179], v[72:75], a[88:91]
M a[92:95], a[176:179], v[76:79], a[92:95]
v_exp_f32 v127, v127
M a[92:95], a[172:175], v[44:47], a[92:95]
v_cvt_pk_bf16_f32 v111, v126, v127
Lk2_l2b:
s_add_u32 m0, s29, 0
s_waitcnt lgkmcnt(4)
M v[32:35], a[116:119], a[180:183], 0
v_exp_f32 v128, v128
M v[32:35], a[120:123], a[184:187], v[32:35]
ds_read_b128 a[148:151], v3 offset:8192
ds_read_b128 a[152:155], v3 offset:9216
M v[32:35], a[124:127], a[188:191], v[32:35]
v_exp_f32 v129, v129
M v[32:35], a[128:131], a[192:195], v[32:35]
buffer_load_dwordx4 v1, s[12:15], s25 offen offset:0 sc1 lds
s_add_u32 s32, s25, 4096
M v[36:39], a[128:131], a[208:211], 0
v_exp_f32 v130, v130
M v[36:39], a[124:127], a[204:207], v[36:39]
v_cvt_pk_bf16_f32 v128, v128, v129
M v[36:39], a[120:123], a[200:203], v[36:39]
v_exp_f32 v131, v131
M v[36:39], a[116:119], a[196:199], v[36:39]
buffer_load_dwordx4 v1, s[12:15], s25 offen offset:1024 sc1 lds
M v[40:43], a[116:119], a[212:215], 0
v_exp_f32 v144, v144
M v[40:43], a[120:123], a[216:219], v[40:43]
ds_read_b128 a[156:159], v3 offset:10240
ds_read_b128 a[160:163], v3 offset:11264
M v[40:43], a[124:127], a[220:223], v[40:43]
v_exp_f32 v145, v145
M v[40:43], a[128:131], a[224:227], v[40:43]
buffer_load_dwordx4 v1, s[12:15], s25 offen offset:2048 sc1 lds
M v[44:47], a[128:131], a[240:243], 0
v_exp_f32 v146, v146
M v[44:47], a[124:127], a[236:239], v[44:47]
v_cvt_pk_bf16_f32 v129, v130, v131
v_cvt_pk_bf16_f32 v130, v144, v145
M v[44:47], a[120:123], a[232:235], v[44:47]
v_exp_f32 v147, v147
M v[44:47], a[116:119], a[228:231], v[44:47]
buffer_load_dwordx4 v1, s[12:15], s25 offen offset:3072 sc1 lds
s_add_u32 m0, s29, 4096
s_waitcnt lgkmcnt(4)
M v[48:51], a[132:135], a[180:183], 0
v_exp_f32 v132, v132
M v[48:51], a[136:139], a[184:187], v[48:51]
ds_read_b128 a[164:167], v3 offset:12288
ds_read_b128 a[168:171], v3 offset:13312
M v[48:51], a[140:143], a[188:191], v[48:51]
v_exp_f32 v133, v133
M v[48:51], a[144:147], a[192:195], v[48:51]
buffer_load_dwordx4 v1, s[12:15], s32 offen offset:0 sc1 lds
M v[52:55], a[144:147], a[208:211], 0
v_exp_f32 v134, v134
M v[52:55], a[140:143], a[204:207], v[52:55]
v_cvt_pk_bf16_f32 v131, v146, v147
v_cvt_pk_bf16_f32 v132, v132, v133
M v[52:55], a[136:139], a[200:203], v[52:55]
v_exp_f32 v135, v135
M v[52:55], a[132:135], a[196:199], v[52:55]
buffer_load_dwordx4 v1, s[12:15], s32 offen offset:1024 sc1 lds
M v[56:59], a[132:135], a[212:215], 0
v_exp_f32 v148, v148
M v[56:59], a[136:139], a[216:219], v[56:59]
ds_read_b128 a[172:175], v3 offset:14336
ds_read_b128 a[176:179], v3 offset:15360
M v[56:59], a[140:143], a[220:223], v[56:59]
v_exp_f32 v149, v149
M v[56:59], a[144:147], a[224:227], v[56:59]
buffer_load_dwordx4 v1, s[12:15], s32 offen offset:2048 sc1 lds
M v[60:63], a[144:147], a[240:243], 0
v_exp_f32 v150, v150
M v[60:63], a[140:143], a[236:239], v[60:63]
v_cvt_pk_bf16_f32 v133, v134, v135
v_cvt_pk_bf16_f32 v134, v148, v149
M v[60:63], a[136:139], a[232:235], v[60:63]
v_exp_f32 v151, v151
M v[60:63], a[132:135], a[228:231], v[60:63]
buffer_load_dwordx4 v1, s[12:15], s32 offen offset:3072 sc1 lds
s_add_u32 m0, s29, 32768
s_waitcnt lgkmcnt(4)
M v[64:67], a[148:151], a[180:183], 0
v_exp_f32 v136, v136
M v[64:67], a[152:155], a[184:187], v[64:67]
ds_read_b128 a[116:119], v6 offset:32768
ds_read_b128 a[120:123], v6 offset:40960
M v[64:67], a[156:159], a[188:191], v[64:67]
v_exp_f32 v137, v137
M v[64:67], a[160:163], a[192:195], v[64:67]
buffer_load_dwordx4 v1, s[12:15], s26 offen offset:0 sc1 lds
s_add_u32 s43, s26, 4096
M v[68:71], a[160:163], a[208:211], 0
v_exp_f32 v138, v138
M v[68:71], a[156:159], a[204:207], v[68:71]
v_cvt_pk_bf16_f32 v135, v150, v151
v_cvt_pk_bf16_f32 v136, v136, v137
M v[68:71], a[152:155], a[200:203], v[68:71]
v_exp_f32 v139, v139
M v[68:71], a[148:151], a[196:199], v[68:71]
buffer_load_dwordx4 v1, s[12:15], s26 offen offset:1024 sc1 lds
M v[72:75], a[148:151], a[212:215], 0
v_exp_f32 v152, v152
M v[72:75], a[152:155], a[216:219], v[72:75]
ds_read_b128 a[124:127], v6 offset:33792
ds_read_b128 a[128:131], v6 offset:41984
M v[72:75], a[156:159], a[220:223], v[72:75]
v_exp_f32 v153, v153
M v[72:75], a[160:163], a[224:227], v[72:75]
buffer_load_dwordx4 v1, s[12:15], s26 offen offset:2048 sc1 lds
M v[76:79], a[160:163], a[240:243], 0
v_exp_f32 v154, v154
M v[76:79], a[156:159], a[236:239], v[76:79]
v_cvt_pk_bf16_f32 v137, v138, v139
v_cvt_pk_bf16_f32 v138, v152, v153
M v[76:79], a[152:155], a[232:235], v[76:79]
v_exp_f32 v155, v155
M v[76:79], a[148:151], a[228:231], v[76:79]
buffer_load_dwordx4 v1, s[12:15], s26 offen offset:3072 sc1 lds
s_add_u32 m0, s29, 36864
s_waitcnt lgkmcnt(4)
M v[80:83], a[164:167], a[180:183], 0
v_exp_f32 v140, v140
M v[80:83], a[168:171], a[184:187], v[80:83]
ds_read_b128 a[132:135], v6 offset:34816
ds_read_b128 a[136:139], v6 offset:43008
M v[80:83], a[172:175], a[188:191], v[80:83]
v_exp_f32 v141, v141
M v[80:83], a[176:179], a[192:195], v[80:83]
buffer_load_dwordx4 v1, s[12:15], s43 offen offset:0 sc1 lds
M v[84:87], a[176:179], a[208:211], 0
v_exp_f32 v142, v142
M v[84:87], a[172:175], a[204:207], v[84:87]
v_cvt_pk_bf16_f32 v139, v154, v155
v_cvt_pk_bf16_f32 v140, v140, v141
M v[84:87], a[168:171], a[200:203], v[84:87]
v_exp_f32 v143, v143
M v[84:87], a[164:167], a[196:199], v[84:87]
buffer_load_dwordx4 v1, s[12:15], s43 offen offset:1024 sc1 lds
M v[88:91], a[164:167], a[212:215], 0
v_exp_f32 v156, v156
M v[88:91], a[168:171], a[216:219], v[88:91]
ds_read_b128 a[140:143], v6 offset:35840
ds_read_b128 a[144:147], v6 offset:44032
M v[88:91], a[172:175], a[220:223], v[88:91]
v_exp_f32 v157, v157
M v[88:91], a[176:179], a[224:227], v[88:91]
buffer_load_dwordx4 v1, s[12:15], s43 offen offset:2048 sc1 lds
M v[92:95], a[176:179], a[240:243], 0
v_exp_f32 v158, v158
M v[92:95], a[172:175], a[236:239], v[92:95]
v_cvt_pk_bf16_f32 v141, v142, v143
v_cvt_pk_bf16_f32 v142, v156, v157
M v[92:95], a[168:171], a[232:235], v[92:95]
v_exp_f32 v159, v159
M v[92:95], a[164:167], a[228:231], v[92:95]
buffer_load_dwordx4 v1, s[12:15], s43 offen offset:3072 sc1 lds
v_cvt_pk_bf16_f32 v143, v158, v159
s_waitcnt lgkmcnt(6)
M v[160:163], a[116:119], v[96:99], v[160:163]
v_exp_f32 v32, v32
M v[160:163], a[120:123], v[128:131], v[160:163]
ds_read_b128 a[148:151], v6 offset:36864
ds_read_b128 a[152:155], v6 offset:45056
M v[164:167], a[120:123], v[132:135], v[164:167]
v_exp_f32 v33, v33
M v[164:167], a[116:119], v[100:103], v[164:167]
v_cvt_pk_bf16_f32 v32, v32, v33
M v[168:171], a[116:119], v[104:107], v[168:171]
v_exp_f32 v34, v34
M v[168:171], a[120:123], v[136:139], v[168:171]
s_add_u32 s25, s25, 32768
s_cmp_eq_u32 s25, s27
M v[172:175], a[120:123], v[140:143], v[172:175]
v_exp_f32 v35, v35
M v[172:175], a[116:119], v[108:111], v[172:175]
v_cvt_pk_bf16_f32 v33, v34, v35
s_waitcnt lgkmcnt(6)
M a[96:99], a[112:115], v[96:99], a[96:99]
s_cselect_b32 s25, s28, s25
s_cselect_b32 s27, -1, s27
M a[96:99], a[112:115], v[128:131], a[96:99]
s_add_u32 s26, s26, 32768
s_cmp_eq_u32 s26, s62
M v[176:179], a[124:127], v[96:99], v[176:179]
v_exp_f32 v48, v48
M v[176:179], a[128:131], v[128:131], v[176:179]
ds_read_b128 a[156:159], v6 offset:37888
ds_read_b128 a[160:163], v6 offset:46080
M v[180:183], a[128:131], v[132:135], v[180:183]
v_exp_f32 v49, v49
M v[180:183], a[124:127], v[100:103], v[180:183]
v_cvt_pk_bf16_f32 v34, v48, v49
M v[184:187], a[124:127], v[104:107], v[184:187]
v_exp_f32 v50, v50
M v[184:187], a[128:131], v[136:139], v[184:187]
s_cselect_b32 s26, s63, s26
s_cselect_b32 s62, -1, s62
M v[188:191], a[128:131], v[140:143], v[188:191]
v_exp_f32 v51, v51
M v[188:191], a[124:127], v[108:111], v[188:191]
v_cvt_pk_bf16_f32 v35, v50, v51
s_waitcnt lgkmcnt(6)
M a[100:103], a[112:115], v[100:103], a[100:103]
M a[100:103], a[112:115], v[132:135], a[100:103]
M v[192:195], a[132:135], v[96:99], v[192:195]
v_exp_f32 v36, v36
M v[192:195], a[136:139], v[128:131], v[192:195]
ds_read_b128 a[164:167], v6 offset:38912
ds_read_b128 a[168:171], v6 offset:47104
M v[196:199], a[136:139], v[132:135], v[196:199]
v_exp_f32 v37, v37
M v[196:199], a[132:135], v[100:103], v[196:199]
v_cvt_pk_bf16_f32 v36, v36, v37
M v[200:203], a[132:135], v[104:107], v[200:203]
v_exp_f32 v38, v38
M v[200:203], a[136:139], v[136:139], v[200:203]
M v[204:207], a[136:139], v[140:143], v[204:207]
v_exp_f32 v39, v39
M v[204:207], a[132:135], v[108:111], v[204:207]
v_cvt_pk_bf16_f32 v37, v38, v39
s_waitcnt lgkmcnt(6)
M a[104:107], a[112:115], v[104:107], a[104:107]
M a[104:107], a[112:115], v[136:139], a[104:107]
M v[208:211], a[140:143], v[96:99], v[208:211]
v_exp_f32 v52, v52
M v[208:211], a[144:147], v[128:131], v[208:211]
ds_read_b128 a[172:175], v6 offset:39936
ds_read_b128 a[176:179], v6 offset:48128
M v[212:215], a[144:147], v[132:135], v[212:215]
v_exp_f32 v53, v53
M v[212:215], a[140:143], v[100:103], v[212:215]
v_cvt_pk_bf16_f32 v38, v52, v53
M v[216:219], a[140:143], v[104:107], v[216:219]
v_exp_f32 v54, v54
M v[216:219], a[144:147], v[136:139], v[216:219]
M v[220:223], a[144:147], v[140:143], v[220:223]
v_exp_f32 v55, v55
M v[220:223], a[140:143], v[108:111], v[220:223]
v_cvt_pk_bf16_f32 v39, v54, v55
s_waitcnt lgkmcnt(6)
M a[108:111], a[112:115], v[108:111], a[108:111]
M a[108:111], a[112:115], v[140:143], a[108:111]
M v[224:227], a[148:151], v[96:99], v[224:227]
v_exp_f32 v40, v40
M v[224:227], a[152:155], v[128:131], v[224:227]
M v[228:231], a[152:155], v[132:135], v[228:231]
v_exp_f32 v41, v41
M v[228:231], a[148:151], v[100:103], v[228:231]
v_cvt_pk_bf16_f32 v40, v40, v41
M v[232:235], a[148:151], v[104:107], v[232:235]
v_exp_f32 v42, v42
M v[232:235], a[152:155], v[136:139], v[232:235]
M v[236:239], a[152:155], v[140:143], v[236:239]
v_exp_f32 v43, v43
M v[236:239], a[148:151], v[108:111], v[236:239]
v_cvt_pk_bf16_f32 v41, v42, v43
s_waitcnt lgkmcnt(4)
M v[240:243], a[156:159], v[96:99], v[240:243]
v_exp_f32 v56, v56
M v[240:243], a[160:163], v[128:131], v[240:243]
M v[244:247], a[160:163], v[132:135], v[244:247]
v_exp_f32 v57, v57
M v[244:247], a[156:159], v[100:103], v[244:247]
v_cvt_pk_bf16_f32 v42, v56, v57
M v[248:251], a[156:159], v[104:107], v[248:251]
v_exp_f32 v58, v58
M v[248:251], a[160:163], v[136:139], v[248:251]
s_waitcnt vmcnt(0) lgkmcnt(0)
s_barrier
ds_read_b128 a[116:119], v2 offset:0
ds_read_b128 a[120:123], v2 offset:1024
M v[252:255], a[160:163], v[140:143], v[252:255]
v_exp_f32 v59, v59
M v[252:255], a[156:159], v[108:111], v[252:255]
v_cvt_pk_bf16_f32 v43, v58, v59
M a[64:67], a[164:167], v[96:99], a[64:67]
v_exp_f32 v44, v44
M a[64:67], a[168:171], v[128:131], a[64:67]
ds_read_b128 a[124:127], v2 offset:2048
ds_read_b128 a[128:131], v2 offset:3072
M a[68:71], a[168:171], v[132:135], a[68:71]
v_exp_f32 v45, v45
M a[68:71], a[164:167], v[100:103], a[68:71]
v_cvt_pk_bf16_f32 v44, v44, v45
M a[72:75], a[164:167], v[104:107], a[72:75]
v_exp_f32 v46, v46
M a[72:75], a[168:171], v[136:139], a[72:75]
ds_read_b128 a[132:135], v2 offset:4096
ds_read_b128 a[136:139], v2 offset:5120
M a[76:79], a[168:171], v[140:143], a[76:79]
v_exp_f32 v47, v47
M a[76:79], a[164:167], v[108:111], a[76:79]
v_cvt_pk_bf16_f32 v45, v46, v47
M a[80:83], a[172:175], v[96:99], a[80:83]
v_exp_f32 v60, v60
M a[80:83], a[176:179], v[128:131], a[80:83]
ds_read_b128 a[140:143], v2 offset:6144
ds_read_b128 a[144:147], v2 offset:7168
M a[84:87], a[176:179], v[132:135], a[84:87]
v_exp_f32 v61, v61
M a[84:87], a[172:175], v[100:103], a[84:87]
v_cvt_pk_bf16_f32 v46, v60, v61
M a[88:91], a[172:175], v[104:107], a[88:91]
v_exp_f32 v62, v62
M a[88:91], a[176:179], v[136:139], a[88:91]
M a[92:95], a[176:179], v[140:143], a[92:95]
v_exp_f32 v63, v63
M a[92:95], a[172:175], v[108:111], a[92:95]
v_cvt_pk_bf16_f32 v47, v62, v63
s_sub_u32 s30, s30, 1
s_cmp_lg_u32 s30, 0
s_cbranch_scc1 Lk2_l2
s_branch Lk2_fin
s_waitcnt lgkmcnt(0)
Lk2_wm:
s_lshl_b32 s33, s2, 1
s_add_u32 s33, s33, s23
s_lshl_b32 s34, s33, 12
s_lshl_b32 s33, s33, 14
v_lshlrev_b32 v8, 3, v1
v_lshlrev_b32 v9, 2, v1
buffer_load_dword a244, v8, s[44:47], s33 offen
s_add_u32 s33, s33, 8192
buffer_load_dword a245, v8, s[44:47], s33 offen
buffer_load_dword a246, v9, s[48:51], s34 offen
s_branch Lk2_l3b
Lk2_g1:
s_mov_b32 s30, 7
s_bfe_u32 s65, s2, 0x20003
s_add_u32 s65, s65, 2
s_lshl_b32 s42, s21, 1
s_min_u32 s42, s42, 13
s_add_u32 s42, s42, 2
s_sub_u32 s33, s42, 1
s_cmp_le_u32 s33, 1
s_cselect_b32 s33, 0x4000, 0
v_add_u32 v3, s33, v3
s_sub_u32 s42, s42, 1
Lk2_l3:
s_cmp_eq_u32 s30, s65
s_cbranch_scc1 Lk2_wm
Lk2_l3b:
s_add_u32 m0, s29, 65536
s_waitcnt lgkmcnt(4)
M v[96:99], a[116:119], a[0:3], 0
v_exp_f32 v64, v64
M v[96:99], a[120:123], a[4:7], v[96:99]
ds_read_b128 a[148:151], v2 offset:8192
ds_read_b128 a[152:155], v2 offset:9216
M v[96:99], a[124:127], a[8:11], v[96:99]
v_exp_f32 v65, v65
M v[96:99], a[128:131], a[12:15], v[96:99]
buffer_load_dwordx4 v1, s[12:15], s25 offen offset:0 sc1 lds
s_add_u32 s32, s25, 4096
M v[100:103], a[128:131], a[28:31], 0
v_exp_f32 v66, v66
M v[100:103], a[124:127], a[24:27], v[100:103]
v_cvt_pk_bf16_f32 v64, v64, v65
M v[100:103], a[120:123], a[20:23], v[100:103]
v_exp_f32 v67, v67
M v[100:103], a[116:119], a[16:19], v[100:103]
buffer_load_dwordx4 v1, s[12:15], s25 offen offset:1024 sc1 lds
M v[104:107], a[116:119], a[32:35], 0
v_exp_f32 v80, v80
M v[104:107], a[120:123], a[36:39], v[104:107]
ds_read_b128 a[156:159], v2 offset:10240
ds_read_b128 a[160:163], v2 offset:11264
M v[104:107], a[124:127], a[40:43], v[104:107]
v_exp_f32 v81, v81
M v[104:107], a[128:131], a[44:47], v[104:107]
buffer_load_dwordx4 v1, s[12:15], s25 offen offset:2048 sc1 lds
M v[108:111], a[128:131], a[60:63], 0
v_exp_f32 v82, v82
M v[108:111], a[124:127], a[56:59], v[108:111]
v_cvt_pk_bf16_f32 v65, v66, v67
v_cvt_pk_bf16_f32 v66, v80, v81
M v[108:111], a[120:123], a[52:55], v[108:111]
v_exp_f32 v83, v83
M v[108:111], a[116:119], a[48:51], v[108:111]
buffer_load_dwordx4 v1, s[12:15], s25 offen offset:3072 sc1 lds
s_add_u32 m0, s29, 69632
s_waitcnt lgkmcnt(4)
M v[112:115], a[132:135], a[0:3], 0
v_exp_f32 v68, v68
M v[112:115], a[136:139], a[4:7], v[112:115]
ds_read_b128 a[164:167], v2 offset:12288
ds_read_b128 a[168:171], v2 offset:13312
M v[112:115], a[140:143], a[8:11], v[112:115]
v_exp_f32 v69, v69
M v[112:115], a[144:147], a[12:15], v[112:115]
buffer_load_dwordx4 v1, s[12:15], s32 offen offset:0 sc1 lds
M v[116:119], a[144:147], a[28:31], 0
v_exp_f32 v70, v70
M v[116:119], a[140:143], a[24:27], v[116:119]
v_cvt_pk_bf16_f32 v67, v82, v83
v_cvt_pk_bf16_f32 v68, v68, v69
M v[116:119], a[136:139], a[20:23], v[116:119]
v_exp_f32 v71, v71
M v[116:119], a[132:135], a[16:19], v[116:119]
buffer_load_dwordx4 v1, s[12:15], s32 offen offset:1024 sc1 lds
M v[120:123], a[132:135], a[32:35], 0
v_exp_f32 v84, v84
M v[120:123], a[136:139], a[36:39], v[120:123]
ds_read_b128 a[172:175], v2 offset:14336
ds_read_b128 a[176:179], v2 offset:15360
M v[120:123], a[140:143], a[40:43], v[120:123]
v_exp_f32 v85, v85
M v[120:123], a[144:147], a[44:47], v[120:123]
buffer_load_dwordx4 v1, s[12:15], s32 offen offset:2048 sc1 lds
M v[124:127], a[144:147], a[60:63], 0
v_exp_f32 v86, v86
M v[124:127], a[140:143], a[56:59], v[124:127]
v_cvt_pk_bf16_f32 v69, v70, v71
v_cvt_pk_bf16_f32 v70, v84, v85
M v[124:127], a[136:139], a[52:55], v[124:127]
v_exp_f32 v87, v87
M v[124:127], a[132:135], a[48:51], v[124:127]
buffer_load_dwordx4 v1, s[12:15], s32 offen offset:3072 sc1 lds
s_add_u32 m0, s29, 98304
s_waitcnt lgkmcnt(4)
M v[128:131], a[148:151], a[0:3], 0
v_exp_f32 v72, v72
M v[128:131], a[152:155], a[4:7], v[128:131]
ds_read_b128 a[116:119], v5 offset:32768
ds_read_b128 a[120:123], v5 offset:40960
M v[128:131], a[156:159], a[8:11], v[128:131]
v_exp_f32 v73, v73
M v[128:131], a[160:163], a[12:15], v[128:131]
buffer_load_dwordx4 v1, s[12:15], s26 offen offset:0 sc1 lds
s_add_u32 s43, s26, 4096
M v[132:135], a[160:163], a[28:31], 0
v_exp_f32 v74, v74
M v[132:135], a[156:159], a[24:27], v[132:135]
v_cvt_pk_bf16_f32 v71, v86, v87
v_cvt_pk_bf16_f32 v72, v72, v73
M v[132:135], a[152:155], a[20:23], v[132:135]
v_exp_f32 v75, v75
M v[132:135], a[148:151], a[16:19], v[132:135]
buffer_load_dwordx4 v1, s[12:15], s26 offen offset:1024 sc1 lds
M v[136:139], a[148:151], a[32:35], 0
v_exp_f32 v88, v88
M v[136:139], a[152:155], a[36:39], v[136:139]
ds_read_b128 a[124:127], v5 offset:33792
ds_read_b128 a[128:131], v5 offset:41984
M v[136:139], a[156:159], a[40:43], v[136:139]
v_exp_f32 v89, v89
M v[136:139], a[160:163], a[44:47], v[136:139]
buffer_load_dwordx4 v1, s[12:15], s26 offen offset:2048 sc1 lds
M v[140:143], a[160:163], a[60:63], 0
v_exp_f32 v90, v90
M v[140:143], a[156:159], a[56:59], v[140:143]
v_cvt_pk_bf16_f32 v73, v74, v75
v_cvt_pk_bf16_f32 v74, v88, v89
M v[140:143], a[152:155], a[52:55], v[140:143]
v_exp_f32 v91, v91
M v[140:143], a[148:151], a[48:51], v[140:143]
buffer_load_dwordx4 v1, s[12:15], s26 offen offset:3072 sc1 lds
s_add_u32 m0, s29, 102400
s_waitcnt lgkmcnt(4)
M v[144:147], a[164:167], a[0:3], 0
v_exp_f32 v76, v76
M v[144:147], a[168:171], a[4:7], v[144:147]
ds_read_b128 a[132:135], v5 offset:34816
ds_read_b128 a[136:139], v5 offset:43008
M v[144:147], a[172:175], a[8:11], v[144:147]
v_exp_f32 v77, v77
M v[144:147], a[176:179], a[12:15], v[144:147]
buffer_load_dwordx4 v1, s[12:15], s43 offen offset:0 sc1 lds
M v[148:151], a[176:179], a[28:31], 0
v_exp_f32 v78, v78
M v[148:151], a[172:175], a[24:27], v[148:151]
v_cvt_pk_bf16_f32 v75, v90, v91
v_cvt_pk_bf16_f32 v76, v76, v77
M v[148:151], a[168:171], a[20:23], v[148:151]
v_exp_f32 v79, v79
M v[148:151], a[164:167], a[16:19], v[148:151]
buffer_load_dwordx4 v1, s[12:15], s43 offen offset:1024 sc1 lds
M v[152:155], a[164:167], a[32:35], 0
v_exp_f32 v92, v92
M v[152:155], a[168:171], a[36:39], v[152:155]
ds_read_b128 a[140:143], v5 offset:35840
ds_read_b128 a[144:147], v5 offset:44032
M v[152:155], a[172:175], a[40:43], v[152:155]
v_exp_f32 v93, v93
M v[152:155], a[176:179], a[44:47], v[152:155]
buffer_load_dwordx4 v1, s[12:15], s43 offen offset:2048 sc1 lds
M v[156:159], a[176:179], a[60:63], 0
v_exp_f32 v94, v94
M v[156:159], a[172:175], a[56:59], v[156:159]
v_cvt_pk_bf16_f32 v77, v78, v79
v_cvt_pk_bf16_f32 v78, v92, v93
M v[156:159], a[168:171], a[52:55], v[156:159]
v_exp_f32 v95, v95
M v[156:159], a[164:167], a[48:51], v[156:159]
buffer_load_dwordx4 v1, s[12:15], s43 offen offset:3072 sc1 lds
v_cvt_pk_bf16_f32 v79, v94, v95
s_waitcnt lgkmcnt(6)
M v[160:163], a[116:119], v[32:35], v[160:163]
v_exp_f32 v96, v96
M v[160:163], a[120:123], v[64:67], v[160:163]
ds_read_b128 a[148:151], v5 offset:36864
ds_read_b128 a[152:155], v5 offset:45056
M v[164:167], a[120:123], v[68:71], v[164:167]
v_exp_f32 v97, v97
M v[164:167], a[116:119], v[36:39], v[164:167]
v_cvt_pk_bf16_f32 v96, v96, v97
M v[168:171], a[116:119], v[40:43], v[168:171]
v_exp_f32 v98, v98
M v[168:171], a[120:123], v[72:75], v[168:171]
s_add_u32 s25, s25, 32768
s_cmp_eq_u32 s25, s27
M v[172:175], a[120:123], v[76:79], v[172:175]
v_exp_f32 v99, v99
M v[172:175], a[116:119], v[44:47], v[172:175]
v_cvt_pk_bf16_f32 v97, v98, v99
s_waitcnt lgkmcnt(6)
M a[96:99], a[112:115], v[32:35], a[96:99]
s_cselect_b32 s25, s28, s25
s_cselect_b32 s27, s56, s27
M a[96:99], a[112:115], v[64:67], a[96:99]
s_cselect_b32 s28, s57, s28
s_cselect_b32 s56, -1, s56
M v[176:179], a[124:127], v[32:35], v[176:179]
v_exp_f32 v112, v112
M v[176:179], a[128:131], v[64:67], v[176:179]
ds_read_b128 a[156:159], v5 offset:37888
ds_read_b128 a[160:163], v5 offset:46080
M v[180:183], a[128:131], v[68:71], v[180:183]
v_exp_f32 v113, v113
M v[180:183], a[124:127], v[36:39], v[180:183]
v_cvt_pk_bf16_f32 v98, v112, v113
M v[184:187], a[124:127], v[40:43], v[184:187]
v_exp_f32 v114, v114
M v[184:187], a[128:131], v[72:75], v[184:187]
s_add_u32 s26, s26, 32768
s_cmp_eq_u32 s26, s62
M v[188:191], a[128:131], v[76:79], v[188:191]
v_exp_f32 v115, v115
M v[188:191], a[124:127], v[44:47], v[188:191]
v_cvt_pk_bf16_f32 v99, v114, v115
s_waitcnt lgkmcnt(6)
M a[100:103], a[112:115], v[36:39], a[100:103]
s_cselect_b32 s26, s63, s26
s_cselect_b32 s62, s58, s62
M a[100:103], a[112:115], v[68:71], a[100:103]
s_cselect_b32 s63, s59, s63
s_cselect_b32 s58, -1, s58
M v[192:195], a[132:135], v[32:35], v[192:195]
v_exp_f32 v100, v100
M v[192:195], a[136:139], v[64:67], v[192:195]
ds_read_b128 a[164:167], v5 offset:38912
ds_read_b128 a[168:171], v5 offset:47104
M v[196:199], a[136:139], v[68:71], v[196:199]
v_exp_f32 v101, v101
M v[196:199], a[132:135], v[36:39], v[196:199]
v_cvt_pk_bf16_f32 v100, v100, v101
M v[200:203], a[132:135], v[40:43], v[200:203]
v_exp_f32 v102, v102
M v[200:203], a[136:139], v[72:75], v[200:203]
s_sub_u32 s33, s42, 1
s_cmp_le_u32 s33, 1
s_cselect_b32 s33, 0x4000, 0
v_add_u32 v2, s33, v2
M v[204:207], a[136:139], v[76:79], v[204:207]
v_exp_f32 v103, v103
M v[204:207], a[132:135], v[44:47], v[204:207]
v_cvt_pk_bf16_f32 v101, v102, v103
s_waitcnt lgkmcnt(6)
M a[104:107], a[112:115], v[40:43], a[104:107]
M a[104:107], a[112:115], v[72:75], a[104:107]
M v[208:211], a[140:143], v[32:35], v[208:211]
v_exp_f32 v116, v116
M v[208:211], a[144:147], v[64:67], v[208:211]
ds_read_b128 a[172:175], v5 offset:39936
ds_read_b128 a[176:179], v5 offset:48128
M v[212:215], a[144:147], v[68:71], v[212:215]
v_exp_f32 v117, v117
M v[212:215], a[140:143], v[36:39], v[212:215]
v_cvt_pk_bf16_f32 v102, v116, v117
M v[216:219], a[140:143], v[40:43], v[216:219]
v_exp_f32 v118, v118
M v[216:219], a[144:147], v[72:75], v[216:219]
M v[220:223], a[144:147], v[76:79], v[220:223]
v_exp_f32 v119, v119
M v[220:223], a[140:143], v[44:47], v[220:223]
v_cvt_pk_bf16_f32 v103, v118, v119
s_waitcnt lgkmcnt(6)
M a[108:111], a[112:115], v[44:47], a[108:111]
M a[108:111], a[112:115], v[76:79], a[108:111]
M v[224:227], a[148:151], v[32:35], v[224:227]
v_exp_f32 v104, v104
M v[224:227], a[152:155], v[64:67], v[224:227]
s_cmp_le_u32 s42, 1
s_cselect_b32 s33, 0x4000, 0
v_add_u32 v5, s33, v5
s_sub_u32 s42, s42, 1
M v[228:231], a[152:155], v[68:71], v[228:231]
v_exp_f32 v105, v105
M v[228:231], a[148:151], v[36:39], v[228:231]
v_cvt_pk_bf16_f32 v104, v104, v105
M v[232:235], a[148:151], v[40:43], v[232:235]
v_exp_f32 v106, v106
M v[232:235], a[152:155], v[72:75], v[232:235]
M v[236:239], a[152:155], v[76:79], v[236:239]
v_exp_f32 v107, v107
M v[236:239], a[148:151], v[44:47], v[236:239]
v_cvt_pk_bf16_f32 v105, v106, v107
s_waitcnt lgkmcnt(4)
M v[240:243], a[156:159], v[32:35], v[240:243]
v_exp_f32 v120, v120
M v[240:243], a[160:163], v[64:67], v[240:243]
M v[244:247], a[160:163], v[68:71], v[244:247]
v_exp_f32 v121, v121
M v[244:247], a[156:159], v[36:39], v[244:247]
v_cvt_pk_bf16_f32 v106, v120, v121
M v[248:251], a[156:159], v[40:43], v[248:251]
v_exp_f32 v122, v122
M v[248:251], a[160:163], v[72:75], v[248:251]
s_waitcnt vmcnt(0) lgkmcnt(0)
s_barrier
ds_read_b128 a[116:119], v3 offset:0
ds_read_b128 a[120:123], v3 offset:1024
M v[252:255], a[160:163], v[76:79], v[252:255]
v_exp_f32 v123, v123
M v[252:255], a[156:159], v[44:47], v[252:255]
v_cvt_pk_bf16_f32 v107, v122, v123
M a[64:67], a[164:167], v[32:35], a[64:67]
v_exp_f32 v108, v108
M a[64:67], a[168:171], v[64:67], a[64:67]
ds_read_b128 a[124:127], v3 offset:2048
ds_read_b128 a[128:131], v3 offset:3072
M a[68:71], a[168:171], v[68:71], a[68:71]
v_exp_f32 v109, v109
M a[68:71], a[164:167], v[36:39], a[68:71]
v_cvt_pk_bf16_f32 v108, v108, v109
M a[72:75], a[164:167], v[40:43], a[72:75]
v_exp_f32 v110, v110
M a[72:75], a[168:171], v[72:75], a[72:75]
ds_read_b128 a[132:135], v3 offset:4096
ds_read_b128 a[136:139], v3 offset:5120
M a[76:79], a[168:171], v[76:79], a[76:79]
v_exp_f32 v111, v111
M a[76:79], a[164:167], v[44:47], a[76:79]
v_cvt_pk_bf16_f32 v109, v110, v111
M a[80:83], a[172:175], v[32:35], a[80:83]
v_exp_f32 v124, v124
M a[80:83], a[176:179], v[64:67], a[80:83]
ds_read_b128 a[140:143], v3 offset:6144
ds_read_b128 a[144:147], v3 offset:7168
M a[84:87], a[176:179], v[68:71], a[84:87]
v_exp_f32 v125, v125
M a[84:87], a[172:175], v[36:39], a[84:87]
v_cvt_pk_bf16_f32 v110, v124, v125
M a[88:91], a[172:175], v[40:43], a[88:91]
v_exp_f32 v126, v126
M a[88:91], a[176:179], v[72:75], a[88:91]
M a[92:95], a[176:179], v[76:79], a[92:95]
v_exp_f32 v127, v127
M a[92:95], a[172:175], v[44:47], a[92:95]
v_cvt_pk_bf16_f32 v111, v126, v127
s_add_u32 m0, s29, 0
s_waitcnt lgkmcnt(4)
M v[32:35], a[116:119], a[0:3], 0
v_exp_f32 v128, v128
M v[32:35], a[120:123], a[4:7], v[32:35]
ds_read_b128 a[148:151], v3 offset:8192
ds_read_b128 a[152:155], v3 offset:9216
M v[32:35], a[124:127], a[8:11], v[32:35]
v_exp_f32 v129, v129
M v[32:35], a[128:131], a[12:15], v[32:35]
buffer_load_dwordx4 v1, s[12:15], s25 offen offset:0 sc1 lds
s_add_u32 s32, s25, 4096
M v[36:39], a[128:131], a[28:31], 0
v_exp_f32 v130, v130
M v[36:39], a[124:127], a[24:27], v[36:39]
v_cvt_pk_bf16_f32 v128, v128, v129
M v[36:39], a[120:123], a[20:23], v[36:39]
v_exp_f32 v131, v131
M v[36:39], a[116:119], a[16:19], v[36:39]
buffer_load_dwordx4 v1, s[12:15], s25 offen offset:1024 sc1 lds
M v[40:43], a[116:119], a[32:35], 0
v_exp_f32 v144, v144
M v[40:43], a[120:123], a[36:39], v[40:43]
ds_read_b128 a[156:159], v3 offset:10240
ds_read_b128 a[160:163], v3 offset:11264
M v[40:43], a[124:127], a[40:43], v[40:43]
v_exp_f32 v145, v145
M v[40:43], a[128:131], a[44:47], v[40:43]
buffer_load_dwordx4 v1, s[12:15], s25 offen offset:2048 sc1 lds
M v[44:47], a[128:131], a[60:63], 0
v_exp_f32 v146, v146
M v[44:47], a[124:127], a[56:59], v[44:47]
v_cvt_pk_bf16_f32 v129, v130, v131
v_cvt_pk_bf16_f32 v130, v144, v145
M v[44:47], a[120:123], a[52:55], v[44:47]
v_exp_f32 v147, v147
M v[44:47], a[116:119], a[48:51], v[44:47]
buffer_load_dwordx4 v1, s[12:15], s25 offen offset:3072 sc1 lds
s_add_u32 m0, s29, 4096
s_waitcnt lgkmcnt(4)
M v[48:51], a[132:135], a[0:3], 0
v_exp_f32 v132, v132
M v[48:51], a[136:139], a[4:7], v[48:51]
ds_read_b128 a[164:167], v3 offset:12288
ds_read_b128 a[168:171], v3 offset:13312
M v[48:51], a[140:143], a[8:11], v[48:51]
v_exp_f32 v133, v133
M v[48:51], a[144:147], a[12:15], v[48:51]
buffer_load_dwordx4 v1, s[12:15], s32 offen offset:0 sc1 lds
M v[52:55], a[144:147], a[28:31], 0
v_exp_f32 v134, v134
M v[52:55], a[140:143], a[24:27], v[52:55]
v_cvt_pk_bf16_f32 v131, v146, v147
v_cvt_pk_bf16_f32 v132, v132, v133
M v[52:55], a[136:139], a[20:23], v[52:55]
v_exp_f32 v135, v135
M v[52:55], a[132:135], a[16:19], v[52:55]
buffer_load_dwordx4 v1, s[12:15], s32 offen offset:1024 sc1 lds
M v[56:59], a[132:135], a[32:35], 0
v_exp_f32 v148, v148
M v[56:59], a[136:139], a[36:39], v[56:59]
ds_read_b128 a[172:175], v3 offset:14336
ds_read_b128 a[176:179], v3 offset:15360
M v[56:59], a[140:143], a[40:43], v[56:59]
v_exp_f32 v149, v149
M v[56:59], a[144:147], a[44:47], v[56:59]
buffer_load_dwordx4 v1, s[12:15], s32 offen offset:2048 sc1 lds
M v[60:63], a[144:147], a[60:63], 0
v_exp_f32 v150, v150
M v[60:63], a[140:143], a[56:59], v[60:63]
v_cvt_pk_bf16_f32 v133, v134, v135
v_cvt_pk_bf16_f32 v134, v148, v149
M v[60:63], a[136:139], a[52:55], v[60:63]
v_exp_f32 v151, v151
M v[60:63], a[132:135], a[48:51], v[60:63]
buffer_load_dwordx4 v1, s[12:15], s32 offen offset:3072 sc1 lds
s_add_u32 m0, s29, 32768
s_waitcnt lgkmcnt(4)
M v[64:67], a[148:151], a[0:3], 0
v_exp_f32 v136, v136
M v[64:67], a[152:155], a[4:7], v[64:67]
ds_read_b128 a[116:119], v6 offset:32768
ds_read_b128 a[120:123], v6 offset:40960
M v[64:67], a[156:159], a[8:11], v[64:67]
v_exp_f32 v137, v137
M v[64:67], a[160:163], a[12:15], v[64:67]
buffer_load_dwordx4 v1, s[12:15], s26 offen offset:0 sc1 lds
s_add_u32 s43, s26, 4096
M v[68:71], a[160:163], a[28:31], 0
v_exp_f32 v138, v138
M v[68:71], a[156:159], a[24:27], v[68:71]
v_cvt_pk_bf16_f32 v135, v150, v151
v_cvt_pk_bf16_f32 v136, v136, v137
M v[68:71], a[152:155], a[20:23], v[68:71]
v_exp_f32 v139, v139
M v[68:71], a[148:151], a[16:19], v[68:71]
buffer_load_dwordx4 v1, s[12:15], s26 offen offset:1024 sc1 lds
M v[72:75], a[148:151], a[32:35], 0
v_exp_f32 v152, v152
M v[72:75], a[152:155], a[36:39], v[72:75]
ds_read_b128 a[124:127], v6 offset:33792
ds_read_b128 a[128:131], v6 offset:41984
M v[72:75], a[156:159], a[40:43], v[72:75]
v_exp_f32 v153, v153
M v[72:75], a[160:163], a[44:47], v[72:75]
buffer_load_dwordx4 v1, s[12:15], s26 offen offset:2048 sc1 lds
M v[76:79], a[160:163], a[60:63], 0
v_exp_f32 v154, v154
M v[76:79], a[156:159], a[56:59], v[76:79]
v_cvt_pk_bf16_f32 v137, v138, v139
v_cvt_pk_bf16_f32 v138, v152, v153
M v[76:79], a[152:155], a[52:55], v[76:79]
v_exp_f32 v155, v155
M v[76:79], a[148:151], a[48:51], v[76:79]
buffer_load_dwordx4 v1, s[12:15], s26 offen offset:3072 sc1 lds
s_add_u32 m0, s29, 36864
s_waitcnt lgkmcnt(4)
M v[80:83], a[164:167], a[0:3], 0
v_exp_f32 v140, v140
M v[80:83], a[168:171], a[4:7], v[80:83]
ds_read_b128 a[132:135], v6 offset:34816
ds_read_b128 a[136:139], v6 offset:43008
M v[80:83], a[172:175], a[8:11], v[80:83]
v_exp_f32 v141, v141
M v[80:83], a[176:179], a[12:15], v[80:83]
buffer_load_dwordx4 v1, s[12:15], s43 offen offset:0 sc1 lds
M v[84:87], a[176:179], a[28:31], 0
v_exp_f32 v142, v142
M v[84:87], a[172:175], a[24:27], v[84:87]
v_cvt_pk_bf16_f32 v139, v154, v155
v_cvt_pk_bf16_f32 v140, v140, v141
M v[84:87], a[168:171], a[20:23], v[84:87]
v_exp_f32 v143, v143
M v[84:87], a[164:167], a[16:19], v[84:87]
buffer_load_dwordx4 v1, s[12:15], s43 offen offset:1024 sc1 lds
M v[88:91], a[164:167], a[32:35], 0
v_exp_f32 v156, v156
M v[88:91], a[168:171], a[36:39], v[88:91]
ds_read_b128 a[140:143], v6 offset:35840
ds_read_b128 a[144:147], v6 offset:44032
M v[88:91], a[172:175], a[40:43], v[88:91]
v_exp_f32 v157, v157
M v[88:91], a[176:179], a[44:47], v[88:91]
buffer_load_dwordx4 v1, s[12:15], s43 offen offset:2048 sc1 lds
M v[92:95], a[176:179], a[60:63], 0
v_exp_f32 v158, v158
M v[92:95], a[172:175], a[56:59], v[92:95]
v_cvt_pk_bf16_f32 v141, v142, v143
v_cvt_pk_bf16_f32 v142, v156, v157
M v[92:95], a[168:171], a[52:55], v[92:95]
v_exp_f32 v159, v159
M v[92:95], a[164:167], a[48:51], v[92:95]
buffer_load_dwordx4 v1, s[12:15], s43 offen offset:3072 sc1 lds
v_cvt_pk_bf16_f32 v143, v158, v159
s_waitcnt lgkmcnt(6)
M v[160:163], a[116:119], v[96:99], v[160:163]
v_exp_f32 v32, v32
M v[160:163], a[120:123], v[128:131], v[160:163]
ds_read_b128 a[148:151], v6 offset:36864
ds_read_b128 a[152:155], v6 offset:45056
M v[164:167], a[120:123], v[132:135], v[164:167]
v_exp_f32 v33, v33
M v[164:167], a[116:119], v[100:103], v[164:167]
v_cvt_pk_bf16_f32 v32, v32, v33
M v[168:171], a[116:119], v[104:107], v[168:171]
v_exp_f32 v34, v34
M v[168:171], a[120:123], v[136:139], v[168:171]
s_add_u32 s25, s25, 32768
s_cmp_eq_u32 s25, s27
M v[172:175], a[120:123], v[140:143], v[172:175]
v_exp_f32 v35, v35
M v[172:175], a[116:119], v[108:111], v[172:175]
v_cvt_pk_bf16_f32 v33, v34, v35
s_waitcnt lgkmcnt(6)
M a[96:99], a[112:115], v[96:99], a[96:99]
s_cselect_b32 s25, s28, s25
s_cselect_b32 s27, s56, s27
M a[96:99], a[112:115], v[128:131], a[96:99]
s_cselect_b32 s28, s57, s28
s_cselect_b32 s56, -1, s56
M v[176:179], a[124:127], v[96:99], v[176:179]
v_exp_f32 v48, v48
M v[176:179], a[128:131], v[128:131], v[176:179]
ds_read_b128 a[156:159], v6 offset:37888
ds_read_b128 a[160:163], v6 offset:46080
M v[180:183], a[128:131], v[132:135], v[180:183]
v_exp_f32 v49, v49
M v[180:183], a[124:127], v[100:103], v[180:183]
v_cvt_pk_bf16_f32 v34, v48, v49
M v[184:187], a[124:127], v[104:107], v[184:187]
v_exp_f32 v50, v50
M v[184:187], a[128:131], v[136:139], v[184:187]
s_add_u32 s26, s26, 32768
s_cmp_eq_u32 s26, s62
M v[188:191], a[128:131], v[140:143], v[188:191]
v_exp_f32 v51, v51
M v[188:191], a[124:127], v[108:111], v[188:191]
v_cvt_pk_bf16_f32 v35, v50, v51
s_waitcnt lgkmcnt(6)
M a[100:103], a[112:115], v[100:103], a[100:103]
s_cselect_b32 s26, s63, s26
s_cselect_b32 s62, s58, s62
M a[100:103], a[112:115], v[132:135], a[100:103]
s_cselect_b32 s63, s59, s63
s_cselect_b32 s58, -1, s58
M v[192:195], a[132:135], v[96:99], v[192:195]
v_exp_f32 v36, v36
M v[192:195], a[136:139], v[128:131], v[192:195]
ds_read_b128 a[164:167], v6 offset:38912
ds_read_b128 a[168:171], v6 offset:47104
M v[196:199], a[136:139], v[132:135], v[196:199]
v_exp_f32 v37, v37
M v[196:199], a[132:135], v[100:103], v[196:199]
v_cvt_pk_bf16_f32 v36, v36, v37
M v[200:203], a[132:135], v[104:107], v[200:203]
v_exp_f32 v38, v38
M v[200:203], a[136:139], v[136:139], v[200:203]
s_sub_u32 s33, s42, 1
s_cmp_le_u32 s33, 1
s_cselect_b32 s33, 0x4000, 0
v_add_u32 v3, s33, v3
M v[204:207], a[136:139], v[140:143], v[204:207]
v_exp_f32 v39, v39
M v[204:207], a[132:135], v[108:111], v[204:207]
v_cvt_pk_bf16_f32 v37, v38, v39
s_waitcnt lgkmcnt(6)
M a[104:107], a[112:115], v[104:107], a[104:107]
M a[104:107], a[112:115], v[136:139], a[104:107]
M v[208:211], a[140:143], v[96:99], v[208:211]
v_exp_f32 v52, v52
M v[208:211], a[144:147], v[128:131], v[208:211]
ds_read_b128 a[172:175], v6 offset:39936
ds_read_b128 a[176:179], v6 offset:48128
M v[212:215], a[144:147], v[132:135], v[212:215]
v_exp_f32 v53, v53
M v[212:215], a[140:143], v[100:103], v[212:215]
v_cvt_pk_bf16_f32 v38, v52, v53
M v[216:219], a[140:143], v[104:107], v[216:219]
v_exp_f32 v54, v54
M v[216:219], a[144:147], v[136:139], v[216:219]
M v[220:223], a[144:147], v[140:143], v[220:223]
v_exp_f32 v55, v55
M v[220:223], a[140:143], v[108:111], v[220:223]
v_cvt_pk_bf16_f32 v39, v54, v55
s_waitcnt lgkmcnt(6)
M a[108:111], a[112:115], v[108:111], a[108:111]
M a[108:111], a[112:115], v[140:143], a[108:111]
M v[224:227], a[148:151], v[96:99], v[224:227]
v_exp_f32 v40, v40
M v[224:227], a[152:155], v[128:131], v[224:227]
s_cmp_le_u32 s42, 1
s_cselect_b32 s33, 0x4000, 0
v_add_u32 v6, s33, v6
s_sub_u32 s42, s42, 1
M v[228:231], a[152:155], v[132:135], v[228:231]
v_exp_f32 v41, v41
M v[228:231], a[148:151], v[100:103], v[228:231]
v_cvt_pk_bf16_f32 v40, v40, v41
M v[232:235], a[148:151], v[104:107], v[232:235]
v_exp_f32 v42, v42
M v[232:235], a[152:155], v[136:139], v[232:235]
M v[236:239], a[152:155], v[140:143], v[236:239]
v_exp_f32 v43, v43
M v[236:239], a[148:151], v[108:111], v[236:239]
v_cvt_pk_bf16_f32 v41, v42, v43
s_waitcnt lgkmcnt(4)
M v[240:243], a[156:159], v[96:99], v[240:243]
v_exp_f32 v56, v56
M v[240:243], a[160:163], v[128:131], v[240:243]
M v[244:247], a[160:163], v[132:135], v[244:247]
v_exp_f32 v57, v57
M v[244:247], a[156:159], v[100:103], v[244:247]
v_cvt_pk_bf16_f32 v42, v56, v57
M v[248:251], a[156:159], v[104:107], v[248:251]
v_exp_f32 v58, v58
M v[248:251], a[160:163], v[136:139], v[248:251]
s_waitcnt vmcnt(0) lgkmcnt(0)
s_barrier
ds_read_b128 a[116:119], v2 offset:0
ds_read_b128 a[120:123], v2 offset:1024
M v[252:255], a[160:163], v[140:143], v[252:255]
v_exp_f32 v59, v59
M v[252:255], a[156:159], v[108:111], v[252:255]
v_cvt_pk_bf16_f32 v43, v58, v59
M a[64:67], a[164:167], v[96:99], a[64:67]
v_exp_f32 v44, v44
M a[64:67], a[168:171], v[128:131], a[64:67]
ds_read_b128 a[124:127], v2 offset:2048
ds_read_b128 a[128:131], v2 offset:3072
M a[68:71], a[168:171], v[132:135], a[68:71]
v_exp_f32 v45, v45
M a[68:71], a[164:167], v[100:103], a[68:71]
v_cvt_pk_bf16_f32 v44, v44, v45
M a[72:75], a[164:167], v[104:107], a[72:75]
v_exp_f32 v46, v46
M a[72:75], a[168:171], v[136:139], a[72:75]
ds_read_b128 a[132:135], v2 offset:4096
ds_read_b128 a[136:139], v2 offset:5120
M a[76:79], a[168:171], v[140:143], a[76:79]
v_exp_f32 v47, v47
M a[76:79], a[164:167], v[108:111], a[76:79]
v_cvt_pk_bf16_f32 v45, v46, v47
M a[80:83], a[172:175], v[96:99], a[80:83]
v_exp_f32 v60, v60
M a[80:83], a[176:179], v[128:131], a[80:83]
ds_read_b128 a[140:143], v2 offset:6144
ds_read_b128 a[144:147], v2 offset:7168
M a[84:87], a[176:179], v[132:135], a[84:87]
v_exp_f32 v61, v61
M a[84:87], a[172:175], v[100:103], a[84:87]
v_cvt_pk_bf16_f32 v46, v60, v61
M a[88:91], a[172:175], v[104:107], a[88:91]
v_exp_f32 v62, v62
M a[88:91], a[176:179], v[136:139], a[88:91]
M a[92:95], a[176:179], v[140:143], a[92:95]
v_exp_f32 v63, v63
M a[92:95], a[172:175], v[108:111], a[92:95]
v_cvt_pk_bf16_f32 v47, v62, v63
s_sub_u32 s30, s30, 1
s_cmp_lg_u32 s30, 0
s_cbranch_scc1 Lk2_l3
s_lshl_b32 s33, s23, 6
s_add_i32 s33, s33, 0
s_cmp_gt_i32 s33, 0
s_cselect_b32 s34, 0, 0xf149f2ca
s_cmp_lt_i32 s33, 0
s_cselect_b32 s33, 0xf149f2ca, 0
v_mov_b32 v20, s34
v_mov_b32 v21, s34
v_mov_b32 v22, s34
v_mov_b32 v23, s34
v_mov_b32 v28, s33
v_mov_b32 v29, s33
v_mov_b32 v30, s33
v_mov_b32 v31, s33
v_med3_f32 v24, v16, v20, v28
v_med3_f32 v25, v17, v20, v28
v_med3_f32 v26, v18, v20, v28
v_med3_f32 v27, v19, v20, v28
s_add_u32 m0, s29, 65536
s_waitcnt lgkmcnt(4)
M v[96:99], a[116:119], a[0:3], v[24:27]
v_exp_f32 v64, v64
M v[96:99], a[120:123], a[4:7], v[96:99]
ds_read_b128 a[148:151], v2 offset:8192
ds_read_b128 a[152:155], v2 offset:9216
M v[96:99], a[124:127], a[8:11], v[96:99]
v_exp_f32 v65, v65
M v[96:99], a[128:131], a[12:15], v[96:99]
buffer_load_dwordx4 v1, s[12:15], s25 offen offset:0 sc1 lds
s_add_u32 s32, s25, 4096
M v[100:103], a[128:131], a[28:31], v[28:31]
v_exp_f32 v66, v66
M v[100:103], a[124:127], a[24:27], v[100:103]
v_cvt_pk_bf16_f32 v64, v64, v65
M v[100:103], a[120:123], a[20:23], v[100:103]
v_exp_f32 v67, v67
M v[100:103], a[116:119], a[16:19], v[100:103]
buffer_load_dwordx4 v1, s[12:15], s25 offen offset:1024 sc1 lds
M v[104:107], a[116:119], a[32:35], v[28:31]
v_exp_f32 v80, v80
M v[104:107], a[120:123], a[36:39], v[104:107]
ds_read_b128 a[156:159], v2 offset:10240
ds_read_b128 a[160:163], v2 offset:11264
M v[104:107], a[124:127], a[40:43], v[104:107]
v_exp_f32 v81, v81
M v[104:107], a[128:131], a[44:47], v[104:107]
buffer_load_dwordx4 v1, s[12:15], s25 offen offset:2048 sc1 lds
M v[108:111], a[128:131], a[60:63], v[28:31]
v_exp_f32 v82, v82
M v[108:111], a[124:127], a[56:59], v[108:111]
v_cvt_pk_bf16_f32 v65, v66, v67
v_cvt_pk_bf16_f32 v66, v80, v81
M v[108:111], a[120:123], a[52:55], v[108:111]
v_exp_f32 v83, v83
M v[108:111], a[116:119], a[48:51], v[108:111]
buffer_load_dwordx4 v1, s[12:15], s25 offen offset:3072 sc1 lds
s_add_u32 m0, s29, 69632
s_waitcnt lgkmcnt(4)
M v[112:115], a[132:135], a[0:3], v[20:23]
v_exp_f32 v68, v68
M v[112:115], a[136:139], a[4:7], v[112:115]
ds_read_b128 a[164:167], v2 offset:12288
ds_read_b128 a[168:171], v2 offset:13312
M v[112:115], a[140:143], a[8:11], v[112:115]
v_exp_f32 v69, v69
M v[112:115], a[144:147], a[12:15], v[112:115]
buffer_load_dwordx4 v1, s[12:15], s32 offen offset:0 sc1 lds
M v[116:119], a[144:147], a[28:31], v[24:27]
v_exp_f32 v70, v70
M v[116:119], a[140:143], a[24:27], v[116:119]
v_cvt_pk_bf16_f32 v67, v82, v83
v_cvt_pk_bf16_f32 v68, v68, v69
M v[116:119], a[136:139], a[20:23], v[116:119]
v_exp_f32 v71, v71
M v[116:119], a[132:135], a[16:19], v[116:119]
buffer_load_dwordx4 v1, s[12:15], s32 offen offset:1024 sc1 lds
M v[120:123], a[132:135], a[32:35], v[28:31]
v_exp_f32 v84, v84
M v[120:123], a[136:139], a[36:39], v[120:123]
ds_read_b128 a[172:175], v2 offset:14336
ds_read_b128 a[176:179], v2 offset:15360
M v[120:123], a[140:143], a[40:43], v[120:123]
v_exp_f32 v85, v85
M v[120:123], a[144:147], a[44:47], v[120:123]
buffer_load_dwordx4 v1, s[12:15], s32 offen offset:2048 sc1 lds
M v[124:127], a[144:147], a[60:63], v[28:31]
v_exp_f32 v86, v86
M v[124:127], a[140:143], a[56:59], v[124:127]
v_cvt_pk_bf16_f32 v69, v70, v71
v_cvt_pk_bf16_f32 v70, v84, v85
M v[124:127], a[136:139], a[52:55], v[124:127]
v_exp_f32 v87, v87
M v[124:127], a[132:135], a[48:51], v[124:127]
buffer_load_dwordx4 v1, s[12:15], s32 offen offset:3072 sc1 lds
s_add_u32 m0, s29, 98304
s_waitcnt lgkmcnt(4)
M v[128:131], a[148:151], a[0:3], v[20:23]
v_exp_f32 v72, v72
M v[128:131], a[152:155], a[4:7], v[128:131]
ds_read_b128 a[116:119], v5 offset:32768
ds_read_b128 a[120:123], v5 offset:40960
M v[128:131], a[156:159], a[8:11], v[128:131]
v_exp_f32 v73, v73
M v[128:131], a[160:163], a[12:15], v[128:131]
buffer_load_dwordx4 v1, s[12:15], s26 offen offset:0 sc1 lds
s_add_u32 s43, s26, 4096
M v[132:135], a[160:163], a[28:31], v[20:23]
v_exp_f32 v74, v74
M v[132:135], a[156:159], a[24:27], v[132:135]
v_cvt_pk_bf16_f32 v71, v86, v87
v_cvt_pk_bf16_f32 v72, v72, v73
M v[132:135], a[152:155], a[20:23], v[132:135]
v_exp_f32 v75, v75
M v[132:135], a[148:151], a[16:19], v[132:135]
buffer_load_dwordx4 v1, s[12:15], s26 offen offset:1024 sc1 lds
M v[136:139], a[148:151], a[32:35], v[24:27]
v_exp_f32 v88, v88
M v[136:139], a[152:155], a[36:39], v[136:139]
ds_read_b128 a[124:127], v5 offset:33792
ds_read_b128 a[128:131], v5 offset:41984
M v[136:139], a[156:159], a[40:43], v[136:139]
v_exp_f32 v89, v89
M v[136:139], a[160:163], a[44:47], v[136:139]
buffer_load_dwordx4 v1, s[12:15], s26 offen offset:2048 sc1 lds
M v[140:143], a[160:163], a[60:63], v[28:31]
v_exp_f32 v90, v90
M v[140:143], a[156:159], a[56:59], v[140:143]
v_cvt_pk_bf16_f32 v73, v74, v75
v_cvt_pk_bf16_f32 v74, v88, v89
M v[140:143], a[152:155], a[52:55], v[140:143]
v_exp_f32 v91, v91
M v[140:143], a[148:151], a[48:51], v[140:143]
buffer_load_dwordx4 v1, s[12:15], s26 offen offset:3072 sc1 lds
s_add_u32 m0, s29, 102400
s_waitcnt lgkmcnt(4)
M v[144:147], a[164:167], a[0:3], v[20:23]
v_exp_f32 v76, v76
M v[144:147], a[168:171], a[4:7], v[144:147]
ds_read_b128 a[132:135], v5 offset:34816
ds_read_b128 a[136:139], v5 offset:43008
M v[144:147], a[172:175], a[8:11], v[144:147]
v_exp_f32 v77, v77
M v[144:147], a[176:179], a[12:15], v[144:147]
buffer_load_dwordx4 v1, s[12:15], s43 offen offset:0 sc1 lds
M v[148:151], a[176:179], a[28:31], v[20:23]
v_exp_f32 v78, v78
M v[148:151], a[172:175], a[24:27], v[148:151]
v_cvt_pk_bf16_f32 v75, v90, v91
v_cvt_pk_bf16_f32 v76, v76, v77
M v[148:151], a[168:171], a[20:23], v[148:151]
v_exp_f32 v79, v79
M v[148:151], a[164:167], a[16:19], v[148:151]
buffer_load_dwordx4 v1, s[12:15], s43 offen offset:1024 sc1 lds
M v[152:155], a[164:167], a[32:35], v[20:23]
v_exp_f32 v92, v92
M v[152:155], a[168:171], a[36:39], v[152:155]
ds_read_b128 a[140:143], v5 offset:35840
ds_read_b128 a[144:147], v5 offset:44032
M v[152:155], a[172:175], a[40:43], v[152:155]
v_exp_f32 v93, v93
M v[152:155], a[176:179], a[44:47], v[152:155]
buffer_load_dwordx4 v1, s[12:15], s43 offen offset:2048 sc1 lds
M v[156:159], a[176:179], a[60:63], v[24:27]
v_exp_f32 v94, v94
M v[156:159], a[172:175], a[56:59], v[156:159]
v_cvt_pk_bf16_f32 v77, v78, v79
v_cvt_pk_bf16_f32 v78, v92, v93
M v[156:159], a[168:171], a[52:55], v[156:159]
v_exp_f32 v95, v95
M v[156:159], a[164:167], a[48:51], v[156:159]
buffer_load_dwordx4 v1, s[12:15], s43 offen offset:3072 sc1 lds
v_cvt_pk_bf16_f32 v79, v94, v95
s_waitcnt lgkmcnt(6)
M v[160:163], a[116:119], v[32:35], v[160:163]
v_exp_f32 v96, v96
M v[160:163], a[120:123], v[64:67], v[160:163]
ds_read_b128 a[148:151], v5 offset:36864
ds_read_b128 a[152:155], v5 offset:45056
M v[164:167], a[120:123], v[68:71], v[164:167]
v_exp_f32 v97, v97
M v[164:167], a[116:119], v[36:39], v[164:167]
v_cvt_pk_bf16_f32 v96, v96, v97
M v[168:171], a[116:119], v[40:43], v[168:171]
v_exp_f32 v98, v98
M v[168:171], a[120:123], v[72:75], v[168:171]
s_add_u32 s25, s25, 32768
s_cmp_eq_u32 s25, s27
M v[172:175], a[120:123], v[76:79], v[172:175]
v_exp_f32 v99, v99
M v[172:175], a[116:119], v[44:47], v[172:175]
v_cvt_pk_bf16_f32 v97, v98, v99
s_waitcnt lgkmcnt(6)
M a[96:99], a[112:115], v[32:35], a[96:99]
s_cselect_b32 s25, s28, s25
s_cselect_b32 s27, s56, s27
M a[96:99], a[112:115], v[64:67], a[96:99]
s_cselect_b32 s28, s57, s28
s_cselect_b32 s56, -1, s56
M v[176:179], a[124:127], v[32:35], v[176:179]
v_exp_f32 v112, v112
M v[176:179], a[128:131], v[64:67], v[176:179]
ds_read_b128 a[156:159], v5 offset:37888
ds_read_b128 a[160:163], v5 offset:46080
M v[180:183], a[128:131], v[68:71], v[180:183]
v_exp_f32 v113, v113
M v[180:183], a[124:127], v[36:39], v[180:183]
v_cvt_pk_bf16_f32 v98, v112, v113
M v[184:187], a[124:127], v[40:43], v[184:187]
v_exp_f32 v114, v114
M v[184:187], a[128:131], v[72:75], v[184:187]
s_add_u32 s26, s26, 32768
s_cmp_eq_u32 s26, s62
M v[188:191], a[128:131], v[76:79], v[188:191]
v_exp_f32 v115, v115
M v[188:191], a[124:127], v[44:47], v[188:191]
v_cvt_pk_bf16_f32 v99, v114, v115
s_waitcnt lgkmcnt(6)
M a[100:103], a[112:115], v[36:39], a[100:103]
s_cselect_b32 s26, s63, s26
s_cselect_b32 s62, s58, s62
M a[100:103], a[112:115], v[68:71], a[100:103]
s_cselect_b32 s63, s59, s63
s_cselect_b32 s58, -1, s58
M v[192:195], a[132:135], v[32:35], v[192:195]
v_exp_f32 v100, v100
M v[192:195], a[136:139], v[64:67], v[192:195]
ds_read_b128 a[164:167], v5 offset:38912
ds_read_b128 a[168:171], v5 offset:47104
M v[196:199], a[136:139], v[68:71], v[196:199]
v_exp_f32 v101, v101
M v[196:199], a[132:135], v[36:39], v[196:199]
v_cvt_pk_bf16_f32 v100, v100, v101
M v[200:203], a[132:135], v[40:43], v[200:203]
v_exp_f32 v102, v102
M v[200:203], a[136:139], v[72:75], v[200:203]
s_sub_u32 s33, s42, 1
s_cmp_le_u32 s33, 1
s_cselect_b32 s33, 0x4000, 0
v_add_u32 v2, s33, v2
M v[204:207], a[136:139], v[76:79], v[204:207]
v_exp_f32 v103, v103
M v[204:207], a[132:135], v[44:47], v[204:207]
v_cvt_pk_bf16_f32 v101, v102, v103
s_waitcnt lgkmcnt(6)
M a[104:107], a[112:115], v[40:43], a[104:107]
M a[104:107], a[112:115], v[72:75], a[104:107]
M v[208:211], a[140:143], v[32:35], v[208:211]
v_exp_f32 v116, v116
M v[208:211], a[144:147], v[64:67], v[208:211]
ds_read_b128 a[172:175], v5 offset:39936
ds_read_b128 a[176:179], v5 offset:48128
M v[212:215], a[144:147], v[68:71], v[212:215]
v_exp_f32 v117, v117
M v[212:215], a[140:143], v[36:39], v[212:215]
v_cvt_pk_bf16_f32 v102, v116, v117
M v[216:219], a[140:143], v[40:43], v[216:219]
v_exp_f32 v118, v118
M v[216:219], a[144:147], v[72:75], v[216:219]
M v[220:223], a[144:147], v[76:79], v[220:223]
v_exp_f32 v119, v119
M v[220:223], a[140:143], v[44:47], v[220:223]
v_cvt_pk_bf16_f32 v103, v118, v119
s_waitcnt lgkmcnt(6)
M a[108:111], a[112:115], v[44:47], a[108:111]
M a[108:111], a[112:115], v[76:79], a[108:111]
M v[224:227], a[148:151], v[32:35], v[224:227]
v_exp_f32 v104, v104
M v[224:227], a[152:155], v[64:67], v[224:227]
s_cmp_le_u32 s42, 1
s_cselect_b32 s33, 0x4000, 0
v_add_u32 v5, s33, v5
s_sub_u32 s42, s42, 1
M v[228:231], a[152:155], v[68:71], v[228:231]
v_exp_f32 v105, v105
M v[228:231], a[148:151], v[36:39], v[228:231]
v_cvt_pk_bf16_f32 v104, v104, v105
M v[232:235], a[148:151], v[40:43], v[232:235]
v_exp_f32 v106, v106
M v[232:235], a[152:155], v[72:75], v[232:235]
M v[236:239], a[152:155], v[76:79], v[236:239]
v_exp_f32 v107, v107
M v[236:239], a[148:151], v[44:47], v[236:239]
v_cvt_pk_bf16_f32 v105, v106, v107
s_waitcnt lgkmcnt(4)
M v[240:243], a[156:159], v[32:35], v[240:243]
v_exp_f32 v120, v120
M v[240:243], a[160:163], v[64:67], v[240:243]
M v[244:247], a[160:163], v[68:71], v[244:247]
v_exp_f32 v121, v121
M v[244:247], a[156:159], v[36:39], v[244:247]
v_cvt_pk_bf16_f32 v106, v120, v121
M v[248:251], a[156:159], v[40:43], v[248:251]
v_exp_f32 v122, v122
M v[248:251], a[160:163], v[72:75], v[248:251]
s_waitcnt vmcnt(0) lgkmcnt(0)
s_barrier
ds_read_b128 a[116:119], v3 offset:0
ds_read_b128 a[120:123], v3 offset:1024
M v[252:255], a[160:163], v[76:79], v[252:255]
v_exp_f32 v123, v123
M v[252:255], a[156:159], v[44:47], v[252:255]
v_cvt_pk_bf16_f32 v107, v122, v123
M a[64:67], a[164:167], v[32:35], a[64:67]
v_exp_f32 v108, v108
M a[64:67], a[168:171], v[64:67], a[64:67]
ds_read_b128 a[124:127], v3 offset:2048
ds_read_b128 a[128:131], v3 offset:3072
M a[68:71], a[168:171], v[68:71], a[68:71]
v_exp_f32 v109, v109
M a[68:71], a[164:167], v[36:39], a[68:71]
v_cvt_pk_bf16_f32 v108, v108, v109
M a[72:75], a[164:167], v[40:43], a[72:75]
v_exp_f32 v110, v110
M a[72:75], a[168:171], v[72:75], a[72:75]
ds_read_b128 a[132:135], v3 offset:4096
ds_read_b128 a[136:139], v3 offset:5120
M a[76:79], a[168:171], v[76:79], a[76:79]
v_exp_f32 v111, v111
M a[76:79], a[164:167], v[44:47], a[76:79]
v_cvt_pk_bf16_f32 v109, v110, v111
M a[80:83], a[172:175], v[32:35], a[80:83]
v_exp_f32 v124, v124
M a[80:83], a[176:179], v[64:67], a[80:83]
ds_read_b128 a[140:143], v3 offset:6144
ds_read_b128 a[144:147], v3 offset:7168
M a[84:87], a[176:179], v[68:71], a[84:87]
v_exp_f32 v125, v125
M a[84:87], a[172:175], v[36:39], a[84:87]
v_cvt_pk_bf16_f32 v110, v124, v125
M a[88:91], a[172:175], v[40:43], a[88:91]
v_exp_f32 v126, v126
M a[88:91], a[176:179], v[72:75], a[88:91]
M a[92:95], a[176:179], v[76:79], a[92:95]
v_exp_f32 v127, v127
M a[92:95], a[172:175], v[44:47], a[92:95]
v_cvt_pk_bf16_f32 v111, v126, v127
s_lshl_b32 s33, s23, 6
s_add_i32 s33, s33, -64
s_cmp_gt_i32 s33, 0
s_cselect_b32 s34, 0, 0xf149f2ca
s_cmp_lt_i32 s33, 0
s_cselect_b32 s33, 0xf149f2ca, 0
v_mov_b32 v20, s34
v_mov_b32 v21, s34
v_mov_b32 v22, s34
v_mov_b32 v23, s34
v_mov_b32 v28, s33
v_mov_b32 v29, s33
v_mov_b32 v30, s33
v_mov_b32 v31, s33
v_med3_f32 v24, v16, v20, v28
v_med3_f32 v25, v17, v20, v28
v_med3_f32 v26, v18, v20, v28
v_med3_f32 v27, v19, v20, v28
s_add_u32 m0, s29, 0
s_waitcnt lgkmcnt(4)
M v[32:35], a[116:119], a[0:3], v[24:27]
v_exp_f32 v128, v128
M v[32:35], a[120:123], a[4:7], v[32:35]
ds_read_b128 a[148:151], v3 offset:8192
ds_read_b128 a[152:155], v3 offset:9216
M v[32:35], a[124:127], a[8:11], v[32:35]
v_exp_f32 v129, v129
M v[32:35], a[128:131], a[12:15], v[32:35]
buffer_load_dwordx4 v1, s[12:15], s25 offen offset:0 sc1 lds
s_add_u32 s32, s25, 4096
M v[36:39], a[128:131], a[28:31], v[28:31]
v_exp_f32 v130, v130
M v[36:39], a[124:127], a[24:27], v[36:39]
v_cvt_pk_bf16_f32 v128, v128, v129
M v[36:39], a[120:123], a[20:23], v[36:39]
v_exp_f32 v131, v131
M v[36:39], a[116:119], a[16:19], v[36:39]
buffer_load_dwordx4 v1, s[12:15], s25 offen offset:1024 sc1 lds
M v[40:43], a[116:119], a[32:35], v[28:31]
v_exp_f32 v144, v144
M v[40:43], a[120:123], a[36:39], v[40:43]
ds_read_b128 a[156:159], v3 offset:10240
ds_read_b128 a[160:163], v3 offset:11264
M v[40:43], a[124:127], a[40:43], v[40:43]
v_exp_f32 v145, v145
M v[40:43], a[128:131], a[44:47], v[40:43]
buffer_load_dwordx4 v1, s[12:15], s25 offen offset:2048 sc1 lds
M v[44:47], a[128:131], a[60:63], v[28:31]
v_exp_f32 v146, v146
M v[44:47], a[124:127], a[56:59], v[44:47]
v_cvt_pk_bf16_f32 v129, v130, v131
v_cvt_pk_bf16_f32 v130, v144, v145
M v[44:47], a[120:123], a[52:55], v[44:47]
v_exp_f32 v147, v147
M v[44:47], a[116:119], a[48:51], v[44:47]
buffer_load_dwordx4 v1, s[12:15], s25 offen offset:3072 sc1 lds
s_add_u32 m0, s29, 4096
s_waitcnt lgkmcnt(4)
M v[48:51], a[132:135], a[0:3], v[20:23]
v_exp_f32 v132, v132
M v[48:51], a[136:139], a[4:7], v[48:51]
ds_read_b128 a[164:167], v3 offset:12288
ds_read_b128 a[168:171], v3 offset:13312
M v[48:51], a[140:143], a[8:11], v[48:51]
v_exp_f32 v133, v133
M v[48:51], a[144:147], a[12:15], v[48:51]
buffer_load_dwordx4 v1, s[12:15], s32 offen offset:0 sc1 lds
M v[52:55], a[144:147], a[28:31], v[24:27]
v_exp_f32 v134, v134
M v[52:55], a[140:143], a[24:27], v[52:55]
v_cvt_pk_bf16_f32 v131, v146, v147
v_cvt_pk_bf16_f32 v132, v132, v133
M v[52:55], a[136:139], a[20:23], v[52:55]
v_exp_f32 v135, v135
M v[52:55], a[132:135], a[16:19], v[52:55]
buffer_load_dwordx4 v1, s[12:15], s32 offen offset:1024 sc1 lds
M v[56:59], a[132:135], a[32:35], v[28:31]
v_exp_f32 v148, v148
M v[56:59], a[136:139], a[36:39], v[56:59]
ds_read_b128 a[172:175], v3 offset:14336
ds_read_b128 a[176:179], v3 offset:15360
M v[56:59], a[140:143], a[40:43], v[56:59]
v_exp_f32 v149, v149
M v[56:59], a[144:147], a[44:47], v[56:59]
buffer_load_dwordx4 v1, s[12:15], s32 offen offset:2048 sc1 lds
M v[60:63], a[144:147], a[60:63], v[28:31]
v_exp_f32 v150, v150
M v[60:63], a[140:143], a[56:59], v[60:63]
v_cvt_pk_bf16_f32 v133, v134, v135
v_cvt_pk_bf16_f32 v134, v148, v149
M v[60:63], a[136:139], a[52:55], v[60:63]
v_exp_f32 v151, v151
M v[60:63], a[132:135], a[48:51], v[60:63]
buffer_load_dwordx4 v1, s[12:15], s32 offen offset:3072 sc1 lds
s_add_u32 m0, s29, 32768
s_waitcnt lgkmcnt(4)
M v[64:67], a[148:151], a[0:3], v[20:23]
v_exp_f32 v136, v136
M v[64:67], a[152:155], a[4:7], v[64:67]
ds_read_b128 a[116:119], v6 offset:32768
ds_read_b128 a[120:123], v6 offset:40960
M v[64:67], a[156:159], a[8:11], v[64:67]
v_exp_f32 v137, v137
M v[64:67], a[160:163], a[12:15], v[64:67]
buffer_load_dwordx4 v1, s[12:15], s26 offen offset:0 sc1 lds
s_add_u32 s43, s26, 4096
M v[68:71], a[160:163], a[28:31], v[20:23]
v_exp_f32 v138, v138
M v[68:71], a[156:159], a[24:27], v[68:71]
v_cvt_pk_bf16_f32 v135, v150, v151
v_cvt_pk_bf16_f32 v136, v136, v137
M v[68:71], a[152:155], a[20:23], v[68:71]
v_exp_f32 v139, v139
M v[68:71], a[148:151], a[16:19], v[68:71]
buffer_load_dwordx4 v1, s[12:15], s26 offen offset:1024 sc1 lds
M v[72:75], a[148:151], a[32:35], v[24:27]
v_exp_f32 v152, v152
M v[72:75], a[152:155], a[36:39], v[72:75]
ds_read_b128 a[124:127], v6 offset:33792
ds_read_b128 a[128:131], v6 offset:41984
M v[72:75], a[156:159], a[40:43], v[72:75]
v_exp_f32 v153, v153
M v[72:75], a[160:163], a[44:47], v[72:75]
buffer_load_dwordx4 v1, s[12:15], s26 offen offset:2048 sc1 lds
M v[76:79], a[160:163], a[60:63], v[28:31]
v_exp_f32 v154, v154
M v[76:79], a[156:159], a[56:59], v[76:79]
v_cvt_pk_bf16_f32 v137, v138, v139
v_cvt_pk_bf16_f32 v138, v152, v153
M v[76:79], a[152:155], a[52:55], v[76:79]
v_exp_f32 v155, v155
M v[76:79], a[148:151], a[48:51], v[76:79]
buffer_load_dwordx4 v1, s[12:15], s26 offen offset:3072 sc1 lds
s_add_u32 m0, s29, 36864
s_waitcnt lgkmcnt(4)
M v[80:83], a[164:167], a[0:3], v[20:23]
v_exp_f32 v140, v140
M v[80:83], a[168:171], a[4:7], v[80:83]
ds_read_b128 a[132:135], v6 offset:34816
ds_read_b128 a[136:139], v6 offset:43008
M v[80:83], a[172:175], a[8:11], v[80:83]
v_exp_f32 v141, v141
M v[80:83], a[176:179], a[12:15], v[80:83]
buffer_load_dwordx4 v1, s[12:15], s43 offen offset:0 sc1 lds
M v[84:87], a[176:179], a[28:31], v[20:23]
v_exp_f32 v142, v142
M v[84:87], a[172:175], a[24:27], v[84:87]
v_cvt_pk_bf16_f32 v139, v154, v155
v_cvt_pk_bf16_f32 v140, v140, v141
M v[84:87], a[168:171], a[20:23], v[84:87]
v_exp_f32 v143, v143
M v[84:87], a[164:167], a[16:19], v[84:87]
buffer_load_dwordx4 v1, s[12:15], s43 offen offset:1024 sc1 lds
M v[88:91], a[164:167], a[32:35], v[20:23]
v_exp_f32 v156, v156
M v[88:91], a[168:171], a[36:39], v[88:91]
ds_read_b128 a[140:143], v6 offset:35840
ds_read_b128 a[144:147], v6 offset:44032
M v[88:91], a[172:175], a[40:43], v[88:91]
v_exp_f32 v157, v157
M v[88:91], a[176:179], a[44:47], v[88:91]
buffer_load_dwordx4 v1, s[12:15], s43 offen offset:2048 sc1 lds
M v[92:95], a[176:179], a[60:63], v[24:27]
v_exp_f32 v158, v158
M v[92:95], a[172:175], a[56:59], v[92:95]
v_cvt_pk_bf16_f32 v141, v142, v143
v_cvt_pk_bf16_f32 v142, v156, v157
M v[92:95], a[168:171], a[52:55], v[92:95]
v_exp_f32 v159, v159
M v[92:95], a[164:167], a[48:51], v[92:95]
buffer_load_dwordx4 v1, s[12:15], s43 offen offset:3072 sc1 lds
v_cvt_pk_bf16_f32 v143, v158, v159
s_waitcnt lgkmcnt(6)
M v[160:163], a[116:119], v[96:99], v[160:163]
v_exp_f32 v32, v32
M v[160:163], a[120:123], v[128:131], v[160:163]
ds_read_b128 a[148:151], v6 offset:36864
ds_read_b128 a[152:155], v6 offset:45056
M v[164:167], a[120:123], v[132:135], v[164:167]
v_exp_f32 v33, v33
M v[164:167], a[116:119], v[100:103], v[164:167]
v_cvt_pk_bf16_f32 v32, v32, v33
M v[168:171], a[116:119], v[104:107], v[168:171]
v_exp_f32 v34, v34
M v[168:171], a[120:123], v[136:139], v[168:171]
s_add_u32 s25, s25, 32768
s_cmp_eq_u32 s25, s27
M v[172:175], a[120:123], v[140:143], v[172:175]
v_exp_f32 v35, v35
M v[172:175], a[116:119], v[108:111], v[172:175]
v_cvt_pk_bf16_f32 v33, v34, v35
s_waitcnt lgkmcnt(6)
M a[96:99], a[112:115], v[96:99], a[96:99]
s_cselect_b32 s25, s28, s25
s_cselect_b32 s27, s56, s27
M a[96:99], a[112:115], v[128:131], a[96:99]
s_cselect_b32 s28, s57, s28
s_cselect_b32 s56, -1, s56
M v[176:179], a[124:127], v[96:99], v[176:179]
v_exp_f32 v48, v48
M v[176:179], a[128:131], v[128:131], v[176:179]
ds_read_b128 a[156:159], v6 offset:37888
ds_read_b128 a[160:163], v6 offset:46080
M v[180:183], a[128:131], v[132:135], v[180:183]
v_exp_f32 v49, v49
M v[180:183], a[124:127], v[100:103], v[180:183]
v_cvt_pk_bf16_f32 v34, v48, v49
M v[184:187], a[124:127], v[104:107], v[184:187]
v_exp_f32 v50, v50
M v[184:187], a[128:131], v[136:139], v[184:187]
s_add_u32 s26, s26, 32768
s_cmp_eq_u32 s26, s62
M v[188:191], a[128:131], v[140:143], v[188:191]
v_exp_f32 v51, v51
M v[188:191], a[124:127], v[108:111], v[188:191]
v_cvt_pk_bf16_f32 v35, v50, v51
s_waitcnt lgkmcnt(6)
M a[100:103], a[112:115], v[100:103], a[100:103]
s_cselect_b32 s26, s63, s26
s_cselect_b32 s62, s58, s62
M a[100:103], a[112:115], v[132:135], a[100:103]
s_cselect_b32 s63, s59, s63
s_cselect_b32 s58, -1, s58
M v[192:195], a[132:135], v[96:99], v[192:195]
v_exp_f32 v36, v36
M v[192:195], a[136:139], v[128:131], v[192:195]
ds_read_b128 a[164:167], v6 offset:38912
ds_read_b128 a[168:171], v6 offset:47104
M v[196:199], a[136:139], v[132:135], v[196:199]
v_exp_f32 v37, v37
M v[196:199], a[132:135], v[100:103], v[196:199]
v_cvt_pk_bf16_f32 v36, v36, v37
M v[200:203], a[132:135], v[104:107], v[200:203]
v_exp_f32 v38, v38
M v[200:203], a[136:139], v[136:139], v[200:203]
s_sub_u32 s33, s42, 1
s_cmp_le_u32 s33, 1
s_cselect_b32 s33, 0x4000, 0
v_add_u32 v3, s33, v3
M v[204:207], a[136:139], v[140:143], v[204:207]
v_exp_f32 v39, v39
M v[204:207], a[132:135], v[108:111], v[204:207]
v_cvt_pk_bf16_f32 v37, v38, v39
s_waitcnt lgkmcnt(6)
M a[104:107], a[112:115], v[104:107], a[104:107]
M a[104:107], a[112:115], v[136:139], a[104:107]
M v[208:211], a[140:143], v[96:99], v[208:211]
v_exp_f32 v52, v52
M v[208:211], a[144:147], v[128:131], v[208:211]
ds_read_b128 a[172:175], v6 offset:39936
ds_read_b128 a[176:179], v6 offset:48128
M v[212:215], a[144:147], v[132:135], v[212:215]
v_exp_f32 v53, v53
M v[212:215], a[140:143], v[100:103], v[212:215]
v_cvt_pk_bf16_f32 v38, v52, v53
M v[216:219], a[140:143], v[104:107], v[216:219]
v_exp_f32 v54, v54
M v[216:219], a[144:147], v[136:139], v[216:219]
M v[220:223], a[144:147], v[140:143], v[220:223]
v_exp_f32 v55, v55
M v[220:223], a[140:143], v[108:111], v[220:223]
v_cvt_pk_bf16_f32 v39, v54, v55
s_waitcnt lgkmcnt(6)
M a[108:111], a[112:115], v[108:111], a[108:111]
M a[108:111], a[112:115], v[140:143], a[108:111]
M v[224:227], a[148:151], v[96:99], v[224:227]
v_exp_f32 v40, v40
M v[224:227], a[152:155], v[128:131], v[224:227]
s_cmp_le_u32 s42, 1
s_cselect_b32 s33, 0x4000, 0
v_add_u32 v6, s33, v6
s_sub_u32 s42, s42, 1
M v[228:231], a[152:155], v[132:135], v[228:231]
v_exp_f32 v41, v41
M v[228:231], a[148:151], v[100:103], v[228:231]
v_cvt_pk_bf16_f32 v40, v40, v41
M v[232:235], a[148:151], v[104:107], v[232:235]
v_exp_f32 v42, v42
M v[232:235], a[152:155], v[136:139], v[232:235]
M v[236:239], a[152:155], v[140:143], v[236:239]
v_exp_f32 v43, v43
M v[236:239], a[148:151], v[108:111], v[236:239]
v_cvt_pk_bf16_f32 v41, v42, v43
s_waitcnt lgkmcnt(4)
M v[240:243], a[156:159], v[96:99], v[240:243]
v_exp_f32 v56, v56
M v[240:243], a[160:163], v[128:131], v[240:243]
M v[244:247], a[160:163], v[132:135], v[244:247]
v_exp_f32 v57, v57
M v[244:247], a[156:159], v[100:103], v[244:247]
v_cvt_pk_bf16_f32 v42, v56, v57
M v[248:251], a[156:159], v[104:107], v[248:251]
v_exp_f32 v58, v58
M v[248:251], a[160:163], v[136:139], v[248:251]
s_waitcnt vmcnt(0) lgkmcnt(0)
s_barrier
ds_read_b128 a[116:119], v2 offset:0
ds_read_b128 a[120:123], v2 offset:1024
M v[252:255], a[160:163], v[140:143], v[252:255]
v_exp_f32 v59, v59
M v[252:255], a[156:159], v[108:111], v[252:255]
v_cvt_pk_bf16_f32 v43, v58, v59
M a[64:67], a[164:167], v[96:99], a[64:67]
v_exp_f32 v44, v44
M a[64:67], a[168:171], v[128:131], a[64:67]
ds_read_b128 a[124:127], v2 offset:2048
ds_read_b128 a[128:131], v2 offset:3072
M a[68:71], a[168:171], v[132:135], a[68:71]
v_exp_f32 v45, v45
M a[68:71], a[164:167], v[100:103], a[68:71]
v_cvt_pk_bf16_f32 v44, v44, v45
M a[72:75], a[164:167], v[104:107], a[72:75]
v_exp_f32 v46, v46
M a[72:75], a[168:171], v[136:139], a[72:75]
ds_read_b128 a[132:135], v2 offset:4096
ds_read_b128 a[136:139], v2 offset:5120
M a[76:79], a[168:171], v[140:143], a[76:79]
v_exp_f32 v47, v47
M a[76:79], a[164:167], v[108:111], a[76:79]
v_cvt_pk_bf16_f32 v45, v46, v47
M a[80:83], a[172:175], v[96:99], a[80:83]
v_exp_f32 v60, v60
M a[80:83], a[176:179], v[128:131], a[80:83]
ds_read_b128 a[140:143], v2 offset:6144
ds_read_b128 a[144:147], v2 offset:7168
M a[84:87], a[176:179], v[132:135], a[84:87]
v_exp_f32 v61, v61
M a[84:87], a[172:175], v[100:103], a[84:87]
v_cvt_pk_bf16_f32 v46, v60, v61
M a[88:91], a[172:175], v[104:107], a[88:91]
v_exp_f32 v62, v62
M a[88:91], a[176:179], v[136:139], a[88:91]
M a[92:95], a[176:179], v[140:143], a[92:95]
v_exp_f32 v63, v63
M a[92:95], a[172:175], v[108:111], a[92:95]
v_cvt_pk_bf16_f32 v47, v62, v63
s_waitcnt lgkmcnt(0)
Lk2_fin:
s_and_b32 s3, s2, 3
s_lshl_b32 s3, s3, 2
s_bfe_u32 s27, s2, 0x20003
s_add_u32 s27, s3, s27
s_lshl_b32 s43, s27, 8
s_add_u32 s43, s43, 8400896
v_lshlrev_b32 v15, 2, v0
buffer_load_dword v7, v15, s[52:55], s43 offen sc1
ds_read_b128 a[116:119], v5 offset:32768
ds_read_b128 a[120:123], v5 offset:40960
ds_read_b128 a[124:127], v5 offset:33792
ds_read_b128 a[128:131], v5 offset:41984
ds_read_b128 a[132:135], v5 offset:34816
ds_read_b128 a[136:139], v5 offset:43008
ds_read_b128 a[140:143], v5 offset:35840
ds_read_b128 a[144:147], v5 offset:44032
v_exp_f32 v64, v64
v_exp_f32 v65, v65
v_exp_f32 v66, v66
v_exp_f32 v67, v67
v_exp_f32 v80, v80
v_exp_f32 v81, v81
v_exp_f32 v82, v82
v_exp_f32 v83, v83
v_cvt_pk_bf16_f32 v64, v64, v65
v_cvt_pk_bf16_f32 v65, v66, v67
v_exp_f32 v68, v68
v_exp_f32 v69, v69
v_exp_f32 v70, v70
v_exp_f32 v71, v71
v_cvt_pk_bf16_f32 v66, v80, v81
v_cvt_pk_bf16_f32 v67, v82, v83
v_exp_f32 v84, v84
v_exp_f32 v85, v85
v_exp_f32 v86, v86
v_exp_f32 v87, v87
v_cvt_pk_bf16_f32 v68, v68, v69
v_cvt_pk_bf16_f32 v69, v70, v71
v_exp_f32 v72, v72
v_exp_f32 v73, v73
v_exp_f32 v74, v74
v_exp_f32 v75, v75
v_cvt_pk_bf16_f32 v70, v84, v85
v_cvt_pk_bf16_f32 v71, v86, v87
v_exp_f32 v88, v88
v_exp_f32 v89, v89
v_exp_f32 v90, v90
v_exp_f32 v91, v91
v_cvt_pk_bf16_f32 v72, v72, v73
v_cvt_pk_bf16_f32 v73, v74, v75
v_exp_f32 v76, v76
v_exp_f32 v77, v77
v_exp_f32 v78, v78
v_exp_f32 v79, v79
v_cvt_pk_bf16_f32 v74, v88, v89
v_cvt_pk_bf16_f32 v75, v90, v91
v_exp_f32 v92, v92
v_exp_f32 v93, v93
v_exp_f32 v94, v94
v_exp_f32 v95, v95
v_cvt_pk_bf16_f32 v76, v76, v77
v_cvt_pk_bf16_f32 v77, v78, v79
v_cvt_pk_bf16_f32 v78, v92, v93
v_cvt_pk_bf16_f32 v79, v94, v95
s_waitcnt lgkmcnt(6)
M v[160:163], a[116:119], v[32:35], v[160:163]
M v[160:163], a[120:123], v[64:67], v[160:163]
ds_read_b128 a[148:151], v5 offset:36864
ds_read_b128 a[152:155], v5 offset:45056
s_mov_b32 s61, 0
M v[164:167], a[120:123], v[68:71], v[164:167]
M v[164:167], a[116:119], v[36:39], v[164:167]
s_bfe_u32 s3, s2, 0x10002
M v[168:171], a[116:119], v[40:43], v[168:171]
M v[168:171], a[120:123], v[72:75], v[168:171]
s_lshl_b32 s3, s3, 3
M v[172:175], a[120:123], v[76:79], v[172:175]
M v[172:175], a[116:119], v[44:47], v[172:175]
s_waitcnt lgkmcnt(6)
s_lshr_b32 s28, s2, 5
M a[96:99], a[112:115], v[32:35], a[96:99]
M a[96:99], a[112:115], v[64:67], a[96:99]
M v[176:179], a[124:127], v[32:35], v[176:179]
M v[176:179], a[128:131], v[64:67], v[176:179]
ds_read_b128 a[156:159], v5 offset:37888
ds_read_b128 a[160:163], v5 offset:46080
s_add_u32 s28, s3, s28
M v[180:183], a[128:131], v[68:71], v[180:183]
s_lshl_b32 s25, s27, 18
M v[180:183], a[124:127], v[36:39], v[180:183]
M v[184:187], a[124:127], v[40:43], v[184:187]
s_lshl_b32 s3, s101, 12
M v[184:187], a[128:131], v[72:75], v[184:187]
M v[188:191], a[128:131], v[76:79], v[188:191]
s_add_u32 s25, s25, s3
M v[188:191], a[124:127], v[44:47], v[188:191]
s_waitcnt lgkmcnt(6)
M a[100:103], a[112:115], v[36:39], a[100:103]
M a[100:103], a[112:115], v[68:71], a[100:103]
M v[192:195], a[132:135], v[32:35], v[192:195]
s_lshl_b32 s26, s28, 7
M v[192:195], a[136:139], v[64:67], v[192:195]
ds_read_b128 a[164:167], v5 offset:38912
ds_read_b128 a[168:171], v5 offset:47104
M v[196:199], a[136:139], v[68:71], v[196:199]
s_lshl_b32 s42, s101, 11
M v[196:199], a[132:135], v[36:39], v[196:199]
M v[200:203], a[132:135], v[40:43], v[200:203]
s_add_u32 s44, s4, 83886080
s_addc_u32 s45, s5, 0
M v[200:203], a[136:139], v[72:75], v[200:203]
s_mov_b32 s46, 4194304
M v[204:207], a[136:139], v[76:79], v[204:207]
M v[204:207], a[132:135], v[44:47], v[204:207]
s_waitcnt lgkmcnt(6)
s_mov_b32 s47, 0x00020000
M a[104:107], a[112:115], v[40:43], a[104:107]
M a[104:107], a[112:115], v[72:75], a[104:107]
M v[208:211], a[140:143], v[32:35], v[208:211]
M v[208:211], a[144:147], v[64:67], v[208:211]
ds_read_b128 a[172:175], v5 offset:39936
ds_read_b128 a[176:179], v5 offset:48128
s_mov_b32 s50, 2097152
M v[212:215], a[144:147], v[68:71], v[212:215]
M v[212:215], a[140:143], v[36:39], v[212:215]
s_mov_b32 s51, 0x00020000
M v[216:219], a[140:143], v[40:43], v[216:219]
M v[216:219], a[144:147], v[72:75], v[216:219]
s_lshl_b32 s3, s101, 4
M v[220:223], a[144:147], v[76:79], v[220:223]
M v[220:223], a[140:143], v[44:47], v[220:223]
s_waitcnt lgkmcnt(6)
v_lshrrev_b32 v96, 3, v0
M a[108:111], a[112:115], v[44:47], a[108:111]
M a[108:111], a[112:115], v[76:79], a[108:111]
M v[224:227], a[148:151], v[32:35], v[224:227]
v_and_b32 v97, 6, v96
M v[224:227], a[152:155], v[64:67], v[224:227]
M v[228:231], a[152:155], v[68:71], v[228:231]
v_and_b32 v98, 7, v0
M v[228:231], a[148:151], v[36:39], v[228:231]
M v[232:235], a[148:151], v[40:43], v[232:235]
v_xor_b32 v97, v97, v98
M v[232:235], a[152:155], v[72:75], v[232:235]
M v[236:239], a[152:155], v[76:79], v[236:239]
v_add_u32 v96, s3, v96
M v[236:239], a[148:151], v[44:47], v[236:239]
s_waitcnt lgkmcnt(4)
M v[240:243], a[156:159], v[32:35], v[240:243]
v_lshlrev_b32 v96, 11, v96
M v[240:243], a[160:163], v[64:67], v[240:243]
M v[244:247], a[160:163], v[68:71], v[244:247]
v_lshl_add_u32 v99, v97, 4, v96
M v[244:247], a[156:159], v[36:39], v[244:247]
v_add_u32 v100, 15360, v99
M v[248:251], a[156:159], v[40:43], v[248:251]
M v[248:251], a[160:163], v[72:75], v[248:251]
s_waitcnt vmcnt(0) lgkmcnt(0)
s_barrier
v_cmp_ne_u32 vcc, 1, v7
s_nop 0
s_cbranch_vccnz Lk3_spinb0
Lk3_gotb0:
M v[252:255], a[160:163], v[76:79], v[252:255]
s_add_u32 m0, s42, 65536
s_nop 0
buffer_load_dwordx4 v99, s[48:51], s26 offen offset:0 lds
buffer_load_dwordx4 v100, s[48:51], s26 offen offset:1024 lds
M v[252:255], a[156:159], v[44:47], v[252:255]
buffer_load_dwordx4 a[192:195], v1, s[44:47], s25 offen offset:0 sc1
buffer_load_dwordx4 a[196:199], v1, s[44:47], s25 offen offset:1024 sc1
M a[64:67], a[164:167], v[32:35], a[64:67]
buffer_load_dwordx4 a[200:203], v1, s[44:47], s25 offen offset:2048 sc1
buffer_load_dwordx4 a[204:207], v1, s[44:47], s25 offen offset:3072 sc1
M a[64:67], a[168:171], v[64:67], a[64:67]
s_add_u32 s25, s25, 16384
s_add_u32 s26, s26, 131072
s_add_u32 m0, s42, 81920
s_nop 0
buffer_load_dwordx4 v99, s[48:51], s26 offen offset:0 lds
M a[68:71], a[168:171], v[68:71], a[68:71]
buffer_load_dwordx4 v100, s[48:51], s26 offen offset:1024 lds
buffer_load_dwordx4 a[208:211], v1, s[44:47], s25 offen offset:0 sc1
M a[68:71], a[164:167], v[36:39], a[68:71]
buffer_load_dwordx4 a[212:215], v1, s[44:47], s25 offen offset:1024 sc1
buffer_load_dwordx4 a[216:219], v1, s[44:47], s25 offen offset:2048 sc1
M a[72:75], a[164:167], v[40:43], a[72:75]
buffer_load_dwordx4 a[220:223], v1, s[44:47], s25 offen offset:3072 sc1
s_add_u32 s25, s25, 16384
s_add_u32 s26, s26, 131072
M a[72:75], a[168:171], v[72:75], a[72:75]
s_add_u32 m0, s42, 98304
s_nop 0
buffer_load_dwordx4 v99, s[48:51], s26 offen offset:0 lds
buffer_load_dwordx4 v100, s[48:51], s26 offen offset:1024 lds
M a[76:79], a[168:171], v[76:79], a[76:79]
buffer_load_dwordx4 a[224:227], v1, s[44:47], s25 offen offset:0 sc1
M a[76:79], a[164:167], v[44:47], a[76:79]
buffer_load_dwordx4 a[228:231], v1, s[44:47], s25 offen offset:1024 sc1
buffer_load_dwordx4 a[232:235], v1, s[44:47], s25 offen offset:2048 sc1
M a[80:83], a[172:175], v[32:35], a[80:83]
buffer_load_dwordx4 a[236:239], v1, s[44:47], s25 offen offset:3072 sc1
s_add_u32 s25, s25, 16384
s_add_u32 s26, s26, 131072
M a[80:83], a[176:179], v[64:67], a[80:83]
s_add_u32 m0, s42, 114688
s_nop 0
buffer_load_dwordx4 v99, s[48:51], s26 offen offset:0 lds
buffer_load_dwordx4 v100, s[48:51], s26 offen offset:1024 lds
M a[84:87], a[176:179], v[68:71], a[84:87]
buffer_load_dwordx4 a[240:243], v1, s[44:47], s25 offen offset:0 sc1
buffer_load_dwordx4 a[244:247], v1, s[44:47], s25 offen offset:1024 sc1
M a[84:87], a[172:175], v[36:39], a[84:87]
buffer_load_dwordx4 a[248:251], v1, s[44:47], s25 offen offset:2048 sc1
buffer_load_dwordx4 a[252:255], v1, s[44:47], s25 offen offset:3072 sc1
M a[88:91], a[172:175], v[40:43], a[88:91]
s_add_u32 s25, s25, 16384
s_add_u32 s26, s26, 131072
s_add_u32 m0, s42, 0
s_nop 0
buffer_load_dwordx4 v99, s[48:51], s26 offen offset:0 lds
M a[88:91], a[176:179], v[72:75], a[88:91]
buffer_load_dwordx4 v100, s[48:51], s26 offen offset:1024 lds
buffer_load_dwordx4 a[128:131], v1, s[44:47], s25 offen offset:0 sc1
M a[92:95], a[176:179], v[76:79], a[92:95]
buffer_load_dwordx4 a[132:135], v1, s[44:47], s25 offen offset:1024 sc1
buffer_load_dwordx4 a[136:139], v1, s[44:47], s25 offen offset:2048 sc1
M a[92:95], a[172:175], v[44:47], a[92:95]
buffer_load_dwordx4 a[140:143], v1, s[44:47], s25 offen offset:3072 sc1
s_add_u32 s25, s25, 16384
s_add_u32 s26, s26, 131072
Lk2_merge:
s_lshl_b32 s33, s23, 14
s_add_u32 s34, s33, 131072
s_add_u32 s33, s33, 32768
s_cmp_eq_u32 s24, 0
s_cselect_b32 s35, s34, s33
s_cselect_b32 s36, s33, s34
v_add_u32 v2, s35, v1
v_add_u32 v3, s36, v1
s_lshl_b32 s33, s22, 10
s_add_u32 s33, s33, 28672
s_xor_b32 s34, s33, 2048
v_add_u32 v14, s33, v1
v_add_u32 v15, s34, v1
v_accvgpr_read_b32 v20, a96
v_accvgpr_read_b32 v21, a100
v_accvgpr_read_b32 v22, a104
v_accvgpr_read_b32 v23, a108
ds_write_b128 v14, v[20:23]
s_cmp_eq_u32 s24, 1
s_waitcnt lgkmcnt(0)
s_cbranch_scc1 Lk2_mg1
ds_write_b128 v2, v[224:227] offset:0
ds_write_b128 v2, v[228:231] offset:1024
ds_write_b128 v2, v[232:235] offset:2048
ds_write_b128 v2, v[236:239] offset:3072
ds_write_b128 v2, v[240:243] offset:4096
ds_write_b128 v2, v[244:247] offset:5120
ds_write_b128 v2, v[248:251] offset:6144
ds_write_b128 v2, v[252:255] offset:7168
ds_write_b128 v2, a[64:67] offset:8192
ds_write_b128 v2, a[68:71] offset:9216
ds_write_b128 v2, a[72:75] offset:10240
ds_write_b128 v2, a[76:79] offset:11264
ds_write_b128 v2, a[80:83] offset:12288
ds_write_b128 v2, a[84:87] offset:13312
ds_write_b128 v2, a[88:91] offset:14336
ds_write_b128 v2, a[92:95] offset:15360
s_waitcnt lgkmcnt(0)
s_barrier
ds_read_b128 v[28:31], v15
ds_read_b128 v[32:35], v3 offset:0
ds_read_b128 v[36:39], v3 offset:1024
ds_read_b128 v[40:43], v3 offset:2048
ds_read_b128 v[44:47], v3 offset:3072
ds_read_b128 v[48:51], v3 offset:4096
ds_read_b128 v[52:55], v3 offset:5120
ds_read_b128 v[56:59], v3 offset:6144
ds_read_b128 v[60:63], v3 offset:7168
ds_read_b128 v[64:67], v3 offset:8192
ds_read_b128 v[68:71], v3 offset:9216
ds_read_b128 v[72:75], v3 offset:10240
ds_read_b128 v[76:79], v3 offset:11264
ds_read_b128 v[80:83], v3 offset:12288
ds_read_b128 v[84:87], v3 offset:13312
ds_read_b128 v[88:91], v3 offset:14336
ds_read_b128 v[92:95], v3 offset:15360
s_waitcnt lgkmcnt(15)
v_add_f32 v20, v20, v28
v_add_f32 v21, v21, v29
v_add_f32 v22, v22, v30
v_add_f32 v23, v23, v31
s_sub_u32 s35, 15, s21
v_rcp_f32 v8, v20
v_rcp_f32 v9, v21
v_rcp_f32 v10, v22
v_rcp_f32 v11, v23
v_subrev_u32 v20, 0x21800000, v20
v_subrev_u32 v21, 0x21800000, v21
v_subrev_u32 v22, 0x21800000, v22
v_subrev_u32 v23, 0x21800000, v23
v_max_u32 v12, v20, v21
v_max3_u32 v12, v12, v22, v23
s_mov_b32 s64, 0x207
s_lshl_b32 s33, s35, 20
s_lshl_b32 s34, s20, 15
s_add_u32 s33, s33, s34
s_lshl_b32 s34, s23, 13
s_add_u32 s36, s33, s34
s_add_u32 s37, s36, 4096
s_add_u32 s38, s36, 16384
s_add_u32 s39, s36, 20480
v_pk_add_f32 v[160:161], v[160:161], v[32:33]
v_pk_add_f32 v[162:163], v[162:163], v[34:35]
s_waitcnt lgkmcnt(11)
v_pk_add_f32 v[176:177], v[176:177], v[48:49]
v_pk_add_f32 v[178:179], v[178:179], v[50:51]
v_pk_mul_f32 v[160:161], v[160:161], v[8:9] op_sel:[0,0] op_sel_hi:[1,0]
v_pk_mul_f32 v[162:163], v[162:163], v[8:9] op_sel:[0,0] op_sel_hi:[1,0]
v_pk_mul_f32 v[176:177], v[176:177], v[8:9] op_sel:[0,0] op_sel_hi:[1,0]
v_pk_mul_f32 v[178:179], v[178:179], v[8:9] op_sel:[0,0] op_sel_hi:[1,0]
v_cvt_pk_bf16_f32 v160, v160, v161
v_cvt_pk_bf16_f32 v161, v162, v163
v_cvt_pk_bf16_f32 v162, v176, v177
v_cvt_pk_bf16_f32 v163, v178, v179
v_pk_add_f32 v[164:165], v[164:165], v[36:37]
v_pk_add_f32 v[166:167], v[166:167], v[38:39]
s_waitcnt lgkmcnt(10)
v_pk_add_f32 v[180:181], v[180:181], v[52:53]
v_pk_add_f32 v[182:183], v[182:183], v[54:55]
M v[24:27], a[112:115], v[160:163], 0
buffer_store_dwordx4 v[160:163], v1, s[16:19], s36 offen offset:0 sc1
v_pk_mul_f32 v[164:165], v[164:165], v[8:9] op_sel:[0,1] op_sel_hi:[1,1]
v_pk_mul_f32 v[166:167], v[166:167], v[8:9] op_sel:[0,1] op_sel_hi:[1,1]
v_pk_mul_f32 v[180:181], v[180:181], v[8:9] op_sel:[0,1] op_sel_hi:[1,1]
v_pk_mul_f32 v[182:183], v[182:183], v[8:9] op_sel:[0,1] op_sel_hi:[1,1]
v_cvt_pk_bf16_f32 v164, v164, v165
v_cvt_pk_bf16_f32 v165, v166, v167
v_cvt_pk_bf16_f32 v166, v180, v181
v_cvt_pk_bf16_f32 v167, v182, v183
v_pk_add_f32 v[168:169], v[168:169], v[40:41]
v_pk_add_f32 v[170:171], v[170:171], v[42:43]
s_waitcnt lgkmcnt(9)
v_pk_add_f32 v[184:185], v[184:185], v[56:57]
v_pk_add_f32 v[186:187], v[186:187], v[58:59]
M v[24:27], a[112:115], v[164:167], v[24:27]
buffer_store_dwordx4 v[164:167], v1, s[16:19], s36 offen offset:2048 sc1
v_pk_mul_f32 v[168:169], v[168:169], v[10:11] op_sel:[0,0] op_sel_hi:[1,0]
v_pk_mul_f32 v[170:171], v[170:171], v[10:11] op_sel:[0,0] op_sel_hi:[1,0]
v_pk_mul_f32 v[184:185], v[184:185], v[10:11] op_sel:[0,0] op_sel_hi:[1,0]
v_pk_mul_f32 v[186:187], v[186:187], v[10:11] op_sel:[0,0] op_sel_hi:[1,0]
v_cvt_pk_bf16_f32 v168, v168, v169
v_cvt_pk_bf16_f32 v169, v170, v171
v_cvt_pk_bf16_f32 v170, v184, v185
v_cvt_pk_bf16_f32 v171, v186, v187
v_pk_add_f32 v[172:173], v[172:173], v[44:45]
v_pk_add_f32 v[174:175], v[174:175], v[46:47]
s_waitcnt lgkmcnt(8)
v_pk_add_f32 v[188:189], v[188:189], v[60:61]
v_pk_add_f32 v[190:191], v[190:191], v[62:63]
M v[24:27], a[112:115], v[168:171], v[24:27]
buffer_store_dwordx4 v[168:171], v1, s[16:19], s37 offen offset:0 sc1
v_pk_mul_f32 v[172:173], v[172:173], v[10:11] op_sel:[0,1] op_sel_hi:[1,1]
v_pk_mul_f32 v[174:175], v[174:175], v[10:11] op_sel:[0,1] op_sel_hi:[1,1]
v_pk_mul_f32 v[188:189], v[188:189], v[10:11] op_sel:[0,1] op_sel_hi:[1,1]
v_pk_mul_f32 v[190:191], v[190:191], v[10:11] op_sel:[0,1] op_sel_hi:[1,1]
v_cvt_pk_bf16_f32 v172, v172, v173
v_cvt_pk_bf16_f32 v173, v174, v175
v_cvt_pk_bf16_f32 v174, v188, v189
v_cvt_pk_bf16_f32 v175, v190, v191
s_waitcnt lgkmcnt(7)
v_pk_add_f32 v[192:193], v[192:193], v[64:65]
v_pk_add_f32 v[194:195], v[194:195], v[66:67]
s_waitcnt lgkmcnt(3)
v_pk_add_f32 v[208:209], v[208:209], v[80:81]
v_pk_add_f32 v[210:211], v[210:211], v[82:83]
M v[24:27], a[112:115], v[172:175], v[24:27]
buffer_store_dwordx4 v[172:175], v1, s[16:19], s37 offen offset:2048 sc1
v_pk_mul_f32 v[192:193], v[192:193], v[8:9] op_sel:[0,0] op_sel_hi:[1,0]
v_pk_mul_f32 v[194:195], v[194:195], v[8:9] op_sel:[0,0] op_sel_hi:[1,0]
v_pk_mul_f32 v[208:209], v[208:209], v[8:9] op_sel:[0,0] op_sel_hi:[1,0]
v_pk_mul_f32 v[210:211], v[210:211], v[8:9] op_sel:[0,0] op_sel_hi:[1,0]
v_cvt_pk_bf16_f32 v192, v192, v193
v_cvt_pk_bf16_f32 v193, v194, v195
v_cvt_pk_bf16_f32 v194, v208, v209
v_cvt_pk_bf16_f32 v195, v210, v211
v_pk_add_f32 v[196:197], v[196:197], v[68:69]
v_pk_add_f32 v[198:199], v[198:199], v[70:71]
s_waitcnt lgkmcnt(2)
v_pk_add_f32 v[212:213], v[212:213], v[84:85]
v_pk_add_f32 v[214:215], v[214:215], v[86:87]
M v[24:27], a[112:115], v[192:195], v[24:27]
buffer_store_dwordx4 v[192:195], v1, s[16:19], s36 offen offset:1024 sc1
v_pk_mul_f32 v[196:197], v[196:197], v[8:9] op_sel:[0,1] op_sel_hi:[1,1]
v_pk_mul_f32 v[198:199], v[198:199], v[8:9] op_sel:[0,1] op_sel_hi:[1,1]
v_pk_mul_f32 v[212:213], v[212:213], v[8:9] op_sel:[0,1] op_sel_hi:[1,1]
v_pk_mul_f32 v[214:215], v[214:215], v[8:9] op_sel:[0,1] op_sel_hi:[1,1]
v_cvt_pk_bf16_f32 v196, v196, v197
v_cvt_pk_bf16_f32 v197, v198, v199
v_cvt_pk_bf16_f32 v198, v212, v213
v_cvt_pk_bf16_f32 v199, v214, v215
v_pk_add_f32 v[200:201], v[200:201], v[72:73]
v_pk_add_f32 v[202:203], v[202:203], v[74:75]
s_waitcnt lgkmcnt(1)
v_pk_add_f32 v[216:217], v[216:217], v[88:89]
v_pk_add_f32 v[218:219], v[218:219], v[90:91]
M v[24:27], a[112:115], v[196:199], v[24:27]
buffer_store_dwordx4 v[196:199], v1, s[16:19], s36 offen offset:3072 sc1
v_pk_mul_f32 v[200:201], v[200:201], v[10:11] op_sel:[0,0] op_sel_hi:[1,0]
v_pk_mul_f32 v[202:203], v[202:203], v[10:11] op_sel:[0,0] op_sel_hi:[1,0]
v_pk_mul_f32 v[216:217], v[216:217], v[10:11] op_sel:[0,0] op_sel_hi:[1,0]
v_pk_mul_f32 v[218:219], v[218:219], v[10:11] op_sel:[0,0] op_sel_hi:[1,0]
v_cvt_pk_bf16_f32 v200, v200, v201
v_cvt_pk_bf16_f32 v201, v202, v203
v_cvt_pk_bf16_f32 v202, v216, v217
v_cvt_pk_bf16_f32 v203, v218, v219
v_pk_add_f32 v[204:205], v[204:205], v[76:77]
v_pk_add_f32 v[206:207], v[206:207], v[78:79]
s_waitcnt lgkmcnt(0)
v_pk_add_f32 v[220:221], v[220:221], v[92:93]
v_pk_add_f32 v[222:223], v[222:223], v[94:95]
M v[24:27], a[112:115], v[200:203], v[24:27]
buffer_store_dwordx4 v[200:203], v1, s[16:19], s37 offen offset:1024 sc1
v_pk_mul_f32 v[204:205], v[204:205], v[10:11] op_sel:[0,1] op_sel_hi:[1,1]
v_pk_mul_f32 v[206:207], v[206:207], v[10:11] op_sel:[0,1] op_sel_hi:[1,1]
v_pk_mul_f32 v[220:221], v[220:221], v[10:11] op_sel:[0,1] op_sel_hi:[1,1]
v_pk_mul_f32 v[222:223], v[222:223], v[10:11] op_sel:[0,1] op_sel_hi:[1,1]
v_cvt_pk_bf16_f32 v204, v204, v205
v_cvt_pk_bf16_f32 v205, v206, v207
v_cvt_pk_bf16_f32 v206, v220, v221
v_cvt_pk_bf16_f32 v207, v222, v223
s_nop 1
M v[24:27], a[112:115], v[204:207], v[24:27]
buffer_store_dwordx4 v[204:207], v1, s[16:19], s37 offen offset:3072 sc1
v_cmp_lt_u32 vcc, 0x3c000000, v12
s_nop 5
v_cmp_class_f32 s[40:41], v24, s64
s_nop 0
s_or_b64 vcc, vcc, s[40:41]
s_cmp_lg_u64 vcc, 0
s_cselect_b32 s33, 2, 0
s_or_b32 s60, s60, s33
s_branch Lk2_chk
Lk2_mg1:
ds_write_b128 v2, v[160:163] offset:0
ds_write_b128 v2, v[164:167] offset:1024
ds_write_b128 v2, v[168:171] offset:2048
ds_write_b128 v2, v[172:175] offset:3072
ds_write_b128 v2, v[176:179] offset:4096
ds_write_b128 v2, v[180:183] offset:5120
ds_write_b128 v2, v[184:187] offset:6144
ds_write_b128 v2, v[188:191] offset:7168
ds_write_b128 v2, v[192:195] offset:8192
ds_write_b128 v2, v[196:199] offset:9216
ds_write_b128 v2, v[200:203] offset:10240
ds_write_b128 v2, v[204:207] offset:11264
ds_write_b128 v2, v[208:211] offset:12288
ds_write_b128 v2, v[212:215] offset:13312
ds_write_b128 v2, v[216:219] offset:14336
ds_write_b128 v2, v[220:223] offset:15360
s_waitcnt lgkmcnt(0)
s_barrier
ds_read_b128 v[28:31], v15
ds_read_b128 v[32:35], v3 offset:0
ds_read_b128 v[36:39], v3 offset:1024
ds_read_b128 v[40:43], v3 offset:2048
ds_read_b128 v[44:47], v3 offset:3072
ds_read_b128 v[48:51], v3 offset:4096
ds_read_b128 v[52:55], v3 offset:5120
ds_read_b128 v[56:59], v3 offset:6144
ds_read_b128 v[60:63], v3 offset:7168
ds_read_b128 v[64:67], v3 offset:8192
ds_read_b128 v[68:71], v3 offset:9216
ds_read_b128 v[72:75], v3 offset:10240
ds_read_b128 v[76:79], v3 offset:11264
ds_read_b128 v[80:83], v3 offset:12288
ds_read_b128 v[84:87], v3 offset:13312
ds_read_b128 v[88:91], v3 offset:14336
ds_read_b128 v[92:95], v3 offset:15360
s_waitcnt lgkmcnt(15)
v_add_f32 v20, v20, v28
v_add_f32 v21, v21, v29
v_add_f32 v22, v22, v30
v_add_f32 v23, v23, v31
s_sub_u32 s35, 15, s21
v_rcp_f32 v8, v20
v_rcp_f32 v9, v21
v_rcp_f32 v10, v22
v_rcp_f32 v11, v23
v_subrev_u32 v20, 0x21800000, v20
v_subrev_u32 v21, 0x21800000, v21
v_subrev_u32 v22, 0x21800000, v22
v_subrev_u32 v23, 0x21800000, v23
v_max_u32 v12, v20, v21
v_max3_u32 v12, v12, v22, v23
s_mov_b32 s64, 0x207
s_lshl_b32 s33, s35, 20
s_lshl_b32 s34, s20, 15
s_add_u32 s33, s33, s34
s_lshl_b32 s34, s23, 13
s_add_u32 s36, s33, s34
s_add_u32 s37, s36, 4096
s_add_u32 s38, s36, 16384
s_add_u32 s39, s36, 20480
v_pk_add_f32 v[224:225], v[224:225], v[32:33]
v_pk_add_f32 v[226:227], v[226:227], v[34:35]
s_waitcnt lgkmcnt(11)
v_pk_add_f32 v[240:241], v[240:241], v[48:49]
v_pk_add_f32 v[242:243], v[242:243], v[50:51]
v_pk_mul_f32 v[224:225], v[224:225], v[8:9] op_sel:[0,0] op_sel_hi:[1,0]
v_pk_mul_f32 v[226:227], v[226:227], v[8:9] op_sel:[0,0] op_sel_hi:[1,0]
v_pk_mul_f32 v[240:241], v[240:241], v[8:9] op_sel:[0,0] op_sel_hi:[1,0]
v_pk_mul_f32 v[242:243], v[242:243], v[8:9] op_sel:[0,0] op_sel_hi:[1,0]
v_cvt_pk_bf16_f32 v224, v224, v225
v_cvt_pk_bf16_f32 v225, v226, v227
v_cvt_pk_bf16_f32 v226, v240, v241
v_cvt_pk_bf16_f32 v227, v242, v243
v_pk_add_f32 v[228:229], v[228:229], v[36:37]
v_pk_add_f32 v[230:231], v[230:231], v[38:39]
s_waitcnt lgkmcnt(10)
v_pk_add_f32 v[244:245], v[244:245], v[52:53]
v_pk_add_f32 v[246:247], v[246:247], v[54:55]
M v[24:27], a[112:115], v[224:227], 0
buffer_store_dwordx4 v[224:227], v1, s[16:19], s38 offen offset:0 sc1
v_pk_mul_f32 v[228:229], v[228:229], v[8:9] op_sel:[0,1] op_sel_hi:[1,1]
v_pk_mul_f32 v[230:231], v[230:231], v[8:9] op_sel:[0,1] op_sel_hi:[1,1]
v_pk_mul_f32 v[244:245], v[244:245], v[8:9] op_sel:[0,1] op_sel_hi:[1,1]
v_pk_mul_f32 v[246:247], v[246:247], v[8:9] op_sel:[0,1] op_sel_hi:[1,1]
v_cvt_pk_bf16_f32 v228, v228, v229
v_cvt_pk_bf16_f32 v229, v230, v231
v_cvt_pk_bf16_f32 v230, v244, v245
v_cvt_pk_bf16_f32 v231, v246, v247
v_pk_add_f32 v[232:233], v[232:233], v[40:41]
v_pk_add_f32 v[234:235], v[234:235], v[42:43]
s_waitcnt lgkmcnt(9)
v_pk_add_f32 v[248:249], v[248:249], v[56:57]
v_pk_add_f32 v[250:251], v[250:251], v[58:59]
M v[24:27], a[112:115], v[228:231], v[24:27]
buffer_store_dwordx4 v[228:231], v1, s[16:19], s38 offen offset:2048 sc1
v_pk_mul_f32 v[232:233], v[232:233], v[10:11] op_sel:[0,0] op_sel_hi:[1,0]
v_pk_mul_f32 v[234:235], v[234:235], v[10:11] op_sel:[0,0] op_sel_hi:[1,0]
v_pk_mul_f32 v[248:249], v[248:249], v[10:11] op_sel:[0,0] op_sel_hi:[1,0]
v_pk_mul_f32 v[250:251], v[250:251], v[10:11] op_sel:[0,0] op_sel_hi:[1,0]
v_cvt_pk_bf16_f32 v232, v232, v233
v_cvt_pk_bf16_f32 v233, v234, v235
v_cvt_pk_bf16_f32 v234, v248, v249
v_cvt_pk_bf16_f32 v235, v250, v251
v_pk_add_f32 v[236:237], v[236:237], v[44:45]
v_pk_add_f32 v[238:239], v[238:239], v[46:47]
s_waitcnt lgkmcnt(8)
v_pk_add_f32 v[252:253], v[252:253], v[60:61]
v_pk_add_f32 v[254:255], v[254:255], v[62:63]
M v[24:27], a[112:115], v[232:235], v[24:27]
buffer_store_dwordx4 v[232:235], v1, s[16:19], s39 offen offset:0 sc1
v_pk_mul_f32 v[236:237], v[236:237], v[10:11] op_sel:[0,1] op_sel_hi:[1,1]
v_pk_mul_f32 v[238:239], v[238:239], v[10:11] op_sel:[0,1] op_sel_hi:[1,1]
v_pk_mul_f32 v[252:253], v[252:253], v[10:11] op_sel:[0,1] op_sel_hi:[1,1]
v_pk_mul_f32 v[254:255], v[254:255], v[10:11] op_sel:[0,1] op_sel_hi:[1,1]
v_cvt_pk_bf16_f32 v236, v236, v237
v_cvt_pk_bf16_f32 v237, v238, v239
v_cvt_pk_bf16_f32 v238, v252, v253
v_cvt_pk_bf16_f32 v239, v254, v255
v_accvgpr_read_b32 v32, a64
v_accvgpr_read_b32 v33, a65
v_accvgpr_read_b32 v34, a66
v_accvgpr_read_b32 v35, a67
s_waitcnt lgkmcnt(7)
v_pk_add_f32 v[32:33], v[32:33], v[64:65]
v_pk_add_f32 v[34:35], v[34:35], v[66:67]
v_accvgpr_read_b32 v48, a80
v_accvgpr_read_b32 v49, a81
v_accvgpr_read_b32 v50, a82
v_accvgpr_read_b32 v51, a83
s_waitcnt lgkmcnt(3)
v_pk_add_f32 v[48:49], v[48:49], v[80:81]
v_pk_add_f32 v[50:51], v[50:51], v[82:83]
M v[24:27], a[112:115], v[236:239], v[24:27]
buffer_store_dwordx4 v[236:239], v1, s[16:19], s39 offen offset:2048 sc1
v_pk_mul_f32 v[32:33], v[32:33], v[8:9] op_sel:[0,0] op_sel_hi:[1,0]
v_pk_mul_f32 v[34:35], v[34:35], v[8:9] op_sel:[0,0] op_sel_hi:[1,0]
v_pk_mul_f32 v[48:49], v[48:49], v[8:9] op_sel:[0,0] op_sel_hi:[1,0]
v_pk_mul_f32 v[50:51], v[50:51], v[8:9] op_sel:[0,0] op_sel_hi:[1,0]
v_cvt_pk_bf16_f32 v32, v32, v33
v_cvt_pk_bf16_f32 v33, v34, v35
v_cvt_pk_bf16_f32 v34, v48, v49
v_cvt_pk_bf16_f32 v35, v50, v51
v_accvgpr_read_b32 v240, a68
v_accvgpr_read_b32 v241, a69
v_accvgpr_read_b32 v242, a70
v_accvgpr_read_b32 v243, a71
v_pk_add_f32 v[240:241], v[240:241], v[68:69]
v_pk_add_f32 v[242:243], v[242:243], v[70:71]
v_accvgpr_read_b32 v36, a84
v_accvgpr_read_b32 v37, a85
v_accvgpr_read_b32 v38, a86
v_accvgpr_read_b32 v39, a87
s_waitcnt lgkmcnt(2)
v_pk_add_f32 v[36:37], v[36:37], v[84:85]
v_pk_add_f32 v[38:39], v[38:39], v[86:87]
M v[24:27], a[112:115], v[32:35], v[24:27]
buffer_store_dwordx4 v[32:35], v1, s[16:19], s38 offen offset:1024 sc1
v_pk_mul_f32 v[240:241], v[240:241], v[8:9] op_sel:[0,1] op_sel_hi:[1,1]
v_pk_mul_f32 v[242:243], v[242:243], v[8:9] op_sel:[0,1] op_sel_hi:[1,1]
v_pk_mul_f32 v[36:37], v[36:37], v[8:9] op_sel:[0,1] op_sel_hi:[1,1]
v_pk_mul_f32 v[38:39], v[38:39], v[8:9] op_sel:[0,1] op_sel_hi:[1,1]
v_cvt_pk_bf16_f32 v240, v240, v241
v_cvt_pk_bf16_f32 v241, v242, v243
v_cvt_pk_bf16_f32 v242, v36, v37
v_cvt_pk_bf16_f32 v243, v38, v39
v_accvgpr_read_b32 v52, a72
v_accvgpr_read_b32 v53, a73
v_accvgpr_read_b32 v54, a74
v_accvgpr_read_b32 v55, a75
v_pk_add_f32 v[52:53], v[52:53], v[72:73]
v_pk_add_f32 v[54:55], v[54:55], v[74:75]
v_accvgpr_read_b32 v244, a88
v_accvgpr_read_b32 v245, a89
v_accvgpr_read_b32 v246, a90
v_accvgpr_read_b32 v247, a91
s_waitcnt lgkmcnt(1)
v_pk_add_f32 v[244:245], v[244:245], v[88:89]
v_pk_add_f32 v[246:247], v[246:247], v[90:91]
M v[24:27], a[112:115], v[240:243], v[24:27]
buffer_store_dwordx4 v[240:243], v1, s[16:19], s38 offen offset:3072 sc1
v_pk_mul_f32 v[52:53], v[52:53], v[10:11] op_sel:[0,0] op_sel_hi:[1,0]
v_pk_mul_f32 v[54:55], v[54:55], v[10:11] op_sel:[0,0] op_sel_hi:[1,0]
v_pk_mul_f32 v[244:245], v[244:245], v[10:11] op_sel:[0,0] op_sel_hi:[1,0]
v_pk_mul_f32 v[246:247], v[246:247], v[10:11] op_sel:[0,0] op_sel_hi:[1,0]
v_cvt_pk_bf16_f32 v52, v52, v53
v_cvt_pk_bf16_f32 v53, v54, v55
v_cvt_pk_bf16_f32 v54, v244, v245
v_cvt_pk_bf16_f32 v55, v246, v247
v_accvgpr_read_b32 v40, a76
v_accvgpr_read_b32 v41, a77
v_accvgpr_read_b32 v42, a78
v_accvgpr_read_b32 v43, a79
v_pk_add_f32 v[40:41], v[40:41], v[76:77]
v_pk_add_f32 v[42:43], v[42:43], v[78:79]
v_accvgpr_read_b32 v56, a92
v_accvgpr_read_b32 v57, a93
v_accvgpr_read_b32 v58, a94
v_accvgpr_read_b32 v59, a95
s_waitcnt lgkmcnt(0)
v_pk_add_f32 v[56:57], v[56:57], v[92:93]
v_pk_add_f32 v[58:59], v[58:59], v[94:95]
M v[24:27], a[112:115], v[52:55], v[24:27]
buffer_store_dwordx4 v[52:55], v1, s[16:19], s39 offen offset:1024 sc1
v_pk_mul_f32 v[40:41], v[40:41], v[10:11] op_sel:[0,1] op_sel_hi:[1,1]
v_pk_mul_f32 v[42:43], v[42:43], v[10:11] op_sel:[0,1] op_sel_hi:[1,1]
v_pk_mul_f32 v[56:57], v[56:57], v[10:11] op_sel:[0,1] op_sel_hi:[1,1]
v_pk_mul_f32 v[58:59], v[58:59], v[10:11] op_sel:[0,1] op_sel_hi:[1,1]
v_cvt_pk_bf16_f32 v40, v40, v41
v_cvt_pk_bf16_f32 v41, v42, v43
v_cvt_pk_bf16_f32 v42, v56, v57
v_cvt_pk_bf16_f32 v43, v58, v59
s_nop 1
M v[24:27], a[112:115], v[40:43], v[24:27]
buffer_store_dwordx4 v[40:43], v1, s[16:19], s39 offen offset:3072 sc1
v_cmp_lt_u32 vcc, 0x3c000000, v12
s_nop 5
v_cmp_class_f32 s[40:41], v24, s64
s_nop 0
s_or_b64 vcc, vcc, s[40:41]
s_cmp_lg_u64 vcc, 0
s_cselect_b32 s33, 2, 0
s_or_b32 s60, s60, s33
Lk2_chk:
s_cmp_eq_u32 s60, 0
s_cbranch_scc1 Lk2_done
s_sub_u32 s56, 15, s21
s_lshl_b32 s33, s24, 1
s_lshl_b32 s61, 3, s33
s_and_b32 s34, s60, 2
s_bitcmp1_b32 s60, 0
s_cselect_b32 s56, s21, s56
s_cselect_b32 s61, 15, s61
s_cselect_b32 s60, s34, 0
s_waitcnt vmcnt(0)
s_lshl_b32 s33, s20, 7
s_lshl_b32 s34, s56, 3
s_add_u32 s33, s33, s34
s_lshl_b32 s34, s23, 2
s_add_u32 s33, s33, s34
s_lshl_b32 s33, s33, 12
buffer_load_dwordx4 a[0:3], v1, s[8:11], s33 offen offset:0 sc1
buffer_load_dwordx4 a[4:7], v1, s[8:11], s33 offen offset:1024 sc1
buffer_load_dwordx4 a[8:11], v1, s[8:11], s33 offen offset:2048 sc1
buffer_load_dwordx4 a[12:15], v1, s[8:11], s33 offen offset:3072 sc1
s_add_u32 s33, s33, 4096
buffer_load_dwordx4 a[16:19], v1, s[8:11], s33 offen offset:0 sc1
buffer_load_dwordx4 a[20:23], v1, s[8:11], s33 offen offset:1024 sc1
buffer_load_dwordx4 a[24:27], v1, s[8:11], s33 offen offset:2048 sc1
buffer_load_dwordx4 a[28:31], v1, s[8:11], s33 offen offset:3072 sc1
s_add_u32 s33, s33, 4096
buffer_load_dwordx4 a[32:35], v1, s[8:11], s33 offen offset:0 sc1
buffer_load_dwordx4 a[36:39], v1, s[8:11], s33 offen offset:1024 sc1
buffer_load_dwordx4 a[40:43], v1, s[8:11], s33 offen offset:2048 sc1
buffer_load_dwordx4 a[44:47], v1, s[8:11], s33 offen offset:3072 sc1
s_add_u32 s33, s33, 4096
buffer_load_dwordx4 a[48:51], v1, s[8:11], s33 offen offset:0 sc1
buffer_load_dwordx4 a[52:55], v1, s[8:11], s33 offen offset:1024 sc1
buffer_load_dwordx4 a[56:59], v1, s[8:11], s33 offen offset:2048 sc1
buffer_load_dwordx4 a[60:63], v1, s[8:11], s33 offen offset:3072 sc1
v_accvgpr_write_b32 a64, 0
v_accvgpr_write_b32 a65, 0
v_accvgpr_write_b32 a66, 0
v_accvgpr_write_b32 a67, 0
v_accvgpr_write_b32 a68, 0
v_accvgpr_write_b32 a69, 0
v_accvgpr_write_b32 a70, 0
v_accvgpr_write_b32 a71, 0
v_accvgpr_write_b32 a72, 0
v_accvgpr_write_b32 a73, 0
v_accvgpr_write_b32 a74, 0
v_accvgpr_write_b32 a75, 0
v_accvgpr_write_b32 a76, 0
v_accvgpr_write_b32 a77, 0
v_accvgpr_write_b32 a78, 0
v_accvgpr_write_b32 a79, 0
v_accvgpr_write_b32 a80, 0
v_accvgpr_write_b32 a81, 0
v_accvgpr_write_b32 a82, 0
v_accvgpr_write_b32 a83, 0
v_accvgpr_write_b32 a84, 0
v_accvgpr_write_b32 a85, 0
v_accvgpr_write_b32 a86, 0
v_accvgpr_write_b32 a87, 0
v_accvgpr_write_b32 a88, 0
v_accvgpr_write_b32 a89, 0
v_accvgpr_write_b32 a90, 0
v_accvgpr_write_b32 a91, 0
v_accvgpr_write_b32 a92, 0
v_accvgpr_write_b32 a93, 0
v_accvgpr_write_b32 a94, 0
v_accvgpr_write_b32 a95, 0
v_accvgpr_write_b32 a96, 0
v_accvgpr_write_b32 a97, 0
v_accvgpr_write_b32 a98, 0
v_accvgpr_write_b32 a99, 0
v_accvgpr_write_b32 a100, 0
v_accvgpr_write_b32 a101, 0
v_accvgpr_write_b32 a102, 0
v_accvgpr_write_b32 a103, 0
v_accvgpr_write_b32 a104, 0
v_accvgpr_write_b32 a105, 0
v_accvgpr_write_b32 a106, 0
v_accvgpr_write_b32 a107, 0
v_accvgpr_write_b32 a108, 0
v_accvgpr_write_b32 a109, 0
v_accvgpr_write_b32 a110, 0
v_accvgpr_write_b32 a111, 0
v_mov_b32 v160, 0
v_mov_b32 v161, 0
v_mov_b32 v162, 0
v_mov_b32 v163, 0
v_mov_b32 v164, 0
v_mov_b32 v165, 0
v_mov_b32 v166, 0
v_mov_b32 v167, 0
v_mov_b32 v168, 0
v_mov_b32 v169, 0
v_mov_b32 v170, 0
v_mov_b32 v171, 0
v_mov_b32 v172, 0
v_mov_b32 v173, 0
v_mov_b32 v174, 0
v_mov_b32 v175, 0
v_mov_b32 v176, 0
v_mov_b32 v177, 0
v_mov_b32 v178, 0
v_mov_b32 v179, 0
v_mov_b32 v180, 0
v_mov_b32 v181, 0
v_mov_b32 v182, 0
v_mov_b32 v183, 0
v_mov_b32 v184, 0
v_mov_b32 v185, 0
v_mov_b32 v186, 0
v_mov_b32 v187, 0
v_mov_b32 v188, 0
v_mov_b32 v189, 0
v_mov_b32 v190, 0
v_mov_b32 v191, 0
v_mov_b32 v192, 0
v_mov_b32 v193, 0
v_mov_b32 v194, 0
v_mov_b32 v195, 0
v_mov_b32 v196, 0
v_mov_b32 v197, 0
v_mov_b32 v198, 0
v_mov_b32 v199, 0
v_mov_b32 v200, 0
v_mov_b32 v201, 0
v_mov_b32 v202, 0
v_mov_b32 v203, 0
v_mov_b32 v204, 0
v_mov_b32 v205, 0
v_mov_b32 v206, 0
v_mov_b32 v207, 0
v_mov_b32 v208, 0
v_mov_b32 v209, 0
v_mov_b32 v210, 0
v_mov_b32 v211, 0
v_mov_b32 v212, 0
v_mov_b32 v213, 0
v_mov_b32 v214, 0
v_mov_b32 v215, 0
v_mov_b32 v216, 0
v_mov_b32 v217, 0
v_mov_b32 v218, 0
v_mov_b32 v219, 0
v_mov_b32 v220, 0
v_mov_b32 v221, 0
v_mov_b32 v222, 0
v_mov_b32 v223, 0
v_mov_b32 v224, 0
v_mov_b32 v225, 0
v_mov_b32 v226, 0
v_mov_b32 v227, 0
v_mov_b32 v228, 0
v_mov_b32 v229, 0
v_mov_b32 v230, 0
v_mov_b32 v231, 0
v_mov_b32 v232, 0
v_mov_b32 v233, 0
v_mov_b32 v234, 0
v_mov_b32 v235, 0
v_mov_b32 v236, 0
v_mov_b32 v237, 0
v_mov_b32 v238, 0
v_mov_b32 v239, 0
v_mov_b32 v240, 0
v_mov_b32 v241, 0
v_mov_b32 v242, 0
v_mov_b32 v243, 0
v_mov_b32 v244, 0
v_mov_b32 v245, 0
v_mov_b32 v246, 0
v_mov_b32 v247, 0
v_mov_b32 v248, 0
v_mov_b32 v249, 0
v_mov_b32 v250, 0
v_mov_b32 v251, 0
v_mov_b32 v252, 0
v_mov_b32 v253, 0
v_mov_b32 v254, 0
v_mov_b32 v255, 0
v_mov_b32 v8, v4
v_mov_b32 v9, v4
v_mov_b32 v10, v4
v_mov_b32 v11, v4
s_lshl_b32 s57, s20, 20
s_lshl_b32 s58, s56, 7
s_lshl_b32 s59, s56, 1
s_add_u32 s59, s59, 2
Lslow_2:
s_add_u32 s35, s57, 0
buffer_load_dwordx4 v[96:99], v1, s[12:15], s35 offen offset:0 sc1
buffer_load_dwordx4 v[100:103], v1, s[12:15], s35 offen offset:1024 sc1
buffer_load_dwordx4 v[104:107], v1, s[12:15], s35 offen offset:2048 sc1
buffer_load_dwordx4 v[108:111], v1, s[12:15], s35 offen offset:3072 sc1
s_add_u32 s35, s57, 4096
buffer_load_dwordx4 v[112:115], v1, s[12:15], s35 offen offset:0 sc1
buffer_load_dwordx4 v[116:119], v1, s[12:15], s35 offen offset:1024 sc1
buffer_load_dwordx4 v[120:123], v1, s[12:15], s35 offen offset:2048 sc1
buffer_load_dwordx4 v[124:127], v1, s[12:15], s35 offen offset:3072 sc1
s_add_u32 s35, s57, 8192
buffer_load_dwordx4 v[128:131], v1, s[12:15], s35 offen offset:0 sc1
buffer_load_dwordx4 v[132:135], v1, s[12:15], s35 offen offset:1024 sc1
buffer_load_dwordx4 v[136:139], v1, s[12:15], s35 offen offset:2048 sc1
buffer_load_dwordx4 v[140:143], v1, s[12:15], s35 offen offset:3072 sc1
s_add_u32 s35, s57, 12288
buffer_load_dwordx4 v[144:147], v1, s[12:15], s35 offen offset:0 sc1
buffer_load_dwordx4 v[148:151], v1, s[12:15], s35 offen offset:1024 sc1
buffer_load_dwordx4 v[152:155], v1, s[12:15], s35 offen offset:2048 sc1
buffer_load_dwordx4 v[156:159], v1, s[12:15], s35 offen offset:3072 sc1
s_lshl_b32 s33, s23, 6
s_add_i32 s33, s33, s58
s_cmp_gt_i32 s33, 0
s_cselect_b32 s34, 0, 0xf149f2ca
s_cmp_lt_i32 s33, 0
s_cselect_b32 s33, 0xf149f2ca, 0
v_mov_b32 v20, s34
v_mov_b32 v21, s34
v_mov_b32 v22, s34
v_mov_b32 v23, s34
v_mov_b32 v28, s33
v_mov_b32 v29, s33
v_mov_b32 v30, s33
v_mov_b32 v31, s33
v_med3_f32 v24, v16, v20, v28
v_med3_f32 v25, v17, v20, v28
v_med3_f32 v26, v18, v20, v28
v_med3_f32 v27, v19, v20, v28
s_waitcnt vmcnt(0)
s_nop 0
M v[32:35], v[96:99], a[0:3], v[24:27]
M v[32:35], v[100:103], a[4:7], v[32:35]
M v[32:35], v[104:107], a[8:11], v[32:35]
M v[32:35], v[108:111], a[12:15], v[32:35]
M v[36:39], v[96:99], a[16:19], v[28:31]
M v[36:39], v[100:103], a[20:23], v[36:39]
M v[36:39], v[104:107], a[24:27], v[36:39]
M v[36:39], v[108:111], a[28:31], v[36:39]
M v[40:43], v[96:99], a[32:35], v[28:31]
M v[40:43], v[100:103], a[36:39], v[40:43]
M v[40:43], v[104:107], a[40:43], v[40:43]
M v[40:43], v[108:111], a[44:47], v[40:43]
M v[44:47], v[96:99], a[48:51], v[28:31]
M v[44:47], v[100:103], a[52:55], v[44:47]
M v[44:47], v[104:107], a[56:59], v[44:47]
M v[44:47], v[108:111], a[60:63], v[44:47]
M v[48:51], v[112:115], a[0:3], v[20:23]
M v[48:51], v[116:119], a[4:7], v[48:51]
M v[48:51], v[120:123], a[8:11], v[48:51]
M v[48:51], v[124:127], a[12:15], v[48:51]
M v[52:55], v[112:115], a[16:19], v[24:27]
M v[52:55], v[116:119], a[20:23], v[52:55]
M v[52:55], v[120:123], a[24:27], v[52:55]
M v[52:55], v[124:127], a[28:31], v[52:55]
M v[56:59], v[112:115], a[32:35], v[28:31]
M v[56:59], v[116:119], a[36:39], v[56:59]
M v[56:59], v[120:123], a[40:43], v[56:59]
M v[56:59], v[124:127], a[44:47], v[56:59]
M v[60:63], v[112:115], a[48:51], v[28:31]
M v[60:63], v[116:119], a[52:55], v[60:63]
M v[60:63], v[120:123], a[56:59], v[60:63]
M v[60:63], v[124:127], a[60:63], v[60:63]
M v[64:67], v[128:131], a[0:3], v[20:23]
M v[64:67], v[132:135], a[4:7], v[64:67]
M v[64:67], v[136:139], a[8:11], v[64:67]
M v[64:67], v[140:143], a[12:15], v[64:67]
M v[68:71], v[128:131], a[16:19], v[20:23]
M v[68:71], v[132:135], a[20:23], v[68:71]
M v[68:71], v[136:139], a[24:27], v[68:71]
M v[68:71], v[140:143], a[28:31], v[68:71]
M v[72:75], v[128:131], a[32:35], v[24:27]
M v[72:75], v[132:135], a[36:39], v[72:75]
M v[72:75], v[136:139], a[40:43], v[72:75]
M v[72:75], v[140:143], a[44:47], v[72:75]
M v[76:79], v[128:131], a[48:51], v[28:31]
M v[76:79], v[132:135], a[52:55], v[76:79]
M v[76:79], v[136:139], a[56:59], v[76:79]
M v[76:79], v[140:143], a[60:63], v[76:79]
M v[80:83], v[144:147], a[0:3], v[20:23]
M v[80:83], v[148:151], a[4:7], v[80:83]
M v[80:83], v[152:155], a[8:11], v[80:83]
M v[80:83], v[156:159], a[12:15], v[80:83]
M v[84:87], v[144:147], a[16:19], v[20:23]
M v[84:87], v[148:151], a[20:23], v[84:87]
M v[84:87], v[152:155], a[24:27], v[84:87]
M v[84:87], v[156:159], a[28:31], v[84:87]
M v[88:91], v[144:147], a[32:35], v[20:23]
M v[88:91], v[148:151], a[36:39], v[88:91]
M v[88:91], v[152:155], a[40:43], v[88:91]
M v[88:91], v[156:159], a[44:47], v[88:91]
M v[92:95], v[144:147], a[48:51], v[24:27]
M v[92:95], v[148:151], a[52:55], v[92:95]
M v[92:95], v[152:155], a[56:59], v[92:95]
M v[92:95], v[156:159], a[60:63], v[92:95]
s_nop 7
s_add_u32 s35, s57, 16384
buffer_load_dwordx4 v[96:99], v1, s[12:15], s35 offen offset:0 sc1
buffer_load_dwordx4 v[100:103], v1, s[12:15], s35 offen offset:1024 sc1
buffer_load_dwordx4 v[104:107], v1, s[12:15], s35 offen offset:2048 sc1
buffer_load_dwordx4 v[108:111], v1, s[12:15], s35 offen offset:3072 sc1
s_add_u32 s35, s57, 20480
buffer_load_dwordx4 v[112:115], v1, s[12:15], s35 offen offset:0 sc1
buffer_load_dwordx4 v[116:119], v1, s[12:15], s35 offen offset:1024 sc1
buffer_load_dwordx4 v[120:123], v1, s[12:15], s35 offen offset:2048 sc1
buffer_load_dwordx4 v[124:127], v1, s[12:15], s35 offen offset:3072 sc1
s_add_u32 s35, s57, 24576
buffer_load_dwordx4 v[128:131], v1, s[12:15], s35 offen offset:0 sc1
buffer_load_dwordx4 v[132:135], v1, s[12:15], s35 offen offset:1024 sc1
buffer_load_dwordx4 v[136:139], v1, s[12:15], s35 offen offset:2048 sc1
buffer_load_dwordx4 v[140:143], v1, s[12:15], s35 offen offset:3072 sc1
s_add_u32 s35, s57, 28672
buffer_load_dwordx4 v[144:147], v1, s[12:15], s35 offen offset:0 sc1
buffer_load_dwordx4 v[148:151], v1, s[12:15], s35 offen offset:1024 sc1
buffer_load_dwordx4 v[152:155], v1, s[12:15], s35 offen offset:2048 sc1
buffer_load_dwordx4 v[156:159], v1, s[12:15], s35 offen offset:3072 sc1
v_max3_f32 v13, v32, v33, v8
v_max3_f32 v13, v13, v34, v35
v_max3_f32 v13, v13, v48, v49
v_max3_f32 v13, v13, v50, v51
v_max3_f32 v13, v13, v64, v65
v_max3_f32 v13, v13, v66, v67
v_max3_f32 v13, v13, v80, v81
v_max3_f32 v13, v13, v82, v83
v_mov_b32 v14, v13
s_nop 1
v_permlane16_swap_b32 v13, v14
v_max_f32 v13, v13, v14
v_mov_b32 v14, v13
s_nop 1
v_permlane32_swap_b32 v13, v14
v_max_f32 v13, v13, v14
v_sub_f32 v12, v8, v13
v_exp_f32 v12, v12
v_mov_b32 v8, v13
v_sub_f32 v32, v32, v13
v_sub_f32 v33, v33, v13
v_sub_f32 v34, v34, v13
v_sub_f32 v35, v35, v13
v_sub_f32 v48, v48, v13
v_sub_f32 v49, v49, v13
v_sub_f32 v50, v50, v13
v_sub_f32 v51, v51, v13
v_sub_f32 v64, v64, v13
v_sub_f32 v65, v65, v13
v_sub_f32 v66, v66, v13
v_sub_f32 v67, v67, v13
v_sub_f32 v80, v80, v13
v_sub_f32 v81, v81, v13
v_sub_f32 v82, v82, v13
v_sub_f32 v83, v83, v13
v_mul_f32 v160, v160, v12
v_mul_f32 v161, v161, v12
v_mul_f32 v162, v162, v12
v_mul_f32 v163, v163, v12
v_mul_f32 v176, v176, v12
v_mul_f32 v177, v177, v12
v_mul_f32 v178, v178, v12
v_mul_f32 v179, v179, v12
v_mul_f32 v192, v192, v12
v_mul_f32 v193, v193, v12
v_mul_f32 v194, v194, v12
v_mul_f32 v195, v195, v12
v_mul_f32 v208, v208, v12
v_mul_f32 v209, v209, v12
v_mul_f32 v210, v210, v12
v_mul_f32 v211, v211, v12
v_mul_f32 v224, v224, v12
v_mul_f32 v225, v225, v12
v_mul_f32 v226, v226, v12
v_mul_f32 v227, v227, v12
v_mul_f32 v240, v240, v12
v_mul_f32 v241, v241, v12
v_mul_f32 v242, v242, v12
v_mul_f32 v243, v243, v12
v_accvgpr_read_b32 v14, a64
v_mul_f32 v14, v14, v12
v_accvgpr_write_b32 a64, v14
v_accvgpr_read_b32 v14, a65
v_mul_f32 v14, v14, v12
v_accvgpr_write_b32 a65, v14
v_accvgpr_read_b32 v14, a66
v_mul_f32 v14, v14, v12
v_accvgpr_write_b32 a66, v14
v_accvgpr_read_b32 v14, a67
v_mul_f32 v14, v14, v12
v_accvgpr_write_b32 a67, v14
v_accvgpr_read_b32 v14, a80
v_mul_f32 v14, v14, v12
v_accvgpr_write_b32 a80, v14
v_accvgpr_read_b32 v14, a81
v_mul_f32 v14, v14, v12
v_accvgpr_write_b32 a81, v14
v_accvgpr_read_b32 v14, a82
v_mul_f32 v14, v14, v12
v_accvgpr_write_b32 a82, v14
v_accvgpr_read_b32 v14, a83
v_mul_f32 v14, v14, v12
v_accvgpr_write_b32 a83, v14
v_accvgpr_read_b32 v14, a96
v_mul_f32 v14, v14, v12
v_accvgpr_write_b32 a96, v14
v_accvgpr_read_b32 v14, a97
v_mul_f32 v14, v14, v12
v_accvgpr_write_b32 a97, v14
v_accvgpr_read_b32 v14, a98
v_mul_f32 v14, v14, v12
v_accvgpr_write_b32 a98, v14
v_accvgpr_read_b32 v14, a99
v_mul_f32 v14, v14, v12
v_accvgpr_write_b32 a99, v14
v_max3_f32 v13, v36, v37, v9
v_max3_f32 v13, v13, v38, v39
v_max3_f32 v13, v13, v52, v53
v_max3_f32 v13, v13, v54, v55
v_max3_f32 v13, v13, v68, v69
v_max3_f32 v13, v13, v70, v71
v_max3_f32 v13, v13, v84, v85
v_max3_f32 v13, v13, v86, v87
v_mov_b32 v14, v13
s_nop 1
v_permlane16_swap_b32 v13, v14
v_max_f32 v13, v13, v14
v_mov_b32 v14, v13
s_nop 1
v_permlane32_swap_b32 v13, v14
v_max_f32 v13, v13, v14
v_sub_f32 v12, v9, v13
v_exp_f32 v12, v12
v_mov_b32 v9, v13
v_sub_f32 v36, v36, v13
v_sub_f32 v37, v37, v13
v_sub_f32 v38, v38, v13
v_sub_f32 v39, v39, v13
v_sub_f32 v52, v52, v13
v_sub_f32 v53, v53, v13
v_sub_f32 v54, v54, v13
v_sub_f32 v55, v55, v13
v_sub_f32 v68, v68, v13
v_sub_f32 v69, v69, v13
v_sub_f32 v70, v70, v13
v_sub_f32 v71, v71, v13
v_sub_f32 v84, v84, v13
v_sub_f32 v85, v85, v13
v_sub_f32 v86, v86, v13
v_sub_f32 v87, v87, v13
v_mul_f32 v164, v164, v12
v_mul_f32 v165, v165, v12
v_mul_f32 v166, v166, v12
v_mul_f32 v167, v167, v12
v_mul_f32 v180, v180, v12
v_mul_f32 v181, v181, v12
v_mul_f32 v182, v182, v12
v_mul_f32 v183, v183, v12
v_mul_f32 v196, v196, v12
v_mul_f32 v197, v197, v12
v_mul_f32 v198, v198, v12
v_mul_f32 v199, v199, v12
v_mul_f32 v212, v212, v12
v_mul_f32 v213, v213, v12
v_mul_f32 v214, v214, v12
v_mul_f32 v215, v215, v12
v_mul_f32 v228, v228, v12
v_mul_f32 v229, v229, v12
v_mul_f32 v230, v230, v12
v_mul_f32 v231, v231, v12
v_mul_f32 v244, v244, v12
v_mul_f32 v245, v245, v12
v_mul_f32 v246, v246, v12
v_mul_f32 v247, v247, v12
v_accvgpr_read_b32 v14, a68
v_mul_f32 v14, v14, v12
v_accvgpr_write_b32 a68, v14
v_accvgpr_read_b32 v14, a69
v_mul_f32 v14, v14, v12
v_accvgpr_write_b32 a69, v14
v_accvgpr_read_b32 v14, a70
v_mul_f32 v14, v14, v12
v_accvgpr_write_b32 a70, v14
v_accvgpr_read_b32 v14, a71
v_mul_f32 v14, v14, v12
v_accvgpr_write_b32 a71, v14
v_accvgpr_read_b32 v14, a84
v_mul_f32 v14, v14, v12
v_accvgpr_write_b32 a84, v14
v_accvgpr_read_b32 v14, a85
v_mul_f32 v14, v14, v12
v_accvgpr_write_b32 a85, v14
v_accvgpr_read_b32 v14, a86
v_mul_f32 v14, v14, v12
v_accvgpr_write_b32 a86, v14
v_accvgpr_read_b32 v14, a87
v_mul_f32 v14, v14, v12
v_accvgpr_write_b32 a87, v14
v_accvgpr_read_b32 v14, a100
v_mul_f32 v14, v14, v12
v_accvgpr_write_b32 a100, v14
v_accvgpr_read_b32 v14, a101
v_mul_f32 v14, v14, v12
v_accvgpr_write_b32 a101, v14
v_accvgpr_read_b32 v14, a102
v_mul_f32 v14, v14, v12
v_accvgpr_write_b32 a102, v14
v_accvgpr_read_b32 v14, a103
v_mul_f32 v14, v14, v12
v_accvgpr_write_b32 a103, v14
v_max3_f32 v13, v40, v41, v10
v_max3_f32 v13, v13, v42, v43
v_max3_f32 v13, v13, v56, v57
v_max3_f32 v13, v13, v58, v59
v_max3_f32 v13, v13, v72, v73
v_max3_f32 v13, v13, v74, v75
v_max3_f32 v13, v13, v88, v89
v_max3_f32 v13, v13, v90, v91
v_mov_b32 v14, v13
s_nop 1
v_permlane16_swap_b32 v13, v14
v_max_f32 v13, v13, v14
v_mov_b32 v14, v13
s_nop 1
v_permlane32_swap_b32 v13, v14
v_max_f32 v13, v13, v14
v_sub_f32 v12, v10, v13
v_exp_f32 v12, v12
v_mov_b32 v10, v13
v_sub_f32 v40, v40, v13
v_sub_f32 v41, v41, v13
v_sub_f32 v42, v42, v13
v_sub_f32 v43, v43, v13
v_sub_f32 v56, v56, v13
v_sub_f32 v57, v57, v13
v_sub_f32 v58, v58, v13
v_sub_f32 v59, v59, v13
v_sub_f32 v72, v72, v13
v_sub_f32 v73, v73, v13
v_sub_f32 v74, v74, v13
v_sub_f32 v75, v75, v13
v_sub_f32 v88, v88, v13
v_sub_f32 v89, v89, v13
v_sub_f32 v90, v90, v13
v_sub_f32 v91, v91, v13
v_mul_f32 v168, v168, v12
v_mul_f32 v169, v169, v12
v_mul_f32 v170, v170, v12
v_mul_f32 v171, v171, v12
v_mul_f32 v184, v184, v12
v_mul_f32 v185, v185, v12
v_mul_f32 v186, v186, v12
v_mul_f32 v187, v187, v12
v_mul_f32 v200, v200, v12
v_mul_f32 v201, v201, v12
v_mul_f32 v202, v202, v12
v_mul_f32 v203, v203, v12
v_mul_f32 v216, v216, v12
v_mul_f32 v217, v217, v12
v_mul_f32 v218, v218, v12
v_mul_f32 v219, v219, v12
v_mul_f32 v232, v232, v12
v_mul_f32 v233, v233, v12
v_mul_f32 v234, v234, v12
v_mul_f32 v235, v235, v12
v_mul_f32 v248, v248, v12
v_mul_f32 v249, v249, v12
v_mul_f32 v250, v250, v12
v_mul_f32 v251, v251, v12
v_accvgpr_read_b32 v14, a72
v_mul_f32 v14, v14, v12
v_accvgpr_write_b32 a72, v14
v_accvgpr_read_b32 v14, a73
v_mul_f32 v14, v14, v12
v_accvgpr_write_b32 a73, v14
v_accvgpr_read_b32 v14, a74
v_mul_f32 v14, v14, v12
v_accvgpr_write_b32 a74, v14
v_accvgpr_read_b32 v14, a75
v_mul_f32 v14, v14, v12
v_accvgpr_write_b32 a75, v14
v_accvgpr_read_b32 v14, a88
v_mul_f32 v14, v14, v12
v_accvgpr_write_b32 a88, v14
v_accvgpr_read_b32 v14, a89
v_mul_f32 v14, v14, v12
v_accvgpr_write_b32 a89, v14
v_accvgpr_read_b32 v14, a90
v_mul_f32 v14, v14, v12
v_accvgpr_write_b32 a90, v14
v_accvgpr_read_b32 v14, a91
v_mul_f32 v14, v14, v12
v_accvgpr_write_b32 a91, v14
v_accvgpr_read_b32 v14, a104
v_mul_f32 v14, v14, v12
v_accvgpr_write_b32 a104, v14
v_accvgpr_read_b32 v14, a105
v_mul_f32 v14, v14, v12
v_accvgpr_write_b32 a105, v14
v_accvgpr_read_b32 v14, a106
v_mul_f32 v14, v14, v12
v_accvgpr_write_b32 a106, v14
v_accvgpr_read_b32 v14, a107
v_mul_f32 v14, v14, v12
v_accvgpr_write_b32 a107, v14
v_max3_f32 v13, v44, v45, v11
v_max3_f32 v13, v13, v46, v47
v_max3_f32 v13, v13, v60, v61
v_max3_f32 v13, v13, v62, v63
v_max3_f32 v13, v13, v76, v77
v_max3_f32 v13, v13, v78, v79
v_max3_f32 v13, v13, v92, v93
v_max3_f32 v13, v13, v94, v95
v_mov_b32 v14, v13
s_nop 1
v_permlane16_swap_b32 v13, v14
v_max_f32 v13, v13, v14
v_mov_b32 v14, v13
s_nop 1
v_permlane32_swap_b32 v13, v14
v_max_f32 v13, v13, v14
v_sub_f32 v12, v11, v13
v_exp_f32 v12, v12
v_mov_b32 v11, v13
v_sub_f32 v44, v44, v13
v_sub_f32 v45, v45, v13
v_sub_f32 v46, v46, v13
v_sub_f32 v47, v47, v13
v_sub_f32 v60, v60, v13
v_sub_f32 v61, v61, v13
v_sub_f32 v62, v62, v13
v_sub_f32 v63, v63, v13
v_sub_f32 v76, v76, v13
v_sub_f32 v77, v77, v13
v_sub_f32 v78, v78, v13
v_sub_f32 v79, v79, v13
v_sub_f32 v92, v92, v13
v_sub_f32 v93, v93, v13
v_sub_f32 v94, v94, v13
v_sub_f32 v95, v95, v13
v_mul_f32 v172, v172, v12
v_mul_f32 v173, v173, v12
v_mul_f32 v174, v174, v12
v_mul_f32 v175, v175, v12
v_mul_f32 v188, v188, v12
v_mul_f32 v189, v189, v12
v_mul_f32 v190, v190, v12
v_mul_f32 v191, v191, v12
v_mul_f32 v204, v204, v12
v_mul_f32 v205, v205, v12
v_mul_f32 v206, v206, v12
v_mul_f32 v207, v207, v12
v_mul_f32 v220, v220, v12
v_mul_f32 v221, v221, v12
v_mul_f32 v222, v222, v12
v_mul_f32 v223, v223, v12
v_mul_f32 v236, v236, v12
v_mul_f32 v237, v237, v12
v_mul_f32 v238, v238, v12
v_mul_f32 v239, v239, v12
v_mul_f32 v252, v252, v12
v_mul_f32 v253, v253, v12
v_mul_f32 v254, v254, v12
v_mul_f32 v255, v255, v12
v_accvgpr_read_b32 v14, a76
v_mul_f32 v14, v14, v12
v_accvgpr_write_b32 a76, v14
v_accvgpr_read_b32 v14, a77
v_mul_f32 v14, v14, v12
v_accvgpr_write_b32 a77, v14
v_accvgpr_read_b32 v14, a78
v_mul_f32 v14, v14, v12
v_accvgpr_write_b32 a78, v14
v_accvgpr_read_b32 v14, a79
v_mul_f32 v14, v14, v12
v_accvgpr_write_b32 a79, v14
v_accvgpr_read_b32 v14, a92
v_mul_f32 v14, v14, v12
v_accvgpr_write_b32 a92, v14
v_accvgpr_read_b32 v14, a93
v_mul_f32 v14, v14, v12
v_accvgpr_write_b32 a93, v14
v_accvgpr_read_b32 v14, a94
v_mul_f32 v14, v14, v12
v_accvgpr_write_b32 a94, v14
v_accvgpr_read_b32 v14, a95
v_mul_f32 v14, v14, v12
v_accvgpr_write_b32 a95, v14
v_accvgpr_read_b32 v14, a108
v_mul_f32 v14, v14, v12
v_accvgpr_write_b32 a108, v14
v_accvgpr_read_b32 v14, a109
v_mul_f32 v14, v14, v12
v_accvgpr_write_b32 a109, v14
v_accvgpr_read_b32 v14, a110
v_mul_f32 v14, v14, v12
v_accvgpr_write_b32 a110, v14
v_accvgpr_read_b32 v14, a111
v_mul_f32 v14, v14, v12
v_accvgpr_write_b32 a111, v14
v_exp_f32 v32, v32
v_exp_f32 v33, v33
v_exp_f32 v34, v34
v_exp_f32 v35, v35
v_exp_f32 v48, v48
v_exp_f32 v49, v49
v_exp_f32 v50, v50
v_exp_f32 v51, v51
v_cvt_pk_bf16_f32 v32, v32, v33
v_cvt_pk_bf16_f32 v33, v34, v35
v_exp_f32 v36, v36
v_exp_f32 v37, v37
v_exp_f32 v38, v38
v_exp_f32 v39, v39
v_cvt_pk_bf16_f32 v34, v48, v49
v_cvt_pk_bf16_f32 v35, v50, v51
v_exp_f32 v52, v52
v_exp_f32 v53, v53
v_exp_f32 v54, v54
v_exp_f32 v55, v55
v_cvt_pk_bf16_f32 v36, v36, v37
v_cvt_pk_bf16_f32 v37, v38, v39
v_exp_f32 v40, v40
v_exp_f32 v41, v41
v_exp_f32 v42, v42
v_exp_f32 v43, v43
v_cvt_pk_bf16_f32 v38, v52, v53
v_cvt_pk_bf16_f32 v39, v54, v55
v_exp_f32 v56, v56
v_exp_f32 v57, v57
v_exp_f32 v58, v58
v_exp_f32 v59, v59
v_cvt_pk_bf16_f32 v40, v40, v41
v_cvt_pk_bf16_f32 v41, v42, v43
v_exp_f32 v44, v44
v_exp_f32 v45, v45
v_exp_f32 v46, v46
v_exp_f32 v47, v47
v_cvt_pk_bf16_f32 v42, v56, v57
v_cvt_pk_bf16_f32 v43, v58, v59
v_exp_f32 v60, v60
v_exp_f32 v61, v61
v_exp_f32 v62, v62
v_exp_f32 v63, v63
v_cvt_pk_bf16_f32 v44, v44, v45
v_cvt_pk_bf16_f32 v45, v46, v47
v_cvt_pk_bf16_f32 v46, v60, v61
v_cvt_pk_bf16_f32 v47, v62, v63
v_exp_f32 v64, v64
v_exp_f32 v65, v65
v_exp_f32 v66, v66
v_exp_f32 v67, v67
v_exp_f32 v80, v80
v_exp_f32 v81, v81
v_exp_f32 v82, v82
v_exp_f32 v83, v83
v_cvt_pk_bf16_f32 v64, v64, v65
v_cvt_pk_bf16_f32 v65, v66, v67
v_exp_f32 v68, v68
v_exp_f32 v69, v69
v_exp_f32 v70, v70
v_exp_f32 v71, v71
v_cvt_pk_bf16_f32 v66, v80, v81
v_cvt_pk_bf16_f32 v67, v82, v83
v_exp_f32 v84, v84
v_exp_f32 v85, v85
v_exp_f32 v86, v86
v_exp_f32 v87, v87
v_cvt_pk_bf16_f32 v68, v68, v69
v_cvt_pk_bf16_f32 v69, v70, v71
v_exp_f32 v72, v72
v_exp_f32 v73, v73
v_exp_f32 v74, v74
v_exp_f32 v75, v75
v_cvt_pk_bf16_f32 v70, v84, v85
v_cvt_pk_bf16_f32 v71, v86, v87
v_exp_f32 v88, v88
v_exp_f32 v89, v89
v_exp_f32 v90, v90
v_exp_f32 v91, v91
v_cvt_pk_bf16_f32 v72, v72, v73
v_cvt_pk_bf16_f32 v73, v74, v75
v_exp_f32 v76, v76
v_exp_f32 v77, v77
v_exp_f32 v78, v78
v_exp_f32 v79, v79
v_cvt_pk_bf16_f32 v74, v88, v89
v_cvt_pk_bf16_f32 v75, v90, v91
v_exp_f32 v92, v92
v_exp_f32 v93, v93
v_exp_f32 v94, v94
v_exp_f32 v95, v95
v_cvt_pk_bf16_f32 v76, v76, v77
v_cvt_pk_bf16_f32 v77, v78, v79
v_cvt_pk_bf16_f32 v78, v92, v93
v_cvt_pk_bf16_f32 v79, v94, v95
s_waitcnt vmcnt(0)
M a[96:99], a[112:115], v[32:35], a[96:99]
M a[100:103], a[112:115], v[36:39], a[100:103]
M a[104:107], a[112:115], v[40:43], a[104:107]
M a[108:111], a[112:115], v[44:47], a[108:111]
M v[160:163], v[96:99], v[32:35], v[160:163]
M v[164:167], v[96:99], v[36:39], v[164:167]
M v[168:171], v[96:99], v[40:43], v[168:171]
M v[172:175], v[96:99], v[44:47], v[172:175]
M v[176:179], v[100:103], v[32:35], v[176:179]
M v[180:183], v[100:103], v[36:39], v[180:183]
M v[184:187], v[100:103], v[40:43], v[184:187]
M v[188:191], v[100:103], v[44:47], v[188:191]
M v[192:195], v[104:107], v[32:35], v[192:195]
M v[196:199], v[104:107], v[36:39], v[196:199]
M v[200:203], v[104:107], v[40:43], v[200:203]
M v[204:207], v[104:107], v[44:47], v[204:207]
M v[208:211], v[108:111], v[32:35], v[208:211]
M v[212:215], v[108:111], v[36:39], v[212:215]
M v[216:219], v[108:111], v[40:43], v[216:219]
M v[220:223], v[108:111], v[44:47], v[220:223]
M v[224:227], v[112:115], v[32:35], v[224:227]
M v[228:231], v[112:115], v[36:39], v[228:231]
M v[232:235], v[112:115], v[40:43], v[232:235]
M v[236:239], v[112:115], v[44:47], v[236:239]
M v[240:243], v[116:119], v[32:35], v[240:243]
M v[244:247], v[116:119], v[36:39], v[244:247]
M v[248:251], v[116:119], v[40:43], v[248:251]
M v[252:255], v[116:119], v[44:47], v[252:255]
M a[64:67], v[120:123], v[32:35], a[64:67]
M a[68:71], v[120:123], v[36:39], a[68:71]
M a[72:75], v[120:123], v[40:43], a[72:75]
M a[76:79], v[120:123], v[44:47], a[76:79]
M a[80:83], v[124:127], v[32:35], a[80:83]
M a[84:87], v[124:127], v[36:39], a[84:87]
M a[88:91], v[124:127], v[40:43], a[88:91]
M a[92:95], v[124:127], v[44:47], a[92:95]
M a[96:99], a[112:115], v[64:67], a[96:99]
M a[100:103], a[112:115], v[68:71], a[100:103]
M a[104:107], a[112:115], v[72:75], a[104:107]
M a[108:111], a[112:115], v[76:79], a[108:111]
M v[160:163], v[128:131], v[64:67], v[160:163]
M v[164:167], v[128:131], v[68:71], v[164:167]
M v[168:171], v[128:131], v[72:75], v[168:171]
M v[172:175], v[128:131], v[76:79], v[172:175]
M v[176:179], v[132:135], v[64:67], v[176:179]
M v[180:183], v[132:135], v[68:71], v[180:183]
M v[184:187], v[132:135], v[72:75], v[184:187]
M v[188:191], v[132:135], v[76:79], v[188:191]
M v[192:195], v[136:139], v[64:67], v[192:195]
M v[196:199], v[136:139], v[68:71], v[196:199]
M v[200:203], v[136:139], v[72:75], v[200:203]
M v[204:207], v[136:139], v[76:79], v[204:207]
M v[208:211], v[140:143], v[64:67], v[208:211]
M v[212:215], v[140:143], v[68:71], v[212:215]
M v[216:219], v[140:143], v[72:75], v[216:219]
M v[220:223], v[140:143], v[76:79], v[220:223]
M v[224:227], v[144:147], v[64:67], v[224:227]
M v[228:231], v[144:147], v[68:71], v[228:231]
M v[232:235], v[144:147], v[72:75], v[232:235]
M v[236:239], v[144:147], v[76:79], v[236:239]
M v[240:243], v[148:151], v[64:67], v[240:243]
M v[244:247], v[148:151], v[68:71], v[244:247]
M v[248:251], v[148:151], v[72:75], v[248:251]
M v[252:255], v[148:151], v[76:79], v[252:255]
M a[64:67], v[152:155], v[64:67], a[64:67]
M a[68:71], v[152:155], v[68:71], a[68:71]
M a[72:75], v[152:155], v[72:75], a[72:75]
M a[76:79], v[152:155], v[76:79], a[76:79]
M a[80:83], v[156:159], v[64:67], a[80:83]
M a[84:87], v[156:159], v[68:71], a[84:87]
M a[88:91], v[156:159], v[72:75], a[88:91]
M a[92:95], v[156:159], v[76:79], a[92:95]
s_nop 7
s_add_u32 s57, s57, 32768
s_sub_u32 s58, s58, 64
s_sub_u32 s59, s59, 1
s_cmp_lg_u32 s59, 0
s_cbranch_scc1 Lslow_2
v_accvgpr_read_b32 v20, a96
v_accvgpr_read_b32 v21, a100
v_accvgpr_read_b32 v22, a104
v_accvgpr_read_b32 v23, a108
v_rcp_f32 v8, v20
v_rcp_f32 v9, v21
v_rcp_f32 v10, v22
v_rcp_f32 v11, v23
s_lshl_b32 s33, s56, 20
s_lshl_b32 s34, s20, 15
s_add_u32 s33, s33, s34
s_lshl_b32 s34, s23, 13
s_add_u32 s36, s33, s34
s_add_u32 s37, s36, 4096
s_add_u32 s38, s36, 16384
s_add_u32 s39, s36, 20480
v_pk_mul_f32 v[160:161], v[160:161], v[8:9] op_sel:[0,0] op_sel_hi:[1,0]
v_pk_mul_f32 v[162:163], v[162:163], v[8:9] op_sel:[0,0] op_sel_hi:[1,0]
v_pk_mul_f32 v[176:177], v[176:177], v[8:9] op_sel:[0,0] op_sel_hi:[1,0]
v_pk_mul_f32 v[178:179], v[178:179], v[8:9] op_sel:[0,0] op_sel_hi:[1,0]
v_cvt_pk_bf16_f32 v160, v160, v161
v_cvt_pk_bf16_f32 v161, v162, v163
v_cvt_pk_bf16_f32 v162, v176, v177
v_cvt_pk_bf16_f32 v163, v178, v179
v_pk_mul_f32 v[164:165], v[164:165], v[8:9] op_sel:[0,1] op_sel_hi:[1,1]
v_pk_mul_f32 v[166:167], v[166:167], v[8:9] op_sel:[0,1] op_sel_hi:[1,1]
v_pk_mul_f32 v[180:181], v[180:181], v[8:9] op_sel:[0,1] op_sel_hi:[1,1]
v_pk_mul_f32 v[182:183], v[182:183], v[8:9] op_sel:[0,1] op_sel_hi:[1,1]
v_cvt_pk_bf16_f32 v164, v164, v165
v_cvt_pk_bf16_f32 v165, v166, v167
v_cvt_pk_bf16_f32 v166, v180, v181
v_cvt_pk_bf16_f32 v167, v182, v183
v_pk_mul_f32 v[168:169], v[168:169], v[10:11] op_sel:[0,0] op_sel_hi:[1,0]
v_pk_mul_f32 v[170:171], v[170:171], v[10:11] op_sel:[0,0] op_sel_hi:[1,0]
v_pk_mul_f32 v[184:185], v[184:185], v[10:11] op_sel:[0,0] op_sel_hi:[1,0]
v_pk_mul_f32 v[186:187], v[186:187], v[10:11] op_sel:[0,0] op_sel_hi:[1,0]
v_cvt_pk_bf16_f32 v168, v168, v169
v_cvt_pk_bf16_f32 v169, v170, v171
v_cvt_pk_bf16_f32 v170, v184, v185
v_cvt_pk_bf16_f32 v171, v186, v187
v_pk_mul_f32 v[172:173], v[172:173], v[10:11] op_sel:[0,1] op_sel_hi:[1,1]
v_pk_mul_f32 v[174:175], v[174:175], v[10:11] op_sel:[0,1] op_sel_hi:[1,1]
v_pk_mul_f32 v[188:189], v[188:189], v[10:11] op_sel:[0,1] op_sel_hi:[1,1]
v_pk_mul_f32 v[190:191], v[190:191], v[10:11] op_sel:[0,1] op_sel_hi:[1,1]
v_cvt_pk_bf16_f32 v172, v172, v173
v_cvt_pk_bf16_f32 v173, v174, v175
v_cvt_pk_bf16_f32 v174, v188, v189
v_cvt_pk_bf16_f32 v175, v190, v191
v_pk_mul_f32 v[192:193], v[192:193], v[8:9] op_sel:[0,0] op_sel_hi:[1,0]
v_pk_mul_f32 v[194:195], v[194:195], v[8:9] op_sel:[0,0] op_sel_hi:[1,0]
v_pk_mul_f32 v[208:209], v[208:209], v[8:9] op_sel:[0,0] op_sel_hi:[1,0]
v_pk_mul_f32 v[210:211], v[210:211], v[8:9] op_sel:[0,0] op_sel_hi:[1,0]
v_cvt_pk_bf16_f32 v192, v192, v193
v_cvt_pk_bf16_f32 v193, v194, v195
v_cvt_pk_bf16_f32 v194, v208, v209
v_cvt_pk_bf16_f32 v195, v210, v211
v_pk_mul_f32 v[196:197], v[196:197], v[8:9] op_sel:[0,1] op_sel_hi:[1,1]
v_pk_mul_f32 v[198:199], v[198:199], v[8:9] op_sel:[0,1] op_sel_hi:[1,1]
v_pk_mul_f32 v[212:213], v[212:213], v[8:9] op_sel:[0,1] op_sel_hi:[1,1]
v_pk_mul_f32 v[214:215], v[214:215], v[8:9] op_sel:[0,1] op_sel_hi:[1,1]
v_cvt_pk_bf16_f32 v196, v196, v197
v_cvt_pk_bf16_f32 v197, v198, v199
v_cvt_pk_bf16_f32 v198, v212, v213
v_cvt_pk_bf16_f32 v199, v214, v215
v_pk_mul_f32 v[200:201], v[200:201], v[10:11] op_sel:[0,0] op_sel_hi:[1,0]
v_pk_mul_f32 v[202:203], v[202:203], v[10:11] op_sel:[0,0] op_sel_hi:[1,0]
v_pk_mul_f32 v[216:217], v[216:217], v[10:11] op_sel:[0,0] op_sel_hi:[1,0]
v_pk_mul_f32 v[218:219], v[218:219], v[10:11] op_sel:[0,0] op_sel_hi:[1,0]
v_cvt_pk_bf16_f32 v200, v200, v201
v_cvt_pk_bf16_f32 v201, v202, v203
v_cvt_pk_bf16_f32 v202, v216, v217
v_cvt_pk_bf16_f32 v203, v218, v219
v_pk_mul_f32 v[204:205], v[204:205], v[10:11] op_sel:[0,1] op_sel_hi:[1,1]
v_pk_mul_f32 v[206:207], v[206:207], v[10:11] op_sel:[0,1] op_sel_hi:[1,1]
v_pk_mul_f32 v[220:221], v[220:221], v[10:11] op_sel:[0,1] op_sel_hi:[1,1]
v_pk_mul_f32 v[222:223], v[222:223], v[10:11] op_sel:[0,1] op_sel_hi:[1,1]
v_cvt_pk_bf16_f32 v204, v204, v205
v_cvt_pk_bf16_f32 v205, v206, v207
v_cvt_pk_bf16_f32 v206, v220, v221
v_cvt_pk_bf16_f32 v207, v222, v223
v_pk_mul_f32 v[224:225], v[224:225], v[8:9] op_sel:[0,0] op_sel_hi:[1,0]
v_pk_mul_f32 v[226:227], v[226:227], v[8:9] op_sel:[0,0] op_sel_hi:[1,0]
v_pk_mul_f32 v[240:241], v[240:241], v[8:9] op_sel:[0,0] op_sel_hi:[1,0]
v_pk_mul_f32 v[242:243], v[242:243], v[8:9] op_sel:[0,0] op_sel_hi:[1,0]
v_cvt_pk_bf16_f32 v224, v224, v225
v_cvt_pk_bf16_f32 v225, v226, v227
v_cvt_pk_bf16_f32 v226, v240, v241
v_cvt_pk_bf16_f32 v227, v242, v243
v_pk_mul_f32 v[228:229], v[228:229], v[8:9] op_sel:[0,1] op_sel_hi:[1,1]
v_pk_mul_f32 v[230:231], v[230:231], v[8:9] op_sel:[0,1] op_sel_hi:[1,1]
v_pk_mul_f32 v[244:245], v[244:245], v[8:9] op_sel:[0,1] op_sel_hi:[1,1]
v_pk_mul_f32 v[246:247], v[246:247], v[8:9] op_sel:[0,1] op_sel_hi:[1,1]
v_cvt_pk_bf16_f32 v228, v228, v229
v_cvt_pk_bf16_f32 v229, v230, v231
v_cvt_pk_bf16_f32 v230, v244, v245
v_cvt_pk_bf16_f32 v231, v246, v247
v_pk_mul_f32 v[232:233], v[232:233], v[10:11] op_sel:[0,0] op_sel_hi:[1,0]
v_pk_mul_f32 v[234:235], v[234:235], v[10:11] op_sel:[0,0] op_sel_hi:[1,0]
v_pk_mul_f32 v[248:249], v[248:249], v[10:11] op_sel:[0,0] op_sel_hi:[1,0]
v_pk_mul_f32 v[250:251], v[250:251], v[10:11] op_sel:[0,0] op_sel_hi:[1,0]
v_cvt_pk_bf16_f32 v232, v232, v233
v_cvt_pk_bf16_f32 v233, v234, v235
v_cvt_pk_bf16_f32 v234, v248, v249
v_cvt_pk_bf16_f32 v235, v250, v251
v_pk_mul_f32 v[236:237], v[236:237], v[10:11] op_sel:[0,1] op_sel_hi:[1,1]
v_pk_mul_f32 v[238:239], v[238:239], v[10:11] op_sel:[0,1] op_sel_hi:[1,1]
v_pk_mul_f32 v[252:253], v[252:253], v[10:11] op_sel:[0,1] op_sel_hi:[1,1]
v_pk_mul_f32 v[254:255], v[254:255], v[10:11] op_sel:[0,1] op_sel_hi:[1,1]
v_cvt_pk_bf16_f32 v236, v236, v237
v_cvt_pk_bf16_f32 v237, v238, v239
v_cvt_pk_bf16_f32 v238, v252, v253
v_cvt_pk_bf16_f32 v239, v254, v255
v_accvgpr_read_b32 v176, a64
v_accvgpr_read_b32 v177, a65
v_accvgpr_read_b32 v178, a66
v_accvgpr_read_b32 v179, a67
v_accvgpr_read_b32 v180, a80
v_accvgpr_read_b32 v181, a81
v_accvgpr_read_b32 v182, a82
v_accvgpr_read_b32 v183, a83
v_pk_mul_f32 v[176:177], v[176:177], v[8:9] op_sel:[0,0] op_sel_hi:[1,0]
v_pk_mul_f32 v[178:179], v[178:179], v[8:9] op_sel:[0,0] op_sel_hi:[1,0]
v_pk_mul_f32 v[180:181], v[180:181], v[8:9] op_sel:[0,0] op_sel_hi:[1,0]
v_pk_mul_f32 v[182:183], v[182:183], v[8:9] op_sel:[0,0] op_sel_hi:[1,0]
v_cvt_pk_bf16_f32 v176, v176, v177
v_cvt_pk_bf16_f32 v177, v178, v179
v_cvt_pk_bf16_f32 v178, v180, v181
v_cvt_pk_bf16_f32 v179, v182, v183
v_accvgpr_read_b32 v184, a68
v_accvgpr_read_b32 v185, a69
v_accvgpr_read_b32 v186, a70
v_accvgpr_read_b32 v187, a71
v_accvgpr_read_b32 v188, a84
v_accvgpr_read_b32 v189, a85
v_accvgpr_read_b32 v190, a86
v_accvgpr_read_b32 v191, a87
v_pk_mul_f32 v[184:185], v[184:185], v[8:9] op_sel:[0,1] op_sel_hi:[1,1]
v_pk_mul_f32 v[186:187], v[186:187], v[8:9] op_sel:[0,1] op_sel_hi:[1,1]
v_pk_mul_f32 v[188:189], v[188:189], v[8:9] op_sel:[0,1] op_sel_hi:[1,1]
v_pk_mul_f32 v[190:191], v[190:191], v[8:9] op_sel:[0,1] op_sel_hi:[1,1]
v_cvt_pk_bf16_f32 v184, v184, v185
v_cvt_pk_bf16_f32 v185, v186, v187
v_cvt_pk_bf16_f32 v186, v188, v189
v_cvt_pk_bf16_f32 v187, v190, v191
v_accvgpr_read_b32 v208, a72
v_accvgpr_read_b32 v209, a73
v_accvgpr_read_b32 v210, a74
v_accvgpr_read_b32 v211, a75
v_accvgpr_read_b32 v212, a88
v_accvgpr_read_b32 v213, a89
v_accvgpr_read_b32 v214, a90
v_accvgpr_read_b32 v215, a91
v_pk_mul_f32 v[208:209], v[208:209], v[10:11] op_sel:[0,0] op_sel_hi:[1,0]
v_pk_mul_f32 v[210:211], v[210:211], v[10:11] op_sel:[0,0] op_sel_hi:[1,0]
v_pk_mul_f32 v[212:213], v[212:213], v[10:11] op_sel:[0,0] op_sel_hi:[1,0]
v_pk_mul_f32 v[214:215], v[214:215], v[10:11] op_sel:[0,0] op_sel_hi:[1,0]
v_cvt_pk_bf16_f32 v208, v208, v209
v_cvt_pk_bf16_f32 v209, v210, v211
v_cvt_pk_bf16_f32 v210, v212, v213
v_cvt_pk_bf16_f32 v211, v214, v215
v_accvgpr_read_b32 v216, a76
v_accvgpr_read_b32 v217, a77
v_accvgpr_read_b32 v218, a78
v_accvgpr_read_b32 v219, a79
v_accvgpr_read_b32 v220, a92
v_accvgpr_read_b32 v221, a93
v_accvgpr_read_b32 v222, a94
v_accvgpr_read_b32 v223, a95
v_pk_mul_f32 v[216:217], v[216:217], v[10:11] op_sel:[0,1] op_sel_hi:[1,1]
v_pk_mul_f32 v[218:219], v[218:219], v[10:11] op_sel:[0,1] op_sel_hi:[1,1]
v_pk_mul_f32 v[220:221], v[220:221], v[10:11] op_sel:[0,1] op_sel_hi:[1,1]
v_pk_mul_f32 v[222:223], v[222:223], v[10:11] op_sel:[0,1] op_sel_hi:[1,1]
v_cvt_pk_bf16_f32 v216, v216, v217
v_cvt_pk_bf16_f32 v217, v218, v219
v_cvt_pk_bf16_f32 v218, v220, v221
v_cvt_pk_bf16_f32 v219, v222, v223
s_bitcmp1_b32 s61, 0
s_cbranch_scc0 Lss_3
buffer_store_dwordx4 v[160:163], v1, s[16:19], s36 offen offset:0 sc1
buffer_store_dwordx4 v[164:167], v1, s[16:19], s36 offen offset:2048 sc1
buffer_store_dwordx4 v[168:171], v1, s[16:19], s37 offen offset:0 sc1
buffer_store_dwordx4 v[172:175], v1, s[16:19], s37 offen offset:2048 sc1
Lss_3:
s_bitcmp1_b32 s61, 1
s_cbranch_scc0 Lss_4
buffer_store_dwordx4 v[192:195], v1, s[16:19], s36 offen offset:1024 sc1
buffer_store_dwordx4 v[196:199], v1, s[16:19], s36 offen offset:3072 sc1
buffer_store_dwordx4 v[200:203], v1, s[16:19], s37 offen offset:1024 sc1
buffer_store_dwordx4 v[204:207], v1, s[16:19], s37 offen offset:3072 sc1
Lss_4:
s_bitcmp1_b32 s61, 2
s_cbranch_scc0 Lss_5
buffer_store_dwordx4 v[224:227], v1, s[16:19], s38 offen offset:0 sc1
buffer_store_dwordx4 v[228:231], v1, s[16:19], s38 offen offset:2048 sc1
buffer_store_dwordx4 v[232:235], v1, s[16:19], s39 offen offset:0 sc1
buffer_store_dwordx4 v[236:239], v1, s[16:19], s39 offen offset:2048 sc1
Lss_5:
s_bitcmp1_b32 s61, 3
s_cbranch_scc0 Lss_6
buffer_store_dwordx4 v[176:179], v1, s[16:19], s38 offen offset:1024 sc1
buffer_store_dwordx4 v[184:187], v1, s[16:19], s38 offen offset:3072 sc1
buffer_store_dwordx4 v[208:211], v1, s[16:19], s39 offen offset:1024 sc1
buffer_store_dwordx4 v[216:219], v1, s[16:19], s39 offen offset:3072 sc1
Lss_6:
s_branch Lk2_chk
Lk2_done:
s_lshl_b32 s33, s20, 4
s_add_u32 s33, s33, 8392704
s_sub_u32 s34, 15, s21
s_lshl_b32 s34, s34, 9
s_add_u32 s92, s33, s34
s_lshl_b32 s34, s22, 2
s_add_u32 s92, s92, s34
s_lshl_b32 s34, s21, 9
s_add_u32 s93, s33, s34
s_lshl_b32 s34, s23, 3
s_add_u32 s93, s93, s34
s_cmp_eq_u32 s24, 0
s_cselect_b32 s93, s93, s92
s_cselect_b32 s94, 4, 0
s_add_u32 s94, s94, s93
s_load_dwordx2 s[10:11], s[0:1], 40
s_load_dwordx2 s[14:15], s[0:1], 72
s_lshl_b32 s21, s27, 7
s_lshl_b32 s22, s28, 6
s_lshl_b32 s3, s101, 4
v_lshrrev_b32 v224, 3, v0
v_and_b32 v225, 6, v224
v_and_b32 v226, 7, v0
v_xor_b32 v225, v225, v226
v_add_u32 v224, s3, v224
v_lshlrev_b32 v224, 11, v224
v_lshl_add_u32 v6, v225, 4, v224
v_add_u32 v7, 15360, v6
v_lshrrev_b32 v224, 2, v0
v_and_b32 v226, 1, v0
v_bfe_u32 v229, v0, 1, 1
v_lshlrev_b32 v225, 7, v224
v_lshl_add_u32 v225, v226, 3, v225
v_and_b32 v228, 6, v224
v_add_u32 v227, 0, v229
v_xor_b32 v227, v227, v228
v_lshl_add_u32 v24, v227, 4, v225
v_add_u32 v28, 0x10000, v24
v_add_u32 v227, 2, v229
v_xor_b32 v227, v227, v228
v_lshl_add_u32 v25, v227, 4, v225
v_add_u32 v29, 0x10000, v25
v_add_u32 v227, 4, v229
v_xor_b32 v227, v227, v228
v_lshl_add_u32 v26, v227, 4, v225
v_add_u32 v30, 0x10000, v26
v_add_u32 v227, 6, v229
v_xor_b32 v227, v227, v228
v_lshl_add_u32 v27, v227, 4, v225
v_add_u32 v31, 0x10000, v27
s_waitcnt vmcnt(32)
s_barrier
ds_read_b64_tr_b16 v[96:97], v28 offset:0
ds_read_b64_tr_b16 v[98:99], v28 offset:2048
ds_read_b64_tr_b16 v[100:101], v28 offset:4096
ds_read_b64_tr_b16 v[102:103], v28 offset:6144
ds_read_b64_tr_b16 v[104:105], v29 offset:0
ds_read_b64_tr_b16 v[106:107], v29 offset:2048
ds_read_b64_tr_b16 v[108:109], v29 offset:4096
ds_read_b64_tr_b16 v[110:111], v29 offset:6144
ds_read_b64_tr_b16 v[112:113], v30 offset:0
ds_read_b64_tr_b16 v[114:115], v30 offset:2048
ds_read_b64_tr_b16 v[116:117], v30 offset:4096
ds_read_b64_tr_b16 v[118:119], v30 offset:6144
ds_read_b64_tr_b16 v[120:121], v31 offset:0
ds_read_b64_tr_b16 v[122:123], v31 offset:2048
ds_read_b64_tr_b16 v[124:125], v31 offset:4096
ds_read_b64_tr_b16 v[126:127], v31 offset:6144
s_and_b32 s40, s2, 1
s_bfe_u32 s3, s2, 0x10001
s_lshl_b32 s3, s3, 3
s_bfe_u32 s36, s2, 0x30003
s_add_u32 s36, s3, s36
s_lshl_b32 s29, s36, 7
s_bfe_u32 s3, s2, 0x10002
s_lshl_b32 s3, s3, 2
s_lshr_b32 s37, s2, 6
s_add_u32 s3, s3, s37
s_lshl_b32 s13, s3, 8
s_lshl_b32 s30, s3, 7
s_lshl_b32 s3, s40, 6
s_add_u32 s30, s30, s3
s_lshl_b32 s41, s101, 12
s_lshl_b32 s12, s36, 20
s_add_u32 s12, s12, s41
s_lshl_b32 s62, s36, 9
s_lshl_b32 s3, s40, 8
s_add_u32 s62, s62, s3
s_add_u32 s62, s62, 8392704
s_lshr_b32 s3, s2, 1
s_lshr_b32 s38, s2, 2
s_xor_b32 s3, s3, s38
s_and_b32 s3, s3, 1
s_lshl_b32 s3, s3, 4
s_sub_u32 s39, 32, s3
s_lshl_b32 s38, s40, 5
s_add_u32 s3, s3, s38
s_lshl_b32 s3, s3, 14
s_add_u32 s12, s12, s3
s_lshl_b32 s3, s3, 3
s_add_u32 s13, s13, s3
s_mov_b32 s64, 4294459392
s_mov_b32 s65, 16384
s_add_u32 s8, s4, 67108864
s_addc_u32 s9, s5, 0
s_lshl_b32 s56, s2, 15
s_lshl_b32 s38, s101, 13
s_add_u32 s56, s56, s38
s_xor_b32 s57, s56, 32768
s_lshl_b32 s58, s2, 2
s_add_u32 s58, s58, 8388608
s_xor_b32 s59, s58, 4
s_mov_b32 s61, 0
s_lshl_b32 s3, s101, 4
v_lshrrev_b32 v232, 4, v0
v_and_b32 v234, 15, v0
v_add_u32 v233, 0, v232
v_lshlrev_b32 v233, 1, v233
v_xor_b32 v233, v233, v234
v_add_u32 v235, s3, v232
v_lshlrev_b32 v235, 11, v235
v_lshl_add_u32 v235, v233, 4, v235
v_add_u32 v2, 0, v235
v_add_u32 v233, 4, v232
v_lshlrev_b32 v233, 1, v233
v_xor_b32 v233, v233, v234
v_add_u32 v235, s3, v232
v_lshlrev_b32 v235, 11, v235
v_lshl_add_u32 v235, v233, 4, v235
v_add_u32 v3, 7168, v235
v_add_u32 v233, 0, v232
v_lshlrev_b32 v233, 1, v233
v_xor_b32 v233, v233, v234
v_add_u32 v235, s3, v232
v_lshlrev_b32 v235, 11, v235
v_lshl_add_u32 v235, v233, 4, v235
v_add_u32 v4, 14336, v235
v_add_u32 v233, 4, v232
v_lshlrev_b32 v233, 1, v233
v_xor_b32 v233, v233, v234
v_add_u32 v235, s3, v232
v_lshlrev_b32 v235, 11, v235
v_lshl_add_u32 v235, v233, 4, v235
v_add_u32 v5, 21504, v235
v_lshlrev_b32 v225, 8, v224
v_lshl_add_u32 v225, v226, 3, v225
v_and_b32 v228, 7, v224
v_lshlrev_b32 v228, 1, v228
s_lshl_b32 s38, s40, 3
v_xor_b32 v228, s38, v228
v_add_u32 v227, 0, v229
v_xor_b32 v227, v227, v228
v_lshl_add_u32 v8, v227, 4, v225
v_add_u32 v16, 0x10000, v8
v_add_u32 v227, 2, v229
v_xor_b32 v227, v227, v228
v_lshl_add_u32 v9, v227, 4, v225
v_add_u32 v17, 0x10000, v9
v_add_u32 v227, 4, v229
v_xor_b32 v227, v227, v228
v_lshl_add_u32 v10, v227, 4, v225
v_add_u32 v18, 0x10000, v10
v_add_u32 v227, 6, v229
v_xor_b32 v227, v227, v228
v_lshl_add_u32 v11, v227, 4, v225
v_add_u32 v19, 0x10000, v11
v_add_u32 v227, 8, v229
v_xor_b32 v227, v227, v228
v_lshl_add_u32 v12, v227, 4, v225
v_add_u32 v20, 0x10000, v12
v_add_u32 v227, 10, v229
v_xor_b32 v227, v227, v228
v_lshl_add_u32 v13, v227, 4, v225
v_add_u32 v21, 0x10000, v13
v_add_u32 v227, 12, v229
v_xor_b32 v227, v227, v228
v_lshl_add_u32 v14, v227, 4, v225
v_add_u32 v22, 0x10000, v14
v_add_u32 v227, 14, v229
v_xor_b32 v227, v227, v228
v_lshl_add_u32 v15, v227, 4, v225
v_add_u32 v23, 0x10000, v15
v_mov_b32 v253, 0
v_mov_b32 v254, 1
v_lshlrev_b32 v255, 2, v0
s_waitcnt lgkmcnt(0)
s_mov_b32 s16, s14
s_mov_b32 s17, s15
s_mov_b32 s18, 8388608
s_mov_b32 s19, 0x00020000
s_waitcnt vmcnt(26) lgkmcnt(0)
s_barrier
M a[0:3], v[96:99], a[192:195], 0
s_add_u32 m0, s42, 16384
s_nop 0
buffer_load_dwordx4 v6, s[48:51], s26 offen offset:0 lds
ds_read_b64_tr_b16 v[160:161], v28 offset:16384
ds_read_b64_tr_b16 v[162:163], v28 offset:18432
M a[0:3], v[100:103], a[196:199], a[0:3]
buffer_load_dwordx4 v7, s[48:51], s26 offen offset:1024 lds
M a[4:7], v[108:111], a[196:199], 0
ds_read_b64_tr_b16 v[164:165], v28 offset:20480
ds_read_b64_tr_b16 v[166:167], v28 offset:22528
M a[4:7], v[104:107], a[192:195], a[4:7]
buffer_load_dwordx4 a[144:147], v1, s[44:47], s25 offen offset:0 sc1
M a[8:11], v[112:115], a[192:195], 0
ds_read_b64_tr_b16 v[168:169], v29 offset:16384
ds_read_b64_tr_b16 v[170:171], v29 offset:18432
M a[8:11], v[116:119], a[196:199], a[8:11]
buffer_load_dwordx4 a[148:151], v1, s[44:47], s25 offen offset:1024 sc1
M a[12:15], v[124:127], a[196:199], 0
ds_read_b64_tr_b16 v[172:173], v29 offset:20480
ds_read_b64_tr_b16 v[174:175], v29 offset:22528
M a[12:15], v[120:123], a[192:195], a[12:15]
buffer_load_dwordx4 a[152:155], v1, s[44:47], s25 offen offset:2048 sc1
M a[16:19], v[96:99], a[200:203], 0
ds_read_b64_tr_b16 v[176:177], v30 offset:16384
ds_read_b64_tr_b16 v[178:179], v30 offset:18432
M a[16:19], v[100:103], a[204:207], a[16:19]
buffer_load_dwordx4 a[156:159], v1, s[44:47], s25 offen offset:3072 sc1
M a[20:23], v[108:111], a[204:207], 0
ds_read_b64_tr_b16 v[180:181], v30 offset:20480
ds_read_b64_tr_b16 v[182:183], v30 offset:22528
M a[20:23], v[104:107], a[200:203], a[20:23]
s_add_u32 s25, s25, 16384
s_add_u32 s26, s26, 131072
M a[24:27], v[112:115], a[200:203], 0
ds_read_b64_tr_b16 v[184:185], v31 offset:16384
ds_read_b64_tr_b16 v[186:187], v31 offset:18432
M a[24:27], v[116:119], a[204:207], a[24:27]
ds_read_b64_tr_b16 v[188:189], v31 offset:20480
ds_read_b64_tr_b16 v[190:191], v31 offset:22528
M a[28:31], v[124:127], a[204:207], 0
M a[28:31], v[120:123], a[200:203], a[28:31]
s_waitcnt vmcnt(6) lgkmcnt(0)
s_barrier
s_mov_b64 exec, 1
buffer_store_dword v254, v253, s[52:55], s92 offen sc1
buffer_store_dword v254, v253, s[52:55], s93 offen sc1
buffer_store_dword v254, v253, s[52:55], s94 offen sc1
s_mov_b64 exec, -1
M a[0:3], v[160:163], a[208:211], a[0:3]
s_add_u32 m0, s42, 32768
s_nop 0
buffer_load_dwordx4 v6, s[48:51], s26 offen offset:0 lds
ds_read_b64_tr_b16 v[96:97], v28 offset:32768
ds_read_b64_tr_b16 v[98:99], v28 offset:34816
M a[0:3], v[164:167], a[212:215], a[0:3]
buffer_load_dwordx4 v7, s[48:51], s26 offen offset:1024 lds
M a[4:7], v[172:175], a[212:215], a[4:7]
ds_read_b64_tr_b16 v[100:101], v28 offset:36864
ds_read_b64_tr_b16 v[102:103], v28 offset:38912
M a[4:7], v[168:171], a[208:211], a[4:7]
buffer_load_dwordx4 a[160:163], v1, s[44:47], s25 offen offset:0 sc1
M a[8:11], v[176:179], a[208:211], a[8:11]
ds_read_b64_tr_b16 v[104:105], v29 offset:32768
ds_read_b64_tr_b16 v[106:107], v29 offset:34816
M a[8:11], v[180:183], a[212:215], a[8:11]
buffer_load_dwordx4 a[164:167], v1, s[44:47], s25 offen offset:1024 sc1
M a[12:15], v[188:191], a[212:215], a[12:15]
ds_read_b64_tr_b16 v[108:109], v29 offset:36864
ds_read_b64_tr_b16 v[110:111], v29 offset:38912
M a[12:15], v[184:187], a[208:211], a[12:15]
buffer_load_dwordx4 a[168:171], v1, s[44:47], s25 offen offset:2048 sc1
M a[16:19], v[160:163], a[216:219], a[16:19]
ds_read_b64_tr_b16 v[112:113], v30 offset:32768
ds_read_b64_tr_b16 v[114:115], v30 offset:34816
M a[16:19], v[164:167], a[220:223], a[16:19]
buffer_load_dwordx4 a[172:175], v1, s[44:47], s25 offen offset:3072 sc1
M a[20:23], v[172:175], a[220:223], a[20:23]
ds_read_b64_tr_b16 v[116:117], v30 offset:36864
ds_read_b64_tr_b16 v[118:119], v30 offset:38912
M a[20:23], v[168:171], a[216:219], a[20:23]
s_add_u32 s25, s25, 16384
s_add_u32 s26, s26, 131072
M a[24:27], v[176:179], a[216:219], a[24:27]
ds_read_b64_tr_b16 v[120:121], v31 offset:32768
ds_read_b64_tr_b16 v[122:123], v31 offset:34816
M a[24:27], v[180:183], a[220:223], a[24:27]
ds_read_b64_tr_b16 v[124:125], v31 offset:36864
ds_read_b64_tr_b16 v[126:127], v31 offset:38912
M a[28:31], v[188:191], a[220:223], a[28:31]
M a[28:31], v[184:187], a[216:219], a[28:31]
s_waitcnt vmcnt(29) lgkmcnt(0)
s_barrier
M a[0:3], v[96:99], a[224:227], a[0:3]
s_add_u32 m0, s42, 49152
s_nop 0
buffer_load_dwordx4 v6, s[48:51], s26 offen offset:0 lds
ds_read_b64_tr_b16 v[160:161], v28 offset:49152
ds_read_b64_tr_b16 v[162:163], v28 offset:51200
M a[0:3], v[100:103], a[228:231], a[0:3]
buffer_load_dwordx4 v7, s[48:51], s26 offen offset:1024 lds
M a[4:7], v[108:111], a[228:231], a[4:7]
ds_read_b64_tr_b16 v[164:165], v28 offset:53248
ds_read_b64_tr_b16 v[166:167], v28 offset:55296
M a[4:7], v[104:107], a[224:227], a[4:7]
buffer_load_dwordx4 a[176:179], v1, s[44:47], s25 offen offset:0 sc1
M a[8:11], v[112:115], a[224:227], a[8:11]
ds_read_b64_tr_b16 v[168:169], v29 offset:49152
ds_read_b64_tr_b16 v[170:171], v29 offset:51200
M a[8:11], v[116:119], a[228:231], a[8:11]
buffer_load_dwordx4 a[180:183], v1, s[44:47], s25 offen offset:1024 sc1
M a[12:15], v[124:127], a[228:231], a[12:15]
ds_read_b64_tr_b16 v[172:173], v29 offset:53248
ds_read_b64_tr_b16 v[174:175], v29 offset:55296
M a[12:15], v[120:123], a[224:227], a[12:15]
buffer_load_dwordx4 a[184:187], v1, s[44:47], s25 offen offset:2048 sc1
ds_read_b64_tr_b16 v[176:177], v30 offset:49152
ds_read_b64_tr_b16 v[178:179], v30 offset:51200
M a[16:19], v[96:99], a[232:235], a[16:19]
buffer_load_dwordx4 a[188:191], v1, s[44:47], s25 offen offset:3072 sc1
M a[16:19], v[100:103], a[236:239], a[16:19]
ds_read_b64_tr_b16 v[180:181], v30 offset:53248
ds_read_b64_tr_b16 v[182:183], v30 offset:55296
M a[20:23], v[108:111], a[236:239], a[20:23]
s_add_u32 s25, s25, 16384
s_add_u32 s26, s26, 131072
M a[20:23], v[104:107], a[232:235], a[20:23]
ds_read_b64_tr_b16 v[184:185], v31 offset:49152
ds_read_b64_tr_b16 v[186:187], v31 offset:51200
M a[24:27], v[112:115], a[232:235], a[24:27]
buffer_load_dword v252, v255, s[52:55], s62 offen sc1
M a[24:27], v[116:119], a[236:239], a[24:27]
ds_read_b64_tr_b16 v[188:189], v31 offset:53248
ds_read_b64_tr_b16 v[190:191], v31 offset:55296
M a[28:31], v[124:127], a[236:239], a[28:31]
M a[28:31], v[120:123], a[232:235], a[28:31]
s_waitcnt vmcnt(30) lgkmcnt(0)
s_barrier
s_waitcnt vmcnt(0)
v_cmp_ne_u32 vcc, 1, v252
s_nop 0
s_cbranch_vccnz Lk3_spinft
Lk3_gotft:
M a[0:3], v[160:163], a[240:243], a[0:3]
s_mov_b32 s32, s25
s_mov_b32 s33, s26
s_mov_b64 s[34:35], s[44:45]
s_mov_b64 s[36:37], s[48:49]
s_mov_b64 s[44:45], s[8:9]
s_mov_b32 s46, 16777216
s_mov_b64 s[48:49], s[10:11]
s_mov_b32 s50, 8388608
s_mov_b32 s25, s12
s_mov_b32 s26, s13
s_add_u32 m0, s41, 65536
s_nop 0
buffer_load_dwordx4 v2, s[48:51], s26 offen offset:0 lds
ds_read_b64_tr_b16 v[96:97], v24 offset:0
ds_read_b64_tr_b16 v[98:99], v24 offset:2048
M a[0:3], v[164:167], a[244:247], a[0:3]
buffer_load_dwordx4 v3, s[48:51], s26 offen offset:1024 lds
M a[4:7], v[172:175], a[244:247], a[4:7]
ds_read_b64_tr_b16 v[100:101], v24 offset:4096
ds_read_b64_tr_b16 v[102:103], v24 offset:6144
M a[4:7], v[168:171], a[240:243], a[4:7]
buffer_load_dwordx4 v4, s[48:51], s26 offen offset:2048 lds
ds_read_b64_tr_b16 v[104:105], v25 offset:0
ds_read_b64_tr_b16 v[106:107], v25 offset:2048
M a[8:11], v[176:179], a[240:243], a[8:11]
buffer_load_dwordx4 v5, s[48:51], s26 offen offset:3072 lds
M a[8:11], v[180:183], a[244:247], a[8:11]
ds_read_b64_tr_b16 v[108:109], v25 offset:4096
ds_read_b64_tr_b16 v[110:111], v25 offset:6144
M a[12:15], v[188:191], a[244:247], a[12:15]
buffer_load_dwordx4 a[192:195], v1, s[44:47], s25 offen offset:0 sc1
M a[12:15], v[184:187], a[240:243], a[12:15]
ds_read_b64_tr_b16 v[112:113], v26 offset:0
ds_read_b64_tr_b16 v[114:115], v26 offset:2048
buffer_load_dwordx4 a[196:199], v1, s[44:47], s25 offen offset:1024 sc1
M a[16:19], v[160:163], a[248:251], a[16:19]
ds_read_b64_tr_b16 v[116:117], v26 offset:4096
ds_read_b64_tr_b16 v[118:119], v26 offset:6144
M a[16:19], v[164:167], a[252:255], a[16:19]
buffer_load_dwordx4 a[200:203], v1, s[44:47], s25 offen offset:2048 sc1
M a[20:23], v[172:175], a[252:255], a[20:23]
ds_read_b64_tr_b16 v[120:121], v27 offset:0
ds_read_b64_tr_b16 v[122:123], v27 offset:2048
buffer_load_dwordx4 a[204:207], v1, s[44:47], s25 offen offset:3072 sc1
M a[20:23], v[168:171], a[248:251], a[20:23]
ds_read_b64_tr_b16 v[124:125], v27 offset:4096
ds_read_b64_tr_b16 v[126:127], v27 offset:6144
M a[24:27], v[176:179], a[248:251], a[24:27]
s_sub_u32 s39, s39, 1
s_cmp_eq_u32 s39, 0
s_cselect_b32 s3, s64, s65
M a[24:27], v[180:183], a[252:255], a[24:27]
s_add_u32 s25, s25, s3
s_lshl_b32 s3, s3, 3
s_add_u32 s26, s26, s3
M a[28:31], v[188:191], a[252:255], a[28:31]
M a[28:31], v[184:187], a[248:251], a[28:31]
s_waitcnt vmcnt(24) lgkmcnt(0)
s_barrier
M a[0:3], v[96:99], a[128:131], a[0:3]
s_add_u32 m0, s41, 81920
s_nop 0
buffer_load_dwordx4 v2, s[48:51], s26 offen offset:0 lds
ds_read_b64_tr_b16 v[160:161], v24 offset:16384
ds_read_b64_tr_b16 v[162:163], v24 offset:18432
M a[0:3], v[100:103], a[132:135], a[0:3]
buffer_load_dwordx4 v3, s[48:51], s26 offen offset:1024 lds
M a[4:7], v[108:111], a[132:135], a[4:7]
ds_read_b64_tr_b16 v[164:165], v24 offset:20480
ds_read_b64_tr_b16 v[166:167], v24 offset:22528
M a[4:7], v[104:107], a[128:131], a[4:7]
buffer_load_dwordx4 v4, s[48:51], s26 offen offset:2048 lds
ds_read_b64_tr_b16 v[168:169], v25 offset:16384
ds_read_b64_tr_b16 v[170:171], v25 offset:18432
M a[8:11], v[112:115], a[128:131], a[8:11]
buffer_load_dwordx4 v5, s[48:51], s26 offen offset:3072 lds
M a[8:11], v[116:119], a[132:135], a[8:11]
ds_read_b64_tr_b16 v[172:173], v25 offset:20480
ds_read_b64_tr_b16 v[174:175], v25 offset:22528
M a[12:15], v[124:127], a[132:135], a[12:15]
buffer_load_dwordx4 a[208:211], v1, s[44:47], s25 offen offset:0 sc1
M a[12:15], v[120:123], a[128:131], a[12:15]
ds_read_b64_tr_b16 v[176:177], v26 offset:16384
ds_read_b64_tr_b16 v[178:179], v26 offset:18432
buffer_load_dwordx4 a[212:215], v1, s[44:47], s25 offen offset:1024 sc1
M a[16:19], v[96:99], a[136:139], a[16:19]
ds_read_b64_tr_b16 v[180:181], v26 offset:20480
ds_read_b64_tr_b16 v[182:183], v26 offset:22528
M a[16:19], v[100:103], a[140:143], a[16:19]
buffer_load_dwordx4 a[216:219], v1, s[44:47], s25 offen offset:2048 sc1
M a[20:23], v[108:111], a[140:143], a[20:23]
ds_read_b64_tr_b16 v[184:185], v27 offset:16384
ds_read_b64_tr_b16 v[186:187], v27 offset:18432
buffer_load_dwordx4 a[220:223], v1, s[44:47], s25 offen offset:3072 sc1
M a[20:23], v[104:107], a[136:139], a[20:23]
ds_read_b64_tr_b16 v[188:189], v27 offset:20480
ds_read_b64_tr_b16 v[190:191], v27 offset:22528
M a[24:27], v[112:115], a[136:139], a[24:27]
s_sub_u32 s39, s39, 1
s_cmp_eq_u32 s39, 0
s_cselect_b32 s3, s64, s65
M a[24:27], v[116:119], a[140:143], a[24:27]
s_add_u32 s25, s25, s3
s_lshl_b32 s3, s3, 3
s_add_u32 s26, s26, s3
M a[28:31], v[124:127], a[140:143], a[28:31]
M a[28:31], v[120:123], a[136:139], a[28:31]
s_waitcnt vmcnt(23) lgkmcnt(0)
s_barrier
M a[0:3], v[160:163], a[144:147], a[0:3]
s_add_u32 m0, s41, 98304
s_nop 0
buffer_load_dwordx4 v2, s[48:51], s26 offen offset:0 lds
ds_read_b64_tr_b16 v[96:97], v24 offset:32768
ds_read_b64_tr_b16 v[98:99], v24 offset:34816
M a[0:3], v[164:167], a[148:151], a[0:3]
buffer_load_dwordx4 v3, s[48:51], s26 offen offset:1024 lds
M a[4:7], v[172:175], a[148:151], a[4:7]
ds_read_b64_tr_b16 v[100:101], v24 offset:36864
ds_read_b64_tr_b16 v[102:103], v24 offset:38912
M a[4:7], v[168:171], a[144:147], a[4:7]
buffer_load_dwordx4 v4, s[48:51], s26 offen offset:2048 lds
ds_read_b64_tr_b16 v[104:105], v25 offset:32768
ds_read_b64_tr_b16 v[106:107], v25 offset:34816
M a[8:11], v[176:179], a[144:147], a[8:11]
buffer_load_dwordx4 v5, s[48:51], s26 offen offset:3072 lds
M a[8:11], v[180:183], a[148:151], a[8:11]
ds_read_b64_tr_b16 v[108:109], v25 offset:36864
ds_read_b64_tr_b16 v[110:111], v25 offset:38912
M a[12:15], v[188:191], a[148:151], a[12:15]
buffer_load_dwordx4 a[224:227], v1, s[44:47], s25 offen offset:0 sc1
M a[12:15], v[184:187], a[144:147], a[12:15]
ds_read_b64_tr_b16 v[112:113], v26 offset:32768
ds_read_b64_tr_b16 v[114:115], v26 offset:34816
buffer_load_dwordx4 a[228:231], v1, s[44:47], s25 offen offset:1024 sc1
M a[16:19], v[160:163], a[152:155], a[16:19]
ds_read_b64_tr_b16 v[116:117], v26 offset:36864
ds_read_b64_tr_b16 v[118:119], v26 offset:38912
M a[16:19], v[164:167], a[156:159], a[16:19]
buffer_load_dwordx4 a[232:235], v1, s[44:47], s25 offen offset:2048 sc1
M a[20:23], v[172:175], a[156:159], a[20:23]
ds_read_b64_tr_b16 v[120:121], v27 offset:32768
ds_read_b64_tr_b16 v[122:123], v27 offset:34816
buffer_load_dwordx4 a[236:239], v1, s[44:47], s25 offen offset:3072 sc1
M a[20:23], v[168:171], a[152:155], a[20:23]
ds_read_b64_tr_b16 v[124:125], v27 offset:36864
ds_read_b64_tr_b16 v[126:127], v27 offset:38912
M a[24:27], v[176:179], a[152:155], a[24:27]
s_sub_u32 s39, s39, 1
s_cmp_eq_u32 s39, 0
s_cselect_b32 s3, s64, s65
M a[24:27], v[180:183], a[156:159], a[24:27]
s_add_u32 s25, s25, s3
s_lshl_b32 s3, s3, 3
s_add_u32 s26, s26, s3
M a[28:31], v[188:191], a[156:159], a[28:31]
M a[28:31], v[184:187], a[152:155], a[28:31]
s_waitcnt vmcnt(25) lgkmcnt(0)
s_barrier
M a[0:3], v[96:99], a[160:163], a[0:3]
s_add_u32 m0, s41, 114688
s_nop 0
buffer_load_dwordx4 v2, s[48:51], s26 offen offset:0 lds
ds_read_b64_tr_b16 v[160:161], v24 offset:49152
ds_read_b64_tr_b16 v[162:163], v24 offset:51200
M a[0:3], v[100:103], a[164:167], a[0:3]
buffer_load_dwordx4 v3, s[48:51], s26 offen offset:1024 lds
M a[4:7], v[108:111], a[164:167], a[4:7]
ds_read_b64_tr_b16 v[164:165], v24 offset:53248
ds_read_b64_tr_b16 v[166:167], v24 offset:55296
M a[4:7], v[104:107], a[160:163], a[4:7]
buffer_load_dwordx4 v4, s[48:51], s26 offen offset:2048 lds
ds_read_b64_tr_b16 v[168:169], v25 offset:49152
ds_read_b64_tr_b16 v[170:171], v25 offset:51200
M a[8:11], v[112:115], a[160:163], a[8:11]
buffer_load_dwordx4 v5, s[48:51], s26 offen offset:3072 lds
M a[8:11], v[116:119], a[164:167], a[8:11]
ds_read_b64_tr_b16 v[172:173], v25 offset:53248
ds_read_b64_tr_b16 v[174:175], v25 offset:55296
M a[12:15], v[124:127], a[164:167], a[12:15]
buffer_load_dwordx4 a[240:243], v1, s[44:47], s25 offen offset:0 sc1
M a[12:15], v[120:123], a[160:163], a[12:15]
ds_read_b64_tr_b16 v[176:177], v26 offset:49152
ds_read_b64_tr_b16 v[178:179], v26 offset:51200
buffer_load_dwordx4 a[244:247], v1, s[44:47], s25 offen offset:1024 sc1
M a[16:19], v[96:99], a[168:171], a[16:19]
ds_read_b64_tr_b16 v[180:181], v26 offset:53248
ds_read_b64_tr_b16 v[182:183], v26 offset:55296
M a[16:19], v[100:103], a[172:175], a[16:19]
buffer_load_dwordx4 a[248:251], v1, s[44:47], s25 offen offset:2048 sc1
M a[20:23], v[108:111], a[172:175], a[20:23]
ds_read_b64_tr_b16 v[184:185], v27 offset:49152
ds_read_b64_tr_b16 v[186:187], v27 offset:51200
buffer_load_dwordx4 a[252:255], v1, s[44:47], s25 offen offset:3072 sc1
M a[20:23], v[104:107], a[168:171], a[20:23]
ds_read_b64_tr_b16 v[188:189], v27 offset:53248
ds_read_b64_tr_b16 v[190:191], v27 offset:55296
M a[24:27], v[112:115], a[168:171], a[24:27]
s_sub_u32 s39, s39, 1
s_cmp_eq_u32 s39, 0
s_cselect_b32 s3, s64, s65
M a[24:27], v[116:119], a[172:175], a[24:27]
s_add_u32 s25, s25, s3
s_lshl_b32 s3, s3, 3
s_add_u32 s26, s26, s3
M a[28:31], v[124:127], a[172:175], a[28:31]
M a[28:31], v[120:123], a[168:171], a[28:31]
s_waitcnt vmcnt(24) lgkmcnt(0)
s_barrier
M a[0:3], v[160:163], a[176:179], a[0:3]
s_add_u32 m0, s41, 0
s_nop 0
buffer_load_dwordx4 v2, s[48:51], s26 offen offset:0 lds
ds_read_b64_tr_b16 v[96:97], v16 offset:0
ds_read_b64_tr_b16 v[98:99], v16 offset:4096
M a[0:3], v[164:167], a[180:183], a[0:3]
buffer_load_dwordx4 v3, s[48:51], s26 offen offset:1024 lds
ds_read_b64_tr_b16 v[100:101], v16 offset:8192
ds_read_b64_tr_b16 v[102:103], v16 offset:12288
M a[4:7], v[172:175], a[180:183], a[4:7]
buffer_load_dwordx4 v4, s[48:51], s26 offen offset:2048 lds
ds_read_b64_tr_b16 v[104:105], v17 offset:0
ds_read_b64_tr_b16 v[106:107], v17 offset:4096
M a[4:7], v[168:171], a[176:179], a[4:7]
buffer_load_dwordx4 v5, s[48:51], s26 offen offset:3072 lds
ds_read_b64_tr_b16 v[108:109], v17 offset:8192
ds_read_b64_tr_b16 v[110:111], v17 offset:12288
M a[8:11], v[176:179], a[176:179], a[8:11]
buffer_load_dwordx4 a[128:131], v1, s[44:47], s25 offen offset:0 sc1
ds_read_b64_tr_b16 v[112:113], v18 offset:0
ds_read_b64_tr_b16 v[114:115], v18 offset:4096
M a[8:11], v[180:183], a[180:183], a[8:11]
buffer_load_dwordx4 a[132:135], v1, s[44:47], s25 offen offset:1024 sc1
ds_read_b64_tr_b16 v[116:117], v18 offset:8192
ds_read_b64_tr_b16 v[118:119], v18 offset:12288
M a[12:15], v[188:191], a[180:183], a[12:15]
buffer_load_dwordx4 a[136:139], v1, s[44:47], s25 offen offset:2048 sc1
M a[12:15], v[184:187], a[176:179], a[12:15]
ds_read_b64_tr_b16 v[120:121], v19 offset:0
ds_read_b64_tr_b16 v[122:123], v19 offset:4096
buffer_load_dwordx4 a[140:143], v1, s[44:47], s25 offen offset:3072 sc1
M a[16:19], v[160:163], a[184:187], a[16:19]
ds_read_b64_tr_b16 v[124:125], v19 offset:8192
ds_read_b64_tr_b16 v[126:127], v19 offset:12288
s_sub_u32 s39, s39, 1
s_cmp_eq_u32 s39, 0
s_cselect_b32 s3, s64, s65
M a[16:19], v[164:167], a[188:191], a[16:19]
ds_read_b64_tr_b16 v[128:129], v20 offset:0
ds_read_b64_tr_b16 v[130:131], v20 offset:4096
s_add_u32 s25, s25, s3
s_lshl_b32 s3, s3, 3
s_add_u32 s26, s26, s3
M a[20:23], v[172:175], a[188:191], a[20:23]
ds_read_b64_tr_b16 v[132:133], v20 offset:8192
ds_read_b64_tr_b16 v[134:135], v20 offset:12288
ds_read_b64_tr_b16 v[136:137], v21 offset:0
ds_read_b64_tr_b16 v[138:139], v21 offset:4096
M a[20:23], v[168:171], a[184:187], a[20:23]
ds_read_b64_tr_b16 v[140:141], v21 offset:8192
ds_read_b64_tr_b16 v[142:143], v21 offset:12288
ds_read_b64_tr_b16 v[144:145], v22 offset:0
ds_read_b64_tr_b16 v[146:147], v22 offset:4096
M a[24:27], v[176:179], a[184:187], a[24:27]
ds_read_b64_tr_b16 v[148:149], v22 offset:8192
ds_read_b64_tr_b16 v[150:151], v22 offset:12288
ds_read_b64_tr_b16 v[152:153], v23 offset:0
ds_read_b64_tr_b16 v[154:155], v23 offset:4096
M a[24:27], v[180:183], a[188:191], a[24:27]
ds_read_b64_tr_b16 v[156:157], v23 offset:8192
ds_read_b64_tr_b16 v[158:159], v23 offset:12288
M a[28:31], v[188:191], a[188:191], a[28:31]
M a[28:31], v[184:187], a[184:187], a[28:31]
s_waitcnt vmcnt(24) lgkmcnt(0)
s_barrier
M v[32:35], v[96:99], a[192:195], 0
s_add_u32 m0, s41, 16384
s_nop 0
buffer_load_dwordx4 v2, s[48:51], s26 offen offset:0 lds
M v[32:35], v[100:103], a[196:199], v[32:35]
ds_read_b64_tr_b16 v[160:161], v16 offset:16384
ds_read_b64_tr_b16 v[162:163], v16 offset:20480
M v[36:39], v[108:111], a[196:199], 0
buffer_load_dwordx4 v3, s[48:51], s26 offen offset:1024 lds
M v[36:39], v[104:107], a[192:195], v[36:39]
ds_read_b64_tr_b16 v[164:165], v16 offset:24576
ds_read_b64_tr_b16 v[166:167], v16 offset:28672
M v[40:43], v[112:115], a[192:195], 0
buffer_load_dwordx4 v4, s[48:51], s26 offen offset:2048 lds
M v[40:43], v[116:119], a[196:199], v[40:43]
ds_read_b64_tr_b16 v[168:169], v17 offset:16384
ds_read_b64_tr_b16 v[170:171], v17 offset:20480
M v[44:47], v[124:127], a[196:199], 0
buffer_load_dwordx4 v5, s[48:51], s26 offen offset:3072 lds
M v[44:47], v[120:123], a[192:195], v[44:47]
M v[48:51], v[128:131], a[192:195], 0
ds_read_b64_tr_b16 v[172:173], v17 offset:24576
ds_read_b64_tr_b16 v[174:175], v17 offset:28672
M v[48:51], v[132:135], a[196:199], v[48:51]
buffer_load_dwordx4 a[144:147], v1, s[44:47], s25 offen offset:0 sc1
M v[52:55], v[140:143], a[196:199], 0
ds_read_b64_tr_b16 v[176:177], v18 offset:16384
ds_read_b64_tr_b16 v[178:179], v18 offset:20480
M v[52:55], v[136:139], a[192:195], v[52:55]
buffer_load_dwordx4 a[148:151], v1, s[44:47], s25 offen offset:1024 sc1
M v[56:59], v[144:147], a[192:195], 0
ds_read_b64_tr_b16 v[180:181], v18 offset:24576
ds_read_b64_tr_b16 v[182:183], v18 offset:28672
M v[56:59], v[148:151], a[196:199], v[56:59]
buffer_load_dwordx4 a[152:155], v1, s[44:47], s25 offen offset:2048 sc1
M v[60:63], v[156:159], a[196:199], 0
M v[60:63], v[152:155], a[192:195], v[60:63]
ds_read_b64_tr_b16 v[184:185], v19 offset:16384
ds_read_b64_tr_b16 v[186:187], v19 offset:20480
M v[64:67], v[96:99], a[200:203], 0
buffer_load_dwordx4 a[156:159], v1, s[44:47], s25 offen offset:3072 sc1
M v[64:67], v[100:103], a[204:207], v[64:67]
ds_read_b64_tr_b16 v[188:189], v19 offset:24576
ds_read_b64_tr_b16 v[190:191], v19 offset:28672
M v[68:71], v[108:111], a[204:207], 0
s_sub_u32 s39, s39, 1
s_cmp_eq_u32 s39, 0
s_cselect_b32 s3, s64, s65
M v[68:71], v[104:107], a[200:203], v[68:71]
ds_read_b64_tr_b16 v[192:193], v20 offset:16384
ds_read_b64_tr_b16 v[194:195], v20 offset:20480
M v[72:75], v[112:115], a[200:203], 0
s_add_u32 s25, s25, s3
s_lshl_b32 s3, s3, 3
s_add_u32 s26, s26, s3
M v[72:75], v[116:119], a[204:207], v[72:75]
ds_read_b64_tr_b16 v[196:197], v20 offset:24576
ds_read_b64_tr_b16 v[198:199], v20 offset:28672
M v[76:79], v[124:127], a[204:207], 0
M v[76:79], v[120:123], a[200:203], v[76:79]
ds_read_b64_tr_b16 v[200:201], v21 offset:16384
ds_read_b64_tr_b16 v[202:203], v21 offset:20480
M v[80:83], v[128:131], a[200:203], 0
ds_read_b64_tr_b16 v[204:205], v21 offset:24576
ds_read_b64_tr_b16 v[206:207], v21 offset:28672
M v[80:83], v[132:135], a[204:207], v[80:83]
ds_read_b64_tr_b16 v[208:209], v22 offset:16384
ds_read_b64_tr_b16 v[210:211], v22 offset:20480
M v[84:87], v[140:143], a[204:207], 0
ds_read_b64_tr_b16 v[212:213], v22 offset:24576
ds_read_b64_tr_b16 v[214:215], v22 offset:28672
M v[84:87], v[136:139], a[200:203], v[84:87]
ds_read_b64_tr_b16 v[216:217], v23 offset:16384
ds_read_b64_tr_b16 v[218:219], v23 offset:20480
M v[88:91], v[144:147], a[200:203], 0
ds_read_b64_tr_b16 v[220:221], v23 offset:24576
ds_read_b64_tr_b16 v[222:223], v23 offset:28672
M v[88:91], v[148:151], a[204:207], v[88:91]
M v[92:95], v[156:159], a[204:207], 0
M v[92:95], v[152:155], a[200:203], v[92:95]
s_mov_b32 s28, 3
Lk3_la:
s_waitcnt vmcnt(24) lgkmcnt(0)
s_barrier
M v[32:35], v[160:163], a[208:211], v[32:35]
s_add_u32 m0, s41, 32768
s_nop 0
buffer_load_dwordx4 v2, s[48:51], s26 offen offset:0 lds
M v[32:35], v[164:167], a[212:215], v[32:35]
ds_read_b64_tr_b16 v[96:97], v16 offset:32768
ds_read_b64_tr_b16 v[98:99], v16 offset:36864
M v[36:39], v[172:175], a[212:215], v[36:39]
buffer_load_dwordx4 v3, s[48:51], s26 offen offset:1024 lds
M v[36:39], v[168:171], a[208:211], v[36:39]
ds_read_b64_tr_b16 v[100:101], v16 offset:40960
ds_read_b64_tr_b16 v[102:103], v16 offset:45056
M v[40:43], v[176:179], a[208:211], v[40:43]
buffer_load_dwordx4 v4, s[48:51], s26 offen offset:2048 lds
M v[40:43], v[180:183], a[212:215], v[40:43]
ds_read_b64_tr_b16 v[104:105], v17 offset:32768
ds_read_b64_tr_b16 v[106:107], v17 offset:36864
M v[44:47], v[188:191], a[212:215], v[44:47]
buffer_load_dwordx4 v5, s[48:51], s26 offen offset:3072 lds
M v[44:47], v[184:187], a[208:211], v[44:47]
M v[48:51], v[192:195], a[208:211], v[48:51]
ds_read_b64_tr_b16 v[108:109], v17 offset:40960
ds_read_b64_tr_b16 v[110:111], v17 offset:45056
M v[48:51], v[196:199], a[212:215], v[48:51]
buffer_load_dwordx4 a[160:163], v1, s[44:47], s25 offen offset:0 sc1
M v[52:55], v[204:207], a[212:215], v[52:55]
ds_read_b64_tr_b16 v[112:113], v18 offset:32768
ds_read_b64_tr_b16 v[114:115], v18 offset:36864
M v[52:55], v[200:203], a[208:211], v[52:55]
buffer_load_dwordx4 a[164:167], v1, s[44:47], s25 offen offset:1024 sc1
M v[56:59], v[208:211], a[208:211], v[56:59]
ds_read_b64_tr_b16 v[116:117], v18 offset:40960
ds_read_b64_tr_b16 v[118:119], v18 offset:45056
M v[56:59], v[212:215], a[212:215], v[56:59]
buffer_load_dwordx4 a[168:171], v1, s[44:47], s25 offen offset:2048 sc1
M v[60:63], v[220:223], a[212:215], v[60:63]
M v[60:63], v[216:219], a[208:211], v[60:63]
ds_read_b64_tr_b16 v[120:121], v19 offset:32768
ds_read_b64_tr_b16 v[122:123], v19 offset:36864
M v[64:67], v[160:163], a[216:219], v[64:67]
buffer_load_dwordx4 a[172:175], v1, s[44:47], s25 offen offset:3072 sc1
M v[64:67], v[164:167], a[220:223], v[64:67]
ds_read_b64_tr_b16 v[124:125], v19 offset:40960
ds_read_b64_tr_b16 v[126:127], v19 offset:45056
M v[68:71], v[172:175], a[220:223], v[68:71]
s_sub_u32 s39, s39, 1
s_cmp_eq_u32 s39, 0
s_cselect_b32 s3, s64, s65
M v[68:71], v[168:171], a[216:219], v[68:71]
ds_read_b64_tr_b16 v[128:129], v20 offset:32768
ds_read_b64_tr_b16 v[130:131], v20 offset:36864
M v[72:75], v[176:179], a[216:219], v[72:75]
s_add_u32 s25, s25, s3
s_lshl_b32 s3, s3, 3
s_add_u32 s26, s26, s3
M v[72:75], v[180:183], a[220:223], v[72:75]
ds_read_b64_tr_b16 v[132:133], v20 offset:40960
ds_read_b64_tr_b16 v[134:135], v20 offset:45056
M v[76:79], v[188:191], a[220:223], v[76:79]
M v[76:79], v[184:187], a[216:219], v[76:79]
ds_read_b64_tr_b16 v[136:137], v21 offset:32768
ds_read_b64_tr_b16 v[138:139], v21 offset:36864
M v[80:83], v[192:195], a[216:219], v[80:83]
ds_read_b64_tr_b16 v[140:141], v21 offset:40960
ds_read_b64_tr_b16 v[142:143], v21 offset:45056
M v[80:83], v[196:199], a[220:223], v[80:83]
ds_read_b64_tr_b16 v[144:145], v22 offset:32768
ds_read_b64_tr_b16 v[146:147], v22 offset:36864
M v[84:87], v[204:207], a[220:223], v[84:87]
ds_read_b64_tr_b16 v[148:149], v22 offset:40960
ds_read_b64_tr_b16 v[150:151], v22 offset:45056
M v[84:87], v[200:203], a[216:219], v[84:87]
ds_read_b64_tr_b16 v[152:153], v23 offset:32768
ds_read_b64_tr_b16 v[154:155], v23 offset:36864
M v[88:91], v[208:211], a[216:219], v[88:91]
ds_read_b64_tr_b16 v[156:157], v23 offset:40960
ds_read_b64_tr_b16 v[158:159], v23 offset:45056
M v[88:91], v[212:215], a[220:223], v[88:91]
M v[92:95], v[220:223], a[220:223], v[92:95]
M v[92:95], v[216:219], a[216:219], v[92:95]
s_waitcnt vmcnt(24) lgkmcnt(0)
s_barrier
M v[32:35], v[96:99], a[224:227], v[32:35]
s_add_u32 m0, s41, 49152
s_nop 0
buffer_load_dwordx4 v2, s[48:51], s26 offen offset:0 lds
M v[32:35], v[100:103], a[228:231], v[32:35]
ds_read_b64_tr_b16 v[160:161], v16 offset:49152
ds_read_b64_tr_b16 v[162:163], v16 offset:53248
M v[36:39], v[108:111], a[228:231], v[36:39]
buffer_load_dwordx4 v3, s[48:51], s26 offen offset:1024 lds
M v[36:39], v[104:107], a[224:227], v[36:39]
ds_read_b64_tr_b16 v[164:165], v16 offset:57344
ds_read_b64_tr_b16 v[166:167], v16 offset:61440
M v[40:43], v[112:115], a[224:227], v[40:43]
buffer_load_dwordx4 v4, s[48:51], s26 offen offset:2048 lds
M v[40:43], v[116:119], a[228:231], v[40:43]
ds_read_b64_tr_b16 v[168:169], v17 offset:49152
ds_read_b64_tr_b16 v[170:171], v17 offset:53248
M v[44:47], v[124:127], a[228:231], v[44:47]
buffer_load_dwordx4 v5, s[48:51], s26 offen offset:3072 lds
M v[44:47], v[120:123], a[224:227], v[44:47]
M v[48:51], v[128:131], a[224:227], v[48:51]
ds_read_b64_tr_b16 v[172:173], v17 offset:57344
ds_read_b64_tr_b16 v[174:175], v17 offset:61440
M v[48:51], v[132:135], a[228:231], v[48:51]
buffer_load_dwordx4 a[176:179], v1, s[44:47], s25 offen offset:0 sc1
M v[52:55], v[140:143], a[228:231], v[52:55]
ds_read_b64_tr_b16 v[176:177], v18 offset:49152
ds_read_b64_tr_b16 v[178:179], v18 offset:53248
M v[52:55], v[136:139], a[224:227], v[52:55]
buffer_load_dwordx4 a[180:183], v1, s[44:47], s25 offen offset:1024 sc1
M v[56:59], v[144:147], a[224:227], v[56:59]
ds_read_b64_tr_b16 v[180:181], v18 offset:57344
ds_read_b64_tr_b16 v[182:183], v18 offset:61440
M v[56:59], v[148:151], a[228:231], v[56:59]
buffer_load_dwordx4 a[184:187], v1, s[44:47], s25 offen offset:2048 sc1
M v[60:63], v[156:159], a[228:231], v[60:63]
M v[60:63], v[152:155], a[224:227], v[60:63]
ds_read_b64_tr_b16 v[184:185], v19 offset:49152
ds_read_b64_tr_b16 v[186:187], v19 offset:53248
M v[64:67], v[96:99], a[232:235], v[64:67]
buffer_load_dwordx4 a[188:191], v1, s[44:47], s25 offen offset:3072 sc1
M v[64:67], v[100:103], a[236:239], v[64:67]
ds_read_b64_tr_b16 v[188:189], v19 offset:57344
ds_read_b64_tr_b16 v[190:191], v19 offset:61440
M v[68:71], v[108:111], a[236:239], v[68:71]
s_sub_u32 s39, s39, 1
s_cmp_eq_u32 s39, 0
s_cselect_b32 s3, s64, s65
M v[68:71], v[104:107], a[232:235], v[68:71]
ds_read_b64_tr_b16 v[192:193], v20 offset:49152
ds_read_b64_tr_b16 v[194:195], v20 offset:53248
M v[72:75], v[112:115], a[232:235], v[72:75]
s_add_u32 s25, s25, s3
s_lshl_b32 s3, s3, 3
s_add_u32 s26, s26, s3
M v[72:75], v[116:119], a[236:239], v[72:75]
ds_read_b64_tr_b16 v[196:197], v20 offset:57344
ds_read_b64_tr_b16 v[198:199], v20 offset:61440
M v[76:79], v[124:127], a[236:239], v[76:79]
M v[76:79], v[120:123], a[232:235], v[76:79]
ds_read_b64_tr_b16 v[200:201], v21 offset:49152
ds_read_b64_tr_b16 v[202:203], v21 offset:53248
M v[80:83], v[128:131], a[232:235], v[80:83]
ds_read_b64_tr_b16 v[204:205], v21 offset:57344
ds_read_b64_tr_b16 v[206:207], v21 offset:61440
M v[80:83], v[132:135], a[236:239], v[80:83]
ds_read_b64_tr_b16 v[208:209], v22 offset:49152
ds_read_b64_tr_b16 v[210:211], v22 offset:53248
M v[84:87], v[140:143], a[236:239], v[84:87]
ds_read_b64_tr_b16 v[212:213], v22 offset:57344
ds_read_b64_tr_b16 v[214:215], v22 offset:61440
M v[84:87], v[136:139], a[232:235], v[84:87]
ds_read_b64_tr_b16 v[216:217], v23 offset:49152
ds_read_b64_tr_b16 v[218:219], v23 offset:53248
M v[88:91], v[144:147], a[232:235], v[88:91]
ds_read_b64_tr_b16 v[220:221], v23 offset:57344
ds_read_b64_tr_b16 v[222:223], v23 offset:61440
M v[88:91], v[148:151], a[236:239], v[88:91]
M v[92:95], v[156:159], a[236:239], v[92:95]
M v[92:95], v[152:155], a[232:235], v[92:95]
s_waitcnt vmcnt(24) lgkmcnt(0)
s_barrier
M v[32:35], v[160:163], a[240:243], v[32:35]
s_add_u32 m0, s41, 65536
s_nop 0
buffer_load_dwordx4 v2, s[48:51], s26 offen offset:0 lds
M v[32:35], v[164:167], a[244:247], v[32:35]
ds_read_b64_tr_b16 v[96:97], v8 offset:0
ds_read_b64_tr_b16 v[98:99], v8 offset:4096
M v[36:39], v[172:175], a[244:247], v[36:39]
buffer_load_dwordx4 v3, s[48:51], s26 offen offset:1024 lds
M v[36:39], v[168:171], a[240:243], v[36:39]
ds_read_b64_tr_b16 v[100:101], v8 offset:8192
ds_read_b64_tr_b16 v[102:103], v8 offset:12288
M v[40:43], v[176:179], a[240:243], v[40:43]
buffer_load_dwordx4 v4, s[48:51], s26 offen offset:2048 lds
M v[40:43], v[180:183], a[244:247], v[40:43]
ds_read_b64_tr_b16 v[104:105], v9 offset:0
ds_read_b64_tr_b16 v[106:107], v9 offset:4096
M v[44:47], v[188:191], a[244:247], v[44:47]
buffer_load_dwordx4 v5, s[48:51], s26 offen offset:3072 lds
M v[44:47], v[184:187], a[240:243], v[44:47]
M v[48:51], v[192:195], a[240:243], v[48:51]
ds_read_b64_tr_b16 v[108:109], v9 offset:8192
ds_read_b64_tr_b16 v[110:111], v9 offset:12288
M v[48:51], v[196:199], a[244:247], v[48:51]
buffer_load_dwordx4 a[192:195], v1, s[44:47], s25 offen offset:0 sc1
M v[52:55], v[204:207], a[244:247], v[52:55]
ds_read_b64_tr_b16 v[112:113], v10 offset:0
ds_read_b64_tr_b16 v[114:115], v10 offset:4096
M v[52:55], v[200:203], a[240:243], v[52:55]
buffer_load_dwordx4 a[196:199], v1, s[44:47], s25 offen offset:1024 sc1
M v[56:59], v[208:211], a[240:243], v[56:59]
ds_read_b64_tr_b16 v[116:117], v10 offset:8192
ds_read_b64_tr_b16 v[118:119], v10 offset:12288
M v[56:59], v[212:215], a[244:247], v[56:59]
buffer_load_dwordx4 a[200:203], v1, s[44:47], s25 offen offset:2048 sc1
M v[60:63], v[220:223], a[244:247], v[60:63]
M v[60:63], v[216:219], a[240:243], v[60:63]
ds_read_b64_tr_b16 v[120:121], v11 offset:0
ds_read_b64_tr_b16 v[122:123], v11 offset:4096
M v[64:67], v[160:163], a[248:251], v[64:67]
buffer_load_dwordx4 a[204:207], v1, s[44:47], s25 offen offset:3072 sc1
M v[64:67], v[164:167], a[252:255], v[64:67]
ds_read_b64_tr_b16 v[124:125], v11 offset:8192
ds_read_b64_tr_b16 v[126:127], v11 offset:12288
M v[68:71], v[172:175], a[252:255], v[68:71]
s_sub_u32 s39, s39, 1
s_cmp_eq_u32 s39, 0
s_cselect_b32 s3, s64, s65
M v[68:71], v[168:171], a[248:251], v[68:71]
ds_read_b64_tr_b16 v[128:129], v12 offset:0
ds_read_b64_tr_b16 v[130:131], v12 offset:4096
M v[72:75], v[176:179], a[248:251], v[72:75]
s_add_u32 s25, s25, s3
s_lshl_b32 s3, s3, 3
s_add_u32 s26, s26, s3
M v[72:75], v[180:183], a[252:255], v[72:75]
ds_read_b64_tr_b16 v[132:133], v12 offset:8192
ds_read_b64_tr_b16 v[134:135], v12 offset:12288
M v[76:79], v[188:191], a[252:255], v[76:79]
M v[76:79], v[184:187], a[248:251], v[76:79]
ds_read_b64_tr_b16 v[136:137], v13 offset:0
ds_read_b64_tr_b16 v[138:139], v13 offset:4096
M v[80:83], v[192:195], a[248:251], v[80:83]
ds_read_b64_tr_b16 v[140:141], v13 offset:8192
ds_read_b64_tr_b16 v[142:143], v13 offset:12288
M v[80:83], v[196:199], a[252:255], v[80:83]
ds_read_b64_tr_b16 v[144:145], v14 offset:0
ds_read_b64_tr_b16 v[146:147], v14 offset:4096
M v[84:87], v[204:207], a[252:255], v[84:87]
ds_read_b64_tr_b16 v[148:149], v14 offset:8192
ds_read_b64_tr_b16 v[150:151], v14 offset:12288
M v[84:87], v[200:203], a[248:251], v[84:87]
ds_read_b64_tr_b16 v[152:153], v15 offset:0
ds_read_b64_tr_b16 v[154:155], v15 offset:4096
M v[88:91], v[208:211], a[248:251], v[88:91]
ds_read_b64_tr_b16 v[156:157], v15 offset:8192
ds_read_b64_tr_b16 v[158:159], v15 offset:12288
M v[88:91], v[212:215], a[252:255], v[88:91]
M v[92:95], v[220:223], a[252:255], v[92:95]
M v[92:95], v[216:219], a[248:251], v[92:95]
s_waitcnt vmcnt(24) lgkmcnt(0)
s_barrier
M v[32:35], v[96:99], a[128:131], v[32:35]
s_add_u32 m0, s41, 81920
s_nop 0
buffer_load_dwordx4 v2, s[48:51], s26 offen offset:0 lds
M v[32:35], v[100:103], a[132:135], v[32:35]
ds_read_b64_tr_b16 v[160:161], v8 offset:16384
ds_read_b64_tr_b16 v[162:163], v8 offset:20480
M v[36:39], v[108:111], a[132:135], v[36:39]
buffer_load_dwordx4 v3, s[48:51], s26 offen offset:1024 lds
M v[36:39], v[104:107], a[128:131], v[36:39]
ds_read_b64_tr_b16 v[164:165], v8 offset:24576
ds_read_b64_tr_b16 v[166:167], v8 offset:28672
M v[40:43], v[112:115], a[128:131], v[40:43]
buffer_load_dwordx4 v4, s[48:51], s26 offen offset:2048 lds
M v[40:43], v[116:119], a[132:135], v[40:43]
ds_read_b64_tr_b16 v[168:169], v9 offset:16384
ds_read_b64_tr_b16 v[170:171], v9 offset:20480
M v[44:47], v[124:127], a[132:135], v[44:47]
buffer_load_dwordx4 v5, s[48:51], s26 offen offset:3072 lds
M v[44:47], v[120:123], a[128:131], v[44:47]
M v[48:51], v[128:131], a[128:131], v[48:51]
ds_read_b64_tr_b16 v[172:173], v9 offset:24576
ds_read_b64_tr_b16 v[174:175], v9 offset:28672
M v[48:51], v[132:135], a[132:135], v[48:51]
buffer_load_dwordx4 a[208:211], v1, s[44:47], s25 offen offset:0 sc1
M v[52:55], v[140:143], a[132:135], v[52:55]
ds_read_b64_tr_b16 v[176:177], v10 offset:16384
ds_read_b64_tr_b16 v[178:179], v10 offset:20480
M v[52:55], v[136:139], a[128:131], v[52:55]
buffer_load_dwordx4 a[212:215], v1, s[44:47], s25 offen offset:1024 sc1
M v[56:59], v[144:147], a[128:131], v[56:59]
ds_read_b64_tr_b16 v[180:181], v10 offset:24576
ds_read_b64_tr_b16 v[182:183], v10 offset:28672
M v[56:59], v[148:151], a[132:135], v[56:59]
buffer_load_dwordx4 a[216:219], v1, s[44:47], s25 offen offset:2048 sc1
M v[60:63], v[156:159], a[132:135], v[60:63]
M v[60:63], v[152:155], a[128:131], v[60:63]
ds_read_b64_tr_b16 v[184:185], v11 offset:16384
ds_read_b64_tr_b16 v[186:187], v11 offset:20480
M v[64:67], v[96:99], a[136:139], v[64:67]
buffer_load_dwordx4 a[220:223], v1, s[44:47], s25 offen offset:3072 sc1
M v[64:67], v[100:103], a[140:143], v[64:67]
ds_read_b64_tr_b16 v[188:189], v11 offset:24576
ds_read_b64_tr_b16 v[190:191], v11 offset:28672
M v[68:71], v[108:111], a[140:143], v[68:71]
s_sub_u32 s39, s39, 1
s_cmp_eq_u32 s39, 0
s_cselect_b32 s3, s64, s65
M v[68:71], v[104:107], a[136:139], v[68:71]
ds_read_b64_tr_b16 v[192:193], v12 offset:16384
ds_read_b64_tr_b16 v[194:195], v12 offset:20480
M v[72:75], v[112:115], a[136:139], v[72:75]
s_add_u32 s25, s25, s3
s_lshl_b32 s3, s3, 3
s_add_u32 s26, s26, s3
M v[72:75], v[116:119], a[140:143], v[72:75]
ds_read_b64_tr_b16 v[196:197], v12 offset:24576
ds_read_b64_tr_b16 v[198:199], v12 offset:28672
M v[76:79], v[124:127], a[140:143], v[76:79]
M v[76:79], v[120:123], a[136:139], v[76:79]
ds_read_b64_tr_b16 v[200:201], v13 offset:16384
ds_read_b64_tr_b16 v[202:203], v13 offset:20480
M v[80:83], v[128:131], a[136:139], v[80:83]
ds_read_b64_tr_b16 v[204:205], v13 offset:24576
ds_read_b64_tr_b16 v[206:207], v13 offset:28672
M v[80:83], v[132:135], a[140:143], v[80:83]
ds_read_b64_tr_b16 v[208:209], v14 offset:16384
ds_read_b64_tr_b16 v[210:211], v14 offset:20480
M v[84:87], v[140:143], a[140:143], v[84:87]
ds_read_b64_tr_b16 v[212:213], v14 offset:24576
ds_read_b64_tr_b16 v[214:215], v14 offset:28672
M v[84:87], v[136:139], a[136:139], v[84:87]
ds_read_b64_tr_b16 v[216:217], v15 offset:16384
ds_read_b64_tr_b16 v[218:219], v15 offset:20480
M v[88:91], v[144:147], a[136:139], v[88:91]
ds_read_b64_tr_b16 v[220:221], v15 offset:24576
ds_read_b64_tr_b16 v[222:223], v15 offset:28672
M v[88:91], v[148:151], a[140:143], v[88:91]
M v[92:95], v[156:159], a[140:143], v[92:95]
M v[92:95], v[152:155], a[136:139], v[92:95]
s_waitcnt vmcnt(24) lgkmcnt(0)
s_barrier
M v[32:35], v[160:163], a[144:147], v[32:35]
s_add_u32 m0, s41, 98304
s_nop 0
buffer_load_dwordx4 v2, s[48:51], s26 offen offset:0 lds
M v[32:35], v[164:167], a[148:151], v[32:35]
ds_read_b64_tr_b16 v[96:97], v8 offset:32768
ds_read_b64_tr_b16 v[98:99], v8 offset:36864
M v[36:39], v[172:175], a[148:151], v[36:39]
buffer_load_dwordx4 v3, s[48:51], s26 offen offset:1024 lds
M v[36:39], v[168:171], a[144:147], v[36:39]
ds_read_b64_tr_b16 v[100:101], v8 offset:40960
ds_read_b64_tr_b16 v[102:103], v8 offset:45056
M v[40:43], v[176:179], a[144:147], v[40:43]
buffer_load_dwordx4 v4, s[48:51], s26 offen offset:2048 lds
M v[40:43], v[180:183], a[148:151], v[40:43]
ds_read_b64_tr_b16 v[104:105], v9 offset:32768
ds_read_b64_tr_b16 v[106:107], v9 offset:36864
M v[44:47], v[188:191], a[148:151], v[44:47]
buffer_load_dwordx4 v5, s[48:51], s26 offen offset:3072 lds
M v[44:47], v[184:187], a[144:147], v[44:47]
M v[48:51], v[192:195], a[144:147], v[48:51]
ds_read_b64_tr_b16 v[108:109], v9 offset:40960
ds_read_b64_tr_b16 v[110:111], v9 offset:45056
M v[48:51], v[196:199], a[148:151], v[48:51]
buffer_load_dwordx4 a[224:227], v1, s[44:47], s25 offen offset:0 sc1
M v[52:55], v[204:207], a[148:151], v[52:55]
ds_read_b64_tr_b16 v[112:113], v10 offset:32768
ds_read_b64_tr_b16 v[114:115], v10 offset:36864
M v[52:55], v[200:203], a[144:147], v[52:55]
buffer_load_dwordx4 a[228:231], v1, s[44:47], s25 offen offset:1024 sc1
M v[56:59], v[208:211], a[144:147], v[56:59]
ds_read_b64_tr_b16 v[116:117], v10 offset:40960
ds_read_b64_tr_b16 v[118:119], v10 offset:45056
M v[56:59], v[212:215], a[148:151], v[56:59]
buffer_load_dwordx4 a[232:235], v1, s[44:47], s25 offen offset:2048 sc1
M v[60:63], v[220:223], a[148:151], v[60:63]
M v[60:63], v[216:219], a[144:147], v[60:63]
ds_read_b64_tr_b16 v[120:121], v11 offset:32768
ds_read_b64_tr_b16 v[122:123], v11 offset:36864
M v[64:67], v[160:163], a[152:155], v[64:67]
buffer_load_dwordx4 a[236:239], v1, s[44:47], s25 offen offset:3072 sc1
M v[64:67], v[164:167], a[156:159], v[64:67]
ds_read_b64_tr_b16 v[124:125], v11 offset:40960
ds_read_b64_tr_b16 v[126:127], v11 offset:45056
M v[68:71], v[172:175], a[156:159], v[68:71]
s_sub_u32 s39, s39, 1
s_cmp_eq_u32 s39, 0
s_cselect_b32 s3, s64, s65
M v[68:71], v[168:171], a[152:155], v[68:71]
ds_read_b64_tr_b16 v[128:129], v12 offset:32768
ds_read_b64_tr_b16 v[130:131], v12 offset:36864
M v[72:75], v[176:179], a[152:155], v[72:75]
s_add_u32 s25, s25, s3
s_lshl_b32 s3, s3, 3
s_add_u32 s26, s26, s3
M v[72:75], v[180:183], a[156:159], v[72:75]
ds_read_b64_tr_b16 v[132:133], v12 offset:40960
ds_read_b64_tr_b16 v[134:135], v12 offset:45056
M v[76:79], v[188:191], a[156:159], v[76:79]
M v[76:79], v[184:187], a[152:155], v[76:79]
ds_read_b64_tr_b16 v[136:137], v13 offset:32768
ds_read_b64_tr_b16 v[138:139], v13 offset:36864
M v[80:83], v[192:195], a[152:155], v[80:83]
ds_read_b64_tr_b16 v[140:141], v13 offset:40960
ds_read_b64_tr_b16 v[142:143], v13 offset:45056
M v[80:83], v[196:199], a[156:159], v[80:83]
ds_read_b64_tr_b16 v[144:145], v14 offset:32768
ds_read_b64_tr_b16 v[146:147], v14 offset:36864
M v[84:87], v[204:207], a[156:159], v[84:87]
ds_read_b64_tr_b16 v[148:149], v14 offset:40960
ds_read_b64_tr_b16 v[150:151], v14 offset:45056
M v[84:87], v[200:203], a[152:155], v[84:87]
ds_read_b64_tr_b16 v[152:153], v15 offset:32768
ds_read_b64_tr_b16 v[154:155], v15 offset:36864
M v[88:91], v[208:211], a[152:155], v[88:91]
ds_read_b64_tr_b16 v[156:157], v15 offset:40960
ds_read_b64_tr_b16 v[158:159], v15 offset:45056
M v[88:91], v[212:215], a[156:159], v[88:91]
M v[92:95], v[220:223], a[156:159], v[92:95]
M v[92:95], v[216:219], a[152:155], v[92:95]
s_waitcnt vmcnt(24) lgkmcnt(0)
s_barrier
M v[32:35], v[96:99], a[160:163], v[32:35]
s_add_u32 m0, s41, 114688
s_nop 0
buffer_load_dwordx4 v2, s[48:51], s26 offen offset:0 lds
M v[32:35], v[100:103], a[164:167], v[32:35]
ds_read_b64_tr_b16 v[160:161], v8 offset:49152
ds_read_b64_tr_b16 v[162:163], v8 offset:53248
M v[36:39], v[108:111], a[164:167], v[36:39]
buffer_load_dwordx4 v3, s[48:51], s26 offen offset:1024 lds
M v[36:39], v[104:107], a[160:163], v[36:39]
ds_read_b64_tr_b16 v[164:165], v8 offset:57344
ds_read_b64_tr_b16 v[166:167], v8 offset:61440
M v[40:43], v[112:115], a[160:163], v[40:43]
buffer_load_dwordx4 v4, s[48:51], s26 offen offset:2048 lds
M v[40:43], v[116:119], a[164:167], v[40:43]
ds_read_b64_tr_b16 v[168:169], v9 offset:49152
ds_read_b64_tr_b16 v[170:171], v9 offset:53248
M v[44:47], v[124:127], a[164:167], v[44:47]
buffer_load_dwordx4 v5, s[48:51], s26 offen offset:3072 lds
M v[44:47], v[120:123], a[160:163], v[44:47]
M v[48:51], v[128:131], a[160:163], v[48:51]
ds_read_b64_tr_b16 v[172:173], v9 offset:57344
ds_read_b64_tr_b16 v[174:175], v9 offset:61440
M v[48:51], v[132:135], a[164:167], v[48:51]
buffer_load_dwordx4 a[240:243], v1, s[44:47], s25 offen offset:0 sc1
M v[52:55], v[140:143], a[164:167], v[52:55]
ds_read_b64_tr_b16 v[176:177], v10 offset:49152
ds_read_b64_tr_b16 v[178:179], v10 offset:53248
M v[52:55], v[136:139], a[160:163], v[52:55]
buffer_load_dwordx4 a[244:247], v1, s[44:47], s25 offen offset:1024 sc1
M v[56:59], v[144:147], a[160:163], v[56:59]
ds_read_b64_tr_b16 v[180:181], v10 offset:57344
ds_read_b64_tr_b16 v[182:183], v10 offset:61440
M v[56:59], v[148:151], a[164:167], v[56:59]
buffer_load_dwordx4 a[248:251], v1, s[44:47], s25 offen offset:2048 sc1
M v[60:63], v[156:159], a[164:167], v[60:63]
M v[60:63], v[152:155], a[160:163], v[60:63]
ds_read_b64_tr_b16 v[184:185], v11 offset:49152
ds_read_b64_tr_b16 v[186:187], v11 offset:53248
M v[64:67], v[96:99], a[168:171], v[64:67]
buffer_load_dwordx4 a[252:255], v1, s[44:47], s25 offen offset:3072 sc1
M v[64:67], v[100:103], a[172:175], v[64:67]
ds_read_b64_tr_b16 v[188:189], v11 offset:57344
ds_read_b64_tr_b16 v[190:191], v11 offset:61440
M v[68:71], v[108:111], a[172:175], v[68:71]
s_sub_u32 s39, s39, 1
s_cmp_eq_u32 s39, 0
s_cselect_b32 s3, s64, s65
M v[68:71], v[104:107], a[168:171], v[68:71]
ds_read_b64_tr_b16 v[192:193], v12 offset:49152
ds_read_b64_tr_b16 v[194:195], v12 offset:53248
M v[72:75], v[112:115], a[168:171], v[72:75]
s_add_u32 s25, s25, s3
s_lshl_b32 s3, s3, 3
s_add_u32 s26, s26, s3
M v[72:75], v[116:119], a[172:175], v[72:75]
ds_read_b64_tr_b16 v[196:197], v12 offset:57344
ds_read_b64_tr_b16 v[198:199], v12 offset:61440
M v[76:79], v[124:127], a[172:175], v[76:79]
M v[76:79], v[120:123], a[168:171], v[76:79]
ds_read_b64_tr_b16 v[200:201], v13 offset:49152
ds_read_b64_tr_b16 v[202:203], v13 offset:53248
M v[80:83], v[128:131], a[168:171], v[80:83]
ds_read_b64_tr_b16 v[204:205], v13 offset:57344
ds_read_b64_tr_b16 v[206:207], v13 offset:61440
M v[80:83], v[132:135], a[172:175], v[80:83]
ds_read_b64_tr_b16 v[208:209], v14 offset:49152
ds_read_b64_tr_b16 v[210:211], v14 offset:53248
M v[84:87], v[140:143], a[172:175], v[84:87]
ds_read_b64_tr_b16 v[212:213], v14 offset:57344
ds_read_b64_tr_b16 v[214:215], v14 offset:61440
M v[84:87], v[136:139], a[168:171], v[84:87]
ds_read_b64_tr_b16 v[216:217], v15 offset:49152
ds_read_b64_tr_b16 v[218:219], v15 offset:53248
M v[88:91], v[144:147], a[168:171], v[88:91]
ds_read_b64_tr_b16 v[220:221], v15 offset:57344
ds_read_b64_tr_b16 v[222:223], v15 offset:61440
M v[88:91], v[148:151], a[172:175], v[88:91]
M v[92:95], v[156:159], a[172:175], v[92:95]
M v[92:95], v[152:155], a[168:171], v[92:95]
s_waitcnt vmcnt(24) lgkmcnt(0)
s_barrier
M v[32:35], v[160:163], a[176:179], v[32:35]
s_add_u32 m0, s41, 0
s_nop 0
buffer_load_dwordx4 v2, s[48:51], s26 offen offset:0 lds
M v[32:35], v[164:167], a[180:183], v[32:35]
ds_read_b64_tr_b16 v[96:97], v16 offset:0
ds_read_b64_tr_b16 v[98:99], v16 offset:4096
M v[36:39], v[172:175], a[180:183], v[36:39]
buffer_load_dwordx4 v3, s[48:51], s26 offen offset:1024 lds
M v[36:39], v[168:171], a[176:179], v[36:39]
ds_read_b64_tr_b16 v[100:101], v16 offset:8192
ds_read_b64_tr_b16 v[102:103], v16 offset:12288
M v[40:43], v[176:179], a[176:179], v[40:43]
buffer_load_dwordx4 v4, s[48:51], s26 offen offset:2048 lds
M v[40:43], v[180:183], a[180:183], v[40:43]
ds_read_b64_tr_b16 v[104:105], v17 offset:0
ds_read_b64_tr_b16 v[106:107], v17 offset:4096
M v[44:47], v[188:191], a[180:183], v[44:47]
buffer_load_dwordx4 v5, s[48:51], s26 offen offset:3072 lds
M v[44:47], v[184:187], a[176:179], v[44:47]
M v[48:51], v[192:195], a[176:179], v[48:51]
ds_read_b64_tr_b16 v[108:109], v17 offset:8192
ds_read_b64_tr_b16 v[110:111], v17 offset:12288
M v[48:51], v[196:199], a[180:183], v[48:51]
buffer_load_dwordx4 a[128:131], v1, s[44:47], s25 offen offset:0 sc1
M v[52:55], v[204:207], a[180:183], v[52:55]
ds_read_b64_tr_b16 v[112:113], v18 offset:0
ds_read_b64_tr_b16 v[114:115], v18 offset:4096
M v[52:55], v[200:203], a[176:179], v[52:55]
buffer_load_dwordx4 a[132:135], v1, s[44:47], s25 offen offset:1024 sc1
M v[56:59], v[208:211], a[176:179], v[56:59]
ds_read_b64_tr_b16 v[116:117], v18 offset:8192
ds_read_b64_tr_b16 v[118:119], v18 offset:12288
M v[56:59], v[212:215], a[180:183], v[56:59]
buffer_load_dwordx4 a[136:139], v1, s[44:47], s25 offen offset:2048 sc1
M v[60:63], v[220:223], a[180:183], v[60:63]
M v[60:63], v[216:219], a[176:179], v[60:63]
ds_read_b64_tr_b16 v[120:121], v19 offset:0
ds_read_b64_tr_b16 v[122:123], v19 offset:4096
M v[64:67], v[160:163], a[184:187], v[64:67]
buffer_load_dwordx4 a[140:143], v1, s[44:47], s25 offen offset:3072 sc1
M v[64:67], v[164:167], a[188:191], v[64:67]
ds_read_b64_tr_b16 v[124:125], v19 offset:8192
ds_read_b64_tr_b16 v[126:127], v19 offset:12288
M v[68:71], v[172:175], a[188:191], v[68:71]
s_sub_u32 s39, s39, 1
s_cmp_eq_u32 s39, 0
s_cselect_b32 s3, s64, s65
M v[68:71], v[168:171], a[184:187], v[68:71]
ds_read_b64_tr_b16 v[128:129], v20 offset:0
ds_read_b64_tr_b16 v[130:131], v20 offset:4096
M v[72:75], v[176:179], a[184:187], v[72:75]
s_add_u32 s25, s25, s3
s_lshl_b32 s3, s3, 3
s_add_u32 s26, s26, s3
M v[72:75], v[180:183], a[188:191], v[72:75]
ds_read_b64_tr_b16 v[132:133], v20 offset:8192
ds_read_b64_tr_b16 v[134:135], v20 offset:12288
M v[76:79], v[188:191], a[188:191], v[76:79]
M v[76:79], v[184:187], a[184:187], v[76:79]
ds_read_b64_tr_b16 v[136:137], v21 offset:0
ds_read_b64_tr_b16 v[138:139], v21 offset:4096
M v[80:83], v[192:195], a[184:187], v[80:83]
ds_read_b64_tr_b16 v[140:141], v21 offset:8192
ds_read_b64_tr_b16 v[142:143], v21 offset:12288
M v[80:83], v[196:199], a[188:191], v[80:83]
ds_read_b64_tr_b16 v[144:145], v22 offset:0
ds_read_b64_tr_b16 v[146:147], v22 offset:4096
M v[84:87], v[204:207], a[188:191], v[84:87]
ds_read_b64_tr_b16 v[148:149], v22 offset:8192
ds_read_b64_tr_b16 v[150:151], v22 offset:12288
M v[84:87], v[200:203], a[184:187], v[84:87]
ds_read_b64_tr_b16 v[152:153], v23 offset:0
ds_read_b64_tr_b16 v[154:155], v23 offset:4096
M v[88:91], v[208:211], a[184:187], v[88:91]
ds_read_b64_tr_b16 v[156:157], v23 offset:8192
ds_read_b64_tr_b16 v[158:159], v23 offset:12288
M v[88:91], v[212:215], a[188:191], v[88:91]
M v[92:95], v[220:223], a[188:191], v[92:95]
M v[92:95], v[216:219], a[184:187], v[92:95]
s_waitcnt vmcnt(24) lgkmcnt(0)
s_barrier
M v[32:35], v[96:99], a[192:195], v[32:35]
s_add_u32 m0, s41, 16384
s_nop 0
buffer_load_dwordx4 v2, s[48:51], s26 offen offset:0 lds
M v[32:35], v[100:103], a[196:199], v[32:35]
ds_read_b64_tr_b16 v[160:161], v16 offset:16384
ds_read_b64_tr_b16 v[162:163], v16 offset:20480
M v[36:39], v[108:111], a[196:199], v[36:39]
buffer_load_dwordx4 v3, s[48:51], s26 offen offset:1024 lds
M v[36:39], v[104:107], a[192:195], v[36:39]
ds_read_b64_tr_b16 v[164:165], v16 offset:24576
ds_read_b64_tr_b16 v[166:167], v16 offset:28672
M v[40:43], v[112:115], a[192:195], v[40:43]
buffer_load_dwordx4 v4, s[48:51], s26 offen offset:2048 lds
M v[40:43], v[116:119], a[196:199], v[40:43]
ds_read_b64_tr_b16 v[168:169], v17 offset:16384
ds_read_b64_tr_b16 v[170:171], v17 offset:20480
M v[44:47], v[124:127], a[196:199], v[44:47]
buffer_load_dwordx4 v5, s[48:51], s26 offen offset:3072 lds
M v[44:47], v[120:123], a[192:195], v[44:47]
M v[48:51], v[128:131], a[192:195], v[48:51]
ds_read_b64_tr_b16 v[172:173], v17 offset:24576
ds_read_b64_tr_b16 v[174:175], v17 offset:28672
M v[48:51], v[132:135], a[196:199], v[48:51]
buffer_load_dwordx4 a[144:147], v1, s[44:47], s25 offen offset:0 sc1
M v[52:55], v[140:143], a[196:199], v[52:55]
ds_read_b64_tr_b16 v[176:177], v18 offset:16384
ds_read_b64_tr_b16 v[178:179], v18 offset:20480
M v[52:55], v[136:139], a[192:195], v[52:55]
buffer_load_dwordx4 a[148:151], v1, s[44:47], s25 offen offset:1024 sc1
M v[56:59], v[144:147], a[192:195], v[56:59]
ds_read_b64_tr_b16 v[180:181], v18 offset:24576
ds_read_b64_tr_b16 v[182:183], v18 offset:28672
M v[56:59], v[148:151], a[196:199], v[56:59]
buffer_load_dwordx4 a[152:155], v1, s[44:47], s25 offen offset:2048 sc1
M v[60:63], v[156:159], a[196:199], v[60:63]
M v[60:63], v[152:155], a[192:195], v[60:63]
ds_read_b64_tr_b16 v[184:185], v19 offset:16384
ds_read_b64_tr_b16 v[186:187], v19 offset:20480
M v[64:67], v[96:99], a[200:203], v[64:67]
buffer_load_dwordx4 a[156:159], v1, s[44:47], s25 offen offset:3072 sc1
M v[64:67], v[100:103], a[204:207], v[64:67]
ds_read_b64_tr_b16 v[188:189], v19 offset:24576
ds_read_b64_tr_b16 v[190:191], v19 offset:28672
M v[68:71], v[108:111], a[204:207], v[68:71]
s_sub_u32 s39, s39, 1
s_cmp_eq_u32 s39, 0
s_cselect_b32 s3, s64, s65
M v[68:71], v[104:107], a[200:203], v[68:71]
ds_read_b64_tr_b16 v[192:193], v20 offset:16384
ds_read_b64_tr_b16 v[194:195], v20 offset:20480
M v[72:75], v[112:115], a[200:203], v[72:75]
s_add_u32 s25, s25, s3
s_lshl_b32 s3, s3, 3
s_add_u32 s26, s26, s3
M v[72:75], v[116:119], a[204:207], v[72:75]
ds_read_b64_tr_b16 v[196:197], v20 offset:24576
ds_read_b64_tr_b16 v[198:199], v20 offset:28672
M v[76:79], v[124:127], a[204:207], v[76:79]
M v[76:79], v[120:123], a[200:203], v[76:79]
ds_read_b64_tr_b16 v[200:201], v21 offset:16384
ds_read_b64_tr_b16 v[202:203], v21 offset:20480
M v[80:83], v[128:131], a[200:203], v[80:83]
ds_read_b64_tr_b16 v[204:205], v21 offset:24576
ds_read_b64_tr_b16 v[206:207], v21 offset:28672
M v[80:83], v[132:135], a[204:207], v[80:83]
ds_read_b64_tr_b16 v[208:209], v22 offset:16384
ds_read_b64_tr_b16 v[210:211], v22 offset:20480
M v[84:87], v[140:143], a[204:207], v[84:87]
ds_read_b64_tr_b16 v[212:213], v22 offset:24576
ds_read_b64_tr_b16 v[214:215], v22 offset:28672
M v[84:87], v[136:139], a[200:203], v[84:87]
ds_read_b64_tr_b16 v[216:217], v23 offset:16384
ds_read_b64_tr_b16 v[218:219], v23 offset:20480
M v[88:91], v[144:147], a[200:203], v[88:91]
ds_read_b64_tr_b16 v[220:221], v23 offset:24576
ds_read_b64_tr_b16 v[222:223], v23 offset:28672
M v[88:91], v[148:151], a[204:207], v[88:91]
M v[92:95], v[156:159], a[204:207], v[92:95]
M v[92:95], v[152:155], a[200:203], v[92:95]
s_sub_u32 s28, s28, 1
s_cmp_lg_u32 s28, 0
s_cbranch_scc1 Lk3_la
s_waitcnt vmcnt(24) lgkmcnt(0)
s_barrier
M v[32:35], v[160:163], a[208:211], v[32:35]
s_add_u32 m0, s41, 32768
s_nop 0
buffer_load_dwordx4 v2, s[48:51], s26 offen offset:0 lds
M v[32:35], v[164:167], a[212:215], v[32:35]
ds_read_b64_tr_b16 v[96:97], v16 offset:32768
ds_read_b64_tr_b16 v[98:99], v16 offset:36864
M v[36:39], v[172:175], a[212:215], v[36:39]
buffer_load_dwordx4 v3, s[48:51], s26 offen offset:1024 lds
M v[36:39], v[168:171], a[208:211], v[36:39]
ds_read_b64_tr_b16 v[100:101], v16 offset:40960
ds_read_b64_tr_b16 v[102:103], v16 offset:45056
M v[40:43], v[176:179], a[208:211], v[40:43]
buffer_load_dwordx4 v4, s[48:51], s26 offen offset:2048 lds
M v[40:43], v[180:183], a[212:215], v[40:43]
ds_read_b64_tr_b16 v[104:105], v17 offset:32768
ds_read_b64_tr_b16 v[106:107], v17 offset:36864
M v[44:47], v[188:191], a[212:215], v[44:47]
buffer_load_dwordx4 v5, s[48:51], s26 offen offset:3072 lds
M v[44:47], v[184:187], a[208:211], v[44:47]
M v[48:51], v[192:195], a[208:211], v[48:51]
ds_read_b64_tr_b16 v[108:109], v17 offset:40960
ds_read_b64_tr_b16 v[110:111], v17 offset:45056
M v[48:51], v[196:199], a[212:215], v[48:51]
buffer_load_dwordx4 a[160:163], v1, s[44:47], s25 offen offset:0 sc1
M v[52:55], v[204:207], a[212:215], v[52:55]
ds_read_b64_tr_b16 v[112:113], v18 offset:32768
ds_read_b64_tr_b16 v[114:115], v18 offset:36864
M v[52:55], v[200:203], a[208:211], v[52:55]
buffer_load_dwordx4 a[164:167], v1, s[44:47], s25 offen offset:1024 sc1
M v[56:59], v[208:211], a[208:211], v[56:59]
ds_read_b64_tr_b16 v[116:117], v18 offset:40960
ds_read_b64_tr_b16 v[118:119], v18 offset:45056
M v[56:59], v[212:215], a[212:215], v[56:59]
buffer_load_dwordx4 a[168:171], v1, s[44:47], s25 offen offset:2048 sc1
M v[60:63], v[220:223], a[212:215], v[60:63]
M v[60:63], v[216:219], a[208:211], v[60:63]
ds_read_b64_tr_b16 v[120:121], v19 offset:32768
ds_read_b64_tr_b16 v[122:123], v19 offset:36864
M v[64:67], v[160:163], a[216:219], v[64:67]
buffer_load_dwordx4 a[172:175], v1, s[44:47], s25 offen offset:3072 sc1
M v[64:67], v[164:167], a[220:223], v[64:67]
ds_read_b64_tr_b16 v[124:125], v19 offset:40960
ds_read_b64_tr_b16 v[126:127], v19 offset:45056
M v[68:71], v[172:175], a[220:223], v[68:71]
s_sub_u32 s39, s39, 1
s_cmp_eq_u32 s39, 0
s_cselect_b32 s3, s64, s65
M v[68:71], v[168:171], a[216:219], v[68:71]
ds_read_b64_tr_b16 v[128:129], v20 offset:32768
ds_read_b64_tr_b16 v[130:131], v20 offset:36864
M v[72:75], v[176:179], a[216:219], v[72:75]
s_add_u32 s25, s25, s3
s_lshl_b32 s3, s3, 3
s_add_u32 s26, s26, s3
M v[72:75], v[180:183], a[220:223], v[72:75]
ds_read_b64_tr_b16 v[132:133], v20 offset:40960
ds_read_b64_tr_b16 v[134:135], v20 offset:45056
M v[76:79], v[188:191], a[220:223], v[76:79]
M v[76:79], v[184:187], a[216:219], v[76:79]
ds_read_b64_tr_b16 v[136:137], v21 offset:32768
ds_read_b64_tr_b16 v[138:139], v21 offset:36864
M v[80:83], v[192:195], a[216:219], v[80:83]
ds_read_b64_tr_b16 v[140:141], v21 offset:40960
ds_read_b64_tr_b16 v[142:143], v21 offset:45056
M v[80:83], v[196:199], a[220:223], v[80:83]
ds_read_b64_tr_b16 v[144:145], v22 offset:32768
ds_read_b64_tr_b16 v[146:147], v22 offset:36864
M v[84:87], v[204:207], a[220:223], v[84:87]
ds_read_b64_tr_b16 v[148:149], v22 offset:40960
ds_read_b64_tr_b16 v[150:151], v22 offset:45056
M v[84:87], v[200:203], a[216:219], v[84:87]
ds_read_b64_tr_b16 v[152:153], v23 offset:32768
ds_read_b64_tr_b16 v[154:155], v23 offset:36864
M v[88:91], v[208:211], a[216:219], v[88:91]
ds_read_b64_tr_b16 v[156:157], v23 offset:40960
ds_read_b64_tr_b16 v[158:159], v23 offset:45056
M v[88:91], v[212:215], a[220:223], v[88:91]
M v[92:95], v[220:223], a[220:223], v[92:95]
M v[92:95], v[216:219], a[216:219], v[92:95]
s_waitcnt vmcnt(24) lgkmcnt(0)
s_barrier
M v[32:35], v[96:99], a[224:227], v[32:35]
s_add_u32 m0, s41, 49152
s_nop 0
buffer_load_dwordx4 v2, s[48:51], s26 offen offset:0 lds
M v[32:35], v[100:103], a[228:231], v[32:35]
ds_read_b64_tr_b16 v[160:161], v16 offset:49152
ds_read_b64_tr_b16 v[162:163], v16 offset:53248
M v[36:39], v[108:111], a[228:231], v[36:39]
buffer_load_dwordx4 v3, s[48:51], s26 offen offset:1024 lds
M v[36:39], v[104:107], a[224:227], v[36:39]
ds_read_b64_tr_b16 v[164:165], v16 offset:57344
ds_read_b64_tr_b16 v[166:167], v16 offset:61440
M v[40:43], v[112:115], a[224:227], v[40:43]
buffer_load_dwordx4 v4, s[48:51], s26 offen offset:2048 lds
M v[40:43], v[116:119], a[228:231], v[40:43]
ds_read_b64_tr_b16 v[168:169], v17 offset:49152
ds_read_b64_tr_b16 v[170:171], v17 offset:53248
M v[44:47], v[124:127], a[228:231], v[44:47]
buffer_load_dwordx4 v5, s[48:51], s26 offen offset:3072 lds
M v[44:47], v[120:123], a[224:227], v[44:47]
M v[48:51], v[128:131], a[224:227], v[48:51]
ds_read_b64_tr_b16 v[172:173], v17 offset:57344
ds_read_b64_tr_b16 v[174:175], v17 offset:61440
M v[48:51], v[132:135], a[228:231], v[48:51]
buffer_load_dwordx4 a[176:179], v1, s[44:47], s25 offen offset:0 sc1
M v[52:55], v[140:143], a[228:231], v[52:55]
ds_read_b64_tr_b16 v[176:177], v18 offset:49152
ds_read_b64_tr_b16 v[178:179], v18 offset:53248
M v[52:55], v[136:139], a[224:227], v[52:55]
buffer_load_dwordx4 a[180:183], v1, s[44:47], s25 offen offset:1024 sc1
M v[56:59], v[144:147], a[224:227], v[56:59]
ds_read_b64_tr_b16 v[180:181], v18 offset:57344
ds_read_b64_tr_b16 v[182:183], v18 offset:61440
M v[56:59], v[148:151], a[228:231], v[56:59]
buffer_load_dwordx4 a[184:187], v1, s[44:47], s25 offen offset:2048 sc1
M v[60:63], v[156:159], a[228:231], v[60:63]
M v[60:63], v[152:155], a[224:227], v[60:63]
ds_read_b64_tr_b16 v[184:185], v19 offset:49152
ds_read_b64_tr_b16 v[186:187], v19 offset:53248
M v[64:67], v[96:99], a[232:235], v[64:67]
buffer_load_dwordx4 a[188:191], v1, s[44:47], s25 offen offset:3072 sc1
M v[64:67], v[100:103], a[236:239], v[64:67]
ds_read_b64_tr_b16 v[188:189], v19 offset:57344
ds_read_b64_tr_b16 v[190:191], v19 offset:61440
M v[68:71], v[108:111], a[236:239], v[68:71]
s_sub_u32 s39, s39, 1
s_cmp_eq_u32 s39, 0
s_cselect_b32 s3, s64, s65
M v[68:71], v[104:107], a[232:235], v[68:71]
ds_read_b64_tr_b16 v[192:193], v20 offset:49152
ds_read_b64_tr_b16 v[194:195], v20 offset:53248
M v[72:75], v[112:115], a[232:235], v[72:75]
s_add_u32 s25, s25, s3
s_lshl_b32 s3, s3, 3
s_add_u32 s26, s26, s3
M v[72:75], v[116:119], a[236:239], v[72:75]
ds_read_b64_tr_b16 v[196:197], v20 offset:57344
ds_read_b64_tr_b16 v[198:199], v20 offset:61440
M v[76:79], v[124:127], a[236:239], v[76:79]
M v[76:79], v[120:123], a[232:235], v[76:79]
ds_read_b64_tr_b16 v[200:201], v21 offset:49152
ds_read_b64_tr_b16 v[202:203], v21 offset:53248
M v[80:83], v[128:131], a[232:235], v[80:83]
ds_read_b64_tr_b16 v[204:205], v21 offset:57344
ds_read_b64_tr_b16 v[206:207], v21 offset:61440
M v[80:83], v[132:135], a[236:239], v[80:83]
ds_read_b64_tr_b16 v[208:209], v22 offset:49152
ds_read_b64_tr_b16 v[210:211], v22 offset:53248
M v[84:87], v[140:143], a[236:239], v[84:87]
ds_read_b64_tr_b16 v[212:213], v22 offset:57344
ds_read_b64_tr_b16 v[214:215], v22 offset:61440
M v[84:87], v[136:139], a[232:235], v[84:87]
ds_read_b64_tr_b16 v[216:217], v23 offset:49152
ds_read_b64_tr_b16 v[218:219], v23 offset:53248
M v[88:91], v[144:147], a[232:235], v[88:91]
ds_read_b64_tr_b16 v[220:221], v23 offset:57344
ds_read_b64_tr_b16 v[222:223], v23 offset:61440
M v[88:91], v[148:151], a[236:239], v[88:91]
M v[92:95], v[156:159], a[236:239], v[92:95]
M v[92:95], v[152:155], a[232:235], v[92:95]
s_waitcnt vmcnt(24) lgkmcnt(0)
s_barrier
M v[32:35], v[160:163], a[240:243], v[32:35]
s_mov_b64 s[44:45], s[34:35]
s_mov_b32 s46, 4194304
s_mov_b64 s[48:49], s[36:37]
s_mov_b32 s50, 2097152
s_mov_b32 s25, s32
s_mov_b32 s26, s33
s_add_u32 m0, s42, 65536
s_nop 0
buffer_load_dwordx4 v6, s[48:51], s26 offen offset:0 lds
M v[32:35], v[164:167], a[244:247], v[32:35]
ds_read_b64_tr_b16 v[96:97], v8 offset:0
ds_read_b64_tr_b16 v[98:99], v8 offset:4096
M v[36:39], v[172:175], a[244:247], v[36:39]
buffer_load_dwordx4 v7, s[48:51], s26 offen offset:1024 lds
M v[36:39], v[168:171], a[240:243], v[36:39]
ds_read_b64_tr_b16 v[100:101], v8 offset:8192
ds_read_b64_tr_b16 v[102:103], v8 offset:12288
M v[40:43], v[176:179], a[240:243], v[40:43]
M v[40:43], v[180:183], a[244:247], v[40:43]
buffer_load_dwordx4 a[192:195], v1, s[44:47], s25 offen offset:0 sc1
M v[44:47], v[188:191], a[244:247], v[44:47]
ds_read_b64_tr_b16 v[104:105], v9 offset:0
ds_read_b64_tr_b16 v[106:107], v9 offset:4096
M v[44:47], v[184:187], a[240:243], v[44:47]
buffer_load_dwordx4 a[196:199], v1, s[44:47], s25 offen offset:1024 sc1
M v[48:51], v[192:195], a[240:243], v[48:51]
M v[48:51], v[196:199], a[244:247], v[48:51]
ds_read_b64_tr_b16 v[108:109], v9 offset:8192
ds_read_b64_tr_b16 v[110:111], v9 offset:12288
M v[52:55], v[204:207], a[244:247], v[52:55]
buffer_load_dwordx4 a[200:203], v1, s[44:47], s25 offen offset:2048 sc1
M v[52:55], v[200:203], a[240:243], v[52:55]
ds_read_b64_tr_b16 v[112:113], v10 offset:0
ds_read_b64_tr_b16 v[114:115], v10 offset:4096
M v[56:59], v[208:211], a[240:243], v[56:59]
M v[56:59], v[212:215], a[244:247], v[56:59]
buffer_load_dwordx4 a[204:207], v1, s[44:47], s25 offen offset:3072 sc1
M v[60:63], v[220:223], a[244:247], v[60:63]
ds_read_b64_tr_b16 v[116:117], v10 offset:8192
ds_read_b64_tr_b16 v[118:119], v10 offset:12288
M v[60:63], v[216:219], a[240:243], v[60:63]
s_add_u32 s25, s25, 16384
s_add_u32 s26, s26, 131072
M v[64:67], v[160:163], a[248:251], v[64:67]
ds_read_b64_tr_b16 v[120:121], v11 offset:0
ds_read_b64_tr_b16 v[122:123], v11 offset:4096
M v[64:67], v[164:167], a[252:255], v[64:67]
M v[68:71], v[172:175], a[252:255], v[68:71]
ds_read_b64_tr_b16 v[124:125], v11 offset:8192
ds_read_b64_tr_b16 v[126:127], v11 offset:12288
M v[68:71], v[168:171], a[248:251], v[68:71]
ds_read_b64_tr_b16 v[128:129], v12 offset:0
ds_read_b64_tr_b16 v[130:131], v12 offset:4096
M v[72:75], v[176:179], a[248:251], v[72:75]
ds_read_b64_tr_b16 v[132:133], v12 offset:8192
ds_read_b64_tr_b16 v[134:135], v12 offset:12288
M v[72:75], v[180:183], a[252:255], v[72:75]
M v[76:79], v[188:191], a[252:255], v[76:79]
ds_read_b64_tr_b16 v[136:137], v13 offset:0
ds_read_b64_tr_b16 v[138:139], v13 offset:4096
M v[76:79], v[184:187], a[248:251], v[76:79]
ds_read_b64_tr_b16 v[140:141], v13 offset:8192
ds_read_b64_tr_b16 v[142:143], v13 offset:12288
M v[80:83], v[192:195], a[248:251], v[80:83]
ds_read_b64_tr_b16 v[144:145], v14 offset:0
ds_read_b64_tr_b16 v[146:147], v14 offset:4096
M v[80:83], v[196:199], a[252:255], v[80:83]
M v[84:87], v[204:207], a[252:255], v[84:87]
ds_read_b64_tr_b16 v[148:149], v14 offset:8192
ds_read_b64_tr_b16 v[150:151], v14 offset:12288
M v[84:87], v[200:203], a[248:251], v[84:87]
ds_read_b64_tr_b16 v[152:153], v15 offset:0
ds_read_b64_tr_b16 v[154:155], v15 offset:4096
M v[88:91], v[208:211], a[248:251], v[88:91]
ds_read_b64_tr_b16 v[156:157], v15 offset:8192
ds_read_b64_tr_b16 v[158:159], v15 offset:12288
M v[88:91], v[212:215], a[252:255], v[88:91]
M v[92:95], v[220:223], a[252:255], v[92:95]
M v[92:95], v[216:219], a[248:251], v[92:95]
s_waitcnt vmcnt(22) lgkmcnt(0)
s_barrier
M v[32:35], v[96:99], a[128:131], v[32:35]
s_add_u32 m0, s42, 81920
s_nop 0
buffer_load_dwordx4 v6, s[48:51], s26 offen offset:0 lds
M v[32:35], v[100:103], a[132:135], v[32:35]
ds_read_b64_tr_b16 v[160:161], v8 offset:16384
ds_read_b64_tr_b16 v[162:163], v8 offset:20480
M v[36:39], v[108:111], a[132:135], v[36:39]
buffer_load_dwordx4 v7, s[48:51], s26 offen offset:1024 lds
M v[36:39], v[104:107], a[128:131], v[36:39]
ds_read_b64_tr_b16 v[164:165], v8 offset:24576
ds_read_b64_tr_b16 v[166:167], v8 offset:28672
M v[40:43], v[112:115], a[128:131], v[40:43]
M v[40:43], v[116:119], a[132:135], v[40:43]
buffer_load_dwordx4 a[208:211], v1, s[44:47], s25 offen offset:0 sc1
M v[44:47], v[124:127], a[132:135], v[44:47]
ds_read_b64_tr_b16 v[168:169], v9 offset:16384
ds_read_b64_tr_b16 v[170:171], v9 offset:20480
M v[44:47], v[120:123], a[128:131], v[44:47]
buffer_load_dwordx4 a[212:215], v1, s[44:47], s25 offen offset:1024 sc1
M v[48:51], v[128:131], a[128:131], v[48:51]
M v[48:51], v[132:135], a[132:135], v[48:51]
ds_read_b64_tr_b16 v[172:173], v9 offset:24576
ds_read_b64_tr_b16 v[174:175], v9 offset:28672
M v[52:55], v[140:143], a[132:135], v[52:55]
buffer_load_dwordx4 a[216:219], v1, s[44:47], s25 offen offset:2048 sc1
M v[52:55], v[136:139], a[128:131], v[52:55]
ds_read_b64_tr_b16 v[176:177], v10 offset:16384
ds_read_b64_tr_b16 v[178:179], v10 offset:20480
M v[56:59], v[144:147], a[128:131], v[56:59]
M v[56:59], v[148:151], a[132:135], v[56:59]
buffer_load_dwordx4 a[220:223], v1, s[44:47], s25 offen offset:3072 sc1
M v[60:63], v[156:159], a[132:135], v[60:63]
ds_read_b64_tr_b16 v[180:181], v10 offset:24576
ds_read_b64_tr_b16 v[182:183], v10 offset:28672
M v[60:63], v[152:155], a[128:131], v[60:63]
s_add_u32 s25, s25, 16384
s_add_u32 s26, s26, 131072
M v[64:67], v[96:99], a[136:139], v[64:67]
ds_read_b64_tr_b16 v[184:185], v11 offset:16384
ds_read_b64_tr_b16 v[186:187], v11 offset:20480
M v[64:67], v[100:103], a[140:143], v[64:67]
M v[68:71], v[108:111], a[140:143], v[68:71]
ds_read_b64_tr_b16 v[188:189], v11 offset:24576
ds_read_b64_tr_b16 v[190:191], v11 offset:28672
M v[68:71], v[104:107], a[136:139], v[68:71]
ds_read_b64_tr_b16 v[192:193], v12 offset:16384
ds_read_b64_tr_b16 v[194:195], v12 offset:20480
M v[72:75], v[112:115], a[136:139], v[72:75]
ds_read_b64_tr_b16 v[196:197], v12 offset:24576
ds_read_b64_tr_b16 v[198:199], v12 offset:28672
M v[72:75], v[116:119], a[140:143], v[72:75]
M v[76:79], v[124:127], a[140:143], v[76:79]
ds_read_b64_tr_b16 v[200:201], v13 offset:16384
ds_read_b64_tr_b16 v[202:203], v13 offset:20480
M v[76:79], v[120:123], a[136:139], v[76:79]
ds_read_b64_tr_b16 v[204:205], v13 offset:24576
ds_read_b64_tr_b16 v[206:207], v13 offset:28672
M v[80:83], v[128:131], a[136:139], v[80:83]
ds_read_b64_tr_b16 v[208:209], v14 offset:16384
ds_read_b64_tr_b16 v[210:211], v14 offset:20480
M v[80:83], v[132:135], a[140:143], v[80:83]
M v[84:87], v[140:143], a[140:143], v[84:87]
ds_read_b64_tr_b16 v[212:213], v14 offset:24576
ds_read_b64_tr_b16 v[214:215], v14 offset:28672
M v[84:87], v[136:139], a[136:139], v[84:87]
ds_read_b64_tr_b16 v[216:217], v15 offset:16384
ds_read_b64_tr_b16 v[218:219], v15 offset:20480
M v[88:91], v[144:147], a[136:139], v[88:91]
ds_read_b64_tr_b16 v[220:221], v15 offset:24576
ds_read_b64_tr_b16 v[222:223], v15 offset:28672
M v[88:91], v[148:151], a[140:143], v[88:91]
M v[92:95], v[156:159], a[140:143], v[92:95]
M v[92:95], v[152:155], a[136:139], v[92:95]
s_waitcnt vmcnt(20) lgkmcnt(0)
s_barrier
M v[32:35], v[160:163], a[144:147], v[32:35]
s_add_u32 m0, s42, 98304
s_nop 0
buffer_load_dwordx4 v6, s[48:51], s26 offen offset:0 lds
M v[32:35], v[164:167], a[148:151], v[32:35]
ds_read_b64_tr_b16 v[96:97], v8 offset:32768
ds_read_b64_tr_b16 v[98:99], v8 offset:36864
M v[36:39], v[172:175], a[148:151], v[36:39]
buffer_load_dwordx4 v7, s[48:51], s26 offen offset:1024 lds
M v[36:39], v[168:171], a[144:147], v[36:39]
ds_read_b64_tr_b16 v[100:101], v8 offset:40960
ds_read_b64_tr_b16 v[102:103], v8 offset:45056
M v[40:43], v[176:179], a[144:147], v[40:43]
M v[40:43], v[180:183], a[148:151], v[40:43]
buffer_load_dwordx4 a[224:227], v1, s[44:47], s25 offen offset:0 sc1
M v[44:47], v[188:191], a[148:151], v[44:47]
ds_read_b64_tr_b16 v[104:105], v9 offset:32768
ds_read_b64_tr_b16 v[106:107], v9 offset:36864
M v[44:47], v[184:187], a[144:147], v[44:47]
buffer_load_dwordx4 a[228:231], v1, s[44:47], s25 offen offset:1024 sc1
M v[48:51], v[192:195], a[144:147], v[48:51]
M v[48:51], v[196:199], a[148:151], v[48:51]
ds_read_b64_tr_b16 v[108:109], v9 offset:40960
ds_read_b64_tr_b16 v[110:111], v9 offset:45056
M v[52:55], v[204:207], a[148:151], v[52:55]
buffer_load_dwordx4 a[232:235], v1, s[44:47], s25 offen offset:2048 sc1
M v[52:55], v[200:203], a[144:147], v[52:55]
ds_read_b64_tr_b16 v[112:113], v10 offset:32768
ds_read_b64_tr_b16 v[114:115], v10 offset:36864
M v[56:59], v[208:211], a[144:147], v[56:59]
M v[56:59], v[212:215], a[148:151], v[56:59]
buffer_load_dwordx4 a[236:239], v1, s[44:47], s25 offen offset:3072 sc1
M v[60:63], v[220:223], a[148:151], v[60:63]
ds_read_b64_tr_b16 v[116:117], v10 offset:40960
ds_read_b64_tr_b16 v[118:119], v10 offset:45056
M v[60:63], v[216:219], a[144:147], v[60:63]
s_add_u32 s25, s25, 16384
s_add_u32 s26, s26, 131072
M v[64:67], v[160:163], a[152:155], v[64:67]
ds_read_b64_tr_b16 v[120:121], v11 offset:32768
ds_read_b64_tr_b16 v[122:123], v11 offset:36864
M v[64:67], v[164:167], a[156:159], v[64:67]
M v[68:71], v[172:175], a[156:159], v[68:71]
ds_read_b64_tr_b16 v[124:125], v11 offset:40960
ds_read_b64_tr_b16 v[126:127], v11 offset:45056
M v[68:71], v[168:171], a[152:155], v[68:71]
ds_read_b64_tr_b16 v[128:129], v12 offset:32768
ds_read_b64_tr_b16 v[130:131], v12 offset:36864
M v[72:75], v[176:179], a[152:155], v[72:75]
ds_read_b64_tr_b16 v[132:133], v12 offset:40960
ds_read_b64_tr_b16 v[134:135], v12 offset:45056
M v[72:75], v[180:183], a[156:159], v[72:75]
M v[76:79], v[188:191], a[156:159], v[76:79]
ds_read_b64_tr_b16 v[136:137], v13 offset:32768
ds_read_b64_tr_b16 v[138:139], v13 offset:36864
M v[76:79], v[184:187], a[152:155], v[76:79]
ds_read_b64_tr_b16 v[140:141], v13 offset:40960
ds_read_b64_tr_b16 v[142:143], v13 offset:45056
M v[80:83], v[192:195], a[152:155], v[80:83]
ds_read_b64_tr_b16 v[144:145], v14 offset:32768
ds_read_b64_tr_b16 v[146:147], v14 offset:36864
M v[80:83], v[196:199], a[156:159], v[80:83]
M v[84:87], v[204:207], a[156:159], v[84:87]
ds_read_b64_tr_b16 v[148:149], v14 offset:40960
ds_read_b64_tr_b16 v[150:151], v14 offset:45056
M v[84:87], v[200:203], a[152:155], v[84:87]
ds_read_b64_tr_b16 v[152:153], v15 offset:32768
ds_read_b64_tr_b16 v[154:155], v15 offset:36864
M v[88:91], v[208:211], a[152:155], v[88:91]
ds_read_b64_tr_b16 v[156:157], v15 offset:40960
ds_read_b64_tr_b16 v[158:159], v15 offset:45056
M v[88:91], v[212:215], a[156:159], v[88:91]
M v[92:95], v[220:223], a[156:159], v[92:95]
M v[92:95], v[216:219], a[152:155], v[92:95]
s_waitcnt vmcnt(18) lgkmcnt(0)
s_barrier
M v[32:35], v[96:99], a[160:163], v[32:35]
s_add_u32 m0, s42, 114688
s_nop 0
buffer_load_dwordx4 v6, s[48:51], s26 offen offset:0 lds
M v[32:35], v[100:103], a[164:167], v[32:35]
ds_read_b64_tr_b16 v[160:161], v8 offset:49152
ds_read_b64_tr_b16 v[162:163], v8 offset:53248
M v[36:39], v[108:111], a[164:167], v[36:39]
buffer_load_dwordx4 v7, s[48:51], s26 offen offset:1024 lds
M v[36:39], v[104:107], a[160:163], v[36:39]
ds_read_b64_tr_b16 v[164:165], v8 offset:57344
ds_read_b64_tr_b16 v[166:167], v8 offset:61440
M v[40:43], v[112:115], a[160:163], v[40:43]
M v[40:43], v[116:119], a[164:167], v[40:43]
buffer_load_dwordx4 a[240:243], v1, s[44:47], s25 offen offset:0 sc1
M v[44:47], v[124:127], a[164:167], v[44:47]
ds_read_b64_tr_b16 v[168:169], v9 offset:49152
ds_read_b64_tr_b16 v[170:171], v9 offset:53248
M v[44:47], v[120:123], a[160:163], v[44:47]
buffer_load_dwordx4 a[244:247], v1, s[44:47], s25 offen offset:1024 sc1
M v[48:51], v[128:131], a[160:163], v[48:51]
M v[48:51], v[132:135], a[164:167], v[48:51]
ds_read_b64_tr_b16 v[172:173], v9 offset:57344
ds_read_b64_tr_b16 v[174:175], v9 offset:61440
M v[52:55], v[140:143], a[164:167], v[52:55]
buffer_load_dwordx4 a[248:251], v1, s[44:47], s25 offen offset:2048 sc1
M v[52:55], v[136:139], a[160:163], v[52:55]
ds_read_b64_tr_b16 v[176:177], v10 offset:49152
ds_read_b64_tr_b16 v[178:179], v10 offset:53248
M v[56:59], v[144:147], a[160:163], v[56:59]
M v[56:59], v[148:151], a[164:167], v[56:59]
buffer_load_dwordx4 a[252:255], v1, s[44:47], s25 offen offset:3072 sc1
M v[60:63], v[156:159], a[164:167], v[60:63]
ds_read_b64_tr_b16 v[180:181], v10 offset:57344
ds_read_b64_tr_b16 v[182:183], v10 offset:61440
M v[60:63], v[152:155], a[160:163], v[60:63]
s_add_u32 s25, s25, 16384
s_add_u32 s26, s26, 131072
M v[64:67], v[96:99], a[168:171], v[64:67]
ds_read_b64_tr_b16 v[184:185], v11 offset:49152
ds_read_b64_tr_b16 v[186:187], v11 offset:53248
M v[64:67], v[100:103], a[172:175], v[64:67]
M v[68:71], v[108:111], a[172:175], v[68:71]
ds_read_b64_tr_b16 v[188:189], v11 offset:57344
ds_read_b64_tr_b16 v[190:191], v11 offset:61440
M v[68:71], v[104:107], a[168:171], v[68:71]
ds_read_b64_tr_b16 v[192:193], v12 offset:49152
ds_read_b64_tr_b16 v[194:195], v12 offset:53248
M v[72:75], v[112:115], a[168:171], v[72:75]
ds_read_b64_tr_b16 v[196:197], v12 offset:57344
ds_read_b64_tr_b16 v[198:199], v12 offset:61440
M v[72:75], v[116:119], a[172:175], v[72:75]
M v[76:79], v[124:127], a[172:175], v[76:79]
ds_read_b64_tr_b16 v[200:201], v13 offset:49152
ds_read_b64_tr_b16 v[202:203], v13 offset:53248
M v[76:79], v[120:123], a[168:171], v[76:79]
ds_read_b64_tr_b16 v[204:205], v13 offset:57344
ds_read_b64_tr_b16 v[206:207], v13 offset:61440
M v[80:83], v[128:131], a[168:171], v[80:83]
ds_read_b64_tr_b16 v[208:209], v14 offset:49152
ds_read_b64_tr_b16 v[210:211], v14 offset:53248
M v[80:83], v[132:135], a[172:175], v[80:83]
M v[84:87], v[140:143], a[172:175], v[84:87]
ds_read_b64_tr_b16 v[212:213], v14 offset:57344
ds_read_b64_tr_b16 v[214:215], v14 offset:61440
M v[84:87], v[136:139], a[168:171], v[84:87]
ds_read_b64_tr_b16 v[216:217], v15 offset:49152
ds_read_b64_tr_b16 v[218:219], v15 offset:53248
M v[88:91], v[144:147], a[168:171], v[88:91]
ds_read_b64_tr_b16 v[220:221], v15 offset:57344
ds_read_b64_tr_b16 v[222:223], v15 offset:61440
M v[88:91], v[148:151], a[172:175], v[88:91]
M v[92:95], v[156:159], a[172:175], v[92:95]
M v[92:95], v[152:155], a[168:171], v[92:95]
s_waitcnt vmcnt(18) lgkmcnt(0)
s_barrier
M v[32:35], v[160:163], a[176:179], v[32:35]
s_add_u32 m0, s42, 0
s_nop 0
buffer_load_dwordx4 v6, s[48:51], s26 offen offset:0 lds
M v[32:35], v[164:167], a[180:183], v[32:35]
M v[36:39], v[172:175], a[180:183], v[36:39]
ds_read_b64_tr_b16 v[96:97], v28 offset:0
ds_read_b64_tr_b16 v[98:99], v28 offset:2048
M v[36:39], v[168:171], a[176:179], v[36:39]
M v[40:43], v[176:179], a[176:179], v[40:43]
buffer_load_dwordx4 v7, s[48:51], s26 offen offset:1024 lds
M v[40:43], v[180:183], a[180:183], v[40:43]
M v[44:47], v[188:191], a[180:183], v[44:47]
ds_read_b64_tr_b16 v[100:101], v28 offset:4096
ds_read_b64_tr_b16 v[102:103], v28 offset:6144
M v[44:47], v[184:187], a[176:179], v[44:47]
M v[48:51], v[192:195], a[176:179], v[48:51]
buffer_load_dwordx4 a[128:131], v1, s[44:47], s25 offen offset:0 sc1
M v[48:51], v[196:199], a[180:183], v[48:51]
M v[52:55], v[204:207], a[180:183], v[52:55]
ds_read_b64_tr_b16 v[104:105], v29 offset:0
ds_read_b64_tr_b16 v[106:107], v29 offset:2048
M v[52:55], v[200:203], a[176:179], v[52:55]
M v[56:59], v[208:211], a[176:179], v[56:59]
buffer_load_dwordx4 a[132:135], v1, s[44:47], s25 offen offset:1024 sc1
M v[56:59], v[212:215], a[180:183], v[56:59]
M v[60:63], v[220:223], a[180:183], v[60:63]
ds_read_b64_tr_b16 v[108:109], v29 offset:4096
ds_read_b64_tr_b16 v[110:111], v29 offset:6144
M v[60:63], v[216:219], a[176:179], v[60:63]
M v[64:67], v[160:163], a[184:187], v[64:67]
buffer_load_dwordx4 a[136:139], v1, s[44:47], s25 offen offset:2048 sc1
M v[64:67], v[164:167], a[188:191], v[64:67]
M v[68:71], v[172:175], a[188:191], v[68:71]
ds_read_b64_tr_b16 v[112:113], v30 offset:0
ds_read_b64_tr_b16 v[114:115], v30 offset:2048
M v[68:71], v[168:171], a[184:187], v[68:71]
M v[72:75], v[176:179], a[184:187], v[72:75]
buffer_load_dwordx4 a[140:143], v1, s[44:47], s25 offen offset:3072 sc1
M v[72:75], v[180:183], a[188:191], v[72:75]
M v[76:79], v[188:191], a[188:191], v[76:79]
ds_read_b64_tr_b16 v[116:117], v30 offset:4096
ds_read_b64_tr_b16 v[118:119], v30 offset:6144
M v[76:79], v[184:187], a[184:187], v[76:79]
M v[80:83], v[192:195], a[184:187], v[80:83]
s_add_u32 s25, s25, 16384
s_add_u32 s26, s26, 131072
M v[80:83], v[196:199], a[188:191], v[80:83]
M v[84:87], v[204:207], a[188:191], v[84:87]
ds_read_b64_tr_b16 v[120:121], v31 offset:0
ds_read_b64_tr_b16 v[122:123], v31 offset:2048
M v[84:87], v[200:203], a[184:187], v[84:87]
M v[88:91], v[208:211], a[184:187], v[88:91]
ds_read_b64_tr_b16 v[124:125], v31 offset:4096
ds_read_b64_tr_b16 v[126:127], v31 offset:6144
M v[88:91], v[212:215], a[188:191], v[88:91]
M v[92:95], v[220:223], a[188:191], v[92:95]
M v[92:95], v[216:219], a[184:187], v[92:95]
s_waitcnt vmcnt(18) lgkmcnt(0)
s_barrier
M a[0:3], v[96:99], a[192:195], a[0:3]
s_add_u32 m0, s42, 16384
s_nop 0
buffer_load_dwordx4 v6, s[48:51], s26 offen offset:0 lds
ds_read_b64_tr_b16 v[160:161], v28 offset:16384
ds_read_b64_tr_b16 v[162:163], v28 offset:18432
M a[0:3], v[100:103], a[196:199], a[0:3]
buffer_load_dwordx4 v7, s[48:51], s26 offen offset:1024 lds
ds_read_b64_tr_b16 v[164:165], v28 offset:20480
ds_read_b64_tr_b16 v[166:167], v28 offset:22528
M a[4:7], v[108:111], a[196:199], a[4:7]
buffer_load_dwordx4 a[144:147], v1, s[44:47], s25 offen offset:0 sc1
ds_read_b64_tr_b16 v[168:169], v29 offset:16384
ds_read_b64_tr_b16 v[170:171], v29 offset:18432
M a[4:7], v[104:107], a[192:195], a[4:7]
buffer_load_dwordx4 a[148:151], v1, s[44:47], s25 offen offset:1024 sc1
M a[8:11], v[112:115], a[192:195], a[8:11]
ds_read_b64_tr_b16 v[172:173], v29 offset:20480
ds_read_b64_tr_b16 v[174:175], v29 offset:22528
buffer_load_dwordx4 a[152:155], v1, s[44:47], s25 offen offset:2048 sc1
M a[8:11], v[116:119], a[196:199], a[8:11]
ds_read_b64_tr_b16 v[176:177], v30 offset:16384
ds_read_b64_tr_b16 v[178:179], v30 offset:18432
buffer_load_dwordx4 a[156:159], v1, s[44:47], s25 offen offset:3072 sc1
M a[12:15], v[124:127], a[196:199], a[12:15]
ds_read_b64_tr_b16 v[180:181], v30 offset:20480
ds_read_b64_tr_b16 v[182:183], v30 offset:22528
M a[12:15], v[120:123], a[192:195], a[12:15]
s_add_u32 s25, s25, 16384
s_add_u32 s26, s26, 131072
ds_read_b64_tr_b16 v[184:185], v31 offset:16384
ds_read_b64_tr_b16 v[186:187], v31 offset:18432
M a[16:19], v[96:99], a[200:203], a[16:19]
s_add_u32 s60, s56, 0
buffer_store_dwordx4 v[48:51], v1, s[52:55], s60 offen offset:0 sc1
ds_read_b64_tr_b16 v[188:189], v31 offset:20480
ds_read_b64_tr_b16 v[190:191], v31 offset:22528
M a[16:19], v[100:103], a[204:207], a[16:19]
buffer_store_dwordx4 v[52:55], v1, s[52:55], s60 offen offset:1024 sc1
buffer_store_dwordx4 v[56:59], v1, s[52:55], s60 offen offset:2048 sc1
M a[20:23], v[108:111], a[204:207], a[20:23]
buffer_store_dwordx4 v[60:63], v1, s[52:55], s60 offen offset:3072 sc1
M a[20:23], v[104:107], a[200:203], a[20:23]
s_add_u32 s60, s56, 4096
buffer_store_dwordx4 v[80:83], v1, s[52:55], s60 offen offset:0 sc1
buffer_store_dwordx4 v[84:87], v1, s[52:55], s60 offen offset:1024 sc1
M a[24:27], v[112:115], a[200:203], a[24:27]
buffer_store_dwordx4 v[88:91], v1, s[52:55], s60 offen offset:2048 sc1
buffer_store_dwordx4 v[92:95], v1, s[52:55], s60 offen offset:3072 sc1
M a[24:27], v[116:119], a[204:207], a[24:27]
v_mov_b32 v11, 0
M a[28:31], v[124:127], a[204:207], a[28:31]
M a[28:31], v[120:123], a[200:203], a[28:31]
s_waitcnt vmcnt(26) lgkmcnt(0)
s_barrier
M a[0:3], v[160:163], a[208:211], a[0:3]
s_add_u32 m0, s42, 32768
s_nop 0
buffer_load_dwordx4 v6, s[48:51], s26 offen offset:0 lds
ds_read_b64_tr_b16 v[96:97], v28 offset:32768
ds_read_b64_tr_b16 v[98:99], v28 offset:34816
M a[0:3], v[164:167], a[212:215], a[0:3]
buffer_load_dwordx4 v7, s[48:51], s26 offen offset:1024 lds
M a[4:7], v[172:175], a[212:215], a[4:7]
ds_read_b64_tr_b16 v[100:101], v28 offset:36864
ds_read_b64_tr_b16 v[102:103], v28 offset:38912
M a[4:7], v[168:171], a[208:211], a[4:7]
buffer_load_dwordx4 a[160:163], v1, s[44:47], s25 offen offset:0 sc1
M a[8:11], v[176:179], a[208:211], a[8:11]
ds_read_b64_tr_b16 v[104:105], v29 offset:32768
ds_read_b64_tr_b16 v[106:107], v29 offset:34816
M a[8:11], v[180:183], a[212:215], a[8:11]
buffer_load_dwordx4 a[164:167], v1, s[44:47], s25 offen offset:1024 sc1
M a[12:15], v[188:191], a[212:215], a[12:15]
ds_read_b64_tr_b16 v[108:109], v29 offset:36864
ds_read_b64_tr_b16 v[110:111], v29 offset:38912
M a[12:15], v[184:187], a[208:211], a[12:15]
buffer_load_dwordx4 a[168:171], v1, s[44:47], s25 offen offset:2048 sc1
M a[16:19], v[160:163], a[216:219], a[16:19]
ds_read_b64_tr_b16 v[112:113], v30 offset:32768
ds_read_b64_tr_b16 v[114:115], v30 offset:34816
M a[16:19], v[164:167], a[220:223], a[16:19]
buffer_load_dwordx4 a[172:175], v1, s[44:47], s25 offen offset:3072 sc1
M a[20:23], v[172:175], a[220:223], a[20:23]
ds_read_b64_tr_b16 v[116:117], v30 offset:36864
ds_read_b64_tr_b16 v[118:119], v30 offset:38912
M a[20:23], v[168:171], a[216:219], a[20:23]
s_add_u32 s25, s25, 16384
s_add_u32 s26, s26, 131072
M a[24:27], v[176:179], a[216:219], a[24:27]
ds_read_b64_tr_b16 v[120:121], v31 offset:32768
ds_read_b64_tr_b16 v[122:123], v31 offset:34816
M a[24:27], v[180:183], a[220:223], a[24:27]
ds_read_b64_tr_b16 v[124:125], v31 offset:36864
ds_read_b64_tr_b16 v[126:127], v31 offset:38912
M a[28:31], v[188:191], a[220:223], a[28:31]
M a[28:31], v[184:187], a[216:219], a[28:31]
s_waitcnt vmcnt(6) lgkmcnt(0)
s_barrier
s_cmp_lg_u32 s101, 0
s_cbranch_scc1 Lk3f_7
v_mov_b32 v9, 1
s_mov_b64 exec, 1
buffer_store_dword v9, v11, s[52:55], s58 offen sc1
s_mov_b64 exec, -1
Lk3f_7:
M a[0:3], v[96:99], a[224:227], a[0:3]
s_add_u32 m0, s42, 49152
s_nop 0
buffer_load_dwordx4 v6, s[48:51], s26 offen offset:0 lds
ds_read_b64_tr_b16 v[160:161], v28 offset:49152
ds_read_b64_tr_b16 v[162:163], v28 offset:51200
M a[0:3], v[100:103], a[228:231], a[0:3]
buffer_load_dwordx4 v7, s[48:51], s26 offen offset:1024 lds
M a[4:7], v[108:111], a[228:231], a[4:7]
ds_read_b64_tr_b16 v[164:165], v28 offset:53248
ds_read_b64_tr_b16 v[166:167], v28 offset:55296
M a[4:7], v[104:107], a[224:227], a[4:7]
buffer_load_dwordx4 a[176:179], v1, s[44:47], s25 offen offset:0 sc1
M a[8:11], v[112:115], a[224:227], a[8:11]
ds_read_b64_tr_b16 v[168:169], v29 offset:49152
ds_read_b64_tr_b16 v[170:171], v29 offset:51200
M a[8:11], v[116:119], a[228:231], a[8:11]
buffer_load_dwordx4 a[180:183], v1, s[44:47], s25 offen offset:1024 sc1
M a[12:15], v[124:127], a[228:231], a[12:15]
ds_read_b64_tr_b16 v[172:173], v29 offset:53248
ds_read_b64_tr_b16 v[174:175], v29 offset:55296
M a[12:15], v[120:123], a[224:227], a[12:15]
buffer_load_dwordx4 a[184:187], v1, s[44:47], s25 offen offset:2048 sc1
M a[16:19], v[96:99], a[232:235], a[16:19]
ds_read_b64_tr_b16 v[176:177], v30 offset:49152
ds_read_b64_tr_b16 v[178:179], v30 offset:51200
M a[16:19], v[100:103], a[236:239], a[16:19]
buffer_load_dwordx4 a[188:191], v1, s[44:47], s25 offen offset:3072 sc1
M a[20:23], v[108:111], a[236:239], a[20:23]
ds_read_b64_tr_b16 v[180:181], v30 offset:53248
ds_read_b64_tr_b16 v[182:183], v30 offset:55296
M a[20:23], v[104:107], a[232:235], a[20:23]
s_add_u32 s25, s25, 16384
s_add_u32 s26, s26, 131072
M a[24:27], v[112:115], a[232:235], a[24:27]
ds_read_b64_tr_b16 v[184:185], v31 offset:49152
ds_read_b64_tr_b16 v[186:187], v31 offset:51200
M a[24:27], v[116:119], a[236:239], a[24:27]
ds_read_b64_tr_b16 v[188:189], v31 offset:53248
ds_read_b64_tr_b16 v[190:191], v31 offset:55296
M a[28:31], v[124:127], a[236:239], a[28:31]
M a[28:31], v[120:123], a[232:235], a[28:31]
s_waitcnt vmcnt(26) lgkmcnt(0)
s_barrier
M a[0:3], v[160:163], a[240:243], a[0:3]
ds_read_b64_tr_b16 v[96:97], v24 offset:0
ds_read_b64_tr_b16 v[98:99], v24 offset:2048
M a[0:3], v[164:167], a[244:247], a[0:3]
ds_read_b64_tr_b16 v[100:101], v24 offset:4096
ds_read_b64_tr_b16 v[102:103], v24 offset:6144
M a[4:7], v[172:175], a[244:247], a[4:7]
M a[4:7], v[168:171], a[240:243], a[4:7]
ds_read_b64_tr_b16 v[104:105], v25 offset:0
ds_read_b64_tr_b16 v[106:107], v25 offset:2048
M a[8:11], v[176:179], a[240:243], a[8:11]
M a[8:11], v[180:183], a[244:247], a[8:11]
ds_read_b64_tr_b16 v[108:109], v25 offset:4096
ds_read_b64_tr_b16 v[110:111], v25 offset:6144
M a[12:15], v[188:191], a[244:247], a[12:15]
M a[12:15], v[184:187], a[240:243], a[12:15]
ds_read_b64_tr_b16 v[112:113], v26 offset:0
ds_read_b64_tr_b16 v[114:115], v26 offset:2048
M a[16:19], v[160:163], a[248:251], a[16:19]
ds_read_b64_tr_b16 v[116:117], v26 offset:4096
ds_read_b64_tr_b16 v[118:119], v26 offset:6144
M a[16:19], v[164:167], a[252:255], a[16:19]
M a[20:23], v[172:175], a[252:255], a[20:23]
ds_read_b64_tr_b16 v[120:121], v27 offset:0
ds_read_b64_tr_b16 v[122:123], v27 offset:2048
M a[20:23], v[168:171], a[248:251], a[20:23]
M a[24:27], v[176:179], a[248:251], a[24:27]
ds_read_b64_tr_b16 v[124:125], v27 offset:4096
ds_read_b64_tr_b16 v[126:127], v27 offset:6144
M a[24:27], v[180:183], a[252:255], a[24:27]
M a[28:31], v[188:191], a[252:255], a[28:31]
M a[28:31], v[184:187], a[248:251], a[28:31]
s_waitcnt vmcnt(20) lgkmcnt(0)
s_barrier
M a[0:3], v[96:99], a[128:131], a[0:3]
ds_read_b64_tr_b16 v[160:161], v24 offset:16384
ds_read_b64_tr_b16 v[162:163], v24 offset:18432
M a[0:3], v[100:103], a[132:135], a[0:3]
ds_read_b64_tr_b16 v[164:165], v24 offset:20480
ds_read_b64_tr_b16 v[166:167], v24 offset:22528
M a[4:7], v[108:111], a[132:135], a[4:7]
M a[4:7], v[104:107], a[128:131], a[4:7]
ds_read_b64_tr_b16 v[168:169], v25 offset:16384
ds_read_b64_tr_b16 v[170:171], v25 offset:18432
M a[8:11], v[112:115], a[128:131], a[8:11]
M a[8:11], v[116:119], a[132:135], a[8:11]
ds_read_b64_tr_b16 v[172:173], v25 offset:20480
ds_read_b64_tr_b16 v[174:175], v25 offset:22528
M a[12:15], v[124:127], a[132:135], a[12:15]
M a[12:15], v[120:123], a[128:131], a[12:15]
ds_read_b64_tr_b16 v[176:177], v26 offset:16384
ds_read_b64_tr_b16 v[178:179], v26 offset:18432
M a[16:19], v[96:99], a[136:139], a[16:19]
ds_read_b64_tr_b16 v[180:181], v26 offset:20480
ds_read_b64_tr_b16 v[182:183], v26 offset:22528
M a[16:19], v[100:103], a[140:143], a[16:19]
M a[20:23], v[108:111], a[140:143], a[20:23]
ds_read_b64_tr_b16 v[184:185], v27 offset:16384
ds_read_b64_tr_b16 v[186:187], v27 offset:18432
M a[20:23], v[104:107], a[136:139], a[20:23]
M a[24:27], v[112:115], a[136:139], a[24:27]
ds_read_b64_tr_b16 v[188:189], v27 offset:20480
ds_read_b64_tr_b16 v[190:191], v27 offset:22528
M a[24:27], v[116:119], a[140:143], a[24:27]
M a[28:31], v[124:127], a[140:143], a[28:31]
M a[28:31], v[120:123], a[136:139], a[28:31]
s_waitcnt vmcnt(6) lgkmcnt(0)
s_barrier
M a[0:3], v[160:163], a[144:147], a[0:3]
buffer_load_dword v8, v11, s[52:55], s59 offen sc1
M a[0:3], v[164:167], a[148:151], a[0:3]
ds_read_b64_tr_b16 v[96:97], v24 offset:32768
ds_read_b64_tr_b16 v[98:99], v24 offset:34816
M a[4:7], v[172:175], a[148:151], a[4:7]
M a[4:7], v[168:171], a[144:147], a[4:7]
ds_read_b64_tr_b16 v[100:101], v24 offset:36864
ds_read_b64_tr_b16 v[102:103], v24 offset:38912
M a[8:11], v[176:179], a[144:147], a[8:11]
ds_read_b64_tr_b16 v[104:105], v25 offset:32768
ds_read_b64_tr_b16 v[106:107], v25 offset:34816
M a[8:11], v[180:183], a[148:151], a[8:11]
M a[12:15], v[188:191], a[148:151], a[12:15]
ds_read_b64_tr_b16 v[108:109], v25 offset:36864
ds_read_b64_tr_b16 v[110:111], v25 offset:38912
M a[12:15], v[184:187], a[144:147], a[12:15]
ds_read_b64_tr_b16 v[112:113], v26 offset:32768
ds_read_b64_tr_b16 v[114:115], v26 offset:34816
M a[16:19], v[160:163], a[152:155], a[16:19]
M a[16:19], v[164:167], a[156:159], a[16:19]
ds_read_b64_tr_b16 v[116:117], v26 offset:36864
ds_read_b64_tr_b16 v[118:119], v26 offset:38912
M a[20:23], v[172:175], a[156:159], a[20:23]
ds_read_b64_tr_b16 v[120:121], v27 offset:32768
ds_read_b64_tr_b16 v[122:123], v27 offset:34816
M a[20:23], v[168:171], a[152:155], a[20:23]
M a[24:27], v[176:179], a[152:155], a[24:27]
ds_read_b64_tr_b16 v[124:125], v27 offset:36864
ds_read_b64_tr_b16 v[126:127], v27 offset:38912
M a[24:27], v[180:183], a[156:159], a[24:27]
M a[28:31], v[188:191], a[156:159], a[28:31]
M a[28:31], v[184:187], a[152:155], a[28:31]
s_waitcnt vmcnt(1) lgkmcnt(0)
s_barrier
s_waitcnt vmcnt(0)
v_cmp_ne_u32 vcc, 1, v8
s_nop 0
s_cbranch_vccnz Lk3_spinfl
Lk3_gotfl:
M a[0:3], v[96:99], a[160:163], a[0:3]
s_add_u32 s60, s57, 0
buffer_load_dwordx4 v[224:227], v1, s[52:55], s60 offen offset:0 sc1
ds_read_b64_tr_b16 v[160:161], v24 offset:49152
ds_read_b64_tr_b16 v[162:163], v24 offset:51200
M a[0:3], v[100:103], a[164:167], a[0:3]
buffer_load_dwordx4 v[228:231], v1, s[52:55], s60 offen offset:1024 sc1
M a[4:7], v[108:111], a[164:167], a[4:7]
ds_read_b64_tr_b16 v[164:165], v24 offset:53248
ds_read_b64_tr_b16 v[166:167], v24 offset:55296
M a[4:7], v[104:107], a[160:163], a[4:7]
buffer_load_dwordx4 v[232:235], v1, s[52:55], s60 offen offset:2048 sc1
M a[8:11], v[112:115], a[160:163], a[8:11]
ds_read_b64_tr_b16 v[168:169], v25 offset:49152
ds_read_b64_tr_b16 v[170:171], v25 offset:51200
M a[8:11], v[116:119], a[164:167], a[8:11]
buffer_load_dwordx4 v[236:239], v1, s[52:55], s60 offen offset:3072 sc1
M a[12:15], v[124:127], a[164:167], a[12:15]
ds_read_b64_tr_b16 v[172:173], v25 offset:53248
ds_read_b64_tr_b16 v[174:175], v25 offset:55296
M a[12:15], v[120:123], a[160:163], a[12:15]
s_add_u32 s60, s57, 4096
buffer_load_dwordx4 v[240:243], v1, s[52:55], s60 offen offset:0 sc1
ds_read_b64_tr_b16 v[176:177], v26 offset:49152
ds_read_b64_tr_b16 v[178:179], v26 offset:51200
M a[16:19], v[96:99], a[168:171], a[16:19]
buffer_load_dwordx4 v[244:247], v1, s[52:55], s60 offen offset:1024 sc1
M a[16:19], v[100:103], a[172:175], a[16:19]
ds_read_b64_tr_b16 v[180:181], v26 offset:53248
ds_read_b64_tr_b16 v[182:183], v26 offset:55296
M a[20:23], v[108:111], a[172:175], a[20:23]
buffer_load_dwordx4 v[248:251], v1, s[52:55], s60 offen offset:2048 sc1
M a[20:23], v[104:107], a[168:171], a[20:23]
ds_read_b64_tr_b16 v[184:185], v27 offset:49152
ds_read_b64_tr_b16 v[186:187], v27 offset:51200
M a[24:27], v[112:115], a[168:171], a[24:27]
buffer_load_dwordx4 v[252:255], v1, s[52:55], s60 offen offset:3072 sc1
M a[24:27], v[116:119], a[172:175], a[24:27]
ds_read_b64_tr_b16 v[188:189], v27 offset:53248
ds_read_b64_tr_b16 v[190:191], v27 offset:55296
M a[28:31], v[124:127], a[172:175], a[28:31]
M a[28:31], v[120:123], a[168:171], a[28:31]
s_waitcnt lgkmcnt(0)
M a[0:3], v[160:163], a[176:179], a[0:3]
M a[0:3], v[164:167], a[180:183], a[0:3]
M a[4:7], v[172:175], a[180:183], a[4:7]
M a[4:7], v[168:171], a[176:179], a[4:7]
M a[8:11], v[176:179], a[176:179], a[8:11]
M a[8:11], v[180:183], a[180:183], a[8:11]
M a[12:15], v[188:191], a[180:183], a[12:15]
M a[12:15], v[184:187], a[176:179], a[12:15]
M a[16:19], v[160:163], a[184:187], a[16:19]
M a[16:19], v[164:167], a[188:191], a[16:19]
M a[20:23], v[172:175], a[188:191], a[20:23]
M a[20:23], v[168:171], a[184:187], a[20:23]
M a[24:27], v[176:179], a[184:187], a[24:27]
M a[24:27], v[180:183], a[188:191], a[24:27]
M a[28:31], v[188:191], a[188:191], a[28:31]
M a[28:31], v[184:187], a[184:187], a[28:31]
v_bfe_u32 v96, v0, 4, 1
v_lshrrev_b32 v97, 5, v0
v_lshl_or_b32 v96, v96, 1, v97
v_and_b32 v97, 15, v0
v_lshlrev_b32 v97, 13, v97
v_lshl_add_u32 v96, v96, 4, v97
s_and_b32 s3, s101, 1
s_lshl_b32 s3, s3, 6
s_lshr_b32 s6, s101, 1
s_add_u32 s3, s3, s6
s_add_u32 s3, s3, s21
s_lshl_b32 s3, s3, 12
s_lshl_b32 s6, s22, 1
s_add_u32 s3, s3, s6
s_add_u32 s3, s3, 2048
v_accvgpr_read_b32 v108, a0
v_accvgpr_read_b32 v109, a1
v_accvgpr_read_b32 v110, a2
v_accvgpr_read_b32 v111, a3
v_accvgpr_read_b32 v112, a4
v_accvgpr_read_b32 v113, a5
v_accvgpr_read_b32 v114, a6
v_accvgpr_read_b32 v115, a7
v_cvt_pk_bf16_f32 v100, v108, v109
v_cvt_pk_bf16_f32 v101, v110, v111
v_cvt_pk_bf16_f32 v102, v112, v113
v_cvt_pk_bf16_f32 v103, v114, v115
s_nop 0
v_permlane16_swap_b32 v100, v102
v_permlane16_swap_b32 v101, v103
buffer_store_dwordx4 v[100:103], v96, s[16:19], s3 offen offset:0
v_accvgpr_read_b32 v108, a8
v_accvgpr_read_b32 v109, a9
v_accvgpr_read_b32 v110, a10
v_accvgpr_read_b32 v111, a11
v_accvgpr_read_b32 v112, a12
v_accvgpr_read_b32 v113, a13
v_accvgpr_read_b32 v114, a14
v_accvgpr_read_b32 v115, a15
v_cvt_pk_bf16_f32 v104, v108, v109
v_cvt_pk_bf16_f32 v105, v110, v111
v_cvt_pk_bf16_f32 v106, v112, v113
v_cvt_pk_bf16_f32 v107, v114, v115
s_nop 0
v_permlane16_swap_b32 v104, v106
v_permlane16_swap_b32 v105, v107
buffer_store_dwordx4 v[104:107], v96, s[16:19], s3 offen offset:64
s_add_u32 s3, s3, 131072
v_accvgpr_read_b32 v108, a16
v_accvgpr_read_b32 v109, a17
v_accvgpr_read_b32 v110, a18
v_accvgpr_read_b32 v111, a19
v_accvgpr_read_b32 v112, a20
v_accvgpr_read_b32 v113, a21
v_accvgpr_read_b32 v114, a22
v_accvgpr_read_b32 v115, a23
v_cvt_pk_bf16_f32 v100, v108, v109
v_cvt_pk_bf16_f32 v101, v110, v111
v_cvt_pk_bf16_f32 v102, v112, v113
v_cvt_pk_bf16_f32 v103, v114, v115
s_nop 0
v_permlane16_swap_b32 v100, v102
v_permlane16_swap_b32 v101, v103
buffer_store_dwordx4 v[100:103], v96, s[16:19], s3 offen offset:0
v_accvgpr_read_b32 v108, a24
v_accvgpr_read_b32 v109, a25
v_accvgpr_read_b32 v110, a26
v_accvgpr_read_b32 v111, a27
v_accvgpr_read_b32 v112, a28
v_accvgpr_read_b32 v113, a29
v_accvgpr_read_b32 v114, a30
v_accvgpr_read_b32 v115, a31
v_cvt_pk_bf16_f32 v104, v108, v109
v_cvt_pk_bf16_f32 v105, v110, v111
v_cvt_pk_bf16_f32 v106, v112, v113
v_cvt_pk_bf16_f32 v107, v114, v115
s_nop 0
v_permlane16_swap_b32 v104, v106
v_permlane16_swap_b32 v105, v107
buffer_store_dwordx4 v[104:107], v96, s[16:19], s3 offen offset:64
v_bfe_u32 v128, v0, 4, 1
v_lshrrev_b32 v129, 5, v0
v_lshl_or_b32 v128, v128, 1, v129
v_and_b32 v129, 15, v0
v_lshlrev_b32 v129, 12, v129
v_lshl_add_u32 v128, v128, 4, v129
s_lshl_b32 s3, s101, 5
s_add_u32 s3, s3, s29
s_lshl_b32 s3, s3, 12
s_lshl_b32 s6, s30, 1
s_add_u32 s3, s3, s6
s_waitcnt vmcnt(4)
v_pk_add_f32 v[32:33], v[32:33], v[224:225]
v_pk_add_f32 v[34:35], v[34:35], v[226:227]
v_pk_add_f32 v[36:37], v[36:37], v[228:229]
v_pk_add_f32 v[38:39], v[38:39], v[230:231]
v_cvt_pk_bf16_f32 v132, v32, v33
v_cvt_pk_bf16_f32 v133, v34, v35
v_cvt_pk_bf16_f32 v134, v36, v37
v_cvt_pk_bf16_f32 v135, v38, v39
s_nop 0
v_permlane16_swap_b32 v132, v134
v_permlane16_swap_b32 v133, v135
buffer_store_dwordx4 v[132:135], v128, s[16:19], s3 offen offset:0
v_pk_add_f32 v[40:41], v[40:41], v[232:233]
v_pk_add_f32 v[42:43], v[42:43], v[234:235]
v_pk_add_f32 v[44:45], v[44:45], v[236:237]
v_pk_add_f32 v[46:47], v[46:47], v[238:239]
v_cvt_pk_bf16_f32 v136, v40, v41
v_cvt_pk_bf16_f32 v137, v42, v43
v_cvt_pk_bf16_f32 v138, v44, v45
v_cvt_pk_bf16_f32 v139, v46, v47
s_nop 0
v_permlane16_swap_b32 v136, v138
v_permlane16_swap_b32 v137, v139
buffer_store_dwordx4 v[136:139], v128, s[16:19], s3 offen offset:64
s_add_u32 s3, s3, 65536
v_pk_add_f32 v[64:65], v[64:65], v[240:241]
v_pk_add_f32 v[66:67], v[66:67], v[242:243]
v_pk_add_f32 v[68:69], v[68:69], v[244:245]
v_pk_add_f32 v[70:71], v[70:71], v[246:247]
v_cvt_pk_bf16_f32 v132, v64, v65
v_cvt_pk_bf16_f32 v133, v66, v67
v_cvt_pk_bf16_f32 v134, v68, v69
v_cvt_pk_bf16_f32 v135, v70, v71
s_nop 0
v_permlane16_swap_b32 v132, v134
v_permlane16_swap_b32 v133, v135
buffer_store_dwordx4 v[132:135], v128, s[16:19], s3 offen offset:0
v_pk_add_f32 v[72:73], v[72:73], v[248:249]
v_pk_add_f32 v[74:75], v[74:75], v[250:251]
v_pk_add_f32 v[76:77], v[76:77], v[252:253]
v_pk_add_f32 v[78:79], v[78:79], v[254:255]
v_cvt_pk_bf16_f32 v136, v72, v73
v_cvt_pk_bf16_f32 v137, v74, v75
v_cvt_pk_bf16_f32 v138, v76, v77
v_cvt_pk_bf16_f32 v139, v78, v79
s_nop 0
v_permlane16_swap_b32 v136, v138
v_permlane16_swap_b32 v137, v139
buffer_store_dwordx4 v[136:139], v128, s[16:19], s3 offen offset:64
s_endpgm
Lk3_spinb0:
Lk3_spinb0_:
s_add_u32 s61, s61, 1
s_cmp_gt_u32 s61, 1048576
s_cbranch_scc1 Lk3_gotb0
s_sleep 2
buffer_load_dword v7, v15, s[52:55], s43 offen sc1
s_waitcnt vmcnt(0)
v_cmp_ne_u32 vcc, 1, v7
s_nop 0
s_cbranch_vccnz Lk3_spinb0_
s_branch Lk3_gotb0
Lk3_spinb1:
Lk3_spinb1_:
s_add_u32 s61, s61, 1
s_cmp_gt_u32 s61, 1048576
s_cbranch_scc1 Lk3_gotb1
s_sleep 2
buffer_load_dword v7, v15, s[52:55], s43 offen sc1
s_waitcnt vmcnt(0)
v_cmp_ne_u32 vcc, 1, v7
s_nop 0
s_cbranch_vccnz Lk3_spinb1_
s_branch Lk3_gotb1
Lk3_spinft:
s_add_u32 s61, s61, 1
s_cmp_gt_u32 s61, 1048576
s_cbranch_scc1 Lk3_gotft
s_sleep 2
buffer_load_dword v252, v255, s[52:55], s62 offen sc1
s_waitcnt vmcnt(0)
v_cmp_ne_u32 vcc, 1, v252
s_nop 0
s_cbranch_vccnz Lk3_spinft
s_branch Lk3_gotft
Lk3_spinfl:
s_add_u32 s61, s61, 1
s_cmp_gt_u32 s61, 1048576
s_cbranch_scc1 Lk3_gotfl
s_sleep 2
buffer_load_dword v8, v11, s[52:55], s59 offen sc1
s_waitcnt vmcnt(0)
v_cmp_ne_u32 vcc, 1, v8
s_nop 0
s_cbranch_vccnz Lk3_spinfl
s_branch Lk3_gotfl
Lc3:
.section .rodata,"a"
.p2align 6
.amdhsa_kernel concat_heads__compressed_kv_cla__sliding_local_dilated__prompt_kernel
  .amdhsa_next_free_vgpr 512
  .amdhsa_next_free_sgpr 102
  .amdhsa_accum_offset 256
  .amdhsa_group_segment_fixed_size 0
  .amdhsa_kernarg_size 96
  .amdhsa_user_sgpr_count 2
  .amdhsa_user_sgpr_kernarg_segment_ptr 1
  .amdhsa_system_sgpr_workgroup_id_x 1
.end_amdhsa_kernel
```

```asm
; @launch grid=(256,1,1) block=(256,1,1) lds=163840
.amdgcn_target "amdgcn-amd-amdhsa--gfx950"
.text
.macro M d, a, b, c
v_mfma_f32_16x16x32_bf16 \d, \a, \b, \c
.endm
.globl concat_heads__compressed_kv_cla__sliding_local_dilated__prompt_kernel
.p2align 8
.type concat_heads__compressed_kv_cla__sliding_local_dilated__prompt_kernel,@function
concat_heads__compressed_kv_cla__sliding_local_dilated__prompt_kernel:
s_cmp_lt_u32 s2, 256
s_cbranch_scc1 Lk1_go
s_endpgm
Lk1_go:
s_load_dwordx16 s[32:47], s[0:1], 0
s_load_dwordx2 s[48:49], s[0:1], 64
s_load_dwordx2 s[50:51], s[0:1], 88
s_load_dwordx2 s[90:91], s[0:1], 80
v_lshrrev_b32 v24, 6, v0
s_nop 0
v_readfirstlane_b32 s20, v24
v_and_b32 v0, 63, v0
v_lshlrev_b32 v1, 4, v0
s_mov_b32 s101, s20
s_lshr_b32 s21, s20, 1
s_and_b32 s22, s20, 1
s_lshl_b32 s29, s20, 12
s_and_b32 s3, s2, 1
s_lshl_b32 s3, s3, 2
s_bfe_u32 s6, s2, 0x20003
s_add_u32 s3, s3, s6
s_lshl_b32 s52, s3, 8
s_bfe_u32 s3, s2, 0x20001
s_lshl_b32 s3, s3, 2
s_bfe_u32 s7, s2, 0x20005
s_add_u32 s3, s3, s7
s_lshl_b32 s53, s3, 8
s_cmp_lt_u32 s2, 128
s_cselect_b32 s5, 11, 10
s_lshl_b32 s3, s21, 7
s_lshl_b32 s4, s22, 5
s_add_u32 s3, s3, s4
v_lshrrev_b32 v24, 3, v0
v_add_u32 v24, s3, v24
v_and_b32 v25, 7, v0
v_add_u32 v26, 0, v24
v_bfe_u32 v27, v26, 1, 3
v_xor_b32 v27, v27, v25
v_lshlrev_b32 v26, s5, v26
v_lshl_add_u32 v26, v27, 4, v26
v_subrev_u32 v2, 0, v26
v_add_u32 v26, 8, v24
v_bfe_u32 v27, v26, 1, 3
v_xor_b32 v27, v27, v25
v_lshlrev_b32 v26, s5, v26
v_lshl_add_u32 v26, v27, 4, v26
v_subrev_u32 v3, 1024, v26
v_add_u32 v26, 16, v24
v_bfe_u32 v27, v26, 1, 3
v_xor_b32 v27, v27, v25
v_lshlrev_b32 v26, s5, v26
v_lshl_add_u32 v26, v27, 4, v26
v_subrev_u32 v4, 2048, v26
v_add_u32 v26, 24, v24
v_bfe_u32 v27, v26, 1, 3
v_xor_b32 v27, v27, v25
v_lshlrev_b32 v26, s5, v26
v_lshl_add_u32 v26, v27, 4, v26
v_subrev_u32 v5, 3072, v26
s_lshl_b32 s3, s20, 3
v_lshrrev_b32 v24, 5, v0
v_add_u32 v24, s3, v24
v_and_b32 v25, 31, v0
v_add_u32 v26, 0, v24
v_and_b32 v27, 3, v26
v_lshlrev_b32 v27, 1, v27
v_and_or_b32 v27, v26, 8, v27
v_xor_b32 v27, v27, v25
v_lshlrev_b32 v26, 13, v26
v_lshl_add_u32 v26, v27, 4, v26
v_subrev_u32 v6, 0, v26
v_add_u32 v26, 2, v24
v_and_b32 v27, 3, v26
v_lshlrev_b32 v27, 1, v27
v_and_or_b32 v27, v26, 8, v27
v_xor_b32 v27, v27, v25
v_lshlrev_b32 v26, 13, v26
v_lshl_add_u32 v26, v27, 4, v26
v_subrev_u32 v7, 1024, v26
v_add_u32 v26, 4, v24
v_and_b32 v27, 3, v26
v_lshlrev_b32 v27, 1, v27
v_and_or_b32 v27, v26, 8, v27
v_xor_b32 v27, v27, v25
v_lshlrev_b32 v26, 13, v26
v_lshl_add_u32 v26, v27, 4, v26
v_subrev_u32 v8, 2048, v26
v_add_u32 v26, 6, v24
v_and_b32 v27, 3, v26
v_lshlrev_b32 v27, 1, v27
v_and_or_b32 v27, v26, 8, v27
v_xor_b32 v27, v27, v25
v_lshlrev_b32 v26, 13, v26
v_lshl_add_u32 v26, v27, 4, v26
v_subrev_u32 v9, 3072, v26
s_lshl_b32 s23, s52, s5
s_lshl_b32 s31, 64, s5
s_mov_b32 s26, s23
s_lshl_b32 s24, s53, 1
s_mov_b32 s28, s24
s_lshl_b32 s3, 1, s5
s_add_u32 s25, s23, s3
s_lshl_b32 s3, s3, 12
s_add_u32 s27, s24, s3
s_bfe_u32 s3, s2, 0x20001
s_and_b32 s4, s2, 1
s_lshl_b32 s4, s4, 1
s_add_u32 s3, s3, s4
s_and_b32 s3, s3, 3
s_sub_u32 s4, s5, 2
s_lshl_b32 s3, s3, s4
s_add_u32 s23, s23, s3
s_lshl_b32 s3, s3, 12
s_add_u32 s24, s24, s3
s_mov_b32 s95, s6
s_cmp_lt_u32 s2, 128
s_cselect_b32 s6, -1, 8
s_waitcnt lgkmcnt(0)
s_cmp_lt_u32 s2, 128
s_cselect_b64 s[8:9], s[32:33], s[34:35]
s_mov_b32 s10, 2097152
s_cselect_b32 s10, 4194304, s10
s_mov_b32 s11, 0x00020000
s_cselect_b64 s[12:13], s[36:37], s[38:39]
s_mov_b32 s14, 4194304
s_cselect_b32 s14, 8388608, s14
s_mov_b32 s15, 0x00020000
s_mov_b64 s[64:65], s[40:41]
s_add_u32 m0, s29, 65536
s_nop 0
buffer_load_dwordx4 v6, s[12:15], s24 offen offset:0 lds
buffer_load_dwordx4 v7, s[12:15], s24 offen offset:1024 lds
buffer_load_dwordx4 v8, s[12:15], s24 offen offset:2048 lds
buffer_load_dwordx4 v9, s[12:15], s24 offen offset:3072 lds
s_add_u32 s24, s24, 262144
s_add_u32 m0, s29, 0
s_nop 0
buffer_load_dwordx4 v2, s[8:11], s23 offen offset:0 lds
buffer_load_dwordx4 v3, s[8:11], s23 offen offset:1024 lds
buffer_load_dwordx4 v4, s[8:11], s23 offen offset:2048 lds
buffer_load_dwordx4 v5, s[8:11], s23 offen offset:3072 lds
s_add_u32 m0, s29, 81920
s_nop 0
buffer_load_dwordx4 v6, s[12:15], s24 offen offset:0 lds
buffer_load_dwordx4 v7, s[12:15], s24 offen offset:1024 lds
buffer_load_dwordx4 v8, s[12:15], s24 offen offset:2048 lds
buffer_load_dwordx4 v9, s[12:15], s24 offen offset:3072 lds
s_add_u32 s24, s24, 262144
s_cmp_eq_u32 s24, s27
s_cselect_b32 s24, s28, s24
s_sub_u32 s6, s6, 1
s_cmp_eq_u32 s6, 0
s_cselect_b64 s[12:13], s[64:65], s[12:13]
s_add_u32 s16, s50, 109051904
s_addc_u32 s17, s51, 0
s_mov_b32 s18, 16384
s_mov_b32 s19, 0x00020000
v_mov_b32 v24, 0
v_mov_b32 v25, 0
v_mov_b32 v26, 0
v_mov_b32 v27, 0
s_lshl_b32 s3, s2, 2
buffer_store_dword v24, v24, s[16:19], s3 offen sc1
s_and_b32 s3, s2, 7
s_lshr_b32 s4, s2, 6
s_lshl_b32 s4, s4, 3
s_add_u32 s3, s3, s4
s_lshl_b32 s3, s3, 4
s_add_u32 s3, s3, 4096
s_bfe_u32 s4, s2, 0x30003
s_lshl_b32 s4, s4, 9
s_add_u32 s92, s3, s4
s_sub_u32 s4, 7680, s4
s_add_u32 s93, s3, s4
buffer_store_dwordx4 v[24:27], v24, s[16:19], s92 offen sc1
buffer_store_dwordx4 v[24:27], v24, s[16:19], s93 offen sc1
s_and_b32 s3, s2, 1
s_lshl_b32 s3, s3, 3
s_bfe_u32 s4, s2, 0x30003
s_add_u32 s92, s3, s4
s_bfe_u32 s3, s2, 0x20001
s_lshl_b32 s3, s3, 2
s_lshr_b32 s4, s2, 6
s_xor_b32 s4, s4, 2
s_add_u32 s93, s3, s4
s_lshl_b32 s92, s92, 8
s_lshl_b32 s93, s93, 4
s_add_u32 s92, s92, s93
s_add_u32 s92, s92, 12288
buffer_store_dwordx4 v[24:27], v24, s[16:19], s92 offen sc1
v_lshlrev_b32 v20, 7, v0
s_lshl_b32 s54, s2, 13
s_mov_b64 s[60:61], s[40:41]
s_mov_b32 s62, 0
s_cmp_eq_u32 s20, 1
s_cselect_b64 s[60:61], s[46:47], s[60:61]
s_cselect_b32 s62, 6291456, s62
s_cmp_eq_u32 s20, 2
s_cselect_b64 s[60:61], s[44:45], s[60:61]
s_cselect_b32 s62, 4194304, s62
s_cmp_eq_u32 s20, 3
s_cselect_b32 s62, 0, s62
s_mov_b32 s63, 0x00020000
s_mov_b32 s3, 0
s_cmp_eq_u32 s20, 1
s_cselect_b32 s3, 6291456, s3
s_cmp_eq_u32 s20, 2
s_cselect_b32 s3, 6291456, s3
s_sub_u32 s54, s54, s3
Lc0:
s_add_u32 m0, s29, 98304
s_nop 0
buffer_load_dwordx4 v6, s[12:15], s24 offen offset:0 lds
buffer_load_dwordx4 v7, s[12:15], s24 offen offset:1024 lds
buffer_load_dwordx4 v8, s[12:15], s24 offen offset:2048 lds
buffer_load_dwordx4 v9, s[12:15], s24 offen offset:3072 lds
s_add_u32 s24, s24, 262144
s_lshl_b32 s4, s21, 13
v_and_b32 v24, 15, v0
v_lshlrev_b32 v24, 7, v24
v_add_u32 v24, s4, v24
v_bfe_u32 v25, v0, 1, 3
v_lshrrev_b32 v26, 4, v0
v_xor_b32 v25, v25, v26
v_lshl_add_u32 v10, v25, 4, v24
v_xor_b32 v11, 64, v10
v_bfe_u32 v24, v0, 2, 2
v_lshl_add_u32 v29, v26, 3, v24
v_lshlrev_b32 v25, 9, v29
v_and_b32 v27, 1, v0
v_lshl_add_u32 v25, v27, 3, v25
v_add_u32 v25, 65536, v25
v_lshlrev_b32 v24, 1, v24
v_and_or_b32 v24, v29, 8, v24
v_bfe_u32 v26, v0, 1, 1
s_lshl_b32 s4, s22, 4
s_add_u32 s3, s4, 0
v_add_u32 v27, s3, v26
v_xor_b32 v27, v27, v24
v_lshl_add_u32 v12, v27, 4, v25
s_add_u32 s3, s4, 2
v_add_u32 v27, s3, v26
v_xor_b32 v27, v27, v24
v_lshl_add_u32 v13, v27, 4, v25
s_add_u32 s3, s4, 4
v_add_u32 v27, s3, v26
v_xor_b32 v27, v27, v24
v_lshl_add_u32 v14, v27, 4, v25
s_add_u32 s3, s4, 6
v_add_u32 v27, s3, v26
v_xor_b32 v27, v27, v24
v_lshl_add_u32 v15, v27, 4, v25
s_add_u32 s3, s4, 8
v_add_u32 v27, s3, v26
v_xor_b32 v27, v27, v24
v_lshl_add_u32 v16, v27, 4, v25
s_add_u32 s3, s4, 10
v_add_u32 v27, s3, v26
v_xor_b32 v27, v27, v24
v_lshl_add_u32 v17, v27, 4, v25
s_add_u32 s3, s4, 12
v_add_u32 v27, s3, v26
v_xor_b32 v27, v27, v24
v_lshl_add_u32 v18, v27, 4, v25
s_add_u32 s3, s4, 14
v_add_u32 v27, s3, v26
v_xor_b32 v27, v27, v24
v_lshl_add_u32 v19, v27, 4, v25
s_waitcnt vmcnt(8)
s_barrier
ds_read_b64_tr_b16 a[32:33], v12 offset:0
ds_read_b64_tr_b16 a[34:35], v12 offset:2048
ds_read_b64_tr_b16 a[40:41], v13 offset:0
ds_read_b64_tr_b16 a[42:43], v13 offset:2048
ds_read_b64_tr_b16 a[48:49], v14 offset:0
ds_read_b64_tr_b16 a[50:51], v14 offset:2048
ds_read_b64_tr_b16 a[56:57], v15 offset:0
ds_read_b64_tr_b16 a[58:59], v15 offset:2048
ds_read_b64_tr_b16 a[64:65], v16 offset:0
ds_read_b64_tr_b16 a[66:67], v16 offset:2048
ds_read_b64_tr_b16 a[72:73], v17 offset:0
ds_read_b64_tr_b16 a[74:75], v17 offset:2048
ds_read_b64_tr_b16 a[80:81], v18 offset:0
ds_read_b64_tr_b16 a[82:83], v18 offset:2048
ds_read_b64_tr_b16 a[88:89], v19 offset:0
ds_read_b64_tr_b16 a[90:91], v19 offset:2048
ds_read_b64_tr_b16 a[36:37], v12 offset:16384
ds_read_b64_tr_b16 a[38:39], v12 offset:18432
ds_read_b64_tr_b16 a[44:45], v13 offset:16384
ds_read_b64_tr_b16 a[46:47], v13 offset:18432
ds_read_b64_tr_b16 a[52:53], v14 offset:16384
ds_read_b64_tr_b16 a[54:55], v14 offset:18432
ds_read_b64_tr_b16 a[60:61], v15 offset:16384
ds_read_b64_tr_b16 a[62:63], v15 offset:18432
ds_read_b64_tr_b16 a[68:69], v16 offset:16384
ds_read_b64_tr_b16 a[70:71], v16 offset:18432
ds_read_b64_tr_b16 a[76:77], v17 offset:16384
ds_read_b64_tr_b16 a[78:79], v17 offset:18432
ds_read_b64_tr_b16 a[84:85], v18 offset:16384
ds_read_b64_tr_b16 a[86:87], v18 offset:18432
ds_read_b64_tr_b16 a[92:93], v19 offset:16384
ds_read_b64_tr_b16 a[94:95], v19 offset:18432
ds_read_b128 a[160:163], v10 offset:0
ds_read_b128 a[164:167], v11 offset:0
ds_read_b128 a[168:171], v10 offset:2048
ds_read_b128 a[172:175], v11 offset:2048
s_add_u32 m0, s29, 16384
s_add_u32 s3, s23, s31
s_nop 0
buffer_load_dwordx4 v2, s[8:11], s3 offen offset:0 lds
buffer_load_dwordx4 v3, s[8:11], s3 offen offset:1024 lds
buffer_load_dwordx4 v4, s[8:11], s3 offen offset:2048 lds
buffer_load_dwordx4 v5, s[8:11], s3 offen offset:3072 lds
s_add_u32 s23, s23, 128
s_cmp_eq_u32 s23, s25
s_cselect_b32 s23, s26, s23
s_add_u32 m0, s29, 114688
s_nop 0
buffer_load_dwordx4 v6, s[12:15], s24 offen offset:0 lds
buffer_load_dwordx4 v7, s[12:15], s24 offen offset:1024 lds
buffer_load_dwordx4 v8, s[12:15], s24 offen offset:2048 lds
buffer_load_dwordx4 v9, s[12:15], s24 offen offset:3072 lds
s_add_u32 s24, s24, 262144
s_cmp_eq_u32 s24, s27
s_cselect_b32 s24, s28, s24
s_sub_u32 s6, s6, 1
s_cmp_eq_u32 s6, 0
s_cselect_b64 s[12:13], s[64:65], s[12:13]
s_waitcnt vmcnt(8) lgkmcnt(0)
s_barrier
s_getpc_b64 s[92:93]
Lpc_1:
s_add_u32 s92, s92, Lc1-Lpc_1
s_addc_u32 s93, s93, 0
s_lshr_b32 s94, s2, 3
s_mul_i32 s94, s94, ((Lc3-Lc1)/32+127)&~127
v_lshlrev_b32 v24, 7, v0
v_add_u32 v24, s94, v24
v_min_u32 v24, Lc3-Lc1-4, v24
global_load_dword v21, v24, s[92:93]
Lc1:
s_cmp_lt_u32 s2, 128
s_cbranch_scc0 Lk1_kv
M v[32:35], a[32:35], a[160:163], 0
s_add_u32 m0, s29, 32768
s_nop 0
buffer_load_dwordx4 v2, s[8:11], s23 offen offset:0 lds
M v[32:35], a[36:39], a[164:167], v[32:35]
ds_read_b128 a[176:179], v10 offset:4096
ds_read_b128 a[180:183], v11 offset:4096
M v[36:39], a[44:47], a[164:167], 0
M v[36:39], a[40:43], a[160:163], v[36:39]
ds_read_b64_tr_b16 a[96:97], v12 offset:32768
ds_read_b64_tr_b16 a[98:99], v12 offset:34816
M v[40:43], a[48:51], a[160:163], 0
M v[40:43], a[52:55], a[164:167], v[40:43]
buffer_load_dwordx4 v3, s[8:11], s23 offen offset:1024 lds
M v[44:47], a[60:63], a[164:167], 0
M v[44:47], a[56:59], a[160:163], v[44:47]
ds_read_b64_tr_b16 a[104:105], v13 offset:32768
ds_read_b64_tr_b16 a[106:107], v13 offset:34816
M v[48:51], a[64:67], a[160:163], 0
M v[48:51], a[68:71], a[164:167], v[48:51]
buffer_load_dwordx4 v4, s[8:11], s23 offen offset:2048 lds
M v[52:55], a[76:79], a[164:167], 0
M v[52:55], a[72:75], a[160:163], v[52:55]
ds_read_b64_tr_b16 a[112:113], v14 offset:32768
ds_read_b64_tr_b16 a[114:115], v14 offset:34816
M v[56:59], a[80:83], a[160:163], 0
M v[56:59], a[84:87], a[164:167], v[56:59]
buffer_load_dwordx4 v5, s[8:11], s23 offen offset:3072 lds
M v[60:63], a[92:95], a[164:167], 0
M v[60:63], a[88:91], a[160:163], v[60:63]
ds_read_b64_tr_b16 a[120:121], v15 offset:32768
ds_read_b64_tr_b16 a[122:123], v15 offset:34816
M v[64:67], a[32:35], a[168:171], 0
M v[64:67], a[36:39], a[172:175], v[64:67]
ds_read_b128 a[184:187], v10 offset:6144
ds_read_b128 a[188:191], v11 offset:6144
M v[68:71], a[44:47], a[172:175], 0
s_add_u32 m0, s29, 65536
s_nop 0
buffer_load_dwordx4 v6, s[12:15], s24 offen offset:0 lds
M v[68:71], a[40:43], a[168:171], v[68:71]
ds_read_b64_tr_b16 a[128:129], v16 offset:32768
ds_read_b64_tr_b16 a[130:131], v16 offset:34816
M v[72:75], a[48:51], a[168:171], 0
M v[72:75], a[52:55], a[172:175], v[72:75]
M v[76:79], a[60:63], a[172:175], 0
buffer_load_dwordx4 v7, s[12:15], s24 offen offset:1024 lds
M v[76:79], a[56:59], a[168:171], v[76:79]
ds_read_b64_tr_b16 a[136:137], v17 offset:32768
ds_read_b64_tr_b16 a[138:139], v17 offset:34816
M v[80:83], a[64:67], a[168:171], 0
M v[80:83], a[68:71], a[172:175], v[80:83]
M v[84:87], a[76:79], a[172:175], 0
buffer_load_dwordx4 v8, s[12:15], s24 offen offset:2048 lds
M v[84:87], a[72:75], a[168:171], v[84:87]
ds_read_b64_tr_b16 a[144:145], v18 offset:32768
ds_read_b64_tr_b16 a[146:147], v18 offset:34816
M v[88:91], a[80:83], a[168:171], 0
M v[88:91], a[84:87], a[172:175], v[88:91]
M v[92:95], a[92:95], a[172:175], 0
buffer_load_dwordx4 v9, s[12:15], s24 offen offset:3072 lds
M v[92:95], a[88:91], a[168:171], v[92:95]
s_waitcnt lgkmcnt(15)
ds_read_b64_tr_b16 a[152:153], v19 offset:32768
ds_read_b64_tr_b16 a[154:155], v19 offset:34816
M v[96:99], a[32:35], a[176:179], 0
M v[96:99], a[36:39], a[180:183], v[96:99]
M v[100:103], a[44:47], a[180:183], 0
s_add_u32 s24, s24, 262144
M v[100:103], a[40:43], a[176:179], v[100:103]
M v[104:107], a[48:51], a[176:179], 0
M v[104:107], a[52:55], a[180:183], v[104:107]
M v[108:111], a[60:63], a[180:183], 0
M v[108:111], a[56:59], a[176:179], v[108:111]
s_waitcnt vmcnt(9) lgkmcnt(0)
s_barrier
ds_read_b128 a[160:163], v10 offset:16384
ds_read_b128 a[164:167], v11 offset:16384
M v[112:115], a[64:67], a[176:179], 0
s_add_u32 m0, s29, 49152
s_add_u32 s3, s23, s31
buffer_load_dwordx4 v2, s[8:11], s3 offen offset:0 lds
M v[112:115], a[68:71], a[180:183], v[112:115]
M v[116:119], a[76:79], a[180:183], 0
M v[116:119], a[72:75], a[176:179], v[116:119]
ds_read_b64_tr_b16 a[100:101], v12 offset:49152
ds_read_b64_tr_b16 a[102:103], v12 offset:51200
M v[120:123], a[80:83], a[176:179], 0
M v[120:123], a[84:87], a[180:183], v[120:123]
buffer_load_dwordx4 v3, s[8:11], s3 offen offset:1024 lds
M v[124:127], a[92:95], a[180:183], 0
M v[124:127], a[88:91], a[176:179], v[124:127]
M v[128:131], a[32:35], a[184:187], 0
M v[128:131], a[36:39], a[188:191], v[128:131]
ds_read_b128 a[168:171], v10 offset:18432
ds_read_b128 a[172:175], v11 offset:18432
ds_read_b64_tr_b16 a[108:109], v13 offset:49152
ds_read_b64_tr_b16 a[110:111], v13 offset:51200
M v[132:135], a[44:47], a[188:191], 0
M v[132:135], a[40:43], a[184:187], v[132:135]
buffer_load_dwordx4 v4, s[8:11], s3 offen offset:2048 lds
M v[136:139], a[48:51], a[184:187], 0
M v[136:139], a[52:55], a[188:191], v[136:139]
M v[140:143], a[60:63], a[188:191], 0
M v[140:143], a[56:59], a[184:187], v[140:143]
ds_read_b64_tr_b16 a[116:117], v14 offset:49152
ds_read_b64_tr_b16 a[118:119], v14 offset:51200
M v[144:147], a[64:67], a[184:187], 0
M v[144:147], a[68:71], a[188:191], v[144:147]
buffer_load_dwordx4 v5, s[8:11], s3 offen offset:3072 lds
M v[148:151], a[76:79], a[188:191], 0
M v[148:151], a[72:75], a[184:187], v[148:151]
M v[152:155], a[80:83], a[184:187], 0
M v[152:155], a[84:87], a[188:191], v[152:155]
ds_read_b64_tr_b16 a[124:125], v15 offset:49152
ds_read_b64_tr_b16 a[126:127], v15 offset:51200
M v[156:159], a[92:95], a[188:191], 0
s_add_u32 s23, s23, 128
s_cmp_eq_u32 s23, s25
s_cselect_b32 s23, s26, s23
M v[156:159], a[88:91], a[184:187], v[156:159]
s_waitcnt lgkmcnt(10)
M v[160:163], a[32:35], a[160:163], 0
M v[160:163], a[36:39], a[164:167], v[160:163]
ds_read_b128 a[176:179], v10 offset:20480
ds_read_b128 a[180:183], v11 offset:20480
M v[164:167], a[44:47], a[164:167], 0
M v[164:167], a[40:43], a[160:163], v[164:167]
ds_read_b64_tr_b16 a[132:133], v16 offset:49152
ds_read_b64_tr_b16 a[134:135], v16 offset:51200
M v[168:171], a[48:51], a[160:163], 0
M v[168:171], a[52:55], a[164:167], v[168:171]
s_add_u32 m0, s29, 81920
s_nop 0
buffer_load_dwordx4 v6, s[12:15], s24 offen offset:0 lds
M v[172:175], a[60:63], a[164:167], 0
M v[172:175], a[56:59], a[160:163], v[172:175]
M v[176:179], a[64:67], a[160:163], 0
M v[176:179], a[68:71], a[164:167], v[176:179]
ds_read_b64_tr_b16 a[140:141], v17 offset:49152
ds_read_b64_tr_b16 a[142:143], v17 offset:51200
M v[180:183], a[76:79], a[164:167], 0
M v[180:183], a[72:75], a[160:163], v[180:183]
buffer_load_dwordx4 v7, s[12:15], s24 offen offset:1024 lds
M v[184:187], a[80:83], a[160:163], 0
M v[184:187], a[84:87], a[164:167], v[184:187]
M v[188:191], a[92:95], a[164:167], 0
M v[188:191], a[88:91], a[160:163], v[188:191]
s_waitcnt lgkmcnt(12)
ds_read_b64_tr_b16 a[148:149], v18 offset:49152
ds_read_b64_tr_b16 a[150:151], v18 offset:51200
M v[192:195], a[32:35], a[168:171], 0
buffer_load_dwordx4 v8, s[12:15], s24 offen offset:2048 lds
M v[192:195], a[36:39], a[172:175], v[192:195]
ds_read_b128 a[184:187], v10 offset:22528
ds_read_b128 a[188:191], v11 offset:22528
M v[196:199], a[44:47], a[172:175], 0
M v[196:199], a[40:43], a[168:171], v[196:199]
M v[200:203], a[48:51], a[168:171], 0
M v[200:203], a[52:55], a[172:175], v[200:203]
ds_read_b64_tr_b16 a[156:157], v19 offset:49152
ds_read_b64_tr_b16 a[158:159], v19 offset:51200
M v[204:207], a[60:63], a[172:175], 0
buffer_load_dwordx4 v9, s[12:15], s24 offen offset:3072 lds
M v[204:207], a[56:59], a[168:171], v[204:207]
M v[208:211], a[64:67], a[168:171], 0
M v[208:211], a[68:71], a[172:175], v[208:211]
M v[212:215], a[76:79], a[172:175], 0
M v[212:215], a[72:75], a[168:171], v[212:215]
s_add_u32 s24, s24, 262144
s_cmp_eq_u32 s24, s27
s_cselect_b32 s24, s28, s24
s_sub_u32 s6, s6, 1
s_cmp_eq_u32 s6, 0
s_cselect_b64 s[12:13], s[64:65], s[12:13]
M v[216:219], a[80:83], a[168:171], 0
M v[216:219], a[84:87], a[172:175], v[216:219]
M v[220:223], a[92:95], a[172:175], 0
M v[220:223], a[88:91], a[168:171], v[220:223]
s_waitcnt lgkmcnt(10)
M v[224:227], a[32:35], a[176:179], 0
buffer_load_dword v21, v20, s[60:63], s54 offen
s_add_u32 s54, s54, 1048576
M v[224:227], a[36:39], a[180:183], v[224:227]
M v[228:231], a[44:47], a[180:183], 0
M v[228:231], a[40:43], a[176:179], v[228:231]
M v[232:235], a[48:51], a[176:179], 0
M v[232:235], a[52:55], a[180:183], v[232:235]
M v[236:239], a[60:63], a[180:183], 0
M v[236:239], a[56:59], a[176:179], v[236:239]
s_waitcnt vmcnt(9) lgkmcnt(0)
s_barrier
ds_read_b128 a[160:163], v10 offset:32768
ds_read_b128 a[164:167], v11 offset:32768
M v[240:243], a[64:67], a[176:179], 0
s_add_u32 m0, s29, 0
s_nop 0
buffer_load_dwordx4 v2, s[8:11], s23 offen offset:0 lds
M v[240:243], a[68:71], a[180:183], v[240:243]
M v[244:247], a[76:79], a[180:183], 0
M v[244:247], a[72:75], a[176:179], v[244:247]
M v[248:251], a[80:83], a[176:179], 0
M v[248:251], a[84:87], a[180:183], v[248:251]
buffer_load_dwordx4 v3, s[8:11], s23 offen offset:1024 lds
M v[252:255], a[92:95], a[180:183], 0
M v[252:255], a[88:91], a[176:179], v[252:255]
M a[0:3], a[32:35], a[184:187], 0
M a[0:3], a[36:39], a[188:191], a[0:3]
ds_read_b128 a[168:171], v10 offset:34816
ds_read_b128 a[172:175], v11 offset:34816
M a[4:7], a[44:47], a[188:191], 0
M a[4:7], a[40:43], a[184:187], a[4:7]
M a[8:11], a[48:51], a[184:187], 0
buffer_load_dwordx4 v4, s[8:11], s23 offen offset:2048 lds
M a[8:11], a[52:55], a[188:191], a[8:11]
M a[12:15], a[60:63], a[188:191], 0
M a[12:15], a[56:59], a[184:187], a[12:15]
M a[16:19], a[64:67], a[184:187], 0
M a[16:19], a[68:71], a[188:191], a[16:19]
buffer_load_dwordx4 v5, s[8:11], s23 offen offset:3072 lds
M a[20:23], a[76:79], a[188:191], 0
M a[20:23], a[72:75], a[184:187], a[20:23]
M a[24:27], a[80:83], a[184:187], 0
M a[24:27], a[84:87], a[188:191], a[24:27]
M a[28:31], a[92:95], a[188:191], 0
M a[28:31], a[88:91], a[184:187], a[28:31]
s_waitcnt lgkmcnt(2)
M v[32:35], a[96:99], a[160:163], v[32:35]
s_add_u32 m0, s29, 98304
s_nop 0
buffer_load_dwordx4 v6, s[12:15], s24 offen offset:0 lds
M v[32:35], a[100:103], a[164:167], v[32:35]
ds_read_b128 a[176:179], v10 offset:36864
ds_read_b128 a[180:183], v11 offset:36864
M v[36:39], a[108:111], a[164:167], v[36:39]
M v[36:39], a[104:107], a[160:163], v[36:39]
ds_read_b64_tr_b16 a[32:33], v12 offset:0
ds_read_b64_tr_b16 a[34:35], v12 offset:2048
M v[40:43], a[112:115], a[160:163], v[40:43]
M v[40:43], a[116:119], a[164:167], v[40:43]
M v[44:47], a[124:127], a[164:167], v[44:47]
M v[44:47], a[120:123], a[160:163], v[44:47]
ds_read_b64_tr_b16 a[40:41], v13 offset:0
ds_read_b64_tr_b16 a[42:43], v13 offset:2048
M v[48:51], a[128:131], a[160:163], v[48:51]
buffer_load_dwordx4 v7, s[12:15], s24 offen offset:1024 lds
M v[48:51], a[132:135], a[164:167], v[48:51]
M v[52:55], a[140:143], a[164:167], v[52:55]
M v[52:55], a[136:139], a[160:163], v[52:55]
ds_read_b64_tr_b16 a[48:49], v14 offset:0
ds_read_b64_tr_b16 a[50:51], v14 offset:2048
M v[56:59], a[144:147], a[160:163], v[56:59]
M v[56:59], a[148:151], a[164:167], v[56:59]
M v[60:63], a[156:159], a[164:167], v[60:63]
buffer_load_dwordx4 v8, s[12:15], s24 offen offset:2048 lds
M v[60:63], a[152:155], a[160:163], v[60:63]
s_waitcnt lgkmcnt(8)
ds_read_b64_tr_b16 a[56:57], v15 offset:0
ds_read_b64_tr_b16 a[58:59], v15 offset:2048
M v[64:67], a[96:99], a[168:171], v[64:67]
M v[64:67], a[100:103], a[172:175], v[64:67]
ds_read_b128 a[184:187], v10 offset:38912
ds_read_b128 a[188:191], v11 offset:38912
M v[68:71], a[108:111], a[172:175], v[68:71]
M v[68:71], a[104:107], a[168:171], v[68:71]
ds_read_b64_tr_b16 a[64:65], v16 offset:0
ds_read_b64_tr_b16 a[66:67], v16 offset:2048
M v[72:75], a[112:115], a[168:171], v[72:75]
M v[72:75], a[116:119], a[172:175], v[72:75]
M v[76:79], a[124:127], a[172:175], v[76:79]
M v[76:79], a[120:123], a[168:171], v[76:79]
ds_read_b64_tr_b16 a[72:73], v17 offset:0
ds_read_b64_tr_b16 a[74:75], v17 offset:2048
M v[80:83], a[128:131], a[168:171], v[80:83]
buffer_load_dwordx4 v9, s[12:15], s24 offen offset:3072 lds
M v[80:83], a[132:135], a[172:175], v[80:83]
M v[84:87], a[140:143], a[172:175], v[84:87]
M v[84:87], a[136:139], a[168:171], v[84:87]
ds_read_b64_tr_b16 a[80:81], v18 offset:0
ds_read_b64_tr_b16 a[82:83], v18 offset:2048
M v[88:91], a[144:147], a[168:171], v[88:91]
M v[88:91], a[148:151], a[172:175], v[88:91]
M v[92:95], a[156:159], a[172:175], v[92:95]
s_add_u32 s24, s24, 262144
M v[92:95], a[152:155], a[168:171], v[92:95]
s_waitcnt lgkmcnt(15)
ds_read_b64_tr_b16 a[88:89], v19 offset:0
ds_read_b64_tr_b16 a[90:91], v19 offset:2048
M v[96:99], a[96:99], a[176:179], v[96:99]
M v[96:99], a[100:103], a[180:183], v[96:99]
M v[100:103], a[108:111], a[180:183], v[100:103]
M v[100:103], a[104:107], a[176:179], v[100:103]
M v[104:107], a[112:115], a[176:179], v[104:107]
M v[104:107], a[116:119], a[180:183], v[104:107]
M v[108:111], a[124:127], a[180:183], v[108:111]
M v[108:111], a[120:123], a[176:179], v[108:111]
s_waitcnt vmcnt(9) lgkmcnt(0)
s_barrier
ds_read_b128 a[160:163], v10 offset:49152
ds_read_b128 a[164:167], v11 offset:49152
M v[112:115], a[128:131], a[176:179], v[112:115]
s_add_u32 m0, s29, 16384
s_add_u32 s3, s23, s31
buffer_load_dwordx4 v2, s[8:11], s3 offen offset:0 lds
M v[112:115], a[132:135], a[180:183], v[112:115]
M v[116:119], a[140:143], a[180:183], v[116:119]
M v[116:119], a[136:139], a[176:179], v[116:119]
ds_read_b64_tr_b16 a[36:37], v12 offset:16384
ds_read_b64_tr_b16 a[38:39], v12 offset:18432
M v[120:123], a[144:147], a[176:179], v[120:123]
M v[120:123], a[148:151], a[180:183], v[120:123]
buffer_load_dwordx4 v3, s[8:11], s3 offen offset:1024 lds
M v[124:127], a[156:159], a[180:183], v[124:127]
M v[124:127], a[152:155], a[176:179], v[124:127]
M v[128:131], a[96:99], a[184:187], v[128:131]
M v[128:131], a[100:103], a[188:191], v[128:131]
ds_read_b128 a[168:171], v10 offset:51200
ds_read_b128 a[172:175], v11 offset:51200
ds_read_b64_tr_b16 a[44:45], v13 offset:16384
ds_read_b64_tr_b16 a[46:47], v13 offset:18432
M v[132:135], a[108:111], a[188:191], v[132:135]
M v[132:135], a[104:107], a[184:187], v[132:135]
buffer_load_dwordx4 v4, s[8:11], s3 offen offset:2048 lds
M v[136:139], a[112:115], a[184:187], v[136:139]
M v[136:139], a[116:119], a[188:191], v[136:139]
M v[140:143], a[124:127], a[188:191], v[140:143]
M v[140:143], a[120:123], a[184:187], v[140:143]
ds_read_b64_tr_b16 a[52:53], v14 offset:16384
ds_read_b64_tr_b16 a[54:55], v14 offset:18432
M v[144:147], a[128:131], a[184:187], v[144:147]
M v[144:147], a[132:135], a[188:191], v[144:147]
buffer_load_dwordx4 v5, s[8:11], s3 offen offset:3072 lds
M v[148:151], a[140:143], a[188:191], v[148:151]
M v[148:151], a[136:139], a[184:187], v[148:151]
M v[152:155], a[144:147], a[184:187], v[152:155]
M v[152:155], a[148:151], a[188:191], v[152:155]
ds_read_b64_tr_b16 a[60:61], v15 offset:16384
ds_read_b64_tr_b16 a[62:63], v15 offset:18432
M v[156:159], a[156:159], a[188:191], v[156:159]
s_add_u32 s23, s23, 128
s_cmp_eq_u32 s23, s25
s_cselect_b32 s23, s26, s23
M v[156:159], a[152:155], a[184:187], v[156:159]
s_waitcnt lgkmcnt(10)
M v[160:163], a[96:99], a[160:163], v[160:163]
M v[160:163], a[100:103], a[164:167], v[160:163]
ds_read_b128 a[176:179], v10 offset:53248
ds_read_b128 a[180:183], v11 offset:53248
M v[164:167], a[108:111], a[164:167], v[164:167]
M v[164:167], a[104:107], a[160:163], v[164:167]
ds_read_b64_tr_b16 a[68:69], v16 offset:16384
ds_read_b64_tr_b16 a[70:71], v16 offset:18432
M v[168:171], a[112:115], a[160:163], v[168:171]
M v[168:171], a[116:119], a[164:167], v[168:171]
s_add_u32 m0, s29, 114688
s_nop 0
buffer_load_dwordx4 v6, s[12:15], s24 offen offset:0 lds
M v[172:175], a[124:127], a[164:167], v[172:175]
M v[172:175], a[120:123], a[160:163], v[172:175]
M v[176:179], a[128:131], a[160:163], v[176:179]
M v[176:179], a[132:135], a[164:167], v[176:179]
ds_read_b64_tr_b16 a[76:77], v17 offset:16384
ds_read_b64_tr_b16 a[78:79], v17 offset:18432
M v[180:183], a[140:143], a[164:167], v[180:183]
M v[180:183], a[136:139], a[160:163], v[180:183]
buffer_load_dwordx4 v7, s[12:15], s24 offen offset:1024 lds
M v[184:187], a[144:147], a[160:163], v[184:187]
M v[184:187], a[148:151], a[164:167], v[184:187]
M v[188:191], a[156:159], a[164:167], v[188:191]
M v[188:191], a[152:155], a[160:163], v[188:191]
s_waitcnt lgkmcnt(12)
ds_read_b64_tr_b16 a[84:85], v18 offset:16384
ds_read_b64_tr_b16 a[86:87], v18 offset:18432
M v[192:195], a[96:99], a[168:171], v[192:195]
buffer_load_dwordx4 v8, s[12:15], s24 offen offset:2048 lds
M v[192:195], a[100:103], a[172:175], v[192:195]
ds_read_b128 a[184:187], v10 offset:55296
ds_read_b128 a[188:191], v11 offset:55296
M v[196:199], a[108:111], a[172:175], v[196:199]
M v[196:199], a[104:107], a[168:171], v[196:199]
M v[200:203], a[112:115], a[168:171], v[200:203]
M v[200:203], a[116:119], a[172:175], v[200:203]
ds_read_b64_tr_b16 a[92:93], v19 offset:16384
ds_read_b64_tr_b16 a[94:95], v19 offset:18432
M v[204:207], a[124:127], a[172:175], v[204:207]
buffer_load_dwordx4 v9, s[12:15], s24 offen offset:3072 lds
M v[204:207], a[120:123], a[168:171], v[204:207]
M v[208:211], a[128:131], a[168:171], v[208:211]
M v[208:211], a[132:135], a[172:175], v[208:211]
M v[212:215], a[140:143], a[172:175], v[212:215]
M v[212:215], a[136:139], a[168:171], v[212:215]
s_add_u32 s24, s24, 262144
s_cmp_eq_u32 s24, s27
s_cselect_b32 s24, s28, s24
s_sub_u32 s6, s6, 1
s_cmp_eq_u32 s6, 0
s_cselect_b64 s[12:13], s[64:65], s[12:13]
M v[216:219], a[144:147], a[168:171], v[216:219]
M v[216:219], a[148:151], a[172:175], v[216:219]
M v[220:223], a[156:159], a[172:175], v[220:223]
M v[220:223], a[152:155], a[168:171], v[220:223]
s_waitcnt lgkmcnt(10)
M v[224:227], a[96:99], a[176:179], v[224:227]
buffer_load_dword v21, v20, s[60:63], s54 offen
s_add_u32 s54, s54, 1048576
M v[224:227], a[100:103], a[180:183], v[224:227]
M v[228:231], a[108:111], a[180:183], v[228:231]
M v[228:231], a[104:107], a[176:179], v[228:231]
M v[232:235], a[112:115], a[176:179], v[232:235]
M v[232:235], a[116:119], a[180:183], v[232:235]
M v[236:239], a[124:127], a[180:183], v[236:239]
M v[236:239], a[120:123], a[176:179], v[236:239]
s_waitcnt vmcnt(9) lgkmcnt(0)
s_barrier
ds_read_b128 a[160:163], v10 offset:0
ds_read_b128 a[164:167], v11 offset:0
M v[240:243], a[128:131], a[176:179], v[240:243]
s_add_u32 m0, s29, 32768
s_nop 0
buffer_load_dwordx4 v2, s[8:11], s23 offen offset:0 lds
M v[240:243], a[132:135], a[180:183], v[240:243]
M v[244:247], a[140:143], a[180:183], v[244:247]
M v[244:247], a[136:139], a[176:179], v[244:247]
M v[248:251], a[144:147], a[176:179], v[248:251]
M v[248:251], a[148:151], a[180:183], v[248:251]
buffer_load_dwordx4 v3, s[8:11], s23 offen offset:1024 lds
M v[252:255], a[156:159], a[180:183], v[252:255]
M v[252:255], a[152:155], a[176:179], v[252:255]
M a[0:3], a[96:99], a[184:187], a[0:3]
M a[0:3], a[100:103], a[188:191], a[0:3]
ds_read_b128 a[168:171], v10 offset:2048
ds_read_b128 a[172:175], v11 offset:2048
M a[4:7], a[108:111], a[188:191], a[4:7]
M a[4:7], a[104:107], a[184:187], a[4:7]
M a[8:11], a[112:115], a[184:187], a[8:11]
buffer_load_dwordx4 v4, s[8:11], s23 offen offset:2048 lds
M a[8:11], a[116:119], a[188:191], a[8:11]
M a[12:15], a[124:127], a[188:191], a[12:15]
M a[12:15], a[120:123], a[184:187], a[12:15]
M a[16:19], a[128:131], a[184:187], a[16:19]
M a[16:19], a[132:135], a[188:191], a[16:19]
buffer_load_dwordx4 v5, s[8:11], s23 offen offset:3072 lds
M a[20:23], a[140:143], a[188:191], a[20:23]
M a[20:23], a[136:139], a[184:187], a[20:23]
M a[24:27], a[144:147], a[184:187], a[24:27]
M a[24:27], a[148:151], a[188:191], a[24:27]
M a[28:31], a[156:159], a[188:191], a[28:31]
M a[28:31], a[152:155], a[184:187], a[28:31]
s_waitcnt lgkmcnt(2)
s_mov_b32 s30, 5
Lk1_ql:
M v[32:35], a[32:35], a[160:163], v[32:35]
s_add_u32 m0, s29, 65536
s_nop 0
buffer_load_dwordx4 v6, s[12:15], s24 offen offset:0 lds
M v[32:35], a[36:39], a[164:167], v[32:35]
ds_read_b128 a[176:179], v10 offset:4096
ds_read_b128 a[180:183], v11 offset:4096
M v[36:39], a[44:47], a[164:167], v[36:39]
M v[36:39], a[40:43], a[160:163], v[36:39]
ds_read_b64_tr_b16 a[96:97], v12 offset:32768
ds_read_b64_tr_b16 a[98:99], v12 offset:34816
M v[40:43], a[48:51], a[160:163], v[40:43]
M v[40:43], a[52:55], a[164:167], v[40:43]
M v[44:47], a[60:63], a[164:167], v[44:47]
M v[44:47], a[56:59], a[160:163], v[44:47]
ds_read_b64_tr_b16 a[104:105], v13 offset:32768
ds_read_b64_tr_b16 a[106:107], v13 offset:34816
M v[48:51], a[64:67], a[160:163], v[48:51]
buffer_load_dwordx4 v7, s[12:15], s24 offen offset:1024 lds
M v[48:51], a[68:71], a[164:167], v[48:51]
M v[52:55], a[76:79], a[164:167], v[52:55]
M v[52:55], a[72:75], a[160:163], v[52:55]
ds_read_b64_tr_b16 a[112:113], v14 offset:32768
ds_read_b64_tr_b16 a[114:115], v14 offset:34816
M v[56:59], a[80:83], a[160:163], v[56:59]
M v[56:59], a[84:87], a[164:167], v[56:59]
M v[60:63], a[92:95], a[164:167], v[60:63]
buffer_load_dwordx4 v8, s[12:15], s24 offen offset:2048 lds
M v[60:63], a[88:91], a[160:163], v[60:63]
s_waitcnt lgkmcnt(8)
ds_read_b64_tr_b16 a[120:121], v15 offset:32768
ds_read_b64_tr_b16 a[122:123], v15 offset:34816
M v[64:67], a[32:35], a[168:171], v[64:67]
M v[64:67], a[36:39], a[172:175], v[64:67]
ds_read_b128 a[184:187], v10 offset:6144
ds_read_b128 a[188:191], v11 offset:6144
M v[68:71], a[44:47], a[172:175], v[68:71]
M v[68:71], a[40:43], a[168:171], v[68:71]
ds_read_b64_tr_b16 a[128:129], v16 offset:32768
ds_read_b64_tr_b16 a[130:131], v16 offset:34816
M v[72:75], a[48:51], a[168:171], v[72:75]
M v[72:75], a[52:55], a[172:175], v[72:75]
M v[76:79], a[60:63], a[172:175], v[76:79]
M v[76:79], a[56:59], a[168:171], v[76:79]
ds_read_b64_tr_b16 a[136:137], v17 offset:32768
ds_read_b64_tr_b16 a[138:139], v17 offset:34816
M v[80:83], a[64:67], a[168:171], v[80:83]
buffer_load_dwordx4 v9, s[12:15], s24 offen offset:3072 lds
M v[80:83], a[68:71], a[172:175], v[80:83]
M v[84:87], a[76:79], a[172:175], v[84:87]
M v[84:87], a[72:75], a[168:171], v[84:87]
ds_read_b64_tr_b16 a[144:145], v18 offset:32768
ds_read_b64_tr_b16 a[146:147], v18 offset:34816
M v[88:91], a[80:83], a[168:171], v[88:91]
M v[88:91], a[84:87], a[172:175], v[88:91]
M v[92:95], a[92:95], a[172:175], v[92:95]
s_add_u32 s24, s24, 262144
M v[92:95], a[88:91], a[168:171], v[92:95]
s_waitcnt lgkmcnt(15)
ds_read_b64_tr_b16 a[152:153], v19 offset:32768
ds_read_b64_tr_b16 a[154:155], v19 offset:34816
M v[96:99], a[32:35], a[176:179], v[96:99]
M v[96:99], a[36:39], a[180:183], v[96:99]
M v[100:103], a[44:47], a[180:183], v[100:103]
M v[100:103], a[40:43], a[176:179], v[100:103]
M v[104:107], a[48:51], a[176:179], v[104:107]
M v[104:107], a[52:55], a[180:183], v[104:107]
M v[108:111], a[60:63], a[180:183], v[108:111]
M v[108:111], a[56:59], a[176:179], v[108:111]
s_waitcnt vmcnt(9) lgkmcnt(0)
s_barrier
ds_read_b128 a[160:163], v10 offset:16384
ds_read_b128 a[164:167], v11 offset:16384
M v[112:115], a[64:67], a[176:179], v[112:115]
s_add_u32 m0, s29, 49152
s_add_u32 s3, s23, s31
buffer_load_dwordx4 v2, s[8:11], s3 offen offset:0 lds
M v[112:115], a[68:71], a[180:183], v[112:115]
M v[116:119], a[76:79], a[180:183], v[116:119]
M v[116:119], a[72:75], a[176:179], v[116:119]
ds_read_b64_tr_b16 a[100:101], v12 offset:49152
ds_read_b64_tr_b16 a[102:103], v12 offset:51200
M v[120:123], a[80:83], a[176:179], v[120:123]
M v[120:123], a[84:87], a[180:183], v[120:123]
buffer_load_dwordx4 v3, s[8:11], s3 offen offset:1024 lds
M v[124:127], a[92:95], a[180:183], v[124:127]
M v[124:127], a[88:91], a[176:179], v[124:127]
M v[128:131], a[32:35], a[184:187], v[128:131]
M v[128:131], a[36:39], a[188:191], v[128:131]
ds_read_b128 a[168:171], v10 offset:18432
ds_read_b128 a[172:175], v11 offset:18432
ds_read_b64_tr_b16 a[108:109], v13 offset:49152
ds_read_b64_tr_b16 a[110:111], v13 offset:51200
M v[132:135], a[44:47], a[188:191], v[132:135]
M v[132:135], a[40:43], a[184:187], v[132:135]
buffer_load_dwordx4 v4, s[8:11], s3 offen offset:2048 lds
M v[136:139], a[48:51], a[184:187], v[136:139]
M v[136:139], a[52:55], a[188:191], v[136:139]
M v[140:143], a[60:63], a[188:191], v[140:143]
M v[140:143], a[56:59], a[184:187], v[140:143]
ds_read_b64_tr_b16 a[116:117], v14 offset:49152
ds_read_b64_tr_b16 a[118:119], v14 offset:51200
M v[144:147], a[64:67], a[184:187], v[144:147]
M v[144:147], a[68:71], a[188:191], v[144:147]
buffer_load_dwordx4 v5, s[8:11], s3 offen offset:3072 lds
M v[148:151], a[76:79], a[188:191], v[148:151]
M v[148:151], a[72:75], a[184:187], v[148:151]
M v[152:155], a[80:83], a[184:187], v[152:155]
M v[152:155], a[84:87], a[188:191], v[152:155]
ds_read_b64_tr_b16 a[124:125], v15 offset:49152
ds_read_b64_tr_b16 a[126:127], v15 offset:51200
M v[156:159], a[92:95], a[188:191], v[156:159]
s_add_u32 s23, s23, 128
s_cmp_eq_u32 s23, s25
s_cselect_b32 s23, s26, s23
M v[156:159], a[88:91], a[184:187], v[156:159]
s_waitcnt lgkmcnt(10)
M v[160:163], a[32:35], a[160:163], v[160:163]
M v[160:163], a[36:39], a[164:167], v[160:163]
ds_read_b128 a[176:179], v10 offset:20480
ds_read_b128 a[180:183], v11 offset:20480
M v[164:167], a[44:47], a[164:167], v[164:167]
M v[164:167], a[40:43], a[160:163], v[164:167]
ds_read_b64_tr_b16 a[132:133], v16 offset:49152
ds_read_b64_tr_b16 a[134:135], v16 offset:51200
M v[168:171], a[48:51], a[160:163], v[168:171]
M v[168:171], a[52:55], a[164:167], v[168:171]
s_add_u32 m0, s29, 81920
s_nop 0
buffer_load_dwordx4 v6, s[12:15], s24 offen offset:0 lds
M v[172:175], a[60:63], a[164:167], v[172:175]
M v[172:175], a[56:59], a[160:163], v[172:175]
M v[176:179], a[64:67], a[160:163], v[176:179]
M v[176:179], a[68:71], a[164:167], v[176:179]
ds_read_b64_tr_b16 a[140:141], v17 offset:49152
ds_read_b64_tr_b16 a[142:143], v17 offset:51200
M v[180:183], a[76:79], a[164:167], v[180:183]
M v[180:183], a[72:75], a[160:163], v[180:183]
buffer_load_dwordx4 v7, s[12:15], s24 offen offset:1024 lds
M v[184:187], a[80:83], a[160:163], v[184:187]
M v[184:187], a[84:87], a[164:167], v[184:187]
M v[188:191], a[92:95], a[164:167], v[188:191]
M v[188:191], a[88:91], a[160:163], v[188:191]
s_waitcnt lgkmcnt(12)
ds_read_b64_tr_b16 a[148:149], v18 offset:49152
ds_read_b64_tr_b16 a[150:151], v18 offset:51200
M v[192:195], a[32:35], a[168:171], v[192:195]
buffer_load_dwordx4 v8, s[12:15], s24 offen offset:2048 lds
M v[192:195], a[36:39], a[172:175], v[192:195]
ds_read_b128 a[184:187], v10 offset:22528
ds_read_b128 a[188:191], v11 offset:22528
M v[196:199], a[44:47], a[172:175], v[196:199]
M v[196:199], a[40:43], a[168:171], v[196:199]
M v[200:203], a[48:51], a[168:171], v[200:203]
M v[200:203], a[52:55], a[172:175], v[200:203]
ds_read_b64_tr_b16 a[156:157], v19 offset:49152
ds_read_b64_tr_b16 a[158:159], v19 offset:51200
M v[204:207], a[60:63], a[172:175], v[204:207]
buffer_load_dwordx4 v9, s[12:15], s24 offen offset:3072 lds
M v[204:207], a[56:59], a[168:171], v[204:207]
M v[208:211], a[64:67], a[168:171], v[208:211]
M v[208:211], a[68:71], a[172:175], v[208:211]
M v[212:215], a[76:79], a[172:175], v[212:215]
M v[212:215], a[72:75], a[168:171], v[212:215]
s_add_u32 s24, s24, 262144
s_cmp_eq_u32 s24, s27
s_cselect_b32 s24, s28, s24
s_sub_u32 s6, s6, 1
s_cmp_eq_u32 s6, 0
s_cselect_b64 s[12:13], s[64:65], s[12:13]
M v[216:219], a[80:83], a[168:171], v[216:219]
M v[216:219], a[84:87], a[172:175], v[216:219]
M v[220:223], a[92:95], a[172:175], v[220:223]
M v[220:223], a[88:91], a[168:171], v[220:223]
s_waitcnt lgkmcnt(10)
M v[224:227], a[32:35], a[176:179], v[224:227]
buffer_load_dword v21, v20, s[60:63], s54 offen
s_add_u32 s54, s54, 1048576
M v[224:227], a[36:39], a[180:183], v[224:227]
M v[228:231], a[44:47], a[180:183], v[228:231]
M v[228:231], a[40:43], a[176:179], v[228:231]
M v[232:235], a[48:51], a[176:179], v[232:235]
M v[232:235], a[52:55], a[180:183], v[232:235]
M v[236:239], a[60:63], a[180:183], v[236:239]
M v[236:239], a[56:59], a[176:179], v[236:239]
s_waitcnt vmcnt(9) lgkmcnt(0)
s_barrier
ds_read_b128 a[160:163], v10 offset:32768
ds_read_b128 a[164:167], v11 offset:32768
M v[240:243], a[64:67], a[176:179], v[240:243]
s_add_u32 m0, s29, 0
s_nop 0
buffer_load_dwordx4 v2, s[8:11], s23 offen offset:0 lds
M v[240:243], a[68:71], a[180:183], v[240:243]
M v[244:247], a[76:79], a[180:183], v[244:247]
M v[244:247], a[72:75], a[176:179], v[244:247]
M v[248:251], a[80:83], a[176:179], v[248:251]
M v[248:251], a[84:87], a[180:183], v[248:251]
buffer_load_dwordx4 v3, s[8:11], s23 offen offset:1024 lds
M v[252:255], a[92:95], a[180:183], v[252:255]
M v[252:255], a[88:91], a[176:179], v[252:255]
M a[0:3], a[32:35], a[184:187], a[0:3]
M a[0:3], a[36:39], a[188:191], a[0:3]
ds_read_b128 a[168:171], v10 offset:34816
ds_read_b128 a[172:175], v11 offset:34816
M a[4:7], a[44:47], a[188:191], a[4:7]
M a[4:7], a[40:43], a[184:187], a[4:7]
M a[8:11], a[48:51], a[184:187], a[8:11]
buffer_load_dwordx4 v4, s[8:11], s23 offen offset:2048 lds
M a[8:11], a[52:55], a[188:191], a[8:11]
M a[12:15], a[60:63], a[188:191], a[12:15]
M a[12:15], a[56:59], a[184:187], a[12:15]
M a[16:19], a[64:67], a[184:187], a[16:19]
M a[16:19], a[68:71], a[188:191], a[16:19]
buffer_load_dwordx4 v5, s[8:11], s23 offen offset:3072 lds
M a[20:23], a[76:79], a[188:191], a[20:23]
M a[20:23], a[72:75], a[184:187], a[20:23]
M a[24:27], a[80:83], a[184:187], a[24:27]
M a[24:27], a[84:87], a[188:191], a[24:27]
M a[28:31], a[92:95], a[188:191], a[28:31]
M a[28:31], a[88:91], a[184:187], a[28:31]
s_waitcnt lgkmcnt(2)
M v[32:35], a[96:99], a[160:163], v[32:35]
s_add_u32 m0, s29, 98304
s_nop 0
buffer_load_dwordx4 v6, s[12:15], s24 offen offset:0 lds
M v[32:35], a[100:103], a[164:167], v[32:35]
ds_read_b128 a[176:179], v10 offset:36864
ds_read_b128 a[180:183], v11 offset:36864
M v[36:39], a[108:111], a[164:167], v[36:39]
M v[36:39], a[104:107], a[160:163], v[36:39]
ds_read_b64_tr_b16 a[32:33], v12 offset:0
ds_read_b64_tr_b16 a[34:35], v12 offset:2048
M v[40:43], a[112:115], a[160:163], v[40:43]
M v[40:43], a[116:119], a[164:167], v[40:43]
M v[44:47], a[124:127], a[164:167], v[44:47]
M v[44:47], a[120:123], a[160:163], v[44:47]
ds_read_b64_tr_b16 a[40:41], v13 offset:0
ds_read_b64_tr_b16 a[42:43], v13 offset:2048
M v[48:51], a[128:131], a[160:163], v[48:51]
buffer_load_dwordx4 v7, s[12:15], s24 offen offset:1024 lds
M v[48:51], a[132:135], a[164:167], v[48:51]
M v[52:55], a[140:143], a[164:167], v[52:55]
M v[52:55], a[136:139], a[160:163], v[52:55]
ds_read_b64_tr_b16 a[48:49], v14 offset:0
ds_read_b64_tr_b16 a[50:51], v14 offset:2048
M v[56:59], a[144:147], a[160:163], v[56:59]
M v[56:59], a[148:151], a[164:167], v[56:59]
M v[60:63], a[156:159], a[164:167], v[60:63]
buffer_load_dwordx4 v8, s[12:15], s24 offen offset:2048 lds
M v[60:63], a[152:155], a[160:163], v[60:63]
s_waitcnt lgkmcnt(8)
ds_read_b64_tr_b16 a[56:57], v15 offset:0
ds_read_b64_tr_b16 a[58:59], v15 offset:2048
M v[64:67], a[96:99], a[168:171], v[64:67]
M v[64:67], a[100:103], a[172:175], v[64:67]
ds_read_b128 a[184:187], v10 offset:38912
ds_read_b128 a[188:191], v11 offset:38912
M v[68:71], a[108:111], a[172:175], v[68:71]
M v[68:71], a[104:107], a[168:171], v[68:71]
ds_read_b64_tr_b16 a[64:65], v16 offset:0
ds_read_b64_tr_b16 a[66:67], v16 offset:2048
M v[72:75], a[112:115], a[168:171], v[72:75]
M v[72:75], a[116:119], a[172:175], v[72:75]
M v[76:79], a[124:127], a[172:175], v[76:79]
M v[76:79], a[120:123], a[168:171], v[76:79]
ds_read_b64_tr_b16 a[72:73], v17 offset:0
ds_read_b64_tr_b16 a[74:75], v17 offset:2048
M v[80:83], a[128:131], a[168:171], v[80:83]
buffer_load_dwordx4 v9, s[12:15], s24 offen offset:3072 lds
M v[80:83], a[132:135], a[172:175], v[80:83]
M v[84:87], a[140:143], a[172:175], v[84:87]
M v[84:87], a[136:139], a[168:171], v[84:87]
ds_read_b64_tr_b16 a[80:81], v18 offset:0
ds_read_b64_tr_b16 a[82:83], v18 offset:2048
M v[88:91], a[144:147], a[168:171], v[88:91]
M v[88:91], a[148:151], a[172:175], v[88:91]
M v[92:95], a[156:159], a[172:175], v[92:95]
s_add_u32 s24, s24, 262144
M v[92:95], a[152:155], a[168:171], v[92:95]
s_waitcnt lgkmcnt(15)
ds_read_b64_tr_b16 a[88:89], v19 offset:0
ds_read_b64_tr_b16 a[90:91], v19 offset:2048
M v[96:99], a[96:99], a[176:179], v[96:99]
M v[96:99], a[100:103], a[180:183], v[96:99]
M v[100:103], a[108:111], a[180:183], v[100:103]
M v[100:103], a[104:107], a[176:179], v[100:103]
M v[104:107], a[112:115], a[176:179], v[104:107]
M v[104:107], a[116:119], a[180:183], v[104:107]
M v[108:111], a[124:127], a[180:183], v[108:111]
M v[108:111], a[120:123], a[176:179], v[108:111]
s_waitcnt vmcnt(9) lgkmcnt(0)
s_barrier
ds_read_b128 a[160:163], v10 offset:49152
ds_read_b128 a[164:167], v11 offset:49152
M v[112:115], a[128:131], a[176:179], v[112:115]
s_add_u32 m0, s29, 16384
s_add_u32 s3, s23, s31
buffer_load_dwordx4 v2, s[8:11], s3 offen offset:0 lds
M v[112:115], a[132:135], a[180:183], v[112:115]
M v[116:119], a[140:143], a[180:183], v[116:119]
M v[116:119], a[136:139], a[176:179], v[116:119]
ds_read_b64_tr_b16 a[36:37], v12 offset:16384
ds_read_b64_tr_b16 a[38:39], v12 offset:18432
M v[120:123], a[144:147], a[176:179], v[120:123]
M v[120:123], a[148:151], a[180:183], v[120:123]
buffer_load_dwordx4 v3, s[8:11], s3 offen offset:1024 lds
M v[124:127], a[156:159], a[180:183], v[124:127]
M v[124:127], a[152:155], a[176:179], v[124:127]
M v[128:131], a[96:99], a[184:187], v[128:131]
M v[128:131], a[100:103], a[188:191], v[128:131]
ds_read_b128 a[168:171], v10 offset:51200
ds_read_b128 a[172:175], v11 offset:51200
ds_read_b64_tr_b16 a[44:45], v13 offset:16384
ds_read_b64_tr_b16 a[46:47], v13 offset:18432
M v[132:135], a[108:111], a[188:191], v[132:135]
M v[132:135], a[104:107], a[184:187], v[132:135]
buffer_load_dwordx4 v4, s[8:11], s3 offen offset:2048 lds
M v[136:139], a[112:115], a[184:187], v[136:139]
M v[136:139], a[116:119], a[188:191], v[136:139]
M v[140:143], a[124:127], a[188:191], v[140:143]
M v[140:143], a[120:123], a[184:187], v[140:143]
ds_read_b64_tr_b16 a[52:53], v14 offset:16384
ds_read_b64_tr_b16 a[54:55], v14 offset:18432
M v[144:147], a[128:131], a[184:187], v[144:147]
M v[144:147], a[132:135], a[188:191], v[144:147]
buffer_load_dwordx4 v5, s[8:11], s3 offen offset:3072 lds
M v[148:151], a[140:143], a[188:191], v[148:151]
M v[148:151], a[136:139], a[184:187], v[148:151]
M v[152:155], a[144:147], a[184:187], v[152:155]
M v[152:155], a[148:151], a[188:191], v[152:155]
ds_read_b64_tr_b16 a[60:61], v15 offset:16384
ds_read_b64_tr_b16 a[62:63], v15 offset:18432
M v[156:159], a[156:159], a[188:191], v[156:159]
s_add_u32 s23, s23, 128
s_cmp_eq_u32 s23, s25
s_cselect_b32 s23, s26, s23
M v[156:159], a[152:155], a[184:187], v[156:159]
s_waitcnt lgkmcnt(10)
M v[160:163], a[96:99], a[160:163], v[160:163]
M v[160:163], a[100:103], a[164:167], v[160:163]
ds_read_b128 a[176:179], v10 offset:53248
ds_read_b128 a[180:183], v11 offset:53248
M v[164:167], a[108:111], a[164:167], v[164:167]
M v[164:167], a[104:107], a[160:163], v[164:167]
ds_read_b64_tr_b16 a[68:69], v16 offset:16384
ds_read_b64_tr_b16 a[70:71], v16 offset:18432
M v[168:171], a[112:115], a[160:163], v[168:171]
M v[168:171], a[116:119], a[164:167], v[168:171]
s_add_u32 m0, s29, 114688
s_nop 0
buffer_load_dwordx4 v6, s[12:15], s24 offen offset:0 lds
M v[172:175], a[124:127], a[164:167], v[172:175]
M v[172:175], a[120:123], a[160:163], v[172:175]
M v[176:179], a[128:131], a[160:163], v[176:179]
M v[176:179], a[132:135], a[164:167], v[176:179]
ds_read_b64_tr_b16 a[76:77], v17 offset:16384
ds_read_b64_tr_b16 a[78:79], v17 offset:18432
M v[180:183], a[140:143], a[164:167], v[180:183]
M v[180:183], a[136:139], a[160:163], v[180:183]
buffer_load_dwordx4 v7, s[12:15], s24 offen offset:1024 lds
M v[184:187], a[144:147], a[160:163], v[184:187]
M v[184:187], a[148:151], a[164:167], v[184:187]
M v[188:191], a[156:159], a[164:167], v[188:191]
M v[188:191], a[152:155], a[160:163], v[188:191]
s_waitcnt lgkmcnt(12)
ds_read_b64_tr_b16 a[84:85], v18 offset:16384
ds_read_b64_tr_b16 a[86:87], v18 offset:18432
M v[192:195], a[96:99], a[168:171], v[192:195]
buffer_load_dwordx4 v8, s[12:15], s24 offen offset:2048 lds
M v[192:195], a[100:103], a[172:175], v[192:195]
ds_read_b128 a[184:187], v10 offset:55296
ds_read_b128 a[188:191], v11 offset:55296
M v[196:199], a[108:111], a[172:175], v[196:199]
M v[196:199], a[104:107], a[168:171], v[196:199]
M v[200:203], a[112:115], a[168:171], v[200:203]
M v[200:203], a[116:119], a[172:175], v[200:203]
ds_read_b64_tr_b16 a[92:93], v19 offset:16384
ds_read_b64_tr_b16 a[94:95], v19 offset:18432
M v[204:207], a[124:127], a[172:175], v[204:207]
buffer_load_dwordx4 v9, s[12:15], s24 offen offset:3072 lds
M v[204:207], a[120:123], a[168:171], v[204:207]
M v[208:211], a[128:131], a[168:171], v[208:211]
M v[208:211], a[132:135], a[172:175], v[208:211]
M v[212:215], a[140:143], a[172:175], v[212:215]
M v[212:215], a[136:139], a[168:171], v[212:215]
s_add_u32 s24, s24, 262144
s_cmp_eq_u32 s24, s27
s_cselect_b32 s24, s28, s24
s_sub_u32 s6, s6, 1
s_cmp_eq_u32 s6, 0
s_cselect_b64 s[12:13], s[64:65], s[12:13]
M v[216:219], a[144:147], a[168:171], v[216:219]
M v[216:219], a[148:151], a[172:175], v[216:219]
M v[220:223], a[156:159], a[172:175], v[220:223]
M v[220:223], a[152:155], a[168:171], v[220:223]
s_waitcnt lgkmcnt(10)
M v[224:227], a[96:99], a[176:179], v[224:227]
buffer_load_dword v21, v20, s[60:63], s54 offen
s_add_u32 s54, s54, 1048576
M v[224:227], a[100:103], a[180:183], v[224:227]
M v[228:231], a[108:111], a[180:183], v[228:231]
M v[228:231], a[104:107], a[176:179], v[228:231]
M v[232:235], a[112:115], a[176:179], v[232:235]
M v[232:235], a[116:119], a[180:183], v[232:235]
M v[236:239], a[124:127], a[180:183], v[236:239]
M v[236:239], a[120:123], a[176:179], v[236:239]
s_waitcnt vmcnt(9) lgkmcnt(0)
s_barrier
ds_read_b128 a[160:163], v10 offset:0
ds_read_b128 a[164:167], v11 offset:0
M v[240:243], a[128:131], a[176:179], v[240:243]
s_add_u32 m0, s29, 32768
s_nop 0
buffer_load_dwordx4 v2, s[8:11], s23 offen offset:0 lds
M v[240:243], a[132:135], a[180:183], v[240:243]
M v[244:247], a[140:143], a[180:183], v[244:247]
M v[244:247], a[136:139], a[176:179], v[244:247]
M v[248:251], a[144:147], a[176:179], v[248:251]
M v[248:251], a[148:151], a[180:183], v[248:251]
buffer_load_dwordx4 v3, s[8:11], s23 offen offset:1024 lds
M v[252:255], a[156:159], a[180:183], v[252:255]
M v[252:255], a[152:155], a[176:179], v[252:255]
M a[0:3], a[96:99], a[184:187], a[0:3]
M a[0:3], a[100:103], a[188:191], a[0:3]
ds_read_b128 a[168:171], v10 offset:2048
ds_read_b128 a[172:175], v11 offset:2048
M a[4:7], a[108:111], a[188:191], a[4:7]
M a[4:7], a[104:107], a[184:187], a[4:7]
M a[8:11], a[112:115], a[184:187], a[8:11]
buffer_load_dwordx4 v4, s[8:11], s23 offen offset:2048 lds
M a[8:11], a[116:119], a[188:191], a[8:11]
M a[12:15], a[124:127], a[188:191], a[12:15]
M a[12:15], a[120:123], a[184:187], a[12:15]
M a[16:19], a[128:131], a[184:187], a[16:19]
M a[16:19], a[132:135], a[188:191], a[16:19]
buffer_load_dwordx4 v5, s[8:11], s23 offen offset:3072 lds
M a[20:23], a[140:143], a[188:191], a[20:23]
M a[20:23], a[136:139], a[184:187], a[20:23]
M a[24:27], a[144:147], a[184:187], a[24:27]
M a[24:27], a[148:151], a[188:191], a[24:27]
M a[28:31], a[156:159], a[188:191], a[28:31]
M a[28:31], a[152:155], a[184:187], a[28:31]
s_waitcnt lgkmcnt(2)
s_sub_u32 s30, s30, 1
s_cmp_lg_u32 s30, 0
s_cbranch_scc1 Lk1_ql
M v[32:35], a[32:35], a[160:163], v[32:35]
s_add_u32 m0, s29, 65536
s_nop 0
buffer_load_dwordx4 v6, s[12:15], s24 offen offset:0 lds
M v[32:35], a[36:39], a[164:167], v[32:35]
ds_read_b128 a[176:179], v10 offset:4096
ds_read_b128 a[180:183], v11 offset:4096
M v[36:39], a[44:47], a[164:167], v[36:39]
M v[36:39], a[40:43], a[160:163], v[36:39]
ds_read_b64_tr_b16 a[96:97], v12 offset:32768
ds_read_b64_tr_b16 a[98:99], v12 offset:34816
M v[40:43], a[48:51], a[160:163], v[40:43]
M v[40:43], a[52:55], a[164:167], v[40:43]
M v[44:47], a[60:63], a[164:167], v[44:47]
M v[44:47], a[56:59], a[160:163], v[44:47]
ds_read_b64_tr_b16 a[104:105], v13 offset:32768
ds_read_b64_tr_b16 a[106:107], v13 offset:34816
M v[48:51], a[64:67], a[160:163], v[48:51]
buffer_load_dwordx4 v7, s[12:15], s24 offen offset:1024 lds
M v[48:51], a[68:71], a[164:167], v[48:51]
M v[52:55], a[76:79], a[164:167], v[52:55]
M v[52:55], a[72:75], a[160:163], v[52:55]
ds_read_b64_tr_b16 a[112:113], v14 offset:32768
ds_read_b64_tr_b16 a[114:115], v14 offset:34816
M v[56:59], a[80:83], a[160:163], v[56:59]
M v[56:59], a[84:87], a[164:167], v[56:59]
M v[60:63], a[92:95], a[164:167], v[60:63]
buffer_load_dwordx4 v8, s[12:15], s24 offen offset:2048 lds
M v[60:63], a[88:91], a[160:163], v[60:63]
s_waitcnt lgkmcnt(8)
ds_read_b64_tr_b16 a[120:121], v15 offset:32768
ds_read_b64_tr_b16 a[122:123], v15 offset:34816
M v[64:67], a[32:35], a[168:171], v[64:67]
M v[64:67], a[36:39], a[172:175], v[64:67]
ds_read_b128 a[184:187], v10 offset:6144
ds_read_b128 a[188:191], v11 offset:6144
M v[68:71], a[44:47], a[172:175], v[68:71]
M v[68:71], a[40:43], a[168:171], v[68:71]
ds_read_b64_tr_b16 a[128:129], v16 offset:32768
ds_read_b64_tr_b16 a[130:131], v16 offset:34816
M v[72:75], a[48:51], a[168:171], v[72:75]
M v[72:75], a[52:55], a[172:175], v[72:75]
M v[76:79], a[60:63], a[172:175], v[76:79]
M v[76:79], a[56:59], a[168:171], v[76:79]
ds_read_b64_tr_b16 a[136:137], v17 offset:32768
ds_read_b64_tr_b16 a[138:139], v17 offset:34816
M v[80:83], a[64:67], a[168:171], v[80:83]
buffer_load_dwordx4 v9, s[12:15], s24 offen offset:3072 lds
M v[80:83], a[68:71], a[172:175], v[80:83]
M v[84:87], a[76:79], a[172:175], v[84:87]
M v[84:87], a[72:75], a[168:171], v[84:87]
ds_read_b64_tr_b16 a[144:145], v18 offset:32768
ds_read_b64_tr_b16 a[146:147], v18 offset:34816
M v[88:91], a[80:83], a[168:171], v[88:91]
M v[88:91], a[84:87], a[172:175], v[88:91]
M v[92:95], a[92:95], a[172:175], v[92:95]
s_add_u32 s24, s24, 262144
M v[92:95], a[88:91], a[168:171], v[92:95]
s_waitcnt lgkmcnt(15)
ds_read_b64_tr_b16 a[152:153], v19 offset:32768
ds_read_b64_tr_b16 a[154:155], v19 offset:34816
M v[96:99], a[32:35], a[176:179], v[96:99]
M v[96:99], a[36:39], a[180:183], v[96:99]
M v[100:103], a[44:47], a[180:183], v[100:103]
M v[100:103], a[40:43], a[176:179], v[100:103]
M v[104:107], a[48:51], a[176:179], v[104:107]
M v[104:107], a[52:55], a[180:183], v[104:107]
M v[108:111], a[60:63], a[180:183], v[108:111]
M v[108:111], a[56:59], a[176:179], v[108:111]
s_waitcnt vmcnt(9) lgkmcnt(0)
s_barrier
ds_read_b128 a[160:163], v10 offset:16384
ds_read_b128 a[164:167], v11 offset:16384
M v[112:115], a[64:67], a[176:179], v[112:115]
s_add_u32 m0, s29, 49152
s_add_u32 s3, s23, s31
buffer_load_dwordx4 v2, s[8:11], s3 offen offset:0 lds
M v[112:115], a[68:71], a[180:183], v[112:115]
M v[116:119], a[76:79], a[180:183], v[116:119]
M v[116:119], a[72:75], a[176:179], v[116:119]
ds_read_b64_tr_b16 a[100:101], v12 offset:49152
ds_read_b64_tr_b16 a[102:103], v12 offset:51200
M v[120:123], a[80:83], a[176:179], v[120:123]
M v[120:123], a[84:87], a[180:183], v[120:123]
buffer_load_dwordx4 v3, s[8:11], s3 offen offset:1024 lds
M v[124:127], a[92:95], a[180:183], v[124:127]
M v[124:127], a[88:91], a[176:179], v[124:127]
M v[128:131], a[32:35], a[184:187], v[128:131]
M v[128:131], a[36:39], a[188:191], v[128:131]
ds_read_b128 a[168:171], v10 offset:18432
ds_read_b128 a[172:175], v11 offset:18432
ds_read_b64_tr_b16 a[108:109], v13 offset:49152
ds_read_b64_tr_b16 a[110:111], v13 offset:51200
M v[132:135], a[44:47], a[188:191], v[132:135]
M v[132:135], a[40:43], a[184:187], v[132:135]
M v[136:139], a[48:51], a[184:187], v[136:139]
buffer_load_dwordx4 v4, s[8:11], s3 offen offset:2048 lds
M v[136:139], a[52:55], a[188:191], v[136:139]
M v[140:143], a[60:63], a[188:191], v[140:143]
M v[140:143], a[56:59], a[184:187], v[140:143]
ds_read_b64_tr_b16 a[116:117], v14 offset:49152
ds_read_b64_tr_b16 a[118:119], v14 offset:51200
M v[144:147], a[64:67], a[184:187], v[144:147]
M v[144:147], a[68:71], a[188:191], v[144:147]
M v[148:151], a[76:79], a[188:191], v[148:151]
buffer_load_dwordx4 v5, s[8:11], s3 offen offset:3072 lds
M v[148:151], a[72:75], a[184:187], v[148:151]
M v[152:155], a[80:83], a[184:187], v[152:155]
M v[152:155], a[84:87], a[188:191], v[152:155]
ds_read_b64_tr_b16 a[124:125], v15 offset:49152
ds_read_b64_tr_b16 a[126:127], v15 offset:51200
M v[156:159], a[92:95], a[188:191], v[156:159]
M v[156:159], a[88:91], a[184:187], v[156:159]
s_waitcnt lgkmcnt(10)
M v[160:163], a[32:35], a[160:163], v[160:163]
M v[160:163], a[36:39], a[164:167], v[160:163]
ds_read_b128 a[176:179], v10 offset:20480
ds_read_b128 a[180:183], v11 offset:20480
M v[164:167], a[44:47], a[164:167], v[164:167]
s_add_u32 s23, s23, 128
s_cmp_eq_u32 s23, s25
s_cselect_b32 s23, s26, s23
M v[164:167], a[40:43], a[160:163], v[164:167]
ds_read_b64_tr_b16 a[132:133], v16 offset:49152
ds_read_b64_tr_b16 a[134:135], v16 offset:51200
M v[168:171], a[48:51], a[160:163], v[168:171]
M v[168:171], a[52:55], a[164:167], v[168:171]
M v[172:175], a[60:63], a[164:167], v[172:175]
M v[172:175], a[56:59], a[160:163], v[172:175]
M v[176:179], a[64:67], a[160:163], v[176:179]
s_add_u32 m0, s29, 81920
s_nop 0
buffer_load_dwordx4 v6, s[12:15], s24 offen offset:0 lds
M v[176:179], a[68:71], a[164:167], v[176:179]
ds_read_b64_tr_b16 a[140:141], v17 offset:49152
ds_read_b64_tr_b16 a[142:143], v17 offset:51200
M v[180:183], a[76:79], a[164:167], v[180:183]
M v[180:183], a[72:75], a[160:163], v[180:183]
M v[184:187], a[80:83], a[160:163], v[184:187]
M v[184:187], a[84:87], a[164:167], v[184:187]
buffer_load_dwordx4 v7, s[12:15], s24 offen offset:1024 lds
M v[188:191], a[92:95], a[164:167], v[188:191]
M v[188:191], a[88:91], a[160:163], v[188:191]
s_waitcnt lgkmcnt(12)
ds_read_b64_tr_b16 a[148:149], v18 offset:49152
ds_read_b64_tr_b16 a[150:151], v18 offset:51200
M v[192:195], a[32:35], a[168:171], v[192:195]
M v[192:195], a[36:39], a[172:175], v[192:195]
ds_read_b128 a[184:187], v10 offset:22528
ds_read_b128 a[188:191], v11 offset:22528
M v[196:199], a[44:47], a[172:175], v[196:199]
M v[196:199], a[40:43], a[168:171], v[196:199]
M v[200:203], a[48:51], a[168:171], v[200:203]
buffer_load_dwordx4 v8, s[12:15], s24 offen offset:2048 lds
M v[200:203], a[52:55], a[172:175], v[200:203]
ds_read_b64_tr_b16 a[156:157], v19 offset:49152
ds_read_b64_tr_b16 a[158:159], v19 offset:51200
M v[204:207], a[60:63], a[172:175], v[204:207]
M v[204:207], a[56:59], a[168:171], v[204:207]
M v[208:211], a[64:67], a[168:171], v[208:211]
M v[208:211], a[68:71], a[172:175], v[208:211]
M v[212:215], a[76:79], a[172:175], v[212:215]
buffer_load_dwordx4 v9, s[12:15], s24 offen offset:3072 lds
M v[212:215], a[72:75], a[168:171], v[212:215]
M v[216:219], a[80:83], a[168:171], v[216:219]
M v[216:219], a[84:87], a[172:175], v[216:219]
M v[220:223], a[92:95], a[172:175], v[220:223]
M v[220:223], a[88:91], a[168:171], v[220:223]
s_waitcnt lgkmcnt(10)
M v[224:227], a[32:35], a[176:179], v[224:227]
s_add_u32 s24, s24, 262144
s_cmp_eq_u32 s24, s27
s_cselect_b32 s24, s28, s24
s_sub_u32 s6, s6, 1
s_cmp_eq_u32 s6, 0
s_cselect_b64 s[12:13], s[64:65], s[12:13]
M v[224:227], a[36:39], a[180:183], v[224:227]
M v[228:231], a[44:47], a[180:183], v[228:231]
M v[228:231], a[40:43], a[176:179], v[228:231]
M v[232:235], a[48:51], a[176:179], v[232:235]
M v[232:235], a[52:55], a[180:183], v[232:235]
M v[236:239], a[60:63], a[180:183], v[236:239]
M v[236:239], a[56:59], a[176:179], v[236:239]
s_waitcnt vmcnt(8) lgkmcnt(0)
s_barrier
ds_read_b128 a[160:163], v10 offset:32768
ds_read_b128 a[164:167], v11 offset:32768
M v[240:243], a[64:67], a[176:179], v[240:243]
s_add_u32 m0, s29, 0
s_nop 0
buffer_load_dwordx4 v2, s[8:11], s23 offen offset:0 lds
M v[240:243], a[68:71], a[180:183], v[240:243]
M v[244:247], a[76:79], a[180:183], v[244:247]
M v[244:247], a[72:75], a[176:179], v[244:247]
M v[248:251], a[80:83], a[176:179], v[248:251]
M v[248:251], a[84:87], a[180:183], v[248:251]
buffer_load_dwordx4 v3, s[8:11], s23 offen offset:1024 lds
M v[252:255], a[92:95], a[180:183], v[252:255]
M v[252:255], a[88:91], a[176:179], v[252:255]
M a[0:3], a[32:35], a[184:187], a[0:3]
M a[0:3], a[36:39], a[188:191], a[0:3]
ds_read_b128 a[168:171], v10 offset:34816
ds_read_b128 a[172:175], v11 offset:34816
M a[4:7], a[44:47], a[188:191], a[4:7]
M a[4:7], a[40:43], a[184:187], a[4:7]
M a[8:11], a[48:51], a[184:187], a[8:11]
buffer_load_dwordx4 v4, s[8:11], s23 offen offset:2048 lds
M a[8:11], a[52:55], a[188:191], a[8:11]
M a[12:15], a[60:63], a[188:191], a[12:15]
M a[12:15], a[56:59], a[184:187], a[12:15]
M a[16:19], a[64:67], a[184:187], a[16:19]
M a[16:19], a[68:71], a[188:191], a[16:19]
buffer_load_dwordx4 v5, s[8:11], s23 offen offset:3072 lds
M a[20:23], a[76:79], a[188:191], a[20:23]
M a[20:23], a[72:75], a[184:187], a[20:23]
M a[24:27], a[80:83], a[184:187], a[24:27]
M a[24:27], a[84:87], a[188:191], a[24:27]
M a[28:31], a[92:95], a[188:191], a[28:31]
M a[28:31], a[88:91], a[184:187], a[28:31]
s_waitcnt lgkmcnt(2)
M v[32:35], a[96:99], a[160:163], v[32:35]
s_add_u32 m0, s29, 98304
s_nop 0
buffer_load_dwordx4 v6, s[12:15], s24 offen offset:0 lds
M v[32:35], a[100:103], a[164:167], v[32:35]
ds_read_b128 a[176:179], v10 offset:36864
ds_read_b128 a[180:183], v11 offset:36864
M v[36:39], a[108:111], a[164:167], v[36:39]
M v[36:39], a[104:107], a[160:163], v[36:39]
ds_read_b64_tr_b16 a[32:33], v12 offset:0
ds_read_b64_tr_b16 a[34:35], v12 offset:2048
M v[40:43], a[112:115], a[160:163], v[40:43]
M v[40:43], a[116:119], a[164:167], v[40:43]
M v[44:47], a[124:127], a[164:167], v[44:47]
M v[44:47], a[120:123], a[160:163], v[44:47]
ds_read_b64_tr_b16 a[40:41], v13 offset:0
ds_read_b64_tr_b16 a[42:43], v13 offset:2048
M v[48:51], a[128:131], a[160:163], v[48:51]
buffer_load_dwordx4 v7, s[12:15], s24 offen offset:1024 lds
M v[48:51], a[132:135], a[164:167], v[48:51]
M v[52:55], a[140:143], a[164:167], v[52:55]
M v[52:55], a[136:139], a[160:163], v[52:55]
ds_read_b64_tr_b16 a[48:49], v14 offset:0
ds_read_b64_tr_b16 a[50:51], v14 offset:2048
M v[56:59], a[144:147], a[160:163], v[56:59]
M v[56:59], a[148:151], a[164:167], v[56:59]
M v[60:63], a[156:159], a[164:167], v[60:63]
buffer_load_dwordx4 v8, s[12:15], s24 offen offset:2048 lds
M v[60:63], a[152:155], a[160:163], v[60:63]
s_waitcnt lgkmcnt(8)
ds_read_b64_tr_b16 a[56:57], v15 offset:0
ds_read_b64_tr_b16 a[58:59], v15 offset:2048
M v[64:67], a[96:99], a[168:171], v[64:67]
M v[64:67], a[100:103], a[172:175], v[64:67]
ds_read_b128 a[184:187], v10 offset:38912
ds_read_b128 a[188:191], v11 offset:38912
M v[68:71], a[108:111], a[172:175], v[68:71]
M v[68:71], a[104:107], a[168:171], v[68:71]
ds_read_b64_tr_b16 a[64:65], v16 offset:0
ds_read_b64_tr_b16 a[66:67], v16 offset:2048
M v[72:75], a[112:115], a[168:171], v[72:75]
M v[72:75], a[116:119], a[172:175], v[72:75]
M v[76:79], a[124:127], a[172:175], v[76:79]
M v[76:79], a[120:123], a[168:171], v[76:79]
ds_read_b64_tr_b16 a[72:73], v17 offset:0
ds_read_b64_tr_b16 a[74:75], v17 offset:2048
M v[80:83], a[128:131], a[168:171], v[80:83]
buffer_load_dwordx4 v9, s[12:15], s24 offen offset:3072 lds
M v[80:83], a[132:135], a[172:175], v[80:83]
M v[84:87], a[140:143], a[172:175], v[84:87]
M v[84:87], a[136:139], a[168:171], v[84:87]
ds_read_b64_tr_b16 a[80:81], v18 offset:0
ds_read_b64_tr_b16 a[82:83], v18 offset:2048
M v[88:91], a[144:147], a[168:171], v[88:91]
M v[88:91], a[148:151], a[172:175], v[88:91]
M v[92:95], a[156:159], a[172:175], v[92:95]
s_add_u32 s24, s24, 262144
M v[92:95], a[152:155], a[168:171], v[92:95]
s_waitcnt lgkmcnt(15)
ds_read_b64_tr_b16 a[88:89], v19 offset:0
ds_read_b64_tr_b16 a[90:91], v19 offset:2048
M v[96:99], a[96:99], a[176:179], v[96:99]
M v[96:99], a[100:103], a[180:183], v[96:99]
M v[100:103], a[108:111], a[180:183], v[100:103]
M v[100:103], a[104:107], a[176:179], v[100:103]
M v[104:107], a[112:115], a[176:179], v[104:107]
M v[104:107], a[116:119], a[180:183], v[104:107]
M v[108:111], a[124:127], a[180:183], v[108:111]
M v[108:111], a[120:123], a[176:179], v[108:111]
s_waitcnt vmcnt(8) lgkmcnt(0)
s_barrier
ds_read_b128 a[160:163], v10 offset:49152
ds_read_b128 a[164:167], v11 offset:49152
M v[112:115], a[128:131], a[176:179], v[112:115]
s_add_u32 m0, s29, 16384
s_add_u32 s3, s23, s31
buffer_load_dwordx4 v2, s[8:11], s3 offen offset:0 lds
M v[112:115], a[132:135], a[180:183], v[112:115]
M v[116:119], a[140:143], a[180:183], v[116:119]
M v[116:119], a[136:139], a[176:179], v[116:119]
ds_read_b64_tr_b16 a[36:37], v12 offset:16384
ds_read_b64_tr_b16 a[38:39], v12 offset:18432
M v[120:123], a[144:147], a[176:179], v[120:123]
M v[120:123], a[148:151], a[180:183], v[120:123]
buffer_load_dwordx4 v3, s[8:11], s3 offen offset:1024 lds
M v[124:127], a[156:159], a[180:183], v[124:127]
M v[124:127], a[152:155], a[176:179], v[124:127]
M v[128:131], a[96:99], a[184:187], v[128:131]
M v[128:131], a[100:103], a[188:191], v[128:131]
ds_read_b128 a[168:171], v10 offset:51200
ds_read_b128 a[172:175], v11 offset:51200
ds_read_b64_tr_b16 a[44:45], v13 offset:16384
ds_read_b64_tr_b16 a[46:47], v13 offset:18432
M v[132:135], a[108:111], a[188:191], v[132:135]
M v[132:135], a[104:107], a[184:187], v[132:135]
M v[136:139], a[112:115], a[184:187], v[136:139]
buffer_load_dwordx4 v4, s[8:11], s3 offen offset:2048 lds
M v[136:139], a[116:119], a[188:191], v[136:139]
M v[140:143], a[124:127], a[188:191], v[140:143]
M v[140:143], a[120:123], a[184:187], v[140:143]
ds_read_b64_tr_b16 a[52:53], v14 offset:16384
ds_read_b64_tr_b16 a[54:55], v14 offset:18432
M v[144:147], a[128:131], a[184:187], v[144:147]
M v[144:147], a[132:135], a[188:191], v[144:147]
M v[148:151], a[140:143], a[188:191], v[148:151]
buffer_load_dwordx4 v5, s[8:11], s3 offen offset:3072 lds
M v[148:151], a[136:139], a[184:187], v[148:151]
M v[152:155], a[144:147], a[184:187], v[152:155]
M v[152:155], a[148:151], a[188:191], v[152:155]
ds_read_b64_tr_b16 a[60:61], v15 offset:16384
ds_read_b64_tr_b16 a[62:63], v15 offset:18432
M v[156:159], a[156:159], a[188:191], v[156:159]
M v[156:159], a[152:155], a[184:187], v[156:159]
s_waitcnt lgkmcnt(10)
M v[160:163], a[96:99], a[160:163], v[160:163]
M v[160:163], a[100:103], a[164:167], v[160:163]
ds_read_b128 a[176:179], v10 offset:53248
ds_read_b128 a[180:183], v11 offset:53248
M v[164:167], a[108:111], a[164:167], v[164:167]
s_add_u32 s23, s23, 128
s_cmp_eq_u32 s23, s25
s_cselect_b32 s23, s26, s23
M v[164:167], a[104:107], a[160:163], v[164:167]
ds_read_b64_tr_b16 a[68:69], v16 offset:16384
ds_read_b64_tr_b16 a[70:71], v16 offset:18432
M v[168:171], a[112:115], a[160:163], v[168:171]
M v[168:171], a[116:119], a[164:167], v[168:171]
M v[172:175], a[124:127], a[164:167], v[172:175]
M v[172:175], a[120:123], a[160:163], v[172:175]
M v[176:179], a[128:131], a[160:163], v[176:179]
s_add_u32 m0, s29, 114688
s_nop 0
buffer_load_dwordx4 v6, s[12:15], s24 offen offset:0 lds
M v[176:179], a[132:135], a[164:167], v[176:179]
ds_read_b64_tr_b16 a[76:77], v17 offset:16384
ds_read_b64_tr_b16 a[78:79], v17 offset:18432
M v[180:183], a[140:143], a[164:167], v[180:183]
M v[180:183], a[136:139], a[160:163], v[180:183]
M v[184:187], a[144:147], a[160:163], v[184:187]
M v[184:187], a[148:151], a[164:167], v[184:187]
buffer_load_dwordx4 v7, s[12:15], s24 offen offset:1024 lds
M v[188:191], a[156:159], a[164:167], v[188:191]
M v[188:191], a[152:155], a[160:163], v[188:191]
s_waitcnt lgkmcnt(12)
ds_read_b64_tr_b16 a[84:85], v18 offset:16384
ds_read_b64_tr_b16 a[86:87], v18 offset:18432
M v[192:195], a[96:99], a[168:171], v[192:195]
M v[192:195], a[100:103], a[172:175], v[192:195]
ds_read_b128 a[184:187], v10 offset:55296
ds_read_b128 a[188:191], v11 offset:55296
M v[196:199], a[108:111], a[172:175], v[196:199]
M v[196:199], a[104:107], a[168:171], v[196:199]
M v[200:203], a[112:115], a[168:171], v[200:203]
buffer_load_dwordx4 v8, s[12:15], s24 offen offset:2048 lds
M v[200:203], a[116:119], a[172:175], v[200:203]
ds_read_b64_tr_b16 a[92:93], v19 offset:16384
ds_read_b64_tr_b16 a[94:95], v19 offset:18432
M v[204:207], a[124:127], a[172:175], v[204:207]
M v[204:207], a[120:123], a[168:171], v[204:207]
M v[208:211], a[128:131], a[168:171], v[208:211]
M v[208:211], a[132:135], a[172:175], v[208:211]
M v[212:215], a[140:143], a[172:175], v[212:215]
buffer_load_dwordx4 v9, s[12:15], s24 offen offset:3072 lds
M v[212:215], a[136:139], a[168:171], v[212:215]
M v[216:219], a[144:147], a[168:171], v[216:219]
M v[216:219], a[148:151], a[172:175], v[216:219]
M v[220:223], a[156:159], a[172:175], v[220:223]
M v[220:223], a[152:155], a[168:171], v[220:223]
s_waitcnt lgkmcnt(10)
M v[224:227], a[96:99], a[176:179], v[224:227]
s_add_u32 s24, s24, 262144
s_cmp_eq_u32 s24, s27
s_cselect_b32 s24, s28, s24
s_sub_u32 s6, s6, 1
s_cmp_eq_u32 s6, 0
s_cselect_b64 s[12:13], s[64:65], s[12:13]
M v[224:227], a[100:103], a[180:183], v[224:227]
M v[228:231], a[108:111], a[180:183], v[228:231]
M v[228:231], a[104:107], a[176:179], v[228:231]
M v[232:235], a[112:115], a[176:179], v[232:235]
M v[232:235], a[116:119], a[180:183], v[232:235]
M v[236:239], a[124:127], a[180:183], v[236:239]
M v[236:239], a[120:123], a[176:179], v[236:239]
s_waitcnt vmcnt(8) lgkmcnt(0)
s_barrier
ds_read_b128 a[160:163], v10 offset:0
ds_read_b128 a[164:167], v11 offset:0
M v[240:243], a[128:131], a[176:179], v[240:243]
s_add_u32 m0, s29, 32768
s_nop 0
buffer_load_dwordx4 v2, s[8:11], s23 offen offset:0 lds
M v[240:243], a[132:135], a[180:183], v[240:243]
M v[244:247], a[140:143], a[180:183], v[244:247]
M v[244:247], a[136:139], a[176:179], v[244:247]
M v[248:251], a[144:147], a[176:179], v[248:251]
M v[248:251], a[148:151], a[180:183], v[248:251]
M v[252:255], a[156:159], a[180:183], v[252:255]
M v[252:255], a[152:155], a[176:179], v[252:255]
M a[0:3], a[96:99], a[184:187], a[0:3]
M a[0:3], a[100:103], a[188:191], a[0:3]
ds_read_b128 a[168:171], v10 offset:2048
ds_read_b128 a[172:175], v11 offset:2048
M a[4:7], a[108:111], a[188:191], a[4:7]
M a[4:7], a[104:107], a[184:187], a[4:7]
M a[8:11], a[112:115], a[184:187], a[8:11]
buffer_load_dwordx4 v3, s[8:11], s23 offen offset:1024 lds
M a[8:11], a[116:119], a[188:191], a[8:11]
M a[12:15], a[124:127], a[188:191], a[12:15]
M a[12:15], a[120:123], a[184:187], a[12:15]
M a[16:19], a[128:131], a[184:187], a[16:19]
M a[16:19], a[132:135], a[188:191], a[16:19]
M a[20:23], a[140:143], a[188:191], a[20:23]
M a[20:23], a[136:139], a[184:187], a[20:23]
M a[24:27], a[144:147], a[184:187], a[24:27]
M a[24:27], a[148:151], a[188:191], a[24:27]
M a[28:31], a[156:159], a[188:191], a[28:31]
M a[28:31], a[152:155], a[184:187], a[28:31]
s_waitcnt lgkmcnt(2)
M v[32:35], a[32:35], a[160:163], v[32:35]
buffer_load_dwordx4 v4, s[8:11], s23 offen offset:2048 lds
M v[32:35], a[36:39], a[164:167], v[32:35]
ds_read_b128 a[176:179], v10 offset:4096
ds_read_b128 a[180:183], v11 offset:4096
M v[36:39], a[44:47], a[164:167], v[36:39]
M v[36:39], a[40:43], a[160:163], v[36:39]
ds_read_b64_tr_b16 a[96:97], v12 offset:32768
ds_read_b64_tr_b16 a[98:99], v12 offset:34816
M v[40:43], a[48:51], a[160:163], v[40:43]
M v[40:43], a[52:55], a[164:167], v[40:43]
M v[44:47], a[60:63], a[164:167], v[44:47]
M v[44:47], a[56:59], a[160:163], v[44:47]
ds_read_b64_tr_b16 a[104:105], v13 offset:32768
ds_read_b64_tr_b16 a[106:107], v13 offset:34816
M v[48:51], a[64:67], a[160:163], v[48:51]
M v[48:51], a[68:71], a[164:167], v[48:51]
M v[52:55], a[76:79], a[164:167], v[52:55]
M v[52:55], a[72:75], a[160:163], v[52:55]
ds_read_b64_tr_b16 a[112:113], v14 offset:32768
ds_read_b64_tr_b16 a[114:115], v14 offset:34816
M v[56:59], a[80:83], a[160:163], v[56:59]
M v[56:59], a[84:87], a[164:167], v[56:59]
M v[60:63], a[92:95], a[164:167], v[60:63]
M v[60:63], a[88:91], a[160:163], v[60:63]
s_waitcnt lgkmcnt(8)
ds_read_b64_tr_b16 a[120:121], v15 offset:32768
ds_read_b64_tr_b16 a[122:123], v15 offset:34816
M v[64:67], a[32:35], a[168:171], v[64:67]
M v[64:67], a[36:39], a[172:175], v[64:67]
ds_read_b128 a[184:187], v10 offset:6144
ds_read_b128 a[188:191], v11 offset:6144
M v[68:71], a[44:47], a[172:175], v[68:71]
M v[68:71], a[40:43], a[168:171], v[68:71]
ds_read_b64_tr_b16 a[128:129], v16 offset:32768
ds_read_b64_tr_b16 a[130:131], v16 offset:34816
M v[72:75], a[48:51], a[168:171], v[72:75]
buffer_load_dwordx4 v5, s[8:11], s23 offen offset:3072 lds
M v[72:75], a[52:55], a[172:175], v[72:75]
M v[76:79], a[60:63], a[172:175], v[76:79]
M v[76:79], a[56:59], a[168:171], v[76:79]
ds_read_b64_tr_b16 a[136:137], v17 offset:32768
ds_read_b64_tr_b16 a[138:139], v17 offset:34816
M v[80:83], a[64:67], a[168:171], v[80:83]
M v[80:83], a[68:71], a[172:175], v[80:83]
M v[84:87], a[76:79], a[172:175], v[84:87]
M v[84:87], a[72:75], a[168:171], v[84:87]
ds_read_b64_tr_b16 a[144:145], v18 offset:32768
ds_read_b64_tr_b16 a[146:147], v18 offset:34816
M v[88:91], a[80:83], a[168:171], v[88:91]
M v[88:91], a[84:87], a[172:175], v[88:91]
M v[92:95], a[92:95], a[172:175], v[92:95]
M v[92:95], a[88:91], a[168:171], v[92:95]
s_waitcnt lgkmcnt(15)
ds_read_b64_tr_b16 a[152:153], v19 offset:32768
ds_read_b64_tr_b16 a[154:155], v19 offset:34816
M v[96:99], a[32:35], a[176:179], v[96:99]
M v[96:99], a[36:39], a[180:183], v[96:99]
M v[100:103], a[44:47], a[180:183], v[100:103]
M v[100:103], a[40:43], a[176:179], v[100:103]
M v[104:107], a[48:51], a[176:179], v[104:107]
M v[104:107], a[52:55], a[180:183], v[104:107]
M v[108:111], a[60:63], a[180:183], v[108:111]
M v[108:111], a[56:59], a[176:179], v[108:111]
s_waitcnt vmcnt(4) lgkmcnt(0)
s_barrier
ds_read_b128 a[160:163], v10 offset:16384
ds_read_b128 a[164:167], v11 offset:16384
M v[112:115], a[64:67], a[176:179], v[112:115]
s_add_u32 m0, s29, 49152
s_add_u32 s3, s23, s31
buffer_load_dwordx4 v2, s[8:11], s3 offen offset:0 lds
M v[112:115], a[68:71], a[180:183], v[112:115]
M v[116:119], a[76:79], a[180:183], v[116:119]
buffer_load_dwordx4 v3, s[8:11], s3 offen offset:1024 lds
M v[116:119], a[72:75], a[176:179], v[116:119]
ds_read_b64_tr_b16 a[100:101], v12 offset:49152
ds_read_b64_tr_b16 a[102:103], v12 offset:51200
M v[120:123], a[80:83], a[176:179], v[120:123]
buffer_load_dwordx4 v4, s[8:11], s3 offen offset:2048 lds
M v[120:123], a[84:87], a[180:183], v[120:123]
M v[124:127], a[92:95], a[180:183], v[124:127]
buffer_load_dwordx4 v5, s[8:11], s3 offen offset:3072 lds
M v[124:127], a[88:91], a[176:179], v[124:127]
M v[128:131], a[32:35], a[184:187], v[128:131]
M v[128:131], a[36:39], a[188:191], v[128:131]
ds_read_b128 a[168:171], v10 offset:18432
ds_read_b128 a[172:175], v11 offset:18432
ds_read_b64_tr_b16 a[108:109], v13 offset:49152
ds_read_b64_tr_b16 a[110:111], v13 offset:51200
M v[132:135], a[44:47], a[188:191], v[132:135]
M v[132:135], a[40:43], a[184:187], v[132:135]
M v[136:139], a[48:51], a[184:187], v[136:139]
s_and_b32 s3, s2, 1
s_lshl_b32 s3, s3, 3
s_bfe_u32 s4, s2, 0x30003
s_add_u32 s26, s3, s4
M v[136:139], a[52:55], a[188:191], v[136:139]
s_bfe_u32 s3, s2, 0x20001
s_lshl_b32 s3, s3, 2
s_lshr_b32 s4, s2, 6
M v[140:143], a[60:63], a[188:191], v[140:143]
s_xor_b32 s4, s4, 2
s_add_u32 s27, s3, s4
s_lshl_b32 s23, s26, 18
M v[140:143], a[56:59], a[184:187], v[140:143]
ds_read_b64_tr_b16 a[116:117], v14 offset:49152
ds_read_b64_tr_b16 a[118:119], v14 offset:51200
s_sub_u32 s24, s23, 32768
s_max_i32 s24, s24, 0
s_lshl_b32 s25, s27, 7
s_add_u32 s3, s26, s27
M v[144:147], a[64:67], a[184:187], v[144:147]
s_and_b32 s3, s3, 0
s_mul_i32 s3, s3, 16
s_sub_u32 s31, 16, s3
M v[144:147], a[68:71], a[188:191], v[144:147]
s_mov_b32 s54, s31
s_movk_i32 s57, 128
s_mov_b32 s55, 4289069056
M v[148:151], a[76:79], a[188:191], v[148:151]
s_mov_b32 s56, 393216
s_lshl_b32 s4, s3, 7
s_add_u32 s23, s23, s4
s_add_u32 s24, s24, s4
M v[148:151], a[72:75], a[184:187], v[148:151]
s_mul_i32 s4, s3, 393216
s_add_u32 s25, s25, s4
s_mov_b64 s[8:9], s[44:45]
M v[152:155], a[80:83], a[184:187], v[152:155]
s_mov_b32 s10, 4194304
s_mov_b64 s[12:13], s[46:47]
s_mov_b32 s14, 6291456
M v[152:155], a[84:87], a[188:191], v[152:155]
ds_read_b64_tr_b16 a[124:125], v15 offset:49152
ds_read_b64_tr_b16 a[126:127], v15 offset:51200
s_mov_b64 s[36:37], s[90:91]
s_mov_b32 s38, 256
s_mov_b32 s39, 0x00020000
M v[156:159], a[92:95], a[188:191], v[156:159]
s_lshl_b32 s28, s20, 9
s_mul_i32 s30, s20, 6144
s_lshl_b32 s3, s20, 5
v_lshrrev_b32 v24, 3, v0
M v[156:159], a[88:91], a[184:187], v[156:159]
s_waitcnt lgkmcnt(10)
v_and_b32 v25, 7, v0
v_add_u32 v28, s3, v24
v_add_u32 v26, 0, v28
M v[160:163], a[32:35], a[160:163], v[160:163]
v_bfe_u32 v27, v26, 1, 3
v_xor_b32 v27, v27, v25
v_lshlrev_b32 v26, 11, v26
M v[160:163], a[36:39], a[164:167], v[160:163]
ds_read_b128 a[176:179], v10 offset:20480
ds_read_b128 a[180:183], v11 offset:20480
v_lshl_add_u32 v26, v27, 4, v26
v_subrev_u32 v2, 0, v26
v_add_u32 v26, 8, v28
v_bfe_u32 v27, v26, 1, 3
M v[164:167], a[44:47], a[164:167], v[164:167]
v_xor_b32 v27, v27, v25
v_lshlrev_b32 v26, 11, v26
v_lshl_add_u32 v26, v27, 4, v26
M v[164:167], a[40:43], a[160:163], v[164:167]
ds_read_b64_tr_b16 a[132:133], v16 offset:49152
ds_read_b64_tr_b16 a[134:135], v16 offset:51200
v_subrev_u32 v3, 1024, v26
v_add_u32 v26, 16, v28
v_bfe_u32 v27, v26, 1, 3
M v[168:171], a[48:51], a[160:163], v[168:171]
v_xor_b32 v27, v27, v25
v_lshlrev_b32 v26, 11, v26
v_lshl_add_u32 v26, v27, 4, v26
M v[168:171], a[52:55], a[164:167], v[168:171]
v_subrev_u32 v4, 2048, v26
v_add_u32 v26, 24, v28
v_bfe_u32 v27, v26, 1, 3
v_xor_b32 v27, v27, v25
M v[172:175], a[60:63], a[164:167], v[172:175]
v_lshlrev_b32 v26, 11, v26
v_lshl_add_u32 v26, v27, 4, v26
v_subrev_u32 v5, 3072, v26
M v[172:175], a[56:59], a[160:163], v[172:175]
s_lshl_b32 s3, s20, 2
v_lshrrev_b32 v26, 5, v0
v_add_u32 v26, s3, v26
M v[176:179], a[64:67], a[160:163], v[176:179]
v_bfe_u32 v29, v0, 2, 3
v_bfe_u32 v27, v26, 1, 3
v_xor_b32 v27, v27, v29
v_lshlrev_b32 v27, 4, v27
M v[176:179], a[68:71], a[164:167], v[176:179]
ds_read_b64_tr_b16 a[140:141], v17 offset:49152
ds_read_b64_tr_b16 a[142:143], v17 offset:51200
v_and_b32 v30, 3, v0
v_lshl_add_u32 v27, v30, 2, v27
v_lshl_add_u32 v20, v26, 11, v27
M v[180:183], a[76:79], a[164:167], v[180:183]
v_add_u32 v26, 2, v26
v_bfe_u32 v27, v26, 1, 3
v_xor_b32 v27, v27, v29
M v[180:183], a[72:75], a[160:163], v[180:183]
v_lshlrev_b32 v27, 4, v27
v_and_b32 v30, 3, v0
v_lshl_add_u32 v27, v30, 2, v27
M v[184:187], a[80:83], a[160:163], v[184:187]
v_lshl_add_u32 v23, v26, 11, v27
v_subrev_u32 v23, 256, v23
s_mul_i32 s3, s20, 48
v_add_u32 v28, s3, v24
M v[184:187], a[84:87], a[164:167], v[184:187]
v_add_u32 v26, 0, v28
v_mul_u32_u24 v27, 0xaaab, v26
v_lshrrev_b32 v27, 17, v27
M v[188:191], a[92:95], a[164:167], v[188:191]
v_lshrrev_b32 v29, 1, v27
v_and_b32 v29, 4, v29
v_and_or_b32 v27, v27, 2, v29
M v[188:191], a[88:91], a[160:163], v[188:191]
s_waitcnt lgkmcnt(12)
ds_read_b64_tr_b16 a[148:149], v18 offset:49152
ds_read_b64_tr_b16 a[150:151], v18 offset:51200
v_xor_b32 v27, v27, v25
v_lshlrev_b32 v26, 11, v26
v_lshl_add_u32 v26, v27, 4, v26
v_subrev_u32 v6, 0, v26
M v[192:195], a[32:35], a[168:171], v[192:195]
v_add_u32 v26, 8, v28
v_mul_u32_u24 v27, 0xaaab, v26
v_lshrrev_b32 v27, 17, v27
M v[192:195], a[36:39], a[172:175], v[192:195]
ds_read_b128 a[184:187], v10 offset:22528
ds_read_b128 a[188:191], v11 offset:22528
v_lshrrev_b32 v29, 1, v27
v_and_b32 v29, 4, v29
v_and_or_b32 v27, v27, 2, v29
M v[196:199], a[44:47], a[172:175], v[196:199]
v_xor_b32 v27, v27, v25
v_lshlrev_b32 v26, 11, v26
v_lshl_add_u32 v26, v27, 4, v26
v_subrev_u32 v7, 1024, v26
M v[196:199], a[40:43], a[168:171], v[196:199]
v_add_u32 v26, 16, v28
v_mul_u32_u24 v27, 0xaaab, v26
v_lshrrev_b32 v27, 17, v27
M v[200:203], a[48:51], a[168:171], v[200:203]
v_lshrrev_b32 v29, 1, v27
v_and_b32 v29, 4, v29
v_and_or_b32 v27, v27, 2, v29
M v[200:203], a[52:55], a[172:175], v[200:203]
ds_read_b64_tr_b16 a[156:157], v19 offset:49152
ds_read_b64_tr_b16 a[158:159], v19 offset:51200
v_xor_b32 v27, v27, v25
v_lshlrev_b32 v26, 11, v26
v_lshl_add_u32 v26, v27, 4, v26
M v[204:207], a[60:63], a[172:175], v[204:207]
v_subrev_u32 v8, 2048, v26
v_add_u32 v26, 24, v28
v_mul_u32_u24 v27, 0xaaab, v26
v_lshrrev_b32 v27, 17, v27
M v[204:207], a[56:59], a[168:171], v[204:207]
v_lshrrev_b32 v29, 1, v27
v_and_b32 v29, 4, v29
v_and_or_b32 v27, v27, 2, v29
M v[208:211], a[64:67], a[168:171], v[208:211]
v_xor_b32 v27, v27, v25
v_lshlrev_b32 v26, 11, v26
v_lshl_add_u32 v26, v27, 4, v26
M v[208:211], a[68:71], a[172:175], v[208:211]
v_subrev_u32 v9, 3072, v26
v_add_u32 v26, 32, v28
v_mul_u32_u24 v27, 0xaaab, v26
v_lshrrev_b32 v27, 17, v27
M v[212:215], a[76:79], a[172:175], v[212:215]
v_lshrrev_b32 v29, 1, v27
v_and_b32 v29, 4, v29
v_and_or_b32 v27, v27, 2, v29
M v[212:215], a[72:75], a[168:171], v[212:215]
v_xor_b32 v27, v27, v25
v_lshlrev_b32 v26, 11, v26
v_lshl_add_u32 v26, v27, 4, v26
M v[216:219], a[80:83], a[168:171], v[216:219]
v_subrev_u32 v21, 0, v26
v_add_u32 v26, 40, v28
v_mul_u32_u24 v27, 0xaaab, v26
M v[216:219], a[84:87], a[172:175], v[216:219]
v_lshrrev_b32 v27, 17, v27
v_lshrrev_b32 v29, 1, v27
v_and_b32 v29, 4, v29
v_and_or_b32 v27, v27, 2, v29
M v[220:223], a[92:95], a[172:175], v[220:223]
v_xor_b32 v27, v27, v25
v_lshlrev_b32 v26, 11, v26
v_lshl_add_u32 v26, v27, 4, v26
M v[220:223], a[88:91], a[168:171], v[220:223]
s_waitcnt lgkmcnt(10)
v_subrev_u32 v22, 1024, v26
s_lshr_b32 s3, s53, 7
s_add_u32 s3, s3, s22
M v[224:227], a[32:35], a[176:179], v[224:227]
s_lshl_b32 s3, s3, 5
s_lshr_b32 s19, s52, 6
s_add_u32 s3, s3, s19
s_lshl_b32 s19, s21, 1
M v[224:227], a[36:39], a[180:183], v[224:227]
s_add_u32 s3, s3, s19
s_lshl_b32 s92, s3, 14
s_add_u32 s93, s92, 16384
M v[228:231], a[44:47], a[180:183], v[228:231]
s_add_u32 s16, s50, 0
s_addc_u32 s17, s51, 0
s_mov_b32 s18, 16777216
M v[228:231], a[40:43], a[176:179], v[228:231]
s_mov_b32 s19, 0x00020000
s_mov_b32 s4, 0x3e0293ee
s_mov_b32 s5, 0x3e0293ee
M v[232:235], a[48:51], a[176:179], v[232:235]
M v[232:235], a[52:55], a[180:183], v[232:235]
M v[236:239], a[60:63], a[180:183], v[236:239]
M v[236:239], a[56:59], a[176:179], v[236:239]
s_waitcnt vmcnt(4) lgkmcnt(0)
s_barrier
ds_read_b128 a[160:163], v10 offset:32768
ds_read_b128 a[164:167], v11 offset:32768
M v[240:243], a[64:67], a[176:179], v[240:243]
s_add_u32 m0, s28, 131072
s_nop 0
buffer_load_dword v20, s[8:11], s24 offen lds
M v[240:243], a[68:71], a[180:183], v[240:243]
M v[244:247], a[76:79], a[180:183], v[244:247]
M v[244:247], a[72:75], a[176:179], v[244:247]
buffer_load_dword v23, s[8:11], s24 offen offset:256 lds
M v[248:251], a[80:83], a[176:179], v[248:251]
M v[248:251], a[84:87], a[180:183], v[248:251]
M v[252:255], a[92:95], a[180:183], v[252:255]
M v[252:255], a[88:91], a[176:179], v[252:255]
M a[0:3], a[32:35], a[184:187], a[0:3]
s_add_u32 m0, s29, 133120
s_nop 0
buffer_load_dwordx4 v2, s[8:11], s23 offen offset:0 lds
M a[0:3], a[36:39], a[188:191], a[0:3]
ds_read_b128 a[168:171], v10 offset:34816
ds_read_b128 a[172:175], v11 offset:34816
M a[4:7], a[44:47], a[188:191], a[4:7]
M a[4:7], a[40:43], a[184:187], a[4:7]
M a[8:11], a[48:51], a[184:187], a[8:11]
buffer_load_dwordx4 v3, s[8:11], s23 offen offset:1024 lds
M a[8:11], a[52:55], a[188:191], a[8:11]
M a[12:15], a[60:63], a[188:191], a[12:15]
M a[12:15], a[56:59], a[184:187], a[12:15]
M a[16:19], a[64:67], a[184:187], a[16:19]
buffer_load_dwordx4 v4, s[8:11], s23 offen offset:2048 lds
M a[16:19], a[68:71], a[188:191], a[16:19]
M a[20:23], a[76:79], a[188:191], a[20:23]
M a[20:23], a[72:75], a[184:187], a[20:23]
buffer_load_dwordx4 v5, s[8:11], s23 offen offset:3072 lds
M a[24:27], a[80:83], a[184:187], a[24:27]
M a[24:27], a[84:87], a[188:191], a[24:27]
M a[28:31], a[92:95], a[188:191], a[28:31]
M a[28:31], a[88:91], a[184:187], a[28:31]
s_waitcnt lgkmcnt(2)
M v[32:35], a[96:99], a[160:163], v[32:35]
s_sub_u32 s31, s31, 1
s_cmp_eq_u32 s31, 0
s_cselect_b32 s58, -1920, s57
s_add_u32 s23, s23, s58
s_add_u32 s24, s24, s58
M v[32:35], a[100:103], a[164:167], v[32:35]
ds_read_b128 a[176:179], v10 offset:36864
ds_read_b128 a[180:183], v11 offset:36864
M v[36:39], a[108:111], a[164:167], v[36:39]
M v[36:39], a[104:107], a[160:163], v[36:39]
M v[40:43], a[112:115], a[160:163], v[40:43]
M v[40:43], a[116:119], a[164:167], v[40:43]
s_add_u32 m0, s30, 65536
s_nop 0
buffer_load_dwordx4 v6, s[12:15], s25 offen offset:0 lds
M v[44:47], a[124:127], a[164:167], v[44:47]
M v[44:47], a[120:123], a[160:163], v[44:47]
M v[48:51], a[128:131], a[160:163], v[48:51]
M v[48:51], a[132:135], a[164:167], v[48:51]
buffer_load_dwordx4 v7, s[12:15], s25 offen offset:1024 lds
M v[52:55], a[140:143], a[164:167], v[52:55]
M v[52:55], a[136:139], a[160:163], v[52:55]
M v[56:59], a[144:147], a[160:163], v[56:59]
M v[56:59], a[148:151], a[164:167], v[56:59]
buffer_load_dwordx4 v8, s[12:15], s25 offen offset:2048 lds
M v[60:63], a[156:159], a[164:167], v[60:63]
M v[60:63], a[152:155], a[160:163], v[60:63]
s_waitcnt lgkmcnt(2)
M v[64:67], a[96:99], a[168:171], v[64:67]
M v[64:67], a[100:103], a[172:175], v[64:67]
ds_read_b128 a[184:187], v10 offset:38912
ds_read_b128 a[188:191], v11 offset:38912
M v[68:71], a[108:111], a[172:175], v[68:71]
M v[68:71], a[104:107], a[168:171], v[68:71]
buffer_load_dwordx4 v9, s[12:15], s25 offen offset:3072 lds
v_pk_mul_f32 v[32:33], v[32:33], s[4:5]
v_pk_mul_f32 v[34:35], v[34:35], s[4:5]
v_pk_mul_f32 v[36:37], v[36:37], s[4:5]
M v[72:75], a[112:115], a[168:171], v[72:75]
v_pk_mul_f32 v[38:39], v[38:39], s[4:5]
v_cvt_pk_bf16_f32 v32, v32, v33
M v[72:75], a[116:119], a[172:175], v[72:75]
v_cvt_pk_bf16_f32 v33, v34, v35
v_cvt_pk_bf16_f32 v34, v36, v37
M v[76:79], a[124:127], a[172:175], v[76:79]
v_cvt_pk_bf16_f32 v35, v38, v39
v_pk_mul_f32 v[40:41], v[40:41], s[4:5]
v_pk_mul_f32 v[42:43], v[42:43], s[4:5]
M v[76:79], a[120:123], a[168:171], v[76:79]
s_add_u32 m0, s30, 69632
s_nop 0
buffer_load_dwordx4 v21, s[12:15], s25 offen offset:0 lds
v_pk_mul_f32 v[44:45], v[44:45], s[4:5]
v_pk_mul_f32 v[46:47], v[46:47], s[4:5]
M v[80:83], a[128:131], a[168:171], v[80:83]
v_cvt_pk_bf16_f32 v40, v40, v41
v_cvt_pk_bf16_f32 v41, v42, v43
M v[80:83], a[132:135], a[172:175], v[80:83]
v_cvt_pk_bf16_f32 v42, v44, v45
v_cvt_pk_bf16_f32 v43, v46, v47
M v[84:87], a[140:143], a[172:175], v[84:87]
v_pk_mul_f32 v[48:49], v[48:49], s[4:5]
v_pk_mul_f32 v[50:51], v[50:51], s[4:5]
v_pk_mul_f32 v[52:53], v[52:53], s[4:5]
M v[84:87], a[136:139], a[168:171], v[84:87]
buffer_load_dwordx4 v22, s[12:15], s25 offen offset:1024 lds
v_pk_mul_f32 v[54:55], v[54:55], s[4:5]
v_cvt_pk_bf16_f32 v48, v48, v49
M v[88:91], a[144:147], a[168:171], v[88:91]
v_cvt_pk_bf16_f32 v49, v50, v51
v_cvt_pk_bf16_f32 v50, v52, v53
M v[88:91], a[148:151], a[172:175], v[88:91]
v_cvt_pk_bf16_f32 v51, v54, v55
v_pk_mul_f32 v[56:57], v[56:57], s[4:5]
v_pk_mul_f32 v[58:59], v[58:59], s[4:5]
M v[92:95], a[156:159], a[172:175], v[92:95]
v_pk_mul_f32 v[60:61], v[60:61], s[4:5]
v_pk_mul_f32 v[62:63], v[62:63], s[4:5]
M v[92:95], a[152:155], a[168:171], v[92:95]
s_waitcnt lgkmcnt(2)
v_cvt_pk_bf16_f32 v56, v56, v57
v_cvt_pk_bf16_f32 v57, v58, v59
M v[96:99], a[96:99], a[176:179], v[96:99]
s_sub_u32 s54, s54, 1
s_cmp_eq_u32 s54, 0
s_cselect_b32 s58, s55, s56
s_add_u32 s25, s25, s58
v_cvt_pk_bf16_f32 v58, v60, v61
v_cvt_pk_bf16_f32 v59, v62, v63
M v[96:99], a[100:103], a[180:183], v[96:99]
M v[100:103], a[108:111], a[180:183], v[100:103]
M v[100:103], a[104:107], a[176:179], v[100:103]
v_pk_mul_f32 v[64:65], v[64:65], s[4:5]
v_pk_mul_f32 v[66:67], v[66:67], s[4:5]
v_pk_mul_f32 v[68:69], v[68:69], s[4:5]
M v[104:107], a[112:115], a[176:179], v[104:107]
s_add_u32 s94, s92, 0
buffer_store_dwordx4 v[32:35], v1, s[16:19], s94 offen offset:0 sc1
v_pk_mul_f32 v[70:71], v[70:71], s[4:5]
v_cvt_pk_bf16_f32 v64, v64, v65
M v[104:107], a[116:119], a[180:183], v[104:107]
v_cvt_pk_bf16_f32 v65, v66, v67
v_cvt_pk_bf16_f32 v66, v68, v69
M v[108:111], a[124:127], a[180:183], v[108:111]
v_cvt_pk_bf16_f32 v67, v70, v71
v_pk_mul_f32 v[72:73], v[72:73], s[4:5]
v_pk_mul_f32 v[74:75], v[74:75], s[4:5]
M v[108:111], a[120:123], a[176:179], v[108:111]
s_waitcnt vmcnt(13) lgkmcnt(0)
s_barrier
ds_read_b128 a[160:163], v10 offset:49152
ds_read_b128 a[164:167], v11 offset:49152
v_pk_mul_f32 v[76:77], v[76:77], s[4:5]
v_pk_mul_f32 v[78:79], v[78:79], s[4:5]
M v[112:115], a[128:131], a[176:179], v[112:115]
s_add_u32 m0, s28, 0
s_nop 0
buffer_load_dword v20, s[8:11], s24 offen lds
v_cvt_pk_bf16_f32 v72, v72, v73
v_cvt_pk_bf16_f32 v73, v74, v75
M v[112:115], a[132:135], a[180:183], v[112:115]
v_cvt_pk_bf16_f32 v74, v76, v77
v_cvt_pk_bf16_f32 v75, v78, v79
M v[116:119], a[140:143], a[180:183], v[116:119]
s_add_u32 s94, s92, 0
buffer_store_dwordx4 v[40:43], v1, s[16:19], s94 offen offset:1024 sc1
v_pk_mul_f32 v[80:81], v[80:81], s[4:5]
v_pk_mul_f32 v[82:83], v[82:83], s[4:5]
v_pk_mul_f32 v[84:85], v[84:85], s[4:5]
M v[116:119], a[136:139], a[176:179], v[116:119]
v_pk_mul_f32 v[86:87], v[86:87], s[4:5]
v_cvt_pk_bf16_f32 v80, v80, v81
M v[120:123], a[144:147], a[176:179], v[120:123]
buffer_load_dword v23, s[8:11], s24 offen offset:256 lds
v_cvt_pk_bf16_f32 v81, v82, v83
v_cvt_pk_bf16_f32 v82, v84, v85
M v[120:123], a[148:151], a[180:183], v[120:123]
v_cvt_pk_bf16_f32 v83, v86, v87
v_pk_mul_f32 v[88:89], v[88:89], s[4:5]
v_pk_mul_f32 v[90:91], v[90:91], s[4:5]
M v[124:127], a[156:159], a[180:183], v[124:127]
v_pk_mul_f32 v[92:93], v[92:93], s[4:5]
v_pk_mul_f32 v[94:95], v[94:95], s[4:5]
M v[124:127], a[152:155], a[176:179], v[124:127]
v_cvt_pk_bf16_f32 v88, v88, v89
v_cvt_pk_bf16_f32 v89, v90, v91
M v[128:131], a[96:99], a[184:187], v[128:131]
s_add_u32 m0, s29, 2048
s_nop 0
buffer_load_dwordx4 v2, s[8:11], s23 offen offset:0 lds
v_cvt_pk_bf16_f32 v90, v92, v93
v_cvt_pk_bf16_f32 v91, v94, v95
M v[128:131], a[100:103], a[188:191], v[128:131]
ds_read_b128 a[168:171], v10 offset:51200
ds_read_b128 a[172:175], v11 offset:51200
M v[132:135], a[108:111], a[188:191], v[132:135]
s_add_u32 s94, s92, 0
buffer_store_dwordx4 v[48:51], v1, s[16:19], s94 offen offset:2048 sc1
M v[132:135], a[104:107], a[184:187], v[132:135]
v_pk_mul_f32 v[96:97], v[96:97], s[4:5]
v_pk_mul_f32 v[98:99], v[98:99], s[4:5]
v_pk_mul_f32 v[100:101], v[100:101], s[4:5]
M v[136:139], a[112:115], a[184:187], v[136:139]
v_pk_mul_f32 v[102:103], v[102:103], s[4:5]
v_cvt_pk_bf16_f32 v96, v96, v97
M v[136:139], a[116:119], a[188:191], v[136:139]
buffer_load_dwordx4 v3, s[8:11], s23 offen offset:1024 lds
v_cvt_pk_bf16_f32 v97, v98, v99
v_cvt_pk_bf16_f32 v98, v100, v101
M v[140:143], a[124:127], a[188:191], v[140:143]
v_cvt_pk_bf16_f32 v99, v102, v103
v_pk_mul_f32 v[104:105], v[104:105], s[4:5]
v_pk_mul_f32 v[106:107], v[106:107], s[4:5]
M v[140:143], a[120:123], a[184:187], v[140:143]
v_pk_mul_f32 v[108:109], v[108:109], s[4:5]
v_pk_mul_f32 v[110:111], v[110:111], s[4:5]
M v[144:147], a[128:131], a[184:187], v[144:147]
s_add_u32 s94, s92, 0
buffer_store_dwordx4 v[56:59], v1, s[16:19], s94 offen offset:3072 sc1
v_cvt_pk_bf16_f32 v104, v104, v105
v_cvt_pk_bf16_f32 v105, v106, v107
M v[144:147], a[132:135], a[188:191], v[144:147]
v_cvt_pk_bf16_f32 v106, v108, v109
v_cvt_pk_bf16_f32 v107, v110, v111
M v[148:151], a[140:143], a[188:191], v[148:151]
buffer_load_dwordx4 v4, s[8:11], s23 offen offset:2048 lds
v_pk_mul_f32 v[112:113], v[112:113], s[4:5]
v_pk_mul_f32 v[114:115], v[114:115], s[4:5]
v_pk_mul_f32 v[116:117], v[116:117], s[4:5]
M v[148:151], a[136:139], a[184:187], v[148:151]
v_pk_mul_f32 v[118:119], v[118:119], s[4:5]
v_cvt_pk_bf16_f32 v112, v112, v113
M v[152:155], a[144:147], a[184:187], v[152:155]
v_cvt_pk_bf16_f32 v113, v114, v115
v_cvt_pk_bf16_f32 v114, v116, v117
M v[152:155], a[148:151], a[188:191], v[152:155]
buffer_load_dwordx4 v5, s[8:11], s23 offen offset:3072 lds
v_cvt_pk_bf16_f32 v115, v118, v119
v_pk_mul_f32 v[120:121], v[120:121], s[4:5]
v_pk_mul_f32 v[122:123], v[122:123], s[4:5]
M v[156:159], a[156:159], a[188:191], v[156:159]
v_pk_mul_f32 v[124:125], v[124:125], s[4:5]
v_pk_mul_f32 v[126:127], v[126:127], s[4:5]
M v[156:159], a[152:155], a[184:187], v[156:159]
s_add_u32 s94, s92, 4096
buffer_store_dwordx4 v[64:67], v1, s[16:19], s94 offen offset:0 sc1
s_waitcnt lgkmcnt(2)
v_cvt_pk_bf16_f32 v120, v120, v121
v_cvt_pk_bf16_f32 v121, v122, v123
M v[160:163], a[96:99], a[160:163], v[160:163]
v_cvt_pk_bf16_f32 v122, v124, v125
v_cvt_pk_bf16_f32 v123, v126, v127
M v[160:163], a[100:103], a[164:167], v[160:163]
ds_read_b128 a[176:179], v10 offset:53248
ds_read_b128 a[180:183], v11 offset:53248
M v[164:167], a[108:111], a[164:167], v[164:167]
s_sub_u32 s31, s31, 1
s_cmp_eq_u32 s31, 0
s_cselect_b32 s58, -1920, s57
s_add_u32 s23, s23, s58
s_add_u32 s24, s24, s58
M v[164:167], a[104:107], a[160:163], v[164:167]
v_pk_mul_f32 v[128:129], v[128:129], s[4:5]
v_pk_mul_f32 v[130:131], v[130:131], s[4:5]
v_pk_mul_f32 v[132:133], v[132:133], s[4:5]
M v[168:171], a[112:115], a[160:163], v[168:171]
v_pk_mul_f32 v[134:135], v[134:135], s[4:5]
v_cvt_pk_bf16_f32 v128, v128, v129
M v[168:171], a[116:119], a[164:167], v[168:171]
s_add_u32 s94, s92, 4096
buffer_store_dwordx4 v[72:75], v1, s[16:19], s94 offen offset:1024 sc1
v_cvt_pk_bf16_f32 v129, v130, v131
v_cvt_pk_bf16_f32 v130, v132, v133
M v[172:175], a[124:127], a[164:167], v[172:175]
v_cvt_pk_bf16_f32 v131, v134, v135
v_pk_mul_f32 v[136:137], v[136:137], s[4:5]
v_pk_mul_f32 v[138:139], v[138:139], s[4:5]
M v[172:175], a[120:123], a[160:163], v[172:175]
s_add_u32 m0, s30, 98304
s_nop 0
buffer_load_dwordx4 v6, s[12:15], s25 offen offset:0 lds
v_pk_mul_f32 v[140:141], v[140:141], s[4:5]
v_pk_mul_f32 v[142:143], v[142:143], s[4:5]
M v[176:179], a[128:131], a[160:163], v[176:179]
v_cvt_pk_bf16_f32 v136, v136, v137
v_cvt_pk_bf16_f32 v137, v138, v139
M v[176:179], a[132:135], a[164:167], v[176:179]
v_cvt_pk_bf16_f32 v138, v140, v141
v_cvt_pk_bf16_f32 v139, v142, v143
M v[180:183], a[140:143], a[164:167], v[180:183]
buffer_load_dwordx4 v7, s[12:15], s25 offen offset:1024 lds
v_pk_mul_f32 v[144:145], v[144:145], s[4:5]
v_pk_mul_f32 v[146:147], v[146:147], s[4:5]
v_pk_mul_f32 v[148:149], v[148:149], s[4:5]
M v[180:183], a[136:139], a[160:163], v[180:183]
v_pk_mul_f32 v[150:151], v[150:151], s[4:5]
v_cvt_pk_bf16_f32 v144, v144, v145
M v[184:187], a[144:147], a[160:163], v[184:187]
s_add_u32 s94, s92, 4096
buffer_store_dwordx4 v[80:83], v1, s[16:19], s94 offen offset:2048 sc1
v_cvt_pk_bf16_f32 v145, v146, v147
v_cvt_pk_bf16_f32 v146, v148, v149
M v[184:187], a[148:151], a[164:167], v[184:187]
v_cvt_pk_bf16_f32 v147, v150, v151
v_pk_mul_f32 v[152:153], v[152:153], s[4:5]
v_pk_mul_f32 v[154:155], v[154:155], s[4:5]
M v[188:191], a[156:159], a[164:167], v[188:191]
buffer_load_dwordx4 v8, s[12:15], s25 offen offset:2048 lds
v_pk_mul_f32 v[156:157], v[156:157], s[4:5]
v_pk_mul_f32 v[158:159], v[158:159], s[4:5]
M v[188:191], a[152:155], a[160:163], v[188:191]
s_waitcnt lgkmcnt(2)
v_cvt_pk_bf16_f32 v152, v152, v153
v_cvt_pk_bf16_f32 v153, v154, v155
M v[192:195], a[96:99], a[168:171], v[192:195]
v_cvt_pk_bf16_f32 v154, v156, v157
v_cvt_pk_bf16_f32 v155, v158, v159
M v[192:195], a[100:103], a[172:175], v[192:195]
ds_read_b128 a[184:187], v10 offset:55296
ds_read_b128 a[188:191], v11 offset:55296
M v[196:199], a[108:111], a[172:175], v[196:199]
M v[196:199], a[104:107], a[168:171], v[196:199]
s_add_u32 s94, s92, 4096
buffer_store_dwordx4 v[88:91], v1, s[16:19], s94 offen offset:3072 sc1
v_pk_mul_f32 v[160:161], v[160:161], s[4:5]
v_pk_mul_f32 v[162:163], v[162:163], s[4:5]
v_pk_mul_f32 v[164:165], v[164:165], s[4:5]
M v[200:203], a[112:115], a[168:171], v[200:203]
buffer_load_dwordx4 v9, s[12:15], s25 offen offset:3072 lds
v_pk_mul_f32 v[166:167], v[166:167], s[4:5]
v_cvt_pk_bf16_f32 v160, v160, v161
M v[200:203], a[116:119], a[172:175], v[200:203]
v_cvt_pk_bf16_f32 v161, v162, v163
v_cvt_pk_bf16_f32 v162, v164, v165
M v[204:207], a[124:127], a[172:175], v[204:207]
v_cvt_pk_bf16_f32 v163, v166, v167
v_pk_mul_f32 v[168:169], v[168:169], s[4:5]
v_pk_mul_f32 v[170:171], v[170:171], s[4:5]
M v[204:207], a[120:123], a[168:171], v[204:207]
v_pk_mul_f32 v[172:173], v[172:173], s[4:5]
v_pk_mul_f32 v[174:175], v[174:175], s[4:5]
M v[208:211], a[128:131], a[168:171], v[208:211]
s_add_u32 m0, s30, 102400
s_nop 0
buffer_load_dwordx4 v21, s[12:15], s25 offen offset:0 lds
v_cvt_pk_bf16_f32 v168, v168, v169
v_cvt_pk_bf16_f32 v169, v170, v171
M v[208:211], a[132:135], a[172:175], v[208:211]
v_cvt_pk_bf16_f32 v170, v172, v173
v_cvt_pk_bf16_f32 v171, v174, v175
M v[212:215], a[140:143], a[172:175], v[212:215]
s_add_u32 s94, s92, 8192
buffer_store_dwordx4 v[96:99], v1, s[16:19], s94 offen offset:0 sc1
v_pk_mul_f32 v[176:177], v[176:177], s[4:5]
v_pk_mul_f32 v[178:179], v[178:179], s[4:5]
v_pk_mul_f32 v[180:181], v[180:181], s[4:5]
M v[212:215], a[136:139], a[168:171], v[212:215]
v_pk_mul_f32 v[182:183], v[182:183], s[4:5]
v_cvt_pk_bf16_f32 v176, v176, v177
M v[216:219], a[144:147], a[168:171], v[216:219]
buffer_load_dwordx4 v22, s[12:15], s25 offen offset:1024 lds
v_cvt_pk_bf16_f32 v177, v178, v179
v_cvt_pk_bf16_f32 v178, v180, v181
M v[216:219], a[148:151], a[172:175], v[216:219]
v_cvt_pk_bf16_f32 v179, v182, v183
v_pk_mul_f32 v[184:185], v[184:185], s[4:5]
v_pk_mul_f32 v[186:187], v[186:187], s[4:5]
M v[220:223], a[156:159], a[172:175], v[220:223]
v_pk_mul_f32 v[188:189], v[188:189], s[4:5]
v_pk_mul_f32 v[190:191], v[190:191], s[4:5]
M v[220:223], a[152:155], a[168:171], v[220:223]
s_waitcnt lgkmcnt(2)
v_cvt_pk_bf16_f32 v184, v184, v185
v_cvt_pk_bf16_f32 v185, v186, v187
M v[224:227], a[96:99], a[176:179], v[224:227]
s_add_u32 s94, s92, 8192
buffer_store_dwordx4 v[104:107], v1, s[16:19], s94 offen offset:1024 sc1
v_cvt_pk_bf16_f32 v186, v188, v189
v_cvt_pk_bf16_f32 v187, v190, v191
M v[224:227], a[100:103], a[180:183], v[224:227]
s_sub_u32 s54, s54, 1
s_cmp_eq_u32 s54, 0
s_cselect_b32 s58, s55, s56
s_add_u32 s25, s25, s58
M v[228:231], a[108:111], a[180:183], v[228:231]
M v[228:231], a[104:107], a[176:179], v[228:231]
v_pk_mul_f32 v[192:193], v[192:193], s[4:5]
v_pk_mul_f32 v[194:195], v[194:195], s[4:5]
v_pk_mul_f32 v[196:197], v[196:197], s[4:5]
M v[232:235], a[112:115], a[176:179], v[232:235]
v_pk_mul_f32 v[198:199], v[198:199], s[4:5]
v_cvt_pk_bf16_f32 v192, v192, v193
M v[232:235], a[116:119], a[180:183], v[232:235]
v_cvt_pk_bf16_f32 v193, v194, v195
v_cvt_pk_bf16_f32 v194, v196, v197
M v[236:239], a[124:127], a[180:183], v[236:239]
v_cvt_pk_bf16_f32 v195, v198, v199
v_pk_mul_f32 v[200:201], v[200:201], s[4:5]
v_pk_mul_f32 v[202:203], v[202:203], s[4:5]
M v[236:239], a[120:123], a[176:179], v[236:239]
s_waitcnt vmcnt(63) lgkmcnt(0)
s_barrier
v_pk_mul_f32 v[204:205], v[204:205], s[4:5]
v_pk_mul_f32 v[206:207], v[206:207], s[4:5]
M v[240:243], a[128:131], a[176:179], v[240:243]
s_add_u32 s94, s92, 8192
buffer_store_dwordx4 v[112:115], v1, s[16:19], s94 offen offset:2048 sc1
v_cvt_pk_bf16_f32 v200, v200, v201
v_cvt_pk_bf16_f32 v201, v202, v203
M v[240:243], a[132:135], a[180:183], v[240:243]
s_add_u32 m0, s28, 18432
s_nop 0
buffer_load_dword v20, s[8:11], s24 offen lds
v_cvt_pk_bf16_f32 v202, v204, v205
v_cvt_pk_bf16_f32 v203, v206, v207
M v[244:247], a[140:143], a[180:183], v[244:247]
v_pk_mul_f32 v[208:209], v[208:209], s[4:5]
v_pk_mul_f32 v[210:211], v[210:211], s[4:5]
v_pk_mul_f32 v[212:213], v[212:213], s[4:5]
M v[244:247], a[136:139], a[176:179], v[244:247]
v_pk_mul_f32 v[214:215], v[214:215], s[4:5]
v_cvt_pk_bf16_f32 v208, v208, v209
M v[248:251], a[144:147], a[176:179], v[248:251]
buffer_load_dword v23, s[8:11], s24 offen offset:256 lds
v_cvt_pk_bf16_f32 v209, v210, v211
v_cvt_pk_bf16_f32 v210, v212, v213
M v[248:251], a[148:151], a[180:183], v[248:251]
v_cvt_pk_bf16_f32 v211, v214, v215
v_pk_mul_f32 v[216:217], v[216:217], s[4:5]
v_pk_mul_f32 v[218:219], v[218:219], s[4:5]
M v[252:255], a[156:159], a[180:183], v[252:255]
s_add_u32 s94, s92, 8192
buffer_store_dwordx4 v[120:123], v1, s[16:19], s94 offen offset:3072 sc1
v_pk_mul_f32 v[220:221], v[220:221], s[4:5]
v_pk_mul_f32 v[222:223], v[222:223], s[4:5]
M v[252:255], a[152:155], a[176:179], v[252:255]
v_cvt_pk_bf16_f32 v216, v216, v217
v_cvt_pk_bf16_f32 v217, v218, v219
M a[0:3], a[96:99], a[184:187], a[0:3]
v_cvt_pk_bf16_f32 v218, v220, v221
v_cvt_pk_bf16_f32 v219, v222, v223
M a[0:3], a[100:103], a[188:191], a[0:3]
s_add_u32 m0, s29, 20480
s_nop 0
buffer_load_dwordx4 v2, s[8:11], s23 offen offset:0 lds
M a[4:7], a[108:111], a[188:191], a[4:7]
M a[4:7], a[104:107], a[184:187], a[4:7]
v_pk_mul_f32 v[224:225], v[224:225], s[4:5]
v_pk_mul_f32 v[226:227], v[226:227], s[4:5]
v_pk_mul_f32 v[228:229], v[228:229], s[4:5]
M a[8:11], a[112:115], a[184:187], a[8:11]
buffer_load_dwordx4 v3, s[8:11], s23 offen offset:1024 lds
v_pk_mul_f32 v[230:231], v[230:231], s[4:5]
v_cvt_pk_bf16_f32 v224, v224, v225
M a[8:11], a[116:119], a[188:191], a[8:11]
s_add_u32 s94, s92, 12288
buffer_store_dwordx4 v[128:131], v1, s[16:19], s94 offen offset:0 sc1
v_cvt_pk_bf16_f32 v225, v226, v227
v_cvt_pk_bf16_f32 v226, v228, v229
M a[12:15], a[124:127], a[188:191], a[12:15]
v_cvt_pk_bf16_f32 v227, v230, v231
v_pk_mul_f32 v[232:233], v[232:233], s[4:5]
v_pk_mul_f32 v[234:235], v[234:235], s[4:5]
M a[12:15], a[120:123], a[184:187], a[12:15]
v_pk_mul_f32 v[236:237], v[236:237], s[4:5]
v_pk_mul_f32 v[238:239], v[238:239], s[4:5]
M a[16:19], a[128:131], a[184:187], a[16:19]
buffer_load_dwordx4 v4, s[8:11], s23 offen offset:2048 lds
v_cvt_pk_bf16_f32 v232, v232, v233
v_cvt_pk_bf16_f32 v233, v234, v235
M a[16:19], a[132:135], a[188:191], a[16:19]
v_cvt_pk_bf16_f32 v234, v236, v237
v_cvt_pk_bf16_f32 v235, v238, v239
M a[20:23], a[140:143], a[188:191], a[20:23]
v_pk_mul_f32 v[240:241], v[240:241], s[4:5]
v_pk_mul_f32 v[242:243], v[242:243], s[4:5]
v_pk_mul_f32 v[244:245], v[244:245], s[4:5]
M a[20:23], a[136:139], a[184:187], a[20:23]
buffer_load_dwordx4 v5, s[8:11], s23 offen offset:3072 lds
v_pk_mul_f32 v[246:247], v[246:247], s[4:5]
v_cvt_pk_bf16_f32 v240, v240, v241
M a[24:27], a[144:147], a[184:187], a[24:27]
s_add_u32 s94, s92, 12288
buffer_store_dwordx4 v[136:139], v1, s[16:19], s94 offen offset:1024 sc1
v_cvt_pk_bf16_f32 v241, v242, v243
v_cvt_pk_bf16_f32 v242, v244, v245
M a[24:27], a[148:151], a[188:191], a[24:27]
v_cvt_pk_bf16_f32 v243, v246, v247
v_pk_mul_f32 v[248:249], v[248:249], s[4:5]
v_pk_mul_f32 v[250:251], v[250:251], s[4:5]
M a[28:31], a[156:159], a[188:191], a[28:31]
v_pk_mul_f32 v[252:253], v[252:253], s[4:5]
v_pk_mul_f32 v[254:255], v[254:255], s[4:5]
M a[28:31], a[152:155], a[184:187], a[28:31]
v_cvt_pk_bf16_f32 v248, v248, v249
v_cvt_pk_bf16_f32 v249, v250, v251
v_cvt_pk_bf16_f32 v250, v252, v253
v_cvt_pk_bf16_f32 v251, v254, v255
v_accvgpr_read_b32 v24, a0
v_accvgpr_read_b32 v25, a1
v_accvgpr_read_b32 v26, a2
v_accvgpr_read_b32 v27, a3
v_accvgpr_read_b32 v28, a4
v_accvgpr_read_b32 v29, a5
v_accvgpr_read_b32 v30, a6
v_accvgpr_read_b32 v31, a7
v_pk_mul_f32 v[24:25], v[24:25], s[4:5]
v_pk_mul_f32 v[26:27], v[26:27], s[4:5]
v_pk_mul_f32 v[28:29], v[28:29], s[4:5]
v_pk_mul_f32 v[30:31], v[30:31], s[4:5]
v_cvt_pk_bf16_f32 v36, v24, v25
v_cvt_pk_bf16_f32 v37, v26, v27
v_cvt_pk_bf16_f32 v38, v28, v29
v_cvt_pk_bf16_f32 v39, v30, v31
v_accvgpr_read_b32 v24, a8
v_accvgpr_read_b32 v25, a9
v_accvgpr_read_b32 v26, a10
v_accvgpr_read_b32 v27, a11
v_accvgpr_read_b32 v28, a12
v_accvgpr_read_b32 v29, a13
v_accvgpr_read_b32 v30, a14
v_accvgpr_read_b32 v31, a15
v_pk_mul_f32 v[24:25], v[24:25], s[4:5]
v_pk_mul_f32 v[26:27], v[26:27], s[4:5]
v_pk_mul_f32 v[28:29], v[28:29], s[4:5]
v_pk_mul_f32 v[30:31], v[30:31], s[4:5]
v_cvt_pk_bf16_f32 v44, v24, v25
v_cvt_pk_bf16_f32 v45, v26, v27
v_cvt_pk_bf16_f32 v46, v28, v29
v_cvt_pk_bf16_f32 v47, v30, v31
v_accvgpr_read_b32 v24, a16
v_accvgpr_read_b32 v25, a17
v_accvgpr_read_b32 v26, a18
v_accvgpr_read_b32 v27, a19
v_accvgpr_read_b32 v28, a20
v_accvgpr_read_b32 v29, a21
v_accvgpr_read_b32 v30, a22
v_accvgpr_read_b32 v31, a23
v_pk_mul_f32 v[24:25], v[24:25], s[4:5]
v_pk_mul_f32 v[26:27], v[26:27], s[4:5]
v_pk_mul_f32 v[28:29], v[28:29], s[4:5]
v_pk_mul_f32 v[30:31], v[30:31], s[4:5]
v_cvt_pk_bf16_f32 v52, v24, v25
v_cvt_pk_bf16_f32 v53, v26, v27
v_cvt_pk_bf16_f32 v54, v28, v29
v_cvt_pk_bf16_f32 v55, v30, v31
v_accvgpr_read_b32 v24, a24
v_accvgpr_read_b32 v25, a25
v_accvgpr_read_b32 v26, a26
v_accvgpr_read_b32 v27, a27
v_accvgpr_read_b32 v28, a28
v_accvgpr_read_b32 v29, a29
v_accvgpr_read_b32 v30, a30
v_accvgpr_read_b32 v31, a31
v_pk_mul_f32 v[24:25], v[24:25], s[4:5]
v_pk_mul_f32 v[26:27], v[26:27], s[4:5]
v_pk_mul_f32 v[28:29], v[28:29], s[4:5]
v_pk_mul_f32 v[30:31], v[30:31], s[4:5]
v_cvt_pk_bf16_f32 v60, v24, v25
v_cvt_pk_bf16_f32 v61, v26, v27
v_cvt_pk_bf16_f32 v62, v28, v29
v_cvt_pk_bf16_f32 v63, v30, v31
s_branch Lk1_b
Lk1_spin:
s_add_u32 s40, s40, 1
s_cmp_gt_u32 s40, 1048576
s_cbranch_scc1 Lk1_got
s_sleep 2
buffer_load_dword v126, v119, s[36:39], 0 offen offset:128 sc1
s_waitcnt vmcnt(0)
v_cmp_gt_u32 vcc, 0x80, v126
s_nop 0
s_cbranch_vccnz Lk1_spin
s_branch Lk1_got
Lk1_spinq:
s_add_u32 s40, s40, 1
s_cmp_gt_u32 s40, 1048576
s_cbranch_scc1 Lk1_gotq
s_sleep 2
buffer_load_dword v125, v119, s[36:39], 0 offen offset:0 sc1
s_waitcnt vmcnt(0)
v_cmp_gt_u32 vcc, 0x80, v125
s_nop 0
s_cbranch_vccnz Lk1_spinq
s_branch Lk1_gotq
Lk1_kv:
s_mov_b64 s[60:61], s[40:41]
s_mov_b32 s62, 4194304
s_and_b32 s3, s2, 127
s_lshl_b32 s3, s3, 2
s_add_u32 s3, s3, s20
s_mul_i32 s54, s3, 1024
M v[32:35], a[32:35], a[160:163], 0
s_add_u32 m0, s29, 32768
s_nop 0
buffer_load_dwordx4 v2, s[8:11], s23 offen offset:0 lds
M v[32:35], a[36:39], a[164:167], v[32:35]
ds_read_b128 a[176:179], v10 offset:4096
ds_read_b128 a[180:183], v11 offset:4096
M v[36:39], a[44:47], a[164:167], 0
M v[36:39], a[40:43], a[160:163], v[36:39]
ds_read_b64_tr_b16 a[96:97], v12 offset:32768
ds_read_b64_tr_b16 a[98:99], v12 offset:34816
M v[40:43], a[48:51], a[160:163], 0
M v[40:43], a[52:55], a[164:167], v[40:43]
buffer_load_dwordx4 v3, s[8:11], s23 offen offset:1024 lds
M v[44:47], a[60:63], a[164:167], 0
M v[44:47], a[56:59], a[160:163], v[44:47]
ds_read_b64_tr_b16 a[104:105], v13 offset:32768
ds_read_b64_tr_b16 a[106:107], v13 offset:34816
M v[48:51], a[64:67], a[160:163], 0
M v[48:51], a[68:71], a[164:167], v[48:51]
buffer_load_dwordx4 v4, s[8:11], s23 offen offset:2048 lds
M v[52:55], a[76:79], a[164:167], 0
M v[52:55], a[72:75], a[160:163], v[52:55]
ds_read_b64_tr_b16 a[112:113], v14 offset:32768
ds_read_b64_tr_b16 a[114:115], v14 offset:34816
M v[56:59], a[80:83], a[160:163], 0
M v[56:59], a[84:87], a[164:167], v[56:59]
buffer_load_dwordx4 v5, s[8:11], s23 offen offset:3072 lds
M v[60:63], a[92:95], a[164:167], 0
M v[60:63], a[88:91], a[160:163], v[60:63]
ds_read_b64_tr_b16 a[120:121], v15 offset:32768
ds_read_b64_tr_b16 a[122:123], v15 offset:34816
M v[64:67], a[32:35], a[168:171], 0
M v[64:67], a[36:39], a[172:175], v[64:67]
ds_read_b128 a[184:187], v10 offset:6144
ds_read_b128 a[188:191], v11 offset:6144
M v[68:71], a[44:47], a[172:175], 0
s_add_u32 m0, s29, 65536
s_nop 0
buffer_load_dwordx4 v6, s[12:15], s24 offen offset:0 lds
M v[68:71], a[40:43], a[168:171], v[68:71]
ds_read_b64_tr_b16 a[128:129], v16 offset:32768
ds_read_b64_tr_b16 a[130:131], v16 offset:34816
M v[72:75], a[48:51], a[168:171], 0
M v[72:75], a[52:55], a[172:175], v[72:75]
M v[76:79], a[60:63], a[172:175], 0
buffer_load_dwordx4 v7, s[12:15], s24 offen offset:1024 lds
M v[76:79], a[56:59], a[168:171], v[76:79]
ds_read_b64_tr_b16 a[136:137], v17 offset:32768
ds_read_b64_tr_b16 a[138:139], v17 offset:34816
M v[80:83], a[64:67], a[168:171], 0
M v[80:83], a[68:71], a[172:175], v[80:83]
M v[84:87], a[76:79], a[172:175], 0
buffer_load_dwordx4 v8, s[12:15], s24 offen offset:2048 lds
M v[84:87], a[72:75], a[168:171], v[84:87]
ds_read_b64_tr_b16 a[144:145], v18 offset:32768
ds_read_b64_tr_b16 a[146:147], v18 offset:34816
M v[88:91], a[80:83], a[168:171], 0
M v[88:91], a[84:87], a[172:175], v[88:91]
M v[92:95], a[92:95], a[172:175], 0
buffer_load_dwordx4 v9, s[12:15], s24 offen offset:3072 lds
M v[92:95], a[88:91], a[168:171], v[92:95]
s_waitcnt lgkmcnt(15)
ds_read_b64_tr_b16 a[152:153], v19 offset:32768
ds_read_b64_tr_b16 a[154:155], v19 offset:34816
M v[96:99], a[32:35], a[176:179], 0
M v[96:99], a[36:39], a[180:183], v[96:99]
M v[100:103], a[44:47], a[180:183], 0
s_add_u32 s24, s24, 262144
M v[100:103], a[40:43], a[176:179], v[100:103]
M v[104:107], a[48:51], a[176:179], 0
M v[104:107], a[52:55], a[180:183], v[104:107]
M v[108:111], a[60:63], a[180:183], 0
M v[108:111], a[56:59], a[176:179], v[108:111]
s_waitcnt vmcnt(9) lgkmcnt(0)
s_barrier
ds_read_b128 a[160:163], v10 offset:16384
ds_read_b128 a[164:167], v11 offset:16384
M v[112:115], a[64:67], a[176:179], 0
s_add_u32 m0, s29, 49152
s_add_u32 s3, s23, s31
buffer_load_dwordx4 v2, s[8:11], s3 offen offset:0 lds
M v[112:115], a[68:71], a[180:183], v[112:115]
M v[116:119], a[76:79], a[180:183], 0
M v[116:119], a[72:75], a[176:179], v[116:119]
ds_read_b64_tr_b16 a[100:101], v12 offset:49152
ds_read_b64_tr_b16 a[102:103], v12 offset:51200
M v[120:123], a[80:83], a[176:179], 0
M v[120:123], a[84:87], a[180:183], v[120:123]
buffer_load_dwordx4 v3, s[8:11], s3 offen offset:1024 lds
M v[124:127], a[92:95], a[180:183], 0
M v[124:127], a[88:91], a[176:179], v[124:127]
M v[128:131], a[32:35], a[184:187], 0
M v[128:131], a[36:39], a[188:191], v[128:131]
ds_read_b128 a[168:171], v10 offset:18432
ds_read_b128 a[172:175], v11 offset:18432
ds_read_b64_tr_b16 a[108:109], v13 offset:49152
ds_read_b64_tr_b16 a[110:111], v13 offset:51200
M v[132:135], a[44:47], a[188:191], 0
M v[132:135], a[40:43], a[184:187], v[132:135]
M v[136:139], a[48:51], a[184:187], 0
buffer_load_dwordx4 v4, s[8:11], s3 offen offset:2048 lds
M v[136:139], a[52:55], a[188:191], v[136:139]
M v[140:143], a[60:63], a[188:191], 0
M v[140:143], a[56:59], a[184:187], v[140:143]
ds_read_b64_tr_b16 a[116:117], v14 offset:49152
ds_read_b64_tr_b16 a[118:119], v14 offset:51200
M v[144:147], a[64:67], a[184:187], 0
M v[144:147], a[68:71], a[188:191], v[144:147]
M v[148:151], a[76:79], a[188:191], 0
buffer_load_dwordx4 v5, s[8:11], s3 offen offset:3072 lds
M v[148:151], a[72:75], a[184:187], v[148:151]
M v[152:155], a[80:83], a[184:187], 0
M v[152:155], a[84:87], a[188:191], v[152:155]
ds_read_b64_tr_b16 a[124:125], v15 offset:49152
ds_read_b64_tr_b16 a[126:127], v15 offset:51200
M v[156:159], a[92:95], a[188:191], 0
M v[156:159], a[88:91], a[184:187], v[156:159]
s_waitcnt lgkmcnt(10)
M v[160:163], a[32:35], a[160:163], 0
M v[160:163], a[36:39], a[164:167], v[160:163]
ds_read_b128 a[176:179], v10 offset:20480
ds_read_b128 a[180:183], v11 offset:20480
M v[164:167], a[44:47], a[164:167], 0
s_add_u32 s23, s23, 128
s_cmp_eq_u32 s23, s25
s_cselect_b32 s23, s26, s23
M v[164:167], a[40:43], a[160:163], v[164:167]
ds_read_b64_tr_b16 a[132:133], v16 offset:49152
ds_read_b64_tr_b16 a[134:135], v16 offset:51200
M v[168:171], a[48:51], a[160:163], 0
M v[168:171], a[52:55], a[164:167], v[168:171]
M v[172:175], a[60:63], a[164:167], 0
M v[172:175], a[56:59], a[160:163], v[172:175]
M v[176:179], a[64:67], a[160:163], 0
s_add_u32 m0, s29, 81920
s_nop 0
buffer_load_dwordx4 v6, s[12:15], s24 offen offset:0 lds
M v[176:179], a[68:71], a[164:167], v[176:179]
ds_read_b64_tr_b16 a[140:141], v17 offset:49152
ds_read_b64_tr_b16 a[142:143], v17 offset:51200
M v[180:183], a[76:79], a[164:167], 0
M v[180:183], a[72:75], a[160:163], v[180:183]
M v[184:187], a[80:83], a[160:163], 0
M v[184:187], a[84:87], a[164:167], v[184:187]
buffer_load_dwordx4 v7, s[12:15], s24 offen offset:1024 lds
M v[188:191], a[92:95], a[164:167], 0
M v[188:191], a[88:91], a[160:163], v[188:191]
s_waitcnt lgkmcnt(12)
ds_read_b64_tr_b16 a[148:149], v18 offset:49152
ds_read_b64_tr_b16 a[150:151], v18 offset:51200
M v[192:195], a[32:35], a[168:171], 0
M v[192:195], a[36:39], a[172:175], v[192:195]
ds_read_b128 a[184:187], v10 offset:22528
ds_read_b128 a[188:191], v11 offset:22528
M v[196:199], a[44:47], a[172:175], 0
M v[196:199], a[40:43], a[168:171], v[196:199]
M v[200:203], a[48:51], a[168:171], 0
buffer_load_dwordx4 v8, s[12:15], s24 offen offset:2048 lds
M v[200:203], a[52:55], a[172:175], v[200:203]
ds_read_b64_tr_b16 a[156:157], v19 offset:49152
ds_read_b64_tr_b16 a[158:159], v19 offset:51200
M v[204:207], a[60:63], a[172:175], 0
M v[204:207], a[56:59], a[168:171], v[204:207]
M v[208:211], a[64:67], a[168:171], 0
M v[208:211], a[68:71], a[172:175], v[208:211]
M v[212:215], a[76:79], a[172:175], 0
buffer_load_dwordx4 v9, s[12:15], s24 offen offset:3072 lds
M v[212:215], a[72:75], a[168:171], v[212:215]
M v[216:219], a[80:83], a[168:171], 0
M v[216:219], a[84:87], a[172:175], v[216:219]
M v[220:223], a[92:95], a[172:175], 0
M v[220:223], a[88:91], a[168:171], v[220:223]
s_waitcnt lgkmcnt(10)
M v[224:227], a[32:35], a[176:179], 0
s_add_u32 s24, s24, 262144
s_cmp_eq_u32 s24, s27
s_cselect_b32 s24, s28, s24
s_sub_u32 s6, s6, 1
s_cmp_eq_u32 s6, 0
s_cselect_b64 s[12:13], s[64:65], s[12:13]
M v[224:227], a[36:39], a[180:183], v[224:227]
M v[228:231], a[44:47], a[180:183], 0
M v[228:231], a[40:43], a[176:179], v[228:231]
M v[232:235], a[48:51], a[176:179], 0
M v[232:235], a[52:55], a[180:183], v[232:235]
M v[236:239], a[60:63], a[180:183], 0
M v[236:239], a[56:59], a[176:179], v[236:239]
s_waitcnt vmcnt(8) lgkmcnt(0)
s_barrier
ds_read_b128 a[160:163], v10 offset:32768
ds_read_b128 a[164:167], v11 offset:32768
M v[240:243], a[64:67], a[176:179], 0
s_add_u32 m0, s29, 0
s_nop 0
buffer_load_dwordx4 v2, s[8:11], s23 offen offset:0 lds
M v[240:243], a[68:71], a[180:183], v[240:243]
M v[244:247], a[76:79], a[180:183], 0
M v[244:247], a[72:75], a[176:179], v[244:247]
M v[248:251], a[80:83], a[176:179], 0
M v[248:251], a[84:87], a[180:183], v[248:251]
buffer_load_dwordx4 v3, s[8:11], s23 offen offset:1024 lds
M v[252:255], a[92:95], a[180:183], 0
M v[252:255], a[88:91], a[176:179], v[252:255]
M a[0:3], a[32:35], a[184:187], 0
M a[0:3], a[36:39], a[188:191], a[0:3]
ds_read_b128 a[168:171], v10 offset:34816
ds_read_b128 a[172:175], v11 offset:34816
M a[4:7], a[44:47], a[188:191], 0
M a[4:7], a[40:43], a[184:187], a[4:7]
M a[8:11], a[48:51], a[184:187], 0
buffer_load_dwordx4 v4, s[8:11], s23 offen offset:2048 lds
M a[8:11], a[52:55], a[188:191], a[8:11]
M a[12:15], a[60:63], a[188:191], 0
M a[12:15], a[56:59], a[184:187], a[12:15]
M a[16:19], a[64:67], a[184:187], 0
M a[16:19], a[68:71], a[188:191], a[16:19]
buffer_load_dwordx4 v5, s[8:11], s23 offen offset:3072 lds
M a[20:23], a[76:79], a[188:191], 0
M a[20:23], a[72:75], a[184:187], a[20:23]
M a[24:27], a[80:83], a[184:187], 0
M a[24:27], a[84:87], a[188:191], a[24:27]
M a[28:31], a[92:95], a[188:191], 0
M a[28:31], a[88:91], a[184:187], a[28:31]
s_waitcnt lgkmcnt(2)
M v[32:35], a[96:99], a[160:163], v[32:35]
s_add_u32 m0, s29, 98304
s_nop 0
buffer_load_dwordx4 v6, s[12:15], s24 offen offset:0 lds
M v[32:35], a[100:103], a[164:167], v[32:35]
ds_read_b128 a[176:179], v10 offset:36864
ds_read_b128 a[180:183], v11 offset:36864
M v[36:39], a[108:111], a[164:167], v[36:39]
M v[36:39], a[104:107], a[160:163], v[36:39]
ds_read_b64_tr_b16 a[32:33], v12 offset:0
ds_read_b64_tr_b16 a[34:35], v12 offset:2048
M v[40:43], a[112:115], a[160:163], v[40:43]
M v[40:43], a[116:119], a[164:167], v[40:43]
M v[44:47], a[124:127], a[164:167], v[44:47]
M v[44:47], a[120:123], a[160:163], v[44:47]
ds_read_b64_tr_b16 a[40:41], v13 offset:0
ds_read_b64_tr_b16 a[42:43], v13 offset:2048
M v[48:51], a[128:131], a[160:163], v[48:51]
buffer_load_dwordx4 v7, s[12:15], s24 offen offset:1024 lds
M v[48:51], a[132:135], a[164:167], v[48:51]
M v[52:55], a[140:143], a[164:167], v[52:55]
M v[52:55], a[136:139], a[160:163], v[52:55]
ds_read_b64_tr_b16 a[48:49], v14 offset:0
ds_read_b64_tr_b16 a[50:51], v14 offset:2048
M v[56:59], a[144:147], a[160:163], v[56:59]
M v[56:59], a[148:151], a[164:167], v[56:59]
M v[60:63], a[156:159], a[164:167], v[60:63]
buffer_load_dwordx4 v8, s[12:15], s24 offen offset:2048 lds
M v[60:63], a[152:155], a[160:163], v[60:63]
s_waitcnt lgkmcnt(8)
ds_read_b64_tr_b16 a[56:57], v15 offset:0
ds_read_b64_tr_b16 a[58:59], v15 offset:2048
M v[64:67], a[96:99], a[168:171], v[64:67]
M v[64:67], a[100:103], a[172:175], v[64:67]
ds_read_b128 a[184:187], v10 offset:38912
ds_read_b128 a[188:191], v11 offset:38912
M v[68:71], a[108:111], a[172:175], v[68:71]
M v[68:71], a[104:107], a[168:171], v[68:71]
ds_read_b64_tr_b16 a[64:65], v16 offset:0
ds_read_b64_tr_b16 a[66:67], v16 offset:2048
M v[72:75], a[112:115], a[168:171], v[72:75]
M v[72:75], a[116:119], a[172:175], v[72:75]
M v[76:79], a[124:127], a[172:175], v[76:79]
M v[76:79], a[120:123], a[168:171], v[76:79]
ds_read_b64_tr_b16 a[72:73], v17 offset:0
ds_read_b64_tr_b16 a[74:75], v17 offset:2048
M v[80:83], a[128:131], a[168:171], v[80:83]
buffer_load_dwordx4 v9, s[12:15], s24 offen offset:3072 lds
M v[80:83], a[132:135], a[172:175], v[80:83]
M v[84:87], a[140:143], a[172:175], v[84:87]
M v[84:87], a[136:139], a[168:171], v[84:87]
ds_read_b64_tr_b16 a[80:81], v18 offset:0
ds_read_b64_tr_b16 a[82:83], v18 offset:2048
M v[88:91], a[144:147], a[168:171], v[88:91]
M v[88:91], a[148:151], a[172:175], v[88:91]
M v[92:95], a[156:159], a[172:175], v[92:95]
s_add_u32 s24, s24, 262144
M v[92:95], a[152:155], a[168:171], v[92:95]
s_waitcnt lgkmcnt(15)
ds_read_b64_tr_b16 a[88:89], v19 offset:0
ds_read_b64_tr_b16 a[90:91], v19 offset:2048
M v[96:99], a[96:99], a[176:179], v[96:99]
M v[96:99], a[100:103], a[180:183], v[96:99]
M v[100:103], a[108:111], a[180:183], v[100:103]
M v[100:103], a[104:107], a[176:179], v[100:103]
M v[104:107], a[112:115], a[176:179], v[104:107]
M v[104:107], a[116:119], a[180:183], v[104:107]
M v[108:111], a[124:127], a[180:183], v[108:111]
M v[108:111], a[120:123], a[176:179], v[108:111]
s_waitcnt vmcnt(8) lgkmcnt(0)
s_barrier
ds_read_b128 a[160:163], v10 offset:49152
ds_read_b128 a[164:167], v11 offset:49152
M v[112:115], a[128:131], a[176:179], v[112:115]
s_add_u32 m0, s29, 16384
s_add_u32 s3, s23, s31
buffer_load_dwordx4 v2, s[8:11], s3 offen offset:0 lds
M v[112:115], a[132:135], a[180:183], v[112:115]
M v[116:119], a[140:143], a[180:183], v[116:119]
M v[116:119], a[136:139], a[176:179], v[116:119]
ds_read_b64_tr_b16 a[36:37], v12 offset:16384
ds_read_b64_tr_b16 a[38:39], v12 offset:18432
M v[120:123], a[144:147], a[176:179], v[120:123]
M v[120:123], a[148:151], a[180:183], v[120:123]
buffer_load_dwordx4 v3, s[8:11], s3 offen offset:1024 lds
M v[124:127], a[156:159], a[180:183], v[124:127]
M v[124:127], a[152:155], a[176:179], v[124:127]
M v[128:131], a[96:99], a[184:187], v[128:131]
M v[128:131], a[100:103], a[188:191], v[128:131]
ds_read_b128 a[168:171], v10 offset:51200
ds_read_b128 a[172:175], v11 offset:51200
ds_read_b64_tr_b16 a[44:45], v13 offset:16384
ds_read_b64_tr_b16 a[46:47], v13 offset:18432
M v[132:135], a[108:111], a[188:191], v[132:135]
M v[132:135], a[104:107], a[184:187], v[132:135]
M v[136:139], a[112:115], a[184:187], v[136:139]
buffer_load_dwordx4 v4, s[8:11], s3 offen offset:2048 lds
M v[136:139], a[116:119], a[188:191], v[136:139]
M v[140:143], a[124:127], a[188:191], v[140:143]
M v[140:143], a[120:123], a[184:187], v[140:143]
ds_read_b64_tr_b16 a[52:53], v14 offset:16384
ds_read_b64_tr_b16 a[54:55], v14 offset:18432
M v[144:147], a[128:131], a[184:187], v[144:147]
M v[144:147], a[132:135], a[188:191], v[144:147]
M v[148:151], a[140:143], a[188:191], v[148:151]
buffer_load_dwordx4 v5, s[8:11], s3 offen offset:3072 lds
M v[148:151], a[136:139], a[184:187], v[148:151]
M v[152:155], a[144:147], a[184:187], v[152:155]
M v[152:155], a[148:151], a[188:191], v[152:155]
ds_read_b64_tr_b16 a[60:61], v15 offset:16384
ds_read_b64_tr_b16 a[62:63], v15 offset:18432
M v[156:159], a[156:159], a[188:191], v[156:159]
M v[156:159], a[152:155], a[184:187], v[156:159]
s_waitcnt lgkmcnt(10)
M v[160:163], a[96:99], a[160:163], v[160:163]
M v[160:163], a[100:103], a[164:167], v[160:163]
ds_read_b128 a[176:179], v10 offset:53248
ds_read_b128 a[180:183], v11 offset:53248
M v[164:167], a[108:111], a[164:167], v[164:167]
s_add_u32 s23, s23, 128
s_cmp_eq_u32 s23, s25
s_cselect_b32 s23, s26, s23
M v[164:167], a[104:107], a[160:163], v[164:167]
ds_read_b64_tr_b16 a[68:69], v16 offset:16384
ds_read_b64_tr_b16 a[70:71], v16 offset:18432
M v[168:171], a[112:115], a[160:163], v[168:171]
M v[168:171], a[116:119], a[164:167], v[168:171]
M v[172:175], a[124:127], a[164:167], v[172:175]
M v[172:175], a[120:123], a[160:163], v[172:175]
M v[176:179], a[128:131], a[160:163], v[176:179]
s_add_u32 m0, s29, 114688
s_nop 0
buffer_load_dwordx4 v6, s[12:15], s24 offen offset:0 lds
M v[176:179], a[132:135], a[164:167], v[176:179]
ds_read_b64_tr_b16 a[76:77], v17 offset:16384
ds_read_b64_tr_b16 a[78:79], v17 offset:18432
M v[180:183], a[140:143], a[164:167], v[180:183]
M v[180:183], a[136:139], a[160:163], v[180:183]
M v[184:187], a[144:147], a[160:163], v[184:187]
M v[184:187], a[148:151], a[164:167], v[184:187]
buffer_load_dwordx4 v7, s[12:15], s24 offen offset:1024 lds
M v[188:191], a[156:159], a[164:167], v[188:191]
M v[188:191], a[152:155], a[160:163], v[188:191]
s_waitcnt lgkmcnt(12)
ds_read_b64_tr_b16 a[84:85], v18 offset:16384
ds_read_b64_tr_b16 a[86:87], v18 offset:18432
M v[192:195], a[96:99], a[168:171], v[192:195]
M v[192:195], a[100:103], a[172:175], v[192:195]
ds_read_b128 a[184:187], v10 offset:55296
ds_read_b128 a[188:191], v11 offset:55296
M v[196:199], a[108:111], a[172:175], v[196:199]
M v[196:199], a[104:107], a[168:171], v[196:199]
M v[200:203], a[112:115], a[168:171], v[200:203]
buffer_load_dwordx4 v8, s[12:15], s24 offen offset:2048 lds
M v[200:203], a[116:119], a[172:175], v[200:203]
ds_read_b64_tr_b16 a[92:93], v19 offset:16384
ds_read_b64_tr_b16 a[94:95], v19 offset:18432
M v[204:207], a[124:127], a[172:175], v[204:207]
M v[204:207], a[120:123], a[168:171], v[204:207]
M v[208:211], a[128:131], a[168:171], v[208:211]
M v[208:211], a[132:135], a[172:175], v[208:211]
M v[212:215], a[140:143], a[172:175], v[212:215]
buffer_load_dwordx4 v9, s[12:15], s24 offen offset:3072 lds
M v[212:215], a[136:139], a[168:171], v[212:215]
M v[216:219], a[144:147], a[168:171], v[216:219]
M v[216:219], a[148:151], a[172:175], v[216:219]
M v[220:223], a[156:159], a[172:175], v[220:223]
M v[220:223], a[152:155], a[168:171], v[220:223]
s_waitcnt lgkmcnt(10)
M v[224:227], a[96:99], a[176:179], v[224:227]
s_add_u32 s24, s24, 262144
s_cmp_eq_u32 s24, s27
s_cselect_b32 s24, s28, s24
s_sub_u32 s6, s6, 1
s_cmp_eq_u32 s6, 0
s_cselect_b64 s[12:13], s[64:65], s[12:13]
M v[224:227], a[100:103], a[180:183], v[224:227]
M v[228:231], a[108:111], a[180:183], v[228:231]
M v[228:231], a[104:107], a[176:179], v[228:231]
M v[232:235], a[112:115], a[176:179], v[232:235]
M v[232:235], a[116:119], a[180:183], v[232:235]
M v[236:239], a[124:127], a[180:183], v[236:239]
M v[236:239], a[120:123], a[176:179], v[236:239]
s_waitcnt vmcnt(8) lgkmcnt(0)
s_barrier
ds_read_b128 a[160:163], v10 offset:0
ds_read_b128 a[164:167], v11 offset:0
M v[240:243], a[128:131], a[176:179], v[240:243]
s_add_u32 m0, s29, 32768
s_nop 0
buffer_load_dwordx4 v2, s[8:11], s23 offen offset:0 lds
M v[240:243], a[132:135], a[180:183], v[240:243]
M v[244:247], a[140:143], a[180:183], v[244:247]
M v[244:247], a[136:139], a[176:179], v[244:247]
M v[248:251], a[144:147], a[176:179], v[248:251]
M v[248:251], a[148:151], a[180:183], v[248:251]
buffer_load_dwordx4 v3, s[8:11], s23 offen offset:1024 lds
M v[252:255], a[156:159], a[180:183], v[252:255]
M v[252:255], a[152:155], a[176:179], v[252:255]
M a[0:3], a[96:99], a[184:187], a[0:3]
M a[0:3], a[100:103], a[188:191], a[0:3]
ds_read_b128 a[168:171], v10 offset:2048
ds_read_b128 a[172:175], v11 offset:2048
M a[4:7], a[108:111], a[188:191], a[4:7]
M a[4:7], a[104:107], a[184:187], a[4:7]
M a[8:11], a[112:115], a[184:187], a[8:11]
buffer_load_dwordx4 v4, s[8:11], s23 offen offset:2048 lds
M a[8:11], a[116:119], a[188:191], a[8:11]
M a[12:15], a[124:127], a[188:191], a[12:15]
M a[12:15], a[120:123], a[184:187], a[12:15]
M a[16:19], a[128:131], a[184:187], a[16:19]
M a[16:19], a[132:135], a[188:191], a[16:19]
buffer_load_dwordx4 v5, s[8:11], s23 offen offset:3072 lds
M a[20:23], a[140:143], a[188:191], a[20:23]
M a[20:23], a[136:139], a[184:187], a[20:23]
M a[24:27], a[144:147], a[184:187], a[24:27]
M a[24:27], a[148:151], a[188:191], a[24:27]
M a[28:31], a[156:159], a[188:191], a[28:31]
M a[28:31], a[152:155], a[184:187], a[28:31]
s_waitcnt lgkmcnt(2)
s_mov_b32 s30, 2
Lk1_kl:
M v[32:35], a[32:35], a[160:163], v[32:35]
s_add_u32 m0, s29, 65536
s_nop 0
buffer_load_dwordx4 v6, s[12:15], s24 offen offset:0 lds
M v[32:35], a[36:39], a[164:167], v[32:35]
ds_read_b128 a[176:179], v10 offset:4096
ds_read_b128 a[180:183], v11 offset:4096
M v[36:39], a[44:47], a[164:167], v[36:39]
M v[36:39], a[40:43], a[160:163], v[36:39]
ds_read_b64_tr_b16 a[96:97], v12 offset:32768
ds_read_b64_tr_b16 a[98:99], v12 offset:34816
M v[40:43], a[48:51], a[160:163], v[40:43]
M v[40:43], a[52:55], a[164:167], v[40:43]
M v[44:47], a[60:63], a[164:167], v[44:47]
M v[44:47], a[56:59], a[160:163], v[44:47]
ds_read_b64_tr_b16 a[104:105], v13 offset:32768
ds_read_b64_tr_b16 a[106:107], v13 offset:34816
M v[48:51], a[64:67], a[160:163], v[48:51]
buffer_load_dwordx4 v7, s[12:15], s24 offen offset:1024 lds
M v[48:51], a[68:71], a[164:167], v[48:51]
M v[52:55], a[76:79], a[164:167], v[52:55]
M v[52:55], a[72:75], a[160:163], v[52:55]
ds_read_b64_tr_b16 a[112:113], v14 offset:32768
ds_read_b64_tr_b16 a[114:115], v14 offset:34816
M v[56:59], a[80:83], a[160:163], v[56:59]
M v[56:59], a[84:87], a[164:167], v[56:59]
M v[60:63], a[92:95], a[164:167], v[60:63]
buffer_load_dwordx4 v8, s[12:15], s24 offen offset:2048 lds
M v[60:63], a[88:91], a[160:163], v[60:63]
s_waitcnt lgkmcnt(8)
ds_read_b64_tr_b16 a[120:121], v15 offset:32768
ds_read_b64_tr_b16 a[122:123], v15 offset:34816
M v[64:67], a[32:35], a[168:171], v[64:67]
M v[64:67], a[36:39], a[172:175], v[64:67]
ds_read_b128 a[184:187], v10 offset:6144
ds_read_b128 a[188:191], v11 offset:6144
M v[68:71], a[44:47], a[172:175], v[68:71]
M v[68:71], a[40:43], a[168:171], v[68:71]
ds_read_b64_tr_b16 a[128:129], v16 offset:32768
ds_read_b64_tr_b16 a[130:131], v16 offset:34816
M v[72:75], a[48:51], a[168:171], v[72:75]
M v[72:75], a[52:55], a[172:175], v[72:75]
M v[76:79], a[60:63], a[172:175], v[76:79]
M v[76:79], a[56:59], a[168:171], v[76:79]
ds_read_b64_tr_b16 a[136:137], v17 offset:32768
ds_read_b64_tr_b16 a[138:139], v17 offset:34816
M v[80:83], a[64:67], a[168:171], v[80:83]
buffer_load_dwordx4 v9, s[12:15], s24 offen offset:3072 lds
M v[80:83], a[68:71], a[172:175], v[80:83]
M v[84:87], a[76:79], a[172:175], v[84:87]
M v[84:87], a[72:75], a[168:171], v[84:87]
ds_read_b64_tr_b16 a[144:145], v18 offset:32768
ds_read_b64_tr_b16 a[146:147], v18 offset:34816
M v[88:91], a[80:83], a[168:171], v[88:91]
M v[88:91], a[84:87], a[172:175], v[88:91]
M v[92:95], a[92:95], a[172:175], v[92:95]
s_add_u32 s24, s24, 262144
M v[92:95], a[88:91], a[168:171], v[92:95]
s_waitcnt lgkmcnt(15)
ds_read_b64_tr_b16 a[152:153], v19 offset:32768
ds_read_b64_tr_b16 a[154:155], v19 offset:34816
M v[96:99], a[32:35], a[176:179], v[96:99]
M v[96:99], a[36:39], a[180:183], v[96:99]
M v[100:103], a[44:47], a[180:183], v[100:103]
M v[100:103], a[40:43], a[176:179], v[100:103]
M v[104:107], a[48:51], a[176:179], v[104:107]
M v[104:107], a[52:55], a[180:183], v[104:107]
M v[108:111], a[60:63], a[180:183], v[108:111]
M v[108:111], a[56:59], a[176:179], v[108:111]
s_waitcnt vmcnt(8) lgkmcnt(0)
s_barrier
ds_read_b128 a[160:163], v10 offset:16384
ds_read_b128 a[164:167], v11 offset:16384
M v[112:115], a[64:67], a[176:179], v[112:115]
s_add_u32 m0, s29, 49152
s_add_u32 s3, s23, s31
buffer_load_dwordx4 v2, s[8:11], s3 offen offset:0 lds
M v[112:115], a[68:71], a[180:183], v[112:115]
M v[116:119], a[76:79], a[180:183], v[116:119]
M v[116:119], a[72:75], a[176:179], v[116:119]
ds_read_b64_tr_b16 a[100:101], v12 offset:49152
ds_read_b64_tr_b16 a[102:103], v12 offset:51200
M v[120:123], a[80:83], a[176:179], v[120:123]
M v[120:123], a[84:87], a[180:183], v[120:123]
buffer_load_dwordx4 v3, s[8:11], s3 offen offset:1024 lds
M v[124:127], a[92:95], a[180:183], v[124:127]
M v[124:127], a[88:91], a[176:179], v[124:127]
M v[128:131], a[32:35], a[184:187], v[128:131]
M v[128:131], a[36:39], a[188:191], v[128:131]
ds_read_b128 a[168:171], v10 offset:18432
ds_read_b128 a[172:175], v11 offset:18432
ds_read_b64_tr_b16 a[108:109], v13 offset:49152
ds_read_b64_tr_b16 a[110:111], v13 offset:51200
M v[132:135], a[44:47], a[188:191], v[132:135]
M v[132:135], a[40:43], a[184:187], v[132:135]
M v[136:139], a[48:51], a[184:187], v[136:139]
buffer_load_dwordx4 v4, s[8:11], s3 offen offset:2048 lds
M v[136:139], a[52:55], a[188:191], v[136:139]
M v[140:143], a[60:63], a[188:191], v[140:143]
M v[140:143], a[56:59], a[184:187], v[140:143]
ds_read_b64_tr_b16 a[116:117], v14 offset:49152
ds_read_b64_tr_b16 a[118:119], v14 offset:51200
M v[144:147], a[64:67], a[184:187], v[144:147]
M v[144:147], a[68:71], a[188:191], v[144:147]
M v[148:151], a[76:79], a[188:191], v[148:151]
buffer_load_dwordx4 v5, s[8:11], s3 offen offset:3072 lds
M v[148:151], a[72:75], a[184:187], v[148:151]
M v[152:155], a[80:83], a[184:187], v[152:155]
M v[152:155], a[84:87], a[188:191], v[152:155]
ds_read_b64_tr_b16 a[124:125], v15 offset:49152
ds_read_b64_tr_b16 a[126:127], v15 offset:51200
M v[156:159], a[92:95], a[188:191], v[156:159]
M v[156:159], a[88:91], a[184:187], v[156:159]
s_waitcnt lgkmcnt(10)
M v[160:163], a[32:35], a[160:163], v[160:163]
M v[160:163], a[36:39], a[164:167], v[160:163]
ds_read_b128 a[176:179], v10 offset:20480
ds_read_b128 a[180:183], v11 offset:20480
M v[164:167], a[44:47], a[164:167], v[164:167]
s_add_u32 s23, s23, 128
s_cmp_eq_u32 s23, s25
s_cselect_b32 s23, s26, s23
M v[164:167], a[40:43], a[160:163], v[164:167]
ds_read_b64_tr_b16 a[132:133], v16 offset:49152
ds_read_b64_tr_b16 a[134:135], v16 offset:51200
M v[168:171], a[48:51], a[160:163], v[168:171]
M v[168:171], a[52:55], a[164:167], v[168:171]
M v[172:175], a[60:63], a[164:167], v[172:175]
M v[172:175], a[56:59], a[160:163], v[172:175]
M v[176:179], a[64:67], a[160:163], v[176:179]
s_add_u32 m0, s29, 81920
s_nop 0
buffer_load_dwordx4 v6, s[12:15], s24 offen offset:0 lds
M v[176:179], a[68:71], a[164:167], v[176:179]
ds_read_b64_tr_b16 a[140:141], v17 offset:49152
ds_read_b64_tr_b16 a[142:143], v17 offset:51200
M v[180:183], a[76:79], a[164:167], v[180:183]
M v[180:183], a[72:75], a[160:163], v[180:183]
M v[184:187], a[80:83], a[160:163], v[184:187]
M v[184:187], a[84:87], a[164:167], v[184:187]
buffer_load_dwordx4 v7, s[12:15], s24 offen offset:1024 lds
M v[188:191], a[92:95], a[164:167], v[188:191]
M v[188:191], a[88:91], a[160:163], v[188:191]
s_waitcnt lgkmcnt(12)
ds_read_b64_tr_b16 a[148:149], v18 offset:49152
ds_read_b64_tr_b16 a[150:151], v18 offset:51200
M v[192:195], a[32:35], a[168:171], v[192:195]
M v[192:195], a[36:39], a[172:175], v[192:195]
ds_read_b128 a[184:187], v10 offset:22528
ds_read_b128 a[188:191], v11 offset:22528
M v[196:199], a[44:47], a[172:175], v[196:199]
M v[196:199], a[40:43], a[168:171], v[196:199]
M v[200:203], a[48:51], a[168:171], v[200:203]
buffer_load_dwordx4 v8, s[12:15], s24 offen offset:2048 lds
M v[200:203], a[52:55], a[172:175], v[200:203]
ds_read_b64_tr_b16 a[156:157], v19 offset:49152
ds_read_b64_tr_b16 a[158:159], v19 offset:51200
M v[204:207], a[60:63], a[172:175], v[204:207]
M v[204:207], a[56:59], a[168:171], v[204:207]
M v[208:211], a[64:67], a[168:171], v[208:211]
M v[208:211], a[68:71], a[172:175], v[208:211]
M v[212:215], a[76:79], a[172:175], v[212:215]
buffer_load_dwordx4 v9, s[12:15], s24 offen offset:3072 lds
M v[212:215], a[72:75], a[168:171], v[212:215]
M v[216:219], a[80:83], a[168:171], v[216:219]
M v[216:219], a[84:87], a[172:175], v[216:219]
M v[220:223], a[92:95], a[172:175], v[220:223]
M v[220:223], a[88:91], a[168:171], v[220:223]
s_waitcnt lgkmcnt(10)
M v[224:227], a[32:35], a[176:179], v[224:227]
s_add_u32 s24, s24, 262144
s_cmp_eq_u32 s24, s27
s_cselect_b32 s24, s28, s24
s_sub_u32 s6, s6, 1
s_cmp_eq_u32 s6, 0
s_cselect_b64 s[12:13], s[64:65], s[12:13]
M v[224:227], a[36:39], a[180:183], v[224:227]
M v[228:231], a[44:47], a[180:183], v[228:231]
M v[228:231], a[40:43], a[176:179], v[228:231]
M v[232:235], a[48:51], a[176:179], v[232:235]
M v[232:235], a[52:55], a[180:183], v[232:235]
M v[236:239], a[60:63], a[180:183], v[236:239]
M v[236:239], a[56:59], a[176:179], v[236:239]
s_waitcnt vmcnt(8) lgkmcnt(0)
s_barrier
ds_read_b128 a[160:163], v10 offset:32768
ds_read_b128 a[164:167], v11 offset:32768
M v[240:243], a[64:67], a[176:179], v[240:243]
s_add_u32 m0, s29, 0
s_nop 0
buffer_load_dwordx4 v2, s[8:11], s23 offen offset:0 lds
M v[240:243], a[68:71], a[180:183], v[240:243]
M v[244:247], a[76:79], a[180:183], v[244:247]
M v[244:247], a[72:75], a[176:179], v[244:247]
M v[248:251], a[80:83], a[176:179], v[248:251]
M v[248:251], a[84:87], a[180:183], v[248:251]
buffer_load_dwordx4 v3, s[8:11], s23 offen offset:1024 lds
M v[252:255], a[92:95], a[180:183], v[252:255]
M v[252:255], a[88:91], a[176:179], v[252:255]
M a[0:3], a[32:35], a[184:187], a[0:3]
M a[0:3], a[36:39], a[188:191], a[0:3]
ds_read_b128 a[168:171], v10 offset:34816
ds_read_b128 a[172:175], v11 offset:34816
M a[4:7], a[44:47], a[188:191], a[4:7]
M a[4:7], a[40:43], a[184:187], a[4:7]
M a[8:11], a[48:51], a[184:187], a[8:11]
buffer_load_dwordx4 v4, s[8:11], s23 offen offset:2048 lds
M a[8:11], a[52:55], a[188:191], a[8:11]
M a[12:15], a[60:63], a[188:191], a[12:15]
M a[12:15], a[56:59], a[184:187], a[12:15]
M a[16:19], a[64:67], a[184:187], a[16:19]
M a[16:19], a[68:71], a[188:191], a[16:19]
buffer_load_dwordx4 v5, s[8:11], s23 offen offset:3072 lds
M a[20:23], a[76:79], a[188:191], a[20:23]
M a[20:23], a[72:75], a[184:187], a[20:23]
M a[24:27], a[80:83], a[184:187], a[24:27]
M a[24:27], a[84:87], a[188:191], a[24:27]
M a[28:31], a[92:95], a[188:191], a[28:31]
M a[28:31], a[88:91], a[184:187], a[28:31]
s_waitcnt lgkmcnt(2)
M v[32:35], a[96:99], a[160:163], v[32:35]
s_add_u32 m0, s29, 98304
s_nop 0
buffer_load_dwordx4 v6, s[12:15], s24 offen offset:0 lds
M v[32:35], a[100:103], a[164:167], v[32:35]
ds_read_b128 a[176:179], v10 offset:36864
ds_read_b128 a[180:183], v11 offset:36864
M v[36:39], a[108:111], a[164:167], v[36:39]
M v[36:39], a[104:107], a[160:163], v[36:39]
ds_read_b64_tr_b16 a[32:33], v12 offset:0
ds_read_b64_tr_b16 a[34:35], v12 offset:2048
M v[40:43], a[112:115], a[160:163], v[40:43]
M v[40:43], a[116:119], a[164:167], v[40:43]
M v[44:47], a[124:127], a[164:167], v[44:47]
M v[44:47], a[120:123], a[160:163], v[44:47]
ds_read_b64_tr_b16 a[40:41], v13 offset:0
ds_read_b64_tr_b16 a[42:43], v13 offset:2048
M v[48:51], a[128:131], a[160:163], v[48:51]
buffer_load_dwordx4 v7, s[12:15], s24 offen offset:1024 lds
M v[48:51], a[132:135], a[164:167], v[48:51]
M v[52:55], a[140:143], a[164:167], v[52:55]
M v[52:55], a[136:139], a[160:163], v[52:55]
ds_read_b64_tr_b16 a[48:49], v14 offset:0
ds_read_b64_tr_b16 a[50:51], v14 offset:2048
M v[56:59], a[144:147], a[160:163], v[56:59]
M v[56:59], a[148:151], a[164:167], v[56:59]
M v[60:63], a[156:159], a[164:167], v[60:63]
buffer_load_dwordx4 v8, s[12:15], s24 offen offset:2048 lds
M v[60:63], a[152:155], a[160:163], v[60:63]
s_waitcnt lgkmcnt(8)
ds_read_b64_tr_b16 a[56:57], v15 offset:0
ds_read_b64_tr_b16 a[58:59], v15 offset:2048
M v[64:67], a[96:99], a[168:171], v[64:67]
M v[64:67], a[100:103], a[172:175], v[64:67]
ds_read_b128 a[184:187], v10 offset:38912
ds_read_b128 a[188:191], v11 offset:38912
M v[68:71], a[108:111], a[172:175], v[68:71]
M v[68:71], a[104:107], a[168:171], v[68:71]
ds_read_b64_tr_b16 a[64:65], v16 offset:0
ds_read_b64_tr_b16 a[66:67], v16 offset:2048
M v[72:75], a[112:115], a[168:171], v[72:75]
M v[72:75], a[116:119], a[172:175], v[72:75]
M v[76:79], a[124:127], a[172:175], v[76:79]
M v[76:79], a[120:123], a[168:171], v[76:79]
ds_read_b64_tr_b16 a[72:73], v17 offset:0
ds_read_b64_tr_b16 a[74:75], v17 offset:2048
M v[80:83], a[128:131], a[168:171], v[80:83]
buffer_load_dwordx4 v9, s[12:15], s24 offen offset:3072 lds
M v[80:83], a[132:135], a[172:175], v[80:83]
M v[84:87], a[140:143], a[172:175], v[84:87]
M v[84:87], a[136:139], a[168:171], v[84:87]
ds_read_b64_tr_b16 a[80:81], v18 offset:0
ds_read_b64_tr_b16 a[82:83], v18 offset:2048
M v[88:91], a[144:147], a[168:171], v[88:91]
M v[88:91], a[148:151], a[172:175], v[88:91]
M v[92:95], a[156:159], a[172:175], v[92:95]
s_add_u32 s24, s24, 262144
M v[92:95], a[152:155], a[168:171], v[92:95]
s_waitcnt lgkmcnt(15)
ds_read_b64_tr_b16 a[88:89], v19 offset:0
ds_read_b64_tr_b16 a[90:91], v19 offset:2048
M v[96:99], a[96:99], a[176:179], v[96:99]
M v[96:99], a[100:103], a[180:183], v[96:99]
M v[100:103], a[108:111], a[180:183], v[100:103]
M v[100:103], a[104:107], a[176:179], v[100:103]
M v[104:107], a[112:115], a[176:179], v[104:107]
M v[104:107], a[116:119], a[180:183], v[104:107]
M v[108:111], a[124:127], a[180:183], v[108:111]
M v[108:111], a[120:123], a[176:179], v[108:111]
s_waitcnt vmcnt(8) lgkmcnt(0)
s_barrier
ds_read_b128 a[160:163], v10 offset:49152
ds_read_b128 a[164:167], v11 offset:49152
M v[112:115], a[128:131], a[176:179], v[112:115]
s_add_u32 m0, s29, 16384
s_add_u32 s3, s23, s31
buffer_load_dwordx4 v2, s[8:11], s3 offen offset:0 lds
M v[112:115], a[132:135], a[180:183], v[112:115]
M v[116:119], a[140:143], a[180:183], v[116:119]
M v[116:119], a[136:139], a[176:179], v[116:119]
ds_read_b64_tr_b16 a[36:37], v12 offset:16384
ds_read_b64_tr_b16 a[38:39], v12 offset:18432
M v[120:123], a[144:147], a[176:179], v[120:123]
M v[120:123], a[148:151], a[180:183], v[120:123]
buffer_load_dwordx4 v3, s[8:11], s3 offen offset:1024 lds
M v[124:127], a[156:159], a[180:183], v[124:127]
M v[124:127], a[152:155], a[176:179], v[124:127]
M v[128:131], a[96:99], a[184:187], v[128:131]
M v[128:131], a[100:103], a[188:191], v[128:131]
ds_read_b128 a[168:171], v10 offset:51200
ds_read_b128 a[172:175], v11 offset:51200
ds_read_b64_tr_b16 a[44:45], v13 offset:16384
ds_read_b64_tr_b16 a[46:47], v13 offset:18432
M v[132:135], a[108:111], a[188:191], v[132:135]
M v[132:135], a[104:107], a[184:187], v[132:135]
M v[136:139], a[112:115], a[184:187], v[136:139]
buffer_load_dwordx4 v4, s[8:11], s3 offen offset:2048 lds
M v[136:139], a[116:119], a[188:191], v[136:139]
M v[140:143], a[124:127], a[188:191], v[140:143]
M v[140:143], a[120:123], a[184:187], v[140:143]
ds_read_b64_tr_b16 a[52:53], v14 offset:16384
ds_read_b64_tr_b16 a[54:55], v14 offset:18432
M v[144:147], a[128:131], a[184:187], v[144:147]
M v[144:147], a[132:135], a[188:191], v[144:147]
M v[148:151], a[140:143], a[188:191], v[148:151]
buffer_load_dwordx4 v5, s[8:11], s3 offen offset:3072 lds
M v[148:151], a[136:139], a[184:187], v[148:151]
M v[152:155], a[144:147], a[184:187], v[152:155]
M v[152:155], a[148:151], a[188:191], v[152:155]
ds_read_b64_tr_b16 a[60:61], v15 offset:16384
ds_read_b64_tr_b16 a[62:63], v15 offset:18432
M v[156:159], a[156:159], a[188:191], v[156:159]
M v[156:159], a[152:155], a[184:187], v[156:159]
s_waitcnt lgkmcnt(10)
M v[160:163], a[96:99], a[160:163], v[160:163]
M v[160:163], a[100:103], a[164:167], v[160:163]
ds_read_b128 a[176:179], v10 offset:53248
ds_read_b128 a[180:183], v11 offset:53248
M v[164:167], a[108:111], a[164:167], v[164:167]
s_add_u32 s23, s23, 128
s_cmp_eq_u32 s23, s25
s_cselect_b32 s23, s26, s23
M v[164:167], a[104:107], a[160:163], v[164:167]
ds_read_b64_tr_b16 a[68:69], v16 offset:16384
ds_read_b64_tr_b16 a[70:71], v16 offset:18432
M v[168:171], a[112:115], a[160:163], v[168:171]
M v[168:171], a[116:119], a[164:167], v[168:171]
M v[172:175], a[124:127], a[164:167], v[172:175]
M v[172:175], a[120:123], a[160:163], v[172:175]
M v[176:179], a[128:131], a[160:163], v[176:179]
s_add_u32 m0, s29, 114688
s_nop 0
buffer_load_dwordx4 v6, s[12:15], s24 offen offset:0 lds
M v[176:179], a[132:135], a[164:167], v[176:179]
ds_read_b64_tr_b16 a[76:77], v17 offset:16384
ds_read_b64_tr_b16 a[78:79], v17 offset:18432
M v[180:183], a[140:143], a[164:167], v[180:183]
M v[180:183], a[136:139], a[160:163], v[180:183]
M v[184:187], a[144:147], a[160:163], v[184:187]
M v[184:187], a[148:151], a[164:167], v[184:187]
buffer_load_dwordx4 v7, s[12:15], s24 offen offset:1024 lds
M v[188:191], a[156:159], a[164:167], v[188:191]
M v[188:191], a[152:155], a[160:163], v[188:191]
s_waitcnt lgkmcnt(12)
ds_read_b64_tr_b16 a[84:85], v18 offset:16384
ds_read_b64_tr_b16 a[86:87], v18 offset:18432
M v[192:195], a[96:99], a[168:171], v[192:195]
M v[192:195], a[100:103], a[172:175], v[192:195]
ds_read_b128 a[184:187], v10 offset:55296
ds_read_b128 a[188:191], v11 offset:55296
M v[196:199], a[108:111], a[172:175], v[196:199]
M v[196:199], a[104:107], a[168:171], v[196:199]
M v[200:203], a[112:115], a[168:171], v[200:203]
buffer_load_dwordx4 v8, s[12:15], s24 offen offset:2048 lds
M v[200:203], a[116:119], a[172:175], v[200:203]
ds_read_b64_tr_b16 a[92:93], v19 offset:16384
ds_read_b64_tr_b16 a[94:95], v19 offset:18432
M v[204:207], a[124:127], a[172:175], v[204:207]
M v[204:207], a[120:123], a[168:171], v[204:207]
M v[208:211], a[128:131], a[168:171], v[208:211]
M v[208:211], a[132:135], a[172:175], v[208:211]
M v[212:215], a[140:143], a[172:175], v[212:215]
buffer_load_dwordx4 v9, s[12:15], s24 offen offset:3072 lds
M v[212:215], a[136:139], a[168:171], v[212:215]
M v[216:219], a[144:147], a[168:171], v[216:219]
M v[216:219], a[148:151], a[172:175], v[216:219]
M v[220:223], a[156:159], a[172:175], v[220:223]
M v[220:223], a[152:155], a[168:171], v[220:223]
s_waitcnt lgkmcnt(10)
M v[224:227], a[96:99], a[176:179], v[224:227]
s_add_u32 s24, s24, 262144
s_cmp_eq_u32 s24, s27
s_cselect_b32 s24, s28, s24
s_sub_u32 s6, s6, 1
s_cmp_eq_u32 s6, 0
s_cselect_b64 s[12:13], s[64:65], s[12:13]
M v[224:227], a[100:103], a[180:183], v[224:227]
M v[228:231], a[108:111], a[180:183], v[228:231]
M v[228:231], a[104:107], a[176:179], v[228:231]
M v[232:235], a[112:115], a[176:179], v[232:235]
M v[232:235], a[116:119], a[180:183], v[232:235]
M v[236:239], a[124:127], a[180:183], v[236:239]
M v[236:239], a[120:123], a[176:179], v[236:239]
s_waitcnt vmcnt(8) lgkmcnt(0)
s_barrier
ds_read_b128 a[160:163], v10 offset:0
ds_read_b128 a[164:167], v11 offset:0
M v[240:243], a[128:131], a[176:179], v[240:243]
s_add_u32 m0, s29, 32768
s_nop 0
buffer_load_dwordx4 v2, s[8:11], s23 offen offset:0 lds
M v[240:243], a[132:135], a[180:183], v[240:243]
M v[244:247], a[140:143], a[180:183], v[244:247]
M v[244:247], a[136:139], a[176:179], v[244:247]
M v[248:251], a[144:147], a[176:179], v[248:251]
M v[248:251], a[148:151], a[180:183], v[248:251]
buffer_load_dwordx4 v3, s[8:11], s23 offen offset:1024 lds
M v[252:255], a[156:159], a[180:183], v[252:255]
M v[252:255], a[152:155], a[176:179], v[252:255]
M a[0:3], a[96:99], a[184:187], a[0:3]
M a[0:3], a[100:103], a[188:191], a[0:3]
ds_read_b128 a[168:171], v10 offset:2048
ds_read_b128 a[172:175], v11 offset:2048
M a[4:7], a[108:111], a[188:191], a[4:7]
M a[4:7], a[104:107], a[184:187], a[4:7]
M a[8:11], a[112:115], a[184:187], a[8:11]
buffer_load_dwordx4 v4, s[8:11], s23 offen offset:2048 lds
M a[8:11], a[116:119], a[188:191], a[8:11]
M a[12:15], a[124:127], a[188:191], a[12:15]
M a[12:15], a[120:123], a[184:187], a[12:15]
M a[16:19], a[128:131], a[184:187], a[16:19]
M a[16:19], a[132:135], a[188:191], a[16:19]
buffer_load_dwordx4 v5, s[8:11], s23 offen offset:3072 lds
M a[20:23], a[140:143], a[188:191], a[20:23]
M a[20:23], a[136:139], a[184:187], a[20:23]
M a[24:27], a[144:147], a[184:187], a[24:27]
M a[24:27], a[148:151], a[188:191], a[24:27]
M a[28:31], a[156:159], a[188:191], a[28:31]
M a[28:31], a[152:155], a[184:187], a[28:31]
s_waitcnt lgkmcnt(2)
s_sub_u32 s30, s30, 1
s_cmp_lg_u32 s30, 0
s_cbranch_scc1 Lk1_kl
M v[32:35], a[32:35], a[160:163], v[32:35]
s_add_u32 m0, s29, 65536
s_nop 0
buffer_load_dwordx4 v6, s[12:15], s24 offen offset:0 lds
M v[32:35], a[36:39], a[164:167], v[32:35]
ds_read_b128 a[176:179], v10 offset:4096
ds_read_b128 a[180:183], v11 offset:4096
M v[36:39], a[44:47], a[164:167], v[36:39]
M v[36:39], a[40:43], a[160:163], v[36:39]
ds_read_b64_tr_b16 a[96:97], v12 offset:32768
ds_read_b64_tr_b16 a[98:99], v12 offset:34816
M v[40:43], a[48:51], a[160:163], v[40:43]
M v[40:43], a[52:55], a[164:167], v[40:43]
M v[44:47], a[60:63], a[164:167], v[44:47]
M v[44:47], a[56:59], a[160:163], v[44:47]
ds_read_b64_tr_b16 a[104:105], v13 offset:32768
ds_read_b64_tr_b16 a[106:107], v13 offset:34816
M v[48:51], a[64:67], a[160:163], v[48:51]
buffer_load_dwordx4 v7, s[12:15], s24 offen offset:1024 lds
M v[48:51], a[68:71], a[164:167], v[48:51]
M v[52:55], a[76:79], a[164:167], v[52:55]
M v[52:55], a[72:75], a[160:163], v[52:55]
ds_read_b64_tr_b16 a[112:113], v14 offset:32768
ds_read_b64_tr_b16 a[114:115], v14 offset:34816
M v[56:59], a[80:83], a[160:163], v[56:59]
M v[56:59], a[84:87], a[164:167], v[56:59]
M v[60:63], a[92:95], a[164:167], v[60:63]
buffer_load_dwordx4 v8, s[12:15], s24 offen offset:2048 lds
M v[60:63], a[88:91], a[160:163], v[60:63]
s_waitcnt lgkmcnt(8)
ds_read_b64_tr_b16 a[120:121], v15 offset:32768
ds_read_b64_tr_b16 a[122:123], v15 offset:34816
M v[64:67], a[32:35], a[168:171], v[64:67]
M v[64:67], a[36:39], a[172:175], v[64:67]
ds_read_b128 a[184:187], v10 offset:6144
ds_read_b128 a[188:191], v11 offset:6144
M v[68:71], a[44:47], a[172:175], v[68:71]
M v[68:71], a[40:43], a[168:171], v[68:71]
ds_read_b64_tr_b16 a[128:129], v16 offset:32768
ds_read_b64_tr_b16 a[130:131], v16 offset:34816
M v[72:75], a[48:51], a[168:171], v[72:75]
M v[72:75], a[52:55], a[172:175], v[72:75]
M v[76:79], a[60:63], a[172:175], v[76:79]
M v[76:79], a[56:59], a[168:171], v[76:79]
ds_read_b64_tr_b16 a[136:137], v17 offset:32768
ds_read_b64_tr_b16 a[138:139], v17 offset:34816
M v[80:83], a[64:67], a[168:171], v[80:83]
buffer_load_dwordx4 v9, s[12:15], s24 offen offset:3072 lds
M v[80:83], a[68:71], a[172:175], v[80:83]
M v[84:87], a[76:79], a[172:175], v[84:87]
M v[84:87], a[72:75], a[168:171], v[84:87]
ds_read_b64_tr_b16 a[144:145], v18 offset:32768
ds_read_b64_tr_b16 a[146:147], v18 offset:34816
M v[88:91], a[80:83], a[168:171], v[88:91]
M v[88:91], a[84:87], a[172:175], v[88:91]
M v[92:95], a[92:95], a[172:175], v[92:95]
s_add_u32 s24, s24, 262144
M v[92:95], a[88:91], a[168:171], v[92:95]
s_waitcnt lgkmcnt(15)
ds_read_b64_tr_b16 a[152:153], v19 offset:32768
ds_read_b64_tr_b16 a[154:155], v19 offset:34816
M v[96:99], a[32:35], a[176:179], v[96:99]
M v[96:99], a[36:39], a[180:183], v[96:99]
M v[100:103], a[44:47], a[180:183], v[100:103]
M v[100:103], a[40:43], a[176:179], v[100:103]
M v[104:107], a[48:51], a[176:179], v[104:107]
M v[104:107], a[52:55], a[180:183], v[104:107]
M v[108:111], a[60:63], a[180:183], v[108:111]
M v[108:111], a[56:59], a[176:179], v[108:111]
s_waitcnt vmcnt(8) lgkmcnt(0)
s_barrier
ds_read_b128 a[160:163], v10 offset:16384
ds_read_b128 a[164:167], v11 offset:16384
M v[112:115], a[64:67], a[176:179], v[112:115]
s_add_u32 m0, s29, 49152
s_add_u32 s3, s23, s31
buffer_load_dwordx4 v2, s[8:11], s3 offen offset:0 lds
M v[112:115], a[68:71], a[180:183], v[112:115]
M v[116:119], a[76:79], a[180:183], v[116:119]
M v[116:119], a[72:75], a[176:179], v[116:119]
ds_read_b64_tr_b16 a[100:101], v12 offset:49152
ds_read_b64_tr_b16 a[102:103], v12 offset:51200
M v[120:123], a[80:83], a[176:179], v[120:123]
M v[120:123], a[84:87], a[180:183], v[120:123]
buffer_load_dwordx4 v3, s[8:11], s3 offen offset:1024 lds
M v[124:127], a[92:95], a[180:183], v[124:127]
M v[124:127], a[88:91], a[176:179], v[124:127]
M v[128:131], a[32:35], a[184:187], v[128:131]
M v[128:131], a[36:39], a[188:191], v[128:131]
ds_read_b128 a[168:171], v10 offset:18432
ds_read_b128 a[172:175], v11 offset:18432
ds_read_b64_tr_b16 a[108:109], v13 offset:49152
ds_read_b64_tr_b16 a[110:111], v13 offset:51200
M v[132:135], a[44:47], a[188:191], v[132:135]
M v[132:135], a[40:43], a[184:187], v[132:135]
M v[136:139], a[48:51], a[184:187], v[136:139]
buffer_load_dwordx4 v4, s[8:11], s3 offen offset:2048 lds
M v[136:139], a[52:55], a[188:191], v[136:139]
M v[140:143], a[60:63], a[188:191], v[140:143]
M v[140:143], a[56:59], a[184:187], v[140:143]
ds_read_b64_tr_b16 a[116:117], v14 offset:49152
ds_read_b64_tr_b16 a[118:119], v14 offset:51200
M v[144:147], a[64:67], a[184:187], v[144:147]
M v[144:147], a[68:71], a[188:191], v[144:147]
M v[148:151], a[76:79], a[188:191], v[148:151]
buffer_load_dwordx4 v5, s[8:11], s3 offen offset:3072 lds
M v[148:151], a[72:75], a[184:187], v[148:151]
M v[152:155], a[80:83], a[184:187], v[152:155]
s_lshr_b32 s95, s53, 7
s_add_u32 s95, s95, s22
M v[152:155], a[84:87], a[188:191], v[152:155]
ds_read_b64_tr_b16 a[124:125], v15 offset:49152
ds_read_b64_tr_b16 a[126:127], v15 offset:51200
s_lshl_b32 s95, s95, 5
s_lshr_b32 s19, s52, 6
M v[156:159], a[92:95], a[188:191], v[156:159]
s_add_u32 s95, s95, s19
s_lshl_b32 s19, s21, 1
M v[156:159], a[88:91], a[184:187], v[156:159]
s_waitcnt lgkmcnt(10)
s_add_u32 s95, s95, s19
s_lshl_b32 s92, s95, 15
M v[160:163], a[32:35], a[160:163], v[160:163]
s_add_u32 s93, s92, 32768
s_add_u32 s16, s50, 16777216
M v[160:163], a[36:39], a[164:167], v[160:163]
ds_read_b128 a[176:179], v10 offset:20480
ds_read_b128 a[180:183], v11 offset:20480
s_addc_u32 s17, s51, 0
s_mov_b32 s18, 33554432
M v[164:167], a[44:47], a[164:167], v[164:167]
s_add_u32 s23, s23, 128
s_cmp_eq_u32 s23, s25
s_cselect_b32 s23, s26, s23
s_mov_b32 s19, 0x00020000
M v[164:167], a[40:43], a[160:163], v[164:167]
ds_read_b64_tr_b16 a[132:133], v16 offset:49152
ds_read_b64_tr_b16 a[134:135], v16 offset:51200
M v[168:171], a[48:51], a[160:163], v[168:171]
M v[168:171], a[52:55], a[164:167], v[168:171]
M v[172:175], a[60:63], a[164:167], v[172:175]
M v[172:175], a[56:59], a[160:163], v[172:175]
M v[176:179], a[64:67], a[160:163], v[176:179]
s_add_u32 m0, s29, 81920
s_nop 0
buffer_load_dwordx4 v6, s[12:15], s24 offen offset:0 lds
M v[176:179], a[68:71], a[164:167], v[176:179]
ds_read_b64_tr_b16 a[140:141], v17 offset:49152
ds_read_b64_tr_b16 a[142:143], v17 offset:51200
M v[180:183], a[76:79], a[164:167], v[180:183]
M v[180:183], a[72:75], a[160:163], v[180:183]
M v[184:187], a[80:83], a[160:163], v[184:187]
M v[184:187], a[84:87], a[164:167], v[184:187]
buffer_load_dwordx4 v7, s[12:15], s24 offen offset:1024 lds
M v[188:191], a[92:95], a[164:167], v[188:191]
M v[188:191], a[88:91], a[160:163], v[188:191]
s_waitcnt lgkmcnt(12)
ds_read_b64_tr_b16 a[148:149], v18 offset:49152
ds_read_b64_tr_b16 a[150:151], v18 offset:51200
M v[192:195], a[32:35], a[168:171], v[192:195]
M v[192:195], a[36:39], a[172:175], v[192:195]
ds_read_b128 a[184:187], v10 offset:22528
ds_read_b128 a[188:191], v11 offset:22528
M v[196:199], a[44:47], a[172:175], v[196:199]
M v[196:199], a[40:43], a[168:171], v[196:199]
M v[200:203], a[48:51], a[168:171], v[200:203]
buffer_load_dwordx4 v8, s[12:15], s24 offen offset:2048 lds
M v[200:203], a[52:55], a[172:175], v[200:203]
ds_read_b64_tr_b16 a[156:157], v19 offset:49152
ds_read_b64_tr_b16 a[158:159], v19 offset:51200
M v[204:207], a[60:63], a[172:175], v[204:207]
M v[204:207], a[56:59], a[168:171], v[204:207]
M v[208:211], a[64:67], a[168:171], v[208:211]
M v[208:211], a[68:71], a[172:175], v[208:211]
M v[212:215], a[76:79], a[172:175], v[212:215]
buffer_load_dwordx4 v9, s[12:15], s24 offen offset:3072 lds
M v[212:215], a[72:75], a[168:171], v[212:215]
M v[216:219], a[80:83], a[168:171], v[216:219]
M v[216:219], a[84:87], a[172:175], v[216:219]
M v[220:223], a[92:95], a[172:175], v[220:223]
M v[220:223], a[88:91], a[168:171], v[220:223]
s_waitcnt lgkmcnt(10)
M v[224:227], a[32:35], a[176:179], v[224:227]
s_add_u32 s24, s24, 262144
s_cmp_eq_u32 s24, s27
s_cselect_b32 s24, s28, s24
s_sub_u32 s6, s6, 1
s_cmp_eq_u32 s6, 0
s_cselect_b64 s[12:13], s[64:65], s[12:13]
M v[224:227], a[36:39], a[180:183], v[224:227]
M v[228:231], a[44:47], a[180:183], v[228:231]
M v[228:231], a[40:43], a[176:179], v[228:231]
M v[232:235], a[48:51], a[176:179], v[232:235]
M v[232:235], a[52:55], a[180:183], v[232:235]
M v[236:239], a[60:63], a[180:183], v[236:239]
M v[236:239], a[56:59], a[176:179], v[236:239]
s_waitcnt vmcnt(8) lgkmcnt(0)
s_barrier
ds_read_b128 a[160:163], v10 offset:32768
ds_read_b128 a[164:167], v11 offset:32768
M v[240:243], a[64:67], a[176:179], v[240:243]
s_add_u32 m0, s29, 0
s_nop 0
buffer_load_dwordx4 v2, s[8:11], s23 offen offset:0 lds
M v[240:243], a[68:71], a[180:183], v[240:243]
M v[244:247], a[76:79], a[180:183], v[244:247]
M v[244:247], a[72:75], a[176:179], v[244:247]
M v[248:251], a[80:83], a[176:179], v[248:251]
M v[248:251], a[84:87], a[180:183], v[248:251]
buffer_load_dwordx4 v3, s[8:11], s23 offen offset:1024 lds
M v[252:255], a[92:95], a[180:183], v[252:255]
M v[252:255], a[88:91], a[176:179], v[252:255]
M a[0:3], a[32:35], a[184:187], a[0:3]
M a[0:3], a[36:39], a[188:191], a[0:3]
ds_read_b128 a[168:171], v10 offset:34816
ds_read_b128 a[172:175], v11 offset:34816
M a[4:7], a[44:47], a[188:191], a[4:7]
M a[4:7], a[40:43], a[184:187], a[4:7]
M a[8:11], a[48:51], a[184:187], a[8:11]
buffer_load_dwordx4 v4, s[8:11], s23 offen offset:2048 lds
M a[8:11], a[52:55], a[188:191], a[8:11]
M a[12:15], a[60:63], a[188:191], a[12:15]
M a[12:15], a[56:59], a[184:187], a[12:15]
M a[16:19], a[64:67], a[184:187], a[16:19]
M a[16:19], a[68:71], a[188:191], a[16:19]
buffer_load_dwordx4 v5, s[8:11], s23 offen offset:3072 lds
M a[20:23], a[76:79], a[188:191], a[20:23]
M a[20:23], a[72:75], a[184:187], a[20:23]
M a[24:27], a[80:83], a[184:187], a[24:27]
M a[24:27], a[84:87], a[188:191], a[24:27]
M a[28:31], a[92:95], a[188:191], a[28:31]
M a[28:31], a[88:91], a[184:187], a[28:31]
s_waitcnt lgkmcnt(2)
M v[32:35], a[96:99], a[160:163], v[32:35]
s_add_u32 m0, s29, 98304
s_nop 0
buffer_load_dwordx4 v6, s[12:15], s24 offen offset:0 lds
M v[32:35], a[100:103], a[164:167], v[32:35]
ds_read_b128 a[176:179], v10 offset:36864
ds_read_b128 a[180:183], v11 offset:36864
M v[36:39], a[108:111], a[164:167], v[36:39]
M v[36:39], a[104:107], a[160:163], v[36:39]
ds_read_b64_tr_b16 a[32:33], v12 offset:0
ds_read_b64_tr_b16 a[34:35], v12 offset:2048
M v[40:43], a[112:115], a[160:163], v[40:43]
M v[40:43], a[116:119], a[164:167], v[40:43]
M v[44:47], a[124:127], a[164:167], v[44:47]
M v[44:47], a[120:123], a[160:163], v[44:47]
ds_read_b64_tr_b16 a[40:41], v13 offset:0
ds_read_b64_tr_b16 a[42:43], v13 offset:2048
M v[48:51], a[128:131], a[160:163], v[48:51]
buffer_load_dwordx4 v7, s[12:15], s24 offen offset:1024 lds
M v[48:51], a[132:135], a[164:167], v[48:51]
M v[52:55], a[140:143], a[164:167], v[52:55]
M v[52:55], a[136:139], a[160:163], v[52:55]
ds_read_b64_tr_b16 a[48:49], v14 offset:0
ds_read_b64_tr_b16 a[50:51], v14 offset:2048
M v[56:59], a[144:147], a[160:163], v[56:59]
M v[56:59], a[148:151], a[164:167], v[56:59]
M v[60:63], a[156:159], a[164:167], v[60:63]
buffer_load_dwordx4 v8, s[12:15], s24 offen offset:2048 lds
M v[60:63], a[152:155], a[160:163], v[60:63]
s_waitcnt lgkmcnt(8)
ds_read_b64_tr_b16 a[56:57], v15 offset:0
ds_read_b64_tr_b16 a[58:59], v15 offset:2048
M v[64:67], a[96:99], a[168:171], v[64:67]
M v[64:67], a[100:103], a[172:175], v[64:67]
ds_read_b128 a[184:187], v10 offset:38912
ds_read_b128 a[188:191], v11 offset:38912
M v[68:71], a[108:111], a[172:175], v[68:71]
M v[68:71], a[104:107], a[168:171], v[68:71]
ds_read_b64_tr_b16 a[64:65], v16 offset:0
ds_read_b64_tr_b16 a[66:67], v16 offset:2048
v_cvt_pk_bf16_f32 v32, v32, v33
v_cvt_pk_bf16_f32 v33, v34, v35
M v[72:75], a[112:115], a[168:171], v[72:75]
v_cvt_pk_bf16_f32 v34, v36, v37
v_cvt_pk_bf16_f32 v35, v38, v39
M v[72:75], a[116:119], a[172:175], v[72:75]
v_cvt_pk_bf16_f32 v40, v40, v41
v_cvt_pk_bf16_f32 v41, v42, v43
M v[76:79], a[124:127], a[172:175], v[76:79]
buffer_load_dwordx4 v9, s[12:15], s24 offen offset:3072 lds
v_cvt_pk_bf16_f32 v42, v44, v45
v_cvt_pk_bf16_f32 v43, v46, v47
M v[76:79], a[120:123], a[168:171], v[76:79]
ds_read_b64_tr_b16 a[72:73], v17 offset:0
ds_read_b64_tr_b16 a[74:75], v17 offset:2048
v_cvt_pk_bf16_f32 v48, v48, v49
v_cvt_pk_bf16_f32 v49, v50, v51
M v[80:83], a[128:131], a[168:171], v[80:83]
v_cvt_pk_bf16_f32 v50, v52, v53
v_cvt_pk_bf16_f32 v51, v54, v55
M v[80:83], a[132:135], a[172:175], v[80:83]
v_cvt_pk_bf16_f32 v56, v56, v57
v_cvt_pk_bf16_f32 v57, v58, v59
M v[84:87], a[140:143], a[172:175], v[84:87]
v_cvt_pk_bf16_f32 v58, v60, v61
v_cvt_pk_bf16_f32 v59, v62, v63
M v[84:87], a[136:139], a[168:171], v[84:87]
ds_read_b64_tr_b16 a[80:81], v18 offset:0
ds_read_b64_tr_b16 a[82:83], v18 offset:2048
M v[88:91], a[144:147], a[168:171], v[88:91]
M v[88:91], a[148:151], a[172:175], v[88:91]
s_add_u32 s24, s24, 262144
M v[92:95], a[156:159], a[172:175], v[92:95]
s_add_u32 s94, s92, 0
buffer_store_dwordx4 v[32:35], v1, s[16:19], s94 offen offset:0 sc1
M v[92:95], a[152:155], a[168:171], v[92:95]
s_waitcnt lgkmcnt(15)
ds_read_b64_tr_b16 a[88:89], v19 offset:0
ds_read_b64_tr_b16 a[90:91], v19 offset:2048
M v[96:99], a[96:99], a[176:179], v[96:99]
M v[96:99], a[100:103], a[180:183], v[96:99]
M v[100:103], a[108:111], a[180:183], v[100:103]
M v[100:103], a[104:107], a[176:179], v[100:103]
v_cvt_pk_bf16_f32 v64, v64, v65
v_cvt_pk_bf16_f32 v65, v66, v67
M v[104:107], a[112:115], a[176:179], v[104:107]
v_cvt_pk_bf16_f32 v66, v68, v69
v_cvt_pk_bf16_f32 v67, v70, v71
M v[104:107], a[116:119], a[180:183], v[104:107]
v_cvt_pk_bf16_f32 v72, v72, v73
v_cvt_pk_bf16_f32 v73, v74, v75
M v[108:111], a[124:127], a[180:183], v[108:111]
v_cvt_pk_bf16_f32 v74, v76, v77
v_cvt_pk_bf16_f32 v75, v78, v79
M v[108:111], a[120:123], a[176:179], v[108:111]
s_waitcnt vmcnt(9) lgkmcnt(0)
s_barrier
ds_read_b128 a[160:163], v10 offset:49152
ds_read_b128 a[164:167], v11 offset:49152
v_cvt_pk_bf16_f32 v80, v80, v81
v_cvt_pk_bf16_f32 v81, v82, v83
M v[112:115], a[128:131], a[176:179], v[112:115]
s_add_u32 s94, s92, 0
buffer_store_dwordx4 v[40:43], v1, s[16:19], s94 offen offset:1024 sc1
v_cvt_pk_bf16_f32 v82, v84, v85
v_cvt_pk_bf16_f32 v83, v86, v87
M v[112:115], a[132:135], a[180:183], v[112:115]
s_add_u32 m0, s29, 16384
s_add_u32 s3, s23, s31
buffer_load_dwordx4 v2, s[8:11], s3 offen offset:0 lds
v_cvt_pk_bf16_f32 v88, v88, v89
v_cvt_pk_bf16_f32 v89, v90, v91
M v[116:119], a[140:143], a[180:183], v[116:119]
v_cvt_pk_bf16_f32 v90, v92, v93
v_cvt_pk_bf16_f32 v91, v94, v95
M v[116:119], a[136:139], a[176:179], v[116:119]
ds_read_b64_tr_b16 a[36:37], v12 offset:16384
ds_read_b64_tr_b16 a[38:39], v12 offset:18432
M v[120:123], a[144:147], a[176:179], v[120:123]
M v[120:123], a[148:151], a[180:183], v[120:123]
M v[124:127], a[156:159], a[180:183], v[124:127]
buffer_load_dwordx4 v3, s[8:11], s3 offen offset:1024 lds
M v[124:127], a[152:155], a[176:179], v[124:127]
M v[128:131], a[96:99], a[184:187], v[128:131]
M v[128:131], a[100:103], a[188:191], v[128:131]
ds_read_b128 a[168:171], v10 offset:51200
ds_read_b128 a[172:175], v11 offset:51200
ds_read_b64_tr_b16 a[44:45], v13 offset:16384
ds_read_b64_tr_b16 a[46:47], v13 offset:18432
M v[132:135], a[108:111], a[188:191], v[132:135]
M v[132:135], a[104:107], a[184:187], v[132:135]
s_add_u32 s94, s92, 0
buffer_store_dwordx4 v[48:51], v1, s[16:19], s94 offen offset:2048 sc1
v_cvt_pk_bf16_f32 v96, v96, v97
v_cvt_pk_bf16_f32 v97, v98, v99
M v[136:139], a[112:115], a[184:187], v[136:139]
v_cvt_pk_bf16_f32 v98, v100, v101
v_cvt_pk_bf16_f32 v99, v102, v103
M v[136:139], a[116:119], a[188:191], v[136:139]
buffer_load_dwordx4 v4, s[8:11], s3 offen offset:2048 lds
v_cvt_pk_bf16_f32 v104, v104, v105
v_cvt_pk_bf16_f32 v105, v106, v107
M v[140:143], a[124:127], a[188:191], v[140:143]
v_cvt_pk_bf16_f32 v106, v108, v109
v_cvt_pk_bf16_f32 v107, v110, v111
M v[140:143], a[120:123], a[184:187], v[140:143]
ds_read_b64_tr_b16 a[52:53], v14 offset:16384
ds_read_b64_tr_b16 a[54:55], v14 offset:18432
v_cvt_pk_bf16_f32 v112, v112, v113
v_cvt_pk_bf16_f32 v113, v114, v115
M v[144:147], a[128:131], a[184:187], v[144:147]
v_cvt_pk_bf16_f32 v114, v116, v117
v_cvt_pk_bf16_f32 v115, v118, v119
M v[144:147], a[132:135], a[188:191], v[144:147]
v_cvt_pk_bf16_f32 v120, v120, v121
v_cvt_pk_bf16_f32 v121, v122, v123
M v[148:151], a[140:143], a[188:191], v[148:151]
buffer_load_dwordx4 v5, s[8:11], s3 offen offset:3072 lds
v_cvt_pk_bf16_f32 v122, v124, v125
v_cvt_pk_bf16_f32 v123, v126, v127
M v[148:151], a[136:139], a[184:187], v[148:151]
M v[152:155], a[144:147], a[184:187], v[152:155]
M v[152:155], a[148:151], a[188:191], v[152:155]
ds_read_b64_tr_b16 a[60:61], v15 offset:16384
ds_read_b64_tr_b16 a[62:63], v15 offset:18432
M v[156:159], a[156:159], a[188:191], v[156:159]
s_add_u32 s94, s92, 0
buffer_store_dwordx4 v[56:59], v1, s[16:19], s94 offen offset:3072 sc1
M v[156:159], a[152:155], a[184:187], v[156:159]
s_waitcnt lgkmcnt(10)
M v[160:163], a[96:99], a[160:163], v[160:163]
M v[160:163], a[100:103], a[164:167], v[160:163]
ds_read_b128 a[176:179], v10 offset:53248
ds_read_b128 a[180:183], v11 offset:53248
M v[164:167], a[108:111], a[164:167], v[164:167]
s_add_u32 s23, s23, 128
s_cmp_eq_u32 s23, s25
s_cselect_b32 s23, s26, s23
M v[164:167], a[104:107], a[160:163], v[164:167]
ds_read_b64_tr_b16 a[68:69], v16 offset:16384
ds_read_b64_tr_b16 a[70:71], v16 offset:18432
v_cvt_pk_bf16_f32 v128, v128, v129
v_cvt_pk_bf16_f32 v129, v130, v131
M v[168:171], a[112:115], a[160:163], v[168:171]
v_cvt_pk_bf16_f32 v130, v132, v133
v_cvt_pk_bf16_f32 v131, v134, v135
M v[168:171], a[116:119], a[164:167], v[168:171]
v_cvt_pk_bf16_f32 v136, v136, v137
v_cvt_pk_bf16_f32 v137, v138, v139
M v[172:175], a[124:127], a[164:167], v[172:175]
v_cvt_pk_bf16_f32 v138, v140, v141
v_cvt_pk_bf16_f32 v139, v142, v143
M v[172:175], a[120:123], a[160:163], v[172:175]
v_cvt_pk_bf16_f32 v144, v144, v145
v_cvt_pk_bf16_f32 v145, v146, v147
M v[176:179], a[128:131], a[160:163], v[176:179]
s_add_u32 s94, s92, 4096
buffer_store_dwordx4 v[64:67], v1, s[16:19], s94 offen offset:0 sc1
v_cvt_pk_bf16_f32 v146, v148, v149
v_cvt_pk_bf16_f32 v147, v150, v151
M v[176:179], a[132:135], a[164:167], v[176:179]
ds_read_b64_tr_b16 a[76:77], v17 offset:16384
ds_read_b64_tr_b16 a[78:79], v17 offset:18432
v_cvt_pk_bf16_f32 v152, v152, v153
v_cvt_pk_bf16_f32 v153, v154, v155
M v[180:183], a[140:143], a[164:167], v[180:183]
s_add_u32 m0, s29, 114688
s_nop 0
buffer_load_dwordx4 v6, s[12:15], s24 offen offset:0 lds
v_cvt_pk_bf16_f32 v154, v156, v157
v_cvt_pk_bf16_f32 v155, v158, v159
M v[180:183], a[136:139], a[160:163], v[180:183]
M v[184:187], a[144:147], a[160:163], v[184:187]
v_accvgpr_write_b32 a192, v128
v_accvgpr_write_b32 a193, v129
v_accvgpr_write_b32 a194, v130
v_accvgpr_write_b32 a195, v131
M v[184:187], a[148:151], a[164:167], v[184:187]
v_accvgpr_write_b32 a196, v136
v_accvgpr_write_b32 a197, v137
v_accvgpr_write_b32 a198, v138
v_accvgpr_write_b32 a199, v139
M v[188:191], a[156:159], a[164:167], v[188:191]
buffer_load_dwordx4 v7, s[12:15], s24 offen offset:1024 lds
v_accvgpr_write_b32 a200, v144
v_accvgpr_write_b32 a201, v145
v_accvgpr_write_b32 a202, v146
v_accvgpr_write_b32 a203, v147
M v[188:191], a[152:155], a[160:163], v[188:191]
s_waitcnt lgkmcnt(12)
ds_read_b64_tr_b16 a[84:85], v18 offset:16384
ds_read_b64_tr_b16 a[86:87], v18 offset:18432
v_accvgpr_write_b32 a204, v152
v_accvgpr_write_b32 a205, v153
v_accvgpr_write_b32 a206, v154
v_accvgpr_write_b32 a207, v155
M v[192:195], a[96:99], a[168:171], v[192:195]
M v[192:195], a[100:103], a[172:175], v[192:195]
ds_read_b128 a[184:187], v10 offset:55296
ds_read_b128 a[188:191], v11 offset:55296
M v[196:199], a[108:111], a[172:175], v[196:199]
s_add_u32 s94, s92, 4096
buffer_store_dwordx4 v[72:75], v1, s[16:19], s94 offen offset:1024 sc1
M v[196:199], a[104:107], a[168:171], v[196:199]
v_cvt_pk_bf16_f32 v160, v160, v161
v_cvt_pk_bf16_f32 v161, v162, v163
M v[200:203], a[112:115], a[168:171], v[200:203]
v_cvt_pk_bf16_f32 v162, v164, v165
v_cvt_pk_bf16_f32 v163, v166, v167
M v[200:203], a[116:119], a[172:175], v[200:203]
ds_read_b64_tr_b16 a[92:93], v19 offset:16384
ds_read_b64_tr_b16 a[94:95], v19 offset:18432
v_cvt_pk_bf16_f32 v168, v168, v169
v_cvt_pk_bf16_f32 v169, v170, v171
M v[204:207], a[124:127], a[172:175], v[204:207]
buffer_load_dwordx4 v8, s[12:15], s24 offen offset:2048 lds
v_cvt_pk_bf16_f32 v170, v172, v173
v_cvt_pk_bf16_f32 v171, v174, v175
M v[204:207], a[120:123], a[168:171], v[204:207]
v_cvt_pk_bf16_f32 v176, v176, v177
v_cvt_pk_bf16_f32 v177, v178, v179
M v[208:211], a[128:131], a[168:171], v[208:211]
v_cvt_pk_bf16_f32 v178, v180, v181
v_cvt_pk_bf16_f32 v179, v182, v183
M v[208:211], a[132:135], a[172:175], v[208:211]
v_cvt_pk_bf16_f32 v184, v184, v185
v_cvt_pk_bf16_f32 v185, v186, v187
M v[212:215], a[140:143], a[172:175], v[212:215]
buffer_load_dwordx4 v9, s[12:15], s24 offen offset:3072 lds
v_cvt_pk_bf16_f32 v186, v188, v189
v_cvt_pk_bf16_f32 v187, v190, v191
M v[212:215], a[136:139], a[168:171], v[212:215]
M v[216:219], a[144:147], a[168:171], v[216:219]
v_accvgpr_write_b32 a208, v160
v_accvgpr_write_b32 a209, v161
v_accvgpr_write_b32 a210, v162
v_accvgpr_write_b32 a211, v163
M v[216:219], a[148:151], a[172:175], v[216:219]
s_add_u32 s94, s92, 4096
buffer_store_dwordx4 v[80:83], v1, s[16:19], s94 offen offset:2048 sc1
v_accvgpr_write_b32 a212, v168
v_accvgpr_write_b32 a213, v169
v_accvgpr_write_b32 a214, v170
v_accvgpr_write_b32 a215, v171
M v[220:223], a[156:159], a[172:175], v[220:223]
v_accvgpr_write_b32 a216, v176
v_accvgpr_write_b32 a217, v177
v_accvgpr_write_b32 a218, v178
v_accvgpr_write_b32 a219, v179
M v[220:223], a[152:155], a[168:171], v[220:223]
s_waitcnt lgkmcnt(10)
v_accvgpr_write_b32 a220, v184
v_accvgpr_write_b32 a221, v185
v_accvgpr_write_b32 a222, v186
v_accvgpr_write_b32 a223, v187
M v[224:227], a[96:99], a[176:179], v[224:227]
s_add_u32 s24, s24, 262144
s_cmp_eq_u32 s24, s27
s_cselect_b32 s24, s28, s24
s_sub_u32 s6, s6, 1
s_cmp_eq_u32 s6, 0
s_cselect_b64 s[12:13], s[64:65], s[12:13]
M v[224:227], a[100:103], a[180:183], v[224:227]
M v[228:231], a[108:111], a[180:183], v[228:231]
M v[228:231], a[104:107], a[176:179], v[228:231]
v_cvt_pk_bf16_f32 v192, v192, v193
v_cvt_pk_bf16_f32 v193, v194, v195
M v[232:235], a[112:115], a[176:179], v[232:235]
v_cvt_pk_bf16_f32 v194, v196, v197
v_cvt_pk_bf16_f32 v195, v198, v199
M v[232:235], a[116:119], a[180:183], v[232:235]
v_cvt_pk_bf16_f32 v200, v200, v201
v_cvt_pk_bf16_f32 v201, v202, v203
M v[236:239], a[124:127], a[180:183], v[236:239]
v_cvt_pk_bf16_f32 v202, v204, v205
v_cvt_pk_bf16_f32 v203, v206, v207
M v[236:239], a[120:123], a[176:179], v[236:239]
s_waitcnt vmcnt(15) lgkmcnt(0)
s_barrier
ds_read_b128 a[160:163], v10 offset:0
ds_read_b128 a[164:167], v11 offset:0
v_cvt_pk_bf16_f32 v208, v208, v209
v_cvt_pk_bf16_f32 v209, v210, v211
M v[240:243], a[128:131], a[176:179], v[240:243]
s_add_u32 s94, s92, 4096
buffer_store_dwordx4 v[88:91], v1, s[16:19], s94 offen offset:3072 sc1
v_cvt_pk_bf16_f32 v210, v212, v213
v_cvt_pk_bf16_f32 v211, v214, v215
M v[240:243], a[132:135], a[180:183], v[240:243]
s_add_u32 m0, s29, 32768
s_nop 0
buffer_load_dwordx4 v2, s[8:11], s23 offen offset:0 lds
v_cvt_pk_bf16_f32 v216, v216, v217
v_cvt_pk_bf16_f32 v217, v218, v219
M v[244:247], a[140:143], a[180:183], v[244:247]
v_cvt_pk_bf16_f32 v218, v220, v221
v_cvt_pk_bf16_f32 v219, v222, v223
M v[244:247], a[136:139], a[176:179], v[244:247]
M v[248:251], a[144:147], a[176:179], v[248:251]
v_accvgpr_write_b32 a224, v192
v_accvgpr_write_b32 a225, v193
v_accvgpr_write_b32 a226, v194
v_accvgpr_write_b32 a227, v195
M v[248:251], a[148:151], a[180:183], v[248:251]
buffer_load_dwordx4 v3, s[8:11], s23 offen offset:1024 lds
v_accvgpr_write_b32 a228, v200
v_accvgpr_write_b32 a229, v201
v_accvgpr_write_b32 a230, v202
v_accvgpr_write_b32 a231, v203
M v[252:255], a[156:159], a[180:183], v[252:255]
v_accvgpr_write_b32 a232, v208
v_accvgpr_write_b32 a233, v209
v_accvgpr_write_b32 a234, v210
v_accvgpr_write_b32 a235, v211
M v[252:255], a[152:155], a[176:179], v[252:255]
v_accvgpr_write_b32 a236, v216
v_accvgpr_write_b32 a237, v217
v_accvgpr_write_b32 a238, v218
v_accvgpr_write_b32 a239, v219
M a[0:3], a[96:99], a[184:187], a[0:3]
M a[0:3], a[100:103], a[188:191], a[0:3]
ds_read_b128 a[168:171], v10 offset:2048
ds_read_b128 a[172:175], v11 offset:2048
M a[4:7], a[108:111], a[188:191], a[4:7]
s_add_u32 s94, s92, 8192
buffer_store_dwordx4 v[96:99], v1, s[16:19], s94 offen offset:0 sc1
M a[4:7], a[104:107], a[184:187], a[4:7]
v_cvt_pk_bf16_f32 v224, v224, v225
v_cvt_pk_bf16_f32 v225, v226, v227
M a[8:11], a[112:115], a[184:187], a[8:11]
v_cvt_pk_bf16_f32 v226, v228, v229
v_cvt_pk_bf16_f32 v227, v230, v231
M a[8:11], a[116:119], a[188:191], a[8:11]
buffer_load_dwordx4 v4, s[8:11], s23 offen offset:2048 lds
v_cvt_pk_bf16_f32 v232, v232, v233
v_cvt_pk_bf16_f32 v233, v234, v235
M a[12:15], a[124:127], a[188:191], a[12:15]
v_cvt_pk_bf16_f32 v234, v236, v237
v_cvt_pk_bf16_f32 v235, v238, v239
M a[12:15], a[120:123], a[184:187], a[12:15]
v_cvt_pk_bf16_f32 v240, v240, v241
v_cvt_pk_bf16_f32 v241, v242, v243
M a[16:19], a[128:131], a[184:187], a[16:19]
v_cvt_pk_bf16_f32 v242, v244, v245
v_cvt_pk_bf16_f32 v243, v246, v247
M a[16:19], a[132:135], a[188:191], a[16:19]
buffer_load_dwordx4 v5, s[8:11], s23 offen offset:3072 lds
v_cvt_pk_bf16_f32 v248, v248, v249
v_cvt_pk_bf16_f32 v249, v250, v251
M a[20:23], a[140:143], a[188:191], a[20:23]
v_cvt_pk_bf16_f32 v250, v252, v253
v_cvt_pk_bf16_f32 v251, v254, v255
M a[20:23], a[136:139], a[184:187], a[20:23]
M a[24:27], a[144:147], a[184:187], a[24:27]
s_add_u32 s94, s92, 8192
buffer_store_dwordx4 v[104:107], v1, s[16:19], s94 offen offset:1024 sc1
v_accvgpr_write_b32 a240, v224
v_accvgpr_write_b32 a241, v225
v_accvgpr_write_b32 a242, v226
v_accvgpr_write_b32 a243, v227
M a[24:27], a[148:151], a[188:191], a[24:27]
v_accvgpr_write_b32 a244, v232
v_accvgpr_write_b32 a245, v233
v_accvgpr_write_b32 a246, v234
v_accvgpr_write_b32 a247, v235
M a[28:31], a[156:159], a[188:191], a[28:31]
v_accvgpr_write_b32 a248, v240
v_accvgpr_write_b32 a249, v241
v_accvgpr_write_b32 a250, v242
v_accvgpr_write_b32 a251, v243
M a[28:31], a[152:155], a[184:187], a[28:31]
s_waitcnt lgkmcnt(2)
v_accvgpr_write_b32 a252, v248
v_accvgpr_write_b32 a253, v249
v_accvgpr_write_b32 a254, v250
v_accvgpr_write_b32 a255, v251
M v[32:35], a[160:163], a[32:35], 0
s_add_u32 m0, s29, 65536
s_nop 0
buffer_load_dwordx4 v6, s[12:15], s24 offen offset:0 lds
M v[32:35], a[164:167], a[36:39], v[32:35]
ds_read_b128 a[176:179], v10 offset:4096
ds_read_b128 a[180:183], v11 offset:4096
M v[36:39], a[164:167], a[44:47], 0
M v[36:39], a[160:163], a[40:43], v[36:39]
ds_read_b64_tr_b16 a[96:97], v12 offset:32768
ds_read_b64_tr_b16 a[98:99], v12 offset:34816
M v[40:43], a[160:163], a[48:51], 0
M v[40:43], a[164:167], a[52:55], v[40:43]
M v[44:47], a[164:167], a[60:63], 0
buffer_load_dwordx4 v7, s[12:15], s24 offen offset:1024 lds
M v[44:47], a[160:163], a[56:59], v[44:47]
ds_read_b64_tr_b16 a[104:105], v13 offset:32768
ds_read_b64_tr_b16 a[106:107], v13 offset:34816
M v[48:51], a[160:163], a[64:67], 0
s_add_u32 s94, s92, 8192
buffer_store_dwordx4 v[112:115], v1, s[16:19], s94 offen offset:2048 sc1
M v[48:51], a[164:167], a[68:71], v[48:51]
M v[52:55], a[164:167], a[76:79], 0
M v[52:55], a[160:163], a[72:75], v[52:55]
ds_read_b64_tr_b16 a[112:113], v14 offset:32768
ds_read_b64_tr_b16 a[114:115], v14 offset:34816
M v[56:59], a[160:163], a[80:83], 0
M v[56:59], a[164:167], a[84:87], v[56:59]
M v[60:63], a[164:167], a[92:95], 0
buffer_load_dwordx4 v8, s[12:15], s24 offen offset:2048 lds
M v[60:63], a[160:163], a[88:91], v[60:63]
s_waitcnt lgkmcnt(8)
ds_read_b64_tr_b16 a[120:121], v15 offset:32768
ds_read_b64_tr_b16 a[122:123], v15 offset:34816
M v[64:67], a[168:171], a[32:35], 0
M v[64:67], a[172:175], a[36:39], v[64:67]
ds_read_b128 a[184:187], v10 offset:6144
ds_read_b128 a[188:191], v11 offset:6144
M v[68:71], a[172:175], a[44:47], 0
s_add_u32 s94, s92, 8192
buffer_store_dwordx4 v[120:123], v1, s[16:19], s94 offen offset:3072 sc1
M v[68:71], a[168:171], a[40:43], v[68:71]
ds_read_b64_tr_b16 a[128:129], v16 offset:32768
ds_read_b64_tr_b16 a[130:131], v16 offset:34816
M v[72:75], a[168:171], a[48:51], 0
v_accvgpr_read_b32 v24, a0
v_accvgpr_read_b32 v25, a1
M v[72:75], a[172:175], a[52:55], v[72:75]
v_accvgpr_read_b32 v26, a2
v_accvgpr_read_b32 v27, a3
M v[76:79], a[172:175], a[60:63], 0
v_accvgpr_read_b32 v28, a4
v_accvgpr_read_b32 v29, a5
M v[76:79], a[168:171], a[56:59], v[76:79]
ds_read_b64_tr_b16 a[136:137], v17 offset:32768
ds_read_b64_tr_b16 a[138:139], v17 offset:34816
v_accvgpr_read_b32 v30, a6
v_accvgpr_read_b32 v31, a7
M v[80:83], a[168:171], a[64:67], 0
buffer_load_dwordx4 v9, s[12:15], s24 offen offset:3072 lds
v_cvt_pk_bf16_f32 v24, v24, v25
v_cvt_pk_bf16_f32 v25, v26, v27
M v[80:83], a[172:175], a[68:71], v[80:83]
v_cvt_pk_bf16_f32 v26, v28, v29
v_cvt_pk_bf16_f32 v27, v30, v31
M v[84:87], a[172:175], a[76:79], 0
M v[84:87], a[168:171], a[72:75], v[84:87]
ds_read_b64_tr_b16 a[144:145], v18 offset:32768
ds_read_b64_tr_b16 a[146:147], v18 offset:34816
M v[88:91], a[168:171], a[80:83], 0
M v[88:91], a[172:175], a[84:87], v[88:91]
s_add_u32 s94, s93, 12288
buffer_store_dwordx4 v[24:27], v1, s[16:19], s94 offen offset:0 sc1
M v[92:95], a[172:175], a[92:95], 0
M v[92:95], a[168:171], a[88:91], v[92:95]
s_waitcnt lgkmcnt(15)
ds_read_b64_tr_b16 a[152:153], v19 offset:32768
ds_read_b64_tr_b16 a[154:155], v19 offset:34816
M v[96:99], a[176:179], a[32:35], 0
s_add_u32 s24, s24, 262144
M v[96:99], a[180:183], a[36:39], v[96:99]
M v[100:103], a[180:183], a[44:47], 0
M v[100:103], a[176:179], a[40:43], v[100:103]
M v[104:107], a[176:179], a[48:51], 0
M v[104:107], a[180:183], a[52:55], v[104:107]
M v[108:111], a[180:183], a[60:63], 0
M v[108:111], a[176:179], a[56:59], v[108:111]
s_waitcnt vmcnt(15) lgkmcnt(0)
s_barrier
ds_read_b128 a[160:163], v10 offset:16384
ds_read_b128 a[164:167], v11 offset:16384
M v[112:115], a[176:179], a[64:67], 0
s_add_u32 m0, s29, 49152
s_add_u32 s3, s23, s31
buffer_load_dwordx4 v2, s[8:11], s3 offen offset:0 lds
M v[112:115], a[180:183], a[68:71], v[112:115]
M v[116:119], a[180:183], a[76:79], 0
M v[116:119], a[176:179], a[72:75], v[116:119]
ds_read_b64_tr_b16 a[100:101], v12 offset:49152
ds_read_b64_tr_b16 a[102:103], v12 offset:51200
M v[120:123], a[176:179], a[80:83], 0
v_accvgpr_read_b32 v24, a8
v_accvgpr_read_b32 v25, a9
M v[120:123], a[180:183], a[84:87], v[120:123]
buffer_load_dwordx4 v3, s[8:11], s3 offen offset:1024 lds
v_accvgpr_read_b32 v26, a10
v_accvgpr_read_b32 v27, a11
M v[124:127], a[180:183], a[92:95], 0
v_accvgpr_read_b32 v28, a12
v_accvgpr_read_b32 v29, a13
M v[124:127], a[176:179], a[88:91], v[124:127]
v_accvgpr_read_b32 v30, a14
v_accvgpr_read_b32 v31, a15
M v[128:131], a[184:187], a[32:35], 0
v_cvt_pk_bf16_f32 v24, v24, v25
v_cvt_pk_bf16_f32 v25, v26, v27
M v[128:131], a[188:191], a[36:39], v[128:131]
ds_read_b128 a[168:171], v10 offset:18432
ds_read_b128 a[172:175], v11 offset:18432
ds_read_b64_tr_b16 a[108:109], v13 offset:49152
ds_read_b64_tr_b16 a[110:111], v13 offset:51200
v_cvt_pk_bf16_f32 v26, v28, v29
v_cvt_pk_bf16_f32 v27, v30, v31
M v[132:135], a[188:191], a[44:47], 0
M v[132:135], a[184:187], a[40:43], v[132:135]
M v[136:139], a[184:187], a[48:51], 0
buffer_load_dwordx4 v4, s[8:11], s3 offen offset:2048 lds
M v[136:139], a[188:191], a[52:55], v[136:139]
s_add_u32 s94, s93, 12288
buffer_store_dwordx4 v[24:27], v1, s[16:19], s94 offen offset:1024 sc1
M v[140:143], a[188:191], a[60:63], 0
M v[140:143], a[184:187], a[56:59], v[140:143]
ds_read_b64_tr_b16 a[116:117], v14 offset:49152
ds_read_b64_tr_b16 a[118:119], v14 offset:51200
M v[144:147], a[184:187], a[64:67], 0
M v[144:147], a[188:191], a[68:71], v[144:147]
M v[148:151], a[188:191], a[76:79], 0
buffer_load_dwordx4 v5, s[8:11], s3 offen offset:3072 lds
M v[148:151], a[184:187], a[72:75], v[148:151]
M v[152:155], a[184:187], a[80:83], 0
M v[152:155], a[188:191], a[84:87], v[152:155]
ds_read_b64_tr_b16 a[124:125], v15 offset:49152
ds_read_b64_tr_b16 a[126:127], v15 offset:51200
M v[156:159], a[188:191], a[92:95], 0
M v[156:159], a[184:187], a[88:91], v[156:159]
s_waitcnt lgkmcnt(10)
M v[160:163], a[160:163], a[32:35], 0
M v[160:163], a[164:167], a[36:39], v[160:163]
ds_read_b128 a[176:179], v10 offset:20480
ds_read_b128 a[180:183], v11 offset:20480
M v[164:167], a[164:167], a[44:47], 0
s_add_u32 s23, s23, 128
s_cmp_eq_u32 s23, s25
s_cselect_b32 s23, s26, s23
M v[164:167], a[160:163], a[40:43], v[164:167]
ds_read_b64_tr_b16 a[132:133], v16 offset:49152
ds_read_b64_tr_b16 a[134:135], v16 offset:51200
M v[168:171], a[160:163], a[48:51], 0
v_accvgpr_read_b32 v24, a16
v_accvgpr_read_b32 v25, a17
M v[168:171], a[164:167], a[52:55], v[168:171]
v_accvgpr_read_b32 v26, a18
v_accvgpr_read_b32 v27, a19
M v[172:175], a[164:167], a[60:63], 0
v_accvgpr_read_b32 v28, a20
v_accvgpr_read_b32 v29, a21
M v[172:175], a[160:163], a[56:59], v[172:175]
v_accvgpr_read_b32 v30, a22
v_accvgpr_read_b32 v31, a23
M v[176:179], a[160:163], a[64:67], 0
s_add_u32 m0, s29, 81920
s_nop 0
buffer_load_dwordx4 v6, s[12:15], s24 offen offset:0 lds
v_cvt_pk_bf16_f32 v24, v24, v25
v_cvt_pk_bf16_f32 v25, v26, v27
M v[176:179], a[164:167], a[68:71], v[176:179]
ds_read_b64_tr_b16 a[140:141], v17 offset:49152
ds_read_b64_tr_b16 a[142:143], v17 offset:51200
v_cvt_pk_bf16_f32 v26, v28, v29
v_cvt_pk_bf16_f32 v27, v30, v31
M v[180:183], a[164:167], a[76:79], 0
M v[180:183], a[160:163], a[72:75], v[180:183]
M v[184:187], a[160:163], a[80:83], 0
M v[184:187], a[164:167], a[84:87], v[184:187]
s_add_u32 s94, s93, 12288
buffer_store_dwordx4 v[24:27], v1, s[16:19], s94 offen offset:2048 sc1
M v[188:191], a[164:167], a[92:95], 0
buffer_load_dwordx4 v7, s[12:15], s24 offen offset:1024 lds
M v[188:191], a[160:163], a[88:91], v[188:191]
s_waitcnt lgkmcnt(12)
ds_read_b64_tr_b16 a[148:149], v18 offset:49152
ds_read_b64_tr_b16 a[150:151], v18 offset:51200
M v[192:195], a[168:171], a[32:35], 0
M v[192:195], a[172:175], a[36:39], v[192:195]
ds_read_b128 a[184:187], v10 offset:22528
ds_read_b128 a[188:191], v11 offset:22528
M v[196:199], a[172:175], a[44:47], 0
M v[196:199], a[168:171], a[40:43], v[196:199]
M v[200:203], a[168:171], a[48:51], 0
M v[200:203], a[172:175], a[52:55], v[200:203]
ds_read_b64_tr_b16 a[156:157], v19 offset:49152
ds_read_b64_tr_b16 a[158:159], v19 offset:51200
M v[204:207], a[172:175], a[60:63], 0
buffer_load_dwordx4 v8, s[12:15], s24 offen offset:2048 lds
M v[204:207], a[168:171], a[56:59], v[204:207]
M v[208:211], a[168:171], a[64:67], 0
M v[208:211], a[172:175], a[68:71], v[208:211]
M v[212:215], a[172:175], a[76:79], 0
buffer_load_dwordx4 v9, s[12:15], s24 offen offset:3072 lds
M v[212:215], a[168:171], a[72:75], v[212:215]
M v[216:219], a[168:171], a[80:83], 0
v_accvgpr_read_b32 v24, a24
v_accvgpr_read_b32 v25, a25
M v[216:219], a[172:175], a[84:87], v[216:219]
v_accvgpr_read_b32 v26, a26
v_accvgpr_read_b32 v27, a27
M v[220:223], a[172:175], a[92:95], 0
v_accvgpr_read_b32 v28, a28
v_accvgpr_read_b32 v29, a29
M v[220:223], a[168:171], a[88:91], v[220:223]
s_waitcnt lgkmcnt(10)
v_accvgpr_read_b32 v30, a30
v_accvgpr_read_b32 v31, a31
M v[224:227], a[176:179], a[32:35], 0
s_add_u32 s24, s24, 262144
s_cmp_eq_u32 s24, s27
s_cselect_b32 s24, s28, s24
s_sub_u32 s6, s6, 1
s_cmp_eq_u32 s6, 0
s_cselect_b64 s[12:13], s[64:65], s[12:13]
v_cvt_pk_bf16_f32 v24, v24, v25
v_cvt_pk_bf16_f32 v25, v26, v27
M v[224:227], a[180:183], a[36:39], v[224:227]
v_cvt_pk_bf16_f32 v26, v28, v29
v_cvt_pk_bf16_f32 v27, v30, v31
M v[228:231], a[180:183], a[44:47], 0
M v[228:231], a[176:179], a[40:43], v[228:231]
M v[232:235], a[176:179], a[48:51], 0
M v[232:235], a[180:183], a[52:55], v[232:235]
s_add_u32 s94, s93, 12288
buffer_store_dwordx4 v[24:27], v1, s[16:19], s94 offen offset:3072 sc1
M v[236:239], a[180:183], a[60:63], 0
M v[236:239], a[176:179], a[56:59], v[236:239]
s_waitcnt vmcnt(12) lgkmcnt(0)
s_barrier
ds_read_b128 a[160:163], v10 offset:32768
ds_read_b128 a[164:167], v11 offset:32768
M v[240:243], a[176:179], a[64:67], 0
s_add_u32 m0, s29, 0
s_nop 0
buffer_load_dwordx4 v2, s[8:11], s23 offen offset:0 lds
M v[240:243], a[180:183], a[68:71], v[240:243]
M v[244:247], a[180:183], a[76:79], 0
M v[244:247], a[176:179], a[72:75], v[244:247]
M v[248:251], a[176:179], a[80:83], 0
M v[248:251], a[180:183], a[84:87], v[248:251]
buffer_load_dwordx4 v3, s[8:11], s23 offen offset:1024 lds
M v[252:255], a[180:183], a[92:95], 0
M v[252:255], a[176:179], a[88:91], v[252:255]
M a[0:3], a[184:187], a[32:35], 0
M a[0:3], a[188:191], a[36:39], a[0:3]
ds_read_b128 a[168:171], v10 offset:34816
ds_read_b128 a[172:175], v11 offset:34816
M a[4:7], a[188:191], a[44:47], 0
M a[4:7], a[184:187], a[40:43], a[4:7]
M a[8:11], a[184:187], a[48:51], 0
buffer_load_dwordx4 v4, s[8:11], s23 offen offset:2048 lds
M a[8:11], a[188:191], a[52:55], a[8:11]
M a[12:15], a[188:191], a[60:63], 0
M a[12:15], a[184:187], a[56:59], a[12:15]
M a[16:19], a[184:187], a[64:67], 0
M a[16:19], a[188:191], a[68:71], a[16:19]
buffer_load_dwordx4 v5, s[8:11], s23 offen offset:3072 lds
M a[20:23], a[188:191], a[76:79], 0
M a[20:23], a[184:187], a[72:75], a[20:23]
M a[24:27], a[184:187], a[80:83], 0
M a[24:27], a[188:191], a[84:87], a[24:27]
M a[28:31], a[188:191], a[92:95], 0
M a[28:31], a[184:187], a[88:91], a[28:31]
s_waitcnt lgkmcnt(2)
M v[32:35], a[160:163], a[96:99], v[32:35]
s_add_u32 m0, s29, 98304
s_nop 0
buffer_load_dwordx4 v6, s[12:15], s24 offen offset:0 lds
M v[32:35], a[164:167], a[100:103], v[32:35]
ds_read_b128 a[176:179], v10 offset:36864
ds_read_b128 a[180:183], v11 offset:36864
M v[36:39], a[164:167], a[108:111], v[36:39]
M v[36:39], a[160:163], a[104:107], v[36:39]
ds_read_b64_tr_b16 a[32:33], v12 offset:0
ds_read_b64_tr_b16 a[34:35], v12 offset:2048
M v[40:43], a[160:163], a[112:115], v[40:43]
M v[40:43], a[164:167], a[116:119], v[40:43]
M v[44:47], a[164:167], a[124:127], v[44:47]
M v[44:47], a[160:163], a[120:123], v[44:47]
ds_read_b64_tr_b16 a[40:41], v13 offset:0
ds_read_b64_tr_b16 a[42:43], v13 offset:2048
M v[48:51], a[160:163], a[128:131], v[48:51]
s_add_u32 s94, s92, 12288
buffer_store_dwordx4 a[192:195], v1, s[16:19], s94 offen offset:0 sc1
M v[48:51], a[164:167], a[132:135], v[48:51]
buffer_load_dwordx4 v7, s[12:15], s24 offen offset:1024 lds
M v[52:55], a[164:167], a[140:143], v[52:55]
M v[52:55], a[160:163], a[136:139], v[52:55]
ds_read_b64_tr_b16 a[48:49], v14 offset:0
ds_read_b64_tr_b16 a[50:51], v14 offset:2048
M v[56:59], a[160:163], a[144:147], v[56:59]
M v[56:59], a[164:167], a[148:151], v[56:59]
M v[60:63], a[164:167], a[156:159], v[60:63]
M v[60:63], a[160:163], a[152:155], v[60:63]
s_waitcnt lgkmcnt(8)
ds_read_b64_tr_b16 a[56:57], v15 offset:0
ds_read_b64_tr_b16 a[58:59], v15 offset:2048
M v[64:67], a[168:171], a[96:99], v[64:67]
buffer_load_dwordx4 v8, s[12:15], s24 offen offset:2048 lds
M v[64:67], a[172:175], a[100:103], v[64:67]
ds_read_b128 a[184:187], v10 offset:38912
ds_read_b128 a[188:191], v11 offset:38912
M v[68:71], a[172:175], a[108:111], v[68:71]
M v[68:71], a[168:171], a[104:107], v[68:71]
ds_read_b64_tr_b16 a[64:65], v16 offset:0
ds_read_b64_tr_b16 a[66:67], v16 offset:2048
M v[72:75], a[168:171], a[112:115], v[72:75]
M v[72:75], a[172:175], a[116:119], v[72:75]
M v[76:79], a[172:175], a[124:127], v[76:79]
M v[76:79], a[168:171], a[120:123], v[76:79]
ds_read_b64_tr_b16 a[72:73], v17 offset:0
ds_read_b64_tr_b16 a[74:75], v17 offset:2048
M v[80:83], a[168:171], a[128:131], v[80:83]
buffer_load_dwordx4 v9, s[12:15], s24 offen offset:3072 lds
M v[80:83], a[172:175], a[132:135], v[80:83]
M v[84:87], a[172:175], a[140:143], v[84:87]
M v[84:87], a[168:171], a[136:139], v[84:87]
ds_read_b64_tr_b16 a[80:81], v18 offset:0
ds_read_b64_tr_b16 a[82:83], v18 offset:2048
M v[88:91], a[168:171], a[144:147], v[88:91]
M v[88:91], a[172:175], a[148:151], v[88:91]
M v[92:95], a[172:175], a[156:159], v[92:95]
s_add_u32 s24, s24, 262144
M v[92:95], a[168:171], a[152:155], v[92:95]
s_waitcnt lgkmcnt(15)
ds_read_b64_tr_b16 a[88:89], v19 offset:0
ds_read_b64_tr_b16 a[90:91], v19 offset:2048
M v[96:99], a[176:179], a[96:99], v[96:99]
M v[96:99], a[180:183], a[100:103], v[96:99]
M v[100:103], a[180:183], a[108:111], v[100:103]
M v[100:103], a[176:179], a[104:107], v[100:103]
M v[104:107], a[176:179], a[112:115], v[104:107]
s_add_u32 s94, s92, 12288
buffer_store_dwordx4 a[196:199], v1, s[16:19], s94 offen offset:1024 sc1
M v[104:107], a[180:183], a[116:119], v[104:107]
M v[108:111], a[180:183], a[124:127], v[108:111]
M v[108:111], a[176:179], a[120:123], v[108:111]
s_waitcnt vmcnt(11) lgkmcnt(0)
s_barrier
ds_read_b128 a[160:163], v10 offset:49152
ds_read_b128 a[164:167], v11 offset:49152
M v[112:115], a[176:179], a[128:131], v[112:115]
s_add_u32 m0, s29, 16384
s_add_u32 s3, s23, s31
buffer_load_dwordx4 v2, s[8:11], s3 offen offset:0 lds
M v[112:115], a[180:183], a[132:135], v[112:115]
M v[116:119], a[180:183], a[140:143], v[116:119]
M v[116:119], a[176:179], a[136:139], v[116:119]
ds_read_b64_tr_b16 a[36:37], v12 offset:16384
ds_read_b64_tr_b16 a[38:39], v12 offset:18432
M v[120:123], a[176:179], a[144:147], v[120:123]
M v[120:123], a[180:183], a[148:151], v[120:123]
buffer_load_dwordx4 v3, s[8:11], s3 offen offset:1024 lds
M v[124:127], a[180:183], a[156:159], v[124:127]
M v[124:127], a[176:179], a[152:155], v[124:127]
M v[128:131], a[184:187], a[96:99], v[128:131]
M v[128:131], a[188:191], a[100:103], v[128:131]
ds_read_b128 a[168:171], v10 offset:51200
ds_read_b128 a[172:175], v11 offset:51200
ds_read_b64_tr_b16 a[44:45], v13 offset:16384
ds_read_b64_tr_b16 a[46:47], v13 offset:18432
M v[132:135], a[188:191], a[108:111], v[132:135]
M v[132:135], a[184:187], a[104:107], v[132:135]
M v[136:139], a[184:187], a[112:115], v[136:139]
buffer_load_dwordx4 v4, s[8:11], s3 offen offset:2048 lds
M v[136:139], a[188:191], a[116:119], v[136:139]
M v[140:143], a[188:191], a[124:127], v[140:143]
M v[140:143], a[184:187], a[120:123], v[140:143]
ds_read_b64_tr_b16 a[52:53], v14 offset:16384
ds_read_b64_tr_b16 a[54:55], v14 offset:18432
M v[144:147], a[184:187], a[128:131], v[144:147]
M v[144:147], a[188:191], a[132:135], v[144:147]
buffer_load_dwordx4 v5, s[8:11], s3 offen offset:3072 lds
M v[148:151], a[188:191], a[140:143], v[148:151]
M v[148:151], a[184:187], a[136:139], v[148:151]
M v[152:155], a[184:187], a[144:147], v[152:155]
M v[152:155], a[188:191], a[148:151], v[152:155]
ds_read_b64_tr_b16 a[60:61], v15 offset:16384
ds_read_b64_tr_b16 a[62:63], v15 offset:18432
M v[156:159], a[188:191], a[156:159], v[156:159]
M v[156:159], a[184:187], a[152:155], v[156:159]
s_waitcnt lgkmcnt(10)
M v[160:163], a[160:163], a[96:99], v[160:163]
s_add_u32 s94, s92, 12288
buffer_store_dwordx4 a[200:203], v1, s[16:19], s94 offen offset:2048 sc1
M v[160:163], a[164:167], a[100:103], v[160:163]
ds_read_b128 a[176:179], v10 offset:53248
ds_read_b128 a[180:183], v11 offset:53248
M v[164:167], a[164:167], a[108:111], v[164:167]
s_add_u32 s23, s23, 128
s_cmp_eq_u32 s23, s25
s_cselect_b32 s23, s26, s23
M v[164:167], a[160:163], a[104:107], v[164:167]
ds_read_b64_tr_b16 a[68:69], v16 offset:16384
ds_read_b64_tr_b16 a[70:71], v16 offset:18432
M v[168:171], a[160:163], a[112:115], v[168:171]
M v[168:171], a[164:167], a[116:119], v[168:171]
M v[172:175], a[164:167], a[124:127], v[172:175]
M v[172:175], a[160:163], a[120:123], v[172:175]
M v[176:179], a[160:163], a[128:131], v[176:179]
s_add_u32 m0, s29, 114688
s_nop 0
buffer_load_dwordx4 v6, s[12:15], s24 offen offset:0 lds
M v[176:179], a[164:167], a[132:135], v[176:179]
ds_read_b64_tr_b16 a[76:77], v17 offset:16384
ds_read_b64_tr_b16 a[78:79], v17 offset:18432
M v[180:183], a[164:167], a[140:143], v[180:183]
M v[180:183], a[160:163], a[136:139], v[180:183]
M v[184:187], a[160:163], a[144:147], v[184:187]
M v[184:187], a[164:167], a[148:151], v[184:187]
buffer_load_dwordx4 v7, s[12:15], s24 offen offset:1024 lds
M v[188:191], a[164:167], a[156:159], v[188:191]
M v[188:191], a[160:163], a[152:155], v[188:191]
s_waitcnt lgkmcnt(12)
ds_read_b64_tr_b16 a[84:85], v18 offset:16384
ds_read_b64_tr_b16 a[86:87], v18 offset:18432
M v[192:195], a[168:171], a[96:99], v[192:195]
M v[192:195], a[172:175], a[100:103], v[192:195]
ds_read_b128 a[184:187], v10 offset:55296
ds_read_b128 a[188:191], v11 offset:55296
M v[196:199], a[172:175], a[108:111], v[196:199]
M v[196:199], a[168:171], a[104:107], v[196:199]
M v[200:203], a[168:171], a[112:115], v[200:203]
buffer_load_dwordx4 v8, s[12:15], s24 offen offset:2048 lds
M v[200:203], a[172:175], a[116:119], v[200:203]
ds_read_b64_tr_b16 a[92:93], v19 offset:16384
ds_read_b64_tr_b16 a[94:95], v19 offset:18432
M v[204:207], a[172:175], a[124:127], v[204:207]
M v[204:207], a[168:171], a[120:123], v[204:207]
M v[208:211], a[168:171], a[128:131], v[208:211]
M v[208:211], a[172:175], a[132:135], v[208:211]
buffer_load_dwordx4 v9, s[12:15], s24 offen offset:3072 lds
M v[212:215], a[172:175], a[140:143], v[212:215]
M v[212:215], a[168:171], a[136:139], v[212:215]
M v[216:219], a[168:171], a[144:147], v[216:219]
s_add_u32 s94, s92, 12288
buffer_store_dwordx4 a[204:207], v1, s[16:19], s94 offen offset:3072 sc1
M v[216:219], a[172:175], a[148:151], v[216:219]
M v[220:223], a[172:175], a[156:159], v[220:223]
M v[220:223], a[168:171], a[152:155], v[220:223]
s_waitcnt lgkmcnt(10)
M v[224:227], a[176:179], a[96:99], v[224:227]
s_add_u32 s24, s24, 262144
s_cmp_eq_u32 s24, s27
s_cselect_b32 s24, s28, s24
s_sub_u32 s6, s6, 1
s_cmp_eq_u32 s6, 0
s_cselect_b64 s[12:13], s[64:65], s[12:13]
M v[224:227], a[180:183], a[100:103], v[224:227]
M v[228:231], a[180:183], a[108:111], v[228:231]
M v[228:231], a[176:179], a[104:107], v[228:231]
M v[232:235], a[176:179], a[112:115], v[232:235]
M v[232:235], a[180:183], a[116:119], v[232:235]
M v[236:239], a[180:183], a[124:127], v[236:239]
M v[236:239], a[176:179], a[120:123], v[236:239]
s_waitcnt vmcnt(11) lgkmcnt(0)
s_barrier
ds_read_b128 a[160:163], v10 offset:0
ds_read_b128 a[164:167], v11 offset:0
M v[240:243], a[176:179], a[128:131], v[240:243]
s_add_u32 m0, s29, 32768
s_nop 0
buffer_load_dwordx4 v2, s[8:11], s23 offen offset:0 lds
M v[240:243], a[180:183], a[132:135], v[240:243]
M v[244:247], a[180:183], a[140:143], v[244:247]
M v[244:247], a[176:179], a[136:139], v[244:247]
M v[248:251], a[176:179], a[144:147], v[248:251]
M v[248:251], a[180:183], a[148:151], v[248:251]
buffer_load_dwordx4 v3, s[8:11], s23 offen offset:1024 lds
M v[252:255], a[180:183], a[156:159], v[252:255]
M v[252:255], a[176:179], a[152:155], v[252:255]
M a[0:3], a[184:187], a[96:99], a[0:3]
M a[0:3], a[188:191], a[100:103], a[0:3]
ds_read_b128 a[168:171], v10 offset:2048
ds_read_b128 a[172:175], v11 offset:2048
M a[4:7], a[188:191], a[108:111], a[4:7]
M a[4:7], a[184:187], a[104:107], a[4:7]
M a[8:11], a[184:187], a[112:115], a[8:11]
buffer_load_dwordx4 v4, s[8:11], s23 offen offset:2048 lds
M a[8:11], a[188:191], a[116:119], a[8:11]
M a[12:15], a[188:191], a[124:127], a[12:15]
M a[12:15], a[184:187], a[120:123], a[12:15]
M a[16:19], a[184:187], a[128:131], a[16:19]
M a[16:19], a[188:191], a[132:135], a[16:19]
buffer_load_dwordx4 v5, s[8:11], s23 offen offset:3072 lds
M a[20:23], a[188:191], a[140:143], a[20:23]
M a[20:23], a[184:187], a[136:139], a[20:23]
M a[24:27], a[184:187], a[144:147], a[24:27]
M a[24:27], a[188:191], a[148:151], a[24:27]
M a[28:31], a[188:191], a[156:159], a[28:31]
M a[28:31], a[184:187], a[152:155], a[28:31]
s_waitcnt lgkmcnt(2)
M v[32:35], a[160:163], a[32:35], v[32:35]
s_add_u32 m0, s29, 65536
s_nop 0
buffer_load_dwordx4 v6, s[12:15], s24 offen offset:0 lds
M v[32:35], a[164:167], a[36:39], v[32:35]
ds_read_b128 a[176:179], v10 offset:4096
ds_read_b128 a[180:183], v11 offset:4096
M v[36:39], a[164:167], a[44:47], v[36:39]
M v[36:39], a[160:163], a[40:43], v[36:39]
ds_read_b64_tr_b16 a[96:97], v12 offset:32768
ds_read_b64_tr_b16 a[98:99], v12 offset:34816
M v[40:43], a[160:163], a[48:51], v[40:43]
M v[40:43], a[164:167], a[52:55], v[40:43]
M v[44:47], a[164:167], a[60:63], v[44:47]
M v[44:47], a[160:163], a[56:59], v[44:47]
ds_read_b64_tr_b16 a[104:105], v13 offset:32768
ds_read_b64_tr_b16 a[106:107], v13 offset:34816
M v[48:51], a[160:163], a[64:67], v[48:51]
s_add_u32 s94, s93, 0
buffer_store_dwordx4 a[208:211], v1, s[16:19], s94 offen offset:0 sc1
M v[48:51], a[164:167], a[68:71], v[48:51]
buffer_load_dwordx4 v7, s[12:15], s24 offen offset:1024 lds
M v[52:55], a[164:167], a[76:79], v[52:55]
M v[52:55], a[160:163], a[72:75], v[52:55]
ds_read_b64_tr_b16 a[112:113], v14 offset:32768
ds_read_b64_tr_b16 a[114:115], v14 offset:34816
M v[56:59], a[160:163], a[80:83], v[56:59]
M v[56:59], a[164:167], a[84:87], v[56:59]
M v[60:63], a[164:167], a[92:95], v[60:63]
M v[60:63], a[160:163], a[88:91], v[60:63]
s_waitcnt lgkmcnt(8)
ds_read_b64_tr_b16 a[120:121], v15 offset:32768
ds_read_b64_tr_b16 a[122:123], v15 offset:34816
M v[64:67], a[168:171], a[32:35], v[64:67]
buffer_load_dwordx4 v8, s[12:15], s24 offen offset:2048 lds
M v[64:67], a[172:175], a[36:39], v[64:67]
ds_read_b128 a[184:187], v10 offset:6144
ds_read_b128 a[188:191], v11 offset:6144
M v[68:71], a[172:175], a[44:47], v[68:71]
M v[68:71], a[168:171], a[40:43], v[68:71]
ds_read_b64_tr_b16 a[128:129], v16 offset:32768
ds_read_b64_tr_b16 a[130:131], v16 offset:34816
M v[72:75], a[168:171], a[48:51], v[72:75]
M v[72:75], a[172:175], a[52:55], v[72:75]
M v[76:79], a[172:175], a[60:63], v[76:79]
M v[76:79], a[168:171], a[56:59], v[76:79]
ds_read_b64_tr_b16 a[136:137], v17 offset:32768
ds_read_b64_tr_b16 a[138:139], v17 offset:34816
M v[80:83], a[168:171], a[64:67], v[80:83]
buffer_load_dwordx4 v9, s[12:15], s24 offen offset:3072 lds
M v[80:83], a[172:175], a[68:71], v[80:83]
M v[84:87], a[172:175], a[76:79], v[84:87]
M v[84:87], a[168:171], a[72:75], v[84:87]
ds_read_b64_tr_b16 a[144:145], v18 offset:32768
ds_read_b64_tr_b16 a[146:147], v18 offset:34816
M v[88:91], a[168:171], a[80:83], v[88:91]
M v[88:91], a[172:175], a[84:87], v[88:91]
M v[92:95], a[172:175], a[92:95], v[92:95]
s_add_u32 s24, s24, 262144
M v[92:95], a[168:171], a[88:91], v[92:95]
s_waitcnt lgkmcnt(15)
ds_read_b64_tr_b16 a[152:153], v19 offset:32768
ds_read_b64_tr_b16 a[154:155], v19 offset:34816
M v[96:99], a[176:179], a[32:35], v[96:99]
M v[96:99], a[180:183], a[36:39], v[96:99]
M v[100:103], a[180:183], a[44:47], v[100:103]
M v[100:103], a[176:179], a[40:43], v[100:103]
M v[104:107], a[176:179], a[48:51], v[104:107]
s_add_u32 s94, s93, 0
buffer_store_dwordx4 a[212:215], v1, s[16:19], s94 offen offset:1024 sc1
M v[104:107], a[180:183], a[52:55], v[104:107]
M v[108:111], a[180:183], a[60:63], v[108:111]
M v[108:111], a[176:179], a[56:59], v[108:111]
s_waitcnt vmcnt(11) lgkmcnt(0)
s_barrier
ds_read_b128 a[160:163], v10 offset:16384
ds_read_b128 a[164:167], v11 offset:16384
M v[112:115], a[176:179], a[64:67], v[112:115]
s_add_u32 m0, s29, 49152
s_add_u32 s3, s23, s31
buffer_load_dwordx4 v2, s[8:11], s3 offen offset:0 lds
M v[112:115], a[180:183], a[68:71], v[112:115]
M v[116:119], a[180:183], a[76:79], v[116:119]
M v[116:119], a[176:179], a[72:75], v[116:119]
ds_read_b64_tr_b16 a[100:101], v12 offset:49152
ds_read_b64_tr_b16 a[102:103], v12 offset:51200
M v[120:123], a[176:179], a[80:83], v[120:123]
M v[120:123], a[180:183], a[84:87], v[120:123]
buffer_load_dwordx4 v3, s[8:11], s3 offen offset:1024 lds
M v[124:127], a[180:183], a[92:95], v[124:127]
M v[124:127], a[176:179], a[88:91], v[124:127]
M v[128:131], a[184:187], a[32:35], v[128:131]
M v[128:131], a[188:191], a[36:39], v[128:131]
ds_read_b128 a[168:171], v10 offset:18432
ds_read_b128 a[172:175], v11 offset:18432
ds_read_b64_tr_b16 a[108:109], v13 offset:49152
ds_read_b64_tr_b16 a[110:111], v13 offset:51200
M v[132:135], a[188:191], a[44:47], v[132:135]
M v[132:135], a[184:187], a[40:43], v[132:135]
M v[136:139], a[184:187], a[48:51], v[136:139]
buffer_load_dwordx4 v4, s[8:11], s3 offen offset:2048 lds
M v[136:139], a[188:191], a[52:55], v[136:139]
M v[140:143], a[188:191], a[60:63], v[140:143]
M v[140:143], a[184:187], a[56:59], v[140:143]
ds_read_b64_tr_b16 a[116:117], v14 offset:49152
ds_read_b64_tr_b16 a[118:119], v14 offset:51200
M v[144:147], a[184:187], a[64:67], v[144:147]
M v[144:147], a[188:191], a[68:71], v[144:147]
buffer_load_dwordx4 v5, s[8:11], s3 offen offset:3072 lds
M v[148:151], a[188:191], a[76:79], v[148:151]
M v[148:151], a[184:187], a[72:75], v[148:151]
M v[152:155], a[184:187], a[80:83], v[152:155]
M v[152:155], a[188:191], a[84:87], v[152:155]
ds_read_b64_tr_b16 a[124:125], v15 offset:49152
ds_read_b64_tr_b16 a[126:127], v15 offset:51200
M v[156:159], a[188:191], a[92:95], v[156:159]
M v[156:159], a[184:187], a[88:91], v[156:159]
s_waitcnt lgkmcnt(10)
M v[160:163], a[160:163], a[32:35], v[160:163]
s_add_u32 s94, s93, 0
buffer_store_dwordx4 a[216:219], v1, s[16:19], s94 offen offset:2048 sc1
M v[160:163], a[164:167], a[36:39], v[160:163]
ds_read_b128 a[176:179], v10 offset:20480
ds_read_b128 a[180:183], v11 offset:20480
M v[164:167], a[164:167], a[44:47], v[164:167]
s_add_u32 s23, s23, 128
s_cmp_eq_u32 s23, s25
s_cselect_b32 s23, s26, s23
M v[164:167], a[160:163], a[40:43], v[164:167]
ds_read_b64_tr_b16 a[132:133], v16 offset:49152
ds_read_b64_tr_b16 a[134:135], v16 offset:51200
M v[168:171], a[160:163], a[48:51], v[168:171]
M v[168:171], a[164:167], a[52:55], v[168:171]
M v[172:175], a[164:167], a[60:63], v[172:175]
M v[172:175], a[160:163], a[56:59], v[172:175]
M v[176:179], a[160:163], a[64:67], v[176:179]
s_add_u32 m0, s29, 81920
s_nop 0
buffer_load_dwordx4 v6, s[12:15], s24 offen offset:0 lds
M v[176:179], a[164:167], a[68:71], v[176:179]
ds_read_b64_tr_b16 a[140:141], v17 offset:49152
ds_read_b64_tr_b16 a[142:143], v17 offset:51200
M v[180:183], a[164:167], a[76:79], v[180:183]
M v[180:183], a[160:163], a[72:75], v[180:183]
M v[184:187], a[160:163], a[80:83], v[184:187]
M v[184:187], a[164:167], a[84:87], v[184:187]
buffer_load_dwordx4 v7, s[12:15], s24 offen offset:1024 lds
M v[188:191], a[164:167], a[92:95], v[188:191]
M v[188:191], a[160:163], a[88:91], v[188:191]
s_waitcnt lgkmcnt(12)
ds_read_b64_tr_b16 a[148:149], v18 offset:49152
ds_read_b64_tr_b16 a[150:151], v18 offset:51200
M v[192:195], a[168:171], a[32:35], v[192:195]
M v[192:195], a[172:175], a[36:39], v[192:195]
ds_read_b128 a[184:187], v10 offset:22528
ds_read_b128 a[188:191], v11 offset:22528
M v[196:199], a[172:175], a[44:47], v[196:199]
M v[196:199], a[168:171], a[40:43], v[196:199]
M v[200:203], a[168:171], a[48:51], v[200:203]
buffer_load_dwordx4 v8, s[12:15], s24 offen offset:2048 lds
M v[200:203], a[172:175], a[52:55], v[200:203]
ds_read_b64_tr_b16 a[156:157], v19 offset:49152
ds_read_b64_tr_b16 a[158:159], v19 offset:51200
M v[204:207], a[172:175], a[60:63], v[204:207]
M v[204:207], a[168:171], a[56:59], v[204:207]
M v[208:211], a[168:171], a[64:67], v[208:211]
M v[208:211], a[172:175], a[68:71], v[208:211]
buffer_load_dwordx4 v9, s[12:15], s24 offen offset:3072 lds
M v[212:215], a[172:175], a[76:79], v[212:215]
M v[212:215], a[168:171], a[72:75], v[212:215]
M v[216:219], a[168:171], a[80:83], v[216:219]
s_add_u32 s94, s93, 0
buffer_store_dwordx4 a[220:223], v1, s[16:19], s94 offen offset:3072 sc1
M v[216:219], a[172:175], a[84:87], v[216:219]
M v[220:223], a[172:175], a[92:95], v[220:223]
M v[220:223], a[168:171], a[88:91], v[220:223]
s_waitcnt lgkmcnt(10)
M v[224:227], a[176:179], a[32:35], v[224:227]
s_add_u32 s24, s24, 262144
s_cmp_eq_u32 s24, s27
s_cselect_b32 s24, s28, s24
s_sub_u32 s6, s6, 1
s_cmp_eq_u32 s6, 0
s_cselect_b64 s[12:13], s[64:65], s[12:13]
M v[224:227], a[180:183], a[36:39], v[224:227]
M v[228:231], a[180:183], a[44:47], v[228:231]
M v[228:231], a[176:179], a[40:43], v[228:231]
M v[232:235], a[176:179], a[48:51], v[232:235]
M v[232:235], a[180:183], a[52:55], v[232:235]
M v[236:239], a[180:183], a[60:63], v[236:239]
M v[236:239], a[176:179], a[56:59], v[236:239]
s_waitcnt vmcnt(11) lgkmcnt(0)
s_barrier
ds_read_b128 a[160:163], v10 offset:32768
ds_read_b128 a[164:167], v11 offset:32768
M v[240:243], a[176:179], a[64:67], v[240:243]
s_add_u32 m0, s29, 0
s_nop 0
buffer_load_dwordx4 v2, s[8:11], s23 offen offset:0 lds
M v[240:243], a[180:183], a[68:71], v[240:243]
M v[244:247], a[180:183], a[76:79], v[244:247]
M v[244:247], a[176:179], a[72:75], v[244:247]
M v[248:251], a[176:179], a[80:83], v[248:251]
M v[248:251], a[180:183], a[84:87], v[248:251]
buffer_load_dwordx4 v3, s[8:11], s23 offen offset:1024 lds
M v[252:255], a[180:183], a[92:95], v[252:255]
M v[252:255], a[176:179], a[88:91], v[252:255]
M a[0:3], a[184:187], a[32:35], a[0:3]
M a[0:3], a[188:191], a[36:39], a[0:3]
ds_read_b128 a[168:171], v10 offset:34816
ds_read_b128 a[172:175], v11 offset:34816
M a[4:7], a[188:191], a[44:47], a[4:7]
M a[4:7], a[184:187], a[40:43], a[4:7]
M a[8:11], a[184:187], a[48:51], a[8:11]
buffer_load_dwordx4 v4, s[8:11], s23 offen offset:2048 lds
M a[8:11], a[188:191], a[52:55], a[8:11]
M a[12:15], a[188:191], a[60:63], a[12:15]
M a[12:15], a[184:187], a[56:59], a[12:15]
M a[16:19], a[184:187], a[64:67], a[16:19]
M a[16:19], a[188:191], a[68:71], a[16:19]
buffer_load_dwordx4 v5, s[8:11], s23 offen offset:3072 lds
M a[20:23], a[188:191], a[76:79], a[20:23]
M a[20:23], a[184:187], a[72:75], a[20:23]
M a[24:27], a[184:187], a[80:83], a[24:27]
M a[24:27], a[188:191], a[84:87], a[24:27]
M a[28:31], a[188:191], a[92:95], a[28:31]
M a[28:31], a[184:187], a[88:91], a[28:31]
s_waitcnt lgkmcnt(2)
M v[32:35], a[160:163], a[96:99], v[32:35]
s_add_u32 m0, s29, 98304
s_nop 0
buffer_load_dwordx4 v6, s[12:15], s24 offen offset:0 lds
M v[32:35], a[164:167], a[100:103], v[32:35]
ds_read_b128 a[176:179], v10 offset:36864
ds_read_b128 a[180:183], v11 offset:36864
M v[36:39], a[164:167], a[108:111], v[36:39]
M v[36:39], a[160:163], a[104:107], v[36:39]
ds_read_b64_tr_b16 a[32:33], v12 offset:0
ds_read_b64_tr_b16 a[34:35], v12 offset:2048
M v[40:43], a[160:163], a[112:115], v[40:43]
M v[40:43], a[164:167], a[116:119], v[40:43]
M v[44:47], a[164:167], a[124:127], v[44:47]
M v[44:47], a[160:163], a[120:123], v[44:47]
ds_read_b64_tr_b16 a[40:41], v13 offset:0
ds_read_b64_tr_b16 a[42:43], v13 offset:2048
M v[48:51], a[160:163], a[128:131], v[48:51]
s_add_u32 s94, s93, 4096
buffer_store_dwordx4 a[224:227], v1, s[16:19], s94 offen offset:0 sc1
M v[48:51], a[164:167], a[132:135], v[48:51]
buffer_load_dwordx4 v7, s[12:15], s24 offen offset:1024 lds
M v[52:55], a[164:167], a[140:143], v[52:55]
M v[52:55], a[160:163], a[136:139], v[52:55]
ds_read_b64_tr_b16 a[48:49], v14 offset:0
ds_read_b64_tr_b16 a[50:51], v14 offset:2048
M v[56:59], a[160:163], a[144:147], v[56:59]
M v[56:59], a[164:167], a[148:151], v[56:59]
M v[60:63], a[164:167], a[156:159], v[60:63]
M v[60:63], a[160:163], a[152:155], v[60:63]
s_waitcnt lgkmcnt(8)
ds_read_b64_tr_b16 a[56:57], v15 offset:0
ds_read_b64_tr_b16 a[58:59], v15 offset:2048
M v[64:67], a[168:171], a[96:99], v[64:67]
buffer_load_dwordx4 v8, s[12:15], s24 offen offset:2048 lds
M v[64:67], a[172:175], a[100:103], v[64:67]
ds_read_b128 a[184:187], v10 offset:38912
ds_read_b128 a[188:191], v11 offset:38912
M v[68:71], a[172:175], a[108:111], v[68:71]
M v[68:71], a[168:171], a[104:107], v[68:71]
ds_read_b64_tr_b16 a[64:65], v16 offset:0
ds_read_b64_tr_b16 a[66:67], v16 offset:2048
M v[72:75], a[168:171], a[112:115], v[72:75]
M v[72:75], a[172:175], a[116:119], v[72:75]
M v[76:79], a[172:175], a[124:127], v[76:79]
M v[76:79], a[168:171], a[120:123], v[76:79]
ds_read_b64_tr_b16 a[72:73], v17 offset:0
ds_read_b64_tr_b16 a[74:75], v17 offset:2048
M v[80:83], a[168:171], a[128:131], v[80:83]
buffer_load_dwordx4 v9, s[12:15], s24 offen offset:3072 lds
M v[80:83], a[172:175], a[132:135], v[80:83]
M v[84:87], a[172:175], a[140:143], v[84:87]
M v[84:87], a[168:171], a[136:139], v[84:87]
ds_read_b64_tr_b16 a[80:81], v18 offset:0
ds_read_b64_tr_b16 a[82:83], v18 offset:2048
M v[88:91], a[168:171], a[144:147], v[88:91]
M v[88:91], a[172:175], a[148:151], v[88:91]
M v[92:95], a[172:175], a[156:159], v[92:95]
s_add_u32 s24, s24, 262144
M v[92:95], a[168:171], a[152:155], v[92:95]
s_waitcnt lgkmcnt(15)
ds_read_b64_tr_b16 a[88:89], v19 offset:0
ds_read_b64_tr_b16 a[90:91], v19 offset:2048
M v[96:99], a[176:179], a[96:99], v[96:99]
M v[96:99], a[180:183], a[100:103], v[96:99]
M v[100:103], a[180:183], a[108:111], v[100:103]
M v[100:103], a[176:179], a[104:107], v[100:103]
M v[104:107], a[176:179], a[112:115], v[104:107]
s_add_u32 s94, s93, 4096
buffer_store_dwordx4 a[228:231], v1, s[16:19], s94 offen offset:1024 sc1
M v[104:107], a[180:183], a[116:119], v[104:107]
M v[108:111], a[180:183], a[124:127], v[108:111]
M v[108:111], a[176:179], a[120:123], v[108:111]
s_waitcnt vmcnt(11) lgkmcnt(0)
s_barrier
ds_read_b128 a[160:163], v10 offset:49152
ds_read_b128 a[164:167], v11 offset:49152
M v[112:115], a[176:179], a[128:131], v[112:115]
s_add_u32 m0, s29, 16384
s_add_u32 s3, s23, s31
buffer_load_dwordx4 v2, s[8:11], s3 offen offset:0 lds
M v[112:115], a[180:183], a[132:135], v[112:115]
M v[116:119], a[180:183], a[140:143], v[116:119]
M v[116:119], a[176:179], a[136:139], v[116:119]
ds_read_b64_tr_b16 a[36:37], v12 offset:16384
ds_read_b64_tr_b16 a[38:39], v12 offset:18432
M v[120:123], a[176:179], a[144:147], v[120:123]
M v[120:123], a[180:183], a[148:151], v[120:123]
buffer_load_dwordx4 v3, s[8:11], s3 offen offset:1024 lds
M v[124:127], a[180:183], a[156:159], v[124:127]
M v[124:127], a[176:179], a[152:155], v[124:127]
M v[128:131], a[184:187], a[96:99], v[128:131]
M v[128:131], a[188:191], a[100:103], v[128:131]
ds_read_b128 a[168:171], v10 offset:51200
ds_read_b128 a[172:175], v11 offset:51200
ds_read_b64_tr_b16 a[44:45], v13 offset:16384
ds_read_b64_tr_b16 a[46:47], v13 offset:18432
M v[132:135], a[188:191], a[108:111], v[132:135]
M v[132:135], a[184:187], a[104:107], v[132:135]
M v[136:139], a[184:187], a[112:115], v[136:139]
buffer_load_dwordx4 v4, s[8:11], s3 offen offset:2048 lds
M v[136:139], a[188:191], a[116:119], v[136:139]
M v[140:143], a[188:191], a[124:127], v[140:143]
M v[140:143], a[184:187], a[120:123], v[140:143]
ds_read_b64_tr_b16 a[52:53], v14 offset:16384
ds_read_b64_tr_b16 a[54:55], v14 offset:18432
M v[144:147], a[184:187], a[128:131], v[144:147]
M v[144:147], a[188:191], a[132:135], v[144:147]
buffer_load_dwordx4 v5, s[8:11], s3 offen offset:3072 lds
M v[148:151], a[188:191], a[140:143], v[148:151]
M v[148:151], a[184:187], a[136:139], v[148:151]
M v[152:155], a[184:187], a[144:147], v[152:155]
M v[152:155], a[188:191], a[148:151], v[152:155]
ds_read_b64_tr_b16 a[60:61], v15 offset:16384
ds_read_b64_tr_b16 a[62:63], v15 offset:18432
M v[156:159], a[188:191], a[156:159], v[156:159]
M v[156:159], a[184:187], a[152:155], v[156:159]
s_waitcnt lgkmcnt(10)
M v[160:163], a[160:163], a[96:99], v[160:163]
s_add_u32 s94, s93, 4096
buffer_store_dwordx4 a[232:235], v1, s[16:19], s94 offen offset:2048 sc1
M v[160:163], a[164:167], a[100:103], v[160:163]
ds_read_b128 a[176:179], v10 offset:53248
ds_read_b128 a[180:183], v11 offset:53248
M v[164:167], a[164:167], a[108:111], v[164:167]
s_add_u32 s23, s23, 128
s_cmp_eq_u32 s23, s25
s_cselect_b32 s23, s26, s23
M v[164:167], a[160:163], a[104:107], v[164:167]
ds_read_b64_tr_b16 a[68:69], v16 offset:16384
ds_read_b64_tr_b16 a[70:71], v16 offset:18432
M v[168:171], a[160:163], a[112:115], v[168:171]
M v[168:171], a[164:167], a[116:119], v[168:171]
M v[172:175], a[164:167], a[124:127], v[172:175]
M v[172:175], a[160:163], a[120:123], v[172:175]
M v[176:179], a[160:163], a[128:131], v[176:179]
s_add_u32 m0, s29, 114688
s_nop 0
buffer_load_dwordx4 v6, s[12:15], s24 offen offset:0 lds
M v[176:179], a[164:167], a[132:135], v[176:179]
ds_read_b64_tr_b16 a[76:77], v17 offset:16384
ds_read_b64_tr_b16 a[78:79], v17 offset:18432
M v[180:183], a[164:167], a[140:143], v[180:183]
M v[180:183], a[160:163], a[136:139], v[180:183]
M v[184:187], a[160:163], a[144:147], v[184:187]
M v[184:187], a[164:167], a[148:151], v[184:187]
buffer_load_dwordx4 v7, s[12:15], s24 offen offset:1024 lds
M v[188:191], a[164:167], a[156:159], v[188:191]
M v[188:191], a[160:163], a[152:155], v[188:191]
s_waitcnt lgkmcnt(12)
ds_read_b64_tr_b16 a[84:85], v18 offset:16384
ds_read_b64_tr_b16 a[86:87], v18 offset:18432
M v[192:195], a[168:171], a[96:99], v[192:195]
M v[192:195], a[172:175], a[100:103], v[192:195]
ds_read_b128 a[184:187], v10 offset:55296
ds_read_b128 a[188:191], v11 offset:55296
M v[196:199], a[172:175], a[108:111], v[196:199]
M v[196:199], a[168:171], a[104:107], v[196:199]
M v[200:203], a[168:171], a[112:115], v[200:203]
buffer_load_dwordx4 v8, s[12:15], s24 offen offset:2048 lds
M v[200:203], a[172:175], a[116:119], v[200:203]
ds_read_b64_tr_b16 a[92:93], v19 offset:16384
ds_read_b64_tr_b16 a[94:95], v19 offset:18432
M v[204:207], a[172:175], a[124:127], v[204:207]
M v[204:207], a[168:171], a[120:123], v[204:207]
M v[208:211], a[168:171], a[128:131], v[208:211]
M v[208:211], a[172:175], a[132:135], v[208:211]
buffer_load_dwordx4 v9, s[12:15], s24 offen offset:3072 lds
M v[212:215], a[172:175], a[140:143], v[212:215]
M v[212:215], a[168:171], a[136:139], v[212:215]
M v[216:219], a[168:171], a[144:147], v[216:219]
s_add_u32 s94, s93, 4096
buffer_store_dwordx4 a[236:239], v1, s[16:19], s94 offen offset:3072 sc1
M v[216:219], a[172:175], a[148:151], v[216:219]
M v[220:223], a[172:175], a[156:159], v[220:223]
M v[220:223], a[168:171], a[152:155], v[220:223]
s_waitcnt lgkmcnt(10)
M v[224:227], a[176:179], a[96:99], v[224:227]
s_add_u32 s24, s24, 262144
s_cmp_eq_u32 s24, s27
s_cselect_b32 s24, s28, s24
s_sub_u32 s6, s6, 1
s_cmp_eq_u32 s6, 0
s_cselect_b64 s[12:13], s[64:65], s[12:13]
M v[224:227], a[180:183], a[100:103], v[224:227]
M v[228:231], a[180:183], a[108:111], v[228:231]
M v[228:231], a[176:179], a[104:107], v[228:231]
M v[232:235], a[176:179], a[112:115], v[232:235]
M v[232:235], a[180:183], a[116:119], v[232:235]
M v[236:239], a[180:183], a[124:127], v[236:239]
M v[236:239], a[176:179], a[120:123], v[236:239]
s_waitcnt vmcnt(11) lgkmcnt(0)
s_barrier
ds_read_b128 a[160:163], v10 offset:0
ds_read_b128 a[164:167], v11 offset:0
M v[240:243], a[176:179], a[128:131], v[240:243]
s_add_u32 m0, s29, 32768
s_nop 0
buffer_load_dwordx4 v2, s[8:11], s23 offen offset:0 lds
M v[240:243], a[180:183], a[132:135], v[240:243]
M v[244:247], a[180:183], a[140:143], v[244:247]
M v[244:247], a[176:179], a[136:139], v[244:247]
M v[248:251], a[176:179], a[144:147], v[248:251]
M v[248:251], a[180:183], a[148:151], v[248:251]
buffer_load_dwordx4 v3, s[8:11], s23 offen offset:1024 lds
M v[252:255], a[180:183], a[156:159], v[252:255]
M v[252:255], a[176:179], a[152:155], v[252:255]
M a[0:3], a[184:187], a[96:99], a[0:3]
M a[0:3], a[188:191], a[100:103], a[0:3]
ds_read_b128 a[168:171], v10 offset:2048
ds_read_b128 a[172:175], v11 offset:2048
M a[4:7], a[188:191], a[108:111], a[4:7]
M a[4:7], a[184:187], a[104:107], a[4:7]
M a[8:11], a[184:187], a[112:115], a[8:11]
buffer_load_dwordx4 v4, s[8:11], s23 offen offset:2048 lds
M a[8:11], a[188:191], a[116:119], a[8:11]
M a[12:15], a[188:191], a[124:127], a[12:15]
M a[12:15], a[184:187], a[120:123], a[12:15]
M a[16:19], a[184:187], a[128:131], a[16:19]
M a[16:19], a[188:191], a[132:135], a[16:19]
buffer_load_dwordx4 v5, s[8:11], s23 offen offset:3072 lds
M a[20:23], a[188:191], a[140:143], a[20:23]
M a[20:23], a[184:187], a[136:139], a[20:23]
M a[24:27], a[184:187], a[144:147], a[24:27]
M a[24:27], a[188:191], a[148:151], a[24:27]
M a[28:31], a[188:191], a[156:159], a[28:31]
M a[28:31], a[184:187], a[152:155], a[28:31]
s_waitcnt lgkmcnt(2)
M v[32:35], a[160:163], a[32:35], v[32:35]
s_add_u32 m0, s29, 65536
s_nop 0
buffer_load_dwordx4 v6, s[12:15], s24 offen offset:0 lds
M v[32:35], a[164:167], a[36:39], v[32:35]
ds_read_b128 a[176:179], v10 offset:4096
ds_read_b128 a[180:183], v11 offset:4096
M v[36:39], a[164:167], a[44:47], v[36:39]
M v[36:39], a[160:163], a[40:43], v[36:39]
ds_read_b64_tr_b16 a[96:97], v12 offset:32768
ds_read_b64_tr_b16 a[98:99], v12 offset:34816
M v[40:43], a[160:163], a[48:51], v[40:43]
M v[40:43], a[164:167], a[52:55], v[40:43]
M v[44:47], a[164:167], a[60:63], v[44:47]
M v[44:47], a[160:163], a[56:59], v[44:47]
ds_read_b64_tr_b16 a[104:105], v13 offset:32768
ds_read_b64_tr_b16 a[106:107], v13 offset:34816
M v[48:51], a[160:163], a[64:67], v[48:51]
s_add_u32 s94, s93, 8192
buffer_store_dwordx4 a[240:243], v1, s[16:19], s94 offen offset:0 sc1
M v[48:51], a[164:167], a[68:71], v[48:51]
buffer_load_dwordx4 v7, s[12:15], s24 offen offset:1024 lds
M v[52:55], a[164:167], a[76:79], v[52:55]
M v[52:55], a[160:163], a[72:75], v[52:55]
ds_read_b64_tr_b16 a[112:113], v14 offset:32768
ds_read_b64_tr_b16 a[114:115], v14 offset:34816
M v[56:59], a[160:163], a[80:83], v[56:59]
M v[56:59], a[164:167], a[84:87], v[56:59]
M v[60:63], a[164:167], a[92:95], v[60:63]
M v[60:63], a[160:163], a[88:91], v[60:63]
s_waitcnt lgkmcnt(8)
ds_read_b64_tr_b16 a[120:121], v15 offset:32768
ds_read_b64_tr_b16 a[122:123], v15 offset:34816
M v[64:67], a[168:171], a[32:35], v[64:67]
buffer_load_dwordx4 v8, s[12:15], s24 offen offset:2048 lds
M v[64:67], a[172:175], a[36:39], v[64:67]
ds_read_b128 a[184:187], v10 offset:6144
ds_read_b128 a[188:191], v11 offset:6144
M v[68:71], a[172:175], a[44:47], v[68:71]
M v[68:71], a[168:171], a[40:43], v[68:71]
ds_read_b64_tr_b16 a[128:129], v16 offset:32768
ds_read_b64_tr_b16 a[130:131], v16 offset:34816
M v[72:75], a[168:171], a[48:51], v[72:75]
M v[72:75], a[172:175], a[52:55], v[72:75]
M v[76:79], a[172:175], a[60:63], v[76:79]
M v[76:79], a[168:171], a[56:59], v[76:79]
ds_read_b64_tr_b16 a[136:137], v17 offset:32768
ds_read_b64_tr_b16 a[138:139], v17 offset:34816
M v[80:83], a[168:171], a[64:67], v[80:83]
buffer_load_dwordx4 v9, s[12:15], s24 offen offset:3072 lds
M v[80:83], a[172:175], a[68:71], v[80:83]
M v[84:87], a[172:175], a[76:79], v[84:87]
M v[84:87], a[168:171], a[72:75], v[84:87]
ds_read_b64_tr_b16 a[144:145], v18 offset:32768
ds_read_b64_tr_b16 a[146:147], v18 offset:34816
M v[88:91], a[168:171], a[80:83], v[88:91]
M v[88:91], a[172:175], a[84:87], v[88:91]
M v[92:95], a[172:175], a[92:95], v[92:95]
s_add_u32 s24, s24, 262144
M v[92:95], a[168:171], a[88:91], v[92:95]
s_waitcnt lgkmcnt(15)
ds_read_b64_tr_b16 a[152:153], v19 offset:32768
ds_read_b64_tr_b16 a[154:155], v19 offset:34816
M v[96:99], a[176:179], a[32:35], v[96:99]
M v[96:99], a[180:183], a[36:39], v[96:99]
M v[100:103], a[180:183], a[44:47], v[100:103]
M v[100:103], a[176:179], a[40:43], v[100:103]
M v[104:107], a[176:179], a[48:51], v[104:107]
s_add_u32 s94, s93, 8192
buffer_store_dwordx4 a[244:247], v1, s[16:19], s94 offen offset:1024 sc1
M v[104:107], a[180:183], a[52:55], v[104:107]
M v[108:111], a[180:183], a[60:63], v[108:111]
M v[108:111], a[176:179], a[56:59], v[108:111]
s_waitcnt vmcnt(11) lgkmcnt(0)
s_barrier
ds_read_b128 a[160:163], v10 offset:16384
ds_read_b128 a[164:167], v11 offset:16384
M v[112:115], a[176:179], a[64:67], v[112:115]
s_add_u32 m0, s29, 49152
s_add_u32 s3, s23, s31
buffer_load_dwordx4 v2, s[8:11], s3 offen offset:0 lds
M v[112:115], a[180:183], a[68:71], v[112:115]
M v[116:119], a[180:183], a[76:79], v[116:119]
M v[116:119], a[176:179], a[72:75], v[116:119]
ds_read_b64_tr_b16 a[100:101], v12 offset:49152
ds_read_b64_tr_b16 a[102:103], v12 offset:51200
M v[120:123], a[176:179], a[80:83], v[120:123]
M v[120:123], a[180:183], a[84:87], v[120:123]
buffer_load_dwordx4 v3, s[8:11], s3 offen offset:1024 lds
M v[124:127], a[180:183], a[92:95], v[124:127]
M v[124:127], a[176:179], a[88:91], v[124:127]
M v[128:131], a[184:187], a[32:35], v[128:131]
M v[128:131], a[188:191], a[36:39], v[128:131]
ds_read_b128 a[168:171], v10 offset:18432
ds_read_b128 a[172:175], v11 offset:18432
ds_read_b64_tr_b16 a[108:109], v13 offset:49152
ds_read_b64_tr_b16 a[110:111], v13 offset:51200
M v[132:135], a[188:191], a[44:47], v[132:135]
M v[132:135], a[184:187], a[40:43], v[132:135]
M v[136:139], a[184:187], a[48:51], v[136:139]
buffer_load_dwordx4 v4, s[8:11], s3 offen offset:2048 lds
M v[136:139], a[188:191], a[52:55], v[136:139]
M v[140:143], a[188:191], a[60:63], v[140:143]
M v[140:143], a[184:187], a[56:59], v[140:143]
ds_read_b64_tr_b16 a[116:117], v14 offset:49152
ds_read_b64_tr_b16 a[118:119], v14 offset:51200
M v[144:147], a[184:187], a[64:67], v[144:147]
M v[144:147], a[188:191], a[68:71], v[144:147]
buffer_load_dwordx4 v5, s[8:11], s3 offen offset:3072 lds
M v[148:151], a[188:191], a[76:79], v[148:151]
M v[148:151], a[184:187], a[72:75], v[148:151]
M v[152:155], a[184:187], a[80:83], v[152:155]
M v[152:155], a[188:191], a[84:87], v[152:155]
ds_read_b64_tr_b16 a[124:125], v15 offset:49152
ds_read_b64_tr_b16 a[126:127], v15 offset:51200
M v[156:159], a[188:191], a[92:95], v[156:159]
M v[156:159], a[184:187], a[88:91], v[156:159]
s_waitcnt lgkmcnt(10)
M v[160:163], a[160:163], a[32:35], v[160:163]
s_add_u32 s94, s93, 8192
buffer_store_dwordx4 a[248:251], v1, s[16:19], s94 offen offset:2048 sc1
M v[160:163], a[164:167], a[36:39], v[160:163]
ds_read_b128 a[176:179], v10 offset:20480
ds_read_b128 a[180:183], v11 offset:20480
M v[164:167], a[164:167], a[44:47], v[164:167]
s_add_u32 s23, s23, 128
s_cmp_eq_u32 s23, s25
s_cselect_b32 s23, s26, s23
M v[164:167], a[160:163], a[40:43], v[164:167]
ds_read_b64_tr_b16 a[132:133], v16 offset:49152
ds_read_b64_tr_b16 a[134:135], v16 offset:51200
M v[168:171], a[160:163], a[48:51], v[168:171]
M v[168:171], a[164:167], a[52:55], v[168:171]
M v[172:175], a[164:167], a[60:63], v[172:175]
M v[172:175], a[160:163], a[56:59], v[172:175]
M v[176:179], a[160:163], a[64:67], v[176:179]
s_add_u32 m0, s29, 81920
s_nop 0
buffer_load_dwordx4 v6, s[12:15], s24 offen offset:0 lds
M v[176:179], a[164:167], a[68:71], v[176:179]
ds_read_b64_tr_b16 a[140:141], v17 offset:49152
ds_read_b64_tr_b16 a[142:143], v17 offset:51200
M v[180:183], a[164:167], a[76:79], v[180:183]
M v[180:183], a[160:163], a[72:75], v[180:183]
M v[184:187], a[160:163], a[80:83], v[184:187]
M v[184:187], a[164:167], a[84:87], v[184:187]
buffer_load_dwordx4 v7, s[12:15], s24 offen offset:1024 lds
M v[188:191], a[164:167], a[92:95], v[188:191]
M v[188:191], a[160:163], a[88:91], v[188:191]
s_waitcnt lgkmcnt(12)
ds_read_b64_tr_b16 a[148:149], v18 offset:49152
ds_read_b64_tr_b16 a[150:151], v18 offset:51200
M v[192:195], a[168:171], a[32:35], v[192:195]
M v[192:195], a[172:175], a[36:39], v[192:195]
ds_read_b128 a[184:187], v10 offset:22528
ds_read_b128 a[188:191], v11 offset:22528
M v[196:199], a[172:175], a[44:47], v[196:199]
M v[196:199], a[168:171], a[40:43], v[196:199]
M v[200:203], a[168:171], a[48:51], v[200:203]
buffer_load_dwordx4 v8, s[12:15], s24 offen offset:2048 lds
M v[200:203], a[172:175], a[52:55], v[200:203]
ds_read_b64_tr_b16 a[156:157], v19 offset:49152
ds_read_b64_tr_b16 a[158:159], v19 offset:51200
M v[204:207], a[172:175], a[60:63], v[204:207]
M v[204:207], a[168:171], a[56:59], v[204:207]
M v[208:211], a[168:171], a[64:67], v[208:211]
M v[208:211], a[172:175], a[68:71], v[208:211]
buffer_load_dwordx4 v9, s[12:15], s24 offen offset:3072 lds
M v[212:215], a[172:175], a[76:79], v[212:215]
M v[212:215], a[168:171], a[72:75], v[212:215]
M v[216:219], a[168:171], a[80:83], v[216:219]
s_add_u32 s94, s93, 8192
buffer_store_dwordx4 a[252:255], v1, s[16:19], s94 offen offset:3072 sc1
M v[216:219], a[172:175], a[84:87], v[216:219]
M v[220:223], a[172:175], a[92:95], v[220:223]
M v[220:223], a[168:171], a[88:91], v[220:223]
s_waitcnt lgkmcnt(10)
M v[224:227], a[176:179], a[32:35], v[224:227]
s_add_u32 s24, s24, 262144
s_cmp_eq_u32 s24, s27
s_cselect_b32 s24, s28, s24
s_sub_u32 s6, s6, 1
s_cmp_eq_u32 s6, 0
s_cselect_b64 s[12:13], s[64:65], s[12:13]
M v[224:227], a[180:183], a[36:39], v[224:227]
M v[228:231], a[180:183], a[44:47], v[228:231]
M v[228:231], a[176:179], a[40:43], v[228:231]
M v[232:235], a[176:179], a[48:51], v[232:235]
M v[232:235], a[180:183], a[52:55], v[232:235]
M v[236:239], a[180:183], a[60:63], v[236:239]
M v[236:239], a[176:179], a[56:59], v[236:239]
s_waitcnt vmcnt(11) lgkmcnt(0)
s_barrier
ds_read_b128 a[160:163], v10 offset:32768
ds_read_b128 a[164:167], v11 offset:32768
M v[240:243], a[176:179], a[64:67], v[240:243]
s_add_u32 m0, s29, 0
s_nop 0
buffer_load_dwordx4 v2, s[8:11], s23 offen offset:0 lds
M v[240:243], a[180:183], a[68:71], v[240:243]
M v[244:247], a[180:183], a[76:79], v[244:247]
M v[244:247], a[176:179], a[72:75], v[244:247]
M v[248:251], a[176:179], a[80:83], v[248:251]
M v[248:251], a[180:183], a[84:87], v[248:251]
buffer_load_dwordx4 v3, s[8:11], s23 offen offset:1024 lds
M v[252:255], a[180:183], a[92:95], v[252:255]
M v[252:255], a[176:179], a[88:91], v[252:255]
M a[0:3], a[184:187], a[32:35], a[0:3]
M a[0:3], a[188:191], a[36:39], a[0:3]
ds_read_b128 a[168:171], v10 offset:34816
ds_read_b128 a[172:175], v11 offset:34816
M a[4:7], a[188:191], a[44:47], a[4:7]
M a[4:7], a[184:187], a[40:43], a[4:7]
M a[8:11], a[184:187], a[48:51], a[8:11]
buffer_load_dwordx4 v4, s[8:11], s23 offen offset:2048 lds
M a[8:11], a[188:191], a[52:55], a[8:11]
M a[12:15], a[188:191], a[60:63], a[12:15]
M a[12:15], a[184:187], a[56:59], a[12:15]
M a[16:19], a[184:187], a[64:67], a[16:19]
M a[16:19], a[188:191], a[68:71], a[16:19]
buffer_load_dwordx4 v5, s[8:11], s23 offen offset:3072 lds
M a[20:23], a[188:191], a[76:79], a[20:23]
M a[20:23], a[184:187], a[72:75], a[20:23]
M a[24:27], a[184:187], a[80:83], a[24:27]
M a[24:27], a[188:191], a[84:87], a[24:27]
M a[28:31], a[188:191], a[92:95], a[28:31]
M a[28:31], a[184:187], a[88:91], a[28:31]
s_waitcnt lgkmcnt(2)
M v[32:35], a[160:163], a[96:99], v[32:35]
s_add_u32 m0, s29, 98304
s_nop 0
buffer_load_dwordx4 v6, s[12:15], s24 offen offset:0 lds
M v[32:35], a[164:167], a[100:103], v[32:35]
ds_read_b128 a[176:179], v10 offset:36864
ds_read_b128 a[180:183], v11 offset:36864
M v[36:39], a[164:167], a[108:111], v[36:39]
M v[36:39], a[160:163], a[104:107], v[36:39]
ds_read_b64_tr_b16 a[32:33], v12 offset:0
ds_read_b64_tr_b16 a[34:35], v12 offset:2048
M v[40:43], a[160:163], a[112:115], v[40:43]
M v[40:43], a[164:167], a[116:119], v[40:43]
M v[44:47], a[164:167], a[124:127], v[44:47]
M v[44:47], a[160:163], a[120:123], v[44:47]
ds_read_b64_tr_b16 a[40:41], v13 offset:0
ds_read_b64_tr_b16 a[42:43], v13 offset:2048
M v[48:51], a[160:163], a[128:131], v[48:51]
buffer_load_dwordx4 v7, s[12:15], s24 offen offset:1024 lds
M v[48:51], a[164:167], a[132:135], v[48:51]
M v[52:55], a[164:167], a[140:143], v[52:55]
M v[52:55], a[160:163], a[136:139], v[52:55]
ds_read_b64_tr_b16 a[48:49], v14 offset:0
ds_read_b64_tr_b16 a[50:51], v14 offset:2048
M v[56:59], a[160:163], a[144:147], v[56:59]
M v[56:59], a[164:167], a[148:151], v[56:59]
M v[60:63], a[164:167], a[156:159], v[60:63]
buffer_load_dwordx4 v8, s[12:15], s24 offen offset:2048 lds
M v[60:63], a[160:163], a[152:155], v[60:63]
s_waitcnt lgkmcnt(8)
ds_read_b64_tr_b16 a[56:57], v15 offset:0
ds_read_b64_tr_b16 a[58:59], v15 offset:2048
M v[64:67], a[168:171], a[96:99], v[64:67]
M v[64:67], a[172:175], a[100:103], v[64:67]
ds_read_b128 a[184:187], v10 offset:38912
ds_read_b128 a[188:191], v11 offset:38912
M v[68:71], a[172:175], a[108:111], v[68:71]
M v[68:71], a[168:171], a[104:107], v[68:71]
ds_read_b64_tr_b16 a[64:65], v16 offset:0
ds_read_b64_tr_b16 a[66:67], v16 offset:2048
M v[72:75], a[168:171], a[112:115], v[72:75]
M v[72:75], a[172:175], a[116:119], v[72:75]
M v[76:79], a[172:175], a[124:127], v[76:79]
M v[76:79], a[168:171], a[120:123], v[76:79]
ds_read_b64_tr_b16 a[72:73], v17 offset:0
ds_read_b64_tr_b16 a[74:75], v17 offset:2048
M v[80:83], a[168:171], a[128:131], v[80:83]
buffer_load_dwordx4 v9, s[12:15], s24 offen offset:3072 lds
M v[80:83], a[172:175], a[132:135], v[80:83]
M v[84:87], a[172:175], a[140:143], v[84:87]
M v[84:87], a[168:171], a[136:139], v[84:87]
ds_read_b64_tr_b16 a[80:81], v18 offset:0
ds_read_b64_tr_b16 a[82:83], v18 offset:2048
M v[88:91], a[168:171], a[144:147], v[88:91]
M v[88:91], a[172:175], a[148:151], v[88:91]
M v[92:95], a[172:175], a[156:159], v[92:95]
s_add_u32 s24, s24, 262144
M v[92:95], a[168:171], a[152:155], v[92:95]
s_waitcnt lgkmcnt(15)
ds_read_b64_tr_b16 a[88:89], v19 offset:0
ds_read_b64_tr_b16 a[90:91], v19 offset:2048
M v[96:99], a[176:179], a[96:99], v[96:99]
M v[96:99], a[180:183], a[100:103], v[96:99]
M v[100:103], a[180:183], a[108:111], v[100:103]
M v[100:103], a[176:179], a[104:107], v[100:103]
M v[104:107], a[176:179], a[112:115], v[104:107]
M v[104:107], a[180:183], a[116:119], v[104:107]
M v[108:111], a[180:183], a[124:127], v[108:111]
M v[108:111], a[176:179], a[120:123], v[108:111]
s_waitcnt vmcnt(9) lgkmcnt(0)
s_barrier
ds_read_b128 a[160:163], v10 offset:49152
ds_read_b128 a[164:167], v11 offset:49152
M v[112:115], a[176:179], a[128:131], v[112:115]
s_add_u32 m0, s29, 16384
s_add_u32 s3, s23, s31
buffer_load_dwordx4 v2, s[8:11], s3 offen offset:0 lds
M v[112:115], a[180:183], a[132:135], v[112:115]
M v[116:119], a[180:183], a[140:143], v[116:119]
M v[116:119], a[176:179], a[136:139], v[116:119]
ds_read_b64_tr_b16 a[36:37], v12 offset:16384
ds_read_b64_tr_b16 a[38:39], v12 offset:18432
M v[120:123], a[176:179], a[144:147], v[120:123]
M v[120:123], a[180:183], a[148:151], v[120:123]
buffer_load_dwordx4 v3, s[8:11], s3 offen offset:1024 lds
M v[124:127], a[180:183], a[156:159], v[124:127]
M v[124:127], a[176:179], a[152:155], v[124:127]
M v[128:131], a[184:187], a[96:99], v[128:131]
M v[128:131], a[188:191], a[100:103], v[128:131]
ds_read_b128 a[168:171], v10 offset:51200
ds_read_b128 a[172:175], v11 offset:51200
ds_read_b64_tr_b16 a[44:45], v13 offset:16384
ds_read_b64_tr_b16 a[46:47], v13 offset:18432
M v[132:135], a[188:191], a[108:111], v[132:135]
M v[132:135], a[184:187], a[104:107], v[132:135]
M v[136:139], a[184:187], a[112:115], v[136:139]
buffer_load_dwordx4 v4, s[8:11], s3 offen offset:2048 lds
M v[136:139], a[188:191], a[116:119], v[136:139]
M v[140:143], a[188:191], a[124:127], v[140:143]
M v[140:143], a[184:187], a[120:123], v[140:143]
ds_read_b64_tr_b16 a[52:53], v14 offset:16384
ds_read_b64_tr_b16 a[54:55], v14 offset:18432
M v[144:147], a[184:187], a[128:131], v[144:147]
M v[144:147], a[188:191], a[132:135], v[144:147]
M v[148:151], a[188:191], a[140:143], v[148:151]
buffer_load_dwordx4 v5, s[8:11], s3 offen offset:3072 lds
M v[148:151], a[184:187], a[136:139], v[148:151]
M v[152:155], a[184:187], a[144:147], v[152:155]
M v[152:155], a[188:191], a[148:151], v[152:155]
ds_read_b64_tr_b16 a[60:61], v15 offset:16384
ds_read_b64_tr_b16 a[62:63], v15 offset:18432
M v[156:159], a[188:191], a[156:159], v[156:159]
M v[156:159], a[184:187], a[152:155], v[156:159]
s_waitcnt lgkmcnt(10)
M v[160:163], a[160:163], a[96:99], v[160:163]
M v[160:163], a[164:167], a[100:103], v[160:163]
ds_read_b128 a[176:179], v10 offset:53248
ds_read_b128 a[180:183], v11 offset:53248
M v[164:167], a[164:167], a[108:111], v[164:167]
s_add_u32 s23, s23, 128
s_cmp_eq_u32 s23, s25
s_cselect_b32 s23, s26, s23
M v[164:167], a[160:163], a[104:107], v[164:167]
ds_read_b64_tr_b16 a[68:69], v16 offset:16384
ds_read_b64_tr_b16 a[70:71], v16 offset:18432
M v[168:171], a[160:163], a[112:115], v[168:171]
M v[168:171], a[164:167], a[116:119], v[168:171]
M v[172:175], a[164:167], a[124:127], v[172:175]
M v[172:175], a[160:163], a[120:123], v[172:175]
M v[176:179], a[160:163], a[128:131], v[176:179]
s_add_u32 m0, s29, 114688
s_nop 0
buffer_load_dwordx4 v6, s[12:15], s24 offen offset:0 lds
M v[176:179], a[164:167], a[132:135], v[176:179]
ds_read_b64_tr_b16 a[76:77], v17 offset:16384
ds_read_b64_tr_b16 a[78:79], v17 offset:18432
M v[180:183], a[164:167], a[140:143], v[180:183]
M v[180:183], a[160:163], a[136:139], v[180:183]
M v[184:187], a[160:163], a[144:147], v[184:187]
M v[184:187], a[164:167], a[148:151], v[184:187]
buffer_load_dwordx4 v7, s[12:15], s24 offen offset:1024 lds
M v[188:191], a[164:167], a[156:159], v[188:191]
M v[188:191], a[160:163], a[152:155], v[188:191]
s_waitcnt lgkmcnt(12)
ds_read_b64_tr_b16 a[84:85], v18 offset:16384
ds_read_b64_tr_b16 a[86:87], v18 offset:18432
M v[192:195], a[168:171], a[96:99], v[192:195]
M v[192:195], a[172:175], a[100:103], v[192:195]
ds_read_b128 a[184:187], v10 offset:55296
ds_read_b128 a[188:191], v11 offset:55296
M v[196:199], a[172:175], a[108:111], v[196:199]
M v[196:199], a[168:171], a[104:107], v[196:199]
M v[200:203], a[168:171], a[112:115], v[200:203]
buffer_load_dwordx4 v8, s[12:15], s24 offen offset:2048 lds
M v[200:203], a[172:175], a[116:119], v[200:203]
ds_read_b64_tr_b16 a[92:93], v19 offset:16384
ds_read_b64_tr_b16 a[94:95], v19 offset:18432
M v[204:207], a[172:175], a[124:127], v[204:207]
M v[204:207], a[168:171], a[120:123], v[204:207]
M v[208:211], a[168:171], a[128:131], v[208:211]
M v[208:211], a[172:175], a[132:135], v[208:211]
M v[212:215], a[172:175], a[140:143], v[212:215]
buffer_load_dwordx4 v9, s[12:15], s24 offen offset:3072 lds
M v[212:215], a[168:171], a[136:139], v[212:215]
M v[216:219], a[168:171], a[144:147], v[216:219]
M v[216:219], a[172:175], a[148:151], v[216:219]
M v[220:223], a[172:175], a[156:159], v[220:223]
M v[220:223], a[168:171], a[152:155], v[220:223]
s_waitcnt lgkmcnt(10)
M v[224:227], a[176:179], a[96:99], v[224:227]
s_add_u32 s24, s24, 262144
s_cmp_eq_u32 s24, s27
s_cselect_b32 s24, s28, s24
s_sub_u32 s6, s6, 1
s_cmp_eq_u32 s6, 0
s_cselect_b64 s[12:13], s[64:65], s[12:13]
M v[224:227], a[180:183], a[100:103], v[224:227]
M v[228:231], a[180:183], a[108:111], v[228:231]
M v[228:231], a[176:179], a[104:107], v[228:231]
M v[232:235], a[176:179], a[112:115], v[232:235]
M v[232:235], a[180:183], a[116:119], v[232:235]
M v[236:239], a[180:183], a[124:127], v[236:239]
M v[236:239], a[176:179], a[120:123], v[236:239]
s_waitcnt vmcnt(8) lgkmcnt(0)
s_barrier
ds_read_b128 a[160:163], v10 offset:0
ds_read_b128 a[164:167], v11 offset:0
M v[240:243], a[176:179], a[128:131], v[240:243]
s_add_u32 m0, s29, 32768
s_nop 0
buffer_load_dwordx4 v2, s[8:11], s23 offen offset:0 lds
M v[240:243], a[180:183], a[132:135], v[240:243]
M v[244:247], a[180:183], a[140:143], v[244:247]
M v[244:247], a[176:179], a[136:139], v[244:247]
M v[248:251], a[176:179], a[144:147], v[248:251]
M v[248:251], a[180:183], a[148:151], v[248:251]
M v[252:255], a[180:183], a[156:159], v[252:255]
M v[252:255], a[176:179], a[152:155], v[252:255]
M a[0:3], a[184:187], a[96:99], a[0:3]
M a[0:3], a[188:191], a[100:103], a[0:3]
ds_read_b128 a[168:171], v10 offset:2048
ds_read_b128 a[172:175], v11 offset:2048
M a[4:7], a[188:191], a[108:111], a[4:7]
M a[4:7], a[184:187], a[104:107], a[4:7]
M a[8:11], a[184:187], a[112:115], a[8:11]
buffer_load_dwordx4 v3, s[8:11], s23 offen offset:1024 lds
M a[8:11], a[188:191], a[116:119], a[8:11]
M a[12:15], a[188:191], a[124:127], a[12:15]
M a[12:15], a[184:187], a[120:123], a[12:15]
M a[16:19], a[184:187], a[128:131], a[16:19]
M a[16:19], a[188:191], a[132:135], a[16:19]
M a[20:23], a[188:191], a[140:143], a[20:23]
M a[20:23], a[184:187], a[136:139], a[20:23]
M a[24:27], a[184:187], a[144:147], a[24:27]
M a[24:27], a[188:191], a[148:151], a[24:27]
M a[28:31], a[188:191], a[156:159], a[28:31]
M a[28:31], a[184:187], a[152:155], a[28:31]
s_waitcnt lgkmcnt(2)
M v[32:35], a[160:163], a[32:35], v[32:35]
buffer_load_dwordx4 v4, s[8:11], s23 offen offset:2048 lds
M v[32:35], a[164:167], a[36:39], v[32:35]
ds_read_b128 a[176:179], v10 offset:4096
ds_read_b128 a[180:183], v11 offset:4096
M v[36:39], a[164:167], a[44:47], v[36:39]
M v[36:39], a[160:163], a[40:43], v[36:39]
ds_read_b64_tr_b16 a[96:97], v12 offset:32768
ds_read_b64_tr_b16 a[98:99], v12 offset:34816
M v[40:43], a[160:163], a[48:51], v[40:43]
M v[40:43], a[164:167], a[52:55], v[40:43]
M v[44:47], a[164:167], a[60:63], v[44:47]
M v[44:47], a[160:163], a[56:59], v[44:47]
ds_read_b64_tr_b16 a[104:105], v13 offset:32768
ds_read_b64_tr_b16 a[106:107], v13 offset:34816
M v[48:51], a[160:163], a[64:67], v[48:51]
M v[48:51], a[164:167], a[68:71], v[48:51]
M v[52:55], a[164:167], a[76:79], v[52:55]
M v[52:55], a[160:163], a[72:75], v[52:55]
ds_read_b64_tr_b16 a[112:113], v14 offset:32768
ds_read_b64_tr_b16 a[114:115], v14 offset:34816
M v[56:59], a[160:163], a[80:83], v[56:59]
M v[56:59], a[164:167], a[84:87], v[56:59]
M v[60:63], a[164:167], a[92:95], v[60:63]
M v[60:63], a[160:163], a[88:91], v[60:63]
s_waitcnt lgkmcnt(8)
ds_read_b64_tr_b16 a[120:121], v15 offset:32768
ds_read_b64_tr_b16 a[122:123], v15 offset:34816
M v[64:67], a[168:171], a[32:35], v[64:67]
M v[64:67], a[172:175], a[36:39], v[64:67]
ds_read_b128 a[184:187], v10 offset:6144
ds_read_b128 a[188:191], v11 offset:6144
M v[68:71], a[172:175], a[44:47], v[68:71]
M v[68:71], a[168:171], a[40:43], v[68:71]
ds_read_b64_tr_b16 a[128:129], v16 offset:32768
ds_read_b64_tr_b16 a[130:131], v16 offset:34816
M v[72:75], a[168:171], a[48:51], v[72:75]
buffer_load_dwordx4 v5, s[8:11], s23 offen offset:3072 lds
M v[72:75], a[172:175], a[52:55], v[72:75]
M v[76:79], a[172:175], a[60:63], v[76:79]
M v[76:79], a[168:171], a[56:59], v[76:79]
ds_read_b64_tr_b16 a[136:137], v17 offset:32768
ds_read_b64_tr_b16 a[138:139], v17 offset:34816
M v[80:83], a[168:171], a[64:67], v[80:83]
M v[80:83], a[172:175], a[68:71], v[80:83]
M v[84:87], a[172:175], a[76:79], v[84:87]
M v[84:87], a[168:171], a[72:75], v[84:87]
ds_read_b64_tr_b16 a[144:145], v18 offset:32768
ds_read_b64_tr_b16 a[146:147], v18 offset:34816
M v[88:91], a[168:171], a[80:83], v[88:91]
M v[88:91], a[172:175], a[84:87], v[88:91]
M v[92:95], a[172:175], a[92:95], v[92:95]
M v[92:95], a[168:171], a[88:91], v[92:95]
s_waitcnt lgkmcnt(15)
ds_read_b64_tr_b16 a[152:153], v19 offset:32768
ds_read_b64_tr_b16 a[154:155], v19 offset:34816
M v[96:99], a[176:179], a[32:35], v[96:99]
M v[96:99], a[180:183], a[36:39], v[96:99]
M v[100:103], a[180:183], a[44:47], v[100:103]
M v[100:103], a[176:179], a[40:43], v[100:103]
M v[104:107], a[176:179], a[48:51], v[104:107]
M v[104:107], a[180:183], a[52:55], v[104:107]
M v[108:111], a[180:183], a[60:63], v[108:111]
M v[108:111], a[176:179], a[56:59], v[108:111]
s_waitcnt vmcnt(4) lgkmcnt(0)
s_barrier
ds_read_b128 a[160:163], v10 offset:16384
ds_read_b128 a[164:167], v11 offset:16384
M v[112:115], a[176:179], a[64:67], v[112:115]
s_add_u32 m0, s29, 49152
s_add_u32 s3, s23, s31
buffer_load_dwordx4 v2, s[8:11], s3 offen offset:0 lds
M v[112:115], a[180:183], a[68:71], v[112:115]
M v[116:119], a[180:183], a[76:79], v[116:119]
buffer_load_dwordx4 v3, s[8:11], s3 offen offset:1024 lds
M v[116:119], a[176:179], a[72:75], v[116:119]
ds_read_b64_tr_b16 a[100:101], v12 offset:49152
ds_read_b64_tr_b16 a[102:103], v12 offset:51200
M v[120:123], a[176:179], a[80:83], v[120:123]
buffer_load_dwordx4 v4, s[8:11], s3 offen offset:2048 lds
M v[120:123], a[180:183], a[84:87], v[120:123]
M v[124:127], a[180:183], a[92:95], v[124:127]
buffer_load_dwordx4 v5, s[8:11], s3 offen offset:3072 lds
M v[124:127], a[176:179], a[88:91], v[124:127]
M v[128:131], a[184:187], a[32:35], v[128:131]
M v[128:131], a[188:191], a[36:39], v[128:131]
ds_read_b128 a[168:171], v10 offset:18432
ds_read_b128 a[172:175], v11 offset:18432
ds_read_b64_tr_b16 a[108:109], v13 offset:49152
ds_read_b64_tr_b16 a[110:111], v13 offset:51200
M v[132:135], a[188:191], a[44:47], v[132:135]
M v[132:135], a[184:187], a[40:43], v[132:135]
M v[136:139], a[184:187], a[48:51], v[136:139]
s_and_b32 s3, s2, 1
s_lshl_b32 s3, s3, 3
s_bfe_u32 s4, s2, 0x30003
s_add_u32 s26, s3, s4
M v[136:139], a[188:191], a[52:55], v[136:139]
s_bfe_u32 s3, s2, 0x20001
s_lshl_b32 s3, s3, 2
s_lshr_b32 s4, s2, 6
M v[140:143], a[188:191], a[60:63], v[140:143]
s_xor_b32 s4, s4, 2
s_add_u32 s27, s3, s4
s_lshl_b32 s23, s26, 18
M v[140:143], a[184:187], a[56:59], v[140:143]
ds_read_b64_tr_b16 a[116:117], v14 offset:49152
ds_read_b64_tr_b16 a[118:119], v14 offset:51200
s_sub_u32 s24, s23, 32768
s_max_i32 s24, s24, 0
s_lshl_b32 s25, s27, 7
s_add_u32 s3, s26, s27
M v[144:147], a[184:187], a[64:67], v[144:147]
s_and_b32 s3, s3, 0
s_mul_i32 s3, s3, 16
s_sub_u32 s31, 16, s3
M v[144:147], a[188:191], a[68:71], v[144:147]
s_mov_b32 s54, s31
s_movk_i32 s57, 128
s_mov_b32 s55, 4289069056
M v[148:151], a[188:191], a[76:79], v[148:151]
s_mov_b32 s56, 393216
s_lshl_b32 s4, s3, 7
s_add_u32 s23, s23, s4
M v[148:151], a[184:187], a[72:75], v[148:151]
s_add_u32 s24, s24, s4
s_mul_i32 s4, s3, 393216
s_add_u32 s25, s25, s4
s_mov_b64 s[8:9], s[44:45]
M v[152:155], a[184:187], a[80:83], v[152:155]
s_mov_b32 s10, 4194304
s_mov_b64 s[12:13], s[46:47]
s_mov_b32 s14, 6291456
M v[152:155], a[188:191], a[84:87], v[152:155]
ds_read_b64_tr_b16 a[124:125], v15 offset:49152
ds_read_b64_tr_b16 a[126:127], v15 offset:51200
s_mov_b64 s[36:37], s[90:91]
s_mov_b32 s38, 256
s_mov_b32 s39, 0x00020000
M v[156:159], a[188:191], a[92:95], v[156:159]
s_lshl_b32 s28, s20, 9
s_mul_i32 s30, s20, 6144
s_lshl_b32 s3, s20, 5
M v[156:159], a[184:187], a[88:91], v[156:159]
s_waitcnt lgkmcnt(10)
v_lshrrev_b32 v24, 3, v0
v_and_b32 v25, 7, v0
v_add_u32 v28, s3, v24
v_add_u32 v26, 0, v28
M v[160:163], a[160:163], a[32:35], v[160:163]
v_bfe_u32 v27, v26, 1, 3
v_xor_b32 v27, v27, v25
v_lshlrev_b32 v26, 11, v26
M v[160:163], a[164:167], a[36:39], v[160:163]
ds_read_b128 a[176:179], v10 offset:20480
ds_read_b128 a[180:183], v11 offset:20480
v_lshl_add_u32 v26, v27, 4, v26
v_subrev_u32 v2, 0, v26
v_add_u32 v26, 8, v28
M v[164:167], a[164:167], a[44:47], v[164:167]
v_bfe_u32 v27, v26, 1, 3
v_xor_b32 v27, v27, v25
v_lshlrev_b32 v26, 11, v26
v_lshl_add_u32 v26, v27, 4, v26
M v[164:167], a[160:163], a[40:43], v[164:167]
ds_read_b64_tr_b16 a[132:133], v16 offset:49152
ds_read_b64_tr_b16 a[134:135], v16 offset:51200
v_subrev_u32 v3, 1024, v26
v_add_u32 v26, 16, v28
v_bfe_u32 v27, v26, 1, 3
M v[168:171], a[160:163], a[48:51], v[168:171]
v_xor_b32 v27, v27, v25
v_lshlrev_b32 v26, 11, v26
v_lshl_add_u32 v26, v27, 4, v26
M v[168:171], a[164:167], a[52:55], v[168:171]
v_subrev_u32 v4, 2048, v26
v_add_u32 v26, 24, v28
v_bfe_u32 v27, v26, 1, 3
M v[172:175], a[164:167], a[60:63], v[172:175]
v_xor_b32 v27, v27, v25
v_lshlrev_b32 v26, 11, v26
v_lshl_add_u32 v26, v27, 4, v26
v_subrev_u32 v5, 3072, v26
M v[172:175], a[160:163], a[56:59], v[172:175]
s_lshl_b32 s3, s20, 2
v_lshrrev_b32 v26, 5, v0
v_add_u32 v26, s3, v26
M v[176:179], a[160:163], a[64:67], v[176:179]
v_bfe_u32 v29, v0, 2, 3
v_bfe_u32 v27, v26, 1, 3
v_xor_b32 v27, v27, v29
M v[176:179], a[164:167], a[68:71], v[176:179]
ds_read_b64_tr_b16 a[140:141], v17 offset:49152
ds_read_b64_tr_b16 a[142:143], v17 offset:51200
v_lshlrev_b32 v27, 4, v27
v_and_b32 v30, 3, v0
v_lshl_add_u32 v27, v30, 2, v27
M v[180:183], a[164:167], a[76:79], v[180:183]
v_lshl_add_u32 v20, v26, 11, v27
v_add_u32 v26, 2, v26
v_bfe_u32 v27, v26, 1, 3
v_xor_b32 v27, v27, v29
M v[180:183], a[160:163], a[72:75], v[180:183]
v_lshlrev_b32 v27, 4, v27
v_and_b32 v30, 3, v0
v_lshl_add_u32 v27, v30, 2, v27
M v[184:187], a[160:163], a[80:83], v[184:187]
v_lshl_add_u32 v23, v26, 11, v27
v_subrev_u32 v23, 256, v23
s_mul_i32 s3, s20, 48
M v[184:187], a[164:167], a[84:87], v[184:187]
v_add_u32 v28, s3, v24
v_add_u32 v26, 0, v28
v_mul_u32_u24 v27, 0xaaab, v26
v_lshrrev_b32 v27, 17, v27
M v[188:191], a[164:167], a[92:95], v[188:191]
v_lshrrev_b32 v29, 1, v27
v_and_b32 v29, 4, v29
v_and_or_b32 v27, v27, 2, v29
M v[188:191], a[160:163], a[88:91], v[188:191]
s_waitcnt lgkmcnt(12)
ds_read_b64_tr_b16 a[148:149], v18 offset:49152
ds_read_b64_tr_b16 a[150:151], v18 offset:51200
v_xor_b32 v27, v27, v25
v_lshlrev_b32 v26, 11, v26
v_lshl_add_u32 v26, v27, 4, v26
M v[192:195], a[168:171], a[32:35], v[192:195]
v_subrev_u32 v6, 0, v26
v_add_u32 v26, 8, v28
v_mul_u32_u24 v27, 0xaaab, v26
M v[192:195], a[172:175], a[36:39], v[192:195]
ds_read_b128 a[184:187], v10 offset:22528
ds_read_b128 a[188:191], v11 offset:22528
v_lshrrev_b32 v27, 17, v27
v_lshrrev_b32 v29, 1, v27
v_and_b32 v29, 4, v29
v_and_or_b32 v27, v27, 2, v29
M v[196:199], a[172:175], a[44:47], v[196:199]
v_xor_b32 v27, v27, v25
v_lshlrev_b32 v26, 11, v26
v_lshl_add_u32 v26, v27, 4, v26
M v[196:199], a[168:171], a[40:43], v[196:199]
v_subrev_u32 v7, 1024, v26
v_add_u32 v26, 16, v28
v_mul_u32_u24 v27, 0xaaab, v26
M v[200:203], a[168:171], a[48:51], v[200:203]
v_lshrrev_b32 v27, 17, v27
v_lshrrev_b32 v29, 1, v27
v_and_b32 v29, 4, v29
M v[200:203], a[172:175], a[52:55], v[200:203]
ds_read_b64_tr_b16 a[156:157], v19 offset:49152
ds_read_b64_tr_b16 a[158:159], v19 offset:51200
v_and_or_b32 v27, v27, 2, v29
v_xor_b32 v27, v27, v25
v_lshlrev_b32 v26, 11, v26
v_lshl_add_u32 v26, v27, 4, v26
M v[204:207], a[172:175], a[60:63], v[204:207]
v_subrev_u32 v8, 2048, v26
v_add_u32 v26, 24, v28
v_mul_u32_u24 v27, 0xaaab, v26
M v[204:207], a[168:171], a[56:59], v[204:207]
v_lshrrev_b32 v27, 17, v27
v_lshrrev_b32 v29, 1, v27
v_and_b32 v29, 4, v29
M v[208:211], a[168:171], a[64:67], v[208:211]
v_and_or_b32 v27, v27, 2, v29
v_xor_b32 v27, v27, v25
v_lshlrev_b32 v26, 11, v26
v_lshl_add_u32 v26, v27, 4, v26
M v[208:211], a[172:175], a[68:71], v[208:211]
v_subrev_u32 v9, 3072, v26
v_add_u32 v26, 32, v28
v_mul_u32_u24 v27, 0xaaab, v26
M v[212:215], a[172:175], a[76:79], v[212:215]
v_lshrrev_b32 v27, 17, v27
v_lshrrev_b32 v29, 1, v27
v_and_b32 v29, 4, v29
M v[212:215], a[168:171], a[72:75], v[212:215]
v_and_or_b32 v27, v27, 2, v29
v_xor_b32 v27, v27, v25
v_lshlrev_b32 v26, 11, v26
M v[216:219], a[168:171], a[80:83], v[216:219]
v_lshl_add_u32 v26, v27, 4, v26
v_subrev_u32 v21, 0, v26
v_add_u32 v26, 40, v28
v_mul_u32_u24 v27, 0xaaab, v26
M v[216:219], a[172:175], a[84:87], v[216:219]
v_lshrrev_b32 v27, 17, v27
v_lshrrev_b32 v29, 1, v27
v_and_b32 v29, 4, v29
M v[220:223], a[172:175], a[92:95], v[220:223]
v_and_or_b32 v27, v27, 2, v29
v_xor_b32 v27, v27, v25
v_lshlrev_b32 v26, 11, v26
M v[220:223], a[168:171], a[88:91], v[220:223]
s_waitcnt lgkmcnt(10)
v_lshl_add_u32 v26, v27, 4, v26
v_subrev_u32 v22, 1024, v26
s_lshr_b32 s3, s53, 7
M v[224:227], a[176:179], a[32:35], v[224:227]
s_add_u32 s3, s3, s22
s_lshl_b32 s3, s3, 5
s_lshr_b32 s19, s52, 6
s_add_u32 s3, s3, s19
M v[224:227], a[180:183], a[36:39], v[224:227]
s_lshl_b32 s19, s21, 1
s_add_u32 s3, s3, s19
s_lshl_b32 s92, s3, 15
M v[228:231], a[180:183], a[44:47], v[228:231]
s_add_u32 s92, s92, 16384
s_add_u32 s93, s92, 32768
s_add_u32 s16, s50, 16777216
M v[228:231], a[176:179], a[40:43], v[228:231]
s_addc_u32 s17, s51, 0
s_mov_b32 s18, 33554432
s_mov_b32 s19, 0x00020000
M v[232:235], a[176:179], a[48:51], v[232:235]
M v[232:235], a[180:183], a[52:55], v[232:235]
M v[236:239], a[180:183], a[60:63], v[236:239]
M v[236:239], a[176:179], a[56:59], v[236:239]
s_waitcnt vmcnt(4) lgkmcnt(0)
s_barrier
ds_read_b128 a[160:163], v10 offset:32768
ds_read_b128 a[164:167], v11 offset:32768
M v[240:243], a[176:179], a[64:67], v[240:243]
s_add_u32 m0, s28, 131072
s_nop 0
buffer_load_dword v20, s[8:11], s24 offen lds
M v[240:243], a[180:183], a[68:71], v[240:243]
M v[244:247], a[180:183], a[76:79], v[244:247]
M v[244:247], a[176:179], a[72:75], v[244:247]
buffer_load_dword v23, s[8:11], s24 offen offset:256 lds
M v[248:251], a[176:179], a[80:83], v[248:251]
M v[248:251], a[180:183], a[84:87], v[248:251]
M v[252:255], a[180:183], a[92:95], v[252:255]
M v[252:255], a[176:179], a[88:91], v[252:255]
M a[0:3], a[184:187], a[32:35], a[0:3]
s_add_u32 m0, s29, 133120
s_nop 0
buffer_load_dwordx4 v2, s[8:11], s23 offen offset:0 lds
M a[0:3], a[188:191], a[36:39], a[0:3]
ds_read_b128 a[168:171], v10 offset:34816
ds_read_b128 a[172:175], v11 offset:34816
M a[4:7], a[188:191], a[44:47], a[4:7]
M a[4:7], a[184:187], a[40:43], a[4:7]
M a[8:11], a[184:187], a[48:51], a[8:11]
buffer_load_dwordx4 v3, s[8:11], s23 offen offset:1024 lds
M a[8:11], a[188:191], a[52:55], a[8:11]
M a[12:15], a[188:191], a[60:63], a[12:15]
M a[12:15], a[184:187], a[56:59], a[12:15]
M a[16:19], a[184:187], a[64:67], a[16:19]
buffer_load_dwordx4 v4, s[8:11], s23 offen offset:2048 lds
M a[16:19], a[188:191], a[68:71], a[16:19]
M a[20:23], a[188:191], a[76:79], a[20:23]
M a[20:23], a[184:187], a[72:75], a[20:23]
buffer_load_dwordx4 v5, s[8:11], s23 offen offset:3072 lds
M a[24:27], a[184:187], a[80:83], a[24:27]
M a[24:27], a[188:191], a[84:87], a[24:27]
M a[28:31], a[188:191], a[92:95], a[28:31]
M a[28:31], a[184:187], a[88:91], a[28:31]
s_waitcnt lgkmcnt(2)
M v[32:35], a[160:163], a[96:99], v[32:35]
s_sub_u32 s31, s31, 1
s_cmp_eq_u32 s31, 0
s_cselect_b32 s58, -1920, s57
s_add_u32 s23, s23, s58
s_add_u32 s24, s24, s58
M v[32:35], a[164:167], a[100:103], v[32:35]
ds_read_b128 a[176:179], v10 offset:36864
ds_read_b128 a[180:183], v11 offset:36864
M v[36:39], a[164:167], a[108:111], v[36:39]
M v[36:39], a[160:163], a[104:107], v[36:39]
M v[40:43], a[160:163], a[112:115], v[40:43]
M v[40:43], a[164:167], a[116:119], v[40:43]
s_add_u32 m0, s30, 65536
s_nop 0
buffer_load_dwordx4 v6, s[12:15], s25 offen offset:0 lds
M v[44:47], a[164:167], a[124:127], v[44:47]
M v[44:47], a[160:163], a[120:123], v[44:47]
M v[48:51], a[160:163], a[128:131], v[48:51]
M v[48:51], a[164:167], a[132:135], v[48:51]
buffer_load_dwordx4 v7, s[12:15], s25 offen offset:1024 lds
M v[52:55], a[164:167], a[140:143], v[52:55]
M v[52:55], a[160:163], a[136:139], v[52:55]
M v[56:59], a[160:163], a[144:147], v[56:59]
M v[56:59], a[164:167], a[148:151], v[56:59]
buffer_load_dwordx4 v8, s[12:15], s25 offen offset:2048 lds
M v[60:63], a[164:167], a[156:159], v[60:63]
M v[60:63], a[160:163], a[152:155], v[60:63]
s_waitcnt lgkmcnt(2)
M v[64:67], a[168:171], a[96:99], v[64:67]
M v[64:67], a[172:175], a[100:103], v[64:67]
ds_read_b128 a[184:187], v10 offset:38912
ds_read_b128 a[188:191], v11 offset:38912
M v[68:71], a[172:175], a[108:111], v[68:71]
M v[68:71], a[168:171], a[104:107], v[68:71]
buffer_load_dwordx4 v9, s[12:15], s25 offen offset:3072 lds
M v[72:75], a[168:171], a[112:115], v[72:75]
M v[72:75], a[172:175], a[116:119], v[72:75]
M v[76:79], a[172:175], a[124:127], v[76:79]
M v[76:79], a[168:171], a[120:123], v[76:79]
s_add_u32 m0, s30, 69632
s_nop 0
buffer_load_dwordx4 v21, s[12:15], s25 offen offset:0 lds
M v[80:83], a[168:171], a[128:131], v[80:83]
M v[80:83], a[172:175], a[132:135], v[80:83]
M v[84:87], a[172:175], a[140:143], v[84:87]
M v[84:87], a[168:171], a[136:139], v[84:87]
buffer_load_dwordx4 v22, s[12:15], s25 offen offset:1024 lds
M v[88:91], a[168:171], a[144:147], v[88:91]
M v[88:91], a[172:175], a[148:151], v[88:91]
M v[92:95], a[172:175], a[156:159], v[92:95]
M v[92:95], a[168:171], a[152:155], v[92:95]
s_waitcnt lgkmcnt(2)
M v[96:99], a[176:179], a[96:99], v[96:99]
s_sub_u32 s54, s54, 1
s_cmp_eq_u32 s54, 0
s_cselect_b32 s58, s55, s56
s_add_u32 s25, s25, s58
M v[96:99], a[180:183], a[100:103], v[96:99]
M v[100:103], a[180:183], a[108:111], v[100:103]
M v[100:103], a[176:179], a[104:107], v[100:103]
v_cvt_pk_bf16_f32 v32, v32, v33
v_cvt_pk_bf16_f32 v33, v34, v35
M v[104:107], a[176:179], a[112:115], v[104:107]
v_cvt_pk_bf16_f32 v34, v64, v65
v_cvt_pk_bf16_f32 v35, v66, v67
M v[104:107], a[180:183], a[116:119], v[104:107]
v_cvt_pk_bf16_f32 v64, v48, v49
M v[108:111], a[180:183], a[124:127], v[108:111]
v_cvt_pk_bf16_f32 v65, v50, v51
v_cvt_pk_bf16_f32 v66, v80, v81
M v[108:111], a[176:179], a[120:123], v[108:111]
s_waitcnt vmcnt(12) lgkmcnt(0)
s_barrier
ds_read_b128 a[160:163], v10 offset:49152
ds_read_b128 a[164:167], v11 offset:49152
v_cvt_pk_bf16_f32 v67, v82, v83
M v[112:115], a[176:179], a[128:131], v[112:115]
s_add_u32 m0, s28, 0
s_nop 0
buffer_load_dword v20, s[8:11], s24 offen lds
v_cvt_pk_bf16_f32 v48, v40, v41
v_cvt_pk_bf16_f32 v49, v42, v43
M v[112:115], a[180:183], a[132:135], v[112:115]
v_cvt_pk_bf16_f32 v50, v72, v73
v_cvt_pk_bf16_f32 v51, v74, v75
M v[116:119], a[180:183], a[140:143], v[116:119]
v_cvt_pk_bf16_f32 v80, v56, v57
M v[116:119], a[176:179], a[136:139], v[116:119]
buffer_load_dword v23, s[8:11], s24 offen offset:256 lds
v_cvt_pk_bf16_f32 v81, v58, v59
v_cvt_pk_bf16_f32 v82, v88, v89
M v[120:123], a[176:179], a[144:147], v[120:123]
v_cvt_pk_bf16_f32 v83, v90, v91
M v[120:123], a[180:183], a[148:151], v[120:123]
v_cvt_pk_bf16_f32 v40, v36, v37
v_cvt_pk_bf16_f32 v41, v38, v39
M v[124:127], a[180:183], a[156:159], v[124:127]
s_add_u32 m0, s29, 2048
s_nop 0
buffer_load_dwordx4 v2, s[8:11], s23 offen offset:0 lds
v_cvt_pk_bf16_f32 v42, v68, v69
v_cvt_pk_bf16_f32 v43, v70, v71
M v[124:127], a[176:179], a[152:155], v[124:127]
v_cvt_pk_bf16_f32 v72, v52, v53
M v[128:131], a[184:187], a[96:99], v[128:131]
v_cvt_pk_bf16_f32 v73, v54, v55
v_cvt_pk_bf16_f32 v74, v84, v85
M v[128:131], a[188:191], a[100:103], v[128:131]
ds_read_b128 a[168:171], v10 offset:51200
ds_read_b128 a[172:175], v11 offset:51200
v_cvt_pk_bf16_f32 v75, v86, v87
M v[132:135], a[188:191], a[108:111], v[132:135]
v_cvt_pk_bf16_f32 v56, v44, v45
v_cvt_pk_bf16_f32 v57, v46, v47
M v[132:135], a[184:187], a[104:107], v[132:135]
buffer_load_dwordx4 v3, s[8:11], s23 offen offset:1024 lds
v_cvt_pk_bf16_f32 v58, v76, v77
v_cvt_pk_bf16_f32 v59, v78, v79
M v[136:139], a[184:187], a[112:115], v[136:139]
v_cvt_pk_bf16_f32 v88, v60, v61
M v[136:139], a[188:191], a[116:119], v[136:139]
v_cvt_pk_bf16_f32 v89, v62, v63
v_cvt_pk_bf16_f32 v90, v92, v93
M v[140:143], a[188:191], a[124:127], v[140:143]
buffer_load_dwordx4 v4, s[8:11], s23 offen offset:2048 lds
v_cvt_pk_bf16_f32 v91, v94, v95
M v[140:143], a[184:187], a[120:123], v[140:143]
M v[144:147], a[184:187], a[128:131], v[144:147]
M v[144:147], a[188:191], a[132:135], v[144:147]
buffer_load_dwordx4 v5, s[8:11], s23 offen offset:3072 lds
M v[148:151], a[188:191], a[140:143], v[148:151]
s_add_u32 s94, s92, 0
buffer_store_dwordx4 v[32:35], v1, s[16:19], s94 offen offset:0 sc1
M v[148:151], a[184:187], a[136:139], v[148:151]
M v[152:155], a[184:187], a[144:147], v[152:155]
M v[152:155], a[188:191], a[148:151], v[152:155]
s_sub_u32 s31, s31, 1
s_cmp_eq_u32 s31, 0
s_cselect_b32 s58, -1920, s57
s_add_u32 s23, s23, s58
s_add_u32 s24, s24, s58
M v[156:159], a[188:191], a[156:159], v[156:159]
s_add_u32 s94, s92, 0
buffer_store_dwordx4 v[40:43], v1, s[16:19], s94 offen offset:1024 sc1
M v[156:159], a[184:187], a[152:155], v[156:159]
s_waitcnt lgkmcnt(2)
M v[160:163], a[160:163], a[96:99], v[160:163]
M v[160:163], a[164:167], a[100:103], v[160:163]
ds_read_b128 a[176:179], v10 offset:53248
ds_read_b128 a[180:183], v11 offset:53248
M v[164:167], a[164:167], a[108:111], v[164:167]
s_add_u32 s94, s92, 0
buffer_store_dwordx4 v[48:51], v1, s[16:19], s94 offen offset:2048 sc1
M v[164:167], a[160:163], a[104:107], v[164:167]
v_cvt_pk_bf16_f32 v96, v96, v97
v_cvt_pk_bf16_f32 v97, v98, v99
M v[168:171], a[160:163], a[112:115], v[168:171]
v_cvt_pk_bf16_f32 v98, v128, v129
v_cvt_pk_bf16_f32 v99, v130, v131
M v[168:171], a[164:167], a[116:119], v[168:171]
s_add_u32 m0, s30, 98304
s_nop 0
buffer_load_dwordx4 v6, s[12:15], s25 offen offset:0 lds
v_cvt_pk_bf16_f32 v128, v112, v113
M v[172:175], a[164:167], a[124:127], v[172:175]
s_add_u32 s94, s92, 0
buffer_store_dwordx4 v[56:59], v1, s[16:19], s94 offen offset:3072 sc1
v_cvt_pk_bf16_f32 v129, v114, v115
v_cvt_pk_bf16_f32 v130, v144, v145
M v[172:175], a[160:163], a[120:123], v[172:175]
v_cvt_pk_bf16_f32 v131, v146, v147
M v[176:179], a[160:163], a[128:131], v[176:179]
v_cvt_pk_bf16_f32 v112, v104, v105
v_cvt_pk_bf16_f32 v113, v106, v107
M v[176:179], a[164:167], a[132:135], v[176:179]
buffer_load_dwordx4 v7, s[12:15], s25 offen offset:1024 lds
v_cvt_pk_bf16_f32 v114, v136, v137
v_cvt_pk_bf16_f32 v115, v138, v139
M v[180:183], a[164:167], a[140:143], v[180:183]
s_add_u32 s94, s92, 4096
buffer_store_dwordx4 v[64:67], v1, s[16:19], s94 offen offset:0 sc1
v_cvt_pk_bf16_f32 v144, v120, v121
M v[180:183], a[160:163], a[136:139], v[180:183]
v_cvt_pk_bf16_f32 v145, v122, v123
v_cvt_pk_bf16_f32 v146, v152, v153
M v[184:187], a[160:163], a[144:147], v[184:187]
v_cvt_pk_bf16_f32 v147, v154, v155
M v[184:187], a[164:167], a[148:151], v[184:187]
buffer_load_dwordx4 v8, s[12:15], s25 offen offset:2048 lds
v_cvt_pk_bf16_f32 v104, v100, v101
v_cvt_pk_bf16_f32 v105, v102, v103
M v[188:191], a[164:167], a[156:159], v[188:191]
s_add_u32 s94, s92, 4096
buffer_store_dwordx4 v[72:75], v1, s[16:19], s94 offen offset:1024 sc1
v_cvt_pk_bf16_f32 v106, v132, v133
v_cvt_pk_bf16_f32 v107, v134, v135
M v[188:191], a[160:163], a[152:155], v[188:191]
s_waitcnt lgkmcnt(2)
v_cvt_pk_bf16_f32 v136, v116, v117
M v[192:195], a[168:171], a[96:99], v[192:195]
v_cvt_pk_bf16_f32 v137, v118, v119
v_cvt_pk_bf16_f32 v138, v148, v149
M v[192:195], a[172:175], a[100:103], v[192:195]
ds_read_b128 a[184:187], v10 offset:55296
ds_read_b128 a[188:191], v11 offset:55296
v_cvt_pk_bf16_f32 v139, v150, v151
M v[196:199], a[172:175], a[108:111], v[196:199]
s_add_u32 s94, s92, 4096
buffer_store_dwordx4 v[80:83], v1, s[16:19], s94 offen offset:2048 sc1
v_cvt_pk_bf16_f32 v120, v108, v109
v_cvt_pk_bf16_f32 v121, v110, v111
M v[196:199], a[168:171], a[104:107], v[196:199]
v_cvt_pk_bf16_f32 v122, v140, v141
v_cvt_pk_bf16_f32 v123, v142, v143
M v[200:203], a[168:171], a[112:115], v[200:203]
buffer_load_dwordx4 v9, s[12:15], s25 offen offset:3072 lds
v_cvt_pk_bf16_f32 v152, v124, v125
M v[200:203], a[172:175], a[116:119], v[200:203]
v_cvt_pk_bf16_f32 v153, v126, v127
v_cvt_pk_bf16_f32 v154, v156, v157
M v[204:207], a[172:175], a[124:127], v[204:207]
s_add_u32 s94, s92, 4096
buffer_store_dwordx4 v[88:91], v1, s[16:19], s94 offen offset:3072 sc1
v_cvt_pk_bf16_f32 v155, v158, v159
M v[204:207], a[168:171], a[120:123], v[204:207]
M v[208:211], a[168:171], a[128:131], v[208:211]
s_add_u32 m0, s30, 102400
s_nop 0
buffer_load_dwordx4 v21, s[12:15], s25 offen offset:0 lds
M v[208:211], a[172:175], a[132:135], v[208:211]
M v[212:215], a[172:175], a[140:143], v[212:215]
M v[212:215], a[168:171], a[136:139], v[212:215]
buffer_load_dwordx4 v22, s[12:15], s25 offen offset:1024 lds
M v[216:219], a[168:171], a[144:147], v[216:219]
s_add_u32 s94, s92, 8192
buffer_store_dwordx4 v[96:99], v1, s[16:19], s94 offen offset:0 sc1
M v[216:219], a[172:175], a[148:151], v[216:219]
M v[220:223], a[172:175], a[156:159], v[220:223]
M v[220:223], a[168:171], a[152:155], v[220:223]
s_waitcnt lgkmcnt(2)
M v[224:227], a[176:179], a[96:99], v[224:227]
s_sub_u32 s54, s54, 1
s_cmp_eq_u32 s54, 0
s_cselect_b32 s58, s55, s56
s_add_u32 s25, s25, s58
M v[224:227], a[180:183], a[100:103], v[224:227]
M v[228:231], a[180:183], a[108:111], v[228:231]
s_add_u32 s94, s92, 8192
buffer_store_dwordx4 v[104:107], v1, s[16:19], s94 offen offset:1024 sc1
M v[228:231], a[176:179], a[104:107], v[228:231]
v_cvt_pk_bf16_f32 v160, v160, v161
v_cvt_pk_bf16_f32 v161, v162, v163
M v[232:235], a[176:179], a[112:115], v[232:235]
v_cvt_pk_bf16_f32 v162, v192, v193
v_cvt_pk_bf16_f32 v163, v194, v195
M v[232:235], a[180:183], a[116:119], v[232:235]
v_cvt_pk_bf16_f32 v192, v176, v177
M v[236:239], a[180:183], a[124:127], v[236:239]
v_cvt_pk_bf16_f32 v193, v178, v179
v_cvt_pk_bf16_f32 v194, v208, v209
M v[236:239], a[176:179], a[120:123], v[236:239]
s_waitcnt vmcnt(63) lgkmcnt(0)
s_barrier
v_cvt_pk_bf16_f32 v195, v210, v211
M v[240:243], a[176:179], a[128:131], v[240:243]
s_add_u32 s94, s92, 8192
buffer_store_dwordx4 v[112:115], v1, s[16:19], s94 offen offset:2048 sc1
v_cvt_pk_bf16_f32 v176, v168, v169
v_cvt_pk_bf16_f32 v177, v170, v171
M v[240:243], a[180:183], a[132:135], v[240:243]
s_add_u32 m0, s28, 18432
s_nop 0
buffer_load_dword v20, s[8:11], s24 offen lds
v_cvt_pk_bf16_f32 v178, v200, v201
v_cvt_pk_bf16_f32 v179, v202, v203
M v[244:247], a[180:183], a[140:143], v[244:247]
v_cvt_pk_bf16_f32 v208, v184, v185
M v[244:247], a[176:179], a[136:139], v[244:247]
v_cvt_pk_bf16_f32 v209, v186, v187
v_cvt_pk_bf16_f32 v210, v216, v217
M v[248:251], a[176:179], a[144:147], v[248:251]
buffer_load_dword v23, s[8:11], s24 offen offset:256 lds
v_cvt_pk_bf16_f32 v211, v218, v219
M v[248:251], a[180:183], a[148:151], v[248:251]
v_cvt_pk_bf16_f32 v168, v164, v165
v_cvt_pk_bf16_f32 v169, v166, v167
M v[252:255], a[180:183], a[156:159], v[252:255]
s_add_u32 s94, s92, 8192
buffer_store_dwordx4 v[120:123], v1, s[16:19], s94 offen offset:3072 sc1
v_cvt_pk_bf16_f32 v170, v196, v197
v_cvt_pk_bf16_f32 v171, v198, v199
M v[252:255], a[176:179], a[152:155], v[252:255]
v_cvt_pk_bf16_f32 v200, v180, v181
M a[0:3], a[184:187], a[96:99], a[0:3]
v_cvt_pk_bf16_f32 v201, v182, v183
v_cvt_pk_bf16_f32 v202, v212, v213
M a[0:3], a[188:191], a[100:103], a[0:3]
s_add_u32 m0, s29, 20480
s_nop 0
buffer_load_dwordx4 v2, s[8:11], s23 offen offset:0 lds
v_cvt_pk_bf16_f32 v203, v214, v215
M a[4:7], a[188:191], a[108:111], a[4:7]
v_cvt_pk_bf16_f32 v184, v172, v173
v_cvt_pk_bf16_f32 v185, v174, v175
M a[4:7], a[184:187], a[104:107], a[4:7]
v_cvt_pk_bf16_f32 v186, v204, v205
v_cvt_pk_bf16_f32 v187, v206, v207
M a[8:11], a[184:187], a[112:115], a[8:11]
s_add_u32 s94, s92, 12288
buffer_store_dwordx4 v[128:131], v1, s[16:19], s94 offen offset:0 sc1
v_cvt_pk_bf16_f32 v216, v188, v189
M a[8:11], a[188:191], a[116:119], a[8:11]
buffer_load_dwordx4 v3, s[8:11], s23 offen offset:1024 lds
v_cvt_pk_bf16_f32 v217, v190, v191
v_cvt_pk_bf16_f32 v218, v220, v221
M a[12:15], a[188:191], a[124:127], a[12:15]
v_cvt_pk_bf16_f32 v219, v222, v223
M a[12:15], a[184:187], a[120:123], a[12:15]
M a[16:19], a[184:187], a[128:131], a[16:19]
buffer_load_dwordx4 v4, s[8:11], s23 offen offset:2048 lds
M a[16:19], a[188:191], a[132:135], a[16:19]
M a[20:23], a[188:191], a[140:143], a[20:23]
s_add_u32 s94, s92, 12288
buffer_store_dwordx4 v[136:139], v1, s[16:19], s94 offen offset:1024 sc1
M a[20:23], a[184:187], a[136:139], a[20:23]
M a[24:27], a[184:187], a[144:147], a[24:27]
buffer_load_dwordx4 v5, s[8:11], s23 offen offset:3072 lds
M a[24:27], a[188:191], a[148:151], a[24:27]
M a[28:31], a[188:191], a[156:159], a[28:31]
M a[28:31], a[184:187], a[152:155], a[28:31]
v_accvgpr_read_b32 v24, a0
v_accvgpr_read_b32 v25, a1
v_accvgpr_read_b32 v26, a2
v_accvgpr_read_b32 v27, a3
v_cvt_pk_bf16_f32 v224, v224, v225
v_cvt_pk_bf16_f32 v225, v226, v227
v_cvt_pk_bf16_f32 v226, v24, v25
v_cvt_pk_bf16_f32 v227, v26, v27
v_accvgpr_read_b32 v24, a16
v_accvgpr_read_b32 v25, a17
v_accvgpr_read_b32 v26, a18
v_accvgpr_read_b32 v27, a19
v_cvt_pk_bf16_f32 v36, v240, v241
v_cvt_pk_bf16_f32 v37, v242, v243
v_cvt_pk_bf16_f32 v38, v24, v25
v_cvt_pk_bf16_f32 v39, v26, v27
v_accvgpr_read_b32 v24, a24
v_accvgpr_read_b32 v25, a25
v_accvgpr_read_b32 v26, a26
v_accvgpr_read_b32 v27, a27
v_cvt_pk_bf16_f32 v52, v248, v249
v_cvt_pk_bf16_f32 v53, v250, v251
v_cvt_pk_bf16_f32 v54, v24, v25
v_cvt_pk_bf16_f32 v55, v26, v27
v_accvgpr_read_b32 v24, a8
v_accvgpr_read_b32 v25, a9
v_accvgpr_read_b32 v26, a10
v_accvgpr_read_b32 v27, a11
v_cvt_pk_bf16_f32 v240, v232, v233
v_cvt_pk_bf16_f32 v241, v234, v235
v_cvt_pk_bf16_f32 v242, v24, v25
v_cvt_pk_bf16_f32 v243, v26, v27
v_accvgpr_read_b32 v28, a4
v_accvgpr_read_b32 v29, a5
v_accvgpr_read_b32 v30, a6
v_accvgpr_read_b32 v31, a7
v_cvt_pk_bf16_f32 v232, v228, v229
v_cvt_pk_bf16_f32 v233, v230, v231
v_cvt_pk_bf16_f32 v234, v28, v29
v_cvt_pk_bf16_f32 v235, v30, v31
v_accvgpr_read_b32 v28, a12
v_accvgpr_read_b32 v29, a13
v_accvgpr_read_b32 v30, a14
v_accvgpr_read_b32 v31, a15
v_cvt_pk_bf16_f32 v248, v236, v237
v_cvt_pk_bf16_f32 v249, v238, v239
v_cvt_pk_bf16_f32 v250, v28, v29
v_cvt_pk_bf16_f32 v251, v30, v31
v_accvgpr_read_b32 v28, a20
v_accvgpr_read_b32 v29, a21
v_accvgpr_read_b32 v30, a22
v_accvgpr_read_b32 v31, a23
v_cvt_pk_bf16_f32 v44, v244, v245
v_cvt_pk_bf16_f32 v45, v246, v247
v_cvt_pk_bf16_f32 v46, v28, v29
v_cvt_pk_bf16_f32 v47, v30, v31
v_accvgpr_read_b32 v28, a28
v_accvgpr_read_b32 v29, a29
v_accvgpr_read_b32 v30, a30
v_accvgpr_read_b32 v31, a31
v_cvt_pk_bf16_f32 v60, v252, v253
v_cvt_pk_bf16_f32 v61, v254, v255
v_cvt_pk_bf16_f32 v62, v28, v29
v_cvt_pk_bf16_f32 v63, v30, v31
Lk1_b:
v_and_b32 v24, 15, v0
v_lshlrev_b32 v24, 7, v24
v_bfe_u32 v25, v0, 1, 3
v_lshrrev_b32 v26, 4, v0
v_xor_b32 v25, v25, v26
v_lshl_add_u32 v10, v25, 4, v24
v_xor_b32 v11, 64, v10
v_add_u32 v12, 131072, v10
v_add_u32 v13, 131072, v11
v_bfe_u32 v24, v0, 2, 2
v_lshl_add_u32 v29, v26, 3, v24
v_mul_u32_u24 v25, 384, v29
v_and_b32 v27, 1, v0
v_lshl_add_u32 v25, v27, 3, v25
v_add_u32 v25, 36864, v25
v_lshrrev_b32 v24, 1, v29
v_and_b32 v24, 4, v24
v_and_or_b32 v24, v29, 2, v24
v_bfe_u32 v26, v0, 1, 1
s_mul_i32 s4, s20, 3
s_add_u32 s3, s4, 0
s_and_b32 s5, s3, 3
s_lshl_b32 s5, s5, 1
s_lshr_b32 s3, s3, 2
s_lshl_b32 s3, s3, 7
v_add_u32 v27, s5, v26
v_xor_b32 v27, v27, v24
v_lshl_add_u32 v27, v27, 4, v25
v_add_u32 v14, s3, v27
v_add_u32 v17, 61440, v14
s_add_u32 s3, s4, 1
s_and_b32 s5, s3, 3
s_lshl_b32 s5, s5, 1
s_lshr_b32 s3, s3, 2
s_lshl_b32 s3, s3, 7
v_add_u32 v27, s5, v26
v_xor_b32 v27, v27, v24
v_lshl_add_u32 v27, v27, 4, v25
v_add_u32 v15, s3, v27
v_add_u32 v18, 61440, v15
s_add_u32 s3, s4, 2
s_and_b32 s5, s3, 3
s_lshl_b32 s5, s5, 1
s_lshr_b32 s3, s3, 2
s_lshl_b32 s3, s3, 7
v_add_u32 v27, s5, v26
v_xor_b32 v27, v27, v24
v_lshl_add_u32 v27, v27, 4, v25
v_add_u32 v16, s3, v27
v_add_u32 v19, 61440, v16
s_waitcnt vmcnt(11)
s_barrier
ds_read_b64_tr_b16 a[176:177], v14 offset:28672
ds_read_b64_tr_b16 a[178:179], v14 offset:30208
ds_read_b64_tr_b16 a[184:185], v15 offset:28672
ds_read_b64_tr_b16 a[186:187], v15 offset:30208
ds_read_b64_tr_b16 a[192:193], v16 offset:28672
ds_read_b64_tr_b16 a[194:195], v16 offset:30208
ds_read_b64_tr_b16 a[180:181], v14 offset:40960
ds_read_b64_tr_b16 a[182:183], v14 offset:42496
ds_read_b64_tr_b16 a[188:189], v15 offset:40960
ds_read_b64_tr_b16 a[190:191], v15 offset:42496
ds_read_b64_tr_b16 a[196:197], v16 offset:40960
ds_read_b64_tr_b16 a[198:199], v16 offset:42496
ds_read_b128 a[224:227], v12 offset:0
ds_read_b128 a[228:231], v13 offset:0
ds_read_b128 a[232:235], v12 offset:2048
ds_read_b128 a[236:239], v13 offset:2048
ds_read_b128 a[240:243], v12 offset:4096
ds_read_b128 a[244:247], v13 offset:4096
s_waitcnt lgkmcnt(0)
s_barrier
M a[68:71], a[176:179], a[224:227], 0
ds_read_b128 a[248:251], v12 offset:6144
ds_read_b128 a[252:255], v13 offset:6144
M a[68:71], a[180:183], a[228:231], a[68:71]
s_sub_u32 s31, s31, 1
s_cmp_eq_u32 s31, 0
s_cselect_b32 s58, -1920, s57
s_add_u32 s23, s23, s58
s_add_u32 s24, s24, s58
M a[72:75], a[188:191], a[228:231], 0
ds_read_b64_tr_b16 a[200:201], v17 offset:0
ds_read_b64_tr_b16 a[202:203], v17 offset:1536
M a[72:75], a[184:187], a[224:227], a[72:75]
s_add_u32 m0, s30, 36864
s_nop 0
buffer_load_dwordx4 v6, s[12:15], s25 offen offset:0 lds
M a[76:79], a[192:195], a[224:227], 0
M a[76:79], a[196:199], a[228:231], a[76:79]
buffer_load_dwordx4 v7, s[12:15], s25 offen offset:1024 lds
M a[80:83], a[180:183], a[236:239], 0
ds_read_b128 a[224:227], v12 offset:8192
ds_read_b128 a[228:231], v13 offset:8192
M a[80:83], a[176:179], a[232:235], a[80:83]
M a[84:87], a[184:187], a[232:235], 0
ds_read_b64_tr_b16 a[208:209], v18 offset:0
ds_read_b64_tr_b16 a[210:211], v18 offset:1536
M a[84:87], a[188:191], a[236:239], a[84:87]
buffer_load_dwordx4 v8, s[12:15], s25 offen offset:2048 lds
M a[88:91], a[196:199], a[236:239], 0
M a[88:91], a[192:195], a[232:235], a[88:91]
buffer_load_dwordx4 v9, s[12:15], s25 offen offset:3072 lds
M a[92:95], a[176:179], a[240:243], 0
ds_read_b128 a[232:235], v12 offset:10240
ds_read_b128 a[236:239], v13 offset:10240
M a[92:95], a[180:183], a[244:247], a[92:95]
M a[96:99], a[188:191], a[244:247], 0
ds_read_b64_tr_b16 a[216:217], v19 offset:0
ds_read_b64_tr_b16 a[218:219], v19 offset:1536
M a[96:99], a[184:187], a[240:243], a[96:99]
s_add_u32 m0, s30, 40960
s_nop 0
buffer_load_dwordx4 v21, s[12:15], s25 offen offset:0 lds
M a[100:103], a[192:195], a[240:243], 0
buffer_load_dwordx4 v22, s[12:15], s25 offen offset:1024 lds
M a[100:103], a[196:199], a[244:247], a[100:103]
s_waitcnt lgkmcnt(10)
M a[104:107], a[180:183], a[252:255], 0
ds_read_b128 a[240:243], v12 offset:12288
ds_read_b128 a[244:247], v13 offset:12288
M a[104:107], a[176:179], a[248:251], a[104:107]
s_sub_u32 s54, s54, 1
s_cmp_eq_u32 s54, 0
s_cselect_b32 s58, s55, s56
s_add_u32 s25, s25, s58
M a[108:111], a[184:187], a[248:251], 0
ds_read_b64_tr_b16 a[204:205], v17 offset:12288
ds_read_b64_tr_b16 a[206:207], v17 offset:13824
M a[108:111], a[188:191], a[252:255], a[108:111]
M a[112:115], a[196:199], a[252:255], 0
s_add_u32 m0, s30, 65536
s_nop 0
buffer_load_dwordx4 v6, s[12:15], s25 offen offset:0 lds
M a[112:115], a[192:195], a[248:251], a[112:115]
s_waitcnt lgkmcnt(10)
M a[116:119], a[176:179], a[224:227], 0
ds_read_b128 a[248:251], v12 offset:14336
ds_read_b128 a[252:255], v13 offset:14336
M a[116:119], a[180:183], a[228:231], a[116:119]
buffer_load_dwordx4 v7, s[12:15], s25 offen offset:1024 lds
M a[120:123], a[188:191], a[228:231], 0
ds_read_b64_tr_b16 a[212:213], v18 offset:12288
ds_read_b64_tr_b16 a[214:215], v18 offset:13824
M a[120:123], a[184:187], a[224:227], a[120:123]
M a[124:127], a[192:195], a[224:227], 0
buffer_load_dwordx4 v8, s[12:15], s25 offen offset:2048 lds
M a[124:127], a[196:199], a[228:231], a[124:127]
buffer_load_dwordx4 v9, s[12:15], s25 offen offset:3072 lds
s_waitcnt lgkmcnt(10)
M a[128:131], a[180:183], a[236:239], 0
ds_read_b128 a[224:227], v12 offset:16384
ds_read_b128 a[228:231], v13 offset:16384
M a[128:131], a[176:179], a[232:235], a[128:131]
M a[132:135], a[184:187], a[232:235], 0
ds_read_b64_tr_b16 a[220:221], v19 offset:12288
ds_read_b64_tr_b16 a[222:223], v19 offset:13824
M a[132:135], a[188:191], a[236:239], a[132:135]
s_add_u32 m0, s30, 69632
s_nop 0
buffer_load_dwordx4 v21, s[12:15], s25 offen offset:0 lds
M a[136:139], a[196:199], a[236:239], 0
M a[136:139], a[192:195], a[232:235], a[136:139]
buffer_load_dwordx4 v22, s[12:15], s25 offen offset:1024 lds
s_waitcnt lgkmcnt(10)
M a[140:143], a[176:179], a[240:243], 0
M a[140:143], a[180:183], a[244:247], a[140:143]
s_sub_u32 s54, s54, 1
s_cmp_eq_u32 s54, 0
s_cselect_b32 s58, s55, s56
s_add_u32 s25, s25, s58
M a[144:147], a[188:191], a[244:247], 0
M a[144:147], a[184:187], a[240:243], a[144:147]
M a[148:151], a[192:195], a[240:243], 0
s_waitcnt vmcnt(6) lgkmcnt(0)
s_barrier
ds_read_b128 a[232:235], v10 offset:0
ds_read_b128 a[236:239], v11 offset:0
M a[148:151], a[196:199], a[244:247], a[148:151]
s_add_u32 m0, s28, 131072
s_nop 0
buffer_load_dword v20, s[8:11], s24 offen lds
M a[152:155], a[180:183], a[252:255], 0
ds_read_b128 a[240:243], v10 offset:2048
ds_read_b128 a[244:247], v11 offset:2048
M a[152:155], a[176:179], a[248:251], a[152:155]
M a[156:159], a[184:187], a[248:251], 0
buffer_load_dword v23, s[8:11], s24 offen offset:256 lds
M a[156:159], a[188:191], a[252:255], a[156:159]
M a[160:163], a[196:199], a[252:255], 0
M a[160:163], a[192:195], a[248:251], a[160:163]
s_add_u32 m0, s29, 133120
s_nop 0
buffer_load_dwordx4 v2, s[8:11], s23 offen offset:0 lds
M a[164:167], a[176:179], a[224:227], 0
ds_read_b128 a[248:251], v10 offset:4096
ds_read_b128 a[252:255], v11 offset:4096
M a[164:167], a[180:183], a[228:231], a[164:167]
M a[168:171], a[188:191], a[228:231], 0
M a[168:171], a[184:187], a[224:227], a[168:171]
buffer_load_dwordx4 v3, s[8:11], s23 offen offset:1024 lds
M a[172:175], a[192:195], a[224:227], 0
M a[172:175], a[196:199], a[228:231], a[172:175]
s_waitcnt lgkmcnt(4)
M a[68:71], a[200:203], a[232:235], a[68:71]
ds_read_b128 a[224:227], v10 offset:6144
ds_read_b128 a[228:231], v11 offset:6144
M a[68:71], a[204:207], a[236:239], a[68:71]
buffer_load_dwordx4 v4, s[8:11], s23 offen offset:2048 lds
M a[72:75], a[212:215], a[236:239], a[72:75]
ds_read_b64_tr_b16 a[176:177], v14 offset:0
ds_read_b64_tr_b16 a[178:179], v14 offset:1536
M a[72:75], a[208:211], a[232:235], a[72:75]
buffer_load_dwordx4 v5, s[8:11], s23 offen offset:3072 lds
M a[76:79], a[216:219], a[232:235], a[76:79]
M a[76:79], a[220:223], a[236:239], a[76:79]
s_sub_u32 s31, s31, 1
s_cmp_eq_u32 s31, 0
s_cselect_b32 s58, -1920, s57
s_add_u32 s23, s23, s58
s_add_u32 s24, s24, s58
s_waitcnt lgkmcnt(6)
M a[80:83], a[204:207], a[244:247], a[80:83]
ds_read_b128 a[232:235], v10 offset:8192
ds_read_b128 a[236:239], v11 offset:8192
M a[80:83], a[200:203], a[240:243], a[80:83]
M a[84:87], a[208:211], a[240:243], a[84:87]
ds_read_b64_tr_b16 a[184:185], v15 offset:0
ds_read_b64_tr_b16 a[186:187], v15 offset:1536
M a[84:87], a[212:215], a[244:247], a[84:87]
s_add_u32 m0, s30, 98304
s_nop 0
buffer_load_dwordx4 v6, s[12:15], s25 offen offset:0 lds
M a[88:91], a[220:223], a[244:247], a[88:91]
M a[88:91], a[216:219], a[240:243], a[88:91]
buffer_load_dwordx4 v7, s[12:15], s25 offen offset:1024 lds
s_waitcnt lgkmcnt(8)
M a[92:95], a[200:203], a[248:251], a[92:95]
ds_read_b128 a[240:243], v10 offset:10240
ds_read_b128 a[244:247], v11 offset:10240
M a[92:95], a[204:207], a[252:255], a[92:95]
M a[96:99], a[212:215], a[252:255], a[96:99]
ds_read_b64_tr_b16 a[192:193], v16 offset:0
ds_read_b64_tr_b16 a[194:195], v16 offset:1536
M a[96:99], a[208:211], a[248:251], a[96:99]
buffer_load_dwordx4 v8, s[12:15], s25 offen offset:2048 lds
M a[100:103], a[216:219], a[248:251], a[100:103]
M a[100:103], a[220:223], a[252:255], a[100:103]
buffer_load_dwordx4 v9, s[12:15], s25 offen offset:3072 lds
s_waitcnt lgkmcnt(10)
M a[104:107], a[204:207], a[228:231], a[104:107]
ds_read_b128 a[248:251], v10 offset:12288
ds_read_b128 a[252:255], v11 offset:12288
M a[104:107], a[200:203], a[224:227], a[104:107]
M a[108:111], a[208:211], a[224:227], a[108:111]
ds_read_b64_tr_b16 a[180:181], v14 offset:12288
ds_read_b64_tr_b16 a[182:183], v14 offset:13824
M a[108:111], a[212:215], a[228:231], a[108:111]
s_add_u32 m0, s30, 102400
s_nop 0
buffer_load_dwordx4 v21, s[12:15], s25 offen offset:0 lds
M a[112:115], a[220:223], a[228:231], a[112:115]
M a[112:115], a[216:219], a[224:227], a[112:115]
buffer_load_dwordx4 v22, s[12:15], s25 offen offset:1024 lds
s_waitcnt lgkmcnt(10)
M a[116:119], a[200:203], a[232:235], a[116:119]
ds_read_b128 a[224:227], v10 offset:14336
ds_read_b128 a[228:231], v11 offset:14336
M a[116:119], a[204:207], a[236:239], a[116:119]
M a[120:123], a[212:215], a[236:239], a[120:123]
ds_read_b64_tr_b16 a[188:189], v15 offset:12288
ds_read_b64_tr_b16 a[190:191], v15 offset:13824
M a[120:123], a[208:211], a[232:235], a[120:123]
s_sub_u32 s54, s54, 1
s_cmp_eq_u32 s54, 0
s_cselect_b32 s58, s55, s56
s_add_u32 s25, s25, s58
M a[124:127], a[216:219], a[232:235], a[124:127]
M a[124:127], a[220:223], a[236:239], a[124:127]
s_add_u32 s94, s92, 12288
buffer_store_dwordx4 v[144:147], v1, s[16:19], s94 offen offset:2048 sc1
s_waitcnt lgkmcnt(10)
M a[128:131], a[204:207], a[244:247], a[128:131]
ds_read_b128 a[232:235], v10 offset:16384
ds_read_b128 a[236:239], v11 offset:16384
M a[128:131], a[200:203], a[240:243], a[128:131]
M a[132:135], a[208:211], a[240:243], a[132:135]
ds_read_b64_tr_b16 a[196:197], v16 offset:12288
ds_read_b64_tr_b16 a[198:199], v16 offset:13824
M a[132:135], a[212:215], a[244:247], a[132:135]
s_add_u32 s94, s92, 12288
buffer_store_dwordx4 v[152:155], v1, s[16:19], s94 offen offset:3072 sc1
M a[136:139], a[220:223], a[244:247], a[136:139]
M a[136:139], a[216:219], a[240:243], a[136:139]
s_add_u32 s94, s93, 0
buffer_store_dwordx4 v[160:163], v1, s[16:19], s94 offen offset:0 sc1
s_waitcnt lgkmcnt(10)
M a[140:143], a[200:203], a[248:251], a[140:143]
M a[140:143], a[204:207], a[252:255], a[140:143]
s_add_u32 s94, s93, 0
buffer_store_dwordx4 v[168:171], v1, s[16:19], s94 offen offset:1024 sc1
M a[144:147], a[212:215], a[252:255], a[144:147]
M a[144:147], a[208:211], a[248:251], a[144:147]
M a[148:151], a[216:219], a[248:251], a[148:151]
s_waitcnt vmcnt(16) lgkmcnt(0)
s_barrier
ds_read_b128 a[240:243], v10 offset:18432
ds_read_b128 a[244:247], v11 offset:18432
M a[148:151], a[220:223], a[252:255], a[148:151]
s_add_u32 m0, s28, 0
s_nop 0
buffer_load_dword v20, s[8:11], s24 offen lds
M a[152:155], a[204:207], a[228:231], a[152:155]
ds_read_b128 a[248:251], v10 offset:20480
ds_read_b128 a[252:255], v11 offset:20480
M a[152:155], a[200:203], a[224:227], a[152:155]
M a[156:159], a[208:211], a[224:227], a[156:159]
buffer_load_dword v23, s[8:11], s24 offen offset:256 lds
M a[156:159], a[212:215], a[228:231], a[156:159]
M a[160:163], a[220:223], a[228:231], a[160:163]
M a[160:163], a[216:219], a[224:227], a[160:163]
s_add_u32 m0, s29, 2048
s_nop 0
buffer_load_dwordx4 v2, s[8:11], s23 offen offset:0 lds
M a[164:167], a[200:203], a[232:235], a[164:167]
ds_read_b128 a[224:227], v10 offset:22528
ds_read_b128 a[228:231], v11 offset:22528
M a[164:167], a[204:207], a[236:239], a[164:167]
M a[168:171], a[212:215], a[236:239], a[168:171]
M a[168:171], a[208:211], a[232:235], a[168:171]
buffer_load_dwordx4 v3, s[8:11], s23 offen offset:1024 lds
M a[172:175], a[216:219], a[232:235], a[172:175]
M a[172:175], a[220:223], a[236:239], a[172:175]
s_waitcnt lgkmcnt(4)
M a[68:71], a[176:179], a[240:243], a[68:71]
ds_read_b128 a[232:235], v10 offset:24576
ds_read_b128 a[236:239], v11 offset:24576
M a[68:71], a[180:183], a[244:247], a[68:71]
buffer_load_dwordx4 v4, s[8:11], s23 offen offset:2048 lds
M a[72:75], a[188:191], a[244:247], a[72:75]
ds_read_b64_tr_b16 a[200:201], v14 offset:28672
ds_read_b64_tr_b16 a[202:203], v14 offset:30208
M a[72:75], a[184:187], a[240:243], a[72:75]
buffer_load_dwordx4 v5, s[8:11], s23 offen offset:3072 lds
M a[76:79], a[192:195], a[240:243], a[76:79]
M a[76:79], a[196:199], a[244:247], a[76:79]
s_sub_u32 s31, s31, 1
s_cmp_eq_u32 s31, 0
s_cselect_b32 s58, -1920, s57
s_add_u32 s23, s23, s58
s_add_u32 s24, s24, s58
s_waitcnt lgkmcnt(6)
M a[80:83], a[180:183], a[252:255], a[80:83]
ds_read_b128 a[240:243], v10 offset:26624
ds_read_b128 a[244:247], v11 offset:26624
M a[80:83], a[176:179], a[248:251], a[80:83]
M a[84:87], a[184:187], a[248:251], a[84:87]
ds_read_b64_tr_b16 a[208:209], v15 offset:28672
ds_read_b64_tr_b16 a[210:211], v15 offset:30208
M a[84:87], a[188:191], a[252:255], a[84:87]
s_add_u32 m0, s30, 36864
s_nop 0
buffer_load_dwordx4 v6, s[12:15], s25 offen offset:0 lds
M a[88:91], a[196:199], a[252:255], a[88:91]
M a[88:91], a[192:195], a[248:251], a[88:91]
buffer_load_dwordx4 v7, s[12:15], s25 offen offset:1024 lds
s_waitcnt lgkmcnt(8)
M a[92:95], a[176:179], a[224:227], a[92:95]
ds_read_b128 a[248:251], v10 offset:28672
ds_read_b128 a[252:255], v11 offset:28672
M a[92:95], a[180:183], a[228:231], a[92:95]
M a[96:99], a[188:191], a[228:231], a[96:99]
ds_read_b64_tr_b16 a[216:217], v16 offset:28672
ds_read_b64_tr_b16 a[218:219], v16 offset:30208
M a[96:99], a[184:187], a[224:227], a[96:99]
buffer_load_dwordx4 v8, s[12:15], s25 offen offset:2048 lds
M a[100:103], a[192:195], a[224:227], a[100:103]
M a[100:103], a[196:199], a[228:231], a[100:103]
buffer_load_dwordx4 v9, s[12:15], s25 offen offset:3072 lds
s_waitcnt lgkmcnt(10)
M a[104:107], a[180:183], a[236:239], a[104:107]
ds_read_b128 a[224:227], v10 offset:30720
ds_read_b128 a[228:231], v11 offset:30720
M a[104:107], a[176:179], a[232:235], a[104:107]
M a[108:111], a[184:187], a[232:235], a[108:111]
ds_read_b64_tr_b16 a[204:205], v14 offset:40960
ds_read_b64_tr_b16 a[206:207], v14 offset:42496
M a[108:111], a[188:191], a[236:239], a[108:111]
s_add_u32 m0, s30, 40960
s_nop 0
buffer_load_dwordx4 v21, s[12:15], s25 offen offset:0 lds
M a[112:115], a[196:199], a[236:239], a[112:115]
M a[112:115], a[192:195], a[232:235], a[112:115]
buffer_load_dwordx4 v22, s[12:15], s25 offen offset:1024 lds
s_waitcnt lgkmcnt(10)
M a[116:119], a[176:179], a[240:243], a[116:119]
ds_read_b128 a[232:235], v10 offset:32768
ds_read_b128 a[236:239], v11 offset:32768
M a[116:119], a[180:183], a[244:247], a[116:119]
M a[120:123], a[188:191], a[244:247], a[120:123]
ds_read_b64_tr_b16 a[212:213], v15 offset:40960
ds_read_b64_tr_b16 a[214:215], v15 offset:42496
M a[120:123], a[184:187], a[240:243], a[120:123]
s_sub_u32 s54, s54, 1
s_cmp_eq_u32 s54, 0
s_cselect_b32 s58, s55, s56
s_add_u32 s25, s25, s58
M a[124:127], a[192:195], a[240:243], a[124:127]
M a[124:127], a[196:199], a[244:247], a[124:127]
s_add_u32 s94, s93, 0
buffer_store_dwordx4 v[176:179], v1, s[16:19], s94 offen offset:2048 sc1
s_waitcnt lgkmcnt(10)
M a[128:131], a[180:183], a[252:255], a[128:131]
ds_read_b128 a[240:243], v10 offset:34816
ds_read_b128 a[244:247], v11 offset:34816
M a[128:131], a[176:179], a[248:251], a[128:131]
M a[132:135], a[184:187], a[248:251], a[132:135]
ds_read_b64_tr_b16 a[220:221], v16 offset:40960
ds_read_b64_tr_b16 a[222:223], v16 offset:42496
M a[132:135], a[188:191], a[252:255], a[132:135]
s_add_u32 s94, s93, 0
buffer_store_dwordx4 v[184:187], v1, s[16:19], s94 offen offset:3072 sc1
M a[136:139], a[196:199], a[252:255], a[136:139]
M a[136:139], a[192:195], a[248:251], a[136:139]
s_add_u32 s94, s93, 4096
buffer_store_dwordx4 v[192:195], v1, s[16:19], s94 offen offset:0 sc1
s_waitcnt lgkmcnt(10)
M a[140:143], a[176:179], a[224:227], a[140:143]
M a[140:143], a[180:183], a[228:231], a[140:143]
s_add_u32 s94, s93, 4096
buffer_store_dwordx4 v[200:203], v1, s[16:19], s94 offen offset:1024 sc1
M a[144:147], a[188:191], a[228:231], a[144:147]
M a[144:147], a[184:187], a[224:227], a[144:147]
M a[148:151], a[192:195], a[224:227], a[148:151]
s_waitcnt vmcnt(20) lgkmcnt(0)
s_barrier
ds_read_b128 a[248:251], v12 offset:0
ds_read_b128 a[252:255], v13 offset:0
M a[148:151], a[196:199], a[228:231], a[148:151]
s_add_u32 m0, s28, 18432
s_nop 0
buffer_load_dword v20, s[8:11], s24 offen lds
M a[152:155], a[180:183], a[236:239], a[152:155]
ds_read_b128 a[224:227], v12 offset:2048
ds_read_b128 a[228:231], v13 offset:2048
M a[152:155], a[176:179], a[232:235], a[152:155]
M a[156:159], a[184:187], a[232:235], a[156:159]
buffer_load_dword v23, s[8:11], s24 offen offset:256 lds
M a[156:159], a[188:191], a[236:239], a[156:159]
M a[160:163], a[196:199], a[236:239], a[160:163]
M a[160:163], a[192:195], a[232:235], a[160:163]
s_add_u32 m0, s29, 20480
s_nop 0
buffer_load_dwordx4 v2, s[8:11], s23 offen offset:0 lds
M a[164:167], a[176:179], a[240:243], a[164:167]
ds_read_b128 a[232:235], v12 offset:4096
ds_read_b128 a[236:239], v13 offset:4096
M a[164:167], a[180:183], a[244:247], a[164:167]
M a[168:171], a[188:191], a[244:247], a[168:171]
M a[168:171], a[184:187], a[240:243], a[168:171]
buffer_load_dwordx4 v3, s[8:11], s23 offen offset:1024 lds
M a[172:175], a[192:195], a[240:243], a[172:175]
M a[172:175], a[196:199], a[244:247], a[172:175]
s_waitcnt lgkmcnt(4)
M a[68:71], a[200:203], a[248:251], a[68:71]
ds_read_b128 a[240:243], v12 offset:6144
ds_read_b128 a[244:247], v13 offset:6144
M a[68:71], a[204:207], a[252:255], a[68:71]
buffer_load_dwordx4 v4, s[8:11], s23 offen offset:2048 lds
M a[72:75], a[212:215], a[252:255], a[72:75]
ds_read_b64_tr_b16 a[176:177], v17 offset:0
ds_read_b64_tr_b16 a[178:179], v17 offset:1536
M a[72:75], a[208:211], a[248:251], a[72:75]
buffer_load_dwordx4 v5, s[8:11], s23 offen offset:3072 lds
M a[76:79], a[216:219], a[248:251], a[76:79]
M a[76:79], a[220:223], a[252:255], a[76:79]
s_sub_u32 s31, s31, 1
s_cmp_eq_u32 s31, 0
s_cselect_b32 s58, -1920, s57
s_add_u32 s23, s23, s58
s_add_u32 s24, s24, s58
s_waitcnt lgkmcnt(6)
M a[80:83], a[204:207], a[228:231], a[80:83]
ds_read_b128 a[248:251], v12 offset:8192
ds_read_b128 a[252:255], v13 offset:8192
M a[80:83], a[200:203], a[224:227], a[80:83]
M a[84:87], a[208:211], a[224:227], a[84:87]
ds_read_b64_tr_b16 a[184:185], v18 offset:0
ds_read_b64_tr_b16 a[186:187], v18 offset:1536
M a[84:87], a[212:215], a[228:231], a[84:87]
s_add_u32 m0, s30, 65536
s_nop 0
buffer_load_dwordx4 v6, s[12:15], s25 offen offset:0 lds
M a[88:91], a[220:223], a[228:231], a[88:91]
M a[88:91], a[216:219], a[224:227], a[88:91]
buffer_load_dwordx4 v7, s[12:15], s25 offen offset:1024 lds
s_waitcnt lgkmcnt(8)
M a[92:95], a[200:203], a[232:235], a[92:95]
ds_read_b128 a[224:227], v12 offset:10240
ds_read_b128 a[228:231], v13 offset:10240
M a[92:95], a[204:207], a[236:239], a[92:95]
M a[96:99], a[212:215], a[236:239], a[96:99]
ds_read_b64_tr_b16 a[192:193], v19 offset:0
ds_read_b64_tr_b16 a[194:195], v19 offset:1536
M a[96:99], a[208:211], a[232:235], a[96:99]
buffer_load_dwordx4 v8, s[12:15], s25 offen offset:2048 lds
M a[100:103], a[216:219], a[232:235], a[100:103]
M a[100:103], a[220:223], a[236:239], a[100:103]
buffer_load_dwordx4 v9, s[12:15], s25 offen offset:3072 lds
s_waitcnt lgkmcnt(10)
M a[104:107], a[204:207], a[244:247], a[104:107]
ds_read_b128 a[232:235], v12 offset:12288
ds_read_b128 a[236:239], v13 offset:12288
M a[104:107], a[200:203], a[240:243], a[104:107]
M a[108:111], a[208:211], a[240:243], a[108:111]
ds_read_b64_tr_b16 a[180:181], v17 offset:12288
ds_read_b64_tr_b16 a[182:183], v17 offset:13824
M a[108:111], a[212:215], a[244:247], a[108:111]
s_add_u32 m0, s30, 69632
s_nop 0
buffer_load_dwordx4 v21, s[12:15], s25 offen offset:0 lds
M a[112:115], a[220:223], a[244:247], a[112:115]
M a[112:115], a[216:219], a[240:243], a[112:115]
buffer_load_dwordx4 v22, s[12:15], s25 offen offset:1024 lds
s_waitcnt lgkmcnt(10)
M a[116:119], a[200:203], a[248:251], a[116:119]
ds_read_b128 a[240:243], v12 offset:14336
ds_read_b128 a[244:247], v13 offset:14336
M a[116:119], a[204:207], a[252:255], a[116:119]
M a[120:123], a[212:215], a[252:255], a[120:123]
ds_read_b64_tr_b16 a[188:189], v18 offset:12288
ds_read_b64_tr_b16 a[190:191], v18 offset:13824
M a[120:123], a[208:211], a[248:251], a[120:123]
s_sub_u32 s54, s54, 1
s_cmp_eq_u32 s54, 0
s_cselect_b32 s58, s55, s56
s_add_u32 s25, s25, s58
M a[124:127], a[216:219], a[248:251], a[124:127]
M a[124:127], a[220:223], a[252:255], a[124:127]
s_add_u32 s94, s93, 4096
buffer_store_dwordx4 v[208:211], v1, s[16:19], s94 offen offset:2048 sc1
s_waitcnt lgkmcnt(10)
M a[128:131], a[204:207], a[228:231], a[128:131]
ds_read_b128 a[248:251], v12 offset:16384
ds_read_b128 a[252:255], v13 offset:16384
M a[128:131], a[200:203], a[224:227], a[128:131]
M a[132:135], a[208:211], a[224:227], a[132:135]
ds_read_b64_tr_b16 a[196:197], v19 offset:12288
ds_read_b64_tr_b16 a[198:199], v19 offset:13824
M a[132:135], a[212:215], a[228:231], a[132:135]
s_add_u32 s94, s93, 4096
buffer_store_dwordx4 v[216:219], v1, s[16:19], s94 offen offset:3072 sc1
M a[136:139], a[220:223], a[228:231], a[136:139]
M a[136:139], a[216:219], a[224:227], a[136:139]
s_add_u32 s94, s93, 8192
buffer_store_dwordx4 v[224:227], v1, s[16:19], s94 offen offset:0 sc1
s_waitcnt lgkmcnt(10)
M a[140:143], a[200:203], a[232:235], a[140:143]
M a[140:143], a[204:207], a[236:239], a[140:143]
s_add_u32 s94, s93, 8192
buffer_store_dwordx4 v[232:235], v1, s[16:19], s94 offen offset:1024 sc1
M a[144:147], a[212:215], a[236:239], a[144:147]
M a[144:147], a[208:211], a[232:235], a[144:147]
M a[148:151], a[216:219], a[232:235], a[148:151]
s_waitcnt vmcnt(20) lgkmcnt(0)
s_barrier
ds_read_b128 a[224:227], v10 offset:0
ds_read_b128 a[228:231], v11 offset:0
M a[148:151], a[220:223], a[236:239], a[148:151]
s_add_u32 m0, s28, 131072
s_nop 0
buffer_load_dword v20, s[8:11], s24 offen lds
M a[152:155], a[204:207], a[244:247], a[152:155]
ds_read_b128 a[232:235], v10 offset:2048
ds_read_b128 a[236:239], v11 offset:2048
M a[152:155], a[200:203], a[240:243], a[152:155]
M a[156:159], a[208:211], a[240:243], a[156:159]
buffer_load_dword v23, s[8:11], s24 offen offset:256 lds
M a[156:159], a[212:215], a[244:247], a[156:159]
M a[160:163], a[220:223], a[244:247], a[160:163]
M a[160:163], a[216:219], a[240:243], a[160:163]
s_add_u32 m0, s29, 133120
s_nop 0
buffer_load_dwordx4 v2, s[8:11], s23 offen offset:0 lds
M a[164:167], a[200:203], a[248:251], a[164:167]
ds_read_b128 a[240:243], v10 offset:4096
ds_read_b128 a[244:247], v11 offset:4096
M a[164:167], a[204:207], a[252:255], a[164:167]
M a[168:171], a[212:215], a[252:255], a[168:171]
M a[168:171], a[208:211], a[248:251], a[168:171]
buffer_load_dwordx4 v3, s[8:11], s23 offen offset:1024 lds
M a[172:175], a[216:219], a[248:251], a[172:175]
M a[172:175], a[220:223], a[252:255], a[172:175]
s_waitcnt lgkmcnt(4)
M a[68:71], a[176:179], a[224:227], a[68:71]
ds_read_b128 a[248:251], v10 offset:6144
ds_read_b128 a[252:255], v11 offset:6144
M a[68:71], a[180:183], a[228:231], a[68:71]
buffer_load_dwordx4 v4, s[8:11], s23 offen offset:2048 lds
M a[72:75], a[188:191], a[228:231], a[72:75]
ds_read_b64_tr_b16 a[200:201], v14 offset:0
ds_read_b64_tr_b16 a[202:203], v14 offset:1536
M a[72:75], a[184:187], a[224:227], a[72:75]
buffer_load_dwordx4 v5, s[8:11], s23 offen offset:3072 lds
M a[76:79], a[192:195], a[224:227], a[76:79]
M a[76:79], a[196:199], a[228:231], a[76:79]
s_sub_u32 s31, s31, 1
s_cmp_eq_u32 s31, 0
s_cselect_b32 s58, -1920, s57
s_add_u32 s23, s23, s58
s_add_u32 s24, s24, s58
s_waitcnt lgkmcnt(6)
M a[80:83], a[180:183], a[236:239], a[80:83]
ds_read_b128 a[224:227], v10 offset:8192
ds_read_b128 a[228:231], v11 offset:8192
M a[80:83], a[176:179], a[232:235], a[80:83]
M a[84:87], a[184:187], a[232:235], a[84:87]
ds_read_b64_tr_b16 a[208:209], v15 offset:0
ds_read_b64_tr_b16 a[210:211], v15 offset:1536
M a[84:87], a[188:191], a[236:239], a[84:87]
s_add_u32 m0, s30, 98304
s_nop 0
buffer_load_dwordx4 v6, s[12:15], s25 offen offset:0 lds
M a[88:91], a[196:199], a[236:239], a[88:91]
M a[88:91], a[192:195], a[232:235], a[88:91]
buffer_load_dwordx4 v7, s[12:15], s25 offen offset:1024 lds
s_waitcnt lgkmcnt(8)
M a[92:95], a[176:179], a[240:243], a[92:95]
ds_read_b128 a[232:235], v10 offset:10240
ds_read_b128 a[236:239], v11 offset:10240
M a[92:95], a[180:183], a[244:247], a[92:95]
M a[96:99], a[188:191], a[244:247], a[96:99]
ds_read_b64_tr_b16 a[216:217], v16 offset:0
ds_read_b64_tr_b16 a[218:219], v16 offset:1536
M a[96:99], a[184:187], a[240:243], a[96:99]
buffer_load_dwordx4 v8, s[12:15], s25 offen offset:2048 lds
M a[100:103], a[192:195], a[240:243], a[100:103]
M a[100:103], a[196:199], a[244:247], a[100:103]
buffer_load_dwordx4 v9, s[12:15], s25 offen offset:3072 lds
s_waitcnt lgkmcnt(10)
M a[104:107], a[180:183], a[252:255], a[104:107]
ds_read_b128 a[240:243], v10 offset:12288
ds_read_b128 a[244:247], v11 offset:12288
M a[104:107], a[176:179], a[248:251], a[104:107]
M a[108:111], a[184:187], a[248:251], a[108:111]
ds_read_b64_tr_b16 a[204:205], v14 offset:12288
ds_read_b64_tr_b16 a[206:207], v14 offset:13824
M a[108:111], a[188:191], a[252:255], a[108:111]
s_add_u32 m0, s30, 102400
s_nop 0
buffer_load_dwordx4 v21, s[12:15], s25 offen offset:0 lds
M a[112:115], a[196:199], a[252:255], a[112:115]
M a[112:115], a[192:195], a[248:251], a[112:115]
buffer_load_dwordx4 v22, s[12:15], s25 offen offset:1024 lds
s_waitcnt lgkmcnt(10)
M a[116:119], a[176:179], a[224:227], a[116:119]
ds_read_b128 a[248:251], v10 offset:14336
ds_read_b128 a[252:255], v11 offset:14336
M a[116:119], a[180:183], a[228:231], a[116:119]
M a[120:123], a[188:191], a[228:231], a[120:123]
ds_read_b64_tr_b16 a[212:213], v15 offset:12288
ds_read_b64_tr_b16 a[214:215], v15 offset:13824
M a[120:123], a[184:187], a[224:227], a[120:123]
s_sub_u32 s54, s54, 1
s_cmp_eq_u32 s54, 0
s_cselect_b32 s58, s55, s56
s_add_u32 s25, s25, s58
M a[124:127], a[192:195], a[224:227], a[124:127]
M a[124:127], a[196:199], a[228:231], a[124:127]
s_add_u32 s94, s93, 8192
buffer_store_dwordx4 v[240:243], v1, s[16:19], s94 offen offset:2048 sc1
s_waitcnt lgkmcnt(10)
M a[128:131], a[180:183], a[236:239], a[128:131]
ds_read_b128 a[224:227], v10 offset:16384
ds_read_b128 a[228:231], v11 offset:16384
M a[128:131], a[176:179], a[232:235], a[128:131]
M a[132:135], a[184:187], a[232:235], a[132:135]
ds_read_b64_tr_b16 a[220:221], v16 offset:12288
ds_read_b64_tr_b16 a[222:223], v16 offset:13824
M a[132:135], a[188:191], a[236:239], a[132:135]
s_add_u32 s94, s93, 8192
buffer_store_dwordx4 v[248:251], v1, s[16:19], s94 offen offset:3072 sc1
M a[136:139], a[196:199], a[236:239], a[136:139]
M a[136:139], a[192:195], a[232:235], a[136:139]
s_add_u32 s94, s93, 12288
buffer_store_dwordx4 v[36:39], v1, s[16:19], s94 offen offset:0 sc1
s_waitcnt lgkmcnt(10)
M a[140:143], a[176:179], a[240:243], a[140:143]
M a[140:143], a[180:183], a[244:247], a[140:143]
s_add_u32 s94, s93, 12288
buffer_store_dwordx4 v[44:47], v1, s[16:19], s94 offen offset:1024 sc1
M a[144:147], a[188:191], a[244:247], a[144:147]
M a[144:147], a[184:187], a[240:243], a[144:147]
M a[148:151], a[192:195], a[240:243], a[148:151]
s_waitcnt vmcnt(20) lgkmcnt(0)
s_barrier
ds_read_b128 a[232:235], v10 offset:18432
ds_read_b128 a[236:239], v11 offset:18432
M a[148:151], a[196:199], a[244:247], a[148:151]
s_add_u32 m0, s28, 0
s_nop 0
buffer_load_dword v20, s[8:11], s24 offen lds
M a[152:155], a[180:183], a[252:255], a[152:155]
ds_read_b128 a[240:243], v10 offset:20480
ds_read_b128 a[244:247], v11 offset:20480
M a[152:155], a[176:179], a[248:251], a[152:155]
M a[156:159], a[184:187], a[248:251], a[156:159]
buffer_load_dword v23, s[8:11], s24 offen offset:256 lds
M a[156:159], a[188:191], a[252:255], a[156:159]
M a[160:163], a[196:199], a[252:255], a[160:163]
M a[160:163], a[192:195], a[248:251], a[160:163]
s_add_u32 m0, s29, 2048
s_nop 0
buffer_load_dwordx4 v2, s[8:11], s23 offen offset:0 lds
M a[164:167], a[176:179], a[224:227], a[164:167]
ds_read_b128 a[248:251], v10 offset:22528
ds_read_b128 a[252:255], v11 offset:22528
M a[164:167], a[180:183], a[228:231], a[164:167]
M a[168:171], a[188:191], a[228:231], a[168:171]
M a[168:171], a[184:187], a[224:227], a[168:171]
buffer_load_dwordx4 v3, s[8:11], s23 offen offset:1024 lds
M a[172:175], a[192:195], a[224:227], a[172:175]
M a[172:175], a[196:199], a[228:231], a[172:175]
s_waitcnt lgkmcnt(4)
M a[68:71], a[200:203], a[232:235], a[68:71]
ds_read_b128 a[224:227], v10 offset:24576
ds_read_b128 a[228:231], v11 offset:24576
M a[68:71], a[204:207], a[236:239], a[68:71]
buffer_load_dwordx4 v4, s[8:11], s23 offen offset:2048 lds
M a[72:75], a[212:215], a[236:239], a[72:75]
ds_read_b64_tr_b16 a[176:177], v14 offset:28672
ds_read_b64_tr_b16 a[178:179], v14 offset:30208
M a[72:75], a[208:211], a[232:235], a[72:75]
M a[76:79], a[216:219], a[232:235], a[76:79]
buffer_load_dwordx4 v5, s[8:11], s23 offen offset:3072 lds
M a[76:79], a[220:223], a[236:239], a[76:79]
s_waitcnt lgkmcnt(6)
M a[80:83], a[204:207], a[244:247], a[80:83]
ds_read_b128 a[232:235], v10 offset:26624
ds_read_b128 a[236:239], v11 offset:26624
M a[80:83], a[200:203], a[240:243], a[80:83]
s_sub_u32 s31, s31, 1
s_cmp_eq_u32 s31, 0
s_cselect_b32 s58, -1920, s57
s_add_u32 s23, s23, s58
s_add_u32 s24, s24, s58
M a[84:87], a[208:211], a[240:243], a[84:87]
ds_read_b64_tr_b16 a[184:185], v15 offset:28672
ds_read_b64_tr_b16 a[186:187], v15 offset:30208
M a[84:87], a[212:215], a[244:247], a[84:87]
M a[88:91], a[220:223], a[244:247], a[88:91]
s_add_u32 m0, s30, 36864
s_nop 0
buffer_load_dwordx4 v6, s[12:15], s25 offen offset:0 lds
M a[88:91], a[216:219], a[240:243], a[88:91]
s_waitcnt lgkmcnt(8)
M a[92:95], a[200:203], a[248:251], a[92:95]
ds_read_b128 a[240:243], v10 offset:28672
ds_read_b128 a[244:247], v11 offset:28672
M a[92:95], a[204:207], a[252:255], a[92:95]
M a[96:99], a[212:215], a[252:255], a[96:99]
ds_read_b64_tr_b16 a[192:193], v16 offset:28672
ds_read_b64_tr_b16 a[194:195], v16 offset:30208
M a[96:99], a[208:211], a[248:251], a[96:99]
buffer_load_dwordx4 v7, s[12:15], s25 offen offset:1024 lds
M a[100:103], a[216:219], a[248:251], a[100:103]
M a[100:103], a[220:223], a[252:255], a[100:103]
buffer_load_dwordx4 v8, s[12:15], s25 offen offset:2048 lds
s_waitcnt lgkmcnt(10)
M a[104:107], a[204:207], a[228:231], a[104:107]
ds_read_b128 a[248:251], v10 offset:30720
ds_read_b128 a[252:255], v11 offset:30720
M a[104:107], a[200:203], a[224:227], a[104:107]
M a[108:111], a[208:211], a[224:227], a[108:111]
ds_read_b64_tr_b16 a[180:181], v14 offset:40960
ds_read_b64_tr_b16 a[182:183], v14 offset:42496
M a[108:111], a[212:215], a[228:231], a[108:111]
buffer_load_dwordx4 v9, s[12:15], s25 offen offset:3072 lds
M a[112:115], a[220:223], a[228:231], a[112:115]
M a[112:115], a[216:219], a[224:227], a[112:115]
s_add_u32 m0, s30, 40960
s_nop 0
buffer_load_dwordx4 v21, s[12:15], s25 offen offset:0 lds
s_waitcnt lgkmcnt(10)
M a[116:119], a[200:203], a[232:235], a[116:119]
ds_read_b128 a[224:227], v10 offset:32768
ds_read_b128 a[228:231], v11 offset:32768
M a[116:119], a[204:207], a[236:239], a[116:119]
M a[120:123], a[212:215], a[236:239], a[120:123]
ds_read_b64_tr_b16 a[188:189], v15 offset:40960
ds_read_b64_tr_b16 a[190:191], v15 offset:42496
M a[120:123], a[208:211], a[232:235], a[120:123]
M a[124:127], a[216:219], a[232:235], a[124:127]
buffer_load_dwordx4 v22, s[12:15], s25 offen offset:1024 lds
M a[124:127], a[220:223], a[236:239], a[124:127]
s_waitcnt lgkmcnt(10)
M a[128:131], a[204:207], a[244:247], a[128:131]
ds_read_b128 a[232:235], v10 offset:34816
ds_read_b128 a[236:239], v11 offset:34816
M a[128:131], a[200:203], a[240:243], a[128:131]
s_sub_u32 s54, s54, 1
s_cmp_eq_u32 s54, 0
s_cselect_b32 s58, s55, s56
s_add_u32 s25, s25, s58
M a[132:135], a[208:211], a[240:243], a[132:135]
ds_read_b64_tr_b16 a[196:197], v16 offset:40960
ds_read_b64_tr_b16 a[198:199], v16 offset:42496
M a[132:135], a[212:215], a[244:247], a[132:135]
M a[136:139], a[220:223], a[244:247], a[136:139]
s_add_u32 s94, s93, 12288
buffer_store_dwordx4 v[52:55], v1, s[16:19], s94 offen offset:2048 sc1
M a[136:139], a[216:219], a[240:243], a[136:139]
s_waitcnt lgkmcnt(10)
M a[140:143], a[200:203], a[248:251], a[140:143]
s_add_u32 s94, s93, 12288
buffer_store_dwordx4 v[60:63], v1, s[16:19], s94 offen offset:3072 sc1
M a[140:143], a[204:207], a[252:255], a[140:143]
M a[144:147], a[212:215], a[252:255], a[144:147]
M a[144:147], a[208:211], a[248:251], a[144:147]
M a[148:151], a[216:219], a[248:251], a[148:151]
s_waitcnt vmcnt(18) lgkmcnt(0)
s_barrier
ds_read_b128 a[240:243], v12 offset:0
ds_read_b128 a[244:247], v13 offset:0
M a[148:151], a[220:223], a[252:255], a[148:151]
s_add_u32 m0, s28, 18432
s_nop 0
buffer_load_dword v20, s[8:11], s24 offen lds
M a[152:155], a[204:207], a[228:231], a[152:155]
ds_read_b128 a[248:251], v12 offset:2048
ds_read_b128 a[252:255], v13 offset:2048
M a[152:155], a[200:203], a[224:227], a[152:155]
M a[156:159], a[208:211], a[224:227], a[156:159]
buffer_load_dword v23, s[8:11], s24 offen offset:256 lds
M a[156:159], a[212:215], a[228:231], a[156:159]
M a[160:163], a[220:223], a[228:231], a[160:163]
M a[160:163], a[216:219], a[224:227], a[160:163]
s_add_u32 m0, s29, 20480
s_nop 0
buffer_load_dwordx4 v2, s[8:11], s23 offen offset:0 lds
M a[164:167], a[200:203], a[232:235], a[164:167]
ds_read_b128 a[224:227], v12 offset:4096
ds_read_b128 a[228:231], v13 offset:4096
M a[164:167], a[204:207], a[236:239], a[164:167]
M a[168:171], a[212:215], a[236:239], a[168:171]
M a[168:171], a[208:211], a[232:235], a[168:171]
buffer_load_dwordx4 v3, s[8:11], s23 offen offset:1024 lds
M a[172:175], a[216:219], a[232:235], a[172:175]
M a[172:175], a[220:223], a[236:239], a[172:175]
s_waitcnt lgkmcnt(4)
M a[68:71], a[176:179], a[240:243], a[68:71]
ds_read_b128 a[232:235], v12 offset:6144
ds_read_b128 a[236:239], v13 offset:6144
M a[68:71], a[180:183], a[244:247], a[68:71]
buffer_load_dwordx4 v4, s[8:11], s23 offen offset:2048 lds
M a[72:75], a[188:191], a[244:247], a[72:75]
ds_read_b64_tr_b16 a[200:201], v17 offset:0
ds_read_b64_tr_b16 a[202:203], v17 offset:1536
M a[72:75], a[184:187], a[240:243], a[72:75]
M a[76:79], a[192:195], a[240:243], a[76:79]
buffer_load_dwordx4 v5, s[8:11], s23 offen offset:3072 lds
M a[76:79], a[196:199], a[244:247], a[76:79]
s_waitcnt lgkmcnt(6)
M a[80:83], a[180:183], a[252:255], a[80:83]
ds_read_b128 a[240:243], v12 offset:8192
ds_read_b128 a[244:247], v13 offset:8192
M a[80:83], a[176:179], a[248:251], a[80:83]
M a[84:87], a[184:187], a[248:251], a[84:87]
ds_read_b64_tr_b16 a[208:209], v18 offset:0
ds_read_b64_tr_b16 a[210:211], v18 offset:1536
M a[84:87], a[188:191], a[252:255], a[84:87]
s_sub_u32 s31, s31, 1
s_cmp_eq_u32 s31, 0
s_cselect_b32 s58, -1920, s57
s_add_u32 s23, s23, s58
s_add_u32 s24, s24, s58
M a[88:91], a[196:199], a[252:255], a[88:91]
M a[88:91], a[192:195], a[248:251], a[88:91]
s_waitcnt lgkmcnt(8)
M a[92:95], a[176:179], a[224:227], a[92:95]
ds_read_b128 a[248:251], v12 offset:10240
ds_read_b128 a[252:255], v13 offset:10240
M a[92:95], a[180:183], a[228:231], a[92:95]
s_add_u32 m0, s30, 65536
s_nop 0
buffer_load_dwordx4 v6, s[12:15], s25 offen offset:0 lds
M a[96:99], a[188:191], a[228:231], a[96:99]
ds_read_b64_tr_b16 a[216:217], v19 offset:0
ds_read_b64_tr_b16 a[218:219], v19 offset:1536
M a[96:99], a[184:187], a[224:227], a[96:99]
M a[100:103], a[192:195], a[224:227], a[100:103]
buffer_load_dwordx4 v7, s[12:15], s25 offen offset:1024 lds
M a[100:103], a[196:199], a[228:231], a[100:103]
s_waitcnt lgkmcnt(10)
M a[104:107], a[180:183], a[236:239], a[104:107]
ds_read_b128 a[224:227], v12 offset:12288
ds_read_b128 a[228:231], v13 offset:12288
M a[104:107], a[176:179], a[232:235], a[104:107]
M a[108:111], a[184:187], a[232:235], a[108:111]
ds_read_b64_tr_b16 a[204:205], v17 offset:12288
ds_read_b64_tr_b16 a[206:207], v17 offset:13824
M a[108:111], a[188:191], a[236:239], a[108:111]
buffer_load_dwordx4 v8, s[12:15], s25 offen offset:2048 lds
M a[112:115], a[196:199], a[236:239], a[112:115]
M a[112:115], a[192:195], a[232:235], a[112:115]
s_waitcnt lgkmcnt(10)
M a[116:119], a[176:179], a[240:243], a[116:119]
ds_read_b128 a[232:235], v12 offset:14336
ds_read_b128 a[236:239], v13 offset:14336
M a[116:119], a[180:183], a[244:247], a[116:119]
buffer_load_dwordx4 v9, s[12:15], s25 offen offset:3072 lds
M a[120:123], a[188:191], a[244:247], a[120:123]
ds_read_b64_tr_b16 a[212:213], v18 offset:12288
ds_read_b64_tr_b16 a[214:215], v18 offset:13824
M a[120:123], a[184:187], a[240:243], a[120:123]
M a[124:127], a[192:195], a[240:243], a[124:127]
s_add_u32 m0, s30, 69632
s_nop 0
buffer_load_dwordx4 v21, s[12:15], s25 offen offset:0 lds
M a[124:127], a[196:199], a[244:247], a[124:127]
s_waitcnt lgkmcnt(10)
M a[128:131], a[180:183], a[252:255], a[128:131]
ds_read_b128 a[240:243], v12 offset:16384
ds_read_b128 a[244:247], v13 offset:16384
M a[128:131], a[176:179], a[248:251], a[128:131]
M a[132:135], a[184:187], a[248:251], a[132:135]
ds_read_b64_tr_b16 a[220:221], v19 offset:12288
ds_read_b64_tr_b16 a[222:223], v19 offset:13824
M a[132:135], a[188:191], a[252:255], a[132:135]
buffer_load_dwordx4 v22, s[12:15], s25 offen offset:1024 lds
M a[136:139], a[196:199], a[252:255], a[136:139]
M a[136:139], a[192:195], a[248:251], a[136:139]
s_waitcnt lgkmcnt(10)
M a[140:143], a[176:179], a[224:227], a[140:143]
s_sub_u32 s54, s54, 1
s_cmp_eq_u32 s54, 0
s_cselect_b32 s58, s55, s56
s_add_u32 s25, s25, s58
M a[140:143], a[180:183], a[228:231], a[140:143]
M a[144:147], a[188:191], a[228:231], a[144:147]
M a[144:147], a[184:187], a[224:227], a[144:147]
M a[148:151], a[192:195], a[224:227], a[148:151]
s_waitcnt vmcnt(12) lgkmcnt(0)
s_barrier
ds_read_b128 a[248:251], v10 offset:0
ds_read_b128 a[252:255], v11 offset:0
s_cmp_lg_u32 s101, 0
s_cbranch_scc1 Lk1_arr
v_mov_b32 v127, 1
s_and_b32 s41, s2, 128
s_mov_b64 exec, 1
buffer_atomic_add v127, off, s[36:39], s41 sc1
s_mov_b64 exec, -1
Lk1_arr:
M a[148:151], a[196:199], a[228:231], a[148:151]
s_add_u32 m0, s28, 131072
s_nop 0
buffer_load_dword v20, s[8:11], s24 offen lds
M a[152:155], a[180:183], a[236:239], a[152:155]
ds_read_b128 a[224:227], v10 offset:2048
ds_read_b128 a[228:231], v11 offset:2048
M a[152:155], a[176:179], a[232:235], a[152:155]
M a[156:159], a[184:187], a[232:235], a[156:159]
buffer_load_dword v23, s[8:11], s24 offen offset:256 lds
M a[156:159], a[188:191], a[236:239], a[156:159]
M a[160:163], a[196:199], a[236:239], a[160:163]
M a[160:163], a[192:195], a[232:235], a[160:163]
s_add_u32 m0, s29, 133120
s_nop 0
buffer_load_dwordx4 v2, s[8:11], s23 offen offset:0 lds
M a[164:167], a[176:179], a[240:243], a[164:167]
ds_read_b128 a[232:235], v10 offset:4096
ds_read_b128 a[236:239], v11 offset:4096
M a[164:167], a[180:183], a[244:247], a[164:167]
M a[168:171], a[188:191], a[244:247], a[168:171]
M a[168:171], a[184:187], a[240:243], a[168:171]
buffer_load_dwordx4 v3, s[8:11], s23 offen offset:1024 lds
M a[172:175], a[192:195], a[240:243], a[172:175]
M a[172:175], a[196:199], a[244:247], a[172:175]
s_waitcnt lgkmcnt(4)
M a[68:71], a[200:203], a[248:251], a[68:71]
ds_read_b128 a[240:243], v10 offset:6144
ds_read_b128 a[244:247], v11 offset:6144
M a[68:71], a[204:207], a[252:255], a[68:71]
buffer_load_dwordx4 v4, s[8:11], s23 offen offset:2048 lds
M a[72:75], a[212:215], a[252:255], a[72:75]
ds_read_b64_tr_b16 a[176:177], v14 offset:0
ds_read_b64_tr_b16 a[178:179], v14 offset:1536
M a[72:75], a[208:211], a[248:251], a[72:75]
M a[76:79], a[216:219], a[248:251], a[76:79]
buffer_load_dwordx4 v5, s[8:11], s23 offen offset:3072 lds
M a[76:79], a[220:223], a[252:255], a[76:79]
s_waitcnt lgkmcnt(6)
M a[80:83], a[204:207], a[228:231], a[80:83]
ds_read_b128 a[248:251], v10 offset:8192
ds_read_b128 a[252:255], v11 offset:8192
M a[80:83], a[200:203], a[224:227], a[80:83]
M a[84:87], a[208:211], a[224:227], a[84:87]
ds_read_b64_tr_b16 a[184:185], v15 offset:0
ds_read_b64_tr_b16 a[186:187], v15 offset:1536
M a[84:87], a[212:215], a[228:231], a[84:87]
s_sub_u32 s31, s31, 1
s_cmp_eq_u32 s31, 0
s_cselect_b32 s58, -1920, s57
s_add_u32 s23, s23, s58
s_add_u32 s24, s24, s58
M a[88:91], a[220:223], a[228:231], a[88:91]
M a[88:91], a[216:219], a[224:227], a[88:91]
s_waitcnt lgkmcnt(8)
M a[92:95], a[200:203], a[232:235], a[92:95]
ds_read_b128 a[224:227], v10 offset:10240
ds_read_b128 a[228:231], v11 offset:10240
M a[92:95], a[204:207], a[236:239], a[92:95]
s_add_u32 m0, s30, 98304
s_nop 0
buffer_load_dwordx4 v6, s[12:15], s25 offen offset:0 lds
M a[96:99], a[212:215], a[236:239], a[96:99]
ds_read_b64_tr_b16 a[192:193], v16 offset:0
ds_read_b64_tr_b16 a[194:195], v16 offset:1536
M a[96:99], a[208:211], a[232:235], a[96:99]
M a[100:103], a[216:219], a[232:235], a[100:103]
buffer_load_dwordx4 v7, s[12:15], s25 offen offset:1024 lds
M a[100:103], a[220:223], a[236:239], a[100:103]
s_waitcnt lgkmcnt(10)
M a[104:107], a[204:207], a[244:247], a[104:107]
ds_read_b128 a[232:235], v10 offset:12288
ds_read_b128 a[236:239], v11 offset:12288
M a[104:107], a[200:203], a[240:243], a[104:107]
M a[108:111], a[208:211], a[240:243], a[108:111]
ds_read_b64_tr_b16 a[180:181], v14 offset:12288
ds_read_b64_tr_b16 a[182:183], v14 offset:13824
M a[108:111], a[212:215], a[244:247], a[108:111]
buffer_load_dwordx4 v8, s[12:15], s25 offen offset:2048 lds
M a[112:115], a[220:223], a[244:247], a[112:115]
M a[112:115], a[216:219], a[240:243], a[112:115]
s_waitcnt lgkmcnt(10)
M a[116:119], a[200:203], a[248:251], a[116:119]
ds_read_b128 a[240:243], v10 offset:14336
ds_read_b128 a[244:247], v11 offset:14336
M a[116:119], a[204:207], a[252:255], a[116:119]
buffer_load_dwordx4 v9, s[12:15], s25 offen offset:3072 lds
M a[120:123], a[212:215], a[252:255], a[120:123]
ds_read_b64_tr_b16 a[188:189], v15 offset:12288
ds_read_b64_tr_b16 a[190:191], v15 offset:13824
M a[120:123], a[208:211], a[248:251], a[120:123]
M a[124:127], a[216:219], a[248:251], a[124:127]
s_add_u32 m0, s30, 102400
s_nop 0
buffer_load_dwordx4 v21, s[12:15], s25 offen offset:0 lds
M a[124:127], a[220:223], a[252:255], a[124:127]
s_waitcnt lgkmcnt(10)
M a[128:131], a[204:207], a[228:231], a[128:131]
ds_read_b128 a[248:251], v10 offset:16384
ds_read_b128 a[252:255], v11 offset:16384
M a[128:131], a[200:203], a[224:227], a[128:131]
M a[132:135], a[208:211], a[224:227], a[132:135]
ds_read_b64_tr_b16 a[196:197], v16 offset:12288
ds_read_b64_tr_b16 a[198:199], v16 offset:13824
M a[132:135], a[212:215], a[228:231], a[132:135]
buffer_load_dwordx4 v22, s[12:15], s25 offen offset:1024 lds
M a[136:139], a[220:223], a[228:231], a[136:139]
M a[136:139], a[216:219], a[224:227], a[136:139]
s_waitcnt lgkmcnt(10)
M a[140:143], a[200:203], a[232:235], a[140:143]
s_sub_u32 s54, s54, 1
s_cmp_eq_u32 s54, 0
s_cselect_b32 s58, s55, s56
s_add_u32 s25, s25, s58
M a[140:143], a[204:207], a[236:239], a[140:143]
M a[144:147], a[212:215], a[236:239], a[144:147]
M a[144:147], a[208:211], a[232:235], a[144:147]
M a[148:151], a[216:219], a[232:235], a[148:151]
s_waitcnt vmcnt(12) lgkmcnt(0)
s_barrier
ds_read_b128 a[224:227], v10 offset:18432
ds_read_b128 a[228:231], v11 offset:18432
M a[148:151], a[220:223], a[236:239], a[148:151]
s_add_u32 m0, s28, 0
s_nop 0
buffer_load_dword v20, s[8:11], s24 offen lds
M a[152:155], a[204:207], a[244:247], a[152:155]
ds_read_b128 a[232:235], v10 offset:20480
ds_read_b128 a[236:239], v11 offset:20480
M a[152:155], a[200:203], a[240:243], a[152:155]
M a[156:159], a[208:211], a[240:243], a[156:159]
buffer_load_dword v23, s[8:11], s24 offen offset:256 lds
M a[156:159], a[212:215], a[244:247], a[156:159]
M a[160:163], a[220:223], a[244:247], a[160:163]
M a[160:163], a[216:219], a[240:243], a[160:163]
s_add_u32 m0, s29, 2048
s_nop 0
buffer_load_dwordx4 v2, s[8:11], s23 offen offset:0 lds
M a[164:167], a[200:203], a[248:251], a[164:167]
ds_read_b128 a[240:243], v10 offset:22528
ds_read_b128 a[244:247], v11 offset:22528
M a[164:167], a[204:207], a[252:255], a[164:167]
M a[168:171], a[212:215], a[252:255], a[168:171]
M a[168:171], a[208:211], a[248:251], a[168:171]
buffer_load_dwordx4 v3, s[8:11], s23 offen offset:1024 lds
M a[172:175], a[216:219], a[248:251], a[172:175]
M a[172:175], a[220:223], a[252:255], a[172:175]
s_waitcnt lgkmcnt(4)
M a[68:71], a[176:179], a[224:227], a[68:71]
ds_read_b128 a[248:251], v10 offset:24576
ds_read_b128 a[252:255], v11 offset:24576
v_mov_b32 v160, 0
v_mov_b32 v161, 0
M a[68:71], a[180:183], a[228:231], a[68:71]
buffer_load_dwordx4 v4, s[8:11], s23 offen offset:2048 lds
M a[72:75], a[188:191], a[228:231], a[72:75]
ds_read_b64_tr_b16 a[200:201], v14 offset:28672
ds_read_b64_tr_b16 a[202:203], v14 offset:30208
v_mov_b32 v162, 0
v_mov_b32 v163, 0
M a[72:75], a[184:187], a[224:227], a[72:75]
M a[76:79], a[192:195], a[224:227], a[76:79]
buffer_load_dwordx4 v5, s[8:11], s23 offen offset:3072 lds
v_mov_b32 v164, 0
v_mov_b32 v165, 0
M a[76:79], a[196:199], a[228:231], a[76:79]
s_waitcnt lgkmcnt(6)
M a[80:83], a[180:183], a[236:239], a[80:83]
ds_read_b128 a[224:227], v10 offset:26624
ds_read_b128 a[228:231], v11 offset:26624
v_mov_b32 v166, 0
v_mov_b32 v167, 0
M a[80:83], a[176:179], a[232:235], a[80:83]
M a[84:87], a[184:187], a[232:235], a[84:87]
ds_read_b64_tr_b16 a[208:209], v15 offset:28672
ds_read_b64_tr_b16 a[210:211], v15 offset:30208
M a[84:87], a[188:191], a[236:239], a[84:87]
s_sub_u32 s31, s31, 1
s_cmp_eq_u32 s31, 0
s_cselect_b32 s58, -1920, s57
s_add_u32 s23, s23, s58
s_add_u32 s24, s24, s58
v_mov_b32 v168, 0
v_mov_b32 v169, 0
M a[88:91], a[196:199], a[236:239], a[88:91]
M a[88:91], a[192:195], a[232:235], a[88:91]
s_waitcnt lgkmcnt(8)
v_mov_b32 v170, 0
v_mov_b32 v171, 0
M a[92:95], a[176:179], a[240:243], a[92:95]
ds_read_b128 a[232:235], v10 offset:28672
ds_read_b128 a[236:239], v11 offset:28672
M a[92:95], a[180:183], a[244:247], a[92:95]
s_add_u32 m0, s30, 36864
s_nop 0
buffer_load_dwordx4 v6, s[12:15], s25 offen offset:0 lds
v_mov_b32 v172, 0
v_mov_b32 v173, 0
M a[96:99], a[188:191], a[244:247], a[96:99]
ds_read_b64_tr_b16 a[216:217], v16 offset:28672
ds_read_b64_tr_b16 a[218:219], v16 offset:30208
M a[96:99], a[184:187], a[240:243], a[96:99]
v_mov_b32 v174, 0
v_mov_b32 v175, 0
M a[100:103], a[192:195], a[240:243], a[100:103]
buffer_load_dwordx4 v7, s[12:15], s25 offen offset:1024 lds
M a[100:103], a[196:199], a[244:247], a[100:103]
s_waitcnt lgkmcnt(10)
M a[104:107], a[180:183], a[252:255], a[104:107]
ds_read_b128 a[240:243], v10 offset:30720
ds_read_b128 a[244:247], v11 offset:30720
v_mov_b32 v176, 0
v_mov_b32 v177, 0
M a[104:107], a[176:179], a[248:251], a[104:107]
M a[108:111], a[184:187], a[248:251], a[108:111]
ds_read_b64_tr_b16 a[204:205], v14 offset:40960
ds_read_b64_tr_b16 a[206:207], v14 offset:42496
v_mov_b32 v178, 0
v_mov_b32 v179, 0
M a[108:111], a[188:191], a[252:255], a[108:111]
buffer_load_dwordx4 v8, s[12:15], s25 offen offset:2048 lds
M a[112:115], a[196:199], a[252:255], a[112:115]
v_mov_b32 v180, 0
v_mov_b32 v181, 0
M a[112:115], a[192:195], a[248:251], a[112:115]
s_waitcnt lgkmcnt(10)
M a[116:119], a[176:179], a[224:227], a[116:119]
ds_read_b128 a[248:251], v10 offset:32768
ds_read_b128 a[252:255], v11 offset:32768
v_mov_b32 v182, 0
v_mov_b32 v183, 0
M a[116:119], a[180:183], a[228:231], a[116:119]
buffer_load_dwordx4 v9, s[12:15], s25 offen offset:3072 lds
M a[120:123], a[188:191], a[228:231], a[120:123]
ds_read_b64_tr_b16 a[212:213], v15 offset:40960
ds_read_b64_tr_b16 a[214:215], v15 offset:42496
M a[120:123], a[184:187], a[224:227], a[120:123]
v_mov_b32 v184, 0
v_mov_b32 v185, 0
M a[124:127], a[192:195], a[224:227], a[124:127]
s_add_u32 m0, s30, 40960
s_nop 0
buffer_load_dwordx4 v21, s[12:15], s25 offen offset:0 lds
M a[124:127], a[196:199], a[228:231], a[124:127]
s_waitcnt lgkmcnt(10)
v_mov_b32 v186, 0
v_mov_b32 v187, 0
M a[128:131], a[180:183], a[236:239], a[128:131]
ds_read_b128 a[224:227], v10 offset:34816
ds_read_b128 a[228:231], v11 offset:34816
M a[128:131], a[176:179], a[232:235], a[128:131]
v_mov_b32 v188, 0
v_mov_b32 v189, 0
M a[132:135], a[184:187], a[232:235], a[132:135]
ds_read_b64_tr_b16 a[220:221], v16 offset:40960
ds_read_b64_tr_b16 a[222:223], v16 offset:42496
M a[132:135], a[188:191], a[236:239], a[132:135]
buffer_load_dwordx4 v22, s[12:15], s25 offen offset:1024 lds
v_mov_b32 v190, 0
v_mov_b32 v191, 0
M a[136:139], a[196:199], a[236:239], a[136:139]
M a[136:139], a[192:195], a[232:235], a[136:139]
s_waitcnt lgkmcnt(10)
M a[140:143], a[176:179], a[240:243], a[140:143]
s_sub_u32 s54, s54, 1
s_cmp_eq_u32 s54, 0
s_cselect_b32 s58, s55, s56
s_add_u32 s25, s25, s58
v_mov_b32 v192, 0
v_mov_b32 v193, 0
M a[140:143], a[180:183], a[244:247], a[140:143]
M a[144:147], a[188:191], a[244:247], a[144:147]
v_mov_b32 v194, 0
v_mov_b32 v195, 0
M a[144:147], a[184:187], a[240:243], a[144:147]
M a[148:151], a[192:195], a[240:243], a[148:151]
s_waitcnt vmcnt(12) lgkmcnt(0)
s_barrier
ds_read_b128 a[232:235], v12 offset:0
ds_read_b128 a[236:239], v13 offset:0
v_mov_b32 v196, 0
v_mov_b32 v197, 0
M a[148:151], a[196:199], a[244:247], a[148:151]
s_add_u32 m0, s28, 18432
s_nop 0
buffer_load_dword v20, s[8:11], s24 offen lds
M a[152:155], a[180:183], a[252:255], a[152:155]
ds_read_b128 a[240:243], v12 offset:2048
ds_read_b128 a[244:247], v13 offset:2048
v_mov_b32 v198, 0
v_mov_b32 v199, 0
M a[152:155], a[176:179], a[248:251], a[152:155]
M a[156:159], a[184:187], a[248:251], a[156:159]
buffer_load_dword v23, s[8:11], s24 offen offset:256 lds
M a[156:159], a[188:191], a[252:255], a[156:159]
v_mov_b32 v200, 0
v_mov_b32 v201, 0
M a[160:163], a[196:199], a[252:255], a[160:163]
M a[160:163], a[192:195], a[248:251], a[160:163]
s_add_u32 m0, s29, 20480
s_nop 0
buffer_load_dwordx4 v2, s[8:11], s23 offen offset:0 lds
v_mov_b32 v202, 0
v_mov_b32 v203, 0
M a[164:167], a[176:179], a[224:227], a[164:167]
ds_read_b128 a[248:251], v12 offset:4096
ds_read_b128 a[252:255], v13 offset:4096
M a[164:167], a[180:183], a[228:231], a[164:167]
v_mov_b32 v204, 0
v_mov_b32 v205, 0
M a[168:171], a[188:191], a[228:231], a[168:171]
M a[168:171], a[184:187], a[224:227], a[168:171]
buffer_load_dwordx4 v3, s[8:11], s23 offen offset:1024 lds
v_mov_b32 v206, 0
v_mov_b32 v207, 0
M a[172:175], a[192:195], a[224:227], a[172:175]
M a[172:175], a[196:199], a[228:231], a[172:175]
s_waitcnt lgkmcnt(4)
M a[68:71], a[200:203], a[232:235], a[68:71]
ds_read_b128 a[224:227], v12 offset:6144
ds_read_b128 a[228:231], v13 offset:6144
v_and_b32 v128, 15, v0
v_mul_u32_u24 v128, 400, v128
M a[68:71], a[204:207], a[236:239], a[68:71]
buffer_load_dwordx4 v4, s[8:11], s23 offen offset:2048 lds
M a[72:75], a[212:215], a[236:239], a[72:75]
ds_read_b64_tr_b16 a[176:177], v17 offset:0
ds_read_b64_tr_b16 a[178:179], v17 offset:1536
v_lshrrev_b32 v129, 4, v0
v_lshl_add_u32 v128, v129, 3, v128
M a[72:75], a[208:211], a[232:235], a[72:75]
M a[76:79], a[216:219], a[232:235], a[76:79]
buffer_load_dwordx4 v5, s[8:11], s23 offen offset:3072 lds
s_mul_i32 s3, s20, 96
s_add_u32 s3, s3, 98304
M a[76:79], a[220:223], a[236:239], a[76:79]
s_waitcnt lgkmcnt(6)
M a[80:83], a[204:207], a[244:247], a[80:83]
ds_read_b128 a[232:235], v12 offset:8192
ds_read_b128 a[236:239], v13 offset:8192
v_add_u32 v124, s3, v128
v_and_b32 v128, 15, v0
M a[80:83], a[200:203], a[240:243], a[80:83]
M a[84:87], a[208:211], a[240:243], a[84:87]
ds_read_b64_tr_b16 a[184:185], v18 offset:0
ds_read_b64_tr_b16 a[186:187], v18 offset:1536
v_lshrrev_b32 v129, 4, v0
s_add_u32 s3, s21, 16
M a[84:87], a[212:215], a[244:247], a[84:87]
s_sub_u32 s31, s31, 1
s_cmp_eq_u32 s31, 0
s_cselect_b32 s58, -1920, s57
s_add_u32 s23, s23, s58
s_add_u32 s24, s24, s58
M a[88:91], a[220:223], a[244:247], a[88:91]
v_lshl_add_u32 v130, v128, 1, s3
s_lshl_b32 s4, s22, 6
M a[88:91], a[216:219], a[240:243], a[88:91]
s_waitcnt lgkmcnt(8)
M a[92:95], a[200:203], a[248:251], a[92:95]
ds_read_b128 a[240:243], v12 offset:10240
ds_read_b128 a[244:247], v13 offset:10240
s_add_u32 s4, s4, 98304
v_mul_u32_u24 v120, 400, v130
M a[92:95], a[204:207], a[252:255], a[92:95]
s_add_u32 m0, s30, 65536
s_nop 0
buffer_load_dwordx4 v6, s[12:15], s25 offen offset:0 lds
M a[96:99], a[212:215], a[252:255], a[96:99]
ds_read_b64_tr_b16 a[192:193], v19 offset:0
ds_read_b64_tr_b16 a[194:195], v19 offset:1536
M a[96:99], a[208:211], a[248:251], a[96:99]
v_lshl_add_u32 v120, v129, 4, v120
v_add_u32 v120, s4, v120
M a[100:103], a[216:219], a[248:251], a[100:103]
buffer_load_dwordx4 v7, s[12:15], s25 offen offset:1024 lds
M a[100:103], a[220:223], a[252:255], a[100:103]
s_waitcnt lgkmcnt(10)
v_subrev_u32 v130, 32, v130
v_max_i32 v130, 0, v130
M a[104:107], a[204:207], a[228:231], a[104:107]
ds_read_b128 a[248:251], v12 offset:12288
ds_read_b128 a[252:255], v13 offset:12288
M a[104:107], a[200:203], a[224:227], a[104:107]
v_mul_u32_u24 v121, 400, v130
v_lshl_add_u32 v121, v129, 4, v121
M a[108:111], a[208:211], a[224:227], a[108:111]
ds_read_b64_tr_b16 a[180:181], v17 offset:12288
ds_read_b64_tr_b16 a[182:183], v17 offset:13824
M a[108:111], a[212:215], a[228:231], a[108:111]
buffer_load_dwordx4 v8, s[12:15], s25 offen offset:2048 lds
v_add_u32 v121, s4, v121
v_bfe_u32 v131, v0, 2, 2
M a[112:115], a[220:223], a[228:231], a[112:115]
M a[112:115], a[216:219], a[224:227], a[112:115]
s_waitcnt lgkmcnt(10)
v_lshl_add_u32 v131, v129, 2, v131
v_lshl_add_u32 v131, v131, 1, s3
M a[116:119], a[200:203], a[232:235], a[116:119]
ds_read_b128 a[224:227], v12 offset:14336
ds_read_b128 a[228:231], v13 offset:14336
M a[116:119], a[204:207], a[236:239], a[116:119]
buffer_load_dwordx4 v9, s[12:15], s25 offen offset:3072 lds
v_and_b32 v132, 3, v0
v_lshlrev_b32 v132, 3, v132
M a[120:123], a[212:215], a[236:239], a[120:123]
ds_read_b64_tr_b16 a[188:189], v18 offset:12288
ds_read_b64_tr_b16 a[190:191], v18 offset:13824
M a[120:123], a[208:211], a[232:235], a[120:123]
M a[124:127], a[216:219], a[232:235], a[124:127]
s_add_u32 m0, s30, 69632
s_nop 0
buffer_load_dwordx4 v21, s[12:15], s25 offen offset:0 lds
v_add_u32 v132, s4, v132
s_movk_i32 s5, 400
M a[124:127], a[220:223], a[236:239], a[124:127]
s_waitcnt lgkmcnt(10)
M a[128:131], a[204:207], a[244:247], a[128:131]
ds_read_b128 a[232:235], v12 offset:16384
ds_read_b128 a[236:239], v13 offset:16384
v_mad_u32_u24 v122, v131, s5, v132
v_subrev_u32 v131, 32, v131
M a[128:131], a[200:203], a[240:243], a[128:131]
M a[132:135], a[208:211], a[240:243], a[132:135]
ds_read_b64_tr_b16 a[196:197], v19 offset:12288
ds_read_b64_tr_b16 a[198:199], v19 offset:13824
v_max_i32 v131, 0, v131
v_mad_u32_u24 v123, v131, s5, v132
M a[132:135], a[212:215], a[244:247], a[132:135]
buffer_load_dwordx4 v22, s[12:15], s25 offen offset:1024 lds
M a[136:139], a[220:223], a[244:247], a[136:139]
v_lshlrev_b32 v129, 2, v129
v_sub_u32 v128, v128, v129
M a[136:139], a[216:219], a[240:243], a[136:139]
s_waitcnt lgkmcnt(10)
M a[140:143], a[200:203], a[248:251], a[140:143]
s_sub_u32 s54, s54, 1
s_cmp_eq_u32 s54, 0
s_cselect_b32 s58, s55, s56
s_add_u32 s25, s25, s58
v_mov_b32 v129, 0xf149f2ca
s_cmp_eq_u32 s26, 0
s_cselect_b32 s3, 0xf149f2ca, 0
M a[140:143], a[204:207], a[252:255], a[140:143]
M a[144:147], a[212:215], a[252:255], a[144:147]
v_cmp_lt_i32 vcc, -9, v128
s_nop 1
v_cndmask_b32 v144, 0, v129, vcc
M a[144:147], a[208:211], a[248:251], a[144:147]
M a[148:151], a[216:219], a[248:251], a[148:151]
s_waitcnt vmcnt(12) lgkmcnt(0)
s_barrier
ds_read_b128 a[240:243], v10 offset:0
ds_read_b128 a[244:247], v11 offset:0
M a[148:151], a[220:223], a[252:255], a[148:151]
s_add_u32 m0, s28, 131072
s_nop 0
buffer_load_dword v20, s[8:11], s24 offen lds
v_subrev_u32 v130, 0, v128
v_cmp_lt_u32 vcc, 7, v130
s_nop 1
v_cndmask_b32 v148, 0, v129, vcc
M a[152:155], a[204:207], a[228:231], a[152:155]
ds_read_b128 a[248:251], v10 offset:2048
ds_read_b128 a[252:255], v11 offset:2048
M a[152:155], a[200:203], a[224:227], a[152:155]
v_min_f32 v152, s3, v144
v_mov_b32 v156, 0x3f803f80
M a[156:159], a[208:211], a[224:227], a[156:159]
buffer_load_dword v23, s[8:11], s24 offen offset:256 lds
M a[156:159], a[212:215], a[228:231], a[156:159]
v_cmp_lt_i32 vcc, -8, v128
s_nop 1
v_cndmask_b32 v145, 0, v129, vcc
M a[160:163], a[220:223], a[228:231], a[160:163]
M a[160:163], a[216:219], a[224:227], a[160:163]
s_add_u32 m0, s29, 133120
s_nop 0
buffer_load_dwordx4 v2, s[8:11], s23 offen offset:0 lds
v_subrev_u32 v130, 1, v128
v_cmp_lt_u32 vcc, 7, v130
s_nop 1
v_cndmask_b32 v149, 0, v129, vcc
M a[164:167], a[200:203], a[232:235], a[164:167]
ds_read_b128 a[224:227], v10 offset:4096
ds_read_b128 a[228:231], v11 offset:4096
M a[164:167], a[204:207], a[236:239], a[164:167]
v_min_f32 v153, s3, v145
v_mov_b32 v157, 0x3f803f80
M a[168:171], a[212:215], a[236:239], a[168:171]
M a[168:171], a[208:211], a[232:235], a[168:171]
buffer_load_dwordx4 v3, s[8:11], s23 offen offset:1024 lds
v_cmp_lt_i32 vcc, -7, v128
s_nop 1
v_cndmask_b32 v146, 0, v129, vcc
M a[172:175], a[216:219], a[232:235], a[172:175]
M a[172:175], a[220:223], a[236:239], a[172:175]
s_waitcnt lgkmcnt(4)
M a[68:71], a[176:179], a[240:243], a[68:71]
ds_read_b128 a[232:235], v10 offset:6144
ds_read_b128 a[236:239], v11 offset:6144
v_subrev_u32 v130, 2, v128
v_cmp_lt_u32 vcc, 7, v130
s_nop 1
v_cndmask_b32 v150, 0, v129, vcc
M a[68:71], a[180:183], a[244:247], a[68:71]
buffer_load_dwordx4 v4, s[8:11], s23 offen offset:2048 lds
v_min_f32 v154, s3, v146
v_mov_b32 v158, 0x3f803f80
M a[72:75], a[188:191], a[244:247], a[72:75]
ds_read_b64_tr_b16 a[200:201], v14 offset:0
ds_read_b64_tr_b16 a[202:203], v14 offset:1536
M a[72:75], a[184:187], a[240:243], a[72:75]
v_cmp_lt_i32 vcc, -6, v128
s_nop 1
v_cndmask_b32 v147, 0, v129, vcc
M a[76:79], a[192:195], a[240:243], a[76:79]
buffer_load_dwordx4 v5, s[8:11], s23 offen offset:3072 lds
v_subrev_u32 v130, 3, v128
v_cmp_lt_u32 vcc, 7, v130
s_nop 1
v_cndmask_b32 v151, 0, v129, vcc
M a[76:79], a[196:199], a[244:247], a[76:79]
s_waitcnt lgkmcnt(6)
M a[80:83], a[180:183], a[252:255], a[80:83]
ds_read_b128 a[240:243], v10 offset:8192
ds_read_b128 a[244:247], v11 offset:8192
v_min_f32 v155, s3, v147
v_mov_b32 v159, 0x3f803f80
M a[80:83], a[176:179], a[248:251], a[80:83]
s_add_u32 s16, s50, 83886080
s_addc_u32 s17, s51, 0
M a[84:87], a[184:187], a[248:251], a[84:87]
ds_read_b64_tr_b16 a[208:209], v15 offset:0
ds_read_b64_tr_b16 a[210:211], v15 offset:1536
M a[84:87], a[188:191], a[252:255], a[84:87]
s_sub_u32 s31, s31, 1
s_cmp_eq_u32 s31, 0
s_cselect_b32 s58, -1920, s57
s_add_u32 s23, s23, s58
s_add_u32 s24, s24, s58
s_mov_b32 s18, 4194304
s_mov_b32 s19, 0x00020000
M a[88:91], a[196:199], a[252:255], a[88:91]
s_lshl_b32 s3, s26, 18
s_lshl_b32 s4, s27, 14
M a[88:91], a[192:195], a[248:251], a[88:91]
s_waitcnt lgkmcnt(8)
M a[92:95], a[176:179], a[224:227], a[92:95]
ds_read_b128 a[248:251], v10 offset:10240
ds_read_b128 a[252:255], v11 offset:10240
s_add_u32 s3, s3, s4
s_lshl_b32 s4, s21, 13
M a[92:95], a[180:183], a[228:231], a[92:95]
s_add_u32 m0, s30, 98304
s_nop 0
buffer_load_dwordx4 v6, s[12:15], s25 offen offset:0 lds
s_add_u32 s3, s3, s4
s_lshl_b32 s4, s22, 10
M a[96:99], a[188:191], a[228:231], a[96:99]
ds_read_b64_tr_b16 a[216:217], v16 offset:0
ds_read_b64_tr_b16 a[218:219], v16 offset:1536
M a[96:99], a[184:187], a[224:227], a[96:99]
s_add_u32 s6, s3, s4
s_mov_b32 s7, 0x3e8293ee
M a[100:103], a[192:195], a[224:227], a[100:103]
buffer_load_dwordx4 v7, s[12:15], s25 offen offset:1024 lds
s_lshl_b32 s65, s26, 8
s_lshl_b32 s3, s27, 4
M a[100:103], a[196:199], a[228:231], a[100:103]
s_waitcnt lgkmcnt(10)
M a[104:107], a[180:183], a[236:239], a[104:107]
ds_read_b128 a[224:227], v10 offset:12288
ds_read_b128 a[228:231], v11 offset:12288
s_add_u32 s65, s65, s3
s_lshl_b32 s3, s101, 2
M a[104:107], a[176:179], a[232:235], a[104:107]
s_add_u32 s65, s65, s3
s_add_u32 s65, s65, 8400896
M a[108:111], a[184:187], a[232:235], a[108:111]
ds_read_b64_tr_b16 a[204:205], v14 offset:12288
ds_read_b64_tr_b16 a[206:207], v14 offset:13824
M a[108:111], a[188:191], a[236:239], a[108:111]
buffer_load_dwordx4 v8, s[12:15], s25 offen offset:2048 lds
s_mov_b32 s40, 0
v_mov_b32 v119, 0
M a[112:115], a[196:199], a[236:239], a[112:115]
s_mov_b64 s[4:5], s[50:51]
s_and_b32 s20, s2, 7
M a[112:115], a[192:195], a[232:235], a[112:115]
s_waitcnt lgkmcnt(10)
M a[116:119], a[176:179], a[240:243], a[116:119]
ds_read_b128 a[232:235], v10 offset:14336
ds_read_b128 a[236:239], v11 offset:14336
s_lshr_b32 s33, s2, 6
s_lshl_b32 s33, s33, 3
M a[116:119], a[180:183], a[244:247], a[116:119]
buffer_load_dwordx4 v9, s[12:15], s25 offen offset:3072 lds
s_add_u32 s20, s20, s33
s_bfe_u32 s21, s2, 0x30003
M a[120:123], a[188:191], a[244:247], a[120:123]
ds_read_b64_tr_b16 a[212:213], v15 offset:12288
ds_read_b64_tr_b16 a[214:215], v15 offset:13824
M a[120:123], a[184:187], a[240:243], a[120:123]
s_sub_u32 s35, 15, s21
s_cmp_lt_u32 s101, 2
s_cselect_b32 s35, s21, s35
M a[124:127], a[192:195], a[240:243], a[124:127]
s_add_u32 m0, s30, 102400
s_nop 0
buffer_load_dwordx4 v21, s[12:15], s25 offen offset:0 lds
s_lshl_b32 s33, s20, 7
s_lshl_b32 s34, s35, 3
M a[124:127], a[196:199], a[244:247], a[124:127]
s_waitcnt lgkmcnt(10)
M a[128:131], a[180:183], a[252:255], a[128:131]
ds_read_b128 a[240:243], v10 offset:16384
ds_read_b128 a[244:247], v11 offset:16384
s_add_u32 s33, s33, s34
s_and_b32 s34, s101, 1
M a[128:131], a[176:179], a[248:251], a[128:131]
s_lshl_b32 s34, s34, 2
s_add_u32 s33, s33, s34
M a[132:135], a[184:187], a[248:251], a[132:135]
ds_read_b64_tr_b16 a[220:221], v16 offset:12288
ds_read_b64_tr_b16 a[222:223], v16 offset:13824
M a[132:135], a[188:191], a[252:255], a[132:135]
buffer_load_dwordx4 v22, s[12:15], s25 offen offset:1024 lds
s_lshl_b32 s64, s33, 12
s_mov_b32 s44, s4
M a[136:139], a[196:199], a[252:255], a[136:139]
s_mov_b32 s45, s5
s_mov_b32 s46, 16777216
M a[136:139], a[192:195], a[248:251], a[136:139]
s_waitcnt lgkmcnt(10)
M a[140:143], a[176:179], a[224:227], a[140:143]
s_sub_u32 s54, s54, 1
s_cmp_eq_u32 s54, 0
s_cselect_b32 s58, s55, s56
s_add_u32 s25, s25, s58
s_mov_b32 s47, 0x00020000
M a[140:143], a[180:183], a[228:231], a[140:143]
M a[144:147], a[188:191], a[228:231], a[144:147]
M a[144:147], a[184:187], a[224:227], a[144:147]
M a[148:151], a[192:195], a[224:227], a[148:151]
s_waitcnt vmcnt(12) lgkmcnt(0)
s_barrier
ds_read_b128 a[248:251], v10 offset:18432
ds_read_b128 a[252:255], v11 offset:18432
M a[148:151], a[196:199], a[228:231], a[148:151]
s_add_u32 m0, s28, 0
s_nop 0
buffer_load_dword v20, s[8:11], s24 offen lds
M a[152:155], a[180:183], a[236:239], a[152:155]
ds_read_b128 a[224:227], v10 offset:20480
ds_read_b128 a[228:231], v11 offset:20480
M a[152:155], a[176:179], a[232:235], a[152:155]
M a[156:159], a[184:187], a[232:235], a[156:159]
buffer_load_dword v23, s[8:11], s24 offen offset:256 lds
M a[156:159], a[188:191], a[236:239], a[156:159]
M a[160:163], a[196:199], a[236:239], a[160:163]
M a[160:163], a[192:195], a[232:235], a[160:163]
s_add_u32 m0, s29, 2048
s_nop 0
buffer_load_dwordx4 v2, s[8:11], s23 offen offset:0 lds
M a[164:167], a[176:179], a[240:243], a[164:167]
ds_read_b128 a[232:235], v10 offset:22528
ds_read_b128 a[236:239], v11 offset:22528
M a[164:167], a[180:183], a[244:247], a[164:167]
M a[168:171], a[188:191], a[244:247], a[168:171]
M a[168:171], a[184:187], a[240:243], a[168:171]
buffer_load_dwordx4 v3, s[8:11], s23 offen offset:1024 lds
M a[172:175], a[192:195], a[240:243], a[172:175]
M a[172:175], a[196:199], a[244:247], a[172:175]
s_waitcnt lgkmcnt(4)
M a[68:71], a[200:203], a[248:251], a[68:71]
ds_read_b128 a[240:243], v10 offset:24576
ds_read_b128 a[244:247], v11 offset:24576
M a[68:71], a[204:207], a[252:255], a[68:71]
buffer_load_dwordx4 v4, s[8:11], s23 offen offset:2048 lds
M a[72:75], a[212:215], a[252:255], a[72:75]
ds_read_b64_tr_b16 a[176:177], v14 offset:28672
ds_read_b64_tr_b16 a[178:179], v14 offset:30208
M a[72:75], a[208:211], a[248:251], a[72:75]
M a[76:79], a[216:219], a[248:251], a[76:79]
buffer_load_dwordx4 v5, s[8:11], s23 offen offset:3072 lds
M a[76:79], a[220:223], a[252:255], a[76:79]
s_waitcnt lgkmcnt(6)
M a[80:83], a[204:207], a[228:231], a[80:83]
ds_read_b128 a[248:251], v10 offset:26624
ds_read_b128 a[252:255], v11 offset:26624
M a[80:83], a[200:203], a[224:227], a[80:83]
M a[84:87], a[208:211], a[224:227], a[84:87]
ds_read_b64_tr_b16 a[184:185], v15 offset:28672
ds_read_b64_tr_b16 a[186:187], v15 offset:30208
M a[84:87], a[212:215], a[228:231], a[84:87]
s_sub_u32 s31, s31, 1
s_cmp_eq_u32 s31, 0
s_cselect_b32 s58, -1920, s57
s_add_u32 s23, s23, s58
s_add_u32 s24, s24, s58
M a[88:91], a[220:223], a[228:231], a[88:91]
M a[88:91], a[216:219], a[224:227], a[88:91]
s_waitcnt lgkmcnt(8)
M a[92:95], a[200:203], a[232:235], a[92:95]
ds_read_b128 a[224:227], v10 offset:28672
ds_read_b128 a[228:231], v11 offset:28672
M a[92:95], a[204:207], a[236:239], a[92:95]
s_add_u32 m0, s30, 36864
s_nop 0
buffer_load_dwordx4 v6, s[12:15], s25 offen offset:0 lds
M a[96:99], a[212:215], a[236:239], a[96:99]
ds_read_b64_tr_b16 a[192:193], v16 offset:28672
ds_read_b64_tr_b16 a[194:195], v16 offset:30208
M a[96:99], a[208:211], a[232:235], a[96:99]
M a[100:103], a[216:219], a[232:235], a[100:103]
buffer_load_dwordx4 v7, s[12:15], s25 offen offset:1024 lds
M a[100:103], a[220:223], a[236:239], a[100:103]
s_waitcnt lgkmcnt(10)
M a[104:107], a[204:207], a[244:247], a[104:107]
ds_read_b128 a[232:235], v10 offset:30720
ds_read_b128 a[236:239], v11 offset:30720
M a[104:107], a[200:203], a[240:243], a[104:107]
M a[108:111], a[208:211], a[240:243], a[108:111]
ds_read_b64_tr_b16 a[180:181], v14 offset:40960
ds_read_b64_tr_b16 a[182:183], v14 offset:42496
M a[108:111], a[212:215], a[244:247], a[108:111]
buffer_load_dwordx4 v8, s[12:15], s25 offen offset:2048 lds
M a[112:115], a[220:223], a[244:247], a[112:115]
M a[112:115], a[216:219], a[240:243], a[112:115]
s_waitcnt lgkmcnt(10)
M a[116:119], a[200:203], a[248:251], a[116:119]
ds_read_b128 a[240:243], v10 offset:32768
ds_read_b128 a[244:247], v11 offset:32768
M a[116:119], a[204:207], a[252:255], a[116:119]
buffer_load_dwordx4 v9, s[12:15], s25 offen offset:3072 lds
M a[120:123], a[212:215], a[252:255], a[120:123]
ds_read_b64_tr_b16 a[188:189], v15 offset:40960
ds_read_b64_tr_b16 a[190:191], v15 offset:42496
M a[120:123], a[208:211], a[248:251], a[120:123]
M a[124:127], a[216:219], a[248:251], a[124:127]
s_add_u32 m0, s30, 40960
s_nop 0
buffer_load_dwordx4 v21, s[12:15], s25 offen offset:0 lds
M a[124:127], a[220:223], a[252:255], a[124:127]
s_waitcnt lgkmcnt(10)
M a[128:131], a[204:207], a[228:231], a[128:131]
ds_read_b128 a[248:251], v10 offset:34816
ds_read_b128 a[252:255], v11 offset:34816
M a[128:131], a[200:203], a[224:227], a[128:131]
M a[132:135], a[208:211], a[224:227], a[132:135]
ds_read_b64_tr_b16 a[196:197], v16 offset:40960
ds_read_b64_tr_b16 a[198:199], v16 offset:42496
M a[132:135], a[212:215], a[228:231], a[132:135]
buffer_load_dwordx4 v22, s[12:15], s25 offen offset:1024 lds
M a[136:139], a[220:223], a[228:231], a[136:139]
M a[136:139], a[216:219], a[224:227], a[136:139]
s_waitcnt lgkmcnt(10)
M a[140:143], a[200:203], a[232:235], a[140:143]
s_sub_u32 s54, s54, 1
s_cmp_eq_u32 s54, 0
s_cselect_b32 s58, s55, s56
s_add_u32 s25, s25, s58
M a[140:143], a[204:207], a[236:239], a[140:143]
M a[144:147], a[212:215], a[236:239], a[144:147]
M a[144:147], a[208:211], a[232:235], a[144:147]
M a[148:151], a[216:219], a[232:235], a[148:151]
s_waitcnt vmcnt(12) lgkmcnt(0)
s_barrier
ds_read_b128 a[224:227], v12 offset:0
ds_read_b128 a[228:231], v13 offset:0
M a[148:151], a[220:223], a[236:239], a[148:151]
s_add_u32 m0, s28, 18432
s_nop 0
buffer_load_dword v20, s[8:11], s24 offen lds
M a[152:155], a[204:207], a[244:247], a[152:155]
ds_read_b128 a[232:235], v12 offset:2048
ds_read_b128 a[236:239], v13 offset:2048
M a[152:155], a[200:203], a[240:243], a[152:155]
M a[156:159], a[208:211], a[240:243], a[156:159]
buffer_load_dword v23, s[8:11], s24 offen offset:256 lds
M a[156:159], a[212:215], a[244:247], a[156:159]
M a[160:163], a[220:223], a[244:247], a[160:163]
M a[160:163], a[216:219], a[240:243], a[160:163]
s_add_u32 m0, s29, 20480
s_nop 0
buffer_load_dwordx4 v2, s[8:11], s23 offen offset:0 lds
M a[164:167], a[200:203], a[248:251], a[164:167]
ds_read_b128 a[240:243], v12 offset:4096
ds_read_b128 a[244:247], v13 offset:4096
M a[164:167], a[204:207], a[252:255], a[164:167]
M a[168:171], a[212:215], a[252:255], a[168:171]
M a[168:171], a[208:211], a[248:251], a[168:171]
buffer_load_dwordx4 v3, s[8:11], s23 offen offset:1024 lds
M a[172:175], a[216:219], a[248:251], a[172:175]
M a[172:175], a[220:223], a[252:255], a[172:175]
s_waitcnt lgkmcnt(4)
M a[68:71], a[176:179], a[224:227], a[68:71]
ds_read_b128 a[248:251], v12 offset:6144
ds_read_b128 a[252:255], v13 offset:6144
M a[68:71], a[180:183], a[228:231], a[68:71]
buffer_load_dwordx4 v4, s[8:11], s23 offen offset:2048 lds
M a[72:75], a[188:191], a[228:231], a[72:75]
ds_read_b64_tr_b16 a[200:201], v17 offset:0
ds_read_b64_tr_b16 a[202:203], v17 offset:1536
M a[72:75], a[184:187], a[224:227], a[72:75]
M a[76:79], a[192:195], a[224:227], a[76:79]
buffer_load_dwordx4 v5, s[8:11], s23 offen offset:3072 lds
M a[76:79], a[196:199], a[228:231], a[76:79]
s_waitcnt lgkmcnt(6)
M a[80:83], a[180:183], a[236:239], a[80:83]
ds_read_b128 a[224:227], v12 offset:8192
ds_read_b128 a[228:231], v13 offset:8192
M a[80:83], a[176:179], a[232:235], a[80:83]
s_sub_u32 s31, s31, 1
s_cmp_eq_u32 s31, 0
s_cselect_b32 s58, -1920, s57
s_add_u32 s23, s23, s58
s_add_u32 s24, s24, s58
M a[84:87], a[184:187], a[232:235], a[84:87]
ds_read_b64_tr_b16 a[208:209], v18 offset:0
ds_read_b64_tr_b16 a[210:211], v18 offset:1536
M a[84:87], a[188:191], a[236:239], a[84:87]
M a[88:91], a[196:199], a[236:239], a[88:91]
M a[88:91], a[192:195], a[232:235], a[88:91]
s_add_u32 m0, s30, 65536
s_nop 0
buffer_load_dwordx4 v6, s[12:15], s25 offen offset:0 lds
s_waitcnt lgkmcnt(8)
M a[92:95], a[176:179], a[240:243], a[92:95]
ds_read_b128 a[232:235], v12 offset:10240
ds_read_b128 a[236:239], v13 offset:10240
M a[92:95], a[180:183], a[244:247], a[92:95]
M a[96:99], a[188:191], a[244:247], a[96:99]
ds_read_b64_tr_b16 a[216:217], v19 offset:0
ds_read_b64_tr_b16 a[218:219], v19 offset:1536
M a[96:99], a[184:187], a[240:243], a[96:99]
buffer_load_dwordx4 v7, s[12:15], s25 offen offset:1024 lds
M a[100:103], a[192:195], a[240:243], a[100:103]
M a[100:103], a[196:199], a[244:247], a[100:103]
s_waitcnt lgkmcnt(10)
M a[104:107], a[180:183], a[252:255], a[104:107]
ds_read_b128 a[240:243], v12 offset:12288
ds_read_b128 a[244:247], v13 offset:12288
M a[104:107], a[176:179], a[248:251], a[104:107]
buffer_load_dwordx4 v8, s[12:15], s25 offen offset:2048 lds
M a[108:111], a[184:187], a[248:251], a[108:111]
ds_read_b64_tr_b16 a[204:205], v17 offset:12288
ds_read_b64_tr_b16 a[206:207], v17 offset:13824
M a[108:111], a[188:191], a[252:255], a[108:111]
M a[112:115], a[196:199], a[252:255], a[112:115]
buffer_load_dwordx4 v9, s[12:15], s25 offen offset:3072 lds
M a[112:115], a[192:195], a[248:251], a[112:115]
s_waitcnt lgkmcnt(10)
M a[116:119], a[176:179], a[224:227], a[116:119]
ds_read_b128 a[248:251], v12 offset:14336
ds_read_b128 a[252:255], v13 offset:14336
M a[116:119], a[180:183], a[228:231], a[116:119]
M a[120:123], a[188:191], a[228:231], a[120:123]
ds_read_b64_tr_b16 a[212:213], v18 offset:12288
ds_read_b64_tr_b16 a[214:215], v18 offset:13824
M a[120:123], a[184:187], a[224:227], a[120:123]
s_add_u32 m0, s30, 69632
s_nop 0
buffer_load_dwordx4 v21, s[12:15], s25 offen offset:0 lds
M a[124:127], a[192:195], a[224:227], a[124:127]
M a[124:127], a[196:199], a[228:231], a[124:127]
buffer_load_dwordx4 v22, s[12:15], s25 offen offset:1024 lds
s_waitcnt lgkmcnt(10)
M a[128:131], a[180:183], a[236:239], a[128:131]
ds_read_b128 a[224:227], v12 offset:16384
ds_read_b128 a[228:231], v13 offset:16384
M a[128:131], a[176:179], a[232:235], a[128:131]
M a[132:135], a[184:187], a[232:235], a[132:135]
ds_read_b64_tr_b16 a[220:221], v19 offset:12288
ds_read_b64_tr_b16 a[222:223], v19 offset:13824
M a[132:135], a[188:191], a[236:239], a[132:135]
M a[136:139], a[196:199], a[236:239], a[136:139]
s_sub_u32 s54, s54, 1
s_cmp_eq_u32 s54, 0
s_cselect_b32 s58, s55, s56
s_add_u32 s25, s25, s58
M a[136:139], a[192:195], a[232:235], a[136:139]
s_waitcnt lgkmcnt(10)
M a[140:143], a[176:179], a[240:243], a[140:143]
buffer_load_dword v125, v119, s[36:39], 0 offen sc1
M a[140:143], a[180:183], a[244:247], a[140:143]
M a[144:147], a[188:191], a[244:247], a[144:147]
M a[144:147], a[184:187], a[240:243], a[144:147]
M a[148:151], a[192:195], a[240:243], a[148:151]
s_waitcnt vmcnt(13) lgkmcnt(0)
s_barrier
ds_read_b128 a[232:235], v10 offset:0
ds_read_b128 a[236:239], v11 offset:0
s_waitcnt vmcnt(0)
v_cmp_gt_u32 vcc, 0x80, v125
s_nop 0
s_cbranch_vccnz Lk1_spinq
Lk1_gotq:
M a[148:151], a[196:199], a[244:247], a[148:151]
s_add_u32 m0, s28, 131072
s_nop 0
buffer_load_dword v20, s[8:11], s24 offen lds
M a[152:155], a[180:183], a[252:255], a[152:155]
ds_read_b128 a[240:243], v10 offset:2048
ds_read_b128 a[244:247], v11 offset:2048
M a[152:155], a[176:179], a[248:251], a[152:155]
M a[156:159], a[184:187], a[248:251], a[156:159]
buffer_load_dword v23, s[8:11], s24 offen offset:256 lds
M a[156:159], a[188:191], a[252:255], a[156:159]
M a[160:163], a[196:199], a[252:255], a[160:163]
M a[160:163], a[192:195], a[248:251], a[160:163]
s_add_u32 m0, s29, 133120
s_nop 0
buffer_load_dwordx4 v2, s[8:11], s23 offen offset:0 lds
M a[164:167], a[176:179], a[224:227], a[164:167]
ds_read_b128 a[248:251], v10 offset:4096
ds_read_b128 a[252:255], v11 offset:4096
M a[164:167], a[180:183], a[228:231], a[164:167]
M a[168:171], a[188:191], a[228:231], a[168:171]
M a[168:171], a[184:187], a[224:227], a[168:171]
buffer_load_dwordx4 v3, s[8:11], s23 offen offset:1024 lds
M a[172:175], a[192:195], a[224:227], a[172:175]
M a[172:175], a[196:199], a[228:231], a[172:175]
s_waitcnt lgkmcnt(4)
M a[68:71], a[200:203], a[232:235], a[68:71]
ds_read_b128 a[224:227], v10 offset:6144
ds_read_b128 a[228:231], v11 offset:6144
v_mov_b32 v208, 0
v_mov_b32 v209, 0
M a[68:71], a[204:207], a[236:239], a[68:71]
buffer_load_dwordx4 v4, s[8:11], s23 offen offset:2048 lds
M a[72:75], a[212:215], a[236:239], a[72:75]
ds_read_b64_tr_b16 a[176:177], v14 offset:0
ds_read_b64_tr_b16 a[178:179], v14 offset:1536
v_mov_b32 v210, 0
v_mov_b32 v211, 0
M a[72:75], a[208:211], a[232:235], a[72:75]
M a[76:79], a[216:219], a[232:235], a[76:79]
buffer_load_dwordx4 v5, s[8:11], s23 offen offset:3072 lds
v_mov_b32 v212, 0
v_mov_b32 v213, 0
M a[76:79], a[220:223], a[236:239], a[76:79]
s_waitcnt lgkmcnt(6)
M a[80:83], a[204:207], a[244:247], a[80:83]
ds_read_b128 a[232:235], v10 offset:8192
ds_read_b128 a[236:239], v11 offset:8192
v_mov_b32 v214, 0
v_mov_b32 v215, 0
M a[80:83], a[200:203], a[240:243], a[80:83]
s_sub_u32 s31, s31, 1
s_cmp_eq_u32 s31, 0
s_cselect_b32 s58, -1920, s57
s_add_u32 s23, s23, s58
s_add_u32 s24, s24, s58
M a[84:87], a[208:211], a[240:243], a[84:87]
ds_read_b64_tr_b16 a[184:185], v15 offset:0
ds_read_b64_tr_b16 a[186:187], v15 offset:1536
M a[84:87], a[212:215], a[244:247], a[84:87]
v_mov_b32 v216, 0
v_mov_b32 v217, 0
M a[88:91], a[220:223], a[244:247], a[88:91]
M a[88:91], a[216:219], a[240:243], a[88:91]
buffer_load_dwordx4 a[0:3], v1, s[44:47], s64 offen offset:0 sc1
s_waitcnt lgkmcnt(8)
v_mov_b32 v218, 0
v_mov_b32 v219, 0
M a[92:95], a[200:203], a[248:251], a[92:95]
ds_read_b128 a[240:243], v10 offset:10240
ds_read_b128 a[244:247], v11 offset:10240
M a[92:95], a[204:207], a[252:255], a[92:95]
v_mov_b32 v220, 0
v_mov_b32 v221, 0
M a[96:99], a[212:215], a[252:255], a[96:99]
ds_read_b64_tr_b16 a[192:193], v16 offset:0
ds_read_b64_tr_b16 a[194:195], v16 offset:1536
M a[96:99], a[208:211], a[248:251], a[96:99]
buffer_load_dwordx4 a[4:7], v1, s[44:47], s64 offen offset:1024 sc1
v_mov_b32 v222, 0
v_mov_b32 v223, 0
M a[100:103], a[216:219], a[248:251], a[100:103]
M a[100:103], a[220:223], a[252:255], a[100:103]
s_waitcnt lgkmcnt(10)
M a[104:107], a[204:207], a[228:231], a[104:107]
ds_read_b128 a[248:251], v10 offset:12288
ds_read_b128 a[252:255], v11 offset:12288
v_mov_b32 v224, 0
v_mov_b32 v225, 0
M a[104:107], a[200:203], a[224:227], a[104:107]
buffer_load_dwordx4 a[8:11], v1, s[44:47], s64 offen offset:2048 sc1
M a[108:111], a[208:211], a[224:227], a[108:111]
ds_read_b64_tr_b16 a[180:181], v14 offset:12288
ds_read_b64_tr_b16 a[182:183], v14 offset:13824
v_mov_b32 v226, 0
v_mov_b32 v227, 0
M a[108:111], a[212:215], a[228:231], a[108:111]
M a[112:115], a[220:223], a[228:231], a[112:115]
buffer_load_dwordx4 a[12:15], v1, s[44:47], s64 offen offset:3072 sc1
s_add_u32 s64, s64, 4096
v_mov_b32 v228, 0
v_mov_b32 v229, 0
M a[112:115], a[216:219], a[224:227], a[112:115]
s_waitcnt lgkmcnt(10)
M a[116:119], a[200:203], a[232:235], a[116:119]
ds_read_b128 a[224:227], v10 offset:14336
ds_read_b128 a[228:231], v11 offset:14336
v_mov_b32 v230, 0
v_mov_b32 v231, 0
M a[116:119], a[204:207], a[236:239], a[116:119]
M a[120:123], a[212:215], a[236:239], a[120:123]
ds_read_b64_tr_b16 a[188:189], v15 offset:12288
ds_read_b64_tr_b16 a[190:191], v15 offset:13824
M a[120:123], a[208:211], a[232:235], a[120:123]
buffer_load_dwordx4 a[16:19], v1, s[44:47], s64 offen offset:0 sc1
v_mov_b32 v232, 0
v_mov_b32 v233, 0
M a[124:127], a[216:219], a[232:235], a[124:127]
M a[124:127], a[220:223], a[236:239], a[124:127]
buffer_load_dwordx4 a[20:23], v1, s[44:47], s64 offen offset:1024 sc1
s_waitcnt lgkmcnt(10)
v_mov_b32 v234, 0
v_mov_b32 v235, 0
M a[128:131], a[204:207], a[244:247], a[128:131]
ds_read_b128 a[232:235], v10 offset:16384
ds_read_b128 a[236:239], v11 offset:16384
M a[128:131], a[200:203], a[240:243], a[128:131]
v_mov_b32 v236, 0
v_mov_b32 v237, 0
M a[132:135], a[208:211], a[240:243], a[132:135]
ds_read_b64_tr_b16 a[196:197], v16 offset:12288
ds_read_b64_tr_b16 a[198:199], v16 offset:13824
M a[132:135], a[212:215], a[244:247], a[132:135]
v_mov_b32 v238, 0
v_mov_b32 v239, 0
M a[136:139], a[220:223], a[244:247], a[136:139]
buffer_load_dwordx4 a[24:27], v1, s[44:47], s64 offen offset:2048 sc1
M a[136:139], a[216:219], a[240:243], a[136:139]
s_waitcnt lgkmcnt(10)
M a[140:143], a[200:203], a[248:251], a[140:143]
buffer_load_dwordx4 a[28:31], v1, s[44:47], s64 offen offset:3072 sc1
s_add_u32 s64, s64, 4096
v_mov_b32 v240, 0
v_mov_b32 v241, 0
M a[140:143], a[204:207], a[252:255], a[140:143]
M a[144:147], a[212:215], a[252:255], a[144:147]
v_mov_b32 v242, 0
v_mov_b32 v243, 0
M a[144:147], a[208:211], a[248:251], a[144:147]
M a[148:151], a[216:219], a[248:251], a[148:151]
s_waitcnt vmcnt(15) lgkmcnt(0)
s_barrier
ds_read_b128 a[240:243], v10 offset:18432
ds_read_b128 a[244:247], v11 offset:18432
v_mov_b32 v244, 0
v_mov_b32 v245, 0
M a[148:151], a[220:223], a[252:255], a[148:151]
buffer_load_dwordx4 a[32:35], v1, s[44:47], s64 offen offset:0 sc1
M a[152:155], a[204:207], a[228:231], a[152:155]
ds_read_b128 a[248:251], v10 offset:20480
ds_read_b128 a[252:255], v11 offset:20480
v_mov_b32 v246, 0
v_mov_b32 v247, 0
M a[152:155], a[200:203], a[224:227], a[152:155]
M a[156:159], a[208:211], a[224:227], a[156:159]
buffer_load_dwordx4 a[36:39], v1, s[44:47], s64 offen offset:1024 sc1
M a[156:159], a[212:215], a[228:231], a[156:159]
v_mov_b32 v248, 0
v_mov_b32 v249, 0
M a[160:163], a[220:223], a[228:231], a[160:163]
M a[160:163], a[216:219], a[224:227], a[160:163]
buffer_load_dwordx4 a[40:43], v1, s[44:47], s64 offen offset:2048 sc1
v_mov_b32 v250, 0
v_mov_b32 v251, 0
M a[164:167], a[200:203], a[232:235], a[164:167]
ds_read_b128 a[224:227], v10 offset:22528
ds_read_b128 a[228:231], v11 offset:22528
M a[164:167], a[204:207], a[236:239], a[164:167]
v_mov_b32 v252, 0
v_mov_b32 v253, 0
M a[168:171], a[212:215], a[236:239], a[168:171]
M a[168:171], a[208:211], a[232:235], a[168:171]
buffer_load_dwordx4 a[44:47], v1, s[44:47], s64 offen offset:3072 sc1
s_add_u32 s64, s64, 4096
v_mov_b32 v254, 0
v_mov_b32 v255, 0
M a[172:175], a[216:219], a[232:235], a[172:175]
M a[172:175], a[220:223], a[236:239], a[172:175]
s_waitcnt lgkmcnt(4)
M a[68:71], a[176:179], a[240:243], a[68:71]
ds_read_b128 a[232:235], v10 offset:24576
ds_read_b128 a[236:239], v11 offset:24576
s_mov_b32 s22, s101
s_and_b32 s23, s22, 1
M a[68:71], a[180:183], a[244:247], a[68:71]
buffer_load_dwordx4 a[48:51], v1, s[44:47], s64 offen offset:0 sc1
s_lshr_b32 s24, s22, 1
s_lshl_b32 s33, s24, 14
M a[72:75], a[188:191], a[244:247], a[72:75]
ds_read_b64_tr_b16 a[200:201], v14 offset:28672
ds_read_b64_tr_b16 a[202:203], v14 offset:30208
M a[72:75], a[184:187], a[240:243], a[72:75]
s_lshl_b32 s34, s23, 13
s_add_u32 s29, s33, s34
M a[76:79], a[192:195], a[240:243], a[76:79]
M a[76:79], a[196:199], a[244:247], a[76:79]
s_waitcnt lgkmcnt(6)
s_lshl_b32 s28, s20, 20
s_add_u32 s28, s28, s34
M a[80:83], a[180:183], a[252:255], a[80:83]
ds_read_b128 a[240:243], v10 offset:26624
ds_read_b128 a[244:247], v11 offset:26624
M a[80:83], a[176:179], a[248:251], a[80:83]
s_mov_b32 s25, s28
s_lshl_b32 s33, s21, 16
M a[84:87], a[184:187], a[248:251], a[84:87]
ds_read_b64_tr_b16 a[208:209], v15 offset:28672
ds_read_b64_tr_b16 a[210:211], v15 offset:30208
M a[84:87], a[188:191], a[252:255], a[84:87]
buffer_load_dwordx4 a[52:55], v1, s[44:47], s64 offen offset:1024 sc1
s_add_u32 s34, s28, s33
s_add_u32 s34, s34, 65536
M a[88:91], a[196:199], a[252:255], a[88:91]
M a[88:91], a[192:195], a[248:251], a[88:91]
s_waitcnt lgkmcnt(8)
s_add_u32 s32, s28, 491520
s_sub_u32 s33, s32, s33
M a[92:95], a[176:179], a[224:227], a[92:95]
ds_read_b128 a[248:251], v10 offset:28672
ds_read_b128 a[252:255], v11 offset:28672
M a[92:95], a[180:183], a[228:231], a[92:95]
s_add_u32 s33, s33, 491520
s_cmp_eq_u32 s24, 0
s_cselect_b32 s27, s34, s32
s_cselect_b32 s28, s32, s33
M a[96:99], a[188:191], a[228:231], a[96:99]
ds_read_b64_tr_b16 a[216:217], v16 offset:28672
ds_read_b64_tr_b16 a[218:219], v16 offset:30208
M a[96:99], a[184:187], a[224:227], a[96:99]
s_mov_b32 s56, s27
s_mov_b32 s57, s28
M a[100:103], a[192:195], a[224:227], a[100:103]
buffer_load_dwordx4 a[56:59], v1, s[44:47], s64 offen offset:2048 sc1
M a[100:103], a[196:199], a[228:231], a[100:103]
s_waitcnt lgkmcnt(10)
s_min_u32 s34, s34, s32
s_cmp_eq_u32 s34, s32
s_cselect_b32 s33, s33, s34
M a[104:107], a[180:183], a[236:239], a[104:107]
ds_read_b128 a[224:227], v10 offset:30720
ds_read_b128 a[228:231], v11 offset:30720
M a[104:107], a[176:179], a[232:235], a[104:107]
s_or_b32 s34, s34, 0x40000000
s_or_b32 s32, s25, 0x40000000
M a[108:111], a[184:187], a[232:235], a[108:111]
ds_read_b64_tr_b16 a[204:205], v14 offset:40960
ds_read_b64_tr_b16 a[206:207], v14 offset:42496
s_cmp_eq_u32 s24, 1
s_cselect_b32 s25, s32, s25
s_cselect_b32 s27, s34, s27
s_cselect_b32 s28, s33, s28
s_cselect_b32 s56, s56, -1
M a[108:111], a[188:191], a[236:239], a[108:111]
M a[112:115], a[196:199], a[236:239], a[112:115]
s_add_u32 s58, s56, 16384
s_add_u32 s59, s57, 16384
M a[112:115], a[192:195], a[232:235], a[112:115]
s_waitcnt lgkmcnt(10)
M a[116:119], a[176:179], a[240:243], a[116:119]
ds_read_b128 a[232:235], v10 offset:32768
ds_read_b128 a[236:239], v11 offset:32768
s_add_u32 s26, s25, 16384
s_add_u32 s62, s27, 16384
M a[116:119], a[180:183], a[244:247], a[116:119]
buffer_load_dwordx4 a[60:63], v1, s[44:47], s64 offen offset:3072 sc1
M a[120:123], a[188:191], a[244:247], a[120:123]
ds_read_b64_tr_b16 a[212:213], v15 offset:40960
ds_read_b64_tr_b16 a[214:215], v15 offset:42496
s_add_u32 s63, s28, 16384
s_lshl_b32 s31, s21, 7
M a[120:123], a[184:187], a[240:243], a[120:123]
M a[124:127], a[192:195], a[240:243], a[124:127]
s_cmp_eq_u32 s24, 0
s_cselect_b32 s31, s31, 960
M a[124:127], a[196:199], a[244:247], a[124:127]
s_waitcnt lgkmcnt(10)
M a[128:131], a[180:183], a[252:255], a[128:131]
ds_read_b128 a[240:243], v10 offset:34816
ds_read_b128 a[244:247], v11 offset:34816
s_mov_b32 s60, 0
s_add_u32 s12, s4, 16777216
s_addc_u32 s13, s5, 0
M a[128:131], a[176:179], a[248:251], a[128:131]
M a[132:135], a[184:187], a[248:251], a[132:135]
ds_read_b64_tr_b16 a[220:221], v16 offset:40960
ds_read_b64_tr_b16 a[222:223], v16 offset:42496
s_mov_b32 s14, 33554432
s_mov_b32 s15, 0x00020000
M a[132:135], a[188:191], a[252:255], a[132:135]
buffer_load_dword v126, v119, s[36:39], 0 offen offset:128 sc1
M a[136:139], a[196:199], a[252:255], a[136:139]
s_mov_b32 s8, s4
s_mov_b32 s9, s5
M a[136:139], a[192:195], a[248:251], a[136:139]
s_waitcnt lgkmcnt(10)
M a[140:143], a[176:179], a[224:227], a[140:143]
s_mov_b32 s10, 16777216
s_mov_b32 s11, 0x00020000
M a[140:143], a[180:183], a[228:231], a[140:143]
M a[144:147], a[188:191], a[228:231], a[144:147]
M a[144:147], a[184:187], a[224:227], a[144:147]
M a[148:151], a[192:195], a[224:227], a[148:151]
s_waitcnt vmcnt(17) lgkmcnt(0)
s_barrier
ds_read_b128 a[248:251], v12 offset:0
ds_read_b128 a[252:255], v13 offset:0
s_waitcnt vmcnt(0)
v_cmp_gt_u32 vcc, 0x80, v126
s_nop 0
s_cbranch_vccnz Lk1_spin
Lk1_got:
M a[148:151], a[196:199], a[228:231], a[148:151]
s_add_u32 m0, s29, 65536
s_add_u32 s32, s25, 4096
buffer_load_dwordx4 v1, s[12:15], s25 offen offset:0 sc1 lds
M a[152:155], a[180:183], a[236:239], a[152:155]
ds_read_b128 a[224:227], v12 offset:2048
ds_read_b128 a[228:231], v13 offset:2048
M a[152:155], a[176:179], a[232:235], a[152:155]
buffer_load_dwordx4 v1, s[12:15], s25 offen offset:1024 sc1 lds
M a[156:159], a[184:187], a[232:235], a[156:159]
M a[156:159], a[188:191], a[236:239], a[156:159]
buffer_load_dwordx4 v1, s[12:15], s25 offen offset:2048 sc1 lds
M a[160:163], a[196:199], a[236:239], a[160:163]
buffer_load_dwordx4 v1, s[12:15], s25 offen offset:3072 sc1 lds
M a[160:163], a[192:195], a[232:235], a[160:163]
M a[164:167], a[176:179], a[240:243], a[164:167]
ds_read_b128 a[232:235], v12 offset:4096
ds_read_b128 a[236:239], v13 offset:4096
M a[164:167], a[180:183], a[244:247], a[164:167]
s_add_u32 m0, s29, 69632
s_nop 0
buffer_load_dwordx4 v1, s[12:15], s32 offen offset:0 sc1 lds
M a[168:171], a[188:191], a[244:247], a[168:171]
buffer_load_dwordx4 v1, s[12:15], s32 offen offset:1024 sc1 lds
M a[168:171], a[184:187], a[240:243], a[168:171]
M a[172:175], a[192:195], a[240:243], a[172:175]
buffer_load_dwordx4 v1, s[12:15], s32 offen offset:2048 sc1 lds
M a[172:175], a[196:199], a[244:247], a[172:175]
s_waitcnt lgkmcnt(4)
M a[68:71], a[200:203], a[248:251], a[68:71]
ds_read_b128 a[240:243], v12 offset:6144
ds_read_b128 a[244:247], v13 offset:6144
M a[68:71], a[204:207], a[252:255], a[68:71]
buffer_load_dwordx4 v1, s[12:15], s32 offen offset:3072 sc1 lds
M a[72:75], a[212:215], a[252:255], a[72:75]
M a[72:75], a[208:211], a[248:251], a[72:75]
M a[76:79], a[216:219], a[248:251], a[76:79]
M a[76:79], a[220:223], a[252:255], a[76:79]
s_waitcnt lgkmcnt(4)
M a[80:83], a[204:207], a[228:231], a[80:83]
ds_read_b128 a[248:251], v12 offset:8192
ds_read_b128 a[252:255], v13 offset:8192
M a[80:83], a[200:203], a[224:227], a[80:83]
M a[84:87], a[208:211], a[224:227], a[84:87]
M a[84:87], a[212:215], a[228:231], a[84:87]
M a[88:91], a[220:223], a[228:231], a[88:91]
M a[88:91], a[216:219], a[224:227], a[88:91]
s_waitcnt lgkmcnt(4)
M a[92:95], a[200:203], a[232:235], a[92:95]
ds_read_b128 a[224:227], v12 offset:10240
ds_read_b128 a[228:231], v13 offset:10240
v_accvgpr_read_b32 v24, a68
v_accvgpr_read_b32 v25, a69
v_accvgpr_read_b32 v26, a70
M a[92:95], a[204:207], a[236:239], a[92:95]
v_accvgpr_read_b32 v27, a71
v_cvt_pk_bf16_f32 v24, v24, v25
v_cvt_pk_bf16_f32 v25, v26, v27
ds_write_b64 v124, v[24:25] offset:0
M a[96:99], a[212:215], a[236:239], a[96:99]
v_accvgpr_read_b32 v28, a72
v_accvgpr_read_b32 v29, a73
v_accvgpr_read_b32 v30, a74
M a[96:99], a[208:211], a[232:235], a[96:99]
v_accvgpr_read_b32 v31, a75
v_cvt_pk_bf16_f32 v28, v28, v29
v_cvt_pk_bf16_f32 v29, v30, v31
ds_write_b64 v124, v[28:29] offset:32
M a[100:103], a[216:219], a[232:235], a[100:103]
v_accvgpr_read_b32 v24, a76
v_accvgpr_read_b32 v25, a77
v_accvgpr_read_b32 v26, a78
M a[100:103], a[220:223], a[236:239], a[100:103]
s_waitcnt lgkmcnt(6)
v_accvgpr_read_b32 v27, a79
v_cvt_pk_bf16_f32 v24, v24, v25
v_cvt_pk_bf16_f32 v25, v26, v27
ds_write_b64 v124, v[24:25] offset:64
M a[104:107], a[204:207], a[244:247], a[104:107]
ds_read_b128 a[232:235], v12 offset:12288
ds_read_b128 a[236:239], v13 offset:12288
v_accvgpr_read_b32 v24, a80
v_accvgpr_read_b32 v25, a81
v_accvgpr_read_b32 v26, a82
M a[104:107], a[200:203], a[240:243], a[104:107]
v_accvgpr_read_b32 v27, a83
v_cvt_pk_bf16_f32 v24, v24, v25
v_cvt_pk_bf16_f32 v25, v26, v27
ds_write_b64 v124, v[24:25] offset:6400
M a[108:111], a[208:211], a[240:243], a[108:111]
v_accvgpr_read_b32 v28, a84
v_accvgpr_read_b32 v29, a85
v_accvgpr_read_b32 v30, a86
M a[108:111], a[212:215], a[244:247], a[108:111]
v_accvgpr_read_b32 v31, a87
v_cvt_pk_bf16_f32 v28, v28, v29
v_cvt_pk_bf16_f32 v29, v30, v31
ds_write_b64 v124, v[28:29] offset:6432
M a[112:115], a[220:223], a[244:247], a[112:115]
v_accvgpr_read_b32 v24, a88
v_accvgpr_read_b32 v25, a89
v_accvgpr_read_b32 v26, a90
M a[112:115], a[216:219], a[240:243], a[112:115]
s_waitcnt lgkmcnt(9)
v_accvgpr_read_b32 v27, a91
v_cvt_pk_bf16_f32 v24, v24, v25
v_cvt_pk_bf16_f32 v25, v26, v27
ds_write_b64 v124, v[24:25] offset:6464
M a[116:119], a[200:203], a[248:251], a[116:119]
ds_read_b128 a[240:243], v12 offset:14336
ds_read_b128 a[244:247], v13 offset:14336
v_accvgpr_read_b32 v24, a92
v_accvgpr_read_b32 v25, a93
v_accvgpr_read_b32 v26, a94
M a[116:119], a[204:207], a[252:255], a[116:119]
v_accvgpr_read_b32 v27, a95
v_cvt_pk_bf16_f32 v24, v24, v25
v_cvt_pk_bf16_f32 v25, v26, v27
ds_write_b64 v124, v[24:25] offset:12800
M a[120:123], a[212:215], a[252:255], a[120:123]
v_accvgpr_read_b32 v28, a96
v_accvgpr_read_b32 v29, a97
v_accvgpr_read_b32 v30, a98
M a[120:123], a[208:211], a[248:251], a[120:123]
v_accvgpr_read_b32 v31, a99
v_cvt_pk_bf16_f32 v28, v28, v29
v_cvt_pk_bf16_f32 v29, v30, v31
ds_write_b64 v124, v[28:29] offset:12832
M a[124:127], a[216:219], a[248:251], a[124:127]
v_accvgpr_read_b32 v24, a100
v_accvgpr_read_b32 v25, a101
v_accvgpr_read_b32 v26, a102
M a[124:127], a[220:223], a[252:255], a[124:127]
s_add_u32 s25, s25, 32768
s_cmp_eq_u32 s25, s27
s_cselect_b32 s25, s28, s25
s_cselect_b32 s27, s56, s27
s_cselect_b32 s28, s57, s28
s_cselect_b32 s56, -1, s56
s_waitcnt lgkmcnt(12)
v_accvgpr_read_b32 v27, a103
v_cvt_pk_bf16_f32 v24, v24, v25
v_cvt_pk_bf16_f32 v25, v26, v27
ds_write_b64 v124, v[24:25] offset:12864
M a[128:131], a[204:207], a[228:231], a[128:131]
ds_read_b128 a[248:251], v12 offset:16384
ds_read_b128 a[252:255], v13 offset:16384
v_accvgpr_read_b32 v24, a104
v_accvgpr_read_b32 v25, a105
v_accvgpr_read_b32 v26, a106
M a[128:131], a[200:203], a[224:227], a[128:131]
v_accvgpr_read_b32 v27, a107
v_cvt_pk_bf16_f32 v24, v24, v25
v_cvt_pk_bf16_f32 v25, v26, v27
ds_write_b64 v124, v[24:25] offset:19200
M a[132:135], a[208:211], a[224:227], a[132:135]
v_accvgpr_read_b32 v28, a108
v_accvgpr_read_b32 v29, a109
v_accvgpr_read_b32 v30, a110
M a[132:135], a[212:215], a[228:231], a[132:135]
v_accvgpr_read_b32 v31, a111
v_cvt_pk_bf16_f32 v28, v28, v29
v_cvt_pk_bf16_f32 v29, v30, v31
ds_write_b64 v124, v[28:29] offset:19232
M a[136:139], a[220:223], a[228:231], a[136:139]
v_accvgpr_read_b32 v24, a112
v_accvgpr_read_b32 v25, a113
v_accvgpr_read_b32 v26, a114
M a[136:139], a[216:219], a[224:227], a[136:139]
s_waitcnt lgkmcnt(12)
v_accvgpr_read_b32 v27, a115
v_cvt_pk_bf16_f32 v24, v24, v25
v_cvt_pk_bf16_f32 v25, v26, v27
ds_write_b64 v124, v[24:25] offset:19264
M a[140:143], a[200:203], a[232:235], a[140:143]
v_accvgpr_read_b32 v24, a116
v_accvgpr_read_b32 v25, a117
v_accvgpr_read_b32 v26, a118
M a[140:143], a[204:207], a[236:239], a[140:143]
v_accvgpr_read_b32 v27, a119
v_cvt_pk_bf16_f32 v24, v24, v25
v_cvt_pk_bf16_f32 v25, v26, v27
ds_write_b64 v124, v[24:25] offset:25600
M a[144:147], a[212:215], a[236:239], a[144:147]
v_accvgpr_read_b32 v28, a120
v_accvgpr_read_b32 v29, a121
v_accvgpr_read_b32 v30, a122
M a[144:147], a[208:211], a[232:235], a[144:147]
v_accvgpr_read_b32 v31, a123
v_cvt_pk_bf16_f32 v28, v28, v29
v_cvt_pk_bf16_f32 v29, v30, v31
ds_write_b64 v124, v[28:29] offset:25632
M a[148:151], a[216:219], a[232:235], a[148:151]
s_waitcnt lgkmcnt(0)
s_barrier
v_accvgpr_read_b32 v24, a124
v_accvgpr_read_b32 v25, a125
v_accvgpr_read_b32 v26, a126
M a[148:151], a[220:223], a[236:239], a[148:151]
v_accvgpr_read_b32 v27, a127
v_cvt_pk_bf16_f32 v24, v24, v25
v_cvt_pk_bf16_f32 v25, v26, v27
ds_write_b64 v124, v[24:25] offset:25664
v_accvgpr_read_b32 v24, a128
v_accvgpr_read_b32 v25, a129
v_accvgpr_read_b32 v26, a130
M a[152:155], a[204:207], a[244:247], a[152:155]
v_accvgpr_read_b32 v27, a131
v_cvt_pk_bf16_f32 v24, v24, v25
v_cvt_pk_bf16_f32 v25, v26, v27
M a[152:155], a[200:203], a[240:243], a[152:155]
ds_write_b64 v124, v[24:25] offset:32000
v_accvgpr_read_b32 v28, a132
v_accvgpr_read_b32 v29, a133
M a[156:159], a[208:211], a[240:243], a[156:159]
v_accvgpr_read_b32 v30, a134
v_accvgpr_read_b32 v31, a135
v_cvt_pk_bf16_f32 v28, v28, v29
M a[156:159], a[212:215], a[244:247], a[156:159]
v_cvt_pk_bf16_f32 v29, v30, v31
ds_write_b64 v124, v[28:29] offset:32032
v_accvgpr_read_b32 v24, a136
M a[160:163], a[220:223], a[244:247], a[160:163]
v_accvgpr_read_b32 v25, a137
v_accvgpr_read_b32 v26, a138
v_accvgpr_read_b32 v27, a139
M a[160:163], a[216:219], a[240:243], a[160:163]
v_cvt_pk_bf16_f32 v24, v24, v25
v_cvt_pk_bf16_f32 v25, v26, v27
ds_write_b64 v124, v[24:25] offset:32064
M a[164:167], a[200:203], a[248:251], a[164:167]
v_accvgpr_read_b32 v24, a140
v_accvgpr_read_b32 v25, a141
v_accvgpr_read_b32 v26, a142
M a[164:167], a[204:207], a[252:255], a[164:167]
v_accvgpr_read_b32 v27, a143
v_cvt_pk_bf16_f32 v24, v24, v25
v_cvt_pk_bf16_f32 v25, v26, v27
ds_write_b64 v124, v[24:25] offset:38400
M a[168:171], a[212:215], a[252:255], a[168:171]
v_accvgpr_read_b32 v28, a144
v_accvgpr_read_b32 v29, a145
v_accvgpr_read_b32 v30, a146
M a[168:171], a[208:211], a[248:251], a[168:171]
v_accvgpr_read_b32 v31, a147
v_cvt_pk_bf16_f32 v28, v28, v29
v_cvt_pk_bf16_f32 v29, v30, v31
ds_write_b64 v124, v[28:29] offset:38432
M a[172:175], a[216:219], a[248:251], a[172:175]
v_accvgpr_read_b32 v24, a148
v_accvgpr_read_b32 v25, a149
v_accvgpr_read_b32 v26, a150
M a[172:175], a[220:223], a[252:255], a[172:175]
v_accvgpr_read_b32 v27, a151
v_cvt_pk_bf16_f32 v24, v24, v25
v_cvt_pk_bf16_f32 v25, v26, v27
ds_write_b64 v124, v[24:25] offset:38464
s_mov_b64 s[44:45], s[42:43]
v_accvgpr_read_b32 v24, a152
v_accvgpr_read_b32 v25, a153
v_accvgpr_read_b32 v26, a154
v_accvgpr_read_b32 v27, a155
v_cvt_pk_bf16_f32 v24, v24, v25
v_cvt_pk_bf16_f32 v25, v26, v27
ds_write_b64 v124, v[24:25] offset:44800
v_accvgpr_read_b32 v28, a156
v_accvgpr_read_b32 v29, a157
v_accvgpr_read_b32 v30, a158
v_accvgpr_read_b32 v31, a159
v_cvt_pk_bf16_f32 v28, v28, v29
v_cvt_pk_bf16_f32 v29, v30, v31
ds_write_b64 v124, v[28:29] offset:44832
v_accvgpr_read_b32 v24, a160
v_accvgpr_read_b32 v25, a161
v_accvgpr_read_b32 v26, a162
v_accvgpr_read_b32 v27, a163
v_cvt_pk_bf16_f32 v24, v24, v25
v_cvt_pk_bf16_f32 v25, v26, v27
ds_write_b64 v124, v[24:25] offset:44864
v_accvgpr_read_b32 v24, a164
v_accvgpr_read_b32 v25, a165
v_accvgpr_read_b32 v26, a166
v_accvgpr_read_b32 v27, a167
v_cvt_pk_bf16_f32 v24, v24, v25
v_cvt_pk_bf16_f32 v25, v26, v27
ds_write_b64 v124, v[24:25] offset:51200
v_accvgpr_read_b32 v28, a168
v_accvgpr_read_b32 v29, a169
v_accvgpr_read_b32 v30, a170
v_accvgpr_read_b32 v31, a171
v_cvt_pk_bf16_f32 v28, v28, v29
v_cvt_pk_bf16_f32 v29, v30, v31
ds_write_b64 v124, v[28:29] offset:51232
v_accvgpr_read_b32 v24, a172
v_accvgpr_read_b32 v25, a173
v_accvgpr_read_b32 v26, a174
v_accvgpr_read_b32 v27, a175
v_cvt_pk_bf16_f32 v24, v24, v25
v_cvt_pk_bf16_f32 v25, v26, v27
ds_write_b64 v124, v[24:25] offset:51264
s_waitcnt lgkmcnt(0)
s_barrier
ds_read_b128 v[48:51], v121 offset:128
ds_read_b128 v[32:35], v120 offset:0
ds_read_b128 v[52:55], v120 offset:128
ds_read_b128 v[36:39], v120 offset:12800
ds_read_b128 v[56:59], v120 offset:12928
ds_read_b128 v[40:43], v120 offset:25600
ds_read_b128 v[60:63], v120 offset:25728
ds_read_b128 v[44:47], v120 offset:38400
ds_read_b128 v[64:67], v120 offset:38528
ds_read_b64_tr_b16 v[68:69], v123 offset:256
ds_read_b64_tr_b16 v[70:71], v122 offset:256
ds_read_b64_tr_b16 v[72:73], v122 offset:13056
ds_read_b64_tr_b16 v[74:75], v122 offset:25856
ds_read_b64_tr_b16 v[76:77], v122 offset:38656
ds_read_b64_tr_b16 v[78:79], v123 offset:288
ds_read_b64_tr_b16 v[80:81], v122 offset:288
ds_read_b64_tr_b16 v[82:83], v122 offset:13088
ds_read_b64_tr_b16 v[84:85], v122 offset:25888
ds_read_b64_tr_b16 v[86:87], v122 offset:38688
v_accvgpr_write_b32 a64, 0
v_accvgpr_write_b32 a65, 0
v_accvgpr_write_b32 a66, 0
v_accvgpr_write_b32 a67, 0
v_accvgpr_write_b32 a68, 0
v_accvgpr_write_b32 a69, 0
v_accvgpr_write_b32 a70, 0
v_accvgpr_write_b32 a71, 0
v_accvgpr_write_b32 a72, 0
v_accvgpr_write_b32 a73, 0
v_accvgpr_write_b32 a74, 0
v_accvgpr_write_b32 a75, 0
s_add_u32 m0, s29, 0
s_add_u32 s32, s25, 4096
buffer_load_dwordx4 v1, s[12:15], s25 offen offset:0 sc1 lds
v_accvgpr_write_b32 a76, 0
v_accvgpr_write_b32 a77, 0
v_accvgpr_write_b32 a78, 0
v_accvgpr_write_b32 a79, 0
v_accvgpr_write_b32 a80, 0
v_accvgpr_write_b32 a81, 0
v_accvgpr_write_b32 a82, 0
v_accvgpr_write_b32 a83, 0
v_accvgpr_write_b32 a84, 0
v_accvgpr_write_b32 a85, 0
v_accvgpr_write_b32 a86, 0
buffer_load_dwordx4 v1, s[12:15], s25 offen offset:1024 sc1 lds
v_accvgpr_write_b32 a87, 0
v_accvgpr_write_b32 a88, 0
v_accvgpr_write_b32 a89, 0
v_accvgpr_write_b32 a90, 0
v_accvgpr_write_b32 a91, 0
v_accvgpr_write_b32 a92, 0
v_accvgpr_write_b32 a93, 0
v_accvgpr_write_b32 a94, 0
v_accvgpr_write_b32 a95, 0
v_accvgpr_write_b32 a96, 0
buffer_load_dwordx4 v1, s[12:15], s25 offen offset:2048 sc1 lds
v_accvgpr_write_b32 a97, 0
v_accvgpr_write_b32 a98, 0
v_accvgpr_write_b32 a99, 0
v_accvgpr_write_b32 a100, 0
v_accvgpr_write_b32 a101, 0
v_accvgpr_write_b32 a102, 0
v_accvgpr_write_b32 a103, 0
v_accvgpr_write_b32 a104, 0
v_accvgpr_write_b32 a105, 0
v_accvgpr_write_b32 a106, 0
v_accvgpr_write_b32 a107, 0
buffer_load_dwordx4 v1, s[12:15], s25 offen offset:3072 sc1 lds
v_accvgpr_write_b32 a108, 0
v_accvgpr_write_b32 a109, 0
v_accvgpr_write_b32 a110, 0
v_accvgpr_write_b32 a111, 0
s_waitcnt lgkmcnt(15)
M v[88:91], v[48:51], v[32:35], v[152:155]
M v[92:95], v[52:55], v[32:35], v[148:151]
M v[96:99], v[52:55], v[36:39], v[144:147]
s_waitcnt lgkmcnt(14)
M v[100:103], v[56:59], v[36:39], v[148:151]
s_waitcnt lgkmcnt(13)
M v[104:107], v[56:59], v[40:43], v[144:147]
s_waitcnt lgkmcnt(12)
M v[108:111], v[60:63], v[40:43], v[148:151]
s_add_u32 m0, s29, 4096
s_nop 0
buffer_load_dwordx4 v1, s[12:15], s32 offen offset:0 sc1 lds
s_waitcnt lgkmcnt(11)
M v[112:115], v[60:63], v[44:47], v[144:147]
s_waitcnt lgkmcnt(10)
M v[116:119], v[64:67], v[44:47], v[148:151]
v_max3_f32 v136, v88, v89, v90
v_max3_f32 v136, v136, v91, v92
v_max3_f32 v136, v136, v93, v94
v_max_f32 v136, v136, v95
v_max3_f32 v137, v96, v97, v98
v_max3_f32 v137, v137, v99, v100
v_max3_f32 v137, v137, v101, v102
v_max_f32 v137, v137, v103
v_max3_f32 v138, v104, v105, v106
buffer_load_dwordx4 v1, s[12:15], s32 offen offset:1024 sc1 lds
v_max3_f32 v138, v138, v107, v108
v_max3_f32 v138, v138, v109, v110
v_max_f32 v138, v138, v111
v_max3_f32 v139, v112, v113, v114
v_max3_f32 v139, v139, v115, v116
v_max3_f32 v139, v139, v117, v118
v_max_f32 v139, v139, v119
v_mov_b32 v140, v136
v_mov_b32 v141, v137
v_mov_b32 v142, v138
buffer_load_dwordx4 v1, s[12:15], s32 offen offset:2048 sc1 lds
v_mov_b32 v143, v139
v_permlane16_swap_b32 v136, v140
v_permlane16_swap_b32 v137, v141
v_permlane16_swap_b32 v138, v142
v_permlane16_swap_b32 v139, v143
v_max_f32 v136, v136, v140
v_max_f32 v137, v137, v141
v_max_f32 v138, v138, v142
v_max_f32 v139, v139, v143
v_mov_b32 v140, v136
v_mov_b32 v141, v137
buffer_load_dwordx4 v1, s[12:15], s32 offen offset:3072 sc1 lds
v_mov_b32 v142, v138
v_mov_b32 v143, v139
v_permlane32_swap_b32 v136, v140
v_permlane32_swap_b32 v137, v141
v_permlane32_swap_b32 v138, v142
v_permlane32_swap_b32 v139, v143
v_max_f32 v136, v136, v140
v_max_f32 v137, v137, v141
v_max_f32 v138, v138, v142
v_max_f32 v139, v139, v143
s_add_u32 s25, s25, 32768
s_cmp_eq_u32 s25, s27
s_cselect_b32 s25, s28, s25
s_cselect_b32 s27, s56, s27
s_cselect_b32 s28, s57, s28
s_cselect_b32 s56, -1, s56
v_mul_f32 v136, s7, v136
v_mul_f32 v137, s7, v137
v_mul_f32 v138, s7, v138
v_mul_f32 v139, s7, v139
v_fma_f32 v88, v88, s7, -v136
v_fma_f32 v89, v89, s7, -v136
v_fma_f32 v90, v90, s7, -v136
v_fma_f32 v91, v91, s7, -v136
v_fma_f32 v92, v92, s7, -v136
v_fma_f32 v93, v93, s7, -v136
v_fma_f32 v94, v94, s7, -v136
s_add_u32 m0, s29, 32768
s_add_u32 s32, s26, 4096
buffer_load_dwordx4 v1, s[12:15], s26 offen offset:0 sc1 lds
v_fma_f32 v95, v95, s7, -v136
v_exp_f32 v88, v88
v_exp_f32 v89, v89
v_exp_f32 v90, v90
v_exp_f32 v91, v91
v_exp_f32 v92, v92
v_exp_f32 v93, v93
v_exp_f32 v94, v94
v_exp_f32 v95, v95
v_fma_f32 v96, v96, s7, -v137
v_fma_f32 v97, v97, s7, -v137
buffer_load_dwordx4 v1, s[12:15], s26 offen offset:1024 sc1 lds
v_fma_f32 v98, v98, s7, -v137
v_fma_f32 v99, v99, s7, -v137
v_fma_f32 v100, v100, s7, -v137
v_fma_f32 v101, v101, s7, -v137
v_fma_f32 v102, v102, s7, -v137
v_fma_f32 v103, v103, s7, -v137
v_exp_f32 v96, v96
v_exp_f32 v97, v97
v_exp_f32 v98, v98
v_exp_f32 v99, v99
buffer_load_dwordx4 v1, s[12:15], s26 offen offset:2048 sc1 lds
v_exp_f32 v100, v100
v_exp_f32 v101, v101
v_exp_f32 v102, v102
v_exp_f32 v103, v103
v_fma_f32 v104, v104, s7, -v138
v_fma_f32 v105, v105, s7, -v138
v_fma_f32 v106, v106, s7, -v138
v_fma_f32 v107, v107, s7, -v138
v_fma_f32 v108, v108, s7, -v138
v_fma_f32 v109, v109, s7, -v138
v_fma_f32 v110, v110, s7, -v138
buffer_load_dwordx4 v1, s[12:15], s26 offen offset:3072 sc1 lds
v_fma_f32 v111, v111, s7, -v138
v_exp_f32 v104, v104
v_exp_f32 v105, v105
v_exp_f32 v106, v106
v_exp_f32 v107, v107
v_exp_f32 v108, v108
v_exp_f32 v109, v109
v_exp_f32 v110, v110
v_exp_f32 v111, v111
v_fma_f32 v112, v112, s7, -v139
s_add_u32 m0, s29, 36864
s_nop 0
buffer_load_dwordx4 v1, s[12:15], s32 offen offset:0 sc1 lds
v_fma_f32 v113, v113, s7, -v139
v_fma_f32 v114, v114, s7, -v139
v_fma_f32 v115, v115, s7, -v139
v_fma_f32 v116, v116, s7, -v139
v_fma_f32 v117, v117, s7, -v139
v_fma_f32 v118, v118, s7, -v139
v_fma_f32 v119, v119, s7, -v139
v_exp_f32 v112, v112
v_exp_f32 v113, v113
v_exp_f32 v114, v114
v_exp_f32 v115, v115
buffer_load_dwordx4 v1, s[12:15], s32 offen offset:1024 sc1 lds
v_exp_f32 v116, v116
v_exp_f32 v117, v117
v_exp_f32 v118, v118
v_exp_f32 v119, v119
v_cvt_pk_bf16_f32 v88, v88, v89
v_cvt_pk_bf16_f32 v89, v90, v91
v_cvt_pk_bf16_f32 v90, v92, v93
v_cvt_pk_bf16_f32 v91, v94, v95
v_cvt_pk_bf16_f32 v96, v96, v97
v_cvt_pk_bf16_f32 v97, v98, v99
buffer_load_dwordx4 v1, s[12:15], s32 offen offset:2048 sc1 lds
v_cvt_pk_bf16_f32 v98, v100, v101
v_cvt_pk_bf16_f32 v99, v102, v103
v_cvt_pk_bf16_f32 v104, v104, v105
v_cvt_pk_bf16_f32 v105, v106, v107
v_cvt_pk_bf16_f32 v106, v108, v109
v_cvt_pk_bf16_f32 v107, v110, v111
v_cvt_pk_bf16_f32 v112, v112, v113
v_cvt_pk_bf16_f32 v113, v114, v115
v_cvt_pk_bf16_f32 v114, v116, v117
v_cvt_pk_bf16_f32 v115, v118, v119
M v[120:123], v[156:159], v[88:91], 0
buffer_load_dwordx4 v1, s[12:15], s32 offen offset:3072 sc1 lds
s_waitcnt lgkmcnt(8)
M v[32:35], v[68:71], v[88:91], 0
s_waitcnt lgkmcnt(3)
M v[36:39], v[78:81], v[88:91], 0
M v[124:127], v[156:159], v[96:99], 0
M v[40:43], v[70:73], v[96:99], 0
s_waitcnt lgkmcnt(2)
M v[44:47], v[80:83], v[96:99], 0
M v[128:131], v[156:159], v[104:107], 0
M v[48:51], v[72:75], v[104:107], 0
s_waitcnt lgkmcnt(1)
M v[52:55], v[82:85], v[104:107], 0
M v[132:135], v[156:159], v[112:115], 0
M v[56:59], v[74:77], v[112:115], 0
s_add_u32 s26, s26, 32768
s_cmp_eq_u32 s26, s62
s_cselect_b32 s26, s63, s26
s_cselect_b32 s62, s58, s62
s_cselect_b32 s63, s59, s63
s_cselect_b32 s58, -1, s58
s_waitcnt lgkmcnt(0)
M v[60:63], v[84:87], v[112:115], 0
v_rcp_f32 v120, v120
v_rcp_f32 v124, v124
v_rcp_f32 v128, v128
v_rcp_f32 v132, v132
v_pk_mul_f32 v[32:33], v[32:33], v[120:121] op_sel_hi:[1,0]
v_pk_mul_f32 v[34:35], v[34:35], v[120:121] op_sel_hi:[1,0]
v_pk_mul_f32 v[36:37], v[36:37], v[120:121] op_sel_hi:[1,0]
v_pk_mul_f32 v[38:39], v[38:39], v[120:121] op_sel_hi:[1,0]
v_cvt_pk_bf16_f32 v32, v32, v33
v_cvt_pk_bf16_f32 v33, v34, v35
v_cvt_pk_bf16_f32 v34, v36, v37
v_cvt_pk_bf16_f32 v35, v38, v39
s_add_u32 s3, s6, 0
buffer_store_dwordx4 v[32:35], v1, s[16:19], s3 offen sc1
v_pk_mul_f32 v[40:41], v[40:41], v[124:125] op_sel_hi:[1,0]
v_pk_mul_f32 v[42:43], v[42:43], v[124:125] op_sel_hi:[1,0]
v_pk_mul_f32 v[44:45], v[44:45], v[124:125] op_sel_hi:[1,0]
v_pk_mul_f32 v[46:47], v[46:47], v[124:125] op_sel_hi:[1,0]
v_cvt_pk_bf16_f32 v40, v40, v41
v_cvt_pk_bf16_f32 v41, v42, v43
v_cvt_pk_bf16_f32 v42, v44, v45
v_cvt_pk_bf16_f32 v43, v46, v47
s_add_u32 s3, s6, 2048
buffer_store_dwordx4 v[40:43], v1, s[16:19], s3 offen sc1
v_pk_mul_f32 v[48:49], v[48:49], v[128:129] op_sel_hi:[1,0]
v_pk_mul_f32 v[50:51], v[50:51], v[128:129] op_sel_hi:[1,0]
v_pk_mul_f32 v[52:53], v[52:53], v[128:129] op_sel_hi:[1,0]
v_pk_mul_f32 v[54:55], v[54:55], v[128:129] op_sel_hi:[1,0]
v_cvt_pk_bf16_f32 v48, v48, v49
v_cvt_pk_bf16_f32 v49, v50, v51
v_cvt_pk_bf16_f32 v50, v52, v53
v_cvt_pk_bf16_f32 v51, v54, v55
s_add_u32 s3, s6, 4096
buffer_store_dwordx4 v[48:51], v1, s[16:19], s3 offen sc1
v_pk_mul_f32 v[56:57], v[56:57], v[132:133] op_sel_hi:[1,0]
v_pk_mul_f32 v[58:59], v[58:59], v[132:133] op_sel_hi:[1,0]
v_pk_mul_f32 v[60:61], v[60:61], v[132:133] op_sel_hi:[1,0]
v_pk_mul_f32 v[62:63], v[62:63], v[132:133] op_sel_hi:[1,0]
v_cvt_pk_bf16_f32 v56, v56, v57
v_cvt_pk_bf16_f32 v57, v58, v59
v_cvt_pk_bf16_f32 v58, v60, v61
v_cvt_pk_bf16_f32 v59, v62, v63
s_add_u32 s3, s6, 6144
buffer_store_dwordx4 v[56:59], v1, s[16:19], s3 offen sc1
Lc2:
s_add_u32 s16, s4, 67108864
s_addc_u32 s17, s5, 0
s_mov_b32 s18, 16777216
s_mov_b32 s19, 0x00020000
s_add_u32 s52, s4, 100663296
s_addc_u32 s53, s5, 0
s_mov_b32 s54, 8404992
s_mov_b32 s55, 0x00020000
s_mov_b32 s46, 8388608
s_mov_b32 s47, 0x00020000
s_mov_b32 s50, 2097152
s_mov_b32 s51, 0x00020000
s_lshl_b32 s33, s24, 14
v_add_u32 v2, 0, v1
v_add_u32 v3, 0x10000, v2
v_mov_b32 v5, v2
v_mov_b32 v6, v3
v_and_b32 v8, 15, v0
v_bfe_u32 v9, v0, 4, 2
v_lshlrev_b32 v9, 2, v9
v_sub_u32 v8, v8, v9
v_mov_b32 v4, 0xf149f2ca
v_cmp_gt_i32 vcc, 0, v8
s_nop 1
v_cndmask_b32 v16, 0, v4, vcc
v_cmp_gt_i32 vcc, 1, v8
s_nop 1
v_cndmask_b32 v17, 0, v4, vcc
v_cmp_gt_i32 vcc, 2, v8
s_nop 1
v_cndmask_b32 v18, 0, v4, vcc
v_cmp_gt_i32 vcc, 3, v8
s_nop 1
v_cndmask_b32 v19, 0, v4, vcc
v_mov_b32 v8, 0x3f803f80
v_accvgpr_write_b32 a112, v8
v_accvgpr_write_b32 a113, v8
v_accvgpr_write_b32 a114, v8
v_accvgpr_write_b32 a115, v8
s_lshl_b32 s33, s23, 6
s_add_i32 s33, s33, s31
s_cmp_gt_i32 s33, 0
s_cselect_b32 s34, 0, 0xf149f2ca
s_cmp_lt_i32 s33, 0
s_cselect_b32 s33, 0xf149f2ca, 0
v_mov_b32 v20, s34
v_mov_b32 v21, s34
v_mov_b32 v22, s34
v_mov_b32 v23, s34
v_mov_b32 v28, s33
v_mov_b32 v29, s33
v_mov_b32 v30, s33
v_mov_b32 v31, s33
v_med3_f32 v24, v16, v20, v28
v_med3_f32 v25, v17, v20, v28
v_med3_f32 v26, v18, v20, v28
v_med3_f32 v27, v19, v20, v28
v_mov_b32 v12, 0
v_mov_b32 v13, 1
s_waitcnt vmcnt(20)
s_barrier
ds_read_b128 a[116:119], v3 offset:0
ds_read_b128 a[120:123], v3 offset:1024
ds_read_b128 a[124:127], v3 offset:2048
ds_read_b128 a[128:131], v3 offset:3072
ds_read_b128 a[132:135], v3 offset:4096
ds_read_b128 a[136:139], v3 offset:5120
ds_read_b128 a[140:143], v3 offset:6144
ds_read_b128 a[144:147], v3 offset:7168
s_waitcnt lgkmcnt(4)
M v[32:35], a[116:119], a[0:3], v[24:27]
M v[32:35], a[120:123], a[4:7], v[32:35]
ds_read_b128 a[148:151], v3 offset:8192
ds_read_b128 a[152:155], v3 offset:9216
M v[32:35], a[124:127], a[8:11], v[32:35]
M v[32:35], a[128:131], a[12:15], v[32:35]
M v[36:39], a[128:131], a[28:31], v[28:31]
M v[36:39], a[124:127], a[24:27], v[36:39]
M v[36:39], a[120:123], a[20:23], v[36:39]
M v[36:39], a[116:119], a[16:19], v[36:39]
M v[40:43], a[116:119], a[32:35], v[28:31]
M v[40:43], a[120:123], a[36:39], v[40:43]
ds_read_b128 a[156:159], v3 offset:10240
ds_read_b128 a[160:163], v3 offset:11264
M v[40:43], a[124:127], a[40:43], v[40:43]
M v[40:43], a[128:131], a[44:47], v[40:43]
M v[44:47], a[128:131], a[60:63], v[28:31]
M v[44:47], a[124:127], a[56:59], v[44:47]
M v[44:47], a[120:123], a[52:55], v[44:47]
M v[44:47], a[116:119], a[48:51], v[44:47]
s_waitcnt lgkmcnt(4)
M v[48:51], a[132:135], a[0:3], v[20:23]
M v[48:51], a[136:139], a[4:7], v[48:51]
ds_read_b128 a[164:167], v3 offset:12288
ds_read_b128 a[168:171], v3 offset:13312
M v[48:51], a[140:143], a[8:11], v[48:51]
M v[48:51], a[144:147], a[12:15], v[48:51]
M v[52:55], a[144:147], a[28:31], v[24:27]
M v[52:55], a[140:143], a[24:27], v[52:55]
M v[52:55], a[136:139], a[20:23], v[52:55]
M v[52:55], a[132:135], a[16:19], v[52:55]
M v[56:59], a[132:135], a[32:35], v[28:31]
M v[56:59], a[136:139], a[36:39], v[56:59]
ds_read_b128 a[172:175], v3 offset:14336
ds_read_b128 a[176:179], v3 offset:15360
M v[56:59], a[140:143], a[40:43], v[56:59]
M v[56:59], a[144:147], a[44:47], v[56:59]
M v[60:63], a[144:147], a[60:63], v[28:31]
M v[60:63], a[140:143], a[56:59], v[60:63]
M v[60:63], a[136:139], a[52:55], v[60:63]
M v[60:63], a[132:135], a[48:51], v[60:63]
s_waitcnt lgkmcnt(4)
M v[64:67], a[148:151], a[0:3], v[20:23]
M v[64:67], a[152:155], a[4:7], v[64:67]
M v[64:67], a[156:159], a[8:11], v[64:67]
M v[64:67], a[160:163], a[12:15], v[64:67]
M v[68:71], a[160:163], a[28:31], v[20:23]
M v[68:71], a[156:159], a[24:27], v[68:71]
M v[68:71], a[152:155], a[20:23], v[68:71]
M v[68:71], a[148:151], a[16:19], v[68:71]
M v[72:75], a[148:151], a[32:35], v[24:27]
M v[72:75], a[152:155], a[36:39], v[72:75]
M v[72:75], a[156:159], a[40:43], v[72:75]
M v[72:75], a[160:163], a[44:47], v[72:75]
M v[76:79], a[160:163], a[60:63], v[28:31]
M v[76:79], a[156:159], a[56:59], v[76:79]
s_waitcnt vmcnt(4) lgkmcnt(0)
s_barrier
ds_read_b128 a[116:119], v2 offset:0
ds_read_b128 a[120:123], v2 offset:1024
M v[76:79], a[152:155], a[52:55], v[76:79]
M v[76:79], a[148:151], a[48:51], v[76:79]
M v[80:83], a[164:167], a[0:3], v[20:23]
M v[80:83], a[168:171], a[4:7], v[80:83]
ds_read_b128 a[124:127], v2 offset:2048
ds_read_b128 a[128:131], v2 offset:3072
M v[80:83], a[172:175], a[8:11], v[80:83]
M v[80:83], a[176:179], a[12:15], v[80:83]
M v[84:87], a[176:179], a[28:31], v[20:23]
M v[84:87], a[172:175], a[24:27], v[84:87]
ds_read_b128 a[132:135], v2 offset:4096
ds_read_b128 a[136:139], v2 offset:5120
M v[84:87], a[168:171], a[20:23], v[84:87]
M v[84:87], a[164:167], a[16:19], v[84:87]
M v[88:91], a[164:167], a[32:35], v[20:23]
M v[88:91], a[168:171], a[36:39], v[88:91]
ds_read_b128 a[140:143], v2 offset:6144
ds_read_b128 a[144:147], v2 offset:7168
M v[88:91], a[172:175], a[40:43], v[88:91]
M v[88:91], a[176:179], a[44:47], v[88:91]
M v[92:95], a[176:179], a[60:63], v[24:27]
M v[92:95], a[172:175], a[56:59], v[92:95]
M v[92:95], a[168:171], a[52:55], v[92:95]
M v[92:95], a[164:167], a[48:51], v[92:95]
s_waitcnt vmcnt(0)
s_mov_b64 exec, 1
buffer_store_dword v13, v12, s[52:55], s65 offen sc1
s_mov_b64 exec, -1
v_exp_f32 v32, v32
v_exp_f32 v33, v33
v_exp_f32 v34, v34
v_exp_f32 v35, v35
v_exp_f32 v48, v48
v_exp_f32 v49, v49
v_exp_f32 v50, v50
v_exp_f32 v51, v51
v_cvt_pk_bf16_f32 v32, v32, v33
v_cvt_pk_bf16_f32 v33, v34, v35
v_exp_f32 v36, v36
v_exp_f32 v37, v37
v_exp_f32 v38, v38
v_exp_f32 v39, v39
v_cvt_pk_bf16_f32 v34, v48, v49
v_cvt_pk_bf16_f32 v35, v50, v51
v_exp_f32 v52, v52
v_exp_f32 v53, v53
v_exp_f32 v54, v54
v_exp_f32 v55, v55
v_cvt_pk_bf16_f32 v36, v36, v37
v_cvt_pk_bf16_f32 v37, v38, v39
v_exp_f32 v40, v40
v_exp_f32 v41, v41
v_exp_f32 v42, v42
v_exp_f32 v43, v43
v_cvt_pk_bf16_f32 v38, v52, v53
v_cvt_pk_bf16_f32 v39, v54, v55
v_exp_f32 v56, v56
v_exp_f32 v57, v57
v_exp_f32 v58, v58
v_exp_f32 v59, v59
v_cvt_pk_bf16_f32 v40, v40, v41
v_cvt_pk_bf16_f32 v41, v42, v43
v_exp_f32 v44, v44
v_exp_f32 v45, v45
v_exp_f32 v46, v46
v_exp_f32 v47, v47
v_cvt_pk_bf16_f32 v42, v56, v57
v_cvt_pk_bf16_f32 v43, v58, v59
v_exp_f32 v60, v60
v_exp_f32 v61, v61
v_exp_f32 v62, v62
v_exp_f32 v63, v63
v_cvt_pk_bf16_f32 v44, v44, v45
v_cvt_pk_bf16_f32 v45, v46, v47
v_cvt_pk_bf16_f32 v46, v60, v61
v_cvt_pk_bf16_f32 v47, v62, v63
s_cmp_eq_u32 s24, 1
s_cbranch_scc1 Lk2_g1
s_mov_b32 s30, s21
s_cmp_eq_u32 s21, 0
s_cbranch_scc1 Lk2_m2
Lk2_l1:
s_add_u32 m0, s29, 65536
s_waitcnt lgkmcnt(4)
M v[96:99], a[116:119], a[0:3], 0
v_exp_f32 v64, v64
M v[96:99], a[120:123], a[4:7], v[96:99]
ds_read_b128 a[148:151], v2 offset:8192
ds_read_b128 a[152:155], v2 offset:9216
M v[96:99], a[124:127], a[8:11], v[96:99]
v_exp_f32 v65, v65
M v[96:99], a[128:131], a[12:15], v[96:99]
buffer_load_dwordx4 v1, s[12:15], s25 offen offset:0 sc1 lds
s_add_u32 s32, s25, 4096
M v[100:103], a[128:131], a[28:31], 0
v_exp_f32 v66, v66
M v[100:103], a[124:127], a[24:27], v[100:103]
v_cvt_pk_bf16_f32 v64, v64, v65
M v[100:103], a[120:123], a[20:23], v[100:103]
v_exp_f32 v67, v67
M v[100:103], a[116:119], a[16:19], v[100:103]
buffer_load_dwordx4 v1, s[12:15], s25 offen offset:1024 sc1 lds
M v[104:107], a[116:119], a[32:35], 0
v_exp_f32 v80, v80
M v[104:107], a[120:123], a[36:39], v[104:107]
ds_read_b128 a[156:159], v2 offset:10240
ds_read_b128 a[160:163], v2 offset:11264
M v[104:107], a[124:127], a[40:43], v[104:107]
v_exp_f32 v81, v81
M v[104:107], a[128:131], a[44:47], v[104:107]
buffer_load_dwordx4 v1, s[12:15], s25 offen offset:2048 sc1 lds
M v[108:111], a[128:131], a[60:63], 0
v_exp_f32 v82, v82
M v[108:111], a[124:127], a[56:59], v[108:111]
v_cvt_pk_bf16_f32 v65, v66, v67
v_cvt_pk_bf16_f32 v66, v80, v81
M v[108:111], a[120:123], a[52:55], v[108:111]
v_exp_f32 v83, v83
M v[108:111], a[116:119], a[48:51], v[108:111]
buffer_load_dwordx4 v1, s[12:15], s25 offen offset:3072 sc1 lds
s_add_u32 m0, s29, 69632
s_waitcnt lgkmcnt(4)
M v[112:115], a[132:135], a[0:3], 0
v_exp_f32 v68, v68
M v[112:115], a[136:139], a[4:7], v[112:115]
ds_read_b128 a[164:167], v2 offset:12288
ds_read_b128 a[168:171], v2 offset:13312
M v[112:115], a[140:143], a[8:11], v[112:115]
v_exp_f32 v69, v69
M v[112:115], a[144:147], a[12:15], v[112:115]
buffer_load_dwordx4 v1, s[12:15], s32 offen offset:0 sc1 lds
M v[116:119], a[144:147], a[28:31], 0
v_exp_f32 v70, v70
M v[116:119], a[140:143], a[24:27], v[116:119]
v_cvt_pk_bf16_f32 v67, v82, v83
v_cvt_pk_bf16_f32 v68, v68, v69
M v[116:119], a[136:139], a[20:23], v[116:119]
v_exp_f32 v71, v71
M v[116:119], a[132:135], a[16:19], v[116:119]
buffer_load_dwordx4 v1, s[12:15], s32 offen offset:1024 sc1 lds
M v[120:123], a[132:135], a[32:35], 0
v_exp_f32 v84, v84
M v[120:123], a[136:139], a[36:39], v[120:123]
ds_read_b128 a[172:175], v2 offset:14336
ds_read_b128 a[176:179], v2 offset:15360
M v[120:123], a[140:143], a[40:43], v[120:123]
v_exp_f32 v85, v85
M v[120:123], a[144:147], a[44:47], v[120:123]
buffer_load_dwordx4 v1, s[12:15], s32 offen offset:2048 sc1 lds
M v[124:127], a[144:147], a[60:63], 0
v_exp_f32 v86, v86
M v[124:127], a[140:143], a[56:59], v[124:127]
v_cvt_pk_bf16_f32 v69, v70, v71
v_cvt_pk_bf16_f32 v70, v84, v85
M v[124:127], a[136:139], a[52:55], v[124:127]
v_exp_f32 v87, v87
M v[124:127], a[132:135], a[48:51], v[124:127]
buffer_load_dwordx4 v1, s[12:15], s32 offen offset:3072 sc1 lds
s_add_u32 m0, s29, 98304
s_waitcnt lgkmcnt(4)
M v[128:131], a[148:151], a[0:3], 0
v_exp_f32 v72, v72
M v[128:131], a[152:155], a[4:7], v[128:131]
ds_read_b128 a[116:119], v5 offset:32768
ds_read_b128 a[120:123], v5 offset:40960
M v[128:131], a[156:159], a[8:11], v[128:131]
v_exp_f32 v73, v73
M v[128:131], a[160:163], a[12:15], v[128:131]
buffer_load_dwordx4 v1, s[12:15], s26 offen offset:0 sc1 lds
s_add_u32 s43, s26, 4096
M v[132:135], a[160:163], a[28:31], 0
v_exp_f32 v74, v74
M v[132:135], a[156:159], a[24:27], v[132:135]
v_cvt_pk_bf16_f32 v71, v86, v87
v_cvt_pk_bf16_f32 v72, v72, v73
M v[132:135], a[152:155], a[20:23], v[132:135]
v_exp_f32 v75, v75
M v[132:135], a[148:151], a[16:19], v[132:135]
buffer_load_dwordx4 v1, s[12:15], s26 offen offset:1024 sc1 lds
M v[136:139], a[148:151], a[32:35], 0
v_exp_f32 v88, v88
M v[136:139], a[152:155], a[36:39], v[136:139]
ds_read_b128 a[124:127], v5 offset:33792
ds_read_b128 a[128:131], v5 offset:41984
M v[136:139], a[156:159], a[40:43], v[136:139]
v_exp_f32 v89, v89
M v[136:139], a[160:163], a[44:47], v[136:139]
buffer_load_dwordx4 v1, s[12:15], s26 offen offset:2048 sc1 lds
M v[140:143], a[160:163], a[60:63], 0
v_exp_f32 v90, v90
M v[140:143], a[156:159], a[56:59], v[140:143]
v_cvt_pk_bf16_f32 v73, v74, v75
v_cvt_pk_bf16_f32 v74, v88, v89
M v[140:143], a[152:155], a[52:55], v[140:143]
v_exp_f32 v91, v91
M v[140:143], a[148:151], a[48:51], v[140:143]
buffer_load_dwordx4 v1, s[12:15], s26 offen offset:3072 sc1 lds
s_add_u32 m0, s29, 102400
s_waitcnt lgkmcnt(4)
M v[144:147], a[164:167], a[0:3], 0
v_exp_f32 v76, v76
M v[144:147], a[168:171], a[4:7], v[144:147]
ds_read_b128 a[132:135], v5 offset:34816
ds_read_b128 a[136:139], v5 offset:43008
M v[144:147], a[172:175], a[8:11], v[144:147]
v_exp_f32 v77, v77
M v[144:147], a[176:179], a[12:15], v[144:147]
buffer_load_dwordx4 v1, s[12:15], s43 offen offset:0 sc1 lds
M v[148:151], a[176:179], a[28:31], 0
v_exp_f32 v78, v78
M v[148:151], a[172:175], a[24:27], v[148:151]
v_cvt_pk_bf16_f32 v75, v90, v91
v_cvt_pk_bf16_f32 v76, v76, v77
M v[148:151], a[168:171], a[20:23], v[148:151]
v_exp_f32 v79, v79
M v[148:151], a[164:167], a[16:19], v[148:151]
buffer_load_dwordx4 v1, s[12:15], s43 offen offset:1024 sc1 lds
M v[152:155], a[164:167], a[32:35], 0
v_exp_f32 v92, v92
M v[152:155], a[168:171], a[36:39], v[152:155]
ds_read_b128 a[140:143], v5 offset:35840
ds_read_b128 a[144:147], v5 offset:44032
M v[152:155], a[172:175], a[40:43], v[152:155]
v_exp_f32 v93, v93
M v[152:155], a[176:179], a[44:47], v[152:155]
buffer_load_dwordx4 v1, s[12:15], s43 offen offset:2048 sc1 lds
M v[156:159], a[176:179], a[60:63], 0
v_exp_f32 v94, v94
M v[156:159], a[172:175], a[56:59], v[156:159]
v_cvt_pk_bf16_f32 v77, v78, v79
v_cvt_pk_bf16_f32 v78, v92, v93
M v[156:159], a[168:171], a[52:55], v[156:159]
v_exp_f32 v95, v95
M v[156:159], a[164:167], a[48:51], v[156:159]
buffer_load_dwordx4 v1, s[12:15], s43 offen offset:3072 sc1 lds
v_cvt_pk_bf16_f32 v79, v94, v95
s_waitcnt lgkmcnt(6)
M v[160:163], a[116:119], v[32:35], v[160:163]
v_exp_f32 v96, v96
M v[160:163], a[120:123], v[64:67], v[160:163]
ds_read_b128 a[148:151], v5 offset:36864
ds_read_b128 a[152:155], v5 offset:45056
M v[164:167], a[120:123], v[68:71], v[164:167]
v_exp_f32 v97, v97
M v[164:167], a[116:119], v[36:39], v[164:167]
v_cvt_pk_bf16_f32 v96, v96, v97
M v[168:171], a[116:119], v[40:43], v[168:171]
v_exp_f32 v98, v98
M v[168:171], a[120:123], v[72:75], v[168:171]
s_add_u32 s25, s25, 32768
s_cmp_eq_u32 s25, s27
M v[172:175], a[120:123], v[76:79], v[172:175]
v_exp_f32 v99, v99
M v[172:175], a[116:119], v[44:47], v[172:175]
v_cvt_pk_bf16_f32 v97, v98, v99
s_waitcnt lgkmcnt(6)
M a[96:99], a[112:115], v[32:35], a[96:99]
s_cselect_b32 s25, s28, s25
s_cselect_b32 s27, -1, s27
M a[96:99], a[112:115], v[64:67], a[96:99]
s_add_u32 s26, s26, 32768
s_cmp_eq_u32 s26, s62
M v[176:179], a[124:127], v[32:35], v[176:179]
v_exp_f32 v112, v112
M v[176:179], a[128:131], v[64:67], v[176:179]
ds_read_b128 a[156:159], v5 offset:37888
ds_read_b128 a[160:163], v5 offset:46080
M v[180:183], a[128:131], v[68:71], v[180:183]
v_exp_f32 v113, v113
M v[180:183], a[124:127], v[36:39], v[180:183]
v_cvt_pk_bf16_f32 v98, v112, v113
M v[184:187], a[124:127], v[40:43], v[184:187]
v_exp_f32 v114, v114
M v[184:187], a[128:131], v[72:75], v[184:187]
s_cselect_b32 s26, s63, s26
s_cselect_b32 s62, -1, s62
M v[188:191], a[128:131], v[76:79], v[188:191]
v_exp_f32 v115, v115
M v[188:191], a[124:127], v[44:47], v[188:191]
v_cvt_pk_bf16_f32 v99, v114, v115
s_waitcnt lgkmcnt(6)
M a[100:103], a[112:115], v[36:39], a[100:103]
M a[100:103], a[112:115], v[68:71], a[100:103]
M v[192:195], a[132:135], v[32:35], v[192:195]
v_exp_f32 v100, v100
M v[192:195], a[136:139], v[64:67], v[192:195]
ds_read_b128 a[164:167], v5 offset:38912
ds_read_b128 a[168:171], v5 offset:47104
M v[196:199], a[136:139], v[68:71], v[196:199]
v_exp_f32 v101, v101
M v[196:199], a[132:135], v[36:39], v[196:199]
v_cvt_pk_bf16_f32 v100, v100, v101
M v[200:203], a[132:135], v[40:43], v[200:203]
v_exp_f32 v102, v102
M v[200:203], a[136:139], v[72:75], v[200:203]
M v[204:207], a[136:139], v[76:79], v[204:207]
v_exp_f32 v103, v103
M v[204:207], a[132:135], v[44:47], v[204:207]
v_cvt_pk_bf16_f32 v101, v102, v103
s_waitcnt lgkmcnt(6)
M a[104:107], a[112:115], v[40:43], a[104:107]
M a[104:107], a[112:115], v[72:75], a[104:107]
M v[208:211], a[140:143], v[32:35], v[208:211]
v_exp_f32 v116, v116
M v[208:211], a[144:147], v[64:67], v[208:211]
ds_read_b128 a[172:175], v5 offset:39936
ds_read_b128 a[176:179], v5 offset:48128
M v[212:215], a[144:147], v[68:71], v[212:215]
v_exp_f32 v117, v117
M v[212:215], a[140:143], v[36:39], v[212:215]
v_cvt_pk_bf16_f32 v102, v116, v117
M v[216:219], a[140:143], v[40:43], v[216:219]
v_exp_f32 v118, v118
M v[216:219], a[144:147], v[72:75], v[216:219]
M v[220:223], a[144:147], v[76:79], v[220:223]
v_exp_f32 v119, v119
M v[220:223], a[140:143], v[44:47], v[220:223]
v_cvt_pk_bf16_f32 v103, v118, v119
s_waitcnt lgkmcnt(6)
M a[108:111], a[112:115], v[44:47], a[108:111]
M a[108:111], a[112:115], v[76:79], a[108:111]
M v[224:227], a[148:151], v[32:35], v[224:227]
v_exp_f32 v104, v104
M v[224:227], a[152:155], v[64:67], v[224:227]
M v[228:231], a[152:155], v[68:71], v[228:231]
v_exp_f32 v105, v105
M v[228:231], a[148:151], v[36:39], v[228:231]
v_cvt_pk_bf16_f32 v104, v104, v105
M v[232:235], a[148:151], v[40:43], v[232:235]
v_exp_f32 v106, v106
M v[232:235], a[152:155], v[72:75], v[232:235]
M v[236:239], a[152:155], v[76:79], v[236:239]
v_exp_f32 v107, v107
M v[236:239], a[148:151], v[44:47], v[236:239]
v_cvt_pk_bf16_f32 v105, v106, v107
s_waitcnt lgkmcnt(4)
M v[240:243], a[156:159], v[32:35], v[240:243]
v_exp_f32 v120, v120
M v[240:243], a[160:163], v[64:67], v[240:243]
M v[244:247], a[160:163], v[68:71], v[244:247]
v_exp_f32 v121, v121
M v[244:247], a[156:159], v[36:39], v[244:247]
v_cvt_pk_bf16_f32 v106, v120, v121
M v[248:251], a[156:159], v[40:43], v[248:251]
v_exp_f32 v122, v122
M v[248:251], a[160:163], v[72:75], v[248:251]
s_waitcnt vmcnt(0) lgkmcnt(0)
s_barrier
ds_read_b128 a[116:119], v3 offset:0
ds_read_b128 a[120:123], v3 offset:1024
M v[252:255], a[160:163], v[76:79], v[252:255]
v_exp_f32 v123, v123
M v[252:255], a[156:159], v[44:47], v[252:255]
v_cvt_pk_bf16_f32 v107, v122, v123
M a[64:67], a[164:167], v[32:35], a[64:67]
v_exp_f32 v108, v108
M a[64:67], a[168:171], v[64:67], a[64:67]
ds_read_b128 a[124:127], v3 offset:2048
ds_read_b128 a[128:131], v3 offset:3072
M a[68:71], a[168:171], v[68:71], a[68:71]
v_exp_f32 v109, v109
M a[68:71], a[164:167], v[36:39], a[68:71]
v_cvt_pk_bf16_f32 v108, v108, v109
M a[72:75], a[164:167], v[40:43], a[72:75]
v_exp_f32 v110, v110
M a[72:75], a[168:171], v[72:75], a[72:75]
ds_read_b128 a[132:135], v3 offset:4096
ds_read_b128 a[136:139], v3 offset:5120
M a[76:79], a[168:171], v[76:79], a[76:79]
v_exp_f32 v111, v111
M a[76:79], a[164:167], v[44:47], a[76:79]
v_cvt_pk_bf16_f32 v109, v110, v111
M a[80:83], a[172:175], v[32:35], a[80:83]
v_exp_f32 v124, v124
M a[80:83], a[176:179], v[64:67], a[80:83]
ds_read_b128 a[140:143], v3 offset:6144
ds_read_b128 a[144:147], v3 offset:7168
M a[84:87], a[176:179], v[68:71], a[84:87]
v_exp_f32 v125, v125
M a[84:87], a[172:175], v[36:39], a[84:87]
v_cvt_pk_bf16_f32 v110, v124, v125
M a[88:91], a[172:175], v[40:43], a[88:91]
v_exp_f32 v126, v126
M a[88:91], a[176:179], v[72:75], a[88:91]
M a[92:95], a[176:179], v[76:79], a[92:95]
v_exp_f32 v127, v127
M a[92:95], a[172:175], v[44:47], a[92:95]
v_cvt_pk_bf16_f32 v111, v126, v127
s_sub_u32 s30, s30, 1
s_cmp_eq_u32 s30, 0
s_cbranch_scc1 Lk2_m1
s_add_u32 m0, s29, 0
s_waitcnt lgkmcnt(4)
M v[32:35], a[116:119], a[0:3], 0
v_exp_f32 v128, v128
M v[32:35], a[120:123], a[4:7], v[32:35]
ds_read_b128 a[148:151], v3 offset:8192
ds_read_b128 a[152:155], v3 offset:9216
M v[32:35], a[124:127], a[8:11], v[32:35]
v_exp_f32 v129, v129
M v[32:35], a[128:131], a[12:15], v[32:35]
buffer_load_dwordx4 v1, s[12:15], s25 offen offset:0 sc1 lds
s_add_u32 s32, s25, 4096
M v[36:39], a[128:131], a[28:31], 0
v_exp_f32 v130, v130
M v[36:39], a[124:127], a[24:27], v[36:39]
v_cvt_pk_bf16_f32 v128, v128, v129
M v[36:39], a[120:123], a[20:23], v[36:39]
v_exp_f32 v131, v131
M v[36:39], a[116:119], a[16:19], v[36:39]
buffer_load_dwordx4 v1, s[12:15], s25 offen offset:1024 sc1 lds
M v[40:43], a[116:119], a[32:35], 0
v_exp_f32 v144, v144
M v[40:43], a[120:123], a[36:39], v[40:43]
ds_read_b128 a[156:159], v3 offset:10240
ds_read_b128 a[160:163], v3 offset:11264
M v[40:43], a[124:127], a[40:43], v[40:43]
v_exp_f32 v145, v145
M v[40:43], a[128:131], a[44:47], v[40:43]
buffer_load_dwordx4 v1, s[12:15], s25 offen offset:2048 sc1 lds
M v[44:47], a[128:131], a[60:63], 0
v_exp_f32 v146, v146
M v[44:47], a[124:127], a[56:59], v[44:47]
v_cvt_pk_bf16_f32 v129, v130, v131
v_cvt_pk_bf16_f32 v130, v144, v145
M v[44:47], a[120:123], a[52:55], v[44:47]
v_exp_f32 v147, v147
M v[44:47], a[116:119], a[48:51], v[44:47]
buffer_load_dwordx4 v1, s[12:15], s25 offen offset:3072 sc1 lds
s_add_u32 m0, s29, 4096
s_waitcnt lgkmcnt(4)
M v[48:51], a[132:135], a[0:3], 0
v_exp_f32 v132, v132
M v[48:51], a[136:139], a[4:7], v[48:51]
ds_read_b128 a[164:167], v3 offset:12288
ds_read_b128 a[168:171], v3 offset:13312
M v[48:51], a[140:143], a[8:11], v[48:51]
v_exp_f32 v133, v133
M v[48:51], a[144:147], a[12:15], v[48:51]
buffer_load_dwordx4 v1, s[12:15], s32 offen offset:0 sc1 lds
M v[52:55], a[144:147], a[28:31], 0
v_exp_f32 v134, v134
M v[52:55], a[140:143], a[24:27], v[52:55]
v_cvt_pk_bf16_f32 v131, v146, v147
v_cvt_pk_bf16_f32 v132, v132, v133
M v[52:55], a[136:139], a[20:23], v[52:55]
v_exp_f32 v135, v135
M v[52:55], a[132:135], a[16:19], v[52:55]
buffer_load_dwordx4 v1, s[12:15], s32 offen offset:1024 sc1 lds
M v[56:59], a[132:135], a[32:35], 0
v_exp_f32 v148, v148
M v[56:59], a[136:139], a[36:39], v[56:59]
ds_read_b128 a[172:175], v3 offset:14336
ds_read_b128 a[176:179], v3 offset:15360
M v[56:59], a[140:143], a[40:43], v[56:59]
v_exp_f32 v149, v149
M v[56:59], a[144:147], a[44:47], v[56:59]
buffer_load_dwordx4 v1, s[12:15], s32 offen offset:2048 sc1 lds
M v[60:63], a[144:147], a[60:63], 0
v_exp_f32 v150, v150
M v[60:63], a[140:143], a[56:59], v[60:63]
v_cvt_pk_bf16_f32 v133, v134, v135
v_cvt_pk_bf16_f32 v134, v148, v149
M v[60:63], a[136:139], a[52:55], v[60:63]
v_exp_f32 v151, v151
M v[60:63], a[132:135], a[48:51], v[60:63]
buffer_load_dwordx4 v1, s[12:15], s32 offen offset:3072 sc1 lds
s_add_u32 m0, s29, 32768
s_waitcnt lgkmcnt(4)
M v[64:67], a[148:151], a[0:3], 0
v_exp_f32 v136, v136
M v[64:67], a[152:155], a[4:7], v[64:67]
ds_read_b128 a[116:119], v6 offset:32768
ds_read_b128 a[120:123], v6 offset:40960
M v[64:67], a[156:159], a[8:11], v[64:67]
v_exp_f32 v137, v137
M v[64:67], a[160:163], a[12:15], v[64:67]
buffer_load_dwordx4 v1, s[12:15], s26 offen offset:0 sc1 lds
s_add_u32 s43, s26, 4096
M v[68:71], a[160:163], a[28:31], 0
v_exp_f32 v138, v138
M v[68:71], a[156:159], a[24:27], v[68:71]
v_cvt_pk_bf16_f32 v135, v150, v151
v_cvt_pk_bf16_f32 v136, v136, v137
M v[68:71], a[152:155], a[20:23], v[68:71]
v_exp_f32 v139, v139
M v[68:71], a[148:151], a[16:19], v[68:71]
buffer_load_dwordx4 v1, s[12:15], s26 offen offset:1024 sc1 lds
M v[72:75], a[148:151], a[32:35], 0
v_exp_f32 v152, v152
M v[72:75], a[152:155], a[36:39], v[72:75]
ds_read_b128 a[124:127], v6 offset:33792
ds_read_b128 a[128:131], v6 offset:41984
M v[72:75], a[156:159], a[40:43], v[72:75]
v_exp_f32 v153, v153
M v[72:75], a[160:163], a[44:47], v[72:75]
buffer_load_dwordx4 v1, s[12:15], s26 offen offset:2048 sc1 lds
M v[76:79], a[160:163], a[60:63], 0
v_exp_f32 v154, v154
M v[76:79], a[156:159], a[56:59], v[76:79]
v_cvt_pk_bf16_f32 v137, v138, v139
v_cvt_pk_bf16_f32 v138, v152, v153
M v[76:79], a[152:155], a[52:55], v[76:79]
v_exp_f32 v155, v155
M v[76:79], a[148:151], a[48:51], v[76:79]
buffer_load_dwordx4 v1, s[12:15], s26 offen offset:3072 sc1 lds
s_add_u32 m0, s29, 36864
s_waitcnt lgkmcnt(4)
M v[80:83], a[164:167], a[0:3], 0
v_exp_f32 v140, v140
M v[80:83], a[168:171], a[4:7], v[80:83]
ds_read_b128 a[132:135], v6 offset:34816
ds_read_b128 a[136:139], v6 offset:43008
M v[80:83], a[172:175], a[8:11], v[80:83]
v_exp_f32 v141, v141
M v[80:83], a[176:179], a[12:15], v[80:83]
buffer_load_dwordx4 v1, s[12:15], s43 offen offset:0 sc1 lds
M v[84:87], a[176:179], a[28:31], 0
v_exp_f32 v142, v142
M v[84:87], a[172:175], a[24:27], v[84:87]
v_cvt_pk_bf16_f32 v139, v154, v155
v_cvt_pk_bf16_f32 v140, v140, v141
M v[84:87], a[168:171], a[20:23], v[84:87]
v_exp_f32 v143, v143
M v[84:87], a[164:167], a[16:19], v[84:87]
buffer_load_dwordx4 v1, s[12:15], s43 offen offset:1024 sc1 lds
M v[88:91], a[164:167], a[32:35], 0
v_exp_f32 v156, v156
M v[88:91], a[168:171], a[36:39], v[88:91]
ds_read_b128 a[140:143], v6 offset:35840
ds_read_b128 a[144:147], v6 offset:44032
M v[88:91], a[172:175], a[40:43], v[88:91]
v_exp_f32 v157, v157
M v[88:91], a[176:179], a[44:47], v[88:91]
buffer_load_dwordx4 v1, s[12:15], s43 offen offset:2048 sc1 lds
M v[92:95], a[176:179], a[60:63], 0
v_exp_f32 v158, v158
M v[92:95], a[172:175], a[56:59], v[92:95]
v_cvt_pk_bf16_f32 v141, v142, v143
v_cvt_pk_bf16_f32 v142, v156, v157
M v[92:95], a[168:171], a[52:55], v[92:95]
v_exp_f32 v159, v159
M v[92:95], a[164:167], a[48:51], v[92:95]
buffer_load_dwordx4 v1, s[12:15], s43 offen offset:3072 sc1 lds
v_cvt_pk_bf16_f32 v143, v158, v159
s_waitcnt lgkmcnt(6)
M v[160:163], a[116:119], v[96:99], v[160:163]
v_exp_f32 v32, v32
M v[160:163], a[120:123], v[128:131], v[160:163]
ds_read_b128 a[148:151], v6 offset:36864
ds_read_b128 a[152:155], v6 offset:45056
M v[164:167], a[120:123], v[132:135], v[164:167]
v_exp_f32 v33, v33
M v[164:167], a[116:119], v[100:103], v[164:167]
v_cvt_pk_bf16_f32 v32, v32, v33
M v[168:171], a[116:119], v[104:107], v[168:171]
v_exp_f32 v34, v34
M v[168:171], a[120:123], v[136:139], v[168:171]
s_add_u32 s25, s25, 32768
s_cmp_eq_u32 s25, s27
M v[172:175], a[120:123], v[140:143], v[172:175]
v_exp_f32 v35, v35
M v[172:175], a[116:119], v[108:111], v[172:175]
v_cvt_pk_bf16_f32 v33, v34, v35
s_waitcnt lgkmcnt(6)
M a[96:99], a[112:115], v[96:99], a[96:99]
s_cselect_b32 s25, s28, s25
s_cselect_b32 s27, -1, s27
M a[96:99], a[112:115], v[128:131], a[96:99]
s_add_u32 s26, s26, 32768
s_cmp_eq_u32 s26, s62
M v[176:179], a[124:127], v[96:99], v[176:179]
v_exp_f32 v48, v48
M v[176:179], a[128:131], v[128:131], v[176:179]
ds_read_b128 a[156:159], v6 offset:37888
ds_read_b128 a[160:163], v6 offset:46080
M v[180:183], a[128:131], v[132:135], v[180:183]
v_exp_f32 v49, v49
M v[180:183], a[124:127], v[100:103], v[180:183]
v_cvt_pk_bf16_f32 v34, v48, v49
M v[184:187], a[124:127], v[104:107], v[184:187]
v_exp_f32 v50, v50
M v[184:187], a[128:131], v[136:139], v[184:187]
s_cselect_b32 s26, s63, s26
s_cselect_b32 s62, -1, s62
M v[188:191], a[128:131], v[140:143], v[188:191]
v_exp_f32 v51, v51
M v[188:191], a[124:127], v[108:111], v[188:191]
v_cvt_pk_bf16_f32 v35, v50, v51
s_waitcnt lgkmcnt(6)
M a[100:103], a[112:115], v[100:103], a[100:103]
M a[100:103], a[112:115], v[132:135], a[100:103]
M v[192:195], a[132:135], v[96:99], v[192:195]
v_exp_f32 v36, v36
M v[192:195], a[136:139], v[128:131], v[192:195]
ds_read_b128 a[164:167], v6 offset:38912
ds_read_b128 a[168:171], v6 offset:47104
M v[196:199], a[136:139], v[132:135], v[196:199]
v_exp_f32 v37, v37
M v[196:199], a[132:135], v[100:103], v[196:199]
v_cvt_pk_bf16_f32 v36, v36, v37
M v[200:203], a[132:135], v[104:107], v[200:203]
v_exp_f32 v38, v38
M v[200:203], a[136:139], v[136:139], v[200:203]
M v[204:207], a[136:139], v[140:143], v[204:207]
v_exp_f32 v39, v39
M v[204:207], a[132:135], v[108:111], v[204:207]
v_cvt_pk_bf16_f32 v37, v38, v39
s_waitcnt lgkmcnt(6)
M a[104:107], a[112:115], v[104:107], a[104:107]
M a[104:107], a[112:115], v[136:139], a[104:107]
M v[208:211], a[140:143], v[96:99], v[208:211]
v_exp_f32 v52, v52
M v[208:211], a[144:147], v[128:131], v[208:211]
ds_read_b128 a[172:175], v6 offset:39936
ds_read_b128 a[176:179], v6 offset:48128
M v[212:215], a[144:147], v[132:135], v[212:215]
v_exp_f32 v53, v53
M v[212:215], a[140:143], v[100:103], v[212:215]
v_cvt_pk_bf16_f32 v38, v52, v53
M v[216:219], a[140:143], v[104:107], v[216:219]
v_exp_f32 v54, v54
M v[216:219], a[144:147], v[136:139], v[216:219]
M v[220:223], a[144:147], v[140:143], v[220:223]
v_exp_f32 v55, v55
M v[220:223], a[140:143], v[108:111], v[220:223]
v_cvt_pk_bf16_f32 v39, v54, v55
s_waitcnt lgkmcnt(6)
M a[108:111], a[112:115], v[108:111], a[108:111]
M a[108:111], a[112:115], v[140:143], a[108:111]
M v[224:227], a[148:151], v[96:99], v[224:227]
v_exp_f32 v40, v40
M v[224:227], a[152:155], v[128:131], v[224:227]
M v[228:231], a[152:155], v[132:135], v[228:231]
v_exp_f32 v41, v41
M v[228:231], a[148:151], v[100:103], v[228:231]
v_cvt_pk_bf16_f32 v40, v40, v41
M v[232:235], a[148:151], v[104:107], v[232:235]
v_exp_f32 v42, v42
M v[232:235], a[152:155], v[136:139], v[232:235]
M v[236:239], a[152:155], v[140:143], v[236:239]
v_exp_f32 v43, v43
M v[236:239], a[148:151], v[108:111], v[236:239]
v_cvt_pk_bf16_f32 v41, v42, v43
s_waitcnt lgkmcnt(4)
M v[240:243], a[156:159], v[96:99], v[240:243]
v_exp_f32 v56, v56
M v[240:243], a[160:163], v[128:131], v[240:243]
M v[244:247], a[160:163], v[132:135], v[244:247]
v_exp_f32 v57, v57
M v[244:247], a[156:159], v[100:103], v[244:247]
v_cvt_pk_bf16_f32 v42, v56, v57
M v[248:251], a[156:159], v[104:107], v[248:251]
v_exp_f32 v58, v58
M v[248:251], a[160:163], v[136:139], v[248:251]
s_waitcnt vmcnt(0) lgkmcnt(0)
s_barrier
ds_read_b128 a[116:119], v2 offset:0
ds_read_b128 a[120:123], v2 offset:1024
M v[252:255], a[160:163], v[140:143], v[252:255]
v_exp_f32 v59, v59
M v[252:255], a[156:159], v[108:111], v[252:255]
v_cvt_pk_bf16_f32 v43, v58, v59
M a[64:67], a[164:167], v[96:99], a[64:67]
v_exp_f32 v44, v44
M a[64:67], a[168:171], v[128:131], a[64:67]
ds_read_b128 a[124:127], v2 offset:2048
ds_read_b128 a[128:131], v2 offset:3072
M a[68:71], a[168:171], v[132:135], a[68:71]
v_exp_f32 v45, v45
M a[68:71], a[164:167], v[100:103], a[68:71]
v_cvt_pk_bf16_f32 v44, v44, v45
M a[72:75], a[164:167], v[104:107], a[72:75]
v_exp_f32 v46, v46
M a[72:75], a[168:171], v[136:139], a[72:75]
ds_read_b128 a[132:135], v2 offset:4096
ds_read_b128 a[136:139], v2 offset:5120
M a[76:79], a[168:171], v[140:143], a[76:79]
v_exp_f32 v47, v47
M a[76:79], a[164:167], v[108:111], a[76:79]
v_cvt_pk_bf16_f32 v45, v46, v47
M a[80:83], a[172:175], v[96:99], a[80:83]
v_exp_f32 v60, v60
M a[80:83], a[176:179], v[128:131], a[80:83]
ds_read_b128 a[140:143], v2 offset:6144
ds_read_b128 a[144:147], v2 offset:7168
M a[84:87], a[176:179], v[132:135], a[84:87]
v_exp_f32 v61, v61
M a[84:87], a[172:175], v[100:103], a[84:87]
v_cvt_pk_bf16_f32 v46, v60, v61
M a[88:91], a[172:175], v[104:107], a[88:91]
v_exp_f32 v62, v62
M a[88:91], a[176:179], v[136:139], a[88:91]
M a[92:95], a[176:179], v[140:143], a[92:95]
v_exp_f32 v63, v63
M a[92:95], a[172:175], v[108:111], a[92:95]
v_cvt_pk_bf16_f32 v47, v62, v63
s_branch Lk2_l1
Lk2_m1:
s_lshl_b32 s33, s23, 6
s_add_i32 s33, s33, 0
s_cmp_gt_i32 s33, 0
s_cselect_b32 s34, 0, 0xf149f2ca
s_cmp_lt_i32 s33, 0
s_cselect_b32 s33, 0xf149f2ca, 0
v_mov_b32 v20, s34
v_mov_b32 v21, s34
v_mov_b32 v22, s34
v_mov_b32 v23, s34
v_mov_b32 v28, s33
v_mov_b32 v29, s33
v_mov_b32 v30, s33
v_mov_b32 v31, s33
v_med3_f32 v24, v16, v20, v28
v_med3_f32 v25, v17, v20, v28
v_med3_f32 v26, v18, v20, v28
v_med3_f32 v27, v19, v20, v28
s_add_u32 m0, s29, 0
s_waitcnt lgkmcnt(4)
M v[32:35], a[116:119], a[0:3], v[24:27]
v_exp_f32 v128, v128
M v[32:35], a[120:123], a[4:7], v[32:35]
ds_read_b128 a[148:151], v3 offset:8192
ds_read_b128 a[152:155], v3 offset:9216
M v[32:35], a[124:127], a[8:11], v[32:35]
v_exp_f32 v129, v129
M v[32:35], a[128:131], a[12:15], v[32:35]
buffer_load_dwordx4 v1, s[12:15], s25 offen offset:0 sc1 lds
s_add_u32 s32, s25, 4096
M v[36:39], a[128:131], a[28:31], v[28:31]
v_exp_f32 v130, v130
M v[36:39], a[124:127], a[24:27], v[36:39]
v_cvt_pk_bf16_f32 v128, v128, v129
M v[36:39], a[120:123], a[20:23], v[36:39]
v_exp_f32 v131, v131
M v[36:39], a[116:119], a[16:19], v[36:39]
buffer_load_dwordx4 v1, s[12:15], s25 offen offset:1024 sc1 lds
M v[40:43], a[116:119], a[32:35], v[28:31]
v_exp_f32 v144, v144
M v[40:43], a[120:123], a[36:39], v[40:43]
ds_read_b128 a[156:159], v3 offset:10240
ds_read_b128 a[160:163], v3 offset:11264
M v[40:43], a[124:127], a[40:43], v[40:43]
v_exp_f32 v145, v145
M v[40:43], a[128:131], a[44:47], v[40:43]
buffer_load_dwordx4 v1, s[12:15], s25 offen offset:2048 sc1 lds
M v[44:47], a[128:131], a[60:63], v[28:31]
v_exp_f32 v146, v146
M v[44:47], a[124:127], a[56:59], v[44:47]
v_cvt_pk_bf16_f32 v129, v130, v131
v_cvt_pk_bf16_f32 v130, v144, v145
M v[44:47], a[120:123], a[52:55], v[44:47]
v_exp_f32 v147, v147
M v[44:47], a[116:119], a[48:51], v[44:47]
buffer_load_dwordx4 v1, s[12:15], s25 offen offset:3072 sc1 lds
s_add_u32 m0, s29, 4096
s_waitcnt lgkmcnt(4)
M v[48:51], a[132:135], a[0:3], v[20:23]
v_exp_f32 v132, v132
M v[48:51], a[136:139], a[4:7], v[48:51]
ds_read_b128 a[164:167], v3 offset:12288
ds_read_b128 a[168:171], v3 offset:13312
M v[48:51], a[140:143], a[8:11], v[48:51]
v_exp_f32 v133, v133
M v[48:51], a[144:147], a[12:15], v[48:51]
buffer_load_dwordx4 v1, s[12:15], s32 offen offset:0 sc1 lds
M v[52:55], a[144:147], a[28:31], v[24:27]
v_exp_f32 v134, v134
M v[52:55], a[140:143], a[24:27], v[52:55]
v_cvt_pk_bf16_f32 v131, v146, v147
v_cvt_pk_bf16_f32 v132, v132, v133
M v[52:55], a[136:139], a[20:23], v[52:55]
v_exp_f32 v135, v135
M v[52:55], a[132:135], a[16:19], v[52:55]
buffer_load_dwordx4 v1, s[12:15], s32 offen offset:1024 sc1 lds
M v[56:59], a[132:135], a[32:35], v[28:31]
v_exp_f32 v148, v148
M v[56:59], a[136:139], a[36:39], v[56:59]
ds_read_b128 a[172:175], v3 offset:14336
ds_read_b128 a[176:179], v3 offset:15360
M v[56:59], a[140:143], a[40:43], v[56:59]
v_exp_f32 v149, v149
M v[56:59], a[144:147], a[44:47], v[56:59]
buffer_load_dwordx4 v1, s[12:15], s32 offen offset:2048 sc1 lds
M v[60:63], a[144:147], a[60:63], v[28:31]
v_exp_f32 v150, v150
M v[60:63], a[140:143], a[56:59], v[60:63]
v_cvt_pk_bf16_f32 v133, v134, v135
v_cvt_pk_bf16_f32 v134, v148, v149
M v[60:63], a[136:139], a[52:55], v[60:63]
v_exp_f32 v151, v151
M v[60:63], a[132:135], a[48:51], v[60:63]
buffer_load_dwordx4 v1, s[12:15], s32 offen offset:3072 sc1 lds
s_add_u32 m0, s29, 32768
s_waitcnt lgkmcnt(4)
M v[64:67], a[148:151], a[0:3], v[20:23]
v_exp_f32 v136, v136
M v[64:67], a[152:155], a[4:7], v[64:67]
ds_read_b128 a[116:119], v6 offset:32768
ds_read_b128 a[120:123], v6 offset:40960
M v[64:67], a[156:159], a[8:11], v[64:67]
v_exp_f32 v137, v137
M v[64:67], a[160:163], a[12:15], v[64:67]
buffer_load_dwordx4 v1, s[12:15], s26 offen offset:0 sc1 lds
s_add_u32 s43, s26, 4096
M v[68:71], a[160:163], a[28:31], v[20:23]
v_exp_f32 v138, v138
M v[68:71], a[156:159], a[24:27], v[68:71]
v_cvt_pk_bf16_f32 v135, v150, v151
v_cvt_pk_bf16_f32 v136, v136, v137
M v[68:71], a[152:155], a[20:23], v[68:71]
v_exp_f32 v139, v139
M v[68:71], a[148:151], a[16:19], v[68:71]
buffer_load_dwordx4 v1, s[12:15], s26 offen offset:1024 sc1 lds
M v[72:75], a[148:151], a[32:35], v[24:27]
v_exp_f32 v152, v152
M v[72:75], a[152:155], a[36:39], v[72:75]
ds_read_b128 a[124:127], v6 offset:33792
ds_read_b128 a[128:131], v6 offset:41984
M v[72:75], a[156:159], a[40:43], v[72:75]
v_exp_f32 v153, v153
M v[72:75], a[160:163], a[44:47], v[72:75]
buffer_load_dwordx4 v1, s[12:15], s26 offen offset:2048 sc1 lds
M v[76:79], a[160:163], a[60:63], v[28:31]
v_exp_f32 v154, v154
M v[76:79], a[156:159], a[56:59], v[76:79]
v_cvt_pk_bf16_f32 v137, v138, v139
v_cvt_pk_bf16_f32 v138, v152, v153
M v[76:79], a[152:155], a[52:55], v[76:79]
v_exp_f32 v155, v155
M v[76:79], a[148:151], a[48:51], v[76:79]
buffer_load_dwordx4 v1, s[12:15], s26 offen offset:3072 sc1 lds
s_add_u32 m0, s29, 36864
s_waitcnt lgkmcnt(4)
M v[80:83], a[164:167], a[0:3], v[20:23]
v_exp_f32 v140, v140
M v[80:83], a[168:171], a[4:7], v[80:83]
ds_read_b128 a[132:135], v6 offset:34816
ds_read_b128 a[136:139], v6 offset:43008
M v[80:83], a[172:175], a[8:11], v[80:83]
v_exp_f32 v141, v141
M v[80:83], a[176:179], a[12:15], v[80:83]
buffer_load_dwordx4 v1, s[12:15], s43 offen offset:0 sc1 lds
M v[84:87], a[176:179], a[28:31], v[20:23]
v_exp_f32 v142, v142
M v[84:87], a[172:175], a[24:27], v[84:87]
v_cvt_pk_bf16_f32 v139, v154, v155
v_cvt_pk_bf16_f32 v140, v140, v141
M v[84:87], a[168:171], a[20:23], v[84:87]
v_exp_f32 v143, v143
M v[84:87], a[164:167], a[16:19], v[84:87]
buffer_load_dwordx4 v1, s[12:15], s43 offen offset:1024 sc1 lds
M v[88:91], a[164:167], a[32:35], v[20:23]
v_exp_f32 v156, v156
M v[88:91], a[168:171], a[36:39], v[88:91]
ds_read_b128 a[140:143], v6 offset:35840
ds_read_b128 a[144:147], v6 offset:44032
M v[88:91], a[172:175], a[40:43], v[88:91]
v_exp_f32 v157, v157
M v[88:91], a[176:179], a[44:47], v[88:91]
buffer_load_dwordx4 v1, s[12:15], s43 offen offset:2048 sc1 lds
M v[92:95], a[176:179], a[60:63], v[24:27]
v_exp_f32 v158, v158
M v[92:95], a[172:175], a[56:59], v[92:95]
v_cvt_pk_bf16_f32 v141, v142, v143
v_cvt_pk_bf16_f32 v142, v156, v157
M v[92:95], a[168:171], a[52:55], v[92:95]
v_exp_f32 v159, v159
M v[92:95], a[164:167], a[48:51], v[92:95]
buffer_load_dwordx4 v1, s[12:15], s43 offen offset:3072 sc1 lds
v_cvt_pk_bf16_f32 v143, v158, v159
s_waitcnt lgkmcnt(6)
M v[160:163], a[116:119], v[96:99], v[160:163]
v_exp_f32 v32, v32
M v[160:163], a[120:123], v[128:131], v[160:163]
ds_read_b128 a[148:151], v6 offset:36864
ds_read_b128 a[152:155], v6 offset:45056
M v[164:167], a[120:123], v[132:135], v[164:167]
v_exp_f32 v33, v33
M v[164:167], a[116:119], v[100:103], v[164:167]
v_cvt_pk_bf16_f32 v32, v32, v33
M v[168:171], a[116:119], v[104:107], v[168:171]
v_exp_f32 v34, v34
M v[168:171], a[120:123], v[136:139], v[168:171]
s_add_u32 s25, s25, 32768
s_cmp_eq_u32 s25, s27
M v[172:175], a[120:123], v[140:143], v[172:175]
v_exp_f32 v35, v35
M v[172:175], a[116:119], v[108:111], v[172:175]
v_cvt_pk_bf16_f32 v33, v34, v35
s_waitcnt lgkmcnt(6)
M a[96:99], a[112:115], v[96:99], a[96:99]
s_cselect_b32 s25, s28, s25
s_cselect_b32 s27, -1, s27
M a[96:99], a[112:115], v[128:131], a[96:99]
s_add_u32 s26, s26, 32768
s_cmp_eq_u32 s26, s62
M v[176:179], a[124:127], v[96:99], v[176:179]
v_exp_f32 v48, v48
M v[176:179], a[128:131], v[128:131], v[176:179]
ds_read_b128 a[156:159], v6 offset:37888
ds_read_b128 a[160:163], v6 offset:46080
M v[180:183], a[128:131], v[132:135], v[180:183]
v_exp_f32 v49, v49
M v[180:183], a[124:127], v[100:103], v[180:183]
v_cvt_pk_bf16_f32 v34, v48, v49
M v[184:187], a[124:127], v[104:107], v[184:187]
v_exp_f32 v50, v50
M v[184:187], a[128:131], v[136:139], v[184:187]
s_cselect_b32 s26, s63, s26
s_cselect_b32 s62, -1, s62
M v[188:191], a[128:131], v[140:143], v[188:191]
v_exp_f32 v51, v51
M v[188:191], a[124:127], v[108:111], v[188:191]
v_cvt_pk_bf16_f32 v35, v50, v51
s_waitcnt lgkmcnt(6)
M a[100:103], a[112:115], v[100:103], a[100:103]
M a[100:103], a[112:115], v[132:135], a[100:103]
M v[192:195], a[132:135], v[96:99], v[192:195]
v_exp_f32 v36, v36
M v[192:195], a[136:139], v[128:131], v[192:195]
ds_read_b128 a[164:167], v6 offset:38912
ds_read_b128 a[168:171], v6 offset:47104
M v[196:199], a[136:139], v[132:135], v[196:199]
v_exp_f32 v37, v37
M v[196:199], a[132:135], v[100:103], v[196:199]
v_cvt_pk_bf16_f32 v36, v36, v37
M v[200:203], a[132:135], v[104:107], v[200:203]
v_exp_f32 v38, v38
M v[200:203], a[136:139], v[136:139], v[200:203]
M v[204:207], a[136:139], v[140:143], v[204:207]
v_exp_f32 v39, v39
M v[204:207], a[132:135], v[108:111], v[204:207]
v_cvt_pk_bf16_f32 v37, v38, v39
s_waitcnt lgkmcnt(6)
M a[104:107], a[112:115], v[104:107], a[104:107]
M a[104:107], a[112:115], v[136:139], a[104:107]
M v[208:211], a[140:143], v[96:99], v[208:211]
v_exp_f32 v52, v52
M v[208:211], a[144:147], v[128:131], v[208:211]
ds_read_b128 a[172:175], v6 offset:39936
ds_read_b128 a[176:179], v6 offset:48128
M v[212:215], a[144:147], v[132:135], v[212:215]
v_exp_f32 v53, v53
M v[212:215], a[140:143], v[100:103], v[212:215]
v_cvt_pk_bf16_f32 v38, v52, v53
M v[216:219], a[140:143], v[104:107], v[216:219]
v_exp_f32 v54, v54
M v[216:219], a[144:147], v[136:139], v[216:219]
M v[220:223], a[144:147], v[140:143], v[220:223]
v_exp_f32 v55, v55
M v[220:223], a[140:143], v[108:111], v[220:223]
v_cvt_pk_bf16_f32 v39, v54, v55
s_waitcnt lgkmcnt(6)
M a[108:111], a[112:115], v[108:111], a[108:111]
M a[108:111], a[112:115], v[140:143], a[108:111]
M v[224:227], a[148:151], v[96:99], v[224:227]
v_exp_f32 v40, v40
M v[224:227], a[152:155], v[128:131], v[224:227]
M v[228:231], a[152:155], v[132:135], v[228:231]
v_exp_f32 v41, v41
M v[228:231], a[148:151], v[100:103], v[228:231]
v_cvt_pk_bf16_f32 v40, v40, v41
M v[232:235], a[148:151], v[104:107], v[232:235]
v_exp_f32 v42, v42
M v[232:235], a[152:155], v[136:139], v[232:235]
M v[236:239], a[152:155], v[140:143], v[236:239]
v_exp_f32 v43, v43
M v[236:239], a[148:151], v[108:111], v[236:239]
v_cvt_pk_bf16_f32 v41, v42, v43
s_waitcnt lgkmcnt(4)
M v[240:243], a[156:159], v[96:99], v[240:243]
v_exp_f32 v56, v56
M v[240:243], a[160:163], v[128:131], v[240:243]
M v[244:247], a[160:163], v[132:135], v[244:247]
v_exp_f32 v57, v57
M v[244:247], a[156:159], v[100:103], v[244:247]
v_cvt_pk_bf16_f32 v42, v56, v57
M v[248:251], a[156:159], v[104:107], v[248:251]
v_exp_f32 v58, v58
M v[248:251], a[160:163], v[136:139], v[248:251]
s_waitcnt vmcnt(0) lgkmcnt(0)
s_barrier
ds_read_b128 a[116:119], v2 offset:0
ds_read_b128 a[120:123], v2 offset:1024
M v[252:255], a[160:163], v[140:143], v[252:255]
v_exp_f32 v59, v59
M v[252:255], a[156:159], v[108:111], v[252:255]
v_cvt_pk_bf16_f32 v43, v58, v59
M a[64:67], a[164:167], v[96:99], a[64:67]
v_exp_f32 v44, v44
M a[64:67], a[168:171], v[128:131], a[64:67]
ds_read_b128 a[124:127], v2 offset:2048
ds_read_b128 a[128:131], v2 offset:3072
M a[68:71], a[168:171], v[132:135], a[68:71]
v_exp_f32 v45, v45
M a[68:71], a[164:167], v[100:103], a[68:71]
v_cvt_pk_bf16_f32 v44, v44, v45
M a[72:75], a[164:167], v[104:107], a[72:75]
v_exp_f32 v46, v46
M a[72:75], a[168:171], v[136:139], a[72:75]
ds_read_b128 a[132:135], v2 offset:4096
ds_read_b128 a[136:139], v2 offset:5120
M a[76:79], a[168:171], v[140:143], a[76:79]
v_exp_f32 v47, v47
M a[76:79], a[164:167], v[108:111], a[76:79]
v_cvt_pk_bf16_f32 v45, v46, v47
M a[80:83], a[172:175], v[96:99], a[80:83]
v_exp_f32 v60, v60
M a[80:83], a[176:179], v[128:131], a[80:83]
ds_read_b128 a[140:143], v2 offset:6144
ds_read_b128 a[144:147], v2 offset:7168
M a[84:87], a[176:179], v[132:135], a[84:87]
v_exp_f32 v61, v61
M a[84:87], a[172:175], v[100:103], a[84:87]
v_cvt_pk_bf16_f32 v46, v60, v61
M a[88:91], a[172:175], v[104:107], a[88:91]
v_exp_f32 v62, v62
M a[88:91], a[176:179], v[136:139], a[88:91]
M a[92:95], a[176:179], v[140:143], a[92:95]
v_exp_f32 v63, v63
M a[92:95], a[172:175], v[108:111], a[92:95]
v_cvt_pk_bf16_f32 v47, v62, v63
Lk2_m2:
s_sub_u32 s35, 15, s21
s_lshl_b32 s33, s20, 7
s_lshl_b32 s34, s35, 3
s_add_u32 s33, s33, s34
s_lshl_b32 s34, s23, 2
s_add_u32 s33, s33, s34
s_lshl_b32 s33, s33, 12
buffer_load_dwordx4 a[180:183], v1, s[8:11], s33 offen offset:0 sc1
buffer_load_dwordx4 a[184:187], v1, s[8:11], s33 offen offset:1024 sc1
buffer_load_dwordx4 a[188:191], v1, s[8:11], s33 offen offset:2048 sc1
buffer_load_dwordx4 a[192:195], v1, s[8:11], s33 offen offset:3072 sc1
s_add_u32 s33, s33, 4096
buffer_load_dwordx4 a[196:199], v1, s[8:11], s33 offen offset:0 sc1
buffer_load_dwordx4 a[200:203], v1, s[8:11], s33 offen offset:1024 sc1
buffer_load_dwordx4 a[204:207], v1, s[8:11], s33 offen offset:2048 sc1
buffer_load_dwordx4 a[208:211], v1, s[8:11], s33 offen offset:3072 sc1
s_add_u32 s33, s33, 4096
buffer_load_dwordx4 a[212:215], v1, s[8:11], s33 offen offset:0 sc1
buffer_load_dwordx4 a[216:219], v1, s[8:11], s33 offen offset:1024 sc1
buffer_load_dwordx4 a[220:223], v1, s[8:11], s33 offen offset:2048 sc1
buffer_load_dwordx4 a[224:227], v1, s[8:11], s33 offen offset:3072 sc1
s_add_u32 s33, s33, 4096
buffer_load_dwordx4 a[228:231], v1, s[8:11], s33 offen offset:0 sc1
buffer_load_dwordx4 a[232:235], v1, s[8:11], s33 offen offset:1024 sc1
buffer_load_dwordx4 a[236:239], v1, s[8:11], s33 offen offset:2048 sc1
buffer_load_dwordx4 a[240:243], v1, s[8:11], s33 offen offset:3072 sc1
s_lshl_b32 s33, s23, 6
s_add_i32 s33, s33, -64
s_cmp_gt_i32 s33, 0
s_cselect_b32 s34, 0, 0xf149f2ca
s_cmp_lt_i32 s33, 0
s_cselect_b32 s33, 0xf149f2ca, 0
v_mov_b32 v20, s34
v_mov_b32 v21, s34
v_mov_b32 v22, s34
v_mov_b32 v23, s34
v_mov_b32 v28, s33
v_mov_b32 v29, s33
v_mov_b32 v30, s33
v_mov_b32 v31, s33
v_med3_f32 v24, v16, v20, v28
v_med3_f32 v25, v17, v20, v28
v_med3_f32 v26, v18, v20, v28
v_med3_f32 v27, v19, v20, v28
s_add_u32 m0, s29, 65536
s_waitcnt lgkmcnt(4)
M v[96:99], a[116:119], a[0:3], v[24:27]
v_exp_f32 v64, v64
M v[96:99], a[120:123], a[4:7], v[96:99]
ds_read_b128 a[148:151], v2 offset:8192
ds_read_b128 a[152:155], v2 offset:9216
M v[96:99], a[124:127], a[8:11], v[96:99]
v_exp_f32 v65, v65
M v[96:99], a[128:131], a[12:15], v[96:99]
buffer_load_dwordx4 v1, s[12:15], s25 offen offset:0 sc1 lds
s_add_u32 s32, s25, 4096
M v[100:103], a[128:131], a[28:31], v[28:31]
v_exp_f32 v66, v66
M v[100:103], a[124:127], a[24:27], v[100:103]
v_cvt_pk_bf16_f32 v64, v64, v65
M v[100:103], a[120:123], a[20:23], v[100:103]
v_exp_f32 v67, v67
M v[100:103], a[116:119], a[16:19], v[100:103]
buffer_load_dwordx4 v1, s[12:15], s25 offen offset:1024 sc1 lds
M v[104:107], a[116:119], a[32:35], v[28:31]
v_exp_f32 v80, v80
M v[104:107], a[120:123], a[36:39], v[104:107]
ds_read_b128 a[156:159], v2 offset:10240
ds_read_b128 a[160:163], v2 offset:11264
M v[104:107], a[124:127], a[40:43], v[104:107]
v_exp_f32 v81, v81
M v[104:107], a[128:131], a[44:47], v[104:107]
buffer_load_dwordx4 v1, s[12:15], s25 offen offset:2048 sc1 lds
M v[108:111], a[128:131], a[60:63], v[28:31]
v_exp_f32 v82, v82
M v[108:111], a[124:127], a[56:59], v[108:111]
v_cvt_pk_bf16_f32 v65, v66, v67
v_cvt_pk_bf16_f32 v66, v80, v81
M v[108:111], a[120:123], a[52:55], v[108:111]
v_exp_f32 v83, v83
M v[108:111], a[116:119], a[48:51], v[108:111]
buffer_load_dwordx4 v1, s[12:15], s25 offen offset:3072 sc1 lds
s_add_u32 m0, s29, 69632
s_waitcnt lgkmcnt(4)
M v[112:115], a[132:135], a[0:3], v[20:23]
v_exp_f32 v68, v68
M v[112:115], a[136:139], a[4:7], v[112:115]
ds_read_b128 a[164:167], v2 offset:12288
ds_read_b128 a[168:171], v2 offset:13312
M v[112:115], a[140:143], a[8:11], v[112:115]
v_exp_f32 v69, v69
M v[112:115], a[144:147], a[12:15], v[112:115]
buffer_load_dwordx4 v1, s[12:15], s32 offen offset:0 sc1 lds
M v[116:119], a[144:147], a[28:31], v[24:27]
v_exp_f32 v70, v70
M v[116:119], a[140:143], a[24:27], v[116:119]
v_cvt_pk_bf16_f32 v67, v82, v83
v_cvt_pk_bf16_f32 v68, v68, v69
M v[116:119], a[136:139], a[20:23], v[116:119]
v_exp_f32 v71, v71
M v[116:119], a[132:135], a[16:19], v[116:119]
buffer_load_dwordx4 v1, s[12:15], s32 offen offset:1024 sc1 lds
M v[120:123], a[132:135], a[32:35], v[28:31]
v_exp_f32 v84, v84
M v[120:123], a[136:139], a[36:39], v[120:123]
ds_read_b128 a[172:175], v2 offset:14336
ds_read_b128 a[176:179], v2 offset:15360
M v[120:123], a[140:143], a[40:43], v[120:123]
v_exp_f32 v85, v85
M v[120:123], a[144:147], a[44:47], v[120:123]
buffer_load_dwordx4 v1, s[12:15], s32 offen offset:2048 sc1 lds
M v[124:127], a[144:147], a[60:63], v[28:31]
v_exp_f32 v86, v86
M v[124:127], a[140:143], a[56:59], v[124:127]
v_cvt_pk_bf16_f32 v69, v70, v71
v_cvt_pk_bf16_f32 v70, v84, v85
M v[124:127], a[136:139], a[52:55], v[124:127]
v_exp_f32 v87, v87
M v[124:127], a[132:135], a[48:51], v[124:127]
buffer_load_dwordx4 v1, s[12:15], s32 offen offset:3072 sc1 lds
s_add_u32 m0, s29, 98304
s_waitcnt lgkmcnt(4)
M v[128:131], a[148:151], a[0:3], v[20:23]
v_exp_f32 v72, v72
M v[128:131], a[152:155], a[4:7], v[128:131]
ds_read_b128 a[116:119], v5 offset:32768
ds_read_b128 a[120:123], v5 offset:40960
M v[128:131], a[156:159], a[8:11], v[128:131]
v_exp_f32 v73, v73
M v[128:131], a[160:163], a[12:15], v[128:131]
buffer_load_dwordx4 v1, s[12:15], s26 offen offset:0 sc1 lds
s_add_u32 s43, s26, 4096
M v[132:135], a[160:163], a[28:31], v[20:23]
v_exp_f32 v74, v74
M v[132:135], a[156:159], a[24:27], v[132:135]
v_cvt_pk_bf16_f32 v71, v86, v87
v_cvt_pk_bf16_f32 v72, v72, v73
M v[132:135], a[152:155], a[20:23], v[132:135]
v_exp_f32 v75, v75
M v[132:135], a[148:151], a[16:19], v[132:135]
buffer_load_dwordx4 v1, s[12:15], s26 offen offset:1024 sc1 lds
M v[136:139], a[148:151], a[32:35], v[24:27]
v_exp_f32 v88, v88
M v[136:139], a[152:155], a[36:39], v[136:139]
ds_read_b128 a[124:127], v5 offset:33792
ds_read_b128 a[128:131], v5 offset:41984
M v[136:139], a[156:159], a[40:43], v[136:139]
v_exp_f32 v89, v89
M v[136:139], a[160:163], a[44:47], v[136:139]
buffer_load_dwordx4 v1, s[12:15], s26 offen offset:2048 sc1 lds
M v[140:143], a[160:163], a[60:63], v[28:31]
v_exp_f32 v90, v90
M v[140:143], a[156:159], a[56:59], v[140:143]
v_cvt_pk_bf16_f32 v73, v74, v75
v_cvt_pk_bf16_f32 v74, v88, v89
M v[140:143], a[152:155], a[52:55], v[140:143]
v_exp_f32 v91, v91
M v[140:143], a[148:151], a[48:51], v[140:143]
buffer_load_dwordx4 v1, s[12:15], s26 offen offset:3072 sc1 lds
s_add_u32 m0, s29, 102400
s_waitcnt lgkmcnt(4)
M v[144:147], a[164:167], a[0:3], v[20:23]
v_exp_f32 v76, v76
M v[144:147], a[168:171], a[4:7], v[144:147]
ds_read_b128 a[132:135], v5 offset:34816
ds_read_b128 a[136:139], v5 offset:43008
M v[144:147], a[172:175], a[8:11], v[144:147]
v_exp_f32 v77, v77
M v[144:147], a[176:179], a[12:15], v[144:147]
buffer_load_dwordx4 v1, s[12:15], s43 offen offset:0 sc1 lds
M v[148:151], a[176:179], a[28:31], v[20:23]
v_exp_f32 v78, v78
M v[148:151], a[172:175], a[24:27], v[148:151]
v_cvt_pk_bf16_f32 v75, v90, v91
v_cvt_pk_bf16_f32 v76, v76, v77
M v[148:151], a[168:171], a[20:23], v[148:151]
v_exp_f32 v79, v79
M v[148:151], a[164:167], a[16:19], v[148:151]
buffer_load_dwordx4 v1, s[12:15], s43 offen offset:1024 sc1 lds
M v[152:155], a[164:167], a[32:35], v[20:23]
v_exp_f32 v92, v92
M v[152:155], a[168:171], a[36:39], v[152:155]
ds_read_b128 a[140:143], v5 offset:35840
ds_read_b128 a[144:147], v5 offset:44032
M v[152:155], a[172:175], a[40:43], v[152:155]
v_exp_f32 v93, v93
M v[152:155], a[176:179], a[44:47], v[152:155]
buffer_load_dwordx4 v1, s[12:15], s43 offen offset:2048 sc1 lds
M v[156:159], a[176:179], a[60:63], v[24:27]
v_exp_f32 v94, v94
M v[156:159], a[172:175], a[56:59], v[156:159]
v_cvt_pk_bf16_f32 v77, v78, v79
v_cvt_pk_bf16_f32 v78, v92, v93
M v[156:159], a[168:171], a[52:55], v[156:159]
v_exp_f32 v95, v95
M v[156:159], a[164:167], a[48:51], v[156:159]
buffer_load_dwordx4 v1, s[12:15], s43 offen offset:3072 sc1 lds
v_cvt_pk_bf16_f32 v79, v94, v95
s_waitcnt lgkmcnt(6)
M v[160:163], a[116:119], v[32:35], v[160:163]
v_exp_f32 v96, v96
M v[160:163], a[120:123], v[64:67], v[160:163]
ds_read_b128 a[148:151], v5 offset:36864
ds_read_b128 a[152:155], v5 offset:45056
M v[164:167], a[120:123], v[68:71], v[164:167]
v_exp_f32 v97, v97
M v[164:167], a[116:119], v[36:39], v[164:167]
v_cvt_pk_bf16_f32 v96, v96, v97
M v[168:171], a[116:119], v[40:43], v[168:171]
v_exp_f32 v98, v98
M v[168:171], a[120:123], v[72:75], v[168:171]
s_add_u32 s25, s25, 32768
s_cmp_eq_u32 s25, s27
M v[172:175], a[120:123], v[76:79], v[172:175]
v_exp_f32 v99, v99
M v[172:175], a[116:119], v[44:47], v[172:175]
v_cvt_pk_bf16_f32 v97, v98, v99
s_waitcnt lgkmcnt(6)
M a[96:99], a[112:115], v[32:35], a[96:99]
s_cselect_b32 s25, s28, s25
s_cselect_b32 s27, -1, s27
M a[96:99], a[112:115], v[64:67], a[96:99]
s_add_u32 s26, s26, 32768
s_cmp_eq_u32 s26, s62
M v[176:179], a[124:127], v[32:35], v[176:179]
v_exp_f32 v112, v112
M v[176:179], a[128:131], v[64:67], v[176:179]
ds_read_b128 a[156:159], v5 offset:37888
ds_read_b128 a[160:163], v5 offset:46080
M v[180:183], a[128:131], v[68:71], v[180:183]
v_exp_f32 v113, v113
M v[180:183], a[124:127], v[36:39], v[180:183]
v_cvt_pk_bf16_f32 v98, v112, v113
M v[184:187], a[124:127], v[40:43], v[184:187]
v_exp_f32 v114, v114
M v[184:187], a[128:131], v[72:75], v[184:187]
s_cselect_b32 s26, s63, s26
s_cselect_b32 s62, -1, s62
M v[188:191], a[128:131], v[76:79], v[188:191]
v_exp_f32 v115, v115
M v[188:191], a[124:127], v[44:47], v[188:191]
v_cvt_pk_bf16_f32 v99, v114, v115
s_waitcnt lgkmcnt(6)
M a[100:103], a[112:115], v[36:39], a[100:103]
M a[100:103], a[112:115], v[68:71], a[100:103]
M v[192:195], a[132:135], v[32:35], v[192:195]
v_exp_f32 v100, v100
M v[192:195], a[136:139], v[64:67], v[192:195]
ds_read_b128 a[164:167], v5 offset:38912
ds_read_b128 a[168:171], v5 offset:47104
M v[196:199], a[136:139], v[68:71], v[196:199]
v_exp_f32 v101, v101
M v[196:199], a[132:135], v[36:39], v[196:199]
v_cvt_pk_bf16_f32 v100, v100, v101
M v[200:203], a[132:135], v[40:43], v[200:203]
v_exp_f32 v102, v102
M v[200:203], a[136:139], v[72:75], v[200:203]
M v[204:207], a[136:139], v[76:79], v[204:207]
v_exp_f32 v103, v103
M v[204:207], a[132:135], v[44:47], v[204:207]
v_cvt_pk_bf16_f32 v101, v102, v103
s_waitcnt lgkmcnt(6)
M a[104:107], a[112:115], v[40:43], a[104:107]
M a[104:107], a[112:115], v[72:75], a[104:107]
M v[208:211], a[140:143], v[32:35], v[208:211]
v_exp_f32 v116, v116
M v[208:211], a[144:147], v[64:67], v[208:211]
ds_read_b128 a[172:175], v5 offset:39936
ds_read_b128 a[176:179], v5 offset:48128
M v[212:215], a[144:147], v[68:71], v[212:215]
v_exp_f32 v117, v117
M v[212:215], a[140:143], v[36:39], v[212:215]
v_cvt_pk_bf16_f32 v102, v116, v117
M v[216:219], a[140:143], v[40:43], v[216:219]
v_exp_f32 v118, v118
M v[216:219], a[144:147], v[72:75], v[216:219]
M v[220:223], a[144:147], v[76:79], v[220:223]
v_exp_f32 v119, v119
M v[220:223], a[140:143], v[44:47], v[220:223]
v_cvt_pk_bf16_f32 v103, v118, v119
s_waitcnt lgkmcnt(6)
M a[108:111], a[112:115], v[44:47], a[108:111]
M a[108:111], a[112:115], v[76:79], a[108:111]
M v[224:227], a[148:151], v[32:35], v[224:227]
v_exp_f32 v104, v104
M v[224:227], a[152:155], v[64:67], v[224:227]
M v[228:231], a[152:155], v[68:71], v[228:231]
v_exp_f32 v105, v105
M v[228:231], a[148:151], v[36:39], v[228:231]
v_cvt_pk_bf16_f32 v104, v104, v105
M v[232:235], a[148:151], v[40:43], v[232:235]
v_exp_f32 v106, v106
M v[232:235], a[152:155], v[72:75], v[232:235]
M v[236:239], a[152:155], v[76:79], v[236:239]
v_exp_f32 v107, v107
M v[236:239], a[148:151], v[44:47], v[236:239]
v_cvt_pk_bf16_f32 v105, v106, v107
s_waitcnt lgkmcnt(4)
M v[240:243], a[156:159], v[32:35], v[240:243]
v_exp_f32 v120, v120
M v[240:243], a[160:163], v[64:67], v[240:243]
M v[244:247], a[160:163], v[68:71], v[244:247]
v_exp_f32 v121, v121
M v[244:247], a[156:159], v[36:39], v[244:247]
v_cvt_pk_bf16_f32 v106, v120, v121
M v[248:251], a[156:159], v[40:43], v[248:251]
v_exp_f32 v122, v122
M v[248:251], a[160:163], v[72:75], v[248:251]
s_waitcnt vmcnt(0) lgkmcnt(0)
s_barrier
ds_read_b128 a[116:119], v3 offset:0
ds_read_b128 a[120:123], v3 offset:1024
M v[252:255], a[160:163], v[76:79], v[252:255]
v_exp_f32 v123, v123
M v[252:255], a[156:159], v[44:47], v[252:255]
v_cvt_pk_bf16_f32 v107, v122, v123
M a[64:67], a[164:167], v[32:35], a[64:67]
v_exp_f32 v108, v108
M a[64:67], a[168:171], v[64:67], a[64:67]
ds_read_b128 a[124:127], v3 offset:2048
ds_read_b128 a[128:131], v3 offset:3072
M a[68:71], a[168:171], v[68:71], a[68:71]
v_exp_f32 v109, v109
M a[68:71], a[164:167], v[36:39], a[68:71]
v_cvt_pk_bf16_f32 v108, v108, v109
M a[72:75], a[164:167], v[40:43], a[72:75]
v_exp_f32 v110, v110
M a[72:75], a[168:171], v[72:75], a[72:75]
ds_read_b128 a[132:135], v3 offset:4096
ds_read_b128 a[136:139], v3 offset:5120
M a[76:79], a[168:171], v[76:79], a[76:79]
v_exp_f32 v111, v111
M a[76:79], a[164:167], v[44:47], a[76:79]
v_cvt_pk_bf16_f32 v109, v110, v111
M a[80:83], a[172:175], v[32:35], a[80:83]
v_exp_f32 v124, v124
M a[80:83], a[176:179], v[64:67], a[80:83]
ds_read_b128 a[140:143], v3 offset:6144
ds_read_b128 a[144:147], v3 offset:7168
M a[84:87], a[176:179], v[68:71], a[84:87]
v_exp_f32 v125, v125
M a[84:87], a[172:175], v[36:39], a[84:87]
v_cvt_pk_bf16_f32 v110, v124, v125
M a[88:91], a[172:175], v[40:43], a[88:91]
v_exp_f32 v126, v126
M a[88:91], a[176:179], v[72:75], a[88:91]
M a[92:95], a[176:179], v[76:79], a[92:95]
v_exp_f32 v127, v127
M a[92:95], a[172:175], v[44:47], a[92:95]
v_cvt_pk_bf16_f32 v111, v126, v127
s_waitcnt vmcnt(16)
s_add_u32 m0, s29, 0
s_waitcnt lgkmcnt(4)
M v[32:35], a[116:119], a[180:183], 0
v_exp_f32 v128, v128
M v[32:35], a[120:123], a[184:187], v[32:35]
ds_read_b128 a[148:151], v3 offset:8192
ds_read_b128 a[152:155], v3 offset:9216
M v[32:35], a[124:127], a[188:191], v[32:35]
v_exp_f32 v129, v129
M v[32:35], a[128:131], a[192:195], v[32:35]
buffer_load_dwordx4 v1, s[12:15], s25 offen offset:0 sc1 lds
s_add_u32 s32, s25, 4096
M v[36:39], a[128:131], a[208:211], 0
v_exp_f32 v130, v130
M v[36:39], a[124:127], a[204:207], v[36:39]
v_cvt_pk_bf16_f32 v128, v128, v129
M v[36:39], a[120:123], a[200:203], v[36:39]
v_exp_f32 v131, v131
M v[36:39], a[116:119], a[196:199], v[36:39]
buffer_load_dwordx4 v1, s[12:15], s25 offen offset:1024 sc1 lds
M v[40:43], a[116:119], a[212:215], 0
v_exp_f32 v144, v144
M v[40:43], a[120:123], a[216:219], v[40:43]
ds_read_b128 a[156:159], v3 offset:10240
ds_read_b128 a[160:163], v3 offset:11264
M v[40:43], a[124:127], a[220:223], v[40:43]
v_exp_f32 v145, v145
M v[40:43], a[128:131], a[224:227], v[40:43]
buffer_load_dwordx4 v1, s[12:15], s25 offen offset:2048 sc1 lds
M v[44:47], a[128:131], a[240:243], 0
v_exp_f32 v146, v146
M v[44:47], a[124:127], a[236:239], v[44:47]
v_cvt_pk_bf16_f32 v129, v130, v131
v_cvt_pk_bf16_f32 v130, v144, v145
M v[44:47], a[120:123], a[232:235], v[44:47]
v_exp_f32 v147, v147
M v[44:47], a[116:119], a[228:231], v[44:47]
buffer_load_dwordx4 v1, s[12:15], s25 offen offset:3072 sc1 lds
s_add_u32 m0, s29, 4096
s_waitcnt lgkmcnt(4)
M v[48:51], a[132:135], a[180:183], 0
v_exp_f32 v132, v132
M v[48:51], a[136:139], a[184:187], v[48:51]
ds_read_b128 a[164:167], v3 offset:12288
ds_read_b128 a[168:171], v3 offset:13312
M v[48:51], a[140:143], a[188:191], v[48:51]
v_exp_f32 v133, v133
M v[48:51], a[144:147], a[192:195], v[48:51]
buffer_load_dwordx4 v1, s[12:15], s32 offen offset:0 sc1 lds
M v[52:55], a[144:147], a[208:211], 0
v_exp_f32 v134, v134
M v[52:55], a[140:143], a[204:207], v[52:55]
v_cvt_pk_bf16_f32 v131, v146, v147
v_cvt_pk_bf16_f32 v132, v132, v133
M v[52:55], a[136:139], a[200:203], v[52:55]
v_exp_f32 v135, v135
M v[52:55], a[132:135], a[196:199], v[52:55]
buffer_load_dwordx4 v1, s[12:15], s32 offen offset:1024 sc1 lds
M v[56:59], a[132:135], a[212:215], 0
v_exp_f32 v148, v148
M v[56:59], a[136:139], a[216:219], v[56:59]
ds_read_b128 a[172:175], v3 offset:14336
ds_read_b128 a[176:179], v3 offset:15360
M v[56:59], a[140:143], a[220:223], v[56:59]
v_exp_f32 v149, v149
M v[56:59], a[144:147], a[224:227], v[56:59]
buffer_load_dwordx4 v1, s[12:15], s32 offen offset:2048 sc1 lds
M v[60:63], a[144:147], a[240:243], 0
v_exp_f32 v150, v150
M v[60:63], a[140:143], a[236:239], v[60:63]
v_cvt_pk_bf16_f32 v133, v134, v135
v_cvt_pk_bf16_f32 v134, v148, v149
M v[60:63], a[136:139], a[232:235], v[60:63]
v_exp_f32 v151, v151
M v[60:63], a[132:135], a[228:231], v[60:63]
buffer_load_dwordx4 v1, s[12:15], s32 offen offset:3072 sc1 lds
s_add_u32 m0, s29, 32768
s_waitcnt lgkmcnt(4)
M v[64:67], a[148:151], a[180:183], 0
v_exp_f32 v136, v136
M v[64:67], a[152:155], a[184:187], v[64:67]
ds_read_b128 a[116:119], v6 offset:32768
ds_read_b128 a[120:123], v6 offset:40960
M v[64:67], a[156:159], a[188:191], v[64:67]
v_exp_f32 v137, v137
M v[64:67], a[160:163], a[192:195], v[64:67]
buffer_load_dwordx4 v1, s[12:15], s26 offen offset:0 sc1 lds
s_add_u32 s43, s26, 4096
M v[68:71], a[160:163], a[208:211], 0
v_exp_f32 v138, v138
M v[68:71], a[156:159], a[204:207], v[68:71]
v_cvt_pk_bf16_f32 v135, v150, v151
v_cvt_pk_bf16_f32 v136, v136, v137
M v[68:71], a[152:155], a[200:203], v[68:71]
v_exp_f32 v139, v139
M v[68:71], a[148:151], a[196:199], v[68:71]
buffer_load_dwordx4 v1, s[12:15], s26 offen offset:1024 sc1 lds
M v[72:75], a[148:151], a[212:215], 0
v_exp_f32 v152, v152
M v[72:75], a[152:155], a[216:219], v[72:75]
ds_read_b128 a[124:127], v6 offset:33792
ds_read_b128 a[128:131], v6 offset:41984
M v[72:75], a[156:159], a[220:223], v[72:75]
v_exp_f32 v153, v153
M v[72:75], a[160:163], a[224:227], v[72:75]
buffer_load_dwordx4 v1, s[12:15], s26 offen offset:2048 sc1 lds
M v[76:79], a[160:163], a[240:243], 0
v_exp_f32 v154, v154
M v[76:79], a[156:159], a[236:239], v[76:79]
v_cvt_pk_bf16_f32 v137, v138, v139
v_cvt_pk_bf16_f32 v138, v152, v153
M v[76:79], a[152:155], a[232:235], v[76:79]
v_exp_f32 v155, v155
M v[76:79], a[148:151], a[228:231], v[76:79]
buffer_load_dwordx4 v1, s[12:15], s26 offen offset:3072 sc1 lds
s_add_u32 m0, s29, 36864
s_waitcnt lgkmcnt(4)
M v[80:83], a[164:167], a[180:183], 0
v_exp_f32 v140, v140
M v[80:83], a[168:171], a[184:187], v[80:83]
ds_read_b128 a[132:135], v6 offset:34816
ds_read_b128 a[136:139], v6 offset:43008
M v[80:83], a[172:175], a[188:191], v[80:83]
v_exp_f32 v141, v141
M v[80:83], a[176:179], a[192:195], v[80:83]
buffer_load_dwordx4 v1, s[12:15], s43 offen offset:0 sc1 lds
M v[84:87], a[176:179], a[208:211], 0
v_exp_f32 v142, v142
M v[84:87], a[172:175], a[204:207], v[84:87]
v_cvt_pk_bf16_f32 v139, v154, v155
v_cvt_pk_bf16_f32 v140, v140, v141
M v[84:87], a[168:171], a[200:203], v[84:87]
v_exp_f32 v143, v143
M v[84:87], a[164:167], a[196:199], v[84:87]
buffer_load_dwordx4 v1, s[12:15], s43 offen offset:1024 sc1 lds
M v[88:91], a[164:167], a[212:215], 0
v_exp_f32 v156, v156
M v[88:91], a[168:171], a[216:219], v[88:91]
ds_read_b128 a[140:143], v6 offset:35840
ds_read_b128 a[144:147], v6 offset:44032
M v[88:91], a[172:175], a[220:223], v[88:91]
v_exp_f32 v157, v157
M v[88:91], a[176:179], a[224:227], v[88:91]
buffer_load_dwordx4 v1, s[12:15], s43 offen offset:2048 sc1 lds
M v[92:95], a[176:179], a[240:243], 0
v_exp_f32 v158, v158
M v[92:95], a[172:175], a[236:239], v[92:95]
v_cvt_pk_bf16_f32 v141, v142, v143
v_cvt_pk_bf16_f32 v142, v156, v157
M v[92:95], a[168:171], a[232:235], v[92:95]
v_exp_f32 v159, v159
M v[92:95], a[164:167], a[228:231], v[92:95]
buffer_load_dwordx4 v1, s[12:15], s43 offen offset:3072 sc1 lds
v_cvt_pk_bf16_f32 v143, v158, v159
s_waitcnt lgkmcnt(6)
M v[160:163], a[116:119], v[96:99], v[160:163]
v_exp_f32 v32, v32
M v[160:163], a[120:123], v[128:131], v[160:163]
ds_read_b128 a[148:151], v6 offset:36864
ds_read_b128 a[152:155], v6 offset:45056
M v[164:167], a[120:123], v[132:135], v[164:167]
v_exp_f32 v33, v33
M v[164:167], a[116:119], v[100:103], v[164:167]
v_cvt_pk_bf16_f32 v32, v32, v33
M v[168:171], a[116:119], v[104:107], v[168:171]
v_exp_f32 v34, v34
M v[168:171], a[120:123], v[136:139], v[168:171]
s_add_u32 s25, s25, 32768
s_cmp_eq_u32 s25, s27
M v[172:175], a[120:123], v[140:143], v[172:175]
v_exp_f32 v35, v35
M v[172:175], a[116:119], v[108:111], v[172:175]
v_cvt_pk_bf16_f32 v33, v34, v35
s_waitcnt lgkmcnt(6)
M a[96:99], a[112:115], v[96:99], a[96:99]
s_cselect_b32 s25, s28, s25
s_cselect_b32 s27, -1, s27
M a[96:99], a[112:115], v[128:131], a[96:99]
s_add_u32 s26, s26, 32768
s_cmp_eq_u32 s26, s62
M v[176:179], a[124:127], v[96:99], v[176:179]
v_exp_f32 v48, v48
M v[176:179], a[128:131], v[128:131], v[176:179]
ds_read_b128 a[156:159], v6 offset:37888
ds_read_b128 a[160:163], v6 offset:46080
M v[180:183], a[128:131], v[132:135], v[180:183]
v_exp_f32 v49, v49
M v[180:183], a[124:127], v[100:103], v[180:183]
v_cvt_pk_bf16_f32 v34, v48, v49
M v[184:187], a[124:127], v[104:107], v[184:187]
v_exp_f32 v50, v50
M v[184:187], a[128:131], v[136:139], v[184:187]
s_cselect_b32 s26, s63, s26
s_cselect_b32 s62, -1, s62
M v[188:191], a[128:131], v[140:143], v[188:191]
v_exp_f32 v51, v51
M v[188:191], a[124:127], v[108:111], v[188:191]
v_cvt_pk_bf16_f32 v35, v50, v51
s_waitcnt lgkmcnt(6)
M a[100:103], a[112:115], v[100:103], a[100:103]
M a[100:103], a[112:115], v[132:135], a[100:103]
M v[192:195], a[132:135], v[96:99], v[192:195]
v_exp_f32 v36, v36
M v[192:195], a[136:139], v[128:131], v[192:195]
ds_read_b128 a[164:167], v6 offset:38912
ds_read_b128 a[168:171], v6 offset:47104
M v[196:199], a[136:139], v[132:135], v[196:199]
v_exp_f32 v37, v37
M v[196:199], a[132:135], v[100:103], v[196:199]
v_cvt_pk_bf16_f32 v36, v36, v37
M v[200:203], a[132:135], v[104:107], v[200:203]
v_exp_f32 v38, v38
M v[200:203], a[136:139], v[136:139], v[200:203]
M v[204:207], a[136:139], v[140:143], v[204:207]
v_exp_f32 v39, v39
M v[204:207], a[132:135], v[108:111], v[204:207]
v_cvt_pk_bf16_f32 v37, v38, v39
s_waitcnt lgkmcnt(6)
M a[104:107], a[112:115], v[104:107], a[104:107]
M a[104:107], a[112:115], v[136:139], a[104:107]
M v[208:211], a[140:143], v[96:99], v[208:211]
v_exp_f32 v52, v52
M v[208:211], a[144:147], v[128:131], v[208:211]
ds_read_b128 a[172:175], v6 offset:39936
ds_read_b128 a[176:179], v6 offset:48128
M v[212:215], a[144:147], v[132:135], v[212:215]
v_exp_f32 v53, v53
M v[212:215], a[140:143], v[100:103], v[212:215]
v_cvt_pk_bf16_f32 v38, v52, v53
M v[216:219], a[140:143], v[104:107], v[216:219]
v_exp_f32 v54, v54
M v[216:219], a[144:147], v[136:139], v[216:219]
M v[220:223], a[144:147], v[140:143], v[220:223]
v_exp_f32 v55, v55
M v[220:223], a[140:143], v[108:111], v[220:223]
v_cvt_pk_bf16_f32 v39, v54, v55
s_waitcnt lgkmcnt(6)
M a[108:111], a[112:115], v[108:111], a[108:111]
M a[108:111], a[112:115], v[140:143], a[108:111]
M v[224:227], a[148:151], v[96:99], v[224:227]
v_exp_f32 v40, v40
M v[224:227], a[152:155], v[128:131], v[224:227]
M v[228:231], a[152:155], v[132:135], v[228:231]
v_exp_f32 v41, v41
M v[228:231], a[148:151], v[100:103], v[228:231]
v_cvt_pk_bf16_f32 v40, v40, v41
M v[232:235], a[148:151], v[104:107], v[232:235]
v_exp_f32 v42, v42
M v[232:235], a[152:155], v[136:139], v[232:235]
M v[236:239], a[152:155], v[140:143], v[236:239]
v_exp_f32 v43, v43
M v[236:239], a[148:151], v[108:111], v[236:239]
v_cvt_pk_bf16_f32 v41, v42, v43
s_waitcnt lgkmcnt(4)
M v[240:243], a[156:159], v[96:99], v[240:243]
v_exp_f32 v56, v56
M v[240:243], a[160:163], v[128:131], v[240:243]
M v[244:247], a[160:163], v[132:135], v[244:247]
v_exp_f32 v57, v57
M v[244:247], a[156:159], v[100:103], v[244:247]
v_cvt_pk_bf16_f32 v42, v56, v57
M v[248:251], a[156:159], v[104:107], v[248:251]
v_exp_f32 v58, v58
M v[248:251], a[160:163], v[136:139], v[248:251]
s_waitcnt vmcnt(0) lgkmcnt(0)
s_barrier
ds_read_b128 a[116:119], v2 offset:0
ds_read_b128 a[120:123], v2 offset:1024
M v[252:255], a[160:163], v[140:143], v[252:255]
v_exp_f32 v59, v59
M v[252:255], a[156:159], v[108:111], v[252:255]
v_cvt_pk_bf16_f32 v43, v58, v59
M a[64:67], a[164:167], v[96:99], a[64:67]
v_exp_f32 v44, v44
M a[64:67], a[168:171], v[128:131], a[64:67]
ds_read_b128 a[124:127], v2 offset:2048
ds_read_b128 a[128:131], v2 offset:3072
M a[68:71], a[168:171], v[132:135], a[68:71]
v_exp_f32 v45, v45
M a[68:71], a[164:167], v[100:103], a[68:71]
v_cvt_pk_bf16_f32 v44, v44, v45
M a[72:75], a[164:167], v[104:107], a[72:75]
v_exp_f32 v46, v46
M a[72:75], a[168:171], v[136:139], a[72:75]
ds_read_b128 a[132:135], v2 offset:4096
ds_read_b128 a[136:139], v2 offset:5120
M a[76:79], a[168:171], v[140:143], a[76:79]
v_exp_f32 v47, v47
M a[76:79], a[164:167], v[108:111], a[76:79]
v_cvt_pk_bf16_f32 v45, v46, v47
M a[80:83], a[172:175], v[96:99], a[80:83]
v_exp_f32 v60, v60
M a[80:83], a[176:179], v[128:131], a[80:83]
ds_read_b128 a[140:143], v2 offset:6144
ds_read_b128 a[144:147], v2 offset:7168
M a[84:87], a[176:179], v[132:135], a[84:87]
v_exp_f32 v61, v61
M a[84:87], a[172:175], v[100:103], a[84:87]
v_cvt_pk_bf16_f32 v46, v60, v61
M a[88:91], a[172:175], v[104:107], a[88:91]
v_exp_f32 v62, v62
M a[88:91], a[176:179], v[136:139], a[88:91]
M a[92:95], a[176:179], v[140:143], a[92:95]
v_exp_f32 v63, v63
M a[92:95], a[172:175], v[108:111], a[92:95]
v_cvt_pk_bf16_f32 v47, v62, v63
v_accvgpr_read_b32 v20, a96
v_accvgpr_read_b32 v21, a100
v_accvgpr_read_b32 v22, a104
v_accvgpr_read_b32 v23, a108
v_rcp_f32 v8, v20
v_rcp_f32 v9, v21
v_rcp_f32 v10, v22
v_rcp_f32 v11, v23
v_subrev_u32 v20, 0x21800000, v20
v_subrev_u32 v21, 0x21800000, v21
v_subrev_u32 v22, 0x21800000, v22
v_subrev_u32 v23, 0x21800000, v23
v_max_u32 v12, v20, v21
v_max3_u32 v12, v12, v22, v23
s_mov_b32 s64, 0x207
s_lshl_b32 s33, s21, 20
s_lshl_b32 s34, s20, 15
s_add_u32 s33, s33, s34
s_lshl_b32 s34, s23, 13
s_add_u32 s36, s33, s34
s_add_u32 s37, s36, 4096
s_add_u32 s38, s36, 16384
s_add_u32 s39, s36, 20480
v_pk_mul_f32 v[160:161], v[160:161], v[8:9] op_sel:[0,0] op_sel_hi:[1,0]
v_pk_mul_f32 v[162:163], v[162:163], v[8:9] op_sel:[0,0] op_sel_hi:[1,0]
v_pk_mul_f32 v[176:177], v[176:177], v[8:9] op_sel:[0,0] op_sel_hi:[1,0]
v_pk_mul_f32 v[178:179], v[178:179], v[8:9] op_sel:[0,0] op_sel_hi:[1,0]
v_cvt_pk_bf16_f32 v160, v160, v161
v_cvt_pk_bf16_f32 v161, v162, v163
v_cvt_pk_bf16_f32 v162, v176, v177
v_cvt_pk_bf16_f32 v163, v178, v179
s_nop 1
M v[24:27], a[112:115], v[160:163], 0
buffer_store_dwordx4 v[160:163], v1, s[16:19], s36 offen offset:0 sc1
v_pk_mul_f32 v[164:165], v[164:165], v[8:9] op_sel:[0,1] op_sel_hi:[1,1]
v_pk_mul_f32 v[166:167], v[166:167], v[8:9] op_sel:[0,1] op_sel_hi:[1,1]
v_pk_mul_f32 v[180:181], v[180:181], v[8:9] op_sel:[0,1] op_sel_hi:[1,1]
v_pk_mul_f32 v[182:183], v[182:183], v[8:9] op_sel:[0,1] op_sel_hi:[1,1]
v_cvt_pk_bf16_f32 v164, v164, v165
v_cvt_pk_bf16_f32 v165, v166, v167
v_cvt_pk_bf16_f32 v166, v180, v181
v_cvt_pk_bf16_f32 v167, v182, v183
s_nop 1
M v[24:27], a[112:115], v[164:167], v[24:27]
buffer_store_dwordx4 v[164:167], v1, s[16:19], s36 offen offset:2048 sc1
v_pk_mul_f32 v[168:169], v[168:169], v[10:11] op_sel:[0,0] op_sel_hi:[1,0]
v_pk_mul_f32 v[170:171], v[170:171], v[10:11] op_sel:[0,0] op_sel_hi:[1,0]
v_pk_mul_f32 v[184:185], v[184:185], v[10:11] op_sel:[0,0] op_sel_hi:[1,0]
v_pk_mul_f32 v[186:187], v[186:187], v[10:11] op_sel:[0,0] op_sel_hi:[1,0]
v_cvt_pk_bf16_f32 v168, v168, v169
v_cvt_pk_bf16_f32 v169, v170, v171
v_cvt_pk_bf16_f32 v170, v184, v185
v_cvt_pk_bf16_f32 v171, v186, v187
s_nop 1
M v[24:27], a[112:115], v[168:171], v[24:27]
buffer_store_dwordx4 v[168:171], v1, s[16:19], s37 offen offset:0 sc1
v_pk_mul_f32 v[172:173], v[172:173], v[10:11] op_sel:[0,1] op_sel_hi:[1,1]
v_pk_mul_f32 v[174:175], v[174:175], v[10:11] op_sel:[0,1] op_sel_hi:[1,1]
v_pk_mul_f32 v[188:189], v[188:189], v[10:11] op_sel:[0,1] op_sel_hi:[1,1]
v_pk_mul_f32 v[190:191], v[190:191], v[10:11] op_sel:[0,1] op_sel_hi:[1,1]
v_cvt_pk_bf16_f32 v172, v172, v173
v_cvt_pk_bf16_f32 v173, v174, v175
v_cvt_pk_bf16_f32 v174, v188, v189
v_cvt_pk_bf16_f32 v175, v190, v191
s_nop 1
M v[24:27], a[112:115], v[172:175], v[24:27]
buffer_store_dwordx4 v[172:175], v1, s[16:19], s37 offen offset:2048 sc1
v_pk_mul_f32 v[192:193], v[192:193], v[8:9] op_sel:[0,0] op_sel_hi:[1,0]
v_pk_mul_f32 v[194:195], v[194:195], v[8:9] op_sel:[0,0] op_sel_hi:[1,0]
v_pk_mul_f32 v[208:209], v[208:209], v[8:9] op_sel:[0,0] op_sel_hi:[1,0]
v_pk_mul_f32 v[210:211], v[210:211], v[8:9] op_sel:[0,0] op_sel_hi:[1,0]
v_cvt_pk_bf16_f32 v192, v192, v193
v_cvt_pk_bf16_f32 v193, v194, v195
v_cvt_pk_bf16_f32 v194, v208, v209
v_cvt_pk_bf16_f32 v195, v210, v211
s_nop 1
M v[24:27], a[112:115], v[192:195], v[24:27]
buffer_store_dwordx4 v[192:195], v1, s[16:19], s36 offen offset:1024 sc1
v_pk_mul_f32 v[196:197], v[196:197], v[8:9] op_sel:[0,1] op_sel_hi:[1,1]
v_pk_mul_f32 v[198:199], v[198:199], v[8:9] op_sel:[0,1] op_sel_hi:[1,1]
v_pk_mul_f32 v[212:213], v[212:213], v[8:9] op_sel:[0,1] op_sel_hi:[1,1]
v_pk_mul_f32 v[214:215], v[214:215], v[8:9] op_sel:[0,1] op_sel_hi:[1,1]
v_cvt_pk_bf16_f32 v196, v196, v197
v_cvt_pk_bf16_f32 v197, v198, v199
v_cvt_pk_bf16_f32 v198, v212, v213
v_cvt_pk_bf16_f32 v199, v214, v215
s_nop 1
M v[24:27], a[112:115], v[196:199], v[24:27]
buffer_store_dwordx4 v[196:199], v1, s[16:19], s36 offen offset:3072 sc1
v_pk_mul_f32 v[200:201], v[200:201], v[10:11] op_sel:[0,0] op_sel_hi:[1,0]
v_pk_mul_f32 v[202:203], v[202:203], v[10:11] op_sel:[0,0] op_sel_hi:[1,0]
v_pk_mul_f32 v[216:217], v[216:217], v[10:11] op_sel:[0,0] op_sel_hi:[1,0]
v_pk_mul_f32 v[218:219], v[218:219], v[10:11] op_sel:[0,0] op_sel_hi:[1,0]
v_cvt_pk_bf16_f32 v200, v200, v201
v_cvt_pk_bf16_f32 v201, v202, v203
v_cvt_pk_bf16_f32 v202, v216, v217
v_cvt_pk_bf16_f32 v203, v218, v219
s_nop 1
M v[24:27], a[112:115], v[200:203], v[24:27]
buffer_store_dwordx4 v[200:203], v1, s[16:19], s37 offen offset:1024 sc1
v_pk_mul_f32 v[204:205], v[204:205], v[10:11] op_sel:[0,1] op_sel_hi:[1,1]
v_pk_mul_f32 v[206:207], v[206:207], v[10:11] op_sel:[0,1] op_sel_hi:[1,1]
v_pk_mul_f32 v[220:221], v[220:221], v[10:11] op_sel:[0,1] op_sel_hi:[1,1]
v_pk_mul_f32 v[222:223], v[222:223], v[10:11] op_sel:[0,1] op_sel_hi:[1,1]
v_cvt_pk_bf16_f32 v204, v204, v205
v_cvt_pk_bf16_f32 v205, v206, v207
v_cvt_pk_bf16_f32 v206, v220, v221
v_cvt_pk_bf16_f32 v207, v222, v223
s_nop 1
M v[24:27], a[112:115], v[204:207], v[24:27]
buffer_store_dwordx4 v[204:207], v1, s[16:19], s37 offen offset:3072 sc1
v_pk_mul_f32 v[224:225], v[224:225], v[8:9] op_sel:[0,0] op_sel_hi:[1,0]
v_pk_mul_f32 v[226:227], v[226:227], v[8:9] op_sel:[0,0] op_sel_hi:[1,0]
v_pk_mul_f32 v[240:241], v[240:241], v[8:9] op_sel:[0,0] op_sel_hi:[1,0]
v_pk_mul_f32 v[242:243], v[242:243], v[8:9] op_sel:[0,0] op_sel_hi:[1,0]
v_cvt_pk_bf16_f32 v224, v224, v225
v_cvt_pk_bf16_f32 v225, v226, v227
v_cvt_pk_bf16_f32 v226, v240, v241
v_cvt_pk_bf16_f32 v227, v242, v243
s_nop 1
M v[24:27], a[112:115], v[224:227], v[24:27]
buffer_store_dwordx4 v[224:227], v1, s[16:19], s38 offen offset:0 sc1
v_pk_mul_f32 v[228:229], v[228:229], v[8:9] op_sel:[0,1] op_sel_hi:[1,1]
v_pk_mul_f32 v[230:231], v[230:231], v[8:9] op_sel:[0,1] op_sel_hi:[1,1]
v_pk_mul_f32 v[244:245], v[244:245], v[8:9] op_sel:[0,1] op_sel_hi:[1,1]
v_pk_mul_f32 v[246:247], v[246:247], v[8:9] op_sel:[0,1] op_sel_hi:[1,1]
v_cvt_pk_bf16_f32 v228, v228, v229
v_cvt_pk_bf16_f32 v229, v230, v231
v_cvt_pk_bf16_f32 v230, v244, v245
v_cvt_pk_bf16_f32 v231, v246, v247
s_nop 1
M v[24:27], a[112:115], v[228:231], v[24:27]
buffer_store_dwordx4 v[228:231], v1, s[16:19], s38 offen offset:2048 sc1
v_pk_mul_f32 v[232:233], v[232:233], v[10:11] op_sel:[0,0] op_sel_hi:[1,0]
v_pk_mul_f32 v[234:235], v[234:235], v[10:11] op_sel:[0,0] op_sel_hi:[1,0]
v_pk_mul_f32 v[248:249], v[248:249], v[10:11] op_sel:[0,0] op_sel_hi:[1,0]
v_pk_mul_f32 v[250:251], v[250:251], v[10:11] op_sel:[0,0] op_sel_hi:[1,0]
v_cvt_pk_bf16_f32 v232, v232, v233
v_cvt_pk_bf16_f32 v233, v234, v235
v_cvt_pk_bf16_f32 v234, v248, v249
v_cvt_pk_bf16_f32 v235, v250, v251
s_nop 1
M v[24:27], a[112:115], v[232:235], v[24:27]
buffer_store_dwordx4 v[232:235], v1, s[16:19], s39 offen offset:0 sc1
v_pk_mul_f32 v[236:237], v[236:237], v[10:11] op_sel:[0,1] op_sel_hi:[1,1]
v_pk_mul_f32 v[238:239], v[238:239], v[10:11] op_sel:[0,1] op_sel_hi:[1,1]
v_pk_mul_f32 v[252:253], v[252:253], v[10:11] op_sel:[0,1] op_sel_hi:[1,1]
v_pk_mul_f32 v[254:255], v[254:255], v[10:11] op_sel:[0,1] op_sel_hi:[1,1]
v_cvt_pk_bf16_f32 v236, v236, v237
v_cvt_pk_bf16_f32 v237, v238, v239
v_cvt_pk_bf16_f32 v238, v252, v253
v_cvt_pk_bf16_f32 v239, v254, v255
v_accvgpr_read_b32 v176, a64
v_accvgpr_read_b32 v177, a65
v_accvgpr_read_b32 v178, a66
v_accvgpr_read_b32 v179, a67
v_accvgpr_read_b32 v180, a80
v_accvgpr_read_b32 v181, a81
v_accvgpr_read_b32 v182, a82
v_accvgpr_read_b32 v183, a83
M v[24:27], a[112:115], v[236:239], v[24:27]
buffer_store_dwordx4 v[236:239], v1, s[16:19], s39 offen offset:2048 sc1
v_pk_mul_f32 v[176:177], v[176:177], v[8:9] op_sel:[0,0] op_sel_hi:[1,0]
v_pk_mul_f32 v[178:179], v[178:179], v[8:9] op_sel:[0,0] op_sel_hi:[1,0]
v_pk_mul_f32 v[180:181], v[180:181], v[8:9] op_sel:[0,0] op_sel_hi:[1,0]
v_pk_mul_f32 v[182:183], v[182:183], v[8:9] op_sel:[0,0] op_sel_hi:[1,0]
v_cvt_pk_bf16_f32 v176, v176, v177
v_cvt_pk_bf16_f32 v177, v178, v179
v_cvt_pk_bf16_f32 v178, v180, v181
v_cvt_pk_bf16_f32 v179, v182, v183
v_accvgpr_read_b32 v184, a68
v_accvgpr_read_b32 v185, a69
v_accvgpr_read_b32 v186, a70
v_accvgpr_read_b32 v187, a71
v_accvgpr_read_b32 v188, a84
v_accvgpr_read_b32 v189, a85
v_accvgpr_read_b32 v190, a86
v_accvgpr_read_b32 v191, a87
M v[24:27], a[112:115], v[176:179], v[24:27]
buffer_store_dwordx4 v[176:179], v1, s[16:19], s38 offen offset:1024 sc1
v_pk_mul_f32 v[184:185], v[184:185], v[8:9] op_sel:[0,1] op_sel_hi:[1,1]
v_pk_mul_f32 v[186:187], v[186:187], v[8:9] op_sel:[0,1] op_sel_hi:[1,1]
v_pk_mul_f32 v[188:189], v[188:189], v[8:9] op_sel:[0,1] op_sel_hi:[1,1]
v_pk_mul_f32 v[190:191], v[190:191], v[8:9] op_sel:[0,1] op_sel_hi:[1,1]
v_cvt_pk_bf16_f32 v184, v184, v185
v_cvt_pk_bf16_f32 v185, v186, v187
v_cvt_pk_bf16_f32 v186, v188, v189
v_cvt_pk_bf16_f32 v187, v190, v191
v_accvgpr_read_b32 v208, a72
v_accvgpr_read_b32 v209, a73
v_accvgpr_read_b32 v210, a74
v_accvgpr_read_b32 v211, a75
v_accvgpr_read_b32 v212, a88
v_accvgpr_read_b32 v213, a89
v_accvgpr_read_b32 v214, a90
v_accvgpr_read_b32 v215, a91
M v[24:27], a[112:115], v[184:187], v[24:27]
buffer_store_dwordx4 v[184:187], v1, s[16:19], s38 offen offset:3072 sc1
v_pk_mul_f32 v[208:209], v[208:209], v[10:11] op_sel:[0,0] op_sel_hi:[1,0]
v_pk_mul_f32 v[210:211], v[210:211], v[10:11] op_sel:[0,0] op_sel_hi:[1,0]
v_pk_mul_f32 v[212:213], v[212:213], v[10:11] op_sel:[0,0] op_sel_hi:[1,0]
v_pk_mul_f32 v[214:215], v[214:215], v[10:11] op_sel:[0,0] op_sel_hi:[1,0]
v_cvt_pk_bf16_f32 v208, v208, v209
v_cvt_pk_bf16_f32 v209, v210, v211
v_cvt_pk_bf16_f32 v210, v212, v213
v_cvt_pk_bf16_f32 v211, v214, v215
v_accvgpr_read_b32 v216, a76
v_accvgpr_read_b32 v217, a77
v_accvgpr_read_b32 v218, a78
v_accvgpr_read_b32 v219, a79
v_accvgpr_read_b32 v220, a92
v_accvgpr_read_b32 v221, a93
v_accvgpr_read_b32 v222, a94
v_accvgpr_read_b32 v223, a95
M v[24:27], a[112:115], v[208:211], v[24:27]
buffer_store_dwordx4 v[208:211], v1, s[16:19], s39 offen offset:1024 sc1
v_pk_mul_f32 v[216:217], v[216:217], v[10:11] op_sel:[0,1] op_sel_hi:[1,1]
v_pk_mul_f32 v[218:219], v[218:219], v[10:11] op_sel:[0,1] op_sel_hi:[1,1]
v_pk_mul_f32 v[220:221], v[220:221], v[10:11] op_sel:[0,1] op_sel_hi:[1,1]
v_pk_mul_f32 v[222:223], v[222:223], v[10:11] op_sel:[0,1] op_sel_hi:[1,1]
v_cvt_pk_bf16_f32 v216, v216, v217
v_cvt_pk_bf16_f32 v217, v218, v219
v_cvt_pk_bf16_f32 v218, v220, v221
v_cvt_pk_bf16_f32 v219, v222, v223
s_nop 1
M v[24:27], a[112:115], v[216:219], v[24:27]
buffer_store_dwordx4 v[216:219], v1, s[16:19], s39 offen offset:3072 sc1
v_cmp_lt_u32 vcc, 0x3c000000, v12
s_nop 5
v_cmp_class_f32 s[40:41], v24, s64
s_nop 0
s_or_b64 vcc, vcc, s[40:41]
s_cmp_lg_u64 vcc, 0
s_cselect_b32 s33, 1, 0
s_or_b32 s60, s60, s33
s_sub_u32 s30, 7, s21
s_cmp_lg_u32 s30, 0
s_cbranch_scc1 Lk2_b0
s_and_b32 s3, s2, 3
s_lshl_b32 s3, s3, 2
s_bfe_u32 s27, s2, 0x20003
s_add_u32 s27, s3, s27
s_lshl_b32 s43, s27, 8
s_add_u32 s43, s43, 8400896
v_lshlrev_b32 v15, 2, v0
buffer_load_dword v7, v15, s[52:55], s43 offen sc1
s_waitcnt lgkmcnt(7)
ds_read_b128 a[116:119], v5 offset:36864
s_waitcnt lgkmcnt(7)
ds_read_b128 a[120:123], v5 offset:45056
s_waitcnt lgkmcnt(7)
ds_read_b128 a[124:127], v5 offset:37888
s_waitcnt lgkmcnt(7)
ds_read_b128 a[128:131], v5 offset:46080
s_waitcnt lgkmcnt(7)
ds_read_b128 a[132:135], v5 offset:38912
s_waitcnt lgkmcnt(7)
ds_read_b128 a[136:139], v5 offset:47104
s_waitcnt lgkmcnt(7)
ds_read_b128 a[140:143], v5 offset:39936
s_waitcnt lgkmcnt(7)
ds_read_b128 a[144:147], v5 offset:48128
s_lshl_b32 s33, s23, 14
s_add_u32 s34, s33, 98304
s_add_u32 s33, s33, 131072
v_add_u32 v2, s34, v1
v_add_u32 v3, s33, v1
v_exp_f32 v64, v64
v_exp_f32 v65, v65
v_exp_f32 v66, v66
v_exp_f32 v67, v67
v_exp_f32 v80, v80
v_exp_f32 v81, v81
v_exp_f32 v82, v82
v_exp_f32 v83, v83
v_cvt_pk_bf16_f32 v64, v64, v65
v_cvt_pk_bf16_f32 v65, v66, v67
v_exp_f32 v68, v68
v_exp_f32 v69, v69
v_exp_f32 v70, v70
v_exp_f32 v71, v71
v_cvt_pk_bf16_f32 v66, v80, v81
v_cvt_pk_bf16_f32 v67, v82, v83
v_exp_f32 v84, v84
v_exp_f32 v85, v85
v_exp_f32 v86, v86
v_exp_f32 v87, v87
v_cvt_pk_bf16_f32 v68, v68, v69
v_cvt_pk_bf16_f32 v69, v70, v71
v_exp_f32 v72, v72
v_exp_f32 v73, v73
v_exp_f32 v74, v74
v_exp_f32 v75, v75
v_cvt_pk_bf16_f32 v70, v84, v85
v_cvt_pk_bf16_f32 v71, v86, v87
v_exp_f32 v88, v88
v_exp_f32 v89, v89
v_exp_f32 v90, v90
v_exp_f32 v91, v91
v_cvt_pk_bf16_f32 v72, v72, v73
v_cvt_pk_bf16_f32 v73, v74, v75
v_exp_f32 v76, v76
v_exp_f32 v77, v77
v_exp_f32 v78, v78
v_exp_f32 v79, v79
v_cvt_pk_bf16_f32 v74, v88, v89
v_cvt_pk_bf16_f32 v75, v90, v91
v_exp_f32 v92, v92
v_exp_f32 v93, v93
v_exp_f32 v94, v94
v_exp_f32 v95, v95
v_cvt_pk_bf16_f32 v76, v76, v77
v_cvt_pk_bf16_f32 v77, v78, v79
v_cvt_pk_bf16_f32 v78, v92, v93
v_cvt_pk_bf16_f32 v79, v94, v95
s_waitcnt lgkmcnt(6)
M v[224:227], a[116:119], v[32:35], 0
M v[224:227], a[120:123], v[64:67], v[224:227]
ds_read_b128 a[148:151], v5 offset:32768
ds_read_b128 a[152:155], v5 offset:40960
s_mov_b32 s61, 0
M v[228:231], a[120:123], v[68:71], 0
M v[228:231], a[116:119], v[36:39], v[228:231]
s_bfe_u32 s3, s2, 0x10002
M v[232:235], a[116:119], v[40:43], 0
M v[232:235], a[120:123], v[72:75], v[232:235]
s_lshl_b32 s3, s3, 3
M v[236:239], a[120:123], v[76:79], 0
M v[236:239], a[116:119], v[44:47], v[236:239]
s_waitcnt lgkmcnt(6)
s_lshr_b32 s28, s2, 5
M a[96:99], a[112:115], v[32:35], 0
M a[96:99], a[112:115], v[64:67], a[96:99]
M v[240:243], a[124:127], v[32:35], 0
M v[240:243], a[128:131], v[64:67], v[240:243]
ds_read_b128 a[156:159], v5 offset:33792
ds_read_b128 a[160:163], v5 offset:41984
s_add_u32 s28, s3, s28
M v[244:247], a[128:131], v[68:71], 0
s_lshl_b32 s25, s27, 18
M v[244:247], a[124:127], v[36:39], v[244:247]
M v[248:251], a[124:127], v[40:43], 0
s_lshl_b32 s3, s101, 12
M v[248:251], a[128:131], v[72:75], v[248:251]
M v[252:255], a[128:131], v[76:79], 0
s_add_u32 s25, s25, s3
M v[252:255], a[124:127], v[44:47], v[252:255]
s_waitcnt lgkmcnt(6)
M a[100:103], a[112:115], v[36:39], 0
M a[100:103], a[112:115], v[68:71], a[100:103]
M a[64:67], a[132:135], v[32:35], 0
s_lshl_b32 s26, s28, 7
M a[64:67], a[136:139], v[64:67], a[64:67]
ds_read_b128 a[164:167], v5 offset:34816
ds_read_b128 a[168:171], v5 offset:43008
M a[68:71], a[136:139], v[68:71], 0
s_lshl_b32 s42, s101, 11
M a[68:71], a[132:135], v[36:39], a[68:71]
M a[72:75], a[132:135], v[40:43], 0
s_add_u32 s44, s4, 83886080
s_addc_u32 s45, s5, 0
M a[72:75], a[136:139], v[72:75], a[72:75]
s_mov_b32 s46, 4194304
M a[76:79], a[136:139], v[76:79], 0
M a[76:79], a[132:135], v[44:47], a[76:79]
s_waitcnt lgkmcnt(6)
s_mov_b32 s47, 0x00020000
M a[104:107], a[112:115], v[40:43], 0
M a[104:107], a[112:115], v[72:75], a[104:107]
M a[80:83], a[140:143], v[32:35], 0
M a[80:83], a[144:147], v[64:67], a[80:83]
ds_read_b128 a[172:175], v5 offset:35840
ds_read_b128 a[176:179], v5 offset:44032
s_mov_b32 s50, 2097152
M a[84:87], a[144:147], v[68:71], 0
M a[84:87], a[140:143], v[36:39], a[84:87]
s_mov_b32 s51, 0x00020000
M a[88:91], a[140:143], v[40:43], 0
M a[88:91], a[144:147], v[72:75], a[88:91]
s_lshl_b32 s3, s101, 4
M a[92:95], a[144:147], v[76:79], 0
M a[92:95], a[140:143], v[44:47], a[92:95]
s_waitcnt lgkmcnt(6)
v_lshrrev_b32 v96, 3, v0
M a[108:111], a[112:115], v[44:47], 0
M a[108:111], a[112:115], v[76:79], a[108:111]
M v[160:163], a[148:151], v[32:35], 0
v_and_b32 v97, 6, v96
M v[160:163], a[152:155], v[64:67], v[160:163]
M v[164:167], a[152:155], v[68:71], 0
ds_write_b128 v2, v[224:227] offset:0
v_and_b32 v98, 7, v0
M v[164:167], a[148:151], v[36:39], v[164:167]
M v[168:171], a[148:151], v[40:43], 0
ds_write_b128 v2, v[228:231] offset:1024
v_xor_b32 v97, v97, v98
M v[168:171], a[152:155], v[72:75], v[168:171]
M v[172:175], a[152:155], v[76:79], 0
ds_write_b128 v2, v[232:235] offset:2048
v_add_u32 v96, s3, v96
M v[172:175], a[148:151], v[44:47], v[172:175]
s_waitcnt lgkmcnt(7)
M v[176:179], a[156:159], v[32:35], 0
ds_write_b128 v2, v[236:239] offset:3072
v_lshlrev_b32 v96, 11, v96
M v[176:179], a[160:163], v[64:67], v[176:179]
M v[180:183], a[160:163], v[68:71], 0
ds_write_b128 v2, v[240:243] offset:4096
v_lshl_add_u32 v99, v97, 4, v96
M v[180:183], a[156:159], v[36:39], v[180:183]
v_add_u32 v100, 15360, v99
M v[184:187], a[156:159], v[40:43], 0
ds_write_b128 v2, v[244:247] offset:5120
M v[184:187], a[160:163], v[72:75], v[184:187]
s_waitcnt vmcnt(0) lgkmcnt(0)
s_barrier
v_cmp_ne_u32 vcc, 1, v7
s_nop 0
s_cbranch_vccnz Lk3_spinb0
Lk3_gotb0:
M v[188:191], a[160:163], v[76:79], 0
ds_write_b128 v2, v[248:251] offset:6144
s_add_u32 m0, s42, 16384
s_nop 0
buffer_load_dwordx4 v99, s[48:51], s26 offen offset:0 lds
buffer_load_dwordx4 v100, s[48:51], s26 offen offset:1024 lds
M v[188:191], a[156:159], v[44:47], v[188:191]
buffer_load_dwordx4 a[192:195], v1, s[44:47], s25 offen offset:0 sc1
buffer_load_dwordx4 a[196:199], v1, s[44:47], s25 offen offset:1024 sc1
M v[192:195], a[164:167], v[32:35], 0
ds_write_b128 v2, v[252:255] offset:7168
buffer_load_dwordx4 a[200:203], v1, s[44:47], s25 offen offset:2048 sc1
buffer_load_dwordx4 a[204:207], v1, s[44:47], s25 offen offset:3072 sc1
M v[192:195], a[168:171], v[64:67], v[192:195]
s_add_u32 s25, s25, 16384
s_add_u32 s26, s26, 131072
s_add_u32 m0, s42, 32768
s_nop 0
buffer_load_dwordx4 v99, s[48:51], s26 offen offset:0 lds
M v[196:199], a[168:171], v[68:71], 0
ds_write_b128 v2, a[64:67] offset:8192
buffer_load_dwordx4 v100, s[48:51], s26 offen offset:1024 lds
buffer_load_dwordx4 a[208:211], v1, s[44:47], s25 offen offset:0 sc1
M v[196:199], a[164:167], v[36:39], v[196:199]
buffer_load_dwordx4 a[212:215], v1, s[44:47], s25 offen offset:1024 sc1
buffer_load_dwordx4 a[216:219], v1, s[44:47], s25 offen offset:2048 sc1
M v[200:203], a[164:167], v[40:43], 0
ds_write_b128 v2, a[68:71] offset:9216
buffer_load_dwordx4 a[220:223], v1, s[44:47], s25 offen offset:3072 sc1
s_add_u32 s25, s25, 16384
s_add_u32 s26, s26, 131072
M v[200:203], a[168:171], v[72:75], v[200:203]
s_add_u32 m0, s42, 49152
s_nop 0
buffer_load_dwordx4 v99, s[48:51], s26 offen offset:0 lds
buffer_load_dwordx4 v100, s[48:51], s26 offen offset:1024 lds
M v[204:207], a[168:171], v[76:79], 0
ds_write_b128 v2, a[72:75] offset:10240
buffer_load_dwordx4 a[224:227], v1, s[44:47], s25 offen offset:0 sc1
M v[204:207], a[164:167], v[44:47], v[204:207]
buffer_load_dwordx4 a[228:231], v1, s[44:47], s25 offen offset:1024 sc1
buffer_load_dwordx4 a[232:235], v1, s[44:47], s25 offen offset:2048 sc1
M v[208:211], a[172:175], v[32:35], 0
ds_write_b128 v2, a[76:79] offset:11264
buffer_load_dwordx4 a[236:239], v1, s[44:47], s25 offen offset:3072 sc1
s_add_u32 s25, s25, 16384
s_add_u32 s26, s26, 131072
M v[208:211], a[176:179], v[64:67], v[208:211]
s_add_u32 m0, s42, 65536
s_nop 0
buffer_load_dwordx4 v99, s[48:51], s26 offen offset:0 lds
buffer_load_dwordx4 v100, s[48:51], s26 offen offset:1024 lds
M v[212:215], a[176:179], v[68:71], 0
ds_write_b128 v2, a[80:83] offset:12288
buffer_load_dwordx4 a[240:243], v1, s[44:47], s25 offen offset:0 sc1
buffer_load_dwordx4 a[244:247], v1, s[44:47], s25 offen offset:1024 sc1
M v[212:215], a[172:175], v[36:39], v[212:215]
buffer_load_dwordx4 a[248:251], v1, s[44:47], s25 offen offset:2048 sc1
buffer_load_dwordx4 a[252:255], v1, s[44:47], s25 offen offset:3072 sc1
M v[216:219], a[172:175], v[40:43], 0
ds_write_b128 v2, a[84:87] offset:13312
s_add_u32 s25, s25, 16384
s_add_u32 s26, s26, 131072
s_add_u32 m0, s42, 81920
s_nop 0
buffer_load_dwordx4 v99, s[48:51], s26 offen offset:0 lds
M v[216:219], a[176:179], v[72:75], v[216:219]
buffer_load_dwordx4 v100, s[48:51], s26 offen offset:1024 lds
buffer_load_dwordx4 a[128:131], v1, s[44:47], s25 offen offset:0 sc1
M v[220:223], a[176:179], v[76:79], 0
ds_write_b128 v2, a[88:91] offset:14336
buffer_load_dwordx4 a[132:135], v1, s[44:47], s25 offen offset:1024 sc1
buffer_load_dwordx4 a[136:139], v1, s[44:47], s25 offen offset:2048 sc1
M v[220:223], a[172:175], v[44:47], v[220:223]
buffer_load_dwordx4 a[140:143], v1, s[44:47], s25 offen offset:3072 sc1
s_add_u32 s25, s25, 16384
s_add_u32 s26, s26, 131072
ds_write_b128 v2, a[92:95] offset:15360
s_waitcnt lgkmcnt(0)
s_branch Lk2_merge
Lk2_b0:
s_add_u32 m0, s29, 65536
s_waitcnt lgkmcnt(4)
M v[96:99], a[116:119], a[180:183], 0
v_exp_f32 v64, v64
M v[96:99], a[120:123], a[184:187], v[96:99]
ds_read_b128 a[148:151], v2 offset:8192
ds_read_b128 a[152:155], v2 offset:9216
M v[96:99], a[124:127], a[188:191], v[96:99]
v_exp_f32 v65, v65
M v[96:99], a[128:131], a[192:195], v[96:99]
buffer_load_dwordx4 v1, s[12:15], s25 offen offset:0 sc1 lds
s_add_u32 s32, s25, 4096
M v[100:103], a[128:131], a[208:211], 0
v_exp_f32 v66, v66
M v[100:103], a[124:127], a[204:207], v[100:103]
v_cvt_pk_bf16_f32 v64, v64, v65
M v[100:103], a[120:123], a[200:203], v[100:103]
v_exp_f32 v67, v67
M v[100:103], a[116:119], a[196:199], v[100:103]
buffer_load_dwordx4 v1, s[12:15], s25 offen offset:1024 sc1 lds
M v[104:107], a[116:119], a[212:215], 0
v_exp_f32 v80, v80
M v[104:107], a[120:123], a[216:219], v[104:107]
ds_read_b128 a[156:159], v2 offset:10240
ds_read_b128 a[160:163], v2 offset:11264
M v[104:107], a[124:127], a[220:223], v[104:107]
v_exp_f32 v81, v81
M v[104:107], a[128:131], a[224:227], v[104:107]
buffer_load_dwordx4 v1, s[12:15], s25 offen offset:2048 sc1 lds
M v[108:111], a[128:131], a[240:243], 0
v_exp_f32 v82, v82
M v[108:111], a[124:127], a[236:239], v[108:111]
v_cvt_pk_bf16_f32 v65, v66, v67
v_cvt_pk_bf16_f32 v66, v80, v81
M v[108:111], a[120:123], a[232:235], v[108:111]
v_exp_f32 v83, v83
M v[108:111], a[116:119], a[228:231], v[108:111]
buffer_load_dwordx4 v1, s[12:15], s25 offen offset:3072 sc1 lds
s_add_u32 m0, s29, 69632
s_waitcnt lgkmcnt(4)
M v[112:115], a[132:135], a[180:183], 0
v_exp_f32 v68, v68
M v[112:115], a[136:139], a[184:187], v[112:115]
ds_read_b128 a[164:167], v2 offset:12288
ds_read_b128 a[168:171], v2 offset:13312
M v[112:115], a[140:143], a[188:191], v[112:115]
v_exp_f32 v69, v69
M v[112:115], a[144:147], a[192:195], v[112:115]
buffer_load_dwordx4 v1, s[12:15], s32 offen offset:0 sc1 lds
M v[116:119], a[144:147], a[208:211], 0
v_exp_f32 v70, v70
M v[116:119], a[140:143], a[204:207], v[116:119]
v_cvt_pk_bf16_f32 v67, v82, v83
v_cvt_pk_bf16_f32 v68, v68, v69
M v[116:119], a[136:139], a[200:203], v[116:119]
v_exp_f32 v71, v71
M v[116:119], a[132:135], a[196:199], v[116:119]
buffer_load_dwordx4 v1, s[12:15], s32 offen offset:1024 sc1 lds
M v[120:123], a[132:135], a[212:215], 0
v_exp_f32 v84, v84
M v[120:123], a[136:139], a[216:219], v[120:123]
ds_read_b128 a[172:175], v2 offset:14336
ds_read_b128 a[176:179], v2 offset:15360
M v[120:123], a[140:143], a[220:223], v[120:123]
v_exp_f32 v85, v85
M v[120:123], a[144:147], a[224:227], v[120:123]
buffer_load_dwordx4 v1, s[12:15], s32 offen offset:2048 sc1 lds
M v[124:127], a[144:147], a[240:243], 0
v_exp_f32 v86, v86
M v[124:127], a[140:143], a[236:239], v[124:127]
v_cvt_pk_bf16_f32 v69, v70, v71
v_cvt_pk_bf16_f32 v70, v84, v85
M v[124:127], a[136:139], a[232:235], v[124:127]
v_exp_f32 v87, v87
M v[124:127], a[132:135], a[228:231], v[124:127]
buffer_load_dwordx4 v1, s[12:15], s32 offen offset:3072 sc1 lds
s_add_u32 m0, s29, 98304
s_waitcnt lgkmcnt(4)
M v[128:131], a[148:151], a[180:183], 0
v_exp_f32 v72, v72
M v[128:131], a[152:155], a[184:187], v[128:131]
ds_read_b128 a[116:119], v5 offset:32768
ds_read_b128 a[120:123], v5 offset:40960
M v[128:131], a[156:159], a[188:191], v[128:131]
v_exp_f32 v73, v73
M v[128:131], a[160:163], a[192:195], v[128:131]
buffer_load_dwordx4 v1, s[12:15], s26 offen offset:0 sc1 lds
s_add_u32 s43, s26, 4096
M v[132:135], a[160:163], a[208:211], 0
v_exp_f32 v74, v74
M v[132:135], a[156:159], a[204:207], v[132:135]
v_cvt_pk_bf16_f32 v71, v86, v87
v_cvt_pk_bf16_f32 v72, v72, v73
M v[132:135], a[152:155], a[200:203], v[132:135]
v_exp_f32 v75, v75
M v[132:135], a[148:151], a[196:199], v[132:135]
buffer_load_dwordx4 v1, s[12:15], s26 offen offset:1024 sc1 lds
M v[136:139], a[148:151], a[212:215], 0
v_exp_f32 v88, v88
M v[136:139], a[152:155], a[216:219], v[136:139]
ds_read_b128 a[124:127], v5 offset:33792
ds_read_b128 a[128:131], v5 offset:41984
M v[136:139], a[156:159], a[220:223], v[136:139]
v_exp_f32 v89, v89
M v[136:139], a[160:163], a[224:227], v[136:139]
buffer_load_dwordx4 v1, s[12:15], s26 offen offset:2048 sc1 lds
M v[140:143], a[160:163], a[240:243], 0
v_exp_f32 v90, v90
M v[140:143], a[156:159], a[236:239], v[140:143]
v_cvt_pk_bf16_f32 v73, v74, v75
v_cvt_pk_bf16_f32 v74, v88, v89
M v[140:143], a[152:155], a[232:235], v[140:143]
v_exp_f32 v91, v91
M v[140:143], a[148:151], a[228:231], v[140:143]
buffer_load_dwordx4 v1, s[12:15], s26 offen offset:3072 sc1 lds
s_add_u32 m0, s29, 102400
s_waitcnt lgkmcnt(4)
M v[144:147], a[164:167], a[180:183], 0
v_exp_f32 v76, v76
M v[144:147], a[168:171], a[184:187], v[144:147]
ds_read_b128 a[132:135], v5 offset:34816
ds_read_b128 a[136:139], v5 offset:43008
M v[144:147], a[172:175], a[188:191], v[144:147]
v_exp_f32 v77, v77
M v[144:147], a[176:179], a[192:195], v[144:147]
buffer_load_dwordx4 v1, s[12:15], s43 offen offset:0 sc1 lds
M v[148:151], a[176:179], a[208:211], 0
v_exp_f32 v78, v78
M v[148:151], a[172:175], a[204:207], v[148:151]
v_cvt_pk_bf16_f32 v75, v90, v91
v_cvt_pk_bf16_f32 v76, v76, v77
M v[148:151], a[168:171], a[200:203], v[148:151]
v_exp_f32 v79, v79
M v[148:151], a[164:167], a[196:199], v[148:151]
buffer_load_dwordx4 v1, s[12:15], s43 offen offset:1024 sc1 lds
M v[152:155], a[164:167], a[212:215], 0
v_exp_f32 v92, v92
M v[152:155], a[168:171], a[216:219], v[152:155]
ds_read_b128 a[140:143], v5 offset:35840
ds_read_b128 a[144:147], v5 offset:44032
M v[152:155], a[172:175], a[220:223], v[152:155]
v_exp_f32 v93, v93
M v[152:155], a[176:179], a[224:227], v[152:155]
buffer_load_dwordx4 v1, s[12:15], s43 offen offset:2048 sc1 lds
M v[156:159], a[176:179], a[240:243], 0
v_exp_f32 v94, v94
M v[156:159], a[172:175], a[236:239], v[156:159]
v_cvt_pk_bf16_f32 v77, v78, v79
v_cvt_pk_bf16_f32 v78, v92, v93
M v[156:159], a[168:171], a[232:235], v[156:159]
v_exp_f32 v95, v95
M v[156:159], a[164:167], a[228:231], v[156:159]
buffer_load_dwordx4 v1, s[12:15], s43 offen offset:3072 sc1 lds
v_cvt_pk_bf16_f32 v79, v94, v95
s_waitcnt lgkmcnt(6)
M v[160:163], a[116:119], v[32:35], 0
v_exp_f32 v96, v96
M v[160:163], a[120:123], v[64:67], v[160:163]
ds_read_b128 a[148:151], v5 offset:36864
ds_read_b128 a[152:155], v5 offset:45056
M v[164:167], a[120:123], v[68:71], 0
v_exp_f32 v97, v97
M v[164:167], a[116:119], v[36:39], v[164:167]
v_cvt_pk_bf16_f32 v96, v96, v97
M v[168:171], a[116:119], v[40:43], 0
v_exp_f32 v98, v98
M v[168:171], a[120:123], v[72:75], v[168:171]
s_add_u32 s25, s25, 32768
s_cmp_eq_u32 s25, s27
M v[172:175], a[120:123], v[76:79], 0
v_exp_f32 v99, v99
M v[172:175], a[116:119], v[44:47], v[172:175]
v_cvt_pk_bf16_f32 v97, v98, v99
s_waitcnt lgkmcnt(6)
M a[96:99], a[112:115], v[32:35], 0
s_cselect_b32 s25, s28, s25
s_cselect_b32 s27, -1, s27
M a[96:99], a[112:115], v[64:67], a[96:99]
s_add_u32 s26, s26, 32768
s_cmp_eq_u32 s26, s62
M v[176:179], a[124:127], v[32:35], 0
v_exp_f32 v112, v112
M v[176:179], a[128:131], v[64:67], v[176:179]
ds_read_b128 a[156:159], v5 offset:37888
ds_read_b128 a[160:163], v5 offset:46080
M v[180:183], a[128:131], v[68:71], 0
v_exp_f32 v113, v113
M v[180:183], a[124:127], v[36:39], v[180:183]
v_cvt_pk_bf16_f32 v98, v112, v113
M v[184:187], a[124:127], v[40:43], 0
v_exp_f32 v114, v114
M v[184:187], a[128:131], v[72:75], v[184:187]
s_cselect_b32 s26, s63, s26
s_cselect_b32 s62, -1, s62
M v[188:191], a[128:131], v[76:79], 0
v_exp_f32 v115, v115
M v[188:191], a[124:127], v[44:47], v[188:191]
v_cvt_pk_bf16_f32 v99, v114, v115
s_waitcnt lgkmcnt(6)
M a[100:103], a[112:115], v[36:39], 0
M a[100:103], a[112:115], v[68:71], a[100:103]
M v[192:195], a[132:135], v[32:35], 0
v_exp_f32 v100, v100
M v[192:195], a[136:139], v[64:67], v[192:195]
ds_read_b128 a[164:167], v5 offset:38912
ds_read_b128 a[168:171], v5 offset:47104
M v[196:199], a[136:139], v[68:71], 0
v_exp_f32 v101, v101
M v[196:199], a[132:135], v[36:39], v[196:199]
v_cvt_pk_bf16_f32 v100, v100, v101
M v[200:203], a[132:135], v[40:43], 0
v_exp_f32 v102, v102
M v[200:203], a[136:139], v[72:75], v[200:203]
M v[204:207], a[136:139], v[76:79], 0
v_exp_f32 v103, v103
M v[204:207], a[132:135], v[44:47], v[204:207]
v_cvt_pk_bf16_f32 v101, v102, v103
s_waitcnt lgkmcnt(6)
M a[104:107], a[112:115], v[40:43], 0
M a[104:107], a[112:115], v[72:75], a[104:107]
M v[208:211], a[140:143], v[32:35], 0
v_exp_f32 v116, v116
M v[208:211], a[144:147], v[64:67], v[208:211]
ds_read_b128 a[172:175], v5 offset:39936
ds_read_b128 a[176:179], v5 offset:48128
M v[212:215], a[144:147], v[68:71], 0
v_exp_f32 v117, v117
M v[212:215], a[140:143], v[36:39], v[212:215]
v_cvt_pk_bf16_f32 v102, v116, v117
M v[216:219], a[140:143], v[40:43], 0
v_exp_f32 v118, v118
M v[216:219], a[144:147], v[72:75], v[216:219]
M v[220:223], a[144:147], v[76:79], 0
v_exp_f32 v119, v119
M v[220:223], a[140:143], v[44:47], v[220:223]
v_cvt_pk_bf16_f32 v103, v118, v119
s_waitcnt lgkmcnt(6)
M a[108:111], a[112:115], v[44:47], 0
M a[108:111], a[112:115], v[76:79], a[108:111]
M v[224:227], a[148:151], v[32:35], 0
v_exp_f32 v104, v104
M v[224:227], a[152:155], v[64:67], v[224:227]
M v[228:231], a[152:155], v[68:71], 0
v_exp_f32 v105, v105
M v[228:231], a[148:151], v[36:39], v[228:231]
v_cvt_pk_bf16_f32 v104, v104, v105
M v[232:235], a[148:151], v[40:43], 0
v_exp_f32 v106, v106
M v[232:235], a[152:155], v[72:75], v[232:235]
M v[236:239], a[152:155], v[76:79], 0
v_exp_f32 v107, v107
M v[236:239], a[148:151], v[44:47], v[236:239]
v_cvt_pk_bf16_f32 v105, v106, v107
s_waitcnt lgkmcnt(4)
M v[240:243], a[156:159], v[32:35], 0
v_exp_f32 v120, v120
M v[240:243], a[160:163], v[64:67], v[240:243]
M v[244:247], a[160:163], v[68:71], 0
v_exp_f32 v121, v121
M v[244:247], a[156:159], v[36:39], v[244:247]
v_cvt_pk_bf16_f32 v106, v120, v121
M v[248:251], a[156:159], v[40:43], 0
v_exp_f32 v122, v122
M v[248:251], a[160:163], v[72:75], v[248:251]
s_waitcnt vmcnt(0) lgkmcnt(0)
s_barrier
ds_read_b128 a[116:119], v3 offset:0
ds_read_b128 a[120:123], v3 offset:1024
M v[252:255], a[160:163], v[76:79], 0
v_exp_f32 v123, v123
M v[252:255], a[156:159], v[44:47], v[252:255]
v_cvt_pk_bf16_f32 v107, v122, v123
M a[64:67], a[164:167], v[32:35], 0
v_exp_f32 v108, v108
M a[64:67], a[168:171], v[64:67], a[64:67]
ds_read_b128 a[124:127], v3 offset:2048
ds_read_b128 a[128:131], v3 offset:3072
M a[68:71], a[168:171], v[68:71], 0
v_exp_f32 v109, v109
M a[68:71], a[164:167], v[36:39], a[68:71]
v_cvt_pk_bf16_f32 v108, v108, v109
M a[72:75], a[164:167], v[40:43], 0
v_exp_f32 v110, v110
M a[72:75], a[168:171], v[72:75], a[72:75]
ds_read_b128 a[132:135], v3 offset:4096
ds_read_b128 a[136:139], v3 offset:5120
M a[76:79], a[168:171], v[76:79], 0
v_exp_f32 v111, v111
M a[76:79], a[164:167], v[44:47], a[76:79]
v_cvt_pk_bf16_f32 v109, v110, v111
M a[80:83], a[172:175], v[32:35], 0
v_exp_f32 v124, v124
M a[80:83], a[176:179], v[64:67], a[80:83]
ds_read_b128 a[140:143], v3 offset:6144
ds_read_b128 a[144:147], v3 offset:7168
M a[84:87], a[176:179], v[68:71], 0
v_exp_f32 v125, v125
M a[84:87], a[172:175], v[36:39], a[84:87]
v_cvt_pk_bf16_f32 v110, v124, v125
M a[88:91], a[172:175], v[40:43], 0
v_exp_f32 v126, v126
M a[88:91], a[176:179], v[72:75], a[88:91]
M a[92:95], a[176:179], v[76:79], 0
v_exp_f32 v127, v127
M a[92:95], a[172:175], v[44:47], a[92:95]
v_cvt_pk_bf16_f32 v111, v126, v127
s_branch Lk2_l2b
Lk2_l2:
s_add_u32 m0, s29, 65536
s_waitcnt lgkmcnt(4)
M v[96:99], a[116:119], a[180:183], 0
v_exp_f32 v64, v64
M v[96:99], a[120:123], a[184:187], v[96:99]
ds_read_b128 a[148:151], v2 offset:8192
ds_read_b128 a[152:155], v2 offset:9216
M v[96:99], a[124:127], a[188:191], v[96:99]
v_exp_f32 v65, v65
M v[96:99], a[128:131], a[192:195], v[96:99]
buffer_load_dwordx4 v1, s[12:15], s25 offen offset:0 sc1 lds
s_add_u32 s32, s25, 4096
M v[100:103], a[128:131], a[208:211], 0
v_exp_f32 v66, v66
M v[100:103], a[124:127], a[204:207], v[100:103]
v_cvt_pk_bf16_f32 v64, v64, v65
M v[100:103], a[120:123], a[200:203], v[100:103]
v_exp_f32 v67, v67
M v[100:103], a[116:119], a[196:199], v[100:103]
buffer_load_dwordx4 v1, s[12:15], s25 offen offset:1024 sc1 lds
M v[104:107], a[116:119], a[212:215], 0
v_exp_f32 v80, v80
M v[104:107], a[120:123], a[216:219], v[104:107]
ds_read_b128 a[156:159], v2 offset:10240
ds_read_b128 a[160:163], v2 offset:11264
M v[104:107], a[124:127], a[220:223], v[104:107]
v_exp_f32 v81, v81
M v[104:107], a[128:131], a[224:227], v[104:107]
buffer_load_dwordx4 v1, s[12:15], s25 offen offset:2048 sc1 lds
M v[108:111], a[128:131], a[240:243], 0
v_exp_f32 v82, v82
M v[108:111], a[124:127], a[236:239], v[108:111]
v_cvt_pk_bf16_f32 v65, v66, v67
v_cvt_pk_bf16_f32 v66, v80, v81
M v[108:111], a[120:123], a[232:235], v[108:111]
v_exp_f32 v83, v83
M v[108:111], a[116:119], a[228:231], v[108:111]
buffer_load_dwordx4 v1, s[12:15], s25 offen offset:3072 sc1 lds
s_add_u32 m0, s29, 69632
s_waitcnt lgkmcnt(4)
M v[112:115], a[132:135], a[180:183], 0
v_exp_f32 v68, v68
M v[112:115], a[136:139], a[184:187], v[112:115]
ds_read_b128 a[164:167], v2 offset:12288
ds_read_b128 a[168:171], v2 offset:13312
M v[112:115], a[140:143], a[188:191], v[112:115]
v_exp_f32 v69, v69
M v[112:115], a[144:147], a[192:195], v[112:115]
buffer_load_dwordx4 v1, s[12:15], s32 offen offset:0 sc1 lds
M v[116:119], a[144:147], a[208:211], 0
v_exp_f32 v70, v70
M v[116:119], a[140:143], a[204:207], v[116:119]
v_cvt_pk_bf16_f32 v67, v82, v83
v_cvt_pk_bf16_f32 v68, v68, v69
M v[116:119], a[136:139], a[200:203], v[116:119]
v_exp_f32 v71, v71
M v[116:119], a[132:135], a[196:199], v[116:119]
buffer_load_dwordx4 v1, s[12:15], s32 offen offset:1024 sc1 lds
M v[120:123], a[132:135], a[212:215], 0
v_exp_f32 v84, v84
M v[120:123], a[136:139], a[216:219], v[120:123]
ds_read_b128 a[172:175], v2 offset:14336
ds_read_b128 a[176:179], v2 offset:15360
M v[120:123], a[140:143], a[220:223], v[120:123]
v_exp_f32 v85, v85
M v[120:123], a[144:147], a[224:227], v[120:123]
buffer_load_dwordx4 v1, s[12:15], s32 offen offset:2048 sc1 lds
M v[124:127], a[144:147], a[240:243], 0
v_exp_f32 v86, v86
M v[124:127], a[140:143], a[236:239], v[124:127]
v_cvt_pk_bf16_f32 v69, v70, v71
v_cvt_pk_bf16_f32 v70, v84, v85
M v[124:127], a[136:139], a[232:235], v[124:127]
v_exp_f32 v87, v87
M v[124:127], a[132:135], a[228:231], v[124:127]
buffer_load_dwordx4 v1, s[12:15], s32 offen offset:3072 sc1 lds
s_add_u32 m0, s29, 98304
s_waitcnt lgkmcnt(4)
M v[128:131], a[148:151], a[180:183], 0
v_exp_f32 v72, v72
M v[128:131], a[152:155], a[184:187], v[128:131]
ds_read_b128 a[116:119], v5 offset:32768
ds_read_b128 a[120:123], v5 offset:40960
M v[128:131], a[156:159], a[188:191], v[128:131]
v_exp_f32 v73, v73
M v[128:131], a[160:163], a[192:195], v[128:131]
buffer_load_dwordx4 v1, s[12:15], s26 offen offset:0 sc1 lds
s_add_u32 s43, s26, 4096
M v[132:135], a[160:163], a[208:211], 0
v_exp_f32 v74, v74
M v[132:135], a[156:159], a[204:207], v[132:135]
v_cvt_pk_bf16_f32 v71, v86, v87
v_cvt_pk_bf16_f32 v72, v72, v73
M v[132:135], a[152:155], a[200:203], v[132:135]
v_exp_f32 v75, v75
M v[132:135], a[148:151], a[196:199], v[132:135]
buffer_load_dwordx4 v1, s[12:15], s26 offen offset:1024 sc1 lds
M v[136:139], a[148:151], a[212:215], 0
v_exp_f32 v88, v88
M v[136:139], a[152:155], a[216:219], v[136:139]
ds_read_b128 a[124:127], v5 offset:33792
ds_read_b128 a[128:131], v5 offset:41984
M v[136:139], a[156:159], a[220:223], v[136:139]
v_exp_f32 v89, v89
M v[136:139], a[160:163], a[224:227], v[136:139]
buffer_load_dwordx4 v1, s[12:15], s26 offen offset:2048 sc1 lds
M v[140:143], a[160:163], a[240:243], 0
v_exp_f32 v90, v90
M v[140:143], a[156:159], a[236:239], v[140:143]
v_cvt_pk_bf16_f32 v73, v74, v75
v_cvt_pk_bf16_f32 v74, v88, v89
M v[140:143], a[152:155], a[232:235], v[140:143]
v_exp_f32 v91, v91
M v[140:143], a[148:151], a[228:231], v[140:143]
buffer_load_dwordx4 v1, s[12:15], s26 offen offset:3072 sc1 lds
s_add_u32 m0, s29, 102400
s_waitcnt lgkmcnt(4)
M v[144:147], a[164:167], a[180:183], 0
v_exp_f32 v76, v76
M v[144:147], a[168:171], a[184:187], v[144:147]
ds_read_b128 a[132:135], v5 offset:34816
ds_read_b128 a[136:139], v5 offset:43008
M v[144:147], a[172:175], a[188:191], v[144:147]
v_exp_f32 v77, v77
M v[144:147], a[176:179], a[192:195], v[144:147]
buffer_load_dwordx4 v1, s[12:15], s43 offen offset:0 sc1 lds
M v[148:151], a[176:179], a[208:211], 0
v_exp_f32 v78, v78
M v[148:151], a[172:175], a[204:207], v[148:151]
v_cvt_pk_bf16_f32 v75, v90, v91
v_cvt_pk_bf16_f32 v76, v76, v77
M v[148:151], a[168:171], a[200:203], v[148:151]
v_exp_f32 v79, v79
M v[148:151], a[164:167], a[196:199], v[148:151]
buffer_load_dwordx4 v1, s[12:15], s43 offen offset:1024 sc1 lds
M v[152:155], a[164:167], a[212:215], 0
v_exp_f32 v92, v92
M v[152:155], a[168:171], a[216:219], v[152:155]
ds_read_b128 a[140:143], v5 offset:35840
ds_read_b128 a[144:147], v5 offset:44032
M v[152:155], a[172:175], a[220:223], v[152:155]
v_exp_f32 v93, v93
M v[152:155], a[176:179], a[224:227], v[152:155]
buffer_load_dwordx4 v1, s[12:15], s43 offen offset:2048 sc1 lds
M v[156:159], a[176:179], a[240:243], 0
v_exp_f32 v94, v94
M v[156:159], a[172:175], a[236:239], v[156:159]
v_cvt_pk_bf16_f32 v77, v78, v79
v_cvt_pk_bf16_f32 v78, v92, v93
M v[156:159], a[168:171], a[232:235], v[156:159]
v_exp_f32 v95, v95
M v[156:159], a[164:167], a[228:231], v[156:159]
buffer_load_dwordx4 v1, s[12:15], s43 offen offset:3072 sc1 lds
v_cvt_pk_bf16_f32 v79, v94, v95
s_waitcnt lgkmcnt(6)
M v[160:163], a[116:119], v[32:35], v[160:163]
v_exp_f32 v96, v96
M v[160:163], a[120:123], v[64:67], v[160:163]
ds_read_b128 a[148:151], v5 offset:36864
ds_read_b128 a[152:155], v5 offset:45056
M v[164:167], a[120:123], v[68:71], v[164:167]
v_exp_f32 v97, v97
M v[164:167], a[116:119], v[36:39], v[164:167]
v_cvt_pk_bf16_f32 v96, v96, v97
M v[168:171], a[116:119], v[40:43], v[168:171]
v_exp_f32 v98, v98
M v[168:171], a[120:123], v[72:75], v[168:171]
s_add_u32 s25, s25, 32768
s_cmp_eq_u32 s25, s27
M v[172:175], a[120:123], v[76:79], v[172:175]
v_exp_f32 v99, v99
M v[172:175], a[116:119], v[44:47], v[172:175]
v_cvt_pk_bf16_f32 v97, v98, v99
s_waitcnt lgkmcnt(6)
M a[96:99], a[112:115], v[32:35], a[96:99]
s_cselect_b32 s25, s28, s25
s_cselect_b32 s27, -1, s27
M a[96:99], a[112:115], v[64:67], a[96:99]
s_add_u32 s26, s26, 32768
s_cmp_eq_u32 s26, s62
M v[176:179], a[124:127], v[32:35], v[176:179]
v_exp_f32 v112, v112
M v[176:179], a[128:131], v[64:67], v[176:179]
ds_read_b128 a[156:159], v5 offset:37888
ds_read_b128 a[160:163], v5 offset:46080
M v[180:183], a[128:131], v[68:71], v[180:183]
v_exp_f32 v113, v113
M v[180:183], a[124:127], v[36:39], v[180:183]
v_cvt_pk_bf16_f32 v98, v112, v113
M v[184:187], a[124:127], v[40:43], v[184:187]
v_exp_f32 v114, v114
M v[184:187], a[128:131], v[72:75], v[184:187]
s_cselect_b32 s26, s63, s26
s_cselect_b32 s62, -1, s62
M v[188:191], a[128:131], v[76:79], v[188:191]
v_exp_f32 v115, v115
M v[188:191], a[124:127], v[44:47], v[188:191]
v_cvt_pk_bf16_f32 v99, v114, v115
s_waitcnt lgkmcnt(6)
M a[100:103], a[112:115], v[36:39], a[100:103]
M a[100:103], a[112:115], v[68:71], a[100:103]
M v[192:195], a[132:135], v[32:35], v[192:195]
v_exp_f32 v100, v100
M v[192:195], a[136:139], v[64:67], v[192:195]
ds_read_b128 a[164:167], v5 offset:38912
ds_read_b128 a[168:171], v5 offset:47104
M v[196:199], a[136:139], v[68:71], v[196:199]
v_exp_f32 v101, v101
M v[196:199], a[132:135], v[36:39], v[196:199]
v_cvt_pk_bf16_f32 v100, v100, v101
M v[200:203], a[132:135], v[40:43], v[200:203]
v_exp_f32 v102, v102
M v[200:203], a[136:139], v[72:75], v[200:203]
M v[204:207], a[136:139], v[76:79], v[204:207]
v_exp_f32 v103, v103
M v[204:207], a[132:135], v[44:47], v[204:207]
v_cvt_pk_bf16_f32 v101, v102, v103
s_waitcnt lgkmcnt(6)
M a[104:107], a[112:115], v[40:43], a[104:107]
M a[104:107], a[112:115], v[72:75], a[104:107]
M v[208:211], a[140:143], v[32:35], v[208:211]
v_exp_f32 v116, v116
M v[208:211], a[144:147], v[64:67], v[208:211]
ds_read_b128 a[172:175], v5 offset:39936
ds_read_b128 a[176:179], v5 offset:48128
M v[212:215], a[144:147], v[68:71], v[212:215]
v_exp_f32 v117, v117
M v[212:215], a[140:143], v[36:39], v[212:215]
v_cvt_pk_bf16_f32 v102, v116, v117
M v[216:219], a[140:143], v[40:43], v[216:219]
v_exp_f32 v118, v118
M v[216:219], a[144:147], v[72:75], v[216:219]
M v[220:223], a[144:147], v[76:79], v[220:223]
v_exp_f32 v119, v119
M v[220:223], a[140:143], v[44:47], v[220:223]
v_cvt_pk_bf16_f32 v103, v118, v119
s_waitcnt lgkmcnt(6)
M a[108:111], a[112:115], v[44:47], a[108:111]
M a[108:111], a[112:115], v[76:79], a[108:111]
M v[224:227], a[148:151], v[32:35], v[224:227]
v_exp_f32 v104, v104
M v[224:227], a[152:155], v[64:67], v[224:227]
M v[228:231], a[152:155], v[68:71], v[228:231]
v_exp_f32 v105, v105
M v[228:231], a[148:151], v[36:39], v[228:231]
v_cvt_pk_bf16_f32 v104, v104, v105
M v[232:235], a[148:151], v[40:43], v[232:235]
v_exp_f32 v106, v106
M v[232:235], a[152:155], v[72:75], v[232:235]
M v[236:239], a[152:155], v[76:79], v[236:239]
v_exp_f32 v107, v107
M v[236:239], a[148:151], v[44:47], v[236:239]
v_cvt_pk_bf16_f32 v105, v106, v107
s_waitcnt lgkmcnt(4)
M v[240:243], a[156:159], v[32:35], v[240:243]
v_exp_f32 v120, v120
M v[240:243], a[160:163], v[64:67], v[240:243]
M v[244:247], a[160:163], v[68:71], v[244:247]
v_exp_f32 v121, v121
M v[244:247], a[156:159], v[36:39], v[244:247]
v_cvt_pk_bf16_f32 v106, v120, v121
M v[248:251], a[156:159], v[40:43], v[248:251]
v_exp_f32 v122, v122
M v[248:251], a[160:163], v[72:75], v[248:251]
s_waitcnt vmcnt(0) lgkmcnt(0)
s_barrier
ds_read_b128 a[116:119], v3 offset:0
ds_read_b128 a[120:123], v3 offset:1024
M v[252:255], a[160:163], v[76:79], v[252:255]
v_exp_f32 v123, v123
M v[252:255], a[156:159], v[44:47], v[252:255]
v_cvt_pk_bf16_f32 v107, v122, v123
M a[64:67], a[164:167], v[32:35], a[64:67]
v_exp_f32 v108, v108
M a[64:67], a[168:171], v[64:67], a[64:67]
ds_read_b128 a[124:127], v3 offset:2048
ds_read_b128 a[128:131], v3 offset:3072
M a[68:71], a[168:171], v[68:71], a[68:71]
v_exp_f32 v109, v109
M a[68:71], a[164:167], v[36:39], a[68:71]
v_cvt_pk_bf16_f32 v108, v108, v109
M a[72:75], a[164:167], v[40:43], a[72:75]
v_exp_f32 v110, v110
M a[72:75], a[168:171], v[72:75], a[72:75]
ds_read_b128 a[132:135], v3 offset:4096
ds_read_b128 a[136:139], v3 offset:5120
M a[76:79], a[168:171], v[76:79], a[76:79]
v_exp_f32 v111, v111
M a[76:79], a[164:167], v[44:47], a[76:79]
v_cvt_pk_bf16_f32 v109, v110, v111
M a[80:83], a[172:175], v[32:35], a[80:83]
v_exp_f32 v124, v124
M a[80:83], a[176:179], v[64:67], a[80:83]
ds_read_b128 a[140:143], v3 offset:6144
ds_read_b128 a[144:147], v3 offset:7168
M a[84:87], a[176:179], v[68:71], a[84:87]
v_exp_f32 v125, v125
M a[84:87], a[172:175], v[36:39], a[84:87]
v_cvt_pk_bf16_f32 v110, v124, v125
M a[88:91], a[172:175], v[40:43], a[88:91]
v_exp_f32 v126, v126
M a[88:91], a[176:179], v[72:75], a[88:91]
M a[92:95], a[176:179], v[76:79], a[92:95]
v_exp_f32 v127, v127
M a[92:95], a[172:175], v[44:47], a[92:95]
v_cvt_pk_bf16_f32 v111, v126, v127
Lk2_l2b:
s_add_u32 m0, s29, 0
s_waitcnt lgkmcnt(4)
M v[32:35], a[116:119], a[180:183], 0
v_exp_f32 v128, v128
M v[32:35], a[120:123], a[184:187], v[32:35]
ds_read_b128 a[148:151], v3 offset:8192
ds_read_b128 a[152:155], v3 offset:9216
M v[32:35], a[124:127], a[188:191], v[32:35]
v_exp_f32 v129, v129
M v[32:35], a[128:131], a[192:195], v[32:35]
buffer_load_dwordx4 v1, s[12:15], s25 offen offset:0 sc1 lds
s_add_u32 s32, s25, 4096
M v[36:39], a[128:131], a[208:211], 0
v_exp_f32 v130, v130
M v[36:39], a[124:127], a[204:207], v[36:39]
v_cvt_pk_bf16_f32 v128, v128, v129
M v[36:39], a[120:123], a[200:203], v[36:39]
v_exp_f32 v131, v131
M v[36:39], a[116:119], a[196:199], v[36:39]
buffer_load_dwordx4 v1, s[12:15], s25 offen offset:1024 sc1 lds
M v[40:43], a[116:119], a[212:215], 0
v_exp_f32 v144, v144
M v[40:43], a[120:123], a[216:219], v[40:43]
ds_read_b128 a[156:159], v3 offset:10240
ds_read_b128 a[160:163], v3 offset:11264
M v[40:43], a[124:127], a[220:223], v[40:43]
v_exp_f32 v145, v145
M v[40:43], a[128:131], a[224:227], v[40:43]
buffer_load_dwordx4 v1, s[12:15], s25 offen offset:2048 sc1 lds
M v[44:47], a[128:131], a[240:243], 0
v_exp_f32 v146, v146
M v[44:47], a[124:127], a[236:239], v[44:47]
v_cvt_pk_bf16_f32 v129, v130, v131
v_cvt_pk_bf16_f32 v130, v144, v145
M v[44:47], a[120:123], a[232:235], v[44:47]
v_exp_f32 v147, v147
M v[44:47], a[116:119], a[228:231], v[44:47]
buffer_load_dwordx4 v1, s[12:15], s25 offen offset:3072 sc1 lds
s_add_u32 m0, s29, 4096
s_waitcnt lgkmcnt(4)
M v[48:51], a[132:135], a[180:183], 0
v_exp_f32 v132, v132
M v[48:51], a[136:139], a[184:187], v[48:51]
ds_read_b128 a[164:167], v3 offset:12288
ds_read_b128 a[168:171], v3 offset:13312
M v[48:51], a[140:143], a[188:191], v[48:51]
v_exp_f32 v133, v133
M v[48:51], a[144:147], a[192:195], v[48:51]
buffer_load_dwordx4 v1, s[12:15], s32 offen offset:0 sc1 lds
M v[52:55], a[144:147], a[208:211], 0
v_exp_f32 v134, v134
M v[52:55], a[140:143], a[204:207], v[52:55]
v_cvt_pk_bf16_f32 v131, v146, v147
v_cvt_pk_bf16_f32 v132, v132, v133
M v[52:55], a[136:139], a[200:203], v[52:55]
v_exp_f32 v135, v135
M v[52:55], a[132:135], a[196:199], v[52:55]
buffer_load_dwordx4 v1, s[12:15], s32 offen offset:1024 sc1 lds
M v[56:59], a[132:135], a[212:215], 0
v_exp_f32 v148, v148
M v[56:59], a[136:139], a[216:219], v[56:59]
ds_read_b128 a[172:175], v3 offset:14336
ds_read_b128 a[176:179], v3 offset:15360
M v[56:59], a[140:143], a[220:223], v[56:59]
v_exp_f32 v149, v149
M v[56:59], a[144:147], a[224:227], v[56:59]
buffer_load_dwordx4 v1, s[12:15], s32 offen offset:2048 sc1 lds
M v[60:63], a[144:147], a[240:243], 0
v_exp_f32 v150, v150
M v[60:63], a[140:143], a[236:239], v[60:63]
v_cvt_pk_bf16_f32 v133, v134, v135
v_cvt_pk_bf16_f32 v134, v148, v149
M v[60:63], a[136:139], a[232:235], v[60:63]
v_exp_f32 v151, v151
M v[60:63], a[132:135], a[228:231], v[60:63]
buffer_load_dwordx4 v1, s[12:15], s32 offen offset:3072 sc1 lds
s_add_u32 m0, s29, 32768
s_waitcnt lgkmcnt(4)
M v[64:67], a[148:151], a[180:183], 0
v_exp_f32 v136, v136
M v[64:67], a[152:155], a[184:187], v[64:67]
ds_read_b128 a[116:119], v6 offset:32768
ds_read_b128 a[120:123], v6 offset:40960
M v[64:67], a[156:159], a[188:191], v[64:67]
v_exp_f32 v137, v137
M v[64:67], a[160:163], a[192:195], v[64:67]
buffer_load_dwordx4 v1, s[12:15], s26 offen offset:0 sc1 lds
s_add_u32 s43, s26, 4096
M v[68:71], a[160:163], a[208:211], 0
v_exp_f32 v138, v138
M v[68:71], a[156:159], a[204:207], v[68:71]
v_cvt_pk_bf16_f32 v135, v150, v151
v_cvt_pk_bf16_f32 v136, v136, v137
M v[68:71], a[152:155], a[200:203], v[68:71]
v_exp_f32 v139, v139
M v[68:71], a[148:151], a[196:199], v[68:71]
buffer_load_dwordx4 v1, s[12:15], s26 offen offset:1024 sc1 lds
M v[72:75], a[148:151], a[212:215], 0
v_exp_f32 v152, v152
M v[72:75], a[152:155], a[216:219], v[72:75]
ds_read_b128 a[124:127], v6 offset:33792
ds_read_b128 a[128:131], v6 offset:41984
M v[72:75], a[156:159], a[220:223], v[72:75]
v_exp_f32 v153, v153
M v[72:75], a[160:163], a[224:227], v[72:75]
buffer_load_dwordx4 v1, s[12:15], s26 offen offset:2048 sc1 lds
M v[76:79], a[160:163], a[240:243], 0
v_exp_f32 v154, v154
M v[76:79], a[156:159], a[236:239], v[76:79]
v_cvt_pk_bf16_f32 v137, v138, v139
v_cvt_pk_bf16_f32 v138, v152, v153
M v[76:79], a[152:155], a[232:235], v[76:79]
v_exp_f32 v155, v155
M v[76:79], a[148:151], a[228:231], v[76:79]
buffer_load_dwordx4 v1, s[12:15], s26 offen offset:3072 sc1 lds
s_add_u32 m0, s29, 36864
s_waitcnt lgkmcnt(4)
M v[80:83], a[164:167], a[180:183], 0
v_exp_f32 v140, v140
M v[80:83], a[168:171], a[184:187], v[80:83]
ds_read_b128 a[132:135], v6 offset:34816
ds_read_b128 a[136:139], v6 offset:43008
M v[80:83], a[172:175], a[188:191], v[80:83]
v_exp_f32 v141, v141
M v[80:83], a[176:179], a[192:195], v[80:83]
buffer_load_dwordx4 v1, s[12:15], s43 offen offset:0 sc1 lds
M v[84:87], a[176:179], a[208:211], 0
v_exp_f32 v142, v142
M v[84:87], a[172:175], a[204:207], v[84:87]
v_cvt_pk_bf16_f32 v139, v154, v155
v_cvt_pk_bf16_f32 v140, v140, v141
M v[84:87], a[168:171], a[200:203], v[84:87]
v_exp_f32 v143, v143
M v[84:87], a[164:167], a[196:199], v[84:87]
buffer_load_dwordx4 v1, s[12:15], s43 offen offset:1024 sc1 lds
M v[88:91], a[164:167], a[212:215], 0
v_exp_f32 v156, v156
M v[88:91], a[168:171], a[216:219], v[88:91]
ds_read_b128 a[140:143], v6 offset:35840
ds_read_b128 a[144:147], v6 offset:44032
M v[88:91], a[172:175], a[220:223], v[88:91]
v_exp_f32 v157, v157
M v[88:91], a[176:179], a[224:227], v[88:91]
buffer_load_dwordx4 v1, s[12:15], s43 offen offset:2048 sc1 lds
M v[92:95], a[176:179], a[240:243], 0
v_exp_f32 v158, v158
M v[92:95], a[172:175], a[236:239], v[92:95]
v_cvt_pk_bf16_f32 v141, v142, v143
v_cvt_pk_bf16_f32 v142, v156, v157
M v[92:95], a[168:171], a[232:235], v[92:95]
v_exp_f32 v159, v159
M v[92:95], a[164:167], a[228:231], v[92:95]
buffer_load_dwordx4 v1, s[12:15], s43 offen offset:3072 sc1 lds
v_cvt_pk_bf16_f32 v143, v158, v159
s_waitcnt lgkmcnt(6)
M v[160:163], a[116:119], v[96:99], v[160:163]
v_exp_f32 v32, v32
M v[160:163], a[120:123], v[128:131], v[160:163]
ds_read_b128 a[148:151], v6 offset:36864
ds_read_b128 a[152:155], v6 offset:45056
M v[164:167], a[120:123], v[132:135], v[164:167]
v_exp_f32 v33, v33
M v[164:167], a[116:119], v[100:103], v[164:167]
v_cvt_pk_bf16_f32 v32, v32, v33
M v[168:171], a[116:119], v[104:107], v[168:171]
v_exp_f32 v34, v34
M v[168:171], a[120:123], v[136:139], v[168:171]
s_add_u32 s25, s25, 32768
s_cmp_eq_u32 s25, s27
M v[172:175], a[120:123], v[140:143], v[172:175]
v_exp_f32 v35, v35
M v[172:175], a[116:119], v[108:111], v[172:175]
v_cvt_pk_bf16_f32 v33, v34, v35
s_waitcnt lgkmcnt(6)
M a[96:99], a[112:115], v[96:99], a[96:99]
s_cselect_b32 s25, s28, s25
s_cselect_b32 s27, -1, s27
M a[96:99], a[112:115], v[128:131], a[96:99]
s_add_u32 s26, s26, 32768
s_cmp_eq_u32 s26, s62
M v[176:179], a[124:127], v[96:99], v[176:179]
v_exp_f32 v48, v48
M v[176:179], a[128:131], v[128:131], v[176:179]
ds_read_b128 a[156:159], v6 offset:37888
ds_read_b128 a[160:163], v6 offset:46080
M v[180:183], a[128:131], v[132:135], v[180:183]
v_exp_f32 v49, v49
M v[180:183], a[124:127], v[100:103], v[180:183]
v_cvt_pk_bf16_f32 v34, v48, v49
M v[184:187], a[124:127], v[104:107], v[184:187]
v_exp_f32 v50, v50
M v[184:187], a[128:131], v[136:139], v[184:187]
s_cselect_b32 s26, s63, s26
s_cselect_b32 s62, -1, s62
M v[188:191], a[128:131], v[140:143], v[188:191]
v_exp_f32 v51, v51
M v[188:191], a[124:127], v[108:111], v[188:191]
v_cvt_pk_bf16_f32 v35, v50, v51
s_waitcnt lgkmcnt(6)
M a[100:103], a[112:115], v[100:103], a[100:103]
M a[100:103], a[112:115], v[132:135], a[100:103]
M v[192:195], a[132:135], v[96:99], v[192:195]
v_exp_f32 v36, v36
M v[192:195], a[136:139], v[128:131], v[192:195]
ds_read_b128 a[164:167], v6 offset:38912
ds_read_b128 a[168:171], v6 offset:47104
M v[196:199], a[136:139], v[132:135], v[196:199]
v_exp_f32 v37, v37
M v[196:199], a[132:135], v[100:103], v[196:199]
v_cvt_pk_bf16_f32 v36, v36, v37
M v[200:203], a[132:135], v[104:107], v[200:203]
v_exp_f32 v38, v38
M v[200:203], a[136:139], v[136:139], v[200:203]
M v[204:207], a[136:139], v[140:143], v[204:207]
v_exp_f32 v39, v39
M v[204:207], a[132:135], v[108:111], v[204:207]
v_cvt_pk_bf16_f32 v37, v38, v39
s_waitcnt lgkmcnt(6)
M a[104:107], a[112:115], v[104:107], a[104:107]
M a[104:107], a[112:115], v[136:139], a[104:107]
M v[208:211], a[140:143], v[96:99], v[208:211]
v_exp_f32 v52, v52
M v[208:211], a[144:147], v[128:131], v[208:211]
ds_read_b128 a[172:175], v6 offset:39936
ds_read_b128 a[176:179], v6 offset:48128
M v[212:215], a[144:147], v[132:135], v[212:215]
v_exp_f32 v53, v53
M v[212:215], a[140:143], v[100:103], v[212:215]
v_cvt_pk_bf16_f32 v38, v52, v53
M v[216:219], a[140:143], v[104:107], v[216:219]
v_exp_f32 v54, v54
M v[216:219], a[144:147], v[136:139], v[216:219]
M v[220:223], a[144:147], v[140:143], v[220:223]
v_exp_f32 v55, v55
M v[220:223], a[140:143], v[108:111], v[220:223]
v_cvt_pk_bf16_f32 v39, v54, v55
s_waitcnt lgkmcnt(6)
M a[108:111], a[112:115], v[108:111], a[108:111]
M a[108:111], a[112:115], v[140:143], a[108:111]
M v[224:227], a[148:151], v[96:99], v[224:227]
v_exp_f32 v40, v40
M v[224:227], a[152:155], v[128:131], v[224:227]
M v[228:231], a[152:155], v[132:135], v[228:231]
v_exp_f32 v41, v41
M v[228:231], a[148:151], v[100:103], v[228:231]
v_cvt_pk_bf16_f32 v40, v40, v41
M v[232:235], a[148:151], v[104:107], v[232:235]
v_exp_f32 v42, v42
M v[232:235], a[152:155], v[136:139], v[232:235]
M v[236:239], a[152:155], v[140:143], v[236:239]
v_exp_f32 v43, v43
M v[236:239], a[148:151], v[108:111], v[236:239]
v_cvt_pk_bf16_f32 v41, v42, v43
s_waitcnt lgkmcnt(4)
M v[240:243], a[156:159], v[96:99], v[240:243]
v_exp_f32 v56, v56
M v[240:243], a[160:163], v[128:131], v[240:243]
M v[244:247], a[160:163], v[132:135], v[244:247]
v_exp_f32 v57, v57
M v[244:247], a[156:159], v[100:103], v[244:247]
v_cvt_pk_bf16_f32 v42, v56, v57
M v[248:251], a[156:159], v[104:107], v[248:251]
v_exp_f32 v58, v58
M v[248:251], a[160:163], v[136:139], v[248:251]
s_waitcnt vmcnt(0) lgkmcnt(0)
s_barrier
ds_read_b128 a[116:119], v2 offset:0
ds_read_b128 a[120:123], v2 offset:1024
M v[252:255], a[160:163], v[140:143], v[252:255]
v_exp_f32 v59, v59
M v[252:255], a[156:159], v[108:111], v[252:255]
v_cvt_pk_bf16_f32 v43, v58, v59
M a[64:67], a[164:167], v[96:99], a[64:67]
v_exp_f32 v44, v44
M a[64:67], a[168:171], v[128:131], a[64:67]
ds_read_b128 a[124:127], v2 offset:2048
ds_read_b128 a[128:131], v2 offset:3072
M a[68:71], a[168:171], v[132:135], a[68:71]
v_exp_f32 v45, v45
M a[68:71], a[164:167], v[100:103], a[68:71]
v_cvt_pk_bf16_f32 v44, v44, v45
M a[72:75], a[164:167], v[104:107], a[72:75]
v_exp_f32 v46, v46
M a[72:75], a[168:171], v[136:139], a[72:75]
ds_read_b128 a[132:135], v2 offset:4096
ds_read_b128 a[136:139], v2 offset:5120
M a[76:79], a[168:171], v[140:143], a[76:79]
v_exp_f32 v47, v47
M a[76:79], a[164:167], v[108:111], a[76:79]
v_cvt_pk_bf16_f32 v45, v46, v47
M a[80:83], a[172:175], v[96:99], a[80:83]
v_exp_f32 v60, v60
M a[80:83], a[176:179], v[128:131], a[80:83]
ds_read_b128 a[140:143], v2 offset:6144
ds_read_b128 a[144:147], v2 offset:7168
M a[84:87], a[176:179], v[132:135], a[84:87]
v_exp_f32 v61, v61
M a[84:87], a[172:175], v[100:103], a[84:87]
v_cvt_pk_bf16_f32 v46, v60, v61
M a[88:91], a[172:175], v[104:107], a[88:91]
v_exp_f32 v62, v62
M a[88:91], a[176:179], v[136:139], a[88:91]
M a[92:95], a[176:179], v[140:143], a[92:95]
v_exp_f32 v63, v63
M a[92:95], a[172:175], v[108:111], a[92:95]
v_cvt_pk_bf16_f32 v47, v62, v63
s_sub_u32 s30, s30, 1
s_cmp_lg_u32 s30, 0
s_cbranch_scc1 Lk2_l2
s_and_b32 s3, s2, 3
s_lshl_b32 s3, s3, 2
s_bfe_u32 s27, s2, 0x20003
s_add_u32 s27, s3, s27
s_lshl_b32 s43, s27, 8
s_add_u32 s43, s43, 8400896
v_lshlrev_b32 v15, 2, v0
buffer_load_dword v7, v15, s[52:55], s43 offen sc1
s_waitcnt lgkmcnt(7)
ds_read_b128 a[116:119], v5 offset:36864
s_waitcnt lgkmcnt(7)
ds_read_b128 a[120:123], v5 offset:45056
s_waitcnt lgkmcnt(7)
ds_read_b128 a[124:127], v5 offset:37888
s_waitcnt lgkmcnt(7)
ds_read_b128 a[128:131], v5 offset:46080
s_waitcnt lgkmcnt(7)
ds_read_b128 a[132:135], v5 offset:38912
s_waitcnt lgkmcnt(7)
ds_read_b128 a[136:139], v5 offset:47104
s_waitcnt lgkmcnt(7)
ds_read_b128 a[140:143], v5 offset:39936
s_waitcnt lgkmcnt(7)
ds_read_b128 a[144:147], v5 offset:48128
s_lshl_b32 s33, s23, 14
s_add_u32 s34, s33, 98304
s_add_u32 s33, s33, 131072
v_add_u32 v2, s34, v1
v_add_u32 v3, s33, v1
v_exp_f32 v64, v64
v_exp_f32 v65, v65
v_exp_f32 v66, v66
v_exp_f32 v67, v67
v_exp_f32 v80, v80
v_exp_f32 v81, v81
v_exp_f32 v82, v82
v_exp_f32 v83, v83
v_cvt_pk_bf16_f32 v64, v64, v65
v_cvt_pk_bf16_f32 v65, v66, v67
v_exp_f32 v68, v68
v_exp_f32 v69, v69
v_exp_f32 v70, v70
v_exp_f32 v71, v71
v_cvt_pk_bf16_f32 v66, v80, v81
v_cvt_pk_bf16_f32 v67, v82, v83
v_exp_f32 v84, v84
v_exp_f32 v85, v85
v_exp_f32 v86, v86
v_exp_f32 v87, v87
v_cvt_pk_bf16_f32 v68, v68, v69
v_cvt_pk_bf16_f32 v69, v70, v71
v_exp_f32 v72, v72
v_exp_f32 v73, v73
v_exp_f32 v74, v74
v_exp_f32 v75, v75
v_cvt_pk_bf16_f32 v70, v84, v85
v_cvt_pk_bf16_f32 v71, v86, v87
v_exp_f32 v88, v88
v_exp_f32 v89, v89
v_exp_f32 v90, v90
v_exp_f32 v91, v91
v_cvt_pk_bf16_f32 v72, v72, v73
v_cvt_pk_bf16_f32 v73, v74, v75
v_exp_f32 v76, v76
v_exp_f32 v77, v77
v_exp_f32 v78, v78
v_exp_f32 v79, v79
v_cvt_pk_bf16_f32 v74, v88, v89
v_cvt_pk_bf16_f32 v75, v90, v91
v_exp_f32 v92, v92
v_exp_f32 v93, v93
v_exp_f32 v94, v94
v_exp_f32 v95, v95
v_cvt_pk_bf16_f32 v76, v76, v77
v_cvt_pk_bf16_f32 v77, v78, v79
v_cvt_pk_bf16_f32 v78, v92, v93
v_cvt_pk_bf16_f32 v79, v94, v95
s_waitcnt lgkmcnt(6)
M v[224:227], a[116:119], v[32:35], v[224:227]
M v[224:227], a[120:123], v[64:67], v[224:227]
ds_read_b128 a[148:151], v5 offset:32768
ds_read_b128 a[152:155], v5 offset:40960
s_mov_b32 s61, 0
M v[228:231], a[120:123], v[68:71], v[228:231]
M v[228:231], a[116:119], v[36:39], v[228:231]
s_bfe_u32 s3, s2, 0x10002
M v[232:235], a[116:119], v[40:43], v[232:235]
M v[232:235], a[120:123], v[72:75], v[232:235]
s_lshl_b32 s3, s3, 3
M v[236:239], a[120:123], v[76:79], v[236:239]
M v[236:239], a[116:119], v[44:47], v[236:239]
s_waitcnt lgkmcnt(6)
s_lshr_b32 s28, s2, 5
M a[96:99], a[112:115], v[32:35], a[96:99]
M a[96:99], a[112:115], v[64:67], a[96:99]
M v[240:243], a[124:127], v[32:35], v[240:243]
M v[240:243], a[128:131], v[64:67], v[240:243]
ds_read_b128 a[156:159], v5 offset:33792
ds_read_b128 a[160:163], v5 offset:41984
s_add_u32 s28, s3, s28
M v[244:247], a[128:131], v[68:71], v[244:247]
s_lshl_b32 s25, s27, 18
M v[244:247], a[124:127], v[36:39], v[244:247]
M v[248:251], a[124:127], v[40:43], v[248:251]
s_lshl_b32 s3, s101, 12
M v[248:251], a[128:131], v[72:75], v[248:251]
M v[252:255], a[128:131], v[76:79], v[252:255]
s_add_u32 s25, s25, s3
M v[252:255], a[124:127], v[44:47], v[252:255]
s_waitcnt lgkmcnt(6)
M a[100:103], a[112:115], v[36:39], a[100:103]
M a[100:103], a[112:115], v[68:71], a[100:103]
M a[64:67], a[132:135], v[32:35], a[64:67]
s_lshl_b32 s26, s28, 7
M a[64:67], a[136:139], v[64:67], a[64:67]
ds_read_b128 a[164:167], v5 offset:34816
ds_read_b128 a[168:171], v5 offset:43008
M a[68:71], a[136:139], v[68:71], a[68:71]
s_lshl_b32 s42, s101, 11
M a[68:71], a[132:135], v[36:39], a[68:71]
M a[72:75], a[132:135], v[40:43], a[72:75]
s_add_u32 s44, s4, 83886080
s_addc_u32 s45, s5, 0
M a[72:75], a[136:139], v[72:75], a[72:75]
s_mov_b32 s46, 4194304
M a[76:79], a[136:139], v[76:79], a[76:79]
M a[76:79], a[132:135], v[44:47], a[76:79]
s_waitcnt lgkmcnt(6)
s_mov_b32 s47, 0x00020000
M a[104:107], a[112:115], v[40:43], a[104:107]
M a[104:107], a[112:115], v[72:75], a[104:107]
M a[80:83], a[140:143], v[32:35], a[80:83]
M a[80:83], a[144:147], v[64:67], a[80:83]
ds_read_b128 a[172:175], v5 offset:35840
ds_read_b128 a[176:179], v5 offset:44032
s_mov_b32 s50, 2097152
M a[84:87], a[144:147], v[68:71], a[84:87]
M a[84:87], a[140:143], v[36:39], a[84:87]
s_mov_b32 s51, 0x00020000
M a[88:91], a[140:143], v[40:43], a[88:91]
M a[88:91], a[144:147], v[72:75], a[88:91]
s_lshl_b32 s3, s101, 4
M a[92:95], a[144:147], v[76:79], a[92:95]
M a[92:95], a[140:143], v[44:47], a[92:95]
s_waitcnt lgkmcnt(6)
v_lshrrev_b32 v96, 3, v0
M a[108:111], a[112:115], v[44:47], a[108:111]
M a[108:111], a[112:115], v[76:79], a[108:111]
M v[160:163], a[148:151], v[32:35], v[160:163]
v_and_b32 v97, 6, v96
M v[160:163], a[152:155], v[64:67], v[160:163]
M v[164:167], a[152:155], v[68:71], v[164:167]
ds_write_b128 v2, v[224:227] offset:0
v_and_b32 v98, 7, v0
M v[164:167], a[148:151], v[36:39], v[164:167]
M v[168:171], a[148:151], v[40:43], v[168:171]
ds_write_b128 v2, v[228:231] offset:1024
v_xor_b32 v97, v97, v98
M v[168:171], a[152:155], v[72:75], v[168:171]
M v[172:175], a[152:155], v[76:79], v[172:175]
ds_write_b128 v2, v[232:235] offset:2048
v_add_u32 v96, s3, v96
M v[172:175], a[148:151], v[44:47], v[172:175]
s_waitcnt lgkmcnt(7)
M v[176:179], a[156:159], v[32:35], v[176:179]
ds_write_b128 v2, v[236:239] offset:3072
v_lshlrev_b32 v96, 11, v96
M v[176:179], a[160:163], v[64:67], v[176:179]
M v[180:183], a[160:163], v[68:71], v[180:183]
ds_write_b128 v2, v[240:243] offset:4096
v_lshl_add_u32 v99, v97, 4, v96
M v[180:183], a[156:159], v[36:39], v[180:183]
v_add_u32 v100, 15360, v99
M v[184:187], a[156:159], v[40:43], v[184:187]
ds_write_b128 v2, v[244:247] offset:5120
M v[184:187], a[160:163], v[72:75], v[184:187]
s_waitcnt vmcnt(0) lgkmcnt(0)
s_barrier
v_cmp_ne_u32 vcc, 1, v7
s_nop 0
s_cbranch_vccnz Lk3_spinb1
Lk3_gotb1:
M v[188:191], a[160:163], v[76:79], v[188:191]
ds_write_b128 v2, v[248:251] offset:6144
s_add_u32 m0, s42, 16384
s_nop 0
buffer_load_dwordx4 v99, s[48:51], s26 offen offset:0 lds
buffer_load_dwordx4 v100, s[48:51], s26 offen offset:1024 lds
M v[188:191], a[156:159], v[44:47], v[188:191]
buffer_load_dwordx4 a[192:195], v1, s[44:47], s25 offen offset:0 sc1
buffer_load_dwordx4 a[196:199], v1, s[44:47], s25 offen offset:1024 sc1
M v[192:195], a[164:167], v[32:35], v[192:195]
ds_write_b128 v2, v[252:255] offset:7168
buffer_load_dwordx4 a[200:203], v1, s[44:47], s25 offen offset:2048 sc1
buffer_load_dwordx4 a[204:207], v1, s[44:47], s25 offen offset:3072 sc1
M v[192:195], a[168:171], v[64:67], v[192:195]
s_add_u32 s25, s25, 16384
s_add_u32 s26, s26, 131072
s_add_u32 m0, s42, 32768
s_nop 0
buffer_load_dwordx4 v99, s[48:51], s26 offen offset:0 lds
M v[196:199], a[168:171], v[68:71], v[196:199]
ds_write_b128 v2, a[64:67] offset:8192
buffer_load_dwordx4 v100, s[48:51], s26 offen offset:1024 lds
buffer_load_dwordx4 a[208:211], v1, s[44:47], s25 offen offset:0 sc1
M v[196:199], a[164:167], v[36:39], v[196:199]
buffer_load_dwordx4 a[212:215], v1, s[44:47], s25 offen offset:1024 sc1
buffer_load_dwordx4 a[216:219], v1, s[44:47], s25 offen offset:2048 sc1
M v[200:203], a[164:167], v[40:43], v[200:203]
ds_write_b128 v2, a[68:71] offset:9216
buffer_load_dwordx4 a[220:223], v1, s[44:47], s25 offen offset:3072 sc1
s_add_u32 s25, s25, 16384
s_add_u32 s26, s26, 131072
M v[200:203], a[168:171], v[72:75], v[200:203]
s_add_u32 m0, s42, 49152
s_nop 0
buffer_load_dwordx4 v99, s[48:51], s26 offen offset:0 lds
buffer_load_dwordx4 v100, s[48:51], s26 offen offset:1024 lds
M v[204:207], a[168:171], v[76:79], v[204:207]
ds_write_b128 v2, a[72:75] offset:10240
buffer_load_dwordx4 a[224:227], v1, s[44:47], s25 offen offset:0 sc1
M v[204:207], a[164:167], v[44:47], v[204:207]
buffer_load_dwordx4 a[228:231], v1, s[44:47], s25 offen offset:1024 sc1
buffer_load_dwordx4 a[232:235], v1, s[44:47], s25 offen offset:2048 sc1
M v[208:211], a[172:175], v[32:35], v[208:211]
ds_write_b128 v2, a[76:79] offset:11264
buffer_load_dwordx4 a[236:239], v1, s[44:47], s25 offen offset:3072 sc1
s_add_u32 s25, s25, 16384
s_add_u32 s26, s26, 131072
M v[208:211], a[176:179], v[64:67], v[208:211]
s_add_u32 m0, s42, 65536
s_nop 0
buffer_load_dwordx4 v99, s[48:51], s26 offen offset:0 lds
buffer_load_dwordx4 v100, s[48:51], s26 offen offset:1024 lds
M v[212:215], a[176:179], v[68:71], v[212:215]
ds_write_b128 v2, a[80:83] offset:12288
buffer_load_dwordx4 a[240:243], v1, s[44:47], s25 offen offset:0 sc1
buffer_load_dwordx4 a[244:247], v1, s[44:47], s25 offen offset:1024 sc1
M v[212:215], a[172:175], v[36:39], v[212:215]
buffer_load_dwordx4 a[248:251], v1, s[44:47], s25 offen offset:2048 sc1
buffer_load_dwordx4 a[252:255], v1, s[44:47], s25 offen offset:3072 sc1
M v[216:219], a[172:175], v[40:43], v[216:219]
ds_write_b128 v2, a[84:87] offset:13312
s_add_u32 s25, s25, 16384
s_add_u32 s26, s26, 131072
s_add_u32 m0, s42, 81920
s_nop 0
buffer_load_dwordx4 v99, s[48:51], s26 offen offset:0 lds
M v[216:219], a[176:179], v[72:75], v[216:219]
buffer_load_dwordx4 v100, s[48:51], s26 offen offset:1024 lds
buffer_load_dwordx4 a[128:131], v1, s[44:47], s25 offen offset:0 sc1
M v[220:223], a[176:179], v[76:79], v[220:223]
ds_write_b128 v2, a[88:91] offset:14336
buffer_load_dwordx4 a[132:135], v1, s[44:47], s25 offen offset:1024 sc1
buffer_load_dwordx4 a[136:139], v1, s[44:47], s25 offen offset:2048 sc1
M v[220:223], a[172:175], v[44:47], v[220:223]
buffer_load_dwordx4 a[140:143], v1, s[44:47], s25 offen offset:3072 sc1
s_add_u32 s25, s25, 16384
s_add_u32 s26, s26, 131072
ds_write_b128 v2, a[92:95] offset:15360
s_waitcnt lgkmcnt(0)
Lk2_merge:
s_lshl_b32 s33, s22, 10
s_add_u32 s33, s33, 28672
s_xor_b32 s34, s33, 2048
v_add_u32 v14, s33, v1
v_add_u32 v15, s34, v1
v_accvgpr_read_b32 v20, a96
v_accvgpr_read_b32 v21, a100
v_accvgpr_read_b32 v22, a104
v_accvgpr_read_b32 v23, a108
ds_write_b128 v14, v[20:23]
s_waitcnt lgkmcnt(0)
s_barrier
ds_read_b128 v[28:31], v15
ds_read_b128 v[32:35], v3 offset:0
ds_read_b128 v[36:39], v3 offset:1024
ds_read_b128 v[40:43], v3 offset:2048
ds_read_b128 v[44:47], v3 offset:3072
ds_read_b128 v[48:51], v3 offset:4096
ds_read_b128 v[52:55], v3 offset:5120
ds_read_b128 v[56:59], v3 offset:6144
ds_read_b128 v[60:63], v3 offset:7168
ds_read_b128 v[64:67], v3 offset:8192
ds_read_b128 v[68:71], v3 offset:9216
ds_read_b128 v[72:75], v3 offset:10240
ds_read_b128 v[76:79], v3 offset:11264
ds_read_b128 v[80:83], v3 offset:12288
ds_read_b128 v[84:87], v3 offset:13312
ds_read_b128 v[88:91], v3 offset:14336
ds_read_b128 v[92:95], v3 offset:15360
s_waitcnt lgkmcnt(15)
v_add_f32 v20, v20, v28
v_add_f32 v21, v21, v29
v_add_f32 v22, v22, v30
v_add_f32 v23, v23, v31
s_sub_u32 s35, 15, s21
v_rcp_f32 v8, v20
v_rcp_f32 v9, v21
v_rcp_f32 v10, v22
v_rcp_f32 v11, v23
v_subrev_u32 v20, 0x21800000, v20
v_subrev_u32 v21, 0x21800000, v21
v_subrev_u32 v22, 0x21800000, v22
v_subrev_u32 v23, 0x21800000, v23
v_max_u32 v12, v20, v21
v_max3_u32 v12, v12, v22, v23
s_mov_b32 s64, 0x207
s_lshl_b32 s33, s35, 20
s_lshl_b32 s34, s20, 15
s_add_u32 s33, s33, s34
s_lshl_b32 s34, s23, 13
s_add_u32 s36, s33, s34
s_add_u32 s37, s36, 4096
s_add_u32 s38, s36, 16384
s_add_u32 s39, s36, 20480
v_pk_add_f32 v[160:161], v[160:161], v[32:33]
v_pk_add_f32 v[162:163], v[162:163], v[34:35]
s_waitcnt lgkmcnt(11)
v_pk_add_f32 v[176:177], v[176:177], v[48:49]
v_pk_add_f32 v[178:179], v[178:179], v[50:51]
v_pk_mul_f32 v[160:161], v[160:161], v[8:9] op_sel:[0,0] op_sel_hi:[1,0]
v_pk_mul_f32 v[162:163], v[162:163], v[8:9] op_sel:[0,0] op_sel_hi:[1,0]
v_pk_mul_f32 v[176:177], v[176:177], v[8:9] op_sel:[0,0] op_sel_hi:[1,0]
v_pk_mul_f32 v[178:179], v[178:179], v[8:9] op_sel:[0,0] op_sel_hi:[1,0]
v_cvt_pk_bf16_f32 v160, v160, v161
v_cvt_pk_bf16_f32 v161, v162, v163
v_cvt_pk_bf16_f32 v162, v176, v177
v_cvt_pk_bf16_f32 v163, v178, v179
v_pk_add_f32 v[164:165], v[164:165], v[36:37]
v_pk_add_f32 v[166:167], v[166:167], v[38:39]
s_waitcnt lgkmcnt(10)
v_pk_add_f32 v[180:181], v[180:181], v[52:53]
v_pk_add_f32 v[182:183], v[182:183], v[54:55]
M v[24:27], a[112:115], v[160:163], 0
buffer_store_dwordx4 v[160:163], v1, s[16:19], s36 offen offset:0 sc1
v_pk_mul_f32 v[164:165], v[164:165], v[8:9] op_sel:[0,1] op_sel_hi:[1,1]
v_pk_mul_f32 v[166:167], v[166:167], v[8:9] op_sel:[0,1] op_sel_hi:[1,1]
v_pk_mul_f32 v[180:181], v[180:181], v[8:9] op_sel:[0,1] op_sel_hi:[1,1]
v_pk_mul_f32 v[182:183], v[182:183], v[8:9] op_sel:[0,1] op_sel_hi:[1,1]
v_cvt_pk_bf16_f32 v164, v164, v165
v_cvt_pk_bf16_f32 v165, v166, v167
v_cvt_pk_bf16_f32 v166, v180, v181
v_cvt_pk_bf16_f32 v167, v182, v183
v_pk_add_f32 v[168:169], v[168:169], v[40:41]
v_pk_add_f32 v[170:171], v[170:171], v[42:43]
s_waitcnt lgkmcnt(9)
v_pk_add_f32 v[184:185], v[184:185], v[56:57]
v_pk_add_f32 v[186:187], v[186:187], v[58:59]
M v[24:27], a[112:115], v[164:167], v[24:27]
buffer_store_dwordx4 v[164:167], v1, s[16:19], s36 offen offset:2048 sc1
v_pk_mul_f32 v[168:169], v[168:169], v[10:11] op_sel:[0,0] op_sel_hi:[1,0]
v_pk_mul_f32 v[170:171], v[170:171], v[10:11] op_sel:[0,0] op_sel_hi:[1,0]
v_pk_mul_f32 v[184:185], v[184:185], v[10:11] op_sel:[0,0] op_sel_hi:[1,0]
v_pk_mul_f32 v[186:187], v[186:187], v[10:11] op_sel:[0,0] op_sel_hi:[1,0]
v_cvt_pk_bf16_f32 v168, v168, v169
v_cvt_pk_bf16_f32 v169, v170, v171
v_cvt_pk_bf16_f32 v170, v184, v185
v_cvt_pk_bf16_f32 v171, v186, v187
v_pk_add_f32 v[172:173], v[172:173], v[44:45]
v_pk_add_f32 v[174:175], v[174:175], v[46:47]
s_waitcnt lgkmcnt(8)
v_pk_add_f32 v[188:189], v[188:189], v[60:61]
v_pk_add_f32 v[190:191], v[190:191], v[62:63]
M v[24:27], a[112:115], v[168:171], v[24:27]
buffer_store_dwordx4 v[168:171], v1, s[16:19], s37 offen offset:0 sc1
v_pk_mul_f32 v[172:173], v[172:173], v[10:11] op_sel:[0,1] op_sel_hi:[1,1]
v_pk_mul_f32 v[174:175], v[174:175], v[10:11] op_sel:[0,1] op_sel_hi:[1,1]
v_pk_mul_f32 v[188:189], v[188:189], v[10:11] op_sel:[0,1] op_sel_hi:[1,1]
v_pk_mul_f32 v[190:191], v[190:191], v[10:11] op_sel:[0,1] op_sel_hi:[1,1]
v_cvt_pk_bf16_f32 v172, v172, v173
v_cvt_pk_bf16_f32 v173, v174, v175
v_cvt_pk_bf16_f32 v174, v188, v189
v_cvt_pk_bf16_f32 v175, v190, v191
s_waitcnt lgkmcnt(7)
v_pk_add_f32 v[192:193], v[192:193], v[64:65]
v_pk_add_f32 v[194:195], v[194:195], v[66:67]
s_waitcnt lgkmcnt(3)
v_pk_add_f32 v[208:209], v[208:209], v[80:81]
v_pk_add_f32 v[210:211], v[210:211], v[82:83]
M v[24:27], a[112:115], v[172:175], v[24:27]
buffer_store_dwordx4 v[172:175], v1, s[16:19], s37 offen offset:2048 sc1
v_pk_mul_f32 v[192:193], v[192:193], v[8:9] op_sel:[0,0] op_sel_hi:[1,0]
v_pk_mul_f32 v[194:195], v[194:195], v[8:9] op_sel:[0,0] op_sel_hi:[1,0]
v_pk_mul_f32 v[208:209], v[208:209], v[8:9] op_sel:[0,0] op_sel_hi:[1,0]
v_pk_mul_f32 v[210:211], v[210:211], v[8:9] op_sel:[0,0] op_sel_hi:[1,0]
v_cvt_pk_bf16_f32 v192, v192, v193
v_cvt_pk_bf16_f32 v193, v194, v195
v_cvt_pk_bf16_f32 v194, v208, v209
v_cvt_pk_bf16_f32 v195, v210, v211
v_pk_add_f32 v[196:197], v[196:197], v[68:69]
v_pk_add_f32 v[198:199], v[198:199], v[70:71]
s_waitcnt lgkmcnt(2)
v_pk_add_f32 v[212:213], v[212:213], v[84:85]
v_pk_add_f32 v[214:215], v[214:215], v[86:87]
M v[24:27], a[112:115], v[192:195], v[24:27]
buffer_store_dwordx4 v[192:195], v1, s[16:19], s36 offen offset:1024 sc1
v_pk_mul_f32 v[196:197], v[196:197], v[8:9] op_sel:[0,1] op_sel_hi:[1,1]
v_pk_mul_f32 v[198:199], v[198:199], v[8:9] op_sel:[0,1] op_sel_hi:[1,1]
v_pk_mul_f32 v[212:213], v[212:213], v[8:9] op_sel:[0,1] op_sel_hi:[1,1]
v_pk_mul_f32 v[214:215], v[214:215], v[8:9] op_sel:[0,1] op_sel_hi:[1,1]
v_cvt_pk_bf16_f32 v196, v196, v197
v_cvt_pk_bf16_f32 v197, v198, v199
v_cvt_pk_bf16_f32 v198, v212, v213
v_cvt_pk_bf16_f32 v199, v214, v215
v_pk_add_f32 v[200:201], v[200:201], v[72:73]
v_pk_add_f32 v[202:203], v[202:203], v[74:75]
s_waitcnt lgkmcnt(1)
v_pk_add_f32 v[216:217], v[216:217], v[88:89]
v_pk_add_f32 v[218:219], v[218:219], v[90:91]
M v[24:27], a[112:115], v[196:199], v[24:27]
buffer_store_dwordx4 v[196:199], v1, s[16:19], s36 offen offset:3072 sc1
v_pk_mul_f32 v[200:201], v[200:201], v[10:11] op_sel:[0,0] op_sel_hi:[1,0]
v_pk_mul_f32 v[202:203], v[202:203], v[10:11] op_sel:[0,0] op_sel_hi:[1,0]
v_pk_mul_f32 v[216:217], v[216:217], v[10:11] op_sel:[0,0] op_sel_hi:[1,0]
v_pk_mul_f32 v[218:219], v[218:219], v[10:11] op_sel:[0,0] op_sel_hi:[1,0]
v_cvt_pk_bf16_f32 v200, v200, v201
v_cvt_pk_bf16_f32 v201, v202, v203
v_cvt_pk_bf16_f32 v202, v216, v217
v_cvt_pk_bf16_f32 v203, v218, v219
v_pk_add_f32 v[204:205], v[204:205], v[76:77]
v_pk_add_f32 v[206:207], v[206:207], v[78:79]
s_waitcnt lgkmcnt(0)
v_pk_add_f32 v[220:221], v[220:221], v[92:93]
v_pk_add_f32 v[222:223], v[222:223], v[94:95]
M v[24:27], a[112:115], v[200:203], v[24:27]
buffer_store_dwordx4 v[200:203], v1, s[16:19], s37 offen offset:1024 sc1
v_pk_mul_f32 v[204:205], v[204:205], v[10:11] op_sel:[0,1] op_sel_hi:[1,1]
v_pk_mul_f32 v[206:207], v[206:207], v[10:11] op_sel:[0,1] op_sel_hi:[1,1]
v_pk_mul_f32 v[220:221], v[220:221], v[10:11] op_sel:[0,1] op_sel_hi:[1,1]
v_pk_mul_f32 v[222:223], v[222:223], v[10:11] op_sel:[0,1] op_sel_hi:[1,1]
v_cvt_pk_bf16_f32 v204, v204, v205
v_cvt_pk_bf16_f32 v205, v206, v207
v_cvt_pk_bf16_f32 v206, v220, v221
v_cvt_pk_bf16_f32 v207, v222, v223
s_nop 1
M v[24:27], a[112:115], v[204:207], v[24:27]
buffer_store_dwordx4 v[204:207], v1, s[16:19], s37 offen offset:3072 sc1
v_cmp_lt_u32 vcc, 0x3c000000, v12
s_nop 5
v_cmp_class_f32 s[40:41], v24, s64
s_nop 0
s_or_b64 vcc, vcc, s[40:41]
s_cmp_lg_u64 vcc, 0
s_cselect_b32 s33, 2, 0
s_or_b32 s60, s60, s33
s_branch Lk2_chk
Lk2_wm:
s_lshl_b32 s33, s2, 1
s_add_u32 s33, s33, s23
s_lshl_b32 s34, s33, 12
s_lshl_b32 s33, s33, 14
v_lshlrev_b32 v8, 3, v1
v_lshlrev_b32 v9, 2, v1
buffer_load_dword a244, v8, s[44:47], s33 offen
s_add_u32 s33, s33, 8192
buffer_load_dword a245, v8, s[44:47], s33 offen
buffer_load_dword a246, v9, s[48:51], s34 offen
s_branch Lk2_l3b
Lk2_g1:
s_mov_b32 s30, 7
s_bfe_u32 s65, s2, 0x20003
s_add_u32 s65, s65, 2
s_lshl_b32 s42, s21, 1
s_min_u32 s42, s42, 13
s_add_u32 s42, s42, 2
s_sub_u32 s33, s42, 1
s_cmp_le_u32 s33, 1
s_cselect_b32 s33, 0x4000, 0
v_add_u32 v3, s33, v3
s_sub_u32 s42, s42, 1
Lk2_l3:
s_cmp_eq_u32 s30, s65
s_cbranch_scc1 Lk2_wm
Lk2_l3b:
s_add_u32 m0, s29, 65536
s_waitcnt lgkmcnt(4)
M v[96:99], a[116:119], a[0:3], 0
v_exp_f32 v64, v64
M v[96:99], a[120:123], a[4:7], v[96:99]
ds_read_b128 a[148:151], v2 offset:8192
ds_read_b128 a[152:155], v2 offset:9216
M v[96:99], a[124:127], a[8:11], v[96:99]
v_exp_f32 v65, v65
M v[96:99], a[128:131], a[12:15], v[96:99]
buffer_load_dwordx4 v1, s[12:15], s25 offen offset:0 sc1 lds
s_add_u32 s32, s25, 4096
M v[100:103], a[128:131], a[28:31], 0
v_exp_f32 v66, v66
M v[100:103], a[124:127], a[24:27], v[100:103]
v_cvt_pk_bf16_f32 v64, v64, v65
M v[100:103], a[120:123], a[20:23], v[100:103]
v_exp_f32 v67, v67
M v[100:103], a[116:119], a[16:19], v[100:103]
buffer_load_dwordx4 v1, s[12:15], s25 offen offset:1024 sc1 lds
M v[104:107], a[116:119], a[32:35], 0
v_exp_f32 v80, v80
M v[104:107], a[120:123], a[36:39], v[104:107]
ds_read_b128 a[156:159], v2 offset:10240
ds_read_b128 a[160:163], v2 offset:11264
M v[104:107], a[124:127], a[40:43], v[104:107]
v_exp_f32 v81, v81
M v[104:107], a[128:131], a[44:47], v[104:107]
buffer_load_dwordx4 v1, s[12:15], s25 offen offset:2048 sc1 lds
M v[108:111], a[128:131], a[60:63], 0
v_exp_f32 v82, v82
M v[108:111], a[124:127], a[56:59], v[108:111]
v_cvt_pk_bf16_f32 v65, v66, v67
v_cvt_pk_bf16_f32 v66, v80, v81
M v[108:111], a[120:123], a[52:55], v[108:111]
v_exp_f32 v83, v83
M v[108:111], a[116:119], a[48:51], v[108:111]
buffer_load_dwordx4 v1, s[12:15], s25 offen offset:3072 sc1 lds
s_add_u32 m0, s29, 69632
s_waitcnt lgkmcnt(4)
M v[112:115], a[132:135], a[0:3], 0
v_exp_f32 v68, v68
M v[112:115], a[136:139], a[4:7], v[112:115]
ds_read_b128 a[164:167], v2 offset:12288
ds_read_b128 a[168:171], v2 offset:13312
M v[112:115], a[140:143], a[8:11], v[112:115]
v_exp_f32 v69, v69
M v[112:115], a[144:147], a[12:15], v[112:115]
buffer_load_dwordx4 v1, s[12:15], s32 offen offset:0 sc1 lds
M v[116:119], a[144:147], a[28:31], 0
v_exp_f32 v70, v70
M v[116:119], a[140:143], a[24:27], v[116:119]
v_cvt_pk_bf16_f32 v67, v82, v83
v_cvt_pk_bf16_f32 v68, v68, v69
M v[116:119], a[136:139], a[20:23], v[116:119]
v_exp_f32 v71, v71
M v[116:119], a[132:135], a[16:19], v[116:119]
buffer_load_dwordx4 v1, s[12:15], s32 offen offset:1024 sc1 lds
M v[120:123], a[132:135], a[32:35], 0
v_exp_f32 v84, v84
M v[120:123], a[136:139], a[36:39], v[120:123]
ds_read_b128 a[172:175], v2 offset:14336
ds_read_b128 a[176:179], v2 offset:15360
M v[120:123], a[140:143], a[40:43], v[120:123]
v_exp_f32 v85, v85
M v[120:123], a[144:147], a[44:47], v[120:123]
buffer_load_dwordx4 v1, s[12:15], s32 offen offset:2048 sc1 lds
M v[124:127], a[144:147], a[60:63], 0
v_exp_f32 v86, v86
M v[124:127], a[140:143], a[56:59], v[124:127]
v_cvt_pk_bf16_f32 v69, v70, v71
v_cvt_pk_bf16_f32 v70, v84, v85
M v[124:127], a[136:139], a[52:55], v[124:127]
v_exp_f32 v87, v87
M v[124:127], a[132:135], a[48:51], v[124:127]
buffer_load_dwordx4 v1, s[12:15], s32 offen offset:3072 sc1 lds
s_add_u32 m0, s29, 98304
s_waitcnt lgkmcnt(4)
M v[128:131], a[148:151], a[0:3], 0
v_exp_f32 v72, v72
M v[128:131], a[152:155], a[4:7], v[128:131]
ds_read_b128 a[116:119], v5 offset:32768
ds_read_b128 a[120:123], v5 offset:40960
M v[128:131], a[156:159], a[8:11], v[128:131]
v_exp_f32 v73, v73
M v[128:131], a[160:163], a[12:15], v[128:131]
buffer_load_dwordx4 v1, s[12:15], s26 offen offset:0 sc1 lds
s_add_u32 s43, s26, 4096
M v[132:135], a[160:163], a[28:31], 0
v_exp_f32 v74, v74
M v[132:135], a[156:159], a[24:27], v[132:135]
v_cvt_pk_bf16_f32 v71, v86, v87
v_cvt_pk_bf16_f32 v72, v72, v73
M v[132:135], a[152:155], a[20:23], v[132:135]
v_exp_f32 v75, v75
M v[132:135], a[148:151], a[16:19], v[132:135]
buffer_load_dwordx4 v1, s[12:15], s26 offen offset:1024 sc1 lds
M v[136:139], a[148:151], a[32:35], 0
v_exp_f32 v88, v88
M v[136:139], a[152:155], a[36:39], v[136:139]
ds_read_b128 a[124:127], v5 offset:33792
ds_read_b128 a[128:131], v5 offset:41984
M v[136:139], a[156:159], a[40:43], v[136:139]
v_exp_f32 v89, v89
M v[136:139], a[160:163], a[44:47], v[136:139]
buffer_load_dwordx4 v1, s[12:15], s26 offen offset:2048 sc1 lds
M v[140:143], a[160:163], a[60:63], 0
v_exp_f32 v90, v90
M v[140:143], a[156:159], a[56:59], v[140:143]
v_cvt_pk_bf16_f32 v73, v74, v75
v_cvt_pk_bf16_f32 v74, v88, v89
M v[140:143], a[152:155], a[52:55], v[140:143]
v_exp_f32 v91, v91
M v[140:143], a[148:151], a[48:51], v[140:143]
buffer_load_dwordx4 v1, s[12:15], s26 offen offset:3072 sc1 lds
s_add_u32 m0, s29, 102400
s_waitcnt lgkmcnt(4)
M v[144:147], a[164:167], a[0:3], 0
v_exp_f32 v76, v76
M v[144:147], a[168:171], a[4:7], v[144:147]
ds_read_b128 a[132:135], v5 offset:34816
ds_read_b128 a[136:139], v5 offset:43008
M v[144:147], a[172:175], a[8:11], v[144:147]
v_exp_f32 v77, v77
M v[144:147], a[176:179], a[12:15], v[144:147]
buffer_load_dwordx4 v1, s[12:15], s43 offen offset:0 sc1 lds
M v[148:151], a[176:179], a[28:31], 0
v_exp_f32 v78, v78
M v[148:151], a[172:175], a[24:27], v[148:151]
v_cvt_pk_bf16_f32 v75, v90, v91
v_cvt_pk_bf16_f32 v76, v76, v77
M v[148:151], a[168:171], a[20:23], v[148:151]
v_exp_f32 v79, v79
M v[148:151], a[164:167], a[16:19], v[148:151]
buffer_load_dwordx4 v1, s[12:15], s43 offen offset:1024 sc1 lds
M v[152:155], a[164:167], a[32:35], 0
v_exp_f32 v92, v92
M v[152:155], a[168:171], a[36:39], v[152:155]
ds_read_b128 a[140:143], v5 offset:35840
ds_read_b128 a[144:147], v5 offset:44032
M v[152:155], a[172:175], a[40:43], v[152:155]
v_exp_f32 v93, v93
M v[152:155], a[176:179], a[44:47], v[152:155]
buffer_load_dwordx4 v1, s[12:15], s43 offen offset:2048 sc1 lds
M v[156:159], a[176:179], a[60:63], 0
v_exp_f32 v94, v94
M v[156:159], a[172:175], a[56:59], v[156:159]
v_cvt_pk_bf16_f32 v77, v78, v79
v_cvt_pk_bf16_f32 v78, v92, v93
M v[156:159], a[168:171], a[52:55], v[156:159]
v_exp_f32 v95, v95
M v[156:159], a[164:167], a[48:51], v[156:159]
buffer_load_dwordx4 v1, s[12:15], s43 offen offset:3072 sc1 lds
v_cvt_pk_bf16_f32 v79, v94, v95
s_waitcnt lgkmcnt(6)
M v[160:163], a[116:119], v[32:35], v[160:163]
v_exp_f32 v96, v96
M v[160:163], a[120:123], v[64:67], v[160:163]
ds_read_b128 a[148:151], v5 offset:36864
ds_read_b128 a[152:155], v5 offset:45056
M v[164:167], a[120:123], v[68:71], v[164:167]
v_exp_f32 v97, v97
M v[164:167], a[116:119], v[36:39], v[164:167]
v_cvt_pk_bf16_f32 v96, v96, v97
M v[168:171], a[116:119], v[40:43], v[168:171]
v_exp_f32 v98, v98
M v[168:171], a[120:123], v[72:75], v[168:171]
s_add_u32 s25, s25, 32768
s_cmp_eq_u32 s25, s27
M v[172:175], a[120:123], v[76:79], v[172:175]
v_exp_f32 v99, v99
M v[172:175], a[116:119], v[44:47], v[172:175]
v_cvt_pk_bf16_f32 v97, v98, v99
s_waitcnt lgkmcnt(6)
M a[96:99], a[112:115], v[32:35], a[96:99]
s_cselect_b32 s25, s28, s25
s_cselect_b32 s27, s56, s27
M a[96:99], a[112:115], v[64:67], a[96:99]
s_cselect_b32 s28, s57, s28
s_cselect_b32 s56, -1, s56
M v[176:179], a[124:127], v[32:35], v[176:179]
v_exp_f32 v112, v112
M v[176:179], a[128:131], v[64:67], v[176:179]
ds_read_b128 a[156:159], v5 offset:37888
ds_read_b128 a[160:163], v5 offset:46080
M v[180:183], a[128:131], v[68:71], v[180:183]
v_exp_f32 v113, v113
M v[180:183], a[124:127], v[36:39], v[180:183]
v_cvt_pk_bf16_f32 v98, v112, v113
M v[184:187], a[124:127], v[40:43], v[184:187]
v_exp_f32 v114, v114
M v[184:187], a[128:131], v[72:75], v[184:187]
s_add_u32 s26, s26, 32768
s_cmp_eq_u32 s26, s62
M v[188:191], a[128:131], v[76:79], v[188:191]
v_exp_f32 v115, v115
M v[188:191], a[124:127], v[44:47], v[188:191]
v_cvt_pk_bf16_f32 v99, v114, v115
s_waitcnt lgkmcnt(6)
M a[100:103], a[112:115], v[36:39], a[100:103]
s_cselect_b32 s26, s63, s26
s_cselect_b32 s62, s58, s62
M a[100:103], a[112:115], v[68:71], a[100:103]
s_cselect_b32 s63, s59, s63
s_cselect_b32 s58, -1, s58
M v[192:195], a[132:135], v[32:35], v[192:195]
v_exp_f32 v100, v100
M v[192:195], a[136:139], v[64:67], v[192:195]
ds_read_b128 a[164:167], v5 offset:38912
ds_read_b128 a[168:171], v5 offset:47104
M v[196:199], a[136:139], v[68:71], v[196:199]
v_exp_f32 v101, v101
M v[196:199], a[132:135], v[36:39], v[196:199]
v_cvt_pk_bf16_f32 v100, v100, v101
M v[200:203], a[132:135], v[40:43], v[200:203]
v_exp_f32 v102, v102
M v[200:203], a[136:139], v[72:75], v[200:203]
s_sub_u32 s33, s42, 1
s_cmp_le_u32 s33, 1
s_cselect_b32 s33, 0x4000, 0
v_add_u32 v2, s33, v2
M v[204:207], a[136:139], v[76:79], v[204:207]
v_exp_f32 v103, v103
M v[204:207], a[132:135], v[44:47], v[204:207]
v_cvt_pk_bf16_f32 v101, v102, v103
s_waitcnt lgkmcnt(6)
M a[104:107], a[112:115], v[40:43], a[104:107]
M a[104:107], a[112:115], v[72:75], a[104:107]
M v[208:211], a[140:143], v[32:35], v[208:211]
v_exp_f32 v116, v116
M v[208:211], a[144:147], v[64:67], v[208:211]
ds_read_b128 a[172:175], v5 offset:39936
ds_read_b128 a[176:179], v5 offset:48128
M v[212:215], a[144:147], v[68:71], v[212:215]
v_exp_f32 v117, v117
M v[212:215], a[140:143], v[36:39], v[212:215]
v_cvt_pk_bf16_f32 v102, v116, v117
M v[216:219], a[140:143], v[40:43], v[216:219]
v_exp_f32 v118, v118
M v[216:219], a[144:147], v[72:75], v[216:219]
M v[220:223], a[144:147], v[76:79], v[220:223]
v_exp_f32 v119, v119
M v[220:223], a[140:143], v[44:47], v[220:223]
v_cvt_pk_bf16_f32 v103, v118, v119
s_waitcnt lgkmcnt(6)
M a[108:111], a[112:115], v[44:47], a[108:111]
M a[108:111], a[112:115], v[76:79], a[108:111]
M v[224:227], a[148:151], v[32:35], v[224:227]
v_exp_f32 v104, v104
M v[224:227], a[152:155], v[64:67], v[224:227]
s_cmp_le_u32 s42, 1
s_cselect_b32 s33, 0x4000, 0
v_add_u32 v5, s33, v5
s_sub_u32 s42, s42, 1
M v[228:231], a[152:155], v[68:71], v[228:231]
v_exp_f32 v105, v105
M v[228:231], a[148:151], v[36:39], v[228:231]
v_cvt_pk_bf16_f32 v104, v104, v105
M v[232:235], a[148:151], v[40:43], v[232:235]
v_exp_f32 v106, v106
M v[232:235], a[152:155], v[72:75], v[232:235]
M v[236:239], a[152:155], v[76:79], v[236:239]
v_exp_f32 v107, v107
M v[236:239], a[148:151], v[44:47], v[236:239]
v_cvt_pk_bf16_f32 v105, v106, v107
s_waitcnt lgkmcnt(4)
M v[240:243], a[156:159], v[32:35], v[240:243]
v_exp_f32 v120, v120
M v[240:243], a[160:163], v[64:67], v[240:243]
M v[244:247], a[160:163], v[68:71], v[244:247]
v_exp_f32 v121, v121
M v[244:247], a[156:159], v[36:39], v[244:247]
v_cvt_pk_bf16_f32 v106, v120, v121
M v[248:251], a[156:159], v[40:43], v[248:251]
v_exp_f32 v122, v122
M v[248:251], a[160:163], v[72:75], v[248:251]
s_waitcnt vmcnt(0) lgkmcnt(0)
s_barrier
ds_read_b128 a[116:119], v3 offset:0
ds_read_b128 a[120:123], v3 offset:1024
M v[252:255], a[160:163], v[76:79], v[252:255]
v_exp_f32 v123, v123
M v[252:255], a[156:159], v[44:47], v[252:255]
v_cvt_pk_bf16_f32 v107, v122, v123
M a[64:67], a[164:167], v[32:35], a[64:67]
v_exp_f32 v108, v108
M a[64:67], a[168:171], v[64:67], a[64:67]
ds_read_b128 a[124:127], v3 offset:2048
ds_read_b128 a[128:131], v3 offset:3072
M a[68:71], a[168:171], v[68:71], a[68:71]
v_exp_f32 v109, v109
M a[68:71], a[164:167], v[36:39], a[68:71]
v_cvt_pk_bf16_f32 v108, v108, v109
M a[72:75], a[164:167], v[40:43], a[72:75]
v_exp_f32 v110, v110
M a[72:75], a[168:171], v[72:75], a[72:75]
ds_read_b128 a[132:135], v3 offset:4096
ds_read_b128 a[136:139], v3 offset:5120
M a[76:79], a[168:171], v[76:79], a[76:79]
v_exp_f32 v111, v111
M a[76:79], a[164:167], v[44:47], a[76:79]
v_cvt_pk_bf16_f32 v109, v110, v111
M a[80:83], a[172:175], v[32:35], a[80:83]
v_exp_f32 v124, v124
M a[80:83], a[176:179], v[64:67], a[80:83]
ds_read_b128 a[140:143], v3 offset:6144
ds_read_b128 a[144:147], v3 offset:7168
M a[84:87], a[176:179], v[68:71], a[84:87]
v_exp_f32 v125, v125
M a[84:87], a[172:175], v[36:39], a[84:87]
v_cvt_pk_bf16_f32 v110, v124, v125
M a[88:91], a[172:175], v[40:43], a[88:91]
v_exp_f32 v126, v126
M a[88:91], a[176:179], v[72:75], a[88:91]
M a[92:95], a[176:179], v[76:79], a[92:95]
v_exp_f32 v127, v127
M a[92:95], a[172:175], v[44:47], a[92:95]
v_cvt_pk_bf16_f32 v111, v126, v127
s_add_u32 m0, s29, 0
s_waitcnt lgkmcnt(4)
M v[32:35], a[116:119], a[0:3], 0
v_exp_f32 v128, v128
M v[32:35], a[120:123], a[4:7], v[32:35]
ds_read_b128 a[148:151], v3 offset:8192
ds_read_b128 a[152:155], v3 offset:9216
M v[32:35], a[124:127], a[8:11], v[32:35]
v_exp_f32 v129, v129
M v[32:35], a[128:131], a[12:15], v[32:35]
buffer_load_dwordx4 v1, s[12:15], s25 offen offset:0 sc1 lds
s_add_u32 s32, s25, 4096
M v[36:39], a[128:131], a[28:31], 0
v_exp_f32 v130, v130
M v[36:39], a[124:127], a[24:27], v[36:39]
v_cvt_pk_bf16_f32 v128, v128, v129
M v[36:39], a[120:123], a[20:23], v[36:39]
v_exp_f32 v131, v131
M v[36:39], a[116:119], a[16:19], v[36:39]
buffer_load_dwordx4 v1, s[12:15], s25 offen offset:1024 sc1 lds
M v[40:43], a[116:119], a[32:35], 0
v_exp_f32 v144, v144
M v[40:43], a[120:123], a[36:39], v[40:43]
ds_read_b128 a[156:159], v3 offset:10240
ds_read_b128 a[160:163], v3 offset:11264
M v[40:43], a[124:127], a[40:43], v[40:43]
v_exp_f32 v145, v145
M v[40:43], a[128:131], a[44:47], v[40:43]
buffer_load_dwordx4 v1, s[12:15], s25 offen offset:2048 sc1 lds
M v[44:47], a[128:131], a[60:63], 0
v_exp_f32 v146, v146
M v[44:47], a[124:127], a[56:59], v[44:47]
v_cvt_pk_bf16_f32 v129, v130, v131
v_cvt_pk_bf16_f32 v130, v144, v145
M v[44:47], a[120:123], a[52:55], v[44:47]
v_exp_f32 v147, v147
M v[44:47], a[116:119], a[48:51], v[44:47]
buffer_load_dwordx4 v1, s[12:15], s25 offen offset:3072 sc1 lds
s_add_u32 m0, s29, 4096
s_waitcnt lgkmcnt(4)
M v[48:51], a[132:135], a[0:3], 0
v_exp_f32 v132, v132
M v[48:51], a[136:139], a[4:7], v[48:51]
ds_read_b128 a[164:167], v3 offset:12288
ds_read_b128 a[168:171], v3 offset:13312
M v[48:51], a[140:143], a[8:11], v[48:51]
v_exp_f32 v133, v133
M v[48:51], a[144:147], a[12:15], v[48:51]
buffer_load_dwordx4 v1, s[12:15], s32 offen offset:0 sc1 lds
M v[52:55], a[144:147], a[28:31], 0
v_exp_f32 v134, v134
M v[52:55], a[140:143], a[24:27], v[52:55]
v_cvt_pk_bf16_f32 v131, v146, v147
v_cvt_pk_bf16_f32 v132, v132, v133
M v[52:55], a[136:139], a[20:23], v[52:55]
v_exp_f32 v135, v135
M v[52:55], a[132:135], a[16:19], v[52:55]
buffer_load_dwordx4 v1, s[12:15], s32 offen offset:1024 sc1 lds
M v[56:59], a[132:135], a[32:35], 0
v_exp_f32 v148, v148
M v[56:59], a[136:139], a[36:39], v[56:59]
ds_read_b128 a[172:175], v3 offset:14336
ds_read_b128 a[176:179], v3 offset:15360
M v[56:59], a[140:143], a[40:43], v[56:59]
v_exp_f32 v149, v149
M v[56:59], a[144:147], a[44:47], v[56:59]
buffer_load_dwordx4 v1, s[12:15], s32 offen offset:2048 sc1 lds
M v[60:63], a[144:147], a[60:63], 0
v_exp_f32 v150, v150
M v[60:63], a[140:143], a[56:59], v[60:63]
v_cvt_pk_bf16_f32 v133, v134, v135
v_cvt_pk_bf16_f32 v134, v148, v149
M v[60:63], a[136:139], a[52:55], v[60:63]
v_exp_f32 v151, v151
M v[60:63], a[132:135], a[48:51], v[60:63]
buffer_load_dwordx4 v1, s[12:15], s32 offen offset:3072 sc1 lds
s_add_u32 m0, s29, 32768
s_waitcnt lgkmcnt(4)
M v[64:67], a[148:151], a[0:3], 0
v_exp_f32 v136, v136
M v[64:67], a[152:155], a[4:7], v[64:67]
ds_read_b128 a[116:119], v6 offset:32768
ds_read_b128 a[120:123], v6 offset:40960
M v[64:67], a[156:159], a[8:11], v[64:67]
v_exp_f32 v137, v137
M v[64:67], a[160:163], a[12:15], v[64:67]
buffer_load_dwordx4 v1, s[12:15], s26 offen offset:0 sc1 lds
s_add_u32 s43, s26, 4096
M v[68:71], a[160:163], a[28:31], 0
v_exp_f32 v138, v138
M v[68:71], a[156:159], a[24:27], v[68:71]
v_cvt_pk_bf16_f32 v135, v150, v151
v_cvt_pk_bf16_f32 v136, v136, v137
M v[68:71], a[152:155], a[20:23], v[68:71]
v_exp_f32 v139, v139
M v[68:71], a[148:151], a[16:19], v[68:71]
buffer_load_dwordx4 v1, s[12:15], s26 offen offset:1024 sc1 lds
M v[72:75], a[148:151], a[32:35], 0
v_exp_f32 v152, v152
M v[72:75], a[152:155], a[36:39], v[72:75]
ds_read_b128 a[124:127], v6 offset:33792
ds_read_b128 a[128:131], v6 offset:41984
M v[72:75], a[156:159], a[40:43], v[72:75]
v_exp_f32 v153, v153
M v[72:75], a[160:163], a[44:47], v[72:75]
buffer_load_dwordx4 v1, s[12:15], s26 offen offset:2048 sc1 lds
M v[76:79], a[160:163], a[60:63], 0
v_exp_f32 v154, v154
M v[76:79], a[156:159], a[56:59], v[76:79]
v_cvt_pk_bf16_f32 v137, v138, v139
v_cvt_pk_bf16_f32 v138, v152, v153
M v[76:79], a[152:155], a[52:55], v[76:79]
v_exp_f32 v155, v155
M v[76:79], a[148:151], a[48:51], v[76:79]
buffer_load_dwordx4 v1, s[12:15], s26 offen offset:3072 sc1 lds
s_add_u32 m0, s29, 36864
s_waitcnt lgkmcnt(4)
M v[80:83], a[164:167], a[0:3], 0
v_exp_f32 v140, v140
M v[80:83], a[168:171], a[4:7], v[80:83]
ds_read_b128 a[132:135], v6 offset:34816
ds_read_b128 a[136:139], v6 offset:43008
M v[80:83], a[172:175], a[8:11], v[80:83]
v_exp_f32 v141, v141
M v[80:83], a[176:179], a[12:15], v[80:83]
buffer_load_dwordx4 v1, s[12:15], s43 offen offset:0 sc1 lds
M v[84:87], a[176:179], a[28:31], 0
v_exp_f32 v142, v142
M v[84:87], a[172:175], a[24:27], v[84:87]
v_cvt_pk_bf16_f32 v139, v154, v155
v_cvt_pk_bf16_f32 v140, v140, v141
M v[84:87], a[168:171], a[20:23], v[84:87]
v_exp_f32 v143, v143
M v[84:87], a[164:167], a[16:19], v[84:87]
buffer_load_dwordx4 v1, s[12:15], s43 offen offset:1024 sc1 lds
M v[88:91], a[164:167], a[32:35], 0
v_exp_f32 v156, v156
M v[88:91], a[168:171], a[36:39], v[88:91]
ds_read_b128 a[140:143], v6 offset:35840
ds_read_b128 a[144:147], v6 offset:44032
M v[88:91], a[172:175], a[40:43], v[88:91]
v_exp_f32 v157, v157
M v[88:91], a[176:179], a[44:47], v[88:91]
buffer_load_dwordx4 v1, s[12:15], s43 offen offset:2048 sc1 lds
M v[92:95], a[176:179], a[60:63], 0
v_exp_f32 v158, v158
M v[92:95], a[172:175], a[56:59], v[92:95]
v_cvt_pk_bf16_f32 v141, v142, v143
v_cvt_pk_bf16_f32 v142, v156, v157
M v[92:95], a[168:171], a[52:55], v[92:95]
v_exp_f32 v159, v159
M v[92:95], a[164:167], a[48:51], v[92:95]
buffer_load_dwordx4 v1, s[12:15], s43 offen offset:3072 sc1 lds
v_cvt_pk_bf16_f32 v143, v158, v159
s_waitcnt lgkmcnt(6)
M v[160:163], a[116:119], v[96:99], v[160:163]
v_exp_f32 v32, v32
M v[160:163], a[120:123], v[128:131], v[160:163]
ds_read_b128 a[148:151], v6 offset:36864
ds_read_b128 a[152:155], v6 offset:45056
M v[164:167], a[120:123], v[132:135], v[164:167]
v_exp_f32 v33, v33
M v[164:167], a[116:119], v[100:103], v[164:167]
v_cvt_pk_bf16_f32 v32, v32, v33
M v[168:171], a[116:119], v[104:107], v[168:171]
v_exp_f32 v34, v34
M v[168:171], a[120:123], v[136:139], v[168:171]
s_add_u32 s25, s25, 32768
s_cmp_eq_u32 s25, s27
M v[172:175], a[120:123], v[140:143], v[172:175]
v_exp_f32 v35, v35
M v[172:175], a[116:119], v[108:111], v[172:175]
v_cvt_pk_bf16_f32 v33, v34, v35
s_waitcnt lgkmcnt(6)
M a[96:99], a[112:115], v[96:99], a[96:99]
s_cselect_b32 s25, s28, s25
s_cselect_b32 s27, s56, s27
M a[96:99], a[112:115], v[128:131], a[96:99]
s_cselect_b32 s28, s57, s28
s_cselect_b32 s56, -1, s56
M v[176:179], a[124:127], v[96:99], v[176:179]
v_exp_f32 v48, v48
M v[176:179], a[128:131], v[128:131], v[176:179]
ds_read_b128 a[156:159], v6 offset:37888
ds_read_b128 a[160:163], v6 offset:46080
M v[180:183], a[128:131], v[132:135], v[180:183]
v_exp_f32 v49, v49
M v[180:183], a[124:127], v[100:103], v[180:183]
v_cvt_pk_bf16_f32 v34, v48, v49
M v[184:187], a[124:127], v[104:107], v[184:187]
v_exp_f32 v50, v50
M v[184:187], a[128:131], v[136:139], v[184:187]
s_add_u32 s26, s26, 32768
s_cmp_eq_u32 s26, s62
M v[188:191], a[128:131], v[140:143], v[188:191]
v_exp_f32 v51, v51
M v[188:191], a[124:127], v[108:111], v[188:191]
v_cvt_pk_bf16_f32 v35, v50, v51
s_waitcnt lgkmcnt(6)
M a[100:103], a[112:115], v[100:103], a[100:103]
s_cselect_b32 s26, s63, s26
s_cselect_b32 s62, s58, s62
M a[100:103], a[112:115], v[132:135], a[100:103]
s_cselect_b32 s63, s59, s63
s_cselect_b32 s58, -1, s58
M v[192:195], a[132:135], v[96:99], v[192:195]
v_exp_f32 v36, v36
M v[192:195], a[136:139], v[128:131], v[192:195]
ds_read_b128 a[164:167], v6 offset:38912
ds_read_b128 a[168:171], v6 offset:47104
M v[196:199], a[136:139], v[132:135], v[196:199]
v_exp_f32 v37, v37
M v[196:199], a[132:135], v[100:103], v[196:199]
v_cvt_pk_bf16_f32 v36, v36, v37
M v[200:203], a[132:135], v[104:107], v[200:203]
v_exp_f32 v38, v38
M v[200:203], a[136:139], v[136:139], v[200:203]
s_sub_u32 s33, s42, 1
s_cmp_le_u32 s33, 1
s_cselect_b32 s33, 0x4000, 0
v_add_u32 v3, s33, v3
M v[204:207], a[136:139], v[140:143], v[204:207]
v_exp_f32 v39, v39
M v[204:207], a[132:135], v[108:111], v[204:207]
v_cvt_pk_bf16_f32 v37, v38, v39
s_waitcnt lgkmcnt(6)
M a[104:107], a[112:115], v[104:107], a[104:107]
M a[104:107], a[112:115], v[136:139], a[104:107]
M v[208:211], a[140:143], v[96:99], v[208:211]
v_exp_f32 v52, v52
M v[208:211], a[144:147], v[128:131], v[208:211]
ds_read_b128 a[172:175], v6 offset:39936
ds_read_b128 a[176:179], v6 offset:48128
M v[212:215], a[144:147], v[132:135], v[212:215]
v_exp_f32 v53, v53
M v[212:215], a[140:143], v[100:103], v[212:215]
v_cvt_pk_bf16_f32 v38, v52, v53
M v[216:219], a[140:143], v[104:107], v[216:219]
v_exp_f32 v54, v54
M v[216:219], a[144:147], v[136:139], v[216:219]
M v[220:223], a[144:147], v[140:143], v[220:223]
v_exp_f32 v55, v55
M v[220:223], a[140:143], v[108:111], v[220:223]
v_cvt_pk_bf16_f32 v39, v54, v55
s_waitcnt lgkmcnt(6)
M a[108:111], a[112:115], v[108:111], a[108:111]
M a[108:111], a[112:115], v[140:143], a[108:111]
M v[224:227], a[148:151], v[96:99], v[224:227]
v_exp_f32 v40, v40
M v[224:227], a[152:155], v[128:131], v[224:227]
s_cmp_le_u32 s42, 1
s_cselect_b32 s33, 0x4000, 0
v_add_u32 v6, s33, v6
s_sub_u32 s42, s42, 1
M v[228:231], a[152:155], v[132:135], v[228:231]
v_exp_f32 v41, v41
M v[228:231], a[148:151], v[100:103], v[228:231]
v_cvt_pk_bf16_f32 v40, v40, v41
M v[232:235], a[148:151], v[104:107], v[232:235]
v_exp_f32 v42, v42
M v[232:235], a[152:155], v[136:139], v[232:235]
M v[236:239], a[152:155], v[140:143], v[236:239]
v_exp_f32 v43, v43
M v[236:239], a[148:151], v[108:111], v[236:239]
v_cvt_pk_bf16_f32 v41, v42, v43
s_waitcnt lgkmcnt(4)
M v[240:243], a[156:159], v[96:99], v[240:243]
v_exp_f32 v56, v56
M v[240:243], a[160:163], v[128:131], v[240:243]
M v[244:247], a[160:163], v[132:135], v[244:247]
v_exp_f32 v57, v57
M v[244:247], a[156:159], v[100:103], v[244:247]
v_cvt_pk_bf16_f32 v42, v56, v57
M v[248:251], a[156:159], v[104:107], v[248:251]
v_exp_f32 v58, v58
M v[248:251], a[160:163], v[136:139], v[248:251]
s_waitcnt vmcnt(0) lgkmcnt(0)
s_barrier
ds_read_b128 a[116:119], v2 offset:0
ds_read_b128 a[120:123], v2 offset:1024
M v[252:255], a[160:163], v[140:143], v[252:255]
v_exp_f32 v59, v59
M v[252:255], a[156:159], v[108:111], v[252:255]
v_cvt_pk_bf16_f32 v43, v58, v59
M a[64:67], a[164:167], v[96:99], a[64:67]
v_exp_f32 v44, v44
M a[64:67], a[168:171], v[128:131], a[64:67]
ds_read_b128 a[124:127], v2 offset:2048
ds_read_b128 a[128:131], v2 offset:3072
M a[68:71], a[168:171], v[132:135], a[68:71]
v_exp_f32 v45, v45
M a[68:71], a[164:167], v[100:103], a[68:71]
v_cvt_pk_bf16_f32 v44, v44, v45
M a[72:75], a[164:167], v[104:107], a[72:75]
v_exp_f32 v46, v46
M a[72:75], a[168:171], v[136:139], a[72:75]
ds_read_b128 a[132:135], v2 offset:4096
ds_read_b128 a[136:139], v2 offset:5120
M a[76:79], a[168:171], v[140:143], a[76:79]
v_exp_f32 v47, v47
M a[76:79], a[164:167], v[108:111], a[76:79]
v_cvt_pk_bf16_f32 v45, v46, v47
M a[80:83], a[172:175], v[96:99], a[80:83]
v_exp_f32 v60, v60
M a[80:83], a[176:179], v[128:131], a[80:83]
ds_read_b128 a[140:143], v2 offset:6144
ds_read_b128 a[144:147], v2 offset:7168
M a[84:87], a[176:179], v[132:135], a[84:87]
v_exp_f32 v61, v61
M a[84:87], a[172:175], v[100:103], a[84:87]
v_cvt_pk_bf16_f32 v46, v60, v61
M a[88:91], a[172:175], v[104:107], a[88:91]
v_exp_f32 v62, v62
M a[88:91], a[176:179], v[136:139], a[88:91]
M a[92:95], a[176:179], v[140:143], a[92:95]
v_exp_f32 v63, v63
M a[92:95], a[172:175], v[108:111], a[92:95]
v_cvt_pk_bf16_f32 v47, v62, v63
s_sub_u32 s30, s30, 1
s_cmp_lg_u32 s30, 0
s_cbranch_scc1 Lk2_l3
s_lshl_b32 s33, s23, 6
s_add_i32 s33, s33, 0
s_cmp_gt_i32 s33, 0
s_cselect_b32 s34, 0, 0xf149f2ca
s_cmp_lt_i32 s33, 0
s_cselect_b32 s33, 0xf149f2ca, 0
v_mov_b32 v20, s34
v_mov_b32 v21, s34
v_mov_b32 v22, s34
v_mov_b32 v23, s34
v_mov_b32 v28, s33
v_mov_b32 v29, s33
v_mov_b32 v30, s33
v_mov_b32 v31, s33
v_med3_f32 v24, v16, v20, v28
v_med3_f32 v25, v17, v20, v28
v_med3_f32 v26, v18, v20, v28
v_med3_f32 v27, v19, v20, v28
s_add_u32 m0, s29, 65536
s_waitcnt lgkmcnt(4)
M v[96:99], a[116:119], a[0:3], v[24:27]
v_exp_f32 v64, v64
M v[96:99], a[120:123], a[4:7], v[96:99]
ds_read_b128 a[148:151], v2 offset:8192
ds_read_b128 a[152:155], v2 offset:9216
M v[96:99], a[124:127], a[8:11], v[96:99]
v_exp_f32 v65, v65
M v[96:99], a[128:131], a[12:15], v[96:99]
buffer_load_dwordx4 v1, s[12:15], s25 offen offset:0 sc1 lds
s_add_u32 s32, s25, 4096
M v[100:103], a[128:131], a[28:31], v[28:31]
v_exp_f32 v66, v66
M v[100:103], a[124:127], a[24:27], v[100:103]
v_cvt_pk_bf16_f32 v64, v64, v65
M v[100:103], a[120:123], a[20:23], v[100:103]
v_exp_f32 v67, v67
M v[100:103], a[116:119], a[16:19], v[100:103]
buffer_load_dwordx4 v1, s[12:15], s25 offen offset:1024 sc1 lds
M v[104:107], a[116:119], a[32:35], v[28:31]
v_exp_f32 v80, v80
M v[104:107], a[120:123], a[36:39], v[104:107]
ds_read_b128 a[156:159], v2 offset:10240
ds_read_b128 a[160:163], v2 offset:11264
M v[104:107], a[124:127], a[40:43], v[104:107]
v_exp_f32 v81, v81
M v[104:107], a[128:131], a[44:47], v[104:107]
buffer_load_dwordx4 v1, s[12:15], s25 offen offset:2048 sc1 lds
M v[108:111], a[128:131], a[60:63], v[28:31]
v_exp_f32 v82, v82
M v[108:111], a[124:127], a[56:59], v[108:111]
v_cvt_pk_bf16_f32 v65, v66, v67
v_cvt_pk_bf16_f32 v66, v80, v81
M v[108:111], a[120:123], a[52:55], v[108:111]
v_exp_f32 v83, v83
M v[108:111], a[116:119], a[48:51], v[108:111]
buffer_load_dwordx4 v1, s[12:15], s25 offen offset:3072 sc1 lds
s_add_u32 m0, s29, 69632
s_waitcnt lgkmcnt(4)
M v[112:115], a[132:135], a[0:3], v[20:23]
v_exp_f32 v68, v68
M v[112:115], a[136:139], a[4:7], v[112:115]
ds_read_b128 a[164:167], v2 offset:12288
ds_read_b128 a[168:171], v2 offset:13312
M v[112:115], a[140:143], a[8:11], v[112:115]
v_exp_f32 v69, v69
M v[112:115], a[144:147], a[12:15], v[112:115]
buffer_load_dwordx4 v1, s[12:15], s32 offen offset:0 sc1 lds
M v[116:119], a[144:147], a[28:31], v[24:27]
v_exp_f32 v70, v70
M v[116:119], a[140:143], a[24:27], v[116:119]
v_cvt_pk_bf16_f32 v67, v82, v83
v_cvt_pk_bf16_f32 v68, v68, v69
M v[116:119], a[136:139], a[20:23], v[116:119]
v_exp_f32 v71, v71
M v[116:119], a[132:135], a[16:19], v[116:119]
buffer_load_dwordx4 v1, s[12:15], s32 offen offset:1024 sc1 lds
M v[120:123], a[132:135], a[32:35], v[28:31]
v_exp_f32 v84, v84
M v[120:123], a[136:139], a[36:39], v[120:123]
ds_read_b128 a[172:175], v2 offset:14336
ds_read_b128 a[176:179], v2 offset:15360
M v[120:123], a[140:143], a[40:43], v[120:123]
v_exp_f32 v85, v85
M v[120:123], a[144:147], a[44:47], v[120:123]
buffer_load_dwordx4 v1, s[12:15], s32 offen offset:2048 sc1 lds
M v[124:127], a[144:147], a[60:63], v[28:31]
v_exp_f32 v86, v86
M v[124:127], a[140:143], a[56:59], v[124:127]
v_cvt_pk_bf16_f32 v69, v70, v71
v_cvt_pk_bf16_f32 v70, v84, v85
M v[124:127], a[136:139], a[52:55], v[124:127]
v_exp_f32 v87, v87
M v[124:127], a[132:135], a[48:51], v[124:127]
buffer_load_dwordx4 v1, s[12:15], s32 offen offset:3072 sc1 lds
s_add_u32 m0, s29, 98304
s_waitcnt lgkmcnt(4)
M v[128:131], a[148:151], a[0:3], v[20:23]
v_exp_f32 v72, v72
M v[128:131], a[152:155], a[4:7], v[128:131]
ds_read_b128 a[116:119], v5 offset:32768
ds_read_b128 a[120:123], v5 offset:40960
M v[128:131], a[156:159], a[8:11], v[128:131]
v_exp_f32 v73, v73
M v[128:131], a[160:163], a[12:15], v[128:131]
buffer_load_dwordx4 v1, s[12:15], s26 offen offset:0 sc1 lds
s_add_u32 s43, s26, 4096
M v[132:135], a[160:163], a[28:31], v[20:23]
v_exp_f32 v74, v74
M v[132:135], a[156:159], a[24:27], v[132:135]
v_cvt_pk_bf16_f32 v71, v86, v87
v_cvt_pk_bf16_f32 v72, v72, v73
M v[132:135], a[152:155], a[20:23], v[132:135]
v_exp_f32 v75, v75
M v[132:135], a[148:151], a[16:19], v[132:135]
buffer_load_dwordx4 v1, s[12:15], s26 offen offset:1024 sc1 lds
M v[136:139], a[148:151], a[32:35], v[24:27]
v_exp_f32 v88, v88
M v[136:139], a[152:155], a[36:39], v[136:139]
ds_read_b128 a[124:127], v5 offset:33792
ds_read_b128 a[128:131], v5 offset:41984
M v[136:139], a[156:159], a[40:43], v[136:139]
v_exp_f32 v89, v89
M v[136:139], a[160:163], a[44:47], v[136:139]
buffer_load_dwordx4 v1, s[12:15], s26 offen offset:2048 sc1 lds
M v[140:143], a[160:163], a[60:63], v[28:31]
v_exp_f32 v90, v90
M v[140:143], a[156:159], a[56:59], v[140:143]
v_cvt_pk_bf16_f32 v73, v74, v75
v_cvt_pk_bf16_f32 v74, v88, v89
M v[140:143], a[152:155], a[52:55], v[140:143]
v_exp_f32 v91, v91
M v[140:143], a[148:151], a[48:51], v[140:143]
buffer_load_dwordx4 v1, s[12:15], s26 offen offset:3072 sc1 lds
s_add_u32 m0, s29, 102400
s_waitcnt lgkmcnt(4)
M v[144:147], a[164:167], a[0:3], v[20:23]
v_exp_f32 v76, v76
M v[144:147], a[168:171], a[4:7], v[144:147]
ds_read_b128 a[132:135], v5 offset:34816
ds_read_b128 a[136:139], v5 offset:43008
M v[144:147], a[172:175], a[8:11], v[144:147]
v_exp_f32 v77, v77
M v[144:147], a[176:179], a[12:15], v[144:147]
buffer_load_dwordx4 v1, s[12:15], s43 offen offset:0 sc1 lds
M v[148:151], a[176:179], a[28:31], v[20:23]
v_exp_f32 v78, v78
M v[148:151], a[172:175], a[24:27], v[148:151]
v_cvt_pk_bf16_f32 v75, v90, v91
v_cvt_pk_bf16_f32 v76, v76, v77
M v[148:151], a[168:171], a[20:23], v[148:151]
v_exp_f32 v79, v79
M v[148:151], a[164:167], a[16:19], v[148:151]
buffer_load_dwordx4 v1, s[12:15], s43 offen offset:1024 sc1 lds
M v[152:155], a[164:167], a[32:35], v[20:23]
v_exp_f32 v92, v92
M v[152:155], a[168:171], a[36:39], v[152:155]
ds_read_b128 a[140:143], v5 offset:35840
ds_read_b128 a[144:147], v5 offset:44032
M v[152:155], a[172:175], a[40:43], v[152:155]
v_exp_f32 v93, v93
M v[152:155], a[176:179], a[44:47], v[152:155]
buffer_load_dwordx4 v1, s[12:15], s43 offen offset:2048 sc1 lds
M v[156:159], a[176:179], a[60:63], v[24:27]
v_exp_f32 v94, v94
M v[156:159], a[172:175], a[56:59], v[156:159]
v_cvt_pk_bf16_f32 v77, v78, v79
v_cvt_pk_bf16_f32 v78, v92, v93
M v[156:159], a[168:171], a[52:55], v[156:159]
v_exp_f32 v95, v95
M v[156:159], a[164:167], a[48:51], v[156:159]
buffer_load_dwordx4 v1, s[12:15], s43 offen offset:3072 sc1 lds
v_cvt_pk_bf16_f32 v79, v94, v95
s_waitcnt lgkmcnt(6)
M v[160:163], a[116:119], v[32:35], v[160:163]
v_exp_f32 v96, v96
M v[160:163], a[120:123], v[64:67], v[160:163]
ds_read_b128 a[148:151], v5 offset:36864
ds_read_b128 a[152:155], v5 offset:45056
M v[164:167], a[120:123], v[68:71], v[164:167]
v_exp_f32 v97, v97
M v[164:167], a[116:119], v[36:39], v[164:167]
v_cvt_pk_bf16_f32 v96, v96, v97
M v[168:171], a[116:119], v[40:43], v[168:171]
v_exp_f32 v98, v98
M v[168:171], a[120:123], v[72:75], v[168:171]
s_add_u32 s25, s25, 32768
s_cmp_eq_u32 s25, s27
M v[172:175], a[120:123], v[76:79], v[172:175]
v_exp_f32 v99, v99
M v[172:175], a[116:119], v[44:47], v[172:175]
v_cvt_pk_bf16_f32 v97, v98, v99
s_waitcnt lgkmcnt(6)
M a[96:99], a[112:115], v[32:35], a[96:99]
s_cselect_b32 s25, s28, s25
s_cselect_b32 s27, s56, s27
M a[96:99], a[112:115], v[64:67], a[96:99]
s_cselect_b32 s28, s57, s28
s_cselect_b32 s56, -1, s56
M v[176:179], a[124:127], v[32:35], v[176:179]
v_exp_f32 v112, v112
M v[176:179], a[128:131], v[64:67], v[176:179]
ds_read_b128 a[156:159], v5 offset:37888
ds_read_b128 a[160:163], v5 offset:46080
M v[180:183], a[128:131], v[68:71], v[180:183]
v_exp_f32 v113, v113
M v[180:183], a[124:127], v[36:39], v[180:183]
v_cvt_pk_bf16_f32 v98, v112, v113
M v[184:187], a[124:127], v[40:43], v[184:187]
v_exp_f32 v114, v114
M v[184:187], a[128:131], v[72:75], v[184:187]
s_add_u32 s26, s26, 32768
s_cmp_eq_u32 s26, s62
M v[188:191], a[128:131], v[76:79], v[188:191]
v_exp_f32 v115, v115
M v[188:191], a[124:127], v[44:47], v[188:191]
v_cvt_pk_bf16_f32 v99, v114, v115
s_waitcnt lgkmcnt(6)
M a[100:103], a[112:115], v[36:39], a[100:103]
s_cselect_b32 s26, s63, s26
s_cselect_b32 s62, s58, s62
M a[100:103], a[112:115], v[68:71], a[100:103]
s_cselect_b32 s63, s59, s63
s_cselect_b32 s58, -1, s58
M v[192:195], a[132:135], v[32:35], v[192:195]
v_exp_f32 v100, v100
M v[192:195], a[136:139], v[64:67], v[192:195]
ds_read_b128 a[164:167], v5 offset:38912
ds_read_b128 a[168:171], v5 offset:47104
M v[196:199], a[136:139], v[68:71], v[196:199]
v_exp_f32 v101, v101
M v[196:199], a[132:135], v[36:39], v[196:199]
v_cvt_pk_bf16_f32 v100, v100, v101
M v[200:203], a[132:135], v[40:43], v[200:203]
v_exp_f32 v102, v102
M v[200:203], a[136:139], v[72:75], v[200:203]
s_sub_u32 s33, s42, 1
s_cmp_le_u32 s33, 1
s_cselect_b32 s33, 0x4000, 0
v_add_u32 v2, s33, v2
M v[204:207], a[136:139], v[76:79], v[204:207]
v_exp_f32 v103, v103
M v[204:207], a[132:135], v[44:47], v[204:207]
v_cvt_pk_bf16_f32 v101, v102, v103
s_waitcnt lgkmcnt(6)
M a[104:107], a[112:115], v[40:43], a[104:107]
M a[104:107], a[112:115], v[72:75], a[104:107]
M v[208:211], a[140:143], v[32:35], v[208:211]
v_exp_f32 v116, v116
M v[208:211], a[144:147], v[64:67], v[208:211]
ds_read_b128 a[172:175], v5 offset:39936
ds_read_b128 a[176:179], v5 offset:48128
M v[212:215], a[144:147], v[68:71], v[212:215]
v_exp_f32 v117, v117
M v[212:215], a[140:143], v[36:39], v[212:215]
v_cvt_pk_bf16_f32 v102, v116, v117
M v[216:219], a[140:143], v[40:43], v[216:219]
v_exp_f32 v118, v118
M v[216:219], a[144:147], v[72:75], v[216:219]
M v[220:223], a[144:147], v[76:79], v[220:223]
v_exp_f32 v119, v119
M v[220:223], a[140:143], v[44:47], v[220:223]
v_cvt_pk_bf16_f32 v103, v118, v119
s_waitcnt lgkmcnt(6)
M a[108:111], a[112:115], v[44:47], a[108:111]
M a[108:111], a[112:115], v[76:79], a[108:111]
M v[224:227], a[148:151], v[32:35], v[224:227]
v_exp_f32 v104, v104
M v[224:227], a[152:155], v[64:67], v[224:227]
s_cmp_le_u32 s42, 1
s_cselect_b32 s33, 0x4000, 0
v_add_u32 v5, s33, v5
s_sub_u32 s42, s42, 1
M v[228:231], a[152:155], v[68:71], v[228:231]
v_exp_f32 v105, v105
M v[228:231], a[148:151], v[36:39], v[228:231]
v_cvt_pk_bf16_f32 v104, v104, v105
M v[232:235], a[148:151], v[40:43], v[232:235]
v_exp_f32 v106, v106
M v[232:235], a[152:155], v[72:75], v[232:235]
M v[236:239], a[152:155], v[76:79], v[236:239]
v_exp_f32 v107, v107
M v[236:239], a[148:151], v[44:47], v[236:239]
v_cvt_pk_bf16_f32 v105, v106, v107
s_waitcnt lgkmcnt(4)
M v[240:243], a[156:159], v[32:35], v[240:243]
v_exp_f32 v120, v120
M v[240:243], a[160:163], v[64:67], v[240:243]
M v[244:247], a[160:163], v[68:71], v[244:247]
v_exp_f32 v121, v121
M v[244:247], a[156:159], v[36:39], v[244:247]
v_cvt_pk_bf16_f32 v106, v120, v121
M v[248:251], a[156:159], v[40:43], v[248:251]
v_exp_f32 v122, v122
M v[248:251], a[160:163], v[72:75], v[248:251]
s_waitcnt vmcnt(0) lgkmcnt(0)
s_barrier
ds_read_b128 a[116:119], v3 offset:0
ds_read_b128 a[120:123], v3 offset:1024
M v[252:255], a[160:163], v[76:79], v[252:255]
v_exp_f32 v123, v123
M v[252:255], a[156:159], v[44:47], v[252:255]
v_cvt_pk_bf16_f32 v107, v122, v123
M a[64:67], a[164:167], v[32:35], a[64:67]
v_exp_f32 v108, v108
M a[64:67], a[168:171], v[64:67], a[64:67]
ds_read_b128 a[124:127], v3 offset:2048
ds_read_b128 a[128:131], v3 offset:3072
M a[68:71], a[168:171], v[68:71], a[68:71]
v_exp_f32 v109, v109
M a[68:71], a[164:167], v[36:39], a[68:71]
v_cvt_pk_bf16_f32 v108, v108, v109
M a[72:75], a[164:167], v[40:43], a[72:75]
v_exp_f32 v110, v110
M a[72:75], a[168:171], v[72:75], a[72:75]
ds_read_b128 a[132:135], v3 offset:4096
ds_read_b128 a[136:139], v3 offset:5120
M a[76:79], a[168:171], v[76:79], a[76:79]
v_exp_f32 v111, v111
M a[76:79], a[164:167], v[44:47], a[76:79]
v_cvt_pk_bf16_f32 v109, v110, v111
M a[80:83], a[172:175], v[32:35], a[80:83]
v_exp_f32 v124, v124
M a[80:83], a[176:179], v[64:67], a[80:83]
ds_read_b128 a[140:143], v3 offset:6144
ds_read_b128 a[144:147], v3 offset:7168
M a[84:87], a[176:179], v[68:71], a[84:87]
v_exp_f32 v125, v125
M a[84:87], a[172:175], v[36:39], a[84:87]
v_cvt_pk_bf16_f32 v110, v124, v125
M a[88:91], a[172:175], v[40:43], a[88:91]
v_exp_f32 v126, v126
M a[88:91], a[176:179], v[72:75], a[88:91]
M a[92:95], a[176:179], v[76:79], a[92:95]
v_exp_f32 v127, v127
M a[92:95], a[172:175], v[44:47], a[92:95]
v_cvt_pk_bf16_f32 v111, v126, v127
s_lshl_b32 s33, s23, 6
s_add_i32 s33, s33, -64
s_cmp_gt_i32 s33, 0
s_cselect_b32 s34, 0, 0xf149f2ca
s_cmp_lt_i32 s33, 0
s_cselect_b32 s33, 0xf149f2ca, 0
v_mov_b32 v20, s34
v_mov_b32 v21, s34
v_mov_b32 v22, s34
v_mov_b32 v23, s34
v_mov_b32 v28, s33
v_mov_b32 v29, s33
v_mov_b32 v30, s33
v_mov_b32 v31, s33
v_med3_f32 v24, v16, v20, v28
v_med3_f32 v25, v17, v20, v28
v_med3_f32 v26, v18, v20, v28
v_med3_f32 v27, v19, v20, v28
s_add_u32 m0, s29, 0
s_waitcnt lgkmcnt(4)
M v[32:35], a[116:119], a[0:3], v[24:27]
v_exp_f32 v128, v128
M v[32:35], a[120:123], a[4:7], v[32:35]
ds_read_b128 a[148:151], v3 offset:8192
ds_read_b128 a[152:155], v3 offset:9216
M v[32:35], a[124:127], a[8:11], v[32:35]
v_exp_f32 v129, v129
M v[32:35], a[128:131], a[12:15], v[32:35]
buffer_load_dwordx4 v1, s[12:15], s25 offen offset:0 sc1 lds
s_add_u32 s32, s25, 4096
M v[36:39], a[128:131], a[28:31], v[28:31]
v_exp_f32 v130, v130
M v[36:39], a[124:127], a[24:27], v[36:39]
v_cvt_pk_bf16_f32 v128, v128, v129
M v[36:39], a[120:123], a[20:23], v[36:39]
v_exp_f32 v131, v131
M v[36:39], a[116:119], a[16:19], v[36:39]
buffer_load_dwordx4 v1, s[12:15], s25 offen offset:1024 sc1 lds
M v[40:43], a[116:119], a[32:35], v[28:31]
v_exp_f32 v144, v144
M v[40:43], a[120:123], a[36:39], v[40:43]
ds_read_b128 a[156:159], v3 offset:10240
ds_read_b128 a[160:163], v3 offset:11264
M v[40:43], a[124:127], a[40:43], v[40:43]
v_exp_f32 v145, v145
M v[40:43], a[128:131], a[44:47], v[40:43]
buffer_load_dwordx4 v1, s[12:15], s25 offen offset:2048 sc1 lds
M v[44:47], a[128:131], a[60:63], v[28:31]
v_exp_f32 v146, v146
M v[44:47], a[124:127], a[56:59], v[44:47]
v_cvt_pk_bf16_f32 v129, v130, v131
v_cvt_pk_bf16_f32 v130, v144, v145
M v[44:47], a[120:123], a[52:55], v[44:47]
v_exp_f32 v147, v147
M v[44:47], a[116:119], a[48:51], v[44:47]
buffer_load_dwordx4 v1, s[12:15], s25 offen offset:3072 sc1 lds
s_add_u32 m0, s29, 4096
s_waitcnt lgkmcnt(4)
M v[48:51], a[132:135], a[0:3], v[20:23]
v_exp_f32 v132, v132
M v[48:51], a[136:139], a[4:7], v[48:51]
ds_read_b128 a[164:167], v3 offset:12288
ds_read_b128 a[168:171], v3 offset:13312
M v[48:51], a[140:143], a[8:11], v[48:51]
v_exp_f32 v133, v133
M v[48:51], a[144:147], a[12:15], v[48:51]
buffer_load_dwordx4 v1, s[12:15], s32 offen offset:0 sc1 lds
M v[52:55], a[144:147], a[28:31], v[24:27]
v_exp_f32 v134, v134
M v[52:55], a[140:143], a[24:27], v[52:55]
v_cvt_pk_bf16_f32 v131, v146, v147
v_cvt_pk_bf16_f32 v132, v132, v133
M v[52:55], a[136:139], a[20:23], v[52:55]
v_exp_f32 v135, v135
M v[52:55], a[132:135], a[16:19], v[52:55]
buffer_load_dwordx4 v1, s[12:15], s32 offen offset:1024 sc1 lds
M v[56:59], a[132:135], a[32:35], v[28:31]
v_exp_f32 v148, v148
M v[56:59], a[136:139], a[36:39], v[56:59]
ds_read_b128 a[172:175], v3 offset:14336
ds_read_b128 a[176:179], v3 offset:15360
M v[56:59], a[140:143], a[40:43], v[56:59]
v_exp_f32 v149, v149
M v[56:59], a[144:147], a[44:47], v[56:59]
buffer_load_dwordx4 v1, s[12:15], s32 offen offset:2048 sc1 lds
M v[60:63], a[144:147], a[60:63], v[28:31]
v_exp_f32 v150, v150
M v[60:63], a[140:143], a[56:59], v[60:63]
v_cvt_pk_bf16_f32 v133, v134, v135
v_cvt_pk_bf16_f32 v134, v148, v149
M v[60:63], a[136:139], a[52:55], v[60:63]
v_exp_f32 v151, v151
M v[60:63], a[132:135], a[48:51], v[60:63]
buffer_load_dwordx4 v1, s[12:15], s32 offen offset:3072 sc1 lds
s_add_u32 m0, s29, 32768
s_waitcnt lgkmcnt(4)
M v[64:67], a[148:151], a[0:3], v[20:23]
v_exp_f32 v136, v136
M v[64:67], a[152:155], a[4:7], v[64:67]
ds_read_b128 a[116:119], v6 offset:32768
ds_read_b128 a[120:123], v6 offset:40960
M v[64:67], a[156:159], a[8:11], v[64:67]
v_exp_f32 v137, v137
M v[64:67], a[160:163], a[12:15], v[64:67]
buffer_load_dwordx4 v1, s[12:15], s26 offen offset:0 sc1 lds
s_add_u32 s43, s26, 4096
M v[68:71], a[160:163], a[28:31], v[20:23]
v_exp_f32 v138, v138
M v[68:71], a[156:159], a[24:27], v[68:71]
v_cvt_pk_bf16_f32 v135, v150, v151
v_cvt_pk_bf16_f32 v136, v136, v137
M v[68:71], a[152:155], a[20:23], v[68:71]
v_exp_f32 v139, v139
M v[68:71], a[148:151], a[16:19], v[68:71]
buffer_load_dwordx4 v1, s[12:15], s26 offen offset:1024 sc1 lds
M v[72:75], a[148:151], a[32:35], v[24:27]
v_exp_f32 v152, v152
M v[72:75], a[152:155], a[36:39], v[72:75]
ds_read_b128 a[124:127], v6 offset:33792
ds_read_b128 a[128:131], v6 offset:41984
M v[72:75], a[156:159], a[40:43], v[72:75]
v_exp_f32 v153, v153
M v[72:75], a[160:163], a[44:47], v[72:75]
buffer_load_dwordx4 v1, s[12:15], s26 offen offset:2048 sc1 lds
M v[76:79], a[160:163], a[60:63], v[28:31]
v_exp_f32 v154, v154
M v[76:79], a[156:159], a[56:59], v[76:79]
v_cvt_pk_bf16_f32 v137, v138, v139
v_cvt_pk_bf16_f32 v138, v152, v153
M v[76:79], a[152:155], a[52:55], v[76:79]
v_exp_f32 v155, v155
M v[76:79], a[148:151], a[48:51], v[76:79]
buffer_load_dwordx4 v1, s[12:15], s26 offen offset:3072 sc1 lds
s_add_u32 m0, s29, 36864
s_waitcnt lgkmcnt(4)
M v[80:83], a[164:167], a[0:3], v[20:23]
v_exp_f32 v140, v140
M v[80:83], a[168:171], a[4:7], v[80:83]
ds_read_b128 a[132:135], v6 offset:34816
ds_read_b128 a[136:139], v6 offset:43008
M v[80:83], a[172:175], a[8:11], v[80:83]
v_exp_f32 v141, v141
M v[80:83], a[176:179], a[12:15], v[80:83]
buffer_load_dwordx4 v1, s[12:15], s43 offen offset:0 sc1 lds
M v[84:87], a[176:179], a[28:31], v[20:23]
v_exp_f32 v142, v142
M v[84:87], a[172:175], a[24:27], v[84:87]
v_cvt_pk_bf16_f32 v139, v154, v155
v_cvt_pk_bf16_f32 v140, v140, v141
M v[84:87], a[168:171], a[20:23], v[84:87]
v_exp_f32 v143, v143
M v[84:87], a[164:167], a[16:19], v[84:87]
buffer_load_dwordx4 v1, s[12:15], s43 offen offset:1024 sc1 lds
M v[88:91], a[164:167], a[32:35], v[20:23]
v_exp_f32 v156, v156
M v[88:91], a[168:171], a[36:39], v[88:91]
ds_read_b128 a[140:143], v6 offset:35840
ds_read_b128 a[144:147], v6 offset:44032
M v[88:91], a[172:175], a[40:43], v[88:91]
v_exp_f32 v157, v157
M v[88:91], a[176:179], a[44:47], v[88:91]
buffer_load_dwordx4 v1, s[12:15], s43 offen offset:2048 sc1 lds
M v[92:95], a[176:179], a[60:63], v[24:27]
v_exp_f32 v158, v158
M v[92:95], a[172:175], a[56:59], v[92:95]
v_cvt_pk_bf16_f32 v141, v142, v143
v_cvt_pk_bf16_f32 v142, v156, v157
M v[92:95], a[168:171], a[52:55], v[92:95]
v_exp_f32 v159, v159
M v[92:95], a[164:167], a[48:51], v[92:95]
buffer_load_dwordx4 v1, s[12:15], s43 offen offset:3072 sc1 lds
v_cvt_pk_bf16_f32 v143, v158, v159
s_waitcnt lgkmcnt(6)
M v[160:163], a[116:119], v[96:99], v[160:163]
v_exp_f32 v32, v32
M v[160:163], a[120:123], v[128:131], v[160:163]
ds_read_b128 a[148:151], v6 offset:36864
ds_read_b128 a[152:155], v6 offset:45056
M v[164:167], a[120:123], v[132:135], v[164:167]
v_exp_f32 v33, v33
M v[164:167], a[116:119], v[100:103], v[164:167]
v_cvt_pk_bf16_f32 v32, v32, v33
M v[168:171], a[116:119], v[104:107], v[168:171]
v_exp_f32 v34, v34
M v[168:171], a[120:123], v[136:139], v[168:171]
s_add_u32 s25, s25, 32768
s_cmp_eq_u32 s25, s27
M v[172:175], a[120:123], v[140:143], v[172:175]
v_exp_f32 v35, v35
M v[172:175], a[116:119], v[108:111], v[172:175]
v_cvt_pk_bf16_f32 v33, v34, v35
s_waitcnt lgkmcnt(6)
M a[96:99], a[112:115], v[96:99], a[96:99]
s_cselect_b32 s25, s28, s25
s_cselect_b32 s27, s56, s27
M a[96:99], a[112:115], v[128:131], a[96:99]
s_cselect_b32 s28, s57, s28
s_cselect_b32 s56, -1, s56
M v[176:179], a[124:127], v[96:99], v[176:179]
v_exp_f32 v48, v48
M v[176:179], a[128:131], v[128:131], v[176:179]
ds_read_b128 a[156:159], v6 offset:37888
ds_read_b128 a[160:163], v6 offset:46080
M v[180:183], a[128:131], v[132:135], v[180:183]
v_exp_f32 v49, v49
M v[180:183], a[124:127], v[100:103], v[180:183]
v_cvt_pk_bf16_f32 v34, v48, v49
M v[184:187], a[124:127], v[104:107], v[184:187]
v_exp_f32 v50, v50
M v[184:187], a[128:131], v[136:139], v[184:187]
s_add_u32 s26, s26, 32768
s_cmp_eq_u32 s26, s62
M v[188:191], a[128:131], v[140:143], v[188:191]
v_exp_f32 v51, v51
M v[188:191], a[124:127], v[108:111], v[188:191]
v_cvt_pk_bf16_f32 v35, v50, v51
s_waitcnt lgkmcnt(6)
M a[100:103], a[112:115], v[100:103], a[100:103]
s_cselect_b32 s26, s63, s26
s_cselect_b32 s62, s58, s62
M a[100:103], a[112:115], v[132:135], a[100:103]
s_cselect_b32 s63, s59, s63
s_cselect_b32 s58, -1, s58
M v[192:195], a[132:135], v[96:99], v[192:195]
v_exp_f32 v36, v36
M v[192:195], a[136:139], v[128:131], v[192:195]
ds_read_b128 a[164:167], v6 offset:38912
ds_read_b128 a[168:171], v6 offset:47104
M v[196:199], a[136:139], v[132:135], v[196:199]
v_exp_f32 v37, v37
M v[196:199], a[132:135], v[100:103], v[196:199]
v_cvt_pk_bf16_f32 v36, v36, v37
M v[200:203], a[132:135], v[104:107], v[200:203]
v_exp_f32 v38, v38
M v[200:203], a[136:139], v[136:139], v[200:203]
s_sub_u32 s33, s42, 1
s_cmp_le_u32 s33, 1
s_cselect_b32 s33, 0x4000, 0
v_add_u32 v3, s33, v3
M v[204:207], a[136:139], v[140:143], v[204:207]
v_exp_f32 v39, v39
M v[204:207], a[132:135], v[108:111], v[204:207]
v_cvt_pk_bf16_f32 v37, v38, v39
s_waitcnt lgkmcnt(6)
M a[104:107], a[112:115], v[104:107], a[104:107]
M a[104:107], a[112:115], v[136:139], a[104:107]
M v[208:211], a[140:143], v[96:99], v[208:211]
v_exp_f32 v52, v52
M v[208:211], a[144:147], v[128:131], v[208:211]
ds_read_b128 a[172:175], v6 offset:39936
ds_read_b128 a[176:179], v6 offset:48128
M v[212:215], a[144:147], v[132:135], v[212:215]
v_exp_f32 v53, v53
M v[212:215], a[140:143], v[100:103], v[212:215]
v_cvt_pk_bf16_f32 v38, v52, v53
M v[216:219], a[140:143], v[104:107], v[216:219]
v_exp_f32 v54, v54
M v[216:219], a[144:147], v[136:139], v[216:219]
M v[220:223], a[144:147], v[140:143], v[220:223]
v_exp_f32 v55, v55
M v[220:223], a[140:143], v[108:111], v[220:223]
v_cvt_pk_bf16_f32 v39, v54, v55
s_waitcnt lgkmcnt(6)
M a[108:111], a[112:115], v[108:111], a[108:111]
M a[108:111], a[112:115], v[140:143], a[108:111]
M v[224:227], a[148:151], v[96:99], v[224:227]
v_exp_f32 v40, v40
M v[224:227], a[152:155], v[128:131], v[224:227]
s_cmp_le_u32 s42, 1
s_cselect_b32 s33, 0x4000, 0
v_add_u32 v6, s33, v6
s_sub_u32 s42, s42, 1
M v[228:231], a[152:155], v[132:135], v[228:231]
v_exp_f32 v41, v41
M v[228:231], a[148:151], v[100:103], v[228:231]
v_cvt_pk_bf16_f32 v40, v40, v41
M v[232:235], a[148:151], v[104:107], v[232:235]
v_exp_f32 v42, v42
M v[232:235], a[152:155], v[136:139], v[232:235]
M v[236:239], a[152:155], v[140:143], v[236:239]
v_exp_f32 v43, v43
M v[236:239], a[148:151], v[108:111], v[236:239]
v_cvt_pk_bf16_f32 v41, v42, v43
s_waitcnt lgkmcnt(4)
M v[240:243], a[156:159], v[96:99], v[240:243]
v_exp_f32 v56, v56
M v[240:243], a[160:163], v[128:131], v[240:243]
M v[244:247], a[160:163], v[132:135], v[244:247]
v_exp_f32 v57, v57
M v[244:247], a[156:159], v[100:103], v[244:247]
v_cvt_pk_bf16_f32 v42, v56, v57
M v[248:251], a[156:159], v[104:107], v[248:251]
v_exp_f32 v58, v58
M v[248:251], a[160:163], v[136:139], v[248:251]
s_waitcnt vmcnt(0) lgkmcnt(0)
s_barrier
ds_read_b128 a[116:119], v2 offset:0
ds_read_b128 a[120:123], v2 offset:1024
M v[252:255], a[160:163], v[140:143], v[252:255]
v_exp_f32 v59, v59
M v[252:255], a[156:159], v[108:111], v[252:255]
v_cvt_pk_bf16_f32 v43, v58, v59
M a[64:67], a[164:167], v[96:99], a[64:67]
v_exp_f32 v44, v44
M a[64:67], a[168:171], v[128:131], a[64:67]
ds_read_b128 a[124:127], v2 offset:2048
ds_read_b128 a[128:131], v2 offset:3072
M a[68:71], a[168:171], v[132:135], a[68:71]
v_exp_f32 v45, v45
M a[68:71], a[164:167], v[100:103], a[68:71]
v_cvt_pk_bf16_f32 v44, v44, v45
M a[72:75], a[164:167], v[104:107], a[72:75]
v_exp_f32 v46, v46
M a[72:75], a[168:171], v[136:139], a[72:75]
ds_read_b128 a[132:135], v2 offset:4096
ds_read_b128 a[136:139], v2 offset:5120
M a[76:79], a[168:171], v[140:143], a[76:79]
v_exp_f32 v47, v47
M a[76:79], a[164:167], v[108:111], a[76:79]
v_cvt_pk_bf16_f32 v45, v46, v47
M a[80:83], a[172:175], v[96:99], a[80:83]
v_exp_f32 v60, v60
M a[80:83], a[176:179], v[128:131], a[80:83]
ds_read_b128 a[140:143], v2 offset:6144
ds_read_b128 a[144:147], v2 offset:7168
M a[84:87], a[176:179], v[132:135], a[84:87]
v_exp_f32 v61, v61
M a[84:87], a[172:175], v[100:103], a[84:87]
v_cvt_pk_bf16_f32 v46, v60, v61
M a[88:91], a[172:175], v[104:107], a[88:91]
v_exp_f32 v62, v62
M a[88:91], a[176:179], v[136:139], a[88:91]
M a[92:95], a[176:179], v[140:143], a[92:95]
v_exp_f32 v63, v63
M a[92:95], a[172:175], v[108:111], a[92:95]
v_cvt_pk_bf16_f32 v47, v62, v63
s_and_b32 s3, s2, 3
s_lshl_b32 s3, s3, 2
s_bfe_u32 s27, s2, 0x20003
s_add_u32 s27, s3, s27
s_lshl_b32 s43, s27, 8
s_add_u32 s43, s43, 8400896
v_lshlrev_b32 v15, 2, v0
buffer_load_dword v7, v15, s[52:55], s43 offen sc1
s_waitcnt lgkmcnt(7)
ds_read_b128 a[116:119], v5 offset:32768
s_waitcnt lgkmcnt(7)
ds_read_b128 a[120:123], v5 offset:40960
s_waitcnt lgkmcnt(7)
ds_read_b128 a[124:127], v5 offset:33792
s_waitcnt lgkmcnt(7)
ds_read_b128 a[128:131], v5 offset:41984
s_waitcnt lgkmcnt(7)
ds_read_b128 a[132:135], v5 offset:34816
s_waitcnt lgkmcnt(7)
ds_read_b128 a[136:139], v5 offset:43008
s_waitcnt lgkmcnt(7)
ds_read_b128 a[140:143], v5 offset:35840
s_waitcnt lgkmcnt(7)
ds_read_b128 a[144:147], v5 offset:44032
s_lshl_b32 s33, s23, 14
s_add_u32 s34, s33, 131072
s_add_u32 s33, s33, 98304
v_add_u32 v2, s34, v1
v_add_u32 v3, s33, v1
v_exp_f32 v64, v64
v_exp_f32 v65, v65
v_exp_f32 v66, v66
v_exp_f32 v67, v67
v_exp_f32 v80, v80
v_exp_f32 v81, v81
v_exp_f32 v82, v82
v_exp_f32 v83, v83
v_cvt_pk_bf16_f32 v64, v64, v65
v_cvt_pk_bf16_f32 v65, v66, v67
v_exp_f32 v68, v68
v_exp_f32 v69, v69
v_exp_f32 v70, v70
v_exp_f32 v71, v71
v_cvt_pk_bf16_f32 v66, v80, v81
v_cvt_pk_bf16_f32 v67, v82, v83
v_exp_f32 v84, v84
v_exp_f32 v85, v85
v_exp_f32 v86, v86
v_exp_f32 v87, v87
v_cvt_pk_bf16_f32 v68, v68, v69
v_cvt_pk_bf16_f32 v69, v70, v71
v_exp_f32 v72, v72
v_exp_f32 v73, v73
v_exp_f32 v74, v74
v_exp_f32 v75, v75
v_cvt_pk_bf16_f32 v70, v84, v85
v_cvt_pk_bf16_f32 v71, v86, v87
v_exp_f32 v88, v88
v_exp_f32 v89, v89
v_exp_f32 v90, v90
v_exp_f32 v91, v91
v_cvt_pk_bf16_f32 v72, v72, v73
v_cvt_pk_bf16_f32 v73, v74, v75
v_exp_f32 v76, v76
v_exp_f32 v77, v77
v_exp_f32 v78, v78
v_exp_f32 v79, v79
v_cvt_pk_bf16_f32 v74, v88, v89
v_cvt_pk_bf16_f32 v75, v90, v91
v_exp_f32 v92, v92
v_exp_f32 v93, v93
v_exp_f32 v94, v94
v_exp_f32 v95, v95
v_cvt_pk_bf16_f32 v76, v76, v77
v_cvt_pk_bf16_f32 v77, v78, v79
v_cvt_pk_bf16_f32 v78, v92, v93
v_cvt_pk_bf16_f32 v79, v94, v95
s_waitcnt lgkmcnt(6)
M v[160:163], a[116:119], v[32:35], v[160:163]
M v[160:163], a[120:123], v[64:67], v[160:163]
ds_read_b128 a[148:151], v5 offset:36864
ds_read_b128 a[152:155], v5 offset:45056
s_mov_b32 s61, 0
M v[164:167], a[120:123], v[68:71], v[164:167]
M v[164:167], a[116:119], v[36:39], v[164:167]
s_bfe_u32 s3, s2, 0x10002
M v[168:171], a[116:119], v[40:43], v[168:171]
M v[168:171], a[120:123], v[72:75], v[168:171]
s_lshl_b32 s3, s3, 3
M v[172:175], a[120:123], v[76:79], v[172:175]
M v[172:175], a[116:119], v[44:47], v[172:175]
s_waitcnt lgkmcnt(6)
s_lshr_b32 s28, s2, 5
M a[96:99], a[112:115], v[32:35], a[96:99]
M a[96:99], a[112:115], v[64:67], a[96:99]
M v[176:179], a[124:127], v[32:35], v[176:179]
M v[176:179], a[128:131], v[64:67], v[176:179]
ds_read_b128 a[156:159], v5 offset:37888
ds_read_b128 a[160:163], v5 offset:46080
s_add_u32 s28, s3, s28
M v[180:183], a[128:131], v[68:71], v[180:183]
s_lshl_b32 s25, s27, 18
M v[180:183], a[124:127], v[36:39], v[180:183]
M v[184:187], a[124:127], v[40:43], v[184:187]
s_lshl_b32 s3, s101, 12
M v[184:187], a[128:131], v[72:75], v[184:187]
M v[188:191], a[128:131], v[76:79], v[188:191]
s_add_u32 s25, s25, s3
M v[188:191], a[124:127], v[44:47], v[188:191]
s_waitcnt lgkmcnt(6)
M a[100:103], a[112:115], v[36:39], a[100:103]
M a[100:103], a[112:115], v[68:71], a[100:103]
M v[192:195], a[132:135], v[32:35], v[192:195]
s_lshl_b32 s26, s28, 7
M v[192:195], a[136:139], v[64:67], v[192:195]
ds_read_b128 a[164:167], v5 offset:38912
ds_read_b128 a[168:171], v5 offset:47104
M v[196:199], a[136:139], v[68:71], v[196:199]
s_lshl_b32 s42, s101, 11
M v[196:199], a[132:135], v[36:39], v[196:199]
M v[200:203], a[132:135], v[40:43], v[200:203]
s_add_u32 s44, s4, 83886080
s_addc_u32 s45, s5, 0
M v[200:203], a[136:139], v[72:75], v[200:203]
s_mov_b32 s46, 4194304
M v[204:207], a[136:139], v[76:79], v[204:207]
M v[204:207], a[132:135], v[44:47], v[204:207]
s_waitcnt lgkmcnt(6)
s_mov_b32 s47, 0x00020000
M a[104:107], a[112:115], v[40:43], a[104:107]
M a[104:107], a[112:115], v[72:75], a[104:107]
M v[208:211], a[140:143], v[32:35], v[208:211]
M v[208:211], a[144:147], v[64:67], v[208:211]
ds_read_b128 a[172:175], v5 offset:39936
ds_read_b128 a[176:179], v5 offset:48128
s_mov_b32 s50, 2097152
M v[212:215], a[144:147], v[68:71], v[212:215]
M v[212:215], a[140:143], v[36:39], v[212:215]
s_mov_b32 s51, 0x00020000
M v[216:219], a[140:143], v[40:43], v[216:219]
M v[216:219], a[144:147], v[72:75], v[216:219]
s_lshl_b32 s3, s101, 4
M v[220:223], a[144:147], v[76:79], v[220:223]
M v[220:223], a[140:143], v[44:47], v[220:223]
s_waitcnt lgkmcnt(6)
v_lshrrev_b32 v96, 3, v0
M a[108:111], a[112:115], v[44:47], a[108:111]
M a[108:111], a[112:115], v[76:79], a[108:111]
M v[224:227], a[148:151], v[32:35], v[224:227]
v_and_b32 v97, 6, v96
M v[224:227], a[152:155], v[64:67], v[224:227]
M v[228:231], a[152:155], v[68:71], v[228:231]
ds_write_b128 v2, v[160:163] offset:0
v_and_b32 v98, 7, v0
M v[228:231], a[148:151], v[36:39], v[228:231]
M v[232:235], a[148:151], v[40:43], v[232:235]
ds_write_b128 v2, v[164:167] offset:1024
v_xor_b32 v97, v97, v98
M v[232:235], a[152:155], v[72:75], v[232:235]
M v[236:239], a[152:155], v[76:79], v[236:239]
ds_write_b128 v2, v[168:171] offset:2048
v_add_u32 v96, s3, v96
M v[236:239], a[148:151], v[44:47], v[236:239]
s_waitcnt lgkmcnt(7)
M v[240:243], a[156:159], v[32:35], v[240:243]
ds_write_b128 v2, v[172:175] offset:3072
v_lshlrev_b32 v96, 11, v96
M v[240:243], a[160:163], v[64:67], v[240:243]
M v[244:247], a[160:163], v[68:71], v[244:247]
ds_write_b128 v2, v[176:179] offset:4096
v_lshl_add_u32 v99, v97, 4, v96
M v[244:247], a[156:159], v[36:39], v[244:247]
v_add_u32 v100, 15360, v99
M v[248:251], a[156:159], v[40:43], v[248:251]
ds_write_b128 v2, v[180:183] offset:5120
M v[248:251], a[160:163], v[72:75], v[248:251]
s_waitcnt vmcnt(0) lgkmcnt(0)
s_barrier
v_cmp_ne_u32 vcc, 1, v7
s_nop 0
s_cbranch_vccnz Lk3_spinb2
Lk3_gotb2:
M v[252:255], a[160:163], v[76:79], v[252:255]
ds_write_b128 v2, v[184:187] offset:6144
s_add_u32 m0, s42, 16384
s_nop 0
buffer_load_dwordx4 v99, s[48:51], s26 offen offset:0 lds
buffer_load_dwordx4 v100, s[48:51], s26 offen offset:1024 lds
M v[252:255], a[156:159], v[44:47], v[252:255]
buffer_load_dwordx4 a[192:195], v1, s[44:47], s25 offen offset:0 sc1
buffer_load_dwordx4 a[196:199], v1, s[44:47], s25 offen offset:1024 sc1
M a[64:67], a[164:167], v[32:35], a[64:67]
ds_write_b128 v2, v[188:191] offset:7168
buffer_load_dwordx4 a[200:203], v1, s[44:47], s25 offen offset:2048 sc1
buffer_load_dwordx4 a[204:207], v1, s[44:47], s25 offen offset:3072 sc1
M a[64:67], a[168:171], v[64:67], a[64:67]
s_add_u32 s25, s25, 16384
s_add_u32 s26, s26, 131072
s_add_u32 m0, s42, 32768
s_nop 0
buffer_load_dwordx4 v99, s[48:51], s26 offen offset:0 lds
M a[68:71], a[168:171], v[68:71], a[68:71]
ds_write_b128 v2, v[192:195] offset:8192
buffer_load_dwordx4 v100, s[48:51], s26 offen offset:1024 lds
buffer_load_dwordx4 a[208:211], v1, s[44:47], s25 offen offset:0 sc1
M a[68:71], a[164:167], v[36:39], a[68:71]
buffer_load_dwordx4 a[212:215], v1, s[44:47], s25 offen offset:1024 sc1
buffer_load_dwordx4 a[216:219], v1, s[44:47], s25 offen offset:2048 sc1
M a[72:75], a[164:167], v[40:43], a[72:75]
ds_write_b128 v2, v[196:199] offset:9216
buffer_load_dwordx4 a[220:223], v1, s[44:47], s25 offen offset:3072 sc1
s_add_u32 s25, s25, 16384
s_add_u32 s26, s26, 131072
M a[72:75], a[168:171], v[72:75], a[72:75]
s_add_u32 m0, s42, 49152
s_nop 0
buffer_load_dwordx4 v99, s[48:51], s26 offen offset:0 lds
buffer_load_dwordx4 v100, s[48:51], s26 offen offset:1024 lds
M a[76:79], a[168:171], v[76:79], a[76:79]
ds_write_b128 v2, v[200:203] offset:10240
buffer_load_dwordx4 a[224:227], v1, s[44:47], s25 offen offset:0 sc1
M a[76:79], a[164:167], v[44:47], a[76:79]
buffer_load_dwordx4 a[228:231], v1, s[44:47], s25 offen offset:1024 sc1
buffer_load_dwordx4 a[232:235], v1, s[44:47], s25 offen offset:2048 sc1
M a[80:83], a[172:175], v[32:35], a[80:83]
ds_write_b128 v2, v[204:207] offset:11264
buffer_load_dwordx4 a[236:239], v1, s[44:47], s25 offen offset:3072 sc1
s_add_u32 s25, s25, 16384
s_add_u32 s26, s26, 131072
M a[80:83], a[176:179], v[64:67], a[80:83]
s_add_u32 m0, s42, 65536
s_nop 0
buffer_load_dwordx4 v99, s[48:51], s26 offen offset:0 lds
buffer_load_dwordx4 v100, s[48:51], s26 offen offset:1024 lds
M a[84:87], a[176:179], v[68:71], a[84:87]
ds_write_b128 v2, v[208:211] offset:12288
buffer_load_dwordx4 a[240:243], v1, s[44:47], s25 offen offset:0 sc1
buffer_load_dwordx4 a[244:247], v1, s[44:47], s25 offen offset:1024 sc1
M a[84:87], a[172:175], v[36:39], a[84:87]
buffer_load_dwordx4 a[248:251], v1, s[44:47], s25 offen offset:2048 sc1
buffer_load_dwordx4 a[252:255], v1, s[44:47], s25 offen offset:3072 sc1
M a[88:91], a[172:175], v[40:43], a[88:91]
ds_write_b128 v2, v[212:215] offset:13312
s_add_u32 s25, s25, 16384
s_add_u32 s26, s26, 131072
s_add_u32 m0, s42, 81920
s_nop 0
buffer_load_dwordx4 v99, s[48:51], s26 offen offset:0 lds
M a[88:91], a[176:179], v[72:75], a[88:91]
buffer_load_dwordx4 v100, s[48:51], s26 offen offset:1024 lds
buffer_load_dwordx4 a[128:131], v1, s[44:47], s25 offen offset:0 sc1
M a[92:95], a[176:179], v[76:79], a[92:95]
ds_write_b128 v2, v[216:219] offset:14336
buffer_load_dwordx4 a[132:135], v1, s[44:47], s25 offen offset:1024 sc1
buffer_load_dwordx4 a[136:139], v1, s[44:47], s25 offen offset:2048 sc1
M a[92:95], a[172:175], v[44:47], a[92:95]
buffer_load_dwordx4 a[140:143], v1, s[44:47], s25 offen offset:3072 sc1
s_add_u32 s25, s25, 16384
s_add_u32 s26, s26, 131072
ds_write_b128 v2, v[220:223] offset:15360
s_lshl_b32 s33, s22, 10
s_add_u32 s33, s33, 28672
s_xor_b32 s34, s33, 2048
v_add_u32 v14, s33, v1
v_add_u32 v15, s34, v1
v_accvgpr_read_b32 v20, a96
v_accvgpr_read_b32 v21, a100
v_accvgpr_read_b32 v22, a104
v_accvgpr_read_b32 v23, a108
ds_write_b128 v14, v[20:23]
s_waitcnt lgkmcnt(0)
s_barrier
ds_read_b128 v[28:31], v15
ds_read_b128 v[32:35], v3 offset:0
ds_read_b128 v[36:39], v3 offset:1024
ds_read_b128 v[40:43], v3 offset:2048
ds_read_b128 v[44:47], v3 offset:3072
ds_read_b128 v[48:51], v3 offset:4096
ds_read_b128 v[52:55], v3 offset:5120
ds_read_b128 v[56:59], v3 offset:6144
ds_read_b128 v[60:63], v3 offset:7168
ds_read_b128 v[64:67], v3 offset:8192
ds_read_b128 v[68:71], v3 offset:9216
ds_read_b128 v[72:75], v3 offset:10240
ds_read_b128 v[76:79], v3 offset:11264
ds_read_b128 v[80:83], v3 offset:12288
ds_read_b128 v[84:87], v3 offset:13312
ds_read_b128 v[88:91], v3 offset:14336
ds_read_b128 v[92:95], v3 offset:15360
s_waitcnt lgkmcnt(15)
v_add_f32 v20, v20, v28
v_add_f32 v21, v21, v29
v_add_f32 v22, v22, v30
v_add_f32 v23, v23, v31
s_sub_u32 s35, 15, s21
v_rcp_f32 v8, v20
v_rcp_f32 v9, v21
v_rcp_f32 v10, v22
v_rcp_f32 v11, v23
v_subrev_u32 v20, 0x21800000, v20
v_subrev_u32 v21, 0x21800000, v21
v_subrev_u32 v22, 0x21800000, v22
v_subrev_u32 v23, 0x21800000, v23
v_max_u32 v12, v20, v21
v_max3_u32 v12, v12, v22, v23
s_mov_b32 s64, 0x207
s_lshl_b32 s33, s35, 20
s_lshl_b32 s34, s20, 15
s_add_u32 s33, s33, s34
s_lshl_b32 s34, s23, 13
s_add_u32 s36, s33, s34
s_add_u32 s37, s36, 4096
s_add_u32 s38, s36, 16384
s_add_u32 s39, s36, 20480
v_pk_add_f32 v[224:225], v[224:225], v[32:33]
v_pk_add_f32 v[226:227], v[226:227], v[34:35]
s_waitcnt lgkmcnt(11)
v_pk_add_f32 v[240:241], v[240:241], v[48:49]
v_pk_add_f32 v[242:243], v[242:243], v[50:51]
v_pk_mul_f32 v[224:225], v[224:225], v[8:9] op_sel:[0,0] op_sel_hi:[1,0]
v_pk_mul_f32 v[226:227], v[226:227], v[8:9] op_sel:[0,0] op_sel_hi:[1,0]
v_pk_mul_f32 v[240:241], v[240:241], v[8:9] op_sel:[0,0] op_sel_hi:[1,0]
v_pk_mul_f32 v[242:243], v[242:243], v[8:9] op_sel:[0,0] op_sel_hi:[1,0]
v_cvt_pk_bf16_f32 v224, v224, v225
v_cvt_pk_bf16_f32 v225, v226, v227
v_cvt_pk_bf16_f32 v226, v240, v241
v_cvt_pk_bf16_f32 v227, v242, v243
v_pk_add_f32 v[228:229], v[228:229], v[36:37]
v_pk_add_f32 v[230:231], v[230:231], v[38:39]
s_waitcnt lgkmcnt(10)
v_pk_add_f32 v[244:245], v[244:245], v[52:53]
v_pk_add_f32 v[246:247], v[246:247], v[54:55]
M v[24:27], a[112:115], v[224:227], 0
buffer_store_dwordx4 v[224:227], v1, s[16:19], s38 offen offset:0 sc1
v_pk_mul_f32 v[228:229], v[228:229], v[8:9] op_sel:[0,1] op_sel_hi:[1,1]
v_pk_mul_f32 v[230:231], v[230:231], v[8:9] op_sel:[0,1] op_sel_hi:[1,1]
v_pk_mul_f32 v[244:245], v[244:245], v[8:9] op_sel:[0,1] op_sel_hi:[1,1]
v_pk_mul_f32 v[246:247], v[246:247], v[8:9] op_sel:[0,1] op_sel_hi:[1,1]
v_cvt_pk_bf16_f32 v228, v228, v229
v_cvt_pk_bf16_f32 v229, v230, v231
v_cvt_pk_bf16_f32 v230, v244, v245
v_cvt_pk_bf16_f32 v231, v246, v247
v_pk_add_f32 v[232:233], v[232:233], v[40:41]
v_pk_add_f32 v[234:235], v[234:235], v[42:43]
s_waitcnt lgkmcnt(9)
v_pk_add_f32 v[248:249], v[248:249], v[56:57]
v_pk_add_f32 v[250:251], v[250:251], v[58:59]
M v[24:27], a[112:115], v[228:231], v[24:27]
buffer_store_dwordx4 v[228:231], v1, s[16:19], s38 offen offset:2048 sc1
v_pk_mul_f32 v[232:233], v[232:233], v[10:11] op_sel:[0,0] op_sel_hi:[1,0]
v_pk_mul_f32 v[234:235], v[234:235], v[10:11] op_sel:[0,0] op_sel_hi:[1,0]
v_pk_mul_f32 v[248:249], v[248:249], v[10:11] op_sel:[0,0] op_sel_hi:[1,0]
v_pk_mul_f32 v[250:251], v[250:251], v[10:11] op_sel:[0,0] op_sel_hi:[1,0]
v_cvt_pk_bf16_f32 v232, v232, v233
v_cvt_pk_bf16_f32 v233, v234, v235
v_cvt_pk_bf16_f32 v234, v248, v249
v_cvt_pk_bf16_f32 v235, v250, v251
v_pk_add_f32 v[236:237], v[236:237], v[44:45]
v_pk_add_f32 v[238:239], v[238:239], v[46:47]
s_waitcnt lgkmcnt(8)
v_pk_add_f32 v[252:253], v[252:253], v[60:61]
v_pk_add_f32 v[254:255], v[254:255], v[62:63]
M v[24:27], a[112:115], v[232:235], v[24:27]
buffer_store_dwordx4 v[232:235], v1, s[16:19], s39 offen offset:0 sc1
v_pk_mul_f32 v[236:237], v[236:237], v[10:11] op_sel:[0,1] op_sel_hi:[1,1]
v_pk_mul_f32 v[238:239], v[238:239], v[10:11] op_sel:[0,1] op_sel_hi:[1,1]
v_pk_mul_f32 v[252:253], v[252:253], v[10:11] op_sel:[0,1] op_sel_hi:[1,1]
v_pk_mul_f32 v[254:255], v[254:255], v[10:11] op_sel:[0,1] op_sel_hi:[1,1]
v_cvt_pk_bf16_f32 v236, v236, v237
v_cvt_pk_bf16_f32 v237, v238, v239
v_cvt_pk_bf16_f32 v238, v252, v253
v_cvt_pk_bf16_f32 v239, v254, v255
v_accvgpr_read_b32 v32, a64
v_accvgpr_read_b32 v33, a65
v_accvgpr_read_b32 v34, a66
v_accvgpr_read_b32 v35, a67
s_waitcnt lgkmcnt(7)
v_pk_add_f32 v[32:33], v[32:33], v[64:65]
v_pk_add_f32 v[34:35], v[34:35], v[66:67]
v_accvgpr_read_b32 v48, a80
v_accvgpr_read_b32 v49, a81
v_accvgpr_read_b32 v50, a82
v_accvgpr_read_b32 v51, a83
s_waitcnt lgkmcnt(3)
v_pk_add_f32 v[48:49], v[48:49], v[80:81]
v_pk_add_f32 v[50:51], v[50:51], v[82:83]
M v[24:27], a[112:115], v[236:239], v[24:27]
buffer_store_dwordx4 v[236:239], v1, s[16:19], s39 offen offset:2048 sc1
v_pk_mul_f32 v[32:33], v[32:33], v[8:9] op_sel:[0,0] op_sel_hi:[1,0]
v_pk_mul_f32 v[34:35], v[34:35], v[8:9] op_sel:[0,0] op_sel_hi:[1,0]
v_pk_mul_f32 v[48:49], v[48:49], v[8:9] op_sel:[0,0] op_sel_hi:[1,0]
v_pk_mul_f32 v[50:51], v[50:51], v[8:9] op_sel:[0,0] op_sel_hi:[1,0]
v_cvt_pk_bf16_f32 v32, v32, v33
v_cvt_pk_bf16_f32 v33, v34, v35
v_cvt_pk_bf16_f32 v34, v48, v49
v_cvt_pk_bf16_f32 v35, v50, v51
v_accvgpr_read_b32 v240, a68
v_accvgpr_read_b32 v241, a69
v_accvgpr_read_b32 v242, a70
v_accvgpr_read_b32 v243, a71
v_pk_add_f32 v[240:241], v[240:241], v[68:69]
v_pk_add_f32 v[242:243], v[242:243], v[70:71]
v_accvgpr_read_b32 v36, a84
v_accvgpr_read_b32 v37, a85
v_accvgpr_read_b32 v38, a86
v_accvgpr_read_b32 v39, a87
s_waitcnt lgkmcnt(2)
v_pk_add_f32 v[36:37], v[36:37], v[84:85]
v_pk_add_f32 v[38:39], v[38:39], v[86:87]
M v[24:27], a[112:115], v[32:35], v[24:27]
buffer_store_dwordx4 v[32:35], v1, s[16:19], s38 offen offset:1024 sc1
v_pk_mul_f32 v[240:241], v[240:241], v[8:9] op_sel:[0,1] op_sel_hi:[1,1]
v_pk_mul_f32 v[242:243], v[242:243], v[8:9] op_sel:[0,1] op_sel_hi:[1,1]
v_pk_mul_f32 v[36:37], v[36:37], v[8:9] op_sel:[0,1] op_sel_hi:[1,1]
v_pk_mul_f32 v[38:39], v[38:39], v[8:9] op_sel:[0,1] op_sel_hi:[1,1]
v_cvt_pk_bf16_f32 v240, v240, v241
v_cvt_pk_bf16_f32 v241, v242, v243
v_cvt_pk_bf16_f32 v242, v36, v37
v_cvt_pk_bf16_f32 v243, v38, v39
v_accvgpr_read_b32 v52, a72
v_accvgpr_read_b32 v53, a73
v_accvgpr_read_b32 v54, a74
v_accvgpr_read_b32 v55, a75
v_pk_add_f32 v[52:53], v[52:53], v[72:73]
v_pk_add_f32 v[54:55], v[54:55], v[74:75]
v_accvgpr_read_b32 v244, a88
v_accvgpr_read_b32 v245, a89
v_accvgpr_read_b32 v246, a90
v_accvgpr_read_b32 v247, a91
s_waitcnt lgkmcnt(1)
v_pk_add_f32 v[244:245], v[244:245], v[88:89]
v_pk_add_f32 v[246:247], v[246:247], v[90:91]
M v[24:27], a[112:115], v[240:243], v[24:27]
buffer_store_dwordx4 v[240:243], v1, s[16:19], s38 offen offset:3072 sc1
v_pk_mul_f32 v[52:53], v[52:53], v[10:11] op_sel:[0,0] op_sel_hi:[1,0]
v_pk_mul_f32 v[54:55], v[54:55], v[10:11] op_sel:[0,0] op_sel_hi:[1,0]
v_pk_mul_f32 v[244:245], v[244:245], v[10:11] op_sel:[0,0] op_sel_hi:[1,0]
v_pk_mul_f32 v[246:247], v[246:247], v[10:11] op_sel:[0,0] op_sel_hi:[1,0]
v_cvt_pk_bf16_f32 v52, v52, v53
v_cvt_pk_bf16_f32 v53, v54, v55
v_cvt_pk_bf16_f32 v54, v244, v245
v_cvt_pk_bf16_f32 v55, v246, v247
v_accvgpr_read_b32 v40, a76
v_accvgpr_read_b32 v41, a77
v_accvgpr_read_b32 v42, a78
v_accvgpr_read_b32 v43, a79
v_pk_add_f32 v[40:41], v[40:41], v[76:77]
v_pk_add_f32 v[42:43], v[42:43], v[78:79]
v_accvgpr_read_b32 v56, a92
v_accvgpr_read_b32 v57, a93
v_accvgpr_read_b32 v58, a94
v_accvgpr_read_b32 v59, a95
s_waitcnt lgkmcnt(0)
v_pk_add_f32 v[56:57], v[56:57], v[92:93]
v_pk_add_f32 v[58:59], v[58:59], v[94:95]
M v[24:27], a[112:115], v[52:55], v[24:27]
buffer_store_dwordx4 v[52:55], v1, s[16:19], s39 offen offset:1024 sc1
v_pk_mul_f32 v[40:41], v[40:41], v[10:11] op_sel:[0,1] op_sel_hi:[1,1]
v_pk_mul_f32 v[42:43], v[42:43], v[10:11] op_sel:[0,1] op_sel_hi:[1,1]
v_pk_mul_f32 v[56:57], v[56:57], v[10:11] op_sel:[0,1] op_sel_hi:[1,1]
v_pk_mul_f32 v[58:59], v[58:59], v[10:11] op_sel:[0,1] op_sel_hi:[1,1]
v_cvt_pk_bf16_f32 v40, v40, v41
v_cvt_pk_bf16_f32 v41, v42, v43
v_cvt_pk_bf16_f32 v42, v56, v57
v_cvt_pk_bf16_f32 v43, v58, v59
s_nop 1
M v[24:27], a[112:115], v[40:43], v[24:27]
buffer_store_dwordx4 v[40:43], v1, s[16:19], s39 offen offset:3072 sc1
v_cmp_lt_u32 vcc, 0x3c000000, v12
s_nop 5
v_cmp_class_f32 s[40:41], v24, s64
s_nop 0
s_or_b64 vcc, vcc, s[40:41]
s_cmp_lg_u64 vcc, 0
s_cselect_b32 s33, 2, 0
s_or_b32 s60, s60, s33
Lk2_chk:
s_cmp_eq_u32 s60, 0
s_cbranch_scc1 Lk2_done
s_sub_u32 s56, 15, s21
s_lshl_b32 s33, s24, 1
s_lshl_b32 s61, 3, s33
s_and_b32 s34, s60, 2
s_bitcmp1_b32 s60, 0
s_cselect_b32 s56, s21, s56
s_cselect_b32 s61, 15, s61
s_cselect_b32 s60, s34, 0
s_waitcnt vmcnt(0)
s_lshl_b32 s33, s20, 7
s_lshl_b32 s34, s56, 3
s_add_u32 s33, s33, s34
s_lshl_b32 s34, s23, 2
s_add_u32 s33, s33, s34
s_lshl_b32 s33, s33, 12
buffer_load_dwordx4 a[0:3], v1, s[8:11], s33 offen offset:0 sc1
buffer_load_dwordx4 a[4:7], v1, s[8:11], s33 offen offset:1024 sc1
buffer_load_dwordx4 a[8:11], v1, s[8:11], s33 offen offset:2048 sc1
buffer_load_dwordx4 a[12:15], v1, s[8:11], s33 offen offset:3072 sc1
s_add_u32 s33, s33, 4096
buffer_load_dwordx4 a[16:19], v1, s[8:11], s33 offen offset:0 sc1
buffer_load_dwordx4 a[20:23], v1, s[8:11], s33 offen offset:1024 sc1
buffer_load_dwordx4 a[24:27], v1, s[8:11], s33 offen offset:2048 sc1
buffer_load_dwordx4 a[28:31], v1, s[8:11], s33 offen offset:3072 sc1
s_add_u32 s33, s33, 4096
buffer_load_dwordx4 a[32:35], v1, s[8:11], s33 offen offset:0 sc1
buffer_load_dwordx4 a[36:39], v1, s[8:11], s33 offen offset:1024 sc1
buffer_load_dwordx4 a[40:43], v1, s[8:11], s33 offen offset:2048 sc1
buffer_load_dwordx4 a[44:47], v1, s[8:11], s33 offen offset:3072 sc1
s_add_u32 s33, s33, 4096
buffer_load_dwordx4 a[48:51], v1, s[8:11], s33 offen offset:0 sc1
buffer_load_dwordx4 a[52:55], v1, s[8:11], s33 offen offset:1024 sc1
buffer_load_dwordx4 a[56:59], v1, s[8:11], s33 offen offset:2048 sc1
buffer_load_dwordx4 a[60:63], v1, s[8:11], s33 offen offset:3072 sc1
v_accvgpr_write_b32 a64, 0
v_accvgpr_write_b32 a65, 0
v_accvgpr_write_b32 a66, 0
v_accvgpr_write_b32 a67, 0
v_accvgpr_write_b32 a68, 0
v_accvgpr_write_b32 a69, 0
v_accvgpr_write_b32 a70, 0
v_accvgpr_write_b32 a71, 0
v_accvgpr_write_b32 a72, 0
v_accvgpr_write_b32 a73, 0
v_accvgpr_write_b32 a74, 0
v_accvgpr_write_b32 a75, 0
v_accvgpr_write_b32 a76, 0
v_accvgpr_write_b32 a77, 0
v_accvgpr_write_b32 a78, 0
v_accvgpr_write_b32 a79, 0
v_accvgpr_write_b32 a80, 0
v_accvgpr_write_b32 a81, 0
v_accvgpr_write_b32 a82, 0
v_accvgpr_write_b32 a83, 0
v_accvgpr_write_b32 a84, 0
v_accvgpr_write_b32 a85, 0
v_accvgpr_write_b32 a86, 0
v_accvgpr_write_b32 a87, 0
v_accvgpr_write_b32 a88, 0
v_accvgpr_write_b32 a89, 0
v_accvgpr_write_b32 a90, 0
v_accvgpr_write_b32 a91, 0
v_accvgpr_write_b32 a92, 0
v_accvgpr_write_b32 a93, 0
v_accvgpr_write_b32 a94, 0
v_accvgpr_write_b32 a95, 0
v_accvgpr_write_b32 a96, 0
v_accvgpr_write_b32 a97, 0
v_accvgpr_write_b32 a98, 0
v_accvgpr_write_b32 a99, 0
v_accvgpr_write_b32 a100, 0
v_accvgpr_write_b32 a101, 0
v_accvgpr_write_b32 a102, 0
v_accvgpr_write_b32 a103, 0
v_accvgpr_write_b32 a104, 0
v_accvgpr_write_b32 a105, 0
v_accvgpr_write_b32 a106, 0
v_accvgpr_write_b32 a107, 0
v_accvgpr_write_b32 a108, 0
v_accvgpr_write_b32 a109, 0
v_accvgpr_write_b32 a110, 0
v_accvgpr_write_b32 a111, 0
v_mov_b32 v160, 0
v_mov_b32 v161, 0
v_mov_b32 v162, 0
v_mov_b32 v163, 0
v_mov_b32 v164, 0
v_mov_b32 v165, 0
v_mov_b32 v166, 0
v_mov_b32 v167, 0
v_mov_b32 v168, 0
v_mov_b32 v169, 0
v_mov_b32 v170, 0
v_mov_b32 v171, 0
v_mov_b32 v172, 0
v_mov_b32 v173, 0
v_mov_b32 v174, 0
v_mov_b32 v175, 0
v_mov_b32 v176, 0
v_mov_b32 v177, 0
v_mov_b32 v178, 0
v_mov_b32 v179, 0
v_mov_b32 v180, 0
v_mov_b32 v181, 0
v_mov_b32 v182, 0
v_mov_b32 v183, 0
v_mov_b32 v184, 0
v_mov_b32 v185, 0
v_mov_b32 v186, 0
v_mov_b32 v187, 0
v_mov_b32 v188, 0
v_mov_b32 v189, 0
v_mov_b32 v190, 0
v_mov_b32 v191, 0
v_mov_b32 v192, 0
v_mov_b32 v193, 0
v_mov_b32 v194, 0
v_mov_b32 v195, 0
v_mov_b32 v196, 0
v_mov_b32 v197, 0
v_mov_b32 v198, 0
v_mov_b32 v199, 0
v_mov_b32 v200, 0
v_mov_b32 v201, 0
v_mov_b32 v202, 0
v_mov_b32 v203, 0
v_mov_b32 v204, 0
v_mov_b32 v205, 0
v_mov_b32 v206, 0
v_mov_b32 v207, 0
v_mov_b32 v208, 0
v_mov_b32 v209, 0
v_mov_b32 v210, 0
v_mov_b32 v211, 0
v_mov_b32 v212, 0
v_mov_b32 v213, 0
v_mov_b32 v214, 0
v_mov_b32 v215, 0
v_mov_b32 v216, 0
v_mov_b32 v217, 0
v_mov_b32 v218, 0
v_mov_b32 v219, 0
v_mov_b32 v220, 0
v_mov_b32 v221, 0
v_mov_b32 v222, 0
v_mov_b32 v223, 0
v_mov_b32 v224, 0
v_mov_b32 v225, 0
v_mov_b32 v226, 0
v_mov_b32 v227, 0
v_mov_b32 v228, 0
v_mov_b32 v229, 0
v_mov_b32 v230, 0
v_mov_b32 v231, 0
v_mov_b32 v232, 0
v_mov_b32 v233, 0
v_mov_b32 v234, 0
v_mov_b32 v235, 0
v_mov_b32 v236, 0
v_mov_b32 v237, 0
v_mov_b32 v238, 0
v_mov_b32 v239, 0
v_mov_b32 v240, 0
v_mov_b32 v241, 0
v_mov_b32 v242, 0
v_mov_b32 v243, 0
v_mov_b32 v244, 0
v_mov_b32 v245, 0
v_mov_b32 v246, 0
v_mov_b32 v247, 0
v_mov_b32 v248, 0
v_mov_b32 v249, 0
v_mov_b32 v250, 0
v_mov_b32 v251, 0
v_mov_b32 v252, 0
v_mov_b32 v253, 0
v_mov_b32 v254, 0
v_mov_b32 v255, 0
v_mov_b32 v8, v4
v_mov_b32 v9, v4
v_mov_b32 v10, v4
v_mov_b32 v11, v4
s_lshl_b32 s57, s20, 20
s_lshl_b32 s58, s56, 7
s_lshl_b32 s59, s56, 1
s_add_u32 s59, s59, 2
Lslow_2:
s_add_u32 s35, s57, 0
buffer_load_dwordx4 v[96:99], v1, s[12:15], s35 offen offset:0 sc1
buffer_load_dwordx4 v[100:103], v1, s[12:15], s35 offen offset:1024 sc1
buffer_load_dwordx4 v[104:107], v1, s[12:15], s35 offen offset:2048 sc1
buffer_load_dwordx4 v[108:111], v1, s[12:15], s35 offen offset:3072 sc1
s_add_u32 s35, s57, 4096
buffer_load_dwordx4 v[112:115], v1, s[12:15], s35 offen offset:0 sc1
buffer_load_dwordx4 v[116:119], v1, s[12:15], s35 offen offset:1024 sc1
buffer_load_dwordx4 v[120:123], v1, s[12:15], s35 offen offset:2048 sc1
buffer_load_dwordx4 v[124:127], v1, s[12:15], s35 offen offset:3072 sc1
s_add_u32 s35, s57, 8192
buffer_load_dwordx4 v[128:131], v1, s[12:15], s35 offen offset:0 sc1
buffer_load_dwordx4 v[132:135], v1, s[12:15], s35 offen offset:1024 sc1
buffer_load_dwordx4 v[136:139], v1, s[12:15], s35 offen offset:2048 sc1
buffer_load_dwordx4 v[140:143], v1, s[12:15], s35 offen offset:3072 sc1
s_add_u32 s35, s57, 12288
buffer_load_dwordx4 v[144:147], v1, s[12:15], s35 offen offset:0 sc1
buffer_load_dwordx4 v[148:151], v1, s[12:15], s35 offen offset:1024 sc1
buffer_load_dwordx4 v[152:155], v1, s[12:15], s35 offen offset:2048 sc1
buffer_load_dwordx4 v[156:159], v1, s[12:15], s35 offen offset:3072 sc1
s_lshl_b32 s33, s23, 6
s_add_i32 s33, s33, s58
s_cmp_gt_i32 s33, 0
s_cselect_b32 s34, 0, 0xf149f2ca
s_cmp_lt_i32 s33, 0
s_cselect_b32 s33, 0xf149f2ca, 0
v_mov_b32 v20, s34
v_mov_b32 v21, s34
v_mov_b32 v22, s34
v_mov_b32 v23, s34
v_mov_b32 v28, s33
v_mov_b32 v29, s33
v_mov_b32 v30, s33
v_mov_b32 v31, s33
v_med3_f32 v24, v16, v20, v28
v_med3_f32 v25, v17, v20, v28
v_med3_f32 v26, v18, v20, v28
v_med3_f32 v27, v19, v20, v28
s_waitcnt vmcnt(0)
s_nop 0
M v[32:35], v[96:99], a[0:3], v[24:27]
M v[32:35], v[100:103], a[4:7], v[32:35]
M v[32:35], v[104:107], a[8:11], v[32:35]
M v[32:35], v[108:111], a[12:15], v[32:35]
M v[36:39], v[96:99], a[16:19], v[28:31]
M v[36:39], v[100:103], a[20:23], v[36:39]
M v[36:39], v[104:107], a[24:27], v[36:39]
M v[36:39], v[108:111], a[28:31], v[36:39]
M v[40:43], v[96:99], a[32:35], v[28:31]
M v[40:43], v[100:103], a[36:39], v[40:43]
M v[40:43], v[104:107], a[40:43], v[40:43]
M v[40:43], v[108:111], a[44:47], v[40:43]
M v[44:47], v[96:99], a[48:51], v[28:31]
M v[44:47], v[100:103], a[52:55], v[44:47]
M v[44:47], v[104:107], a[56:59], v[44:47]
M v[44:47], v[108:111], a[60:63], v[44:47]
M v[48:51], v[112:115], a[0:3], v[20:23]
M v[48:51], v[116:119], a[4:7], v[48:51]
M v[48:51], v[120:123], a[8:11], v[48:51]
M v[48:51], v[124:127], a[12:15], v[48:51]
M v[52:55], v[112:115], a[16:19], v[24:27]
M v[52:55], v[116:119], a[20:23], v[52:55]
M v[52:55], v[120:123], a[24:27], v[52:55]
M v[52:55], v[124:127], a[28:31], v[52:55]
M v[56:59], v[112:115], a[32:35], v[28:31]
M v[56:59], v[116:119], a[36:39], v[56:59]
M v[56:59], v[120:123], a[40:43], v[56:59]
M v[56:59], v[124:127], a[44:47], v[56:59]
M v[60:63], v[112:115], a[48:51], v[28:31]
M v[60:63], v[116:119], a[52:55], v[60:63]
M v[60:63], v[120:123], a[56:59], v[60:63]
M v[60:63], v[124:127], a[60:63], v[60:63]
M v[64:67], v[128:131], a[0:3], v[20:23]
M v[64:67], v[132:135], a[4:7], v[64:67]
M v[64:67], v[136:139], a[8:11], v[64:67]
M v[64:67], v[140:143], a[12:15], v[64:67]
M v[68:71], v[128:131], a[16:19], v[20:23]
M v[68:71], v[132:135], a[20:23], v[68:71]
M v[68:71], v[136:139], a[24:27], v[68:71]
M v[68:71], v[140:143], a[28:31], v[68:71]
M v[72:75], v[128:131], a[32:35], v[24:27]
M v[72:75], v[132:135], a[36:39], v[72:75]
M v[72:75], v[136:139], a[40:43], v[72:75]
M v[72:75], v[140:143], a[44:47], v[72:75]
M v[76:79], v[128:131], a[48:51], v[28:31]
M v[76:79], v[132:135], a[52:55], v[76:79]
M v[76:79], v[136:139], a[56:59], v[76:79]
M v[76:79], v[140:143], a[60:63], v[76:79]
M v[80:83], v[144:147], a[0:3], v[20:23]
M v[80:83], v[148:151], a[4:7], v[80:83]
M v[80:83], v[152:155], a[8:11], v[80:83]
M v[80:83], v[156:159], a[12:15], v[80:83]
M v[84:87], v[144:147], a[16:19], v[20:23]
M v[84:87], v[148:151], a[20:23], v[84:87]
M v[84:87], v[152:155], a[24:27], v[84:87]
M v[84:87], v[156:159], a[28:31], v[84:87]
M v[88:91], v[144:147], a[32:35], v[20:23]
M v[88:91], v[148:151], a[36:39], v[88:91]
M v[88:91], v[152:155], a[40:43], v[88:91]
M v[88:91], v[156:159], a[44:47], v[88:91]
M v[92:95], v[144:147], a[48:51], v[24:27]
M v[92:95], v[148:151], a[52:55], v[92:95]
M v[92:95], v[152:155], a[56:59], v[92:95]
M v[92:95], v[156:159], a[60:63], v[92:95]
s_nop 7
s_add_u32 s35, s57, 16384
buffer_load_dwordx4 v[96:99], v1, s[12:15], s35 offen offset:0 sc1
buffer_load_dwordx4 v[100:103], v1, s[12:15], s35 offen offset:1024 sc1
buffer_load_dwordx4 v[104:107], v1, s[12:15], s35 offen offset:2048 sc1
buffer_load_dwordx4 v[108:111], v1, s[12:15], s35 offen offset:3072 sc1
s_add_u32 s35, s57, 20480
buffer_load_dwordx4 v[112:115], v1, s[12:15], s35 offen offset:0 sc1
buffer_load_dwordx4 v[116:119], v1, s[12:15], s35 offen offset:1024 sc1
buffer_load_dwordx4 v[120:123], v1, s[12:15], s35 offen offset:2048 sc1
buffer_load_dwordx4 v[124:127], v1, s[12:15], s35 offen offset:3072 sc1
s_add_u32 s35, s57, 24576
buffer_load_dwordx4 v[128:131], v1, s[12:15], s35 offen offset:0 sc1
buffer_load_dwordx4 v[132:135], v1, s[12:15], s35 offen offset:1024 sc1
buffer_load_dwordx4 v[136:139], v1, s[12:15], s35 offen offset:2048 sc1
buffer_load_dwordx4 v[140:143], v1, s[12:15], s35 offen offset:3072 sc1
s_add_u32 s35, s57, 28672
buffer_load_dwordx4 v[144:147], v1, s[12:15], s35 offen offset:0 sc1
buffer_load_dwordx4 v[148:151], v1, s[12:15], s35 offen offset:1024 sc1
buffer_load_dwordx4 v[152:155], v1, s[12:15], s35 offen offset:2048 sc1
buffer_load_dwordx4 v[156:159], v1, s[12:15], s35 offen offset:3072 sc1
v_max3_f32 v13, v32, v33, v8
v_max3_f32 v13, v13, v34, v35
v_max3_f32 v13, v13, v48, v49
v_max3_f32 v13, v13, v50, v51
v_max3_f32 v13, v13, v64, v65
v_max3_f32 v13, v13, v66, v67
v_max3_f32 v13, v13, v80, v81
v_max3_f32 v13, v13, v82, v83
v_mov_b32 v14, v13
s_nop 1
v_permlane16_swap_b32 v13, v14
v_max_f32 v13, v13, v14
v_mov_b32 v14, v13
s_nop 1
v_permlane32_swap_b32 v13, v14
v_max_f32 v13, v13, v14
v_sub_f32 v12, v8, v13
v_exp_f32 v12, v12
v_mov_b32 v8, v13
v_sub_f32 v32, v32, v13
v_sub_f32 v33, v33, v13
v_sub_f32 v34, v34, v13
v_sub_f32 v35, v35, v13
v_sub_f32 v48, v48, v13
v_sub_f32 v49, v49, v13
v_sub_f32 v50, v50, v13
v_sub_f32 v51, v51, v13
v_sub_f32 v64, v64, v13
v_sub_f32 v65, v65, v13
v_sub_f32 v66, v66, v13
v_sub_f32 v67, v67, v13
v_sub_f32 v80, v80, v13
v_sub_f32 v81, v81, v13
v_sub_f32 v82, v82, v13
v_sub_f32 v83, v83, v13
v_mul_f32 v160, v160, v12
v_mul_f32 v161, v161, v12
v_mul_f32 v162, v162, v12
v_mul_f32 v163, v163, v12
v_mul_f32 v176, v176, v12
v_mul_f32 v177, v177, v12
v_mul_f32 v178, v178, v12
v_mul_f32 v179, v179, v12
v_mul_f32 v192, v192, v12
v_mul_f32 v193, v193, v12
v_mul_f32 v194, v194, v12
v_mul_f32 v195, v195, v12
v_mul_f32 v208, v208, v12
v_mul_f32 v209, v209, v12
v_mul_f32 v210, v210, v12
v_mul_f32 v211, v211, v12
v_mul_f32 v224, v224, v12
v_mul_f32 v225, v225, v12
v_mul_f32 v226, v226, v12
v_mul_f32 v227, v227, v12
v_mul_f32 v240, v240, v12
v_mul_f32 v241, v241, v12
v_mul_f32 v242, v242, v12
v_mul_f32 v243, v243, v12
v_accvgpr_read_b32 v14, a64
v_mul_f32 v14, v14, v12
v_accvgpr_write_b32 a64, v14
v_accvgpr_read_b32 v14, a65
v_mul_f32 v14, v14, v12
v_accvgpr_write_b32 a65, v14
v_accvgpr_read_b32 v14, a66
v_mul_f32 v14, v14, v12
v_accvgpr_write_b32 a66, v14
v_accvgpr_read_b32 v14, a67
v_mul_f32 v14, v14, v12
v_accvgpr_write_b32 a67, v14
v_accvgpr_read_b32 v14, a80
v_mul_f32 v14, v14, v12
v_accvgpr_write_b32 a80, v14
v_accvgpr_read_b32 v14, a81
v_mul_f32 v14, v14, v12
v_accvgpr_write_b32 a81, v14
v_accvgpr_read_b32 v14, a82
v_mul_f32 v14, v14, v12
v_accvgpr_write_b32 a82, v14
v_accvgpr_read_b32 v14, a83
v_mul_f32 v14, v14, v12
v_accvgpr_write_b32 a83, v14
v_accvgpr_read_b32 v14, a96
v_mul_f32 v14, v14, v12
v_accvgpr_write_b32 a96, v14
v_accvgpr_read_b32 v14, a97
v_mul_f32 v14, v14, v12
v_accvgpr_write_b32 a97, v14
v_accvgpr_read_b32 v14, a98
v_mul_f32 v14, v14, v12
v_accvgpr_write_b32 a98, v14
v_accvgpr_read_b32 v14, a99
v_mul_f32 v14, v14, v12
v_accvgpr_write_b32 a99, v14
v_max3_f32 v13, v36, v37, v9
v_max3_f32 v13, v13, v38, v39
v_max3_f32 v13, v13, v52, v53
v_max3_f32 v13, v13, v54, v55
v_max3_f32 v13, v13, v68, v69
v_max3_f32 v13, v13, v70, v71
v_max3_f32 v13, v13, v84, v85
v_max3_f32 v13, v13, v86, v87
v_mov_b32 v14, v13
s_nop 1
v_permlane16_swap_b32 v13, v14
v_max_f32 v13, v13, v14
v_mov_b32 v14, v13
s_nop 1
v_permlane32_swap_b32 v13, v14
v_max_f32 v13, v13, v14
v_sub_f32 v12, v9, v13
v_exp_f32 v12, v12
v_mov_b32 v9, v13
v_sub_f32 v36, v36, v13
v_sub_f32 v37, v37, v13
v_sub_f32 v38, v38, v13
v_sub_f32 v39, v39, v13
v_sub_f32 v52, v52, v13
v_sub_f32 v53, v53, v13
v_sub_f32 v54, v54, v13
v_sub_f32 v55, v55, v13
v_sub_f32 v68, v68, v13
v_sub_f32 v69, v69, v13
v_sub_f32 v70, v70, v13
v_sub_f32 v71, v71, v13
v_sub_f32 v84, v84, v13
v_sub_f32 v85, v85, v13
v_sub_f32 v86, v86, v13
v_sub_f32 v87, v87, v13
v_mul_f32 v164, v164, v12
v_mul_f32 v165, v165, v12
v_mul_f32 v166, v166, v12
v_mul_f32 v167, v167, v12
v_mul_f32 v180, v180, v12
v_mul_f32 v181, v181, v12
v_mul_f32 v182, v182, v12
v_mul_f32 v183, v183, v12
v_mul_f32 v196, v196, v12
v_mul_f32 v197, v197, v12
v_mul_f32 v198, v198, v12
v_mul_f32 v199, v199, v12
v_mul_f32 v212, v212, v12
v_mul_f32 v213, v213, v12
v_mul_f32 v214, v214, v12
v_mul_f32 v215, v215, v12
v_mul_f32 v228, v228, v12
v_mul_f32 v229, v229, v12
v_mul_f32 v230, v230, v12
v_mul_f32 v231, v231, v12
v_mul_f32 v244, v244, v12
v_mul_f32 v245, v245, v12
v_mul_f32 v246, v246, v12
v_mul_f32 v247, v247, v12
v_accvgpr_read_b32 v14, a68
v_mul_f32 v14, v14, v12
v_accvgpr_write_b32 a68, v14
v_accvgpr_read_b32 v14, a69
v_mul_f32 v14, v14, v12
v_accvgpr_write_b32 a69, v14
v_accvgpr_read_b32 v14, a70
v_mul_f32 v14, v14, v12
v_accvgpr_write_b32 a70, v14
v_accvgpr_read_b32 v14, a71
v_mul_f32 v14, v14, v12
v_accvgpr_write_b32 a71, v14
v_accvgpr_read_b32 v14, a84
v_mul_f32 v14, v14, v12
v_accvgpr_write_b32 a84, v14
v_accvgpr_read_b32 v14, a85
v_mul_f32 v14, v14, v12
v_accvgpr_write_b32 a85, v14
v_accvgpr_read_b32 v14, a86
v_mul_f32 v14, v14, v12
v_accvgpr_write_b32 a86, v14
v_accvgpr_read_b32 v14, a87
v_mul_f32 v14, v14, v12
v_accvgpr_write_b32 a87, v14
v_accvgpr_read_b32 v14, a100
v_mul_f32 v14, v14, v12
v_accvgpr_write_b32 a100, v14
v_accvgpr_read_b32 v14, a101
v_mul_f32 v14, v14, v12
v_accvgpr_write_b32 a101, v14
v_accvgpr_read_b32 v14, a102
v_mul_f32 v14, v14, v12
v_accvgpr_write_b32 a102, v14
v_accvgpr_read_b32 v14, a103
v_mul_f32 v14, v14, v12
v_accvgpr_write_b32 a103, v14
v_max3_f32 v13, v40, v41, v10
v_max3_f32 v13, v13, v42, v43
v_max3_f32 v13, v13, v56, v57
v_max3_f32 v13, v13, v58, v59
v_max3_f32 v13, v13, v72, v73
v_max3_f32 v13, v13, v74, v75
v_max3_f32 v13, v13, v88, v89
v_max3_f32 v13, v13, v90, v91
v_mov_b32 v14, v13
s_nop 1
v_permlane16_swap_b32 v13, v14
v_max_f32 v13, v13, v14
v_mov_b32 v14, v13
s_nop 1
v_permlane32_swap_b32 v13, v14
v_max_f32 v13, v13, v14
v_sub_f32 v12, v10, v13
v_exp_f32 v12, v12
v_mov_b32 v10, v13
v_sub_f32 v40, v40, v13
v_sub_f32 v41, v41, v13
v_sub_f32 v42, v42, v13
v_sub_f32 v43, v43, v13
v_sub_f32 v56, v56, v13
v_sub_f32 v57, v57, v13
v_sub_f32 v58, v58, v13
v_sub_f32 v59, v59, v13
v_sub_f32 v72, v72, v13
v_sub_f32 v73, v73, v13
v_sub_f32 v74, v74, v13
v_sub_f32 v75, v75, v13
v_sub_f32 v88, v88, v13
v_sub_f32 v89, v89, v13
v_sub_f32 v90, v90, v13
v_sub_f32 v91, v91, v13
v_mul_f32 v168, v168, v12
v_mul_f32 v169, v169, v12
v_mul_f32 v170, v170, v12
v_mul_f32 v171, v171, v12
v_mul_f32 v184, v184, v12
v_mul_f32 v185, v185, v12
v_mul_f32 v186, v186, v12
v_mul_f32 v187, v187, v12
v_mul_f32 v200, v200, v12
v_mul_f32 v201, v201, v12
v_mul_f32 v202, v202, v12
v_mul_f32 v203, v203, v12
v_mul_f32 v216, v216, v12
v_mul_f32 v217, v217, v12
v_mul_f32 v218, v218, v12
v_mul_f32 v219, v219, v12
v_mul_f32 v232, v232, v12
v_mul_f32 v233, v233, v12
v_mul_f32 v234, v234, v12
v_mul_f32 v235, v235, v12
v_mul_f32 v248, v248, v12
v_mul_f32 v249, v249, v12
v_mul_f32 v250, v250, v12
v_mul_f32 v251, v251, v12
v_accvgpr_read_b32 v14, a72
v_mul_f32 v14, v14, v12
v_accvgpr_write_b32 a72, v14
v_accvgpr_read_b32 v14, a73
v_mul_f32 v14, v14, v12
v_accvgpr_write_b32 a73, v14
v_accvgpr_read_b32 v14, a74
v_mul_f32 v14, v14, v12
v_accvgpr_write_b32 a74, v14
v_accvgpr_read_b32 v14, a75
v_mul_f32 v14, v14, v12
v_accvgpr_write_b32 a75, v14
v_accvgpr_read_b32 v14, a88
v_mul_f32 v14, v14, v12
v_accvgpr_write_b32 a88, v14
v_accvgpr_read_b32 v14, a89
v_mul_f32 v14, v14, v12
v_accvgpr_write_b32 a89, v14
v_accvgpr_read_b32 v14, a90
v_mul_f32 v14, v14, v12
v_accvgpr_write_b32 a90, v14
v_accvgpr_read_b32 v14, a91
v_mul_f32 v14, v14, v12
v_accvgpr_write_b32 a91, v14
v_accvgpr_read_b32 v14, a104
v_mul_f32 v14, v14, v12
v_accvgpr_write_b32 a104, v14
v_accvgpr_read_b32 v14, a105
v_mul_f32 v14, v14, v12
v_accvgpr_write_b32 a105, v14
v_accvgpr_read_b32 v14, a106
v_mul_f32 v14, v14, v12
v_accvgpr_write_b32 a106, v14
v_accvgpr_read_b32 v14, a107
v_mul_f32 v14, v14, v12
v_accvgpr_write_b32 a107, v14
v_max3_f32 v13, v44, v45, v11
v_max3_f32 v13, v13, v46, v47
v_max3_f32 v13, v13, v60, v61
v_max3_f32 v13, v13, v62, v63
v_max3_f32 v13, v13, v76, v77
v_max3_f32 v13, v13, v78, v79
v_max3_f32 v13, v13, v92, v93
v_max3_f32 v13, v13, v94, v95
v_mov_b32 v14, v13
s_nop 1
v_permlane16_swap_b32 v13, v14
v_max_f32 v13, v13, v14
v_mov_b32 v14, v13
s_nop 1
v_permlane32_swap_b32 v13, v14
v_max_f32 v13, v13, v14
v_sub_f32 v12, v11, v13
v_exp_f32 v12, v12
v_mov_b32 v11, v13
v_sub_f32 v44, v44, v13
v_sub_f32 v45, v45, v13
v_sub_f32 v46, v46, v13
v_sub_f32 v47, v47, v13
v_sub_f32 v60, v60, v13
v_sub_f32 v61, v61, v13
v_sub_f32 v62, v62, v13
v_sub_f32 v63, v63, v13
v_sub_f32 v76, v76, v13
v_sub_f32 v77, v77, v13
v_sub_f32 v78, v78, v13
v_sub_f32 v79, v79, v13
v_sub_f32 v92, v92, v13
v_sub_f32 v93, v93, v13
v_sub_f32 v94, v94, v13
v_sub_f32 v95, v95, v13
v_mul_f32 v172, v172, v12
v_mul_f32 v173, v173, v12
v_mul_f32 v174, v174, v12
v_mul_f32 v175, v175, v12
v_mul_f32 v188, v188, v12
v_mul_f32 v189, v189, v12
v_mul_f32 v190, v190, v12
v_mul_f32 v191, v191, v12
v_mul_f32 v204, v204, v12
v_mul_f32 v205, v205, v12
v_mul_f32 v206, v206, v12
v_mul_f32 v207, v207, v12
v_mul_f32 v220, v220, v12
v_mul_f32 v221, v221, v12
v_mul_f32 v222, v222, v12
v_mul_f32 v223, v223, v12
v_mul_f32 v236, v236, v12
v_mul_f32 v237, v237, v12
v_mul_f32 v238, v238, v12
v_mul_f32 v239, v239, v12
v_mul_f32 v252, v252, v12
v_mul_f32 v253, v253, v12
v_mul_f32 v254, v254, v12
v_mul_f32 v255, v255, v12
v_accvgpr_read_b32 v14, a76
v_mul_f32 v14, v14, v12
v_accvgpr_write_b32 a76, v14
v_accvgpr_read_b32 v14, a77
v_mul_f32 v14, v14, v12
v_accvgpr_write_b32 a77, v14
v_accvgpr_read_b32 v14, a78
v_mul_f32 v14, v14, v12
v_accvgpr_write_b32 a78, v14
v_accvgpr_read_b32 v14, a79
v_mul_f32 v14, v14, v12
v_accvgpr_write_b32 a79, v14
v_accvgpr_read_b32 v14, a92
v_mul_f32 v14, v14, v12
v_accvgpr_write_b32 a92, v14
v_accvgpr_read_b32 v14, a93
v_mul_f32 v14, v14, v12
v_accvgpr_write_b32 a93, v14
v_accvgpr_read_b32 v14, a94
v_mul_f32 v14, v14, v12
v_accvgpr_write_b32 a94, v14
v_accvgpr_read_b32 v14, a95
v_mul_f32 v14, v14, v12
v_accvgpr_write_b32 a95, v14
v_accvgpr_read_b32 v14, a108
v_mul_f32 v14, v14, v12
v_accvgpr_write_b32 a108, v14
v_accvgpr_read_b32 v14, a109
v_mul_f32 v14, v14, v12
v_accvgpr_write_b32 a109, v14
v_accvgpr_read_b32 v14, a110
v_mul_f32 v14, v14, v12
v_accvgpr_write_b32 a110, v14
v_accvgpr_read_b32 v14, a111
v_mul_f32 v14, v14, v12
v_accvgpr_write_b32 a111, v14
v_exp_f32 v32, v32
v_exp_f32 v33, v33
v_exp_f32 v34, v34
v_exp_f32 v35, v35
v_exp_f32 v48, v48
v_exp_f32 v49, v49
v_exp_f32 v50, v50
v_exp_f32 v51, v51
v_cvt_pk_bf16_f32 v32, v32, v33
v_cvt_pk_bf16_f32 v33, v34, v35
v_exp_f32 v36, v36
v_exp_f32 v37, v37
v_exp_f32 v38, v38
v_exp_f32 v39, v39
v_cvt_pk_bf16_f32 v34, v48, v49
v_cvt_pk_bf16_f32 v35, v50, v51
v_exp_f32 v52, v52
v_exp_f32 v53, v53
v_exp_f32 v54, v54
v_exp_f32 v55, v55
v_cvt_pk_bf16_f32 v36, v36, v37
v_cvt_pk_bf16_f32 v37, v38, v39
v_exp_f32 v40, v40
v_exp_f32 v41, v41
v_exp_f32 v42, v42
v_exp_f32 v43, v43
v_cvt_pk_bf16_f32 v38, v52, v53
v_cvt_pk_bf16_f32 v39, v54, v55
v_exp_f32 v56, v56
v_exp_f32 v57, v57
v_exp_f32 v58, v58
v_exp_f32 v59, v59
v_cvt_pk_bf16_f32 v40, v40, v41
v_cvt_pk_bf16_f32 v41, v42, v43
v_exp_f32 v44, v44
v_exp_f32 v45, v45
v_exp_f32 v46, v46
v_exp_f32 v47, v47
v_cvt_pk_bf16_f32 v42, v56, v57
v_cvt_pk_bf16_f32 v43, v58, v59
v_exp_f32 v60, v60
v_exp_f32 v61, v61
v_exp_f32 v62, v62
v_exp_f32 v63, v63
v_cvt_pk_bf16_f32 v44, v44, v45
v_cvt_pk_bf16_f32 v45, v46, v47
v_cvt_pk_bf16_f32 v46, v60, v61
v_cvt_pk_bf16_f32 v47, v62, v63
v_exp_f32 v64, v64
v_exp_f32 v65, v65
v_exp_f32 v66, v66
v_exp_f32 v67, v67
v_exp_f32 v80, v80
v_exp_f32 v81, v81
v_exp_f32 v82, v82
v_exp_f32 v83, v83
v_cvt_pk_bf16_f32 v64, v64, v65
v_cvt_pk_bf16_f32 v65, v66, v67
v_exp_f32 v68, v68
v_exp_f32 v69, v69
v_exp_f32 v70, v70
v_exp_f32 v71, v71
v_cvt_pk_bf16_f32 v66, v80, v81
v_cvt_pk_bf16_f32 v67, v82, v83
v_exp_f32 v84, v84
v_exp_f32 v85, v85
v_exp_f32 v86, v86
v_exp_f32 v87, v87
v_cvt_pk_bf16_f32 v68, v68, v69
v_cvt_pk_bf16_f32 v69, v70, v71
v_exp_f32 v72, v72
v_exp_f32 v73, v73
v_exp_f32 v74, v74
v_exp_f32 v75, v75
v_cvt_pk_bf16_f32 v70, v84, v85
v_cvt_pk_bf16_f32 v71, v86, v87
v_exp_f32 v88, v88
v_exp_f32 v89, v89
v_exp_f32 v90, v90
v_exp_f32 v91, v91
v_cvt_pk_bf16_f32 v72, v72, v73
v_cvt_pk_bf16_f32 v73, v74, v75
v_exp_f32 v76, v76
v_exp_f32 v77, v77
v_exp_f32 v78, v78
v_exp_f32 v79, v79
v_cvt_pk_bf16_f32 v74, v88, v89
v_cvt_pk_bf16_f32 v75, v90, v91
v_exp_f32 v92, v92
v_exp_f32 v93, v93
v_exp_f32 v94, v94
v_exp_f32 v95, v95
v_cvt_pk_bf16_f32 v76, v76, v77
v_cvt_pk_bf16_f32 v77, v78, v79
v_cvt_pk_bf16_f32 v78, v92, v93
v_cvt_pk_bf16_f32 v79, v94, v95
s_waitcnt vmcnt(0)
M a[96:99], a[112:115], v[32:35], a[96:99]
M a[100:103], a[112:115], v[36:39], a[100:103]
M a[104:107], a[112:115], v[40:43], a[104:107]
M a[108:111], a[112:115], v[44:47], a[108:111]
M v[160:163], v[96:99], v[32:35], v[160:163]
M v[164:167], v[96:99], v[36:39], v[164:167]
M v[168:171], v[96:99], v[40:43], v[168:171]
M v[172:175], v[96:99], v[44:47], v[172:175]
M v[176:179], v[100:103], v[32:35], v[176:179]
M v[180:183], v[100:103], v[36:39], v[180:183]
M v[184:187], v[100:103], v[40:43], v[184:187]
M v[188:191], v[100:103], v[44:47], v[188:191]
M v[192:195], v[104:107], v[32:35], v[192:195]
M v[196:199], v[104:107], v[36:39], v[196:199]
M v[200:203], v[104:107], v[40:43], v[200:203]
M v[204:207], v[104:107], v[44:47], v[204:207]
M v[208:211], v[108:111], v[32:35], v[208:211]
M v[212:215], v[108:111], v[36:39], v[212:215]
M v[216:219], v[108:111], v[40:43], v[216:219]
M v[220:223], v[108:111], v[44:47], v[220:223]
M v[224:227], v[112:115], v[32:35], v[224:227]
M v[228:231], v[112:115], v[36:39], v[228:231]
M v[232:235], v[112:115], v[40:43], v[232:235]
M v[236:239], v[112:115], v[44:47], v[236:239]
M v[240:243], v[116:119], v[32:35], v[240:243]
M v[244:247], v[116:119], v[36:39], v[244:247]
M v[248:251], v[116:119], v[40:43], v[248:251]
M v[252:255], v[116:119], v[44:47], v[252:255]
M a[64:67], v[120:123], v[32:35], a[64:67]
M a[68:71], v[120:123], v[36:39], a[68:71]
M a[72:75], v[120:123], v[40:43], a[72:75]
M a[76:79], v[120:123], v[44:47], a[76:79]
M a[80:83], v[124:127], v[32:35], a[80:83]
M a[84:87], v[124:127], v[36:39], a[84:87]
M a[88:91], v[124:127], v[40:43], a[88:91]
M a[92:95], v[124:127], v[44:47], a[92:95]
M a[96:99], a[112:115], v[64:67], a[96:99]
M a[100:103], a[112:115], v[68:71], a[100:103]
M a[104:107], a[112:115], v[72:75], a[104:107]
M a[108:111], a[112:115], v[76:79], a[108:111]
M v[160:163], v[128:131], v[64:67], v[160:163]
M v[164:167], v[128:131], v[68:71], v[164:167]
M v[168:171], v[128:131], v[72:75], v[168:171]
M v[172:175], v[128:131], v[76:79], v[172:175]
M v[176:179], v[132:135], v[64:67], v[176:179]
M v[180:183], v[132:135], v[68:71], v[180:183]
M v[184:187], v[132:135], v[72:75], v[184:187]
M v[188:191], v[132:135], v[76:79], v[188:191]
M v[192:195], v[136:139], v[64:67], v[192:195]
M v[196:199], v[136:139], v[68:71], v[196:199]
M v[200:203], v[136:139], v[72:75], v[200:203]
M v[204:207], v[136:139], v[76:79], v[204:207]
M v[208:211], v[140:143], v[64:67], v[208:211]
M v[212:215], v[140:143], v[68:71], v[212:215]
M v[216:219], v[140:143], v[72:75], v[216:219]
M v[220:223], v[140:143], v[76:79], v[220:223]
M v[224:227], v[144:147], v[64:67], v[224:227]
M v[228:231], v[144:147], v[68:71], v[228:231]
M v[232:235], v[144:147], v[72:75], v[232:235]
M v[236:239], v[144:147], v[76:79], v[236:239]
M v[240:243], v[148:151], v[64:67], v[240:243]
M v[244:247], v[148:151], v[68:71], v[244:247]
M v[248:251], v[148:151], v[72:75], v[248:251]
M v[252:255], v[148:151], v[76:79], v[252:255]
M a[64:67], v[152:155], v[64:67], a[64:67]
M a[68:71], v[152:155], v[68:71], a[68:71]
M a[72:75], v[152:155], v[72:75], a[72:75]
M a[76:79], v[152:155], v[76:79], a[76:79]
M a[80:83], v[156:159], v[64:67], a[80:83]
M a[84:87], v[156:159], v[68:71], a[84:87]
M a[88:91], v[156:159], v[72:75], a[88:91]
M a[92:95], v[156:159], v[76:79], a[92:95]
s_nop 7
s_add_u32 s57, s57, 32768
s_sub_u32 s58, s58, 64
s_sub_u32 s59, s59, 1
s_cmp_lg_u32 s59, 0
s_cbranch_scc1 Lslow_2
v_accvgpr_read_b32 v20, a96
v_accvgpr_read_b32 v21, a100
v_accvgpr_read_b32 v22, a104
v_accvgpr_read_b32 v23, a108
v_rcp_f32 v8, v20
v_rcp_f32 v9, v21
v_rcp_f32 v10, v22
v_rcp_f32 v11, v23
s_lshl_b32 s33, s56, 20
s_lshl_b32 s34, s20, 15
s_add_u32 s33, s33, s34
s_lshl_b32 s34, s23, 13
s_add_u32 s36, s33, s34
s_add_u32 s37, s36, 4096
s_add_u32 s38, s36, 16384
s_add_u32 s39, s36, 20480
v_pk_mul_f32 v[160:161], v[160:161], v[8:9] op_sel:[0,0] op_sel_hi:[1,0]
v_pk_mul_f32 v[162:163], v[162:163], v[8:9] op_sel:[0,0] op_sel_hi:[1,0]
v_pk_mul_f32 v[176:177], v[176:177], v[8:9] op_sel:[0,0] op_sel_hi:[1,0]
v_pk_mul_f32 v[178:179], v[178:179], v[8:9] op_sel:[0,0] op_sel_hi:[1,0]
v_cvt_pk_bf16_f32 v160, v160, v161
v_cvt_pk_bf16_f32 v161, v162, v163
v_cvt_pk_bf16_f32 v162, v176, v177
v_cvt_pk_bf16_f32 v163, v178, v179
v_pk_mul_f32 v[164:165], v[164:165], v[8:9] op_sel:[0,1] op_sel_hi:[1,1]
v_pk_mul_f32 v[166:167], v[166:167], v[8:9] op_sel:[0,1] op_sel_hi:[1,1]
v_pk_mul_f32 v[180:181], v[180:181], v[8:9] op_sel:[0,1] op_sel_hi:[1,1]
v_pk_mul_f32 v[182:183], v[182:183], v[8:9] op_sel:[0,1] op_sel_hi:[1,1]
v_cvt_pk_bf16_f32 v164, v164, v165
v_cvt_pk_bf16_f32 v165, v166, v167
v_cvt_pk_bf16_f32 v166, v180, v181
v_cvt_pk_bf16_f32 v167, v182, v183
v_pk_mul_f32 v[168:169], v[168:169], v[10:11] op_sel:[0,0] op_sel_hi:[1,0]
v_pk_mul_f32 v[170:171], v[170:171], v[10:11] op_sel:[0,0] op_sel_hi:[1,0]
v_pk_mul_f32 v[184:185], v[184:185], v[10:11] op_sel:[0,0] op_sel_hi:[1,0]
v_pk_mul_f32 v[186:187], v[186:187], v[10:11] op_sel:[0,0] op_sel_hi:[1,0]
v_cvt_pk_bf16_f32 v168, v168, v169
v_cvt_pk_bf16_f32 v169, v170, v171
v_cvt_pk_bf16_f32 v170, v184, v185
v_cvt_pk_bf16_f32 v171, v186, v187
v_pk_mul_f32 v[172:173], v[172:173], v[10:11] op_sel:[0,1] op_sel_hi:[1,1]
v_pk_mul_f32 v[174:175], v[174:175], v[10:11] op_sel:[0,1] op_sel_hi:[1,1]
v_pk_mul_f32 v[188:189], v[188:189], v[10:11] op_sel:[0,1] op_sel_hi:[1,1]
v_pk_mul_f32 v[190:191], v[190:191], v[10:11] op_sel:[0,1] op_sel_hi:[1,1]
v_cvt_pk_bf16_f32 v172, v172, v173
v_cvt_pk_bf16_f32 v173, v174, v175
v_cvt_pk_bf16_f32 v174, v188, v189
v_cvt_pk_bf16_f32 v175, v190, v191
v_pk_mul_f32 v[192:193], v[192:193], v[8:9] op_sel:[0,0] op_sel_hi:[1,0]
v_pk_mul_f32 v[194:195], v[194:195], v[8:9] op_sel:[0,0] op_sel_hi:[1,0]
v_pk_mul_f32 v[208:209], v[208:209], v[8:9] op_sel:[0,0] op_sel_hi:[1,0]
v_pk_mul_f32 v[210:211], v[210:211], v[8:9] op_sel:[0,0] op_sel_hi:[1,0]
v_cvt_pk_bf16_f32 v192, v192, v193
v_cvt_pk_bf16_f32 v193, v194, v195
v_cvt_pk_bf16_f32 v194, v208, v209
v_cvt_pk_bf16_f32 v195, v210, v211
v_pk_mul_f32 v[196:197], v[196:197], v[8:9] op_sel:[0,1] op_sel_hi:[1,1]
v_pk_mul_f32 v[198:199], v[198:199], v[8:9] op_sel:[0,1] op_sel_hi:[1,1]
v_pk_mul_f32 v[212:213], v[212:213], v[8:9] op_sel:[0,1] op_sel_hi:[1,1]
v_pk_mul_f32 v[214:215], v[214:215], v[8:9] op_sel:[0,1] op_sel_hi:[1,1]
v_cvt_pk_bf16_f32 v196, v196, v197
v_cvt_pk_bf16_f32 v197, v198, v199
v_cvt_pk_bf16_f32 v198, v212, v213
v_cvt_pk_bf16_f32 v199, v214, v215
v_pk_mul_f32 v[200:201], v[200:201], v[10:11] op_sel:[0,0] op_sel_hi:[1,0]
v_pk_mul_f32 v[202:203], v[202:203], v[10:11] op_sel:[0,0] op_sel_hi:[1,0]
v_pk_mul_f32 v[216:217], v[216:217], v[10:11] op_sel:[0,0] op_sel_hi:[1,0]
v_pk_mul_f32 v[218:219], v[218:219], v[10:11] op_sel:[0,0] op_sel_hi:[1,0]
v_cvt_pk_bf16_f32 v200, v200, v201
v_cvt_pk_bf16_f32 v201, v202, v203
v_cvt_pk_bf16_f32 v202, v216, v217
v_cvt_pk_bf16_f32 v203, v218, v219
v_pk_mul_f32 v[204:205], v[204:205], v[10:11] op_sel:[0,1] op_sel_hi:[1,1]
v_pk_mul_f32 v[206:207], v[206:207], v[10:11] op_sel:[0,1] op_sel_hi:[1,1]
v_pk_mul_f32 v[220:221], v[220:221], v[10:11] op_sel:[0,1] op_sel_hi:[1,1]
v_pk_mul_f32 v[222:223], v[222:223], v[10:11] op_sel:[0,1] op_sel_hi:[1,1]
v_cvt_pk_bf16_f32 v204, v204, v205
v_cvt_pk_bf16_f32 v205, v206, v207
v_cvt_pk_bf16_f32 v206, v220, v221
v_cvt_pk_bf16_f32 v207, v222, v223
v_pk_mul_f32 v[224:225], v[224:225], v[8:9] op_sel:[0,0] op_sel_hi:[1,0]
v_pk_mul_f32 v[226:227], v[226:227], v[8:9] op_sel:[0,0] op_sel_hi:[1,0]
v_pk_mul_f32 v[240:241], v[240:241], v[8:9] op_sel:[0,0] op_sel_hi:[1,0]
v_pk_mul_f32 v[242:243], v[242:243], v[8:9] op_sel:[0,0] op_sel_hi:[1,0]
v_cvt_pk_bf16_f32 v224, v224, v225
v_cvt_pk_bf16_f32 v225, v226, v227
v_cvt_pk_bf16_f32 v226, v240, v241
v_cvt_pk_bf16_f32 v227, v242, v243
v_pk_mul_f32 v[228:229], v[228:229], v[8:9] op_sel:[0,1] op_sel_hi:[1,1]
v_pk_mul_f32 v[230:231], v[230:231], v[8:9] op_sel:[0,1] op_sel_hi:[1,1]
v_pk_mul_f32 v[244:245], v[244:245], v[8:9] op_sel:[0,1] op_sel_hi:[1,1]
v_pk_mul_f32 v[246:247], v[246:247], v[8:9] op_sel:[0,1] op_sel_hi:[1,1]
v_cvt_pk_bf16_f32 v228, v228, v229
v_cvt_pk_bf16_f32 v229, v230, v231
v_cvt_pk_bf16_f32 v230, v244, v245
v_cvt_pk_bf16_f32 v231, v246, v247
v_pk_mul_f32 v[232:233], v[232:233], v[10:11] op_sel:[0,0] op_sel_hi:[1,0]
v_pk_mul_f32 v[234:235], v[234:235], v[10:11] op_sel:[0,0] op_sel_hi:[1,0]
v_pk_mul_f32 v[248:249], v[248:249], v[10:11] op_sel:[0,0] op_sel_hi:[1,0]
v_pk_mul_f32 v[250:251], v[250:251], v[10:11] op_sel:[0,0] op_sel_hi:[1,0]
v_cvt_pk_bf16_f32 v232, v232, v233
v_cvt_pk_bf16_f32 v233, v234, v235
v_cvt_pk_bf16_f32 v234, v248, v249
v_cvt_pk_bf16_f32 v235, v250, v251
v_pk_mul_f32 v[236:237], v[236:237], v[10:11] op_sel:[0,1] op_sel_hi:[1,1]
v_pk_mul_f32 v[238:239], v[238:239], v[10:11] op_sel:[0,1] op_sel_hi:[1,1]
v_pk_mul_f32 v[252:253], v[252:253], v[10:11] op_sel:[0,1] op_sel_hi:[1,1]
v_pk_mul_f32 v[254:255], v[254:255], v[10:11] op_sel:[0,1] op_sel_hi:[1,1]
v_cvt_pk_bf16_f32 v236, v236, v237
v_cvt_pk_bf16_f32 v237, v238, v239
v_cvt_pk_bf16_f32 v238, v252, v253
v_cvt_pk_bf16_f32 v239, v254, v255
v_accvgpr_read_b32 v176, a64
v_accvgpr_read_b32 v177, a65
v_accvgpr_read_b32 v178, a66
v_accvgpr_read_b32 v179, a67
v_accvgpr_read_b32 v180, a80
v_accvgpr_read_b32 v181, a81
v_accvgpr_read_b32 v182, a82
v_accvgpr_read_b32 v183, a83
v_pk_mul_f32 v[176:177], v[176:177], v[8:9] op_sel:[0,0] op_sel_hi:[1,0]
v_pk_mul_f32 v[178:179], v[178:179], v[8:9] op_sel:[0,0] op_sel_hi:[1,0]
v_pk_mul_f32 v[180:181], v[180:181], v[8:9] op_sel:[0,0] op_sel_hi:[1,0]
v_pk_mul_f32 v[182:183], v[182:183], v[8:9] op_sel:[0,0] op_sel_hi:[1,0]
v_cvt_pk_bf16_f32 v176, v176, v177
v_cvt_pk_bf16_f32 v177, v178, v179
v_cvt_pk_bf16_f32 v178, v180, v181
v_cvt_pk_bf16_f32 v179, v182, v183
v_accvgpr_read_b32 v184, a68
v_accvgpr_read_b32 v185, a69
v_accvgpr_read_b32 v186, a70
v_accvgpr_read_b32 v187, a71
v_accvgpr_read_b32 v188, a84
v_accvgpr_read_b32 v189, a85
v_accvgpr_read_b32 v190, a86
v_accvgpr_read_b32 v191, a87
v_pk_mul_f32 v[184:185], v[184:185], v[8:9] op_sel:[0,1] op_sel_hi:[1,1]
v_pk_mul_f32 v[186:187], v[186:187], v[8:9] op_sel:[0,1] op_sel_hi:[1,1]
v_pk_mul_f32 v[188:189], v[188:189], v[8:9] op_sel:[0,1] op_sel_hi:[1,1]
v_pk_mul_f32 v[190:191], v[190:191], v[8:9] op_sel:[0,1] op_sel_hi:[1,1]
v_cvt_pk_bf16_f32 v184, v184, v185
v_cvt_pk_bf16_f32 v185, v186, v187
v_cvt_pk_bf16_f32 v186, v188, v189
v_cvt_pk_bf16_f32 v187, v190, v191
v_accvgpr_read_b32 v208, a72
v_accvgpr_read_b32 v209, a73
v_accvgpr_read_b32 v210, a74
v_accvgpr_read_b32 v211, a75
v_accvgpr_read_b32 v212, a88
v_accvgpr_read_b32 v213, a89
v_accvgpr_read_b32 v214, a90
v_accvgpr_read_b32 v215, a91
v_pk_mul_f32 v[208:209], v[208:209], v[10:11] op_sel:[0,0] op_sel_hi:[1,0]
v_pk_mul_f32 v[210:211], v[210:211], v[10:11] op_sel:[0,0] op_sel_hi:[1,0]
v_pk_mul_f32 v[212:213], v[212:213], v[10:11] op_sel:[0,0] op_sel_hi:[1,0]
v_pk_mul_f32 v[214:215], v[214:215], v[10:11] op_sel:[0,0] op_sel_hi:[1,0]
v_cvt_pk_bf16_f32 v208, v208, v209
v_cvt_pk_bf16_f32 v209, v210, v211
v_cvt_pk_bf16_f32 v210, v212, v213
v_cvt_pk_bf16_f32 v211, v214, v215
v_accvgpr_read_b32 v216, a76
v_accvgpr_read_b32 v217, a77
v_accvgpr_read_b32 v218, a78
v_accvgpr_read_b32 v219, a79
v_accvgpr_read_b32 v220, a92
v_accvgpr_read_b32 v221, a93
v_accvgpr_read_b32 v222, a94
v_accvgpr_read_b32 v223, a95
v_pk_mul_f32 v[216:217], v[216:217], v[10:11] op_sel:[0,1] op_sel_hi:[1,1]
v_pk_mul_f32 v[218:219], v[218:219], v[10:11] op_sel:[0,1] op_sel_hi:[1,1]
v_pk_mul_f32 v[220:221], v[220:221], v[10:11] op_sel:[0,1] op_sel_hi:[1,1]
v_pk_mul_f32 v[222:223], v[222:223], v[10:11] op_sel:[0,1] op_sel_hi:[1,1]
v_cvt_pk_bf16_f32 v216, v216, v217
v_cvt_pk_bf16_f32 v217, v218, v219
v_cvt_pk_bf16_f32 v218, v220, v221
v_cvt_pk_bf16_f32 v219, v222, v223
s_bitcmp1_b32 s61, 0
s_cbranch_scc0 Lss_3
buffer_store_dwordx4 v[160:163], v1, s[16:19], s36 offen offset:0 sc1
buffer_store_dwordx4 v[164:167], v1, s[16:19], s36 offen offset:2048 sc1
buffer_store_dwordx4 v[168:171], v1, s[16:19], s37 offen offset:0 sc1
buffer_store_dwordx4 v[172:175], v1, s[16:19], s37 offen offset:2048 sc1
Lss_3:
s_bitcmp1_b32 s61, 1
s_cbranch_scc0 Lss_4
buffer_store_dwordx4 v[192:195], v1, s[16:19], s36 offen offset:1024 sc1
buffer_store_dwordx4 v[196:199], v1, s[16:19], s36 offen offset:3072 sc1
buffer_store_dwordx4 v[200:203], v1, s[16:19], s37 offen offset:1024 sc1
buffer_store_dwordx4 v[204:207], v1, s[16:19], s37 offen offset:3072 sc1
Lss_4:
s_bitcmp1_b32 s61, 2
s_cbranch_scc0 Lss_5
buffer_store_dwordx4 v[224:227], v1, s[16:19], s38 offen offset:0 sc1
buffer_store_dwordx4 v[228:231], v1, s[16:19], s38 offen offset:2048 sc1
buffer_store_dwordx4 v[232:235], v1, s[16:19], s39 offen offset:0 sc1
buffer_store_dwordx4 v[236:239], v1, s[16:19], s39 offen offset:2048 sc1
Lss_5:
s_bitcmp1_b32 s61, 3
s_cbranch_scc0 Lss_6
buffer_store_dwordx4 v[176:179], v1, s[16:19], s38 offen offset:1024 sc1
buffer_store_dwordx4 v[184:187], v1, s[16:19], s38 offen offset:3072 sc1
buffer_store_dwordx4 v[208:211], v1, s[16:19], s39 offen offset:1024 sc1
buffer_store_dwordx4 v[216:219], v1, s[16:19], s39 offen offset:3072 sc1
Lss_6:
s_branch Lk2_chk
Lk2_done:
s_lshl_b32 s33, s20, 4
s_add_u32 s33, s33, 8392704
s_sub_u32 s34, 15, s21
s_lshl_b32 s34, s34, 9
s_add_u32 s92, s33, s34
s_lshl_b32 s34, s22, 2
s_add_u32 s92, s92, s34
s_lshl_b32 s34, s21, 9
s_add_u32 s93, s33, s34
s_lshl_b32 s34, s23, 3
s_add_u32 s93, s93, s34
s_cmp_eq_u32 s24, 0
s_cselect_b32 s93, s93, s92
s_cselect_b32 s94, 4, 0
s_add_u32 s94, s94, s93
s_load_dwordx2 s[10:11], s[0:1], 40
s_load_dwordx2 s[14:15], s[0:1], 72
s_lshl_b32 s21, s27, 7
s_lshl_b32 s22, s28, 6
s_lshl_b32 s3, s101, 4
v_lshrrev_b32 v224, 3, v0
v_and_b32 v225, 6, v224
v_and_b32 v226, 7, v0
v_xor_b32 v225, v225, v226
v_add_u32 v224, s3, v224
v_lshlrev_b32 v224, 11, v224
v_lshl_add_u32 v6, v225, 4, v224
v_add_u32 v7, 15360, v6
v_lshrrev_b32 v224, 2, v0
v_and_b32 v226, 1, v0
v_bfe_u32 v229, v0, 1, 1
v_lshlrev_b32 v225, 7, v224
v_lshl_add_u32 v225, v226, 3, v225
v_and_b32 v228, 6, v224
v_add_u32 v227, 0, v229
v_xor_b32 v227, v227, v228
v_lshl_add_u32 v24, v227, 4, v225
v_add_u32 v28, 0x10000, v24
v_add_u32 v227, 2, v229
v_xor_b32 v227, v227, v228
v_lshl_add_u32 v25, v227, 4, v225
v_add_u32 v29, 0x10000, v25
v_add_u32 v227, 4, v229
v_xor_b32 v227, v227, v228
v_lshl_add_u32 v26, v227, 4, v225
v_add_u32 v30, 0x10000, v26
v_add_u32 v227, 6, v229
v_xor_b32 v227, v227, v228
v_lshl_add_u32 v27, v227, 4, v225
v_add_u32 v31, 0x10000, v27
s_waitcnt vmcnt(32)
s_barrier
ds_read_b64_tr_b16 v[160:161], v24 offset:16384
ds_read_b64_tr_b16 v[162:163], v24 offset:18432
ds_read_b64_tr_b16 v[164:165], v24 offset:20480
ds_read_b64_tr_b16 v[166:167], v24 offset:22528
ds_read_b64_tr_b16 v[168:169], v25 offset:16384
ds_read_b64_tr_b16 v[170:171], v25 offset:18432
ds_read_b64_tr_b16 v[172:173], v25 offset:20480
ds_read_b64_tr_b16 v[174:175], v25 offset:22528
ds_read_b64_tr_b16 v[176:177], v26 offset:16384
ds_read_b64_tr_b16 v[178:179], v26 offset:18432
ds_read_b64_tr_b16 v[180:181], v26 offset:20480
ds_read_b64_tr_b16 v[182:183], v26 offset:22528
ds_read_b64_tr_b16 v[184:185], v27 offset:16384
ds_read_b64_tr_b16 v[186:187], v27 offset:18432
ds_read_b64_tr_b16 v[188:189], v27 offset:20480
ds_read_b64_tr_b16 v[190:191], v27 offset:22528
s_and_b32 s40, s2, 1
s_bfe_u32 s3, s2, 0x10001
s_lshl_b32 s3, s3, 3
s_bfe_u32 s36, s2, 0x30003
s_add_u32 s36, s3, s36
s_lshl_b32 s29, s36, 7
s_bfe_u32 s3, s2, 0x10002
s_lshl_b32 s3, s3, 2
s_lshr_b32 s37, s2, 6
s_add_u32 s3, s3, s37
s_lshl_b32 s13, s3, 8
s_lshl_b32 s30, s3, 7
s_lshl_b32 s3, s40, 6
s_add_u32 s30, s30, s3
s_lshl_b32 s41, s101, 12
s_lshl_b32 s12, s36, 20
s_add_u32 s12, s12, s41
s_lshl_b32 s62, s36, 9
s_lshl_b32 s3, s40, 8
s_add_u32 s62, s62, s3
s_add_u32 s62, s62, 8392704
s_lshr_b32 s3, s2, 1
s_lshr_b32 s38, s2, 2
s_xor_b32 s3, s3, s38
s_and_b32 s3, s3, 1
s_lshl_b32 s3, s3, 4
s_sub_u32 s39, 32, s3
s_lshl_b32 s38, s40, 5
s_add_u32 s3, s3, s38
s_lshl_b32 s3, s3, 14
s_add_u32 s12, s12, s3
s_lshl_b32 s3, s3, 3
s_add_u32 s13, s13, s3
s_mov_b32 s64, 4294459392
s_mov_b32 s65, 16384
s_add_u32 s8, s4, 67108864
s_addc_u32 s9, s5, 0
s_lshl_b32 s56, s2, 15
s_lshl_b32 s38, s101, 13
s_add_u32 s56, s56, s38
s_xor_b32 s57, s56, 32768
s_lshl_b32 s58, s2, 2
s_add_u32 s58, s58, 8388608
s_xor_b32 s59, s58, 4
s_mov_b32 s61, 0
s_lshl_b32 s3, s101, 4
v_lshrrev_b32 v232, 4, v0
v_and_b32 v234, 15, v0
v_add_u32 v233, 0, v232
v_lshlrev_b32 v233, 1, v233
v_xor_b32 v233, v233, v234
v_add_u32 v235, s3, v232
v_lshlrev_b32 v235, 11, v235
v_lshl_add_u32 v235, v233, 4, v235
v_add_u32 v2, 0, v235
v_add_u32 v233, 4, v232
v_lshlrev_b32 v233, 1, v233
v_xor_b32 v233, v233, v234
v_add_u32 v235, s3, v232
v_lshlrev_b32 v235, 11, v235
v_lshl_add_u32 v235, v233, 4, v235
v_add_u32 v3, 7168, v235
v_add_u32 v233, 0, v232
v_lshlrev_b32 v233, 1, v233
v_xor_b32 v233, v233, v234
v_add_u32 v235, s3, v232
v_lshlrev_b32 v235, 11, v235
v_lshl_add_u32 v235, v233, 4, v235
v_add_u32 v4, 14336, v235
v_add_u32 v233, 4, v232
v_lshlrev_b32 v233, 1, v233
v_xor_b32 v233, v233, v234
v_add_u32 v235, s3, v232
v_lshlrev_b32 v235, 11, v235
v_lshl_add_u32 v235, v233, 4, v235
v_add_u32 v5, 21504, v235
v_lshlrev_b32 v225, 8, v224
v_lshl_add_u32 v225, v226, 3, v225
v_and_b32 v228, 7, v224
v_lshlrev_b32 v228, 1, v228
s_lshl_b32 s38, s40, 3
v_xor_b32 v228, s38, v228
v_add_u32 v227, 0, v229
v_xor_b32 v227, v227, v228
v_lshl_add_u32 v8, v227, 4, v225
v_add_u32 v16, 0x10000, v8
v_add_u32 v227, 2, v229
v_xor_b32 v227, v227, v228
v_lshl_add_u32 v9, v227, 4, v225
v_add_u32 v17, 0x10000, v9
v_add_u32 v227, 4, v229
v_xor_b32 v227, v227, v228
v_lshl_add_u32 v10, v227, 4, v225
v_add_u32 v18, 0x10000, v10
v_add_u32 v227, 6, v229
v_xor_b32 v227, v227, v228
v_lshl_add_u32 v11, v227, 4, v225
v_add_u32 v19, 0x10000, v11
v_add_u32 v227, 8, v229
v_xor_b32 v227, v227, v228
v_lshl_add_u32 v12, v227, 4, v225
v_add_u32 v20, 0x10000, v12
v_add_u32 v227, 10, v229
v_xor_b32 v227, v227, v228
v_lshl_add_u32 v13, v227, 4, v225
v_add_u32 v21, 0x10000, v13
v_add_u32 v227, 12, v229
v_xor_b32 v227, v227, v228
v_lshl_add_u32 v14, v227, 4, v225
v_add_u32 v22, 0x10000, v14
v_add_u32 v227, 14, v229
v_xor_b32 v227, v227, v228
v_lshl_add_u32 v15, v227, 4, v225
v_add_u32 v23, 0x10000, v15
v_mov_b32 v253, 0
v_mov_b32 v254, 1
v_lshlrev_b32 v255, 2, v0
s_waitcnt lgkmcnt(0)
s_mov_b32 s16, s14
s_mov_b32 s17, s15
s_mov_b32 s18, 8388608
s_mov_b32 s19, 0x00020000
s_waitcnt vmcnt(26) lgkmcnt(0)
s_barrier
M a[0:3], v[160:163], a[192:195], 0
s_add_u32 m0, s42, 98304
s_nop 0
buffer_load_dwordx4 v6, s[48:51], s26 offen offset:0 lds
ds_read_b64_tr_b16 v[96:97], v24 offset:32768
ds_read_b64_tr_b16 v[98:99], v24 offset:34816
M a[0:3], v[164:167], a[196:199], a[0:3]
buffer_load_dwordx4 v7, s[48:51], s26 offen offset:1024 lds
M a[4:7], v[172:175], a[196:199], 0
ds_read_b64_tr_b16 v[100:101], v24 offset:36864
ds_read_b64_tr_b16 v[102:103], v24 offset:38912
M a[4:7], v[168:171], a[192:195], a[4:7]
buffer_load_dwordx4 a[144:147], v1, s[44:47], s25 offen offset:0 sc1
M a[8:11], v[176:179], a[192:195], 0
ds_read_b64_tr_b16 v[104:105], v25 offset:32768
ds_read_b64_tr_b16 v[106:107], v25 offset:34816
M a[8:11], v[180:183], a[196:199], a[8:11]
buffer_load_dwordx4 a[148:151], v1, s[44:47], s25 offen offset:1024 sc1
M a[12:15], v[188:191], a[196:199], 0
ds_read_b64_tr_b16 v[108:109], v25 offset:36864
ds_read_b64_tr_b16 v[110:111], v25 offset:38912
M a[12:15], v[184:187], a[192:195], a[12:15]
buffer_load_dwordx4 a[152:155], v1, s[44:47], s25 offen offset:2048 sc1
M a[16:19], v[160:163], a[200:203], 0
ds_read_b64_tr_b16 v[112:113], v26 offset:32768
ds_read_b64_tr_b16 v[114:115], v26 offset:34816
M a[16:19], v[164:167], a[204:207], a[16:19]
buffer_load_dwordx4 a[156:159], v1, s[44:47], s25 offen offset:3072 sc1
M a[20:23], v[172:175], a[204:207], 0
ds_read_b64_tr_b16 v[116:117], v26 offset:36864
ds_read_b64_tr_b16 v[118:119], v26 offset:38912
M a[20:23], v[168:171], a[200:203], a[20:23]
s_add_u32 s25, s25, 16384
s_add_u32 s26, s26, 131072
M a[24:27], v[176:179], a[200:203], 0
ds_read_b64_tr_b16 v[120:121], v27 offset:32768
ds_read_b64_tr_b16 v[122:123], v27 offset:34816
M a[24:27], v[180:183], a[204:207], a[24:27]
ds_read_b64_tr_b16 v[124:125], v27 offset:36864
ds_read_b64_tr_b16 v[126:127], v27 offset:38912
M a[28:31], v[188:191], a[204:207], 0
M a[28:31], v[184:187], a[200:203], a[28:31]
s_waitcnt vmcnt(6) lgkmcnt(0)
s_barrier
s_mov_b64 exec, 1
buffer_store_dword v254, v253, s[52:55], s92 offen sc1
buffer_store_dword v254, v253, s[52:55], s93 offen sc1
buffer_store_dword v254, v253, s[52:55], s94 offen sc1
s_mov_b64 exec, -1
M a[0:3], v[96:99], a[208:211], a[0:3]
s_add_u32 m0, s42, 114688
s_nop 0
buffer_load_dwordx4 v6, s[48:51], s26 offen offset:0 lds
ds_read_b64_tr_b16 v[160:161], v24 offset:49152
ds_read_b64_tr_b16 v[162:163], v24 offset:51200
M a[0:3], v[100:103], a[212:215], a[0:3]
buffer_load_dwordx4 v7, s[48:51], s26 offen offset:1024 lds
M a[4:7], v[108:111], a[212:215], a[4:7]
ds_read_b64_tr_b16 v[164:165], v24 offset:53248
ds_read_b64_tr_b16 v[166:167], v24 offset:55296
M a[4:7], v[104:107], a[208:211], a[4:7]
buffer_load_dwordx4 a[160:163], v1, s[44:47], s25 offen offset:0 sc1
M a[8:11], v[112:115], a[208:211], a[8:11]
ds_read_b64_tr_b16 v[168:169], v25 offset:49152
ds_read_b64_tr_b16 v[170:171], v25 offset:51200
M a[8:11], v[116:119], a[212:215], a[8:11]
buffer_load_dwordx4 a[164:167], v1, s[44:47], s25 offen offset:1024 sc1
M a[12:15], v[124:127], a[212:215], a[12:15]
ds_read_b64_tr_b16 v[172:173], v25 offset:53248
ds_read_b64_tr_b16 v[174:175], v25 offset:55296
M a[12:15], v[120:123], a[208:211], a[12:15]
buffer_load_dwordx4 a[168:171], v1, s[44:47], s25 offen offset:2048 sc1
M a[16:19], v[96:99], a[216:219], a[16:19]
ds_read_b64_tr_b16 v[176:177], v26 offset:49152
ds_read_b64_tr_b16 v[178:179], v26 offset:51200
M a[16:19], v[100:103], a[220:223], a[16:19]
buffer_load_dwordx4 a[172:175], v1, s[44:47], s25 offen offset:3072 sc1
M a[20:23], v[108:111], a[220:223], a[20:23]
ds_read_b64_tr_b16 v[180:181], v26 offset:53248
ds_read_b64_tr_b16 v[182:183], v26 offset:55296
M a[20:23], v[104:107], a[216:219], a[20:23]
s_add_u32 s25, s25, 16384
s_add_u32 s26, s26, 131072
M a[24:27], v[112:115], a[216:219], a[24:27]
ds_read_b64_tr_b16 v[184:185], v27 offset:49152
ds_read_b64_tr_b16 v[186:187], v27 offset:51200
M a[24:27], v[116:119], a[220:223], a[24:27]
ds_read_b64_tr_b16 v[188:189], v27 offset:53248
ds_read_b64_tr_b16 v[190:191], v27 offset:55296
M a[28:31], v[124:127], a[220:223], a[28:31]
M a[28:31], v[120:123], a[216:219], a[28:31]
s_waitcnt vmcnt(29) lgkmcnt(0)
s_barrier
M a[0:3], v[160:163], a[224:227], a[0:3]
s_add_u32 m0, s42, 0
s_nop 0
buffer_load_dwordx4 v6, s[48:51], s26 offen offset:0 lds
ds_read_b64_tr_b16 v[96:97], v28 offset:0
ds_read_b64_tr_b16 v[98:99], v28 offset:2048
M a[0:3], v[164:167], a[228:231], a[0:3]
buffer_load_dwordx4 v7, s[48:51], s26 offen offset:1024 lds
M a[4:7], v[172:175], a[228:231], a[4:7]
ds_read_b64_tr_b16 v[100:101], v28 offset:4096
ds_read_b64_tr_b16 v[102:103], v28 offset:6144
M a[4:7], v[168:171], a[224:227], a[4:7]
buffer_load_dwordx4 a[176:179], v1, s[44:47], s25 offen offset:0 sc1
M a[8:11], v[176:179], a[224:227], a[8:11]
ds_read_b64_tr_b16 v[104:105], v29 offset:0
ds_read_b64_tr_b16 v[106:107], v29 offset:2048
M a[8:11], v[180:183], a[228:231], a[8:11]
buffer_load_dwordx4 a[180:183], v1, s[44:47], s25 offen offset:1024 sc1
M a[12:15], v[188:191], a[228:231], a[12:15]
ds_read_b64_tr_b16 v[108:109], v29 offset:4096
ds_read_b64_tr_b16 v[110:111], v29 offset:6144
M a[12:15], v[184:187], a[224:227], a[12:15]
buffer_load_dwordx4 a[184:187], v1, s[44:47], s25 offen offset:2048 sc1
ds_read_b64_tr_b16 v[112:113], v30 offset:0
ds_read_b64_tr_b16 v[114:115], v30 offset:2048
M a[16:19], v[160:163], a[232:235], a[16:19]
buffer_load_dwordx4 a[188:191], v1, s[44:47], s25 offen offset:3072 sc1
M a[16:19], v[164:167], a[236:239], a[16:19]
ds_read_b64_tr_b16 v[116:117], v30 offset:4096
ds_read_b64_tr_b16 v[118:119], v30 offset:6144
M a[20:23], v[172:175], a[236:239], a[20:23]
s_add_u32 s25, s25, 16384
s_add_u32 s26, s26, 131072
M a[20:23], v[168:171], a[232:235], a[20:23]
ds_read_b64_tr_b16 v[120:121], v31 offset:0
ds_read_b64_tr_b16 v[122:123], v31 offset:2048
M a[24:27], v[176:179], a[232:235], a[24:27]
buffer_load_dword v252, v255, s[52:55], s62 offen sc1
M a[24:27], v[180:183], a[236:239], a[24:27]
ds_read_b64_tr_b16 v[124:125], v31 offset:4096
ds_read_b64_tr_b16 v[126:127], v31 offset:6144
M a[28:31], v[188:191], a[236:239], a[28:31]
M a[28:31], v[184:187], a[232:235], a[28:31]
s_waitcnt vmcnt(30) lgkmcnt(0)
s_barrier
s_waitcnt vmcnt(0)
v_cmp_ne_u32 vcc, 1, v252
s_nop 0
s_cbranch_vccnz Lk3_spinft
Lk3_gotft:
M a[0:3], v[96:99], a[240:243], a[0:3]
s_mov_b32 s32, s25
s_mov_b32 s33, s26
s_mov_b64 s[34:35], s[44:45]
s_mov_b64 s[36:37], s[48:49]
s_mov_b64 s[44:45], s[8:9]
s_mov_b32 s46, 16777216
s_mov_b64 s[48:49], s[10:11]
s_mov_b32 s50, 8388608
s_mov_b32 s25, s12
s_mov_b32 s26, s13
s_add_u32 m0, s41, 16384
s_nop 0
buffer_load_dwordx4 v2, s[48:51], s26 offen offset:0 lds
ds_read_b64_tr_b16 v[160:161], v28 offset:16384
ds_read_b64_tr_b16 v[162:163], v28 offset:18432
M a[0:3], v[100:103], a[244:247], a[0:3]
buffer_load_dwordx4 v3, s[48:51], s26 offen offset:1024 lds
M a[4:7], v[108:111], a[244:247], a[4:7]
ds_read_b64_tr_b16 v[164:165], v28 offset:20480
ds_read_b64_tr_b16 v[166:167], v28 offset:22528
M a[4:7], v[104:107], a[240:243], a[4:7]
buffer_load_dwordx4 v4, s[48:51], s26 offen offset:2048 lds
ds_read_b64_tr_b16 v[168:169], v29 offset:16384
ds_read_b64_tr_b16 v[170:171], v29 offset:18432
M a[8:11], v[112:115], a[240:243], a[8:11]
buffer_load_dwordx4 v5, s[48:51], s26 offen offset:3072 lds
M a[8:11], v[116:119], a[244:247], a[8:11]
ds_read_b64_tr_b16 v[172:173], v29 offset:20480
ds_read_b64_tr_b16 v[174:175], v29 offset:22528
M a[12:15], v[124:127], a[244:247], a[12:15]
buffer_load_dwordx4 a[192:195], v1, s[44:47], s25 offen offset:0 sc1
M a[12:15], v[120:123], a[240:243], a[12:15]
ds_read_b64_tr_b16 v[176:177], v30 offset:16384
ds_read_b64_tr_b16 v[178:179], v30 offset:18432
buffer_load_dwordx4 a[196:199], v1, s[44:47], s25 offen offset:1024 sc1
M a[16:19], v[96:99], a[248:251], a[16:19]
ds_read_b64_tr_b16 v[180:181], v30 offset:20480
ds_read_b64_tr_b16 v[182:183], v30 offset:22528
M a[16:19], v[100:103], a[252:255], a[16:19]
buffer_load_dwordx4 a[200:203], v1, s[44:47], s25 offen offset:2048 sc1
M a[20:23], v[108:111], a[252:255], a[20:23]
ds_read_b64_tr_b16 v[184:185], v31 offset:16384
ds_read_b64_tr_b16 v[186:187], v31 offset:18432
buffer_load_dwordx4 a[204:207], v1, s[44:47], s25 offen offset:3072 sc1
M a[20:23], v[104:107], a[248:251], a[20:23]
ds_read_b64_tr_b16 v[188:189], v31 offset:20480
ds_read_b64_tr_b16 v[190:191], v31 offset:22528
M a[24:27], v[112:115], a[248:251], a[24:27]
s_sub_u32 s39, s39, 1
s_cmp_eq_u32 s39, 0
s_cselect_b32 s3, s64, s65
M a[24:27], v[116:119], a[252:255], a[24:27]
s_add_u32 s25, s25, s3
s_lshl_b32 s3, s3, 3
s_add_u32 s26, s26, s3
M a[28:31], v[124:127], a[252:255], a[28:31]
M a[28:31], v[120:123], a[248:251], a[28:31]
s_waitcnt vmcnt(24) lgkmcnt(0)
s_barrier
M a[0:3], v[160:163], a[128:131], a[0:3]
s_add_u32 m0, s41, 32768
s_nop 0
buffer_load_dwordx4 v2, s[48:51], s26 offen offset:0 lds
ds_read_b64_tr_b16 v[96:97], v28 offset:32768
ds_read_b64_tr_b16 v[98:99], v28 offset:34816
M a[0:3], v[164:167], a[132:135], a[0:3]
buffer_load_dwordx4 v3, s[48:51], s26 offen offset:1024 lds
M a[4:7], v[172:175], a[132:135], a[4:7]
ds_read_b64_tr_b16 v[100:101], v28 offset:36864
ds_read_b64_tr_b16 v[102:103], v28 offset:38912
M a[4:7], v[168:171], a[128:131], a[4:7]
buffer_load_dwordx4 v4, s[48:51], s26 offen offset:2048 lds
ds_read_b64_tr_b16 v[104:105], v29 offset:32768
ds_read_b64_tr_b16 v[106:107], v29 offset:34816
M a[8:11], v[176:179], a[128:131], a[8:11]
buffer_load_dwordx4 v5, s[48:51], s26 offen offset:3072 lds
M a[8:11], v[180:183], a[132:135], a[8:11]
ds_read_b64_tr_b16 v[108:109], v29 offset:36864
ds_read_b64_tr_b16 v[110:111], v29 offset:38912
M a[12:15], v[188:191], a[132:135], a[12:15]
buffer_load_dwordx4 a[208:211], v1, s[44:47], s25 offen offset:0 sc1
M a[12:15], v[184:187], a[128:131], a[12:15]
ds_read_b64_tr_b16 v[112:113], v30 offset:32768
ds_read_b64_tr_b16 v[114:115], v30 offset:34816
buffer_load_dwordx4 a[212:215], v1, s[44:47], s25 offen offset:1024 sc1
M a[16:19], v[160:163], a[136:139], a[16:19]
ds_read_b64_tr_b16 v[116:117], v30 offset:36864
ds_read_b64_tr_b16 v[118:119], v30 offset:38912
M a[16:19], v[164:167], a[140:143], a[16:19]
buffer_load_dwordx4 a[216:219], v1, s[44:47], s25 offen offset:2048 sc1
M a[20:23], v[172:175], a[140:143], a[20:23]
ds_read_b64_tr_b16 v[120:121], v31 offset:32768
ds_read_b64_tr_b16 v[122:123], v31 offset:34816
buffer_load_dwordx4 a[220:223], v1, s[44:47], s25 offen offset:3072 sc1
M a[20:23], v[168:171], a[136:139], a[20:23]
ds_read_b64_tr_b16 v[124:125], v31 offset:36864
ds_read_b64_tr_b16 v[126:127], v31 offset:38912
M a[24:27], v[176:179], a[136:139], a[24:27]
s_sub_u32 s39, s39, 1
s_cmp_eq_u32 s39, 0
s_cselect_b32 s3, s64, s65
M a[24:27], v[180:183], a[140:143], a[24:27]
s_add_u32 s25, s25, s3
s_lshl_b32 s3, s3, 3
s_add_u32 s26, s26, s3
M a[28:31], v[188:191], a[140:143], a[28:31]
M a[28:31], v[184:187], a[136:139], a[28:31]
s_waitcnt vmcnt(23) lgkmcnt(0)
s_barrier
M a[0:3], v[96:99], a[144:147], a[0:3]
s_add_u32 m0, s41, 49152
s_nop 0
buffer_load_dwordx4 v2, s[48:51], s26 offen offset:0 lds
ds_read_b64_tr_b16 v[160:161], v28 offset:49152
ds_read_b64_tr_b16 v[162:163], v28 offset:51200
M a[0:3], v[100:103], a[148:151], a[0:3]
buffer_load_dwordx4 v3, s[48:51], s26 offen offset:1024 lds
M a[4:7], v[108:111], a[148:151], a[4:7]
ds_read_b64_tr_b16 v[164:165], v28 offset:53248
ds_read_b64_tr_b16 v[166:167], v28 offset:55296
M a[4:7], v[104:107], a[144:147], a[4:7]
buffer_load_dwordx4 v4, s[48:51], s26 offen offset:2048 lds
ds_read_b64_tr_b16 v[168:169], v29 offset:49152
ds_read_b64_tr_b16 v[170:171], v29 offset:51200
M a[8:11], v[112:115], a[144:147], a[8:11]
buffer_load_dwordx4 v5, s[48:51], s26 offen offset:3072 lds
M a[8:11], v[116:119], a[148:151], a[8:11]
ds_read_b64_tr_b16 v[172:173], v29 offset:53248
ds_read_b64_tr_b16 v[174:175], v29 offset:55296
M a[12:15], v[124:127], a[148:151], a[12:15]
buffer_load_dwordx4 a[224:227], v1, s[44:47], s25 offen offset:0 sc1
M a[12:15], v[120:123], a[144:147], a[12:15]
ds_read_b64_tr_b16 v[176:177], v30 offset:49152
ds_read_b64_tr_b16 v[178:179], v30 offset:51200
buffer_load_dwordx4 a[228:231], v1, s[44:47], s25 offen offset:1024 sc1
M a[16:19], v[96:99], a[152:155], a[16:19]
ds_read_b64_tr_b16 v[180:181], v30 offset:53248
ds_read_b64_tr_b16 v[182:183], v30 offset:55296
M a[16:19], v[100:103], a[156:159], a[16:19]
buffer_load_dwordx4 a[232:235], v1, s[44:47], s25 offen offset:2048 sc1
M a[20:23], v[108:111], a[156:159], a[20:23]
ds_read_b64_tr_b16 v[184:185], v31 offset:49152
ds_read_b64_tr_b16 v[186:187], v31 offset:51200
buffer_load_dwordx4 a[236:239], v1, s[44:47], s25 offen offset:3072 sc1
M a[20:23], v[104:107], a[152:155], a[20:23]
ds_read_b64_tr_b16 v[188:189], v31 offset:53248
ds_read_b64_tr_b16 v[190:191], v31 offset:55296
M a[24:27], v[112:115], a[152:155], a[24:27]
s_sub_u32 s39, s39, 1
s_cmp_eq_u32 s39, 0
s_cselect_b32 s3, s64, s65
M a[24:27], v[116:119], a[156:159], a[24:27]
s_add_u32 s25, s25, s3
s_lshl_b32 s3, s3, 3
s_add_u32 s26, s26, s3
M a[28:31], v[124:127], a[156:159], a[28:31]
M a[28:31], v[120:123], a[152:155], a[28:31]
s_waitcnt vmcnt(25) lgkmcnt(0)
s_barrier
M a[0:3], v[160:163], a[160:163], a[0:3]
s_add_u32 m0, s41, 65536
s_nop 0
buffer_load_dwordx4 v2, s[48:51], s26 offen offset:0 lds
ds_read_b64_tr_b16 v[96:97], v24 offset:0
ds_read_b64_tr_b16 v[98:99], v24 offset:2048
M a[0:3], v[164:167], a[164:167], a[0:3]
buffer_load_dwordx4 v3, s[48:51], s26 offen offset:1024 lds
M a[4:7], v[172:175], a[164:167], a[4:7]
ds_read_b64_tr_b16 v[100:101], v24 offset:4096
ds_read_b64_tr_b16 v[102:103], v24 offset:6144
M a[4:7], v[168:171], a[160:163], a[4:7]
buffer_load_dwordx4 v4, s[48:51], s26 offen offset:2048 lds
ds_read_b64_tr_b16 v[104:105], v25 offset:0
ds_read_b64_tr_b16 v[106:107], v25 offset:2048
M a[8:11], v[176:179], a[160:163], a[8:11]
buffer_load_dwordx4 v5, s[48:51], s26 offen offset:3072 lds
M a[8:11], v[180:183], a[164:167], a[8:11]
ds_read_b64_tr_b16 v[108:109], v25 offset:4096
ds_read_b64_tr_b16 v[110:111], v25 offset:6144
M a[12:15], v[188:191], a[164:167], a[12:15]
buffer_load_dwordx4 a[240:243], v1, s[44:47], s25 offen offset:0 sc1
M a[12:15], v[184:187], a[160:163], a[12:15]
ds_read_b64_tr_b16 v[112:113], v26 offset:0
ds_read_b64_tr_b16 v[114:115], v26 offset:2048
buffer_load_dwordx4 a[244:247], v1, s[44:47], s25 offen offset:1024 sc1
M a[16:19], v[160:163], a[168:171], a[16:19]
ds_read_b64_tr_b16 v[116:117], v26 offset:4096
ds_read_b64_tr_b16 v[118:119], v26 offset:6144
M a[16:19], v[164:167], a[172:175], a[16:19]
buffer_load_dwordx4 a[248:251], v1, s[44:47], s25 offen offset:2048 sc1
M a[20:23], v[172:175], a[172:175], a[20:23]
ds_read_b64_tr_b16 v[120:121], v27 offset:0
ds_read_b64_tr_b16 v[122:123], v27 offset:2048
buffer_load_dwordx4 a[252:255], v1, s[44:47], s25 offen offset:3072 sc1
M a[20:23], v[168:171], a[168:171], a[20:23]
ds_read_b64_tr_b16 v[124:125], v27 offset:4096
ds_read_b64_tr_b16 v[126:127], v27 offset:6144
M a[24:27], v[176:179], a[168:171], a[24:27]
s_sub_u32 s39, s39, 1
s_cmp_eq_u32 s39, 0
s_cselect_b32 s3, s64, s65
M a[24:27], v[180:183], a[172:175], a[24:27]
s_add_u32 s25, s25, s3
s_lshl_b32 s3, s3, 3
s_add_u32 s26, s26, s3
M a[28:31], v[188:191], a[172:175], a[28:31]
M a[28:31], v[184:187], a[168:171], a[28:31]
s_waitcnt vmcnt(24) lgkmcnt(0)
s_barrier
M a[0:3], v[96:99], a[176:179], a[0:3]
s_add_u32 m0, s41, 81920
s_nop 0
buffer_load_dwordx4 v2, s[48:51], s26 offen offset:0 lds
ds_read_b64_tr_b16 v[160:161], v8 offset:16384
ds_read_b64_tr_b16 v[162:163], v8 offset:20480
M a[0:3], v[100:103], a[180:183], a[0:3]
buffer_load_dwordx4 v3, s[48:51], s26 offen offset:1024 lds
ds_read_b64_tr_b16 v[164:165], v8 offset:24576
ds_read_b64_tr_b16 v[166:167], v8 offset:28672
M a[4:7], v[108:111], a[180:183], a[4:7]
buffer_load_dwordx4 v4, s[48:51], s26 offen offset:2048 lds
ds_read_b64_tr_b16 v[168:169], v9 offset:16384
ds_read_b64_tr_b16 v[170:171], v9 offset:20480
M a[4:7], v[104:107], a[176:179], a[4:7]
buffer_load_dwordx4 v5, s[48:51], s26 offen offset:3072 lds
ds_read_b64_tr_b16 v[172:173], v9 offset:24576
ds_read_b64_tr_b16 v[174:175], v9 offset:28672
M a[8:11], v[112:115], a[176:179], a[8:11]
buffer_load_dwordx4 a[128:131], v1, s[44:47], s25 offen offset:0 sc1
ds_read_b64_tr_b16 v[176:177], v10 offset:16384
ds_read_b64_tr_b16 v[178:179], v10 offset:20480
M a[8:11], v[116:119], a[180:183], a[8:11]
buffer_load_dwordx4 a[132:135], v1, s[44:47], s25 offen offset:1024 sc1
ds_read_b64_tr_b16 v[180:181], v10 offset:24576
ds_read_b64_tr_b16 v[182:183], v10 offset:28672
M a[12:15], v[124:127], a[180:183], a[12:15]
buffer_load_dwordx4 a[136:139], v1, s[44:47], s25 offen offset:2048 sc1
M a[12:15], v[120:123], a[176:179], a[12:15]
ds_read_b64_tr_b16 v[184:185], v11 offset:16384
ds_read_b64_tr_b16 v[186:187], v11 offset:20480
buffer_load_dwordx4 a[140:143], v1, s[44:47], s25 offen offset:3072 sc1
M a[16:19], v[96:99], a[184:187], a[16:19]
ds_read_b64_tr_b16 v[188:189], v11 offset:24576
ds_read_b64_tr_b16 v[190:191], v11 offset:28672
s_sub_u32 s39, s39, 1
s_cmp_eq_u32 s39, 0
s_cselect_b32 s3, s64, s65
M a[16:19], v[100:103], a[188:191], a[16:19]
ds_read_b64_tr_b16 v[192:193], v12 offset:16384
ds_read_b64_tr_b16 v[194:195], v12 offset:20480
s_add_u32 s25, s25, s3
s_lshl_b32 s3, s3, 3
s_add_u32 s26, s26, s3
M a[20:23], v[108:111], a[188:191], a[20:23]
ds_read_b64_tr_b16 v[196:197], v12 offset:24576
ds_read_b64_tr_b16 v[198:199], v12 offset:28672
ds_read_b64_tr_b16 v[200:201], v13 offset:16384
ds_read_b64_tr_b16 v[202:203], v13 offset:20480
M a[20:23], v[104:107], a[184:187], a[20:23]
ds_read_b64_tr_b16 v[204:205], v13 offset:24576
ds_read_b64_tr_b16 v[206:207], v13 offset:28672
ds_read_b64_tr_b16 v[208:209], v14 offset:16384
ds_read_b64_tr_b16 v[210:211], v14 offset:20480
M a[24:27], v[112:115], a[184:187], a[24:27]
ds_read_b64_tr_b16 v[212:213], v14 offset:24576
ds_read_b64_tr_b16 v[214:215], v14 offset:28672
ds_read_b64_tr_b16 v[216:217], v15 offset:16384
ds_read_b64_tr_b16 v[218:219], v15 offset:20480
M a[24:27], v[116:119], a[188:191], a[24:27]
ds_read_b64_tr_b16 v[220:221], v15 offset:24576
ds_read_b64_tr_b16 v[222:223], v15 offset:28672
M a[28:31], v[124:127], a[188:191], a[28:31]
M a[28:31], v[120:123], a[184:187], a[28:31]
s_waitcnt vmcnt(24) lgkmcnt(0)
s_barrier
M v[32:35], v[160:163], a[192:195], 0
s_add_u32 m0, s41, 98304
s_nop 0
buffer_load_dwordx4 v2, s[48:51], s26 offen offset:0 lds
M v[32:35], v[164:167], a[196:199], v[32:35]
ds_read_b64_tr_b16 v[96:97], v8 offset:32768
ds_read_b64_tr_b16 v[98:99], v8 offset:36864
M v[36:39], v[172:175], a[196:199], 0
buffer_load_dwordx4 v3, s[48:51], s26 offen offset:1024 lds
M v[36:39], v[168:171], a[192:195], v[36:39]
ds_read_b64_tr_b16 v[100:101], v8 offset:40960
ds_read_b64_tr_b16 v[102:103], v8 offset:45056
M v[40:43], v[176:179], a[192:195], 0
buffer_load_dwordx4 v4, s[48:51], s26 offen offset:2048 lds
M v[40:43], v[180:183], a[196:199], v[40:43]
ds_read_b64_tr_b16 v[104:105], v9 offset:32768
ds_read_b64_tr_b16 v[106:107], v9 offset:36864
M v[44:47], v[188:191], a[196:199], 0
buffer_load_dwordx4 v5, s[48:51], s26 offen offset:3072 lds
M v[44:47], v[184:187], a[192:195], v[44:47]
M v[48:51], v[192:195], a[192:195], 0
ds_read_b64_tr_b16 v[108:109], v9 offset:40960
ds_read_b64_tr_b16 v[110:111], v9 offset:45056
M v[48:51], v[196:199], a[196:199], v[48:51]
buffer_load_dwordx4 a[144:147], v1, s[44:47], s25 offen offset:0 sc1
M v[52:55], v[204:207], a[196:199], 0
ds_read_b64_tr_b16 v[112:113], v10 offset:32768
ds_read_b64_tr_b16 v[114:115], v10 offset:36864
M v[52:55], v[200:203], a[192:195], v[52:55]
buffer_load_dwordx4 a[148:151], v1, s[44:47], s25 offen offset:1024 sc1
M v[56:59], v[208:211], a[192:195], 0
ds_read_b64_tr_b16 v[116:117], v10 offset:40960
ds_read_b64_tr_b16 v[118:119], v10 offset:45056
M v[56:59], v[212:215], a[196:199], v[56:59]
buffer_load_dwordx4 a[152:155], v1, s[44:47], s25 offen offset:2048 sc1
M v[60:63], v[220:223], a[196:199], 0
M v[60:63], v[216:219], a[192:195], v[60:63]
ds_read_b64_tr_b16 v[120:121], v11 offset:32768
ds_read_b64_tr_b16 v[122:123], v11 offset:36864
M v[64:67], v[160:163], a[200:203], 0
buffer_load_dwordx4 a[156:159], v1, s[44:47], s25 offen offset:3072 sc1
M v[64:67], v[164:167], a[204:207], v[64:67]
ds_read_b64_tr_b16 v[124:125], v11 offset:40960
ds_read_b64_tr_b16 v[126:127], v11 offset:45056
M v[68:71], v[172:175], a[204:207], 0
s_sub_u32 s39, s39, 1
s_cmp_eq_u32 s39, 0
s_cselect_b32 s3, s64, s65
M v[68:71], v[168:171], a[200:203], v[68:71]
ds_read_b64_tr_b16 v[128:129], v12 offset:32768
ds_read_b64_tr_b16 v[130:131], v12 offset:36864
M v[72:75], v[176:179], a[200:203], 0
s_add_u32 s25, s25, s3
s_lshl_b32 s3, s3, 3
s_add_u32 s26, s26, s3
M v[72:75], v[180:183], a[204:207], v[72:75]
ds_read_b64_tr_b16 v[132:133], v12 offset:40960
ds_read_b64_tr_b16 v[134:135], v12 offset:45056
M v[76:79], v[188:191], a[204:207], 0
M v[76:79], v[184:187], a[200:203], v[76:79]
ds_read_b64_tr_b16 v[136:137], v13 offset:32768
ds_read_b64_tr_b16 v[138:139], v13 offset:36864
M v[80:83], v[192:195], a[200:203], 0
ds_read_b64_tr_b16 v[140:141], v13 offset:40960
ds_read_b64_tr_b16 v[142:143], v13 offset:45056
M v[80:83], v[196:199], a[204:207], v[80:83]
ds_read_b64_tr_b16 v[144:145], v14 offset:32768
ds_read_b64_tr_b16 v[146:147], v14 offset:36864
M v[84:87], v[204:207], a[204:207], 0
ds_read_b64_tr_b16 v[148:149], v14 offset:40960
ds_read_b64_tr_b16 v[150:151], v14 offset:45056
M v[84:87], v[200:203], a[200:203], v[84:87]
ds_read_b64_tr_b16 v[152:153], v15 offset:32768
ds_read_b64_tr_b16 v[154:155], v15 offset:36864
M v[88:91], v[208:211], a[200:203], 0
ds_read_b64_tr_b16 v[156:157], v15 offset:40960
ds_read_b64_tr_b16 v[158:159], v15 offset:45056
M v[88:91], v[212:215], a[204:207], v[88:91]
M v[92:95], v[220:223], a[204:207], 0
M v[92:95], v[216:219], a[200:203], v[92:95]
s_mov_b32 s28, 3
Lk3_la:
s_waitcnt vmcnt(24) lgkmcnt(0)
s_barrier
M v[32:35], v[96:99], a[208:211], v[32:35]
s_add_u32 m0, s41, 114688
s_nop 0
buffer_load_dwordx4 v2, s[48:51], s26 offen offset:0 lds
M v[32:35], v[100:103], a[212:215], v[32:35]
ds_read_b64_tr_b16 v[160:161], v8 offset:49152
ds_read_b64_tr_b16 v[162:163], v8 offset:53248
M v[36:39], v[108:111], a[212:215], v[36:39]
buffer_load_dwordx4 v3, s[48:51], s26 offen offset:1024 lds
M v[36:39], v[104:107], a[208:211], v[36:39]
ds_read_b64_tr_b16 v[164:165], v8 offset:57344
ds_read_b64_tr_b16 v[166:167], v8 offset:61440
M v[40:43], v[112:115], a[208:211], v[40:43]
buffer_load_dwordx4 v4, s[48:51], s26 offen offset:2048 lds
M v[40:43], v[116:119], a[212:215], v[40:43]
ds_read_b64_tr_b16 v[168:169], v9 offset:49152
ds_read_b64_tr_b16 v[170:171], v9 offset:53248
M v[44:47], v[124:127], a[212:215], v[44:47]
buffer_load_dwordx4 v5, s[48:51], s26 offen offset:3072 lds
M v[44:47], v[120:123], a[208:211], v[44:47]
M v[48:51], v[128:131], a[208:211], v[48:51]
ds_read_b64_tr_b16 v[172:173], v9 offset:57344
ds_read_b64_tr_b16 v[174:175], v9 offset:61440
M v[48:51], v[132:135], a[212:215], v[48:51]
buffer_load_dwordx4 a[160:163], v1, s[44:47], s25 offen offset:0 sc1
M v[52:55], v[140:143], a[212:215], v[52:55]
ds_read_b64_tr_b16 v[176:177], v10 offset:49152
ds_read_b64_tr_b16 v[178:179], v10 offset:53248
M v[52:55], v[136:139], a[208:211], v[52:55]
buffer_load_dwordx4 a[164:167], v1, s[44:47], s25 offen offset:1024 sc1
M v[56:59], v[144:147], a[208:211], v[56:59]
ds_read_b64_tr_b16 v[180:181], v10 offset:57344
ds_read_b64_tr_b16 v[182:183], v10 offset:61440
M v[56:59], v[148:151], a[212:215], v[56:59]
buffer_load_dwordx4 a[168:171], v1, s[44:47], s25 offen offset:2048 sc1
M v[60:63], v[156:159], a[212:215], v[60:63]
M v[60:63], v[152:155], a[208:211], v[60:63]
ds_read_b64_tr_b16 v[184:185], v11 offset:49152
ds_read_b64_tr_b16 v[186:187], v11 offset:53248
M v[64:67], v[96:99], a[216:219], v[64:67]
buffer_load_dwordx4 a[172:175], v1, s[44:47], s25 offen offset:3072 sc1
M v[64:67], v[100:103], a[220:223], v[64:67]
ds_read_b64_tr_b16 v[188:189], v11 offset:57344
ds_read_b64_tr_b16 v[190:191], v11 offset:61440
M v[68:71], v[108:111], a[220:223], v[68:71]
s_sub_u32 s39, s39, 1
s_cmp_eq_u32 s39, 0
s_cselect_b32 s3, s64, s65
M v[68:71], v[104:107], a[216:219], v[68:71]
ds_read_b64_tr_b16 v[192:193], v12 offset:49152
ds_read_b64_tr_b16 v[194:195], v12 offset:53248
M v[72:75], v[112:115], a[216:219], v[72:75]
s_add_u32 s25, s25, s3
s_lshl_b32 s3, s3, 3
s_add_u32 s26, s26, s3
M v[72:75], v[116:119], a[220:223], v[72:75]
ds_read_b64_tr_b16 v[196:197], v12 offset:57344
ds_read_b64_tr_b16 v[198:199], v12 offset:61440
M v[76:79], v[124:127], a[220:223], v[76:79]
M v[76:79], v[120:123], a[216:219], v[76:79]
ds_read_b64_tr_b16 v[200:201], v13 offset:49152
ds_read_b64_tr_b16 v[202:203], v13 offset:53248
M v[80:83], v[128:131], a[216:219], v[80:83]
ds_read_b64_tr_b16 v[204:205], v13 offset:57344
ds_read_b64_tr_b16 v[206:207], v13 offset:61440
M v[80:83], v[132:135], a[220:223], v[80:83]
ds_read_b64_tr_b16 v[208:209], v14 offset:49152
ds_read_b64_tr_b16 v[210:211], v14 offset:53248
M v[84:87], v[140:143], a[220:223], v[84:87]
ds_read_b64_tr_b16 v[212:213], v14 offset:57344
ds_read_b64_tr_b16 v[214:215], v14 offset:61440
M v[84:87], v[136:139], a[216:219], v[84:87]
ds_read_b64_tr_b16 v[216:217], v15 offset:49152
ds_read_b64_tr_b16 v[218:219], v15 offset:53248
M v[88:91], v[144:147], a[216:219], v[88:91]
ds_read_b64_tr_b16 v[220:221], v15 offset:57344
ds_read_b64_tr_b16 v[222:223], v15 offset:61440
M v[88:91], v[148:151], a[220:223], v[88:91]
M v[92:95], v[156:159], a[220:223], v[92:95]
M v[92:95], v[152:155], a[216:219], v[92:95]
s_waitcnt vmcnt(24) lgkmcnt(0)
s_barrier
M v[32:35], v[160:163], a[224:227], v[32:35]
s_add_u32 m0, s41, 0
s_nop 0
buffer_load_dwordx4 v2, s[48:51], s26 offen offset:0 lds
M v[32:35], v[164:167], a[228:231], v[32:35]
ds_read_b64_tr_b16 v[96:97], v16 offset:0
ds_read_b64_tr_b16 v[98:99], v16 offset:4096
M v[36:39], v[172:175], a[228:231], v[36:39]
buffer_load_dwordx4 v3, s[48:51], s26 offen offset:1024 lds
M v[36:39], v[168:171], a[224:227], v[36:39]
ds_read_b64_tr_b16 v[100:101], v16 offset:8192
ds_read_b64_tr_b16 v[102:103], v16 offset:12288
M v[40:43], v[176:179], a[224:227], v[40:43]
buffer_load_dwordx4 v4, s[48:51], s26 offen offset:2048 lds
M v[40:43], v[180:183], a[228:231], v[40:43]
ds_read_b64_tr_b16 v[104:105], v17 offset:0
ds_read_b64_tr_b16 v[106:107], v17 offset:4096
M v[44:47], v[188:191], a[228:231], v[44:47]
buffer_load_dwordx4 v5, s[48:51], s26 offen offset:3072 lds
M v[44:47], v[184:187], a[224:227], v[44:47]
M v[48:51], v[192:195], a[224:227], v[48:51]
ds_read_b64_tr_b16 v[108:109], v17 offset:8192
ds_read_b64_tr_b16 v[110:111], v17 offset:12288
M v[48:51], v[196:199], a[228:231], v[48:51]
buffer_load_dwordx4 a[176:179], v1, s[44:47], s25 offen offset:0 sc1
M v[52:55], v[204:207], a[228:231], v[52:55]
ds_read_b64_tr_b16 v[112:113], v18 offset:0
ds_read_b64_tr_b16 v[114:115], v18 offset:4096
M v[52:55], v[200:203], a[224:227], v[52:55]
buffer_load_dwordx4 a[180:183], v1, s[44:47], s25 offen offset:1024 sc1
M v[56:59], v[208:211], a[224:227], v[56:59]
ds_read_b64_tr_b16 v[116:117], v18 offset:8192
ds_read_b64_tr_b16 v[118:119], v18 offset:12288
M v[56:59], v[212:215], a[228:231], v[56:59]
buffer_load_dwordx4 a[184:187], v1, s[44:47], s25 offen offset:2048 sc1
M v[60:63], v[220:223], a[228:231], v[60:63]
M v[60:63], v[216:219], a[224:227], v[60:63]
ds_read_b64_tr_b16 v[120:121], v19 offset:0
ds_read_b64_tr_b16 v[122:123], v19 offset:4096
M v[64:67], v[160:163], a[232:235], v[64:67]
buffer_load_dwordx4 a[188:191], v1, s[44:47], s25 offen offset:3072 sc1
M v[64:67], v[164:167], a[236:239], v[64:67]
ds_read_b64_tr_b16 v[124:125], v19 offset:8192
ds_read_b64_tr_b16 v[126:127], v19 offset:12288
M v[68:71], v[172:175], a[236:239], v[68:71]
s_sub_u32 s39, s39, 1
s_cmp_eq_u32 s39, 0
s_cselect_b32 s3, s64, s65
M v[68:71], v[168:171], a[232:235], v[68:71]
ds_read_b64_tr_b16 v[128:129], v20 offset:0
ds_read_b64_tr_b16 v[130:131], v20 offset:4096
M v[72:75], v[176:179], a[232:235], v[72:75]
s_add_u32 s25, s25, s3
s_lshl_b32 s3, s3, 3
s_add_u32 s26, s26, s3
M v[72:75], v[180:183], a[236:239], v[72:75]
ds_read_b64_tr_b16 v[132:133], v20 offset:8192
ds_read_b64_tr_b16 v[134:135], v20 offset:12288
M v[76:79], v[188:191], a[236:239], v[76:79]
M v[76:79], v[184:187], a[232:235], v[76:79]
ds_read_b64_tr_b16 v[136:137], v21 offset:0
ds_read_b64_tr_b16 v[138:139], v21 offset:4096
M v[80:83], v[192:195], a[232:235], v[80:83]
ds_read_b64_tr_b16 v[140:141], v21 offset:8192
ds_read_b64_tr_b16 v[142:143], v21 offset:12288
M v[80:83], v[196:199], a[236:239], v[80:83]
ds_read_b64_tr_b16 v[144:145], v22 offset:0
ds_read_b64_tr_b16 v[146:147], v22 offset:4096
M v[84:87], v[204:207], a[236:239], v[84:87]
ds_read_b64_tr_b16 v[148:149], v22 offset:8192
ds_read_b64_tr_b16 v[150:151], v22 offset:12288
M v[84:87], v[200:203], a[232:235], v[84:87]
ds_read_b64_tr_b16 v[152:153], v23 offset:0
ds_read_b64_tr_b16 v[154:155], v23 offset:4096
M v[88:91], v[208:211], a[232:235], v[88:91]
ds_read_b64_tr_b16 v[156:157], v23 offset:8192
ds_read_b64_tr_b16 v[158:159], v23 offset:12288
M v[88:91], v[212:215], a[236:239], v[88:91]
M v[92:95], v[220:223], a[236:239], v[92:95]
M v[92:95], v[216:219], a[232:235], v[92:95]
s_waitcnt vmcnt(24) lgkmcnt(0)
s_barrier
M v[32:35], v[96:99], a[240:243], v[32:35]
s_add_u32 m0, s41, 16384
s_nop 0
buffer_load_dwordx4 v2, s[48:51], s26 offen offset:0 lds
M v[32:35], v[100:103], a[244:247], v[32:35]
ds_read_b64_tr_b16 v[160:161], v16 offset:16384
ds_read_b64_tr_b16 v[162:163], v16 offset:20480
M v[36:39], v[108:111], a[244:247], v[36:39]
buffer_load_dwordx4 v3, s[48:51], s26 offen offset:1024 lds
M v[36:39], v[104:107], a[240:243], v[36:39]
ds_read_b64_tr_b16 v[164:165], v16 offset:24576
ds_read_b64_tr_b16 v[166:167], v16 offset:28672
M v[40:43], v[112:115], a[240:243], v[40:43]
buffer_load_dwordx4 v4, s[48:51], s26 offen offset:2048 lds
M v[40:43], v[116:119], a[244:247], v[40:43]
ds_read_b64_tr_b16 v[168:169], v17 offset:16384
ds_read_b64_tr_b16 v[170:171], v17 offset:20480
M v[44:47], v[124:127], a[244:247], v[44:47]
buffer_load_dwordx4 v5, s[48:51], s26 offen offset:3072 lds
M v[44:47], v[120:123], a[240:243], v[44:47]
M v[48:51], v[128:131], a[240:243], v[48:51]
ds_read_b64_tr_b16 v[172:173], v17 offset:24576
ds_read_b64_tr_b16 v[174:175], v17 offset:28672
M v[48:51], v[132:135], a[244:247], v[48:51]
buffer_load_dwordx4 a[192:195], v1, s[44:47], s25 offen offset:0 sc1
M v[52:55], v[140:143], a[244:247], v[52:55]
ds_read_b64_tr_b16 v[176:177], v18 offset:16384
ds_read_b64_tr_b16 v[178:179], v18 offset:20480
M v[52:55], v[136:139], a[240:243], v[52:55]
buffer_load_dwordx4 a[196:199], v1, s[44:47], s25 offen offset:1024 sc1
M v[56:59], v[144:147], a[240:243], v[56:59]
ds_read_b64_tr_b16 v[180:181], v18 offset:24576
ds_read_b64_tr_b16 v[182:183], v18 offset:28672
M v[56:59], v[148:151], a[244:247], v[56:59]
buffer_load_dwordx4 a[200:203], v1, s[44:47], s25 offen offset:2048 sc1
M v[60:63], v[156:159], a[244:247], v[60:63]
M v[60:63], v[152:155], a[240:243], v[60:63]
ds_read_b64_tr_b16 v[184:185], v19 offset:16384
ds_read_b64_tr_b16 v[186:187], v19 offset:20480
M v[64:67], v[96:99], a[248:251], v[64:67]
buffer_load_dwordx4 a[204:207], v1, s[44:47], s25 offen offset:3072 sc1
M v[64:67], v[100:103], a[252:255], v[64:67]
ds_read_b64_tr_b16 v[188:189], v19 offset:24576
ds_read_b64_tr_b16 v[190:191], v19 offset:28672
M v[68:71], v[108:111], a[252:255], v[68:71]
s_sub_u32 s39, s39, 1
s_cmp_eq_u32 s39, 0
s_cselect_b32 s3, s64, s65
M v[68:71], v[104:107], a[248:251], v[68:71]
ds_read_b64_tr_b16 v[192:193], v20 offset:16384
ds_read_b64_tr_b16 v[194:195], v20 offset:20480
M v[72:75], v[112:115], a[248:251], v[72:75]
s_add_u32 s25, s25, s3
s_lshl_b32 s3, s3, 3
s_add_u32 s26, s26, s3
M v[72:75], v[116:119], a[252:255], v[72:75]
ds_read_b64_tr_b16 v[196:197], v20 offset:24576
ds_read_b64_tr_b16 v[198:199], v20 offset:28672
M v[76:79], v[124:127], a[252:255], v[76:79]
M v[76:79], v[120:123], a[248:251], v[76:79]
ds_read_b64_tr_b16 v[200:201], v21 offset:16384
ds_read_b64_tr_b16 v[202:203], v21 offset:20480
M v[80:83], v[128:131], a[248:251], v[80:83]
ds_read_b64_tr_b16 v[204:205], v21 offset:24576
ds_read_b64_tr_b16 v[206:207], v21 offset:28672
M v[80:83], v[132:135], a[252:255], v[80:83]
ds_read_b64_tr_b16 v[208:209], v22 offset:16384
ds_read_b64_tr_b16 v[210:211], v22 offset:20480
M v[84:87], v[140:143], a[252:255], v[84:87]
ds_read_b64_tr_b16 v[212:213], v22 offset:24576
ds_read_b64_tr_b16 v[214:215], v22 offset:28672
M v[84:87], v[136:139], a[248:251], v[84:87]
ds_read_b64_tr_b16 v[216:217], v23 offset:16384
ds_read_b64_tr_b16 v[218:219], v23 offset:20480
M v[88:91], v[144:147], a[248:251], v[88:91]
ds_read_b64_tr_b16 v[220:221], v23 offset:24576
ds_read_b64_tr_b16 v[222:223], v23 offset:28672
M v[88:91], v[148:151], a[252:255], v[88:91]
M v[92:95], v[156:159], a[252:255], v[92:95]
M v[92:95], v[152:155], a[248:251], v[92:95]
s_waitcnt vmcnt(24) lgkmcnt(0)
s_barrier
M v[32:35], v[160:163], a[128:131], v[32:35]
s_add_u32 m0, s41, 32768
s_nop 0
buffer_load_dwordx4 v2, s[48:51], s26 offen offset:0 lds
M v[32:35], v[164:167], a[132:135], v[32:35]
ds_read_b64_tr_b16 v[96:97], v16 offset:32768
ds_read_b64_tr_b16 v[98:99], v16 offset:36864
M v[36:39], v[172:175], a[132:135], v[36:39]
buffer_load_dwordx4 v3, s[48:51], s26 offen offset:1024 lds
M v[36:39], v[168:171], a[128:131], v[36:39]
ds_read_b64_tr_b16 v[100:101], v16 offset:40960
ds_read_b64_tr_b16 v[102:103], v16 offset:45056
M v[40:43], v[176:179], a[128:131], v[40:43]
buffer_load_dwordx4 v4, s[48:51], s26 offen offset:2048 lds
M v[40:43], v[180:183], a[132:135], v[40:43]
ds_read_b64_tr_b16 v[104:105], v17 offset:32768
ds_read_b64_tr_b16 v[106:107], v17 offset:36864
M v[44:47], v[188:191], a[132:135], v[44:47]
buffer_load_dwordx4 v5, s[48:51], s26 offen offset:3072 lds
M v[44:47], v[184:187], a[128:131], v[44:47]
M v[48:51], v[192:195], a[128:131], v[48:51]
ds_read_b64_tr_b16 v[108:109], v17 offset:40960
ds_read_b64_tr_b16 v[110:111], v17 offset:45056
M v[48:51], v[196:199], a[132:135], v[48:51]
buffer_load_dwordx4 a[208:211], v1, s[44:47], s25 offen offset:0 sc1
M v[52:55], v[204:207], a[132:135], v[52:55]
ds_read_b64_tr_b16 v[112:113], v18 offset:32768
ds_read_b64_tr_b16 v[114:115], v18 offset:36864
M v[52:55], v[200:203], a[128:131], v[52:55]
buffer_load_dwordx4 a[212:215], v1, s[44:47], s25 offen offset:1024 sc1
M v[56:59], v[208:211], a[128:131], v[56:59]
ds_read_b64_tr_b16 v[116:117], v18 offset:40960
ds_read_b64_tr_b16 v[118:119], v18 offset:45056
M v[56:59], v[212:215], a[132:135], v[56:59]
buffer_load_dwordx4 a[216:219], v1, s[44:47], s25 offen offset:2048 sc1
M v[60:63], v[220:223], a[132:135], v[60:63]
M v[60:63], v[216:219], a[128:131], v[60:63]
ds_read_b64_tr_b16 v[120:121], v19 offset:32768
ds_read_b64_tr_b16 v[122:123], v19 offset:36864
M v[64:67], v[160:163], a[136:139], v[64:67]
buffer_load_dwordx4 a[220:223], v1, s[44:47], s25 offen offset:3072 sc1
M v[64:67], v[164:167], a[140:143], v[64:67]
ds_read_b64_tr_b16 v[124:125], v19 offset:40960
ds_read_b64_tr_b16 v[126:127], v19 offset:45056
M v[68:71], v[172:175], a[140:143], v[68:71]
s_sub_u32 s39, s39, 1
s_cmp_eq_u32 s39, 0
s_cselect_b32 s3, s64, s65
M v[68:71], v[168:171], a[136:139], v[68:71]
ds_read_b64_tr_b16 v[128:129], v20 offset:32768
ds_read_b64_tr_b16 v[130:131], v20 offset:36864
M v[72:75], v[176:179], a[136:139], v[72:75]
s_add_u32 s25, s25, s3
s_lshl_b32 s3, s3, 3
s_add_u32 s26, s26, s3
M v[72:75], v[180:183], a[140:143], v[72:75]
ds_read_b64_tr_b16 v[132:133], v20 offset:40960
ds_read_b64_tr_b16 v[134:135], v20 offset:45056
M v[76:79], v[188:191], a[140:143], v[76:79]
M v[76:79], v[184:187], a[136:139], v[76:79]
ds_read_b64_tr_b16 v[136:137], v21 offset:32768
ds_read_b64_tr_b16 v[138:139], v21 offset:36864
M v[80:83], v[192:195], a[136:139], v[80:83]
ds_read_b64_tr_b16 v[140:141], v21 offset:40960
ds_read_b64_tr_b16 v[142:143], v21 offset:45056
M v[80:83], v[196:199], a[140:143], v[80:83]
ds_read_b64_tr_b16 v[144:145], v22 offset:32768
ds_read_b64_tr_b16 v[146:147], v22 offset:36864
M v[84:87], v[204:207], a[140:143], v[84:87]
ds_read_b64_tr_b16 v[148:149], v22 offset:40960
ds_read_b64_tr_b16 v[150:151], v22 offset:45056
M v[84:87], v[200:203], a[136:139], v[84:87]
ds_read_b64_tr_b16 v[152:153], v23 offset:32768
ds_read_b64_tr_b16 v[154:155], v23 offset:36864
M v[88:91], v[208:211], a[136:139], v[88:91]
ds_read_b64_tr_b16 v[156:157], v23 offset:40960
ds_read_b64_tr_b16 v[158:159], v23 offset:45056
M v[88:91], v[212:215], a[140:143], v[88:91]
M v[92:95], v[220:223], a[140:143], v[92:95]
M v[92:95], v[216:219], a[136:139], v[92:95]
s_waitcnt vmcnt(24) lgkmcnt(0)
s_barrier
M v[32:35], v[96:99], a[144:147], v[32:35]
s_add_u32 m0, s41, 49152
s_nop 0
buffer_load_dwordx4 v2, s[48:51], s26 offen offset:0 lds
M v[32:35], v[100:103], a[148:151], v[32:35]
ds_read_b64_tr_b16 v[160:161], v16 offset:49152
ds_read_b64_tr_b16 v[162:163], v16 offset:53248
M v[36:39], v[108:111], a[148:151], v[36:39]
buffer_load_dwordx4 v3, s[48:51], s26 offen offset:1024 lds
M v[36:39], v[104:107], a[144:147], v[36:39]
ds_read_b64_tr_b16 v[164:165], v16 offset:57344
ds_read_b64_tr_b16 v[166:167], v16 offset:61440
M v[40:43], v[112:115], a[144:147], v[40:43]
buffer_load_dwordx4 v4, s[48:51], s26 offen offset:2048 lds
M v[40:43], v[116:119], a[148:151], v[40:43]
ds_read_b64_tr_b16 v[168:169], v17 offset:49152
ds_read_b64_tr_b16 v[170:171], v17 offset:53248
M v[44:47], v[124:127], a[148:151], v[44:47]
buffer_load_dwordx4 v5, s[48:51], s26 offen offset:3072 lds
M v[44:47], v[120:123], a[144:147], v[44:47]
M v[48:51], v[128:131], a[144:147], v[48:51]
ds_read_b64_tr_b16 v[172:173], v17 offset:57344
ds_read_b64_tr_b16 v[174:175], v17 offset:61440
M v[48:51], v[132:135], a[148:151], v[48:51]
buffer_load_dwordx4 a[224:227], v1, s[44:47], s25 offen offset:0 sc1
M v[52:55], v[140:143], a[148:151], v[52:55]
ds_read_b64_tr_b16 v[176:177], v18 offset:49152
ds_read_b64_tr_b16 v[178:179], v18 offset:53248
M v[52:55], v[136:139], a[144:147], v[52:55]
buffer_load_dwordx4 a[228:231], v1, s[44:47], s25 offen offset:1024 sc1
M v[56:59], v[144:147], a[144:147], v[56:59]
ds_read_b64_tr_b16 v[180:181], v18 offset:57344
ds_read_b64_tr_b16 v[182:183], v18 offset:61440
M v[56:59], v[148:151], a[148:151], v[56:59]
buffer_load_dwordx4 a[232:235], v1, s[44:47], s25 offen offset:2048 sc1
M v[60:63], v[156:159], a[148:151], v[60:63]
M v[60:63], v[152:155], a[144:147], v[60:63]
ds_read_b64_tr_b16 v[184:185], v19 offset:49152
ds_read_b64_tr_b16 v[186:187], v19 offset:53248
M v[64:67], v[96:99], a[152:155], v[64:67]
buffer_load_dwordx4 a[236:239], v1, s[44:47], s25 offen offset:3072 sc1
M v[64:67], v[100:103], a[156:159], v[64:67]
ds_read_b64_tr_b16 v[188:189], v19 offset:57344
ds_read_b64_tr_b16 v[190:191], v19 offset:61440
M v[68:71], v[108:111], a[156:159], v[68:71]
s_sub_u32 s39, s39, 1
s_cmp_eq_u32 s39, 0
s_cselect_b32 s3, s64, s65
M v[68:71], v[104:107], a[152:155], v[68:71]
ds_read_b64_tr_b16 v[192:193], v20 offset:49152
ds_read_b64_tr_b16 v[194:195], v20 offset:53248
M v[72:75], v[112:115], a[152:155], v[72:75]
s_add_u32 s25, s25, s3
s_lshl_b32 s3, s3, 3
s_add_u32 s26, s26, s3
M v[72:75], v[116:119], a[156:159], v[72:75]
ds_read_b64_tr_b16 v[196:197], v20 offset:57344
ds_read_b64_tr_b16 v[198:199], v20 offset:61440
M v[76:79], v[124:127], a[156:159], v[76:79]
M v[76:79], v[120:123], a[152:155], v[76:79]
ds_read_b64_tr_b16 v[200:201], v21 offset:49152
ds_read_b64_tr_b16 v[202:203], v21 offset:53248
M v[80:83], v[128:131], a[152:155], v[80:83]
ds_read_b64_tr_b16 v[204:205], v21 offset:57344
ds_read_b64_tr_b16 v[206:207], v21 offset:61440
M v[80:83], v[132:135], a[156:159], v[80:83]
ds_read_b64_tr_b16 v[208:209], v22 offset:49152
ds_read_b64_tr_b16 v[210:211], v22 offset:53248
M v[84:87], v[140:143], a[156:159], v[84:87]
ds_read_b64_tr_b16 v[212:213], v22 offset:57344
ds_read_b64_tr_b16 v[214:215], v22 offset:61440
M v[84:87], v[136:139], a[152:155], v[84:87]
ds_read_b64_tr_b16 v[216:217], v23 offset:49152
ds_read_b64_tr_b16 v[218:219], v23 offset:53248
M v[88:91], v[144:147], a[152:155], v[88:91]
ds_read_b64_tr_b16 v[220:221], v23 offset:57344
ds_read_b64_tr_b16 v[222:223], v23 offset:61440
M v[88:91], v[148:151], a[156:159], v[88:91]
M v[92:95], v[156:159], a[156:159], v[92:95]
M v[92:95], v[152:155], a[152:155], v[92:95]
s_waitcnt vmcnt(24) lgkmcnt(0)
s_barrier
M v[32:35], v[160:163], a[160:163], v[32:35]
s_add_u32 m0, s41, 65536
s_nop 0
buffer_load_dwordx4 v2, s[48:51], s26 offen offset:0 lds
M v[32:35], v[164:167], a[164:167], v[32:35]
ds_read_b64_tr_b16 v[96:97], v8 offset:0
ds_read_b64_tr_b16 v[98:99], v8 offset:4096
M v[36:39], v[172:175], a[164:167], v[36:39]
buffer_load_dwordx4 v3, s[48:51], s26 offen offset:1024 lds
M v[36:39], v[168:171], a[160:163], v[36:39]
ds_read_b64_tr_b16 v[100:101], v8 offset:8192
ds_read_b64_tr_b16 v[102:103], v8 offset:12288
M v[40:43], v[176:179], a[160:163], v[40:43]
buffer_load_dwordx4 v4, s[48:51], s26 offen offset:2048 lds
M v[40:43], v[180:183], a[164:167], v[40:43]
ds_read_b64_tr_b16 v[104:105], v9 offset:0
ds_read_b64_tr_b16 v[106:107], v9 offset:4096
M v[44:47], v[188:191], a[164:167], v[44:47]
buffer_load_dwordx4 v5, s[48:51], s26 offen offset:3072 lds
M v[44:47], v[184:187], a[160:163], v[44:47]
M v[48:51], v[192:195], a[160:163], v[48:51]
ds_read_b64_tr_b16 v[108:109], v9 offset:8192
ds_read_b64_tr_b16 v[110:111], v9 offset:12288
M v[48:51], v[196:199], a[164:167], v[48:51]
buffer_load_dwordx4 a[240:243], v1, s[44:47], s25 offen offset:0 sc1
M v[52:55], v[204:207], a[164:167], v[52:55]
ds_read_b64_tr_b16 v[112:113], v10 offset:0
ds_read_b64_tr_b16 v[114:115], v10 offset:4096
M v[52:55], v[200:203], a[160:163], v[52:55]
buffer_load_dwordx4 a[244:247], v1, s[44:47], s25 offen offset:1024 sc1
M v[56:59], v[208:211], a[160:163], v[56:59]
ds_read_b64_tr_b16 v[116:117], v10 offset:8192
ds_read_b64_tr_b16 v[118:119], v10 offset:12288
M v[56:59], v[212:215], a[164:167], v[56:59]
buffer_load_dwordx4 a[248:251], v1, s[44:47], s25 offen offset:2048 sc1
M v[60:63], v[220:223], a[164:167], v[60:63]
M v[60:63], v[216:219], a[160:163], v[60:63]
ds_read_b64_tr_b16 v[120:121], v11 offset:0
ds_read_b64_tr_b16 v[122:123], v11 offset:4096
M v[64:67], v[160:163], a[168:171], v[64:67]
buffer_load_dwordx4 a[252:255], v1, s[44:47], s25 offen offset:3072 sc1
M v[64:67], v[164:167], a[172:175], v[64:67]
ds_read_b64_tr_b16 v[124:125], v11 offset:8192
ds_read_b64_tr_b16 v[126:127], v11 offset:12288
M v[68:71], v[172:175], a[172:175], v[68:71]
s_sub_u32 s39, s39, 1
s_cmp_eq_u32 s39, 0
s_cselect_b32 s3, s64, s65
M v[68:71], v[168:171], a[168:171], v[68:71]
ds_read_b64_tr_b16 v[128:129], v12 offset:0
ds_read_b64_tr_b16 v[130:131], v12 offset:4096
M v[72:75], v[176:179], a[168:171], v[72:75]
s_add_u32 s25, s25, s3
s_lshl_b32 s3, s3, 3
s_add_u32 s26, s26, s3
M v[72:75], v[180:183], a[172:175], v[72:75]
ds_read_b64_tr_b16 v[132:133], v12 offset:8192
ds_read_b64_tr_b16 v[134:135], v12 offset:12288
M v[76:79], v[188:191], a[172:175], v[76:79]
M v[76:79], v[184:187], a[168:171], v[76:79]
ds_read_b64_tr_b16 v[136:137], v13 offset:0
ds_read_b64_tr_b16 v[138:139], v13 offset:4096
M v[80:83], v[192:195], a[168:171], v[80:83]
ds_read_b64_tr_b16 v[140:141], v13 offset:8192
ds_read_b64_tr_b16 v[142:143], v13 offset:12288
M v[80:83], v[196:199], a[172:175], v[80:83]
ds_read_b64_tr_b16 v[144:145], v14 offset:0
ds_read_b64_tr_b16 v[146:147], v14 offset:4096
M v[84:87], v[204:207], a[172:175], v[84:87]
ds_read_b64_tr_b16 v[148:149], v14 offset:8192
ds_read_b64_tr_b16 v[150:151], v14 offset:12288
M v[84:87], v[200:203], a[168:171], v[84:87]
ds_read_b64_tr_b16 v[152:153], v15 offset:0
ds_read_b64_tr_b16 v[154:155], v15 offset:4096
M v[88:91], v[208:211], a[168:171], v[88:91]
ds_read_b64_tr_b16 v[156:157], v15 offset:8192
ds_read_b64_tr_b16 v[158:159], v15 offset:12288
M v[88:91], v[212:215], a[172:175], v[88:91]
M v[92:95], v[220:223], a[172:175], v[92:95]
M v[92:95], v[216:219], a[168:171], v[92:95]
s_waitcnt vmcnt(24) lgkmcnt(0)
s_barrier
M v[32:35], v[96:99], a[176:179], v[32:35]
s_add_u32 m0, s41, 81920
s_nop 0
buffer_load_dwordx4 v2, s[48:51], s26 offen offset:0 lds
M v[32:35], v[100:103], a[180:183], v[32:35]
ds_read_b64_tr_b16 v[160:161], v8 offset:16384
ds_read_b64_tr_b16 v[162:163], v8 offset:20480
M v[36:39], v[108:111], a[180:183], v[36:39]
buffer_load_dwordx4 v3, s[48:51], s26 offen offset:1024 lds
M v[36:39], v[104:107], a[176:179], v[36:39]
ds_read_b64_tr_b16 v[164:165], v8 offset:24576
ds_read_b64_tr_b16 v[166:167], v8 offset:28672
M v[40:43], v[112:115], a[176:179], v[40:43]
buffer_load_dwordx4 v4, s[48:51], s26 offen offset:2048 lds
M v[40:43], v[116:119], a[180:183], v[40:43]
ds_read_b64_tr_b16 v[168:169], v9 offset:16384
ds_read_b64_tr_b16 v[170:171], v9 offset:20480
M v[44:47], v[124:127], a[180:183], v[44:47]
buffer_load_dwordx4 v5, s[48:51], s26 offen offset:3072 lds
M v[44:47], v[120:123], a[176:179], v[44:47]
M v[48:51], v[128:131], a[176:179], v[48:51]
ds_read_b64_tr_b16 v[172:173], v9 offset:24576
ds_read_b64_tr_b16 v[174:175], v9 offset:28672
M v[48:51], v[132:135], a[180:183], v[48:51]
buffer_load_dwordx4 a[128:131], v1, s[44:47], s25 offen offset:0 sc1
M v[52:55], v[140:143], a[180:183], v[52:55]
ds_read_b64_tr_b16 v[176:177], v10 offset:16384
ds_read_b64_tr_b16 v[178:179], v10 offset:20480
M v[52:55], v[136:139], a[176:179], v[52:55]
buffer_load_dwordx4 a[132:135], v1, s[44:47], s25 offen offset:1024 sc1
M v[56:59], v[144:147], a[176:179], v[56:59]
ds_read_b64_tr_b16 v[180:181], v10 offset:24576
ds_read_b64_tr_b16 v[182:183], v10 offset:28672
M v[56:59], v[148:151], a[180:183], v[56:59]
buffer_load_dwordx4 a[136:139], v1, s[44:47], s25 offen offset:2048 sc1
M v[60:63], v[156:159], a[180:183], v[60:63]
M v[60:63], v[152:155], a[176:179], v[60:63]
ds_read_b64_tr_b16 v[184:185], v11 offset:16384
ds_read_b64_tr_b16 v[186:187], v11 offset:20480
M v[64:67], v[96:99], a[184:187], v[64:67]
buffer_load_dwordx4 a[140:143], v1, s[44:47], s25 offen offset:3072 sc1
M v[64:67], v[100:103], a[188:191], v[64:67]
ds_read_b64_tr_b16 v[188:189], v11 offset:24576
ds_read_b64_tr_b16 v[190:191], v11 offset:28672
M v[68:71], v[108:111], a[188:191], v[68:71]
s_sub_u32 s39, s39, 1
s_cmp_eq_u32 s39, 0
s_cselect_b32 s3, s64, s65
M v[68:71], v[104:107], a[184:187], v[68:71]
ds_read_b64_tr_b16 v[192:193], v12 offset:16384
ds_read_b64_tr_b16 v[194:195], v12 offset:20480
M v[72:75], v[112:115], a[184:187], v[72:75]
s_add_u32 s25, s25, s3
s_lshl_b32 s3, s3, 3
s_add_u32 s26, s26, s3
M v[72:75], v[116:119], a[188:191], v[72:75]
ds_read_b64_tr_b16 v[196:197], v12 offset:24576
ds_read_b64_tr_b16 v[198:199], v12 offset:28672
M v[76:79], v[124:127], a[188:191], v[76:79]
M v[76:79], v[120:123], a[184:187], v[76:79]
ds_read_b64_tr_b16 v[200:201], v13 offset:16384
ds_read_b64_tr_b16 v[202:203], v13 offset:20480
M v[80:83], v[128:131], a[184:187], v[80:83]
ds_read_b64_tr_b16 v[204:205], v13 offset:24576
ds_read_b64_tr_b16 v[206:207], v13 offset:28672
M v[80:83], v[132:135], a[188:191], v[80:83]
ds_read_b64_tr_b16 v[208:209], v14 offset:16384
ds_read_b64_tr_b16 v[210:211], v14 offset:20480
M v[84:87], v[140:143], a[188:191], v[84:87]
ds_read_b64_tr_b16 v[212:213], v14 offset:24576
ds_read_b64_tr_b16 v[214:215], v14 offset:28672
M v[84:87], v[136:139], a[184:187], v[84:87]
ds_read_b64_tr_b16 v[216:217], v15 offset:16384
ds_read_b64_tr_b16 v[218:219], v15 offset:20480
M v[88:91], v[144:147], a[184:187], v[88:91]
ds_read_b64_tr_b16 v[220:221], v15 offset:24576
ds_read_b64_tr_b16 v[222:223], v15 offset:28672
M v[88:91], v[148:151], a[188:191], v[88:91]
M v[92:95], v[156:159], a[188:191], v[92:95]
M v[92:95], v[152:155], a[184:187], v[92:95]
s_waitcnt vmcnt(24) lgkmcnt(0)
s_barrier
M v[32:35], v[160:163], a[192:195], v[32:35]
s_add_u32 m0, s41, 98304
s_nop 0
buffer_load_dwordx4 v2, s[48:51], s26 offen offset:0 lds
M v[32:35], v[164:167], a[196:199], v[32:35]
ds_read_b64_tr_b16 v[96:97], v8 offset:32768
ds_read_b64_tr_b16 v[98:99], v8 offset:36864
M v[36:39], v[172:175], a[196:199], v[36:39]
buffer_load_dwordx4 v3, s[48:51], s26 offen offset:1024 lds
M v[36:39], v[168:171], a[192:195], v[36:39]
ds_read_b64_tr_b16 v[100:101], v8 offset:40960
ds_read_b64_tr_b16 v[102:103], v8 offset:45056
M v[40:43], v[176:179], a[192:195], v[40:43]
buffer_load_dwordx4 v4, s[48:51], s26 offen offset:2048 lds
M v[40:43], v[180:183], a[196:199], v[40:43]
ds_read_b64_tr_b16 v[104:105], v9 offset:32768
ds_read_b64_tr_b16 v[106:107], v9 offset:36864
M v[44:47], v[188:191], a[196:199], v[44:47]
buffer_load_dwordx4 v5, s[48:51], s26 offen offset:3072 lds
M v[44:47], v[184:187], a[192:195], v[44:47]
M v[48:51], v[192:195], a[192:195], v[48:51]
ds_read_b64_tr_b16 v[108:109], v9 offset:40960
ds_read_b64_tr_b16 v[110:111], v9 offset:45056
M v[48:51], v[196:199], a[196:199], v[48:51]
buffer_load_dwordx4 a[144:147], v1, s[44:47], s25 offen offset:0 sc1
M v[52:55], v[204:207], a[196:199], v[52:55]
ds_read_b64_tr_b16 v[112:113], v10 offset:32768
ds_read_b64_tr_b16 v[114:115], v10 offset:36864
M v[52:55], v[200:203], a[192:195], v[52:55]
buffer_load_dwordx4 a[148:151], v1, s[44:47], s25 offen offset:1024 sc1
M v[56:59], v[208:211], a[192:195], v[56:59]
ds_read_b64_tr_b16 v[116:117], v10 offset:40960
ds_read_b64_tr_b16 v[118:119], v10 offset:45056
M v[56:59], v[212:215], a[196:199], v[56:59]
buffer_load_dwordx4 a[152:155], v1, s[44:47], s25 offen offset:2048 sc1
M v[60:63], v[220:223], a[196:199], v[60:63]
M v[60:63], v[216:219], a[192:195], v[60:63]
ds_read_b64_tr_b16 v[120:121], v11 offset:32768
ds_read_b64_tr_b16 v[122:123], v11 offset:36864
M v[64:67], v[160:163], a[200:203], v[64:67]
buffer_load_dwordx4 a[156:159], v1, s[44:47], s25 offen offset:3072 sc1
M v[64:67], v[164:167], a[204:207], v[64:67]
ds_read_b64_tr_b16 v[124:125], v11 offset:40960
ds_read_b64_tr_b16 v[126:127], v11 offset:45056
M v[68:71], v[172:175], a[204:207], v[68:71]
s_sub_u32 s39, s39, 1
s_cmp_eq_u32 s39, 0
s_cselect_b32 s3, s64, s65
M v[68:71], v[168:171], a[200:203], v[68:71]
ds_read_b64_tr_b16 v[128:129], v12 offset:32768
ds_read_b64_tr_b16 v[130:131], v12 offset:36864
M v[72:75], v[176:179], a[200:203], v[72:75]
s_add_u32 s25, s25, s3
s_lshl_b32 s3, s3, 3
s_add_u32 s26, s26, s3
M v[72:75], v[180:183], a[204:207], v[72:75]
ds_read_b64_tr_b16 v[132:133], v12 offset:40960
ds_read_b64_tr_b16 v[134:135], v12 offset:45056
M v[76:79], v[188:191], a[204:207], v[76:79]
M v[76:79], v[184:187], a[200:203], v[76:79]
ds_read_b64_tr_b16 v[136:137], v13 offset:32768
ds_read_b64_tr_b16 v[138:139], v13 offset:36864
M v[80:83], v[192:195], a[200:203], v[80:83]
ds_read_b64_tr_b16 v[140:141], v13 offset:40960
ds_read_b64_tr_b16 v[142:143], v13 offset:45056
M v[80:83], v[196:199], a[204:207], v[80:83]
ds_read_b64_tr_b16 v[144:145], v14 offset:32768
ds_read_b64_tr_b16 v[146:147], v14 offset:36864
M v[84:87], v[204:207], a[204:207], v[84:87]
ds_read_b64_tr_b16 v[148:149], v14 offset:40960
ds_read_b64_tr_b16 v[150:151], v14 offset:45056
M v[84:87], v[200:203], a[200:203], v[84:87]
ds_read_b64_tr_b16 v[152:153], v15 offset:32768
ds_read_b64_tr_b16 v[154:155], v15 offset:36864
M v[88:91], v[208:211], a[200:203], v[88:91]
ds_read_b64_tr_b16 v[156:157], v15 offset:40960
ds_read_b64_tr_b16 v[158:159], v15 offset:45056
M v[88:91], v[212:215], a[204:207], v[88:91]
M v[92:95], v[220:223], a[204:207], v[92:95]
M v[92:95], v[216:219], a[200:203], v[92:95]
s_sub_u32 s28, s28, 1
s_cmp_lg_u32 s28, 0
s_cbranch_scc1 Lk3_la
s_waitcnt vmcnt(24) lgkmcnt(0)
s_barrier
M v[32:35], v[96:99], a[208:211], v[32:35]
s_add_u32 m0, s41, 114688
s_nop 0
buffer_load_dwordx4 v2, s[48:51], s26 offen offset:0 lds
M v[32:35], v[100:103], a[212:215], v[32:35]
ds_read_b64_tr_b16 v[160:161], v8 offset:49152
ds_read_b64_tr_b16 v[162:163], v8 offset:53248
M v[36:39], v[108:111], a[212:215], v[36:39]
buffer_load_dwordx4 v3, s[48:51], s26 offen offset:1024 lds
M v[36:39], v[104:107], a[208:211], v[36:39]
ds_read_b64_tr_b16 v[164:165], v8 offset:57344
ds_read_b64_tr_b16 v[166:167], v8 offset:61440
M v[40:43], v[112:115], a[208:211], v[40:43]
buffer_load_dwordx4 v4, s[48:51], s26 offen offset:2048 lds
M v[40:43], v[116:119], a[212:215], v[40:43]
ds_read_b64_tr_b16 v[168:169], v9 offset:49152
ds_read_b64_tr_b16 v[170:171], v9 offset:53248
M v[44:47], v[124:127], a[212:215], v[44:47]
buffer_load_dwordx4 v5, s[48:51], s26 offen offset:3072 lds
M v[44:47], v[120:123], a[208:211], v[44:47]
M v[48:51], v[128:131], a[208:211], v[48:51]
ds_read_b64_tr_b16 v[172:173], v9 offset:57344
ds_read_b64_tr_b16 v[174:175], v9 offset:61440
M v[48:51], v[132:135], a[212:215], v[48:51]
buffer_load_dwordx4 a[160:163], v1, s[44:47], s25 offen offset:0 sc1
M v[52:55], v[140:143], a[212:215], v[52:55]
ds_read_b64_tr_b16 v[176:177], v10 offset:49152
ds_read_b64_tr_b16 v[178:179], v10 offset:53248
M v[52:55], v[136:139], a[208:211], v[52:55]
buffer_load_dwordx4 a[164:167], v1, s[44:47], s25 offen offset:1024 sc1
M v[56:59], v[144:147], a[208:211], v[56:59]
ds_read_b64_tr_b16 v[180:181], v10 offset:57344
ds_read_b64_tr_b16 v[182:183], v10 offset:61440
M v[56:59], v[148:151], a[212:215], v[56:59]
buffer_load_dwordx4 a[168:171], v1, s[44:47], s25 offen offset:2048 sc1
M v[60:63], v[156:159], a[212:215], v[60:63]
M v[60:63], v[152:155], a[208:211], v[60:63]
ds_read_b64_tr_b16 v[184:185], v11 offset:49152
ds_read_b64_tr_b16 v[186:187], v11 offset:53248
M v[64:67], v[96:99], a[216:219], v[64:67]
buffer_load_dwordx4 a[172:175], v1, s[44:47], s25 offen offset:3072 sc1
M v[64:67], v[100:103], a[220:223], v[64:67]
ds_read_b64_tr_b16 v[188:189], v11 offset:57344
ds_read_b64_tr_b16 v[190:191], v11 offset:61440
M v[68:71], v[108:111], a[220:223], v[68:71]
s_sub_u32 s39, s39, 1
s_cmp_eq_u32 s39, 0
s_cselect_b32 s3, s64, s65
M v[68:71], v[104:107], a[216:219], v[68:71]
ds_read_b64_tr_b16 v[192:193], v12 offset:49152
ds_read_b64_tr_b16 v[194:195], v12 offset:53248
M v[72:75], v[112:115], a[216:219], v[72:75]
s_add_u32 s25, s25, s3
s_lshl_b32 s3, s3, 3
s_add_u32 s26, s26, s3
M v[72:75], v[116:119], a[220:223], v[72:75]
ds_read_b64_tr_b16 v[196:197], v12 offset:57344
ds_read_b64_tr_b16 v[198:199], v12 offset:61440
M v[76:79], v[124:127], a[220:223], v[76:79]
M v[76:79], v[120:123], a[216:219], v[76:79]
ds_read_b64_tr_b16 v[200:201], v13 offset:49152
ds_read_b64_tr_b16 v[202:203], v13 offset:53248
M v[80:83], v[128:131], a[216:219], v[80:83]
ds_read_b64_tr_b16 v[204:205], v13 offset:57344
ds_read_b64_tr_b16 v[206:207], v13 offset:61440
M v[80:83], v[132:135], a[220:223], v[80:83]
ds_read_b64_tr_b16 v[208:209], v14 offset:49152
ds_read_b64_tr_b16 v[210:211], v14 offset:53248
M v[84:87], v[140:143], a[220:223], v[84:87]
ds_read_b64_tr_b16 v[212:213], v14 offset:57344
ds_read_b64_tr_b16 v[214:215], v14 offset:61440
M v[84:87], v[136:139], a[216:219], v[84:87]
ds_read_b64_tr_b16 v[216:217], v15 offset:49152
ds_read_b64_tr_b16 v[218:219], v15 offset:53248
M v[88:91], v[144:147], a[216:219], v[88:91]
ds_read_b64_tr_b16 v[220:221], v15 offset:57344
ds_read_b64_tr_b16 v[222:223], v15 offset:61440
M v[88:91], v[148:151], a[220:223], v[88:91]
M v[92:95], v[156:159], a[220:223], v[92:95]
M v[92:95], v[152:155], a[216:219], v[92:95]
s_waitcnt vmcnt(24) lgkmcnt(0)
s_barrier
M v[32:35], v[160:163], a[224:227], v[32:35]
s_add_u32 m0, s41, 0
s_nop 0
buffer_load_dwordx4 v2, s[48:51], s26 offen offset:0 lds
M v[32:35], v[164:167], a[228:231], v[32:35]
ds_read_b64_tr_b16 v[96:97], v16 offset:0
ds_read_b64_tr_b16 v[98:99], v16 offset:4096
M v[36:39], v[172:175], a[228:231], v[36:39]
buffer_load_dwordx4 v3, s[48:51], s26 offen offset:1024 lds
M v[36:39], v[168:171], a[224:227], v[36:39]
ds_read_b64_tr_b16 v[100:101], v16 offset:8192
ds_read_b64_tr_b16 v[102:103], v16 offset:12288
M v[40:43], v[176:179], a[224:227], v[40:43]
buffer_load_dwordx4 v4, s[48:51], s26 offen offset:2048 lds
M v[40:43], v[180:183], a[228:231], v[40:43]
ds_read_b64_tr_b16 v[104:105], v17 offset:0
ds_read_b64_tr_b16 v[106:107], v17 offset:4096
M v[44:47], v[188:191], a[228:231], v[44:47]
buffer_load_dwordx4 v5, s[48:51], s26 offen offset:3072 lds
M v[44:47], v[184:187], a[224:227], v[44:47]
M v[48:51], v[192:195], a[224:227], v[48:51]
ds_read_b64_tr_b16 v[108:109], v17 offset:8192
ds_read_b64_tr_b16 v[110:111], v17 offset:12288
M v[48:51], v[196:199], a[228:231], v[48:51]
buffer_load_dwordx4 a[176:179], v1, s[44:47], s25 offen offset:0 sc1
M v[52:55], v[204:207], a[228:231], v[52:55]
ds_read_b64_tr_b16 v[112:113], v18 offset:0
ds_read_b64_tr_b16 v[114:115], v18 offset:4096
M v[52:55], v[200:203], a[224:227], v[52:55]
buffer_load_dwordx4 a[180:183], v1, s[44:47], s25 offen offset:1024 sc1
M v[56:59], v[208:211], a[224:227], v[56:59]
ds_read_b64_tr_b16 v[116:117], v18 offset:8192
ds_read_b64_tr_b16 v[118:119], v18 offset:12288
M v[56:59], v[212:215], a[228:231], v[56:59]
buffer_load_dwordx4 a[184:187], v1, s[44:47], s25 offen offset:2048 sc1
M v[60:63], v[220:223], a[228:231], v[60:63]
M v[60:63], v[216:219], a[224:227], v[60:63]
ds_read_b64_tr_b16 v[120:121], v19 offset:0
ds_read_b64_tr_b16 v[122:123], v19 offset:4096
M v[64:67], v[160:163], a[232:235], v[64:67]
buffer_load_dwordx4 a[188:191], v1, s[44:47], s25 offen offset:3072 sc1
M v[64:67], v[164:167], a[236:239], v[64:67]
ds_read_b64_tr_b16 v[124:125], v19 offset:8192
ds_read_b64_tr_b16 v[126:127], v19 offset:12288
M v[68:71], v[172:175], a[236:239], v[68:71]
s_sub_u32 s39, s39, 1
s_cmp_eq_u32 s39, 0
s_cselect_b32 s3, s64, s65
M v[68:71], v[168:171], a[232:235], v[68:71]
ds_read_b64_tr_b16 v[128:129], v20 offset:0
ds_read_b64_tr_b16 v[130:131], v20 offset:4096
M v[72:75], v[176:179], a[232:235], v[72:75]
s_add_u32 s25, s25, s3
s_lshl_b32 s3, s3, 3
s_add_u32 s26, s26, s3
M v[72:75], v[180:183], a[236:239], v[72:75]
ds_read_b64_tr_b16 v[132:133], v20 offset:8192
ds_read_b64_tr_b16 v[134:135], v20 offset:12288
M v[76:79], v[188:191], a[236:239], v[76:79]
M v[76:79], v[184:187], a[232:235], v[76:79]
ds_read_b64_tr_b16 v[136:137], v21 offset:0
ds_read_b64_tr_b16 v[138:139], v21 offset:4096
M v[80:83], v[192:195], a[232:235], v[80:83]
ds_read_b64_tr_b16 v[140:141], v21 offset:8192
ds_read_b64_tr_b16 v[142:143], v21 offset:12288
M v[80:83], v[196:199], a[236:239], v[80:83]
ds_read_b64_tr_b16 v[144:145], v22 offset:0
ds_read_b64_tr_b16 v[146:147], v22 offset:4096
M v[84:87], v[204:207], a[236:239], v[84:87]
ds_read_b64_tr_b16 v[148:149], v22 offset:8192
ds_read_b64_tr_b16 v[150:151], v22 offset:12288
M v[84:87], v[200:203], a[232:235], v[84:87]
ds_read_b64_tr_b16 v[152:153], v23 offset:0
ds_read_b64_tr_b16 v[154:155], v23 offset:4096
M v[88:91], v[208:211], a[232:235], v[88:91]
ds_read_b64_tr_b16 v[156:157], v23 offset:8192
ds_read_b64_tr_b16 v[158:159], v23 offset:12288
M v[88:91], v[212:215], a[236:239], v[88:91]
M v[92:95], v[220:223], a[236:239], v[92:95]
M v[92:95], v[216:219], a[232:235], v[92:95]
s_waitcnt vmcnt(24) lgkmcnt(0)
s_barrier
M v[32:35], v[96:99], a[240:243], v[32:35]
s_mov_b64 s[44:45], s[34:35]
s_mov_b32 s46, 4194304
s_mov_b64 s[48:49], s[36:37]
s_mov_b32 s50, 2097152
s_mov_b32 s25, s32
s_mov_b32 s26, s33
s_add_u32 m0, s42, 16384
s_nop 0
buffer_load_dwordx4 v6, s[48:51], s26 offen offset:0 lds
M v[32:35], v[100:103], a[244:247], v[32:35]
ds_read_b64_tr_b16 v[160:161], v16 offset:16384
ds_read_b64_tr_b16 v[162:163], v16 offset:20480
M v[36:39], v[108:111], a[244:247], v[36:39]
buffer_load_dwordx4 v7, s[48:51], s26 offen offset:1024 lds
M v[36:39], v[104:107], a[240:243], v[36:39]
ds_read_b64_tr_b16 v[164:165], v16 offset:24576
ds_read_b64_tr_b16 v[166:167], v16 offset:28672
M v[40:43], v[112:115], a[240:243], v[40:43]
M v[40:43], v[116:119], a[244:247], v[40:43]
buffer_load_dwordx4 a[192:195], v1, s[44:47], s25 offen offset:0 sc1
M v[44:47], v[124:127], a[244:247], v[44:47]
ds_read_b64_tr_b16 v[168:169], v17 offset:16384
ds_read_b64_tr_b16 v[170:171], v17 offset:20480
M v[44:47], v[120:123], a[240:243], v[44:47]
buffer_load_dwordx4 a[196:199], v1, s[44:47], s25 offen offset:1024 sc1
M v[48:51], v[128:131], a[240:243], v[48:51]
M v[48:51], v[132:135], a[244:247], v[48:51]
ds_read_b64_tr_b16 v[172:173], v17 offset:24576
ds_read_b64_tr_b16 v[174:175], v17 offset:28672
M v[52:55], v[140:143], a[244:247], v[52:55]
buffer_load_dwordx4 a[200:203], v1, s[44:47], s25 offen offset:2048 sc1
M v[52:55], v[136:139], a[240:243], v[52:55]
ds_read_b64_tr_b16 v[176:177], v18 offset:16384
ds_read_b64_tr_b16 v[178:179], v18 offset:20480
M v[56:59], v[144:147], a[240:243], v[56:59]
M v[56:59], v[148:151], a[244:247], v[56:59]
buffer_load_dwordx4 a[204:207], v1, s[44:47], s25 offen offset:3072 sc1
M v[60:63], v[156:159], a[244:247], v[60:63]
ds_read_b64_tr_b16 v[180:181], v18 offset:24576
ds_read_b64_tr_b16 v[182:183], v18 offset:28672
M v[60:63], v[152:155], a[240:243], v[60:63]
s_add_u32 s25, s25, 16384
s_add_u32 s26, s26, 131072
M v[64:67], v[96:99], a[248:251], v[64:67]
ds_read_b64_tr_b16 v[184:185], v19 offset:16384
ds_read_b64_tr_b16 v[186:187], v19 offset:20480
M v[64:67], v[100:103], a[252:255], v[64:67]
M v[68:71], v[108:111], a[252:255], v[68:71]
ds_read_b64_tr_b16 v[188:189], v19 offset:24576
ds_read_b64_tr_b16 v[190:191], v19 offset:28672
M v[68:71], v[104:107], a[248:251], v[68:71]
ds_read_b64_tr_b16 v[192:193], v20 offset:16384
ds_read_b64_tr_b16 v[194:195], v20 offset:20480
M v[72:75], v[112:115], a[248:251], v[72:75]
ds_read_b64_tr_b16 v[196:197], v20 offset:24576
ds_read_b64_tr_b16 v[198:199], v20 offset:28672
M v[72:75], v[116:119], a[252:255], v[72:75]
M v[76:79], v[124:127], a[252:255], v[76:79]
ds_read_b64_tr_b16 v[200:201], v21 offset:16384
ds_read_b64_tr_b16 v[202:203], v21 offset:20480
M v[76:79], v[120:123], a[248:251], v[76:79]
ds_read_b64_tr_b16 v[204:205], v21 offset:24576
ds_read_b64_tr_b16 v[206:207], v21 offset:28672
M v[80:83], v[128:131], a[248:251], v[80:83]
ds_read_b64_tr_b16 v[208:209], v22 offset:16384
ds_read_b64_tr_b16 v[210:211], v22 offset:20480
M v[80:83], v[132:135], a[252:255], v[80:83]
M v[84:87], v[140:143], a[252:255], v[84:87]
ds_read_b64_tr_b16 v[212:213], v22 offset:24576
ds_read_b64_tr_b16 v[214:215], v22 offset:28672
M v[84:87], v[136:139], a[248:251], v[84:87]
ds_read_b64_tr_b16 v[216:217], v23 offset:16384
ds_read_b64_tr_b16 v[218:219], v23 offset:20480
M v[88:91], v[144:147], a[248:251], v[88:91]
ds_read_b64_tr_b16 v[220:221], v23 offset:24576
ds_read_b64_tr_b16 v[222:223], v23 offset:28672
M v[88:91], v[148:151], a[252:255], v[88:91]
M v[92:95], v[156:159], a[252:255], v[92:95]
M v[92:95], v[152:155], a[248:251], v[92:95]
s_waitcnt vmcnt(22) lgkmcnt(0)
s_barrier
M v[32:35], v[160:163], a[128:131], v[32:35]
s_add_u32 m0, s42, 32768
s_nop 0
buffer_load_dwordx4 v6, s[48:51], s26 offen offset:0 lds
M v[32:35], v[164:167], a[132:135], v[32:35]
ds_read_b64_tr_b16 v[96:97], v16 offset:32768
ds_read_b64_tr_b16 v[98:99], v16 offset:36864
M v[36:39], v[172:175], a[132:135], v[36:39]
buffer_load_dwordx4 v7, s[48:51], s26 offen offset:1024 lds
M v[36:39], v[168:171], a[128:131], v[36:39]
ds_read_b64_tr_b16 v[100:101], v16 offset:40960
ds_read_b64_tr_b16 v[102:103], v16 offset:45056
M v[40:43], v[176:179], a[128:131], v[40:43]
M v[40:43], v[180:183], a[132:135], v[40:43]
buffer_load_dwordx4 a[208:211], v1, s[44:47], s25 offen offset:0 sc1
M v[44:47], v[188:191], a[132:135], v[44:47]
ds_read_b64_tr_b16 v[104:105], v17 offset:32768
ds_read_b64_tr_b16 v[106:107], v17 offset:36864
M v[44:47], v[184:187], a[128:131], v[44:47]
buffer_load_dwordx4 a[212:215], v1, s[44:47], s25 offen offset:1024 sc1
M v[48:51], v[192:195], a[128:131], v[48:51]
M v[48:51], v[196:199], a[132:135], v[48:51]
ds_read_b64_tr_b16 v[108:109], v17 offset:40960
ds_read_b64_tr_b16 v[110:111], v17 offset:45056
M v[52:55], v[204:207], a[132:135], v[52:55]
buffer_load_dwordx4 a[216:219], v1, s[44:47], s25 offen offset:2048 sc1
M v[52:55], v[200:203], a[128:131], v[52:55]
ds_read_b64_tr_b16 v[112:113], v18 offset:32768
ds_read_b64_tr_b16 v[114:115], v18 offset:36864
M v[56:59], v[208:211], a[128:131], v[56:59]
M v[56:59], v[212:215], a[132:135], v[56:59]
buffer_load_dwordx4 a[220:223], v1, s[44:47], s25 offen offset:3072 sc1
M v[60:63], v[220:223], a[132:135], v[60:63]
ds_read_b64_tr_b16 v[116:117], v18 offset:40960
ds_read_b64_tr_b16 v[118:119], v18 offset:45056
M v[60:63], v[216:219], a[128:131], v[60:63]
s_add_u32 s25, s25, 16384
s_add_u32 s26, s26, 131072
M v[64:67], v[160:163], a[136:139], v[64:67]
ds_read_b64_tr_b16 v[120:121], v19 offset:32768
ds_read_b64_tr_b16 v[122:123], v19 offset:36864
M v[64:67], v[164:167], a[140:143], v[64:67]
M v[68:71], v[172:175], a[140:143], v[68:71]
ds_read_b64_tr_b16 v[124:125], v19 offset:40960
ds_read_b64_tr_b16 v[126:127], v19 offset:45056
M v[68:71], v[168:171], a[136:139], v[68:71]
ds_read_b64_tr_b16 v[128:129], v20 offset:32768
ds_read_b64_tr_b16 v[130:131], v20 offset:36864
M v[72:75], v[176:179], a[136:139], v[72:75]
ds_read_b64_tr_b16 v[132:133], v20 offset:40960
ds_read_b64_tr_b16 v[134:135], v20 offset:45056
M v[72:75], v[180:183], a[140:143], v[72:75]
M v[76:79], v[188:191], a[140:143], v[76:79]
ds_read_b64_tr_b16 v[136:137], v21 offset:32768
ds_read_b64_tr_b16 v[138:139], v21 offset:36864
M v[76:79], v[184:187], a[136:139], v[76:79]
ds_read_b64_tr_b16 v[140:141], v21 offset:40960
ds_read_b64_tr_b16 v[142:143], v21 offset:45056
M v[80:83], v[192:195], a[136:139], v[80:83]
ds_read_b64_tr_b16 v[144:145], v22 offset:32768
ds_read_b64_tr_b16 v[146:147], v22 offset:36864
M v[80:83], v[196:199], a[140:143], v[80:83]
M v[84:87], v[204:207], a[140:143], v[84:87]
ds_read_b64_tr_b16 v[148:149], v22 offset:40960
ds_read_b64_tr_b16 v[150:151], v22 offset:45056
M v[84:87], v[200:203], a[136:139], v[84:87]
ds_read_b64_tr_b16 v[152:153], v23 offset:32768
ds_read_b64_tr_b16 v[154:155], v23 offset:36864
M v[88:91], v[208:211], a[136:139], v[88:91]
ds_read_b64_tr_b16 v[156:157], v23 offset:40960
ds_read_b64_tr_b16 v[158:159], v23 offset:45056
M v[88:91], v[212:215], a[140:143], v[88:91]
M v[92:95], v[220:223], a[140:143], v[92:95]
M v[92:95], v[216:219], a[136:139], v[92:95]
s_waitcnt vmcnt(20) lgkmcnt(0)
s_barrier
M v[32:35], v[96:99], a[144:147], v[32:35]
s_add_u32 m0, s42, 49152
s_nop 0
buffer_load_dwordx4 v6, s[48:51], s26 offen offset:0 lds
M v[32:35], v[100:103], a[148:151], v[32:35]
ds_read_b64_tr_b16 v[160:161], v16 offset:49152
ds_read_b64_tr_b16 v[162:163], v16 offset:53248
M v[36:39], v[108:111], a[148:151], v[36:39]
buffer_load_dwordx4 v7, s[48:51], s26 offen offset:1024 lds
M v[36:39], v[104:107], a[144:147], v[36:39]
ds_read_b64_tr_b16 v[164:165], v16 offset:57344
ds_read_b64_tr_b16 v[166:167], v16 offset:61440
M v[40:43], v[112:115], a[144:147], v[40:43]
M v[40:43], v[116:119], a[148:151], v[40:43]
buffer_load_dwordx4 a[224:227], v1, s[44:47], s25 offen offset:0 sc1
M v[44:47], v[124:127], a[148:151], v[44:47]
ds_read_b64_tr_b16 v[168:169], v17 offset:49152
ds_read_b64_tr_b16 v[170:171], v17 offset:53248
M v[44:47], v[120:123], a[144:147], v[44:47]
buffer_load_dwordx4 a[228:231], v1, s[44:47], s25 offen offset:1024 sc1
M v[48:51], v[128:131], a[144:147], v[48:51]
M v[48:51], v[132:135], a[148:151], v[48:51]
ds_read_b64_tr_b16 v[172:173], v17 offset:57344
ds_read_b64_tr_b16 v[174:175], v17 offset:61440
M v[52:55], v[140:143], a[148:151], v[52:55]
buffer_load_dwordx4 a[232:235], v1, s[44:47], s25 offen offset:2048 sc1
M v[52:55], v[136:139], a[144:147], v[52:55]
ds_read_b64_tr_b16 v[176:177], v18 offset:49152
ds_read_b64_tr_b16 v[178:179], v18 offset:53248
M v[56:59], v[144:147], a[144:147], v[56:59]
M v[56:59], v[148:151], a[148:151], v[56:59]
buffer_load_dwordx4 a[236:239], v1, s[44:47], s25 offen offset:3072 sc1
M v[60:63], v[156:159], a[148:151], v[60:63]
ds_read_b64_tr_b16 v[180:181], v18 offset:57344
ds_read_b64_tr_b16 v[182:183], v18 offset:61440
M v[60:63], v[152:155], a[144:147], v[60:63]
s_add_u32 s25, s25, 16384
s_add_u32 s26, s26, 131072
M v[64:67], v[96:99], a[152:155], v[64:67]
ds_read_b64_tr_b16 v[184:185], v19 offset:49152
ds_read_b64_tr_b16 v[186:187], v19 offset:53248
M v[64:67], v[100:103], a[156:159], v[64:67]
M v[68:71], v[108:111], a[156:159], v[68:71]
ds_read_b64_tr_b16 v[188:189], v19 offset:57344
ds_read_b64_tr_b16 v[190:191], v19 offset:61440
M v[68:71], v[104:107], a[152:155], v[68:71]
ds_read_b64_tr_b16 v[192:193], v20 offset:49152
ds_read_b64_tr_b16 v[194:195], v20 offset:53248
M v[72:75], v[112:115], a[152:155], v[72:75]
ds_read_b64_tr_b16 v[196:197], v20 offset:57344
ds_read_b64_tr_b16 v[198:199], v20 offset:61440
M v[72:75], v[116:119], a[156:159], v[72:75]
M v[76:79], v[124:127], a[156:159], v[76:79]
ds_read_b64_tr_b16 v[200:201], v21 offset:49152
ds_read_b64_tr_b16 v[202:203], v21 offset:53248
M v[76:79], v[120:123], a[152:155], v[76:79]
ds_read_b64_tr_b16 v[204:205], v21 offset:57344
ds_read_b64_tr_b16 v[206:207], v21 offset:61440
M v[80:83], v[128:131], a[152:155], v[80:83]
ds_read_b64_tr_b16 v[208:209], v22 offset:49152
ds_read_b64_tr_b16 v[210:211], v22 offset:53248
M v[80:83], v[132:135], a[156:159], v[80:83]
M v[84:87], v[140:143], a[156:159], v[84:87]
ds_read_b64_tr_b16 v[212:213], v22 offset:57344
ds_read_b64_tr_b16 v[214:215], v22 offset:61440
M v[84:87], v[136:139], a[152:155], v[84:87]
ds_read_b64_tr_b16 v[216:217], v23 offset:49152
ds_read_b64_tr_b16 v[218:219], v23 offset:53248
M v[88:91], v[144:147], a[152:155], v[88:91]
ds_read_b64_tr_b16 v[220:221], v23 offset:57344
ds_read_b64_tr_b16 v[222:223], v23 offset:61440
M v[88:91], v[148:151], a[156:159], v[88:91]
M v[92:95], v[156:159], a[156:159], v[92:95]
M v[92:95], v[152:155], a[152:155], v[92:95]
s_waitcnt vmcnt(18) lgkmcnt(0)
s_barrier
M v[32:35], v[160:163], a[160:163], v[32:35]
s_add_u32 m0, s42, 65536
s_nop 0
buffer_load_dwordx4 v6, s[48:51], s26 offen offset:0 lds
M v[32:35], v[164:167], a[164:167], v[32:35]
ds_read_b64_tr_b16 v[96:97], v8 offset:0
ds_read_b64_tr_b16 v[98:99], v8 offset:4096
M v[36:39], v[172:175], a[164:167], v[36:39]
buffer_load_dwordx4 v7, s[48:51], s26 offen offset:1024 lds
M v[36:39], v[168:171], a[160:163], v[36:39]
ds_read_b64_tr_b16 v[100:101], v8 offset:8192
ds_read_b64_tr_b16 v[102:103], v8 offset:12288
M v[40:43], v[176:179], a[160:163], v[40:43]
M v[40:43], v[180:183], a[164:167], v[40:43]
buffer_load_dwordx4 a[240:243], v1, s[44:47], s25 offen offset:0 sc1
M v[44:47], v[188:191], a[164:167], v[44:47]
ds_read_b64_tr_b16 v[104:105], v9 offset:0
ds_read_b64_tr_b16 v[106:107], v9 offset:4096
M v[44:47], v[184:187], a[160:163], v[44:47]
buffer_load_dwordx4 a[244:247], v1, s[44:47], s25 offen offset:1024 sc1
M v[48:51], v[192:195], a[160:163], v[48:51]
M v[48:51], v[196:199], a[164:167], v[48:51]
ds_read_b64_tr_b16 v[108:109], v9 offset:8192
ds_read_b64_tr_b16 v[110:111], v9 offset:12288
M v[52:55], v[204:207], a[164:167], v[52:55]
buffer_load_dwordx4 a[248:251], v1, s[44:47], s25 offen offset:2048 sc1
M v[52:55], v[200:203], a[160:163], v[52:55]
ds_read_b64_tr_b16 v[112:113], v10 offset:0
ds_read_b64_tr_b16 v[114:115], v10 offset:4096
M v[56:59], v[208:211], a[160:163], v[56:59]
M v[56:59], v[212:215], a[164:167], v[56:59]
buffer_load_dwordx4 a[252:255], v1, s[44:47], s25 offen offset:3072 sc1
M v[60:63], v[220:223], a[164:167], v[60:63]
ds_read_b64_tr_b16 v[116:117], v10 offset:8192
ds_read_b64_tr_b16 v[118:119], v10 offset:12288
M v[60:63], v[216:219], a[160:163], v[60:63]
s_add_u32 s25, s25, 16384
s_add_u32 s26, s26, 131072
M v[64:67], v[160:163], a[168:171], v[64:67]
ds_read_b64_tr_b16 v[120:121], v11 offset:0
ds_read_b64_tr_b16 v[122:123], v11 offset:4096
M v[64:67], v[164:167], a[172:175], v[64:67]
M v[68:71], v[172:175], a[172:175], v[68:71]
ds_read_b64_tr_b16 v[124:125], v11 offset:8192
ds_read_b64_tr_b16 v[126:127], v11 offset:12288
M v[68:71], v[168:171], a[168:171], v[68:71]
ds_read_b64_tr_b16 v[128:129], v12 offset:0
ds_read_b64_tr_b16 v[130:131], v12 offset:4096
M v[72:75], v[176:179], a[168:171], v[72:75]
ds_read_b64_tr_b16 v[132:133], v12 offset:8192
ds_read_b64_tr_b16 v[134:135], v12 offset:12288
M v[72:75], v[180:183], a[172:175], v[72:75]
M v[76:79], v[188:191], a[172:175], v[76:79]
ds_read_b64_tr_b16 v[136:137], v13 offset:0
ds_read_b64_tr_b16 v[138:139], v13 offset:4096
M v[76:79], v[184:187], a[168:171], v[76:79]
ds_read_b64_tr_b16 v[140:141], v13 offset:8192
ds_read_b64_tr_b16 v[142:143], v13 offset:12288
M v[80:83], v[192:195], a[168:171], v[80:83]
ds_read_b64_tr_b16 v[144:145], v14 offset:0
ds_read_b64_tr_b16 v[146:147], v14 offset:4096
M v[80:83], v[196:199], a[172:175], v[80:83]
M v[84:87], v[204:207], a[172:175], v[84:87]
ds_read_b64_tr_b16 v[148:149], v14 offset:8192
ds_read_b64_tr_b16 v[150:151], v14 offset:12288
M v[84:87], v[200:203], a[168:171], v[84:87]
ds_read_b64_tr_b16 v[152:153], v15 offset:0
ds_read_b64_tr_b16 v[154:155], v15 offset:4096
M v[88:91], v[208:211], a[168:171], v[88:91]
ds_read_b64_tr_b16 v[156:157], v15 offset:8192
ds_read_b64_tr_b16 v[158:159], v15 offset:12288
M v[88:91], v[212:215], a[172:175], v[88:91]
M v[92:95], v[220:223], a[172:175], v[92:95]
M v[92:95], v[216:219], a[168:171], v[92:95]
s_waitcnt vmcnt(18) lgkmcnt(0)
s_barrier
M v[32:35], v[96:99], a[176:179], v[32:35]
s_add_u32 m0, s42, 81920
s_nop 0
buffer_load_dwordx4 v6, s[48:51], s26 offen offset:0 lds
M v[32:35], v[100:103], a[180:183], v[32:35]
M v[36:39], v[108:111], a[180:183], v[36:39]
ds_read_b64_tr_b16 v[160:161], v24 offset:16384
ds_read_b64_tr_b16 v[162:163], v24 offset:18432
M v[36:39], v[104:107], a[176:179], v[36:39]
M v[40:43], v[112:115], a[176:179], v[40:43]
buffer_load_dwordx4 v7, s[48:51], s26 offen offset:1024 lds
M v[40:43], v[116:119], a[180:183], v[40:43]
M v[44:47], v[124:127], a[180:183], v[44:47]
ds_read_b64_tr_b16 v[164:165], v24 offset:20480
ds_read_b64_tr_b16 v[166:167], v24 offset:22528
M v[44:47], v[120:123], a[176:179], v[44:47]
M v[48:51], v[128:131], a[176:179], v[48:51]
buffer_load_dwordx4 a[128:131], v1, s[44:47], s25 offen offset:0 sc1
M v[48:51], v[132:135], a[180:183], v[48:51]
M v[52:55], v[140:143], a[180:183], v[52:55]
ds_read_b64_tr_b16 v[168:169], v25 offset:16384
ds_read_b64_tr_b16 v[170:171], v25 offset:18432
M v[52:55], v[136:139], a[176:179], v[52:55]
M v[56:59], v[144:147], a[176:179], v[56:59]
buffer_load_dwordx4 a[132:135], v1, s[44:47], s25 offen offset:1024 sc1
M v[56:59], v[148:151], a[180:183], v[56:59]
M v[60:63], v[156:159], a[180:183], v[60:63]
ds_read_b64_tr_b16 v[172:173], v25 offset:20480
ds_read_b64_tr_b16 v[174:175], v25 offset:22528
M v[60:63], v[152:155], a[176:179], v[60:63]
M v[64:67], v[96:99], a[184:187], v[64:67]
buffer_load_dwordx4 a[136:139], v1, s[44:47], s25 offen offset:2048 sc1
M v[64:67], v[100:103], a[188:191], v[64:67]
M v[68:71], v[108:111], a[188:191], v[68:71]
ds_read_b64_tr_b16 v[176:177], v26 offset:16384
ds_read_b64_tr_b16 v[178:179], v26 offset:18432
M v[68:71], v[104:107], a[184:187], v[68:71]
M v[72:75], v[112:115], a[184:187], v[72:75]
buffer_load_dwordx4 a[140:143], v1, s[44:47], s25 offen offset:3072 sc1
M v[72:75], v[116:119], a[188:191], v[72:75]
M v[76:79], v[124:127], a[188:191], v[76:79]
ds_read_b64_tr_b16 v[180:181], v26 offset:20480
ds_read_b64_tr_b16 v[182:183], v26 offset:22528
M v[76:79], v[120:123], a[184:187], v[76:79]
M v[80:83], v[128:131], a[184:187], v[80:83]
s_add_u32 s25, s25, 16384
s_add_u32 s26, s26, 131072
M v[80:83], v[132:135], a[188:191], v[80:83]
M v[84:87], v[140:143], a[188:191], v[84:87]
ds_read_b64_tr_b16 v[184:185], v27 offset:16384
ds_read_b64_tr_b16 v[186:187], v27 offset:18432
M v[84:87], v[136:139], a[184:187], v[84:87]
M v[88:91], v[144:147], a[184:187], v[88:91]
ds_read_b64_tr_b16 v[188:189], v27 offset:20480
ds_read_b64_tr_b16 v[190:191], v27 offset:22528
M v[88:91], v[148:151], a[188:191], v[88:91]
M v[92:95], v[156:159], a[188:191], v[92:95]
M v[92:95], v[152:155], a[184:187], v[92:95]
s_waitcnt vmcnt(18) lgkmcnt(0)
s_barrier
M a[0:3], v[160:163], a[192:195], a[0:3]
s_add_u32 m0, s42, 98304
s_nop 0
buffer_load_dwordx4 v6, s[48:51], s26 offen offset:0 lds
ds_read_b64_tr_b16 v[96:97], v24 offset:32768
ds_read_b64_tr_b16 v[98:99], v24 offset:34816
M a[0:3], v[164:167], a[196:199], a[0:3]
buffer_load_dwordx4 v7, s[48:51], s26 offen offset:1024 lds
ds_read_b64_tr_b16 v[100:101], v24 offset:36864
ds_read_b64_tr_b16 v[102:103], v24 offset:38912
M a[4:7], v[172:175], a[196:199], a[4:7]
buffer_load_dwordx4 a[144:147], v1, s[44:47], s25 offen offset:0 sc1
ds_read_b64_tr_b16 v[104:105], v25 offset:32768
ds_read_b64_tr_b16 v[106:107], v25 offset:34816
M a[4:7], v[168:171], a[192:195], a[4:7]
buffer_load_dwordx4 a[148:151], v1, s[44:47], s25 offen offset:1024 sc1
M a[8:11], v[176:179], a[192:195], a[8:11]
ds_read_b64_tr_b16 v[108:109], v25 offset:36864
ds_read_b64_tr_b16 v[110:111], v25 offset:38912
buffer_load_dwordx4 a[152:155], v1, s[44:47], s25 offen offset:2048 sc1
M a[8:11], v[180:183], a[196:199], a[8:11]
ds_read_b64_tr_b16 v[112:113], v26 offset:32768
ds_read_b64_tr_b16 v[114:115], v26 offset:34816
buffer_load_dwordx4 a[156:159], v1, s[44:47], s25 offen offset:3072 sc1
M a[12:15], v[188:191], a[196:199], a[12:15]
ds_read_b64_tr_b16 v[116:117], v26 offset:36864
ds_read_b64_tr_b16 v[118:119], v26 offset:38912
M a[12:15], v[184:187], a[192:195], a[12:15]
s_add_u32 s25, s25, 16384
s_add_u32 s26, s26, 131072
ds_read_b64_tr_b16 v[120:121], v27 offset:32768
ds_read_b64_tr_b16 v[122:123], v27 offset:34816
M a[16:19], v[160:163], a[200:203], a[16:19]
s_add_u32 s60, s56, 0
buffer_store_dwordx4 v[48:51], v1, s[52:55], s60 offen offset:0 sc1
ds_read_b64_tr_b16 v[124:125], v27 offset:36864
ds_read_b64_tr_b16 v[126:127], v27 offset:38912
M a[16:19], v[164:167], a[204:207], a[16:19]
buffer_store_dwordx4 v[52:55], v1, s[52:55], s60 offen offset:1024 sc1
buffer_store_dwordx4 v[56:59], v1, s[52:55], s60 offen offset:2048 sc1
M a[20:23], v[172:175], a[204:207], a[20:23]
buffer_store_dwordx4 v[60:63], v1, s[52:55], s60 offen offset:3072 sc1
M a[20:23], v[168:171], a[200:203], a[20:23]
s_add_u32 s60, s56, 4096
buffer_store_dwordx4 v[80:83], v1, s[52:55], s60 offen offset:0 sc1
buffer_store_dwordx4 v[84:87], v1, s[52:55], s60 offen offset:1024 sc1
M a[24:27], v[176:179], a[200:203], a[24:27]
buffer_store_dwordx4 v[88:91], v1, s[52:55], s60 offen offset:2048 sc1
buffer_store_dwordx4 v[92:95], v1, s[52:55], s60 offen offset:3072 sc1
M a[24:27], v[180:183], a[204:207], a[24:27]
v_mov_b32 v11, 0
M a[28:31], v[188:191], a[204:207], a[28:31]
M a[28:31], v[184:187], a[200:203], a[28:31]
s_waitcnt vmcnt(26) lgkmcnt(0)
s_barrier
M a[0:3], v[96:99], a[208:211], a[0:3]
s_add_u32 m0, s42, 114688
s_nop 0
buffer_load_dwordx4 v6, s[48:51], s26 offen offset:0 lds
ds_read_b64_tr_b16 v[160:161], v24 offset:49152
ds_read_b64_tr_b16 v[162:163], v24 offset:51200
M a[0:3], v[100:103], a[212:215], a[0:3]
buffer_load_dwordx4 v7, s[48:51], s26 offen offset:1024 lds
M a[4:7], v[108:111], a[212:215], a[4:7]
ds_read_b64_tr_b16 v[164:165], v24 offset:53248
ds_read_b64_tr_b16 v[166:167], v24 offset:55296
M a[4:7], v[104:107], a[208:211], a[4:7]
buffer_load_dwordx4 a[160:163], v1, s[44:47], s25 offen offset:0 sc1
M a[8:11], v[112:115], a[208:211], a[8:11]
ds_read_b64_tr_b16 v[168:169], v25 offset:49152
ds_read_b64_tr_b16 v[170:171], v25 offset:51200
M a[8:11], v[116:119], a[212:215], a[8:11]
buffer_load_dwordx4 a[164:167], v1, s[44:47], s25 offen offset:1024 sc1
M a[12:15], v[124:127], a[212:215], a[12:15]
ds_read_b64_tr_b16 v[172:173], v25 offset:53248
ds_read_b64_tr_b16 v[174:175], v25 offset:55296
M a[12:15], v[120:123], a[208:211], a[12:15]
buffer_load_dwordx4 a[168:171], v1, s[44:47], s25 offen offset:2048 sc1
M a[16:19], v[96:99], a[216:219], a[16:19]
ds_read_b64_tr_b16 v[176:177], v26 offset:49152
ds_read_b64_tr_b16 v[178:179], v26 offset:51200
M a[16:19], v[100:103], a[220:223], a[16:19]
buffer_load_dwordx4 a[172:175], v1, s[44:47], s25 offen offset:3072 sc1
M a[20:23], v[108:111], a[220:223], a[20:23]
ds_read_b64_tr_b16 v[180:181], v26 offset:53248
ds_read_b64_tr_b16 v[182:183], v26 offset:55296
M a[20:23], v[104:107], a[216:219], a[20:23]
s_add_u32 s25, s25, 16384
s_add_u32 s26, s26, 131072
M a[24:27], v[112:115], a[216:219], a[24:27]
ds_read_b64_tr_b16 v[184:185], v27 offset:49152
ds_read_b64_tr_b16 v[186:187], v27 offset:51200
M a[24:27], v[116:119], a[220:223], a[24:27]
ds_read_b64_tr_b16 v[188:189], v27 offset:53248
ds_read_b64_tr_b16 v[190:191], v27 offset:55296
M a[28:31], v[124:127], a[220:223], a[28:31]
M a[28:31], v[120:123], a[216:219], a[28:31]
s_waitcnt vmcnt(6) lgkmcnt(0)
s_barrier
s_cmp_lg_u32 s101, 0
s_cbranch_scc1 Lk3f_7
v_mov_b32 v9, 1
s_mov_b64 exec, 1
buffer_store_dword v9, v11, s[52:55], s58 offen sc1
s_mov_b64 exec, -1
Lk3f_7:
M a[0:3], v[160:163], a[224:227], a[0:3]
s_add_u32 m0, s42, 0
s_nop 0
buffer_load_dwordx4 v6, s[48:51], s26 offen offset:0 lds
ds_read_b64_tr_b16 v[96:97], v28 offset:0
ds_read_b64_tr_b16 v[98:99], v28 offset:2048
M a[0:3], v[164:167], a[228:231], a[0:3]
buffer_load_dwordx4 v7, s[48:51], s26 offen offset:1024 lds
M a[4:7], v[172:175], a[228:231], a[4:7]
ds_read_b64_tr_b16 v[100:101], v28 offset:4096
ds_read_b64_tr_b16 v[102:103], v28 offset:6144
M a[4:7], v[168:171], a[224:227], a[4:7]
buffer_load_dwordx4 a[176:179], v1, s[44:47], s25 offen offset:0 sc1
M a[8:11], v[176:179], a[224:227], a[8:11]
ds_read_b64_tr_b16 v[104:105], v29 offset:0
ds_read_b64_tr_b16 v[106:107], v29 offset:2048
M a[8:11], v[180:183], a[228:231], a[8:11]
buffer_load_dwordx4 a[180:183], v1, s[44:47], s25 offen offset:1024 sc1
M a[12:15], v[188:191], a[228:231], a[12:15]
ds_read_b64_tr_b16 v[108:109], v29 offset:4096
ds_read_b64_tr_b16 v[110:111], v29 offset:6144
M a[12:15], v[184:187], a[224:227], a[12:15]
buffer_load_dwordx4 a[184:187], v1, s[44:47], s25 offen offset:2048 sc1
M a[16:19], v[160:163], a[232:235], a[16:19]
ds_read_b64_tr_b16 v[112:113], v30 offset:0
ds_read_b64_tr_b16 v[114:115], v30 offset:2048
M a[16:19], v[164:167], a[236:239], a[16:19]
buffer_load_dwordx4 a[188:191], v1, s[44:47], s25 offen offset:3072 sc1
M a[20:23], v[172:175], a[236:239], a[20:23]
ds_read_b64_tr_b16 v[116:117], v30 offset:4096
ds_read_b64_tr_b16 v[118:119], v30 offset:6144
M a[20:23], v[168:171], a[232:235], a[20:23]
s_add_u32 s25, s25, 16384
s_add_u32 s26, s26, 131072
M a[24:27], v[176:179], a[232:235], a[24:27]
ds_read_b64_tr_b16 v[120:121], v31 offset:0
ds_read_b64_tr_b16 v[122:123], v31 offset:2048
M a[24:27], v[180:183], a[236:239], a[24:27]
ds_read_b64_tr_b16 v[124:125], v31 offset:4096
ds_read_b64_tr_b16 v[126:127], v31 offset:6144
M a[28:31], v[188:191], a[236:239], a[28:31]
M a[28:31], v[184:187], a[232:235], a[28:31]
s_waitcnt vmcnt(26) lgkmcnt(0)
s_barrier
M a[0:3], v[96:99], a[240:243], a[0:3]
ds_read_b64_tr_b16 v[160:161], v28 offset:16384
ds_read_b64_tr_b16 v[162:163], v28 offset:18432
M a[0:3], v[100:103], a[244:247], a[0:3]
ds_read_b64_tr_b16 v[164:165], v28 offset:20480
ds_read_b64_tr_b16 v[166:167], v28 offset:22528
M a[4:7], v[108:111], a[244:247], a[4:7]
M a[4:7], v[104:107], a[240:243], a[4:7]
ds_read_b64_tr_b16 v[168:169], v29 offset:16384
ds_read_b64_tr_b16 v[170:171], v29 offset:18432
M a[8:11], v[112:115], a[240:243], a[8:11]
M a[8:11], v[116:119], a[244:247], a[8:11]
ds_read_b64_tr_b16 v[172:173], v29 offset:20480
ds_read_b64_tr_b16 v[174:175], v29 offset:22528
M a[12:15], v[124:127], a[244:247], a[12:15]
M a[12:15], v[120:123], a[240:243], a[12:15]
ds_read_b64_tr_b16 v[176:177], v30 offset:16384
ds_read_b64_tr_b16 v[178:179], v30 offset:18432
M a[16:19], v[96:99], a[248:251], a[16:19]
ds_read_b64_tr_b16 v[180:181], v30 offset:20480
ds_read_b64_tr_b16 v[182:183], v30 offset:22528
M a[16:19], v[100:103], a[252:255], a[16:19]
M a[20:23], v[108:111], a[252:255], a[20:23]
ds_read_b64_tr_b16 v[184:185], v31 offset:16384
ds_read_b64_tr_b16 v[186:187], v31 offset:18432
M a[20:23], v[104:107], a[248:251], a[20:23]
M a[24:27], v[112:115], a[248:251], a[24:27]
ds_read_b64_tr_b16 v[188:189], v31 offset:20480
ds_read_b64_tr_b16 v[190:191], v31 offset:22528
M a[24:27], v[116:119], a[252:255], a[24:27]
M a[28:31], v[124:127], a[252:255], a[28:31]
M a[28:31], v[120:123], a[248:251], a[28:31]
s_waitcnt vmcnt(20) lgkmcnt(0)
s_barrier
M a[0:3], v[160:163], a[128:131], a[0:3]
ds_read_b64_tr_b16 v[96:97], v28 offset:32768
ds_read_b64_tr_b16 v[98:99], v28 offset:34816
M a[0:3], v[164:167], a[132:135], a[0:3]
ds_read_b64_tr_b16 v[100:101], v28 offset:36864
ds_read_b64_tr_b16 v[102:103], v28 offset:38912
M a[4:7], v[172:175], a[132:135], a[4:7]
M a[4:7], v[168:171], a[128:131], a[4:7]
ds_read_b64_tr_b16 v[104:105], v29 offset:32768
ds_read_b64_tr_b16 v[106:107], v29 offset:34816
M a[8:11], v[176:179], a[128:131], a[8:11]
M a[8:11], v[180:183], a[132:135], a[8:11]
ds_read_b64_tr_b16 v[108:109], v29 offset:36864
ds_read_b64_tr_b16 v[110:111], v29 offset:38912
M a[12:15], v[188:191], a[132:135], a[12:15]
M a[12:15], v[184:187], a[128:131], a[12:15]
ds_read_b64_tr_b16 v[112:113], v30 offset:32768
ds_read_b64_tr_b16 v[114:115], v30 offset:34816
M a[16:19], v[160:163], a[136:139], a[16:19]
ds_read_b64_tr_b16 v[116:117], v30 offset:36864
ds_read_b64_tr_b16 v[118:119], v30 offset:38912
M a[16:19], v[164:167], a[140:143], a[16:19]
M a[20:23], v[172:175], a[140:143], a[20:23]
ds_read_b64_tr_b16 v[120:121], v31 offset:32768
ds_read_b64_tr_b16 v[122:123], v31 offset:34816
M a[20:23], v[168:171], a[136:139], a[20:23]
M a[24:27], v[176:179], a[136:139], a[24:27]
ds_read_b64_tr_b16 v[124:125], v31 offset:36864
ds_read_b64_tr_b16 v[126:127], v31 offset:38912
M a[24:27], v[180:183], a[140:143], a[24:27]
M a[28:31], v[188:191], a[140:143], a[28:31]
M a[28:31], v[184:187], a[136:139], a[28:31]
s_waitcnt vmcnt(6) lgkmcnt(0)
s_barrier
M a[0:3], v[96:99], a[144:147], a[0:3]
buffer_load_dword v8, v11, s[52:55], s59 offen sc1
M a[0:3], v[100:103], a[148:151], a[0:3]
ds_read_b64_tr_b16 v[160:161], v28 offset:49152
ds_read_b64_tr_b16 v[162:163], v28 offset:51200
M a[4:7], v[108:111], a[148:151], a[4:7]
M a[4:7], v[104:107], a[144:147], a[4:7]
ds_read_b64_tr_b16 v[164:165], v28 offset:53248
ds_read_b64_tr_b16 v[166:167], v28 offset:55296
M a[8:11], v[112:115], a[144:147], a[8:11]
ds_read_b64_tr_b16 v[168:169], v29 offset:49152
ds_read_b64_tr_b16 v[170:171], v29 offset:51200
M a[8:11], v[116:119], a[148:151], a[8:11]
M a[12:15], v[124:127], a[148:151], a[12:15]
ds_read_b64_tr_b16 v[172:173], v29 offset:53248
ds_read_b64_tr_b16 v[174:175], v29 offset:55296
M a[12:15], v[120:123], a[144:147], a[12:15]
ds_read_b64_tr_b16 v[176:177], v30 offset:49152
ds_read_b64_tr_b16 v[178:179], v30 offset:51200
M a[16:19], v[96:99], a[152:155], a[16:19]
M a[16:19], v[100:103], a[156:159], a[16:19]
ds_read_b64_tr_b16 v[180:181], v30 offset:53248
ds_read_b64_tr_b16 v[182:183], v30 offset:55296
M a[20:23], v[108:111], a[156:159], a[20:23]
ds_read_b64_tr_b16 v[184:185], v31 offset:49152
ds_read_b64_tr_b16 v[186:187], v31 offset:51200
M a[20:23], v[104:107], a[152:155], a[20:23]
M a[24:27], v[112:115], a[152:155], a[24:27]
ds_read_b64_tr_b16 v[188:189], v31 offset:53248
ds_read_b64_tr_b16 v[190:191], v31 offset:55296
M a[24:27], v[116:119], a[156:159], a[24:27]
M a[28:31], v[124:127], a[156:159], a[28:31]
M a[28:31], v[120:123], a[152:155], a[28:31]
s_waitcnt vmcnt(1) lgkmcnt(0)
s_barrier
s_waitcnt vmcnt(0)
v_cmp_ne_u32 vcc, 1, v8
s_nop 0
s_cbranch_vccnz Lk3_spinfl
Lk3_gotfl:
M a[0:3], v[160:163], a[160:163], a[0:3]
s_add_u32 s60, s57, 0
buffer_load_dwordx4 v[224:227], v1, s[52:55], s60 offen offset:0 sc1
ds_read_b64_tr_b16 v[96:97], v24 offset:0
ds_read_b64_tr_b16 v[98:99], v24 offset:2048
M a[0:3], v[164:167], a[164:167], a[0:3]
buffer_load_dwordx4 v[228:231], v1, s[52:55], s60 offen offset:1024 sc1
M a[4:7], v[172:175], a[164:167], a[4:7]
ds_read_b64_tr_b16 v[100:101], v24 offset:4096
ds_read_b64_tr_b16 v[102:103], v24 offset:6144
M a[4:7], v[168:171], a[160:163], a[4:7]
buffer_load_dwordx4 v[232:235], v1, s[52:55], s60 offen offset:2048 sc1
M a[8:11], v[176:179], a[160:163], a[8:11]
ds_read_b64_tr_b16 v[104:105], v25 offset:0
ds_read_b64_tr_b16 v[106:107], v25 offset:2048
M a[8:11], v[180:183], a[164:167], a[8:11]
buffer_load_dwordx4 v[236:239], v1, s[52:55], s60 offen offset:3072 sc1
M a[12:15], v[188:191], a[164:167], a[12:15]
ds_read_b64_tr_b16 v[108:109], v25 offset:4096
ds_read_b64_tr_b16 v[110:111], v25 offset:6144
M a[12:15], v[184:187], a[160:163], a[12:15]
s_add_u32 s60, s57, 4096
buffer_load_dwordx4 v[240:243], v1, s[52:55], s60 offen offset:0 sc1
ds_read_b64_tr_b16 v[112:113], v26 offset:0
ds_read_b64_tr_b16 v[114:115], v26 offset:2048
M a[16:19], v[160:163], a[168:171], a[16:19]
buffer_load_dwordx4 v[244:247], v1, s[52:55], s60 offen offset:1024 sc1
M a[16:19], v[164:167], a[172:175], a[16:19]
ds_read_b64_tr_b16 v[116:117], v26 offset:4096
ds_read_b64_tr_b16 v[118:119], v26 offset:6144
M a[20:23], v[172:175], a[172:175], a[20:23]
buffer_load_dwordx4 v[248:251], v1, s[52:55], s60 offen offset:2048 sc1
M a[20:23], v[168:171], a[168:171], a[20:23]
ds_read_b64_tr_b16 v[120:121], v27 offset:0
ds_read_b64_tr_b16 v[122:123], v27 offset:2048
M a[24:27], v[176:179], a[168:171], a[24:27]
buffer_load_dwordx4 v[252:255], v1, s[52:55], s60 offen offset:3072 sc1
M a[24:27], v[180:183], a[172:175], a[24:27]
ds_read_b64_tr_b16 v[124:125], v27 offset:4096
ds_read_b64_tr_b16 v[126:127], v27 offset:6144
M a[28:31], v[188:191], a[172:175], a[28:31]
M a[28:31], v[184:187], a[168:171], a[28:31]
s_waitcnt lgkmcnt(0)
M a[0:3], v[96:99], a[176:179], a[0:3]
M a[0:3], v[100:103], a[180:183], a[0:3]
M a[4:7], v[108:111], a[180:183], a[4:7]
M a[4:7], v[104:107], a[176:179], a[4:7]
M a[8:11], v[112:115], a[176:179], a[8:11]
M a[8:11], v[116:119], a[180:183], a[8:11]
M a[12:15], v[124:127], a[180:183], a[12:15]
M a[12:15], v[120:123], a[176:179], a[12:15]
M a[16:19], v[96:99], a[184:187], a[16:19]
M a[16:19], v[100:103], a[188:191], a[16:19]
M a[20:23], v[108:111], a[188:191], a[20:23]
M a[20:23], v[104:107], a[184:187], a[20:23]
M a[24:27], v[112:115], a[184:187], a[24:27]
M a[24:27], v[116:119], a[188:191], a[24:27]
M a[28:31], v[124:127], a[188:191], a[28:31]
M a[28:31], v[120:123], a[184:187], a[28:31]
v_bfe_u32 v96, v0, 4, 1
v_lshrrev_b32 v97, 5, v0
v_lshl_or_b32 v96, v96, 1, v97
v_and_b32 v97, 15, v0
v_lshlrev_b32 v97, 13, v97
v_lshl_add_u32 v96, v96, 4, v97
s_and_b32 s3, s101, 1
s_lshl_b32 s3, s3, 6
s_lshr_b32 s6, s101, 1
s_add_u32 s3, s3, s6
s_add_u32 s3, s3, s21
s_lshl_b32 s3, s3, 12
s_lshl_b32 s6, s22, 1
s_add_u32 s3, s3, s6
s_add_u32 s3, s3, 2048
v_accvgpr_read_b32 v108, a0
v_accvgpr_read_b32 v109, a1
v_accvgpr_read_b32 v110, a2
v_accvgpr_read_b32 v111, a3
v_accvgpr_read_b32 v112, a4
v_accvgpr_read_b32 v113, a5
v_accvgpr_read_b32 v114, a6
v_accvgpr_read_b32 v115, a7
v_cvt_pk_bf16_f32 v100, v108, v109
v_cvt_pk_bf16_f32 v101, v110, v111
v_cvt_pk_bf16_f32 v102, v112, v113
v_cvt_pk_bf16_f32 v103, v114, v115
s_nop 0
v_permlane16_swap_b32 v100, v102
v_permlane16_swap_b32 v101, v103
buffer_store_dwordx4 v[100:103], v96, s[16:19], s3 offen offset:0
v_accvgpr_read_b32 v108, a8
v_accvgpr_read_b32 v109, a9
v_accvgpr_read_b32 v110, a10
v_accvgpr_read_b32 v111, a11
v_accvgpr_read_b32 v112, a12
v_accvgpr_read_b32 v113, a13
v_accvgpr_read_b32 v114, a14
v_accvgpr_read_b32 v115, a15
v_cvt_pk_bf16_f32 v104, v108, v109
v_cvt_pk_bf16_f32 v105, v110, v111
v_cvt_pk_bf16_f32 v106, v112, v113
v_cvt_pk_bf16_f32 v107, v114, v115
s_nop 0
v_permlane16_swap_b32 v104, v106
v_permlane16_swap_b32 v105, v107
buffer_store_dwordx4 v[104:107], v96, s[16:19], s3 offen offset:64
s_add_u32 s3, s3, 131072
v_accvgpr_read_b32 v108, a16
v_accvgpr_read_b32 v109, a17
v_accvgpr_read_b32 v110, a18
v_accvgpr_read_b32 v111, a19
v_accvgpr_read_b32 v112, a20
v_accvgpr_read_b32 v113, a21
v_accvgpr_read_b32 v114, a22
v_accvgpr_read_b32 v115, a23
v_cvt_pk_bf16_f32 v100, v108, v109
v_cvt_pk_bf16_f32 v101, v110, v111
v_cvt_pk_bf16_f32 v102, v112, v113
v_cvt_pk_bf16_f32 v103, v114, v115
s_nop 0
v_permlane16_swap_b32 v100, v102
v_permlane16_swap_b32 v101, v103
buffer_store_dwordx4 v[100:103], v96, s[16:19], s3 offen offset:0
v_accvgpr_read_b32 v108, a24
v_accvgpr_read_b32 v109, a25
v_accvgpr_read_b32 v110, a26
v_accvgpr_read_b32 v111, a27
v_accvgpr_read_b32 v112, a28
v_accvgpr_read_b32 v113, a29
v_accvgpr_read_b32 v114, a30
v_accvgpr_read_b32 v115, a31
v_cvt_pk_bf16_f32 v104, v108, v109
v_cvt_pk_bf16_f32 v105, v110, v111
v_cvt_pk_bf16_f32 v106, v112, v113
v_cvt_pk_bf16_f32 v107, v114, v115
s_nop 0
v_permlane16_swap_b32 v104, v106
v_permlane16_swap_b32 v105, v107
buffer_store_dwordx4 v[104:107], v96, s[16:19], s3 offen offset:64
v_bfe_u32 v128, v0, 4, 1
v_lshrrev_b32 v129, 5, v0
v_lshl_or_b32 v128, v128, 1, v129
v_and_b32 v129, 15, v0
v_lshlrev_b32 v129, 12, v129
v_lshl_add_u32 v128, v128, 4, v129
s_lshl_b32 s3, s101, 5
s_add_u32 s3, s3, s29
s_lshl_b32 s3, s3, 12
s_lshl_b32 s6, s30, 1
s_add_u32 s3, s3, s6
s_waitcnt vmcnt(4)
v_pk_add_f32 v[32:33], v[32:33], v[224:225]
v_pk_add_f32 v[34:35], v[34:35], v[226:227]
v_pk_add_f32 v[36:37], v[36:37], v[228:229]
v_pk_add_f32 v[38:39], v[38:39], v[230:231]
v_cvt_pk_bf16_f32 v132, v32, v33
v_cvt_pk_bf16_f32 v133, v34, v35
v_cvt_pk_bf16_f32 v134, v36, v37
v_cvt_pk_bf16_f32 v135, v38, v39
s_nop 0
v_permlane16_swap_b32 v132, v134
v_permlane16_swap_b32 v133, v135
buffer_store_dwordx4 v[132:135], v128, s[16:19], s3 offen offset:0
v_pk_add_f32 v[40:41], v[40:41], v[232:233]
v_pk_add_f32 v[42:43], v[42:43], v[234:235]
v_pk_add_f32 v[44:45], v[44:45], v[236:237]
v_pk_add_f32 v[46:47], v[46:47], v[238:239]
v_cvt_pk_bf16_f32 v136, v40, v41
v_cvt_pk_bf16_f32 v137, v42, v43
v_cvt_pk_bf16_f32 v138, v44, v45
v_cvt_pk_bf16_f32 v139, v46, v47
s_nop 0
v_permlane16_swap_b32 v136, v138
v_permlane16_swap_b32 v137, v139
buffer_store_dwordx4 v[136:139], v128, s[16:19], s3 offen offset:64
s_add_u32 s3, s3, 65536
v_pk_add_f32 v[64:65], v[64:65], v[240:241]
v_pk_add_f32 v[66:67], v[66:67], v[242:243]
v_pk_add_f32 v[68:69], v[68:69], v[244:245]
v_pk_add_f32 v[70:71], v[70:71], v[246:247]
v_cvt_pk_bf16_f32 v132, v64, v65
v_cvt_pk_bf16_f32 v133, v66, v67
v_cvt_pk_bf16_f32 v134, v68, v69
v_cvt_pk_bf16_f32 v135, v70, v71
s_nop 0
v_permlane16_swap_b32 v132, v134
v_permlane16_swap_b32 v133, v135
buffer_store_dwordx4 v[132:135], v128, s[16:19], s3 offen offset:0
v_pk_add_f32 v[72:73], v[72:73], v[248:249]
v_pk_add_f32 v[74:75], v[74:75], v[250:251]
v_pk_add_f32 v[76:77], v[76:77], v[252:253]
v_pk_add_f32 v[78:79], v[78:79], v[254:255]
v_cvt_pk_bf16_f32 v136, v72, v73
v_cvt_pk_bf16_f32 v137, v74, v75
v_cvt_pk_bf16_f32 v138, v76, v77
v_cvt_pk_bf16_f32 v139, v78, v79
s_nop 0
v_permlane16_swap_b32 v136, v138
v_permlane16_swap_b32 v137, v139
buffer_store_dwordx4 v[136:139], v128, s[16:19], s3 offen offset:64
s_endpgm
Lk3_spinb0:
Lk3_spinb0_:
s_add_u32 s61, s61, 1
s_cmp_gt_u32 s61, 1048576
s_cbranch_scc1 Lk3_gotb0
s_sleep 2
buffer_load_dword v7, v15, s[52:55], s43 offen sc1
s_waitcnt vmcnt(0)
v_cmp_ne_u32 vcc, 1, v7
s_nop 0
s_cbranch_vccnz Lk3_spinb0_
s_branch Lk3_gotb0
Lk3_spinb1:
Lk3_spinb1_:
s_add_u32 s61, s61, 1
s_cmp_gt_u32 s61, 1048576
s_cbranch_scc1 Lk3_gotb1
s_sleep 2
buffer_load_dword v7, v15, s[52:55], s43 offen sc1
s_waitcnt vmcnt(0)
v_cmp_ne_u32 vcc, 1, v7
s_nop 0
s_cbranch_vccnz Lk3_spinb1_
s_branch Lk3_gotb1
Lk3_spinb2:
Lk3_spinb2_:
s_add_u32 s61, s61, 1
s_cmp_gt_u32 s61, 1048576
s_cbranch_scc1 Lk3_gotb2
s_sleep 2
buffer_load_dword v7, v15, s[52:55], s43 offen sc1
s_waitcnt vmcnt(0)
v_cmp_ne_u32 vcc, 1, v7
s_nop 0
s_cbranch_vccnz Lk3_spinb2_
s_branch Lk3_gotb2
Lk3_spinft:
s_add_u32 s61, s61, 1
s_cmp_gt_u32 s61, 1048576
s_cbranch_scc1 Lk3_gotft
s_sleep 2
buffer_load_dword v252, v255, s[52:55], s62 offen sc1
s_waitcnt vmcnt(0)
v_cmp_ne_u32 vcc, 1, v252
s_nop 0
s_cbranch_vccnz Lk3_spinft
s_branch Lk3_gotft
Lk3_spinfl:
s_add_u32 s61, s61, 1
s_cmp_gt_u32 s61, 1048576
s_cbranch_scc1 Lk3_gotfl
s_sleep 2
buffer_load_dword v8, v11, s[52:55], s59 offen sc1
s_waitcnt vmcnt(0)
v_cmp_ne_u32 vcc, 1, v8
s_nop 0
s_cbranch_vccnz Lk3_spinfl
s_branch Lk3_gotfl
Lc3:
.section .rodata,"a"
.p2align 6
.amdhsa_kernel concat_heads__compressed_kv_cla__sliding_local_dilated__prompt_kernel
  .amdhsa_next_free_vgpr 512
  .amdhsa_next_free_sgpr 102
  .amdhsa_accum_offset 256
  .amdhsa_group_segment_fixed_size 0
  .amdhsa_kernarg_size 96
  .amdhsa_user_sgpr_count 2
  .amdhsa_user_sgpr_kernarg_segment_ptr 1
  .amdhsa_system_sgpr_workgroup_id_x 1
.end_amdhsa_kernel
```

```asm
; @launch grid=(256,1,1) block=(256,1,1) lds=163840
.amdgcn_target "amdgcn-amd-amdhsa--gfx950"
.text
.macro M d, a, b, c
v_mfma_f32_16x16x32_bf16 \d, \a, \b, \c
.endm
.globl concat_heads__compressed_kv_cla__sliding_local_dilated__prompt_kernel
.p2align 8
.type concat_heads__compressed_kv_cla__sliding_local_dilated__prompt_kernel,@function
concat_heads__compressed_kv_cla__sliding_local_dilated__prompt_kernel:
s_cmp_lt_u32 s2, 256
s_cbranch_scc1 Lk1_go
s_endpgm
Lk1_go:
s_load_dwordx16 s[32:47], s[0:1], 0
s_load_dwordx2 s[48:49], s[0:1], 64
s_load_dwordx2 s[50:51], s[0:1], 88
s_load_dwordx2 s[90:91], s[0:1], 80
v_lshrrev_b32 v24, 6, v0
s_nop 0
v_readfirstlane_b32 s20, v24
v_and_b32 v0, 63, v0
v_lshlrev_b32 v1, 4, v0
s_mov_b32 s101, s20
s_lshr_b32 s21, s20, 1
s_and_b32 s22, s20, 1
s_lshl_b32 s29, s20, 12
s_and_b32 s3, s2, 1
s_lshl_b32 s3, s3, 2
s_bfe_u32 s6, s2, 0x20003
s_add_u32 s3, s3, s6
s_lshl_b32 s52, s3, 8
s_bfe_u32 s3, s2, 0x20001
s_lshl_b32 s3, s3, 2
s_bfe_u32 s7, s2, 0x20005
s_add_u32 s3, s3, s7
s_lshl_b32 s53, s3, 8
s_cmp_lt_u32 s2, 128
s_cselect_b32 s5, 11, 10
s_lshl_b32 s3, s21, 7
s_lshl_b32 s4, s22, 5
s_add_u32 s3, s3, s4
v_lshrrev_b32 v24, 3, v0
v_add_u32 v24, s3, v24
v_and_b32 v25, 7, v0
v_add_u32 v26, 0, v24
v_bfe_u32 v27, v26, 1, 3
v_xor_b32 v27, v27, v25
v_lshlrev_b32 v26, s5, v26
v_lshl_add_u32 v26, v27, 4, v26
v_subrev_u32 v2, 0, v26
v_add_u32 v26, 8, v24
v_bfe_u32 v27, v26, 1, 3
v_xor_b32 v27, v27, v25
v_lshlrev_b32 v26, s5, v26
v_lshl_add_u32 v26, v27, 4, v26
v_subrev_u32 v3, 1024, v26
v_add_u32 v26, 16, v24
v_bfe_u32 v27, v26, 1, 3
v_xor_b32 v27, v27, v25
v_lshlrev_b32 v26, s5, v26
v_lshl_add_u32 v26, v27, 4, v26
v_subrev_u32 v4, 2048, v26
v_add_u32 v26, 24, v24
v_bfe_u32 v27, v26, 1, 3
v_xor_b32 v27, v27, v25
v_lshlrev_b32 v26, s5, v26
v_lshl_add_u32 v26, v27, 4, v26
v_subrev_u32 v5, 3072, v26
s_lshl_b32 s3, s20, 3
v_lshrrev_b32 v24, 5, v0
v_add_u32 v24, s3, v24
v_and_b32 v25, 31, v0
v_add_u32 v26, 0, v24
v_and_b32 v27, 3, v26
v_lshlrev_b32 v27, 1, v27
v_and_or_b32 v27, v26, 8, v27
v_xor_b32 v27, v27, v25
v_lshlrev_b32 v26, 13, v26
v_lshl_add_u32 v26, v27, 4, v26
v_subrev_u32 v6, 0, v26
v_add_u32 v26, 2, v24
v_and_b32 v27, 3, v26
v_lshlrev_b32 v27, 1, v27
v_and_or_b32 v27, v26, 8, v27
v_xor_b32 v27, v27, v25
v_lshlrev_b32 v26, 13, v26
v_lshl_add_u32 v26, v27, 4, v26
v_subrev_u32 v7, 1024, v26
v_add_u32 v26, 4, v24
v_and_b32 v27, 3, v26
v_lshlrev_b32 v27, 1, v27
v_and_or_b32 v27, v26, 8, v27
v_xor_b32 v27, v27, v25
v_lshlrev_b32 v26, 13, v26
v_lshl_add_u32 v26, v27, 4, v26
v_subrev_u32 v8, 2048, v26
v_add_u32 v26, 6, v24
v_and_b32 v27, 3, v26
v_lshlrev_b32 v27, 1, v27
v_and_or_b32 v27, v26, 8, v27
v_xor_b32 v27, v27, v25
v_lshlrev_b32 v26, 13, v26
v_lshl_add_u32 v26, v27, 4, v26
v_subrev_u32 v9, 3072, v26
s_lshl_b32 s23, s52, s5
s_lshl_b32 s31, 64, s5
s_mov_b32 s26, s23
s_lshl_b32 s24, s53, 1
s_mov_b32 s28, s24
s_lshl_b32 s3, 1, s5
s_add_u32 s25, s23, s3
s_lshl_b32 s3, s3, 12
s_add_u32 s27, s24, s3
s_bfe_u32 s3, s2, 0x20001
s_and_b32 s4, s2, 1
s_lshl_b32 s4, s4, 1
s_add_u32 s3, s3, s4
s_and_b32 s3, s3, 3
s_sub_u32 s4, s5, 2
s_lshl_b32 s3, s3, s4
s_add_u32 s23, s23, s3
s_lshl_b32 s3, s3, 12
s_add_u32 s24, s24, s3
s_mov_b32 s95, s6
s_cmp_lt_u32 s2, 128
s_cselect_b32 s6, -1, 8
s_waitcnt lgkmcnt(0)
s_cmp_lt_u32 s2, 128
s_cselect_b64 s[8:9], s[32:33], s[34:35]
s_mov_b32 s10, 2097152
s_cselect_b32 s10, 4194304, s10
s_mov_b32 s11, 0x00020000
s_cselect_b64 s[12:13], s[36:37], s[38:39]
s_mov_b32 s14, 4194304
s_cselect_b32 s14, 8388608, s14
s_mov_b32 s15, 0x00020000
s_mov_b64 s[64:65], s[40:41]
s_add_u32 m0, s29, 65536
s_nop 0
buffer_load_dwordx4 v6, s[12:15], s24 offen offset:0 lds
buffer_load_dwordx4 v7, s[12:15], s24 offen offset:1024 lds
buffer_load_dwordx4 v8, s[12:15], s24 offen offset:2048 lds
buffer_load_dwordx4 v9, s[12:15], s24 offen offset:3072 lds
s_add_u32 s24, s24, 262144
s_add_u32 m0, s29, 0
s_nop 0
buffer_load_dwordx4 v2, s[8:11], s23 offen offset:0 lds
buffer_load_dwordx4 v3, s[8:11], s23 offen offset:1024 lds
buffer_load_dwordx4 v4, s[8:11], s23 offen offset:2048 lds
buffer_load_dwordx4 v5, s[8:11], s23 offen offset:3072 lds
s_add_u32 m0, s29, 81920
s_nop 0
buffer_load_dwordx4 v6, s[12:15], s24 offen offset:0 lds
buffer_load_dwordx4 v7, s[12:15], s24 offen offset:1024 lds
buffer_load_dwordx4 v8, s[12:15], s24 offen offset:2048 lds
buffer_load_dwordx4 v9, s[12:15], s24 offen offset:3072 lds
s_add_u32 s24, s24, 262144
s_cmp_eq_u32 s24, s27
s_cselect_b32 s24, s28, s24
s_sub_u32 s6, s6, 1
s_cmp_eq_u32 s6, 0
s_cselect_b64 s[12:13], s[64:65], s[12:13]
s_add_u32 s16, s50, 117440512
s_addc_u32 s17, s51, 0
s_mov_b32 s18, 16384
s_mov_b32 s19, 0x00020000
v_mov_b32 v24, 0
v_mov_b32 v25, 0
v_mov_b32 v26, 0
v_mov_b32 v27, 0
s_lshl_b32 s3, s2, 2
buffer_store_dword v24, v24, s[16:19], s3 offen sc1
s_and_b32 s3, s2, 7
s_lshr_b32 s4, s2, 6
s_lshl_b32 s4, s4, 3
s_add_u32 s3, s3, s4
s_lshl_b32 s3, s3, 4
s_add_u32 s3, s3, 4096
s_bfe_u32 s4, s2, 0x30003
s_lshl_b32 s4, s4, 9
s_add_u32 s92, s3, s4
s_sub_u32 s4, 7680, s4
s_add_u32 s93, s3, s4
buffer_store_dwordx4 v[24:27], v24, s[16:19], s92 offen sc1
buffer_store_dwordx4 v[24:27], v24, s[16:19], s93 offen sc1
s_and_b32 s3, s2, 1
s_lshl_b32 s3, s3, 3
s_bfe_u32 s4, s2, 0x30003
s_add_u32 s92, s3, s4
s_bfe_u32 s3, s2, 0x20001
s_lshl_b32 s3, s3, 2
s_lshr_b32 s4, s2, 6
s_xor_b32 s4, s4, 2
s_add_u32 s93, s3, s4
s_lshl_b32 s92, s92, 8
s_lshl_b32 s93, s93, 4
s_add_u32 s92, s92, s93
s_add_u32 s92, s92, 12288
buffer_store_dwordx4 v[24:27], v24, s[16:19], s92 offen sc1
v_lshlrev_b32 v20, 7, v0
s_lshl_b32 s54, s2, 13
s_mov_b64 s[60:61], s[40:41]
s_mov_b32 s62, 0
s_cmp_eq_u32 s20, 1
s_cselect_b64 s[60:61], s[46:47], s[60:61]
s_cselect_b32 s62, 6291456, s62
s_cmp_eq_u32 s20, 2
s_cselect_b64 s[60:61], s[44:45], s[60:61]
s_cselect_b32 s62, 4194304, s62
s_cmp_eq_u32 s20, 3
s_cselect_b32 s62, 0, s62
s_mov_b32 s63, 0x00020000
s_mov_b32 s3, 0
s_cmp_eq_u32 s20, 1
s_cselect_b32 s3, 6291456, s3
s_cmp_eq_u32 s20, 2
s_cselect_b32 s3, 6291456, s3
s_sub_u32 s54, s54, s3
Lc0:
s_add_u32 m0, s29, 98304
s_nop 0
buffer_load_dwordx4 v6, s[12:15], s24 offen offset:0 lds
buffer_load_dwordx4 v7, s[12:15], s24 offen offset:1024 lds
buffer_load_dwordx4 v8, s[12:15], s24 offen offset:2048 lds
buffer_load_dwordx4 v9, s[12:15], s24 offen offset:3072 lds
s_add_u32 s24, s24, 262144
s_lshl_b32 s4, s21, 13
v_and_b32 v24, 15, v0
v_lshlrev_b32 v24, 7, v24
v_add_u32 v24, s4, v24
v_bfe_u32 v25, v0, 1, 3
v_lshrrev_b32 v26, 4, v0
v_xor_b32 v25, v25, v26
v_lshl_add_u32 v10, v25, 4, v24
v_xor_b32 v11, 64, v10
v_bfe_u32 v24, v0, 2, 2
v_lshl_add_u32 v29, v26, 3, v24
v_lshlrev_b32 v25, 9, v29
v_and_b32 v27, 1, v0
v_lshl_add_u32 v25, v27, 3, v25
v_add_u32 v25, 65536, v25
v_lshlrev_b32 v24, 1, v24
v_and_or_b32 v24, v29, 8, v24
v_bfe_u32 v26, v0, 1, 1
s_lshl_b32 s4, s22, 4
s_add_u32 s3, s4, 0
v_add_u32 v27, s3, v26
v_xor_b32 v27, v27, v24
v_lshl_add_u32 v12, v27, 4, v25
s_add_u32 s3, s4, 2
v_add_u32 v27, s3, v26
v_xor_b32 v27, v27, v24
v_lshl_add_u32 v13, v27, 4, v25
s_add_u32 s3, s4, 4
v_add_u32 v27, s3, v26
v_xor_b32 v27, v27, v24
v_lshl_add_u32 v14, v27, 4, v25
s_add_u32 s3, s4, 6
v_add_u32 v27, s3, v26
v_xor_b32 v27, v27, v24
v_lshl_add_u32 v15, v27, 4, v25
s_add_u32 s3, s4, 8
v_add_u32 v27, s3, v26
v_xor_b32 v27, v27, v24
v_lshl_add_u32 v16, v27, 4, v25
s_add_u32 s3, s4, 10
v_add_u32 v27, s3, v26
v_xor_b32 v27, v27, v24
v_lshl_add_u32 v17, v27, 4, v25
s_add_u32 s3, s4, 12
v_add_u32 v27, s3, v26
v_xor_b32 v27, v27, v24
v_lshl_add_u32 v18, v27, 4, v25
s_add_u32 s3, s4, 14
v_add_u32 v27, s3, v26
v_xor_b32 v27, v27, v24
v_lshl_add_u32 v19, v27, 4, v25
s_waitcnt vmcnt(8)
s_barrier
ds_read_b64_tr_b16 a[32:33], v12 offset:0
ds_read_b64_tr_b16 a[34:35], v12 offset:2048
ds_read_b64_tr_b16 a[40:41], v13 offset:0
ds_read_b64_tr_b16 a[42:43], v13 offset:2048
ds_read_b64_tr_b16 a[48:49], v14 offset:0
ds_read_b64_tr_b16 a[50:51], v14 offset:2048
ds_read_b64_tr_b16 a[56:57], v15 offset:0
ds_read_b64_tr_b16 a[58:59], v15 offset:2048
ds_read_b64_tr_b16 a[64:65], v16 offset:0
ds_read_b64_tr_b16 a[66:67], v16 offset:2048
ds_read_b64_tr_b16 a[72:73], v17 offset:0
ds_read_b64_tr_b16 a[74:75], v17 offset:2048
ds_read_b64_tr_b16 a[80:81], v18 offset:0
ds_read_b64_tr_b16 a[82:83], v18 offset:2048
ds_read_b64_tr_b16 a[88:89], v19 offset:0
ds_read_b64_tr_b16 a[90:91], v19 offset:2048
ds_read_b64_tr_b16 a[36:37], v12 offset:16384
ds_read_b64_tr_b16 a[38:39], v12 offset:18432
ds_read_b64_tr_b16 a[44:45], v13 offset:16384
ds_read_b64_tr_b16 a[46:47], v13 offset:18432
ds_read_b64_tr_b16 a[52:53], v14 offset:16384
ds_read_b64_tr_b16 a[54:55], v14 offset:18432
ds_read_b64_tr_b16 a[60:61], v15 offset:16384
ds_read_b64_tr_b16 a[62:63], v15 offset:18432
ds_read_b64_tr_b16 a[68:69], v16 offset:16384
ds_read_b64_tr_b16 a[70:71], v16 offset:18432
ds_read_b64_tr_b16 a[76:77], v17 offset:16384
ds_read_b64_tr_b16 a[78:79], v17 offset:18432
ds_read_b64_tr_b16 a[84:85], v18 offset:16384
ds_read_b64_tr_b16 a[86:87], v18 offset:18432
ds_read_b64_tr_b16 a[92:93], v19 offset:16384
ds_read_b64_tr_b16 a[94:95], v19 offset:18432
ds_read_b128 a[160:163], v10 offset:0
ds_read_b128 a[164:167], v11 offset:0
ds_read_b128 a[168:171], v10 offset:2048
ds_read_b128 a[172:175], v11 offset:2048
s_add_u32 m0, s29, 16384
s_add_u32 s3, s23, s31
s_nop 0
buffer_load_dwordx4 v2, s[8:11], s3 offen offset:0 lds
buffer_load_dwordx4 v3, s[8:11], s3 offen offset:1024 lds
buffer_load_dwordx4 v4, s[8:11], s3 offen offset:2048 lds
buffer_load_dwordx4 v5, s[8:11], s3 offen offset:3072 lds
s_add_u32 s23, s23, 128
s_cmp_eq_u32 s23, s25
s_cselect_b32 s23, s26, s23
s_add_u32 m0, s29, 114688
s_nop 0
buffer_load_dwordx4 v6, s[12:15], s24 offen offset:0 lds
buffer_load_dwordx4 v7, s[12:15], s24 offen offset:1024 lds
buffer_load_dwordx4 v8, s[12:15], s24 offen offset:2048 lds
buffer_load_dwordx4 v9, s[12:15], s24 offen offset:3072 lds
s_add_u32 s24, s24, 262144
s_cmp_eq_u32 s24, s27
s_cselect_b32 s24, s28, s24
s_sub_u32 s6, s6, 1
s_cmp_eq_u32 s6, 0
s_cselect_b64 s[12:13], s[64:65], s[12:13]
s_waitcnt vmcnt(8) lgkmcnt(0)
s_barrier
s_getpc_b64 s[92:93]
Lpc_1:
s_add_u32 s92, s92, Lc1-Lpc_1
s_addc_u32 s93, s93, 0
s_lshr_b32 s94, s2, 3
s_mul_i32 s94, s94, ((Lc3-Lc1)/32+127)&~127
v_lshlrev_b32 v24, 7, v0
v_add_u32 v24, s94, v24
v_min_u32 v24, Lc3-Lc1-4, v24
global_load_dword v21, v24, s[92:93]
Lc1:
s_cmp_lt_u32 s2, 128
s_cbranch_scc0 Lk1_kv
M v[32:35], a[32:35], a[160:163], 0
s_add_u32 m0, s29, 32768
s_nop 0
buffer_load_dwordx4 v2, s[8:11], s23 offen offset:0 lds
M v[32:35], a[36:39], a[164:167], v[32:35]
ds_read_b128 a[176:179], v10 offset:4096
ds_read_b128 a[180:183], v11 offset:4096
M v[36:39], a[44:47], a[164:167], 0
M v[36:39], a[40:43], a[160:163], v[36:39]
ds_read_b64_tr_b16 a[96:97], v12 offset:32768
ds_read_b64_tr_b16 a[98:99], v12 offset:34816
M v[40:43], a[48:51], a[160:163], 0
M v[40:43], a[52:55], a[164:167], v[40:43]
buffer_load_dwordx4 v3, s[8:11], s23 offen offset:1024 lds
M v[44:47], a[60:63], a[164:167], 0
M v[44:47], a[56:59], a[160:163], v[44:47]
ds_read_b64_tr_b16 a[104:105], v13 offset:32768
ds_read_b64_tr_b16 a[106:107], v13 offset:34816
M v[48:51], a[64:67], a[160:163], 0
M v[48:51], a[68:71], a[164:167], v[48:51]
buffer_load_dwordx4 v4, s[8:11], s23 offen offset:2048 lds
M v[52:55], a[76:79], a[164:167], 0
M v[52:55], a[72:75], a[160:163], v[52:55]
ds_read_b64_tr_b16 a[112:113], v14 offset:32768
ds_read_b64_tr_b16 a[114:115], v14 offset:34816
M v[56:59], a[80:83], a[160:163], 0
M v[56:59], a[84:87], a[164:167], v[56:59]
buffer_load_dwordx4 v5, s[8:11], s23 offen offset:3072 lds
M v[60:63], a[92:95], a[164:167], 0
M v[60:63], a[88:91], a[160:163], v[60:63]
ds_read_b64_tr_b16 a[120:121], v15 offset:32768
ds_read_b64_tr_b16 a[122:123], v15 offset:34816
M v[64:67], a[32:35], a[168:171], 0
M v[64:67], a[36:39], a[172:175], v[64:67]
ds_read_b128 a[184:187], v10 offset:6144
ds_read_b128 a[188:191], v11 offset:6144
M v[68:71], a[44:47], a[172:175], 0
s_add_u32 m0, s29, 65536
s_nop 0
buffer_load_dwordx4 v6, s[12:15], s24 offen offset:0 lds
M v[68:71], a[40:43], a[168:171], v[68:71]
ds_read_b64_tr_b16 a[128:129], v16 offset:32768
ds_read_b64_tr_b16 a[130:131], v16 offset:34816
M v[72:75], a[48:51], a[168:171], 0
M v[72:75], a[52:55], a[172:175], v[72:75]
M v[76:79], a[60:63], a[172:175], 0
buffer_load_dwordx4 v7, s[12:15], s24 offen offset:1024 lds
M v[76:79], a[56:59], a[168:171], v[76:79]
ds_read_b64_tr_b16 a[136:137], v17 offset:32768
ds_read_b64_tr_b16 a[138:139], v17 offset:34816
M v[80:83], a[64:67], a[168:171], 0
M v[80:83], a[68:71], a[172:175], v[80:83]
M v[84:87], a[76:79], a[172:175], 0
buffer_load_dwordx4 v8, s[12:15], s24 offen offset:2048 lds
M v[84:87], a[72:75], a[168:171], v[84:87]
ds_read_b64_tr_b16 a[144:145], v18 offset:32768
ds_read_b64_tr_b16 a[146:147], v18 offset:34816
M v[88:91], a[80:83], a[168:171], 0
M v[88:91], a[84:87], a[172:175], v[88:91]
M v[92:95], a[92:95], a[172:175], 0
buffer_load_dwordx4 v9, s[12:15], s24 offen offset:3072 lds
M v[92:95], a[88:91], a[168:171], v[92:95]
s_waitcnt lgkmcnt(15)
ds_read_b64_tr_b16 a[152:153], v19 offset:32768
ds_read_b64_tr_b16 a[154:155], v19 offset:34816
M v[96:99], a[32:35], a[176:179], 0
M v[96:99], a[36:39], a[180:183], v[96:99]
M v[100:103], a[44:47], a[180:183], 0
s_add_u32 s24, s24, 262144
M v[100:103], a[40:43], a[176:179], v[100:103]
M v[104:107], a[48:51], a[176:179], 0
M v[104:107], a[52:55], a[180:183], v[104:107]
M v[108:111], a[60:63], a[180:183], 0
M v[108:111], a[56:59], a[176:179], v[108:111]
s_waitcnt vmcnt(9) lgkmcnt(0)
s_barrier
ds_read_b128 a[160:163], v10 offset:16384
ds_read_b128 a[164:167], v11 offset:16384
M v[112:115], a[64:67], a[176:179], 0
s_add_u32 m0, s29, 49152
s_add_u32 s3, s23, s31
buffer_load_dwordx4 v2, s[8:11], s3 offen offset:0 lds
M v[112:115], a[68:71], a[180:183], v[112:115]
M v[116:119], a[76:79], a[180:183], 0
M v[116:119], a[72:75], a[176:179], v[116:119]
ds_read_b64_tr_b16 a[100:101], v12 offset:49152
ds_read_b64_tr_b16 a[102:103], v12 offset:51200
M v[120:123], a[80:83], a[176:179], 0
M v[120:123], a[84:87], a[180:183], v[120:123]
buffer_load_dwordx4 v3, s[8:11], s3 offen offset:1024 lds
M v[124:127], a[92:95], a[180:183], 0
M v[124:127], a[88:91], a[176:179], v[124:127]
M v[128:131], a[32:35], a[184:187], 0
M v[128:131], a[36:39], a[188:191], v[128:131]
ds_read_b128 a[168:171], v10 offset:18432
ds_read_b128 a[172:175], v11 offset:18432
ds_read_b64_tr_b16 a[108:109], v13 offset:49152
ds_read_b64_tr_b16 a[110:111], v13 offset:51200
M v[132:135], a[44:47], a[188:191], 0
M v[132:135], a[40:43], a[184:187], v[132:135]
buffer_load_dwordx4 v4, s[8:11], s3 offen offset:2048 lds
M v[136:139], a[48:51], a[184:187], 0
M v[136:139], a[52:55], a[188:191], v[136:139]
M v[140:143], a[60:63], a[188:191], 0
M v[140:143], a[56:59], a[184:187], v[140:143]
ds_read_b64_tr_b16 a[116:117], v14 offset:49152
ds_read_b64_tr_b16 a[118:119], v14 offset:51200
M v[144:147], a[64:67], a[184:187], 0
M v[144:147], a[68:71], a[188:191], v[144:147]
buffer_load_dwordx4 v5, s[8:11], s3 offen offset:3072 lds
M v[148:151], a[76:79], a[188:191], 0
M v[148:151], a[72:75], a[184:187], v[148:151]
M v[152:155], a[80:83], a[184:187], 0
M v[152:155], a[84:87], a[188:191], v[152:155]
ds_read_b64_tr_b16 a[124:125], v15 offset:49152
ds_read_b64_tr_b16 a[126:127], v15 offset:51200
M v[156:159], a[92:95], a[188:191], 0
s_add_u32 s23, s23, 128
s_cmp_eq_u32 s23, s25
s_cselect_b32 s23, s26, s23
M v[156:159], a[88:91], a[184:187], v[156:159]
s_waitcnt lgkmcnt(10)
M v[160:163], a[32:35], a[160:163], 0
M v[160:163], a[36:39], a[164:167], v[160:163]
ds_read_b128 a[176:179], v10 offset:20480
ds_read_b128 a[180:183], v11 offset:20480
M v[164:167], a[44:47], a[164:167], 0
M v[164:167], a[40:43], a[160:163], v[164:167]
ds_read_b64_tr_b16 a[132:133], v16 offset:49152
ds_read_b64_tr_b16 a[134:135], v16 offset:51200
M v[168:171], a[48:51], a[160:163], 0
M v[168:171], a[52:55], a[164:167], v[168:171]
s_add_u32 m0, s29, 81920
s_nop 0
buffer_load_dwordx4 v6, s[12:15], s24 offen offset:0 lds
M v[172:175], a[60:63], a[164:167], 0
M v[172:175], a[56:59], a[160:163], v[172:175]
M v[176:179], a[64:67], a[160:163], 0
M v[176:179], a[68:71], a[164:167], v[176:179]
ds_read_b64_tr_b16 a[140:141], v17 offset:49152
ds_read_b64_tr_b16 a[142:143], v17 offset:51200
M v[180:183], a[76:79], a[164:167], 0
M v[180:183], a[72:75], a[160:163], v[180:183]
buffer_load_dwordx4 v7, s[12:15], s24 offen offset:1024 lds
M v[184:187], a[80:83], a[160:163], 0
M v[184:187], a[84:87], a[164:167], v[184:187]
M v[188:191], a[92:95], a[164:167], 0
M v[188:191], a[88:91], a[160:163], v[188:191]
s_waitcnt lgkmcnt(12)
ds_read_b64_tr_b16 a[148:149], v18 offset:49152
ds_read_b64_tr_b16 a[150:151], v18 offset:51200
M v[192:195], a[32:35], a[168:171], 0
buffer_load_dwordx4 v8, s[12:15], s24 offen offset:2048 lds
M v[192:195], a[36:39], a[172:175], v[192:195]
ds_read_b128 a[184:187], v10 offset:22528
ds_read_b128 a[188:191], v11 offset:22528
M v[196:199], a[44:47], a[172:175], 0
M v[196:199], a[40:43], a[168:171], v[196:199]
M v[200:203], a[48:51], a[168:171], 0
M v[200:203], a[52:55], a[172:175], v[200:203]
ds_read_b64_tr_b16 a[156:157], v19 offset:49152
ds_read_b64_tr_b16 a[158:159], v19 offset:51200
M v[204:207], a[60:63], a[172:175], 0
buffer_load_dwordx4 v9, s[12:15], s24 offen offset:3072 lds
M v[204:207], a[56:59], a[168:171], v[204:207]
M v[208:211], a[64:67], a[168:171], 0
M v[208:211], a[68:71], a[172:175], v[208:211]
M v[212:215], a[76:79], a[172:175], 0
M v[212:215], a[72:75], a[168:171], v[212:215]
s_add_u32 s24, s24, 262144
s_cmp_eq_u32 s24, s27
s_cselect_b32 s24, s28, s24
s_sub_u32 s6, s6, 1
s_cmp_eq_u32 s6, 0
s_cselect_b64 s[12:13], s[64:65], s[12:13]
M v[216:219], a[80:83], a[168:171], 0
M v[216:219], a[84:87], a[172:175], v[216:219]
M v[220:223], a[92:95], a[172:175], 0
M v[220:223], a[88:91], a[168:171], v[220:223]
s_waitcnt lgkmcnt(10)
M v[224:227], a[32:35], a[176:179], 0
buffer_load_dword v21, v20, s[60:63], s54 offen
s_add_u32 s54, s54, 1048576
M v[224:227], a[36:39], a[180:183], v[224:227]
M v[228:231], a[44:47], a[180:183], 0
M v[228:231], a[40:43], a[176:179], v[228:231]
M v[232:235], a[48:51], a[176:179], 0
M v[232:235], a[52:55], a[180:183], v[232:235]
M v[236:239], a[60:63], a[180:183], 0
M v[236:239], a[56:59], a[176:179], v[236:239]
s_waitcnt vmcnt(9) lgkmcnt(0)
s_barrier
ds_read_b128 a[160:163], v10 offset:32768
ds_read_b128 a[164:167], v11 offset:32768
M v[240:243], a[64:67], a[176:179], 0
s_add_u32 m0, s29, 0
s_nop 0
buffer_load_dwordx4 v2, s[8:11], s23 offen offset:0 lds
M v[240:243], a[68:71], a[180:183], v[240:243]
M v[244:247], a[76:79], a[180:183], 0
M v[244:247], a[72:75], a[176:179], v[244:247]
M v[248:251], a[80:83], a[176:179], 0
M v[248:251], a[84:87], a[180:183], v[248:251]
buffer_load_dwordx4 v3, s[8:11], s23 offen offset:1024 lds
M v[252:255], a[92:95], a[180:183], 0
M v[252:255], a[88:91], a[176:179], v[252:255]
M a[0:3], a[32:35], a[184:187], 0
M a[0:3], a[36:39], a[188:191], a[0:3]
ds_read_b128 a[168:171], v10 offset:34816
ds_read_b128 a[172:175], v11 offset:34816
M a[4:7], a[44:47], a[188:191], 0
M a[4:7], a[40:43], a[184:187], a[4:7]
M a[8:11], a[48:51], a[184:187], 0
buffer_load_dwordx4 v4, s[8:11], s23 offen offset:2048 lds
M a[8:11], a[52:55], a[188:191], a[8:11]
M a[12:15], a[60:63], a[188:191], 0
M a[12:15], a[56:59], a[184:187], a[12:15]
M a[16:19], a[64:67], a[184:187], 0
M a[16:19], a[68:71], a[188:191], a[16:19]
buffer_load_dwordx4 v5, s[8:11], s23 offen offset:3072 lds
M a[20:23], a[76:79], a[188:191], 0
M a[20:23], a[72:75], a[184:187], a[20:23]
M a[24:27], a[80:83], a[184:187], 0
M a[24:27], a[84:87], a[188:191], a[24:27]
M a[28:31], a[92:95], a[188:191], 0
M a[28:31], a[88:91], a[184:187], a[28:31]
s_waitcnt lgkmcnt(2)
M v[32:35], a[96:99], a[160:163], v[32:35]
s_add_u32 m0, s29, 98304
s_nop 0
buffer_load_dwordx4 v6, s[12:15], s24 offen offset:0 lds
M v[32:35], a[100:103], a[164:167], v[32:35]
ds_read_b128 a[176:179], v10 offset:36864
ds_read_b128 a[180:183], v11 offset:36864
M v[36:39], a[108:111], a[164:167], v[36:39]
M v[36:39], a[104:107], a[160:163], v[36:39]
ds_read_b64_tr_b16 a[32:33], v12 offset:0
ds_read_b64_tr_b16 a[34:35], v12 offset:2048
M v[40:43], a[112:115], a[160:163], v[40:43]
M v[40:43], a[116:119], a[164:167], v[40:43]
M v[44:47], a[124:127], a[164:167], v[44:47]
M v[44:47], a[120:123], a[160:163], v[44:47]
ds_read_b64_tr_b16 a[40:41], v13 offset:0
ds_read_b64_tr_b16 a[42:43], v13 offset:2048
M v[48:51], a[128:131], a[160:163], v[48:51]
buffer_load_dwordx4 v7, s[12:15], s24 offen offset:1024 lds
M v[48:51], a[132:135], a[164:167], v[48:51]
M v[52:55], a[140:143], a[164:167], v[52:55]
M v[52:55], a[136:139], a[160:163], v[52:55]
ds_read_b64_tr_b16 a[48:49], v14 offset:0
ds_read_b64_tr_b16 a[50:51], v14 offset:2048
M v[56:59], a[144:147], a[160:163], v[56:59]
M v[56:59], a[148:151], a[164:167], v[56:59]
M v[60:63], a[156:159], a[164:167], v[60:63]
buffer_load_dwordx4 v8, s[12:15], s24 offen offset:2048 lds
M v[60:63], a[152:155], a[160:163], v[60:63]
s_waitcnt lgkmcnt(8)
ds_read_b64_tr_b16 a[56:57], v15 offset:0
ds_read_b64_tr_b16 a[58:59], v15 offset:2048
M v[64:67], a[96:99], a[168:171], v[64:67]
M v[64:67], a[100:103], a[172:175], v[64:67]
ds_read_b128 a[184:187], v10 offset:38912
ds_read_b128 a[188:191], v11 offset:38912
M v[68:71], a[108:111], a[172:175], v[68:71]
M v[68:71], a[104:107], a[168:171], v[68:71]
ds_read_b64_tr_b16 a[64:65], v16 offset:0
ds_read_b64_tr_b16 a[66:67], v16 offset:2048
M v[72:75], a[112:115], a[168:171], v[72:75]
M v[72:75], a[116:119], a[172:175], v[72:75]
M v[76:79], a[124:127], a[172:175], v[76:79]
M v[76:79], a[120:123], a[168:171], v[76:79]
ds_read_b64_tr_b16 a[72:73], v17 offset:0
ds_read_b64_tr_b16 a[74:75], v17 offset:2048
M v[80:83], a[128:131], a[168:171], v[80:83]
buffer_load_dwordx4 v9, s[12:15], s24 offen offset:3072 lds
M v[80:83], a[132:135], a[172:175], v[80:83]
M v[84:87], a[140:143], a[172:175], v[84:87]
M v[84:87], a[136:139], a[168:171], v[84:87]
ds_read_b64_tr_b16 a[80:81], v18 offset:0
ds_read_b64_tr_b16 a[82:83], v18 offset:2048
M v[88:91], a[144:147], a[168:171], v[88:91]
M v[88:91], a[148:151], a[172:175], v[88:91]
M v[92:95], a[156:159], a[172:175], v[92:95]
s_add_u32 s24, s24, 262144
M v[92:95], a[152:155], a[168:171], v[92:95]
s_waitcnt lgkmcnt(15)
ds_read_b64_tr_b16 a[88:89], v19 offset:0
ds_read_b64_tr_b16 a[90:91], v19 offset:2048
M v[96:99], a[96:99], a[176:179], v[96:99]
M v[96:99], a[100:103], a[180:183], v[96:99]
M v[100:103], a[108:111], a[180:183], v[100:103]
M v[100:103], a[104:107], a[176:179], v[100:103]
M v[104:107], a[112:115], a[176:179], v[104:107]
M v[104:107], a[116:119], a[180:183], v[104:107]
M v[108:111], a[124:127], a[180:183], v[108:111]
M v[108:111], a[120:123], a[176:179], v[108:111]
s_waitcnt vmcnt(9) lgkmcnt(0)
s_barrier
ds_read_b128 a[160:163], v10 offset:49152
ds_read_b128 a[164:167], v11 offset:49152
M v[112:115], a[128:131], a[176:179], v[112:115]
s_add_u32 m0, s29, 16384
s_add_u32 s3, s23, s31
buffer_load_dwordx4 v2, s[8:11], s3 offen offset:0 lds
M v[112:115], a[132:135], a[180:183], v[112:115]
M v[116:119], a[140:143], a[180:183], v[116:119]
M v[116:119], a[136:139], a[176:179], v[116:119]
ds_read_b64_tr_b16 a[36:37], v12 offset:16384
ds_read_b64_tr_b16 a[38:39], v12 offset:18432
M v[120:123], a[144:147], a[176:179], v[120:123]
M v[120:123], a[148:151], a[180:183], v[120:123]
buffer_load_dwordx4 v3, s[8:11], s3 offen offset:1024 lds
M v[124:127], a[156:159], a[180:183], v[124:127]
M v[124:127], a[152:155], a[176:179], v[124:127]
M v[128:131], a[96:99], a[184:187], v[128:131]
M v[128:131], a[100:103], a[188:191], v[128:131]
ds_read_b128 a[168:171], v10 offset:51200
ds_read_b128 a[172:175], v11 offset:51200
ds_read_b64_tr_b16 a[44:45], v13 offset:16384
ds_read_b64_tr_b16 a[46:47], v13 offset:18432
M v[132:135], a[108:111], a[188:191], v[132:135]
M v[132:135], a[104:107], a[184:187], v[132:135]
buffer_load_dwordx4 v4, s[8:11], s3 offen offset:2048 lds
M v[136:139], a[112:115], a[184:187], v[136:139]
M v[136:139], a[116:119], a[188:191], v[136:139]
M v[140:143], a[124:127], a[188:191], v[140:143]
M v[140:143], a[120:123], a[184:187], v[140:143]
ds_read_b64_tr_b16 a[52:53], v14 offset:16384
ds_read_b64_tr_b16 a[54:55], v14 offset:18432
M v[144:147], a[128:131], a[184:187], v[144:147]
M v[144:147], a[132:135], a[188:191], v[144:147]
buffer_load_dwordx4 v5, s[8:11], s3 offen offset:3072 lds
M v[148:151], a[140:143], a[188:191], v[148:151]
M v[148:151], a[136:139], a[184:187], v[148:151]
M v[152:155], a[144:147], a[184:187], v[152:155]
M v[152:155], a[148:151], a[188:191], v[152:155]
ds_read_b64_tr_b16 a[60:61], v15 offset:16384
ds_read_b64_tr_b16 a[62:63], v15 offset:18432
M v[156:159], a[156:159], a[188:191], v[156:159]
s_add_u32 s23, s23, 128
s_cmp_eq_u32 s23, s25
s_cselect_b32 s23, s26, s23
M v[156:159], a[152:155], a[184:187], v[156:159]
s_waitcnt lgkmcnt(10)
M v[160:163], a[96:99], a[160:163], v[160:163]
M v[160:163], a[100:103], a[164:167], v[160:163]
ds_read_b128 a[176:179], v10 offset:53248
ds_read_b128 a[180:183], v11 offset:53248
M v[164:167], a[108:111], a[164:167], v[164:167]
M v[164:167], a[104:107], a[160:163], v[164:167]
ds_read_b64_tr_b16 a[68:69], v16 offset:16384
ds_read_b64_tr_b16 a[70:71], v16 offset:18432
M v[168:171], a[112:115], a[160:163], v[168:171]
M v[168:171], a[116:119], a[164:167], v[168:171]
s_add_u32 m0, s29, 114688
s_nop 0
buffer_load_dwordx4 v6, s[12:15], s24 offen offset:0 lds
M v[172:175], a[124:127], a[164:167], v[172:175]
M v[172:175], a[120:123], a[160:163], v[172:175]
M v[176:179], a[128:131], a[160:163], v[176:179]
M v[176:179], a[132:135], a[164:167], v[176:179]
ds_read_b64_tr_b16 a[76:77], v17 offset:16384
ds_read_b64_tr_b16 a[78:79], v17 offset:18432
M v[180:183], a[140:143], a[164:167], v[180:183]
M v[180:183], a[136:139], a[160:163], v[180:183]
buffer_load_dwordx4 v7, s[12:15], s24 offen offset:1024 lds
M v[184:187], a[144:147], a[160:163], v[184:187]
M v[184:187], a[148:151], a[164:167], v[184:187]
M v[188:191], a[156:159], a[164:167], v[188:191]
M v[188:191], a[152:155], a[160:163], v[188:191]
s_waitcnt lgkmcnt(12)
ds_read_b64_tr_b16 a[84:85], v18 offset:16384
ds_read_b64_tr_b16 a[86:87], v18 offset:18432
M v[192:195], a[96:99], a[168:171], v[192:195]
buffer_load_dwordx4 v8, s[12:15], s24 offen offset:2048 lds
M v[192:195], a[100:103], a[172:175], v[192:195]
ds_read_b128 a[184:187], v10 offset:55296
ds_read_b128 a[188:191], v11 offset:55296
M v[196:199], a[108:111], a[172:175], v[196:199]
M v[196:199], a[104:107], a[168:171], v[196:199]
M v[200:203], a[112:115], a[168:171], v[200:203]
M v[200:203], a[116:119], a[172:175], v[200:203]
ds_read_b64_tr_b16 a[92:93], v19 offset:16384
ds_read_b64_tr_b16 a[94:95], v19 offset:18432
M v[204:207], a[124:127], a[172:175], v[204:207]
buffer_load_dwordx4 v9, s[12:15], s24 offen offset:3072 lds
M v[204:207], a[120:123], a[168:171], v[204:207]
M v[208:211], a[128:131], a[168:171], v[208:211]
M v[208:211], a[132:135], a[172:175], v[208:211]
M v[212:215], a[140:143], a[172:175], v[212:215]
M v[212:215], a[136:139], a[168:171], v[212:215]
s_add_u32 s24, s24, 262144
s_cmp_eq_u32 s24, s27
s_cselect_b32 s24, s28, s24
s_sub_u32 s6, s6, 1
s_cmp_eq_u32 s6, 0
s_cselect_b64 s[12:13], s[64:65], s[12:13]
M v[216:219], a[144:147], a[168:171], v[216:219]
M v[216:219], a[148:151], a[172:175], v[216:219]
M v[220:223], a[156:159], a[172:175], v[220:223]
M v[220:223], a[152:155], a[168:171], v[220:223]
s_waitcnt lgkmcnt(10)
M v[224:227], a[96:99], a[176:179], v[224:227]
buffer_load_dword v21, v20, s[60:63], s54 offen
s_add_u32 s54, s54, 1048576
M v[224:227], a[100:103], a[180:183], v[224:227]
M v[228:231], a[108:111], a[180:183], v[228:231]
M v[228:231], a[104:107], a[176:179], v[228:231]
M v[232:235], a[112:115], a[176:179], v[232:235]
M v[232:235], a[116:119], a[180:183], v[232:235]
M v[236:239], a[124:127], a[180:183], v[236:239]
M v[236:239], a[120:123], a[176:179], v[236:239]
s_waitcnt vmcnt(9) lgkmcnt(0)
s_barrier
ds_read_b128 a[160:163], v10 offset:0
ds_read_b128 a[164:167], v11 offset:0
M v[240:243], a[128:131], a[176:179], v[240:243]
s_add_u32 m0, s29, 32768
s_nop 0
buffer_load_dwordx4 v2, s[8:11], s23 offen offset:0 lds
M v[240:243], a[132:135], a[180:183], v[240:243]
M v[244:247], a[140:143], a[180:183], v[244:247]
M v[244:247], a[136:139], a[176:179], v[244:247]
M v[248:251], a[144:147], a[176:179], v[248:251]
M v[248:251], a[148:151], a[180:183], v[248:251]
buffer_load_dwordx4 v3, s[8:11], s23 offen offset:1024 lds
M v[252:255], a[156:159], a[180:183], v[252:255]
M v[252:255], a[152:155], a[176:179], v[252:255]
M a[0:3], a[96:99], a[184:187], a[0:3]
M a[0:3], a[100:103], a[188:191], a[0:3]
ds_read_b128 a[168:171], v10 offset:2048
ds_read_b128 a[172:175], v11 offset:2048
M a[4:7], a[108:111], a[188:191], a[4:7]
M a[4:7], a[104:107], a[184:187], a[4:7]
M a[8:11], a[112:115], a[184:187], a[8:11]
buffer_load_dwordx4 v4, s[8:11], s23 offen offset:2048 lds
M a[8:11], a[116:119], a[188:191], a[8:11]
M a[12:15], a[124:127], a[188:191], a[12:15]
M a[12:15], a[120:123], a[184:187], a[12:15]
M a[16:19], a[128:131], a[184:187], a[16:19]
M a[16:19], a[132:135], a[188:191], a[16:19]
buffer_load_dwordx4 v5, s[8:11], s23 offen offset:3072 lds
M a[20:23], a[140:143], a[188:191], a[20:23]
M a[20:23], a[136:139], a[184:187], a[20:23]
M a[24:27], a[144:147], a[184:187], a[24:27]
M a[24:27], a[148:151], a[188:191], a[24:27]
M a[28:31], a[156:159], a[188:191], a[28:31]
M a[28:31], a[152:155], a[184:187], a[28:31]
s_waitcnt lgkmcnt(2)
s_mov_b32 s30, 5
Lk1_ql:
M v[32:35], a[32:35], a[160:163], v[32:35]
s_add_u32 m0, s29, 65536
s_nop 0
buffer_load_dwordx4 v6, s[12:15], s24 offen offset:0 lds
M v[32:35], a[36:39], a[164:167], v[32:35]
ds_read_b128 a[176:179], v10 offset:4096
ds_read_b128 a[180:183], v11 offset:4096
M v[36:39], a[44:47], a[164:167], v[36:39]
M v[36:39], a[40:43], a[160:163], v[36:39]
ds_read_b64_tr_b16 a[96:97], v12 offset:32768
ds_read_b64_tr_b16 a[98:99], v12 offset:34816
M v[40:43], a[48:51], a[160:163], v[40:43]
M v[40:43], a[52:55], a[164:167], v[40:43]
M v[44:47], a[60:63], a[164:167], v[44:47]
M v[44:47], a[56:59], a[160:163], v[44:47]
ds_read_b64_tr_b16 a[104:105], v13 offset:32768
ds_read_b64_tr_b16 a[106:107], v13 offset:34816
M v[48:51], a[64:67], a[160:163], v[48:51]
buffer_load_dwordx4 v7, s[12:15], s24 offen offset:1024 lds
M v[48:51], a[68:71], a[164:167], v[48:51]
M v[52:55], a[76:79], a[164:167], v[52:55]
M v[52:55], a[72:75], a[160:163], v[52:55]
ds_read_b64_tr_b16 a[112:113], v14 offset:32768
ds_read_b64_tr_b16 a[114:115], v14 offset:34816
M v[56:59], a[80:83], a[160:163], v[56:59]
M v[56:59], a[84:87], a[164:167], v[56:59]
M v[60:63], a[92:95], a[164:167], v[60:63]
buffer_load_dwordx4 v8, s[12:15], s24 offen offset:2048 lds
M v[60:63], a[88:91], a[160:163], v[60:63]
s_waitcnt lgkmcnt(8)
ds_read_b64_tr_b16 a[120:121], v15 offset:32768
ds_read_b64_tr_b16 a[122:123], v15 offset:34816
M v[64:67], a[32:35], a[168:171], v[64:67]
M v[64:67], a[36:39], a[172:175], v[64:67]
ds_read_b128 a[184:187], v10 offset:6144
ds_read_b128 a[188:191], v11 offset:6144
M v[68:71], a[44:47], a[172:175], v[68:71]
M v[68:71], a[40:43], a[168:171], v[68:71]
ds_read_b64_tr_b16 a[128:129], v16 offset:32768
ds_read_b64_tr_b16 a[130:131], v16 offset:34816
M v[72:75], a[48:51], a[168:171], v[72:75]
M v[72:75], a[52:55], a[172:175], v[72:75]
M v[76:79], a[60:63], a[172:175], v[76:79]
M v[76:79], a[56:59], a[168:171], v[76:79]
ds_read_b64_tr_b16 a[136:137], v17 offset:32768
ds_read_b64_tr_b16 a[138:139], v17 offset:34816
M v[80:83], a[64:67], a[168:171], v[80:83]
buffer_load_dwordx4 v9, s[12:15], s24 offen offset:3072 lds
M v[80:83], a[68:71], a[172:175], v[80:83]
M v[84:87], a[76:79], a[172:175], v[84:87]
M v[84:87], a[72:75], a[168:171], v[84:87]
ds_read_b64_tr_b16 a[144:145], v18 offset:32768
ds_read_b64_tr_b16 a[146:147], v18 offset:34816
M v[88:91], a[80:83], a[168:171], v[88:91]
M v[88:91], a[84:87], a[172:175], v[88:91]
M v[92:95], a[92:95], a[172:175], v[92:95]
s_add_u32 s24, s24, 262144
M v[92:95], a[88:91], a[168:171], v[92:95]
s_waitcnt lgkmcnt(15)
ds_read_b64_tr_b16 a[152:153], v19 offset:32768
ds_read_b64_tr_b16 a[154:155], v19 offset:34816
M v[96:99], a[32:35], a[176:179], v[96:99]
M v[96:99], a[36:39], a[180:183], v[96:99]
M v[100:103], a[44:47], a[180:183], v[100:103]
M v[100:103], a[40:43], a[176:179], v[100:103]
M v[104:107], a[48:51], a[176:179], v[104:107]
M v[104:107], a[52:55], a[180:183], v[104:107]
M v[108:111], a[60:63], a[180:183], v[108:111]
M v[108:111], a[56:59], a[176:179], v[108:111]
s_waitcnt vmcnt(9) lgkmcnt(0)
s_barrier
ds_read_b128 a[160:163], v10 offset:16384
ds_read_b128 a[164:167], v11 offset:16384
M v[112:115], a[64:67], a[176:179], v[112:115]
s_add_u32 m0, s29, 49152
s_add_u32 s3, s23, s31
buffer_load_dwordx4 v2, s[8:11], s3 offen offset:0 lds
M v[112:115], a[68:71], a[180:183], v[112:115]
M v[116:119], a[76:79], a[180:183], v[116:119]
M v[116:119], a[72:75], a[176:179], v[116:119]
ds_read_b64_tr_b16 a[100:101], v12 offset:49152
ds_read_b64_tr_b16 a[102:103], v12 offset:51200
M v[120:123], a[80:83], a[176:179], v[120:123]
M v[120:123], a[84:87], a[180:183], v[120:123]
buffer_load_dwordx4 v3, s[8:11], s3 offen offset:1024 lds
M v[124:127], a[92:95], a[180:183], v[124:127]
M v[124:127], a[88:91], a[176:179], v[124:127]
M v[128:131], a[32:35], a[184:187], v[128:131]
M v[128:131], a[36:39], a[188:191], v[128:131]
ds_read_b128 a[168:171], v10 offset:18432
ds_read_b128 a[172:175], v11 offset:18432
ds_read_b64_tr_b16 a[108:109], v13 offset:49152
ds_read_b64_tr_b16 a[110:111], v13 offset:51200
M v[132:135], a[44:47], a[188:191], v[132:135]
M v[132:135], a[40:43], a[184:187], v[132:135]
buffer_load_dwordx4 v4, s[8:11], s3 offen offset:2048 lds
M v[136:139], a[48:51], a[184:187], v[136:139]
M v[136:139], a[52:55], a[188:191], v[136:139]
M v[140:143], a[60:63], a[188:191], v[140:143]
M v[140:143], a[56:59], a[184:187], v[140:143]
ds_read_b64_tr_b16 a[116:117], v14 offset:49152
ds_read_b64_tr_b16 a[118:119], v14 offset:51200
M v[144:147], a[64:67], a[184:187], v[144:147]
M v[144:147], a[68:71], a[188:191], v[144:147]
buffer_load_dwordx4 v5, s[8:11], s3 offen offset:3072 lds
M v[148:151], a[76:79], a[188:191], v[148:151]
M v[148:151], a[72:75], a[184:187], v[148:151]
M v[152:155], a[80:83], a[184:187], v[152:155]
M v[152:155], a[84:87], a[188:191], v[152:155]
ds_read_b64_tr_b16 a[124:125], v15 offset:49152
ds_read_b64_tr_b16 a[126:127], v15 offset:51200
M v[156:159], a[92:95], a[188:191], v[156:159]
s_add_u32 s23, s23, 128
s_cmp_eq_u32 s23, s25
s_cselect_b32 s23, s26, s23
M v[156:159], a[88:91], a[184:187], v[156:159]
s_waitcnt lgkmcnt(10)
M v[160:163], a[32:35], a[160:163], v[160:163]
M v[160:163], a[36:39], a[164:167], v[160:163]
ds_read_b128 a[176:179], v10 offset:20480
ds_read_b128 a[180:183], v11 offset:20480
M v[164:167], a[44:47], a[164:167], v[164:167]
M v[164:167], a[40:43], a[160:163], v[164:167]
ds_read_b64_tr_b16 a[132:133], v16 offset:49152
ds_read_b64_tr_b16 a[134:135], v16 offset:51200
M v[168:171], a[48:51], a[160:163], v[168:171]
M v[168:171], a[52:55], a[164:167], v[168:171]
s_add_u32 m0, s29, 81920
s_nop 0
buffer_load_dwordx4 v6, s[12:15], s24 offen offset:0 lds
M v[172:175], a[60:63], a[164:167], v[172:175]
M v[172:175], a[56:59], a[160:163], v[172:175]
M v[176:179], a[64:67], a[160:163], v[176:179]
M v[176:179], a[68:71], a[164:167], v[176:179]
ds_read_b64_tr_b16 a[140:141], v17 offset:49152
ds_read_b64_tr_b16 a[142:143], v17 offset:51200
M v[180:183], a[76:79], a[164:167], v[180:183]
M v[180:183], a[72:75], a[160:163], v[180:183]
buffer_load_dwordx4 v7, s[12:15], s24 offen offset:1024 lds
M v[184:187], a[80:83], a[160:163], v[184:187]
M v[184:187], a[84:87], a[164:167], v[184:187]
M v[188:191], a[92:95], a[164:167], v[188:191]
M v[188:191], a[88:91], a[160:163], v[188:191]
s_waitcnt lgkmcnt(12)
ds_read_b64_tr_b16 a[148:149], v18 offset:49152
ds_read_b64_tr_b16 a[150:151], v18 offset:51200
M v[192:195], a[32:35], a[168:171], v[192:195]
buffer_load_dwordx4 v8, s[12:15], s24 offen offset:2048 lds
M v[192:195], a[36:39], a[172:175], v[192:195]
ds_read_b128 a[184:187], v10 offset:22528
ds_read_b128 a[188:191], v11 offset:22528
M v[196:199], a[44:47], a[172:175], v[196:199]
M v[196:199], a[40:43], a[168:171], v[196:199]
M v[200:203], a[48:51], a[168:171], v[200:203]
M v[200:203], a[52:55], a[172:175], v[200:203]
ds_read_b64_tr_b16 a[156:157], v19 offset:49152
ds_read_b64_tr_b16 a[158:159], v19 offset:51200
M v[204:207], a[60:63], a[172:175], v[204:207]
buffer_load_dwordx4 v9, s[12:15], s24 offen offset:3072 lds
M v[204:207], a[56:59], a[168:171], v[204:207]
M v[208:211], a[64:67], a[168:171], v[208:211]
M v[208:211], a[68:71], a[172:175], v[208:211]
M v[212:215], a[76:79], a[172:175], v[212:215]
M v[212:215], a[72:75], a[168:171], v[212:215]
s_add_u32 s24, s24, 262144
s_cmp_eq_u32 s24, s27
s_cselect_b32 s24, s28, s24
s_sub_u32 s6, s6, 1
s_cmp_eq_u32 s6, 0
s_cselect_b64 s[12:13], s[64:65], s[12:13]
M v[216:219], a[80:83], a[168:171], v[216:219]
M v[216:219], a[84:87], a[172:175], v[216:219]
M v[220:223], a[92:95], a[172:175], v[220:223]
M v[220:223], a[88:91], a[168:171], v[220:223]
s_waitcnt lgkmcnt(10)
M v[224:227], a[32:35], a[176:179], v[224:227]
buffer_load_dword v21, v20, s[60:63], s54 offen
s_add_u32 s54, s54, 1048576
M v[224:227], a[36:39], a[180:183], v[224:227]
M v[228:231], a[44:47], a[180:183], v[228:231]
M v[228:231], a[40:43], a[176:179], v[228:231]
M v[232:235], a[48:51], a[176:179], v[232:235]
M v[232:235], a[52:55], a[180:183], v[232:235]
M v[236:239], a[60:63], a[180:183], v[236:239]
M v[236:239], a[56:59], a[176:179], v[236:239]
s_waitcnt vmcnt(9) lgkmcnt(0)
s_barrier
ds_read_b128 a[160:163], v10 offset:32768
ds_read_b128 a[164:167], v11 offset:32768
M v[240:243], a[64:67], a[176:179], v[240:243]
s_add_u32 m0, s29, 0
s_nop 0
buffer_load_dwordx4 v2, s[8:11], s23 offen offset:0 lds
M v[240:243], a[68:71], a[180:183], v[240:243]
M v[244:247], a[76:79], a[180:183], v[244:247]
M v[244:247], a[72:75], a[176:179], v[244:247]
M v[248:251], a[80:83], a[176:179], v[248:251]
M v[248:251], a[84:87], a[180:183], v[248:251]
buffer_load_dwordx4 v3, s[8:11], s23 offen offset:1024 lds
M v[252:255], a[92:95], a[180:183], v[252:255]
M v[252:255], a[88:91], a[176:179], v[252:255]
M a[0:3], a[32:35], a[184:187], a[0:3]
M a[0:3], a[36:39], a[188:191], a[0:3]
ds_read_b128 a[168:171], v10 offset:34816
ds_read_b128 a[172:175], v11 offset:34816
M a[4:7], a[44:47], a[188:191], a[4:7]
M a[4:7], a[40:43], a[184:187], a[4:7]
M a[8:11], a[48:51], a[184:187], a[8:11]
buffer_load_dwordx4 v4, s[8:11], s23 offen offset:2048 lds
M a[8:11], a[52:55], a[188:191], a[8:11]
M a[12:15], a[60:63], a[188:191], a[12:15]
M a[12:15], a[56:59], a[184:187], a[12:15]
M a[16:19], a[64:67], a[184:187], a[16:19]
M a[16:19], a[68:71], a[188:191], a[16:19]
buffer_load_dwordx4 v5, s[8:11], s23 offen offset:3072 lds
M a[20:23], a[76:79], a[188:191], a[20:23]
M a[20:23], a[72:75], a[184:187], a[20:23]
M a[24:27], a[80:83], a[184:187], a[24:27]
M a[24:27], a[84:87], a[188:191], a[24:27]
M a[28:31], a[92:95], a[188:191], a[28:31]
M a[28:31], a[88:91], a[184:187], a[28:31]
s_waitcnt lgkmcnt(2)
M v[32:35], a[96:99], a[160:163], v[32:35]
s_add_u32 m0, s29, 98304
s_nop 0
buffer_load_dwordx4 v6, s[12:15], s24 offen offset:0 lds
M v[32:35], a[100:103], a[164:167], v[32:35]
ds_read_b128 a[176:179], v10 offset:36864
ds_read_b128 a[180:183], v11 offset:36864
M v[36:39], a[108:111], a[164:167], v[36:39]
M v[36:39], a[104:107], a[160:163], v[36:39]
ds_read_b64_tr_b16 a[32:33], v12 offset:0
ds_read_b64_tr_b16 a[34:35], v12 offset:2048
M v[40:43], a[112:115], a[160:163], v[40:43]
M v[40:43], a[116:119], a[164:167], v[40:43]
M v[44:47], a[124:127], a[164:167], v[44:47]
M v[44:47], a[120:123], a[160:163], v[44:47]
ds_read_b64_tr_b16 a[40:41], v13 offset:0
ds_read_b64_tr_b16 a[42:43], v13 offset:2048
M v[48:51], a[128:131], a[160:163], v[48:51]
buffer_load_dwordx4 v7, s[12:15], s24 offen offset:1024 lds
M v[48:51], a[132:135], a[164:167], v[48:51]
M v[52:55], a[140:143], a[164:167], v[52:55]
M v[52:55], a[136:139], a[160:163], v[52:55]
ds_read_b64_tr_b16 a[48:49], v14 offset:0
ds_read_b64_tr_b16 a[50:51], v14 offset:2048
M v[56:59], a[144:147], a[160:163], v[56:59]
M v[56:59], a[148:151], a[164:167], v[56:59]
M v[60:63], a[156:159], a[164:167], v[60:63]
buffer_load_dwordx4 v8, s[12:15], s24 offen offset:2048 lds
M v[60:63], a[152:155], a[160:163], v[60:63]
s_waitcnt lgkmcnt(8)
ds_read_b64_tr_b16 a[56:57], v15 offset:0
ds_read_b64_tr_b16 a[58:59], v15 offset:2048
M v[64:67], a[96:99], a[168:171], v[64:67]
M v[64:67], a[100:103], a[172:175], v[64:67]
ds_read_b128 a[184:187], v10 offset:38912
ds_read_b128 a[188:191], v11 offset:38912
M v[68:71], a[108:111], a[172:175], v[68:71]
M v[68:71], a[104:107], a[168:171], v[68:71]
ds_read_b64_tr_b16 a[64:65], v16 offset:0
ds_read_b64_tr_b16 a[66:67], v16 offset:2048
M v[72:75], a[112:115], a[168:171], v[72:75]
M v[72:75], a[116:119], a[172:175], v[72:75]
M v[76:79], a[124:127], a[172:175], v[76:79]
M v[76:79], a[120:123], a[168:171], v[76:79]
ds_read_b64_tr_b16 a[72:73], v17 offset:0
ds_read_b64_tr_b16 a[74:75], v17 offset:2048
M v[80:83], a[128:131], a[168:171], v[80:83]
buffer_load_dwordx4 v9, s[12:15], s24 offen offset:3072 lds
M v[80:83], a[132:135], a[172:175], v[80:83]
M v[84:87], a[140:143], a[172:175], v[84:87]
M v[84:87], a[136:139], a[168:171], v[84:87]
ds_read_b64_tr_b16 a[80:81], v18 offset:0
ds_read_b64_tr_b16 a[82:83], v18 offset:2048
M v[88:91], a[144:147], a[168:171], v[88:91]
M v[88:91], a[148:151], a[172:175], v[88:91]
M v[92:95], a[156:159], a[172:175], v[92:95]
s_add_u32 s24, s24, 262144
M v[92:95], a[152:155], a[168:171], v[92:95]
s_waitcnt lgkmcnt(15)
ds_read_b64_tr_b16 a[88:89], v19 offset:0
ds_read_b64_tr_b16 a[90:91], v19 offset:2048
M v[96:99], a[96:99], a[176:179], v[96:99]
M v[96:99], a[100:103], a[180:183], v[96:99]
M v[100:103], a[108:111], a[180:183], v[100:103]
M v[100:103], a[104:107], a[176:179], v[100:103]
M v[104:107], a[112:115], a[176:179], v[104:107]
M v[104:107], a[116:119], a[180:183], v[104:107]
M v[108:111], a[124:127], a[180:183], v[108:111]
M v[108:111], a[120:123], a[176:179], v[108:111]
s_waitcnt vmcnt(9) lgkmcnt(0)
s_barrier
ds_read_b128 a[160:163], v10 offset:49152
ds_read_b128 a[164:167], v11 offset:49152
M v[112:115], a[128:131], a[176:179], v[112:115]
s_add_u32 m0, s29, 16384
s_add_u32 s3, s23, s31
buffer_load_dwordx4 v2, s[8:11], s3 offen offset:0 lds
M v[112:115], a[132:135], a[180:183], v[112:115]
M v[116:119], a[140:143], a[180:183], v[116:119]
M v[116:119], a[136:139], a[176:179], v[116:119]
ds_read_b64_tr_b16 a[36:37], v12 offset:16384
ds_read_b64_tr_b16 a[38:39], v12 offset:18432
M v[120:123], a[144:147], a[176:179], v[120:123]
M v[120:123], a[148:151], a[180:183], v[120:123]
buffer_load_dwordx4 v3, s[8:11], s3 offen offset:1024 lds
M v[124:127], a[156:159], a[180:183], v[124:127]
M v[124:127], a[152:155], a[176:179], v[124:127]
M v[128:131], a[96:99], a[184:187], v[128:131]
M v[128:131], a[100:103], a[188:191], v[128:131]
ds_read_b128 a[168:171], v10 offset:51200
ds_read_b128 a[172:175], v11 offset:51200
ds_read_b64_tr_b16 a[44:45], v13 offset:16384
ds_read_b64_tr_b16 a[46:47], v13 offset:18432
M v[132:135], a[108:111], a[188:191], v[132:135]
M v[132:135], a[104:107], a[184:187], v[132:135]
buffer_load_dwordx4 v4, s[8:11], s3 offen offset:2048 lds
M v[136:139], a[112:115], a[184:187], v[136:139]
M v[136:139], a[116:119], a[188:191], v[136:139]
M v[140:143], a[124:127], a[188:191], v[140:143]
M v[140:143], a[120:123], a[184:187], v[140:143]
ds_read_b64_tr_b16 a[52:53], v14 offset:16384
ds_read_b64_tr_b16 a[54:55], v14 offset:18432
M v[144:147], a[128:131], a[184:187], v[144:147]
M v[144:147], a[132:135], a[188:191], v[144:147]
buffer_load_dwordx4 v5, s[8:11], s3 offen offset:3072 lds
M v[148:151], a[140:143], a[188:191], v[148:151]
M v[148:151], a[136:139], a[184:187], v[148:151]
M v[152:155], a[144:147], a[184:187], v[152:155]
M v[152:155], a[148:151], a[188:191], v[152:155]
ds_read_b64_tr_b16 a[60:61], v15 offset:16384
ds_read_b64_tr_b16 a[62:63], v15 offset:18432
M v[156:159], a[156:159], a[188:191], v[156:159]
s_add_u32 s23, s23, 128
s_cmp_eq_u32 s23, s25
s_cselect_b32 s23, s26, s23
M v[156:159], a[152:155], a[184:187], v[156:159]
s_waitcnt lgkmcnt(10)
M v[160:163], a[96:99], a[160:163], v[160:163]
M v[160:163], a[100:103], a[164:167], v[160:163]
ds_read_b128 a[176:179], v10 offset:53248
ds_read_b128 a[180:183], v11 offset:53248
M v[164:167], a[108:111], a[164:167], v[164:167]
M v[164:167], a[104:107], a[160:163], v[164:167]
ds_read_b64_tr_b16 a[68:69], v16 offset:16384
ds_read_b64_tr_b16 a[70:71], v16 offset:18432
M v[168:171], a[112:115], a[160:163], v[168:171]
M v[168:171], a[116:119], a[164:167], v[168:171]
s_add_u32 m0, s29, 114688
s_nop 0
buffer_load_dwordx4 v6, s[12:15], s24 offen offset:0 lds
M v[172:175], a[124:127], a[164:167], v[172:175]
M v[172:175], a[120:123], a[160:163], v[172:175]
M v[176:179], a[128:131], a[160:163], v[176:179]
M v[176:179], a[132:135], a[164:167], v[176:179]
ds_read_b64_tr_b16 a[76:77], v17 offset:16384
ds_read_b64_tr_b16 a[78:79], v17 offset:18432
M v[180:183], a[140:143], a[164:167], v[180:183]
M v[180:183], a[136:139], a[160:163], v[180:183]
buffer_load_dwordx4 v7, s[12:15], s24 offen offset:1024 lds
M v[184:187], a[144:147], a[160:163], v[184:187]
M v[184:187], a[148:151], a[164:167], v[184:187]
M v[188:191], a[156:159], a[164:167], v[188:191]
M v[188:191], a[152:155], a[160:163], v[188:191]
s_waitcnt lgkmcnt(12)
ds_read_b64_tr_b16 a[84:85], v18 offset:16384
ds_read_b64_tr_b16 a[86:87], v18 offset:18432
M v[192:195], a[96:99], a[168:171], v[192:195]
buffer_load_dwordx4 v8, s[12:15], s24 offen offset:2048 lds
M v[192:195], a[100:103], a[172:175], v[192:195]
ds_read_b128 a[184:187], v10 offset:55296
ds_read_b128 a[188:191], v11 offset:55296
M v[196:199], a[108:111], a[172:175], v[196:199]
M v[196:199], a[104:107], a[168:171], v[196:199]
M v[200:203], a[112:115], a[168:171], v[200:203]
M v[200:203], a[116:119], a[172:175], v[200:203]
ds_read_b64_tr_b16 a[92:93], v19 offset:16384
ds_read_b64_tr_b16 a[94:95], v19 offset:18432
M v[204:207], a[124:127], a[172:175], v[204:207]
buffer_load_dwordx4 v9, s[12:15], s24 offen offset:3072 lds
M v[204:207], a[120:123], a[168:171], v[204:207]
M v[208:211], a[128:131], a[168:171], v[208:211]
M v[208:211], a[132:135], a[172:175], v[208:211]
M v[212:215], a[140:143], a[172:175], v[212:215]
M v[212:215], a[136:139], a[168:171], v[212:215]
s_add_u32 s24, s24, 262144
s_cmp_eq_u32 s24, s27
s_cselect_b32 s24, s28, s24
s_sub_u32 s6, s6, 1
s_cmp_eq_u32 s6, 0
s_cselect_b64 s[12:13], s[64:65], s[12:13]
M v[216:219], a[144:147], a[168:171], v[216:219]
M v[216:219], a[148:151], a[172:175], v[216:219]
M v[220:223], a[156:159], a[172:175], v[220:223]
M v[220:223], a[152:155], a[168:171], v[220:223]
s_waitcnt lgkmcnt(10)
M v[224:227], a[96:99], a[176:179], v[224:227]
buffer_load_dword v21, v20, s[60:63], s54 offen
s_add_u32 s54, s54, 1048576
M v[224:227], a[100:103], a[180:183], v[224:227]
M v[228:231], a[108:111], a[180:183], v[228:231]
M v[228:231], a[104:107], a[176:179], v[228:231]
M v[232:235], a[112:115], a[176:179], v[232:235]
M v[232:235], a[116:119], a[180:183], v[232:235]
M v[236:239], a[124:127], a[180:183], v[236:239]
M v[236:239], a[120:123], a[176:179], v[236:239]
s_waitcnt vmcnt(9) lgkmcnt(0)
s_barrier
ds_read_b128 a[160:163], v10 offset:0
ds_read_b128 a[164:167], v11 offset:0
M v[240:243], a[128:131], a[176:179], v[240:243]
s_add_u32 m0, s29, 32768
s_nop 0
buffer_load_dwordx4 v2, s[8:11], s23 offen offset:0 lds
M v[240:243], a[132:135], a[180:183], v[240:243]
M v[244:247], a[140:143], a[180:183], v[244:247]
M v[244:247], a[136:139], a[176:179], v[244:247]
M v[248:251], a[144:147], a[176:179], v[248:251]
M v[248:251], a[148:151], a[180:183], v[248:251]
buffer_load_dwordx4 v3, s[8:11], s23 offen offset:1024 lds
M v[252:255], a[156:159], a[180:183], v[252:255]
M v[252:255], a[152:155], a[176:179], v[252:255]
M a[0:3], a[96:99], a[184:187], a[0:3]
M a[0:3], a[100:103], a[188:191], a[0:3]
ds_read_b128 a[168:171], v10 offset:2048
ds_read_b128 a[172:175], v11 offset:2048
M a[4:7], a[108:111], a[188:191], a[4:7]
M a[4:7], a[104:107], a[184:187], a[4:7]
M a[8:11], a[112:115], a[184:187], a[8:11]
buffer_load_dwordx4 v4, s[8:11], s23 offen offset:2048 lds
M a[8:11], a[116:119], a[188:191], a[8:11]
M a[12:15], a[124:127], a[188:191], a[12:15]
M a[12:15], a[120:123], a[184:187], a[12:15]
M a[16:19], a[128:131], a[184:187], a[16:19]
M a[16:19], a[132:135], a[188:191], a[16:19]
buffer_load_dwordx4 v5, s[8:11], s23 offen offset:3072 lds
M a[20:23], a[140:143], a[188:191], a[20:23]
M a[20:23], a[136:139], a[184:187], a[20:23]
M a[24:27], a[144:147], a[184:187], a[24:27]
M a[24:27], a[148:151], a[188:191], a[24:27]
M a[28:31], a[156:159], a[188:191], a[28:31]
M a[28:31], a[152:155], a[184:187], a[28:31]
s_waitcnt lgkmcnt(2)
s_sub_u32 s30, s30, 1
s_cmp_lg_u32 s30, 0
s_cbranch_scc1 Lk1_ql
M v[32:35], a[32:35], a[160:163], v[32:35]
s_add_u32 m0, s29, 65536
s_nop 0
buffer_load_dwordx4 v6, s[12:15], s24 offen offset:0 lds
M v[32:35], a[36:39], a[164:167], v[32:35]
ds_read_b128 a[176:179], v10 offset:4096
ds_read_b128 a[180:183], v11 offset:4096
M v[36:39], a[44:47], a[164:167], v[36:39]
M v[36:39], a[40:43], a[160:163], v[36:39]
ds_read_b64_tr_b16 a[96:97], v12 offset:32768
ds_read_b64_tr_b16 a[98:99], v12 offset:34816
M v[40:43], a[48:51], a[160:163], v[40:43]
M v[40:43], a[52:55], a[164:167], v[40:43]
M v[44:47], a[60:63], a[164:167], v[44:47]
M v[44:47], a[56:59], a[160:163], v[44:47]
ds_read_b64_tr_b16 a[104:105], v13 offset:32768
ds_read_b64_tr_b16 a[106:107], v13 offset:34816
M v[48:51], a[64:67], a[160:163], v[48:51]
buffer_load_dwordx4 v7, s[12:15], s24 offen offset:1024 lds
M v[48:51], a[68:71], a[164:167], v[48:51]
M v[52:55], a[76:79], a[164:167], v[52:55]
M v[52:55], a[72:75], a[160:163], v[52:55]
ds_read_b64_tr_b16 a[112:113], v14 offset:32768
ds_read_b64_tr_b16 a[114:115], v14 offset:34816
M v[56:59], a[80:83], a[160:163], v[56:59]
M v[56:59], a[84:87], a[164:167], v[56:59]
M v[60:63], a[92:95], a[164:167], v[60:63]
buffer_load_dwordx4 v8, s[12:15], s24 offen offset:2048 lds
M v[60:63], a[88:91], a[160:163], v[60:63]
s_waitcnt lgkmcnt(8)
ds_read_b64_tr_b16 a[120:121], v15 offset:32768
ds_read_b64_tr_b16 a[122:123], v15 offset:34816
M v[64:67], a[32:35], a[168:171], v[64:67]
M v[64:67], a[36:39], a[172:175], v[64:67]
ds_read_b128 a[184:187], v10 offset:6144
ds_read_b128 a[188:191], v11 offset:6144
M v[68:71], a[44:47], a[172:175], v[68:71]
M v[68:71], a[40:43], a[168:171], v[68:71]
ds_read_b64_tr_b16 a[128:129], v16 offset:32768
ds_read_b64_tr_b16 a[130:131], v16 offset:34816
M v[72:75], a[48:51], a[168:171], v[72:75]
M v[72:75], a[52:55], a[172:175], v[72:75]
M v[76:79], a[60:63], a[172:175], v[76:79]
M v[76:79], a[56:59], a[168:171], v[76:79]
ds_read_b64_tr_b16 a[136:137], v17 offset:32768
ds_read_b64_tr_b16 a[138:139], v17 offset:34816
M v[80:83], a[64:67], a[168:171], v[80:83]
buffer_load_dwordx4 v9, s[12:15], s24 offen offset:3072 lds
M v[80:83], a[68:71], a[172:175], v[80:83]
M v[84:87], a[76:79], a[172:175], v[84:87]
M v[84:87], a[72:75], a[168:171], v[84:87]
ds_read_b64_tr_b16 a[144:145], v18 offset:32768
ds_read_b64_tr_b16 a[146:147], v18 offset:34816
M v[88:91], a[80:83], a[168:171], v[88:91]
M v[88:91], a[84:87], a[172:175], v[88:91]
M v[92:95], a[92:95], a[172:175], v[92:95]
s_add_u32 s24, s24, 262144
M v[92:95], a[88:91], a[168:171], v[92:95]
s_waitcnt lgkmcnt(15)
ds_read_b64_tr_b16 a[152:153], v19 offset:32768
ds_read_b64_tr_b16 a[154:155], v19 offset:34816
M v[96:99], a[32:35], a[176:179], v[96:99]
M v[96:99], a[36:39], a[180:183], v[96:99]
M v[100:103], a[44:47], a[180:183], v[100:103]
M v[100:103], a[40:43], a[176:179], v[100:103]
M v[104:107], a[48:51], a[176:179], v[104:107]
M v[104:107], a[52:55], a[180:183], v[104:107]
M v[108:111], a[60:63], a[180:183], v[108:111]
M v[108:111], a[56:59], a[176:179], v[108:111]
s_waitcnt vmcnt(9) lgkmcnt(0)
s_barrier
ds_read_b128 a[160:163], v10 offset:16384
ds_read_b128 a[164:167], v11 offset:16384
M v[112:115], a[64:67], a[176:179], v[112:115]
s_add_u32 m0, s29, 49152
s_add_u32 s3, s23, s31
buffer_load_dwordx4 v2, s[8:11], s3 offen offset:0 lds
M v[112:115], a[68:71], a[180:183], v[112:115]
M v[116:119], a[76:79], a[180:183], v[116:119]
M v[116:119], a[72:75], a[176:179], v[116:119]
ds_read_b64_tr_b16 a[100:101], v12 offset:49152
ds_read_b64_tr_b16 a[102:103], v12 offset:51200
M v[120:123], a[80:83], a[176:179], v[120:123]
M v[120:123], a[84:87], a[180:183], v[120:123]
buffer_load_dwordx4 v3, s[8:11], s3 offen offset:1024 lds
M v[124:127], a[92:95], a[180:183], v[124:127]
M v[124:127], a[88:91], a[176:179], v[124:127]
M v[128:131], a[32:35], a[184:187], v[128:131]
M v[128:131], a[36:39], a[188:191], v[128:131]
ds_read_b128 a[168:171], v10 offset:18432
ds_read_b128 a[172:175], v11 offset:18432
ds_read_b64_tr_b16 a[108:109], v13 offset:49152
ds_read_b64_tr_b16 a[110:111], v13 offset:51200
M v[132:135], a[44:47], a[188:191], v[132:135]
M v[132:135], a[40:43], a[184:187], v[132:135]
M v[136:139], a[48:51], a[184:187], v[136:139]
buffer_load_dwordx4 v4, s[8:11], s3 offen offset:2048 lds
M v[136:139], a[52:55], a[188:191], v[136:139]
M v[140:143], a[60:63], a[188:191], v[140:143]
M v[140:143], a[56:59], a[184:187], v[140:143]
ds_read_b64_tr_b16 a[116:117], v14 offset:49152
ds_read_b64_tr_b16 a[118:119], v14 offset:51200
M v[144:147], a[64:67], a[184:187], v[144:147]
M v[144:147], a[68:71], a[188:191], v[144:147]
M v[148:151], a[76:79], a[188:191], v[148:151]
buffer_load_dwordx4 v5, s[8:11], s3 offen offset:3072 lds
M v[148:151], a[72:75], a[184:187], v[148:151]
M v[152:155], a[80:83], a[184:187], v[152:155]
M v[152:155], a[84:87], a[188:191], v[152:155]
ds_read_b64_tr_b16 a[124:125], v15 offset:49152
ds_read_b64_tr_b16 a[126:127], v15 offset:51200
M v[156:159], a[92:95], a[188:191], v[156:159]
M v[156:159], a[88:91], a[184:187], v[156:159]
s_waitcnt lgkmcnt(10)
M v[160:163], a[32:35], a[160:163], v[160:163]
M v[160:163], a[36:39], a[164:167], v[160:163]
ds_read_b128 a[176:179], v10 offset:20480
ds_read_b128 a[180:183], v11 offset:20480
M v[164:167], a[44:47], a[164:167], v[164:167]
s_add_u32 s23, s23, 128
s_cmp_eq_u32 s23, s25
s_cselect_b32 s23, s26, s23
M v[164:167], a[40:43], a[160:163], v[164:167]
ds_read_b64_tr_b16 a[132:133], v16 offset:49152
ds_read_b64_tr_b16 a[134:135], v16 offset:51200
M v[168:171], a[48:51], a[160:163], v[168:171]
M v[168:171], a[52:55], a[164:167], v[168:171]
M v[172:175], a[60:63], a[164:167], v[172:175]
M v[172:175], a[56:59], a[160:163], v[172:175]
M v[176:179], a[64:67], a[160:163], v[176:179]
s_add_u32 m0, s29, 81920
s_nop 0
buffer_load_dwordx4 v6, s[12:15], s24 offen offset:0 lds
M v[176:179], a[68:71], a[164:167], v[176:179]
ds_read_b64_tr_b16 a[140:141], v17 offset:49152
ds_read_b64_tr_b16 a[142:143], v17 offset:51200
M v[180:183], a[76:79], a[164:167], v[180:183]
M v[180:183], a[72:75], a[160:163], v[180:183]
M v[184:187], a[80:83], a[160:163], v[184:187]
M v[184:187], a[84:87], a[164:167], v[184:187]
buffer_load_dwordx4 v7, s[12:15], s24 offen offset:1024 lds
M v[188:191], a[92:95], a[164:167], v[188:191]
M v[188:191], a[88:91], a[160:163], v[188:191]
s_waitcnt lgkmcnt(12)
ds_read_b64_tr_b16 a[148:149], v18 offset:49152
ds_read_b64_tr_b16 a[150:151], v18 offset:51200
M v[192:195], a[32:35], a[168:171], v[192:195]
M v[192:195], a[36:39], a[172:175], v[192:195]
ds_read_b128 a[184:187], v10 offset:22528
ds_read_b128 a[188:191], v11 offset:22528
M v[196:199], a[44:47], a[172:175], v[196:199]
M v[196:199], a[40:43], a[168:171], v[196:199]
M v[200:203], a[48:51], a[168:171], v[200:203]
buffer_load_dwordx4 v8, s[12:15], s24 offen offset:2048 lds
M v[200:203], a[52:55], a[172:175], v[200:203]
ds_read_b64_tr_b16 a[156:157], v19 offset:49152
ds_read_b64_tr_b16 a[158:159], v19 offset:51200
M v[204:207], a[60:63], a[172:175], v[204:207]
M v[204:207], a[56:59], a[168:171], v[204:207]
M v[208:211], a[64:67], a[168:171], v[208:211]
M v[208:211], a[68:71], a[172:175], v[208:211]
M v[212:215], a[76:79], a[172:175], v[212:215]
buffer_load_dwordx4 v9, s[12:15], s24 offen offset:3072 lds
M v[212:215], a[72:75], a[168:171], v[212:215]
M v[216:219], a[80:83], a[168:171], v[216:219]
M v[216:219], a[84:87], a[172:175], v[216:219]
M v[220:223], a[92:95], a[172:175], v[220:223]
M v[220:223], a[88:91], a[168:171], v[220:223]
s_waitcnt lgkmcnt(10)
M v[224:227], a[32:35], a[176:179], v[224:227]
s_add_u32 s24, s24, 262144
s_cmp_eq_u32 s24, s27
s_cselect_b32 s24, s28, s24
s_sub_u32 s6, s6, 1
s_cmp_eq_u32 s6, 0
s_cselect_b64 s[12:13], s[64:65], s[12:13]
M v[224:227], a[36:39], a[180:183], v[224:227]
M v[228:231], a[44:47], a[180:183], v[228:231]
M v[228:231], a[40:43], a[176:179], v[228:231]
M v[232:235], a[48:51], a[176:179], v[232:235]
M v[232:235], a[52:55], a[180:183], v[232:235]
M v[236:239], a[60:63], a[180:183], v[236:239]
M v[236:239], a[56:59], a[176:179], v[236:239]
s_waitcnt vmcnt(8) lgkmcnt(0)
s_barrier
ds_read_b128 a[160:163], v10 offset:32768
ds_read_b128 a[164:167], v11 offset:32768
M v[240:243], a[64:67], a[176:179], v[240:243]
s_add_u32 m0, s29, 0
s_nop 0
buffer_load_dwordx4 v2, s[8:11], s23 offen offset:0 lds
M v[240:243], a[68:71], a[180:183], v[240:243]
M v[244:247], a[76:79], a[180:183], v[244:247]
M v[244:247], a[72:75], a[176:179], v[244:247]
M v[248:251], a[80:83], a[176:179], v[248:251]
M v[248:251], a[84:87], a[180:183], v[248:251]
buffer_load_dwordx4 v3, s[8:11], s23 offen offset:1024 lds
M v[252:255], a[92:95], a[180:183], v[252:255]
M v[252:255], a[88:91], a[176:179], v[252:255]
M a[0:3], a[32:35], a[184:187], a[0:3]
M a[0:3], a[36:39], a[188:191], a[0:3]
ds_read_b128 a[168:171], v10 offset:34816
ds_read_b128 a[172:175], v11 offset:34816
M a[4:7], a[44:47], a[188:191], a[4:7]
M a[4:7], a[40:43], a[184:187], a[4:7]
M a[8:11], a[48:51], a[184:187], a[8:11]
buffer_load_dwordx4 v4, s[8:11], s23 offen offset:2048 lds
M a[8:11], a[52:55], a[188:191], a[8:11]
M a[12:15], a[60:63], a[188:191], a[12:15]
M a[12:15], a[56:59], a[184:187], a[12:15]
M a[16:19], a[64:67], a[184:187], a[16:19]
M a[16:19], a[68:71], a[188:191], a[16:19]
buffer_load_dwordx4 v5, s[8:11], s23 offen offset:3072 lds
M a[20:23], a[76:79], a[188:191], a[20:23]
M a[20:23], a[72:75], a[184:187], a[20:23]
M a[24:27], a[80:83], a[184:187], a[24:27]
M a[24:27], a[84:87], a[188:191], a[24:27]
M a[28:31], a[92:95], a[188:191], a[28:31]
M a[28:31], a[88:91], a[184:187], a[28:31]
s_waitcnt lgkmcnt(2)
M v[32:35], a[96:99], a[160:163], v[32:35]
s_add_u32 m0, s29, 98304
s_nop 0
buffer_load_dwordx4 v6, s[12:15], s24 offen offset:0 lds
M v[32:35], a[100:103], a[164:167], v[32:35]
ds_read_b128 a[176:179], v10 offset:36864
ds_read_b128 a[180:183], v11 offset:36864
M v[36:39], a[108:111], a[164:167], v[36:39]
M v[36:39], a[104:107], a[160:163], v[36:39]
ds_read_b64_tr_b16 a[32:33], v12 offset:0
ds_read_b64_tr_b16 a[34:35], v12 offset:2048
M v[40:43], a[112:115], a[160:163], v[40:43]
M v[40:43], a[116:119], a[164:167], v[40:43]
M v[44:47], a[124:127], a[164:167], v[44:47]
M v[44:47], a[120:123], a[160:163], v[44:47]
ds_read_b64_tr_b16 a[40:41], v13 offset:0
ds_read_b64_tr_b16 a[42:43], v13 offset:2048
M v[48:51], a[128:131], a[160:163], v[48:51]
buffer_load_dwordx4 v7, s[12:15], s24 offen offset:1024 lds
M v[48:51], a[132:135], a[164:167], v[48:51]
M v[52:55], a[140:143], a[164:167], v[52:55]
M v[52:55], a[136:139], a[160:163], v[52:55]
ds_read_b64_tr_b16 a[48:49], v14 offset:0
ds_read_b64_tr_b16 a[50:51], v14 offset:2048
M v[56:59], a[144:147], a[160:163], v[56:59]
M v[56:59], a[148:151], a[164:167], v[56:59]
M v[60:63], a[156:159], a[164:167], v[60:63]
buffer_load_dwordx4 v8, s[12:15], s24 offen offset:2048 lds
M v[60:63], a[152:155], a[160:163], v[60:63]
s_waitcnt lgkmcnt(8)
ds_read_b64_tr_b16 a[56:57], v15 offset:0
ds_read_b64_tr_b16 a[58:59], v15 offset:2048
M v[64:67], a[96:99], a[168:171], v[64:67]
M v[64:67], a[100:103], a[172:175], v[64:67]
ds_read_b128 a[184:187], v10 offset:38912
ds_read_b128 a[188:191], v11 offset:38912
M v[68:71], a[108:111], a[172:175], v[68:71]
M v[68:71], a[104:107], a[168:171], v[68:71]
ds_read_b64_tr_b16 a[64:65], v16 offset:0
ds_read_b64_tr_b16 a[66:67], v16 offset:2048
M v[72:75], a[112:115], a[168:171], v[72:75]
M v[72:75], a[116:119], a[172:175], v[72:75]
M v[76:79], a[124:127], a[172:175], v[76:79]
M v[76:79], a[120:123], a[168:171], v[76:79]
ds_read_b64_tr_b16 a[72:73], v17 offset:0
ds_read_b64_tr_b16 a[74:75], v17 offset:2048
M v[80:83], a[128:131], a[168:171], v[80:83]
buffer_load_dwordx4 v9, s[12:15], s24 offen offset:3072 lds
M v[80:83], a[132:135], a[172:175], v[80:83]
M v[84:87], a[140:143], a[172:175], v[84:87]
M v[84:87], a[136:139], a[168:171], v[84:87]
ds_read_b64_tr_b16 a[80:81], v18 offset:0
ds_read_b64_tr_b16 a[82:83], v18 offset:2048
M v[88:91], a[144:147], a[168:171], v[88:91]
M v[88:91], a[148:151], a[172:175], v[88:91]
M v[92:95], a[156:159], a[172:175], v[92:95]
s_add_u32 s24, s24, 262144
M v[92:95], a[152:155], a[168:171], v[92:95]
s_waitcnt lgkmcnt(15)
ds_read_b64_tr_b16 a[88:89], v19 offset:0
ds_read_b64_tr_b16 a[90:91], v19 offset:2048
M v[96:99], a[96:99], a[176:179], v[96:99]
M v[96:99], a[100:103], a[180:183], v[96:99]
M v[100:103], a[108:111], a[180:183], v[100:103]
M v[100:103], a[104:107], a[176:179], v[100:103]
M v[104:107], a[112:115], a[176:179], v[104:107]
M v[104:107], a[116:119], a[180:183], v[104:107]
M v[108:111], a[124:127], a[180:183], v[108:111]
M v[108:111], a[120:123], a[176:179], v[108:111]
s_waitcnt vmcnt(8) lgkmcnt(0)
s_barrier
ds_read_b128 a[160:163], v10 offset:49152
ds_read_b128 a[164:167], v11 offset:49152
M v[112:115], a[128:131], a[176:179], v[112:115]
s_add_u32 m0, s29, 16384
s_add_u32 s3, s23, s31
buffer_load_dwordx4 v2, s[8:11], s3 offen offset:0 lds
M v[112:115], a[132:135], a[180:183], v[112:115]
M v[116:119], a[140:143], a[180:183], v[116:119]
M v[116:119], a[136:139], a[176:179], v[116:119]
ds_read_b64_tr_b16 a[36:37], v12 offset:16384
ds_read_b64_tr_b16 a[38:39], v12 offset:18432
M v[120:123], a[144:147], a[176:179], v[120:123]
M v[120:123], a[148:151], a[180:183], v[120:123]
buffer_load_dwordx4 v3, s[8:11], s3 offen offset:1024 lds
M v[124:127], a[156:159], a[180:183], v[124:127]
M v[124:127], a[152:155], a[176:179], v[124:127]
M v[128:131], a[96:99], a[184:187], v[128:131]
M v[128:131], a[100:103], a[188:191], v[128:131]
ds_read_b128 a[168:171], v10 offset:51200
ds_read_b128 a[172:175], v11 offset:51200
ds_read_b64_tr_b16 a[44:45], v13 offset:16384
ds_read_b64_tr_b16 a[46:47], v13 offset:18432
M v[132:135], a[108:111], a[188:191], v[132:135]
M v[132:135], a[104:107], a[184:187], v[132:135]
M v[136:139], a[112:115], a[184:187], v[136:139]
buffer_load_dwordx4 v4, s[8:11], s3 offen offset:2048 lds
M v[136:139], a[116:119], a[188:191], v[136:139]
M v[140:143], a[124:127], a[188:191], v[140:143]
M v[140:143], a[120:123], a[184:187], v[140:143]
ds_read_b64_tr_b16 a[52:53], v14 offset:16384
ds_read_b64_tr_b16 a[54:55], v14 offset:18432
M v[144:147], a[128:131], a[184:187], v[144:147]
M v[144:147], a[132:135], a[188:191], v[144:147]
M v[148:151], a[140:143], a[188:191], v[148:151]
buffer_load_dwordx4 v5, s[8:11], s3 offen offset:3072 lds
M v[148:151], a[136:139], a[184:187], v[148:151]
M v[152:155], a[144:147], a[184:187], v[152:155]
M v[152:155], a[148:151], a[188:191], v[152:155]
ds_read_b64_tr_b16 a[60:61], v15 offset:16384
ds_read_b64_tr_b16 a[62:63], v15 offset:18432
M v[156:159], a[156:159], a[188:191], v[156:159]
M v[156:159], a[152:155], a[184:187], v[156:159]
s_waitcnt lgkmcnt(10)
M v[160:163], a[96:99], a[160:163], v[160:163]
M v[160:163], a[100:103], a[164:167], v[160:163]
ds_read_b128 a[176:179], v10 offset:53248
ds_read_b128 a[180:183], v11 offset:53248
M v[164:167], a[108:111], a[164:167], v[164:167]
s_add_u32 s23, s23, 128
s_cmp_eq_u32 s23, s25
s_cselect_b32 s23, s26, s23
M v[164:167], a[104:107], a[160:163], v[164:167]
ds_read_b64_tr_b16 a[68:69], v16 offset:16384
ds_read_b64_tr_b16 a[70:71], v16 offset:18432
M v[168:171], a[112:115], a[160:163], v[168:171]
M v[168:171], a[116:119], a[164:167], v[168:171]
M v[172:175], a[124:127], a[164:167], v[172:175]
M v[172:175], a[120:123], a[160:163], v[172:175]
M v[176:179], a[128:131], a[160:163], v[176:179]
s_add_u32 m0, s29, 114688
s_nop 0
buffer_load_dwordx4 v6, s[12:15], s24 offen offset:0 lds
M v[176:179], a[132:135], a[164:167], v[176:179]
ds_read_b64_tr_b16 a[76:77], v17 offset:16384
ds_read_b64_tr_b16 a[78:79], v17 offset:18432
M v[180:183], a[140:143], a[164:167], v[180:183]
M v[180:183], a[136:139], a[160:163], v[180:183]
M v[184:187], a[144:147], a[160:163], v[184:187]
M v[184:187], a[148:151], a[164:167], v[184:187]
buffer_load_dwordx4 v7, s[12:15], s24 offen offset:1024 lds
M v[188:191], a[156:159], a[164:167], v[188:191]
M v[188:191], a[152:155], a[160:163], v[188:191]
s_waitcnt lgkmcnt(12)
ds_read_b64_tr_b16 a[84:85], v18 offset:16384
ds_read_b64_tr_b16 a[86:87], v18 offset:18432
M v[192:195], a[96:99], a[168:171], v[192:195]
M v[192:195], a[100:103], a[172:175], v[192:195]
ds_read_b128 a[184:187], v10 offset:55296
ds_read_b128 a[188:191], v11 offset:55296
M v[196:199], a[108:111], a[172:175], v[196:199]
M v[196:199], a[104:107], a[168:171], v[196:199]
M v[200:203], a[112:115], a[168:171], v[200:203]
buffer_load_dwordx4 v8, s[12:15], s24 offen offset:2048 lds
M v[200:203], a[116:119], a[172:175], v[200:203]
ds_read_b64_tr_b16 a[92:93], v19 offset:16384
ds_read_b64_tr_b16 a[94:95], v19 offset:18432
M v[204:207], a[124:127], a[172:175], v[204:207]
M v[204:207], a[120:123], a[168:171], v[204:207]
M v[208:211], a[128:131], a[168:171], v[208:211]
M v[208:211], a[132:135], a[172:175], v[208:211]
M v[212:215], a[140:143], a[172:175], v[212:215]
buffer_load_dwordx4 v9, s[12:15], s24 offen offset:3072 lds
M v[212:215], a[136:139], a[168:171], v[212:215]
M v[216:219], a[144:147], a[168:171], v[216:219]
M v[216:219], a[148:151], a[172:175], v[216:219]
M v[220:223], a[156:159], a[172:175], v[220:223]
M v[220:223], a[152:155], a[168:171], v[220:223]
s_waitcnt lgkmcnt(10)
M v[224:227], a[96:99], a[176:179], v[224:227]
s_add_u32 s24, s24, 262144
s_cmp_eq_u32 s24, s27
s_cselect_b32 s24, s28, s24
s_sub_u32 s6, s6, 1
s_cmp_eq_u32 s6, 0
s_cselect_b64 s[12:13], s[64:65], s[12:13]
M v[224:227], a[100:103], a[180:183], v[224:227]
M v[228:231], a[108:111], a[180:183], v[228:231]
M v[228:231], a[104:107], a[176:179], v[228:231]
M v[232:235], a[112:115], a[176:179], v[232:235]
M v[232:235], a[116:119], a[180:183], v[232:235]
M v[236:239], a[124:127], a[180:183], v[236:239]
M v[236:239], a[120:123], a[176:179], v[236:239]
s_waitcnt vmcnt(8) lgkmcnt(0)
s_barrier
ds_read_b128 a[160:163], v10 offset:0
ds_read_b128 a[164:167], v11 offset:0
M v[240:243], a[128:131], a[176:179], v[240:243]
s_add_u32 m0, s29, 32768
s_nop 0
buffer_load_dwordx4 v2, s[8:11], s23 offen offset:0 lds
M v[240:243], a[132:135], a[180:183], v[240:243]
M v[244:247], a[140:143], a[180:183], v[244:247]
M v[244:247], a[136:139], a[176:179], v[244:247]
M v[248:251], a[144:147], a[176:179], v[248:251]
M v[248:251], a[148:151], a[180:183], v[248:251]
M v[252:255], a[156:159], a[180:183], v[252:255]
M v[252:255], a[152:155], a[176:179], v[252:255]
M a[0:3], a[96:99], a[184:187], a[0:3]
M a[0:3], a[100:103], a[188:191], a[0:3]
ds_read_b128 a[168:171], v10 offset:2048
ds_read_b128 a[172:175], v11 offset:2048
M a[4:7], a[108:111], a[188:191], a[4:7]
M a[4:7], a[104:107], a[184:187], a[4:7]
M a[8:11], a[112:115], a[184:187], a[8:11]
buffer_load_dwordx4 v3, s[8:11], s23 offen offset:1024 lds
M a[8:11], a[116:119], a[188:191], a[8:11]
M a[12:15], a[124:127], a[188:191], a[12:15]
M a[12:15], a[120:123], a[184:187], a[12:15]
M a[16:19], a[128:131], a[184:187], a[16:19]
M a[16:19], a[132:135], a[188:191], a[16:19]
M a[20:23], a[140:143], a[188:191], a[20:23]
M a[20:23], a[136:139], a[184:187], a[20:23]
M a[24:27], a[144:147], a[184:187], a[24:27]
M a[24:27], a[148:151], a[188:191], a[24:27]
M a[28:31], a[156:159], a[188:191], a[28:31]
M a[28:31], a[152:155], a[184:187], a[28:31]
s_waitcnt lgkmcnt(2)
M v[32:35], a[32:35], a[160:163], v[32:35]
buffer_load_dwordx4 v4, s[8:11], s23 offen offset:2048 lds
M v[32:35], a[36:39], a[164:167], v[32:35]
ds_read_b128 a[176:179], v10 offset:4096
ds_read_b128 a[180:183], v11 offset:4096
M v[36:39], a[44:47], a[164:167], v[36:39]
M v[36:39], a[40:43], a[160:163], v[36:39]
ds_read_b64_tr_b16 a[96:97], v12 offset:32768
ds_read_b64_tr_b16 a[98:99], v12 offset:34816
M v[40:43], a[48:51], a[160:163], v[40:43]
M v[40:43], a[52:55], a[164:167], v[40:43]
M v[44:47], a[60:63], a[164:167], v[44:47]
M v[44:47], a[56:59], a[160:163], v[44:47]
ds_read_b64_tr_b16 a[104:105], v13 offset:32768
ds_read_b64_tr_b16 a[106:107], v13 offset:34816
M v[48:51], a[64:67], a[160:163], v[48:51]
M v[48:51], a[68:71], a[164:167], v[48:51]
M v[52:55], a[76:79], a[164:167], v[52:55]
M v[52:55], a[72:75], a[160:163], v[52:55]
ds_read_b64_tr_b16 a[112:113], v14 offset:32768
ds_read_b64_tr_b16 a[114:115], v14 offset:34816
M v[56:59], a[80:83], a[160:163], v[56:59]
M v[56:59], a[84:87], a[164:167], v[56:59]
M v[60:63], a[92:95], a[164:167], v[60:63]
M v[60:63], a[88:91], a[160:163], v[60:63]
s_waitcnt lgkmcnt(8)
ds_read_b64_tr_b16 a[120:121], v15 offset:32768
ds_read_b64_tr_b16 a[122:123], v15 offset:34816
M v[64:67], a[32:35], a[168:171], v[64:67]
M v[64:67], a[36:39], a[172:175], v[64:67]
ds_read_b128 a[184:187], v10 offset:6144
ds_read_b128 a[188:191], v11 offset:6144
M v[68:71], a[44:47], a[172:175], v[68:71]
M v[68:71], a[40:43], a[168:171], v[68:71]
ds_read_b64_tr_b16 a[128:129], v16 offset:32768
ds_read_b64_tr_b16 a[130:131], v16 offset:34816
M v[72:75], a[48:51], a[168:171], v[72:75]
buffer_load_dwordx4 v5, s[8:11], s23 offen offset:3072 lds
M v[72:75], a[52:55], a[172:175], v[72:75]
M v[76:79], a[60:63], a[172:175], v[76:79]
M v[76:79], a[56:59], a[168:171], v[76:79]
ds_read_b64_tr_b16 a[136:137], v17 offset:32768
ds_read_b64_tr_b16 a[138:139], v17 offset:34816
M v[80:83], a[64:67], a[168:171], v[80:83]
M v[80:83], a[68:71], a[172:175], v[80:83]
M v[84:87], a[76:79], a[172:175], v[84:87]
M v[84:87], a[72:75], a[168:171], v[84:87]
ds_read_b64_tr_b16 a[144:145], v18 offset:32768
ds_read_b64_tr_b16 a[146:147], v18 offset:34816
M v[88:91], a[80:83], a[168:171], v[88:91]
M v[88:91], a[84:87], a[172:175], v[88:91]
M v[92:95], a[92:95], a[172:175], v[92:95]
M v[92:95], a[88:91], a[168:171], v[92:95]
s_waitcnt lgkmcnt(15)
ds_read_b64_tr_b16 a[152:153], v19 offset:32768
ds_read_b64_tr_b16 a[154:155], v19 offset:34816
M v[96:99], a[32:35], a[176:179], v[96:99]
M v[96:99], a[36:39], a[180:183], v[96:99]
M v[100:103], a[44:47], a[180:183], v[100:103]
M v[100:103], a[40:43], a[176:179], v[100:103]
M v[104:107], a[48:51], a[176:179], v[104:107]
M v[104:107], a[52:55], a[180:183], v[104:107]
M v[108:111], a[60:63], a[180:183], v[108:111]
M v[108:111], a[56:59], a[176:179], v[108:111]
s_waitcnt vmcnt(4) lgkmcnt(0)
s_barrier
ds_read_b128 a[160:163], v10 offset:16384
ds_read_b128 a[164:167], v11 offset:16384
M v[112:115], a[64:67], a[176:179], v[112:115]
s_add_u32 m0, s29, 49152
s_add_u32 s3, s23, s31
buffer_load_dwordx4 v2, s[8:11], s3 offen offset:0 lds
M v[112:115], a[68:71], a[180:183], v[112:115]
M v[116:119], a[76:79], a[180:183], v[116:119]
buffer_load_dwordx4 v3, s[8:11], s3 offen offset:1024 lds
M v[116:119], a[72:75], a[176:179], v[116:119]
ds_read_b64_tr_b16 a[100:101], v12 offset:49152
ds_read_b64_tr_b16 a[102:103], v12 offset:51200
M v[120:123], a[80:83], a[176:179], v[120:123]
buffer_load_dwordx4 v4, s[8:11], s3 offen offset:2048 lds
M v[120:123], a[84:87], a[180:183], v[120:123]
M v[124:127], a[92:95], a[180:183], v[124:127]
buffer_load_dwordx4 v5, s[8:11], s3 offen offset:3072 lds
M v[124:127], a[88:91], a[176:179], v[124:127]
M v[128:131], a[32:35], a[184:187], v[128:131]
M v[128:131], a[36:39], a[188:191], v[128:131]
ds_read_b128 a[168:171], v10 offset:18432
ds_read_b128 a[172:175], v11 offset:18432
ds_read_b64_tr_b16 a[108:109], v13 offset:49152
ds_read_b64_tr_b16 a[110:111], v13 offset:51200
M v[132:135], a[44:47], a[188:191], v[132:135]
M v[132:135], a[40:43], a[184:187], v[132:135]
M v[136:139], a[48:51], a[184:187], v[136:139]
s_and_b32 s3, s2, 1
s_lshl_b32 s3, s3, 3
s_bfe_u32 s4, s2, 0x30003
s_add_u32 s26, s3, s4
M v[136:139], a[52:55], a[188:191], v[136:139]
s_bfe_u32 s3, s2, 0x20001
s_lshl_b32 s3, s3, 2
s_lshr_b32 s4, s2, 6
M v[140:143], a[60:63], a[188:191], v[140:143]
s_xor_b32 s4, s4, 2
s_add_u32 s27, s3, s4
s_lshl_b32 s23, s26, 18
M v[140:143], a[56:59], a[184:187], v[140:143]
ds_read_b64_tr_b16 a[116:117], v14 offset:49152
ds_read_b64_tr_b16 a[118:119], v14 offset:51200
s_sub_u32 s24, s23, 32768
s_max_i32 s24, s24, 0
s_lshl_b32 s25, s27, 7
s_add_u32 s3, s26, s27
M v[144:147], a[64:67], a[184:187], v[144:147]
s_and_b32 s3, s3, 0
s_mul_i32 s3, s3, 16
s_sub_u32 s31, 16, s3
M v[144:147], a[68:71], a[188:191], v[144:147]
s_mov_b32 s54, s31
s_movk_i32 s57, 128
s_mov_b32 s55, 4289069056
M v[148:151], a[76:79], a[188:191], v[148:151]
s_mov_b32 s56, 393216
s_lshl_b32 s4, s3, 7
s_add_u32 s23, s23, s4
s_add_u32 s24, s24, s4
M v[148:151], a[72:75], a[184:187], v[148:151]
s_mul_i32 s4, s3, 393216
s_add_u32 s25, s25, s4
s_mov_b64 s[8:9], s[44:45]
M v[152:155], a[80:83], a[184:187], v[152:155]
s_mov_b32 s10, 4194304
s_mov_b64 s[12:13], s[46:47]
s_mov_b32 s14, 6291456
M v[152:155], a[84:87], a[188:191], v[152:155]
ds_read_b64_tr_b16 a[124:125], v15 offset:49152
ds_read_b64_tr_b16 a[126:127], v15 offset:51200
s_mov_b64 s[36:37], s[90:91]
s_mov_b32 s38, 256
s_mov_b32 s39, 0x00020000
M v[156:159], a[92:95], a[188:191], v[156:159]
s_lshl_b32 s28, s20, 9
s_mul_i32 s30, s20, 6144
s_lshl_b32 s3, s20, 5
v_lshrrev_b32 v24, 3, v0
M v[156:159], a[88:91], a[184:187], v[156:159]
s_waitcnt lgkmcnt(10)
v_and_b32 v25, 7, v0
v_add_u32 v28, s3, v24
v_add_u32 v26, 0, v28
M v[160:163], a[32:35], a[160:163], v[160:163]
v_bfe_u32 v27, v26, 1, 3
v_xor_b32 v27, v27, v25
v_lshlrev_b32 v26, 11, v26
M v[160:163], a[36:39], a[164:167], v[160:163]
ds_read_b128 a[176:179], v10 offset:20480
ds_read_b128 a[180:183], v11 offset:20480
v_lshl_add_u32 v26, v27, 4, v26
v_subrev_u32 v2, 0, v26
v_add_u32 v26, 8, v28
v_bfe_u32 v27, v26, 1, 3
M v[164:167], a[44:47], a[164:167], v[164:167]
v_xor_b32 v27, v27, v25
v_lshlrev_b32 v26, 11, v26
v_lshl_add_u32 v26, v27, 4, v26
M v[164:167], a[40:43], a[160:163], v[164:167]
ds_read_b64_tr_b16 a[132:133], v16 offset:49152
ds_read_b64_tr_b16 a[134:135], v16 offset:51200
v_subrev_u32 v3, 1024, v26
v_add_u32 v26, 16, v28
v_bfe_u32 v27, v26, 1, 3
M v[168:171], a[48:51], a[160:163], v[168:171]
v_xor_b32 v27, v27, v25
v_lshlrev_b32 v26, 11, v26
v_lshl_add_u32 v26, v27, 4, v26
M v[168:171], a[52:55], a[164:167], v[168:171]
v_subrev_u32 v4, 2048, v26
v_add_u32 v26, 24, v28
v_bfe_u32 v27, v26, 1, 3
v_xor_b32 v27, v27, v25
M v[172:175], a[60:63], a[164:167], v[172:175]
v_lshlrev_b32 v26, 11, v26
v_lshl_add_u32 v26, v27, 4, v26
v_subrev_u32 v5, 3072, v26
M v[172:175], a[56:59], a[160:163], v[172:175]
s_lshl_b32 s3, s20, 2
v_lshrrev_b32 v26, 5, v0
v_add_u32 v26, s3, v26
M v[176:179], a[64:67], a[160:163], v[176:179]
v_bfe_u32 v29, v0, 2, 3
v_bfe_u32 v27, v26, 1, 3
v_xor_b32 v27, v27, v29
v_lshlrev_b32 v27, 4, v27
M v[176:179], a[68:71], a[164:167], v[176:179]
ds_read_b64_tr_b16 a[140:141], v17 offset:49152
ds_read_b64_tr_b16 a[142:143], v17 offset:51200
v_and_b32 v30, 3, v0
v_lshl_add_u32 v27, v30, 2, v27
v_lshl_add_u32 v20, v26, 11, v27
M v[180:183], a[76:79], a[164:167], v[180:183]
v_add_u32 v26, 2, v26
v_bfe_u32 v27, v26, 1, 3
v_xor_b32 v27, v27, v29
M v[180:183], a[72:75], a[160:163], v[180:183]
v_lshlrev_b32 v27, 4, v27
v_and_b32 v30, 3, v0
v_lshl_add_u32 v27, v30, 2, v27
M v[184:187], a[80:83], a[160:163], v[184:187]
v_lshl_add_u32 v23, v26, 11, v27
v_subrev_u32 v23, 256, v23
s_mul_i32 s3, s20, 48
v_add_u32 v28, s3, v24
M v[184:187], a[84:87], a[164:167], v[184:187]
v_add_u32 v26, 0, v28
v_mul_u32_u24 v27, 0xaaab, v26
v_lshrrev_b32 v27, 17, v27
M v[188:191], a[92:95], a[164:167], v[188:191]
v_lshrrev_b32 v29, 1, v27
v_and_b32 v29, 4, v29
v_and_or_b32 v27, v27, 2, v29
M v[188:191], a[88:91], a[160:163], v[188:191]
s_waitcnt lgkmcnt(12)
ds_read_b64_tr_b16 a[148:149], v18 offset:49152
ds_read_b64_tr_b16 a[150:151], v18 offset:51200
v_xor_b32 v27, v27, v25
v_lshlrev_b32 v26, 11, v26
v_lshl_add_u32 v26, v27, 4, v26
v_subrev_u32 v6, 0, v26
M v[192:195], a[32:35], a[168:171], v[192:195]
v_add_u32 v26, 8, v28
v_mul_u32_u24 v27, 0xaaab, v26
v_lshrrev_b32 v27, 17, v27
M v[192:195], a[36:39], a[172:175], v[192:195]
ds_read_b128 a[184:187], v10 offset:22528
ds_read_b128 a[188:191], v11 offset:22528
v_lshrrev_b32 v29, 1, v27
v_and_b32 v29, 4, v29
v_and_or_b32 v27, v27, 2, v29
M v[196:199], a[44:47], a[172:175], v[196:199]
v_xor_b32 v27, v27, v25
v_lshlrev_b32 v26, 11, v26
v_lshl_add_u32 v26, v27, 4, v26
v_subrev_u32 v7, 1024, v26
M v[196:199], a[40:43], a[168:171], v[196:199]
v_add_u32 v26, 16, v28
v_mul_u32_u24 v27, 0xaaab, v26
v_lshrrev_b32 v27, 17, v27
M v[200:203], a[48:51], a[168:171], v[200:203]
v_lshrrev_b32 v29, 1, v27
v_and_b32 v29, 4, v29
v_and_or_b32 v27, v27, 2, v29
M v[200:203], a[52:55], a[172:175], v[200:203]
ds_read_b64_tr_b16 a[156:157], v19 offset:49152
ds_read_b64_tr_b16 a[158:159], v19 offset:51200
v_xor_b32 v27, v27, v25
v_lshlrev_b32 v26, 11, v26
v_lshl_add_u32 v26, v27, 4, v26
M v[204:207], a[60:63], a[172:175], v[204:207]
v_subrev_u32 v8, 2048, v26
v_add_u32 v26, 24, v28
v_mul_u32_u24 v27, 0xaaab, v26
v_lshrrev_b32 v27, 17, v27
M v[204:207], a[56:59], a[168:171], v[204:207]
v_lshrrev_b32 v29, 1, v27
v_and_b32 v29, 4, v29
v_and_or_b32 v27, v27, 2, v29
M v[208:211], a[64:67], a[168:171], v[208:211]
v_xor_b32 v27, v27, v25
v_lshlrev_b32 v26, 11, v26
v_lshl_add_u32 v26, v27, 4, v26
M v[208:211], a[68:71], a[172:175], v[208:211]
v_subrev_u32 v9, 3072, v26
v_add_u32 v26, 32, v28
v_mul_u32_u24 v27, 0xaaab, v26
v_lshrrev_b32 v27, 17, v27
M v[212:215], a[76:79], a[172:175], v[212:215]
v_lshrrev_b32 v29, 1, v27
v_and_b32 v29, 4, v29
v_and_or_b32 v27, v27, 2, v29
M v[212:215], a[72:75], a[168:171], v[212:215]
v_xor_b32 v27, v27, v25
v_lshlrev_b32 v26, 11, v26
v_lshl_add_u32 v26, v27, 4, v26
M v[216:219], a[80:83], a[168:171], v[216:219]
v_subrev_u32 v21, 0, v26
v_add_u32 v26, 40, v28
v_mul_u32_u24 v27, 0xaaab, v26
M v[216:219], a[84:87], a[172:175], v[216:219]
v_lshrrev_b32 v27, 17, v27
v_lshrrev_b32 v29, 1, v27
v_and_b32 v29, 4, v29
v_and_or_b32 v27, v27, 2, v29
M v[220:223], a[92:95], a[172:175], v[220:223]
v_xor_b32 v27, v27, v25
v_lshlrev_b32 v26, 11, v26
v_lshl_add_u32 v26, v27, 4, v26
M v[220:223], a[88:91], a[168:171], v[220:223]
s_waitcnt lgkmcnt(10)
v_subrev_u32 v22, 1024, v26
s_lshr_b32 s3, s53, 7
s_add_u32 s3, s3, s22
M v[224:227], a[32:35], a[176:179], v[224:227]
s_lshl_b32 s3, s3, 5
s_lshr_b32 s19, s52, 6
s_add_u32 s3, s3, s19
s_lshl_b32 s19, s21, 1
M v[224:227], a[36:39], a[180:183], v[224:227]
s_add_u32 s3, s3, s19
s_lshl_b32 s92, s3, 14
s_add_u32 s93, s92, 16384
M v[228:231], a[44:47], a[180:183], v[228:231]
s_add_u32 s16, s50, 0
s_addc_u32 s17, s51, 0
s_mov_b32 s18, 16777216
M v[228:231], a[40:43], a[176:179], v[228:231]
s_mov_b32 s19, 0x00020000
s_mov_b32 s4, 0x3e0293ee
s_mov_b32 s5, 0x3e0293ee
M v[232:235], a[48:51], a[176:179], v[232:235]
M v[232:235], a[52:55], a[180:183], v[232:235]
M v[236:239], a[60:63], a[180:183], v[236:239]
M v[236:239], a[56:59], a[176:179], v[236:239]
s_waitcnt vmcnt(4) lgkmcnt(0)
s_barrier
ds_read_b128 a[160:163], v10 offset:32768
ds_read_b128 a[164:167], v11 offset:32768
M v[240:243], a[64:67], a[176:179], v[240:243]
s_add_u32 m0, s28, 131072
s_nop 0
buffer_load_dword v20, s[8:11], s24 offen lds
M v[240:243], a[68:71], a[180:183], v[240:243]
M v[244:247], a[76:79], a[180:183], v[244:247]
M v[244:247], a[72:75], a[176:179], v[244:247]
buffer_load_dword v23, s[8:11], s24 offen offset:256 lds
M v[248:251], a[80:83], a[176:179], v[248:251]
M v[248:251], a[84:87], a[180:183], v[248:251]
M v[252:255], a[92:95], a[180:183], v[252:255]
M v[252:255], a[88:91], a[176:179], v[252:255]
M a[0:3], a[32:35], a[184:187], a[0:3]
s_add_u32 m0, s29, 133120
s_nop 0
buffer_load_dwordx4 v2, s[8:11], s23 offen offset:0 lds
M a[0:3], a[36:39], a[188:191], a[0:3]
ds_read_b128 a[168:171], v10 offset:34816
ds_read_b128 a[172:175], v11 offset:34816
M a[4:7], a[44:47], a[188:191], a[4:7]
M a[4:7], a[40:43], a[184:187], a[4:7]
M a[8:11], a[48:51], a[184:187], a[8:11]
buffer_load_dwordx4 v3, s[8:11], s23 offen offset:1024 lds
M a[8:11], a[52:55], a[188:191], a[8:11]
M a[12:15], a[60:63], a[188:191], a[12:15]
M a[12:15], a[56:59], a[184:187], a[12:15]
M a[16:19], a[64:67], a[184:187], a[16:19]
buffer_load_dwordx4 v4, s[8:11], s23 offen offset:2048 lds
M a[16:19], a[68:71], a[188:191], a[16:19]
M a[20:23], a[76:79], a[188:191], a[20:23]
M a[20:23], a[72:75], a[184:187], a[20:23]
buffer_load_dwordx4 v5, s[8:11], s23 offen offset:3072 lds
M a[24:27], a[80:83], a[184:187], a[24:27]
M a[24:27], a[84:87], a[188:191], a[24:27]
M a[28:31], a[92:95], a[188:191], a[28:31]
M a[28:31], a[88:91], a[184:187], a[28:31]
s_waitcnt lgkmcnt(2)
M v[32:35], a[96:99], a[160:163], v[32:35]
s_sub_u32 s31, s31, 1
s_cmp_eq_u32 s31, 0
s_cselect_b32 s58, -1920, s57
s_add_u32 s23, s23, s58
s_add_u32 s24, s24, s58
M v[32:35], a[100:103], a[164:167], v[32:35]
ds_read_b128 a[176:179], v10 offset:36864
ds_read_b128 a[180:183], v11 offset:36864
M v[36:39], a[108:111], a[164:167], v[36:39]
M v[36:39], a[104:107], a[160:163], v[36:39]
M v[40:43], a[112:115], a[160:163], v[40:43]
M v[40:43], a[116:119], a[164:167], v[40:43]
s_add_u32 m0, s30, 65536
s_nop 0
buffer_load_dwordx4 v6, s[12:15], s25 offen offset:0 lds
M v[44:47], a[124:127], a[164:167], v[44:47]
M v[44:47], a[120:123], a[160:163], v[44:47]
M v[48:51], a[128:131], a[160:163], v[48:51]
M v[48:51], a[132:135], a[164:167], v[48:51]
buffer_load_dwordx4 v7, s[12:15], s25 offen offset:1024 lds
M v[52:55], a[140:143], a[164:167], v[52:55]
M v[52:55], a[136:139], a[160:163], v[52:55]
M v[56:59], a[144:147], a[160:163], v[56:59]
M v[56:59], a[148:151], a[164:167], v[56:59]
buffer_load_dwordx4 v8, s[12:15], s25 offen offset:2048 lds
M v[60:63], a[156:159], a[164:167], v[60:63]
M v[60:63], a[152:155], a[160:163], v[60:63]
s_waitcnt lgkmcnt(2)
M v[64:67], a[96:99], a[168:171], v[64:67]
M v[64:67], a[100:103], a[172:175], v[64:67]
ds_read_b128 a[184:187], v10 offset:38912
ds_read_b128 a[188:191], v11 offset:38912
M v[68:71], a[108:111], a[172:175], v[68:71]
M v[68:71], a[104:107], a[168:171], v[68:71]
buffer_load_dwordx4 v9, s[12:15], s25 offen offset:3072 lds
v_pk_mul_f32 v[32:33], v[32:33], s[4:5]
v_pk_mul_f32 v[34:35], v[34:35], s[4:5]
v_pk_mul_f32 v[36:37], v[36:37], s[4:5]
M v[72:75], a[112:115], a[168:171], v[72:75]
v_pk_mul_f32 v[38:39], v[38:39], s[4:5]
v_cvt_pk_bf16_f32 v32, v32, v33
M v[72:75], a[116:119], a[172:175], v[72:75]
v_cvt_pk_bf16_f32 v33, v34, v35
v_cvt_pk_bf16_f32 v34, v36, v37
M v[76:79], a[124:127], a[172:175], v[76:79]
v_cvt_pk_bf16_f32 v35, v38, v39
v_pk_mul_f32 v[40:41], v[40:41], s[4:5]
v_pk_mul_f32 v[42:43], v[42:43], s[4:5]
M v[76:79], a[120:123], a[168:171], v[76:79]
s_add_u32 m0, s30, 69632
s_nop 0
buffer_load_dwordx4 v21, s[12:15], s25 offen offset:0 lds
v_pk_mul_f32 v[44:45], v[44:45], s[4:5]
v_pk_mul_f32 v[46:47], v[46:47], s[4:5]
M v[80:83], a[128:131], a[168:171], v[80:83]
v_cvt_pk_bf16_f32 v40, v40, v41
v_cvt_pk_bf16_f32 v41, v42, v43
M v[80:83], a[132:135], a[172:175], v[80:83]
v_cvt_pk_bf16_f32 v42, v44, v45
v_cvt_pk_bf16_f32 v43, v46, v47
M v[84:87], a[140:143], a[172:175], v[84:87]
v_pk_mul_f32 v[48:49], v[48:49], s[4:5]
v_pk_mul_f32 v[50:51], v[50:51], s[4:5]
v_pk_mul_f32 v[52:53], v[52:53], s[4:5]
M v[84:87], a[136:139], a[168:171], v[84:87]
buffer_load_dwordx4 v22, s[12:15], s25 offen offset:1024 lds
v_pk_mul_f32 v[54:55], v[54:55], s[4:5]
v_cvt_pk_bf16_f32 v48, v48, v49
M v[88:91], a[144:147], a[168:171], v[88:91]
v_cvt_pk_bf16_f32 v49, v50, v51
v_cvt_pk_bf16_f32 v50, v52, v53
M v[88:91], a[148:151], a[172:175], v[88:91]
v_cvt_pk_bf16_f32 v51, v54, v55
v_pk_mul_f32 v[56:57], v[56:57], s[4:5]
v_pk_mul_f32 v[58:59], v[58:59], s[4:5]
M v[92:95], a[156:159], a[172:175], v[92:95]
v_pk_mul_f32 v[60:61], v[60:61], s[4:5]
v_pk_mul_f32 v[62:63], v[62:63], s[4:5]
M v[92:95], a[152:155], a[168:171], v[92:95]
s_waitcnt lgkmcnt(2)
v_cvt_pk_bf16_f32 v56, v56, v57
v_cvt_pk_bf16_f32 v57, v58, v59
M v[96:99], a[96:99], a[176:179], v[96:99]
s_sub_u32 s54, s54, 1
s_cmp_eq_u32 s54, 0
s_cselect_b32 s58, s55, s56
s_add_u32 s25, s25, s58
v_cvt_pk_bf16_f32 v58, v60, v61
v_cvt_pk_bf16_f32 v59, v62, v63
M v[96:99], a[100:103], a[180:183], v[96:99]
M v[100:103], a[108:111], a[180:183], v[100:103]
M v[100:103], a[104:107], a[176:179], v[100:103]
v_pk_mul_f32 v[64:65], v[64:65], s[4:5]
v_pk_mul_f32 v[66:67], v[66:67], s[4:5]
v_pk_mul_f32 v[68:69], v[68:69], s[4:5]
M v[104:107], a[112:115], a[176:179], v[104:107]
s_add_u32 s94, s92, 0
buffer_store_dwordx4 v[32:35], v1, s[16:19], s94 offen offset:0 sc1
v_pk_mul_f32 v[70:71], v[70:71], s[4:5]
v_cvt_pk_bf16_f32 v64, v64, v65
M v[104:107], a[116:119], a[180:183], v[104:107]
v_cvt_pk_bf16_f32 v65, v66, v67
v_cvt_pk_bf16_f32 v66, v68, v69
M v[108:111], a[124:127], a[180:183], v[108:111]
v_cvt_pk_bf16_f32 v67, v70, v71
v_pk_mul_f32 v[72:73], v[72:73], s[4:5]
v_pk_mul_f32 v[74:75], v[74:75], s[4:5]
M v[108:111], a[120:123], a[176:179], v[108:111]
s_waitcnt vmcnt(13) lgkmcnt(0)
s_barrier
ds_read_b128 a[160:163], v10 offset:49152
ds_read_b128 a[164:167], v11 offset:49152
v_pk_mul_f32 v[76:77], v[76:77], s[4:5]
v_pk_mul_f32 v[78:79], v[78:79], s[4:5]
M v[112:115], a[128:131], a[176:179], v[112:115]
s_add_u32 m0, s28, 0
s_nop 0
buffer_load_dword v20, s[8:11], s24 offen lds
v_cvt_pk_bf16_f32 v72, v72, v73
v_cvt_pk_bf16_f32 v73, v74, v75
M v[112:115], a[132:135], a[180:183], v[112:115]
v_cvt_pk_bf16_f32 v74, v76, v77
v_cvt_pk_bf16_f32 v75, v78, v79
M v[116:119], a[140:143], a[180:183], v[116:119]
s_add_u32 s94, s92, 0
buffer_store_dwordx4 v[40:43], v1, s[16:19], s94 offen offset:1024 sc1
v_pk_mul_f32 v[80:81], v[80:81], s[4:5]
v_pk_mul_f32 v[82:83], v[82:83], s[4:5]
v_pk_mul_f32 v[84:85], v[84:85], s[4:5]
M v[116:119], a[136:139], a[176:179], v[116:119]
v_pk_mul_f32 v[86:87], v[86:87], s[4:5]
v_cvt_pk_bf16_f32 v80, v80, v81
M v[120:123], a[144:147], a[176:179], v[120:123]
buffer_load_dword v23, s[8:11], s24 offen offset:256 lds
v_cvt_pk_bf16_f32 v81, v82, v83
v_cvt_pk_bf16_f32 v82, v84, v85
M v[120:123], a[148:151], a[180:183], v[120:123]
v_cvt_pk_bf16_f32 v83, v86, v87
v_pk_mul_f32 v[88:89], v[88:89], s[4:5]
v_pk_mul_f32 v[90:91], v[90:91], s[4:5]
M v[124:127], a[156:159], a[180:183], v[124:127]
v_pk_mul_f32 v[92:93], v[92:93], s[4:5]
v_pk_mul_f32 v[94:95], v[94:95], s[4:5]
M v[124:127], a[152:155], a[176:179], v[124:127]
v_cvt_pk_bf16_f32 v88, v88, v89
v_cvt_pk_bf16_f32 v89, v90, v91
M v[128:131], a[96:99], a[184:187], v[128:131]
s_add_u32 m0, s29, 2048
s_nop 0
buffer_load_dwordx4 v2, s[8:11], s23 offen offset:0 lds
v_cvt_pk_bf16_f32 v90, v92, v93
v_cvt_pk_bf16_f32 v91, v94, v95
M v[128:131], a[100:103], a[188:191], v[128:131]
ds_read_b128 a[168:171], v10 offset:51200
ds_read_b128 a[172:175], v11 offset:51200
M v[132:135], a[108:111], a[188:191], v[132:135]
s_add_u32 s94, s92, 0
buffer_store_dwordx4 v[48:51], v1, s[16:19], s94 offen offset:2048 sc1
M v[132:135], a[104:107], a[184:187], v[132:135]
v_pk_mul_f32 v[96:97], v[96:97], s[4:5]
v_pk_mul_f32 v[98:99], v[98:99], s[4:5]
v_pk_mul_f32 v[100:101], v[100:101], s[4:5]
M v[136:139], a[112:115], a[184:187], v[136:139]
v_pk_mul_f32 v[102:103], v[102:103], s[4:5]
v_cvt_pk_bf16_f32 v96, v96, v97
M v[136:139], a[116:119], a[188:191], v[136:139]
buffer_load_dwordx4 v3, s[8:11], s23 offen offset:1024 lds
v_cvt_pk_bf16_f32 v97, v98, v99
v_cvt_pk_bf16_f32 v98, v100, v101
M v[140:143], a[124:127], a[188:191], v[140:143]
v_cvt_pk_bf16_f32 v99, v102, v103
v_pk_mul_f32 v[104:105], v[104:105], s[4:5]
v_pk_mul_f32 v[106:107], v[106:107], s[4:5]
M v[140:143], a[120:123], a[184:187], v[140:143]
v_pk_mul_f32 v[108:109], v[108:109], s[4:5]
v_pk_mul_f32 v[110:111], v[110:111], s[4:5]
M v[144:147], a[128:131], a[184:187], v[144:147]
s_add_u32 s94, s92, 0
buffer_store_dwordx4 v[56:59], v1, s[16:19], s94 offen offset:3072 sc1
v_cvt_pk_bf16_f32 v104, v104, v105
v_cvt_pk_bf16_f32 v105, v106, v107
M v[144:147], a[132:135], a[188:191], v[144:147]
v_cvt_pk_bf16_f32 v106, v108, v109
v_cvt_pk_bf16_f32 v107, v110, v111
M v[148:151], a[140:143], a[188:191], v[148:151]
buffer_load_dwordx4 v4, s[8:11], s23 offen offset:2048 lds
v_pk_mul_f32 v[112:113], v[112:113], s[4:5]
v_pk_mul_f32 v[114:115], v[114:115], s[4:5]
v_pk_mul_f32 v[116:117], v[116:117], s[4:5]
M v[148:151], a[136:139], a[184:187], v[148:151]
v_pk_mul_f32 v[118:119], v[118:119], s[4:5]
v_cvt_pk_bf16_f32 v112, v112, v113
M v[152:155], a[144:147], a[184:187], v[152:155]
v_cvt_pk_bf16_f32 v113, v114, v115
v_cvt_pk_bf16_f32 v114, v116, v117
M v[152:155], a[148:151], a[188:191], v[152:155]
buffer_load_dwordx4 v5, s[8:11], s23 offen offset:3072 lds
v_cvt_pk_bf16_f32 v115, v118, v119
v_pk_mul_f32 v[120:121], v[120:121], s[4:5]
v_pk_mul_f32 v[122:123], v[122:123], s[4:5]
M v[156:159], a[156:159], a[188:191], v[156:159]
v_pk_mul_f32 v[124:125], v[124:125], s[4:5]
v_pk_mul_f32 v[126:127], v[126:127], s[4:5]
M v[156:159], a[152:155], a[184:187], v[156:159]
s_add_u32 s94, s92, 4096
buffer_store_dwordx4 v[64:67], v1, s[16:19], s94 offen offset:0 sc1
s_waitcnt lgkmcnt(2)
v_cvt_pk_bf16_f32 v120, v120, v121
v_cvt_pk_bf16_f32 v121, v122, v123
M v[160:163], a[96:99], a[160:163], v[160:163]
v_cvt_pk_bf16_f32 v122, v124, v125
v_cvt_pk_bf16_f32 v123, v126, v127
M v[160:163], a[100:103], a[164:167], v[160:163]
ds_read_b128 a[176:179], v10 offset:53248
ds_read_b128 a[180:183], v11 offset:53248
M v[164:167], a[108:111], a[164:167], v[164:167]
s_sub_u32 s31, s31, 1
s_cmp_eq_u32 s31, 0
s_cselect_b32 s58, -1920, s57
s_add_u32 s23, s23, s58
s_add_u32 s24, s24, s58
M v[164:167], a[104:107], a[160:163], v[164:167]
v_pk_mul_f32 v[128:129], v[128:129], s[4:5]
v_pk_mul_f32 v[130:131], v[130:131], s[4:5]
v_pk_mul_f32 v[132:133], v[132:133], s[4:5]
M v[168:171], a[112:115], a[160:163], v[168:171]
v_pk_mul_f32 v[134:135], v[134:135], s[4:5]
v_cvt_pk_bf16_f32 v128, v128, v129
M v[168:171], a[116:119], a[164:167], v[168:171]
s_add_u32 s94, s92, 4096
buffer_store_dwordx4 v[72:75], v1, s[16:19], s94 offen offset:1024 sc1
v_cvt_pk_bf16_f32 v129, v130, v131
v_cvt_pk_bf16_f32 v130, v132, v133
M v[172:175], a[124:127], a[164:167], v[172:175]
v_cvt_pk_bf16_f32 v131, v134, v135
v_pk_mul_f32 v[136:137], v[136:137], s[4:5]
v_pk_mul_f32 v[138:139], v[138:139], s[4:5]
M v[172:175], a[120:123], a[160:163], v[172:175]
s_add_u32 m0, s30, 98304
s_nop 0
buffer_load_dwordx4 v6, s[12:15], s25 offen offset:0 lds
v_pk_mul_f32 v[140:141], v[140:141], s[4:5]
v_pk_mul_f32 v[142:143], v[142:143], s[4:5]
M v[176:179], a[128:131], a[160:163], v[176:179]
v_cvt_pk_bf16_f32 v136, v136, v137
v_cvt_pk_bf16_f32 v137, v138, v139
M v[176:179], a[132:135], a[164:167], v[176:179]
v_cvt_pk_bf16_f32 v138, v140, v141
v_cvt_pk_bf16_f32 v139, v142, v143
M v[180:183], a[140:143], a[164:167], v[180:183]
buffer_load_dwordx4 v7, s[12:15], s25 offen offset:1024 lds
v_pk_mul_f32 v[144:145], v[144:145], s[4:5]
v_pk_mul_f32 v[146:147], v[146:147], s[4:5]
v_pk_mul_f32 v[148:149], v[148:149], s[4:5]
M v[180:183], a[136:139], a[160:163], v[180:183]
v_pk_mul_f32 v[150:151], v[150:151], s[4:5]
v_cvt_pk_bf16_f32 v144, v144, v145
M v[184:187], a[144:147], a[160:163], v[184:187]
s_add_u32 s94, s92, 4096
buffer_store_dwordx4 v[80:83], v1, s[16:19], s94 offen offset:2048 sc1
v_cvt_pk_bf16_f32 v145, v146, v147
v_cvt_pk_bf16_f32 v146, v148, v149
M v[184:187], a[148:151], a[164:167], v[184:187]
v_cvt_pk_bf16_f32 v147, v150, v151
v_pk_mul_f32 v[152:153], v[152:153], s[4:5]
v_pk_mul_f32 v[154:155], v[154:155], s[4:5]
M v[188:191], a[156:159], a[164:167], v[188:191]
buffer_load_dwordx4 v8, s[12:15], s25 offen offset:2048 lds
v_pk_mul_f32 v[156:157], v[156:157], s[4:5]
v_pk_mul_f32 v[158:159], v[158:159], s[4:5]
M v[188:191], a[152:155], a[160:163], v[188:191]
s_waitcnt lgkmcnt(2)
v_cvt_pk_bf16_f32 v152, v152, v153
v_cvt_pk_bf16_f32 v153, v154, v155
M v[192:195], a[96:99], a[168:171], v[192:195]
v_cvt_pk_bf16_f32 v154, v156, v157
v_cvt_pk_bf16_f32 v155, v158, v159
M v[192:195], a[100:103], a[172:175], v[192:195]
ds_read_b128 a[184:187], v10 offset:55296
ds_read_b128 a[188:191], v11 offset:55296
M v[196:199], a[108:111], a[172:175], v[196:199]
M v[196:199], a[104:107], a[168:171], v[196:199]
s_add_u32 s94, s92, 4096
buffer_store_dwordx4 v[88:91], v1, s[16:19], s94 offen offset:3072 sc1
v_pk_mul_f32 v[160:161], v[160:161], s[4:5]
v_pk_mul_f32 v[162:163], v[162:163], s[4:5]
v_pk_mul_f32 v[164:165], v[164:165], s[4:5]
M v[200:203], a[112:115], a[168:171], v[200:203]
buffer_load_dwordx4 v9, s[12:15], s25 offen offset:3072 lds
v_pk_mul_f32 v[166:167], v[166:167], s[4:5]
v_cvt_pk_bf16_f32 v160, v160, v161
M v[200:203], a[116:119], a[172:175], v[200:203]
v_cvt_pk_bf16_f32 v161, v162, v163
v_cvt_pk_bf16_f32 v162, v164, v165
M v[204:207], a[124:127], a[172:175], v[204:207]
v_cvt_pk_bf16_f32 v163, v166, v167
v_pk_mul_f32 v[168:169], v[168:169], s[4:5]
v_pk_mul_f32 v[170:171], v[170:171], s[4:5]
M v[204:207], a[120:123], a[168:171], v[204:207]
v_pk_mul_f32 v[172:173], v[172:173], s[4:5]
v_pk_mul_f32 v[174:175], v[174:175], s[4:5]
M v[208:211], a[128:131], a[168:171], v[208:211]
s_add_u32 m0, s30, 102400
s_nop 0
buffer_load_dwordx4 v21, s[12:15], s25 offen offset:0 lds
v_cvt_pk_bf16_f32 v168, v168, v169
v_cvt_pk_bf16_f32 v169, v170, v171
M v[208:211], a[132:135], a[172:175], v[208:211]
v_cvt_pk_bf16_f32 v170, v172, v173
v_cvt_pk_bf16_f32 v171, v174, v175
M v[212:215], a[140:143], a[172:175], v[212:215]
s_add_u32 s94, s92, 8192
buffer_store_dwordx4 v[96:99], v1, s[16:19], s94 offen offset:0 sc1
v_pk_mul_f32 v[176:177], v[176:177], s[4:5]
v_pk_mul_f32 v[178:179], v[178:179], s[4:5]
v_pk_mul_f32 v[180:181], v[180:181], s[4:5]
M v[212:215], a[136:139], a[168:171], v[212:215]
v_pk_mul_f32 v[182:183], v[182:183], s[4:5]
v_cvt_pk_bf16_f32 v176, v176, v177
M v[216:219], a[144:147], a[168:171], v[216:219]
buffer_load_dwordx4 v22, s[12:15], s25 offen offset:1024 lds
v_cvt_pk_bf16_f32 v177, v178, v179
v_cvt_pk_bf16_f32 v178, v180, v181
M v[216:219], a[148:151], a[172:175], v[216:219]
v_cvt_pk_bf16_f32 v179, v182, v183
v_pk_mul_f32 v[184:185], v[184:185], s[4:5]
v_pk_mul_f32 v[186:187], v[186:187], s[4:5]
M v[220:223], a[156:159], a[172:175], v[220:223]
v_pk_mul_f32 v[188:189], v[188:189], s[4:5]
v_pk_mul_f32 v[190:191], v[190:191], s[4:5]
M v[220:223], a[152:155], a[168:171], v[220:223]
s_waitcnt lgkmcnt(2)
v_cvt_pk_bf16_f32 v184, v184, v185
v_cvt_pk_bf16_f32 v185, v186, v187
M v[224:227], a[96:99], a[176:179], v[224:227]
s_add_u32 s94, s92, 8192
buffer_store_dwordx4 v[104:107], v1, s[16:19], s94 offen offset:1024 sc1
v_cvt_pk_bf16_f32 v186, v188, v189
v_cvt_pk_bf16_f32 v187, v190, v191
M v[224:227], a[100:103], a[180:183], v[224:227]
s_sub_u32 s54, s54, 1
s_cmp_eq_u32 s54, 0
s_cselect_b32 s58, s55, s56
s_add_u32 s25, s25, s58
M v[228:231], a[108:111], a[180:183], v[228:231]
M v[228:231], a[104:107], a[176:179], v[228:231]
v_pk_mul_f32 v[192:193], v[192:193], s[4:5]
v_pk_mul_f32 v[194:195], v[194:195], s[4:5]
v_pk_mul_f32 v[196:197], v[196:197], s[4:5]
M v[232:235], a[112:115], a[176:179], v[232:235]
v_pk_mul_f32 v[198:199], v[198:199], s[4:5]
v_cvt_pk_bf16_f32 v192, v192, v193
M v[232:235], a[116:119], a[180:183], v[232:235]
v_cvt_pk_bf16_f32 v193, v194, v195
v_cvt_pk_bf16_f32 v194, v196, v197
M v[236:239], a[124:127], a[180:183], v[236:239]
v_cvt_pk_bf16_f32 v195, v198, v199
v_pk_mul_f32 v[200:201], v[200:201], s[4:5]
v_pk_mul_f32 v[202:203], v[202:203], s[4:5]
M v[236:239], a[120:123], a[176:179], v[236:239]
s_waitcnt vmcnt(63) lgkmcnt(0)
s_barrier
v_pk_mul_f32 v[204:205], v[204:205], s[4:5]
v_pk_mul_f32 v[206:207], v[206:207], s[4:5]
M v[240:243], a[128:131], a[176:179], v[240:243]
s_add_u32 s94, s92, 8192
buffer_store_dwordx4 v[112:115], v1, s[16:19], s94 offen offset:2048 sc1
v_cvt_pk_bf16_f32 v200, v200, v201
v_cvt_pk_bf16_f32 v201, v202, v203
M v[240:243], a[132:135], a[180:183], v[240:243]
s_add_u32 m0, s28, 18432
s_nop 0
buffer_load_dword v20, s[8:11], s24 offen lds
v_cvt_pk_bf16_f32 v202, v204, v205
v_cvt_pk_bf16_f32 v203, v206, v207
M v[244:247], a[140:143], a[180:183], v[244:247]
v_pk_mul_f32 v[208:209], v[208:209], s[4:5]
v_pk_mul_f32 v[210:211], v[210:211], s[4:5]
v_pk_mul_f32 v[212:213], v[212:213], s[4:5]
M v[244:247], a[136:139], a[176:179], v[244:247]
v_pk_mul_f32 v[214:215], v[214:215], s[4:5]
v_cvt_pk_bf16_f32 v208, v208, v209
M v[248:251], a[144:147], a[176:179], v[248:251]
buffer_load_dword v23, s[8:11], s24 offen offset:256 lds
v_cvt_pk_bf16_f32 v209, v210, v211
v_cvt_pk_bf16_f32 v210, v212, v213
M v[248:251], a[148:151], a[180:183], v[248:251]
v_cvt_pk_bf16_f32 v211, v214, v215
v_pk_mul_f32 v[216:217], v[216:217], s[4:5]
v_pk_mul_f32 v[218:219], v[218:219], s[4:5]
M v[252:255], a[156:159], a[180:183], v[252:255]
s_add_u32 s94, s92, 8192
buffer_store_dwordx4 v[120:123], v1, s[16:19], s94 offen offset:3072 sc1
v_pk_mul_f32 v[220:221], v[220:221], s[4:5]
v_pk_mul_f32 v[222:223], v[222:223], s[4:5]
M v[252:255], a[152:155], a[176:179], v[252:255]
v_cvt_pk_bf16_f32 v216, v216, v217
v_cvt_pk_bf16_f32 v217, v218, v219
M a[0:3], a[96:99], a[184:187], a[0:3]
v_cvt_pk_bf16_f32 v218, v220, v221
v_cvt_pk_bf16_f32 v219, v222, v223
M a[0:3], a[100:103], a[188:191], a[0:3]
s_add_u32 m0, s29, 20480
s_nop 0
buffer_load_dwordx4 v2, s[8:11], s23 offen offset:0 lds
M a[4:7], a[108:111], a[188:191], a[4:7]
M a[4:7], a[104:107], a[184:187], a[4:7]
v_pk_mul_f32 v[224:225], v[224:225], s[4:5]
v_pk_mul_f32 v[226:227], v[226:227], s[4:5]
v_pk_mul_f32 v[228:229], v[228:229], s[4:5]
M a[8:11], a[112:115], a[184:187], a[8:11]
buffer_load_dwordx4 v3, s[8:11], s23 offen offset:1024 lds
v_pk_mul_f32 v[230:231], v[230:231], s[4:5]
v_cvt_pk_bf16_f32 v224, v224, v225
M a[8:11], a[116:119], a[188:191], a[8:11]
s_add_u32 s94, s92, 12288
buffer_store_dwordx4 v[128:131], v1, s[16:19], s94 offen offset:0 sc1
v_cvt_pk_bf16_f32 v225, v226, v227
v_cvt_pk_bf16_f32 v226, v228, v229
M a[12:15], a[124:127], a[188:191], a[12:15]
v_cvt_pk_bf16_f32 v227, v230, v231
v_pk_mul_f32 v[232:233], v[232:233], s[4:5]
v_pk_mul_f32 v[234:235], v[234:235], s[4:5]
M a[12:15], a[120:123], a[184:187], a[12:15]
v_pk_mul_f32 v[236:237], v[236:237], s[4:5]
v_pk_mul_f32 v[238:239], v[238:239], s[4:5]
M a[16:19], a[128:131], a[184:187], a[16:19]
buffer_load_dwordx4 v4, s[8:11], s23 offen offset:2048 lds
v_cvt_pk_bf16_f32 v232, v232, v233
v_cvt_pk_bf16_f32 v233, v234, v235
M a[16:19], a[132:135], a[188:191], a[16:19]
v_cvt_pk_bf16_f32 v234, v236, v237
v_cvt_pk_bf16_f32 v235, v238, v239
M a[20:23], a[140:143], a[188:191], a[20:23]
v_pk_mul_f32 v[240:241], v[240:241], s[4:5]
v_pk_mul_f32 v[242:243], v[242:243], s[4:5]
v_pk_mul_f32 v[244:245], v[244:245], s[4:5]
M a[20:23], a[136:139], a[184:187], a[20:23]
buffer_load_dwordx4 v5, s[8:11], s23 offen offset:3072 lds
v_pk_mul_f32 v[246:247], v[246:247], s[4:5]
v_cvt_pk_bf16_f32 v240, v240, v241
M a[24:27], a[144:147], a[184:187], a[24:27]
s_add_u32 s94, s92, 12288
buffer_store_dwordx4 v[136:139], v1, s[16:19], s94 offen offset:1024 sc1
v_cvt_pk_bf16_f32 v241, v242, v243
v_cvt_pk_bf16_f32 v242, v244, v245
M a[24:27], a[148:151], a[188:191], a[24:27]
v_cvt_pk_bf16_f32 v243, v246, v247
v_pk_mul_f32 v[248:249], v[248:249], s[4:5]
v_pk_mul_f32 v[250:251], v[250:251], s[4:5]
M a[28:31], a[156:159], a[188:191], a[28:31]
v_pk_mul_f32 v[252:253], v[252:253], s[4:5]
v_pk_mul_f32 v[254:255], v[254:255], s[4:5]
M a[28:31], a[152:155], a[184:187], a[28:31]
v_cvt_pk_bf16_f32 v248, v248, v249
v_cvt_pk_bf16_f32 v249, v250, v251
v_cvt_pk_bf16_f32 v250, v252, v253
v_cvt_pk_bf16_f32 v251, v254, v255
v_accvgpr_read_b32 v24, a0
v_accvgpr_read_b32 v25, a1
v_accvgpr_read_b32 v26, a2
v_accvgpr_read_b32 v27, a3
v_accvgpr_read_b32 v28, a4
v_accvgpr_read_b32 v29, a5
v_accvgpr_read_b32 v30, a6
v_accvgpr_read_b32 v31, a7
v_pk_mul_f32 v[24:25], v[24:25], s[4:5]
v_pk_mul_f32 v[26:27], v[26:27], s[4:5]
v_pk_mul_f32 v[28:29], v[28:29], s[4:5]
v_pk_mul_f32 v[30:31], v[30:31], s[4:5]
v_cvt_pk_bf16_f32 v36, v24, v25
v_cvt_pk_bf16_f32 v37, v26, v27
v_cvt_pk_bf16_f32 v38, v28, v29
v_cvt_pk_bf16_f32 v39, v30, v31
v_accvgpr_read_b32 v24, a8
v_accvgpr_read_b32 v25, a9
v_accvgpr_read_b32 v26, a10
v_accvgpr_read_b32 v27, a11
v_accvgpr_read_b32 v28, a12
v_accvgpr_read_b32 v29, a13
v_accvgpr_read_b32 v30, a14
v_accvgpr_read_b32 v31, a15
v_pk_mul_f32 v[24:25], v[24:25], s[4:5]
v_pk_mul_f32 v[26:27], v[26:27], s[4:5]
v_pk_mul_f32 v[28:29], v[28:29], s[4:5]
v_pk_mul_f32 v[30:31], v[30:31], s[4:5]
v_cvt_pk_bf16_f32 v44, v24, v25
v_cvt_pk_bf16_f32 v45, v26, v27
v_cvt_pk_bf16_f32 v46, v28, v29
v_cvt_pk_bf16_f32 v47, v30, v31
v_accvgpr_read_b32 v24, a16
v_accvgpr_read_b32 v25, a17
v_accvgpr_read_b32 v26, a18
v_accvgpr_read_b32 v27, a19
v_accvgpr_read_b32 v28, a20
v_accvgpr_read_b32 v29, a21
v_accvgpr_read_b32 v30, a22
v_accvgpr_read_b32 v31, a23
v_pk_mul_f32 v[24:25], v[24:25], s[4:5]
v_pk_mul_f32 v[26:27], v[26:27], s[4:5]
v_pk_mul_f32 v[28:29], v[28:29], s[4:5]
v_pk_mul_f32 v[30:31], v[30:31], s[4:5]
v_cvt_pk_bf16_f32 v52, v24, v25
v_cvt_pk_bf16_f32 v53, v26, v27
v_cvt_pk_bf16_f32 v54, v28, v29
v_cvt_pk_bf16_f32 v55, v30, v31
v_accvgpr_read_b32 v24, a24
v_accvgpr_read_b32 v25, a25
v_accvgpr_read_b32 v26, a26
v_accvgpr_read_b32 v27, a27
v_accvgpr_read_b32 v28, a28
v_accvgpr_read_b32 v29, a29
v_accvgpr_read_b32 v30, a30
v_accvgpr_read_b32 v31, a31
v_pk_mul_f32 v[24:25], v[24:25], s[4:5]
v_pk_mul_f32 v[26:27], v[26:27], s[4:5]
v_pk_mul_f32 v[28:29], v[28:29], s[4:5]
v_pk_mul_f32 v[30:31], v[30:31], s[4:5]
v_cvt_pk_bf16_f32 v60, v24, v25
v_cvt_pk_bf16_f32 v61, v26, v27
v_cvt_pk_bf16_f32 v62, v28, v29
v_cvt_pk_bf16_f32 v63, v30, v31
s_branch Lk1_b
Lk1_spin:
s_add_u32 s40, s40, 1
s_cmp_gt_u32 s40, 1048576
s_cbranch_scc1 Lk1_got
s_sleep 2
buffer_load_dword v126, v119, s[36:39], 0 offen offset:128 sc1
s_waitcnt vmcnt(0)
v_cmp_gt_u32 vcc, 0x80, v126
s_nop 0
s_cbranch_vccnz Lk1_spin
s_branch Lk1_got
Lk1_spinq:
s_add_u32 s40, s40, 1
s_cmp_gt_u32 s40, 1048576
s_cbranch_scc1 Lk1_gotq
s_sleep 2
buffer_load_dword v125, v119, s[36:39], 0 offen offset:0 sc1
s_waitcnt vmcnt(0)
v_cmp_gt_u32 vcc, 0x80, v125
s_nop 0
s_cbranch_vccnz Lk1_spinq
s_branch Lk1_gotq
Lk1_kv:
s_mov_b64 s[60:61], s[40:41]
s_mov_b32 s62, 4194304
s_and_b32 s3, s2, 127
s_lshl_b32 s3, s3, 2
s_add_u32 s3, s3, s20
s_mul_i32 s54, s3, 1024
M v[32:35], a[32:35], a[160:163], 0
s_add_u32 m0, s29, 32768
s_nop 0
buffer_load_dwordx4 v2, s[8:11], s23 offen offset:0 lds
M v[32:35], a[36:39], a[164:167], v[32:35]
ds_read_b128 a[176:179], v10 offset:4096
ds_read_b128 a[180:183], v11 offset:4096
M v[36:39], a[44:47], a[164:167], 0
M v[36:39], a[40:43], a[160:163], v[36:39]
ds_read_b64_tr_b16 a[96:97], v12 offset:32768
ds_read_b64_tr_b16 a[98:99], v12 offset:34816
M v[40:43], a[48:51], a[160:163], 0
M v[40:43], a[52:55], a[164:167], v[40:43]
buffer_load_dwordx4 v3, s[8:11], s23 offen offset:1024 lds
M v[44:47], a[60:63], a[164:167], 0
M v[44:47], a[56:59], a[160:163], v[44:47]
ds_read_b64_tr_b16 a[104:105], v13 offset:32768
ds_read_b64_tr_b16 a[106:107], v13 offset:34816
M v[48:51], a[64:67], a[160:163], 0
M v[48:51], a[68:71], a[164:167], v[48:51]
buffer_load_dwordx4 v4, s[8:11], s23 offen offset:2048 lds
M v[52:55], a[76:79], a[164:167], 0
M v[52:55], a[72:75], a[160:163], v[52:55]
ds_read_b64_tr_b16 a[112:113], v14 offset:32768
ds_read_b64_tr_b16 a[114:115], v14 offset:34816
M v[56:59], a[80:83], a[160:163], 0
M v[56:59], a[84:87], a[164:167], v[56:59]
buffer_load_dwordx4 v5, s[8:11], s23 offen offset:3072 lds
M v[60:63], a[92:95], a[164:167], 0
M v[60:63], a[88:91], a[160:163], v[60:63]
ds_read_b64_tr_b16 a[120:121], v15 offset:32768
ds_read_b64_tr_b16 a[122:123], v15 offset:34816
M v[64:67], a[32:35], a[168:171], 0
M v[64:67], a[36:39], a[172:175], v[64:67]
ds_read_b128 a[184:187], v10 offset:6144
ds_read_b128 a[188:191], v11 offset:6144
M v[68:71], a[44:47], a[172:175], 0
s_add_u32 m0, s29, 65536
s_nop 0
buffer_load_dwordx4 v6, s[12:15], s24 offen offset:0 lds
M v[68:71], a[40:43], a[168:171], v[68:71]
ds_read_b64_tr_b16 a[128:129], v16 offset:32768
ds_read_b64_tr_b16 a[130:131], v16 offset:34816
M v[72:75], a[48:51], a[168:171], 0
M v[72:75], a[52:55], a[172:175], v[72:75]
M v[76:79], a[60:63], a[172:175], 0
buffer_load_dwordx4 v7, s[12:15], s24 offen offset:1024 lds
M v[76:79], a[56:59], a[168:171], v[76:79]
ds_read_b64_tr_b16 a[136:137], v17 offset:32768
ds_read_b64_tr_b16 a[138:139], v17 offset:34816
M v[80:83], a[64:67], a[168:171], 0
M v[80:83], a[68:71], a[172:175], v[80:83]
M v[84:87], a[76:79], a[172:175], 0
buffer_load_dwordx4 v8, s[12:15], s24 offen offset:2048 lds
M v[84:87], a[72:75], a[168:171], v[84:87]
ds_read_b64_tr_b16 a[144:145], v18 offset:32768
ds_read_b64_tr_b16 a[146:147], v18 offset:34816
M v[88:91], a[80:83], a[168:171], 0
M v[88:91], a[84:87], a[172:175], v[88:91]
M v[92:95], a[92:95], a[172:175], 0
buffer_load_dwordx4 v9, s[12:15], s24 offen offset:3072 lds
M v[92:95], a[88:91], a[168:171], v[92:95]
s_waitcnt lgkmcnt(15)
ds_read_b64_tr_b16 a[152:153], v19 offset:32768
ds_read_b64_tr_b16 a[154:155], v19 offset:34816
M v[96:99], a[32:35], a[176:179], 0
M v[96:99], a[36:39], a[180:183], v[96:99]
M v[100:103], a[44:47], a[180:183], 0
s_add_u32 s24, s24, 262144
M v[100:103], a[40:43], a[176:179], v[100:103]
M v[104:107], a[48:51], a[176:179], 0
M v[104:107], a[52:55], a[180:183], v[104:107]
M v[108:111], a[60:63], a[180:183], 0
M v[108:111], a[56:59], a[176:179], v[108:111]
s_waitcnt vmcnt(9) lgkmcnt(0)
s_barrier
ds_read_b128 a[160:163], v10 offset:16384
ds_read_b128 a[164:167], v11 offset:16384
M v[112:115], a[64:67], a[176:179], 0
s_add_u32 m0, s29, 49152
s_add_u32 s3, s23, s31
buffer_load_dwordx4 v2, s[8:11], s3 offen offset:0 lds
M v[112:115], a[68:71], a[180:183], v[112:115]
M v[116:119], a[76:79], a[180:183], 0
M v[116:119], a[72:75], a[176:179], v[116:119]
ds_read_b64_tr_b16 a[100:101], v12 offset:49152
ds_read_b64_tr_b16 a[102:103], v12 offset:51200
M v[120:123], a[80:83], a[176:179], 0
M v[120:123], a[84:87], a[180:183], v[120:123]
buffer_load_dwordx4 v3, s[8:11], s3 offen offset:1024 lds
M v[124:127], a[92:95], a[180:183], 0
M v[124:127], a[88:91], a[176:179], v[124:127]
M v[128:131], a[32:35], a[184:187], 0
M v[128:131], a[36:39], a[188:191], v[128:131]
ds_read_b128 a[168:171], v10 offset:18432
ds_read_b128 a[172:175], v11 offset:18432
ds_read_b64_tr_b16 a[108:109], v13 offset:49152
ds_read_b64_tr_b16 a[110:111], v13 offset:51200
M v[132:135], a[44:47], a[188:191], 0
M v[132:135], a[40:43], a[184:187], v[132:135]
M v[136:139], a[48:51], a[184:187], 0
buffer_load_dwordx4 v4, s[8:11], s3 offen offset:2048 lds
M v[136:139], a[52:55], a[188:191], v[136:139]
M v[140:143], a[60:63], a[188:191], 0
M v[140:143], a[56:59], a[184:187], v[140:143]
ds_read_b64_tr_b16 a[116:117], v14 offset:49152
ds_read_b64_tr_b16 a[118:119], v14 offset:51200
M v[144:147], a[64:67], a[184:187], 0
M v[144:147], a[68:71], a[188:191], v[144:147]
M v[148:151], a[76:79], a[188:191], 0
buffer_load_dwordx4 v5, s[8:11], s3 offen offset:3072 lds
M v[148:151], a[72:75], a[184:187], v[148:151]
M v[152:155], a[80:83], a[184:187], 0
M v[152:155], a[84:87], a[188:191], v[152:155]
ds_read_b64_tr_b16 a[124:125], v15 offset:49152
ds_read_b64_tr_b16 a[126:127], v15 offset:51200
M v[156:159], a[92:95], a[188:191], 0
M v[156:159], a[88:91], a[184:187], v[156:159]
s_waitcnt lgkmcnt(10)
M v[160:163], a[32:35], a[160:163], 0
M v[160:163], a[36:39], a[164:167], v[160:163]
ds_read_b128 a[176:179], v10 offset:20480
ds_read_b128 a[180:183], v11 offset:20480
M v[164:167], a[44:47], a[164:167], 0
s_add_u32 s23, s23, 128
s_cmp_eq_u32 s23, s25
s_cselect_b32 s23, s26, s23
M v[164:167], a[40:43], a[160:163], v[164:167]
ds_read_b64_tr_b16 a[132:133], v16 offset:49152
ds_read_b64_tr_b16 a[134:135], v16 offset:51200
M v[168:171], a[48:51], a[160:163], 0
M v[168:171], a[52:55], a[164:167], v[168:171]
M v[172:175], a[60:63], a[164:167], 0
M v[172:175], a[56:59], a[160:163], v[172:175]
M v[176:179], a[64:67], a[160:163], 0
s_add_u32 m0, s29, 81920
s_nop 0
buffer_load_dwordx4 v6, s[12:15], s24 offen offset:0 lds
M v[176:179], a[68:71], a[164:167], v[176:179]
ds_read_b64_tr_b16 a[140:141], v17 offset:49152
ds_read_b64_tr_b16 a[142:143], v17 offset:51200
M v[180:183], a[76:79], a[164:167], 0
M v[180:183], a[72:75], a[160:163], v[180:183]
M v[184:187], a[80:83], a[160:163], 0
M v[184:187], a[84:87], a[164:167], v[184:187]
buffer_load_dwordx4 v7, s[12:15], s24 offen offset:1024 lds
M v[188:191], a[92:95], a[164:167], 0
M v[188:191], a[88:91], a[160:163], v[188:191]
s_waitcnt lgkmcnt(12)
ds_read_b64_tr_b16 a[148:149], v18 offset:49152
ds_read_b64_tr_b16 a[150:151], v18 offset:51200
M v[192:195], a[32:35], a[168:171], 0
M v[192:195], a[36:39], a[172:175], v[192:195]
ds_read_b128 a[184:187], v10 offset:22528
ds_read_b128 a[188:191], v11 offset:22528
M v[196:199], a[44:47], a[172:175], 0
M v[196:199], a[40:43], a[168:171], v[196:199]
M v[200:203], a[48:51], a[168:171], 0
buffer_load_dwordx4 v8, s[12:15], s24 offen offset:2048 lds
M v[200:203], a[52:55], a[172:175], v[200:203]
ds_read_b64_tr_b16 a[156:157], v19 offset:49152
ds_read_b64_tr_b16 a[158:159], v19 offset:51200
M v[204:207], a[60:63], a[172:175], 0
M v[204:207], a[56:59], a[168:171], v[204:207]
M v[208:211], a[64:67], a[168:171], 0
M v[208:211], a[68:71], a[172:175], v[208:211]
M v[212:215], a[76:79], a[172:175], 0
buffer_load_dwordx4 v9, s[12:15], s24 offen offset:3072 lds
M v[212:215], a[72:75], a[168:171], v[212:215]
M v[216:219], a[80:83], a[168:171], 0
M v[216:219], a[84:87], a[172:175], v[216:219]
M v[220:223], a[92:95], a[172:175], 0
M v[220:223], a[88:91], a[168:171], v[220:223]
s_waitcnt lgkmcnt(10)
M v[224:227], a[32:35], a[176:179], 0
s_add_u32 s24, s24, 262144
s_cmp_eq_u32 s24, s27
s_cselect_b32 s24, s28, s24
s_sub_u32 s6, s6, 1
s_cmp_eq_u32 s6, 0
s_cselect_b64 s[12:13], s[64:65], s[12:13]
M v[224:227], a[36:39], a[180:183], v[224:227]
M v[228:231], a[44:47], a[180:183], 0
M v[228:231], a[40:43], a[176:179], v[228:231]
M v[232:235], a[48:51], a[176:179], 0
M v[232:235], a[52:55], a[180:183], v[232:235]
M v[236:239], a[60:63], a[180:183], 0
M v[236:239], a[56:59], a[176:179], v[236:239]
s_waitcnt vmcnt(8) lgkmcnt(0)
s_barrier
ds_read_b128 a[160:163], v10 offset:32768
ds_read_b128 a[164:167], v11 offset:32768
M v[240:243], a[64:67], a[176:179], 0
s_add_u32 m0, s29, 0
s_nop 0
buffer_load_dwordx4 v2, s[8:11], s23 offen offset:0 lds
M v[240:243], a[68:71], a[180:183], v[240:243]
M v[244:247], a[76:79], a[180:183], 0
M v[244:247], a[72:75], a[176:179], v[244:247]
M v[248:251], a[80:83], a[176:179], 0
M v[248:251], a[84:87], a[180:183], v[248:251]
buffer_load_dwordx4 v3, s[8:11], s23 offen offset:1024 lds
M v[252:255], a[92:95], a[180:183], 0
M v[252:255], a[88:91], a[176:179], v[252:255]
M a[0:3], a[32:35], a[184:187], 0
M a[0:3], a[36:39], a[188:191], a[0:3]
ds_read_b128 a[168:171], v10 offset:34816
ds_read_b128 a[172:175], v11 offset:34816
M a[4:7], a[44:47], a[188:191], 0
M a[4:7], a[40:43], a[184:187], a[4:7]
M a[8:11], a[48:51], a[184:187], 0
buffer_load_dwordx4 v4, s[8:11], s23 offen offset:2048 lds
M a[8:11], a[52:55], a[188:191], a[8:11]
M a[12:15], a[60:63], a[188:191], 0
M a[12:15], a[56:59], a[184:187], a[12:15]
M a[16:19], a[64:67], a[184:187], 0
M a[16:19], a[68:71], a[188:191], a[16:19]
buffer_load_dwordx4 v5, s[8:11], s23 offen offset:3072 lds
M a[20:23], a[76:79], a[188:191], 0
M a[20:23], a[72:75], a[184:187], a[20:23]
M a[24:27], a[80:83], a[184:187], 0
M a[24:27], a[84:87], a[188:191], a[24:27]
M a[28:31], a[92:95], a[188:191], 0
M a[28:31], a[88:91], a[184:187], a[28:31]
s_waitcnt lgkmcnt(2)
M v[32:35], a[96:99], a[160:163], v[32:35]
s_add_u32 m0, s29, 98304
s_nop 0
buffer_load_dwordx4 v6, s[12:15], s24 offen offset:0 lds
M v[32:35], a[100:103], a[164:167], v[32:35]
ds_read_b128 a[176:179], v10 offset:36864
ds_read_b128 a[180:183], v11 offset:36864
M v[36:39], a[108:111], a[164:167], v[36:39]
M v[36:39], a[104:107], a[160:163], v[36:39]
ds_read_b64_tr_b16 a[32:33], v12 offset:0
ds_read_b64_tr_b16 a[34:35], v12 offset:2048
M v[40:43], a[112:115], a[160:163], v[40:43]
M v[40:43], a[116:119], a[164:167], v[40:43]
M v[44:47], a[124:127], a[164:167], v[44:47]
M v[44:47], a[120:123], a[160:163], v[44:47]
ds_read_b64_tr_b16 a[40:41], v13 offset:0
ds_read_b64_tr_b16 a[42:43], v13 offset:2048
M v[48:51], a[128:131], a[160:163], v[48:51]
buffer_load_dwordx4 v7, s[12:15], s24 offen offset:1024 lds
M v[48:51], a[132:135], a[164:167], v[48:51]
M v[52:55], a[140:143], a[164:167], v[52:55]
M v[52:55], a[136:139], a[160:163], v[52:55]
ds_read_b64_tr_b16 a[48:49], v14 offset:0
ds_read_b64_tr_b16 a[50:51], v14 offset:2048
M v[56:59], a[144:147], a[160:163], v[56:59]
M v[56:59], a[148:151], a[164:167], v[56:59]
M v[60:63], a[156:159], a[164:167], v[60:63]
buffer_load_dwordx4 v8, s[12:15], s24 offen offset:2048 lds
M v[60:63], a[152:155], a[160:163], v[60:63]
s_waitcnt lgkmcnt(8)
ds_read_b64_tr_b16 a[56:57], v15 offset:0
ds_read_b64_tr_b16 a[58:59], v15 offset:2048
M v[64:67], a[96:99], a[168:171], v[64:67]
M v[64:67], a[100:103], a[172:175], v[64:67]
ds_read_b128 a[184:187], v10 offset:38912
ds_read_b128 a[188:191], v11 offset:38912
M v[68:71], a[108:111], a[172:175], v[68:71]
M v[68:71], a[104:107], a[168:171], v[68:71]
ds_read_b64_tr_b16 a[64:65], v16 offset:0
ds_read_b64_tr_b16 a[66:67], v16 offset:2048
M v[72:75], a[112:115], a[168:171], v[72:75]
M v[72:75], a[116:119], a[172:175], v[72:75]
M v[76:79], a[124:127], a[172:175], v[76:79]
M v[76:79], a[120:123], a[168:171], v[76:79]
ds_read_b64_tr_b16 a[72:73], v17 offset:0
ds_read_b64_tr_b16 a[74:75], v17 offset:2048
M v[80:83], a[128:131], a[168:171], v[80:83]
buffer_load_dwordx4 v9, s[12:15], s24 offen offset:3072 lds
M v[80:83], a[132:135], a[172:175], v[80:83]
M v[84:87], a[140:143], a[172:175], v[84:87]
M v[84:87], a[136:139], a[168:171], v[84:87]
ds_read_b64_tr_b16 a[80:81], v18 offset:0
ds_read_b64_tr_b16 a[82:83], v18 offset:2048
M v[88:91], a[144:147], a[168:171], v[88:91]
M v[88:91], a[148:151], a[172:175], v[88:91]
M v[92:95], a[156:159], a[172:175], v[92:95]
s_add_u32 s24, s24, 262144
M v[92:95], a[152:155], a[168:171], v[92:95]
s_waitcnt lgkmcnt(15)
ds_read_b64_tr_b16 a[88:89], v19 offset:0
ds_read_b64_tr_b16 a[90:91], v19 offset:2048
M v[96:99], a[96:99], a[176:179], v[96:99]
M v[96:99], a[100:103], a[180:183], v[96:99]
M v[100:103], a[108:111], a[180:183], v[100:103]
M v[100:103], a[104:107], a[176:179], v[100:103]
M v[104:107], a[112:115], a[176:179], v[104:107]
M v[104:107], a[116:119], a[180:183], v[104:107]
M v[108:111], a[124:127], a[180:183], v[108:111]
M v[108:111], a[120:123], a[176:179], v[108:111]
s_waitcnt vmcnt(8) lgkmcnt(0)
s_barrier
ds_read_b128 a[160:163], v10 offset:49152
ds_read_b128 a[164:167], v11 offset:49152
M v[112:115], a[128:131], a[176:179], v[112:115]
s_add_u32 m0, s29, 16384
s_add_u32 s3, s23, s31
buffer_load_dwordx4 v2, s[8:11], s3 offen offset:0 lds
M v[112:115], a[132:135], a[180:183], v[112:115]
M v[116:119], a[140:143], a[180:183], v[116:119]
M v[116:119], a[136:139], a[176:179], v[116:119]
ds_read_b64_tr_b16 a[36:37], v12 offset:16384
ds_read_b64_tr_b16 a[38:39], v12 offset:18432
M v[120:123], a[144:147], a[176:179], v[120:123]
M v[120:123], a[148:151], a[180:183], v[120:123]
buffer_load_dwordx4 v3, s[8:11], s3 offen offset:1024 lds
M v[124:127], a[156:159], a[180:183], v[124:127]
M v[124:127], a[152:155], a[176:179], v[124:127]
M v[128:131], a[96:99], a[184:187], v[128:131]
M v[128:131], a[100:103], a[188:191], v[128:131]
ds_read_b128 a[168:171], v10 offset:51200
ds_read_b128 a[172:175], v11 offset:51200
ds_read_b64_tr_b16 a[44:45], v13 offset:16384
ds_read_b64_tr_b16 a[46:47], v13 offset:18432
M v[132:135], a[108:111], a[188:191], v[132:135]
M v[132:135], a[104:107], a[184:187], v[132:135]
M v[136:139], a[112:115], a[184:187], v[136:139]
buffer_load_dwordx4 v4, s[8:11], s3 offen offset:2048 lds
M v[136:139], a[116:119], a[188:191], v[136:139]
M v[140:143], a[124:127], a[188:191], v[140:143]
M v[140:143], a[120:123], a[184:187], v[140:143]
ds_read_b64_tr_b16 a[52:53], v14 offset:16384
ds_read_b64_tr_b16 a[54:55], v14 offset:18432
M v[144:147], a[128:131], a[184:187], v[144:147]
M v[144:147], a[132:135], a[188:191], v[144:147]
M v[148:151], a[140:143], a[188:191], v[148:151]
buffer_load_dwordx4 v5, s[8:11], s3 offen offset:3072 lds
M v[148:151], a[136:139], a[184:187], v[148:151]
M v[152:155], a[144:147], a[184:187], v[152:155]
M v[152:155], a[148:151], a[188:191], v[152:155]
ds_read_b64_tr_b16 a[60:61], v15 offset:16384
ds_read_b64_tr_b16 a[62:63], v15 offset:18432
M v[156:159], a[156:159], a[188:191], v[156:159]
M v[156:159], a[152:155], a[184:187], v[156:159]
s_waitcnt lgkmcnt(10)
M v[160:163], a[96:99], a[160:163], v[160:163]
M v[160:163], a[100:103], a[164:167], v[160:163]
ds_read_b128 a[176:179], v10 offset:53248
ds_read_b128 a[180:183], v11 offset:53248
M v[164:167], a[108:111], a[164:167], v[164:167]
s_add_u32 s23, s23, 128
s_cmp_eq_u32 s23, s25
s_cselect_b32 s23, s26, s23
M v[164:167], a[104:107], a[160:163], v[164:167]
ds_read_b64_tr_b16 a[68:69], v16 offset:16384
ds_read_b64_tr_b16 a[70:71], v16 offset:18432
M v[168:171], a[112:115], a[160:163], v[168:171]
M v[168:171], a[116:119], a[164:167], v[168:171]
M v[172:175], a[124:127], a[164:167], v[172:175]
M v[172:175], a[120:123], a[160:163], v[172:175]
M v[176:179], a[128:131], a[160:163], v[176:179]
s_add_u32 m0, s29, 114688
s_nop 0
buffer_load_dwordx4 v6, s[12:15], s24 offen offset:0 lds
M v[176:179], a[132:135], a[164:167], v[176:179]
ds_read_b64_tr_b16 a[76:77], v17 offset:16384
ds_read_b64_tr_b16 a[78:79], v17 offset:18432
M v[180:183], a[140:143], a[164:167], v[180:183]
M v[180:183], a[136:139], a[160:163], v[180:183]
M v[184:187], a[144:147], a[160:163], v[184:187]
M v[184:187], a[148:151], a[164:167], v[184:187]
buffer_load_dwordx4 v7, s[12:15], s24 offen offset:1024 lds
M v[188:191], a[156:159], a[164:167], v[188:191]
M v[188:191], a[152:155], a[160:163], v[188:191]
s_waitcnt lgkmcnt(12)
ds_read_b64_tr_b16 a[84:85], v18 offset:16384
ds_read_b64_tr_b16 a[86:87], v18 offset:18432
M v[192:195], a[96:99], a[168:171], v[192:195]
M v[192:195], a[100:103], a[172:175], v[192:195]
ds_read_b128 a[184:187], v10 offset:55296
ds_read_b128 a[188:191], v11 offset:55296
M v[196:199], a[108:111], a[172:175], v[196:199]
M v[196:199], a[104:107], a[168:171], v[196:199]
M v[200:203], a[112:115], a[168:171], v[200:203]
buffer_load_dwordx4 v8, s[12:15], s24 offen offset:2048 lds
M v[200:203], a[116:119], a[172:175], v[200:203]
ds_read_b64_tr_b16 a[92:93], v19 offset:16384
ds_read_b64_tr_b16 a[94:95], v19 offset:18432
M v[204:207], a[124:127], a[172:175], v[204:207]
M v[204:207], a[120:123], a[168:171], v[204:207]
M v[208:211], a[128:131], a[168:171], v[208:211]
M v[208:211], a[132:135], a[172:175], v[208:211]
M v[212:215], a[140:143], a[172:175], v[212:215]
buffer_load_dwordx4 v9, s[12:15], s24 offen offset:3072 lds
M v[212:215], a[136:139], a[168:171], v[212:215]
M v[216:219], a[144:147], a[168:171], v[216:219]
M v[216:219], a[148:151], a[172:175], v[216:219]
M v[220:223], a[156:159], a[172:175], v[220:223]
M v[220:223], a[152:155], a[168:171], v[220:223]
s_waitcnt lgkmcnt(10)
M v[224:227], a[96:99], a[176:179], v[224:227]
s_add_u32 s24, s24, 262144
s_cmp_eq_u32 s24, s27
s_cselect_b32 s24, s28, s24
s_sub_u32 s6, s6, 1
s_cmp_eq_u32 s6, 0
s_cselect_b64 s[12:13], s[64:65], s[12:13]
M v[224:227], a[100:103], a[180:183], v[224:227]
M v[228:231], a[108:111], a[180:183], v[228:231]
M v[228:231], a[104:107], a[176:179], v[228:231]
M v[232:235], a[112:115], a[176:179], v[232:235]
M v[232:235], a[116:119], a[180:183], v[232:235]
M v[236:239], a[124:127], a[180:183], v[236:239]
M v[236:239], a[120:123], a[176:179], v[236:239]
s_waitcnt vmcnt(8) lgkmcnt(0)
s_barrier
ds_read_b128 a[160:163], v10 offset:0
ds_read_b128 a[164:167], v11 offset:0
M v[240:243], a[128:131], a[176:179], v[240:243]
s_add_u32 m0, s29, 32768
s_nop 0
buffer_load_dwordx4 v2, s[8:11], s23 offen offset:0 lds
M v[240:243], a[132:135], a[180:183], v[240:243]
M v[244:247], a[140:143], a[180:183], v[244:247]
M v[244:247], a[136:139], a[176:179], v[244:247]
M v[248:251], a[144:147], a[176:179], v[248:251]
M v[248:251], a[148:151], a[180:183], v[248:251]
buffer_load_dwordx4 v3, s[8:11], s23 offen offset:1024 lds
M v[252:255], a[156:159], a[180:183], v[252:255]
M v[252:255], a[152:155], a[176:179], v[252:255]
M a[0:3], a[96:99], a[184:187], a[0:3]
M a[0:3], a[100:103], a[188:191], a[0:3]
ds_read_b128 a[168:171], v10 offset:2048
ds_read_b128 a[172:175], v11 offset:2048
M a[4:7], a[108:111], a[188:191], a[4:7]
M a[4:7], a[104:107], a[184:187], a[4:7]
M a[8:11], a[112:115], a[184:187], a[8:11]
buffer_load_dwordx4 v4, s[8:11], s23 offen offset:2048 lds
M a[8:11], a[116:119], a[188:191], a[8:11]
M a[12:15], a[124:127], a[188:191], a[12:15]
M a[12:15], a[120:123], a[184:187], a[12:15]
M a[16:19], a[128:131], a[184:187], a[16:19]
M a[16:19], a[132:135], a[188:191], a[16:19]
buffer_load_dwordx4 v5, s[8:11], s23 offen offset:3072 lds
M a[20:23], a[140:143], a[188:191], a[20:23]
M a[20:23], a[136:139], a[184:187], a[20:23]
M a[24:27], a[144:147], a[184:187], a[24:27]
M a[24:27], a[148:151], a[188:191], a[24:27]
M a[28:31], a[156:159], a[188:191], a[28:31]
M a[28:31], a[152:155], a[184:187], a[28:31]
s_waitcnt lgkmcnt(2)
s_mov_b32 s30, 2
Lk1_kl:
M v[32:35], a[32:35], a[160:163], v[32:35]
s_add_u32 m0, s29, 65536
s_nop 0
buffer_load_dwordx4 v6, s[12:15], s24 offen offset:0 lds
M v[32:35], a[36:39], a[164:167], v[32:35]
ds_read_b128 a[176:179], v10 offset:4096
ds_read_b128 a[180:183], v11 offset:4096
M v[36:39], a[44:47], a[164:167], v[36:39]
M v[36:39], a[40:43], a[160:163], v[36:39]
ds_read_b64_tr_b16 a[96:97], v12 offset:32768
ds_read_b64_tr_b16 a[98:99], v12 offset:34816
M v[40:43], a[48:51], a[160:163], v[40:43]
M v[40:43], a[52:55], a[164:167], v[40:43]
M v[44:47], a[60:63], a[164:167], v[44:47]
M v[44:47], a[56:59], a[160:163], v[44:47]
ds_read_b64_tr_b16 a[104:105], v13 offset:32768
ds_read_b64_tr_b16 a[106:107], v13 offset:34816
M v[48:51], a[64:67], a[160:163], v[48:51]
buffer_load_dwordx4 v7, s[12:15], s24 offen offset:1024 lds
M v[48:51], a[68:71], a[164:167], v[48:51]
M v[52:55], a[76:79], a[164:167], v[52:55]
M v[52:55], a[72:75], a[160:163], v[52:55]
ds_read_b64_tr_b16 a[112:113], v14 offset:32768
ds_read_b64_tr_b16 a[114:115], v14 offset:34816
M v[56:59], a[80:83], a[160:163], v[56:59]
M v[56:59], a[84:87], a[164:167], v[56:59]
M v[60:63], a[92:95], a[164:167], v[60:63]
buffer_load_dwordx4 v8, s[12:15], s24 offen offset:2048 lds
M v[60:63], a[88:91], a[160:163], v[60:63]
s_waitcnt lgkmcnt(8)
ds_read_b64_tr_b16 a[120:121], v15 offset:32768
ds_read_b64_tr_b16 a[122:123], v15 offset:34816
M v[64:67], a[32:35], a[168:171], v[64:67]
M v[64:67], a[36:39], a[172:175], v[64:67]
ds_read_b128 a[184:187], v10 offset:6144
ds_read_b128 a[188:191], v11 offset:6144
M v[68:71], a[44:47], a[172:175], v[68:71]
M v[68:71], a[40:43], a[168:171], v[68:71]
ds_read_b64_tr_b16 a[128:129], v16 offset:32768
ds_read_b64_tr_b16 a[130:131], v16 offset:34816
M v[72:75], a[48:51], a[168:171], v[72:75]
M v[72:75], a[52:55], a[172:175], v[72:75]
M v[76:79], a[60:63], a[172:175], v[76:79]
M v[76:79], a[56:59], a[168:171], v[76:79]
ds_read_b64_tr_b16 a[136:137], v17 offset:32768
ds_read_b64_tr_b16 a[138:139], v17 offset:34816
M v[80:83], a[64:67], a[168:171], v[80:83]
buffer_load_dwordx4 v9, s[12:15], s24 offen offset:3072 lds
M v[80:83], a[68:71], a[172:175], v[80:83]
M v[84:87], a[76:79], a[172:175], v[84:87]
M v[84:87], a[72:75], a[168:171], v[84:87]
ds_read_b64_tr_b16 a[144:145], v18 offset:32768
ds_read_b64_tr_b16 a[146:147], v18 offset:34816
M v[88:91], a[80:83], a[168:171], v[88:91]
M v[88:91], a[84:87], a[172:175], v[88:91]
M v[92:95], a[92:95], a[172:175], v[92:95]
s_add_u32 s24, s24, 262144
M v[92:95], a[88:91], a[168:171], v[92:95]
s_waitcnt lgkmcnt(15)
ds_read_b64_tr_b16 a[152:153], v19 offset:32768
ds_read_b64_tr_b16 a[154:155], v19 offset:34816
M v[96:99], a[32:35], a[176:179], v[96:99]
M v[96:99], a[36:39], a[180:183], v[96:99]
M v[100:103], a[44:47], a[180:183], v[100:103]
M v[100:103], a[40:43], a[176:179], v[100:103]
M v[104:107], a[48:51], a[176:179], v[104:107]
M v[104:107], a[52:55], a[180:183], v[104:107]
M v[108:111], a[60:63], a[180:183], v[108:111]
M v[108:111], a[56:59], a[176:179], v[108:111]
s_waitcnt vmcnt(8) lgkmcnt(0)
s_barrier
ds_read_b128 a[160:163], v10 offset:16384
ds_read_b128 a[164:167], v11 offset:16384
M v[112:115], a[64:67], a[176:179], v[112:115]
s_add_u32 m0, s29, 49152
s_add_u32 s3, s23, s31
buffer_load_dwordx4 v2, s[8:11], s3 offen offset:0 lds
M v[112:115], a[68:71], a[180:183], v[112:115]
M v[116:119], a[76:79], a[180:183], v[116:119]
M v[116:119], a[72:75], a[176:179], v[116:119]
ds_read_b64_tr_b16 a[100:101], v12 offset:49152
ds_read_b64_tr_b16 a[102:103], v12 offset:51200
M v[120:123], a[80:83], a[176:179], v[120:123]
M v[120:123], a[84:87], a[180:183], v[120:123]
buffer_load_dwordx4 v3, s[8:11], s3 offen offset:1024 lds
M v[124:127], a[92:95], a[180:183], v[124:127]
M v[124:127], a[88:91], a[176:179], v[124:127]
M v[128:131], a[32:35], a[184:187], v[128:131]
M v[128:131], a[36:39], a[188:191], v[128:131]
ds_read_b128 a[168:171], v10 offset:18432
ds_read_b128 a[172:175], v11 offset:18432
ds_read_b64_tr_b16 a[108:109], v13 offset:49152
ds_read_b64_tr_b16 a[110:111], v13 offset:51200
M v[132:135], a[44:47], a[188:191], v[132:135]
M v[132:135], a[40:43], a[184:187], v[132:135]
M v[136:139], a[48:51], a[184:187], v[136:139]
buffer_load_dwordx4 v4, s[8:11], s3 offen offset:2048 lds
M v[136:139], a[52:55], a[188:191], v[136:139]
M v[140:143], a[60:63], a[188:191], v[140:143]
M v[140:143], a[56:59], a[184:187], v[140:143]
ds_read_b64_tr_b16 a[116:117], v14 offset:49152
ds_read_b64_tr_b16 a[118:119], v14 offset:51200
M v[144:147], a[64:67], a[184:187], v[144:147]
M v[144:147], a[68:71], a[188:191], v[144:147]
M v[148:151], a[76:79], a[188:191], v[148:151]
buffer_load_dwordx4 v5, s[8:11], s3 offen offset:3072 lds
M v[148:151], a[72:75], a[184:187], v[148:151]
M v[152:155], a[80:83], a[184:187], v[152:155]
M v[152:155], a[84:87], a[188:191], v[152:155]
ds_read_b64_tr_b16 a[124:125], v15 offset:49152
ds_read_b64_tr_b16 a[126:127], v15 offset:51200
M v[156:159], a[92:95], a[188:191], v[156:159]
M v[156:159], a[88:91], a[184:187], v[156:159]
s_waitcnt lgkmcnt(10)
M v[160:163], a[32:35], a[160:163], v[160:163]
M v[160:163], a[36:39], a[164:167], v[160:163]
ds_read_b128 a[176:179], v10 offset:20480
ds_read_b128 a[180:183], v11 offset:20480
M v[164:167], a[44:47], a[164:167], v[164:167]
s_add_u32 s23, s23, 128
s_cmp_eq_u32 s23, s25
s_cselect_b32 s23, s26, s23
M v[164:167], a[40:43], a[160:163], v[164:167]
ds_read_b64_tr_b16 a[132:133], v16 offset:49152
ds_read_b64_tr_b16 a[134:135], v16 offset:51200
M v[168:171], a[48:51], a[160:163], v[168:171]
M v[168:171], a[52:55], a[164:167], v[168:171]
M v[172:175], a[60:63], a[164:167], v[172:175]
M v[172:175], a[56:59], a[160:163], v[172:175]
M v[176:179], a[64:67], a[160:163], v[176:179]
s_add_u32 m0, s29, 81920
s_nop 0
buffer_load_dwordx4 v6, s[12:15], s24 offen offset:0 lds
M v[176:179], a[68:71], a[164:167], v[176:179]
ds_read_b64_tr_b16 a[140:141], v17 offset:49152
ds_read_b64_tr_b16 a[142:143], v17 offset:51200
M v[180:183], a[76:79], a[164:167], v[180:183]
M v[180:183], a[72:75], a[160:163], v[180:183]
M v[184:187], a[80:83], a[160:163], v[184:187]
M v[184:187], a[84:87], a[164:167], v[184:187]
buffer_load_dwordx4 v7, s[12:15], s24 offen offset:1024 lds
M v[188:191], a[92:95], a[164:167], v[188:191]
M v[188:191], a[88:91], a[160:163], v[188:191]
s_waitcnt lgkmcnt(12)
ds_read_b64_tr_b16 a[148:149], v18 offset:49152
ds_read_b64_tr_b16 a[150:151], v18 offset:51200
M v[192:195], a[32:35], a[168:171], v[192:195]
M v[192:195], a[36:39], a[172:175], v[192:195]
ds_read_b128 a[184:187], v10 offset:22528
ds_read_b128 a[188:191], v11 offset:22528
M v[196:199], a[44:47], a[172:175], v[196:199]
M v[196:199], a[40:43], a[168:171], v[196:199]
M v[200:203], a[48:51], a[168:171], v[200:203]
buffer_load_dwordx4 v8, s[12:15], s24 offen offset:2048 lds
M v[200:203], a[52:55], a[172:175], v[200:203]
ds_read_b64_tr_b16 a[156:157], v19 offset:49152
ds_read_b64_tr_b16 a[158:159], v19 offset:51200
M v[204:207], a[60:63], a[172:175], v[204:207]
M v[204:207], a[56:59], a[168:171], v[204:207]
M v[208:211], a[64:67], a[168:171], v[208:211]
M v[208:211], a[68:71], a[172:175], v[208:211]
M v[212:215], a[76:79], a[172:175], v[212:215]
buffer_load_dwordx4 v9, s[12:15], s24 offen offset:3072 lds
M v[212:215], a[72:75], a[168:171], v[212:215]
M v[216:219], a[80:83], a[168:171], v[216:219]
M v[216:219], a[84:87], a[172:175], v[216:219]
M v[220:223], a[92:95], a[172:175], v[220:223]
M v[220:223], a[88:91], a[168:171], v[220:223]
s_waitcnt lgkmcnt(10)
M v[224:227], a[32:35], a[176:179], v[224:227]
s_add_u32 s24, s24, 262144
s_cmp_eq_u32 s24, s27
s_cselect_b32 s24, s28, s24
s_sub_u32 s6, s6, 1
s_cmp_eq_u32 s6, 0
s_cselect_b64 s[12:13], s[64:65], s[12:13]
M v[224:227], a[36:39], a[180:183], v[224:227]
M v[228:231], a[44:47], a[180:183], v[228:231]
M v[228:231], a[40:43], a[176:179], v[228:231]
M v[232:235], a[48:51], a[176:179], v[232:235]
M v[232:235], a[52:55], a[180:183], v[232:235]
M v[236:239], a[60:63], a[180:183], v[236:239]
M v[236:239], a[56:59], a[176:179], v[236:239]
s_waitcnt vmcnt(8) lgkmcnt(0)
s_barrier
ds_read_b128 a[160:163], v10 offset:32768
ds_read_b128 a[164:167], v11 offset:32768
M v[240:243], a[64:67], a[176:179], v[240:243]
s_add_u32 m0, s29, 0
s_nop 0
buffer_load_dwordx4 v2, s[8:11], s23 offen offset:0 lds
M v[240:243], a[68:71], a[180:183], v[240:243]
M v[244:247], a[76:79], a[180:183], v[244:247]
M v[244:247], a[72:75], a[176:179], v[244:247]
M v[248:251], a[80:83], a[176:179], v[248:251]
M v[248:251], a[84:87], a[180:183], v[248:251]
buffer_load_dwordx4 v3, s[8:11], s23 offen offset:1024 lds
M v[252:255], a[92:95], a[180:183], v[252:255]
M v[252:255], a[88:91], a[176:179], v[252:255]
M a[0:3], a[32:35], a[184:187], a[0:3]
M a[0:3], a[36:39], a[188:191], a[0:3]
ds_read_b128 a[168:171], v10 offset:34816
ds_read_b128 a[172:175], v11 offset:34816
M a[4:7], a[44:47], a[188:191], a[4:7]
M a[4:7], a[40:43], a[184:187], a[4:7]
M a[8:11], a[48:51], a[184:187], a[8:11]
buffer_load_dwordx4 v4, s[8:11], s23 offen offset:2048 lds
M a[8:11], a[52:55], a[188:191], a[8:11]
M a[12:15], a[60:63], a[188:191], a[12:15]
M a[12:15], a[56:59], a[184:187], a[12:15]
M a[16:19], a[64:67], a[184:187], a[16:19]
M a[16:19], a[68:71], a[188:191], a[16:19]
buffer_load_dwordx4 v5, s[8:11], s23 offen offset:3072 lds
M a[20:23], a[76:79], a[188:191], a[20:23]
M a[20:23], a[72:75], a[184:187], a[20:23]
M a[24:27], a[80:83], a[184:187], a[24:27]
M a[24:27], a[84:87], a[188:191], a[24:27]
M a[28:31], a[92:95], a[188:191], a[28:31]
M a[28:31], a[88:91], a[184:187], a[28:31]
s_waitcnt lgkmcnt(2)
M v[32:35], a[96:99], a[160:163], v[32:35]
s_add_u32 m0, s29, 98304
s_nop 0
buffer_load_dwordx4 v6, s[12:15], s24 offen offset:0 lds
M v[32:35], a[100:103], a[164:167], v[32:35]
ds_read_b128 a[176:179], v10 offset:36864
ds_read_b128 a[180:183], v11 offset:36864
M v[36:39], a[108:111], a[164:167], v[36:39]
M v[36:39], a[104:107], a[160:163], v[36:39]
ds_read_b64_tr_b16 a[32:33], v12 offset:0
ds_read_b64_tr_b16 a[34:35], v12 offset:2048
M v[40:43], a[112:115], a[160:163], v[40:43]
M v[40:43], a[116:119], a[164:167], v[40:43]
M v[44:47], a[124:127], a[164:167], v[44:47]
M v[44:47], a[120:123], a[160:163], v[44:47]
ds_read_b64_tr_b16 a[40:41], v13 offset:0
ds_read_b64_tr_b16 a[42:43], v13 offset:2048
M v[48:51], a[128:131], a[160:163], v[48:51]
buffer_load_dwordx4 v7, s[12:15], s24 offen offset:1024 lds
M v[48:51], a[132:135], a[164:167], v[48:51]
M v[52:55], a[140:143], a[164:167], v[52:55]
M v[52:55], a[136:139], a[160:163], v[52:55]
ds_read_b64_tr_b16 a[48:49], v14 offset:0
ds_read_b64_tr_b16 a[50:51], v14 offset:2048
M v[56:59], a[144:147], a[160:163], v[56:59]
M v[56:59], a[148:151], a[164:167], v[56:59]
M v[60:63], a[156:159], a[164:167], v[60:63]
buffer_load_dwordx4 v8, s[12:15], s24 offen offset:2048 lds
M v[60:63], a[152:155], a[160:163], v[60:63]
s_waitcnt lgkmcnt(8)
ds_read_b64_tr_b16 a[56:57], v15 offset:0
ds_read_b64_tr_b16 a[58:59], v15 offset:2048
M v[64:67], a[96:99], a[168:171], v[64:67]
M v[64:67], a[100:103], a[172:175], v[64:67]
ds_read_b128 a[184:187], v10 offset:38912
ds_read_b128 a[188:191], v11 offset:38912
M v[68:71], a[108:111], a[172:175], v[68:71]
M v[68:71], a[104:107], a[168:171], v[68:71]
ds_read_b64_tr_b16 a[64:65], v16 offset:0
ds_read_b64_tr_b16 a[66:67], v16 offset:2048
M v[72:75], a[112:115], a[168:171], v[72:75]
M v[72:75], a[116:119], a[172:175], v[72:75]
M v[76:79], a[124:127], a[172:175], v[76:79]
M v[76:79], a[120:123], a[168:171], v[76:79]
ds_read_b64_tr_b16 a[72:73], v17 offset:0
ds_read_b64_tr_b16 a[74:75], v17 offset:2048
M v[80:83], a[128:131], a[168:171], v[80:83]
buffer_load_dwordx4 v9, s[12:15], s24 offen offset:3072 lds
M v[80:83], a[132:135], a[172:175], v[80:83]
M v[84:87], a[140:143], a[172:175], v[84:87]
M v[84:87], a[136:139], a[168:171], v[84:87]
ds_read_b64_tr_b16 a[80:81], v18 offset:0
ds_read_b64_tr_b16 a[82:83], v18 offset:2048
M v[88:91], a[144:147], a[168:171], v[88:91]
M v[88:91], a[148:151], a[172:175], v[88:91]
M v[92:95], a[156:159], a[172:175], v[92:95]
s_add_u32 s24, s24, 262144
M v[92:95], a[152:155], a[168:171], v[92:95]
s_waitcnt lgkmcnt(15)
ds_read_b64_tr_b16 a[88:89], v19 offset:0
ds_read_b64_tr_b16 a[90:91], v19 offset:2048
M v[96:99], a[96:99], a[176:179], v[96:99]
M v[96:99], a[100:103], a[180:183], v[96:99]
M v[100:103], a[108:111], a[180:183], v[100:103]
M v[100:103], a[104:107], a[176:179], v[100:103]
M v[104:107], a[112:115], a[176:179], v[104:107]
M v[104:107], a[116:119], a[180:183], v[104:107]
M v[108:111], a[124:127], a[180:183], v[108:111]
M v[108:111], a[120:123], a[176:179], v[108:111]
s_waitcnt vmcnt(8) lgkmcnt(0)
s_barrier
ds_read_b128 a[160:163], v10 offset:49152
ds_read_b128 a[164:167], v11 offset:49152
M v[112:115], a[128:131], a[176:179], v[112:115]
s_add_u32 m0, s29, 16384
s_add_u32 s3, s23, s31
buffer_load_dwordx4 v2, s[8:11], s3 offen offset:0 lds
M v[112:115], a[132:135], a[180:183], v[112:115]
M v[116:119], a[140:143], a[180:183], v[116:119]
M v[116:119], a[136:139], a[176:179], v[116:119]
ds_read_b64_tr_b16 a[36:37], v12 offset:16384
ds_read_b64_tr_b16 a[38:39], v12 offset:18432
M v[120:123], a[144:147], a[176:179], v[120:123]
M v[120:123], a[148:151], a[180:183], v[120:123]
buffer_load_dwordx4 v3, s[8:11], s3 offen offset:1024 lds
M v[124:127], a[156:159], a[180:183], v[124:127]
M v[124:127], a[152:155], a[176:179], v[124:127]
M v[128:131], a[96:99], a[184:187], v[128:131]
M v[128:131], a[100:103], a[188:191], v[128:131]
ds_read_b128 a[168:171], v10 offset:51200
ds_read_b128 a[172:175], v11 offset:51200
ds_read_b64_tr_b16 a[44:45], v13 offset:16384
ds_read_b64_tr_b16 a[46:47], v13 offset:18432
M v[132:135], a[108:111], a[188:191], v[132:135]
M v[132:135], a[104:107], a[184:187], v[132:135]
M v[136:139], a[112:115], a[184:187], v[136:139]
buffer_load_dwordx4 v4, s[8:11], s3 offen offset:2048 lds
M v[136:139], a[116:119], a[188:191], v[136:139]
M v[140:143], a[124:127], a[188:191], v[140:143]
M v[140:143], a[120:123], a[184:187], v[140:143]
ds_read_b64_tr_b16 a[52:53], v14 offset:16384
ds_read_b64_tr_b16 a[54:55], v14 offset:18432
M v[144:147], a[128:131], a[184:187], v[144:147]
M v[144:147], a[132:135], a[188:191], v[144:147]
M v[148:151], a[140:143], a[188:191], v[148:151]
buffer_load_dwordx4 v5, s[8:11], s3 offen offset:3072 lds
M v[148:151], a[136:139], a[184:187], v[148:151]
M v[152:155], a[144:147], a[184:187], v[152:155]
M v[152:155], a[148:151], a[188:191], v[152:155]
ds_read_b64_tr_b16 a[60:61], v15 offset:16384
ds_read_b64_tr_b16 a[62:63], v15 offset:18432
M v[156:159], a[156:159], a[188:191], v[156:159]
M v[156:159], a[152:155], a[184:187], v[156:159]
s_waitcnt lgkmcnt(10)
M v[160:163], a[96:99], a[160:163], v[160:163]
M v[160:163], a[100:103], a[164:167], v[160:163]
ds_read_b128 a[176:179], v10 offset:53248
ds_read_b128 a[180:183], v11 offset:53248
M v[164:167], a[108:111], a[164:167], v[164:167]
s_add_u32 s23, s23, 128
s_cmp_eq_u32 s23, s25
s_cselect_b32 s23, s26, s23
M v[164:167], a[104:107], a[160:163], v[164:167]
ds_read_b64_tr_b16 a[68:69], v16 offset:16384
ds_read_b64_tr_b16 a[70:71], v16 offset:18432
M v[168:171], a[112:115], a[160:163], v[168:171]
M v[168:171], a[116:119], a[164:167], v[168:171]
M v[172:175], a[124:127], a[164:167], v[172:175]
M v[172:175], a[120:123], a[160:163], v[172:175]
M v[176:179], a[128:131], a[160:163], v[176:179]
s_add_u32 m0, s29, 114688
s_nop 0
buffer_load_dwordx4 v6, s[12:15], s24 offen offset:0 lds
M v[176:179], a[132:135], a[164:167], v[176:179]
ds_read_b64_tr_b16 a[76:77], v17 offset:16384
ds_read_b64_tr_b16 a[78:79], v17 offset:18432
M v[180:183], a[140:143], a[164:167], v[180:183]
M v[180:183], a[136:139], a[160:163], v[180:183]
M v[184:187], a[144:147], a[160:163], v[184:187]
M v[184:187], a[148:151], a[164:167], v[184:187]
buffer_load_dwordx4 v7, s[12:15], s24 offen offset:1024 lds
M v[188:191], a[156:159], a[164:167], v[188:191]
M v[188:191], a[152:155], a[160:163], v[188:191]
s_waitcnt lgkmcnt(12)
ds_read_b64_tr_b16 a[84:85], v18 offset:16384
ds_read_b64_tr_b16 a[86:87], v18 offset:18432
M v[192:195], a[96:99], a[168:171], v[192:195]
M v[192:195], a[100:103], a[172:175], v[192:195]
ds_read_b128 a[184:187], v10 offset:55296
ds_read_b128 a[188:191], v11 offset:55296
M v[196:199], a[108:111], a[172:175], v[196:199]
M v[196:199], a[104:107], a[168:171], v[196:199]
M v[200:203], a[112:115], a[168:171], v[200:203]
buffer_load_dwordx4 v8, s[12:15], s24 offen offset:2048 lds
M v[200:203], a[116:119], a[172:175], v[200:203]
ds_read_b64_tr_b16 a[92:93], v19 offset:16384
ds_read_b64_tr_b16 a[94:95], v19 offset:18432
M v[204:207], a[124:127], a[172:175], v[204:207]
M v[204:207], a[120:123], a[168:171], v[204:207]
M v[208:211], a[128:131], a[168:171], v[208:211]
M v[208:211], a[132:135], a[172:175], v[208:211]
M v[212:215], a[140:143], a[172:175], v[212:215]
buffer_load_dwordx4 v9, s[12:15], s24 offen offset:3072 lds
M v[212:215], a[136:139], a[168:171], v[212:215]
M v[216:219], a[144:147], a[168:171], v[216:219]
M v[216:219], a[148:151], a[172:175], v[216:219]
M v[220:223], a[156:159], a[172:175], v[220:223]
M v[220:223], a[152:155], a[168:171], v[220:223]
s_waitcnt lgkmcnt(10)
M v[224:227], a[96:99], a[176:179], v[224:227]
s_add_u32 s24, s24, 262144
s_cmp_eq_u32 s24, s27
s_cselect_b32 s24, s28, s24
s_sub_u32 s6, s6, 1
s_cmp_eq_u32 s6, 0
s_cselect_b64 s[12:13], s[64:65], s[12:13]
M v[224:227], a[100:103], a[180:183], v[224:227]
M v[228:231], a[108:111], a[180:183], v[228:231]
M v[228:231], a[104:107], a[176:179], v[228:231]
M v[232:235], a[112:115], a[176:179], v[232:235]
M v[232:235], a[116:119], a[180:183], v[232:235]
M v[236:239], a[124:127], a[180:183], v[236:239]
M v[236:239], a[120:123], a[176:179], v[236:239]
s_waitcnt vmcnt(8) lgkmcnt(0)
s_barrier
ds_read_b128 a[160:163], v10 offset:0
ds_read_b128 a[164:167], v11 offset:0
M v[240:243], a[128:131], a[176:179], v[240:243]
s_add_u32 m0, s29, 32768
s_nop 0
buffer_load_dwordx4 v2, s[8:11], s23 offen offset:0 lds
M v[240:243], a[132:135], a[180:183], v[240:243]
M v[244:247], a[140:143], a[180:183], v[244:247]
M v[244:247], a[136:139], a[176:179], v[244:247]
M v[248:251], a[144:147], a[176:179], v[248:251]
M v[248:251], a[148:151], a[180:183], v[248:251]
buffer_load_dwordx4 v3, s[8:11], s23 offen offset:1024 lds
M v[252:255], a[156:159], a[180:183], v[252:255]
M v[252:255], a[152:155], a[176:179], v[252:255]
M a[0:3], a[96:99], a[184:187], a[0:3]
M a[0:3], a[100:103], a[188:191], a[0:3]
ds_read_b128 a[168:171], v10 offset:2048
ds_read_b128 a[172:175], v11 offset:2048
M a[4:7], a[108:111], a[188:191], a[4:7]
M a[4:7], a[104:107], a[184:187], a[4:7]
M a[8:11], a[112:115], a[184:187], a[8:11]
buffer_load_dwordx4 v4, s[8:11], s23 offen offset:2048 lds
M a[8:11], a[116:119], a[188:191], a[8:11]
M a[12:15], a[124:127], a[188:191], a[12:15]
M a[12:15], a[120:123], a[184:187], a[12:15]
M a[16:19], a[128:131], a[184:187], a[16:19]
M a[16:19], a[132:135], a[188:191], a[16:19]
buffer_load_dwordx4 v5, s[8:11], s23 offen offset:3072 lds
M a[20:23], a[140:143], a[188:191], a[20:23]
M a[20:23], a[136:139], a[184:187], a[20:23]
M a[24:27], a[144:147], a[184:187], a[24:27]
M a[24:27], a[148:151], a[188:191], a[24:27]
M a[28:31], a[156:159], a[188:191], a[28:31]
M a[28:31], a[152:155], a[184:187], a[28:31]
s_waitcnt lgkmcnt(2)
s_sub_u32 s30, s30, 1
s_cmp_lg_u32 s30, 0
s_cbranch_scc1 Lk1_kl
M v[32:35], a[32:35], a[160:163], v[32:35]
s_add_u32 m0, s29, 65536
s_nop 0
buffer_load_dwordx4 v6, s[12:15], s24 offen offset:0 lds
M v[32:35], a[36:39], a[164:167], v[32:35]
ds_read_b128 a[176:179], v10 offset:4096
ds_read_b128 a[180:183], v11 offset:4096
M v[36:39], a[44:47], a[164:167], v[36:39]
M v[36:39], a[40:43], a[160:163], v[36:39]
ds_read_b64_tr_b16 a[96:97], v12 offset:32768
ds_read_b64_tr_b16 a[98:99], v12 offset:34816
M v[40:43], a[48:51], a[160:163], v[40:43]
M v[40:43], a[52:55], a[164:167], v[40:43]
M v[44:47], a[60:63], a[164:167], v[44:47]
M v[44:47], a[56:59], a[160:163], v[44:47]
ds_read_b64_tr_b16 a[104:105], v13 offset:32768
ds_read_b64_tr_b16 a[106:107], v13 offset:34816
M v[48:51], a[64:67], a[160:163], v[48:51]
buffer_load_dwordx4 v7, s[12:15], s24 offen offset:1024 lds
M v[48:51], a[68:71], a[164:167], v[48:51]
M v[52:55], a[76:79], a[164:167], v[52:55]
M v[52:55], a[72:75], a[160:163], v[52:55]
ds_read_b64_tr_b16 a[112:113], v14 offset:32768
ds_read_b64_tr_b16 a[114:115], v14 offset:34816
M v[56:59], a[80:83], a[160:163], v[56:59]
M v[56:59], a[84:87], a[164:167], v[56:59]
M v[60:63], a[92:95], a[164:167], v[60:63]
buffer_load_dwordx4 v8, s[12:15], s24 offen offset:2048 lds
M v[60:63], a[88:91], a[160:163], v[60:63]
s_waitcnt lgkmcnt(8)
ds_read_b64_tr_b16 a[120:121], v15 offset:32768
ds_read_b64_tr_b16 a[122:123], v15 offset:34816
M v[64:67], a[32:35], a[168:171], v[64:67]
M v[64:67], a[36:39], a[172:175], v[64:67]
ds_read_b128 a[184:187], v10 offset:6144
ds_read_b128 a[188:191], v11 offset:6144
M v[68:71], a[44:47], a[172:175], v[68:71]
M v[68:71], a[40:43], a[168:171], v[68:71]
ds_read_b64_tr_b16 a[128:129], v16 offset:32768
ds_read_b64_tr_b16 a[130:131], v16 offset:34816
M v[72:75], a[48:51], a[168:171], v[72:75]
M v[72:75], a[52:55], a[172:175], v[72:75]
M v[76:79], a[60:63], a[172:175], v[76:79]
M v[76:79], a[56:59], a[168:171], v[76:79]
ds_read_b64_tr_b16 a[136:137], v17 offset:32768
ds_read_b64_tr_b16 a[138:139], v17 offset:34816
M v[80:83], a[64:67], a[168:171], v[80:83]
buffer_load_dwordx4 v9, s[12:15], s24 offen offset:3072 lds
M v[80:83], a[68:71], a[172:175], v[80:83]
M v[84:87], a[76:79], a[172:175], v[84:87]
M v[84:87], a[72:75], a[168:171], v[84:87]
ds_read_b64_tr_b16 a[144:145], v18 offset:32768
ds_read_b64_tr_b16 a[146:147], v18 offset:34816
M v[88:91], a[80:83], a[168:171], v[88:91]
M v[88:91], a[84:87], a[172:175], v[88:91]
M v[92:95], a[92:95], a[172:175], v[92:95]
s_add_u32 s24, s24, 262144
M v[92:95], a[88:91], a[168:171], v[92:95]
s_waitcnt lgkmcnt(15)
ds_read_b64_tr_b16 a[152:153], v19 offset:32768
ds_read_b64_tr_b16 a[154:155], v19 offset:34816
M v[96:99], a[32:35], a[176:179], v[96:99]
M v[96:99], a[36:39], a[180:183], v[96:99]
M v[100:103], a[44:47], a[180:183], v[100:103]
M v[100:103], a[40:43], a[176:179], v[100:103]
M v[104:107], a[48:51], a[176:179], v[104:107]
M v[104:107], a[52:55], a[180:183], v[104:107]
M v[108:111], a[60:63], a[180:183], v[108:111]
M v[108:111], a[56:59], a[176:179], v[108:111]
s_waitcnt vmcnt(8) lgkmcnt(0)
s_barrier
ds_read_b128 a[160:163], v10 offset:16384
ds_read_b128 a[164:167], v11 offset:16384
M v[112:115], a[64:67], a[176:179], v[112:115]
s_add_u32 m0, s29, 49152
s_add_u32 s3, s23, s31
buffer_load_dwordx4 v2, s[8:11], s3 offen offset:0 lds
M v[112:115], a[68:71], a[180:183], v[112:115]
M v[116:119], a[76:79], a[180:183], v[116:119]
M v[116:119], a[72:75], a[176:179], v[116:119]
ds_read_b64_tr_b16 a[100:101], v12 offset:49152
ds_read_b64_tr_b16 a[102:103], v12 offset:51200
M v[120:123], a[80:83], a[176:179], v[120:123]
M v[120:123], a[84:87], a[180:183], v[120:123]
buffer_load_dwordx4 v3, s[8:11], s3 offen offset:1024 lds
M v[124:127], a[92:95], a[180:183], v[124:127]
M v[124:127], a[88:91], a[176:179], v[124:127]
M v[128:131], a[32:35], a[184:187], v[128:131]
M v[128:131], a[36:39], a[188:191], v[128:131]
ds_read_b128 a[168:171], v10 offset:18432
ds_read_b128 a[172:175], v11 offset:18432
ds_read_b64_tr_b16 a[108:109], v13 offset:49152
ds_read_b64_tr_b16 a[110:111], v13 offset:51200
M v[132:135], a[44:47], a[188:191], v[132:135]
M v[132:135], a[40:43], a[184:187], v[132:135]
M v[136:139], a[48:51], a[184:187], v[136:139]
buffer_load_dwordx4 v4, s[8:11], s3 offen offset:2048 lds
M v[136:139], a[52:55], a[188:191], v[136:139]
M v[140:143], a[60:63], a[188:191], v[140:143]
M v[140:143], a[56:59], a[184:187], v[140:143]
ds_read_b64_tr_b16 a[116:117], v14 offset:49152
ds_read_b64_tr_b16 a[118:119], v14 offset:51200
M v[144:147], a[64:67], a[184:187], v[144:147]
M v[144:147], a[68:71], a[188:191], v[144:147]
M v[148:151], a[76:79], a[188:191], v[148:151]
buffer_load_dwordx4 v5, s[8:11], s3 offen offset:3072 lds
M v[148:151], a[72:75], a[184:187], v[148:151]
M v[152:155], a[80:83], a[184:187], v[152:155]
s_lshr_b32 s95, s53, 7
s_add_u32 s95, s95, s22
M v[152:155], a[84:87], a[188:191], v[152:155]
ds_read_b64_tr_b16 a[124:125], v15 offset:49152
ds_read_b64_tr_b16 a[126:127], v15 offset:51200
s_lshl_b32 s95, s95, 5
s_lshr_b32 s19, s52, 6
M v[156:159], a[92:95], a[188:191], v[156:159]
s_add_u32 s95, s95, s19
s_lshl_b32 s19, s21, 1
M v[156:159], a[88:91], a[184:187], v[156:159]
s_waitcnt lgkmcnt(10)
s_add_u32 s95, s95, s19
s_lshl_b32 s92, s95, 15
M v[160:163], a[32:35], a[160:163], v[160:163]
s_add_u32 s93, s92, 32768
s_add_u32 s16, s50, 16777216
M v[160:163], a[36:39], a[164:167], v[160:163]
ds_read_b128 a[176:179], v10 offset:20480
ds_read_b128 a[180:183], v11 offset:20480
s_addc_u32 s17, s51, 0
s_mov_b32 s18, 33554432
M v[164:167], a[44:47], a[164:167], v[164:167]
s_add_u32 s23, s23, 128
s_cmp_eq_u32 s23, s25
s_cselect_b32 s23, s26, s23
s_mov_b32 s19, 0x00020000
M v[164:167], a[40:43], a[160:163], v[164:167]
ds_read_b64_tr_b16 a[132:133], v16 offset:49152
ds_read_b64_tr_b16 a[134:135], v16 offset:51200
M v[168:171], a[48:51], a[160:163], v[168:171]
M v[168:171], a[52:55], a[164:167], v[168:171]
M v[172:175], a[60:63], a[164:167], v[172:175]
M v[172:175], a[56:59], a[160:163], v[172:175]
M v[176:179], a[64:67], a[160:163], v[176:179]
s_add_u32 m0, s29, 81920
s_nop 0
buffer_load_dwordx4 v6, s[12:15], s24 offen offset:0 lds
M v[176:179], a[68:71], a[164:167], v[176:179]
ds_read_b64_tr_b16 a[140:141], v17 offset:49152
ds_read_b64_tr_b16 a[142:143], v17 offset:51200
M v[180:183], a[76:79], a[164:167], v[180:183]
M v[180:183], a[72:75], a[160:163], v[180:183]
M v[184:187], a[80:83], a[160:163], v[184:187]
M v[184:187], a[84:87], a[164:167], v[184:187]
buffer_load_dwordx4 v7, s[12:15], s24 offen offset:1024 lds
M v[188:191], a[92:95], a[164:167], v[188:191]
M v[188:191], a[88:91], a[160:163], v[188:191]
s_waitcnt lgkmcnt(12)
ds_read_b64_tr_b16 a[148:149], v18 offset:49152
ds_read_b64_tr_b16 a[150:151], v18 offset:51200
M v[192:195], a[32:35], a[168:171], v[192:195]
M v[192:195], a[36:39], a[172:175], v[192:195]
ds_read_b128 a[184:187], v10 offset:22528
ds_read_b128 a[188:191], v11 offset:22528
M v[196:199], a[44:47], a[172:175], v[196:199]
M v[196:199], a[40:43], a[168:171], v[196:199]
M v[200:203], a[48:51], a[168:171], v[200:203]
buffer_load_dwordx4 v8, s[12:15], s24 offen offset:2048 lds
M v[200:203], a[52:55], a[172:175], v[200:203]
ds_read_b64_tr_b16 a[156:157], v19 offset:49152
ds_read_b64_tr_b16 a[158:159], v19 offset:51200
M v[204:207], a[60:63], a[172:175], v[204:207]
M v[204:207], a[56:59], a[168:171], v[204:207]
M v[208:211], a[64:67], a[168:171], v[208:211]
M v[208:211], a[68:71], a[172:175], v[208:211]
M v[212:215], a[76:79], a[172:175], v[212:215]
buffer_load_dwordx4 v9, s[12:15], s24 offen offset:3072 lds
M v[212:215], a[72:75], a[168:171], v[212:215]
M v[216:219], a[80:83], a[168:171], v[216:219]
M v[216:219], a[84:87], a[172:175], v[216:219]
M v[220:223], a[92:95], a[172:175], v[220:223]
M v[220:223], a[88:91], a[168:171], v[220:223]
s_waitcnt lgkmcnt(10)
M v[224:227], a[32:35], a[176:179], v[224:227]
s_add_u32 s24, s24, 262144
s_cmp_eq_u32 s24, s27
s_cselect_b32 s24, s28, s24
s_sub_u32 s6, s6, 1
s_cmp_eq_u32 s6, 0
s_cselect_b64 s[12:13], s[64:65], s[12:13]
M v[224:227], a[36:39], a[180:183], v[224:227]
M v[228:231], a[44:47], a[180:183], v[228:231]
M v[228:231], a[40:43], a[176:179], v[228:231]
M v[232:235], a[48:51], a[176:179], v[232:235]
M v[232:235], a[52:55], a[180:183], v[232:235]
M v[236:239], a[60:63], a[180:183], v[236:239]
M v[236:239], a[56:59], a[176:179], v[236:239]
s_waitcnt vmcnt(8) lgkmcnt(0)
s_barrier
ds_read_b128 a[160:163], v10 offset:32768
ds_read_b128 a[164:167], v11 offset:32768
M v[240:243], a[64:67], a[176:179], v[240:243]
s_add_u32 m0, s29, 0
s_nop 0
buffer_load_dwordx4 v2, s[8:11], s23 offen offset:0 lds
M v[240:243], a[68:71], a[180:183], v[240:243]
M v[244:247], a[76:79], a[180:183], v[244:247]
M v[244:247], a[72:75], a[176:179], v[244:247]
M v[248:251], a[80:83], a[176:179], v[248:251]
M v[248:251], a[84:87], a[180:183], v[248:251]
buffer_load_dwordx4 v3, s[8:11], s23 offen offset:1024 lds
M v[252:255], a[92:95], a[180:183], v[252:255]
M v[252:255], a[88:91], a[176:179], v[252:255]
M a[0:3], a[32:35], a[184:187], a[0:3]
M a[0:3], a[36:39], a[188:191], a[0:3]
ds_read_b128 a[168:171], v10 offset:34816
ds_read_b128 a[172:175], v11 offset:34816
M a[4:7], a[44:47], a[188:191], a[4:7]
M a[4:7], a[40:43], a[184:187], a[4:7]
M a[8:11], a[48:51], a[184:187], a[8:11]
buffer_load_dwordx4 v4, s[8:11], s23 offen offset:2048 lds
M a[8:11], a[52:55], a[188:191], a[8:11]
M a[12:15], a[60:63], a[188:191], a[12:15]
M a[12:15], a[56:59], a[184:187], a[12:15]
M a[16:19], a[64:67], a[184:187], a[16:19]
M a[16:19], a[68:71], a[188:191], a[16:19]
buffer_load_dwordx4 v5, s[8:11], s23 offen offset:3072 lds
M a[20:23], a[76:79], a[188:191], a[20:23]
M a[20:23], a[72:75], a[184:187], a[20:23]
M a[24:27], a[80:83], a[184:187], a[24:27]
M a[24:27], a[84:87], a[188:191], a[24:27]
M a[28:31], a[92:95], a[188:191], a[28:31]
M a[28:31], a[88:91], a[184:187], a[28:31]
s_waitcnt lgkmcnt(2)
M v[32:35], a[96:99], a[160:163], v[32:35]
s_add_u32 m0, s29, 98304
s_nop 0
buffer_load_dwordx4 v6, s[12:15], s24 offen offset:0 lds
M v[32:35], a[100:103], a[164:167], v[32:35]
ds_read_b128 a[176:179], v10 offset:36864
ds_read_b128 a[180:183], v11 offset:36864
M v[36:39], a[108:111], a[164:167], v[36:39]
M v[36:39], a[104:107], a[160:163], v[36:39]
ds_read_b64_tr_b16 a[32:33], v12 offset:0
ds_read_b64_tr_b16 a[34:35], v12 offset:2048
M v[40:43], a[112:115], a[160:163], v[40:43]
M v[40:43], a[116:119], a[164:167], v[40:43]
M v[44:47], a[124:127], a[164:167], v[44:47]
M v[44:47], a[120:123], a[160:163], v[44:47]
ds_read_b64_tr_b16 a[40:41], v13 offset:0
ds_read_b64_tr_b16 a[42:43], v13 offset:2048
M v[48:51], a[128:131], a[160:163], v[48:51]
buffer_load_dwordx4 v7, s[12:15], s24 offen offset:1024 lds
M v[48:51], a[132:135], a[164:167], v[48:51]
M v[52:55], a[140:143], a[164:167], v[52:55]
M v[52:55], a[136:139], a[160:163], v[52:55]
ds_read_b64_tr_b16 a[48:49], v14 offset:0
ds_read_b64_tr_b16 a[50:51], v14 offset:2048
M v[56:59], a[144:147], a[160:163], v[56:59]
M v[56:59], a[148:151], a[164:167], v[56:59]
M v[60:63], a[156:159], a[164:167], v[60:63]
buffer_load_dwordx4 v8, s[12:15], s24 offen offset:2048 lds
M v[60:63], a[152:155], a[160:163], v[60:63]
s_waitcnt lgkmcnt(8)
ds_read_b64_tr_b16 a[56:57], v15 offset:0
ds_read_b64_tr_b16 a[58:59], v15 offset:2048
M v[64:67], a[96:99], a[168:171], v[64:67]
M v[64:67], a[100:103], a[172:175], v[64:67]
ds_read_b128 a[184:187], v10 offset:38912
ds_read_b128 a[188:191], v11 offset:38912
M v[68:71], a[108:111], a[172:175], v[68:71]
M v[68:71], a[104:107], a[168:171], v[68:71]
ds_read_b64_tr_b16 a[64:65], v16 offset:0
ds_read_b64_tr_b16 a[66:67], v16 offset:2048
v_cvt_pk_bf16_f32 v32, v32, v33
v_cvt_pk_bf16_f32 v33, v34, v35
M v[72:75], a[112:115], a[168:171], v[72:75]
v_cvt_pk_bf16_f32 v34, v36, v37
v_cvt_pk_bf16_f32 v35, v38, v39
M v[72:75], a[116:119], a[172:175], v[72:75]
v_cvt_pk_bf16_f32 v40, v40, v41
v_cvt_pk_bf16_f32 v41, v42, v43
M v[76:79], a[124:127], a[172:175], v[76:79]
buffer_load_dwordx4 v9, s[12:15], s24 offen offset:3072 lds
v_cvt_pk_bf16_f32 v42, v44, v45
v_cvt_pk_bf16_f32 v43, v46, v47
M v[76:79], a[120:123], a[168:171], v[76:79]
ds_read_b64_tr_b16 a[72:73], v17 offset:0
ds_read_b64_tr_b16 a[74:75], v17 offset:2048
v_cvt_pk_bf16_f32 v48, v48, v49
v_cvt_pk_bf16_f32 v49, v50, v51
M v[80:83], a[128:131], a[168:171], v[80:83]
v_cvt_pk_bf16_f32 v50, v52, v53
v_cvt_pk_bf16_f32 v51, v54, v55
M v[80:83], a[132:135], a[172:175], v[80:83]
v_cvt_pk_bf16_f32 v56, v56, v57
v_cvt_pk_bf16_f32 v57, v58, v59
M v[84:87], a[140:143], a[172:175], v[84:87]
v_cvt_pk_bf16_f32 v58, v60, v61
v_cvt_pk_bf16_f32 v59, v62, v63
M v[84:87], a[136:139], a[168:171], v[84:87]
ds_read_b64_tr_b16 a[80:81], v18 offset:0
ds_read_b64_tr_b16 a[82:83], v18 offset:2048
M v[88:91], a[144:147], a[168:171], v[88:91]
M v[88:91], a[148:151], a[172:175], v[88:91]
s_add_u32 s24, s24, 262144
M v[92:95], a[156:159], a[172:175], v[92:95]
s_add_u32 s94, s92, 0
buffer_store_dwordx4 v[32:35], v1, s[16:19], s94 offen offset:0 sc1
M v[92:95], a[152:155], a[168:171], v[92:95]
s_waitcnt lgkmcnt(15)
ds_read_b64_tr_b16 a[88:89], v19 offset:0
ds_read_b64_tr_b16 a[90:91], v19 offset:2048
M v[96:99], a[96:99], a[176:179], v[96:99]
M v[96:99], a[100:103], a[180:183], v[96:99]
M v[100:103], a[108:111], a[180:183], v[100:103]
M v[100:103], a[104:107], a[176:179], v[100:103]
v_cvt_pk_bf16_f32 v64, v64, v65
v_cvt_pk_bf16_f32 v65, v66, v67
M v[104:107], a[112:115], a[176:179], v[104:107]
v_cvt_pk_bf16_f32 v66, v68, v69
v_cvt_pk_bf16_f32 v67, v70, v71
M v[104:107], a[116:119], a[180:183], v[104:107]
v_cvt_pk_bf16_f32 v72, v72, v73
v_cvt_pk_bf16_f32 v73, v74, v75
M v[108:111], a[124:127], a[180:183], v[108:111]
v_cvt_pk_bf16_f32 v74, v76, v77
v_cvt_pk_bf16_f32 v75, v78, v79
M v[108:111], a[120:123], a[176:179], v[108:111]
s_waitcnt vmcnt(9) lgkmcnt(0)
s_barrier
ds_read_b128 a[160:163], v10 offset:49152
ds_read_b128 a[164:167], v11 offset:49152
v_cvt_pk_bf16_f32 v80, v80, v81
v_cvt_pk_bf16_f32 v81, v82, v83
M v[112:115], a[128:131], a[176:179], v[112:115]
s_add_u32 s94, s92, 0
buffer_store_dwordx4 v[40:43], v1, s[16:19], s94 offen offset:1024 sc1
v_cvt_pk_bf16_f32 v82, v84, v85
v_cvt_pk_bf16_f32 v83, v86, v87
M v[112:115], a[132:135], a[180:183], v[112:115]
s_add_u32 m0, s29, 16384
s_add_u32 s3, s23, s31
buffer_load_dwordx4 v2, s[8:11], s3 offen offset:0 lds
v_cvt_pk_bf16_f32 v88, v88, v89
v_cvt_pk_bf16_f32 v89, v90, v91
M v[116:119], a[140:143], a[180:183], v[116:119]
v_cvt_pk_bf16_f32 v90, v92, v93
v_cvt_pk_bf16_f32 v91, v94, v95
M v[116:119], a[136:139], a[176:179], v[116:119]
ds_read_b64_tr_b16 a[36:37], v12 offset:16384
ds_read_b64_tr_b16 a[38:39], v12 offset:18432
M v[120:123], a[144:147], a[176:179], v[120:123]
M v[120:123], a[148:151], a[180:183], v[120:123]
M v[124:127], a[156:159], a[180:183], v[124:127]
buffer_load_dwordx4 v3, s[8:11], s3 offen offset:1024 lds
M v[124:127], a[152:155], a[176:179], v[124:127]
M v[128:131], a[96:99], a[184:187], v[128:131]
M v[128:131], a[100:103], a[188:191], v[128:131]
ds_read_b128 a[168:171], v10 offset:51200
ds_read_b128 a[172:175], v11 offset:51200
ds_read_b64_tr_b16 a[44:45], v13 offset:16384
ds_read_b64_tr_b16 a[46:47], v13 offset:18432
M v[132:135], a[108:111], a[188:191], v[132:135]
M v[132:135], a[104:107], a[184:187], v[132:135]
s_add_u32 s94, s92, 0
buffer_store_dwordx4 v[48:51], v1, s[16:19], s94 offen offset:2048 sc1
v_cvt_pk_bf16_f32 v96, v96, v97
v_cvt_pk_bf16_f32 v97, v98, v99
M v[136:139], a[112:115], a[184:187], v[136:139]
v_cvt_pk_bf16_f32 v98, v100, v101
v_cvt_pk_bf16_f32 v99, v102, v103
M v[136:139], a[116:119], a[188:191], v[136:139]
buffer_load_dwordx4 v4, s[8:11], s3 offen offset:2048 lds
v_cvt_pk_bf16_f32 v104, v104, v105
v_cvt_pk_bf16_f32 v105, v106, v107
M v[140:143], a[124:127], a[188:191], v[140:143]
v_cvt_pk_bf16_f32 v106, v108, v109
v_cvt_pk_bf16_f32 v107, v110, v111
M v[140:143], a[120:123], a[184:187], v[140:143]
ds_read_b64_tr_b16 a[52:53], v14 offset:16384
ds_read_b64_tr_b16 a[54:55], v14 offset:18432
v_cvt_pk_bf16_f32 v112, v112, v113
v_cvt_pk_bf16_f32 v113, v114, v115
M v[144:147], a[128:131], a[184:187], v[144:147]
v_cvt_pk_bf16_f32 v114, v116, v117
v_cvt_pk_bf16_f32 v115, v118, v119
M v[144:147], a[132:135], a[188:191], v[144:147]
v_cvt_pk_bf16_f32 v120, v120, v121
v_cvt_pk_bf16_f32 v121, v122, v123
M v[148:151], a[140:143], a[188:191], v[148:151]
buffer_load_dwordx4 v5, s[8:11], s3 offen offset:3072 lds
v_cvt_pk_bf16_f32 v122, v124, v125
v_cvt_pk_bf16_f32 v123, v126, v127
M v[148:151], a[136:139], a[184:187], v[148:151]
M v[152:155], a[144:147], a[184:187], v[152:155]
M v[152:155], a[148:151], a[188:191], v[152:155]
ds_read_b64_tr_b16 a[60:61], v15 offset:16384
ds_read_b64_tr_b16 a[62:63], v15 offset:18432
M v[156:159], a[156:159], a[188:191], v[156:159]
s_add_u32 s94, s92, 0
buffer_store_dwordx4 v[56:59], v1, s[16:19], s94 offen offset:3072 sc1
M v[156:159], a[152:155], a[184:187], v[156:159]
s_waitcnt lgkmcnt(10)
M v[160:163], a[96:99], a[160:163], v[160:163]
M v[160:163], a[100:103], a[164:167], v[160:163]
ds_read_b128 a[176:179], v10 offset:53248
ds_read_b128 a[180:183], v11 offset:53248
M v[164:167], a[108:111], a[164:167], v[164:167]
s_add_u32 s23, s23, 128
s_cmp_eq_u32 s23, s25
s_cselect_b32 s23, s26, s23
M v[164:167], a[104:107], a[160:163], v[164:167]
ds_read_b64_tr_b16 a[68:69], v16 offset:16384
ds_read_b64_tr_b16 a[70:71], v16 offset:18432
v_cvt_pk_bf16_f32 v128, v128, v129
v_cvt_pk_bf16_f32 v129, v130, v131
M v[168:171], a[112:115], a[160:163], v[168:171]
v_cvt_pk_bf16_f32 v130, v132, v133
v_cvt_pk_bf16_f32 v131, v134, v135
M v[168:171], a[116:119], a[164:167], v[168:171]
v_cvt_pk_bf16_f32 v136, v136, v137
v_cvt_pk_bf16_f32 v137, v138, v139
M v[172:175], a[124:127], a[164:167], v[172:175]
v_cvt_pk_bf16_f32 v138, v140, v141
v_cvt_pk_bf16_f32 v139, v142, v143
M v[172:175], a[120:123], a[160:163], v[172:175]
v_cvt_pk_bf16_f32 v144, v144, v145
v_cvt_pk_bf16_f32 v145, v146, v147
M v[176:179], a[128:131], a[160:163], v[176:179]
s_add_u32 s94, s92, 4096
buffer_store_dwordx4 v[64:67], v1, s[16:19], s94 offen offset:0 sc1
v_cvt_pk_bf16_f32 v146, v148, v149
v_cvt_pk_bf16_f32 v147, v150, v151
M v[176:179], a[132:135], a[164:167], v[176:179]
ds_read_b64_tr_b16 a[76:77], v17 offset:16384
ds_read_b64_tr_b16 a[78:79], v17 offset:18432
v_cvt_pk_bf16_f32 v152, v152, v153
v_cvt_pk_bf16_f32 v153, v154, v155
M v[180:183], a[140:143], a[164:167], v[180:183]
s_add_u32 m0, s29, 114688
s_nop 0
buffer_load_dwordx4 v6, s[12:15], s24 offen offset:0 lds
v_cvt_pk_bf16_f32 v154, v156, v157
v_cvt_pk_bf16_f32 v155, v158, v159
M v[180:183], a[136:139], a[160:163], v[180:183]
M v[184:187], a[144:147], a[160:163], v[184:187]
v_accvgpr_write_b32 a192, v128
v_accvgpr_write_b32 a193, v129
v_accvgpr_write_b32 a194, v130
v_accvgpr_write_b32 a195, v131
M v[184:187], a[148:151], a[164:167], v[184:187]
v_accvgpr_write_b32 a196, v136
v_accvgpr_write_b32 a197, v137
v_accvgpr_write_b32 a198, v138
v_accvgpr_write_b32 a199, v139
M v[188:191], a[156:159], a[164:167], v[188:191]
buffer_load_dwordx4 v7, s[12:15], s24 offen offset:1024 lds
v_accvgpr_write_b32 a200, v144
v_accvgpr_write_b32 a201, v145
v_accvgpr_write_b32 a202, v146
v_accvgpr_write_b32 a203, v147
M v[188:191], a[152:155], a[160:163], v[188:191]
s_waitcnt lgkmcnt(12)
ds_read_b64_tr_b16 a[84:85], v18 offset:16384
ds_read_b64_tr_b16 a[86:87], v18 offset:18432
v_accvgpr_write_b32 a204, v152
v_accvgpr_write_b32 a205, v153
v_accvgpr_write_b32 a206, v154
v_accvgpr_write_b32 a207, v155
M v[192:195], a[96:99], a[168:171], v[192:195]
M v[192:195], a[100:103], a[172:175], v[192:195]
ds_read_b128 a[184:187], v10 offset:55296
ds_read_b128 a[188:191], v11 offset:55296
M v[196:199], a[108:111], a[172:175], v[196:199]
s_add_u32 s94, s92, 4096
buffer_store_dwordx4 v[72:75], v1, s[16:19], s94 offen offset:1024 sc1
M v[196:199], a[104:107], a[168:171], v[196:199]
v_cvt_pk_bf16_f32 v160, v160, v161
v_cvt_pk_bf16_f32 v161, v162, v163
M v[200:203], a[112:115], a[168:171], v[200:203]
v_cvt_pk_bf16_f32 v162, v164, v165
v_cvt_pk_bf16_f32 v163, v166, v167
M v[200:203], a[116:119], a[172:175], v[200:203]
ds_read_b64_tr_b16 a[92:93], v19 offset:16384
ds_read_b64_tr_b16 a[94:95], v19 offset:18432
v_cvt_pk_bf16_f32 v168, v168, v169
v_cvt_pk_bf16_f32 v169, v170, v171
M v[204:207], a[124:127], a[172:175], v[204:207]
buffer_load_dwordx4 v8, s[12:15], s24 offen offset:2048 lds
v_cvt_pk_bf16_f32 v170, v172, v173
v_cvt_pk_bf16_f32 v171, v174, v175
M v[204:207], a[120:123], a[168:171], v[204:207]
v_cvt_pk_bf16_f32 v176, v176, v177
v_cvt_pk_bf16_f32 v177, v178, v179
M v[208:211], a[128:131], a[168:171], v[208:211]
v_cvt_pk_bf16_f32 v178, v180, v181
v_cvt_pk_bf16_f32 v179, v182, v183
M v[208:211], a[132:135], a[172:175], v[208:211]
v_cvt_pk_bf16_f32 v184, v184, v185
v_cvt_pk_bf16_f32 v185, v186, v187
M v[212:215], a[140:143], a[172:175], v[212:215]
buffer_load_dwordx4 v9, s[12:15], s24 offen offset:3072 lds
v_cvt_pk_bf16_f32 v186, v188, v189
v_cvt_pk_bf16_f32 v187, v190, v191
M v[212:215], a[136:139], a[168:171], v[212:215]
M v[216:219], a[144:147], a[168:171], v[216:219]
v_accvgpr_write_b32 a208, v160
v_accvgpr_write_b32 a209, v161
v_accvgpr_write_b32 a210, v162
v_accvgpr_write_b32 a211, v163
M v[216:219], a[148:151], a[172:175], v[216:219]
s_add_u32 s94, s92, 4096
buffer_store_dwordx4 v[80:83], v1, s[16:19], s94 offen offset:2048 sc1
v_accvgpr_write_b32 a212, v168
v_accvgpr_write_b32 a213, v169
v_accvgpr_write_b32 a214, v170
v_accvgpr_write_b32 a215, v171
M v[220:223], a[156:159], a[172:175], v[220:223]
v_accvgpr_write_b32 a216, v176
v_accvgpr_write_b32 a217, v177
v_accvgpr_write_b32 a218, v178
v_accvgpr_write_b32 a219, v179
M v[220:223], a[152:155], a[168:171], v[220:223]
s_waitcnt lgkmcnt(10)
v_accvgpr_write_b32 a220, v184
v_accvgpr_write_b32 a221, v185
v_accvgpr_write_b32 a222, v186
v_accvgpr_write_b32 a223, v187
M v[224:227], a[96:99], a[176:179], v[224:227]
s_add_u32 s24, s24, 262144
s_cmp_eq_u32 s24, s27
s_cselect_b32 s24, s28, s24
s_sub_u32 s6, s6, 1
s_cmp_eq_u32 s6, 0
s_cselect_b64 s[12:13], s[64:65], s[12:13]
M v[224:227], a[100:103], a[180:183], v[224:227]
M v[228:231], a[108:111], a[180:183], v[228:231]
M v[228:231], a[104:107], a[176:179], v[228:231]
v_cvt_pk_bf16_f32 v192, v192, v193
v_cvt_pk_bf16_f32 v193, v194, v195
M v[232:235], a[112:115], a[176:179], v[232:235]
v_cvt_pk_bf16_f32 v194, v196, v197
v_cvt_pk_bf16_f32 v195, v198, v199
M v[232:235], a[116:119], a[180:183], v[232:235]
v_cvt_pk_bf16_f32 v200, v200, v201
v_cvt_pk_bf16_f32 v201, v202, v203
M v[236:239], a[124:127], a[180:183], v[236:239]
v_cvt_pk_bf16_f32 v202, v204, v205
v_cvt_pk_bf16_f32 v203, v206, v207
M v[236:239], a[120:123], a[176:179], v[236:239]
s_waitcnt vmcnt(15) lgkmcnt(0)
s_barrier
ds_read_b128 a[160:163], v10 offset:0
ds_read_b128 a[164:167], v11 offset:0
v_cvt_pk_bf16_f32 v208, v208, v209
v_cvt_pk_bf16_f32 v209, v210, v211
M v[240:243], a[128:131], a[176:179], v[240:243]
s_add_u32 s94, s92, 4096
buffer_store_dwordx4 v[88:91], v1, s[16:19], s94 offen offset:3072 sc1
v_cvt_pk_bf16_f32 v210, v212, v213
v_cvt_pk_bf16_f32 v211, v214, v215
M v[240:243], a[132:135], a[180:183], v[240:243]
s_add_u32 m0, s29, 32768
s_nop 0
buffer_load_dwordx4 v2, s[8:11], s23 offen offset:0 lds
v_cvt_pk_bf16_f32 v216, v216, v217
v_cvt_pk_bf16_f32 v217, v218, v219
M v[244:247], a[140:143], a[180:183], v[244:247]
v_cvt_pk_bf16_f32 v218, v220, v221
v_cvt_pk_bf16_f32 v219, v222, v223
M v[244:247], a[136:139], a[176:179], v[244:247]
M v[248:251], a[144:147], a[176:179], v[248:251]
v_accvgpr_write_b32 a224, v192
v_accvgpr_write_b32 a225, v193
v_accvgpr_write_b32 a226, v194
v_accvgpr_write_b32 a227, v195
M v[248:251], a[148:151], a[180:183], v[248:251]
buffer_load_dwordx4 v3, s[8:11], s23 offen offset:1024 lds
v_accvgpr_write_b32 a228, v200
v_accvgpr_write_b32 a229, v201
v_accvgpr_write_b32 a230, v202
v_accvgpr_write_b32 a231, v203
M v[252:255], a[156:159], a[180:183], v[252:255]
v_accvgpr_write_b32 a232, v208
v_accvgpr_write_b32 a233, v209
v_accvgpr_write_b32 a234, v210
v_accvgpr_write_b32 a235, v211
M v[252:255], a[152:155], a[176:179], v[252:255]
v_accvgpr_write_b32 a236, v216
v_accvgpr_write_b32 a237, v217
v_accvgpr_write_b32 a238, v218
v_accvgpr_write_b32 a239, v219
M a[0:3], a[96:99], a[184:187], a[0:3]
M a[0:3], a[100:103], a[188:191], a[0:3]
ds_read_b128 a[168:171], v10 offset:2048
ds_read_b128 a[172:175], v11 offset:2048
M a[4:7], a[108:111], a[188:191], a[4:7]
s_add_u32 s94, s92, 8192
buffer_store_dwordx4 v[96:99], v1, s[16:19], s94 offen offset:0 sc1
M a[4:7], a[104:107], a[184:187], a[4:7]
v_cvt_pk_bf16_f32 v224, v224, v225
v_cvt_pk_bf16_f32 v225, v226, v227
M a[8:11], a[112:115], a[184:187], a[8:11]
v_cvt_pk_bf16_f32 v226, v228, v229
v_cvt_pk_bf16_f32 v227, v230, v231
M a[8:11], a[116:119], a[188:191], a[8:11]
buffer_load_dwordx4 v4, s[8:11], s23 offen offset:2048 lds
v_cvt_pk_bf16_f32 v232, v232, v233
v_cvt_pk_bf16_f32 v233, v234, v235
M a[12:15], a[124:127], a[188:191], a[12:15]
v_cvt_pk_bf16_f32 v234, v236, v237
v_cvt_pk_bf16_f32 v235, v238, v239
M a[12:15], a[120:123], a[184:187], a[12:15]
v_cvt_pk_bf16_f32 v240, v240, v241
v_cvt_pk_bf16_f32 v241, v242, v243
M a[16:19], a[128:131], a[184:187], a[16:19]
v_cvt_pk_bf16_f32 v242, v244, v245
v_cvt_pk_bf16_f32 v243, v246, v247
M a[16:19], a[132:135], a[188:191], a[16:19]
buffer_load_dwordx4 v5, s[8:11], s23 offen offset:3072 lds
v_cvt_pk_bf16_f32 v248, v248, v249
v_cvt_pk_bf16_f32 v249, v250, v251
M a[20:23], a[140:143], a[188:191], a[20:23]
v_cvt_pk_bf16_f32 v250, v252, v253
v_cvt_pk_bf16_f32 v251, v254, v255
M a[20:23], a[136:139], a[184:187], a[20:23]
M a[24:27], a[144:147], a[184:187], a[24:27]
s_add_u32 s94, s92, 8192
buffer_store_dwordx4 v[104:107], v1, s[16:19], s94 offen offset:1024 sc1
v_accvgpr_write_b32 a240, v224
v_accvgpr_write_b32 a241, v225
v_accvgpr_write_b32 a242, v226
v_accvgpr_write_b32 a243, v227
M a[24:27], a[148:151], a[188:191], a[24:27]
v_accvgpr_write_b32 a244, v232
v_accvgpr_write_b32 a245, v233
v_accvgpr_write_b32 a246, v234
v_accvgpr_write_b32 a247, v235
M a[28:31], a[156:159], a[188:191], a[28:31]
v_accvgpr_write_b32 a248, v240
v_accvgpr_write_b32 a249, v241
v_accvgpr_write_b32 a250, v242
v_accvgpr_write_b32 a251, v243
M a[28:31], a[152:155], a[184:187], a[28:31]
s_waitcnt lgkmcnt(2)
v_accvgpr_write_b32 a252, v248
v_accvgpr_write_b32 a253, v249
v_accvgpr_write_b32 a254, v250
v_accvgpr_write_b32 a255, v251
M v[32:35], a[160:163], a[32:35], 0
s_add_u32 m0, s29, 65536
s_nop 0
buffer_load_dwordx4 v6, s[12:15], s24 offen offset:0 lds
M v[32:35], a[164:167], a[36:39], v[32:35]
ds_read_b128 a[176:179], v10 offset:4096
ds_read_b128 a[180:183], v11 offset:4096
M v[36:39], a[164:167], a[44:47], 0
M v[36:39], a[160:163], a[40:43], v[36:39]
ds_read_b64_tr_b16 a[96:97], v12 offset:32768
ds_read_b64_tr_b16 a[98:99], v12 offset:34816
M v[40:43], a[160:163], a[48:51], 0
M v[40:43], a[164:167], a[52:55], v[40:43]
M v[44:47], a[164:167], a[60:63], 0
buffer_load_dwordx4 v7, s[12:15], s24 offen offset:1024 lds
M v[44:47], a[160:163], a[56:59], v[44:47]
ds_read_b64_tr_b16 a[104:105], v13 offset:32768
ds_read_b64_tr_b16 a[106:107], v13 offset:34816
M v[48:51], a[160:163], a[64:67], 0
s_add_u32 s94, s92, 8192
buffer_store_dwordx4 v[112:115], v1, s[16:19], s94 offen offset:2048 sc1
M v[48:51], a[164:167], a[68:71], v[48:51]
M v[52:55], a[164:167], a[76:79], 0
M v[52:55], a[160:163], a[72:75], v[52:55]
ds_read_b64_tr_b16 a[112:113], v14 offset:32768
ds_read_b64_tr_b16 a[114:115], v14 offset:34816
M v[56:59], a[160:163], a[80:83], 0
M v[56:59], a[164:167], a[84:87], v[56:59]
M v[60:63], a[164:167], a[92:95], 0
buffer_load_dwordx4 v8, s[12:15], s24 offen offset:2048 lds
M v[60:63], a[160:163], a[88:91], v[60:63]
s_waitcnt lgkmcnt(8)
ds_read_b64_tr_b16 a[120:121], v15 offset:32768
ds_read_b64_tr_b16 a[122:123], v15 offset:34816
M v[64:67], a[168:171], a[32:35], 0
M v[64:67], a[172:175], a[36:39], v[64:67]
ds_read_b128 a[184:187], v10 offset:6144
ds_read_b128 a[188:191], v11 offset:6144
M v[68:71], a[172:175], a[44:47], 0
s_add_u32 s94, s92, 8192
buffer_store_dwordx4 v[120:123], v1, s[16:19], s94 offen offset:3072 sc1
M v[68:71], a[168:171], a[40:43], v[68:71]
ds_read_b64_tr_b16 a[128:129], v16 offset:32768
ds_read_b64_tr_b16 a[130:131], v16 offset:34816
M v[72:75], a[168:171], a[48:51], 0
v_accvgpr_read_b32 v24, a0
v_accvgpr_read_b32 v25, a1
M v[72:75], a[172:175], a[52:55], v[72:75]
v_accvgpr_read_b32 v26, a2
v_accvgpr_read_b32 v27, a3
M v[76:79], a[172:175], a[60:63], 0
v_accvgpr_read_b32 v28, a4
v_accvgpr_read_b32 v29, a5
M v[76:79], a[168:171], a[56:59], v[76:79]
ds_read_b64_tr_b16 a[136:137], v17 offset:32768
ds_read_b64_tr_b16 a[138:139], v17 offset:34816
v_accvgpr_read_b32 v30, a6
v_accvgpr_read_b32 v31, a7
M v[80:83], a[168:171], a[64:67], 0
buffer_load_dwordx4 v9, s[12:15], s24 offen offset:3072 lds
v_cvt_pk_bf16_f32 v24, v24, v25
v_cvt_pk_bf16_f32 v25, v26, v27
M v[80:83], a[172:175], a[68:71], v[80:83]
v_cvt_pk_bf16_f32 v26, v28, v29
v_cvt_pk_bf16_f32 v27, v30, v31
M v[84:87], a[172:175], a[76:79], 0
M v[84:87], a[168:171], a[72:75], v[84:87]
ds_read_b64_tr_b16 a[144:145], v18 offset:32768
ds_read_b64_tr_b16 a[146:147], v18 offset:34816
M v[88:91], a[168:171], a[80:83], 0
M v[88:91], a[172:175], a[84:87], v[88:91]
s_add_u32 s94, s93, 12288
buffer_store_dwordx4 v[24:27], v1, s[16:19], s94 offen offset:0 sc1
M v[92:95], a[172:175], a[92:95], 0
M v[92:95], a[168:171], a[88:91], v[92:95]
s_waitcnt lgkmcnt(15)
ds_read_b64_tr_b16 a[152:153], v19 offset:32768
ds_read_b64_tr_b16 a[154:155], v19 offset:34816
M v[96:99], a[176:179], a[32:35], 0
s_add_u32 s24, s24, 262144
M v[96:99], a[180:183], a[36:39], v[96:99]
M v[100:103], a[180:183], a[44:47], 0
M v[100:103], a[176:179], a[40:43], v[100:103]
M v[104:107], a[176:179], a[48:51], 0
M v[104:107], a[180:183], a[52:55], v[104:107]
M v[108:111], a[180:183], a[60:63], 0
M v[108:111], a[176:179], a[56:59], v[108:111]
s_waitcnt vmcnt(15) lgkmcnt(0)
s_barrier
ds_read_b128 a[160:163], v10 offset:16384
ds_read_b128 a[164:167], v11 offset:16384
M v[112:115], a[176:179], a[64:67], 0
s_add_u32 m0, s29, 49152
s_add_u32 s3, s23, s31
buffer_load_dwordx4 v2, s[8:11], s3 offen offset:0 lds
M v[112:115], a[180:183], a[68:71], v[112:115]
M v[116:119], a[180:183], a[76:79], 0
M v[116:119], a[176:179], a[72:75], v[116:119]
ds_read_b64_tr_b16 a[100:101], v12 offset:49152
ds_read_b64_tr_b16 a[102:103], v12 offset:51200
M v[120:123], a[176:179], a[80:83], 0
v_accvgpr_read_b32 v24, a8
v_accvgpr_read_b32 v25, a9
M v[120:123], a[180:183], a[84:87], v[120:123]
buffer_load_dwordx4 v3, s[8:11], s3 offen offset:1024 lds
v_accvgpr_read_b32 v26, a10
v_accvgpr_read_b32 v27, a11
M v[124:127], a[180:183], a[92:95], 0
v_accvgpr_read_b32 v28, a12
v_accvgpr_read_b32 v29, a13
M v[124:127], a[176:179], a[88:91], v[124:127]
v_accvgpr_read_b32 v30, a14
v_accvgpr_read_b32 v31, a15
M v[128:131], a[184:187], a[32:35], 0
v_cvt_pk_bf16_f32 v24, v24, v25
v_cvt_pk_bf16_f32 v25, v26, v27
M v[128:131], a[188:191], a[36:39], v[128:131]
ds_read_b128 a[168:171], v10 offset:18432
ds_read_b128 a[172:175], v11 offset:18432
ds_read_b64_tr_b16 a[108:109], v13 offset:49152
ds_read_b64_tr_b16 a[110:111], v13 offset:51200
v_cvt_pk_bf16_f32 v26, v28, v29
v_cvt_pk_bf16_f32 v27, v30, v31
M v[132:135], a[188:191], a[44:47], 0
M v[132:135], a[184:187], a[40:43], v[132:135]
M v[136:139], a[184:187], a[48:51], 0
buffer_load_dwordx4 v4, s[8:11], s3 offen offset:2048 lds
M v[136:139], a[188:191], a[52:55], v[136:139]
s_add_u32 s94, s93, 12288
buffer_store_dwordx4 v[24:27], v1, s[16:19], s94 offen offset:1024 sc1
M v[140:143], a[188:191], a[60:63], 0
M v[140:143], a[184:187], a[56:59], v[140:143]
ds_read_b64_tr_b16 a[116:117], v14 offset:49152
ds_read_b64_tr_b16 a[118:119], v14 offset:51200
M v[144:147], a[184:187], a[64:67], 0
M v[144:147], a[188:191], a[68:71], v[144:147]
M v[148:151], a[188:191], a[76:79], 0
buffer_load_dwordx4 v5, s[8:11], s3 offen offset:3072 lds
M v[148:151], a[184:187], a[72:75], v[148:151]
M v[152:155], a[184:187], a[80:83], 0
M v[152:155], a[188:191], a[84:87], v[152:155]
ds_read_b64_tr_b16 a[124:125], v15 offset:49152
ds_read_b64_tr_b16 a[126:127], v15 offset:51200
M v[156:159], a[188:191], a[92:95], 0
M v[156:159], a[184:187], a[88:91], v[156:159]
s_waitcnt lgkmcnt(10)
M v[160:163], a[160:163], a[32:35], 0
M v[160:163], a[164:167], a[36:39], v[160:163]
ds_read_b128 a[176:179], v10 offset:20480
ds_read_b128 a[180:183], v11 offset:20480
M v[164:167], a[164:167], a[44:47], 0
s_add_u32 s23, s23, 128
s_cmp_eq_u32 s23, s25
s_cselect_b32 s23, s26, s23
M v[164:167], a[160:163], a[40:43], v[164:167]
ds_read_b64_tr_b16 a[132:133], v16 offset:49152
ds_read_b64_tr_b16 a[134:135], v16 offset:51200
M v[168:171], a[160:163], a[48:51], 0
v_accvgpr_read_b32 v24, a16
v_accvgpr_read_b32 v25, a17
M v[168:171], a[164:167], a[52:55], v[168:171]
v_accvgpr_read_b32 v26, a18
v_accvgpr_read_b32 v27, a19
M v[172:175], a[164:167], a[60:63], 0
v_accvgpr_read_b32 v28, a20
v_accvgpr_read_b32 v29, a21
M v[172:175], a[160:163], a[56:59], v[172:175]
v_accvgpr_read_b32 v30, a22
v_accvgpr_read_b32 v31, a23
M v[176:179], a[160:163], a[64:67], 0
s_add_u32 m0, s29, 81920
s_nop 0
buffer_load_dwordx4 v6, s[12:15], s24 offen offset:0 lds
v_cvt_pk_bf16_f32 v24, v24, v25
v_cvt_pk_bf16_f32 v25, v26, v27
M v[176:179], a[164:167], a[68:71], v[176:179]
ds_read_b64_tr_b16 a[140:141], v17 offset:49152
ds_read_b64_tr_b16 a[142:143], v17 offset:51200
v_cvt_pk_bf16_f32 v26, v28, v29
v_cvt_pk_bf16_f32 v27, v30, v31
M v[180:183], a[164:167], a[76:79], 0
M v[180:183], a[160:163], a[72:75], v[180:183]
M v[184:187], a[160:163], a[80:83], 0
M v[184:187], a[164:167], a[84:87], v[184:187]
s_add_u32 s94, s93, 12288
buffer_store_dwordx4 v[24:27], v1, s[16:19], s94 offen offset:2048 sc1
M v[188:191], a[164:167], a[92:95], 0
buffer_load_dwordx4 v7, s[12:15], s24 offen offset:1024 lds
M v[188:191], a[160:163], a[88:91], v[188:191]
s_waitcnt lgkmcnt(12)
ds_read_b64_tr_b16 a[148:149], v18 offset:49152
ds_read_b64_tr_b16 a[150:151], v18 offset:51200
M v[192:195], a[168:171], a[32:35], 0
M v[192:195], a[172:175], a[36:39], v[192:195]
ds_read_b128 a[184:187], v10 offset:22528
ds_read_b128 a[188:191], v11 offset:22528
M v[196:199], a[172:175], a[44:47], 0
M v[196:199], a[168:171], a[40:43], v[196:199]
M v[200:203], a[168:171], a[48:51], 0
M v[200:203], a[172:175], a[52:55], v[200:203]
ds_read_b64_tr_b16 a[156:157], v19 offset:49152
ds_read_b64_tr_b16 a[158:159], v19 offset:51200
M v[204:207], a[172:175], a[60:63], 0
buffer_load_dwordx4 v8, s[12:15], s24 offen offset:2048 lds
M v[204:207], a[168:171], a[56:59], v[204:207]
M v[208:211], a[168:171], a[64:67], 0
M v[208:211], a[172:175], a[68:71], v[208:211]
M v[212:215], a[172:175], a[76:79], 0
buffer_load_dwordx4 v9, s[12:15], s24 offen offset:3072 lds
M v[212:215], a[168:171], a[72:75], v[212:215]
M v[216:219], a[168:171], a[80:83], 0
v_accvgpr_read_b32 v24, a24
v_accvgpr_read_b32 v25, a25
M v[216:219], a[172:175], a[84:87], v[216:219]
v_accvgpr_read_b32 v26, a26
v_accvgpr_read_b32 v27, a27
M v[220:223], a[172:175], a[92:95], 0
v_accvgpr_read_b32 v28, a28
v_accvgpr_read_b32 v29, a29
M v[220:223], a[168:171], a[88:91], v[220:223]
s_waitcnt lgkmcnt(10)
v_accvgpr_read_b32 v30, a30
v_accvgpr_read_b32 v31, a31
M v[224:227], a[176:179], a[32:35], 0
s_add_u32 s24, s24, 262144
s_cmp_eq_u32 s24, s27
s_cselect_b32 s24, s28, s24
s_sub_u32 s6, s6, 1
s_cmp_eq_u32 s6, 0
s_cselect_b64 s[12:13], s[64:65], s[12:13]
v_cvt_pk_bf16_f32 v24, v24, v25
v_cvt_pk_bf16_f32 v25, v26, v27
M v[224:227], a[180:183], a[36:39], v[224:227]
v_cvt_pk_bf16_f32 v26, v28, v29
v_cvt_pk_bf16_f32 v27, v30, v31
M v[228:231], a[180:183], a[44:47], 0
M v[228:231], a[176:179], a[40:43], v[228:231]
M v[232:235], a[176:179], a[48:51], 0
M v[232:235], a[180:183], a[52:55], v[232:235]
s_add_u32 s94, s93, 12288
buffer_store_dwordx4 v[24:27], v1, s[16:19], s94 offen offset:3072 sc1
M v[236:239], a[180:183], a[60:63], 0
M v[236:239], a[176:179], a[56:59], v[236:239]
s_waitcnt vmcnt(12) lgkmcnt(0)
s_barrier
ds_read_b128 a[160:163], v10 offset:32768
ds_read_b128 a[164:167], v11 offset:32768
M v[240:243], a[176:179], a[64:67], 0
s_add_u32 m0, s29, 0
s_nop 0
buffer_load_dwordx4 v2, s[8:11], s23 offen offset:0 lds
M v[240:243], a[180:183], a[68:71], v[240:243]
M v[244:247], a[180:183], a[76:79], 0
M v[244:247], a[176:179], a[72:75], v[244:247]
M v[248:251], a[176:179], a[80:83], 0
M v[248:251], a[180:183], a[84:87], v[248:251]
buffer_load_dwordx4 v3, s[8:11], s23 offen offset:1024 lds
M v[252:255], a[180:183], a[92:95], 0
M v[252:255], a[176:179], a[88:91], v[252:255]
M a[0:3], a[184:187], a[32:35], 0
M a[0:3], a[188:191], a[36:39], a[0:3]
ds_read_b128 a[168:171], v10 offset:34816
ds_read_b128 a[172:175], v11 offset:34816
M a[4:7], a[188:191], a[44:47], 0
M a[4:7], a[184:187], a[40:43], a[4:7]
M a[8:11], a[184:187], a[48:51], 0
buffer_load_dwordx4 v4, s[8:11], s23 offen offset:2048 lds
M a[8:11], a[188:191], a[52:55], a[8:11]
M a[12:15], a[188:191], a[60:63], 0
M a[12:15], a[184:187], a[56:59], a[12:15]
M a[16:19], a[184:187], a[64:67], 0
M a[16:19], a[188:191], a[68:71], a[16:19]
buffer_load_dwordx4 v5, s[8:11], s23 offen offset:3072 lds
M a[20:23], a[188:191], a[76:79], 0
M a[20:23], a[184:187], a[72:75], a[20:23]
M a[24:27], a[184:187], a[80:83], 0
M a[24:27], a[188:191], a[84:87], a[24:27]
M a[28:31], a[188:191], a[92:95], 0
M a[28:31], a[184:187], a[88:91], a[28:31]
s_waitcnt lgkmcnt(2)
M v[32:35], a[160:163], a[96:99], v[32:35]
s_add_u32 m0, s29, 98304
s_nop 0
buffer_load_dwordx4 v6, s[12:15], s24 offen offset:0 lds
M v[32:35], a[164:167], a[100:103], v[32:35]
ds_read_b128 a[176:179], v10 offset:36864
ds_read_b128 a[180:183], v11 offset:36864
M v[36:39], a[164:167], a[108:111], v[36:39]
M v[36:39], a[160:163], a[104:107], v[36:39]
ds_read_b64_tr_b16 a[32:33], v12 offset:0
ds_read_b64_tr_b16 a[34:35], v12 offset:2048
M v[40:43], a[160:163], a[112:115], v[40:43]
M v[40:43], a[164:167], a[116:119], v[40:43]
M v[44:47], a[164:167], a[124:127], v[44:47]
M v[44:47], a[160:163], a[120:123], v[44:47]
ds_read_b64_tr_b16 a[40:41], v13 offset:0
ds_read_b64_tr_b16 a[42:43], v13 offset:2048
M v[48:51], a[160:163], a[128:131], v[48:51]
s_add_u32 s94, s92, 12288
buffer_store_dwordx4 a[192:195], v1, s[16:19], s94 offen offset:0 sc1
M v[48:51], a[164:167], a[132:135], v[48:51]
buffer_load_dwordx4 v7, s[12:15], s24 offen offset:1024 lds
M v[52:55], a[164:167], a[140:143], v[52:55]
M v[52:55], a[160:163], a[136:139], v[52:55]
ds_read_b64_tr_b16 a[48:49], v14 offset:0
ds_read_b64_tr_b16 a[50:51], v14 offset:2048
M v[56:59], a[160:163], a[144:147], v[56:59]
M v[56:59], a[164:167], a[148:151], v[56:59]
M v[60:63], a[164:167], a[156:159], v[60:63]
M v[60:63], a[160:163], a[152:155], v[60:63]
s_waitcnt lgkmcnt(8)
ds_read_b64_tr_b16 a[56:57], v15 offset:0
ds_read_b64_tr_b16 a[58:59], v15 offset:2048
M v[64:67], a[168:171], a[96:99], v[64:67]
buffer_load_dwordx4 v8, s[12:15], s24 offen offset:2048 lds
M v[64:67], a[172:175], a[100:103], v[64:67]
ds_read_b128 a[184:187], v10 offset:38912
ds_read_b128 a[188:191], v11 offset:38912
M v[68:71], a[172:175], a[108:111], v[68:71]
M v[68:71], a[168:171], a[104:107], v[68:71]
ds_read_b64_tr_b16 a[64:65], v16 offset:0
ds_read_b64_tr_b16 a[66:67], v16 offset:2048
M v[72:75], a[168:171], a[112:115], v[72:75]
M v[72:75], a[172:175], a[116:119], v[72:75]
M v[76:79], a[172:175], a[124:127], v[76:79]
M v[76:79], a[168:171], a[120:123], v[76:79]
ds_read_b64_tr_b16 a[72:73], v17 offset:0
ds_read_b64_tr_b16 a[74:75], v17 offset:2048
M v[80:83], a[168:171], a[128:131], v[80:83]
buffer_load_dwordx4 v9, s[12:15], s24 offen offset:3072 lds
M v[80:83], a[172:175], a[132:135], v[80:83]
M v[84:87], a[172:175], a[140:143], v[84:87]
M v[84:87], a[168:171], a[136:139], v[84:87]
ds_read_b64_tr_b16 a[80:81], v18 offset:0
ds_read_b64_tr_b16 a[82:83], v18 offset:2048
M v[88:91], a[168:171], a[144:147], v[88:91]
M v[88:91], a[172:175], a[148:151], v[88:91]
M v[92:95], a[172:175], a[156:159], v[92:95]
s_add_u32 s24, s24, 262144
M v[92:95], a[168:171], a[152:155], v[92:95]
s_waitcnt lgkmcnt(15)
ds_read_b64_tr_b16 a[88:89], v19 offset:0
ds_read_b64_tr_b16 a[90:91], v19 offset:2048
M v[96:99], a[176:179], a[96:99], v[96:99]
M v[96:99], a[180:183], a[100:103], v[96:99]
M v[100:103], a[180:183], a[108:111], v[100:103]
M v[100:103], a[176:179], a[104:107], v[100:103]
M v[104:107], a[176:179], a[112:115], v[104:107]
s_add_u32 s94, s92, 12288
buffer_store_dwordx4 a[196:199], v1, s[16:19], s94 offen offset:1024 sc1
M v[104:107], a[180:183], a[116:119], v[104:107]
M v[108:111], a[180:183], a[124:127], v[108:111]
M v[108:111], a[176:179], a[120:123], v[108:111]
s_waitcnt vmcnt(11) lgkmcnt(0)
s_barrier
ds_read_b128 a[160:163], v10 offset:49152
ds_read_b128 a[164:167], v11 offset:49152
M v[112:115], a[176:179], a[128:131], v[112:115]
s_add_u32 m0, s29, 16384
s_add_u32 s3, s23, s31
buffer_load_dwordx4 v2, s[8:11], s3 offen offset:0 lds
M v[112:115], a[180:183], a[132:135], v[112:115]
M v[116:119], a[180:183], a[140:143], v[116:119]
M v[116:119], a[176:179], a[136:139], v[116:119]
ds_read_b64_tr_b16 a[36:37], v12 offset:16384
ds_read_b64_tr_b16 a[38:39], v12 offset:18432
M v[120:123], a[176:179], a[144:147], v[120:123]
M v[120:123], a[180:183], a[148:151], v[120:123]
buffer_load_dwordx4 v3, s[8:11], s3 offen offset:1024 lds
M v[124:127], a[180:183], a[156:159], v[124:127]
M v[124:127], a[176:179], a[152:155], v[124:127]
M v[128:131], a[184:187], a[96:99], v[128:131]
M v[128:131], a[188:191], a[100:103], v[128:131]
ds_read_b128 a[168:171], v10 offset:51200
ds_read_b128 a[172:175], v11 offset:51200
ds_read_b64_tr_b16 a[44:45], v13 offset:16384
ds_read_b64_tr_b16 a[46:47], v13 offset:18432
M v[132:135], a[188:191], a[108:111], v[132:135]
M v[132:135], a[184:187], a[104:107], v[132:135]
M v[136:139], a[184:187], a[112:115], v[136:139]
buffer_load_dwordx4 v4, s[8:11], s3 offen offset:2048 lds
M v[136:139], a[188:191], a[116:119], v[136:139]
M v[140:143], a[188:191], a[124:127], v[140:143]
M v[140:143], a[184:187], a[120:123], v[140:143]
ds_read_b64_tr_b16 a[52:53], v14 offset:16384
ds_read_b64_tr_b16 a[54:55], v14 offset:18432
M v[144:147], a[184:187], a[128:131], v[144:147]
M v[144:147], a[188:191], a[132:135], v[144:147]
buffer_load_dwordx4 v5, s[8:11], s3 offen offset:3072 lds
M v[148:151], a[188:191], a[140:143], v[148:151]
M v[148:151], a[184:187], a[136:139], v[148:151]
M v[152:155], a[184:187], a[144:147], v[152:155]
M v[152:155], a[188:191], a[148:151], v[152:155]
ds_read_b64_tr_b16 a[60:61], v15 offset:16384
ds_read_b64_tr_b16 a[62:63], v15 offset:18432
M v[156:159], a[188:191], a[156:159], v[156:159]
M v[156:159], a[184:187], a[152:155], v[156:159]
s_waitcnt lgkmcnt(10)
M v[160:163], a[160:163], a[96:99], v[160:163]
s_add_u32 s94, s92, 12288
buffer_store_dwordx4 a[200:203], v1, s[16:19], s94 offen offset:2048 sc1
M v[160:163], a[164:167], a[100:103], v[160:163]
ds_read_b128 a[176:179], v10 offset:53248
ds_read_b128 a[180:183], v11 offset:53248
M v[164:167], a[164:167], a[108:111], v[164:167]
s_add_u32 s23, s23, 128
s_cmp_eq_u32 s23, s25
s_cselect_b32 s23, s26, s23
M v[164:167], a[160:163], a[104:107], v[164:167]
ds_read_b64_tr_b16 a[68:69], v16 offset:16384
ds_read_b64_tr_b16 a[70:71], v16 offset:18432
M v[168:171], a[160:163], a[112:115], v[168:171]
M v[168:171], a[164:167], a[116:119], v[168:171]
M v[172:175], a[164:167], a[124:127], v[172:175]
M v[172:175], a[160:163], a[120:123], v[172:175]
M v[176:179], a[160:163], a[128:131], v[176:179]
s_add_u32 m0, s29, 114688
s_nop 0
buffer_load_dwordx4 v6, s[12:15], s24 offen offset:0 lds
M v[176:179], a[164:167], a[132:135], v[176:179]
ds_read_b64_tr_b16 a[76:77], v17 offset:16384
ds_read_b64_tr_b16 a[78:79], v17 offset:18432
M v[180:183], a[164:167], a[140:143], v[180:183]
M v[180:183], a[160:163], a[136:139], v[180:183]
M v[184:187], a[160:163], a[144:147], v[184:187]
M v[184:187], a[164:167], a[148:151], v[184:187]
buffer_load_dwordx4 v7, s[12:15], s24 offen offset:1024 lds
M v[188:191], a[164:167], a[156:159], v[188:191]
M v[188:191], a[160:163], a[152:155], v[188:191]
s_waitcnt lgkmcnt(12)
ds_read_b64_tr_b16 a[84:85], v18 offset:16384
ds_read_b64_tr_b16 a[86:87], v18 offset:18432
M v[192:195], a[168:171], a[96:99], v[192:195]
M v[192:195], a[172:175], a[100:103], v[192:195]
ds_read_b128 a[184:187], v10 offset:55296
ds_read_b128 a[188:191], v11 offset:55296
M v[196:199], a[172:175], a[108:111], v[196:199]
M v[196:199], a[168:171], a[104:107], v[196:199]
M v[200:203], a[168:171], a[112:115], v[200:203]
buffer_load_dwordx4 v8, s[12:15], s24 offen offset:2048 lds
M v[200:203], a[172:175], a[116:119], v[200:203]
ds_read_b64_tr_b16 a[92:93], v19 offset:16384
ds_read_b64_tr_b16 a[94:95], v19 offset:18432
M v[204:207], a[172:175], a[124:127], v[204:207]
M v[204:207], a[168:171], a[120:123], v[204:207]
M v[208:211], a[168:171], a[128:131], v[208:211]
M v[208:211], a[172:175], a[132:135], v[208:211]
buffer_load_dwordx4 v9, s[12:15], s24 offen offset:3072 lds
M v[212:215], a[172:175], a[140:143], v[212:215]
M v[212:215], a[168:171], a[136:139], v[212:215]
M v[216:219], a[168:171], a[144:147], v[216:219]
s_add_u32 s94, s92, 12288
buffer_store_dwordx4 a[204:207], v1, s[16:19], s94 offen offset:3072 sc1
M v[216:219], a[172:175], a[148:151], v[216:219]
M v[220:223], a[172:175], a[156:159], v[220:223]
M v[220:223], a[168:171], a[152:155], v[220:223]
s_waitcnt lgkmcnt(10)
M v[224:227], a[176:179], a[96:99], v[224:227]
s_add_u32 s24, s24, 262144
s_cmp_eq_u32 s24, s27
s_cselect_b32 s24, s28, s24
s_sub_u32 s6, s6, 1
s_cmp_eq_u32 s6, 0
s_cselect_b64 s[12:13], s[64:65], s[12:13]
M v[224:227], a[180:183], a[100:103], v[224:227]
M v[228:231], a[180:183], a[108:111], v[228:231]
M v[228:231], a[176:179], a[104:107], v[228:231]
M v[232:235], a[176:179], a[112:115], v[232:235]
M v[232:235], a[180:183], a[116:119], v[232:235]
M v[236:239], a[180:183], a[124:127], v[236:239]
M v[236:239], a[176:179], a[120:123], v[236:239]
s_waitcnt vmcnt(11) lgkmcnt(0)
s_barrier
ds_read_b128 a[160:163], v10 offset:0
ds_read_b128 a[164:167], v11 offset:0
M v[240:243], a[176:179], a[128:131], v[240:243]
s_add_u32 m0, s29, 32768
s_nop 0
buffer_load_dwordx4 v2, s[8:11], s23 offen offset:0 lds
M v[240:243], a[180:183], a[132:135], v[240:243]
M v[244:247], a[180:183], a[140:143], v[244:247]
M v[244:247], a[176:179], a[136:139], v[244:247]
M v[248:251], a[176:179], a[144:147], v[248:251]
M v[248:251], a[180:183], a[148:151], v[248:251]
buffer_load_dwordx4 v3, s[8:11], s23 offen offset:1024 lds
M v[252:255], a[180:183], a[156:159], v[252:255]
M v[252:255], a[176:179], a[152:155], v[252:255]
M a[0:3], a[184:187], a[96:99], a[0:3]
M a[0:3], a[188:191], a[100:103], a[0:3]
ds_read_b128 a[168:171], v10 offset:2048
ds_read_b128 a[172:175], v11 offset:2048
M a[4:7], a[188:191], a[108:111], a[4:7]
M a[4:7], a[184:187], a[104:107], a[4:7]
M a[8:11], a[184:187], a[112:115], a[8:11]
buffer_load_dwordx4 v4, s[8:11], s23 offen offset:2048 lds
M a[8:11], a[188:191], a[116:119], a[8:11]
M a[12:15], a[188:191], a[124:127], a[12:15]
M a[12:15], a[184:187], a[120:123], a[12:15]
M a[16:19], a[184:187], a[128:131], a[16:19]
M a[16:19], a[188:191], a[132:135], a[16:19]
buffer_load_dwordx4 v5, s[8:11], s23 offen offset:3072 lds
M a[20:23], a[188:191], a[140:143], a[20:23]
M a[20:23], a[184:187], a[136:139], a[20:23]
M a[24:27], a[184:187], a[144:147], a[24:27]
M a[24:27], a[188:191], a[148:151], a[24:27]
M a[28:31], a[188:191], a[156:159], a[28:31]
M a[28:31], a[184:187], a[152:155], a[28:31]
s_waitcnt lgkmcnt(2)
M v[32:35], a[160:163], a[32:35], v[32:35]
s_add_u32 m0, s29, 65536
s_nop 0
buffer_load_dwordx4 v6, s[12:15], s24 offen offset:0 lds
M v[32:35], a[164:167], a[36:39], v[32:35]
ds_read_b128 a[176:179], v10 offset:4096
ds_read_b128 a[180:183], v11 offset:4096
M v[36:39], a[164:167], a[44:47], v[36:39]
M v[36:39], a[160:163], a[40:43], v[36:39]
ds_read_b64_tr_b16 a[96:97], v12 offset:32768
ds_read_b64_tr_b16 a[98:99], v12 offset:34816
M v[40:43], a[160:163], a[48:51], v[40:43]
M v[40:43], a[164:167], a[52:55], v[40:43]
M v[44:47], a[164:167], a[60:63], v[44:47]
M v[44:47], a[160:163], a[56:59], v[44:47]
ds_read_b64_tr_b16 a[104:105], v13 offset:32768
ds_read_b64_tr_b16 a[106:107], v13 offset:34816
M v[48:51], a[160:163], a[64:67], v[48:51]
s_add_u32 s94, s93, 0
buffer_store_dwordx4 a[208:211], v1, s[16:19], s94 offen offset:0 sc1
M v[48:51], a[164:167], a[68:71], v[48:51]
buffer_load_dwordx4 v7, s[12:15], s24 offen offset:1024 lds
M v[52:55], a[164:167], a[76:79], v[52:55]
M v[52:55], a[160:163], a[72:75], v[52:55]
ds_read_b64_tr_b16 a[112:113], v14 offset:32768
ds_read_b64_tr_b16 a[114:115], v14 offset:34816
M v[56:59], a[160:163], a[80:83], v[56:59]
M v[56:59], a[164:167], a[84:87], v[56:59]
M v[60:63], a[164:167], a[92:95], v[60:63]
M v[60:63], a[160:163], a[88:91], v[60:63]
s_waitcnt lgkmcnt(8)
ds_read_b64_tr_b16 a[120:121], v15 offset:32768
ds_read_b64_tr_b16 a[122:123], v15 offset:34816
M v[64:67], a[168:171], a[32:35], v[64:67]
buffer_load_dwordx4 v8, s[12:15], s24 offen offset:2048 lds
M v[64:67], a[172:175], a[36:39], v[64:67]
ds_read_b128 a[184:187], v10 offset:6144
ds_read_b128 a[188:191], v11 offset:6144
M v[68:71], a[172:175], a[44:47], v[68:71]
M v[68:71], a[168:171], a[40:43], v[68:71]
ds_read_b64_tr_b16 a[128:129], v16 offset:32768
ds_read_b64_tr_b16 a[130:131], v16 offset:34816
M v[72:75], a[168:171], a[48:51], v[72:75]
M v[72:75], a[172:175], a[52:55], v[72:75]
M v[76:79], a[172:175], a[60:63], v[76:79]
M v[76:79], a[168:171], a[56:59], v[76:79]
ds_read_b64_tr_b16 a[136:137], v17 offset:32768
ds_read_b64_tr_b16 a[138:139], v17 offset:34816
M v[80:83], a[168:171], a[64:67], v[80:83]
buffer_load_dwordx4 v9, s[12:15], s24 offen offset:3072 lds
M v[80:83], a[172:175], a[68:71], v[80:83]
M v[84:87], a[172:175], a[76:79], v[84:87]
M v[84:87], a[168:171], a[72:75], v[84:87]
ds_read_b64_tr_b16 a[144:145], v18 offset:32768
ds_read_b64_tr_b16 a[146:147], v18 offset:34816
M v[88:91], a[168:171], a[80:83], v[88:91]
M v[88:91], a[172:175], a[84:87], v[88:91]
M v[92:95], a[172:175], a[92:95], v[92:95]
s_add_u32 s24, s24, 262144
M v[92:95], a[168:171], a[88:91], v[92:95]
s_waitcnt lgkmcnt(15)
ds_read_b64_tr_b16 a[152:153], v19 offset:32768
ds_read_b64_tr_b16 a[154:155], v19 offset:34816
M v[96:99], a[176:179], a[32:35], v[96:99]
M v[96:99], a[180:183], a[36:39], v[96:99]
M v[100:103], a[180:183], a[44:47], v[100:103]
M v[100:103], a[176:179], a[40:43], v[100:103]
M v[104:107], a[176:179], a[48:51], v[104:107]
s_add_u32 s94, s93, 0
buffer_store_dwordx4 a[212:215], v1, s[16:19], s94 offen offset:1024 sc1
M v[104:107], a[180:183], a[52:55], v[104:107]
M v[108:111], a[180:183], a[60:63], v[108:111]
M v[108:111], a[176:179], a[56:59], v[108:111]
s_waitcnt vmcnt(11) lgkmcnt(0)
s_barrier
ds_read_b128 a[160:163], v10 offset:16384
ds_read_b128 a[164:167], v11 offset:16384
M v[112:115], a[176:179], a[64:67], v[112:115]
s_add_u32 m0, s29, 49152
s_add_u32 s3, s23, s31
buffer_load_dwordx4 v2, s[8:11], s3 offen offset:0 lds
M v[112:115], a[180:183], a[68:71], v[112:115]
M v[116:119], a[180:183], a[76:79], v[116:119]
M v[116:119], a[176:179], a[72:75], v[116:119]
ds_read_b64_tr_b16 a[100:101], v12 offset:49152
ds_read_b64_tr_b16 a[102:103], v12 offset:51200
M v[120:123], a[176:179], a[80:83], v[120:123]
M v[120:123], a[180:183], a[84:87], v[120:123]
buffer_load_dwordx4 v3, s[8:11], s3 offen offset:1024 lds
M v[124:127], a[180:183], a[92:95], v[124:127]
M v[124:127], a[176:179], a[88:91], v[124:127]
M v[128:131], a[184:187], a[32:35], v[128:131]
M v[128:131], a[188:191], a[36:39], v[128:131]
ds_read_b128 a[168:171], v10 offset:18432
ds_read_b128 a[172:175], v11 offset:18432
ds_read_b64_tr_b16 a[108:109], v13 offset:49152
ds_read_b64_tr_b16 a[110:111], v13 offset:51200
M v[132:135], a[188:191], a[44:47], v[132:135]
M v[132:135], a[184:187], a[40:43], v[132:135]
M v[136:139], a[184:187], a[48:51], v[136:139]
buffer_load_dwordx4 v4, s[8:11], s3 offen offset:2048 lds
M v[136:139], a[188:191], a[52:55], v[136:139]
M v[140:143], a[188:191], a[60:63], v[140:143]
M v[140:143], a[184:187], a[56:59], v[140:143]
ds_read_b64_tr_b16 a[116:117], v14 offset:49152
ds_read_b64_tr_b16 a[118:119], v14 offset:51200
M v[144:147], a[184:187], a[64:67], v[144:147]
M v[144:147], a[188:191], a[68:71], v[144:147]
buffer_load_dwordx4 v5, s[8:11], s3 offen offset:3072 lds
M v[148:151], a[188:191], a[76:79], v[148:151]
M v[148:151], a[184:187], a[72:75], v[148:151]
M v[152:155], a[184:187], a[80:83], v[152:155]
M v[152:155], a[188:191], a[84:87], v[152:155]
ds_read_b64_tr_b16 a[124:125], v15 offset:49152
ds_read_b64_tr_b16 a[126:127], v15 offset:51200
M v[156:159], a[188:191], a[92:95], v[156:159]
M v[156:159], a[184:187], a[88:91], v[156:159]
s_waitcnt lgkmcnt(10)
M v[160:163], a[160:163], a[32:35], v[160:163]
s_add_u32 s94, s93, 0
buffer_store_dwordx4 a[216:219], v1, s[16:19], s94 offen offset:2048 sc1
M v[160:163], a[164:167], a[36:39], v[160:163]
ds_read_b128 a[176:179], v10 offset:20480
ds_read_b128 a[180:183], v11 offset:20480
M v[164:167], a[164:167], a[44:47], v[164:167]
s_add_u32 s23, s23, 128
s_cmp_eq_u32 s23, s25
s_cselect_b32 s23, s26, s23
M v[164:167], a[160:163], a[40:43], v[164:167]
ds_read_b64_tr_b16 a[132:133], v16 offset:49152
ds_read_b64_tr_b16 a[134:135], v16 offset:51200
M v[168:171], a[160:163], a[48:51], v[168:171]
M v[168:171], a[164:167], a[52:55], v[168:171]
M v[172:175], a[164:167], a[60:63], v[172:175]
M v[172:175], a[160:163], a[56:59], v[172:175]
M v[176:179], a[160:163], a[64:67], v[176:179]
s_add_u32 m0, s29, 81920
s_nop 0
buffer_load_dwordx4 v6, s[12:15], s24 offen offset:0 lds
M v[176:179], a[164:167], a[68:71], v[176:179]
ds_read_b64_tr_b16 a[140:141], v17 offset:49152
ds_read_b64_tr_b16 a[142:143], v17 offset:51200
M v[180:183], a[164:167], a[76:79], v[180:183]
M v[180:183], a[160:163], a[72:75], v[180:183]
M v[184:187], a[160:163], a[80:83], v[184:187]
M v[184:187], a[164:167], a[84:87], v[184:187]
buffer_load_dwordx4 v7, s[12:15], s24 offen offset:1024 lds
M v[188:191], a[164:167], a[92:95], v[188:191]
M v[188:191], a[160:163], a[88:91], v[188:191]
s_waitcnt lgkmcnt(12)
ds_read_b64_tr_b16 a[148:149], v18 offset:49152
ds_read_b64_tr_b16 a[150:151], v18 offset:51200
M v[192:195], a[168:171], a[32:35], v[192:195]
M v[192:195], a[172:175], a[36:39], v[192:195]
ds_read_b128 a[184:187], v10 offset:22528
ds_read_b128 a[188:191], v11 offset:22528
M v[196:199], a[172:175], a[44:47], v[196:199]
M v[196:199], a[168:171], a[40:43], v[196:199]
M v[200:203], a[168:171], a[48:51], v[200:203]
buffer_load_dwordx4 v8, s[12:15], s24 offen offset:2048 lds
M v[200:203], a[172:175], a[52:55], v[200:203]
ds_read_b64_tr_b16 a[156:157], v19 offset:49152
ds_read_b64_tr_b16 a[158:159], v19 offset:51200
M v[204:207], a[172:175], a[60:63], v[204:207]
M v[204:207], a[168:171], a[56:59], v[204:207]
M v[208:211], a[168:171], a[64:67], v[208:211]
M v[208:211], a[172:175], a[68:71], v[208:211]
buffer_load_dwordx4 v9, s[12:15], s24 offen offset:3072 lds
M v[212:215], a[172:175], a[76:79], v[212:215]
M v[212:215], a[168:171], a[72:75], v[212:215]
M v[216:219], a[168:171], a[80:83], v[216:219]
s_add_u32 s94, s93, 0
buffer_store_dwordx4 a[220:223], v1, s[16:19], s94 offen offset:3072 sc1
M v[216:219], a[172:175], a[84:87], v[216:219]
M v[220:223], a[172:175], a[92:95], v[220:223]
M v[220:223], a[168:171], a[88:91], v[220:223]
s_waitcnt lgkmcnt(10)
M v[224:227], a[176:179], a[32:35], v[224:227]
s_add_u32 s24, s24, 262144
s_cmp_eq_u32 s24, s27
s_cselect_b32 s24, s28, s24
s_sub_u32 s6, s6, 1
s_cmp_eq_u32 s6, 0
s_cselect_b64 s[12:13], s[64:65], s[12:13]
M v[224:227], a[180:183], a[36:39], v[224:227]
M v[228:231], a[180:183], a[44:47], v[228:231]
M v[228:231], a[176:179], a[40:43], v[228:231]
M v[232:235], a[176:179], a[48:51], v[232:235]
M v[232:235], a[180:183], a[52:55], v[232:235]
M v[236:239], a[180:183], a[60:63], v[236:239]
M v[236:239], a[176:179], a[56:59], v[236:239]
s_waitcnt vmcnt(11) lgkmcnt(0)
s_barrier
ds_read_b128 a[160:163], v10 offset:32768
ds_read_b128 a[164:167], v11 offset:32768
M v[240:243], a[176:179], a[64:67], v[240:243]
s_add_u32 m0, s29, 0
s_nop 0
buffer_load_dwordx4 v2, s[8:11], s23 offen offset:0 lds
M v[240:243], a[180:183], a[68:71], v[240:243]
M v[244:247], a[180:183], a[76:79], v[244:247]
M v[244:247], a[176:179], a[72:75], v[244:247]
M v[248:251], a[176:179], a[80:83], v[248:251]
M v[248:251], a[180:183], a[84:87], v[248:251]
buffer_load_dwordx4 v3, s[8:11], s23 offen offset:1024 lds
M v[252:255], a[180:183], a[92:95], v[252:255]
M v[252:255], a[176:179], a[88:91], v[252:255]
M a[0:3], a[184:187], a[32:35], a[0:3]
M a[0:3], a[188:191], a[36:39], a[0:3]
ds_read_b128 a[168:171], v10 offset:34816
ds_read_b128 a[172:175], v11 offset:34816
M a[4:7], a[188:191], a[44:47], a[4:7]
M a[4:7], a[184:187], a[40:43], a[4:7]
M a[8:11], a[184:187], a[48:51], a[8:11]
buffer_load_dwordx4 v4, s[8:11], s23 offen offset:2048 lds
M a[8:11], a[188:191], a[52:55], a[8:11]
M a[12:15], a[188:191], a[60:63], a[12:15]
M a[12:15], a[184:187], a[56:59], a[12:15]
M a[16:19], a[184:187], a[64:67], a[16:19]
M a[16:19], a[188:191], a[68:71], a[16:19]
buffer_load_dwordx4 v5, s[8:11], s23 offen offset:3072 lds
M a[20:23], a[188:191], a[76:79], a[20:23]
M a[20:23], a[184:187], a[72:75], a[20:23]
M a[24:27], a[184:187], a[80:83], a[24:27]
M a[24:27], a[188:191], a[84:87], a[24:27]
M a[28:31], a[188:191], a[92:95], a[28:31]
M a[28:31], a[184:187], a[88:91], a[28:31]
s_waitcnt lgkmcnt(2)
M v[32:35], a[160:163], a[96:99], v[32:35]
s_add_u32 m0, s29, 98304
s_nop 0
buffer_load_dwordx4 v6, s[12:15], s24 offen offset:0 lds
M v[32:35], a[164:167], a[100:103], v[32:35]
ds_read_b128 a[176:179], v10 offset:36864
ds_read_b128 a[180:183], v11 offset:36864
M v[36:39], a[164:167], a[108:111], v[36:39]
M v[36:39], a[160:163], a[104:107], v[36:39]
ds_read_b64_tr_b16 a[32:33], v12 offset:0
ds_read_b64_tr_b16 a[34:35], v12 offset:2048
M v[40:43], a[160:163], a[112:115], v[40:43]
M v[40:43], a[164:167], a[116:119], v[40:43]
M v[44:47], a[164:167], a[124:127], v[44:47]
M v[44:47], a[160:163], a[120:123], v[44:47]
ds_read_b64_tr_b16 a[40:41], v13 offset:0
ds_read_b64_tr_b16 a[42:43], v13 offset:2048
M v[48:51], a[160:163], a[128:131], v[48:51]
s_add_u32 s94, s93, 4096
buffer_store_dwordx4 a[224:227], v1, s[16:19], s94 offen offset:0 sc1
M v[48:51], a[164:167], a[132:135], v[48:51]
buffer_load_dwordx4 v7, s[12:15], s24 offen offset:1024 lds
M v[52:55], a[164:167], a[140:143], v[52:55]
M v[52:55], a[160:163], a[136:139], v[52:55]
ds_read_b64_tr_b16 a[48:49], v14 offset:0
ds_read_b64_tr_b16 a[50:51], v14 offset:2048
M v[56:59], a[160:163], a[144:147], v[56:59]
M v[56:59], a[164:167], a[148:151], v[56:59]
M v[60:63], a[164:167], a[156:159], v[60:63]
M v[60:63], a[160:163], a[152:155], v[60:63]
s_waitcnt lgkmcnt(8)
ds_read_b64_tr_b16 a[56:57], v15 offset:0
ds_read_b64_tr_b16 a[58:59], v15 offset:2048
M v[64:67], a[168:171], a[96:99], v[64:67]
buffer_load_dwordx4 v8, s[12:15], s24 offen offset:2048 lds
M v[64:67], a[172:175], a[100:103], v[64:67]
ds_read_b128 a[184:187], v10 offset:38912
ds_read_b128 a[188:191], v11 offset:38912
M v[68:71], a[172:175], a[108:111], v[68:71]
M v[68:71], a[168:171], a[104:107], v[68:71]
ds_read_b64_tr_b16 a[64:65], v16 offset:0
ds_read_b64_tr_b16 a[66:67], v16 offset:2048
M v[72:75], a[168:171], a[112:115], v[72:75]
M v[72:75], a[172:175], a[116:119], v[72:75]
M v[76:79], a[172:175], a[124:127], v[76:79]
M v[76:79], a[168:171], a[120:123], v[76:79]
ds_read_b64_tr_b16 a[72:73], v17 offset:0
ds_read_b64_tr_b16 a[74:75], v17 offset:2048
M v[80:83], a[168:171], a[128:131], v[80:83]
buffer_load_dwordx4 v9, s[12:15], s24 offen offset:3072 lds
M v[80:83], a[172:175], a[132:135], v[80:83]
M v[84:87], a[172:175], a[140:143], v[84:87]
M v[84:87], a[168:171], a[136:139], v[84:87]
ds_read_b64_tr_b16 a[80:81], v18 offset:0
ds_read_b64_tr_b16 a[82:83], v18 offset:2048
M v[88:91], a[168:171], a[144:147], v[88:91]
M v[88:91], a[172:175], a[148:151], v[88:91]
M v[92:95], a[172:175], a[156:159], v[92:95]
s_add_u32 s24, s24, 262144
M v[92:95], a[168:171], a[152:155], v[92:95]
s_waitcnt lgkmcnt(15)
ds_read_b64_tr_b16 a[88:89], v19 offset:0
ds_read_b64_tr_b16 a[90:91], v19 offset:2048
M v[96:99], a[176:179], a[96:99], v[96:99]
M v[96:99], a[180:183], a[100:103], v[96:99]
M v[100:103], a[180:183], a[108:111], v[100:103]
M v[100:103], a[176:179], a[104:107], v[100:103]
M v[104:107], a[176:179], a[112:115], v[104:107]
s_add_u32 s94, s93, 4096
buffer_store_dwordx4 a[228:231], v1, s[16:19], s94 offen offset:1024 sc1
M v[104:107], a[180:183], a[116:119], v[104:107]
M v[108:111], a[180:183], a[124:127], v[108:111]
M v[108:111], a[176:179], a[120:123], v[108:111]
s_waitcnt vmcnt(11) lgkmcnt(0)
s_barrier
ds_read_b128 a[160:163], v10 offset:49152
ds_read_b128 a[164:167], v11 offset:49152
M v[112:115], a[176:179], a[128:131], v[112:115]
s_add_u32 m0, s29, 16384
s_add_u32 s3, s23, s31
buffer_load_dwordx4 v2, s[8:11], s3 offen offset:0 lds
M v[112:115], a[180:183], a[132:135], v[112:115]
M v[116:119], a[180:183], a[140:143], v[116:119]
M v[116:119], a[176:179], a[136:139], v[116:119]
ds_read_b64_tr_b16 a[36:37], v12 offset:16384
ds_read_b64_tr_b16 a[38:39], v12 offset:18432
M v[120:123], a[176:179], a[144:147], v[120:123]
M v[120:123], a[180:183], a[148:151], v[120:123]
buffer_load_dwordx4 v3, s[8:11], s3 offen offset:1024 lds
M v[124:127], a[180:183], a[156:159], v[124:127]
M v[124:127], a[176:179], a[152:155], v[124:127]
M v[128:131], a[184:187], a[96:99], v[128:131]
M v[128:131], a[188:191], a[100:103], v[128:131]
ds_read_b128 a[168:171], v10 offset:51200
ds_read_b128 a[172:175], v11 offset:51200
ds_read_b64_tr_b16 a[44:45], v13 offset:16384
ds_read_b64_tr_b16 a[46:47], v13 offset:18432
M v[132:135], a[188:191], a[108:111], v[132:135]
M v[132:135], a[184:187], a[104:107], v[132:135]
M v[136:139], a[184:187], a[112:115], v[136:139]
buffer_load_dwordx4 v4, s[8:11], s3 offen offset:2048 lds
M v[136:139], a[188:191], a[116:119], v[136:139]
M v[140:143], a[188:191], a[124:127], v[140:143]
M v[140:143], a[184:187], a[120:123], v[140:143]
ds_read_b64_tr_b16 a[52:53], v14 offset:16384
ds_read_b64_tr_b16 a[54:55], v14 offset:18432
M v[144:147], a[184:187], a[128:131], v[144:147]
M v[144:147], a[188:191], a[132:135], v[144:147]
buffer_load_dwordx4 v5, s[8:11], s3 offen offset:3072 lds
M v[148:151], a[188:191], a[140:143], v[148:151]
M v[148:151], a[184:187], a[136:139], v[148:151]
M v[152:155], a[184:187], a[144:147], v[152:155]
M v[152:155], a[188:191], a[148:151], v[152:155]
ds_read_b64_tr_b16 a[60:61], v15 offset:16384
ds_read_b64_tr_b16 a[62:63], v15 offset:18432
M v[156:159], a[188:191], a[156:159], v[156:159]
M v[156:159], a[184:187], a[152:155], v[156:159]
s_waitcnt lgkmcnt(10)
M v[160:163], a[160:163], a[96:99], v[160:163]
s_add_u32 s94, s93, 4096
buffer_store_dwordx4 a[232:235], v1, s[16:19], s94 offen offset:2048 sc1
M v[160:163], a[164:167], a[100:103], v[160:163]
ds_read_b128 a[176:179], v10 offset:53248
ds_read_b128 a[180:183], v11 offset:53248
M v[164:167], a[164:167], a[108:111], v[164:167]
s_add_u32 s23, s23, 128
s_cmp_eq_u32 s23, s25
s_cselect_b32 s23, s26, s23
M v[164:167], a[160:163], a[104:107], v[164:167]
ds_read_b64_tr_b16 a[68:69], v16 offset:16384
ds_read_b64_tr_b16 a[70:71], v16 offset:18432
M v[168:171], a[160:163], a[112:115], v[168:171]
M v[168:171], a[164:167], a[116:119], v[168:171]
M v[172:175], a[164:167], a[124:127], v[172:175]
M v[172:175], a[160:163], a[120:123], v[172:175]
M v[176:179], a[160:163], a[128:131], v[176:179]
s_add_u32 m0, s29, 114688
s_nop 0
buffer_load_dwordx4 v6, s[12:15], s24 offen offset:0 lds
M v[176:179], a[164:167], a[132:135], v[176:179]
ds_read_b64_tr_b16 a[76:77], v17 offset:16384
ds_read_b64_tr_b16 a[78:79], v17 offset:18432
M v[180:183], a[164:167], a[140:143], v[180:183]
M v[180:183], a[160:163], a[136:139], v[180:183]
M v[184:187], a[160:163], a[144:147], v[184:187]
M v[184:187], a[164:167], a[148:151], v[184:187]
buffer_load_dwordx4 v7, s[12:15], s24 offen offset:1024 lds
M v[188:191], a[164:167], a[156:159], v[188:191]
M v[188:191], a[160:163], a[152:155], v[188:191]
s_waitcnt lgkmcnt(12)
ds_read_b64_tr_b16 a[84:85], v18 offset:16384
ds_read_b64_tr_b16 a[86:87], v18 offset:18432
M v[192:195], a[168:171], a[96:99], v[192:195]
M v[192:195], a[172:175], a[100:103], v[192:195]
ds_read_b128 a[184:187], v10 offset:55296
ds_read_b128 a[188:191], v11 offset:55296
M v[196:199], a[172:175], a[108:111], v[196:199]
M v[196:199], a[168:171], a[104:107], v[196:199]
M v[200:203], a[168:171], a[112:115], v[200:203]
buffer_load_dwordx4 v8, s[12:15], s24 offen offset:2048 lds
M v[200:203], a[172:175], a[116:119], v[200:203]
ds_read_b64_tr_b16 a[92:93], v19 offset:16384
ds_read_b64_tr_b16 a[94:95], v19 offset:18432
M v[204:207], a[172:175], a[124:127], v[204:207]
M v[204:207], a[168:171], a[120:123], v[204:207]
M v[208:211], a[168:171], a[128:131], v[208:211]
M v[208:211], a[172:175], a[132:135], v[208:211]
buffer_load_dwordx4 v9, s[12:15], s24 offen offset:3072 lds
M v[212:215], a[172:175], a[140:143], v[212:215]
M v[212:215], a[168:171], a[136:139], v[212:215]
M v[216:219], a[168:171], a[144:147], v[216:219]
s_add_u32 s94, s93, 4096
buffer_store_dwordx4 a[236:239], v1, s[16:19], s94 offen offset:3072 sc1
M v[216:219], a[172:175], a[148:151], v[216:219]
M v[220:223], a[172:175], a[156:159], v[220:223]
M v[220:223], a[168:171], a[152:155], v[220:223]
s_waitcnt lgkmcnt(10)
M v[224:227], a[176:179], a[96:99], v[224:227]
s_add_u32 s24, s24, 262144
s_cmp_eq_u32 s24, s27
s_cselect_b32 s24, s28, s24
s_sub_u32 s6, s6, 1
s_cmp_eq_u32 s6, 0
s_cselect_b64 s[12:13], s[64:65], s[12:13]
M v[224:227], a[180:183], a[100:103], v[224:227]
M v[228:231], a[180:183], a[108:111], v[228:231]
M v[228:231], a[176:179], a[104:107], v[228:231]
M v[232:235], a[176:179], a[112:115], v[232:235]
M v[232:235], a[180:183], a[116:119], v[232:235]
M v[236:239], a[180:183], a[124:127], v[236:239]
M v[236:239], a[176:179], a[120:123], v[236:239]
s_waitcnt vmcnt(11) lgkmcnt(0)
s_barrier
ds_read_b128 a[160:163], v10 offset:0
ds_read_b128 a[164:167], v11 offset:0
M v[240:243], a[176:179], a[128:131], v[240:243]
s_add_u32 m0, s29, 32768
s_nop 0
buffer_load_dwordx4 v2, s[8:11], s23 offen offset:0 lds
M v[240:243], a[180:183], a[132:135], v[240:243]
M v[244:247], a[180:183], a[140:143], v[244:247]
M v[244:247], a[176:179], a[136:139], v[244:247]
M v[248:251], a[176:179], a[144:147], v[248:251]
M v[248:251], a[180:183], a[148:151], v[248:251]
buffer_load_dwordx4 v3, s[8:11], s23 offen offset:1024 lds
M v[252:255], a[180:183], a[156:159], v[252:255]
M v[252:255], a[176:179], a[152:155], v[252:255]
M a[0:3], a[184:187], a[96:99], a[0:3]
M a[0:3], a[188:191], a[100:103], a[0:3]
ds_read_b128 a[168:171], v10 offset:2048
ds_read_b128 a[172:175], v11 offset:2048
M a[4:7], a[188:191], a[108:111], a[4:7]
M a[4:7], a[184:187], a[104:107], a[4:7]
M a[8:11], a[184:187], a[112:115], a[8:11]
buffer_load_dwordx4 v4, s[8:11], s23 offen offset:2048 lds
M a[8:11], a[188:191], a[116:119], a[8:11]
M a[12:15], a[188:191], a[124:127], a[12:15]
M a[12:15], a[184:187], a[120:123], a[12:15]
M a[16:19], a[184:187], a[128:131], a[16:19]
M a[16:19], a[188:191], a[132:135], a[16:19]
buffer_load_dwordx4 v5, s[8:11], s23 offen offset:3072 lds
M a[20:23], a[188:191], a[140:143], a[20:23]
M a[20:23], a[184:187], a[136:139], a[20:23]
M a[24:27], a[184:187], a[144:147], a[24:27]
M a[24:27], a[188:191], a[148:151], a[24:27]
M a[28:31], a[188:191], a[156:159], a[28:31]
M a[28:31], a[184:187], a[152:155], a[28:31]
s_waitcnt lgkmcnt(2)
M v[32:35], a[160:163], a[32:35], v[32:35]
s_add_u32 m0, s29, 65536
s_nop 0
buffer_load_dwordx4 v6, s[12:15], s24 offen offset:0 lds
M v[32:35], a[164:167], a[36:39], v[32:35]
ds_read_b128 a[176:179], v10 offset:4096
ds_read_b128 a[180:183], v11 offset:4096
M v[36:39], a[164:167], a[44:47], v[36:39]
M v[36:39], a[160:163], a[40:43], v[36:39]
ds_read_b64_tr_b16 a[96:97], v12 offset:32768
ds_read_b64_tr_b16 a[98:99], v12 offset:34816
M v[40:43], a[160:163], a[48:51], v[40:43]
M v[40:43], a[164:167], a[52:55], v[40:43]
M v[44:47], a[164:167], a[60:63], v[44:47]
M v[44:47], a[160:163], a[56:59], v[44:47]
ds_read_b64_tr_b16 a[104:105], v13 offset:32768
ds_read_b64_tr_b16 a[106:107], v13 offset:34816
M v[48:51], a[160:163], a[64:67], v[48:51]
s_add_u32 s94, s93, 8192
buffer_store_dwordx4 a[240:243], v1, s[16:19], s94 offen offset:0 sc1
M v[48:51], a[164:167], a[68:71], v[48:51]
buffer_load_dwordx4 v7, s[12:15], s24 offen offset:1024 lds
M v[52:55], a[164:167], a[76:79], v[52:55]
M v[52:55], a[160:163], a[72:75], v[52:55]
ds_read_b64_tr_b16 a[112:113], v14 offset:32768
ds_read_b64_tr_b16 a[114:115], v14 offset:34816
M v[56:59], a[160:163], a[80:83], v[56:59]
M v[56:59], a[164:167], a[84:87], v[56:59]
M v[60:63], a[164:167], a[92:95], v[60:63]
M v[60:63], a[160:163], a[88:91], v[60:63]
s_waitcnt lgkmcnt(8)
ds_read_b64_tr_b16 a[120:121], v15 offset:32768
ds_read_b64_tr_b16 a[122:123], v15 offset:34816
M v[64:67], a[168:171], a[32:35], v[64:67]
buffer_load_dwordx4 v8, s[12:15], s24 offen offset:2048 lds
M v[64:67], a[172:175], a[36:39], v[64:67]
ds_read_b128 a[184:187], v10 offset:6144
ds_read_b128 a[188:191], v11 offset:6144
M v[68:71], a[172:175], a[44:47], v[68:71]
M v[68:71], a[168:171], a[40:43], v[68:71]
ds_read_b64_tr_b16 a[128:129], v16 offset:32768
ds_read_b64_tr_b16 a[130:131], v16 offset:34816
M v[72:75], a[168:171], a[48:51], v[72:75]
M v[72:75], a[172:175], a[52:55], v[72:75]
M v[76:79], a[172:175], a[60:63], v[76:79]
M v[76:79], a[168:171], a[56:59], v[76:79]
ds_read_b64_tr_b16 a[136:137], v17 offset:32768
ds_read_b64_tr_b16 a[138:139], v17 offset:34816
M v[80:83], a[168:171], a[64:67], v[80:83]
buffer_load_dwordx4 v9, s[12:15], s24 offen offset:3072 lds
M v[80:83], a[172:175], a[68:71], v[80:83]
M v[84:87], a[172:175], a[76:79], v[84:87]
M v[84:87], a[168:171], a[72:75], v[84:87]
ds_read_b64_tr_b16 a[144:145], v18 offset:32768
ds_read_b64_tr_b16 a[146:147], v18 offset:34816
M v[88:91], a[168:171], a[80:83], v[88:91]
M v[88:91], a[172:175], a[84:87], v[88:91]
M v[92:95], a[172:175], a[92:95], v[92:95]
s_add_u32 s24, s24, 262144
M v[92:95], a[168:171], a[88:91], v[92:95]
s_waitcnt lgkmcnt(15)
ds_read_b64_tr_b16 a[152:153], v19 offset:32768
ds_read_b64_tr_b16 a[154:155], v19 offset:34816
M v[96:99], a[176:179], a[32:35], v[96:99]
M v[96:99], a[180:183], a[36:39], v[96:99]
M v[100:103], a[180:183], a[44:47], v[100:103]
M v[100:103], a[176:179], a[40:43], v[100:103]
M v[104:107], a[176:179], a[48:51], v[104:107]
s_add_u32 s94, s93, 8192
buffer_store_dwordx4 a[244:247], v1, s[16:19], s94 offen offset:1024 sc1
M v[104:107], a[180:183], a[52:55], v[104:107]
M v[108:111], a[180:183], a[60:63], v[108:111]
M v[108:111], a[176:179], a[56:59], v[108:111]
s_waitcnt vmcnt(11) lgkmcnt(0)
s_barrier
ds_read_b128 a[160:163], v10 offset:16384
ds_read_b128 a[164:167], v11 offset:16384
M v[112:115], a[176:179], a[64:67], v[112:115]
s_add_u32 m0, s29, 49152
s_add_u32 s3, s23, s31
buffer_load_dwordx4 v2, s[8:11], s3 offen offset:0 lds
M v[112:115], a[180:183], a[68:71], v[112:115]
M v[116:119], a[180:183], a[76:79], v[116:119]
M v[116:119], a[176:179], a[72:75], v[116:119]
ds_read_b64_tr_b16 a[100:101], v12 offset:49152
ds_read_b64_tr_b16 a[102:103], v12 offset:51200
M v[120:123], a[176:179], a[80:83], v[120:123]
M v[120:123], a[180:183], a[84:87], v[120:123]
buffer_load_dwordx4 v3, s[8:11], s3 offen offset:1024 lds
M v[124:127], a[180:183], a[92:95], v[124:127]
M v[124:127], a[176:179], a[88:91], v[124:127]
M v[128:131], a[184:187], a[32:35], v[128:131]
M v[128:131], a[188:191], a[36:39], v[128:131]
ds_read_b128 a[168:171], v10 offset:18432
ds_read_b128 a[172:175], v11 offset:18432
ds_read_b64_tr_b16 a[108:109], v13 offset:49152
ds_read_b64_tr_b16 a[110:111], v13 offset:51200
M v[132:135], a[188:191], a[44:47], v[132:135]
M v[132:135], a[184:187], a[40:43], v[132:135]
M v[136:139], a[184:187], a[48:51], v[136:139]
buffer_load_dwordx4 v4, s[8:11], s3 offen offset:2048 lds
M v[136:139], a[188:191], a[52:55], v[136:139]
M v[140:143], a[188:191], a[60:63], v[140:143]
M v[140:143], a[184:187], a[56:59], v[140:143]
ds_read_b64_tr_b16 a[116:117], v14 offset:49152
ds_read_b64_tr_b16 a[118:119], v14 offset:51200
M v[144:147], a[184:187], a[64:67], v[144:147]
M v[144:147], a[188:191], a[68:71], v[144:147]
buffer_load_dwordx4 v5, s[8:11], s3 offen offset:3072 lds
M v[148:151], a[188:191], a[76:79], v[148:151]
M v[148:151], a[184:187], a[72:75], v[148:151]
M v[152:155], a[184:187], a[80:83], v[152:155]
M v[152:155], a[188:191], a[84:87], v[152:155]
ds_read_b64_tr_b16 a[124:125], v15 offset:49152
ds_read_b64_tr_b16 a[126:127], v15 offset:51200
M v[156:159], a[188:191], a[92:95], v[156:159]
M v[156:159], a[184:187], a[88:91], v[156:159]
s_waitcnt lgkmcnt(10)
M v[160:163], a[160:163], a[32:35], v[160:163]
s_add_u32 s94, s93, 8192
buffer_store_dwordx4 a[248:251], v1, s[16:19], s94 offen offset:2048 sc1
M v[160:163], a[164:167], a[36:39], v[160:163]
ds_read_b128 a[176:179], v10 offset:20480
ds_read_b128 a[180:183], v11 offset:20480
M v[164:167], a[164:167], a[44:47], v[164:167]
s_add_u32 s23, s23, 128
s_cmp_eq_u32 s23, s25
s_cselect_b32 s23, s26, s23
M v[164:167], a[160:163], a[40:43], v[164:167]
ds_read_b64_tr_b16 a[132:133], v16 offset:49152
ds_read_b64_tr_b16 a[134:135], v16 offset:51200
M v[168:171], a[160:163], a[48:51], v[168:171]
M v[168:171], a[164:167], a[52:55], v[168:171]
M v[172:175], a[164:167], a[60:63], v[172:175]
M v[172:175], a[160:163], a[56:59], v[172:175]
M v[176:179], a[160:163], a[64:67], v[176:179]
s_add_u32 m0, s29, 81920
s_nop 0
buffer_load_dwordx4 v6, s[12:15], s24 offen offset:0 lds
M v[176:179], a[164:167], a[68:71], v[176:179]
ds_read_b64_tr_b16 a[140:141], v17 offset:49152
ds_read_b64_tr_b16 a[142:143], v17 offset:51200
M v[180:183], a[164:167], a[76:79], v[180:183]
M v[180:183], a[160:163], a[72:75], v[180:183]
M v[184:187], a[160:163], a[80:83], v[184:187]
M v[184:187], a[164:167], a[84:87], v[184:187]
buffer_load_dwordx4 v7, s[12:15], s24 offen offset:1024 lds
M v[188:191], a[164:167], a[92:95], v[188:191]
M v[188:191], a[160:163], a[88:91], v[188:191]
s_waitcnt lgkmcnt(12)
ds_read_b64_tr_b16 a[148:149], v18 offset:49152
ds_read_b64_tr_b16 a[150:151], v18 offset:51200
M v[192:195], a[168:171], a[32:35], v[192:195]
M v[192:195], a[172:175], a[36:39], v[192:195]
ds_read_b128 a[184:187], v10 offset:22528
ds_read_b128 a[188:191], v11 offset:22528
M v[196:199], a[172:175], a[44:47], v[196:199]
M v[196:199], a[168:171], a[40:43], v[196:199]
M v[200:203], a[168:171], a[48:51], v[200:203]
buffer_load_dwordx4 v8, s[12:15], s24 offen offset:2048 lds
M v[200:203], a[172:175], a[52:55], v[200:203]
ds_read_b64_tr_b16 a[156:157], v19 offset:49152
ds_read_b64_tr_b16 a[158:159], v19 offset:51200
M v[204:207], a[172:175], a[60:63], v[204:207]
M v[204:207], a[168:171], a[56:59], v[204:207]
M v[208:211], a[168:171], a[64:67], v[208:211]
M v[208:211], a[172:175], a[68:71], v[208:211]
buffer_load_dwordx4 v9, s[12:15], s24 offen offset:3072 lds
M v[212:215], a[172:175], a[76:79], v[212:215]
M v[212:215], a[168:171], a[72:75], v[212:215]
M v[216:219], a[168:171], a[80:83], v[216:219]
s_add_u32 s94, s93, 8192
buffer_store_dwordx4 a[252:255], v1, s[16:19], s94 offen offset:3072 sc1
M v[216:219], a[172:175], a[84:87], v[216:219]
M v[220:223], a[172:175], a[92:95], v[220:223]
M v[220:223], a[168:171], a[88:91], v[220:223]
s_waitcnt lgkmcnt(10)
M v[224:227], a[176:179], a[32:35], v[224:227]
s_add_u32 s24, s24, 262144
s_cmp_eq_u32 s24, s27
s_cselect_b32 s24, s28, s24
s_sub_u32 s6, s6, 1
s_cmp_eq_u32 s6, 0
s_cselect_b64 s[12:13], s[64:65], s[12:13]
M v[224:227], a[180:183], a[36:39], v[224:227]
M v[228:231], a[180:183], a[44:47], v[228:231]
M v[228:231], a[176:179], a[40:43], v[228:231]
M v[232:235], a[176:179], a[48:51], v[232:235]
M v[232:235], a[180:183], a[52:55], v[232:235]
M v[236:239], a[180:183], a[60:63], v[236:239]
M v[236:239], a[176:179], a[56:59], v[236:239]
s_waitcnt vmcnt(11) lgkmcnt(0)
s_barrier
ds_read_b128 a[160:163], v10 offset:32768
ds_read_b128 a[164:167], v11 offset:32768
M v[240:243], a[176:179], a[64:67], v[240:243]
s_add_u32 m0, s29, 0
s_nop 0
buffer_load_dwordx4 v2, s[8:11], s23 offen offset:0 lds
M v[240:243], a[180:183], a[68:71], v[240:243]
M v[244:247], a[180:183], a[76:79], v[244:247]
M v[244:247], a[176:179], a[72:75], v[244:247]
M v[248:251], a[176:179], a[80:83], v[248:251]
M v[248:251], a[180:183], a[84:87], v[248:251]
buffer_load_dwordx4 v3, s[8:11], s23 offen offset:1024 lds
M v[252:255], a[180:183], a[92:95], v[252:255]
M v[252:255], a[176:179], a[88:91], v[252:255]
M a[0:3], a[184:187], a[32:35], a[0:3]
M a[0:3], a[188:191], a[36:39], a[0:3]
ds_read_b128 a[168:171], v10 offset:34816
ds_read_b128 a[172:175], v11 offset:34816
M a[4:7], a[188:191], a[44:47], a[4:7]
M a[4:7], a[184:187], a[40:43], a[4:7]
M a[8:11], a[184:187], a[48:51], a[8:11]
buffer_load_dwordx4 v4, s[8:11], s23 offen offset:2048 lds
M a[8:11], a[188:191], a[52:55], a[8:11]
M a[12:15], a[188:191], a[60:63], a[12:15]
M a[12:15], a[184:187], a[56:59], a[12:15]
M a[16:19], a[184:187], a[64:67], a[16:19]
M a[16:19], a[188:191], a[68:71], a[16:19]
buffer_load_dwordx4 v5, s[8:11], s23 offen offset:3072 lds
M a[20:23], a[188:191], a[76:79], a[20:23]
M a[20:23], a[184:187], a[72:75], a[20:23]
M a[24:27], a[184:187], a[80:83], a[24:27]
M a[24:27], a[188:191], a[84:87], a[24:27]
M a[28:31], a[188:191], a[92:95], a[28:31]
M a[28:31], a[184:187], a[88:91], a[28:31]
s_waitcnt lgkmcnt(2)
M v[32:35], a[160:163], a[96:99], v[32:35]
s_add_u32 m0, s29, 98304
s_nop 0
buffer_load_dwordx4 v6, s[12:15], s24 offen offset:0 lds
M v[32:35], a[164:167], a[100:103], v[32:35]
ds_read_b128 a[176:179], v10 offset:36864
ds_read_b128 a[180:183], v11 offset:36864
M v[36:39], a[164:167], a[108:111], v[36:39]
M v[36:39], a[160:163], a[104:107], v[36:39]
ds_read_b64_tr_b16 a[32:33], v12 offset:0
ds_read_b64_tr_b16 a[34:35], v12 offset:2048
M v[40:43], a[160:163], a[112:115], v[40:43]
M v[40:43], a[164:167], a[116:119], v[40:43]
M v[44:47], a[164:167], a[124:127], v[44:47]
M v[44:47], a[160:163], a[120:123], v[44:47]
ds_read_b64_tr_b16 a[40:41], v13 offset:0
ds_read_b64_tr_b16 a[42:43], v13 offset:2048
M v[48:51], a[160:163], a[128:131], v[48:51]
buffer_load_dwordx4 v7, s[12:15], s24 offen offset:1024 lds
M v[48:51], a[164:167], a[132:135], v[48:51]
M v[52:55], a[164:167], a[140:143], v[52:55]
M v[52:55], a[160:163], a[136:139], v[52:55]
ds_read_b64_tr_b16 a[48:49], v14 offset:0
ds_read_b64_tr_b16 a[50:51], v14 offset:2048
M v[56:59], a[160:163], a[144:147], v[56:59]
M v[56:59], a[164:167], a[148:151], v[56:59]
M v[60:63], a[164:167], a[156:159], v[60:63]
buffer_load_dwordx4 v8, s[12:15], s24 offen offset:2048 lds
M v[60:63], a[160:163], a[152:155], v[60:63]
s_waitcnt lgkmcnt(8)
ds_read_b64_tr_b16 a[56:57], v15 offset:0
ds_read_b64_tr_b16 a[58:59], v15 offset:2048
M v[64:67], a[168:171], a[96:99], v[64:67]
M v[64:67], a[172:175], a[100:103], v[64:67]
ds_read_b128 a[184:187], v10 offset:38912
ds_read_b128 a[188:191], v11 offset:38912
M v[68:71], a[172:175], a[108:111], v[68:71]
M v[68:71], a[168:171], a[104:107], v[68:71]
ds_read_b64_tr_b16 a[64:65], v16 offset:0
ds_read_b64_tr_b16 a[66:67], v16 offset:2048
M v[72:75], a[168:171], a[112:115], v[72:75]
M v[72:75], a[172:175], a[116:119], v[72:75]
M v[76:79], a[172:175], a[124:127], v[76:79]
M v[76:79], a[168:171], a[120:123], v[76:79]
ds_read_b64_tr_b16 a[72:73], v17 offset:0
ds_read_b64_tr_b16 a[74:75], v17 offset:2048
M v[80:83], a[168:171], a[128:131], v[80:83]
buffer_load_dwordx4 v9, s[12:15], s24 offen offset:3072 lds
M v[80:83], a[172:175], a[132:135], v[80:83]
M v[84:87], a[172:175], a[140:143], v[84:87]
M v[84:87], a[168:171], a[136:139], v[84:87]
ds_read_b64_tr_b16 a[80:81], v18 offset:0
ds_read_b64_tr_b16 a[82:83], v18 offset:2048
M v[88:91], a[168:171], a[144:147], v[88:91]
M v[88:91], a[172:175], a[148:151], v[88:91]
M v[92:95], a[172:175], a[156:159], v[92:95]
s_add_u32 s24, s24, 262144
M v[92:95], a[168:171], a[152:155], v[92:95]
s_waitcnt lgkmcnt(15)
ds_read_b64_tr_b16 a[88:89], v19 offset:0
ds_read_b64_tr_b16 a[90:91], v19 offset:2048
M v[96:99], a[176:179], a[96:99], v[96:99]
M v[96:99], a[180:183], a[100:103], v[96:99]
M v[100:103], a[180:183], a[108:111], v[100:103]
M v[100:103], a[176:179], a[104:107], v[100:103]
M v[104:107], a[176:179], a[112:115], v[104:107]
M v[104:107], a[180:183], a[116:119], v[104:107]
M v[108:111], a[180:183], a[124:127], v[108:111]
M v[108:111], a[176:179], a[120:123], v[108:111]
s_waitcnt vmcnt(9) lgkmcnt(0)
s_barrier
ds_read_b128 a[160:163], v10 offset:49152
ds_read_b128 a[164:167], v11 offset:49152
M v[112:115], a[176:179], a[128:131], v[112:115]
s_add_u32 m0, s29, 16384
s_add_u32 s3, s23, s31
buffer_load_dwordx4 v2, s[8:11], s3 offen offset:0 lds
M v[112:115], a[180:183], a[132:135], v[112:115]
M v[116:119], a[180:183], a[140:143], v[116:119]
M v[116:119], a[176:179], a[136:139], v[116:119]
ds_read_b64_tr_b16 a[36:37], v12 offset:16384
ds_read_b64_tr_b16 a[38:39], v12 offset:18432
M v[120:123], a[176:179], a[144:147], v[120:123]
M v[120:123], a[180:183], a[148:151], v[120:123]
buffer_load_dwordx4 v3, s[8:11], s3 offen offset:1024 lds
M v[124:127], a[180:183], a[156:159], v[124:127]
M v[124:127], a[176:179], a[152:155], v[124:127]
M v[128:131], a[184:187], a[96:99], v[128:131]
M v[128:131], a[188:191], a[100:103], v[128:131]
ds_read_b128 a[168:171], v10 offset:51200
ds_read_b128 a[172:175], v11 offset:51200
ds_read_b64_tr_b16 a[44:45], v13 offset:16384
ds_read_b64_tr_b16 a[46:47], v13 offset:18432
M v[132:135], a[188:191], a[108:111], v[132:135]
M v[132:135], a[184:187], a[104:107], v[132:135]
M v[136:139], a[184:187], a[112:115], v[136:139]
buffer_load_dwordx4 v4, s[8:11], s3 offen offset:2048 lds
M v[136:139], a[188:191], a[116:119], v[136:139]
M v[140:143], a[188:191], a[124:127], v[140:143]
M v[140:143], a[184:187], a[120:123], v[140:143]
ds_read_b64_tr_b16 a[52:53], v14 offset:16384
ds_read_b64_tr_b16 a[54:55], v14 offset:18432
M v[144:147], a[184:187], a[128:131], v[144:147]
M v[144:147], a[188:191], a[132:135], v[144:147]
M v[148:151], a[188:191], a[140:143], v[148:151]
buffer_load_dwordx4 v5, s[8:11], s3 offen offset:3072 lds
M v[148:151], a[184:187], a[136:139], v[148:151]
M v[152:155], a[184:187], a[144:147], v[152:155]
M v[152:155], a[188:191], a[148:151], v[152:155]
ds_read_b64_tr_b16 a[60:61], v15 offset:16384
ds_read_b64_tr_b16 a[62:63], v15 offset:18432
M v[156:159], a[188:191], a[156:159], v[156:159]
M v[156:159], a[184:187], a[152:155], v[156:159]
s_waitcnt lgkmcnt(10)
M v[160:163], a[160:163], a[96:99], v[160:163]
M v[160:163], a[164:167], a[100:103], v[160:163]
ds_read_b128 a[176:179], v10 offset:53248
ds_read_b128 a[180:183], v11 offset:53248
M v[164:167], a[164:167], a[108:111], v[164:167]
s_add_u32 s23, s23, 128
s_cmp_eq_u32 s23, s25
s_cselect_b32 s23, s26, s23
M v[164:167], a[160:163], a[104:107], v[164:167]
ds_read_b64_tr_b16 a[68:69], v16 offset:16384
ds_read_b64_tr_b16 a[70:71], v16 offset:18432
M v[168:171], a[160:163], a[112:115], v[168:171]
M v[168:171], a[164:167], a[116:119], v[168:171]
M v[172:175], a[164:167], a[124:127], v[172:175]
M v[172:175], a[160:163], a[120:123], v[172:175]
M v[176:179], a[160:163], a[128:131], v[176:179]
s_add_u32 m0, s29, 114688
s_nop 0
buffer_load_dwordx4 v6, s[12:15], s24 offen offset:0 lds
M v[176:179], a[164:167], a[132:135], v[176:179]
ds_read_b64_tr_b16 a[76:77], v17 offset:16384
ds_read_b64_tr_b16 a[78:79], v17 offset:18432
M v[180:183], a[164:167], a[140:143], v[180:183]
M v[180:183], a[160:163], a[136:139], v[180:183]
M v[184:187], a[160:163], a[144:147], v[184:187]
M v[184:187], a[164:167], a[148:151], v[184:187]
buffer_load_dwordx4 v7, s[12:15], s24 offen offset:1024 lds
M v[188:191], a[164:167], a[156:159], v[188:191]
M v[188:191], a[160:163], a[152:155], v[188:191]
s_waitcnt lgkmcnt(12)
ds_read_b64_tr_b16 a[84:85], v18 offset:16384
ds_read_b64_tr_b16 a[86:87], v18 offset:18432
M v[192:195], a[168:171], a[96:99], v[192:195]
M v[192:195], a[172:175], a[100:103], v[192:195]
ds_read_b128 a[184:187], v10 offset:55296
ds_read_b128 a[188:191], v11 offset:55296
M v[196:199], a[172:175], a[108:111], v[196:199]
M v[196:199], a[168:171], a[104:107], v[196:199]
M v[200:203], a[168:171], a[112:115], v[200:203]
buffer_load_dwordx4 v8, s[12:15], s24 offen offset:2048 lds
M v[200:203], a[172:175], a[116:119], v[200:203]
ds_read_b64_tr_b16 a[92:93], v19 offset:16384
ds_read_b64_tr_b16 a[94:95], v19 offset:18432
M v[204:207], a[172:175], a[124:127], v[204:207]
M v[204:207], a[168:171], a[120:123], v[204:207]
M v[208:211], a[168:171], a[128:131], v[208:211]
M v[208:211], a[172:175], a[132:135], v[208:211]
M v[212:215], a[172:175], a[140:143], v[212:215]
buffer_load_dwordx4 v9, s[12:15], s24 offen offset:3072 lds
M v[212:215], a[168:171], a[136:139], v[212:215]
M v[216:219], a[168:171], a[144:147], v[216:219]
M v[216:219], a[172:175], a[148:151], v[216:219]
M v[220:223], a[172:175], a[156:159], v[220:223]
M v[220:223], a[168:171], a[152:155], v[220:223]
s_waitcnt lgkmcnt(10)
M v[224:227], a[176:179], a[96:99], v[224:227]
s_add_u32 s24, s24, 262144
s_cmp_eq_u32 s24, s27
s_cselect_b32 s24, s28, s24
s_sub_u32 s6, s6, 1
s_cmp_eq_u32 s6, 0
s_cselect_b64 s[12:13], s[64:65], s[12:13]
M v[224:227], a[180:183], a[100:103], v[224:227]
M v[228:231], a[180:183], a[108:111], v[228:231]
M v[228:231], a[176:179], a[104:107], v[228:231]
M v[232:235], a[176:179], a[112:115], v[232:235]
M v[232:235], a[180:183], a[116:119], v[232:235]
M v[236:239], a[180:183], a[124:127], v[236:239]
M v[236:239], a[176:179], a[120:123], v[236:239]
s_waitcnt vmcnt(8) lgkmcnt(0)
s_barrier
ds_read_b128 a[160:163], v10 offset:0
ds_read_b128 a[164:167], v11 offset:0
M v[240:243], a[176:179], a[128:131], v[240:243]
s_add_u32 m0, s29, 32768
s_nop 0
buffer_load_dwordx4 v2, s[8:11], s23 offen offset:0 lds
M v[240:243], a[180:183], a[132:135], v[240:243]
M v[244:247], a[180:183], a[140:143], v[244:247]
M v[244:247], a[176:179], a[136:139], v[244:247]
M v[248:251], a[176:179], a[144:147], v[248:251]
M v[248:251], a[180:183], a[148:151], v[248:251]
M v[252:255], a[180:183], a[156:159], v[252:255]
M v[252:255], a[176:179], a[152:155], v[252:255]
M a[0:3], a[184:187], a[96:99], a[0:3]
M a[0:3], a[188:191], a[100:103], a[0:3]
ds_read_b128 a[168:171], v10 offset:2048
ds_read_b128 a[172:175], v11 offset:2048
M a[4:7], a[188:191], a[108:111], a[4:7]
M a[4:7], a[184:187], a[104:107], a[4:7]
M a[8:11], a[184:187], a[112:115], a[8:11]
buffer_load_dwordx4 v3, s[8:11], s23 offen offset:1024 lds
M a[8:11], a[188:191], a[116:119], a[8:11]
M a[12:15], a[188:191], a[124:127], a[12:15]
M a[12:15], a[184:187], a[120:123], a[12:15]
M a[16:19], a[184:187], a[128:131], a[16:19]
M a[16:19], a[188:191], a[132:135], a[16:19]
M a[20:23], a[188:191], a[140:143], a[20:23]
M a[20:23], a[184:187], a[136:139], a[20:23]
M a[24:27], a[184:187], a[144:147], a[24:27]
M a[24:27], a[188:191], a[148:151], a[24:27]
M a[28:31], a[188:191], a[156:159], a[28:31]
M a[28:31], a[184:187], a[152:155], a[28:31]
s_waitcnt lgkmcnt(2)
M v[32:35], a[160:163], a[32:35], v[32:35]
buffer_load_dwordx4 v4, s[8:11], s23 offen offset:2048 lds
M v[32:35], a[164:167], a[36:39], v[32:35]
ds_read_b128 a[176:179], v10 offset:4096
ds_read_b128 a[180:183], v11 offset:4096
M v[36:39], a[164:167], a[44:47], v[36:39]
M v[36:39], a[160:163], a[40:43], v[36:39]
ds_read_b64_tr_b16 a[96:97], v12 offset:32768
ds_read_b64_tr_b16 a[98:99], v12 offset:34816
M v[40:43], a[160:163], a[48:51], v[40:43]
M v[40:43], a[164:167], a[52:55], v[40:43]
M v[44:47], a[164:167], a[60:63], v[44:47]
M v[44:47], a[160:163], a[56:59], v[44:47]
ds_read_b64_tr_b16 a[104:105], v13 offset:32768
ds_read_b64_tr_b16 a[106:107], v13 offset:34816
M v[48:51], a[160:163], a[64:67], v[48:51]
M v[48:51], a[164:167], a[68:71], v[48:51]
M v[52:55], a[164:167], a[76:79], v[52:55]
M v[52:55], a[160:163], a[72:75], v[52:55]
ds_read_b64_tr_b16 a[112:113], v14 offset:32768
ds_read_b64_tr_b16 a[114:115], v14 offset:34816
M v[56:59], a[160:163], a[80:83], v[56:59]
M v[56:59], a[164:167], a[84:87], v[56:59]
M v[60:63], a[164:167], a[92:95], v[60:63]
M v[60:63], a[160:163], a[88:91], v[60:63]
s_waitcnt lgkmcnt(8)
ds_read_b64_tr_b16 a[120:121], v15 offset:32768
ds_read_b64_tr_b16 a[122:123], v15 offset:34816
M v[64:67], a[168:171], a[32:35], v[64:67]
M v[64:67], a[172:175], a[36:39], v[64:67]
ds_read_b128 a[184:187], v10 offset:6144
ds_read_b128 a[188:191], v11 offset:6144
M v[68:71], a[172:175], a[44:47], v[68:71]
M v[68:71], a[168:171], a[40:43], v[68:71]
ds_read_b64_tr_b16 a[128:129], v16 offset:32768
ds_read_b64_tr_b16 a[130:131], v16 offset:34816
M v[72:75], a[168:171], a[48:51], v[72:75]
buffer_load_dwordx4 v5, s[8:11], s23 offen offset:3072 lds
M v[72:75], a[172:175], a[52:55], v[72:75]
M v[76:79], a[172:175], a[60:63], v[76:79]
M v[76:79], a[168:171], a[56:59], v[76:79]
ds_read_b64_tr_b16 a[136:137], v17 offset:32768
ds_read_b64_tr_b16 a[138:139], v17 offset:34816
M v[80:83], a[168:171], a[64:67], v[80:83]
M v[80:83], a[172:175], a[68:71], v[80:83]
M v[84:87], a[172:175], a[76:79], v[84:87]
M v[84:87], a[168:171], a[72:75], v[84:87]
ds_read_b64_tr_b16 a[144:145], v18 offset:32768
ds_read_b64_tr_b16 a[146:147], v18 offset:34816
M v[88:91], a[168:171], a[80:83], v[88:91]
M v[88:91], a[172:175], a[84:87], v[88:91]
M v[92:95], a[172:175], a[92:95], v[92:95]
M v[92:95], a[168:171], a[88:91], v[92:95]
s_waitcnt lgkmcnt(15)
ds_read_b64_tr_b16 a[152:153], v19 offset:32768
ds_read_b64_tr_b16 a[154:155], v19 offset:34816
M v[96:99], a[176:179], a[32:35], v[96:99]
M v[96:99], a[180:183], a[36:39], v[96:99]
M v[100:103], a[180:183], a[44:47], v[100:103]
M v[100:103], a[176:179], a[40:43], v[100:103]
M v[104:107], a[176:179], a[48:51], v[104:107]
M v[104:107], a[180:183], a[52:55], v[104:107]
M v[108:111], a[180:183], a[60:63], v[108:111]
M v[108:111], a[176:179], a[56:59], v[108:111]
s_waitcnt vmcnt(4) lgkmcnt(0)
s_barrier
ds_read_b128 a[160:163], v10 offset:16384
ds_read_b128 a[164:167], v11 offset:16384
M v[112:115], a[176:179], a[64:67], v[112:115]
s_add_u32 m0, s29, 49152
s_add_u32 s3, s23, s31
buffer_load_dwordx4 v2, s[8:11], s3 offen offset:0 lds
M v[112:115], a[180:183], a[68:71], v[112:115]
M v[116:119], a[180:183], a[76:79], v[116:119]
buffer_load_dwordx4 v3, s[8:11], s3 offen offset:1024 lds
M v[116:119], a[176:179], a[72:75], v[116:119]
ds_read_b64_tr_b16 a[100:101], v12 offset:49152
ds_read_b64_tr_b16 a[102:103], v12 offset:51200
M v[120:123], a[176:179], a[80:83], v[120:123]
buffer_load_dwordx4 v4, s[8:11], s3 offen offset:2048 lds
M v[120:123], a[180:183], a[84:87], v[120:123]
M v[124:127], a[180:183], a[92:95], v[124:127]
buffer_load_dwordx4 v5, s[8:11], s3 offen offset:3072 lds
M v[124:127], a[176:179], a[88:91], v[124:127]
M v[128:131], a[184:187], a[32:35], v[128:131]
M v[128:131], a[188:191], a[36:39], v[128:131]
ds_read_b128 a[168:171], v10 offset:18432
ds_read_b128 a[172:175], v11 offset:18432
ds_read_b64_tr_b16 a[108:109], v13 offset:49152
ds_read_b64_tr_b16 a[110:111], v13 offset:51200
M v[132:135], a[188:191], a[44:47], v[132:135]
M v[132:135], a[184:187], a[40:43], v[132:135]
M v[136:139], a[184:187], a[48:51], v[136:139]
s_and_b32 s3, s2, 1
s_lshl_b32 s3, s3, 3
s_bfe_u32 s4, s2, 0x30003
s_add_u32 s26, s3, s4
M v[136:139], a[188:191], a[52:55], v[136:139]
s_bfe_u32 s3, s2, 0x20001
s_lshl_b32 s3, s3, 2
s_lshr_b32 s4, s2, 6
M v[140:143], a[188:191], a[60:63], v[140:143]
s_xor_b32 s4, s4, 2
s_add_u32 s27, s3, s4
s_lshl_b32 s23, s26, 18
M v[140:143], a[184:187], a[56:59], v[140:143]
ds_read_b64_tr_b16 a[116:117], v14 offset:49152
ds_read_b64_tr_b16 a[118:119], v14 offset:51200
s_sub_u32 s24, s23, 32768
s_max_i32 s24, s24, 0
s_lshl_b32 s25, s27, 7
s_add_u32 s3, s26, s27
M v[144:147], a[184:187], a[64:67], v[144:147]
s_and_b32 s3, s3, 0
s_mul_i32 s3, s3, 16
s_sub_u32 s31, 16, s3
M v[144:147], a[188:191], a[68:71], v[144:147]
s_mov_b32 s54, s31
s_movk_i32 s57, 128
s_mov_b32 s55, 4289069056
M v[148:151], a[188:191], a[76:79], v[148:151]
s_mov_b32 s56, 393216
s_lshl_b32 s4, s3, 7
s_add_u32 s23, s23, s4
M v[148:151], a[184:187], a[72:75], v[148:151]
s_add_u32 s24, s24, s4
s_mul_i32 s4, s3, 393216
s_add_u32 s25, s25, s4
s_mov_b64 s[8:9], s[44:45]
M v[152:155], a[184:187], a[80:83], v[152:155]
s_mov_b32 s10, 4194304
s_mov_b64 s[12:13], s[46:47]
s_mov_b32 s14, 6291456
M v[152:155], a[188:191], a[84:87], v[152:155]
ds_read_b64_tr_b16 a[124:125], v15 offset:49152
ds_read_b64_tr_b16 a[126:127], v15 offset:51200
s_mov_b64 s[36:37], s[90:91]
s_mov_b32 s38, 256
s_mov_b32 s39, 0x00020000
M v[156:159], a[188:191], a[92:95], v[156:159]
s_lshl_b32 s28, s20, 9
s_mul_i32 s30, s20, 6144
s_lshl_b32 s3, s20, 5
M v[156:159], a[184:187], a[88:91], v[156:159]
s_waitcnt lgkmcnt(10)
v_lshrrev_b32 v24, 3, v0
v_and_b32 v25, 7, v0
v_add_u32 v28, s3, v24
v_add_u32 v26, 0, v28
M v[160:163], a[160:163], a[32:35], v[160:163]
v_bfe_u32 v27, v26, 1, 3
v_xor_b32 v27, v27, v25
v_lshlrev_b32 v26, 11, v26
M v[160:163], a[164:167], a[36:39], v[160:163]
ds_read_b128 a[176:179], v10 offset:20480
ds_read_b128 a[180:183], v11 offset:20480
v_lshl_add_u32 v26, v27, 4, v26
v_subrev_u32 v2, 0, v26
v_add_u32 v26, 8, v28
M v[164:167], a[164:167], a[44:47], v[164:167]
v_bfe_u32 v27, v26, 1, 3
v_xor_b32 v27, v27, v25
v_lshlrev_b32 v26, 11, v26
v_lshl_add_u32 v26, v27, 4, v26
M v[164:167], a[160:163], a[40:43], v[164:167]
ds_read_b64_tr_b16 a[132:133], v16 offset:49152
ds_read_b64_tr_b16 a[134:135], v16 offset:51200
v_subrev_u32 v3, 1024, v26
v_add_u32 v26, 16, v28
v_bfe_u32 v27, v26, 1, 3
M v[168:171], a[160:163], a[48:51], v[168:171]
v_xor_b32 v27, v27, v25
v_lshlrev_b32 v26, 11, v26
v_lshl_add_u32 v26, v27, 4, v26
M v[168:171], a[164:167], a[52:55], v[168:171]
v_subrev_u32 v4, 2048, v26
v_add_u32 v26, 24, v28
v_bfe_u32 v27, v26, 1, 3
M v[172:175], a[164:167], a[60:63], v[172:175]
v_xor_b32 v27, v27, v25
v_lshlrev_b32 v26, 11, v26
v_lshl_add_u32 v26, v27, 4, v26
v_subrev_u32 v5, 3072, v26
M v[172:175], a[160:163], a[56:59], v[172:175]
s_lshl_b32 s3, s20, 2
v_lshrrev_b32 v26, 5, v0
v_add_u32 v26, s3, v26
M v[176:179], a[160:163], a[64:67], v[176:179]
v_bfe_u32 v29, v0, 2, 3
v_bfe_u32 v27, v26, 1, 3
v_xor_b32 v27, v27, v29
M v[176:179], a[164:167], a[68:71], v[176:179]
ds_read_b64_tr_b16 a[140:141], v17 offset:49152
ds_read_b64_tr_b16 a[142:143], v17 offset:51200
v_lshlrev_b32 v27, 4, v27
v_and_b32 v30, 3, v0
v_lshl_add_u32 v27, v30, 2, v27
M v[180:183], a[164:167], a[76:79], v[180:183]
v_lshl_add_u32 v20, v26, 11, v27
v_add_u32 v26, 2, v26
v_bfe_u32 v27, v26, 1, 3
v_xor_b32 v27, v27, v29
M v[180:183], a[160:163], a[72:75], v[180:183]
v_lshlrev_b32 v27, 4, v27
v_and_b32 v30, 3, v0
v_lshl_add_u32 v27, v30, 2, v27
M v[184:187], a[160:163], a[80:83], v[184:187]
v_lshl_add_u32 v23, v26, 11, v27
v_subrev_u32 v23, 256, v23
s_mul_i32 s3, s20, 48
M v[184:187], a[164:167], a[84:87], v[184:187]
v_add_u32 v28, s3, v24
v_add_u32 v26, 0, v28
v_mul_u32_u24 v27, 0xaaab, v26
v_lshrrev_b32 v27, 17, v27
M v[188:191], a[164:167], a[92:95], v[188:191]
v_lshrrev_b32 v29, 1, v27
v_and_b32 v29, 4, v29
v_and_or_b32 v27, v27, 2, v29
M v[188:191], a[160:163], a[88:91], v[188:191]
s_waitcnt lgkmcnt(12)
ds_read_b64_tr_b16 a[148:149], v18 offset:49152
ds_read_b64_tr_b16 a[150:151], v18 offset:51200
v_xor_b32 v27, v27, v25
v_lshlrev_b32 v26, 11, v26
v_lshl_add_u32 v26, v27, 4, v26
M v[192:195], a[168:171], a[32:35], v[192:195]
v_subrev_u32 v6, 0, v26
v_add_u32 v26, 8, v28
v_mul_u32_u24 v27, 0xaaab, v26
M v[192:195], a[172:175], a[36:39], v[192:195]
ds_read_b128 a[184:187], v10 offset:22528
ds_read_b128 a[188:191], v11 offset:22528
v_lshrrev_b32 v27, 17, v27
v_lshrrev_b32 v29, 1, v27
v_and_b32 v29, 4, v29
v_and_or_b32 v27, v27, 2, v29
M v[196:199], a[172:175], a[44:47], v[196:199]
v_xor_b32 v27, v27, v25
v_lshlrev_b32 v26, 11, v26
v_lshl_add_u32 v26, v27, 4, v26
M v[196:199], a[168:171], a[40:43], v[196:199]
v_subrev_u32 v7, 1024, v26
v_add_u32 v26, 16, v28
v_mul_u32_u24 v27, 0xaaab, v26
M v[200:203], a[168:171], a[48:51], v[200:203]
v_lshrrev_b32 v27, 17, v27
v_lshrrev_b32 v29, 1, v27
v_and_b32 v29, 4, v29
M v[200:203], a[172:175], a[52:55], v[200:203]
ds_read_b64_tr_b16 a[156:157], v19 offset:49152
ds_read_b64_tr_b16 a[158:159], v19 offset:51200
v_and_or_b32 v27, v27, 2, v29
v_xor_b32 v27, v27, v25
v_lshlrev_b32 v26, 11, v26
v_lshl_add_u32 v26, v27, 4, v26
M v[204:207], a[172:175], a[60:63], v[204:207]
v_subrev_u32 v8, 2048, v26
v_add_u32 v26, 24, v28
v_mul_u32_u24 v27, 0xaaab, v26
M v[204:207], a[168:171], a[56:59], v[204:207]
v_lshrrev_b32 v27, 17, v27
v_lshrrev_b32 v29, 1, v27
v_and_b32 v29, 4, v29
M v[208:211], a[168:171], a[64:67], v[208:211]
v_and_or_b32 v27, v27, 2, v29
v_xor_b32 v27, v27, v25
v_lshlrev_b32 v26, 11, v26
v_lshl_add_u32 v26, v27, 4, v26
M v[208:211], a[172:175], a[68:71], v[208:211]
v_subrev_u32 v9, 3072, v26
v_add_u32 v26, 32, v28
v_mul_u32_u24 v27, 0xaaab, v26
M v[212:215], a[172:175], a[76:79], v[212:215]
v_lshrrev_b32 v27, 17, v27
v_lshrrev_b32 v29, 1, v27
v_and_b32 v29, 4, v29
M v[212:215], a[168:171], a[72:75], v[212:215]
v_and_or_b32 v27, v27, 2, v29
v_xor_b32 v27, v27, v25
v_lshlrev_b32 v26, 11, v26
M v[216:219], a[168:171], a[80:83], v[216:219]
v_lshl_add_u32 v26, v27, 4, v26
v_subrev_u32 v21, 0, v26
v_add_u32 v26, 40, v28
v_mul_u32_u24 v27, 0xaaab, v26
M v[216:219], a[172:175], a[84:87], v[216:219]
v_lshrrev_b32 v27, 17, v27
v_lshrrev_b32 v29, 1, v27
v_and_b32 v29, 4, v29
M v[220:223], a[172:175], a[92:95], v[220:223]
v_and_or_b32 v27, v27, 2, v29
v_xor_b32 v27, v27, v25
v_lshlrev_b32 v26, 11, v26
M v[220:223], a[168:171], a[88:91], v[220:223]
s_waitcnt lgkmcnt(10)
v_lshl_add_u32 v26, v27, 4, v26
v_subrev_u32 v22, 1024, v26
s_lshr_b32 s3, s53, 7
M v[224:227], a[176:179], a[32:35], v[224:227]
s_add_u32 s3, s3, s22
s_lshl_b32 s3, s3, 5
s_lshr_b32 s19, s52, 6
s_add_u32 s3, s3, s19
M v[224:227], a[180:183], a[36:39], v[224:227]
s_lshl_b32 s19, s21, 1
s_add_u32 s3, s3, s19
s_lshl_b32 s92, s3, 15
M v[228:231], a[180:183], a[44:47], v[228:231]
s_add_u32 s92, s92, 16384
s_add_u32 s93, s92, 32768
s_add_u32 s16, s50, 16777216
M v[228:231], a[176:179], a[40:43], v[228:231]
s_addc_u32 s17, s51, 0
s_mov_b32 s18, 33554432
s_mov_b32 s19, 0x00020000
M v[232:235], a[176:179], a[48:51], v[232:235]
M v[232:235], a[180:183], a[52:55], v[232:235]
M v[236:239], a[180:183], a[60:63], v[236:239]
M v[236:239], a[176:179], a[56:59], v[236:239]
s_waitcnt vmcnt(4) lgkmcnt(0)
s_barrier
ds_read_b128 a[160:163], v10 offset:32768
ds_read_b128 a[164:167], v11 offset:32768
M v[240:243], a[176:179], a[64:67], v[240:243]
s_add_u32 m0, s28, 131072
s_nop 0
buffer_load_dword v20, s[8:11], s24 offen lds
M v[240:243], a[180:183], a[68:71], v[240:243]
M v[244:247], a[180:183], a[76:79], v[244:247]
M v[244:247], a[176:179], a[72:75], v[244:247]
buffer_load_dword v23, s[8:11], s24 offen offset:256 lds
M v[248:251], a[176:179], a[80:83], v[248:251]
M v[248:251], a[180:183], a[84:87], v[248:251]
M v[252:255], a[180:183], a[92:95], v[252:255]
M v[252:255], a[176:179], a[88:91], v[252:255]
M a[0:3], a[184:187], a[32:35], a[0:3]
s_add_u32 m0, s29, 133120
s_nop 0
buffer_load_dwordx4 v2, s[8:11], s23 offen offset:0 lds
M a[0:3], a[188:191], a[36:39], a[0:3]
ds_read_b128 a[168:171], v10 offset:34816
ds_read_b128 a[172:175], v11 offset:34816
M a[4:7], a[188:191], a[44:47], a[4:7]
M a[4:7], a[184:187], a[40:43], a[4:7]
M a[8:11], a[184:187], a[48:51], a[8:11]
buffer_load_dwordx4 v3, s[8:11], s23 offen offset:1024 lds
M a[8:11], a[188:191], a[52:55], a[8:11]
M a[12:15], a[188:191], a[60:63], a[12:15]
M a[12:15], a[184:187], a[56:59], a[12:15]
M a[16:19], a[184:187], a[64:67], a[16:19]
buffer_load_dwordx4 v4, s[8:11], s23 offen offset:2048 lds
M a[16:19], a[188:191], a[68:71], a[16:19]
M a[20:23], a[188:191], a[76:79], a[20:23]
M a[20:23], a[184:187], a[72:75], a[20:23]
buffer_load_dwordx4 v5, s[8:11], s23 offen offset:3072 lds
M a[24:27], a[184:187], a[80:83], a[24:27]
M a[24:27], a[188:191], a[84:87], a[24:27]
M a[28:31], a[188:191], a[92:95], a[28:31]
M a[28:31], a[184:187], a[88:91], a[28:31]
s_waitcnt lgkmcnt(2)
M v[32:35], a[160:163], a[96:99], v[32:35]
s_sub_u32 s31, s31, 1
s_cmp_eq_u32 s31, 0
s_cselect_b32 s58, -1920, s57
s_add_u32 s23, s23, s58
s_add_u32 s24, s24, s58
M v[32:35], a[164:167], a[100:103], v[32:35]
ds_read_b128 a[176:179], v10 offset:36864
ds_read_b128 a[180:183], v11 offset:36864
M v[36:39], a[164:167], a[108:111], v[36:39]
M v[36:39], a[160:163], a[104:107], v[36:39]
M v[40:43], a[160:163], a[112:115], v[40:43]
M v[40:43], a[164:167], a[116:119], v[40:43]
s_add_u32 m0, s30, 65536
s_nop 0
buffer_load_dwordx4 v6, s[12:15], s25 offen offset:0 lds
M v[44:47], a[164:167], a[124:127], v[44:47]
M v[44:47], a[160:163], a[120:123], v[44:47]
M v[48:51], a[160:163], a[128:131], v[48:51]
M v[48:51], a[164:167], a[132:135], v[48:51]
buffer_load_dwordx4 v7, s[12:15], s25 offen offset:1024 lds
M v[52:55], a[164:167], a[140:143], v[52:55]
M v[52:55], a[160:163], a[136:139], v[52:55]
M v[56:59], a[160:163], a[144:147], v[56:59]
M v[56:59], a[164:167], a[148:151], v[56:59]
buffer_load_dwordx4 v8, s[12:15], s25 offen offset:2048 lds
M v[60:63], a[164:167], a[156:159], v[60:63]
M v[60:63], a[160:163], a[152:155], v[60:63]
s_waitcnt lgkmcnt(2)
M v[64:67], a[168:171], a[96:99], v[64:67]
M v[64:67], a[172:175], a[100:103], v[64:67]
ds_read_b128 a[184:187], v10 offset:38912
ds_read_b128 a[188:191], v11 offset:38912
M v[68:71], a[172:175], a[108:111], v[68:71]
M v[68:71], a[168:171], a[104:107], v[68:71]
buffer_load_dwordx4 v9, s[12:15], s25 offen offset:3072 lds
M v[72:75], a[168:171], a[112:115], v[72:75]
M v[72:75], a[172:175], a[116:119], v[72:75]
M v[76:79], a[172:175], a[124:127], v[76:79]
M v[76:79], a[168:171], a[120:123], v[76:79]
s_add_u32 m0, s30, 69632
s_nop 0
buffer_load_dwordx4 v21, s[12:15], s25 offen offset:0 lds
M v[80:83], a[168:171], a[128:131], v[80:83]
M v[80:83], a[172:175], a[132:135], v[80:83]
M v[84:87], a[172:175], a[140:143], v[84:87]
M v[84:87], a[168:171], a[136:139], v[84:87]
buffer_load_dwordx4 v22, s[12:15], s25 offen offset:1024 lds
M v[88:91], a[168:171], a[144:147], v[88:91]
M v[88:91], a[172:175], a[148:151], v[88:91]
M v[92:95], a[172:175], a[156:159], v[92:95]
M v[92:95], a[168:171], a[152:155], v[92:95]
s_waitcnt lgkmcnt(2)
M v[96:99], a[176:179], a[96:99], v[96:99]
s_sub_u32 s54, s54, 1
s_cmp_eq_u32 s54, 0
s_cselect_b32 s58, s55, s56
s_add_u32 s25, s25, s58
M v[96:99], a[180:183], a[100:103], v[96:99]
M v[100:103], a[180:183], a[108:111], v[100:103]
M v[100:103], a[176:179], a[104:107], v[100:103]
v_cvt_pk_bf16_f32 v32, v32, v33
v_cvt_pk_bf16_f32 v33, v34, v35
M v[104:107], a[176:179], a[112:115], v[104:107]
v_cvt_pk_bf16_f32 v34, v64, v65
v_cvt_pk_bf16_f32 v35, v66, v67
M v[104:107], a[180:183], a[116:119], v[104:107]
v_cvt_pk_bf16_f32 v64, v48, v49
M v[108:111], a[180:183], a[124:127], v[108:111]
v_cvt_pk_bf16_f32 v65, v50, v51
v_cvt_pk_bf16_f32 v66, v80, v81
M v[108:111], a[176:179], a[120:123], v[108:111]
s_waitcnt vmcnt(12) lgkmcnt(0)
s_barrier
ds_read_b128 a[160:163], v10 offset:49152
ds_read_b128 a[164:167], v11 offset:49152
v_cvt_pk_bf16_f32 v67, v82, v83
M v[112:115], a[176:179], a[128:131], v[112:115]
s_add_u32 m0, s28, 0
s_nop 0
buffer_load_dword v20, s[8:11], s24 offen lds
v_cvt_pk_bf16_f32 v48, v40, v41
v_cvt_pk_bf16_f32 v49, v42, v43
M v[112:115], a[180:183], a[132:135], v[112:115]
v_cvt_pk_bf16_f32 v50, v72, v73
v_cvt_pk_bf16_f32 v51, v74, v75
M v[116:119], a[180:183], a[140:143], v[116:119]
v_cvt_pk_bf16_f32 v80, v56, v57
M v[116:119], a[176:179], a[136:139], v[116:119]
buffer_load_dword v23, s[8:11], s24 offen offset:256 lds
v_cvt_pk_bf16_f32 v81, v58, v59
v_cvt_pk_bf16_f32 v82, v88, v89
M v[120:123], a[176:179], a[144:147], v[120:123]
v_cvt_pk_bf16_f32 v83, v90, v91
M v[120:123], a[180:183], a[148:151], v[120:123]
v_cvt_pk_bf16_f32 v40, v36, v37
v_cvt_pk_bf16_f32 v41, v38, v39
M v[124:127], a[180:183], a[156:159], v[124:127]
s_add_u32 m0, s29, 2048
s_nop 0
buffer_load_dwordx4 v2, s[8:11], s23 offen offset:0 lds
v_cvt_pk_bf16_f32 v42, v68, v69
v_cvt_pk_bf16_f32 v43, v70, v71
M v[124:127], a[176:179], a[152:155], v[124:127]
v_cvt_pk_bf16_f32 v72, v52, v53
M v[128:131], a[184:187], a[96:99], v[128:131]
v_cvt_pk_bf16_f32 v73, v54, v55
v_cvt_pk_bf16_f32 v74, v84, v85
M v[128:131], a[188:191], a[100:103], v[128:131]
ds_read_b128 a[168:171], v10 offset:51200
ds_read_b128 a[172:175], v11 offset:51200
v_cvt_pk_bf16_f32 v75, v86, v87
M v[132:135], a[188:191], a[108:111], v[132:135]
v_cvt_pk_bf16_f32 v56, v44, v45
v_cvt_pk_bf16_f32 v57, v46, v47
M v[132:135], a[184:187], a[104:107], v[132:135]
buffer_load_dwordx4 v3, s[8:11], s23 offen offset:1024 lds
v_cvt_pk_bf16_f32 v58, v76, v77
v_cvt_pk_bf16_f32 v59, v78, v79
M v[136:139], a[184:187], a[112:115], v[136:139]
v_cvt_pk_bf16_f32 v88, v60, v61
M v[136:139], a[188:191], a[116:119], v[136:139]
v_cvt_pk_bf16_f32 v89, v62, v63
v_cvt_pk_bf16_f32 v90, v92, v93
M v[140:143], a[188:191], a[124:127], v[140:143]
buffer_load_dwordx4 v4, s[8:11], s23 offen offset:2048 lds
v_cvt_pk_bf16_f32 v91, v94, v95
M v[140:143], a[184:187], a[120:123], v[140:143]
M v[144:147], a[184:187], a[128:131], v[144:147]
M v[144:147], a[188:191], a[132:135], v[144:147]
buffer_load_dwordx4 v5, s[8:11], s23 offen offset:3072 lds
M v[148:151], a[188:191], a[140:143], v[148:151]
s_add_u32 s94, s92, 0
buffer_store_dwordx4 v[32:35], v1, s[16:19], s94 offen offset:0 sc1
M v[148:151], a[184:187], a[136:139], v[148:151]
M v[152:155], a[184:187], a[144:147], v[152:155]
M v[152:155], a[188:191], a[148:151], v[152:155]
s_sub_u32 s31, s31, 1
s_cmp_eq_u32 s31, 0
s_cselect_b32 s58, -1920, s57
s_add_u32 s23, s23, s58
s_add_u32 s24, s24, s58
M v[156:159], a[188:191], a[156:159], v[156:159]
s_add_u32 s94, s92, 0
buffer_store_dwordx4 v[40:43], v1, s[16:19], s94 offen offset:1024 sc1
M v[156:159], a[184:187], a[152:155], v[156:159]
s_waitcnt lgkmcnt(2)
M v[160:163], a[160:163], a[96:99], v[160:163]
M v[160:163], a[164:167], a[100:103], v[160:163]
ds_read_b128 a[176:179], v10 offset:53248
ds_read_b128 a[180:183], v11 offset:53248
M v[164:167], a[164:167], a[108:111], v[164:167]
s_add_u32 s94, s92, 0
buffer_store_dwordx4 v[48:51], v1, s[16:19], s94 offen offset:2048 sc1
M v[164:167], a[160:163], a[104:107], v[164:167]
v_cvt_pk_bf16_f32 v96, v96, v97
v_cvt_pk_bf16_f32 v97, v98, v99
M v[168:171], a[160:163], a[112:115], v[168:171]
v_cvt_pk_bf16_f32 v98, v128, v129
v_cvt_pk_bf16_f32 v99, v130, v131
M v[168:171], a[164:167], a[116:119], v[168:171]
s_add_u32 m0, s30, 98304
s_nop 0
buffer_load_dwordx4 v6, s[12:15], s25 offen offset:0 lds
v_cvt_pk_bf16_f32 v128, v112, v113
M v[172:175], a[164:167], a[124:127], v[172:175]
s_add_u32 s94, s92, 0
buffer_store_dwordx4 v[56:59], v1, s[16:19], s94 offen offset:3072 sc1
v_cvt_pk_bf16_f32 v129, v114, v115
v_cvt_pk_bf16_f32 v130, v144, v145
M v[172:175], a[160:163], a[120:123], v[172:175]
v_cvt_pk_bf16_f32 v131, v146, v147
M v[176:179], a[160:163], a[128:131], v[176:179]
v_cvt_pk_bf16_f32 v112, v104, v105
v_cvt_pk_bf16_f32 v113, v106, v107
M v[176:179], a[164:167], a[132:135], v[176:179]
buffer_load_dwordx4 v7, s[12:15], s25 offen offset:1024 lds
v_cvt_pk_bf16_f32 v114, v136, v137
v_cvt_pk_bf16_f32 v115, v138, v139
M v[180:183], a[164:167], a[140:143], v[180:183]
s_add_u32 s94, s92, 4096
buffer_store_dwordx4 v[64:67], v1, s[16:19], s94 offen offset:0 sc1
v_cvt_pk_bf16_f32 v144, v120, v121
M v[180:183], a[160:163], a[136:139], v[180:183]
v_cvt_pk_bf16_f32 v145, v122, v123
v_cvt_pk_bf16_f32 v146, v152, v153
M v[184:187], a[160:163], a[144:147], v[184:187]
v_cvt_pk_bf16_f32 v147, v154, v155
M v[184:187], a[164:167], a[148:151], v[184:187]
buffer_load_dwordx4 v8, s[12:15], s25 offen offset:2048 lds
v_cvt_pk_bf16_f32 v104, v100, v101
v_cvt_pk_bf16_f32 v105, v102, v103
M v[188:191], a[164:167], a[156:159], v[188:191]
s_add_u32 s94, s92, 4096
buffer_store_dwordx4 v[72:75], v1, s[16:19], s94 offen offset:1024 sc1
v_cvt_pk_bf16_f32 v106, v132, v133
v_cvt_pk_bf16_f32 v107, v134, v135
M v[188:191], a[160:163], a[152:155], v[188:191]
s_waitcnt lgkmcnt(2)
v_cvt_pk_bf16_f32 v136, v116, v117
M v[192:195], a[168:171], a[96:99], v[192:195]
v_cvt_pk_bf16_f32 v137, v118, v119
v_cvt_pk_bf16_f32 v138, v148, v149
M v[192:195], a[172:175], a[100:103], v[192:195]
ds_read_b128 a[184:187], v10 offset:55296
ds_read_b128 a[188:191], v11 offset:55296
v_cvt_pk_bf16_f32 v139, v150, v151
M v[196:199], a[172:175], a[108:111], v[196:199]
s_add_u32 s94, s92, 4096
buffer_store_dwordx4 v[80:83], v1, s[16:19], s94 offen offset:2048 sc1
v_cvt_pk_bf16_f32 v120, v108, v109
v_cvt_pk_bf16_f32 v121, v110, v111
M v[196:199], a[168:171], a[104:107], v[196:199]
v_cvt_pk_bf16_f32 v122, v140, v141
v_cvt_pk_bf16_f32 v123, v142, v143
M v[200:203], a[168:171], a[112:115], v[200:203]
buffer_load_dwordx4 v9, s[12:15], s25 offen offset:3072 lds
v_cvt_pk_bf16_f32 v152, v124, v125
M v[200:203], a[172:175], a[116:119], v[200:203]
v_cvt_pk_bf16_f32 v153, v126, v127
v_cvt_pk_bf16_f32 v154, v156, v157
M v[204:207], a[172:175], a[124:127], v[204:207]
s_add_u32 s94, s92, 4096
buffer_store_dwordx4 v[88:91], v1, s[16:19], s94 offen offset:3072 sc1
v_cvt_pk_bf16_f32 v155, v158, v159
M v[204:207], a[168:171], a[120:123], v[204:207]
M v[208:211], a[168:171], a[128:131], v[208:211]
s_add_u32 m0, s30, 102400
s_nop 0
buffer_load_dwordx4 v21, s[12:15], s25 offen offset:0 lds
M v[208:211], a[172:175], a[132:135], v[208:211]
M v[212:215], a[172:175], a[140:143], v[212:215]
M v[212:215], a[168:171], a[136:139], v[212:215]
buffer_load_dwordx4 v22, s[12:15], s25 offen offset:1024 lds
M v[216:219], a[168:171], a[144:147], v[216:219]
s_add_u32 s94, s92, 8192
buffer_store_dwordx4 v[96:99], v1, s[16:19], s94 offen offset:0 sc1
M v[216:219], a[172:175], a[148:151], v[216:219]
M v[220:223], a[172:175], a[156:159], v[220:223]
M v[220:223], a[168:171], a[152:155], v[220:223]
s_waitcnt lgkmcnt(2)
M v[224:227], a[176:179], a[96:99], v[224:227]
s_sub_u32 s54, s54, 1
s_cmp_eq_u32 s54, 0
s_cselect_b32 s58, s55, s56
s_add_u32 s25, s25, s58
M v[224:227], a[180:183], a[100:103], v[224:227]
M v[228:231], a[180:183], a[108:111], v[228:231]
s_add_u32 s94, s92, 8192
buffer_store_dwordx4 v[104:107], v1, s[16:19], s94 offen offset:1024 sc1
M v[228:231], a[176:179], a[104:107], v[228:231]
v_cvt_pk_bf16_f32 v160, v160, v161
v_cvt_pk_bf16_f32 v161, v162, v163
M v[232:235], a[176:179], a[112:115], v[232:235]
v_cvt_pk_bf16_f32 v162, v192, v193
v_cvt_pk_bf16_f32 v163, v194, v195
M v[232:235], a[180:183], a[116:119], v[232:235]
v_cvt_pk_bf16_f32 v192, v176, v177
M v[236:239], a[180:183], a[124:127], v[236:239]
v_cvt_pk_bf16_f32 v193, v178, v179
v_cvt_pk_bf16_f32 v194, v208, v209
M v[236:239], a[176:179], a[120:123], v[236:239]
s_waitcnt vmcnt(63) lgkmcnt(0)
s_barrier
v_cvt_pk_bf16_f32 v195, v210, v211
M v[240:243], a[176:179], a[128:131], v[240:243]
s_add_u32 s94, s92, 8192
buffer_store_dwordx4 v[112:115], v1, s[16:19], s94 offen offset:2048 sc1
v_cvt_pk_bf16_f32 v176, v168, v169
v_cvt_pk_bf16_f32 v177, v170, v171
M v[240:243], a[180:183], a[132:135], v[240:243]
s_add_u32 m0, s28, 18432
s_nop 0
buffer_load_dword v20, s[8:11], s24 offen lds
v_cvt_pk_bf16_f32 v178, v200, v201
v_cvt_pk_bf16_f32 v179, v202, v203
M v[244:247], a[180:183], a[140:143], v[244:247]
v_cvt_pk_bf16_f32 v208, v184, v185
M v[244:247], a[176:179], a[136:139], v[244:247]
v_cvt_pk_bf16_f32 v209, v186, v187
v_cvt_pk_bf16_f32 v210, v216, v217
M v[248:251], a[176:179], a[144:147], v[248:251]
buffer_load_dword v23, s[8:11], s24 offen offset:256 lds
v_cvt_pk_bf16_f32 v211, v218, v219
M v[248:251], a[180:183], a[148:151], v[248:251]
v_cvt_pk_bf16_f32 v168, v164, v165
v_cvt_pk_bf16_f32 v169, v166, v167
M v[252:255], a[180:183], a[156:159], v[252:255]
s_add_u32 s94, s92, 8192
buffer_store_dwordx4 v[120:123], v1, s[16:19], s94 offen offset:3072 sc1
v_cvt_pk_bf16_f32 v170, v196, v197
v_cvt_pk_bf16_f32 v171, v198, v199
M v[252:255], a[176:179], a[152:155], v[252:255]
v_cvt_pk_bf16_f32 v200, v180, v181
M a[0:3], a[184:187], a[96:99], a[0:3]
v_cvt_pk_bf16_f32 v201, v182, v183
v_cvt_pk_bf16_f32 v202, v212, v213
M a[0:3], a[188:191], a[100:103], a[0:3]
s_add_u32 m0, s29, 20480
s_nop 0
buffer_load_dwordx4 v2, s[8:11], s23 offen offset:0 lds
v_cvt_pk_bf16_f32 v203, v214, v215
M a[4:7], a[188:191], a[108:111], a[4:7]
v_cvt_pk_bf16_f32 v184, v172, v173
v_cvt_pk_bf16_f32 v185, v174, v175
M a[4:7], a[184:187], a[104:107], a[4:7]
v_cvt_pk_bf16_f32 v186, v204, v205
v_cvt_pk_bf16_f32 v187, v206, v207
M a[8:11], a[184:187], a[112:115], a[8:11]
s_add_u32 s94, s92, 12288
buffer_store_dwordx4 v[128:131], v1, s[16:19], s94 offen offset:0 sc1
v_cvt_pk_bf16_f32 v216, v188, v189
M a[8:11], a[188:191], a[116:119], a[8:11]
buffer_load_dwordx4 v3, s[8:11], s23 offen offset:1024 lds
v_cvt_pk_bf16_f32 v217, v190, v191
v_cvt_pk_bf16_f32 v218, v220, v221
M a[12:15], a[188:191], a[124:127], a[12:15]
v_cvt_pk_bf16_f32 v219, v222, v223
M a[12:15], a[184:187], a[120:123], a[12:15]
M a[16:19], a[184:187], a[128:131], a[16:19]
buffer_load_dwordx4 v4, s[8:11], s23 offen offset:2048 lds
M a[16:19], a[188:191], a[132:135], a[16:19]
M a[20:23], a[188:191], a[140:143], a[20:23]
s_add_u32 s94, s92, 12288
buffer_store_dwordx4 v[136:139], v1, s[16:19], s94 offen offset:1024 sc1
M a[20:23], a[184:187], a[136:139], a[20:23]
M a[24:27], a[184:187], a[144:147], a[24:27]
buffer_load_dwordx4 v5, s[8:11], s23 offen offset:3072 lds
M a[24:27], a[188:191], a[148:151], a[24:27]
M a[28:31], a[188:191], a[156:159], a[28:31]
M a[28:31], a[184:187], a[152:155], a[28:31]
v_accvgpr_read_b32 v24, a0
v_accvgpr_read_b32 v25, a1
v_accvgpr_read_b32 v26, a2
v_accvgpr_read_b32 v27, a3
v_cvt_pk_bf16_f32 v224, v224, v225
v_cvt_pk_bf16_f32 v225, v226, v227
v_cvt_pk_bf16_f32 v226, v24, v25
v_cvt_pk_bf16_f32 v227, v26, v27
v_accvgpr_read_b32 v24, a16
v_accvgpr_read_b32 v25, a17
v_accvgpr_read_b32 v26, a18
v_accvgpr_read_b32 v27, a19
v_cvt_pk_bf16_f32 v36, v240, v241
v_cvt_pk_bf16_f32 v37, v242, v243
v_cvt_pk_bf16_f32 v38, v24, v25
v_cvt_pk_bf16_f32 v39, v26, v27
v_accvgpr_read_b32 v24, a24
v_accvgpr_read_b32 v25, a25
v_accvgpr_read_b32 v26, a26
v_accvgpr_read_b32 v27, a27
v_cvt_pk_bf16_f32 v52, v248, v249
v_cvt_pk_bf16_f32 v53, v250, v251
v_cvt_pk_bf16_f32 v54, v24, v25
v_cvt_pk_bf16_f32 v55, v26, v27
v_accvgpr_read_b32 v24, a8
v_accvgpr_read_b32 v25, a9
v_accvgpr_read_b32 v26, a10
v_accvgpr_read_b32 v27, a11
v_cvt_pk_bf16_f32 v240, v232, v233
v_cvt_pk_bf16_f32 v241, v234, v235
v_cvt_pk_bf16_f32 v242, v24, v25
v_cvt_pk_bf16_f32 v243, v26, v27
v_accvgpr_read_b32 v28, a4
v_accvgpr_read_b32 v29, a5
v_accvgpr_read_b32 v30, a6
v_accvgpr_read_b32 v31, a7
v_cvt_pk_bf16_f32 v232, v228, v229
v_cvt_pk_bf16_f32 v233, v230, v231
v_cvt_pk_bf16_f32 v234, v28, v29
v_cvt_pk_bf16_f32 v235, v30, v31
v_accvgpr_read_b32 v28, a12
v_accvgpr_read_b32 v29, a13
v_accvgpr_read_b32 v30, a14
v_accvgpr_read_b32 v31, a15
v_cvt_pk_bf16_f32 v248, v236, v237
v_cvt_pk_bf16_f32 v249, v238, v239
v_cvt_pk_bf16_f32 v250, v28, v29
v_cvt_pk_bf16_f32 v251, v30, v31
v_accvgpr_read_b32 v28, a20
v_accvgpr_read_b32 v29, a21
v_accvgpr_read_b32 v30, a22
v_accvgpr_read_b32 v31, a23
v_cvt_pk_bf16_f32 v44, v244, v245
v_cvt_pk_bf16_f32 v45, v246, v247
v_cvt_pk_bf16_f32 v46, v28, v29
v_cvt_pk_bf16_f32 v47, v30, v31
v_accvgpr_read_b32 v28, a28
v_accvgpr_read_b32 v29, a29
v_accvgpr_read_b32 v30, a30
v_accvgpr_read_b32 v31, a31
v_cvt_pk_bf16_f32 v60, v252, v253
v_cvt_pk_bf16_f32 v61, v254, v255
v_cvt_pk_bf16_f32 v62, v28, v29
v_cvt_pk_bf16_f32 v63, v30, v31
Lk1_b:
v_and_b32 v24, 15, v0
v_lshlrev_b32 v24, 7, v24
v_bfe_u32 v25, v0, 1, 3
v_lshrrev_b32 v26, 4, v0
v_xor_b32 v25, v25, v26
v_lshl_add_u32 v10, v25, 4, v24
v_xor_b32 v11, 64, v10
v_add_u32 v12, 131072, v10
v_add_u32 v13, 131072, v11
v_bfe_u32 v24, v0, 2, 2
v_lshl_add_u32 v29, v26, 3, v24
v_mul_u32_u24 v25, 384, v29
v_and_b32 v27, 1, v0
v_lshl_add_u32 v25, v27, 3, v25
v_add_u32 v25, 36864, v25
v_lshrrev_b32 v24, 1, v29
v_and_b32 v24, 4, v24
v_and_or_b32 v24, v29, 2, v24
v_bfe_u32 v26, v0, 1, 1
s_mul_i32 s4, s20, 3
s_add_u32 s3, s4, 0
s_and_b32 s5, s3, 3
s_lshl_b32 s5, s5, 1
s_lshr_b32 s3, s3, 2
s_lshl_b32 s3, s3, 7
v_add_u32 v27, s5, v26
v_xor_b32 v27, v27, v24
v_lshl_add_u32 v27, v27, 4, v25
v_add_u32 v14, s3, v27
v_add_u32 v17, 61440, v14
s_add_u32 s3, s4, 1
s_and_b32 s5, s3, 3
s_lshl_b32 s5, s5, 1
s_lshr_b32 s3, s3, 2
s_lshl_b32 s3, s3, 7
v_add_u32 v27, s5, v26
v_xor_b32 v27, v27, v24
v_lshl_add_u32 v27, v27, 4, v25
v_add_u32 v15, s3, v27
v_add_u32 v18, 61440, v15
s_add_u32 s3, s4, 2
s_and_b32 s5, s3, 3
s_lshl_b32 s5, s5, 1
s_lshr_b32 s3, s3, 2
s_lshl_b32 s3, s3, 7
v_add_u32 v27, s5, v26
v_xor_b32 v27, v27, v24
v_lshl_add_u32 v27, v27, 4, v25
v_add_u32 v16, s3, v27
v_add_u32 v19, 61440, v16
s_waitcnt vmcnt(11)
s_barrier
ds_read_b64_tr_b16 a[176:177], v14 offset:28672
ds_read_b64_tr_b16 a[178:179], v14 offset:30208
ds_read_b64_tr_b16 a[184:185], v15 offset:28672
ds_read_b64_tr_b16 a[186:187], v15 offset:30208
ds_read_b64_tr_b16 a[192:193], v16 offset:28672
ds_read_b64_tr_b16 a[194:195], v16 offset:30208
ds_read_b64_tr_b16 a[180:181], v14 offset:40960
ds_read_b64_tr_b16 a[182:183], v14 offset:42496
ds_read_b64_tr_b16 a[188:189], v15 offset:40960
ds_read_b64_tr_b16 a[190:191], v15 offset:42496
ds_read_b64_tr_b16 a[196:197], v16 offset:40960
ds_read_b64_tr_b16 a[198:199], v16 offset:42496
ds_read_b128 a[224:227], v12 offset:0
ds_read_b128 a[228:231], v13 offset:0
ds_read_b128 a[232:235], v12 offset:2048
ds_read_b128 a[236:239], v13 offset:2048
ds_read_b128 a[240:243], v12 offset:4096
ds_read_b128 a[244:247], v13 offset:4096
s_waitcnt lgkmcnt(0)
s_barrier
M a[68:71], a[176:179], a[224:227], 0
ds_read_b128 a[248:251], v12 offset:6144
ds_read_b128 a[252:255], v13 offset:6144
M a[68:71], a[180:183], a[228:231], a[68:71]
s_sub_u32 s31, s31, 1
s_cmp_eq_u32 s31, 0
s_cselect_b32 s58, -1920, s57
s_add_u32 s23, s23, s58
s_add_u32 s24, s24, s58
M a[72:75], a[188:191], a[228:231], 0
ds_read_b64_tr_b16 a[200:201], v17 offset:0
ds_read_b64_tr_b16 a[202:203], v17 offset:1536
M a[72:75], a[184:187], a[224:227], a[72:75]
s_add_u32 m0, s30, 36864
s_nop 0
buffer_load_dwordx4 v6, s[12:15], s25 offen offset:0 lds
M a[76:79], a[192:195], a[224:227], 0
M a[76:79], a[196:199], a[228:231], a[76:79]
buffer_load_dwordx4 v7, s[12:15], s25 offen offset:1024 lds
M a[80:83], a[180:183], a[236:239], 0
ds_read_b128 a[224:227], v12 offset:8192
ds_read_b128 a[228:231], v13 offset:8192
M a[80:83], a[176:179], a[232:235], a[80:83]
M a[84:87], a[184:187], a[232:235], 0
ds_read_b64_tr_b16 a[208:209], v18 offset:0
ds_read_b64_tr_b16 a[210:211], v18 offset:1536
M a[84:87], a[188:191], a[236:239], a[84:87]
buffer_load_dwordx4 v8, s[12:15], s25 offen offset:2048 lds
M a[88:91], a[196:199], a[236:239], 0
M a[88:91], a[192:195], a[232:235], a[88:91]
buffer_load_dwordx4 v9, s[12:15], s25 offen offset:3072 lds
M a[92:95], a[176:179], a[240:243], 0
ds_read_b128 a[232:235], v12 offset:10240
ds_read_b128 a[236:239], v13 offset:10240
M a[92:95], a[180:183], a[244:247], a[92:95]
M a[96:99], a[188:191], a[244:247], 0
ds_read_b64_tr_b16 a[216:217], v19 offset:0
ds_read_b64_tr_b16 a[218:219], v19 offset:1536
M a[96:99], a[184:187], a[240:243], a[96:99]
s_add_u32 m0, s30, 40960
s_nop 0
buffer_load_dwordx4 v21, s[12:15], s25 offen offset:0 lds
M a[100:103], a[192:195], a[240:243], 0
buffer_load_dwordx4 v22, s[12:15], s25 offen offset:1024 lds
M a[100:103], a[196:199], a[244:247], a[100:103]
s_waitcnt lgkmcnt(10)
M a[104:107], a[180:183], a[252:255], 0
ds_read_b128 a[240:243], v12 offset:12288
ds_read_b128 a[244:247], v13 offset:12288
M a[104:107], a[176:179], a[248:251], a[104:107]
s_sub_u32 s54, s54, 1
s_cmp_eq_u32 s54, 0
s_cselect_b32 s58, s55, s56
s_add_u32 s25, s25, s58
M a[108:111], a[184:187], a[248:251], 0
ds_read_b64_tr_b16 a[204:205], v17 offset:12288
ds_read_b64_tr_b16 a[206:207], v17 offset:13824
M a[108:111], a[188:191], a[252:255], a[108:111]
M a[112:115], a[196:199], a[252:255], 0
s_add_u32 m0, s30, 65536
s_nop 0
buffer_load_dwordx4 v6, s[12:15], s25 offen offset:0 lds
M a[112:115], a[192:195], a[248:251], a[112:115]
s_waitcnt lgkmcnt(10)
M a[116:119], a[176:179], a[224:227], 0
ds_read_b128 a[248:251], v12 offset:14336
ds_read_b128 a[252:255], v13 offset:14336
M a[116:119], a[180:183], a[228:231], a[116:119]
buffer_load_dwordx4 v7, s[12:15], s25 offen offset:1024 lds
M a[120:123], a[188:191], a[228:231], 0
ds_read_b64_tr_b16 a[212:213], v18 offset:12288
ds_read_b64_tr_b16 a[214:215], v18 offset:13824
M a[120:123], a[184:187], a[224:227], a[120:123]
M a[124:127], a[192:195], a[224:227], 0
buffer_load_dwordx4 v8, s[12:15], s25 offen offset:2048 lds
M a[124:127], a[196:199], a[228:231], a[124:127]
buffer_load_dwordx4 v9, s[12:15], s25 offen offset:3072 lds
s_waitcnt lgkmcnt(10)
M a[128:131], a[180:183], a[236:239], 0
ds_read_b128 a[224:227], v12 offset:16384
ds_read_b128 a[228:231], v13 offset:16384
M a[128:131], a[176:179], a[232:235], a[128:131]
M a[132:135], a[184:187], a[232:235], 0
ds_read_b64_tr_b16 a[220:221], v19 offset:12288
ds_read_b64_tr_b16 a[222:223], v19 offset:13824
M a[132:135], a[188:191], a[236:239], a[132:135]
s_add_u32 m0, s30, 69632
s_nop 0
buffer_load_dwordx4 v21, s[12:15], s25 offen offset:0 lds
M a[136:139], a[196:199], a[236:239], 0
M a[136:139], a[192:195], a[232:235], a[136:139]
buffer_load_dwordx4 v22, s[12:15], s25 offen offset:1024 lds
s_waitcnt lgkmcnt(10)
M a[140:143], a[176:179], a[240:243], 0
M a[140:143], a[180:183], a[244:247], a[140:143]
s_sub_u32 s54, s54, 1
s_cmp_eq_u32 s54, 0
s_cselect_b32 s58, s55, s56
s_add_u32 s25, s25, s58
M a[144:147], a[188:191], a[244:247], 0
M a[144:147], a[184:187], a[240:243], a[144:147]
M a[148:151], a[192:195], a[240:243], 0
s_waitcnt vmcnt(6) lgkmcnt(0)
s_barrier
ds_read_b128 a[232:235], v10 offset:0
ds_read_b128 a[236:239], v11 offset:0
M a[148:151], a[196:199], a[244:247], a[148:151]
s_add_u32 m0, s28, 131072
s_nop 0
buffer_load_dword v20, s[8:11], s24 offen lds
M a[152:155], a[180:183], a[252:255], 0
ds_read_b128 a[240:243], v10 offset:2048
ds_read_b128 a[244:247], v11 offset:2048
M a[152:155], a[176:179], a[248:251], a[152:155]
M a[156:159], a[184:187], a[248:251], 0
buffer_load_dword v23, s[8:11], s24 offen offset:256 lds
M a[156:159], a[188:191], a[252:255], a[156:159]
M a[160:163], a[196:199], a[252:255], 0
M a[160:163], a[192:195], a[248:251], a[160:163]
s_add_u32 m0, s29, 133120
s_nop 0
buffer_load_dwordx4 v2, s[8:11], s23 offen offset:0 lds
M a[164:167], a[176:179], a[224:227], 0
ds_read_b128 a[248:251], v10 offset:4096
ds_read_b128 a[252:255], v11 offset:4096
M a[164:167], a[180:183], a[228:231], a[164:167]
M a[168:171], a[188:191], a[228:231], 0
M a[168:171], a[184:187], a[224:227], a[168:171]
buffer_load_dwordx4 v3, s[8:11], s23 offen offset:1024 lds
M a[172:175], a[192:195], a[224:227], 0
M a[172:175], a[196:199], a[228:231], a[172:175]
s_waitcnt lgkmcnt(4)
M a[68:71], a[200:203], a[232:235], a[68:71]
ds_read_b128 a[224:227], v10 offset:6144
ds_read_b128 a[228:231], v11 offset:6144
M a[68:71], a[204:207], a[236:239], a[68:71]
buffer_load_dwordx4 v4, s[8:11], s23 offen offset:2048 lds
M a[72:75], a[212:215], a[236:239], a[72:75]
ds_read_b64_tr_b16 a[176:177], v14 offset:0
ds_read_b64_tr_b16 a[178:179], v14 offset:1536
M a[72:75], a[208:211], a[232:235], a[72:75]
buffer_load_dwordx4 v5, s[8:11], s23 offen offset:3072 lds
M a[76:79], a[216:219], a[232:235], a[76:79]
M a[76:79], a[220:223], a[236:239], a[76:79]
s_sub_u32 s31, s31, 1
s_cmp_eq_u32 s31, 0
s_cselect_b32 s58, -1920, s57
s_add_u32 s23, s23, s58
s_add_u32 s24, s24, s58
s_waitcnt lgkmcnt(6)
M a[80:83], a[204:207], a[244:247], a[80:83]
ds_read_b128 a[232:235], v10 offset:8192
ds_read_b128 a[236:239], v11 offset:8192
M a[80:83], a[200:203], a[240:243], a[80:83]
M a[84:87], a[208:211], a[240:243], a[84:87]
ds_read_b64_tr_b16 a[184:185], v15 offset:0
ds_read_b64_tr_b16 a[186:187], v15 offset:1536
M a[84:87], a[212:215], a[244:247], a[84:87]
s_add_u32 m0, s30, 98304
s_nop 0
buffer_load_dwordx4 v6, s[12:15], s25 offen offset:0 lds
M a[88:91], a[220:223], a[244:247], a[88:91]
M a[88:91], a[216:219], a[240:243], a[88:91]
buffer_load_dwordx4 v7, s[12:15], s25 offen offset:1024 lds
s_waitcnt lgkmcnt(8)
M a[92:95], a[200:203], a[248:251], a[92:95]
ds_read_b128 a[240:243], v10 offset:10240
ds_read_b128 a[244:247], v11 offset:10240
M a[92:95], a[204:207], a[252:255], a[92:95]
M a[96:99], a[212:215], a[252:255], a[96:99]
ds_read_b64_tr_b16 a[192:193], v16 offset:0
ds_read_b64_tr_b16 a[194:195], v16 offset:1536
M a[96:99], a[208:211], a[248:251], a[96:99]
buffer_load_dwordx4 v8, s[12:15], s25 offen offset:2048 lds
M a[100:103], a[216:219], a[248:251], a[100:103]
M a[100:103], a[220:223], a[252:255], a[100:103]
buffer_load_dwordx4 v9, s[12:15], s25 offen offset:3072 lds
s_waitcnt lgkmcnt(10)
M a[104:107], a[204:207], a[228:231], a[104:107]
ds_read_b128 a[248:251], v10 offset:12288
ds_read_b128 a[252:255], v11 offset:12288
M a[104:107], a[200:203], a[224:227], a[104:107]
M a[108:111], a[208:211], a[224:227], a[108:111]
ds_read_b64_tr_b16 a[180:181], v14 offset:12288
ds_read_b64_tr_b16 a[182:183], v14 offset:13824
M a[108:111], a[212:215], a[228:231], a[108:111]
s_add_u32 m0, s30, 102400
s_nop 0
buffer_load_dwordx4 v21, s[12:15], s25 offen offset:0 lds
M a[112:115], a[220:223], a[228:231], a[112:115]
M a[112:115], a[216:219], a[224:227], a[112:115]
buffer_load_dwordx4 v22, s[12:15], s25 offen offset:1024 lds
s_waitcnt lgkmcnt(10)
M a[116:119], a[200:203], a[232:235], a[116:119]
ds_read_b128 a[224:227], v10 offset:14336
ds_read_b128 a[228:231], v11 offset:14336
M a[116:119], a[204:207], a[236:239], a[116:119]
M a[120:123], a[212:215], a[236:239], a[120:123]
ds_read_b64_tr_b16 a[188:189], v15 offset:12288
ds_read_b64_tr_b16 a[190:191], v15 offset:13824
M a[120:123], a[208:211], a[232:235], a[120:123]
s_sub_u32 s54, s54, 1
s_cmp_eq_u32 s54, 0
s_cselect_b32 s58, s55, s56
s_add_u32 s25, s25, s58
M a[124:127], a[216:219], a[232:235], a[124:127]
M a[124:127], a[220:223], a[236:239], a[124:127]
s_add_u32 s94, s92, 12288
buffer_store_dwordx4 v[144:147], v1, s[16:19], s94 offen offset:2048 sc1
s_waitcnt lgkmcnt(10)
M a[128:131], a[204:207], a[244:247], a[128:131]
ds_read_b128 a[232:235], v10 offset:16384
ds_read_b128 a[236:239], v11 offset:16384
M a[128:131], a[200:203], a[240:243], a[128:131]
M a[132:135], a[208:211], a[240:243], a[132:135]
ds_read_b64_tr_b16 a[196:197], v16 offset:12288
ds_read_b64_tr_b16 a[198:199], v16 offset:13824
M a[132:135], a[212:215], a[244:247], a[132:135]
s_add_u32 s94, s92, 12288
buffer_store_dwordx4 v[152:155], v1, s[16:19], s94 offen offset:3072 sc1
M a[136:139], a[220:223], a[244:247], a[136:139]
M a[136:139], a[216:219], a[240:243], a[136:139]
s_add_u32 s94, s93, 0
buffer_store_dwordx4 v[160:163], v1, s[16:19], s94 offen offset:0 sc1
s_waitcnt lgkmcnt(10)
M a[140:143], a[200:203], a[248:251], a[140:143]
M a[140:143], a[204:207], a[252:255], a[140:143]
s_add_u32 s94, s93, 0
buffer_store_dwordx4 v[168:171], v1, s[16:19], s94 offen offset:1024 sc1
M a[144:147], a[212:215], a[252:255], a[144:147]
M a[144:147], a[208:211], a[248:251], a[144:147]
M a[148:151], a[216:219], a[248:251], a[148:151]
s_waitcnt vmcnt(16) lgkmcnt(0)
s_barrier
ds_read_b128 a[240:243], v10 offset:18432
ds_read_b128 a[244:247], v11 offset:18432
M a[148:151], a[220:223], a[252:255], a[148:151]
s_add_u32 m0, s28, 0
s_nop 0
buffer_load_dword v20, s[8:11], s24 offen lds
M a[152:155], a[204:207], a[228:231], a[152:155]
ds_read_b128 a[248:251], v10 offset:20480
ds_read_b128 a[252:255], v11 offset:20480
M a[152:155], a[200:203], a[224:227], a[152:155]
M a[156:159], a[208:211], a[224:227], a[156:159]
buffer_load_dword v23, s[8:11], s24 offen offset:256 lds
M a[156:159], a[212:215], a[228:231], a[156:159]
M a[160:163], a[220:223], a[228:231], a[160:163]
M a[160:163], a[216:219], a[224:227], a[160:163]
s_add_u32 m0, s29, 2048
s_nop 0
buffer_load_dwordx4 v2, s[8:11], s23 offen offset:0 lds
M a[164:167], a[200:203], a[232:235], a[164:167]
ds_read_b128 a[224:227], v10 offset:22528
ds_read_b128 a[228:231], v11 offset:22528
M a[164:167], a[204:207], a[236:239], a[164:167]
M a[168:171], a[212:215], a[236:239], a[168:171]
M a[168:171], a[208:211], a[232:235], a[168:171]
buffer_load_dwordx4 v3, s[8:11], s23 offen offset:1024 lds
M a[172:175], a[216:219], a[232:235], a[172:175]
M a[172:175], a[220:223], a[236:239], a[172:175]
s_waitcnt lgkmcnt(4)
M a[68:71], a[176:179], a[240:243], a[68:71]
ds_read_b128 a[232:235], v10 offset:24576
ds_read_b128 a[236:239], v11 offset:24576
M a[68:71], a[180:183], a[244:247], a[68:71]
buffer_load_dwordx4 v4, s[8:11], s23 offen offset:2048 lds
M a[72:75], a[188:191], a[244:247], a[72:75]
ds_read_b64_tr_b16 a[200:201], v14 offset:28672
ds_read_b64_tr_b16 a[202:203], v14 offset:30208
M a[72:75], a[184:187], a[240:243], a[72:75]
buffer_load_dwordx4 v5, s[8:11], s23 offen offset:3072 lds
M a[76:79], a[192:195], a[240:243], a[76:79]
M a[76:79], a[196:199], a[244:247], a[76:79]
s_sub_u32 s31, s31, 1
s_cmp_eq_u32 s31, 0
s_cselect_b32 s58, -1920, s57
s_add_u32 s23, s23, s58
s_add_u32 s24, s24, s58
s_waitcnt lgkmcnt(6)
M a[80:83], a[180:183], a[252:255], a[80:83]
ds_read_b128 a[240:243], v10 offset:26624
ds_read_b128 a[244:247], v11 offset:26624
M a[80:83], a[176:179], a[248:251], a[80:83]
M a[84:87], a[184:187], a[248:251], a[84:87]
ds_read_b64_tr_b16 a[208:209], v15 offset:28672
ds_read_b64_tr_b16 a[210:211], v15 offset:30208
M a[84:87], a[188:191], a[252:255], a[84:87]
s_add_u32 m0, s30, 36864
s_nop 0
buffer_load_dwordx4 v6, s[12:15], s25 offen offset:0 lds
M a[88:91], a[196:199], a[252:255], a[88:91]
M a[88:91], a[192:195], a[248:251], a[88:91]
buffer_load_dwordx4 v7, s[12:15], s25 offen offset:1024 lds
s_waitcnt lgkmcnt(8)
M a[92:95], a[176:179], a[224:227], a[92:95]
ds_read_b128 a[248:251], v10 offset:28672
ds_read_b128 a[252:255], v11 offset:28672
M a[92:95], a[180:183], a[228:231], a[92:95]
M a[96:99], a[188:191], a[228:231], a[96:99]
ds_read_b64_tr_b16 a[216:217], v16 offset:28672
ds_read_b64_tr_b16 a[218:219], v16 offset:30208
M a[96:99], a[184:187], a[224:227], a[96:99]
buffer_load_dwordx4 v8, s[12:15], s25 offen offset:2048 lds
M a[100:103], a[192:195], a[224:227], a[100:103]
M a[100:103], a[196:199], a[228:231], a[100:103]
buffer_load_dwordx4 v9, s[12:15], s25 offen offset:3072 lds
s_waitcnt lgkmcnt(10)
M a[104:107], a[180:183], a[236:239], a[104:107]
ds_read_b128 a[224:227], v10 offset:30720
ds_read_b128 a[228:231], v11 offset:30720
M a[104:107], a[176:179], a[232:235], a[104:107]
M a[108:111], a[184:187], a[232:235], a[108:111]
ds_read_b64_tr_b16 a[204:205], v14 offset:40960
ds_read_b64_tr_b16 a[206:207], v14 offset:42496
M a[108:111], a[188:191], a[236:239], a[108:111]
s_add_u32 m0, s30, 40960
s_nop 0
buffer_load_dwordx4 v21, s[12:15], s25 offen offset:0 lds
M a[112:115], a[196:199], a[236:239], a[112:115]
M a[112:115], a[192:195], a[232:235], a[112:115]
buffer_load_dwordx4 v22, s[12:15], s25 offen offset:1024 lds
s_waitcnt lgkmcnt(10)
M a[116:119], a[176:179], a[240:243], a[116:119]
ds_read_b128 a[232:235], v10 offset:32768
ds_read_b128 a[236:239], v11 offset:32768
M a[116:119], a[180:183], a[244:247], a[116:119]
M a[120:123], a[188:191], a[244:247], a[120:123]
ds_read_b64_tr_b16 a[212:213], v15 offset:40960
ds_read_b64_tr_b16 a[214:215], v15 offset:42496
M a[120:123], a[184:187], a[240:243], a[120:123]
s_sub_u32 s54, s54, 1
s_cmp_eq_u32 s54, 0
s_cselect_b32 s58, s55, s56
s_add_u32 s25, s25, s58
M a[124:127], a[192:195], a[240:243], a[124:127]
M a[124:127], a[196:199], a[244:247], a[124:127]
s_add_u32 s94, s93, 0
buffer_store_dwordx4 v[176:179], v1, s[16:19], s94 offen offset:2048 sc1
s_waitcnt lgkmcnt(10)
M a[128:131], a[180:183], a[252:255], a[128:131]
ds_read_b128 a[240:243], v10 offset:34816
ds_read_b128 a[244:247], v11 offset:34816
M a[128:131], a[176:179], a[248:251], a[128:131]
M a[132:135], a[184:187], a[248:251], a[132:135]
ds_read_b64_tr_b16 a[220:221], v16 offset:40960
ds_read_b64_tr_b16 a[222:223], v16 offset:42496
M a[132:135], a[188:191], a[252:255], a[132:135]
s_add_u32 s94, s93, 0
buffer_store_dwordx4 v[184:187], v1, s[16:19], s94 offen offset:3072 sc1
M a[136:139], a[196:199], a[252:255], a[136:139]
M a[136:139], a[192:195], a[248:251], a[136:139]
s_add_u32 s94, s93, 4096
buffer_store_dwordx4 v[192:195], v1, s[16:19], s94 offen offset:0 sc1
s_waitcnt lgkmcnt(10)
M a[140:143], a[176:179], a[224:227], a[140:143]
M a[140:143], a[180:183], a[228:231], a[140:143]
s_add_u32 s94, s93, 4096
buffer_store_dwordx4 v[200:203], v1, s[16:19], s94 offen offset:1024 sc1
M a[144:147], a[188:191], a[228:231], a[144:147]
M a[144:147], a[184:187], a[224:227], a[144:147]
M a[148:151], a[192:195], a[224:227], a[148:151]
s_waitcnt vmcnt(20) lgkmcnt(0)
s_barrier
ds_read_b128 a[248:251], v12 offset:0
ds_read_b128 a[252:255], v13 offset:0
M a[148:151], a[196:199], a[228:231], a[148:151]
s_add_u32 m0, s28, 18432
s_nop 0
buffer_load_dword v20, s[8:11], s24 offen lds
M a[152:155], a[180:183], a[236:239], a[152:155]
ds_read_b128 a[224:227], v12 offset:2048
ds_read_b128 a[228:231], v13 offset:2048
M a[152:155], a[176:179], a[232:235], a[152:155]
M a[156:159], a[184:187], a[232:235], a[156:159]
buffer_load_dword v23, s[8:11], s24 offen offset:256 lds
M a[156:159], a[188:191], a[236:239], a[156:159]
M a[160:163], a[196:199], a[236:239], a[160:163]
M a[160:163], a[192:195], a[232:235], a[160:163]
s_add_u32 m0, s29, 20480
s_nop 0
buffer_load_dwordx4 v2, s[8:11], s23 offen offset:0 lds
M a[164:167], a[176:179], a[240:243], a[164:167]
ds_read_b128 a[232:235], v12 offset:4096
ds_read_b128 a[236:239], v13 offset:4096
M a[164:167], a[180:183], a[244:247], a[164:167]
M a[168:171], a[188:191], a[244:247], a[168:171]
M a[168:171], a[184:187], a[240:243], a[168:171]
buffer_load_dwordx4 v3, s[8:11], s23 offen offset:1024 lds
M a[172:175], a[192:195], a[240:243], a[172:175]
M a[172:175], a[196:199], a[244:247], a[172:175]
s_waitcnt lgkmcnt(4)
M a[68:71], a[200:203], a[248:251], a[68:71]
ds_read_b128 a[240:243], v12 offset:6144
ds_read_b128 a[244:247], v13 offset:6144
M a[68:71], a[204:207], a[252:255], a[68:71]
buffer_load_dwordx4 v4, s[8:11], s23 offen offset:2048 lds
M a[72:75], a[212:215], a[252:255], a[72:75]
ds_read_b64_tr_b16 a[176:177], v17 offset:0
ds_read_b64_tr_b16 a[178:179], v17 offset:1536
M a[72:75], a[208:211], a[248:251], a[72:75]
buffer_load_dwordx4 v5, s[8:11], s23 offen offset:3072 lds
M a[76:79], a[216:219], a[248:251], a[76:79]
M a[76:79], a[220:223], a[252:255], a[76:79]
s_sub_u32 s31, s31, 1
s_cmp_eq_u32 s31, 0
s_cselect_b32 s58, -1920, s57
s_add_u32 s23, s23, s58
s_add_u32 s24, s24, s58
s_waitcnt lgkmcnt(6)
M a[80:83], a[204:207], a[228:231], a[80:83]
ds_read_b128 a[248:251], v12 offset:8192
ds_read_b128 a[252:255], v13 offset:8192
M a[80:83], a[200:203], a[224:227], a[80:83]
M a[84:87], a[208:211], a[224:227], a[84:87]
ds_read_b64_tr_b16 a[184:185], v18 offset:0
ds_read_b64_tr_b16 a[186:187], v18 offset:1536
M a[84:87], a[212:215], a[228:231], a[84:87]
s_add_u32 m0, s30, 65536
s_nop 0
buffer_load_dwordx4 v6, s[12:15], s25 offen offset:0 lds
M a[88:91], a[220:223], a[228:231], a[88:91]
M a[88:91], a[216:219], a[224:227], a[88:91]
buffer_load_dwordx4 v7, s[12:15], s25 offen offset:1024 lds
s_waitcnt lgkmcnt(8)
M a[92:95], a[200:203], a[232:235], a[92:95]
ds_read_b128 a[224:227], v12 offset:10240
ds_read_b128 a[228:231], v13 offset:10240
M a[92:95], a[204:207], a[236:239], a[92:95]
M a[96:99], a[212:215], a[236:239], a[96:99]
ds_read_b64_tr_b16 a[192:193], v19 offset:0
ds_read_b64_tr_b16 a[194:195], v19 offset:1536
M a[96:99], a[208:211], a[232:235], a[96:99]
buffer_load_dwordx4 v8, s[12:15], s25 offen offset:2048 lds
M a[100:103], a[216:219], a[232:235], a[100:103]
M a[100:103], a[220:223], a[236:239], a[100:103]
buffer_load_dwordx4 v9, s[12:15], s25 offen offset:3072 lds
s_waitcnt lgkmcnt(10)
M a[104:107], a[204:207], a[244:247], a[104:107]
ds_read_b128 a[232:235], v12 offset:12288
ds_read_b128 a[236:239], v13 offset:12288
M a[104:107], a[200:203], a[240:243], a[104:107]
M a[108:111], a[208:211], a[240:243], a[108:111]
ds_read_b64_tr_b16 a[180:181], v17 offset:12288
ds_read_b64_tr_b16 a[182:183], v17 offset:13824
M a[108:111], a[212:215], a[244:247], a[108:111]
s_add_u32 m0, s30, 69632
s_nop 0
buffer_load_dwordx4 v21, s[12:15], s25 offen offset:0 lds
M a[112:115], a[220:223], a[244:247], a[112:115]
M a[112:115], a[216:219], a[240:243], a[112:115]
buffer_load_dwordx4 v22, s[12:15], s25 offen offset:1024 lds
s_waitcnt lgkmcnt(10)
M a[116:119], a[200:203], a[248:251], a[116:119]
ds_read_b128 a[240:243], v12 offset:14336
ds_read_b128 a[244:247], v13 offset:14336
M a[116:119], a[204:207], a[252:255], a[116:119]
M a[120:123], a[212:215], a[252:255], a[120:123]
ds_read_b64_tr_b16 a[188:189], v18 offset:12288
ds_read_b64_tr_b16 a[190:191], v18 offset:13824
M a[120:123], a[208:211], a[248:251], a[120:123]
s_sub_u32 s54, s54, 1
s_cmp_eq_u32 s54, 0
s_cselect_b32 s58, s55, s56
s_add_u32 s25, s25, s58
M a[124:127], a[216:219], a[248:251], a[124:127]
M a[124:127], a[220:223], a[252:255], a[124:127]
s_add_u32 s94, s93, 4096
buffer_store_dwordx4 v[208:211], v1, s[16:19], s94 offen offset:2048 sc1
s_waitcnt lgkmcnt(10)
M a[128:131], a[204:207], a[228:231], a[128:131]
ds_read_b128 a[248:251], v12 offset:16384
ds_read_b128 a[252:255], v13 offset:16384
M a[128:131], a[200:203], a[224:227], a[128:131]
M a[132:135], a[208:211], a[224:227], a[132:135]
ds_read_b64_tr_b16 a[196:197], v19 offset:12288
ds_read_b64_tr_b16 a[198:199], v19 offset:13824
M a[132:135], a[212:215], a[228:231], a[132:135]
s_add_u32 s94, s93, 4096
buffer_store_dwordx4 v[216:219], v1, s[16:19], s94 offen offset:3072 sc1
M a[136:139], a[220:223], a[228:231], a[136:139]
M a[136:139], a[216:219], a[224:227], a[136:139]
s_add_u32 s94, s93, 8192
buffer_store_dwordx4 v[224:227], v1, s[16:19], s94 offen offset:0 sc1
s_waitcnt lgkmcnt(10)
M a[140:143], a[200:203], a[232:235], a[140:143]
M a[140:143], a[204:207], a[236:239], a[140:143]
s_add_u32 s94, s93, 8192
buffer_store_dwordx4 v[232:235], v1, s[16:19], s94 offen offset:1024 sc1
M a[144:147], a[212:215], a[236:239], a[144:147]
M a[144:147], a[208:211], a[232:235], a[144:147]
M a[148:151], a[216:219], a[232:235], a[148:151]
s_waitcnt vmcnt(20) lgkmcnt(0)
s_barrier
ds_read_b128 a[224:227], v10 offset:0
ds_read_b128 a[228:231], v11 offset:0
M a[148:151], a[220:223], a[236:239], a[148:151]
s_add_u32 m0, s28, 131072
s_nop 0
buffer_load_dword v20, s[8:11], s24 offen lds
M a[152:155], a[204:207], a[244:247], a[152:155]
ds_read_b128 a[232:235], v10 offset:2048
ds_read_b128 a[236:239], v11 offset:2048
M a[152:155], a[200:203], a[240:243], a[152:155]
M a[156:159], a[208:211], a[240:243], a[156:159]
buffer_load_dword v23, s[8:11], s24 offen offset:256 lds
M a[156:159], a[212:215], a[244:247], a[156:159]
M a[160:163], a[220:223], a[244:247], a[160:163]
M a[160:163], a[216:219], a[240:243], a[160:163]
s_add_u32 m0, s29, 133120
s_nop 0
buffer_load_dwordx4 v2, s[8:11], s23 offen offset:0 lds
M a[164:167], a[200:203], a[248:251], a[164:167]
ds_read_b128 a[240:243], v10 offset:4096
ds_read_b128 a[244:247], v11 offset:4096
M a[164:167], a[204:207], a[252:255], a[164:167]
M a[168:171], a[212:215], a[252:255], a[168:171]
M a[168:171], a[208:211], a[248:251], a[168:171]
buffer_load_dwordx4 v3, s[8:11], s23 offen offset:1024 lds
M a[172:175], a[216:219], a[248:251], a[172:175]
M a[172:175], a[220:223], a[252:255], a[172:175]
s_waitcnt lgkmcnt(4)
M a[68:71], a[176:179], a[224:227], a[68:71]
ds_read_b128 a[248:251], v10 offset:6144
ds_read_b128 a[252:255], v11 offset:6144
M a[68:71], a[180:183], a[228:231], a[68:71]
buffer_load_dwordx4 v4, s[8:11], s23 offen offset:2048 lds
M a[72:75], a[188:191], a[228:231], a[72:75]
ds_read_b64_tr_b16 a[200:201], v14 offset:0
ds_read_b64_tr_b16 a[202:203], v14 offset:1536
M a[72:75], a[184:187], a[224:227], a[72:75]
buffer_load_dwordx4 v5, s[8:11], s23 offen offset:3072 lds
M a[76:79], a[192:195], a[224:227], a[76:79]
M a[76:79], a[196:199], a[228:231], a[76:79]
s_sub_u32 s31, s31, 1
s_cmp_eq_u32 s31, 0
s_cselect_b32 s58, -1920, s57
s_add_u32 s23, s23, s58
s_add_u32 s24, s24, s58
s_waitcnt lgkmcnt(6)
M a[80:83], a[180:183], a[236:239], a[80:83]
ds_read_b128 a[224:227], v10 offset:8192
ds_read_b128 a[228:231], v11 offset:8192
M a[80:83], a[176:179], a[232:235], a[80:83]
M a[84:87], a[184:187], a[232:235], a[84:87]
ds_read_b64_tr_b16 a[208:209], v15 offset:0
ds_read_b64_tr_b16 a[210:211], v15 offset:1536
M a[84:87], a[188:191], a[236:239], a[84:87]
s_add_u32 m0, s30, 98304
s_nop 0
buffer_load_dwordx4 v6, s[12:15], s25 offen offset:0 lds
M a[88:91], a[196:199], a[236:239], a[88:91]
M a[88:91], a[192:195], a[232:235], a[88:91]
buffer_load_dwordx4 v7, s[12:15], s25 offen offset:1024 lds
s_waitcnt lgkmcnt(8)
M a[92:95], a[176:179], a[240:243], a[92:95]
ds_read_b128 a[232:235], v10 offset:10240
ds_read_b128 a[236:239], v11 offset:10240
M a[92:95], a[180:183], a[244:247], a[92:95]
M a[96:99], a[188:191], a[244:247], a[96:99]
ds_read_b64_tr_b16 a[216:217], v16 offset:0
ds_read_b64_tr_b16 a[218:219], v16 offset:1536
M a[96:99], a[184:187], a[240:243], a[96:99]
buffer_load_dwordx4 v8, s[12:15], s25 offen offset:2048 lds
M a[100:103], a[192:195], a[240:243], a[100:103]
M a[100:103], a[196:199], a[244:247], a[100:103]
buffer_load_dwordx4 v9, s[12:15], s25 offen offset:3072 lds
s_waitcnt lgkmcnt(10)
M a[104:107], a[180:183], a[252:255], a[104:107]
ds_read_b128 a[240:243], v10 offset:12288
ds_read_b128 a[244:247], v11 offset:12288
M a[104:107], a[176:179], a[248:251], a[104:107]
M a[108:111], a[184:187], a[248:251], a[108:111]
ds_read_b64_tr_b16 a[204:205], v14 offset:12288
ds_read_b64_tr_b16 a[206:207], v14 offset:13824
M a[108:111], a[188:191], a[252:255], a[108:111]
s_add_u32 m0, s30, 102400
s_nop 0
buffer_load_dwordx4 v21, s[12:15], s25 offen offset:0 lds
M a[112:115], a[196:199], a[252:255], a[112:115]
M a[112:115], a[192:195], a[248:251], a[112:115]
buffer_load_dwordx4 v22, s[12:15], s25 offen offset:1024 lds
s_waitcnt lgkmcnt(10)
M a[116:119], a[176:179], a[224:227], a[116:119]
ds_read_b128 a[248:251], v10 offset:14336
ds_read_b128 a[252:255], v11 offset:14336
M a[116:119], a[180:183], a[228:231], a[116:119]
M a[120:123], a[188:191], a[228:231], a[120:123]
ds_read_b64_tr_b16 a[212:213], v15 offset:12288
ds_read_b64_tr_b16 a[214:215], v15 offset:13824
M a[120:123], a[184:187], a[224:227], a[120:123]
s_sub_u32 s54, s54, 1
s_cmp_eq_u32 s54, 0
s_cselect_b32 s58, s55, s56
s_add_u32 s25, s25, s58
M a[124:127], a[192:195], a[224:227], a[124:127]
M a[124:127], a[196:199], a[228:231], a[124:127]
s_add_u32 s94, s93, 8192
buffer_store_dwordx4 v[240:243], v1, s[16:19], s94 offen offset:2048 sc1
s_waitcnt lgkmcnt(10)
M a[128:131], a[180:183], a[236:239], a[128:131]
ds_read_b128 a[224:227], v10 offset:16384
ds_read_b128 a[228:231], v11 offset:16384
M a[128:131], a[176:179], a[232:235], a[128:131]
M a[132:135], a[184:187], a[232:235], a[132:135]
ds_read_b64_tr_b16 a[220:221], v16 offset:12288
ds_read_b64_tr_b16 a[222:223], v16 offset:13824
M a[132:135], a[188:191], a[236:239], a[132:135]
s_add_u32 s94, s93, 8192
buffer_store_dwordx4 v[248:251], v1, s[16:19], s94 offen offset:3072 sc1
M a[136:139], a[196:199], a[236:239], a[136:139]
M a[136:139], a[192:195], a[232:235], a[136:139]
s_add_u32 s94, s93, 12288
buffer_store_dwordx4 v[36:39], v1, s[16:19], s94 offen offset:0 sc1
s_waitcnt lgkmcnt(10)
M a[140:143], a[176:179], a[240:243], a[140:143]
M a[140:143], a[180:183], a[244:247], a[140:143]
s_add_u32 s94, s93, 12288
buffer_store_dwordx4 v[44:47], v1, s[16:19], s94 offen offset:1024 sc1
M a[144:147], a[188:191], a[244:247], a[144:147]
M a[144:147], a[184:187], a[240:243], a[144:147]
M a[148:151], a[192:195], a[240:243], a[148:151]
s_waitcnt vmcnt(20) lgkmcnt(0)
s_barrier
ds_read_b128 a[232:235], v10 offset:18432
ds_read_b128 a[236:239], v11 offset:18432
M a[148:151], a[196:199], a[244:247], a[148:151]
s_add_u32 m0, s28, 0
s_nop 0
buffer_load_dword v20, s[8:11], s24 offen lds
M a[152:155], a[180:183], a[252:255], a[152:155]
ds_read_b128 a[240:243], v10 offset:20480
ds_read_b128 a[244:247], v11 offset:20480
M a[152:155], a[176:179], a[248:251], a[152:155]
M a[156:159], a[184:187], a[248:251], a[156:159]
buffer_load_dword v23, s[8:11], s24 offen offset:256 lds
M a[156:159], a[188:191], a[252:255], a[156:159]
M a[160:163], a[196:199], a[252:255], a[160:163]
M a[160:163], a[192:195], a[248:251], a[160:163]
s_add_u32 m0, s29, 2048
s_nop 0
buffer_load_dwordx4 v2, s[8:11], s23 offen offset:0 lds
M a[164:167], a[176:179], a[224:227], a[164:167]
ds_read_b128 a[248:251], v10 offset:22528
ds_read_b128 a[252:255], v11 offset:22528
M a[164:167], a[180:183], a[228:231], a[164:167]
M a[168:171], a[188:191], a[228:231], a[168:171]
M a[168:171], a[184:187], a[224:227], a[168:171]
buffer_load_dwordx4 v3, s[8:11], s23 offen offset:1024 lds
M a[172:175], a[192:195], a[224:227], a[172:175]
M a[172:175], a[196:199], a[228:231], a[172:175]
s_waitcnt lgkmcnt(4)
M a[68:71], a[200:203], a[232:235], a[68:71]
ds_read_b128 a[224:227], v10 offset:24576
ds_read_b128 a[228:231], v11 offset:24576
M a[68:71], a[204:207], a[236:239], a[68:71]
buffer_load_dwordx4 v4, s[8:11], s23 offen offset:2048 lds
M a[72:75], a[212:215], a[236:239], a[72:75]
ds_read_b64_tr_b16 a[176:177], v14 offset:28672
ds_read_b64_tr_b16 a[178:179], v14 offset:30208
M a[72:75], a[208:211], a[232:235], a[72:75]
M a[76:79], a[216:219], a[232:235], a[76:79]
buffer_load_dwordx4 v5, s[8:11], s23 offen offset:3072 lds
M a[76:79], a[220:223], a[236:239], a[76:79]
s_waitcnt lgkmcnt(6)
M a[80:83], a[204:207], a[244:247], a[80:83]
ds_read_b128 a[232:235], v10 offset:26624
ds_read_b128 a[236:239], v11 offset:26624
M a[80:83], a[200:203], a[240:243], a[80:83]
s_sub_u32 s31, s31, 1
s_cmp_eq_u32 s31, 0
s_cselect_b32 s58, -1920, s57
s_add_u32 s23, s23, s58
s_add_u32 s24, s24, s58
M a[84:87], a[208:211], a[240:243], a[84:87]
ds_read_b64_tr_b16 a[184:185], v15 offset:28672
ds_read_b64_tr_b16 a[186:187], v15 offset:30208
M a[84:87], a[212:215], a[244:247], a[84:87]
M a[88:91], a[220:223], a[244:247], a[88:91]
s_add_u32 m0, s30, 36864
s_nop 0
buffer_load_dwordx4 v6, s[12:15], s25 offen offset:0 lds
M a[88:91], a[216:219], a[240:243], a[88:91]
s_waitcnt lgkmcnt(8)
M a[92:95], a[200:203], a[248:251], a[92:95]
ds_read_b128 a[240:243], v10 offset:28672
ds_read_b128 a[244:247], v11 offset:28672
M a[92:95], a[204:207], a[252:255], a[92:95]
M a[96:99], a[212:215], a[252:255], a[96:99]
ds_read_b64_tr_b16 a[192:193], v16 offset:28672
ds_read_b64_tr_b16 a[194:195], v16 offset:30208
M a[96:99], a[208:211], a[248:251], a[96:99]
buffer_load_dwordx4 v7, s[12:15], s25 offen offset:1024 lds
M a[100:103], a[216:219], a[248:251], a[100:103]
M a[100:103], a[220:223], a[252:255], a[100:103]
buffer_load_dwordx4 v8, s[12:15], s25 offen offset:2048 lds
s_waitcnt lgkmcnt(10)
M a[104:107], a[204:207], a[228:231], a[104:107]
ds_read_b128 a[248:251], v10 offset:30720
ds_read_b128 a[252:255], v11 offset:30720
M a[104:107], a[200:203], a[224:227], a[104:107]
M a[108:111], a[208:211], a[224:227], a[108:111]
ds_read_b64_tr_b16 a[180:181], v14 offset:40960
ds_read_b64_tr_b16 a[182:183], v14 offset:42496
M a[108:111], a[212:215], a[228:231], a[108:111]
buffer_load_dwordx4 v9, s[12:15], s25 offen offset:3072 lds
M a[112:115], a[220:223], a[228:231], a[112:115]
M a[112:115], a[216:219], a[224:227], a[112:115]
s_add_u32 m0, s30, 40960
s_nop 0
buffer_load_dwordx4 v21, s[12:15], s25 offen offset:0 lds
s_waitcnt lgkmcnt(10)
M a[116:119], a[200:203], a[232:235], a[116:119]
ds_read_b128 a[224:227], v10 offset:32768
ds_read_b128 a[228:231], v11 offset:32768
M a[116:119], a[204:207], a[236:239], a[116:119]
M a[120:123], a[212:215], a[236:239], a[120:123]
ds_read_b64_tr_b16 a[188:189], v15 offset:40960
ds_read_b64_tr_b16 a[190:191], v15 offset:42496
M a[120:123], a[208:211], a[232:235], a[120:123]
M a[124:127], a[216:219], a[232:235], a[124:127]
buffer_load_dwordx4 v22, s[12:15], s25 offen offset:1024 lds
M a[124:127], a[220:223], a[236:239], a[124:127]
s_waitcnt lgkmcnt(10)
M a[128:131], a[204:207], a[244:247], a[128:131]
ds_read_b128 a[232:235], v10 offset:34816
ds_read_b128 a[236:239], v11 offset:34816
M a[128:131], a[200:203], a[240:243], a[128:131]
s_sub_u32 s54, s54, 1
s_cmp_eq_u32 s54, 0
s_cselect_b32 s58, s55, s56
s_add_u32 s25, s25, s58
M a[132:135], a[208:211], a[240:243], a[132:135]
ds_read_b64_tr_b16 a[196:197], v16 offset:40960
ds_read_b64_tr_b16 a[198:199], v16 offset:42496
M a[132:135], a[212:215], a[244:247], a[132:135]
M a[136:139], a[220:223], a[244:247], a[136:139]
s_add_u32 s94, s93, 12288
buffer_store_dwordx4 v[52:55], v1, s[16:19], s94 offen offset:2048 sc1
M a[136:139], a[216:219], a[240:243], a[136:139]
s_waitcnt lgkmcnt(10)
M a[140:143], a[200:203], a[248:251], a[140:143]
s_add_u32 s94, s93, 12288
buffer_store_dwordx4 v[60:63], v1, s[16:19], s94 offen offset:3072 sc1
M a[140:143], a[204:207], a[252:255], a[140:143]
M a[144:147], a[212:215], a[252:255], a[144:147]
M a[144:147], a[208:211], a[248:251], a[144:147]
M a[148:151], a[216:219], a[248:251], a[148:151]
s_waitcnt vmcnt(18) lgkmcnt(0)
s_barrier
ds_read_b128 a[240:243], v12 offset:0
ds_read_b128 a[244:247], v13 offset:0
M a[148:151], a[220:223], a[252:255], a[148:151]
s_add_u32 m0, s28, 18432
s_nop 0
buffer_load_dword v20, s[8:11], s24 offen lds
M a[152:155], a[204:207], a[228:231], a[152:155]
ds_read_b128 a[248:251], v12 offset:2048
ds_read_b128 a[252:255], v13 offset:2048
M a[152:155], a[200:203], a[224:227], a[152:155]
M a[156:159], a[208:211], a[224:227], a[156:159]
buffer_load_dword v23, s[8:11], s24 offen offset:256 lds
M a[156:159], a[212:215], a[228:231], a[156:159]
M a[160:163], a[220:223], a[228:231], a[160:163]
M a[160:163], a[216:219], a[224:227], a[160:163]
s_add_u32 m0, s29, 20480
s_nop 0
buffer_load_dwordx4 v2, s[8:11], s23 offen offset:0 lds
M a[164:167], a[200:203], a[232:235], a[164:167]
ds_read_b128 a[224:227], v12 offset:4096
ds_read_b128 a[228:231], v13 offset:4096
M a[164:167], a[204:207], a[236:239], a[164:167]
M a[168:171], a[212:215], a[236:239], a[168:171]
M a[168:171], a[208:211], a[232:235], a[168:171]
buffer_load_dwordx4 v3, s[8:11], s23 offen offset:1024 lds
M a[172:175], a[216:219], a[232:235], a[172:175]
M a[172:175], a[220:223], a[236:239], a[172:175]
s_waitcnt lgkmcnt(4)
M a[68:71], a[176:179], a[240:243], a[68:71]
ds_read_b128 a[232:235], v12 offset:6144
ds_read_b128 a[236:239], v13 offset:6144
M a[68:71], a[180:183], a[244:247], a[68:71]
buffer_load_dwordx4 v4, s[8:11], s23 offen offset:2048 lds
M a[72:75], a[188:191], a[244:247], a[72:75]
ds_read_b64_tr_b16 a[200:201], v17 offset:0
ds_read_b64_tr_b16 a[202:203], v17 offset:1536
M a[72:75], a[184:187], a[240:243], a[72:75]
M a[76:79], a[192:195], a[240:243], a[76:79]
buffer_load_dwordx4 v5, s[8:11], s23 offen offset:3072 lds
M a[76:79], a[196:199], a[244:247], a[76:79]
s_waitcnt lgkmcnt(6)
M a[80:83], a[180:183], a[252:255], a[80:83]
ds_read_b128 a[240:243], v12 offset:8192
ds_read_b128 a[244:247], v13 offset:8192
M a[80:83], a[176:179], a[248:251], a[80:83]
M a[84:87], a[184:187], a[248:251], a[84:87]
ds_read_b64_tr_b16 a[208:209], v18 offset:0
ds_read_b64_tr_b16 a[210:211], v18 offset:1536
M a[84:87], a[188:191], a[252:255], a[84:87]
s_sub_u32 s31, s31, 1
s_cmp_eq_u32 s31, 0
s_cselect_b32 s58, -1920, s57
s_add_u32 s23, s23, s58
s_add_u32 s24, s24, s58
M a[88:91], a[196:199], a[252:255], a[88:91]
M a[88:91], a[192:195], a[248:251], a[88:91]
s_waitcnt lgkmcnt(8)
M a[92:95], a[176:179], a[224:227], a[92:95]
ds_read_b128 a[248:251], v12 offset:10240
ds_read_b128 a[252:255], v13 offset:10240
M a[92:95], a[180:183], a[228:231], a[92:95]
s_add_u32 m0, s30, 65536
s_nop 0
buffer_load_dwordx4 v6, s[12:15], s25 offen offset:0 lds
M a[96:99], a[188:191], a[228:231], a[96:99]
ds_read_b64_tr_b16 a[216:217], v19 offset:0
ds_read_b64_tr_b16 a[218:219], v19 offset:1536
M a[96:99], a[184:187], a[224:227], a[96:99]
M a[100:103], a[192:195], a[224:227], a[100:103]
buffer_load_dwordx4 v7, s[12:15], s25 offen offset:1024 lds
M a[100:103], a[196:199], a[228:231], a[100:103]
s_waitcnt lgkmcnt(10)
M a[104:107], a[180:183], a[236:239], a[104:107]
ds_read_b128 a[224:227], v12 offset:12288
ds_read_b128 a[228:231], v13 offset:12288
M a[104:107], a[176:179], a[232:235], a[104:107]
M a[108:111], a[184:187], a[232:235], a[108:111]
ds_read_b64_tr_b16 a[204:205], v17 offset:12288
ds_read_b64_tr_b16 a[206:207], v17 offset:13824
M a[108:111], a[188:191], a[236:239], a[108:111]
buffer_load_dwordx4 v8, s[12:15], s25 offen offset:2048 lds
M a[112:115], a[196:199], a[236:239], a[112:115]
M a[112:115], a[192:195], a[232:235], a[112:115]
s_waitcnt lgkmcnt(10)
M a[116:119], a[176:179], a[240:243], a[116:119]
ds_read_b128 a[232:235], v12 offset:14336
ds_read_b128 a[236:239], v13 offset:14336
M a[116:119], a[180:183], a[244:247], a[116:119]
buffer_load_dwordx4 v9, s[12:15], s25 offen offset:3072 lds
M a[120:123], a[188:191], a[244:247], a[120:123]
ds_read_b64_tr_b16 a[212:213], v18 offset:12288
ds_read_b64_tr_b16 a[214:215], v18 offset:13824
M a[120:123], a[184:187], a[240:243], a[120:123]
M a[124:127], a[192:195], a[240:243], a[124:127]
s_add_u32 m0, s30, 69632
s_nop 0
buffer_load_dwordx4 v21, s[12:15], s25 offen offset:0 lds
M a[124:127], a[196:199], a[244:247], a[124:127]
s_waitcnt lgkmcnt(10)
M a[128:131], a[180:183], a[252:255], a[128:131]
ds_read_b128 a[240:243], v12 offset:16384
ds_read_b128 a[244:247], v13 offset:16384
M a[128:131], a[176:179], a[248:251], a[128:131]
M a[132:135], a[184:187], a[248:251], a[132:135]
ds_read_b64_tr_b16 a[220:221], v19 offset:12288
ds_read_b64_tr_b16 a[222:223], v19 offset:13824
M a[132:135], a[188:191], a[252:255], a[132:135]
buffer_load_dwordx4 v22, s[12:15], s25 offen offset:1024 lds
M a[136:139], a[196:199], a[252:255], a[136:139]
M a[136:139], a[192:195], a[248:251], a[136:139]
s_waitcnt lgkmcnt(10)
M a[140:143], a[176:179], a[224:227], a[140:143]
s_sub_u32 s54, s54, 1
s_cmp_eq_u32 s54, 0
s_cselect_b32 s58, s55, s56
s_add_u32 s25, s25, s58
M a[140:143], a[180:183], a[228:231], a[140:143]
M a[144:147], a[188:191], a[228:231], a[144:147]
M a[144:147], a[184:187], a[224:227], a[144:147]
M a[148:151], a[192:195], a[224:227], a[148:151]
s_waitcnt vmcnt(12) lgkmcnt(0)
s_barrier
ds_read_b128 a[248:251], v10 offset:0
ds_read_b128 a[252:255], v11 offset:0
s_cmp_lg_u32 s101, 0
s_cbranch_scc1 Lk1_arr
v_mov_b32 v127, 1
s_and_b32 s41, s2, 128
s_mov_b64 exec, 1
buffer_atomic_add v127, off, s[36:39], s41 sc1
s_mov_b64 exec, -1
Lk1_arr:
M a[148:151], a[196:199], a[228:231], a[148:151]
s_add_u32 m0, s28, 131072
s_nop 0
buffer_load_dword v20, s[8:11], s24 offen lds
M a[152:155], a[180:183], a[236:239], a[152:155]
ds_read_b128 a[224:227], v10 offset:2048
ds_read_b128 a[228:231], v11 offset:2048
M a[152:155], a[176:179], a[232:235], a[152:155]
M a[156:159], a[184:187], a[232:235], a[156:159]
buffer_load_dword v23, s[8:11], s24 offen offset:256 lds
M a[156:159], a[188:191], a[236:239], a[156:159]
M a[160:163], a[196:199], a[236:239], a[160:163]
M a[160:163], a[192:195], a[232:235], a[160:163]
s_add_u32 m0, s29, 133120
s_nop 0
buffer_load_dwordx4 v2, s[8:11], s23 offen offset:0 lds
M a[164:167], a[176:179], a[240:243], a[164:167]
ds_read_b128 a[232:235], v10 offset:4096
ds_read_b128 a[236:239], v11 offset:4096
M a[164:167], a[180:183], a[244:247], a[164:167]
M a[168:171], a[188:191], a[244:247], a[168:171]
M a[168:171], a[184:187], a[240:243], a[168:171]
buffer_load_dwordx4 v3, s[8:11], s23 offen offset:1024 lds
M a[172:175], a[192:195], a[240:243], a[172:175]
M a[172:175], a[196:199], a[244:247], a[172:175]
s_waitcnt lgkmcnt(4)
M a[68:71], a[200:203], a[248:251], a[68:71]
ds_read_b128 a[240:243], v10 offset:6144
ds_read_b128 a[244:247], v11 offset:6144
M a[68:71], a[204:207], a[252:255], a[68:71]
buffer_load_dwordx4 v4, s[8:11], s23 offen offset:2048 lds
M a[72:75], a[212:215], a[252:255], a[72:75]
ds_read_b64_tr_b16 a[176:177], v14 offset:0
ds_read_b64_tr_b16 a[178:179], v14 offset:1536
M a[72:75], a[208:211], a[248:251], a[72:75]
M a[76:79], a[216:219], a[248:251], a[76:79]
buffer_load_dwordx4 v5, s[8:11], s23 offen offset:3072 lds
M a[76:79], a[220:223], a[252:255], a[76:79]
s_waitcnt lgkmcnt(6)
M a[80:83], a[204:207], a[228:231], a[80:83]
ds_read_b128 a[248:251], v10 offset:8192
ds_read_b128 a[252:255], v11 offset:8192
M a[80:83], a[200:203], a[224:227], a[80:83]
M a[84:87], a[208:211], a[224:227], a[84:87]
ds_read_b64_tr_b16 a[184:185], v15 offset:0
ds_read_b64_tr_b16 a[186:187], v15 offset:1536
M a[84:87], a[212:215], a[228:231], a[84:87]
s_sub_u32 s31, s31, 1
s_cmp_eq_u32 s31, 0
s_cselect_b32 s58, -1920, s57
s_add_u32 s23, s23, s58
s_add_u32 s24, s24, s58
M a[88:91], a[220:223], a[228:231], a[88:91]
M a[88:91], a[216:219], a[224:227], a[88:91]
s_waitcnt lgkmcnt(8)
M a[92:95], a[200:203], a[232:235], a[92:95]
ds_read_b128 a[224:227], v10 offset:10240
ds_read_b128 a[228:231], v11 offset:10240
M a[92:95], a[204:207], a[236:239], a[92:95]
s_add_u32 m0, s30, 98304
s_nop 0
buffer_load_dwordx4 v6, s[12:15], s25 offen offset:0 lds
M a[96:99], a[212:215], a[236:239], a[96:99]
ds_read_b64_tr_b16 a[192:193], v16 offset:0
ds_read_b64_tr_b16 a[194:195], v16 offset:1536
M a[96:99], a[208:211], a[232:235], a[96:99]
M a[100:103], a[216:219], a[232:235], a[100:103]
buffer_load_dwordx4 v7, s[12:15], s25 offen offset:1024 lds
M a[100:103], a[220:223], a[236:239], a[100:103]
s_waitcnt lgkmcnt(10)
M a[104:107], a[204:207], a[244:247], a[104:107]
ds_read_b128 a[232:235], v10 offset:12288
ds_read_b128 a[236:239], v11 offset:12288
M a[104:107], a[200:203], a[240:243], a[104:107]
M a[108:111], a[208:211], a[240:243], a[108:111]
ds_read_b64_tr_b16 a[180:181], v14 offset:12288
ds_read_b64_tr_b16 a[182:183], v14 offset:13824
M a[108:111], a[212:215], a[244:247], a[108:111]
buffer_load_dwordx4 v8, s[12:15], s25 offen offset:2048 lds
M a[112:115], a[220:223], a[244:247], a[112:115]
M a[112:115], a[216:219], a[240:243], a[112:115]
s_waitcnt lgkmcnt(10)
M a[116:119], a[200:203], a[248:251], a[116:119]
ds_read_b128 a[240:243], v10 offset:14336
ds_read_b128 a[244:247], v11 offset:14336
M a[116:119], a[204:207], a[252:255], a[116:119]
buffer_load_dwordx4 v9, s[12:15], s25 offen offset:3072 lds
M a[120:123], a[212:215], a[252:255], a[120:123]
ds_read_b64_tr_b16 a[188:189], v15 offset:12288
ds_read_b64_tr_b16 a[190:191], v15 offset:13824
M a[120:123], a[208:211], a[248:251], a[120:123]
M a[124:127], a[216:219], a[248:251], a[124:127]
s_add_u32 m0, s30, 102400
s_nop 0
buffer_load_dwordx4 v21, s[12:15], s25 offen offset:0 lds
M a[124:127], a[220:223], a[252:255], a[124:127]
s_waitcnt lgkmcnt(10)
M a[128:131], a[204:207], a[228:231], a[128:131]
ds_read_b128 a[248:251], v10 offset:16384
ds_read_b128 a[252:255], v11 offset:16384
M a[128:131], a[200:203], a[224:227], a[128:131]
M a[132:135], a[208:211], a[224:227], a[132:135]
ds_read_b64_tr_b16 a[196:197], v16 offset:12288
ds_read_b64_tr_b16 a[198:199], v16 offset:13824
M a[132:135], a[212:215], a[228:231], a[132:135]
buffer_load_dwordx4 v22, s[12:15], s25 offen offset:1024 lds
M a[136:139], a[220:223], a[228:231], a[136:139]
M a[136:139], a[216:219], a[224:227], a[136:139]
s_waitcnt lgkmcnt(10)
M a[140:143], a[200:203], a[232:235], a[140:143]
s_sub_u32 s54, s54, 1
s_cmp_eq_u32 s54, 0
s_cselect_b32 s58, s55, s56
s_add_u32 s25, s25, s58
M a[140:143], a[204:207], a[236:239], a[140:143]
M a[144:147], a[212:215], a[236:239], a[144:147]
M a[144:147], a[208:211], a[232:235], a[144:147]
M a[148:151], a[216:219], a[232:235], a[148:151]
s_waitcnt vmcnt(12) lgkmcnt(0)
s_barrier
ds_read_b128 a[224:227], v10 offset:18432
ds_read_b128 a[228:231], v11 offset:18432
M a[148:151], a[220:223], a[236:239], a[148:151]
s_add_u32 m0, s28, 0
s_nop 0
buffer_load_dword v20, s[8:11], s24 offen lds
M a[152:155], a[204:207], a[244:247], a[152:155]
ds_read_b128 a[232:235], v10 offset:20480
ds_read_b128 a[236:239], v11 offset:20480
M a[152:155], a[200:203], a[240:243], a[152:155]
M a[156:159], a[208:211], a[240:243], a[156:159]
buffer_load_dword v23, s[8:11], s24 offen offset:256 lds
M a[156:159], a[212:215], a[244:247], a[156:159]
M a[160:163], a[220:223], a[244:247], a[160:163]
M a[160:163], a[216:219], a[240:243], a[160:163]
s_add_u32 m0, s29, 2048
s_nop 0
buffer_load_dwordx4 v2, s[8:11], s23 offen offset:0 lds
M a[164:167], a[200:203], a[248:251], a[164:167]
ds_read_b128 a[240:243], v10 offset:22528
ds_read_b128 a[244:247], v11 offset:22528
M a[164:167], a[204:207], a[252:255], a[164:167]
M a[168:171], a[212:215], a[252:255], a[168:171]
M a[168:171], a[208:211], a[248:251], a[168:171]
buffer_load_dwordx4 v3, s[8:11], s23 offen offset:1024 lds
M a[172:175], a[216:219], a[248:251], a[172:175]
M a[172:175], a[220:223], a[252:255], a[172:175]
s_waitcnt lgkmcnt(4)
M a[68:71], a[176:179], a[224:227], a[68:71]
ds_read_b128 a[248:251], v10 offset:24576
ds_read_b128 a[252:255], v11 offset:24576
v_mov_b32 v160, 0
v_mov_b32 v161, 0
M a[68:71], a[180:183], a[228:231], a[68:71]
buffer_load_dwordx4 v4, s[8:11], s23 offen offset:2048 lds
M a[72:75], a[188:191], a[228:231], a[72:75]
ds_read_b64_tr_b16 a[200:201], v14 offset:28672
ds_read_b64_tr_b16 a[202:203], v14 offset:30208
v_mov_b32 v162, 0
v_mov_b32 v163, 0
M a[72:75], a[184:187], a[224:227], a[72:75]
M a[76:79], a[192:195], a[224:227], a[76:79]
buffer_load_dwordx4 v5, s[8:11], s23 offen offset:3072 lds
v_mov_b32 v164, 0
v_mov_b32 v165, 0
M a[76:79], a[196:199], a[228:231], a[76:79]
s_waitcnt lgkmcnt(6)
M a[80:83], a[180:183], a[236:239], a[80:83]
ds_read_b128 a[224:227], v10 offset:26624
ds_read_b128 a[228:231], v11 offset:26624
v_mov_b32 v166, 0
v_mov_b32 v167, 0
M a[80:83], a[176:179], a[232:235], a[80:83]
M a[84:87], a[184:187], a[232:235], a[84:87]
ds_read_b64_tr_b16 a[208:209], v15 offset:28672
ds_read_b64_tr_b16 a[210:211], v15 offset:30208
M a[84:87], a[188:191], a[236:239], a[84:87]
s_sub_u32 s31, s31, 1
s_cmp_eq_u32 s31, 0
s_cselect_b32 s58, -1920, s57
s_add_u32 s23, s23, s58
s_add_u32 s24, s24, s58
v_mov_b32 v168, 0
v_mov_b32 v169, 0
M a[88:91], a[196:199], a[236:239], a[88:91]
M a[88:91], a[192:195], a[232:235], a[88:91]
s_waitcnt lgkmcnt(8)
v_mov_b32 v170, 0
v_mov_b32 v171, 0
M a[92:95], a[176:179], a[240:243], a[92:95]
ds_read_b128 a[232:235], v10 offset:28672
ds_read_b128 a[236:239], v11 offset:28672
M a[92:95], a[180:183], a[244:247], a[92:95]
s_add_u32 m0, s30, 36864
s_nop 0
buffer_load_dwordx4 v6, s[12:15], s25 offen offset:0 lds
v_mov_b32 v172, 0
v_mov_b32 v173, 0
M a[96:99], a[188:191], a[244:247], a[96:99]
ds_read_b64_tr_b16 a[216:217], v16 offset:28672
ds_read_b64_tr_b16 a[218:219], v16 offset:30208
M a[96:99], a[184:187], a[240:243], a[96:99]
v_mov_b32 v174, 0
v_mov_b32 v175, 0
M a[100:103], a[192:195], a[240:243], a[100:103]
buffer_load_dwordx4 v7, s[12:15], s25 offen offset:1024 lds
M a[100:103], a[196:199], a[244:247], a[100:103]
s_waitcnt lgkmcnt(10)
M a[104:107], a[180:183], a[252:255], a[104:107]
ds_read_b128 a[240:243], v10 offset:30720
ds_read_b128 a[244:247], v11 offset:30720
v_mov_b32 v176, 0
v_mov_b32 v177, 0
M a[104:107], a[176:179], a[248:251], a[104:107]
M a[108:111], a[184:187], a[248:251], a[108:111]
ds_read_b64_tr_b16 a[204:205], v14 offset:40960
ds_read_b64_tr_b16 a[206:207], v14 offset:42496
v_mov_b32 v178, 0
v_mov_b32 v179, 0
M a[108:111], a[188:191], a[252:255], a[108:111]
buffer_load_dwordx4 v8, s[12:15], s25 offen offset:2048 lds
M a[112:115], a[196:199], a[252:255], a[112:115]
v_mov_b32 v180, 0
v_mov_b32 v181, 0
M a[112:115], a[192:195], a[248:251], a[112:115]
s_waitcnt lgkmcnt(10)
M a[116:119], a[176:179], a[224:227], a[116:119]
ds_read_b128 a[248:251], v10 offset:32768
ds_read_b128 a[252:255], v11 offset:32768
v_mov_b32 v182, 0
v_mov_b32 v183, 0
M a[116:119], a[180:183], a[228:231], a[116:119]
buffer_load_dwordx4 v9, s[12:15], s25 offen offset:3072 lds
M a[120:123], a[188:191], a[228:231], a[120:123]
ds_read_b64_tr_b16 a[212:213], v15 offset:40960
ds_read_b64_tr_b16 a[214:215], v15 offset:42496
M a[120:123], a[184:187], a[224:227], a[120:123]
v_mov_b32 v184, 0
v_mov_b32 v185, 0
M a[124:127], a[192:195], a[224:227], a[124:127]
s_add_u32 m0, s30, 40960
s_nop 0
buffer_load_dwordx4 v21, s[12:15], s25 offen offset:0 lds
M a[124:127], a[196:199], a[228:231], a[124:127]
s_waitcnt lgkmcnt(10)
v_mov_b32 v186, 0
v_mov_b32 v187, 0
M a[128:131], a[180:183], a[236:239], a[128:131]
ds_read_b128 a[224:227], v10 offset:34816
ds_read_b128 a[228:231], v11 offset:34816
M a[128:131], a[176:179], a[232:235], a[128:131]
v_mov_b32 v188, 0
v_mov_b32 v189, 0
M a[132:135], a[184:187], a[232:235], a[132:135]
ds_read_b64_tr_b16 a[220:221], v16 offset:40960
ds_read_b64_tr_b16 a[222:223], v16 offset:42496
M a[132:135], a[188:191], a[236:239], a[132:135]
buffer_load_dwordx4 v22, s[12:15], s25 offen offset:1024 lds
v_mov_b32 v190, 0
v_mov_b32 v191, 0
M a[136:139], a[196:199], a[236:239], a[136:139]
M a[136:139], a[192:195], a[232:235], a[136:139]
s_waitcnt lgkmcnt(10)
M a[140:143], a[176:179], a[240:243], a[140:143]
s_sub_u32 s54, s54, 1
s_cmp_eq_u32 s54, 0
s_cselect_b32 s58, s55, s56
s_add_u32 s25, s25, s58
v_mov_b32 v192, 0
v_mov_b32 v193, 0
M a[140:143], a[180:183], a[244:247], a[140:143]
M a[144:147], a[188:191], a[244:247], a[144:147]
v_mov_b32 v194, 0
v_mov_b32 v195, 0
M a[144:147], a[184:187], a[240:243], a[144:147]
M a[148:151], a[192:195], a[240:243], a[148:151]
s_waitcnt vmcnt(12) lgkmcnt(0)
s_barrier
ds_read_b128 a[232:235], v12 offset:0
ds_read_b128 a[236:239], v13 offset:0
v_mov_b32 v196, 0
v_mov_b32 v197, 0
M a[148:151], a[196:199], a[244:247], a[148:151]
s_add_u32 m0, s28, 18432
s_nop 0
buffer_load_dword v20, s[8:11], s24 offen lds
M a[152:155], a[180:183], a[252:255], a[152:155]
ds_read_b128 a[240:243], v12 offset:2048
ds_read_b128 a[244:247], v13 offset:2048
v_mov_b32 v198, 0
v_mov_b32 v199, 0
M a[152:155], a[176:179], a[248:251], a[152:155]
M a[156:159], a[184:187], a[248:251], a[156:159]
buffer_load_dword v23, s[8:11], s24 offen offset:256 lds
M a[156:159], a[188:191], a[252:255], a[156:159]
v_mov_b32 v200, 0
v_mov_b32 v201, 0
M a[160:163], a[196:199], a[252:255], a[160:163]
M a[160:163], a[192:195], a[248:251], a[160:163]
s_add_u32 m0, s29, 20480
s_nop 0
buffer_load_dwordx4 v2, s[8:11], s23 offen offset:0 lds
v_mov_b32 v202, 0
v_mov_b32 v203, 0
M a[164:167], a[176:179], a[224:227], a[164:167]
ds_read_b128 a[248:251], v12 offset:4096
ds_read_b128 a[252:255], v13 offset:4096
M a[164:167], a[180:183], a[228:231], a[164:167]
v_mov_b32 v204, 0
v_mov_b32 v205, 0
M a[168:171], a[188:191], a[228:231], a[168:171]
M a[168:171], a[184:187], a[224:227], a[168:171]
buffer_load_dwordx4 v3, s[8:11], s23 offen offset:1024 lds
v_mov_b32 v206, 0
v_mov_b32 v207, 0
M a[172:175], a[192:195], a[224:227], a[172:175]
M a[172:175], a[196:199], a[228:231], a[172:175]
s_waitcnt lgkmcnt(4)
M a[68:71], a[200:203], a[232:235], a[68:71]
ds_read_b128 a[224:227], v12 offset:6144
ds_read_b128 a[228:231], v13 offset:6144
v_and_b32 v128, 15, v0
v_mul_u32_u24 v128, 400, v128
M a[68:71], a[204:207], a[236:239], a[68:71]
buffer_load_dwordx4 v4, s[8:11], s23 offen offset:2048 lds
M a[72:75], a[212:215], a[236:239], a[72:75]
ds_read_b64_tr_b16 a[176:177], v17 offset:0
ds_read_b64_tr_b16 a[178:179], v17 offset:1536
v_lshrrev_b32 v129, 4, v0
v_lshl_add_u32 v128, v129, 3, v128
M a[72:75], a[208:211], a[232:235], a[72:75]
M a[76:79], a[216:219], a[232:235], a[76:79]
buffer_load_dwordx4 v5, s[8:11], s23 offen offset:3072 lds
s_mul_i32 s3, s20, 96
s_add_u32 s3, s3, 98304
M a[76:79], a[220:223], a[236:239], a[76:79]
s_waitcnt lgkmcnt(6)
M a[80:83], a[204:207], a[244:247], a[80:83]
ds_read_b128 a[232:235], v12 offset:8192
ds_read_b128 a[236:239], v13 offset:8192
v_add_u32 v124, s3, v128
v_and_b32 v128, 15, v0
M a[80:83], a[200:203], a[240:243], a[80:83]
M a[84:87], a[208:211], a[240:243], a[84:87]
ds_read_b64_tr_b16 a[184:185], v18 offset:0
ds_read_b64_tr_b16 a[186:187], v18 offset:1536
v_lshrrev_b32 v129, 4, v0
s_add_u32 s3, s21, 16
M a[84:87], a[212:215], a[244:247], a[84:87]
s_sub_u32 s31, s31, 1
s_cmp_eq_u32 s31, 0
s_cselect_b32 s58, -1920, s57
s_add_u32 s23, s23, s58
s_add_u32 s24, s24, s58
M a[88:91], a[220:223], a[244:247], a[88:91]
v_lshl_add_u32 v130, v128, 1, s3
s_lshl_b32 s4, s22, 6
M a[88:91], a[216:219], a[240:243], a[88:91]
s_waitcnt lgkmcnt(8)
M a[92:95], a[200:203], a[248:251], a[92:95]
ds_read_b128 a[240:243], v12 offset:10240
ds_read_b128 a[244:247], v13 offset:10240
s_add_u32 s4, s4, 98304
v_mul_u32_u24 v120, 400, v130
M a[92:95], a[204:207], a[252:255], a[92:95]
s_add_u32 m0, s30, 65536
s_nop 0
buffer_load_dwordx4 v6, s[12:15], s25 offen offset:0 lds
M a[96:99], a[212:215], a[252:255], a[96:99]
ds_read_b64_tr_b16 a[192:193], v19 offset:0
ds_read_b64_tr_b16 a[194:195], v19 offset:1536
M a[96:99], a[208:211], a[248:251], a[96:99]
v_lshl_add_u32 v120, v129, 4, v120
v_add_u32 v120, s4, v120
M a[100:103], a[216:219], a[248:251], a[100:103]
buffer_load_dwordx4 v7, s[12:15], s25 offen offset:1024 lds
M a[100:103], a[220:223], a[252:255], a[100:103]
s_waitcnt lgkmcnt(10)
v_subrev_u32 v130, 32, v130
v_max_i32 v130, 0, v130
M a[104:107], a[204:207], a[228:231], a[104:107]
ds_read_b128 a[248:251], v12 offset:12288
ds_read_b128 a[252:255], v13 offset:12288
M a[104:107], a[200:203], a[224:227], a[104:107]
v_mul_u32_u24 v121, 400, v130
v_lshl_add_u32 v121, v129, 4, v121
M a[108:111], a[208:211], a[224:227], a[108:111]
ds_read_b64_tr_b16 a[180:181], v17 offset:12288
ds_read_b64_tr_b16 a[182:183], v17 offset:13824
M a[108:111], a[212:215], a[228:231], a[108:111]
buffer_load_dwordx4 v8, s[12:15], s25 offen offset:2048 lds
v_add_u32 v121, s4, v121
v_bfe_u32 v131, v0, 2, 2
M a[112:115], a[220:223], a[228:231], a[112:115]
M a[112:115], a[216:219], a[224:227], a[112:115]
s_waitcnt lgkmcnt(10)
v_lshl_add_u32 v131, v129, 2, v131
v_lshl_add_u32 v131, v131, 1, s3
M a[116:119], a[200:203], a[232:235], a[116:119]
ds_read_b128 a[224:227], v12 offset:14336
ds_read_b128 a[228:231], v13 offset:14336
M a[116:119], a[204:207], a[236:239], a[116:119]
buffer_load_dwordx4 v9, s[12:15], s25 offen offset:3072 lds
v_and_b32 v132, 3, v0
v_lshlrev_b32 v132, 3, v132
M a[120:123], a[212:215], a[236:239], a[120:123]
ds_read_b64_tr_b16 a[188:189], v18 offset:12288
ds_read_b64_tr_b16 a[190:191], v18 offset:13824
M a[120:123], a[208:211], a[232:235], a[120:123]
M a[124:127], a[216:219], a[232:235], a[124:127]
s_add_u32 m0, s30, 69632
s_nop 0
buffer_load_dwordx4 v21, s[12:15], s25 offen offset:0 lds
v_add_u32 v132, s4, v132
s_movk_i32 s5, 400
M a[124:127], a[220:223], a[236:239], a[124:127]
s_waitcnt lgkmcnt(10)
M a[128:131], a[204:207], a[244:247], a[128:131]
ds_read_b128 a[232:235], v12 offset:16384
ds_read_b128 a[236:239], v13 offset:16384
v_mad_u32_u24 v122, v131, s5, v132
v_subrev_u32 v131, 32, v131
M a[128:131], a[200:203], a[240:243], a[128:131]
M a[132:135], a[208:211], a[240:243], a[132:135]
ds_read_b64_tr_b16 a[196:197], v19 offset:12288
ds_read_b64_tr_b16 a[198:199], v19 offset:13824
v_max_i32 v131, 0, v131
v_mad_u32_u24 v123, v131, s5, v132
M a[132:135], a[212:215], a[244:247], a[132:135]
buffer_load_dwordx4 v22, s[12:15], s25 offen offset:1024 lds
M a[136:139], a[220:223], a[244:247], a[136:139]
v_lshlrev_b32 v129, 2, v129
v_sub_u32 v128, v128, v129
M a[136:139], a[216:219], a[240:243], a[136:139]
s_waitcnt lgkmcnt(10)
M a[140:143], a[200:203], a[248:251], a[140:143]
s_sub_u32 s54, s54, 1
s_cmp_eq_u32 s54, 0
s_cselect_b32 s58, s55, s56
s_add_u32 s25, s25, s58
v_mov_b32 v129, 0xf149f2ca
s_cmp_eq_u32 s26, 0
s_cselect_b32 s3, 0xf149f2ca, 0
M a[140:143], a[204:207], a[252:255], a[140:143]
M a[144:147], a[212:215], a[252:255], a[144:147]
v_cmp_lt_i32 vcc, -9, v128
s_nop 1
v_cndmask_b32 v144, 0, v129, vcc
M a[144:147], a[208:211], a[248:251], a[144:147]
M a[148:151], a[216:219], a[248:251], a[148:151]
s_waitcnt vmcnt(12) lgkmcnt(0)
s_barrier
ds_read_b128 a[240:243], v10 offset:0
ds_read_b128 a[244:247], v11 offset:0
M a[148:151], a[220:223], a[252:255], a[148:151]
s_add_u32 m0, s28, 131072
s_nop 0
buffer_load_dword v20, s[8:11], s24 offen lds
v_subrev_u32 v130, 0, v128
v_cmp_lt_u32 vcc, 7, v130
s_nop 1
v_cndmask_b32 v148, 0, v129, vcc
M a[152:155], a[204:207], a[228:231], a[152:155]
ds_read_b128 a[248:251], v10 offset:2048
ds_read_b128 a[252:255], v11 offset:2048
M a[152:155], a[200:203], a[224:227], a[152:155]
v_min_f32 v152, s3, v144
v_mov_b32 v156, 0x3f803f80
M a[156:159], a[208:211], a[224:227], a[156:159]
buffer_load_dword v23, s[8:11], s24 offen offset:256 lds
M a[156:159], a[212:215], a[228:231], a[156:159]
v_cmp_lt_i32 vcc, -8, v128
s_nop 1
v_cndmask_b32 v145, 0, v129, vcc
M a[160:163], a[220:223], a[228:231], a[160:163]
M a[160:163], a[216:219], a[224:227], a[160:163]
s_add_u32 m0, s29, 133120
s_nop 0
buffer_load_dwordx4 v2, s[8:11], s23 offen offset:0 lds
v_subrev_u32 v130, 1, v128
v_cmp_lt_u32 vcc, 7, v130
s_nop 1
v_cndmask_b32 v149, 0, v129, vcc
M a[164:167], a[200:203], a[232:235], a[164:167]
ds_read_b128 a[224:227], v10 offset:4096
ds_read_b128 a[228:231], v11 offset:4096
M a[164:167], a[204:207], a[236:239], a[164:167]
v_min_f32 v153, s3, v145
v_mov_b32 v157, 0x3f803f80
M a[168:171], a[212:215], a[236:239], a[168:171]
M a[168:171], a[208:211], a[232:235], a[168:171]
buffer_load_dwordx4 v3, s[8:11], s23 offen offset:1024 lds
v_cmp_lt_i32 vcc, -7, v128
s_nop 1
v_cndmask_b32 v146, 0, v129, vcc
M a[172:175], a[216:219], a[232:235], a[172:175]
M a[172:175], a[220:223], a[236:239], a[172:175]
s_waitcnt lgkmcnt(4)
M a[68:71], a[176:179], a[240:243], a[68:71]
ds_read_b128 a[232:235], v10 offset:6144
ds_read_b128 a[236:239], v11 offset:6144
v_subrev_u32 v130, 2, v128
v_cmp_lt_u32 vcc, 7, v130
s_nop 1
v_cndmask_b32 v150, 0, v129, vcc
M a[68:71], a[180:183], a[244:247], a[68:71]
buffer_load_dwordx4 v4, s[8:11], s23 offen offset:2048 lds
v_min_f32 v154, s3, v146
v_mov_b32 v158, 0x3f803f80
M a[72:75], a[188:191], a[244:247], a[72:75]
ds_read_b64_tr_b16 a[200:201], v14 offset:0
ds_read_b64_tr_b16 a[202:203], v14 offset:1536
M a[72:75], a[184:187], a[240:243], a[72:75]
v_cmp_lt_i32 vcc, -6, v128
s_nop 1
v_cndmask_b32 v147, 0, v129, vcc
M a[76:79], a[192:195], a[240:243], a[76:79]
buffer_load_dwordx4 v5, s[8:11], s23 offen offset:3072 lds
v_subrev_u32 v130, 3, v128
v_cmp_lt_u32 vcc, 7, v130
s_nop 1
v_cndmask_b32 v151, 0, v129, vcc
M a[76:79], a[196:199], a[244:247], a[76:79]
s_waitcnt lgkmcnt(6)
M a[80:83], a[180:183], a[252:255], a[80:83]
ds_read_b128 a[240:243], v10 offset:8192
ds_read_b128 a[244:247], v11 offset:8192
v_min_f32 v155, s3, v147
v_mov_b32 v159, 0x3f803f80
M a[80:83], a[176:179], a[248:251], a[80:83]
s_add_u32 s16, s50, 83886080
s_addc_u32 s17, s51, 0
M a[84:87], a[184:187], a[248:251], a[84:87]
ds_read_b64_tr_b16 a[208:209], v15 offset:0
ds_read_b64_tr_b16 a[210:211], v15 offset:1536
M a[84:87], a[188:191], a[252:255], a[84:87]
s_sub_u32 s31, s31, 1
s_cmp_eq_u32 s31, 0
s_cselect_b32 s58, -1920, s57
s_add_u32 s23, s23, s58
s_add_u32 s24, s24, s58
s_mov_b32 s18, 4194304
s_mov_b32 s19, 0x00020000
M a[88:91], a[196:199], a[252:255], a[88:91]
s_lshl_b32 s3, s26, 18
s_lshl_b32 s4, s27, 14
M a[88:91], a[192:195], a[248:251], a[88:91]
s_waitcnt lgkmcnt(8)
M a[92:95], a[176:179], a[224:227], a[92:95]
ds_read_b128 a[248:251], v10 offset:10240
ds_read_b128 a[252:255], v11 offset:10240
s_add_u32 s3, s3, s4
s_lshl_b32 s4, s21, 13
M a[92:95], a[180:183], a[228:231], a[92:95]
s_add_u32 m0, s30, 98304
s_nop 0
buffer_load_dwordx4 v6, s[12:15], s25 offen offset:0 lds
s_add_u32 s3, s3, s4
s_lshl_b32 s4, s22, 10
M a[96:99], a[188:191], a[228:231], a[96:99]
ds_read_b64_tr_b16 a[216:217], v16 offset:0
ds_read_b64_tr_b16 a[218:219], v16 offset:1536
M a[96:99], a[184:187], a[224:227], a[96:99]
s_add_u32 s6, s3, s4
s_mov_b32 s7, 0x3e8293ee
M a[100:103], a[192:195], a[224:227], a[100:103]
buffer_load_dwordx4 v7, s[12:15], s25 offen offset:1024 lds
s_lshl_b32 s65, s26, 8
s_lshl_b32 s3, s27, 4
M a[100:103], a[196:199], a[228:231], a[100:103]
s_waitcnt lgkmcnt(10)
M a[104:107], a[180:183], a[236:239], a[104:107]
ds_read_b128 a[224:227], v10 offset:12288
ds_read_b128 a[228:231], v11 offset:12288
s_add_u32 s65, s65, s3
s_lshl_b32 s3, s101, 2
M a[104:107], a[176:179], a[232:235], a[104:107]
s_add_u32 s65, s65, s3
s_add_u32 s65, s65, 16789504
M a[108:111], a[184:187], a[232:235], a[108:111]
ds_read_b64_tr_b16 a[204:205], v14 offset:12288
ds_read_b64_tr_b16 a[206:207], v14 offset:13824
M a[108:111], a[188:191], a[236:239], a[108:111]
buffer_load_dwordx4 v8, s[12:15], s25 offen offset:2048 lds
s_mov_b32 s40, 0
v_mov_b32 v119, 0
M a[112:115], a[196:199], a[236:239], a[112:115]
s_mov_b64 s[4:5], s[50:51]
s_and_b32 s20, s2, 7
M a[112:115], a[192:195], a[232:235], a[112:115]
s_waitcnt lgkmcnt(10)
M a[116:119], a[176:179], a[240:243], a[116:119]
ds_read_b128 a[232:235], v10 offset:14336
ds_read_b128 a[236:239], v11 offset:14336
s_lshr_b32 s33, s2, 6
s_lshl_b32 s33, s33, 3
M a[116:119], a[180:183], a[244:247], a[116:119]
buffer_load_dwordx4 v9, s[12:15], s25 offen offset:3072 lds
s_add_u32 s20, s20, s33
s_bfe_u32 s21, s2, 0x30003
M a[120:123], a[188:191], a[244:247], a[120:123]
ds_read_b64_tr_b16 a[212:213], v15 offset:12288
ds_read_b64_tr_b16 a[214:215], v15 offset:13824
M a[120:123], a[184:187], a[240:243], a[120:123]
s_sub_u32 s35, 15, s21
s_cmp_lt_u32 s101, 2
s_cselect_b32 s35, s21, s35
M a[124:127], a[192:195], a[240:243], a[124:127]
s_add_u32 m0, s30, 102400
s_nop 0
buffer_load_dwordx4 v21, s[12:15], s25 offen offset:0 lds
s_lshl_b32 s33, s20, 7
s_lshl_b32 s34, s35, 3
M a[124:127], a[196:199], a[244:247], a[124:127]
s_waitcnt lgkmcnt(10)
M a[128:131], a[180:183], a[252:255], a[128:131]
ds_read_b128 a[240:243], v10 offset:16384
ds_read_b128 a[244:247], v11 offset:16384
s_add_u32 s33, s33, s34
s_and_b32 s34, s101, 1
M a[128:131], a[176:179], a[248:251], a[128:131]
s_lshl_b32 s34, s34, 2
s_add_u32 s33, s33, s34
M a[132:135], a[184:187], a[248:251], a[132:135]
ds_read_b64_tr_b16 a[220:221], v16 offset:12288
ds_read_b64_tr_b16 a[222:223], v16 offset:13824
M a[132:135], a[188:191], a[252:255], a[132:135]
buffer_load_dwordx4 v22, s[12:15], s25 offen offset:1024 lds
s_lshl_b32 s64, s33, 12
s_mov_b32 s44, s4
M a[136:139], a[196:199], a[252:255], a[136:139]
s_mov_b32 s45, s5
s_mov_b32 s46, 16777216
M a[136:139], a[192:195], a[248:251], a[136:139]
s_waitcnt lgkmcnt(10)
M a[140:143], a[176:179], a[224:227], a[140:143]
s_sub_u32 s54, s54, 1
s_cmp_eq_u32 s54, 0
s_cselect_b32 s58, s55, s56
s_add_u32 s25, s25, s58
s_mov_b32 s47, 0x00020000
M a[140:143], a[180:183], a[228:231], a[140:143]
M a[144:147], a[188:191], a[228:231], a[144:147]
M a[144:147], a[184:187], a[224:227], a[144:147]
M a[148:151], a[192:195], a[224:227], a[148:151]
s_waitcnt vmcnt(12) lgkmcnt(0)
s_barrier
ds_read_b128 a[248:251], v10 offset:18432
ds_read_b128 a[252:255], v11 offset:18432
M a[148:151], a[196:199], a[228:231], a[148:151]
s_add_u32 m0, s28, 0
s_nop 0
buffer_load_dword v20, s[8:11], s24 offen lds
M a[152:155], a[180:183], a[236:239], a[152:155]
ds_read_b128 a[224:227], v10 offset:20480
ds_read_b128 a[228:231], v11 offset:20480
M a[152:155], a[176:179], a[232:235], a[152:155]
M a[156:159], a[184:187], a[232:235], a[156:159]
buffer_load_dword v23, s[8:11], s24 offen offset:256 lds
M a[156:159], a[188:191], a[236:239], a[156:159]
M a[160:163], a[196:199], a[236:239], a[160:163]
M a[160:163], a[192:195], a[232:235], a[160:163]
s_add_u32 m0, s29, 2048
s_nop 0
buffer_load_dwordx4 v2, s[8:11], s23 offen offset:0 lds
M a[164:167], a[176:179], a[240:243], a[164:167]
ds_read_b128 a[232:235], v10 offset:22528
ds_read_b128 a[236:239], v11 offset:22528
M a[164:167], a[180:183], a[244:247], a[164:167]
M a[168:171], a[188:191], a[244:247], a[168:171]
M a[168:171], a[184:187], a[240:243], a[168:171]
buffer_load_dwordx4 v3, s[8:11], s23 offen offset:1024 lds
M a[172:175], a[192:195], a[240:243], a[172:175]
M a[172:175], a[196:199], a[244:247], a[172:175]
s_waitcnt lgkmcnt(4)
M a[68:71], a[200:203], a[248:251], a[68:71]
ds_read_b128 a[240:243], v10 offset:24576
ds_read_b128 a[244:247], v11 offset:24576
M a[68:71], a[204:207], a[252:255], a[68:71]
buffer_load_dwordx4 v4, s[8:11], s23 offen offset:2048 lds
M a[72:75], a[212:215], a[252:255], a[72:75]
ds_read_b64_tr_b16 a[176:177], v14 offset:28672
ds_read_b64_tr_b16 a[178:179], v14 offset:30208
M a[72:75], a[208:211], a[248:251], a[72:75]
M a[76:79], a[216:219], a[248:251], a[76:79]
buffer_load_dwordx4 v5, s[8:11], s23 offen offset:3072 lds
M a[76:79], a[220:223], a[252:255], a[76:79]
s_waitcnt lgkmcnt(6)
M a[80:83], a[204:207], a[228:231], a[80:83]
ds_read_b128 a[248:251], v10 offset:26624
ds_read_b128 a[252:255], v11 offset:26624
M a[80:83], a[200:203], a[224:227], a[80:83]
M a[84:87], a[208:211], a[224:227], a[84:87]
ds_read_b64_tr_b16 a[184:185], v15 offset:28672
ds_read_b64_tr_b16 a[186:187], v15 offset:30208
M a[84:87], a[212:215], a[228:231], a[84:87]
s_sub_u32 s31, s31, 1
s_cmp_eq_u32 s31, 0
s_cselect_b32 s58, -1920, s57
s_add_u32 s23, s23, s58
s_add_u32 s24, s24, s58
M a[88:91], a[220:223], a[228:231], a[88:91]
M a[88:91], a[216:219], a[224:227], a[88:91]
s_waitcnt lgkmcnt(8)
M a[92:95], a[200:203], a[232:235], a[92:95]
ds_read_b128 a[224:227], v10 offset:28672
ds_read_b128 a[228:231], v11 offset:28672
M a[92:95], a[204:207], a[236:239], a[92:95]
s_add_u32 m0, s30, 36864
s_nop 0
buffer_load_dwordx4 v6, s[12:15], s25 offen offset:0 lds
M a[96:99], a[212:215], a[236:239], a[96:99]
ds_read_b64_tr_b16 a[192:193], v16 offset:28672
ds_read_b64_tr_b16 a[194:195], v16 offset:30208
M a[96:99], a[208:211], a[232:235], a[96:99]
M a[100:103], a[216:219], a[232:235], a[100:103]
buffer_load_dwordx4 v7, s[12:15], s25 offen offset:1024 lds
M a[100:103], a[220:223], a[236:239], a[100:103]
s_waitcnt lgkmcnt(10)
M a[104:107], a[204:207], a[244:247], a[104:107]
ds_read_b128 a[232:235], v10 offset:30720
ds_read_b128 a[236:239], v11 offset:30720
M a[104:107], a[200:203], a[240:243], a[104:107]
M a[108:111], a[208:211], a[240:243], a[108:111]
ds_read_b64_tr_b16 a[180:181], v14 offset:40960
ds_read_b64_tr_b16 a[182:183], v14 offset:42496
M a[108:111], a[212:215], a[244:247], a[108:111]
buffer_load_dwordx4 v8, s[12:15], s25 offen offset:2048 lds
M a[112:115], a[220:223], a[244:247], a[112:115]
M a[112:115], a[216:219], a[240:243], a[112:115]
s_waitcnt lgkmcnt(10)
M a[116:119], a[200:203], a[248:251], a[116:119]
ds_read_b128 a[240:243], v10 offset:32768
ds_read_b128 a[244:247], v11 offset:32768
M a[116:119], a[204:207], a[252:255], a[116:119]
buffer_load_dwordx4 v9, s[12:15], s25 offen offset:3072 lds
M a[120:123], a[212:215], a[252:255], a[120:123]
ds_read_b64_tr_b16 a[188:189], v15 offset:40960
ds_read_b64_tr_b16 a[190:191], v15 offset:42496
M a[120:123], a[208:211], a[248:251], a[120:123]
M a[124:127], a[216:219], a[248:251], a[124:127]
s_add_u32 m0, s30, 40960
s_nop 0
buffer_load_dwordx4 v21, s[12:15], s25 offen offset:0 lds
M a[124:127], a[220:223], a[252:255], a[124:127]
s_waitcnt lgkmcnt(10)
M a[128:131], a[204:207], a[228:231], a[128:131]
ds_read_b128 a[248:251], v10 offset:34816
ds_read_b128 a[252:255], v11 offset:34816
M a[128:131], a[200:203], a[224:227], a[128:131]
M a[132:135], a[208:211], a[224:227], a[132:135]
ds_read_b64_tr_b16 a[196:197], v16 offset:40960
ds_read_b64_tr_b16 a[198:199], v16 offset:42496
M a[132:135], a[212:215], a[228:231], a[132:135]
buffer_load_dwordx4 v22, s[12:15], s25 offen offset:1024 lds
M a[136:139], a[220:223], a[228:231], a[136:139]
M a[136:139], a[216:219], a[224:227], a[136:139]
s_waitcnt lgkmcnt(10)
M a[140:143], a[200:203], a[232:235], a[140:143]
s_sub_u32 s54, s54, 1
s_cmp_eq_u32 s54, 0
s_cselect_b32 s58, s55, s56
s_add_u32 s25, s25, s58
M a[140:143], a[204:207], a[236:239], a[140:143]
M a[144:147], a[212:215], a[236:239], a[144:147]
M a[144:147], a[208:211], a[232:235], a[144:147]
M a[148:151], a[216:219], a[232:235], a[148:151]
s_waitcnt vmcnt(12) lgkmcnt(0)
s_barrier
ds_read_b128 a[224:227], v12 offset:0
ds_read_b128 a[228:231], v13 offset:0
M a[148:151], a[220:223], a[236:239], a[148:151]
s_add_u32 m0, s28, 18432
s_nop 0
buffer_load_dword v20, s[8:11], s24 offen lds
M a[152:155], a[204:207], a[244:247], a[152:155]
ds_read_b128 a[232:235], v12 offset:2048
ds_read_b128 a[236:239], v13 offset:2048
M a[152:155], a[200:203], a[240:243], a[152:155]
M a[156:159], a[208:211], a[240:243], a[156:159]
buffer_load_dword v23, s[8:11], s24 offen offset:256 lds
M a[156:159], a[212:215], a[244:247], a[156:159]
M a[160:163], a[220:223], a[244:247], a[160:163]
M a[160:163], a[216:219], a[240:243], a[160:163]
s_add_u32 m0, s29, 20480
s_nop 0
buffer_load_dwordx4 v2, s[8:11], s23 offen offset:0 lds
M a[164:167], a[200:203], a[248:251], a[164:167]
ds_read_b128 a[240:243], v12 offset:4096
ds_read_b128 a[244:247], v13 offset:4096
M a[164:167], a[204:207], a[252:255], a[164:167]
M a[168:171], a[212:215], a[252:255], a[168:171]
M a[168:171], a[208:211], a[248:251], a[168:171]
buffer_load_dwordx4 v3, s[8:11], s23 offen offset:1024 lds
M a[172:175], a[216:219], a[248:251], a[172:175]
M a[172:175], a[220:223], a[252:255], a[172:175]
s_waitcnt lgkmcnt(4)
M a[68:71], a[176:179], a[224:227], a[68:71]
ds_read_b128 a[248:251], v12 offset:6144
ds_read_b128 a[252:255], v13 offset:6144
M a[68:71], a[180:183], a[228:231], a[68:71]
buffer_load_dwordx4 v4, s[8:11], s23 offen offset:2048 lds
M a[72:75], a[188:191], a[228:231], a[72:75]
ds_read_b64_tr_b16 a[200:201], v17 offset:0
ds_read_b64_tr_b16 a[202:203], v17 offset:1536
M a[72:75], a[184:187], a[224:227], a[72:75]
M a[76:79], a[192:195], a[224:227], a[76:79]
buffer_load_dwordx4 v5, s[8:11], s23 offen offset:3072 lds
M a[76:79], a[196:199], a[228:231], a[76:79]
s_waitcnt lgkmcnt(6)
M a[80:83], a[180:183], a[236:239], a[80:83]
ds_read_b128 a[224:227], v12 offset:8192
ds_read_b128 a[228:231], v13 offset:8192
M a[80:83], a[176:179], a[232:235], a[80:83]
s_sub_u32 s31, s31, 1
s_cmp_eq_u32 s31, 0
s_cselect_b32 s58, -1920, s57
s_add_u32 s23, s23, s58
s_add_u32 s24, s24, s58
M a[84:87], a[184:187], a[232:235], a[84:87]
ds_read_b64_tr_b16 a[208:209], v18 offset:0
ds_read_b64_tr_b16 a[210:211], v18 offset:1536
M a[84:87], a[188:191], a[236:239], a[84:87]
M a[88:91], a[196:199], a[236:239], a[88:91]
M a[88:91], a[192:195], a[232:235], a[88:91]
s_add_u32 m0, s30, 65536
s_nop 0
buffer_load_dwordx4 v6, s[12:15], s25 offen offset:0 lds
s_waitcnt lgkmcnt(8)
M a[92:95], a[176:179], a[240:243], a[92:95]
ds_read_b128 a[232:235], v12 offset:10240
ds_read_b128 a[236:239], v13 offset:10240
M a[92:95], a[180:183], a[244:247], a[92:95]
M a[96:99], a[188:191], a[244:247], a[96:99]
ds_read_b64_tr_b16 a[216:217], v19 offset:0
ds_read_b64_tr_b16 a[218:219], v19 offset:1536
M a[96:99], a[184:187], a[240:243], a[96:99]
buffer_load_dwordx4 v7, s[12:15], s25 offen offset:1024 lds
M a[100:103], a[192:195], a[240:243], a[100:103]
M a[100:103], a[196:199], a[244:247], a[100:103]
s_waitcnt lgkmcnt(10)
M a[104:107], a[180:183], a[252:255], a[104:107]
ds_read_b128 a[240:243], v12 offset:12288
ds_read_b128 a[244:247], v13 offset:12288
M a[104:107], a[176:179], a[248:251], a[104:107]
buffer_load_dwordx4 v8, s[12:15], s25 offen offset:2048 lds
M a[108:111], a[184:187], a[248:251], a[108:111]
ds_read_b64_tr_b16 a[204:205], v17 offset:12288
ds_read_b64_tr_b16 a[206:207], v17 offset:13824
M a[108:111], a[188:191], a[252:255], a[108:111]
M a[112:115], a[196:199], a[252:255], a[112:115]
buffer_load_dwordx4 v9, s[12:15], s25 offen offset:3072 lds
M a[112:115], a[192:195], a[248:251], a[112:115]
s_waitcnt lgkmcnt(10)
M a[116:119], a[176:179], a[224:227], a[116:119]
ds_read_b128 a[248:251], v12 offset:14336
ds_read_b128 a[252:255], v13 offset:14336
M a[116:119], a[180:183], a[228:231], a[116:119]
M a[120:123], a[188:191], a[228:231], a[120:123]
ds_read_b64_tr_b16 a[212:213], v18 offset:12288
ds_read_b64_tr_b16 a[214:215], v18 offset:13824
M a[120:123], a[184:187], a[224:227], a[120:123]
s_add_u32 m0, s30, 69632
s_nop 0
buffer_load_dwordx4 v21, s[12:15], s25 offen offset:0 lds
M a[124:127], a[192:195], a[224:227], a[124:127]
M a[124:127], a[196:199], a[228:231], a[124:127]
buffer_load_dwordx4 v22, s[12:15], s25 offen offset:1024 lds
s_waitcnt lgkmcnt(10)
M a[128:131], a[180:183], a[236:239], a[128:131]
ds_read_b128 a[224:227], v12 offset:16384
ds_read_b128 a[228:231], v13 offset:16384
M a[128:131], a[176:179], a[232:235], a[128:131]
M a[132:135], a[184:187], a[232:235], a[132:135]
ds_read_b64_tr_b16 a[220:221], v19 offset:12288
ds_read_b64_tr_b16 a[222:223], v19 offset:13824
M a[132:135], a[188:191], a[236:239], a[132:135]
M a[136:139], a[196:199], a[236:239], a[136:139]
s_sub_u32 s54, s54, 1
s_cmp_eq_u32 s54, 0
s_cselect_b32 s58, s55, s56
s_add_u32 s25, s25, s58
M a[136:139], a[192:195], a[232:235], a[136:139]
s_waitcnt lgkmcnt(10)
M a[140:143], a[176:179], a[240:243], a[140:143]
buffer_load_dword v125, v119, s[36:39], 0 offen sc1
M a[140:143], a[180:183], a[244:247], a[140:143]
M a[144:147], a[188:191], a[244:247], a[144:147]
M a[144:147], a[184:187], a[240:243], a[144:147]
M a[148:151], a[192:195], a[240:243], a[148:151]
s_waitcnt vmcnt(13) lgkmcnt(0)
s_barrier
ds_read_b128 a[232:235], v10 offset:0
ds_read_b128 a[236:239], v11 offset:0
s_waitcnt vmcnt(0)
v_cmp_gt_u32 vcc, 0x80, v125
s_nop 0
s_cbranch_vccnz Lk1_spinq
Lk1_gotq:
M a[148:151], a[196:199], a[244:247], a[148:151]
s_add_u32 m0, s28, 131072
s_nop 0
buffer_load_dword v20, s[8:11], s24 offen lds
M a[152:155], a[180:183], a[252:255], a[152:155]
ds_read_b128 a[240:243], v10 offset:2048
ds_read_b128 a[244:247], v11 offset:2048
M a[152:155], a[176:179], a[248:251], a[152:155]
M a[156:159], a[184:187], a[248:251], a[156:159]
buffer_load_dword v23, s[8:11], s24 offen offset:256 lds
M a[156:159], a[188:191], a[252:255], a[156:159]
M a[160:163], a[196:199], a[252:255], a[160:163]
M a[160:163], a[192:195], a[248:251], a[160:163]
s_add_u32 m0, s29, 133120
s_nop 0
buffer_load_dwordx4 v2, s[8:11], s23 offen offset:0 lds
M a[164:167], a[176:179], a[224:227], a[164:167]
ds_read_b128 a[248:251], v10 offset:4096
ds_read_b128 a[252:255], v11 offset:4096
M a[164:167], a[180:183], a[228:231], a[164:167]
M a[168:171], a[188:191], a[228:231], a[168:171]
M a[168:171], a[184:187], a[224:227], a[168:171]
buffer_load_dwordx4 v3, s[8:11], s23 offen offset:1024 lds
M a[172:175], a[192:195], a[224:227], a[172:175]
M a[172:175], a[196:199], a[228:231], a[172:175]
s_waitcnt lgkmcnt(4)
M a[68:71], a[200:203], a[232:235], a[68:71]
ds_read_b128 a[224:227], v10 offset:6144
ds_read_b128 a[228:231], v11 offset:6144
v_mov_b32 v208, 0
v_mov_b32 v209, 0
M a[68:71], a[204:207], a[236:239], a[68:71]
buffer_load_dwordx4 v4, s[8:11], s23 offen offset:2048 lds
M a[72:75], a[212:215], a[236:239], a[72:75]
ds_read_b64_tr_b16 a[176:177], v14 offset:0
ds_read_b64_tr_b16 a[178:179], v14 offset:1536
v_mov_b32 v210, 0
v_mov_b32 v211, 0
M a[72:75], a[208:211], a[232:235], a[72:75]
M a[76:79], a[216:219], a[232:235], a[76:79]
buffer_load_dwordx4 v5, s[8:11], s23 offen offset:3072 lds
v_mov_b32 v212, 0
v_mov_b32 v213, 0
M a[76:79], a[220:223], a[236:239], a[76:79]
s_waitcnt lgkmcnt(6)
M a[80:83], a[204:207], a[244:247], a[80:83]
ds_read_b128 a[232:235], v10 offset:8192
ds_read_b128 a[236:239], v11 offset:8192
v_mov_b32 v214, 0
v_mov_b32 v215, 0
M a[80:83], a[200:203], a[240:243], a[80:83]
s_sub_u32 s31, s31, 1
s_cmp_eq_u32 s31, 0
s_cselect_b32 s58, -1920, s57
s_add_u32 s23, s23, s58
s_add_u32 s24, s24, s58
M a[84:87], a[208:211], a[240:243], a[84:87]
ds_read_b64_tr_b16 a[184:185], v15 offset:0
ds_read_b64_tr_b16 a[186:187], v15 offset:1536
M a[84:87], a[212:215], a[244:247], a[84:87]
v_mov_b32 v216, 0
v_mov_b32 v217, 0
M a[88:91], a[220:223], a[244:247], a[88:91]
M a[88:91], a[216:219], a[240:243], a[88:91]
buffer_load_dwordx4 a[0:3], v1, s[44:47], s64 offen offset:0 sc1
s_waitcnt lgkmcnt(8)
v_mov_b32 v218, 0
v_mov_b32 v219, 0
M a[92:95], a[200:203], a[248:251], a[92:95]
ds_read_b128 a[240:243], v10 offset:10240
ds_read_b128 a[244:247], v11 offset:10240
M a[92:95], a[204:207], a[252:255], a[92:95]
v_mov_b32 v220, 0
v_mov_b32 v221, 0
M a[96:99], a[212:215], a[252:255], a[96:99]
ds_read_b64_tr_b16 a[192:193], v16 offset:0
ds_read_b64_tr_b16 a[194:195], v16 offset:1536
M a[96:99], a[208:211], a[248:251], a[96:99]
buffer_load_dwordx4 a[4:7], v1, s[44:47], s64 offen offset:1024 sc1
v_mov_b32 v222, 0
v_mov_b32 v223, 0
M a[100:103], a[216:219], a[248:251], a[100:103]
M a[100:103], a[220:223], a[252:255], a[100:103]
s_waitcnt lgkmcnt(10)
M a[104:107], a[204:207], a[228:231], a[104:107]
ds_read_b128 a[248:251], v10 offset:12288
ds_read_b128 a[252:255], v11 offset:12288
v_mov_b32 v224, 0
v_mov_b32 v225, 0
M a[104:107], a[200:203], a[224:227], a[104:107]
buffer_load_dwordx4 a[8:11], v1, s[44:47], s64 offen offset:2048 sc1
M a[108:111], a[208:211], a[224:227], a[108:111]
ds_read_b64_tr_b16 a[180:181], v14 offset:12288
ds_read_b64_tr_b16 a[182:183], v14 offset:13824
v_mov_b32 v226, 0
v_mov_b32 v227, 0
M a[108:111], a[212:215], a[228:231], a[108:111]
M a[112:115], a[220:223], a[228:231], a[112:115]
buffer_load_dwordx4 a[12:15], v1, s[44:47], s64 offen offset:3072 sc1
s_add_u32 s64, s64, 4096
v_mov_b32 v228, 0
v_mov_b32 v229, 0
M a[112:115], a[216:219], a[224:227], a[112:115]
s_waitcnt lgkmcnt(10)
M a[116:119], a[200:203], a[232:235], a[116:119]
ds_read_b128 a[224:227], v10 offset:14336
ds_read_b128 a[228:231], v11 offset:14336
v_mov_b32 v230, 0
v_mov_b32 v231, 0
M a[116:119], a[204:207], a[236:239], a[116:119]
M a[120:123], a[212:215], a[236:239], a[120:123]
ds_read_b64_tr_b16 a[188:189], v15 offset:12288
ds_read_b64_tr_b16 a[190:191], v15 offset:13824
M a[120:123], a[208:211], a[232:235], a[120:123]
buffer_load_dwordx4 a[16:19], v1, s[44:47], s64 offen offset:0 sc1
v_mov_b32 v232, 0
v_mov_b32 v233, 0
M a[124:127], a[216:219], a[232:235], a[124:127]
M a[124:127], a[220:223], a[236:239], a[124:127]
buffer_load_dwordx4 a[20:23], v1, s[44:47], s64 offen offset:1024 sc1
s_waitcnt lgkmcnt(10)
v_mov_b32 v234, 0
v_mov_b32 v235, 0
M a[128:131], a[204:207], a[244:247], a[128:131]
ds_read_b128 a[232:235], v10 offset:16384
ds_read_b128 a[236:239], v11 offset:16384
M a[128:131], a[200:203], a[240:243], a[128:131]
v_mov_b32 v236, 0
v_mov_b32 v237, 0
M a[132:135], a[208:211], a[240:243], a[132:135]
ds_read_b64_tr_b16 a[196:197], v16 offset:12288
ds_read_b64_tr_b16 a[198:199], v16 offset:13824
M a[132:135], a[212:215], a[244:247], a[132:135]
v_mov_b32 v238, 0
v_mov_b32 v239, 0
M a[136:139], a[220:223], a[244:247], a[136:139]
buffer_load_dwordx4 a[24:27], v1, s[44:47], s64 offen offset:2048 sc1
M a[136:139], a[216:219], a[240:243], a[136:139]
s_waitcnt lgkmcnt(10)
M a[140:143], a[200:203], a[248:251], a[140:143]
buffer_load_dwordx4 a[28:31], v1, s[44:47], s64 offen offset:3072 sc1
s_add_u32 s64, s64, 4096
v_mov_b32 v240, 0
v_mov_b32 v241, 0
M a[140:143], a[204:207], a[252:255], a[140:143]
M a[144:147], a[212:215], a[252:255], a[144:147]
v_mov_b32 v242, 0
v_mov_b32 v243, 0
M a[144:147], a[208:211], a[248:251], a[144:147]
M a[148:151], a[216:219], a[248:251], a[148:151]
s_waitcnt vmcnt(15) lgkmcnt(0)
s_barrier
ds_read_b128 a[240:243], v10 offset:18432
ds_read_b128 a[244:247], v11 offset:18432
v_mov_b32 v244, 0
v_mov_b32 v245, 0
M a[148:151], a[220:223], a[252:255], a[148:151]
buffer_load_dwordx4 a[32:35], v1, s[44:47], s64 offen offset:0 sc1
M a[152:155], a[204:207], a[228:231], a[152:155]
ds_read_b128 a[248:251], v10 offset:20480
ds_read_b128 a[252:255], v11 offset:20480
v_mov_b32 v246, 0
v_mov_b32 v247, 0
M a[152:155], a[200:203], a[224:227], a[152:155]
M a[156:159], a[208:211], a[224:227], a[156:159]
buffer_load_dwordx4 a[36:39], v1, s[44:47], s64 offen offset:1024 sc1
M a[156:159], a[212:215], a[228:231], a[156:159]
v_mov_b32 v248, 0
v_mov_b32 v249, 0
M a[160:163], a[220:223], a[228:231], a[160:163]
M a[160:163], a[216:219], a[224:227], a[160:163]
buffer_load_dwordx4 a[40:43], v1, s[44:47], s64 offen offset:2048 sc1
v_mov_b32 v250, 0
v_mov_b32 v251, 0
M a[164:167], a[200:203], a[232:235], a[164:167]
ds_read_b128 a[224:227], v10 offset:22528
ds_read_b128 a[228:231], v11 offset:22528
M a[164:167], a[204:207], a[236:239], a[164:167]
v_mov_b32 v252, 0
v_mov_b32 v253, 0
M a[168:171], a[212:215], a[236:239], a[168:171]
M a[168:171], a[208:211], a[232:235], a[168:171]
buffer_load_dwordx4 a[44:47], v1, s[44:47], s64 offen offset:3072 sc1
s_add_u32 s64, s64, 4096
v_mov_b32 v254, 0
v_mov_b32 v255, 0
M a[172:175], a[216:219], a[232:235], a[172:175]
M a[172:175], a[220:223], a[236:239], a[172:175]
s_waitcnt lgkmcnt(4)
M a[68:71], a[176:179], a[240:243], a[68:71]
ds_read_b128 a[232:235], v10 offset:24576
ds_read_b128 a[236:239], v11 offset:24576
s_mov_b32 s22, s101
s_and_b32 s23, s22, 1
M a[68:71], a[180:183], a[244:247], a[68:71]
buffer_load_dwordx4 a[48:51], v1, s[44:47], s64 offen offset:0 sc1
s_lshr_b32 s24, s22, 1
s_lshl_b32 s33, s24, 14
M a[72:75], a[188:191], a[244:247], a[72:75]
ds_read_b64_tr_b16 a[200:201], v14 offset:28672
ds_read_b64_tr_b16 a[202:203], v14 offset:30208
M a[72:75], a[184:187], a[240:243], a[72:75]
s_lshl_b32 s34, s23, 13
s_add_u32 s29, s33, s34
M a[76:79], a[192:195], a[240:243], a[76:79]
M a[76:79], a[196:199], a[244:247], a[76:79]
s_waitcnt lgkmcnt(6)
s_lshl_b32 s28, s20, 20
s_add_u32 s28, s28, s34
M a[80:83], a[180:183], a[252:255], a[80:83]
ds_read_b128 a[240:243], v10 offset:26624
ds_read_b128 a[244:247], v11 offset:26624
M a[80:83], a[176:179], a[248:251], a[80:83]
s_mov_b32 s25, s28
s_lshl_b32 s33, s21, 16
M a[84:87], a[184:187], a[248:251], a[84:87]
ds_read_b64_tr_b16 a[208:209], v15 offset:28672
ds_read_b64_tr_b16 a[210:211], v15 offset:30208
M a[84:87], a[188:191], a[252:255], a[84:87]
buffer_load_dwordx4 a[52:55], v1, s[44:47], s64 offen offset:1024 sc1
s_add_u32 s34, s28, s33
s_add_u32 s34, s34, 65536
M a[88:91], a[196:199], a[252:255], a[88:91]
M a[88:91], a[192:195], a[248:251], a[88:91]
s_waitcnt lgkmcnt(8)
s_add_u32 s32, s28, 491520
s_sub_u32 s33, s32, s33
M a[92:95], a[176:179], a[224:227], a[92:95]
ds_read_b128 a[248:251], v10 offset:28672
ds_read_b128 a[252:255], v11 offset:28672
M a[92:95], a[180:183], a[228:231], a[92:95]
s_add_u32 s33, s33, 491520
s_cmp_eq_u32 s24, 0
s_cselect_b32 s27, s34, s32
s_cselect_b32 s28, s32, s33
M a[96:99], a[188:191], a[228:231], a[96:99]
ds_read_b64_tr_b16 a[216:217], v16 offset:28672
ds_read_b64_tr_b16 a[218:219], v16 offset:30208
M a[96:99], a[184:187], a[224:227], a[96:99]
s_mov_b32 s56, s27
s_mov_b32 s57, s28
M a[100:103], a[192:195], a[224:227], a[100:103]
buffer_load_dwordx4 a[56:59], v1, s[44:47], s64 offen offset:2048 sc1
M a[100:103], a[196:199], a[228:231], a[100:103]
s_waitcnt lgkmcnt(10)
s_min_u32 s34, s34, s32
s_cmp_eq_u32 s34, s32
s_cselect_b32 s33, s33, s34
M a[104:107], a[180:183], a[236:239], a[104:107]
ds_read_b128 a[224:227], v10 offset:30720
ds_read_b128 a[228:231], v11 offset:30720
M a[104:107], a[176:179], a[232:235], a[104:107]
s_or_b32 s34, s34, 0x40000000
s_or_b32 s32, s25, 0x40000000
M a[108:111], a[184:187], a[232:235], a[108:111]
ds_read_b64_tr_b16 a[204:205], v14 offset:40960
ds_read_b64_tr_b16 a[206:207], v14 offset:42496
s_cmp_eq_u32 s24, 1
s_cselect_b32 s25, s32, s25
s_cselect_b32 s27, s34, s27
s_cselect_b32 s28, s33, s28
s_cselect_b32 s56, s56, -1
M a[108:111], a[188:191], a[236:239], a[108:111]
M a[112:115], a[196:199], a[236:239], a[112:115]
s_add_u32 s58, s56, 16384
s_add_u32 s59, s57, 16384
M a[112:115], a[192:195], a[232:235], a[112:115]
s_waitcnt lgkmcnt(10)
M a[116:119], a[176:179], a[240:243], a[116:119]
ds_read_b128 a[232:235], v10 offset:32768
ds_read_b128 a[236:239], v11 offset:32768
s_add_u32 s26, s25, 16384
s_add_u32 s62, s27, 16384
M a[116:119], a[180:183], a[244:247], a[116:119]
buffer_load_dwordx4 a[60:63], v1, s[44:47], s64 offen offset:3072 sc1
M a[120:123], a[188:191], a[244:247], a[120:123]
ds_read_b64_tr_b16 a[212:213], v15 offset:40960
ds_read_b64_tr_b16 a[214:215], v15 offset:42496
s_add_u32 s63, s28, 16384
s_lshl_b32 s31, s21, 7
M a[120:123], a[184:187], a[240:243], a[120:123]
M a[124:127], a[192:195], a[240:243], a[124:127]
s_cmp_eq_u32 s24, 0
s_cselect_b32 s31, s31, 960
M a[124:127], a[196:199], a[244:247], a[124:127]
s_waitcnt lgkmcnt(10)
M a[128:131], a[180:183], a[252:255], a[128:131]
ds_read_b128 a[240:243], v10 offset:34816
ds_read_b128 a[244:247], v11 offset:34816
s_mov_b32 s60, 0
s_add_u32 s12, s4, 16777216
s_addc_u32 s13, s5, 0
M a[128:131], a[176:179], a[248:251], a[128:131]
M a[132:135], a[184:187], a[248:251], a[132:135]
ds_read_b64_tr_b16 a[220:221], v16 offset:40960
ds_read_b64_tr_b16 a[222:223], v16 offset:42496
s_mov_b32 s14, 33554432
s_mov_b32 s15, 0x00020000
M a[132:135], a[188:191], a[252:255], a[132:135]
buffer_load_dword v126, v119, s[36:39], 0 offen offset:128 sc1
M a[136:139], a[196:199], a[252:255], a[136:139]
s_mov_b32 s8, s4
s_mov_b32 s9, s5
M a[136:139], a[192:195], a[248:251], a[136:139]
s_waitcnt lgkmcnt(10)
M a[140:143], a[176:179], a[224:227], a[140:143]
s_mov_b32 s10, 16777216
s_mov_b32 s11, 0x00020000
M a[140:143], a[180:183], a[228:231], a[140:143]
M a[144:147], a[188:191], a[228:231], a[144:147]
M a[144:147], a[184:187], a[224:227], a[144:147]
M a[148:151], a[192:195], a[224:227], a[148:151]
s_waitcnt vmcnt(17) lgkmcnt(0)
s_barrier
ds_read_b128 a[248:251], v12 offset:0
ds_read_b128 a[252:255], v13 offset:0
s_waitcnt vmcnt(0)
v_cmp_gt_u32 vcc, 0x80, v126
s_nop 0
s_cbranch_vccnz Lk1_spin
Lk1_got:
M a[148:151], a[196:199], a[228:231], a[148:151]
s_add_u32 m0, s29, 65536
s_add_u32 s32, s25, 4096
buffer_load_dwordx4 v1, s[12:15], s25 offen offset:0 sc1 lds
M a[152:155], a[180:183], a[236:239], a[152:155]
ds_read_b128 a[224:227], v12 offset:2048
ds_read_b128 a[228:231], v13 offset:2048
M a[152:155], a[176:179], a[232:235], a[152:155]
buffer_load_dwordx4 v1, s[12:15], s25 offen offset:1024 sc1 lds
M a[156:159], a[184:187], a[232:235], a[156:159]
M a[156:159], a[188:191], a[236:239], a[156:159]
buffer_load_dwordx4 v1, s[12:15], s25 offen offset:2048 sc1 lds
M a[160:163], a[196:199], a[236:239], a[160:163]
buffer_load_dwordx4 v1, s[12:15], s25 offen offset:3072 sc1 lds
M a[160:163], a[192:195], a[232:235], a[160:163]
M a[164:167], a[176:179], a[240:243], a[164:167]
ds_read_b128 a[232:235], v12 offset:4096
ds_read_b128 a[236:239], v13 offset:4096
M a[164:167], a[180:183], a[244:247], a[164:167]
s_add_u32 m0, s29, 69632
s_nop 0
buffer_load_dwordx4 v1, s[12:15], s32 offen offset:0 sc1 lds
M a[168:171], a[188:191], a[244:247], a[168:171]
buffer_load_dwordx4 v1, s[12:15], s32 offen offset:1024 sc1 lds
M a[168:171], a[184:187], a[240:243], a[168:171]
M a[172:175], a[192:195], a[240:243], a[172:175]
buffer_load_dwordx4 v1, s[12:15], s32 offen offset:2048 sc1 lds
M a[172:175], a[196:199], a[244:247], a[172:175]
s_waitcnt lgkmcnt(4)
M a[68:71], a[200:203], a[248:251], a[68:71]
ds_read_b128 a[240:243], v12 offset:6144
ds_read_b128 a[244:247], v13 offset:6144
M a[68:71], a[204:207], a[252:255], a[68:71]
buffer_load_dwordx4 v1, s[12:15], s32 offen offset:3072 sc1 lds
M a[72:75], a[212:215], a[252:255], a[72:75]
M a[72:75], a[208:211], a[248:251], a[72:75]
M a[76:79], a[216:219], a[248:251], a[76:79]
M a[76:79], a[220:223], a[252:255], a[76:79]
s_waitcnt lgkmcnt(4)
M a[80:83], a[204:207], a[228:231], a[80:83]
ds_read_b128 a[248:251], v12 offset:8192
ds_read_b128 a[252:255], v13 offset:8192
M a[80:83], a[200:203], a[224:227], a[80:83]
M a[84:87], a[208:211], a[224:227], a[84:87]
M a[84:87], a[212:215], a[228:231], a[84:87]
M a[88:91], a[220:223], a[228:231], a[88:91]
M a[88:91], a[216:219], a[224:227], a[88:91]
s_waitcnt lgkmcnt(4)
M a[92:95], a[200:203], a[232:235], a[92:95]
ds_read_b128 a[224:227], v12 offset:10240
ds_read_b128 a[228:231], v13 offset:10240
v_accvgpr_read_b32 v24, a68
v_accvgpr_read_b32 v25, a69
v_accvgpr_read_b32 v26, a70
M a[92:95], a[204:207], a[236:239], a[92:95]
v_accvgpr_read_b32 v27, a71
v_cvt_pk_bf16_f32 v24, v24, v25
v_cvt_pk_bf16_f32 v25, v26, v27
ds_write_b64 v124, v[24:25] offset:0
M a[96:99], a[212:215], a[236:239], a[96:99]
v_accvgpr_read_b32 v28, a72
v_accvgpr_read_b32 v29, a73
v_accvgpr_read_b32 v30, a74
M a[96:99], a[208:211], a[232:235], a[96:99]
v_accvgpr_read_b32 v31, a75
v_cvt_pk_bf16_f32 v28, v28, v29
v_cvt_pk_bf16_f32 v29, v30, v31
ds_write_b64 v124, v[28:29] offset:32
M a[100:103], a[216:219], a[232:235], a[100:103]
v_accvgpr_read_b32 v24, a76
v_accvgpr_read_b32 v25, a77
v_accvgpr_read_b32 v26, a78
M a[100:103], a[220:223], a[236:239], a[100:103]
s_waitcnt lgkmcnt(6)
v_accvgpr_read_b32 v27, a79
v_cvt_pk_bf16_f32 v24, v24, v25
v_cvt_pk_bf16_f32 v25, v26, v27
ds_write_b64 v124, v[24:25] offset:64
M a[104:107], a[204:207], a[244:247], a[104:107]
ds_read_b128 a[232:235], v12 offset:12288
ds_read_b128 a[236:239], v13 offset:12288
v_accvgpr_read_b32 v24, a80
v_accvgpr_read_b32 v25, a81
v_accvgpr_read_b32 v26, a82
M a[104:107], a[200:203], a[240:243], a[104:107]
v_accvgpr_read_b32 v27, a83
v_cvt_pk_bf16_f32 v24, v24, v25
v_cvt_pk_bf16_f32 v25, v26, v27
ds_write_b64 v124, v[24:25] offset:6400
M a[108:111], a[208:211], a[240:243], a[108:111]
v_accvgpr_read_b32 v28, a84
v_accvgpr_read_b32 v29, a85
v_accvgpr_read_b32 v30, a86
M a[108:111], a[212:215], a[244:247], a[108:111]
v_accvgpr_read_b32 v31, a87
v_cvt_pk_bf16_f32 v28, v28, v29
v_cvt_pk_bf16_f32 v29, v30, v31
ds_write_b64 v124, v[28:29] offset:6432
M a[112:115], a[220:223], a[244:247], a[112:115]
v_accvgpr_read_b32 v24, a88
v_accvgpr_read_b32 v25, a89
v_accvgpr_read_b32 v26, a90
M a[112:115], a[216:219], a[240:243], a[112:115]
s_waitcnt lgkmcnt(9)
v_accvgpr_read_b32 v27, a91
v_cvt_pk_bf16_f32 v24, v24, v25
v_cvt_pk_bf16_f32 v25, v26, v27
ds_write_b64 v124, v[24:25] offset:6464
M a[116:119], a[200:203], a[248:251], a[116:119]
ds_read_b128 a[240:243], v12 offset:14336
ds_read_b128 a[244:247], v13 offset:14336
v_accvgpr_read_b32 v24, a92
v_accvgpr_read_b32 v25, a93
v_accvgpr_read_b32 v26, a94
M a[116:119], a[204:207], a[252:255], a[116:119]
v_accvgpr_read_b32 v27, a95
v_cvt_pk_bf16_f32 v24, v24, v25
v_cvt_pk_bf16_f32 v25, v26, v27
ds_write_b64 v124, v[24:25] offset:12800
M a[120:123], a[212:215], a[252:255], a[120:123]
v_accvgpr_read_b32 v28, a96
v_accvgpr_read_b32 v29, a97
v_accvgpr_read_b32 v30, a98
M a[120:123], a[208:211], a[248:251], a[120:123]
v_accvgpr_read_b32 v31, a99
v_cvt_pk_bf16_f32 v28, v28, v29
v_cvt_pk_bf16_f32 v29, v30, v31
ds_write_b64 v124, v[28:29] offset:12832
M a[124:127], a[216:219], a[248:251], a[124:127]
v_accvgpr_read_b32 v24, a100
v_accvgpr_read_b32 v25, a101
v_accvgpr_read_b32 v26, a102
M a[124:127], a[220:223], a[252:255], a[124:127]
s_add_u32 s25, s25, 32768
s_cmp_eq_u32 s25, s27
s_cselect_b32 s25, s28, s25
s_cselect_b32 s27, s56, s27
s_cselect_b32 s28, s57, s28
s_cselect_b32 s56, -1, s56
s_waitcnt lgkmcnt(12)
v_accvgpr_read_b32 v27, a103
v_cvt_pk_bf16_f32 v24, v24, v25
v_cvt_pk_bf16_f32 v25, v26, v27
ds_write_b64 v124, v[24:25] offset:12864
M a[128:131], a[204:207], a[228:231], a[128:131]
ds_read_b128 a[248:251], v12 offset:16384
ds_read_b128 a[252:255], v13 offset:16384
v_accvgpr_read_b32 v24, a104
v_accvgpr_read_b32 v25, a105
v_accvgpr_read_b32 v26, a106
M a[128:131], a[200:203], a[224:227], a[128:131]
v_accvgpr_read_b32 v27, a107
v_cvt_pk_bf16_f32 v24, v24, v25
v_cvt_pk_bf16_f32 v25, v26, v27
ds_write_b64 v124, v[24:25] offset:19200
M a[132:135], a[208:211], a[224:227], a[132:135]
v_accvgpr_read_b32 v28, a108
v_accvgpr_read_b32 v29, a109
v_accvgpr_read_b32 v30, a110
M a[132:135], a[212:215], a[228:231], a[132:135]
v_accvgpr_read_b32 v31, a111
v_cvt_pk_bf16_f32 v28, v28, v29
v_cvt_pk_bf16_f32 v29, v30, v31
ds_write_b64 v124, v[28:29] offset:19232
M a[136:139], a[220:223], a[228:231], a[136:139]
v_accvgpr_read_b32 v24, a112
v_accvgpr_read_b32 v25, a113
v_accvgpr_read_b32 v26, a114
M a[136:139], a[216:219], a[224:227], a[136:139]
s_waitcnt lgkmcnt(12)
v_accvgpr_read_b32 v27, a115
v_cvt_pk_bf16_f32 v24, v24, v25
v_cvt_pk_bf16_f32 v25, v26, v27
ds_write_b64 v124, v[24:25] offset:19264
M a[140:143], a[200:203], a[232:235], a[140:143]
v_accvgpr_read_b32 v24, a116
v_accvgpr_read_b32 v25, a117
v_accvgpr_read_b32 v26, a118
M a[140:143], a[204:207], a[236:239], a[140:143]
v_accvgpr_read_b32 v27, a119
v_cvt_pk_bf16_f32 v24, v24, v25
v_cvt_pk_bf16_f32 v25, v26, v27
ds_write_b64 v124, v[24:25] offset:25600
M a[144:147], a[212:215], a[236:239], a[144:147]
v_accvgpr_read_b32 v28, a120
v_accvgpr_read_b32 v29, a121
v_accvgpr_read_b32 v30, a122
M a[144:147], a[208:211], a[232:235], a[144:147]
v_accvgpr_read_b32 v31, a123
v_cvt_pk_bf16_f32 v28, v28, v29
v_cvt_pk_bf16_f32 v29, v30, v31
ds_write_b64 v124, v[28:29] offset:25632
M a[148:151], a[216:219], a[232:235], a[148:151]
s_waitcnt lgkmcnt(0)
s_barrier
v_accvgpr_read_b32 v24, a124
v_accvgpr_read_b32 v25, a125
v_accvgpr_read_b32 v26, a126
M a[148:151], a[220:223], a[236:239], a[148:151]
v_accvgpr_read_b32 v27, a127
v_cvt_pk_bf16_f32 v24, v24, v25
v_cvt_pk_bf16_f32 v25, v26, v27
ds_write_b64 v124, v[24:25] offset:25664
v_accvgpr_read_b32 v24, a128
v_accvgpr_read_b32 v25, a129
v_accvgpr_read_b32 v26, a130
M a[152:155], a[204:207], a[244:247], a[152:155]
v_accvgpr_read_b32 v27, a131
v_cvt_pk_bf16_f32 v24, v24, v25
v_cvt_pk_bf16_f32 v25, v26, v27
M a[152:155], a[200:203], a[240:243], a[152:155]
ds_write_b64 v124, v[24:25] offset:32000
v_accvgpr_read_b32 v28, a132
v_accvgpr_read_b32 v29, a133
M a[156:159], a[208:211], a[240:243], a[156:159]
v_accvgpr_read_b32 v30, a134
v_accvgpr_read_b32 v31, a135
v_cvt_pk_bf16_f32 v28, v28, v29
M a[156:159], a[212:215], a[244:247], a[156:159]
v_cvt_pk_bf16_f32 v29, v30, v31
ds_write_b64 v124, v[28:29] offset:32032
v_accvgpr_read_b32 v24, a136
M a[160:163], a[220:223], a[244:247], a[160:163]
v_accvgpr_read_b32 v25, a137
v_accvgpr_read_b32 v26, a138
v_accvgpr_read_b32 v27, a139
M a[160:163], a[216:219], a[240:243], a[160:163]
v_cvt_pk_bf16_f32 v24, v24, v25
v_cvt_pk_bf16_f32 v25, v26, v27
ds_write_b64 v124, v[24:25] offset:32064
M a[164:167], a[200:203], a[248:251], a[164:167]
v_accvgpr_read_b32 v24, a140
v_accvgpr_read_b32 v25, a141
v_accvgpr_read_b32 v26, a142
M a[164:167], a[204:207], a[252:255], a[164:167]
v_accvgpr_read_b32 v27, a143
v_cvt_pk_bf16_f32 v24, v24, v25
v_cvt_pk_bf16_f32 v25, v26, v27
ds_write_b64 v124, v[24:25] offset:38400
M a[168:171], a[212:215], a[252:255], a[168:171]
v_accvgpr_read_b32 v28, a144
v_accvgpr_read_b32 v29, a145
v_accvgpr_read_b32 v30, a146
M a[168:171], a[208:211], a[248:251], a[168:171]
v_accvgpr_read_b32 v31, a147
v_cvt_pk_bf16_f32 v28, v28, v29
v_cvt_pk_bf16_f32 v29, v30, v31
ds_write_b64 v124, v[28:29] offset:38432
M a[172:175], a[216:219], a[248:251], a[172:175]
v_accvgpr_read_b32 v24, a148
v_accvgpr_read_b32 v25, a149
v_accvgpr_read_b32 v26, a150
M a[172:175], a[220:223], a[252:255], a[172:175]
v_accvgpr_read_b32 v27, a151
v_cvt_pk_bf16_f32 v24, v24, v25
v_cvt_pk_bf16_f32 v25, v26, v27
ds_write_b64 v124, v[24:25] offset:38464
s_mov_b64 s[44:45], s[42:43]
v_accvgpr_read_b32 v24, a152
v_accvgpr_read_b32 v25, a153
v_accvgpr_read_b32 v26, a154
v_accvgpr_read_b32 v27, a155
v_cvt_pk_bf16_f32 v24, v24, v25
v_cvt_pk_bf16_f32 v25, v26, v27
ds_write_b64 v124, v[24:25] offset:44800
v_accvgpr_read_b32 v28, a156
v_accvgpr_read_b32 v29, a157
v_accvgpr_read_b32 v30, a158
v_accvgpr_read_b32 v31, a159
v_cvt_pk_bf16_f32 v28, v28, v29
v_cvt_pk_bf16_f32 v29, v30, v31
ds_write_b64 v124, v[28:29] offset:44832
v_accvgpr_read_b32 v24, a160
v_accvgpr_read_b32 v25, a161
v_accvgpr_read_b32 v26, a162
v_accvgpr_read_b32 v27, a163
v_cvt_pk_bf16_f32 v24, v24, v25
v_cvt_pk_bf16_f32 v25, v26, v27
ds_write_b64 v124, v[24:25] offset:44864
v_accvgpr_read_b32 v24, a164
v_accvgpr_read_b32 v25, a165
v_accvgpr_read_b32 v26, a166
v_accvgpr_read_b32 v27, a167
v_cvt_pk_bf16_f32 v24, v24, v25
v_cvt_pk_bf16_f32 v25, v26, v27
ds_write_b64 v124, v[24:25] offset:51200
v_accvgpr_read_b32 v28, a168
v_accvgpr_read_b32 v29, a169
v_accvgpr_read_b32 v30, a170
v_accvgpr_read_b32 v31, a171
v_cvt_pk_bf16_f32 v28, v28, v29
v_cvt_pk_bf16_f32 v29, v30, v31
ds_write_b64 v124, v[28:29] offset:51232
v_accvgpr_read_b32 v24, a172
v_accvgpr_read_b32 v25, a173
v_accvgpr_read_b32 v26, a174
v_accvgpr_read_b32 v27, a175
v_cvt_pk_bf16_f32 v24, v24, v25
v_cvt_pk_bf16_f32 v25, v26, v27
ds_write_b64 v124, v[24:25] offset:51264
s_waitcnt lgkmcnt(0)
s_barrier
ds_read_b128 v[48:51], v121 offset:128
ds_read_b128 v[32:35], v120 offset:0
ds_read_b128 v[52:55], v120 offset:128
ds_read_b128 v[36:39], v120 offset:12800
ds_read_b128 v[56:59], v120 offset:12928
ds_read_b128 v[40:43], v120 offset:25600
ds_read_b128 v[60:63], v120 offset:25728
ds_read_b128 v[44:47], v120 offset:38400
ds_read_b128 v[64:67], v120 offset:38528
ds_read_b64_tr_b16 v[68:69], v123 offset:256
ds_read_b64_tr_b16 v[70:71], v122 offset:256
ds_read_b64_tr_b16 v[72:73], v122 offset:13056
ds_read_b64_tr_b16 v[74:75], v122 offset:25856
ds_read_b64_tr_b16 v[76:77], v122 offset:38656
ds_read_b64_tr_b16 v[78:79], v123 offset:288
ds_read_b64_tr_b16 v[80:81], v122 offset:288
ds_read_b64_tr_b16 v[82:83], v122 offset:13088
ds_read_b64_tr_b16 v[84:85], v122 offset:25888
ds_read_b64_tr_b16 v[86:87], v122 offset:38688
v_accvgpr_write_b32 a64, 0
v_accvgpr_write_b32 a65, 0
v_accvgpr_write_b32 a66, 0
v_accvgpr_write_b32 a67, 0
v_accvgpr_write_b32 a68, 0
v_accvgpr_write_b32 a69, 0
v_accvgpr_write_b32 a70, 0
v_accvgpr_write_b32 a71, 0
v_accvgpr_write_b32 a72, 0
v_accvgpr_write_b32 a73, 0
v_accvgpr_write_b32 a74, 0
v_accvgpr_write_b32 a75, 0
s_add_u32 m0, s29, 0
s_add_u32 s32, s25, 4096
buffer_load_dwordx4 v1, s[12:15], s25 offen offset:0 sc1 lds
v_accvgpr_write_b32 a76, 0
v_accvgpr_write_b32 a77, 0
v_accvgpr_write_b32 a78, 0
v_accvgpr_write_b32 a79, 0
v_accvgpr_write_b32 a80, 0
v_accvgpr_write_b32 a81, 0
v_accvgpr_write_b32 a82, 0
v_accvgpr_write_b32 a83, 0
v_accvgpr_write_b32 a84, 0
v_accvgpr_write_b32 a85, 0
v_accvgpr_write_b32 a86, 0
buffer_load_dwordx4 v1, s[12:15], s25 offen offset:1024 sc1 lds
v_accvgpr_write_b32 a87, 0
v_accvgpr_write_b32 a88, 0
v_accvgpr_write_b32 a89, 0
v_accvgpr_write_b32 a90, 0
v_accvgpr_write_b32 a91, 0
v_accvgpr_write_b32 a92, 0
v_accvgpr_write_b32 a93, 0
v_accvgpr_write_b32 a94, 0
v_accvgpr_write_b32 a95, 0
v_accvgpr_write_b32 a96, 0
buffer_load_dwordx4 v1, s[12:15], s25 offen offset:2048 sc1 lds
v_accvgpr_write_b32 a97, 0
v_accvgpr_write_b32 a98, 0
v_accvgpr_write_b32 a99, 0
v_accvgpr_write_b32 a100, 0
v_accvgpr_write_b32 a101, 0
v_accvgpr_write_b32 a102, 0
v_accvgpr_write_b32 a103, 0
v_accvgpr_write_b32 a104, 0
v_accvgpr_write_b32 a105, 0
v_accvgpr_write_b32 a106, 0
v_accvgpr_write_b32 a107, 0
buffer_load_dwordx4 v1, s[12:15], s25 offen offset:3072 sc1 lds
v_accvgpr_write_b32 a108, 0
v_accvgpr_write_b32 a109, 0
v_accvgpr_write_b32 a110, 0
v_accvgpr_write_b32 a111, 0
s_waitcnt lgkmcnt(15)
M v[88:91], v[48:51], v[32:35], v[152:155]
M v[92:95], v[52:55], v[32:35], v[148:151]
M v[96:99], v[52:55], v[36:39], v[144:147]
s_waitcnt lgkmcnt(14)
M v[100:103], v[56:59], v[36:39], v[148:151]
s_waitcnt lgkmcnt(13)
M v[104:107], v[56:59], v[40:43], v[144:147]
s_waitcnt lgkmcnt(12)
M v[108:111], v[60:63], v[40:43], v[148:151]
s_add_u32 m0, s29, 4096
s_nop 0
buffer_load_dwordx4 v1, s[12:15], s32 offen offset:0 sc1 lds
s_waitcnt lgkmcnt(11)
M v[112:115], v[60:63], v[44:47], v[144:147]
s_waitcnt lgkmcnt(10)
M v[116:119], v[64:67], v[44:47], v[148:151]
v_max3_f32 v136, v88, v89, v90
v_max3_f32 v136, v136, v91, v92
v_max3_f32 v136, v136, v93, v94
v_max_f32 v136, v136, v95
v_max3_f32 v137, v96, v97, v98
v_max3_f32 v137, v137, v99, v100
v_max3_f32 v137, v137, v101, v102
v_max_f32 v137, v137, v103
v_max3_f32 v138, v104, v105, v106
buffer_load_dwordx4 v1, s[12:15], s32 offen offset:1024 sc1 lds
v_max3_f32 v138, v138, v107, v108
v_max3_f32 v138, v138, v109, v110
v_max_f32 v138, v138, v111
v_max3_f32 v139, v112, v113, v114
v_max3_f32 v139, v139, v115, v116
v_max3_f32 v139, v139, v117, v118
v_max_f32 v139, v139, v119
v_mov_b32 v140, v136
v_mov_b32 v141, v137
v_mov_b32 v142, v138
buffer_load_dwordx4 v1, s[12:15], s32 offen offset:2048 sc1 lds
v_mov_b32 v143, v139
v_permlane16_swap_b32 v136, v140
v_permlane16_swap_b32 v137, v141
v_permlane16_swap_b32 v138, v142
v_permlane16_swap_b32 v139, v143
v_max_f32 v136, v136, v140
v_max_f32 v137, v137, v141
v_max_f32 v138, v138, v142
v_max_f32 v139, v139, v143
v_mov_b32 v140, v136
v_mov_b32 v141, v137
buffer_load_dwordx4 v1, s[12:15], s32 offen offset:3072 sc1 lds
v_mov_b32 v142, v138
v_mov_b32 v143, v139
v_permlane32_swap_b32 v136, v140
v_permlane32_swap_b32 v137, v141
v_permlane32_swap_b32 v138, v142
v_permlane32_swap_b32 v139, v143
v_max_f32 v136, v136, v140
v_max_f32 v137, v137, v141
v_max_f32 v138, v138, v142
v_max_f32 v139, v139, v143
s_add_u32 s25, s25, 32768
s_cmp_eq_u32 s25, s27
s_cselect_b32 s25, s28, s25
s_cselect_b32 s27, s56, s27
s_cselect_b32 s28, s57, s28
s_cselect_b32 s56, -1, s56
v_mul_f32 v136, s7, v136
v_mul_f32 v137, s7, v137
v_mul_f32 v138, s7, v138
v_mul_f32 v139, s7, v139
v_fma_f32 v88, v88, s7, -v136
v_fma_f32 v89, v89, s7, -v136
v_fma_f32 v90, v90, s7, -v136
v_fma_f32 v91, v91, s7, -v136
v_fma_f32 v92, v92, s7, -v136
v_fma_f32 v93, v93, s7, -v136
v_fma_f32 v94, v94, s7, -v136
s_add_u32 m0, s29, 32768
s_add_u32 s32, s26, 4096
buffer_load_dwordx4 v1, s[12:15], s26 offen offset:0 sc1 lds
v_fma_f32 v95, v95, s7, -v136
v_exp_f32 v88, v88
v_exp_f32 v89, v89
v_exp_f32 v90, v90
v_exp_f32 v91, v91
v_exp_f32 v92, v92
v_exp_f32 v93, v93
v_exp_f32 v94, v94
v_exp_f32 v95, v95
v_fma_f32 v96, v96, s7, -v137
v_fma_f32 v97, v97, s7, -v137
buffer_load_dwordx4 v1, s[12:15], s26 offen offset:1024 sc1 lds
v_fma_f32 v98, v98, s7, -v137
v_fma_f32 v99, v99, s7, -v137
v_fma_f32 v100, v100, s7, -v137
v_fma_f32 v101, v101, s7, -v137
v_fma_f32 v102, v102, s7, -v137
v_fma_f32 v103, v103, s7, -v137
v_exp_f32 v96, v96
v_exp_f32 v97, v97
v_exp_f32 v98, v98
v_exp_f32 v99, v99
buffer_load_dwordx4 v1, s[12:15], s26 offen offset:2048 sc1 lds
v_exp_f32 v100, v100
v_exp_f32 v101, v101
v_exp_f32 v102, v102
v_exp_f32 v103, v103
v_fma_f32 v104, v104, s7, -v138
v_fma_f32 v105, v105, s7, -v138
v_fma_f32 v106, v106, s7, -v138
v_fma_f32 v107, v107, s7, -v138
v_fma_f32 v108, v108, s7, -v138
v_fma_f32 v109, v109, s7, -v138
v_fma_f32 v110, v110, s7, -v138
buffer_load_dwordx4 v1, s[12:15], s26 offen offset:3072 sc1 lds
v_fma_f32 v111, v111, s7, -v138
v_exp_f32 v104, v104
v_exp_f32 v105, v105
v_exp_f32 v106, v106
v_exp_f32 v107, v107
v_exp_f32 v108, v108
v_exp_f32 v109, v109
v_exp_f32 v110, v110
v_exp_f32 v111, v111
v_fma_f32 v112, v112, s7, -v139
s_add_u32 m0, s29, 36864
s_nop 0
buffer_load_dwordx4 v1, s[12:15], s32 offen offset:0 sc1 lds
v_fma_f32 v113, v113, s7, -v139
v_fma_f32 v114, v114, s7, -v139
v_fma_f32 v115, v115, s7, -v139
v_fma_f32 v116, v116, s7, -v139
v_fma_f32 v117, v117, s7, -v139
v_fma_f32 v118, v118, s7, -v139
v_fma_f32 v119, v119, s7, -v139
v_exp_f32 v112, v112
v_exp_f32 v113, v113
v_exp_f32 v114, v114
v_exp_f32 v115, v115
buffer_load_dwordx4 v1, s[12:15], s32 offen offset:1024 sc1 lds
v_exp_f32 v116, v116
v_exp_f32 v117, v117
v_exp_f32 v118, v118
v_exp_f32 v119, v119
v_cvt_pk_bf16_f32 v88, v88, v89
v_cvt_pk_bf16_f32 v89, v90, v91
v_cvt_pk_bf16_f32 v90, v92, v93
v_cvt_pk_bf16_f32 v91, v94, v95
v_cvt_pk_bf16_f32 v96, v96, v97
v_cvt_pk_bf16_f32 v97, v98, v99
buffer_load_dwordx4 v1, s[12:15], s32 offen offset:2048 sc1 lds
v_cvt_pk_bf16_f32 v98, v100, v101
v_cvt_pk_bf16_f32 v99, v102, v103
v_cvt_pk_bf16_f32 v104, v104, v105
v_cvt_pk_bf16_f32 v105, v106, v107
v_cvt_pk_bf16_f32 v106, v108, v109
v_cvt_pk_bf16_f32 v107, v110, v111
v_cvt_pk_bf16_f32 v112, v112, v113
v_cvt_pk_bf16_f32 v113, v114, v115
v_cvt_pk_bf16_f32 v114, v116, v117
v_cvt_pk_bf16_f32 v115, v118, v119
M v[120:123], v[156:159], v[88:91], 0
buffer_load_dwordx4 v1, s[12:15], s32 offen offset:3072 sc1 lds
s_waitcnt lgkmcnt(8)
M v[32:35], v[68:71], v[88:91], 0
s_waitcnt lgkmcnt(3)
M v[36:39], v[78:81], v[88:91], 0
M v[124:127], v[156:159], v[96:99], 0
M v[40:43], v[70:73], v[96:99], 0
s_waitcnt lgkmcnt(2)
M v[44:47], v[80:83], v[96:99], 0
M v[128:131], v[156:159], v[104:107], 0
M v[48:51], v[72:75], v[104:107], 0
s_waitcnt lgkmcnt(1)
M v[52:55], v[82:85], v[104:107], 0
M v[132:135], v[156:159], v[112:115], 0
M v[56:59], v[74:77], v[112:115], 0
s_add_u32 s26, s26, 32768
s_cmp_eq_u32 s26, s62
s_cselect_b32 s26, s63, s26
s_cselect_b32 s62, s58, s62
s_cselect_b32 s63, s59, s63
s_cselect_b32 s58, -1, s58
s_waitcnt lgkmcnt(0)
M v[60:63], v[84:87], v[112:115], 0
v_rcp_f32 v120, v120
v_rcp_f32 v124, v124
v_rcp_f32 v128, v128
v_rcp_f32 v132, v132
v_pk_mul_f32 v[32:33], v[32:33], v[120:121] op_sel_hi:[1,0]
v_pk_mul_f32 v[34:35], v[34:35], v[120:121] op_sel_hi:[1,0]
v_pk_mul_f32 v[36:37], v[36:37], v[120:121] op_sel_hi:[1,0]
v_pk_mul_f32 v[38:39], v[38:39], v[120:121] op_sel_hi:[1,0]
v_cvt_pk_bf16_f32 v32, v32, v33
v_cvt_pk_bf16_f32 v33, v34, v35
v_cvt_pk_bf16_f32 v34, v36, v37
v_cvt_pk_bf16_f32 v35, v38, v39
s_add_u32 s3, s6, 0
buffer_store_dwordx4 v[32:35], v1, s[16:19], s3 offen sc1
v_pk_mul_f32 v[40:41], v[40:41], v[124:125] op_sel_hi:[1,0]
v_pk_mul_f32 v[42:43], v[42:43], v[124:125] op_sel_hi:[1,0]
v_pk_mul_f32 v[44:45], v[44:45], v[124:125] op_sel_hi:[1,0]
v_pk_mul_f32 v[46:47], v[46:47], v[124:125] op_sel_hi:[1,0]
v_cvt_pk_bf16_f32 v40, v40, v41
v_cvt_pk_bf16_f32 v41, v42, v43
v_cvt_pk_bf16_f32 v42, v44, v45
v_cvt_pk_bf16_f32 v43, v46, v47
s_add_u32 s3, s6, 2048
buffer_store_dwordx4 v[40:43], v1, s[16:19], s3 offen sc1
v_pk_mul_f32 v[48:49], v[48:49], v[128:129] op_sel_hi:[1,0]
v_pk_mul_f32 v[50:51], v[50:51], v[128:129] op_sel_hi:[1,0]
v_pk_mul_f32 v[52:53], v[52:53], v[128:129] op_sel_hi:[1,0]
v_pk_mul_f32 v[54:55], v[54:55], v[128:129] op_sel_hi:[1,0]
v_cvt_pk_bf16_f32 v48, v48, v49
v_cvt_pk_bf16_f32 v49, v50, v51
v_cvt_pk_bf16_f32 v50, v52, v53
v_cvt_pk_bf16_f32 v51, v54, v55
s_add_u32 s3, s6, 4096
buffer_store_dwordx4 v[48:51], v1, s[16:19], s3 offen sc1
v_pk_mul_f32 v[56:57], v[56:57], v[132:133] op_sel_hi:[1,0]
v_pk_mul_f32 v[58:59], v[58:59], v[132:133] op_sel_hi:[1,0]
v_pk_mul_f32 v[60:61], v[60:61], v[132:133] op_sel_hi:[1,0]
v_pk_mul_f32 v[62:63], v[62:63], v[132:133] op_sel_hi:[1,0]
v_cvt_pk_bf16_f32 v56, v56, v57
v_cvt_pk_bf16_f32 v57, v58, v59
v_cvt_pk_bf16_f32 v58, v60, v61
v_cvt_pk_bf16_f32 v59, v62, v63
s_add_u32 s3, s6, 6144
buffer_store_dwordx4 v[56:59], v1, s[16:19], s3 offen sc1
Lc2:
s_add_u32 s16, s4, 67108864
s_addc_u32 s17, s5, 0
s_mov_b32 s18, 16777216
s_mov_b32 s19, 0x00020000
s_add_u32 s52, s4, 100663296
s_addc_u32 s53, s5, 0
s_mov_b32 s54, 16793600
s_mov_b32 s55, 0x00020000
s_mov_b32 s46, 8388608
s_mov_b32 s47, 0x00020000
s_mov_b32 s50, 2097152
s_mov_b32 s51, 0x00020000
s_lshl_b32 s33, s24, 14
v_add_u32 v2, 0, v1
v_add_u32 v3, 0x10000, v2
v_mov_b32 v5, v2
v_mov_b32 v6, v3
v_and_b32 v8, 15, v0
v_bfe_u32 v9, v0, 4, 2
v_lshlrev_b32 v9, 2, v9
v_sub_u32 v8, v8, v9
v_mov_b32 v4, 0xf149f2ca
v_cmp_gt_i32 vcc, 0, v8
s_nop 1
v_cndmask_b32 v16, 0, v4, vcc
v_cmp_gt_i32 vcc, 1, v8
s_nop 1
v_cndmask_b32 v17, 0, v4, vcc
v_cmp_gt_i32 vcc, 2, v8
s_nop 1
v_cndmask_b32 v18, 0, v4, vcc
v_cmp_gt_i32 vcc, 3, v8
s_nop 1
v_cndmask_b32 v19, 0, v4, vcc
v_mov_b32 v8, 0x3f803f80
v_accvgpr_write_b32 a112, v8
v_accvgpr_write_b32 a113, v8
v_accvgpr_write_b32 a114, v8
v_accvgpr_write_b32 a115, v8
s_lshl_b32 s33, s23, 6
s_add_i32 s33, s33, s31
s_cmp_gt_i32 s33, 0
s_cselect_b32 s34, 0, 0xf149f2ca
s_cmp_lt_i32 s33, 0
s_cselect_b32 s33, 0xf149f2ca, 0
v_mov_b32 v20, s34
v_mov_b32 v21, s34
v_mov_b32 v22, s34
v_mov_b32 v23, s34
v_mov_b32 v28, s33
v_mov_b32 v29, s33
v_mov_b32 v30, s33
v_mov_b32 v31, s33
v_med3_f32 v24, v16, v20, v28
v_med3_f32 v25, v17, v20, v28
v_med3_f32 v26, v18, v20, v28
v_med3_f32 v27, v19, v20, v28
v_mov_b32 v12, 0
v_mov_b32 v13, 1
s_waitcnt vmcnt(20)
s_barrier
ds_read_b128 a[116:119], v3 offset:0
ds_read_b128 a[120:123], v3 offset:1024
ds_read_b128 a[124:127], v3 offset:2048
ds_read_b128 a[128:131], v3 offset:3072
ds_read_b128 a[132:135], v3 offset:4096
ds_read_b128 a[136:139], v3 offset:5120
ds_read_b128 a[140:143], v3 offset:6144
ds_read_b128 a[144:147], v3 offset:7168
s_waitcnt lgkmcnt(4)
M v[32:35], a[116:119], a[0:3], v[24:27]
M v[32:35], a[120:123], a[4:7], v[32:35]
ds_read_b128 a[148:151], v3 offset:8192
ds_read_b128 a[152:155], v3 offset:9216
M v[32:35], a[124:127], a[8:11], v[32:35]
M v[32:35], a[128:131], a[12:15], v[32:35]
M v[36:39], a[128:131], a[28:31], v[28:31]
M v[36:39], a[124:127], a[24:27], v[36:39]
M v[36:39], a[120:123], a[20:23], v[36:39]
M v[36:39], a[116:119], a[16:19], v[36:39]
M v[40:43], a[116:119], a[32:35], v[28:31]
M v[40:43], a[120:123], a[36:39], v[40:43]
ds_read_b128 a[156:159], v3 offset:10240
ds_read_b128 a[160:163], v3 offset:11264
M v[40:43], a[124:127], a[40:43], v[40:43]
M v[40:43], a[128:131], a[44:47], v[40:43]
M v[44:47], a[128:131], a[60:63], v[28:31]
M v[44:47], a[124:127], a[56:59], v[44:47]
M v[44:47], a[120:123], a[52:55], v[44:47]
M v[44:47], a[116:119], a[48:51], v[44:47]
s_waitcnt lgkmcnt(4)
M v[48:51], a[132:135], a[0:3], v[20:23]
M v[48:51], a[136:139], a[4:7], v[48:51]
ds_read_b128 a[164:167], v3 offset:12288
ds_read_b128 a[168:171], v3 offset:13312
M v[48:51], a[140:143], a[8:11], v[48:51]
M v[48:51], a[144:147], a[12:15], v[48:51]
M v[52:55], a[144:147], a[28:31], v[24:27]
M v[52:55], a[140:143], a[24:27], v[52:55]
M v[52:55], a[136:139], a[20:23], v[52:55]
M v[52:55], a[132:135], a[16:19], v[52:55]
M v[56:59], a[132:135], a[32:35], v[28:31]
M v[56:59], a[136:139], a[36:39], v[56:59]
ds_read_b128 a[172:175], v3 offset:14336
ds_read_b128 a[176:179], v3 offset:15360
M v[56:59], a[140:143], a[40:43], v[56:59]
M v[56:59], a[144:147], a[44:47], v[56:59]
M v[60:63], a[144:147], a[60:63], v[28:31]
M v[60:63], a[140:143], a[56:59], v[60:63]
M v[60:63], a[136:139], a[52:55], v[60:63]
M v[60:63], a[132:135], a[48:51], v[60:63]
s_waitcnt lgkmcnt(4)
M v[64:67], a[148:151], a[0:3], v[20:23]
M v[64:67], a[152:155], a[4:7], v[64:67]
M v[64:67], a[156:159], a[8:11], v[64:67]
M v[64:67], a[160:163], a[12:15], v[64:67]
M v[68:71], a[160:163], a[28:31], v[20:23]
M v[68:71], a[156:159], a[24:27], v[68:71]
M v[68:71], a[152:155], a[20:23], v[68:71]
M v[68:71], a[148:151], a[16:19], v[68:71]
M v[72:75], a[148:151], a[32:35], v[24:27]
M v[72:75], a[152:155], a[36:39], v[72:75]
M v[72:75], a[156:159], a[40:43], v[72:75]
M v[72:75], a[160:163], a[44:47], v[72:75]
M v[76:79], a[160:163], a[60:63], v[28:31]
M v[76:79], a[156:159], a[56:59], v[76:79]
s_waitcnt vmcnt(4) lgkmcnt(0)
s_barrier
ds_read_b128 a[116:119], v2 offset:0
ds_read_b128 a[120:123], v2 offset:1024
M v[76:79], a[152:155], a[52:55], v[76:79]
M v[76:79], a[148:151], a[48:51], v[76:79]
M v[80:83], a[164:167], a[0:3], v[20:23]
M v[80:83], a[168:171], a[4:7], v[80:83]
ds_read_b128 a[124:127], v2 offset:2048
ds_read_b128 a[128:131], v2 offset:3072
M v[80:83], a[172:175], a[8:11], v[80:83]
M v[80:83], a[176:179], a[12:15], v[80:83]
M v[84:87], a[176:179], a[28:31], v[20:23]
M v[84:87], a[172:175], a[24:27], v[84:87]
ds_read_b128 a[132:135], v2 offset:4096
ds_read_b128 a[136:139], v2 offset:5120
M v[84:87], a[168:171], a[20:23], v[84:87]
M v[84:87], a[164:167], a[16:19], v[84:87]
M v[88:91], a[164:167], a[32:35], v[20:23]
M v[88:91], a[168:171], a[36:39], v[88:91]
ds_read_b128 a[140:143], v2 offset:6144
ds_read_b128 a[144:147], v2 offset:7168
M v[88:91], a[172:175], a[40:43], v[88:91]
M v[88:91], a[176:179], a[44:47], v[88:91]
M v[92:95], a[176:179], a[60:63], v[24:27]
M v[92:95], a[172:175], a[56:59], v[92:95]
M v[92:95], a[168:171], a[52:55], v[92:95]
M v[92:95], a[164:167], a[48:51], v[92:95]
s_waitcnt vmcnt(0)
s_mov_b64 exec, 1
buffer_store_dword v13, v12, s[52:55], s65 offen sc1
s_mov_b64 exec, -1
v_exp_f32 v32, v32
v_exp_f32 v33, v33
v_exp_f32 v34, v34
v_exp_f32 v35, v35
v_exp_f32 v48, v48
v_exp_f32 v49, v49
v_exp_f32 v50, v50
v_exp_f32 v51, v51
v_cvt_pk_bf16_f32 v32, v32, v33
v_cvt_pk_bf16_f32 v33, v34, v35
v_exp_f32 v36, v36
v_exp_f32 v37, v37
v_exp_f32 v38, v38
v_exp_f32 v39, v39
v_cvt_pk_bf16_f32 v34, v48, v49
v_cvt_pk_bf16_f32 v35, v50, v51
v_exp_f32 v52, v52
v_exp_f32 v53, v53
v_exp_f32 v54, v54
v_exp_f32 v55, v55
v_cvt_pk_bf16_f32 v36, v36, v37
v_cvt_pk_bf16_f32 v37, v38, v39
v_exp_f32 v40, v40
v_exp_f32 v41, v41
v_exp_f32 v42, v42
v_exp_f32 v43, v43
v_cvt_pk_bf16_f32 v38, v52, v53
v_cvt_pk_bf16_f32 v39, v54, v55
v_exp_f32 v56, v56
v_exp_f32 v57, v57
v_exp_f32 v58, v58
v_exp_f32 v59, v59
v_cvt_pk_bf16_f32 v40, v40, v41
v_cvt_pk_bf16_f32 v41, v42, v43
v_exp_f32 v44, v44
v_exp_f32 v45, v45
v_exp_f32 v46, v46
v_exp_f32 v47, v47
v_cvt_pk_bf16_f32 v42, v56, v57
v_cvt_pk_bf16_f32 v43, v58, v59
v_exp_f32 v60, v60
v_exp_f32 v61, v61
v_exp_f32 v62, v62
v_exp_f32 v63, v63
v_cvt_pk_bf16_f32 v44, v44, v45
v_cvt_pk_bf16_f32 v45, v46, v47
v_cvt_pk_bf16_f32 v46, v60, v61
v_cvt_pk_bf16_f32 v47, v62, v63
s_cmp_eq_u32 s24, 1
s_cbranch_scc1 Lk2_g1
s_mov_b32 s30, s21
s_cmp_eq_u32 s21, 0
s_cbranch_scc1 Lk2_m2
Lk2_l1:
s_add_u32 m0, s29, 65536
s_waitcnt lgkmcnt(4)
M v[96:99], a[116:119], a[0:3], 0
v_exp_f32 v64, v64
M v[96:99], a[120:123], a[4:7], v[96:99]
ds_read_b128 a[148:151], v2 offset:8192
ds_read_b128 a[152:155], v2 offset:9216
M v[96:99], a[124:127], a[8:11], v[96:99]
v_exp_f32 v65, v65
M v[96:99], a[128:131], a[12:15], v[96:99]
buffer_load_dwordx4 v1, s[12:15], s25 offen offset:0 sc1 lds
s_add_u32 s32, s25, 4096
M v[100:103], a[128:131], a[28:31], 0
v_exp_f32 v66, v66
M v[100:103], a[124:127], a[24:27], v[100:103]
v_cvt_pk_bf16_f32 v64, v64, v65
M v[100:103], a[120:123], a[20:23], v[100:103]
v_exp_f32 v67, v67
M v[100:103], a[116:119], a[16:19], v[100:103]
buffer_load_dwordx4 v1, s[12:15], s25 offen offset:1024 sc1 lds
M v[104:107], a[116:119], a[32:35], 0
v_exp_f32 v80, v80
M v[104:107], a[120:123], a[36:39], v[104:107]
ds_read_b128 a[156:159], v2 offset:10240
ds_read_b128 a[160:163], v2 offset:11264
M v[104:107], a[124:127], a[40:43], v[104:107]
v_exp_f32 v81, v81
M v[104:107], a[128:131], a[44:47], v[104:107]
buffer_load_dwordx4 v1, s[12:15], s25 offen offset:2048 sc1 lds
M v[108:111], a[128:131], a[60:63], 0
v_exp_f32 v82, v82
M v[108:111], a[124:127], a[56:59], v[108:111]
v_cvt_pk_bf16_f32 v65, v66, v67
v_cvt_pk_bf16_f32 v66, v80, v81
M v[108:111], a[120:123], a[52:55], v[108:111]
v_exp_f32 v83, v83
M v[108:111], a[116:119], a[48:51], v[108:111]
buffer_load_dwordx4 v1, s[12:15], s25 offen offset:3072 sc1 lds
s_add_u32 m0, s29, 69632
s_waitcnt lgkmcnt(4)
M v[112:115], a[132:135], a[0:3], 0
v_exp_f32 v68, v68
M v[112:115], a[136:139], a[4:7], v[112:115]
ds_read_b128 a[164:167], v2 offset:12288
ds_read_b128 a[168:171], v2 offset:13312
M v[112:115], a[140:143], a[8:11], v[112:115]
v_exp_f32 v69, v69
M v[112:115], a[144:147], a[12:15], v[112:115]
buffer_load_dwordx4 v1, s[12:15], s32 offen offset:0 sc1 lds
M v[116:119], a[144:147], a[28:31], 0
v_exp_f32 v70, v70
M v[116:119], a[140:143], a[24:27], v[116:119]
v_cvt_pk_bf16_f32 v67, v82, v83
v_cvt_pk_bf16_f32 v68, v68, v69
M v[116:119], a[136:139], a[20:23], v[116:119]
v_exp_f32 v71, v71
M v[116:119], a[132:135], a[16:19], v[116:119]
buffer_load_dwordx4 v1, s[12:15], s32 offen offset:1024 sc1 lds
M v[120:123], a[132:135], a[32:35], 0
v_exp_f32 v84, v84
M v[120:123], a[136:139], a[36:39], v[120:123]
ds_read_b128 a[172:175], v2 offset:14336
ds_read_b128 a[176:179], v2 offset:15360
M v[120:123], a[140:143], a[40:43], v[120:123]
v_exp_f32 v85, v85
M v[120:123], a[144:147], a[44:47], v[120:123]
buffer_load_dwordx4 v1, s[12:15], s32 offen offset:2048 sc1 lds
M v[124:127], a[144:147], a[60:63], 0
v_exp_f32 v86, v86
M v[124:127], a[140:143], a[56:59], v[124:127]
v_cvt_pk_bf16_f32 v69, v70, v71
v_cvt_pk_bf16_f32 v70, v84, v85
M v[124:127], a[136:139], a[52:55], v[124:127]
v_exp_f32 v87, v87
M v[124:127], a[132:135], a[48:51], v[124:127]
buffer_load_dwordx4 v1, s[12:15], s32 offen offset:3072 sc1 lds
s_add_u32 m0, s29, 98304
s_waitcnt lgkmcnt(4)
M v[128:131], a[148:151], a[0:3], 0
v_exp_f32 v72, v72
M v[128:131], a[152:155], a[4:7], v[128:131]
ds_read_b128 a[116:119], v5 offset:32768
ds_read_b128 a[120:123], v5 offset:40960
M v[128:131], a[156:159], a[8:11], v[128:131]
v_exp_f32 v73, v73
M v[128:131], a[160:163], a[12:15], v[128:131]
buffer_load_dwordx4 v1, s[12:15], s26 offen offset:0 sc1 lds
s_add_u32 s43, s26, 4096
M v[132:135], a[160:163], a[28:31], 0
v_exp_f32 v74, v74
M v[132:135], a[156:159], a[24:27], v[132:135]
v_cvt_pk_bf16_f32 v71, v86, v87
v_cvt_pk_bf16_f32 v72, v72, v73
M v[132:135], a[152:155], a[20:23], v[132:135]
v_exp_f32 v75, v75
M v[132:135], a[148:151], a[16:19], v[132:135]
buffer_load_dwordx4 v1, s[12:15], s26 offen offset:1024 sc1 lds
M v[136:139], a[148:151], a[32:35], 0
v_exp_f32 v88, v88
M v[136:139], a[152:155], a[36:39], v[136:139]
ds_read_b128 a[124:127], v5 offset:33792
ds_read_b128 a[128:131], v5 offset:41984
M v[136:139], a[156:159], a[40:43], v[136:139]
v_exp_f32 v89, v89
M v[136:139], a[160:163], a[44:47], v[136:139]
buffer_load_dwordx4 v1, s[12:15], s26 offen offset:2048 sc1 lds
M v[140:143], a[160:163], a[60:63], 0
v_exp_f32 v90, v90
M v[140:143], a[156:159], a[56:59], v[140:143]
v_cvt_pk_bf16_f32 v73, v74, v75
v_cvt_pk_bf16_f32 v74, v88, v89
M v[140:143], a[152:155], a[52:55], v[140:143]
v_exp_f32 v91, v91
M v[140:143], a[148:151], a[48:51], v[140:143]
buffer_load_dwordx4 v1, s[12:15], s26 offen offset:3072 sc1 lds
s_add_u32 m0, s29, 102400
s_waitcnt lgkmcnt(4)
M v[144:147], a[164:167], a[0:3], 0
v_exp_f32 v76, v76
M v[144:147], a[168:171], a[4:7], v[144:147]
ds_read_b128 a[132:135], v5 offset:34816
ds_read_b128 a[136:139], v5 offset:43008
M v[144:147], a[172:175], a[8:11], v[144:147]
v_exp_f32 v77, v77
M v[144:147], a[176:179], a[12:15], v[144:147]
buffer_load_dwordx4 v1, s[12:15], s43 offen offset:0 sc1 lds
M v[148:151], a[176:179], a[28:31], 0
v_exp_f32 v78, v78
M v[148:151], a[172:175], a[24:27], v[148:151]
v_cvt_pk_bf16_f32 v75, v90, v91
v_cvt_pk_bf16_f32 v76, v76, v77
M v[148:151], a[168:171], a[20:23], v[148:151]
v_exp_f32 v79, v79
M v[148:151], a[164:167], a[16:19], v[148:151]
buffer_load_dwordx4 v1, s[12:15], s43 offen offset:1024 sc1 lds
M v[152:155], a[164:167], a[32:35], 0
v_exp_f32 v92, v92
M v[152:155], a[168:171], a[36:39], v[152:155]
ds_read_b128 a[140:143], v5 offset:35840
ds_read_b128 a[144:147], v5 offset:44032
M v[152:155], a[172:175], a[40:43], v[152:155]
v_exp_f32 v93, v93
M v[152:155], a[176:179], a[44:47], v[152:155]
buffer_load_dwordx4 v1, s[12:15], s43 offen offset:2048 sc1 lds
M v[156:159], a[176:179], a[60:63], 0
v_exp_f32 v94, v94
M v[156:159], a[172:175], a[56:59], v[156:159]
v_cvt_pk_bf16_f32 v77, v78, v79
v_cvt_pk_bf16_f32 v78, v92, v93
M v[156:159], a[168:171], a[52:55], v[156:159]
v_exp_f32 v95, v95
M v[156:159], a[164:167], a[48:51], v[156:159]
buffer_load_dwordx4 v1, s[12:15], s43 offen offset:3072 sc1 lds
v_cvt_pk_bf16_f32 v79, v94, v95
s_waitcnt lgkmcnt(6)
M v[160:163], a[116:119], v[32:35], v[160:163]
v_exp_f32 v96, v96
M v[160:163], a[120:123], v[64:67], v[160:163]
ds_read_b128 a[148:151], v5 offset:36864
ds_read_b128 a[152:155], v5 offset:45056
M v[164:167], a[120:123], v[68:71], v[164:167]
v_exp_f32 v97, v97
M v[164:167], a[116:119], v[36:39], v[164:167]
v_cvt_pk_bf16_f32 v96, v96, v97
M v[168:171], a[116:119], v[40:43], v[168:171]
v_exp_f32 v98, v98
M v[168:171], a[120:123], v[72:75], v[168:171]
s_add_u32 s25, s25, 32768
s_cmp_eq_u32 s25, s27
M v[172:175], a[120:123], v[76:79], v[172:175]
v_exp_f32 v99, v99
M v[172:175], a[116:119], v[44:47], v[172:175]
v_cvt_pk_bf16_f32 v97, v98, v99
s_waitcnt lgkmcnt(6)
M a[96:99], a[112:115], v[32:35], a[96:99]
s_cselect_b32 s25, s28, s25
s_cselect_b32 s27, -1, s27
M a[96:99], a[112:115], v[64:67], a[96:99]
s_add_u32 s26, s26, 32768
s_cmp_eq_u32 s26, s62
M v[176:179], a[124:127], v[32:35], v[176:179]
v_exp_f32 v112, v112
M v[176:179], a[128:131], v[64:67], v[176:179]
ds_read_b128 a[156:159], v5 offset:37888
ds_read_b128 a[160:163], v5 offset:46080
M v[180:183], a[128:131], v[68:71], v[180:183]
v_exp_f32 v113, v113
M v[180:183], a[124:127], v[36:39], v[180:183]
v_cvt_pk_bf16_f32 v98, v112, v113
M v[184:187], a[124:127], v[40:43], v[184:187]
v_exp_f32 v114, v114
M v[184:187], a[128:131], v[72:75], v[184:187]
s_cselect_b32 s26, s63, s26
s_cselect_b32 s62, -1, s62
M v[188:191], a[128:131], v[76:79], v[188:191]
v_exp_f32 v115, v115
M v[188:191], a[124:127], v[44:47], v[188:191]
v_cvt_pk_bf16_f32 v99, v114, v115
s_waitcnt lgkmcnt(6)
M a[100:103], a[112:115], v[36:39], a[100:103]
M a[100:103], a[112:115], v[68:71], a[100:103]
M v[192:195], a[132:135], v[32:35], v[192:195]
v_exp_f32 v100, v100
M v[192:195], a[136:139], v[64:67], v[192:195]
ds_read_b128 a[164:167], v5 offset:38912
ds_read_b128 a[168:171], v5 offset:47104
M v[196:199], a[136:139], v[68:71], v[196:199]
v_exp_f32 v101, v101
M v[196:199], a[132:135], v[36:39], v[196:199]
v_cvt_pk_bf16_f32 v100, v100, v101
M v[200:203], a[132:135], v[40:43], v[200:203]
v_exp_f32 v102, v102
M v[200:203], a[136:139], v[72:75], v[200:203]
M v[204:207], a[136:139], v[76:79], v[204:207]
v_exp_f32 v103, v103
M v[204:207], a[132:135], v[44:47], v[204:207]
v_cvt_pk_bf16_f32 v101, v102, v103
s_waitcnt lgkmcnt(6)
M a[104:107], a[112:115], v[40:43], a[104:107]
M a[104:107], a[112:115], v[72:75], a[104:107]
M v[208:211], a[140:143], v[32:35], v[208:211]
v_exp_f32 v116, v116
M v[208:211], a[144:147], v[64:67], v[208:211]
ds_read_b128 a[172:175], v5 offset:39936
ds_read_b128 a[176:179], v5 offset:48128
M v[212:215], a[144:147], v[68:71], v[212:215]
v_exp_f32 v117, v117
M v[212:215], a[140:143], v[36:39], v[212:215]
v_cvt_pk_bf16_f32 v102, v116, v117
M v[216:219], a[140:143], v[40:43], v[216:219]
v_exp_f32 v118, v118
M v[216:219], a[144:147], v[72:75], v[216:219]
M v[220:223], a[144:147], v[76:79], v[220:223]
v_exp_f32 v119, v119
M v[220:223], a[140:143], v[44:47], v[220:223]
v_cvt_pk_bf16_f32 v103, v118, v119
s_waitcnt lgkmcnt(6)
M a[108:111], a[112:115], v[44:47], a[108:111]
M a[108:111], a[112:115], v[76:79], a[108:111]
M v[224:227], a[148:151], v[32:35], v[224:227]
v_exp_f32 v104, v104
M v[224:227], a[152:155], v[64:67], v[224:227]
M v[228:231], a[152:155], v[68:71], v[228:231]
v_exp_f32 v105, v105
M v[228:231], a[148:151], v[36:39], v[228:231]
v_cvt_pk_bf16_f32 v104, v104, v105
M v[232:235], a[148:151], v[40:43], v[232:235]
v_exp_f32 v106, v106
M v[232:235], a[152:155], v[72:75], v[232:235]
M v[236:239], a[152:155], v[76:79], v[236:239]
v_exp_f32 v107, v107
M v[236:239], a[148:151], v[44:47], v[236:239]
v_cvt_pk_bf16_f32 v105, v106, v107
s_waitcnt lgkmcnt(4)
M v[240:243], a[156:159], v[32:35], v[240:243]
v_exp_f32 v120, v120
M v[240:243], a[160:163], v[64:67], v[240:243]
M v[244:247], a[160:163], v[68:71], v[244:247]
v_exp_f32 v121, v121
M v[244:247], a[156:159], v[36:39], v[244:247]
v_cvt_pk_bf16_f32 v106, v120, v121
M v[248:251], a[156:159], v[40:43], v[248:251]
v_exp_f32 v122, v122
M v[248:251], a[160:163], v[72:75], v[248:251]
s_waitcnt vmcnt(0) lgkmcnt(0)
s_barrier
ds_read_b128 a[116:119], v3 offset:0
ds_read_b128 a[120:123], v3 offset:1024
M v[252:255], a[160:163], v[76:79], v[252:255]
v_exp_f32 v123, v123
M v[252:255], a[156:159], v[44:47], v[252:255]
v_cvt_pk_bf16_f32 v107, v122, v123
M a[64:67], a[164:167], v[32:35], a[64:67]
v_exp_f32 v108, v108
M a[64:67], a[168:171], v[64:67], a[64:67]
ds_read_b128 a[124:127], v3 offset:2048
ds_read_b128 a[128:131], v3 offset:3072
M a[68:71], a[168:171], v[68:71], a[68:71]
v_exp_f32 v109, v109
M a[68:71], a[164:167], v[36:39], a[68:71]
v_cvt_pk_bf16_f32 v108, v108, v109
M a[72:75], a[164:167], v[40:43], a[72:75]
v_exp_f32 v110, v110
M a[72:75], a[168:171], v[72:75], a[72:75]
ds_read_b128 a[132:135], v3 offset:4096
ds_read_b128 a[136:139], v3 offset:5120
M a[76:79], a[168:171], v[76:79], a[76:79]
v_exp_f32 v111, v111
M a[76:79], a[164:167], v[44:47], a[76:79]
v_cvt_pk_bf16_f32 v109, v110, v111
M a[80:83], a[172:175], v[32:35], a[80:83]
v_exp_f32 v124, v124
M a[80:83], a[176:179], v[64:67], a[80:83]
ds_read_b128 a[140:143], v3 offset:6144
ds_read_b128 a[144:147], v3 offset:7168
M a[84:87], a[176:179], v[68:71], a[84:87]
v_exp_f32 v125, v125
M a[84:87], a[172:175], v[36:39], a[84:87]
v_cvt_pk_bf16_f32 v110, v124, v125
M a[88:91], a[172:175], v[40:43], a[88:91]
v_exp_f32 v126, v126
M a[88:91], a[176:179], v[72:75], a[88:91]
M a[92:95], a[176:179], v[76:79], a[92:95]
v_exp_f32 v127, v127
M a[92:95], a[172:175], v[44:47], a[92:95]
v_cvt_pk_bf16_f32 v111, v126, v127
s_sub_u32 s30, s30, 1
s_cmp_eq_u32 s30, 0
s_cbranch_scc1 Lk2_m1
s_add_u32 m0, s29, 0
s_waitcnt lgkmcnt(4)
M v[32:35], a[116:119], a[0:3], 0
v_exp_f32 v128, v128
M v[32:35], a[120:123], a[4:7], v[32:35]
ds_read_b128 a[148:151], v3 offset:8192
ds_read_b128 a[152:155], v3 offset:9216
M v[32:35], a[124:127], a[8:11], v[32:35]
v_exp_f32 v129, v129
M v[32:35], a[128:131], a[12:15], v[32:35]
buffer_load_dwordx4 v1, s[12:15], s25 offen offset:0 sc1 lds
s_add_u32 s32, s25, 4096
M v[36:39], a[128:131], a[28:31], 0
v_exp_f32 v130, v130
M v[36:39], a[124:127], a[24:27], v[36:39]
v_cvt_pk_bf16_f32 v128, v128, v129
M v[36:39], a[120:123], a[20:23], v[36:39]
v_exp_f32 v131, v131
M v[36:39], a[116:119], a[16:19], v[36:39]
buffer_load_dwordx4 v1, s[12:15], s25 offen offset:1024 sc1 lds
M v[40:43], a[116:119], a[32:35], 0
v_exp_f32 v144, v144
M v[40:43], a[120:123], a[36:39], v[40:43]
ds_read_b128 a[156:159], v3 offset:10240
ds_read_b128 a[160:163], v3 offset:11264
M v[40:43], a[124:127], a[40:43], v[40:43]
v_exp_f32 v145, v145
M v[40:43], a[128:131], a[44:47], v[40:43]
buffer_load_dwordx4 v1, s[12:15], s25 offen offset:2048 sc1 lds
M v[44:47], a[128:131], a[60:63], 0
v_exp_f32 v146, v146
M v[44:47], a[124:127], a[56:59], v[44:47]
v_cvt_pk_bf16_f32 v129, v130, v131
v_cvt_pk_bf16_f32 v130, v144, v145
M v[44:47], a[120:123], a[52:55], v[44:47]
v_exp_f32 v147, v147
M v[44:47], a[116:119], a[48:51], v[44:47]
buffer_load_dwordx4 v1, s[12:15], s25 offen offset:3072 sc1 lds
s_add_u32 m0, s29, 4096
s_waitcnt lgkmcnt(4)
M v[48:51], a[132:135], a[0:3], 0
v_exp_f32 v132, v132
M v[48:51], a[136:139], a[4:7], v[48:51]
ds_read_b128 a[164:167], v3 offset:12288
ds_read_b128 a[168:171], v3 offset:13312
M v[48:51], a[140:143], a[8:11], v[48:51]
v_exp_f32 v133, v133
M v[48:51], a[144:147], a[12:15], v[48:51]
buffer_load_dwordx4 v1, s[12:15], s32 offen offset:0 sc1 lds
M v[52:55], a[144:147], a[28:31], 0
v_exp_f32 v134, v134
M v[52:55], a[140:143], a[24:27], v[52:55]
v_cvt_pk_bf16_f32 v131, v146, v147
v_cvt_pk_bf16_f32 v132, v132, v133
M v[52:55], a[136:139], a[20:23], v[52:55]
v_exp_f32 v135, v135
M v[52:55], a[132:135], a[16:19], v[52:55]
buffer_load_dwordx4 v1, s[12:15], s32 offen offset:1024 sc1 lds
M v[56:59], a[132:135], a[32:35], 0
v_exp_f32 v148, v148
M v[56:59], a[136:139], a[36:39], v[56:59]
ds_read_b128 a[172:175], v3 offset:14336
ds_read_b128 a[176:179], v3 offset:15360
M v[56:59], a[140:143], a[40:43], v[56:59]
v_exp_f32 v149, v149
M v[56:59], a[144:147], a[44:47], v[56:59]
buffer_load_dwordx4 v1, s[12:15], s32 offen offset:2048 sc1 lds
M v[60:63], a[144:147], a[60:63], 0
v_exp_f32 v150, v150
M v[60:63], a[140:143], a[56:59], v[60:63]
v_cvt_pk_bf16_f32 v133, v134, v135
v_cvt_pk_bf16_f32 v134, v148, v149
M v[60:63], a[136:139], a[52:55], v[60:63]
v_exp_f32 v151, v151
M v[60:63], a[132:135], a[48:51], v[60:63]
buffer_load_dwordx4 v1, s[12:15], s32 offen offset:3072 sc1 lds
s_add_u32 m0, s29, 32768
s_waitcnt lgkmcnt(4)
M v[64:67], a[148:151], a[0:3], 0
v_exp_f32 v136, v136
M v[64:67], a[152:155], a[4:7], v[64:67]
ds_read_b128 a[116:119], v6 offset:32768
ds_read_b128 a[120:123], v6 offset:40960
M v[64:67], a[156:159], a[8:11], v[64:67]
v_exp_f32 v137, v137
M v[64:67], a[160:163], a[12:15], v[64:67]
buffer_load_dwordx4 v1, s[12:15], s26 offen offset:0 sc1 lds
s_add_u32 s43, s26, 4096
M v[68:71], a[160:163], a[28:31], 0
v_exp_f32 v138, v138
M v[68:71], a[156:159], a[24:27], v[68:71]
v_cvt_pk_bf16_f32 v135, v150, v151
v_cvt_pk_bf16_f32 v136, v136, v137
M v[68:71], a[152:155], a[20:23], v[68:71]
v_exp_f32 v139, v139
M v[68:71], a[148:151], a[16:19], v[68:71]
buffer_load_dwordx4 v1, s[12:15], s26 offen offset:1024 sc1 lds
M v[72:75], a[148:151], a[32:35], 0
v_exp_f32 v152, v152
M v[72:75], a[152:155], a[36:39], v[72:75]
ds_read_b128 a[124:127], v6 offset:33792
ds_read_b128 a[128:131], v6 offset:41984
M v[72:75], a[156:159], a[40:43], v[72:75]
v_exp_f32 v153, v153
M v[72:75], a[160:163], a[44:47], v[72:75]
buffer_load_dwordx4 v1, s[12:15], s26 offen offset:2048 sc1 lds
M v[76:79], a[160:163], a[60:63], 0
v_exp_f32 v154, v154
M v[76:79], a[156:159], a[56:59], v[76:79]
v_cvt_pk_bf16_f32 v137, v138, v139
v_cvt_pk_bf16_f32 v138, v152, v153
M v[76:79], a[152:155], a[52:55], v[76:79]
v_exp_f32 v155, v155
M v[76:79], a[148:151], a[48:51], v[76:79]
buffer_load_dwordx4 v1, s[12:15], s26 offen offset:3072 sc1 lds
s_add_u32 m0, s29, 36864
s_waitcnt lgkmcnt(4)
M v[80:83], a[164:167], a[0:3], 0
v_exp_f32 v140, v140
M v[80:83], a[168:171], a[4:7], v[80:83]
ds_read_b128 a[132:135], v6 offset:34816
ds_read_b128 a[136:139], v6 offset:43008
M v[80:83], a[172:175], a[8:11], v[80:83]
v_exp_f32 v141, v141
M v[80:83], a[176:179], a[12:15], v[80:83]
buffer_load_dwordx4 v1, s[12:15], s43 offen offset:0 sc1 lds
M v[84:87], a[176:179], a[28:31], 0
v_exp_f32 v142, v142
M v[84:87], a[172:175], a[24:27], v[84:87]
v_cvt_pk_bf16_f32 v139, v154, v155
v_cvt_pk_bf16_f32 v140, v140, v141
M v[84:87], a[168:171], a[20:23], v[84:87]
v_exp_f32 v143, v143
M v[84:87], a[164:167], a[16:19], v[84:87]
buffer_load_dwordx4 v1, s[12:15], s43 offen offset:1024 sc1 lds
M v[88:91], a[164:167], a[32:35], 0
v_exp_f32 v156, v156
M v[88:91], a[168:171], a[36:39], v[88:91]
ds_read_b128 a[140:143], v6 offset:35840
ds_read_b128 a[144:147], v6 offset:44032
M v[88:91], a[172:175], a[40:43], v[88:91]
v_exp_f32 v157, v157
M v[88:91], a[176:179], a[44:47], v[88:91]
buffer_load_dwordx4 v1, s[12:15], s43 offen offset:2048 sc1 lds
M v[92:95], a[176:179], a[60:63], 0
v_exp_f32 v158, v158
M v[92:95], a[172:175], a[56:59], v[92:95]
v_cvt_pk_bf16_f32 v141, v142, v143
v_cvt_pk_bf16_f32 v142, v156, v157
M v[92:95], a[168:171], a[52:55], v[92:95]
v_exp_f32 v159, v159
M v[92:95], a[164:167], a[48:51], v[92:95]
buffer_load_dwordx4 v1, s[12:15], s43 offen offset:3072 sc1 lds
v_cvt_pk_bf16_f32 v143, v158, v159
s_waitcnt lgkmcnt(6)
M v[160:163], a[116:119], v[96:99], v[160:163]
v_exp_f32 v32, v32
M v[160:163], a[120:123], v[128:131], v[160:163]
ds_read_b128 a[148:151], v6 offset:36864
ds_read_b128 a[152:155], v6 offset:45056
M v[164:167], a[120:123], v[132:135], v[164:167]
v_exp_f32 v33, v33
M v[164:167], a[116:119], v[100:103], v[164:167]
v_cvt_pk_bf16_f32 v32, v32, v33
M v[168:171], a[116:119], v[104:107], v[168:171]
v_exp_f32 v34, v34
M v[168:171], a[120:123], v[136:139], v[168:171]
s_add_u32 s25, s25, 32768
s_cmp_eq_u32 s25, s27
M v[172:175], a[120:123], v[140:143], v[172:175]
v_exp_f32 v35, v35
M v[172:175], a[116:119], v[108:111], v[172:175]
v_cvt_pk_bf16_f32 v33, v34, v35
s_waitcnt lgkmcnt(6)
M a[96:99], a[112:115], v[96:99], a[96:99]
s_cselect_b32 s25, s28, s25
s_cselect_b32 s27, -1, s27
M a[96:99], a[112:115], v[128:131], a[96:99]
s_add_u32 s26, s26, 32768
s_cmp_eq_u32 s26, s62
M v[176:179], a[124:127], v[96:99], v[176:179]
v_exp_f32 v48, v48
M v[176:179], a[128:131], v[128:131], v[176:179]
ds_read_b128 a[156:159], v6 offset:37888
ds_read_b128 a[160:163], v6 offset:46080
M v[180:183], a[128:131], v[132:135], v[180:183]
v_exp_f32 v49, v49
M v[180:183], a[124:127], v[100:103], v[180:183]
v_cvt_pk_bf16_f32 v34, v48, v49
M v[184:187], a[124:127], v[104:107], v[184:187]
v_exp_f32 v50, v50
M v[184:187], a[128:131], v[136:139], v[184:187]
s_cselect_b32 s26, s63, s26
s_cselect_b32 s62, -1, s62
M v[188:191], a[128:131], v[140:143], v[188:191]
v_exp_f32 v51, v51
M v[188:191], a[124:127], v[108:111], v[188:191]
v_cvt_pk_bf16_f32 v35, v50, v51
s_waitcnt lgkmcnt(6)
M a[100:103], a[112:115], v[100:103], a[100:103]
M a[100:103], a[112:115], v[132:135], a[100:103]
M v[192:195], a[132:135], v[96:99], v[192:195]
v_exp_f32 v36, v36
M v[192:195], a[136:139], v[128:131], v[192:195]
ds_read_b128 a[164:167], v6 offset:38912
ds_read_b128 a[168:171], v6 offset:47104
M v[196:199], a[136:139], v[132:135], v[196:199]
v_exp_f32 v37, v37
M v[196:199], a[132:135], v[100:103], v[196:199]
v_cvt_pk_bf16_f32 v36, v36, v37
M v[200:203], a[132:135], v[104:107], v[200:203]
v_exp_f32 v38, v38
M v[200:203], a[136:139], v[136:139], v[200:203]
M v[204:207], a[136:139], v[140:143], v[204:207]
v_exp_f32 v39, v39
M v[204:207], a[132:135], v[108:111], v[204:207]
v_cvt_pk_bf16_f32 v37, v38, v39
s_waitcnt lgkmcnt(6)
M a[104:107], a[112:115], v[104:107], a[104:107]
M a[104:107], a[112:115], v[136:139], a[104:107]
M v[208:211], a[140:143], v[96:99], v[208:211]
v_exp_f32 v52, v52
M v[208:211], a[144:147], v[128:131], v[208:211]
ds_read_b128 a[172:175], v6 offset:39936
ds_read_b128 a[176:179], v6 offset:48128
M v[212:215], a[144:147], v[132:135], v[212:215]
v_exp_f32 v53, v53
M v[212:215], a[140:143], v[100:103], v[212:215]
v_cvt_pk_bf16_f32 v38, v52, v53
M v[216:219], a[140:143], v[104:107], v[216:219]
v_exp_f32 v54, v54
M v[216:219], a[144:147], v[136:139], v[216:219]
M v[220:223], a[144:147], v[140:143], v[220:223]
v_exp_f32 v55, v55
M v[220:223], a[140:143], v[108:111], v[220:223]
v_cvt_pk_bf16_f32 v39, v54, v55
s_waitcnt lgkmcnt(6)
M a[108:111], a[112:115], v[108:111], a[108:111]
M a[108:111], a[112:115], v[140:143], a[108:111]
M v[224:227], a[148:151], v[96:99], v[224:227]
v_exp_f32 v40, v40
M v[224:227], a[152:155], v[128:131], v[224:227]
M v[228:231], a[152:155], v[132:135], v[228:231]
v_exp_f32 v41, v41
M v[228:231], a[148:151], v[100:103], v[228:231]
v_cvt_pk_bf16_f32 v40, v40, v41
M v[232:235], a[148:151], v[104:107], v[232:235]
v_exp_f32 v42, v42
M v[232:235], a[152:155], v[136:139], v[232:235]
M v[236:239], a[152:155], v[140:143], v[236:239]
v_exp_f32 v43, v43
M v[236:239], a[148:151], v[108:111], v[236:239]
v_cvt_pk_bf16_f32 v41, v42, v43
s_waitcnt lgkmcnt(4)
M v[240:243], a[156:159], v[96:99], v[240:243]
v_exp_f32 v56, v56
M v[240:243], a[160:163], v[128:131], v[240:243]
M v[244:247], a[160:163], v[132:135], v[244:247]
v_exp_f32 v57, v57
M v[244:247], a[156:159], v[100:103], v[244:247]
v_cvt_pk_bf16_f32 v42, v56, v57
M v[248:251], a[156:159], v[104:107], v[248:251]
v_exp_f32 v58, v58
M v[248:251], a[160:163], v[136:139], v[248:251]
s_waitcnt vmcnt(0) lgkmcnt(0)
s_barrier
ds_read_b128 a[116:119], v2 offset:0
ds_read_b128 a[120:123], v2 offset:1024
M v[252:255], a[160:163], v[140:143], v[252:255]
v_exp_f32 v59, v59
M v[252:255], a[156:159], v[108:111], v[252:255]
v_cvt_pk_bf16_f32 v43, v58, v59
M a[64:67], a[164:167], v[96:99], a[64:67]
v_exp_f32 v44, v44
M a[64:67], a[168:171], v[128:131], a[64:67]
ds_read_b128 a[124:127], v2 offset:2048
ds_read_b128 a[128:131], v2 offset:3072
M a[68:71], a[168:171], v[132:135], a[68:71]
v_exp_f32 v45, v45
M a[68:71], a[164:167], v[100:103], a[68:71]
v_cvt_pk_bf16_f32 v44, v44, v45
M a[72:75], a[164:167], v[104:107], a[72:75]
v_exp_f32 v46, v46
M a[72:75], a[168:171], v[136:139], a[72:75]
ds_read_b128 a[132:135], v2 offset:4096
ds_read_b128 a[136:139], v2 offset:5120
M a[76:79], a[168:171], v[140:143], a[76:79]
v_exp_f32 v47, v47
M a[76:79], a[164:167], v[108:111], a[76:79]
v_cvt_pk_bf16_f32 v45, v46, v47
M a[80:83], a[172:175], v[96:99], a[80:83]
v_exp_f32 v60, v60
M a[80:83], a[176:179], v[128:131], a[80:83]
ds_read_b128 a[140:143], v2 offset:6144
ds_read_b128 a[144:147], v2 offset:7168
M a[84:87], a[176:179], v[132:135], a[84:87]
v_exp_f32 v61, v61
M a[84:87], a[172:175], v[100:103], a[84:87]
v_cvt_pk_bf16_f32 v46, v60, v61
M a[88:91], a[172:175], v[104:107], a[88:91]
v_exp_f32 v62, v62
M a[88:91], a[176:179], v[136:139], a[88:91]
M a[92:95], a[176:179], v[140:143], a[92:95]
v_exp_f32 v63, v63
M a[92:95], a[172:175], v[108:111], a[92:95]
v_cvt_pk_bf16_f32 v47, v62, v63
s_branch Lk2_l1
Lk2_m1:
s_cmp_eq_u32 s23, 1
s_cbranch_scc1 Lk2_m1b
s_add_u32 m0, s29, 0
s_waitcnt lgkmcnt(4)
M v[32:35], a[116:119], a[0:3], v[16:19]
v_exp_f32 v128, v128
M v[32:35], a[120:123], a[4:7], v[32:35]
ds_read_b128 a[148:151], v3 offset:8192
ds_read_b128 a[152:155], v3 offset:9216
M v[32:35], a[124:127], a[8:11], v[32:35]
v_exp_f32 v129, v129
M v[32:35], a[128:131], a[12:15], v[32:35]
buffer_load_dwordx4 v1, s[12:15], s25 offen offset:0 sc1 lds
s_add_u32 s32, s25, 4096
M v[36:39], a[128:131], a[28:31], 0
v_exp_f32 v130, v130
M v[36:39], a[124:127], a[24:27], v[36:39]
v_cvt_pk_bf16_f32 v128, v128, v129
M v[36:39], a[120:123], a[20:23], v[36:39]
v_exp_f32 v131, v131
M v[36:39], a[116:119], a[16:19], v[36:39]
buffer_load_dwordx4 v1, s[12:15], s25 offen offset:1024 sc1 lds
M v[40:43], a[116:119], a[32:35], 0
v_exp_f32 v144, v144
M v[40:43], a[120:123], a[36:39], v[40:43]
ds_read_b128 a[156:159], v3 offset:10240
ds_read_b128 a[160:163], v3 offset:11264
M v[40:43], a[124:127], a[40:43], v[40:43]
v_exp_f32 v145, v145
M v[40:43], a[128:131], a[44:47], v[40:43]
buffer_load_dwordx4 v1, s[12:15], s25 offen offset:2048 sc1 lds
M v[44:47], a[128:131], a[60:63], 0
v_exp_f32 v146, v146
M v[44:47], a[124:127], a[56:59], v[44:47]
v_cvt_pk_bf16_f32 v129, v130, v131
v_cvt_pk_bf16_f32 v130, v144, v145
M v[44:47], a[120:123], a[52:55], v[44:47]
v_exp_f32 v147, v147
M v[44:47], a[116:119], a[48:51], v[44:47]
buffer_load_dwordx4 v1, s[12:15], s25 offen offset:3072 sc1 lds
s_add_u32 m0, s29, 4096
s_waitcnt lgkmcnt(4)
v_exp_f32 v132, v132
ds_read_b128 a[164:167], v3 offset:12288
ds_read_b128 a[168:171], v3 offset:13312
v_exp_f32 v133, v133
buffer_load_dwordx4 v1, s[12:15], s32 offen offset:0 sc1 lds
M v[52:55], a[144:147], a[28:31], v[16:19]
v_exp_f32 v134, v134
M v[52:55], a[140:143], a[24:27], v[52:55]
v_cvt_pk_bf16_f32 v131, v146, v147
v_cvt_pk_bf16_f32 v132, v132, v133
M v[52:55], a[136:139], a[20:23], v[52:55]
v_exp_f32 v135, v135
M v[52:55], a[132:135], a[16:19], v[52:55]
buffer_load_dwordx4 v1, s[12:15], s32 offen offset:1024 sc1 lds
M v[56:59], a[132:135], a[32:35], 0
v_exp_f32 v148, v148
M v[56:59], a[136:139], a[36:39], v[56:59]
ds_read_b128 a[172:175], v3 offset:14336
ds_read_b128 a[176:179], v3 offset:15360
M v[56:59], a[140:143], a[40:43], v[56:59]
v_exp_f32 v149, v149
M v[56:59], a[144:147], a[44:47], v[56:59]
buffer_load_dwordx4 v1, s[12:15], s32 offen offset:2048 sc1 lds
M v[60:63], a[144:147], a[60:63], 0
v_exp_f32 v150, v150
M v[60:63], a[140:143], a[56:59], v[60:63]
v_cvt_pk_bf16_f32 v133, v134, v135
v_cvt_pk_bf16_f32 v134, v148, v149
M v[60:63], a[136:139], a[52:55], v[60:63]
v_exp_f32 v151, v151
M v[60:63], a[132:135], a[48:51], v[60:63]
buffer_load_dwordx4 v1, s[12:15], s32 offen offset:3072 sc1 lds
s_add_u32 m0, s29, 32768
s_waitcnt lgkmcnt(4)
v_exp_f32 v136, v136
ds_read_b128 a[116:119], v6 offset:32768
ds_read_b128 a[120:123], v6 offset:40960
v_exp_f32 v137, v137
buffer_load_dwordx4 v1, s[12:15], s26 offen offset:0 sc1 lds
s_add_u32 s43, s26, 4096
v_exp_f32 v138, v138
v_cvt_pk_bf16_f32 v135, v150, v151
v_cvt_pk_bf16_f32 v136, v136, v137
v_exp_f32 v139, v139
buffer_load_dwordx4 v1, s[12:15], s26 offen offset:1024 sc1 lds
M v[72:75], a[148:151], a[32:35], v[16:19]
v_exp_f32 v152, v152
M v[72:75], a[152:155], a[36:39], v[72:75]
ds_read_b128 a[124:127], v6 offset:33792
ds_read_b128 a[128:131], v6 offset:41984
M v[72:75], a[156:159], a[40:43], v[72:75]
v_exp_f32 v153, v153
M v[72:75], a[160:163], a[44:47], v[72:75]
buffer_load_dwordx4 v1, s[12:15], s26 offen offset:2048 sc1 lds
M v[76:79], a[160:163], a[60:63], 0
v_exp_f32 v154, v154
M v[76:79], a[156:159], a[56:59], v[76:79]
v_cvt_pk_bf16_f32 v137, v138, v139
v_cvt_pk_bf16_f32 v138, v152, v153
M v[76:79], a[152:155], a[52:55], v[76:79]
v_exp_f32 v155, v155
M v[76:79], a[148:151], a[48:51], v[76:79]
buffer_load_dwordx4 v1, s[12:15], s26 offen offset:3072 sc1 lds
s_add_u32 m0, s29, 36864
s_waitcnt lgkmcnt(4)
v_exp_f32 v140, v140
ds_read_b128 a[132:135], v6 offset:34816
ds_read_b128 a[136:139], v6 offset:43008
v_exp_f32 v141, v141
buffer_load_dwordx4 v1, s[12:15], s43 offen offset:0 sc1 lds
v_exp_f32 v142, v142
v_cvt_pk_bf16_f32 v139, v154, v155
v_cvt_pk_bf16_f32 v140, v140, v141
v_exp_f32 v143, v143
buffer_load_dwordx4 v1, s[12:15], s43 offen offset:1024 sc1 lds
v_exp_f32 v156, v156
ds_read_b128 a[140:143], v6 offset:35840
ds_read_b128 a[144:147], v6 offset:44032
v_exp_f32 v157, v157
buffer_load_dwordx4 v1, s[12:15], s43 offen offset:2048 sc1 lds
M v[92:95], a[176:179], a[60:63], v[16:19]
v_exp_f32 v158, v158
M v[92:95], a[172:175], a[56:59], v[92:95]
v_cvt_pk_bf16_f32 v141, v142, v143
v_cvt_pk_bf16_f32 v142, v156, v157
M v[92:95], a[168:171], a[52:55], v[92:95]
v_exp_f32 v159, v159
M v[92:95], a[164:167], a[48:51], v[92:95]
buffer_load_dwordx4 v1, s[12:15], s43 offen offset:3072 sc1 lds
v_cvt_pk_bf16_f32 v143, v158, v159
s_waitcnt lgkmcnt(6)
M v[160:163], a[116:119], v[96:99], v[160:163]
v_exp_f32 v32, v32
M v[160:163], a[120:123], v[128:131], v[160:163]
ds_read_b128 a[148:151], v6 offset:36864
ds_read_b128 a[152:155], v6 offset:45056
M v[164:167], a[120:123], v[132:135], v[164:167]
v_exp_f32 v33, v33
M v[164:167], a[116:119], v[100:103], v[164:167]
v_cvt_pk_bf16_f32 v32, v32, v33
M v[168:171], a[116:119], v[104:107], v[168:171]
v_exp_f32 v34, v34
M v[168:171], a[120:123], v[136:139], v[168:171]
s_add_u32 s25, s25, 32768
s_cmp_eq_u32 s25, s27
M v[172:175], a[120:123], v[140:143], v[172:175]
v_exp_f32 v35, v35
M v[172:175], a[116:119], v[108:111], v[172:175]
v_cvt_pk_bf16_f32 v33, v34, v35
s_waitcnt lgkmcnt(6)
M a[96:99], a[112:115], v[96:99], a[96:99]
s_cselect_b32 s25, s28, s25
s_cselect_b32 s27, -1, s27
M a[96:99], a[112:115], v[128:131], a[96:99]
s_add_u32 s26, s26, 32768
s_cmp_eq_u32 s26, s62
M v[176:179], a[124:127], v[96:99], v[176:179]
M v[176:179], a[128:131], v[128:131], v[176:179]
ds_read_b128 a[156:159], v6 offset:37888
ds_read_b128 a[160:163], v6 offset:46080
M v[180:183], a[128:131], v[132:135], v[180:183]
M v[180:183], a[124:127], v[100:103], v[180:183]
v_mov_b32 v34, 0
M v[184:187], a[124:127], v[104:107], v[184:187]
M v[184:187], a[128:131], v[136:139], v[184:187]
s_cselect_b32 s26, s63, s26
s_cselect_b32 s62, -1, s62
M v[188:191], a[128:131], v[140:143], v[188:191]
M v[188:191], a[124:127], v[108:111], v[188:191]
v_mov_b32 v35, 0
s_waitcnt lgkmcnt(6)
M a[100:103], a[112:115], v[100:103], a[100:103]
M a[100:103], a[112:115], v[132:135], a[100:103]
M v[192:195], a[132:135], v[96:99], v[192:195]
v_exp_f32 v36, v36
M v[192:195], a[136:139], v[128:131], v[192:195]
ds_read_b128 a[164:167], v6 offset:38912
ds_read_b128 a[168:171], v6 offset:47104
M v[196:199], a[136:139], v[132:135], v[196:199]
v_exp_f32 v37, v37
M v[196:199], a[132:135], v[100:103], v[196:199]
v_cvt_pk_bf16_f32 v36, v36, v37
M v[200:203], a[132:135], v[104:107], v[200:203]
v_exp_f32 v38, v38
M v[200:203], a[136:139], v[136:139], v[200:203]
M v[204:207], a[136:139], v[140:143], v[204:207]
v_exp_f32 v39, v39
M v[204:207], a[132:135], v[108:111], v[204:207]
v_cvt_pk_bf16_f32 v37, v38, v39
s_waitcnt lgkmcnt(6)
M a[104:107], a[112:115], v[104:107], a[104:107]
M a[104:107], a[112:115], v[136:139], a[104:107]
M v[208:211], a[140:143], v[96:99], v[208:211]
v_exp_f32 v52, v52
M v[208:211], a[144:147], v[128:131], v[208:211]
ds_read_b128 a[172:175], v6 offset:39936
ds_read_b128 a[176:179], v6 offset:48128
M v[212:215], a[144:147], v[132:135], v[212:215]
v_exp_f32 v53, v53
M v[212:215], a[140:143], v[100:103], v[212:215]
v_cvt_pk_bf16_f32 v38, v52, v53
M v[216:219], a[140:143], v[104:107], v[216:219]
v_exp_f32 v54, v54
M v[216:219], a[144:147], v[136:139], v[216:219]
M v[220:223], a[144:147], v[140:143], v[220:223]
v_exp_f32 v55, v55
M v[220:223], a[140:143], v[108:111], v[220:223]
v_cvt_pk_bf16_f32 v39, v54, v55
s_waitcnt lgkmcnt(6)
M a[108:111], a[112:115], v[108:111], a[108:111]
M a[108:111], a[112:115], v[140:143], a[108:111]
M v[224:227], a[148:151], v[96:99], v[224:227]
v_exp_f32 v40, v40
M v[224:227], a[152:155], v[128:131], v[224:227]
M v[228:231], a[152:155], v[132:135], v[228:231]
v_exp_f32 v41, v41
M v[228:231], a[148:151], v[100:103], v[228:231]
v_cvt_pk_bf16_f32 v40, v40, v41
M v[232:235], a[148:151], v[104:107], v[232:235]
v_exp_f32 v42, v42
M v[232:235], a[152:155], v[136:139], v[232:235]
M v[236:239], a[152:155], v[140:143], v[236:239]
v_exp_f32 v43, v43
M v[236:239], a[148:151], v[108:111], v[236:239]
v_cvt_pk_bf16_f32 v41, v42, v43
s_waitcnt lgkmcnt(4)
M v[240:243], a[156:159], v[96:99], v[240:243]
v_exp_f32 v56, v56
M v[240:243], a[160:163], v[128:131], v[240:243]
M v[244:247], a[160:163], v[132:135], v[244:247]
v_exp_f32 v57, v57
M v[244:247], a[156:159], v[100:103], v[244:247]
v_cvt_pk_bf16_f32 v42, v56, v57
M v[248:251], a[156:159], v[104:107], v[248:251]
v_exp_f32 v58, v58
M v[248:251], a[160:163], v[136:139], v[248:251]
s_waitcnt vmcnt(0) lgkmcnt(0)
s_barrier
ds_read_b128 a[116:119], v2 offset:0
ds_read_b128 a[120:123], v2 offset:1024
M v[252:255], a[160:163], v[140:143], v[252:255]
v_exp_f32 v59, v59
M v[252:255], a[156:159], v[108:111], v[252:255]
v_cvt_pk_bf16_f32 v43, v58, v59
M a[64:67], a[164:167], v[96:99], a[64:67]
v_exp_f32 v44, v44
M a[64:67], a[168:171], v[128:131], a[64:67]
ds_read_b128 a[124:127], v2 offset:2048
ds_read_b128 a[128:131], v2 offset:3072
M a[68:71], a[168:171], v[132:135], a[68:71]
v_exp_f32 v45, v45
M a[68:71], a[164:167], v[100:103], a[68:71]
v_cvt_pk_bf16_f32 v44, v44, v45
M a[72:75], a[164:167], v[104:107], a[72:75]
v_exp_f32 v46, v46
M a[72:75], a[168:171], v[136:139], a[72:75]
ds_read_b128 a[132:135], v2 offset:4096
ds_read_b128 a[136:139], v2 offset:5120
M a[76:79], a[168:171], v[140:143], a[76:79]
v_exp_f32 v47, v47
M a[76:79], a[164:167], v[108:111], a[76:79]
v_cvt_pk_bf16_f32 v45, v46, v47
M a[80:83], a[172:175], v[96:99], a[80:83]
v_exp_f32 v60, v60
M a[80:83], a[176:179], v[128:131], a[80:83]
ds_read_b128 a[140:143], v2 offset:6144
ds_read_b128 a[144:147], v2 offset:7168
M a[84:87], a[176:179], v[132:135], a[84:87]
v_exp_f32 v61, v61
M a[84:87], a[172:175], v[100:103], a[84:87]
v_cvt_pk_bf16_f32 v46, v60, v61
M a[88:91], a[172:175], v[104:107], a[88:91]
v_exp_f32 v62, v62
M a[88:91], a[176:179], v[136:139], a[88:91]
M a[92:95], a[176:179], v[140:143], a[92:95]
v_exp_f32 v63, v63
M a[92:95], a[172:175], v[108:111], a[92:95]
v_cvt_pk_bf16_f32 v47, v62, v63
Lk2_m2a:
s_sub_u32 s35, 15, s21
s_lshl_b32 s33, s20, 7
s_lshl_b32 s34, s35, 3
s_add_u32 s33, s33, s34
s_lshl_b32 s34, s23, 2
s_add_u32 s33, s33, s34
s_lshl_b32 s33, s33, 12
buffer_load_dwordx4 a[180:183], v1, s[8:11], s33 offen offset:0 sc1
buffer_load_dwordx4 a[184:187], v1, s[8:11], s33 offen offset:1024 sc1
buffer_load_dwordx4 a[188:191], v1, s[8:11], s33 offen offset:2048 sc1
buffer_load_dwordx4 a[192:195], v1, s[8:11], s33 offen offset:3072 sc1
s_add_u32 s33, s33, 4096
buffer_load_dwordx4 a[196:199], v1, s[8:11], s33 offen offset:0 sc1
buffer_load_dwordx4 a[200:203], v1, s[8:11], s33 offen offset:1024 sc1
buffer_load_dwordx4 a[204:207], v1, s[8:11], s33 offen offset:2048 sc1
buffer_load_dwordx4 a[208:211], v1, s[8:11], s33 offen offset:3072 sc1
s_add_u32 s33, s33, 4096
buffer_load_dwordx4 a[212:215], v1, s[8:11], s33 offen offset:0 sc1
buffer_load_dwordx4 a[216:219], v1, s[8:11], s33 offen offset:1024 sc1
buffer_load_dwordx4 a[220:223], v1, s[8:11], s33 offen offset:2048 sc1
buffer_load_dwordx4 a[224:227], v1, s[8:11], s33 offen offset:3072 sc1
s_add_u32 s33, s33, 4096
buffer_load_dwordx4 a[228:231], v1, s[8:11], s33 offen offset:0 sc1
buffer_load_dwordx4 a[232:235], v1, s[8:11], s33 offen offset:1024 sc1
buffer_load_dwordx4 a[236:239], v1, s[8:11], s33 offen offset:2048 sc1
buffer_load_dwordx4 a[240:243], v1, s[8:11], s33 offen offset:3072 sc1
s_add_u32 m0, s29, 65536
s_nop 0
buffer_load_dwordx4 v1, s[12:15], s25 offen offset:0 sc1 lds
s_add_u32 s32, s25, 4096
buffer_load_dwordx4 v1, s[12:15], s25 offen offset:1024 sc1 lds
buffer_load_dwordx4 v1, s[12:15], s25 offen offset:2048 sc1 lds
buffer_load_dwordx4 v1, s[12:15], s25 offen offset:3072 sc1 lds
s_add_u32 m0, s29, 69632
s_nop 0
buffer_load_dwordx4 v1, s[12:15], s32 offen offset:0 sc1 lds
buffer_load_dwordx4 v1, s[12:15], s32 offen offset:1024 sc1 lds
buffer_load_dwordx4 v1, s[12:15], s32 offen offset:2048 sc1 lds
buffer_load_dwordx4 v1, s[12:15], s32 offen offset:3072 sc1 lds
s_add_u32 m0, s29, 98304
v_exp_f32 v72, v72
s_waitcnt lgkmcnt(7)
ds_read_b128 a[116:119], v5 offset:32768
s_waitcnt lgkmcnt(7)
ds_read_b128 a[120:123], v5 offset:40960
v_exp_f32 v73, v73
buffer_load_dwordx4 v1, s[12:15], s26 offen offset:0 sc1 lds
s_add_u32 s43, s26, 4096
v_exp_f32 v74, v74
v_cvt_pk_bf16_f32 v72, v72, v73
v_exp_f32 v75, v75
buffer_load_dwordx4 v1, s[12:15], s26 offen offset:1024 sc1 lds
s_waitcnt lgkmcnt(7)
ds_read_b128 a[124:127], v5 offset:33792
s_waitcnt lgkmcnt(7)
ds_read_b128 a[128:131], v5 offset:41984
buffer_load_dwordx4 v1, s[12:15], s26 offen offset:2048 sc1 lds
v_cvt_pk_bf16_f32 v73, v74, v75
v_mov_b32 v74, 0
buffer_load_dwordx4 v1, s[12:15], s26 offen offset:3072 sc1 lds
s_add_u32 m0, s29, 102400
v_exp_f32 v76, v76
s_waitcnt lgkmcnt(7)
ds_read_b128 a[132:135], v5 offset:34816
s_waitcnt lgkmcnt(7)
ds_read_b128 a[136:139], v5 offset:43008
v_exp_f32 v77, v77
buffer_load_dwordx4 v1, s[12:15], s43 offen offset:0 sc1 lds
v_exp_f32 v78, v78
v_mov_b32 v75, 0
v_cvt_pk_bf16_f32 v76, v76, v77
v_exp_f32 v79, v79
buffer_load_dwordx4 v1, s[12:15], s43 offen offset:1024 sc1 lds
v_exp_f32 v92, v92
s_waitcnt lgkmcnt(7)
ds_read_b128 a[140:143], v5 offset:35840
s_waitcnt lgkmcnt(7)
ds_read_b128 a[144:147], v5 offset:44032
v_exp_f32 v93, v93
buffer_load_dwordx4 v1, s[12:15], s43 offen offset:2048 sc1 lds
v_exp_f32 v94, v94
v_cvt_pk_bf16_f32 v77, v78, v79
v_cvt_pk_bf16_f32 v78, v92, v93
v_exp_f32 v95, v95
buffer_load_dwordx4 v1, s[12:15], s43 offen offset:3072 sc1 lds
v_cvt_pk_bf16_f32 v79, v94, v95
s_waitcnt lgkmcnt(6)
M v[160:163], a[116:119], v[32:35], v[160:163]
ds_read_b128 a[148:151], v5 offset:36864
ds_read_b128 a[152:155], v5 offset:45056
M v[164:167], a[116:119], v[36:39], v[164:167]
M v[168:171], a[116:119], v[40:43], v[168:171]
M v[168:171], a[120:123], v[72:75], v[168:171]
s_add_u32 s25, s25, 32768
s_cmp_eq_u32 s25, s27
M v[172:175], a[120:123], v[76:79], v[172:175]
M v[172:175], a[116:119], v[44:47], v[172:175]
s_waitcnt lgkmcnt(6)
M a[96:99], a[112:115], v[32:35], a[96:99]
s_cselect_b32 s25, s28, s25
s_cselect_b32 s27, -1, s27
s_add_u32 s26, s26, 32768
s_cmp_eq_u32 s26, s62
M v[176:179], a[124:127], v[32:35], v[176:179]
ds_read_b128 a[156:159], v5 offset:37888
ds_read_b128 a[160:163], v5 offset:46080
M v[180:183], a[124:127], v[36:39], v[180:183]
M v[184:187], a[124:127], v[40:43], v[184:187]
M v[184:187], a[128:131], v[72:75], v[184:187]
s_cselect_b32 s26, s63, s26
s_cselect_b32 s62, -1, s62
M v[188:191], a[128:131], v[76:79], v[188:191]
M v[188:191], a[124:127], v[44:47], v[188:191]
s_waitcnt lgkmcnt(6)
M a[100:103], a[112:115], v[36:39], a[100:103]
M v[192:195], a[132:135], v[32:35], v[192:195]
ds_read_b128 a[164:167], v5 offset:38912
ds_read_b128 a[168:171], v5 offset:47104
M v[196:199], a[132:135], v[36:39], v[196:199]
M v[200:203], a[132:135], v[40:43], v[200:203]
M v[200:203], a[136:139], v[72:75], v[200:203]
M v[204:207], a[136:139], v[76:79], v[204:207]
M v[204:207], a[132:135], v[44:47], v[204:207]
s_waitcnt lgkmcnt(6)
M a[104:107], a[112:115], v[40:43], a[104:107]
M a[104:107], a[112:115], v[72:75], a[104:107]
M v[208:211], a[140:143], v[32:35], v[208:211]
ds_read_b128 a[172:175], v5 offset:39936
ds_read_b128 a[176:179], v5 offset:48128
M v[212:215], a[140:143], v[36:39], v[212:215]
M v[216:219], a[140:143], v[40:43], v[216:219]
M v[216:219], a[144:147], v[72:75], v[216:219]
M v[220:223], a[144:147], v[76:79], v[220:223]
M v[220:223], a[140:143], v[44:47], v[220:223]
s_waitcnt lgkmcnt(6)
M a[108:111], a[112:115], v[44:47], a[108:111]
M a[108:111], a[112:115], v[76:79], a[108:111]
M v[224:227], a[148:151], v[32:35], v[224:227]
M v[228:231], a[148:151], v[36:39], v[228:231]
M v[232:235], a[148:151], v[40:43], v[232:235]
M v[232:235], a[152:155], v[72:75], v[232:235]
M v[236:239], a[152:155], v[76:79], v[236:239]
M v[236:239], a[148:151], v[44:47], v[236:239]
s_waitcnt lgkmcnt(4)
M v[240:243], a[156:159], v[32:35], v[240:243]
M v[244:247], a[156:159], v[36:39], v[244:247]
M v[248:251], a[156:159], v[40:43], v[248:251]
M v[248:251], a[160:163], v[72:75], v[248:251]
s_waitcnt vmcnt(0) lgkmcnt(0)
s_barrier
ds_read_b128 a[116:119], v3 offset:0
ds_read_b128 a[120:123], v3 offset:1024
M v[252:255], a[160:163], v[76:79], v[252:255]
M v[252:255], a[156:159], v[44:47], v[252:255]
M a[64:67], a[164:167], v[32:35], a[64:67]
ds_read_b128 a[124:127], v3 offset:2048
ds_read_b128 a[128:131], v3 offset:3072
M a[68:71], a[164:167], v[36:39], a[68:71]
M a[72:75], a[164:167], v[40:43], a[72:75]
M a[72:75], a[168:171], v[72:75], a[72:75]
ds_read_b128 a[132:135], v3 offset:4096
ds_read_b128 a[136:139], v3 offset:5120
M a[76:79], a[168:171], v[76:79], a[76:79]
M a[76:79], a[164:167], v[44:47], a[76:79]
M a[80:83], a[172:175], v[32:35], a[80:83]
ds_read_b128 a[140:143], v3 offset:6144
ds_read_b128 a[144:147], v3 offset:7168
M a[84:87], a[172:175], v[36:39], a[84:87]
M a[88:91], a[172:175], v[40:43], a[88:91]
M a[88:91], a[176:179], v[72:75], a[88:91]
M a[92:95], a[176:179], v[76:79], a[92:95]
M a[92:95], a[172:175], v[44:47], a[92:95]
s_waitcnt vmcnt(16)
s_add_u32 m0, s29, 0
s_waitcnt lgkmcnt(4)
M v[32:35], a[116:119], a[180:183], 0
M v[32:35], a[120:123], a[184:187], v[32:35]
ds_read_b128 a[148:151], v3 offset:8192
ds_read_b128 a[152:155], v3 offset:9216
M v[32:35], a[124:127], a[188:191], v[32:35]
M v[32:35], a[128:131], a[192:195], v[32:35]
buffer_load_dwordx4 v1, s[12:15], s25 offen offset:0 sc1 lds
s_add_u32 s32, s25, 4096
M v[36:39], a[128:131], a[208:211], 0
M v[36:39], a[124:127], a[204:207], v[36:39]
M v[36:39], a[120:123], a[200:203], v[36:39]
M v[36:39], a[116:119], a[196:199], v[36:39]
buffer_load_dwordx4 v1, s[12:15], s25 offen offset:1024 sc1 lds
M v[40:43], a[116:119], a[212:215], 0
M v[40:43], a[120:123], a[216:219], v[40:43]
ds_read_b128 a[156:159], v3 offset:10240
ds_read_b128 a[160:163], v3 offset:11264
M v[40:43], a[124:127], a[220:223], v[40:43]
M v[40:43], a[128:131], a[224:227], v[40:43]
buffer_load_dwordx4 v1, s[12:15], s25 offen offset:2048 sc1 lds
M v[44:47], a[128:131], a[240:243], 0
M v[44:47], a[124:127], a[236:239], v[44:47]
M v[44:47], a[120:123], a[232:235], v[44:47]
M v[44:47], a[116:119], a[228:231], v[44:47]
buffer_load_dwordx4 v1, s[12:15], s25 offen offset:3072 sc1 lds
s_add_u32 m0, s29, 4096
s_waitcnt lgkmcnt(4)
M v[48:51], a[132:135], a[180:183], 0
M v[48:51], a[136:139], a[184:187], v[48:51]
ds_read_b128 a[164:167], v3 offset:12288
ds_read_b128 a[168:171], v3 offset:13312
M v[48:51], a[140:143], a[188:191], v[48:51]
M v[48:51], a[144:147], a[192:195], v[48:51]
buffer_load_dwordx4 v1, s[12:15], s32 offen offset:0 sc1 lds
M v[52:55], a[144:147], a[208:211], 0
M v[52:55], a[140:143], a[204:207], v[52:55]
M v[52:55], a[136:139], a[200:203], v[52:55]
M v[52:55], a[132:135], a[196:199], v[52:55]
buffer_load_dwordx4 v1, s[12:15], s32 offen offset:1024 sc1 lds
M v[56:59], a[132:135], a[212:215], 0
M v[56:59], a[136:139], a[216:219], v[56:59]
ds_read_b128 a[172:175], v3 offset:14336
ds_read_b128 a[176:179], v3 offset:15360
M v[56:59], a[140:143], a[220:223], v[56:59]
M v[56:59], a[144:147], a[224:227], v[56:59]
buffer_load_dwordx4 v1, s[12:15], s32 offen offset:2048 sc1 lds
M v[60:63], a[144:147], a[240:243], 0
M v[60:63], a[140:143], a[236:239], v[60:63]
M v[60:63], a[136:139], a[232:235], v[60:63]
M v[60:63], a[132:135], a[228:231], v[60:63]
buffer_load_dwordx4 v1, s[12:15], s32 offen offset:3072 sc1 lds
s_add_u32 m0, s29, 32768
s_waitcnt lgkmcnt(4)
M v[64:67], a[148:151], a[180:183], 0
M v[64:67], a[152:155], a[184:187], v[64:67]
M v[64:67], a[156:159], a[188:191], v[64:67]
M v[64:67], a[160:163], a[192:195], v[64:67]
buffer_load_dwordx4 v1, s[12:15], s26 offen offset:0 sc1 lds
s_add_u32 s43, s26, 4096
M v[68:71], a[160:163], a[208:211], 0
M v[68:71], a[156:159], a[204:207], v[68:71]
M v[68:71], a[152:155], a[200:203], v[68:71]
M v[68:71], a[148:151], a[196:199], v[68:71]
buffer_load_dwordx4 v1, s[12:15], s26 offen offset:1024 sc1 lds
M v[72:75], a[148:151], a[212:215], 0
M v[72:75], a[152:155], a[216:219], v[72:75]
M v[72:75], a[156:159], a[220:223], v[72:75]
M v[72:75], a[160:163], a[224:227], v[72:75]
buffer_load_dwordx4 v1, s[12:15], s26 offen offset:2048 sc1 lds
M v[76:79], a[160:163], a[240:243], 0
M v[76:79], a[156:159], a[236:239], v[76:79]
M v[76:79], a[152:155], a[232:235], v[76:79]
M v[76:79], a[148:151], a[228:231], v[76:79]
buffer_load_dwordx4 v1, s[12:15], s26 offen offset:3072 sc1 lds
s_add_u32 m0, s29, 36864
s_waitcnt lgkmcnt(0)
M v[80:83], a[164:167], a[180:183], 0
M v[80:83], a[168:171], a[184:187], v[80:83]
M v[80:83], a[172:175], a[188:191], v[80:83]
M v[80:83], a[176:179], a[192:195], v[80:83]
buffer_load_dwordx4 v1, s[12:15], s43 offen offset:0 sc1 lds
M v[84:87], a[176:179], a[208:211], 0
M v[84:87], a[172:175], a[204:207], v[84:87]
M v[84:87], a[168:171], a[200:203], v[84:87]
M v[84:87], a[164:167], a[196:199], v[84:87]
buffer_load_dwordx4 v1, s[12:15], s43 offen offset:1024 sc1 lds
M v[88:91], a[164:167], a[212:215], 0
M v[88:91], a[168:171], a[216:219], v[88:91]
M v[88:91], a[172:175], a[220:223], v[88:91]
M v[88:91], a[176:179], a[224:227], v[88:91]
buffer_load_dwordx4 v1, s[12:15], s43 offen offset:2048 sc1 lds
M v[92:95], a[176:179], a[240:243], 0
M v[92:95], a[172:175], a[236:239], v[92:95]
M v[92:95], a[168:171], a[232:235], v[92:95]
M v[92:95], a[164:167], a[228:231], v[92:95]
buffer_load_dwordx4 v1, s[12:15], s43 offen offset:3072 sc1 lds
v_exp_f32 v32, v32
v_exp_f32 v33, v33
s_nop 0
v_cvt_pk_bf16_f32 v32, v32, v33
v_exp_f32 v34, v34
s_add_u32 s25, s25, 32768
s_cmp_eq_u32 s25, s27
v_exp_f32 v35, v35
s_nop 0
v_cvt_pk_bf16_f32 v33, v34, v35
s_cselect_b32 s25, s28, s25
s_cselect_b32 s27, -1, s27
s_add_u32 s26, s26, 32768
s_cmp_eq_u32 s26, s62
v_exp_f32 v48, v48
v_exp_f32 v49, v49
s_nop 0
v_cvt_pk_bf16_f32 v34, v48, v49
v_exp_f32 v50, v50
s_cselect_b32 s26, s63, s26
s_cselect_b32 s62, -1, s62
v_exp_f32 v51, v51
s_nop 0
v_cvt_pk_bf16_f32 v35, v50, v51
v_exp_f32 v36, v36
v_exp_f32 v37, v37
s_nop 0
v_cvt_pk_bf16_f32 v36, v36, v37
v_exp_f32 v38, v38
v_exp_f32 v39, v39
s_nop 0
v_cvt_pk_bf16_f32 v37, v38, v39
v_exp_f32 v52, v52
v_exp_f32 v53, v53
s_nop 0
v_cvt_pk_bf16_f32 v38, v52, v53
v_exp_f32 v54, v54
v_exp_f32 v55, v55
s_nop 0
v_cvt_pk_bf16_f32 v39, v54, v55
v_exp_f32 v40, v40
v_exp_f32 v41, v41
s_nop 0
v_cvt_pk_bf16_f32 v40, v40, v41
v_exp_f32 v42, v42
v_exp_f32 v43, v43
s_nop 0
v_cvt_pk_bf16_f32 v41, v42, v43
v_exp_f32 v56, v56
v_exp_f32 v57, v57
s_nop 0
v_cvt_pk_bf16_f32 v42, v56, v57
v_exp_f32 v58, v58
s_waitcnt vmcnt(0) lgkmcnt(0)
s_barrier
ds_read_b128 a[116:119], v2 offset:0
ds_read_b128 a[120:123], v2 offset:1024
v_exp_f32 v59, v59
s_nop 0
v_cvt_pk_bf16_f32 v43, v58, v59
v_exp_f32 v44, v44
ds_read_b128 a[124:127], v2 offset:2048
ds_read_b128 a[128:131], v2 offset:3072
v_exp_f32 v45, v45
s_nop 0
v_cvt_pk_bf16_f32 v44, v44, v45
v_exp_f32 v46, v46
ds_read_b128 a[132:135], v2 offset:4096
ds_read_b128 a[136:139], v2 offset:5120
v_exp_f32 v47, v47
s_nop 0
v_cvt_pk_bf16_f32 v45, v46, v47
v_exp_f32 v60, v60
ds_read_b128 a[140:143], v2 offset:6144
ds_read_b128 a[144:147], v2 offset:7168
v_exp_f32 v61, v61
s_nop 0
v_cvt_pk_bf16_f32 v46, v60, v61
v_exp_f32 v62, v62
v_exp_f32 v63, v63
s_nop 0
v_cvt_pk_bf16_f32 v47, v62, v63
s_branch Lk2_ea
Lk2_m2:
s_cmp_eq_u32 s23, 0
s_cbranch_scc1 Lk2_m2a
s_branch Lk2_m2b
Lk2_m1b:
s_add_u32 m0, s29, 0
s_waitcnt lgkmcnt(4)
M v[32:35], a[116:119], a[0:3], 0
v_exp_f32 v128, v128
M v[32:35], a[120:123], a[4:7], v[32:35]
ds_read_b128 a[148:151], v3 offset:8192
ds_read_b128 a[152:155], v3 offset:9216
M v[32:35], a[124:127], a[8:11], v[32:35]
v_exp_f32 v129, v129
M v[32:35], a[128:131], a[12:15], v[32:35]
buffer_load_dwordx4 v1, s[12:15], s25 offen offset:0 sc1 lds
s_add_u32 s32, s25, 4096
M v[36:39], a[128:131], a[28:31], 0
v_exp_f32 v130, v130
M v[36:39], a[124:127], a[24:27], v[36:39]
v_cvt_pk_bf16_f32 v128, v128, v129
M v[36:39], a[120:123], a[20:23], v[36:39]
v_exp_f32 v131, v131
M v[36:39], a[116:119], a[16:19], v[36:39]
buffer_load_dwordx4 v1, s[12:15], s25 offen offset:1024 sc1 lds
M v[40:43], a[116:119], a[32:35], 0
v_exp_f32 v144, v144
M v[40:43], a[120:123], a[36:39], v[40:43]
ds_read_b128 a[156:159], v3 offset:10240
ds_read_b128 a[160:163], v3 offset:11264
M v[40:43], a[124:127], a[40:43], v[40:43]
v_exp_f32 v145, v145
M v[40:43], a[128:131], a[44:47], v[40:43]
buffer_load_dwordx4 v1, s[12:15], s25 offen offset:2048 sc1 lds
M v[44:47], a[128:131], a[60:63], 0
v_exp_f32 v146, v146
M v[44:47], a[124:127], a[56:59], v[44:47]
v_cvt_pk_bf16_f32 v129, v130, v131
v_cvt_pk_bf16_f32 v130, v144, v145
M v[44:47], a[120:123], a[52:55], v[44:47]
v_exp_f32 v147, v147
M v[44:47], a[116:119], a[48:51], v[44:47]
buffer_load_dwordx4 v1, s[12:15], s25 offen offset:3072 sc1 lds
s_add_u32 m0, s29, 4096
s_waitcnt lgkmcnt(4)
M v[48:51], a[132:135], a[0:3], 0
v_exp_f32 v132, v132
M v[48:51], a[136:139], a[4:7], v[48:51]
ds_read_b128 a[164:167], v3 offset:12288
ds_read_b128 a[168:171], v3 offset:13312
M v[48:51], a[140:143], a[8:11], v[48:51]
v_exp_f32 v133, v133
M v[48:51], a[144:147], a[12:15], v[48:51]
buffer_load_dwordx4 v1, s[12:15], s32 offen offset:0 sc1 lds
M v[52:55], a[144:147], a[28:31], 0
v_exp_f32 v134, v134
M v[52:55], a[140:143], a[24:27], v[52:55]
v_cvt_pk_bf16_f32 v131, v146, v147
v_cvt_pk_bf16_f32 v132, v132, v133
M v[52:55], a[136:139], a[20:23], v[52:55]
v_exp_f32 v135, v135
M v[52:55], a[132:135], a[16:19], v[52:55]
buffer_load_dwordx4 v1, s[12:15], s32 offen offset:1024 sc1 lds
M v[56:59], a[132:135], a[32:35], 0
v_exp_f32 v148, v148
M v[56:59], a[136:139], a[36:39], v[56:59]
ds_read_b128 a[172:175], v3 offset:14336
ds_read_b128 a[176:179], v3 offset:15360
M v[56:59], a[140:143], a[40:43], v[56:59]
v_exp_f32 v149, v149
M v[56:59], a[144:147], a[44:47], v[56:59]
buffer_load_dwordx4 v1, s[12:15], s32 offen offset:2048 sc1 lds
M v[60:63], a[144:147], a[60:63], 0
v_exp_f32 v150, v150
M v[60:63], a[140:143], a[56:59], v[60:63]
v_cvt_pk_bf16_f32 v133, v134, v135
v_cvt_pk_bf16_f32 v134, v148, v149
M v[60:63], a[136:139], a[52:55], v[60:63]
v_exp_f32 v151, v151
M v[60:63], a[132:135], a[48:51], v[60:63]
buffer_load_dwordx4 v1, s[12:15], s32 offen offset:3072 sc1 lds
s_add_u32 m0, s29, 32768
s_waitcnt lgkmcnt(4)
M v[64:67], a[148:151], a[0:3], 0
v_exp_f32 v136, v136
M v[64:67], a[152:155], a[4:7], v[64:67]
ds_read_b128 a[116:119], v6 offset:32768
ds_read_b128 a[120:123], v6 offset:40960
M v[64:67], a[156:159], a[8:11], v[64:67]
v_exp_f32 v137, v137
M v[64:67], a[160:163], a[12:15], v[64:67]
buffer_load_dwordx4 v1, s[12:15], s26 offen offset:0 sc1 lds
s_add_u32 s43, s26, 4096
M v[68:71], a[160:163], a[28:31], 0
v_exp_f32 v138, v138
M v[68:71], a[156:159], a[24:27], v[68:71]
v_cvt_pk_bf16_f32 v135, v150, v151
v_cvt_pk_bf16_f32 v136, v136, v137
M v[68:71], a[152:155], a[20:23], v[68:71]
v_exp_f32 v139, v139
M v[68:71], a[148:151], a[16:19], v[68:71]
buffer_load_dwordx4 v1, s[12:15], s26 offen offset:1024 sc1 lds
M v[72:75], a[148:151], a[32:35], 0
v_exp_f32 v152, v152
M v[72:75], a[152:155], a[36:39], v[72:75]
ds_read_b128 a[124:127], v6 offset:33792
ds_read_b128 a[128:131], v6 offset:41984
M v[72:75], a[156:159], a[40:43], v[72:75]
v_exp_f32 v153, v153
M v[72:75], a[160:163], a[44:47], v[72:75]
buffer_load_dwordx4 v1, s[12:15], s26 offen offset:2048 sc1 lds
M v[76:79], a[160:163], a[60:63], 0
v_exp_f32 v154, v154
M v[76:79], a[156:159], a[56:59], v[76:79]
v_cvt_pk_bf16_f32 v137, v138, v139
v_cvt_pk_bf16_f32 v138, v152, v153
M v[76:79], a[152:155], a[52:55], v[76:79]
v_exp_f32 v155, v155
M v[76:79], a[148:151], a[48:51], v[76:79]
buffer_load_dwordx4 v1, s[12:15], s26 offen offset:3072 sc1 lds
s_add_u32 m0, s29, 36864
s_waitcnt lgkmcnt(4)
M v[80:83], a[164:167], a[0:3], 0
v_exp_f32 v140, v140
M v[80:83], a[168:171], a[4:7], v[80:83]
ds_read_b128 a[132:135], v6 offset:34816
ds_read_b128 a[136:139], v6 offset:43008
M v[80:83], a[172:175], a[8:11], v[80:83]
v_exp_f32 v141, v141
M v[80:83], a[176:179], a[12:15], v[80:83]
buffer_load_dwordx4 v1, s[12:15], s43 offen offset:0 sc1 lds
M v[84:87], a[176:179], a[28:31], 0
v_exp_f32 v142, v142
M v[84:87], a[172:175], a[24:27], v[84:87]
v_cvt_pk_bf16_f32 v139, v154, v155
v_cvt_pk_bf16_f32 v140, v140, v141
M v[84:87], a[168:171], a[20:23], v[84:87]
v_exp_f32 v143, v143
M v[84:87], a[164:167], a[16:19], v[84:87]
buffer_load_dwordx4 v1, s[12:15], s43 offen offset:1024 sc1 lds
M v[88:91], a[164:167], a[32:35], 0
v_exp_f32 v156, v156
M v[88:91], a[168:171], a[36:39], v[88:91]
ds_read_b128 a[140:143], v6 offset:35840
ds_read_b128 a[144:147], v6 offset:44032
M v[88:91], a[172:175], a[40:43], v[88:91]
v_exp_f32 v157, v157
M v[88:91], a[176:179], a[44:47], v[88:91]
buffer_load_dwordx4 v1, s[12:15], s43 offen offset:2048 sc1 lds
M v[92:95], a[176:179], a[60:63], 0
v_exp_f32 v158, v158
M v[92:95], a[172:175], a[56:59], v[92:95]
v_cvt_pk_bf16_f32 v141, v142, v143
v_cvt_pk_bf16_f32 v142, v156, v157
M v[92:95], a[168:171], a[52:55], v[92:95]
v_exp_f32 v159, v159
M v[92:95], a[164:167], a[48:51], v[92:95]
buffer_load_dwordx4 v1, s[12:15], s43 offen offset:3072 sc1 lds
v_cvt_pk_bf16_f32 v143, v158, v159
s_waitcnt lgkmcnt(6)
M v[160:163], a[116:119], v[96:99], v[160:163]
v_exp_f32 v32, v32
M v[160:163], a[120:123], v[128:131], v[160:163]
ds_read_b128 a[148:151], v6 offset:36864
ds_read_b128 a[152:155], v6 offset:45056
M v[164:167], a[120:123], v[132:135], v[164:167]
v_exp_f32 v33, v33
M v[164:167], a[116:119], v[100:103], v[164:167]
v_cvt_pk_bf16_f32 v32, v32, v33
M v[168:171], a[116:119], v[104:107], v[168:171]
v_exp_f32 v34, v34
M v[168:171], a[120:123], v[136:139], v[168:171]
s_add_u32 s25, s25, 32768
s_cmp_eq_u32 s25, s27
M v[172:175], a[120:123], v[140:143], v[172:175]
v_exp_f32 v35, v35
M v[172:175], a[116:119], v[108:111], v[172:175]
v_cvt_pk_bf16_f32 v33, v34, v35
s_waitcnt lgkmcnt(6)
M a[96:99], a[112:115], v[96:99], a[96:99]
s_cselect_b32 s25, s28, s25
s_cselect_b32 s27, -1, s27
M a[96:99], a[112:115], v[128:131], a[96:99]
s_add_u32 s26, s26, 32768
s_cmp_eq_u32 s26, s62
M v[176:179], a[124:127], v[96:99], v[176:179]
v_exp_f32 v48, v48
M v[176:179], a[128:131], v[128:131], v[176:179]
ds_read_b128 a[156:159], v6 offset:37888
ds_read_b128 a[160:163], v6 offset:46080
M v[180:183], a[128:131], v[132:135], v[180:183]
v_exp_f32 v49, v49
M v[180:183], a[124:127], v[100:103], v[180:183]
v_cvt_pk_bf16_f32 v34, v48, v49
M v[184:187], a[124:127], v[104:107], v[184:187]
v_exp_f32 v50, v50
M v[184:187], a[128:131], v[136:139], v[184:187]
s_cselect_b32 s26, s63, s26
s_cselect_b32 s62, -1, s62
M v[188:191], a[128:131], v[140:143], v[188:191]
v_exp_f32 v51, v51
M v[188:191], a[124:127], v[108:111], v[188:191]
v_cvt_pk_bf16_f32 v35, v50, v51
s_waitcnt lgkmcnt(6)
M a[100:103], a[112:115], v[100:103], a[100:103]
M a[100:103], a[112:115], v[132:135], a[100:103]
M v[192:195], a[132:135], v[96:99], v[192:195]
v_exp_f32 v36, v36
M v[192:195], a[136:139], v[128:131], v[192:195]
ds_read_b128 a[164:167], v6 offset:38912
ds_read_b128 a[168:171], v6 offset:47104
M v[196:199], a[136:139], v[132:135], v[196:199]
v_exp_f32 v37, v37
M v[196:199], a[132:135], v[100:103], v[196:199]
v_cvt_pk_bf16_f32 v36, v36, v37
M v[200:203], a[132:135], v[104:107], v[200:203]
v_exp_f32 v38, v38
M v[200:203], a[136:139], v[136:139], v[200:203]
M v[204:207], a[136:139], v[140:143], v[204:207]
v_exp_f32 v39, v39
M v[204:207], a[132:135], v[108:111], v[204:207]
v_cvt_pk_bf16_f32 v37, v38, v39
s_waitcnt lgkmcnt(6)
M a[104:107], a[112:115], v[104:107], a[104:107]
M a[104:107], a[112:115], v[136:139], a[104:107]
M v[208:211], a[140:143], v[96:99], v[208:211]
v_exp_f32 v52, v52
M v[208:211], a[144:147], v[128:131], v[208:211]
ds_read_b128 a[172:175], v6 offset:39936
ds_read_b128 a[176:179], v6 offset:48128
M v[212:215], a[144:147], v[132:135], v[212:215]
v_exp_f32 v53, v53
M v[212:215], a[140:143], v[100:103], v[212:215]
v_cvt_pk_bf16_f32 v38, v52, v53
M v[216:219], a[140:143], v[104:107], v[216:219]
v_exp_f32 v54, v54
M v[216:219], a[144:147], v[136:139], v[216:219]
M v[220:223], a[144:147], v[140:143], v[220:223]
v_exp_f32 v55, v55
M v[220:223], a[140:143], v[108:111], v[220:223]
v_cvt_pk_bf16_f32 v39, v54, v55
s_waitcnt lgkmcnt(6)
M a[108:111], a[112:115], v[108:111], a[108:111]
M a[108:111], a[112:115], v[140:143], a[108:111]
M v[224:227], a[148:151], v[96:99], v[224:227]
v_exp_f32 v40, v40
M v[224:227], a[152:155], v[128:131], v[224:227]
M v[228:231], a[152:155], v[132:135], v[228:231]
v_exp_f32 v41, v41
M v[228:231], a[148:151], v[100:103], v[228:231]
v_cvt_pk_bf16_f32 v40, v40, v41
M v[232:235], a[148:151], v[104:107], v[232:235]
v_exp_f32 v42, v42
M v[232:235], a[152:155], v[136:139], v[232:235]
M v[236:239], a[152:155], v[140:143], v[236:239]
v_exp_f32 v43, v43
M v[236:239], a[148:151], v[108:111], v[236:239]
v_cvt_pk_bf16_f32 v41, v42, v43
s_waitcnt lgkmcnt(4)
M v[240:243], a[156:159], v[96:99], v[240:243]
v_exp_f32 v56, v56
M v[240:243], a[160:163], v[128:131], v[240:243]
M v[244:247], a[160:163], v[132:135], v[244:247]
v_exp_f32 v57, v57
M v[244:247], a[156:159], v[100:103], v[244:247]
v_cvt_pk_bf16_f32 v42, v56, v57
M v[248:251], a[156:159], v[104:107], v[248:251]
v_exp_f32 v58, v58
M v[248:251], a[160:163], v[136:139], v[248:251]
s_waitcnt vmcnt(0) lgkmcnt(0)
s_barrier
ds_read_b128 a[116:119], v2 offset:0
ds_read_b128 a[120:123], v2 offset:1024
M v[252:255], a[160:163], v[140:143], v[252:255]
v_exp_f32 v59, v59
M v[252:255], a[156:159], v[108:111], v[252:255]
v_cvt_pk_bf16_f32 v43, v58, v59
M a[64:67], a[164:167], v[96:99], a[64:67]
v_exp_f32 v44, v44
M a[64:67], a[168:171], v[128:131], a[64:67]
ds_read_b128 a[124:127], v2 offset:2048
ds_read_b128 a[128:131], v2 offset:3072
M a[68:71], a[168:171], v[132:135], a[68:71]
v_exp_f32 v45, v45
M a[68:71], a[164:167], v[100:103], a[68:71]
v_cvt_pk_bf16_f32 v44, v44, v45
M a[72:75], a[164:167], v[104:107], a[72:75]
v_exp_f32 v46, v46
M a[72:75], a[168:171], v[136:139], a[72:75]
ds_read_b128 a[132:135], v2 offset:4096
ds_read_b128 a[136:139], v2 offset:5120
M a[76:79], a[168:171], v[140:143], a[76:79]
v_exp_f32 v47, v47
M a[76:79], a[164:167], v[108:111], a[76:79]
v_cvt_pk_bf16_f32 v45, v46, v47
M a[80:83], a[172:175], v[96:99], a[80:83]
v_exp_f32 v60, v60
M a[80:83], a[176:179], v[128:131], a[80:83]
ds_read_b128 a[140:143], v2 offset:6144
ds_read_b128 a[144:147], v2 offset:7168
M a[84:87], a[176:179], v[132:135], a[84:87]
v_exp_f32 v61, v61
M a[84:87], a[172:175], v[100:103], a[84:87]
v_cvt_pk_bf16_f32 v46, v60, v61
M a[88:91], a[172:175], v[104:107], a[88:91]
v_exp_f32 v62, v62
M a[88:91], a[176:179], v[136:139], a[88:91]
M a[92:95], a[176:179], v[140:143], a[92:95]
v_exp_f32 v63, v63
M a[92:95], a[172:175], v[108:111], a[92:95]
v_cvt_pk_bf16_f32 v47, v62, v63
Lk2_m2b:
s_sub_u32 s35, 15, s21
s_lshl_b32 s33, s20, 7
s_lshl_b32 s34, s35, 3
s_add_u32 s33, s33, s34
s_lshl_b32 s34, s23, 2
s_add_u32 s33, s33, s34
s_lshl_b32 s33, s33, 12
buffer_load_dwordx4 a[180:183], v1, s[8:11], s33 offen offset:0 sc1
buffer_load_dwordx4 a[184:187], v1, s[8:11], s33 offen offset:1024 sc1
buffer_load_dwordx4 a[188:191], v1, s[8:11], s33 offen offset:2048 sc1
buffer_load_dwordx4 a[192:195], v1, s[8:11], s33 offen offset:3072 sc1
s_add_u32 s33, s33, 4096
buffer_load_dwordx4 a[196:199], v1, s[8:11], s33 offen offset:0 sc1
buffer_load_dwordx4 a[200:203], v1, s[8:11], s33 offen offset:1024 sc1
buffer_load_dwordx4 a[204:207], v1, s[8:11], s33 offen offset:2048 sc1
buffer_load_dwordx4 a[208:211], v1, s[8:11], s33 offen offset:3072 sc1
s_add_u32 s33, s33, 4096
buffer_load_dwordx4 a[212:215], v1, s[8:11], s33 offen offset:0 sc1
buffer_load_dwordx4 a[216:219], v1, s[8:11], s33 offen offset:1024 sc1
buffer_load_dwordx4 a[220:223], v1, s[8:11], s33 offen offset:2048 sc1
buffer_load_dwordx4 a[224:227], v1, s[8:11], s33 offen offset:3072 sc1
s_add_u32 s33, s33, 4096
buffer_load_dwordx4 a[228:231], v1, s[8:11], s33 offen offset:0 sc1
buffer_load_dwordx4 a[232:235], v1, s[8:11], s33 offen offset:1024 sc1
buffer_load_dwordx4 a[236:239], v1, s[8:11], s33 offen offset:2048 sc1
buffer_load_dwordx4 a[240:243], v1, s[8:11], s33 offen offset:3072 sc1
s_add_u32 m0, s29, 65536
s_waitcnt lgkmcnt(4)
M v[96:99], a[116:119], a[0:3], v[16:19]
v_exp_f32 v64, v64
M v[96:99], a[120:123], a[4:7], v[96:99]
ds_read_b128 a[148:151], v2 offset:8192
ds_read_b128 a[152:155], v2 offset:9216
M v[96:99], a[124:127], a[8:11], v[96:99]
v_exp_f32 v65, v65
M v[96:99], a[128:131], a[12:15], v[96:99]
buffer_load_dwordx4 v1, s[12:15], s25 offen offset:0 sc1 lds
s_add_u32 s32, s25, 4096
M v[100:103], a[128:131], a[28:31], 0
v_exp_f32 v66, v66
M v[100:103], a[124:127], a[24:27], v[100:103]
v_cvt_pk_bf16_f32 v64, v64, v65
M v[100:103], a[120:123], a[20:23], v[100:103]
v_exp_f32 v67, v67
M v[100:103], a[116:119], a[16:19], v[100:103]
buffer_load_dwordx4 v1, s[12:15], s25 offen offset:1024 sc1 lds
M v[104:107], a[116:119], a[32:35], 0
v_exp_f32 v80, v80
M v[104:107], a[120:123], a[36:39], v[104:107]
ds_read_b128 a[156:159], v2 offset:10240
ds_read_b128 a[160:163], v2 offset:11264
M v[104:107], a[124:127], a[40:43], v[104:107]
v_exp_f32 v81, v81
M v[104:107], a[128:131], a[44:47], v[104:107]
buffer_load_dwordx4 v1, s[12:15], s25 offen offset:2048 sc1 lds
M v[108:111], a[128:131], a[60:63], 0
v_exp_f32 v82, v82
M v[108:111], a[124:127], a[56:59], v[108:111]
v_cvt_pk_bf16_f32 v65, v66, v67
v_cvt_pk_bf16_f32 v66, v80, v81
M v[108:111], a[120:123], a[52:55], v[108:111]
v_exp_f32 v83, v83
M v[108:111], a[116:119], a[48:51], v[108:111]
buffer_load_dwordx4 v1, s[12:15], s25 offen offset:3072 sc1 lds
s_add_u32 m0, s29, 69632
s_waitcnt lgkmcnt(4)
v_exp_f32 v68, v68
ds_read_b128 a[164:167], v2 offset:12288
ds_read_b128 a[168:171], v2 offset:13312
v_exp_f32 v69, v69
buffer_load_dwordx4 v1, s[12:15], s32 offen offset:0 sc1 lds
M v[116:119], a[144:147], a[28:31], v[16:19]
v_exp_f32 v70, v70
M v[116:119], a[140:143], a[24:27], v[116:119]
v_cvt_pk_bf16_f32 v67, v82, v83
v_cvt_pk_bf16_f32 v68, v68, v69
M v[116:119], a[136:139], a[20:23], v[116:119]
v_exp_f32 v71, v71
M v[116:119], a[132:135], a[16:19], v[116:119]
buffer_load_dwordx4 v1, s[12:15], s32 offen offset:1024 sc1 lds
M v[120:123], a[132:135], a[32:35], 0
v_exp_f32 v84, v84
M v[120:123], a[136:139], a[36:39], v[120:123]
ds_read_b128 a[172:175], v2 offset:14336
ds_read_b128 a[176:179], v2 offset:15360
M v[120:123], a[140:143], a[40:43], v[120:123]
v_exp_f32 v85, v85
M v[120:123], a[144:147], a[44:47], v[120:123]
buffer_load_dwordx4 v1, s[12:15], s32 offen offset:2048 sc1 lds
M v[124:127], a[144:147], a[60:63], 0
v_exp_f32 v86, v86
M v[124:127], a[140:143], a[56:59], v[124:127]
v_cvt_pk_bf16_f32 v69, v70, v71
v_cvt_pk_bf16_f32 v70, v84, v85
M v[124:127], a[136:139], a[52:55], v[124:127]
v_exp_f32 v87, v87
M v[124:127], a[132:135], a[48:51], v[124:127]
buffer_load_dwordx4 v1, s[12:15], s32 offen offset:3072 sc1 lds
s_add_u32 m0, s29, 98304
s_waitcnt lgkmcnt(4)
v_exp_f32 v72, v72
ds_read_b128 a[116:119], v5 offset:32768
ds_read_b128 a[120:123], v5 offset:40960
v_exp_f32 v73, v73
buffer_load_dwordx4 v1, s[12:15], s26 offen offset:0 sc1 lds
s_add_u32 s43, s26, 4096
v_exp_f32 v74, v74
v_cvt_pk_bf16_f32 v71, v86, v87
v_cvt_pk_bf16_f32 v72, v72, v73
v_exp_f32 v75, v75
buffer_load_dwordx4 v1, s[12:15], s26 offen offset:1024 sc1 lds
M v[136:139], a[148:151], a[32:35], v[16:19]
v_exp_f32 v88, v88
M v[136:139], a[152:155], a[36:39], v[136:139]
ds_read_b128 a[124:127], v5 offset:33792
ds_read_b128 a[128:131], v5 offset:41984
M v[136:139], a[156:159], a[40:43], v[136:139]
v_exp_f32 v89, v89
M v[136:139], a[160:163], a[44:47], v[136:139]
buffer_load_dwordx4 v1, s[12:15], s26 offen offset:2048 sc1 lds
M v[140:143], a[160:163], a[60:63], 0
v_exp_f32 v90, v90
M v[140:143], a[156:159], a[56:59], v[140:143]
v_cvt_pk_bf16_f32 v73, v74, v75
v_cvt_pk_bf16_f32 v74, v88, v89
M v[140:143], a[152:155], a[52:55], v[140:143]
v_exp_f32 v91, v91
M v[140:143], a[148:151], a[48:51], v[140:143]
buffer_load_dwordx4 v1, s[12:15], s26 offen offset:3072 sc1 lds
s_add_u32 m0, s29, 102400
s_waitcnt lgkmcnt(4)
v_exp_f32 v76, v76
ds_read_b128 a[132:135], v5 offset:34816
ds_read_b128 a[136:139], v5 offset:43008
v_exp_f32 v77, v77
buffer_load_dwordx4 v1, s[12:15], s43 offen offset:0 sc1 lds
v_exp_f32 v78, v78
v_cvt_pk_bf16_f32 v75, v90, v91
v_cvt_pk_bf16_f32 v76, v76, v77
v_exp_f32 v79, v79
buffer_load_dwordx4 v1, s[12:15], s43 offen offset:1024 sc1 lds
v_exp_f32 v92, v92
ds_read_b128 a[140:143], v5 offset:35840
ds_read_b128 a[144:147], v5 offset:44032
v_exp_f32 v93, v93
buffer_load_dwordx4 v1, s[12:15], s43 offen offset:2048 sc1 lds
M v[156:159], a[176:179], a[60:63], v[16:19]
v_exp_f32 v94, v94
M v[156:159], a[172:175], a[56:59], v[156:159]
v_cvt_pk_bf16_f32 v77, v78, v79
v_cvt_pk_bf16_f32 v78, v92, v93
M v[156:159], a[168:171], a[52:55], v[156:159]
v_exp_f32 v95, v95
M v[156:159], a[164:167], a[48:51], v[156:159]
buffer_load_dwordx4 v1, s[12:15], s43 offen offset:3072 sc1 lds
v_cvt_pk_bf16_f32 v79, v94, v95
s_waitcnt lgkmcnt(6)
M v[160:163], a[116:119], v[32:35], v[160:163]
v_exp_f32 v96, v96
M v[160:163], a[120:123], v[64:67], v[160:163]
ds_read_b128 a[148:151], v5 offset:36864
ds_read_b128 a[152:155], v5 offset:45056
M v[164:167], a[120:123], v[68:71], v[164:167]
v_exp_f32 v97, v97
M v[164:167], a[116:119], v[36:39], v[164:167]
v_cvt_pk_bf16_f32 v96, v96, v97
M v[168:171], a[116:119], v[40:43], v[168:171]
v_exp_f32 v98, v98
M v[168:171], a[120:123], v[72:75], v[168:171]
s_add_u32 s25, s25, 32768
s_cmp_eq_u32 s25, s27
M v[172:175], a[120:123], v[76:79], v[172:175]
v_exp_f32 v99, v99
M v[172:175], a[116:119], v[44:47], v[172:175]
v_cvt_pk_bf16_f32 v97, v98, v99
s_waitcnt lgkmcnt(6)
M a[96:99], a[112:115], v[32:35], a[96:99]
s_cselect_b32 s25, s28, s25
s_cselect_b32 s27, -1, s27
M a[96:99], a[112:115], v[64:67], a[96:99]
s_add_u32 s26, s26, 32768
s_cmp_eq_u32 s26, s62
M v[176:179], a[124:127], v[32:35], v[176:179]
M v[176:179], a[128:131], v[64:67], v[176:179]
ds_read_b128 a[156:159], v5 offset:37888
ds_read_b128 a[160:163], v5 offset:46080
M v[180:183], a[128:131], v[68:71], v[180:183]
M v[180:183], a[124:127], v[36:39], v[180:183]
v_mov_b32 v98, 0
M v[184:187], a[124:127], v[40:43], v[184:187]
M v[184:187], a[128:131], v[72:75], v[184:187]
s_cselect_b32 s26, s63, s26
s_cselect_b32 s62, -1, s62
M v[188:191], a[128:131], v[76:79], v[188:191]
M v[188:191], a[124:127], v[44:47], v[188:191]
v_mov_b32 v99, 0
s_waitcnt lgkmcnt(6)
M a[100:103], a[112:115], v[36:39], a[100:103]
M a[100:103], a[112:115], v[68:71], a[100:103]
M v[192:195], a[132:135], v[32:35], v[192:195]
v_exp_f32 v100, v100
M v[192:195], a[136:139], v[64:67], v[192:195]
ds_read_b128 a[164:167], v5 offset:38912
ds_read_b128 a[168:171], v5 offset:47104
M v[196:199], a[136:139], v[68:71], v[196:199]
v_exp_f32 v101, v101
M v[196:199], a[132:135], v[36:39], v[196:199]
v_cvt_pk_bf16_f32 v100, v100, v101
M v[200:203], a[132:135], v[40:43], v[200:203]
v_exp_f32 v102, v102
M v[200:203], a[136:139], v[72:75], v[200:203]
M v[204:207], a[136:139], v[76:79], v[204:207]
v_exp_f32 v103, v103
M v[204:207], a[132:135], v[44:47], v[204:207]
v_cvt_pk_bf16_f32 v101, v102, v103
s_waitcnt lgkmcnt(6)
M a[104:107], a[112:115], v[40:43], a[104:107]
M a[104:107], a[112:115], v[72:75], a[104:107]
M v[208:211], a[140:143], v[32:35], v[208:211]
v_exp_f32 v116, v116
M v[208:211], a[144:147], v[64:67], v[208:211]
ds_read_b128 a[172:175], v5 offset:39936
ds_read_b128 a[176:179], v5 offset:48128
M v[212:215], a[144:147], v[68:71], v[212:215]
v_exp_f32 v117, v117
M v[212:215], a[140:143], v[36:39], v[212:215]
v_cvt_pk_bf16_f32 v102, v116, v117
M v[216:219], a[140:143], v[40:43], v[216:219]
v_exp_f32 v118, v118
M v[216:219], a[144:147], v[72:75], v[216:219]
M v[220:223], a[144:147], v[76:79], v[220:223]
v_exp_f32 v119, v119
M v[220:223], a[140:143], v[44:47], v[220:223]
v_cvt_pk_bf16_f32 v103, v118, v119
s_waitcnt lgkmcnt(6)
M a[108:111], a[112:115], v[44:47], a[108:111]
M a[108:111], a[112:115], v[76:79], a[108:111]
M v[224:227], a[148:151], v[32:35], v[224:227]
v_exp_f32 v104, v104
M v[224:227], a[152:155], v[64:67], v[224:227]
M v[228:231], a[152:155], v[68:71], v[228:231]
v_exp_f32 v105, v105
M v[228:231], a[148:151], v[36:39], v[228:231]
v_cvt_pk_bf16_f32 v104, v104, v105
M v[232:235], a[148:151], v[40:43], v[232:235]
v_exp_f32 v106, v106
M v[232:235], a[152:155], v[72:75], v[232:235]
M v[236:239], a[152:155], v[76:79], v[236:239]
v_exp_f32 v107, v107
M v[236:239], a[148:151], v[44:47], v[236:239]
v_cvt_pk_bf16_f32 v105, v106, v107
s_waitcnt lgkmcnt(4)
M v[240:243], a[156:159], v[32:35], v[240:243]
v_exp_f32 v120, v120
M v[240:243], a[160:163], v[64:67], v[240:243]
M v[244:247], a[160:163], v[68:71], v[244:247]
v_exp_f32 v121, v121
M v[244:247], a[156:159], v[36:39], v[244:247]
v_cvt_pk_bf16_f32 v106, v120, v121
M v[248:251], a[156:159], v[40:43], v[248:251]
v_exp_f32 v122, v122
M v[248:251], a[160:163], v[72:75], v[248:251]
s_waitcnt vmcnt(0) lgkmcnt(0)
s_barrier
ds_read_b128 a[116:119], v3 offset:0
ds_read_b128 a[120:123], v3 offset:1024
M v[252:255], a[160:163], v[76:79], v[252:255]
v_exp_f32 v123, v123
M v[252:255], a[156:159], v[44:47], v[252:255]
v_cvt_pk_bf16_f32 v107, v122, v123
M a[64:67], a[164:167], v[32:35], a[64:67]
v_exp_f32 v108, v108
M a[64:67], a[168:171], v[64:67], a[64:67]
ds_read_b128 a[124:127], v3 offset:2048
ds_read_b128 a[128:131], v3 offset:3072
M a[68:71], a[168:171], v[68:71], a[68:71]
v_exp_f32 v109, v109
M a[68:71], a[164:167], v[36:39], a[68:71]
v_cvt_pk_bf16_f32 v108, v108, v109
M a[72:75], a[164:167], v[40:43], a[72:75]
v_exp_f32 v110, v110
M a[72:75], a[168:171], v[72:75], a[72:75]
ds_read_b128 a[132:135], v3 offset:4096
ds_read_b128 a[136:139], v3 offset:5120
M a[76:79], a[168:171], v[76:79], a[76:79]
v_exp_f32 v111, v111
M a[76:79], a[164:167], v[44:47], a[76:79]
v_cvt_pk_bf16_f32 v109, v110, v111
M a[80:83], a[172:175], v[32:35], a[80:83]
v_exp_f32 v124, v124
M a[80:83], a[176:179], v[64:67], a[80:83]
ds_read_b128 a[140:143], v3 offset:6144
ds_read_b128 a[144:147], v3 offset:7168
M a[84:87], a[176:179], v[68:71], a[84:87]
v_exp_f32 v125, v125
M a[84:87], a[172:175], v[36:39], a[84:87]
v_cvt_pk_bf16_f32 v110, v124, v125
M a[88:91], a[172:175], v[40:43], a[88:91]
v_exp_f32 v126, v126
M a[88:91], a[176:179], v[72:75], a[88:91]
M a[92:95], a[176:179], v[76:79], a[92:95]
v_exp_f32 v127, v127
M a[92:95], a[172:175], v[44:47], a[92:95]
v_cvt_pk_bf16_f32 v111, v126, v127
s_waitcnt vmcnt(16)
s_add_u32 m0, s29, 0
s_waitcnt lgkmcnt(4)
M v[32:35], a[116:119], a[180:183], 0
M v[32:35], a[120:123], a[184:187], v[32:35]
ds_read_b128 a[148:151], v3 offset:8192
ds_read_b128 a[152:155], v3 offset:9216
M v[32:35], a[124:127], a[188:191], v[32:35]
M v[32:35], a[128:131], a[192:195], v[32:35]
buffer_load_dwordx4 v1, s[12:15], s25 offen offset:0 sc1 lds
s_add_u32 s32, s25, 4096
M v[36:39], a[128:131], a[208:211], 0
M v[36:39], a[124:127], a[204:207], v[36:39]
M v[36:39], a[120:123], a[200:203], v[36:39]
M v[36:39], a[116:119], a[196:199], v[36:39]
buffer_load_dwordx4 v1, s[12:15], s25 offen offset:1024 sc1 lds
M v[40:43], a[116:119], a[212:215], 0
M v[40:43], a[120:123], a[216:219], v[40:43]
ds_read_b128 a[156:159], v3 offset:10240
ds_read_b128 a[160:163], v3 offset:11264
M v[40:43], a[124:127], a[220:223], v[40:43]
M v[40:43], a[128:131], a[224:227], v[40:43]
buffer_load_dwordx4 v1, s[12:15], s25 offen offset:2048 sc1 lds
M v[44:47], a[128:131], a[240:243], 0
M v[44:47], a[124:127], a[236:239], v[44:47]
M v[44:47], a[120:123], a[232:235], v[44:47]
M v[44:47], a[116:119], a[228:231], v[44:47]
buffer_load_dwordx4 v1, s[12:15], s25 offen offset:3072 sc1 lds
s_add_u32 m0, s29, 4096
s_waitcnt lgkmcnt(4)
M v[48:51], a[132:135], a[180:183], 0
M v[48:51], a[136:139], a[184:187], v[48:51]
ds_read_b128 a[164:167], v3 offset:12288
ds_read_b128 a[168:171], v3 offset:13312
M v[48:51], a[140:143], a[188:191], v[48:51]
M v[48:51], a[144:147], a[192:195], v[48:51]
buffer_load_dwordx4 v1, s[12:15], s32 offen offset:0 sc1 lds
M v[52:55], a[144:147], a[208:211], 0
M v[52:55], a[140:143], a[204:207], v[52:55]
M v[52:55], a[136:139], a[200:203], v[52:55]
M v[52:55], a[132:135], a[196:199], v[52:55]
buffer_load_dwordx4 v1, s[12:15], s32 offen offset:1024 sc1 lds
M v[56:59], a[132:135], a[212:215], 0
M v[56:59], a[136:139], a[216:219], v[56:59]
ds_read_b128 a[172:175], v3 offset:14336
ds_read_b128 a[176:179], v3 offset:15360
M v[56:59], a[140:143], a[220:223], v[56:59]
M v[56:59], a[144:147], a[224:227], v[56:59]
buffer_load_dwordx4 v1, s[12:15], s32 offen offset:2048 sc1 lds
M v[60:63], a[144:147], a[240:243], 0
M v[60:63], a[140:143], a[236:239], v[60:63]
M v[60:63], a[136:139], a[232:235], v[60:63]
M v[60:63], a[132:135], a[228:231], v[60:63]
buffer_load_dwordx4 v1, s[12:15], s32 offen offset:3072 sc1 lds
s_add_u32 m0, s29, 32768
s_waitcnt lgkmcnt(4)
M v[64:67], a[148:151], a[180:183], 0
v_exp_f32 v136, v136
M v[64:67], a[152:155], a[184:187], v[64:67]
ds_read_b128 a[116:119], v6 offset:32768
ds_read_b128 a[120:123], v6 offset:40960
M v[64:67], a[156:159], a[188:191], v[64:67]
v_exp_f32 v137, v137
M v[64:67], a[160:163], a[192:195], v[64:67]
buffer_load_dwordx4 v1, s[12:15], s26 offen offset:0 sc1 lds
s_add_u32 s43, s26, 4096
M v[68:71], a[160:163], a[208:211], 0
v_exp_f32 v138, v138
M v[68:71], a[156:159], a[204:207], v[68:71]
v_cvt_pk_bf16_f32 v136, v136, v137
M v[68:71], a[152:155], a[200:203], v[68:71]
v_exp_f32 v139, v139
M v[68:71], a[148:151], a[196:199], v[68:71]
buffer_load_dwordx4 v1, s[12:15], s26 offen offset:1024 sc1 lds
M v[72:75], a[148:151], a[212:215], 0
M v[72:75], a[152:155], a[216:219], v[72:75]
ds_read_b128 a[124:127], v6 offset:33792
ds_read_b128 a[128:131], v6 offset:41984
M v[72:75], a[156:159], a[220:223], v[72:75]
M v[72:75], a[160:163], a[224:227], v[72:75]
buffer_load_dwordx4 v1, s[12:15], s26 offen offset:2048 sc1 lds
M v[76:79], a[160:163], a[240:243], 0
M v[76:79], a[156:159], a[236:239], v[76:79]
v_cvt_pk_bf16_f32 v137, v138, v139
v_mov_b32 v138, 0
M v[76:79], a[152:155], a[232:235], v[76:79]
M v[76:79], a[148:151], a[228:231], v[76:79]
buffer_load_dwordx4 v1, s[12:15], s26 offen offset:3072 sc1 lds
s_add_u32 m0, s29, 36864
s_waitcnt lgkmcnt(4)
M v[80:83], a[164:167], a[180:183], 0
v_exp_f32 v140, v140
M v[80:83], a[168:171], a[184:187], v[80:83]
ds_read_b128 a[132:135], v6 offset:34816
ds_read_b128 a[136:139], v6 offset:43008
M v[80:83], a[172:175], a[188:191], v[80:83]
v_exp_f32 v141, v141
M v[80:83], a[176:179], a[192:195], v[80:83]
buffer_load_dwordx4 v1, s[12:15], s43 offen offset:0 sc1 lds
M v[84:87], a[176:179], a[208:211], 0
v_exp_f32 v142, v142
M v[84:87], a[172:175], a[204:207], v[84:87]
v_mov_b32 v139, 0
v_cvt_pk_bf16_f32 v140, v140, v141
M v[84:87], a[168:171], a[200:203], v[84:87]
v_exp_f32 v143, v143
M v[84:87], a[164:167], a[196:199], v[84:87]
buffer_load_dwordx4 v1, s[12:15], s43 offen offset:1024 sc1 lds
M v[88:91], a[164:167], a[212:215], 0
v_exp_f32 v156, v156
M v[88:91], a[168:171], a[216:219], v[88:91]
ds_read_b128 a[140:143], v6 offset:35840
ds_read_b128 a[144:147], v6 offset:44032
M v[88:91], a[172:175], a[220:223], v[88:91]
v_exp_f32 v157, v157
M v[88:91], a[176:179], a[224:227], v[88:91]
buffer_load_dwordx4 v1, s[12:15], s43 offen offset:2048 sc1 lds
M v[92:95], a[176:179], a[240:243], 0
v_exp_f32 v158, v158
M v[92:95], a[172:175], a[236:239], v[92:95]
v_cvt_pk_bf16_f32 v141, v142, v143
v_cvt_pk_bf16_f32 v142, v156, v157
M v[92:95], a[168:171], a[232:235], v[92:95]
v_exp_f32 v159, v159
M v[92:95], a[164:167], a[228:231], v[92:95]
buffer_load_dwordx4 v1, s[12:15], s43 offen offset:3072 sc1 lds
v_cvt_pk_bf16_f32 v143, v158, v159
s_waitcnt lgkmcnt(6)
M v[160:163], a[116:119], v[96:99], v[160:163]
v_exp_f32 v32, v32
ds_read_b128 a[148:151], v6 offset:36864
ds_read_b128 a[152:155], v6 offset:45056
v_exp_f32 v33, v33
M v[164:167], a[116:119], v[100:103], v[164:167]
v_cvt_pk_bf16_f32 v32, v32, v33
M v[168:171], a[116:119], v[104:107], v[168:171]
v_exp_f32 v34, v34
M v[168:171], a[120:123], v[136:139], v[168:171]
s_add_u32 s25, s25, 32768
s_cmp_eq_u32 s25, s27
M v[172:175], a[120:123], v[140:143], v[172:175]
v_exp_f32 v35, v35
M v[172:175], a[116:119], v[108:111], v[172:175]
v_cvt_pk_bf16_f32 v33, v34, v35
s_waitcnt lgkmcnt(6)
M a[96:99], a[112:115], v[96:99], a[96:99]
s_cselect_b32 s25, s28, s25
s_cselect_b32 s27, -1, s27
s_add_u32 s26, s26, 32768
s_cmp_eq_u32 s26, s62
M v[176:179], a[124:127], v[96:99], v[176:179]
v_exp_f32 v48, v48
ds_read_b128 a[156:159], v6 offset:37888
ds_read_b128 a[160:163], v6 offset:46080
v_exp_f32 v49, v49
M v[180:183], a[124:127], v[100:103], v[180:183]
v_cvt_pk_bf16_f32 v34, v48, v49
M v[184:187], a[124:127], v[104:107], v[184:187]
v_exp_f32 v50, v50
M v[184:187], a[128:131], v[136:139], v[184:187]
s_cselect_b32 s26, s63, s26
s_cselect_b32 s62, -1, s62
M v[188:191], a[128:131], v[140:143], v[188:191]
v_exp_f32 v51, v51
M v[188:191], a[124:127], v[108:111], v[188:191]
v_cvt_pk_bf16_f32 v35, v50, v51
s_waitcnt lgkmcnt(6)
M a[100:103], a[112:115], v[100:103], a[100:103]
M v[192:195], a[132:135], v[96:99], v[192:195]
v_exp_f32 v36, v36
ds_read_b128 a[164:167], v6 offset:38912
ds_read_b128 a[168:171], v6 offset:47104
v_exp_f32 v37, v37
M v[196:199], a[132:135], v[100:103], v[196:199]
v_cvt_pk_bf16_f32 v36, v36, v37
M v[200:203], a[132:135], v[104:107], v[200:203]
v_exp_f32 v38, v38
M v[200:203], a[136:139], v[136:139], v[200:203]
M v[204:207], a[136:139], v[140:143], v[204:207]
v_exp_f32 v39, v39
M v[204:207], a[132:135], v[108:111], v[204:207]
v_cvt_pk_bf16_f32 v37, v38, v39
s_waitcnt lgkmcnt(6)
M a[104:107], a[112:115], v[104:107], a[104:107]
M a[104:107], a[112:115], v[136:139], a[104:107]
M v[208:211], a[140:143], v[96:99], v[208:211]
v_exp_f32 v52, v52
ds_read_b128 a[172:175], v6 offset:39936
ds_read_b128 a[176:179], v6 offset:48128
v_exp_f32 v53, v53
M v[212:215], a[140:143], v[100:103], v[212:215]
v_cvt_pk_bf16_f32 v38, v52, v53
M v[216:219], a[140:143], v[104:107], v[216:219]
v_exp_f32 v54, v54
M v[216:219], a[144:147], v[136:139], v[216:219]
M v[220:223], a[144:147], v[140:143], v[220:223]
v_exp_f32 v55, v55
M v[220:223], a[140:143], v[108:111], v[220:223]
v_cvt_pk_bf16_f32 v39, v54, v55
s_waitcnt lgkmcnt(6)
M a[108:111], a[112:115], v[108:111], a[108:111]
M a[108:111], a[112:115], v[140:143], a[108:111]
M v[224:227], a[148:151], v[96:99], v[224:227]
v_exp_f32 v40, v40
v_exp_f32 v41, v41
M v[228:231], a[148:151], v[100:103], v[228:231]
v_cvt_pk_bf16_f32 v40, v40, v41
M v[232:235], a[148:151], v[104:107], v[232:235]
v_exp_f32 v42, v42
M v[232:235], a[152:155], v[136:139], v[232:235]
M v[236:239], a[152:155], v[140:143], v[236:239]
v_exp_f32 v43, v43
M v[236:239], a[148:151], v[108:111], v[236:239]
v_cvt_pk_bf16_f32 v41, v42, v43
s_waitcnt lgkmcnt(4)
M v[240:243], a[156:159], v[96:99], v[240:243]
v_exp_f32 v56, v56
v_exp_f32 v57, v57
M v[244:247], a[156:159], v[100:103], v[244:247]
v_cvt_pk_bf16_f32 v42, v56, v57
M v[248:251], a[156:159], v[104:107], v[248:251]
v_exp_f32 v58, v58
M v[248:251], a[160:163], v[136:139], v[248:251]
s_waitcnt vmcnt(0) lgkmcnt(0)
s_barrier
ds_read_b128 a[116:119], v2 offset:0
ds_read_b128 a[120:123], v2 offset:1024
M v[252:255], a[160:163], v[140:143], v[252:255]
v_exp_f32 v59, v59
M v[252:255], a[156:159], v[108:111], v[252:255]
v_cvt_pk_bf16_f32 v43, v58, v59
M a[64:67], a[164:167], v[96:99], a[64:67]
v_exp_f32 v44, v44
ds_read_b128 a[124:127], v2 offset:2048
ds_read_b128 a[128:131], v2 offset:3072
v_exp_f32 v45, v45
M a[68:71], a[164:167], v[100:103], a[68:71]
v_cvt_pk_bf16_f32 v44, v44, v45
M a[72:75], a[164:167], v[104:107], a[72:75]
v_exp_f32 v46, v46
M a[72:75], a[168:171], v[136:139], a[72:75]
ds_read_b128 a[132:135], v2 offset:4096
ds_read_b128 a[136:139], v2 offset:5120
M a[76:79], a[168:171], v[140:143], a[76:79]
v_exp_f32 v47, v47
M a[76:79], a[164:167], v[108:111], a[76:79]
v_cvt_pk_bf16_f32 v45, v46, v47
M a[80:83], a[172:175], v[96:99], a[80:83]
v_exp_f32 v60, v60
ds_read_b128 a[140:143], v2 offset:6144
ds_read_b128 a[144:147], v2 offset:7168
v_exp_f32 v61, v61
M a[84:87], a[172:175], v[100:103], a[84:87]
v_cvt_pk_bf16_f32 v46, v60, v61
M a[88:91], a[172:175], v[104:107], a[88:91]
v_exp_f32 v62, v62
M a[88:91], a[176:179], v[136:139], a[88:91]
M a[92:95], a[176:179], v[140:143], a[92:95]
v_exp_f32 v63, v63
M a[92:95], a[172:175], v[108:111], a[92:95]
v_cvt_pk_bf16_f32 v47, v62, v63
Lk2_ea:
v_accvgpr_read_b32 v20, a96
v_accvgpr_read_b32 v21, a100
v_accvgpr_read_b32 v22, a104
v_accvgpr_read_b32 v23, a108
v_rcp_f32 v8, v20
v_rcp_f32 v9, v21
v_rcp_f32 v10, v22
v_rcp_f32 v11, v23
v_subrev_u32 v20, 0x21800000, v20
v_subrev_u32 v21, 0x21800000, v21
v_subrev_u32 v22, 0x21800000, v22
v_subrev_u32 v23, 0x21800000, v23
v_max_u32 v12, v20, v21
v_max3_u32 v12, v12, v22, v23
s_mov_b32 s64, 0x207
s_lshl_b32 s33, s21, 20
s_lshl_b32 s34, s20, 15
s_add_u32 s33, s33, s34
s_lshl_b32 s34, s23, 13
s_add_u32 s36, s33, s34
s_add_u32 s37, s36, 4096
s_add_u32 s38, s36, 16384
s_add_u32 s39, s36, 20480
v_pk_mul_f32 v[160:161], v[160:161], v[8:9] op_sel:[0,0] op_sel_hi:[1,0]
v_pk_mul_f32 v[162:163], v[162:163], v[8:9] op_sel:[0,0] op_sel_hi:[1,0]
v_pk_mul_f32 v[176:177], v[176:177], v[8:9] op_sel:[0,0] op_sel_hi:[1,0]
v_pk_mul_f32 v[178:179], v[178:179], v[8:9] op_sel:[0,0] op_sel_hi:[1,0]
v_cvt_pk_bf16_f32 v160, v160, v161
v_cvt_pk_bf16_f32 v161, v162, v163
v_cvt_pk_bf16_f32 v162, v176, v177
v_cvt_pk_bf16_f32 v163, v178, v179
s_nop 1
M v[24:27], a[112:115], v[160:163], 0
buffer_store_dwordx4 v[160:163], v1, s[16:19], s36 offen offset:0 sc1
v_pk_mul_f32 v[164:165], v[164:165], v[8:9] op_sel:[0,1] op_sel_hi:[1,1]
v_pk_mul_f32 v[166:167], v[166:167], v[8:9] op_sel:[0,1] op_sel_hi:[1,1]
v_pk_mul_f32 v[180:181], v[180:181], v[8:9] op_sel:[0,1] op_sel_hi:[1,1]
v_pk_mul_f32 v[182:183], v[182:183], v[8:9] op_sel:[0,1] op_sel_hi:[1,1]
v_cvt_pk_bf16_f32 v164, v164, v165
v_cvt_pk_bf16_f32 v165, v166, v167
v_cvt_pk_bf16_f32 v166, v180, v181
v_cvt_pk_bf16_f32 v167, v182, v183
s_nop 1
M v[24:27], a[112:115], v[164:167], v[24:27]
buffer_store_dwordx4 v[164:167], v1, s[16:19], s36 offen offset:2048 sc1
v_pk_mul_f32 v[168:169], v[168:169], v[10:11] op_sel:[0,0] op_sel_hi:[1,0]
v_pk_mul_f32 v[170:171], v[170:171], v[10:11] op_sel:[0,0] op_sel_hi:[1,0]
v_pk_mul_f32 v[184:185], v[184:185], v[10:11] op_sel:[0,0] op_sel_hi:[1,0]
v_pk_mul_f32 v[186:187], v[186:187], v[10:11] op_sel:[0,0] op_sel_hi:[1,0]
v_cvt_pk_bf16_f32 v168, v168, v169
v_cvt_pk_bf16_f32 v169, v170, v171
v_cvt_pk_bf16_f32 v170, v184, v185
v_cvt_pk_bf16_f32 v171, v186, v187
s_nop 1
M v[24:27], a[112:115], v[168:171], v[24:27]
buffer_store_dwordx4 v[168:171], v1, s[16:19], s37 offen offset:0 sc1
v_pk_mul_f32 v[172:173], v[172:173], v[10:11] op_sel:[0,1] op_sel_hi:[1,1]
v_pk_mul_f32 v[174:175], v[174:175], v[10:11] op_sel:[0,1] op_sel_hi:[1,1]
v_pk_mul_f32 v[188:189], v[188:189], v[10:11] op_sel:[0,1] op_sel_hi:[1,1]
v_pk_mul_f32 v[190:191], v[190:191], v[10:11] op_sel:[0,1] op_sel_hi:[1,1]
v_cvt_pk_bf16_f32 v172, v172, v173
v_cvt_pk_bf16_f32 v173, v174, v175
v_cvt_pk_bf16_f32 v174, v188, v189
v_cvt_pk_bf16_f32 v175, v190, v191
s_nop 1
M v[24:27], a[112:115], v[172:175], v[24:27]
buffer_store_dwordx4 v[172:175], v1, s[16:19], s37 offen offset:2048 sc1
v_pk_mul_f32 v[192:193], v[192:193], v[8:9] op_sel:[0,0] op_sel_hi:[1,0]
v_pk_mul_f32 v[194:195], v[194:195], v[8:9] op_sel:[0,0] op_sel_hi:[1,0]
v_pk_mul_f32 v[208:209], v[208:209], v[8:9] op_sel:[0,0] op_sel_hi:[1,0]
v_pk_mul_f32 v[210:211], v[210:211], v[8:9] op_sel:[0,0] op_sel_hi:[1,0]
v_cvt_pk_bf16_f32 v192, v192, v193
v_cvt_pk_bf16_f32 v193, v194, v195
v_cvt_pk_bf16_f32 v194, v208, v209
v_cvt_pk_bf16_f32 v195, v210, v211
s_nop 1
M v[24:27], a[112:115], v[192:195], v[24:27]
buffer_store_dwordx4 v[192:195], v1, s[16:19], s36 offen offset:1024 sc1
v_pk_mul_f32 v[196:197], v[196:197], v[8:9] op_sel:[0,1] op_sel_hi:[1,1]
v_pk_mul_f32 v[198:199], v[198:199], v[8:9] op_sel:[0,1] op_sel_hi:[1,1]
v_pk_mul_f32 v[212:213], v[212:213], v[8:9] op_sel:[0,1] op_sel_hi:[1,1]
v_pk_mul_f32 v[214:215], v[214:215], v[8:9] op_sel:[0,1] op_sel_hi:[1,1]
v_cvt_pk_bf16_f32 v196, v196, v197
v_cvt_pk_bf16_f32 v197, v198, v199
v_cvt_pk_bf16_f32 v198, v212, v213
v_cvt_pk_bf16_f32 v199, v214, v215
s_nop 1
M v[24:27], a[112:115], v[196:199], v[24:27]
buffer_store_dwordx4 v[196:199], v1, s[16:19], s36 offen offset:3072 sc1
v_pk_mul_f32 v[200:201], v[200:201], v[10:11] op_sel:[0,0] op_sel_hi:[1,0]
v_pk_mul_f32 v[202:203], v[202:203], v[10:11] op_sel:[0,0] op_sel_hi:[1,0]
v_pk_mul_f32 v[216:217], v[216:217], v[10:11] op_sel:[0,0] op_sel_hi:[1,0]
v_pk_mul_f32 v[218:219], v[218:219], v[10:11] op_sel:[0,0] op_sel_hi:[1,0]
v_cvt_pk_bf16_f32 v200, v200, v201
v_cvt_pk_bf16_f32 v201, v202, v203
v_cvt_pk_bf16_f32 v202, v216, v217
v_cvt_pk_bf16_f32 v203, v218, v219
s_nop 1
M v[24:27], a[112:115], v[200:203], v[24:27]
buffer_store_dwordx4 v[200:203], v1, s[16:19], s37 offen offset:1024 sc1
v_pk_mul_f32 v[204:205], v[204:205], v[10:11] op_sel:[0,1] op_sel_hi:[1,1]
v_pk_mul_f32 v[206:207], v[206:207], v[10:11] op_sel:[0,1] op_sel_hi:[1,1]
v_pk_mul_f32 v[220:221], v[220:221], v[10:11] op_sel:[0,1] op_sel_hi:[1,1]
v_pk_mul_f32 v[222:223], v[222:223], v[10:11] op_sel:[0,1] op_sel_hi:[1,1]
v_cvt_pk_bf16_f32 v204, v204, v205
v_cvt_pk_bf16_f32 v205, v206, v207
v_cvt_pk_bf16_f32 v206, v220, v221
v_cvt_pk_bf16_f32 v207, v222, v223
s_nop 1
M v[24:27], a[112:115], v[204:207], v[24:27]
buffer_store_dwordx4 v[204:207], v1, s[16:19], s37 offen offset:3072 sc1
v_pk_mul_f32 v[224:225], v[224:225], v[8:9] op_sel:[0,0] op_sel_hi:[1,0]
v_pk_mul_f32 v[226:227], v[226:227], v[8:9] op_sel:[0,0] op_sel_hi:[1,0]
v_pk_mul_f32 v[240:241], v[240:241], v[8:9] op_sel:[0,0] op_sel_hi:[1,0]
v_pk_mul_f32 v[242:243], v[242:243], v[8:9] op_sel:[0,0] op_sel_hi:[1,0]
v_cvt_pk_bf16_f32 v224, v224, v225
v_cvt_pk_bf16_f32 v225, v226, v227
v_cvt_pk_bf16_f32 v226, v240, v241
v_cvt_pk_bf16_f32 v227, v242, v243
s_nop 1
M v[24:27], a[112:115], v[224:227], v[24:27]
buffer_store_dwordx4 v[224:227], v1, s[16:19], s38 offen offset:0 sc1
v_pk_mul_f32 v[228:229], v[228:229], v[8:9] op_sel:[0,1] op_sel_hi:[1,1]
v_pk_mul_f32 v[230:231], v[230:231], v[8:9] op_sel:[0,1] op_sel_hi:[1,1]
v_pk_mul_f32 v[244:245], v[244:245], v[8:9] op_sel:[0,1] op_sel_hi:[1,1]
v_pk_mul_f32 v[246:247], v[246:247], v[8:9] op_sel:[0,1] op_sel_hi:[1,1]
v_cvt_pk_bf16_f32 v228, v228, v229
v_cvt_pk_bf16_f32 v229, v230, v231
v_cvt_pk_bf16_f32 v230, v244, v245
v_cvt_pk_bf16_f32 v231, v246, v247
s_nop 1
M v[24:27], a[112:115], v[228:231], v[24:27]
buffer_store_dwordx4 v[228:231], v1, s[16:19], s38 offen offset:2048 sc1
v_pk_mul_f32 v[232:233], v[232:233], v[10:11] op_sel:[0,0] op_sel_hi:[1,0]
v_pk_mul_f32 v[234:235], v[234:235], v[10:11] op_sel:[0,0] op_sel_hi:[1,0]
v_pk_mul_f32 v[248:249], v[248:249], v[10:11] op_sel:[0,0] op_sel_hi:[1,0]
v_pk_mul_f32 v[250:251], v[250:251], v[10:11] op_sel:[0,0] op_sel_hi:[1,0]
v_cvt_pk_bf16_f32 v232, v232, v233
v_cvt_pk_bf16_f32 v233, v234, v235
v_cvt_pk_bf16_f32 v234, v248, v249
v_cvt_pk_bf16_f32 v235, v250, v251
s_nop 1
M v[24:27], a[112:115], v[232:235], v[24:27]
buffer_store_dwordx4 v[232:235], v1, s[16:19], s39 offen offset:0 sc1
v_pk_mul_f32 v[236:237], v[236:237], v[10:11] op_sel:[0,1] op_sel_hi:[1,1]
v_pk_mul_f32 v[238:239], v[238:239], v[10:11] op_sel:[0,1] op_sel_hi:[1,1]
v_pk_mul_f32 v[252:253], v[252:253], v[10:11] op_sel:[0,1] op_sel_hi:[1,1]
v_pk_mul_f32 v[254:255], v[254:255], v[10:11] op_sel:[0,1] op_sel_hi:[1,1]
v_cvt_pk_bf16_f32 v236, v236, v237
v_cvt_pk_bf16_f32 v237, v238, v239
v_cvt_pk_bf16_f32 v238, v252, v253
v_cvt_pk_bf16_f32 v239, v254, v255
v_accvgpr_read_b32 v176, a64
v_accvgpr_read_b32 v177, a65
v_accvgpr_read_b32 v178, a66
v_accvgpr_read_b32 v179, a67
v_accvgpr_read_b32 v180, a80
v_accvgpr_read_b32 v181, a81
v_accvgpr_read_b32 v182, a82
v_accvgpr_read_b32 v183, a83
M v[24:27], a[112:115], v[236:239], v[24:27]
buffer_store_dwordx4 v[236:239], v1, s[16:19], s39 offen offset:2048 sc1
v_pk_mul_f32 v[176:177], v[176:177], v[8:9] op_sel:[0,0] op_sel_hi:[1,0]
v_pk_mul_f32 v[178:179], v[178:179], v[8:9] op_sel:[0,0] op_sel_hi:[1,0]
v_pk_mul_f32 v[180:181], v[180:181], v[8:9] op_sel:[0,0] op_sel_hi:[1,0]
v_pk_mul_f32 v[182:183], v[182:183], v[8:9] op_sel:[0,0] op_sel_hi:[1,0]
v_cvt_pk_bf16_f32 v176, v176, v177
v_cvt_pk_bf16_f32 v177, v178, v179
v_cvt_pk_bf16_f32 v178, v180, v181
v_cvt_pk_bf16_f32 v179, v182, v183
v_accvgpr_read_b32 v184, a68
v_accvgpr_read_b32 v185, a69
v_accvgpr_read_b32 v186, a70
v_accvgpr_read_b32 v187, a71
v_accvgpr_read_b32 v188, a84
v_accvgpr_read_b32 v189, a85
v_accvgpr_read_b32 v190, a86
v_accvgpr_read_b32 v191, a87
M v[24:27], a[112:115], v[176:179], v[24:27]
buffer_store_dwordx4 v[176:179], v1, s[16:19], s38 offen offset:1024 sc1
v_pk_mul_f32 v[184:185], v[184:185], v[8:9] op_sel:[0,1] op_sel_hi:[1,1]
v_pk_mul_f32 v[186:187], v[186:187], v[8:9] op_sel:[0,1] op_sel_hi:[1,1]
v_pk_mul_f32 v[188:189], v[188:189], v[8:9] op_sel:[0,1] op_sel_hi:[1,1]
v_pk_mul_f32 v[190:191], v[190:191], v[8:9] op_sel:[0,1] op_sel_hi:[1,1]
v_cvt_pk_bf16_f32 v184, v184, v185
v_cvt_pk_bf16_f32 v185, v186, v187
v_cvt_pk_bf16_f32 v186, v188, v189
v_cvt_pk_bf16_f32 v187, v190, v191
v_accvgpr_read_b32 v208, a72
v_accvgpr_read_b32 v209, a73
v_accvgpr_read_b32 v210, a74
v_accvgpr_read_b32 v211, a75
v_accvgpr_read_b32 v212, a88
v_accvgpr_read_b32 v213, a89
v_accvgpr_read_b32 v214, a90
v_accvgpr_read_b32 v215, a91
M v[24:27], a[112:115], v[184:187], v[24:27]
buffer_store_dwordx4 v[184:187], v1, s[16:19], s38 offen offset:3072 sc1
v_pk_mul_f32 v[208:209], v[208:209], v[10:11] op_sel:[0,0] op_sel_hi:[1,0]
v_pk_mul_f32 v[210:211], v[210:211], v[10:11] op_sel:[0,0] op_sel_hi:[1,0]
v_pk_mul_f32 v[212:213], v[212:213], v[10:11] op_sel:[0,0] op_sel_hi:[1,0]
v_pk_mul_f32 v[214:215], v[214:215], v[10:11] op_sel:[0,0] op_sel_hi:[1,0]
v_cvt_pk_bf16_f32 v208, v208, v209
v_cvt_pk_bf16_f32 v209, v210, v211
v_cvt_pk_bf16_f32 v210, v212, v213
v_cvt_pk_bf16_f32 v211, v214, v215
v_accvgpr_read_b32 v216, a76
v_accvgpr_read_b32 v217, a77
v_accvgpr_read_b32 v218, a78
v_accvgpr_read_b32 v219, a79
v_accvgpr_read_b32 v220, a92
v_accvgpr_read_b32 v221, a93
v_accvgpr_read_b32 v222, a94
v_accvgpr_read_b32 v223, a95
M v[24:27], a[112:115], v[208:211], v[24:27]
buffer_store_dwordx4 v[208:211], v1, s[16:19], s39 offen offset:1024 sc1
v_pk_mul_f32 v[216:217], v[216:217], v[10:11] op_sel:[0,1] op_sel_hi:[1,1]
v_pk_mul_f32 v[218:219], v[218:219], v[10:11] op_sel:[0,1] op_sel_hi:[1,1]
v_pk_mul_f32 v[220:221], v[220:221], v[10:11] op_sel:[0,1] op_sel_hi:[1,1]
v_pk_mul_f32 v[222:223], v[222:223], v[10:11] op_sel:[0,1] op_sel_hi:[1,1]
v_cvt_pk_bf16_f32 v216, v216, v217
v_cvt_pk_bf16_f32 v217, v218, v219
v_cvt_pk_bf16_f32 v218, v220, v221
v_cvt_pk_bf16_f32 v219, v222, v223
s_nop 1
M v[24:27], a[112:115], v[216:219], v[24:27]
buffer_store_dwordx4 v[216:219], v1, s[16:19], s39 offen offset:3072 sc1
v_cmp_lt_u32 vcc, 0x3c000000, v12
s_nop 5
v_cmp_class_f32 s[40:41], v24, s64
s_nop 0
s_or_b64 vcc, vcc, s[40:41]
s_cmp_lg_u64 vcc, 0
s_cselect_b32 s33, 1, 0
s_or_b32 s60, s60, s33
s_sub_u32 s30, 7, s21
s_cmp_lg_u32 s30, 0
s_cbranch_scc1 Lk2_b0
s_and_b32 s3, s2, 3
s_lshl_b32 s3, s3, 2
s_bfe_u32 s27, s2, 0x20003
s_add_u32 s27, s3, s27
s_lshl_b32 s43, s27, 8
s_add_u32 s43, s43, 16789504
v_lshlrev_b32 v15, 2, v0
buffer_load_dword v7, v15, s[52:55], s43 offen sc1
s_waitcnt lgkmcnt(7)
ds_read_b128 a[116:119], v5 offset:36864
s_waitcnt lgkmcnt(7)
ds_read_b128 a[120:123], v5 offset:45056
s_waitcnt lgkmcnt(7)
ds_read_b128 a[124:127], v5 offset:37888
s_waitcnt lgkmcnt(7)
ds_read_b128 a[128:131], v5 offset:46080
s_waitcnt lgkmcnt(7)
ds_read_b128 a[132:135], v5 offset:38912
s_waitcnt lgkmcnt(7)
ds_read_b128 a[136:139], v5 offset:47104
s_waitcnt lgkmcnt(7)
ds_read_b128 a[140:143], v5 offset:39936
s_waitcnt lgkmcnt(7)
ds_read_b128 a[144:147], v5 offset:48128
s_lshl_b32 s33, s23, 14
s_add_u32 s34, s33, 98304
s_add_u32 s33, s33, 131072
v_add_u32 v2, s34, v1
v_add_u32 v3, s33, v1
v_exp_f32 v64, v64
v_exp_f32 v65, v65
v_exp_f32 v66, v66
v_exp_f32 v67, v67
v_exp_f32 v80, v80
v_exp_f32 v81, v81
v_exp_f32 v82, v82
v_exp_f32 v83, v83
v_cvt_pk_bf16_f32 v64, v64, v65
v_cvt_pk_bf16_f32 v65, v66, v67
v_exp_f32 v68, v68
v_exp_f32 v69, v69
v_exp_f32 v70, v70
v_exp_f32 v71, v71
v_cvt_pk_bf16_f32 v66, v80, v81
v_cvt_pk_bf16_f32 v67, v82, v83
v_exp_f32 v84, v84
v_exp_f32 v85, v85
v_exp_f32 v86, v86
v_exp_f32 v87, v87
v_cvt_pk_bf16_f32 v68, v68, v69
v_cvt_pk_bf16_f32 v69, v70, v71
v_exp_f32 v72, v72
v_exp_f32 v73, v73
v_exp_f32 v74, v74
v_exp_f32 v75, v75
v_cvt_pk_bf16_f32 v70, v84, v85
v_cvt_pk_bf16_f32 v71, v86, v87
v_exp_f32 v88, v88
v_exp_f32 v89, v89
v_exp_f32 v90, v90
v_exp_f32 v91, v91
v_cvt_pk_bf16_f32 v72, v72, v73
v_cvt_pk_bf16_f32 v73, v74, v75
v_exp_f32 v76, v76
v_exp_f32 v77, v77
v_exp_f32 v78, v78
v_exp_f32 v79, v79
v_cvt_pk_bf16_f32 v74, v88, v89
v_cvt_pk_bf16_f32 v75, v90, v91
v_exp_f32 v92, v92
v_exp_f32 v93, v93
v_exp_f32 v94, v94
v_exp_f32 v95, v95
v_cvt_pk_bf16_f32 v76, v76, v77
v_cvt_pk_bf16_f32 v77, v78, v79
v_cvt_pk_bf16_f32 v78, v92, v93
v_cvt_pk_bf16_f32 v79, v94, v95
s_waitcnt lgkmcnt(6)
M v[224:227], a[116:119], v[32:35], 0
M v[224:227], a[120:123], v[64:67], v[224:227]
ds_read_b128 a[148:151], v5 offset:32768
ds_read_b128 a[152:155], v5 offset:40960
s_mov_b32 s61, 0
M v[228:231], a[120:123], v[68:71], 0
M v[228:231], a[116:119], v[36:39], v[228:231]
s_bfe_u32 s3, s2, 0x10002
M v[232:235], a[116:119], v[40:43], 0
M v[232:235], a[120:123], v[72:75], v[232:235]
s_lshl_b32 s3, s3, 3
M v[236:239], a[120:123], v[76:79], 0
M v[236:239], a[116:119], v[44:47], v[236:239]
s_waitcnt lgkmcnt(6)
s_lshr_b32 s28, s2, 5
M a[96:99], a[112:115], v[32:35], 0
M a[96:99], a[112:115], v[64:67], a[96:99]
M v[240:243], a[124:127], v[32:35], 0
M v[240:243], a[128:131], v[64:67], v[240:243]
ds_read_b128 a[156:159], v5 offset:33792
ds_read_b128 a[160:163], v5 offset:41984
s_add_u32 s28, s3, s28
M v[244:247], a[128:131], v[68:71], 0
s_lshl_b32 s25, s27, 18
M v[244:247], a[124:127], v[36:39], v[244:247]
M v[248:251], a[124:127], v[40:43], 0
s_lshl_b32 s3, s101, 12
M v[248:251], a[128:131], v[72:75], v[248:251]
M v[252:255], a[128:131], v[76:79], 0
s_add_u32 s25, s25, s3
M v[252:255], a[124:127], v[44:47], v[252:255]
s_waitcnt lgkmcnt(6)
M a[100:103], a[112:115], v[36:39], 0
M a[100:103], a[112:115], v[68:71], a[100:103]
M a[64:67], a[132:135], v[32:35], 0
s_lshl_b32 s26, s28, 7
M a[64:67], a[136:139], v[64:67], a[64:67]
ds_read_b128 a[164:167], v5 offset:34816
ds_read_b128 a[168:171], v5 offset:43008
M a[68:71], a[136:139], v[68:71], 0
s_lshl_b32 s42, s101, 11
M a[68:71], a[132:135], v[36:39], a[68:71]
M a[72:75], a[132:135], v[40:43], 0
s_add_u32 s44, s4, 83886080
s_addc_u32 s45, s5, 0
M a[72:75], a[136:139], v[72:75], a[72:75]
s_mov_b32 s46, 4194304
M a[76:79], a[136:139], v[76:79], 0
M a[76:79], a[132:135], v[44:47], a[76:79]
s_waitcnt lgkmcnt(6)
s_mov_b32 s47, 0x00020000
M a[104:107], a[112:115], v[40:43], 0
M a[104:107], a[112:115], v[72:75], a[104:107]
M a[80:83], a[140:143], v[32:35], 0
M a[80:83], a[144:147], v[64:67], a[80:83]
ds_read_b128 a[172:175], v5 offset:35840
ds_read_b128 a[176:179], v5 offset:44032
s_mov_b32 s50, 2097152
M a[84:87], a[144:147], v[68:71], 0
M a[84:87], a[140:143], v[36:39], a[84:87]
s_mov_b32 s51, 0x00020000
M a[88:91], a[140:143], v[40:43], 0
M a[88:91], a[144:147], v[72:75], a[88:91]
s_lshl_b32 s3, s101, 4
M a[92:95], a[144:147], v[76:79], 0
M a[92:95], a[140:143], v[44:47], a[92:95]
s_waitcnt lgkmcnt(6)
v_lshrrev_b32 v96, 3, v0
M a[108:111], a[112:115], v[44:47], 0
M a[108:111], a[112:115], v[76:79], a[108:111]
M v[160:163], a[148:151], v[32:35], 0
v_and_b32 v97, 6, v96
M v[160:163], a[152:155], v[64:67], v[160:163]
M v[164:167], a[152:155], v[68:71], 0
ds_write_b128 v2, v[224:227] offset:0
v_and_b32 v98, 7, v0
M v[164:167], a[148:151], v[36:39], v[164:167]
M v[168:171], a[148:151], v[40:43], 0
ds_write_b128 v2, v[228:231] offset:1024
v_xor_b32 v97, v97, v98
M v[168:171], a[152:155], v[72:75], v[168:171]
M v[172:175], a[152:155], v[76:79], 0
ds_write_b128 v2, v[232:235] offset:2048
v_add_u32 v96, s3, v96
M v[172:175], a[148:151], v[44:47], v[172:175]
s_waitcnt lgkmcnt(7)
M v[176:179], a[156:159], v[32:35], 0
ds_write_b128 v2, v[236:239] offset:3072
v_lshlrev_b32 v96, 11, v96
M v[176:179], a[160:163], v[64:67], v[176:179]
M v[180:183], a[160:163], v[68:71], 0
ds_write_b128 v2, v[240:243] offset:4096
v_lshl_add_u32 v99, v97, 4, v96
M v[180:183], a[156:159], v[36:39], v[180:183]
v_add_u32 v100, 15360, v99
M v[184:187], a[156:159], v[40:43], 0
ds_write_b128 v2, v[244:247] offset:5120
M v[184:187], a[160:163], v[72:75], v[184:187]
s_waitcnt vmcnt(0) lgkmcnt(0)
s_barrier
M v[188:191], a[160:163], v[76:79], 0
ds_write_b128 v2, v[248:251] offset:6144
v_cmp_ne_u32 vcc, 1, v7
s_nop 0
s_cbranch_vccnz Lk3_spinb0
Lk3_gotb0:
M v[188:191], a[156:159], v[44:47], v[188:191]
s_add_u32 m0, s42, 16384
s_nop 0
buffer_load_dwordx4 v99, s[48:51], s26 offen offset:0 lds
M v[192:195], a[164:167], v[32:35], 0
ds_write_b128 v2, v[252:255] offset:7168
buffer_load_dwordx4 v100, s[48:51], s26 offen offset:1024 lds
M v[192:195], a[168:171], v[64:67], v[192:195]
M v[196:199], a[168:171], v[68:71], 0
ds_write_b128 v2, a[64:67] offset:8192
buffer_load_dwordx4 a[192:195], v1, s[44:47], s25 offen offset:0 sc1
M v[196:199], a[164:167], v[36:39], v[196:199]
buffer_load_dwordx4 a[196:199], v1, s[44:47], s25 offen offset:1024 sc1
M v[200:203], a[164:167], v[40:43], 0
ds_write_b128 v2, a[68:71] offset:9216
buffer_load_dwordx4 a[200:203], v1, s[44:47], s25 offen offset:2048 sc1
M v[200:203], a[168:171], v[72:75], v[200:203]
buffer_load_dwordx4 a[204:207], v1, s[44:47], s25 offen offset:3072 sc1
M v[204:207], a[168:171], v[76:79], 0
ds_write_b128 v2, a[72:75] offset:10240
M v[204:207], a[164:167], v[44:47], v[204:207]
s_add_u32 s25, s25, 16384
s_add_u32 s26, s26, 131072
M v[208:211], a[172:175], v[32:35], 0
ds_write_b128 v2, a[76:79] offset:11264
s_add_u32 m0, s42, 32768
s_nop 0
buffer_load_dwordx4 v99, s[48:51], s26 offen offset:0 lds
M v[208:211], a[176:179], v[64:67], v[208:211]
buffer_load_dwordx4 v100, s[48:51], s26 offen offset:1024 lds
M v[212:215], a[176:179], v[68:71], 0
ds_write_b128 v2, a[80:83] offset:12288
buffer_load_dwordx4 a[224:227], v1, s[44:47], s25 offen offset:0 sc1
M v[212:215], a[172:175], v[36:39], v[212:215]
M v[216:219], a[172:175], v[40:43], 0
ds_write_b128 v2, a[84:87] offset:13312
buffer_load_dwordx4 a[228:231], v1, s[44:47], s25 offen offset:1024 sc1
M v[216:219], a[176:179], v[72:75], v[216:219]
buffer_load_dwordx4 a[232:235], v1, s[44:47], s25 offen offset:2048 sc1
M v[220:223], a[176:179], v[76:79], 0
ds_write_b128 v2, a[88:91] offset:14336
buffer_load_dwordx4 a[236:239], v1, s[44:47], s25 offen offset:3072 sc1
M v[220:223], a[172:175], v[44:47], v[220:223]
s_add_u32 s25, s25, 16384
s_add_u32 s26, s26, 131072
ds_write_b128 v2, a[92:95] offset:15360
s_waitcnt lgkmcnt(0)
s_branch Lk2_merge
Lk2_b0:
s_add_u32 m0, s29, 65536
s_waitcnt lgkmcnt(4)
M v[96:99], a[116:119], a[180:183], 0
v_exp_f32 v64, v64
M v[96:99], a[120:123], a[184:187], v[96:99]
ds_read_b128 a[148:151], v2 offset:8192
ds_read_b128 a[152:155], v2 offset:9216
M v[96:99], a[124:127], a[188:191], v[96:99]
v_exp_f32 v65, v65
M v[96:99], a[128:131], a[192:195], v[96:99]
buffer_load_dwordx4 v1, s[12:15], s25 offen offset:0 sc1 lds
s_add_u32 s32, s25, 4096
M v[100:103], a[128:131], a[208:211], 0
v_exp_f32 v66, v66
M v[100:103], a[124:127], a[204:207], v[100:103]
v_cvt_pk_bf16_f32 v64, v64, v65
M v[100:103], a[120:123], a[200:203], v[100:103]
v_exp_f32 v67, v67
M v[100:103], a[116:119], a[196:199], v[100:103]
buffer_load_dwordx4 v1, s[12:15], s25 offen offset:1024 sc1 lds
M v[104:107], a[116:119], a[212:215], 0
v_exp_f32 v80, v80
M v[104:107], a[120:123], a[216:219], v[104:107]
ds_read_b128 a[156:159], v2 offset:10240
ds_read_b128 a[160:163], v2 offset:11264
M v[104:107], a[124:127], a[220:223], v[104:107]
v_exp_f32 v81, v81
M v[104:107], a[128:131], a[224:227], v[104:107]
buffer_load_dwordx4 v1, s[12:15], s25 offen offset:2048 sc1 lds
M v[108:111], a[128:131], a[240:243], 0
v_exp_f32 v82, v82
M v[108:111], a[124:127], a[236:239], v[108:111]
v_cvt_pk_bf16_f32 v65, v66, v67
v_cvt_pk_bf16_f32 v66, v80, v81
M v[108:111], a[120:123], a[232:235], v[108:111]
v_exp_f32 v83, v83
M v[108:111], a[116:119], a[228:231], v[108:111]
buffer_load_dwordx4 v1, s[12:15], s25 offen offset:3072 sc1 lds
s_add_u32 m0, s29, 69632
s_waitcnt lgkmcnt(4)
M v[112:115], a[132:135], a[180:183], 0
v_exp_f32 v68, v68
M v[112:115], a[136:139], a[184:187], v[112:115]
ds_read_b128 a[164:167], v2 offset:12288
ds_read_b128 a[168:171], v2 offset:13312
M v[112:115], a[140:143], a[188:191], v[112:115]
v_exp_f32 v69, v69
M v[112:115], a[144:147], a[192:195], v[112:115]
buffer_load_dwordx4 v1, s[12:15], s32 offen offset:0 sc1 lds
M v[116:119], a[144:147], a[208:211], 0
v_exp_f32 v70, v70
M v[116:119], a[140:143], a[204:207], v[116:119]
v_cvt_pk_bf16_f32 v67, v82, v83
v_cvt_pk_bf16_f32 v68, v68, v69
M v[116:119], a[136:139], a[200:203], v[116:119]
v_exp_f32 v71, v71
M v[116:119], a[132:135], a[196:199], v[116:119]
buffer_load_dwordx4 v1, s[12:15], s32 offen offset:1024 sc1 lds
M v[120:123], a[132:135], a[212:215], 0
v_exp_f32 v84, v84
M v[120:123], a[136:139], a[216:219], v[120:123]
ds_read_b128 a[172:175], v2 offset:14336
ds_read_b128 a[176:179], v2 offset:15360
M v[120:123], a[140:143], a[220:223], v[120:123]
v_exp_f32 v85, v85
M v[120:123], a[144:147], a[224:227], v[120:123]
buffer_load_dwordx4 v1, s[12:15], s32 offen offset:2048 sc1 lds
M v[124:127], a[144:147], a[240:243], 0
v_exp_f32 v86, v86
M v[124:127], a[140:143], a[236:239], v[124:127]
v_cvt_pk_bf16_f32 v69, v70, v71
v_cvt_pk_bf16_f32 v70, v84, v85
M v[124:127], a[136:139], a[232:235], v[124:127]
v_exp_f32 v87, v87
M v[124:127], a[132:135], a[228:231], v[124:127]
buffer_load_dwordx4 v1, s[12:15], s32 offen offset:3072 sc1 lds
s_add_u32 m0, s29, 98304
s_waitcnt lgkmcnt(4)
M v[128:131], a[148:151], a[180:183], 0
v_exp_f32 v72, v72
M v[128:131], a[152:155], a[184:187], v[128:131]
ds_read_b128 a[116:119], v5 offset:32768
ds_read_b128 a[120:123], v5 offset:40960
M v[128:131], a[156:159], a[188:191], v[128:131]
v_exp_f32 v73, v73
M v[128:131], a[160:163], a[192:195], v[128:131]
buffer_load_dwordx4 v1, s[12:15], s26 offen offset:0 sc1 lds
s_add_u32 s43, s26, 4096
M v[132:135], a[160:163], a[208:211], 0
v_exp_f32 v74, v74
M v[132:135], a[156:159], a[204:207], v[132:135]
v_cvt_pk_bf16_f32 v71, v86, v87
v_cvt_pk_bf16_f32 v72, v72, v73
M v[132:135], a[152:155], a[200:203], v[132:135]
v_exp_f32 v75, v75
M v[132:135], a[148:151], a[196:199], v[132:135]
buffer_load_dwordx4 v1, s[12:15], s26 offen offset:1024 sc1 lds
M v[136:139], a[148:151], a[212:215], 0
v_exp_f32 v88, v88
M v[136:139], a[152:155], a[216:219], v[136:139]
ds_read_b128 a[124:127], v5 offset:33792
ds_read_b128 a[128:131], v5 offset:41984
M v[136:139], a[156:159], a[220:223], v[136:139]
v_exp_f32 v89, v89
M v[136:139], a[160:163], a[224:227], v[136:139]
buffer_load_dwordx4 v1, s[12:15], s26 offen offset:2048 sc1 lds
M v[140:143], a[160:163], a[240:243], 0
v_exp_f32 v90, v90
M v[140:143], a[156:159], a[236:239], v[140:143]
v_cvt_pk_bf16_f32 v73, v74, v75
v_cvt_pk_bf16_f32 v74, v88, v89
M v[140:143], a[152:155], a[232:235], v[140:143]
v_exp_f32 v91, v91
M v[140:143], a[148:151], a[228:231], v[140:143]
buffer_load_dwordx4 v1, s[12:15], s26 offen offset:3072 sc1 lds
s_add_u32 m0, s29, 102400
s_waitcnt lgkmcnt(4)
M v[144:147], a[164:167], a[180:183], 0
v_exp_f32 v76, v76
M v[144:147], a[168:171], a[184:187], v[144:147]
ds_read_b128 a[132:135], v5 offset:34816
ds_read_b128 a[136:139], v5 offset:43008
M v[144:147], a[172:175], a[188:191], v[144:147]
v_exp_f32 v77, v77
M v[144:147], a[176:179], a[192:195], v[144:147]
buffer_load_dwordx4 v1, s[12:15], s43 offen offset:0 sc1 lds
M v[148:151], a[176:179], a[208:211], 0
v_exp_f32 v78, v78
M v[148:151], a[172:175], a[204:207], v[148:151]
v_cvt_pk_bf16_f32 v75, v90, v91
v_cvt_pk_bf16_f32 v76, v76, v77
M v[148:151], a[168:171], a[200:203], v[148:151]
v_exp_f32 v79, v79
M v[148:151], a[164:167], a[196:199], v[148:151]
buffer_load_dwordx4 v1, s[12:15], s43 offen offset:1024 sc1 lds
M v[152:155], a[164:167], a[212:215], 0
v_exp_f32 v92, v92
M v[152:155], a[168:171], a[216:219], v[152:155]
ds_read_b128 a[140:143], v5 offset:35840
ds_read_b128 a[144:147], v5 offset:44032
M v[152:155], a[172:175], a[220:223], v[152:155]
v_exp_f32 v93, v93
M v[152:155], a[176:179], a[224:227], v[152:155]
buffer_load_dwordx4 v1, s[12:15], s43 offen offset:2048 sc1 lds
M v[156:159], a[176:179], a[240:243], 0
v_exp_f32 v94, v94
M v[156:159], a[172:175], a[236:239], v[156:159]
v_cvt_pk_bf16_f32 v77, v78, v79
v_cvt_pk_bf16_f32 v78, v92, v93
M v[156:159], a[168:171], a[232:235], v[156:159]
v_exp_f32 v95, v95
M v[156:159], a[164:167], a[228:231], v[156:159]
buffer_load_dwordx4 v1, s[12:15], s43 offen offset:3072 sc1 lds
v_cvt_pk_bf16_f32 v79, v94, v95
s_waitcnt lgkmcnt(6)
M v[160:163], a[116:119], v[32:35], 0
v_exp_f32 v96, v96
M v[160:163], a[120:123], v[64:67], v[160:163]
ds_read_b128 a[148:151], v5 offset:36864
ds_read_b128 a[152:155], v5 offset:45056
M v[164:167], a[120:123], v[68:71], 0
v_exp_f32 v97, v97
M v[164:167], a[116:119], v[36:39], v[164:167]
v_cvt_pk_bf16_f32 v96, v96, v97
M v[168:171], a[116:119], v[40:43], 0
v_exp_f32 v98, v98
M v[168:171], a[120:123], v[72:75], v[168:171]
s_add_u32 s25, s25, 32768
s_cmp_eq_u32 s25, s27
M v[172:175], a[120:123], v[76:79], 0
v_exp_f32 v99, v99
M v[172:175], a[116:119], v[44:47], v[172:175]
v_cvt_pk_bf16_f32 v97, v98, v99
s_waitcnt lgkmcnt(6)
M a[96:99], a[112:115], v[32:35], 0
s_cselect_b32 s25, s28, s25
s_cselect_b32 s27, -1, s27
M a[96:99], a[112:115], v[64:67], a[96:99]
s_add_u32 s26, s26, 32768
s_cmp_eq_u32 s26, s62
M v[176:179], a[124:127], v[32:35], 0
v_exp_f32 v112, v112
M v[176:179], a[128:131], v[64:67], v[176:179]
ds_read_b128 a[156:159], v5 offset:37888
ds_read_b128 a[160:163], v5 offset:46080
M v[180:183], a[128:131], v[68:71], 0
v_exp_f32 v113, v113
M v[180:183], a[124:127], v[36:39], v[180:183]
v_cvt_pk_bf16_f32 v98, v112, v113
M v[184:187], a[124:127], v[40:43], 0
v_exp_f32 v114, v114
M v[184:187], a[128:131], v[72:75], v[184:187]
s_cselect_b32 s26, s63, s26
s_cselect_b32 s62, -1, s62
M v[188:191], a[128:131], v[76:79], 0
v_exp_f32 v115, v115
M v[188:191], a[124:127], v[44:47], v[188:191]
v_cvt_pk_bf16_f32 v99, v114, v115
s_waitcnt lgkmcnt(6)
M a[100:103], a[112:115], v[36:39], 0
M a[100:103], a[112:115], v[68:71], a[100:103]
M v[192:195], a[132:135], v[32:35], 0
v_exp_f32 v100, v100
M v[192:195], a[136:139], v[64:67], v[192:195]
ds_read_b128 a[164:167], v5 offset:38912
ds_read_b128 a[168:171], v5 offset:47104
M v[196:199], a[136:139], v[68:71], 0
v_exp_f32 v101, v101
M v[196:199], a[132:135], v[36:39], v[196:199]
v_cvt_pk_bf16_f32 v100, v100, v101
M v[200:203], a[132:135], v[40:43], 0
v_exp_f32 v102, v102
M v[200:203], a[136:139], v[72:75], v[200:203]
M v[204:207], a[136:139], v[76:79], 0
v_exp_f32 v103, v103
M v[204:207], a[132:135], v[44:47], v[204:207]
v_cvt_pk_bf16_f32 v101, v102, v103
s_waitcnt lgkmcnt(6)
M a[104:107], a[112:115], v[40:43], 0
M a[104:107], a[112:115], v[72:75], a[104:107]
M v[208:211], a[140:143], v[32:35], 0
v_exp_f32 v116, v116
M v[208:211], a[144:147], v[64:67], v[208:211]
ds_read_b128 a[172:175], v5 offset:39936
ds_read_b128 a[176:179], v5 offset:48128
M v[212:215], a[144:147], v[68:71], 0
v_exp_f32 v117, v117
M v[212:215], a[140:143], v[36:39], v[212:215]
v_cvt_pk_bf16_f32 v102, v116, v117
M v[216:219], a[140:143], v[40:43], 0
v_exp_f32 v118, v118
M v[216:219], a[144:147], v[72:75], v[216:219]
M v[220:223], a[144:147], v[76:79], 0
v_exp_f32 v119, v119
M v[220:223], a[140:143], v[44:47], v[220:223]
v_cvt_pk_bf16_f32 v103, v118, v119
s_waitcnt lgkmcnt(6)
M a[108:111], a[112:115], v[44:47], 0
M a[108:111], a[112:115], v[76:79], a[108:111]
M v[224:227], a[148:151], v[32:35], 0
v_exp_f32 v104, v104
M v[224:227], a[152:155], v[64:67], v[224:227]
M v[228:231], a[152:155], v[68:71], 0
v_exp_f32 v105, v105
M v[228:231], a[148:151], v[36:39], v[228:231]
v_cvt_pk_bf16_f32 v104, v104, v105
M v[232:235], a[148:151], v[40:43], 0
v_exp_f32 v106, v106
M v[232:235], a[152:155], v[72:75], v[232:235]
M v[236:239], a[152:155], v[76:79], 0
v_exp_f32 v107, v107
M v[236:239], a[148:151], v[44:47], v[236:239]
v_cvt_pk_bf16_f32 v105, v106, v107
s_waitcnt lgkmcnt(4)
M v[240:243], a[156:159], v[32:35], 0
v_exp_f32 v120, v120
M v[240:243], a[160:163], v[64:67], v[240:243]
M v[244:247], a[160:163], v[68:71], 0
v_exp_f32 v121, v121
M v[244:247], a[156:159], v[36:39], v[244:247]
v_cvt_pk_bf16_f32 v106, v120, v121
M v[248:251], a[156:159], v[40:43], 0
v_exp_f32 v122, v122
M v[248:251], a[160:163], v[72:75], v[248:251]
s_waitcnt vmcnt(0) lgkmcnt(0)
s_barrier
ds_read_b128 a[116:119], v3 offset:0
ds_read_b128 a[120:123], v3 offset:1024
M v[252:255], a[160:163], v[76:79], 0
v_exp_f32 v123, v123
M v[252:255], a[156:159], v[44:47], v[252:255]
v_cvt_pk_bf16_f32 v107, v122, v123
M a[64:67], a[164:167], v[32:35], 0
v_exp_f32 v108, v108
M a[64:67], a[168:171], v[64:67], a[64:67]
ds_read_b128 a[124:127], v3 offset:2048
ds_read_b128 a[128:131], v3 offset:3072
M a[68:71], a[168:171], v[68:71], 0
v_exp_f32 v109, v109
M a[68:71], a[164:167], v[36:39], a[68:71]
v_cvt_pk_bf16_f32 v108, v108, v109
M a[72:75], a[164:167], v[40:43], 0
v_exp_f32 v110, v110
M a[72:75], a[168:171], v[72:75], a[72:75]
ds_read_b128 a[132:135], v3 offset:4096
ds_read_b128 a[136:139], v3 offset:5120
M a[76:79], a[168:171], v[76:79], 0
v_exp_f32 v111, v111
M a[76:79], a[164:167], v[44:47], a[76:79]
v_cvt_pk_bf16_f32 v109, v110, v111
M a[80:83], a[172:175], v[32:35], 0
v_exp_f32 v124, v124
M a[80:83], a[176:179], v[64:67], a[80:83]
ds_read_b128 a[140:143], v3 offset:6144
ds_read_b128 a[144:147], v3 offset:7168
M a[84:87], a[176:179], v[68:71], 0
v_exp_f32 v125, v125
M a[84:87], a[172:175], v[36:39], a[84:87]
v_cvt_pk_bf16_f32 v110, v124, v125
M a[88:91], a[172:175], v[40:43], 0
v_exp_f32 v126, v126
M a[88:91], a[176:179], v[72:75], a[88:91]
M a[92:95], a[176:179], v[76:79], 0
v_exp_f32 v127, v127
M a[92:95], a[172:175], v[44:47], a[92:95]
v_cvt_pk_bf16_f32 v111, v126, v127
s_branch Lk2_l2b
Lk2_l2:
s_add_u32 m0, s29, 65536
s_waitcnt lgkmcnt(4)
M v[96:99], a[116:119], a[180:183], 0
v_exp_f32 v64, v64
M v[96:99], a[120:123], a[184:187], v[96:99]
ds_read_b128 a[148:151], v2 offset:8192
ds_read_b128 a[152:155], v2 offset:9216
M v[96:99], a[124:127], a[188:191], v[96:99]
v_exp_f32 v65, v65
M v[96:99], a[128:131], a[192:195], v[96:99]
buffer_load_dwordx4 v1, s[12:15], s25 offen offset:0 sc1 lds
s_add_u32 s32, s25, 4096
M v[100:103], a[128:131], a[208:211], 0
v_exp_f32 v66, v66
M v[100:103], a[124:127], a[204:207], v[100:103]
v_cvt_pk_bf16_f32 v64, v64, v65
M v[100:103], a[120:123], a[200:203], v[100:103]
v_exp_f32 v67, v67
M v[100:103], a[116:119], a[196:199], v[100:103]
buffer_load_dwordx4 v1, s[12:15], s25 offen offset:1024 sc1 lds
M v[104:107], a[116:119], a[212:215], 0
v_exp_f32 v80, v80
M v[104:107], a[120:123], a[216:219], v[104:107]
ds_read_b128 a[156:159], v2 offset:10240
ds_read_b128 a[160:163], v2 offset:11264
M v[104:107], a[124:127], a[220:223], v[104:107]
v_exp_f32 v81, v81
M v[104:107], a[128:131], a[224:227], v[104:107]
buffer_load_dwordx4 v1, s[12:15], s25 offen offset:2048 sc1 lds
M v[108:111], a[128:131], a[240:243], 0
v_exp_f32 v82, v82
M v[108:111], a[124:127], a[236:239], v[108:111]
v_cvt_pk_bf16_f32 v65, v66, v67
v_cvt_pk_bf16_f32 v66, v80, v81
M v[108:111], a[120:123], a[232:235], v[108:111]
v_exp_f32 v83, v83
M v[108:111], a[116:119], a[228:231], v[108:111]
buffer_load_dwordx4 v1, s[12:15], s25 offen offset:3072 sc1 lds
s_add_u32 m0, s29, 69632
s_waitcnt lgkmcnt(4)
M v[112:115], a[132:135], a[180:183], 0
v_exp_f32 v68, v68
M v[112:115], a[136:139], a[184:187], v[112:115]
ds_read_b128 a[164:167], v2 offset:12288
ds_read_b128 a[168:171], v2 offset:13312
M v[112:115], a[140:143], a[188:191], v[112:115]
v_exp_f32 v69, v69
M v[112:115], a[144:147], a[192:195], v[112:115]
buffer_load_dwordx4 v1, s[12:15], s32 offen offset:0 sc1 lds
M v[116:119], a[144:147], a[208:211], 0
v_exp_f32 v70, v70
M v[116:119], a[140:143], a[204:207], v[116:119]
v_cvt_pk_bf16_f32 v67, v82, v83
v_cvt_pk_bf16_f32 v68, v68, v69
M v[116:119], a[136:139], a[200:203], v[116:119]
v_exp_f32 v71, v71
M v[116:119], a[132:135], a[196:199], v[116:119]
buffer_load_dwordx4 v1, s[12:15], s32 offen offset:1024 sc1 lds
M v[120:123], a[132:135], a[212:215], 0
v_exp_f32 v84, v84
M v[120:123], a[136:139], a[216:219], v[120:123]
ds_read_b128 a[172:175], v2 offset:14336
ds_read_b128 a[176:179], v2 offset:15360
M v[120:123], a[140:143], a[220:223], v[120:123]
v_exp_f32 v85, v85
M v[120:123], a[144:147], a[224:227], v[120:123]
buffer_load_dwordx4 v1, s[12:15], s32 offen offset:2048 sc1 lds
M v[124:127], a[144:147], a[240:243], 0
v_exp_f32 v86, v86
M v[124:127], a[140:143], a[236:239], v[124:127]
v_cvt_pk_bf16_f32 v69, v70, v71
v_cvt_pk_bf16_f32 v70, v84, v85
M v[124:127], a[136:139], a[232:235], v[124:127]
v_exp_f32 v87, v87
M v[124:127], a[132:135], a[228:231], v[124:127]
buffer_load_dwordx4 v1, s[12:15], s32 offen offset:3072 sc1 lds
s_add_u32 m0, s29, 98304
s_waitcnt lgkmcnt(4)
M v[128:131], a[148:151], a[180:183], 0
v_exp_f32 v72, v72
M v[128:131], a[152:155], a[184:187], v[128:131]
ds_read_b128 a[116:119], v5 offset:32768
ds_read_b128 a[120:123], v5 offset:40960
M v[128:131], a[156:159], a[188:191], v[128:131]
v_exp_f32 v73, v73
M v[128:131], a[160:163], a[192:195], v[128:131]
buffer_load_dwordx4 v1, s[12:15], s26 offen offset:0 sc1 lds
s_add_u32 s43, s26, 4096
M v[132:135], a[160:163], a[208:211], 0
v_exp_f32 v74, v74
M v[132:135], a[156:159], a[204:207], v[132:135]
v_cvt_pk_bf16_f32 v71, v86, v87
v_cvt_pk_bf16_f32 v72, v72, v73
M v[132:135], a[152:155], a[200:203], v[132:135]
v_exp_f32 v75, v75
M v[132:135], a[148:151], a[196:199], v[132:135]
buffer_load_dwordx4 v1, s[12:15], s26 offen offset:1024 sc1 lds
M v[136:139], a[148:151], a[212:215], 0
v_exp_f32 v88, v88
M v[136:139], a[152:155], a[216:219], v[136:139]
ds_read_b128 a[124:127], v5 offset:33792
ds_read_b128 a[128:131], v5 offset:41984
M v[136:139], a[156:159], a[220:223], v[136:139]
v_exp_f32 v89, v89
M v[136:139], a[160:163], a[224:227], v[136:139]
buffer_load_dwordx4 v1, s[12:15], s26 offen offset:2048 sc1 lds
M v[140:143], a[160:163], a[240:243], 0
v_exp_f32 v90, v90
M v[140:143], a[156:159], a[236:239], v[140:143]
v_cvt_pk_bf16_f32 v73, v74, v75
v_cvt_pk_bf16_f32 v74, v88, v89
M v[140:143], a[152:155], a[232:235], v[140:143]
v_exp_f32 v91, v91
M v[140:143], a[148:151], a[228:231], v[140:143]
buffer_load_dwordx4 v1, s[12:15], s26 offen offset:3072 sc1 lds
s_add_u32 m0, s29, 102400
s_waitcnt lgkmcnt(4)
M v[144:147], a[164:167], a[180:183], 0
v_exp_f32 v76, v76
M v[144:147], a[168:171], a[184:187], v[144:147]
ds_read_b128 a[132:135], v5 offset:34816
ds_read_b128 a[136:139], v5 offset:43008
M v[144:147], a[172:175], a[188:191], v[144:147]
v_exp_f32 v77, v77
M v[144:147], a[176:179], a[192:195], v[144:147]
buffer_load_dwordx4 v1, s[12:15], s43 offen offset:0 sc1 lds
M v[148:151], a[176:179], a[208:211], 0
v_exp_f32 v78, v78
M v[148:151], a[172:175], a[204:207], v[148:151]
v_cvt_pk_bf16_f32 v75, v90, v91
v_cvt_pk_bf16_f32 v76, v76, v77
M v[148:151], a[168:171], a[200:203], v[148:151]
v_exp_f32 v79, v79
M v[148:151], a[164:167], a[196:199], v[148:151]
buffer_load_dwordx4 v1, s[12:15], s43 offen offset:1024 sc1 lds
M v[152:155], a[164:167], a[212:215], 0
v_exp_f32 v92, v92
M v[152:155], a[168:171], a[216:219], v[152:155]
ds_read_b128 a[140:143], v5 offset:35840
ds_read_b128 a[144:147], v5 offset:44032
M v[152:155], a[172:175], a[220:223], v[152:155]
v_exp_f32 v93, v93
M v[152:155], a[176:179], a[224:227], v[152:155]
buffer_load_dwordx4 v1, s[12:15], s43 offen offset:2048 sc1 lds
M v[156:159], a[176:179], a[240:243], 0
v_exp_f32 v94, v94
M v[156:159], a[172:175], a[236:239], v[156:159]
v_cvt_pk_bf16_f32 v77, v78, v79
v_cvt_pk_bf16_f32 v78, v92, v93
M v[156:159], a[168:171], a[232:235], v[156:159]
v_exp_f32 v95, v95
M v[156:159], a[164:167], a[228:231], v[156:159]
buffer_load_dwordx4 v1, s[12:15], s43 offen offset:3072 sc1 lds
v_cvt_pk_bf16_f32 v79, v94, v95
s_waitcnt lgkmcnt(6)
M v[160:163], a[116:119], v[32:35], v[160:163]
v_exp_f32 v96, v96
M v[160:163], a[120:123], v[64:67], v[160:163]
ds_read_b128 a[148:151], v5 offset:36864
ds_read_b128 a[152:155], v5 offset:45056
M v[164:167], a[120:123], v[68:71], v[164:167]
v_exp_f32 v97, v97
M v[164:167], a[116:119], v[36:39], v[164:167]
v_cvt_pk_bf16_f32 v96, v96, v97
M v[168:171], a[116:119], v[40:43], v[168:171]
v_exp_f32 v98, v98
M v[168:171], a[120:123], v[72:75], v[168:171]
s_add_u32 s25, s25, 32768
s_cmp_eq_u32 s25, s27
M v[172:175], a[120:123], v[76:79], v[172:175]
v_exp_f32 v99, v99
M v[172:175], a[116:119], v[44:47], v[172:175]
v_cvt_pk_bf16_f32 v97, v98, v99
s_waitcnt lgkmcnt(6)
M a[96:99], a[112:115], v[32:35], a[96:99]
s_cselect_b32 s25, s28, s25
s_cselect_b32 s27, -1, s27
M a[96:99], a[112:115], v[64:67], a[96:99]
s_add_u32 s26, s26, 32768
s_cmp_eq_u32 s26, s62
M v[176:179], a[124:127], v[32:35], v[176:179]
v_exp_f32 v112, v112
M v[176:179], a[128:131], v[64:67], v[176:179]
ds_read_b128 a[156:159], v5 offset:37888
ds_read_b128 a[160:163], v5 offset:46080
M v[180:183], a[128:131], v[68:71], v[180:183]
v_exp_f32 v113, v113
M v[180:183], a[124:127], v[36:39], v[180:183]
v_cvt_pk_bf16_f32 v98, v112, v113
M v[184:187], a[124:127], v[40:43], v[184:187]
v_exp_f32 v114, v114
M v[184:187], a[128:131], v[72:75], v[184:187]
s_cselect_b32 s26, s63, s26
s_cselect_b32 s62, -1, s62
M v[188:191], a[128:131], v[76:79], v[188:191]
v_exp_f32 v115, v115
M v[188:191], a[124:127], v[44:47], v[188:191]
v_cvt_pk_bf16_f32 v99, v114, v115
s_waitcnt lgkmcnt(6)
M a[100:103], a[112:115], v[36:39], a[100:103]
M a[100:103], a[112:115], v[68:71], a[100:103]
M v[192:195], a[132:135], v[32:35], v[192:195]
v_exp_f32 v100, v100
M v[192:195], a[136:139], v[64:67], v[192:195]
ds_read_b128 a[164:167], v5 offset:38912
ds_read_b128 a[168:171], v5 offset:47104
M v[196:199], a[136:139], v[68:71], v[196:199]
v_exp_f32 v101, v101
M v[196:199], a[132:135], v[36:39], v[196:199]
v_cvt_pk_bf16_f32 v100, v100, v101
M v[200:203], a[132:135], v[40:43], v[200:203]
v_exp_f32 v102, v102
M v[200:203], a[136:139], v[72:75], v[200:203]
M v[204:207], a[136:139], v[76:79], v[204:207]
v_exp_f32 v103, v103
M v[204:207], a[132:135], v[44:47], v[204:207]
v_cvt_pk_bf16_f32 v101, v102, v103
s_waitcnt lgkmcnt(6)
M a[104:107], a[112:115], v[40:43], a[104:107]
M a[104:107], a[112:115], v[72:75], a[104:107]
M v[208:211], a[140:143], v[32:35], v[208:211]
v_exp_f32 v116, v116
M v[208:211], a[144:147], v[64:67], v[208:211]
ds_read_b128 a[172:175], v5 offset:39936
ds_read_b128 a[176:179], v5 offset:48128
M v[212:215], a[144:147], v[68:71], v[212:215]
v_exp_f32 v117, v117
M v[212:215], a[140:143], v[36:39], v[212:215]
v_cvt_pk_bf16_f32 v102, v116, v117
M v[216:219], a[140:143], v[40:43], v[216:219]
v_exp_f32 v118, v118
M v[216:219], a[144:147], v[72:75], v[216:219]
M v[220:223], a[144:147], v[76:79], v[220:223]
v_exp_f32 v119, v119
M v[220:223], a[140:143], v[44:47], v[220:223]
v_cvt_pk_bf16_f32 v103, v118, v119
s_waitcnt lgkmcnt(6)
M a[108:111], a[112:115], v[44:47], a[108:111]
M a[108:111], a[112:115], v[76:79], a[108:111]
M v[224:227], a[148:151], v[32:35], v[224:227]
v_exp_f32 v104, v104
M v[224:227], a[152:155], v[64:67], v[224:227]
M v[228:231], a[152:155], v[68:71], v[228:231]
v_exp_f32 v105, v105
M v[228:231], a[148:151], v[36:39], v[228:231]
v_cvt_pk_bf16_f32 v104, v104, v105
M v[232:235], a[148:151], v[40:43], v[232:235]
v_exp_f32 v106, v106
M v[232:235], a[152:155], v[72:75], v[232:235]
M v[236:239], a[152:155], v[76:79], v[236:239]
v_exp_f32 v107, v107
M v[236:239], a[148:151], v[44:47], v[236:239]
v_cvt_pk_bf16_f32 v105, v106, v107
s_waitcnt lgkmcnt(4)
M v[240:243], a[156:159], v[32:35], v[240:243]
v_exp_f32 v120, v120
M v[240:243], a[160:163], v[64:67], v[240:243]
M v[244:247], a[160:163], v[68:71], v[244:247]
v_exp_f32 v121, v121
M v[244:247], a[156:159], v[36:39], v[244:247]
v_cvt_pk_bf16_f32 v106, v120, v121
M v[248:251], a[156:159], v[40:43], v[248:251]
v_exp_f32 v122, v122
M v[248:251], a[160:163], v[72:75], v[248:251]
s_waitcnt vmcnt(0) lgkmcnt(0)
s_barrier
ds_read_b128 a[116:119], v3 offset:0
ds_read_b128 a[120:123], v3 offset:1024
M v[252:255], a[160:163], v[76:79], v[252:255]
v_exp_f32 v123, v123
M v[252:255], a[156:159], v[44:47], v[252:255]
v_cvt_pk_bf16_f32 v107, v122, v123
M a[64:67], a[164:167], v[32:35], a[64:67]
v_exp_f32 v108, v108
M a[64:67], a[168:171], v[64:67], a[64:67]
ds_read_b128 a[124:127], v3 offset:2048
ds_read_b128 a[128:131], v3 offset:3072
M a[68:71], a[168:171], v[68:71], a[68:71]
v_exp_f32 v109, v109
M a[68:71], a[164:167], v[36:39], a[68:71]
v_cvt_pk_bf16_f32 v108, v108, v109
M a[72:75], a[164:167], v[40:43], a[72:75]
v_exp_f32 v110, v110
M a[72:75], a[168:171], v[72:75], a[72:75]
ds_read_b128 a[132:135], v3 offset:4096
ds_read_b128 a[136:139], v3 offset:5120
M a[76:79], a[168:171], v[76:79], a[76:79]
v_exp_f32 v111, v111
M a[76:79], a[164:167], v[44:47], a[76:79]
v_cvt_pk_bf16_f32 v109, v110, v111
M a[80:83], a[172:175], v[32:35], a[80:83]
v_exp_f32 v124, v124
M a[80:83], a[176:179], v[64:67], a[80:83]
ds_read_b128 a[140:143], v3 offset:6144
ds_read_b128 a[144:147], v3 offset:7168
M a[84:87], a[176:179], v[68:71], a[84:87]
v_exp_f32 v125, v125
M a[84:87], a[172:175], v[36:39], a[84:87]
v_cvt_pk_bf16_f32 v110, v124, v125
M a[88:91], a[172:175], v[40:43], a[88:91]
v_exp_f32 v126, v126
M a[88:91], a[176:179], v[72:75], a[88:91]
M a[92:95], a[176:179], v[76:79], a[92:95]
v_exp_f32 v127, v127
M a[92:95], a[172:175], v[44:47], a[92:95]
v_cvt_pk_bf16_f32 v111, v126, v127
Lk2_l2b:
s_add_u32 m0, s29, 0
s_waitcnt lgkmcnt(4)
M v[32:35], a[116:119], a[180:183], 0
v_exp_f32 v128, v128
M v[32:35], a[120:123], a[184:187], v[32:35]
ds_read_b128 a[148:151], v3 offset:8192
ds_read_b128 a[152:155], v3 offset:9216
M v[32:35], a[124:127], a[188:191], v[32:35]
v_exp_f32 v129, v129
M v[32:35], a[128:131], a[192:195], v[32:35]
buffer_load_dwordx4 v1, s[12:15], s25 offen offset:0 sc1 lds
s_add_u32 s32, s25, 4096
M v[36:39], a[128:131], a[208:211], 0
v_exp_f32 v130, v130
M v[36:39], a[124:127], a[204:207], v[36:39]
v_cvt_pk_bf16_f32 v128, v128, v129
M v[36:39], a[120:123], a[200:203], v[36:39]
v_exp_f32 v131, v131
M v[36:39], a[116:119], a[196:199], v[36:39]
buffer_load_dwordx4 v1, s[12:15], s25 offen offset:1024 sc1 lds
M v[40:43], a[116:119], a[212:215], 0
v_exp_f32 v144, v144
M v[40:43], a[120:123], a[216:219], v[40:43]
ds_read_b128 a[156:159], v3 offset:10240
ds_read_b128 a[160:163], v3 offset:11264
M v[40:43], a[124:127], a[220:223], v[40:43]
v_exp_f32 v145, v145
M v[40:43], a[128:131], a[224:227], v[40:43]
buffer_load_dwordx4 v1, s[12:15], s25 offen offset:2048 sc1 lds
M v[44:47], a[128:131], a[240:243], 0
v_exp_f32 v146, v146
M v[44:47], a[124:127], a[236:239], v[44:47]
v_cvt_pk_bf16_f32 v129, v130, v131
v_cvt_pk_bf16_f32 v130, v144, v145
M v[44:47], a[120:123], a[232:235], v[44:47]
v_exp_f32 v147, v147
M v[44:47], a[116:119], a[228:231], v[44:47]
buffer_load_dwordx4 v1, s[12:15], s25 offen offset:3072 sc1 lds
s_add_u32 m0, s29, 4096
s_waitcnt lgkmcnt(4)
M v[48:51], a[132:135], a[180:183], 0
v_exp_f32 v132, v132
M v[48:51], a[136:139], a[184:187], v[48:51]
ds_read_b128 a[164:167], v3 offset:12288
ds_read_b128 a[168:171], v3 offset:13312
M v[48:51], a[140:143], a[188:191], v[48:51]
v_exp_f32 v133, v133
M v[48:51], a[144:147], a[192:195], v[48:51]
buffer_load_dwordx4 v1, s[12:15], s32 offen offset:0 sc1 lds
M v[52:55], a[144:147], a[208:211], 0
v_exp_f32 v134, v134
M v[52:55], a[140:143], a[204:207], v[52:55]
v_cvt_pk_bf16_f32 v131, v146, v147
v_cvt_pk_bf16_f32 v132, v132, v133
M v[52:55], a[136:139], a[200:203], v[52:55]
v_exp_f32 v135, v135
M v[52:55], a[132:135], a[196:199], v[52:55]
buffer_load_dwordx4 v1, s[12:15], s32 offen offset:1024 sc1 lds
M v[56:59], a[132:135], a[212:215], 0
v_exp_f32 v148, v148
M v[56:59], a[136:139], a[216:219], v[56:59]
ds_read_b128 a[172:175], v3 offset:14336
ds_read_b128 a[176:179], v3 offset:15360
M v[56:59], a[140:143], a[220:223], v[56:59]
v_exp_f32 v149, v149
M v[56:59], a[144:147], a[224:227], v[56:59]
buffer_load_dwordx4 v1, s[12:15], s32 offen offset:2048 sc1 lds
M v[60:63], a[144:147], a[240:243], 0
v_exp_f32 v150, v150
M v[60:63], a[140:143], a[236:239], v[60:63]
v_cvt_pk_bf16_f32 v133, v134, v135
v_cvt_pk_bf16_f32 v134, v148, v149
M v[60:63], a[136:139], a[232:235], v[60:63]
v_exp_f32 v151, v151
M v[60:63], a[132:135], a[228:231], v[60:63]
buffer_load_dwordx4 v1, s[12:15], s32 offen offset:3072 sc1 lds
s_add_u32 m0, s29, 32768
s_waitcnt lgkmcnt(4)
M v[64:67], a[148:151], a[180:183], 0
v_exp_f32 v136, v136
M v[64:67], a[152:155], a[184:187], v[64:67]
ds_read_b128 a[116:119], v6 offset:32768
ds_read_b128 a[120:123], v6 offset:40960
M v[64:67], a[156:159], a[188:191], v[64:67]
v_exp_f32 v137, v137
M v[64:67], a[160:163], a[192:195], v[64:67]
buffer_load_dwordx4 v1, s[12:15], s26 offen offset:0 sc1 lds
s_add_u32 s43, s26, 4096
M v[68:71], a[160:163], a[208:211], 0
v_exp_f32 v138, v138
M v[68:71], a[156:159], a[204:207], v[68:71]
v_cvt_pk_bf16_f32 v135, v150, v151
v_cvt_pk_bf16_f32 v136, v136, v137
M v[68:71], a[152:155], a[200:203], v[68:71]
v_exp_f32 v139, v139
M v[68:71], a[148:151], a[196:199], v[68:71]
buffer_load_dwordx4 v1, s[12:15], s26 offen offset:1024 sc1 lds
M v[72:75], a[148:151], a[212:215], 0
v_exp_f32 v152, v152
M v[72:75], a[152:155], a[216:219], v[72:75]
ds_read_b128 a[124:127], v6 offset:33792
ds_read_b128 a[128:131], v6 offset:41984
M v[72:75], a[156:159], a[220:223], v[72:75]
v_exp_f32 v153, v153
M v[72:75], a[160:163], a[224:227], v[72:75]
buffer_load_dwordx4 v1, s[12:15], s26 offen offset:2048 sc1 lds
M v[76:79], a[160:163], a[240:243], 0
v_exp_f32 v154, v154
M v[76:79], a[156:159], a[236:239], v[76:79]
v_cvt_pk_bf16_f32 v137, v138, v139
v_cvt_pk_bf16_f32 v138, v152, v153
M v[76:79], a[152:155], a[232:235], v[76:79]
v_exp_f32 v155, v155
M v[76:79], a[148:151], a[228:231], v[76:79]
buffer_load_dwordx4 v1, s[12:15], s26 offen offset:3072 sc1 lds
s_add_u32 m0, s29, 36864
s_waitcnt lgkmcnt(4)
M v[80:83], a[164:167], a[180:183], 0
v_exp_f32 v140, v140
M v[80:83], a[168:171], a[184:187], v[80:83]
ds_read_b128 a[132:135], v6 offset:34816
ds_read_b128 a[136:139], v6 offset:43008
M v[80:83], a[172:175], a[188:191], v[80:83]
v_exp_f32 v141, v141
M v[80:83], a[176:179], a[192:195], v[80:83]
buffer_load_dwordx4 v1, s[12:15], s43 offen offset:0 sc1 lds
M v[84:87], a[176:179], a[208:211], 0
v_exp_f32 v142, v142
M v[84:87], a[172:175], a[204:207], v[84:87]
v_cvt_pk_bf16_f32 v139, v154, v155
v_cvt_pk_bf16_f32 v140, v140, v141
M v[84:87], a[168:171], a[200:203], v[84:87]
v_exp_f32 v143, v143
M v[84:87], a[164:167], a[196:199], v[84:87]
buffer_load_dwordx4 v1, s[12:15], s43 offen offset:1024 sc1 lds
M v[88:91], a[164:167], a[212:215], 0
v_exp_f32 v156, v156
M v[88:91], a[168:171], a[216:219], v[88:91]
ds_read_b128 a[140:143], v6 offset:35840
ds_read_b128 a[144:147], v6 offset:44032
M v[88:91], a[172:175], a[220:223], v[88:91]
v_exp_f32 v157, v157
M v[88:91], a[176:179], a[224:227], v[88:91]
buffer_load_dwordx4 v1, s[12:15], s43 offen offset:2048 sc1 lds
M v[92:95], a[176:179], a[240:243], 0
v_exp_f32 v158, v158
M v[92:95], a[172:175], a[236:239], v[92:95]
v_cvt_pk_bf16_f32 v141, v142, v143
v_cvt_pk_bf16_f32 v142, v156, v157
M v[92:95], a[168:171], a[232:235], v[92:95]
v_exp_f32 v159, v159
M v[92:95], a[164:167], a[228:231], v[92:95]
buffer_load_dwordx4 v1, s[12:15], s43 offen offset:3072 sc1 lds
v_cvt_pk_bf16_f32 v143, v158, v159
s_waitcnt lgkmcnt(6)
M v[160:163], a[116:119], v[96:99], v[160:163]
v_exp_f32 v32, v32
M v[160:163], a[120:123], v[128:131], v[160:163]
ds_read_b128 a[148:151], v6 offset:36864
ds_read_b128 a[152:155], v6 offset:45056
M v[164:167], a[120:123], v[132:135], v[164:167]
v_exp_f32 v33, v33
M v[164:167], a[116:119], v[100:103], v[164:167]
v_cvt_pk_bf16_f32 v32, v32, v33
M v[168:171], a[116:119], v[104:107], v[168:171]
v_exp_f32 v34, v34
M v[168:171], a[120:123], v[136:139], v[168:171]
s_add_u32 s25, s25, 32768
s_cmp_eq_u32 s25, s27
M v[172:175], a[120:123], v[140:143], v[172:175]
v_exp_f32 v35, v35
M v[172:175], a[116:119], v[108:111], v[172:175]
v_cvt_pk_bf16_f32 v33, v34, v35
s_waitcnt lgkmcnt(6)
M a[96:99], a[112:115], v[96:99], a[96:99]
s_cselect_b32 s25, s28, s25
s_cselect_b32 s27, -1, s27
M a[96:99], a[112:115], v[128:131], a[96:99]
s_add_u32 s26, s26, 32768
s_cmp_eq_u32 s26, s62
M v[176:179], a[124:127], v[96:99], v[176:179]
v_exp_f32 v48, v48
M v[176:179], a[128:131], v[128:131], v[176:179]
ds_read_b128 a[156:159], v6 offset:37888
ds_read_b128 a[160:163], v6 offset:46080
M v[180:183], a[128:131], v[132:135], v[180:183]
v_exp_f32 v49, v49
M v[180:183], a[124:127], v[100:103], v[180:183]
v_cvt_pk_bf16_f32 v34, v48, v49
M v[184:187], a[124:127], v[104:107], v[184:187]
v_exp_f32 v50, v50
M v[184:187], a[128:131], v[136:139], v[184:187]
s_cselect_b32 s26, s63, s26
s_cselect_b32 s62, -1, s62
M v[188:191], a[128:131], v[140:143], v[188:191]
v_exp_f32 v51, v51
M v[188:191], a[124:127], v[108:111], v[188:191]
v_cvt_pk_bf16_f32 v35, v50, v51
s_waitcnt lgkmcnt(6)
M a[100:103], a[112:115], v[100:103], a[100:103]
M a[100:103], a[112:115], v[132:135], a[100:103]
M v[192:195], a[132:135], v[96:99], v[192:195]
v_exp_f32 v36, v36
M v[192:195], a[136:139], v[128:131], v[192:195]
ds_read_b128 a[164:167], v6 offset:38912
ds_read_b128 a[168:171], v6 offset:47104
M v[196:199], a[136:139], v[132:135], v[196:199]
v_exp_f32 v37, v37
M v[196:199], a[132:135], v[100:103], v[196:199]
v_cvt_pk_bf16_f32 v36, v36, v37
M v[200:203], a[132:135], v[104:107], v[200:203]
v_exp_f32 v38, v38
M v[200:203], a[136:139], v[136:139], v[200:203]
M v[204:207], a[136:139], v[140:143], v[204:207]
v_exp_f32 v39, v39
M v[204:207], a[132:135], v[108:111], v[204:207]
v_cvt_pk_bf16_f32 v37, v38, v39
s_waitcnt lgkmcnt(6)
M a[104:107], a[112:115], v[104:107], a[104:107]
M a[104:107], a[112:115], v[136:139], a[104:107]
M v[208:211], a[140:143], v[96:99], v[208:211]
v_exp_f32 v52, v52
M v[208:211], a[144:147], v[128:131], v[208:211]
ds_read_b128 a[172:175], v6 offset:39936
ds_read_b128 a[176:179], v6 offset:48128
M v[212:215], a[144:147], v[132:135], v[212:215]
v_exp_f32 v53, v53
M v[212:215], a[140:143], v[100:103], v[212:215]
v_cvt_pk_bf16_f32 v38, v52, v53
M v[216:219], a[140:143], v[104:107], v[216:219]
v_exp_f32 v54, v54
M v[216:219], a[144:147], v[136:139], v[216:219]
M v[220:223], a[144:147], v[140:143], v[220:223]
v_exp_f32 v55, v55
M v[220:223], a[140:143], v[108:111], v[220:223]
v_cvt_pk_bf16_f32 v39, v54, v55
s_waitcnt lgkmcnt(6)
M a[108:111], a[112:115], v[108:111], a[108:111]
M a[108:111], a[112:115], v[140:143], a[108:111]
M v[224:227], a[148:151], v[96:99], v[224:227]
v_exp_f32 v40, v40
M v[224:227], a[152:155], v[128:131], v[224:227]
M v[228:231], a[152:155], v[132:135], v[228:231]
v_exp_f32 v41, v41
M v[228:231], a[148:151], v[100:103], v[228:231]
v_cvt_pk_bf16_f32 v40, v40, v41
M v[232:235], a[148:151], v[104:107], v[232:235]
v_exp_f32 v42, v42
M v[232:235], a[152:155], v[136:139], v[232:235]
M v[236:239], a[152:155], v[140:143], v[236:239]
v_exp_f32 v43, v43
M v[236:239], a[148:151], v[108:111], v[236:239]
v_cvt_pk_bf16_f32 v41, v42, v43
s_waitcnt lgkmcnt(4)
M v[240:243], a[156:159], v[96:99], v[240:243]
v_exp_f32 v56, v56
M v[240:243], a[160:163], v[128:131], v[240:243]
M v[244:247], a[160:163], v[132:135], v[244:247]
v_exp_f32 v57, v57
M v[244:247], a[156:159], v[100:103], v[244:247]
v_cvt_pk_bf16_f32 v42, v56, v57
M v[248:251], a[156:159], v[104:107], v[248:251]
v_exp_f32 v58, v58
M v[248:251], a[160:163], v[136:139], v[248:251]
s_waitcnt vmcnt(0) lgkmcnt(0)
s_barrier
ds_read_b128 a[116:119], v2 offset:0
ds_read_b128 a[120:123], v2 offset:1024
M v[252:255], a[160:163], v[140:143], v[252:255]
v_exp_f32 v59, v59
M v[252:255], a[156:159], v[108:111], v[252:255]
v_cvt_pk_bf16_f32 v43, v58, v59
M a[64:67], a[164:167], v[96:99], a[64:67]
v_exp_f32 v44, v44
M a[64:67], a[168:171], v[128:131], a[64:67]
ds_read_b128 a[124:127], v2 offset:2048
ds_read_b128 a[128:131], v2 offset:3072
M a[68:71], a[168:171], v[132:135], a[68:71]
v_exp_f32 v45, v45
M a[68:71], a[164:167], v[100:103], a[68:71]
v_cvt_pk_bf16_f32 v44, v44, v45
M a[72:75], a[164:167], v[104:107], a[72:75]
v_exp_f32 v46, v46
M a[72:75], a[168:171], v[136:139], a[72:75]
ds_read_b128 a[132:135], v2 offset:4096
ds_read_b128 a[136:139], v2 offset:5120
M a[76:79], a[168:171], v[140:143], a[76:79]
v_exp_f32 v47, v47
M a[76:79], a[164:167], v[108:111], a[76:79]
v_cvt_pk_bf16_f32 v45, v46, v47
M a[80:83], a[172:175], v[96:99], a[80:83]
v_exp_f32 v60, v60
M a[80:83], a[176:179], v[128:131], a[80:83]
ds_read_b128 a[140:143], v2 offset:6144
ds_read_b128 a[144:147], v2 offset:7168
M a[84:87], a[176:179], v[132:135], a[84:87]
v_exp_f32 v61, v61
M a[84:87], a[172:175], v[100:103], a[84:87]
v_cvt_pk_bf16_f32 v46, v60, v61
M a[88:91], a[172:175], v[104:107], a[88:91]
v_exp_f32 v62, v62
M a[88:91], a[176:179], v[136:139], a[88:91]
M a[92:95], a[176:179], v[140:143], a[92:95]
v_exp_f32 v63, v63
M a[92:95], a[172:175], v[108:111], a[92:95]
v_cvt_pk_bf16_f32 v47, v62, v63
s_sub_u32 s30, s30, 1
s_cmp_lg_u32 s30, 0
s_cbranch_scc1 Lk2_l2
s_and_b32 s3, s2, 3
s_lshl_b32 s3, s3, 2
s_bfe_u32 s27, s2, 0x20003
s_add_u32 s27, s3, s27
s_lshl_b32 s43, s27, 8
s_add_u32 s43, s43, 16789504
v_lshlrev_b32 v15, 2, v0
buffer_load_dword v7, v15, s[52:55], s43 offen sc1
s_waitcnt lgkmcnt(7)
ds_read_b128 a[116:119], v5 offset:36864
s_waitcnt lgkmcnt(7)
ds_read_b128 a[120:123], v5 offset:45056
s_waitcnt lgkmcnt(7)
ds_read_b128 a[124:127], v5 offset:37888
s_waitcnt lgkmcnt(7)
ds_read_b128 a[128:131], v5 offset:46080
s_waitcnt lgkmcnt(7)
ds_read_b128 a[132:135], v5 offset:38912
s_waitcnt lgkmcnt(7)
ds_read_b128 a[136:139], v5 offset:47104
s_waitcnt lgkmcnt(7)
ds_read_b128 a[140:143], v5 offset:39936
s_waitcnt lgkmcnt(7)
ds_read_b128 a[144:147], v5 offset:48128
s_lshl_b32 s33, s23, 14
s_add_u32 s34, s33, 98304
s_add_u32 s33, s33, 131072
v_add_u32 v2, s34, v1
v_add_u32 v3, s33, v1
v_exp_f32 v64, v64
v_exp_f32 v65, v65
v_exp_f32 v66, v66
v_exp_f32 v67, v67
v_exp_f32 v80, v80
v_exp_f32 v81, v81
v_exp_f32 v82, v82
v_exp_f32 v83, v83
v_cvt_pk_bf16_f32 v64, v64, v65
v_cvt_pk_bf16_f32 v65, v66, v67
v_exp_f32 v68, v68
v_exp_f32 v69, v69
v_exp_f32 v70, v70
v_exp_f32 v71, v71
v_cvt_pk_bf16_f32 v66, v80, v81
v_cvt_pk_bf16_f32 v67, v82, v83
v_exp_f32 v84, v84
v_exp_f32 v85, v85
v_exp_f32 v86, v86
v_exp_f32 v87, v87
v_cvt_pk_bf16_f32 v68, v68, v69
v_cvt_pk_bf16_f32 v69, v70, v71
v_exp_f32 v72, v72
v_exp_f32 v73, v73
v_exp_f32 v74, v74
v_exp_f32 v75, v75
v_cvt_pk_bf16_f32 v70, v84, v85
v_cvt_pk_bf16_f32 v71, v86, v87
v_exp_f32 v88, v88
v_exp_f32 v89, v89
v_exp_f32 v90, v90
v_exp_f32 v91, v91
v_cvt_pk_bf16_f32 v72, v72, v73
v_cvt_pk_bf16_f32 v73, v74, v75
v_exp_f32 v76, v76
v_exp_f32 v77, v77
v_exp_f32 v78, v78
v_exp_f32 v79, v79
v_cvt_pk_bf16_f32 v74, v88, v89
v_cvt_pk_bf16_f32 v75, v90, v91
v_exp_f32 v92, v92
v_exp_f32 v93, v93
v_exp_f32 v94, v94
v_exp_f32 v95, v95
v_cvt_pk_bf16_f32 v76, v76, v77
v_cvt_pk_bf16_f32 v77, v78, v79
v_cvt_pk_bf16_f32 v78, v92, v93
v_cvt_pk_bf16_f32 v79, v94, v95
s_waitcnt lgkmcnt(6)
M v[224:227], a[116:119], v[32:35], v[224:227]
M v[224:227], a[120:123], v[64:67], v[224:227]
ds_read_b128 a[148:151], v5 offset:32768
ds_read_b128 a[152:155], v5 offset:40960
s_mov_b32 s61, 0
M v[228:231], a[120:123], v[68:71], v[228:231]
M v[228:231], a[116:119], v[36:39], v[228:231]
s_bfe_u32 s3, s2, 0x10002
M v[232:235], a[116:119], v[40:43], v[232:235]
M v[232:235], a[120:123], v[72:75], v[232:235]
s_lshl_b32 s3, s3, 3
M v[236:239], a[120:123], v[76:79], v[236:239]
M v[236:239], a[116:119], v[44:47], v[236:239]
s_waitcnt lgkmcnt(6)
s_lshr_b32 s28, s2, 5
M a[96:99], a[112:115], v[32:35], a[96:99]
M a[96:99], a[112:115], v[64:67], a[96:99]
M v[240:243], a[124:127], v[32:35], v[240:243]
M v[240:243], a[128:131], v[64:67], v[240:243]
ds_read_b128 a[156:159], v5 offset:33792
ds_read_b128 a[160:163], v5 offset:41984
s_add_u32 s28, s3, s28
M v[244:247], a[128:131], v[68:71], v[244:247]
s_lshl_b32 s25, s27, 18
M v[244:247], a[124:127], v[36:39], v[244:247]
M v[248:251], a[124:127], v[40:43], v[248:251]
s_lshl_b32 s3, s101, 12
M v[248:251], a[128:131], v[72:75], v[248:251]
M v[252:255], a[128:131], v[76:79], v[252:255]
s_add_u32 s25, s25, s3
M v[252:255], a[124:127], v[44:47], v[252:255]
s_waitcnt lgkmcnt(6)
M a[100:103], a[112:115], v[36:39], a[100:103]
M a[100:103], a[112:115], v[68:71], a[100:103]
M a[64:67], a[132:135], v[32:35], a[64:67]
s_lshl_b32 s26, s28, 7
M a[64:67], a[136:139], v[64:67], a[64:67]
ds_read_b128 a[164:167], v5 offset:34816
ds_read_b128 a[168:171], v5 offset:43008
M a[68:71], a[136:139], v[68:71], a[68:71]
s_lshl_b32 s42, s101, 11
M a[68:71], a[132:135], v[36:39], a[68:71]
M a[72:75], a[132:135], v[40:43], a[72:75]
s_add_u32 s44, s4, 83886080
s_addc_u32 s45, s5, 0
M a[72:75], a[136:139], v[72:75], a[72:75]
s_mov_b32 s46, 4194304
M a[76:79], a[136:139], v[76:79], a[76:79]
M a[76:79], a[132:135], v[44:47], a[76:79]
s_waitcnt lgkmcnt(6)
s_mov_b32 s47, 0x00020000
M a[104:107], a[112:115], v[40:43], a[104:107]
M a[104:107], a[112:115], v[72:75], a[104:107]
M a[80:83], a[140:143], v[32:35], a[80:83]
M a[80:83], a[144:147], v[64:67], a[80:83]
ds_read_b128 a[172:175], v5 offset:35840
ds_read_b128 a[176:179], v5 offset:44032
s_mov_b32 s50, 2097152
M a[84:87], a[144:147], v[68:71], a[84:87]
M a[84:87], a[140:143], v[36:39], a[84:87]
s_mov_b32 s51, 0x00020000
M a[88:91], a[140:143], v[40:43], a[88:91]
M a[88:91], a[144:147], v[72:75], a[88:91]
s_lshl_b32 s3, s101, 4
M a[92:95], a[144:147], v[76:79], a[92:95]
M a[92:95], a[140:143], v[44:47], a[92:95]
s_waitcnt lgkmcnt(6)
v_lshrrev_b32 v96, 3, v0
M a[108:111], a[112:115], v[44:47], a[108:111]
M a[108:111], a[112:115], v[76:79], a[108:111]
M v[160:163], a[148:151], v[32:35], v[160:163]
v_and_b32 v97, 6, v96
M v[160:163], a[152:155], v[64:67], v[160:163]
M v[164:167], a[152:155], v[68:71], v[164:167]
ds_write_b128 v2, v[224:227] offset:0
v_and_b32 v98, 7, v0
M v[164:167], a[148:151], v[36:39], v[164:167]
M v[168:171], a[148:151], v[40:43], v[168:171]
ds_write_b128 v2, v[228:231] offset:1024
v_xor_b32 v97, v97, v98
M v[168:171], a[152:155], v[72:75], v[168:171]
M v[172:175], a[152:155], v[76:79], v[172:175]
ds_write_b128 v2, v[232:235] offset:2048
v_add_u32 v96, s3, v96
M v[172:175], a[148:151], v[44:47], v[172:175]
s_waitcnt lgkmcnt(7)
M v[176:179], a[156:159], v[32:35], v[176:179]
ds_write_b128 v2, v[236:239] offset:3072
v_lshlrev_b32 v96, 11, v96
M v[176:179], a[160:163], v[64:67], v[176:179]
M v[180:183], a[160:163], v[68:71], v[180:183]
ds_write_b128 v2, v[240:243] offset:4096
v_lshl_add_u32 v99, v97, 4, v96
M v[180:183], a[156:159], v[36:39], v[180:183]
v_add_u32 v100, 15360, v99
M v[184:187], a[156:159], v[40:43], v[184:187]
ds_write_b128 v2, v[244:247] offset:5120
M v[184:187], a[160:163], v[72:75], v[184:187]
s_waitcnt vmcnt(0) lgkmcnt(0)
s_barrier
M v[188:191], a[160:163], v[76:79], v[188:191]
ds_write_b128 v2, v[248:251] offset:6144
v_cmp_ne_u32 vcc, 1, v7
s_nop 0
s_cbranch_vccnz Lk3_spinb1
Lk3_gotb1:
M v[188:191], a[156:159], v[44:47], v[188:191]
s_add_u32 m0, s42, 16384
s_nop 0
buffer_load_dwordx4 v99, s[48:51], s26 offen offset:0 lds
M v[192:195], a[164:167], v[32:35], v[192:195]
ds_write_b128 v2, v[252:255] offset:7168
buffer_load_dwordx4 v100, s[48:51], s26 offen offset:1024 lds
M v[192:195], a[168:171], v[64:67], v[192:195]
M v[196:199], a[168:171], v[68:71], v[196:199]
ds_write_b128 v2, a[64:67] offset:8192
buffer_load_dwordx4 a[192:195], v1, s[44:47], s25 offen offset:0 sc1
M v[196:199], a[164:167], v[36:39], v[196:199]
buffer_load_dwordx4 a[196:199], v1, s[44:47], s25 offen offset:1024 sc1
M v[200:203], a[164:167], v[40:43], v[200:203]
ds_write_b128 v2, a[68:71] offset:9216
buffer_load_dwordx4 a[200:203], v1, s[44:47], s25 offen offset:2048 sc1
M v[200:203], a[168:171], v[72:75], v[200:203]
buffer_load_dwordx4 a[204:207], v1, s[44:47], s25 offen offset:3072 sc1
M v[204:207], a[168:171], v[76:79], v[204:207]
ds_write_b128 v2, a[72:75] offset:10240
M v[204:207], a[164:167], v[44:47], v[204:207]
s_add_u32 s25, s25, 16384
s_add_u32 s26, s26, 131072
M v[208:211], a[172:175], v[32:35], v[208:211]
ds_write_b128 v2, a[76:79] offset:11264
s_add_u32 m0, s42, 32768
s_nop 0
buffer_load_dwordx4 v99, s[48:51], s26 offen offset:0 lds
M v[208:211], a[176:179], v[64:67], v[208:211]
buffer_load_dwordx4 v100, s[48:51], s26 offen offset:1024 lds
M v[212:215], a[176:179], v[68:71], v[212:215]
ds_write_b128 v2, a[80:83] offset:12288
buffer_load_dwordx4 a[224:227], v1, s[44:47], s25 offen offset:0 sc1
M v[212:215], a[172:175], v[36:39], v[212:215]
M v[216:219], a[172:175], v[40:43], v[216:219]
ds_write_b128 v2, a[84:87] offset:13312
buffer_load_dwordx4 a[228:231], v1, s[44:47], s25 offen offset:1024 sc1
M v[216:219], a[176:179], v[72:75], v[216:219]
buffer_load_dwordx4 a[232:235], v1, s[44:47], s25 offen offset:2048 sc1
M v[220:223], a[176:179], v[76:79], v[220:223]
ds_write_b128 v2, a[88:91] offset:14336
buffer_load_dwordx4 a[236:239], v1, s[44:47], s25 offen offset:3072 sc1
M v[220:223], a[172:175], v[44:47], v[220:223]
s_add_u32 s25, s25, 16384
s_add_u32 s26, s26, 131072
ds_write_b128 v2, a[92:95] offset:15360
s_waitcnt lgkmcnt(0)
Lk2_merge:
s_lshl_b32 s33, s22, 10
s_add_u32 s33, s33, 28672
s_xor_b32 s34, s33, 2048
v_add_u32 v14, s33, v1
v_add_u32 v15, s34, v1
v_accvgpr_read_b32 v20, a96
v_accvgpr_read_b32 v21, a100
v_accvgpr_read_b32 v22, a104
v_accvgpr_read_b32 v23, a108
ds_write_b128 v14, v[20:23]
s_waitcnt lgkmcnt(0)
s_barrier
ds_read_b128 v[28:31], v15
ds_read_b128 v[32:35], v3 offset:0
ds_read_b128 v[36:39], v3 offset:1024
ds_read_b128 v[40:43], v3 offset:2048
ds_read_b128 v[44:47], v3 offset:3072
ds_read_b128 v[48:51], v3 offset:4096
ds_read_b128 v[52:55], v3 offset:5120
ds_read_b128 v[56:59], v3 offset:6144
ds_read_b128 v[60:63], v3 offset:7168
ds_read_b128 v[64:67], v3 offset:8192
ds_read_b128 v[68:71], v3 offset:9216
ds_read_b128 v[72:75], v3 offset:10240
ds_read_b128 v[76:79], v3 offset:11264
ds_read_b128 v[80:83], v3 offset:12288
ds_read_b128 v[84:87], v3 offset:13312
ds_read_b128 v[88:91], v3 offset:14336
ds_read_b128 v[92:95], v3 offset:15360
s_waitcnt lgkmcnt(15)
v_add_f32 v20, v20, v28
v_add_f32 v21, v21, v29
v_add_f32 v22, v22, v30
v_add_f32 v23, v23, v31
s_sub_u32 s35, 15, s21
v_rcp_f32 v8, v20
v_rcp_f32 v9, v21
v_rcp_f32 v10, v22
v_rcp_f32 v11, v23
v_subrev_u32 v20, 0x21800000, v20
v_subrev_u32 v21, 0x21800000, v21
v_subrev_u32 v22, 0x21800000, v22
v_subrev_u32 v23, 0x21800000, v23
v_max_u32 v12, v20, v21
v_max3_u32 v12, v12, v22, v23
s_mov_b32 s64, 0x207
s_lshl_b32 s33, s35, 20
s_lshl_b32 s34, s20, 15
s_add_u32 s33, s33, s34
s_lshl_b32 s34, s23, 13
s_add_u32 s36, s33, s34
s_add_u32 s37, s36, 4096
s_add_u32 s38, s36, 16384
s_add_u32 s39, s36, 20480
v_pk_add_f32 v[160:161], v[160:161], v[32:33]
v_pk_add_f32 v[162:163], v[162:163], v[34:35]
s_waitcnt lgkmcnt(11)
v_pk_add_f32 v[176:177], v[176:177], v[48:49]
v_pk_add_f32 v[178:179], v[178:179], v[50:51]
v_pk_mul_f32 v[160:161], v[160:161], v[8:9] op_sel:[0,0] op_sel_hi:[1,0]
v_pk_mul_f32 v[162:163], v[162:163], v[8:9] op_sel:[0,0] op_sel_hi:[1,0]
v_pk_mul_f32 v[176:177], v[176:177], v[8:9] op_sel:[0,0] op_sel_hi:[1,0]
v_pk_mul_f32 v[178:179], v[178:179], v[8:9] op_sel:[0,0] op_sel_hi:[1,0]
v_cvt_pk_bf16_f32 v160, v160, v161
v_cvt_pk_bf16_f32 v161, v162, v163
v_cvt_pk_bf16_f32 v162, v176, v177
v_cvt_pk_bf16_f32 v163, v178, v179
v_pk_add_f32 v[164:165], v[164:165], v[36:37]
v_pk_add_f32 v[166:167], v[166:167], v[38:39]
s_waitcnt lgkmcnt(10)
v_pk_add_f32 v[180:181], v[180:181], v[52:53]
v_pk_add_f32 v[182:183], v[182:183], v[54:55]
M v[24:27], a[112:115], v[160:163], 0
buffer_store_dwordx4 v[160:163], v1, s[16:19], s36 offen offset:0 sc1
v_pk_mul_f32 v[164:165], v[164:165], v[8:9] op_sel:[0,1] op_sel_hi:[1,1]
v_pk_mul_f32 v[166:167], v[166:167], v[8:9] op_sel:[0,1] op_sel_hi:[1,1]
v_pk_mul_f32 v[180:181], v[180:181], v[8:9] op_sel:[0,1] op_sel_hi:[1,1]
v_pk_mul_f32 v[182:183], v[182:183], v[8:9] op_sel:[0,1] op_sel_hi:[1,1]
v_cvt_pk_bf16_f32 v164, v164, v165
v_cvt_pk_bf16_f32 v165, v166, v167
v_cvt_pk_bf16_f32 v166, v180, v181
v_cvt_pk_bf16_f32 v167, v182, v183
v_pk_add_f32 v[168:169], v[168:169], v[40:41]
v_pk_add_f32 v[170:171], v[170:171], v[42:43]
s_waitcnt lgkmcnt(9)
v_pk_add_f32 v[184:185], v[184:185], v[56:57]
v_pk_add_f32 v[186:187], v[186:187], v[58:59]
M v[24:27], a[112:115], v[164:167], v[24:27]
buffer_store_dwordx4 v[164:167], v1, s[16:19], s36 offen offset:2048 sc1
v_pk_mul_f32 v[168:169], v[168:169], v[10:11] op_sel:[0,0] op_sel_hi:[1,0]
v_pk_mul_f32 v[170:171], v[170:171], v[10:11] op_sel:[0,0] op_sel_hi:[1,0]
v_pk_mul_f32 v[184:185], v[184:185], v[10:11] op_sel:[0,0] op_sel_hi:[1,0]
v_pk_mul_f32 v[186:187], v[186:187], v[10:11] op_sel:[0,0] op_sel_hi:[1,0]
v_cvt_pk_bf16_f32 v168, v168, v169
v_cvt_pk_bf16_f32 v169, v170, v171
v_cvt_pk_bf16_f32 v170, v184, v185
v_cvt_pk_bf16_f32 v171, v186, v187
v_pk_add_f32 v[172:173], v[172:173], v[44:45]
v_pk_add_f32 v[174:175], v[174:175], v[46:47]
s_waitcnt lgkmcnt(8)
v_pk_add_f32 v[188:189], v[188:189], v[60:61]
v_pk_add_f32 v[190:191], v[190:191], v[62:63]
M v[24:27], a[112:115], v[168:171], v[24:27]
buffer_store_dwordx4 v[168:171], v1, s[16:19], s37 offen offset:0 sc1
v_pk_mul_f32 v[172:173], v[172:173], v[10:11] op_sel:[0,1] op_sel_hi:[1,1]
v_pk_mul_f32 v[174:175], v[174:175], v[10:11] op_sel:[0,1] op_sel_hi:[1,1]
v_pk_mul_f32 v[188:189], v[188:189], v[10:11] op_sel:[0,1] op_sel_hi:[1,1]
v_pk_mul_f32 v[190:191], v[190:191], v[10:11] op_sel:[0,1] op_sel_hi:[1,1]
v_cvt_pk_bf16_f32 v172, v172, v173
v_cvt_pk_bf16_f32 v173, v174, v175
v_cvt_pk_bf16_f32 v174, v188, v189
v_cvt_pk_bf16_f32 v175, v190, v191
s_waitcnt lgkmcnt(7)
v_pk_add_f32 v[192:193], v[192:193], v[64:65]
v_pk_add_f32 v[194:195], v[194:195], v[66:67]
s_waitcnt lgkmcnt(3)
v_pk_add_f32 v[208:209], v[208:209], v[80:81]
v_pk_add_f32 v[210:211], v[210:211], v[82:83]
M v[24:27], a[112:115], v[172:175], v[24:27]
buffer_store_dwordx4 v[172:175], v1, s[16:19], s37 offen offset:2048 sc1
v_pk_mul_f32 v[192:193], v[192:193], v[8:9] op_sel:[0,0] op_sel_hi:[1,0]
v_pk_mul_f32 v[194:195], v[194:195], v[8:9] op_sel:[0,0] op_sel_hi:[1,0]
v_pk_mul_f32 v[208:209], v[208:209], v[8:9] op_sel:[0,0] op_sel_hi:[1,0]
v_pk_mul_f32 v[210:211], v[210:211], v[8:9] op_sel:[0,0] op_sel_hi:[1,0]
v_cvt_pk_bf16_f32 v192, v192, v193
v_cvt_pk_bf16_f32 v193, v194, v195
v_cvt_pk_bf16_f32 v194, v208, v209
v_cvt_pk_bf16_f32 v195, v210, v211
v_pk_add_f32 v[196:197], v[196:197], v[68:69]
v_pk_add_f32 v[198:199], v[198:199], v[70:71]
s_waitcnt lgkmcnt(2)
v_pk_add_f32 v[212:213], v[212:213], v[84:85]
v_pk_add_f32 v[214:215], v[214:215], v[86:87]
M v[24:27], a[112:115], v[192:195], v[24:27]
buffer_store_dwordx4 v[192:195], v1, s[16:19], s36 offen offset:1024 sc1
v_pk_mul_f32 v[196:197], v[196:197], v[8:9] op_sel:[0,1] op_sel_hi:[1,1]
v_pk_mul_f32 v[198:199], v[198:199], v[8:9] op_sel:[0,1] op_sel_hi:[1,1]
v_pk_mul_f32 v[212:213], v[212:213], v[8:9] op_sel:[0,1] op_sel_hi:[1,1]
v_pk_mul_f32 v[214:215], v[214:215], v[8:9] op_sel:[0,1] op_sel_hi:[1,1]
v_cvt_pk_bf16_f32 v196, v196, v197
v_cvt_pk_bf16_f32 v197, v198, v199
v_cvt_pk_bf16_f32 v198, v212, v213
v_cvt_pk_bf16_f32 v199, v214, v215
v_pk_add_f32 v[200:201], v[200:201], v[72:73]
v_pk_add_f32 v[202:203], v[202:203], v[74:75]
s_waitcnt lgkmcnt(1)
v_pk_add_f32 v[216:217], v[216:217], v[88:89]
v_pk_add_f32 v[218:219], v[218:219], v[90:91]
M v[24:27], a[112:115], v[196:199], v[24:27]
buffer_store_dwordx4 v[196:199], v1, s[16:19], s36 offen offset:3072 sc1
v_pk_mul_f32 v[200:201], v[200:201], v[10:11] op_sel:[0,0] op_sel_hi:[1,0]
v_pk_mul_f32 v[202:203], v[202:203], v[10:11] op_sel:[0,0] op_sel_hi:[1,0]
v_pk_mul_f32 v[216:217], v[216:217], v[10:11] op_sel:[0,0] op_sel_hi:[1,0]
v_pk_mul_f32 v[218:219], v[218:219], v[10:11] op_sel:[0,0] op_sel_hi:[1,0]
v_cvt_pk_bf16_f32 v200, v200, v201
v_cvt_pk_bf16_f32 v201, v202, v203
v_cvt_pk_bf16_f32 v202, v216, v217
v_cvt_pk_bf16_f32 v203, v218, v219
v_pk_add_f32 v[204:205], v[204:205], v[76:77]
v_pk_add_f32 v[206:207], v[206:207], v[78:79]
s_waitcnt lgkmcnt(0)
v_pk_add_f32 v[220:221], v[220:221], v[92:93]
v_pk_add_f32 v[222:223], v[222:223], v[94:95]
M v[24:27], a[112:115], v[200:203], v[24:27]
buffer_store_dwordx4 v[200:203], v1, s[16:19], s37 offen offset:1024 sc1
v_pk_mul_f32 v[204:205], v[204:205], v[10:11] op_sel:[0,1] op_sel_hi:[1,1]
v_pk_mul_f32 v[206:207], v[206:207], v[10:11] op_sel:[0,1] op_sel_hi:[1,1]
v_pk_mul_f32 v[220:221], v[220:221], v[10:11] op_sel:[0,1] op_sel_hi:[1,1]
v_pk_mul_f32 v[222:223], v[222:223], v[10:11] op_sel:[0,1] op_sel_hi:[1,1]
v_cvt_pk_bf16_f32 v204, v204, v205
v_cvt_pk_bf16_f32 v205, v206, v207
v_cvt_pk_bf16_f32 v206, v220, v221
v_cvt_pk_bf16_f32 v207, v222, v223
s_nop 1
M v[24:27], a[112:115], v[204:207], v[24:27]
buffer_store_dwordx4 v[204:207], v1, s[16:19], s37 offen offset:3072 sc1
v_cmp_lt_u32 vcc, 0x3c000000, v12
s_nop 5
v_cmp_class_f32 s[40:41], v24, s64
s_nop 0
s_or_b64 vcc, vcc, s[40:41]
s_cmp_lg_u64 vcc, 0
s_cselect_b32 s33, 2, 0
s_or_b32 s60, s60, s33
s_branch Lk2_chk
Lk2_wm:
s_lshl_b32 s33, s2, 1
s_add_u32 s33, s33, s23
s_lshl_b32 s34, s33, 12
s_lshl_b32 s33, s33, 14
v_lshlrev_b32 v8, 3, v1
v_lshlrev_b32 v9, 2, v1
buffer_load_dword a244, v8, s[44:47], s33 offen
s_add_u32 s33, s33, 8192
buffer_load_dword a245, v8, s[44:47], s33 offen
buffer_load_dword a246, v9, s[48:51], s34 offen
s_branch Lk2_l3b
Lk2_g1:
s_mov_b32 s30, 7
s_bfe_u32 s65, s2, 0x20003
s_add_u32 s65, s65, 2
s_lshl_b32 s42, s21, 1
s_min_u32 s42, s42, 13
s_add_u32 s42, s42, 2
s_sub_u32 s33, s42, 1
s_cmp_le_u32 s33, 1
s_cselect_b32 s33, 0x4000, 0
v_add_u32 v3, s33, v3
s_sub_u32 s42, s42, 1
Lk2_l3:
s_cmp_eq_u32 s30, s65
s_cbranch_scc1 Lk2_wm
Lk2_l3b:
s_add_u32 m0, s29, 65536
s_waitcnt lgkmcnt(4)
M v[96:99], a[116:119], a[0:3], 0
v_exp_f32 v64, v64
M v[96:99], a[120:123], a[4:7], v[96:99]
ds_read_b128 a[148:151], v2 offset:8192
ds_read_b128 a[152:155], v2 offset:9216
M v[96:99], a[124:127], a[8:11], v[96:99]
v_exp_f32 v65, v65
M v[96:99], a[128:131], a[12:15], v[96:99]
buffer_load_dwordx4 v1, s[12:15], s25 offen offset:0 sc1 lds
s_add_u32 s32, s25, 4096
M v[100:103], a[128:131], a[28:31], 0
v_exp_f32 v66, v66
M v[100:103], a[124:127], a[24:27], v[100:103]
v_cvt_pk_bf16_f32 v64, v64, v65
M v[100:103], a[120:123], a[20:23], v[100:103]
v_exp_f32 v67, v67
M v[100:103], a[116:119], a[16:19], v[100:103]
buffer_load_dwordx4 v1, s[12:15], s25 offen offset:1024 sc1 lds
M v[104:107], a[116:119], a[32:35], 0
v_exp_f32 v80, v80
M v[104:107], a[120:123], a[36:39], v[104:107]
ds_read_b128 a[156:159], v2 offset:10240
ds_read_b128 a[160:163], v2 offset:11264
M v[104:107], a[124:127], a[40:43], v[104:107]
v_exp_f32 v81, v81
M v[104:107], a[128:131], a[44:47], v[104:107]
buffer_load_dwordx4 v1, s[12:15], s25 offen offset:2048 sc1 lds
M v[108:111], a[128:131], a[60:63], 0
v_exp_f32 v82, v82
M v[108:111], a[124:127], a[56:59], v[108:111]
v_cvt_pk_bf16_f32 v65, v66, v67
v_cvt_pk_bf16_f32 v66, v80, v81
M v[108:111], a[120:123], a[52:55], v[108:111]
v_exp_f32 v83, v83
M v[108:111], a[116:119], a[48:51], v[108:111]
buffer_load_dwordx4 v1, s[12:15], s25 offen offset:3072 sc1 lds
s_add_u32 m0, s29, 69632
s_waitcnt lgkmcnt(4)
M v[112:115], a[132:135], a[0:3], 0
v_exp_f32 v68, v68
M v[112:115], a[136:139], a[4:7], v[112:115]
ds_read_b128 a[164:167], v2 offset:12288
ds_read_b128 a[168:171], v2 offset:13312
M v[112:115], a[140:143], a[8:11], v[112:115]
v_exp_f32 v69, v69
M v[112:115], a[144:147], a[12:15], v[112:115]
buffer_load_dwordx4 v1, s[12:15], s32 offen offset:0 sc1 lds
M v[116:119], a[144:147], a[28:31], 0
v_exp_f32 v70, v70
M v[116:119], a[140:143], a[24:27], v[116:119]
v_cvt_pk_bf16_f32 v67, v82, v83
v_cvt_pk_bf16_f32 v68, v68, v69
M v[116:119], a[136:139], a[20:23], v[116:119]
v_exp_f32 v71, v71
M v[116:119], a[132:135], a[16:19], v[116:119]
buffer_load_dwordx4 v1, s[12:15], s32 offen offset:1024 sc1 lds
M v[120:123], a[132:135], a[32:35], 0
v_exp_f32 v84, v84
M v[120:123], a[136:139], a[36:39], v[120:123]
ds_read_b128 a[172:175], v2 offset:14336
ds_read_b128 a[176:179], v2 offset:15360
M v[120:123], a[140:143], a[40:43], v[120:123]
v_exp_f32 v85, v85
M v[120:123], a[144:147], a[44:47], v[120:123]
buffer_load_dwordx4 v1, s[12:15], s32 offen offset:2048 sc1 lds
M v[124:127], a[144:147], a[60:63], 0
v_exp_f32 v86, v86
M v[124:127], a[140:143], a[56:59], v[124:127]
v_cvt_pk_bf16_f32 v69, v70, v71
v_cvt_pk_bf16_f32 v70, v84, v85
M v[124:127], a[136:139], a[52:55], v[124:127]
v_exp_f32 v87, v87
M v[124:127], a[132:135], a[48:51], v[124:127]
buffer_load_dwordx4 v1, s[12:15], s32 offen offset:3072 sc1 lds
s_add_u32 m0, s29, 98304
s_waitcnt lgkmcnt(4)
M v[128:131], a[148:151], a[0:3], 0
v_exp_f32 v72, v72
M v[128:131], a[152:155], a[4:7], v[128:131]
ds_read_b128 a[116:119], v5 offset:32768
ds_read_b128 a[120:123], v5 offset:40960
M v[128:131], a[156:159], a[8:11], v[128:131]
v_exp_f32 v73, v73
M v[128:131], a[160:163], a[12:15], v[128:131]
buffer_load_dwordx4 v1, s[12:15], s26 offen offset:0 sc1 lds
s_add_u32 s43, s26, 4096
M v[132:135], a[160:163], a[28:31], 0
v_exp_f32 v74, v74
M v[132:135], a[156:159], a[24:27], v[132:135]
v_cvt_pk_bf16_f32 v71, v86, v87
v_cvt_pk_bf16_f32 v72, v72, v73
M v[132:135], a[152:155], a[20:23], v[132:135]
v_exp_f32 v75, v75
M v[132:135], a[148:151], a[16:19], v[132:135]
buffer_load_dwordx4 v1, s[12:15], s26 offen offset:1024 sc1 lds
M v[136:139], a[148:151], a[32:35], 0
v_exp_f32 v88, v88
M v[136:139], a[152:155], a[36:39], v[136:139]
ds_read_b128 a[124:127], v5 offset:33792
ds_read_b128 a[128:131], v5 offset:41984
M v[136:139], a[156:159], a[40:43], v[136:139]
v_exp_f32 v89, v89
M v[136:139], a[160:163], a[44:47], v[136:139]
buffer_load_dwordx4 v1, s[12:15], s26 offen offset:2048 sc1 lds
M v[140:143], a[160:163], a[60:63], 0
v_exp_f32 v90, v90
M v[140:143], a[156:159], a[56:59], v[140:143]
v_cvt_pk_bf16_f32 v73, v74, v75
v_cvt_pk_bf16_f32 v74, v88, v89
M v[140:143], a[152:155], a[52:55], v[140:143]
v_exp_f32 v91, v91
M v[140:143], a[148:151], a[48:51], v[140:143]
buffer_load_dwordx4 v1, s[12:15], s26 offen offset:3072 sc1 lds
s_add_u32 m0, s29, 102400
s_waitcnt lgkmcnt(4)
M v[144:147], a[164:167], a[0:3], 0
v_exp_f32 v76, v76
M v[144:147], a[168:171], a[4:7], v[144:147]
ds_read_b128 a[132:135], v5 offset:34816
ds_read_b128 a[136:139], v5 offset:43008
M v[144:147], a[172:175], a[8:11], v[144:147]
v_exp_f32 v77, v77
M v[144:147], a[176:179], a[12:15], v[144:147]
buffer_load_dwordx4 v1, s[12:15], s43 offen offset:0 sc1 lds
M v[148:151], a[176:179], a[28:31], 0
v_exp_f32 v78, v78
M v[148:151], a[172:175], a[24:27], v[148:151]
v_cvt_pk_bf16_f32 v75, v90, v91
v_cvt_pk_bf16_f32 v76, v76, v77
M v[148:151], a[168:171], a[20:23], v[148:151]
v_exp_f32 v79, v79
M v[148:151], a[164:167], a[16:19], v[148:151]
buffer_load_dwordx4 v1, s[12:15], s43 offen offset:1024 sc1 lds
M v[152:155], a[164:167], a[32:35], 0
v_exp_f32 v92, v92
M v[152:155], a[168:171], a[36:39], v[152:155]
ds_read_b128 a[140:143], v5 offset:35840
ds_read_b128 a[144:147], v5 offset:44032
M v[152:155], a[172:175], a[40:43], v[152:155]
v_exp_f32 v93, v93
M v[152:155], a[176:179], a[44:47], v[152:155]
buffer_load_dwordx4 v1, s[12:15], s43 offen offset:2048 sc1 lds
M v[156:159], a[176:179], a[60:63], 0
v_exp_f32 v94, v94
M v[156:159], a[172:175], a[56:59], v[156:159]
v_cvt_pk_bf16_f32 v77, v78, v79
v_cvt_pk_bf16_f32 v78, v92, v93
M v[156:159], a[168:171], a[52:55], v[156:159]
v_exp_f32 v95, v95
M v[156:159], a[164:167], a[48:51], v[156:159]
buffer_load_dwordx4 v1, s[12:15], s43 offen offset:3072 sc1 lds
v_cvt_pk_bf16_f32 v79, v94, v95
s_waitcnt lgkmcnt(6)
M v[160:163], a[116:119], v[32:35], v[160:163]
v_exp_f32 v96, v96
M v[160:163], a[120:123], v[64:67], v[160:163]
ds_read_b128 a[148:151], v5 offset:36864
ds_read_b128 a[152:155], v5 offset:45056
M v[164:167], a[120:123], v[68:71], v[164:167]
v_exp_f32 v97, v97
M v[164:167], a[116:119], v[36:39], v[164:167]
v_cvt_pk_bf16_f32 v96, v96, v97
M v[168:171], a[116:119], v[40:43], v[168:171]
v_exp_f32 v98, v98
M v[168:171], a[120:123], v[72:75], v[168:171]
s_add_u32 s25, s25, 32768
s_cmp_eq_u32 s25, s27
M v[172:175], a[120:123], v[76:79], v[172:175]
v_exp_f32 v99, v99
M v[172:175], a[116:119], v[44:47], v[172:175]
v_cvt_pk_bf16_f32 v97, v98, v99
s_waitcnt lgkmcnt(6)
M a[96:99], a[112:115], v[32:35], a[96:99]
s_cselect_b32 s25, s28, s25
s_cselect_b32 s27, s56, s27
M a[96:99], a[112:115], v[64:67], a[96:99]
s_cselect_b32 s28, s57, s28
s_cselect_b32 s56, -1, s56
M v[176:179], a[124:127], v[32:35], v[176:179]
v_exp_f32 v112, v112
M v[176:179], a[128:131], v[64:67], v[176:179]
ds_read_b128 a[156:159], v5 offset:37888
ds_read_b128 a[160:163], v5 offset:46080
M v[180:183], a[128:131], v[68:71], v[180:183]
v_exp_f32 v113, v113
M v[180:183], a[124:127], v[36:39], v[180:183]
v_cvt_pk_bf16_f32 v98, v112, v113
M v[184:187], a[124:127], v[40:43], v[184:187]
v_exp_f32 v114, v114
M v[184:187], a[128:131], v[72:75], v[184:187]
s_add_u32 s26, s26, 32768
s_cmp_eq_u32 s26, s62
M v[188:191], a[128:131], v[76:79], v[188:191]
v_exp_f32 v115, v115
M v[188:191], a[124:127], v[44:47], v[188:191]
v_cvt_pk_bf16_f32 v99, v114, v115
s_waitcnt lgkmcnt(6)
M a[100:103], a[112:115], v[36:39], a[100:103]
s_cselect_b32 s26, s63, s26
s_cselect_b32 s62, s58, s62
M a[100:103], a[112:115], v[68:71], a[100:103]
s_cselect_b32 s63, s59, s63
s_cselect_b32 s58, -1, s58
M v[192:195], a[132:135], v[32:35], v[192:195]
v_exp_f32 v100, v100
M v[192:195], a[136:139], v[64:67], v[192:195]
ds_read_b128 a[164:167], v5 offset:38912
ds_read_b128 a[168:171], v5 offset:47104
M v[196:199], a[136:139], v[68:71], v[196:199]
v_exp_f32 v101, v101
M v[196:199], a[132:135], v[36:39], v[196:199]
v_cvt_pk_bf16_f32 v100, v100, v101
M v[200:203], a[132:135], v[40:43], v[200:203]
v_exp_f32 v102, v102
M v[200:203], a[136:139], v[72:75], v[200:203]
s_sub_u32 s33, s42, 1
s_cmp_le_u32 s33, 1
s_cselect_b32 s33, 0x4000, 0
v_add_u32 v2, s33, v2
M v[204:207], a[136:139], v[76:79], v[204:207]
v_exp_f32 v103, v103
M v[204:207], a[132:135], v[44:47], v[204:207]
v_cvt_pk_bf16_f32 v101, v102, v103
s_waitcnt lgkmcnt(6)
M a[104:107], a[112:115], v[40:43], a[104:107]
M a[104:107], a[112:115], v[72:75], a[104:107]
M v[208:211], a[140:143], v[32:35], v[208:211]
v_exp_f32 v116, v116
M v[208:211], a[144:147], v[64:67], v[208:211]
ds_read_b128 a[172:175], v5 offset:39936
ds_read_b128 a[176:179], v5 offset:48128
M v[212:215], a[144:147], v[68:71], v[212:215]
v_exp_f32 v117, v117
M v[212:215], a[140:143], v[36:39], v[212:215]
v_cvt_pk_bf16_f32 v102, v116, v117
M v[216:219], a[140:143], v[40:43], v[216:219]
v_exp_f32 v118, v118
M v[216:219], a[144:147], v[72:75], v[216:219]
M v[220:223], a[144:147], v[76:79], v[220:223]
v_exp_f32 v119, v119
M v[220:223], a[140:143], v[44:47], v[220:223]
v_cvt_pk_bf16_f32 v103, v118, v119
s_waitcnt lgkmcnt(6)
M a[108:111], a[112:115], v[44:47], a[108:111]
M a[108:111], a[112:115], v[76:79], a[108:111]
M v[224:227], a[148:151], v[32:35], v[224:227]
v_exp_f32 v104, v104
M v[224:227], a[152:155], v[64:67], v[224:227]
s_cmp_le_u32 s42, 1
s_cselect_b32 s33, 0x4000, 0
v_add_u32 v5, s33, v5
s_sub_u32 s42, s42, 1
M v[228:231], a[152:155], v[68:71], v[228:231]
v_exp_f32 v105, v105
M v[228:231], a[148:151], v[36:39], v[228:231]
v_cvt_pk_bf16_f32 v104, v104, v105
M v[232:235], a[148:151], v[40:43], v[232:235]
v_exp_f32 v106, v106
M v[232:235], a[152:155], v[72:75], v[232:235]
M v[236:239], a[152:155], v[76:79], v[236:239]
v_exp_f32 v107, v107
M v[236:239], a[148:151], v[44:47], v[236:239]
v_cvt_pk_bf16_f32 v105, v106, v107
s_waitcnt lgkmcnt(4)
M v[240:243], a[156:159], v[32:35], v[240:243]
v_exp_f32 v120, v120
M v[240:243], a[160:163], v[64:67], v[240:243]
M v[244:247], a[160:163], v[68:71], v[244:247]
v_exp_f32 v121, v121
M v[244:247], a[156:159], v[36:39], v[244:247]
v_cvt_pk_bf16_f32 v106, v120, v121
M v[248:251], a[156:159], v[40:43], v[248:251]
v_exp_f32 v122, v122
M v[248:251], a[160:163], v[72:75], v[248:251]
s_waitcnt vmcnt(0) lgkmcnt(0)
s_barrier
ds_read_b128 a[116:119], v3 offset:0
ds_read_b128 a[120:123], v3 offset:1024
M v[252:255], a[160:163], v[76:79], v[252:255]
v_exp_f32 v123, v123
M v[252:255], a[156:159], v[44:47], v[252:255]
v_cvt_pk_bf16_f32 v107, v122, v123
M a[64:67], a[164:167], v[32:35], a[64:67]
v_exp_f32 v108, v108
M a[64:67], a[168:171], v[64:67], a[64:67]
ds_read_b128 a[124:127], v3 offset:2048
ds_read_b128 a[128:131], v3 offset:3072
M a[68:71], a[168:171], v[68:71], a[68:71]
v_exp_f32 v109, v109
M a[68:71], a[164:167], v[36:39], a[68:71]
v_cvt_pk_bf16_f32 v108, v108, v109
M a[72:75], a[164:167], v[40:43], a[72:75]
v_exp_f32 v110, v110
M a[72:75], a[168:171], v[72:75], a[72:75]
ds_read_b128 a[132:135], v3 offset:4096
ds_read_b128 a[136:139], v3 offset:5120
M a[76:79], a[168:171], v[76:79], a[76:79]
v_exp_f32 v111, v111
M a[76:79], a[164:167], v[44:47], a[76:79]
v_cvt_pk_bf16_f32 v109, v110, v111
M a[80:83], a[172:175], v[32:35], a[80:83]
v_exp_f32 v124, v124
M a[80:83], a[176:179], v[64:67], a[80:83]
ds_read_b128 a[140:143], v3 offset:6144
ds_read_b128 a[144:147], v3 offset:7168
M a[84:87], a[176:179], v[68:71], a[84:87]
v_exp_f32 v125, v125
M a[84:87], a[172:175], v[36:39], a[84:87]
v_cvt_pk_bf16_f32 v110, v124, v125
M a[88:91], a[172:175], v[40:43], a[88:91]
v_exp_f32 v126, v126
M a[88:91], a[176:179], v[72:75], a[88:91]
M a[92:95], a[176:179], v[76:79], a[92:95]
v_exp_f32 v127, v127
M a[92:95], a[172:175], v[44:47], a[92:95]
v_cvt_pk_bf16_f32 v111, v126, v127
s_add_u32 m0, s29, 0
s_waitcnt lgkmcnt(4)
M v[32:35], a[116:119], a[0:3], 0
v_exp_f32 v128, v128
M v[32:35], a[120:123], a[4:7], v[32:35]
ds_read_b128 a[148:151], v3 offset:8192
ds_read_b128 a[152:155], v3 offset:9216
M v[32:35], a[124:127], a[8:11], v[32:35]
v_exp_f32 v129, v129
M v[32:35], a[128:131], a[12:15], v[32:35]
buffer_load_dwordx4 v1, s[12:15], s25 offen offset:0 sc1 lds
s_add_u32 s32, s25, 4096
M v[36:39], a[128:131], a[28:31], 0
v_exp_f32 v130, v130
M v[36:39], a[124:127], a[24:27], v[36:39]
v_cvt_pk_bf16_f32 v128, v128, v129
M v[36:39], a[120:123], a[20:23], v[36:39]
v_exp_f32 v131, v131
M v[36:39], a[116:119], a[16:19], v[36:39]
buffer_load_dwordx4 v1, s[12:15], s25 offen offset:1024 sc1 lds
M v[40:43], a[116:119], a[32:35], 0
v_exp_f32 v144, v144
M v[40:43], a[120:123], a[36:39], v[40:43]
ds_read_b128 a[156:159], v3 offset:10240
ds_read_b128 a[160:163], v3 offset:11264
M v[40:43], a[124:127], a[40:43], v[40:43]
v_exp_f32 v145, v145
M v[40:43], a[128:131], a[44:47], v[40:43]
buffer_load_dwordx4 v1, s[12:15], s25 offen offset:2048 sc1 lds
M v[44:47], a[128:131], a[60:63], 0
v_exp_f32 v146, v146
M v[44:47], a[124:127], a[56:59], v[44:47]
v_cvt_pk_bf16_f32 v129, v130, v131
v_cvt_pk_bf16_f32 v130, v144, v145
M v[44:47], a[120:123], a[52:55], v[44:47]
v_exp_f32 v147, v147
M v[44:47], a[116:119], a[48:51], v[44:47]
buffer_load_dwordx4 v1, s[12:15], s25 offen offset:3072 sc1 lds
s_add_u32 m0, s29, 4096
s_waitcnt lgkmcnt(4)
M v[48:51], a[132:135], a[0:3], 0
v_exp_f32 v132, v132
M v[48:51], a[136:139], a[4:7], v[48:51]
ds_read_b128 a[164:167], v3 offset:12288
ds_read_b128 a[168:171], v3 offset:13312
M v[48:51], a[140:143], a[8:11], v[48:51]
v_exp_f32 v133, v133
M v[48:51], a[144:147], a[12:15], v[48:51]
buffer_load_dwordx4 v1, s[12:15], s32 offen offset:0 sc1 lds
M v[52:55], a[144:147], a[28:31], 0
v_exp_f32 v134, v134
M v[52:55], a[140:143], a[24:27], v[52:55]
v_cvt_pk_bf16_f32 v131, v146, v147
v_cvt_pk_bf16_f32 v132, v132, v133
M v[52:55], a[136:139], a[20:23], v[52:55]
v_exp_f32 v135, v135
M v[52:55], a[132:135], a[16:19], v[52:55]
buffer_load_dwordx4 v1, s[12:15], s32 offen offset:1024 sc1 lds
M v[56:59], a[132:135], a[32:35], 0
v_exp_f32 v148, v148
M v[56:59], a[136:139], a[36:39], v[56:59]
ds_read_b128 a[172:175], v3 offset:14336
ds_read_b128 a[176:179], v3 offset:15360
M v[56:59], a[140:143], a[40:43], v[56:59]
v_exp_f32 v149, v149
M v[56:59], a[144:147], a[44:47], v[56:59]
buffer_load_dwordx4 v1, s[12:15], s32 offen offset:2048 sc1 lds
M v[60:63], a[144:147], a[60:63], 0
v_exp_f32 v150, v150
M v[60:63], a[140:143], a[56:59], v[60:63]
v_cvt_pk_bf16_f32 v133, v134, v135
v_cvt_pk_bf16_f32 v134, v148, v149
M v[60:63], a[136:139], a[52:55], v[60:63]
v_exp_f32 v151, v151
M v[60:63], a[132:135], a[48:51], v[60:63]
buffer_load_dwordx4 v1, s[12:15], s32 offen offset:3072 sc1 lds
s_add_u32 m0, s29, 32768
s_waitcnt lgkmcnt(4)
M v[64:67], a[148:151], a[0:3], 0
v_exp_f32 v136, v136
M v[64:67], a[152:155], a[4:7], v[64:67]
ds_read_b128 a[116:119], v6 offset:32768
ds_read_b128 a[120:123], v6 offset:40960
M v[64:67], a[156:159], a[8:11], v[64:67]
v_exp_f32 v137, v137
M v[64:67], a[160:163], a[12:15], v[64:67]
buffer_load_dwordx4 v1, s[12:15], s26 offen offset:0 sc1 lds
s_add_u32 s43, s26, 4096
M v[68:71], a[160:163], a[28:31], 0
v_exp_f32 v138, v138
M v[68:71], a[156:159], a[24:27], v[68:71]
v_cvt_pk_bf16_f32 v135, v150, v151
v_cvt_pk_bf16_f32 v136, v136, v137
M v[68:71], a[152:155], a[20:23], v[68:71]
v_exp_f32 v139, v139
M v[68:71], a[148:151], a[16:19], v[68:71]
buffer_load_dwordx4 v1, s[12:15], s26 offen offset:1024 sc1 lds
M v[72:75], a[148:151], a[32:35], 0
v_exp_f32 v152, v152
M v[72:75], a[152:155], a[36:39], v[72:75]
ds_read_b128 a[124:127], v6 offset:33792
ds_read_b128 a[128:131], v6 offset:41984
M v[72:75], a[156:159], a[40:43], v[72:75]
v_exp_f32 v153, v153
M v[72:75], a[160:163], a[44:47], v[72:75]
buffer_load_dwordx4 v1, s[12:15], s26 offen offset:2048 sc1 lds
M v[76:79], a[160:163], a[60:63], 0
v_exp_f32 v154, v154
M v[76:79], a[156:159], a[56:59], v[76:79]
v_cvt_pk_bf16_f32 v137, v138, v139
v_cvt_pk_bf16_f32 v138, v152, v153
M v[76:79], a[152:155], a[52:55], v[76:79]
v_exp_f32 v155, v155
M v[76:79], a[148:151], a[48:51], v[76:79]
buffer_load_dwordx4 v1, s[12:15], s26 offen offset:3072 sc1 lds
s_add_u32 m0, s29, 36864
s_waitcnt lgkmcnt(4)
M v[80:83], a[164:167], a[0:3], 0
v_exp_f32 v140, v140
M v[80:83], a[168:171], a[4:7], v[80:83]
ds_read_b128 a[132:135], v6 offset:34816
ds_read_b128 a[136:139], v6 offset:43008
M v[80:83], a[172:175], a[8:11], v[80:83]
v_exp_f32 v141, v141
M v[80:83], a[176:179], a[12:15], v[80:83]
buffer_load_dwordx4 v1, s[12:15], s43 offen offset:0 sc1 lds
M v[84:87], a[176:179], a[28:31], 0
v_exp_f32 v142, v142
M v[84:87], a[172:175], a[24:27], v[84:87]
v_cvt_pk_bf16_f32 v139, v154, v155
v_cvt_pk_bf16_f32 v140, v140, v141
M v[84:87], a[168:171], a[20:23], v[84:87]
v_exp_f32 v143, v143
M v[84:87], a[164:167], a[16:19], v[84:87]
buffer_load_dwordx4 v1, s[12:15], s43 offen offset:1024 sc1 lds
M v[88:91], a[164:167], a[32:35], 0
v_exp_f32 v156, v156
M v[88:91], a[168:171], a[36:39], v[88:91]
ds_read_b128 a[140:143], v6 offset:35840
ds_read_b128 a[144:147], v6 offset:44032
M v[88:91], a[172:175], a[40:43], v[88:91]
v_exp_f32 v157, v157
M v[88:91], a[176:179], a[44:47], v[88:91]
buffer_load_dwordx4 v1, s[12:15], s43 offen offset:2048 sc1 lds
M v[92:95], a[176:179], a[60:63], 0
v_exp_f32 v158, v158
M v[92:95], a[172:175], a[56:59], v[92:95]
v_cvt_pk_bf16_f32 v141, v142, v143
v_cvt_pk_bf16_f32 v142, v156, v157
M v[92:95], a[168:171], a[52:55], v[92:95]
v_exp_f32 v159, v159
M v[92:95], a[164:167], a[48:51], v[92:95]
buffer_load_dwordx4 v1, s[12:15], s43 offen offset:3072 sc1 lds
v_cvt_pk_bf16_f32 v143, v158, v159
s_waitcnt lgkmcnt(6)
M v[160:163], a[116:119], v[96:99], v[160:163]
v_exp_f32 v32, v32
M v[160:163], a[120:123], v[128:131], v[160:163]
ds_read_b128 a[148:151], v6 offset:36864
ds_read_b128 a[152:155], v6 offset:45056
M v[164:167], a[120:123], v[132:135], v[164:167]
v_exp_f32 v33, v33
M v[164:167], a[116:119], v[100:103], v[164:167]
v_cvt_pk_bf16_f32 v32, v32, v33
M v[168:171], a[116:119], v[104:107], v[168:171]
v_exp_f32 v34, v34
M v[168:171], a[120:123], v[136:139], v[168:171]
s_add_u32 s25, s25, 32768
s_cmp_eq_u32 s25, s27
M v[172:175], a[120:123], v[140:143], v[172:175]
v_exp_f32 v35, v35
M v[172:175], a[116:119], v[108:111], v[172:175]
v_cvt_pk_bf16_f32 v33, v34, v35
s_waitcnt lgkmcnt(6)
M a[96:99], a[112:115], v[96:99], a[96:99]
s_cselect_b32 s25, s28, s25
s_cselect_b32 s27, s56, s27
M a[96:99], a[112:115], v[128:131], a[96:99]
s_cselect_b32 s28, s57, s28
s_cselect_b32 s56, -1, s56
M v[176:179], a[124:127], v[96:99], v[176:179]
v_exp_f32 v48, v48
M v[176:179], a[128:131], v[128:131], v[176:179]
ds_read_b128 a[156:159], v6 offset:37888
ds_read_b128 a[160:163], v6 offset:46080
M v[180:183], a[128:131], v[132:135], v[180:183]
v_exp_f32 v49, v49
M v[180:183], a[124:127], v[100:103], v[180:183]
v_cvt_pk_bf16_f32 v34, v48, v49
M v[184:187], a[124:127], v[104:107], v[184:187]
v_exp_f32 v50, v50
M v[184:187], a[128:131], v[136:139], v[184:187]
s_add_u32 s26, s26, 32768
s_cmp_eq_u32 s26, s62
M v[188:191], a[128:131], v[140:143], v[188:191]
v_exp_f32 v51, v51
M v[188:191], a[124:127], v[108:111], v[188:191]
v_cvt_pk_bf16_f32 v35, v50, v51
s_waitcnt lgkmcnt(6)
M a[100:103], a[112:115], v[100:103], a[100:103]
s_cselect_b32 s26, s63, s26
s_cselect_b32 s62, s58, s62
M a[100:103], a[112:115], v[132:135], a[100:103]
s_cselect_b32 s63, s59, s63
s_cselect_b32 s58, -1, s58
M v[192:195], a[132:135], v[96:99], v[192:195]
v_exp_f32 v36, v36
M v[192:195], a[136:139], v[128:131], v[192:195]
ds_read_b128 a[164:167], v6 offset:38912
ds_read_b128 a[168:171], v6 offset:47104
M v[196:199], a[136:139], v[132:135], v[196:199]
v_exp_f32 v37, v37
M v[196:199], a[132:135], v[100:103], v[196:199]
v_cvt_pk_bf16_f32 v36, v36, v37
M v[200:203], a[132:135], v[104:107], v[200:203]
v_exp_f32 v38, v38
M v[200:203], a[136:139], v[136:139], v[200:203]
s_sub_u32 s33, s42, 1
s_cmp_le_u32 s33, 1
s_cselect_b32 s33, 0x4000, 0
v_add_u32 v3, s33, v3
M v[204:207], a[136:139], v[140:143], v[204:207]
v_exp_f32 v39, v39
M v[204:207], a[132:135], v[108:111], v[204:207]
v_cvt_pk_bf16_f32 v37, v38, v39
s_waitcnt lgkmcnt(6)
M a[104:107], a[112:115], v[104:107], a[104:107]
M a[104:107], a[112:115], v[136:139], a[104:107]
M v[208:211], a[140:143], v[96:99], v[208:211]
v_exp_f32 v52, v52
M v[208:211], a[144:147], v[128:131], v[208:211]
ds_read_b128 a[172:175], v6 offset:39936
ds_read_b128 a[176:179], v6 offset:48128
M v[212:215], a[144:147], v[132:135], v[212:215]
v_exp_f32 v53, v53
M v[212:215], a[140:143], v[100:103], v[212:215]
v_cvt_pk_bf16_f32 v38, v52, v53
M v[216:219], a[140:143], v[104:107], v[216:219]
v_exp_f32 v54, v54
M v[216:219], a[144:147], v[136:139], v[216:219]
M v[220:223], a[144:147], v[140:143], v[220:223]
v_exp_f32 v55, v55
M v[220:223], a[140:143], v[108:111], v[220:223]
v_cvt_pk_bf16_f32 v39, v54, v55
s_waitcnt lgkmcnt(6)
M a[108:111], a[112:115], v[108:111], a[108:111]
M a[108:111], a[112:115], v[140:143], a[108:111]
M v[224:227], a[148:151], v[96:99], v[224:227]
v_exp_f32 v40, v40
M v[224:227], a[152:155], v[128:131], v[224:227]
s_cmp_le_u32 s42, 1
s_cselect_b32 s33, 0x4000, 0
v_add_u32 v6, s33, v6
s_sub_u32 s42, s42, 1
M v[228:231], a[152:155], v[132:135], v[228:231]
v_exp_f32 v41, v41
M v[228:231], a[148:151], v[100:103], v[228:231]
v_cvt_pk_bf16_f32 v40, v40, v41
M v[232:235], a[148:151], v[104:107], v[232:235]
v_exp_f32 v42, v42
M v[232:235], a[152:155], v[136:139], v[232:235]
M v[236:239], a[152:155], v[140:143], v[236:239]
v_exp_f32 v43, v43
M v[236:239], a[148:151], v[108:111], v[236:239]
v_cvt_pk_bf16_f32 v41, v42, v43
s_waitcnt lgkmcnt(4)
M v[240:243], a[156:159], v[96:99], v[240:243]
v_exp_f32 v56, v56
M v[240:243], a[160:163], v[128:131], v[240:243]
M v[244:247], a[160:163], v[132:135], v[244:247]
v_exp_f32 v57, v57
M v[244:247], a[156:159], v[100:103], v[244:247]
v_cvt_pk_bf16_f32 v42, v56, v57
M v[248:251], a[156:159], v[104:107], v[248:251]
v_exp_f32 v58, v58
M v[248:251], a[160:163], v[136:139], v[248:251]
s_waitcnt vmcnt(0) lgkmcnt(0)
s_barrier
ds_read_b128 a[116:119], v2 offset:0
ds_read_b128 a[120:123], v2 offset:1024
M v[252:255], a[160:163], v[140:143], v[252:255]
v_exp_f32 v59, v59
M v[252:255], a[156:159], v[108:111], v[252:255]
v_cvt_pk_bf16_f32 v43, v58, v59
M a[64:67], a[164:167], v[96:99], a[64:67]
v_exp_f32 v44, v44
M a[64:67], a[168:171], v[128:131], a[64:67]
ds_read_b128 a[124:127], v2 offset:2048
ds_read_b128 a[128:131], v2 offset:3072
M a[68:71], a[168:171], v[132:135], a[68:71]
v_exp_f32 v45, v45
M a[68:71], a[164:167], v[100:103], a[68:71]
v_cvt_pk_bf16_f32 v44, v44, v45
M a[72:75], a[164:167], v[104:107], a[72:75]
v_exp_f32 v46, v46
M a[72:75], a[168:171], v[136:139], a[72:75]
ds_read_b128 a[132:135], v2 offset:4096
ds_read_b128 a[136:139], v2 offset:5120
M a[76:79], a[168:171], v[140:143], a[76:79]
v_exp_f32 v47, v47
M a[76:79], a[164:167], v[108:111], a[76:79]
v_cvt_pk_bf16_f32 v45, v46, v47
M a[80:83], a[172:175], v[96:99], a[80:83]
v_exp_f32 v60, v60
M a[80:83], a[176:179], v[128:131], a[80:83]
ds_read_b128 a[140:143], v2 offset:6144
ds_read_b128 a[144:147], v2 offset:7168
M a[84:87], a[176:179], v[132:135], a[84:87]
v_exp_f32 v61, v61
M a[84:87], a[172:175], v[100:103], a[84:87]
v_cvt_pk_bf16_f32 v46, v60, v61
M a[88:91], a[172:175], v[104:107], a[88:91]
v_exp_f32 v62, v62
M a[88:91], a[176:179], v[136:139], a[88:91]
M a[92:95], a[176:179], v[140:143], a[92:95]
v_exp_f32 v63, v63
M a[92:95], a[172:175], v[108:111], a[92:95]
v_cvt_pk_bf16_f32 v47, v62, v63
s_sub_u32 s30, s30, 1
s_cmp_lg_u32 s30, 0
s_cbranch_scc1 Lk2_l3
s_cmp_eq_u32 s23, 1
s_cbranch_scc1 Lk2_g1b
s_add_u32 m0, s29, 65536
s_waitcnt lgkmcnt(4)
M v[96:99], a[116:119], a[0:3], v[16:19]
v_exp_f32 v64, v64
M v[96:99], a[120:123], a[4:7], v[96:99]
ds_read_b128 a[148:151], v2 offset:8192
ds_read_b128 a[152:155], v2 offset:9216
M v[96:99], a[124:127], a[8:11], v[96:99]
v_exp_f32 v65, v65
M v[96:99], a[128:131], a[12:15], v[96:99]
buffer_load_dwordx4 v1, s[12:15], s25 offen offset:0 sc1 lds
s_add_u32 s32, s25, 4096
M v[100:103], a[128:131], a[28:31], 0
v_exp_f32 v66, v66
M v[100:103], a[124:127], a[24:27], v[100:103]
v_cvt_pk_bf16_f32 v64, v64, v65
M v[100:103], a[120:123], a[20:23], v[100:103]
v_exp_f32 v67, v67
M v[100:103], a[116:119], a[16:19], v[100:103]
buffer_load_dwordx4 v1, s[12:15], s25 offen offset:1024 sc1 lds
M v[104:107], a[116:119], a[32:35], 0
v_exp_f32 v80, v80
M v[104:107], a[120:123], a[36:39], v[104:107]
ds_read_b128 a[156:159], v2 offset:10240
ds_read_b128 a[160:163], v2 offset:11264
M v[104:107], a[124:127], a[40:43], v[104:107]
v_exp_f32 v81, v81
M v[104:107], a[128:131], a[44:47], v[104:107]
buffer_load_dwordx4 v1, s[12:15], s25 offen offset:2048 sc1 lds
M v[108:111], a[128:131], a[60:63], 0
v_exp_f32 v82, v82
M v[108:111], a[124:127], a[56:59], v[108:111]
v_cvt_pk_bf16_f32 v65, v66, v67
v_cvt_pk_bf16_f32 v66, v80, v81
M v[108:111], a[120:123], a[52:55], v[108:111]
v_exp_f32 v83, v83
M v[108:111], a[116:119], a[48:51], v[108:111]
buffer_load_dwordx4 v1, s[12:15], s25 offen offset:3072 sc1 lds
s_add_u32 m0, s29, 69632
s_waitcnt lgkmcnt(4)
v_exp_f32 v68, v68
ds_read_b128 a[164:167], v2 offset:12288
ds_read_b128 a[168:171], v2 offset:13312
v_exp_f32 v69, v69
buffer_load_dwordx4 v1, s[12:15], s32 offen offset:0 sc1 lds
M v[116:119], a[144:147], a[28:31], v[16:19]
v_exp_f32 v70, v70
M v[116:119], a[140:143], a[24:27], v[116:119]
v_cvt_pk_bf16_f32 v67, v82, v83
v_cvt_pk_bf16_f32 v68, v68, v69
M v[116:119], a[136:139], a[20:23], v[116:119]
v_exp_f32 v71, v71
M v[116:119], a[132:135], a[16:19], v[116:119]
buffer_load_dwordx4 v1, s[12:15], s32 offen offset:1024 sc1 lds
M v[120:123], a[132:135], a[32:35], 0
v_exp_f32 v84, v84
M v[120:123], a[136:139], a[36:39], v[120:123]
ds_read_b128 a[172:175], v2 offset:14336
ds_read_b128 a[176:179], v2 offset:15360
M v[120:123], a[140:143], a[40:43], v[120:123]
v_exp_f32 v85, v85
M v[120:123], a[144:147], a[44:47], v[120:123]
buffer_load_dwordx4 v1, s[12:15], s32 offen offset:2048 sc1 lds
M v[124:127], a[144:147], a[60:63], 0
v_exp_f32 v86, v86
M v[124:127], a[140:143], a[56:59], v[124:127]
v_cvt_pk_bf16_f32 v69, v70, v71
v_cvt_pk_bf16_f32 v70, v84, v85
M v[124:127], a[136:139], a[52:55], v[124:127]
v_exp_f32 v87, v87
M v[124:127], a[132:135], a[48:51], v[124:127]
buffer_load_dwordx4 v1, s[12:15], s32 offen offset:3072 sc1 lds
s_add_u32 m0, s29, 98304
s_waitcnt lgkmcnt(4)
v_exp_f32 v72, v72
ds_read_b128 a[116:119], v5 offset:32768
ds_read_b128 a[120:123], v5 offset:40960
v_exp_f32 v73, v73
buffer_load_dwordx4 v1, s[12:15], s26 offen offset:0 sc1 lds
s_add_u32 s43, s26, 4096
v_exp_f32 v74, v74
v_cvt_pk_bf16_f32 v71, v86, v87
v_cvt_pk_bf16_f32 v72, v72, v73
v_exp_f32 v75, v75
buffer_load_dwordx4 v1, s[12:15], s26 offen offset:1024 sc1 lds
M v[136:139], a[148:151], a[32:35], v[16:19]
v_exp_f32 v88, v88
M v[136:139], a[152:155], a[36:39], v[136:139]
ds_read_b128 a[124:127], v5 offset:33792
ds_read_b128 a[128:131], v5 offset:41984
M v[136:139], a[156:159], a[40:43], v[136:139]
v_exp_f32 v89, v89
M v[136:139], a[160:163], a[44:47], v[136:139]
buffer_load_dwordx4 v1, s[12:15], s26 offen offset:2048 sc1 lds
M v[140:143], a[160:163], a[60:63], 0
v_exp_f32 v90, v90
M v[140:143], a[156:159], a[56:59], v[140:143]
v_cvt_pk_bf16_f32 v73, v74, v75
v_cvt_pk_bf16_f32 v74, v88, v89
M v[140:143], a[152:155], a[52:55], v[140:143]
v_exp_f32 v91, v91
M v[140:143], a[148:151], a[48:51], v[140:143]
buffer_load_dwordx4 v1, s[12:15], s26 offen offset:3072 sc1 lds
s_add_u32 m0, s29, 102400
s_waitcnt lgkmcnt(4)
v_exp_f32 v76, v76
ds_read_b128 a[132:135], v5 offset:34816
ds_read_b128 a[136:139], v5 offset:43008
v_exp_f32 v77, v77
buffer_load_dwordx4 v1, s[12:15], s43 offen offset:0 sc1 lds
v_exp_f32 v78, v78
v_cvt_pk_bf16_f32 v75, v90, v91
v_cvt_pk_bf16_f32 v76, v76, v77
v_exp_f32 v79, v79
buffer_load_dwordx4 v1, s[12:15], s43 offen offset:1024 sc1 lds
v_exp_f32 v92, v92
ds_read_b128 a[140:143], v5 offset:35840
ds_read_b128 a[144:147], v5 offset:44032
v_exp_f32 v93, v93
buffer_load_dwordx4 v1, s[12:15], s43 offen offset:2048 sc1 lds
M v[156:159], a[176:179], a[60:63], v[16:19]
v_exp_f32 v94, v94
M v[156:159], a[172:175], a[56:59], v[156:159]
v_cvt_pk_bf16_f32 v77, v78, v79
v_cvt_pk_bf16_f32 v78, v92, v93
M v[156:159], a[168:171], a[52:55], v[156:159]
v_exp_f32 v95, v95
M v[156:159], a[164:167], a[48:51], v[156:159]
buffer_load_dwordx4 v1, s[12:15], s43 offen offset:3072 sc1 lds
v_cvt_pk_bf16_f32 v79, v94, v95
s_waitcnt lgkmcnt(6)
M v[160:163], a[116:119], v[32:35], v[160:163]
v_exp_f32 v96, v96
M v[160:163], a[120:123], v[64:67], v[160:163]
ds_read_b128 a[148:151], v5 offset:36864
ds_read_b128 a[152:155], v5 offset:45056
M v[164:167], a[120:123], v[68:71], v[164:167]
v_exp_f32 v97, v97
M v[164:167], a[116:119], v[36:39], v[164:167]
v_cvt_pk_bf16_f32 v96, v96, v97
M v[168:171], a[116:119], v[40:43], v[168:171]
v_exp_f32 v98, v98
M v[168:171], a[120:123], v[72:75], v[168:171]
s_add_u32 s25, s25, 32768
s_cmp_eq_u32 s25, s27
M v[172:175], a[120:123], v[76:79], v[172:175]
v_exp_f32 v99, v99
M v[172:175], a[116:119], v[44:47], v[172:175]
v_cvt_pk_bf16_f32 v97, v98, v99
s_waitcnt lgkmcnt(6)
M a[96:99], a[112:115], v[32:35], a[96:99]
s_cselect_b32 s25, s28, s25
s_cselect_b32 s27, s56, s27
M a[96:99], a[112:115], v[64:67], a[96:99]
s_cselect_b32 s28, s57, s28
s_cselect_b32 s56, -1, s56
M v[176:179], a[124:127], v[32:35], v[176:179]
M v[176:179], a[128:131], v[64:67], v[176:179]
ds_read_b128 a[156:159], v5 offset:37888
ds_read_b128 a[160:163], v5 offset:46080
M v[180:183], a[128:131], v[68:71], v[180:183]
M v[180:183], a[124:127], v[36:39], v[180:183]
v_mov_b32 v98, 0
M v[184:187], a[124:127], v[40:43], v[184:187]
M v[184:187], a[128:131], v[72:75], v[184:187]
s_add_u32 s26, s26, 32768
s_cmp_eq_u32 s26, s62
M v[188:191], a[128:131], v[76:79], v[188:191]
M v[188:191], a[124:127], v[44:47], v[188:191]
v_mov_b32 v99, 0
s_waitcnt lgkmcnt(6)
M a[100:103], a[112:115], v[36:39], a[100:103]
s_cselect_b32 s26, s63, s26
s_cselect_b32 s62, s58, s62
M a[100:103], a[112:115], v[68:71], a[100:103]
s_cselect_b32 s63, s59, s63
s_cselect_b32 s58, -1, s58
M v[192:195], a[132:135], v[32:35], v[192:195]
v_exp_f32 v100, v100
M v[192:195], a[136:139], v[64:67], v[192:195]
ds_read_b128 a[164:167], v5 offset:38912
ds_read_b128 a[168:171], v5 offset:47104
M v[196:199], a[136:139], v[68:71], v[196:199]
v_exp_f32 v101, v101
M v[196:199], a[132:135], v[36:39], v[196:199]
v_cvt_pk_bf16_f32 v100, v100, v101
M v[200:203], a[132:135], v[40:43], v[200:203]
v_exp_f32 v102, v102
M v[200:203], a[136:139], v[72:75], v[200:203]
s_sub_u32 s33, s42, 1
s_cmp_le_u32 s33, 1
s_cselect_b32 s33, 0x4000, 0
v_add_u32 v2, s33, v2
M v[204:207], a[136:139], v[76:79], v[204:207]
v_exp_f32 v103, v103
M v[204:207], a[132:135], v[44:47], v[204:207]
v_cvt_pk_bf16_f32 v101, v102, v103
s_waitcnt lgkmcnt(6)
M a[104:107], a[112:115], v[40:43], a[104:107]
M a[104:107], a[112:115], v[72:75], a[104:107]
M v[208:211], a[140:143], v[32:35], v[208:211]
v_exp_f32 v116, v116
M v[208:211], a[144:147], v[64:67], v[208:211]
ds_read_b128 a[172:175], v5 offset:39936
ds_read_b128 a[176:179], v5 offset:48128
M v[212:215], a[144:147], v[68:71], v[212:215]
v_exp_f32 v117, v117
M v[212:215], a[140:143], v[36:39], v[212:215]
v_cvt_pk_bf16_f32 v102, v116, v117
M v[216:219], a[140:143], v[40:43], v[216:219]
v_exp_f32 v118, v118
M v[216:219], a[144:147], v[72:75], v[216:219]
M v[220:223], a[144:147], v[76:79], v[220:223]
v_exp_f32 v119, v119
M v[220:223], a[140:143], v[44:47], v[220:223]
v_cvt_pk_bf16_f32 v103, v118, v119
s_waitcnt lgkmcnt(6)
M a[108:111], a[112:115], v[44:47], a[108:111]
M a[108:111], a[112:115], v[76:79], a[108:111]
M v[224:227], a[148:151], v[32:35], v[224:227]
v_exp_f32 v104, v104
M v[224:227], a[152:155], v[64:67], v[224:227]
s_cmp_le_u32 s42, 1
s_cselect_b32 s33, 0x4000, 0
v_add_u32 v5, s33, v5
s_sub_u32 s42, s42, 1
M v[228:231], a[152:155], v[68:71], v[228:231]
v_exp_f32 v105, v105
M v[228:231], a[148:151], v[36:39], v[228:231]
v_cvt_pk_bf16_f32 v104, v104, v105
M v[232:235], a[148:151], v[40:43], v[232:235]
v_exp_f32 v106, v106
M v[232:235], a[152:155], v[72:75], v[232:235]
M v[236:239], a[152:155], v[76:79], v[236:239]
v_exp_f32 v107, v107
M v[236:239], a[148:151], v[44:47], v[236:239]
v_cvt_pk_bf16_f32 v105, v106, v107
s_waitcnt lgkmcnt(4)
M v[240:243], a[156:159], v[32:35], v[240:243]
v_exp_f32 v120, v120
M v[240:243], a[160:163], v[64:67], v[240:243]
M v[244:247], a[160:163], v[68:71], v[244:247]
v_exp_f32 v121, v121
M v[244:247], a[156:159], v[36:39], v[244:247]
v_cvt_pk_bf16_f32 v106, v120, v121
M v[248:251], a[156:159], v[40:43], v[248:251]
v_exp_f32 v122, v122
M v[248:251], a[160:163], v[72:75], v[248:251]
s_waitcnt vmcnt(0) lgkmcnt(0)
s_barrier
ds_read_b128 a[116:119], v3 offset:0
ds_read_b128 a[120:123], v3 offset:1024
M v[252:255], a[160:163], v[76:79], v[252:255]
v_exp_f32 v123, v123
M v[252:255], a[156:159], v[44:47], v[252:255]
v_cvt_pk_bf16_f32 v107, v122, v123
M a[64:67], a[164:167], v[32:35], a[64:67]
v_exp_f32 v108, v108
M a[64:67], a[168:171], v[64:67], a[64:67]
ds_read_b128 a[124:127], v3 offset:2048
ds_read_b128 a[128:131], v3 offset:3072
M a[68:71], a[168:171], v[68:71], a[68:71]
v_exp_f32 v109, v109
M a[68:71], a[164:167], v[36:39], a[68:71]
v_cvt_pk_bf16_f32 v108, v108, v109
M a[72:75], a[164:167], v[40:43], a[72:75]
v_exp_f32 v110, v110
M a[72:75], a[168:171], v[72:75], a[72:75]
ds_read_b128 a[132:135], v3 offset:4096
ds_read_b128 a[136:139], v3 offset:5120
M a[76:79], a[168:171], v[76:79], a[76:79]
v_exp_f32 v111, v111
M a[76:79], a[164:167], v[44:47], a[76:79]
v_cvt_pk_bf16_f32 v109, v110, v111
M a[80:83], a[172:175], v[32:35], a[80:83]
v_exp_f32 v124, v124
M a[80:83], a[176:179], v[64:67], a[80:83]
ds_read_b128 a[140:143], v3 offset:6144
ds_read_b128 a[144:147], v3 offset:7168
M a[84:87], a[176:179], v[68:71], a[84:87]
v_exp_f32 v125, v125
M a[84:87], a[172:175], v[36:39], a[84:87]
v_cvt_pk_bf16_f32 v110, v124, v125
M a[88:91], a[172:175], v[40:43], a[88:91]
v_exp_f32 v126, v126
M a[88:91], a[176:179], v[72:75], a[88:91]
M a[92:95], a[176:179], v[76:79], a[92:95]
v_exp_f32 v127, v127
M a[92:95], a[172:175], v[44:47], a[92:95]
v_cvt_pk_bf16_f32 v111, v126, v127
s_add_u32 m0, s29, 0
s_nop 0
buffer_load_dwordx4 v1, s[12:15], s25 offen offset:0 sc1 lds
s_add_u32 s32, s25, 4096
buffer_load_dwordx4 v1, s[12:15], s25 offen offset:1024 sc1 lds
buffer_load_dwordx4 v1, s[12:15], s25 offen offset:2048 sc1 lds
buffer_load_dwordx4 v1, s[12:15], s25 offen offset:3072 sc1 lds
s_add_u32 m0, s29, 4096
s_nop 0
buffer_load_dwordx4 v1, s[12:15], s32 offen offset:0 sc1 lds
buffer_load_dwordx4 v1, s[12:15], s32 offen offset:1024 sc1 lds
buffer_load_dwordx4 v1, s[12:15], s32 offen offset:2048 sc1 lds
buffer_load_dwordx4 v1, s[12:15], s32 offen offset:3072 sc1 lds
s_add_u32 m0, s29, 32768
v_exp_f32 v136, v136
s_waitcnt lgkmcnt(7)
ds_read_b128 a[116:119], v6 offset:32768
s_waitcnt lgkmcnt(7)
ds_read_b128 a[120:123], v6 offset:40960
v_exp_f32 v137, v137
buffer_load_dwordx4 v1, s[12:15], s26 offen offset:0 sc1 lds
s_add_u32 s43, s26, 4096
v_exp_f32 v138, v138
v_cvt_pk_bf16_f32 v136, v136, v137
v_exp_f32 v139, v139
buffer_load_dwordx4 v1, s[12:15], s26 offen offset:1024 sc1 lds
s_waitcnt lgkmcnt(7)
ds_read_b128 a[124:127], v6 offset:33792
s_waitcnt lgkmcnt(7)
ds_read_b128 a[128:131], v6 offset:41984
buffer_load_dwordx4 v1, s[12:15], s26 offen offset:2048 sc1 lds
v_cvt_pk_bf16_f32 v137, v138, v139
v_mov_b32 v138, 0
buffer_load_dwordx4 v1, s[12:15], s26 offen offset:3072 sc1 lds
s_add_u32 m0, s29, 36864
v_exp_f32 v140, v140
s_waitcnt lgkmcnt(7)
ds_read_b128 a[132:135], v6 offset:34816
s_waitcnt lgkmcnt(7)
ds_read_b128 a[136:139], v6 offset:43008
v_exp_f32 v141, v141
buffer_load_dwordx4 v1, s[12:15], s43 offen offset:0 sc1 lds
v_exp_f32 v142, v142
v_mov_b32 v139, 0
v_cvt_pk_bf16_f32 v140, v140, v141
v_exp_f32 v143, v143
buffer_load_dwordx4 v1, s[12:15], s43 offen offset:1024 sc1 lds
v_exp_f32 v156, v156
s_waitcnt lgkmcnt(7)
ds_read_b128 a[140:143], v6 offset:35840
s_waitcnt lgkmcnt(7)
ds_read_b128 a[144:147], v6 offset:44032
v_exp_f32 v157, v157
buffer_load_dwordx4 v1, s[12:15], s43 offen offset:2048 sc1 lds
v_exp_f32 v158, v158
v_cvt_pk_bf16_f32 v141, v142, v143
v_cvt_pk_bf16_f32 v142, v156, v157
v_exp_f32 v159, v159
buffer_load_dwordx4 v1, s[12:15], s43 offen offset:3072 sc1 lds
v_cvt_pk_bf16_f32 v143, v158, v159
s_waitcnt lgkmcnt(6)
M v[160:163], a[116:119], v[96:99], v[160:163]
ds_read_b128 a[148:151], v6 offset:36864
ds_read_b128 a[152:155], v6 offset:45056
M v[164:167], a[116:119], v[100:103], v[164:167]
M v[168:171], a[116:119], v[104:107], v[168:171]
M v[168:171], a[120:123], v[136:139], v[168:171]
s_add_u32 s25, s25, 32768
s_cmp_eq_u32 s25, s27
M v[172:175], a[120:123], v[140:143], v[172:175]
M v[172:175], a[116:119], v[108:111], v[172:175]
s_waitcnt lgkmcnt(6)
M a[96:99], a[112:115], v[96:99], a[96:99]
s_cselect_b32 s25, s28, s25
s_cselect_b32 s27, s56, s27
s_cselect_b32 s28, s57, s28
s_cselect_b32 s56, -1, s56
M v[176:179], a[124:127], v[96:99], v[176:179]
ds_read_b128 a[156:159], v6 offset:37888
ds_read_b128 a[160:163], v6 offset:46080
M v[180:183], a[124:127], v[100:103], v[180:183]
M v[184:187], a[124:127], v[104:107], v[184:187]
M v[184:187], a[128:131], v[136:139], v[184:187]
s_add_u32 s26, s26, 32768
s_cmp_eq_u32 s26, s62
M v[188:191], a[128:131], v[140:143], v[188:191]
M v[188:191], a[124:127], v[108:111], v[188:191]
s_waitcnt lgkmcnt(6)
M a[100:103], a[112:115], v[100:103], a[100:103]
s_cselect_b32 s26, s63, s26
s_cselect_b32 s62, s58, s62
s_cselect_b32 s63, s59, s63
s_cselect_b32 s58, -1, s58
M v[192:195], a[132:135], v[96:99], v[192:195]
ds_read_b128 a[164:167], v6 offset:38912
ds_read_b128 a[168:171], v6 offset:47104
M v[196:199], a[132:135], v[100:103], v[196:199]
M v[200:203], a[132:135], v[104:107], v[200:203]
M v[200:203], a[136:139], v[136:139], v[200:203]
s_sub_u32 s33, s42, 1
s_cmp_le_u32 s33, 1
s_cselect_b32 s33, 0x4000, 0
v_add_u32 v3, s33, v3
M v[204:207], a[136:139], v[140:143], v[204:207]
M v[204:207], a[132:135], v[108:111], v[204:207]
s_waitcnt lgkmcnt(6)
M a[104:107], a[112:115], v[104:107], a[104:107]
M a[104:107], a[112:115], v[136:139], a[104:107]
M v[208:211], a[140:143], v[96:99], v[208:211]
ds_read_b128 a[172:175], v6 offset:39936
ds_read_b128 a[176:179], v6 offset:48128
M v[212:215], a[140:143], v[100:103], v[212:215]
M v[216:219], a[140:143], v[104:107], v[216:219]
M v[216:219], a[144:147], v[136:139], v[216:219]
M v[220:223], a[144:147], v[140:143], v[220:223]
M v[220:223], a[140:143], v[108:111], v[220:223]
s_waitcnt lgkmcnt(6)
M a[108:111], a[112:115], v[108:111], a[108:111]
M a[108:111], a[112:115], v[140:143], a[108:111]
M v[224:227], a[148:151], v[96:99], v[224:227]
s_cmp_le_u32 s42, 1
s_cselect_b32 s33, 0x4000, 0
v_add_u32 v6, s33, v6
s_sub_u32 s42, s42, 1
M v[228:231], a[148:151], v[100:103], v[228:231]
M v[232:235], a[148:151], v[104:107], v[232:235]
M v[232:235], a[152:155], v[136:139], v[232:235]
M v[236:239], a[152:155], v[140:143], v[236:239]
M v[236:239], a[148:151], v[108:111], v[236:239]
s_waitcnt lgkmcnt(4)
M v[240:243], a[156:159], v[96:99], v[240:243]
M v[244:247], a[156:159], v[100:103], v[244:247]
M v[248:251], a[156:159], v[104:107], v[248:251]
M v[248:251], a[160:163], v[136:139], v[248:251]
s_waitcnt vmcnt(0) lgkmcnt(0)
s_barrier
ds_read_b128 a[116:119], v2 offset:0
ds_read_b128 a[120:123], v2 offset:1024
M v[252:255], a[160:163], v[140:143], v[252:255]
M v[252:255], a[156:159], v[108:111], v[252:255]
M a[64:67], a[164:167], v[96:99], a[64:67]
ds_read_b128 a[124:127], v2 offset:2048
ds_read_b128 a[128:131], v2 offset:3072
M a[68:71], a[164:167], v[100:103], a[68:71]
M a[72:75], a[164:167], v[104:107], a[72:75]
M a[72:75], a[168:171], v[136:139], a[72:75]
ds_read_b128 a[132:135], v2 offset:4096
ds_read_b128 a[136:139], v2 offset:5120
M a[76:79], a[168:171], v[140:143], a[76:79]
M a[76:79], a[164:167], v[108:111], a[76:79]
M a[80:83], a[172:175], v[96:99], a[80:83]
ds_read_b128 a[140:143], v2 offset:6144
ds_read_b128 a[144:147], v2 offset:7168
M a[84:87], a[172:175], v[100:103], a[84:87]
M a[88:91], a[172:175], v[104:107], a[88:91]
M a[88:91], a[176:179], v[136:139], a[88:91]
M a[92:95], a[176:179], v[140:143], a[92:95]
M a[92:95], a[172:175], v[108:111], a[92:95]
s_and_b32 s3, s2, 3
s_lshl_b32 s3, s3, 2
s_bfe_u32 s27, s2, 0x20003
s_add_u32 s27, s3, s27
s_lshl_b32 s43, s27, 8
s_add_u32 s43, s43, 16789504
v_lshlrev_b32 v15, 2, v0
buffer_load_dword v7, v15, s[52:55], s43 offen sc1
s_lshl_b32 s33, s23, 14
s_add_u32 s34, s33, 131072
s_add_u32 s33, s33, 98304
v_add_u32 v2, s34, v1
v_add_u32 v3, s33, v1
s_mov_b32 s61, 0
s_bfe_u32 s3, s2, 0x10002
s_lshl_b32 s3, s3, 3
s_lshr_b32 s28, s2, 5
s_add_u32 s28, s3, s28
s_lshl_b32 s25, s27, 18
s_lshl_b32 s3, s101, 12
s_add_u32 s25, s25, s3
s_lshl_b32 s26, s28, 7
s_lshl_b32 s42, s101, 11
s_add_u32 s44, s4, 83886080
s_addc_u32 s45, s5, 0
s_mov_b32 s46, 4194304
s_mov_b32 s47, 0x00020000
s_mov_b32 s50, 2097152
s_mov_b32 s51, 0x00020000
s_lshl_b32 s3, s101, 4
v_lshrrev_b32 v96, 3, v0
v_and_b32 v97, 6, v96
ds_write_b128 v2, v[160:163] offset:0
v_and_b32 v98, 7, v0
ds_write_b128 v2, v[164:167] offset:1024
v_xor_b32 v97, v97, v98
ds_write_b128 v2, v[168:171] offset:2048
v_add_u32 v96, s3, v96
ds_write_b128 v2, v[172:175] offset:3072
v_lshlrev_b32 v96, 11, v96
ds_write_b128 v2, v[176:179] offset:4096
v_lshl_add_u32 v99, v97, 4, v96
v_add_u32 v100, 15360, v99
ds_write_b128 v2, v[180:183] offset:5120
s_waitcnt vmcnt(0) lgkmcnt(0)
s_barrier
ds_write_b128 v2, v[184:187] offset:6144
v_cmp_ne_u32 vcc, 1, v7
s_nop 0
s_cbranch_vccnz Lk3_spinb3
Lk3_gotb3:
s_add_u32 m0, s42, 16384
s_nop 0
buffer_load_dwordx4 v99, s[48:51], s26 offen offset:0 lds
ds_write_b128 v2, v[188:191] offset:7168
buffer_load_dwordx4 v100, s[48:51], s26 offen offset:1024 lds
ds_write_b128 v2, v[192:195] offset:8192
buffer_load_dwordx4 a[192:195], v1, s[44:47], s25 offen offset:0 sc1
buffer_load_dwordx4 a[196:199], v1, s[44:47], s25 offen offset:1024 sc1
ds_write_b128 v2, v[196:199] offset:9216
buffer_load_dwordx4 a[200:203], v1, s[44:47], s25 offen offset:2048 sc1
buffer_load_dwordx4 a[204:207], v1, s[44:47], s25 offen offset:3072 sc1
ds_write_b128 v2, v[200:203] offset:10240
s_add_u32 s25, s25, 16384
s_add_u32 s26, s26, 131072
ds_write_b128 v2, v[204:207] offset:11264
s_add_u32 m0, s42, 32768
s_nop 0
buffer_load_dwordx4 v99, s[48:51], s26 offen offset:0 lds
buffer_load_dwordx4 v100, s[48:51], s26 offen offset:1024 lds
ds_write_b128 v2, v[208:211] offset:12288
buffer_load_dwordx4 a[224:227], v1, s[44:47], s25 offen offset:0 sc1
ds_write_b128 v2, v[212:215] offset:13312
buffer_load_dwordx4 a[228:231], v1, s[44:47], s25 offen offset:1024 sc1
buffer_load_dwordx4 a[232:235], v1, s[44:47], s25 offen offset:2048 sc1
ds_write_b128 v2, v[216:219] offset:14336
buffer_load_dwordx4 a[236:239], v1, s[44:47], s25 offen offset:3072 sc1
s_add_u32 s25, s25, 16384
s_add_u32 s26, s26, 131072
ds_write_b128 v2, v[220:223] offset:15360
s_waitcnt lgkmcnt(0)
s_branch Lk2_mg1
Lk2_g1b:
s_add_u32 m0, s29, 65536
s_waitcnt lgkmcnt(4)
M v[96:99], a[116:119], a[0:3], 0
v_exp_f32 v64, v64
M v[96:99], a[120:123], a[4:7], v[96:99]
ds_read_b128 a[148:151], v2 offset:8192
ds_read_b128 a[152:155], v2 offset:9216
M v[96:99], a[124:127], a[8:11], v[96:99]
v_exp_f32 v65, v65
M v[96:99], a[128:131], a[12:15], v[96:99]
buffer_load_dwordx4 v1, s[12:15], s25 offen offset:0 sc1 lds
s_add_u32 s32, s25, 4096
M v[100:103], a[128:131], a[28:31], 0
v_exp_f32 v66, v66
M v[100:103], a[124:127], a[24:27], v[100:103]
v_cvt_pk_bf16_f32 v64, v64, v65
M v[100:103], a[120:123], a[20:23], v[100:103]
v_exp_f32 v67, v67
M v[100:103], a[116:119], a[16:19], v[100:103]
buffer_load_dwordx4 v1, s[12:15], s25 offen offset:1024 sc1 lds
M v[104:107], a[116:119], a[32:35], 0
v_exp_f32 v80, v80
M v[104:107], a[120:123], a[36:39], v[104:107]
ds_read_b128 a[156:159], v2 offset:10240
ds_read_b128 a[160:163], v2 offset:11264
M v[104:107], a[124:127], a[40:43], v[104:107]
v_exp_f32 v81, v81
M v[104:107], a[128:131], a[44:47], v[104:107]
buffer_load_dwordx4 v1, s[12:15], s25 offen offset:2048 sc1 lds
M v[108:111], a[128:131], a[60:63], 0
v_exp_f32 v82, v82
M v[108:111], a[124:127], a[56:59], v[108:111]
v_cvt_pk_bf16_f32 v65, v66, v67
v_cvt_pk_bf16_f32 v66, v80, v81
M v[108:111], a[120:123], a[52:55], v[108:111]
v_exp_f32 v83, v83
M v[108:111], a[116:119], a[48:51], v[108:111]
buffer_load_dwordx4 v1, s[12:15], s25 offen offset:3072 sc1 lds
s_add_u32 m0, s29, 69632
s_waitcnt lgkmcnt(4)
M v[112:115], a[132:135], a[0:3], 0
v_exp_f32 v68, v68
M v[112:115], a[136:139], a[4:7], v[112:115]
ds_read_b128 a[164:167], v2 offset:12288
ds_read_b128 a[168:171], v2 offset:13312
M v[112:115], a[140:143], a[8:11], v[112:115]
v_exp_f32 v69, v69
M v[112:115], a[144:147], a[12:15], v[112:115]
buffer_load_dwordx4 v1, s[12:15], s32 offen offset:0 sc1 lds
M v[116:119], a[144:147], a[28:31], 0
v_exp_f32 v70, v70
M v[116:119], a[140:143], a[24:27], v[116:119]
v_cvt_pk_bf16_f32 v67, v82, v83
v_cvt_pk_bf16_f32 v68, v68, v69
M v[116:119], a[136:139], a[20:23], v[116:119]
v_exp_f32 v71, v71
M v[116:119], a[132:135], a[16:19], v[116:119]
buffer_load_dwordx4 v1, s[12:15], s32 offen offset:1024 sc1 lds
M v[120:123], a[132:135], a[32:35], 0
v_exp_f32 v84, v84
M v[120:123], a[136:139], a[36:39], v[120:123]
ds_read_b128 a[172:175], v2 offset:14336
ds_read_b128 a[176:179], v2 offset:15360
M v[120:123], a[140:143], a[40:43], v[120:123]
v_exp_f32 v85, v85
M v[120:123], a[144:147], a[44:47], v[120:123]
buffer_load_dwordx4 v1, s[12:15], s32 offen offset:2048 sc1 lds
M v[124:127], a[144:147], a[60:63], 0
v_exp_f32 v86, v86
M v[124:127], a[140:143], a[56:59], v[124:127]
v_cvt_pk_bf16_f32 v69, v70, v71
v_cvt_pk_bf16_f32 v70, v84, v85
M v[124:127], a[136:139], a[52:55], v[124:127]
v_exp_f32 v87, v87
M v[124:127], a[132:135], a[48:51], v[124:127]
buffer_load_dwordx4 v1, s[12:15], s32 offen offset:3072 sc1 lds
s_add_u32 m0, s29, 98304
s_waitcnt lgkmcnt(4)
M v[128:131], a[148:151], a[0:3], 0
v_exp_f32 v72, v72
M v[128:131], a[152:155], a[4:7], v[128:131]
ds_read_b128 a[116:119], v5 offset:32768
ds_read_b128 a[120:123], v5 offset:40960
M v[128:131], a[156:159], a[8:11], v[128:131]
v_exp_f32 v73, v73
M v[128:131], a[160:163], a[12:15], v[128:131]
buffer_load_dwordx4 v1, s[12:15], s26 offen offset:0 sc1 lds
s_add_u32 s43, s26, 4096
M v[132:135], a[160:163], a[28:31], 0
v_exp_f32 v74, v74
M v[132:135], a[156:159], a[24:27], v[132:135]
v_cvt_pk_bf16_f32 v71, v86, v87
v_cvt_pk_bf16_f32 v72, v72, v73
M v[132:135], a[152:155], a[20:23], v[132:135]
v_exp_f32 v75, v75
M v[132:135], a[148:151], a[16:19], v[132:135]
buffer_load_dwordx4 v1, s[12:15], s26 offen offset:1024 sc1 lds
M v[136:139], a[148:151], a[32:35], 0
v_exp_f32 v88, v88
M v[136:139], a[152:155], a[36:39], v[136:139]
ds_read_b128 a[124:127], v5 offset:33792
ds_read_b128 a[128:131], v5 offset:41984
M v[136:139], a[156:159], a[40:43], v[136:139]
v_exp_f32 v89, v89
M v[136:139], a[160:163], a[44:47], v[136:139]
buffer_load_dwordx4 v1, s[12:15], s26 offen offset:2048 sc1 lds
M v[140:143], a[160:163], a[60:63], 0
v_exp_f32 v90, v90
M v[140:143], a[156:159], a[56:59], v[140:143]
v_cvt_pk_bf16_f32 v73, v74, v75
v_cvt_pk_bf16_f32 v74, v88, v89
M v[140:143], a[152:155], a[52:55], v[140:143]
v_exp_f32 v91, v91
M v[140:143], a[148:151], a[48:51], v[140:143]
buffer_load_dwordx4 v1, s[12:15], s26 offen offset:3072 sc1 lds
s_add_u32 m0, s29, 102400
s_waitcnt lgkmcnt(4)
M v[144:147], a[164:167], a[0:3], 0
v_exp_f32 v76, v76
M v[144:147], a[168:171], a[4:7], v[144:147]
ds_read_b128 a[132:135], v5 offset:34816
ds_read_b128 a[136:139], v5 offset:43008
M v[144:147], a[172:175], a[8:11], v[144:147]
v_exp_f32 v77, v77
M v[144:147], a[176:179], a[12:15], v[144:147]
buffer_load_dwordx4 v1, s[12:15], s43 offen offset:0 sc1 lds
M v[148:151], a[176:179], a[28:31], 0
v_exp_f32 v78, v78
M v[148:151], a[172:175], a[24:27], v[148:151]
v_cvt_pk_bf16_f32 v75, v90, v91
v_cvt_pk_bf16_f32 v76, v76, v77
M v[148:151], a[168:171], a[20:23], v[148:151]
v_exp_f32 v79, v79
M v[148:151], a[164:167], a[16:19], v[148:151]
buffer_load_dwordx4 v1, s[12:15], s43 offen offset:1024 sc1 lds
M v[152:155], a[164:167], a[32:35], 0
v_exp_f32 v92, v92
M v[152:155], a[168:171], a[36:39], v[152:155]
ds_read_b128 a[140:143], v5 offset:35840
ds_read_b128 a[144:147], v5 offset:44032
M v[152:155], a[172:175], a[40:43], v[152:155]
v_exp_f32 v93, v93
M v[152:155], a[176:179], a[44:47], v[152:155]
buffer_load_dwordx4 v1, s[12:15], s43 offen offset:2048 sc1 lds
M v[156:159], a[176:179], a[60:63], 0
v_exp_f32 v94, v94
M v[156:159], a[172:175], a[56:59], v[156:159]
v_cvt_pk_bf16_f32 v77, v78, v79
v_cvt_pk_bf16_f32 v78, v92, v93
M v[156:159], a[168:171], a[52:55], v[156:159]
v_exp_f32 v95, v95
M v[156:159], a[164:167], a[48:51], v[156:159]
buffer_load_dwordx4 v1, s[12:15], s43 offen offset:3072 sc1 lds
v_cvt_pk_bf16_f32 v79, v94, v95
s_waitcnt lgkmcnt(6)
M v[160:163], a[116:119], v[32:35], v[160:163]
v_exp_f32 v96, v96
M v[160:163], a[120:123], v[64:67], v[160:163]
ds_read_b128 a[148:151], v5 offset:36864
ds_read_b128 a[152:155], v5 offset:45056
M v[164:167], a[120:123], v[68:71], v[164:167]
v_exp_f32 v97, v97
M v[164:167], a[116:119], v[36:39], v[164:167]
v_cvt_pk_bf16_f32 v96, v96, v97
M v[168:171], a[116:119], v[40:43], v[168:171]
v_exp_f32 v98, v98
M v[168:171], a[120:123], v[72:75], v[168:171]
s_add_u32 s25, s25, 32768
s_cmp_eq_u32 s25, s27
M v[172:175], a[120:123], v[76:79], v[172:175]
v_exp_f32 v99, v99
M v[172:175], a[116:119], v[44:47], v[172:175]
v_cvt_pk_bf16_f32 v97, v98, v99
s_waitcnt lgkmcnt(6)
M a[96:99], a[112:115], v[32:35], a[96:99]
s_cselect_b32 s25, s28, s25
s_cselect_b32 s27, s56, s27
M a[96:99], a[112:115], v[64:67], a[96:99]
s_cselect_b32 s28, s57, s28
s_cselect_b32 s56, -1, s56
M v[176:179], a[124:127], v[32:35], v[176:179]
v_exp_f32 v112, v112
M v[176:179], a[128:131], v[64:67], v[176:179]
ds_read_b128 a[156:159], v5 offset:37888
ds_read_b128 a[160:163], v5 offset:46080
M v[180:183], a[128:131], v[68:71], v[180:183]
v_exp_f32 v113, v113
M v[180:183], a[124:127], v[36:39], v[180:183]
v_cvt_pk_bf16_f32 v98, v112, v113
M v[184:187], a[124:127], v[40:43], v[184:187]
v_exp_f32 v114, v114
M v[184:187], a[128:131], v[72:75], v[184:187]
s_add_u32 s26, s26, 32768
s_cmp_eq_u32 s26, s62
M v[188:191], a[128:131], v[76:79], v[188:191]
v_exp_f32 v115, v115
M v[188:191], a[124:127], v[44:47], v[188:191]
v_cvt_pk_bf16_f32 v99, v114, v115
s_waitcnt lgkmcnt(6)
M a[100:103], a[112:115], v[36:39], a[100:103]
s_cselect_b32 s26, s63, s26
s_cselect_b32 s62, s58, s62
M a[100:103], a[112:115], v[68:71], a[100:103]
s_cselect_b32 s63, s59, s63
s_cselect_b32 s58, -1, s58
M v[192:195], a[132:135], v[32:35], v[192:195]
v_exp_f32 v100, v100
M v[192:195], a[136:139], v[64:67], v[192:195]
ds_read_b128 a[164:167], v5 offset:38912
ds_read_b128 a[168:171], v5 offset:47104
M v[196:199], a[136:139], v[68:71], v[196:199]
v_exp_f32 v101, v101
M v[196:199], a[132:135], v[36:39], v[196:199]
v_cvt_pk_bf16_f32 v100, v100, v101
M v[200:203], a[132:135], v[40:43], v[200:203]
v_exp_f32 v102, v102
M v[200:203], a[136:139], v[72:75], v[200:203]
s_sub_u32 s33, s42, 1
s_cmp_le_u32 s33, 1
s_cselect_b32 s33, 0x4000, 0
v_add_u32 v2, s33, v2
M v[204:207], a[136:139], v[76:79], v[204:207]
v_exp_f32 v103, v103
M v[204:207], a[132:135], v[44:47], v[204:207]
v_cvt_pk_bf16_f32 v101, v102, v103
s_waitcnt lgkmcnt(6)
M a[104:107], a[112:115], v[40:43], a[104:107]
M a[104:107], a[112:115], v[72:75], a[104:107]
M v[208:211], a[140:143], v[32:35], v[208:211]
v_exp_f32 v116, v116
M v[208:211], a[144:147], v[64:67], v[208:211]
ds_read_b128 a[172:175], v5 offset:39936
ds_read_b128 a[176:179], v5 offset:48128
M v[212:215], a[144:147], v[68:71], v[212:215]
v_exp_f32 v117, v117
M v[212:215], a[140:143], v[36:39], v[212:215]
v_cvt_pk_bf16_f32 v102, v116, v117
M v[216:219], a[140:143], v[40:43], v[216:219]
v_exp_f32 v118, v118
M v[216:219], a[144:147], v[72:75], v[216:219]
M v[220:223], a[144:147], v[76:79], v[220:223]
v_exp_f32 v119, v119
M v[220:223], a[140:143], v[44:47], v[220:223]
v_cvt_pk_bf16_f32 v103, v118, v119
s_waitcnt lgkmcnt(6)
M a[108:111], a[112:115], v[44:47], a[108:111]
M a[108:111], a[112:115], v[76:79], a[108:111]
M v[224:227], a[148:151], v[32:35], v[224:227]
v_exp_f32 v104, v104
M v[224:227], a[152:155], v[64:67], v[224:227]
s_cmp_le_u32 s42, 1
s_cselect_b32 s33, 0x4000, 0
v_add_u32 v5, s33, v5
s_sub_u32 s42, s42, 1
M v[228:231], a[152:155], v[68:71], v[228:231]
v_exp_f32 v105, v105
M v[228:231], a[148:151], v[36:39], v[228:231]
v_cvt_pk_bf16_f32 v104, v104, v105
M v[232:235], a[148:151], v[40:43], v[232:235]
v_exp_f32 v106, v106
M v[232:235], a[152:155], v[72:75], v[232:235]
M v[236:239], a[152:155], v[76:79], v[236:239]
v_exp_f32 v107, v107
M v[236:239], a[148:151], v[44:47], v[236:239]
v_cvt_pk_bf16_f32 v105, v106, v107
s_waitcnt lgkmcnt(4)
M v[240:243], a[156:159], v[32:35], v[240:243]
v_exp_f32 v120, v120
M v[240:243], a[160:163], v[64:67], v[240:243]
M v[244:247], a[160:163], v[68:71], v[244:247]
v_exp_f32 v121, v121
M v[244:247], a[156:159], v[36:39], v[244:247]
v_cvt_pk_bf16_f32 v106, v120, v121
M v[248:251], a[156:159], v[40:43], v[248:251]
v_exp_f32 v122, v122
M v[248:251], a[160:163], v[72:75], v[248:251]
s_waitcnt vmcnt(0) lgkmcnt(0)
s_barrier
ds_read_b128 a[116:119], v3 offset:0
ds_read_b128 a[120:123], v3 offset:1024
M v[252:255], a[160:163], v[76:79], v[252:255]
v_exp_f32 v123, v123
M v[252:255], a[156:159], v[44:47], v[252:255]
v_cvt_pk_bf16_f32 v107, v122, v123
M a[64:67], a[164:167], v[32:35], a[64:67]
v_exp_f32 v108, v108
M a[64:67], a[168:171], v[64:67], a[64:67]
ds_read_b128 a[124:127], v3 offset:2048
ds_read_b128 a[128:131], v3 offset:3072
M a[68:71], a[168:171], v[68:71], a[68:71]
v_exp_f32 v109, v109
M a[68:71], a[164:167], v[36:39], a[68:71]
v_cvt_pk_bf16_f32 v108, v108, v109
M a[72:75], a[164:167], v[40:43], a[72:75]
v_exp_f32 v110, v110
M a[72:75], a[168:171], v[72:75], a[72:75]
ds_read_b128 a[132:135], v3 offset:4096
ds_read_b128 a[136:139], v3 offset:5120
M a[76:79], a[168:171], v[76:79], a[76:79]
v_exp_f32 v111, v111
M a[76:79], a[164:167], v[44:47], a[76:79]
v_cvt_pk_bf16_f32 v109, v110, v111
M a[80:83], a[172:175], v[32:35], a[80:83]
v_exp_f32 v124, v124
M a[80:83], a[176:179], v[64:67], a[80:83]
ds_read_b128 a[140:143], v3 offset:6144
ds_read_b128 a[144:147], v3 offset:7168
M a[84:87], a[176:179], v[68:71], a[84:87]
v_exp_f32 v125, v125
M a[84:87], a[172:175], v[36:39], a[84:87]
v_cvt_pk_bf16_f32 v110, v124, v125
M a[88:91], a[172:175], v[40:43], a[88:91]
v_exp_f32 v126, v126
M a[88:91], a[176:179], v[72:75], a[88:91]
M a[92:95], a[176:179], v[76:79], a[92:95]
v_exp_f32 v127, v127
M a[92:95], a[172:175], v[44:47], a[92:95]
v_cvt_pk_bf16_f32 v111, v126, v127
s_add_u32 m0, s29, 0
s_waitcnt lgkmcnt(4)
M v[32:35], a[116:119], a[0:3], v[16:19]
v_exp_f32 v128, v128
M v[32:35], a[120:123], a[4:7], v[32:35]
ds_read_b128 a[148:151], v3 offset:8192
ds_read_b128 a[152:155], v3 offset:9216
M v[32:35], a[124:127], a[8:11], v[32:35]
v_exp_f32 v129, v129
M v[32:35], a[128:131], a[12:15], v[32:35]
buffer_load_dwordx4 v1, s[12:15], s25 offen offset:0 sc1 lds
s_add_u32 s32, s25, 4096
M v[36:39], a[128:131], a[28:31], 0
v_exp_f32 v130, v130
M v[36:39], a[124:127], a[24:27], v[36:39]
v_cvt_pk_bf16_f32 v128, v128, v129
M v[36:39], a[120:123], a[20:23], v[36:39]
v_exp_f32 v131, v131
M v[36:39], a[116:119], a[16:19], v[36:39]
buffer_load_dwordx4 v1, s[12:15], s25 offen offset:1024 sc1 lds
M v[40:43], a[116:119], a[32:35], 0
v_exp_f32 v144, v144
M v[40:43], a[120:123], a[36:39], v[40:43]
ds_read_b128 a[156:159], v3 offset:10240
ds_read_b128 a[160:163], v3 offset:11264
M v[40:43], a[124:127], a[40:43], v[40:43]
v_exp_f32 v145, v145
M v[40:43], a[128:131], a[44:47], v[40:43]
buffer_load_dwordx4 v1, s[12:15], s25 offen offset:2048 sc1 lds
M v[44:47], a[128:131], a[60:63], 0
v_exp_f32 v146, v146
M v[44:47], a[124:127], a[56:59], v[44:47]
v_cvt_pk_bf16_f32 v129, v130, v131
v_cvt_pk_bf16_f32 v130, v144, v145
M v[44:47], a[120:123], a[52:55], v[44:47]
v_exp_f32 v147, v147
M v[44:47], a[116:119], a[48:51], v[44:47]
buffer_load_dwordx4 v1, s[12:15], s25 offen offset:3072 sc1 lds
s_add_u32 m0, s29, 4096
s_waitcnt lgkmcnt(4)
v_exp_f32 v132, v132
ds_read_b128 a[164:167], v3 offset:12288
ds_read_b128 a[168:171], v3 offset:13312
v_exp_f32 v133, v133
buffer_load_dwordx4 v1, s[12:15], s32 offen offset:0 sc1 lds
M v[52:55], a[144:147], a[28:31], v[16:19]
v_exp_f32 v134, v134
M v[52:55], a[140:143], a[24:27], v[52:55]
v_cvt_pk_bf16_f32 v131, v146, v147
v_cvt_pk_bf16_f32 v132, v132, v133
M v[52:55], a[136:139], a[20:23], v[52:55]
v_exp_f32 v135, v135
M v[52:55], a[132:135], a[16:19], v[52:55]
buffer_load_dwordx4 v1, s[12:15], s32 offen offset:1024 sc1 lds
M v[56:59], a[132:135], a[32:35], 0
v_exp_f32 v148, v148
M v[56:59], a[136:139], a[36:39], v[56:59]
ds_read_b128 a[172:175], v3 offset:14336
ds_read_b128 a[176:179], v3 offset:15360
M v[56:59], a[140:143], a[40:43], v[56:59]
v_exp_f32 v149, v149
M v[56:59], a[144:147], a[44:47], v[56:59]
buffer_load_dwordx4 v1, s[12:15], s32 offen offset:2048 sc1 lds
M v[60:63], a[144:147], a[60:63], 0
v_exp_f32 v150, v150
M v[60:63], a[140:143], a[56:59], v[60:63]
v_cvt_pk_bf16_f32 v133, v134, v135
v_cvt_pk_bf16_f32 v134, v148, v149
M v[60:63], a[136:139], a[52:55], v[60:63]
v_exp_f32 v151, v151
M v[60:63], a[132:135], a[48:51], v[60:63]
buffer_load_dwordx4 v1, s[12:15], s32 offen offset:3072 sc1 lds
s_add_u32 m0, s29, 32768
s_waitcnt lgkmcnt(4)
v_exp_f32 v136, v136
ds_read_b128 a[116:119], v6 offset:32768
ds_read_b128 a[120:123], v6 offset:40960
v_exp_f32 v137, v137
buffer_load_dwordx4 v1, s[12:15], s26 offen offset:0 sc1 lds
s_add_u32 s43, s26, 4096
v_exp_f32 v138, v138
v_cvt_pk_bf16_f32 v135, v150, v151
v_cvt_pk_bf16_f32 v136, v136, v137
v_exp_f32 v139, v139
buffer_load_dwordx4 v1, s[12:15], s26 offen offset:1024 sc1 lds
M v[72:75], a[148:151], a[32:35], v[16:19]
v_exp_f32 v152, v152
M v[72:75], a[152:155], a[36:39], v[72:75]
ds_read_b128 a[124:127], v6 offset:33792
ds_read_b128 a[128:131], v6 offset:41984
M v[72:75], a[156:159], a[40:43], v[72:75]
v_exp_f32 v153, v153
M v[72:75], a[160:163], a[44:47], v[72:75]
buffer_load_dwordx4 v1, s[12:15], s26 offen offset:2048 sc1 lds
M v[76:79], a[160:163], a[60:63], 0
v_exp_f32 v154, v154
M v[76:79], a[156:159], a[56:59], v[76:79]
v_cvt_pk_bf16_f32 v137, v138, v139
v_cvt_pk_bf16_f32 v138, v152, v153
M v[76:79], a[152:155], a[52:55], v[76:79]
v_exp_f32 v155, v155
M v[76:79], a[148:151], a[48:51], v[76:79]
buffer_load_dwordx4 v1, s[12:15], s26 offen offset:3072 sc1 lds
s_add_u32 m0, s29, 36864
s_waitcnt lgkmcnt(4)
v_exp_f32 v140, v140
ds_read_b128 a[132:135], v6 offset:34816
ds_read_b128 a[136:139], v6 offset:43008
v_exp_f32 v141, v141
buffer_load_dwordx4 v1, s[12:15], s43 offen offset:0 sc1 lds
v_exp_f32 v142, v142
v_cvt_pk_bf16_f32 v139, v154, v155
v_cvt_pk_bf16_f32 v140, v140, v141
v_exp_f32 v143, v143
buffer_load_dwordx4 v1, s[12:15], s43 offen offset:1024 sc1 lds
v_exp_f32 v156, v156
ds_read_b128 a[140:143], v6 offset:35840
ds_read_b128 a[144:147], v6 offset:44032
v_exp_f32 v157, v157
buffer_load_dwordx4 v1, s[12:15], s43 offen offset:2048 sc1 lds
M v[92:95], a[176:179], a[60:63], v[16:19]
v_exp_f32 v158, v158
M v[92:95], a[172:175], a[56:59], v[92:95]
v_cvt_pk_bf16_f32 v141, v142, v143
v_cvt_pk_bf16_f32 v142, v156, v157
M v[92:95], a[168:171], a[52:55], v[92:95]
v_exp_f32 v159, v159
M v[92:95], a[164:167], a[48:51], v[92:95]
buffer_load_dwordx4 v1, s[12:15], s43 offen offset:3072 sc1 lds
v_cvt_pk_bf16_f32 v143, v158, v159
s_waitcnt lgkmcnt(6)
M v[160:163], a[116:119], v[96:99], v[160:163]
v_exp_f32 v32, v32
M v[160:163], a[120:123], v[128:131], v[160:163]
ds_read_b128 a[148:151], v6 offset:36864
ds_read_b128 a[152:155], v6 offset:45056
M v[164:167], a[120:123], v[132:135], v[164:167]
v_exp_f32 v33, v33
M v[164:167], a[116:119], v[100:103], v[164:167]
v_cvt_pk_bf16_f32 v32, v32, v33
M v[168:171], a[116:119], v[104:107], v[168:171]
v_exp_f32 v34, v34
M v[168:171], a[120:123], v[136:139], v[168:171]
s_add_u32 s25, s25, 32768
s_cmp_eq_u32 s25, s27
M v[172:175], a[120:123], v[140:143], v[172:175]
v_exp_f32 v35, v35
M v[172:175], a[116:119], v[108:111], v[172:175]
v_cvt_pk_bf16_f32 v33, v34, v35
s_waitcnt lgkmcnt(6)
M a[96:99], a[112:115], v[96:99], a[96:99]
s_cselect_b32 s25, s28, s25
s_cselect_b32 s27, s56, s27
M a[96:99], a[112:115], v[128:131], a[96:99]
s_cselect_b32 s28, s57, s28
s_cselect_b32 s56, -1, s56
M v[176:179], a[124:127], v[96:99], v[176:179]
M v[176:179], a[128:131], v[128:131], v[176:179]
ds_read_b128 a[156:159], v6 offset:37888
ds_read_b128 a[160:163], v6 offset:46080
M v[180:183], a[128:131], v[132:135], v[180:183]
M v[180:183], a[124:127], v[100:103], v[180:183]
v_mov_b32 v34, 0
M v[184:187], a[124:127], v[104:107], v[184:187]
M v[184:187], a[128:131], v[136:139], v[184:187]
s_add_u32 s26, s26, 32768
s_cmp_eq_u32 s26, s62
M v[188:191], a[128:131], v[140:143], v[188:191]
M v[188:191], a[124:127], v[108:111], v[188:191]
v_mov_b32 v35, 0
s_waitcnt lgkmcnt(6)
M a[100:103], a[112:115], v[100:103], a[100:103]
s_cselect_b32 s26, s63, s26
s_cselect_b32 s62, s58, s62
M a[100:103], a[112:115], v[132:135], a[100:103]
s_cselect_b32 s63, s59, s63
s_cselect_b32 s58, -1, s58
M v[192:195], a[132:135], v[96:99], v[192:195]
v_exp_f32 v36, v36
M v[192:195], a[136:139], v[128:131], v[192:195]
ds_read_b128 a[164:167], v6 offset:38912
ds_read_b128 a[168:171], v6 offset:47104
M v[196:199], a[136:139], v[132:135], v[196:199]
v_exp_f32 v37, v37
M v[196:199], a[132:135], v[100:103], v[196:199]
v_cvt_pk_bf16_f32 v36, v36, v37
M v[200:203], a[132:135], v[104:107], v[200:203]
v_exp_f32 v38, v38
M v[200:203], a[136:139], v[136:139], v[200:203]
s_sub_u32 s33, s42, 1
s_cmp_le_u32 s33, 1
s_cselect_b32 s33, 0x4000, 0
v_add_u32 v3, s33, v3
M v[204:207], a[136:139], v[140:143], v[204:207]
v_exp_f32 v39, v39
M v[204:207], a[132:135], v[108:111], v[204:207]
v_cvt_pk_bf16_f32 v37, v38, v39
s_waitcnt lgkmcnt(6)
M a[104:107], a[112:115], v[104:107], a[104:107]
M a[104:107], a[112:115], v[136:139], a[104:107]
M v[208:211], a[140:143], v[96:99], v[208:211]
v_exp_f32 v52, v52
M v[208:211], a[144:147], v[128:131], v[208:211]
ds_read_b128 a[172:175], v6 offset:39936
ds_read_b128 a[176:179], v6 offset:48128
M v[212:215], a[144:147], v[132:135], v[212:215]
v_exp_f32 v53, v53
M v[212:215], a[140:143], v[100:103], v[212:215]
v_cvt_pk_bf16_f32 v38, v52, v53
M v[216:219], a[140:143], v[104:107], v[216:219]
v_exp_f32 v54, v54
M v[216:219], a[144:147], v[136:139], v[216:219]
M v[220:223], a[144:147], v[140:143], v[220:223]
v_exp_f32 v55, v55
M v[220:223], a[140:143], v[108:111], v[220:223]
v_cvt_pk_bf16_f32 v39, v54, v55
s_waitcnt lgkmcnt(6)
M a[108:111], a[112:115], v[108:111], a[108:111]
M a[108:111], a[112:115], v[140:143], a[108:111]
M v[224:227], a[148:151], v[96:99], v[224:227]
v_exp_f32 v40, v40
M v[224:227], a[152:155], v[128:131], v[224:227]
s_cmp_le_u32 s42, 1
s_cselect_b32 s33, 0x4000, 0
v_add_u32 v6, s33, v6
s_sub_u32 s42, s42, 1
M v[228:231], a[152:155], v[132:135], v[228:231]
v_exp_f32 v41, v41
M v[228:231], a[148:151], v[100:103], v[228:231]
v_cvt_pk_bf16_f32 v40, v40, v41
M v[232:235], a[148:151], v[104:107], v[232:235]
v_exp_f32 v42, v42
M v[232:235], a[152:155], v[136:139], v[232:235]
M v[236:239], a[152:155], v[140:143], v[236:239]
v_exp_f32 v43, v43
M v[236:239], a[148:151], v[108:111], v[236:239]
v_cvt_pk_bf16_f32 v41, v42, v43
s_waitcnt lgkmcnt(4)
M v[240:243], a[156:159], v[96:99], v[240:243]
v_exp_f32 v56, v56
M v[240:243], a[160:163], v[128:131], v[240:243]
M v[244:247], a[160:163], v[132:135], v[244:247]
v_exp_f32 v57, v57
M v[244:247], a[156:159], v[100:103], v[244:247]
v_cvt_pk_bf16_f32 v42, v56, v57
M v[248:251], a[156:159], v[104:107], v[248:251]
v_exp_f32 v58, v58
M v[248:251], a[160:163], v[136:139], v[248:251]
s_waitcnt vmcnt(0) lgkmcnt(0)
s_barrier
ds_read_b128 a[116:119], v2 offset:0
ds_read_b128 a[120:123], v2 offset:1024
M v[252:255], a[160:163], v[140:143], v[252:255]
v_exp_f32 v59, v59
M v[252:255], a[156:159], v[108:111], v[252:255]
v_cvt_pk_bf16_f32 v43, v58, v59
M a[64:67], a[164:167], v[96:99], a[64:67]
v_exp_f32 v44, v44
M a[64:67], a[168:171], v[128:131], a[64:67]
ds_read_b128 a[124:127], v2 offset:2048
ds_read_b128 a[128:131], v2 offset:3072
M a[68:71], a[168:171], v[132:135], a[68:71]
v_exp_f32 v45, v45
M a[68:71], a[164:167], v[100:103], a[68:71]
v_cvt_pk_bf16_f32 v44, v44, v45
M a[72:75], a[164:167], v[104:107], a[72:75]
v_exp_f32 v46, v46
M a[72:75], a[168:171], v[136:139], a[72:75]
ds_read_b128 a[132:135], v2 offset:4096
ds_read_b128 a[136:139], v2 offset:5120
M a[76:79], a[168:171], v[140:143], a[76:79]
v_exp_f32 v47, v47
M a[76:79], a[164:167], v[108:111], a[76:79]
v_cvt_pk_bf16_f32 v45, v46, v47
M a[80:83], a[172:175], v[96:99], a[80:83]
v_exp_f32 v60, v60
M a[80:83], a[176:179], v[128:131], a[80:83]
ds_read_b128 a[140:143], v2 offset:6144
ds_read_b128 a[144:147], v2 offset:7168
M a[84:87], a[176:179], v[132:135], a[84:87]
v_exp_f32 v61, v61
M a[84:87], a[172:175], v[100:103], a[84:87]
v_cvt_pk_bf16_f32 v46, v60, v61
M a[88:91], a[172:175], v[104:107], a[88:91]
v_exp_f32 v62, v62
M a[88:91], a[176:179], v[136:139], a[88:91]
M a[92:95], a[176:179], v[140:143], a[92:95]
v_exp_f32 v63, v63
M a[92:95], a[172:175], v[108:111], a[92:95]
v_cvt_pk_bf16_f32 v47, v62, v63
s_and_b32 s3, s2, 3
s_lshl_b32 s3, s3, 2
s_bfe_u32 s27, s2, 0x20003
s_add_u32 s27, s3, s27
s_lshl_b32 s43, s27, 8
s_add_u32 s43, s43, 16789504
v_lshlrev_b32 v15, 2, v0
buffer_load_dword v7, v15, s[52:55], s43 offen sc1
s_waitcnt lgkmcnt(7)
ds_read_b128 a[116:119], v5 offset:32768
s_waitcnt lgkmcnt(7)
ds_read_b128 a[120:123], v5 offset:40960
s_waitcnt lgkmcnt(7)
ds_read_b128 a[124:127], v5 offset:33792
s_waitcnt lgkmcnt(7)
ds_read_b128 a[128:131], v5 offset:41984
s_waitcnt lgkmcnt(7)
ds_read_b128 a[132:135], v5 offset:34816
s_waitcnt lgkmcnt(7)
ds_read_b128 a[136:139], v5 offset:43008
s_waitcnt lgkmcnt(7)
ds_read_b128 a[140:143], v5 offset:35840
s_waitcnt lgkmcnt(7)
ds_read_b128 a[144:147], v5 offset:44032
s_lshl_b32 s33, s23, 14
s_add_u32 s34, s33, 131072
s_add_u32 s33, s33, 98304
v_add_u32 v2, s34, v1
v_add_u32 v3, s33, v1
v_exp_f32 v72, v72
v_exp_f32 v73, v73
v_exp_f32 v74, v74
v_exp_f32 v75, v75
v_cvt_pk_bf16_f32 v72, v72, v73
v_cvt_pk_bf16_f32 v73, v74, v75
v_exp_f32 v76, v76
v_exp_f32 v77, v77
v_exp_f32 v78, v78
v_exp_f32 v79, v79
v_mov_b32 v74, 0
v_mov_b32 v75, 0
v_exp_f32 v92, v92
v_exp_f32 v93, v93
v_exp_f32 v94, v94
v_exp_f32 v95, v95
v_cvt_pk_bf16_f32 v76, v76, v77
v_cvt_pk_bf16_f32 v77, v78, v79
v_cvt_pk_bf16_f32 v78, v92, v93
v_cvt_pk_bf16_f32 v79, v94, v95
s_waitcnt lgkmcnt(6)
M v[160:163], a[116:119], v[32:35], v[160:163]
ds_read_b128 a[148:151], v5 offset:36864
ds_read_b128 a[152:155], v5 offset:45056
s_mov_b32 s61, 0
M v[164:167], a[116:119], v[36:39], v[164:167]
s_bfe_u32 s3, s2, 0x10002
M v[168:171], a[116:119], v[40:43], v[168:171]
M v[168:171], a[120:123], v[72:75], v[168:171]
s_lshl_b32 s3, s3, 3
M v[172:175], a[120:123], v[76:79], v[172:175]
M v[172:175], a[116:119], v[44:47], v[172:175]
s_waitcnt lgkmcnt(6)
s_lshr_b32 s28, s2, 5
M a[96:99], a[112:115], v[32:35], a[96:99]
M v[176:179], a[124:127], v[32:35], v[176:179]
ds_read_b128 a[156:159], v5 offset:37888
ds_read_b128 a[160:163], v5 offset:46080
s_add_u32 s28, s3, s28
s_lshl_b32 s25, s27, 18
M v[180:183], a[124:127], v[36:39], v[180:183]
M v[184:187], a[124:127], v[40:43], v[184:187]
s_lshl_b32 s3, s101, 12
M v[184:187], a[128:131], v[72:75], v[184:187]
M v[188:191], a[128:131], v[76:79], v[188:191]
s_add_u32 s25, s25, s3
M v[188:191], a[124:127], v[44:47], v[188:191]
s_waitcnt lgkmcnt(6)
M a[100:103], a[112:115], v[36:39], a[100:103]
M v[192:195], a[132:135], v[32:35], v[192:195]
s_lshl_b32 s26, s28, 7
ds_read_b128 a[164:167], v5 offset:38912
ds_read_b128 a[168:171], v5 offset:47104
s_lshl_b32 s42, s101, 11
M v[196:199], a[132:135], v[36:39], v[196:199]
M v[200:203], a[132:135], v[40:43], v[200:203]
s_add_u32 s44, s4, 83886080
s_addc_u32 s45, s5, 0
M v[200:203], a[136:139], v[72:75], v[200:203]
s_mov_b32 s46, 4194304
M v[204:207], a[136:139], v[76:79], v[204:207]
M v[204:207], a[132:135], v[44:47], v[204:207]
s_waitcnt lgkmcnt(6)
s_mov_b32 s47, 0x00020000
M a[104:107], a[112:115], v[40:43], a[104:107]
M a[104:107], a[112:115], v[72:75], a[104:107]
M v[208:211], a[140:143], v[32:35], v[208:211]
ds_read_b128 a[172:175], v5 offset:39936
ds_read_b128 a[176:179], v5 offset:48128
s_mov_b32 s50, 2097152
M v[212:215], a[140:143], v[36:39], v[212:215]
s_mov_b32 s51, 0x00020000
M v[216:219], a[140:143], v[40:43], v[216:219]
M v[216:219], a[144:147], v[72:75], v[216:219]
s_lshl_b32 s3, s101, 4
M v[220:223], a[144:147], v[76:79], v[220:223]
M v[220:223], a[140:143], v[44:47], v[220:223]
s_waitcnt lgkmcnt(6)
v_lshrrev_b32 v96, 3, v0
M a[108:111], a[112:115], v[44:47], a[108:111]
M a[108:111], a[112:115], v[76:79], a[108:111]
M v[224:227], a[148:151], v[32:35], v[224:227]
v_and_b32 v97, 6, v96
ds_write_b128 v2, v[160:163] offset:0
v_and_b32 v98, 7, v0
M v[228:231], a[148:151], v[36:39], v[228:231]
M v[232:235], a[148:151], v[40:43], v[232:235]
ds_write_b128 v2, v[164:167] offset:1024
v_xor_b32 v97, v97, v98
M v[232:235], a[152:155], v[72:75], v[232:235]
M v[236:239], a[152:155], v[76:79], v[236:239]
ds_write_b128 v2, v[168:171] offset:2048
v_add_u32 v96, s3, v96
M v[236:239], a[148:151], v[44:47], v[236:239]
s_waitcnt lgkmcnt(7)
M v[240:243], a[156:159], v[32:35], v[240:243]
ds_write_b128 v2, v[172:175] offset:3072
v_lshlrev_b32 v96, 11, v96
ds_write_b128 v2, v[176:179] offset:4096
v_lshl_add_u32 v99, v97, 4, v96
M v[244:247], a[156:159], v[36:39], v[244:247]
v_add_u32 v100, 15360, v99
M v[248:251], a[156:159], v[40:43], v[248:251]
ds_write_b128 v2, v[180:183] offset:5120
M v[248:251], a[160:163], v[72:75], v[248:251]
s_waitcnt vmcnt(0) lgkmcnt(0)
s_barrier
M v[252:255], a[160:163], v[76:79], v[252:255]
ds_write_b128 v2, v[184:187] offset:6144
v_cmp_ne_u32 vcc, 1, v7
s_nop 0
s_cbranch_vccnz Lk3_spinb2
Lk3_gotb2:
M v[252:255], a[156:159], v[44:47], v[252:255]
s_add_u32 m0, s42, 16384
s_nop 0
buffer_load_dwordx4 v99, s[48:51], s26 offen offset:0 lds
M a[64:67], a[164:167], v[32:35], a[64:67]
ds_write_b128 v2, v[188:191] offset:7168
buffer_load_dwordx4 v100, s[48:51], s26 offen offset:1024 lds
ds_write_b128 v2, v[192:195] offset:8192
buffer_load_dwordx4 a[192:195], v1, s[44:47], s25 offen offset:0 sc1
M a[68:71], a[164:167], v[36:39], a[68:71]
buffer_load_dwordx4 a[196:199], v1, s[44:47], s25 offen offset:1024 sc1
M a[72:75], a[164:167], v[40:43], a[72:75]
ds_write_b128 v2, v[196:199] offset:9216
buffer_load_dwordx4 a[200:203], v1, s[44:47], s25 offen offset:2048 sc1
M a[72:75], a[168:171], v[72:75], a[72:75]
buffer_load_dwordx4 a[204:207], v1, s[44:47], s25 offen offset:3072 sc1
M a[76:79], a[168:171], v[76:79], a[76:79]
ds_write_b128 v2, v[200:203] offset:10240
M a[76:79], a[164:167], v[44:47], a[76:79]
s_add_u32 s25, s25, 16384
s_add_u32 s26, s26, 131072
M a[80:83], a[172:175], v[32:35], a[80:83]
ds_write_b128 v2, v[204:207] offset:11264
s_add_u32 m0, s42, 32768
s_nop 0
buffer_load_dwordx4 v99, s[48:51], s26 offen offset:0 lds
buffer_load_dwordx4 v100, s[48:51], s26 offen offset:1024 lds
ds_write_b128 v2, v[208:211] offset:12288
buffer_load_dwordx4 a[224:227], v1, s[44:47], s25 offen offset:0 sc1
M a[84:87], a[172:175], v[36:39], a[84:87]
M a[88:91], a[172:175], v[40:43], a[88:91]
ds_write_b128 v2, v[212:215] offset:13312
buffer_load_dwordx4 a[228:231], v1, s[44:47], s25 offen offset:1024 sc1
M a[88:91], a[176:179], v[72:75], a[88:91]
buffer_load_dwordx4 a[232:235], v1, s[44:47], s25 offen offset:2048 sc1
M a[92:95], a[176:179], v[76:79], a[92:95]
ds_write_b128 v2, v[216:219] offset:14336
buffer_load_dwordx4 a[236:239], v1, s[44:47], s25 offen offset:3072 sc1
M a[92:95], a[172:175], v[44:47], a[92:95]
s_add_u32 s25, s25, 16384
s_add_u32 s26, s26, 131072
ds_write_b128 v2, v[220:223] offset:15360
s_waitcnt lgkmcnt(0)
Lk2_mg1:
s_lshl_b32 s33, s22, 10
s_add_u32 s33, s33, 28672
s_xor_b32 s34, s33, 2048
v_add_u32 v14, s33, v1
v_add_u32 v15, s34, v1
v_accvgpr_read_b32 v20, a96
v_accvgpr_read_b32 v21, a100
v_accvgpr_read_b32 v22, a104
v_accvgpr_read_b32 v23, a108
ds_write_b128 v14, v[20:23]
s_waitcnt lgkmcnt(0)
s_barrier
ds_read_b128 v[28:31], v15
ds_read_b128 v[32:35], v3 offset:0
ds_read_b128 v[36:39], v3 offset:1024
ds_read_b128 v[40:43], v3 offset:2048
ds_read_b128 v[44:47], v3 offset:3072
ds_read_b128 v[48:51], v3 offset:4096
ds_read_b128 v[52:55], v3 offset:5120
ds_read_b128 v[56:59], v3 offset:6144
ds_read_b128 v[60:63], v3 offset:7168
ds_read_b128 v[64:67], v3 offset:8192
ds_read_b128 v[68:71], v3 offset:9216
ds_read_b128 v[72:75], v3 offset:10240
ds_read_b128 v[76:79], v3 offset:11264
ds_read_b128 v[80:83], v3 offset:12288
ds_read_b128 v[84:87], v3 offset:13312
ds_read_b128 v[88:91], v3 offset:14336
ds_read_b128 v[92:95], v3 offset:15360
s_waitcnt lgkmcnt(15)
v_add_f32 v20, v20, v28
v_add_f32 v21, v21, v29
v_add_f32 v22, v22, v30
v_add_f32 v23, v23, v31
s_sub_u32 s35, 15, s21
v_rcp_f32 v8, v20
v_rcp_f32 v9, v21
v_rcp_f32 v10, v22
v_rcp_f32 v11, v23
v_subrev_u32 v20, 0x21800000, v20
v_subrev_u32 v21, 0x21800000, v21
v_subrev_u32 v22, 0x21800000, v22
v_subrev_u32 v23, 0x21800000, v23
v_max_u32 v12, v20, v21
v_max3_u32 v12, v12, v22, v23
s_mov_b32 s64, 0x207
s_lshl_b32 s33, s35, 20
s_lshl_b32 s34, s20, 15
s_add_u32 s33, s33, s34
s_lshl_b32 s34, s23, 13
s_add_u32 s36, s33, s34
s_add_u32 s37, s36, 4096
s_add_u32 s38, s36, 16384
s_add_u32 s39, s36, 20480
v_pk_add_f32 v[224:225], v[224:225], v[32:33]
v_pk_add_f32 v[226:227], v[226:227], v[34:35]
s_waitcnt lgkmcnt(11)
v_pk_add_f32 v[240:241], v[240:241], v[48:49]
v_pk_add_f32 v[242:243], v[242:243], v[50:51]
v_pk_mul_f32 v[224:225], v[224:225], v[8:9] op_sel:[0,0] op_sel_hi:[1,0]
v_pk_mul_f32 v[226:227], v[226:227], v[8:9] op_sel:[0,0] op_sel_hi:[1,0]
v_pk_mul_f32 v[240:241], v[240:241], v[8:9] op_sel:[0,0] op_sel_hi:[1,0]
v_pk_mul_f32 v[242:243], v[242:243], v[8:9] op_sel:[0,0] op_sel_hi:[1,0]
v_cvt_pk_bf16_f32 v224, v224, v225
v_cvt_pk_bf16_f32 v225, v226, v227
v_cvt_pk_bf16_f32 v226, v240, v241
v_cvt_pk_bf16_f32 v227, v242, v243
v_pk_add_f32 v[228:229], v[228:229], v[36:37]
v_pk_add_f32 v[230:231], v[230:231], v[38:39]
s_waitcnt lgkmcnt(10)
v_pk_add_f32 v[244:245], v[244:245], v[52:53]
v_pk_add_f32 v[246:247], v[246:247], v[54:55]
M v[24:27], a[112:115], v[224:227], 0
buffer_store_dwordx4 v[224:227], v1, s[16:19], s38 offen offset:0 sc1
v_pk_mul_f32 v[228:229], v[228:229], v[8:9] op_sel:[0,1] op_sel_hi:[1,1]
v_pk_mul_f32 v[230:231], v[230:231], v[8:9] op_sel:[0,1] op_sel_hi:[1,1]
v_pk_mul_f32 v[244:245], v[244:245], v[8:9] op_sel:[0,1] op_sel_hi:[1,1]
v_pk_mul_f32 v[246:247], v[246:247], v[8:9] op_sel:[0,1] op_sel_hi:[1,1]
v_cvt_pk_bf16_f32 v228, v228, v229
v_cvt_pk_bf16_f32 v229, v230, v231
v_cvt_pk_bf16_f32 v230, v244, v245
v_cvt_pk_bf16_f32 v231, v246, v247
v_pk_add_f32 v[232:233], v[232:233], v[40:41]
v_pk_add_f32 v[234:235], v[234:235], v[42:43]
s_waitcnt lgkmcnt(9)
v_pk_add_f32 v[248:249], v[248:249], v[56:57]
v_pk_add_f32 v[250:251], v[250:251], v[58:59]
M v[24:27], a[112:115], v[228:231], v[24:27]
buffer_store_dwordx4 v[228:231], v1, s[16:19], s38 offen offset:2048 sc1
v_pk_mul_f32 v[232:233], v[232:233], v[10:11] op_sel:[0,0] op_sel_hi:[1,0]
v_pk_mul_f32 v[234:235], v[234:235], v[10:11] op_sel:[0,0] op_sel_hi:[1,0]
v_pk_mul_f32 v[248:249], v[248:249], v[10:11] op_sel:[0,0] op_sel_hi:[1,0]
v_pk_mul_f32 v[250:251], v[250:251], v[10:11] op_sel:[0,0] op_sel_hi:[1,0]
v_cvt_pk_bf16_f32 v232, v232, v233
v_cvt_pk_bf16_f32 v233, v234, v235
v_cvt_pk_bf16_f32 v234, v248, v249
v_cvt_pk_bf16_f32 v235, v250, v251
v_pk_add_f32 v[236:237], v[236:237], v[44:45]
v_pk_add_f32 v[238:239], v[238:239], v[46:47]
s_waitcnt lgkmcnt(8)
v_pk_add_f32 v[252:253], v[252:253], v[60:61]
v_pk_add_f32 v[254:255], v[254:255], v[62:63]
M v[24:27], a[112:115], v[232:235], v[24:27]
buffer_store_dwordx4 v[232:235], v1, s[16:19], s39 offen offset:0 sc1
v_pk_mul_f32 v[236:237], v[236:237], v[10:11] op_sel:[0,1] op_sel_hi:[1,1]
v_pk_mul_f32 v[238:239], v[238:239], v[10:11] op_sel:[0,1] op_sel_hi:[1,1]
v_pk_mul_f32 v[252:253], v[252:253], v[10:11] op_sel:[0,1] op_sel_hi:[1,1]
v_pk_mul_f32 v[254:255], v[254:255], v[10:11] op_sel:[0,1] op_sel_hi:[1,1]
v_cvt_pk_bf16_f32 v236, v236, v237
v_cvt_pk_bf16_f32 v237, v238, v239
v_cvt_pk_bf16_f32 v238, v252, v253
v_cvt_pk_bf16_f32 v239, v254, v255
v_accvgpr_read_b32 v32, a64
v_accvgpr_read_b32 v33, a65
v_accvgpr_read_b32 v34, a66
v_accvgpr_read_b32 v35, a67
s_waitcnt lgkmcnt(7)
v_pk_add_f32 v[32:33], v[32:33], v[64:65]
v_pk_add_f32 v[34:35], v[34:35], v[66:67]
v_accvgpr_read_b32 v48, a80
v_accvgpr_read_b32 v49, a81
v_accvgpr_read_b32 v50, a82
v_accvgpr_read_b32 v51, a83
s_waitcnt lgkmcnt(3)
v_pk_add_f32 v[48:49], v[48:49], v[80:81]
v_pk_add_f32 v[50:51], v[50:51], v[82:83]
M v[24:27], a[112:115], v[236:239], v[24:27]
buffer_store_dwordx4 v[236:239], v1, s[16:19], s39 offen offset:2048 sc1
v_pk_mul_f32 v[32:33], v[32:33], v[8:9] op_sel:[0,0] op_sel_hi:[1,0]
v_pk_mul_f32 v[34:35], v[34:35], v[8:9] op_sel:[0,0] op_sel_hi:[1,0]
v_pk_mul_f32 v[48:49], v[48:49], v[8:9] op_sel:[0,0] op_sel_hi:[1,0]
v_pk_mul_f32 v[50:51], v[50:51], v[8:9] op_sel:[0,0] op_sel_hi:[1,0]
v_cvt_pk_bf16_f32 v32, v32, v33
v_cvt_pk_bf16_f32 v33, v34, v35
v_cvt_pk_bf16_f32 v34, v48, v49
v_cvt_pk_bf16_f32 v35, v50, v51
v_accvgpr_read_b32 v240, a68
v_accvgpr_read_b32 v241, a69
v_accvgpr_read_b32 v242, a70
v_accvgpr_read_b32 v243, a71
v_pk_add_f32 v[240:241], v[240:241], v[68:69]
v_pk_add_f32 v[242:243], v[242:243], v[70:71]
v_accvgpr_read_b32 v36, a84
v_accvgpr_read_b32 v37, a85
v_accvgpr_read_b32 v38, a86
v_accvgpr_read_b32 v39, a87
s_waitcnt lgkmcnt(2)
v_pk_add_f32 v[36:37], v[36:37], v[84:85]
v_pk_add_f32 v[38:39], v[38:39], v[86:87]
M v[24:27], a[112:115], v[32:35], v[24:27]
buffer_store_dwordx4 v[32:35], v1, s[16:19], s38 offen offset:1024 sc1
v_pk_mul_f32 v[240:241], v[240:241], v[8:9] op_sel:[0,1] op_sel_hi:[1,1]
v_pk_mul_f32 v[242:243], v[242:243], v[8:9] op_sel:[0,1] op_sel_hi:[1,1]
v_pk_mul_f32 v[36:37], v[36:37], v[8:9] op_sel:[0,1] op_sel_hi:[1,1]
v_pk_mul_f32 v[38:39], v[38:39], v[8:9] op_sel:[0,1] op_sel_hi:[1,1]
v_cvt_pk_bf16_f32 v240, v240, v241
v_cvt_pk_bf16_f32 v241, v242, v243
v_cvt_pk_bf16_f32 v242, v36, v37
v_cvt_pk_bf16_f32 v243, v38, v39
v_accvgpr_read_b32 v52, a72
v_accvgpr_read_b32 v53, a73
v_accvgpr_read_b32 v54, a74
v_accvgpr_read_b32 v55, a75
v_pk_add_f32 v[52:53], v[52:53], v[72:73]
v_pk_add_f32 v[54:55], v[54:55], v[74:75]
v_accvgpr_read_b32 v244, a88
v_accvgpr_read_b32 v245, a89
v_accvgpr_read_b32 v246, a90
v_accvgpr_read_b32 v247, a91
s_waitcnt lgkmcnt(1)
v_pk_add_f32 v[244:245], v[244:245], v[88:89]
v_pk_add_f32 v[246:247], v[246:247], v[90:91]
M v[24:27], a[112:115], v[240:243], v[24:27]
buffer_store_dwordx4 v[240:243], v1, s[16:19], s38 offen offset:3072 sc1
v_pk_mul_f32 v[52:53], v[52:53], v[10:11] op_sel:[0,0] op_sel_hi:[1,0]
v_pk_mul_f32 v[54:55], v[54:55], v[10:11] op_sel:[0,0] op_sel_hi:[1,0]
v_pk_mul_f32 v[244:245], v[244:245], v[10:11] op_sel:[0,0] op_sel_hi:[1,0]
v_pk_mul_f32 v[246:247], v[246:247], v[10:11] op_sel:[0,0] op_sel_hi:[1,0]
v_cvt_pk_bf16_f32 v52, v52, v53
v_cvt_pk_bf16_f32 v53, v54, v55
v_cvt_pk_bf16_f32 v54, v244, v245
v_cvt_pk_bf16_f32 v55, v246, v247
v_accvgpr_read_b32 v40, a76
v_accvgpr_read_b32 v41, a77
v_accvgpr_read_b32 v42, a78
v_accvgpr_read_b32 v43, a79
v_pk_add_f32 v[40:41], v[40:41], v[76:77]
v_pk_add_f32 v[42:43], v[42:43], v[78:79]
v_accvgpr_read_b32 v56, a92
v_accvgpr_read_b32 v57, a93
v_accvgpr_read_b32 v58, a94
v_accvgpr_read_b32 v59, a95
s_waitcnt lgkmcnt(0)
v_pk_add_f32 v[56:57], v[56:57], v[92:93]
v_pk_add_f32 v[58:59], v[58:59], v[94:95]
M v[24:27], a[112:115], v[52:55], v[24:27]
buffer_store_dwordx4 v[52:55], v1, s[16:19], s39 offen offset:1024 sc1
v_pk_mul_f32 v[40:41], v[40:41], v[10:11] op_sel:[0,1] op_sel_hi:[1,1]
v_pk_mul_f32 v[42:43], v[42:43], v[10:11] op_sel:[0,1] op_sel_hi:[1,1]
v_pk_mul_f32 v[56:57], v[56:57], v[10:11] op_sel:[0,1] op_sel_hi:[1,1]
v_pk_mul_f32 v[58:59], v[58:59], v[10:11] op_sel:[0,1] op_sel_hi:[1,1]
v_cvt_pk_bf16_f32 v40, v40, v41
v_cvt_pk_bf16_f32 v41, v42, v43
v_cvt_pk_bf16_f32 v42, v56, v57
v_cvt_pk_bf16_f32 v43, v58, v59
s_nop 1
M v[24:27], a[112:115], v[40:43], v[24:27]
buffer_store_dwordx4 v[40:43], v1, s[16:19], s39 offen offset:3072 sc1
v_cmp_lt_u32 vcc, 0x3c000000, v12
s_nop 5
v_cmp_class_f32 s[40:41], v24, s64
s_nop 0
s_or_b64 vcc, vcc, s[40:41]
s_cmp_lg_u64 vcc, 0
s_cselect_b32 s33, 2, 0
s_or_b32 s60, s60, s33
Lk2_chk:
s_cmp_eq_u32 s60, 0
s_cbranch_scc1 Lk2_done
s_sub_u32 s56, 15, s21
s_lshl_b32 s33, s24, 1
s_lshl_b32 s61, 3, s33
s_and_b32 s34, s60, 2
s_bitcmp1_b32 s60, 0
s_cselect_b32 s56, s21, s56
s_cselect_b32 s61, 15, s61
s_cselect_b32 s60, s34, 0
s_waitcnt vmcnt(0)
s_lshl_b32 s33, s20, 7
s_lshl_b32 s34, s56, 3
s_add_u32 s33, s33, s34
s_lshl_b32 s34, s23, 2
s_add_u32 s33, s33, s34
s_lshl_b32 s33, s33, 12
buffer_load_dwordx4 a[0:3], v1, s[8:11], s33 offen offset:0 sc1
buffer_load_dwordx4 a[4:7], v1, s[8:11], s33 offen offset:1024 sc1
buffer_load_dwordx4 a[8:11], v1, s[8:11], s33 offen offset:2048 sc1
buffer_load_dwordx4 a[12:15], v1, s[8:11], s33 offen offset:3072 sc1
s_add_u32 s33, s33, 4096
buffer_load_dwordx4 a[16:19], v1, s[8:11], s33 offen offset:0 sc1
buffer_load_dwordx4 a[20:23], v1, s[8:11], s33 offen offset:1024 sc1
buffer_load_dwordx4 a[24:27], v1, s[8:11], s33 offen offset:2048 sc1
buffer_load_dwordx4 a[28:31], v1, s[8:11], s33 offen offset:3072 sc1
s_add_u32 s33, s33, 4096
buffer_load_dwordx4 a[32:35], v1, s[8:11], s33 offen offset:0 sc1
buffer_load_dwordx4 a[36:39], v1, s[8:11], s33 offen offset:1024 sc1
buffer_load_dwordx4 a[40:43], v1, s[8:11], s33 offen offset:2048 sc1
buffer_load_dwordx4 a[44:47], v1, s[8:11], s33 offen offset:3072 sc1
s_add_u32 s33, s33, 4096
buffer_load_dwordx4 a[48:51], v1, s[8:11], s33 offen offset:0 sc1
buffer_load_dwordx4 a[52:55], v1, s[8:11], s33 offen offset:1024 sc1
buffer_load_dwordx4 a[56:59], v1, s[8:11], s33 offen offset:2048 sc1
buffer_load_dwordx4 a[60:63], v1, s[8:11], s33 offen offset:3072 sc1
v_accvgpr_write_b32 a64, 0
v_accvgpr_write_b32 a65, 0
v_accvgpr_write_b32 a66, 0
v_accvgpr_write_b32 a67, 0
v_accvgpr_write_b32 a68, 0
v_accvgpr_write_b32 a69, 0
v_accvgpr_write_b32 a70, 0
v_accvgpr_write_b32 a71, 0
v_accvgpr_write_b32 a72, 0
v_accvgpr_write_b32 a73, 0
v_accvgpr_write_b32 a74, 0
v_accvgpr_write_b32 a75, 0
v_accvgpr_write_b32 a76, 0
v_accvgpr_write_b32 a77, 0
v_accvgpr_write_b32 a78, 0
v_accvgpr_write_b32 a79, 0
v_accvgpr_write_b32 a80, 0
v_accvgpr_write_b32 a81, 0
v_accvgpr_write_b32 a82, 0
v_accvgpr_write_b32 a83, 0
v_accvgpr_write_b32 a84, 0
v_accvgpr_write_b32 a85, 0
v_accvgpr_write_b32 a86, 0
v_accvgpr_write_b32 a87, 0
v_accvgpr_write_b32 a88, 0
v_accvgpr_write_b32 a89, 0
v_accvgpr_write_b32 a90, 0
v_accvgpr_write_b32 a91, 0
v_accvgpr_write_b32 a92, 0
v_accvgpr_write_b32 a93, 0
v_accvgpr_write_b32 a94, 0
v_accvgpr_write_b32 a95, 0
v_accvgpr_write_b32 a96, 0
v_accvgpr_write_b32 a97, 0
v_accvgpr_write_b32 a98, 0
v_accvgpr_write_b32 a99, 0
v_accvgpr_write_b32 a100, 0
v_accvgpr_write_b32 a101, 0
v_accvgpr_write_b32 a102, 0
v_accvgpr_write_b32 a103, 0
v_accvgpr_write_b32 a104, 0
v_accvgpr_write_b32 a105, 0
v_accvgpr_write_b32 a106, 0
v_accvgpr_write_b32 a107, 0
v_accvgpr_write_b32 a108, 0
v_accvgpr_write_b32 a109, 0
v_accvgpr_write_b32 a110, 0
v_accvgpr_write_b32 a111, 0
v_mov_b32 v160, 0
v_mov_b32 v161, 0
v_mov_b32 v162, 0
v_mov_b32 v163, 0
v_mov_b32 v164, 0
v_mov_b32 v165, 0
v_mov_b32 v166, 0
v_mov_b32 v167, 0
v_mov_b32 v168, 0
v_mov_b32 v169, 0
v_mov_b32 v170, 0
v_mov_b32 v171, 0
v_mov_b32 v172, 0
v_mov_b32 v173, 0
v_mov_b32 v174, 0
v_mov_b32 v175, 0
v_mov_b32 v176, 0
v_mov_b32 v177, 0
v_mov_b32 v178, 0
v_mov_b32 v179, 0
v_mov_b32 v180, 0
v_mov_b32 v181, 0
v_mov_b32 v182, 0
v_mov_b32 v183, 0
v_mov_b32 v184, 0
v_mov_b32 v185, 0
v_mov_b32 v186, 0
v_mov_b32 v187, 0
v_mov_b32 v188, 0
v_mov_b32 v189, 0
v_mov_b32 v190, 0
v_mov_b32 v191, 0
v_mov_b32 v192, 0
v_mov_b32 v193, 0
v_mov_b32 v194, 0
v_mov_b32 v195, 0
v_mov_b32 v196, 0
v_mov_b32 v197, 0
v_mov_b32 v198, 0
v_mov_b32 v199, 0
v_mov_b32 v200, 0
v_mov_b32 v201, 0
v_mov_b32 v202, 0
v_mov_b32 v203, 0
v_mov_b32 v204, 0
v_mov_b32 v205, 0
v_mov_b32 v206, 0
v_mov_b32 v207, 0
v_mov_b32 v208, 0
v_mov_b32 v209, 0
v_mov_b32 v210, 0
v_mov_b32 v211, 0
v_mov_b32 v212, 0
v_mov_b32 v213, 0
v_mov_b32 v214, 0
v_mov_b32 v215, 0
v_mov_b32 v216, 0
v_mov_b32 v217, 0
v_mov_b32 v218, 0
v_mov_b32 v219, 0
v_mov_b32 v220, 0
v_mov_b32 v221, 0
v_mov_b32 v222, 0
v_mov_b32 v223, 0
v_mov_b32 v224, 0
v_mov_b32 v225, 0
v_mov_b32 v226, 0
v_mov_b32 v227, 0
v_mov_b32 v228, 0
v_mov_b32 v229, 0
v_mov_b32 v230, 0
v_mov_b32 v231, 0
v_mov_b32 v232, 0
v_mov_b32 v233, 0
v_mov_b32 v234, 0
v_mov_b32 v235, 0
v_mov_b32 v236, 0
v_mov_b32 v237, 0
v_mov_b32 v238, 0
v_mov_b32 v239, 0
v_mov_b32 v240, 0
v_mov_b32 v241, 0
v_mov_b32 v242, 0
v_mov_b32 v243, 0
v_mov_b32 v244, 0
v_mov_b32 v245, 0
v_mov_b32 v246, 0
v_mov_b32 v247, 0
v_mov_b32 v248, 0
v_mov_b32 v249, 0
v_mov_b32 v250, 0
v_mov_b32 v251, 0
v_mov_b32 v252, 0
v_mov_b32 v253, 0
v_mov_b32 v254, 0
v_mov_b32 v255, 0
v_mov_b32 v8, v4
v_mov_b32 v9, v4
v_mov_b32 v10, v4
v_mov_b32 v11, v4
s_lshl_b32 s57, s20, 20
s_lshl_b32 s58, s56, 7
s_lshl_b32 s59, s56, 1
s_add_u32 s59, s59, 2
Lslow_2:
s_add_u32 s35, s57, 0
buffer_load_dwordx4 v[96:99], v1, s[12:15], s35 offen offset:0 sc1
buffer_load_dwordx4 v[100:103], v1, s[12:15], s35 offen offset:1024 sc1
buffer_load_dwordx4 v[104:107], v1, s[12:15], s35 offen offset:2048 sc1
buffer_load_dwordx4 v[108:111], v1, s[12:15], s35 offen offset:3072 sc1
s_add_u32 s35, s57, 4096
buffer_load_dwordx4 v[112:115], v1, s[12:15], s35 offen offset:0 sc1
buffer_load_dwordx4 v[116:119], v1, s[12:15], s35 offen offset:1024 sc1
buffer_load_dwordx4 v[120:123], v1, s[12:15], s35 offen offset:2048 sc1
buffer_load_dwordx4 v[124:127], v1, s[12:15], s35 offen offset:3072 sc1
s_add_u32 s35, s57, 8192
buffer_load_dwordx4 v[128:131], v1, s[12:15], s35 offen offset:0 sc1
buffer_load_dwordx4 v[132:135], v1, s[12:15], s35 offen offset:1024 sc1
buffer_load_dwordx4 v[136:139], v1, s[12:15], s35 offen offset:2048 sc1
buffer_load_dwordx4 v[140:143], v1, s[12:15], s35 offen offset:3072 sc1
s_add_u32 s35, s57, 12288
buffer_load_dwordx4 v[144:147], v1, s[12:15], s35 offen offset:0 sc1
buffer_load_dwordx4 v[148:151], v1, s[12:15], s35 offen offset:1024 sc1
buffer_load_dwordx4 v[152:155], v1, s[12:15], s35 offen offset:2048 sc1
buffer_load_dwordx4 v[156:159], v1, s[12:15], s35 offen offset:3072 sc1
s_lshl_b32 s33, s23, 6
s_add_i32 s33, s33, s58
s_cmp_gt_i32 s33, 0
s_cselect_b32 s34, 0, 0xf149f2ca
s_cmp_lt_i32 s33, 0
s_cselect_b32 s33, 0xf149f2ca, 0
v_mov_b32 v20, s34
v_mov_b32 v21, s34
v_mov_b32 v22, s34
v_mov_b32 v23, s34
v_mov_b32 v28, s33
v_mov_b32 v29, s33
v_mov_b32 v30, s33
v_mov_b32 v31, s33
v_med3_f32 v24, v16, v20, v28
v_med3_f32 v25, v17, v20, v28
v_med3_f32 v26, v18, v20, v28
v_med3_f32 v27, v19, v20, v28
s_waitcnt vmcnt(0)
s_nop 0
M v[32:35], v[96:99], a[0:3], v[24:27]
M v[32:35], v[100:103], a[4:7], v[32:35]
M v[32:35], v[104:107], a[8:11], v[32:35]
M v[32:35], v[108:111], a[12:15], v[32:35]
M v[36:39], v[96:99], a[16:19], v[28:31]
M v[36:39], v[100:103], a[20:23], v[36:39]
M v[36:39], v[104:107], a[24:27], v[36:39]
M v[36:39], v[108:111], a[28:31], v[36:39]
M v[40:43], v[96:99], a[32:35], v[28:31]
M v[40:43], v[100:103], a[36:39], v[40:43]
M v[40:43], v[104:107], a[40:43], v[40:43]
M v[40:43], v[108:111], a[44:47], v[40:43]
M v[44:47], v[96:99], a[48:51], v[28:31]
M v[44:47], v[100:103], a[52:55], v[44:47]
M v[44:47], v[104:107], a[56:59], v[44:47]
M v[44:47], v[108:111], a[60:63], v[44:47]
M v[48:51], v[112:115], a[0:3], v[20:23]
M v[48:51], v[116:119], a[4:7], v[48:51]
M v[48:51], v[120:123], a[8:11], v[48:51]
M v[48:51], v[124:127], a[12:15], v[48:51]
M v[52:55], v[112:115], a[16:19], v[24:27]
M v[52:55], v[116:119], a[20:23], v[52:55]
M v[52:55], v[120:123], a[24:27], v[52:55]
M v[52:55], v[124:127], a[28:31], v[52:55]
M v[56:59], v[112:115], a[32:35], v[28:31]
M v[56:59], v[116:119], a[36:39], v[56:59]
M v[56:59], v[120:123], a[40:43], v[56:59]
M v[56:59], v[124:127], a[44:47], v[56:59]
M v[60:63], v[112:115], a[48:51], v[28:31]
M v[60:63], v[116:119], a[52:55], v[60:63]
M v[60:63], v[120:123], a[56:59], v[60:63]
M v[60:63], v[124:127], a[60:63], v[60:63]
M v[64:67], v[128:131], a[0:3], v[20:23]
M v[64:67], v[132:135], a[4:7], v[64:67]
M v[64:67], v[136:139], a[8:11], v[64:67]
M v[64:67], v[140:143], a[12:15], v[64:67]
M v[68:71], v[128:131], a[16:19], v[20:23]
M v[68:71], v[132:135], a[20:23], v[68:71]
M v[68:71], v[136:139], a[24:27], v[68:71]
M v[68:71], v[140:143], a[28:31], v[68:71]
M v[72:75], v[128:131], a[32:35], v[24:27]
M v[72:75], v[132:135], a[36:39], v[72:75]
M v[72:75], v[136:139], a[40:43], v[72:75]
M v[72:75], v[140:143], a[44:47], v[72:75]
M v[76:79], v[128:131], a[48:51], v[28:31]
M v[76:79], v[132:135], a[52:55], v[76:79]
M v[76:79], v[136:139], a[56:59], v[76:79]
M v[76:79], v[140:143], a[60:63], v[76:79]
M v[80:83], v[144:147], a[0:3], v[20:23]
M v[80:83], v[148:151], a[4:7], v[80:83]
M v[80:83], v[152:155], a[8:11], v[80:83]
M v[80:83], v[156:159], a[12:15], v[80:83]
M v[84:87], v[144:147], a[16:19], v[20:23]
M v[84:87], v[148:151], a[20:23], v[84:87]
M v[84:87], v[152:155], a[24:27], v[84:87]
M v[84:87], v[156:159], a[28:31], v[84:87]
M v[88:91], v[144:147], a[32:35], v[20:23]
M v[88:91], v[148:151], a[36:39], v[88:91]
M v[88:91], v[152:155], a[40:43], v[88:91]
M v[88:91], v[156:159], a[44:47], v[88:91]
M v[92:95], v[144:147], a[48:51], v[24:27]
M v[92:95], v[148:151], a[52:55], v[92:95]
M v[92:95], v[152:155], a[56:59], v[92:95]
M v[92:95], v[156:159], a[60:63], v[92:95]
s_nop 7
s_add_u32 s35, s57, 16384
buffer_load_dwordx4 v[96:99], v1, s[12:15], s35 offen offset:0 sc1
buffer_load_dwordx4 v[100:103], v1, s[12:15], s35 offen offset:1024 sc1
buffer_load_dwordx4 v[104:107], v1, s[12:15], s35 offen offset:2048 sc1
buffer_load_dwordx4 v[108:111], v1, s[12:15], s35 offen offset:3072 sc1
s_add_u32 s35, s57, 20480
buffer_load_dwordx4 v[112:115], v1, s[12:15], s35 offen offset:0 sc1
buffer_load_dwordx4 v[116:119], v1, s[12:15], s35 offen offset:1024 sc1
buffer_load_dwordx4 v[120:123], v1, s[12:15], s35 offen offset:2048 sc1
buffer_load_dwordx4 v[124:127], v1, s[12:15], s35 offen offset:3072 sc1
s_add_u32 s35, s57, 24576
buffer_load_dwordx4 v[128:131], v1, s[12:15], s35 offen offset:0 sc1
buffer_load_dwordx4 v[132:135], v1, s[12:15], s35 offen offset:1024 sc1
buffer_load_dwordx4 v[136:139], v1, s[12:15], s35 offen offset:2048 sc1
buffer_load_dwordx4 v[140:143], v1, s[12:15], s35 offen offset:3072 sc1
s_add_u32 s35, s57, 28672
buffer_load_dwordx4 v[144:147], v1, s[12:15], s35 offen offset:0 sc1
buffer_load_dwordx4 v[148:151], v1, s[12:15], s35 offen offset:1024 sc1
buffer_load_dwordx4 v[152:155], v1, s[12:15], s35 offen offset:2048 sc1
buffer_load_dwordx4 v[156:159], v1, s[12:15], s35 offen offset:3072 sc1
v_max3_f32 v13, v32, v33, v8
v_max3_f32 v13, v13, v34, v35
v_max3_f32 v13, v13, v48, v49
v_max3_f32 v13, v13, v50, v51
v_max3_f32 v13, v13, v64, v65
v_max3_f32 v13, v13, v66, v67
v_max3_f32 v13, v13, v80, v81
v_max3_f32 v13, v13, v82, v83
v_mov_b32 v14, v13
s_nop 1
v_permlane16_swap_b32 v13, v14
v_max_f32 v13, v13, v14
v_mov_b32 v14, v13
s_nop 1
v_permlane32_swap_b32 v13, v14
v_max_f32 v13, v13, v14
v_sub_f32 v12, v8, v13
v_exp_f32 v12, v12
v_mov_b32 v8, v13
v_sub_f32 v32, v32, v13
v_sub_f32 v33, v33, v13
v_sub_f32 v34, v34, v13
v_sub_f32 v35, v35, v13
v_sub_f32 v48, v48, v13
v_sub_f32 v49, v49, v13
v_sub_f32 v50, v50, v13
v_sub_f32 v51, v51, v13
v_sub_f32 v64, v64, v13
v_sub_f32 v65, v65, v13
v_sub_f32 v66, v66, v13
v_sub_f32 v67, v67, v13
v_sub_f32 v80, v80, v13
v_sub_f32 v81, v81, v13
v_sub_f32 v82, v82, v13
v_sub_f32 v83, v83, v13
v_mul_f32 v160, v160, v12
v_mul_f32 v161, v161, v12
v_mul_f32 v162, v162, v12
v_mul_f32 v163, v163, v12
v_mul_f32 v176, v176, v12
v_mul_f32 v177, v177, v12
v_mul_f32 v178, v178, v12
v_mul_f32 v179, v179, v12
v_mul_f32 v192, v192, v12
v_mul_f32 v193, v193, v12
v_mul_f32 v194, v194, v12
v_mul_f32 v195, v195, v12
v_mul_f32 v208, v208, v12
v_mul_f32 v209, v209, v12
v_mul_f32 v210, v210, v12
v_mul_f32 v211, v211, v12
v_mul_f32 v224, v224, v12
v_mul_f32 v225, v225, v12
v_mul_f32 v226, v226, v12
v_mul_f32 v227, v227, v12
v_mul_f32 v240, v240, v12
v_mul_f32 v241, v241, v12
v_mul_f32 v242, v242, v12
v_mul_f32 v243, v243, v12
v_accvgpr_read_b32 v14, a64
v_mul_f32 v14, v14, v12
v_accvgpr_write_b32 a64, v14
v_accvgpr_read_b32 v14, a65
v_mul_f32 v14, v14, v12
v_accvgpr_write_b32 a65, v14
v_accvgpr_read_b32 v14, a66
v_mul_f32 v14, v14, v12
v_accvgpr_write_b32 a66, v14
v_accvgpr_read_b32 v14, a67
v_mul_f32 v14, v14, v12
v_accvgpr_write_b32 a67, v14
v_accvgpr_read_b32 v14, a80
v_mul_f32 v14, v14, v12
v_accvgpr_write_b32 a80, v14
v_accvgpr_read_b32 v14, a81
v_mul_f32 v14, v14, v12
v_accvgpr_write_b32 a81, v14
v_accvgpr_read_b32 v14, a82
v_mul_f32 v14, v14, v12
v_accvgpr_write_b32 a82, v14
v_accvgpr_read_b32 v14, a83
v_mul_f32 v14, v14, v12
v_accvgpr_write_b32 a83, v14
v_accvgpr_read_b32 v14, a96
v_mul_f32 v14, v14, v12
v_accvgpr_write_b32 a96, v14
v_accvgpr_read_b32 v14, a97
v_mul_f32 v14, v14, v12
v_accvgpr_write_b32 a97, v14
v_accvgpr_read_b32 v14, a98
v_mul_f32 v14, v14, v12
v_accvgpr_write_b32 a98, v14
v_accvgpr_read_b32 v14, a99
v_mul_f32 v14, v14, v12
v_accvgpr_write_b32 a99, v14
v_max3_f32 v13, v36, v37, v9
v_max3_f32 v13, v13, v38, v39
v_max3_f32 v13, v13, v52, v53
v_max3_f32 v13, v13, v54, v55
v_max3_f32 v13, v13, v68, v69
v_max3_f32 v13, v13, v70, v71
v_max3_f32 v13, v13, v84, v85
v_max3_f32 v13, v13, v86, v87
v_mov_b32 v14, v13
s_nop 1
v_permlane16_swap_b32 v13, v14
v_max_f32 v13, v13, v14
v_mov_b32 v14, v13
s_nop 1
v_permlane32_swap_b32 v13, v14
v_max_f32 v13, v13, v14
v_sub_f32 v12, v9, v13
v_exp_f32 v12, v12
v_mov_b32 v9, v13
v_sub_f32 v36, v36, v13
v_sub_f32 v37, v37, v13
v_sub_f32 v38, v38, v13
v_sub_f32 v39, v39, v13
v_sub_f32 v52, v52, v13
v_sub_f32 v53, v53, v13
v_sub_f32 v54, v54, v13
v_sub_f32 v55, v55, v13
v_sub_f32 v68, v68, v13
v_sub_f32 v69, v69, v13
v_sub_f32 v70, v70, v13
v_sub_f32 v71, v71, v13
v_sub_f32 v84, v84, v13
v_sub_f32 v85, v85, v13
v_sub_f32 v86, v86, v13
v_sub_f32 v87, v87, v13
v_mul_f32 v164, v164, v12
v_mul_f32 v165, v165, v12
v_mul_f32 v166, v166, v12
v_mul_f32 v167, v167, v12
v_mul_f32 v180, v180, v12
v_mul_f32 v181, v181, v12
v_mul_f32 v182, v182, v12
v_mul_f32 v183, v183, v12
v_mul_f32 v196, v196, v12
v_mul_f32 v197, v197, v12
v_mul_f32 v198, v198, v12
v_mul_f32 v199, v199, v12
v_mul_f32 v212, v212, v12
v_mul_f32 v213, v213, v12
v_mul_f32 v214, v214, v12
v_mul_f32 v215, v215, v12
v_mul_f32 v228, v228, v12
v_mul_f32 v229, v229, v12
v_mul_f32 v230, v230, v12
v_mul_f32 v231, v231, v12
v_mul_f32 v244, v244, v12
v_mul_f32 v245, v245, v12
v_mul_f32 v246, v246, v12
v_mul_f32 v247, v247, v12
v_accvgpr_read_b32 v14, a68
v_mul_f32 v14, v14, v12
v_accvgpr_write_b32 a68, v14
v_accvgpr_read_b32 v14, a69
v_mul_f32 v14, v14, v12
v_accvgpr_write_b32 a69, v14
v_accvgpr_read_b32 v14, a70
v_mul_f32 v14, v14, v12
v_accvgpr_write_b32 a70, v14
v_accvgpr_read_b32 v14, a71
v_mul_f32 v14, v14, v12
v_accvgpr_write_b32 a71, v14
v_accvgpr_read_b32 v14, a84
v_mul_f32 v14, v14, v12
v_accvgpr_write_b32 a84, v14
v_accvgpr_read_b32 v14, a85
v_mul_f32 v14, v14, v12
v_accvgpr_write_b32 a85, v14
v_accvgpr_read_b32 v14, a86
v_mul_f32 v14, v14, v12
v_accvgpr_write_b32 a86, v14
v_accvgpr_read_b32 v14, a87
v_mul_f32 v14, v14, v12
v_accvgpr_write_b32 a87, v14
v_accvgpr_read_b32 v14, a100
v_mul_f32 v14, v14, v12
v_accvgpr_write_b32 a100, v14
v_accvgpr_read_b32 v14, a101
v_mul_f32 v14, v14, v12
v_accvgpr_write_b32 a101, v14
v_accvgpr_read_b32 v14, a102
v_mul_f32 v14, v14, v12
v_accvgpr_write_b32 a102, v14
v_accvgpr_read_b32 v14, a103
v_mul_f32 v14, v14, v12
v_accvgpr_write_b32 a103, v14
v_max3_f32 v13, v40, v41, v10
v_max3_f32 v13, v13, v42, v43
v_max3_f32 v13, v13, v56, v57
v_max3_f32 v13, v13, v58, v59
v_max3_f32 v13, v13, v72, v73
v_max3_f32 v13, v13, v74, v75
v_max3_f32 v13, v13, v88, v89
v_max3_f32 v13, v13, v90, v91
v_mov_b32 v14, v13
s_nop 1
v_permlane16_swap_b32 v13, v14
v_max_f32 v13, v13, v14
v_mov_b32 v14, v13
s_nop 1
v_permlane32_swap_b32 v13, v14
v_max_f32 v13, v13, v14
v_sub_f32 v12, v10, v13
v_exp_f32 v12, v12
v_mov_b32 v10, v13
v_sub_f32 v40, v40, v13
v_sub_f32 v41, v41, v13
v_sub_f32 v42, v42, v13
v_sub_f32 v43, v43, v13
v_sub_f32 v56, v56, v13
v_sub_f32 v57, v57, v13
v_sub_f32 v58, v58, v13
v_sub_f32 v59, v59, v13
v_sub_f32 v72, v72, v13
v_sub_f32 v73, v73, v13
v_sub_f32 v74, v74, v13
v_sub_f32 v75, v75, v13
v_sub_f32 v88, v88, v13
v_sub_f32 v89, v89, v13
v_sub_f32 v90, v90, v13
v_sub_f32 v91, v91, v13
v_mul_f32 v168, v168, v12
v_mul_f32 v169, v169, v12
v_mul_f32 v170, v170, v12
v_mul_f32 v171, v171, v12
v_mul_f32 v184, v184, v12
v_mul_f32 v185, v185, v12
v_mul_f32 v186, v186, v12
v_mul_f32 v187, v187, v12
v_mul_f32 v200, v200, v12
v_mul_f32 v201, v201, v12
v_mul_f32 v202, v202, v12
v_mul_f32 v203, v203, v12
v_mul_f32 v216, v216, v12
v_mul_f32 v217, v217, v12
v_mul_f32 v218, v218, v12
v_mul_f32 v219, v219, v12
v_mul_f32 v232, v232, v12
v_mul_f32 v233, v233, v12
v_mul_f32 v234, v234, v12
v_mul_f32 v235, v235, v12
v_mul_f32 v248, v248, v12
v_mul_f32 v249, v249, v12
v_mul_f32 v250, v250, v12
v_mul_f32 v251, v251, v12
v_accvgpr_read_b32 v14, a72
v_mul_f32 v14, v14, v12
v_accvgpr_write_b32 a72, v14
v_accvgpr_read_b32 v14, a73
v_mul_f32 v14, v14, v12
v_accvgpr_write_b32 a73, v14
v_accvgpr_read_b32 v14, a74
v_mul_f32 v14, v14, v12
v_accvgpr_write_b32 a74, v14
v_accvgpr_read_b32 v14, a75
v_mul_f32 v14, v14, v12
v_accvgpr_write_b32 a75, v14
v_accvgpr_read_b32 v14, a88
v_mul_f32 v14, v14, v12
v_accvgpr_write_b32 a88, v14
v_accvgpr_read_b32 v14, a89
v_mul_f32 v14, v14, v12
v_accvgpr_write_b32 a89, v14
v_accvgpr_read_b32 v14, a90
v_mul_f32 v14, v14, v12
v_accvgpr_write_b32 a90, v14
v_accvgpr_read_b32 v14, a91
v_mul_f32 v14, v14, v12
v_accvgpr_write_b32 a91, v14
v_accvgpr_read_b32 v14, a104
v_mul_f32 v14, v14, v12
v_accvgpr_write_b32 a104, v14
v_accvgpr_read_b32 v14, a105
v_mul_f32 v14, v14, v12
v_accvgpr_write_b32 a105, v14
v_accvgpr_read_b32 v14, a106
v_mul_f32 v14, v14, v12
v_accvgpr_write_b32 a106, v14
v_accvgpr_read_b32 v14, a107
v_mul_f32 v14, v14, v12
v_accvgpr_write_b32 a107, v14
v_max3_f32 v13, v44, v45, v11
v_max3_f32 v13, v13, v46, v47
v_max3_f32 v13, v13, v60, v61
v_max3_f32 v13, v13, v62, v63
v_max3_f32 v13, v13, v76, v77
v_max3_f32 v13, v13, v78, v79
v_max3_f32 v13, v13, v92, v93
v_max3_f32 v13, v13, v94, v95
v_mov_b32 v14, v13
s_nop 1
v_permlane16_swap_b32 v13, v14
v_max_f32 v13, v13, v14
v_mov_b32 v14, v13
s_nop 1
v_permlane32_swap_b32 v13, v14
v_max_f32 v13, v13, v14
v_sub_f32 v12, v11, v13
v_exp_f32 v12, v12
v_mov_b32 v11, v13
v_sub_f32 v44, v44, v13
v_sub_f32 v45, v45, v13
v_sub_f32 v46, v46, v13
v_sub_f32 v47, v47, v13
v_sub_f32 v60, v60, v13
v_sub_f32 v61, v61, v13
v_sub_f32 v62, v62, v13
v_sub_f32 v63, v63, v13
v_sub_f32 v76, v76, v13
v_sub_f32 v77, v77, v13
v_sub_f32 v78, v78, v13
v_sub_f32 v79, v79, v13
v_sub_f32 v92, v92, v13
v_sub_f32 v93, v93, v13
v_sub_f32 v94, v94, v13
v_sub_f32 v95, v95, v13
v_mul_f32 v172, v172, v12
v_mul_f32 v173, v173, v12
v_mul_f32 v174, v174, v12
v_mul_f32 v175, v175, v12
v_mul_f32 v188, v188, v12
v_mul_f32 v189, v189, v12
v_mul_f32 v190, v190, v12
v_mul_f32 v191, v191, v12
v_mul_f32 v204, v204, v12
v_mul_f32 v205, v205, v12
v_mul_f32 v206, v206, v12
v_mul_f32 v207, v207, v12
v_mul_f32 v220, v220, v12
v_mul_f32 v221, v221, v12
v_mul_f32 v222, v222, v12
v_mul_f32 v223, v223, v12
v_mul_f32 v236, v236, v12
v_mul_f32 v237, v237, v12
v_mul_f32 v238, v238, v12
v_mul_f32 v239, v239, v12
v_mul_f32 v252, v252, v12
v_mul_f32 v253, v253, v12
v_mul_f32 v254, v254, v12
v_mul_f32 v255, v255, v12
v_accvgpr_read_b32 v14, a76
v_mul_f32 v14, v14, v12
v_accvgpr_write_b32 a76, v14
v_accvgpr_read_b32 v14, a77
v_mul_f32 v14, v14, v12
v_accvgpr_write_b32 a77, v14
v_accvgpr_read_b32 v14, a78
v_mul_f32 v14, v14, v12
v_accvgpr_write_b32 a78, v14
v_accvgpr_read_b32 v14, a79
v_mul_f32 v14, v14, v12
v_accvgpr_write_b32 a79, v14
v_accvgpr_read_b32 v14, a92
v_mul_f32 v14, v14, v12
v_accvgpr_write_b32 a92, v14
v_accvgpr_read_b32 v14, a93
v_mul_f32 v14, v14, v12
v_accvgpr_write_b32 a93, v14
v_accvgpr_read_b32 v14, a94
v_mul_f32 v14, v14, v12
v_accvgpr_write_b32 a94, v14
v_accvgpr_read_b32 v14, a95
v_mul_f32 v14, v14, v12
v_accvgpr_write_b32 a95, v14
v_accvgpr_read_b32 v14, a108
v_mul_f32 v14, v14, v12
v_accvgpr_write_b32 a108, v14
v_accvgpr_read_b32 v14, a109
v_mul_f32 v14, v14, v12
v_accvgpr_write_b32 a109, v14
v_accvgpr_read_b32 v14, a110
v_mul_f32 v14, v14, v12
v_accvgpr_write_b32 a110, v14
v_accvgpr_read_b32 v14, a111
v_mul_f32 v14, v14, v12
v_accvgpr_write_b32 a111, v14
v_exp_f32 v32, v32
v_exp_f32 v33, v33
v_exp_f32 v34, v34
v_exp_f32 v35, v35
v_exp_f32 v48, v48
v_exp_f32 v49, v49
v_exp_f32 v50, v50
v_exp_f32 v51, v51
v_cvt_pk_bf16_f32 v32, v32, v33
v_cvt_pk_bf16_f32 v33, v34, v35
v_exp_f32 v36, v36
v_exp_f32 v37, v37
v_exp_f32 v38, v38
v_exp_f32 v39, v39
v_cvt_pk_bf16_f32 v34, v48, v49
v_cvt_pk_bf16_f32 v35, v50, v51
v_exp_f32 v52, v52
v_exp_f32 v53, v53
v_exp_f32 v54, v54
v_exp_f32 v55, v55
v_cvt_pk_bf16_f32 v36, v36, v37
v_cvt_pk_bf16_f32 v37, v38, v39
v_exp_f32 v40, v40
v_exp_f32 v41, v41
v_exp_f32 v42, v42
v_exp_f32 v43, v43
v_cvt_pk_bf16_f32 v38, v52, v53
v_cvt_pk_bf16_f32 v39, v54, v55
v_exp_f32 v56, v56
v_exp_f32 v57, v57
v_exp_f32 v58, v58
v_exp_f32 v59, v59
v_cvt_pk_bf16_f32 v40, v40, v41
v_cvt_pk_bf16_f32 v41, v42, v43
v_exp_f32 v44, v44
v_exp_f32 v45, v45
v_exp_f32 v46, v46
v_exp_f32 v47, v47
v_cvt_pk_bf16_f32 v42, v56, v57
v_cvt_pk_bf16_f32 v43, v58, v59
v_exp_f32 v60, v60
v_exp_f32 v61, v61
v_exp_f32 v62, v62
v_exp_f32 v63, v63
v_cvt_pk_bf16_f32 v44, v44, v45
v_cvt_pk_bf16_f32 v45, v46, v47
v_cvt_pk_bf16_f32 v46, v60, v61
v_cvt_pk_bf16_f32 v47, v62, v63
v_exp_f32 v64, v64
v_exp_f32 v65, v65
v_exp_f32 v66, v66
v_exp_f32 v67, v67
v_exp_f32 v80, v80
v_exp_f32 v81, v81
v_exp_f32 v82, v82
v_exp_f32 v83, v83
v_cvt_pk_bf16_f32 v64, v64, v65
v_cvt_pk_bf16_f32 v65, v66, v67
v_exp_f32 v68, v68
v_exp_f32 v69, v69
v_exp_f32 v70, v70
v_exp_f32 v71, v71
v_cvt_pk_bf16_f32 v66, v80, v81
v_cvt_pk_bf16_f32 v67, v82, v83
v_exp_f32 v84, v84
v_exp_f32 v85, v85
v_exp_f32 v86, v86
v_exp_f32 v87, v87
v_cvt_pk_bf16_f32 v68, v68, v69
v_cvt_pk_bf16_f32 v69, v70, v71
v_exp_f32 v72, v72
v_exp_f32 v73, v73
v_exp_f32 v74, v74
v_exp_f32 v75, v75
v_cvt_pk_bf16_f32 v70, v84, v85
v_cvt_pk_bf16_f32 v71, v86, v87
v_exp_f32 v88, v88
v_exp_f32 v89, v89
v_exp_f32 v90, v90
v_exp_f32 v91, v91
v_cvt_pk_bf16_f32 v72, v72, v73
v_cvt_pk_bf16_f32 v73, v74, v75
v_exp_f32 v76, v76
v_exp_f32 v77, v77
v_exp_f32 v78, v78
v_exp_f32 v79, v79
v_cvt_pk_bf16_f32 v74, v88, v89
v_cvt_pk_bf16_f32 v75, v90, v91
v_exp_f32 v92, v92
v_exp_f32 v93, v93
v_exp_f32 v94, v94
v_exp_f32 v95, v95
v_cvt_pk_bf16_f32 v76, v76, v77
v_cvt_pk_bf16_f32 v77, v78, v79
v_cvt_pk_bf16_f32 v78, v92, v93
v_cvt_pk_bf16_f32 v79, v94, v95
s_waitcnt vmcnt(0)
M a[96:99], a[112:115], v[32:35], a[96:99]
M a[100:103], a[112:115], v[36:39], a[100:103]
M a[104:107], a[112:115], v[40:43], a[104:107]
M a[108:111], a[112:115], v[44:47], a[108:111]
M v[160:163], v[96:99], v[32:35], v[160:163]
M v[164:167], v[96:99], v[36:39], v[164:167]
M v[168:171], v[96:99], v[40:43], v[168:171]
M v[172:175], v[96:99], v[44:47], v[172:175]
M v[176:179], v[100:103], v[32:35], v[176:179]
M v[180:183], v[100:103], v[36:39], v[180:183]
M v[184:187], v[100:103], v[40:43], v[184:187]
M v[188:191], v[100:103], v[44:47], v[188:191]
M v[192:195], v[104:107], v[32:35], v[192:195]
M v[196:199], v[104:107], v[36:39], v[196:199]
M v[200:203], v[104:107], v[40:43], v[200:203]
M v[204:207], v[104:107], v[44:47], v[204:207]
M v[208:211], v[108:111], v[32:35], v[208:211]
M v[212:215], v[108:111], v[36:39], v[212:215]
M v[216:219], v[108:111], v[40:43], v[216:219]
M v[220:223], v[108:111], v[44:47], v[220:223]
M v[224:227], v[112:115], v[32:35], v[224:227]
M v[228:231], v[112:115], v[36:39], v[228:231]
M v[232:235], v[112:115], v[40:43], v[232:235]
M v[236:239], v[112:115], v[44:47], v[236:239]
M v[240:243], v[116:119], v[32:35], v[240:243]
M v[244:247], v[116:119], v[36:39], v[244:247]
M v[248:251], v[116:119], v[40:43], v[248:251]
M v[252:255], v[116:119], v[44:47], v[252:255]
M a[64:67], v[120:123], v[32:35], a[64:67]
M a[68:71], v[120:123], v[36:39], a[68:71]
M a[72:75], v[120:123], v[40:43], a[72:75]
M a[76:79], v[120:123], v[44:47], a[76:79]
M a[80:83], v[124:127], v[32:35], a[80:83]
M a[84:87], v[124:127], v[36:39], a[84:87]
M a[88:91], v[124:127], v[40:43], a[88:91]
M a[92:95], v[124:127], v[44:47], a[92:95]
M a[96:99], a[112:115], v[64:67], a[96:99]
M a[100:103], a[112:115], v[68:71], a[100:103]
M a[104:107], a[112:115], v[72:75], a[104:107]
M a[108:111], a[112:115], v[76:79], a[108:111]
M v[160:163], v[128:131], v[64:67], v[160:163]
M v[164:167], v[128:131], v[68:71], v[164:167]
M v[168:171], v[128:131], v[72:75], v[168:171]
M v[172:175], v[128:131], v[76:79], v[172:175]
M v[176:179], v[132:135], v[64:67], v[176:179]
M v[180:183], v[132:135], v[68:71], v[180:183]
M v[184:187], v[132:135], v[72:75], v[184:187]
M v[188:191], v[132:135], v[76:79], v[188:191]
M v[192:195], v[136:139], v[64:67], v[192:195]
M v[196:199], v[136:139], v[68:71], v[196:199]
M v[200:203], v[136:139], v[72:75], v[200:203]
M v[204:207], v[136:139], v[76:79], v[204:207]
M v[208:211], v[140:143], v[64:67], v[208:211]
M v[212:215], v[140:143], v[68:71], v[212:215]
M v[216:219], v[140:143], v[72:75], v[216:219]
M v[220:223], v[140:143], v[76:79], v[220:223]
M v[224:227], v[144:147], v[64:67], v[224:227]
M v[228:231], v[144:147], v[68:71], v[228:231]
M v[232:235], v[144:147], v[72:75], v[232:235]
M v[236:239], v[144:147], v[76:79], v[236:239]
M v[240:243], v[148:151], v[64:67], v[240:243]
M v[244:247], v[148:151], v[68:71], v[244:247]
M v[248:251], v[148:151], v[72:75], v[248:251]
M v[252:255], v[148:151], v[76:79], v[252:255]
M a[64:67], v[152:155], v[64:67], a[64:67]
M a[68:71], v[152:155], v[68:71], a[68:71]
M a[72:75], v[152:155], v[72:75], a[72:75]
M a[76:79], v[152:155], v[76:79], a[76:79]
M a[80:83], v[156:159], v[64:67], a[80:83]
M a[84:87], v[156:159], v[68:71], a[84:87]
M a[88:91], v[156:159], v[72:75], a[88:91]
M a[92:95], v[156:159], v[76:79], a[92:95]
s_nop 7
s_add_u32 s57, s57, 32768
s_sub_u32 s58, s58, 64
s_sub_u32 s59, s59, 1
s_cmp_lg_u32 s59, 0
s_cbranch_scc1 Lslow_2
v_accvgpr_read_b32 v20, a96
v_accvgpr_read_b32 v21, a100
v_accvgpr_read_b32 v22, a104
v_accvgpr_read_b32 v23, a108
v_rcp_f32 v8, v20
v_rcp_f32 v9, v21
v_rcp_f32 v10, v22
v_rcp_f32 v11, v23
s_lshl_b32 s33, s56, 20
s_lshl_b32 s34, s20, 15
s_add_u32 s33, s33, s34
s_lshl_b32 s34, s23, 13
s_add_u32 s36, s33, s34
s_add_u32 s37, s36, 4096
s_add_u32 s38, s36, 16384
s_add_u32 s39, s36, 20480
v_pk_mul_f32 v[160:161], v[160:161], v[8:9] op_sel:[0,0] op_sel_hi:[1,0]
v_pk_mul_f32 v[162:163], v[162:163], v[8:9] op_sel:[0,0] op_sel_hi:[1,0]
v_pk_mul_f32 v[176:177], v[176:177], v[8:9] op_sel:[0,0] op_sel_hi:[1,0]
v_pk_mul_f32 v[178:179], v[178:179], v[8:9] op_sel:[0,0] op_sel_hi:[1,0]
v_cvt_pk_bf16_f32 v160, v160, v161
v_cvt_pk_bf16_f32 v161, v162, v163
v_cvt_pk_bf16_f32 v162, v176, v177
v_cvt_pk_bf16_f32 v163, v178, v179
v_pk_mul_f32 v[164:165], v[164:165], v[8:9] op_sel:[0,1] op_sel_hi:[1,1]
v_pk_mul_f32 v[166:167], v[166:167], v[8:9] op_sel:[0,1] op_sel_hi:[1,1]
v_pk_mul_f32 v[180:181], v[180:181], v[8:9] op_sel:[0,1] op_sel_hi:[1,1]
v_pk_mul_f32 v[182:183], v[182:183], v[8:9] op_sel:[0,1] op_sel_hi:[1,1]
v_cvt_pk_bf16_f32 v164, v164, v165
v_cvt_pk_bf16_f32 v165, v166, v167
v_cvt_pk_bf16_f32 v166, v180, v181
v_cvt_pk_bf16_f32 v167, v182, v183
v_pk_mul_f32 v[168:169], v[168:169], v[10:11] op_sel:[0,0] op_sel_hi:[1,0]
v_pk_mul_f32 v[170:171], v[170:171], v[10:11] op_sel:[0,0] op_sel_hi:[1,0]
v_pk_mul_f32 v[184:185], v[184:185], v[10:11] op_sel:[0,0] op_sel_hi:[1,0]
v_pk_mul_f32 v[186:187], v[186:187], v[10:11] op_sel:[0,0] op_sel_hi:[1,0]
v_cvt_pk_bf16_f32 v168, v168, v169
v_cvt_pk_bf16_f32 v169, v170, v171
v_cvt_pk_bf16_f32 v170, v184, v185
v_cvt_pk_bf16_f32 v171, v186, v187
v_pk_mul_f32 v[172:173], v[172:173], v[10:11] op_sel:[0,1] op_sel_hi:[1,1]
v_pk_mul_f32 v[174:175], v[174:175], v[10:11] op_sel:[0,1] op_sel_hi:[1,1]
v_pk_mul_f32 v[188:189], v[188:189], v[10:11] op_sel:[0,1] op_sel_hi:[1,1]
v_pk_mul_f32 v[190:191], v[190:191], v[10:11] op_sel:[0,1] op_sel_hi:[1,1]
v_cvt_pk_bf16_f32 v172, v172, v173
v_cvt_pk_bf16_f32 v173, v174, v175
v_cvt_pk_bf16_f32 v174, v188, v189
v_cvt_pk_bf16_f32 v175, v190, v191
v_pk_mul_f32 v[192:193], v[192:193], v[8:9] op_sel:[0,0] op_sel_hi:[1,0]
v_pk_mul_f32 v[194:195], v[194:195], v[8:9] op_sel:[0,0] op_sel_hi:[1,0]
v_pk_mul_f32 v[208:209], v[208:209], v[8:9] op_sel:[0,0] op_sel_hi:[1,0]
v_pk_mul_f32 v[210:211], v[210:211], v[8:9] op_sel:[0,0] op_sel_hi:[1,0]
v_cvt_pk_bf16_f32 v192, v192, v193
v_cvt_pk_bf16_f32 v193, v194, v195
v_cvt_pk_bf16_f32 v194, v208, v209
v_cvt_pk_bf16_f32 v195, v210, v211
v_pk_mul_f32 v[196:197], v[196:197], v[8:9] op_sel:[0,1] op_sel_hi:[1,1]
v_pk_mul_f32 v[198:199], v[198:199], v[8:9] op_sel:[0,1] op_sel_hi:[1,1]
v_pk_mul_f32 v[212:213], v[212:213], v[8:9] op_sel:[0,1] op_sel_hi:[1,1]
v_pk_mul_f32 v[214:215], v[214:215], v[8:9] op_sel:[0,1] op_sel_hi:[1,1]
v_cvt_pk_bf16_f32 v196, v196, v197
v_cvt_pk_bf16_f32 v197, v198, v199
v_cvt_pk_bf16_f32 v198, v212, v213
v_cvt_pk_bf16_f32 v199, v214, v215
v_pk_mul_f32 v[200:201], v[200:201], v[10:11] op_sel:[0,0] op_sel_hi:[1,0]
v_pk_mul_f32 v[202:203], v[202:203], v[10:11] op_sel:[0,0] op_sel_hi:[1,0]
v_pk_mul_f32 v[216:217], v[216:217], v[10:11] op_sel:[0,0] op_sel_hi:[1,0]
v_pk_mul_f32 v[218:219], v[218:219], v[10:11] op_sel:[0,0] op_sel_hi:[1,0]
v_cvt_pk_bf16_f32 v200, v200, v201
v_cvt_pk_bf16_f32 v201, v202, v203
v_cvt_pk_bf16_f32 v202, v216, v217
v_cvt_pk_bf16_f32 v203, v218, v219
v_pk_mul_f32 v[204:205], v[204:205], v[10:11] op_sel:[0,1] op_sel_hi:[1,1]
v_pk_mul_f32 v[206:207], v[206:207], v[10:11] op_sel:[0,1] op_sel_hi:[1,1]
v_pk_mul_f32 v[220:221], v[220:221], v[10:11] op_sel:[0,1] op_sel_hi:[1,1]
v_pk_mul_f32 v[222:223], v[222:223], v[10:11] op_sel:[0,1] op_sel_hi:[1,1]
v_cvt_pk_bf16_f32 v204, v204, v205
v_cvt_pk_bf16_f32 v205, v206, v207
v_cvt_pk_bf16_f32 v206, v220, v221
v_cvt_pk_bf16_f32 v207, v222, v223
v_pk_mul_f32 v[224:225], v[224:225], v[8:9] op_sel:[0,0] op_sel_hi:[1,0]
v_pk_mul_f32 v[226:227], v[226:227], v[8:9] op_sel:[0,0] op_sel_hi:[1,0]
v_pk_mul_f32 v[240:241], v[240:241], v[8:9] op_sel:[0,0] op_sel_hi:[1,0]
v_pk_mul_f32 v[242:243], v[242:243], v[8:9] op_sel:[0,0] op_sel_hi:[1,0]
v_cvt_pk_bf16_f32 v224, v224, v225
v_cvt_pk_bf16_f32 v225, v226, v227
v_cvt_pk_bf16_f32 v226, v240, v241
v_cvt_pk_bf16_f32 v227, v242, v243
v_pk_mul_f32 v[228:229], v[228:229], v[8:9] op_sel:[0,1] op_sel_hi:[1,1]
v_pk_mul_f32 v[230:231], v[230:231], v[8:9] op_sel:[0,1] op_sel_hi:[1,1]
v_pk_mul_f32 v[244:245], v[244:245], v[8:9] op_sel:[0,1] op_sel_hi:[1,1]
v_pk_mul_f32 v[246:247], v[246:247], v[8:9] op_sel:[0,1] op_sel_hi:[1,1]
v_cvt_pk_bf16_f32 v228, v228, v229
v_cvt_pk_bf16_f32 v229, v230, v231
v_cvt_pk_bf16_f32 v230, v244, v245
v_cvt_pk_bf16_f32 v231, v246, v247
v_pk_mul_f32 v[232:233], v[232:233], v[10:11] op_sel:[0,0] op_sel_hi:[1,0]
v_pk_mul_f32 v[234:235], v[234:235], v[10:11] op_sel:[0,0] op_sel_hi:[1,0]
v_pk_mul_f32 v[248:249], v[248:249], v[10:11] op_sel:[0,0] op_sel_hi:[1,0]
v_pk_mul_f32 v[250:251], v[250:251], v[10:11] op_sel:[0,0] op_sel_hi:[1,0]
v_cvt_pk_bf16_f32 v232, v232, v233
v_cvt_pk_bf16_f32 v233, v234, v235
v_cvt_pk_bf16_f32 v234, v248, v249
v_cvt_pk_bf16_f32 v235, v250, v251
v_pk_mul_f32 v[236:237], v[236:237], v[10:11] op_sel:[0,1] op_sel_hi:[1,1]
v_pk_mul_f32 v[238:239], v[238:239], v[10:11] op_sel:[0,1] op_sel_hi:[1,1]
v_pk_mul_f32 v[252:253], v[252:253], v[10:11] op_sel:[0,1] op_sel_hi:[1,1]
v_pk_mul_f32 v[254:255], v[254:255], v[10:11] op_sel:[0,1] op_sel_hi:[1,1]
v_cvt_pk_bf16_f32 v236, v236, v237
v_cvt_pk_bf16_f32 v237, v238, v239
v_cvt_pk_bf16_f32 v238, v252, v253
v_cvt_pk_bf16_f32 v239, v254, v255
v_accvgpr_read_b32 v176, a64
v_accvgpr_read_b32 v177, a65
v_accvgpr_read_b32 v178, a66
v_accvgpr_read_b32 v179, a67
v_accvgpr_read_b32 v180, a80
v_accvgpr_read_b32 v181, a81
v_accvgpr_read_b32 v182, a82
v_accvgpr_read_b32 v183, a83
v_pk_mul_f32 v[176:177], v[176:177], v[8:9] op_sel:[0,0] op_sel_hi:[1,0]
v_pk_mul_f32 v[178:179], v[178:179], v[8:9] op_sel:[0,0] op_sel_hi:[1,0]
v_pk_mul_f32 v[180:181], v[180:181], v[8:9] op_sel:[0,0] op_sel_hi:[1,0]
v_pk_mul_f32 v[182:183], v[182:183], v[8:9] op_sel:[0,0] op_sel_hi:[1,0]
v_cvt_pk_bf16_f32 v176, v176, v177
v_cvt_pk_bf16_f32 v177, v178, v179
v_cvt_pk_bf16_f32 v178, v180, v181
v_cvt_pk_bf16_f32 v179, v182, v183
v_accvgpr_read_b32 v184, a68
v_accvgpr_read_b32 v185, a69
v_accvgpr_read_b32 v186, a70
v_accvgpr_read_b32 v187, a71
v_accvgpr_read_b32 v188, a84
v_accvgpr_read_b32 v189, a85
v_accvgpr_read_b32 v190, a86
v_accvgpr_read_b32 v191, a87
v_pk_mul_f32 v[184:185], v[184:185], v[8:9] op_sel:[0,1] op_sel_hi:[1,1]
v_pk_mul_f32 v[186:187], v[186:187], v[8:9] op_sel:[0,1] op_sel_hi:[1,1]
v_pk_mul_f32 v[188:189], v[188:189], v[8:9] op_sel:[0,1] op_sel_hi:[1,1]
v_pk_mul_f32 v[190:191], v[190:191], v[8:9] op_sel:[0,1] op_sel_hi:[1,1]
v_cvt_pk_bf16_f32 v184, v184, v185
v_cvt_pk_bf16_f32 v185, v186, v187
v_cvt_pk_bf16_f32 v186, v188, v189
v_cvt_pk_bf16_f32 v187, v190, v191
v_accvgpr_read_b32 v208, a72
v_accvgpr_read_b32 v209, a73
v_accvgpr_read_b32 v210, a74
v_accvgpr_read_b32 v211, a75
v_accvgpr_read_b32 v212, a88
v_accvgpr_read_b32 v213, a89
v_accvgpr_read_b32 v214, a90
v_accvgpr_read_b32 v215, a91
v_pk_mul_f32 v[208:209], v[208:209], v[10:11] op_sel:[0,0] op_sel_hi:[1,0]
v_pk_mul_f32 v[210:211], v[210:211], v[10:11] op_sel:[0,0] op_sel_hi:[1,0]
v_pk_mul_f32 v[212:213], v[212:213], v[10:11] op_sel:[0,0] op_sel_hi:[1,0]
v_pk_mul_f32 v[214:215], v[214:215], v[10:11] op_sel:[0,0] op_sel_hi:[1,0]
v_cvt_pk_bf16_f32 v208, v208, v209
v_cvt_pk_bf16_f32 v209, v210, v211
v_cvt_pk_bf16_f32 v210, v212, v213
v_cvt_pk_bf16_f32 v211, v214, v215
v_accvgpr_read_b32 v216, a76
v_accvgpr_read_b32 v217, a77
v_accvgpr_read_b32 v218, a78
v_accvgpr_read_b32 v219, a79
v_accvgpr_read_b32 v220, a92
v_accvgpr_read_b32 v221, a93
v_accvgpr_read_b32 v222, a94
v_accvgpr_read_b32 v223, a95
v_pk_mul_f32 v[216:217], v[216:217], v[10:11] op_sel:[0,1] op_sel_hi:[1,1]
v_pk_mul_f32 v[218:219], v[218:219], v[10:11] op_sel:[0,1] op_sel_hi:[1,1]
v_pk_mul_f32 v[220:221], v[220:221], v[10:11] op_sel:[0,1] op_sel_hi:[1,1]
v_pk_mul_f32 v[222:223], v[222:223], v[10:11] op_sel:[0,1] op_sel_hi:[1,1]
v_cvt_pk_bf16_f32 v216, v216, v217
v_cvt_pk_bf16_f32 v217, v218, v219
v_cvt_pk_bf16_f32 v218, v220, v221
v_cvt_pk_bf16_f32 v219, v222, v223
s_bitcmp1_b32 s61, 0
s_cbranch_scc0 Lss_3
buffer_store_dwordx4 v[160:163], v1, s[16:19], s36 offen offset:0 sc1
buffer_store_dwordx4 v[164:167], v1, s[16:19], s36 offen offset:2048 sc1
buffer_store_dwordx4 v[168:171], v1, s[16:19], s37 offen offset:0 sc1
buffer_store_dwordx4 v[172:175], v1, s[16:19], s37 offen offset:2048 sc1
Lss_3:
s_bitcmp1_b32 s61, 1
s_cbranch_scc0 Lss_4
buffer_store_dwordx4 v[192:195], v1, s[16:19], s36 offen offset:1024 sc1
buffer_store_dwordx4 v[196:199], v1, s[16:19], s36 offen offset:3072 sc1
buffer_store_dwordx4 v[200:203], v1, s[16:19], s37 offen offset:1024 sc1
buffer_store_dwordx4 v[204:207], v1, s[16:19], s37 offen offset:3072 sc1
Lss_4:
s_bitcmp1_b32 s61, 2
s_cbranch_scc0 Lss_5
buffer_store_dwordx4 v[224:227], v1, s[16:19], s38 offen offset:0 sc1
buffer_store_dwordx4 v[228:231], v1, s[16:19], s38 offen offset:2048 sc1
buffer_store_dwordx4 v[232:235], v1, s[16:19], s39 offen offset:0 sc1
buffer_store_dwordx4 v[236:239], v1, s[16:19], s39 offen offset:2048 sc1
Lss_5:
s_bitcmp1_b32 s61, 3
s_cbranch_scc0 Lss_6
buffer_store_dwordx4 v[176:179], v1, s[16:19], s38 offen offset:1024 sc1
buffer_store_dwordx4 v[184:187], v1, s[16:19], s38 offen offset:3072 sc1
buffer_store_dwordx4 v[208:211], v1, s[16:19], s39 offen offset:1024 sc1
buffer_store_dwordx4 v[216:219], v1, s[16:19], s39 offen offset:3072 sc1
Lss_6:
s_branch Lk2_chk
Lk2_done:
s_lshl_b32 s33, s20, 4
s_add_u32 s33, s33, 16781312
s_sub_u32 s34, 15, s21
s_lshl_b32 s34, s34, 9
s_add_u32 s92, s33, s34
s_lshl_b32 s34, s22, 2
s_add_u32 s92, s92, s34
s_lshl_b32 s34, s21, 9
s_add_u32 s93, s33, s34
s_lshl_b32 s34, s23, 3
s_add_u32 s93, s93, s34
s_cmp_eq_u32 s24, 0
s_cselect_b32 s93, s93, s92
s_cselect_b32 s94, 4, 0
s_add_u32 s94, s94, s93
s_load_dwordx2 s[10:11], s[0:1], 40
s_load_dwordx2 s[14:15], s[0:1], 72
s_lshl_b32 s21, s27, 7
s_lshl_b32 s22, s28, 6
s_lshl_b32 s3, s101, 4
v_lshrrev_b32 v232, 3, v0
v_and_b32 v233, 6, v232
v_and_b32 v234, 7, v0
v_xor_b32 v233, v233, v234
v_add_u32 v232, s3, v232
v_lshlrev_b32 v232, 11, v232
v_lshl_add_u32 v6, v233, 4, v232
v_add_u32 v7, 15360, v6
s_add_u32 m0, s42, 49152
s_nop 0
buffer_load_dwordx4 v6, s[48:51], s26 offen offset:0 lds
buffer_load_dwordx4 v7, s[48:51], s26 offen offset:1024 lds
buffer_load_dwordx4 a[96:99], v1, s[44:47], s25 offen offset:0 sc1
buffer_load_dwordx4 a[100:103], v1, s[44:47], s25 offen offset:1024 sc1
buffer_load_dwordx4 a[104:107], v1, s[44:47], s25 offen offset:2048 sc1
buffer_load_dwordx4 a[108:111], v1, s[44:47], s25 offen offset:3072 sc1
s_add_u32 s25, s25, 16384
s_add_u32 s26, s26, 131072
s_add_u32 m0, s42, 65536
s_nop 0
buffer_load_dwordx4 v6, s[48:51], s26 offen offset:0 lds
buffer_load_dwordx4 v7, s[48:51], s26 offen offset:1024 lds
buffer_load_dwordx4 a[128:131], v1, s[44:47], s25 offen offset:0 sc1
buffer_load_dwordx4 a[132:135], v1, s[44:47], s25 offen offset:1024 sc1
buffer_load_dwordx4 a[136:139], v1, s[44:47], s25 offen offset:2048 sc1
buffer_load_dwordx4 a[140:143], v1, s[44:47], s25 offen offset:3072 sc1
s_add_u32 s25, s25, 16384
s_add_u32 s26, s26, 131072
v_lshrrev_b32 v232, 2, v0
v_and_b32 v234, 1, v0
v_bfe_u32 v237, v0, 1, 1
v_lshlrev_b32 v233, 7, v232
v_lshl_add_u32 v233, v234, 3, v233
v_and_b32 v236, 6, v232
v_add_u32 v235, 0, v237
v_xor_b32 v235, v235, v236
v_lshl_add_u32 v24, v235, 4, v233
v_add_u32 v28, 0x10000, v24
v_add_u32 v235, 2, v237
v_xor_b32 v235, v235, v236
v_lshl_add_u32 v25, v235, 4, v233
v_add_u32 v29, 0x10000, v25
v_add_u32 v235, 4, v237
v_xor_b32 v235, v235, v236
v_lshl_add_u32 v26, v235, 4, v233
v_add_u32 v30, 0x10000, v26
v_add_u32 v235, 6, v237
v_xor_b32 v235, v235, v236
v_lshl_add_u32 v27, v235, 4, v233
v_add_u32 v31, 0x10000, v27
s_waitcnt vmcnt(26)
s_barrier
ds_read_b64_tr_b16 a[32:33], v24 offset:16384
ds_read_b64_tr_b16 a[34:35], v24 offset:18432
ds_read_b64_tr_b16 a[36:37], v24 offset:20480
ds_read_b64_tr_b16 a[38:39], v24 offset:22528
ds_read_b64_tr_b16 a[40:41], v25 offset:16384
ds_read_b64_tr_b16 a[42:43], v25 offset:18432
ds_read_b64_tr_b16 a[44:45], v25 offset:20480
ds_read_b64_tr_b16 a[46:47], v25 offset:22528
ds_read_b64_tr_b16 a[48:49], v26 offset:16384
ds_read_b64_tr_b16 a[50:51], v26 offset:18432
ds_read_b64_tr_b16 a[52:53], v26 offset:20480
ds_read_b64_tr_b16 a[54:55], v26 offset:22528
ds_read_b64_tr_b16 a[56:57], v27 offset:16384
ds_read_b64_tr_b16 a[58:59], v27 offset:18432
ds_read_b64_tr_b16 a[60:61], v27 offset:20480
ds_read_b64_tr_b16 a[62:63], v27 offset:22528
s_and_b32 s40, s2, 3
s_bfe_u32 s36, s2, 0x30003
s_lshl_b32 s29, s36, 8
s_bfe_u32 s3, s2, 0x10002
s_lshl_b32 s3, s3, 2
s_lshr_b32 s37, s2, 6
s_add_u32 s3, s3, s37
s_lshl_b32 s13, s3, 8
s_lshl_b32 s30, s3, 7
s_lshl_b32 s3, s40, 5
s_add_u32 s30, s30, s3
s_lshl_b32 s41, s101, 12
s_lshl_b32 s12, s36, 21
s_lshr_b32 s3, s101, 1
s_lshl_b32 s3, s3, 20
s_add_u32 s12, s12, s3
s_and_b32 s3, s101, 1
s_lshl_b32 s3, s3, 13
s_add_u32 s12, s12, s3
s_lshl_b32 s62, s36, 10
s_lshl_b32 s3, s40, 7
s_add_u32 s62, s62, s3
s_add_u32 s62, s62, 16781312
s_bfe_u32 s3, s2, 0x10002
s_lshl_b32 s3, s3, 3
s_sub_u32 s39, 16, s3
s_lshl_b32 s38, s40, 4
s_add_u32 s3, s3, s38
s_lshl_b32 s3, s3, 14
s_add_u32 s12, s12, s3
s_lshl_b32 s3, s3, 3
s_add_u32 s13, s13, s3
s_mov_b32 s64, 4294721536
s_mov_b32 s65, 16384
s_add_u32 s8, s4, 67108864
s_addc_u32 s9, s5, 0
s_lshl_b32 s56, s2, 16
s_lshl_b32 s38, s101, 14
s_add_u32 s56, s56, s38
s_lshl_b32 s58, s2, 2
s_add_u32 s58, s58, 16777216
s_and_b32 s59, s58, 0xfffffff0
s_mov_b32 s61, 0
s_lshl_b32 s3, s101, 4
v_lshrrev_b32 v240, 4, v0
v_and_b32 v242, 15, v0
v_add_u32 v241, 0, v240
v_lshlrev_b32 v241, 1, v241
v_xor_b32 v241, v241, v242
v_add_u32 v243, s3, v240
v_lshlrev_b32 v243, 11, v243
v_lshl_add_u32 v243, v241, 4, v243
v_add_u32 v2, 0, v243
v_add_u32 v241, 4, v240
v_lshlrev_b32 v241, 1, v241
v_xor_b32 v241, v241, v242
v_add_u32 v243, s3, v240
v_lshlrev_b32 v243, 11, v243
v_lshl_add_u32 v243, v241, 4, v243
v_add_u32 v3, 7168, v243
v_add_u32 v241, 0, v240
v_lshlrev_b32 v241, 1, v241
v_xor_b32 v241, v241, v242
v_add_u32 v243, s3, v240
v_lshlrev_b32 v243, 11, v243
v_lshl_add_u32 v243, v241, 4, v243
v_add_u32 v4, 14336, v243
v_add_u32 v241, 4, v240
v_lshlrev_b32 v241, 1, v241
v_xor_b32 v241, v241, v242
v_add_u32 v243, s3, v240
v_lshlrev_b32 v243, 11, v243
v_lshl_add_u32 v243, v241, 4, v243
v_add_u32 v5, 21504, v243
v_lshlrev_b32 v233, 8, v232
v_lshl_add_u32 v233, v234, 3, v233
v_and_b32 v236, 7, v232
v_lshlrev_b32 v236, 1, v236
s_lshl_b32 s38, s40, 2
v_xor_b32 v236, s38, v236
v_add_u32 v235, 0, v237
v_xor_b32 v235, v235, v236
v_lshl_add_u32 v8, v235, 4, v233
v_add_u32 v16, 0x10000, v8
v_add_u32 v235, 2, v237
v_xor_b32 v235, v235, v236
v_lshl_add_u32 v9, v235, 4, v233
v_add_u32 v17, 0x10000, v9
v_add_u32 v235, 4, v237
v_xor_b32 v235, v235, v236
v_lshl_add_u32 v10, v235, 4, v233
v_add_u32 v18, 0x10000, v10
v_add_u32 v235, 6, v237
v_xor_b32 v235, v235, v236
v_lshl_add_u32 v11, v235, 4, v233
v_add_u32 v19, 0x10000, v11
v_add_u32 v235, 8, v237
v_xor_b32 v235, v235, v236
v_lshl_add_u32 v12, v235, 4, v233
v_add_u32 v20, 0x10000, v12
v_add_u32 v235, 10, v237
v_xor_b32 v235, v235, v236
v_lshl_add_u32 v13, v235, 4, v233
v_add_u32 v21, 0x10000, v13
v_add_u32 v235, 12, v237
v_xor_b32 v235, v235, v236
v_lshl_add_u32 v14, v235, 4, v233
v_add_u32 v22, 0x10000, v14
v_add_u32 v235, 14, v237
v_xor_b32 v235, v235, v236
v_lshl_add_u32 v15, v235, 4, v233
v_add_u32 v23, 0x10000, v15
v_mov_b32 v253, 0
v_mov_b32 v254, 1
v_and_b32 v255, 31, v0
v_lshlrev_b32 v255, 2, v255
v_lshrrev_b32 v252, 5, v0
v_lshl_add_u32 v255, v252, 9, v255
s_waitcnt lgkmcnt(0)
s_mov_b32 s16, s14
s_mov_b32 s17, s15
s_mov_b32 s18, 8388608
s_mov_b32 s19, 0x00020000
s_waitcnt vmcnt(20) lgkmcnt(0)
s_barrier
M a[0:3], a[32:35], a[192:195], 0
s_add_u32 m0, s42, 81920
s_nop 0
buffer_load_dwordx4 v6, s[48:51], s26 offen offset:0 lds
ds_read_b64_tr_b16 v[160:161], v24 offset:32768
ds_read_b64_tr_b16 v[162:163], v24 offset:34816
M a[0:3], a[36:39], a[196:199], a[0:3]
buffer_load_dwordx4 v7, s[48:51], s26 offen offset:1024 lds
M a[4:7], a[44:47], a[196:199], 0
ds_read_b64_tr_b16 v[164:165], v24 offset:36864
ds_read_b64_tr_b16 v[166:167], v24 offset:38912
M a[4:7], a[40:43], a[192:195], a[4:7]
buffer_load_dwordx4 a[160:163], v1, s[44:47], s25 offen offset:0 sc1
M a[8:11], a[48:51], a[192:195], 0
ds_read_b64_tr_b16 v[168:169], v25 offset:32768
ds_read_b64_tr_b16 v[170:171], v25 offset:34816
M a[8:11], a[52:55], a[196:199], a[8:11]
buffer_load_dwordx4 a[164:167], v1, s[44:47], s25 offen offset:1024 sc1
M a[12:15], a[60:63], a[196:199], 0
ds_read_b64_tr_b16 v[172:173], v25 offset:36864
ds_read_b64_tr_b16 v[174:175], v25 offset:38912
M a[12:15], a[56:59], a[192:195], a[12:15]
buffer_load_dwordx4 a[168:171], v1, s[44:47], s25 offen offset:2048 sc1
M a[16:19], a[32:35], a[200:203], 0
ds_read_b64_tr_b16 v[176:177], v26 offset:32768
ds_read_b64_tr_b16 v[178:179], v26 offset:34816
M a[16:19], a[36:39], a[204:207], a[16:19]
buffer_load_dwordx4 a[172:175], v1, s[44:47], s25 offen offset:3072 sc1
M a[20:23], a[44:47], a[204:207], 0
ds_read_b64_tr_b16 v[180:181], v26 offset:36864
ds_read_b64_tr_b16 v[182:183], v26 offset:38912
M a[20:23], a[40:43], a[200:203], a[20:23]
s_add_u32 s25, s25, 16384
s_add_u32 s26, s26, 131072
M a[24:27], a[48:51], a[200:203], 0
ds_read_b64_tr_b16 v[184:185], v27 offset:32768
ds_read_b64_tr_b16 v[186:187], v27 offset:34816
M a[24:27], a[52:55], a[204:207], a[24:27]
ds_read_b64_tr_b16 v[188:189], v27 offset:36864
ds_read_b64_tr_b16 v[190:191], v27 offset:38912
M a[28:31], a[60:63], a[204:207], 0
M a[28:31], a[56:59], a[200:203], a[28:31]
s_waitcnt vmcnt(12) lgkmcnt(0)
s_barrier
s_mov_b64 exec, 1
buffer_store_dword v254, v253, s[52:55], s92 offen sc1
buffer_store_dword v254, v253, s[52:55], s93 offen sc1
buffer_store_dword v254, v253, s[52:55], s94 offen sc1
s_mov_b64 exec, -1
M a[0:3], v[160:163], a[224:227], a[0:3]
s_add_u32 m0, s42, 98304
s_nop 0
buffer_load_dwordx4 v6, s[48:51], s26 offen offset:0 lds
ds_read_b64_tr_b16 a[32:33], v24 offset:49152
ds_read_b64_tr_b16 a[34:35], v24 offset:51200
M a[0:3], v[164:167], a[228:231], a[0:3]
buffer_load_dwordx4 v7, s[48:51], s26 offen offset:1024 lds
M a[4:7], v[172:175], a[228:231], a[4:7]
ds_read_b64_tr_b16 a[36:37], v24 offset:53248
ds_read_b64_tr_b16 a[38:39], v24 offset:55296
M a[4:7], v[168:171], a[224:227], a[4:7]
buffer_load_dwordx4 a[192:195], v1, s[44:47], s25 offen offset:0 sc1
M a[8:11], v[176:179], a[224:227], a[8:11]
ds_read_b64_tr_b16 a[40:41], v25 offset:49152
ds_read_b64_tr_b16 a[42:43], v25 offset:51200
M a[8:11], v[180:183], a[228:231], a[8:11]
buffer_load_dwordx4 a[196:199], v1, s[44:47], s25 offen offset:1024 sc1
M a[12:15], v[188:191], a[228:231], a[12:15]
ds_read_b64_tr_b16 a[44:45], v25 offset:53248
ds_read_b64_tr_b16 a[46:47], v25 offset:55296
M a[12:15], v[184:187], a[224:227], a[12:15]
buffer_load_dwordx4 a[200:203], v1, s[44:47], s25 offen offset:2048 sc1
M a[16:19], v[160:163], a[232:235], a[16:19]
ds_read_b64_tr_b16 a[48:49], v26 offset:49152
ds_read_b64_tr_b16 a[50:51], v26 offset:51200
M a[16:19], v[164:167], a[236:239], a[16:19]
buffer_load_dwordx4 a[204:207], v1, s[44:47], s25 offen offset:3072 sc1
M a[20:23], v[172:175], a[236:239], a[20:23]
ds_read_b64_tr_b16 a[52:53], v26 offset:53248
ds_read_b64_tr_b16 a[54:55], v26 offset:55296
M a[20:23], v[168:171], a[232:235], a[20:23]
s_add_u32 s25, s25, 16384
s_add_u32 s26, s26, 131072
M a[24:27], v[176:179], a[232:235], a[24:27]
ds_read_b64_tr_b16 a[56:57], v27 offset:49152
ds_read_b64_tr_b16 a[58:59], v27 offset:51200
M a[24:27], v[180:183], a[236:239], a[24:27]
ds_read_b64_tr_b16 a[60:61], v27 offset:53248
ds_read_b64_tr_b16 a[62:63], v27 offset:55296
M a[28:31], v[188:191], a[236:239], a[28:31]
M a[28:31], v[184:187], a[232:235], a[28:31]
s_waitcnt vmcnt(15) lgkmcnt(0)
s_barrier
M a[0:3], a[32:35], a[96:99], a[0:3]
s_add_u32 m0, s42, 114688
s_nop 0
buffer_load_dwordx4 v6, s[48:51], s26 offen offset:0 lds
ds_read_b64_tr_b16 v[160:161], v28 offset:0
ds_read_b64_tr_b16 v[162:163], v28 offset:2048
M a[0:3], a[36:39], a[100:103], a[0:3]
buffer_load_dwordx4 v7, s[48:51], s26 offen offset:1024 lds
M a[4:7], a[44:47], a[100:103], a[4:7]
ds_read_b64_tr_b16 v[164:165], v28 offset:4096
ds_read_b64_tr_b16 v[166:167], v28 offset:6144
M a[4:7], a[40:43], a[96:99], a[4:7]
buffer_load_dwordx4 a[224:227], v1, s[44:47], s25 offen offset:0 sc1
M a[8:11], a[48:51], a[96:99], a[8:11]
ds_read_b64_tr_b16 v[168:169], v29 offset:0
ds_read_b64_tr_b16 v[170:171], v29 offset:2048
M a[8:11], a[52:55], a[100:103], a[8:11]
buffer_load_dwordx4 a[228:231], v1, s[44:47], s25 offen offset:1024 sc1
M a[12:15], a[60:63], a[100:103], a[12:15]
ds_read_b64_tr_b16 v[172:173], v29 offset:4096
ds_read_b64_tr_b16 v[174:175], v29 offset:6144
M a[12:15], a[56:59], a[96:99], a[12:15]
buffer_load_dwordx4 a[232:235], v1, s[44:47], s25 offen offset:2048 sc1
ds_read_b64_tr_b16 v[176:177], v30 offset:0
ds_read_b64_tr_b16 v[178:179], v30 offset:2048
M a[16:19], a[32:35], a[104:107], a[16:19]
buffer_load_dwordx4 a[236:239], v1, s[44:47], s25 offen offset:3072 sc1
M a[16:19], a[36:39], a[108:111], a[16:19]
ds_read_b64_tr_b16 v[180:181], v30 offset:4096
ds_read_b64_tr_b16 v[182:183], v30 offset:6144
M a[20:23], a[44:47], a[108:111], a[20:23]
s_add_u32 s25, s25, 16384
s_add_u32 s26, s26, 131072
M a[20:23], a[40:43], a[104:107], a[20:23]
ds_read_b64_tr_b16 v[184:185], v31 offset:0
ds_read_b64_tr_b16 v[186:187], v31 offset:2048
M a[24:27], a[48:51], a[104:107], a[24:27]
buffer_load_dword v252, v255, s[52:55], s62 offen sc1
M a[24:27], a[52:55], a[108:111], a[24:27]
ds_read_b64_tr_b16 v[188:189], v31 offset:4096
ds_read_b64_tr_b16 v[190:191], v31 offset:6144
M a[28:31], a[60:63], a[108:111], a[28:31]
M a[28:31], a[56:59], a[104:107], a[28:31]
s_waitcnt vmcnt(16) lgkmcnt(0)
s_barrier
s_waitcnt vmcnt(0)
v_cmp_ne_u32 vcc, 1, v252
s_nop 0
s_cbranch_vccnz Lk3_spinft
Lk3_gotft:
M a[0:3], v[160:163], a[128:131], a[0:3]
s_mov_b32 s32, s25
s_mov_b32 s33, s26
s_mov_b64 s[34:35], s[44:45]
s_mov_b64 s[36:37], s[48:49]
s_mov_b64 s[44:45], s[8:9]
s_mov_b32 s46, 16777216
s_mov_b64 s[48:49], s[10:11]
s_mov_b32 s50, 8388608
s_mov_b32 s25, s12
s_mov_b32 s26, s13
s_add_u32 m0, s41, 0
s_nop 0
buffer_load_dwordx4 v2, s[48:51], s26 offen offset:0 lds
ds_read_b64_tr_b16 a[32:33], v28 offset:16384
ds_read_b64_tr_b16 a[34:35], v28 offset:18432
M a[0:3], v[164:167], a[132:135], a[0:3]
buffer_load_dwordx4 v3, s[48:51], s26 offen offset:1024 lds
ds_read_b64_tr_b16 a[36:37], v28 offset:20480
ds_read_b64_tr_b16 a[38:39], v28 offset:22528
M a[4:7], v[172:175], a[132:135], a[4:7]
buffer_load_dwordx4 v4, s[48:51], s26 offen offset:2048 lds
M a[4:7], v[168:171], a[128:131], a[4:7]
ds_read_b64_tr_b16 a[40:41], v29 offset:16384
ds_read_b64_tr_b16 a[42:43], v29 offset:18432
buffer_load_dwordx4 v5, s[48:51], s26 offen offset:3072 lds
M a[8:11], v[176:179], a[128:131], a[8:11]
ds_read_b64_tr_b16 a[44:45], v29 offset:20480
ds_read_b64_tr_b16 a[46:47], v29 offset:22528
M a[8:11], v[180:183], a[132:135], a[8:11]
buffer_load_dwordx4 a[96:99], v1, s[44:47], s25 offen offset:0 sc1
ds_read_b64_tr_b16 a[48:49], v30 offset:16384
ds_read_b64_tr_b16 a[50:51], v30 offset:18432
M a[12:15], v[188:191], a[132:135], a[12:15]
buffer_load_dwordx4 a[100:103], v1, s[44:47], s25 offen offset:1024 sc1
M a[12:15], v[184:187], a[128:131], a[12:15]
ds_read_b64_tr_b16 a[52:53], v30 offset:20480
ds_read_b64_tr_b16 a[54:55], v30 offset:22528
buffer_load_dwordx4 a[104:107], v1, s[44:47], s25 offen offset:2048 sc1
M a[16:19], v[160:163], a[136:139], a[16:19]
ds_read_b64_tr_b16 a[56:57], v31 offset:16384
ds_read_b64_tr_b16 a[58:59], v31 offset:18432
buffer_load_dwordx4 a[108:111], v1, s[44:47], s25 offen offset:3072 sc1
M a[16:19], v[164:167], a[140:143], a[16:19]
ds_read_b64_tr_b16 a[60:61], v31 offset:20480
ds_read_b64_tr_b16 a[62:63], v31 offset:22528
M a[20:23], v[172:175], a[140:143], a[20:23]
s_add_u32 s63, s25, 4096
buffer_load_dwordx4 a[112:115], v1, s[44:47], s63 offen offset:0 sc1
buffer_load_dwordx4 a[116:119], v1, s[44:47], s63 offen offset:1024 sc1
M a[20:23], v[168:171], a[136:139], a[20:23]
buffer_load_dwordx4 a[120:123], v1, s[44:47], s63 offen offset:2048 sc1
M a[24:27], v[176:179], a[136:139], a[24:27]
buffer_load_dwordx4 a[124:127], v1, s[44:47], s63 offen offset:3072 sc1
s_sub_u32 s39, s39, 1
s_cmp_eq_u32 s39, 0
s_cselect_b32 s3, s64, s65
M a[24:27], v[180:183], a[140:143], a[24:27]
s_add_u32 s25, s25, s3
s_lshl_b32 s3, s3, 3
s_add_u32 s26, s26, s3
M a[28:31], v[188:191], a[140:143], a[28:31]
M a[28:31], v[184:187], a[136:139], a[28:31]
s_waitcnt vmcnt(19) lgkmcnt(0)
s_barrier
M a[0:3], a[32:35], a[160:163], a[0:3]
s_add_u32 m0, s41, 16384
s_nop 0
buffer_load_dwordx4 v2, s[48:51], s26 offen offset:0 lds
ds_read_b64_tr_b16 v[160:161], v28 offset:32768
ds_read_b64_tr_b16 v[162:163], v28 offset:34816
M a[0:3], a[36:39], a[164:167], a[0:3]
buffer_load_dwordx4 v3, s[48:51], s26 offen offset:1024 lds
ds_read_b64_tr_b16 v[164:165], v28 offset:36864
ds_read_b64_tr_b16 v[166:167], v28 offset:38912
M a[4:7], a[44:47], a[164:167], a[4:7]
buffer_load_dwordx4 v4, s[48:51], s26 offen offset:2048 lds
M a[4:7], a[40:43], a[160:163], a[4:7]
ds_read_b64_tr_b16 v[168:169], v29 offset:32768
ds_read_b64_tr_b16 v[170:171], v29 offset:34816
buffer_load_dwordx4 v5, s[48:51], s26 offen offset:3072 lds
M a[8:11], a[48:51], a[160:163], a[8:11]
ds_read_b64_tr_b16 v[172:173], v29 offset:36864
ds_read_b64_tr_b16 v[174:175], v29 offset:38912
M a[8:11], a[52:55], a[164:167], a[8:11]
buffer_load_dwordx4 a[128:131], v1, s[44:47], s25 offen offset:0 sc1
ds_read_b64_tr_b16 v[176:177], v30 offset:32768
ds_read_b64_tr_b16 v[178:179], v30 offset:34816
M a[12:15], a[60:63], a[164:167], a[12:15]
buffer_load_dwordx4 a[132:135], v1, s[44:47], s25 offen offset:1024 sc1
M a[12:15], a[56:59], a[160:163], a[12:15]
ds_read_b64_tr_b16 v[180:181], v30 offset:36864
ds_read_b64_tr_b16 v[182:183], v30 offset:38912
buffer_load_dwordx4 a[136:139], v1, s[44:47], s25 offen offset:2048 sc1
M a[16:19], a[32:35], a[168:171], a[16:19]
ds_read_b64_tr_b16 v[184:185], v31 offset:32768
ds_read_b64_tr_b16 v[186:187], v31 offset:34816
buffer_load_dwordx4 a[140:143], v1, s[44:47], s25 offen offset:3072 sc1
M a[16:19], a[36:39], a[172:175], a[16:19]
ds_read_b64_tr_b16 v[188:189], v31 offset:36864
ds_read_b64_tr_b16 v[190:191], v31 offset:38912
M a[20:23], a[44:47], a[172:175], a[20:23]
s_add_u32 s63, s25, 4096
buffer_load_dwordx4 a[144:147], v1, s[44:47], s63 offen offset:0 sc1
buffer_load_dwordx4 a[148:151], v1, s[44:47], s63 offen offset:1024 sc1
M a[20:23], a[40:43], a[168:171], a[20:23]
buffer_load_dwordx4 a[152:155], v1, s[44:47], s63 offen offset:2048 sc1
M a[24:27], a[48:51], a[168:171], a[24:27]
buffer_load_dwordx4 a[156:159], v1, s[44:47], s63 offen offset:3072 sc1
s_sub_u32 s39, s39, 1
s_cmp_eq_u32 s39, 0
s_cselect_b32 s3, s64, s65
M a[24:27], a[52:55], a[172:175], a[24:27]
s_add_u32 s25, s25, s3
s_lshl_b32 s3, s3, 3
s_add_u32 s26, s26, s3
M a[28:31], a[60:63], a[172:175], a[28:31]
M a[28:31], a[56:59], a[168:171], a[28:31]
s_waitcnt vmcnt(25) lgkmcnt(0)
s_barrier
M a[0:3], v[160:163], a[192:195], a[0:3]
s_add_u32 m0, s41, 32768
s_nop 0
buffer_load_dwordx4 v2, s[48:51], s26 offen offset:0 lds
ds_read_b64_tr_b16 a[32:33], v28 offset:49152
ds_read_b64_tr_b16 a[34:35], v28 offset:51200
M a[0:3], v[164:167], a[196:199], a[0:3]
buffer_load_dwordx4 v3, s[48:51], s26 offen offset:1024 lds
ds_read_b64_tr_b16 a[36:37], v28 offset:53248
ds_read_b64_tr_b16 a[38:39], v28 offset:55296
M a[4:7], v[172:175], a[196:199], a[4:7]
buffer_load_dwordx4 v4, s[48:51], s26 offen offset:2048 lds
M a[4:7], v[168:171], a[192:195], a[4:7]
ds_read_b64_tr_b16 a[40:41], v29 offset:49152
ds_read_b64_tr_b16 a[42:43], v29 offset:51200
buffer_load_dwordx4 v5, s[48:51], s26 offen offset:3072 lds
M a[8:11], v[176:179], a[192:195], a[8:11]
ds_read_b64_tr_b16 a[44:45], v29 offset:53248
ds_read_b64_tr_b16 a[46:47], v29 offset:55296
M a[8:11], v[180:183], a[196:199], a[8:11]
buffer_load_dwordx4 a[160:163], v1, s[44:47], s25 offen offset:0 sc1
ds_read_b64_tr_b16 a[48:49], v30 offset:49152
ds_read_b64_tr_b16 a[50:51], v30 offset:51200
M a[12:15], v[188:191], a[196:199], a[12:15]
buffer_load_dwordx4 a[164:167], v1, s[44:47], s25 offen offset:1024 sc1
M a[12:15], v[184:187], a[192:195], a[12:15]
ds_read_b64_tr_b16 a[52:53], v30 offset:53248
ds_read_b64_tr_b16 a[54:55], v30 offset:55296
buffer_load_dwordx4 a[168:171], v1, s[44:47], s25 offen offset:2048 sc1
M a[16:19], v[160:163], a[200:203], a[16:19]
ds_read_b64_tr_b16 a[56:57], v31 offset:49152
ds_read_b64_tr_b16 a[58:59], v31 offset:51200
buffer_load_dwordx4 a[172:175], v1, s[44:47], s25 offen offset:3072 sc1
M a[16:19], v[164:167], a[204:207], a[16:19]
ds_read_b64_tr_b16 a[60:61], v31 offset:53248
ds_read_b64_tr_b16 a[62:63], v31 offset:55296
M a[20:23], v[172:175], a[204:207], a[20:23]
s_add_u32 s63, s25, 4096
buffer_load_dwordx4 a[176:179], v1, s[44:47], s63 offen offset:0 sc1
buffer_load_dwordx4 a[180:183], v1, s[44:47], s63 offen offset:1024 sc1
M a[20:23], v[168:171], a[200:203], a[20:23]
buffer_load_dwordx4 a[184:187], v1, s[44:47], s63 offen offset:2048 sc1
M a[24:27], v[176:179], a[200:203], a[24:27]
buffer_load_dwordx4 a[188:191], v1, s[44:47], s63 offen offset:3072 sc1
s_sub_u32 s39, s39, 1
s_cmp_eq_u32 s39, 0
s_cselect_b32 s3, s64, s65
M a[24:27], v[180:183], a[204:207], a[24:27]
s_add_u32 s25, s25, s3
s_lshl_b32 s3, s3, 3
s_add_u32 s26, s26, s3
M a[28:31], v[188:191], a[204:207], a[28:31]
M a[28:31], v[184:187], a[200:203], a[28:31]
s_waitcnt vmcnt(24) lgkmcnt(0)
s_barrier
M a[0:3], a[32:35], a[224:227], a[0:3]
s_add_u32 m0, s41, 49152
s_nop 0
buffer_load_dwordx4 v2, s[48:51], s26 offen offset:0 lds
ds_read_b64_tr_b16 v[160:161], v8 offset:0
ds_read_b64_tr_b16 v[162:163], v8 offset:4096
buffer_load_dwordx4 v3, s[48:51], s26 offen offset:1024 lds
M a[0:3], a[36:39], a[228:231], a[0:3]
ds_read_b64_tr_b16 v[164:165], v8 offset:8192
ds_read_b64_tr_b16 v[166:167], v8 offset:12288
buffer_load_dwordx4 v4, s[48:51], s26 offen offset:2048 lds
M a[4:7], a[44:47], a[228:231], a[4:7]
ds_read_b64_tr_b16 v[168:169], v9 offset:0
ds_read_b64_tr_b16 v[170:171], v9 offset:4096
buffer_load_dwordx4 v5, s[48:51], s26 offen offset:3072 lds
M a[4:7], a[40:43], a[224:227], a[4:7]
ds_read_b64_tr_b16 v[172:173], v9 offset:8192
ds_read_b64_tr_b16 v[174:175], v9 offset:12288
buffer_load_dwordx4 a[192:195], v1, s[44:47], s25 offen offset:0 sc1
M a[8:11], a[48:51], a[224:227], a[8:11]
ds_read_b64_tr_b16 v[176:177], v10 offset:0
ds_read_b64_tr_b16 v[178:179], v10 offset:4096
buffer_load_dwordx4 a[196:199], v1, s[44:47], s25 offen offset:1024 sc1
M a[8:11], a[52:55], a[228:231], a[8:11]
ds_read_b64_tr_b16 v[180:181], v10 offset:8192
ds_read_b64_tr_b16 v[182:183], v10 offset:12288
buffer_load_dwordx4 a[200:203], v1, s[44:47], s25 offen offset:2048 sc1
M a[12:15], a[60:63], a[228:231], a[12:15]
ds_read_b64_tr_b16 v[184:185], v11 offset:0
ds_read_b64_tr_b16 v[186:187], v11 offset:4096
buffer_load_dwordx4 a[204:207], v1, s[44:47], s25 offen offset:3072 sc1
M a[12:15], a[56:59], a[224:227], a[12:15]
ds_read_b64_tr_b16 v[188:189], v11 offset:8192
ds_read_b64_tr_b16 v[190:191], v11 offset:12288
s_add_u32 s63, s25, 4096
buffer_load_dwordx4 a[208:211], v1, s[44:47], s63 offen offset:0 sc1
ds_read_b64_tr_b16 v[192:193], v12 offset:0
ds_read_b64_tr_b16 v[194:195], v12 offset:4096
M a[16:19], a[32:35], a[232:235], a[16:19]
buffer_load_dwordx4 a[212:215], v1, s[44:47], s63 offen offset:1024 sc1
ds_read_b64_tr_b16 v[196:197], v12 offset:8192
ds_read_b64_tr_b16 v[198:199], v12 offset:12288
M a[16:19], a[36:39], a[236:239], a[16:19]
buffer_load_dwordx4 a[216:219], v1, s[44:47], s63 offen offset:2048 sc1
ds_read_b64_tr_b16 v[200:201], v13 offset:0
ds_read_b64_tr_b16 v[202:203], v13 offset:4096
M a[20:23], a[44:47], a[236:239], a[20:23]
buffer_load_dwordx4 a[220:223], v1, s[44:47], s63 offen offset:3072 sc1
ds_read_b64_tr_b16 v[204:205], v13 offset:8192
ds_read_b64_tr_b16 v[206:207], v13 offset:12288
M a[20:23], a[40:43], a[232:235], a[20:23]
s_sub_u32 s39, s39, 1
s_cmp_eq_u32 s39, 0
s_cselect_b32 s3, s64, s65
ds_read_b64_tr_b16 v[208:209], v14 offset:0
ds_read_b64_tr_b16 v[210:211], v14 offset:4096
M a[24:27], a[48:51], a[232:235], a[24:27]
s_add_u32 s25, s25, s3
s_lshl_b32 s3, s3, 3
s_add_u32 s26, s26, s3
ds_read_b64_tr_b16 v[212:213], v14 offset:8192
ds_read_b64_tr_b16 v[214:215], v14 offset:12288
M a[24:27], a[52:55], a[236:239], a[24:27]
ds_read_b64_tr_b16 v[216:217], v15 offset:0
ds_read_b64_tr_b16 v[218:219], v15 offset:4096
ds_read_b64_tr_b16 v[220:221], v15 offset:8192
ds_read_b64_tr_b16 v[222:223], v15 offset:12288
M a[28:31], a[60:63], a[236:239], a[28:31]
M a[28:31], a[56:59], a[232:235], a[28:31]
s_waitcnt vmcnt(24) lgkmcnt(0)
s_barrier
M v[32:35], v[160:163], a[96:99], 0
s_add_u32 m0, s41, 65536
s_nop 0
buffer_load_dwordx4 v2, s[48:51], s26 offen offset:0 lds
M v[32:35], v[164:167], a[100:103], v[32:35]
M v[36:39], v[172:175], a[100:103], 0
ds_read_b64_tr_b16 a[32:33], v8 offset:16384
ds_read_b64_tr_b16 a[34:35], v8 offset:20480
M v[36:39], v[168:171], a[96:99], v[36:39]
M v[40:43], v[176:179], a[96:99], 0
buffer_load_dwordx4 v3, s[48:51], s26 offen offset:1024 lds
M v[40:43], v[180:183], a[100:103], v[40:43]
M v[44:47], v[188:191], a[100:103], 0
ds_read_b64_tr_b16 a[36:37], v8 offset:24576
ds_read_b64_tr_b16 a[38:39], v8 offset:28672
M v[44:47], v[184:187], a[96:99], v[44:47]
M v[48:51], v[192:195], a[96:99], 0
buffer_load_dwordx4 v4, s[48:51], s26 offen offset:2048 lds
M v[48:51], v[196:199], a[100:103], v[48:51]
M v[52:55], v[204:207], a[100:103], 0
ds_read_b64_tr_b16 a[40:41], v9 offset:16384
ds_read_b64_tr_b16 a[42:43], v9 offset:20480
M v[52:55], v[200:203], a[96:99], v[52:55]
M v[56:59], v[208:211], a[96:99], 0
buffer_load_dwordx4 v5, s[48:51], s26 offen offset:3072 lds
M v[56:59], v[212:215], a[100:103], v[56:59]
M v[60:63], v[220:223], a[100:103], 0
ds_read_b64_tr_b16 a[44:45], v9 offset:24576
ds_read_b64_tr_b16 a[46:47], v9 offset:28672
M v[60:63], v[216:219], a[96:99], v[60:63]
M v[64:67], v[160:163], a[104:107], 0
buffer_load_dwordx4 a[224:227], v1, s[44:47], s25 offen offset:0 sc1
M v[64:67], v[164:167], a[108:111], v[64:67]
M v[68:71], v[172:175], a[108:111], 0
ds_read_b64_tr_b16 a[48:49], v10 offset:16384
ds_read_b64_tr_b16 a[50:51], v10 offset:20480
M v[68:71], v[168:171], a[104:107], v[68:71]
M v[72:75], v[176:179], a[104:107], 0
buffer_load_dwordx4 a[228:231], v1, s[44:47], s25 offen offset:1024 sc1
M v[72:75], v[180:183], a[108:111], v[72:75]
M v[76:79], v[188:191], a[108:111], 0
ds_read_b64_tr_b16 a[52:53], v10 offset:24576
ds_read_b64_tr_b16 a[54:55], v10 offset:28672
M v[76:79], v[184:187], a[104:107], v[76:79]
M v[80:83], v[192:195], a[104:107], 0
buffer_load_dwordx4 a[232:235], v1, s[44:47], s25 offen offset:2048 sc1
M v[80:83], v[196:199], a[108:111], v[80:83]
M v[84:87], v[204:207], a[108:111], 0
ds_read_b64_tr_b16 a[56:57], v11 offset:16384
ds_read_b64_tr_b16 a[58:59], v11 offset:20480
M v[84:87], v[200:203], a[104:107], v[84:87]
M v[88:91], v[208:211], a[104:107], 0
buffer_load_dwordx4 a[236:239], v1, s[44:47], s25 offen offset:3072 sc1
M v[88:91], v[212:215], a[108:111], v[88:91]
M v[92:95], v[220:223], a[108:111], 0
M v[92:95], v[216:219], a[104:107], v[92:95]
ds_read_b64_tr_b16 a[60:61], v11 offset:24576
ds_read_b64_tr_b16 a[62:63], v11 offset:28672
M v[96:99], v[160:163], a[112:115], 0
M v[96:99], v[164:167], a[116:119], v[96:99]
s_add_u32 s63, s25, 4096
buffer_load_dwordx4 a[240:243], v1, s[44:47], s63 offen offset:0 sc1
M v[100:103], v[172:175], a[116:119], 0
M v[100:103], v[168:171], a[112:115], v[100:103]
ds_read_b64_tr_b16 a[64:65], v12 offset:16384
ds_read_b64_tr_b16 a[66:67], v12 offset:20480
M v[104:107], v[176:179], a[112:115], 0
M v[104:107], v[180:183], a[116:119], v[104:107]
buffer_load_dwordx4 a[244:247], v1, s[44:47], s63 offen offset:1024 sc1
M v[108:111], v[188:191], a[116:119], 0
M v[108:111], v[184:187], a[112:115], v[108:111]
ds_read_b64_tr_b16 a[68:69], v12 offset:24576
ds_read_b64_tr_b16 a[70:71], v12 offset:28672
M v[112:115], v[192:195], a[112:115], 0
M v[112:115], v[196:199], a[116:119], v[112:115]
buffer_load_dwordx4 a[248:251], v1, s[44:47], s63 offen offset:2048 sc1
M v[116:119], v[204:207], a[116:119], 0
M v[116:119], v[200:203], a[112:115], v[116:119]
ds_read_b64_tr_b16 a[72:73], v13 offset:16384
ds_read_b64_tr_b16 a[74:75], v13 offset:20480
M v[120:123], v[208:211], a[112:115], 0
M v[120:123], v[212:215], a[116:119], v[120:123]
buffer_load_dwordx4 a[252:255], v1, s[44:47], s63 offen offset:3072 sc1
M v[124:127], v[220:223], a[116:119], 0
M v[124:127], v[216:219], a[112:115], v[124:127]
ds_read_b64_tr_b16 a[76:77], v13 offset:24576
ds_read_b64_tr_b16 a[78:79], v13 offset:28672
M v[128:131], v[160:163], a[120:123], 0
M v[128:131], v[164:167], a[124:127], v[128:131]
s_sub_u32 s39, s39, 1
s_cmp_eq_u32 s39, 0
s_cselect_b32 s3, s64, s65
M v[132:135], v[172:175], a[124:127], 0
M v[132:135], v[168:171], a[120:123], v[132:135]
ds_read_b64_tr_b16 a[80:81], v14 offset:16384
ds_read_b64_tr_b16 a[82:83], v14 offset:20480
M v[136:139], v[176:179], a[120:123], 0
M v[136:139], v[180:183], a[124:127], v[136:139]
s_add_u32 s25, s25, s3
s_lshl_b32 s3, s3, 3
s_add_u32 s26, s26, s3
M v[140:143], v[188:191], a[124:127], 0
M v[140:143], v[184:187], a[120:123], v[140:143]
ds_read_b64_tr_b16 a[84:85], v14 offset:24576
ds_read_b64_tr_b16 a[86:87], v14 offset:28672
M v[144:147], v[192:195], a[120:123], 0
M v[144:147], v[196:199], a[124:127], v[144:147]
ds_read_b64_tr_b16 a[88:89], v15 offset:16384
ds_read_b64_tr_b16 a[90:91], v15 offset:20480
M v[148:151], v[204:207], a[124:127], 0
M v[148:151], v[200:203], a[120:123], v[148:151]
ds_read_b64_tr_b16 a[92:93], v15 offset:24576
ds_read_b64_tr_b16 a[94:95], v15 offset:28672
M v[152:155], v[208:211], a[120:123], 0
M v[152:155], v[212:215], a[124:127], v[152:155]
M v[156:159], v[220:223], a[124:127], 0
M v[156:159], v[216:219], a[120:123], v[156:159]
s_waitcnt vmcnt(24) lgkmcnt(0)
s_barrier
M v[32:35], a[32:35], a[128:131], v[32:35]
s_add_u32 m0, s41, 81920
s_nop 0
buffer_load_dwordx4 v2, s[48:51], s26 offen offset:0 lds
M v[32:35], a[36:39], a[132:135], v[32:35]
M v[36:39], a[44:47], a[132:135], v[36:39]
ds_read_b64_tr_b16 v[160:161], v8 offset:32768
ds_read_b64_tr_b16 v[162:163], v8 offset:36864
M v[36:39], a[40:43], a[128:131], v[36:39]
M v[40:43], a[48:51], a[128:131], v[40:43]
buffer_load_dwordx4 v3, s[48:51], s26 offen offset:1024 lds
M v[40:43], a[52:55], a[132:135], v[40:43]
M v[44:47], a[60:63], a[132:135], v[44:47]
ds_read_b64_tr_b16 v[164:165], v8 offset:40960
ds_read_b64_tr_b16 v[166:167], v8 offset:45056
M v[44:47], a[56:59], a[128:131], v[44:47]
M v[48:51], a[64:67], a[128:131], v[48:51]
buffer_load_dwordx4 v4, s[48:51], s26 offen offset:2048 lds
M v[48:51], a[68:71], a[132:135], v[48:51]
M v[52:55], a[76:79], a[132:135], v[52:55]
ds_read_b64_tr_b16 v[168:169], v9 offset:32768
ds_read_b64_tr_b16 v[170:171], v9 offset:36864
M v[52:55], a[72:75], a[128:131], v[52:55]
M v[56:59], a[80:83], a[128:131], v[56:59]
buffer_load_dwordx4 v5, s[48:51], s26 offen offset:3072 lds
M v[56:59], a[84:87], a[132:135], v[56:59]
M v[60:63], a[92:95], a[132:135], v[60:63]
ds_read_b64_tr_b16 v[172:173], v9 offset:40960
ds_read_b64_tr_b16 v[174:175], v9 offset:45056
M v[60:63], a[88:91], a[128:131], v[60:63]
M v[64:67], a[32:35], a[136:139], v[64:67]
buffer_load_dwordx4 a[96:99], v1, s[44:47], s25 offen offset:0 sc1
M v[64:67], a[36:39], a[140:143], v[64:67]
M v[68:71], a[44:47], a[140:143], v[68:71]
ds_read_b64_tr_b16 v[176:177], v10 offset:32768
ds_read_b64_tr_b16 v[178:179], v10 offset:36864
M v[68:71], a[40:43], a[136:139], v[68:71]
M v[72:75], a[48:51], a[136:139], v[72:75]
buffer_load_dwordx4 a[100:103], v1, s[44:47], s25 offen offset:1024 sc1
M v[72:75], a[52:55], a[140:143], v[72:75]
M v[76:79], a[60:63], a[140:143], v[76:79]
ds_read_b64_tr_b16 v[180:181], v10 offset:40960
ds_read_b64_tr_b16 v[182:183], v10 offset:45056
M v[76:79], a[56:59], a[136:139], v[76:79]
M v[80:83], a[64:67], a[136:139], v[80:83]
buffer_load_dwordx4 a[104:107], v1, s[44:47], s25 offen offset:2048 sc1
M v[80:83], a[68:71], a[140:143], v[80:83]
M v[84:87], a[76:79], a[140:143], v[84:87]
ds_read_b64_tr_b16 v[184:185], v11 offset:32768
ds_read_b64_tr_b16 v[186:187], v11 offset:36864
M v[84:87], a[72:75], a[136:139], v[84:87]
M v[88:91], a[80:83], a[136:139], v[88:91]
buffer_load_dwordx4 a[108:111], v1, s[44:47], s25 offen offset:3072 sc1
M v[88:91], a[84:87], a[140:143], v[88:91]
M v[92:95], a[92:95], a[140:143], v[92:95]
M v[92:95], a[88:91], a[136:139], v[92:95]
ds_read_b64_tr_b16 v[188:189], v11 offset:40960
ds_read_b64_tr_b16 v[190:191], v11 offset:45056
M v[96:99], a[32:35], a[144:147], v[96:99]
M v[96:99], a[36:39], a[148:151], v[96:99]
s_add_u32 s63, s25, 4096
buffer_load_dwordx4 a[112:115], v1, s[44:47], s63 offen offset:0 sc1
M v[100:103], a[44:47], a[148:151], v[100:103]
M v[100:103], a[40:43], a[144:147], v[100:103]
ds_read_b64_tr_b16 v[192:193], v12 offset:32768
ds_read_b64_tr_b16 v[194:195], v12 offset:36864
M v[104:107], a[48:51], a[144:147], v[104:107]
M v[104:107], a[52:55], a[148:151], v[104:107]
buffer_load_dwordx4 a[116:119], v1, s[44:47], s63 offen offset:1024 sc1
M v[108:111], a[60:63], a[148:151], v[108:111]
M v[108:111], a[56:59], a[144:147], v[108:111]
ds_read_b64_tr_b16 v[196:197], v12 offset:40960
ds_read_b64_tr_b16 v[198:199], v12 offset:45056
M v[112:115], a[64:67], a[144:147], v[112:115]
M v[112:115], a[68:71], a[148:151], v[112:115]
buffer_load_dwordx4 a[120:123], v1, s[44:47], s63 offen offset:2048 sc1
M v[116:119], a[76:79], a[148:151], v[116:119]
M v[116:119], a[72:75], a[144:147], v[116:119]
ds_read_b64_tr_b16 v[200:201], v13 offset:32768
ds_read_b64_tr_b16 v[202:203], v13 offset:36864
M v[120:123], a[80:83], a[144:147], v[120:123]
M v[120:123], a[84:87], a[148:151], v[120:123]
buffer_load_dwordx4 a[124:127], v1, s[44:47], s63 offen offset:3072 sc1
M v[124:127], a[92:95], a[148:151], v[124:127]
M v[124:127], a[88:91], a[144:147], v[124:127]
ds_read_b64_tr_b16 v[204:205], v13 offset:40960
ds_read_b64_tr_b16 v[206:207], v13 offset:45056
M v[128:131], a[32:35], a[152:155], v[128:131]
M v[128:131], a[36:39], a[156:159], v[128:131]
s_sub_u32 s39, s39, 1
s_cmp_eq_u32 s39, 0
s_cselect_b32 s3, s64, s65
M v[132:135], a[44:47], a[156:159], v[132:135]
M v[132:135], a[40:43], a[152:155], v[132:135]
ds_read_b64_tr_b16 v[208:209], v14 offset:32768
ds_read_b64_tr_b16 v[210:211], v14 offset:36864
M v[136:139], a[48:51], a[152:155], v[136:139]
M v[136:139], a[52:55], a[156:159], v[136:139]
s_add_u32 s25, s25, s3
s_lshl_b32 s3, s3, 3
s_add_u32 s26, s26, s3
M v[140:143], a[60:63], a[156:159], v[140:143]
M v[140:143], a[56:59], a[152:155], v[140:143]
ds_read_b64_tr_b16 v[212:213], v14 offset:40960
ds_read_b64_tr_b16 v[214:215], v14 offset:45056
M v[144:147], a[64:67], a[152:155], v[144:147]
M v[144:147], a[68:71], a[156:159], v[144:147]
ds_read_b64_tr_b16 v[216:217], v15 offset:32768
ds_read_b64_tr_b16 v[218:219], v15 offset:36864
M v[148:151], a[76:79], a[156:159], v[148:151]
M v[148:151], a[72:75], a[152:155], v[148:151]
ds_read_b64_tr_b16 v[220:221], v15 offset:40960
ds_read_b64_tr_b16 v[222:223], v15 offset:45056
M v[152:155], a[80:83], a[152:155], v[152:155]
M v[152:155], a[84:87], a[156:159], v[152:155]
M v[156:159], a[92:95], a[156:159], v[156:159]
M v[156:159], a[88:91], a[152:155], v[156:159]
s_waitcnt vmcnt(24) lgkmcnt(0)
s_barrier
M v[32:35], v[160:163], a[160:163], v[32:35]
s_add_u32 m0, s41, 98304
s_nop 0
buffer_load_dwordx4 v2, s[48:51], s26 offen offset:0 lds
M v[32:35], v[164:167], a[164:167], v[32:35]
M v[36:39], v[172:175], a[164:167], v[36:39]
ds_read_b64_tr_b16 a[32:33], v8 offset:49152
ds_read_b64_tr_b16 a[34:35], v8 offset:53248
M v[36:39], v[168:171], a[160:163], v[36:39]
M v[40:43], v[176:179], a[160:163], v[40:43]
buffer_load_dwordx4 v3, s[48:51], s26 offen offset:1024 lds
M v[40:43], v[180:183], a[164:167], v[40:43]
M v[44:47], v[188:191], a[164:167], v[44:47]
ds_read_b64_tr_b16 a[36:37], v8 offset:57344
ds_read_b64_tr_b16 a[38:39], v8 offset:61440
M v[44:47], v[184:187], a[160:163], v[44:47]
M v[48:51], v[192:195], a[160:163], v[48:51]
buffer_load_dwordx4 v4, s[48:51], s26 offen offset:2048 lds
M v[48:51], v[196:199], a[164:167], v[48:51]
M v[52:55], v[204:207], a[164:167], v[52:55]
ds_read_b64_tr_b16 a[40:41], v9 offset:49152
ds_read_b64_tr_b16 a[42:43], v9 offset:53248
M v[52:55], v[200:203], a[160:163], v[52:55]
M v[56:59], v[208:211], a[160:163], v[56:59]
buffer_load_dwordx4 v5, s[48:51], s26 offen offset:3072 lds
M v[56:59], v[212:215], a[164:167], v[56:59]
M v[60:63], v[220:223], a[164:167], v[60:63]
ds_read_b64_tr_b16 a[44:45], v9 offset:57344
ds_read_b64_tr_b16 a[46:47], v9 offset:61440
M v[60:63], v[216:219], a[160:163], v[60:63]
M v[64:67], v[160:163], a[168:171], v[64:67]
buffer_load_dwordx4 a[128:131], v1, s[44:47], s25 offen offset:0 sc1
M v[64:67], v[164:167], a[172:175], v[64:67]
M v[68:71], v[172:175], a[172:175], v[68:71]
ds_read_b64_tr_b16 a[48:49], v10 offset:49152
ds_read_b64_tr_b16 a[50:51], v10 offset:53248
M v[68:71], v[168:171], a[168:171], v[68:71]
M v[72:75], v[176:179], a[168:171], v[72:75]
buffer_load_dwordx4 a[132:135], v1, s[44:47], s25 offen offset:1024 sc1
M v[72:75], v[180:183], a[172:175], v[72:75]
M v[76:79], v[188:191], a[172:175], v[76:79]
ds_read_b64_tr_b16 a[52:53], v10 offset:57344
ds_read_b64_tr_b16 a[54:55], v10 offset:61440
M v[76:79], v[184:187], a[168:171], v[76:79]
M v[80:83], v[192:195], a[168:171], v[80:83]
buffer_load_dwordx4 a[136:139], v1, s[44:47], s25 offen offset:2048 sc1
M v[80:83], v[196:199], a[172:175], v[80:83]
M v[84:87], v[204:207], a[172:175], v[84:87]
ds_read_b64_tr_b16 a[56:57], v11 offset:49152
ds_read_b64_tr_b16 a[58:59], v11 offset:53248
M v[84:87], v[200:203], a[168:171], v[84:87]
M v[88:91], v[208:211], a[168:171], v[88:91]
buffer_load_dwordx4 a[140:143], v1, s[44:47], s25 offen offset:3072 sc1
M v[88:91], v[212:215], a[172:175], v[88:91]
M v[92:95], v[220:223], a[172:175], v[92:95]
M v[92:95], v[216:219], a[168:171], v[92:95]
ds_read_b64_tr_b16 a[60:61], v11 offset:57344
ds_read_b64_tr_b16 a[62:63], v11 offset:61440
M v[96:99], v[160:163], a[176:179], v[96:99]
M v[96:99], v[164:167], a[180:183], v[96:99]
s_add_u32 s63, s25, 4096
buffer_load_dwordx4 a[144:147], v1, s[44:47], s63 offen offset:0 sc1
M v[100:103], v[172:175], a[180:183], v[100:103]
M v[100:103], v[168:171], a[176:179], v[100:103]
ds_read_b64_tr_b16 a[64:65], v12 offset:49152
ds_read_b64_tr_b16 a[66:67], v12 offset:53248
M v[104:107], v[176:179], a[176:179], v[104:107]
M v[104:107], v[180:183], a[180:183], v[104:107]
buffer_load_dwordx4 a[148:151], v1, s[44:47], s63 offen offset:1024 sc1
M v[108:111], v[188:191], a[180:183], v[108:111]
M v[108:111], v[184:187], a[176:179], v[108:111]
ds_read_b64_tr_b16 a[68:69], v12 offset:57344
ds_read_b64_tr_b16 a[70:71], v12 offset:61440
M v[112:115], v[192:195], a[176:179], v[112:115]
M v[112:115], v[196:199], a[180:183], v[112:115]
buffer_load_dwordx4 a[152:155], v1, s[44:47], s63 offen offset:2048 sc1
M v[116:119], v[204:207], a[180:183], v[116:119]
M v[116:119], v[200:203], a[176:179], v[116:119]
ds_read_b64_tr_b16 a[72:73], v13 offset:49152
ds_read_b64_tr_b16 a[74:75], v13 offset:53248
M v[120:123], v[208:211], a[176:179], v[120:123]
M v[120:123], v[212:215], a[180:183], v[120:123]
buffer_load_dwordx4 a[156:159], v1, s[44:47], s63 offen offset:3072 sc1
M v[124:127], v[220:223], a[180:183], v[124:127]
M v[124:127], v[216:219], a[176:179], v[124:127]
ds_read_b64_tr_b16 a[76:77], v13 offset:57344
ds_read_b64_tr_b16 a[78:79], v13 offset:61440
M v[128:131], v[160:163], a[184:187], v[128:131]
M v[128:131], v[164:167], a[188:191], v[128:131]
s_sub_u32 s39, s39, 1
s_cmp_eq_u32 s39, 0
s_cselect_b32 s3, s64, s65
M v[132:135], v[172:175], a[188:191], v[132:135]
M v[132:135], v[168:171], a[184:187], v[132:135]
ds_read_b64_tr_b16 a[80:81], v14 offset:49152
ds_read_b64_tr_b16 a[82:83], v14 offset:53248
M v[136:139], v[176:179], a[184:187], v[136:139]
M v[136:139], v[180:183], a[188:191], v[136:139]
s_add_u32 s25, s25, s3
s_lshl_b32 s3, s3, 3
s_add_u32 s26, s26, s3
M v[140:143], v[188:191], a[188:191], v[140:143]
M v[140:143], v[184:187], a[184:187], v[140:143]
ds_read_b64_tr_b16 a[84:85], v14 offset:57344
ds_read_b64_tr_b16 a[86:87], v14 offset:61440
M v[144:147], v[192:195], a[184:187], v[144:147]
M v[144:147], v[196:199], a[188:191], v[144:147]
ds_read_b64_tr_b16 a[88:89], v15 offset:49152
ds_read_b64_tr_b16 a[90:91], v15 offset:53248
M v[148:151], v[204:207], a[188:191], v[148:151]
M v[148:151], v[200:203], a[184:187], v[148:151]
ds_read_b64_tr_b16 a[92:93], v15 offset:57344
ds_read_b64_tr_b16 a[94:95], v15 offset:61440
M v[152:155], v[208:211], a[184:187], v[152:155]
M v[152:155], v[212:215], a[188:191], v[152:155]
M v[156:159], v[220:223], a[188:191], v[156:159]
M v[156:159], v[216:219], a[184:187], v[156:159]
s_waitcnt vmcnt(24) lgkmcnt(0)
s_barrier
M v[32:35], a[32:35], a[192:195], v[32:35]
s_add_u32 m0, s41, 114688
s_nop 0
buffer_load_dwordx4 v2, s[48:51], s26 offen offset:0 lds
M v[32:35], a[36:39], a[196:199], v[32:35]
M v[36:39], a[44:47], a[196:199], v[36:39]
ds_read_b64_tr_b16 v[160:161], v16 offset:0
ds_read_b64_tr_b16 v[162:163], v16 offset:4096
M v[36:39], a[40:43], a[192:195], v[36:39]
M v[40:43], a[48:51], a[192:195], v[40:43]
buffer_load_dwordx4 v3, s[48:51], s26 offen offset:1024 lds
M v[40:43], a[52:55], a[196:199], v[40:43]
M v[44:47], a[60:63], a[196:199], v[44:47]
ds_read_b64_tr_b16 v[164:165], v16 offset:8192
ds_read_b64_tr_b16 v[166:167], v16 offset:12288
M v[44:47], a[56:59], a[192:195], v[44:47]
M v[48:51], a[64:67], a[192:195], v[48:51]
buffer_load_dwordx4 v4, s[48:51], s26 offen offset:2048 lds
M v[48:51], a[68:71], a[196:199], v[48:51]
M v[52:55], a[76:79], a[196:199], v[52:55]
ds_read_b64_tr_b16 v[168:169], v17 offset:0
ds_read_b64_tr_b16 v[170:171], v17 offset:4096
M v[52:55], a[72:75], a[192:195], v[52:55]
M v[56:59], a[80:83], a[192:195], v[56:59]
buffer_load_dwordx4 v5, s[48:51], s26 offen offset:3072 lds
M v[56:59], a[84:87], a[196:199], v[56:59]
M v[60:63], a[92:95], a[196:199], v[60:63]
ds_read_b64_tr_b16 v[172:173], v17 offset:8192
ds_read_b64_tr_b16 v[174:175], v17 offset:12288
M v[60:63], a[88:91], a[192:195], v[60:63]
M v[64:67], a[32:35], a[200:203], v[64:67]
buffer_load_dwordx4 a[160:163], v1, s[44:47], s25 offen offset:0 sc1
M v[64:67], a[36:39], a[204:207], v[64:67]
M v[68:71], a[44:47], a[204:207], v[68:71]
ds_read_b64_tr_b16 v[176:177], v18 offset:0
ds_read_b64_tr_b16 v[178:179], v18 offset:4096
M v[68:71], a[40:43], a[200:203], v[68:71]
M v[72:75], a[48:51], a[200:203], v[72:75]
buffer_load_dwordx4 a[164:167], v1, s[44:47], s25 offen offset:1024 sc1
M v[72:75], a[52:55], a[204:207], v[72:75]
M v[76:79], a[60:63], a[204:207], v[76:79]
ds_read_b64_tr_b16 v[180:181], v18 offset:8192
ds_read_b64_tr_b16 v[182:183], v18 offset:12288
M v[76:79], a[56:59], a[200:203], v[76:79]
M v[80:83], a[64:67], a[200:203], v[80:83]
buffer_load_dwordx4 a[168:171], v1, s[44:47], s25 offen offset:2048 sc1
M v[80:83], a[68:71], a[204:207], v[80:83]
M v[84:87], a[76:79], a[204:207], v[84:87]
ds_read_b64_tr_b16 v[184:185], v19 offset:0
ds_read_b64_tr_b16 v[186:187], v19 offset:4096
M v[84:87], a[72:75], a[200:203], v[84:87]
M v[88:91], a[80:83], a[200:203], v[88:91]
buffer_load_dwordx4 a[172:175], v1, s[44:47], s25 offen offset:3072 sc1
M v[88:91], a[84:87], a[204:207], v[88:91]
M v[92:95], a[92:95], a[204:207], v[92:95]
M v[92:95], a[88:91], a[200:203], v[92:95]
ds_read_b64_tr_b16 v[188:189], v19 offset:8192
ds_read_b64_tr_b16 v[190:191], v19 offset:12288
M v[96:99], a[32:35], a[208:211], v[96:99]
M v[96:99], a[36:39], a[212:215], v[96:99]
s_add_u32 s63, s25, 4096
buffer_load_dwordx4 a[176:179], v1, s[44:47], s63 offen offset:0 sc1
M v[100:103], a[44:47], a[212:215], v[100:103]
M v[100:103], a[40:43], a[208:211], v[100:103]
ds_read_b64_tr_b16 v[192:193], v20 offset:0
ds_read_b64_tr_b16 v[194:195], v20 offset:4096
M v[104:107], a[48:51], a[208:211], v[104:107]
M v[104:107], a[52:55], a[212:215], v[104:107]
buffer_load_dwordx4 a[180:183], v1, s[44:47], s63 offen offset:1024 sc1
M v[108:111], a[60:63], a[212:215], v[108:111]
M v[108:111], a[56:59], a[208:211], v[108:111]
ds_read_b64_tr_b16 v[196:197], v20 offset:8192
ds_read_b64_tr_b16 v[198:199], v20 offset:12288
M v[112:115], a[64:67], a[208:211], v[112:115]
M v[112:115], a[68:71], a[212:215], v[112:115]
buffer_load_dwordx4 a[184:187], v1, s[44:47], s63 offen offset:2048 sc1
M v[116:119], a[76:79], a[212:215], v[116:119]
M v[116:119], a[72:75], a[208:211], v[116:119]
ds_read_b64_tr_b16 v[200:201], v21 offset:0
ds_read_b64_tr_b16 v[202:203], v21 offset:4096
M v[120:123], a[80:83], a[208:211], v[120:123]
M v[120:123], a[84:87], a[212:215], v[120:123]
buffer_load_dwordx4 a[188:191], v1, s[44:47], s63 offen offset:3072 sc1
M v[124:127], a[92:95], a[212:215], v[124:127]
M v[124:127], a[88:91], a[208:211], v[124:127]
ds_read_b64_tr_b16 v[204:205], v21 offset:8192
ds_read_b64_tr_b16 v[206:207], v21 offset:12288
M v[128:131], a[32:35], a[216:219], v[128:131]
M v[128:131], a[36:39], a[220:223], v[128:131]
s_sub_u32 s39, s39, 1
s_cmp_eq_u32 s39, 0
s_cselect_b32 s3, s64, s65
M v[132:135], a[44:47], a[220:223], v[132:135]
M v[132:135], a[40:43], a[216:219], v[132:135]
ds_read_b64_tr_b16 v[208:209], v22 offset:0
ds_read_b64_tr_b16 v[210:211], v22 offset:4096
M v[136:139], a[48:51], a[216:219], v[136:139]
M v[136:139], a[52:55], a[220:223], v[136:139]
s_add_u32 s25, s25, s3
s_lshl_b32 s3, s3, 3
s_add_u32 s26, s26, s3
M v[140:143], a[60:63], a[220:223], v[140:143]
M v[140:143], a[56:59], a[216:219], v[140:143]
ds_read_b64_tr_b16 v[212:213], v22 offset:8192
ds_read_b64_tr_b16 v[214:215], v22 offset:12288
M v[144:147], a[64:67], a[216:219], v[144:147]
M v[144:147], a[68:71], a[220:223], v[144:147]
ds_read_b64_tr_b16 v[216:217], v23 offset:0
ds_read_b64_tr_b16 v[218:219], v23 offset:4096
M v[148:151], a[76:79], a[220:223], v[148:151]
M v[148:151], a[72:75], a[216:219], v[148:151]
ds_read_b64_tr_b16 v[220:221], v23 offset:8192
ds_read_b64_tr_b16 v[222:223], v23 offset:12288
M v[152:155], a[80:83], a[216:219], v[152:155]
M v[152:155], a[84:87], a[220:223], v[152:155]
M v[156:159], a[92:95], a[220:223], v[156:159]
M v[156:159], a[88:91], a[216:219], v[156:159]
s_waitcnt vmcnt(24) lgkmcnt(0)
s_barrier
M v[32:35], v[160:163], a[224:227], v[32:35]
s_add_u32 m0, s41, 0
s_nop 0
buffer_load_dwordx4 v2, s[48:51], s26 offen offset:0 lds
M v[32:35], v[164:167], a[228:231], v[32:35]
M v[36:39], v[172:175], a[228:231], v[36:39]
ds_read_b64_tr_b16 a[32:33], v16 offset:16384
ds_read_b64_tr_b16 a[34:35], v16 offset:20480
M v[36:39], v[168:171], a[224:227], v[36:39]
M v[40:43], v[176:179], a[224:227], v[40:43]
buffer_load_dwordx4 v3, s[48:51], s26 offen offset:1024 lds
M v[40:43], v[180:183], a[228:231], v[40:43]
M v[44:47], v[188:191], a[228:231], v[44:47]
ds_read_b64_tr_b16 a[36:37], v16 offset:24576
ds_read_b64_tr_b16 a[38:39], v16 offset:28672
M v[44:47], v[184:187], a[224:227], v[44:47]
M v[48:51], v[192:195], a[224:227], v[48:51]
buffer_load_dwordx4 v4, s[48:51], s26 offen offset:2048 lds
M v[48:51], v[196:199], a[228:231], v[48:51]
M v[52:55], v[204:207], a[228:231], v[52:55]
ds_read_b64_tr_b16 a[40:41], v17 offset:16384
ds_read_b64_tr_b16 a[42:43], v17 offset:20480
M v[52:55], v[200:203], a[224:227], v[52:55]
M v[56:59], v[208:211], a[224:227], v[56:59]
buffer_load_dwordx4 v5, s[48:51], s26 offen offset:3072 lds
M v[56:59], v[212:215], a[228:231], v[56:59]
M v[60:63], v[220:223], a[228:231], v[60:63]
ds_read_b64_tr_b16 a[44:45], v17 offset:24576
ds_read_b64_tr_b16 a[46:47], v17 offset:28672
M v[60:63], v[216:219], a[224:227], v[60:63]
M v[64:67], v[160:163], a[232:235], v[64:67]
buffer_load_dwordx4 a[192:195], v1, s[44:47], s25 offen offset:0 sc1
M v[64:67], v[164:167], a[236:239], v[64:67]
M v[68:71], v[172:175], a[236:239], v[68:71]
ds_read_b64_tr_b16 a[48:49], v18 offset:16384
ds_read_b64_tr_b16 a[50:51], v18 offset:20480
M v[68:71], v[168:171], a[232:235], v[68:71]
M v[72:75], v[176:179], a[232:235], v[72:75]
buffer_load_dwordx4 a[196:199], v1, s[44:47], s25 offen offset:1024 sc1
M v[72:75], v[180:183], a[236:239], v[72:75]
M v[76:79], v[188:191], a[236:239], v[76:79]
ds_read_b64_tr_b16 a[52:53], v18 offset:24576
ds_read_b64_tr_b16 a[54:55], v18 offset:28672
M v[76:79], v[184:187], a[232:235], v[76:79]
M v[80:83], v[192:195], a[232:235], v[80:83]
buffer_load_dwordx4 a[200:203], v1, s[44:47], s25 offen offset:2048 sc1
M v[80:83], v[196:199], a[236:239], v[80:83]
M v[84:87], v[204:207], a[236:239], v[84:87]
ds_read_b64_tr_b16 a[56:57], v19 offset:16384
ds_read_b64_tr_b16 a[58:59], v19 offset:20480
M v[84:87], v[200:203], a[232:235], v[84:87]
M v[88:91], v[208:211], a[232:235], v[88:91]
buffer_load_dwordx4 a[204:207], v1, s[44:47], s25 offen offset:3072 sc1
M v[88:91], v[212:215], a[236:239], v[88:91]
M v[92:95], v[220:223], a[236:239], v[92:95]
M v[92:95], v[216:219], a[232:235], v[92:95]
ds_read_b64_tr_b16 a[60:61], v19 offset:24576
ds_read_b64_tr_b16 a[62:63], v19 offset:28672
M v[96:99], v[160:163], a[240:243], v[96:99]
M v[96:99], v[164:167], a[244:247], v[96:99]
s_add_u32 s63, s25, 4096
buffer_load_dwordx4 a[208:211], v1, s[44:47], s63 offen offset:0 sc1
M v[100:103], v[172:175], a[244:247], v[100:103]
M v[100:103], v[168:171], a[240:243], v[100:103]
ds_read_b64_tr_b16 a[64:65], v20 offset:16384
ds_read_b64_tr_b16 a[66:67], v20 offset:20480
M v[104:107], v[176:179], a[240:243], v[104:107]
M v[104:107], v[180:183], a[244:247], v[104:107]
buffer_load_dwordx4 a[212:215], v1, s[44:47], s63 offen offset:1024 sc1
M v[108:111], v[188:191], a[244:247], v[108:111]
M v[108:111], v[184:187], a[240:243], v[108:111]
ds_read_b64_tr_b16 a[68:69], v20 offset:24576
ds_read_b64_tr_b16 a[70:71], v20 offset:28672
M v[112:115], v[192:195], a[240:243], v[112:115]
M v[112:115], v[196:199], a[244:247], v[112:115]
buffer_load_dwordx4 a[216:219], v1, s[44:47], s63 offen offset:2048 sc1
M v[116:119], v[204:207], a[244:247], v[116:119]
M v[116:119], v[200:203], a[240:243], v[116:119]
ds_read_b64_tr_b16 a[72:73], v21 offset:16384
ds_read_b64_tr_b16 a[74:75], v21 offset:20480
M v[120:123], v[208:211], a[240:243], v[120:123]
M v[120:123], v[212:215], a[244:247], v[120:123]
buffer_load_dwordx4 a[220:223], v1, s[44:47], s63 offen offset:3072 sc1
M v[124:127], v[220:223], a[244:247], v[124:127]
M v[124:127], v[216:219], a[240:243], v[124:127]
ds_read_b64_tr_b16 a[76:77], v21 offset:24576
ds_read_b64_tr_b16 a[78:79], v21 offset:28672
M v[128:131], v[160:163], a[248:251], v[128:131]
M v[128:131], v[164:167], a[252:255], v[128:131]
s_sub_u32 s39, s39, 1
s_cmp_eq_u32 s39, 0
s_cselect_b32 s3, s64, s65
M v[132:135], v[172:175], a[252:255], v[132:135]
M v[132:135], v[168:171], a[248:251], v[132:135]
ds_read_b64_tr_b16 a[80:81], v22 offset:16384
ds_read_b64_tr_b16 a[82:83], v22 offset:20480
M v[136:139], v[176:179], a[248:251], v[136:139]
M v[136:139], v[180:183], a[252:255], v[136:139]
s_add_u32 s25, s25, s3
s_lshl_b32 s3, s3, 3
s_add_u32 s26, s26, s3
M v[140:143], v[188:191], a[252:255], v[140:143]
M v[140:143], v[184:187], a[248:251], v[140:143]
ds_read_b64_tr_b16 a[84:85], v22 offset:24576
ds_read_b64_tr_b16 a[86:87], v22 offset:28672
M v[144:147], v[192:195], a[248:251], v[144:147]
M v[144:147], v[196:199], a[252:255], v[144:147]
ds_read_b64_tr_b16 a[88:89], v23 offset:16384
ds_read_b64_tr_b16 a[90:91], v23 offset:20480
M v[148:151], v[204:207], a[252:255], v[148:151]
M v[148:151], v[200:203], a[248:251], v[148:151]
ds_read_b64_tr_b16 a[92:93], v23 offset:24576
ds_read_b64_tr_b16 a[94:95], v23 offset:28672
M v[152:155], v[208:211], a[248:251], v[152:155]
M v[152:155], v[212:215], a[252:255], v[152:155]
M v[156:159], v[220:223], a[252:255], v[156:159]
M v[156:159], v[216:219], a[248:251], v[156:159]
s_waitcnt vmcnt(24) lgkmcnt(0)
s_barrier
M v[32:35], a[32:35], a[96:99], v[32:35]
s_add_u32 m0, s41, 16384
s_nop 0
buffer_load_dwordx4 v2, s[48:51], s26 offen offset:0 lds
M v[32:35], a[36:39], a[100:103], v[32:35]
M v[36:39], a[44:47], a[100:103], v[36:39]
ds_read_b64_tr_b16 v[160:161], v16 offset:32768
ds_read_b64_tr_b16 v[162:163], v16 offset:36864
M v[36:39], a[40:43], a[96:99], v[36:39]
M v[40:43], a[48:51], a[96:99], v[40:43]
buffer_load_dwordx4 v3, s[48:51], s26 offen offset:1024 lds
M v[40:43], a[52:55], a[100:103], v[40:43]
M v[44:47], a[60:63], a[100:103], v[44:47]
ds_read_b64_tr_b16 v[164:165], v16 offset:40960
ds_read_b64_tr_b16 v[166:167], v16 offset:45056
M v[44:47], a[56:59], a[96:99], v[44:47]
M v[48:51], a[64:67], a[96:99], v[48:51]
buffer_load_dwordx4 v4, s[48:51], s26 offen offset:2048 lds
M v[48:51], a[68:71], a[100:103], v[48:51]
M v[52:55], a[76:79], a[100:103], v[52:55]
ds_read_b64_tr_b16 v[168:169], v17 offset:32768
ds_read_b64_tr_b16 v[170:171], v17 offset:36864
M v[52:55], a[72:75], a[96:99], v[52:55]
M v[56:59], a[80:83], a[96:99], v[56:59]
buffer_load_dwordx4 v5, s[48:51], s26 offen offset:3072 lds
M v[56:59], a[84:87], a[100:103], v[56:59]
M v[60:63], a[92:95], a[100:103], v[60:63]
ds_read_b64_tr_b16 v[172:173], v17 offset:40960
ds_read_b64_tr_b16 v[174:175], v17 offset:45056
M v[60:63], a[88:91], a[96:99], v[60:63]
M v[64:67], a[32:35], a[104:107], v[64:67]
buffer_load_dwordx4 a[224:227], v1, s[44:47], s25 offen offset:0 sc1
M v[64:67], a[36:39], a[108:111], v[64:67]
M v[68:71], a[44:47], a[108:111], v[68:71]
ds_read_b64_tr_b16 v[176:177], v18 offset:32768
ds_read_b64_tr_b16 v[178:179], v18 offset:36864
M v[68:71], a[40:43], a[104:107], v[68:71]
M v[72:75], a[48:51], a[104:107], v[72:75]
buffer_load_dwordx4 a[228:231], v1, s[44:47], s25 offen offset:1024 sc1
M v[72:75], a[52:55], a[108:111], v[72:75]
M v[76:79], a[60:63], a[108:111], v[76:79]
ds_read_b64_tr_b16 v[180:181], v18 offset:40960
ds_read_b64_tr_b16 v[182:183], v18 offset:45056
M v[76:79], a[56:59], a[104:107], v[76:79]
M v[80:83], a[64:67], a[104:107], v[80:83]
buffer_load_dwordx4 a[232:235], v1, s[44:47], s25 offen offset:2048 sc1
M v[80:83], a[68:71], a[108:111], v[80:83]
M v[84:87], a[76:79], a[108:111], v[84:87]
ds_read_b64_tr_b16 v[184:185], v19 offset:32768
ds_read_b64_tr_b16 v[186:187], v19 offset:36864
M v[84:87], a[72:75], a[104:107], v[84:87]
M v[88:91], a[80:83], a[104:107], v[88:91]
buffer_load_dwordx4 a[236:239], v1, s[44:47], s25 offen offset:3072 sc1
M v[88:91], a[84:87], a[108:111], v[88:91]
M v[92:95], a[92:95], a[108:111], v[92:95]
M v[92:95], a[88:91], a[104:107], v[92:95]
ds_read_b64_tr_b16 v[188:189], v19 offset:40960
ds_read_b64_tr_b16 v[190:191], v19 offset:45056
M v[96:99], a[32:35], a[112:115], v[96:99]
M v[96:99], a[36:39], a[116:119], v[96:99]
s_add_u32 s63, s25, 4096
buffer_load_dwordx4 a[240:243], v1, s[44:47], s63 offen offset:0 sc1
M v[100:103], a[44:47], a[116:119], v[100:103]
M v[100:103], a[40:43], a[112:115], v[100:103]
ds_read_b64_tr_b16 v[192:193], v20 offset:32768
ds_read_b64_tr_b16 v[194:195], v20 offset:36864
M v[104:107], a[48:51], a[112:115], v[104:107]
M v[104:107], a[52:55], a[116:119], v[104:107]
buffer_load_dwordx4 a[244:247], v1, s[44:47], s63 offen offset:1024 sc1
M v[108:111], a[60:63], a[116:119], v[108:111]
M v[108:111], a[56:59], a[112:115], v[108:111]
ds_read_b64_tr_b16 v[196:197], v20 offset:40960
ds_read_b64_tr_b16 v[198:199], v20 offset:45056
M v[112:115], a[64:67], a[112:115], v[112:115]
M v[112:115], a[68:71], a[116:119], v[112:115]
buffer_load_dwordx4 a[248:251], v1, s[44:47], s63 offen offset:2048 sc1
M v[116:119], a[76:79], a[116:119], v[116:119]
M v[116:119], a[72:75], a[112:115], v[116:119]
ds_read_b64_tr_b16 v[200:201], v21 offset:32768
ds_read_b64_tr_b16 v[202:203], v21 offset:36864
M v[120:123], a[80:83], a[112:115], v[120:123]
M v[120:123], a[84:87], a[116:119], v[120:123]
buffer_load_dwordx4 a[252:255], v1, s[44:47], s63 offen offset:3072 sc1
M v[124:127], a[92:95], a[116:119], v[124:127]
M v[124:127], a[88:91], a[112:115], v[124:127]
ds_read_b64_tr_b16 v[204:205], v21 offset:40960
ds_read_b64_tr_b16 v[206:207], v21 offset:45056
M v[128:131], a[32:35], a[120:123], v[128:131]
M v[128:131], a[36:39], a[124:127], v[128:131]
s_sub_u32 s39, s39, 1
s_cmp_eq_u32 s39, 0
s_cselect_b32 s3, s64, s65
M v[132:135], a[44:47], a[124:127], v[132:135]
M v[132:135], a[40:43], a[120:123], v[132:135]
ds_read_b64_tr_b16 v[208:209], v22 offset:32768
ds_read_b64_tr_b16 v[210:211], v22 offset:36864
M v[136:139], a[48:51], a[120:123], v[136:139]
M v[136:139], a[52:55], a[124:127], v[136:139]
s_add_u32 s25, s25, s3
s_lshl_b32 s3, s3, 3
s_add_u32 s26, s26, s3
M v[140:143], a[60:63], a[124:127], v[140:143]
M v[140:143], a[56:59], a[120:123], v[140:143]
ds_read_b64_tr_b16 v[212:213], v22 offset:40960
ds_read_b64_tr_b16 v[214:215], v22 offset:45056
M v[144:147], a[64:67], a[120:123], v[144:147]
M v[144:147], a[68:71], a[124:127], v[144:147]
ds_read_b64_tr_b16 v[216:217], v23 offset:32768
ds_read_b64_tr_b16 v[218:219], v23 offset:36864
M v[148:151], a[76:79], a[124:127], v[148:151]
M v[148:151], a[72:75], a[120:123], v[148:151]
ds_read_b64_tr_b16 v[220:221], v23 offset:40960
ds_read_b64_tr_b16 v[222:223], v23 offset:45056
M v[152:155], a[80:83], a[120:123], v[152:155]
M v[152:155], a[84:87], a[124:127], v[152:155]
M v[156:159], a[92:95], a[124:127], v[156:159]
M v[156:159], a[88:91], a[120:123], v[156:159]
s_waitcnt vmcnt(24) lgkmcnt(0)
s_barrier
M v[32:35], v[160:163], a[128:131], v[32:35]
s_add_u32 m0, s41, 32768
s_nop 0
buffer_load_dwordx4 v2, s[48:51], s26 offen offset:0 lds
M v[32:35], v[164:167], a[132:135], v[32:35]
M v[36:39], v[172:175], a[132:135], v[36:39]
ds_read_b64_tr_b16 a[32:33], v16 offset:49152
ds_read_b64_tr_b16 a[34:35], v16 offset:53248
M v[36:39], v[168:171], a[128:131], v[36:39]
M v[40:43], v[176:179], a[128:131], v[40:43]
buffer_load_dwordx4 v3, s[48:51], s26 offen offset:1024 lds
M v[40:43], v[180:183], a[132:135], v[40:43]
M v[44:47], v[188:191], a[132:135], v[44:47]
ds_read_b64_tr_b16 a[36:37], v16 offset:57344
ds_read_b64_tr_b16 a[38:39], v16 offset:61440
M v[44:47], v[184:187], a[128:131], v[44:47]
M v[48:51], v[192:195], a[128:131], v[48:51]
buffer_load_dwordx4 v4, s[48:51], s26 offen offset:2048 lds
M v[48:51], v[196:199], a[132:135], v[48:51]
M v[52:55], v[204:207], a[132:135], v[52:55]
ds_read_b64_tr_b16 a[40:41], v17 offset:49152
ds_read_b64_tr_b16 a[42:43], v17 offset:53248
M v[52:55], v[200:203], a[128:131], v[52:55]
M v[56:59], v[208:211], a[128:131], v[56:59]
buffer_load_dwordx4 v5, s[48:51], s26 offen offset:3072 lds
M v[56:59], v[212:215], a[132:135], v[56:59]
M v[60:63], v[220:223], a[132:135], v[60:63]
ds_read_b64_tr_b16 a[44:45], v17 offset:57344
ds_read_b64_tr_b16 a[46:47], v17 offset:61440
M v[60:63], v[216:219], a[128:131], v[60:63]
M v[64:67], v[160:163], a[136:139], v[64:67]
buffer_load_dwordx4 a[96:99], v1, s[44:47], s25 offen offset:0 sc1
M v[64:67], v[164:167], a[140:143], v[64:67]
M v[68:71], v[172:175], a[140:143], v[68:71]
ds_read_b64_tr_b16 a[48:49], v18 offset:49152
ds_read_b64_tr_b16 a[50:51], v18 offset:53248
M v[68:71], v[168:171], a[136:139], v[68:71]
M v[72:75], v[176:179], a[136:139], v[72:75]
buffer_load_dwordx4 a[100:103], v1, s[44:47], s25 offen offset:1024 sc1
M v[72:75], v[180:183], a[140:143], v[72:75]
M v[76:79], v[188:191], a[140:143], v[76:79]
ds_read_b64_tr_b16 a[52:53], v18 offset:57344
ds_read_b64_tr_b16 a[54:55], v18 offset:61440
M v[76:79], v[184:187], a[136:139], v[76:79]
M v[80:83], v[192:195], a[136:139], v[80:83]
buffer_load_dwordx4 a[104:107], v1, s[44:47], s25 offen offset:2048 sc1
M v[80:83], v[196:199], a[140:143], v[80:83]
M v[84:87], v[204:207], a[140:143], v[84:87]
ds_read_b64_tr_b16 a[56:57], v19 offset:49152
ds_read_b64_tr_b16 a[58:59], v19 offset:53248
M v[84:87], v[200:203], a[136:139], v[84:87]
M v[88:91], v[208:211], a[136:139], v[88:91]
buffer_load_dwordx4 a[108:111], v1, s[44:47], s25 offen offset:3072 sc1
M v[88:91], v[212:215], a[140:143], v[88:91]
M v[92:95], v[220:223], a[140:143], v[92:95]
M v[92:95], v[216:219], a[136:139], v[92:95]
ds_read_b64_tr_b16 a[60:61], v19 offset:57344
ds_read_b64_tr_b16 a[62:63], v19 offset:61440
M v[96:99], v[160:163], a[144:147], v[96:99]
M v[96:99], v[164:167], a[148:151], v[96:99]
s_add_u32 s63, s25, 4096
buffer_load_dwordx4 a[112:115], v1, s[44:47], s63 offen offset:0 sc1
M v[100:103], v[172:175], a[148:151], v[100:103]
M v[100:103], v[168:171], a[144:147], v[100:103]
ds_read_b64_tr_b16 a[64:65], v20 offset:49152
ds_read_b64_tr_b16 a[66:67], v20 offset:53248
M v[104:107], v[176:179], a[144:147], v[104:107]
M v[104:107], v[180:183], a[148:151], v[104:107]
buffer_load_dwordx4 a[116:119], v1, s[44:47], s63 offen offset:1024 sc1
M v[108:111], v[188:191], a[148:151], v[108:111]
M v[108:111], v[184:187], a[144:147], v[108:111]
ds_read_b64_tr_b16 a[68:69], v20 offset:57344
ds_read_b64_tr_b16 a[70:71], v20 offset:61440
M v[112:115], v[192:195], a[144:147], v[112:115]
M v[112:115], v[196:199], a[148:151], v[112:115]
buffer_load_dwordx4 a[120:123], v1, s[44:47], s63 offen offset:2048 sc1
M v[116:119], v[204:207], a[148:151], v[116:119]
M v[116:119], v[200:203], a[144:147], v[116:119]
ds_read_b64_tr_b16 a[72:73], v21 offset:49152
ds_read_b64_tr_b16 a[74:75], v21 offset:53248
M v[120:123], v[208:211], a[144:147], v[120:123]
M v[120:123], v[212:215], a[148:151], v[120:123]
buffer_load_dwordx4 a[124:127], v1, s[44:47], s63 offen offset:3072 sc1
M v[124:127], v[220:223], a[148:151], v[124:127]
M v[124:127], v[216:219], a[144:147], v[124:127]
ds_read_b64_tr_b16 a[76:77], v21 offset:57344
ds_read_b64_tr_b16 a[78:79], v21 offset:61440
M v[128:131], v[160:163], a[152:155], v[128:131]
M v[128:131], v[164:167], a[156:159], v[128:131]
s_sub_u32 s39, s39, 1
s_cmp_eq_u32 s39, 0
s_cselect_b32 s3, s64, s65
M v[132:135], v[172:175], a[156:159], v[132:135]
M v[132:135], v[168:171], a[152:155], v[132:135]
ds_read_b64_tr_b16 a[80:81], v22 offset:49152
ds_read_b64_tr_b16 a[82:83], v22 offset:53248
M v[136:139], v[176:179], a[152:155], v[136:139]
M v[136:139], v[180:183], a[156:159], v[136:139]
s_add_u32 s25, s25, s3
s_lshl_b32 s3, s3, 3
s_add_u32 s26, s26, s3
M v[140:143], v[188:191], a[156:159], v[140:143]
M v[140:143], v[184:187], a[152:155], v[140:143]
ds_read_b64_tr_b16 a[84:85], v22 offset:57344
ds_read_b64_tr_b16 a[86:87], v22 offset:61440
M v[144:147], v[192:195], a[152:155], v[144:147]
M v[144:147], v[196:199], a[156:159], v[144:147]
ds_read_b64_tr_b16 a[88:89], v23 offset:49152
ds_read_b64_tr_b16 a[90:91], v23 offset:53248
M v[148:151], v[204:207], a[156:159], v[148:151]
M v[148:151], v[200:203], a[152:155], v[148:151]
ds_read_b64_tr_b16 a[92:93], v23 offset:57344
ds_read_b64_tr_b16 a[94:95], v23 offset:61440
M v[152:155], v[208:211], a[152:155], v[152:155]
M v[152:155], v[212:215], a[156:159], v[152:155]
M v[156:159], v[220:223], a[156:159], v[156:159]
M v[156:159], v[216:219], a[152:155], v[156:159]
s_waitcnt vmcnt(24) lgkmcnt(0)
s_barrier
M v[32:35], a[32:35], a[160:163], v[32:35]
s_add_u32 m0, s41, 49152
s_nop 0
buffer_load_dwordx4 v2, s[48:51], s26 offen offset:0 lds
M v[32:35], a[36:39], a[164:167], v[32:35]
M v[36:39], a[44:47], a[164:167], v[36:39]
ds_read_b64_tr_b16 v[160:161], v8 offset:0
ds_read_b64_tr_b16 v[162:163], v8 offset:4096
M v[36:39], a[40:43], a[160:163], v[36:39]
M v[40:43], a[48:51], a[160:163], v[40:43]
buffer_load_dwordx4 v3, s[48:51], s26 offen offset:1024 lds
M v[40:43], a[52:55], a[164:167], v[40:43]
M v[44:47], a[60:63], a[164:167], v[44:47]
ds_read_b64_tr_b16 v[164:165], v8 offset:8192
ds_read_b64_tr_b16 v[166:167], v8 offset:12288
M v[44:47], a[56:59], a[160:163], v[44:47]
M v[48:51], a[64:67], a[160:163], v[48:51]
buffer_load_dwordx4 v4, s[48:51], s26 offen offset:2048 lds
M v[48:51], a[68:71], a[164:167], v[48:51]
M v[52:55], a[76:79], a[164:167], v[52:55]
ds_read_b64_tr_b16 v[168:169], v9 offset:0
ds_read_b64_tr_b16 v[170:171], v9 offset:4096
M v[52:55], a[72:75], a[160:163], v[52:55]
M v[56:59], a[80:83], a[160:163], v[56:59]
buffer_load_dwordx4 v5, s[48:51], s26 offen offset:3072 lds
M v[56:59], a[84:87], a[164:167], v[56:59]
M v[60:63], a[92:95], a[164:167], v[60:63]
ds_read_b64_tr_b16 v[172:173], v9 offset:8192
ds_read_b64_tr_b16 v[174:175], v9 offset:12288
M v[60:63], a[88:91], a[160:163], v[60:63]
M v[64:67], a[32:35], a[168:171], v[64:67]
buffer_load_dwordx4 a[128:131], v1, s[44:47], s25 offen offset:0 sc1
M v[64:67], a[36:39], a[172:175], v[64:67]
M v[68:71], a[44:47], a[172:175], v[68:71]
ds_read_b64_tr_b16 v[176:177], v10 offset:0
ds_read_b64_tr_b16 v[178:179], v10 offset:4096
M v[68:71], a[40:43], a[168:171], v[68:71]
M v[72:75], a[48:51], a[168:171], v[72:75]
buffer_load_dwordx4 a[132:135], v1, s[44:47], s25 offen offset:1024 sc1
M v[72:75], a[52:55], a[172:175], v[72:75]
M v[76:79], a[60:63], a[172:175], v[76:79]
ds_read_b64_tr_b16 v[180:181], v10 offset:8192
ds_read_b64_tr_b16 v[182:183], v10 offset:12288
M v[76:79], a[56:59], a[168:171], v[76:79]
M v[80:83], a[64:67], a[168:171], v[80:83]
buffer_load_dwordx4 a[136:139], v1, s[44:47], s25 offen offset:2048 sc1
M v[80:83], a[68:71], a[172:175], v[80:83]
M v[84:87], a[76:79], a[172:175], v[84:87]
ds_read_b64_tr_b16 v[184:185], v11 offset:0
ds_read_b64_tr_b16 v[186:187], v11 offset:4096
M v[84:87], a[72:75], a[168:171], v[84:87]
M v[88:91], a[80:83], a[168:171], v[88:91]
buffer_load_dwordx4 a[140:143], v1, s[44:47], s25 offen offset:3072 sc1
M v[88:91], a[84:87], a[172:175], v[88:91]
M v[92:95], a[92:95], a[172:175], v[92:95]
M v[92:95], a[88:91], a[168:171], v[92:95]
ds_read_b64_tr_b16 v[188:189], v11 offset:8192
ds_read_b64_tr_b16 v[190:191], v11 offset:12288
M v[96:99], a[32:35], a[176:179], v[96:99]
M v[96:99], a[36:39], a[180:183], v[96:99]
s_add_u32 s63, s25, 4096
buffer_load_dwordx4 a[144:147], v1, s[44:47], s63 offen offset:0 sc1
M v[100:103], a[44:47], a[180:183], v[100:103]
M v[100:103], a[40:43], a[176:179], v[100:103]
ds_read_b64_tr_b16 v[192:193], v12 offset:0
ds_read_b64_tr_b16 v[194:195], v12 offset:4096
M v[104:107], a[48:51], a[176:179], v[104:107]
M v[104:107], a[52:55], a[180:183], v[104:107]
buffer_load_dwordx4 a[148:151], v1, s[44:47], s63 offen offset:1024 sc1
M v[108:111], a[60:63], a[180:183], v[108:111]
M v[108:111], a[56:59], a[176:179], v[108:111]
ds_read_b64_tr_b16 v[196:197], v12 offset:8192
ds_read_b64_tr_b16 v[198:199], v12 offset:12288
M v[112:115], a[64:67], a[176:179], v[112:115]
M v[112:115], a[68:71], a[180:183], v[112:115]
buffer_load_dwordx4 a[152:155], v1, s[44:47], s63 offen offset:2048 sc1
M v[116:119], a[76:79], a[180:183], v[116:119]
M v[116:119], a[72:75], a[176:179], v[116:119]
ds_read_b64_tr_b16 v[200:201], v13 offset:0
ds_read_b64_tr_b16 v[202:203], v13 offset:4096
M v[120:123], a[80:83], a[176:179], v[120:123]
M v[120:123], a[84:87], a[180:183], v[120:123]
buffer_load_dwordx4 a[156:159], v1, s[44:47], s63 offen offset:3072 sc1
M v[124:127], a[92:95], a[180:183], v[124:127]
M v[124:127], a[88:91], a[176:179], v[124:127]
ds_read_b64_tr_b16 v[204:205], v13 offset:8192
ds_read_b64_tr_b16 v[206:207], v13 offset:12288
M v[128:131], a[32:35], a[184:187], v[128:131]
M v[128:131], a[36:39], a[188:191], v[128:131]
s_sub_u32 s39, s39, 1
s_cmp_eq_u32 s39, 0
s_cselect_b32 s3, s64, s65
M v[132:135], a[44:47], a[188:191], v[132:135]
M v[132:135], a[40:43], a[184:187], v[132:135]
ds_read_b64_tr_b16 v[208:209], v14 offset:0
ds_read_b64_tr_b16 v[210:211], v14 offset:4096
M v[136:139], a[48:51], a[184:187], v[136:139]
M v[136:139], a[52:55], a[188:191], v[136:139]
s_add_u32 s25, s25, s3
s_lshl_b32 s3, s3, 3
s_add_u32 s26, s26, s3
M v[140:143], a[60:63], a[188:191], v[140:143]
M v[140:143], a[56:59], a[184:187], v[140:143]
ds_read_b64_tr_b16 v[212:213], v14 offset:8192
ds_read_b64_tr_b16 v[214:215], v14 offset:12288
M v[144:147], a[64:67], a[184:187], v[144:147]
M v[144:147], a[68:71], a[188:191], v[144:147]
ds_read_b64_tr_b16 v[216:217], v15 offset:0
ds_read_b64_tr_b16 v[218:219], v15 offset:4096
M v[148:151], a[76:79], a[188:191], v[148:151]
M v[148:151], a[72:75], a[184:187], v[148:151]
ds_read_b64_tr_b16 v[220:221], v15 offset:8192
ds_read_b64_tr_b16 v[222:223], v15 offset:12288
M v[152:155], a[80:83], a[184:187], v[152:155]
M v[152:155], a[84:87], a[188:191], v[152:155]
M v[156:159], a[92:95], a[188:191], v[156:159]
M v[156:159], a[88:91], a[184:187], v[156:159]
s_waitcnt vmcnt(24) lgkmcnt(0)
s_barrier
M v[32:35], v[160:163], a[192:195], v[32:35]
s_add_u32 m0, s41, 65536
s_nop 0
buffer_load_dwordx4 v2, s[48:51], s26 offen offset:0 lds
M v[32:35], v[164:167], a[196:199], v[32:35]
M v[36:39], v[172:175], a[196:199], v[36:39]
ds_read_b64_tr_b16 a[32:33], v8 offset:16384
ds_read_b64_tr_b16 a[34:35], v8 offset:20480
M v[36:39], v[168:171], a[192:195], v[36:39]
M v[40:43], v[176:179], a[192:195], v[40:43]
buffer_load_dwordx4 v3, s[48:51], s26 offen offset:1024 lds
M v[40:43], v[180:183], a[196:199], v[40:43]
M v[44:47], v[188:191], a[196:199], v[44:47]
ds_read_b64_tr_b16 a[36:37], v8 offset:24576
ds_read_b64_tr_b16 a[38:39], v8 offset:28672
M v[44:47], v[184:187], a[192:195], v[44:47]
M v[48:51], v[192:195], a[192:195], v[48:51]
buffer_load_dwordx4 v4, s[48:51], s26 offen offset:2048 lds
M v[48:51], v[196:199], a[196:199], v[48:51]
M v[52:55], v[204:207], a[196:199], v[52:55]
ds_read_b64_tr_b16 a[40:41], v9 offset:16384
ds_read_b64_tr_b16 a[42:43], v9 offset:20480
M v[52:55], v[200:203], a[192:195], v[52:55]
M v[56:59], v[208:211], a[192:195], v[56:59]
buffer_load_dwordx4 v5, s[48:51], s26 offen offset:3072 lds
M v[56:59], v[212:215], a[196:199], v[56:59]
M v[60:63], v[220:223], a[196:199], v[60:63]
ds_read_b64_tr_b16 a[44:45], v9 offset:24576
ds_read_b64_tr_b16 a[46:47], v9 offset:28672
M v[60:63], v[216:219], a[192:195], v[60:63]
M v[64:67], v[160:163], a[200:203], v[64:67]
buffer_load_dwordx4 a[160:163], v1, s[44:47], s25 offen offset:0 sc1
M v[64:67], v[164:167], a[204:207], v[64:67]
M v[68:71], v[172:175], a[204:207], v[68:71]
ds_read_b64_tr_b16 a[48:49], v10 offset:16384
ds_read_b64_tr_b16 a[50:51], v10 offset:20480
M v[68:71], v[168:171], a[200:203], v[68:71]
M v[72:75], v[176:179], a[200:203], v[72:75]
buffer_load_dwordx4 a[164:167], v1, s[44:47], s25 offen offset:1024 sc1
M v[72:75], v[180:183], a[204:207], v[72:75]
M v[76:79], v[188:191], a[204:207], v[76:79]
ds_read_b64_tr_b16 a[52:53], v10 offset:24576
ds_read_b64_tr_b16 a[54:55], v10 offset:28672
M v[76:79], v[184:187], a[200:203], v[76:79]
M v[80:83], v[192:195], a[200:203], v[80:83]
buffer_load_dwordx4 a[168:171], v1, s[44:47], s25 offen offset:2048 sc1
M v[80:83], v[196:199], a[204:207], v[80:83]
M v[84:87], v[204:207], a[204:207], v[84:87]
ds_read_b64_tr_b16 a[56:57], v11 offset:16384
ds_read_b64_tr_b16 a[58:59], v11 offset:20480
M v[84:87], v[200:203], a[200:203], v[84:87]
M v[88:91], v[208:211], a[200:203], v[88:91]
buffer_load_dwordx4 a[172:175], v1, s[44:47], s25 offen offset:3072 sc1
M v[88:91], v[212:215], a[204:207], v[88:91]
M v[92:95], v[220:223], a[204:207], v[92:95]
M v[92:95], v[216:219], a[200:203], v[92:95]
ds_read_b64_tr_b16 a[60:61], v11 offset:24576
ds_read_b64_tr_b16 a[62:63], v11 offset:28672
M v[96:99], v[160:163], a[208:211], v[96:99]
M v[96:99], v[164:167], a[212:215], v[96:99]
s_add_u32 s63, s25, 4096
buffer_load_dwordx4 a[176:179], v1, s[44:47], s63 offen offset:0 sc1
M v[100:103], v[172:175], a[212:215], v[100:103]
M v[100:103], v[168:171], a[208:211], v[100:103]
ds_read_b64_tr_b16 a[64:65], v12 offset:16384
ds_read_b64_tr_b16 a[66:67], v12 offset:20480
M v[104:107], v[176:179], a[208:211], v[104:107]
M v[104:107], v[180:183], a[212:215], v[104:107]
buffer_load_dwordx4 a[180:183], v1, s[44:47], s63 offen offset:1024 sc1
M v[108:111], v[188:191], a[212:215], v[108:111]
M v[108:111], v[184:187], a[208:211], v[108:111]
ds_read_b64_tr_b16 a[68:69], v12 offset:24576
ds_read_b64_tr_b16 a[70:71], v12 offset:28672
M v[112:115], v[192:195], a[208:211], v[112:115]
M v[112:115], v[196:199], a[212:215], v[112:115]
buffer_load_dwordx4 a[184:187], v1, s[44:47], s63 offen offset:2048 sc1
M v[116:119], v[204:207], a[212:215], v[116:119]
M v[116:119], v[200:203], a[208:211], v[116:119]
ds_read_b64_tr_b16 a[72:73], v13 offset:16384
ds_read_b64_tr_b16 a[74:75], v13 offset:20480
M v[120:123], v[208:211], a[208:211], v[120:123]
M v[120:123], v[212:215], a[212:215], v[120:123]
buffer_load_dwordx4 a[188:191], v1, s[44:47], s63 offen offset:3072 sc1
M v[124:127], v[220:223], a[212:215], v[124:127]
M v[124:127], v[216:219], a[208:211], v[124:127]
ds_read_b64_tr_b16 a[76:77], v13 offset:24576
ds_read_b64_tr_b16 a[78:79], v13 offset:28672
M v[128:131], v[160:163], a[216:219], v[128:131]
M v[128:131], v[164:167], a[220:223], v[128:131]
s_sub_u32 s39, s39, 1
s_cmp_eq_u32 s39, 0
s_cselect_b32 s3, s64, s65
M v[132:135], v[172:175], a[220:223], v[132:135]
M v[132:135], v[168:171], a[216:219], v[132:135]
ds_read_b64_tr_b16 a[80:81], v14 offset:16384
ds_read_b64_tr_b16 a[82:83], v14 offset:20480
M v[136:139], v[176:179], a[216:219], v[136:139]
M v[136:139], v[180:183], a[220:223], v[136:139]
s_add_u32 s25, s25, s3
s_lshl_b32 s3, s3, 3
s_add_u32 s26, s26, s3
M v[140:143], v[188:191], a[220:223], v[140:143]
M v[140:143], v[184:187], a[216:219], v[140:143]
ds_read_b64_tr_b16 a[84:85], v14 offset:24576
ds_read_b64_tr_b16 a[86:87], v14 offset:28672
M v[144:147], v[192:195], a[216:219], v[144:147]
M v[144:147], v[196:199], a[220:223], v[144:147]
ds_read_b64_tr_b16 a[88:89], v15 offset:16384
ds_read_b64_tr_b16 a[90:91], v15 offset:20480
M v[148:151], v[204:207], a[220:223], v[148:151]
M v[148:151], v[200:203], a[216:219], v[148:151]
ds_read_b64_tr_b16 a[92:93], v15 offset:24576
ds_read_b64_tr_b16 a[94:95], v15 offset:28672
M v[152:155], v[208:211], a[216:219], v[152:155]
M v[152:155], v[212:215], a[220:223], v[152:155]
M v[156:159], v[220:223], a[220:223], v[156:159]
M v[156:159], v[216:219], a[216:219], v[156:159]
s_waitcnt vmcnt(24) lgkmcnt(0)
s_barrier
M v[32:35], a[32:35], a[224:227], v[32:35]
s_add_u32 m0, s41, 81920
s_nop 0
buffer_load_dwordx4 v2, s[48:51], s26 offen offset:0 lds
M v[32:35], a[36:39], a[228:231], v[32:35]
M v[36:39], a[44:47], a[228:231], v[36:39]
ds_read_b64_tr_b16 v[160:161], v8 offset:32768
ds_read_b64_tr_b16 v[162:163], v8 offset:36864
M v[36:39], a[40:43], a[224:227], v[36:39]
M v[40:43], a[48:51], a[224:227], v[40:43]
buffer_load_dwordx4 v3, s[48:51], s26 offen offset:1024 lds
M v[40:43], a[52:55], a[228:231], v[40:43]
M v[44:47], a[60:63], a[228:231], v[44:47]
ds_read_b64_tr_b16 v[164:165], v8 offset:40960
ds_read_b64_tr_b16 v[166:167], v8 offset:45056
M v[44:47], a[56:59], a[224:227], v[44:47]
M v[48:51], a[64:67], a[224:227], v[48:51]
buffer_load_dwordx4 v4, s[48:51], s26 offen offset:2048 lds
M v[48:51], a[68:71], a[228:231], v[48:51]
M v[52:55], a[76:79], a[228:231], v[52:55]
ds_read_b64_tr_b16 v[168:169], v9 offset:32768
ds_read_b64_tr_b16 v[170:171], v9 offset:36864
M v[52:55], a[72:75], a[224:227], v[52:55]
M v[56:59], a[80:83], a[224:227], v[56:59]
buffer_load_dwordx4 v5, s[48:51], s26 offen offset:3072 lds
M v[56:59], a[84:87], a[228:231], v[56:59]
M v[60:63], a[92:95], a[228:231], v[60:63]
ds_read_b64_tr_b16 v[172:173], v9 offset:40960
ds_read_b64_tr_b16 v[174:175], v9 offset:45056
M v[60:63], a[88:91], a[224:227], v[60:63]
M v[64:67], a[32:35], a[232:235], v[64:67]
buffer_load_dwordx4 a[192:195], v1, s[44:47], s25 offen offset:0 sc1
M v[64:67], a[36:39], a[236:239], v[64:67]
M v[68:71], a[44:47], a[236:239], v[68:71]
ds_read_b64_tr_b16 v[176:177], v10 offset:32768
ds_read_b64_tr_b16 v[178:179], v10 offset:36864
M v[68:71], a[40:43], a[232:235], v[68:71]
M v[72:75], a[48:51], a[232:235], v[72:75]
buffer_load_dwordx4 a[196:199], v1, s[44:47], s25 offen offset:1024 sc1
M v[72:75], a[52:55], a[236:239], v[72:75]
M v[76:79], a[60:63], a[236:239], v[76:79]
ds_read_b64_tr_b16 v[180:181], v10 offset:40960
ds_read_b64_tr_b16 v[182:183], v10 offset:45056
M v[76:79], a[56:59], a[232:235], v[76:79]
M v[80:83], a[64:67], a[232:235], v[80:83]
buffer_load_dwordx4 a[200:203], v1, s[44:47], s25 offen offset:2048 sc1
M v[80:83], a[68:71], a[236:239], v[80:83]
M v[84:87], a[76:79], a[236:239], v[84:87]
ds_read_b64_tr_b16 v[184:185], v11 offset:32768
ds_read_b64_tr_b16 v[186:187], v11 offset:36864
M v[84:87], a[72:75], a[232:235], v[84:87]
M v[88:91], a[80:83], a[232:235], v[88:91]
buffer_load_dwordx4 a[204:207], v1, s[44:47], s25 offen offset:3072 sc1
M v[88:91], a[84:87], a[236:239], v[88:91]
M v[92:95], a[92:95], a[236:239], v[92:95]
M v[92:95], a[88:91], a[232:235], v[92:95]
ds_read_b64_tr_b16 v[188:189], v11 offset:40960
ds_read_b64_tr_b16 v[190:191], v11 offset:45056
M v[96:99], a[32:35], a[240:243], v[96:99]
M v[96:99], a[36:39], a[244:247], v[96:99]
s_add_u32 s63, s25, 4096
buffer_load_dwordx4 a[208:211], v1, s[44:47], s63 offen offset:0 sc1
M v[100:103], a[44:47], a[244:247], v[100:103]
M v[100:103], a[40:43], a[240:243], v[100:103]
ds_read_b64_tr_b16 v[192:193], v12 offset:32768
ds_read_b64_tr_b16 v[194:195], v12 offset:36864
M v[104:107], a[48:51], a[240:243], v[104:107]
M v[104:107], a[52:55], a[244:247], v[104:107]
buffer_load_dwordx4 a[212:215], v1, s[44:47], s63 offen offset:1024 sc1
M v[108:111], a[60:63], a[244:247], v[108:111]
M v[108:111], a[56:59], a[240:243], v[108:111]
ds_read_b64_tr_b16 v[196:197], v12 offset:40960
ds_read_b64_tr_b16 v[198:199], v12 offset:45056
M v[112:115], a[64:67], a[240:243], v[112:115]
M v[112:115], a[68:71], a[244:247], v[112:115]
buffer_load_dwordx4 a[216:219], v1, s[44:47], s63 offen offset:2048 sc1
M v[116:119], a[76:79], a[244:247], v[116:119]
M v[116:119], a[72:75], a[240:243], v[116:119]
ds_read_b64_tr_b16 v[200:201], v13 offset:32768
ds_read_b64_tr_b16 v[202:203], v13 offset:36864
M v[120:123], a[80:83], a[240:243], v[120:123]
M v[120:123], a[84:87], a[244:247], v[120:123]
buffer_load_dwordx4 a[220:223], v1, s[44:47], s63 offen offset:3072 sc1
M v[124:127], a[92:95], a[244:247], v[124:127]
M v[124:127], a[88:91], a[240:243], v[124:127]
ds_read_b64_tr_b16 v[204:205], v13 offset:40960
ds_read_b64_tr_b16 v[206:207], v13 offset:45056
M v[128:131], a[32:35], a[248:251], v[128:131]
M v[128:131], a[36:39], a[252:255], v[128:131]
s_sub_u32 s39, s39, 1
s_cmp_eq_u32 s39, 0
s_cselect_b32 s3, s64, s65
M v[132:135], a[44:47], a[252:255], v[132:135]
M v[132:135], a[40:43], a[248:251], v[132:135]
ds_read_b64_tr_b16 v[208:209], v14 offset:32768
ds_read_b64_tr_b16 v[210:211], v14 offset:36864
M v[136:139], a[48:51], a[248:251], v[136:139]
M v[136:139], a[52:55], a[252:255], v[136:139]
s_add_u32 s25, s25, s3
s_lshl_b32 s3, s3, 3
s_add_u32 s26, s26, s3
M v[140:143], a[60:63], a[252:255], v[140:143]
M v[140:143], a[56:59], a[248:251], v[140:143]
ds_read_b64_tr_b16 v[212:213], v14 offset:40960
ds_read_b64_tr_b16 v[214:215], v14 offset:45056
M v[144:147], a[64:67], a[248:251], v[144:147]
M v[144:147], a[68:71], a[252:255], v[144:147]
ds_read_b64_tr_b16 v[216:217], v15 offset:32768
ds_read_b64_tr_b16 v[218:219], v15 offset:36864
M v[148:151], a[76:79], a[252:255], v[148:151]
M v[148:151], a[72:75], a[248:251], v[148:151]
ds_read_b64_tr_b16 v[220:221], v15 offset:40960
ds_read_b64_tr_b16 v[222:223], v15 offset:45056
M v[152:155], a[80:83], a[248:251], v[152:155]
M v[152:155], a[84:87], a[252:255], v[152:155]
M v[156:159], a[92:95], a[252:255], v[156:159]
M v[156:159], a[88:91], a[248:251], v[156:159]
s_waitcnt vmcnt(24) lgkmcnt(0)
s_barrier
M v[32:35], v[160:163], a[96:99], v[32:35]
s_add_u32 m0, s41, 98304
s_nop 0
buffer_load_dwordx4 v2, s[48:51], s26 offen offset:0 lds
M v[32:35], v[164:167], a[100:103], v[32:35]
M v[36:39], v[172:175], a[100:103], v[36:39]
ds_read_b64_tr_b16 a[32:33], v8 offset:49152
ds_read_b64_tr_b16 a[34:35], v8 offset:53248
M v[36:39], v[168:171], a[96:99], v[36:39]
M v[40:43], v[176:179], a[96:99], v[40:43]
buffer_load_dwordx4 v3, s[48:51], s26 offen offset:1024 lds
M v[40:43], v[180:183], a[100:103], v[40:43]
M v[44:47], v[188:191], a[100:103], v[44:47]
ds_read_b64_tr_b16 a[36:37], v8 offset:57344
ds_read_b64_tr_b16 a[38:39], v8 offset:61440
M v[44:47], v[184:187], a[96:99], v[44:47]
M v[48:51], v[192:195], a[96:99], v[48:51]
buffer_load_dwordx4 v4, s[48:51], s26 offen offset:2048 lds
M v[48:51], v[196:199], a[100:103], v[48:51]
M v[52:55], v[204:207], a[100:103], v[52:55]
ds_read_b64_tr_b16 a[40:41], v9 offset:49152
ds_read_b64_tr_b16 a[42:43], v9 offset:53248
M v[52:55], v[200:203], a[96:99], v[52:55]
M v[56:59], v[208:211], a[96:99], v[56:59]
buffer_load_dwordx4 v5, s[48:51], s26 offen offset:3072 lds
M v[56:59], v[212:215], a[100:103], v[56:59]
M v[60:63], v[220:223], a[100:103], v[60:63]
ds_read_b64_tr_b16 a[44:45], v9 offset:57344
ds_read_b64_tr_b16 a[46:47], v9 offset:61440
M v[60:63], v[216:219], a[96:99], v[60:63]
M v[64:67], v[160:163], a[104:107], v[64:67]
buffer_load_dwordx4 a[224:227], v1, s[44:47], s25 offen offset:0 sc1
M v[64:67], v[164:167], a[108:111], v[64:67]
M v[68:71], v[172:175], a[108:111], v[68:71]
ds_read_b64_tr_b16 a[48:49], v10 offset:49152
ds_read_b64_tr_b16 a[50:51], v10 offset:53248
M v[68:71], v[168:171], a[104:107], v[68:71]
M v[72:75], v[176:179], a[104:107], v[72:75]
buffer_load_dwordx4 a[228:231], v1, s[44:47], s25 offen offset:1024 sc1
M v[72:75], v[180:183], a[108:111], v[72:75]
M v[76:79], v[188:191], a[108:111], v[76:79]
ds_read_b64_tr_b16 a[52:53], v10 offset:57344
ds_read_b64_tr_b16 a[54:55], v10 offset:61440
M v[76:79], v[184:187], a[104:107], v[76:79]
M v[80:83], v[192:195], a[104:107], v[80:83]
buffer_load_dwordx4 a[232:235], v1, s[44:47], s25 offen offset:2048 sc1
M v[80:83], v[196:199], a[108:111], v[80:83]
M v[84:87], v[204:207], a[108:111], v[84:87]
ds_read_b64_tr_b16 a[56:57], v11 offset:49152
ds_read_b64_tr_b16 a[58:59], v11 offset:53248
M v[84:87], v[200:203], a[104:107], v[84:87]
M v[88:91], v[208:211], a[104:107], v[88:91]
buffer_load_dwordx4 a[236:239], v1, s[44:47], s25 offen offset:3072 sc1
M v[88:91], v[212:215], a[108:111], v[88:91]
M v[92:95], v[220:223], a[108:111], v[92:95]
M v[92:95], v[216:219], a[104:107], v[92:95]
ds_read_b64_tr_b16 a[60:61], v11 offset:57344
ds_read_b64_tr_b16 a[62:63], v11 offset:61440
M v[96:99], v[160:163], a[112:115], v[96:99]
M v[96:99], v[164:167], a[116:119], v[96:99]
s_add_u32 s63, s25, 4096
buffer_load_dwordx4 a[240:243], v1, s[44:47], s63 offen offset:0 sc1
M v[100:103], v[172:175], a[116:119], v[100:103]
M v[100:103], v[168:171], a[112:115], v[100:103]
ds_read_b64_tr_b16 a[64:65], v12 offset:49152
ds_read_b64_tr_b16 a[66:67], v12 offset:53248
M v[104:107], v[176:179], a[112:115], v[104:107]
M v[104:107], v[180:183], a[116:119], v[104:107]
buffer_load_dwordx4 a[244:247], v1, s[44:47], s63 offen offset:1024 sc1
M v[108:111], v[188:191], a[116:119], v[108:111]
M v[108:111], v[184:187], a[112:115], v[108:111]
ds_read_b64_tr_b16 a[68:69], v12 offset:57344
ds_read_b64_tr_b16 a[70:71], v12 offset:61440
M v[112:115], v[192:195], a[112:115], v[112:115]
M v[112:115], v[196:199], a[116:119], v[112:115]
buffer_load_dwordx4 a[248:251], v1, s[44:47], s63 offen offset:2048 sc1
M v[116:119], v[204:207], a[116:119], v[116:119]
M v[116:119], v[200:203], a[112:115], v[116:119]
ds_read_b64_tr_b16 a[72:73], v13 offset:49152
ds_read_b64_tr_b16 a[74:75], v13 offset:53248
M v[120:123], v[208:211], a[112:115], v[120:123]
M v[120:123], v[212:215], a[116:119], v[120:123]
buffer_load_dwordx4 a[252:255], v1, s[44:47], s63 offen offset:3072 sc1
M v[124:127], v[220:223], a[116:119], v[124:127]
M v[124:127], v[216:219], a[112:115], v[124:127]
ds_read_b64_tr_b16 a[76:77], v13 offset:57344
ds_read_b64_tr_b16 a[78:79], v13 offset:61440
M v[128:131], v[160:163], a[120:123], v[128:131]
M v[128:131], v[164:167], a[124:127], v[128:131]
s_sub_u32 s39, s39, 1
s_cmp_eq_u32 s39, 0
s_cselect_b32 s3, s64, s65
M v[132:135], v[172:175], a[124:127], v[132:135]
M v[132:135], v[168:171], a[120:123], v[132:135]
ds_read_b64_tr_b16 a[80:81], v14 offset:49152
ds_read_b64_tr_b16 a[82:83], v14 offset:53248
M v[136:139], v[176:179], a[120:123], v[136:139]
M v[136:139], v[180:183], a[124:127], v[136:139]
s_add_u32 s25, s25, s3
s_lshl_b32 s3, s3, 3
s_add_u32 s26, s26, s3
M v[140:143], v[188:191], a[124:127], v[140:143]
M v[140:143], v[184:187], a[120:123], v[140:143]
ds_read_b64_tr_b16 a[84:85], v14 offset:57344
ds_read_b64_tr_b16 a[86:87], v14 offset:61440
M v[144:147], v[192:195], a[120:123], v[144:147]
M v[144:147], v[196:199], a[124:127], v[144:147]
ds_read_b64_tr_b16 a[88:89], v15 offset:49152
ds_read_b64_tr_b16 a[90:91], v15 offset:53248
M v[148:151], v[204:207], a[124:127], v[148:151]
M v[148:151], v[200:203], a[120:123], v[148:151]
ds_read_b64_tr_b16 a[92:93], v15 offset:57344
ds_read_b64_tr_b16 a[94:95], v15 offset:61440
M v[152:155], v[208:211], a[120:123], v[152:155]
M v[152:155], v[212:215], a[124:127], v[152:155]
M v[156:159], v[220:223], a[124:127], v[156:159]
M v[156:159], v[216:219], a[120:123], v[156:159]
s_waitcnt vmcnt(24) lgkmcnt(0)
s_barrier
M v[32:35], a[32:35], a[128:131], v[32:35]
s_add_u32 m0, s41, 114688
s_nop 0
buffer_load_dwordx4 v2, s[48:51], s26 offen offset:0 lds
M v[32:35], a[36:39], a[132:135], v[32:35]
M v[36:39], a[44:47], a[132:135], v[36:39]
ds_read_b64_tr_b16 v[160:161], v16 offset:0
ds_read_b64_tr_b16 v[162:163], v16 offset:4096
M v[36:39], a[40:43], a[128:131], v[36:39]
M v[40:43], a[48:51], a[128:131], v[40:43]
buffer_load_dwordx4 v3, s[48:51], s26 offen offset:1024 lds
M v[40:43], a[52:55], a[132:135], v[40:43]
M v[44:47], a[60:63], a[132:135], v[44:47]
ds_read_b64_tr_b16 v[164:165], v16 offset:8192
ds_read_b64_tr_b16 v[166:167], v16 offset:12288
M v[44:47], a[56:59], a[128:131], v[44:47]
M v[48:51], a[64:67], a[128:131], v[48:51]
buffer_load_dwordx4 v4, s[48:51], s26 offen offset:2048 lds
M v[48:51], a[68:71], a[132:135], v[48:51]
M v[52:55], a[76:79], a[132:135], v[52:55]
ds_read_b64_tr_b16 v[168:169], v17 offset:0
ds_read_b64_tr_b16 v[170:171], v17 offset:4096
M v[52:55], a[72:75], a[128:131], v[52:55]
M v[56:59], a[80:83], a[128:131], v[56:59]
buffer_load_dwordx4 v5, s[48:51], s26 offen offset:3072 lds
M v[56:59], a[84:87], a[132:135], v[56:59]
M v[60:63], a[92:95], a[132:135], v[60:63]
ds_read_b64_tr_b16 v[172:173], v17 offset:8192
ds_read_b64_tr_b16 v[174:175], v17 offset:12288
M v[60:63], a[88:91], a[128:131], v[60:63]
M v[64:67], a[32:35], a[136:139], v[64:67]
buffer_load_dwordx4 a[96:99], v1, s[44:47], s25 offen offset:0 sc1
M v[64:67], a[36:39], a[140:143], v[64:67]
M v[68:71], a[44:47], a[140:143], v[68:71]
ds_read_b64_tr_b16 v[176:177], v18 offset:0
ds_read_b64_tr_b16 v[178:179], v18 offset:4096
M v[68:71], a[40:43], a[136:139], v[68:71]
M v[72:75], a[48:51], a[136:139], v[72:75]
buffer_load_dwordx4 a[100:103], v1, s[44:47], s25 offen offset:1024 sc1
M v[72:75], a[52:55], a[140:143], v[72:75]
M v[76:79], a[60:63], a[140:143], v[76:79]
ds_read_b64_tr_b16 v[180:181], v18 offset:8192
ds_read_b64_tr_b16 v[182:183], v18 offset:12288
M v[76:79], a[56:59], a[136:139], v[76:79]
M v[80:83], a[64:67], a[136:139], v[80:83]
buffer_load_dwordx4 a[104:107], v1, s[44:47], s25 offen offset:2048 sc1
M v[80:83], a[68:71], a[140:143], v[80:83]
M v[84:87], a[76:79], a[140:143], v[84:87]
ds_read_b64_tr_b16 v[184:185], v19 offset:0
ds_read_b64_tr_b16 v[186:187], v19 offset:4096
M v[84:87], a[72:75], a[136:139], v[84:87]
M v[88:91], a[80:83], a[136:139], v[88:91]
buffer_load_dwordx4 a[108:111], v1, s[44:47], s25 offen offset:3072 sc1
M v[88:91], a[84:87], a[140:143], v[88:91]
M v[92:95], a[92:95], a[140:143], v[92:95]
M v[92:95], a[88:91], a[136:139], v[92:95]
ds_read_b64_tr_b16 v[188:189], v19 offset:8192
ds_read_b64_tr_b16 v[190:191], v19 offset:12288
M v[96:99], a[32:35], a[144:147], v[96:99]
M v[96:99], a[36:39], a[148:151], v[96:99]
s_add_u32 s63, s25, 4096
buffer_load_dwordx4 a[112:115], v1, s[44:47], s63 offen offset:0 sc1
M v[100:103], a[44:47], a[148:151], v[100:103]
M v[100:103], a[40:43], a[144:147], v[100:103]
ds_read_b64_tr_b16 v[192:193], v20 offset:0
ds_read_b64_tr_b16 v[194:195], v20 offset:4096
M v[104:107], a[48:51], a[144:147], v[104:107]
M v[104:107], a[52:55], a[148:151], v[104:107]
buffer_load_dwordx4 a[116:119], v1, s[44:47], s63 offen offset:1024 sc1
M v[108:111], a[60:63], a[148:151], v[108:111]
M v[108:111], a[56:59], a[144:147], v[108:111]
ds_read_b64_tr_b16 v[196:197], v20 offset:8192
ds_read_b64_tr_b16 v[198:199], v20 offset:12288
M v[112:115], a[64:67], a[144:147], v[112:115]
M v[112:115], a[68:71], a[148:151], v[112:115]
buffer_load_dwordx4 a[120:123], v1, s[44:47], s63 offen offset:2048 sc1
M v[116:119], a[76:79], a[148:151], v[116:119]
M v[116:119], a[72:75], a[144:147], v[116:119]
ds_read_b64_tr_b16 v[200:201], v21 offset:0
ds_read_b64_tr_b16 v[202:203], v21 offset:4096
M v[120:123], a[80:83], a[144:147], v[120:123]
M v[120:123], a[84:87], a[148:151], v[120:123]
buffer_load_dwordx4 a[124:127], v1, s[44:47], s63 offen offset:3072 sc1
M v[124:127], a[92:95], a[148:151], v[124:127]
M v[124:127], a[88:91], a[144:147], v[124:127]
ds_read_b64_tr_b16 v[204:205], v21 offset:8192
ds_read_b64_tr_b16 v[206:207], v21 offset:12288
M v[128:131], a[32:35], a[152:155], v[128:131]
M v[128:131], a[36:39], a[156:159], v[128:131]
s_sub_u32 s39, s39, 1
s_cmp_eq_u32 s39, 0
s_cselect_b32 s3, s64, s65
M v[132:135], a[44:47], a[156:159], v[132:135]
M v[132:135], a[40:43], a[152:155], v[132:135]
ds_read_b64_tr_b16 v[208:209], v22 offset:0
ds_read_b64_tr_b16 v[210:211], v22 offset:4096
M v[136:139], a[48:51], a[152:155], v[136:139]
M v[136:139], a[52:55], a[156:159], v[136:139]
s_add_u32 s25, s25, s3
s_lshl_b32 s3, s3, 3
s_add_u32 s26, s26, s3
M v[140:143], a[60:63], a[156:159], v[140:143]
M v[140:143], a[56:59], a[152:155], v[140:143]
ds_read_b64_tr_b16 v[212:213], v22 offset:8192
ds_read_b64_tr_b16 v[214:215], v22 offset:12288
M v[144:147], a[64:67], a[152:155], v[144:147]
M v[144:147], a[68:71], a[156:159], v[144:147]
ds_read_b64_tr_b16 v[216:217], v23 offset:0
ds_read_b64_tr_b16 v[218:219], v23 offset:4096
M v[148:151], a[76:79], a[156:159], v[148:151]
M v[148:151], a[72:75], a[152:155], v[148:151]
ds_read_b64_tr_b16 v[220:221], v23 offset:8192
ds_read_b64_tr_b16 v[222:223], v23 offset:12288
M v[152:155], a[80:83], a[152:155], v[152:155]
M v[152:155], a[84:87], a[156:159], v[152:155]
M v[156:159], a[92:95], a[156:159], v[156:159]
M v[156:159], a[88:91], a[152:155], v[156:159]
s_waitcnt vmcnt(24) lgkmcnt(0)
s_barrier
M v[32:35], v[160:163], a[160:163], v[32:35]
s_mov_b64 s[44:45], s[34:35]
s_mov_b32 s46, 4194304
s_mov_b64 s[48:49], s[36:37]
s_mov_b32 s50, 2097152
s_mov_b32 s25, s32
s_mov_b32 s26, s33
s_add_u32 m0, s42, 0
s_nop 0
buffer_load_dwordx4 v6, s[48:51], s26 offen offset:0 lds
M v[32:35], v[164:167], a[164:167], v[32:35]
M v[36:39], v[172:175], a[164:167], v[36:39]
ds_read_b64_tr_b16 a[32:33], v16 offset:16384
ds_read_b64_tr_b16 a[34:35], v16 offset:20480
M v[36:39], v[168:171], a[160:163], v[36:39]
M v[40:43], v[176:179], a[160:163], v[40:43]
M v[40:43], v[180:183], a[164:167], v[40:43]
buffer_load_dwordx4 v7, s[48:51], s26 offen offset:1024 lds
M v[44:47], v[188:191], a[164:167], v[44:47]
M v[44:47], v[184:187], a[160:163], v[44:47]
M v[48:51], v[192:195], a[160:163], v[48:51]
ds_read_b64_tr_b16 a[36:37], v16 offset:24576
ds_read_b64_tr_b16 a[38:39], v16 offset:28672
M v[48:51], v[196:199], a[164:167], v[48:51]
M v[52:55], v[204:207], a[164:167], v[52:55]
buffer_load_dwordx4 a[128:131], v1, s[44:47], s25 offen offset:0 sc1
M v[52:55], v[200:203], a[160:163], v[52:55]
M v[56:59], v[208:211], a[160:163], v[56:59]
M v[56:59], v[212:215], a[164:167], v[56:59]
ds_read_b64_tr_b16 a[40:41], v17 offset:16384
ds_read_b64_tr_b16 a[42:43], v17 offset:20480
M v[60:63], v[220:223], a[164:167], v[60:63]
M v[60:63], v[216:219], a[160:163], v[60:63]
M v[64:67], v[160:163], a[168:171], v[64:67]
buffer_load_dwordx4 a[132:135], v1, s[44:47], s25 offen offset:1024 sc1
M v[64:67], v[164:167], a[172:175], v[64:67]
M v[68:71], v[172:175], a[172:175], v[68:71]
ds_read_b64_tr_b16 a[44:45], v17 offset:24576
ds_read_b64_tr_b16 a[46:47], v17 offset:28672
M v[68:71], v[168:171], a[168:171], v[68:71]
M v[72:75], v[176:179], a[168:171], v[72:75]
M v[72:75], v[180:183], a[172:175], v[72:75]
buffer_load_dwordx4 a[136:139], v1, s[44:47], s25 offen offset:2048 sc1
M v[76:79], v[188:191], a[172:175], v[76:79]
M v[76:79], v[184:187], a[168:171], v[76:79]
M v[80:83], v[192:195], a[168:171], v[80:83]
ds_read_b64_tr_b16 a[48:49], v18 offset:16384
ds_read_b64_tr_b16 a[50:51], v18 offset:20480
M v[80:83], v[196:199], a[172:175], v[80:83]
M v[84:87], v[204:207], a[172:175], v[84:87]
buffer_load_dwordx4 a[140:143], v1, s[44:47], s25 offen offset:3072 sc1
M v[84:87], v[200:203], a[168:171], v[84:87]
M v[88:91], v[208:211], a[168:171], v[88:91]
M v[88:91], v[212:215], a[172:175], v[88:91]
ds_read_b64_tr_b16 a[52:53], v18 offset:24576
ds_read_b64_tr_b16 a[54:55], v18 offset:28672
M v[92:95], v[220:223], a[172:175], v[92:95]
M v[92:95], v[216:219], a[168:171], v[92:95]
M v[96:99], v[160:163], a[176:179], v[96:99]
s_add_u32 s25, s25, 16384
s_add_u32 s26, s26, 131072
M v[96:99], v[164:167], a[180:183], v[96:99]
M v[100:103], v[172:175], a[180:183], v[100:103]
M v[100:103], v[168:171], a[176:179], v[100:103]
ds_read_b64_tr_b16 a[56:57], v19 offset:16384
ds_read_b64_tr_b16 a[58:59], v19 offset:20480
M v[104:107], v[176:179], a[176:179], v[104:107]
M v[104:107], v[180:183], a[180:183], v[104:107]
ds_read_b64_tr_b16 a[60:61], v19 offset:24576
ds_read_b64_tr_b16 a[62:63], v19 offset:28672
M v[108:111], v[188:191], a[180:183], v[108:111]
M v[108:111], v[184:187], a[176:179], v[108:111]
M v[112:115], v[192:195], a[176:179], v[112:115]
ds_read_b64_tr_b16 a[64:65], v20 offset:16384
ds_read_b64_tr_b16 a[66:67], v20 offset:20480
M v[112:115], v[196:199], a[180:183], v[112:115]
M v[116:119], v[204:207], a[180:183], v[116:119]
M v[116:119], v[200:203], a[176:179], v[116:119]
ds_read_b64_tr_b16 a[68:69], v20 offset:24576
ds_read_b64_tr_b16 a[70:71], v20 offset:28672
M v[120:123], v[208:211], a[176:179], v[120:123]
M v[120:123], v[212:215], a[180:183], v[120:123]
ds_read_b64_tr_b16 a[72:73], v21 offset:16384
ds_read_b64_tr_b16 a[74:75], v21 offset:20480
M v[124:127], v[220:223], a[180:183], v[124:127]
M v[124:127], v[216:219], a[176:179], v[124:127]
M v[128:131], v[160:163], a[184:187], v[128:131]
ds_read_b64_tr_b16 a[76:77], v21 offset:24576
ds_read_b64_tr_b16 a[78:79], v21 offset:28672
M v[128:131], v[164:167], a[188:191], v[128:131]
M v[132:135], v[172:175], a[188:191], v[132:135]
M v[132:135], v[168:171], a[184:187], v[132:135]
ds_read_b64_tr_b16 a[80:81], v22 offset:16384
ds_read_b64_tr_b16 a[82:83], v22 offset:20480
M v[136:139], v[176:179], a[184:187], v[136:139]
M v[136:139], v[180:183], a[188:191], v[136:139]
ds_read_b64_tr_b16 a[84:85], v22 offset:24576
ds_read_b64_tr_b16 a[86:87], v22 offset:28672
M v[140:143], v[188:191], a[188:191], v[140:143]
M v[140:143], v[184:187], a[184:187], v[140:143]
M v[144:147], v[192:195], a[184:187], v[144:147]
ds_read_b64_tr_b16 a[88:89], v23 offset:16384
ds_read_b64_tr_b16 a[90:91], v23 offset:20480
M v[144:147], v[196:199], a[188:191], v[144:147]
M v[148:151], v[204:207], a[188:191], v[148:151]
M v[148:151], v[200:203], a[184:187], v[148:151]
ds_read_b64_tr_b16 a[92:93], v23 offset:24576
ds_read_b64_tr_b16 a[94:95], v23 offset:28672
M v[152:155], v[208:211], a[184:187], v[152:155]
M v[152:155], v[212:215], a[188:191], v[152:155]
M v[156:159], v[220:223], a[188:191], v[156:159]
M v[156:159], v[216:219], a[184:187], v[156:159]
s_waitcnt vmcnt(18) lgkmcnt(0)
s_barrier
M v[32:35], a[32:35], a[192:195], v[32:35]
s_add_u32 m0, s42, 16384
s_nop 0
buffer_load_dwordx4 v6, s[48:51], s26 offen offset:0 lds
M v[32:35], a[36:39], a[196:199], v[32:35]
M v[36:39], a[44:47], a[196:199], v[36:39]
ds_read_b64_tr_b16 v[160:161], v16 offset:32768
ds_read_b64_tr_b16 v[162:163], v16 offset:36864
M v[36:39], a[40:43], a[192:195], v[36:39]
M v[40:43], a[48:51], a[192:195], v[40:43]
M v[40:43], a[52:55], a[196:199], v[40:43]
buffer_load_dwordx4 v7, s[48:51], s26 offen offset:1024 lds
M v[44:47], a[60:63], a[196:199], v[44:47]
M v[44:47], a[56:59], a[192:195], v[44:47]
M v[48:51], a[64:67], a[192:195], v[48:51]
ds_read_b64_tr_b16 v[164:165], v16 offset:40960
ds_read_b64_tr_b16 v[166:167], v16 offset:45056
M v[48:51], a[68:71], a[196:199], v[48:51]
M v[52:55], a[76:79], a[196:199], v[52:55]
buffer_load_dwordx4 a[160:163], v1, s[44:47], s25 offen offset:0 sc1
M v[52:55], a[72:75], a[192:195], v[52:55]
M v[56:59], a[80:83], a[192:195], v[56:59]
M v[56:59], a[84:87], a[196:199], v[56:59]
ds_read_b64_tr_b16 v[168:169], v17 offset:32768
ds_read_b64_tr_b16 v[170:171], v17 offset:36864
M v[60:63], a[92:95], a[196:199], v[60:63]
M v[60:63], a[88:91], a[192:195], v[60:63]
M v[64:67], a[32:35], a[200:203], v[64:67]
buffer_load_dwordx4 a[164:167], v1, s[44:47], s25 offen offset:1024 sc1
M v[64:67], a[36:39], a[204:207], v[64:67]
M v[68:71], a[44:47], a[204:207], v[68:71]
ds_read_b64_tr_b16 v[172:173], v17 offset:40960
ds_read_b64_tr_b16 v[174:175], v17 offset:45056
M v[68:71], a[40:43], a[200:203], v[68:71]
M v[72:75], a[48:51], a[200:203], v[72:75]
M v[72:75], a[52:55], a[204:207], v[72:75]
buffer_load_dwordx4 a[168:171], v1, s[44:47], s25 offen offset:2048 sc1
M v[76:79], a[60:63], a[204:207], v[76:79]
M v[76:79], a[56:59], a[200:203], v[76:79]
M v[80:83], a[64:67], a[200:203], v[80:83]
ds_read_b64_tr_b16 v[176:177], v18 offset:32768
ds_read_b64_tr_b16 v[178:179], v18 offset:36864
M v[80:83], a[68:71], a[204:207], v[80:83]
M v[84:87], a[76:79], a[204:207], v[84:87]
buffer_load_dwordx4 a[172:175], v1, s[44:47], s25 offen offset:3072 sc1
M v[84:87], a[72:75], a[200:203], v[84:87]
M v[88:91], a[80:83], a[200:203], v[88:91]
M v[88:91], a[84:87], a[204:207], v[88:91]
ds_read_b64_tr_b16 v[180:181], v18 offset:40960
ds_read_b64_tr_b16 v[182:183], v18 offset:45056
M v[92:95], a[92:95], a[204:207], v[92:95]
M v[92:95], a[88:91], a[200:203], v[92:95]
M v[96:99], a[32:35], a[208:211], v[96:99]
s_add_u32 s25, s25, 16384
s_add_u32 s26, s26, 131072
M v[96:99], a[36:39], a[212:215], v[96:99]
M v[100:103], a[44:47], a[212:215], v[100:103]
M v[100:103], a[40:43], a[208:211], v[100:103]
ds_read_b64_tr_b16 v[184:185], v19 offset:32768
ds_read_b64_tr_b16 v[186:187], v19 offset:36864
M v[104:107], a[48:51], a[208:211], v[104:107]
M v[104:107], a[52:55], a[212:215], v[104:107]
ds_read_b64_tr_b16 v[188:189], v19 offset:40960
ds_read_b64_tr_b16 v[190:191], v19 offset:45056
M v[108:111], a[60:63], a[212:215], v[108:111]
M v[108:111], a[56:59], a[208:211], v[108:111]
M v[112:115], a[64:67], a[208:211], v[112:115]
ds_read_b64_tr_b16 v[192:193], v20 offset:32768
ds_read_b64_tr_b16 v[194:195], v20 offset:36864
M v[112:115], a[68:71], a[212:215], v[112:115]
M v[116:119], a[76:79], a[212:215], v[116:119]
M v[116:119], a[72:75], a[208:211], v[116:119]
ds_read_b64_tr_b16 v[196:197], v20 offset:40960
ds_read_b64_tr_b16 v[198:199], v20 offset:45056
M v[120:123], a[80:83], a[208:211], v[120:123]
M v[120:123], a[84:87], a[212:215], v[120:123]
ds_read_b64_tr_b16 v[200:201], v21 offset:32768
ds_read_b64_tr_b16 v[202:203], v21 offset:36864
M v[124:127], a[92:95], a[212:215], v[124:127]
M v[124:127], a[88:91], a[208:211], v[124:127]
M v[128:131], a[32:35], a[216:219], v[128:131]
ds_read_b64_tr_b16 v[204:205], v21 offset:40960
ds_read_b64_tr_b16 v[206:207], v21 offset:45056
M v[128:131], a[36:39], a[220:223], v[128:131]
M v[132:135], a[44:47], a[220:223], v[132:135]
M v[132:135], a[40:43], a[216:219], v[132:135]
ds_read_b64_tr_b16 v[208:209], v22 offset:32768
ds_read_b64_tr_b16 v[210:211], v22 offset:36864
M v[136:139], a[48:51], a[216:219], v[136:139]
M v[136:139], a[52:55], a[220:223], v[136:139]
ds_read_b64_tr_b16 v[212:213], v22 offset:40960
ds_read_b64_tr_b16 v[214:215], v22 offset:45056
M v[140:143], a[60:63], a[220:223], v[140:143]
M v[140:143], a[56:59], a[216:219], v[140:143]
M v[144:147], a[64:67], a[216:219], v[144:147]
ds_read_b64_tr_b16 v[216:217], v23 offset:32768
ds_read_b64_tr_b16 v[218:219], v23 offset:36864
M v[144:147], a[68:71], a[220:223], v[144:147]
M v[148:151], a[76:79], a[220:223], v[148:151]
M v[148:151], a[72:75], a[216:219], v[148:151]
ds_read_b64_tr_b16 v[220:221], v23 offset:40960
ds_read_b64_tr_b16 v[222:223], v23 offset:45056
M v[152:155], a[80:83], a[216:219], v[152:155]
M v[152:155], a[84:87], a[220:223], v[152:155]
M v[156:159], a[92:95], a[220:223], v[156:159]
M v[156:159], a[88:91], a[216:219], v[156:159]
s_waitcnt vmcnt(12) lgkmcnt(0)
s_barrier
M v[32:35], v[160:163], a[224:227], v[32:35]
s_add_u32 m0, s42, 32768
s_nop 0
buffer_load_dwordx4 v6, s[48:51], s26 offen offset:0 lds
M v[32:35], v[164:167], a[228:231], v[32:35]
M v[36:39], v[172:175], a[228:231], v[36:39]
ds_read_b64_tr_b16 a[32:33], v16 offset:49152
ds_read_b64_tr_b16 a[34:35], v16 offset:53248
M v[36:39], v[168:171], a[224:227], v[36:39]
M v[40:43], v[176:179], a[224:227], v[40:43]
M v[40:43], v[180:183], a[228:231], v[40:43]
buffer_load_dwordx4 v7, s[48:51], s26 offen offset:1024 lds
M v[44:47], v[188:191], a[228:231], v[44:47]
M v[44:47], v[184:187], a[224:227], v[44:47]
M v[48:51], v[192:195], a[224:227], v[48:51]
ds_read_b64_tr_b16 a[36:37], v16 offset:57344
ds_read_b64_tr_b16 a[38:39], v16 offset:61440
M v[48:51], v[196:199], a[228:231], v[48:51]
M v[52:55], v[204:207], a[228:231], v[52:55]
buffer_load_dwordx4 a[192:195], v1, s[44:47], s25 offen offset:0 sc1
M v[52:55], v[200:203], a[224:227], v[52:55]
M v[56:59], v[208:211], a[224:227], v[56:59]
M v[56:59], v[212:215], a[228:231], v[56:59]
ds_read_b64_tr_b16 a[40:41], v17 offset:49152
ds_read_b64_tr_b16 a[42:43], v17 offset:53248
M v[60:63], v[220:223], a[228:231], v[60:63]
M v[60:63], v[216:219], a[224:227], v[60:63]
M v[64:67], v[160:163], a[232:235], v[64:67]
buffer_load_dwordx4 a[196:199], v1, s[44:47], s25 offen offset:1024 sc1
M v[64:67], v[164:167], a[236:239], v[64:67]
M v[68:71], v[172:175], a[236:239], v[68:71]
ds_read_b64_tr_b16 a[44:45], v17 offset:57344
ds_read_b64_tr_b16 a[46:47], v17 offset:61440
M v[68:71], v[168:171], a[232:235], v[68:71]
M v[72:75], v[176:179], a[232:235], v[72:75]
M v[72:75], v[180:183], a[236:239], v[72:75]
buffer_load_dwordx4 a[200:203], v1, s[44:47], s25 offen offset:2048 sc1
M v[76:79], v[188:191], a[236:239], v[76:79]
M v[76:79], v[184:187], a[232:235], v[76:79]
M v[80:83], v[192:195], a[232:235], v[80:83]
ds_read_b64_tr_b16 a[48:49], v18 offset:49152
ds_read_b64_tr_b16 a[50:51], v18 offset:53248
M v[80:83], v[196:199], a[236:239], v[80:83]
M v[84:87], v[204:207], a[236:239], v[84:87]
buffer_load_dwordx4 a[204:207], v1, s[44:47], s25 offen offset:3072 sc1
M v[84:87], v[200:203], a[232:235], v[84:87]
M v[88:91], v[208:211], a[232:235], v[88:91]
M v[88:91], v[212:215], a[236:239], v[88:91]
ds_read_b64_tr_b16 a[52:53], v18 offset:57344
ds_read_b64_tr_b16 a[54:55], v18 offset:61440
M v[92:95], v[220:223], a[236:239], v[92:95]
M v[92:95], v[216:219], a[232:235], v[92:95]
M v[96:99], v[160:163], a[240:243], v[96:99]
s_add_u32 s25, s25, 16384
s_add_u32 s26, s26, 131072
M v[96:99], v[164:167], a[244:247], v[96:99]
M v[100:103], v[172:175], a[244:247], v[100:103]
M v[100:103], v[168:171], a[240:243], v[100:103]
ds_read_b64_tr_b16 a[56:57], v19 offset:49152
ds_read_b64_tr_b16 a[58:59], v19 offset:53248
M v[104:107], v[176:179], a[240:243], v[104:107]
M v[104:107], v[180:183], a[244:247], v[104:107]
ds_read_b64_tr_b16 a[60:61], v19 offset:57344
ds_read_b64_tr_b16 a[62:63], v19 offset:61440
M v[108:111], v[188:191], a[244:247], v[108:111]
M v[108:111], v[184:187], a[240:243], v[108:111]
M v[112:115], v[192:195], a[240:243], v[112:115]
ds_read_b64_tr_b16 a[64:65], v20 offset:49152
ds_read_b64_tr_b16 a[66:67], v20 offset:53248
M v[112:115], v[196:199], a[244:247], v[112:115]
M v[116:119], v[204:207], a[244:247], v[116:119]
M v[116:119], v[200:203], a[240:243], v[116:119]
ds_read_b64_tr_b16 a[68:69], v20 offset:57344
ds_read_b64_tr_b16 a[70:71], v20 offset:61440
M v[120:123], v[208:211], a[240:243], v[120:123]
M v[120:123], v[212:215], a[244:247], v[120:123]
ds_read_b64_tr_b16 a[72:73], v21 offset:49152
ds_read_b64_tr_b16 a[74:75], v21 offset:53248
M v[124:127], v[220:223], a[244:247], v[124:127]
M v[124:127], v[216:219], a[240:243], v[124:127]
M v[128:131], v[160:163], a[248:251], v[128:131]
ds_read_b64_tr_b16 a[76:77], v21 offset:57344
ds_read_b64_tr_b16 a[78:79], v21 offset:61440
M v[128:131], v[164:167], a[252:255], v[128:131]
M v[132:135], v[172:175], a[252:255], v[132:135]
M v[132:135], v[168:171], a[248:251], v[132:135]
ds_read_b64_tr_b16 a[80:81], v22 offset:49152
ds_read_b64_tr_b16 a[82:83], v22 offset:53248
M v[136:139], v[176:179], a[248:251], v[136:139]
M v[136:139], v[180:183], a[252:255], v[136:139]
ds_read_b64_tr_b16 a[84:85], v22 offset:57344
ds_read_b64_tr_b16 a[86:87], v22 offset:61440
M v[140:143], v[188:191], a[252:255], v[140:143]
M v[140:143], v[184:187], a[248:251], v[140:143]
M v[144:147], v[192:195], a[248:251], v[144:147]
ds_read_b64_tr_b16 a[88:89], v23 offset:49152
ds_read_b64_tr_b16 a[90:91], v23 offset:53248
M v[144:147], v[196:199], a[252:255], v[144:147]
M v[148:151], v[204:207], a[252:255], v[148:151]
M v[148:151], v[200:203], a[248:251], v[148:151]
ds_read_b64_tr_b16 a[92:93], v23 offset:57344
ds_read_b64_tr_b16 a[94:95], v23 offset:61440
M v[152:155], v[208:211], a[248:251], v[152:155]
M v[152:155], v[212:215], a[252:255], v[152:155]
M v[156:159], v[220:223], a[252:255], v[156:159]
M v[156:159], v[216:219], a[248:251], v[156:159]
s_waitcnt vmcnt(12) lgkmcnt(0)
s_barrier
M v[32:35], a[32:35], a[96:99], v[32:35]
s_add_u32 m0, s42, 49152
s_nop 0
buffer_load_dwordx4 v6, s[48:51], s26 offen offset:0 lds
M v[32:35], a[36:39], a[100:103], v[32:35]
M v[36:39], a[44:47], a[100:103], v[36:39]
M v[36:39], a[40:43], a[96:99], v[36:39]
M v[40:43], a[48:51], a[96:99], v[40:43]
ds_read_b64_tr_b16 v[160:161], v24 offset:0
ds_read_b64_tr_b16 v[162:163], v24 offset:2048
M v[40:43], a[52:55], a[100:103], v[40:43]
M v[44:47], a[60:63], a[100:103], v[44:47]
M v[44:47], a[56:59], a[96:99], v[44:47]
M v[48:51], a[64:67], a[96:99], v[48:51]
buffer_load_dwordx4 v7, s[48:51], s26 offen offset:1024 lds
M v[48:51], a[68:71], a[100:103], v[48:51]
M v[52:55], a[76:79], a[100:103], v[52:55]
M v[52:55], a[72:75], a[96:99], v[52:55]
M v[56:59], a[80:83], a[96:99], v[56:59]
ds_read_b64_tr_b16 v[164:165], v24 offset:4096
ds_read_b64_tr_b16 v[166:167], v24 offset:6144
M v[56:59], a[84:87], a[100:103], v[56:59]
M v[60:63], a[92:95], a[100:103], v[60:63]
M v[60:63], a[88:91], a[96:99], v[60:63]
M v[64:67], a[32:35], a[104:107], v[64:67]
buffer_load_dwordx4 a[224:227], v1, s[44:47], s25 offen offset:0 sc1
M v[64:67], a[36:39], a[108:111], v[64:67]
M v[68:71], a[44:47], a[108:111], v[68:71]
v_cvt_pk_bf16_f32 v40, v40, v41
v_cvt_pk_bf16_f32 v41, v42, v43
M v[68:71], a[40:43], a[104:107], v[68:71]
v_cvt_pk_bf16_f32 v42, v44, v45
v_cvt_pk_bf16_f32 v43, v46, v47
M v[72:75], a[48:51], a[104:107], v[72:75]
ds_read_b64_tr_b16 v[168:169], v25 offset:0
ds_read_b64_tr_b16 v[170:171], v25 offset:2048
M v[72:75], a[52:55], a[108:111], v[72:75]
s_add_u32 s60, s56, 4096
buffer_store_dwordx4 v[40:43], v1, s[52:55], s60 offen offset:0 sc1
M v[76:79], a[60:63], a[108:111], v[76:79]
M v[76:79], a[56:59], a[104:107], v[76:79]
v_cvt_pk_bf16_f32 v48, v48, v49
v_cvt_pk_bf16_f32 v49, v50, v51
M v[80:83], a[64:67], a[104:107], v[80:83]
buffer_load_dwordx4 a[228:231], v1, s[44:47], s25 offen offset:1024 sc1
v_cvt_pk_bf16_f32 v50, v52, v53
v_cvt_pk_bf16_f32 v51, v54, v55
M v[80:83], a[68:71], a[108:111], v[80:83]
M v[84:87], a[76:79], a[108:111], v[84:87]
s_add_u32 s60, s56, 8192
buffer_store_dwordx4 v[48:51], v1, s[52:55], s60 offen offset:0 sc1
M v[84:87], a[72:75], a[104:107], v[84:87]
M v[88:91], a[80:83], a[104:107], v[88:91]
ds_read_b64_tr_b16 v[172:173], v25 offset:4096
ds_read_b64_tr_b16 v[174:175], v25 offset:6144
v_cvt_pk_bf16_f32 v56, v56, v57
v_cvt_pk_bf16_f32 v57, v58, v59
M v[88:91], a[84:87], a[108:111], v[88:91]
v_cvt_pk_bf16_f32 v58, v60, v61
v_cvt_pk_bf16_f32 v59, v62, v63
M v[92:95], a[92:95], a[108:111], v[92:95]
M v[92:95], a[88:91], a[104:107], v[92:95]
s_add_u32 s60, s56, 12288
buffer_store_dwordx4 v[56:59], v1, s[52:55], s60 offen offset:0 sc1
M v[96:99], a[32:35], a[112:115], v[96:99]
M v[96:99], a[36:39], a[116:119], v[96:99]
buffer_load_dwordx4 a[232:235], v1, s[44:47], s25 offen offset:2048 sc1
M v[100:103], a[44:47], a[116:119], v[100:103]
v_cvt_pk_bf16_f32 v72, v72, v73
v_cvt_pk_bf16_f32 v73, v74, v75
M v[100:103], a[40:43], a[112:115], v[100:103]
v_cvt_pk_bf16_f32 v74, v76, v77
v_cvt_pk_bf16_f32 v75, v78, v79
M v[104:107], a[48:51], a[112:115], v[104:107]
M v[104:107], a[52:55], a[116:119], v[104:107]
ds_read_b64_tr_b16 v[176:177], v26 offset:0
ds_read_b64_tr_b16 v[178:179], v26 offset:2048
s_add_u32 s60, s56, 4096
buffer_store_dwordx4 v[72:75], v1, s[52:55], s60 offen offset:1024 sc1
M v[108:111], a[60:63], a[116:119], v[108:111]
M v[108:111], a[56:59], a[112:115], v[108:111]
v_cvt_pk_bf16_f32 v80, v80, v81
v_cvt_pk_bf16_f32 v81, v82, v83
M v[112:115], a[64:67], a[112:115], v[112:115]
v_cvt_pk_bf16_f32 v82, v84, v85
v_cvt_pk_bf16_f32 v83, v86, v87
M v[112:115], a[68:71], a[116:119], v[112:115]
buffer_load_dwordx4 a[236:239], v1, s[44:47], s25 offen offset:3072 sc1
M v[116:119], a[76:79], a[116:119], v[116:119]
s_add_u32 s60, s56, 8192
buffer_store_dwordx4 v[80:83], v1, s[52:55], s60 offen offset:1024 sc1
M v[116:119], a[72:75], a[112:115], v[116:119]
M v[120:123], a[80:83], a[112:115], v[120:123]
v_cvt_pk_bf16_f32 v88, v88, v89
v_cvt_pk_bf16_f32 v89, v90, v91
M v[120:123], a[84:87], a[116:119], v[120:123]
ds_read_b64_tr_b16 v[180:181], v26 offset:4096
ds_read_b64_tr_b16 v[182:183], v26 offset:6144
v_cvt_pk_bf16_f32 v90, v92, v93
v_cvt_pk_bf16_f32 v91, v94, v95
M v[124:127], a[92:95], a[116:119], v[124:127]
M v[124:127], a[88:91], a[112:115], v[124:127]
s_add_u32 s60, s56, 12288
buffer_store_dwordx4 v[88:91], v1, s[52:55], s60 offen offset:1024 sc1
M v[128:131], a[32:35], a[120:123], v[128:131]
M v[128:131], a[36:39], a[124:127], v[128:131]
s_add_u32 s25, s25, 16384
s_add_u32 s26, s26, 131072
M v[132:135], a[44:47], a[124:127], v[132:135]
v_cvt_pk_bf16_f32 v104, v104, v105
v_cvt_pk_bf16_f32 v105, v106, v107
M v[132:135], a[40:43], a[120:123], v[132:135]
v_cvt_pk_bf16_f32 v106, v108, v109
v_cvt_pk_bf16_f32 v107, v110, v111
M v[136:139], a[48:51], a[120:123], v[136:139]
M v[136:139], a[52:55], a[124:127], v[136:139]
ds_read_b64_tr_b16 v[184:185], v27 offset:0
ds_read_b64_tr_b16 v[186:187], v27 offset:2048
s_add_u32 s60, s56, 4096
buffer_store_dwordx4 v[104:107], v1, s[52:55], s60 offen offset:2048 sc1
M v[140:143], a[60:63], a[124:127], v[140:143]
M v[140:143], a[56:59], a[120:123], v[140:143]
v_cvt_pk_bf16_f32 v112, v112, v113
v_cvt_pk_bf16_f32 v113, v114, v115
M v[144:147], a[64:67], a[120:123], v[144:147]
v_cvt_pk_bf16_f32 v114, v116, v117
v_cvt_pk_bf16_f32 v115, v118, v119
M v[144:147], a[68:71], a[124:127], v[144:147]
ds_read_b64_tr_b16 v[188:189], v27 offset:4096
ds_read_b64_tr_b16 v[190:191], v27 offset:6144
M v[148:151], a[76:79], a[124:127], v[148:151]
s_add_u32 s60, s56, 8192
buffer_store_dwordx4 v[112:115], v1, s[52:55], s60 offen offset:2048 sc1
M v[148:151], a[72:75], a[120:123], v[148:151]
M v[152:155], a[80:83], a[120:123], v[152:155]
v_cvt_pk_bf16_f32 v120, v120, v121
v_cvt_pk_bf16_f32 v121, v122, v123
M v[152:155], a[84:87], a[124:127], v[152:155]
v_cvt_pk_bf16_f32 v122, v124, v125
v_cvt_pk_bf16_f32 v123, v126, v127
M v[156:159], a[92:95], a[124:127], v[156:159]
M v[156:159], a[88:91], a[120:123], v[156:159]
s_add_u32 s60, s56, 12288
buffer_store_dwordx4 v[120:123], v1, s[52:55], s60 offen offset:2048 sc1
s_waitcnt vmcnt(21) lgkmcnt(0)
s_barrier
M a[0:3], v[160:163], a[128:131], a[0:3]
s_add_u32 m0, s42, 65536
s_nop 0
buffer_load_dwordx4 v6, s[48:51], s26 offen offset:0 lds
ds_read_b64_tr_b16 a[32:33], v24 offset:16384
ds_read_b64_tr_b16 a[34:35], v24 offset:18432
M a[0:3], v[164:167], a[132:135], a[0:3]
buffer_load_dwordx4 v7, s[48:51], s26 offen offset:1024 lds
M a[4:7], v[172:175], a[132:135], a[4:7]
ds_read_b64_tr_b16 a[36:37], v24 offset:20480
ds_read_b64_tr_b16 a[38:39], v24 offset:22528
buffer_load_dwordx4 a[96:99], v1, s[44:47], s25 offen offset:0 sc1
M a[4:7], v[168:171], a[128:131], a[4:7]
ds_read_b64_tr_b16 a[40:41], v25 offset:16384
ds_read_b64_tr_b16 a[42:43], v25 offset:18432
M a[8:11], v[176:179], a[128:131], a[8:11]
buffer_load_dwordx4 a[100:103], v1, s[44:47], s25 offen offset:1024 sc1
M a[8:11], v[180:183], a[132:135], a[8:11]
ds_read_b64_tr_b16 a[44:45], v25 offset:20480
ds_read_b64_tr_b16 a[46:47], v25 offset:22528
buffer_load_dwordx4 a[104:107], v1, s[44:47], s25 offen offset:2048 sc1
M a[12:15], v[188:191], a[132:135], a[12:15]
ds_read_b64_tr_b16 a[48:49], v26 offset:16384
ds_read_b64_tr_b16 a[50:51], v26 offset:18432
M a[12:15], v[184:187], a[128:131], a[12:15]
buffer_load_dwordx4 a[108:111], v1, s[44:47], s25 offen offset:3072 sc1
M a[16:19], v[160:163], a[136:139], a[16:19]
ds_read_b64_tr_b16 a[52:53], v26 offset:20480
ds_read_b64_tr_b16 a[54:55], v26 offset:22528
s_add_u32 s25, s25, 16384
s_add_u32 s26, s26, 131072
M a[16:19], v[164:167], a[140:143], a[16:19]
ds_read_b64_tr_b16 a[56:57], v27 offset:16384
ds_read_b64_tr_b16 a[58:59], v27 offset:18432
M a[20:23], v[172:175], a[140:143], a[20:23]
v_cvt_pk_bf16_f32 v136, v136, v137
v_cvt_pk_bf16_f32 v137, v138, v139
v_cvt_pk_bf16_f32 v138, v140, v141
v_cvt_pk_bf16_f32 v139, v142, v143
s_add_u32 s60, s56, 4096
buffer_store_dwordx4 v[136:139], v1, s[52:55], s60 offen offset:3072 sc1
M a[20:23], v[168:171], a[136:139], a[20:23]
ds_read_b64_tr_b16 a[60:61], v27 offset:20480
ds_read_b64_tr_b16 a[62:63], v27 offset:22528
v_cvt_pk_bf16_f32 v144, v144, v145
v_cvt_pk_bf16_f32 v145, v146, v147
v_cvt_pk_bf16_f32 v146, v148, v149
v_cvt_pk_bf16_f32 v147, v150, v151
s_add_u32 s60, s56, 8192
buffer_store_dwordx4 v[144:147], v1, s[52:55], s60 offen offset:3072 sc1
M a[24:27], v[176:179], a[136:139], a[24:27]
v_cvt_pk_bf16_f32 v152, v152, v153
v_cvt_pk_bf16_f32 v153, v154, v155
v_cvt_pk_bf16_f32 v154, v156, v157
v_cvt_pk_bf16_f32 v155, v158, v159
s_add_u32 s60, s56, 12288
buffer_store_dwordx4 v[152:155], v1, s[52:55], s60 offen offset:3072 sc1
M a[24:27], v[180:183], a[140:143], a[24:27]
v_and_b32 v11, 3, v0
v_lshlrev_b32 v11, 2, v11
M a[28:31], v[188:191], a[140:143], a[28:31]
M a[28:31], v[184:187], a[136:139], a[28:31]
s_waitcnt vmcnt(24) lgkmcnt(0)
s_barrier
M a[0:3], a[32:35], a[160:163], a[0:3]
s_add_u32 m0, s42, 81920
s_nop 0
buffer_load_dwordx4 v6, s[48:51], s26 offen offset:0 lds
ds_read_b64_tr_b16 v[160:161], v24 offset:32768
ds_read_b64_tr_b16 v[162:163], v24 offset:34816
M a[0:3], a[36:39], a[164:167], a[0:3]
buffer_load_dwordx4 v7, s[48:51], s26 offen offset:1024 lds
M a[4:7], a[44:47], a[164:167], a[4:7]
ds_read_b64_tr_b16 v[164:165], v24 offset:36864
ds_read_b64_tr_b16 v[166:167], v24 offset:38912
M a[4:7], a[40:43], a[160:163], a[4:7]
buffer_load_dwordx4 a[128:131], v1, s[44:47], s25 offen offset:0 sc1
M a[8:11], a[48:51], a[160:163], a[8:11]
ds_read_b64_tr_b16 v[168:169], v25 offset:32768
ds_read_b64_tr_b16 v[170:171], v25 offset:34816
M a[8:11], a[52:55], a[164:167], a[8:11]
buffer_load_dwordx4 a[132:135], v1, s[44:47], s25 offen offset:1024 sc1
M a[12:15], a[60:63], a[164:167], a[12:15]
ds_read_b64_tr_b16 v[172:173], v25 offset:36864
ds_read_b64_tr_b16 v[174:175], v25 offset:38912
M a[12:15], a[56:59], a[160:163], a[12:15]
buffer_load_dwordx4 a[136:139], v1, s[44:47], s25 offen offset:2048 sc1
M a[16:19], a[32:35], a[168:171], a[16:19]
ds_read_b64_tr_b16 v[176:177], v26 offset:32768
ds_read_b64_tr_b16 v[178:179], v26 offset:34816
M a[16:19], a[36:39], a[172:175], a[16:19]
buffer_load_dwordx4 a[140:143], v1, s[44:47], s25 offen offset:3072 sc1
M a[20:23], a[44:47], a[172:175], a[20:23]
ds_read_b64_tr_b16 v[180:181], v26 offset:36864
ds_read_b64_tr_b16 v[182:183], v26 offset:38912
M a[20:23], a[40:43], a[168:171], a[20:23]
s_add_u32 s25, s25, 16384
s_add_u32 s26, s26, 131072
M a[24:27], a[48:51], a[168:171], a[24:27]
ds_read_b64_tr_b16 v[184:185], v27 offset:32768
ds_read_b64_tr_b16 v[186:187], v27 offset:34816
M a[24:27], a[52:55], a[172:175], a[24:27]
ds_read_b64_tr_b16 v[188:189], v27 offset:36864
ds_read_b64_tr_b16 v[190:191], v27 offset:38912
M a[28:31], a[60:63], a[172:175], a[28:31]
M a[28:31], a[56:59], a[168:171], a[28:31]
s_waitcnt vmcnt(6) lgkmcnt(0)
s_barrier
s_cmp_lg_u32 s101, 0
s_cbranch_scc1 Lk3f_7
s_mov_b64 exec, 1
buffer_store_dword v254, v253, s[52:55], s58 offen sc1
s_mov_b64 exec, -1
Lk3f_7:
M a[0:3], v[160:163], a[192:195], a[0:3]
s_add_u32 m0, s42, 98304
s_nop 0
buffer_load_dwordx4 v6, s[48:51], s26 offen offset:0 lds
ds_read_b64_tr_b16 a[32:33], v24 offset:49152
ds_read_b64_tr_b16 a[34:35], v24 offset:51200
M a[0:3], v[164:167], a[196:199], a[0:3]
buffer_load_dwordx4 v7, s[48:51], s26 offen offset:1024 lds
M a[4:7], v[172:175], a[196:199], a[4:7]
ds_read_b64_tr_b16 a[36:37], v24 offset:53248
ds_read_b64_tr_b16 a[38:39], v24 offset:55296
M a[4:7], v[168:171], a[192:195], a[4:7]
buffer_load_dwordx4 a[160:163], v1, s[44:47], s25 offen offset:0 sc1
M a[8:11], v[176:179], a[192:195], a[8:11]
ds_read_b64_tr_b16 a[40:41], v25 offset:49152
ds_read_b64_tr_b16 a[42:43], v25 offset:51200
M a[8:11], v[180:183], a[196:199], a[8:11]
buffer_load_dwordx4 a[164:167], v1, s[44:47], s25 offen offset:1024 sc1
M a[12:15], v[188:191], a[196:199], a[12:15]
ds_read_b64_tr_b16 a[44:45], v25 offset:53248
ds_read_b64_tr_b16 a[46:47], v25 offset:55296
M a[12:15], v[184:187], a[192:195], a[12:15]
buffer_load_dwordx4 a[168:171], v1, s[44:47], s25 offen offset:2048 sc1
M a[16:19], v[160:163], a[200:203], a[16:19]
ds_read_b64_tr_b16 a[48:49], v26 offset:49152
ds_read_b64_tr_b16 a[50:51], v26 offset:51200
M a[16:19], v[164:167], a[204:207], a[16:19]
buffer_load_dwordx4 a[172:175], v1, s[44:47], s25 offen offset:3072 sc1
M a[20:23], v[172:175], a[204:207], a[20:23]
ds_read_b64_tr_b16 a[52:53], v26 offset:53248
ds_read_b64_tr_b16 a[54:55], v26 offset:55296
M a[20:23], v[168:171], a[200:203], a[20:23]
s_add_u32 s25, s25, 16384
s_add_u32 s26, s26, 131072
M a[24:27], v[176:179], a[200:203], a[24:27]
ds_read_b64_tr_b16 a[56:57], v27 offset:49152
ds_read_b64_tr_b16 a[58:59], v27 offset:51200
M a[24:27], v[180:183], a[204:207], a[24:27]
ds_read_b64_tr_b16 a[60:61], v27 offset:53248
ds_read_b64_tr_b16 a[62:63], v27 offset:55296
M a[28:31], v[188:191], a[204:207], a[28:31]
M a[28:31], v[184:187], a[200:203], a[28:31]
s_waitcnt vmcnt(15) lgkmcnt(0)
s_barrier
M a[0:3], a[32:35], a[224:227], a[0:3]
s_add_u32 m0, s42, 114688
s_nop 0
buffer_load_dwordx4 v6, s[48:51], s26 offen offset:0 lds
ds_read_b64_tr_b16 v[160:161], v28 offset:0
ds_read_b64_tr_b16 v[162:163], v28 offset:2048
M a[0:3], a[36:39], a[228:231], a[0:3]
buffer_load_dwordx4 v7, s[48:51], s26 offen offset:1024 lds
M a[4:7], a[44:47], a[228:231], a[4:7]
ds_read_b64_tr_b16 v[164:165], v28 offset:4096
ds_read_b64_tr_b16 v[166:167], v28 offset:6144
M a[4:7], a[40:43], a[224:227], a[4:7]
buffer_load_dwordx4 a[192:195], v1, s[44:47], s25 offen offset:0 sc1
M a[8:11], a[48:51], a[224:227], a[8:11]
ds_read_b64_tr_b16 v[168:169], v29 offset:0
ds_read_b64_tr_b16 v[170:171], v29 offset:2048
M a[8:11], a[52:55], a[228:231], a[8:11]
buffer_load_dwordx4 a[196:199], v1, s[44:47], s25 offen offset:1024 sc1
M a[12:15], a[60:63], a[228:231], a[12:15]
ds_read_b64_tr_b16 v[172:173], v29 offset:4096
ds_read_b64_tr_b16 v[174:175], v29 offset:6144
M a[12:15], a[56:59], a[224:227], a[12:15]
buffer_load_dwordx4 a[200:203], v1, s[44:47], s25 offen offset:2048 sc1
M a[16:19], a[32:35], a[232:235], a[16:19]
ds_read_b64_tr_b16 v[176:177], v30 offset:0
ds_read_b64_tr_b16 v[178:179], v30 offset:2048
M a[16:19], a[36:39], a[236:239], a[16:19]
buffer_load_dwordx4 a[204:207], v1, s[44:47], s25 offen offset:3072 sc1
M a[20:23], a[44:47], a[236:239], a[20:23]
ds_read_b64_tr_b16 v[180:181], v30 offset:4096
ds_read_b64_tr_b16 v[182:183], v30 offset:6144
M a[20:23], a[40:43], a[232:235], a[20:23]
s_add_u32 s25, s25, 16384
s_add_u32 s26, s26, 131072
M a[24:27], a[48:51], a[232:235], a[24:27]
ds_read_b64_tr_b16 v[184:185], v31 offset:0
ds_read_b64_tr_b16 v[186:187], v31 offset:2048
M a[24:27], a[52:55], a[236:239], a[24:27]
ds_read_b64_tr_b16 v[188:189], v31 offset:4096
ds_read_b64_tr_b16 v[190:191], v31 offset:6144
M a[28:31], a[60:63], a[236:239], a[28:31]
M a[28:31], a[56:59], a[232:235], a[28:31]
s_waitcnt vmcnt(12) lgkmcnt(0)
s_barrier
M a[0:3], v[160:163], a[96:99], a[0:3]
s_add_u32 m0, s42, 0
s_nop 0
buffer_load_dwordx4 v6, s[48:51], s26 offen offset:0 lds
ds_read_b64_tr_b16 a[32:33], v28 offset:16384
ds_read_b64_tr_b16 a[34:35], v28 offset:18432
M a[0:3], v[164:167], a[100:103], a[0:3]
buffer_load_dwordx4 v7, s[48:51], s26 offen offset:1024 lds
M a[4:7], v[172:175], a[100:103], a[4:7]
ds_read_b64_tr_b16 a[36:37], v28 offset:20480
ds_read_b64_tr_b16 a[38:39], v28 offset:22528
M a[4:7], v[168:171], a[96:99], a[4:7]
buffer_load_dwordx4 a[224:227], v1, s[44:47], s25 offen offset:0 sc1
M a[8:11], v[176:179], a[96:99], a[8:11]
ds_read_b64_tr_b16 a[40:41], v29 offset:16384
ds_read_b64_tr_b16 a[42:43], v29 offset:18432
M a[8:11], v[180:183], a[100:103], a[8:11]
buffer_load_dwordx4 a[228:231], v1, s[44:47], s25 offen offset:1024 sc1
M a[12:15], v[188:191], a[100:103], a[12:15]
ds_read_b64_tr_b16 a[44:45], v29 offset:20480
ds_read_b64_tr_b16 a[46:47], v29 offset:22528
M a[12:15], v[184:187], a[96:99], a[12:15]
buffer_load_dwordx4 a[232:235], v1, s[44:47], s25 offen offset:2048 sc1
M a[16:19], v[160:163], a[104:107], a[16:19]
ds_read_b64_tr_b16 a[48:49], v30 offset:16384
ds_read_b64_tr_b16 a[50:51], v30 offset:18432
M a[16:19], v[164:167], a[108:111], a[16:19]
buffer_load_dwordx4 a[236:239], v1, s[44:47], s25 offen offset:3072 sc1
M a[20:23], v[172:175], a[108:111], a[20:23]
ds_read_b64_tr_b16 a[52:53], v30 offset:20480
ds_read_b64_tr_b16 a[54:55], v30 offset:22528
M a[20:23], v[168:171], a[104:107], a[20:23]
s_add_u32 s25, s25, 16384
s_add_u32 s26, s26, 131072
M a[24:27], v[176:179], a[104:107], a[24:27]
ds_read_b64_tr_b16 a[56:57], v31 offset:16384
ds_read_b64_tr_b16 a[58:59], v31 offset:18432
M a[24:27], v[180:183], a[108:111], a[24:27]
ds_read_b64_tr_b16 a[60:61], v31 offset:20480
ds_read_b64_tr_b16 a[62:63], v31 offset:22528
M a[28:31], v[188:191], a[108:111], a[28:31]
M a[28:31], v[184:187], a[104:107], a[28:31]
s_waitcnt vmcnt(12) lgkmcnt(0)
s_barrier
M a[0:3], a[32:35], a[128:131], a[0:3]
ds_read_b64_tr_b16 v[160:161], v28 offset:32768
ds_read_b64_tr_b16 v[162:163], v28 offset:34816
M a[0:3], a[36:39], a[132:135], a[0:3]
ds_read_b64_tr_b16 v[164:165], v28 offset:36864
ds_read_b64_tr_b16 v[166:167], v28 offset:38912
M a[4:7], a[44:47], a[132:135], a[4:7]
M a[4:7], a[40:43], a[128:131], a[4:7]
ds_read_b64_tr_b16 v[168:169], v29 offset:32768
ds_read_b64_tr_b16 v[170:171], v29 offset:34816
M a[8:11], a[48:51], a[128:131], a[8:11]
M a[8:11], a[52:55], a[132:135], a[8:11]
ds_read_b64_tr_b16 v[172:173], v29 offset:36864
ds_read_b64_tr_b16 v[174:175], v29 offset:38912
M a[12:15], a[60:63], a[132:135], a[12:15]
M a[12:15], a[56:59], a[128:131], a[12:15]
ds_read_b64_tr_b16 v[176:177], v30 offset:32768
ds_read_b64_tr_b16 v[178:179], v30 offset:34816
M a[16:19], a[32:35], a[136:139], a[16:19]
ds_read_b64_tr_b16 v[180:181], v30 offset:36864
ds_read_b64_tr_b16 v[182:183], v30 offset:38912
M a[16:19], a[36:39], a[140:143], a[16:19]
M a[20:23], a[44:47], a[140:143], a[20:23]
ds_read_b64_tr_b16 v[184:185], v31 offset:32768
ds_read_b64_tr_b16 v[186:187], v31 offset:34816
M a[20:23], a[40:43], a[136:139], a[20:23]
M a[24:27], a[48:51], a[136:139], a[24:27]
ds_read_b64_tr_b16 v[188:189], v31 offset:36864
ds_read_b64_tr_b16 v[190:191], v31 offset:38912
M a[24:27], a[52:55], a[140:143], a[24:27]
M a[28:31], a[60:63], a[140:143], a[28:31]
M a[28:31], a[56:59], a[136:139], a[28:31]
s_waitcnt vmcnt(6) lgkmcnt(0)
s_barrier
M a[0:3], v[160:163], a[160:163], a[0:3]
buffer_load_dword v8, v11, s[52:55], s59 offen sc1
M a[0:3], v[164:167], a[164:167], a[0:3]
ds_read_b64_tr_b16 a[32:33], v28 offset:49152
ds_read_b64_tr_b16 a[34:35], v28 offset:51200
M a[4:7], v[172:175], a[164:167], a[4:7]
M a[4:7], v[168:171], a[160:163], a[4:7]
ds_read_b64_tr_b16 a[36:37], v28 offset:53248
ds_read_b64_tr_b16 a[38:39], v28 offset:55296
M a[8:11], v[176:179], a[160:163], a[8:11]
ds_read_b64_tr_b16 a[40:41], v29 offset:49152
ds_read_b64_tr_b16 a[42:43], v29 offset:51200
M a[8:11], v[180:183], a[164:167], a[8:11]
M a[12:15], v[188:191], a[164:167], a[12:15]
ds_read_b64_tr_b16 a[44:45], v29 offset:53248
ds_read_b64_tr_b16 a[46:47], v29 offset:55296
M a[12:15], v[184:187], a[160:163], a[12:15]
ds_read_b64_tr_b16 a[48:49], v30 offset:49152
ds_read_b64_tr_b16 a[50:51], v30 offset:51200
M a[16:19], v[160:163], a[168:171], a[16:19]
M a[16:19], v[164:167], a[172:175], a[16:19]
ds_read_b64_tr_b16 a[52:53], v30 offset:53248
ds_read_b64_tr_b16 a[54:55], v30 offset:55296
M a[20:23], v[172:175], a[172:175], a[20:23]
ds_read_b64_tr_b16 a[56:57], v31 offset:49152
ds_read_b64_tr_b16 a[58:59], v31 offset:51200
M a[20:23], v[168:171], a[168:171], a[20:23]
M a[24:27], v[176:179], a[168:171], a[24:27]
ds_read_b64_tr_b16 a[60:61], v31 offset:53248
ds_read_b64_tr_b16 a[62:63], v31 offset:55296
M a[24:27], v[180:183], a[172:175], a[24:27]
M a[28:31], v[188:191], a[172:175], a[28:31]
M a[28:31], v[184:187], a[168:171], a[28:31]
s_waitcnt vmcnt(1) lgkmcnt(0)
s_barrier
s_waitcnt vmcnt(0)
v_cmp_ne_u32 vcc, 1, v8
s_nop 0
s_cbranch_vccnz Lk3_spinfl
Lk3_gotfl:
M a[0:3], a[32:35], a[192:195], a[0:3]
s_xor_b32 s60, s56, 65536
s_add_u32 s60, s60, 4096
buffer_load_dwordx4 v[192:195], v1, s[52:55], s60 offen offset:0 sc1
ds_read_b64_tr_b16 v[160:161], v24 offset:0
ds_read_b64_tr_b16 v[162:163], v24 offset:2048
M a[0:3], a[36:39], a[196:199], a[0:3]
buffer_load_dwordx4 v[196:199], v1, s[52:55], s60 offen offset:1024 sc1
M a[4:7], a[44:47], a[196:199], a[4:7]
ds_read_b64_tr_b16 v[164:165], v24 offset:4096
ds_read_b64_tr_b16 v[166:167], v24 offset:6144
buffer_load_dwordx4 v[200:203], v1, s[52:55], s60 offen offset:2048 sc1
M a[4:7], a[40:43], a[192:195], a[4:7]
ds_read_b64_tr_b16 v[168:169], v25 offset:0
ds_read_b64_tr_b16 v[170:171], v25 offset:2048
M a[8:11], a[48:51], a[192:195], a[8:11]
buffer_load_dwordx4 v[204:207], v1, s[52:55], s60 offen offset:3072 sc1
ds_read_b64_tr_b16 v[172:173], v25 offset:4096
ds_read_b64_tr_b16 v[174:175], v25 offset:6144
M a[8:11], a[52:55], a[196:199], a[8:11]
s_xor_b32 s60, s56, 131072
s_add_u32 s60, s60, 8192
buffer_load_dwordx4 v[208:211], v1, s[52:55], s60 offen offset:0 sc1
M a[12:15], a[60:63], a[196:199], a[12:15]
ds_read_b64_tr_b16 v[176:177], v26 offset:0
ds_read_b64_tr_b16 v[178:179], v26 offset:2048
M a[12:15], a[56:59], a[192:195], a[12:15]
buffer_load_dwordx4 v[212:215], v1, s[52:55], s60 offen offset:1024 sc1
ds_read_b64_tr_b16 v[180:181], v26 offset:4096
ds_read_b64_tr_b16 v[182:183], v26 offset:6144
M a[16:19], a[32:35], a[200:203], a[16:19]
buffer_load_dwordx4 v[216:219], v1, s[52:55], s60 offen offset:2048 sc1
M a[16:19], a[36:39], a[204:207], a[16:19]
ds_read_b64_tr_b16 v[184:185], v27 offset:0
ds_read_b64_tr_b16 v[186:187], v27 offset:2048
buffer_load_dwordx4 v[220:223], v1, s[52:55], s60 offen offset:3072 sc1
M a[20:23], a[44:47], a[204:207], a[20:23]
ds_read_b64_tr_b16 v[188:189], v27 offset:4096
ds_read_b64_tr_b16 v[190:191], v27 offset:6144
M a[20:23], a[40:43], a[200:203], a[20:23]
s_xor_b32 s60, s56, 196608
s_add_u32 s60, s60, 12288
buffer_load_dwordx4 v[224:227], v1, s[52:55], s60 offen offset:0 sc1
buffer_load_dwordx4 v[228:231], v1, s[52:55], s60 offen offset:1024 sc1
M a[24:27], a[48:51], a[200:203], a[24:27]
buffer_load_dwordx4 v[232:235], v1, s[52:55], s60 offen offset:2048 sc1
M a[24:27], a[52:55], a[204:207], a[24:27]
buffer_load_dwordx4 v[236:239], v1, s[52:55], s60 offen offset:3072 sc1
M a[28:31], a[60:63], a[204:207], a[28:31]
M a[28:31], a[56:59], a[200:203], a[28:31]
s_waitcnt lgkmcnt(0)
M a[0:3], v[160:163], a[224:227], a[0:3]
M a[0:3], v[164:167], a[228:231], a[0:3]
M a[4:7], v[172:175], a[228:231], a[4:7]
M a[4:7], v[168:171], a[224:227], a[4:7]
M a[8:11], v[176:179], a[224:227], a[8:11]
M a[8:11], v[180:183], a[228:231], a[8:11]
M a[12:15], v[188:191], a[228:231], a[12:15]
M a[12:15], v[184:187], a[224:227], a[12:15]
M a[16:19], v[160:163], a[232:235], a[16:19]
M a[16:19], v[164:167], a[236:239], a[16:19]
M a[20:23], v[172:175], a[236:239], a[20:23]
M a[20:23], v[168:171], a[232:235], a[20:23]
M a[24:27], v[176:179], a[232:235], a[24:27]
M a[24:27], v[180:183], a[236:239], a[24:27]
M a[28:31], v[188:191], a[236:239], a[28:31]
M a[28:31], v[184:187], a[232:235], a[28:31]
v_bfe_u32 v8, v0, 4, 1
v_lshrrev_b32 v9, 5, v0
v_lshl_or_b32 v8, v8, 1, v9
v_and_b32 v9, 15, v0
v_lshlrev_b32 v9, 13, v9
v_lshl_add_u32 v8, v8, 4, v9
s_and_b32 s3, s101, 1
s_lshl_b32 s3, s3, 6
s_lshr_b32 s6, s101, 1
s_add_u32 s3, s3, s6
s_add_u32 s3, s3, s21
s_lshl_b32 s3, s3, 12
s_lshl_b32 s6, s22, 1
s_add_u32 s3, s3, s6
s_add_u32 s3, s3, 2048
v_accvgpr_read_b32 v20, a0
v_accvgpr_read_b32 v21, a1
v_accvgpr_read_b32 v22, a2
v_accvgpr_read_b32 v23, a3
v_accvgpr_read_b32 v24, a4
v_accvgpr_read_b32 v25, a5
v_accvgpr_read_b32 v26, a6
v_accvgpr_read_b32 v27, a7
v_cvt_pk_bf16_f32 v12, v20, v21
v_cvt_pk_bf16_f32 v13, v22, v23
v_cvt_pk_bf16_f32 v14, v24, v25
v_cvt_pk_bf16_f32 v15, v26, v27
s_nop 0
v_permlane16_swap_b32 v12, v14
v_permlane16_swap_b32 v13, v15
buffer_store_dwordx4 v[12:15], v8, s[16:19], s3 offen offset:0
v_accvgpr_read_b32 v20, a8
v_accvgpr_read_b32 v21, a9
v_accvgpr_read_b32 v22, a10
v_accvgpr_read_b32 v23, a11
v_accvgpr_read_b32 v24, a12
v_accvgpr_read_b32 v25, a13
v_accvgpr_read_b32 v26, a14
v_accvgpr_read_b32 v27, a15
v_cvt_pk_bf16_f32 v16, v20, v21
v_cvt_pk_bf16_f32 v17, v22, v23
v_cvt_pk_bf16_f32 v18, v24, v25
v_cvt_pk_bf16_f32 v19, v26, v27
s_nop 0
v_permlane16_swap_b32 v16, v18
v_permlane16_swap_b32 v17, v19
buffer_store_dwordx4 v[16:19], v8, s[16:19], s3 offen offset:64
s_add_u32 s3, s3, 131072
v_accvgpr_read_b32 v20, a16
v_accvgpr_read_b32 v21, a17
v_accvgpr_read_b32 v22, a18
v_accvgpr_read_b32 v23, a19
v_accvgpr_read_b32 v24, a20
v_accvgpr_read_b32 v25, a21
v_accvgpr_read_b32 v26, a22
v_accvgpr_read_b32 v27, a23
v_cvt_pk_bf16_f32 v12, v20, v21
v_cvt_pk_bf16_f32 v13, v22, v23
v_cvt_pk_bf16_f32 v14, v24, v25
v_cvt_pk_bf16_f32 v15, v26, v27
s_nop 0
v_permlane16_swap_b32 v12, v14
v_permlane16_swap_b32 v13, v15
buffer_store_dwordx4 v[12:15], v8, s[16:19], s3 offen offset:0
v_accvgpr_read_b32 v20, a24
v_accvgpr_read_b32 v21, a25
v_accvgpr_read_b32 v22, a26
v_accvgpr_read_b32 v23, a27
v_accvgpr_read_b32 v24, a28
v_accvgpr_read_b32 v25, a29
v_accvgpr_read_b32 v26, a30
v_accvgpr_read_b32 v27, a31
v_cvt_pk_bf16_f32 v16, v20, v21
v_cvt_pk_bf16_f32 v17, v22, v23
v_cvt_pk_bf16_f32 v18, v24, v25
v_cvt_pk_bf16_f32 v19, v26, v27
s_nop 0
v_permlane16_swap_b32 v16, v18
v_permlane16_swap_b32 v17, v19
buffer_store_dwordx4 v[16:19], v8, s[16:19], s3 offen offset:64
v_bfe_u32 v8, v0, 4, 1
v_lshrrev_b32 v9, 5, v0
v_lshl_or_b32 v8, v8, 1, v9
v_and_b32 v9, 15, v0
v_lshlrev_b32 v9, 12, v9
v_lshl_add_u32 v8, v8, 4, v9
s_lshl_b32 s3, s101, 6
s_add_u32 s3, s3, s29
s_lshl_b32 s3, s3, 12
s_lshl_b32 s6, s30, 1
s_add_u32 s3, s3, s6
s_mov_b32 s6, 0x00003f80
s_mov_b32 s7, 0x3f800000
s_waitcnt vmcnt(4)
v_dot2_f32_bf16 v32, v192, s6, v32
v_dot2_f32_bf16 v33, v192, s7, v33
v_dot2_f32_bf16 v34, v193, s6, v34
v_dot2_f32_bf16 v35, v193, s7, v35
v_dot2_f32_bf16 v36, v194, s6, v36
v_dot2_f32_bf16 v37, v194, s7, v37
v_dot2_f32_bf16 v38, v195, s6, v38
v_dot2_f32_bf16 v39, v195, s7, v39
v_dot2_f32_bf16 v32, v208, s6, v32
v_dot2_f32_bf16 v33, v208, s7, v33
v_dot2_f32_bf16 v34, v209, s6, v34
v_dot2_f32_bf16 v35, v209, s7, v35
v_dot2_f32_bf16 v36, v210, s6, v36
v_dot2_f32_bf16 v37, v210, s7, v37
v_dot2_f32_bf16 v38, v211, s6, v38
v_dot2_f32_bf16 v39, v211, s7, v39
v_dot2_f32_bf16 v32, v224, s6, v32
v_dot2_f32_bf16 v33, v224, s7, v33
v_dot2_f32_bf16 v34, v225, s6, v34
v_dot2_f32_bf16 v35, v225, s7, v35
v_dot2_f32_bf16 v36, v226, s6, v36
v_dot2_f32_bf16 v37, v226, s7, v37
v_dot2_f32_bf16 v38, v227, s6, v38
v_dot2_f32_bf16 v39, v227, s7, v39
v_cvt_pk_bf16_f32 v12, v32, v33
v_cvt_pk_bf16_f32 v13, v34, v35
v_cvt_pk_bf16_f32 v14, v36, v37
v_cvt_pk_bf16_f32 v15, v38, v39
s_nop 0
v_permlane16_swap_b32 v12, v14
v_permlane16_swap_b32 v13, v15
buffer_store_dwordx4 v[12:15], v8, s[16:19], s3 offen offset:0
s_add_u32 s3, s3, 65536
v_dot2_f32_bf16 v64, v196, s6, v64
v_dot2_f32_bf16 v65, v196, s7, v65
v_dot2_f32_bf16 v66, v197, s6, v66
v_dot2_f32_bf16 v67, v197, s7, v67
v_dot2_f32_bf16 v68, v198, s6, v68
v_dot2_f32_bf16 v69, v198, s7, v69
v_dot2_f32_bf16 v70, v199, s6, v70
v_dot2_f32_bf16 v71, v199, s7, v71
v_dot2_f32_bf16 v64, v212, s6, v64
v_dot2_f32_bf16 v65, v212, s7, v65
v_dot2_f32_bf16 v66, v213, s6, v66
v_dot2_f32_bf16 v67, v213, s7, v67
v_dot2_f32_bf16 v68, v214, s6, v68
v_dot2_f32_bf16 v69, v214, s7, v69
v_dot2_f32_bf16 v70, v215, s6, v70
v_dot2_f32_bf16 v71, v215, s7, v71
v_dot2_f32_bf16 v64, v228, s6, v64
v_dot2_f32_bf16 v65, v228, s7, v65
v_dot2_f32_bf16 v66, v229, s6, v66
v_dot2_f32_bf16 v67, v229, s7, v67
v_dot2_f32_bf16 v68, v230, s6, v68
v_dot2_f32_bf16 v69, v230, s7, v69
v_dot2_f32_bf16 v70, v231, s6, v70
v_dot2_f32_bf16 v71, v231, s7, v71
v_cvt_pk_bf16_f32 v16, v64, v65
v_cvt_pk_bf16_f32 v17, v66, v67
v_cvt_pk_bf16_f32 v18, v68, v69
v_cvt_pk_bf16_f32 v19, v70, v71
s_nop 0
v_permlane16_swap_b32 v16, v18
v_permlane16_swap_b32 v17, v19
buffer_store_dwordx4 v[16:19], v8, s[16:19], s3 offen offset:0
s_add_u32 s3, s3, 65536
v_dot2_f32_bf16 v96, v200, s6, v96
v_dot2_f32_bf16 v97, v200, s7, v97
v_dot2_f32_bf16 v98, v201, s6, v98
v_dot2_f32_bf16 v99, v201, s7, v99
v_dot2_f32_bf16 v100, v202, s6, v100
v_dot2_f32_bf16 v101, v202, s7, v101
v_dot2_f32_bf16 v102, v203, s6, v102
v_dot2_f32_bf16 v103, v203, s7, v103
v_dot2_f32_bf16 v96, v216, s6, v96
v_dot2_f32_bf16 v97, v216, s7, v97
v_dot2_f32_bf16 v98, v217, s6, v98
v_dot2_f32_bf16 v99, v217, s7, v99
v_dot2_f32_bf16 v100, v218, s6, v100
v_dot2_f32_bf16 v101, v218, s7, v101
v_dot2_f32_bf16 v102, v219, s6, v102
v_dot2_f32_bf16 v103, v219, s7, v103
v_dot2_f32_bf16 v96, v232, s6, v96
v_dot2_f32_bf16 v97, v232, s7, v97
v_dot2_f32_bf16 v98, v233, s6, v98
v_dot2_f32_bf16 v99, v233, s7, v99
v_dot2_f32_bf16 v100, v234, s6, v100
v_dot2_f32_bf16 v101, v234, s7, v101
v_dot2_f32_bf16 v102, v235, s6, v102
v_dot2_f32_bf16 v103, v235, s7, v103
v_cvt_pk_bf16_f32 v12, v96, v97
v_cvt_pk_bf16_f32 v13, v98, v99
v_cvt_pk_bf16_f32 v14, v100, v101
v_cvt_pk_bf16_f32 v15, v102, v103
s_nop 0
v_permlane16_swap_b32 v12, v14
v_permlane16_swap_b32 v13, v15
buffer_store_dwordx4 v[12:15], v8, s[16:19], s3 offen offset:0
s_add_u32 s3, s3, 65536
v_dot2_f32_bf16 v128, v204, s6, v128
v_dot2_f32_bf16 v129, v204, s7, v129
v_dot2_f32_bf16 v130, v205, s6, v130
v_dot2_f32_bf16 v131, v205, s7, v131
v_dot2_f32_bf16 v132, v206, s6, v132
v_dot2_f32_bf16 v133, v206, s7, v133
v_dot2_f32_bf16 v134, v207, s6, v134
v_dot2_f32_bf16 v135, v207, s7, v135
v_dot2_f32_bf16 v128, v220, s6, v128
v_dot2_f32_bf16 v129, v220, s7, v129
v_dot2_f32_bf16 v130, v221, s6, v130
v_dot2_f32_bf16 v131, v221, s7, v131
v_dot2_f32_bf16 v132, v222, s6, v132
v_dot2_f32_bf16 v133, v222, s7, v133
v_dot2_f32_bf16 v134, v223, s6, v134
v_dot2_f32_bf16 v135, v223, s7, v135
v_dot2_f32_bf16 v128, v236, s6, v128
v_dot2_f32_bf16 v129, v236, s7, v129
v_dot2_f32_bf16 v130, v237, s6, v130
v_dot2_f32_bf16 v131, v237, s7, v131
v_dot2_f32_bf16 v132, v238, s6, v132
v_dot2_f32_bf16 v133, v238, s7, v133
v_dot2_f32_bf16 v134, v239, s6, v134
v_dot2_f32_bf16 v135, v239, s7, v135
v_cvt_pk_bf16_f32 v16, v128, v129
v_cvt_pk_bf16_f32 v17, v130, v131
v_cvt_pk_bf16_f32 v18, v132, v133
v_cvt_pk_bf16_f32 v19, v134, v135
s_nop 0
v_permlane16_swap_b32 v16, v18
v_permlane16_swap_b32 v17, v19
buffer_store_dwordx4 v[16:19], v8, s[16:19], s3 offen offset:0
s_endpgm
Lk3_spinb0:
Lk3_spinb0_:
s_add_u32 s61, s61, 1
s_cmp_gt_u32 s61, 1048576
s_cbranch_scc1 Lk3_gotb0
s_sleep 2
buffer_load_dword v7, v15, s[52:55], s43 offen sc1
s_waitcnt vmcnt(0)
v_cmp_ne_u32 vcc, 1, v7
s_nop 0
s_cbranch_vccnz Lk3_spinb0_
s_branch Lk3_gotb0
Lk3_spinb1:
Lk3_spinb1_:
s_add_u32 s61, s61, 1
s_cmp_gt_u32 s61, 1048576
s_cbranch_scc1 Lk3_gotb1
s_sleep 2
buffer_load_dword v7, v15, s[52:55], s43 offen sc1
s_waitcnt vmcnt(0)
v_cmp_ne_u32 vcc, 1, v7
s_nop 0
s_cbranch_vccnz Lk3_spinb1_
s_branch Lk3_gotb1
Lk3_spinb2:
Lk3_spinb2_:
s_add_u32 s61, s61, 1
s_cmp_gt_u32 s61, 1048576
s_cbranch_scc1 Lk3_gotb2
s_sleep 2
buffer_load_dword v7, v15, s[52:55], s43 offen sc1
s_waitcnt vmcnt(0)
v_cmp_ne_u32 vcc, 1, v7
s_nop 0
s_cbranch_vccnz Lk3_spinb2_
s_branch Lk3_gotb2
Lk3_spinb3:
Lk3_spinb3_:
s_add_u32 s61, s61, 1
s_cmp_gt_u32 s61, 1048576
s_cbranch_scc1 Lk3_gotb3
s_sleep 2
buffer_load_dword v7, v15, s[52:55], s43 offen sc1
s_waitcnt vmcnt(0)
v_cmp_ne_u32 vcc, 1, v7
s_nop 0
s_cbranch_vccnz Lk3_spinb3_
s_branch Lk3_gotb3
Lk3_spinft:
s_add_u32 s61, s61, 1
s_cmp_gt_u32 s61, 1048576
s_cbranch_scc1 Lk3_gotft
s_sleep 2
buffer_load_dword v252, v255, s[52:55], s62 offen sc1
s_waitcnt vmcnt(0)
v_cmp_ne_u32 vcc, 1, v252
s_nop 0
s_cbranch_vccnz Lk3_spinft
s_branch Lk3_gotft
Lk3_spinfl:
s_add_u32 s61, s61, 1
s_cmp_gt_u32 s61, 1048576
s_cbranch_scc1 Lk3_gotfl
s_sleep 2
buffer_load_dword v8, v11, s[52:55], s59 offen sc1
s_waitcnt vmcnt(0)
v_cmp_ne_u32 vcc, 1, v8
s_nop 0
s_cbranch_vccnz Lk3_spinfl
s_branch Lk3_gotfl
Lc3:
.section .rodata,"a"
.p2align 6
.amdhsa_kernel concat_heads__compressed_kv_cla__sliding_local_dilated__prompt_kernel
  .amdhsa_next_free_vgpr 512
  .amdhsa_next_free_sgpr 102
  .amdhsa_accum_offset 256
  .amdhsa_group_segment_fixed_size 0
  .amdhsa_kernarg_size 96
  .amdhsa_user_sgpr_count 2
  .amdhsa_user_sgpr_kernarg_segment_ptr 1
  .amdhsa_system_sgpr_workgroup_id_x 1
.end_amdhsa_kernel
```

```asm
; @launch grid=(256,1,1) block=(256,1,1) lds=163840
.amdgcn_target "amdgcn-amd-amdhsa--gfx950"
.text
.macro M d, a, b, c
v_mfma_f32_16x16x32_bf16 \d, \a, \b, \c
.endm
.globl concat_heads__compressed_kv_cla__sliding_local_dilated__prompt_kernel
.p2align 8
.type concat_heads__compressed_kv_cla__sliding_local_dilated__prompt_kernel,@function
concat_heads__compressed_kv_cla__sliding_local_dilated__prompt_kernel:
s_cmp_lt_u32 s2, 256
s_cbranch_scc1 Lk1_go
s_endpgm
Lk1_go:
s_load_dwordx16 s[32:47], s[0:1], 0
s_load_dwordx2 s[48:49], s[0:1], 64
s_load_dwordx2 s[50:51], s[0:1], 88
s_load_dwordx2 s[90:91], s[0:1], 80
v_lshrrev_b32 v24, 6, v0
s_nop 0
v_readfirstlane_b32 s20, v24
v_and_b32 v0, 63, v0
v_lshlrev_b32 v1, 4, v0
s_mov_b32 s101, s20
s_lshr_b32 s21, s20, 1
s_and_b32 s22, s20, 1
s_lshl_b32 s29, s20, 12
s_and_b32 s3, s2, 1
s_lshl_b32 s3, s3, 2
s_bfe_u32 s6, s2, 0x20003
s_add_u32 s3, s3, s6
s_lshl_b32 s52, s3, 8
s_bfe_u32 s3, s2, 0x20001
s_lshl_b32 s3, s3, 2
s_bfe_u32 s7, s2, 0x20005
s_add_u32 s3, s3, s7
s_lshl_b32 s53, s3, 8
s_cmp_lt_u32 s2, 128
s_cselect_b32 s5, 11, 10
s_lshl_b32 s3, s21, 7
s_lshl_b32 s4, s22, 5
s_add_u32 s3, s3, s4
v_lshrrev_b32 v24, 3, v0
v_add_u32 v24, s3, v24
v_and_b32 v25, 7, v0
v_add_u32 v26, 0, v24
v_bfe_u32 v27, v26, 1, 3
v_xor_b32 v27, v27, v25
v_lshlrev_b32 v26, s5, v26
v_lshl_add_u32 v26, v27, 4, v26
v_subrev_u32 v2, 0, v26
v_add_u32 v26, 8, v24
v_bfe_u32 v27, v26, 1, 3
v_xor_b32 v27, v27, v25
v_lshlrev_b32 v26, s5, v26
v_lshl_add_u32 v26, v27, 4, v26
v_subrev_u32 v3, 1024, v26
v_add_u32 v26, 16, v24
v_bfe_u32 v27, v26, 1, 3
v_xor_b32 v27, v27, v25
v_lshlrev_b32 v26, s5, v26
v_lshl_add_u32 v26, v27, 4, v26
v_subrev_u32 v4, 2048, v26
v_add_u32 v26, 24, v24
v_bfe_u32 v27, v26, 1, 3
v_xor_b32 v27, v27, v25
v_lshlrev_b32 v26, s5, v26
v_lshl_add_u32 v26, v27, 4, v26
v_subrev_u32 v5, 3072, v26
s_lshl_b32 s3, s20, 3
v_lshrrev_b32 v24, 5, v0
v_add_u32 v24, s3, v24
v_and_b32 v25, 31, v0
v_add_u32 v26, 0, v24
v_and_b32 v27, 3, v26
v_lshlrev_b32 v27, 1, v27
v_and_or_b32 v27, v26, 8, v27
v_xor_b32 v27, v27, v25
v_lshlrev_b32 v26, 13, v26
v_lshl_add_u32 v26, v27, 4, v26
v_subrev_u32 v6, 0, v26
v_add_u32 v26, 2, v24
v_and_b32 v27, 3, v26
v_lshlrev_b32 v27, 1, v27
v_and_or_b32 v27, v26, 8, v27
v_xor_b32 v27, v27, v25
v_lshlrev_b32 v26, 13, v26
v_lshl_add_u32 v26, v27, 4, v26
v_subrev_u32 v7, 1024, v26
v_add_u32 v26, 4, v24
v_and_b32 v27, 3, v26
v_lshlrev_b32 v27, 1, v27
v_and_or_b32 v27, v26, 8, v27
v_xor_b32 v27, v27, v25
v_lshlrev_b32 v26, 13, v26
v_lshl_add_u32 v26, v27, 4, v26
v_subrev_u32 v8, 2048, v26
v_add_u32 v26, 6, v24
v_and_b32 v27, 3, v26
v_lshlrev_b32 v27, 1, v27
v_and_or_b32 v27, v26, 8, v27
v_xor_b32 v27, v27, v25
v_lshlrev_b32 v26, 13, v26
v_lshl_add_u32 v26, v27, 4, v26
v_subrev_u32 v9, 3072, v26
s_lshl_b32 s23, s52, s5
s_lshl_b32 s31, 64, s5
s_mov_b32 s26, s23
s_lshl_b32 s24, s53, 1
s_mov_b32 s28, s24
s_lshl_b32 s3, 1, s5
s_add_u32 s25, s23, s3
s_lshl_b32 s3, s3, 12
s_add_u32 s27, s24, s3
s_bfe_u32 s3, s2, 0x20001
s_and_b32 s4, s2, 1
s_lshl_b32 s4, s4, 1
s_add_u32 s3, s3, s4
s_and_b32 s3, s3, 3
s_sub_u32 s4, s5, 2
s_lshl_b32 s3, s3, s4
s_add_u32 s23, s23, s3
s_lshl_b32 s3, s3, 12
s_add_u32 s24, s24, s3
s_mov_b32 s95, s6
s_cmp_lt_u32 s2, 128
s_cselect_b32 s6, -1, 8
s_waitcnt lgkmcnt(0)
s_cmp_lt_u32 s2, 128
s_cselect_b64 s[8:9], s[32:33], s[34:35]
s_mov_b32 s10, 2097152
s_cselect_b32 s10, 4194304, s10
s_mov_b32 s11, 0x00020000
s_cselect_b64 s[12:13], s[36:37], s[38:39]
s_mov_b32 s14, 4194304
s_cselect_b32 s14, 8388608, s14
s_mov_b32 s15, 0x00020000
s_mov_b64 s[64:65], s[40:41]
s_add_u32 m0, s29, 65536
s_nop 0
buffer_load_dwordx4 v6, s[12:15], s24 offen offset:0 lds
buffer_load_dwordx4 v7, s[12:15], s24 offen offset:1024 lds
buffer_load_dwordx4 v8, s[12:15], s24 offen offset:2048 lds
buffer_load_dwordx4 v9, s[12:15], s24 offen offset:3072 lds
s_add_u32 s24, s24, 262144
s_add_u32 m0, s29, 0
s_nop 0
buffer_load_dwordx4 v2, s[8:11], s23 offen offset:0 lds
buffer_load_dwordx4 v3, s[8:11], s23 offen offset:1024 lds
buffer_load_dwordx4 v4, s[8:11], s23 offen offset:2048 lds
buffer_load_dwordx4 v5, s[8:11], s23 offen offset:3072 lds
s_add_u32 m0, s29, 81920
s_nop 0
buffer_load_dwordx4 v6, s[12:15], s24 offen offset:0 lds
buffer_load_dwordx4 v7, s[12:15], s24 offen offset:1024 lds
buffer_load_dwordx4 v8, s[12:15], s24 offen offset:2048 lds
buffer_load_dwordx4 v9, s[12:15], s24 offen offset:3072 lds
s_add_u32 s24, s24, 262144
s_cmp_eq_u32 s24, s27
s_cselect_b32 s24, s28, s24
s_sub_u32 s6, s6, 1
s_cmp_eq_u32 s6, 0
s_cselect_b64 s[12:13], s[64:65], s[12:13]
s_add_u32 s16, s50, 117440512
s_addc_u32 s17, s51, 0
s_mov_b32 s18, 16384
s_mov_b32 s19, 0x00020000
v_mov_b32 v24, 0
v_mov_b32 v25, 0
v_mov_b32 v26, 0
v_mov_b32 v27, 0
s_lshl_b32 s3, s2, 4
buffer_store_dwordx4 v[24:27], v24, s[16:19], s3 offen sc1
s_and_b32 s3, s2, 7
s_lshr_b32 s4, s2, 6
s_lshl_b32 s4, s4, 3
s_add_u32 s3, s3, s4
s_lshl_b32 s3, s3, 4
s_add_u32 s3, s3, 4096
s_bfe_u32 s4, s2, 0x30003
s_lshl_b32 s4, s4, 9
s_add_u32 s92, s3, s4
s_sub_u32 s4, 7680, s4
s_add_u32 s93, s3, s4
buffer_store_dwordx4 v[24:27], v24, s[16:19], s92 offen sc1
buffer_store_dwordx4 v[24:27], v24, s[16:19], s93 offen sc1
s_and_b32 s3, s2, 1
s_lshl_b32 s3, s3, 3
s_bfe_u32 s4, s2, 0x30003
s_add_u32 s92, s3, s4
s_bfe_u32 s3, s2, 0x20001
s_lshl_b32 s3, s3, 2
s_lshr_b32 s4, s2, 6
s_xor_b32 s4, s4, 2
s_add_u32 s93, s3, s4
s_lshl_b32 s92, s92, 8
s_lshl_b32 s93, s93, 4
s_add_u32 s92, s92, s93
s_add_u32 s92, s92, 12288
buffer_store_dwordx4 v[24:27], v24, s[16:19], s92 offen sc1
v_lshlrev_b32 v20, 7, v0
s_lshl_b32 s54, s2, 13
s_mov_b64 s[60:61], s[40:41]
s_mov_b32 s62, 0
s_cmp_eq_u32 s20, 1
s_cselect_b64 s[60:61], s[46:47], s[60:61]
s_cselect_b32 s62, 6291456, s62
s_cmp_eq_u32 s20, 2
s_cselect_b64 s[60:61], s[44:45], s[60:61]
s_cselect_b32 s62, 4194304, s62
s_cmp_eq_u32 s20, 3
s_cselect_b32 s62, 0, s62
s_mov_b32 s63, 0x00020000
s_mov_b32 s3, 0
s_cmp_eq_u32 s20, 1
s_cselect_b32 s3, 6291456, s3
s_cmp_eq_u32 s20, 2
s_cselect_b32 s3, 6291456, s3
s_sub_u32 s54, s54, s3
Lc0:
s_add_u32 m0, s29, 98304
s_nop 0
buffer_load_dwordx4 v6, s[12:15], s24 offen offset:0 lds
buffer_load_dwordx4 v7, s[12:15], s24 offen offset:1024 lds
buffer_load_dwordx4 v8, s[12:15], s24 offen offset:2048 lds
buffer_load_dwordx4 v9, s[12:15], s24 offen offset:3072 lds
s_add_u32 s24, s24, 262144
s_lshl_b32 s4, s21, 13
v_and_b32 v24, 15, v0
v_lshlrev_b32 v24, 7, v24
v_add_u32 v24, s4, v24
v_bfe_u32 v25, v0, 1, 3
v_lshrrev_b32 v26, 4, v0
v_xor_b32 v25, v25, v26
v_lshl_add_u32 v10, v25, 4, v24
v_xor_b32 v11, 64, v10
v_bfe_u32 v24, v0, 2, 2
v_lshl_add_u32 v29, v26, 3, v24
v_lshlrev_b32 v25, 9, v29
v_and_b32 v27, 1, v0
v_lshl_add_u32 v25, v27, 3, v25
v_add_u32 v25, 65536, v25
v_lshlrev_b32 v24, 1, v24
v_and_or_b32 v24, v29, 8, v24
v_bfe_u32 v26, v0, 1, 1
s_lshl_b32 s4, s22, 4
s_add_u32 s3, s4, 0
v_add_u32 v27, s3, v26
v_xor_b32 v27, v27, v24
v_lshl_add_u32 v12, v27, 4, v25
s_add_u32 s3, s4, 2
v_add_u32 v27, s3, v26
v_xor_b32 v27, v27, v24
v_lshl_add_u32 v13, v27, 4, v25
s_add_u32 s3, s4, 4
v_add_u32 v27, s3, v26
v_xor_b32 v27, v27, v24
v_lshl_add_u32 v14, v27, 4, v25
s_add_u32 s3, s4, 6
v_add_u32 v27, s3, v26
v_xor_b32 v27, v27, v24
v_lshl_add_u32 v15, v27, 4, v25
s_add_u32 s3, s4, 8
v_add_u32 v27, s3, v26
v_xor_b32 v27, v27, v24
v_lshl_add_u32 v16, v27, 4, v25
s_add_u32 s3, s4, 10
v_add_u32 v27, s3, v26
v_xor_b32 v27, v27, v24
v_lshl_add_u32 v17, v27, 4, v25
s_add_u32 s3, s4, 12
v_add_u32 v27, s3, v26
v_xor_b32 v27, v27, v24
v_lshl_add_u32 v18, v27, 4, v25
s_add_u32 s3, s4, 14
v_add_u32 v27, s3, v26
v_xor_b32 v27, v27, v24
v_lshl_add_u32 v19, v27, 4, v25
s_waitcnt vmcnt(8)
s_barrier
ds_read_b64_tr_b16 a[32:33], v12 offset:0
ds_read_b64_tr_b16 a[34:35], v12 offset:2048
ds_read_b64_tr_b16 a[40:41], v13 offset:0
ds_read_b64_tr_b16 a[42:43], v13 offset:2048
ds_read_b64_tr_b16 a[48:49], v14 offset:0
ds_read_b64_tr_b16 a[50:51], v14 offset:2048
ds_read_b64_tr_b16 a[56:57], v15 offset:0
ds_read_b64_tr_b16 a[58:59], v15 offset:2048
ds_read_b64_tr_b16 a[64:65], v16 offset:0
ds_read_b64_tr_b16 a[66:67], v16 offset:2048
ds_read_b64_tr_b16 a[72:73], v17 offset:0
ds_read_b64_tr_b16 a[74:75], v17 offset:2048
ds_read_b64_tr_b16 a[80:81], v18 offset:0
ds_read_b64_tr_b16 a[82:83], v18 offset:2048
ds_read_b64_tr_b16 a[88:89], v19 offset:0
ds_read_b64_tr_b16 a[90:91], v19 offset:2048
ds_read_b64_tr_b16 a[36:37], v12 offset:16384
ds_read_b64_tr_b16 a[38:39], v12 offset:18432
ds_read_b64_tr_b16 a[44:45], v13 offset:16384
ds_read_b64_tr_b16 a[46:47], v13 offset:18432
ds_read_b64_tr_b16 a[52:53], v14 offset:16384
ds_read_b64_tr_b16 a[54:55], v14 offset:18432
ds_read_b64_tr_b16 a[60:61], v15 offset:16384
ds_read_b64_tr_b16 a[62:63], v15 offset:18432
ds_read_b64_tr_b16 a[68:69], v16 offset:16384
ds_read_b64_tr_b16 a[70:71], v16 offset:18432
ds_read_b64_tr_b16 a[76:77], v17 offset:16384
ds_read_b64_tr_b16 a[78:79], v17 offset:18432
ds_read_b64_tr_b16 a[84:85], v18 offset:16384
ds_read_b64_tr_b16 a[86:87], v18 offset:18432
ds_read_b64_tr_b16 a[92:93], v19 offset:16384
ds_read_b64_tr_b16 a[94:95], v19 offset:18432
ds_read_b128 a[160:163], v10 offset:0
ds_read_b128 a[164:167], v11 offset:0
ds_read_b128 a[168:171], v10 offset:2048
ds_read_b128 a[172:175], v11 offset:2048
s_add_u32 m0, s29, 16384
s_add_u32 s3, s23, s31
s_nop 0
buffer_load_dwordx4 v2, s[8:11], s3 offen offset:0 lds
buffer_load_dwordx4 v3, s[8:11], s3 offen offset:1024 lds
buffer_load_dwordx4 v4, s[8:11], s3 offen offset:2048 lds
buffer_load_dwordx4 v5, s[8:11], s3 offen offset:3072 lds
s_add_u32 s23, s23, 128
s_cmp_eq_u32 s23, s25
s_cselect_b32 s23, s26, s23
s_add_u32 m0, s29, 114688
s_nop 0
buffer_load_dwordx4 v6, s[12:15], s24 offen offset:0 lds
buffer_load_dwordx4 v7, s[12:15], s24 offen offset:1024 lds
buffer_load_dwordx4 v8, s[12:15], s24 offen offset:2048 lds
buffer_load_dwordx4 v9, s[12:15], s24 offen offset:3072 lds
s_add_u32 s24, s24, 262144
s_cmp_eq_u32 s24, s27
s_cselect_b32 s24, s28, s24
s_sub_u32 s6, s6, 1
s_cmp_eq_u32 s6, 0
s_cselect_b64 s[12:13], s[64:65], s[12:13]
s_waitcnt vmcnt(8) lgkmcnt(0)
s_barrier
s_getpc_b64 s[92:93]
Lpc_1:
s_add_u32 s92, s92, Lc1-Lpc_1
s_addc_u32 s93, s93, 0
s_lshr_b32 s94, s2, 3
s_mul_i32 s94, s94, ((Lc3-Lc1)/32+127)&~127
v_lshlrev_b32 v24, 7, v0
v_add_u32 v24, s94, v24
v_min_u32 v24, Lc3-Lc1-4, v24
global_load_dword v21, v24, s[92:93]
Lc1:
s_cmp_lt_u32 s2, 128
s_cbranch_scc0 Lk1_kv
M v[32:35], a[32:35], a[160:163], 0
s_add_u32 m0, s29, 32768
s_nop 0
buffer_load_dwordx4 v2, s[8:11], s23 offen offset:0 lds
M v[32:35], a[36:39], a[164:167], v[32:35]
ds_read_b128 a[176:179], v10 offset:4096
ds_read_b128 a[180:183], v11 offset:4096
M v[36:39], a[44:47], a[164:167], 0
M v[36:39], a[40:43], a[160:163], v[36:39]
ds_read_b64_tr_b16 a[96:97], v12 offset:32768
ds_read_b64_tr_b16 a[98:99], v12 offset:34816
M v[40:43], a[48:51], a[160:163], 0
M v[40:43], a[52:55], a[164:167], v[40:43]
buffer_load_dwordx4 v3, s[8:11], s23 offen offset:1024 lds
M v[44:47], a[60:63], a[164:167], 0
M v[44:47], a[56:59], a[160:163], v[44:47]
ds_read_b64_tr_b16 a[104:105], v13 offset:32768
ds_read_b64_tr_b16 a[106:107], v13 offset:34816
M v[48:51], a[64:67], a[160:163], 0
M v[48:51], a[68:71], a[164:167], v[48:51]
buffer_load_dwordx4 v4, s[8:11], s23 offen offset:2048 lds
M v[52:55], a[76:79], a[164:167], 0
M v[52:55], a[72:75], a[160:163], v[52:55]
ds_read_b64_tr_b16 a[112:113], v14 offset:32768
ds_read_b64_tr_b16 a[114:115], v14 offset:34816
M v[56:59], a[80:83], a[160:163], 0
M v[56:59], a[84:87], a[164:167], v[56:59]
buffer_load_dwordx4 v5, s[8:11], s23 offen offset:3072 lds
M v[60:63], a[92:95], a[164:167], 0
M v[60:63], a[88:91], a[160:163], v[60:63]
ds_read_b64_tr_b16 a[120:121], v15 offset:32768
ds_read_b64_tr_b16 a[122:123], v15 offset:34816
M v[64:67], a[32:35], a[168:171], 0
M v[64:67], a[36:39], a[172:175], v[64:67]
ds_read_b128 a[184:187], v10 offset:6144
ds_read_b128 a[188:191], v11 offset:6144
M v[68:71], a[44:47], a[172:175], 0
s_add_u32 m0, s29, 65536
s_nop 0
buffer_load_dwordx4 v6, s[12:15], s24 offen offset:0 lds
M v[68:71], a[40:43], a[168:171], v[68:71]
ds_read_b64_tr_b16 a[128:129], v16 offset:32768
ds_read_b64_tr_b16 a[130:131], v16 offset:34816
M v[72:75], a[48:51], a[168:171], 0
M v[72:75], a[52:55], a[172:175], v[72:75]
M v[76:79], a[60:63], a[172:175], 0
buffer_load_dwordx4 v7, s[12:15], s24 offen offset:1024 lds
M v[76:79], a[56:59], a[168:171], v[76:79]
ds_read_b64_tr_b16 a[136:137], v17 offset:32768
ds_read_b64_tr_b16 a[138:139], v17 offset:34816
M v[80:83], a[64:67], a[168:171], 0
M v[80:83], a[68:71], a[172:175], v[80:83]
M v[84:87], a[76:79], a[172:175], 0
buffer_load_dwordx4 v8, s[12:15], s24 offen offset:2048 lds
M v[84:87], a[72:75], a[168:171], v[84:87]
ds_read_b64_tr_b16 a[144:145], v18 offset:32768
ds_read_b64_tr_b16 a[146:147], v18 offset:34816
M v[88:91], a[80:83], a[168:171], 0
M v[88:91], a[84:87], a[172:175], v[88:91]
M v[92:95], a[92:95], a[172:175], 0
buffer_load_dwordx4 v9, s[12:15], s24 offen offset:3072 lds
M v[92:95], a[88:91], a[168:171], v[92:95]
s_waitcnt lgkmcnt(15)
ds_read_b64_tr_b16 a[152:153], v19 offset:32768
ds_read_b64_tr_b16 a[154:155], v19 offset:34816
M v[96:99], a[32:35], a[176:179], 0
M v[96:99], a[36:39], a[180:183], v[96:99]
M v[100:103], a[44:47], a[180:183], 0
s_add_u32 s24, s24, 262144
M v[100:103], a[40:43], a[176:179], v[100:103]
M v[104:107], a[48:51], a[176:179], 0
M v[104:107], a[52:55], a[180:183], v[104:107]
M v[108:111], a[60:63], a[180:183], 0
M v[108:111], a[56:59], a[176:179], v[108:111]
s_waitcnt vmcnt(9) lgkmcnt(0)
s_barrier
ds_read_b128 a[160:163], v10 offset:16384
ds_read_b128 a[164:167], v11 offset:16384
M v[112:115], a[64:67], a[176:179], 0
s_add_u32 m0, s29, 49152
s_add_u32 s3, s23, s31
buffer_load_dwordx4 v2, s[8:11], s3 offen offset:0 lds
M v[112:115], a[68:71], a[180:183], v[112:115]
M v[116:119], a[76:79], a[180:183], 0
M v[116:119], a[72:75], a[176:179], v[116:119]
ds_read_b64_tr_b16 a[100:101], v12 offset:49152
ds_read_b64_tr_b16 a[102:103], v12 offset:51200
M v[120:123], a[80:83], a[176:179], 0
M v[120:123], a[84:87], a[180:183], v[120:123]
buffer_load_dwordx4 v3, s[8:11], s3 offen offset:1024 lds
M v[124:127], a[92:95], a[180:183], 0
M v[124:127], a[88:91], a[176:179], v[124:127]
M v[128:131], a[32:35], a[184:187], 0
M v[128:131], a[36:39], a[188:191], v[128:131]
ds_read_b128 a[168:171], v10 offset:18432
ds_read_b128 a[172:175], v11 offset:18432
ds_read_b64_tr_b16 a[108:109], v13 offset:49152
ds_read_b64_tr_b16 a[110:111], v13 offset:51200
M v[132:135], a[44:47], a[188:191], 0
M v[132:135], a[40:43], a[184:187], v[132:135]
buffer_load_dwordx4 v4, s[8:11], s3 offen offset:2048 lds
M v[136:139], a[48:51], a[184:187], 0
M v[136:139], a[52:55], a[188:191], v[136:139]
M v[140:143], a[60:63], a[188:191], 0
M v[140:143], a[56:59], a[184:187], v[140:143]
ds_read_b64_tr_b16 a[116:117], v14 offset:49152
ds_read_b64_tr_b16 a[118:119], v14 offset:51200
M v[144:147], a[64:67], a[184:187], 0
M v[144:147], a[68:71], a[188:191], v[144:147]
buffer_load_dwordx4 v5, s[8:11], s3 offen offset:3072 lds
M v[148:151], a[76:79], a[188:191], 0
M v[148:151], a[72:75], a[184:187], v[148:151]
M v[152:155], a[80:83], a[184:187], 0
M v[152:155], a[84:87], a[188:191], v[152:155]
ds_read_b64_tr_b16 a[124:125], v15 offset:49152
ds_read_b64_tr_b16 a[126:127], v15 offset:51200
M v[156:159], a[92:95], a[188:191], 0
s_add_u32 s23, s23, 128
s_cmp_eq_u32 s23, s25
s_cselect_b32 s23, s26, s23
M v[156:159], a[88:91], a[184:187], v[156:159]
s_waitcnt lgkmcnt(10)
M v[160:163], a[32:35], a[160:163], 0
M v[160:163], a[36:39], a[164:167], v[160:163]
ds_read_b128 a[176:179], v10 offset:20480
ds_read_b128 a[180:183], v11 offset:20480
M v[164:167], a[44:47], a[164:167], 0
M v[164:167], a[40:43], a[160:163], v[164:167]
ds_read_b64_tr_b16 a[132:133], v16 offset:49152
ds_read_b64_tr_b16 a[134:135], v16 offset:51200
M v[168:171], a[48:51], a[160:163], 0
M v[168:171], a[52:55], a[164:167], v[168:171]
s_add_u32 m0, s29, 81920
s_nop 0
buffer_load_dwordx4 v6, s[12:15], s24 offen offset:0 lds
M v[172:175], a[60:63], a[164:167], 0
M v[172:175], a[56:59], a[160:163], v[172:175]
M v[176:179], a[64:67], a[160:163], 0
M v[176:179], a[68:71], a[164:167], v[176:179]
ds_read_b64_tr_b16 a[140:141], v17 offset:49152
ds_read_b64_tr_b16 a[142:143], v17 offset:51200
M v[180:183], a[76:79], a[164:167], 0
M v[180:183], a[72:75], a[160:163], v[180:183]
buffer_load_dwordx4 v7, s[12:15], s24 offen offset:1024 lds
M v[184:187], a[80:83], a[160:163], 0
M v[184:187], a[84:87], a[164:167], v[184:187]
M v[188:191], a[92:95], a[164:167], 0
M v[188:191], a[88:91], a[160:163], v[188:191]
s_waitcnt lgkmcnt(12)
ds_read_b64_tr_b16 a[148:149], v18 offset:49152
ds_read_b64_tr_b16 a[150:151], v18 offset:51200
M v[192:195], a[32:35], a[168:171], 0
buffer_load_dwordx4 v8, s[12:15], s24 offen offset:2048 lds
M v[192:195], a[36:39], a[172:175], v[192:195]
ds_read_b128 a[184:187], v10 offset:22528
ds_read_b128 a[188:191], v11 offset:22528
M v[196:199], a[44:47], a[172:175], 0
M v[196:199], a[40:43], a[168:171], v[196:199]
M v[200:203], a[48:51], a[168:171], 0
M v[200:203], a[52:55], a[172:175], v[200:203]
ds_read_b64_tr_b16 a[156:157], v19 offset:49152
ds_read_b64_tr_b16 a[158:159], v19 offset:51200
M v[204:207], a[60:63], a[172:175], 0
buffer_load_dwordx4 v9, s[12:15], s24 offen offset:3072 lds
M v[204:207], a[56:59], a[168:171], v[204:207]
M v[208:211], a[64:67], a[168:171], 0
M v[208:211], a[68:71], a[172:175], v[208:211]
M v[212:215], a[76:79], a[172:175], 0
M v[212:215], a[72:75], a[168:171], v[212:215]
s_add_u32 s24, s24, 262144
s_cmp_eq_u32 s24, s27
s_cselect_b32 s24, s28, s24
s_sub_u32 s6, s6, 1
s_cmp_eq_u32 s6, 0
s_cselect_b64 s[12:13], s[64:65], s[12:13]
M v[216:219], a[80:83], a[168:171], 0
M v[216:219], a[84:87], a[172:175], v[216:219]
M v[220:223], a[92:95], a[172:175], 0
M v[220:223], a[88:91], a[168:171], v[220:223]
s_waitcnt lgkmcnt(10)
M v[224:227], a[32:35], a[176:179], 0
buffer_load_dword v21, v20, s[60:63], s54 offen
s_add_u32 s54, s54, 1048576
M v[224:227], a[36:39], a[180:183], v[224:227]
M v[228:231], a[44:47], a[180:183], 0
M v[228:231], a[40:43], a[176:179], v[228:231]
M v[232:235], a[48:51], a[176:179], 0
M v[232:235], a[52:55], a[180:183], v[232:235]
M v[236:239], a[60:63], a[180:183], 0
M v[236:239], a[56:59], a[176:179], v[236:239]
s_waitcnt vmcnt(9) lgkmcnt(0)
s_barrier
ds_read_b128 a[160:163], v10 offset:32768
ds_read_b128 a[164:167], v11 offset:32768
M v[240:243], a[64:67], a[176:179], 0
s_add_u32 m0, s29, 0
s_nop 0
buffer_load_dwordx4 v2, s[8:11], s23 offen offset:0 lds
M v[240:243], a[68:71], a[180:183], v[240:243]
M v[244:247], a[76:79], a[180:183], 0
M v[244:247], a[72:75], a[176:179], v[244:247]
M v[248:251], a[80:83], a[176:179], 0
M v[248:251], a[84:87], a[180:183], v[248:251]
buffer_load_dwordx4 v3, s[8:11], s23 offen offset:1024 lds
M v[252:255], a[92:95], a[180:183], 0
M v[252:255], a[88:91], a[176:179], v[252:255]
M a[0:3], a[32:35], a[184:187], 0
M a[0:3], a[36:39], a[188:191], a[0:3]
ds_read_b128 a[168:171], v10 offset:34816
ds_read_b128 a[172:175], v11 offset:34816
M a[4:7], a[44:47], a[188:191], 0
M a[4:7], a[40:43], a[184:187], a[4:7]
M a[8:11], a[48:51], a[184:187], 0
buffer_load_dwordx4 v4, s[8:11], s23 offen offset:2048 lds
M a[8:11], a[52:55], a[188:191], a[8:11]
M a[12:15], a[60:63], a[188:191], 0
M a[12:15], a[56:59], a[184:187], a[12:15]
M a[16:19], a[64:67], a[184:187], 0
M a[16:19], a[68:71], a[188:191], a[16:19]
buffer_load_dwordx4 v5, s[8:11], s23 offen offset:3072 lds
M a[20:23], a[76:79], a[188:191], 0
M a[20:23], a[72:75], a[184:187], a[20:23]
M a[24:27], a[80:83], a[184:187], 0
M a[24:27], a[84:87], a[188:191], a[24:27]
M a[28:31], a[92:95], a[188:191], 0
M a[28:31], a[88:91], a[184:187], a[28:31]
s_waitcnt lgkmcnt(2)
M v[32:35], a[96:99], a[160:163], v[32:35]
s_add_u32 m0, s29, 98304
s_nop 0
buffer_load_dwordx4 v6, s[12:15], s24 offen offset:0 lds
M v[32:35], a[100:103], a[164:167], v[32:35]
ds_read_b128 a[176:179], v10 offset:36864
ds_read_b128 a[180:183], v11 offset:36864
M v[36:39], a[108:111], a[164:167], v[36:39]
M v[36:39], a[104:107], a[160:163], v[36:39]
ds_read_b64_tr_b16 a[32:33], v12 offset:0
ds_read_b64_tr_b16 a[34:35], v12 offset:2048
M v[40:43], a[112:115], a[160:163], v[40:43]
M v[40:43], a[116:119], a[164:167], v[40:43]
M v[44:47], a[124:127], a[164:167], v[44:47]
M v[44:47], a[120:123], a[160:163], v[44:47]
ds_read_b64_tr_b16 a[40:41], v13 offset:0
ds_read_b64_tr_b16 a[42:43], v13 offset:2048
M v[48:51], a[128:131], a[160:163], v[48:51]
buffer_load_dwordx4 v7, s[12:15], s24 offen offset:1024 lds
M v[48:51], a[132:135], a[164:167], v[48:51]
M v[52:55], a[140:143], a[164:167], v[52:55]
M v[52:55], a[136:139], a[160:163], v[52:55]
ds_read_b64_tr_b16 a[48:49], v14 offset:0
ds_read_b64_tr_b16 a[50:51], v14 offset:2048
M v[56:59], a[144:147], a[160:163], v[56:59]
M v[56:59], a[148:151], a[164:167], v[56:59]
M v[60:63], a[156:159], a[164:167], v[60:63]
buffer_load_dwordx4 v8, s[12:15], s24 offen offset:2048 lds
M v[60:63], a[152:155], a[160:163], v[60:63]
s_waitcnt lgkmcnt(8)
ds_read_b64_tr_b16 a[56:57], v15 offset:0
ds_read_b64_tr_b16 a[58:59], v15 offset:2048
M v[64:67], a[96:99], a[168:171], v[64:67]
M v[64:67], a[100:103], a[172:175], v[64:67]
ds_read_b128 a[184:187], v10 offset:38912
ds_read_b128 a[188:191], v11 offset:38912
M v[68:71], a[108:111], a[172:175], v[68:71]
M v[68:71], a[104:107], a[168:171], v[68:71]
ds_read_b64_tr_b16 a[64:65], v16 offset:0
ds_read_b64_tr_b16 a[66:67], v16 offset:2048
M v[72:75], a[112:115], a[168:171], v[72:75]
M v[72:75], a[116:119], a[172:175], v[72:75]
M v[76:79], a[124:127], a[172:175], v[76:79]
M v[76:79], a[120:123], a[168:171], v[76:79]
ds_read_b64_tr_b16 a[72:73], v17 offset:0
ds_read_b64_tr_b16 a[74:75], v17 offset:2048
M v[80:83], a[128:131], a[168:171], v[80:83]
buffer_load_dwordx4 v9, s[12:15], s24 offen offset:3072 lds
M v[80:83], a[132:135], a[172:175], v[80:83]
M v[84:87], a[140:143], a[172:175], v[84:87]
M v[84:87], a[136:139], a[168:171], v[84:87]
ds_read_b64_tr_b16 a[80:81], v18 offset:0
ds_read_b64_tr_b16 a[82:83], v18 offset:2048
M v[88:91], a[144:147], a[168:171], v[88:91]
M v[88:91], a[148:151], a[172:175], v[88:91]
M v[92:95], a[156:159], a[172:175], v[92:95]
s_add_u32 s24, s24, 262144
M v[92:95], a[152:155], a[168:171], v[92:95]
s_waitcnt lgkmcnt(15)
ds_read_b64_tr_b16 a[88:89], v19 offset:0
ds_read_b64_tr_b16 a[90:91], v19 offset:2048
M v[96:99], a[96:99], a[176:179], v[96:99]
M v[96:99], a[100:103], a[180:183], v[96:99]
M v[100:103], a[108:111], a[180:183], v[100:103]
M v[100:103], a[104:107], a[176:179], v[100:103]
M v[104:107], a[112:115], a[176:179], v[104:107]
M v[104:107], a[116:119], a[180:183], v[104:107]
M v[108:111], a[124:127], a[180:183], v[108:111]
M v[108:111], a[120:123], a[176:179], v[108:111]
s_waitcnt vmcnt(9) lgkmcnt(0)
s_barrier
ds_read_b128 a[160:163], v10 offset:49152
ds_read_b128 a[164:167], v11 offset:49152
M v[112:115], a[128:131], a[176:179], v[112:115]
s_add_u32 m0, s29, 16384
s_add_u32 s3, s23, s31
buffer_load_dwordx4 v2, s[8:11], s3 offen offset:0 lds
M v[112:115], a[132:135], a[180:183], v[112:115]
M v[116:119], a[140:143], a[180:183], v[116:119]
M v[116:119], a[136:139], a[176:179], v[116:119]
ds_read_b64_tr_b16 a[36:37], v12 offset:16384
ds_read_b64_tr_b16 a[38:39], v12 offset:18432
M v[120:123], a[144:147], a[176:179], v[120:123]
M v[120:123], a[148:151], a[180:183], v[120:123]
buffer_load_dwordx4 v3, s[8:11], s3 offen offset:1024 lds
M v[124:127], a[156:159], a[180:183], v[124:127]
M v[124:127], a[152:155], a[176:179], v[124:127]
M v[128:131], a[96:99], a[184:187], v[128:131]
M v[128:131], a[100:103], a[188:191], v[128:131]
ds_read_b128 a[168:171], v10 offset:51200
ds_read_b128 a[172:175], v11 offset:51200
ds_read_b64_tr_b16 a[44:45], v13 offset:16384
ds_read_b64_tr_b16 a[46:47], v13 offset:18432
M v[132:135], a[108:111], a[188:191], v[132:135]
M v[132:135], a[104:107], a[184:187], v[132:135]
buffer_load_dwordx4 v4, s[8:11], s3 offen offset:2048 lds
M v[136:139], a[112:115], a[184:187], v[136:139]
M v[136:139], a[116:119], a[188:191], v[136:139]
M v[140:143], a[124:127], a[188:191], v[140:143]
M v[140:143], a[120:123], a[184:187], v[140:143]
ds_read_b64_tr_b16 a[52:53], v14 offset:16384
ds_read_b64_tr_b16 a[54:55], v14 offset:18432
M v[144:147], a[128:131], a[184:187], v[144:147]
M v[144:147], a[132:135], a[188:191], v[144:147]
buffer_load_dwordx4 v5, s[8:11], s3 offen offset:3072 lds
M v[148:151], a[140:143], a[188:191], v[148:151]
M v[148:151], a[136:139], a[184:187], v[148:151]
M v[152:155], a[144:147], a[184:187], v[152:155]
M v[152:155], a[148:151], a[188:191], v[152:155]
ds_read_b64_tr_b16 a[60:61], v15 offset:16384
ds_read_b64_tr_b16 a[62:63], v15 offset:18432
M v[156:159], a[156:159], a[188:191], v[156:159]
s_add_u32 s23, s23, 128
s_cmp_eq_u32 s23, s25
s_cselect_b32 s23, s26, s23
M v[156:159], a[152:155], a[184:187], v[156:159]
s_waitcnt lgkmcnt(10)
M v[160:163], a[96:99], a[160:163], v[160:163]
M v[160:163], a[100:103], a[164:167], v[160:163]
ds_read_b128 a[176:179], v10 offset:53248
ds_read_b128 a[180:183], v11 offset:53248
M v[164:167], a[108:111], a[164:167], v[164:167]
M v[164:167], a[104:107], a[160:163], v[164:167]
ds_read_b64_tr_b16 a[68:69], v16 offset:16384
ds_read_b64_tr_b16 a[70:71], v16 offset:18432
M v[168:171], a[112:115], a[160:163], v[168:171]
M v[168:171], a[116:119], a[164:167], v[168:171]
s_add_u32 m0, s29, 114688
s_nop 0
buffer_load_dwordx4 v6, s[12:15], s24 offen offset:0 lds
M v[172:175], a[124:127], a[164:167], v[172:175]
M v[172:175], a[120:123], a[160:163], v[172:175]
M v[176:179], a[128:131], a[160:163], v[176:179]
M v[176:179], a[132:135], a[164:167], v[176:179]
ds_read_b64_tr_b16 a[76:77], v17 offset:16384
ds_read_b64_tr_b16 a[78:79], v17 offset:18432
M v[180:183], a[140:143], a[164:167], v[180:183]
M v[180:183], a[136:139], a[160:163], v[180:183]
buffer_load_dwordx4 v7, s[12:15], s24 offen offset:1024 lds
M v[184:187], a[144:147], a[160:163], v[184:187]
M v[184:187], a[148:151], a[164:167], v[184:187]
M v[188:191], a[156:159], a[164:167], v[188:191]
M v[188:191], a[152:155], a[160:163], v[188:191]
s_waitcnt lgkmcnt(12)
ds_read_b64_tr_b16 a[84:85], v18 offset:16384
ds_read_b64_tr_b16 a[86:87], v18 offset:18432
M v[192:195], a[96:99], a[168:171], v[192:195]
buffer_load_dwordx4 v8, s[12:15], s24 offen offset:2048 lds
M v[192:195], a[100:103], a[172:175], v[192:195]
ds_read_b128 a[184:187], v10 offset:55296
ds_read_b128 a[188:191], v11 offset:55296
M v[196:199], a[108:111], a[172:175], v[196:199]
M v[196:199], a[104:107], a[168:171], v[196:199]
M v[200:203], a[112:115], a[168:171], v[200:203]
M v[200:203], a[116:119], a[172:175], v[200:203]
ds_read_b64_tr_b16 a[92:93], v19 offset:16384
ds_read_b64_tr_b16 a[94:95], v19 offset:18432
M v[204:207], a[124:127], a[172:175], v[204:207]
buffer_load_dwordx4 v9, s[12:15], s24 offen offset:3072 lds
M v[204:207], a[120:123], a[168:171], v[204:207]
M v[208:211], a[128:131], a[168:171], v[208:211]
M v[208:211], a[132:135], a[172:175], v[208:211]
M v[212:215], a[140:143], a[172:175], v[212:215]
M v[212:215], a[136:139], a[168:171], v[212:215]
s_add_u32 s24, s24, 262144
s_cmp_eq_u32 s24, s27
s_cselect_b32 s24, s28, s24
s_sub_u32 s6, s6, 1
s_cmp_eq_u32 s6, 0
s_cselect_b64 s[12:13], s[64:65], s[12:13]
M v[216:219], a[144:147], a[168:171], v[216:219]
M v[216:219], a[148:151], a[172:175], v[216:219]
M v[220:223], a[156:159], a[172:175], v[220:223]
M v[220:223], a[152:155], a[168:171], v[220:223]
s_waitcnt lgkmcnt(10)
M v[224:227], a[96:99], a[176:179], v[224:227]
buffer_load_dword v21, v20, s[60:63], s54 offen
s_add_u32 s54, s54, 1048576
M v[224:227], a[100:103], a[180:183], v[224:227]
M v[228:231], a[108:111], a[180:183], v[228:231]
M v[228:231], a[104:107], a[176:179], v[228:231]
M v[232:235], a[112:115], a[176:179], v[232:235]
M v[232:235], a[116:119], a[180:183], v[232:235]
M v[236:239], a[124:127], a[180:183], v[236:239]
M v[236:239], a[120:123], a[176:179], v[236:239]
s_waitcnt vmcnt(9) lgkmcnt(0)
s_barrier
ds_read_b128 a[160:163], v10 offset:0
ds_read_b128 a[164:167], v11 offset:0
M v[240:243], a[128:131], a[176:179], v[240:243]
s_add_u32 m0, s29, 32768
s_nop 0
buffer_load_dwordx4 v2, s[8:11], s23 offen offset:0 lds
M v[240:243], a[132:135], a[180:183], v[240:243]
M v[244:247], a[140:143], a[180:183], v[244:247]
M v[244:247], a[136:139], a[176:179], v[244:247]
M v[248:251], a[144:147], a[176:179], v[248:251]
M v[248:251], a[148:151], a[180:183], v[248:251]
buffer_load_dwordx4 v3, s[8:11], s23 offen offset:1024 lds
M v[252:255], a[156:159], a[180:183], v[252:255]
M v[252:255], a[152:155], a[176:179], v[252:255]
M a[0:3], a[96:99], a[184:187], a[0:3]
M a[0:3], a[100:103], a[188:191], a[0:3]
ds_read_b128 a[168:171], v10 offset:2048
ds_read_b128 a[172:175], v11 offset:2048
M a[4:7], a[108:111], a[188:191], a[4:7]
M a[4:7], a[104:107], a[184:187], a[4:7]
M a[8:11], a[112:115], a[184:187], a[8:11]
buffer_load_dwordx4 v4, s[8:11], s23 offen offset:2048 lds
M a[8:11], a[116:119], a[188:191], a[8:11]
M a[12:15], a[124:127], a[188:191], a[12:15]
M a[12:15], a[120:123], a[184:187], a[12:15]
M a[16:19], a[128:131], a[184:187], a[16:19]
M a[16:19], a[132:135], a[188:191], a[16:19]
buffer_load_dwordx4 v5, s[8:11], s23 offen offset:3072 lds
M a[20:23], a[140:143], a[188:191], a[20:23]
M a[20:23], a[136:139], a[184:187], a[20:23]
M a[24:27], a[144:147], a[184:187], a[24:27]
M a[24:27], a[148:151], a[188:191], a[24:27]
M a[28:31], a[156:159], a[188:191], a[28:31]
M a[28:31], a[152:155], a[184:187], a[28:31]
s_waitcnt lgkmcnt(2)
s_mov_b32 s30, 5
Lk1_ql:
M v[32:35], a[32:35], a[160:163], v[32:35]
s_add_u32 m0, s29, 65536
s_nop 0
buffer_load_dwordx4 v6, s[12:15], s24 offen offset:0 lds
M v[32:35], a[36:39], a[164:167], v[32:35]
ds_read_b128 a[176:179], v10 offset:4096
ds_read_b128 a[180:183], v11 offset:4096
M v[36:39], a[44:47], a[164:167], v[36:39]
M v[36:39], a[40:43], a[160:163], v[36:39]
ds_read_b64_tr_b16 a[96:97], v12 offset:32768
ds_read_b64_tr_b16 a[98:99], v12 offset:34816
M v[40:43], a[48:51], a[160:163], v[40:43]
M v[40:43], a[52:55], a[164:167], v[40:43]
M v[44:47], a[60:63], a[164:167], v[44:47]
M v[44:47], a[56:59], a[160:163], v[44:47]
ds_read_b64_tr_b16 a[104:105], v13 offset:32768
ds_read_b64_tr_b16 a[106:107], v13 offset:34816
M v[48:51], a[64:67], a[160:163], v[48:51]
buffer_load_dwordx4 v7, s[12:15], s24 offen offset:1024 lds
M v[48:51], a[68:71], a[164:167], v[48:51]
M v[52:55], a[76:79], a[164:167], v[52:55]
M v[52:55], a[72:75], a[160:163], v[52:55]
ds_read_b64_tr_b16 a[112:113], v14 offset:32768
ds_read_b64_tr_b16 a[114:115], v14 offset:34816
M v[56:59], a[80:83], a[160:163], v[56:59]
M v[56:59], a[84:87], a[164:167], v[56:59]
M v[60:63], a[92:95], a[164:167], v[60:63]
buffer_load_dwordx4 v8, s[12:15], s24 offen offset:2048 lds
M v[60:63], a[88:91], a[160:163], v[60:63]
s_waitcnt lgkmcnt(8)
ds_read_b64_tr_b16 a[120:121], v15 offset:32768
ds_read_b64_tr_b16 a[122:123], v15 offset:34816
M v[64:67], a[32:35], a[168:171], v[64:67]
M v[64:67], a[36:39], a[172:175], v[64:67]
ds_read_b128 a[184:187], v10 offset:6144
ds_read_b128 a[188:191], v11 offset:6144
M v[68:71], a[44:47], a[172:175], v[68:71]
M v[68:71], a[40:43], a[168:171], v[68:71]
ds_read_b64_tr_b16 a[128:129], v16 offset:32768
ds_read_b64_tr_b16 a[130:131], v16 offset:34816
M v[72:75], a[48:51], a[168:171], v[72:75]
M v[72:75], a[52:55], a[172:175], v[72:75]
M v[76:79], a[60:63], a[172:175], v[76:79]
M v[76:79], a[56:59], a[168:171], v[76:79]
ds_read_b64_tr_b16 a[136:137], v17 offset:32768
ds_read_b64_tr_b16 a[138:139], v17 offset:34816
M v[80:83], a[64:67], a[168:171], v[80:83]
buffer_load_dwordx4 v9, s[12:15], s24 offen offset:3072 lds
M v[80:83], a[68:71], a[172:175], v[80:83]
M v[84:87], a[76:79], a[172:175], v[84:87]
M v[84:87], a[72:75], a[168:171], v[84:87]
ds_read_b64_tr_b16 a[144:145], v18 offset:32768
ds_read_b64_tr_b16 a[146:147], v18 offset:34816
M v[88:91], a[80:83], a[168:171], v[88:91]
M v[88:91], a[84:87], a[172:175], v[88:91]
M v[92:95], a[92:95], a[172:175], v[92:95]
s_add_u32 s24, s24, 262144
M v[92:95], a[88:91], a[168:171], v[92:95]
s_waitcnt lgkmcnt(15)
ds_read_b64_tr_b16 a[152:153], v19 offset:32768
ds_read_b64_tr_b16 a[154:155], v19 offset:34816
M v[96:99], a[32:35], a[176:179], v[96:99]
M v[96:99], a[36:39], a[180:183], v[96:99]
M v[100:103], a[44:47], a[180:183], v[100:103]
M v[100:103], a[40:43], a[176:179], v[100:103]
M v[104:107], a[48:51], a[176:179], v[104:107]
M v[104:107], a[52:55], a[180:183], v[104:107]
M v[108:111], a[60:63], a[180:183], v[108:111]
M v[108:111], a[56:59], a[176:179], v[108:111]
s_waitcnt vmcnt(9) lgkmcnt(0)
s_barrier
ds_read_b128 a[160:163], v10 offset:16384
ds_read_b128 a[164:167], v11 offset:16384
M v[112:115], a[64:67], a[176:179], v[112:115]
s_add_u32 m0, s29, 49152
s_add_u32 s3, s23, s31
buffer_load_dwordx4 v2, s[8:11], s3 offen offset:0 lds
M v[112:115], a[68:71], a[180:183], v[112:115]
M v[116:119], a[76:79], a[180:183], v[116:119]
M v[116:119], a[72:75], a[176:179], v[116:119]
ds_read_b64_tr_b16 a[100:101], v12 offset:49152
ds_read_b64_tr_b16 a[102:103], v12 offset:51200
M v[120:123], a[80:83], a[176:179], v[120:123]
M v[120:123], a[84:87], a[180:183], v[120:123]
buffer_load_dwordx4 v3, s[8:11], s3 offen offset:1024 lds
M v[124:127], a[92:95], a[180:183], v[124:127]
M v[124:127], a[88:91], a[176:179], v[124:127]
M v[128:131], a[32:35], a[184:187], v[128:131]
M v[128:131], a[36:39], a[188:191], v[128:131]
ds_read_b128 a[168:171], v10 offset:18432
ds_read_b128 a[172:175], v11 offset:18432
ds_read_b64_tr_b16 a[108:109], v13 offset:49152
ds_read_b64_tr_b16 a[110:111], v13 offset:51200
M v[132:135], a[44:47], a[188:191], v[132:135]
M v[132:135], a[40:43], a[184:187], v[132:135]
buffer_load_dwordx4 v4, s[8:11], s3 offen offset:2048 lds
M v[136:139], a[48:51], a[184:187], v[136:139]
M v[136:139], a[52:55], a[188:191], v[136:139]
M v[140:143], a[60:63], a[188:191], v[140:143]
M v[140:143], a[56:59], a[184:187], v[140:143]
ds_read_b64_tr_b16 a[116:117], v14 offset:49152
ds_read_b64_tr_b16 a[118:119], v14 offset:51200
M v[144:147], a[64:67], a[184:187], v[144:147]
M v[144:147], a[68:71], a[188:191], v[144:147]
buffer_load_dwordx4 v5, s[8:11], s3 offen offset:3072 lds
M v[148:151], a[76:79], a[188:191], v[148:151]
M v[148:151], a[72:75], a[184:187], v[148:151]
M v[152:155], a[80:83], a[184:187], v[152:155]
M v[152:155], a[84:87], a[188:191], v[152:155]
ds_read_b64_tr_b16 a[124:125], v15 offset:49152
ds_read_b64_tr_b16 a[126:127], v15 offset:51200
M v[156:159], a[92:95], a[188:191], v[156:159]
s_add_u32 s23, s23, 128
s_cmp_eq_u32 s23, s25
s_cselect_b32 s23, s26, s23
M v[156:159], a[88:91], a[184:187], v[156:159]
s_waitcnt lgkmcnt(10)
M v[160:163], a[32:35], a[160:163], v[160:163]
M v[160:163], a[36:39], a[164:167], v[160:163]
ds_read_b128 a[176:179], v10 offset:20480
ds_read_b128 a[180:183], v11 offset:20480
M v[164:167], a[44:47], a[164:167], v[164:167]
M v[164:167], a[40:43], a[160:163], v[164:167]
ds_read_b64_tr_b16 a[132:133], v16 offset:49152
ds_read_b64_tr_b16 a[134:135], v16 offset:51200
M v[168:171], a[48:51], a[160:163], v[168:171]
M v[168:171], a[52:55], a[164:167], v[168:171]
s_add_u32 m0, s29, 81920
s_nop 0
buffer_load_dwordx4 v6, s[12:15], s24 offen offset:0 lds
M v[172:175], a[60:63], a[164:167], v[172:175]
M v[172:175], a[56:59], a[160:163], v[172:175]
M v[176:179], a[64:67], a[160:163], v[176:179]
M v[176:179], a[68:71], a[164:167], v[176:179]
ds_read_b64_tr_b16 a[140:141], v17 offset:49152
ds_read_b64_tr_b16 a[142:143], v17 offset:51200
M v[180:183], a[76:79], a[164:167], v[180:183]
M v[180:183], a[72:75], a[160:163], v[180:183]
buffer_load_dwordx4 v7, s[12:15], s24 offen offset:1024 lds
M v[184:187], a[80:83], a[160:163], v[184:187]
M v[184:187], a[84:87], a[164:167], v[184:187]
M v[188:191], a[92:95], a[164:167], v[188:191]
M v[188:191], a[88:91], a[160:163], v[188:191]
s_waitcnt lgkmcnt(12)
ds_read_b64_tr_b16 a[148:149], v18 offset:49152
ds_read_b64_tr_b16 a[150:151], v18 offset:51200
M v[192:195], a[32:35], a[168:171], v[192:195]
buffer_load_dwordx4 v8, s[12:15], s24 offen offset:2048 lds
M v[192:195], a[36:39], a[172:175], v[192:195]
ds_read_b128 a[184:187], v10 offset:22528
ds_read_b128 a[188:191], v11 offset:22528
M v[196:199], a[44:47], a[172:175], v[196:199]
M v[196:199], a[40:43], a[168:171], v[196:199]
M v[200:203], a[48:51], a[168:171], v[200:203]
M v[200:203], a[52:55], a[172:175], v[200:203]
ds_read_b64_tr_b16 a[156:157], v19 offset:49152
ds_read_b64_tr_b16 a[158:159], v19 offset:51200
M v[204:207], a[60:63], a[172:175], v[204:207]
buffer_load_dwordx4 v9, s[12:15], s24 offen offset:3072 lds
M v[204:207], a[56:59], a[168:171], v[204:207]
M v[208:211], a[64:67], a[168:171], v[208:211]
M v[208:211], a[68:71], a[172:175], v[208:211]
M v[212:215], a[76:79], a[172:175], v[212:215]
M v[212:215], a[72:75], a[168:171], v[212:215]
s_add_u32 s24, s24, 262144
s_cmp_eq_u32 s24, s27
s_cselect_b32 s24, s28, s24
s_sub_u32 s6, s6, 1
s_cmp_eq_u32 s6, 0
s_cselect_b64 s[12:13], s[64:65], s[12:13]
M v[216:219], a[80:83], a[168:171], v[216:219]
M v[216:219], a[84:87], a[172:175], v[216:219]
M v[220:223], a[92:95], a[172:175], v[220:223]
M v[220:223], a[88:91], a[168:171], v[220:223]
s_waitcnt lgkmcnt(10)
M v[224:227], a[32:35], a[176:179], v[224:227]
buffer_load_dword v21, v20, s[60:63], s54 offen
s_add_u32 s54, s54, 1048576
M v[224:227], a[36:39], a[180:183], v[224:227]
M v[228:231], a[44:47], a[180:183], v[228:231]
M v[228:231], a[40:43], a[176:179], v[228:231]
M v[232:235], a[48:51], a[176:179], v[232:235]
M v[232:235], a[52:55], a[180:183], v[232:235]
M v[236:239], a[60:63], a[180:183], v[236:239]
M v[236:239], a[56:59], a[176:179], v[236:239]
s_waitcnt vmcnt(9) lgkmcnt(0)
s_barrier
ds_read_b128 a[160:163], v10 offset:32768
ds_read_b128 a[164:167], v11 offset:32768
M v[240:243], a[64:67], a[176:179], v[240:243]
s_add_u32 m0, s29, 0
s_nop 0
buffer_load_dwordx4 v2, s[8:11], s23 offen offset:0 lds
M v[240:243], a[68:71], a[180:183], v[240:243]
M v[244:247], a[76:79], a[180:183], v[244:247]
M v[244:247], a[72:75], a[176:179], v[244:247]
M v[248:251], a[80:83], a[176:179], v[248:251]
M v[248:251], a[84:87], a[180:183], v[248:251]
buffer_load_dwordx4 v3, s[8:11], s23 offen offset:1024 lds
M v[252:255], a[92:95], a[180:183], v[252:255]
M v[252:255], a[88:91], a[176:179], v[252:255]
M a[0:3], a[32:35], a[184:187], a[0:3]
M a[0:3], a[36:39], a[188:191], a[0:3]
ds_read_b128 a[168:171], v10 offset:34816
ds_read_b128 a[172:175], v11 offset:34816
M a[4:7], a[44:47], a[188:191], a[4:7]
M a[4:7], a[40:43], a[184:187], a[4:7]
M a[8:11], a[48:51], a[184:187], a[8:11]
buffer_load_dwordx4 v4, s[8:11], s23 offen offset:2048 lds
M a[8:11], a[52:55], a[188:191], a[8:11]
M a[12:15], a[60:63], a[188:191], a[12:15]
M a[12:15], a[56:59], a[184:187], a[12:15]
M a[16:19], a[64:67], a[184:187], a[16:19]
M a[16:19], a[68:71], a[188:191], a[16:19]
buffer_load_dwordx4 v5, s[8:11], s23 offen offset:3072 lds
M a[20:23], a[76:79], a[188:191], a[20:23]
M a[20:23], a[72:75], a[184:187], a[20:23]
M a[24:27], a[80:83], a[184:187], a[24:27]
M a[24:27], a[84:87], a[188:191], a[24:27]
M a[28:31], a[92:95], a[188:191], a[28:31]
M a[28:31], a[88:91], a[184:187], a[28:31]
s_waitcnt lgkmcnt(2)
M v[32:35], a[96:99], a[160:163], v[32:35]
s_add_u32 m0, s29, 98304
s_nop 0
buffer_load_dwordx4 v6, s[12:15], s24 offen offset:0 lds
M v[32:35], a[100:103], a[164:167], v[32:35]
ds_read_b128 a[176:179], v10 offset:36864
ds_read_b128 a[180:183], v11 offset:36864
M v[36:39], a[108:111], a[164:167], v[36:39]
M v[36:39], a[104:107], a[160:163], v[36:39]
ds_read_b64_tr_b16 a[32:33], v12 offset:0
ds_read_b64_tr_b16 a[34:35], v12 offset:2048
M v[40:43], a[112:115], a[160:163], v[40:43]
M v[40:43], a[116:119], a[164:167], v[40:43]
M v[44:47], a[124:127], a[164:167], v[44:47]
M v[44:47], a[120:123], a[160:163], v[44:47]
ds_read_b64_tr_b16 a[40:41], v13 offset:0
ds_read_b64_tr_b16 a[42:43], v13 offset:2048
M v[48:51], a[128:131], a[160:163], v[48:51]
buffer_load_dwordx4 v7, s[12:15], s24 offen offset:1024 lds
M v[48:51], a[132:135], a[164:167], v[48:51]
M v[52:55], a[140:143], a[164:167], v[52:55]
M v[52:55], a[136:139], a[160:163], v[52:55]
ds_read_b64_tr_b16 a[48:49], v14 offset:0
ds_read_b64_tr_b16 a[50:51], v14 offset:2048
M v[56:59], a[144:147], a[160:163], v[56:59]
M v[56:59], a[148:151], a[164:167], v[56:59]
M v[60:63], a[156:159], a[164:167], v[60:63]
buffer_load_dwordx4 v8, s[12:15], s24 offen offset:2048 lds
M v[60:63], a[152:155], a[160:163], v[60:63]
s_waitcnt lgkmcnt(8)
ds_read_b64_tr_b16 a[56:57], v15 offset:0
ds_read_b64_tr_b16 a[58:59], v15 offset:2048
M v[64:67], a[96:99], a[168:171], v[64:67]
M v[64:67], a[100:103], a[172:175], v[64:67]
ds_read_b128 a[184:187], v10 offset:38912
ds_read_b128 a[188:191], v11 offset:38912
M v[68:71], a[108:111], a[172:175], v[68:71]
M v[68:71], a[104:107], a[168:171], v[68:71]
ds_read_b64_tr_b16 a[64:65], v16 offset:0
ds_read_b64_tr_b16 a[66:67], v16 offset:2048
M v[72:75], a[112:115], a[168:171], v[72:75]
M v[72:75], a[116:119], a[172:175], v[72:75]
M v[76:79], a[124:127], a[172:175], v[76:79]
M v[76:79], a[120:123], a[168:171], v[76:79]
ds_read_b64_tr_b16 a[72:73], v17 offset:0
ds_read_b64_tr_b16 a[74:75], v17 offset:2048
M v[80:83], a[128:131], a[168:171], v[80:83]
buffer_load_dwordx4 v9, s[12:15], s24 offen offset:3072 lds
M v[80:83], a[132:135], a[172:175], v[80:83]
M v[84:87], a[140:143], a[172:175], v[84:87]
M v[84:87], a[136:139], a[168:171], v[84:87]
ds_read_b64_tr_b16 a[80:81], v18 offset:0
ds_read_b64_tr_b16 a[82:83], v18 offset:2048
M v[88:91], a[144:147], a[168:171], v[88:91]
M v[88:91], a[148:151], a[172:175], v[88:91]
M v[92:95], a[156:159], a[172:175], v[92:95]
s_add_u32 s24, s24, 262144
M v[92:95], a[152:155], a[168:171], v[92:95]
s_waitcnt lgkmcnt(15)
ds_read_b64_tr_b16 a[88:89], v19 offset:0
ds_read_b64_tr_b16 a[90:91], v19 offset:2048
M v[96:99], a[96:99], a[176:179], v[96:99]
M v[96:99], a[100:103], a[180:183], v[96:99]
M v[100:103], a[108:111], a[180:183], v[100:103]
M v[100:103], a[104:107], a[176:179], v[100:103]
M v[104:107], a[112:115], a[176:179], v[104:107]
M v[104:107], a[116:119], a[180:183], v[104:107]
M v[108:111], a[124:127], a[180:183], v[108:111]
M v[108:111], a[120:123], a[176:179], v[108:111]
s_waitcnt vmcnt(9) lgkmcnt(0)
s_barrier
ds_read_b128 a[160:163], v10 offset:49152
ds_read_b128 a[164:167], v11 offset:49152
M v[112:115], a[128:131], a[176:179], v[112:115]
s_add_u32 m0, s29, 16384
s_add_u32 s3, s23, s31
buffer_load_dwordx4 v2, s[8:11], s3 offen offset:0 lds
M v[112:115], a[132:135], a[180:183], v[112:115]
M v[116:119], a[140:143], a[180:183], v[116:119]
M v[116:119], a[136:139], a[176:179], v[116:119]
ds_read_b64_tr_b16 a[36:37], v12 offset:16384
ds_read_b64_tr_b16 a[38:39], v12 offset:18432
M v[120:123], a[144:147], a[176:179], v[120:123]
M v[120:123], a[148:151], a[180:183], v[120:123]
buffer_load_dwordx4 v3, s[8:11], s3 offen offset:1024 lds
M v[124:127], a[156:159], a[180:183], v[124:127]
M v[124:127], a[152:155], a[176:179], v[124:127]
M v[128:131], a[96:99], a[184:187], v[128:131]
M v[128:131], a[100:103], a[188:191], v[128:131]
ds_read_b128 a[168:171], v10 offset:51200
ds_read_b128 a[172:175], v11 offset:51200
ds_read_b64_tr_b16 a[44:45], v13 offset:16384
ds_read_b64_tr_b16 a[46:47], v13 offset:18432
M v[132:135], a[108:111], a[188:191], v[132:135]
M v[132:135], a[104:107], a[184:187], v[132:135]
buffer_load_dwordx4 v4, s[8:11], s3 offen offset:2048 lds
M v[136:139], a[112:115], a[184:187], v[136:139]
M v[136:139], a[116:119], a[188:191], v[136:139]
M v[140:143], a[124:127], a[188:191], v[140:143]
M v[140:143], a[120:123], a[184:187], v[140:143]
ds_read_b64_tr_b16 a[52:53], v14 offset:16384
ds_read_b64_tr_b16 a[54:55], v14 offset:18432
M v[144:147], a[128:131], a[184:187], v[144:147]
M v[144:147], a[132:135], a[188:191], v[144:147]
buffer_load_dwordx4 v5, s[8:11], s3 offen offset:3072 lds
M v[148:151], a[140:143], a[188:191], v[148:151]
M v[148:151], a[136:139], a[184:187], v[148:151]
M v[152:155], a[144:147], a[184:187], v[152:155]
M v[152:155], a[148:151], a[188:191], v[152:155]
ds_read_b64_tr_b16 a[60:61], v15 offset:16384
ds_read_b64_tr_b16 a[62:63], v15 offset:18432
M v[156:159], a[156:159], a[188:191], v[156:159]
s_add_u32 s23, s23, 128
s_cmp_eq_u32 s23, s25
s_cselect_b32 s23, s26, s23
M v[156:159], a[152:155], a[184:187], v[156:159]
s_waitcnt lgkmcnt(10)
M v[160:163], a[96:99], a[160:163], v[160:163]
M v[160:163], a[100:103], a[164:167], v[160:163]
ds_read_b128 a[176:179], v10 offset:53248
ds_read_b128 a[180:183], v11 offset:53248
M v[164:167], a[108:111], a[164:167], v[164:167]
M v[164:167], a[104:107], a[160:163], v[164:167]
ds_read_b64_tr_b16 a[68:69], v16 offset:16384
ds_read_b64_tr_b16 a[70:71], v16 offset:18432
M v[168:171], a[112:115], a[160:163], v[168:171]
M v[168:171], a[116:119], a[164:167], v[168:171]
s_add_u32 m0, s29, 114688
s_nop 0
buffer_load_dwordx4 v6, s[12:15], s24 offen offset:0 lds
M v[172:175], a[124:127], a[164:167], v[172:175]
M v[172:175], a[120:123], a[160:163], v[172:175]
M v[176:179], a[128:131], a[160:163], v[176:179]
M v[176:179], a[132:135], a[164:167], v[176:179]
ds_read_b64_tr_b16 a[76:77], v17 offset:16384
ds_read_b64_tr_b16 a[78:79], v17 offset:18432
M v[180:183], a[140:143], a[164:167], v[180:183]
M v[180:183], a[136:139], a[160:163], v[180:183]
buffer_load_dwordx4 v7, s[12:15], s24 offen offset:1024 lds
M v[184:187], a[144:147], a[160:163], v[184:187]
M v[184:187], a[148:151], a[164:167], v[184:187]
M v[188:191], a[156:159], a[164:167], v[188:191]
M v[188:191], a[152:155], a[160:163], v[188:191]
s_waitcnt lgkmcnt(12)
ds_read_b64_tr_b16 a[84:85], v18 offset:16384
ds_read_b64_tr_b16 a[86:87], v18 offset:18432
M v[192:195], a[96:99], a[168:171], v[192:195]
buffer_load_dwordx4 v8, s[12:15], s24 offen offset:2048 lds
M v[192:195], a[100:103], a[172:175], v[192:195]
ds_read_b128 a[184:187], v10 offset:55296
ds_read_b128 a[188:191], v11 offset:55296
M v[196:199], a[108:111], a[172:175], v[196:199]
M v[196:199], a[104:107], a[168:171], v[196:199]
M v[200:203], a[112:115], a[168:171], v[200:203]
M v[200:203], a[116:119], a[172:175], v[200:203]
ds_read_b64_tr_b16 a[92:93], v19 offset:16384
ds_read_b64_tr_b16 a[94:95], v19 offset:18432
M v[204:207], a[124:127], a[172:175], v[204:207]
buffer_load_dwordx4 v9, s[12:15], s24 offen offset:3072 lds
M v[204:207], a[120:123], a[168:171], v[204:207]
M v[208:211], a[128:131], a[168:171], v[208:211]
M v[208:211], a[132:135], a[172:175], v[208:211]
M v[212:215], a[140:143], a[172:175], v[212:215]
M v[212:215], a[136:139], a[168:171], v[212:215]
s_add_u32 s24, s24, 262144
s_cmp_eq_u32 s24, s27
s_cselect_b32 s24, s28, s24
s_sub_u32 s6, s6, 1
s_cmp_eq_u32 s6, 0
s_cselect_b64 s[12:13], s[64:65], s[12:13]
M v[216:219], a[144:147], a[168:171], v[216:219]
M v[216:219], a[148:151], a[172:175], v[216:219]
M v[220:223], a[156:159], a[172:175], v[220:223]
M v[220:223], a[152:155], a[168:171], v[220:223]
s_waitcnt lgkmcnt(10)
M v[224:227], a[96:99], a[176:179], v[224:227]
buffer_load_dword v21, v20, s[60:63], s54 offen
s_add_u32 s54, s54, 1048576
M v[224:227], a[100:103], a[180:183], v[224:227]
M v[228:231], a[108:111], a[180:183], v[228:231]
M v[228:231], a[104:107], a[176:179], v[228:231]
M v[232:235], a[112:115], a[176:179], v[232:235]
M v[232:235], a[116:119], a[180:183], v[232:235]
M v[236:239], a[124:127], a[180:183], v[236:239]
M v[236:239], a[120:123], a[176:179], v[236:239]
s_waitcnt vmcnt(9) lgkmcnt(0)
s_barrier
ds_read_b128 a[160:163], v10 offset:0
ds_read_b128 a[164:167], v11 offset:0
M v[240:243], a[128:131], a[176:179], v[240:243]
s_add_u32 m0, s29, 32768
s_nop 0
buffer_load_dwordx4 v2, s[8:11], s23 offen offset:0 lds
M v[240:243], a[132:135], a[180:183], v[240:243]
M v[244:247], a[140:143], a[180:183], v[244:247]
M v[244:247], a[136:139], a[176:179], v[244:247]
M v[248:251], a[144:147], a[176:179], v[248:251]
M v[248:251], a[148:151], a[180:183], v[248:251]
buffer_load_dwordx4 v3, s[8:11], s23 offen offset:1024 lds
M v[252:255], a[156:159], a[180:183], v[252:255]
M v[252:255], a[152:155], a[176:179], v[252:255]
M a[0:3], a[96:99], a[184:187], a[0:3]
M a[0:3], a[100:103], a[188:191], a[0:3]
ds_read_b128 a[168:171], v10 offset:2048
ds_read_b128 a[172:175], v11 offset:2048
M a[4:7], a[108:111], a[188:191], a[4:7]
M a[4:7], a[104:107], a[184:187], a[4:7]
M a[8:11], a[112:115], a[184:187], a[8:11]
buffer_load_dwordx4 v4, s[8:11], s23 offen offset:2048 lds
M a[8:11], a[116:119], a[188:191], a[8:11]
M a[12:15], a[124:127], a[188:191], a[12:15]
M a[12:15], a[120:123], a[184:187], a[12:15]
M a[16:19], a[128:131], a[184:187], a[16:19]
M a[16:19], a[132:135], a[188:191], a[16:19]
buffer_load_dwordx4 v5, s[8:11], s23 offen offset:3072 lds
M a[20:23], a[140:143], a[188:191], a[20:23]
M a[20:23], a[136:139], a[184:187], a[20:23]
M a[24:27], a[144:147], a[184:187], a[24:27]
M a[24:27], a[148:151], a[188:191], a[24:27]
M a[28:31], a[156:159], a[188:191], a[28:31]
M a[28:31], a[152:155], a[184:187], a[28:31]
s_waitcnt lgkmcnt(2)
s_sub_u32 s30, s30, 1
s_cmp_lg_u32 s30, 0
s_cbranch_scc1 Lk1_ql
M v[32:35], a[32:35], a[160:163], v[32:35]
s_add_u32 m0, s29, 65536
s_nop 0
buffer_load_dwordx4 v6, s[12:15], s24 offen offset:0 lds
M v[32:35], a[36:39], a[164:167], v[32:35]
ds_read_b128 a[176:179], v10 offset:4096
ds_read_b128 a[180:183], v11 offset:4096
M v[36:39], a[44:47], a[164:167], v[36:39]
M v[36:39], a[40:43], a[160:163], v[36:39]
ds_read_b64_tr_b16 a[96:97], v12 offset:32768
ds_read_b64_tr_b16 a[98:99], v12 offset:34816
M v[40:43], a[48:51], a[160:163], v[40:43]
M v[40:43], a[52:55], a[164:167], v[40:43]
M v[44:47], a[60:63], a[164:167], v[44:47]
M v[44:47], a[56:59], a[160:163], v[44:47]
ds_read_b64_tr_b16 a[104:105], v13 offset:32768
ds_read_b64_tr_b16 a[106:107], v13 offset:34816
M v[48:51], a[64:67], a[160:163], v[48:51]
buffer_load_dwordx4 v7, s[12:15], s24 offen offset:1024 lds
M v[48:51], a[68:71], a[164:167], v[48:51]
M v[52:55], a[76:79], a[164:167], v[52:55]
M v[52:55], a[72:75], a[160:163], v[52:55]
ds_read_b64_tr_b16 a[112:113], v14 offset:32768
ds_read_b64_tr_b16 a[114:115], v14 offset:34816
M v[56:59], a[80:83], a[160:163], v[56:59]
M v[56:59], a[84:87], a[164:167], v[56:59]
M v[60:63], a[92:95], a[164:167], v[60:63]
buffer_load_dwordx4 v8, s[12:15], s24 offen offset:2048 lds
M v[60:63], a[88:91], a[160:163], v[60:63]
s_waitcnt lgkmcnt(8)
ds_read_b64_tr_b16 a[120:121], v15 offset:32768
ds_read_b64_tr_b16 a[122:123], v15 offset:34816
M v[64:67], a[32:35], a[168:171], v[64:67]
M v[64:67], a[36:39], a[172:175], v[64:67]
ds_read_b128 a[184:187], v10 offset:6144
ds_read_b128 a[188:191], v11 offset:6144
M v[68:71], a[44:47], a[172:175], v[68:71]
M v[68:71], a[40:43], a[168:171], v[68:71]
ds_read_b64_tr_b16 a[128:129], v16 offset:32768
ds_read_b64_tr_b16 a[130:131], v16 offset:34816
M v[72:75], a[48:51], a[168:171], v[72:75]
M v[72:75], a[52:55], a[172:175], v[72:75]
M v[76:79], a[60:63], a[172:175], v[76:79]
M v[76:79], a[56:59], a[168:171], v[76:79]
ds_read_b64_tr_b16 a[136:137], v17 offset:32768
ds_read_b64_tr_b16 a[138:139], v17 offset:34816
M v[80:83], a[64:67], a[168:171], v[80:83]
buffer_load_dwordx4 v9, s[12:15], s24 offen offset:3072 lds
M v[80:83], a[68:71], a[172:175], v[80:83]
M v[84:87], a[76:79], a[172:175], v[84:87]
M v[84:87], a[72:75], a[168:171], v[84:87]
ds_read_b64_tr_b16 a[144:145], v18 offset:32768
ds_read_b64_tr_b16 a[146:147], v18 offset:34816
M v[88:91], a[80:83], a[168:171], v[88:91]
M v[88:91], a[84:87], a[172:175], v[88:91]
M v[92:95], a[92:95], a[172:175], v[92:95]
s_add_u32 s24, s24, 262144
M v[92:95], a[88:91], a[168:171], v[92:95]
s_waitcnt lgkmcnt(15)
ds_read_b64_tr_b16 a[152:153], v19 offset:32768
ds_read_b64_tr_b16 a[154:155], v19 offset:34816
M v[96:99], a[32:35], a[176:179], v[96:99]
M v[96:99], a[36:39], a[180:183], v[96:99]
M v[100:103], a[44:47], a[180:183], v[100:103]
M v[100:103], a[40:43], a[176:179], v[100:103]
M v[104:107], a[48:51], a[176:179], v[104:107]
M v[104:107], a[52:55], a[180:183], v[104:107]
M v[108:111], a[60:63], a[180:183], v[108:111]
M v[108:111], a[56:59], a[176:179], v[108:111]
s_waitcnt vmcnt(9) lgkmcnt(0)
s_barrier
ds_read_b128 a[160:163], v10 offset:16384
ds_read_b128 a[164:167], v11 offset:16384
M v[112:115], a[64:67], a[176:179], v[112:115]
s_add_u32 m0, s29, 49152
s_add_u32 s3, s23, s31
buffer_load_dwordx4 v2, s[8:11], s3 offen offset:0 lds
M v[112:115], a[68:71], a[180:183], v[112:115]
M v[116:119], a[76:79], a[180:183], v[116:119]
M v[116:119], a[72:75], a[176:179], v[116:119]
ds_read_b64_tr_b16 a[100:101], v12 offset:49152
ds_read_b64_tr_b16 a[102:103], v12 offset:51200
M v[120:123], a[80:83], a[176:179], v[120:123]
M v[120:123], a[84:87], a[180:183], v[120:123]
buffer_load_dwordx4 v3, s[8:11], s3 offen offset:1024 lds
M v[124:127], a[92:95], a[180:183], v[124:127]
M v[124:127], a[88:91], a[176:179], v[124:127]
M v[128:131], a[32:35], a[184:187], v[128:131]
M v[128:131], a[36:39], a[188:191], v[128:131]
ds_read_b128 a[168:171], v10 offset:18432
ds_read_b128 a[172:175], v11 offset:18432
ds_read_b64_tr_b16 a[108:109], v13 offset:49152
ds_read_b64_tr_b16 a[110:111], v13 offset:51200
M v[132:135], a[44:47], a[188:191], v[132:135]
M v[132:135], a[40:43], a[184:187], v[132:135]
M v[136:139], a[48:51], a[184:187], v[136:139]
buffer_load_dwordx4 v4, s[8:11], s3 offen offset:2048 lds
M v[136:139], a[52:55], a[188:191], v[136:139]
M v[140:143], a[60:63], a[188:191], v[140:143]
M v[140:143], a[56:59], a[184:187], v[140:143]
ds_read_b64_tr_b16 a[116:117], v14 offset:49152
ds_read_b64_tr_b16 a[118:119], v14 offset:51200
M v[144:147], a[64:67], a[184:187], v[144:147]
M v[144:147], a[68:71], a[188:191], v[144:147]
M v[148:151], a[76:79], a[188:191], v[148:151]
buffer_load_dwordx4 v5, s[8:11], s3 offen offset:3072 lds
M v[148:151], a[72:75], a[184:187], v[148:151]
M v[152:155], a[80:83], a[184:187], v[152:155]
M v[152:155], a[84:87], a[188:191], v[152:155]
ds_read_b64_tr_b16 a[124:125], v15 offset:49152
ds_read_b64_tr_b16 a[126:127], v15 offset:51200
M v[156:159], a[92:95], a[188:191], v[156:159]
M v[156:159], a[88:91], a[184:187], v[156:159]
s_waitcnt lgkmcnt(10)
M v[160:163], a[32:35], a[160:163], v[160:163]
M v[160:163], a[36:39], a[164:167], v[160:163]
ds_read_b128 a[176:179], v10 offset:20480
ds_read_b128 a[180:183], v11 offset:20480
M v[164:167], a[44:47], a[164:167], v[164:167]
s_add_u32 s23, s23, 128
s_cmp_eq_u32 s23, s25
s_cselect_b32 s23, s26, s23
M v[164:167], a[40:43], a[160:163], v[164:167]
ds_read_b64_tr_b16 a[132:133], v16 offset:49152
ds_read_b64_tr_b16 a[134:135], v16 offset:51200
M v[168:171], a[48:51], a[160:163], v[168:171]
M v[168:171], a[52:55], a[164:167], v[168:171]
M v[172:175], a[60:63], a[164:167], v[172:175]
M v[172:175], a[56:59], a[160:163], v[172:175]
M v[176:179], a[64:67], a[160:163], v[176:179]
s_add_u32 m0, s29, 81920
s_nop 0
buffer_load_dwordx4 v6, s[12:15], s24 offen offset:0 lds
M v[176:179], a[68:71], a[164:167], v[176:179]
ds_read_b64_tr_b16 a[140:141], v17 offset:49152
ds_read_b64_tr_b16 a[142:143], v17 offset:51200
M v[180:183], a[76:79], a[164:167], v[180:183]
M v[180:183], a[72:75], a[160:163], v[180:183]
M v[184:187], a[80:83], a[160:163], v[184:187]
M v[184:187], a[84:87], a[164:167], v[184:187]
buffer_load_dwordx4 v7, s[12:15], s24 offen offset:1024 lds
M v[188:191], a[92:95], a[164:167], v[188:191]
M v[188:191], a[88:91], a[160:163], v[188:191]
s_waitcnt lgkmcnt(12)
ds_read_b64_tr_b16 a[148:149], v18 offset:49152
ds_read_b64_tr_b16 a[150:151], v18 offset:51200
M v[192:195], a[32:35], a[168:171], v[192:195]
M v[192:195], a[36:39], a[172:175], v[192:195]
ds_read_b128 a[184:187], v10 offset:22528
ds_read_b128 a[188:191], v11 offset:22528
M v[196:199], a[44:47], a[172:175], v[196:199]
M v[196:199], a[40:43], a[168:171], v[196:199]
M v[200:203], a[48:51], a[168:171], v[200:203]
buffer_load_dwordx4 v8, s[12:15], s24 offen offset:2048 lds
M v[200:203], a[52:55], a[172:175], v[200:203]
ds_read_b64_tr_b16 a[156:157], v19 offset:49152
ds_read_b64_tr_b16 a[158:159], v19 offset:51200
M v[204:207], a[60:63], a[172:175], v[204:207]
M v[204:207], a[56:59], a[168:171], v[204:207]
M v[208:211], a[64:67], a[168:171], v[208:211]
M v[208:211], a[68:71], a[172:175], v[208:211]
M v[212:215], a[76:79], a[172:175], v[212:215]
buffer_load_dwordx4 v9, s[12:15], s24 offen offset:3072 lds
M v[212:215], a[72:75], a[168:171], v[212:215]
M v[216:219], a[80:83], a[168:171], v[216:219]
M v[216:219], a[84:87], a[172:175], v[216:219]
M v[220:223], a[92:95], a[172:175], v[220:223]
M v[220:223], a[88:91], a[168:171], v[220:223]
s_waitcnt lgkmcnt(10)
M v[224:227], a[32:35], a[176:179], v[224:227]
s_add_u32 s24, s24, 262144
s_cmp_eq_u32 s24, s27
s_cselect_b32 s24, s28, s24
s_sub_u32 s6, s6, 1
s_cmp_eq_u32 s6, 0
s_cselect_b64 s[12:13], s[64:65], s[12:13]
M v[224:227], a[36:39], a[180:183], v[224:227]
M v[228:231], a[44:47], a[180:183], v[228:231]
M v[228:231], a[40:43], a[176:179], v[228:231]
M v[232:235], a[48:51], a[176:179], v[232:235]
M v[232:235], a[52:55], a[180:183], v[232:235]
M v[236:239], a[60:63], a[180:183], v[236:239]
M v[236:239], a[56:59], a[176:179], v[236:239]
s_waitcnt vmcnt(8) lgkmcnt(0)
s_barrier
ds_read_b128 a[160:163], v10 offset:32768
ds_read_b128 a[164:167], v11 offset:32768
M v[240:243], a[64:67], a[176:179], v[240:243]
s_add_u32 m0, s29, 0
s_nop 0
buffer_load_dwordx4 v2, s[8:11], s23 offen offset:0 lds
M v[240:243], a[68:71], a[180:183], v[240:243]
M v[244:247], a[76:79], a[180:183], v[244:247]
M v[244:247], a[72:75], a[176:179], v[244:247]
M v[248:251], a[80:83], a[176:179], v[248:251]
M v[248:251], a[84:87], a[180:183], v[248:251]
buffer_load_dwordx4 v3, s[8:11], s23 offen offset:1024 lds
M v[252:255], a[92:95], a[180:183], v[252:255]
M v[252:255], a[88:91], a[176:179], v[252:255]
M a[0:3], a[32:35], a[184:187], a[0:3]
M a[0:3], a[36:39], a[188:191], a[0:3]
ds_read_b128 a[168:171], v10 offset:34816
ds_read_b128 a[172:175], v11 offset:34816
M a[4:7], a[44:47], a[188:191], a[4:7]
M a[4:7], a[40:43], a[184:187], a[4:7]
M a[8:11], a[48:51], a[184:187], a[8:11]
buffer_load_dwordx4 v4, s[8:11], s23 offen offset:2048 lds
M a[8:11], a[52:55], a[188:191], a[8:11]
M a[12:15], a[60:63], a[188:191], a[12:15]
M a[12:15], a[56:59], a[184:187], a[12:15]
M a[16:19], a[64:67], a[184:187], a[16:19]
M a[16:19], a[68:71], a[188:191], a[16:19]
buffer_load_dwordx4 v5, s[8:11], s23 offen offset:3072 lds
M a[20:23], a[76:79], a[188:191], a[20:23]
M a[20:23], a[72:75], a[184:187], a[20:23]
M a[24:27], a[80:83], a[184:187], a[24:27]
M a[24:27], a[84:87], a[188:191], a[24:27]
M a[28:31], a[92:95], a[188:191], a[28:31]
M a[28:31], a[88:91], a[184:187], a[28:31]
s_waitcnt lgkmcnt(2)
M v[32:35], a[96:99], a[160:163], v[32:35]
s_add_u32 m0, s29, 98304
s_nop 0
buffer_load_dwordx4 v6, s[12:15], s24 offen offset:0 lds
M v[32:35], a[100:103], a[164:167], v[32:35]
ds_read_b128 a[176:179], v10 offset:36864
ds_read_b128 a[180:183], v11 offset:36864
M v[36:39], a[108:111], a[164:167], v[36:39]
M v[36:39], a[104:107], a[160:163], v[36:39]
ds_read_b64_tr_b16 a[32:33], v12 offset:0
ds_read_b64_tr_b16 a[34:35], v12 offset:2048
M v[40:43], a[112:115], a[160:163], v[40:43]
M v[40:43], a[116:119], a[164:167], v[40:43]
M v[44:47], a[124:127], a[164:167], v[44:47]
M v[44:47], a[120:123], a[160:163], v[44:47]
ds_read_b64_tr_b16 a[40:41], v13 offset:0
ds_read_b64_tr_b16 a[42:43], v13 offset:2048
M v[48:51], a[128:131], a[160:163], v[48:51]
buffer_load_dwordx4 v7, s[12:15], s24 offen offset:1024 lds
M v[48:51], a[132:135], a[164:167], v[48:51]
M v[52:55], a[140:143], a[164:167], v[52:55]
M v[52:55], a[136:139], a[160:163], v[52:55]
ds_read_b64_tr_b16 a[48:49], v14 offset:0
ds_read_b64_tr_b16 a[50:51], v14 offset:2048
M v[56:59], a[144:147], a[160:163], v[56:59]
M v[56:59], a[148:151], a[164:167], v[56:59]
M v[60:63], a[156:159], a[164:167], v[60:63]
buffer_load_dwordx4 v8, s[12:15], s24 offen offset:2048 lds
M v[60:63], a[152:155], a[160:163], v[60:63]
s_waitcnt lgkmcnt(8)
ds_read_b64_tr_b16 a[56:57], v15 offset:0
ds_read_b64_tr_b16 a[58:59], v15 offset:2048
M v[64:67], a[96:99], a[168:171], v[64:67]
M v[64:67], a[100:103], a[172:175], v[64:67]
ds_read_b128 a[184:187], v10 offset:38912
ds_read_b128 a[188:191], v11 offset:38912
M v[68:71], a[108:111], a[172:175], v[68:71]
M v[68:71], a[104:107], a[168:171], v[68:71]
ds_read_b64_tr_b16 a[64:65], v16 offset:0
ds_read_b64_tr_b16 a[66:67], v16 offset:2048
M v[72:75], a[112:115], a[168:171], v[72:75]
M v[72:75], a[116:119], a[172:175], v[72:75]
M v[76:79], a[124:127], a[172:175], v[76:79]
M v[76:79], a[120:123], a[168:171], v[76:79]
ds_read_b64_tr_b16 a[72:73], v17 offset:0
ds_read_b64_tr_b16 a[74:75], v17 offset:2048
M v[80:83], a[128:131], a[168:171], v[80:83]
buffer_load_dwordx4 v9, s[12:15], s24 offen offset:3072 lds
M v[80:83], a[132:135], a[172:175], v[80:83]
M v[84:87], a[140:143], a[172:175], v[84:87]
M v[84:87], a[136:139], a[168:171], v[84:87]
ds_read_b64_tr_b16 a[80:81], v18 offset:0
ds_read_b64_tr_b16 a[82:83], v18 offset:2048
M v[88:91], a[144:147], a[168:171], v[88:91]
M v[88:91], a[148:151], a[172:175], v[88:91]
M v[92:95], a[156:159], a[172:175], v[92:95]
s_add_u32 s24, s24, 262144
M v[92:95], a[152:155], a[168:171], v[92:95]
s_waitcnt lgkmcnt(15)
ds_read_b64_tr_b16 a[88:89], v19 offset:0
ds_read_b64_tr_b16 a[90:91], v19 offset:2048
M v[96:99], a[96:99], a[176:179], v[96:99]
M v[96:99], a[100:103], a[180:183], v[96:99]
M v[100:103], a[108:111], a[180:183], v[100:103]
M v[100:103], a[104:107], a[176:179], v[100:103]
M v[104:107], a[112:115], a[176:179], v[104:107]
M v[104:107], a[116:119], a[180:183], v[104:107]
M v[108:111], a[124:127], a[180:183], v[108:111]
M v[108:111], a[120:123], a[176:179], v[108:111]
s_waitcnt vmcnt(8) lgkmcnt(0)
s_barrier
ds_read_b128 a[160:163], v10 offset:49152
ds_read_b128 a[164:167], v11 offset:49152
M v[112:115], a[128:131], a[176:179], v[112:115]
s_add_u32 m0, s29, 16384
s_add_u32 s3, s23, s31
buffer_load_dwordx4 v2, s[8:11], s3 offen offset:0 lds
M v[112:115], a[132:135], a[180:183], v[112:115]
M v[116:119], a[140:143], a[180:183], v[116:119]
M v[116:119], a[136:139], a[176:179], v[116:119]
ds_read_b64_tr_b16 a[36:37], v12 offset:16384
ds_read_b64_tr_b16 a[38:39], v12 offset:18432
M v[120:123], a[144:147], a[176:179], v[120:123]
M v[120:123], a[148:151], a[180:183], v[120:123]
buffer_load_dwordx4 v3, s[8:11], s3 offen offset:1024 lds
M v[124:127], a[156:159], a[180:183], v[124:127]
M v[124:127], a[152:155], a[176:179], v[124:127]
M v[128:131], a[96:99], a[184:187], v[128:131]
M v[128:131], a[100:103], a[188:191], v[128:131]
ds_read_b128 a[168:171], v10 offset:51200
ds_read_b128 a[172:175], v11 offset:51200
ds_read_b64_tr_b16 a[44:45], v13 offset:16384
ds_read_b64_tr_b16 a[46:47], v13 offset:18432
M v[132:135], a[108:111], a[188:191], v[132:135]
M v[132:135], a[104:107], a[184:187], v[132:135]
M v[136:139], a[112:115], a[184:187], v[136:139]
buffer_load_dwordx4 v4, s[8:11], s3 offen offset:2048 lds
M v[136:139], a[116:119], a[188:191], v[136:139]
M v[140:143], a[124:127], a[188:191], v[140:143]
M v[140:143], a[120:123], a[184:187], v[140:143]
ds_read_b64_tr_b16 a[52:53], v14 offset:16384
ds_read_b64_tr_b16 a[54:55], v14 offset:18432
M v[144:147], a[128:131], a[184:187], v[144:147]
M v[144:147], a[132:135], a[188:191], v[144:147]
M v[148:151], a[140:143], a[188:191], v[148:151]
buffer_load_dwordx4 v5, s[8:11], s3 offen offset:3072 lds
M v[148:151], a[136:139], a[184:187], v[148:151]
M v[152:155], a[144:147], a[184:187], v[152:155]
M v[152:155], a[148:151], a[188:191], v[152:155]
ds_read_b64_tr_b16 a[60:61], v15 offset:16384
ds_read_b64_tr_b16 a[62:63], v15 offset:18432
M v[156:159], a[156:159], a[188:191], v[156:159]
M v[156:159], a[152:155], a[184:187], v[156:159]
s_waitcnt lgkmcnt(10)
M v[160:163], a[96:99], a[160:163], v[160:163]
M v[160:163], a[100:103], a[164:167], v[160:163]
ds_read_b128 a[176:179], v10 offset:53248
ds_read_b128 a[180:183], v11 offset:53248
M v[164:167], a[108:111], a[164:167], v[164:167]
s_add_u32 s23, s23, 128
s_cmp_eq_u32 s23, s25
s_cselect_b32 s23, s26, s23
M v[164:167], a[104:107], a[160:163], v[164:167]
ds_read_b64_tr_b16 a[68:69], v16 offset:16384
ds_read_b64_tr_b16 a[70:71], v16 offset:18432
M v[168:171], a[112:115], a[160:163], v[168:171]
M v[168:171], a[116:119], a[164:167], v[168:171]
M v[172:175], a[124:127], a[164:167], v[172:175]
M v[172:175], a[120:123], a[160:163], v[172:175]
M v[176:179], a[128:131], a[160:163], v[176:179]
s_add_u32 m0, s29, 114688
s_nop 0
buffer_load_dwordx4 v6, s[12:15], s24 offen offset:0 lds
M v[176:179], a[132:135], a[164:167], v[176:179]
ds_read_b64_tr_b16 a[76:77], v17 offset:16384
ds_read_b64_tr_b16 a[78:79], v17 offset:18432
M v[180:183], a[140:143], a[164:167], v[180:183]
M v[180:183], a[136:139], a[160:163], v[180:183]
M v[184:187], a[144:147], a[160:163], v[184:187]
M v[184:187], a[148:151], a[164:167], v[184:187]
buffer_load_dwordx4 v7, s[12:15], s24 offen offset:1024 lds
M v[188:191], a[156:159], a[164:167], v[188:191]
M v[188:191], a[152:155], a[160:163], v[188:191]
s_waitcnt lgkmcnt(12)
ds_read_b64_tr_b16 a[84:85], v18 offset:16384
ds_read_b64_tr_b16 a[86:87], v18 offset:18432
M v[192:195], a[96:99], a[168:171], v[192:195]
M v[192:195], a[100:103], a[172:175], v[192:195]
ds_read_b128 a[184:187], v10 offset:55296
ds_read_b128 a[188:191], v11 offset:55296
M v[196:199], a[108:111], a[172:175], v[196:199]
M v[196:199], a[104:107], a[168:171], v[196:199]
M v[200:203], a[112:115], a[168:171], v[200:203]
buffer_load_dwordx4 v8, s[12:15], s24 offen offset:2048 lds
M v[200:203], a[116:119], a[172:175], v[200:203]
ds_read_b64_tr_b16 a[92:93], v19 offset:16384
ds_read_b64_tr_b16 a[94:95], v19 offset:18432
M v[204:207], a[124:127], a[172:175], v[204:207]
M v[204:207], a[120:123], a[168:171], v[204:207]
M v[208:211], a[128:131], a[168:171], v[208:211]
M v[208:211], a[132:135], a[172:175], v[208:211]
M v[212:215], a[140:143], a[172:175], v[212:215]
buffer_load_dwordx4 v9, s[12:15], s24 offen offset:3072 lds
M v[212:215], a[136:139], a[168:171], v[212:215]
M v[216:219], a[144:147], a[168:171], v[216:219]
M v[216:219], a[148:151], a[172:175], v[216:219]
M v[220:223], a[156:159], a[172:175], v[220:223]
M v[220:223], a[152:155], a[168:171], v[220:223]
s_waitcnt lgkmcnt(10)
M v[224:227], a[96:99], a[176:179], v[224:227]
s_add_u32 s24, s24, 262144
s_cmp_eq_u32 s24, s27
s_cselect_b32 s24, s28, s24
s_sub_u32 s6, s6, 1
s_cmp_eq_u32 s6, 0
s_cselect_b64 s[12:13], s[64:65], s[12:13]
M v[224:227], a[100:103], a[180:183], v[224:227]
M v[228:231], a[108:111], a[180:183], v[228:231]
M v[228:231], a[104:107], a[176:179], v[228:231]
M v[232:235], a[112:115], a[176:179], v[232:235]
M v[232:235], a[116:119], a[180:183], v[232:235]
M v[236:239], a[124:127], a[180:183], v[236:239]
M v[236:239], a[120:123], a[176:179], v[236:239]
s_waitcnt vmcnt(8) lgkmcnt(0)
s_barrier
ds_read_b128 a[160:163], v10 offset:0
ds_read_b128 a[164:167], v11 offset:0
M v[240:243], a[128:131], a[176:179], v[240:243]
s_add_u32 m0, s29, 32768
s_nop 0
buffer_load_dwordx4 v2, s[8:11], s23 offen offset:0 lds
M v[240:243], a[132:135], a[180:183], v[240:243]
M v[244:247], a[140:143], a[180:183], v[244:247]
M v[244:247], a[136:139], a[176:179], v[244:247]
M v[248:251], a[144:147], a[176:179], v[248:251]
M v[248:251], a[148:151], a[180:183], v[248:251]
M v[252:255], a[156:159], a[180:183], v[252:255]
M v[252:255], a[152:155], a[176:179], v[252:255]
M a[0:3], a[96:99], a[184:187], a[0:3]
M a[0:3], a[100:103], a[188:191], a[0:3]
ds_read_b128 a[168:171], v10 offset:2048
ds_read_b128 a[172:175], v11 offset:2048
M a[4:7], a[108:111], a[188:191], a[4:7]
M a[4:7], a[104:107], a[184:187], a[4:7]
M a[8:11], a[112:115], a[184:187], a[8:11]
buffer_load_dwordx4 v3, s[8:11], s23 offen offset:1024 lds
M a[8:11], a[116:119], a[188:191], a[8:11]
M a[12:15], a[124:127], a[188:191], a[12:15]
M a[12:15], a[120:123], a[184:187], a[12:15]
M a[16:19], a[128:131], a[184:187], a[16:19]
M a[16:19], a[132:135], a[188:191], a[16:19]
M a[20:23], a[140:143], a[188:191], a[20:23]
M a[20:23], a[136:139], a[184:187], a[20:23]
M a[24:27], a[144:147], a[184:187], a[24:27]
M a[24:27], a[148:151], a[188:191], a[24:27]
M a[28:31], a[156:159], a[188:191], a[28:31]
M a[28:31], a[152:155], a[184:187], a[28:31]
s_waitcnt lgkmcnt(2)
M v[32:35], a[32:35], a[160:163], v[32:35]
buffer_load_dwordx4 v4, s[8:11], s23 offen offset:2048 lds
M v[32:35], a[36:39], a[164:167], v[32:35]
ds_read_b128 a[176:179], v10 offset:4096
ds_read_b128 a[180:183], v11 offset:4096
M v[36:39], a[44:47], a[164:167], v[36:39]
M v[36:39], a[40:43], a[160:163], v[36:39]
ds_read_b64_tr_b16 a[96:97], v12 offset:32768
ds_read_b64_tr_b16 a[98:99], v12 offset:34816
M v[40:43], a[48:51], a[160:163], v[40:43]
M v[40:43], a[52:55], a[164:167], v[40:43]
M v[44:47], a[60:63], a[164:167], v[44:47]
M v[44:47], a[56:59], a[160:163], v[44:47]
ds_read_b64_tr_b16 a[104:105], v13 offset:32768
ds_read_b64_tr_b16 a[106:107], v13 offset:34816
M v[48:51], a[64:67], a[160:163], v[48:51]
M v[48:51], a[68:71], a[164:167], v[48:51]
M v[52:55], a[76:79], a[164:167], v[52:55]
M v[52:55], a[72:75], a[160:163], v[52:55]
ds_read_b64_tr_b16 a[112:113], v14 offset:32768
ds_read_b64_tr_b16 a[114:115], v14 offset:34816
M v[56:59], a[80:83], a[160:163], v[56:59]
M v[56:59], a[84:87], a[164:167], v[56:59]
M v[60:63], a[92:95], a[164:167], v[60:63]
M v[60:63], a[88:91], a[160:163], v[60:63]
s_waitcnt lgkmcnt(8)
ds_read_b64_tr_b16 a[120:121], v15 offset:32768
ds_read_b64_tr_b16 a[122:123], v15 offset:34816
M v[64:67], a[32:35], a[168:171], v[64:67]
M v[64:67], a[36:39], a[172:175], v[64:67]
ds_read_b128 a[184:187], v10 offset:6144
ds_read_b128 a[188:191], v11 offset:6144
M v[68:71], a[44:47], a[172:175], v[68:71]
M v[68:71], a[40:43], a[168:171], v[68:71]
ds_read_b64_tr_b16 a[128:129], v16 offset:32768
ds_read_b64_tr_b16 a[130:131], v16 offset:34816
M v[72:75], a[48:51], a[168:171], v[72:75]
buffer_load_dwordx4 v5, s[8:11], s23 offen offset:3072 lds
M v[72:75], a[52:55], a[172:175], v[72:75]
M v[76:79], a[60:63], a[172:175], v[76:79]
M v[76:79], a[56:59], a[168:171], v[76:79]
ds_read_b64_tr_b16 a[136:137], v17 offset:32768
ds_read_b64_tr_b16 a[138:139], v17 offset:34816
M v[80:83], a[64:67], a[168:171], v[80:83]
M v[80:83], a[68:71], a[172:175], v[80:83]
M v[84:87], a[76:79], a[172:175], v[84:87]
M v[84:87], a[72:75], a[168:171], v[84:87]
ds_read_b64_tr_b16 a[144:145], v18 offset:32768
ds_read_b64_tr_b16 a[146:147], v18 offset:34816
M v[88:91], a[80:83], a[168:171], v[88:91]
M v[88:91], a[84:87], a[172:175], v[88:91]
M v[92:95], a[92:95], a[172:175], v[92:95]
M v[92:95], a[88:91], a[168:171], v[92:95]
s_waitcnt lgkmcnt(15)
ds_read_b64_tr_b16 a[152:153], v19 offset:32768
ds_read_b64_tr_b16 a[154:155], v19 offset:34816
M v[96:99], a[32:35], a[176:179], v[96:99]
M v[96:99], a[36:39], a[180:183], v[96:99]
M v[100:103], a[44:47], a[180:183], v[100:103]
M v[100:103], a[40:43], a[176:179], v[100:103]
M v[104:107], a[48:51], a[176:179], v[104:107]
M v[104:107], a[52:55], a[180:183], v[104:107]
M v[108:111], a[60:63], a[180:183], v[108:111]
M v[108:111], a[56:59], a[176:179], v[108:111]
s_waitcnt vmcnt(4) lgkmcnt(0)
s_barrier
ds_read_b128 a[160:163], v10 offset:16384
ds_read_b128 a[164:167], v11 offset:16384
M v[112:115], a[64:67], a[176:179], v[112:115]
s_add_u32 m0, s29, 49152
s_add_u32 s3, s23, s31
buffer_load_dwordx4 v2, s[8:11], s3 offen offset:0 lds
M v[112:115], a[68:71], a[180:183], v[112:115]
M v[116:119], a[76:79], a[180:183], v[116:119]
buffer_load_dwordx4 v3, s[8:11], s3 offen offset:1024 lds
M v[116:119], a[72:75], a[176:179], v[116:119]
ds_read_b64_tr_b16 a[100:101], v12 offset:49152
ds_read_b64_tr_b16 a[102:103], v12 offset:51200
M v[120:123], a[80:83], a[176:179], v[120:123]
buffer_load_dwordx4 v4, s[8:11], s3 offen offset:2048 lds
M v[120:123], a[84:87], a[180:183], v[120:123]
M v[124:127], a[92:95], a[180:183], v[124:127]
buffer_load_dwordx4 v5, s[8:11], s3 offen offset:3072 lds
M v[124:127], a[88:91], a[176:179], v[124:127]
M v[128:131], a[32:35], a[184:187], v[128:131]
M v[128:131], a[36:39], a[188:191], v[128:131]
ds_read_b128 a[168:171], v10 offset:18432
ds_read_b128 a[172:175], v11 offset:18432
ds_read_b64_tr_b16 a[108:109], v13 offset:49152
ds_read_b64_tr_b16 a[110:111], v13 offset:51200
M v[132:135], a[44:47], a[188:191], v[132:135]
M v[132:135], a[40:43], a[184:187], v[132:135]
M v[136:139], a[48:51], a[184:187], v[136:139]
s_and_b32 s3, s2, 1
s_lshl_b32 s3, s3, 3
s_bfe_u32 s4, s2, 0x30003
s_add_u32 s26, s3, s4
M v[136:139], a[52:55], a[188:191], v[136:139]
s_bfe_u32 s3, s2, 0x20001
s_lshl_b32 s3, s3, 2
s_lshr_b32 s4, s2, 6
M v[140:143], a[60:63], a[188:191], v[140:143]
s_xor_b32 s4, s4, 2
s_add_u32 s27, s3, s4
s_lshl_b32 s23, s26, 18
M v[140:143], a[56:59], a[184:187], v[140:143]
ds_read_b64_tr_b16 a[116:117], v14 offset:49152
ds_read_b64_tr_b16 a[118:119], v14 offset:51200
s_sub_u32 s24, s23, 32768
s_max_i32 s24, s24, 0
s_lshl_b32 s25, s27, 7
s_add_u32 s3, s26, s27
M v[144:147], a[64:67], a[184:187], v[144:147]
s_and_b32 s3, s3, 0
s_mul_i32 s3, s3, 16
s_sub_u32 s31, 16, s3
M v[144:147], a[68:71], a[188:191], v[144:147]
s_mov_b32 s54, s31
s_movk_i32 s57, 128
s_mov_b32 s55, 4289069056
M v[148:151], a[76:79], a[188:191], v[148:151]
s_mov_b32 s56, 393216
s_lshl_b32 s4, s3, 7
s_add_u32 s23, s23, s4
s_add_u32 s24, s24, s4
M v[148:151], a[72:75], a[184:187], v[148:151]
s_mul_i32 s4, s3, 393216
s_add_u32 s25, s25, s4
s_mov_b64 s[8:9], s[44:45]
M v[152:155], a[80:83], a[184:187], v[152:155]
s_mov_b32 s10, 4194304
s_mov_b64 s[12:13], s[46:47]
s_mov_b32 s14, 6291456
M v[152:155], a[84:87], a[188:191], v[152:155]
ds_read_b64_tr_b16 a[124:125], v15 offset:49152
ds_read_b64_tr_b16 a[126:127], v15 offset:51200
s_mov_b64 s[36:37], s[90:91]
s_mov_b32 s38, 256
s_mov_b32 s39, 0x00020000
M v[156:159], a[92:95], a[188:191], v[156:159]
s_lshl_b32 s28, s20, 9
s_mul_i32 s30, s20, 6144
s_lshl_b32 s3, s20, 5
v_lshrrev_b32 v24, 3, v0
M v[156:159], a[88:91], a[184:187], v[156:159]
s_waitcnt lgkmcnt(10)
v_and_b32 v25, 7, v0
v_add_u32 v28, s3, v24
v_add_u32 v26, 0, v28
M v[160:163], a[32:35], a[160:163], v[160:163]
v_bfe_u32 v27, v26, 1, 3
v_xor_b32 v27, v27, v25
v_lshlrev_b32 v26, 11, v26
M v[160:163], a[36:39], a[164:167], v[160:163]
ds_read_b128 a[176:179], v10 offset:20480
ds_read_b128 a[180:183], v11 offset:20480
v_lshl_add_u32 v26, v27, 4, v26
v_subrev_u32 v2, 0, v26
v_add_u32 v26, 8, v28
v_bfe_u32 v27, v26, 1, 3
M v[164:167], a[44:47], a[164:167], v[164:167]
v_xor_b32 v27, v27, v25
v_lshlrev_b32 v26, 11, v26
v_lshl_add_u32 v26, v27, 4, v26
M v[164:167], a[40:43], a[160:163], v[164:167]
ds_read_b64_tr_b16 a[132:133], v16 offset:49152
ds_read_b64_tr_b16 a[134:135], v16 offset:51200
v_subrev_u32 v3, 1024, v26
v_add_u32 v26, 16, v28
v_bfe_u32 v27, v26, 1, 3
M v[168:171], a[48:51], a[160:163], v[168:171]
v_xor_b32 v27, v27, v25
v_lshlrev_b32 v26, 11, v26
v_lshl_add_u32 v26, v27, 4, v26
M v[168:171], a[52:55], a[164:167], v[168:171]
v_subrev_u32 v4, 2048, v26
v_add_u32 v26, 24, v28
v_bfe_u32 v27, v26, 1, 3
v_xor_b32 v27, v27, v25
M v[172:175], a[60:63], a[164:167], v[172:175]
v_lshlrev_b32 v26, 11, v26
v_lshl_add_u32 v26, v27, 4, v26
v_subrev_u32 v5, 3072, v26
M v[172:175], a[56:59], a[160:163], v[172:175]
s_lshl_b32 s3, s20, 2
v_lshrrev_b32 v26, 5, v0
v_add_u32 v26, s3, v26
M v[176:179], a[64:67], a[160:163], v[176:179]
v_bfe_u32 v29, v0, 2, 3
v_bfe_u32 v27, v26, 1, 3
v_xor_b32 v27, v27, v29
v_lshlrev_b32 v27, 4, v27
M v[176:179], a[68:71], a[164:167], v[176:179]
ds_read_b64_tr_b16 a[140:141], v17 offset:49152
ds_read_b64_tr_b16 a[142:143], v17 offset:51200
v_and_b32 v30, 3, v0
v_lshl_add_u32 v27, v30, 2, v27
v_lshl_add_u32 v20, v26, 11, v27
M v[180:183], a[76:79], a[164:167], v[180:183]
v_add_u32 v26, 2, v26
v_bfe_u32 v27, v26, 1, 3
v_xor_b32 v27, v27, v29
M v[180:183], a[72:75], a[160:163], v[180:183]
v_lshlrev_b32 v27, 4, v27
v_and_b32 v30, 3, v0
v_lshl_add_u32 v27, v30, 2, v27
M v[184:187], a[80:83], a[160:163], v[184:187]
v_lshl_add_u32 v23, v26, 11, v27
v_subrev_u32 v23, 256, v23
s_mul_i32 s3, s20, 48
v_add_u32 v28, s3, v24
M v[184:187], a[84:87], a[164:167], v[184:187]
v_add_u32 v26, 0, v28
v_mul_u32_u24 v27, 0xaaab, v26
v_lshrrev_b32 v27, 17, v27
M v[188:191], a[92:95], a[164:167], v[188:191]
v_lshrrev_b32 v29, 1, v27
v_and_b32 v29, 4, v29
v_and_or_b32 v27, v27, 2, v29
M v[188:191], a[88:91], a[160:163], v[188:191]
s_waitcnt lgkmcnt(12)
ds_read_b64_tr_b16 a[148:149], v18 offset:49152
ds_read_b64_tr_b16 a[150:151], v18 offset:51200
v_xor_b32 v27, v27, v25
v_lshlrev_b32 v26, 11, v26
v_lshl_add_u32 v26, v27, 4, v26
v_subrev_u32 v6, 0, v26
M v[192:195], a[32:35], a[168:171], v[192:195]
v_add_u32 v26, 8, v28
v_mul_u32_u24 v27, 0xaaab, v26
v_lshrrev_b32 v27, 17, v27
M v[192:195], a[36:39], a[172:175], v[192:195]
ds_read_b128 a[184:187], v10 offset:22528
ds_read_b128 a[188:191], v11 offset:22528
v_lshrrev_b32 v29, 1, v27
v_and_b32 v29, 4, v29
v_and_or_b32 v27, v27, 2, v29
M v[196:199], a[44:47], a[172:175], v[196:199]
v_xor_b32 v27, v27, v25
v_lshlrev_b32 v26, 11, v26
v_lshl_add_u32 v26, v27, 4, v26
v_subrev_u32 v7, 1024, v26
M v[196:199], a[40:43], a[168:171], v[196:199]
v_add_u32 v26, 16, v28
v_mul_u32_u24 v27, 0xaaab, v26
v_lshrrev_b32 v27, 17, v27
M v[200:203], a[48:51], a[168:171], v[200:203]
v_lshrrev_b32 v29, 1, v27
v_and_b32 v29, 4, v29
v_and_or_b32 v27, v27, 2, v29
M v[200:203], a[52:55], a[172:175], v[200:203]
ds_read_b64_tr_b16 a[156:157], v19 offset:49152
ds_read_b64_tr_b16 a[158:159], v19 offset:51200
v_xor_b32 v27, v27, v25
v_lshlrev_b32 v26, 11, v26
v_lshl_add_u32 v26, v27, 4, v26
M v[204:207], a[60:63], a[172:175], v[204:207]
v_subrev_u32 v8, 2048, v26
v_add_u32 v26, 24, v28
v_mul_u32_u24 v27, 0xaaab, v26
v_lshrrev_b32 v27, 17, v27
M v[204:207], a[56:59], a[168:171], v[204:207]
v_lshrrev_b32 v29, 1, v27
v_and_b32 v29, 4, v29
v_and_or_b32 v27, v27, 2, v29
M v[208:211], a[64:67], a[168:171], v[208:211]
v_xor_b32 v27, v27, v25
v_lshlrev_b32 v26, 11, v26
v_lshl_add_u32 v26, v27, 4, v26
M v[208:211], a[68:71], a[172:175], v[208:211]
v_subrev_u32 v9, 3072, v26
v_add_u32 v26, 32, v28
v_mul_u32_u24 v27, 0xaaab, v26
v_lshrrev_b32 v27, 17, v27
M v[212:215], a[76:79], a[172:175], v[212:215]
v_lshrrev_b32 v29, 1, v27
v_and_b32 v29, 4, v29
v_and_or_b32 v27, v27, 2, v29
M v[212:215], a[72:75], a[168:171], v[212:215]
v_xor_b32 v27, v27, v25
v_lshlrev_b32 v26, 11, v26
v_lshl_add_u32 v26, v27, 4, v26
M v[216:219], a[80:83], a[168:171], v[216:219]
v_subrev_u32 v21, 0, v26
v_add_u32 v26, 40, v28
v_mul_u32_u24 v27, 0xaaab, v26
M v[216:219], a[84:87], a[172:175], v[216:219]
v_lshrrev_b32 v27, 17, v27
v_lshrrev_b32 v29, 1, v27
v_and_b32 v29, 4, v29
v_and_or_b32 v27, v27, 2, v29
M v[220:223], a[92:95], a[172:175], v[220:223]
v_xor_b32 v27, v27, v25
v_lshlrev_b32 v26, 11, v26
v_lshl_add_u32 v26, v27, 4, v26
M v[220:223], a[88:91], a[168:171], v[220:223]
s_waitcnt lgkmcnt(10)
v_subrev_u32 v22, 1024, v26
s_lshr_b32 s3, s53, 7
s_add_u32 s3, s3, s22
M v[224:227], a[32:35], a[176:179], v[224:227]
s_lshl_b32 s3, s3, 5
s_lshr_b32 s19, s52, 6
s_add_u32 s3, s3, s19
s_lshl_b32 s19, s21, 1
M v[224:227], a[36:39], a[180:183], v[224:227]
s_add_u32 s3, s3, s19
s_lshl_b32 s92, s3, 14
s_add_u32 s93, s92, 16384
M v[228:231], a[44:47], a[180:183], v[228:231]
s_add_u32 s16, s50, 0
s_addc_u32 s17, s51, 0
s_mov_b32 s18, 16777216
M v[228:231], a[40:43], a[176:179], v[228:231]
s_mov_b32 s19, 0x00020000
s_mov_b32 s4, 0x3e0293ee
s_mov_b32 s5, 0x3e0293ee
M v[232:235], a[48:51], a[176:179], v[232:235]
M v[232:235], a[52:55], a[180:183], v[232:235]
M v[236:239], a[60:63], a[180:183], v[236:239]
M v[236:239], a[56:59], a[176:179], v[236:239]
s_waitcnt vmcnt(4) lgkmcnt(0)
s_barrier
ds_read_b128 a[160:163], v10 offset:32768
ds_read_b128 a[164:167], v11 offset:32768
M v[240:243], a[64:67], a[176:179], v[240:243]
s_add_u32 m0, s28, 131072
s_nop 0
buffer_load_dword v20, s[8:11], s24 offen lds
M v[240:243], a[68:71], a[180:183], v[240:243]
M v[244:247], a[76:79], a[180:183], v[244:247]
M v[244:247], a[72:75], a[176:179], v[244:247]
buffer_load_dword v23, s[8:11], s24 offen offset:256 lds
M v[248:251], a[80:83], a[176:179], v[248:251]
M v[248:251], a[84:87], a[180:183], v[248:251]
M v[252:255], a[92:95], a[180:183], v[252:255]
M v[252:255], a[88:91], a[176:179], v[252:255]
M a[0:3], a[32:35], a[184:187], a[0:3]
s_add_u32 m0, s29, 133120
s_nop 0
buffer_load_dwordx4 v2, s[8:11], s23 offen offset:0 lds
M a[0:3], a[36:39], a[188:191], a[0:3]
ds_read_b128 a[168:171], v10 offset:34816
ds_read_b128 a[172:175], v11 offset:34816
M a[4:7], a[44:47], a[188:191], a[4:7]
M a[4:7], a[40:43], a[184:187], a[4:7]
M a[8:11], a[48:51], a[184:187], a[8:11]
buffer_load_dwordx4 v3, s[8:11], s23 offen offset:1024 lds
M a[8:11], a[52:55], a[188:191], a[8:11]
M a[12:15], a[60:63], a[188:191], a[12:15]
M a[12:15], a[56:59], a[184:187], a[12:15]
M a[16:19], a[64:67], a[184:187], a[16:19]
buffer_load_dwordx4 v4, s[8:11], s23 offen offset:2048 lds
M a[16:19], a[68:71], a[188:191], a[16:19]
M a[20:23], a[76:79], a[188:191], a[20:23]
M a[20:23], a[72:75], a[184:187], a[20:23]
buffer_load_dwordx4 v5, s[8:11], s23 offen offset:3072 lds
M a[24:27], a[80:83], a[184:187], a[24:27]
M a[24:27], a[84:87], a[188:191], a[24:27]
M a[28:31], a[92:95], a[188:191], a[28:31]
M a[28:31], a[88:91], a[184:187], a[28:31]
s_waitcnt lgkmcnt(2)
M v[32:35], a[96:99], a[160:163], v[32:35]
s_sub_u32 s31, s31, 1
s_cmp_eq_u32 s31, 0
s_cselect_b32 s58, -1920, s57
s_add_u32 s23, s23, s58
s_add_u32 s24, s24, s58
M v[32:35], a[100:103], a[164:167], v[32:35]
ds_read_b128 a[176:179], v10 offset:36864
ds_read_b128 a[180:183], v11 offset:36864
M v[36:39], a[108:111], a[164:167], v[36:39]
M v[36:39], a[104:107], a[160:163], v[36:39]
M v[40:43], a[112:115], a[160:163], v[40:43]
M v[40:43], a[116:119], a[164:167], v[40:43]
s_add_u32 m0, s30, 65536
s_nop 0
buffer_load_dwordx4 v6, s[12:15], s25 offen offset:0 lds
M v[44:47], a[124:127], a[164:167], v[44:47]
M v[44:47], a[120:123], a[160:163], v[44:47]
M v[48:51], a[128:131], a[160:163], v[48:51]
M v[48:51], a[132:135], a[164:167], v[48:51]
buffer_load_dwordx4 v7, s[12:15], s25 offen offset:1024 lds
M v[52:55], a[140:143], a[164:167], v[52:55]
M v[52:55], a[136:139], a[160:163], v[52:55]
M v[56:59], a[144:147], a[160:163], v[56:59]
M v[56:59], a[148:151], a[164:167], v[56:59]
buffer_load_dwordx4 v8, s[12:15], s25 offen offset:2048 lds
M v[60:63], a[156:159], a[164:167], v[60:63]
M v[60:63], a[152:155], a[160:163], v[60:63]
s_waitcnt lgkmcnt(2)
M v[64:67], a[96:99], a[168:171], v[64:67]
M v[64:67], a[100:103], a[172:175], v[64:67]
ds_read_b128 a[184:187], v10 offset:38912
ds_read_b128 a[188:191], v11 offset:38912
M v[68:71], a[108:111], a[172:175], v[68:71]
M v[68:71], a[104:107], a[168:171], v[68:71]
buffer_load_dwordx4 v9, s[12:15], s25 offen offset:3072 lds
v_pk_mul_f32 v[32:33], v[32:33], s[4:5]
v_pk_mul_f32 v[34:35], v[34:35], s[4:5]
v_pk_mul_f32 v[36:37], v[36:37], s[4:5]
M v[72:75], a[112:115], a[168:171], v[72:75]
v_pk_mul_f32 v[38:39], v[38:39], s[4:5]
v_cvt_pk_bf16_f32 v32, v32, v33
M v[72:75], a[116:119], a[172:175], v[72:75]
v_cvt_pk_bf16_f32 v33, v34, v35
v_cvt_pk_bf16_f32 v34, v36, v37
M v[76:79], a[124:127], a[172:175], v[76:79]
v_cvt_pk_bf16_f32 v35, v38, v39
v_pk_mul_f32 v[40:41], v[40:41], s[4:5]
v_pk_mul_f32 v[42:43], v[42:43], s[4:5]
M v[76:79], a[120:123], a[168:171], v[76:79]
s_add_u32 m0, s30, 69632
s_nop 0
buffer_load_dwordx4 v21, s[12:15], s25 offen offset:0 lds
v_pk_mul_f32 v[44:45], v[44:45], s[4:5]
v_pk_mul_f32 v[46:47], v[46:47], s[4:5]
M v[80:83], a[128:131], a[168:171], v[80:83]
v_cvt_pk_bf16_f32 v40, v40, v41
v_cvt_pk_bf16_f32 v41, v42, v43
M v[80:83], a[132:135], a[172:175], v[80:83]
v_cvt_pk_bf16_f32 v42, v44, v45
v_cvt_pk_bf16_f32 v43, v46, v47
M v[84:87], a[140:143], a[172:175], v[84:87]
v_pk_mul_f32 v[48:49], v[48:49], s[4:5]
v_pk_mul_f32 v[50:51], v[50:51], s[4:5]
v_pk_mul_f32 v[52:53], v[52:53], s[4:5]
M v[84:87], a[136:139], a[168:171], v[84:87]
buffer_load_dwordx4 v22, s[12:15], s25 offen offset:1024 lds
v_pk_mul_f32 v[54:55], v[54:55], s[4:5]
v_cvt_pk_bf16_f32 v48, v48, v49
M v[88:91], a[144:147], a[168:171], v[88:91]
v_cvt_pk_bf16_f32 v49, v50, v51
v_cvt_pk_bf16_f32 v50, v52, v53
M v[88:91], a[148:151], a[172:175], v[88:91]
v_cvt_pk_bf16_f32 v51, v54, v55
v_pk_mul_f32 v[56:57], v[56:57], s[4:5]
v_pk_mul_f32 v[58:59], v[58:59], s[4:5]
M v[92:95], a[156:159], a[172:175], v[92:95]
v_pk_mul_f32 v[60:61], v[60:61], s[4:5]
v_pk_mul_f32 v[62:63], v[62:63], s[4:5]
M v[92:95], a[152:155], a[168:171], v[92:95]
s_waitcnt lgkmcnt(2)
v_cvt_pk_bf16_f32 v56, v56, v57
v_cvt_pk_bf16_f32 v57, v58, v59
M v[96:99], a[96:99], a[176:179], v[96:99]
s_sub_u32 s54, s54, 1
s_cmp_eq_u32 s54, 0
s_cselect_b32 s58, s55, s56
s_add_u32 s25, s25, s58
v_cvt_pk_bf16_f32 v58, v60, v61
v_cvt_pk_bf16_f32 v59, v62, v63
M v[96:99], a[100:103], a[180:183], v[96:99]
M v[100:103], a[108:111], a[180:183], v[100:103]
M v[100:103], a[104:107], a[176:179], v[100:103]
v_pk_mul_f32 v[64:65], v[64:65], s[4:5]
v_pk_mul_f32 v[66:67], v[66:67], s[4:5]
v_pk_mul_f32 v[68:69], v[68:69], s[4:5]
M v[104:107], a[112:115], a[176:179], v[104:107]
s_add_u32 s94, s92, 0
buffer_store_dwordx4 v[32:35], v1, s[16:19], s94 offen offset:0 sc1
v_pk_mul_f32 v[70:71], v[70:71], s[4:5]
v_cvt_pk_bf16_f32 v64, v64, v65
M v[104:107], a[116:119], a[180:183], v[104:107]
v_cvt_pk_bf16_f32 v65, v66, v67
v_cvt_pk_bf16_f32 v66, v68, v69
M v[108:111], a[124:127], a[180:183], v[108:111]
v_cvt_pk_bf16_f32 v67, v70, v71
v_pk_mul_f32 v[72:73], v[72:73], s[4:5]
v_pk_mul_f32 v[74:75], v[74:75], s[4:5]
M v[108:111], a[120:123], a[176:179], v[108:111]
s_waitcnt vmcnt(13) lgkmcnt(0)
s_barrier
ds_read_b128 a[160:163], v10 offset:49152
ds_read_b128 a[164:167], v11 offset:49152
v_pk_mul_f32 v[76:77], v[76:77], s[4:5]
v_pk_mul_f32 v[78:79], v[78:79], s[4:5]
M v[112:115], a[128:131], a[176:179], v[112:115]
s_add_u32 m0, s28, 0
s_nop 0
buffer_load_dword v20, s[8:11], s24 offen lds
v_cvt_pk_bf16_f32 v72, v72, v73
v_cvt_pk_bf16_f32 v73, v74, v75
M v[112:115], a[132:135], a[180:183], v[112:115]
v_cvt_pk_bf16_f32 v74, v76, v77
v_cvt_pk_bf16_f32 v75, v78, v79
M v[116:119], a[140:143], a[180:183], v[116:119]
s_add_u32 s94, s92, 0
buffer_store_dwordx4 v[40:43], v1, s[16:19], s94 offen offset:1024 sc1
v_pk_mul_f32 v[80:81], v[80:81], s[4:5]
v_pk_mul_f32 v[82:83], v[82:83], s[4:5]
v_pk_mul_f32 v[84:85], v[84:85], s[4:5]
M v[116:119], a[136:139], a[176:179], v[116:119]
v_pk_mul_f32 v[86:87], v[86:87], s[4:5]
v_cvt_pk_bf16_f32 v80, v80, v81
M v[120:123], a[144:147], a[176:179], v[120:123]
buffer_load_dword v23, s[8:11], s24 offen offset:256 lds
v_cvt_pk_bf16_f32 v81, v82, v83
v_cvt_pk_bf16_f32 v82, v84, v85
M v[120:123], a[148:151], a[180:183], v[120:123]
v_cvt_pk_bf16_f32 v83, v86, v87
v_pk_mul_f32 v[88:89], v[88:89], s[4:5]
v_pk_mul_f32 v[90:91], v[90:91], s[4:5]
M v[124:127], a[156:159], a[180:183], v[124:127]
v_pk_mul_f32 v[92:93], v[92:93], s[4:5]
v_pk_mul_f32 v[94:95], v[94:95], s[4:5]
M v[124:127], a[152:155], a[176:179], v[124:127]
v_cvt_pk_bf16_f32 v88, v88, v89
v_cvt_pk_bf16_f32 v89, v90, v91
M v[128:131], a[96:99], a[184:187], v[128:131]
s_add_u32 m0, s29, 2048
s_nop 0
buffer_load_dwordx4 v2, s[8:11], s23 offen offset:0 lds
v_cvt_pk_bf16_f32 v90, v92, v93
v_cvt_pk_bf16_f32 v91, v94, v95
M v[128:131], a[100:103], a[188:191], v[128:131]
ds_read_b128 a[168:171], v10 offset:51200
ds_read_b128 a[172:175], v11 offset:51200
M v[132:135], a[108:111], a[188:191], v[132:135]
s_add_u32 s94, s92, 0
buffer_store_dwordx4 v[48:51], v1, s[16:19], s94 offen offset:2048 sc1
M v[132:135], a[104:107], a[184:187], v[132:135]
v_pk_mul_f32 v[96:97], v[96:97], s[4:5]
v_pk_mul_f32 v[98:99], v[98:99], s[4:5]
v_pk_mul_f32 v[100:101], v[100:101], s[4:5]
M v[136:139], a[112:115], a[184:187], v[136:139]
v_pk_mul_f32 v[102:103], v[102:103], s[4:5]
v_cvt_pk_bf16_f32 v96, v96, v97
M v[136:139], a[116:119], a[188:191], v[136:139]
buffer_load_dwordx4 v3, s[8:11], s23 offen offset:1024 lds
v_cvt_pk_bf16_f32 v97, v98, v99
v_cvt_pk_bf16_f32 v98, v100, v101
M v[140:143], a[124:127], a[188:191], v[140:143]
v_cvt_pk_bf16_f32 v99, v102, v103
v_pk_mul_f32 v[104:105], v[104:105], s[4:5]
v_pk_mul_f32 v[106:107], v[106:107], s[4:5]
M v[140:143], a[120:123], a[184:187], v[140:143]
v_pk_mul_f32 v[108:109], v[108:109], s[4:5]
v_pk_mul_f32 v[110:111], v[110:111], s[4:5]
M v[144:147], a[128:131], a[184:187], v[144:147]
s_add_u32 s94, s92, 0
buffer_store_dwordx4 v[56:59], v1, s[16:19], s94 offen offset:3072 sc1
v_cvt_pk_bf16_f32 v104, v104, v105
v_cvt_pk_bf16_f32 v105, v106, v107
M v[144:147], a[132:135], a[188:191], v[144:147]
v_cvt_pk_bf16_f32 v106, v108, v109
v_cvt_pk_bf16_f32 v107, v110, v111
M v[148:151], a[140:143], a[188:191], v[148:151]
buffer_load_dwordx4 v4, s[8:11], s23 offen offset:2048 lds
v_pk_mul_f32 v[112:113], v[112:113], s[4:5]
v_pk_mul_f32 v[114:115], v[114:115], s[4:5]
v_pk_mul_f32 v[116:117], v[116:117], s[4:5]
M v[148:151], a[136:139], a[184:187], v[148:151]
v_pk_mul_f32 v[118:119], v[118:119], s[4:5]
v_cvt_pk_bf16_f32 v112, v112, v113
M v[152:155], a[144:147], a[184:187], v[152:155]
v_cvt_pk_bf16_f32 v113, v114, v115
v_cvt_pk_bf16_f32 v114, v116, v117
M v[152:155], a[148:151], a[188:191], v[152:155]
buffer_load_dwordx4 v5, s[8:11], s23 offen offset:3072 lds
v_cvt_pk_bf16_f32 v115, v118, v119
v_pk_mul_f32 v[120:121], v[120:121], s[4:5]
v_pk_mul_f32 v[122:123], v[122:123], s[4:5]
M v[156:159], a[156:159], a[188:191], v[156:159]
v_pk_mul_f32 v[124:125], v[124:125], s[4:5]
v_pk_mul_f32 v[126:127], v[126:127], s[4:5]
M v[156:159], a[152:155], a[184:187], v[156:159]
s_add_u32 s94, s92, 4096
buffer_store_dwordx4 v[64:67], v1, s[16:19], s94 offen offset:0 sc1
s_waitcnt lgkmcnt(2)
v_cvt_pk_bf16_f32 v120, v120, v121
v_cvt_pk_bf16_f32 v121, v122, v123
M v[160:163], a[96:99], a[160:163], v[160:163]
v_cvt_pk_bf16_f32 v122, v124, v125
v_cvt_pk_bf16_f32 v123, v126, v127
M v[160:163], a[100:103], a[164:167], v[160:163]
ds_read_b128 a[176:179], v10 offset:53248
ds_read_b128 a[180:183], v11 offset:53248
M v[164:167], a[108:111], a[164:167], v[164:167]
s_sub_u32 s31, s31, 1
s_cmp_eq_u32 s31, 0
s_cselect_b32 s58, -1920, s57
s_add_u32 s23, s23, s58
s_add_u32 s24, s24, s58
M v[164:167], a[104:107], a[160:163], v[164:167]
v_pk_mul_f32 v[128:129], v[128:129], s[4:5]
v_pk_mul_f32 v[130:131], v[130:131], s[4:5]
v_pk_mul_f32 v[132:133], v[132:133], s[4:5]
M v[168:171], a[112:115], a[160:163], v[168:171]
v_pk_mul_f32 v[134:135], v[134:135], s[4:5]
v_cvt_pk_bf16_f32 v128, v128, v129
M v[168:171], a[116:119], a[164:167], v[168:171]
s_add_u32 s94, s92, 4096
buffer_store_dwordx4 v[72:75], v1, s[16:19], s94 offen offset:1024 sc1
v_cvt_pk_bf16_f32 v129, v130, v131
v_cvt_pk_bf16_f32 v130, v132, v133
M v[172:175], a[124:127], a[164:167], v[172:175]
v_cvt_pk_bf16_f32 v131, v134, v135
v_pk_mul_f32 v[136:137], v[136:137], s[4:5]
v_pk_mul_f32 v[138:139], v[138:139], s[4:5]
M v[172:175], a[120:123], a[160:163], v[172:175]
s_add_u32 m0, s30, 98304
s_nop 0
buffer_load_dwordx4 v6, s[12:15], s25 offen offset:0 lds
v_pk_mul_f32 v[140:141], v[140:141], s[4:5]
v_pk_mul_f32 v[142:143], v[142:143], s[4:5]
M v[176:179], a[128:131], a[160:163], v[176:179]
v_cvt_pk_bf16_f32 v136, v136, v137
v_cvt_pk_bf16_f32 v137, v138, v139
M v[176:179], a[132:135], a[164:167], v[176:179]
v_cvt_pk_bf16_f32 v138, v140, v141
v_cvt_pk_bf16_f32 v139, v142, v143
M v[180:183], a[140:143], a[164:167], v[180:183]
buffer_load_dwordx4 v7, s[12:15], s25 offen offset:1024 lds
v_pk_mul_f32 v[144:145], v[144:145], s[4:5]
v_pk_mul_f32 v[146:147], v[146:147], s[4:5]
v_pk_mul_f32 v[148:149], v[148:149], s[4:5]
M v[180:183], a[136:139], a[160:163], v[180:183]
v_pk_mul_f32 v[150:151], v[150:151], s[4:5]
v_cvt_pk_bf16_f32 v144, v144, v145
M v[184:187], a[144:147], a[160:163], v[184:187]
s_add_u32 s94, s92, 4096
buffer_store_dwordx4 v[80:83], v1, s[16:19], s94 offen offset:2048 sc1
v_cvt_pk_bf16_f32 v145, v146, v147
v_cvt_pk_bf16_f32 v146, v148, v149
M v[184:187], a[148:151], a[164:167], v[184:187]
v_cvt_pk_bf16_f32 v147, v150, v151
v_pk_mul_f32 v[152:153], v[152:153], s[4:5]
v_pk_mul_f32 v[154:155], v[154:155], s[4:5]
M v[188:191], a[156:159], a[164:167], v[188:191]
buffer_load_dwordx4 v8, s[12:15], s25 offen offset:2048 lds
v_pk_mul_f32 v[156:157], v[156:157], s[4:5]
v_pk_mul_f32 v[158:159], v[158:159], s[4:5]
M v[188:191], a[152:155], a[160:163], v[188:191]
s_waitcnt lgkmcnt(2)
v_cvt_pk_bf16_f32 v152, v152, v153
v_cvt_pk_bf16_f32 v153, v154, v155
M v[192:195], a[96:99], a[168:171], v[192:195]
v_cvt_pk_bf16_f32 v154, v156, v157
v_cvt_pk_bf16_f32 v155, v158, v159
M v[192:195], a[100:103], a[172:175], v[192:195]
ds_read_b128 a[184:187], v10 offset:55296
ds_read_b128 a[188:191], v11 offset:55296
M v[196:199], a[108:111], a[172:175], v[196:199]
M v[196:199], a[104:107], a[168:171], v[196:199]
s_add_u32 s94, s92, 4096
buffer_store_dwordx4 v[88:91], v1, s[16:19], s94 offen offset:3072 sc1
v_pk_mul_f32 v[160:161], v[160:161], s[4:5]
v_pk_mul_f32 v[162:163], v[162:163], s[4:5]
v_pk_mul_f32 v[164:165], v[164:165], s[4:5]
M v[200:203], a[112:115], a[168:171], v[200:203]
buffer_load_dwordx4 v9, s[12:15], s25 offen offset:3072 lds
v_pk_mul_f32 v[166:167], v[166:167], s[4:5]
v_cvt_pk_bf16_f32 v160, v160, v161
M v[200:203], a[116:119], a[172:175], v[200:203]
v_cvt_pk_bf16_f32 v161, v162, v163
v_cvt_pk_bf16_f32 v162, v164, v165
M v[204:207], a[124:127], a[172:175], v[204:207]
v_cvt_pk_bf16_f32 v163, v166, v167
v_pk_mul_f32 v[168:169], v[168:169], s[4:5]
v_pk_mul_f32 v[170:171], v[170:171], s[4:5]
M v[204:207], a[120:123], a[168:171], v[204:207]
v_pk_mul_f32 v[172:173], v[172:173], s[4:5]
v_pk_mul_f32 v[174:175], v[174:175], s[4:5]
M v[208:211], a[128:131], a[168:171], v[208:211]
s_add_u32 m0, s30, 102400
s_nop 0
buffer_load_dwordx4 v21, s[12:15], s25 offen offset:0 lds
v_cvt_pk_bf16_f32 v168, v168, v169
v_cvt_pk_bf16_f32 v169, v170, v171
M v[208:211], a[132:135], a[172:175], v[208:211]
v_cvt_pk_bf16_f32 v170, v172, v173
v_cvt_pk_bf16_f32 v171, v174, v175
M v[212:215], a[140:143], a[172:175], v[212:215]
s_add_u32 s94, s92, 8192
buffer_store_dwordx4 v[96:99], v1, s[16:19], s94 offen offset:0 sc1
v_pk_mul_f32 v[176:177], v[176:177], s[4:5]
v_pk_mul_f32 v[178:179], v[178:179], s[4:5]
v_pk_mul_f32 v[180:181], v[180:181], s[4:5]
M v[212:215], a[136:139], a[168:171], v[212:215]
v_pk_mul_f32 v[182:183], v[182:183], s[4:5]
v_cvt_pk_bf16_f32 v176, v176, v177
M v[216:219], a[144:147], a[168:171], v[216:219]
buffer_load_dwordx4 v22, s[12:15], s25 offen offset:1024 lds
v_cvt_pk_bf16_f32 v177, v178, v179
v_cvt_pk_bf16_f32 v178, v180, v181
M v[216:219], a[148:151], a[172:175], v[216:219]
v_cvt_pk_bf16_f32 v179, v182, v183
v_pk_mul_f32 v[184:185], v[184:185], s[4:5]
v_pk_mul_f32 v[186:187], v[186:187], s[4:5]
M v[220:223], a[156:159], a[172:175], v[220:223]
v_pk_mul_f32 v[188:189], v[188:189], s[4:5]
v_pk_mul_f32 v[190:191], v[190:191], s[4:5]
M v[220:223], a[152:155], a[168:171], v[220:223]
s_waitcnt lgkmcnt(2)
v_cvt_pk_bf16_f32 v184, v184, v185
v_cvt_pk_bf16_f32 v185, v186, v187
M v[224:227], a[96:99], a[176:179], v[224:227]
s_add_u32 s94, s92, 8192
buffer_store_dwordx4 v[104:107], v1, s[16:19], s94 offen offset:1024 sc1
v_cvt_pk_bf16_f32 v186, v188, v189
v_cvt_pk_bf16_f32 v187, v190, v191
M v[224:227], a[100:103], a[180:183], v[224:227]
s_sub_u32 s54, s54, 1
s_cmp_eq_u32 s54, 0
s_cselect_b32 s58, s55, s56
s_add_u32 s25, s25, s58
M v[228:231], a[108:111], a[180:183], v[228:231]
M v[228:231], a[104:107], a[176:179], v[228:231]
v_pk_mul_f32 v[192:193], v[192:193], s[4:5]
v_pk_mul_f32 v[194:195], v[194:195], s[4:5]
v_pk_mul_f32 v[196:197], v[196:197], s[4:5]
M v[232:235], a[112:115], a[176:179], v[232:235]
v_pk_mul_f32 v[198:199], v[198:199], s[4:5]
v_cvt_pk_bf16_f32 v192, v192, v193
M v[232:235], a[116:119], a[180:183], v[232:235]
v_cvt_pk_bf16_f32 v193, v194, v195
v_cvt_pk_bf16_f32 v194, v196, v197
M v[236:239], a[124:127], a[180:183], v[236:239]
v_cvt_pk_bf16_f32 v195, v198, v199
v_pk_mul_f32 v[200:201], v[200:201], s[4:5]
v_pk_mul_f32 v[202:203], v[202:203], s[4:5]
M v[236:239], a[120:123], a[176:179], v[236:239]
s_waitcnt vmcnt(63) lgkmcnt(0)
s_barrier
v_pk_mul_f32 v[204:205], v[204:205], s[4:5]
v_pk_mul_f32 v[206:207], v[206:207], s[4:5]
M v[240:243], a[128:131], a[176:179], v[240:243]
s_add_u32 s94, s92, 8192
buffer_store_dwordx4 v[112:115], v1, s[16:19], s94 offen offset:2048 sc1
v_cvt_pk_bf16_f32 v200, v200, v201
v_cvt_pk_bf16_f32 v201, v202, v203
M v[240:243], a[132:135], a[180:183], v[240:243]
s_add_u32 m0, s28, 18432
s_nop 0
buffer_load_dword v20, s[8:11], s24 offen lds
v_cvt_pk_bf16_f32 v202, v204, v205
v_cvt_pk_bf16_f32 v203, v206, v207
M v[244:247], a[140:143], a[180:183], v[244:247]
v_pk_mul_f32 v[208:209], v[208:209], s[4:5]
v_pk_mul_f32 v[210:211], v[210:211], s[4:5]
v_pk_mul_f32 v[212:213], v[212:213], s[4:5]
M v[244:247], a[136:139], a[176:179], v[244:247]
v_pk_mul_f32 v[214:215], v[214:215], s[4:5]
v_cvt_pk_bf16_f32 v208, v208, v209
M v[248:251], a[144:147], a[176:179], v[248:251]
buffer_load_dword v23, s[8:11], s24 offen offset:256 lds
v_cvt_pk_bf16_f32 v209, v210, v211
v_cvt_pk_bf16_f32 v210, v212, v213
M v[248:251], a[148:151], a[180:183], v[248:251]
v_cvt_pk_bf16_f32 v211, v214, v215
v_pk_mul_f32 v[216:217], v[216:217], s[4:5]
v_pk_mul_f32 v[218:219], v[218:219], s[4:5]
M v[252:255], a[156:159], a[180:183], v[252:255]
s_add_u32 s94, s92, 8192
buffer_store_dwordx4 v[120:123], v1, s[16:19], s94 offen offset:3072 sc1
v_pk_mul_f32 v[220:221], v[220:221], s[4:5]
v_pk_mul_f32 v[222:223], v[222:223], s[4:5]
M v[252:255], a[152:155], a[176:179], v[252:255]
v_cvt_pk_bf16_f32 v216, v216, v217
v_cvt_pk_bf16_f32 v217, v218, v219
M a[0:3], a[96:99], a[184:187], a[0:3]
v_cvt_pk_bf16_f32 v218, v220, v221
v_cvt_pk_bf16_f32 v219, v222, v223
M a[0:3], a[100:103], a[188:191], a[0:3]
s_add_u32 m0, s29, 20480
s_nop 0
buffer_load_dwordx4 v2, s[8:11], s23 offen offset:0 lds
M a[4:7], a[108:111], a[188:191], a[4:7]
M a[4:7], a[104:107], a[184:187], a[4:7]
v_pk_mul_f32 v[224:225], v[224:225], s[4:5]
v_pk_mul_f32 v[226:227], v[226:227], s[4:5]
v_pk_mul_f32 v[228:229], v[228:229], s[4:5]
M a[8:11], a[112:115], a[184:187], a[8:11]
buffer_load_dwordx4 v3, s[8:11], s23 offen offset:1024 lds
v_pk_mul_f32 v[230:231], v[230:231], s[4:5]
v_cvt_pk_bf16_f32 v224, v224, v225
M a[8:11], a[116:119], a[188:191], a[8:11]
s_add_u32 s94, s92, 12288
buffer_store_dwordx4 v[128:131], v1, s[16:19], s94 offen offset:0 sc1
v_cvt_pk_bf16_f32 v225, v226, v227
v_cvt_pk_bf16_f32 v226, v228, v229
M a[12:15], a[124:127], a[188:191], a[12:15]
v_cvt_pk_bf16_f32 v227, v230, v231
v_pk_mul_f32 v[232:233], v[232:233], s[4:5]
v_pk_mul_f32 v[234:235], v[234:235], s[4:5]
M a[12:15], a[120:123], a[184:187], a[12:15]
v_pk_mul_f32 v[236:237], v[236:237], s[4:5]
v_pk_mul_f32 v[238:239], v[238:239], s[4:5]
M a[16:19], a[128:131], a[184:187], a[16:19]
buffer_load_dwordx4 v4, s[8:11], s23 offen offset:2048 lds
v_cvt_pk_bf16_f32 v232, v232, v233
v_cvt_pk_bf16_f32 v233, v234, v235
M a[16:19], a[132:135], a[188:191], a[16:19]
v_cvt_pk_bf16_f32 v234, v236, v237
v_cvt_pk_bf16_f32 v235, v238, v239
M a[20:23], a[140:143], a[188:191], a[20:23]
v_pk_mul_f32 v[240:241], v[240:241], s[4:5]
v_pk_mul_f32 v[242:243], v[242:243], s[4:5]
v_pk_mul_f32 v[244:245], v[244:245], s[4:5]
M a[20:23], a[136:139], a[184:187], a[20:23]
buffer_load_dwordx4 v5, s[8:11], s23 offen offset:3072 lds
v_pk_mul_f32 v[246:247], v[246:247], s[4:5]
v_cvt_pk_bf16_f32 v240, v240, v241
M a[24:27], a[144:147], a[184:187], a[24:27]
s_add_u32 s94, s92, 12288
buffer_store_dwordx4 v[136:139], v1, s[16:19], s94 offen offset:1024 sc1
v_cvt_pk_bf16_f32 v241, v242, v243
v_cvt_pk_bf16_f32 v242, v244, v245
M a[24:27], a[148:151], a[188:191], a[24:27]
v_cvt_pk_bf16_f32 v243, v246, v247
v_pk_mul_f32 v[248:249], v[248:249], s[4:5]
v_pk_mul_f32 v[250:251], v[250:251], s[4:5]
M a[28:31], a[156:159], a[188:191], a[28:31]
v_pk_mul_f32 v[252:253], v[252:253], s[4:5]
v_pk_mul_f32 v[254:255], v[254:255], s[4:5]
M a[28:31], a[152:155], a[184:187], a[28:31]
v_cvt_pk_bf16_f32 v248, v248, v249
v_cvt_pk_bf16_f32 v249, v250, v251
v_cvt_pk_bf16_f32 v250, v252, v253
v_cvt_pk_bf16_f32 v251, v254, v255
v_accvgpr_read_b32 v24, a0
v_accvgpr_read_b32 v25, a1
v_accvgpr_read_b32 v26, a2
v_accvgpr_read_b32 v27, a3
v_accvgpr_read_b32 v28, a4
v_accvgpr_read_b32 v29, a5
v_accvgpr_read_b32 v30, a6
v_accvgpr_read_b32 v31, a7
v_pk_mul_f32 v[24:25], v[24:25], s[4:5]
v_pk_mul_f32 v[26:27], v[26:27], s[4:5]
v_pk_mul_f32 v[28:29], v[28:29], s[4:5]
v_pk_mul_f32 v[30:31], v[30:31], s[4:5]
v_cvt_pk_bf16_f32 v36, v24, v25
v_cvt_pk_bf16_f32 v37, v26, v27
v_cvt_pk_bf16_f32 v38, v28, v29
v_cvt_pk_bf16_f32 v39, v30, v31
v_accvgpr_read_b32 v24, a8
v_accvgpr_read_b32 v25, a9
v_accvgpr_read_b32 v26, a10
v_accvgpr_read_b32 v27, a11
v_accvgpr_read_b32 v28, a12
v_accvgpr_read_b32 v29, a13
v_accvgpr_read_b32 v30, a14
v_accvgpr_read_b32 v31, a15
v_pk_mul_f32 v[24:25], v[24:25], s[4:5]
v_pk_mul_f32 v[26:27], v[26:27], s[4:5]
v_pk_mul_f32 v[28:29], v[28:29], s[4:5]
v_pk_mul_f32 v[30:31], v[30:31], s[4:5]
v_cvt_pk_bf16_f32 v44, v24, v25
v_cvt_pk_bf16_f32 v45, v26, v27
v_cvt_pk_bf16_f32 v46, v28, v29
v_cvt_pk_bf16_f32 v47, v30, v31
v_accvgpr_read_b32 v24, a16
v_accvgpr_read_b32 v25, a17
v_accvgpr_read_b32 v26, a18
v_accvgpr_read_b32 v27, a19
v_accvgpr_read_b32 v28, a20
v_accvgpr_read_b32 v29, a21
v_accvgpr_read_b32 v30, a22
v_accvgpr_read_b32 v31, a23
v_pk_mul_f32 v[24:25], v[24:25], s[4:5]
v_pk_mul_f32 v[26:27], v[26:27], s[4:5]
v_pk_mul_f32 v[28:29], v[28:29], s[4:5]
v_pk_mul_f32 v[30:31], v[30:31], s[4:5]
v_cvt_pk_bf16_f32 v52, v24, v25
v_cvt_pk_bf16_f32 v53, v26, v27
v_cvt_pk_bf16_f32 v54, v28, v29
v_cvt_pk_bf16_f32 v55, v30, v31
v_accvgpr_read_b32 v24, a24
v_accvgpr_read_b32 v25, a25
v_accvgpr_read_b32 v26, a26
v_accvgpr_read_b32 v27, a27
v_accvgpr_read_b32 v28, a28
v_accvgpr_read_b32 v29, a29
v_accvgpr_read_b32 v30, a30
v_accvgpr_read_b32 v31, a31
v_pk_mul_f32 v[24:25], v[24:25], s[4:5]
v_pk_mul_f32 v[26:27], v[26:27], s[4:5]
v_pk_mul_f32 v[28:29], v[28:29], s[4:5]
v_pk_mul_f32 v[30:31], v[30:31], s[4:5]
v_cvt_pk_bf16_f32 v60, v24, v25
v_cvt_pk_bf16_f32 v61, v26, v27
v_cvt_pk_bf16_f32 v62, v28, v29
v_cvt_pk_bf16_f32 v63, v30, v31
s_branch Lk1_b
Lk1_spin:
s_add_u32 s40, s40, 1
s_cmp_gt_u32 s40, 1048576
s_cbranch_scc1 Lk1_got
s_sleep 2
buffer_load_dword v126, v119, s[36:39], 0 offen offset:128 sc1
s_waitcnt vmcnt(0)
v_cmp_gt_u32 vcc, 0x80, v126
s_nop 0
s_cbranch_vccnz Lk1_spin
s_branch Lk1_got
Lk1_spinq:
s_add_u32 s40, s40, 1
s_cmp_gt_u32 s40, 1048576
s_cbranch_scc1 Lk1_gotq
s_sleep 2
buffer_load_dword v125, v119, s[36:39], 0 offen offset:0 sc1
s_waitcnt vmcnt(0)
v_cmp_gt_u32 vcc, 0x80, v125
s_nop 0
s_cbranch_vccnz Lk1_spinq
s_branch Lk1_gotq
Lk1_kv:
s_mov_b64 s[60:61], s[40:41]
s_mov_b32 s62, 4194304
s_and_b32 s3, s2, 127
s_lshl_b32 s3, s3, 2
s_add_u32 s3, s3, s20
s_mul_i32 s54, s3, 1024
M v[32:35], a[32:35], a[160:163], 0
s_add_u32 m0, s29, 32768
s_nop 0
buffer_load_dwordx4 v2, s[8:11], s23 offen offset:0 lds
M v[32:35], a[36:39], a[164:167], v[32:35]
ds_read_b128 a[176:179], v10 offset:4096
ds_read_b128 a[180:183], v11 offset:4096
M v[36:39], a[44:47], a[164:167], 0
M v[36:39], a[40:43], a[160:163], v[36:39]
ds_read_b64_tr_b16 a[96:97], v12 offset:32768
ds_read_b64_tr_b16 a[98:99], v12 offset:34816
M v[40:43], a[48:51], a[160:163], 0
M v[40:43], a[52:55], a[164:167], v[40:43]
buffer_load_dwordx4 v3, s[8:11], s23 offen offset:1024 lds
M v[44:47], a[60:63], a[164:167], 0
M v[44:47], a[56:59], a[160:163], v[44:47]
ds_read_b64_tr_b16 a[104:105], v13 offset:32768
ds_read_b64_tr_b16 a[106:107], v13 offset:34816
M v[48:51], a[64:67], a[160:163], 0
M v[48:51], a[68:71], a[164:167], v[48:51]
buffer_load_dwordx4 v4, s[8:11], s23 offen offset:2048 lds
M v[52:55], a[76:79], a[164:167], 0
M v[52:55], a[72:75], a[160:163], v[52:55]
ds_read_b64_tr_b16 a[112:113], v14 offset:32768
ds_read_b64_tr_b16 a[114:115], v14 offset:34816
M v[56:59], a[80:83], a[160:163], 0
M v[56:59], a[84:87], a[164:167], v[56:59]
buffer_load_dwordx4 v5, s[8:11], s23 offen offset:3072 lds
M v[60:63], a[92:95], a[164:167], 0
M v[60:63], a[88:91], a[160:163], v[60:63]
ds_read_b64_tr_b16 a[120:121], v15 offset:32768
ds_read_b64_tr_b16 a[122:123], v15 offset:34816
M v[64:67], a[32:35], a[168:171], 0
M v[64:67], a[36:39], a[172:175], v[64:67]
ds_read_b128 a[184:187], v10 offset:6144
ds_read_b128 a[188:191], v11 offset:6144
M v[68:71], a[44:47], a[172:175], 0
s_add_u32 m0, s29, 65536
s_nop 0
buffer_load_dwordx4 v6, s[12:15], s24 offen offset:0 lds
M v[68:71], a[40:43], a[168:171], v[68:71]
ds_read_b64_tr_b16 a[128:129], v16 offset:32768
ds_read_b64_tr_b16 a[130:131], v16 offset:34816
M v[72:75], a[48:51], a[168:171], 0
M v[72:75], a[52:55], a[172:175], v[72:75]
M v[76:79], a[60:63], a[172:175], 0
buffer_load_dwordx4 v7, s[12:15], s24 offen offset:1024 lds
M v[76:79], a[56:59], a[168:171], v[76:79]
ds_read_b64_tr_b16 a[136:137], v17 offset:32768
ds_read_b64_tr_b16 a[138:139], v17 offset:34816
M v[80:83], a[64:67], a[168:171], 0
M v[80:83], a[68:71], a[172:175], v[80:83]
M v[84:87], a[76:79], a[172:175], 0
buffer_load_dwordx4 v8, s[12:15], s24 offen offset:2048 lds
M v[84:87], a[72:75], a[168:171], v[84:87]
ds_read_b64_tr_b16 a[144:145], v18 offset:32768
ds_read_b64_tr_b16 a[146:147], v18 offset:34816
M v[88:91], a[80:83], a[168:171], 0
M v[88:91], a[84:87], a[172:175], v[88:91]
M v[92:95], a[92:95], a[172:175], 0
buffer_load_dwordx4 v9, s[12:15], s24 offen offset:3072 lds
M v[92:95], a[88:91], a[168:171], v[92:95]
s_waitcnt lgkmcnt(15)
ds_read_b64_tr_b16 a[152:153], v19 offset:32768
ds_read_b64_tr_b16 a[154:155], v19 offset:34816
M v[96:99], a[32:35], a[176:179], 0
M v[96:99], a[36:39], a[180:183], v[96:99]
M v[100:103], a[44:47], a[180:183], 0
s_add_u32 s24, s24, 262144
M v[100:103], a[40:43], a[176:179], v[100:103]
M v[104:107], a[48:51], a[176:179], 0
M v[104:107], a[52:55], a[180:183], v[104:107]
M v[108:111], a[60:63], a[180:183], 0
M v[108:111], a[56:59], a[176:179], v[108:111]
s_waitcnt vmcnt(9) lgkmcnt(0)
s_barrier
ds_read_b128 a[160:163], v10 offset:16384
ds_read_b128 a[164:167], v11 offset:16384
M v[112:115], a[64:67], a[176:179], 0
s_add_u32 m0, s29, 49152
s_add_u32 s3, s23, s31
buffer_load_dwordx4 v2, s[8:11], s3 offen offset:0 lds
M v[112:115], a[68:71], a[180:183], v[112:115]
M v[116:119], a[76:79], a[180:183], 0
M v[116:119], a[72:75], a[176:179], v[116:119]
ds_read_b64_tr_b16 a[100:101], v12 offset:49152
ds_read_b64_tr_b16 a[102:103], v12 offset:51200
M v[120:123], a[80:83], a[176:179], 0
M v[120:123], a[84:87], a[180:183], v[120:123]
buffer_load_dwordx4 v3, s[8:11], s3 offen offset:1024 lds
M v[124:127], a[92:95], a[180:183], 0
M v[124:127], a[88:91], a[176:179], v[124:127]
M v[128:131], a[32:35], a[184:187], 0
M v[128:131], a[36:39], a[188:191], v[128:131]
ds_read_b128 a[168:171], v10 offset:18432
ds_read_b128 a[172:175], v11 offset:18432
ds_read_b64_tr_b16 a[108:109], v13 offset:49152
ds_read_b64_tr_b16 a[110:111], v13 offset:51200
M v[132:135], a[44:47], a[188:191], 0
M v[132:135], a[40:43], a[184:187], v[132:135]
M v[136:139], a[48:51], a[184:187], 0
buffer_load_dwordx4 v4, s[8:11], s3 offen offset:2048 lds
M v[136:139], a[52:55], a[188:191], v[136:139]
M v[140:143], a[60:63], a[188:191], 0
M v[140:143], a[56:59], a[184:187], v[140:143]
ds_read_b64_tr_b16 a[116:117], v14 offset:49152
ds_read_b64_tr_b16 a[118:119], v14 offset:51200
M v[144:147], a[64:67], a[184:187], 0
M v[144:147], a[68:71], a[188:191], v[144:147]
M v[148:151], a[76:79], a[188:191], 0
buffer_load_dwordx4 v5, s[8:11], s3 offen offset:3072 lds
M v[148:151], a[72:75], a[184:187], v[148:151]
M v[152:155], a[80:83], a[184:187], 0
M v[152:155], a[84:87], a[188:191], v[152:155]
ds_read_b64_tr_b16 a[124:125], v15 offset:49152
ds_read_b64_tr_b16 a[126:127], v15 offset:51200
M v[156:159], a[92:95], a[188:191], 0
M v[156:159], a[88:91], a[184:187], v[156:159]
s_waitcnt lgkmcnt(10)
M v[160:163], a[32:35], a[160:163], 0
M v[160:163], a[36:39], a[164:167], v[160:163]
ds_read_b128 a[176:179], v10 offset:20480
ds_read_b128 a[180:183], v11 offset:20480
M v[164:167], a[44:47], a[164:167], 0
s_add_u32 s23, s23, 128
s_cmp_eq_u32 s23, s25
s_cselect_b32 s23, s26, s23
M v[164:167], a[40:43], a[160:163], v[164:167]
ds_read_b64_tr_b16 a[132:133], v16 offset:49152
ds_read_b64_tr_b16 a[134:135], v16 offset:51200
M v[168:171], a[48:51], a[160:163], 0
M v[168:171], a[52:55], a[164:167], v[168:171]
M v[172:175], a[60:63], a[164:167], 0
M v[172:175], a[56:59], a[160:163], v[172:175]
M v[176:179], a[64:67], a[160:163], 0
s_add_u32 m0, s29, 81920
s_nop 0
buffer_load_dwordx4 v6, s[12:15], s24 offen offset:0 lds
M v[176:179], a[68:71], a[164:167], v[176:179]
ds_read_b64_tr_b16 a[140:141], v17 offset:49152
ds_read_b64_tr_b16 a[142:143], v17 offset:51200
M v[180:183], a[76:79], a[164:167], 0
M v[180:183], a[72:75], a[160:163], v[180:183]
M v[184:187], a[80:83], a[160:163], 0
M v[184:187], a[84:87], a[164:167], v[184:187]
buffer_load_dwordx4 v7, s[12:15], s24 offen offset:1024 lds
M v[188:191], a[92:95], a[164:167], 0
M v[188:191], a[88:91], a[160:163], v[188:191]
s_waitcnt lgkmcnt(12)
ds_read_b64_tr_b16 a[148:149], v18 offset:49152
ds_read_b64_tr_b16 a[150:151], v18 offset:51200
M v[192:195], a[32:35], a[168:171], 0
M v[192:195], a[36:39], a[172:175], v[192:195]
ds_read_b128 a[184:187], v10 offset:22528
ds_read_b128 a[188:191], v11 offset:22528
M v[196:199], a[44:47], a[172:175], 0
M v[196:199], a[40:43], a[168:171], v[196:199]
M v[200:203], a[48:51], a[168:171], 0
buffer_load_dwordx4 v8, s[12:15], s24 offen offset:2048 lds
M v[200:203], a[52:55], a[172:175], v[200:203]
ds_read_b64_tr_b16 a[156:157], v19 offset:49152
ds_read_b64_tr_b16 a[158:159], v19 offset:51200
M v[204:207], a[60:63], a[172:175], 0
M v[204:207], a[56:59], a[168:171], v[204:207]
M v[208:211], a[64:67], a[168:171], 0
M v[208:211], a[68:71], a[172:175], v[208:211]
M v[212:215], a[76:79], a[172:175], 0
buffer_load_dwordx4 v9, s[12:15], s24 offen offset:3072 lds
M v[212:215], a[72:75], a[168:171], v[212:215]
M v[216:219], a[80:83], a[168:171], 0
M v[216:219], a[84:87], a[172:175], v[216:219]
M v[220:223], a[92:95], a[172:175], 0
M v[220:223], a[88:91], a[168:171], v[220:223]
s_waitcnt lgkmcnt(10)
M v[224:227], a[32:35], a[176:179], 0
s_add_u32 s24, s24, 262144
s_cmp_eq_u32 s24, s27
s_cselect_b32 s24, s28, s24
s_sub_u32 s6, s6, 1
s_cmp_eq_u32 s6, 0
s_cselect_b64 s[12:13], s[64:65], s[12:13]
M v[224:227], a[36:39], a[180:183], v[224:227]
M v[228:231], a[44:47], a[180:183], 0
M v[228:231], a[40:43], a[176:179], v[228:231]
M v[232:235], a[48:51], a[176:179], 0
M v[232:235], a[52:55], a[180:183], v[232:235]
M v[236:239], a[60:63], a[180:183], 0
M v[236:239], a[56:59], a[176:179], v[236:239]
s_waitcnt vmcnt(8) lgkmcnt(0)
s_barrier
ds_read_b128 a[160:163], v10 offset:32768
ds_read_b128 a[164:167], v11 offset:32768
M v[240:243], a[64:67], a[176:179], 0
s_add_u32 m0, s29, 0
s_nop 0
buffer_load_dwordx4 v2, s[8:11], s23 offen offset:0 lds
M v[240:243], a[68:71], a[180:183], v[240:243]
M v[244:247], a[76:79], a[180:183], 0
M v[244:247], a[72:75], a[176:179], v[244:247]
M v[248:251], a[80:83], a[176:179], 0
M v[248:251], a[84:87], a[180:183], v[248:251]
buffer_load_dwordx4 v3, s[8:11], s23 offen offset:1024 lds
M v[252:255], a[92:95], a[180:183], 0
M v[252:255], a[88:91], a[176:179], v[252:255]
M a[0:3], a[32:35], a[184:187], 0
M a[0:3], a[36:39], a[188:191], a[0:3]
ds_read_b128 a[168:171], v10 offset:34816
ds_read_b128 a[172:175], v11 offset:34816
M a[4:7], a[44:47], a[188:191], 0
M a[4:7], a[40:43], a[184:187], a[4:7]
M a[8:11], a[48:51], a[184:187], 0
buffer_load_dwordx4 v4, s[8:11], s23 offen offset:2048 lds
M a[8:11], a[52:55], a[188:191], a[8:11]
M a[12:15], a[60:63], a[188:191], 0
M a[12:15], a[56:59], a[184:187], a[12:15]
M a[16:19], a[64:67], a[184:187], 0
M a[16:19], a[68:71], a[188:191], a[16:19]
buffer_load_dwordx4 v5, s[8:11], s23 offen offset:3072 lds
M a[20:23], a[76:79], a[188:191], 0
M a[20:23], a[72:75], a[184:187], a[20:23]
M a[24:27], a[80:83], a[184:187], 0
M a[24:27], a[84:87], a[188:191], a[24:27]
M a[28:31], a[92:95], a[188:191], 0
M a[28:31], a[88:91], a[184:187], a[28:31]
s_waitcnt lgkmcnt(2)
M v[32:35], a[96:99], a[160:163], v[32:35]
s_add_u32 m0, s29, 98304
s_nop 0
buffer_load_dwordx4 v6, s[12:15], s24 offen offset:0 lds
M v[32:35], a[100:103], a[164:167], v[32:35]
ds_read_b128 a[176:179], v10 offset:36864
ds_read_b128 a[180:183], v11 offset:36864
M v[36:39], a[108:111], a[164:167], v[36:39]
M v[36:39], a[104:107], a[160:163], v[36:39]
ds_read_b64_tr_b16 a[32:33], v12 offset:0
ds_read_b64_tr_b16 a[34:35], v12 offset:2048
M v[40:43], a[112:115], a[160:163], v[40:43]
M v[40:43], a[116:119], a[164:167], v[40:43]
M v[44:47], a[124:127], a[164:167], v[44:47]
M v[44:47], a[120:123], a[160:163], v[44:47]
ds_read_b64_tr_b16 a[40:41], v13 offset:0
ds_read_b64_tr_b16 a[42:43], v13 offset:2048
M v[48:51], a[128:131], a[160:163], v[48:51]
buffer_load_dwordx4 v7, s[12:15], s24 offen offset:1024 lds
M v[48:51], a[132:135], a[164:167], v[48:51]
M v[52:55], a[140:143], a[164:167], v[52:55]
M v[52:55], a[136:139], a[160:163], v[52:55]
ds_read_b64_tr_b16 a[48:49], v14 offset:0
ds_read_b64_tr_b16 a[50:51], v14 offset:2048
M v[56:59], a[144:147], a[160:163], v[56:59]
M v[56:59], a[148:151], a[164:167], v[56:59]
M v[60:63], a[156:159], a[164:167], v[60:63]
buffer_load_dwordx4 v8, s[12:15], s24 offen offset:2048 lds
M v[60:63], a[152:155], a[160:163], v[60:63]
s_waitcnt lgkmcnt(8)
ds_read_b64_tr_b16 a[56:57], v15 offset:0
ds_read_b64_tr_b16 a[58:59], v15 offset:2048
M v[64:67], a[96:99], a[168:171], v[64:67]
M v[64:67], a[100:103], a[172:175], v[64:67]
ds_read_b128 a[184:187], v10 offset:38912
ds_read_b128 a[188:191], v11 offset:38912
M v[68:71], a[108:111], a[172:175], v[68:71]
M v[68:71], a[104:107], a[168:171], v[68:71]
ds_read_b64_tr_b16 a[64:65], v16 offset:0
ds_read_b64_tr_b16 a[66:67], v16 offset:2048
M v[72:75], a[112:115], a[168:171], v[72:75]
M v[72:75], a[116:119], a[172:175], v[72:75]
M v[76:79], a[124:127], a[172:175], v[76:79]
M v[76:79], a[120:123], a[168:171], v[76:79]
ds_read_b64_tr_b16 a[72:73], v17 offset:0
ds_read_b64_tr_b16 a[74:75], v17 offset:2048
M v[80:83], a[128:131], a[168:171], v[80:83]
buffer_load_dwordx4 v9, s[12:15], s24 offen offset:3072 lds
M v[80:83], a[132:135], a[172:175], v[80:83]
M v[84:87], a[140:143], a[172:175], v[84:87]
M v[84:87], a[136:139], a[168:171], v[84:87]
ds_read_b64_tr_b16 a[80:81], v18 offset:0
ds_read_b64_tr_b16 a[82:83], v18 offset:2048
M v[88:91], a[144:147], a[168:171], v[88:91]
M v[88:91], a[148:151], a[172:175], v[88:91]
M v[92:95], a[156:159], a[172:175], v[92:95]
s_add_u32 s24, s24, 262144
M v[92:95], a[152:155], a[168:171], v[92:95]
s_waitcnt lgkmcnt(15)
ds_read_b64_tr_b16 a[88:89], v19 offset:0
ds_read_b64_tr_b16 a[90:91], v19 offset:2048
M v[96:99], a[96:99], a[176:179], v[96:99]
M v[96:99], a[100:103], a[180:183], v[96:99]
M v[100:103], a[108:111], a[180:183], v[100:103]
M v[100:103], a[104:107], a[176:179], v[100:103]
M v[104:107], a[112:115], a[176:179], v[104:107]
M v[104:107], a[116:119], a[180:183], v[104:107]
M v[108:111], a[124:127], a[180:183], v[108:111]
M v[108:111], a[120:123], a[176:179], v[108:111]
s_waitcnt vmcnt(8) lgkmcnt(0)
s_barrier
ds_read_b128 a[160:163], v10 offset:49152
ds_read_b128 a[164:167], v11 offset:49152
M v[112:115], a[128:131], a[176:179], v[112:115]
s_add_u32 m0, s29, 16384
s_add_u32 s3, s23, s31
buffer_load_dwordx4 v2, s[8:11], s3 offen offset:0 lds
M v[112:115], a[132:135], a[180:183], v[112:115]
M v[116:119], a[140:143], a[180:183], v[116:119]
M v[116:119], a[136:139], a[176:179], v[116:119]
ds_read_b64_tr_b16 a[36:37], v12 offset:16384
ds_read_b64_tr_b16 a[38:39], v12 offset:18432
M v[120:123], a[144:147], a[176:179], v[120:123]
M v[120:123], a[148:151], a[180:183], v[120:123]
buffer_load_dwordx4 v3, s[8:11], s3 offen offset:1024 lds
M v[124:127], a[156:159], a[180:183], v[124:127]
M v[124:127], a[152:155], a[176:179], v[124:127]
M v[128:131], a[96:99], a[184:187], v[128:131]
M v[128:131], a[100:103], a[188:191], v[128:131]
ds_read_b128 a[168:171], v10 offset:51200
ds_read_b128 a[172:175], v11 offset:51200
ds_read_b64_tr_b16 a[44:45], v13 offset:16384
ds_read_b64_tr_b16 a[46:47], v13 offset:18432
M v[132:135], a[108:111], a[188:191], v[132:135]
M v[132:135], a[104:107], a[184:187], v[132:135]
M v[136:139], a[112:115], a[184:187], v[136:139]
buffer_load_dwordx4 v4, s[8:11], s3 offen offset:2048 lds
M v[136:139], a[116:119], a[188:191], v[136:139]
M v[140:143], a[124:127], a[188:191], v[140:143]
M v[140:143], a[120:123], a[184:187], v[140:143]
ds_read_b64_tr_b16 a[52:53], v14 offset:16384
ds_read_b64_tr_b16 a[54:55], v14 offset:18432
M v[144:147], a[128:131], a[184:187], v[144:147]
M v[144:147], a[132:135], a[188:191], v[144:147]
M v[148:151], a[140:143], a[188:191], v[148:151]
buffer_load_dwordx4 v5, s[8:11], s3 offen offset:3072 lds
M v[148:151], a[136:139], a[184:187], v[148:151]
M v[152:155], a[144:147], a[184:187], v[152:155]
M v[152:155], a[148:151], a[188:191], v[152:155]
ds_read_b64_tr_b16 a[60:61], v15 offset:16384
ds_read_b64_tr_b16 a[62:63], v15 offset:18432
M v[156:159], a[156:159], a[188:191], v[156:159]
M v[156:159], a[152:155], a[184:187], v[156:159]
s_waitcnt lgkmcnt(10)
M v[160:163], a[96:99], a[160:163], v[160:163]
M v[160:163], a[100:103], a[164:167], v[160:163]
ds_read_b128 a[176:179], v10 offset:53248
ds_read_b128 a[180:183], v11 offset:53248
M v[164:167], a[108:111], a[164:167], v[164:167]
s_add_u32 s23, s23, 128
s_cmp_eq_u32 s23, s25
s_cselect_b32 s23, s26, s23
M v[164:167], a[104:107], a[160:163], v[164:167]
ds_read_b64_tr_b16 a[68:69], v16 offset:16384
ds_read_b64_tr_b16 a[70:71], v16 offset:18432
M v[168:171], a[112:115], a[160:163], v[168:171]
M v[168:171], a[116:119], a[164:167], v[168:171]
M v[172:175], a[124:127], a[164:167], v[172:175]
M v[172:175], a[120:123], a[160:163], v[172:175]
M v[176:179], a[128:131], a[160:163], v[176:179]
s_add_u32 m0, s29, 114688
s_nop 0
buffer_load_dwordx4 v6, s[12:15], s24 offen offset:0 lds
M v[176:179], a[132:135], a[164:167], v[176:179]
ds_read_b64_tr_b16 a[76:77], v17 offset:16384
ds_read_b64_tr_b16 a[78:79], v17 offset:18432
M v[180:183], a[140:143], a[164:167], v[180:183]
M v[180:183], a[136:139], a[160:163], v[180:183]
M v[184:187], a[144:147], a[160:163], v[184:187]
M v[184:187], a[148:151], a[164:167], v[184:187]
buffer_load_dwordx4 v7, s[12:15], s24 offen offset:1024 lds
M v[188:191], a[156:159], a[164:167], v[188:191]
M v[188:191], a[152:155], a[160:163], v[188:191]
s_waitcnt lgkmcnt(12)
ds_read_b64_tr_b16 a[84:85], v18 offset:16384
ds_read_b64_tr_b16 a[86:87], v18 offset:18432
M v[192:195], a[96:99], a[168:171], v[192:195]
M v[192:195], a[100:103], a[172:175], v[192:195]
ds_read_b128 a[184:187], v10 offset:55296
ds_read_b128 a[188:191], v11 offset:55296
M v[196:199], a[108:111], a[172:175], v[196:199]
M v[196:199], a[104:107], a[168:171], v[196:199]
M v[200:203], a[112:115], a[168:171], v[200:203]
buffer_load_dwordx4 v8, s[12:15], s24 offen offset:2048 lds
M v[200:203], a[116:119], a[172:175], v[200:203]
ds_read_b64_tr_b16 a[92:93], v19 offset:16384
ds_read_b64_tr_b16 a[94:95], v19 offset:18432
M v[204:207], a[124:127], a[172:175], v[204:207]
M v[204:207], a[120:123], a[168:171], v[204:207]
M v[208:211], a[128:131], a[168:171], v[208:211]
M v[208:211], a[132:135], a[172:175], v[208:211]
M v[212:215], a[140:143], a[172:175], v[212:215]
buffer_load_dwordx4 v9, s[12:15], s24 offen offset:3072 lds
M v[212:215], a[136:139], a[168:171], v[212:215]
M v[216:219], a[144:147], a[168:171], v[216:219]
M v[216:219], a[148:151], a[172:175], v[216:219]
M v[220:223], a[156:159], a[172:175], v[220:223]
M v[220:223], a[152:155], a[168:171], v[220:223]
s_waitcnt lgkmcnt(10)
M v[224:227], a[96:99], a[176:179], v[224:227]
s_add_u32 s24, s24, 262144
s_cmp_eq_u32 s24, s27
s_cselect_b32 s24, s28, s24
s_sub_u32 s6, s6, 1
s_cmp_eq_u32 s6, 0
s_cselect_b64 s[12:13], s[64:65], s[12:13]
M v[224:227], a[100:103], a[180:183], v[224:227]
M v[228:231], a[108:111], a[180:183], v[228:231]
M v[228:231], a[104:107], a[176:179], v[228:231]
M v[232:235], a[112:115], a[176:179], v[232:235]
M v[232:235], a[116:119], a[180:183], v[232:235]
M v[236:239], a[124:127], a[180:183], v[236:239]
M v[236:239], a[120:123], a[176:179], v[236:239]
s_waitcnt vmcnt(8) lgkmcnt(0)
s_barrier
ds_read_b128 a[160:163], v10 offset:0
ds_read_b128 a[164:167], v11 offset:0
M v[240:243], a[128:131], a[176:179], v[240:243]
s_add_u32 m0, s29, 32768
s_nop 0
buffer_load_dwordx4 v2, s[8:11], s23 offen offset:0 lds
M v[240:243], a[132:135], a[180:183], v[240:243]
M v[244:247], a[140:143], a[180:183], v[244:247]
M v[244:247], a[136:139], a[176:179], v[244:247]
M v[248:251], a[144:147], a[176:179], v[248:251]
M v[248:251], a[148:151], a[180:183], v[248:251]
buffer_load_dwordx4 v3, s[8:11], s23 offen offset:1024 lds
M v[252:255], a[156:159], a[180:183], v[252:255]
M v[252:255], a[152:155], a[176:179], v[252:255]
M a[0:3], a[96:99], a[184:187], a[0:3]
M a[0:3], a[100:103], a[188:191], a[0:3]
ds_read_b128 a[168:171], v10 offset:2048
ds_read_b128 a[172:175], v11 offset:2048
M a[4:7], a[108:111], a[188:191], a[4:7]
M a[4:7], a[104:107], a[184:187], a[4:7]
M a[8:11], a[112:115], a[184:187], a[8:11]
buffer_load_dwordx4 v4, s[8:11], s23 offen offset:2048 lds
M a[8:11], a[116:119], a[188:191], a[8:11]
M a[12:15], a[124:127], a[188:191], a[12:15]
M a[12:15], a[120:123], a[184:187], a[12:15]
M a[16:19], a[128:131], a[184:187], a[16:19]
M a[16:19], a[132:135], a[188:191], a[16:19]
buffer_load_dwordx4 v5, s[8:11], s23 offen offset:3072 lds
M a[20:23], a[140:143], a[188:191], a[20:23]
M a[20:23], a[136:139], a[184:187], a[20:23]
M a[24:27], a[144:147], a[184:187], a[24:27]
M a[24:27], a[148:151], a[188:191], a[24:27]
M a[28:31], a[156:159], a[188:191], a[28:31]
M a[28:31], a[152:155], a[184:187], a[28:31]
s_waitcnt lgkmcnt(2)
s_mov_b32 s30, 2
Lk1_kl:
M v[32:35], a[32:35], a[160:163], v[32:35]
s_add_u32 m0, s29, 65536
s_nop 0
buffer_load_dwordx4 v6, s[12:15], s24 offen offset:0 lds
M v[32:35], a[36:39], a[164:167], v[32:35]
ds_read_b128 a[176:179], v10 offset:4096
ds_read_b128 a[180:183], v11 offset:4096
M v[36:39], a[44:47], a[164:167], v[36:39]
M v[36:39], a[40:43], a[160:163], v[36:39]
ds_read_b64_tr_b16 a[96:97], v12 offset:32768
ds_read_b64_tr_b16 a[98:99], v12 offset:34816
M v[40:43], a[48:51], a[160:163], v[40:43]
M v[40:43], a[52:55], a[164:167], v[40:43]
M v[44:47], a[60:63], a[164:167], v[44:47]
M v[44:47], a[56:59], a[160:163], v[44:47]
ds_read_b64_tr_b16 a[104:105], v13 offset:32768
ds_read_b64_tr_b16 a[106:107], v13 offset:34816
M v[48:51], a[64:67], a[160:163], v[48:51]
buffer_load_dwordx4 v7, s[12:15], s24 offen offset:1024 lds
M v[48:51], a[68:71], a[164:167], v[48:51]
M v[52:55], a[76:79], a[164:167], v[52:55]
M v[52:55], a[72:75], a[160:163], v[52:55]
ds_read_b64_tr_b16 a[112:113], v14 offset:32768
ds_read_b64_tr_b16 a[114:115], v14 offset:34816
M v[56:59], a[80:83], a[160:163], v[56:59]
M v[56:59], a[84:87], a[164:167], v[56:59]
M v[60:63], a[92:95], a[164:167], v[60:63]
buffer_load_dwordx4 v8, s[12:15], s24 offen offset:2048 lds
M v[60:63], a[88:91], a[160:163], v[60:63]
s_waitcnt lgkmcnt(8)
ds_read_b64_tr_b16 a[120:121], v15 offset:32768
ds_read_b64_tr_b16 a[122:123], v15 offset:34816
M v[64:67], a[32:35], a[168:171], v[64:67]
M v[64:67], a[36:39], a[172:175], v[64:67]
ds_read_b128 a[184:187], v10 offset:6144
ds_read_b128 a[188:191], v11 offset:6144
M v[68:71], a[44:47], a[172:175], v[68:71]
M v[68:71], a[40:43], a[168:171], v[68:71]
ds_read_b64_tr_b16 a[128:129], v16 offset:32768
ds_read_b64_tr_b16 a[130:131], v16 offset:34816
M v[72:75], a[48:51], a[168:171], v[72:75]
M v[72:75], a[52:55], a[172:175], v[72:75]
M v[76:79], a[60:63], a[172:175], v[76:79]
M v[76:79], a[56:59], a[168:171], v[76:79]
ds_read_b64_tr_b16 a[136:137], v17 offset:32768
ds_read_b64_tr_b16 a[138:139], v17 offset:34816
M v[80:83], a[64:67], a[168:171], v[80:83]
buffer_load_dwordx4 v9, s[12:15], s24 offen offset:3072 lds
M v[80:83], a[68:71], a[172:175], v[80:83]
M v[84:87], a[76:79], a[172:175], v[84:87]
M v[84:87], a[72:75], a[168:171], v[84:87]
ds_read_b64_tr_b16 a[144:145], v18 offset:32768
ds_read_b64_tr_b16 a[146:147], v18 offset:34816
M v[88:91], a[80:83], a[168:171], v[88:91]
M v[88:91], a[84:87], a[172:175], v[88:91]
M v[92:95], a[92:95], a[172:175], v[92:95]
s_add_u32 s24, s24, 262144
M v[92:95], a[88:91], a[168:171], v[92:95]
s_waitcnt lgkmcnt(15)
ds_read_b64_tr_b16 a[152:153], v19 offset:32768
ds_read_b64_tr_b16 a[154:155], v19 offset:34816
M v[96:99], a[32:35], a[176:179], v[96:99]
M v[96:99], a[36:39], a[180:183], v[96:99]
M v[100:103], a[44:47], a[180:183], v[100:103]
M v[100:103], a[40:43], a[176:179], v[100:103]
M v[104:107], a[48:51], a[176:179], v[104:107]
M v[104:107], a[52:55], a[180:183], v[104:107]
M v[108:111], a[60:63], a[180:183], v[108:111]
M v[108:111], a[56:59], a[176:179], v[108:111]
s_waitcnt vmcnt(8) lgkmcnt(0)
s_barrier
ds_read_b128 a[160:163], v10 offset:16384
ds_read_b128 a[164:167], v11 offset:16384
M v[112:115], a[64:67], a[176:179], v[112:115]
s_add_u32 m0, s29, 49152
s_add_u32 s3, s23, s31
buffer_load_dwordx4 v2, s[8:11], s3 offen offset:0 lds
M v[112:115], a[68:71], a[180:183], v[112:115]
M v[116:119], a[76:79], a[180:183], v[116:119]
M v[116:119], a[72:75], a[176:179], v[116:119]
ds_read_b64_tr_b16 a[100:101], v12 offset:49152
ds_read_b64_tr_b16 a[102:103], v12 offset:51200
M v[120:123], a[80:83], a[176:179], v[120:123]
M v[120:123], a[84:87], a[180:183], v[120:123]
buffer_load_dwordx4 v3, s[8:11], s3 offen offset:1024 lds
M v[124:127], a[92:95], a[180:183], v[124:127]
M v[124:127], a[88:91], a[176:179], v[124:127]
M v[128:131], a[32:35], a[184:187], v[128:131]
M v[128:131], a[36:39], a[188:191], v[128:131]
ds_read_b128 a[168:171], v10 offset:18432
ds_read_b128 a[172:175], v11 offset:18432
ds_read_b64_tr_b16 a[108:109], v13 offset:49152
ds_read_b64_tr_b16 a[110:111], v13 offset:51200
M v[132:135], a[44:47], a[188:191], v[132:135]
M v[132:135], a[40:43], a[184:187], v[132:135]
M v[136:139], a[48:51], a[184:187], v[136:139]
buffer_load_dwordx4 v4, s[8:11], s3 offen offset:2048 lds
M v[136:139], a[52:55], a[188:191], v[136:139]
M v[140:143], a[60:63], a[188:191], v[140:143]
M v[140:143], a[56:59], a[184:187], v[140:143]
ds_read_b64_tr_b16 a[116:117], v14 offset:49152
ds_read_b64_tr_b16 a[118:119], v14 offset:51200
M v[144:147], a[64:67], a[184:187], v[144:147]
M v[144:147], a[68:71], a[188:191], v[144:147]
M v[148:151], a[76:79], a[188:191], v[148:151]
buffer_load_dwordx4 v5, s[8:11], s3 offen offset:3072 lds
M v[148:151], a[72:75], a[184:187], v[148:151]
M v[152:155], a[80:83], a[184:187], v[152:155]
M v[152:155], a[84:87], a[188:191], v[152:155]
ds_read_b64_tr_b16 a[124:125], v15 offset:49152
ds_read_b64_tr_b16 a[126:127], v15 offset:51200
M v[156:159], a[92:95], a[188:191], v[156:159]
M v[156:159], a[88:91], a[184:187], v[156:159]
s_waitcnt lgkmcnt(10)
M v[160:163], a[32:35], a[160:163], v[160:163]
M v[160:163], a[36:39], a[164:167], v[160:163]
ds_read_b128 a[176:179], v10 offset:20480
ds_read_b128 a[180:183], v11 offset:20480
M v[164:167], a[44:47], a[164:167], v[164:167]
s_add_u32 s23, s23, 128
s_cmp_eq_u32 s23, s25
s_cselect_b32 s23, s26, s23
M v[164:167], a[40:43], a[160:163], v[164:167]
ds_read_b64_tr_b16 a[132:133], v16 offset:49152
ds_read_b64_tr_b16 a[134:135], v16 offset:51200
M v[168:171], a[48:51], a[160:163], v[168:171]
M v[168:171], a[52:55], a[164:167], v[168:171]
M v[172:175], a[60:63], a[164:167], v[172:175]
M v[172:175], a[56:59], a[160:163], v[172:175]
M v[176:179], a[64:67], a[160:163], v[176:179]
s_add_u32 m0, s29, 81920
s_nop 0
buffer_load_dwordx4 v6, s[12:15], s24 offen offset:0 lds
M v[176:179], a[68:71], a[164:167], v[176:179]
ds_read_b64_tr_b16 a[140:141], v17 offset:49152
ds_read_b64_tr_b16 a[142:143], v17 offset:51200
M v[180:183], a[76:79], a[164:167], v[180:183]
M v[180:183], a[72:75], a[160:163], v[180:183]
M v[184:187], a[80:83], a[160:163], v[184:187]
M v[184:187], a[84:87], a[164:167], v[184:187]
buffer_load_dwordx4 v7, s[12:15], s24 offen offset:1024 lds
M v[188:191], a[92:95], a[164:167], v[188:191]
M v[188:191], a[88:91], a[160:163], v[188:191]
s_waitcnt lgkmcnt(12)
ds_read_b64_tr_b16 a[148:149], v18 offset:49152
ds_read_b64_tr_b16 a[150:151], v18 offset:51200
M v[192:195], a[32:35], a[168:171], v[192:195]
M v[192:195], a[36:39], a[172:175], v[192:195]
ds_read_b128 a[184:187], v10 offset:22528
ds_read_b128 a[188:191], v11 offset:22528
M v[196:199], a[44:47], a[172:175], v[196:199]
M v[196:199], a[40:43], a[168:171], v[196:199]
M v[200:203], a[48:51], a[168:171], v[200:203]
buffer_load_dwordx4 v8, s[12:15], s24 offen offset:2048 lds
M v[200:203], a[52:55], a[172:175], v[200:203]
ds_read_b64_tr_b16 a[156:157], v19 offset:49152
ds_read_b64_tr_b16 a[158:159], v19 offset:51200
M v[204:207], a[60:63], a[172:175], v[204:207]
M v[204:207], a[56:59], a[168:171], v[204:207]
M v[208:211], a[64:67], a[168:171], v[208:211]
M v[208:211], a[68:71], a[172:175], v[208:211]
M v[212:215], a[76:79], a[172:175], v[212:215]
buffer_load_dwordx4 v9, s[12:15], s24 offen offset:3072 lds
M v[212:215], a[72:75], a[168:171], v[212:215]
M v[216:219], a[80:83], a[168:171], v[216:219]
M v[216:219], a[84:87], a[172:175], v[216:219]
M v[220:223], a[92:95], a[172:175], v[220:223]
M v[220:223], a[88:91], a[168:171], v[220:223]
s_waitcnt lgkmcnt(10)
M v[224:227], a[32:35], a[176:179], v[224:227]
s_add_u32 s24, s24, 262144
s_cmp_eq_u32 s24, s27
s_cselect_b32 s24, s28, s24
s_sub_u32 s6, s6, 1
s_cmp_eq_u32 s6, 0
s_cselect_b64 s[12:13], s[64:65], s[12:13]
M v[224:227], a[36:39], a[180:183], v[224:227]
M v[228:231], a[44:47], a[180:183], v[228:231]
M v[228:231], a[40:43], a[176:179], v[228:231]
M v[232:235], a[48:51], a[176:179], v[232:235]
M v[232:235], a[52:55], a[180:183], v[232:235]
M v[236:239], a[60:63], a[180:183], v[236:239]
M v[236:239], a[56:59], a[176:179], v[236:239]
s_waitcnt vmcnt(8) lgkmcnt(0)
s_barrier
ds_read_b128 a[160:163], v10 offset:32768
ds_read_b128 a[164:167], v11 offset:32768
M v[240:243], a[64:67], a[176:179], v[240:243]
s_add_u32 m0, s29, 0
s_nop 0
buffer_load_dwordx4 v2, s[8:11], s23 offen offset:0 lds
M v[240:243], a[68:71], a[180:183], v[240:243]
M v[244:247], a[76:79], a[180:183], v[244:247]
M v[244:247], a[72:75], a[176:179], v[244:247]
M v[248:251], a[80:83], a[176:179], v[248:251]
M v[248:251], a[84:87], a[180:183], v[248:251]
buffer_load_dwordx4 v3, s[8:11], s23 offen offset:1024 lds
M v[252:255], a[92:95], a[180:183], v[252:255]
M v[252:255], a[88:91], a[176:179], v[252:255]
M a[0:3], a[32:35], a[184:187], a[0:3]
M a[0:3], a[36:39], a[188:191], a[0:3]
ds_read_b128 a[168:171], v10 offset:34816
ds_read_b128 a[172:175], v11 offset:34816
M a[4:7], a[44:47], a[188:191], a[4:7]
M a[4:7], a[40:43], a[184:187], a[4:7]
M a[8:11], a[48:51], a[184:187], a[8:11]
buffer_load_dwordx4 v4, s[8:11], s23 offen offset:2048 lds
M a[8:11], a[52:55], a[188:191], a[8:11]
M a[12:15], a[60:63], a[188:191], a[12:15]
M a[12:15], a[56:59], a[184:187], a[12:15]
M a[16:19], a[64:67], a[184:187], a[16:19]
M a[16:19], a[68:71], a[188:191], a[16:19]
buffer_load_dwordx4 v5, s[8:11], s23 offen offset:3072 lds
M a[20:23], a[76:79], a[188:191], a[20:23]
M a[20:23], a[72:75], a[184:187], a[20:23]
M a[24:27], a[80:83], a[184:187], a[24:27]
M a[24:27], a[84:87], a[188:191], a[24:27]
M a[28:31], a[92:95], a[188:191], a[28:31]
M a[28:31], a[88:91], a[184:187], a[28:31]
s_waitcnt lgkmcnt(2)
M v[32:35], a[96:99], a[160:163], v[32:35]
s_add_u32 m0, s29, 98304
s_nop 0
buffer_load_dwordx4 v6, s[12:15], s24 offen offset:0 lds
M v[32:35], a[100:103], a[164:167], v[32:35]
ds_read_b128 a[176:179], v10 offset:36864
ds_read_b128 a[180:183], v11 offset:36864
M v[36:39], a[108:111], a[164:167], v[36:39]
M v[36:39], a[104:107], a[160:163], v[36:39]
ds_read_b64_tr_b16 a[32:33], v12 offset:0
ds_read_b64_tr_b16 a[34:35], v12 offset:2048
M v[40:43], a[112:115], a[160:163], v[40:43]
M v[40:43], a[116:119], a[164:167], v[40:43]
M v[44:47], a[124:127], a[164:167], v[44:47]
M v[44:47], a[120:123], a[160:163], v[44:47]
ds_read_b64_tr_b16 a[40:41], v13 offset:0
ds_read_b64_tr_b16 a[42:43], v13 offset:2048
M v[48:51], a[128:131], a[160:163], v[48:51]
buffer_load_dwordx4 v7, s[12:15], s24 offen offset:1024 lds
M v[48:51], a[132:135], a[164:167], v[48:51]
M v[52:55], a[140:143], a[164:167], v[52:55]
M v[52:55], a[136:139], a[160:163], v[52:55]
ds_read_b64_tr_b16 a[48:49], v14 offset:0
ds_read_b64_tr_b16 a[50:51], v14 offset:2048
M v[56:59], a[144:147], a[160:163], v[56:59]
M v[56:59], a[148:151], a[164:167], v[56:59]
M v[60:63], a[156:159], a[164:167], v[60:63]
buffer_load_dwordx4 v8, s[12:15], s24 offen offset:2048 lds
M v[60:63], a[152:155], a[160:163], v[60:63]
s_waitcnt lgkmcnt(8)
ds_read_b64_tr_b16 a[56:57], v15 offset:0
ds_read_b64_tr_b16 a[58:59], v15 offset:2048
M v[64:67], a[96:99], a[168:171], v[64:67]
M v[64:67], a[100:103], a[172:175], v[64:67]
ds_read_b128 a[184:187], v10 offset:38912
ds_read_b128 a[188:191], v11 offset:38912
M v[68:71], a[108:111], a[172:175], v[68:71]
M v[68:71], a[104:107], a[168:171], v[68:71]
ds_read_b64_tr_b16 a[64:65], v16 offset:0
ds_read_b64_tr_b16 a[66:67], v16 offset:2048
M v[72:75], a[112:115], a[168:171], v[72:75]
M v[72:75], a[116:119], a[172:175], v[72:75]
M v[76:79], a[124:127], a[172:175], v[76:79]
M v[76:79], a[120:123], a[168:171], v[76:79]
ds_read_b64_tr_b16 a[72:73], v17 offset:0
ds_read_b64_tr_b16 a[74:75], v17 offset:2048
M v[80:83], a[128:131], a[168:171], v[80:83]
buffer_load_dwordx4 v9, s[12:15], s24 offen offset:3072 lds
M v[80:83], a[132:135], a[172:175], v[80:83]
M v[84:87], a[140:143], a[172:175], v[84:87]
M v[84:87], a[136:139], a[168:171], v[84:87]
ds_read_b64_tr_b16 a[80:81], v18 offset:0
ds_read_b64_tr_b16 a[82:83], v18 offset:2048
M v[88:91], a[144:147], a[168:171], v[88:91]
M v[88:91], a[148:151], a[172:175], v[88:91]
M v[92:95], a[156:159], a[172:175], v[92:95]
s_add_u32 s24, s24, 262144
M v[92:95], a[152:155], a[168:171], v[92:95]
s_waitcnt lgkmcnt(15)
ds_read_b64_tr_b16 a[88:89], v19 offset:0
ds_read_b64_tr_b16 a[90:91], v19 offset:2048
M v[96:99], a[96:99], a[176:179], v[96:99]
M v[96:99], a[100:103], a[180:183], v[96:99]
M v[100:103], a[108:111], a[180:183], v[100:103]
M v[100:103], a[104:107], a[176:179], v[100:103]
M v[104:107], a[112:115], a[176:179], v[104:107]
M v[104:107], a[116:119], a[180:183], v[104:107]
M v[108:111], a[124:127], a[180:183], v[108:111]
M v[108:111], a[120:123], a[176:179], v[108:111]
s_waitcnt vmcnt(8) lgkmcnt(0)
s_barrier
ds_read_b128 a[160:163], v10 offset:49152
ds_read_b128 a[164:167], v11 offset:49152
M v[112:115], a[128:131], a[176:179], v[112:115]
s_add_u32 m0, s29, 16384
s_add_u32 s3, s23, s31
buffer_load_dwordx4 v2, s[8:11], s3 offen offset:0 lds
M v[112:115], a[132:135], a[180:183], v[112:115]
M v[116:119], a[140:143], a[180:183], v[116:119]
M v[116:119], a[136:139], a[176:179], v[116:119]
ds_read_b64_tr_b16 a[36:37], v12 offset:16384
ds_read_b64_tr_b16 a[38:39], v12 offset:18432
M v[120:123], a[144:147], a[176:179], v[120:123]
M v[120:123], a[148:151], a[180:183], v[120:123]
buffer_load_dwordx4 v3, s[8:11], s3 offen offset:1024 lds
M v[124:127], a[156:159], a[180:183], v[124:127]
M v[124:127], a[152:155], a[176:179], v[124:127]
M v[128:131], a[96:99], a[184:187], v[128:131]
M v[128:131], a[100:103], a[188:191], v[128:131]
ds_read_b128 a[168:171], v10 offset:51200
ds_read_b128 a[172:175], v11 offset:51200
ds_read_b64_tr_b16 a[44:45], v13 offset:16384
ds_read_b64_tr_b16 a[46:47], v13 offset:18432
M v[132:135], a[108:111], a[188:191], v[132:135]
M v[132:135], a[104:107], a[184:187], v[132:135]
M v[136:139], a[112:115], a[184:187], v[136:139]
buffer_load_dwordx4 v4, s[8:11], s3 offen offset:2048 lds
M v[136:139], a[116:119], a[188:191], v[136:139]
M v[140:143], a[124:127], a[188:191], v[140:143]
M v[140:143], a[120:123], a[184:187], v[140:143]
ds_read_b64_tr_b16 a[52:53], v14 offset:16384
ds_read_b64_tr_b16 a[54:55], v14 offset:18432
M v[144:147], a[128:131], a[184:187], v[144:147]
M v[144:147], a[132:135], a[188:191], v[144:147]
M v[148:151], a[140:143], a[188:191], v[148:151]
buffer_load_dwordx4 v5, s[8:11], s3 offen offset:3072 lds
M v[148:151], a[136:139], a[184:187], v[148:151]
M v[152:155], a[144:147], a[184:187], v[152:155]
M v[152:155], a[148:151], a[188:191], v[152:155]
ds_read_b64_tr_b16 a[60:61], v15 offset:16384
ds_read_b64_tr_b16 a[62:63], v15 offset:18432
M v[156:159], a[156:159], a[188:191], v[156:159]
M v[156:159], a[152:155], a[184:187], v[156:159]
s_waitcnt lgkmcnt(10)
M v[160:163], a[96:99], a[160:163], v[160:163]
M v[160:163], a[100:103], a[164:167], v[160:163]
ds_read_b128 a[176:179], v10 offset:53248
ds_read_b128 a[180:183], v11 offset:53248
M v[164:167], a[108:111], a[164:167], v[164:167]
s_add_u32 s23, s23, 128
s_cmp_eq_u32 s23, s25
s_cselect_b32 s23, s26, s23
M v[164:167], a[104:107], a[160:163], v[164:167]
ds_read_b64_tr_b16 a[68:69], v16 offset:16384
ds_read_b64_tr_b16 a[70:71], v16 offset:18432
M v[168:171], a[112:115], a[160:163], v[168:171]
M v[168:171], a[116:119], a[164:167], v[168:171]
M v[172:175], a[124:127], a[164:167], v[172:175]
M v[172:175], a[120:123], a[160:163], v[172:175]
M v[176:179], a[128:131], a[160:163], v[176:179]
s_add_u32 m0, s29, 114688
s_nop 0
buffer_load_dwordx4 v6, s[12:15], s24 offen offset:0 lds
M v[176:179], a[132:135], a[164:167], v[176:179]
ds_read_b64_tr_b16 a[76:77], v17 offset:16384
ds_read_b64_tr_b16 a[78:79], v17 offset:18432
M v[180:183], a[140:143], a[164:167], v[180:183]
M v[180:183], a[136:139], a[160:163], v[180:183]
M v[184:187], a[144:147], a[160:163], v[184:187]
M v[184:187], a[148:151], a[164:167], v[184:187]
buffer_load_dwordx4 v7, s[12:15], s24 offen offset:1024 lds
M v[188:191], a[156:159], a[164:167], v[188:191]
M v[188:191], a[152:155], a[160:163], v[188:191]
s_waitcnt lgkmcnt(12)
ds_read_b64_tr_b16 a[84:85], v18 offset:16384
ds_read_b64_tr_b16 a[86:87], v18 offset:18432
M v[192:195], a[96:99], a[168:171], v[192:195]
M v[192:195], a[100:103], a[172:175], v[192:195]
ds_read_b128 a[184:187], v10 offset:55296
ds_read_b128 a[188:191], v11 offset:55296
M v[196:199], a[108:111], a[172:175], v[196:199]
M v[196:199], a[104:107], a[168:171], v[196:199]
M v[200:203], a[112:115], a[168:171], v[200:203]
buffer_load_dwordx4 v8, s[12:15], s24 offen offset:2048 lds
M v[200:203], a[116:119], a[172:175], v[200:203]
ds_read_b64_tr_b16 a[92:93], v19 offset:16384
ds_read_b64_tr_b16 a[94:95], v19 offset:18432
M v[204:207], a[124:127], a[172:175], v[204:207]
M v[204:207], a[120:123], a[168:171], v[204:207]
M v[208:211], a[128:131], a[168:171], v[208:211]
M v[208:211], a[132:135], a[172:175], v[208:211]
M v[212:215], a[140:143], a[172:175], v[212:215]
buffer_load_dwordx4 v9, s[12:15], s24 offen offset:3072 lds
M v[212:215], a[136:139], a[168:171], v[212:215]
M v[216:219], a[144:147], a[168:171], v[216:219]
M v[216:219], a[148:151], a[172:175], v[216:219]
M v[220:223], a[156:159], a[172:175], v[220:223]
M v[220:223], a[152:155], a[168:171], v[220:223]
s_waitcnt lgkmcnt(10)
M v[224:227], a[96:99], a[176:179], v[224:227]
s_add_u32 s24, s24, 262144
s_cmp_eq_u32 s24, s27
s_cselect_b32 s24, s28, s24
s_sub_u32 s6, s6, 1
s_cmp_eq_u32 s6, 0
s_cselect_b64 s[12:13], s[64:65], s[12:13]
M v[224:227], a[100:103], a[180:183], v[224:227]
M v[228:231], a[108:111], a[180:183], v[228:231]
M v[228:231], a[104:107], a[176:179], v[228:231]
M v[232:235], a[112:115], a[176:179], v[232:235]
M v[232:235], a[116:119], a[180:183], v[232:235]
M v[236:239], a[124:127], a[180:183], v[236:239]
M v[236:239], a[120:123], a[176:179], v[236:239]
s_waitcnt vmcnt(8) lgkmcnt(0)
s_barrier
ds_read_b128 a[160:163], v10 offset:0
ds_read_b128 a[164:167], v11 offset:0
M v[240:243], a[128:131], a[176:179], v[240:243]
s_add_u32 m0, s29, 32768
s_nop 0
buffer_load_dwordx4 v2, s[8:11], s23 offen offset:0 lds
M v[240:243], a[132:135], a[180:183], v[240:243]
M v[244:247], a[140:143], a[180:183], v[244:247]
M v[244:247], a[136:139], a[176:179], v[244:247]
M v[248:251], a[144:147], a[176:179], v[248:251]
M v[248:251], a[148:151], a[180:183], v[248:251]
buffer_load_dwordx4 v3, s[8:11], s23 offen offset:1024 lds
M v[252:255], a[156:159], a[180:183], v[252:255]
M v[252:255], a[152:155], a[176:179], v[252:255]
M a[0:3], a[96:99], a[184:187], a[0:3]
M a[0:3], a[100:103], a[188:191], a[0:3]
ds_read_b128 a[168:171], v10 offset:2048
ds_read_b128 a[172:175], v11 offset:2048
M a[4:7], a[108:111], a[188:191], a[4:7]
M a[4:7], a[104:107], a[184:187], a[4:7]
M a[8:11], a[112:115], a[184:187], a[8:11]
buffer_load_dwordx4 v4, s[8:11], s23 offen offset:2048 lds
M a[8:11], a[116:119], a[188:191], a[8:11]
M a[12:15], a[124:127], a[188:191], a[12:15]
M a[12:15], a[120:123], a[184:187], a[12:15]
M a[16:19], a[128:131], a[184:187], a[16:19]
M a[16:19], a[132:135], a[188:191], a[16:19]
buffer_load_dwordx4 v5, s[8:11], s23 offen offset:3072 lds
M a[20:23], a[140:143], a[188:191], a[20:23]
M a[20:23], a[136:139], a[184:187], a[20:23]
M a[24:27], a[144:147], a[184:187], a[24:27]
M a[24:27], a[148:151], a[188:191], a[24:27]
M a[28:31], a[156:159], a[188:191], a[28:31]
M a[28:31], a[152:155], a[184:187], a[28:31]
s_waitcnt lgkmcnt(2)
s_sub_u32 s30, s30, 1
s_cmp_lg_u32 s30, 0
s_cbranch_scc1 Lk1_kl
M v[32:35], a[32:35], a[160:163], v[32:35]
s_add_u32 m0, s29, 65536
s_nop 0
buffer_load_dwordx4 v6, s[12:15], s24 offen offset:0 lds
M v[32:35], a[36:39], a[164:167], v[32:35]
ds_read_b128 a[176:179], v10 offset:4096
ds_read_b128 a[180:183], v11 offset:4096
M v[36:39], a[44:47], a[164:167], v[36:39]
M v[36:39], a[40:43], a[160:163], v[36:39]
ds_read_b64_tr_b16 a[96:97], v12 offset:32768
ds_read_b64_tr_b16 a[98:99], v12 offset:34816
M v[40:43], a[48:51], a[160:163], v[40:43]
M v[40:43], a[52:55], a[164:167], v[40:43]
M v[44:47], a[60:63], a[164:167], v[44:47]
M v[44:47], a[56:59], a[160:163], v[44:47]
ds_read_b64_tr_b16 a[104:105], v13 offset:32768
ds_read_b64_tr_b16 a[106:107], v13 offset:34816
M v[48:51], a[64:67], a[160:163], v[48:51]
buffer_load_dwordx4 v7, s[12:15], s24 offen offset:1024 lds
M v[48:51], a[68:71], a[164:167], v[48:51]
M v[52:55], a[76:79], a[164:167], v[52:55]
M v[52:55], a[72:75], a[160:163], v[52:55]
ds_read_b64_tr_b16 a[112:113], v14 offset:32768
ds_read_b64_tr_b16 a[114:115], v14 offset:34816
M v[56:59], a[80:83], a[160:163], v[56:59]
M v[56:59], a[84:87], a[164:167], v[56:59]
M v[60:63], a[92:95], a[164:167], v[60:63]
buffer_load_dwordx4 v8, s[12:15], s24 offen offset:2048 lds
M v[60:63], a[88:91], a[160:163], v[60:63]
s_waitcnt lgkmcnt(8)
ds_read_b64_tr_b16 a[120:121], v15 offset:32768
ds_read_b64_tr_b16 a[122:123], v15 offset:34816
M v[64:67], a[32:35], a[168:171], v[64:67]
M v[64:67], a[36:39], a[172:175], v[64:67]
ds_read_b128 a[184:187], v10 offset:6144
ds_read_b128 a[188:191], v11 offset:6144
M v[68:71], a[44:47], a[172:175], v[68:71]
M v[68:71], a[40:43], a[168:171], v[68:71]
ds_read_b64_tr_b16 a[128:129], v16 offset:32768
ds_read_b64_tr_b16 a[130:131], v16 offset:34816
M v[72:75], a[48:51], a[168:171], v[72:75]
M v[72:75], a[52:55], a[172:175], v[72:75]
M v[76:79], a[60:63], a[172:175], v[76:79]
M v[76:79], a[56:59], a[168:171], v[76:79]
ds_read_b64_tr_b16 a[136:137], v17 offset:32768
ds_read_b64_tr_b16 a[138:139], v17 offset:34816
M v[80:83], a[64:67], a[168:171], v[80:83]
buffer_load_dwordx4 v9, s[12:15], s24 offen offset:3072 lds
M v[80:83], a[68:71], a[172:175], v[80:83]
M v[84:87], a[76:79], a[172:175], v[84:87]
M v[84:87], a[72:75], a[168:171], v[84:87]
ds_read_b64_tr_b16 a[144:145], v18 offset:32768
ds_read_b64_tr_b16 a[146:147], v18 offset:34816
M v[88:91], a[80:83], a[168:171], v[88:91]
M v[88:91], a[84:87], a[172:175], v[88:91]
M v[92:95], a[92:95], a[172:175], v[92:95]
s_add_u32 s24, s24, 262144
M v[92:95], a[88:91], a[168:171], v[92:95]
s_waitcnt lgkmcnt(15)
ds_read_b64_tr_b16 a[152:153], v19 offset:32768
ds_read_b64_tr_b16 a[154:155], v19 offset:34816
M v[96:99], a[32:35], a[176:179], v[96:99]
M v[96:99], a[36:39], a[180:183], v[96:99]
M v[100:103], a[44:47], a[180:183], v[100:103]
M v[100:103], a[40:43], a[176:179], v[100:103]
M v[104:107], a[48:51], a[176:179], v[104:107]
M v[104:107], a[52:55], a[180:183], v[104:107]
M v[108:111], a[60:63], a[180:183], v[108:111]
M v[108:111], a[56:59], a[176:179], v[108:111]
s_waitcnt vmcnt(8) lgkmcnt(0)
s_barrier
ds_read_b128 a[160:163], v10 offset:16384
ds_read_b128 a[164:167], v11 offset:16384
M v[112:115], a[64:67], a[176:179], v[112:115]
s_add_u32 m0, s29, 49152
s_add_u32 s3, s23, s31
buffer_load_dwordx4 v2, s[8:11], s3 offen offset:0 lds
M v[112:115], a[68:71], a[180:183], v[112:115]
M v[116:119], a[76:79], a[180:183], v[116:119]
M v[116:119], a[72:75], a[176:179], v[116:119]
ds_read_b64_tr_b16 a[100:101], v12 offset:49152
ds_read_b64_tr_b16 a[102:103], v12 offset:51200
M v[120:123], a[80:83], a[176:179], v[120:123]
M v[120:123], a[84:87], a[180:183], v[120:123]
buffer_load_dwordx4 v3, s[8:11], s3 offen offset:1024 lds
M v[124:127], a[92:95], a[180:183], v[124:127]
M v[124:127], a[88:91], a[176:179], v[124:127]
M v[128:131], a[32:35], a[184:187], v[128:131]
M v[128:131], a[36:39], a[188:191], v[128:131]
ds_read_b128 a[168:171], v10 offset:18432
ds_read_b128 a[172:175], v11 offset:18432
ds_read_b64_tr_b16 a[108:109], v13 offset:49152
ds_read_b64_tr_b16 a[110:111], v13 offset:51200
M v[132:135], a[44:47], a[188:191], v[132:135]
M v[132:135], a[40:43], a[184:187], v[132:135]
M v[136:139], a[48:51], a[184:187], v[136:139]
buffer_load_dwordx4 v4, s[8:11], s3 offen offset:2048 lds
M v[136:139], a[52:55], a[188:191], v[136:139]
M v[140:143], a[60:63], a[188:191], v[140:143]
M v[140:143], a[56:59], a[184:187], v[140:143]
ds_read_b64_tr_b16 a[116:117], v14 offset:49152
ds_read_b64_tr_b16 a[118:119], v14 offset:51200
M v[144:147], a[64:67], a[184:187], v[144:147]
M v[144:147], a[68:71], a[188:191], v[144:147]
M v[148:151], a[76:79], a[188:191], v[148:151]
buffer_load_dwordx4 v5, s[8:11], s3 offen offset:3072 lds
M v[148:151], a[72:75], a[184:187], v[148:151]
M v[152:155], a[80:83], a[184:187], v[152:155]
s_lshr_b32 s95, s53, 7
s_add_u32 s95, s95, s22
M v[152:155], a[84:87], a[188:191], v[152:155]
ds_read_b64_tr_b16 a[124:125], v15 offset:49152
ds_read_b64_tr_b16 a[126:127], v15 offset:51200
s_lshl_b32 s95, s95, 5
s_lshr_b32 s19, s52, 6
M v[156:159], a[92:95], a[188:191], v[156:159]
s_add_u32 s95, s95, s19
s_lshl_b32 s19, s21, 1
M v[156:159], a[88:91], a[184:187], v[156:159]
s_waitcnt lgkmcnt(10)
s_add_u32 s95, s95, s19
s_lshl_b32 s92, s95, 15
M v[160:163], a[32:35], a[160:163], v[160:163]
s_add_u32 s93, s92, 32768
s_add_u32 s16, s50, 16777216
M v[160:163], a[36:39], a[164:167], v[160:163]
ds_read_b128 a[176:179], v10 offset:20480
ds_read_b128 a[180:183], v11 offset:20480
s_addc_u32 s17, s51, 0
s_mov_b32 s18, 33554432
M v[164:167], a[44:47], a[164:167], v[164:167]
s_add_u32 s23, s23, 128
s_cmp_eq_u32 s23, s25
s_cselect_b32 s23, s26, s23
s_mov_b32 s19, 0x00020000
M v[164:167], a[40:43], a[160:163], v[164:167]
ds_read_b64_tr_b16 a[132:133], v16 offset:49152
ds_read_b64_tr_b16 a[134:135], v16 offset:51200
M v[168:171], a[48:51], a[160:163], v[168:171]
M v[168:171], a[52:55], a[164:167], v[168:171]
M v[172:175], a[60:63], a[164:167], v[172:175]
M v[172:175], a[56:59], a[160:163], v[172:175]
M v[176:179], a[64:67], a[160:163], v[176:179]
s_add_u32 m0, s29, 81920
s_nop 0
buffer_load_dwordx4 v6, s[12:15], s24 offen offset:0 lds
M v[176:179], a[68:71], a[164:167], v[176:179]
ds_read_b64_tr_b16 a[140:141], v17 offset:49152
ds_read_b64_tr_b16 a[142:143], v17 offset:51200
M v[180:183], a[76:79], a[164:167], v[180:183]
M v[180:183], a[72:75], a[160:163], v[180:183]
M v[184:187], a[80:83], a[160:163], v[184:187]
M v[184:187], a[84:87], a[164:167], v[184:187]
buffer_load_dwordx4 v7, s[12:15], s24 offen offset:1024 lds
M v[188:191], a[92:95], a[164:167], v[188:191]
M v[188:191], a[88:91], a[160:163], v[188:191]
s_waitcnt lgkmcnt(12)
ds_read_b64_tr_b16 a[148:149], v18 offset:49152
ds_read_b64_tr_b16 a[150:151], v18 offset:51200
M v[192:195], a[32:35], a[168:171], v[192:195]
M v[192:195], a[36:39], a[172:175], v[192:195]
ds_read_b128 a[184:187], v10 offset:22528
ds_read_b128 a[188:191], v11 offset:22528
M v[196:199], a[44:47], a[172:175], v[196:199]
M v[196:199], a[40:43], a[168:171], v[196:199]
M v[200:203], a[48:51], a[168:171], v[200:203]
buffer_load_dwordx4 v8, s[12:15], s24 offen offset:2048 lds
M v[200:203], a[52:55], a[172:175], v[200:203]
ds_read_b64_tr_b16 a[156:157], v19 offset:49152
ds_read_b64_tr_b16 a[158:159], v19 offset:51200
M v[204:207], a[60:63], a[172:175], v[204:207]
M v[204:207], a[56:59], a[168:171], v[204:207]
M v[208:211], a[64:67], a[168:171], v[208:211]
M v[208:211], a[68:71], a[172:175], v[208:211]
M v[212:215], a[76:79], a[172:175], v[212:215]
buffer_load_dwordx4 v9, s[12:15], s24 offen offset:3072 lds
M v[212:215], a[72:75], a[168:171], v[212:215]
M v[216:219], a[80:83], a[168:171], v[216:219]
M v[216:219], a[84:87], a[172:175], v[216:219]
M v[220:223], a[92:95], a[172:175], v[220:223]
M v[220:223], a[88:91], a[168:171], v[220:223]
s_waitcnt lgkmcnt(10)
M v[224:227], a[32:35], a[176:179], v[224:227]
s_add_u32 s24, s24, 262144
s_cmp_eq_u32 s24, s27
s_cselect_b32 s24, s28, s24
s_sub_u32 s6, s6, 1
s_cmp_eq_u32 s6, 0
s_cselect_b64 s[12:13], s[64:65], s[12:13]
M v[224:227], a[36:39], a[180:183], v[224:227]
M v[228:231], a[44:47], a[180:183], v[228:231]
M v[228:231], a[40:43], a[176:179], v[228:231]
M v[232:235], a[48:51], a[176:179], v[232:235]
M v[232:235], a[52:55], a[180:183], v[232:235]
M v[236:239], a[60:63], a[180:183], v[236:239]
M v[236:239], a[56:59], a[176:179], v[236:239]
s_waitcnt vmcnt(8) lgkmcnt(0)
s_barrier
ds_read_b128 a[160:163], v10 offset:32768
ds_read_b128 a[164:167], v11 offset:32768
M v[240:243], a[64:67], a[176:179], v[240:243]
s_add_u32 m0, s29, 0
s_nop 0
buffer_load_dwordx4 v2, s[8:11], s23 offen offset:0 lds
M v[240:243], a[68:71], a[180:183], v[240:243]
M v[244:247], a[76:79], a[180:183], v[244:247]
M v[244:247], a[72:75], a[176:179], v[244:247]
M v[248:251], a[80:83], a[176:179], v[248:251]
M v[248:251], a[84:87], a[180:183], v[248:251]
buffer_load_dwordx4 v3, s[8:11], s23 offen offset:1024 lds
M v[252:255], a[92:95], a[180:183], v[252:255]
M v[252:255], a[88:91], a[176:179], v[252:255]
M a[0:3], a[32:35], a[184:187], a[0:3]
M a[0:3], a[36:39], a[188:191], a[0:3]
ds_read_b128 a[168:171], v10 offset:34816
ds_read_b128 a[172:175], v11 offset:34816
M a[4:7], a[44:47], a[188:191], a[4:7]
M a[4:7], a[40:43], a[184:187], a[4:7]
M a[8:11], a[48:51], a[184:187], a[8:11]
buffer_load_dwordx4 v4, s[8:11], s23 offen offset:2048 lds
M a[8:11], a[52:55], a[188:191], a[8:11]
M a[12:15], a[60:63], a[188:191], a[12:15]
M a[12:15], a[56:59], a[184:187], a[12:15]
M a[16:19], a[64:67], a[184:187], a[16:19]
M a[16:19], a[68:71], a[188:191], a[16:19]
buffer_load_dwordx4 v5, s[8:11], s23 offen offset:3072 lds
M a[20:23], a[76:79], a[188:191], a[20:23]
M a[20:23], a[72:75], a[184:187], a[20:23]
M a[24:27], a[80:83], a[184:187], a[24:27]
M a[24:27], a[84:87], a[188:191], a[24:27]
M a[28:31], a[92:95], a[188:191], a[28:31]
M a[28:31], a[88:91], a[184:187], a[28:31]
s_waitcnt lgkmcnt(2)
M v[32:35], a[96:99], a[160:163], v[32:35]
s_add_u32 m0, s29, 98304
s_nop 0
buffer_load_dwordx4 v6, s[12:15], s24 offen offset:0 lds
M v[32:35], a[100:103], a[164:167], v[32:35]
ds_read_b128 a[176:179], v10 offset:36864
ds_read_b128 a[180:183], v11 offset:36864
M v[36:39], a[108:111], a[164:167], v[36:39]
M v[36:39], a[104:107], a[160:163], v[36:39]
ds_read_b64_tr_b16 a[32:33], v12 offset:0
ds_read_b64_tr_b16 a[34:35], v12 offset:2048
M v[40:43], a[112:115], a[160:163], v[40:43]
M v[40:43], a[116:119], a[164:167], v[40:43]
M v[44:47], a[124:127], a[164:167], v[44:47]
M v[44:47], a[120:123], a[160:163], v[44:47]
ds_read_b64_tr_b16 a[40:41], v13 offset:0
ds_read_b64_tr_b16 a[42:43], v13 offset:2048
M v[48:51], a[128:131], a[160:163], v[48:51]
buffer_load_dwordx4 v7, s[12:15], s24 offen offset:1024 lds
M v[48:51], a[132:135], a[164:167], v[48:51]
M v[52:55], a[140:143], a[164:167], v[52:55]
M v[52:55], a[136:139], a[160:163], v[52:55]
ds_read_b64_tr_b16 a[48:49], v14 offset:0
ds_read_b64_tr_b16 a[50:51], v14 offset:2048
M v[56:59], a[144:147], a[160:163], v[56:59]
M v[56:59], a[148:151], a[164:167], v[56:59]
M v[60:63], a[156:159], a[164:167], v[60:63]
buffer_load_dwordx4 v8, s[12:15], s24 offen offset:2048 lds
M v[60:63], a[152:155], a[160:163], v[60:63]
s_waitcnt lgkmcnt(8)
ds_read_b64_tr_b16 a[56:57], v15 offset:0
ds_read_b64_tr_b16 a[58:59], v15 offset:2048
M v[64:67], a[96:99], a[168:171], v[64:67]
M v[64:67], a[100:103], a[172:175], v[64:67]
ds_read_b128 a[184:187], v10 offset:38912
ds_read_b128 a[188:191], v11 offset:38912
M v[68:71], a[108:111], a[172:175], v[68:71]
M v[68:71], a[104:107], a[168:171], v[68:71]
ds_read_b64_tr_b16 a[64:65], v16 offset:0
ds_read_b64_tr_b16 a[66:67], v16 offset:2048
v_cvt_pk_bf16_f32 v32, v32, v33
v_cvt_pk_bf16_f32 v33, v34, v35
M v[72:75], a[112:115], a[168:171], v[72:75]
v_cvt_pk_bf16_f32 v34, v36, v37
v_cvt_pk_bf16_f32 v35, v38, v39
M v[72:75], a[116:119], a[172:175], v[72:75]
v_cvt_pk_bf16_f32 v40, v40, v41
v_cvt_pk_bf16_f32 v41, v42, v43
M v[76:79], a[124:127], a[172:175], v[76:79]
buffer_load_dwordx4 v9, s[12:15], s24 offen offset:3072 lds
v_cvt_pk_bf16_f32 v42, v44, v45
v_cvt_pk_bf16_f32 v43, v46, v47
M v[76:79], a[120:123], a[168:171], v[76:79]
ds_read_b64_tr_b16 a[72:73], v17 offset:0
ds_read_b64_tr_b16 a[74:75], v17 offset:2048
v_cvt_pk_bf16_f32 v48, v48, v49
v_cvt_pk_bf16_f32 v49, v50, v51
M v[80:83], a[128:131], a[168:171], v[80:83]
v_cvt_pk_bf16_f32 v50, v52, v53
v_cvt_pk_bf16_f32 v51, v54, v55
M v[80:83], a[132:135], a[172:175], v[80:83]
v_cvt_pk_bf16_f32 v56, v56, v57
v_cvt_pk_bf16_f32 v57, v58, v59
M v[84:87], a[140:143], a[172:175], v[84:87]
v_cvt_pk_bf16_f32 v58, v60, v61
v_cvt_pk_bf16_f32 v59, v62, v63
M v[84:87], a[136:139], a[168:171], v[84:87]
ds_read_b64_tr_b16 a[80:81], v18 offset:0
ds_read_b64_tr_b16 a[82:83], v18 offset:2048
M v[88:91], a[144:147], a[168:171], v[88:91]
M v[88:91], a[148:151], a[172:175], v[88:91]
s_add_u32 s24, s24, 262144
M v[92:95], a[156:159], a[172:175], v[92:95]
s_add_u32 s94, s92, 0
buffer_store_dwordx4 v[32:35], v1, s[16:19], s94 offen offset:0 sc1
M v[92:95], a[152:155], a[168:171], v[92:95]
s_waitcnt lgkmcnt(15)
ds_read_b64_tr_b16 a[88:89], v19 offset:0
ds_read_b64_tr_b16 a[90:91], v19 offset:2048
M v[96:99], a[96:99], a[176:179], v[96:99]
M v[96:99], a[100:103], a[180:183], v[96:99]
M v[100:103], a[108:111], a[180:183], v[100:103]
M v[100:103], a[104:107], a[176:179], v[100:103]
v_cvt_pk_bf16_f32 v64, v64, v65
v_cvt_pk_bf16_f32 v65, v66, v67
M v[104:107], a[112:115], a[176:179], v[104:107]
v_cvt_pk_bf16_f32 v66, v68, v69
v_cvt_pk_bf16_f32 v67, v70, v71
M v[104:107], a[116:119], a[180:183], v[104:107]
v_cvt_pk_bf16_f32 v72, v72, v73
v_cvt_pk_bf16_f32 v73, v74, v75
M v[108:111], a[124:127], a[180:183], v[108:111]
v_cvt_pk_bf16_f32 v74, v76, v77
v_cvt_pk_bf16_f32 v75, v78, v79
M v[108:111], a[120:123], a[176:179], v[108:111]
s_waitcnt vmcnt(9) lgkmcnt(0)
s_barrier
ds_read_b128 a[160:163], v10 offset:49152
ds_read_b128 a[164:167], v11 offset:49152
v_cvt_pk_bf16_f32 v80, v80, v81
v_cvt_pk_bf16_f32 v81, v82, v83
M v[112:115], a[128:131], a[176:179], v[112:115]
s_add_u32 s94, s92, 0
buffer_store_dwordx4 v[40:43], v1, s[16:19], s94 offen offset:1024 sc1
v_cvt_pk_bf16_f32 v82, v84, v85
v_cvt_pk_bf16_f32 v83, v86, v87
M v[112:115], a[132:135], a[180:183], v[112:115]
s_add_u32 m0, s29, 16384
s_add_u32 s3, s23, s31
buffer_load_dwordx4 v2, s[8:11], s3 offen offset:0 lds
v_cvt_pk_bf16_f32 v88, v88, v89
v_cvt_pk_bf16_f32 v89, v90, v91
M v[116:119], a[140:143], a[180:183], v[116:119]
v_cvt_pk_bf16_f32 v90, v92, v93
v_cvt_pk_bf16_f32 v91, v94, v95
M v[116:119], a[136:139], a[176:179], v[116:119]
ds_read_b64_tr_b16 a[36:37], v12 offset:16384
ds_read_b64_tr_b16 a[38:39], v12 offset:18432
M v[120:123], a[144:147], a[176:179], v[120:123]
M v[120:123], a[148:151], a[180:183], v[120:123]
M v[124:127], a[156:159], a[180:183], v[124:127]
buffer_load_dwordx4 v3, s[8:11], s3 offen offset:1024 lds
M v[124:127], a[152:155], a[176:179], v[124:127]
M v[128:131], a[96:99], a[184:187], v[128:131]
M v[128:131], a[100:103], a[188:191], v[128:131]
ds_read_b128 a[168:171], v10 offset:51200
ds_read_b128 a[172:175], v11 offset:51200
ds_read_b64_tr_b16 a[44:45], v13 offset:16384
ds_read_b64_tr_b16 a[46:47], v13 offset:18432
M v[132:135], a[108:111], a[188:191], v[132:135]
M v[132:135], a[104:107], a[184:187], v[132:135]
s_add_u32 s94, s92, 0
buffer_store_dwordx4 v[48:51], v1, s[16:19], s94 offen offset:2048 sc1
v_cvt_pk_bf16_f32 v96, v96, v97
v_cvt_pk_bf16_f32 v97, v98, v99
M v[136:139], a[112:115], a[184:187], v[136:139]
v_cvt_pk_bf16_f32 v98, v100, v101
v_cvt_pk_bf16_f32 v99, v102, v103
M v[136:139], a[116:119], a[188:191], v[136:139]
buffer_load_dwordx4 v4, s[8:11], s3 offen offset:2048 lds
v_cvt_pk_bf16_f32 v104, v104, v105
v_cvt_pk_bf16_f32 v105, v106, v107
M v[140:143], a[124:127], a[188:191], v[140:143]
v_cvt_pk_bf16_f32 v106, v108, v109
v_cvt_pk_bf16_f32 v107, v110, v111
M v[140:143], a[120:123], a[184:187], v[140:143]
ds_read_b64_tr_b16 a[52:53], v14 offset:16384
ds_read_b64_tr_b16 a[54:55], v14 offset:18432
v_cvt_pk_bf16_f32 v112, v112, v113
v_cvt_pk_bf16_f32 v113, v114, v115
M v[144:147], a[128:131], a[184:187], v[144:147]
v_cvt_pk_bf16_f32 v114, v116, v117
v_cvt_pk_bf16_f32 v115, v118, v119
M v[144:147], a[132:135], a[188:191], v[144:147]
v_cvt_pk_bf16_f32 v120, v120, v121
v_cvt_pk_bf16_f32 v121, v122, v123
M v[148:151], a[140:143], a[188:191], v[148:151]
buffer_load_dwordx4 v5, s[8:11], s3 offen offset:3072 lds
v_cvt_pk_bf16_f32 v122, v124, v125
v_cvt_pk_bf16_f32 v123, v126, v127
M v[148:151], a[136:139], a[184:187], v[148:151]
M v[152:155], a[144:147], a[184:187], v[152:155]
M v[152:155], a[148:151], a[188:191], v[152:155]
ds_read_b64_tr_b16 a[60:61], v15 offset:16384
ds_read_b64_tr_b16 a[62:63], v15 offset:18432
M v[156:159], a[156:159], a[188:191], v[156:159]
s_add_u32 s94, s92, 0
buffer_store_dwordx4 v[56:59], v1, s[16:19], s94 offen offset:3072 sc1
M v[156:159], a[152:155], a[184:187], v[156:159]
s_waitcnt lgkmcnt(10)
M v[160:163], a[96:99], a[160:163], v[160:163]
M v[160:163], a[100:103], a[164:167], v[160:163]
ds_read_b128 a[176:179], v10 offset:53248
ds_read_b128 a[180:183], v11 offset:53248
M v[164:167], a[108:111], a[164:167], v[164:167]
s_add_u32 s23, s23, 128
s_cmp_eq_u32 s23, s25
s_cselect_b32 s23, s26, s23
M v[164:167], a[104:107], a[160:163], v[164:167]
ds_read_b64_tr_b16 a[68:69], v16 offset:16384
ds_read_b64_tr_b16 a[70:71], v16 offset:18432
v_cvt_pk_bf16_f32 v128, v128, v129
v_cvt_pk_bf16_f32 v129, v130, v131
M v[168:171], a[112:115], a[160:163], v[168:171]
v_cvt_pk_bf16_f32 v130, v132, v133
v_cvt_pk_bf16_f32 v131, v134, v135
M v[168:171], a[116:119], a[164:167], v[168:171]
v_cvt_pk_bf16_f32 v136, v136, v137
v_cvt_pk_bf16_f32 v137, v138, v139
M v[172:175], a[124:127], a[164:167], v[172:175]
v_cvt_pk_bf16_f32 v138, v140, v141
v_cvt_pk_bf16_f32 v139, v142, v143
M v[172:175], a[120:123], a[160:163], v[172:175]
v_cvt_pk_bf16_f32 v144, v144, v145
v_cvt_pk_bf16_f32 v145, v146, v147
M v[176:179], a[128:131], a[160:163], v[176:179]
s_add_u32 s94, s92, 4096
buffer_store_dwordx4 v[64:67], v1, s[16:19], s94 offen offset:0 sc1
v_cvt_pk_bf16_f32 v146, v148, v149
v_cvt_pk_bf16_f32 v147, v150, v151
M v[176:179], a[132:135], a[164:167], v[176:179]
ds_read_b64_tr_b16 a[76:77], v17 offset:16384
ds_read_b64_tr_b16 a[78:79], v17 offset:18432
v_cvt_pk_bf16_f32 v152, v152, v153
v_cvt_pk_bf16_f32 v153, v154, v155
M v[180:183], a[140:143], a[164:167], v[180:183]
s_add_u32 m0, s29, 114688
s_nop 0
buffer_load_dwordx4 v6, s[12:15], s24 offen offset:0 lds
v_cvt_pk_bf16_f32 v154, v156, v157
v_cvt_pk_bf16_f32 v155, v158, v159
M v[180:183], a[136:139], a[160:163], v[180:183]
M v[184:187], a[144:147], a[160:163], v[184:187]
v_accvgpr_write_b32 a192, v128
v_accvgpr_write_b32 a193, v129
v_accvgpr_write_b32 a194, v130
v_accvgpr_write_b32 a195, v131
M v[184:187], a[148:151], a[164:167], v[184:187]
v_accvgpr_write_b32 a196, v136
v_accvgpr_write_b32 a197, v137
v_accvgpr_write_b32 a198, v138
v_accvgpr_write_b32 a199, v139
M v[188:191], a[156:159], a[164:167], v[188:191]
buffer_load_dwordx4 v7, s[12:15], s24 offen offset:1024 lds
v_accvgpr_write_b32 a200, v144
v_accvgpr_write_b32 a201, v145
v_accvgpr_write_b32 a202, v146
v_accvgpr_write_b32 a203, v147
M v[188:191], a[152:155], a[160:163], v[188:191]
s_waitcnt lgkmcnt(12)
ds_read_b64_tr_b16 a[84:85], v18 offset:16384
ds_read_b64_tr_b16 a[86:87], v18 offset:18432
v_accvgpr_write_b32 a204, v152
v_accvgpr_write_b32 a205, v153
v_accvgpr_write_b32 a206, v154
v_accvgpr_write_b32 a207, v155
M v[192:195], a[96:99], a[168:171], v[192:195]
M v[192:195], a[100:103], a[172:175], v[192:195]
ds_read_b128 a[184:187], v10 offset:55296
ds_read_b128 a[188:191], v11 offset:55296
M v[196:199], a[108:111], a[172:175], v[196:199]
s_add_u32 s94, s92, 4096
buffer_store_dwordx4 v[72:75], v1, s[16:19], s94 offen offset:1024 sc1
M v[196:199], a[104:107], a[168:171], v[196:199]
v_cvt_pk_bf16_f32 v160, v160, v161
v_cvt_pk_bf16_f32 v161, v162, v163
M v[200:203], a[112:115], a[168:171], v[200:203]
v_cvt_pk_bf16_f32 v162, v164, v165
v_cvt_pk_bf16_f32 v163, v166, v167
M v[200:203], a[116:119], a[172:175], v[200:203]
ds_read_b64_tr_b16 a[92:93], v19 offset:16384
ds_read_b64_tr_b16 a[94:95], v19 offset:18432
v_cvt_pk_bf16_f32 v168, v168, v169
v_cvt_pk_bf16_f32 v169, v170, v171
M v[204:207], a[124:127], a[172:175], v[204:207]
buffer_load_dwordx4 v8, s[12:15], s24 offen offset:2048 lds
v_cvt_pk_bf16_f32 v170, v172, v173
v_cvt_pk_bf16_f32 v171, v174, v175
M v[204:207], a[120:123], a[168:171], v[204:207]
v_cvt_pk_bf16_f32 v176, v176, v177
v_cvt_pk_bf16_f32 v177, v178, v179
M v[208:211], a[128:131], a[168:171], v[208:211]
v_cvt_pk_bf16_f32 v178, v180, v181
v_cvt_pk_bf16_f32 v179, v182, v183
M v[208:211], a[132:135], a[172:175], v[208:211]
v_cvt_pk_bf16_f32 v184, v184, v185
v_cvt_pk_bf16_f32 v185, v186, v187
M v[212:215], a[140:143], a[172:175], v[212:215]
buffer_load_dwordx4 v9, s[12:15], s24 offen offset:3072 lds
v_cvt_pk_bf16_f32 v186, v188, v189
v_cvt_pk_bf16_f32 v187, v190, v191
M v[212:215], a[136:139], a[168:171], v[212:215]
M v[216:219], a[144:147], a[168:171], v[216:219]
v_accvgpr_write_b32 a208, v160
v_accvgpr_write_b32 a209, v161
v_accvgpr_write_b32 a210, v162
v_accvgpr_write_b32 a211, v163
M v[216:219], a[148:151], a[172:175], v[216:219]
s_add_u32 s94, s92, 4096
buffer_store_dwordx4 v[80:83], v1, s[16:19], s94 offen offset:2048 sc1
v_accvgpr_write_b32 a212, v168
v_accvgpr_write_b32 a213, v169
v_accvgpr_write_b32 a214, v170
v_accvgpr_write_b32 a215, v171
M v[220:223], a[156:159], a[172:175], v[220:223]
v_accvgpr_write_b32 a216, v176
v_accvgpr_write_b32 a217, v177
v_accvgpr_write_b32 a218, v178
v_accvgpr_write_b32 a219, v179
M v[220:223], a[152:155], a[168:171], v[220:223]
s_waitcnt lgkmcnt(10)
v_accvgpr_write_b32 a220, v184
v_accvgpr_write_b32 a221, v185
v_accvgpr_write_b32 a222, v186
v_accvgpr_write_b32 a223, v187
M v[224:227], a[96:99], a[176:179], v[224:227]
s_add_u32 s24, s24, 262144
s_cmp_eq_u32 s24, s27
s_cselect_b32 s24, s28, s24
s_sub_u32 s6, s6, 1
s_cmp_eq_u32 s6, 0
s_cselect_b64 s[12:13], s[64:65], s[12:13]
M v[224:227], a[100:103], a[180:183], v[224:227]
M v[228:231], a[108:111], a[180:183], v[228:231]
M v[228:231], a[104:107], a[176:179], v[228:231]
v_cvt_pk_bf16_f32 v192, v192, v193
v_cvt_pk_bf16_f32 v193, v194, v195
M v[232:235], a[112:115], a[176:179], v[232:235]
v_cvt_pk_bf16_f32 v194, v196, v197
v_cvt_pk_bf16_f32 v195, v198, v199
M v[232:235], a[116:119], a[180:183], v[232:235]
v_cvt_pk_bf16_f32 v200, v200, v201
v_cvt_pk_bf16_f32 v201, v202, v203
M v[236:239], a[124:127], a[180:183], v[236:239]
v_cvt_pk_bf16_f32 v202, v204, v205
v_cvt_pk_bf16_f32 v203, v206, v207
M v[236:239], a[120:123], a[176:179], v[236:239]
s_waitcnt vmcnt(15) lgkmcnt(0)
s_barrier
ds_read_b128 a[160:163], v10 offset:0
ds_read_b128 a[164:167], v11 offset:0
v_cvt_pk_bf16_f32 v208, v208, v209
v_cvt_pk_bf16_f32 v209, v210, v211
M v[240:243], a[128:131], a[176:179], v[240:243]
s_add_u32 s94, s92, 4096
buffer_store_dwordx4 v[88:91], v1, s[16:19], s94 offen offset:3072 sc1
v_cvt_pk_bf16_f32 v210, v212, v213
v_cvt_pk_bf16_f32 v211, v214, v215
M v[240:243], a[132:135], a[180:183], v[240:243]
s_add_u32 m0, s29, 32768
s_nop 0
buffer_load_dwordx4 v2, s[8:11], s23 offen offset:0 lds
v_cvt_pk_bf16_f32 v216, v216, v217
v_cvt_pk_bf16_f32 v217, v218, v219
M v[244:247], a[140:143], a[180:183], v[244:247]
v_cvt_pk_bf16_f32 v218, v220, v221
v_cvt_pk_bf16_f32 v219, v222, v223
M v[244:247], a[136:139], a[176:179], v[244:247]
M v[248:251], a[144:147], a[176:179], v[248:251]
v_accvgpr_write_b32 a224, v192
v_accvgpr_write_b32 a225, v193
v_accvgpr_write_b32 a226, v194
v_accvgpr_write_b32 a227, v195
M v[248:251], a[148:151], a[180:183], v[248:251]
buffer_load_dwordx4 v3, s[8:11], s23 offen offset:1024 lds
v_accvgpr_write_b32 a228, v200
v_accvgpr_write_b32 a229, v201
v_accvgpr_write_b32 a230, v202
v_accvgpr_write_b32 a231, v203
M v[252:255], a[156:159], a[180:183], v[252:255]
v_accvgpr_write_b32 a232, v208
v_accvgpr_write_b32 a233, v209
v_accvgpr_write_b32 a234, v210
v_accvgpr_write_b32 a235, v211
M v[252:255], a[152:155], a[176:179], v[252:255]
v_accvgpr_write_b32 a236, v216
v_accvgpr_write_b32 a237, v217
v_accvgpr_write_b32 a238, v218
v_accvgpr_write_b32 a239, v219
M a[0:3], a[96:99], a[184:187], a[0:3]
M a[0:3], a[100:103], a[188:191], a[0:3]
ds_read_b128 a[168:171], v10 offset:2048
ds_read_b128 a[172:175], v11 offset:2048
M a[4:7], a[108:111], a[188:191], a[4:7]
s_add_u32 s94, s92, 8192
buffer_store_dwordx4 v[96:99], v1, s[16:19], s94 offen offset:0 sc1
M a[4:7], a[104:107], a[184:187], a[4:7]
v_cvt_pk_bf16_f32 v224, v224, v225
v_cvt_pk_bf16_f32 v225, v226, v227
M a[8:11], a[112:115], a[184:187], a[8:11]
v_cvt_pk_bf16_f32 v226, v228, v229
v_cvt_pk_bf16_f32 v227, v230, v231
M a[8:11], a[116:119], a[188:191], a[8:11]
buffer_load_dwordx4 v4, s[8:11], s23 offen offset:2048 lds
v_cvt_pk_bf16_f32 v232, v232, v233
v_cvt_pk_bf16_f32 v233, v234, v235
M a[12:15], a[124:127], a[188:191], a[12:15]
v_cvt_pk_bf16_f32 v234, v236, v237
v_cvt_pk_bf16_f32 v235, v238, v239
M a[12:15], a[120:123], a[184:187], a[12:15]
v_cvt_pk_bf16_f32 v240, v240, v241
v_cvt_pk_bf16_f32 v241, v242, v243
M a[16:19], a[128:131], a[184:187], a[16:19]
v_cvt_pk_bf16_f32 v242, v244, v245
v_cvt_pk_bf16_f32 v243, v246, v247
M a[16:19], a[132:135], a[188:191], a[16:19]
buffer_load_dwordx4 v5, s[8:11], s23 offen offset:3072 lds
v_cvt_pk_bf16_f32 v248, v248, v249
v_cvt_pk_bf16_f32 v249, v250, v251
M a[20:23], a[140:143], a[188:191], a[20:23]
v_cvt_pk_bf16_f32 v250, v252, v253
v_cvt_pk_bf16_f32 v251, v254, v255
M a[20:23], a[136:139], a[184:187], a[20:23]
M a[24:27], a[144:147], a[184:187], a[24:27]
s_add_u32 s94, s92, 8192
buffer_store_dwordx4 v[104:107], v1, s[16:19], s94 offen offset:1024 sc1
v_accvgpr_write_b32 a240, v224
v_accvgpr_write_b32 a241, v225
v_accvgpr_write_b32 a242, v226
v_accvgpr_write_b32 a243, v227
M a[24:27], a[148:151], a[188:191], a[24:27]
v_accvgpr_write_b32 a244, v232
v_accvgpr_write_b32 a245, v233
v_accvgpr_write_b32 a246, v234
v_accvgpr_write_b32 a247, v235
M a[28:31], a[156:159], a[188:191], a[28:31]
v_accvgpr_write_b32 a248, v240
v_accvgpr_write_b32 a249, v241
v_accvgpr_write_b32 a250, v242
v_accvgpr_write_b32 a251, v243
M a[28:31], a[152:155], a[184:187], a[28:31]
s_waitcnt lgkmcnt(2)
v_accvgpr_write_b32 a252, v248
v_accvgpr_write_b32 a253, v249
v_accvgpr_write_b32 a254, v250
v_accvgpr_write_b32 a255, v251
M v[32:35], a[160:163], a[32:35], 0
s_add_u32 m0, s29, 65536
s_nop 0
buffer_load_dwordx4 v6, s[12:15], s24 offen offset:0 lds
M v[32:35], a[164:167], a[36:39], v[32:35]
ds_read_b128 a[176:179], v10 offset:4096
ds_read_b128 a[180:183], v11 offset:4096
M v[36:39], a[164:167], a[44:47], 0
M v[36:39], a[160:163], a[40:43], v[36:39]
ds_read_b64_tr_b16 a[96:97], v12 offset:32768
ds_read_b64_tr_b16 a[98:99], v12 offset:34816
M v[40:43], a[160:163], a[48:51], 0
M v[40:43], a[164:167], a[52:55], v[40:43]
M v[44:47], a[164:167], a[60:63], 0
buffer_load_dwordx4 v7, s[12:15], s24 offen offset:1024 lds
M v[44:47], a[160:163], a[56:59], v[44:47]
ds_read_b64_tr_b16 a[104:105], v13 offset:32768
ds_read_b64_tr_b16 a[106:107], v13 offset:34816
M v[48:51], a[160:163], a[64:67], 0
s_add_u32 s94, s92, 8192
buffer_store_dwordx4 v[112:115], v1, s[16:19], s94 offen offset:2048 sc1
M v[48:51], a[164:167], a[68:71], v[48:51]
M v[52:55], a[164:167], a[76:79], 0
M v[52:55], a[160:163], a[72:75], v[52:55]
ds_read_b64_tr_b16 a[112:113], v14 offset:32768
ds_read_b64_tr_b16 a[114:115], v14 offset:34816
M v[56:59], a[160:163], a[80:83], 0
M v[56:59], a[164:167], a[84:87], v[56:59]
M v[60:63], a[164:167], a[92:95], 0
buffer_load_dwordx4 v8, s[12:15], s24 offen offset:2048 lds
M v[60:63], a[160:163], a[88:91], v[60:63]
s_waitcnt lgkmcnt(8)
ds_read_b64_tr_b16 a[120:121], v15 offset:32768
ds_read_b64_tr_b16 a[122:123], v15 offset:34816
M v[64:67], a[168:171], a[32:35], 0
M v[64:67], a[172:175], a[36:39], v[64:67]
ds_read_b128 a[184:187], v10 offset:6144
ds_read_b128 a[188:191], v11 offset:6144
M v[68:71], a[172:175], a[44:47], 0
s_add_u32 s94, s92, 8192
buffer_store_dwordx4 v[120:123], v1, s[16:19], s94 offen offset:3072 sc1
M v[68:71], a[168:171], a[40:43], v[68:71]
ds_read_b64_tr_b16 a[128:129], v16 offset:32768
ds_read_b64_tr_b16 a[130:131], v16 offset:34816
M v[72:75], a[168:171], a[48:51], 0
v_accvgpr_read_b32 v24, a0
v_accvgpr_read_b32 v25, a1
M v[72:75], a[172:175], a[52:55], v[72:75]
v_accvgpr_read_b32 v26, a2
v_accvgpr_read_b32 v27, a3
M v[76:79], a[172:175], a[60:63], 0
v_accvgpr_read_b32 v28, a4
v_accvgpr_read_b32 v29, a5
M v[76:79], a[168:171], a[56:59], v[76:79]
ds_read_b64_tr_b16 a[136:137], v17 offset:32768
ds_read_b64_tr_b16 a[138:139], v17 offset:34816
v_accvgpr_read_b32 v30, a6
v_accvgpr_read_b32 v31, a7
M v[80:83], a[168:171], a[64:67], 0
buffer_load_dwordx4 v9, s[12:15], s24 offen offset:3072 lds
v_cvt_pk_bf16_f32 v24, v24, v25
v_cvt_pk_bf16_f32 v25, v26, v27
M v[80:83], a[172:175], a[68:71], v[80:83]
v_cvt_pk_bf16_f32 v26, v28, v29
v_cvt_pk_bf16_f32 v27, v30, v31
M v[84:87], a[172:175], a[76:79], 0
M v[84:87], a[168:171], a[72:75], v[84:87]
ds_read_b64_tr_b16 a[144:145], v18 offset:32768
ds_read_b64_tr_b16 a[146:147], v18 offset:34816
M v[88:91], a[168:171], a[80:83], 0
M v[88:91], a[172:175], a[84:87], v[88:91]
s_add_u32 s94, s93, 12288
buffer_store_dwordx4 v[24:27], v1, s[16:19], s94 offen offset:0 sc1
M v[92:95], a[172:175], a[92:95], 0
M v[92:95], a[168:171], a[88:91], v[92:95]
s_waitcnt lgkmcnt(15)
ds_read_b64_tr_b16 a[152:153], v19 offset:32768
ds_read_b64_tr_b16 a[154:155], v19 offset:34816
M v[96:99], a[176:179], a[32:35], 0
s_add_u32 s24, s24, 262144
M v[96:99], a[180:183], a[36:39], v[96:99]
M v[100:103], a[180:183], a[44:47], 0
M v[100:103], a[176:179], a[40:43], v[100:103]
M v[104:107], a[176:179], a[48:51], 0
M v[104:107], a[180:183], a[52:55], v[104:107]
M v[108:111], a[180:183], a[60:63], 0
M v[108:111], a[176:179], a[56:59], v[108:111]
s_waitcnt vmcnt(15) lgkmcnt(0)
s_barrier
ds_read_b128 a[160:163], v10 offset:16384
ds_read_b128 a[164:167], v11 offset:16384
M v[112:115], a[176:179], a[64:67], 0
s_add_u32 m0, s29, 49152
s_add_u32 s3, s23, s31
buffer_load_dwordx4 v2, s[8:11], s3 offen offset:0 lds
M v[112:115], a[180:183], a[68:71], v[112:115]
M v[116:119], a[180:183], a[76:79], 0
M v[116:119], a[176:179], a[72:75], v[116:119]
ds_read_b64_tr_b16 a[100:101], v12 offset:49152
ds_read_b64_tr_b16 a[102:103], v12 offset:51200
M v[120:123], a[176:179], a[80:83], 0
v_accvgpr_read_b32 v24, a8
v_accvgpr_read_b32 v25, a9
M v[120:123], a[180:183], a[84:87], v[120:123]
buffer_load_dwordx4 v3, s[8:11], s3 offen offset:1024 lds
v_accvgpr_read_b32 v26, a10
v_accvgpr_read_b32 v27, a11
M v[124:127], a[180:183], a[92:95], 0
v_accvgpr_read_b32 v28, a12
v_accvgpr_read_b32 v29, a13
M v[124:127], a[176:179], a[88:91], v[124:127]
v_accvgpr_read_b32 v30, a14
v_accvgpr_read_b32 v31, a15
M v[128:131], a[184:187], a[32:35], 0
v_cvt_pk_bf16_f32 v24, v24, v25
v_cvt_pk_bf16_f32 v25, v26, v27
M v[128:131], a[188:191], a[36:39], v[128:131]
ds_read_b128 a[168:171], v10 offset:18432
ds_read_b128 a[172:175], v11 offset:18432
ds_read_b64_tr_b16 a[108:109], v13 offset:49152
ds_read_b64_tr_b16 a[110:111], v13 offset:51200
v_cvt_pk_bf16_f32 v26, v28, v29
v_cvt_pk_bf16_f32 v27, v30, v31
M v[132:135], a[188:191], a[44:47], 0
M v[132:135], a[184:187], a[40:43], v[132:135]
M v[136:139], a[184:187], a[48:51], 0
buffer_load_dwordx4 v4, s[8:11], s3 offen offset:2048 lds
M v[136:139], a[188:191], a[52:55], v[136:139]
s_add_u32 s94, s93, 12288
buffer_store_dwordx4 v[24:27], v1, s[16:19], s94 offen offset:1024 sc1
M v[140:143], a[188:191], a[60:63], 0
M v[140:143], a[184:187], a[56:59], v[140:143]
ds_read_b64_tr_b16 a[116:117], v14 offset:49152
ds_read_b64_tr_b16 a[118:119], v14 offset:51200
M v[144:147], a[184:187], a[64:67], 0
M v[144:147], a[188:191], a[68:71], v[144:147]
M v[148:151], a[188:191], a[76:79], 0
buffer_load_dwordx4 v5, s[8:11], s3 offen offset:3072 lds
M v[148:151], a[184:187], a[72:75], v[148:151]
M v[152:155], a[184:187], a[80:83], 0
M v[152:155], a[188:191], a[84:87], v[152:155]
ds_read_b64_tr_b16 a[124:125], v15 offset:49152
ds_read_b64_tr_b16 a[126:127], v15 offset:51200
M v[156:159], a[188:191], a[92:95], 0
M v[156:159], a[184:187], a[88:91], v[156:159]
s_waitcnt lgkmcnt(10)
M v[160:163], a[160:163], a[32:35], 0
M v[160:163], a[164:167], a[36:39], v[160:163]
ds_read_b128 a[176:179], v10 offset:20480
ds_read_b128 a[180:183], v11 offset:20480
M v[164:167], a[164:167], a[44:47], 0
s_add_u32 s23, s23, 128
s_cmp_eq_u32 s23, s25
s_cselect_b32 s23, s26, s23
M v[164:167], a[160:163], a[40:43], v[164:167]
ds_read_b64_tr_b16 a[132:133], v16 offset:49152
ds_read_b64_tr_b16 a[134:135], v16 offset:51200
M v[168:171], a[160:163], a[48:51], 0
v_accvgpr_read_b32 v24, a16
v_accvgpr_read_b32 v25, a17
M v[168:171], a[164:167], a[52:55], v[168:171]
v_accvgpr_read_b32 v26, a18
v_accvgpr_read_b32 v27, a19
M v[172:175], a[164:167], a[60:63], 0
v_accvgpr_read_b32 v28, a20
v_accvgpr_read_b32 v29, a21
M v[172:175], a[160:163], a[56:59], v[172:175]
v_accvgpr_read_b32 v30, a22
v_accvgpr_read_b32 v31, a23
M v[176:179], a[160:163], a[64:67], 0
s_add_u32 m0, s29, 81920
s_nop 0
buffer_load_dwordx4 v6, s[12:15], s24 offen offset:0 lds
v_cvt_pk_bf16_f32 v24, v24, v25
v_cvt_pk_bf16_f32 v25, v26, v27
M v[176:179], a[164:167], a[68:71], v[176:179]
ds_read_b64_tr_b16 a[140:141], v17 offset:49152
ds_read_b64_tr_b16 a[142:143], v17 offset:51200
v_cvt_pk_bf16_f32 v26, v28, v29
v_cvt_pk_bf16_f32 v27, v30, v31
M v[180:183], a[164:167], a[76:79], 0
M v[180:183], a[160:163], a[72:75], v[180:183]
M v[184:187], a[160:163], a[80:83], 0
M v[184:187], a[164:167], a[84:87], v[184:187]
s_add_u32 s94, s93, 12288
buffer_store_dwordx4 v[24:27], v1, s[16:19], s94 offen offset:2048 sc1
M v[188:191], a[164:167], a[92:95], 0
buffer_load_dwordx4 v7, s[12:15], s24 offen offset:1024 lds
M v[188:191], a[160:163], a[88:91], v[188:191]
s_waitcnt lgkmcnt(12)
ds_read_b64_tr_b16 a[148:149], v18 offset:49152
ds_read_b64_tr_b16 a[150:151], v18 offset:51200
M v[192:195], a[168:171], a[32:35], 0
M v[192:195], a[172:175], a[36:39], v[192:195]
ds_read_b128 a[184:187], v10 offset:22528
ds_read_b128 a[188:191], v11 offset:22528
M v[196:199], a[172:175], a[44:47], 0
M v[196:199], a[168:171], a[40:43], v[196:199]
M v[200:203], a[168:171], a[48:51], 0
M v[200:203], a[172:175], a[52:55], v[200:203]
ds_read_b64_tr_b16 a[156:157], v19 offset:49152
ds_read_b64_tr_b16 a[158:159], v19 offset:51200
M v[204:207], a[172:175], a[60:63], 0
buffer_load_dwordx4 v8, s[12:15], s24 offen offset:2048 lds
M v[204:207], a[168:171], a[56:59], v[204:207]
M v[208:211], a[168:171], a[64:67], 0
M v[208:211], a[172:175], a[68:71], v[208:211]
M v[212:215], a[172:175], a[76:79], 0
buffer_load_dwordx4 v9, s[12:15], s24 offen offset:3072 lds
M v[212:215], a[168:171], a[72:75], v[212:215]
M v[216:219], a[168:171], a[80:83], 0
v_accvgpr_read_b32 v24, a24
v_accvgpr_read_b32 v25, a25
M v[216:219], a[172:175], a[84:87], v[216:219]
v_accvgpr_read_b32 v26, a26
v_accvgpr_read_b32 v27, a27
M v[220:223], a[172:175], a[92:95], 0
v_accvgpr_read_b32 v28, a28
v_accvgpr_read_b32 v29, a29
M v[220:223], a[168:171], a[88:91], v[220:223]
s_waitcnt lgkmcnt(10)
v_accvgpr_read_b32 v30, a30
v_accvgpr_read_b32 v31, a31
M v[224:227], a[176:179], a[32:35], 0
s_add_u32 s24, s24, 262144
s_cmp_eq_u32 s24, s27
s_cselect_b32 s24, s28, s24
s_sub_u32 s6, s6, 1
s_cmp_eq_u32 s6, 0
s_cselect_b64 s[12:13], s[64:65], s[12:13]
v_cvt_pk_bf16_f32 v24, v24, v25
v_cvt_pk_bf16_f32 v25, v26, v27
M v[224:227], a[180:183], a[36:39], v[224:227]
v_cvt_pk_bf16_f32 v26, v28, v29
v_cvt_pk_bf16_f32 v27, v30, v31
M v[228:231], a[180:183], a[44:47], 0
M v[228:231], a[176:179], a[40:43], v[228:231]
M v[232:235], a[176:179], a[48:51], 0
M v[232:235], a[180:183], a[52:55], v[232:235]
s_add_u32 s94, s93, 12288
buffer_store_dwordx4 v[24:27], v1, s[16:19], s94 offen offset:3072 sc1
M v[236:239], a[180:183], a[60:63], 0
M v[236:239], a[176:179], a[56:59], v[236:239]
s_waitcnt vmcnt(12) lgkmcnt(0)
s_barrier
ds_read_b128 a[160:163], v10 offset:32768
ds_read_b128 a[164:167], v11 offset:32768
M v[240:243], a[176:179], a[64:67], 0
s_add_u32 m0, s29, 0
s_nop 0
buffer_load_dwordx4 v2, s[8:11], s23 offen offset:0 lds
M v[240:243], a[180:183], a[68:71], v[240:243]
M v[244:247], a[180:183], a[76:79], 0
M v[244:247], a[176:179], a[72:75], v[244:247]
M v[248:251], a[176:179], a[80:83], 0
M v[248:251], a[180:183], a[84:87], v[248:251]
buffer_load_dwordx4 v3, s[8:11], s23 offen offset:1024 lds
M v[252:255], a[180:183], a[92:95], 0
M v[252:255], a[176:179], a[88:91], v[252:255]
M a[0:3], a[184:187], a[32:35], 0
M a[0:3], a[188:191], a[36:39], a[0:3]
ds_read_b128 a[168:171], v10 offset:34816
ds_read_b128 a[172:175], v11 offset:34816
M a[4:7], a[188:191], a[44:47], 0
M a[4:7], a[184:187], a[40:43], a[4:7]
M a[8:11], a[184:187], a[48:51], 0
buffer_load_dwordx4 v4, s[8:11], s23 offen offset:2048 lds
M a[8:11], a[188:191], a[52:55], a[8:11]
M a[12:15], a[188:191], a[60:63], 0
M a[12:15], a[184:187], a[56:59], a[12:15]
M a[16:19], a[184:187], a[64:67], 0
M a[16:19], a[188:191], a[68:71], a[16:19]
buffer_load_dwordx4 v5, s[8:11], s23 offen offset:3072 lds
M a[20:23], a[188:191], a[76:79], 0
M a[20:23], a[184:187], a[72:75], a[20:23]
M a[24:27], a[184:187], a[80:83], 0
M a[24:27], a[188:191], a[84:87], a[24:27]
M a[28:31], a[188:191], a[92:95], 0
M a[28:31], a[184:187], a[88:91], a[28:31]
s_waitcnt lgkmcnt(2)
M v[32:35], a[160:163], a[96:99], v[32:35]
s_add_u32 m0, s29, 98304
s_nop 0
buffer_load_dwordx4 v6, s[12:15], s24 offen offset:0 lds
M v[32:35], a[164:167], a[100:103], v[32:35]
ds_read_b128 a[176:179], v10 offset:36864
ds_read_b128 a[180:183], v11 offset:36864
M v[36:39], a[164:167], a[108:111], v[36:39]
M v[36:39], a[160:163], a[104:107], v[36:39]
ds_read_b64_tr_b16 a[32:33], v12 offset:0
ds_read_b64_tr_b16 a[34:35], v12 offset:2048
M v[40:43], a[160:163], a[112:115], v[40:43]
M v[40:43], a[164:167], a[116:119], v[40:43]
M v[44:47], a[164:167], a[124:127], v[44:47]
M v[44:47], a[160:163], a[120:123], v[44:47]
ds_read_b64_tr_b16 a[40:41], v13 offset:0
ds_read_b64_tr_b16 a[42:43], v13 offset:2048
M v[48:51], a[160:163], a[128:131], v[48:51]
s_add_u32 s94, s92, 12288
buffer_store_dwordx4 a[192:195], v1, s[16:19], s94 offen offset:0 sc1
M v[48:51], a[164:167], a[132:135], v[48:51]
buffer_load_dwordx4 v7, s[12:15], s24 offen offset:1024 lds
M v[52:55], a[164:167], a[140:143], v[52:55]
M v[52:55], a[160:163], a[136:139], v[52:55]
ds_read_b64_tr_b16 a[48:49], v14 offset:0
ds_read_b64_tr_b16 a[50:51], v14 offset:2048
M v[56:59], a[160:163], a[144:147], v[56:59]
M v[56:59], a[164:167], a[148:151], v[56:59]
M v[60:63], a[164:167], a[156:159], v[60:63]
M v[60:63], a[160:163], a[152:155], v[60:63]
s_waitcnt lgkmcnt(8)
ds_read_b64_tr_b16 a[56:57], v15 offset:0
ds_read_b64_tr_b16 a[58:59], v15 offset:2048
M v[64:67], a[168:171], a[96:99], v[64:67]
buffer_load_dwordx4 v8, s[12:15], s24 offen offset:2048 lds
M v[64:67], a[172:175], a[100:103], v[64:67]
ds_read_b128 a[184:187], v10 offset:38912
ds_read_b128 a[188:191], v11 offset:38912
M v[68:71], a[172:175], a[108:111], v[68:71]
M v[68:71], a[168:171], a[104:107], v[68:71]
ds_read_b64_tr_b16 a[64:65], v16 offset:0
ds_read_b64_tr_b16 a[66:67], v16 offset:2048
M v[72:75], a[168:171], a[112:115], v[72:75]
M v[72:75], a[172:175], a[116:119], v[72:75]
M v[76:79], a[172:175], a[124:127], v[76:79]
M v[76:79], a[168:171], a[120:123], v[76:79]
ds_read_b64_tr_b16 a[72:73], v17 offset:0
ds_read_b64_tr_b16 a[74:75], v17 offset:2048
M v[80:83], a[168:171], a[128:131], v[80:83]
buffer_load_dwordx4 v9, s[12:15], s24 offen offset:3072 lds
M v[80:83], a[172:175], a[132:135], v[80:83]
M v[84:87], a[172:175], a[140:143], v[84:87]
M v[84:87], a[168:171], a[136:139], v[84:87]
ds_read_b64_tr_b16 a[80:81], v18 offset:0
ds_read_b64_tr_b16 a[82:83], v18 offset:2048
M v[88:91], a[168:171], a[144:147], v[88:91]
M v[88:91], a[172:175], a[148:151], v[88:91]
M v[92:95], a[172:175], a[156:159], v[92:95]
s_add_u32 s24, s24, 262144
M v[92:95], a[168:171], a[152:155], v[92:95]
s_waitcnt lgkmcnt(15)
ds_read_b64_tr_b16 a[88:89], v19 offset:0
ds_read_b64_tr_b16 a[90:91], v19 offset:2048
M v[96:99], a[176:179], a[96:99], v[96:99]
M v[96:99], a[180:183], a[100:103], v[96:99]
M v[100:103], a[180:183], a[108:111], v[100:103]
M v[100:103], a[176:179], a[104:107], v[100:103]
M v[104:107], a[176:179], a[112:115], v[104:107]
s_add_u32 s94, s92, 12288
buffer_store_dwordx4 a[196:199], v1, s[16:19], s94 offen offset:1024 sc1
M v[104:107], a[180:183], a[116:119], v[104:107]
M v[108:111], a[180:183], a[124:127], v[108:111]
M v[108:111], a[176:179], a[120:123], v[108:111]
s_waitcnt vmcnt(11) lgkmcnt(0)
s_barrier
ds_read_b128 a[160:163], v10 offset:49152
ds_read_b128 a[164:167], v11 offset:49152
M v[112:115], a[176:179], a[128:131], v[112:115]
s_add_u32 m0, s29, 16384
s_add_u32 s3, s23, s31
buffer_load_dwordx4 v2, s[8:11], s3 offen offset:0 lds
M v[112:115], a[180:183], a[132:135], v[112:115]
M v[116:119], a[180:183], a[140:143], v[116:119]
M v[116:119], a[176:179], a[136:139], v[116:119]
ds_read_b64_tr_b16 a[36:37], v12 offset:16384
ds_read_b64_tr_b16 a[38:39], v12 offset:18432
M v[120:123], a[176:179], a[144:147], v[120:123]
M v[120:123], a[180:183], a[148:151], v[120:123]
buffer_load_dwordx4 v3, s[8:11], s3 offen offset:1024 lds
M v[124:127], a[180:183], a[156:159], v[124:127]
M v[124:127], a[176:179], a[152:155], v[124:127]
M v[128:131], a[184:187], a[96:99], v[128:131]
M v[128:131], a[188:191], a[100:103], v[128:131]
ds_read_b128 a[168:171], v10 offset:51200
ds_read_b128 a[172:175], v11 offset:51200
ds_read_b64_tr_b16 a[44:45], v13 offset:16384
ds_read_b64_tr_b16 a[46:47], v13 offset:18432
M v[132:135], a[188:191], a[108:111], v[132:135]
M v[132:135], a[184:187], a[104:107], v[132:135]
M v[136:139], a[184:187], a[112:115], v[136:139]
buffer_load_dwordx4 v4, s[8:11], s3 offen offset:2048 lds
M v[136:139], a[188:191], a[116:119], v[136:139]
M v[140:143], a[188:191], a[124:127], v[140:143]
M v[140:143], a[184:187], a[120:123], v[140:143]
ds_read_b64_tr_b16 a[52:53], v14 offset:16384
ds_read_b64_tr_b16 a[54:55], v14 offset:18432
M v[144:147], a[184:187], a[128:131], v[144:147]
M v[144:147], a[188:191], a[132:135], v[144:147]
buffer_load_dwordx4 v5, s[8:11], s3 offen offset:3072 lds
M v[148:151], a[188:191], a[140:143], v[148:151]
M v[148:151], a[184:187], a[136:139], v[148:151]
M v[152:155], a[184:187], a[144:147], v[152:155]
M v[152:155], a[188:191], a[148:151], v[152:155]
ds_read_b64_tr_b16 a[60:61], v15 offset:16384
ds_read_b64_tr_b16 a[62:63], v15 offset:18432
M v[156:159], a[188:191], a[156:159], v[156:159]
M v[156:159], a[184:187], a[152:155], v[156:159]
s_waitcnt lgkmcnt(10)
M v[160:163], a[160:163], a[96:99], v[160:163]
s_add_u32 s94, s92, 12288
buffer_store_dwordx4 a[200:203], v1, s[16:19], s94 offen offset:2048 sc1
M v[160:163], a[164:167], a[100:103], v[160:163]
ds_read_b128 a[176:179], v10 offset:53248
ds_read_b128 a[180:183], v11 offset:53248
M v[164:167], a[164:167], a[108:111], v[164:167]
s_add_u32 s23, s23, 128
s_cmp_eq_u32 s23, s25
s_cselect_b32 s23, s26, s23
M v[164:167], a[160:163], a[104:107], v[164:167]
ds_read_b64_tr_b16 a[68:69], v16 offset:16384
ds_read_b64_tr_b16 a[70:71], v16 offset:18432
M v[168:171], a[160:163], a[112:115], v[168:171]
M v[168:171], a[164:167], a[116:119], v[168:171]
M v[172:175], a[164:167], a[124:127], v[172:175]
M v[172:175], a[160:163], a[120:123], v[172:175]
M v[176:179], a[160:163], a[128:131], v[176:179]
s_add_u32 m0, s29, 114688
s_nop 0
buffer_load_dwordx4 v6, s[12:15], s24 offen offset:0 lds
M v[176:179], a[164:167], a[132:135], v[176:179]
ds_read_b64_tr_b16 a[76:77], v17 offset:16384
ds_read_b64_tr_b16 a[78:79], v17 offset:18432
M v[180:183], a[164:167], a[140:143], v[180:183]
M v[180:183], a[160:163], a[136:139], v[180:183]
M v[184:187], a[160:163], a[144:147], v[184:187]
M v[184:187], a[164:167], a[148:151], v[184:187]
buffer_load_dwordx4 v7, s[12:15], s24 offen offset:1024 lds
M v[188:191], a[164:167], a[156:159], v[188:191]
M v[188:191], a[160:163], a[152:155], v[188:191]
s_waitcnt lgkmcnt(12)
ds_read_b64_tr_b16 a[84:85], v18 offset:16384
ds_read_b64_tr_b16 a[86:87], v18 offset:18432
M v[192:195], a[168:171], a[96:99], v[192:195]
M v[192:195], a[172:175], a[100:103], v[192:195]
ds_read_b128 a[184:187], v10 offset:55296
ds_read_b128 a[188:191], v11 offset:55296
M v[196:199], a[172:175], a[108:111], v[196:199]
M v[196:199], a[168:171], a[104:107], v[196:199]
M v[200:203], a[168:171], a[112:115], v[200:203]
buffer_load_dwordx4 v8, s[12:15], s24 offen offset:2048 lds
M v[200:203], a[172:175], a[116:119], v[200:203]
ds_read_b64_tr_b16 a[92:93], v19 offset:16384
ds_read_b64_tr_b16 a[94:95], v19 offset:18432
M v[204:207], a[172:175], a[124:127], v[204:207]
M v[204:207], a[168:171], a[120:123], v[204:207]
M v[208:211], a[168:171], a[128:131], v[208:211]
M v[208:211], a[172:175], a[132:135], v[208:211]
buffer_load_dwordx4 v9, s[12:15], s24 offen offset:3072 lds
M v[212:215], a[172:175], a[140:143], v[212:215]
M v[212:215], a[168:171], a[136:139], v[212:215]
M v[216:219], a[168:171], a[144:147], v[216:219]
s_add_u32 s94, s92, 12288
buffer_store_dwordx4 a[204:207], v1, s[16:19], s94 offen offset:3072 sc1
M v[216:219], a[172:175], a[148:151], v[216:219]
M v[220:223], a[172:175], a[156:159], v[220:223]
M v[220:223], a[168:171], a[152:155], v[220:223]
s_waitcnt lgkmcnt(10)
M v[224:227], a[176:179], a[96:99], v[224:227]
s_add_u32 s24, s24, 262144
s_cmp_eq_u32 s24, s27
s_cselect_b32 s24, s28, s24
s_sub_u32 s6, s6, 1
s_cmp_eq_u32 s6, 0
s_cselect_b64 s[12:13], s[64:65], s[12:13]
M v[224:227], a[180:183], a[100:103], v[224:227]
M v[228:231], a[180:183], a[108:111], v[228:231]
M v[228:231], a[176:179], a[104:107], v[228:231]
M v[232:235], a[176:179], a[112:115], v[232:235]
M v[232:235], a[180:183], a[116:119], v[232:235]
M v[236:239], a[180:183], a[124:127], v[236:239]
M v[236:239], a[176:179], a[120:123], v[236:239]
s_waitcnt vmcnt(11) lgkmcnt(0)
s_barrier
ds_read_b128 a[160:163], v10 offset:0
ds_read_b128 a[164:167], v11 offset:0
M v[240:243], a[176:179], a[128:131], v[240:243]
s_add_u32 m0, s29, 32768
s_nop 0
buffer_load_dwordx4 v2, s[8:11], s23 offen offset:0 lds
M v[240:243], a[180:183], a[132:135], v[240:243]
M v[244:247], a[180:183], a[140:143], v[244:247]
M v[244:247], a[176:179], a[136:139], v[244:247]
M v[248:251], a[176:179], a[144:147], v[248:251]
M v[248:251], a[180:183], a[148:151], v[248:251]
buffer_load_dwordx4 v3, s[8:11], s23 offen offset:1024 lds
M v[252:255], a[180:183], a[156:159], v[252:255]
M v[252:255], a[176:179], a[152:155], v[252:255]
M a[0:3], a[184:187], a[96:99], a[0:3]
M a[0:3], a[188:191], a[100:103], a[0:3]
ds_read_b128 a[168:171], v10 offset:2048
ds_read_b128 a[172:175], v11 offset:2048
M a[4:7], a[188:191], a[108:111], a[4:7]
M a[4:7], a[184:187], a[104:107], a[4:7]
M a[8:11], a[184:187], a[112:115], a[8:11]
buffer_load_dwordx4 v4, s[8:11], s23 offen offset:2048 lds
M a[8:11], a[188:191], a[116:119], a[8:11]
M a[12:15], a[188:191], a[124:127], a[12:15]
M a[12:15], a[184:187], a[120:123], a[12:15]
M a[16:19], a[184:187], a[128:131], a[16:19]
M a[16:19], a[188:191], a[132:135], a[16:19]
buffer_load_dwordx4 v5, s[8:11], s23 offen offset:3072 lds
M a[20:23], a[188:191], a[140:143], a[20:23]
M a[20:23], a[184:187], a[136:139], a[20:23]
M a[24:27], a[184:187], a[144:147], a[24:27]
M a[24:27], a[188:191], a[148:151], a[24:27]
M a[28:31], a[188:191], a[156:159], a[28:31]
M a[28:31], a[184:187], a[152:155], a[28:31]
s_waitcnt lgkmcnt(2)
M v[32:35], a[160:163], a[32:35], v[32:35]
s_add_u32 m0, s29, 65536
s_nop 0
buffer_load_dwordx4 v6, s[12:15], s24 offen offset:0 lds
M v[32:35], a[164:167], a[36:39], v[32:35]
ds_read_b128 a[176:179], v10 offset:4096
ds_read_b128 a[180:183], v11 offset:4096
M v[36:39], a[164:167], a[44:47], v[36:39]
M v[36:39], a[160:163], a[40:43], v[36:39]
ds_read_b64_tr_b16 a[96:97], v12 offset:32768
ds_read_b64_tr_b16 a[98:99], v12 offset:34816
M v[40:43], a[160:163], a[48:51], v[40:43]
M v[40:43], a[164:167], a[52:55], v[40:43]
M v[44:47], a[164:167], a[60:63], v[44:47]
M v[44:47], a[160:163], a[56:59], v[44:47]
ds_read_b64_tr_b16 a[104:105], v13 offset:32768
ds_read_b64_tr_b16 a[106:107], v13 offset:34816
M v[48:51], a[160:163], a[64:67], v[48:51]
s_add_u32 s94, s93, 0
buffer_store_dwordx4 a[208:211], v1, s[16:19], s94 offen offset:0 sc1
M v[48:51], a[164:167], a[68:71], v[48:51]
buffer_load_dwordx4 v7, s[12:15], s24 offen offset:1024 lds
M v[52:55], a[164:167], a[76:79], v[52:55]
M v[52:55], a[160:163], a[72:75], v[52:55]
ds_read_b64_tr_b16 a[112:113], v14 offset:32768
ds_read_b64_tr_b16 a[114:115], v14 offset:34816
M v[56:59], a[160:163], a[80:83], v[56:59]
M v[56:59], a[164:167], a[84:87], v[56:59]
M v[60:63], a[164:167], a[92:95], v[60:63]
M v[60:63], a[160:163], a[88:91], v[60:63]
s_waitcnt lgkmcnt(8)
ds_read_b64_tr_b16 a[120:121], v15 offset:32768
ds_read_b64_tr_b16 a[122:123], v15 offset:34816
M v[64:67], a[168:171], a[32:35], v[64:67]
buffer_load_dwordx4 v8, s[12:15], s24 offen offset:2048 lds
M v[64:67], a[172:175], a[36:39], v[64:67]
ds_read_b128 a[184:187], v10 offset:6144
ds_read_b128 a[188:191], v11 offset:6144
M v[68:71], a[172:175], a[44:47], v[68:71]
M v[68:71], a[168:171], a[40:43], v[68:71]
ds_read_b64_tr_b16 a[128:129], v16 offset:32768
ds_read_b64_tr_b16 a[130:131], v16 offset:34816
M v[72:75], a[168:171], a[48:51], v[72:75]
M v[72:75], a[172:175], a[52:55], v[72:75]
M v[76:79], a[172:175], a[60:63], v[76:79]
M v[76:79], a[168:171], a[56:59], v[76:79]
ds_read_b64_tr_b16 a[136:137], v17 offset:32768
ds_read_b64_tr_b16 a[138:139], v17 offset:34816
M v[80:83], a[168:171], a[64:67], v[80:83]
buffer_load_dwordx4 v9, s[12:15], s24 offen offset:3072 lds
M v[80:83], a[172:175], a[68:71], v[80:83]
M v[84:87], a[172:175], a[76:79], v[84:87]
M v[84:87], a[168:171], a[72:75], v[84:87]
ds_read_b64_tr_b16 a[144:145], v18 offset:32768
ds_read_b64_tr_b16 a[146:147], v18 offset:34816
M v[88:91], a[168:171], a[80:83], v[88:91]
M v[88:91], a[172:175], a[84:87], v[88:91]
M v[92:95], a[172:175], a[92:95], v[92:95]
s_add_u32 s24, s24, 262144
M v[92:95], a[168:171], a[88:91], v[92:95]
s_waitcnt lgkmcnt(15)
ds_read_b64_tr_b16 a[152:153], v19 offset:32768
ds_read_b64_tr_b16 a[154:155], v19 offset:34816
M v[96:99], a[176:179], a[32:35], v[96:99]
M v[96:99], a[180:183], a[36:39], v[96:99]
M v[100:103], a[180:183], a[44:47], v[100:103]
M v[100:103], a[176:179], a[40:43], v[100:103]
M v[104:107], a[176:179], a[48:51], v[104:107]
s_add_u32 s94, s93, 0
buffer_store_dwordx4 a[212:215], v1, s[16:19], s94 offen offset:1024 sc1
M v[104:107], a[180:183], a[52:55], v[104:107]
M v[108:111], a[180:183], a[60:63], v[108:111]
M v[108:111], a[176:179], a[56:59], v[108:111]
s_waitcnt vmcnt(11) lgkmcnt(0)
s_barrier
ds_read_b128 a[160:163], v10 offset:16384
ds_read_b128 a[164:167], v11 offset:16384
M v[112:115], a[176:179], a[64:67], v[112:115]
s_add_u32 m0, s29, 49152
s_add_u32 s3, s23, s31
buffer_load_dwordx4 v2, s[8:11], s3 offen offset:0 lds
M v[112:115], a[180:183], a[68:71], v[112:115]
M v[116:119], a[180:183], a[76:79], v[116:119]
M v[116:119], a[176:179], a[72:75], v[116:119]
ds_read_b64_tr_b16 a[100:101], v12 offset:49152
ds_read_b64_tr_b16 a[102:103], v12 offset:51200
M v[120:123], a[176:179], a[80:83], v[120:123]
M v[120:123], a[180:183], a[84:87], v[120:123]
buffer_load_dwordx4 v3, s[8:11], s3 offen offset:1024 lds
M v[124:127], a[180:183], a[92:95], v[124:127]
M v[124:127], a[176:179], a[88:91], v[124:127]
M v[128:131], a[184:187], a[32:35], v[128:131]
M v[128:131], a[188:191], a[36:39], v[128:131]
ds_read_b128 a[168:171], v10 offset:18432
ds_read_b128 a[172:175], v11 offset:18432
ds_read_b64_tr_b16 a[108:109], v13 offset:49152
ds_read_b64_tr_b16 a[110:111], v13 offset:51200
M v[132:135], a[188:191], a[44:47], v[132:135]
M v[132:135], a[184:187], a[40:43], v[132:135]
M v[136:139], a[184:187], a[48:51], v[136:139]
buffer_load_dwordx4 v4, s[8:11], s3 offen offset:2048 lds
M v[136:139], a[188:191], a[52:55], v[136:139]
M v[140:143], a[188:191], a[60:63], v[140:143]
M v[140:143], a[184:187], a[56:59], v[140:143]
ds_read_b64_tr_b16 a[116:117], v14 offset:49152
ds_read_b64_tr_b16 a[118:119], v14 offset:51200
M v[144:147], a[184:187], a[64:67], v[144:147]
M v[144:147], a[188:191], a[68:71], v[144:147]
buffer_load_dwordx4 v5, s[8:11], s3 offen offset:3072 lds
M v[148:151], a[188:191], a[76:79], v[148:151]
M v[148:151], a[184:187], a[72:75], v[148:151]
M v[152:155], a[184:187], a[80:83], v[152:155]
M v[152:155], a[188:191], a[84:87], v[152:155]
ds_read_b64_tr_b16 a[124:125], v15 offset:49152
ds_read_b64_tr_b16 a[126:127], v15 offset:51200
M v[156:159], a[188:191], a[92:95], v[156:159]
M v[156:159], a[184:187], a[88:91], v[156:159]
s_waitcnt lgkmcnt(10)
M v[160:163], a[160:163], a[32:35], v[160:163]
s_add_u32 s94, s93, 0
buffer_store_dwordx4 a[216:219], v1, s[16:19], s94 offen offset:2048 sc1
M v[160:163], a[164:167], a[36:39], v[160:163]
ds_read_b128 a[176:179], v10 offset:20480
ds_read_b128 a[180:183], v11 offset:20480
M v[164:167], a[164:167], a[44:47], v[164:167]
s_add_u32 s23, s23, 128
s_cmp_eq_u32 s23, s25
s_cselect_b32 s23, s26, s23
M v[164:167], a[160:163], a[40:43], v[164:167]
ds_read_b64_tr_b16 a[132:133], v16 offset:49152
ds_read_b64_tr_b16 a[134:135], v16 offset:51200
M v[168:171], a[160:163], a[48:51], v[168:171]
M v[168:171], a[164:167], a[52:55], v[168:171]
M v[172:175], a[164:167], a[60:63], v[172:175]
M v[172:175], a[160:163], a[56:59], v[172:175]
M v[176:179], a[160:163], a[64:67], v[176:179]
s_add_u32 m0, s29, 81920
s_nop 0
buffer_load_dwordx4 v6, s[12:15], s24 offen offset:0 lds
M v[176:179], a[164:167], a[68:71], v[176:179]
ds_read_b64_tr_b16 a[140:141], v17 offset:49152
ds_read_b64_tr_b16 a[142:143], v17 offset:51200
M v[180:183], a[164:167], a[76:79], v[180:183]
M v[180:183], a[160:163], a[72:75], v[180:183]
M v[184:187], a[160:163], a[80:83], v[184:187]
M v[184:187], a[164:167], a[84:87], v[184:187]
buffer_load_dwordx4 v7, s[12:15], s24 offen offset:1024 lds
M v[188:191], a[164:167], a[92:95], v[188:191]
M v[188:191], a[160:163], a[88:91], v[188:191]
s_waitcnt lgkmcnt(12)
ds_read_b64_tr_b16 a[148:149], v18 offset:49152
ds_read_b64_tr_b16 a[150:151], v18 offset:51200
M v[192:195], a[168:171], a[32:35], v[192:195]
M v[192:195], a[172:175], a[36:39], v[192:195]
ds_read_b128 a[184:187], v10 offset:22528
ds_read_b128 a[188:191], v11 offset:22528
M v[196:199], a[172:175], a[44:47], v[196:199]
M v[196:199], a[168:171], a[40:43], v[196:199]
M v[200:203], a[168:171], a[48:51], v[200:203]
buffer_load_dwordx4 v8, s[12:15], s24 offen offset:2048 lds
M v[200:203], a[172:175], a[52:55], v[200:203]
ds_read_b64_tr_b16 a[156:157], v19 offset:49152
ds_read_b64_tr_b16 a[158:159], v19 offset:51200
M v[204:207], a[172:175], a[60:63], v[204:207]
M v[204:207], a[168:171], a[56:59], v[204:207]
M v[208:211], a[168:171], a[64:67], v[208:211]
M v[208:211], a[172:175], a[68:71], v[208:211]
buffer_load_dwordx4 v9, s[12:15], s24 offen offset:3072 lds
M v[212:215], a[172:175], a[76:79], v[212:215]
M v[212:215], a[168:171], a[72:75], v[212:215]
M v[216:219], a[168:171], a[80:83], v[216:219]
s_add_u32 s94, s93, 0
buffer_store_dwordx4 a[220:223], v1, s[16:19], s94 offen offset:3072 sc1
M v[216:219], a[172:175], a[84:87], v[216:219]
M v[220:223], a[172:175], a[92:95], v[220:223]
M v[220:223], a[168:171], a[88:91], v[220:223]
s_waitcnt lgkmcnt(10)
M v[224:227], a[176:179], a[32:35], v[224:227]
s_add_u32 s24, s24, 262144
s_cmp_eq_u32 s24, s27
s_cselect_b32 s24, s28, s24
s_sub_u32 s6, s6, 1
s_cmp_eq_u32 s6, 0
s_cselect_b64 s[12:13], s[64:65], s[12:13]
M v[224:227], a[180:183], a[36:39], v[224:227]
M v[228:231], a[180:183], a[44:47], v[228:231]
M v[228:231], a[176:179], a[40:43], v[228:231]
M v[232:235], a[176:179], a[48:51], v[232:235]
M v[232:235], a[180:183], a[52:55], v[232:235]
M v[236:239], a[180:183], a[60:63], v[236:239]
M v[236:239], a[176:179], a[56:59], v[236:239]
s_waitcnt vmcnt(11) lgkmcnt(0)
s_barrier
ds_read_b128 a[160:163], v10 offset:32768
ds_read_b128 a[164:167], v11 offset:32768
M v[240:243], a[176:179], a[64:67], v[240:243]
s_add_u32 m0, s29, 0
s_nop 0
buffer_load_dwordx4 v2, s[8:11], s23 offen offset:0 lds
M v[240:243], a[180:183], a[68:71], v[240:243]
M v[244:247], a[180:183], a[76:79], v[244:247]
M v[244:247], a[176:179], a[72:75], v[244:247]
M v[248:251], a[176:179], a[80:83], v[248:251]
M v[248:251], a[180:183], a[84:87], v[248:251]
buffer_load_dwordx4 v3, s[8:11], s23 offen offset:1024 lds
M v[252:255], a[180:183], a[92:95], v[252:255]
M v[252:255], a[176:179], a[88:91], v[252:255]
M a[0:3], a[184:187], a[32:35], a[0:3]
M a[0:3], a[188:191], a[36:39], a[0:3]
ds_read_b128 a[168:171], v10 offset:34816
ds_read_b128 a[172:175], v11 offset:34816
M a[4:7], a[188:191], a[44:47], a[4:7]
M a[4:7], a[184:187], a[40:43], a[4:7]
M a[8:11], a[184:187], a[48:51], a[8:11]
buffer_load_dwordx4 v4, s[8:11], s23 offen offset:2048 lds
M a[8:11], a[188:191], a[52:55], a[8:11]
M a[12:15], a[188:191], a[60:63], a[12:15]
M a[12:15], a[184:187], a[56:59], a[12:15]
M a[16:19], a[184:187], a[64:67], a[16:19]
M a[16:19], a[188:191], a[68:71], a[16:19]
buffer_load_dwordx4 v5, s[8:11], s23 offen offset:3072 lds
M a[20:23], a[188:191], a[76:79], a[20:23]
M a[20:23], a[184:187], a[72:75], a[20:23]
M a[24:27], a[184:187], a[80:83], a[24:27]
M a[24:27], a[188:191], a[84:87], a[24:27]
M a[28:31], a[188:191], a[92:95], a[28:31]
M a[28:31], a[184:187], a[88:91], a[28:31]
s_waitcnt lgkmcnt(2)
M v[32:35], a[160:163], a[96:99], v[32:35]
s_add_u32 m0, s29, 98304
s_nop 0
buffer_load_dwordx4 v6, s[12:15], s24 offen offset:0 lds
M v[32:35], a[164:167], a[100:103], v[32:35]
ds_read_b128 a[176:179], v10 offset:36864
ds_read_b128 a[180:183], v11 offset:36864
M v[36:39], a[164:167], a[108:111], v[36:39]
M v[36:39], a[160:163], a[104:107], v[36:39]
ds_read_b64_tr_b16 a[32:33], v12 offset:0
ds_read_b64_tr_b16 a[34:35], v12 offset:2048
M v[40:43], a[160:163], a[112:115], v[40:43]
M v[40:43], a[164:167], a[116:119], v[40:43]
M v[44:47], a[164:167], a[124:127], v[44:47]
M v[44:47], a[160:163], a[120:123], v[44:47]
ds_read_b64_tr_b16 a[40:41], v13 offset:0
ds_read_b64_tr_b16 a[42:43], v13 offset:2048
M v[48:51], a[160:163], a[128:131], v[48:51]
s_add_u32 s94, s93, 4096
buffer_store_dwordx4 a[224:227], v1, s[16:19], s94 offen offset:0 sc1
M v[48:51], a[164:167], a[132:135], v[48:51]
buffer_load_dwordx4 v7, s[12:15], s24 offen offset:1024 lds
M v[52:55], a[164:167], a[140:143], v[52:55]
M v[52:55], a[160:163], a[136:139], v[52:55]
ds_read_b64_tr_b16 a[48:49], v14 offset:0
ds_read_b64_tr_b16 a[50:51], v14 offset:2048
M v[56:59], a[160:163], a[144:147], v[56:59]
M v[56:59], a[164:167], a[148:151], v[56:59]
M v[60:63], a[164:167], a[156:159], v[60:63]
M v[60:63], a[160:163], a[152:155], v[60:63]
s_waitcnt lgkmcnt(8)
ds_read_b64_tr_b16 a[56:57], v15 offset:0
ds_read_b64_tr_b16 a[58:59], v15 offset:2048
M v[64:67], a[168:171], a[96:99], v[64:67]
buffer_load_dwordx4 v8, s[12:15], s24 offen offset:2048 lds
M v[64:67], a[172:175], a[100:103], v[64:67]
ds_read_b128 a[184:187], v10 offset:38912
ds_read_b128 a[188:191], v11 offset:38912
M v[68:71], a[172:175], a[108:111], v[68:71]
M v[68:71], a[168:171], a[104:107], v[68:71]
ds_read_b64_tr_b16 a[64:65], v16 offset:0
ds_read_b64_tr_b16 a[66:67], v16 offset:2048
M v[72:75], a[168:171], a[112:115], v[72:75]
M v[72:75], a[172:175], a[116:119], v[72:75]
M v[76:79], a[172:175], a[124:127], v[76:79]
M v[76:79], a[168:171], a[120:123], v[76:79]
ds_read_b64_tr_b16 a[72:73], v17 offset:0
ds_read_b64_tr_b16 a[74:75], v17 offset:2048
M v[80:83], a[168:171], a[128:131], v[80:83]
buffer_load_dwordx4 v9, s[12:15], s24 offen offset:3072 lds
M v[80:83], a[172:175], a[132:135], v[80:83]
M v[84:87], a[172:175], a[140:143], v[84:87]
M v[84:87], a[168:171], a[136:139], v[84:87]
ds_read_b64_tr_b16 a[80:81], v18 offset:0
ds_read_b64_tr_b16 a[82:83], v18 offset:2048
M v[88:91], a[168:171], a[144:147], v[88:91]
M v[88:91], a[172:175], a[148:151], v[88:91]
M v[92:95], a[172:175], a[156:159], v[92:95]
s_add_u32 s24, s24, 262144
M v[92:95], a[168:171], a[152:155], v[92:95]
s_waitcnt lgkmcnt(15)
ds_read_b64_tr_b16 a[88:89], v19 offset:0
ds_read_b64_tr_b16 a[90:91], v19 offset:2048
M v[96:99], a[176:179], a[96:99], v[96:99]
M v[96:99], a[180:183], a[100:103], v[96:99]
M v[100:103], a[180:183], a[108:111], v[100:103]
M v[100:103], a[176:179], a[104:107], v[100:103]
M v[104:107], a[176:179], a[112:115], v[104:107]
s_add_u32 s94, s93, 4096
buffer_store_dwordx4 a[228:231], v1, s[16:19], s94 offen offset:1024 sc1
M v[104:107], a[180:183], a[116:119], v[104:107]
M v[108:111], a[180:183], a[124:127], v[108:111]
M v[108:111], a[176:179], a[120:123], v[108:111]
s_waitcnt vmcnt(11) lgkmcnt(0)
s_barrier
ds_read_b128 a[160:163], v10 offset:49152
ds_read_b128 a[164:167], v11 offset:49152
M v[112:115], a[176:179], a[128:131], v[112:115]
s_add_u32 m0, s29, 16384
s_add_u32 s3, s23, s31
buffer_load_dwordx4 v2, s[8:11], s3 offen offset:0 lds
M v[112:115], a[180:183], a[132:135], v[112:115]
M v[116:119], a[180:183], a[140:143], v[116:119]
M v[116:119], a[176:179], a[136:139], v[116:119]
ds_read_b64_tr_b16 a[36:37], v12 offset:16384
ds_read_b64_tr_b16 a[38:39], v12 offset:18432
M v[120:123], a[176:179], a[144:147], v[120:123]
M v[120:123], a[180:183], a[148:151], v[120:123]
buffer_load_dwordx4 v3, s[8:11], s3 offen offset:1024 lds
M v[124:127], a[180:183], a[156:159], v[124:127]
M v[124:127], a[176:179], a[152:155], v[124:127]
M v[128:131], a[184:187], a[96:99], v[128:131]
M v[128:131], a[188:191], a[100:103], v[128:131]
ds_read_b128 a[168:171], v10 offset:51200
ds_read_b128 a[172:175], v11 offset:51200
ds_read_b64_tr_b16 a[44:45], v13 offset:16384
ds_read_b64_tr_b16 a[46:47], v13 offset:18432
M v[132:135], a[188:191], a[108:111], v[132:135]
M v[132:135], a[184:187], a[104:107], v[132:135]
M v[136:139], a[184:187], a[112:115], v[136:139]
buffer_load_dwordx4 v4, s[8:11], s3 offen offset:2048 lds
M v[136:139], a[188:191], a[116:119], v[136:139]
M v[140:143], a[188:191], a[124:127], v[140:143]
M v[140:143], a[184:187], a[120:123], v[140:143]
ds_read_b64_tr_b16 a[52:53], v14 offset:16384
ds_read_b64_tr_b16 a[54:55], v14 offset:18432
M v[144:147], a[184:187], a[128:131], v[144:147]
M v[144:147], a[188:191], a[132:135], v[144:147]
buffer_load_dwordx4 v5, s[8:11], s3 offen offset:3072 lds
M v[148:151], a[188:191], a[140:143], v[148:151]
M v[148:151], a[184:187], a[136:139], v[148:151]
M v[152:155], a[184:187], a[144:147], v[152:155]
M v[152:155], a[188:191], a[148:151], v[152:155]
ds_read_b64_tr_b16 a[60:61], v15 offset:16384
ds_read_b64_tr_b16 a[62:63], v15 offset:18432
M v[156:159], a[188:191], a[156:159], v[156:159]
M v[156:159], a[184:187], a[152:155], v[156:159]
s_waitcnt lgkmcnt(10)
M v[160:163], a[160:163], a[96:99], v[160:163]
s_add_u32 s94, s93, 4096
buffer_store_dwordx4 a[232:235], v1, s[16:19], s94 offen offset:2048 sc1
M v[160:163], a[164:167], a[100:103], v[160:163]
ds_read_b128 a[176:179], v10 offset:53248
ds_read_b128 a[180:183], v11 offset:53248
M v[164:167], a[164:167], a[108:111], v[164:167]
s_add_u32 s23, s23, 128
s_cmp_eq_u32 s23, s25
s_cselect_b32 s23, s26, s23
M v[164:167], a[160:163], a[104:107], v[164:167]
ds_read_b64_tr_b16 a[68:69], v16 offset:16384
ds_read_b64_tr_b16 a[70:71], v16 offset:18432
M v[168:171], a[160:163], a[112:115], v[168:171]
M v[168:171], a[164:167], a[116:119], v[168:171]
M v[172:175], a[164:167], a[124:127], v[172:175]
M v[172:175], a[160:163], a[120:123], v[172:175]
M v[176:179], a[160:163], a[128:131], v[176:179]
s_add_u32 m0, s29, 114688
s_nop 0
buffer_load_dwordx4 v6, s[12:15], s24 offen offset:0 lds
M v[176:179], a[164:167], a[132:135], v[176:179]
ds_read_b64_tr_b16 a[76:77], v17 offset:16384
ds_read_b64_tr_b16 a[78:79], v17 offset:18432
M v[180:183], a[164:167], a[140:143], v[180:183]
M v[180:183], a[160:163], a[136:139], v[180:183]
M v[184:187], a[160:163], a[144:147], v[184:187]
M v[184:187], a[164:167], a[148:151], v[184:187]
buffer_load_dwordx4 v7, s[12:15], s24 offen offset:1024 lds
M v[188:191], a[164:167], a[156:159], v[188:191]
M v[188:191], a[160:163], a[152:155], v[188:191]
s_waitcnt lgkmcnt(12)
ds_read_b64_tr_b16 a[84:85], v18 offset:16384
ds_read_b64_tr_b16 a[86:87], v18 offset:18432
M v[192:195], a[168:171], a[96:99], v[192:195]
M v[192:195], a[172:175], a[100:103], v[192:195]
ds_read_b128 a[184:187], v10 offset:55296
ds_read_b128 a[188:191], v11 offset:55296
M v[196:199], a[172:175], a[108:111], v[196:199]
M v[196:199], a[168:171], a[104:107], v[196:199]
M v[200:203], a[168:171], a[112:115], v[200:203]
buffer_load_dwordx4 v8, s[12:15], s24 offen offset:2048 lds
M v[200:203], a[172:175], a[116:119], v[200:203]
ds_read_b64_tr_b16 a[92:93], v19 offset:16384
ds_read_b64_tr_b16 a[94:95], v19 offset:18432
M v[204:207], a[172:175], a[124:127], v[204:207]
M v[204:207], a[168:171], a[120:123], v[204:207]
M v[208:211], a[168:171], a[128:131], v[208:211]
M v[208:211], a[172:175], a[132:135], v[208:211]
buffer_load_dwordx4 v9, s[12:15], s24 offen offset:3072 lds
M v[212:215], a[172:175], a[140:143], v[212:215]
M v[212:215], a[168:171], a[136:139], v[212:215]
M v[216:219], a[168:171], a[144:147], v[216:219]
s_add_u32 s94, s93, 4096
buffer_store_dwordx4 a[236:239], v1, s[16:19], s94 offen offset:3072 sc1
M v[216:219], a[172:175], a[148:151], v[216:219]
M v[220:223], a[172:175], a[156:159], v[220:223]
M v[220:223], a[168:171], a[152:155], v[220:223]
s_waitcnt lgkmcnt(10)
M v[224:227], a[176:179], a[96:99], v[224:227]
s_add_u32 s24, s24, 262144
s_cmp_eq_u32 s24, s27
s_cselect_b32 s24, s28, s24
s_sub_u32 s6, s6, 1
s_cmp_eq_u32 s6, 0
s_cselect_b64 s[12:13], s[64:65], s[12:13]
M v[224:227], a[180:183], a[100:103], v[224:227]
M v[228:231], a[180:183], a[108:111], v[228:231]
M v[228:231], a[176:179], a[104:107], v[228:231]
M v[232:235], a[176:179], a[112:115], v[232:235]
M v[232:235], a[180:183], a[116:119], v[232:235]
M v[236:239], a[180:183], a[124:127], v[236:239]
M v[236:239], a[176:179], a[120:123], v[236:239]
s_waitcnt vmcnt(11) lgkmcnt(0)
s_barrier
ds_read_b128 a[160:163], v10 offset:0
ds_read_b128 a[164:167], v11 offset:0
M v[240:243], a[176:179], a[128:131], v[240:243]
s_add_u32 m0, s29, 32768
s_nop 0
buffer_load_dwordx4 v2, s[8:11], s23 offen offset:0 lds
M v[240:243], a[180:183], a[132:135], v[240:243]
M v[244:247], a[180:183], a[140:143], v[244:247]
M v[244:247], a[176:179], a[136:139], v[244:247]
M v[248:251], a[176:179], a[144:147], v[248:251]
M v[248:251], a[180:183], a[148:151], v[248:251]
buffer_load_dwordx4 v3, s[8:11], s23 offen offset:1024 lds
M v[252:255], a[180:183], a[156:159], v[252:255]
M v[252:255], a[176:179], a[152:155], v[252:255]
M a[0:3], a[184:187], a[96:99], a[0:3]
M a[0:3], a[188:191], a[100:103], a[0:3]
ds_read_b128 a[168:171], v10 offset:2048
ds_read_b128 a[172:175], v11 offset:2048
M a[4:7], a[188:191], a[108:111], a[4:7]
M a[4:7], a[184:187], a[104:107], a[4:7]
M a[8:11], a[184:187], a[112:115], a[8:11]
buffer_load_dwordx4 v4, s[8:11], s23 offen offset:2048 lds
M a[8:11], a[188:191], a[116:119], a[8:11]
M a[12:15], a[188:191], a[124:127], a[12:15]
M a[12:15], a[184:187], a[120:123], a[12:15]
M a[16:19], a[184:187], a[128:131], a[16:19]
M a[16:19], a[188:191], a[132:135], a[16:19]
buffer_load_dwordx4 v5, s[8:11], s23 offen offset:3072 lds
M a[20:23], a[188:191], a[140:143], a[20:23]
M a[20:23], a[184:187], a[136:139], a[20:23]
M a[24:27], a[184:187], a[144:147], a[24:27]
M a[24:27], a[188:191], a[148:151], a[24:27]
M a[28:31], a[188:191], a[156:159], a[28:31]
M a[28:31], a[184:187], a[152:155], a[28:31]
s_waitcnt lgkmcnt(2)
M v[32:35], a[160:163], a[32:35], v[32:35]
s_add_u32 m0, s29, 65536
s_nop 0
buffer_load_dwordx4 v6, s[12:15], s24 offen offset:0 lds
M v[32:35], a[164:167], a[36:39], v[32:35]
ds_read_b128 a[176:179], v10 offset:4096
ds_read_b128 a[180:183], v11 offset:4096
M v[36:39], a[164:167], a[44:47], v[36:39]
M v[36:39], a[160:163], a[40:43], v[36:39]
ds_read_b64_tr_b16 a[96:97], v12 offset:32768
ds_read_b64_tr_b16 a[98:99], v12 offset:34816
M v[40:43], a[160:163], a[48:51], v[40:43]
M v[40:43], a[164:167], a[52:55], v[40:43]
M v[44:47], a[164:167], a[60:63], v[44:47]
M v[44:47], a[160:163], a[56:59], v[44:47]
ds_read_b64_tr_b16 a[104:105], v13 offset:32768
ds_read_b64_tr_b16 a[106:107], v13 offset:34816
M v[48:51], a[160:163], a[64:67], v[48:51]
s_add_u32 s94, s93, 8192
buffer_store_dwordx4 a[240:243], v1, s[16:19], s94 offen offset:0 sc1
M v[48:51], a[164:167], a[68:71], v[48:51]
buffer_load_dwordx4 v7, s[12:15], s24 offen offset:1024 lds
M v[52:55], a[164:167], a[76:79], v[52:55]
M v[52:55], a[160:163], a[72:75], v[52:55]
ds_read_b64_tr_b16 a[112:113], v14 offset:32768
ds_read_b64_tr_b16 a[114:115], v14 offset:34816
M v[56:59], a[160:163], a[80:83], v[56:59]
M v[56:59], a[164:167], a[84:87], v[56:59]
M v[60:63], a[164:167], a[92:95], v[60:63]
M v[60:63], a[160:163], a[88:91], v[60:63]
s_waitcnt lgkmcnt(8)
ds_read_b64_tr_b16 a[120:121], v15 offset:32768
ds_read_b64_tr_b16 a[122:123], v15 offset:34816
M v[64:67], a[168:171], a[32:35], v[64:67]
buffer_load_dwordx4 v8, s[12:15], s24 offen offset:2048 lds
M v[64:67], a[172:175], a[36:39], v[64:67]
ds_read_b128 a[184:187], v10 offset:6144
ds_read_b128 a[188:191], v11 offset:6144
M v[68:71], a[172:175], a[44:47], v[68:71]
M v[68:71], a[168:171], a[40:43], v[68:71]
ds_read_b64_tr_b16 a[128:129], v16 offset:32768
ds_read_b64_tr_b16 a[130:131], v16 offset:34816
M v[72:75], a[168:171], a[48:51], v[72:75]
M v[72:75], a[172:175], a[52:55], v[72:75]
M v[76:79], a[172:175], a[60:63], v[76:79]
M v[76:79], a[168:171], a[56:59], v[76:79]
ds_read_b64_tr_b16 a[136:137], v17 offset:32768
ds_read_b64_tr_b16 a[138:139], v17 offset:34816
M v[80:83], a[168:171], a[64:67], v[80:83]
buffer_load_dwordx4 v9, s[12:15], s24 offen offset:3072 lds
M v[80:83], a[172:175], a[68:71], v[80:83]
M v[84:87], a[172:175], a[76:79], v[84:87]
M v[84:87], a[168:171], a[72:75], v[84:87]
ds_read_b64_tr_b16 a[144:145], v18 offset:32768
ds_read_b64_tr_b16 a[146:147], v18 offset:34816
M v[88:91], a[168:171], a[80:83], v[88:91]
M v[88:91], a[172:175], a[84:87], v[88:91]
M v[92:95], a[172:175], a[92:95], v[92:95]
s_add_u32 s24, s24, 262144
M v[92:95], a[168:171], a[88:91], v[92:95]
s_waitcnt lgkmcnt(15)
ds_read_b64_tr_b16 a[152:153], v19 offset:32768
ds_read_b64_tr_b16 a[154:155], v19 offset:34816
M v[96:99], a[176:179], a[32:35], v[96:99]
M v[96:99], a[180:183], a[36:39], v[96:99]
M v[100:103], a[180:183], a[44:47], v[100:103]
M v[100:103], a[176:179], a[40:43], v[100:103]
M v[104:107], a[176:179], a[48:51], v[104:107]
s_add_u32 s94, s93, 8192
buffer_store_dwordx4 a[244:247], v1, s[16:19], s94 offen offset:1024 sc1
M v[104:107], a[180:183], a[52:55], v[104:107]
M v[108:111], a[180:183], a[60:63], v[108:111]
M v[108:111], a[176:179], a[56:59], v[108:111]
s_waitcnt vmcnt(11) lgkmcnt(0)
s_barrier
ds_read_b128 a[160:163], v10 offset:16384
ds_read_b128 a[164:167], v11 offset:16384
M v[112:115], a[176:179], a[64:67], v[112:115]
s_add_u32 m0, s29, 49152
s_add_u32 s3, s23, s31
buffer_load_dwordx4 v2, s[8:11], s3 offen offset:0 lds
M v[112:115], a[180:183], a[68:71], v[112:115]
M v[116:119], a[180:183], a[76:79], v[116:119]
M v[116:119], a[176:179], a[72:75], v[116:119]
ds_read_b64_tr_b16 a[100:101], v12 offset:49152
ds_read_b64_tr_b16 a[102:103], v12 offset:51200
M v[120:123], a[176:179], a[80:83], v[120:123]
M v[120:123], a[180:183], a[84:87], v[120:123]
buffer_load_dwordx4 v3, s[8:11], s3 offen offset:1024 lds
M v[124:127], a[180:183], a[92:95], v[124:127]
M v[124:127], a[176:179], a[88:91], v[124:127]
M v[128:131], a[184:187], a[32:35], v[128:131]
M v[128:131], a[188:191], a[36:39], v[128:131]
ds_read_b128 a[168:171], v10 offset:18432
ds_read_b128 a[172:175], v11 offset:18432
ds_read_b64_tr_b16 a[108:109], v13 offset:49152
ds_read_b64_tr_b16 a[110:111], v13 offset:51200
M v[132:135], a[188:191], a[44:47], v[132:135]
M v[132:135], a[184:187], a[40:43], v[132:135]
M v[136:139], a[184:187], a[48:51], v[136:139]
buffer_load_dwordx4 v4, s[8:11], s3 offen offset:2048 lds
M v[136:139], a[188:191], a[52:55], v[136:139]
M v[140:143], a[188:191], a[60:63], v[140:143]
M v[140:143], a[184:187], a[56:59], v[140:143]
ds_read_b64_tr_b16 a[116:117], v14 offset:49152
ds_read_b64_tr_b16 a[118:119], v14 offset:51200
M v[144:147], a[184:187], a[64:67], v[144:147]
M v[144:147], a[188:191], a[68:71], v[144:147]
buffer_load_dwordx4 v5, s[8:11], s3 offen offset:3072 lds
M v[148:151], a[188:191], a[76:79], v[148:151]
M v[148:151], a[184:187], a[72:75], v[148:151]
M v[152:155], a[184:187], a[80:83], v[152:155]
M v[152:155], a[188:191], a[84:87], v[152:155]
ds_read_b64_tr_b16 a[124:125], v15 offset:49152
ds_read_b64_tr_b16 a[126:127], v15 offset:51200
M v[156:159], a[188:191], a[92:95], v[156:159]
M v[156:159], a[184:187], a[88:91], v[156:159]
s_waitcnt lgkmcnt(10)
M v[160:163], a[160:163], a[32:35], v[160:163]
s_add_u32 s94, s93, 8192
buffer_store_dwordx4 a[248:251], v1, s[16:19], s94 offen offset:2048 sc1
M v[160:163], a[164:167], a[36:39], v[160:163]
ds_read_b128 a[176:179], v10 offset:20480
ds_read_b128 a[180:183], v11 offset:20480
M v[164:167], a[164:167], a[44:47], v[164:167]
s_add_u32 s23, s23, 128
s_cmp_eq_u32 s23, s25
s_cselect_b32 s23, s26, s23
M v[164:167], a[160:163], a[40:43], v[164:167]
ds_read_b64_tr_b16 a[132:133], v16 offset:49152
ds_read_b64_tr_b16 a[134:135], v16 offset:51200
M v[168:171], a[160:163], a[48:51], v[168:171]
M v[168:171], a[164:167], a[52:55], v[168:171]
M v[172:175], a[164:167], a[60:63], v[172:175]
M v[172:175], a[160:163], a[56:59], v[172:175]
M v[176:179], a[160:163], a[64:67], v[176:179]
s_add_u32 m0, s29, 81920
s_nop 0
buffer_load_dwordx4 v6, s[12:15], s24 offen offset:0 lds
M v[176:179], a[164:167], a[68:71], v[176:179]
ds_read_b64_tr_b16 a[140:141], v17 offset:49152
ds_read_b64_tr_b16 a[142:143], v17 offset:51200
M v[180:183], a[164:167], a[76:79], v[180:183]
M v[180:183], a[160:163], a[72:75], v[180:183]
M v[184:187], a[160:163], a[80:83], v[184:187]
M v[184:187], a[164:167], a[84:87], v[184:187]
buffer_load_dwordx4 v7, s[12:15], s24 offen offset:1024 lds
M v[188:191], a[164:167], a[92:95], v[188:191]
M v[188:191], a[160:163], a[88:91], v[188:191]
s_waitcnt lgkmcnt(12)
ds_read_b64_tr_b16 a[148:149], v18 offset:49152
ds_read_b64_tr_b16 a[150:151], v18 offset:51200
M v[192:195], a[168:171], a[32:35], v[192:195]
M v[192:195], a[172:175], a[36:39], v[192:195]
ds_read_b128 a[184:187], v10 offset:22528
ds_read_b128 a[188:191], v11 offset:22528
M v[196:199], a[172:175], a[44:47], v[196:199]
M v[196:199], a[168:171], a[40:43], v[196:199]
M v[200:203], a[168:171], a[48:51], v[200:203]
buffer_load_dwordx4 v8, s[12:15], s24 offen offset:2048 lds
M v[200:203], a[172:175], a[52:55], v[200:203]
ds_read_b64_tr_b16 a[156:157], v19 offset:49152
ds_read_b64_tr_b16 a[158:159], v19 offset:51200
M v[204:207], a[172:175], a[60:63], v[204:207]
M v[204:207], a[168:171], a[56:59], v[204:207]
M v[208:211], a[168:171], a[64:67], v[208:211]
M v[208:211], a[172:175], a[68:71], v[208:211]
buffer_load_dwordx4 v9, s[12:15], s24 offen offset:3072 lds
M v[212:215], a[172:175], a[76:79], v[212:215]
M v[212:215], a[168:171], a[72:75], v[212:215]
M v[216:219], a[168:171], a[80:83], v[216:219]
s_add_u32 s94, s93, 8192
buffer_store_dwordx4 a[252:255], v1, s[16:19], s94 offen offset:3072 sc1
M v[216:219], a[172:175], a[84:87], v[216:219]
M v[220:223], a[172:175], a[92:95], v[220:223]
M v[220:223], a[168:171], a[88:91], v[220:223]
s_waitcnt lgkmcnt(10)
M v[224:227], a[176:179], a[32:35], v[224:227]
s_add_u32 s24, s24, 262144
s_cmp_eq_u32 s24, s27
s_cselect_b32 s24, s28, s24
s_sub_u32 s6, s6, 1
s_cmp_eq_u32 s6, 0
s_cselect_b64 s[12:13], s[64:65], s[12:13]
M v[224:227], a[180:183], a[36:39], v[224:227]
M v[228:231], a[180:183], a[44:47], v[228:231]
M v[228:231], a[176:179], a[40:43], v[228:231]
M v[232:235], a[176:179], a[48:51], v[232:235]
M v[232:235], a[180:183], a[52:55], v[232:235]
M v[236:239], a[180:183], a[60:63], v[236:239]
M v[236:239], a[176:179], a[56:59], v[236:239]
s_waitcnt vmcnt(11) lgkmcnt(0)
s_barrier
ds_read_b128 a[160:163], v10 offset:32768
ds_read_b128 a[164:167], v11 offset:32768
M v[240:243], a[176:179], a[64:67], v[240:243]
s_add_u32 m0, s29, 0
s_nop 0
buffer_load_dwordx4 v2, s[8:11], s23 offen offset:0 lds
M v[240:243], a[180:183], a[68:71], v[240:243]
M v[244:247], a[180:183], a[76:79], v[244:247]
M v[244:247], a[176:179], a[72:75], v[244:247]
M v[248:251], a[176:179], a[80:83], v[248:251]
M v[248:251], a[180:183], a[84:87], v[248:251]
buffer_load_dwordx4 v3, s[8:11], s23 offen offset:1024 lds
M v[252:255], a[180:183], a[92:95], v[252:255]
M v[252:255], a[176:179], a[88:91], v[252:255]
M a[0:3], a[184:187], a[32:35], a[0:3]
M a[0:3], a[188:191], a[36:39], a[0:3]
ds_read_b128 a[168:171], v10 offset:34816
ds_read_b128 a[172:175], v11 offset:34816
M a[4:7], a[188:191], a[44:47], a[4:7]
M a[4:7], a[184:187], a[40:43], a[4:7]
M a[8:11], a[184:187], a[48:51], a[8:11]
buffer_load_dwordx4 v4, s[8:11], s23 offen offset:2048 lds
M a[8:11], a[188:191], a[52:55], a[8:11]
M a[12:15], a[188:191], a[60:63], a[12:15]
M a[12:15], a[184:187], a[56:59], a[12:15]
M a[16:19], a[184:187], a[64:67], a[16:19]
M a[16:19], a[188:191], a[68:71], a[16:19]
buffer_load_dwordx4 v5, s[8:11], s23 offen offset:3072 lds
M a[20:23], a[188:191], a[76:79], a[20:23]
M a[20:23], a[184:187], a[72:75], a[20:23]
M a[24:27], a[184:187], a[80:83], a[24:27]
M a[24:27], a[188:191], a[84:87], a[24:27]
M a[28:31], a[188:191], a[92:95], a[28:31]
M a[28:31], a[184:187], a[88:91], a[28:31]
s_waitcnt lgkmcnt(2)
M v[32:35], a[160:163], a[96:99], v[32:35]
s_add_u32 m0, s29, 98304
s_nop 0
buffer_load_dwordx4 v6, s[12:15], s24 offen offset:0 lds
M v[32:35], a[164:167], a[100:103], v[32:35]
ds_read_b128 a[176:179], v10 offset:36864
ds_read_b128 a[180:183], v11 offset:36864
M v[36:39], a[164:167], a[108:111], v[36:39]
M v[36:39], a[160:163], a[104:107], v[36:39]
ds_read_b64_tr_b16 a[32:33], v12 offset:0
ds_read_b64_tr_b16 a[34:35], v12 offset:2048
M v[40:43], a[160:163], a[112:115], v[40:43]
M v[40:43], a[164:167], a[116:119], v[40:43]
M v[44:47], a[164:167], a[124:127], v[44:47]
M v[44:47], a[160:163], a[120:123], v[44:47]
ds_read_b64_tr_b16 a[40:41], v13 offset:0
ds_read_b64_tr_b16 a[42:43], v13 offset:2048
M v[48:51], a[160:163], a[128:131], v[48:51]
buffer_load_dwordx4 v7, s[12:15], s24 offen offset:1024 lds
M v[48:51], a[164:167], a[132:135], v[48:51]
M v[52:55], a[164:167], a[140:143], v[52:55]
M v[52:55], a[160:163], a[136:139], v[52:55]
ds_read_b64_tr_b16 a[48:49], v14 offset:0
ds_read_b64_tr_b16 a[50:51], v14 offset:2048
M v[56:59], a[160:163], a[144:147], v[56:59]
M v[56:59], a[164:167], a[148:151], v[56:59]
M v[60:63], a[164:167], a[156:159], v[60:63]
buffer_load_dwordx4 v8, s[12:15], s24 offen offset:2048 lds
M v[60:63], a[160:163], a[152:155], v[60:63]
s_waitcnt lgkmcnt(8)
ds_read_b64_tr_b16 a[56:57], v15 offset:0
ds_read_b64_tr_b16 a[58:59], v15 offset:2048
M v[64:67], a[168:171], a[96:99], v[64:67]
M v[64:67], a[172:175], a[100:103], v[64:67]
ds_read_b128 a[184:187], v10 offset:38912
ds_read_b128 a[188:191], v11 offset:38912
M v[68:71], a[172:175], a[108:111], v[68:71]
M v[68:71], a[168:171], a[104:107], v[68:71]
ds_read_b64_tr_b16 a[64:65], v16 offset:0
ds_read_b64_tr_b16 a[66:67], v16 offset:2048
M v[72:75], a[168:171], a[112:115], v[72:75]
M v[72:75], a[172:175], a[116:119], v[72:75]
M v[76:79], a[172:175], a[124:127], v[76:79]
M v[76:79], a[168:171], a[120:123], v[76:79]
ds_read_b64_tr_b16 a[72:73], v17 offset:0
ds_read_b64_tr_b16 a[74:75], v17 offset:2048
M v[80:83], a[168:171], a[128:131], v[80:83]
buffer_load_dwordx4 v9, s[12:15], s24 offen offset:3072 lds
M v[80:83], a[172:175], a[132:135], v[80:83]
M v[84:87], a[172:175], a[140:143], v[84:87]
M v[84:87], a[168:171], a[136:139], v[84:87]
ds_read_b64_tr_b16 a[80:81], v18 offset:0
ds_read_b64_tr_b16 a[82:83], v18 offset:2048
M v[88:91], a[168:171], a[144:147], v[88:91]
M v[88:91], a[172:175], a[148:151], v[88:91]
M v[92:95], a[172:175], a[156:159], v[92:95]
s_add_u32 s24, s24, 262144
M v[92:95], a[168:171], a[152:155], v[92:95]
s_waitcnt lgkmcnt(15)
ds_read_b64_tr_b16 a[88:89], v19 offset:0
ds_read_b64_tr_b16 a[90:91], v19 offset:2048
M v[96:99], a[176:179], a[96:99], v[96:99]
M v[96:99], a[180:183], a[100:103], v[96:99]
M v[100:103], a[180:183], a[108:111], v[100:103]
M v[100:103], a[176:179], a[104:107], v[100:103]
M v[104:107], a[176:179], a[112:115], v[104:107]
M v[104:107], a[180:183], a[116:119], v[104:107]
M v[108:111], a[180:183], a[124:127], v[108:111]
M v[108:111], a[176:179], a[120:123], v[108:111]
s_waitcnt vmcnt(9) lgkmcnt(0)
s_barrier
ds_read_b128 a[160:163], v10 offset:49152
ds_read_b128 a[164:167], v11 offset:49152
M v[112:115], a[176:179], a[128:131], v[112:115]
s_add_u32 m0, s29, 16384
s_add_u32 s3, s23, s31
buffer_load_dwordx4 v2, s[8:11], s3 offen offset:0 lds
M v[112:115], a[180:183], a[132:135], v[112:115]
M v[116:119], a[180:183], a[140:143], v[116:119]
M v[116:119], a[176:179], a[136:139], v[116:119]
ds_read_b64_tr_b16 a[36:37], v12 offset:16384
ds_read_b64_tr_b16 a[38:39], v12 offset:18432
M v[120:123], a[176:179], a[144:147], v[120:123]
M v[120:123], a[180:183], a[148:151], v[120:123]
buffer_load_dwordx4 v3, s[8:11], s3 offen offset:1024 lds
M v[124:127], a[180:183], a[156:159], v[124:127]
M v[124:127], a[176:179], a[152:155], v[124:127]
M v[128:131], a[184:187], a[96:99], v[128:131]
M v[128:131], a[188:191], a[100:103], v[128:131]
ds_read_b128 a[168:171], v10 offset:51200
ds_read_b128 a[172:175], v11 offset:51200
ds_read_b64_tr_b16 a[44:45], v13 offset:16384
ds_read_b64_tr_b16 a[46:47], v13 offset:18432
M v[132:135], a[188:191], a[108:111], v[132:135]
M v[132:135], a[184:187], a[104:107], v[132:135]
M v[136:139], a[184:187], a[112:115], v[136:139]
buffer_load_dwordx4 v4, s[8:11], s3 offen offset:2048 lds
M v[136:139], a[188:191], a[116:119], v[136:139]
M v[140:143], a[188:191], a[124:127], v[140:143]
M v[140:143], a[184:187], a[120:123], v[140:143]
ds_read_b64_tr_b16 a[52:53], v14 offset:16384
ds_read_b64_tr_b16 a[54:55], v14 offset:18432
M v[144:147], a[184:187], a[128:131], v[144:147]
M v[144:147], a[188:191], a[132:135], v[144:147]
M v[148:151], a[188:191], a[140:143], v[148:151]
buffer_load_dwordx4 v5, s[8:11], s3 offen offset:3072 lds
M v[148:151], a[184:187], a[136:139], v[148:151]
M v[152:155], a[184:187], a[144:147], v[152:155]
M v[152:155], a[188:191], a[148:151], v[152:155]
ds_read_b64_tr_b16 a[60:61], v15 offset:16384
ds_read_b64_tr_b16 a[62:63], v15 offset:18432
M v[156:159], a[188:191], a[156:159], v[156:159]
M v[156:159], a[184:187], a[152:155], v[156:159]
s_waitcnt lgkmcnt(10)
M v[160:163], a[160:163], a[96:99], v[160:163]
M v[160:163], a[164:167], a[100:103], v[160:163]
ds_read_b128 a[176:179], v10 offset:53248
ds_read_b128 a[180:183], v11 offset:53248
M v[164:167], a[164:167], a[108:111], v[164:167]
s_add_u32 s23, s23, 128
s_cmp_eq_u32 s23, s25
s_cselect_b32 s23, s26, s23
M v[164:167], a[160:163], a[104:107], v[164:167]
ds_read_b64_tr_b16 a[68:69], v16 offset:16384
ds_read_b64_tr_b16 a[70:71], v16 offset:18432
M v[168:171], a[160:163], a[112:115], v[168:171]
M v[168:171], a[164:167], a[116:119], v[168:171]
M v[172:175], a[164:167], a[124:127], v[172:175]
M v[172:175], a[160:163], a[120:123], v[172:175]
M v[176:179], a[160:163], a[128:131], v[176:179]
s_add_u32 m0, s29, 114688
s_nop 0
buffer_load_dwordx4 v6, s[12:15], s24 offen offset:0 lds
M v[176:179], a[164:167], a[132:135], v[176:179]
ds_read_b64_tr_b16 a[76:77], v17 offset:16384
ds_read_b64_tr_b16 a[78:79], v17 offset:18432
M v[180:183], a[164:167], a[140:143], v[180:183]
M v[180:183], a[160:163], a[136:139], v[180:183]
M v[184:187], a[160:163], a[144:147], v[184:187]
M v[184:187], a[164:167], a[148:151], v[184:187]
buffer_load_dwordx4 v7, s[12:15], s24 offen offset:1024 lds
M v[188:191], a[164:167], a[156:159], v[188:191]
M v[188:191], a[160:163], a[152:155], v[188:191]
s_waitcnt lgkmcnt(12)
ds_read_b64_tr_b16 a[84:85], v18 offset:16384
ds_read_b64_tr_b16 a[86:87], v18 offset:18432
M v[192:195], a[168:171], a[96:99], v[192:195]
M v[192:195], a[172:175], a[100:103], v[192:195]
ds_read_b128 a[184:187], v10 offset:55296
ds_read_b128 a[188:191], v11 offset:55296
M v[196:199], a[172:175], a[108:111], v[196:199]
M v[196:199], a[168:171], a[104:107], v[196:199]
M v[200:203], a[168:171], a[112:115], v[200:203]
buffer_load_dwordx4 v8, s[12:15], s24 offen offset:2048 lds
M v[200:203], a[172:175], a[116:119], v[200:203]
ds_read_b64_tr_b16 a[92:93], v19 offset:16384
ds_read_b64_tr_b16 a[94:95], v19 offset:18432
M v[204:207], a[172:175], a[124:127], v[204:207]
M v[204:207], a[168:171], a[120:123], v[204:207]
M v[208:211], a[168:171], a[128:131], v[208:211]
M v[208:211], a[172:175], a[132:135], v[208:211]
M v[212:215], a[172:175], a[140:143], v[212:215]
buffer_load_dwordx4 v9, s[12:15], s24 offen offset:3072 lds
M v[212:215], a[168:171], a[136:139], v[212:215]
M v[216:219], a[168:171], a[144:147], v[216:219]
M v[216:219], a[172:175], a[148:151], v[216:219]
M v[220:223], a[172:175], a[156:159], v[220:223]
M v[220:223], a[168:171], a[152:155], v[220:223]
s_waitcnt lgkmcnt(10)
M v[224:227], a[176:179], a[96:99], v[224:227]
s_add_u32 s24, s24, 262144
s_cmp_eq_u32 s24, s27
s_cselect_b32 s24, s28, s24
s_sub_u32 s6, s6, 1
s_cmp_eq_u32 s6, 0
s_cselect_b64 s[12:13], s[64:65], s[12:13]
M v[224:227], a[180:183], a[100:103], v[224:227]
M v[228:231], a[180:183], a[108:111], v[228:231]
M v[228:231], a[176:179], a[104:107], v[228:231]
M v[232:235], a[176:179], a[112:115], v[232:235]
M v[232:235], a[180:183], a[116:119], v[232:235]
M v[236:239], a[180:183], a[124:127], v[236:239]
M v[236:239], a[176:179], a[120:123], v[236:239]
s_waitcnt vmcnt(8) lgkmcnt(0)
s_barrier
ds_read_b128 a[160:163], v10 offset:0
ds_read_b128 a[164:167], v11 offset:0
M v[240:243], a[176:179], a[128:131], v[240:243]
s_add_u32 m0, s29, 32768
s_nop 0
buffer_load_dwordx4 v2, s[8:11], s23 offen offset:0 lds
M v[240:243], a[180:183], a[132:135], v[240:243]
M v[244:247], a[180:183], a[140:143], v[244:247]
M v[244:247], a[176:179], a[136:139], v[244:247]
M v[248:251], a[176:179], a[144:147], v[248:251]
M v[248:251], a[180:183], a[148:151], v[248:251]
M v[252:255], a[180:183], a[156:159], v[252:255]
M v[252:255], a[176:179], a[152:155], v[252:255]
M a[0:3], a[184:187], a[96:99], a[0:3]
M a[0:3], a[188:191], a[100:103], a[0:3]
ds_read_b128 a[168:171], v10 offset:2048
ds_read_b128 a[172:175], v11 offset:2048
M a[4:7], a[188:191], a[108:111], a[4:7]
M a[4:7], a[184:187], a[104:107], a[4:7]
M a[8:11], a[184:187], a[112:115], a[8:11]
buffer_load_dwordx4 v3, s[8:11], s23 offen offset:1024 lds
M a[8:11], a[188:191], a[116:119], a[8:11]
M a[12:15], a[188:191], a[124:127], a[12:15]
M a[12:15], a[184:187], a[120:123], a[12:15]
M a[16:19], a[184:187], a[128:131], a[16:19]
M a[16:19], a[188:191], a[132:135], a[16:19]
M a[20:23], a[188:191], a[140:143], a[20:23]
M a[20:23], a[184:187], a[136:139], a[20:23]
M a[24:27], a[184:187], a[144:147], a[24:27]
M a[24:27], a[188:191], a[148:151], a[24:27]
M a[28:31], a[188:191], a[156:159], a[28:31]
M a[28:31], a[184:187], a[152:155], a[28:31]
s_waitcnt lgkmcnt(2)
M v[32:35], a[160:163], a[32:35], v[32:35]
buffer_load_dwordx4 v4, s[8:11], s23 offen offset:2048 lds
M v[32:35], a[164:167], a[36:39], v[32:35]
ds_read_b128 a[176:179], v10 offset:4096
ds_read_b128 a[180:183], v11 offset:4096
M v[36:39], a[164:167], a[44:47], v[36:39]
M v[36:39], a[160:163], a[40:43], v[36:39]
ds_read_b64_tr_b16 a[96:97], v12 offset:32768
ds_read_b64_tr_b16 a[98:99], v12 offset:34816
M v[40:43], a[160:163], a[48:51], v[40:43]
M v[40:43], a[164:167], a[52:55], v[40:43]
M v[44:47], a[164:167], a[60:63], v[44:47]
M v[44:47], a[160:163], a[56:59], v[44:47]
ds_read_b64_tr_b16 a[104:105], v13 offset:32768
ds_read_b64_tr_b16 a[106:107], v13 offset:34816
M v[48:51], a[160:163], a[64:67], v[48:51]
M v[48:51], a[164:167], a[68:71], v[48:51]
M v[52:55], a[164:167], a[76:79], v[52:55]
M v[52:55], a[160:163], a[72:75], v[52:55]
ds_read_b64_tr_b16 a[112:113], v14 offset:32768
ds_read_b64_tr_b16 a[114:115], v14 offset:34816
M v[56:59], a[160:163], a[80:83], v[56:59]
M v[56:59], a[164:167], a[84:87], v[56:59]
M v[60:63], a[164:167], a[92:95], v[60:63]
M v[60:63], a[160:163], a[88:91], v[60:63]
s_waitcnt lgkmcnt(8)
ds_read_b64_tr_b16 a[120:121], v15 offset:32768
ds_read_b64_tr_b16 a[122:123], v15 offset:34816
M v[64:67], a[168:171], a[32:35], v[64:67]
M v[64:67], a[172:175], a[36:39], v[64:67]
ds_read_b128 a[184:187], v10 offset:6144
ds_read_b128 a[188:191], v11 offset:6144
M v[68:71], a[172:175], a[44:47], v[68:71]
M v[68:71], a[168:171], a[40:43], v[68:71]
ds_read_b64_tr_b16 a[128:129], v16 offset:32768
ds_read_b64_tr_b16 a[130:131], v16 offset:34816
M v[72:75], a[168:171], a[48:51], v[72:75]
buffer_load_dwordx4 v5, s[8:11], s23 offen offset:3072 lds
M v[72:75], a[172:175], a[52:55], v[72:75]
M v[76:79], a[172:175], a[60:63], v[76:79]
M v[76:79], a[168:171], a[56:59], v[76:79]
ds_read_b64_tr_b16 a[136:137], v17 offset:32768
ds_read_b64_tr_b16 a[138:139], v17 offset:34816
M v[80:83], a[168:171], a[64:67], v[80:83]
M v[80:83], a[172:175], a[68:71], v[80:83]
M v[84:87], a[172:175], a[76:79], v[84:87]
M v[84:87], a[168:171], a[72:75], v[84:87]
ds_read_b64_tr_b16 a[144:145], v18 offset:32768
ds_read_b64_tr_b16 a[146:147], v18 offset:34816
M v[88:91], a[168:171], a[80:83], v[88:91]
M v[88:91], a[172:175], a[84:87], v[88:91]
M v[92:95], a[172:175], a[92:95], v[92:95]
M v[92:95], a[168:171], a[88:91], v[92:95]
s_waitcnt lgkmcnt(15)
ds_read_b64_tr_b16 a[152:153], v19 offset:32768
ds_read_b64_tr_b16 a[154:155], v19 offset:34816
M v[96:99], a[176:179], a[32:35], v[96:99]
M v[96:99], a[180:183], a[36:39], v[96:99]
M v[100:103], a[180:183], a[44:47], v[100:103]
M v[100:103], a[176:179], a[40:43], v[100:103]
M v[104:107], a[176:179], a[48:51], v[104:107]
M v[104:107], a[180:183], a[52:55], v[104:107]
M v[108:111], a[180:183], a[60:63], v[108:111]
M v[108:111], a[176:179], a[56:59], v[108:111]
s_waitcnt vmcnt(4) lgkmcnt(0)
s_barrier
ds_read_b128 a[160:163], v10 offset:16384
ds_read_b128 a[164:167], v11 offset:16384
M v[112:115], a[176:179], a[64:67], v[112:115]
s_add_u32 m0, s29, 49152
s_add_u32 s3, s23, s31
buffer_load_dwordx4 v2, s[8:11], s3 offen offset:0 lds
M v[112:115], a[180:183], a[68:71], v[112:115]
M v[116:119], a[180:183], a[76:79], v[116:119]
buffer_load_dwordx4 v3, s[8:11], s3 offen offset:1024 lds
M v[116:119], a[176:179], a[72:75], v[116:119]
ds_read_b64_tr_b16 a[100:101], v12 offset:49152
ds_read_b64_tr_b16 a[102:103], v12 offset:51200
M v[120:123], a[176:179], a[80:83], v[120:123]
buffer_load_dwordx4 v4, s[8:11], s3 offen offset:2048 lds
M v[120:123], a[180:183], a[84:87], v[120:123]
M v[124:127], a[180:183], a[92:95], v[124:127]
buffer_load_dwordx4 v5, s[8:11], s3 offen offset:3072 lds
M v[124:127], a[176:179], a[88:91], v[124:127]
M v[128:131], a[184:187], a[32:35], v[128:131]
M v[128:131], a[188:191], a[36:39], v[128:131]
ds_read_b128 a[168:171], v10 offset:18432
ds_read_b128 a[172:175], v11 offset:18432
ds_read_b64_tr_b16 a[108:109], v13 offset:49152
ds_read_b64_tr_b16 a[110:111], v13 offset:51200
M v[132:135], a[188:191], a[44:47], v[132:135]
M v[132:135], a[184:187], a[40:43], v[132:135]
M v[136:139], a[184:187], a[48:51], v[136:139]
s_and_b32 s3, s2, 1
s_lshl_b32 s3, s3, 3
s_bfe_u32 s4, s2, 0x30003
s_add_u32 s26, s3, s4
M v[136:139], a[188:191], a[52:55], v[136:139]
s_bfe_u32 s3, s2, 0x20001
s_lshl_b32 s3, s3, 2
s_lshr_b32 s4, s2, 6
M v[140:143], a[188:191], a[60:63], v[140:143]
s_xor_b32 s4, s4, 2
s_add_u32 s27, s3, s4
s_lshl_b32 s23, s26, 18
M v[140:143], a[184:187], a[56:59], v[140:143]
ds_read_b64_tr_b16 a[116:117], v14 offset:49152
ds_read_b64_tr_b16 a[118:119], v14 offset:51200
s_sub_u32 s24, s23, 32768
s_max_i32 s24, s24, 0
s_lshl_b32 s25, s27, 7
s_add_u32 s3, s26, s27
M v[144:147], a[184:187], a[64:67], v[144:147]
s_and_b32 s3, s3, 0
s_mul_i32 s3, s3, 16
s_sub_u32 s31, 16, s3
M v[144:147], a[188:191], a[68:71], v[144:147]
s_mov_b32 s54, s31
s_movk_i32 s57, 128
s_mov_b32 s55, 4289069056
M v[148:151], a[188:191], a[76:79], v[148:151]
s_mov_b32 s56, 393216
s_lshl_b32 s4, s3, 7
s_add_u32 s23, s23, s4
M v[148:151], a[184:187], a[72:75], v[148:151]
s_add_u32 s24, s24, s4
s_mul_i32 s4, s3, 393216
s_add_u32 s25, s25, s4
s_mov_b64 s[8:9], s[44:45]
M v[152:155], a[184:187], a[80:83], v[152:155]
s_mov_b32 s10, 4194304
s_mov_b64 s[12:13], s[46:47]
s_mov_b32 s14, 6291456
M v[152:155], a[188:191], a[84:87], v[152:155]
ds_read_b64_tr_b16 a[124:125], v15 offset:49152
ds_read_b64_tr_b16 a[126:127], v15 offset:51200
s_mov_b64 s[36:37], s[90:91]
s_mov_b32 s38, 256
s_mov_b32 s39, 0x00020000
M v[156:159], a[188:191], a[92:95], v[156:159]
s_lshl_b32 s28, s20, 9
s_mul_i32 s30, s20, 6144
s_lshl_b32 s3, s20, 5
M v[156:159], a[184:187], a[88:91], v[156:159]
s_waitcnt lgkmcnt(10)
v_lshrrev_b32 v24, 3, v0
v_and_b32 v25, 7, v0
v_add_u32 v28, s3, v24
v_add_u32 v26, 0, v28
M v[160:163], a[160:163], a[32:35], v[160:163]
v_bfe_u32 v27, v26, 1, 3
v_xor_b32 v27, v27, v25
v_lshlrev_b32 v26, 11, v26
M v[160:163], a[164:167], a[36:39], v[160:163]
ds_read_b128 a[176:179], v10 offset:20480
ds_read_b128 a[180:183], v11 offset:20480
v_lshl_add_u32 v26, v27, 4, v26
v_subrev_u32 v2, 0, v26
v_add_u32 v26, 8, v28
M v[164:167], a[164:167], a[44:47], v[164:167]
v_bfe_u32 v27, v26, 1, 3
v_xor_b32 v27, v27, v25
v_lshlrev_b32 v26, 11, v26
v_lshl_add_u32 v26, v27, 4, v26
M v[164:167], a[160:163], a[40:43], v[164:167]
ds_read_b64_tr_b16 a[132:133], v16 offset:49152
ds_read_b64_tr_b16 a[134:135], v16 offset:51200
v_subrev_u32 v3, 1024, v26
v_add_u32 v26, 16, v28
v_bfe_u32 v27, v26, 1, 3
M v[168:171], a[160:163], a[48:51], v[168:171]
v_xor_b32 v27, v27, v25
v_lshlrev_b32 v26, 11, v26
v_lshl_add_u32 v26, v27, 4, v26
M v[168:171], a[164:167], a[52:55], v[168:171]
v_subrev_u32 v4, 2048, v26
v_add_u32 v26, 24, v28
v_bfe_u32 v27, v26, 1, 3
M v[172:175], a[164:167], a[60:63], v[172:175]
v_xor_b32 v27, v27, v25
v_lshlrev_b32 v26, 11, v26
v_lshl_add_u32 v26, v27, 4, v26
v_subrev_u32 v5, 3072, v26
M v[172:175], a[160:163], a[56:59], v[172:175]
s_lshl_b32 s3, s20, 2
v_lshrrev_b32 v26, 5, v0
v_add_u32 v26, s3, v26
M v[176:179], a[160:163], a[64:67], v[176:179]
v_bfe_u32 v29, v0, 2, 3
v_bfe_u32 v27, v26, 1, 3
v_xor_b32 v27, v27, v29
M v[176:179], a[164:167], a[68:71], v[176:179]
ds_read_b64_tr_b16 a[140:141], v17 offset:49152
ds_read_b64_tr_b16 a[142:143], v17 offset:51200
v_lshlrev_b32 v27, 4, v27
v_and_b32 v30, 3, v0
v_lshl_add_u32 v27, v30, 2, v27
M v[180:183], a[164:167], a[76:79], v[180:183]
v_lshl_add_u32 v20, v26, 11, v27
v_add_u32 v26, 2, v26
v_bfe_u32 v27, v26, 1, 3
v_xor_b32 v27, v27, v29
M v[180:183], a[160:163], a[72:75], v[180:183]
v_lshlrev_b32 v27, 4, v27
v_and_b32 v30, 3, v0
v_lshl_add_u32 v27, v30, 2, v27
M v[184:187], a[160:163], a[80:83], v[184:187]
v_lshl_add_u32 v23, v26, 11, v27
v_subrev_u32 v23, 256, v23
s_mul_i32 s3, s20, 48
M v[184:187], a[164:167], a[84:87], v[184:187]
v_add_u32 v28, s3, v24
v_add_u32 v26, 0, v28
v_mul_u32_u24 v27, 0xaaab, v26
v_lshrrev_b32 v27, 17, v27
M v[188:191], a[164:167], a[92:95], v[188:191]
v_lshrrev_b32 v29, 1, v27
v_and_b32 v29, 4, v29
v_and_or_b32 v27, v27, 2, v29
M v[188:191], a[160:163], a[88:91], v[188:191]
s_waitcnt lgkmcnt(12)
ds_read_b64_tr_b16 a[148:149], v18 offset:49152
ds_read_b64_tr_b16 a[150:151], v18 offset:51200
v_xor_b32 v27, v27, v25
v_lshlrev_b32 v26, 11, v26
v_lshl_add_u32 v26, v27, 4, v26
M v[192:195], a[168:171], a[32:35], v[192:195]
v_subrev_u32 v6, 0, v26
v_add_u32 v26, 8, v28
v_mul_u32_u24 v27, 0xaaab, v26
M v[192:195], a[172:175], a[36:39], v[192:195]
ds_read_b128 a[184:187], v10 offset:22528
ds_read_b128 a[188:191], v11 offset:22528
v_lshrrev_b32 v27, 17, v27
v_lshrrev_b32 v29, 1, v27
v_and_b32 v29, 4, v29
v_and_or_b32 v27, v27, 2, v29
M v[196:199], a[172:175], a[44:47], v[196:199]
v_xor_b32 v27, v27, v25
v_lshlrev_b32 v26, 11, v26
v_lshl_add_u32 v26, v27, 4, v26
M v[196:199], a[168:171], a[40:43], v[196:199]
v_subrev_u32 v7, 1024, v26
v_add_u32 v26, 16, v28
v_mul_u32_u24 v27, 0xaaab, v26
M v[200:203], a[168:171], a[48:51], v[200:203]
v_lshrrev_b32 v27, 17, v27
v_lshrrev_b32 v29, 1, v27
v_and_b32 v29, 4, v29
M v[200:203], a[172:175], a[52:55], v[200:203]
ds_read_b64_tr_b16 a[156:157], v19 offset:49152
ds_read_b64_tr_b16 a[158:159], v19 offset:51200
v_and_or_b32 v27, v27, 2, v29
v_xor_b32 v27, v27, v25
v_lshlrev_b32 v26, 11, v26
v_lshl_add_u32 v26, v27, 4, v26
M v[204:207], a[172:175], a[60:63], v[204:207]
v_subrev_u32 v8, 2048, v26
v_add_u32 v26, 24, v28
v_mul_u32_u24 v27, 0xaaab, v26
M v[204:207], a[168:171], a[56:59], v[204:207]
v_lshrrev_b32 v27, 17, v27
v_lshrrev_b32 v29, 1, v27
v_and_b32 v29, 4, v29
M v[208:211], a[168:171], a[64:67], v[208:211]
v_and_or_b32 v27, v27, 2, v29
v_xor_b32 v27, v27, v25
v_lshlrev_b32 v26, 11, v26
v_lshl_add_u32 v26, v27, 4, v26
M v[208:211], a[172:175], a[68:71], v[208:211]
v_subrev_u32 v9, 3072, v26
v_add_u32 v26, 32, v28
v_mul_u32_u24 v27, 0xaaab, v26
M v[212:215], a[172:175], a[76:79], v[212:215]
v_lshrrev_b32 v27, 17, v27
v_lshrrev_b32 v29, 1, v27
v_and_b32 v29, 4, v29
M v[212:215], a[168:171], a[72:75], v[212:215]
v_and_or_b32 v27, v27, 2, v29
v_xor_b32 v27, v27, v25
v_lshlrev_b32 v26, 11, v26
M v[216:219], a[168:171], a[80:83], v[216:219]
v_lshl_add_u32 v26, v27, 4, v26
v_subrev_u32 v21, 0, v26
v_add_u32 v26, 40, v28
v_mul_u32_u24 v27, 0xaaab, v26
M v[216:219], a[172:175], a[84:87], v[216:219]
v_lshrrev_b32 v27, 17, v27
v_lshrrev_b32 v29, 1, v27
v_and_b32 v29, 4, v29
M v[220:223], a[172:175], a[92:95], v[220:223]
v_and_or_b32 v27, v27, 2, v29
v_xor_b32 v27, v27, v25
v_lshlrev_b32 v26, 11, v26
M v[220:223], a[168:171], a[88:91], v[220:223]
s_waitcnt lgkmcnt(10)
v_lshl_add_u32 v26, v27, 4, v26
v_subrev_u32 v22, 1024, v26
s_lshr_b32 s3, s53, 7
M v[224:227], a[176:179], a[32:35], v[224:227]
s_add_u32 s3, s3, s22
s_lshl_b32 s3, s3, 5
s_lshr_b32 s19, s52, 6
s_add_u32 s3, s3, s19
M v[224:227], a[180:183], a[36:39], v[224:227]
s_lshl_b32 s19, s21, 1
s_add_u32 s3, s3, s19
s_lshl_b32 s92, s3, 15
M v[228:231], a[180:183], a[44:47], v[228:231]
s_add_u32 s92, s92, 16384
s_add_u32 s93, s92, 32768
s_add_u32 s16, s50, 16777216
M v[228:231], a[176:179], a[40:43], v[228:231]
s_addc_u32 s17, s51, 0
s_mov_b32 s18, 33554432
s_mov_b32 s19, 0x00020000
M v[232:235], a[176:179], a[48:51], v[232:235]
M v[232:235], a[180:183], a[52:55], v[232:235]
M v[236:239], a[180:183], a[60:63], v[236:239]
M v[236:239], a[176:179], a[56:59], v[236:239]
s_waitcnt vmcnt(4) lgkmcnt(0)
s_barrier
ds_read_b128 a[160:163], v10 offset:32768
ds_read_b128 a[164:167], v11 offset:32768
M v[240:243], a[176:179], a[64:67], v[240:243]
s_add_u32 m0, s28, 131072
s_nop 0
buffer_load_dword v20, s[8:11], s24 offen lds
M v[240:243], a[180:183], a[68:71], v[240:243]
M v[244:247], a[180:183], a[76:79], v[244:247]
M v[244:247], a[176:179], a[72:75], v[244:247]
buffer_load_dword v23, s[8:11], s24 offen offset:256 lds
M v[248:251], a[176:179], a[80:83], v[248:251]
M v[248:251], a[180:183], a[84:87], v[248:251]
M v[252:255], a[180:183], a[92:95], v[252:255]
M v[252:255], a[176:179], a[88:91], v[252:255]
M a[0:3], a[184:187], a[32:35], a[0:3]
s_add_u32 m0, s29, 133120
s_nop 0
buffer_load_dwordx4 v2, s[8:11], s23 offen offset:0 lds
M a[0:3], a[188:191], a[36:39], a[0:3]
ds_read_b128 a[168:171], v10 offset:34816
ds_read_b128 a[172:175], v11 offset:34816
M a[4:7], a[188:191], a[44:47], a[4:7]
M a[4:7], a[184:187], a[40:43], a[4:7]
M a[8:11], a[184:187], a[48:51], a[8:11]
buffer_load_dwordx4 v3, s[8:11], s23 offen offset:1024 lds
M a[8:11], a[188:191], a[52:55], a[8:11]
M a[12:15], a[188:191], a[60:63], a[12:15]
M a[12:15], a[184:187], a[56:59], a[12:15]
M a[16:19], a[184:187], a[64:67], a[16:19]
buffer_load_dwordx4 v4, s[8:11], s23 offen offset:2048 lds
M a[16:19], a[188:191], a[68:71], a[16:19]
M a[20:23], a[188:191], a[76:79], a[20:23]
M a[20:23], a[184:187], a[72:75], a[20:23]
buffer_load_dwordx4 v5, s[8:11], s23 offen offset:3072 lds
M a[24:27], a[184:187], a[80:83], a[24:27]
M a[24:27], a[188:191], a[84:87], a[24:27]
M a[28:31], a[188:191], a[92:95], a[28:31]
M a[28:31], a[184:187], a[88:91], a[28:31]
s_waitcnt lgkmcnt(2)
M v[32:35], a[160:163], a[96:99], v[32:35]
s_sub_u32 s31, s31, 1
s_cmp_eq_u32 s31, 0
s_cselect_b32 s58, -1920, s57
s_add_u32 s23, s23, s58
s_add_u32 s24, s24, s58
M v[32:35], a[164:167], a[100:103], v[32:35]
ds_read_b128 a[176:179], v10 offset:36864
ds_read_b128 a[180:183], v11 offset:36864
M v[36:39], a[164:167], a[108:111], v[36:39]
M v[36:39], a[160:163], a[104:107], v[36:39]
M v[40:43], a[160:163], a[112:115], v[40:43]
M v[40:43], a[164:167], a[116:119], v[40:43]
s_add_u32 m0, s30, 65536
s_nop 0
buffer_load_dwordx4 v6, s[12:15], s25 offen offset:0 lds
M v[44:47], a[164:167], a[124:127], v[44:47]
M v[44:47], a[160:163], a[120:123], v[44:47]
M v[48:51], a[160:163], a[128:131], v[48:51]
M v[48:51], a[164:167], a[132:135], v[48:51]
buffer_load_dwordx4 v7, s[12:15], s25 offen offset:1024 lds
M v[52:55], a[164:167], a[140:143], v[52:55]
M v[52:55], a[160:163], a[136:139], v[52:55]
M v[56:59], a[160:163], a[144:147], v[56:59]
M v[56:59], a[164:167], a[148:151], v[56:59]
buffer_load_dwordx4 v8, s[12:15], s25 offen offset:2048 lds
M v[60:63], a[164:167], a[156:159], v[60:63]
M v[60:63], a[160:163], a[152:155], v[60:63]
s_waitcnt lgkmcnt(2)
M v[64:67], a[168:171], a[96:99], v[64:67]
M v[64:67], a[172:175], a[100:103], v[64:67]
ds_read_b128 a[184:187], v10 offset:38912
ds_read_b128 a[188:191], v11 offset:38912
M v[68:71], a[172:175], a[108:111], v[68:71]
M v[68:71], a[168:171], a[104:107], v[68:71]
buffer_load_dwordx4 v9, s[12:15], s25 offen offset:3072 lds
M v[72:75], a[168:171], a[112:115], v[72:75]
M v[72:75], a[172:175], a[116:119], v[72:75]
M v[76:79], a[172:175], a[124:127], v[76:79]
M v[76:79], a[168:171], a[120:123], v[76:79]
s_add_u32 m0, s30, 69632
s_nop 0
buffer_load_dwordx4 v21, s[12:15], s25 offen offset:0 lds
M v[80:83], a[168:171], a[128:131], v[80:83]
M v[80:83], a[172:175], a[132:135], v[80:83]
M v[84:87], a[172:175], a[140:143], v[84:87]
M v[84:87], a[168:171], a[136:139], v[84:87]
buffer_load_dwordx4 v22, s[12:15], s25 offen offset:1024 lds
M v[88:91], a[168:171], a[144:147], v[88:91]
M v[88:91], a[172:175], a[148:151], v[88:91]
M v[92:95], a[172:175], a[156:159], v[92:95]
M v[92:95], a[168:171], a[152:155], v[92:95]
s_waitcnt lgkmcnt(2)
M v[96:99], a[176:179], a[96:99], v[96:99]
s_sub_u32 s54, s54, 1
s_cmp_eq_u32 s54, 0
s_cselect_b32 s58, s55, s56
s_add_u32 s25, s25, s58
M v[96:99], a[180:183], a[100:103], v[96:99]
M v[100:103], a[180:183], a[108:111], v[100:103]
M v[100:103], a[176:179], a[104:107], v[100:103]
v_cvt_pk_bf16_f32 v32, v32, v33
v_cvt_pk_bf16_f32 v33, v34, v35
M v[104:107], a[176:179], a[112:115], v[104:107]
v_cvt_pk_bf16_f32 v34, v64, v65
v_cvt_pk_bf16_f32 v35, v66, v67
M v[104:107], a[180:183], a[116:119], v[104:107]
v_cvt_pk_bf16_f32 v64, v48, v49
M v[108:111], a[180:183], a[124:127], v[108:111]
v_cvt_pk_bf16_f32 v65, v50, v51
v_cvt_pk_bf16_f32 v66, v80, v81
M v[108:111], a[176:179], a[120:123], v[108:111]
s_waitcnt vmcnt(12) lgkmcnt(0)
s_barrier
ds_read_b128 a[160:163], v10 offset:49152
ds_read_b128 a[164:167], v11 offset:49152
v_cvt_pk_bf16_f32 v67, v82, v83
M v[112:115], a[176:179], a[128:131], v[112:115]
s_add_u32 m0, s28, 0
s_nop 0
buffer_load_dword v20, s[8:11], s24 offen lds
v_cvt_pk_bf16_f32 v48, v40, v41
v_cvt_pk_bf16_f32 v49, v42, v43
M v[112:115], a[180:183], a[132:135], v[112:115]
v_cvt_pk_bf16_f32 v50, v72, v73
v_cvt_pk_bf16_f32 v51, v74, v75
M v[116:119], a[180:183], a[140:143], v[116:119]
v_cvt_pk_bf16_f32 v80, v56, v57
M v[116:119], a[176:179], a[136:139], v[116:119]
buffer_load_dword v23, s[8:11], s24 offen offset:256 lds
v_cvt_pk_bf16_f32 v81, v58, v59
v_cvt_pk_bf16_f32 v82, v88, v89
M v[120:123], a[176:179], a[144:147], v[120:123]
v_cvt_pk_bf16_f32 v83, v90, v91
M v[120:123], a[180:183], a[148:151], v[120:123]
v_cvt_pk_bf16_f32 v40, v36, v37
v_cvt_pk_bf16_f32 v41, v38, v39
M v[124:127], a[180:183], a[156:159], v[124:127]
s_add_u32 m0, s29, 2048
s_nop 0
buffer_load_dwordx4 v2, s[8:11], s23 offen offset:0 lds
v_cvt_pk_bf16_f32 v42, v68, v69
v_cvt_pk_bf16_f32 v43, v70, v71
M v[124:127], a[176:179], a[152:155], v[124:127]
v_cvt_pk_bf16_f32 v72, v52, v53
M v[128:131], a[184:187], a[96:99], v[128:131]
v_cvt_pk_bf16_f32 v73, v54, v55
v_cvt_pk_bf16_f32 v74, v84, v85
M v[128:131], a[188:191], a[100:103], v[128:131]
ds_read_b128 a[168:171], v10 offset:51200
ds_read_b128 a[172:175], v11 offset:51200
v_cvt_pk_bf16_f32 v75, v86, v87
M v[132:135], a[188:191], a[108:111], v[132:135]
v_cvt_pk_bf16_f32 v56, v44, v45
v_cvt_pk_bf16_f32 v57, v46, v47
M v[132:135], a[184:187], a[104:107], v[132:135]
buffer_load_dwordx4 v3, s[8:11], s23 offen offset:1024 lds
v_cvt_pk_bf16_f32 v58, v76, v77
v_cvt_pk_bf16_f32 v59, v78, v79
M v[136:139], a[184:187], a[112:115], v[136:139]
v_cvt_pk_bf16_f32 v88, v60, v61
M v[136:139], a[188:191], a[116:119], v[136:139]
v_cvt_pk_bf16_f32 v89, v62, v63
v_cvt_pk_bf16_f32 v90, v92, v93
M v[140:143], a[188:191], a[124:127], v[140:143]
buffer_load_dwordx4 v4, s[8:11], s23 offen offset:2048 lds
v_cvt_pk_bf16_f32 v91, v94, v95
M v[140:143], a[184:187], a[120:123], v[140:143]
M v[144:147], a[184:187], a[128:131], v[144:147]
M v[144:147], a[188:191], a[132:135], v[144:147]
buffer_load_dwordx4 v5, s[8:11], s23 offen offset:3072 lds
M v[148:151], a[188:191], a[140:143], v[148:151]
s_add_u32 s94, s92, 0
buffer_store_dwordx4 v[32:35], v1, s[16:19], s94 offen offset:0 sc1
M v[148:151], a[184:187], a[136:139], v[148:151]
M v[152:155], a[184:187], a[144:147], v[152:155]
M v[152:155], a[188:191], a[148:151], v[152:155]
s_sub_u32 s31, s31, 1
s_cmp_eq_u32 s31, 0
s_cselect_b32 s58, -1920, s57
s_add_u32 s23, s23, s58
s_add_u32 s24, s24, s58
M v[156:159], a[188:191], a[156:159], v[156:159]
s_add_u32 s94, s92, 0
buffer_store_dwordx4 v[40:43], v1, s[16:19], s94 offen offset:1024 sc1
M v[156:159], a[184:187], a[152:155], v[156:159]
s_waitcnt lgkmcnt(2)
M v[160:163], a[160:163], a[96:99], v[160:163]
M v[160:163], a[164:167], a[100:103], v[160:163]
ds_read_b128 a[176:179], v10 offset:53248
ds_read_b128 a[180:183], v11 offset:53248
M v[164:167], a[164:167], a[108:111], v[164:167]
s_add_u32 s94, s92, 0
buffer_store_dwordx4 v[48:51], v1, s[16:19], s94 offen offset:2048 sc1
M v[164:167], a[160:163], a[104:107], v[164:167]
v_cvt_pk_bf16_f32 v96, v96, v97
v_cvt_pk_bf16_f32 v97, v98, v99
M v[168:171], a[160:163], a[112:115], v[168:171]
v_cvt_pk_bf16_f32 v98, v128, v129
v_cvt_pk_bf16_f32 v99, v130, v131
M v[168:171], a[164:167], a[116:119], v[168:171]
s_add_u32 m0, s30, 98304
s_nop 0
buffer_load_dwordx4 v6, s[12:15], s25 offen offset:0 lds
v_cvt_pk_bf16_f32 v128, v112, v113
M v[172:175], a[164:167], a[124:127], v[172:175]
s_add_u32 s94, s92, 0
buffer_store_dwordx4 v[56:59], v1, s[16:19], s94 offen offset:3072 sc1
v_cvt_pk_bf16_f32 v129, v114, v115
v_cvt_pk_bf16_f32 v130, v144, v145
M v[172:175], a[160:163], a[120:123], v[172:175]
v_cvt_pk_bf16_f32 v131, v146, v147
M v[176:179], a[160:163], a[128:131], v[176:179]
v_cvt_pk_bf16_f32 v112, v104, v105
v_cvt_pk_bf16_f32 v113, v106, v107
M v[176:179], a[164:167], a[132:135], v[176:179]
buffer_load_dwordx4 v7, s[12:15], s25 offen offset:1024 lds
v_cvt_pk_bf16_f32 v114, v136, v137
v_cvt_pk_bf16_f32 v115, v138, v139
M v[180:183], a[164:167], a[140:143], v[180:183]
s_add_u32 s94, s92, 4096
buffer_store_dwordx4 v[64:67], v1, s[16:19], s94 offen offset:0 sc1
v_cvt_pk_bf16_f32 v144, v120, v121
M v[180:183], a[160:163], a[136:139], v[180:183]
v_cvt_pk_bf16_f32 v145, v122, v123
v_cvt_pk_bf16_f32 v146, v152, v153
M v[184:187], a[160:163], a[144:147], v[184:187]
v_cvt_pk_bf16_f32 v147, v154, v155
M v[184:187], a[164:167], a[148:151], v[184:187]
buffer_load_dwordx4 v8, s[12:15], s25 offen offset:2048 lds
v_cvt_pk_bf16_f32 v104, v100, v101
v_cvt_pk_bf16_f32 v105, v102, v103
M v[188:191], a[164:167], a[156:159], v[188:191]
s_add_u32 s94, s92, 4096
buffer_store_dwordx4 v[72:75], v1, s[16:19], s94 offen offset:1024 sc1
v_cvt_pk_bf16_f32 v106, v132, v133
v_cvt_pk_bf16_f32 v107, v134, v135
M v[188:191], a[160:163], a[152:155], v[188:191]
s_waitcnt lgkmcnt(2)
v_cvt_pk_bf16_f32 v136, v116, v117
M v[192:195], a[168:171], a[96:99], v[192:195]
v_cvt_pk_bf16_f32 v137, v118, v119
v_cvt_pk_bf16_f32 v138, v148, v149
M v[192:195], a[172:175], a[100:103], v[192:195]
ds_read_b128 a[184:187], v10 offset:55296
ds_read_b128 a[188:191], v11 offset:55296
v_cvt_pk_bf16_f32 v139, v150, v151
M v[196:199], a[172:175], a[108:111], v[196:199]
s_add_u32 s94, s92, 4096
buffer_store_dwordx4 v[80:83], v1, s[16:19], s94 offen offset:2048 sc1
v_cvt_pk_bf16_f32 v120, v108, v109
v_cvt_pk_bf16_f32 v121, v110, v111
M v[196:199], a[168:171], a[104:107], v[196:199]
v_cvt_pk_bf16_f32 v122, v140, v141
v_cvt_pk_bf16_f32 v123, v142, v143
M v[200:203], a[168:171], a[112:115], v[200:203]
buffer_load_dwordx4 v9, s[12:15], s25 offen offset:3072 lds
v_cvt_pk_bf16_f32 v152, v124, v125
M v[200:203], a[172:175], a[116:119], v[200:203]
v_cvt_pk_bf16_f32 v153, v126, v127
v_cvt_pk_bf16_f32 v154, v156, v157
M v[204:207], a[172:175], a[124:127], v[204:207]
s_add_u32 s94, s92, 4096
buffer_store_dwordx4 v[88:91], v1, s[16:19], s94 offen offset:3072 sc1
v_cvt_pk_bf16_f32 v155, v158, v159
M v[204:207], a[168:171], a[120:123], v[204:207]
M v[208:211], a[168:171], a[128:131], v[208:211]
s_add_u32 m0, s30, 102400
s_nop 0
buffer_load_dwordx4 v21, s[12:15], s25 offen offset:0 lds
M v[208:211], a[172:175], a[132:135], v[208:211]
M v[212:215], a[172:175], a[140:143], v[212:215]
M v[212:215], a[168:171], a[136:139], v[212:215]
buffer_load_dwordx4 v22, s[12:15], s25 offen offset:1024 lds
M v[216:219], a[168:171], a[144:147], v[216:219]
s_add_u32 s94, s92, 8192
buffer_store_dwordx4 v[96:99], v1, s[16:19], s94 offen offset:0 sc1
M v[216:219], a[172:175], a[148:151], v[216:219]
M v[220:223], a[172:175], a[156:159], v[220:223]
M v[220:223], a[168:171], a[152:155], v[220:223]
s_waitcnt lgkmcnt(2)
M v[224:227], a[176:179], a[96:99], v[224:227]
s_sub_u32 s54, s54, 1
s_cmp_eq_u32 s54, 0
s_cselect_b32 s58, s55, s56
s_add_u32 s25, s25, s58
M v[224:227], a[180:183], a[100:103], v[224:227]
M v[228:231], a[180:183], a[108:111], v[228:231]
s_add_u32 s94, s92, 8192
buffer_store_dwordx4 v[104:107], v1, s[16:19], s94 offen offset:1024 sc1
M v[228:231], a[176:179], a[104:107], v[228:231]
v_cvt_pk_bf16_f32 v160, v160, v161
v_cvt_pk_bf16_f32 v161, v162, v163
M v[232:235], a[176:179], a[112:115], v[232:235]
v_cvt_pk_bf16_f32 v162, v192, v193
v_cvt_pk_bf16_f32 v163, v194, v195
M v[232:235], a[180:183], a[116:119], v[232:235]
v_cvt_pk_bf16_f32 v192, v176, v177
M v[236:239], a[180:183], a[124:127], v[236:239]
v_cvt_pk_bf16_f32 v193, v178, v179
v_cvt_pk_bf16_f32 v194, v208, v209
M v[236:239], a[176:179], a[120:123], v[236:239]
s_waitcnt vmcnt(63) lgkmcnt(0)
s_barrier
v_cvt_pk_bf16_f32 v195, v210, v211
M v[240:243], a[176:179], a[128:131], v[240:243]
s_add_u32 s94, s92, 8192
buffer_store_dwordx4 v[112:115], v1, s[16:19], s94 offen offset:2048 sc1
v_cvt_pk_bf16_f32 v176, v168, v169
v_cvt_pk_bf16_f32 v177, v170, v171
M v[240:243], a[180:183], a[132:135], v[240:243]
s_add_u32 m0, s28, 18432
s_nop 0
buffer_load_dword v20, s[8:11], s24 offen lds
v_cvt_pk_bf16_f32 v178, v200, v201
v_cvt_pk_bf16_f32 v179, v202, v203
M v[244:247], a[180:183], a[140:143], v[244:247]
v_cvt_pk_bf16_f32 v208, v184, v185
M v[244:247], a[176:179], a[136:139], v[244:247]
v_cvt_pk_bf16_f32 v209, v186, v187
v_cvt_pk_bf16_f32 v210, v216, v217
M v[248:251], a[176:179], a[144:147], v[248:251]
buffer_load_dword v23, s[8:11], s24 offen offset:256 lds
v_cvt_pk_bf16_f32 v211, v218, v219
M v[248:251], a[180:183], a[148:151], v[248:251]
v_cvt_pk_bf16_f32 v168, v164, v165
v_cvt_pk_bf16_f32 v169, v166, v167
M v[252:255], a[180:183], a[156:159], v[252:255]
s_add_u32 s94, s92, 8192
buffer_store_dwordx4 v[120:123], v1, s[16:19], s94 offen offset:3072 sc1
v_cvt_pk_bf16_f32 v170, v196, v197
v_cvt_pk_bf16_f32 v171, v198, v199
M v[252:255], a[176:179], a[152:155], v[252:255]
v_cvt_pk_bf16_f32 v200, v180, v181
M a[0:3], a[184:187], a[96:99], a[0:3]
v_cvt_pk_bf16_f32 v201, v182, v183
v_cvt_pk_bf16_f32 v202, v212, v213
M a[0:3], a[188:191], a[100:103], a[0:3]
s_add_u32 m0, s29, 20480
s_nop 0
buffer_load_dwordx4 v2, s[8:11], s23 offen offset:0 lds
v_cvt_pk_bf16_f32 v203, v214, v215
M a[4:7], a[188:191], a[108:111], a[4:7]
v_cvt_pk_bf16_f32 v184, v172, v173
v_cvt_pk_bf16_f32 v185, v174, v175
M a[4:7], a[184:187], a[104:107], a[4:7]
v_cvt_pk_bf16_f32 v186, v204, v205
v_cvt_pk_bf16_f32 v187, v206, v207
M a[8:11], a[184:187], a[112:115], a[8:11]
s_add_u32 s94, s92, 12288
buffer_store_dwordx4 v[128:131], v1, s[16:19], s94 offen offset:0 sc1
v_cvt_pk_bf16_f32 v216, v188, v189
M a[8:11], a[188:191], a[116:119], a[8:11]
buffer_load_dwordx4 v3, s[8:11], s23 offen offset:1024 lds
v_cvt_pk_bf16_f32 v217, v190, v191
v_cvt_pk_bf16_f32 v218, v220, v221
M a[12:15], a[188:191], a[124:127], a[12:15]
v_cvt_pk_bf16_f32 v219, v222, v223
M a[12:15], a[184:187], a[120:123], a[12:15]
M a[16:19], a[184:187], a[128:131], a[16:19]
buffer_load_dwordx4 v4, s[8:11], s23 offen offset:2048 lds
M a[16:19], a[188:191], a[132:135], a[16:19]
M a[20:23], a[188:191], a[140:143], a[20:23]
s_add_u32 s94, s92, 12288
buffer_store_dwordx4 v[136:139], v1, s[16:19], s94 offen offset:1024 sc1
M a[20:23], a[184:187], a[136:139], a[20:23]
M a[24:27], a[184:187], a[144:147], a[24:27]
buffer_load_dwordx4 v5, s[8:11], s23 offen offset:3072 lds
M a[24:27], a[188:191], a[148:151], a[24:27]
M a[28:31], a[188:191], a[156:159], a[28:31]
M a[28:31], a[184:187], a[152:155], a[28:31]
v_accvgpr_read_b32 v24, a0
v_accvgpr_read_b32 v25, a1
v_accvgpr_read_b32 v26, a2
v_accvgpr_read_b32 v27, a3
v_cvt_pk_bf16_f32 v224, v224, v225
v_cvt_pk_bf16_f32 v225, v226, v227
v_cvt_pk_bf16_f32 v226, v24, v25
v_cvt_pk_bf16_f32 v227, v26, v27
v_accvgpr_read_b32 v24, a16
v_accvgpr_read_b32 v25, a17
v_accvgpr_read_b32 v26, a18
v_accvgpr_read_b32 v27, a19
v_cvt_pk_bf16_f32 v36, v240, v241
v_cvt_pk_bf16_f32 v37, v242, v243
v_cvt_pk_bf16_f32 v38, v24, v25
v_cvt_pk_bf16_f32 v39, v26, v27
v_accvgpr_read_b32 v24, a24
v_accvgpr_read_b32 v25, a25
v_accvgpr_read_b32 v26, a26
v_accvgpr_read_b32 v27, a27
v_cvt_pk_bf16_f32 v52, v248, v249
v_cvt_pk_bf16_f32 v53, v250, v251
v_cvt_pk_bf16_f32 v54, v24, v25
v_cvt_pk_bf16_f32 v55, v26, v27
v_accvgpr_read_b32 v24, a8
v_accvgpr_read_b32 v25, a9
v_accvgpr_read_b32 v26, a10
v_accvgpr_read_b32 v27, a11
v_cvt_pk_bf16_f32 v240, v232, v233
v_cvt_pk_bf16_f32 v241, v234, v235
v_cvt_pk_bf16_f32 v242, v24, v25
v_cvt_pk_bf16_f32 v243, v26, v27
v_accvgpr_read_b32 v28, a4
v_accvgpr_read_b32 v29, a5
v_accvgpr_read_b32 v30, a6
v_accvgpr_read_b32 v31, a7
v_cvt_pk_bf16_f32 v232, v228, v229
v_cvt_pk_bf16_f32 v233, v230, v231
v_cvt_pk_bf16_f32 v234, v28, v29
v_cvt_pk_bf16_f32 v235, v30, v31
v_accvgpr_read_b32 v28, a12
v_accvgpr_read_b32 v29, a13
v_accvgpr_read_b32 v30, a14
v_accvgpr_read_b32 v31, a15
v_cvt_pk_bf16_f32 v248, v236, v237
v_cvt_pk_bf16_f32 v249, v238, v239
v_cvt_pk_bf16_f32 v250, v28, v29
v_cvt_pk_bf16_f32 v251, v30, v31
v_accvgpr_read_b32 v28, a20
v_accvgpr_read_b32 v29, a21
v_accvgpr_read_b32 v30, a22
v_accvgpr_read_b32 v31, a23
v_cvt_pk_bf16_f32 v44, v244, v245
v_cvt_pk_bf16_f32 v45, v246, v247
v_cvt_pk_bf16_f32 v46, v28, v29
v_cvt_pk_bf16_f32 v47, v30, v31
v_accvgpr_read_b32 v28, a28
v_accvgpr_read_b32 v29, a29
v_accvgpr_read_b32 v30, a30
v_accvgpr_read_b32 v31, a31
v_cvt_pk_bf16_f32 v60, v252, v253
v_cvt_pk_bf16_f32 v61, v254, v255
v_cvt_pk_bf16_f32 v62, v28, v29
v_cvt_pk_bf16_f32 v63, v30, v31
Lk1_b:
v_and_b32 v24, 15, v0
v_lshlrev_b32 v24, 7, v24
v_bfe_u32 v25, v0, 1, 3
v_lshrrev_b32 v26, 4, v0
v_xor_b32 v25, v25, v26
v_lshl_add_u32 v10, v25, 4, v24
v_xor_b32 v11, 64, v10
v_add_u32 v12, 131072, v10
v_add_u32 v13, 131072, v11
v_bfe_u32 v24, v0, 2, 2
v_lshl_add_u32 v29, v26, 3, v24
v_mul_u32_u24 v25, 384, v29
v_and_b32 v27, 1, v0
v_lshl_add_u32 v25, v27, 3, v25
v_add_u32 v25, 36864, v25
v_lshrrev_b32 v24, 1, v29
v_and_b32 v24, 4, v24
v_and_or_b32 v24, v29, 2, v24
v_bfe_u32 v26, v0, 1, 1
s_mul_i32 s4, s20, 3
s_add_u32 s3, s4, 0
s_and_b32 s5, s3, 3
s_lshl_b32 s5, s5, 1
s_lshr_b32 s3, s3, 2
s_lshl_b32 s3, s3, 7
v_add_u32 v27, s5, v26
v_xor_b32 v27, v27, v24
v_lshl_add_u32 v27, v27, 4, v25
v_add_u32 v14, s3, v27
v_add_u32 v17, 61440, v14
s_add_u32 s3, s4, 1
s_and_b32 s5, s3, 3
s_lshl_b32 s5, s5, 1
s_lshr_b32 s3, s3, 2
s_lshl_b32 s3, s3, 7
v_add_u32 v27, s5, v26
v_xor_b32 v27, v27, v24
v_lshl_add_u32 v27, v27, 4, v25
v_add_u32 v15, s3, v27
v_add_u32 v18, 61440, v15
s_add_u32 s3, s4, 2
s_and_b32 s5, s3, 3
s_lshl_b32 s5, s5, 1
s_lshr_b32 s3, s3, 2
s_lshl_b32 s3, s3, 7
v_add_u32 v27, s5, v26
v_xor_b32 v27, v27, v24
v_lshl_add_u32 v27, v27, 4, v25
v_add_u32 v16, s3, v27
v_add_u32 v19, 61440, v16
s_waitcnt vmcnt(11)
s_barrier
ds_read_b64_tr_b16 a[176:177], v14 offset:28672
ds_read_b64_tr_b16 a[178:179], v14 offset:30208
ds_read_b64_tr_b16 a[184:185], v15 offset:28672
ds_read_b64_tr_b16 a[186:187], v15 offset:30208
ds_read_b64_tr_b16 a[192:193], v16 offset:28672
ds_read_b64_tr_b16 a[194:195], v16 offset:30208
ds_read_b64_tr_b16 a[180:181], v14 offset:40960
ds_read_b64_tr_b16 a[182:183], v14 offset:42496
ds_read_b64_tr_b16 a[188:189], v15 offset:40960
ds_read_b64_tr_b16 a[190:191], v15 offset:42496
ds_read_b64_tr_b16 a[196:197], v16 offset:40960
ds_read_b64_tr_b16 a[198:199], v16 offset:42496
ds_read_b128 a[224:227], v12 offset:0
ds_read_b128 a[228:231], v13 offset:0
ds_read_b128 a[232:235], v12 offset:2048
ds_read_b128 a[236:239], v13 offset:2048
ds_read_b128 a[240:243], v12 offset:4096
ds_read_b128 a[244:247], v13 offset:4096
s_waitcnt lgkmcnt(0)
s_barrier
M a[68:71], a[176:179], a[224:227], 0
ds_read_b128 a[248:251], v12 offset:6144
ds_read_b128 a[252:255], v13 offset:6144
M a[68:71], a[180:183], a[228:231], a[68:71]
s_sub_u32 s31, s31, 1
s_cmp_eq_u32 s31, 0
s_cselect_b32 s58, -1920, s57
s_add_u32 s23, s23, s58
s_add_u32 s24, s24, s58
M a[72:75], a[188:191], a[228:231], 0
ds_read_b64_tr_b16 a[200:201], v17 offset:0
ds_read_b64_tr_b16 a[202:203], v17 offset:1536
M a[72:75], a[184:187], a[224:227], a[72:75]
s_add_u32 m0, s30, 36864
s_nop 0
buffer_load_dwordx4 v6, s[12:15], s25 offen offset:0 lds
M a[76:79], a[192:195], a[224:227], 0
M a[76:79], a[196:199], a[228:231], a[76:79]
buffer_load_dwordx4 v7, s[12:15], s25 offen offset:1024 lds
M a[80:83], a[180:183], a[236:239], 0
ds_read_b128 a[224:227], v12 offset:8192
ds_read_b128 a[228:231], v13 offset:8192
M a[80:83], a[176:179], a[232:235], a[80:83]
M a[84:87], a[184:187], a[232:235], 0
ds_read_b64_tr_b16 a[208:209], v18 offset:0
ds_read_b64_tr_b16 a[210:211], v18 offset:1536
M a[84:87], a[188:191], a[236:239], a[84:87]
buffer_load_dwordx4 v8, s[12:15], s25 offen offset:2048 lds
M a[88:91], a[196:199], a[236:239], 0
M a[88:91], a[192:195], a[232:235], a[88:91]
buffer_load_dwordx4 v9, s[12:15], s25 offen offset:3072 lds
M a[92:95], a[176:179], a[240:243], 0
ds_read_b128 a[232:235], v12 offset:10240
ds_read_b128 a[236:239], v13 offset:10240
M a[92:95], a[180:183], a[244:247], a[92:95]
M a[96:99], a[188:191], a[244:247], 0
ds_read_b64_tr_b16 a[216:217], v19 offset:0
ds_read_b64_tr_b16 a[218:219], v19 offset:1536
M a[96:99], a[184:187], a[240:243], a[96:99]
s_add_u32 m0, s30, 40960
s_nop 0
buffer_load_dwordx4 v21, s[12:15], s25 offen offset:0 lds
M a[100:103], a[192:195], a[240:243], 0
buffer_load_dwordx4 v22, s[12:15], s25 offen offset:1024 lds
M a[100:103], a[196:199], a[244:247], a[100:103]
s_waitcnt lgkmcnt(10)
M a[104:107], a[180:183], a[252:255], 0
ds_read_b128 a[240:243], v12 offset:12288
ds_read_b128 a[244:247], v13 offset:12288
M a[104:107], a[176:179], a[248:251], a[104:107]
s_sub_u32 s54, s54, 1
s_cmp_eq_u32 s54, 0
s_cselect_b32 s58, s55, s56
s_add_u32 s25, s25, s58
M a[108:111], a[184:187], a[248:251], 0
ds_read_b64_tr_b16 a[204:205], v17 offset:12288
ds_read_b64_tr_b16 a[206:207], v17 offset:13824
M a[108:111], a[188:191], a[252:255], a[108:111]
M a[112:115], a[196:199], a[252:255], 0
s_add_u32 m0, s30, 65536
s_nop 0
buffer_load_dwordx4 v6, s[12:15], s25 offen offset:0 lds
M a[112:115], a[192:195], a[248:251], a[112:115]
s_waitcnt lgkmcnt(10)
M a[116:119], a[176:179], a[224:227], 0
ds_read_b128 a[248:251], v12 offset:14336
ds_read_b128 a[252:255], v13 offset:14336
M a[116:119], a[180:183], a[228:231], a[116:119]
buffer_load_dwordx4 v7, s[12:15], s25 offen offset:1024 lds
M a[120:123], a[188:191], a[228:231], 0
ds_read_b64_tr_b16 a[212:213], v18 offset:12288
ds_read_b64_tr_b16 a[214:215], v18 offset:13824
M a[120:123], a[184:187], a[224:227], a[120:123]
M a[124:127], a[192:195], a[224:227], 0
buffer_load_dwordx4 v8, s[12:15], s25 offen offset:2048 lds
M a[124:127], a[196:199], a[228:231], a[124:127]
buffer_load_dwordx4 v9, s[12:15], s25 offen offset:3072 lds
s_waitcnt lgkmcnt(10)
M a[128:131], a[180:183], a[236:239], 0
ds_read_b128 a[224:227], v12 offset:16384
ds_read_b128 a[228:231], v13 offset:16384
M a[128:131], a[176:179], a[232:235], a[128:131]
M a[132:135], a[184:187], a[232:235], 0
ds_read_b64_tr_b16 a[220:221], v19 offset:12288
ds_read_b64_tr_b16 a[222:223], v19 offset:13824
M a[132:135], a[188:191], a[236:239], a[132:135]
s_add_u32 m0, s30, 69632
s_nop 0
buffer_load_dwordx4 v21, s[12:15], s25 offen offset:0 lds
M a[136:139], a[196:199], a[236:239], 0
M a[136:139], a[192:195], a[232:235], a[136:139]
buffer_load_dwordx4 v22, s[12:15], s25 offen offset:1024 lds
s_waitcnt lgkmcnt(10)
M a[140:143], a[176:179], a[240:243], 0
M a[140:143], a[180:183], a[244:247], a[140:143]
s_sub_u32 s54, s54, 1
s_cmp_eq_u32 s54, 0
s_cselect_b32 s58, s55, s56
s_add_u32 s25, s25, s58
M a[144:147], a[188:191], a[244:247], 0
M a[144:147], a[184:187], a[240:243], a[144:147]
M a[148:151], a[192:195], a[240:243], 0
s_waitcnt vmcnt(6) lgkmcnt(0)
s_barrier
ds_read_b128 a[232:235], v10 offset:0
ds_read_b128 a[236:239], v11 offset:0
M a[148:151], a[196:199], a[244:247], a[148:151]
s_add_u32 m0, s28, 131072
s_nop 0
buffer_load_dword v20, s[8:11], s24 offen lds
M a[152:155], a[180:183], a[252:255], 0
ds_read_b128 a[240:243], v10 offset:2048
ds_read_b128 a[244:247], v11 offset:2048
M a[152:155], a[176:179], a[248:251], a[152:155]
M a[156:159], a[184:187], a[248:251], 0
buffer_load_dword v23, s[8:11], s24 offen offset:256 lds
M a[156:159], a[188:191], a[252:255], a[156:159]
M a[160:163], a[196:199], a[252:255], 0
M a[160:163], a[192:195], a[248:251], a[160:163]
s_add_u32 m0, s29, 133120
s_nop 0
buffer_load_dwordx4 v2, s[8:11], s23 offen offset:0 lds
M a[164:167], a[176:179], a[224:227], 0
ds_read_b128 a[248:251], v10 offset:4096
ds_read_b128 a[252:255], v11 offset:4096
M a[164:167], a[180:183], a[228:231], a[164:167]
M a[168:171], a[188:191], a[228:231], 0
M a[168:171], a[184:187], a[224:227], a[168:171]
buffer_load_dwordx4 v3, s[8:11], s23 offen offset:1024 lds
M a[172:175], a[192:195], a[224:227], 0
M a[172:175], a[196:199], a[228:231], a[172:175]
s_waitcnt lgkmcnt(4)
M a[68:71], a[200:203], a[232:235], a[68:71]
ds_read_b128 a[224:227], v10 offset:6144
ds_read_b128 a[228:231], v11 offset:6144
M a[68:71], a[204:207], a[236:239], a[68:71]
buffer_load_dwordx4 v4, s[8:11], s23 offen offset:2048 lds
M a[72:75], a[212:215], a[236:239], a[72:75]
ds_read_b64_tr_b16 a[176:177], v14 offset:0
ds_read_b64_tr_b16 a[178:179], v14 offset:1536
M a[72:75], a[208:211], a[232:235], a[72:75]
buffer_load_dwordx4 v5, s[8:11], s23 offen offset:3072 lds
M a[76:79], a[216:219], a[232:235], a[76:79]
M a[76:79], a[220:223], a[236:239], a[76:79]
s_sub_u32 s31, s31, 1
s_cmp_eq_u32 s31, 0
s_cselect_b32 s58, -1920, s57
s_add_u32 s23, s23, s58
s_add_u32 s24, s24, s58
s_waitcnt lgkmcnt(6)
M a[80:83], a[204:207], a[244:247], a[80:83]
ds_read_b128 a[232:235], v10 offset:8192
ds_read_b128 a[236:239], v11 offset:8192
M a[80:83], a[200:203], a[240:243], a[80:83]
M a[84:87], a[208:211], a[240:243], a[84:87]
ds_read_b64_tr_b16 a[184:185], v15 offset:0
ds_read_b64_tr_b16 a[186:187], v15 offset:1536
M a[84:87], a[212:215], a[244:247], a[84:87]
s_add_u32 m0, s30, 98304
s_nop 0
buffer_load_dwordx4 v6, s[12:15], s25 offen offset:0 lds
M a[88:91], a[220:223], a[244:247], a[88:91]
M a[88:91], a[216:219], a[240:243], a[88:91]
buffer_load_dwordx4 v7, s[12:15], s25 offen offset:1024 lds
s_waitcnt lgkmcnt(8)
M a[92:95], a[200:203], a[248:251], a[92:95]
ds_read_b128 a[240:243], v10 offset:10240
ds_read_b128 a[244:247], v11 offset:10240
M a[92:95], a[204:207], a[252:255], a[92:95]
M a[96:99], a[212:215], a[252:255], a[96:99]
ds_read_b64_tr_b16 a[192:193], v16 offset:0
ds_read_b64_tr_b16 a[194:195], v16 offset:1536
M a[96:99], a[208:211], a[248:251], a[96:99]
buffer_load_dwordx4 v8, s[12:15], s25 offen offset:2048 lds
M a[100:103], a[216:219], a[248:251], a[100:103]
M a[100:103], a[220:223], a[252:255], a[100:103]
buffer_load_dwordx4 v9, s[12:15], s25 offen offset:3072 lds
s_waitcnt lgkmcnt(10)
M a[104:107], a[204:207], a[228:231], a[104:107]
ds_read_b128 a[248:251], v10 offset:12288
ds_read_b128 a[252:255], v11 offset:12288
M a[104:107], a[200:203], a[224:227], a[104:107]
M a[108:111], a[208:211], a[224:227], a[108:111]
ds_read_b64_tr_b16 a[180:181], v14 offset:12288
ds_read_b64_tr_b16 a[182:183], v14 offset:13824
M a[108:111], a[212:215], a[228:231], a[108:111]
s_add_u32 m0, s30, 102400
s_nop 0
buffer_load_dwordx4 v21, s[12:15], s25 offen offset:0 lds
M a[112:115], a[220:223], a[228:231], a[112:115]
M a[112:115], a[216:219], a[224:227], a[112:115]
buffer_load_dwordx4 v22, s[12:15], s25 offen offset:1024 lds
s_waitcnt lgkmcnt(10)
M a[116:119], a[200:203], a[232:235], a[116:119]
ds_read_b128 a[224:227], v10 offset:14336
ds_read_b128 a[228:231], v11 offset:14336
M a[116:119], a[204:207], a[236:239], a[116:119]
M a[120:123], a[212:215], a[236:239], a[120:123]
ds_read_b64_tr_b16 a[188:189], v15 offset:12288
ds_read_b64_tr_b16 a[190:191], v15 offset:13824
M a[120:123], a[208:211], a[232:235], a[120:123]
s_sub_u32 s54, s54, 1
s_cmp_eq_u32 s54, 0
s_cselect_b32 s58, s55, s56
s_add_u32 s25, s25, s58
M a[124:127], a[216:219], a[232:235], a[124:127]
M a[124:127], a[220:223], a[236:239], a[124:127]
s_add_u32 s94, s92, 12288
buffer_store_dwordx4 v[144:147], v1, s[16:19], s94 offen offset:2048 sc1
s_waitcnt lgkmcnt(10)
M a[128:131], a[204:207], a[244:247], a[128:131]
ds_read_b128 a[232:235], v10 offset:16384
ds_read_b128 a[236:239], v11 offset:16384
M a[128:131], a[200:203], a[240:243], a[128:131]
M a[132:135], a[208:211], a[240:243], a[132:135]
ds_read_b64_tr_b16 a[196:197], v16 offset:12288
ds_read_b64_tr_b16 a[198:199], v16 offset:13824
M a[132:135], a[212:215], a[244:247], a[132:135]
s_add_u32 s94, s92, 12288
buffer_store_dwordx4 v[152:155], v1, s[16:19], s94 offen offset:3072 sc1
M a[136:139], a[220:223], a[244:247], a[136:139]
M a[136:139], a[216:219], a[240:243], a[136:139]
s_add_u32 s94, s93, 0
buffer_store_dwordx4 v[160:163], v1, s[16:19], s94 offen offset:0 sc1
s_waitcnt lgkmcnt(10)
M a[140:143], a[200:203], a[248:251], a[140:143]
M a[140:143], a[204:207], a[252:255], a[140:143]
s_add_u32 s94, s93, 0
buffer_store_dwordx4 v[168:171], v1, s[16:19], s94 offen offset:1024 sc1
M a[144:147], a[212:215], a[252:255], a[144:147]
M a[144:147], a[208:211], a[248:251], a[144:147]
M a[148:151], a[216:219], a[248:251], a[148:151]
s_waitcnt vmcnt(16) lgkmcnt(0)
s_barrier
ds_read_b128 a[240:243], v10 offset:18432
ds_read_b128 a[244:247], v11 offset:18432
M a[148:151], a[220:223], a[252:255], a[148:151]
s_add_u32 m0, s28, 0
s_nop 0
buffer_load_dword v20, s[8:11], s24 offen lds
M a[152:155], a[204:207], a[228:231], a[152:155]
ds_read_b128 a[248:251], v10 offset:20480
ds_read_b128 a[252:255], v11 offset:20480
M a[152:155], a[200:203], a[224:227], a[152:155]
M a[156:159], a[208:211], a[224:227], a[156:159]
buffer_load_dword v23, s[8:11], s24 offen offset:256 lds
M a[156:159], a[212:215], a[228:231], a[156:159]
M a[160:163], a[220:223], a[228:231], a[160:163]
M a[160:163], a[216:219], a[224:227], a[160:163]
s_add_u32 m0, s29, 2048
s_nop 0
buffer_load_dwordx4 v2, s[8:11], s23 offen offset:0 lds
M a[164:167], a[200:203], a[232:235], a[164:167]
ds_read_b128 a[224:227], v10 offset:22528
ds_read_b128 a[228:231], v11 offset:22528
M a[164:167], a[204:207], a[236:239], a[164:167]
M a[168:171], a[212:215], a[236:239], a[168:171]
M a[168:171], a[208:211], a[232:235], a[168:171]
buffer_load_dwordx4 v3, s[8:11], s23 offen offset:1024 lds
M a[172:175], a[216:219], a[232:235], a[172:175]
M a[172:175], a[220:223], a[236:239], a[172:175]
s_waitcnt lgkmcnt(4)
M a[68:71], a[176:179], a[240:243], a[68:71]
ds_read_b128 a[232:235], v10 offset:24576
ds_read_b128 a[236:239], v11 offset:24576
M a[68:71], a[180:183], a[244:247], a[68:71]
buffer_load_dwordx4 v4, s[8:11], s23 offen offset:2048 lds
M a[72:75], a[188:191], a[244:247], a[72:75]
ds_read_b64_tr_b16 a[200:201], v14 offset:28672
ds_read_b64_tr_b16 a[202:203], v14 offset:30208
M a[72:75], a[184:187], a[240:243], a[72:75]
buffer_load_dwordx4 v5, s[8:11], s23 offen offset:3072 lds
M a[76:79], a[192:195], a[240:243], a[76:79]
M a[76:79], a[196:199], a[244:247], a[76:79]
s_sub_u32 s31, s31, 1
s_cmp_eq_u32 s31, 0
s_cselect_b32 s58, -1920, s57
s_add_u32 s23, s23, s58
s_add_u32 s24, s24, s58
s_waitcnt lgkmcnt(6)
M a[80:83], a[180:183], a[252:255], a[80:83]
ds_read_b128 a[240:243], v10 offset:26624
ds_read_b128 a[244:247], v11 offset:26624
M a[80:83], a[176:179], a[248:251], a[80:83]
M a[84:87], a[184:187], a[248:251], a[84:87]
ds_read_b64_tr_b16 a[208:209], v15 offset:28672
ds_read_b64_tr_b16 a[210:211], v15 offset:30208
M a[84:87], a[188:191], a[252:255], a[84:87]
s_add_u32 m0, s30, 36864
s_nop 0
buffer_load_dwordx4 v6, s[12:15], s25 offen offset:0 lds
M a[88:91], a[196:199], a[252:255], a[88:91]
M a[88:91], a[192:195], a[248:251], a[88:91]
buffer_load_dwordx4 v7, s[12:15], s25 offen offset:1024 lds
s_waitcnt lgkmcnt(8)
M a[92:95], a[176:179], a[224:227], a[92:95]
ds_read_b128 a[248:251], v10 offset:28672
ds_read_b128 a[252:255], v11 offset:28672
M a[92:95], a[180:183], a[228:231], a[92:95]
M a[96:99], a[188:191], a[228:231], a[96:99]
ds_read_b64_tr_b16 a[216:217], v16 offset:28672
ds_read_b64_tr_b16 a[218:219], v16 offset:30208
M a[96:99], a[184:187], a[224:227], a[96:99]
buffer_load_dwordx4 v8, s[12:15], s25 offen offset:2048 lds
M a[100:103], a[192:195], a[224:227], a[100:103]
M a[100:103], a[196:199], a[228:231], a[100:103]
buffer_load_dwordx4 v9, s[12:15], s25 offen offset:3072 lds
s_waitcnt lgkmcnt(10)
M a[104:107], a[180:183], a[236:239], a[104:107]
ds_read_b128 a[224:227], v10 offset:30720
ds_read_b128 a[228:231], v11 offset:30720
M a[104:107], a[176:179], a[232:235], a[104:107]
M a[108:111], a[184:187], a[232:235], a[108:111]
ds_read_b64_tr_b16 a[204:205], v14 offset:40960
ds_read_b64_tr_b16 a[206:207], v14 offset:42496
M a[108:111], a[188:191], a[236:239], a[108:111]
s_add_u32 m0, s30, 40960
s_nop 0
buffer_load_dwordx4 v21, s[12:15], s25 offen offset:0 lds
M a[112:115], a[196:199], a[236:239], a[112:115]
M a[112:115], a[192:195], a[232:235], a[112:115]
buffer_load_dwordx4 v22, s[12:15], s25 offen offset:1024 lds
s_waitcnt lgkmcnt(10)
M a[116:119], a[176:179], a[240:243], a[116:119]
ds_read_b128 a[232:235], v10 offset:32768
ds_read_b128 a[236:239], v11 offset:32768
M a[116:119], a[180:183], a[244:247], a[116:119]
M a[120:123], a[188:191], a[244:247], a[120:123]
ds_read_b64_tr_b16 a[212:213], v15 offset:40960
ds_read_b64_tr_b16 a[214:215], v15 offset:42496
M a[120:123], a[184:187], a[240:243], a[120:123]
s_sub_u32 s54, s54, 1
s_cmp_eq_u32 s54, 0
s_cselect_b32 s58, s55, s56
s_add_u32 s25, s25, s58
M a[124:127], a[192:195], a[240:243], a[124:127]
M a[124:127], a[196:199], a[244:247], a[124:127]
s_add_u32 s94, s93, 0
buffer_store_dwordx4 v[176:179], v1, s[16:19], s94 offen offset:2048 sc1
s_waitcnt lgkmcnt(10)
M a[128:131], a[180:183], a[252:255], a[128:131]
ds_read_b128 a[240:243], v10 offset:34816
ds_read_b128 a[244:247], v11 offset:34816
M a[128:131], a[176:179], a[248:251], a[128:131]
M a[132:135], a[184:187], a[248:251], a[132:135]
ds_read_b64_tr_b16 a[220:221], v16 offset:40960
ds_read_b64_tr_b16 a[222:223], v16 offset:42496
M a[132:135], a[188:191], a[252:255], a[132:135]
s_add_u32 s94, s93, 0
buffer_store_dwordx4 v[184:187], v1, s[16:19], s94 offen offset:3072 sc1
M a[136:139], a[196:199], a[252:255], a[136:139]
M a[136:139], a[192:195], a[248:251], a[136:139]
s_add_u32 s94, s93, 4096
buffer_store_dwordx4 v[192:195], v1, s[16:19], s94 offen offset:0 sc1
s_waitcnt lgkmcnt(10)
M a[140:143], a[176:179], a[224:227], a[140:143]
M a[140:143], a[180:183], a[228:231], a[140:143]
s_add_u32 s94, s93, 4096
buffer_store_dwordx4 v[200:203], v1, s[16:19], s94 offen offset:1024 sc1
M a[144:147], a[188:191], a[228:231], a[144:147]
M a[144:147], a[184:187], a[224:227], a[144:147]
M a[148:151], a[192:195], a[224:227], a[148:151]
s_waitcnt vmcnt(20) lgkmcnt(0)
s_barrier
ds_read_b128 a[248:251], v12 offset:0
ds_read_b128 a[252:255], v13 offset:0
M a[148:151], a[196:199], a[228:231], a[148:151]
s_add_u32 m0, s28, 18432
s_nop 0
buffer_load_dword v20, s[8:11], s24 offen lds
M a[152:155], a[180:183], a[236:239], a[152:155]
ds_read_b128 a[224:227], v12 offset:2048
ds_read_b128 a[228:231], v13 offset:2048
M a[152:155], a[176:179], a[232:235], a[152:155]
M a[156:159], a[184:187], a[232:235], a[156:159]
buffer_load_dword v23, s[8:11], s24 offen offset:256 lds
M a[156:159], a[188:191], a[236:239], a[156:159]
M a[160:163], a[196:199], a[236:239], a[160:163]
M a[160:163], a[192:195], a[232:235], a[160:163]
s_add_u32 m0, s29, 20480
s_nop 0
buffer_load_dwordx4 v2, s[8:11], s23 offen offset:0 lds
M a[164:167], a[176:179], a[240:243], a[164:167]
ds_read_b128 a[232:235], v12 offset:4096
ds_read_b128 a[236:239], v13 offset:4096
M a[164:167], a[180:183], a[244:247], a[164:167]
M a[168:171], a[188:191], a[244:247], a[168:171]
M a[168:171], a[184:187], a[240:243], a[168:171]
buffer_load_dwordx4 v3, s[8:11], s23 offen offset:1024 lds
M a[172:175], a[192:195], a[240:243], a[172:175]
M a[172:175], a[196:199], a[244:247], a[172:175]
s_waitcnt lgkmcnt(4)
M a[68:71], a[200:203], a[248:251], a[68:71]
ds_read_b128 a[240:243], v12 offset:6144
ds_read_b128 a[244:247], v13 offset:6144
M a[68:71], a[204:207], a[252:255], a[68:71]
buffer_load_dwordx4 v4, s[8:11], s23 offen offset:2048 lds
M a[72:75], a[212:215], a[252:255], a[72:75]
ds_read_b64_tr_b16 a[176:177], v17 offset:0
ds_read_b64_tr_b16 a[178:179], v17 offset:1536
M a[72:75], a[208:211], a[248:251], a[72:75]
buffer_load_dwordx4 v5, s[8:11], s23 offen offset:3072 lds
M a[76:79], a[216:219], a[248:251], a[76:79]
M a[76:79], a[220:223], a[252:255], a[76:79]
s_sub_u32 s31, s31, 1
s_cmp_eq_u32 s31, 0
s_cselect_b32 s58, -1920, s57
s_add_u32 s23, s23, s58
s_add_u32 s24, s24, s58
s_waitcnt lgkmcnt(6)
M a[80:83], a[204:207], a[228:231], a[80:83]
ds_read_b128 a[248:251], v12 offset:8192
ds_read_b128 a[252:255], v13 offset:8192
M a[80:83], a[200:203], a[224:227], a[80:83]
M a[84:87], a[208:211], a[224:227], a[84:87]
ds_read_b64_tr_b16 a[184:185], v18 offset:0
ds_read_b64_tr_b16 a[186:187], v18 offset:1536
M a[84:87], a[212:215], a[228:231], a[84:87]
s_add_u32 m0, s30, 65536
s_nop 0
buffer_load_dwordx4 v6, s[12:15], s25 offen offset:0 lds
M a[88:91], a[220:223], a[228:231], a[88:91]
M a[88:91], a[216:219], a[224:227], a[88:91]
buffer_load_dwordx4 v7, s[12:15], s25 offen offset:1024 lds
s_waitcnt lgkmcnt(8)
M a[92:95], a[200:203], a[232:235], a[92:95]
ds_read_b128 a[224:227], v12 offset:10240
ds_read_b128 a[228:231], v13 offset:10240
M a[92:95], a[204:207], a[236:239], a[92:95]
M a[96:99], a[212:215], a[236:239], a[96:99]
ds_read_b64_tr_b16 a[192:193], v19 offset:0
ds_read_b64_tr_b16 a[194:195], v19 offset:1536
M a[96:99], a[208:211], a[232:235], a[96:99]
buffer_load_dwordx4 v8, s[12:15], s25 offen offset:2048 lds
M a[100:103], a[216:219], a[232:235], a[100:103]
M a[100:103], a[220:223], a[236:239], a[100:103]
buffer_load_dwordx4 v9, s[12:15], s25 offen offset:3072 lds
s_waitcnt lgkmcnt(10)
M a[104:107], a[204:207], a[244:247], a[104:107]
ds_read_b128 a[232:235], v12 offset:12288
ds_read_b128 a[236:239], v13 offset:12288
M a[104:107], a[200:203], a[240:243], a[104:107]
M a[108:111], a[208:211], a[240:243], a[108:111]
ds_read_b64_tr_b16 a[180:181], v17 offset:12288
ds_read_b64_tr_b16 a[182:183], v17 offset:13824
M a[108:111], a[212:215], a[244:247], a[108:111]
s_add_u32 m0, s30, 69632
s_nop 0
buffer_load_dwordx4 v21, s[12:15], s25 offen offset:0 lds
M a[112:115], a[220:223], a[244:247], a[112:115]
M a[112:115], a[216:219], a[240:243], a[112:115]
buffer_load_dwordx4 v22, s[12:15], s25 offen offset:1024 lds
s_waitcnt lgkmcnt(10)
M a[116:119], a[200:203], a[248:251], a[116:119]
ds_read_b128 a[240:243], v12 offset:14336
ds_read_b128 a[244:247], v13 offset:14336
M a[116:119], a[204:207], a[252:255], a[116:119]
M a[120:123], a[212:215], a[252:255], a[120:123]
ds_read_b64_tr_b16 a[188:189], v18 offset:12288
ds_read_b64_tr_b16 a[190:191], v18 offset:13824
M a[120:123], a[208:211], a[248:251], a[120:123]
s_sub_u32 s54, s54, 1
s_cmp_eq_u32 s54, 0
s_cselect_b32 s58, s55, s56
s_add_u32 s25, s25, s58
M a[124:127], a[216:219], a[248:251], a[124:127]
M a[124:127], a[220:223], a[252:255], a[124:127]
s_add_u32 s94, s93, 4096
buffer_store_dwordx4 v[208:211], v1, s[16:19], s94 offen offset:2048 sc1
s_waitcnt lgkmcnt(10)
M a[128:131], a[204:207], a[228:231], a[128:131]
ds_read_b128 a[248:251], v12 offset:16384
ds_read_b128 a[252:255], v13 offset:16384
M a[128:131], a[200:203], a[224:227], a[128:131]
M a[132:135], a[208:211], a[224:227], a[132:135]
ds_read_b64_tr_b16 a[196:197], v19 offset:12288
ds_read_b64_tr_b16 a[198:199], v19 offset:13824
M a[132:135], a[212:215], a[228:231], a[132:135]
s_add_u32 s94, s93, 4096
buffer_store_dwordx4 v[216:219], v1, s[16:19], s94 offen offset:3072 sc1
M a[136:139], a[220:223], a[228:231], a[136:139]
M a[136:139], a[216:219], a[224:227], a[136:139]
s_add_u32 s94, s93, 8192
buffer_store_dwordx4 v[224:227], v1, s[16:19], s94 offen offset:0 sc1
s_waitcnt lgkmcnt(10)
M a[140:143], a[200:203], a[232:235], a[140:143]
M a[140:143], a[204:207], a[236:239], a[140:143]
s_add_u32 s94, s93, 8192
buffer_store_dwordx4 v[232:235], v1, s[16:19], s94 offen offset:1024 sc1
M a[144:147], a[212:215], a[236:239], a[144:147]
M a[144:147], a[208:211], a[232:235], a[144:147]
M a[148:151], a[216:219], a[232:235], a[148:151]
s_waitcnt vmcnt(20) lgkmcnt(0)
s_barrier
ds_read_b128 a[224:227], v10 offset:0
ds_read_b128 a[228:231], v11 offset:0
M a[148:151], a[220:223], a[236:239], a[148:151]
s_add_u32 m0, s28, 131072
s_nop 0
buffer_load_dword v20, s[8:11], s24 offen lds
M a[152:155], a[204:207], a[244:247], a[152:155]
ds_read_b128 a[232:235], v10 offset:2048
ds_read_b128 a[236:239], v11 offset:2048
M a[152:155], a[200:203], a[240:243], a[152:155]
M a[156:159], a[208:211], a[240:243], a[156:159]
buffer_load_dword v23, s[8:11], s24 offen offset:256 lds
M a[156:159], a[212:215], a[244:247], a[156:159]
M a[160:163], a[220:223], a[244:247], a[160:163]
M a[160:163], a[216:219], a[240:243], a[160:163]
s_add_u32 m0, s29, 133120
s_nop 0
buffer_load_dwordx4 v2, s[8:11], s23 offen offset:0 lds
M a[164:167], a[200:203], a[248:251], a[164:167]
ds_read_b128 a[240:243], v10 offset:4096
ds_read_b128 a[244:247], v11 offset:4096
M a[164:167], a[204:207], a[252:255], a[164:167]
M a[168:171], a[212:215], a[252:255], a[168:171]
M a[168:171], a[208:211], a[248:251], a[168:171]
buffer_load_dwordx4 v3, s[8:11], s23 offen offset:1024 lds
M a[172:175], a[216:219], a[248:251], a[172:175]
M a[172:175], a[220:223], a[252:255], a[172:175]
s_waitcnt lgkmcnt(4)
M a[68:71], a[176:179], a[224:227], a[68:71]
ds_read_b128 a[248:251], v10 offset:6144
ds_read_b128 a[252:255], v11 offset:6144
M a[68:71], a[180:183], a[228:231], a[68:71]
buffer_load_dwordx4 v4, s[8:11], s23 offen offset:2048 lds
M a[72:75], a[188:191], a[228:231], a[72:75]
ds_read_b64_tr_b16 a[200:201], v14 offset:0
ds_read_b64_tr_b16 a[202:203], v14 offset:1536
M a[72:75], a[184:187], a[224:227], a[72:75]
buffer_load_dwordx4 v5, s[8:11], s23 offen offset:3072 lds
M a[76:79], a[192:195], a[224:227], a[76:79]
M a[76:79], a[196:199], a[228:231], a[76:79]
s_sub_u32 s31, s31, 1
s_cmp_eq_u32 s31, 0
s_cselect_b32 s58, -1920, s57
s_add_u32 s23, s23, s58
s_add_u32 s24, s24, s58
s_waitcnt lgkmcnt(6)
M a[80:83], a[180:183], a[236:239], a[80:83]
ds_read_b128 a[224:227], v10 offset:8192
ds_read_b128 a[228:231], v11 offset:8192
M a[80:83], a[176:179], a[232:235], a[80:83]
M a[84:87], a[184:187], a[232:235], a[84:87]
ds_read_b64_tr_b16 a[208:209], v15 offset:0
ds_read_b64_tr_b16 a[210:211], v15 offset:1536
M a[84:87], a[188:191], a[236:239], a[84:87]
s_add_u32 m0, s30, 98304
s_nop 0
buffer_load_dwordx4 v6, s[12:15], s25 offen offset:0 lds
M a[88:91], a[196:199], a[236:239], a[88:91]
M a[88:91], a[192:195], a[232:235], a[88:91]
buffer_load_dwordx4 v7, s[12:15], s25 offen offset:1024 lds
s_waitcnt lgkmcnt(8)
M a[92:95], a[176:179], a[240:243], a[92:95]
ds_read_b128 a[232:235], v10 offset:10240
ds_read_b128 a[236:239], v11 offset:10240
M a[92:95], a[180:183], a[244:247], a[92:95]
M a[96:99], a[188:191], a[244:247], a[96:99]
ds_read_b64_tr_b16 a[216:217], v16 offset:0
ds_read_b64_tr_b16 a[218:219], v16 offset:1536
M a[96:99], a[184:187], a[240:243], a[96:99]
buffer_load_dwordx4 v8, s[12:15], s25 offen offset:2048 lds
M a[100:103], a[192:195], a[240:243], a[100:103]
M a[100:103], a[196:199], a[244:247], a[100:103]
buffer_load_dwordx4 v9, s[12:15], s25 offen offset:3072 lds
s_waitcnt lgkmcnt(10)
M a[104:107], a[180:183], a[252:255], a[104:107]
ds_read_b128 a[240:243], v10 offset:12288
ds_read_b128 a[244:247], v11 offset:12288
M a[104:107], a[176:179], a[248:251], a[104:107]
M a[108:111], a[184:187], a[248:251], a[108:111]
ds_read_b64_tr_b16 a[204:205], v14 offset:12288
ds_read_b64_tr_b16 a[206:207], v14 offset:13824
M a[108:111], a[188:191], a[252:255], a[108:111]
s_add_u32 m0, s30, 102400
s_nop 0
buffer_load_dwordx4 v21, s[12:15], s25 offen offset:0 lds
M a[112:115], a[196:199], a[252:255], a[112:115]
M a[112:115], a[192:195], a[248:251], a[112:115]
buffer_load_dwordx4 v22, s[12:15], s25 offen offset:1024 lds
s_waitcnt lgkmcnt(10)
M a[116:119], a[176:179], a[224:227], a[116:119]
ds_read_b128 a[248:251], v10 offset:14336
ds_read_b128 a[252:255], v11 offset:14336
M a[116:119], a[180:183], a[228:231], a[116:119]
M a[120:123], a[188:191], a[228:231], a[120:123]
ds_read_b64_tr_b16 a[212:213], v15 offset:12288
ds_read_b64_tr_b16 a[214:215], v15 offset:13824
M a[120:123], a[184:187], a[224:227], a[120:123]
s_sub_u32 s54, s54, 1
s_cmp_eq_u32 s54, 0
s_cselect_b32 s58, s55, s56
s_add_u32 s25, s25, s58
M a[124:127], a[192:195], a[224:227], a[124:127]
M a[124:127], a[196:199], a[228:231], a[124:127]
s_add_u32 s94, s93, 8192
buffer_store_dwordx4 v[240:243], v1, s[16:19], s94 offen offset:2048 sc1
s_waitcnt lgkmcnt(10)
M a[128:131], a[180:183], a[236:239], a[128:131]
ds_read_b128 a[224:227], v10 offset:16384
ds_read_b128 a[228:231], v11 offset:16384
M a[128:131], a[176:179], a[232:235], a[128:131]
M a[132:135], a[184:187], a[232:235], a[132:135]
ds_read_b64_tr_b16 a[220:221], v16 offset:12288
ds_read_b64_tr_b16 a[222:223], v16 offset:13824
M a[132:135], a[188:191], a[236:239], a[132:135]
s_add_u32 s94, s93, 8192
buffer_store_dwordx4 v[248:251], v1, s[16:19], s94 offen offset:3072 sc1
M a[136:139], a[196:199], a[236:239], a[136:139]
M a[136:139], a[192:195], a[232:235], a[136:139]
s_add_u32 s94, s93, 12288
buffer_store_dwordx4 v[36:39], v1, s[16:19], s94 offen offset:0 sc1
s_waitcnt lgkmcnt(10)
M a[140:143], a[176:179], a[240:243], a[140:143]
M a[140:143], a[180:183], a[244:247], a[140:143]
s_add_u32 s94, s93, 12288
buffer_store_dwordx4 v[44:47], v1, s[16:19], s94 offen offset:1024 sc1
M a[144:147], a[188:191], a[244:247], a[144:147]
M a[144:147], a[184:187], a[240:243], a[144:147]
M a[148:151], a[192:195], a[240:243], a[148:151]
s_waitcnt vmcnt(20) lgkmcnt(0)
s_barrier
ds_read_b128 a[232:235], v10 offset:18432
ds_read_b128 a[236:239], v11 offset:18432
M a[148:151], a[196:199], a[244:247], a[148:151]
s_add_u32 m0, s28, 0
s_nop 0
buffer_load_dword v20, s[8:11], s24 offen lds
M a[152:155], a[180:183], a[252:255], a[152:155]
ds_read_b128 a[240:243], v10 offset:20480
ds_read_b128 a[244:247], v11 offset:20480
M a[152:155], a[176:179], a[248:251], a[152:155]
M a[156:159], a[184:187], a[248:251], a[156:159]
buffer_load_dword v23, s[8:11], s24 offen offset:256 lds
M a[156:159], a[188:191], a[252:255], a[156:159]
M a[160:163], a[196:199], a[252:255], a[160:163]
M a[160:163], a[192:195], a[248:251], a[160:163]
s_add_u32 m0, s29, 2048
s_nop 0
buffer_load_dwordx4 v2, s[8:11], s23 offen offset:0 lds
M a[164:167], a[176:179], a[224:227], a[164:167]
ds_read_b128 a[248:251], v10 offset:22528
ds_read_b128 a[252:255], v11 offset:22528
M a[164:167], a[180:183], a[228:231], a[164:167]
M a[168:171], a[188:191], a[228:231], a[168:171]
M a[168:171], a[184:187], a[224:227], a[168:171]
buffer_load_dwordx4 v3, s[8:11], s23 offen offset:1024 lds
M a[172:175], a[192:195], a[224:227], a[172:175]
M a[172:175], a[196:199], a[228:231], a[172:175]
s_waitcnt lgkmcnt(4)
M a[68:71], a[200:203], a[232:235], a[68:71]
ds_read_b128 a[224:227], v10 offset:24576
ds_read_b128 a[228:231], v11 offset:24576
M a[68:71], a[204:207], a[236:239], a[68:71]
buffer_load_dwordx4 v4, s[8:11], s23 offen offset:2048 lds
M a[72:75], a[212:215], a[236:239], a[72:75]
ds_read_b64_tr_b16 a[176:177], v14 offset:28672
ds_read_b64_tr_b16 a[178:179], v14 offset:30208
M a[72:75], a[208:211], a[232:235], a[72:75]
M a[76:79], a[216:219], a[232:235], a[76:79]
buffer_load_dwordx4 v5, s[8:11], s23 offen offset:3072 lds
M a[76:79], a[220:223], a[236:239], a[76:79]
s_waitcnt lgkmcnt(6)
M a[80:83], a[204:207], a[244:247], a[80:83]
ds_read_b128 a[232:235], v10 offset:26624
ds_read_b128 a[236:239], v11 offset:26624
M a[80:83], a[200:203], a[240:243], a[80:83]
s_sub_u32 s31, s31, 1
s_cmp_eq_u32 s31, 0
s_cselect_b32 s58, -1920, s57
s_add_u32 s23, s23, s58
s_add_u32 s24, s24, s58
M a[84:87], a[208:211], a[240:243], a[84:87]
ds_read_b64_tr_b16 a[184:185], v15 offset:28672
ds_read_b64_tr_b16 a[186:187], v15 offset:30208
M a[84:87], a[212:215], a[244:247], a[84:87]
M a[88:91], a[220:223], a[244:247], a[88:91]
s_add_u32 m0, s30, 36864
s_nop 0
buffer_load_dwordx4 v6, s[12:15], s25 offen offset:0 lds
M a[88:91], a[216:219], a[240:243], a[88:91]
s_waitcnt lgkmcnt(8)
M a[92:95], a[200:203], a[248:251], a[92:95]
ds_read_b128 a[240:243], v10 offset:28672
ds_read_b128 a[244:247], v11 offset:28672
M a[92:95], a[204:207], a[252:255], a[92:95]
M a[96:99], a[212:215], a[252:255], a[96:99]
ds_read_b64_tr_b16 a[192:193], v16 offset:28672
ds_read_b64_tr_b16 a[194:195], v16 offset:30208
M a[96:99], a[208:211], a[248:251], a[96:99]
buffer_load_dwordx4 v7, s[12:15], s25 offen offset:1024 lds
M a[100:103], a[216:219], a[248:251], a[100:103]
M a[100:103], a[220:223], a[252:255], a[100:103]
buffer_load_dwordx4 v8, s[12:15], s25 offen offset:2048 lds
s_waitcnt lgkmcnt(10)
M a[104:107], a[204:207], a[228:231], a[104:107]
ds_read_b128 a[248:251], v10 offset:30720
ds_read_b128 a[252:255], v11 offset:30720
M a[104:107], a[200:203], a[224:227], a[104:107]
M a[108:111], a[208:211], a[224:227], a[108:111]
ds_read_b64_tr_b16 a[180:181], v14 offset:40960
ds_read_b64_tr_b16 a[182:183], v14 offset:42496
M a[108:111], a[212:215], a[228:231], a[108:111]
buffer_load_dwordx4 v9, s[12:15], s25 offen offset:3072 lds
M a[112:115], a[220:223], a[228:231], a[112:115]
M a[112:115], a[216:219], a[224:227], a[112:115]
s_add_u32 m0, s30, 40960
s_nop 0
buffer_load_dwordx4 v21, s[12:15], s25 offen offset:0 lds
s_waitcnt lgkmcnt(10)
M a[116:119], a[200:203], a[232:235], a[116:119]
ds_read_b128 a[224:227], v10 offset:32768
ds_read_b128 a[228:231], v11 offset:32768
M a[116:119], a[204:207], a[236:239], a[116:119]
M a[120:123], a[212:215], a[236:239], a[120:123]
ds_read_b64_tr_b16 a[188:189], v15 offset:40960
ds_read_b64_tr_b16 a[190:191], v15 offset:42496
M a[120:123], a[208:211], a[232:235], a[120:123]
M a[124:127], a[216:219], a[232:235], a[124:127]
buffer_load_dwordx4 v22, s[12:15], s25 offen offset:1024 lds
M a[124:127], a[220:223], a[236:239], a[124:127]
s_waitcnt lgkmcnt(10)
M a[128:131], a[204:207], a[244:247], a[128:131]
ds_read_b128 a[232:235], v10 offset:34816
ds_read_b128 a[236:239], v11 offset:34816
M a[128:131], a[200:203], a[240:243], a[128:131]
s_sub_u32 s54, s54, 1
s_cmp_eq_u32 s54, 0
s_cselect_b32 s58, s55, s56
s_add_u32 s25, s25, s58
M a[132:135], a[208:211], a[240:243], a[132:135]
ds_read_b64_tr_b16 a[196:197], v16 offset:40960
ds_read_b64_tr_b16 a[198:199], v16 offset:42496
M a[132:135], a[212:215], a[244:247], a[132:135]
M a[136:139], a[220:223], a[244:247], a[136:139]
s_add_u32 s94, s93, 12288
buffer_store_dwordx4 v[52:55], v1, s[16:19], s94 offen offset:2048 sc1
M a[136:139], a[216:219], a[240:243], a[136:139]
s_waitcnt lgkmcnt(10)
M a[140:143], a[200:203], a[248:251], a[140:143]
s_add_u32 s94, s93, 12288
buffer_store_dwordx4 v[60:63], v1, s[16:19], s94 offen offset:3072 sc1
M a[140:143], a[204:207], a[252:255], a[140:143]
M a[144:147], a[212:215], a[252:255], a[144:147]
M a[144:147], a[208:211], a[248:251], a[144:147]
M a[148:151], a[216:219], a[248:251], a[148:151]
s_waitcnt vmcnt(18) lgkmcnt(0)
s_barrier
ds_read_b128 a[240:243], v12 offset:0
ds_read_b128 a[244:247], v13 offset:0
M a[148:151], a[220:223], a[252:255], a[148:151]
s_add_u32 m0, s28, 18432
s_nop 0
buffer_load_dword v20, s[8:11], s24 offen lds
M a[152:155], a[204:207], a[228:231], a[152:155]
ds_read_b128 a[248:251], v12 offset:2048
ds_read_b128 a[252:255], v13 offset:2048
M a[152:155], a[200:203], a[224:227], a[152:155]
M a[156:159], a[208:211], a[224:227], a[156:159]
buffer_load_dword v23, s[8:11], s24 offen offset:256 lds
M a[156:159], a[212:215], a[228:231], a[156:159]
M a[160:163], a[220:223], a[228:231], a[160:163]
M a[160:163], a[216:219], a[224:227], a[160:163]
s_add_u32 m0, s29, 20480
s_nop 0
buffer_load_dwordx4 v2, s[8:11], s23 offen offset:0 lds
M a[164:167], a[200:203], a[232:235], a[164:167]
ds_read_b128 a[224:227], v12 offset:4096
ds_read_b128 a[228:231], v13 offset:4096
M a[164:167], a[204:207], a[236:239], a[164:167]
M a[168:171], a[212:215], a[236:239], a[168:171]
M a[168:171], a[208:211], a[232:235], a[168:171]
buffer_load_dwordx4 v3, s[8:11], s23 offen offset:1024 lds
M a[172:175], a[216:219], a[232:235], a[172:175]
M a[172:175], a[220:223], a[236:239], a[172:175]
s_waitcnt lgkmcnt(4)
M a[68:71], a[176:179], a[240:243], a[68:71]
ds_read_b128 a[232:235], v12 offset:6144
ds_read_b128 a[236:239], v13 offset:6144
M a[68:71], a[180:183], a[244:247], a[68:71]
buffer_load_dwordx4 v4, s[8:11], s23 offen offset:2048 lds
M a[72:75], a[188:191], a[244:247], a[72:75]
ds_read_b64_tr_b16 a[200:201], v17 offset:0
ds_read_b64_tr_b16 a[202:203], v17 offset:1536
M a[72:75], a[184:187], a[240:243], a[72:75]
M a[76:79], a[192:195], a[240:243], a[76:79]
buffer_load_dwordx4 v5, s[8:11], s23 offen offset:3072 lds
M a[76:79], a[196:199], a[244:247], a[76:79]
s_waitcnt lgkmcnt(6)
M a[80:83], a[180:183], a[252:255], a[80:83]
ds_read_b128 a[240:243], v12 offset:8192
ds_read_b128 a[244:247], v13 offset:8192
M a[80:83], a[176:179], a[248:251], a[80:83]
M a[84:87], a[184:187], a[248:251], a[84:87]
ds_read_b64_tr_b16 a[208:209], v18 offset:0
ds_read_b64_tr_b16 a[210:211], v18 offset:1536
M a[84:87], a[188:191], a[252:255], a[84:87]
s_sub_u32 s31, s31, 1
s_cmp_eq_u32 s31, 0
s_cselect_b32 s58, -1920, s57
s_add_u32 s23, s23, s58
s_add_u32 s24, s24, s58
M a[88:91], a[196:199], a[252:255], a[88:91]
M a[88:91], a[192:195], a[248:251], a[88:91]
s_waitcnt lgkmcnt(8)
M a[92:95], a[176:179], a[224:227], a[92:95]
ds_read_b128 a[248:251], v12 offset:10240
ds_read_b128 a[252:255], v13 offset:10240
M a[92:95], a[180:183], a[228:231], a[92:95]
s_add_u32 m0, s30, 65536
s_nop 0
buffer_load_dwordx4 v6, s[12:15], s25 offen offset:0 lds
M a[96:99], a[188:191], a[228:231], a[96:99]
ds_read_b64_tr_b16 a[216:217], v19 offset:0
ds_read_b64_tr_b16 a[218:219], v19 offset:1536
M a[96:99], a[184:187], a[224:227], a[96:99]
M a[100:103], a[192:195], a[224:227], a[100:103]
buffer_load_dwordx4 v7, s[12:15], s25 offen offset:1024 lds
M a[100:103], a[196:199], a[228:231], a[100:103]
s_waitcnt lgkmcnt(10)
M a[104:107], a[180:183], a[236:239], a[104:107]
ds_read_b128 a[224:227], v12 offset:12288
ds_read_b128 a[228:231], v13 offset:12288
M a[104:107], a[176:179], a[232:235], a[104:107]
M a[108:111], a[184:187], a[232:235], a[108:111]
ds_read_b64_tr_b16 a[204:205], v17 offset:12288
ds_read_b64_tr_b16 a[206:207], v17 offset:13824
M a[108:111], a[188:191], a[236:239], a[108:111]
buffer_load_dwordx4 v8, s[12:15], s25 offen offset:2048 lds
M a[112:115], a[196:199], a[236:239], a[112:115]
M a[112:115], a[192:195], a[232:235], a[112:115]
s_waitcnt lgkmcnt(10)
M a[116:119], a[176:179], a[240:243], a[116:119]
ds_read_b128 a[232:235], v12 offset:14336
ds_read_b128 a[236:239], v13 offset:14336
M a[116:119], a[180:183], a[244:247], a[116:119]
buffer_load_dwordx4 v9, s[12:15], s25 offen offset:3072 lds
M a[120:123], a[188:191], a[244:247], a[120:123]
ds_read_b64_tr_b16 a[212:213], v18 offset:12288
ds_read_b64_tr_b16 a[214:215], v18 offset:13824
M a[120:123], a[184:187], a[240:243], a[120:123]
M a[124:127], a[192:195], a[240:243], a[124:127]
s_add_u32 m0, s30, 69632
s_nop 0
buffer_load_dwordx4 v21, s[12:15], s25 offen offset:0 lds
M a[124:127], a[196:199], a[244:247], a[124:127]
s_waitcnt lgkmcnt(10)
M a[128:131], a[180:183], a[252:255], a[128:131]
ds_read_b128 a[240:243], v12 offset:16384
ds_read_b128 a[244:247], v13 offset:16384
M a[128:131], a[176:179], a[248:251], a[128:131]
M a[132:135], a[184:187], a[248:251], a[132:135]
ds_read_b64_tr_b16 a[220:221], v19 offset:12288
ds_read_b64_tr_b16 a[222:223], v19 offset:13824
M a[132:135], a[188:191], a[252:255], a[132:135]
buffer_load_dwordx4 v22, s[12:15], s25 offen offset:1024 lds
M a[136:139], a[196:199], a[252:255], a[136:139]
M a[136:139], a[192:195], a[248:251], a[136:139]
s_waitcnt lgkmcnt(10)
M a[140:143], a[176:179], a[224:227], a[140:143]
s_sub_u32 s54, s54, 1
s_cmp_eq_u32 s54, 0
s_cselect_b32 s58, s55, s56
s_add_u32 s25, s25, s58
M a[140:143], a[180:183], a[228:231], a[140:143]
M a[144:147], a[188:191], a[228:231], a[144:147]
M a[144:147], a[184:187], a[224:227], a[144:147]
M a[148:151], a[192:195], a[224:227], a[148:151]
s_waitcnt vmcnt(12) lgkmcnt(0)
s_barrier
ds_read_b128 a[248:251], v10 offset:0
ds_read_b128 a[252:255], v11 offset:0
s_cmp_lg_u32 s101, 0
s_cbranch_scc1 Lk1_arr
v_mov_b32 v127, 1
s_and_b32 s41, s2, 128
s_mov_b64 exec, 1
buffer_atomic_add v127, off, s[36:39], s41 sc1
s_mov_b64 exec, -1
Lk1_arr:
M a[148:151], a[196:199], a[228:231], a[148:151]
s_add_u32 m0, s28, 131072
s_nop 0
buffer_load_dword v20, s[8:11], s24 offen lds
M a[152:155], a[180:183], a[236:239], a[152:155]
ds_read_b128 a[224:227], v10 offset:2048
ds_read_b128 a[228:231], v11 offset:2048
M a[152:155], a[176:179], a[232:235], a[152:155]
M a[156:159], a[184:187], a[232:235], a[156:159]
buffer_load_dword v23, s[8:11], s24 offen offset:256 lds
M a[156:159], a[188:191], a[236:239], a[156:159]
M a[160:163], a[196:199], a[236:239], a[160:163]
M a[160:163], a[192:195], a[232:235], a[160:163]
s_add_u32 m0, s29, 133120
s_nop 0
buffer_load_dwordx4 v2, s[8:11], s23 offen offset:0 lds
M a[164:167], a[176:179], a[240:243], a[164:167]
ds_read_b128 a[232:235], v10 offset:4096
ds_read_b128 a[236:239], v11 offset:4096
M a[164:167], a[180:183], a[244:247], a[164:167]
M a[168:171], a[188:191], a[244:247], a[168:171]
M a[168:171], a[184:187], a[240:243], a[168:171]
buffer_load_dwordx4 v3, s[8:11], s23 offen offset:1024 lds
M a[172:175], a[192:195], a[240:243], a[172:175]
M a[172:175], a[196:199], a[244:247], a[172:175]
s_waitcnt lgkmcnt(4)
M a[68:71], a[200:203], a[248:251], a[68:71]
ds_read_b128 a[240:243], v10 offset:6144
ds_read_b128 a[244:247], v11 offset:6144
M a[68:71], a[204:207], a[252:255], a[68:71]
buffer_load_dwordx4 v4, s[8:11], s23 offen offset:2048 lds
M a[72:75], a[212:215], a[252:255], a[72:75]
ds_read_b64_tr_b16 a[176:177], v14 offset:0
ds_read_b64_tr_b16 a[178:179], v14 offset:1536
M a[72:75], a[208:211], a[248:251], a[72:75]
M a[76:79], a[216:219], a[248:251], a[76:79]
buffer_load_dwordx4 v5, s[8:11], s23 offen offset:3072 lds
M a[76:79], a[220:223], a[252:255], a[76:79]
s_waitcnt lgkmcnt(6)
M a[80:83], a[204:207], a[228:231], a[80:83]
ds_read_b128 a[248:251], v10 offset:8192
ds_read_b128 a[252:255], v11 offset:8192
M a[80:83], a[200:203], a[224:227], a[80:83]
M a[84:87], a[208:211], a[224:227], a[84:87]
ds_read_b64_tr_b16 a[184:185], v15 offset:0
ds_read_b64_tr_b16 a[186:187], v15 offset:1536
M a[84:87], a[212:215], a[228:231], a[84:87]
s_sub_u32 s31, s31, 1
s_cmp_eq_u32 s31, 0
s_cselect_b32 s58, -1920, s57
s_add_u32 s23, s23, s58
s_add_u32 s24, s24, s58
M a[88:91], a[220:223], a[228:231], a[88:91]
M a[88:91], a[216:219], a[224:227], a[88:91]
s_waitcnt lgkmcnt(8)
M a[92:95], a[200:203], a[232:235], a[92:95]
ds_read_b128 a[224:227], v10 offset:10240
ds_read_b128 a[228:231], v11 offset:10240
M a[92:95], a[204:207], a[236:239], a[92:95]
s_add_u32 m0, s30, 98304
s_nop 0
buffer_load_dwordx4 v6, s[12:15], s25 offen offset:0 lds
M a[96:99], a[212:215], a[236:239], a[96:99]
ds_read_b64_tr_b16 a[192:193], v16 offset:0
ds_read_b64_tr_b16 a[194:195], v16 offset:1536
M a[96:99], a[208:211], a[232:235], a[96:99]
M a[100:103], a[216:219], a[232:235], a[100:103]
buffer_load_dwordx4 v7, s[12:15], s25 offen offset:1024 lds
M a[100:103], a[220:223], a[236:239], a[100:103]
s_waitcnt lgkmcnt(10)
M a[104:107], a[204:207], a[244:247], a[104:107]
ds_read_b128 a[232:235], v10 offset:12288
ds_read_b128 a[236:239], v11 offset:12288
M a[104:107], a[200:203], a[240:243], a[104:107]
M a[108:111], a[208:211], a[240:243], a[108:111]
ds_read_b64_tr_b16 a[180:181], v14 offset:12288
ds_read_b64_tr_b16 a[182:183], v14 offset:13824
M a[108:111], a[212:215], a[244:247], a[108:111]
buffer_load_dwordx4 v8, s[12:15], s25 offen offset:2048 lds
M a[112:115], a[220:223], a[244:247], a[112:115]
M a[112:115], a[216:219], a[240:243], a[112:115]
s_waitcnt lgkmcnt(10)
M a[116:119], a[200:203], a[248:251], a[116:119]
ds_read_b128 a[240:243], v10 offset:14336
ds_read_b128 a[244:247], v11 offset:14336
M a[116:119], a[204:207], a[252:255], a[116:119]
buffer_load_dwordx4 v9, s[12:15], s25 offen offset:3072 lds
M a[120:123], a[212:215], a[252:255], a[120:123]
ds_read_b64_tr_b16 a[188:189], v15 offset:12288
ds_read_b64_tr_b16 a[190:191], v15 offset:13824
M a[120:123], a[208:211], a[248:251], a[120:123]
M a[124:127], a[216:219], a[248:251], a[124:127]
s_add_u32 m0, s30, 102400
s_nop 0
buffer_load_dwordx4 v21, s[12:15], s25 offen offset:0 lds
M a[124:127], a[220:223], a[252:255], a[124:127]
s_waitcnt lgkmcnt(10)
M a[128:131], a[204:207], a[228:231], a[128:131]
ds_read_b128 a[248:251], v10 offset:16384
ds_read_b128 a[252:255], v11 offset:16384
M a[128:131], a[200:203], a[224:227], a[128:131]
M a[132:135], a[208:211], a[224:227], a[132:135]
ds_read_b64_tr_b16 a[196:197], v16 offset:12288
ds_read_b64_tr_b16 a[198:199], v16 offset:13824
M a[132:135], a[212:215], a[228:231], a[132:135]
buffer_load_dwordx4 v22, s[12:15], s25 offen offset:1024 lds
M a[136:139], a[220:223], a[228:231], a[136:139]
M a[136:139], a[216:219], a[224:227], a[136:139]
s_waitcnt lgkmcnt(10)
M a[140:143], a[200:203], a[232:235], a[140:143]
s_sub_u32 s54, s54, 1
s_cmp_eq_u32 s54, 0
s_cselect_b32 s58, s55, s56
s_add_u32 s25, s25, s58
M a[140:143], a[204:207], a[236:239], a[140:143]
M a[144:147], a[212:215], a[236:239], a[144:147]
M a[144:147], a[208:211], a[232:235], a[144:147]
M a[148:151], a[216:219], a[232:235], a[148:151]
s_waitcnt vmcnt(12) lgkmcnt(0)
s_barrier
ds_read_b128 a[224:227], v10 offset:18432
ds_read_b128 a[228:231], v11 offset:18432
M a[148:151], a[220:223], a[236:239], a[148:151]
s_add_u32 m0, s28, 0
s_nop 0
buffer_load_dword v20, s[8:11], s24 offen lds
M a[152:155], a[204:207], a[244:247], a[152:155]
ds_read_b128 a[232:235], v10 offset:20480
ds_read_b128 a[236:239], v11 offset:20480
M a[152:155], a[200:203], a[240:243], a[152:155]
M a[156:159], a[208:211], a[240:243], a[156:159]
buffer_load_dword v23, s[8:11], s24 offen offset:256 lds
M a[156:159], a[212:215], a[244:247], a[156:159]
M a[160:163], a[220:223], a[244:247], a[160:163]
M a[160:163], a[216:219], a[240:243], a[160:163]
s_add_u32 m0, s29, 2048
s_nop 0
buffer_load_dwordx4 v2, s[8:11], s23 offen offset:0 lds
M a[164:167], a[200:203], a[248:251], a[164:167]
ds_read_b128 a[240:243], v10 offset:22528
ds_read_b128 a[244:247], v11 offset:22528
M a[164:167], a[204:207], a[252:255], a[164:167]
M a[168:171], a[212:215], a[252:255], a[168:171]
M a[168:171], a[208:211], a[248:251], a[168:171]
buffer_load_dwordx4 v3, s[8:11], s23 offen offset:1024 lds
M a[172:175], a[216:219], a[248:251], a[172:175]
M a[172:175], a[220:223], a[252:255], a[172:175]
s_waitcnt lgkmcnt(4)
M a[68:71], a[176:179], a[224:227], a[68:71]
ds_read_b128 a[248:251], v10 offset:24576
ds_read_b128 a[252:255], v11 offset:24576
v_mov_b32 v160, 0
v_mov_b32 v161, 0
M a[68:71], a[180:183], a[228:231], a[68:71]
buffer_load_dwordx4 v4, s[8:11], s23 offen offset:2048 lds
M a[72:75], a[188:191], a[228:231], a[72:75]
ds_read_b64_tr_b16 a[200:201], v14 offset:28672
ds_read_b64_tr_b16 a[202:203], v14 offset:30208
v_mov_b32 v162, 0
v_mov_b32 v163, 0
M a[72:75], a[184:187], a[224:227], a[72:75]
M a[76:79], a[192:195], a[224:227], a[76:79]
buffer_load_dwordx4 v5, s[8:11], s23 offen offset:3072 lds
v_mov_b32 v164, 0
v_mov_b32 v165, 0
M a[76:79], a[196:199], a[228:231], a[76:79]
s_waitcnt lgkmcnt(6)
M a[80:83], a[180:183], a[236:239], a[80:83]
ds_read_b128 a[224:227], v10 offset:26624
ds_read_b128 a[228:231], v11 offset:26624
v_mov_b32 v166, 0
v_mov_b32 v167, 0
M a[80:83], a[176:179], a[232:235], a[80:83]
M a[84:87], a[184:187], a[232:235], a[84:87]
ds_read_b64_tr_b16 a[208:209], v15 offset:28672
ds_read_b64_tr_b16 a[210:211], v15 offset:30208
M a[84:87], a[188:191], a[236:239], a[84:87]
s_sub_u32 s31, s31, 1
s_cmp_eq_u32 s31, 0
s_cselect_b32 s58, -1920, s57
s_add_u32 s23, s23, s58
s_add_u32 s24, s24, s58
v_mov_b32 v168, 0
v_mov_b32 v169, 0
M a[88:91], a[196:199], a[236:239], a[88:91]
M a[88:91], a[192:195], a[232:235], a[88:91]
s_waitcnt lgkmcnt(8)
v_mov_b32 v170, 0
v_mov_b32 v171, 0
M a[92:95], a[176:179], a[240:243], a[92:95]
ds_read_b128 a[232:235], v10 offset:28672
ds_read_b128 a[236:239], v11 offset:28672
M a[92:95], a[180:183], a[244:247], a[92:95]
s_add_u32 m0, s30, 36864
s_nop 0
buffer_load_dwordx4 v6, s[12:15], s25 offen offset:0 lds
v_mov_b32 v172, 0
v_mov_b32 v173, 0
M a[96:99], a[188:191], a[244:247], a[96:99]
ds_read_b64_tr_b16 a[216:217], v16 offset:28672
ds_read_b64_tr_b16 a[218:219], v16 offset:30208
M a[96:99], a[184:187], a[240:243], a[96:99]
v_mov_b32 v174, 0
v_mov_b32 v175, 0
M a[100:103], a[192:195], a[240:243], a[100:103]
buffer_load_dwordx4 v7, s[12:15], s25 offen offset:1024 lds
M a[100:103], a[196:199], a[244:247], a[100:103]
s_waitcnt lgkmcnt(10)
M a[104:107], a[180:183], a[252:255], a[104:107]
ds_read_b128 a[240:243], v10 offset:30720
ds_read_b128 a[244:247], v11 offset:30720
v_mov_b32 v176, 0
v_mov_b32 v177, 0
M a[104:107], a[176:179], a[248:251], a[104:107]
M a[108:111], a[184:187], a[248:251], a[108:111]
ds_read_b64_tr_b16 a[204:205], v14 offset:40960
ds_read_b64_tr_b16 a[206:207], v14 offset:42496
v_mov_b32 v178, 0
v_mov_b32 v179, 0
M a[108:111], a[188:191], a[252:255], a[108:111]
buffer_load_dwordx4 v8, s[12:15], s25 offen offset:2048 lds
M a[112:115], a[196:199], a[252:255], a[112:115]
v_mov_b32 v180, 0
v_mov_b32 v181, 0
M a[112:115], a[192:195], a[248:251], a[112:115]
s_waitcnt lgkmcnt(10)
M a[116:119], a[176:179], a[224:227], a[116:119]
ds_read_b128 a[248:251], v10 offset:32768
ds_read_b128 a[252:255], v11 offset:32768
v_mov_b32 v182, 0
v_mov_b32 v183, 0
M a[116:119], a[180:183], a[228:231], a[116:119]
buffer_load_dwordx4 v9, s[12:15], s25 offen offset:3072 lds
M a[120:123], a[188:191], a[228:231], a[120:123]
ds_read_b64_tr_b16 a[212:213], v15 offset:40960
ds_read_b64_tr_b16 a[214:215], v15 offset:42496
M a[120:123], a[184:187], a[224:227], a[120:123]
v_mov_b32 v184, 0
v_mov_b32 v185, 0
M a[124:127], a[192:195], a[224:227], a[124:127]
s_add_u32 m0, s30, 40960
s_nop 0
buffer_load_dwordx4 v21, s[12:15], s25 offen offset:0 lds
M a[124:127], a[196:199], a[228:231], a[124:127]
s_waitcnt lgkmcnt(10)
v_mov_b32 v186, 0
v_mov_b32 v187, 0
M a[128:131], a[180:183], a[236:239], a[128:131]
ds_read_b128 a[224:227], v10 offset:34816
ds_read_b128 a[228:231], v11 offset:34816
M a[128:131], a[176:179], a[232:235], a[128:131]
v_mov_b32 v188, 0
v_mov_b32 v189, 0
M a[132:135], a[184:187], a[232:235], a[132:135]
ds_read_b64_tr_b16 a[220:221], v16 offset:40960
ds_read_b64_tr_b16 a[222:223], v16 offset:42496
M a[132:135], a[188:191], a[236:239], a[132:135]
buffer_load_dwordx4 v22, s[12:15], s25 offen offset:1024 lds
v_mov_b32 v190, 0
v_mov_b32 v191, 0
M a[136:139], a[196:199], a[236:239], a[136:139]
M a[136:139], a[192:195], a[232:235], a[136:139]
s_waitcnt lgkmcnt(10)
M a[140:143], a[176:179], a[240:243], a[140:143]
s_sub_u32 s54, s54, 1
s_cmp_eq_u32 s54, 0
s_cselect_b32 s58, s55, s56
s_add_u32 s25, s25, s58
v_mov_b32 v192, 0
v_mov_b32 v193, 0
M a[140:143], a[180:183], a[244:247], a[140:143]
M a[144:147], a[188:191], a[244:247], a[144:147]
v_mov_b32 v194, 0
v_mov_b32 v195, 0
M a[144:147], a[184:187], a[240:243], a[144:147]
M a[148:151], a[192:195], a[240:243], a[148:151]
s_waitcnt vmcnt(12) lgkmcnt(0)
s_barrier
ds_read_b128 a[232:235], v12 offset:0
ds_read_b128 a[236:239], v13 offset:0
v_mov_b32 v196, 0
v_mov_b32 v197, 0
M a[148:151], a[196:199], a[244:247], a[148:151]
s_add_u32 m0, s28, 18432
s_nop 0
buffer_load_dword v20, s[8:11], s24 offen lds
M a[152:155], a[180:183], a[252:255], a[152:155]
ds_read_b128 a[240:243], v12 offset:2048
ds_read_b128 a[244:247], v13 offset:2048
v_mov_b32 v198, 0
v_mov_b32 v199, 0
M a[152:155], a[176:179], a[248:251], a[152:155]
M a[156:159], a[184:187], a[248:251], a[156:159]
buffer_load_dword v23, s[8:11], s24 offen offset:256 lds
M a[156:159], a[188:191], a[252:255], a[156:159]
v_mov_b32 v200, 0
v_mov_b32 v201, 0
M a[160:163], a[196:199], a[252:255], a[160:163]
M a[160:163], a[192:195], a[248:251], a[160:163]
s_add_u32 m0, s29, 20480
s_nop 0
buffer_load_dwordx4 v2, s[8:11], s23 offen offset:0 lds
v_mov_b32 v202, 0
v_mov_b32 v203, 0
M a[164:167], a[176:179], a[224:227], a[164:167]
ds_read_b128 a[248:251], v12 offset:4096
ds_read_b128 a[252:255], v13 offset:4096
M a[164:167], a[180:183], a[228:231], a[164:167]
v_mov_b32 v204, 0
v_mov_b32 v205, 0
M a[168:171], a[188:191], a[228:231], a[168:171]
M a[168:171], a[184:187], a[224:227], a[168:171]
buffer_load_dwordx4 v3, s[8:11], s23 offen offset:1024 lds
v_mov_b32 v206, 0
v_mov_b32 v207, 0
M a[172:175], a[192:195], a[224:227], a[172:175]
M a[172:175], a[196:199], a[228:231], a[172:175]
s_waitcnt lgkmcnt(4)
M a[68:71], a[200:203], a[232:235], a[68:71]
ds_read_b128 a[224:227], v12 offset:6144
ds_read_b128 a[228:231], v13 offset:6144
v_and_b32 v128, 15, v0
v_mul_u32_u24 v128, 400, v128
M a[68:71], a[204:207], a[236:239], a[68:71]
buffer_load_dwordx4 v4, s[8:11], s23 offen offset:2048 lds
M a[72:75], a[212:215], a[236:239], a[72:75]
ds_read_b64_tr_b16 a[176:177], v17 offset:0
ds_read_b64_tr_b16 a[178:179], v17 offset:1536
v_lshrrev_b32 v129, 4, v0
v_lshl_add_u32 v128, v129, 3, v128
M a[72:75], a[208:211], a[232:235], a[72:75]
M a[76:79], a[216:219], a[232:235], a[76:79]
buffer_load_dwordx4 v5, s[8:11], s23 offen offset:3072 lds
s_mul_i32 s3, s20, 96
s_add_u32 s3, s3, 98304
M a[76:79], a[220:223], a[236:239], a[76:79]
s_waitcnt lgkmcnt(6)
M a[80:83], a[204:207], a[244:247], a[80:83]
ds_read_b128 a[232:235], v12 offset:8192
ds_read_b128 a[236:239], v13 offset:8192
v_add_u32 v124, s3, v128
v_and_b32 v128, 15, v0
M a[80:83], a[200:203], a[240:243], a[80:83]
M a[84:87], a[208:211], a[240:243], a[84:87]
ds_read_b64_tr_b16 a[184:185], v18 offset:0
ds_read_b64_tr_b16 a[186:187], v18 offset:1536
v_lshrrev_b32 v129, 4, v0
s_add_u32 s3, s21, 16
M a[84:87], a[212:215], a[244:247], a[84:87]
s_sub_u32 s31, s31, 1
s_cmp_eq_u32 s31, 0
s_cselect_b32 s58, -1920, s57
s_add_u32 s23, s23, s58
s_add_u32 s24, s24, s58
M a[88:91], a[220:223], a[244:247], a[88:91]
v_lshl_add_u32 v130, v128, 1, s3
s_lshl_b32 s4, s22, 6
M a[88:91], a[216:219], a[240:243], a[88:91]
s_waitcnt lgkmcnt(8)
M a[92:95], a[200:203], a[248:251], a[92:95]
ds_read_b128 a[240:243], v12 offset:10240
ds_read_b128 a[244:247], v13 offset:10240
s_add_u32 s4, s4, 98304
v_mul_u32_u24 v120, 400, v130
M a[92:95], a[204:207], a[252:255], a[92:95]
s_add_u32 m0, s30, 65536
s_nop 0
buffer_load_dwordx4 v6, s[12:15], s25 offen offset:0 lds
M a[96:99], a[212:215], a[252:255], a[96:99]
ds_read_b64_tr_b16 a[192:193], v19 offset:0
ds_read_b64_tr_b16 a[194:195], v19 offset:1536
M a[96:99], a[208:211], a[248:251], a[96:99]
v_lshl_add_u32 v120, v129, 4, v120
v_add_u32 v120, s4, v120
M a[100:103], a[216:219], a[248:251], a[100:103]
buffer_load_dwordx4 v7, s[12:15], s25 offen offset:1024 lds
M a[100:103], a[220:223], a[252:255], a[100:103]
s_waitcnt lgkmcnt(10)
v_subrev_u32 v130, 32, v130
v_max_i32 v130, 0, v130
M a[104:107], a[204:207], a[228:231], a[104:107]
ds_read_b128 a[248:251], v12 offset:12288
ds_read_b128 a[252:255], v13 offset:12288
M a[104:107], a[200:203], a[224:227], a[104:107]
v_mul_u32_u24 v121, 400, v130
v_lshl_add_u32 v121, v129, 4, v121
M a[108:111], a[208:211], a[224:227], a[108:111]
ds_read_b64_tr_b16 a[180:181], v17 offset:12288
ds_read_b64_tr_b16 a[182:183], v17 offset:13824
M a[108:111], a[212:215], a[228:231], a[108:111]
buffer_load_dwordx4 v8, s[12:15], s25 offen offset:2048 lds
v_add_u32 v121, s4, v121
v_bfe_u32 v131, v0, 2, 2
M a[112:115], a[220:223], a[228:231], a[112:115]
M a[112:115], a[216:219], a[224:227], a[112:115]
s_waitcnt lgkmcnt(10)
v_lshl_add_u32 v131, v129, 2, v131
v_lshl_add_u32 v131, v131, 1, s3
M a[116:119], a[200:203], a[232:235], a[116:119]
ds_read_b128 a[224:227], v12 offset:14336
ds_read_b128 a[228:231], v13 offset:14336
M a[116:119], a[204:207], a[236:239], a[116:119]
buffer_load_dwordx4 v9, s[12:15], s25 offen offset:3072 lds
v_and_b32 v132, 3, v0
v_lshlrev_b32 v132, 3, v132
M a[120:123], a[212:215], a[236:239], a[120:123]
ds_read_b64_tr_b16 a[188:189], v18 offset:12288
ds_read_b64_tr_b16 a[190:191], v18 offset:13824
M a[120:123], a[208:211], a[232:235], a[120:123]
M a[124:127], a[216:219], a[232:235], a[124:127]
s_add_u32 m0, s30, 69632
s_nop 0
buffer_load_dwordx4 v21, s[12:15], s25 offen offset:0 lds
v_add_u32 v132, s4, v132
s_movk_i32 s5, 400
M a[124:127], a[220:223], a[236:239], a[124:127]
s_waitcnt lgkmcnt(10)
M a[128:131], a[204:207], a[244:247], a[128:131]
ds_read_b128 a[232:235], v12 offset:16384
ds_read_b128 a[236:239], v13 offset:16384
v_mad_u32_u24 v122, v131, s5, v132
v_subrev_u32 v131, 32, v131
M a[128:131], a[200:203], a[240:243], a[128:131]
M a[132:135], a[208:211], a[240:243], a[132:135]
ds_read_b64_tr_b16 a[196:197], v19 offset:12288
ds_read_b64_tr_b16 a[198:199], v19 offset:13824
v_max_i32 v131, 0, v131
v_mad_u32_u24 v123, v131, s5, v132
M a[132:135], a[212:215], a[244:247], a[132:135]
buffer_load_dwordx4 v22, s[12:15], s25 offen offset:1024 lds
M a[136:139], a[220:223], a[244:247], a[136:139]
v_lshlrev_b32 v129, 2, v129
v_sub_u32 v128, v128, v129
M a[136:139], a[216:219], a[240:243], a[136:139]
s_waitcnt lgkmcnt(10)
M a[140:143], a[200:203], a[248:251], a[140:143]
s_sub_u32 s54, s54, 1
s_cmp_eq_u32 s54, 0
s_cselect_b32 s58, s55, s56
s_add_u32 s25, s25, s58
v_mov_b32 v129, 0xf149f2ca
s_cmp_eq_u32 s26, 0
s_cselect_b32 s3, 0xf149f2ca, 0
M a[140:143], a[204:207], a[252:255], a[140:143]
M a[144:147], a[212:215], a[252:255], a[144:147]
v_cmp_lt_i32 vcc, -9, v128
s_nop 1
v_cndmask_b32 v144, 0, v129, vcc
M a[144:147], a[208:211], a[248:251], a[144:147]
M a[148:151], a[216:219], a[248:251], a[148:151]
s_waitcnt vmcnt(12) lgkmcnt(0)
s_barrier
ds_read_b128 a[240:243], v10 offset:0
ds_read_b128 a[244:247], v11 offset:0
M a[148:151], a[220:223], a[252:255], a[148:151]
s_add_u32 m0, s28, 131072
s_nop 0
buffer_load_dword v20, s[8:11], s24 offen lds
v_subrev_u32 v130, 0, v128
v_cmp_lt_u32 vcc, 7, v130
s_nop 1
v_cndmask_b32 v148, 0, v129, vcc
M a[152:155], a[204:207], a[228:231], a[152:155]
ds_read_b128 a[248:251], v10 offset:2048
ds_read_b128 a[252:255], v11 offset:2048
M a[152:155], a[200:203], a[224:227], a[152:155]
v_min_f32 v152, s3, v144
v_mov_b32 v156, 0x3f803f80
M a[156:159], a[208:211], a[224:227], a[156:159]
buffer_load_dword v23, s[8:11], s24 offen offset:256 lds
M a[156:159], a[212:215], a[228:231], a[156:159]
v_cmp_lt_i32 vcc, -8, v128
s_nop 1
v_cndmask_b32 v145, 0, v129, vcc
M a[160:163], a[220:223], a[228:231], a[160:163]
M a[160:163], a[216:219], a[224:227], a[160:163]
s_add_u32 m0, s29, 133120
s_nop 0
buffer_load_dwordx4 v2, s[8:11], s23 offen offset:0 lds
v_subrev_u32 v130, 1, v128
v_cmp_lt_u32 vcc, 7, v130
s_nop 1
v_cndmask_b32 v149, 0, v129, vcc
M a[164:167], a[200:203], a[232:235], a[164:167]
ds_read_b128 a[224:227], v10 offset:4096
ds_read_b128 a[228:231], v11 offset:4096
M a[164:167], a[204:207], a[236:239], a[164:167]
v_min_f32 v153, s3, v145
v_mov_b32 v157, 0x3f803f80
M a[168:171], a[212:215], a[236:239], a[168:171]
M a[168:171], a[208:211], a[232:235], a[168:171]
buffer_load_dwordx4 v3, s[8:11], s23 offen offset:1024 lds
v_cmp_lt_i32 vcc, -7, v128
s_nop 1
v_cndmask_b32 v146, 0, v129, vcc
M a[172:175], a[216:219], a[232:235], a[172:175]
M a[172:175], a[220:223], a[236:239], a[172:175]
s_waitcnt lgkmcnt(4)
M a[68:71], a[176:179], a[240:243], a[68:71]
ds_read_b128 a[232:235], v10 offset:6144
ds_read_b128 a[236:239], v11 offset:6144
v_subrev_u32 v130, 2, v128
v_cmp_lt_u32 vcc, 7, v130
s_nop 1
v_cndmask_b32 v150, 0, v129, vcc
M a[68:71], a[180:183], a[244:247], a[68:71]
buffer_load_dwordx4 v4, s[8:11], s23 offen offset:2048 lds
v_min_f32 v154, s3, v146
v_mov_b32 v158, 0x3f803f80
M a[72:75], a[188:191], a[244:247], a[72:75]
ds_read_b64_tr_b16 a[200:201], v14 offset:0
ds_read_b64_tr_b16 a[202:203], v14 offset:1536
M a[72:75], a[184:187], a[240:243], a[72:75]
v_cmp_lt_i32 vcc, -6, v128
s_nop 1
v_cndmask_b32 v147, 0, v129, vcc
M a[76:79], a[192:195], a[240:243], a[76:79]
buffer_load_dwordx4 v5, s[8:11], s23 offen offset:3072 lds
v_subrev_u32 v130, 3, v128
v_cmp_lt_u32 vcc, 7, v130
s_nop 1
v_cndmask_b32 v151, 0, v129, vcc
M a[76:79], a[196:199], a[244:247], a[76:79]
s_waitcnt lgkmcnt(6)
M a[80:83], a[180:183], a[252:255], a[80:83]
ds_read_b128 a[240:243], v10 offset:8192
ds_read_b128 a[244:247], v11 offset:8192
v_min_f32 v155, s3, v147
v_mov_b32 v159, 0x3f803f80
M a[80:83], a[176:179], a[248:251], a[80:83]
s_add_u32 s16, s50, 83886080
s_addc_u32 s17, s51, 0
M a[84:87], a[184:187], a[248:251], a[84:87]
ds_read_b64_tr_b16 a[208:209], v15 offset:0
ds_read_b64_tr_b16 a[210:211], v15 offset:1536
M a[84:87], a[188:191], a[252:255], a[84:87]
s_sub_u32 s31, s31, 1
s_cmp_eq_u32 s31, 0
s_cselect_b32 s58, -1920, s57
s_add_u32 s23, s23, s58
s_add_u32 s24, s24, s58
s_mov_b32 s18, 4194304
s_mov_b32 s19, 0x00020000
M a[88:91], a[196:199], a[252:255], a[88:91]
s_lshl_b32 s3, s26, 18
s_lshl_b32 s4, s27, 14
M a[88:91], a[192:195], a[248:251], a[88:91]
s_waitcnt lgkmcnt(8)
M a[92:95], a[176:179], a[224:227], a[92:95]
ds_read_b128 a[248:251], v10 offset:10240
ds_read_b128 a[252:255], v11 offset:10240
s_add_u32 s3, s3, s4
s_lshl_b32 s4, s21, 13
M a[92:95], a[180:183], a[228:231], a[92:95]
s_add_u32 m0, s30, 98304
s_nop 0
buffer_load_dwordx4 v6, s[12:15], s25 offen offset:0 lds
s_add_u32 s3, s3, s4
s_lshl_b32 s4, s22, 10
M a[96:99], a[188:191], a[228:231], a[96:99]
ds_read_b64_tr_b16 a[216:217], v16 offset:0
ds_read_b64_tr_b16 a[218:219], v16 offset:1536
M a[96:99], a[184:187], a[224:227], a[96:99]
s_add_u32 s6, s3, s4
s_mov_b32 s7, 0x3e8293ee
M a[100:103], a[192:195], a[224:227], a[100:103]
buffer_load_dwordx4 v7, s[12:15], s25 offen offset:1024 lds
s_lshl_b32 s65, s26, 8
s_lshl_b32 s3, s27, 4
M a[100:103], a[196:199], a[228:231], a[100:103]
s_waitcnt lgkmcnt(10)
M a[104:107], a[180:183], a[236:239], a[104:107]
ds_read_b128 a[224:227], v10 offset:12288
ds_read_b128 a[228:231], v11 offset:12288
s_add_u32 s65, s65, s3
s_lshl_b32 s3, s101, 2
M a[104:107], a[176:179], a[232:235], a[104:107]
s_add_u32 s65, s65, s3
s_add_u32 s65, s65, 16789504
M a[108:111], a[184:187], a[232:235], a[108:111]
ds_read_b64_tr_b16 a[204:205], v14 offset:12288
ds_read_b64_tr_b16 a[206:207], v14 offset:13824
M a[108:111], a[188:191], a[236:239], a[108:111]
buffer_load_dwordx4 v8, s[12:15], s25 offen offset:2048 lds
s_mov_b32 s40, 0
v_mov_b32 v119, 0
M a[112:115], a[196:199], a[236:239], a[112:115]
s_mov_b64 s[4:5], s[50:51]
s_and_b32 s20, s2, 7
M a[112:115], a[192:195], a[232:235], a[112:115]
s_waitcnt lgkmcnt(10)
M a[116:119], a[176:179], a[240:243], a[116:119]
ds_read_b128 a[232:235], v10 offset:14336
ds_read_b128 a[236:239], v11 offset:14336
s_lshr_b32 s33, s2, 6
s_lshl_b32 s33, s33, 3
M a[116:119], a[180:183], a[244:247], a[116:119]
buffer_load_dwordx4 v9, s[12:15], s25 offen offset:3072 lds
s_add_u32 s20, s20, s33
s_bfe_u32 s21, s2, 0x30003
M a[120:123], a[188:191], a[244:247], a[120:123]
ds_read_b64_tr_b16 a[212:213], v15 offset:12288
ds_read_b64_tr_b16 a[214:215], v15 offset:13824
M a[120:123], a[184:187], a[240:243], a[120:123]
s_sub_u32 s35, 15, s21
s_cmp_lt_u32 s101, 2
s_cselect_b32 s35, s21, s35
M a[124:127], a[192:195], a[240:243], a[124:127]
s_add_u32 m0, s30, 102400
s_nop 0
buffer_load_dwordx4 v21, s[12:15], s25 offen offset:0 lds
s_lshl_b32 s33, s20, 7
s_lshl_b32 s34, s35, 3
M a[124:127], a[196:199], a[244:247], a[124:127]
s_waitcnt lgkmcnt(10)
M a[128:131], a[180:183], a[252:255], a[128:131]
ds_read_b128 a[240:243], v10 offset:16384
ds_read_b128 a[244:247], v11 offset:16384
s_add_u32 s33, s33, s34
s_and_b32 s34, s101, 1
M a[128:131], a[176:179], a[248:251], a[128:131]
s_lshl_b32 s34, s34, 2
s_add_u32 s33, s33, s34
M a[132:135], a[184:187], a[248:251], a[132:135]
ds_read_b64_tr_b16 a[220:221], v16 offset:12288
ds_read_b64_tr_b16 a[222:223], v16 offset:13824
M a[132:135], a[188:191], a[252:255], a[132:135]
buffer_load_dwordx4 v22, s[12:15], s25 offen offset:1024 lds
s_lshl_b32 s64, s33, 12
s_mov_b32 s44, s4
M a[136:139], a[196:199], a[252:255], a[136:139]
s_mov_b32 s45, s5
s_mov_b32 s46, 16777216
M a[136:139], a[192:195], a[248:251], a[136:139]
s_waitcnt lgkmcnt(10)
M a[140:143], a[176:179], a[224:227], a[140:143]
s_sub_u32 s54, s54, 1
s_cmp_eq_u32 s54, 0
s_cselect_b32 s58, s55, s56
s_add_u32 s25, s25, s58
s_mov_b32 s47, 0x00020000
M a[140:143], a[180:183], a[228:231], a[140:143]
M a[144:147], a[188:191], a[228:231], a[144:147]
M a[144:147], a[184:187], a[224:227], a[144:147]
M a[148:151], a[192:195], a[224:227], a[148:151]
s_waitcnt vmcnt(12) lgkmcnt(0)
s_barrier
ds_read_b128 a[248:251], v10 offset:18432
ds_read_b128 a[252:255], v11 offset:18432
M a[148:151], a[196:199], a[228:231], a[148:151]
s_add_u32 m0, s28, 0
s_nop 0
buffer_load_dword v20, s[8:11], s24 offen lds
M a[152:155], a[180:183], a[236:239], a[152:155]
ds_read_b128 a[224:227], v10 offset:20480
ds_read_b128 a[228:231], v11 offset:20480
M a[152:155], a[176:179], a[232:235], a[152:155]
M a[156:159], a[184:187], a[232:235], a[156:159]
buffer_load_dword v23, s[8:11], s24 offen offset:256 lds
M a[156:159], a[188:191], a[236:239], a[156:159]
M a[160:163], a[196:199], a[236:239], a[160:163]
M a[160:163], a[192:195], a[232:235], a[160:163]
s_add_u32 m0, s29, 2048
s_nop 0
buffer_load_dwordx4 v2, s[8:11], s23 offen offset:0 lds
M a[164:167], a[176:179], a[240:243], a[164:167]
ds_read_b128 a[232:235], v10 offset:22528
ds_read_b128 a[236:239], v11 offset:22528
M a[164:167], a[180:183], a[244:247], a[164:167]
M a[168:171], a[188:191], a[244:247], a[168:171]
M a[168:171], a[184:187], a[240:243], a[168:171]
buffer_load_dwordx4 v3, s[8:11], s23 offen offset:1024 lds
M a[172:175], a[192:195], a[240:243], a[172:175]
M a[172:175], a[196:199], a[244:247], a[172:175]
s_waitcnt lgkmcnt(4)
M a[68:71], a[200:203], a[248:251], a[68:71]
ds_read_b128 a[240:243], v10 offset:24576
ds_read_b128 a[244:247], v11 offset:24576
M a[68:71], a[204:207], a[252:255], a[68:71]
buffer_load_dwordx4 v4, s[8:11], s23 offen offset:2048 lds
M a[72:75], a[212:215], a[252:255], a[72:75]
ds_read_b64_tr_b16 a[176:177], v14 offset:28672
ds_read_b64_tr_b16 a[178:179], v14 offset:30208
M a[72:75], a[208:211], a[248:251], a[72:75]
M a[76:79], a[216:219], a[248:251], a[76:79]
buffer_load_dwordx4 v5, s[8:11], s23 offen offset:3072 lds
M a[76:79], a[220:223], a[252:255], a[76:79]
s_waitcnt lgkmcnt(6)
M a[80:83], a[204:207], a[228:231], a[80:83]
ds_read_b128 a[248:251], v10 offset:26624
ds_read_b128 a[252:255], v11 offset:26624
M a[80:83], a[200:203], a[224:227], a[80:83]
M a[84:87], a[208:211], a[224:227], a[84:87]
ds_read_b64_tr_b16 a[184:185], v15 offset:28672
ds_read_b64_tr_b16 a[186:187], v15 offset:30208
M a[84:87], a[212:215], a[228:231], a[84:87]
s_sub_u32 s31, s31, 1
s_cmp_eq_u32 s31, 0
s_cselect_b32 s58, -1920, s57
s_add_u32 s23, s23, s58
s_add_u32 s24, s24, s58
M a[88:91], a[220:223], a[228:231], a[88:91]
M a[88:91], a[216:219], a[224:227], a[88:91]
s_waitcnt lgkmcnt(8)
M a[92:95], a[200:203], a[232:235], a[92:95]
ds_read_b128 a[224:227], v10 offset:28672
ds_read_b128 a[228:231], v11 offset:28672
M a[92:95], a[204:207], a[236:239], a[92:95]
s_add_u32 m0, s30, 36864
s_nop 0
buffer_load_dwordx4 v6, s[12:15], s25 offen offset:0 lds
M a[96:99], a[212:215], a[236:239], a[96:99]
ds_read_b64_tr_b16 a[192:193], v16 offset:28672
ds_read_b64_tr_b16 a[194:195], v16 offset:30208
M a[96:99], a[208:211], a[232:235], a[96:99]
M a[100:103], a[216:219], a[232:235], a[100:103]
buffer_load_dwordx4 v7, s[12:15], s25 offen offset:1024 lds
M a[100:103], a[220:223], a[236:239], a[100:103]
s_waitcnt lgkmcnt(10)
M a[104:107], a[204:207], a[244:247], a[104:107]
ds_read_b128 a[232:235], v10 offset:30720
ds_read_b128 a[236:239], v11 offset:30720
M a[104:107], a[200:203], a[240:243], a[104:107]
M a[108:111], a[208:211], a[240:243], a[108:111]
ds_read_b64_tr_b16 a[180:181], v14 offset:40960
ds_read_b64_tr_b16 a[182:183], v14 offset:42496
M a[108:111], a[212:215], a[244:247], a[108:111]
buffer_load_dwordx4 v8, s[12:15], s25 offen offset:2048 lds
M a[112:115], a[220:223], a[244:247], a[112:115]
M a[112:115], a[216:219], a[240:243], a[112:115]
s_waitcnt lgkmcnt(10)
M a[116:119], a[200:203], a[248:251], a[116:119]
ds_read_b128 a[240:243], v10 offset:32768
ds_read_b128 a[244:247], v11 offset:32768
M a[116:119], a[204:207], a[252:255], a[116:119]
buffer_load_dwordx4 v9, s[12:15], s25 offen offset:3072 lds
M a[120:123], a[212:215], a[252:255], a[120:123]
ds_read_b64_tr_b16 a[188:189], v15 offset:40960
ds_read_b64_tr_b16 a[190:191], v15 offset:42496
M a[120:123], a[208:211], a[248:251], a[120:123]
M a[124:127], a[216:219], a[248:251], a[124:127]
s_add_u32 m0, s30, 40960
s_nop 0
buffer_load_dwordx4 v21, s[12:15], s25 offen offset:0 lds
M a[124:127], a[220:223], a[252:255], a[124:127]
s_waitcnt lgkmcnt(10)
M a[128:131], a[204:207], a[228:231], a[128:131]
ds_read_b128 a[248:251], v10 offset:34816
ds_read_b128 a[252:255], v11 offset:34816
M a[128:131], a[200:203], a[224:227], a[128:131]
M a[132:135], a[208:211], a[224:227], a[132:135]
ds_read_b64_tr_b16 a[196:197], v16 offset:40960
ds_read_b64_tr_b16 a[198:199], v16 offset:42496
M a[132:135], a[212:215], a[228:231], a[132:135]
buffer_load_dwordx4 v22, s[12:15], s25 offen offset:1024 lds
M a[136:139], a[220:223], a[228:231], a[136:139]
M a[136:139], a[216:219], a[224:227], a[136:139]
s_waitcnt lgkmcnt(10)
M a[140:143], a[200:203], a[232:235], a[140:143]
s_sub_u32 s54, s54, 1
s_cmp_eq_u32 s54, 0
s_cselect_b32 s58, s55, s56
s_add_u32 s25, s25, s58
M a[140:143], a[204:207], a[236:239], a[140:143]
M a[144:147], a[212:215], a[236:239], a[144:147]
M a[144:147], a[208:211], a[232:235], a[144:147]
M a[148:151], a[216:219], a[232:235], a[148:151]
s_waitcnt vmcnt(12) lgkmcnt(0)
s_barrier
ds_read_b128 a[224:227], v12 offset:0
ds_read_b128 a[228:231], v13 offset:0
M a[148:151], a[220:223], a[236:239], a[148:151]
s_add_u32 m0, s28, 18432
s_nop 0
buffer_load_dword v20, s[8:11], s24 offen lds
M a[152:155], a[204:207], a[244:247], a[152:155]
ds_read_b128 a[232:235], v12 offset:2048
ds_read_b128 a[236:239], v13 offset:2048
M a[152:155], a[200:203], a[240:243], a[152:155]
M a[156:159], a[208:211], a[240:243], a[156:159]
buffer_load_dword v23, s[8:11], s24 offen offset:256 lds
M a[156:159], a[212:215], a[244:247], a[156:159]
M a[160:163], a[220:223], a[244:247], a[160:163]
M a[160:163], a[216:219], a[240:243], a[160:163]
s_add_u32 m0, s29, 20480
s_nop 0
buffer_load_dwordx4 v2, s[8:11], s23 offen offset:0 lds
M a[164:167], a[200:203], a[248:251], a[164:167]
ds_read_b128 a[240:243], v12 offset:4096
ds_read_b128 a[244:247], v13 offset:4096
M a[164:167], a[204:207], a[252:255], a[164:167]
M a[168:171], a[212:215], a[252:255], a[168:171]
M a[168:171], a[208:211], a[248:251], a[168:171]
buffer_load_dwordx4 v3, s[8:11], s23 offen offset:1024 lds
M a[172:175], a[216:219], a[248:251], a[172:175]
M a[172:175], a[220:223], a[252:255], a[172:175]
s_waitcnt lgkmcnt(4)
M a[68:71], a[176:179], a[224:227], a[68:71]
ds_read_b128 a[248:251], v12 offset:6144
ds_read_b128 a[252:255], v13 offset:6144
M a[68:71], a[180:183], a[228:231], a[68:71]
buffer_load_dwordx4 v4, s[8:11], s23 offen offset:2048 lds
M a[72:75], a[188:191], a[228:231], a[72:75]
ds_read_b64_tr_b16 a[200:201], v17 offset:0
ds_read_b64_tr_b16 a[202:203], v17 offset:1536
M a[72:75], a[184:187], a[224:227], a[72:75]
M a[76:79], a[192:195], a[224:227], a[76:79]
buffer_load_dwordx4 v5, s[8:11], s23 offen offset:3072 lds
M a[76:79], a[196:199], a[228:231], a[76:79]
s_waitcnt lgkmcnt(6)
M a[80:83], a[180:183], a[236:239], a[80:83]
ds_read_b128 a[224:227], v12 offset:8192
ds_read_b128 a[228:231], v13 offset:8192
M a[80:83], a[176:179], a[232:235], a[80:83]
s_sub_u32 s31, s31, 1
s_cmp_eq_u32 s31, 0
s_cselect_b32 s58, -1920, s57
s_add_u32 s23, s23, s58
s_add_u32 s24, s24, s58
M a[84:87], a[184:187], a[232:235], a[84:87]
ds_read_b64_tr_b16 a[208:209], v18 offset:0
ds_read_b64_tr_b16 a[210:211], v18 offset:1536
M a[84:87], a[188:191], a[236:239], a[84:87]
M a[88:91], a[196:199], a[236:239], a[88:91]
M a[88:91], a[192:195], a[232:235], a[88:91]
s_add_u32 m0, s30, 65536
s_nop 0
buffer_load_dwordx4 v6, s[12:15], s25 offen offset:0 lds
s_waitcnt lgkmcnt(8)
M a[92:95], a[176:179], a[240:243], a[92:95]
ds_read_b128 a[232:235], v12 offset:10240
ds_read_b128 a[236:239], v13 offset:10240
M a[92:95], a[180:183], a[244:247], a[92:95]
M a[96:99], a[188:191], a[244:247], a[96:99]
ds_read_b64_tr_b16 a[216:217], v19 offset:0
ds_read_b64_tr_b16 a[218:219], v19 offset:1536
M a[96:99], a[184:187], a[240:243], a[96:99]
buffer_load_dwordx4 v7, s[12:15], s25 offen offset:1024 lds
M a[100:103], a[192:195], a[240:243], a[100:103]
M a[100:103], a[196:199], a[244:247], a[100:103]
s_waitcnt lgkmcnt(10)
M a[104:107], a[180:183], a[252:255], a[104:107]
ds_read_b128 a[240:243], v12 offset:12288
ds_read_b128 a[244:247], v13 offset:12288
M a[104:107], a[176:179], a[248:251], a[104:107]
buffer_load_dwordx4 v8, s[12:15], s25 offen offset:2048 lds
M a[108:111], a[184:187], a[248:251], a[108:111]
ds_read_b64_tr_b16 a[204:205], v17 offset:12288
ds_read_b64_tr_b16 a[206:207], v17 offset:13824
M a[108:111], a[188:191], a[252:255], a[108:111]
M a[112:115], a[196:199], a[252:255], a[112:115]
buffer_load_dwordx4 v9, s[12:15], s25 offen offset:3072 lds
M a[112:115], a[192:195], a[248:251], a[112:115]
s_waitcnt lgkmcnt(10)
M a[116:119], a[176:179], a[224:227], a[116:119]
ds_read_b128 a[248:251], v12 offset:14336
ds_read_b128 a[252:255], v13 offset:14336
M a[116:119], a[180:183], a[228:231], a[116:119]
M a[120:123], a[188:191], a[228:231], a[120:123]
ds_read_b64_tr_b16 a[212:213], v18 offset:12288
ds_read_b64_tr_b16 a[214:215], v18 offset:13824
M a[120:123], a[184:187], a[224:227], a[120:123]
s_add_u32 m0, s30, 69632
s_nop 0
buffer_load_dwordx4 v21, s[12:15], s25 offen offset:0 lds
M a[124:127], a[192:195], a[224:227], a[124:127]
M a[124:127], a[196:199], a[228:231], a[124:127]
buffer_load_dwordx4 v22, s[12:15], s25 offen offset:1024 lds
s_waitcnt lgkmcnt(10)
M a[128:131], a[180:183], a[236:239], a[128:131]
ds_read_b128 a[224:227], v12 offset:16384
ds_read_b128 a[228:231], v13 offset:16384
M a[128:131], a[176:179], a[232:235], a[128:131]
M a[132:135], a[184:187], a[232:235], a[132:135]
ds_read_b64_tr_b16 a[220:221], v19 offset:12288
ds_read_b64_tr_b16 a[222:223], v19 offset:13824
M a[132:135], a[188:191], a[236:239], a[132:135]
M a[136:139], a[196:199], a[236:239], a[136:139]
s_sub_u32 s54, s54, 1
s_cmp_eq_u32 s54, 0
s_cselect_b32 s58, s55, s56
s_add_u32 s25, s25, s58
M a[136:139], a[192:195], a[232:235], a[136:139]
s_waitcnt lgkmcnt(10)
M a[140:143], a[176:179], a[240:243], a[140:143]
buffer_load_dword v125, v119, s[36:39], 0 offen sc1
M a[140:143], a[180:183], a[244:247], a[140:143]
M a[144:147], a[188:191], a[244:247], a[144:147]
M a[144:147], a[184:187], a[240:243], a[144:147]
M a[148:151], a[192:195], a[240:243], a[148:151]
s_waitcnt vmcnt(13) lgkmcnt(0)
s_barrier
ds_read_b128 a[232:235], v10 offset:0
ds_read_b128 a[236:239], v11 offset:0
s_waitcnt vmcnt(0)
v_cmp_gt_u32 vcc, 0x80, v125
s_nop 0
s_cbranch_vccnz Lk1_spinq
Lk1_gotq:
M a[148:151], a[196:199], a[244:247], a[148:151]
s_add_u32 m0, s28, 131072
s_nop 0
buffer_load_dword v20, s[8:11], s24 offen lds
M a[152:155], a[180:183], a[252:255], a[152:155]
ds_read_b128 a[240:243], v10 offset:2048
ds_read_b128 a[244:247], v11 offset:2048
M a[152:155], a[176:179], a[248:251], a[152:155]
M a[156:159], a[184:187], a[248:251], a[156:159]
buffer_load_dword v23, s[8:11], s24 offen offset:256 lds
M a[156:159], a[188:191], a[252:255], a[156:159]
M a[160:163], a[196:199], a[252:255], a[160:163]
M a[160:163], a[192:195], a[248:251], a[160:163]
s_add_u32 m0, s29, 133120
s_nop 0
buffer_load_dwordx4 v2, s[8:11], s23 offen offset:0 lds
M a[164:167], a[176:179], a[224:227], a[164:167]
ds_read_b128 a[248:251], v10 offset:4096
ds_read_b128 a[252:255], v11 offset:4096
M a[164:167], a[180:183], a[228:231], a[164:167]
M a[168:171], a[188:191], a[228:231], a[168:171]
M a[168:171], a[184:187], a[224:227], a[168:171]
buffer_load_dwordx4 v3, s[8:11], s23 offen offset:1024 lds
M a[172:175], a[192:195], a[224:227], a[172:175]
M a[172:175], a[196:199], a[228:231], a[172:175]
s_waitcnt lgkmcnt(4)
M a[68:71], a[200:203], a[232:235], a[68:71]
ds_read_b128 a[224:227], v10 offset:6144
ds_read_b128 a[228:231], v11 offset:6144
v_mov_b32 v208, 0
v_mov_b32 v209, 0
M a[68:71], a[204:207], a[236:239], a[68:71]
buffer_load_dwordx4 v4, s[8:11], s23 offen offset:2048 lds
M a[72:75], a[212:215], a[236:239], a[72:75]
ds_read_b64_tr_b16 a[176:177], v14 offset:0
ds_read_b64_tr_b16 a[178:179], v14 offset:1536
v_mov_b32 v210, 0
v_mov_b32 v211, 0
M a[72:75], a[208:211], a[232:235], a[72:75]
M a[76:79], a[216:219], a[232:235], a[76:79]
buffer_load_dwordx4 v5, s[8:11], s23 offen offset:3072 lds
v_mov_b32 v212, 0
v_mov_b32 v213, 0
M a[76:79], a[220:223], a[236:239], a[76:79]
s_waitcnt lgkmcnt(6)
M a[80:83], a[204:207], a[244:247], a[80:83]
ds_read_b128 a[232:235], v10 offset:8192
ds_read_b128 a[236:239], v11 offset:8192
v_mov_b32 v214, 0
v_mov_b32 v215, 0
M a[80:83], a[200:203], a[240:243], a[80:83]
s_sub_u32 s31, s31, 1
s_cmp_eq_u32 s31, 0
s_cselect_b32 s58, -1920, s57
s_add_u32 s23, s23, s58
s_add_u32 s24, s24, s58
M a[84:87], a[208:211], a[240:243], a[84:87]
ds_read_b64_tr_b16 a[184:185], v15 offset:0
ds_read_b64_tr_b16 a[186:187], v15 offset:1536
M a[84:87], a[212:215], a[244:247], a[84:87]
v_mov_b32 v216, 0
v_mov_b32 v217, 0
M a[88:91], a[220:223], a[244:247], a[88:91]
M a[88:91], a[216:219], a[240:243], a[88:91]
buffer_load_dwordx4 a[0:3], v1, s[44:47], s64 offen offset:0 sc1
s_waitcnt lgkmcnt(8)
v_mov_b32 v218, 0
v_mov_b32 v219, 0
M a[92:95], a[200:203], a[248:251], a[92:95]
ds_read_b128 a[240:243], v10 offset:10240
ds_read_b128 a[244:247], v11 offset:10240
M a[92:95], a[204:207], a[252:255], a[92:95]
v_mov_b32 v220, 0
v_mov_b32 v221, 0
M a[96:99], a[212:215], a[252:255], a[96:99]
ds_read_b64_tr_b16 a[192:193], v16 offset:0
ds_read_b64_tr_b16 a[194:195], v16 offset:1536
M a[96:99], a[208:211], a[248:251], a[96:99]
buffer_load_dwordx4 a[4:7], v1, s[44:47], s64 offen offset:1024 sc1
v_mov_b32 v222, 0
v_mov_b32 v223, 0
M a[100:103], a[216:219], a[248:251], a[100:103]
M a[100:103], a[220:223], a[252:255], a[100:103]
s_waitcnt lgkmcnt(10)
M a[104:107], a[204:207], a[228:231], a[104:107]
ds_read_b128 a[248:251], v10 offset:12288
ds_read_b128 a[252:255], v11 offset:12288
v_mov_b32 v224, 0
v_mov_b32 v225, 0
M a[104:107], a[200:203], a[224:227], a[104:107]
buffer_load_dwordx4 a[8:11], v1, s[44:47], s64 offen offset:2048 sc1
M a[108:111], a[208:211], a[224:227], a[108:111]
ds_read_b64_tr_b16 a[180:181], v14 offset:12288
ds_read_b64_tr_b16 a[182:183], v14 offset:13824
v_mov_b32 v226, 0
v_mov_b32 v227, 0
M a[108:111], a[212:215], a[228:231], a[108:111]
M a[112:115], a[220:223], a[228:231], a[112:115]
buffer_load_dwordx4 a[12:15], v1, s[44:47], s64 offen offset:3072 sc1
s_add_u32 s64, s64, 4096
v_mov_b32 v228, 0
v_mov_b32 v229, 0
M a[112:115], a[216:219], a[224:227], a[112:115]
s_waitcnt lgkmcnt(10)
M a[116:119], a[200:203], a[232:235], a[116:119]
ds_read_b128 a[224:227], v10 offset:14336
ds_read_b128 a[228:231], v11 offset:14336
v_mov_b32 v230, 0
v_mov_b32 v231, 0
M a[116:119], a[204:207], a[236:239], a[116:119]
M a[120:123], a[212:215], a[236:239], a[120:123]
ds_read_b64_tr_b16 a[188:189], v15 offset:12288
ds_read_b64_tr_b16 a[190:191], v15 offset:13824
M a[120:123], a[208:211], a[232:235], a[120:123]
buffer_load_dwordx4 a[16:19], v1, s[44:47], s64 offen offset:0 sc1
v_mov_b32 v232, 0
v_mov_b32 v233, 0
M a[124:127], a[216:219], a[232:235], a[124:127]
M a[124:127], a[220:223], a[236:239], a[124:127]
buffer_load_dwordx4 a[20:23], v1, s[44:47], s64 offen offset:1024 sc1
s_waitcnt lgkmcnt(10)
v_mov_b32 v234, 0
v_mov_b32 v235, 0
M a[128:131], a[204:207], a[244:247], a[128:131]
ds_read_b128 a[232:235], v10 offset:16384
ds_read_b128 a[236:239], v11 offset:16384
M a[128:131], a[200:203], a[240:243], a[128:131]
v_mov_b32 v236, 0
v_mov_b32 v237, 0
M a[132:135], a[208:211], a[240:243], a[132:135]
ds_read_b64_tr_b16 a[196:197], v16 offset:12288
ds_read_b64_tr_b16 a[198:199], v16 offset:13824
M a[132:135], a[212:215], a[244:247], a[132:135]
v_mov_b32 v238, 0
v_mov_b32 v239, 0
M a[136:139], a[220:223], a[244:247], a[136:139]
buffer_load_dwordx4 a[24:27], v1, s[44:47], s64 offen offset:2048 sc1
M a[136:139], a[216:219], a[240:243], a[136:139]
s_waitcnt lgkmcnt(10)
M a[140:143], a[200:203], a[248:251], a[140:143]
buffer_load_dwordx4 a[28:31], v1, s[44:47], s64 offen offset:3072 sc1
s_add_u32 s64, s64, 4096
v_mov_b32 v240, 0
v_mov_b32 v241, 0
M a[140:143], a[204:207], a[252:255], a[140:143]
M a[144:147], a[212:215], a[252:255], a[144:147]
v_mov_b32 v242, 0
v_mov_b32 v243, 0
M a[144:147], a[208:211], a[248:251], a[144:147]
M a[148:151], a[216:219], a[248:251], a[148:151]
s_waitcnt vmcnt(15) lgkmcnt(0)
s_barrier
ds_read_b128 a[240:243], v10 offset:18432
ds_read_b128 a[244:247], v11 offset:18432
v_mov_b32 v244, 0
v_mov_b32 v245, 0
M a[148:151], a[220:223], a[252:255], a[148:151]
buffer_load_dwordx4 a[32:35], v1, s[44:47], s64 offen offset:0 sc1
M a[152:155], a[204:207], a[228:231], a[152:155]
ds_read_b128 a[248:251], v10 offset:20480
ds_read_b128 a[252:255], v11 offset:20480
v_mov_b32 v246, 0
v_mov_b32 v247, 0
M a[152:155], a[200:203], a[224:227], a[152:155]
M a[156:159], a[208:211], a[224:227], a[156:159]
buffer_load_dwordx4 a[36:39], v1, s[44:47], s64 offen offset:1024 sc1
M a[156:159], a[212:215], a[228:231], a[156:159]
v_mov_b32 v248, 0
v_mov_b32 v249, 0
M a[160:163], a[220:223], a[228:231], a[160:163]
M a[160:163], a[216:219], a[224:227], a[160:163]
buffer_load_dwordx4 a[40:43], v1, s[44:47], s64 offen offset:2048 sc1
v_mov_b32 v250, 0
v_mov_b32 v251, 0
M a[164:167], a[200:203], a[232:235], a[164:167]
ds_read_b128 a[224:227], v10 offset:22528
ds_read_b128 a[228:231], v11 offset:22528
M a[164:167], a[204:207], a[236:239], a[164:167]
v_mov_b32 v252, 0
v_mov_b32 v253, 0
M a[168:171], a[212:215], a[236:239], a[168:171]
M a[168:171], a[208:211], a[232:235], a[168:171]
buffer_load_dwordx4 a[44:47], v1, s[44:47], s64 offen offset:3072 sc1
s_add_u32 s64, s64, 4096
v_mov_b32 v254, 0
v_mov_b32 v255, 0
M a[172:175], a[216:219], a[232:235], a[172:175]
M a[172:175], a[220:223], a[236:239], a[172:175]
s_waitcnt lgkmcnt(4)
M a[68:71], a[176:179], a[240:243], a[68:71]
ds_read_b128 a[232:235], v10 offset:24576
ds_read_b128 a[236:239], v11 offset:24576
s_mov_b32 s22, s101
s_and_b32 s23, s22, 1
M a[68:71], a[180:183], a[244:247], a[68:71]
buffer_load_dwordx4 a[48:51], v1, s[44:47], s64 offen offset:0 sc1
s_lshr_b32 s24, s22, 1
s_lshl_b32 s33, s24, 14
M a[72:75], a[188:191], a[244:247], a[72:75]
ds_read_b64_tr_b16 a[200:201], v14 offset:28672
ds_read_b64_tr_b16 a[202:203], v14 offset:30208
M a[72:75], a[184:187], a[240:243], a[72:75]
s_lshl_b32 s34, s23, 13
s_add_u32 s29, s33, s34
M a[76:79], a[192:195], a[240:243], a[76:79]
M a[76:79], a[196:199], a[244:247], a[76:79]
s_waitcnt lgkmcnt(6)
s_lshl_b32 s28, s20, 20
s_add_u32 s28, s28, s34
M a[80:83], a[180:183], a[252:255], a[80:83]
ds_read_b128 a[240:243], v10 offset:26624
ds_read_b128 a[244:247], v11 offset:26624
M a[80:83], a[176:179], a[248:251], a[80:83]
s_mov_b32 s25, s28
s_lshl_b32 s33, s21, 16
M a[84:87], a[184:187], a[248:251], a[84:87]
ds_read_b64_tr_b16 a[208:209], v15 offset:28672
ds_read_b64_tr_b16 a[210:211], v15 offset:30208
M a[84:87], a[188:191], a[252:255], a[84:87]
buffer_load_dwordx4 a[52:55], v1, s[44:47], s64 offen offset:1024 sc1
s_add_u32 s34, s28, s33
s_add_u32 s34, s34, 65536
M a[88:91], a[196:199], a[252:255], a[88:91]
M a[88:91], a[192:195], a[248:251], a[88:91]
s_waitcnt lgkmcnt(8)
s_add_u32 s32, s28, 491520
s_sub_u32 s33, s32, s33
M a[92:95], a[176:179], a[224:227], a[92:95]
ds_read_b128 a[248:251], v10 offset:28672
ds_read_b128 a[252:255], v11 offset:28672
M a[92:95], a[180:183], a[228:231], a[92:95]
s_add_u32 s33, s33, 491520
s_cmp_eq_u32 s24, 0
s_cselect_b32 s27, s34, s32
s_cselect_b32 s28, s32, s33
M a[96:99], a[188:191], a[228:231], a[96:99]
ds_read_b64_tr_b16 a[216:217], v16 offset:28672
ds_read_b64_tr_b16 a[218:219], v16 offset:30208
M a[96:99], a[184:187], a[224:227], a[96:99]
s_mov_b32 s56, s27
s_mov_b32 s57, s28
M a[100:103], a[192:195], a[224:227], a[100:103]
buffer_load_dwordx4 a[56:59], v1, s[44:47], s64 offen offset:2048 sc1
M a[100:103], a[196:199], a[228:231], a[100:103]
s_waitcnt lgkmcnt(10)
s_min_u32 s34, s34, s32
s_cmp_eq_u32 s34, s32
s_cselect_b32 s33, s33, s34
M a[104:107], a[180:183], a[236:239], a[104:107]
ds_read_b128 a[224:227], v10 offset:30720
ds_read_b128 a[228:231], v11 offset:30720
M a[104:107], a[176:179], a[232:235], a[104:107]
s_or_b32 s34, s34, 0x40000000
s_or_b32 s32, s25, 0x40000000
M a[108:111], a[184:187], a[232:235], a[108:111]
ds_read_b64_tr_b16 a[204:205], v14 offset:40960
ds_read_b64_tr_b16 a[206:207], v14 offset:42496
s_cmp_eq_u32 s24, 1
s_cselect_b32 s25, s32, s25
s_cselect_b32 s27, s34, s27
s_cselect_b32 s28, s33, s28
s_cselect_b32 s56, s56, -1
M a[108:111], a[188:191], a[236:239], a[108:111]
M a[112:115], a[196:199], a[236:239], a[112:115]
s_add_u32 s58, s56, 16384
s_add_u32 s59, s57, 16384
M a[112:115], a[192:195], a[232:235], a[112:115]
s_waitcnt lgkmcnt(10)
M a[116:119], a[176:179], a[240:243], a[116:119]
ds_read_b128 a[232:235], v10 offset:32768
ds_read_b128 a[236:239], v11 offset:32768
s_add_u32 s26, s25, 16384
s_add_u32 s62, s27, 16384
M a[116:119], a[180:183], a[244:247], a[116:119]
buffer_load_dwordx4 a[60:63], v1, s[44:47], s64 offen offset:3072 sc1
M a[120:123], a[188:191], a[244:247], a[120:123]
ds_read_b64_tr_b16 a[212:213], v15 offset:40960
ds_read_b64_tr_b16 a[214:215], v15 offset:42496
s_add_u32 s63, s28, 16384
s_lshl_b32 s31, s21, 7
M a[120:123], a[184:187], a[240:243], a[120:123]
M a[124:127], a[192:195], a[240:243], a[124:127]
s_cmp_eq_u32 s24, 0
s_cselect_b32 s31, s31, 960
M a[124:127], a[196:199], a[244:247], a[124:127]
s_waitcnt lgkmcnt(10)
M a[128:131], a[180:183], a[252:255], a[128:131]
ds_read_b128 a[240:243], v10 offset:34816
ds_read_b128 a[244:247], v11 offset:34816
s_mov_b32 s60, 0
s_add_u32 s12, s4, 16777216
s_addc_u32 s13, s5, 0
M a[128:131], a[176:179], a[248:251], a[128:131]
M a[132:135], a[184:187], a[248:251], a[132:135]
ds_read_b64_tr_b16 a[220:221], v16 offset:40960
ds_read_b64_tr_b16 a[222:223], v16 offset:42496
s_mov_b32 s14, 33554432
s_mov_b32 s15, 0x00020000
M a[132:135], a[188:191], a[252:255], a[132:135]
buffer_load_dword v126, v119, s[36:39], 0 offen offset:128 sc1
M a[136:139], a[196:199], a[252:255], a[136:139]
s_mov_b32 s8, s4
s_mov_b32 s9, s5
M a[136:139], a[192:195], a[248:251], a[136:139]
s_waitcnt lgkmcnt(10)
M a[140:143], a[176:179], a[224:227], a[140:143]
s_mov_b32 s10, 16777216
s_mov_b32 s11, 0x00020000
M a[140:143], a[180:183], a[228:231], a[140:143]
M a[144:147], a[188:191], a[228:231], a[144:147]
M a[144:147], a[184:187], a[224:227], a[144:147]
M a[148:151], a[192:195], a[224:227], a[148:151]
s_waitcnt vmcnt(17) lgkmcnt(0)
s_barrier
ds_read_b128 a[248:251], v12 offset:0
ds_read_b128 a[252:255], v13 offset:0
s_waitcnt vmcnt(0)
v_cmp_gt_u32 vcc, 0x80, v126
s_nop 0
s_cbranch_vccnz Lk1_spin
Lk1_got:
M a[148:151], a[196:199], a[228:231], a[148:151]
s_add_u32 m0, s29, 65536
s_add_u32 s32, s25, 4096
buffer_load_dwordx4 v1, s[12:15], s25 offen offset:0 sc1 lds
M a[152:155], a[180:183], a[236:239], a[152:155]
ds_read_b128 a[224:227], v12 offset:2048
ds_read_b128 a[228:231], v13 offset:2048
M a[152:155], a[176:179], a[232:235], a[152:155]
buffer_load_dwordx4 v1, s[12:15], s25 offen offset:1024 sc1 lds
M a[156:159], a[184:187], a[232:235], a[156:159]
M a[156:159], a[188:191], a[236:239], a[156:159]
buffer_load_dwordx4 v1, s[12:15], s25 offen offset:2048 sc1 lds
M a[160:163], a[196:199], a[236:239], a[160:163]
buffer_load_dwordx4 v1, s[12:15], s25 offen offset:3072 sc1 lds
M a[160:163], a[192:195], a[232:235], a[160:163]
M a[164:167], a[176:179], a[240:243], a[164:167]
ds_read_b128 a[232:235], v12 offset:4096
ds_read_b128 a[236:239], v13 offset:4096
M a[164:167], a[180:183], a[244:247], a[164:167]
s_add_u32 m0, s29, 69632
s_nop 0
buffer_load_dwordx4 v1, s[12:15], s32 offen offset:0 sc1 lds
M a[168:171], a[188:191], a[244:247], a[168:171]
buffer_load_dwordx4 v1, s[12:15], s32 offen offset:1024 sc1 lds
M a[168:171], a[184:187], a[240:243], a[168:171]
M a[172:175], a[192:195], a[240:243], a[172:175]
buffer_load_dwordx4 v1, s[12:15], s32 offen offset:2048 sc1 lds
M a[172:175], a[196:199], a[244:247], a[172:175]
s_waitcnt lgkmcnt(4)
M a[68:71], a[200:203], a[248:251], a[68:71]
ds_read_b128 a[240:243], v12 offset:6144
ds_read_b128 a[244:247], v13 offset:6144
M a[68:71], a[204:207], a[252:255], a[68:71]
buffer_load_dwordx4 v1, s[12:15], s32 offen offset:3072 sc1 lds
M a[72:75], a[212:215], a[252:255], a[72:75]
M a[72:75], a[208:211], a[248:251], a[72:75]
M a[76:79], a[216:219], a[248:251], a[76:79]
M a[76:79], a[220:223], a[252:255], a[76:79]
s_waitcnt lgkmcnt(4)
M a[80:83], a[204:207], a[228:231], a[80:83]
ds_read_b128 a[248:251], v12 offset:8192
ds_read_b128 a[252:255], v13 offset:8192
M a[80:83], a[200:203], a[224:227], a[80:83]
M a[84:87], a[208:211], a[224:227], a[84:87]
M a[84:87], a[212:215], a[228:231], a[84:87]
M a[88:91], a[220:223], a[228:231], a[88:91]
M a[88:91], a[216:219], a[224:227], a[88:91]
s_waitcnt lgkmcnt(4)
M a[92:95], a[200:203], a[232:235], a[92:95]
ds_read_b128 a[224:227], v12 offset:10240
ds_read_b128 a[228:231], v13 offset:10240
v_accvgpr_read_b32 v24, a68
v_accvgpr_read_b32 v25, a69
v_accvgpr_read_b32 v26, a70
M a[92:95], a[204:207], a[236:239], a[92:95]
v_accvgpr_read_b32 v27, a71
v_cvt_pk_bf16_f32 v24, v24, v25
v_cvt_pk_bf16_f32 v25, v26, v27
ds_write_b64 v124, v[24:25] offset:0
M a[96:99], a[212:215], a[236:239], a[96:99]
v_accvgpr_read_b32 v28, a72
v_accvgpr_read_b32 v29, a73
v_accvgpr_read_b32 v30, a74
M a[96:99], a[208:211], a[232:235], a[96:99]
v_accvgpr_read_b32 v31, a75
v_cvt_pk_bf16_f32 v28, v28, v29
v_cvt_pk_bf16_f32 v29, v30, v31
ds_write_b64 v124, v[28:29] offset:32
M a[100:103], a[216:219], a[232:235], a[100:103]
v_accvgpr_read_b32 v24, a76
v_accvgpr_read_b32 v25, a77
v_accvgpr_read_b32 v26, a78
M a[100:103], a[220:223], a[236:239], a[100:103]
s_waitcnt lgkmcnt(6)
v_accvgpr_read_b32 v27, a79
v_cvt_pk_bf16_f32 v24, v24, v25
v_cvt_pk_bf16_f32 v25, v26, v27
ds_write_b64 v124, v[24:25] offset:64
M a[104:107], a[204:207], a[244:247], a[104:107]
ds_read_b128 a[232:235], v12 offset:12288
ds_read_b128 a[236:239], v13 offset:12288
v_accvgpr_read_b32 v24, a80
v_accvgpr_read_b32 v25, a81
v_accvgpr_read_b32 v26, a82
M a[104:107], a[200:203], a[240:243], a[104:107]
v_accvgpr_read_b32 v27, a83
v_cvt_pk_bf16_f32 v24, v24, v25
v_cvt_pk_bf16_f32 v25, v26, v27
ds_write_b64 v124, v[24:25] offset:6400
M a[108:111], a[208:211], a[240:243], a[108:111]
v_accvgpr_read_b32 v28, a84
v_accvgpr_read_b32 v29, a85
v_accvgpr_read_b32 v30, a86
M a[108:111], a[212:215], a[244:247], a[108:111]
v_accvgpr_read_b32 v31, a87
v_cvt_pk_bf16_f32 v28, v28, v29
v_cvt_pk_bf16_f32 v29, v30, v31
ds_write_b64 v124, v[28:29] offset:6432
M a[112:115], a[220:223], a[244:247], a[112:115]
v_accvgpr_read_b32 v24, a88
v_accvgpr_read_b32 v25, a89
v_accvgpr_read_b32 v26, a90
M a[112:115], a[216:219], a[240:243], a[112:115]
s_waitcnt lgkmcnt(9)
v_accvgpr_read_b32 v27, a91
v_cvt_pk_bf16_f32 v24, v24, v25
v_cvt_pk_bf16_f32 v25, v26, v27
ds_write_b64 v124, v[24:25] offset:6464
M a[116:119], a[200:203], a[248:251], a[116:119]
ds_read_b128 a[240:243], v12 offset:14336
ds_read_b128 a[244:247], v13 offset:14336
v_accvgpr_read_b32 v24, a92
v_accvgpr_read_b32 v25, a93
v_accvgpr_read_b32 v26, a94
M a[116:119], a[204:207], a[252:255], a[116:119]
v_accvgpr_read_b32 v27, a95
v_cvt_pk_bf16_f32 v24, v24, v25
v_cvt_pk_bf16_f32 v25, v26, v27
ds_write_b64 v124, v[24:25] offset:12800
M a[120:123], a[212:215], a[252:255], a[120:123]
v_accvgpr_read_b32 v28, a96
v_accvgpr_read_b32 v29, a97
v_accvgpr_read_b32 v30, a98
M a[120:123], a[208:211], a[248:251], a[120:123]
v_accvgpr_read_b32 v31, a99
v_cvt_pk_bf16_f32 v28, v28, v29
v_cvt_pk_bf16_f32 v29, v30, v31
ds_write_b64 v124, v[28:29] offset:12832
M a[124:127], a[216:219], a[248:251], a[124:127]
v_accvgpr_read_b32 v24, a100
v_accvgpr_read_b32 v25, a101
v_accvgpr_read_b32 v26, a102
M a[124:127], a[220:223], a[252:255], a[124:127]
s_add_u32 s25, s25, 32768
s_cmp_eq_u32 s25, s27
s_cselect_b32 s25, s28, s25
s_cselect_b32 s27, s56, s27
s_cselect_b32 s28, s57, s28
s_cselect_b32 s56, -1, s56
s_waitcnt lgkmcnt(12)
v_accvgpr_read_b32 v27, a103
v_cvt_pk_bf16_f32 v24, v24, v25
v_cvt_pk_bf16_f32 v25, v26, v27
ds_write_b64 v124, v[24:25] offset:12864
M a[128:131], a[204:207], a[228:231], a[128:131]
ds_read_b128 a[248:251], v12 offset:16384
ds_read_b128 a[252:255], v13 offset:16384
v_accvgpr_read_b32 v24, a104
v_accvgpr_read_b32 v25, a105
v_accvgpr_read_b32 v26, a106
M a[128:131], a[200:203], a[224:227], a[128:131]
v_accvgpr_read_b32 v27, a107
v_cvt_pk_bf16_f32 v24, v24, v25
v_cvt_pk_bf16_f32 v25, v26, v27
ds_write_b64 v124, v[24:25] offset:19200
M a[132:135], a[208:211], a[224:227], a[132:135]
v_accvgpr_read_b32 v28, a108
v_accvgpr_read_b32 v29, a109
v_accvgpr_read_b32 v30, a110
M a[132:135], a[212:215], a[228:231], a[132:135]
v_accvgpr_read_b32 v31, a111
v_cvt_pk_bf16_f32 v28, v28, v29
v_cvt_pk_bf16_f32 v29, v30, v31
ds_write_b64 v124, v[28:29] offset:19232
M a[136:139], a[220:223], a[228:231], a[136:139]
v_accvgpr_read_b32 v24, a112
v_accvgpr_read_b32 v25, a113
v_accvgpr_read_b32 v26, a114
M a[136:139], a[216:219], a[224:227], a[136:139]
s_waitcnt lgkmcnt(12)
v_accvgpr_read_b32 v27, a115
v_cvt_pk_bf16_f32 v24, v24, v25
v_cvt_pk_bf16_f32 v25, v26, v27
ds_write_b64 v124, v[24:25] offset:19264
M a[140:143], a[200:203], a[232:235], a[140:143]
v_accvgpr_read_b32 v24, a116
v_accvgpr_read_b32 v25, a117
v_accvgpr_read_b32 v26, a118
M a[140:143], a[204:207], a[236:239], a[140:143]
v_accvgpr_read_b32 v27, a119
v_cvt_pk_bf16_f32 v24, v24, v25
v_cvt_pk_bf16_f32 v25, v26, v27
ds_write_b64 v124, v[24:25] offset:25600
M a[144:147], a[212:215], a[236:239], a[144:147]
v_accvgpr_read_b32 v28, a120
v_accvgpr_read_b32 v29, a121
v_accvgpr_read_b32 v30, a122
M a[144:147], a[208:211], a[232:235], a[144:147]
v_accvgpr_read_b32 v31, a123
v_cvt_pk_bf16_f32 v28, v28, v29
v_cvt_pk_bf16_f32 v29, v30, v31
ds_write_b64 v124, v[28:29] offset:25632
M a[148:151], a[216:219], a[232:235], a[148:151]
s_waitcnt lgkmcnt(0)
s_barrier
v_accvgpr_read_b32 v24, a124
v_accvgpr_read_b32 v25, a125
v_accvgpr_read_b32 v26, a126
M a[148:151], a[220:223], a[236:239], a[148:151]
v_accvgpr_read_b32 v27, a127
v_cvt_pk_bf16_f32 v24, v24, v25
v_cvt_pk_bf16_f32 v25, v26, v27
ds_write_b64 v124, v[24:25] offset:25664
v_accvgpr_read_b32 v24, a128
v_accvgpr_read_b32 v25, a129
v_accvgpr_read_b32 v26, a130
M a[152:155], a[204:207], a[244:247], a[152:155]
v_accvgpr_read_b32 v27, a131
v_cvt_pk_bf16_f32 v24, v24, v25
v_cvt_pk_bf16_f32 v25, v26, v27
M a[152:155], a[200:203], a[240:243], a[152:155]
ds_write_b64 v124, v[24:25] offset:32000
v_accvgpr_read_b32 v28, a132
v_accvgpr_read_b32 v29, a133
M a[156:159], a[208:211], a[240:243], a[156:159]
v_accvgpr_read_b32 v30, a134
v_accvgpr_read_b32 v31, a135
v_cvt_pk_bf16_f32 v28, v28, v29
M a[156:159], a[212:215], a[244:247], a[156:159]
v_cvt_pk_bf16_f32 v29, v30, v31
ds_write_b64 v124, v[28:29] offset:32032
v_accvgpr_read_b32 v24, a136
M a[160:163], a[220:223], a[244:247], a[160:163]
v_accvgpr_read_b32 v25, a137
v_accvgpr_read_b32 v26, a138
v_accvgpr_read_b32 v27, a139
M a[160:163], a[216:219], a[240:243], a[160:163]
v_cvt_pk_bf16_f32 v24, v24, v25
v_cvt_pk_bf16_f32 v25, v26, v27
ds_write_b64 v124, v[24:25] offset:32064
M a[164:167], a[200:203], a[248:251], a[164:167]
v_accvgpr_read_b32 v24, a140
v_accvgpr_read_b32 v25, a141
v_accvgpr_read_b32 v26, a142
M a[164:167], a[204:207], a[252:255], a[164:167]
v_accvgpr_read_b32 v27, a143
v_cvt_pk_bf16_f32 v24, v24, v25
v_cvt_pk_bf16_f32 v25, v26, v27
ds_write_b64 v124, v[24:25] offset:38400
M a[168:171], a[212:215], a[252:255], a[168:171]
v_accvgpr_read_b32 v28, a144
v_accvgpr_read_b32 v29, a145
v_accvgpr_read_b32 v30, a146
M a[168:171], a[208:211], a[248:251], a[168:171]
v_accvgpr_read_b32 v31, a147
v_cvt_pk_bf16_f32 v28, v28, v29
v_cvt_pk_bf16_f32 v29, v30, v31
ds_write_b64 v124, v[28:29] offset:38432
M a[172:175], a[216:219], a[248:251], a[172:175]
v_accvgpr_read_b32 v24, a148
v_accvgpr_read_b32 v25, a149
v_accvgpr_read_b32 v26, a150
M a[172:175], a[220:223], a[252:255], a[172:175]
v_accvgpr_read_b32 v27, a151
v_cvt_pk_bf16_f32 v24, v24, v25
v_cvt_pk_bf16_f32 v25, v26, v27
ds_write_b64 v124, v[24:25] offset:38464
s_mov_b64 s[44:45], s[42:43]
v_accvgpr_read_b32 v24, a152
v_accvgpr_read_b32 v25, a153
v_accvgpr_read_b32 v26, a154
v_accvgpr_read_b32 v27, a155
v_cvt_pk_bf16_f32 v24, v24, v25
v_cvt_pk_bf16_f32 v25, v26, v27
ds_write_b64 v124, v[24:25] offset:44800
v_accvgpr_read_b32 v28, a156
v_accvgpr_read_b32 v29, a157
v_accvgpr_read_b32 v30, a158
v_accvgpr_read_b32 v31, a159
v_cvt_pk_bf16_f32 v28, v28, v29
v_cvt_pk_bf16_f32 v29, v30, v31
ds_write_b64 v124, v[28:29] offset:44832
v_accvgpr_read_b32 v24, a160
v_accvgpr_read_b32 v25, a161
v_accvgpr_read_b32 v26, a162
v_accvgpr_read_b32 v27, a163
v_cvt_pk_bf16_f32 v24, v24, v25
v_cvt_pk_bf16_f32 v25, v26, v27
ds_write_b64 v124, v[24:25] offset:44864
v_accvgpr_read_b32 v24, a164
v_accvgpr_read_b32 v25, a165
v_accvgpr_read_b32 v26, a166
v_accvgpr_read_b32 v27, a167
v_cvt_pk_bf16_f32 v24, v24, v25
v_cvt_pk_bf16_f32 v25, v26, v27
ds_write_b64 v124, v[24:25] offset:51200
v_accvgpr_read_b32 v28, a168
v_accvgpr_read_b32 v29, a169
v_accvgpr_read_b32 v30, a170
v_accvgpr_read_b32 v31, a171
v_cvt_pk_bf16_f32 v28, v28, v29
v_cvt_pk_bf16_f32 v29, v30, v31
ds_write_b64 v124, v[28:29] offset:51232
v_accvgpr_read_b32 v24, a172
v_accvgpr_read_b32 v25, a173
v_accvgpr_read_b32 v26, a174
v_accvgpr_read_b32 v27, a175
v_cvt_pk_bf16_f32 v24, v24, v25
v_cvt_pk_bf16_f32 v25, v26, v27
ds_write_b64 v124, v[24:25] offset:51264
s_waitcnt lgkmcnt(0)
s_barrier
ds_read_b128 v[48:51], v121 offset:128
ds_read_b128 v[32:35], v120 offset:0
ds_read_b128 v[52:55], v120 offset:128
ds_read_b128 v[36:39], v120 offset:12800
ds_read_b128 v[56:59], v120 offset:12928
ds_read_b128 v[40:43], v120 offset:25600
ds_read_b128 v[60:63], v120 offset:25728
ds_read_b128 v[44:47], v120 offset:38400
ds_read_b128 v[64:67], v120 offset:38528
ds_read_b64_tr_b16 v[68:69], v123 offset:256
ds_read_b64_tr_b16 v[70:71], v122 offset:256
ds_read_b64_tr_b16 v[72:73], v122 offset:13056
ds_read_b64_tr_b16 v[74:75], v122 offset:25856
ds_read_b64_tr_b16 v[76:77], v122 offset:38656
ds_read_b64_tr_b16 v[78:79], v123 offset:288
ds_read_b64_tr_b16 v[80:81], v122 offset:288
ds_read_b64_tr_b16 v[82:83], v122 offset:13088
ds_read_b64_tr_b16 v[84:85], v122 offset:25888
ds_read_b64_tr_b16 v[86:87], v122 offset:38688
v_accvgpr_write_b32 a64, 0
v_accvgpr_write_b32 a65, 0
v_accvgpr_write_b32 a66, 0
v_accvgpr_write_b32 a67, 0
v_accvgpr_write_b32 a68, 0
v_accvgpr_write_b32 a69, 0
v_accvgpr_write_b32 a70, 0
v_accvgpr_write_b32 a71, 0
v_accvgpr_write_b32 a72, 0
v_accvgpr_write_b32 a73, 0
v_accvgpr_write_b32 a74, 0
v_accvgpr_write_b32 a75, 0
s_add_u32 m0, s29, 0
s_add_u32 s32, s25, 4096
buffer_load_dwordx4 v1, s[12:15], s25 offen offset:0 sc1 lds
v_accvgpr_write_b32 a76, 0
v_accvgpr_write_b32 a77, 0
v_accvgpr_write_b32 a78, 0
v_accvgpr_write_b32 a79, 0
v_accvgpr_write_b32 a80, 0
v_accvgpr_write_b32 a81, 0
v_accvgpr_write_b32 a82, 0
v_accvgpr_write_b32 a83, 0
v_accvgpr_write_b32 a84, 0
v_accvgpr_write_b32 a85, 0
v_accvgpr_write_b32 a86, 0
buffer_load_dwordx4 v1, s[12:15], s25 offen offset:1024 sc1 lds
v_accvgpr_write_b32 a87, 0
v_accvgpr_write_b32 a88, 0
v_accvgpr_write_b32 a89, 0
v_accvgpr_write_b32 a90, 0
v_accvgpr_write_b32 a91, 0
v_accvgpr_write_b32 a92, 0
v_accvgpr_write_b32 a93, 0
v_accvgpr_write_b32 a94, 0
v_accvgpr_write_b32 a95, 0
v_accvgpr_write_b32 a96, 0
buffer_load_dwordx4 v1, s[12:15], s25 offen offset:2048 sc1 lds
v_accvgpr_write_b32 a97, 0
v_accvgpr_write_b32 a98, 0
v_accvgpr_write_b32 a99, 0
v_accvgpr_write_b32 a100, 0
v_accvgpr_write_b32 a101, 0
v_accvgpr_write_b32 a102, 0
v_accvgpr_write_b32 a103, 0
v_accvgpr_write_b32 a104, 0
v_accvgpr_write_b32 a105, 0
v_accvgpr_write_b32 a106, 0
v_accvgpr_write_b32 a107, 0
buffer_load_dwordx4 v1, s[12:15], s25 offen offset:3072 sc1 lds
v_accvgpr_write_b32 a108, 0
v_accvgpr_write_b32 a109, 0
v_accvgpr_write_b32 a110, 0
v_accvgpr_write_b32 a111, 0
s_waitcnt lgkmcnt(15)
M v[88:91], v[48:51], v[32:35], v[152:155]
M v[92:95], v[52:55], v[32:35], v[148:151]
M v[96:99], v[52:55], v[36:39], v[144:147]
s_waitcnt lgkmcnt(14)
M v[100:103], v[56:59], v[36:39], v[148:151]
s_waitcnt lgkmcnt(13)
M v[104:107], v[56:59], v[40:43], v[144:147]
s_waitcnt lgkmcnt(12)
M v[108:111], v[60:63], v[40:43], v[148:151]
s_add_u32 m0, s29, 4096
s_nop 0
buffer_load_dwordx4 v1, s[12:15], s32 offen offset:0 sc1 lds
s_waitcnt lgkmcnt(11)
M v[112:115], v[60:63], v[44:47], v[144:147]
s_waitcnt lgkmcnt(10)
M v[116:119], v[64:67], v[44:47], v[148:151]
v_max3_f32 v136, v88, v89, v90
v_max3_f32 v136, v136, v91, v92
v_max3_f32 v136, v136, v93, v94
v_max_f32 v136, v136, v95
v_max3_f32 v137, v96, v97, v98
v_max3_f32 v137, v137, v99, v100
v_max3_f32 v137, v137, v101, v102
v_max_f32 v137, v137, v103
v_max3_f32 v138, v104, v105, v106
buffer_load_dwordx4 v1, s[12:15], s32 offen offset:1024 sc1 lds
v_max3_f32 v138, v138, v107, v108
v_max3_f32 v138, v138, v109, v110
v_max_f32 v138, v138, v111
v_max3_f32 v139, v112, v113, v114
v_max3_f32 v139, v139, v115, v116
v_max3_f32 v139, v139, v117, v118
v_max_f32 v139, v139, v119
v_mov_b32 v140, v136
v_mov_b32 v141, v137
v_mov_b32 v142, v138
buffer_load_dwordx4 v1, s[12:15], s32 offen offset:2048 sc1 lds
v_mov_b32 v143, v139
v_permlane16_swap_b32 v136, v140
v_permlane16_swap_b32 v137, v141
v_permlane16_swap_b32 v138, v142
v_permlane16_swap_b32 v139, v143
v_max_f32 v136, v136, v140
v_max_f32 v137, v137, v141
v_max_f32 v138, v138, v142
v_max_f32 v139, v139, v143
v_mov_b32 v140, v136
v_mov_b32 v141, v137
buffer_load_dwordx4 v1, s[12:15], s32 offen offset:3072 sc1 lds
v_mov_b32 v142, v138
v_mov_b32 v143, v139
v_permlane32_swap_b32 v136, v140
v_permlane32_swap_b32 v137, v141
v_permlane32_swap_b32 v138, v142
v_permlane32_swap_b32 v139, v143
v_max_f32 v136, v136, v140
v_max_f32 v137, v137, v141
v_max_f32 v138, v138, v142
v_max_f32 v139, v139, v143
s_add_u32 s25, s25, 32768
s_cmp_eq_u32 s25, s27
s_cselect_b32 s25, s28, s25
s_cselect_b32 s27, s56, s27
s_cselect_b32 s28, s57, s28
s_cselect_b32 s56, -1, s56
v_mul_f32 v136, s7, v136
v_mul_f32 v137, s7, v137
v_mul_f32 v138, s7, v138
v_mul_f32 v139, s7, v139
v_fma_f32 v88, v88, s7, -v136
v_fma_f32 v89, v89, s7, -v136
v_fma_f32 v90, v90, s7, -v136
v_fma_f32 v91, v91, s7, -v136
v_fma_f32 v92, v92, s7, -v136
v_fma_f32 v93, v93, s7, -v136
v_fma_f32 v94, v94, s7, -v136
s_add_u32 m0, s29, 32768
s_add_u32 s32, s26, 4096
buffer_load_dwordx4 v1, s[12:15], s26 offen offset:0 sc1 lds
v_fma_f32 v95, v95, s7, -v136
v_exp_f32 v88, v88
v_exp_f32 v89, v89
v_exp_f32 v90, v90
v_exp_f32 v91, v91
v_exp_f32 v92, v92
v_exp_f32 v93, v93
v_exp_f32 v94, v94
v_exp_f32 v95, v95
v_fma_f32 v96, v96, s7, -v137
v_fma_f32 v97, v97, s7, -v137
buffer_load_dwordx4 v1, s[12:15], s26 offen offset:1024 sc1 lds
v_fma_f32 v98, v98, s7, -v137
v_fma_f32 v99, v99, s7, -v137
v_fma_f32 v100, v100, s7, -v137
v_fma_f32 v101, v101, s7, -v137
v_fma_f32 v102, v102, s7, -v137
v_fma_f32 v103, v103, s7, -v137
v_exp_f32 v96, v96
v_exp_f32 v97, v97
v_exp_f32 v98, v98
v_exp_f32 v99, v99
buffer_load_dwordx4 v1, s[12:15], s26 offen offset:2048 sc1 lds
v_exp_f32 v100, v100
v_exp_f32 v101, v101
v_exp_f32 v102, v102
v_exp_f32 v103, v103
v_fma_f32 v104, v104, s7, -v138
v_fma_f32 v105, v105, s7, -v138
v_fma_f32 v106, v106, s7, -v138
v_fma_f32 v107, v107, s7, -v138
v_fma_f32 v108, v108, s7, -v138
v_fma_f32 v109, v109, s7, -v138
v_fma_f32 v110, v110, s7, -v138
buffer_load_dwordx4 v1, s[12:15], s26 offen offset:3072 sc1 lds
v_fma_f32 v111, v111, s7, -v138
v_exp_f32 v104, v104
v_exp_f32 v105, v105
v_exp_f32 v106, v106
v_exp_f32 v107, v107
v_exp_f32 v108, v108
v_exp_f32 v109, v109
v_exp_f32 v110, v110
v_exp_f32 v111, v111
v_fma_f32 v112, v112, s7, -v139
s_add_u32 m0, s29, 36864
s_nop 0
buffer_load_dwordx4 v1, s[12:15], s32 offen offset:0 sc1 lds
v_fma_f32 v113, v113, s7, -v139
v_fma_f32 v114, v114, s7, -v139
v_fma_f32 v115, v115, s7, -v139
v_fma_f32 v116, v116, s7, -v139
v_fma_f32 v117, v117, s7, -v139
v_fma_f32 v118, v118, s7, -v139
v_fma_f32 v119, v119, s7, -v139
v_exp_f32 v112, v112
v_exp_f32 v113, v113
v_exp_f32 v114, v114
v_exp_f32 v115, v115
buffer_load_dwordx4 v1, s[12:15], s32 offen offset:1024 sc1 lds
v_exp_f32 v116, v116
v_exp_f32 v117, v117
v_exp_f32 v118, v118
v_exp_f32 v119, v119
v_cvt_pk_bf16_f32 v88, v88, v89
v_cvt_pk_bf16_f32 v89, v90, v91
v_cvt_pk_bf16_f32 v90, v92, v93
v_cvt_pk_bf16_f32 v91, v94, v95
v_cvt_pk_bf16_f32 v96, v96, v97
v_cvt_pk_bf16_f32 v97, v98, v99
buffer_load_dwordx4 v1, s[12:15], s32 offen offset:2048 sc1 lds
v_cvt_pk_bf16_f32 v98, v100, v101
v_cvt_pk_bf16_f32 v99, v102, v103
v_cvt_pk_bf16_f32 v104, v104, v105
v_cvt_pk_bf16_f32 v105, v106, v107
v_cvt_pk_bf16_f32 v106, v108, v109
v_cvt_pk_bf16_f32 v107, v110, v111
v_cvt_pk_bf16_f32 v112, v112, v113
v_cvt_pk_bf16_f32 v113, v114, v115
v_cvt_pk_bf16_f32 v114, v116, v117
v_cvt_pk_bf16_f32 v115, v118, v119
M v[120:123], v[156:159], v[88:91], 0
buffer_load_dwordx4 v1, s[12:15], s32 offen offset:3072 sc1 lds
s_waitcnt lgkmcnt(8)
M v[32:35], v[68:71], v[88:91], 0
s_waitcnt lgkmcnt(3)
M v[36:39], v[78:81], v[88:91], 0
M v[124:127], v[156:159], v[96:99], 0
M v[40:43], v[70:73], v[96:99], 0
s_waitcnt lgkmcnt(2)
M v[44:47], v[80:83], v[96:99], 0
M v[128:131], v[156:159], v[104:107], 0
M v[48:51], v[72:75], v[104:107], 0
s_waitcnt lgkmcnt(1)
M v[52:55], v[82:85], v[104:107], 0
M v[132:135], v[156:159], v[112:115], 0
M v[56:59], v[74:77], v[112:115], 0
s_add_u32 s26, s26, 32768
s_cmp_eq_u32 s26, s62
s_cselect_b32 s26, s63, s26
s_cselect_b32 s62, s58, s62
s_cselect_b32 s63, s59, s63
s_cselect_b32 s58, -1, s58
s_waitcnt lgkmcnt(0)
M v[60:63], v[84:87], v[112:115], 0
v_rcp_f32 v120, v120
v_rcp_f32 v124, v124
v_rcp_f32 v128, v128
v_rcp_f32 v132, v132
v_pk_mul_f32 v[32:33], v[32:33], v[120:121] op_sel_hi:[1,0]
v_pk_mul_f32 v[34:35], v[34:35], v[120:121] op_sel_hi:[1,0]
v_pk_mul_f32 v[36:37], v[36:37], v[120:121] op_sel_hi:[1,0]
v_pk_mul_f32 v[38:39], v[38:39], v[120:121] op_sel_hi:[1,0]
v_cvt_pk_bf16_f32 v32, v32, v33
v_cvt_pk_bf16_f32 v33, v34, v35
v_cvt_pk_bf16_f32 v34, v36, v37
v_cvt_pk_bf16_f32 v35, v38, v39
s_add_u32 s3, s6, 0
buffer_store_dwordx4 v[32:35], v1, s[16:19], s3 offen sc1
v_pk_mul_f32 v[40:41], v[40:41], v[124:125] op_sel_hi:[1,0]
v_pk_mul_f32 v[42:43], v[42:43], v[124:125] op_sel_hi:[1,0]
v_pk_mul_f32 v[44:45], v[44:45], v[124:125] op_sel_hi:[1,0]
v_pk_mul_f32 v[46:47], v[46:47], v[124:125] op_sel_hi:[1,0]
v_cvt_pk_bf16_f32 v40, v40, v41
v_cvt_pk_bf16_f32 v41, v42, v43
v_cvt_pk_bf16_f32 v42, v44, v45
v_cvt_pk_bf16_f32 v43, v46, v47
s_add_u32 s3, s6, 2048
buffer_store_dwordx4 v[40:43], v1, s[16:19], s3 offen sc1
v_pk_mul_f32 v[48:49], v[48:49], v[128:129] op_sel_hi:[1,0]
v_pk_mul_f32 v[50:51], v[50:51], v[128:129] op_sel_hi:[1,0]
v_pk_mul_f32 v[52:53], v[52:53], v[128:129] op_sel_hi:[1,0]
v_pk_mul_f32 v[54:55], v[54:55], v[128:129] op_sel_hi:[1,0]
v_cvt_pk_bf16_f32 v48, v48, v49
v_cvt_pk_bf16_f32 v49, v50, v51
v_cvt_pk_bf16_f32 v50, v52, v53
v_cvt_pk_bf16_f32 v51, v54, v55
s_add_u32 s3, s6, 4096
buffer_store_dwordx4 v[48:51], v1, s[16:19], s3 offen sc1
v_pk_mul_f32 v[56:57], v[56:57], v[132:133] op_sel_hi:[1,0]
v_pk_mul_f32 v[58:59], v[58:59], v[132:133] op_sel_hi:[1,0]
v_pk_mul_f32 v[60:61], v[60:61], v[132:133] op_sel_hi:[1,0]
v_pk_mul_f32 v[62:63], v[62:63], v[132:133] op_sel_hi:[1,0]
v_cvt_pk_bf16_f32 v56, v56, v57
v_cvt_pk_bf16_f32 v57, v58, v59
v_cvt_pk_bf16_f32 v58, v60, v61
v_cvt_pk_bf16_f32 v59, v62, v63
s_add_u32 s3, s6, 6144
buffer_store_dwordx4 v[56:59], v1, s[16:19], s3 offen sc1
Lc2:
s_add_u32 s16, s4, 67108864
s_addc_u32 s17, s5, 0
s_mov_b32 s18, 16777216
s_mov_b32 s19, 0x00020000
s_add_u32 s52, s4, 100663296
s_addc_u32 s53, s5, 0
s_mov_b32 s54, 16793600
s_mov_b32 s55, 0x00020000
s_mov_b32 s46, 8388608
s_mov_b32 s47, 0x00020000
s_mov_b32 s50, 2097152
s_mov_b32 s51, 0x00020000
s_lshl_b32 s33, s24, 14
v_add_u32 v2, 0, v1
v_add_u32 v3, 0x10000, v2
v_mov_b32 v5, v2
v_mov_b32 v6, v3
v_and_b32 v8, 15, v0
v_bfe_u32 v9, v0, 4, 2
v_lshlrev_b32 v9, 2, v9
v_sub_u32 v8, v8, v9
v_mov_b32 v4, 0xf149f2ca
v_cmp_gt_i32 vcc, 0, v8
s_nop 1
v_cndmask_b32 v16, 0, v4, vcc
v_cmp_gt_i32 vcc, 1, v8
s_nop 1
v_cndmask_b32 v17, 0, v4, vcc
v_cmp_gt_i32 vcc, 2, v8
s_nop 1
v_cndmask_b32 v18, 0, v4, vcc
v_cmp_gt_i32 vcc, 3, v8
s_nop 1
v_cndmask_b32 v19, 0, v4, vcc
v_mov_b32 v8, 0x3f803f80
v_accvgpr_write_b32 a112, v8
v_accvgpr_write_b32 a113, v8
v_accvgpr_write_b32 a114, v8
v_accvgpr_write_b32 a115, v8
s_lshl_b32 s33, s23, 6
s_add_i32 s33, s33, s31
s_cmp_gt_i32 s33, 0
s_cselect_b32 s34, 0, 0xf149f2ca
s_cmp_lt_i32 s33, 0
s_cselect_b32 s33, 0xf149f2ca, 0
v_mov_b32 v20, s34
v_mov_b32 v21, s34
v_mov_b32 v22, s34
v_mov_b32 v23, s34
v_mov_b32 v28, s33
v_mov_b32 v29, s33
v_mov_b32 v30, s33
v_mov_b32 v31, s33
v_med3_f32 v24, v16, v20, v28
v_med3_f32 v25, v17, v20, v28
v_med3_f32 v26, v18, v20, v28
v_med3_f32 v27, v19, v20, v28
v_mov_b32 v12, 0
v_mov_b32 v13, 1
s_waitcnt vmcnt(20)
s_barrier
ds_read_b128 a[116:119], v3 offset:0
ds_read_b128 a[120:123], v3 offset:1024
ds_read_b128 a[124:127], v3 offset:2048
ds_read_b128 a[128:131], v3 offset:3072
ds_read_b128 a[132:135], v3 offset:4096
ds_read_b128 a[136:139], v3 offset:5120
ds_read_b128 a[140:143], v3 offset:6144
ds_read_b128 a[144:147], v3 offset:7168
s_waitcnt lgkmcnt(4)
M v[32:35], a[116:119], a[0:3], v[24:27]
M v[32:35], a[120:123], a[4:7], v[32:35]
ds_read_b128 a[148:151], v3 offset:8192
ds_read_b128 a[152:155], v3 offset:9216
M v[32:35], a[124:127], a[8:11], v[32:35]
M v[32:35], a[128:131], a[12:15], v[32:35]
M v[36:39], a[128:131], a[28:31], v[28:31]
M v[36:39], a[124:127], a[24:27], v[36:39]
M v[36:39], a[120:123], a[20:23], v[36:39]
M v[36:39], a[116:119], a[16:19], v[36:39]
M v[40:43], a[116:119], a[32:35], v[28:31]
M v[40:43], a[120:123], a[36:39], v[40:43]
ds_read_b128 a[156:159], v3 offset:10240
ds_read_b128 a[160:163], v3 offset:11264
M v[40:43], a[124:127], a[40:43], v[40:43]
M v[40:43], a[128:131], a[44:47], v[40:43]
M v[44:47], a[128:131], a[60:63], v[28:31]
M v[44:47], a[124:127], a[56:59], v[44:47]
M v[44:47], a[120:123], a[52:55], v[44:47]
M v[44:47], a[116:119], a[48:51], v[44:47]
s_waitcnt lgkmcnt(4)
M v[48:51], a[132:135], a[0:3], v[20:23]
M v[48:51], a[136:139], a[4:7], v[48:51]
ds_read_b128 a[164:167], v3 offset:12288
ds_read_b128 a[168:171], v3 offset:13312
M v[48:51], a[140:143], a[8:11], v[48:51]
M v[48:51], a[144:147], a[12:15], v[48:51]
M v[52:55], a[144:147], a[28:31], v[24:27]
M v[52:55], a[140:143], a[24:27], v[52:55]
M v[52:55], a[136:139], a[20:23], v[52:55]
M v[52:55], a[132:135], a[16:19], v[52:55]
M v[56:59], a[132:135], a[32:35], v[28:31]
M v[56:59], a[136:139], a[36:39], v[56:59]
ds_read_b128 a[172:175], v3 offset:14336
ds_read_b128 a[176:179], v3 offset:15360
M v[56:59], a[140:143], a[40:43], v[56:59]
M v[56:59], a[144:147], a[44:47], v[56:59]
M v[60:63], a[144:147], a[60:63], v[28:31]
M v[60:63], a[140:143], a[56:59], v[60:63]
M v[60:63], a[136:139], a[52:55], v[60:63]
M v[60:63], a[132:135], a[48:51], v[60:63]
s_waitcnt lgkmcnt(4)
M v[64:67], a[148:151], a[0:3], v[20:23]
M v[64:67], a[152:155], a[4:7], v[64:67]
M v[64:67], a[156:159], a[8:11], v[64:67]
M v[64:67], a[160:163], a[12:15], v[64:67]
M v[68:71], a[160:163], a[28:31], v[20:23]
M v[68:71], a[156:159], a[24:27], v[68:71]
M v[68:71], a[152:155], a[20:23], v[68:71]
M v[68:71], a[148:151], a[16:19], v[68:71]
M v[72:75], a[148:151], a[32:35], v[24:27]
M v[72:75], a[152:155], a[36:39], v[72:75]
M v[72:75], a[156:159], a[40:43], v[72:75]
M v[72:75], a[160:163], a[44:47], v[72:75]
M v[76:79], a[160:163], a[60:63], v[28:31]
M v[76:79], a[156:159], a[56:59], v[76:79]
s_waitcnt vmcnt(4) lgkmcnt(0)
s_barrier
ds_read_b128 a[116:119], v2 offset:0
ds_read_b128 a[120:123], v2 offset:1024
M v[76:79], a[152:155], a[52:55], v[76:79]
M v[76:79], a[148:151], a[48:51], v[76:79]
M v[80:83], a[164:167], a[0:3], v[20:23]
M v[80:83], a[168:171], a[4:7], v[80:83]
ds_read_b128 a[124:127], v2 offset:2048
ds_read_b128 a[128:131], v2 offset:3072
M v[80:83], a[172:175], a[8:11], v[80:83]
M v[80:83], a[176:179], a[12:15], v[80:83]
M v[84:87], a[176:179], a[28:31], v[20:23]
M v[84:87], a[172:175], a[24:27], v[84:87]
ds_read_b128 a[132:135], v2 offset:4096
ds_read_b128 a[136:139], v2 offset:5120
M v[84:87], a[168:171], a[20:23], v[84:87]
M v[84:87], a[164:167], a[16:19], v[84:87]
M v[88:91], a[164:167], a[32:35], v[20:23]
M v[88:91], a[168:171], a[36:39], v[88:91]
ds_read_b128 a[140:143], v2 offset:6144
ds_read_b128 a[144:147], v2 offset:7168
M v[88:91], a[172:175], a[40:43], v[88:91]
M v[88:91], a[176:179], a[44:47], v[88:91]
M v[92:95], a[176:179], a[60:63], v[24:27]
M v[92:95], a[172:175], a[56:59], v[92:95]
M v[92:95], a[168:171], a[52:55], v[92:95]
M v[92:95], a[164:167], a[48:51], v[92:95]
s_waitcnt vmcnt(0)
s_mov_b64 exec, 1
buffer_store_dword v13, v12, s[52:55], s65 offen sc1
s_mov_b64 exec, -1
v_exp_f32 v32, v32
v_exp_f32 v33, v33
v_exp_f32 v34, v34
v_exp_f32 v35, v35
v_exp_f32 v48, v48
v_exp_f32 v49, v49
v_exp_f32 v50, v50
v_exp_f32 v51, v51
v_cvt_pk_bf16_f32 v32, v32, v33
v_cvt_pk_bf16_f32 v33, v34, v35
v_exp_f32 v36, v36
v_exp_f32 v37, v37
v_exp_f32 v38, v38
v_exp_f32 v39, v39
v_cvt_pk_bf16_f32 v34, v48, v49
v_cvt_pk_bf16_f32 v35, v50, v51
v_exp_f32 v52, v52
v_exp_f32 v53, v53
v_exp_f32 v54, v54
v_exp_f32 v55, v55
v_cvt_pk_bf16_f32 v36, v36, v37
v_cvt_pk_bf16_f32 v37, v38, v39
v_exp_f32 v40, v40
v_exp_f32 v41, v41
v_exp_f32 v42, v42
v_exp_f32 v43, v43
v_cvt_pk_bf16_f32 v38, v52, v53
v_cvt_pk_bf16_f32 v39, v54, v55
v_exp_f32 v56, v56
v_exp_f32 v57, v57
v_exp_f32 v58, v58
v_exp_f32 v59, v59
v_cvt_pk_bf16_f32 v40, v40, v41
v_cvt_pk_bf16_f32 v41, v42, v43
v_exp_f32 v44, v44
v_exp_f32 v45, v45
v_exp_f32 v46, v46
v_exp_f32 v47, v47
v_cvt_pk_bf16_f32 v42, v56, v57
v_cvt_pk_bf16_f32 v43, v58, v59
v_exp_f32 v60, v60
v_exp_f32 v61, v61
v_exp_f32 v62, v62
v_exp_f32 v63, v63
v_cvt_pk_bf16_f32 v44, v44, v45
v_cvt_pk_bf16_f32 v45, v46, v47
v_cvt_pk_bf16_f32 v46, v60, v61
v_cvt_pk_bf16_f32 v47, v62, v63
s_cmp_eq_u32 s24, 1
s_cbranch_scc1 Lk2_g1
s_mov_b32 s30, s21
s_cmp_eq_u32 s21, 0
s_cbranch_scc1 Lk2_m2
Lk2_l1:
s_add_u32 m0, s29, 65536
s_waitcnt lgkmcnt(4)
M v[96:99], a[116:119], a[0:3], 0
v_exp_f32 v64, v64
M v[96:99], a[120:123], a[4:7], v[96:99]
ds_read_b128 a[148:151], v2 offset:8192
ds_read_b128 a[152:155], v2 offset:9216
M v[96:99], a[124:127], a[8:11], v[96:99]
v_exp_f32 v65, v65
M v[96:99], a[128:131], a[12:15], v[96:99]
buffer_load_dwordx4 v1, s[12:15], s25 offen offset:0 sc1 lds
s_add_u32 s32, s25, 4096
M v[100:103], a[128:131], a[28:31], 0
v_exp_f32 v66, v66
M v[100:103], a[124:127], a[24:27], v[100:103]
v_cvt_pk_bf16_f32 v64, v64, v65
M v[100:103], a[120:123], a[20:23], v[100:103]
v_exp_f32 v67, v67
M v[100:103], a[116:119], a[16:19], v[100:103]
buffer_load_dwordx4 v1, s[12:15], s25 offen offset:1024 sc1 lds
M v[104:107], a[116:119], a[32:35], 0
v_exp_f32 v80, v80
M v[104:107], a[120:123], a[36:39], v[104:107]
ds_read_b128 a[156:159], v2 offset:10240
ds_read_b128 a[160:163], v2 offset:11264
M v[104:107], a[124:127], a[40:43], v[104:107]
v_exp_f32 v81, v81
M v[104:107], a[128:131], a[44:47], v[104:107]
buffer_load_dwordx4 v1, s[12:15], s25 offen offset:2048 sc1 lds
M v[108:111], a[128:131], a[60:63], 0
v_exp_f32 v82, v82
M v[108:111], a[124:127], a[56:59], v[108:111]
v_cvt_pk_bf16_f32 v65, v66, v67
v_cvt_pk_bf16_f32 v66, v80, v81
M v[108:111], a[120:123], a[52:55], v[108:111]
v_exp_f32 v83, v83
M v[108:111], a[116:119], a[48:51], v[108:111]
buffer_load_dwordx4 v1, s[12:15], s25 offen offset:3072 sc1 lds
s_add_u32 m0, s29, 69632
s_waitcnt lgkmcnt(4)
M v[112:115], a[132:135], a[0:3], 0
v_exp_f32 v68, v68
M v[112:115], a[136:139], a[4:7], v[112:115]
ds_read_b128 a[164:167], v2 offset:12288
ds_read_b128 a[168:171], v2 offset:13312
M v[112:115], a[140:143], a[8:11], v[112:115]
v_exp_f32 v69, v69
M v[112:115], a[144:147], a[12:15], v[112:115]
buffer_load_dwordx4 v1, s[12:15], s32 offen offset:0 sc1 lds
M v[116:119], a[144:147], a[28:31], 0
v_exp_f32 v70, v70
M v[116:119], a[140:143], a[24:27], v[116:119]
v_cvt_pk_bf16_f32 v67, v82, v83
v_cvt_pk_bf16_f32 v68, v68, v69
M v[116:119], a[136:139], a[20:23], v[116:119]
v_exp_f32 v71, v71
M v[116:119], a[132:135], a[16:19], v[116:119]
buffer_load_dwordx4 v1, s[12:15], s32 offen offset:1024 sc1 lds
M v[120:123], a[132:135], a[32:35], 0
v_exp_f32 v84, v84
M v[120:123], a[136:139], a[36:39], v[120:123]
ds_read_b128 a[172:175], v2 offset:14336
ds_read_b128 a[176:179], v2 offset:15360
M v[120:123], a[140:143], a[40:43], v[120:123]
v_exp_f32 v85, v85
M v[120:123], a[144:147], a[44:47], v[120:123]
buffer_load_dwordx4 v1, s[12:15], s32 offen offset:2048 sc1 lds
M v[124:127], a[144:147], a[60:63], 0
v_exp_f32 v86, v86
M v[124:127], a[140:143], a[56:59], v[124:127]
v_cvt_pk_bf16_f32 v69, v70, v71
v_cvt_pk_bf16_f32 v70, v84, v85
M v[124:127], a[136:139], a[52:55], v[124:127]
v_exp_f32 v87, v87
M v[124:127], a[132:135], a[48:51], v[124:127]
buffer_load_dwordx4 v1, s[12:15], s32 offen offset:3072 sc1 lds
s_add_u32 m0, s29, 98304
s_waitcnt lgkmcnt(4)
M v[128:131], a[148:151], a[0:3], 0
v_exp_f32 v72, v72
M v[128:131], a[152:155], a[4:7], v[128:131]
ds_read_b128 a[116:119], v5 offset:32768
ds_read_b128 a[120:123], v5 offset:40960
M v[128:131], a[156:159], a[8:11], v[128:131]
v_exp_f32 v73, v73
M v[128:131], a[160:163], a[12:15], v[128:131]
buffer_load_dwordx4 v1, s[12:15], s26 offen offset:0 sc1 lds
s_add_u32 s43, s26, 4096
M v[132:135], a[160:163], a[28:31], 0
v_exp_f32 v74, v74
M v[132:135], a[156:159], a[24:27], v[132:135]
v_cvt_pk_bf16_f32 v71, v86, v87
v_cvt_pk_bf16_f32 v72, v72, v73
M v[132:135], a[152:155], a[20:23], v[132:135]
v_exp_f32 v75, v75
M v[132:135], a[148:151], a[16:19], v[132:135]
buffer_load_dwordx4 v1, s[12:15], s26 offen offset:1024 sc1 lds
M v[136:139], a[148:151], a[32:35], 0
v_exp_f32 v88, v88
M v[136:139], a[152:155], a[36:39], v[136:139]
ds_read_b128 a[124:127], v5 offset:33792
ds_read_b128 a[128:131], v5 offset:41984
M v[136:139], a[156:159], a[40:43], v[136:139]
v_exp_f32 v89, v89
M v[136:139], a[160:163], a[44:47], v[136:139]
buffer_load_dwordx4 v1, s[12:15], s26 offen offset:2048 sc1 lds
M v[140:143], a[160:163], a[60:63], 0
v_exp_f32 v90, v90
M v[140:143], a[156:159], a[56:59], v[140:143]
v_cvt_pk_bf16_f32 v73, v74, v75
v_cvt_pk_bf16_f32 v74, v88, v89
M v[140:143], a[152:155], a[52:55], v[140:143]
v_exp_f32 v91, v91
M v[140:143], a[148:151], a[48:51], v[140:143]
buffer_load_dwordx4 v1, s[12:15], s26 offen offset:3072 sc1 lds
s_add_u32 m0, s29, 102400
s_waitcnt lgkmcnt(4)
M v[144:147], a[164:167], a[0:3], 0
v_exp_f32 v76, v76
M v[144:147], a[168:171], a[4:7], v[144:147]
ds_read_b128 a[132:135], v5 offset:34816
ds_read_b128 a[136:139], v5 offset:43008
M v[144:147], a[172:175], a[8:11], v[144:147]
v_exp_f32 v77, v77
M v[144:147], a[176:179], a[12:15], v[144:147]
buffer_load_dwordx4 v1, s[12:15], s43 offen offset:0 sc1 lds
M v[148:151], a[176:179], a[28:31], 0
v_exp_f32 v78, v78
M v[148:151], a[172:175], a[24:27], v[148:151]
v_cvt_pk_bf16_f32 v75, v90, v91
v_cvt_pk_bf16_f32 v76, v76, v77
M v[148:151], a[168:171], a[20:23], v[148:151]
v_exp_f32 v79, v79
M v[148:151], a[164:167], a[16:19], v[148:151]
buffer_load_dwordx4 v1, s[12:15], s43 offen offset:1024 sc1 lds
M v[152:155], a[164:167], a[32:35], 0
v_exp_f32 v92, v92
M v[152:155], a[168:171], a[36:39], v[152:155]
ds_read_b128 a[140:143], v5 offset:35840
ds_read_b128 a[144:147], v5 offset:44032
M v[152:155], a[172:175], a[40:43], v[152:155]
v_exp_f32 v93, v93
M v[152:155], a[176:179], a[44:47], v[152:155]
buffer_load_dwordx4 v1, s[12:15], s43 offen offset:2048 sc1 lds
M v[156:159], a[176:179], a[60:63], 0
v_exp_f32 v94, v94
M v[156:159], a[172:175], a[56:59], v[156:159]
v_cvt_pk_bf16_f32 v77, v78, v79
v_cvt_pk_bf16_f32 v78, v92, v93
M v[156:159], a[168:171], a[52:55], v[156:159]
v_exp_f32 v95, v95
M v[156:159], a[164:167], a[48:51], v[156:159]
buffer_load_dwordx4 v1, s[12:15], s43 offen offset:3072 sc1 lds
v_cvt_pk_bf16_f32 v79, v94, v95
s_waitcnt lgkmcnt(6)
M v[160:163], a[116:119], v[32:35], v[160:163]
v_exp_f32 v96, v96
M v[160:163], a[120:123], v[64:67], v[160:163]
ds_read_b128 a[148:151], v5 offset:36864
ds_read_b128 a[152:155], v5 offset:45056
M v[164:167], a[120:123], v[68:71], v[164:167]
v_exp_f32 v97, v97
M v[164:167], a[116:119], v[36:39], v[164:167]
v_cvt_pk_bf16_f32 v96, v96, v97
M v[168:171], a[116:119], v[40:43], v[168:171]
v_exp_f32 v98, v98
M v[168:171], a[120:123], v[72:75], v[168:171]
s_add_u32 s25, s25, 32768
s_cmp_eq_u32 s25, s27
M v[172:175], a[120:123], v[76:79], v[172:175]
v_exp_f32 v99, v99
M v[172:175], a[116:119], v[44:47], v[172:175]
v_cvt_pk_bf16_f32 v97, v98, v99
s_waitcnt lgkmcnt(6)
M a[96:99], a[112:115], v[32:35], a[96:99]
s_cselect_b32 s25, s28, s25
s_cselect_b32 s27, -1, s27
M a[96:99], a[112:115], v[64:67], a[96:99]
s_add_u32 s26, s26, 32768
s_cmp_eq_u32 s26, s62
M v[176:179], a[124:127], v[32:35], v[176:179]
v_exp_f32 v112, v112
M v[176:179], a[128:131], v[64:67], v[176:179]
ds_read_b128 a[156:159], v5 offset:37888
ds_read_b128 a[160:163], v5 offset:46080
M v[180:183], a[128:131], v[68:71], v[180:183]
v_exp_f32 v113, v113
M v[180:183], a[124:127], v[36:39], v[180:183]
v_cvt_pk_bf16_f32 v98, v112, v113
M v[184:187], a[124:127], v[40:43], v[184:187]
v_exp_f32 v114, v114
M v[184:187], a[128:131], v[72:75], v[184:187]
s_cselect_b32 s26, s63, s26
s_cselect_b32 s62, -1, s62
M v[188:191], a[128:131], v[76:79], v[188:191]
v_exp_f32 v115, v115
M v[188:191], a[124:127], v[44:47], v[188:191]
v_cvt_pk_bf16_f32 v99, v114, v115
s_waitcnt lgkmcnt(6)
M a[100:103], a[112:115], v[36:39], a[100:103]
M a[100:103], a[112:115], v[68:71], a[100:103]
M v[192:195], a[132:135], v[32:35], v[192:195]
v_exp_f32 v100, v100
M v[192:195], a[136:139], v[64:67], v[192:195]
ds_read_b128 a[164:167], v5 offset:38912
ds_read_b128 a[168:171], v5 offset:47104
M v[196:199], a[136:139], v[68:71], v[196:199]
v_exp_f32 v101, v101
M v[196:199], a[132:135], v[36:39], v[196:199]
v_cvt_pk_bf16_f32 v100, v100, v101
M v[200:203], a[132:135], v[40:43], v[200:203]
v_exp_f32 v102, v102
M v[200:203], a[136:139], v[72:75], v[200:203]
M v[204:207], a[136:139], v[76:79], v[204:207]
v_exp_f32 v103, v103
M v[204:207], a[132:135], v[44:47], v[204:207]
v_cvt_pk_bf16_f32 v101, v102, v103
s_waitcnt lgkmcnt(6)
M a[104:107], a[112:115], v[40:43], a[104:107]
M a[104:107], a[112:115], v[72:75], a[104:107]
M v[208:211], a[140:143], v[32:35], v[208:211]
v_exp_f32 v116, v116
M v[208:211], a[144:147], v[64:67], v[208:211]
ds_read_b128 a[172:175], v5 offset:39936
ds_read_b128 a[176:179], v5 offset:48128
M v[212:215], a[144:147], v[68:71], v[212:215]
v_exp_f32 v117, v117
M v[212:215], a[140:143], v[36:39], v[212:215]
v_cvt_pk_bf16_f32 v102, v116, v117
M v[216:219], a[140:143], v[40:43], v[216:219]
v_exp_f32 v118, v118
M v[216:219], a[144:147], v[72:75], v[216:219]
M v[220:223], a[144:147], v[76:79], v[220:223]
v_exp_f32 v119, v119
M v[220:223], a[140:143], v[44:47], v[220:223]
v_cvt_pk_bf16_f32 v103, v118, v119
s_waitcnt lgkmcnt(6)
M a[108:111], a[112:115], v[44:47], a[108:111]
M a[108:111], a[112:115], v[76:79], a[108:111]
M v[224:227], a[148:151], v[32:35], v[224:227]
v_exp_f32 v104, v104
M v[224:227], a[152:155], v[64:67], v[224:227]
M v[228:231], a[152:155], v[68:71], v[228:231]
v_exp_f32 v105, v105
M v[228:231], a[148:151], v[36:39], v[228:231]
v_cvt_pk_bf16_f32 v104, v104, v105
M v[232:235], a[148:151], v[40:43], v[232:235]
v_exp_f32 v106, v106
M v[232:235], a[152:155], v[72:75], v[232:235]
M v[236:239], a[152:155], v[76:79], v[236:239]
v_exp_f32 v107, v107
M v[236:239], a[148:151], v[44:47], v[236:239]
v_cvt_pk_bf16_f32 v105, v106, v107
s_waitcnt lgkmcnt(4)
M v[240:243], a[156:159], v[32:35], v[240:243]
v_exp_f32 v120, v120
M v[240:243], a[160:163], v[64:67], v[240:243]
M v[244:247], a[160:163], v[68:71], v[244:247]
v_exp_f32 v121, v121
M v[244:247], a[156:159], v[36:39], v[244:247]
v_cvt_pk_bf16_f32 v106, v120, v121
M v[248:251], a[156:159], v[40:43], v[248:251]
v_exp_f32 v122, v122
M v[248:251], a[160:163], v[72:75], v[248:251]
s_waitcnt vmcnt(0) lgkmcnt(0)
s_barrier
ds_read_b128 a[116:119], v3 offset:0
ds_read_b128 a[120:123], v3 offset:1024
M v[252:255], a[160:163], v[76:79], v[252:255]
v_exp_f32 v123, v123
M v[252:255], a[156:159], v[44:47], v[252:255]
v_cvt_pk_bf16_f32 v107, v122, v123
M a[64:67], a[164:167], v[32:35], a[64:67]
v_exp_f32 v108, v108
M a[64:67], a[168:171], v[64:67], a[64:67]
ds_read_b128 a[124:127], v3 offset:2048
ds_read_b128 a[128:131], v3 offset:3072
M a[68:71], a[168:171], v[68:71], a[68:71]
v_exp_f32 v109, v109
M a[68:71], a[164:167], v[36:39], a[68:71]
v_cvt_pk_bf16_f32 v108, v108, v109
M a[72:75], a[164:167], v[40:43], a[72:75]
v_exp_f32 v110, v110
M a[72:75], a[168:171], v[72:75], a[72:75]
ds_read_b128 a[132:135], v3 offset:4096
ds_read_b128 a[136:139], v3 offset:5120
M a[76:79], a[168:171], v[76:79], a[76:79]
v_exp_f32 v111, v111
M a[76:79], a[164:167], v[44:47], a[76:79]
v_cvt_pk_bf16_f32 v109, v110, v111
M a[80:83], a[172:175], v[32:35], a[80:83]
v_exp_f32 v124, v124
M a[80:83], a[176:179], v[64:67], a[80:83]
ds_read_b128 a[140:143], v3 offset:6144
ds_read_b128 a[144:147], v3 offset:7168
M a[84:87], a[176:179], v[68:71], a[84:87]
v_exp_f32 v125, v125
M a[84:87], a[172:175], v[36:39], a[84:87]
v_cvt_pk_bf16_f32 v110, v124, v125
M a[88:91], a[172:175], v[40:43], a[88:91]
v_exp_f32 v126, v126
M a[88:91], a[176:179], v[72:75], a[88:91]
M a[92:95], a[176:179], v[76:79], a[92:95]
v_exp_f32 v127, v127
M a[92:95], a[172:175], v[44:47], a[92:95]
v_cvt_pk_bf16_f32 v111, v126, v127
s_sub_u32 s30, s30, 1
s_cmp_eq_u32 s30, 0
s_cbranch_scc1 Lk2_m1
s_add_u32 m0, s29, 0
s_waitcnt lgkmcnt(4)
M v[32:35], a[116:119], a[0:3], 0
v_exp_f32 v128, v128
M v[32:35], a[120:123], a[4:7], v[32:35]
ds_read_b128 a[148:151], v3 offset:8192
ds_read_b128 a[152:155], v3 offset:9216
M v[32:35], a[124:127], a[8:11], v[32:35]
v_exp_f32 v129, v129
M v[32:35], a[128:131], a[12:15], v[32:35]
buffer_load_dwordx4 v1, s[12:15], s25 offen offset:0 sc1 lds
s_add_u32 s32, s25, 4096
M v[36:39], a[128:131], a[28:31], 0
v_exp_f32 v130, v130
M v[36:39], a[124:127], a[24:27], v[36:39]
v_cvt_pk_bf16_f32 v128, v128, v129
M v[36:39], a[120:123], a[20:23], v[36:39]
v_exp_f32 v131, v131
M v[36:39], a[116:119], a[16:19], v[36:39]
buffer_load_dwordx4 v1, s[12:15], s25 offen offset:1024 sc1 lds
M v[40:43], a[116:119], a[32:35], 0
v_exp_f32 v144, v144
M v[40:43], a[120:123], a[36:39], v[40:43]
ds_read_b128 a[156:159], v3 offset:10240
ds_read_b128 a[160:163], v3 offset:11264
M v[40:43], a[124:127], a[40:43], v[40:43]
v_exp_f32 v145, v145
M v[40:43], a[128:131], a[44:47], v[40:43]
buffer_load_dwordx4 v1, s[12:15], s25 offen offset:2048 sc1 lds
M v[44:47], a[128:131], a[60:63], 0
v_exp_f32 v146, v146
M v[44:47], a[124:127], a[56:59], v[44:47]
v_cvt_pk_bf16_f32 v129, v130, v131
v_cvt_pk_bf16_f32 v130, v144, v145
M v[44:47], a[120:123], a[52:55], v[44:47]
v_exp_f32 v147, v147
M v[44:47], a[116:119], a[48:51], v[44:47]
buffer_load_dwordx4 v1, s[12:15], s25 offen offset:3072 sc1 lds
s_add_u32 m0, s29, 4096
s_waitcnt lgkmcnt(4)
M v[48:51], a[132:135], a[0:3], 0
v_exp_f32 v132, v132
M v[48:51], a[136:139], a[4:7], v[48:51]
ds_read_b128 a[164:167], v3 offset:12288
ds_read_b128 a[168:171], v3 offset:13312
M v[48:51], a[140:143], a[8:11], v[48:51]
v_exp_f32 v133, v133
M v[48:51], a[144:147], a[12:15], v[48:51]
buffer_load_dwordx4 v1, s[12:15], s32 offen offset:0 sc1 lds
M v[52:55], a[144:147], a[28:31], 0
v_exp_f32 v134, v134
M v[52:55], a[140:143], a[24:27], v[52:55]
v_cvt_pk_bf16_f32 v131, v146, v147
v_cvt_pk_bf16_f32 v132, v132, v133
M v[52:55], a[136:139], a[20:23], v[52:55]
v_exp_f32 v135, v135
M v[52:55], a[132:135], a[16:19], v[52:55]
buffer_load_dwordx4 v1, s[12:15], s32 offen offset:1024 sc1 lds
M v[56:59], a[132:135], a[32:35], 0
v_exp_f32 v148, v148
M v[56:59], a[136:139], a[36:39], v[56:59]
ds_read_b128 a[172:175], v3 offset:14336
ds_read_b128 a[176:179], v3 offset:15360
M v[56:59], a[140:143], a[40:43], v[56:59]
v_exp_f32 v149, v149
M v[56:59], a[144:147], a[44:47], v[56:59]
buffer_load_dwordx4 v1, s[12:15], s32 offen offset:2048 sc1 lds
M v[60:63], a[144:147], a[60:63], 0
v_exp_f32 v150, v150
M v[60:63], a[140:143], a[56:59], v[60:63]
v_cvt_pk_bf16_f32 v133, v134, v135
v_cvt_pk_bf16_f32 v134, v148, v149
M v[60:63], a[136:139], a[52:55], v[60:63]
v_exp_f32 v151, v151
M v[60:63], a[132:135], a[48:51], v[60:63]
buffer_load_dwordx4 v1, s[12:15], s32 offen offset:3072 sc1 lds
s_add_u32 m0, s29, 32768
s_waitcnt lgkmcnt(4)
M v[64:67], a[148:151], a[0:3], 0
v_exp_f32 v136, v136
M v[64:67], a[152:155], a[4:7], v[64:67]
ds_read_b128 a[116:119], v6 offset:32768
ds_read_b128 a[120:123], v6 offset:40960
M v[64:67], a[156:159], a[8:11], v[64:67]
v_exp_f32 v137, v137
M v[64:67], a[160:163], a[12:15], v[64:67]
buffer_load_dwordx4 v1, s[12:15], s26 offen offset:0 sc1 lds
s_add_u32 s43, s26, 4096
M v[68:71], a[160:163], a[28:31], 0
v_exp_f32 v138, v138
M v[68:71], a[156:159], a[24:27], v[68:71]
v_cvt_pk_bf16_f32 v135, v150, v151
v_cvt_pk_bf16_f32 v136, v136, v137
M v[68:71], a[152:155], a[20:23], v[68:71]
v_exp_f32 v139, v139
M v[68:71], a[148:151], a[16:19], v[68:71]
buffer_load_dwordx4 v1, s[12:15], s26 offen offset:1024 sc1 lds
M v[72:75], a[148:151], a[32:35], 0
v_exp_f32 v152, v152
M v[72:75], a[152:155], a[36:39], v[72:75]
ds_read_b128 a[124:127], v6 offset:33792
ds_read_b128 a[128:131], v6 offset:41984
M v[72:75], a[156:159], a[40:43], v[72:75]
v_exp_f32 v153, v153
M v[72:75], a[160:163], a[44:47], v[72:75]
buffer_load_dwordx4 v1, s[12:15], s26 offen offset:2048 sc1 lds
M v[76:79], a[160:163], a[60:63], 0
v_exp_f32 v154, v154
M v[76:79], a[156:159], a[56:59], v[76:79]
v_cvt_pk_bf16_f32 v137, v138, v139
v_cvt_pk_bf16_f32 v138, v152, v153
M v[76:79], a[152:155], a[52:55], v[76:79]
v_exp_f32 v155, v155
M v[76:79], a[148:151], a[48:51], v[76:79]
buffer_load_dwordx4 v1, s[12:15], s26 offen offset:3072 sc1 lds
s_add_u32 m0, s29, 36864
s_waitcnt lgkmcnt(4)
M v[80:83], a[164:167], a[0:3], 0
v_exp_f32 v140, v140
M v[80:83], a[168:171], a[4:7], v[80:83]
ds_read_b128 a[132:135], v6 offset:34816
ds_read_b128 a[136:139], v6 offset:43008
M v[80:83], a[172:175], a[8:11], v[80:83]
v_exp_f32 v141, v141
M v[80:83], a[176:179], a[12:15], v[80:83]
buffer_load_dwordx4 v1, s[12:15], s43 offen offset:0 sc1 lds
M v[84:87], a[176:179], a[28:31], 0
v_exp_f32 v142, v142
M v[84:87], a[172:175], a[24:27], v[84:87]
v_cvt_pk_bf16_f32 v139, v154, v155
v_cvt_pk_bf16_f32 v140, v140, v141
M v[84:87], a[168:171], a[20:23], v[84:87]
v_exp_f32 v143, v143
M v[84:87], a[164:167], a[16:19], v[84:87]
buffer_load_dwordx4 v1, s[12:15], s43 offen offset:1024 sc1 lds
M v[88:91], a[164:167], a[32:35], 0
v_exp_f32 v156, v156
M v[88:91], a[168:171], a[36:39], v[88:91]
ds_read_b128 a[140:143], v6 offset:35840
ds_read_b128 a[144:147], v6 offset:44032
M v[88:91], a[172:175], a[40:43], v[88:91]
v_exp_f32 v157, v157
M v[88:91], a[176:179], a[44:47], v[88:91]
buffer_load_dwordx4 v1, s[12:15], s43 offen offset:2048 sc1 lds
M v[92:95], a[176:179], a[60:63], 0
v_exp_f32 v158, v158
M v[92:95], a[172:175], a[56:59], v[92:95]
v_cvt_pk_bf16_f32 v141, v142, v143
v_cvt_pk_bf16_f32 v142, v156, v157
M v[92:95], a[168:171], a[52:55], v[92:95]
v_exp_f32 v159, v159
M v[92:95], a[164:167], a[48:51], v[92:95]
buffer_load_dwordx4 v1, s[12:15], s43 offen offset:3072 sc1 lds
v_cvt_pk_bf16_f32 v143, v158, v159
s_waitcnt lgkmcnt(6)
M v[160:163], a[116:119], v[96:99], v[160:163]
v_exp_f32 v32, v32
M v[160:163], a[120:123], v[128:131], v[160:163]
ds_read_b128 a[148:151], v6 offset:36864
ds_read_b128 a[152:155], v6 offset:45056
M v[164:167], a[120:123], v[132:135], v[164:167]
v_exp_f32 v33, v33
M v[164:167], a[116:119], v[100:103], v[164:167]
v_cvt_pk_bf16_f32 v32, v32, v33
M v[168:171], a[116:119], v[104:107], v[168:171]
v_exp_f32 v34, v34
M v[168:171], a[120:123], v[136:139], v[168:171]
s_add_u32 s25, s25, 32768
s_cmp_eq_u32 s25, s27
M v[172:175], a[120:123], v[140:143], v[172:175]
v_exp_f32 v35, v35
M v[172:175], a[116:119], v[108:111], v[172:175]
v_cvt_pk_bf16_f32 v33, v34, v35
s_waitcnt lgkmcnt(6)
M a[96:99], a[112:115], v[96:99], a[96:99]
s_cselect_b32 s25, s28, s25
s_cselect_b32 s27, -1, s27
M a[96:99], a[112:115], v[128:131], a[96:99]
s_add_u32 s26, s26, 32768
s_cmp_eq_u32 s26, s62
M v[176:179], a[124:127], v[96:99], v[176:179]
v_exp_f32 v48, v48
M v[176:179], a[128:131], v[128:131], v[176:179]
ds_read_b128 a[156:159], v6 offset:37888
ds_read_b128 a[160:163], v6 offset:46080
M v[180:183], a[128:131], v[132:135], v[180:183]
v_exp_f32 v49, v49
M v[180:183], a[124:127], v[100:103], v[180:183]
v_cvt_pk_bf16_f32 v34, v48, v49
M v[184:187], a[124:127], v[104:107], v[184:187]
v_exp_f32 v50, v50
M v[184:187], a[128:131], v[136:139], v[184:187]
s_cselect_b32 s26, s63, s26
s_cselect_b32 s62, -1, s62
M v[188:191], a[128:131], v[140:143], v[188:191]
v_exp_f32 v51, v51
M v[188:191], a[124:127], v[108:111], v[188:191]
v_cvt_pk_bf16_f32 v35, v50, v51
s_waitcnt lgkmcnt(6)
M a[100:103], a[112:115], v[100:103], a[100:103]
M a[100:103], a[112:115], v[132:135], a[100:103]
M v[192:195], a[132:135], v[96:99], v[192:195]
v_exp_f32 v36, v36
M v[192:195], a[136:139], v[128:131], v[192:195]
ds_read_b128 a[164:167], v6 offset:38912
ds_read_b128 a[168:171], v6 offset:47104
M v[196:199], a[136:139], v[132:135], v[196:199]
v_exp_f32 v37, v37
M v[196:199], a[132:135], v[100:103], v[196:199]
v_cvt_pk_bf16_f32 v36, v36, v37
M v[200:203], a[132:135], v[104:107], v[200:203]
v_exp_f32 v38, v38
M v[200:203], a[136:139], v[136:139], v[200:203]
M v[204:207], a[136:139], v[140:143], v[204:207]
v_exp_f32 v39, v39
M v[204:207], a[132:135], v[108:111], v[204:207]
v_cvt_pk_bf16_f32 v37, v38, v39
s_waitcnt lgkmcnt(6)
M a[104:107], a[112:115], v[104:107], a[104:107]
M a[104:107], a[112:115], v[136:139], a[104:107]
M v[208:211], a[140:143], v[96:99], v[208:211]
v_exp_f32 v52, v52
M v[208:211], a[144:147], v[128:131], v[208:211]
ds_read_b128 a[172:175], v6 offset:39936
ds_read_b128 a[176:179], v6 offset:48128
M v[212:215], a[144:147], v[132:135], v[212:215]
v_exp_f32 v53, v53
M v[212:215], a[140:143], v[100:103], v[212:215]
v_cvt_pk_bf16_f32 v38, v52, v53
M v[216:219], a[140:143], v[104:107], v[216:219]
v_exp_f32 v54, v54
M v[216:219], a[144:147], v[136:139], v[216:219]
M v[220:223], a[144:147], v[140:143], v[220:223]
v_exp_f32 v55, v55
M v[220:223], a[140:143], v[108:111], v[220:223]
v_cvt_pk_bf16_f32 v39, v54, v55
s_waitcnt lgkmcnt(6)
M a[108:111], a[112:115], v[108:111], a[108:111]
M a[108:111], a[112:115], v[140:143], a[108:111]
M v[224:227], a[148:151], v[96:99], v[224:227]
v_exp_f32 v40, v40
M v[224:227], a[152:155], v[128:131], v[224:227]
M v[228:231], a[152:155], v[132:135], v[228:231]
v_exp_f32 v41, v41
M v[228:231], a[148:151], v[100:103], v[228:231]
v_cvt_pk_bf16_f32 v40, v40, v41
M v[232:235], a[148:151], v[104:107], v[232:235]
v_exp_f32 v42, v42
M v[232:235], a[152:155], v[136:139], v[232:235]
M v[236:239], a[152:155], v[140:143], v[236:239]
v_exp_f32 v43, v43
M v[236:239], a[148:151], v[108:111], v[236:239]
v_cvt_pk_bf16_f32 v41, v42, v43
s_waitcnt lgkmcnt(4)
M v[240:243], a[156:159], v[96:99], v[240:243]
v_exp_f32 v56, v56
M v[240:243], a[160:163], v[128:131], v[240:243]
M v[244:247], a[160:163], v[132:135], v[244:247]
v_exp_f32 v57, v57
M v[244:247], a[156:159], v[100:103], v[244:247]
v_cvt_pk_bf16_f32 v42, v56, v57
M v[248:251], a[156:159], v[104:107], v[248:251]
v_exp_f32 v58, v58
M v[248:251], a[160:163], v[136:139], v[248:251]
s_waitcnt vmcnt(0) lgkmcnt(0)
s_barrier
ds_read_b128 a[116:119], v2 offset:0
ds_read_b128 a[120:123], v2 offset:1024
M v[252:255], a[160:163], v[140:143], v[252:255]
v_exp_f32 v59, v59
M v[252:255], a[156:159], v[108:111], v[252:255]
v_cvt_pk_bf16_f32 v43, v58, v59
M a[64:67], a[164:167], v[96:99], a[64:67]
v_exp_f32 v44, v44
M a[64:67], a[168:171], v[128:131], a[64:67]
ds_read_b128 a[124:127], v2 offset:2048
ds_read_b128 a[128:131], v2 offset:3072
M a[68:71], a[168:171], v[132:135], a[68:71]
v_exp_f32 v45, v45
M a[68:71], a[164:167], v[100:103], a[68:71]
v_cvt_pk_bf16_f32 v44, v44, v45
M a[72:75], a[164:167], v[104:107], a[72:75]
v_exp_f32 v46, v46
M a[72:75], a[168:171], v[136:139], a[72:75]
ds_read_b128 a[132:135], v2 offset:4096
ds_read_b128 a[136:139], v2 offset:5120
M a[76:79], a[168:171], v[140:143], a[76:79]
v_exp_f32 v47, v47
M a[76:79], a[164:167], v[108:111], a[76:79]
v_cvt_pk_bf16_f32 v45, v46, v47
M a[80:83], a[172:175], v[96:99], a[80:83]
v_exp_f32 v60, v60
M a[80:83], a[176:179], v[128:131], a[80:83]
ds_read_b128 a[140:143], v2 offset:6144
ds_read_b128 a[144:147], v2 offset:7168
M a[84:87], a[176:179], v[132:135], a[84:87]
v_exp_f32 v61, v61
M a[84:87], a[172:175], v[100:103], a[84:87]
v_cvt_pk_bf16_f32 v46, v60, v61
M a[88:91], a[172:175], v[104:107], a[88:91]
v_exp_f32 v62, v62
M a[88:91], a[176:179], v[136:139], a[88:91]
M a[92:95], a[176:179], v[140:143], a[92:95]
v_exp_f32 v63, v63
M a[92:95], a[172:175], v[108:111], a[92:95]
v_cvt_pk_bf16_f32 v47, v62, v63
s_branch Lk2_l1
Lk2_m1:
s_cmp_eq_u32 s23, 1
s_cbranch_scc1 Lk2_m1b
s_add_u32 m0, s29, 0
s_waitcnt lgkmcnt(4)
M v[32:35], a[116:119], a[0:3], v[16:19]
v_exp_f32 v128, v128
M v[32:35], a[120:123], a[4:7], v[32:35]
ds_read_b128 a[148:151], v3 offset:8192
ds_read_b128 a[152:155], v3 offset:9216
M v[32:35], a[124:127], a[8:11], v[32:35]
v_exp_f32 v129, v129
M v[32:35], a[128:131], a[12:15], v[32:35]
buffer_load_dwordx4 v1, s[12:15], s25 offen offset:0 sc1 lds
s_add_u32 s32, s25, 4096
M v[36:39], a[128:131], a[28:31], 0
v_exp_f32 v130, v130
M v[36:39], a[124:127], a[24:27], v[36:39]
v_cvt_pk_bf16_f32 v128, v128, v129
M v[36:39], a[120:123], a[20:23], v[36:39]
v_exp_f32 v131, v131
M v[36:39], a[116:119], a[16:19], v[36:39]
buffer_load_dwordx4 v1, s[12:15], s25 offen offset:1024 sc1 lds
M v[40:43], a[116:119], a[32:35], 0
v_exp_f32 v144, v144
M v[40:43], a[120:123], a[36:39], v[40:43]
ds_read_b128 a[156:159], v3 offset:10240
ds_read_b128 a[160:163], v3 offset:11264
M v[40:43], a[124:127], a[40:43], v[40:43]
v_exp_f32 v145, v145
M v[40:43], a[128:131], a[44:47], v[40:43]
buffer_load_dwordx4 v1, s[12:15], s25 offen offset:2048 sc1 lds
M v[44:47], a[128:131], a[60:63], 0
v_exp_f32 v146, v146
M v[44:47], a[124:127], a[56:59], v[44:47]
v_cvt_pk_bf16_f32 v129, v130, v131
v_cvt_pk_bf16_f32 v130, v144, v145
M v[44:47], a[120:123], a[52:55], v[44:47]
v_exp_f32 v147, v147
M v[44:47], a[116:119], a[48:51], v[44:47]
buffer_load_dwordx4 v1, s[12:15], s25 offen offset:3072 sc1 lds
s_add_u32 m0, s29, 4096
s_waitcnt lgkmcnt(4)
v_exp_f32 v132, v132
ds_read_b128 a[164:167], v3 offset:12288
ds_read_b128 a[168:171], v3 offset:13312
v_exp_f32 v133, v133
buffer_load_dwordx4 v1, s[12:15], s32 offen offset:0 sc1 lds
M v[52:55], a[144:147], a[28:31], v[16:19]
v_exp_f32 v134, v134
M v[52:55], a[140:143], a[24:27], v[52:55]
v_cvt_pk_bf16_f32 v131, v146, v147
v_cvt_pk_bf16_f32 v132, v132, v133
M v[52:55], a[136:139], a[20:23], v[52:55]
v_exp_f32 v135, v135
M v[52:55], a[132:135], a[16:19], v[52:55]
buffer_load_dwordx4 v1, s[12:15], s32 offen offset:1024 sc1 lds
M v[56:59], a[132:135], a[32:35], 0
v_exp_f32 v148, v148
M v[56:59], a[136:139], a[36:39], v[56:59]
ds_read_b128 a[172:175], v3 offset:14336
ds_read_b128 a[176:179], v3 offset:15360
M v[56:59], a[140:143], a[40:43], v[56:59]
v_exp_f32 v149, v149
M v[56:59], a[144:147], a[44:47], v[56:59]
buffer_load_dwordx4 v1, s[12:15], s32 offen offset:2048 sc1 lds
M v[60:63], a[144:147], a[60:63], 0
v_exp_f32 v150, v150
M v[60:63], a[140:143], a[56:59], v[60:63]
v_cvt_pk_bf16_f32 v133, v134, v135
v_cvt_pk_bf16_f32 v134, v148, v149
M v[60:63], a[136:139], a[52:55], v[60:63]
v_exp_f32 v151, v151
M v[60:63], a[132:135], a[48:51], v[60:63]
buffer_load_dwordx4 v1, s[12:15], s32 offen offset:3072 sc1 lds
s_add_u32 m0, s29, 32768
s_waitcnt lgkmcnt(4)
v_exp_f32 v136, v136
ds_read_b128 a[116:119], v6 offset:32768
ds_read_b128 a[120:123], v6 offset:40960
v_exp_f32 v137, v137
buffer_load_dwordx4 v1, s[12:15], s26 offen offset:0 sc1 lds
s_add_u32 s43, s26, 4096
v_exp_f32 v138, v138
v_cvt_pk_bf16_f32 v135, v150, v151
v_cvt_pk_bf16_f32 v136, v136, v137
v_exp_f32 v139, v139
buffer_load_dwordx4 v1, s[12:15], s26 offen offset:1024 sc1 lds
M v[72:75], a[148:151], a[32:35], v[16:19]
v_exp_f32 v152, v152
M v[72:75], a[152:155], a[36:39], v[72:75]
ds_read_b128 a[124:127], v6 offset:33792
ds_read_b128 a[128:131], v6 offset:41984
M v[72:75], a[156:159], a[40:43], v[72:75]
v_exp_f32 v153, v153
M v[72:75], a[160:163], a[44:47], v[72:75]
buffer_load_dwordx4 v1, s[12:15], s26 offen offset:2048 sc1 lds
M v[76:79], a[160:163], a[60:63], 0
v_exp_f32 v154, v154
M v[76:79], a[156:159], a[56:59], v[76:79]
v_cvt_pk_bf16_f32 v137, v138, v139
v_cvt_pk_bf16_f32 v138, v152, v153
M v[76:79], a[152:155], a[52:55], v[76:79]
v_exp_f32 v155, v155
M v[76:79], a[148:151], a[48:51], v[76:79]
buffer_load_dwordx4 v1, s[12:15], s26 offen offset:3072 sc1 lds
s_add_u32 m0, s29, 36864
s_waitcnt lgkmcnt(4)
v_exp_f32 v140, v140
ds_read_b128 a[132:135], v6 offset:34816
ds_read_b128 a[136:139], v6 offset:43008
v_exp_f32 v141, v141
buffer_load_dwordx4 v1, s[12:15], s43 offen offset:0 sc1 lds
v_exp_f32 v142, v142
v_cvt_pk_bf16_f32 v139, v154, v155
v_cvt_pk_bf16_f32 v140, v140, v141
v_exp_f32 v143, v143
buffer_load_dwordx4 v1, s[12:15], s43 offen offset:1024 sc1 lds
v_exp_f32 v156, v156
ds_read_b128 a[140:143], v6 offset:35840
ds_read_b128 a[144:147], v6 offset:44032
v_exp_f32 v157, v157
buffer_load_dwordx4 v1, s[12:15], s43 offen offset:2048 sc1 lds
M v[92:95], a[176:179], a[60:63], v[16:19]
v_exp_f32 v158, v158
M v[92:95], a[172:175], a[56:59], v[92:95]
v_cvt_pk_bf16_f32 v141, v142, v143
v_cvt_pk_bf16_f32 v142, v156, v157
M v[92:95], a[168:171], a[52:55], v[92:95]
v_exp_f32 v159, v159
M v[92:95], a[164:167], a[48:51], v[92:95]
buffer_load_dwordx4 v1, s[12:15], s43 offen offset:3072 sc1 lds
v_cvt_pk_bf16_f32 v143, v158, v159
s_waitcnt lgkmcnt(6)
M v[160:163], a[116:119], v[96:99], v[160:163]
v_exp_f32 v32, v32
M v[160:163], a[120:123], v[128:131], v[160:163]
ds_read_b128 a[148:151], v6 offset:36864
ds_read_b128 a[152:155], v6 offset:45056
M v[164:167], a[120:123], v[132:135], v[164:167]
v_exp_f32 v33, v33
M v[164:167], a[116:119], v[100:103], v[164:167]
v_cvt_pk_bf16_f32 v32, v32, v33
M v[168:171], a[116:119], v[104:107], v[168:171]
v_exp_f32 v34, v34
M v[168:171], a[120:123], v[136:139], v[168:171]
s_add_u32 s25, s25, 32768
s_cmp_eq_u32 s25, s27
M v[172:175], a[120:123], v[140:143], v[172:175]
v_exp_f32 v35, v35
M v[172:175], a[116:119], v[108:111], v[172:175]
v_cvt_pk_bf16_f32 v33, v34, v35
s_waitcnt lgkmcnt(6)
M a[96:99], a[112:115], v[96:99], a[96:99]
s_cselect_b32 s25, s28, s25
s_cselect_b32 s27, -1, s27
M a[96:99], a[112:115], v[128:131], a[96:99]
s_add_u32 s26, s26, 32768
s_cmp_eq_u32 s26, s62
M v[176:179], a[124:127], v[96:99], v[176:179]
M v[176:179], a[128:131], v[128:131], v[176:179]
ds_read_b128 a[156:159], v6 offset:37888
ds_read_b128 a[160:163], v6 offset:46080
M v[180:183], a[128:131], v[132:135], v[180:183]
M v[180:183], a[124:127], v[100:103], v[180:183]
v_mov_b32 v34, 0
M v[184:187], a[124:127], v[104:107], v[184:187]
M v[184:187], a[128:131], v[136:139], v[184:187]
s_cselect_b32 s26, s63, s26
s_cselect_b32 s62, -1, s62
M v[188:191], a[128:131], v[140:143], v[188:191]
M v[188:191], a[124:127], v[108:111], v[188:191]
v_mov_b32 v35, 0
s_waitcnt lgkmcnt(6)
M a[100:103], a[112:115], v[100:103], a[100:103]
M a[100:103], a[112:115], v[132:135], a[100:103]
M v[192:195], a[132:135], v[96:99], v[192:195]
v_exp_f32 v36, v36
M v[192:195], a[136:139], v[128:131], v[192:195]
ds_read_b128 a[164:167], v6 offset:38912
ds_read_b128 a[168:171], v6 offset:47104
M v[196:199], a[136:139], v[132:135], v[196:199]
v_exp_f32 v37, v37
M v[196:199], a[132:135], v[100:103], v[196:199]
v_cvt_pk_bf16_f32 v36, v36, v37
M v[200:203], a[132:135], v[104:107], v[200:203]
v_exp_f32 v38, v38
M v[200:203], a[136:139], v[136:139], v[200:203]
M v[204:207], a[136:139], v[140:143], v[204:207]
v_exp_f32 v39, v39
M v[204:207], a[132:135], v[108:111], v[204:207]
v_cvt_pk_bf16_f32 v37, v38, v39
s_waitcnt lgkmcnt(6)
M a[104:107], a[112:115], v[104:107], a[104:107]
M a[104:107], a[112:115], v[136:139], a[104:107]
M v[208:211], a[140:143], v[96:99], v[208:211]
v_exp_f32 v52, v52
M v[208:211], a[144:147], v[128:131], v[208:211]
ds_read_b128 a[172:175], v6 offset:39936
ds_read_b128 a[176:179], v6 offset:48128
M v[212:215], a[144:147], v[132:135], v[212:215]
v_exp_f32 v53, v53
M v[212:215], a[140:143], v[100:103], v[212:215]
v_cvt_pk_bf16_f32 v38, v52, v53
M v[216:219], a[140:143], v[104:107], v[216:219]
v_exp_f32 v54, v54
M v[216:219], a[144:147], v[136:139], v[216:219]
M v[220:223], a[144:147], v[140:143], v[220:223]
v_exp_f32 v55, v55
M v[220:223], a[140:143], v[108:111], v[220:223]
v_cvt_pk_bf16_f32 v39, v54, v55
s_waitcnt lgkmcnt(6)
M a[108:111], a[112:115], v[108:111], a[108:111]
M a[108:111], a[112:115], v[140:143], a[108:111]
M v[224:227], a[148:151], v[96:99], v[224:227]
v_exp_f32 v40, v40
M v[224:227], a[152:155], v[128:131], v[224:227]
M v[228:231], a[152:155], v[132:135], v[228:231]
v_exp_f32 v41, v41
M v[228:231], a[148:151], v[100:103], v[228:231]
v_cvt_pk_bf16_f32 v40, v40, v41
M v[232:235], a[148:151], v[104:107], v[232:235]
v_exp_f32 v42, v42
M v[232:235], a[152:155], v[136:139], v[232:235]
M v[236:239], a[152:155], v[140:143], v[236:239]
v_exp_f32 v43, v43
M v[236:239], a[148:151], v[108:111], v[236:239]
v_cvt_pk_bf16_f32 v41, v42, v43
s_waitcnt lgkmcnt(4)
M v[240:243], a[156:159], v[96:99], v[240:243]
v_exp_f32 v56, v56
M v[240:243], a[160:163], v[128:131], v[240:243]
M v[244:247], a[160:163], v[132:135], v[244:247]
v_exp_f32 v57, v57
M v[244:247], a[156:159], v[100:103], v[244:247]
v_cvt_pk_bf16_f32 v42, v56, v57
M v[248:251], a[156:159], v[104:107], v[248:251]
v_exp_f32 v58, v58
M v[248:251], a[160:163], v[136:139], v[248:251]
s_waitcnt vmcnt(0) lgkmcnt(0)
s_barrier
ds_read_b128 a[116:119], v2 offset:0
ds_read_b128 a[120:123], v2 offset:1024
M v[252:255], a[160:163], v[140:143], v[252:255]
v_exp_f32 v59, v59
M v[252:255], a[156:159], v[108:111], v[252:255]
v_cvt_pk_bf16_f32 v43, v58, v59
M a[64:67], a[164:167], v[96:99], a[64:67]
v_exp_f32 v44, v44
M a[64:67], a[168:171], v[128:131], a[64:67]
ds_read_b128 a[124:127], v2 offset:2048
ds_read_b128 a[128:131], v2 offset:3072
M a[68:71], a[168:171], v[132:135], a[68:71]
v_exp_f32 v45, v45
M a[68:71], a[164:167], v[100:103], a[68:71]
v_cvt_pk_bf16_f32 v44, v44, v45
M a[72:75], a[164:167], v[104:107], a[72:75]
v_exp_f32 v46, v46
M a[72:75], a[168:171], v[136:139], a[72:75]
ds_read_b128 a[132:135], v2 offset:4096
ds_read_b128 a[136:139], v2 offset:5120
M a[76:79], a[168:171], v[140:143], a[76:79]
v_exp_f32 v47, v47
M a[76:79], a[164:167], v[108:111], a[76:79]
v_cvt_pk_bf16_f32 v45, v46, v47
M a[80:83], a[172:175], v[96:99], a[80:83]
v_exp_f32 v60, v60
M a[80:83], a[176:179], v[128:131], a[80:83]
ds_read_b128 a[140:143], v2 offset:6144
ds_read_b128 a[144:147], v2 offset:7168
M a[84:87], a[176:179], v[132:135], a[84:87]
v_exp_f32 v61, v61
M a[84:87], a[172:175], v[100:103], a[84:87]
v_cvt_pk_bf16_f32 v46, v60, v61
M a[88:91], a[172:175], v[104:107], a[88:91]
v_exp_f32 v62, v62
M a[88:91], a[176:179], v[136:139], a[88:91]
M a[92:95], a[176:179], v[140:143], a[92:95]
v_exp_f32 v63, v63
M a[92:95], a[172:175], v[108:111], a[92:95]
v_cvt_pk_bf16_f32 v47, v62, v63
Lk2_m2a:
s_sub_u32 s35, 15, s21
s_lshl_b32 s33, s20, 7
s_lshl_b32 s34, s35, 3
s_add_u32 s33, s33, s34
s_lshl_b32 s34, s23, 2
s_add_u32 s33, s33, s34
s_lshl_b32 s33, s33, 12
buffer_load_dwordx4 a[180:183], v1, s[8:11], s33 offen offset:0 sc1
buffer_load_dwordx4 a[184:187], v1, s[8:11], s33 offen offset:1024 sc1
buffer_load_dwordx4 a[188:191], v1, s[8:11], s33 offen offset:2048 sc1
buffer_load_dwordx4 a[192:195], v1, s[8:11], s33 offen offset:3072 sc1
s_add_u32 s33, s33, 4096
buffer_load_dwordx4 a[196:199], v1, s[8:11], s33 offen offset:0 sc1
buffer_load_dwordx4 a[200:203], v1, s[8:11], s33 offen offset:1024 sc1
buffer_load_dwordx4 a[204:207], v1, s[8:11], s33 offen offset:2048 sc1
buffer_load_dwordx4 a[208:211], v1, s[8:11], s33 offen offset:3072 sc1
s_add_u32 s33, s33, 4096
buffer_load_dwordx4 a[212:215], v1, s[8:11], s33 offen offset:0 sc1
buffer_load_dwordx4 a[216:219], v1, s[8:11], s33 offen offset:1024 sc1
buffer_load_dwordx4 a[220:223], v1, s[8:11], s33 offen offset:2048 sc1
buffer_load_dwordx4 a[224:227], v1, s[8:11], s33 offen offset:3072 sc1
s_add_u32 s33, s33, 4096
buffer_load_dwordx4 a[228:231], v1, s[8:11], s33 offen offset:0 sc1
buffer_load_dwordx4 a[232:235], v1, s[8:11], s33 offen offset:1024 sc1
buffer_load_dwordx4 a[236:239], v1, s[8:11], s33 offen offset:2048 sc1
buffer_load_dwordx4 a[240:243], v1, s[8:11], s33 offen offset:3072 sc1
s_add_u32 m0, s29, 65536
s_nop 0
buffer_load_dwordx4 v1, s[12:15], s25 offen offset:0 sc1 lds
s_add_u32 s32, s25, 4096
buffer_load_dwordx4 v1, s[12:15], s25 offen offset:1024 sc1 lds
buffer_load_dwordx4 v1, s[12:15], s25 offen offset:2048 sc1 lds
buffer_load_dwordx4 v1, s[12:15], s25 offen offset:3072 sc1 lds
s_add_u32 m0, s29, 69632
s_nop 0
buffer_load_dwordx4 v1, s[12:15], s32 offen offset:0 sc1 lds
buffer_load_dwordx4 v1, s[12:15], s32 offen offset:1024 sc1 lds
buffer_load_dwordx4 v1, s[12:15], s32 offen offset:2048 sc1 lds
buffer_load_dwordx4 v1, s[12:15], s32 offen offset:3072 sc1 lds
s_add_u32 m0, s29, 98304
v_exp_f32 v72, v72
s_waitcnt lgkmcnt(7)
ds_read_b128 a[116:119], v5 offset:32768
s_waitcnt lgkmcnt(7)
ds_read_b128 a[120:123], v5 offset:40960
v_exp_f32 v73, v73
buffer_load_dwordx4 v1, s[12:15], s26 offen offset:0 sc1 lds
s_add_u32 s43, s26, 4096
v_exp_f32 v74, v74
v_cvt_pk_bf16_f32 v72, v72, v73
v_exp_f32 v75, v75
buffer_load_dwordx4 v1, s[12:15], s26 offen offset:1024 sc1 lds
s_waitcnt lgkmcnt(7)
ds_read_b128 a[124:127], v5 offset:33792
s_waitcnt lgkmcnt(7)
ds_read_b128 a[128:131], v5 offset:41984
buffer_load_dwordx4 v1, s[12:15], s26 offen offset:2048 sc1 lds
v_cvt_pk_bf16_f32 v73, v74, v75
v_mov_b32 v74, 0
buffer_load_dwordx4 v1, s[12:15], s26 offen offset:3072 sc1 lds
s_add_u32 m0, s29, 102400
v_exp_f32 v76, v76
s_waitcnt lgkmcnt(7)
ds_read_b128 a[132:135], v5 offset:34816
s_waitcnt lgkmcnt(7)
ds_read_b128 a[136:139], v5 offset:43008
v_exp_f32 v77, v77
buffer_load_dwordx4 v1, s[12:15], s43 offen offset:0 sc1 lds
v_exp_f32 v78, v78
v_mov_b32 v75, 0
v_cvt_pk_bf16_f32 v76, v76, v77
v_exp_f32 v79, v79
buffer_load_dwordx4 v1, s[12:15], s43 offen offset:1024 sc1 lds
v_exp_f32 v92, v92
s_waitcnt lgkmcnt(7)
ds_read_b128 a[140:143], v5 offset:35840
s_waitcnt lgkmcnt(7)
ds_read_b128 a[144:147], v5 offset:44032
v_exp_f32 v93, v93
buffer_load_dwordx4 v1, s[12:15], s43 offen offset:2048 sc1 lds
v_exp_f32 v94, v94
v_cvt_pk_bf16_f32 v77, v78, v79
v_cvt_pk_bf16_f32 v78, v92, v93
v_exp_f32 v95, v95
buffer_load_dwordx4 v1, s[12:15], s43 offen offset:3072 sc1 lds
v_cvt_pk_bf16_f32 v79, v94, v95
s_waitcnt lgkmcnt(6)
M v[160:163], a[116:119], v[32:35], v[160:163]
ds_read_b128 a[148:151], v5 offset:36864
ds_read_b128 a[152:155], v5 offset:45056
M v[164:167], a[116:119], v[36:39], v[164:167]
M v[168:171], a[116:119], v[40:43], v[168:171]
M v[168:171], a[120:123], v[72:75], v[168:171]
s_add_u32 s25, s25, 32768
s_cmp_eq_u32 s25, s27
M v[172:175], a[120:123], v[76:79], v[172:175]
M v[172:175], a[116:119], v[44:47], v[172:175]
s_waitcnt lgkmcnt(6)
M a[96:99], a[112:115], v[32:35], a[96:99]
s_cselect_b32 s25, s28, s25
s_cselect_b32 s27, -1, s27
s_add_u32 s26, s26, 32768
s_cmp_eq_u32 s26, s62
M v[176:179], a[124:127], v[32:35], v[176:179]
ds_read_b128 a[156:159], v5 offset:37888
ds_read_b128 a[160:163], v5 offset:46080
M v[180:183], a[124:127], v[36:39], v[180:183]
M v[184:187], a[124:127], v[40:43], v[184:187]
M v[184:187], a[128:131], v[72:75], v[184:187]
s_cselect_b32 s26, s63, s26
s_cselect_b32 s62, -1, s62
M v[188:191], a[128:131], v[76:79], v[188:191]
M v[188:191], a[124:127], v[44:47], v[188:191]
s_waitcnt lgkmcnt(6)
M a[100:103], a[112:115], v[36:39], a[100:103]
M v[192:195], a[132:135], v[32:35], v[192:195]
ds_read_b128 a[164:167], v5 offset:38912
ds_read_b128 a[168:171], v5 offset:47104
M v[196:199], a[132:135], v[36:39], v[196:199]
M v[200:203], a[132:135], v[40:43], v[200:203]
M v[200:203], a[136:139], v[72:75], v[200:203]
M v[204:207], a[136:139], v[76:79], v[204:207]
M v[204:207], a[132:135], v[44:47], v[204:207]
s_waitcnt lgkmcnt(6)
M a[104:107], a[112:115], v[40:43], a[104:107]
M a[104:107], a[112:115], v[72:75], a[104:107]
M v[208:211], a[140:143], v[32:35], v[208:211]
ds_read_b128 a[172:175], v5 offset:39936
ds_read_b128 a[176:179], v5 offset:48128
M v[212:215], a[140:143], v[36:39], v[212:215]
M v[216:219], a[140:143], v[40:43], v[216:219]
M v[216:219], a[144:147], v[72:75], v[216:219]
M v[220:223], a[144:147], v[76:79], v[220:223]
M v[220:223], a[140:143], v[44:47], v[220:223]
s_waitcnt lgkmcnt(6)
M a[108:111], a[112:115], v[44:47], a[108:111]
M a[108:111], a[112:115], v[76:79], a[108:111]
M v[224:227], a[148:151], v[32:35], v[224:227]
M v[228:231], a[148:151], v[36:39], v[228:231]
M v[232:235], a[148:151], v[40:43], v[232:235]
M v[232:235], a[152:155], v[72:75], v[232:235]
M v[236:239], a[152:155], v[76:79], v[236:239]
M v[236:239], a[148:151], v[44:47], v[236:239]
s_waitcnt lgkmcnt(4)
M v[240:243], a[156:159], v[32:35], v[240:243]
M v[244:247], a[156:159], v[36:39], v[244:247]
M v[248:251], a[156:159], v[40:43], v[248:251]
M v[248:251], a[160:163], v[72:75], v[248:251]
s_waitcnt vmcnt(0) lgkmcnt(0)
s_barrier
ds_read_b128 a[116:119], v3 offset:0
ds_read_b128 a[120:123], v3 offset:1024
M v[252:255], a[160:163], v[76:79], v[252:255]
M v[252:255], a[156:159], v[44:47], v[252:255]
M a[64:67], a[164:167], v[32:35], a[64:67]
ds_read_b128 a[124:127], v3 offset:2048
ds_read_b128 a[128:131], v3 offset:3072
M a[68:71], a[164:167], v[36:39], a[68:71]
M a[72:75], a[164:167], v[40:43], a[72:75]
M a[72:75], a[168:171], v[72:75], a[72:75]
ds_read_b128 a[132:135], v3 offset:4096
ds_read_b128 a[136:139], v3 offset:5120
M a[76:79], a[168:171], v[76:79], a[76:79]
M a[76:79], a[164:167], v[44:47], a[76:79]
M a[80:83], a[172:175], v[32:35], a[80:83]
ds_read_b128 a[140:143], v3 offset:6144
ds_read_b128 a[144:147], v3 offset:7168
M a[84:87], a[172:175], v[36:39], a[84:87]
M a[88:91], a[172:175], v[40:43], a[88:91]
M a[88:91], a[176:179], v[72:75], a[88:91]
M a[92:95], a[176:179], v[76:79], a[92:95]
M a[92:95], a[172:175], v[44:47], a[92:95]
s_waitcnt vmcnt(16)
s_add_u32 m0, s29, 0
s_waitcnt lgkmcnt(4)
M v[32:35], a[116:119], a[180:183], 0
M v[32:35], a[120:123], a[184:187], v[32:35]
ds_read_b128 a[148:151], v3 offset:8192
ds_read_b128 a[152:155], v3 offset:9216
M v[32:35], a[124:127], a[188:191], v[32:35]
M v[32:35], a[128:131], a[192:195], v[32:35]
buffer_load_dwordx4 v1, s[12:15], s25 offen offset:0 sc1 lds
s_add_u32 s32, s25, 4096
M v[36:39], a[128:131], a[208:211], 0
M v[36:39], a[124:127], a[204:207], v[36:39]
M v[36:39], a[120:123], a[200:203], v[36:39]
M v[36:39], a[116:119], a[196:199], v[36:39]
buffer_load_dwordx4 v1, s[12:15], s25 offen offset:1024 sc1 lds
M v[40:43], a[116:119], a[212:215], 0
M v[40:43], a[120:123], a[216:219], v[40:43]
ds_read_b128 a[156:159], v3 offset:10240
ds_read_b128 a[160:163], v3 offset:11264
M v[40:43], a[124:127], a[220:223], v[40:43]
M v[40:43], a[128:131], a[224:227], v[40:43]
buffer_load_dwordx4 v1, s[12:15], s25 offen offset:2048 sc1 lds
M v[44:47], a[128:131], a[240:243], 0
M v[44:47], a[124:127], a[236:239], v[44:47]
M v[44:47], a[120:123], a[232:235], v[44:47]
M v[44:47], a[116:119], a[228:231], v[44:47]
buffer_load_dwordx4 v1, s[12:15], s25 offen offset:3072 sc1 lds
s_add_u32 m0, s29, 4096
s_waitcnt lgkmcnt(4)
M v[48:51], a[132:135], a[180:183], 0
M v[48:51], a[136:139], a[184:187], v[48:51]
ds_read_b128 a[164:167], v3 offset:12288
ds_read_b128 a[168:171], v3 offset:13312
M v[48:51], a[140:143], a[188:191], v[48:51]
M v[48:51], a[144:147], a[192:195], v[48:51]
buffer_load_dwordx4 v1, s[12:15], s32 offen offset:0 sc1 lds
M v[52:55], a[144:147], a[208:211], 0
M v[52:55], a[140:143], a[204:207], v[52:55]
M v[52:55], a[136:139], a[200:203], v[52:55]
M v[52:55], a[132:135], a[196:199], v[52:55]
buffer_load_dwordx4 v1, s[12:15], s32 offen offset:1024 sc1 lds
M v[56:59], a[132:135], a[212:215], 0
M v[56:59], a[136:139], a[216:219], v[56:59]
ds_read_b128 a[172:175], v3 offset:14336
ds_read_b128 a[176:179], v3 offset:15360
M v[56:59], a[140:143], a[220:223], v[56:59]
M v[56:59], a[144:147], a[224:227], v[56:59]
buffer_load_dwordx4 v1, s[12:15], s32 offen offset:2048 sc1 lds
M v[60:63], a[144:147], a[240:243], 0
M v[60:63], a[140:143], a[236:239], v[60:63]
M v[60:63], a[136:139], a[232:235], v[60:63]
M v[60:63], a[132:135], a[228:231], v[60:63]
buffer_load_dwordx4 v1, s[12:15], s32 offen offset:3072 sc1 lds
s_add_u32 m0, s29, 32768
s_waitcnt lgkmcnt(4)
M v[64:67], a[148:151], a[180:183], 0
M v[64:67], a[152:155], a[184:187], v[64:67]
M v[64:67], a[156:159], a[188:191], v[64:67]
M v[64:67], a[160:163], a[192:195], v[64:67]
buffer_load_dwordx4 v1, s[12:15], s26 offen offset:0 sc1 lds
s_add_u32 s43, s26, 4096
M v[68:71], a[160:163], a[208:211], 0
M v[68:71], a[156:159], a[204:207], v[68:71]
M v[68:71], a[152:155], a[200:203], v[68:71]
M v[68:71], a[148:151], a[196:199], v[68:71]
buffer_load_dwordx4 v1, s[12:15], s26 offen offset:1024 sc1 lds
M v[72:75], a[148:151], a[212:215], 0
M v[72:75], a[152:155], a[216:219], v[72:75]
M v[72:75], a[156:159], a[220:223], v[72:75]
M v[72:75], a[160:163], a[224:227], v[72:75]
buffer_load_dwordx4 v1, s[12:15], s26 offen offset:2048 sc1 lds
M v[76:79], a[160:163], a[240:243], 0
M v[76:79], a[156:159], a[236:239], v[76:79]
M v[76:79], a[152:155], a[232:235], v[76:79]
M v[76:79], a[148:151], a[228:231], v[76:79]
buffer_load_dwordx4 v1, s[12:15], s26 offen offset:3072 sc1 lds
s_add_u32 m0, s29, 36864
s_waitcnt lgkmcnt(0)
M v[80:83], a[164:167], a[180:183], 0
M v[80:83], a[168:171], a[184:187], v[80:83]
M v[80:83], a[172:175], a[188:191], v[80:83]
M v[80:83], a[176:179], a[192:195], v[80:83]
buffer_load_dwordx4 v1, s[12:15], s43 offen offset:0 sc1 lds
M v[84:87], a[176:179], a[208:211], 0
M v[84:87], a[172:175], a[204:207], v[84:87]
M v[84:87], a[168:171], a[200:203], v[84:87]
M v[84:87], a[164:167], a[196:199], v[84:87]
buffer_load_dwordx4 v1, s[12:15], s43 offen offset:1024 sc1 lds
M v[88:91], a[164:167], a[212:215], 0
M v[88:91], a[168:171], a[216:219], v[88:91]
M v[88:91], a[172:175], a[220:223], v[88:91]
M v[88:91], a[176:179], a[224:227], v[88:91]
buffer_load_dwordx4 v1, s[12:15], s43 offen offset:2048 sc1 lds
M v[92:95], a[176:179], a[240:243], 0
M v[92:95], a[172:175], a[236:239], v[92:95]
M v[92:95], a[168:171], a[232:235], v[92:95]
M v[92:95], a[164:167], a[228:231], v[92:95]
buffer_load_dwordx4 v1, s[12:15], s43 offen offset:3072 sc1 lds
v_exp_f32 v32, v32
v_exp_f32 v33, v33
s_nop 0
v_cvt_pk_bf16_f32 v32, v32, v33
v_exp_f32 v34, v34
s_add_u32 s25, s25, 32768
s_cmp_eq_u32 s25, s27
v_exp_f32 v35, v35
s_nop 0
v_cvt_pk_bf16_f32 v33, v34, v35
s_cselect_b32 s25, s28, s25
s_cselect_b32 s27, -1, s27
s_add_u32 s26, s26, 32768
s_cmp_eq_u32 s26, s62
v_exp_f32 v48, v48
v_exp_f32 v49, v49
s_nop 0
v_cvt_pk_bf16_f32 v34, v48, v49
v_exp_f32 v50, v50
s_cselect_b32 s26, s63, s26
s_cselect_b32 s62, -1, s62
v_exp_f32 v51, v51
s_nop 0
v_cvt_pk_bf16_f32 v35, v50, v51
v_exp_f32 v36, v36
v_exp_f32 v37, v37
s_nop 0
v_cvt_pk_bf16_f32 v36, v36, v37
v_exp_f32 v38, v38
v_exp_f32 v39, v39
s_nop 0
v_cvt_pk_bf16_f32 v37, v38, v39
v_exp_f32 v52, v52
v_exp_f32 v53, v53
s_nop 0
v_cvt_pk_bf16_f32 v38, v52, v53
v_exp_f32 v54, v54
v_exp_f32 v55, v55
s_nop 0
v_cvt_pk_bf16_f32 v39, v54, v55
v_exp_f32 v40, v40
v_exp_f32 v41, v41
s_nop 0
v_cvt_pk_bf16_f32 v40, v40, v41
v_exp_f32 v42, v42
v_exp_f32 v43, v43
s_nop 0
v_cvt_pk_bf16_f32 v41, v42, v43
v_exp_f32 v56, v56
v_exp_f32 v57, v57
s_nop 0
v_cvt_pk_bf16_f32 v42, v56, v57
v_exp_f32 v58, v58
s_waitcnt vmcnt(0) lgkmcnt(0)
s_barrier
ds_read_b128 a[116:119], v2 offset:0
ds_read_b128 a[120:123], v2 offset:1024
v_exp_f32 v59, v59
s_nop 0
v_cvt_pk_bf16_f32 v43, v58, v59
v_exp_f32 v44, v44
ds_read_b128 a[124:127], v2 offset:2048
ds_read_b128 a[128:131], v2 offset:3072
v_exp_f32 v45, v45
s_nop 0
v_cvt_pk_bf16_f32 v44, v44, v45
v_exp_f32 v46, v46
ds_read_b128 a[132:135], v2 offset:4096
ds_read_b128 a[136:139], v2 offset:5120
v_exp_f32 v47, v47
s_nop 0
v_cvt_pk_bf16_f32 v45, v46, v47
v_exp_f32 v60, v60
ds_read_b128 a[140:143], v2 offset:6144
ds_read_b128 a[144:147], v2 offset:7168
v_exp_f32 v61, v61
s_nop 0
v_cvt_pk_bf16_f32 v46, v60, v61
v_exp_f32 v62, v62
v_exp_f32 v63, v63
s_nop 0
v_cvt_pk_bf16_f32 v47, v62, v63
s_branch Lk2_ea
Lk2_m2:
s_cmp_eq_u32 s23, 0
s_cbranch_scc1 Lk2_m2a
s_branch Lk2_m2b
Lk2_m1b:
s_add_u32 m0, s29, 0
s_waitcnt lgkmcnt(4)
M v[32:35], a[116:119], a[0:3], 0
v_exp_f32 v128, v128
M v[32:35], a[120:123], a[4:7], v[32:35]
ds_read_b128 a[148:151], v3 offset:8192
ds_read_b128 a[152:155], v3 offset:9216
M v[32:35], a[124:127], a[8:11], v[32:35]
v_exp_f32 v129, v129
M v[32:35], a[128:131], a[12:15], v[32:35]
buffer_load_dwordx4 v1, s[12:15], s25 offen offset:0 sc1 lds
s_add_u32 s32, s25, 4096
M v[36:39], a[128:131], a[28:31], 0
v_exp_f32 v130, v130
M v[36:39], a[124:127], a[24:27], v[36:39]
v_cvt_pk_bf16_f32 v128, v128, v129
M v[36:39], a[120:123], a[20:23], v[36:39]
v_exp_f32 v131, v131
M v[36:39], a[116:119], a[16:19], v[36:39]
buffer_load_dwordx4 v1, s[12:15], s25 offen offset:1024 sc1 lds
M v[40:43], a[116:119], a[32:35], 0
v_exp_f32 v144, v144
M v[40:43], a[120:123], a[36:39], v[40:43]
ds_read_b128 a[156:159], v3 offset:10240
ds_read_b128 a[160:163], v3 offset:11264
M v[40:43], a[124:127], a[40:43], v[40:43]
v_exp_f32 v145, v145
M v[40:43], a[128:131], a[44:47], v[40:43]
buffer_load_dwordx4 v1, s[12:15], s25 offen offset:2048 sc1 lds
M v[44:47], a[128:131], a[60:63], 0
v_exp_f32 v146, v146
M v[44:47], a[124:127], a[56:59], v[44:47]
v_cvt_pk_bf16_f32 v129, v130, v131
v_cvt_pk_bf16_f32 v130, v144, v145
M v[44:47], a[120:123], a[52:55], v[44:47]
v_exp_f32 v147, v147
M v[44:47], a[116:119], a[48:51], v[44:47]
buffer_load_dwordx4 v1, s[12:15], s25 offen offset:3072 sc1 lds
s_add_u32 m0, s29, 4096
s_waitcnt lgkmcnt(4)
M v[48:51], a[132:135], a[0:3], 0
v_exp_f32 v132, v132
M v[48:51], a[136:139], a[4:7], v[48:51]
ds_read_b128 a[164:167], v3 offset:12288
ds_read_b128 a[168:171], v3 offset:13312
M v[48:51], a[140:143], a[8:11], v[48:51]
v_exp_f32 v133, v133
M v[48:51], a[144:147], a[12:15], v[48:51]
buffer_load_dwordx4 v1, s[12:15], s32 offen offset:0 sc1 lds
M v[52:55], a[144:147], a[28:31], 0
v_exp_f32 v134, v134
M v[52:55], a[140:143], a[24:27], v[52:55]
v_cvt_pk_bf16_f32 v131, v146, v147
v_cvt_pk_bf16_f32 v132, v132, v133
M v[52:55], a[136:139], a[20:23], v[52:55]
v_exp_f32 v135, v135
M v[52:55], a[132:135], a[16:19], v[52:55]
buffer_load_dwordx4 v1, s[12:15], s32 offen offset:1024 sc1 lds
M v[56:59], a[132:135], a[32:35], 0
v_exp_f32 v148, v148
M v[56:59], a[136:139], a[36:39], v[56:59]
ds_read_b128 a[172:175], v3 offset:14336
ds_read_b128 a[176:179], v3 offset:15360
M v[56:59], a[140:143], a[40:43], v[56:59]
v_exp_f32 v149, v149
M v[56:59], a[144:147], a[44:47], v[56:59]
buffer_load_dwordx4 v1, s[12:15], s32 offen offset:2048 sc1 lds
M v[60:63], a[144:147], a[60:63], 0
v_exp_f32 v150, v150
M v[60:63], a[140:143], a[56:59], v[60:63]
v_cvt_pk_bf16_f32 v133, v134, v135
v_cvt_pk_bf16_f32 v134, v148, v149
M v[60:63], a[136:139], a[52:55], v[60:63]
v_exp_f32 v151, v151
M v[60:63], a[132:135], a[48:51], v[60:63]
buffer_load_dwordx4 v1, s[12:15], s32 offen offset:3072 sc1 lds
s_add_u32 m0, s29, 32768
s_waitcnt lgkmcnt(4)
M v[64:67], a[148:151], a[0:3], 0
v_exp_f32 v136, v136
M v[64:67], a[152:155], a[4:7], v[64:67]
ds_read_b128 a[116:119], v6 offset:32768
ds_read_b128 a[120:123], v6 offset:40960
M v[64:67], a[156:159], a[8:11], v[64:67]
v_exp_f32 v137, v137
M v[64:67], a[160:163], a[12:15], v[64:67]
buffer_load_dwordx4 v1, s[12:15], s26 offen offset:0 sc1 lds
s_add_u32 s43, s26, 4096
M v[68:71], a[160:163], a[28:31], 0
v_exp_f32 v138, v138
M v[68:71], a[156:159], a[24:27], v[68:71]
v_cvt_pk_bf16_f32 v135, v150, v151
v_cvt_pk_bf16_f32 v136, v136, v137
M v[68:71], a[152:155], a[20:23], v[68:71]
v_exp_f32 v139, v139
M v[68:71], a[148:151], a[16:19], v[68:71]
buffer_load_dwordx4 v1, s[12:15], s26 offen offset:1024 sc1 lds
M v[72:75], a[148:151], a[32:35], 0
v_exp_f32 v152, v152
M v[72:75], a[152:155], a[36:39], v[72:75]
ds_read_b128 a[124:127], v6 offset:33792
ds_read_b128 a[128:131], v6 offset:41984
M v[72:75], a[156:159], a[40:43], v[72:75]
v_exp_f32 v153, v153
M v[72:75], a[160:163], a[44:47], v[72:75]
buffer_load_dwordx4 v1, s[12:15], s26 offen offset:2048 sc1 lds
M v[76:79], a[160:163], a[60:63], 0
v_exp_f32 v154, v154
M v[76:79], a[156:159], a[56:59], v[76:79]
v_cvt_pk_bf16_f32 v137, v138, v139
v_cvt_pk_bf16_f32 v138, v152, v153
M v[76:79], a[152:155], a[52:55], v[76:79]
v_exp_f32 v155, v155
M v[76:79], a[148:151], a[48:51], v[76:79]
buffer_load_dwordx4 v1, s[12:15], s26 offen offset:3072 sc1 lds
s_add_u32 m0, s29, 36864
s_waitcnt lgkmcnt(4)
M v[80:83], a[164:167], a[0:3], 0
v_exp_f32 v140, v140
M v[80:83], a[168:171], a[4:7], v[80:83]
ds_read_b128 a[132:135], v6 offset:34816
ds_read_b128 a[136:139], v6 offset:43008
M v[80:83], a[172:175], a[8:11], v[80:83]
v_exp_f32 v141, v141
M v[80:83], a[176:179], a[12:15], v[80:83]
buffer_load_dwordx4 v1, s[12:15], s43 offen offset:0 sc1 lds
M v[84:87], a[176:179], a[28:31], 0
v_exp_f32 v142, v142
M v[84:87], a[172:175], a[24:27], v[84:87]
v_cvt_pk_bf16_f32 v139, v154, v155
v_cvt_pk_bf16_f32 v140, v140, v141
M v[84:87], a[168:171], a[20:23], v[84:87]
v_exp_f32 v143, v143
M v[84:87], a[164:167], a[16:19], v[84:87]
buffer_load_dwordx4 v1, s[12:15], s43 offen offset:1024 sc1 lds
M v[88:91], a[164:167], a[32:35], 0
v_exp_f32 v156, v156
M v[88:91], a[168:171], a[36:39], v[88:91]
ds_read_b128 a[140:143], v6 offset:35840
ds_read_b128 a[144:147], v6 offset:44032
M v[88:91], a[172:175], a[40:43], v[88:91]
v_exp_f32 v157, v157
M v[88:91], a[176:179], a[44:47], v[88:91]
buffer_load_dwordx4 v1, s[12:15], s43 offen offset:2048 sc1 lds
M v[92:95], a[176:179], a[60:63], 0
v_exp_f32 v158, v158
M v[92:95], a[172:175], a[56:59], v[92:95]
v_cvt_pk_bf16_f32 v141, v142, v143
v_cvt_pk_bf16_f32 v142, v156, v157
M v[92:95], a[168:171], a[52:55], v[92:95]
v_exp_f32 v159, v159
M v[92:95], a[164:167], a[48:51], v[92:95]
buffer_load_dwordx4 v1, s[12:15], s43 offen offset:3072 sc1 lds
v_cvt_pk_bf16_f32 v143, v158, v159
s_waitcnt lgkmcnt(6)
M v[160:163], a[116:119], v[96:99], v[160:163]
v_exp_f32 v32, v32
M v[160:163], a[120:123], v[128:131], v[160:163]
ds_read_b128 a[148:151], v6 offset:36864
ds_read_b128 a[152:155], v6 offset:45056
M v[164:167], a[120:123], v[132:135], v[164:167]
v_exp_f32 v33, v33
M v[164:167], a[116:119], v[100:103], v[164:167]
v_cvt_pk_bf16_f32 v32, v32, v33
M v[168:171], a[116:119], v[104:107], v[168:171]
v_exp_f32 v34, v34
M v[168:171], a[120:123], v[136:139], v[168:171]
s_add_u32 s25, s25, 32768
s_cmp_eq_u32 s25, s27
M v[172:175], a[120:123], v[140:143], v[172:175]
v_exp_f32 v35, v35
M v[172:175], a[116:119], v[108:111], v[172:175]
v_cvt_pk_bf16_f32 v33, v34, v35
s_waitcnt lgkmcnt(6)
M a[96:99], a[112:115], v[96:99], a[96:99]
s_cselect_b32 s25, s28, s25
s_cselect_b32 s27, -1, s27
M a[96:99], a[112:115], v[128:131], a[96:99]
s_add_u32 s26, s26, 32768
s_cmp_eq_u32 s26, s62
M v[176:179], a[124:127], v[96:99], v[176:179]
v_exp_f32 v48, v48
M v[176:179], a[128:131], v[128:131], v[176:179]
ds_read_b128 a[156:159], v6 offset:37888
ds_read_b128 a[160:163], v6 offset:46080
M v[180:183], a[128:131], v[132:135], v[180:183]
v_exp_f32 v49, v49
M v[180:183], a[124:127], v[100:103], v[180:183]
v_cvt_pk_bf16_f32 v34, v48, v49
M v[184:187], a[124:127], v[104:107], v[184:187]
v_exp_f32 v50, v50
M v[184:187], a[128:131], v[136:139], v[184:187]
s_cselect_b32 s26, s63, s26
s_cselect_b32 s62, -1, s62
M v[188:191], a[128:131], v[140:143], v[188:191]
v_exp_f32 v51, v51
M v[188:191], a[124:127], v[108:111], v[188:191]
v_cvt_pk_bf16_f32 v35, v50, v51
s_waitcnt lgkmcnt(6)
M a[100:103], a[112:115], v[100:103], a[100:103]
M a[100:103], a[112:115], v[132:135], a[100:103]
M v[192:195], a[132:135], v[96:99], v[192:195]
v_exp_f32 v36, v36
M v[192:195], a[136:139], v[128:131], v[192:195]
ds_read_b128 a[164:167], v6 offset:38912
ds_read_b128 a[168:171], v6 offset:47104
M v[196:199], a[136:139], v[132:135], v[196:199]
v_exp_f32 v37, v37
M v[196:199], a[132:135], v[100:103], v[196:199]
v_cvt_pk_bf16_f32 v36, v36, v37
M v[200:203], a[132:135], v[104:107], v[200:203]
v_exp_f32 v38, v38
M v[200:203], a[136:139], v[136:139], v[200:203]
M v[204:207], a[136:139], v[140:143], v[204:207]
v_exp_f32 v39, v39
M v[204:207], a[132:135], v[108:111], v[204:207]
v_cvt_pk_bf16_f32 v37, v38, v39
s_waitcnt lgkmcnt(6)
M a[104:107], a[112:115], v[104:107], a[104:107]
M a[104:107], a[112:115], v[136:139], a[104:107]
M v[208:211], a[140:143], v[96:99], v[208:211]
v_exp_f32 v52, v52
M v[208:211], a[144:147], v[128:131], v[208:211]
ds_read_b128 a[172:175], v6 offset:39936
ds_read_b128 a[176:179], v6 offset:48128
M v[212:215], a[144:147], v[132:135], v[212:215]
v_exp_f32 v53, v53
M v[212:215], a[140:143], v[100:103], v[212:215]
v_cvt_pk_bf16_f32 v38, v52, v53
M v[216:219], a[140:143], v[104:107], v[216:219]
v_exp_f32 v54, v54
M v[216:219], a[144:147], v[136:139], v[216:219]
M v[220:223], a[144:147], v[140:143], v[220:223]
v_exp_f32 v55, v55
M v[220:223], a[140:143], v[108:111], v[220:223]
v_cvt_pk_bf16_f32 v39, v54, v55
s_waitcnt lgkmcnt(6)
M a[108:111], a[112:115], v[108:111], a[108:111]
M a[108:111], a[112:115], v[140:143], a[108:111]
M v[224:227], a[148:151], v[96:99], v[224:227]
v_exp_f32 v40, v40
M v[224:227], a[152:155], v[128:131], v[224:227]
M v[228:231], a[152:155], v[132:135], v[228:231]
v_exp_f32 v41, v41
M v[228:231], a[148:151], v[100:103], v[228:231]
v_cvt_pk_bf16_f32 v40, v40, v41
M v[232:235], a[148:151], v[104:107], v[232:235]
v_exp_f32 v42, v42
M v[232:235], a[152:155], v[136:139], v[232:235]
M v[236:239], a[152:155], v[140:143], v[236:239]
v_exp_f32 v43, v43
M v[236:239], a[148:151], v[108:111], v[236:239]
v_cvt_pk_bf16_f32 v41, v42, v43
s_waitcnt lgkmcnt(4)
M v[240:243], a[156:159], v[96:99], v[240:243]
v_exp_f32 v56, v56
M v[240:243], a[160:163], v[128:131], v[240:243]
M v[244:247], a[160:163], v[132:135], v[244:247]
v_exp_f32 v57, v57
M v[244:247], a[156:159], v[100:103], v[244:247]
v_cvt_pk_bf16_f32 v42, v56, v57
M v[248:251], a[156:159], v[104:107], v[248:251]
v_exp_f32 v58, v58
M v[248:251], a[160:163], v[136:139], v[248:251]
s_waitcnt vmcnt(0) lgkmcnt(0)
s_barrier
ds_read_b128 a[116:119], v2 offset:0
ds_read_b128 a[120:123], v2 offset:1024
M v[252:255], a[160:163], v[140:143], v[252:255]
v_exp_f32 v59, v59
M v[252:255], a[156:159], v[108:111], v[252:255]
v_cvt_pk_bf16_f32 v43, v58, v59
M a[64:67], a[164:167], v[96:99], a[64:67]
v_exp_f32 v44, v44
M a[64:67], a[168:171], v[128:131], a[64:67]
ds_read_b128 a[124:127], v2 offset:2048
ds_read_b128 a[128:131], v2 offset:3072
M a[68:71], a[168:171], v[132:135], a[68:71]
v_exp_f32 v45, v45
M a[68:71], a[164:167], v[100:103], a[68:71]
v_cvt_pk_bf16_f32 v44, v44, v45
M a[72:75], a[164:167], v[104:107], a[72:75]
v_exp_f32 v46, v46
M a[72:75], a[168:171], v[136:139], a[72:75]
ds_read_b128 a[132:135], v2 offset:4096
ds_read_b128 a[136:139], v2 offset:5120
M a[76:79], a[168:171], v[140:143], a[76:79]
v_exp_f32 v47, v47
M a[76:79], a[164:167], v[108:111], a[76:79]
v_cvt_pk_bf16_f32 v45, v46, v47
M a[80:83], a[172:175], v[96:99], a[80:83]
v_exp_f32 v60, v60
M a[80:83], a[176:179], v[128:131], a[80:83]
ds_read_b128 a[140:143], v2 offset:6144
ds_read_b128 a[144:147], v2 offset:7168
M a[84:87], a[176:179], v[132:135], a[84:87]
v_exp_f32 v61, v61
M a[84:87], a[172:175], v[100:103], a[84:87]
v_cvt_pk_bf16_f32 v46, v60, v61
M a[88:91], a[172:175], v[104:107], a[88:91]
v_exp_f32 v62, v62
M a[88:91], a[176:179], v[136:139], a[88:91]
M a[92:95], a[176:179], v[140:143], a[92:95]
v_exp_f32 v63, v63
M a[92:95], a[172:175], v[108:111], a[92:95]
v_cvt_pk_bf16_f32 v47, v62, v63
Lk2_m2b:
s_sub_u32 s35, 15, s21
s_lshl_b32 s33, s20, 7
s_lshl_b32 s34, s35, 3
s_add_u32 s33, s33, s34
s_lshl_b32 s34, s23, 2
s_add_u32 s33, s33, s34
s_lshl_b32 s33, s33, 12
buffer_load_dwordx4 a[180:183], v1, s[8:11], s33 offen offset:0 sc1
buffer_load_dwordx4 a[184:187], v1, s[8:11], s33 offen offset:1024 sc1
buffer_load_dwordx4 a[188:191], v1, s[8:11], s33 offen offset:2048 sc1
buffer_load_dwordx4 a[192:195], v1, s[8:11], s33 offen offset:3072 sc1
s_add_u32 s33, s33, 4096
buffer_load_dwordx4 a[196:199], v1, s[8:11], s33 offen offset:0 sc1
buffer_load_dwordx4 a[200:203], v1, s[8:11], s33 offen offset:1024 sc1
buffer_load_dwordx4 a[204:207], v1, s[8:11], s33 offen offset:2048 sc1
buffer_load_dwordx4 a[208:211], v1, s[8:11], s33 offen offset:3072 sc1
s_add_u32 s33, s33, 4096
buffer_load_dwordx4 a[212:215], v1, s[8:11], s33 offen offset:0 sc1
buffer_load_dwordx4 a[216:219], v1, s[8:11], s33 offen offset:1024 sc1
buffer_load_dwordx4 a[220:223], v1, s[8:11], s33 offen offset:2048 sc1
buffer_load_dwordx4 a[224:227], v1, s[8:11], s33 offen offset:3072 sc1
s_add_u32 s33, s33, 4096
buffer_load_dwordx4 a[228:231], v1, s[8:11], s33 offen offset:0 sc1
buffer_load_dwordx4 a[232:235], v1, s[8:11], s33 offen offset:1024 sc1
buffer_load_dwordx4 a[236:239], v1, s[8:11], s33 offen offset:2048 sc1
buffer_load_dwordx4 a[240:243], v1, s[8:11], s33 offen offset:3072 sc1
s_add_u32 m0, s29, 65536
s_waitcnt lgkmcnt(4)
M v[96:99], a[116:119], a[0:3], v[16:19]
v_exp_f32 v64, v64
M v[96:99], a[120:123], a[4:7], v[96:99]
ds_read_b128 a[148:151], v2 offset:8192
ds_read_b128 a[152:155], v2 offset:9216
M v[96:99], a[124:127], a[8:11], v[96:99]
v_exp_f32 v65, v65
M v[96:99], a[128:131], a[12:15], v[96:99]
buffer_load_dwordx4 v1, s[12:15], s25 offen offset:0 sc1 lds
s_add_u32 s32, s25, 4096
M v[100:103], a[128:131], a[28:31], 0
v_exp_f32 v66, v66
M v[100:103], a[124:127], a[24:27], v[100:103]
v_cvt_pk_bf16_f32 v64, v64, v65
M v[100:103], a[120:123], a[20:23], v[100:103]
v_exp_f32 v67, v67
M v[100:103], a[116:119], a[16:19], v[100:103]
buffer_load_dwordx4 v1, s[12:15], s25 offen offset:1024 sc1 lds
M v[104:107], a[116:119], a[32:35], 0
v_exp_f32 v80, v80
M v[104:107], a[120:123], a[36:39], v[104:107]
ds_read_b128 a[156:159], v2 offset:10240
ds_read_b128 a[160:163], v2 offset:11264
M v[104:107], a[124:127], a[40:43], v[104:107]
v_exp_f32 v81, v81
M v[104:107], a[128:131], a[44:47], v[104:107]
buffer_load_dwordx4 v1, s[12:15], s25 offen offset:2048 sc1 lds
M v[108:111], a[128:131], a[60:63], 0
v_exp_f32 v82, v82
M v[108:111], a[124:127], a[56:59], v[108:111]
v_cvt_pk_bf16_f32 v65, v66, v67
v_cvt_pk_bf16_f32 v66, v80, v81
M v[108:111], a[120:123], a[52:55], v[108:111]
v_exp_f32 v83, v83
M v[108:111], a[116:119], a[48:51], v[108:111]
buffer_load_dwordx4 v1, s[12:15], s25 offen offset:3072 sc1 lds
s_add_u32 m0, s29, 69632
s_waitcnt lgkmcnt(4)
v_exp_f32 v68, v68
ds_read_b128 a[164:167], v2 offset:12288
ds_read_b128 a[168:171], v2 offset:13312
v_exp_f32 v69, v69
buffer_load_dwordx4 v1, s[12:15], s32 offen offset:0 sc1 lds
M v[116:119], a[144:147], a[28:31], v[16:19]
v_exp_f32 v70, v70
M v[116:119], a[140:143], a[24:27], v[116:119]
v_cvt_pk_bf16_f32 v67, v82, v83
v_cvt_pk_bf16_f32 v68, v68, v69
M v[116:119], a[136:139], a[20:23], v[116:119]
v_exp_f32 v71, v71
M v[116:119], a[132:135], a[16:19], v[116:119]
buffer_load_dwordx4 v1, s[12:15], s32 offen offset:1024 sc1 lds
M v[120:123], a[132:135], a[32:35], 0
v_exp_f32 v84, v84
M v[120:123], a[136:139], a[36:39], v[120:123]
ds_read_b128 a[172:175], v2 offset:14336
ds_read_b128 a[176:179], v2 offset:15360
M v[120:123], a[140:143], a[40:43], v[120:123]
v_exp_f32 v85, v85
M v[120:123], a[144:147], a[44:47], v[120:123]
buffer_load_dwordx4 v1, s[12:15], s32 offen offset:2048 sc1 lds
M v[124:127], a[144:147], a[60:63], 0
v_exp_f32 v86, v86
M v[124:127], a[140:143], a[56:59], v[124:127]
v_cvt_pk_bf16_f32 v69, v70, v71
v_cvt_pk_bf16_f32 v70, v84, v85
M v[124:127], a[136:139], a[52:55], v[124:127]
v_exp_f32 v87, v87
M v[124:127], a[132:135], a[48:51], v[124:127]
buffer_load_dwordx4 v1, s[12:15], s32 offen offset:3072 sc1 lds
s_add_u32 m0, s29, 98304
s_waitcnt lgkmcnt(4)
v_exp_f32 v72, v72
ds_read_b128 a[116:119], v5 offset:32768
ds_read_b128 a[120:123], v5 offset:40960
v_exp_f32 v73, v73
buffer_load_dwordx4 v1, s[12:15], s26 offen offset:0 sc1 lds
s_add_u32 s43, s26, 4096
v_exp_f32 v74, v74
v_cvt_pk_bf16_f32 v71, v86, v87
v_cvt_pk_bf16_f32 v72, v72, v73
v_exp_f32 v75, v75
buffer_load_dwordx4 v1, s[12:15], s26 offen offset:1024 sc1 lds
M v[136:139], a[148:151], a[32:35], v[16:19]
v_exp_f32 v88, v88
M v[136:139], a[152:155], a[36:39], v[136:139]
ds_read_b128 a[124:127], v5 offset:33792
ds_read_b128 a[128:131], v5 offset:41984
M v[136:139], a[156:159], a[40:43], v[136:139]
v_exp_f32 v89, v89
M v[136:139], a[160:163], a[44:47], v[136:139]
buffer_load_dwordx4 v1, s[12:15], s26 offen offset:2048 sc1 lds
M v[140:143], a[160:163], a[60:63], 0
v_exp_f32 v90, v90
M v[140:143], a[156:159], a[56:59], v[140:143]
v_cvt_pk_bf16_f32 v73, v74, v75
v_cvt_pk_bf16_f32 v74, v88, v89
M v[140:143], a[152:155], a[52:55], v[140:143]
v_exp_f32 v91, v91
M v[140:143], a[148:151], a[48:51], v[140:143]
buffer_load_dwordx4 v1, s[12:15], s26 offen offset:3072 sc1 lds
s_add_u32 m0, s29, 102400
s_waitcnt lgkmcnt(4)
v_exp_f32 v76, v76
ds_read_b128 a[132:135], v5 offset:34816
ds_read_b128 a[136:139], v5 offset:43008
v_exp_f32 v77, v77
buffer_load_dwordx4 v1, s[12:15], s43 offen offset:0 sc1 lds
v_exp_f32 v78, v78
v_cvt_pk_bf16_f32 v75, v90, v91
v_cvt_pk_bf16_f32 v76, v76, v77
v_exp_f32 v79, v79
buffer_load_dwordx4 v1, s[12:15], s43 offen offset:1024 sc1 lds
v_exp_f32 v92, v92
ds_read_b128 a[140:143], v5 offset:35840
ds_read_b128 a[144:147], v5 offset:44032
v_exp_f32 v93, v93
buffer_load_dwordx4 v1, s[12:15], s43 offen offset:2048 sc1 lds
M v[156:159], a[176:179], a[60:63], v[16:19]
v_exp_f32 v94, v94
M v[156:159], a[172:175], a[56:59], v[156:159]
v_cvt_pk_bf16_f32 v77, v78, v79
v_cvt_pk_bf16_f32 v78, v92, v93
M v[156:159], a[168:171], a[52:55], v[156:159]
v_exp_f32 v95, v95
M v[156:159], a[164:167], a[48:51], v[156:159]
buffer_load_dwordx4 v1, s[12:15], s43 offen offset:3072 sc1 lds
v_cvt_pk_bf16_f32 v79, v94, v95
s_waitcnt lgkmcnt(6)
M v[160:163], a[116:119], v[32:35], v[160:163]
v_exp_f32 v96, v96
M v[160:163], a[120:123], v[64:67], v[160:163]
ds_read_b128 a[148:151], v5 offset:36864
ds_read_b128 a[152:155], v5 offset:45056
M v[164:167], a[120:123], v[68:71], v[164:167]
v_exp_f32 v97, v97
M v[164:167], a[116:119], v[36:39], v[164:167]
v_cvt_pk_bf16_f32 v96, v96, v97
M v[168:171], a[116:119], v[40:43], v[168:171]
v_exp_f32 v98, v98
M v[168:171], a[120:123], v[72:75], v[168:171]
s_add_u32 s25, s25, 32768
s_cmp_eq_u32 s25, s27
M v[172:175], a[120:123], v[76:79], v[172:175]
v_exp_f32 v99, v99
M v[172:175], a[116:119], v[44:47], v[172:175]
v_cvt_pk_bf16_f32 v97, v98, v99
s_waitcnt lgkmcnt(6)
M a[96:99], a[112:115], v[32:35], a[96:99]
s_cselect_b32 s25, s28, s25
s_cselect_b32 s27, -1, s27
M a[96:99], a[112:115], v[64:67], a[96:99]
s_add_u32 s26, s26, 32768
s_cmp_eq_u32 s26, s62
M v[176:179], a[124:127], v[32:35], v[176:179]
M v[176:179], a[128:131], v[64:67], v[176:179]
ds_read_b128 a[156:159], v5 offset:37888
ds_read_b128 a[160:163], v5 offset:46080
M v[180:183], a[128:131], v[68:71], v[180:183]
M v[180:183], a[124:127], v[36:39], v[180:183]
v_mov_b32 v98, 0
M v[184:187], a[124:127], v[40:43], v[184:187]
M v[184:187], a[128:131], v[72:75], v[184:187]
s_cselect_b32 s26, s63, s26
s_cselect_b32 s62, -1, s62
M v[188:191], a[128:131], v[76:79], v[188:191]
M v[188:191], a[124:127], v[44:47], v[188:191]
v_mov_b32 v99, 0
s_waitcnt lgkmcnt(6)
M a[100:103], a[112:115], v[36:39], a[100:103]
M a[100:103], a[112:115], v[68:71], a[100:103]
M v[192:195], a[132:135], v[32:35], v[192:195]
v_exp_f32 v100, v100
M v[192:195], a[136:139], v[64:67], v[192:195]
ds_read_b128 a[164:167], v5 offset:38912
ds_read_b128 a[168:171], v5 offset:47104
M v[196:199], a[136:139], v[68:71], v[196:199]
v_exp_f32 v101, v101
M v[196:199], a[132:135], v[36:39], v[196:199]
v_cvt_pk_bf16_f32 v100, v100, v101
M v[200:203], a[132:135], v[40:43], v[200:203]
v_exp_f32 v102, v102
M v[200:203], a[136:139], v[72:75], v[200:203]
M v[204:207], a[136:139], v[76:79], v[204:207]
v_exp_f32 v103, v103
M v[204:207], a[132:135], v[44:47], v[204:207]
v_cvt_pk_bf16_f32 v101, v102, v103
s_waitcnt lgkmcnt(6)
M a[104:107], a[112:115], v[40:43], a[104:107]
M a[104:107], a[112:115], v[72:75], a[104:107]
M v[208:211], a[140:143], v[32:35], v[208:211]
v_exp_f32 v116, v116
M v[208:211], a[144:147], v[64:67], v[208:211]
ds_read_b128 a[172:175], v5 offset:39936
ds_read_b128 a[176:179], v5 offset:48128
M v[212:215], a[144:147], v[68:71], v[212:215]
v_exp_f32 v117, v117
M v[212:215], a[140:143], v[36:39], v[212:215]
v_cvt_pk_bf16_f32 v102, v116, v117
M v[216:219], a[140:143], v[40:43], v[216:219]
v_exp_f32 v118, v118
M v[216:219], a[144:147], v[72:75], v[216:219]
M v[220:223], a[144:147], v[76:79], v[220:223]
v_exp_f32 v119, v119
M v[220:223], a[140:143], v[44:47], v[220:223]
v_cvt_pk_bf16_f32 v103, v118, v119
s_waitcnt lgkmcnt(6)
M a[108:111], a[112:115], v[44:47], a[108:111]
M a[108:111], a[112:115], v[76:79], a[108:111]
M v[224:227], a[148:151], v[32:35], v[224:227]
v_exp_f32 v104, v104
M v[224:227], a[152:155], v[64:67], v[224:227]
M v[228:231], a[152:155], v[68:71], v[228:231]
v_exp_f32 v105, v105
M v[228:231], a[148:151], v[36:39], v[228:231]
v_cvt_pk_bf16_f32 v104, v104, v105
M v[232:235], a[148:151], v[40:43], v[232:235]
v_exp_f32 v106, v106
M v[232:235], a[152:155], v[72:75], v[232:235]
M v[236:239], a[152:155], v[76:79], v[236:239]
v_exp_f32 v107, v107
M v[236:239], a[148:151], v[44:47], v[236:239]
v_cvt_pk_bf16_f32 v105, v106, v107
s_waitcnt lgkmcnt(4)
M v[240:243], a[156:159], v[32:35], v[240:243]
v_exp_f32 v120, v120
M v[240:243], a[160:163], v[64:67], v[240:243]
M v[244:247], a[160:163], v[68:71], v[244:247]
v_exp_f32 v121, v121
M v[244:247], a[156:159], v[36:39], v[244:247]
v_cvt_pk_bf16_f32 v106, v120, v121
M v[248:251], a[156:159], v[40:43], v[248:251]
v_exp_f32 v122, v122
M v[248:251], a[160:163], v[72:75], v[248:251]
s_waitcnt vmcnt(0) lgkmcnt(0)
s_barrier
ds_read_b128 a[116:119], v3 offset:0
ds_read_b128 a[120:123], v3 offset:1024
M v[252:255], a[160:163], v[76:79], v[252:255]
v_exp_f32 v123, v123
M v[252:255], a[156:159], v[44:47], v[252:255]
v_cvt_pk_bf16_f32 v107, v122, v123
M a[64:67], a[164:167], v[32:35], a[64:67]
v_exp_f32 v108, v108
M a[64:67], a[168:171], v[64:67], a[64:67]
ds_read_b128 a[124:127], v3 offset:2048
ds_read_b128 a[128:131], v3 offset:3072
M a[68:71], a[168:171], v[68:71], a[68:71]
v_exp_f32 v109, v109
M a[68:71], a[164:167], v[36:39], a[68:71]
v_cvt_pk_bf16_f32 v108, v108, v109
M a[72:75], a[164:167], v[40:43], a[72:75]
v_exp_f32 v110, v110
M a[72:75], a[168:171], v[72:75], a[72:75]
ds_read_b128 a[132:135], v3 offset:4096
ds_read_b128 a[136:139], v3 offset:5120
M a[76:79], a[168:171], v[76:79], a[76:79]
v_exp_f32 v111, v111
M a[76:79], a[164:167], v[44:47], a[76:79]
v_cvt_pk_bf16_f32 v109, v110, v111
M a[80:83], a[172:175], v[32:35], a[80:83]
v_exp_f32 v124, v124
M a[80:83], a[176:179], v[64:67], a[80:83]
ds_read_b128 a[140:143], v3 offset:6144
ds_read_b128 a[144:147], v3 offset:7168
M a[84:87], a[176:179], v[68:71], a[84:87]
v_exp_f32 v125, v125
M a[84:87], a[172:175], v[36:39], a[84:87]
v_cvt_pk_bf16_f32 v110, v124, v125
M a[88:91], a[172:175], v[40:43], a[88:91]
v_exp_f32 v126, v126
M a[88:91], a[176:179], v[72:75], a[88:91]
M a[92:95], a[176:179], v[76:79], a[92:95]
v_exp_f32 v127, v127
M a[92:95], a[172:175], v[44:47], a[92:95]
v_cvt_pk_bf16_f32 v111, v126, v127
s_waitcnt vmcnt(16)
s_add_u32 m0, s29, 0
s_waitcnt lgkmcnt(4)
M v[32:35], a[116:119], a[180:183], 0
M v[32:35], a[120:123], a[184:187], v[32:35]
ds_read_b128 a[148:151], v3 offset:8192
ds_read_b128 a[152:155], v3 offset:9216
M v[32:35], a[124:127], a[188:191], v[32:35]
M v[32:35], a[128:131], a[192:195], v[32:35]
buffer_load_dwordx4 v1, s[12:15], s25 offen offset:0 sc1 lds
s_add_u32 s32, s25, 4096
M v[36:39], a[128:131], a[208:211], 0
M v[36:39], a[124:127], a[204:207], v[36:39]
M v[36:39], a[120:123], a[200:203], v[36:39]
M v[36:39], a[116:119], a[196:199], v[36:39]
buffer_load_dwordx4 v1, s[12:15], s25 offen offset:1024 sc1 lds
M v[40:43], a[116:119], a[212:215], 0
M v[40:43], a[120:123], a[216:219], v[40:43]
ds_read_b128 a[156:159], v3 offset:10240
ds_read_b128 a[160:163], v3 offset:11264
M v[40:43], a[124:127], a[220:223], v[40:43]
M v[40:43], a[128:131], a[224:227], v[40:43]
buffer_load_dwordx4 v1, s[12:15], s25 offen offset:2048 sc1 lds
M v[44:47], a[128:131], a[240:243], 0
M v[44:47], a[124:127], a[236:239], v[44:47]
M v[44:47], a[120:123], a[232:235], v[44:47]
M v[44:47], a[116:119], a[228:231], v[44:47]
buffer_load_dwordx4 v1, s[12:15], s25 offen offset:3072 sc1 lds
s_add_u32 m0, s29, 4096
s_waitcnt lgkmcnt(4)
M v[48:51], a[132:135], a[180:183], 0
M v[48:51], a[136:139], a[184:187], v[48:51]
ds_read_b128 a[164:167], v3 offset:12288
ds_read_b128 a[168:171], v3 offset:13312
M v[48:51], a[140:143], a[188:191], v[48:51]
M v[48:51], a[144:147], a[192:195], v[48:51]
buffer_load_dwordx4 v1, s[12:15], s32 offen offset:0 sc1 lds
M v[52:55], a[144:147], a[208:211], 0
M v[52:55], a[140:143], a[204:207], v[52:55]
M v[52:55], a[136:139], a[200:203], v[52:55]
M v[52:55], a[132:135], a[196:199], v[52:55]
buffer_load_dwordx4 v1, s[12:15], s32 offen offset:1024 sc1 lds
M v[56:59], a[132:135], a[212:215], 0
M v[56:59], a[136:139], a[216:219], v[56:59]
ds_read_b128 a[172:175], v3 offset:14336
ds_read_b128 a[176:179], v3 offset:15360
M v[56:59], a[140:143], a[220:223], v[56:59]
M v[56:59], a[144:147], a[224:227], v[56:59]
buffer_load_dwordx4 v1, s[12:15], s32 offen offset:2048 sc1 lds
M v[60:63], a[144:147], a[240:243], 0
M v[60:63], a[140:143], a[236:239], v[60:63]
M v[60:63], a[136:139], a[232:235], v[60:63]
M v[60:63], a[132:135], a[228:231], v[60:63]
buffer_load_dwordx4 v1, s[12:15], s32 offen offset:3072 sc1 lds
s_add_u32 m0, s29, 32768
s_waitcnt lgkmcnt(4)
M v[64:67], a[148:151], a[180:183], 0
v_exp_f32 v136, v136
M v[64:67], a[152:155], a[184:187], v[64:67]
ds_read_b128 a[116:119], v6 offset:32768
ds_read_b128 a[120:123], v6 offset:40960
M v[64:67], a[156:159], a[188:191], v[64:67]
v_exp_f32 v137, v137
M v[64:67], a[160:163], a[192:195], v[64:67]
buffer_load_dwordx4 v1, s[12:15], s26 offen offset:0 sc1 lds
s_add_u32 s43, s26, 4096
M v[68:71], a[160:163], a[208:211], 0
v_exp_f32 v138, v138
M v[68:71], a[156:159], a[204:207], v[68:71]
v_cvt_pk_bf16_f32 v136, v136, v137
M v[68:71], a[152:155], a[200:203], v[68:71]
v_exp_f32 v139, v139
M v[68:71], a[148:151], a[196:199], v[68:71]
buffer_load_dwordx4 v1, s[12:15], s26 offen offset:1024 sc1 lds
M v[72:75], a[148:151], a[212:215], 0
M v[72:75], a[152:155], a[216:219], v[72:75]
ds_read_b128 a[124:127], v6 offset:33792
ds_read_b128 a[128:131], v6 offset:41984
M v[72:75], a[156:159], a[220:223], v[72:75]
M v[72:75], a[160:163], a[224:227], v[72:75]
buffer_load_dwordx4 v1, s[12:15], s26 offen offset:2048 sc1 lds
M v[76:79], a[160:163], a[240:243], 0
M v[76:79], a[156:159], a[236:239], v[76:79]
v_cvt_pk_bf16_f32 v137, v138, v139
v_mov_b32 v138, 0
M v[76:79], a[152:155], a[232:235], v[76:79]
M v[76:79], a[148:151], a[228:231], v[76:79]
buffer_load_dwordx4 v1, s[12:15], s26 offen offset:3072 sc1 lds
s_add_u32 m0, s29, 36864
s_waitcnt lgkmcnt(4)
M v[80:83], a[164:167], a[180:183], 0
v_exp_f32 v140, v140
M v[80:83], a[168:171], a[184:187], v[80:83]
ds_read_b128 a[132:135], v6 offset:34816
ds_read_b128 a[136:139], v6 offset:43008
M v[80:83], a[172:175], a[188:191], v[80:83]
v_exp_f32 v141, v141
M v[80:83], a[176:179], a[192:195], v[80:83]
buffer_load_dwordx4 v1, s[12:15], s43 offen offset:0 sc1 lds
M v[84:87], a[176:179], a[208:211], 0
v_exp_f32 v142, v142
M v[84:87], a[172:175], a[204:207], v[84:87]
v_mov_b32 v139, 0
v_cvt_pk_bf16_f32 v140, v140, v141
M v[84:87], a[168:171], a[200:203], v[84:87]
v_exp_f32 v143, v143
M v[84:87], a[164:167], a[196:199], v[84:87]
buffer_load_dwordx4 v1, s[12:15], s43 offen offset:1024 sc1 lds
M v[88:91], a[164:167], a[212:215], 0
v_exp_f32 v156, v156
M v[88:91], a[168:171], a[216:219], v[88:91]
ds_read_b128 a[140:143], v6 offset:35840
ds_read_b128 a[144:147], v6 offset:44032
M v[88:91], a[172:175], a[220:223], v[88:91]
v_exp_f32 v157, v157
M v[88:91], a[176:179], a[224:227], v[88:91]
buffer_load_dwordx4 v1, s[12:15], s43 offen offset:2048 sc1 lds
M v[92:95], a[176:179], a[240:243], 0
v_exp_f32 v158, v158
M v[92:95], a[172:175], a[236:239], v[92:95]
v_cvt_pk_bf16_f32 v141, v142, v143
v_cvt_pk_bf16_f32 v142, v156, v157
M v[92:95], a[168:171], a[232:235], v[92:95]
v_exp_f32 v159, v159
M v[92:95], a[164:167], a[228:231], v[92:95]
buffer_load_dwordx4 v1, s[12:15], s43 offen offset:3072 sc1 lds
v_cvt_pk_bf16_f32 v143, v158, v159
s_waitcnt lgkmcnt(6)
M v[160:163], a[116:119], v[96:99], v[160:163]
v_exp_f32 v32, v32
ds_read_b128 a[148:151], v6 offset:36864
ds_read_b128 a[152:155], v6 offset:45056
v_exp_f32 v33, v33
M v[164:167], a[116:119], v[100:103], v[164:167]
v_cvt_pk_bf16_f32 v32, v32, v33
M v[168:171], a[116:119], v[104:107], v[168:171]
v_exp_f32 v34, v34
M v[168:171], a[120:123], v[136:139], v[168:171]
s_add_u32 s25, s25, 32768
s_cmp_eq_u32 s25, s27
M v[172:175], a[120:123], v[140:143], v[172:175]
v_exp_f32 v35, v35
M v[172:175], a[116:119], v[108:111], v[172:175]
v_cvt_pk_bf16_f32 v33, v34, v35
s_waitcnt lgkmcnt(6)
M a[96:99], a[112:115], v[96:99], a[96:99]
s_cselect_b32 s25, s28, s25
s_cselect_b32 s27, -1, s27
s_add_u32 s26, s26, 32768
s_cmp_eq_u32 s26, s62
M v[176:179], a[124:127], v[96:99], v[176:179]
v_exp_f32 v48, v48
ds_read_b128 a[156:159], v6 offset:37888
ds_read_b128 a[160:163], v6 offset:46080
v_exp_f32 v49, v49
M v[180:183], a[124:127], v[100:103], v[180:183]
v_cvt_pk_bf16_f32 v34, v48, v49
M v[184:187], a[124:127], v[104:107], v[184:187]
v_exp_f32 v50, v50
M v[184:187], a[128:131], v[136:139], v[184:187]
s_cselect_b32 s26, s63, s26
s_cselect_b32 s62, -1, s62
M v[188:191], a[128:131], v[140:143], v[188:191]
v_exp_f32 v51, v51
M v[188:191], a[124:127], v[108:111], v[188:191]
v_cvt_pk_bf16_f32 v35, v50, v51
s_waitcnt lgkmcnt(6)
M a[100:103], a[112:115], v[100:103], a[100:103]
M v[192:195], a[132:135], v[96:99], v[192:195]
v_exp_f32 v36, v36
ds_read_b128 a[164:167], v6 offset:38912
ds_read_b128 a[168:171], v6 offset:47104
v_exp_f32 v37, v37
M v[196:199], a[132:135], v[100:103], v[196:199]
v_cvt_pk_bf16_f32 v36, v36, v37
M v[200:203], a[132:135], v[104:107], v[200:203]
v_exp_f32 v38, v38
M v[200:203], a[136:139], v[136:139], v[200:203]
M v[204:207], a[136:139], v[140:143], v[204:207]
v_exp_f32 v39, v39
M v[204:207], a[132:135], v[108:111], v[204:207]
v_cvt_pk_bf16_f32 v37, v38, v39
s_waitcnt lgkmcnt(6)
M a[104:107], a[112:115], v[104:107], a[104:107]
M a[104:107], a[112:115], v[136:139], a[104:107]
M v[208:211], a[140:143], v[96:99], v[208:211]
v_exp_f32 v52, v52
ds_read_b128 a[172:175], v6 offset:39936
ds_read_b128 a[176:179], v6 offset:48128
v_exp_f32 v53, v53
M v[212:215], a[140:143], v[100:103], v[212:215]
v_cvt_pk_bf16_f32 v38, v52, v53
M v[216:219], a[140:143], v[104:107], v[216:219]
v_exp_f32 v54, v54
M v[216:219], a[144:147], v[136:139], v[216:219]
M v[220:223], a[144:147], v[140:143], v[220:223]
v_exp_f32 v55, v55
M v[220:223], a[140:143], v[108:111], v[220:223]
v_cvt_pk_bf16_f32 v39, v54, v55
s_waitcnt lgkmcnt(6)
M a[108:111], a[112:115], v[108:111], a[108:111]
M a[108:111], a[112:115], v[140:143], a[108:111]
M v[224:227], a[148:151], v[96:99], v[224:227]
v_exp_f32 v40, v40
v_exp_f32 v41, v41
M v[228:231], a[148:151], v[100:103], v[228:231]
v_cvt_pk_bf16_f32 v40, v40, v41
M v[232:235], a[148:151], v[104:107], v[232:235]
v_exp_f32 v42, v42
M v[232:235], a[152:155], v[136:139], v[232:235]
M v[236:239], a[152:155], v[140:143], v[236:239]
v_exp_f32 v43, v43
M v[236:239], a[148:151], v[108:111], v[236:239]
v_cvt_pk_bf16_f32 v41, v42, v43
s_waitcnt lgkmcnt(4)
M v[240:243], a[156:159], v[96:99], v[240:243]
v_exp_f32 v56, v56
v_exp_f32 v57, v57
M v[244:247], a[156:159], v[100:103], v[244:247]
v_cvt_pk_bf16_f32 v42, v56, v57
M v[248:251], a[156:159], v[104:107], v[248:251]
v_exp_f32 v58, v58
M v[248:251], a[160:163], v[136:139], v[248:251]
s_waitcnt vmcnt(0) lgkmcnt(0)
s_barrier
ds_read_b128 a[116:119], v2 offset:0
ds_read_b128 a[120:123], v2 offset:1024
M v[252:255], a[160:163], v[140:143], v[252:255]
v_exp_f32 v59, v59
M v[252:255], a[156:159], v[108:111], v[252:255]
v_cvt_pk_bf16_f32 v43, v58, v59
M a[64:67], a[164:167], v[96:99], a[64:67]
v_exp_f32 v44, v44
ds_read_b128 a[124:127], v2 offset:2048
ds_read_b128 a[128:131], v2 offset:3072
v_exp_f32 v45, v45
M a[68:71], a[164:167], v[100:103], a[68:71]
v_cvt_pk_bf16_f32 v44, v44, v45
M a[72:75], a[164:167], v[104:107], a[72:75]
v_exp_f32 v46, v46
M a[72:75], a[168:171], v[136:139], a[72:75]
ds_read_b128 a[132:135], v2 offset:4096
ds_read_b128 a[136:139], v2 offset:5120
M a[76:79], a[168:171], v[140:143], a[76:79]
v_exp_f32 v47, v47
M a[76:79], a[164:167], v[108:111], a[76:79]
v_cvt_pk_bf16_f32 v45, v46, v47
M a[80:83], a[172:175], v[96:99], a[80:83]
v_exp_f32 v60, v60
ds_read_b128 a[140:143], v2 offset:6144
ds_read_b128 a[144:147], v2 offset:7168
v_exp_f32 v61, v61
M a[84:87], a[172:175], v[100:103], a[84:87]
v_cvt_pk_bf16_f32 v46, v60, v61
M a[88:91], a[172:175], v[104:107], a[88:91]
v_exp_f32 v62, v62
M a[88:91], a[176:179], v[136:139], a[88:91]
M a[92:95], a[176:179], v[140:143], a[92:95]
v_exp_f32 v63, v63
M a[92:95], a[172:175], v[108:111], a[92:95]
v_cvt_pk_bf16_f32 v47, v62, v63
Lk2_ea:
v_accvgpr_read_b32 v20, a96
v_accvgpr_read_b32 v21, a100
v_accvgpr_read_b32 v22, a104
v_accvgpr_read_b32 v23, a108
v_rcp_f32 v8, v20
v_rcp_f32 v9, v21
v_rcp_f32 v10, v22
v_rcp_f32 v11, v23
v_subrev_u32 v20, 0x21800000, v20
v_subrev_u32 v21, 0x21800000, v21
v_subrev_u32 v22, 0x21800000, v22
v_subrev_u32 v23, 0x21800000, v23
v_max_u32 v12, v20, v21
v_max3_u32 v12, v12, v22, v23
s_mov_b32 s64, 0x207
s_lshl_b32 s33, s21, 20
s_lshl_b32 s34, s20, 15
s_add_u32 s33, s33, s34
s_lshl_b32 s34, s23, 13
s_add_u32 s36, s33, s34
s_add_u32 s37, s36, 4096
s_add_u32 s38, s36, 16384
s_add_u32 s39, s36, 20480
v_pk_mul_f32 v[160:161], v[160:161], v[8:9] op_sel:[0,0] op_sel_hi:[1,0]
v_pk_mul_f32 v[162:163], v[162:163], v[8:9] op_sel:[0,0] op_sel_hi:[1,0]
v_pk_mul_f32 v[176:177], v[176:177], v[8:9] op_sel:[0,0] op_sel_hi:[1,0]
v_pk_mul_f32 v[178:179], v[178:179], v[8:9] op_sel:[0,0] op_sel_hi:[1,0]
v_cvt_pk_bf16_f32 v160, v160, v161
v_cvt_pk_bf16_f32 v161, v162, v163
v_cvt_pk_bf16_f32 v162, v176, v177
v_cvt_pk_bf16_f32 v163, v178, v179
s_nop 1
M v[24:27], a[112:115], v[160:163], 0
buffer_store_dwordx4 v[160:163], v1, s[16:19], s36 offen offset:0 sc1
v_pk_mul_f32 v[164:165], v[164:165], v[8:9] op_sel:[0,1] op_sel_hi:[1,1]
v_pk_mul_f32 v[166:167], v[166:167], v[8:9] op_sel:[0,1] op_sel_hi:[1,1]
v_pk_mul_f32 v[180:181], v[180:181], v[8:9] op_sel:[0,1] op_sel_hi:[1,1]
v_pk_mul_f32 v[182:183], v[182:183], v[8:9] op_sel:[0,1] op_sel_hi:[1,1]
v_cvt_pk_bf16_f32 v164, v164, v165
v_cvt_pk_bf16_f32 v165, v166, v167
v_cvt_pk_bf16_f32 v166, v180, v181
v_cvt_pk_bf16_f32 v167, v182, v183
s_nop 1
M v[24:27], a[112:115], v[164:167], v[24:27]
buffer_store_dwordx4 v[164:167], v1, s[16:19], s36 offen offset:2048 sc1
v_pk_mul_f32 v[168:169], v[168:169], v[10:11] op_sel:[0,0] op_sel_hi:[1,0]
v_pk_mul_f32 v[170:171], v[170:171], v[10:11] op_sel:[0,0] op_sel_hi:[1,0]
v_pk_mul_f32 v[184:185], v[184:185], v[10:11] op_sel:[0,0] op_sel_hi:[1,0]
v_pk_mul_f32 v[186:187], v[186:187], v[10:11] op_sel:[0,0] op_sel_hi:[1,0]
v_cvt_pk_bf16_f32 v168, v168, v169
v_cvt_pk_bf16_f32 v169, v170, v171
v_cvt_pk_bf16_f32 v170, v184, v185
v_cvt_pk_bf16_f32 v171, v186, v187
s_nop 1
M v[24:27], a[112:115], v[168:171], v[24:27]
buffer_store_dwordx4 v[168:171], v1, s[16:19], s37 offen offset:0 sc1
v_pk_mul_f32 v[172:173], v[172:173], v[10:11] op_sel:[0,1] op_sel_hi:[1,1]
v_pk_mul_f32 v[174:175], v[174:175], v[10:11] op_sel:[0,1] op_sel_hi:[1,1]
v_pk_mul_f32 v[188:189], v[188:189], v[10:11] op_sel:[0,1] op_sel_hi:[1,1]
v_pk_mul_f32 v[190:191], v[190:191], v[10:11] op_sel:[0,1] op_sel_hi:[1,1]
v_cvt_pk_bf16_f32 v172, v172, v173
v_cvt_pk_bf16_f32 v173, v174, v175
v_cvt_pk_bf16_f32 v174, v188, v189
v_cvt_pk_bf16_f32 v175, v190, v191
s_nop 1
M v[24:27], a[112:115], v[172:175], v[24:27]
buffer_store_dwordx4 v[172:175], v1, s[16:19], s37 offen offset:2048 sc1
v_pk_mul_f32 v[192:193], v[192:193], v[8:9] op_sel:[0,0] op_sel_hi:[1,0]
v_pk_mul_f32 v[194:195], v[194:195], v[8:9] op_sel:[0,0] op_sel_hi:[1,0]
v_pk_mul_f32 v[208:209], v[208:209], v[8:9] op_sel:[0,0] op_sel_hi:[1,0]
v_pk_mul_f32 v[210:211], v[210:211], v[8:9] op_sel:[0,0] op_sel_hi:[1,0]
v_cvt_pk_bf16_f32 v192, v192, v193
v_cvt_pk_bf16_f32 v193, v194, v195
v_cvt_pk_bf16_f32 v194, v208, v209
v_cvt_pk_bf16_f32 v195, v210, v211
s_nop 1
M v[24:27], a[112:115], v[192:195], v[24:27]
buffer_store_dwordx4 v[192:195], v1, s[16:19], s36 offen offset:1024 sc1
v_pk_mul_f32 v[196:197], v[196:197], v[8:9] op_sel:[0,1] op_sel_hi:[1,1]
v_pk_mul_f32 v[198:199], v[198:199], v[8:9] op_sel:[0,1] op_sel_hi:[1,1]
v_pk_mul_f32 v[212:213], v[212:213], v[8:9] op_sel:[0,1] op_sel_hi:[1,1]
v_pk_mul_f32 v[214:215], v[214:215], v[8:9] op_sel:[0,1] op_sel_hi:[1,1]
v_cvt_pk_bf16_f32 v196, v196, v197
v_cvt_pk_bf16_f32 v197, v198, v199
v_cvt_pk_bf16_f32 v198, v212, v213
v_cvt_pk_bf16_f32 v199, v214, v215
s_nop 1
M v[24:27], a[112:115], v[196:199], v[24:27]
buffer_store_dwordx4 v[196:199], v1, s[16:19], s36 offen offset:3072 sc1
v_pk_mul_f32 v[200:201], v[200:201], v[10:11] op_sel:[0,0] op_sel_hi:[1,0]
v_pk_mul_f32 v[202:203], v[202:203], v[10:11] op_sel:[0,0] op_sel_hi:[1,0]
v_pk_mul_f32 v[216:217], v[216:217], v[10:11] op_sel:[0,0] op_sel_hi:[1,0]
v_pk_mul_f32 v[218:219], v[218:219], v[10:11] op_sel:[0,0] op_sel_hi:[1,0]
v_cvt_pk_bf16_f32 v200, v200, v201
v_cvt_pk_bf16_f32 v201, v202, v203
v_cvt_pk_bf16_f32 v202, v216, v217
v_cvt_pk_bf16_f32 v203, v218, v219
s_nop 1
M v[24:27], a[112:115], v[200:203], v[24:27]
buffer_store_dwordx4 v[200:203], v1, s[16:19], s37 offen offset:1024 sc1
v_pk_mul_f32 v[204:205], v[204:205], v[10:11] op_sel:[0,1] op_sel_hi:[1,1]
v_pk_mul_f32 v[206:207], v[206:207], v[10:11] op_sel:[0,1] op_sel_hi:[1,1]
v_pk_mul_f32 v[220:221], v[220:221], v[10:11] op_sel:[0,1] op_sel_hi:[1,1]
v_pk_mul_f32 v[222:223], v[222:223], v[10:11] op_sel:[0,1] op_sel_hi:[1,1]
v_cvt_pk_bf16_f32 v204, v204, v205
v_cvt_pk_bf16_f32 v205, v206, v207
v_cvt_pk_bf16_f32 v206, v220, v221
v_cvt_pk_bf16_f32 v207, v222, v223
s_nop 1
M v[24:27], a[112:115], v[204:207], v[24:27]
buffer_store_dwordx4 v[204:207], v1, s[16:19], s37 offen offset:3072 sc1
v_pk_mul_f32 v[224:225], v[224:225], v[8:9] op_sel:[0,0] op_sel_hi:[1,0]
v_pk_mul_f32 v[226:227], v[226:227], v[8:9] op_sel:[0,0] op_sel_hi:[1,0]
v_pk_mul_f32 v[240:241], v[240:241], v[8:9] op_sel:[0,0] op_sel_hi:[1,0]
v_pk_mul_f32 v[242:243], v[242:243], v[8:9] op_sel:[0,0] op_sel_hi:[1,0]
v_cvt_pk_bf16_f32 v224, v224, v225
v_cvt_pk_bf16_f32 v225, v226, v227
v_cvt_pk_bf16_f32 v226, v240, v241
v_cvt_pk_bf16_f32 v227, v242, v243
s_nop 1
M v[24:27], a[112:115], v[224:227], v[24:27]
buffer_store_dwordx4 v[224:227], v1, s[16:19], s38 offen offset:0 sc1
v_pk_mul_f32 v[228:229], v[228:229], v[8:9] op_sel:[0,1] op_sel_hi:[1,1]
v_pk_mul_f32 v[230:231], v[230:231], v[8:9] op_sel:[0,1] op_sel_hi:[1,1]
v_pk_mul_f32 v[244:245], v[244:245], v[8:9] op_sel:[0,1] op_sel_hi:[1,1]
v_pk_mul_f32 v[246:247], v[246:247], v[8:9] op_sel:[0,1] op_sel_hi:[1,1]
v_cvt_pk_bf16_f32 v228, v228, v229
v_cvt_pk_bf16_f32 v229, v230, v231
v_cvt_pk_bf16_f32 v230, v244, v245
v_cvt_pk_bf16_f32 v231, v246, v247
s_nop 1
M v[24:27], a[112:115], v[228:231], v[24:27]
buffer_store_dwordx4 v[228:231], v1, s[16:19], s38 offen offset:2048 sc1
v_pk_mul_f32 v[232:233], v[232:233], v[10:11] op_sel:[0,0] op_sel_hi:[1,0]
v_pk_mul_f32 v[234:235], v[234:235], v[10:11] op_sel:[0,0] op_sel_hi:[1,0]
v_pk_mul_f32 v[248:249], v[248:249], v[10:11] op_sel:[0,0] op_sel_hi:[1,0]
v_pk_mul_f32 v[250:251], v[250:251], v[10:11] op_sel:[0,0] op_sel_hi:[1,0]
v_cvt_pk_bf16_f32 v232, v232, v233
v_cvt_pk_bf16_f32 v233, v234, v235
v_cvt_pk_bf16_f32 v234, v248, v249
v_cvt_pk_bf16_f32 v235, v250, v251
s_nop 1
M v[24:27], a[112:115], v[232:235], v[24:27]
buffer_store_dwordx4 v[232:235], v1, s[16:19], s39 offen offset:0 sc1
v_pk_mul_f32 v[236:237], v[236:237], v[10:11] op_sel:[0,1] op_sel_hi:[1,1]
v_pk_mul_f32 v[238:239], v[238:239], v[10:11] op_sel:[0,1] op_sel_hi:[1,1]
v_pk_mul_f32 v[252:253], v[252:253], v[10:11] op_sel:[0,1] op_sel_hi:[1,1]
v_pk_mul_f32 v[254:255], v[254:255], v[10:11] op_sel:[0,1] op_sel_hi:[1,1]
v_cvt_pk_bf16_f32 v236, v236, v237
v_cvt_pk_bf16_f32 v237, v238, v239
v_cvt_pk_bf16_f32 v238, v252, v253
v_cvt_pk_bf16_f32 v239, v254, v255
v_accvgpr_read_b32 v176, a64
v_accvgpr_read_b32 v177, a65
v_accvgpr_read_b32 v178, a66
v_accvgpr_read_b32 v179, a67
v_accvgpr_read_b32 v180, a80
v_accvgpr_read_b32 v181, a81
v_accvgpr_read_b32 v182, a82
v_accvgpr_read_b32 v183, a83
M v[24:27], a[112:115], v[236:239], v[24:27]
buffer_store_dwordx4 v[236:239], v1, s[16:19], s39 offen offset:2048 sc1
v_pk_mul_f32 v[176:177], v[176:177], v[8:9] op_sel:[0,0] op_sel_hi:[1,0]
v_pk_mul_f32 v[178:179], v[178:179], v[8:9] op_sel:[0,0] op_sel_hi:[1,0]
v_pk_mul_f32 v[180:181], v[180:181], v[8:9] op_sel:[0,0] op_sel_hi:[1,0]
v_pk_mul_f32 v[182:183], v[182:183], v[8:9] op_sel:[0,0] op_sel_hi:[1,0]
v_cvt_pk_bf16_f32 v176, v176, v177
v_cvt_pk_bf16_f32 v177, v178, v179
v_cvt_pk_bf16_f32 v178, v180, v181
v_cvt_pk_bf16_f32 v179, v182, v183
v_accvgpr_read_b32 v184, a68
v_accvgpr_read_b32 v185, a69
v_accvgpr_read_b32 v186, a70
v_accvgpr_read_b32 v187, a71
v_accvgpr_read_b32 v188, a84
v_accvgpr_read_b32 v189, a85
v_accvgpr_read_b32 v190, a86
v_accvgpr_read_b32 v191, a87
M v[24:27], a[112:115], v[176:179], v[24:27]
buffer_store_dwordx4 v[176:179], v1, s[16:19], s38 offen offset:1024 sc1
v_pk_mul_f32 v[184:185], v[184:185], v[8:9] op_sel:[0,1] op_sel_hi:[1,1]
v_pk_mul_f32 v[186:187], v[186:187], v[8:9] op_sel:[0,1] op_sel_hi:[1,1]
v_pk_mul_f32 v[188:189], v[188:189], v[8:9] op_sel:[0,1] op_sel_hi:[1,1]
v_pk_mul_f32 v[190:191], v[190:191], v[8:9] op_sel:[0,1] op_sel_hi:[1,1]
v_cvt_pk_bf16_f32 v184, v184, v185
v_cvt_pk_bf16_f32 v185, v186, v187
v_cvt_pk_bf16_f32 v186, v188, v189
v_cvt_pk_bf16_f32 v187, v190, v191
v_accvgpr_read_b32 v208, a72
v_accvgpr_read_b32 v209, a73
v_accvgpr_read_b32 v210, a74
v_accvgpr_read_b32 v211, a75
v_accvgpr_read_b32 v212, a88
v_accvgpr_read_b32 v213, a89
v_accvgpr_read_b32 v214, a90
v_accvgpr_read_b32 v215, a91
M v[24:27], a[112:115], v[184:187], v[24:27]
buffer_store_dwordx4 v[184:187], v1, s[16:19], s38 offen offset:3072 sc1
v_pk_mul_f32 v[208:209], v[208:209], v[10:11] op_sel:[0,0] op_sel_hi:[1,0]
v_pk_mul_f32 v[210:211], v[210:211], v[10:11] op_sel:[0,0] op_sel_hi:[1,0]
v_pk_mul_f32 v[212:213], v[212:213], v[10:11] op_sel:[0,0] op_sel_hi:[1,0]
v_pk_mul_f32 v[214:215], v[214:215], v[10:11] op_sel:[0,0] op_sel_hi:[1,0]
v_cvt_pk_bf16_f32 v208, v208, v209
v_cvt_pk_bf16_f32 v209, v210, v211
v_cvt_pk_bf16_f32 v210, v212, v213
v_cvt_pk_bf16_f32 v211, v214, v215
v_accvgpr_read_b32 v216, a76
v_accvgpr_read_b32 v217, a77
v_accvgpr_read_b32 v218, a78
v_accvgpr_read_b32 v219, a79
v_accvgpr_read_b32 v220, a92
v_accvgpr_read_b32 v221, a93
v_accvgpr_read_b32 v222, a94
v_accvgpr_read_b32 v223, a95
M v[24:27], a[112:115], v[208:211], v[24:27]
buffer_store_dwordx4 v[208:211], v1, s[16:19], s39 offen offset:1024 sc1
v_pk_mul_f32 v[216:217], v[216:217], v[10:11] op_sel:[0,1] op_sel_hi:[1,1]
v_pk_mul_f32 v[218:219], v[218:219], v[10:11] op_sel:[0,1] op_sel_hi:[1,1]
v_pk_mul_f32 v[220:221], v[220:221], v[10:11] op_sel:[0,1] op_sel_hi:[1,1]
v_pk_mul_f32 v[222:223], v[222:223], v[10:11] op_sel:[0,1] op_sel_hi:[1,1]
v_cvt_pk_bf16_f32 v216, v216, v217
v_cvt_pk_bf16_f32 v217, v218, v219
v_cvt_pk_bf16_f32 v218, v220, v221
v_cvt_pk_bf16_f32 v219, v222, v223
s_nop 1
M v[24:27], a[112:115], v[216:219], v[24:27]
buffer_store_dwordx4 v[216:219], v1, s[16:19], s39 offen offset:3072 sc1
v_cmp_lt_u32 vcc, 0x3c000000, v12
s_nop 5
v_cmp_class_f32 s[40:41], v24, s64
s_nop 0
s_or_b64 vcc, vcc, s[40:41]
s_cmp_lg_u64 vcc, 0
s_cselect_b32 s33, 1, 0
s_or_b32 s60, s60, s33
s_sub_u32 s30, 7, s21
s_cmp_lg_u32 s30, 0
s_cbranch_scc1 Lk2_b0
s_and_b32 s3, s2, 3
s_lshl_b32 s3, s3, 2
s_bfe_u32 s27, s2, 0x20003
s_add_u32 s27, s3, s27
s_lshl_b32 s43, s27, 8
s_add_u32 s43, s43, 16789504
v_lshlrev_b32 v15, 2, v0
buffer_load_dword v7, v15, s[52:55], s43 offen sc1
s_waitcnt lgkmcnt(7)
ds_read_b128 a[116:119], v5 offset:36864
s_waitcnt lgkmcnt(7)
ds_read_b128 a[120:123], v5 offset:45056
s_waitcnt lgkmcnt(7)
ds_read_b128 a[124:127], v5 offset:37888
s_waitcnt lgkmcnt(7)
ds_read_b128 a[128:131], v5 offset:46080
s_waitcnt lgkmcnt(7)
ds_read_b128 a[132:135], v5 offset:38912
s_waitcnt lgkmcnt(7)
ds_read_b128 a[136:139], v5 offset:47104
s_waitcnt lgkmcnt(7)
ds_read_b128 a[140:143], v5 offset:39936
s_waitcnt lgkmcnt(7)
ds_read_b128 a[144:147], v5 offset:48128
s_lshl_b32 s33, s23, 14
s_add_u32 s34, s33, 98304
s_add_u32 s33, s33, 131072
v_add_u32 v2, s34, v1
v_add_u32 v3, s33, v1
v_exp_f32 v64, v64
v_exp_f32 v65, v65
v_exp_f32 v66, v66
v_exp_f32 v67, v67
v_exp_f32 v80, v80
v_exp_f32 v81, v81
v_exp_f32 v82, v82
v_exp_f32 v83, v83
v_cvt_pk_bf16_f32 v64, v64, v65
v_cvt_pk_bf16_f32 v65, v66, v67
v_exp_f32 v68, v68
v_exp_f32 v69, v69
v_exp_f32 v70, v70
v_exp_f32 v71, v71
v_cvt_pk_bf16_f32 v66, v80, v81
v_cvt_pk_bf16_f32 v67, v82, v83
v_exp_f32 v84, v84
v_exp_f32 v85, v85
v_exp_f32 v86, v86
v_exp_f32 v87, v87
v_cvt_pk_bf16_f32 v68, v68, v69
v_cvt_pk_bf16_f32 v69, v70, v71
v_exp_f32 v72, v72
v_exp_f32 v73, v73
v_exp_f32 v74, v74
v_exp_f32 v75, v75
v_cvt_pk_bf16_f32 v70, v84, v85
v_cvt_pk_bf16_f32 v71, v86, v87
v_exp_f32 v88, v88
v_exp_f32 v89, v89
v_exp_f32 v90, v90
v_exp_f32 v91, v91
v_cvt_pk_bf16_f32 v72, v72, v73
v_cvt_pk_bf16_f32 v73, v74, v75
v_exp_f32 v76, v76
v_exp_f32 v77, v77
v_exp_f32 v78, v78
v_exp_f32 v79, v79
v_cvt_pk_bf16_f32 v74, v88, v89
v_cvt_pk_bf16_f32 v75, v90, v91
v_exp_f32 v92, v92
v_exp_f32 v93, v93
v_exp_f32 v94, v94
v_exp_f32 v95, v95
v_cvt_pk_bf16_f32 v76, v76, v77
v_cvt_pk_bf16_f32 v77, v78, v79
v_cvt_pk_bf16_f32 v78, v92, v93
v_cvt_pk_bf16_f32 v79, v94, v95
s_waitcnt lgkmcnt(6)
M v[224:227], a[116:119], v[32:35], 0
M v[224:227], a[120:123], v[64:67], v[224:227]
ds_read_b128 a[148:151], v5 offset:32768
ds_read_b128 a[152:155], v5 offset:40960
s_mov_b32 s61, 0
M v[228:231], a[120:123], v[68:71], 0
M v[228:231], a[116:119], v[36:39], v[228:231]
s_bfe_u32 s3, s2, 0x10002
M v[232:235], a[116:119], v[40:43], 0
M v[232:235], a[120:123], v[72:75], v[232:235]
s_lshl_b32 s3, s3, 3
M v[236:239], a[120:123], v[76:79], 0
M v[236:239], a[116:119], v[44:47], v[236:239]
s_waitcnt lgkmcnt(6)
s_lshr_b32 s28, s2, 5
M a[96:99], a[112:115], v[32:35], 0
M a[96:99], a[112:115], v[64:67], a[96:99]
M v[240:243], a[124:127], v[32:35], 0
M v[240:243], a[128:131], v[64:67], v[240:243]
ds_read_b128 a[156:159], v5 offset:33792
ds_read_b128 a[160:163], v5 offset:41984
s_add_u32 s28, s3, s28
M v[244:247], a[128:131], v[68:71], 0
s_lshl_b32 s25, s27, 18
M v[244:247], a[124:127], v[36:39], v[244:247]
M v[248:251], a[124:127], v[40:43], 0
s_lshl_b32 s3, s101, 12
M v[248:251], a[128:131], v[72:75], v[248:251]
M v[252:255], a[128:131], v[76:79], 0
s_add_u32 s25, s25, s3
M v[252:255], a[124:127], v[44:47], v[252:255]
s_waitcnt lgkmcnt(6)
M a[100:103], a[112:115], v[36:39], 0
M a[100:103], a[112:115], v[68:71], a[100:103]
M a[64:67], a[132:135], v[32:35], 0
s_lshl_b32 s26, s28, 7
M a[64:67], a[136:139], v[64:67], a[64:67]
ds_read_b128 a[164:167], v5 offset:34816
ds_read_b128 a[168:171], v5 offset:43008
M a[68:71], a[136:139], v[68:71], 0
s_lshl_b32 s42, s101, 11
M a[68:71], a[132:135], v[36:39], a[68:71]
M a[72:75], a[132:135], v[40:43], 0
s_add_u32 s44, s4, 83886080
s_addc_u32 s45, s5, 0
M a[72:75], a[136:139], v[72:75], a[72:75]
s_mov_b32 s46, 4194304
M a[76:79], a[136:139], v[76:79], 0
M a[76:79], a[132:135], v[44:47], a[76:79]
s_waitcnt lgkmcnt(6)
s_mov_b32 s47, 0x00020000
M a[104:107], a[112:115], v[40:43], 0
M a[104:107], a[112:115], v[72:75], a[104:107]
M a[80:83], a[140:143], v[32:35], 0
M a[80:83], a[144:147], v[64:67], a[80:83]
ds_read_b128 a[172:175], v5 offset:35840
ds_read_b128 a[176:179], v5 offset:44032
s_mov_b32 s50, 2097152
M a[84:87], a[144:147], v[68:71], 0
M a[84:87], a[140:143], v[36:39], a[84:87]
s_mov_b32 s51, 0x00020000
M a[88:91], a[140:143], v[40:43], 0
M a[88:91], a[144:147], v[72:75], a[88:91]
s_lshl_b32 s3, s101, 4
M a[92:95], a[144:147], v[76:79], 0
M a[92:95], a[140:143], v[44:47], a[92:95]
s_waitcnt lgkmcnt(6)
v_lshrrev_b32 v96, 3, v0
M a[108:111], a[112:115], v[44:47], 0
M a[108:111], a[112:115], v[76:79], a[108:111]
M v[160:163], a[148:151], v[32:35], 0
v_and_b32 v97, 6, v96
M v[160:163], a[152:155], v[64:67], v[160:163]
M v[164:167], a[152:155], v[68:71], 0
ds_write_b128 v2, v[224:227] offset:0
v_and_b32 v98, 7, v0
M v[164:167], a[148:151], v[36:39], v[164:167]
M v[168:171], a[148:151], v[40:43], 0
ds_write_b128 v2, v[228:231] offset:1024
v_xor_b32 v97, v97, v98
M v[168:171], a[152:155], v[72:75], v[168:171]
M v[172:175], a[152:155], v[76:79], 0
ds_write_b128 v2, v[232:235] offset:2048
v_add_u32 v96, s3, v96
M v[172:175], a[148:151], v[44:47], v[172:175]
s_waitcnt lgkmcnt(7)
M v[176:179], a[156:159], v[32:35], 0
ds_write_b128 v2, v[236:239] offset:3072
v_lshlrev_b32 v96, 11, v96
M v[176:179], a[160:163], v[64:67], v[176:179]
M v[180:183], a[160:163], v[68:71], 0
ds_write_b128 v2, v[240:243] offset:4096
v_lshl_add_u32 v99, v97, 4, v96
M v[180:183], a[156:159], v[36:39], v[180:183]
v_add_u32 v100, 15360, v99
M v[184:187], a[156:159], v[40:43], 0
ds_write_b128 v2, v[244:247] offset:5120
M v[184:187], a[160:163], v[72:75], v[184:187]
s_waitcnt vmcnt(0) lgkmcnt(0)
s_barrier
M v[188:191], a[160:163], v[76:79], 0
ds_write_b128 v2, v[248:251] offset:6144
v_cmp_ne_u32 vcc, 1, v7
s_nop 0
s_cbranch_vccnz Lk3_spinb0
Lk3_gotb0:
M v[188:191], a[156:159], v[44:47], v[188:191]
s_add_u32 m0, s42, 16384
s_nop 0
buffer_load_dwordx4 v99, s[48:51], s26 offen offset:0 lds
M v[192:195], a[164:167], v[32:35], 0
ds_write_b128 v2, v[252:255] offset:7168
buffer_load_dwordx4 v100, s[48:51], s26 offen offset:1024 lds
M v[192:195], a[168:171], v[64:67], v[192:195]
M v[196:199], a[168:171], v[68:71], 0
ds_write_b128 v2, a[64:67] offset:8192
buffer_load_dwordx4 a[192:195], v1, s[44:47], s25 offen offset:0 sc1
M v[196:199], a[164:167], v[36:39], v[196:199]
buffer_load_dwordx4 a[196:199], v1, s[44:47], s25 offen offset:1024 sc1
M v[200:203], a[164:167], v[40:43], 0
ds_write_b128 v2, a[68:71] offset:9216
buffer_load_dwordx4 a[200:203], v1, s[44:47], s25 offen offset:2048 sc1
M v[200:203], a[168:171], v[72:75], v[200:203]
buffer_load_dwordx4 a[204:207], v1, s[44:47], s25 offen offset:3072 sc1
M v[204:207], a[168:171], v[76:79], 0
ds_write_b128 v2, a[72:75] offset:10240
M v[204:207], a[164:167], v[44:47], v[204:207]
s_add_u32 s25, s25, 16384
s_add_u32 s26, s26, 131072
M v[208:211], a[172:175], v[32:35], 0
ds_write_b128 v2, a[76:79] offset:11264
s_add_u32 m0, s42, 32768
s_nop 0
buffer_load_dwordx4 v99, s[48:51], s26 offen offset:0 lds
M v[208:211], a[176:179], v[64:67], v[208:211]
buffer_load_dwordx4 v100, s[48:51], s26 offen offset:1024 lds
M v[212:215], a[176:179], v[68:71], 0
ds_write_b128 v2, a[80:83] offset:12288
buffer_load_dwordx4 a[224:227], v1, s[44:47], s25 offen offset:0 sc1
M v[212:215], a[172:175], v[36:39], v[212:215]
M v[216:219], a[172:175], v[40:43], 0
ds_write_b128 v2, a[84:87] offset:13312
buffer_load_dwordx4 a[228:231], v1, s[44:47], s25 offen offset:1024 sc1
M v[216:219], a[176:179], v[72:75], v[216:219]
buffer_load_dwordx4 a[232:235], v1, s[44:47], s25 offen offset:2048 sc1
M v[220:223], a[176:179], v[76:79], 0
ds_write_b128 v2, a[88:91] offset:14336
buffer_load_dwordx4 a[236:239], v1, s[44:47], s25 offen offset:3072 sc1
M v[220:223], a[172:175], v[44:47], v[220:223]
s_add_u32 s25, s25, 16384
s_add_u32 s26, s26, 131072
ds_write_b128 v2, a[92:95] offset:15360
s_waitcnt lgkmcnt(0)
s_branch Lk2_merge
Lk2_b0:
s_add_u32 m0, s29, 65536
s_waitcnt lgkmcnt(4)
M v[96:99], a[116:119], a[180:183], 0
v_exp_f32 v64, v64
M v[96:99], a[120:123], a[184:187], v[96:99]
ds_read_b128 a[148:151], v2 offset:8192
ds_read_b128 a[152:155], v2 offset:9216
M v[96:99], a[124:127], a[188:191], v[96:99]
v_exp_f32 v65, v65
M v[96:99], a[128:131], a[192:195], v[96:99]
buffer_load_dwordx4 v1, s[12:15], s25 offen offset:0 sc1 lds
s_add_u32 s32, s25, 4096
M v[100:103], a[128:131], a[208:211], 0
v_exp_f32 v66, v66
M v[100:103], a[124:127], a[204:207], v[100:103]
v_cvt_pk_bf16_f32 v64, v64, v65
M v[100:103], a[120:123], a[200:203], v[100:103]
v_exp_f32 v67, v67
M v[100:103], a[116:119], a[196:199], v[100:103]
buffer_load_dwordx4 v1, s[12:15], s25 offen offset:1024 sc1 lds
M v[104:107], a[116:119], a[212:215], 0
v_exp_f32 v80, v80
M v[104:107], a[120:123], a[216:219], v[104:107]
ds_read_b128 a[156:159], v2 offset:10240
ds_read_b128 a[160:163], v2 offset:11264
M v[104:107], a[124:127], a[220:223], v[104:107]
v_exp_f32 v81, v81
M v[104:107], a[128:131], a[224:227], v[104:107]
buffer_load_dwordx4 v1, s[12:15], s25 offen offset:2048 sc1 lds
M v[108:111], a[128:131], a[240:243], 0
v_exp_f32 v82, v82
M v[108:111], a[124:127], a[236:239], v[108:111]
v_cvt_pk_bf16_f32 v65, v66, v67
v_cvt_pk_bf16_f32 v66, v80, v81
M v[108:111], a[120:123], a[232:235], v[108:111]
v_exp_f32 v83, v83
M v[108:111], a[116:119], a[228:231], v[108:111]
buffer_load_dwordx4 v1, s[12:15], s25 offen offset:3072 sc1 lds
s_add_u32 m0, s29, 69632
s_waitcnt lgkmcnt(4)
M v[112:115], a[132:135], a[180:183], 0
v_exp_f32 v68, v68
M v[112:115], a[136:139], a[184:187], v[112:115]
ds_read_b128 a[164:167], v2 offset:12288
ds_read_b128 a[168:171], v2 offset:13312
M v[112:115], a[140:143], a[188:191], v[112:115]
v_exp_f32 v69, v69
M v[112:115], a[144:147], a[192:195], v[112:115]
buffer_load_dwordx4 v1, s[12:15], s32 offen offset:0 sc1 lds
M v[116:119], a[144:147], a[208:211], 0
v_exp_f32 v70, v70
M v[116:119], a[140:143], a[204:207], v[116:119]
v_cvt_pk_bf16_f32 v67, v82, v83
v_cvt_pk_bf16_f32 v68, v68, v69
M v[116:119], a[136:139], a[200:203], v[116:119]
v_exp_f32 v71, v71
M v[116:119], a[132:135], a[196:199], v[116:119]
buffer_load_dwordx4 v1, s[12:15], s32 offen offset:1024 sc1 lds
M v[120:123], a[132:135], a[212:215], 0
v_exp_f32 v84, v84
M v[120:123], a[136:139], a[216:219], v[120:123]
ds_read_b128 a[172:175], v2 offset:14336
ds_read_b128 a[176:179], v2 offset:15360
M v[120:123], a[140:143], a[220:223], v[120:123]
v_exp_f32 v85, v85
M v[120:123], a[144:147], a[224:227], v[120:123]
buffer_load_dwordx4 v1, s[12:15], s32 offen offset:2048 sc1 lds
M v[124:127], a[144:147], a[240:243], 0
v_exp_f32 v86, v86
M v[124:127], a[140:143], a[236:239], v[124:127]
v_cvt_pk_bf16_f32 v69, v70, v71
v_cvt_pk_bf16_f32 v70, v84, v85
M v[124:127], a[136:139], a[232:235], v[124:127]
v_exp_f32 v87, v87
M v[124:127], a[132:135], a[228:231], v[124:127]
buffer_load_dwordx4 v1, s[12:15], s32 offen offset:3072 sc1 lds
s_add_u32 m0, s29, 98304
s_waitcnt lgkmcnt(4)
M v[128:131], a[148:151], a[180:183], 0
v_exp_f32 v72, v72
M v[128:131], a[152:155], a[184:187], v[128:131]
ds_read_b128 a[116:119], v5 offset:32768
ds_read_b128 a[120:123], v5 offset:40960
M v[128:131], a[156:159], a[188:191], v[128:131]
v_exp_f32 v73, v73
M v[128:131], a[160:163], a[192:195], v[128:131]
buffer_load_dwordx4 v1, s[12:15], s26 offen offset:0 sc1 lds
s_add_u32 s43, s26, 4096
M v[132:135], a[160:163], a[208:211], 0
v_exp_f32 v74, v74
M v[132:135], a[156:159], a[204:207], v[132:135]
v_cvt_pk_bf16_f32 v71, v86, v87
v_cvt_pk_bf16_f32 v72, v72, v73
M v[132:135], a[152:155], a[200:203], v[132:135]
v_exp_f32 v75, v75
M v[132:135], a[148:151], a[196:199], v[132:135]
buffer_load_dwordx4 v1, s[12:15], s26 offen offset:1024 sc1 lds
M v[136:139], a[148:151], a[212:215], 0
v_exp_f32 v88, v88
M v[136:139], a[152:155], a[216:219], v[136:139]
ds_read_b128 a[124:127], v5 offset:33792
ds_read_b128 a[128:131], v5 offset:41984
M v[136:139], a[156:159], a[220:223], v[136:139]
v_exp_f32 v89, v89
M v[136:139], a[160:163], a[224:227], v[136:139]
buffer_load_dwordx4 v1, s[12:15], s26 offen offset:2048 sc1 lds
M v[140:143], a[160:163], a[240:243], 0
v_exp_f32 v90, v90
M v[140:143], a[156:159], a[236:239], v[140:143]
v_cvt_pk_bf16_f32 v73, v74, v75
v_cvt_pk_bf16_f32 v74, v88, v89
M v[140:143], a[152:155], a[232:235], v[140:143]
v_exp_f32 v91, v91
M v[140:143], a[148:151], a[228:231], v[140:143]
buffer_load_dwordx4 v1, s[12:15], s26 offen offset:3072 sc1 lds
s_add_u32 m0, s29, 102400
s_waitcnt lgkmcnt(4)
M v[144:147], a[164:167], a[180:183], 0
v_exp_f32 v76, v76
M v[144:147], a[168:171], a[184:187], v[144:147]
ds_read_b128 a[132:135], v5 offset:34816
ds_read_b128 a[136:139], v5 offset:43008
M v[144:147], a[172:175], a[188:191], v[144:147]
v_exp_f32 v77, v77
M v[144:147], a[176:179], a[192:195], v[144:147]
buffer_load_dwordx4 v1, s[12:15], s43 offen offset:0 sc1 lds
M v[148:151], a[176:179], a[208:211], 0
v_exp_f32 v78, v78
M v[148:151], a[172:175], a[204:207], v[148:151]
v_cvt_pk_bf16_f32 v75, v90, v91
v_cvt_pk_bf16_f32 v76, v76, v77
M v[148:151], a[168:171], a[200:203], v[148:151]
v_exp_f32 v79, v79
M v[148:151], a[164:167], a[196:199], v[148:151]
buffer_load_dwordx4 v1, s[12:15], s43 offen offset:1024 sc1 lds
M v[152:155], a[164:167], a[212:215], 0
v_exp_f32 v92, v92
M v[152:155], a[168:171], a[216:219], v[152:155]
ds_read_b128 a[140:143], v5 offset:35840
ds_read_b128 a[144:147], v5 offset:44032
M v[152:155], a[172:175], a[220:223], v[152:155]
v_exp_f32 v93, v93
M v[152:155], a[176:179], a[224:227], v[152:155]
buffer_load_dwordx4 v1, s[12:15], s43 offen offset:2048 sc1 lds
M v[156:159], a[176:179], a[240:243], 0
v_exp_f32 v94, v94
M v[156:159], a[172:175], a[236:239], v[156:159]
v_cvt_pk_bf16_f32 v77, v78, v79
v_cvt_pk_bf16_f32 v78, v92, v93
M v[156:159], a[168:171], a[232:235], v[156:159]
v_exp_f32 v95, v95
M v[156:159], a[164:167], a[228:231], v[156:159]
buffer_load_dwordx4 v1, s[12:15], s43 offen offset:3072 sc1 lds
v_cvt_pk_bf16_f32 v79, v94, v95
s_waitcnt lgkmcnt(6)
M v[160:163], a[116:119], v[32:35], 0
v_exp_f32 v96, v96
M v[160:163], a[120:123], v[64:67], v[160:163]
ds_read_b128 a[148:151], v5 offset:36864
ds_read_b128 a[152:155], v5 offset:45056
M v[164:167], a[120:123], v[68:71], 0
v_exp_f32 v97, v97
M v[164:167], a[116:119], v[36:39], v[164:167]
v_cvt_pk_bf16_f32 v96, v96, v97
M v[168:171], a[116:119], v[40:43], 0
v_exp_f32 v98, v98
M v[168:171], a[120:123], v[72:75], v[168:171]
s_add_u32 s25, s25, 32768
s_cmp_eq_u32 s25, s27
M v[172:175], a[120:123], v[76:79], 0
v_exp_f32 v99, v99
M v[172:175], a[116:119], v[44:47], v[172:175]
v_cvt_pk_bf16_f32 v97, v98, v99
s_waitcnt lgkmcnt(6)
M a[96:99], a[112:115], v[32:35], 0
s_cselect_b32 s25, s28, s25
s_cselect_b32 s27, -1, s27
M a[96:99], a[112:115], v[64:67], a[96:99]
s_add_u32 s26, s26, 32768
s_cmp_eq_u32 s26, s62
M v[176:179], a[124:127], v[32:35], 0
v_exp_f32 v112, v112
M v[176:179], a[128:131], v[64:67], v[176:179]
ds_read_b128 a[156:159], v5 offset:37888
ds_read_b128 a[160:163], v5 offset:46080
M v[180:183], a[128:131], v[68:71], 0
v_exp_f32 v113, v113
M v[180:183], a[124:127], v[36:39], v[180:183]
v_cvt_pk_bf16_f32 v98, v112, v113
M v[184:187], a[124:127], v[40:43], 0
v_exp_f32 v114, v114
M v[184:187], a[128:131], v[72:75], v[184:187]
s_cselect_b32 s26, s63, s26
s_cselect_b32 s62, -1, s62
M v[188:191], a[128:131], v[76:79], 0
v_exp_f32 v115, v115
M v[188:191], a[124:127], v[44:47], v[188:191]
v_cvt_pk_bf16_f32 v99, v114, v115
s_waitcnt lgkmcnt(6)
M a[100:103], a[112:115], v[36:39], 0
M a[100:103], a[112:115], v[68:71], a[100:103]
M v[192:195], a[132:135], v[32:35], 0
v_exp_f32 v100, v100
M v[192:195], a[136:139], v[64:67], v[192:195]
ds_read_b128 a[164:167], v5 offset:38912
ds_read_b128 a[168:171], v5 offset:47104
M v[196:199], a[136:139], v[68:71], 0
v_exp_f32 v101, v101
M v[196:199], a[132:135], v[36:39], v[196:199]
v_cvt_pk_bf16_f32 v100, v100, v101
M v[200:203], a[132:135], v[40:43], 0
v_exp_f32 v102, v102
M v[200:203], a[136:139], v[72:75], v[200:203]
M v[204:207], a[136:139], v[76:79], 0
v_exp_f32 v103, v103
M v[204:207], a[132:135], v[44:47], v[204:207]
v_cvt_pk_bf16_f32 v101, v102, v103
s_waitcnt lgkmcnt(6)
M a[104:107], a[112:115], v[40:43], 0
M a[104:107], a[112:115], v[72:75], a[104:107]
M v[208:211], a[140:143], v[32:35], 0
v_exp_f32 v116, v116
M v[208:211], a[144:147], v[64:67], v[208:211]
ds_read_b128 a[172:175], v5 offset:39936
ds_read_b128 a[176:179], v5 offset:48128
M v[212:215], a[144:147], v[68:71], 0
v_exp_f32 v117, v117
M v[212:215], a[140:143], v[36:39], v[212:215]
v_cvt_pk_bf16_f32 v102, v116, v117
M v[216:219], a[140:143], v[40:43], 0
v_exp_f32 v118, v118
M v[216:219], a[144:147], v[72:75], v[216:219]
M v[220:223], a[144:147], v[76:79], 0
v_exp_f32 v119, v119
M v[220:223], a[140:143], v[44:47], v[220:223]
v_cvt_pk_bf16_f32 v103, v118, v119
s_waitcnt lgkmcnt(6)
M a[108:111], a[112:115], v[44:47], 0
M a[108:111], a[112:115], v[76:79], a[108:111]
M v[224:227], a[148:151], v[32:35], 0
v_exp_f32 v104, v104
M v[224:227], a[152:155], v[64:67], v[224:227]
M v[228:231], a[152:155], v[68:71], 0
v_exp_f32 v105, v105
M v[228:231], a[148:151], v[36:39], v[228:231]
v_cvt_pk_bf16_f32 v104, v104, v105
M v[232:235], a[148:151], v[40:43], 0
v_exp_f32 v106, v106
M v[232:235], a[152:155], v[72:75], v[232:235]
M v[236:239], a[152:155], v[76:79], 0
v_exp_f32 v107, v107
M v[236:239], a[148:151], v[44:47], v[236:239]
v_cvt_pk_bf16_f32 v105, v106, v107
s_waitcnt lgkmcnt(4)
M v[240:243], a[156:159], v[32:35], 0
v_exp_f32 v120, v120
M v[240:243], a[160:163], v[64:67], v[240:243]
M v[244:247], a[160:163], v[68:71], 0
v_exp_f32 v121, v121
M v[244:247], a[156:159], v[36:39], v[244:247]
v_cvt_pk_bf16_f32 v106, v120, v121
M v[248:251], a[156:159], v[40:43], 0
v_exp_f32 v122, v122
M v[248:251], a[160:163], v[72:75], v[248:251]
s_waitcnt vmcnt(0) lgkmcnt(0)
s_barrier
ds_read_b128 a[116:119], v3 offset:0
ds_read_b128 a[120:123], v3 offset:1024
M v[252:255], a[160:163], v[76:79], 0
v_exp_f32 v123, v123
M v[252:255], a[156:159], v[44:47], v[252:255]
v_cvt_pk_bf16_f32 v107, v122, v123
M a[64:67], a[164:167], v[32:35], 0
v_exp_f32 v108, v108
M a[64:67], a[168:171], v[64:67], a[64:67]
ds_read_b128 a[124:127], v3 offset:2048
ds_read_b128 a[128:131], v3 offset:3072
M a[68:71], a[168:171], v[68:71], 0
v_exp_f32 v109, v109
M a[68:71], a[164:167], v[36:39], a[68:71]
v_cvt_pk_bf16_f32 v108, v108, v109
M a[72:75], a[164:167], v[40:43], 0
v_exp_f32 v110, v110
M a[72:75], a[168:171], v[72:75], a[72:75]
ds_read_b128 a[132:135], v3 offset:4096
ds_read_b128 a[136:139], v3 offset:5120
M a[76:79], a[168:171], v[76:79], 0
v_exp_f32 v111, v111
M a[76:79], a[164:167], v[44:47], a[76:79]
v_cvt_pk_bf16_f32 v109, v110, v111
M a[80:83], a[172:175], v[32:35], 0
v_exp_f32 v124, v124
M a[80:83], a[176:179], v[64:67], a[80:83]
ds_read_b128 a[140:143], v3 offset:6144
ds_read_b128 a[144:147], v3 offset:7168
M a[84:87], a[176:179], v[68:71], 0
v_exp_f32 v125, v125
M a[84:87], a[172:175], v[36:39], a[84:87]
v_cvt_pk_bf16_f32 v110, v124, v125
M a[88:91], a[172:175], v[40:43], 0
v_exp_f32 v126, v126
M a[88:91], a[176:179], v[72:75], a[88:91]
M a[92:95], a[176:179], v[76:79], 0
v_exp_f32 v127, v127
M a[92:95], a[172:175], v[44:47], a[92:95]
v_cvt_pk_bf16_f32 v111, v126, v127
s_branch Lk2_l2b
Lk2_l2:
s_add_u32 m0, s29, 65536
s_waitcnt lgkmcnt(4)
M v[96:99], a[116:119], a[180:183], 0
v_exp_f32 v64, v64
M v[96:99], a[120:123], a[184:187], v[96:99]
ds_read_b128 a[148:151], v2 offset:8192
ds_read_b128 a[152:155], v2 offset:9216
M v[96:99], a[124:127], a[188:191], v[96:99]
v_exp_f32 v65, v65
M v[96:99], a[128:131], a[192:195], v[96:99]
buffer_load_dwordx4 v1, s[12:15], s25 offen offset:0 sc1 lds
s_add_u32 s32, s25, 4096
M v[100:103], a[128:131], a[208:211], 0
v_exp_f32 v66, v66
M v[100:103], a[124:127], a[204:207], v[100:103]
v_cvt_pk_bf16_f32 v64, v64, v65
M v[100:103], a[120:123], a[200:203], v[100:103]
v_exp_f32 v67, v67
M v[100:103], a[116:119], a[196:199], v[100:103]
buffer_load_dwordx4 v1, s[12:15], s25 offen offset:1024 sc1 lds
M v[104:107], a[116:119], a[212:215], 0
v_exp_f32 v80, v80
M v[104:107], a[120:123], a[216:219], v[104:107]
ds_read_b128 a[156:159], v2 offset:10240
ds_read_b128 a[160:163], v2 offset:11264
M v[104:107], a[124:127], a[220:223], v[104:107]
v_exp_f32 v81, v81
M v[104:107], a[128:131], a[224:227], v[104:107]
buffer_load_dwordx4 v1, s[12:15], s25 offen offset:2048 sc1 lds
M v[108:111], a[128:131], a[240:243], 0
v_exp_f32 v82, v82
M v[108:111], a[124:127], a[236:239], v[108:111]
v_cvt_pk_bf16_f32 v65, v66, v67
v_cvt_pk_bf16_f32 v66, v80, v81
M v[108:111], a[120:123], a[232:235], v[108:111]
v_exp_f32 v83, v83
M v[108:111], a[116:119], a[228:231], v[108:111]
buffer_load_dwordx4 v1, s[12:15], s25 offen offset:3072 sc1 lds
s_add_u32 m0, s29, 69632
s_waitcnt lgkmcnt(4)
M v[112:115], a[132:135], a[180:183], 0
v_exp_f32 v68, v68
M v[112:115], a[136:139], a[184:187], v[112:115]
ds_read_b128 a[164:167], v2 offset:12288
ds_read_b128 a[168:171], v2 offset:13312
M v[112:115], a[140:143], a[188:191], v[112:115]
v_exp_f32 v69, v69
M v[112:115], a[144:147], a[192:195], v[112:115]
buffer_load_dwordx4 v1, s[12:15], s32 offen offset:0 sc1 lds
M v[116:119], a[144:147], a[208:211], 0
v_exp_f32 v70, v70
M v[116:119], a[140:143], a[204:207], v[116:119]
v_cvt_pk_bf16_f32 v67, v82, v83
v_cvt_pk_bf16_f32 v68, v68, v69
M v[116:119], a[136:139], a[200:203], v[116:119]
v_exp_f32 v71, v71
M v[116:119], a[132:135], a[196:199], v[116:119]
buffer_load_dwordx4 v1, s[12:15], s32 offen offset:1024 sc1 lds
M v[120:123], a[132:135], a[212:215], 0
v_exp_f32 v84, v84
M v[120:123], a[136:139], a[216:219], v[120:123]
ds_read_b128 a[172:175], v2 offset:14336
ds_read_b128 a[176:179], v2 offset:15360
M v[120:123], a[140:143], a[220:223], v[120:123]
v_exp_f32 v85, v85
M v[120:123], a[144:147], a[224:227], v[120:123]
buffer_load_dwordx4 v1, s[12:15], s32 offen offset:2048 sc1 lds
M v[124:127], a[144:147], a[240:243], 0
v_exp_f32 v86, v86
M v[124:127], a[140:143], a[236:239], v[124:127]
v_cvt_pk_bf16_f32 v69, v70, v71
v_cvt_pk_bf16_f32 v70, v84, v85
M v[124:127], a[136:139], a[232:235], v[124:127]
v_exp_f32 v87, v87
M v[124:127], a[132:135], a[228:231], v[124:127]
buffer_load_dwordx4 v1, s[12:15], s32 offen offset:3072 sc1 lds
s_add_u32 m0, s29, 98304
s_waitcnt lgkmcnt(4)
M v[128:131], a[148:151], a[180:183], 0
v_exp_f32 v72, v72
M v[128:131], a[152:155], a[184:187], v[128:131]
ds_read_b128 a[116:119], v5 offset:32768
ds_read_b128 a[120:123], v5 offset:40960
M v[128:131], a[156:159], a[188:191], v[128:131]
v_exp_f32 v73, v73
M v[128:131], a[160:163], a[192:195], v[128:131]
buffer_load_dwordx4 v1, s[12:15], s26 offen offset:0 sc1 lds
s_add_u32 s43, s26, 4096
M v[132:135], a[160:163], a[208:211], 0
v_exp_f32 v74, v74
M v[132:135], a[156:159], a[204:207], v[132:135]
v_cvt_pk_bf16_f32 v71, v86, v87
v_cvt_pk_bf16_f32 v72, v72, v73
M v[132:135], a[152:155], a[200:203], v[132:135]
v_exp_f32 v75, v75
M v[132:135], a[148:151], a[196:199], v[132:135]
buffer_load_dwordx4 v1, s[12:15], s26 offen offset:1024 sc1 lds
M v[136:139], a[148:151], a[212:215], 0
v_exp_f32 v88, v88
M v[136:139], a[152:155], a[216:219], v[136:139]
ds_read_b128 a[124:127], v5 offset:33792
ds_read_b128 a[128:131], v5 offset:41984
M v[136:139], a[156:159], a[220:223], v[136:139]
v_exp_f32 v89, v89
M v[136:139], a[160:163], a[224:227], v[136:139]
buffer_load_dwordx4 v1, s[12:15], s26 offen offset:2048 sc1 lds
M v[140:143], a[160:163], a[240:243], 0
v_exp_f32 v90, v90
M v[140:143], a[156:159], a[236:239], v[140:143]
v_cvt_pk_bf16_f32 v73, v74, v75
v_cvt_pk_bf16_f32 v74, v88, v89
M v[140:143], a[152:155], a[232:235], v[140:143]
v_exp_f32 v91, v91
M v[140:143], a[148:151], a[228:231], v[140:143]
buffer_load_dwordx4 v1, s[12:15], s26 offen offset:3072 sc1 lds
s_add_u32 m0, s29, 102400
s_waitcnt lgkmcnt(4)
M v[144:147], a[164:167], a[180:183], 0
v_exp_f32 v76, v76
M v[144:147], a[168:171], a[184:187], v[144:147]
ds_read_b128 a[132:135], v5 offset:34816
ds_read_b128 a[136:139], v5 offset:43008
M v[144:147], a[172:175], a[188:191], v[144:147]
v_exp_f32 v77, v77
M v[144:147], a[176:179], a[192:195], v[144:147]
buffer_load_dwordx4 v1, s[12:15], s43 offen offset:0 sc1 lds
M v[148:151], a[176:179], a[208:211], 0
v_exp_f32 v78, v78
M v[148:151], a[172:175], a[204:207], v[148:151]
v_cvt_pk_bf16_f32 v75, v90, v91
v_cvt_pk_bf16_f32 v76, v76, v77
M v[148:151], a[168:171], a[200:203], v[148:151]
v_exp_f32 v79, v79
M v[148:151], a[164:167], a[196:199], v[148:151]
buffer_load_dwordx4 v1, s[12:15], s43 offen offset:1024 sc1 lds
M v[152:155], a[164:167], a[212:215], 0
v_exp_f32 v92, v92
M v[152:155], a[168:171], a[216:219], v[152:155]
ds_read_b128 a[140:143], v5 offset:35840
ds_read_b128 a[144:147], v5 offset:44032
M v[152:155], a[172:175], a[220:223], v[152:155]
v_exp_f32 v93, v93
M v[152:155], a[176:179], a[224:227], v[152:155]
buffer_load_dwordx4 v1, s[12:15], s43 offen offset:2048 sc1 lds
M v[156:159], a[176:179], a[240:243], 0
v_exp_f32 v94, v94
M v[156:159], a[172:175], a[236:239], v[156:159]
v_cvt_pk_bf16_f32 v77, v78, v79
v_cvt_pk_bf16_f32 v78, v92, v93
M v[156:159], a[168:171], a[232:235], v[156:159]
v_exp_f32 v95, v95
M v[156:159], a[164:167], a[228:231], v[156:159]
buffer_load_dwordx4 v1, s[12:15], s43 offen offset:3072 sc1 lds
v_cvt_pk_bf16_f32 v79, v94, v95
s_waitcnt lgkmcnt(6)
M v[160:163], a[116:119], v[32:35], v[160:163]
v_exp_f32 v96, v96
M v[160:163], a[120:123], v[64:67], v[160:163]
ds_read_b128 a[148:151], v5 offset:36864
ds_read_b128 a[152:155], v5 offset:45056
M v[164:167], a[120:123], v[68:71], v[164:167]
v_exp_f32 v97, v97
M v[164:167], a[116:119], v[36:39], v[164:167]
v_cvt_pk_bf16_f32 v96, v96, v97
M v[168:171], a[116:119], v[40:43], v[168:171]
v_exp_f32 v98, v98
M v[168:171], a[120:123], v[72:75], v[168:171]
s_add_u32 s25, s25, 32768
s_cmp_eq_u32 s25, s27
M v[172:175], a[120:123], v[76:79], v[172:175]
v_exp_f32 v99, v99
M v[172:175], a[116:119], v[44:47], v[172:175]
v_cvt_pk_bf16_f32 v97, v98, v99
s_waitcnt lgkmcnt(6)
M a[96:99], a[112:115], v[32:35], a[96:99]
s_cselect_b32 s25, s28, s25
s_cselect_b32 s27, -1, s27
M a[96:99], a[112:115], v[64:67], a[96:99]
s_add_u32 s26, s26, 32768
s_cmp_eq_u32 s26, s62
M v[176:179], a[124:127], v[32:35], v[176:179]
v_exp_f32 v112, v112
M v[176:179], a[128:131], v[64:67], v[176:179]
ds_read_b128 a[156:159], v5 offset:37888
ds_read_b128 a[160:163], v5 offset:46080
M v[180:183], a[128:131], v[68:71], v[180:183]
v_exp_f32 v113, v113
M v[180:183], a[124:127], v[36:39], v[180:183]
v_cvt_pk_bf16_f32 v98, v112, v113
M v[184:187], a[124:127], v[40:43], v[184:187]
v_exp_f32 v114, v114
M v[184:187], a[128:131], v[72:75], v[184:187]
s_cselect_b32 s26, s63, s26
s_cselect_b32 s62, -1, s62
M v[188:191], a[128:131], v[76:79], v[188:191]
v_exp_f32 v115, v115
M v[188:191], a[124:127], v[44:47], v[188:191]
v_cvt_pk_bf16_f32 v99, v114, v115
s_waitcnt lgkmcnt(6)
M a[100:103], a[112:115], v[36:39], a[100:103]
M a[100:103], a[112:115], v[68:71], a[100:103]
M v[192:195], a[132:135], v[32:35], v[192:195]
v_exp_f32 v100, v100
M v[192:195], a[136:139], v[64:67], v[192:195]
ds_read_b128 a[164:167], v5 offset:38912
ds_read_b128 a[168:171], v5 offset:47104
M v[196:199], a[136:139], v[68:71], v[196:199]
v_exp_f32 v101, v101
M v[196:199], a[132:135], v[36:39], v[196:199]
v_cvt_pk_bf16_f32 v100, v100, v101
M v[200:203], a[132:135], v[40:43], v[200:203]
v_exp_f32 v102, v102
M v[200:203], a[136:139], v[72:75], v[200:203]
M v[204:207], a[136:139], v[76:79], v[204:207]
v_exp_f32 v103, v103
M v[204:207], a[132:135], v[44:47], v[204:207]
v_cvt_pk_bf16_f32 v101, v102, v103
s_waitcnt lgkmcnt(6)
M a[104:107], a[112:115], v[40:43], a[104:107]
M a[104:107], a[112:115], v[72:75], a[104:107]
M v[208:211], a[140:143], v[32:35], v[208:211]
v_exp_f32 v116, v116
M v[208:211], a[144:147], v[64:67], v[208:211]
ds_read_b128 a[172:175], v5 offset:39936
ds_read_b128 a[176:179], v5 offset:48128
M v[212:215], a[144:147], v[68:71], v[212:215]
v_exp_f32 v117, v117
M v[212:215], a[140:143], v[36:39], v[212:215]
v_cvt_pk_bf16_f32 v102, v116, v117
M v[216:219], a[140:143], v[40:43], v[216:219]
v_exp_f32 v118, v118
M v[216:219], a[144:147], v[72:75], v[216:219]
M v[220:223], a[144:147], v[76:79], v[220:223]
v_exp_f32 v119, v119
M v[220:223], a[140:143], v[44:47], v[220:223]
v_cvt_pk_bf16_f32 v103, v118, v119
s_waitcnt lgkmcnt(6)
M a[108:111], a[112:115], v[44:47], a[108:111]
M a[108:111], a[112:115], v[76:79], a[108:111]
M v[224:227], a[148:151], v[32:35], v[224:227]
v_exp_f32 v104, v104
M v[224:227], a[152:155], v[64:67], v[224:227]
M v[228:231], a[152:155], v[68:71], v[228:231]
v_exp_f32 v105, v105
M v[228:231], a[148:151], v[36:39], v[228:231]
v_cvt_pk_bf16_f32 v104, v104, v105
M v[232:235], a[148:151], v[40:43], v[232:235]
v_exp_f32 v106, v106
M v[232:235], a[152:155], v[72:75], v[232:235]
M v[236:239], a[152:155], v[76:79], v[236:239]
v_exp_f32 v107, v107
M v[236:239], a[148:151], v[44:47], v[236:239]
v_cvt_pk_bf16_f32 v105, v106, v107
s_waitcnt lgkmcnt(4)
M v[240:243], a[156:159], v[32:35], v[240:243]
v_exp_f32 v120, v120
M v[240:243], a[160:163], v[64:67], v[240:243]
M v[244:247], a[160:163], v[68:71], v[244:247]
v_exp_f32 v121, v121
M v[244:247], a[156:159], v[36:39], v[244:247]
v_cvt_pk_bf16_f32 v106, v120, v121
M v[248:251], a[156:159], v[40:43], v[248:251]
v_exp_f32 v122, v122
M v[248:251], a[160:163], v[72:75], v[248:251]
s_waitcnt vmcnt(0) lgkmcnt(0)
s_barrier
ds_read_b128 a[116:119], v3 offset:0
ds_read_b128 a[120:123], v3 offset:1024
M v[252:255], a[160:163], v[76:79], v[252:255]
v_exp_f32 v123, v123
M v[252:255], a[156:159], v[44:47], v[252:255]
v_cvt_pk_bf16_f32 v107, v122, v123
M a[64:67], a[164:167], v[32:35], a[64:67]
v_exp_f32 v108, v108
M a[64:67], a[168:171], v[64:67], a[64:67]
ds_read_b128 a[124:127], v3 offset:2048
ds_read_b128 a[128:131], v3 offset:3072
M a[68:71], a[168:171], v[68:71], a[68:71]
v_exp_f32 v109, v109
M a[68:71], a[164:167], v[36:39], a[68:71]
v_cvt_pk_bf16_f32 v108, v108, v109
M a[72:75], a[164:167], v[40:43], a[72:75]
v_exp_f32 v110, v110
M a[72:75], a[168:171], v[72:75], a[72:75]
ds_read_b128 a[132:135], v3 offset:4096
ds_read_b128 a[136:139], v3 offset:5120
M a[76:79], a[168:171], v[76:79], a[76:79]
v_exp_f32 v111, v111
M a[76:79], a[164:167], v[44:47], a[76:79]
v_cvt_pk_bf16_f32 v109, v110, v111
M a[80:83], a[172:175], v[32:35], a[80:83]
v_exp_f32 v124, v124
M a[80:83], a[176:179], v[64:67], a[80:83]
ds_read_b128 a[140:143], v3 offset:6144
ds_read_b128 a[144:147], v3 offset:7168
M a[84:87], a[176:179], v[68:71], a[84:87]
v_exp_f32 v125, v125
M a[84:87], a[172:175], v[36:39], a[84:87]
v_cvt_pk_bf16_f32 v110, v124, v125
M a[88:91], a[172:175], v[40:43], a[88:91]
v_exp_f32 v126, v126
M a[88:91], a[176:179], v[72:75], a[88:91]
M a[92:95], a[176:179], v[76:79], a[92:95]
v_exp_f32 v127, v127
M a[92:95], a[172:175], v[44:47], a[92:95]
v_cvt_pk_bf16_f32 v111, v126, v127
Lk2_l2b:
s_add_u32 m0, s29, 0
s_waitcnt lgkmcnt(4)
M v[32:35], a[116:119], a[180:183], 0
v_exp_f32 v128, v128
M v[32:35], a[120:123], a[184:187], v[32:35]
ds_read_b128 a[148:151], v3 offset:8192
ds_read_b128 a[152:155], v3 offset:9216
M v[32:35], a[124:127], a[188:191], v[32:35]
v_exp_f32 v129, v129
M v[32:35], a[128:131], a[192:195], v[32:35]
buffer_load_dwordx4 v1, s[12:15], s25 offen offset:0 sc1 lds
s_add_u32 s32, s25, 4096
M v[36:39], a[128:131], a[208:211], 0
v_exp_f32 v130, v130
M v[36:39], a[124:127], a[204:207], v[36:39]
v_cvt_pk_bf16_f32 v128, v128, v129
M v[36:39], a[120:123], a[200:203], v[36:39]
v_exp_f32 v131, v131
M v[36:39], a[116:119], a[196:199], v[36:39]
buffer_load_dwordx4 v1, s[12:15], s25 offen offset:1024 sc1 lds
M v[40:43], a[116:119], a[212:215], 0
v_exp_f32 v144, v144
M v[40:43], a[120:123], a[216:219], v[40:43]
ds_read_b128 a[156:159], v3 offset:10240
ds_read_b128 a[160:163], v3 offset:11264
M v[40:43], a[124:127], a[220:223], v[40:43]
v_exp_f32 v145, v145
M v[40:43], a[128:131], a[224:227], v[40:43]
buffer_load_dwordx4 v1, s[12:15], s25 offen offset:2048 sc1 lds
M v[44:47], a[128:131], a[240:243], 0
v_exp_f32 v146, v146
M v[44:47], a[124:127], a[236:239], v[44:47]
v_cvt_pk_bf16_f32 v129, v130, v131
v_cvt_pk_bf16_f32 v130, v144, v145
M v[44:47], a[120:123], a[232:235], v[44:47]
v_exp_f32 v147, v147
M v[44:47], a[116:119], a[228:231], v[44:47]
buffer_load_dwordx4 v1, s[12:15], s25 offen offset:3072 sc1 lds
s_add_u32 m0, s29, 4096
s_waitcnt lgkmcnt(4)
M v[48:51], a[132:135], a[180:183], 0
v_exp_f32 v132, v132
M v[48:51], a[136:139], a[184:187], v[48:51]
ds_read_b128 a[164:167], v3 offset:12288
ds_read_b128 a[168:171], v3 offset:13312
M v[48:51], a[140:143], a[188:191], v[48:51]
v_exp_f32 v133, v133
M v[48:51], a[144:147], a[192:195], v[48:51]
buffer_load_dwordx4 v1, s[12:15], s32 offen offset:0 sc1 lds
M v[52:55], a[144:147], a[208:211], 0
v_exp_f32 v134, v134
M v[52:55], a[140:143], a[204:207], v[52:55]
v_cvt_pk_bf16_f32 v131, v146, v147
v_cvt_pk_bf16_f32 v132, v132, v133
M v[52:55], a[136:139], a[200:203], v[52:55]
v_exp_f32 v135, v135
M v[52:55], a[132:135], a[196:199], v[52:55]
buffer_load_dwordx4 v1, s[12:15], s32 offen offset:1024 sc1 lds
M v[56:59], a[132:135], a[212:215], 0
v_exp_f32 v148, v148
M v[56:59], a[136:139], a[216:219], v[56:59]
ds_read_b128 a[172:175], v3 offset:14336
ds_read_b128 a[176:179], v3 offset:15360
M v[56:59], a[140:143], a[220:223], v[56:59]
v_exp_f32 v149, v149
M v[56:59], a[144:147], a[224:227], v[56:59]
buffer_load_dwordx4 v1, s[12:15], s32 offen offset:2048 sc1 lds
M v[60:63], a[144:147], a[240:243], 0
v_exp_f32 v150, v150
M v[60:63], a[140:143], a[236:239], v[60:63]
v_cvt_pk_bf16_f32 v133, v134, v135
v_cvt_pk_bf16_f32 v134, v148, v149
M v[60:63], a[136:139], a[232:235], v[60:63]
v_exp_f32 v151, v151
M v[60:63], a[132:135], a[228:231], v[60:63]
buffer_load_dwordx4 v1, s[12:15], s32 offen offset:3072 sc1 lds
s_add_u32 m0, s29, 32768
s_waitcnt lgkmcnt(4)
M v[64:67], a[148:151], a[180:183], 0
v_exp_f32 v136, v136
M v[64:67], a[152:155], a[184:187], v[64:67]
ds_read_b128 a[116:119], v6 offset:32768
ds_read_b128 a[120:123], v6 offset:40960
M v[64:67], a[156:159], a[188:191], v[64:67]
v_exp_f32 v137, v137
M v[64:67], a[160:163], a[192:195], v[64:67]
buffer_load_dwordx4 v1, s[12:15], s26 offen offset:0 sc1 lds
s_add_u32 s43, s26, 4096
M v[68:71], a[160:163], a[208:211], 0
v_exp_f32 v138, v138
M v[68:71], a[156:159], a[204:207], v[68:71]
v_cvt_pk_bf16_f32 v135, v150, v151
v_cvt_pk_bf16_f32 v136, v136, v137
M v[68:71], a[152:155], a[200:203], v[68:71]
v_exp_f32 v139, v139
M v[68:71], a[148:151], a[196:199], v[68:71]
buffer_load_dwordx4 v1, s[12:15], s26 offen offset:1024 sc1 lds
M v[72:75], a[148:151], a[212:215], 0
v_exp_f32 v152, v152
M v[72:75], a[152:155], a[216:219], v[72:75]
ds_read_b128 a[124:127], v6 offset:33792
ds_read_b128 a[128:131], v6 offset:41984
M v[72:75], a[156:159], a[220:223], v[72:75]
v_exp_f32 v153, v153
M v[72:75], a[160:163], a[224:227], v[72:75]
buffer_load_dwordx4 v1, s[12:15], s26 offen offset:2048 sc1 lds
M v[76:79], a[160:163], a[240:243], 0
v_exp_f32 v154, v154
M v[76:79], a[156:159], a[236:239], v[76:79]
v_cvt_pk_bf16_f32 v137, v138, v139
v_cvt_pk_bf16_f32 v138, v152, v153
M v[76:79], a[152:155], a[232:235], v[76:79]
v_exp_f32 v155, v155
M v[76:79], a[148:151], a[228:231], v[76:79]
buffer_load_dwordx4 v1, s[12:15], s26 offen offset:3072 sc1 lds
s_add_u32 m0, s29, 36864
s_waitcnt lgkmcnt(4)
M v[80:83], a[164:167], a[180:183], 0
v_exp_f32 v140, v140
M v[80:83], a[168:171], a[184:187], v[80:83]
ds_read_b128 a[132:135], v6 offset:34816
ds_read_b128 a[136:139], v6 offset:43008
M v[80:83], a[172:175], a[188:191], v[80:83]
v_exp_f32 v141, v141
M v[80:83], a[176:179], a[192:195], v[80:83]
buffer_load_dwordx4 v1, s[12:15], s43 offen offset:0 sc1 lds
M v[84:87], a[176:179], a[208:211], 0
v_exp_f32 v142, v142
M v[84:87], a[172:175], a[204:207], v[84:87]
v_cvt_pk_bf16_f32 v139, v154, v155
v_cvt_pk_bf16_f32 v140, v140, v141
M v[84:87], a[168:171], a[200:203], v[84:87]
v_exp_f32 v143, v143
M v[84:87], a[164:167], a[196:199], v[84:87]
buffer_load_dwordx4 v1, s[12:15], s43 offen offset:1024 sc1 lds
M v[88:91], a[164:167], a[212:215], 0
v_exp_f32 v156, v156
M v[88:91], a[168:171], a[216:219], v[88:91]
ds_read_b128 a[140:143], v6 offset:35840
ds_read_b128 a[144:147], v6 offset:44032
M v[88:91], a[172:175], a[220:223], v[88:91]
v_exp_f32 v157, v157
M v[88:91], a[176:179], a[224:227], v[88:91]
buffer_load_dwordx4 v1, s[12:15], s43 offen offset:2048 sc1 lds
M v[92:95], a[176:179], a[240:243], 0
v_exp_f32 v158, v158
M v[92:95], a[172:175], a[236:239], v[92:95]
v_cvt_pk_bf16_f32 v141, v142, v143
v_cvt_pk_bf16_f32 v142, v156, v157
M v[92:95], a[168:171], a[232:235], v[92:95]
v_exp_f32 v159, v159
M v[92:95], a[164:167], a[228:231], v[92:95]
buffer_load_dwordx4 v1, s[12:15], s43 offen offset:3072 sc1 lds
v_cvt_pk_bf16_f32 v143, v158, v159
s_waitcnt lgkmcnt(6)
M v[160:163], a[116:119], v[96:99], v[160:163]
v_exp_f32 v32, v32
M v[160:163], a[120:123], v[128:131], v[160:163]
ds_read_b128 a[148:151], v6 offset:36864
ds_read_b128 a[152:155], v6 offset:45056
M v[164:167], a[120:123], v[132:135], v[164:167]
v_exp_f32 v33, v33
M v[164:167], a[116:119], v[100:103], v[164:167]
v_cvt_pk_bf16_f32 v32, v32, v33
M v[168:171], a[116:119], v[104:107], v[168:171]
v_exp_f32 v34, v34
M v[168:171], a[120:123], v[136:139], v[168:171]
s_add_u32 s25, s25, 32768
s_cmp_eq_u32 s25, s27
M v[172:175], a[120:123], v[140:143], v[172:175]
v_exp_f32 v35, v35
M v[172:175], a[116:119], v[108:111], v[172:175]
v_cvt_pk_bf16_f32 v33, v34, v35
s_waitcnt lgkmcnt(6)
M a[96:99], a[112:115], v[96:99], a[96:99]
s_cselect_b32 s25, s28, s25
s_cselect_b32 s27, -1, s27
M a[96:99], a[112:115], v[128:131], a[96:99]
s_add_u32 s26, s26, 32768
s_cmp_eq_u32 s26, s62
M v[176:179], a[124:127], v[96:99], v[176:179]
v_exp_f32 v48, v48
M v[176:179], a[128:131], v[128:131], v[176:179]
ds_read_b128 a[156:159], v6 offset:37888
ds_read_b128 a[160:163], v6 offset:46080
M v[180:183], a[128:131], v[132:135], v[180:183]
v_exp_f32 v49, v49
M v[180:183], a[124:127], v[100:103], v[180:183]
v_cvt_pk_bf16_f32 v34, v48, v49
M v[184:187], a[124:127], v[104:107], v[184:187]
v_exp_f32 v50, v50
M v[184:187], a[128:131], v[136:139], v[184:187]
s_cselect_b32 s26, s63, s26
s_cselect_b32 s62, -1, s62
M v[188:191], a[128:131], v[140:143], v[188:191]
v_exp_f32 v51, v51
M v[188:191], a[124:127], v[108:111], v[188:191]
v_cvt_pk_bf16_f32 v35, v50, v51
s_waitcnt lgkmcnt(6)
M a[100:103], a[112:115], v[100:103], a[100:103]
M a[100:103], a[112:115], v[132:135], a[100:103]
M v[192:195], a[132:135], v[96:99], v[192:195]
v_exp_f32 v36, v36
M v[192:195], a[136:139], v[128:131], v[192:195]
ds_read_b128 a[164:167], v6 offset:38912
ds_read_b128 a[168:171], v6 offset:47104
M v[196:199], a[136:139], v[132:135], v[196:199]
v_exp_f32 v37, v37
M v[196:199], a[132:135], v[100:103], v[196:199]
v_cvt_pk_bf16_f32 v36, v36, v37
M v[200:203], a[132:135], v[104:107], v[200:203]
v_exp_f32 v38, v38
M v[200:203], a[136:139], v[136:139], v[200:203]
M v[204:207], a[136:139], v[140:143], v[204:207]
v_exp_f32 v39, v39
M v[204:207], a[132:135], v[108:111], v[204:207]
v_cvt_pk_bf16_f32 v37, v38, v39
s_waitcnt lgkmcnt(6)
M a[104:107], a[112:115], v[104:107], a[104:107]
M a[104:107], a[112:115], v[136:139], a[104:107]
M v[208:211], a[140:143], v[96:99], v[208:211]
v_exp_f32 v52, v52
M v[208:211], a[144:147], v[128:131], v[208:211]
ds_read_b128 a[172:175], v6 offset:39936
ds_read_b128 a[176:179], v6 offset:48128
M v[212:215], a[144:147], v[132:135], v[212:215]
v_exp_f32 v53, v53
M v[212:215], a[140:143], v[100:103], v[212:215]
v_cvt_pk_bf16_f32 v38, v52, v53
M v[216:219], a[140:143], v[104:107], v[216:219]
v_exp_f32 v54, v54
M v[216:219], a[144:147], v[136:139], v[216:219]
M v[220:223], a[144:147], v[140:143], v[220:223]
v_exp_f32 v55, v55
M v[220:223], a[140:143], v[108:111], v[220:223]
v_cvt_pk_bf16_f32 v39, v54, v55
s_waitcnt lgkmcnt(6)
M a[108:111], a[112:115], v[108:111], a[108:111]
M a[108:111], a[112:115], v[140:143], a[108:111]
M v[224:227], a[148:151], v[96:99], v[224:227]
v_exp_f32 v40, v40
M v[224:227], a[152:155], v[128:131], v[224:227]
M v[228:231], a[152:155], v[132:135], v[228:231]
v_exp_f32 v41, v41
M v[228:231], a[148:151], v[100:103], v[228:231]
v_cvt_pk_bf16_f32 v40, v40, v41
M v[232:235], a[148:151], v[104:107], v[232:235]
v_exp_f32 v42, v42
M v[232:235], a[152:155], v[136:139], v[232:235]
M v[236:239], a[152:155], v[140:143], v[236:239]
v_exp_f32 v43, v43
M v[236:239], a[148:151], v[108:111], v[236:239]
v_cvt_pk_bf16_f32 v41, v42, v43
s_waitcnt lgkmcnt(4)
M v[240:243], a[156:159], v[96:99], v[240:243]
v_exp_f32 v56, v56
M v[240:243], a[160:163], v[128:131], v[240:243]
M v[244:247], a[160:163], v[132:135], v[244:247]
v_exp_f32 v57, v57
M v[244:247], a[156:159], v[100:103], v[244:247]
v_cvt_pk_bf16_f32 v42, v56, v57
M v[248:251], a[156:159], v[104:107], v[248:251]
v_exp_f32 v58, v58
M v[248:251], a[160:163], v[136:139], v[248:251]
s_waitcnt vmcnt(0) lgkmcnt(0)
s_barrier
ds_read_b128 a[116:119], v2 offset:0
ds_read_b128 a[120:123], v2 offset:1024
M v[252:255], a[160:163], v[140:143], v[252:255]
v_exp_f32 v59, v59
M v[252:255], a[156:159], v[108:111], v[252:255]
v_cvt_pk_bf16_f32 v43, v58, v59
M a[64:67], a[164:167], v[96:99], a[64:67]
v_exp_f32 v44, v44
M a[64:67], a[168:171], v[128:131], a[64:67]
ds_read_b128 a[124:127], v2 offset:2048
ds_read_b128 a[128:131], v2 offset:3072
M a[68:71], a[168:171], v[132:135], a[68:71]
v_exp_f32 v45, v45
M a[68:71], a[164:167], v[100:103], a[68:71]
v_cvt_pk_bf16_f32 v44, v44, v45
M a[72:75], a[164:167], v[104:107], a[72:75]
v_exp_f32 v46, v46
M a[72:75], a[168:171], v[136:139], a[72:75]
ds_read_b128 a[132:135], v2 offset:4096
ds_read_b128 a[136:139], v2 offset:5120
M a[76:79], a[168:171], v[140:143], a[76:79]
v_exp_f32 v47, v47
M a[76:79], a[164:167], v[108:111], a[76:79]
v_cvt_pk_bf16_f32 v45, v46, v47
M a[80:83], a[172:175], v[96:99], a[80:83]
v_exp_f32 v60, v60
M a[80:83], a[176:179], v[128:131], a[80:83]
ds_read_b128 a[140:143], v2 offset:6144
ds_read_b128 a[144:147], v2 offset:7168
M a[84:87], a[176:179], v[132:135], a[84:87]
v_exp_f32 v61, v61
M a[84:87], a[172:175], v[100:103], a[84:87]
v_cvt_pk_bf16_f32 v46, v60, v61
M a[88:91], a[172:175], v[104:107], a[88:91]
v_exp_f32 v62, v62
M a[88:91], a[176:179], v[136:139], a[88:91]
M a[92:95], a[176:179], v[140:143], a[92:95]
v_exp_f32 v63, v63
M a[92:95], a[172:175], v[108:111], a[92:95]
v_cvt_pk_bf16_f32 v47, v62, v63
s_sub_u32 s30, s30, 1
s_cmp_lg_u32 s30, 0
s_cbranch_scc1 Lk2_l2
s_and_b32 s3, s2, 3
s_lshl_b32 s3, s3, 2
s_bfe_u32 s27, s2, 0x20003
s_add_u32 s27, s3, s27
s_lshl_b32 s43, s27, 8
s_add_u32 s43, s43, 16789504
v_lshlrev_b32 v15, 2, v0
buffer_load_dword v7, v15, s[52:55], s43 offen sc1
s_waitcnt lgkmcnt(7)
ds_read_b128 a[116:119], v5 offset:36864
s_waitcnt lgkmcnt(7)
ds_read_b128 a[120:123], v5 offset:45056
s_waitcnt lgkmcnt(7)
ds_read_b128 a[124:127], v5 offset:37888
s_waitcnt lgkmcnt(7)
ds_read_b128 a[128:131], v5 offset:46080
s_waitcnt lgkmcnt(7)
ds_read_b128 a[132:135], v5 offset:38912
s_waitcnt lgkmcnt(7)
ds_read_b128 a[136:139], v5 offset:47104
s_waitcnt lgkmcnt(7)
ds_read_b128 a[140:143], v5 offset:39936
s_waitcnt lgkmcnt(7)
ds_read_b128 a[144:147], v5 offset:48128
s_lshl_b32 s33, s23, 14
s_add_u32 s34, s33, 98304
s_add_u32 s33, s33, 131072
v_add_u32 v2, s34, v1
v_add_u32 v3, s33, v1
v_exp_f32 v64, v64
v_exp_f32 v65, v65
v_exp_f32 v66, v66
v_exp_f32 v67, v67
v_exp_f32 v80, v80
v_exp_f32 v81, v81
v_exp_f32 v82, v82
v_exp_f32 v83, v83
v_cvt_pk_bf16_f32 v64, v64, v65
v_cvt_pk_bf16_f32 v65, v66, v67
v_exp_f32 v68, v68
v_exp_f32 v69, v69
v_exp_f32 v70, v70
v_exp_f32 v71, v71
v_cvt_pk_bf16_f32 v66, v80, v81
v_cvt_pk_bf16_f32 v67, v82, v83
v_exp_f32 v84, v84
v_exp_f32 v85, v85
v_exp_f32 v86, v86
v_exp_f32 v87, v87
v_cvt_pk_bf16_f32 v68, v68, v69
v_cvt_pk_bf16_f32 v69, v70, v71
v_exp_f32 v72, v72
v_exp_f32 v73, v73
v_exp_f32 v74, v74
v_exp_f32 v75, v75
v_cvt_pk_bf16_f32 v70, v84, v85
v_cvt_pk_bf16_f32 v71, v86, v87
v_exp_f32 v88, v88
v_exp_f32 v89, v89
v_exp_f32 v90, v90
v_exp_f32 v91, v91
v_cvt_pk_bf16_f32 v72, v72, v73
v_cvt_pk_bf16_f32 v73, v74, v75
v_exp_f32 v76, v76
v_exp_f32 v77, v77
v_exp_f32 v78, v78
v_exp_f32 v79, v79
v_cvt_pk_bf16_f32 v74, v88, v89
v_cvt_pk_bf16_f32 v75, v90, v91
v_exp_f32 v92, v92
v_exp_f32 v93, v93
v_exp_f32 v94, v94
v_exp_f32 v95, v95
v_cvt_pk_bf16_f32 v76, v76, v77
v_cvt_pk_bf16_f32 v77, v78, v79
v_cvt_pk_bf16_f32 v78, v92, v93
v_cvt_pk_bf16_f32 v79, v94, v95
s_waitcnt lgkmcnt(6)
M v[224:227], a[116:119], v[32:35], v[224:227]
M v[224:227], a[120:123], v[64:67], v[224:227]
ds_read_b128 a[148:151], v5 offset:32768
ds_read_b128 a[152:155], v5 offset:40960
s_mov_b32 s61, 0
M v[228:231], a[120:123], v[68:71], v[228:231]
M v[228:231], a[116:119], v[36:39], v[228:231]
s_bfe_u32 s3, s2, 0x10002
M v[232:235], a[116:119], v[40:43], v[232:235]
M v[232:235], a[120:123], v[72:75], v[232:235]
s_lshl_b32 s3, s3, 3
M v[236:239], a[120:123], v[76:79], v[236:239]
M v[236:239], a[116:119], v[44:47], v[236:239]
s_waitcnt lgkmcnt(6)
s_lshr_b32 s28, s2, 5
M a[96:99], a[112:115], v[32:35], a[96:99]
M a[96:99], a[112:115], v[64:67], a[96:99]
M v[240:243], a[124:127], v[32:35], v[240:243]
M v[240:243], a[128:131], v[64:67], v[240:243]
ds_read_b128 a[156:159], v5 offset:33792
ds_read_b128 a[160:163], v5 offset:41984
s_add_u32 s28, s3, s28
M v[244:247], a[128:131], v[68:71], v[244:247]
s_lshl_b32 s25, s27, 18
M v[244:247], a[124:127], v[36:39], v[244:247]
M v[248:251], a[124:127], v[40:43], v[248:251]
s_lshl_b32 s3, s101, 12
M v[248:251], a[128:131], v[72:75], v[248:251]
M v[252:255], a[128:131], v[76:79], v[252:255]
s_add_u32 s25, s25, s3
M v[252:255], a[124:127], v[44:47], v[252:255]
s_waitcnt lgkmcnt(6)
M a[100:103], a[112:115], v[36:39], a[100:103]
M a[100:103], a[112:115], v[68:71], a[100:103]
M a[64:67], a[132:135], v[32:35], a[64:67]
s_lshl_b32 s26, s28, 7
M a[64:67], a[136:139], v[64:67], a[64:67]
ds_read_b128 a[164:167], v5 offset:34816
ds_read_b128 a[168:171], v5 offset:43008
M a[68:71], a[136:139], v[68:71], a[68:71]
s_lshl_b32 s42, s101, 11
M a[68:71], a[132:135], v[36:39], a[68:71]
M a[72:75], a[132:135], v[40:43], a[72:75]
s_add_u32 s44, s4, 83886080
s_addc_u32 s45, s5, 0
M a[72:75], a[136:139], v[72:75], a[72:75]
s_mov_b32 s46, 4194304
M a[76:79], a[136:139], v[76:79], a[76:79]
M a[76:79], a[132:135], v[44:47], a[76:79]
s_waitcnt lgkmcnt(6)
s_mov_b32 s47, 0x00020000
M a[104:107], a[112:115], v[40:43], a[104:107]
M a[104:107], a[112:115], v[72:75], a[104:107]
M a[80:83], a[140:143], v[32:35], a[80:83]
M a[80:83], a[144:147], v[64:67], a[80:83]
ds_read_b128 a[172:175], v5 offset:35840
ds_read_b128 a[176:179], v5 offset:44032
s_mov_b32 s50, 2097152
M a[84:87], a[144:147], v[68:71], a[84:87]
M a[84:87], a[140:143], v[36:39], a[84:87]
s_mov_b32 s51, 0x00020000
M a[88:91], a[140:143], v[40:43], a[88:91]
M a[88:91], a[144:147], v[72:75], a[88:91]
s_lshl_b32 s3, s101, 4
M a[92:95], a[144:147], v[76:79], a[92:95]
M a[92:95], a[140:143], v[44:47], a[92:95]
s_waitcnt lgkmcnt(6)
v_lshrrev_b32 v96, 3, v0
M a[108:111], a[112:115], v[44:47], a[108:111]
M a[108:111], a[112:115], v[76:79], a[108:111]
M v[160:163], a[148:151], v[32:35], v[160:163]
v_and_b32 v97, 6, v96
M v[160:163], a[152:155], v[64:67], v[160:163]
M v[164:167], a[152:155], v[68:71], v[164:167]
ds_write_b128 v2, v[224:227] offset:0
v_and_b32 v98, 7, v0
M v[164:167], a[148:151], v[36:39], v[164:167]
M v[168:171], a[148:151], v[40:43], v[168:171]
ds_write_b128 v2, v[228:231] offset:1024
v_xor_b32 v97, v97, v98
M v[168:171], a[152:155], v[72:75], v[168:171]
M v[172:175], a[152:155], v[76:79], v[172:175]
ds_write_b128 v2, v[232:235] offset:2048
v_add_u32 v96, s3, v96
M v[172:175], a[148:151], v[44:47], v[172:175]
s_waitcnt lgkmcnt(7)
M v[176:179], a[156:159], v[32:35], v[176:179]
ds_write_b128 v2, v[236:239] offset:3072
v_lshlrev_b32 v96, 11, v96
M v[176:179], a[160:163], v[64:67], v[176:179]
M v[180:183], a[160:163], v[68:71], v[180:183]
ds_write_b128 v2, v[240:243] offset:4096
v_lshl_add_u32 v99, v97, 4, v96
M v[180:183], a[156:159], v[36:39], v[180:183]
v_add_u32 v100, 15360, v99
M v[184:187], a[156:159], v[40:43], v[184:187]
ds_write_b128 v2, v[244:247] offset:5120
M v[184:187], a[160:163], v[72:75], v[184:187]
s_waitcnt vmcnt(0) lgkmcnt(0)
s_barrier
M v[188:191], a[160:163], v[76:79], v[188:191]
ds_write_b128 v2, v[248:251] offset:6144
v_cmp_ne_u32 vcc, 1, v7
s_nop 0
s_cbranch_vccnz Lk3_spinb1
Lk3_gotb1:
M v[188:191], a[156:159], v[44:47], v[188:191]
s_add_u32 m0, s42, 16384
s_nop 0
buffer_load_dwordx4 v99, s[48:51], s26 offen offset:0 lds
M v[192:195], a[164:167], v[32:35], v[192:195]
ds_write_b128 v2, v[252:255] offset:7168
buffer_load_dwordx4 v100, s[48:51], s26 offen offset:1024 lds
M v[192:195], a[168:171], v[64:67], v[192:195]
M v[196:199], a[168:171], v[68:71], v[196:199]
ds_write_b128 v2, a[64:67] offset:8192
buffer_load_dwordx4 a[192:195], v1, s[44:47], s25 offen offset:0 sc1
M v[196:199], a[164:167], v[36:39], v[196:199]
buffer_load_dwordx4 a[196:199], v1, s[44:47], s25 offen offset:1024 sc1
M v[200:203], a[164:167], v[40:43], v[200:203]
ds_write_b128 v2, a[68:71] offset:9216
buffer_load_dwordx4 a[200:203], v1, s[44:47], s25 offen offset:2048 sc1
M v[200:203], a[168:171], v[72:75], v[200:203]
buffer_load_dwordx4 a[204:207], v1, s[44:47], s25 offen offset:3072 sc1
M v[204:207], a[168:171], v[76:79], v[204:207]
ds_write_b128 v2, a[72:75] offset:10240
M v[204:207], a[164:167], v[44:47], v[204:207]
s_add_u32 s25, s25, 16384
s_add_u32 s26, s26, 131072
M v[208:211], a[172:175], v[32:35], v[208:211]
ds_write_b128 v2, a[76:79] offset:11264
s_add_u32 m0, s42, 32768
s_nop 0
buffer_load_dwordx4 v99, s[48:51], s26 offen offset:0 lds
M v[208:211], a[176:179], v[64:67], v[208:211]
buffer_load_dwordx4 v100, s[48:51], s26 offen offset:1024 lds
M v[212:215], a[176:179], v[68:71], v[212:215]
ds_write_b128 v2, a[80:83] offset:12288
buffer_load_dwordx4 a[224:227], v1, s[44:47], s25 offen offset:0 sc1
M v[212:215], a[172:175], v[36:39], v[212:215]
M v[216:219], a[172:175], v[40:43], v[216:219]
ds_write_b128 v2, a[84:87] offset:13312
buffer_load_dwordx4 a[228:231], v1, s[44:47], s25 offen offset:1024 sc1
M v[216:219], a[176:179], v[72:75], v[216:219]
buffer_load_dwordx4 a[232:235], v1, s[44:47], s25 offen offset:2048 sc1
M v[220:223], a[176:179], v[76:79], v[220:223]
ds_write_b128 v2, a[88:91] offset:14336
buffer_load_dwordx4 a[236:239], v1, s[44:47], s25 offen offset:3072 sc1
M v[220:223], a[172:175], v[44:47], v[220:223]
s_add_u32 s25, s25, 16384
s_add_u32 s26, s26, 131072
ds_write_b128 v2, a[92:95] offset:15360
s_waitcnt lgkmcnt(0)
Lk2_merge:
s_lshl_b32 s33, s22, 10
s_add_u32 s33, s33, 28672
s_xor_b32 s34, s33, 2048
v_add_u32 v14, s33, v1
v_add_u32 v15, s34, v1
v_accvgpr_read_b32 v20, a96
v_accvgpr_read_b32 v21, a100
v_accvgpr_read_b32 v22, a104
v_accvgpr_read_b32 v23, a108
ds_write_b128 v14, v[20:23]
s_waitcnt lgkmcnt(0)
s_barrier
ds_read_b128 v[28:31], v15
ds_read_b128 v[32:35], v3 offset:0
ds_read_b128 v[36:39], v3 offset:1024
ds_read_b128 v[40:43], v3 offset:2048
ds_read_b128 v[44:47], v3 offset:3072
ds_read_b128 v[48:51], v3 offset:4096
ds_read_b128 v[52:55], v3 offset:5120
ds_read_b128 v[56:59], v3 offset:6144
ds_read_b128 v[60:63], v3 offset:7168
ds_read_b128 v[64:67], v3 offset:8192
ds_read_b128 v[68:71], v3 offset:9216
ds_read_b128 v[72:75], v3 offset:10240
ds_read_b128 v[76:79], v3 offset:11264
ds_read_b128 v[80:83], v3 offset:12288
ds_read_b128 v[84:87], v3 offset:13312
ds_read_b128 v[88:91], v3 offset:14336
ds_read_b128 v[92:95], v3 offset:15360
s_waitcnt lgkmcnt(15)
v_add_f32 v20, v20, v28
v_add_f32 v21, v21, v29
v_add_f32 v22, v22, v30
v_add_f32 v23, v23, v31
s_sub_u32 s35, 15, s21
v_rcp_f32 v8, v20
v_rcp_f32 v9, v21
v_rcp_f32 v10, v22
v_rcp_f32 v11, v23
v_subrev_u32 v20, 0x21800000, v20
v_subrev_u32 v21, 0x21800000, v21
v_subrev_u32 v22, 0x21800000, v22
v_subrev_u32 v23, 0x21800000, v23
v_max_u32 v12, v20, v21
v_max3_u32 v12, v12, v22, v23
s_mov_b32 s64, 0x207
s_lshl_b32 s33, s35, 20
s_lshl_b32 s34, s20, 15
s_add_u32 s33, s33, s34
s_lshl_b32 s34, s23, 13
s_add_u32 s36, s33, s34
s_add_u32 s37, s36, 4096
s_add_u32 s38, s36, 16384
s_add_u32 s39, s36, 20480
v_pk_add_f32 v[160:161], v[160:161], v[32:33]
v_pk_add_f32 v[162:163], v[162:163], v[34:35]
s_waitcnt lgkmcnt(11)
v_pk_add_f32 v[176:177], v[176:177], v[48:49]
v_pk_add_f32 v[178:179], v[178:179], v[50:51]
v_pk_mul_f32 v[160:161], v[160:161], v[8:9] op_sel:[0,0] op_sel_hi:[1,0]
v_pk_mul_f32 v[162:163], v[162:163], v[8:9] op_sel:[0,0] op_sel_hi:[1,0]
v_pk_mul_f32 v[176:177], v[176:177], v[8:9] op_sel:[0,0] op_sel_hi:[1,0]
v_pk_mul_f32 v[178:179], v[178:179], v[8:9] op_sel:[0,0] op_sel_hi:[1,0]
v_cvt_pk_bf16_f32 v160, v160, v161
v_cvt_pk_bf16_f32 v161, v162, v163
v_cvt_pk_bf16_f32 v162, v176, v177
v_cvt_pk_bf16_f32 v163, v178, v179
v_pk_add_f32 v[164:165], v[164:165], v[36:37]
v_pk_add_f32 v[166:167], v[166:167], v[38:39]
s_waitcnt lgkmcnt(10)
v_pk_add_f32 v[180:181], v[180:181], v[52:53]
v_pk_add_f32 v[182:183], v[182:183], v[54:55]
M v[24:27], a[112:115], v[160:163], 0
buffer_store_dwordx4 v[160:163], v1, s[16:19], s36 offen offset:0 sc1
v_pk_mul_f32 v[164:165], v[164:165], v[8:9] op_sel:[0,1] op_sel_hi:[1,1]
v_pk_mul_f32 v[166:167], v[166:167], v[8:9] op_sel:[0,1] op_sel_hi:[1,1]
v_pk_mul_f32 v[180:181], v[180:181], v[8:9] op_sel:[0,1] op_sel_hi:[1,1]
v_pk_mul_f32 v[182:183], v[182:183], v[8:9] op_sel:[0,1] op_sel_hi:[1,1]
v_cvt_pk_bf16_f32 v164, v164, v165
v_cvt_pk_bf16_f32 v165, v166, v167
v_cvt_pk_bf16_f32 v166, v180, v181
v_cvt_pk_bf16_f32 v167, v182, v183
v_pk_add_f32 v[168:169], v[168:169], v[40:41]
v_pk_add_f32 v[170:171], v[170:171], v[42:43]
s_waitcnt lgkmcnt(9)
v_pk_add_f32 v[184:185], v[184:185], v[56:57]
v_pk_add_f32 v[186:187], v[186:187], v[58:59]
M v[24:27], a[112:115], v[164:167], v[24:27]
buffer_store_dwordx4 v[164:167], v1, s[16:19], s36 offen offset:2048 sc1
v_pk_mul_f32 v[168:169], v[168:169], v[10:11] op_sel:[0,0] op_sel_hi:[1,0]
v_pk_mul_f32 v[170:171], v[170:171], v[10:11] op_sel:[0,0] op_sel_hi:[1,0]
v_pk_mul_f32 v[184:185], v[184:185], v[10:11] op_sel:[0,0] op_sel_hi:[1,0]
v_pk_mul_f32 v[186:187], v[186:187], v[10:11] op_sel:[0,0] op_sel_hi:[1,0]
v_cvt_pk_bf16_f32 v168, v168, v169
v_cvt_pk_bf16_f32 v169, v170, v171
v_cvt_pk_bf16_f32 v170, v184, v185
v_cvt_pk_bf16_f32 v171, v186, v187
v_pk_add_f32 v[172:173], v[172:173], v[44:45]
v_pk_add_f32 v[174:175], v[174:175], v[46:47]
s_waitcnt lgkmcnt(8)
v_pk_add_f32 v[188:189], v[188:189], v[60:61]
v_pk_add_f32 v[190:191], v[190:191], v[62:63]
M v[24:27], a[112:115], v[168:171], v[24:27]
buffer_store_dwordx4 v[168:171], v1, s[16:19], s37 offen offset:0 sc1
v_pk_mul_f32 v[172:173], v[172:173], v[10:11] op_sel:[0,1] op_sel_hi:[1,1]
v_pk_mul_f32 v[174:175], v[174:175], v[10:11] op_sel:[0,1] op_sel_hi:[1,1]
v_pk_mul_f32 v[188:189], v[188:189], v[10:11] op_sel:[0,1] op_sel_hi:[1,1]
v_pk_mul_f32 v[190:191], v[190:191], v[10:11] op_sel:[0,1] op_sel_hi:[1,1]
v_cvt_pk_bf16_f32 v172, v172, v173
v_cvt_pk_bf16_f32 v173, v174, v175
v_cvt_pk_bf16_f32 v174, v188, v189
v_cvt_pk_bf16_f32 v175, v190, v191
s_waitcnt lgkmcnt(7)
v_pk_add_f32 v[192:193], v[192:193], v[64:65]
v_pk_add_f32 v[194:195], v[194:195], v[66:67]
s_waitcnt lgkmcnt(3)
v_pk_add_f32 v[208:209], v[208:209], v[80:81]
v_pk_add_f32 v[210:211], v[210:211], v[82:83]
M v[24:27], a[112:115], v[172:175], v[24:27]
buffer_store_dwordx4 v[172:175], v1, s[16:19], s37 offen offset:2048 sc1
v_pk_mul_f32 v[192:193], v[192:193], v[8:9] op_sel:[0,0] op_sel_hi:[1,0]
v_pk_mul_f32 v[194:195], v[194:195], v[8:9] op_sel:[0,0] op_sel_hi:[1,0]
v_pk_mul_f32 v[208:209], v[208:209], v[8:9] op_sel:[0,0] op_sel_hi:[1,0]
v_pk_mul_f32 v[210:211], v[210:211], v[8:9] op_sel:[0,0] op_sel_hi:[1,0]
v_cvt_pk_bf16_f32 v192, v192, v193
v_cvt_pk_bf16_f32 v193, v194, v195
v_cvt_pk_bf16_f32 v194, v208, v209
v_cvt_pk_bf16_f32 v195, v210, v211
v_pk_add_f32 v[196:197], v[196:197], v[68:69]
v_pk_add_f32 v[198:199], v[198:199], v[70:71]
s_waitcnt lgkmcnt(2)
v_pk_add_f32 v[212:213], v[212:213], v[84:85]
v_pk_add_f32 v[214:215], v[214:215], v[86:87]
M v[24:27], a[112:115], v[192:195], v[24:27]
buffer_store_dwordx4 v[192:195], v1, s[16:19], s36 offen offset:1024 sc1
v_pk_mul_f32 v[196:197], v[196:197], v[8:9] op_sel:[0,1] op_sel_hi:[1,1]
v_pk_mul_f32 v[198:199], v[198:199], v[8:9] op_sel:[0,1] op_sel_hi:[1,1]
v_pk_mul_f32 v[212:213], v[212:213], v[8:9] op_sel:[0,1] op_sel_hi:[1,1]
v_pk_mul_f32 v[214:215], v[214:215], v[8:9] op_sel:[0,1] op_sel_hi:[1,1]
v_cvt_pk_bf16_f32 v196, v196, v197
v_cvt_pk_bf16_f32 v197, v198, v199
v_cvt_pk_bf16_f32 v198, v212, v213
v_cvt_pk_bf16_f32 v199, v214, v215
v_pk_add_f32 v[200:201], v[200:201], v[72:73]
v_pk_add_f32 v[202:203], v[202:203], v[74:75]
s_waitcnt lgkmcnt(1)
v_pk_add_f32 v[216:217], v[216:217], v[88:89]
v_pk_add_f32 v[218:219], v[218:219], v[90:91]
M v[24:27], a[112:115], v[196:199], v[24:27]
buffer_store_dwordx4 v[196:199], v1, s[16:19], s36 offen offset:3072 sc1
v_pk_mul_f32 v[200:201], v[200:201], v[10:11] op_sel:[0,0] op_sel_hi:[1,0]
v_pk_mul_f32 v[202:203], v[202:203], v[10:11] op_sel:[0,0] op_sel_hi:[1,0]
v_pk_mul_f32 v[216:217], v[216:217], v[10:11] op_sel:[0,0] op_sel_hi:[1,0]
v_pk_mul_f32 v[218:219], v[218:219], v[10:11] op_sel:[0,0] op_sel_hi:[1,0]
v_cvt_pk_bf16_f32 v200, v200, v201
v_cvt_pk_bf16_f32 v201, v202, v203
v_cvt_pk_bf16_f32 v202, v216, v217
v_cvt_pk_bf16_f32 v203, v218, v219
v_pk_add_f32 v[204:205], v[204:205], v[76:77]
v_pk_add_f32 v[206:207], v[206:207], v[78:79]
s_waitcnt lgkmcnt(0)
v_pk_add_f32 v[220:221], v[220:221], v[92:93]
v_pk_add_f32 v[222:223], v[222:223], v[94:95]
M v[24:27], a[112:115], v[200:203], v[24:27]
buffer_store_dwordx4 v[200:203], v1, s[16:19], s37 offen offset:1024 sc1
v_pk_mul_f32 v[204:205], v[204:205], v[10:11] op_sel:[0,1] op_sel_hi:[1,1]
v_pk_mul_f32 v[206:207], v[206:207], v[10:11] op_sel:[0,1] op_sel_hi:[1,1]
v_pk_mul_f32 v[220:221], v[220:221], v[10:11] op_sel:[0,1] op_sel_hi:[1,1]
v_pk_mul_f32 v[222:223], v[222:223], v[10:11] op_sel:[0,1] op_sel_hi:[1,1]
v_cvt_pk_bf16_f32 v204, v204, v205
v_cvt_pk_bf16_f32 v205, v206, v207
v_cvt_pk_bf16_f32 v206, v220, v221
v_cvt_pk_bf16_f32 v207, v222, v223
s_nop 1
M v[24:27], a[112:115], v[204:207], v[24:27]
buffer_store_dwordx4 v[204:207], v1, s[16:19], s37 offen offset:3072 sc1
v_cmp_lt_u32 vcc, 0x3c000000, v12
s_nop 5
v_cmp_class_f32 s[40:41], v24, s64
s_nop 0
s_or_b64 vcc, vcc, s[40:41]
s_cmp_lg_u64 vcc, 0
s_cselect_b32 s33, 2, 0
s_or_b32 s60, s60, s33
s_branch Lk2_chk
Lk2_wm:
s_lshl_b32 s33, s2, 1
s_add_u32 s33, s33, s23
s_lshl_b32 s34, s33, 12
s_lshl_b32 s33, s33, 14
v_lshlrev_b32 v8, 3, v1
v_lshlrev_b32 v9, 2, v1
buffer_load_dword a244, v8, s[44:47], s33 offen
s_add_u32 s33, s33, 8192
buffer_load_dword a245, v8, s[44:47], s33 offen
buffer_load_dword a246, v9, s[48:51], s34 offen
s_branch Lk2_l3b
Lk2_g1:
s_mov_b32 s30, 7
s_bfe_u32 s65, s2, 0x20003
s_add_u32 s65, s65, 2
s_lshl_b32 s42, s21, 1
s_min_u32 s42, s42, 13
s_add_u32 s42, s42, 2
s_sub_u32 s33, s42, 1
s_cmp_le_u32 s33, 1
s_cselect_b32 s33, 0x4000, 0
v_add_u32 v3, s33, v3
s_sub_u32 s42, s42, 1
Lk2_l3:
s_cmp_eq_u32 s30, s65
s_cbranch_scc1 Lk2_wm
Lk2_l3b:
s_add_u32 m0, s29, 65536
s_waitcnt lgkmcnt(4)
M v[96:99], a[116:119], a[0:3], 0
v_exp_f32 v64, v64
M v[96:99], a[120:123], a[4:7], v[96:99]
ds_read_b128 a[148:151], v2 offset:8192
ds_read_b128 a[152:155], v2 offset:9216
M v[96:99], a[124:127], a[8:11], v[96:99]
v_exp_f32 v65, v65
M v[96:99], a[128:131], a[12:15], v[96:99]
buffer_load_dwordx4 v1, s[12:15], s25 offen offset:0 sc1 lds
s_add_u32 s32, s25, 4096
M v[100:103], a[128:131], a[28:31], 0
v_exp_f32 v66, v66
M v[100:103], a[124:127], a[24:27], v[100:103]
v_cvt_pk_bf16_f32 v64, v64, v65
M v[100:103], a[120:123], a[20:23], v[100:103]
v_exp_f32 v67, v67
M v[100:103], a[116:119], a[16:19], v[100:103]
buffer_load_dwordx4 v1, s[12:15], s25 offen offset:1024 sc1 lds
M v[104:107], a[116:119], a[32:35], 0
v_exp_f32 v80, v80
M v[104:107], a[120:123], a[36:39], v[104:107]
ds_read_b128 a[156:159], v2 offset:10240
ds_read_b128 a[160:163], v2 offset:11264
M v[104:107], a[124:127], a[40:43], v[104:107]
v_exp_f32 v81, v81
M v[104:107], a[128:131], a[44:47], v[104:107]
buffer_load_dwordx4 v1, s[12:15], s25 offen offset:2048 sc1 lds
M v[108:111], a[128:131], a[60:63], 0
v_exp_f32 v82, v82
M v[108:111], a[124:127], a[56:59], v[108:111]
v_cvt_pk_bf16_f32 v65, v66, v67
v_cvt_pk_bf16_f32 v66, v80, v81
M v[108:111], a[120:123], a[52:55], v[108:111]
v_exp_f32 v83, v83
M v[108:111], a[116:119], a[48:51], v[108:111]
buffer_load_dwordx4 v1, s[12:15], s25 offen offset:3072 sc1 lds
s_add_u32 m0, s29, 69632
s_waitcnt lgkmcnt(4)
M v[112:115], a[132:135], a[0:3], 0
v_exp_f32 v68, v68
M v[112:115], a[136:139], a[4:7], v[112:115]
ds_read_b128 a[164:167], v2 offset:12288
ds_read_b128 a[168:171], v2 offset:13312
M v[112:115], a[140:143], a[8:11], v[112:115]
v_exp_f32 v69, v69
M v[112:115], a[144:147], a[12:15], v[112:115]
buffer_load_dwordx4 v1, s[12:15], s32 offen offset:0 sc1 lds
M v[116:119], a[144:147], a[28:31], 0
v_exp_f32 v70, v70
M v[116:119], a[140:143], a[24:27], v[116:119]
v_cvt_pk_bf16_f32 v67, v82, v83
v_cvt_pk_bf16_f32 v68, v68, v69
M v[116:119], a[136:139], a[20:23], v[116:119]
v_exp_f32 v71, v71
M v[116:119], a[132:135], a[16:19], v[116:119]
buffer_load_dwordx4 v1, s[12:15], s32 offen offset:1024 sc1 lds
M v[120:123], a[132:135], a[32:35], 0
v_exp_f32 v84, v84
M v[120:123], a[136:139], a[36:39], v[120:123]
ds_read_b128 a[172:175], v2 offset:14336
ds_read_b128 a[176:179], v2 offset:15360
M v[120:123], a[140:143], a[40:43], v[120:123]
v_exp_f32 v85, v85
M v[120:123], a[144:147], a[44:47], v[120:123]
buffer_load_dwordx4 v1, s[12:15], s32 offen offset:2048 sc1 lds
M v[124:127], a[144:147], a[60:63], 0
v_exp_f32 v86, v86
M v[124:127], a[140:143], a[56:59], v[124:127]
v_cvt_pk_bf16_f32 v69, v70, v71
v_cvt_pk_bf16_f32 v70, v84, v85
M v[124:127], a[136:139], a[52:55], v[124:127]
v_exp_f32 v87, v87
M v[124:127], a[132:135], a[48:51], v[124:127]
buffer_load_dwordx4 v1, s[12:15], s32 offen offset:3072 sc1 lds
s_add_u32 m0, s29, 98304
s_waitcnt lgkmcnt(4)
M v[128:131], a[148:151], a[0:3], 0
v_exp_f32 v72, v72
M v[128:131], a[152:155], a[4:7], v[128:131]
ds_read_b128 a[116:119], v5 offset:32768
ds_read_b128 a[120:123], v5 offset:40960
M v[128:131], a[156:159], a[8:11], v[128:131]
v_exp_f32 v73, v73
M v[128:131], a[160:163], a[12:15], v[128:131]
buffer_load_dwordx4 v1, s[12:15], s26 offen offset:0 sc1 lds
s_add_u32 s43, s26, 4096
M v[132:135], a[160:163], a[28:31], 0
v_exp_f32 v74, v74
M v[132:135], a[156:159], a[24:27], v[132:135]
v_cvt_pk_bf16_f32 v71, v86, v87
v_cvt_pk_bf16_f32 v72, v72, v73
M v[132:135], a[152:155], a[20:23], v[132:135]
v_exp_f32 v75, v75
M v[132:135], a[148:151], a[16:19], v[132:135]
buffer_load_dwordx4 v1, s[12:15], s26 offen offset:1024 sc1 lds
M v[136:139], a[148:151], a[32:35], 0
v_exp_f32 v88, v88
M v[136:139], a[152:155], a[36:39], v[136:139]
ds_read_b128 a[124:127], v5 offset:33792
ds_read_b128 a[128:131], v5 offset:41984
M v[136:139], a[156:159], a[40:43], v[136:139]
v_exp_f32 v89, v89
M v[136:139], a[160:163], a[44:47], v[136:139]
buffer_load_dwordx4 v1, s[12:15], s26 offen offset:2048 sc1 lds
M v[140:143], a[160:163], a[60:63], 0
v_exp_f32 v90, v90
M v[140:143], a[156:159], a[56:59], v[140:143]
v_cvt_pk_bf16_f32 v73, v74, v75
v_cvt_pk_bf16_f32 v74, v88, v89
M v[140:143], a[152:155], a[52:55], v[140:143]
v_exp_f32 v91, v91
M v[140:143], a[148:151], a[48:51], v[140:143]
buffer_load_dwordx4 v1, s[12:15], s26 offen offset:3072 sc1 lds
s_add_u32 m0, s29, 102400
s_waitcnt lgkmcnt(4)
M v[144:147], a[164:167], a[0:3], 0
v_exp_f32 v76, v76
M v[144:147], a[168:171], a[4:7], v[144:147]
ds_read_b128 a[132:135], v5 offset:34816
ds_read_b128 a[136:139], v5 offset:43008
M v[144:147], a[172:175], a[8:11], v[144:147]
v_exp_f32 v77, v77
M v[144:147], a[176:179], a[12:15], v[144:147]
buffer_load_dwordx4 v1, s[12:15], s43 offen offset:0 sc1 lds
M v[148:151], a[176:179], a[28:31], 0
v_exp_f32 v78, v78
M v[148:151], a[172:175], a[24:27], v[148:151]
v_cvt_pk_bf16_f32 v75, v90, v91
v_cvt_pk_bf16_f32 v76, v76, v77
M v[148:151], a[168:171], a[20:23], v[148:151]
v_exp_f32 v79, v79
M v[148:151], a[164:167], a[16:19], v[148:151]
buffer_load_dwordx4 v1, s[12:15], s43 offen offset:1024 sc1 lds
M v[152:155], a[164:167], a[32:35], 0
v_exp_f32 v92, v92
M v[152:155], a[168:171], a[36:39], v[152:155]
ds_read_b128 a[140:143], v5 offset:35840
ds_read_b128 a[144:147], v5 offset:44032
M v[152:155], a[172:175], a[40:43], v[152:155]
v_exp_f32 v93, v93
M v[152:155], a[176:179], a[44:47], v[152:155]
buffer_load_dwordx4 v1, s[12:15], s43 offen offset:2048 sc1 lds
M v[156:159], a[176:179], a[60:63], 0
v_exp_f32 v94, v94
M v[156:159], a[172:175], a[56:59], v[156:159]
v_cvt_pk_bf16_f32 v77, v78, v79
v_cvt_pk_bf16_f32 v78, v92, v93
M v[156:159], a[168:171], a[52:55], v[156:159]
v_exp_f32 v95, v95
M v[156:159], a[164:167], a[48:51], v[156:159]
buffer_load_dwordx4 v1, s[12:15], s43 offen offset:3072 sc1 lds
v_cvt_pk_bf16_f32 v79, v94, v95
s_waitcnt lgkmcnt(6)
M v[160:163], a[116:119], v[32:35], v[160:163]
v_exp_f32 v96, v96
M v[160:163], a[120:123], v[64:67], v[160:163]
ds_read_b128 a[148:151], v5 offset:36864
ds_read_b128 a[152:155], v5 offset:45056
M v[164:167], a[120:123], v[68:71], v[164:167]
v_exp_f32 v97, v97
M v[164:167], a[116:119], v[36:39], v[164:167]
v_cvt_pk_bf16_f32 v96, v96, v97
M v[168:171], a[116:119], v[40:43], v[168:171]
v_exp_f32 v98, v98
M v[168:171], a[120:123], v[72:75], v[168:171]
s_add_u32 s25, s25, 32768
s_cmp_eq_u32 s25, s27
M v[172:175], a[120:123], v[76:79], v[172:175]
v_exp_f32 v99, v99
M v[172:175], a[116:119], v[44:47], v[172:175]
v_cvt_pk_bf16_f32 v97, v98, v99
s_waitcnt lgkmcnt(6)
M a[96:99], a[112:115], v[32:35], a[96:99]
s_cselect_b32 s25, s28, s25
s_cselect_b32 s27, s56, s27
M a[96:99], a[112:115], v[64:67], a[96:99]
s_cselect_b32 s28, s57, s28
s_cselect_b32 s56, -1, s56
M v[176:179], a[124:127], v[32:35], v[176:179]
v_exp_f32 v112, v112
M v[176:179], a[128:131], v[64:67], v[176:179]
ds_read_b128 a[156:159], v5 offset:37888
ds_read_b128 a[160:163], v5 offset:46080
M v[180:183], a[128:131], v[68:71], v[180:183]
v_exp_f32 v113, v113
M v[180:183], a[124:127], v[36:39], v[180:183]
v_cvt_pk_bf16_f32 v98, v112, v113
M v[184:187], a[124:127], v[40:43], v[184:187]
v_exp_f32 v114, v114
M v[184:187], a[128:131], v[72:75], v[184:187]
s_add_u32 s26, s26, 32768
s_cmp_eq_u32 s26, s62
M v[188:191], a[128:131], v[76:79], v[188:191]
v_exp_f32 v115, v115
M v[188:191], a[124:127], v[44:47], v[188:191]
v_cvt_pk_bf16_f32 v99, v114, v115
s_waitcnt lgkmcnt(6)
M a[100:103], a[112:115], v[36:39], a[100:103]
s_cselect_b32 s26, s63, s26
s_cselect_b32 s62, s58, s62
M a[100:103], a[112:115], v[68:71], a[100:103]
s_cselect_b32 s63, s59, s63
s_cselect_b32 s58, -1, s58
M v[192:195], a[132:135], v[32:35], v[192:195]
v_exp_f32 v100, v100
M v[192:195], a[136:139], v[64:67], v[192:195]
ds_read_b128 a[164:167], v5 offset:38912
ds_read_b128 a[168:171], v5 offset:47104
M v[196:199], a[136:139], v[68:71], v[196:199]
v_exp_f32 v101, v101
M v[196:199], a[132:135], v[36:39], v[196:199]
v_cvt_pk_bf16_f32 v100, v100, v101
M v[200:203], a[132:135], v[40:43], v[200:203]
v_exp_f32 v102, v102
M v[200:203], a[136:139], v[72:75], v[200:203]
s_sub_u32 s33, s42, 1
s_cmp_le_u32 s33, 1
s_cselect_b32 s33, 0x4000, 0
v_add_u32 v2, s33, v2
M v[204:207], a[136:139], v[76:79], v[204:207]
v_exp_f32 v103, v103
M v[204:207], a[132:135], v[44:47], v[204:207]
v_cvt_pk_bf16_f32 v101, v102, v103
s_waitcnt lgkmcnt(6)
M a[104:107], a[112:115], v[40:43], a[104:107]
M a[104:107], a[112:115], v[72:75], a[104:107]
M v[208:211], a[140:143], v[32:35], v[208:211]
v_exp_f32 v116, v116
M v[208:211], a[144:147], v[64:67], v[208:211]
ds_read_b128 a[172:175], v5 offset:39936
ds_read_b128 a[176:179], v5 offset:48128
M v[212:215], a[144:147], v[68:71], v[212:215]
v_exp_f32 v117, v117
M v[212:215], a[140:143], v[36:39], v[212:215]
v_cvt_pk_bf16_f32 v102, v116, v117
M v[216:219], a[140:143], v[40:43], v[216:219]
v_exp_f32 v118, v118
M v[216:219], a[144:147], v[72:75], v[216:219]
M v[220:223], a[144:147], v[76:79], v[220:223]
v_exp_f32 v119, v119
M v[220:223], a[140:143], v[44:47], v[220:223]
v_cvt_pk_bf16_f32 v103, v118, v119
s_waitcnt lgkmcnt(6)
M a[108:111], a[112:115], v[44:47], a[108:111]
M a[108:111], a[112:115], v[76:79], a[108:111]
M v[224:227], a[148:151], v[32:35], v[224:227]
v_exp_f32 v104, v104
M v[224:227], a[152:155], v[64:67], v[224:227]
s_cmp_le_u32 s42, 1
s_cselect_b32 s33, 0x4000, 0
v_add_u32 v5, s33, v5
s_sub_u32 s42, s42, 1
M v[228:231], a[152:155], v[68:71], v[228:231]
v_exp_f32 v105, v105
M v[228:231], a[148:151], v[36:39], v[228:231]
v_cvt_pk_bf16_f32 v104, v104, v105
M v[232:235], a[148:151], v[40:43], v[232:235]
v_exp_f32 v106, v106
M v[232:235], a[152:155], v[72:75], v[232:235]
M v[236:239], a[152:155], v[76:79], v[236:239]
v_exp_f32 v107, v107
M v[236:239], a[148:151], v[44:47], v[236:239]
v_cvt_pk_bf16_f32 v105, v106, v107
s_waitcnt lgkmcnt(4)
M v[240:243], a[156:159], v[32:35], v[240:243]
v_exp_f32 v120, v120
M v[240:243], a[160:163], v[64:67], v[240:243]
M v[244:247], a[160:163], v[68:71], v[244:247]
v_exp_f32 v121, v121
M v[244:247], a[156:159], v[36:39], v[244:247]
v_cvt_pk_bf16_f32 v106, v120, v121
M v[248:251], a[156:159], v[40:43], v[248:251]
v_exp_f32 v122, v122
M v[248:251], a[160:163], v[72:75], v[248:251]
s_waitcnt vmcnt(0) lgkmcnt(0)
s_barrier
ds_read_b128 a[116:119], v3 offset:0
ds_read_b128 a[120:123], v3 offset:1024
M v[252:255], a[160:163], v[76:79], v[252:255]
v_exp_f32 v123, v123
M v[252:255], a[156:159], v[44:47], v[252:255]
v_cvt_pk_bf16_f32 v107, v122, v123
M a[64:67], a[164:167], v[32:35], a[64:67]
v_exp_f32 v108, v108
M a[64:67], a[168:171], v[64:67], a[64:67]
ds_read_b128 a[124:127], v3 offset:2048
ds_read_b128 a[128:131], v3 offset:3072
M a[68:71], a[168:171], v[68:71], a[68:71]
v_exp_f32 v109, v109
M a[68:71], a[164:167], v[36:39], a[68:71]
v_cvt_pk_bf16_f32 v108, v108, v109
M a[72:75], a[164:167], v[40:43], a[72:75]
v_exp_f32 v110, v110
M a[72:75], a[168:171], v[72:75], a[72:75]
ds_read_b128 a[132:135], v3 offset:4096
ds_read_b128 a[136:139], v3 offset:5120
M a[76:79], a[168:171], v[76:79], a[76:79]
v_exp_f32 v111, v111
M a[76:79], a[164:167], v[44:47], a[76:79]
v_cvt_pk_bf16_f32 v109, v110, v111
M a[80:83], a[172:175], v[32:35], a[80:83]
v_exp_f32 v124, v124
M a[80:83], a[176:179], v[64:67], a[80:83]
ds_read_b128 a[140:143], v3 offset:6144
ds_read_b128 a[144:147], v3 offset:7168
M a[84:87], a[176:179], v[68:71], a[84:87]
v_exp_f32 v125, v125
M a[84:87], a[172:175], v[36:39], a[84:87]
v_cvt_pk_bf16_f32 v110, v124, v125
M a[88:91], a[172:175], v[40:43], a[88:91]
v_exp_f32 v126, v126
M a[88:91], a[176:179], v[72:75], a[88:91]
M a[92:95], a[176:179], v[76:79], a[92:95]
v_exp_f32 v127, v127
M a[92:95], a[172:175], v[44:47], a[92:95]
v_cvt_pk_bf16_f32 v111, v126, v127
s_add_u32 m0, s29, 0
s_waitcnt lgkmcnt(4)
M v[32:35], a[116:119], a[0:3], 0
v_exp_f32 v128, v128
M v[32:35], a[120:123], a[4:7], v[32:35]
ds_read_b128 a[148:151], v3 offset:8192
ds_read_b128 a[152:155], v3 offset:9216
M v[32:35], a[124:127], a[8:11], v[32:35]
v_exp_f32 v129, v129
M v[32:35], a[128:131], a[12:15], v[32:35]
buffer_load_dwordx4 v1, s[12:15], s25 offen offset:0 sc1 lds
s_add_u32 s32, s25, 4096
M v[36:39], a[128:131], a[28:31], 0
v_exp_f32 v130, v130
M v[36:39], a[124:127], a[24:27], v[36:39]
v_cvt_pk_bf16_f32 v128, v128, v129
M v[36:39], a[120:123], a[20:23], v[36:39]
v_exp_f32 v131, v131
M v[36:39], a[116:119], a[16:19], v[36:39]
buffer_load_dwordx4 v1, s[12:15], s25 offen offset:1024 sc1 lds
M v[40:43], a[116:119], a[32:35], 0
v_exp_f32 v144, v144
M v[40:43], a[120:123], a[36:39], v[40:43]
ds_read_b128 a[156:159], v3 offset:10240
ds_read_b128 a[160:163], v3 offset:11264
M v[40:43], a[124:127], a[40:43], v[40:43]
v_exp_f32 v145, v145
M v[40:43], a[128:131], a[44:47], v[40:43]
buffer_load_dwordx4 v1, s[12:15], s25 offen offset:2048 sc1 lds
M v[44:47], a[128:131], a[60:63], 0
v_exp_f32 v146, v146
M v[44:47], a[124:127], a[56:59], v[44:47]
v_cvt_pk_bf16_f32 v129, v130, v131
v_cvt_pk_bf16_f32 v130, v144, v145
M v[44:47], a[120:123], a[52:55], v[44:47]
v_exp_f32 v147, v147
M v[44:47], a[116:119], a[48:51], v[44:47]
buffer_load_dwordx4 v1, s[12:15], s25 offen offset:3072 sc1 lds
s_add_u32 m0, s29, 4096
s_waitcnt lgkmcnt(4)
M v[48:51], a[132:135], a[0:3], 0
v_exp_f32 v132, v132
M v[48:51], a[136:139], a[4:7], v[48:51]
ds_read_b128 a[164:167], v3 offset:12288
ds_read_b128 a[168:171], v3 offset:13312
M v[48:51], a[140:143], a[8:11], v[48:51]
v_exp_f32 v133, v133
M v[48:51], a[144:147], a[12:15], v[48:51]
buffer_load_dwordx4 v1, s[12:15], s32 offen offset:0 sc1 lds
M v[52:55], a[144:147], a[28:31], 0
v_exp_f32 v134, v134
M v[52:55], a[140:143], a[24:27], v[52:55]
v_cvt_pk_bf16_f32 v131, v146, v147
v_cvt_pk_bf16_f32 v132, v132, v133
M v[52:55], a[136:139], a[20:23], v[52:55]
v_exp_f32 v135, v135
M v[52:55], a[132:135], a[16:19], v[52:55]
buffer_load_dwordx4 v1, s[12:15], s32 offen offset:1024 sc1 lds
M v[56:59], a[132:135], a[32:35], 0
v_exp_f32 v148, v148
M v[56:59], a[136:139], a[36:39], v[56:59]
ds_read_b128 a[172:175], v3 offset:14336
ds_read_b128 a[176:179], v3 offset:15360
M v[56:59], a[140:143], a[40:43], v[56:59]
v_exp_f32 v149, v149
M v[56:59], a[144:147], a[44:47], v[56:59]
buffer_load_dwordx4 v1, s[12:15], s32 offen offset:2048 sc1 lds
M v[60:63], a[144:147], a[60:63], 0
v_exp_f32 v150, v150
M v[60:63], a[140:143], a[56:59], v[60:63]
v_cvt_pk_bf16_f32 v133, v134, v135
v_cvt_pk_bf16_f32 v134, v148, v149
M v[60:63], a[136:139], a[52:55], v[60:63]
v_exp_f32 v151, v151
M v[60:63], a[132:135], a[48:51], v[60:63]
buffer_load_dwordx4 v1, s[12:15], s32 offen offset:3072 sc1 lds
s_add_u32 m0, s29, 32768
s_waitcnt lgkmcnt(4)
M v[64:67], a[148:151], a[0:3], 0
v_exp_f32 v136, v136
M v[64:67], a[152:155], a[4:7], v[64:67]
ds_read_b128 a[116:119], v6 offset:32768
ds_read_b128 a[120:123], v6 offset:40960
M v[64:67], a[156:159], a[8:11], v[64:67]
v_exp_f32 v137, v137
M v[64:67], a[160:163], a[12:15], v[64:67]
buffer_load_dwordx4 v1, s[12:15], s26 offen offset:0 sc1 lds
s_add_u32 s43, s26, 4096
M v[68:71], a[160:163], a[28:31], 0
v_exp_f32 v138, v138
M v[68:71], a[156:159], a[24:27], v[68:71]
v_cvt_pk_bf16_f32 v135, v150, v151
v_cvt_pk_bf16_f32 v136, v136, v137
M v[68:71], a[152:155], a[20:23], v[68:71]
v_exp_f32 v139, v139
M v[68:71], a[148:151], a[16:19], v[68:71]
buffer_load_dwordx4 v1, s[12:15], s26 offen offset:1024 sc1 lds
M v[72:75], a[148:151], a[32:35], 0
v_exp_f32 v152, v152
M v[72:75], a[152:155], a[36:39], v[72:75]
ds_read_b128 a[124:127], v6 offset:33792
ds_read_b128 a[128:131], v6 offset:41984
M v[72:75], a[156:159], a[40:43], v[72:75]
v_exp_f32 v153, v153
M v[72:75], a[160:163], a[44:47], v[72:75]
buffer_load_dwordx4 v1, s[12:15], s26 offen offset:2048 sc1 lds
M v[76:79], a[160:163], a[60:63], 0
v_exp_f32 v154, v154
M v[76:79], a[156:159], a[56:59], v[76:79]
v_cvt_pk_bf16_f32 v137, v138, v139
v_cvt_pk_bf16_f32 v138, v152, v153
M v[76:79], a[152:155], a[52:55], v[76:79]
v_exp_f32 v155, v155
M v[76:79], a[148:151], a[48:51], v[76:79]
buffer_load_dwordx4 v1, s[12:15], s26 offen offset:3072 sc1 lds
s_add_u32 m0, s29, 36864
s_waitcnt lgkmcnt(4)
M v[80:83], a[164:167], a[0:3], 0
v_exp_f32 v140, v140
M v[80:83], a[168:171], a[4:7], v[80:83]
ds_read_b128 a[132:135], v6 offset:34816
ds_read_b128 a[136:139], v6 offset:43008
M v[80:83], a[172:175], a[8:11], v[80:83]
v_exp_f32 v141, v141
M v[80:83], a[176:179], a[12:15], v[80:83]
buffer_load_dwordx4 v1, s[12:15], s43 offen offset:0 sc1 lds
M v[84:87], a[176:179], a[28:31], 0
v_exp_f32 v142, v142
M v[84:87], a[172:175], a[24:27], v[84:87]
v_cvt_pk_bf16_f32 v139, v154, v155
v_cvt_pk_bf16_f32 v140, v140, v141
M v[84:87], a[168:171], a[20:23], v[84:87]
v_exp_f32 v143, v143
M v[84:87], a[164:167], a[16:19], v[84:87]
buffer_load_dwordx4 v1, s[12:15], s43 offen offset:1024 sc1 lds
M v[88:91], a[164:167], a[32:35], 0
v_exp_f32 v156, v156
M v[88:91], a[168:171], a[36:39], v[88:91]
ds_read_b128 a[140:143], v6 offset:35840
ds_read_b128 a[144:147], v6 offset:44032
M v[88:91], a[172:175], a[40:43], v[88:91]
v_exp_f32 v157, v157
M v[88:91], a[176:179], a[44:47], v[88:91]
buffer_load_dwordx4 v1, s[12:15], s43 offen offset:2048 sc1 lds
M v[92:95], a[176:179], a[60:63], 0
v_exp_f32 v158, v158
M v[92:95], a[172:175], a[56:59], v[92:95]
v_cvt_pk_bf16_f32 v141, v142, v143
v_cvt_pk_bf16_f32 v142, v156, v157
M v[92:95], a[168:171], a[52:55], v[92:95]
v_exp_f32 v159, v159
M v[92:95], a[164:167], a[48:51], v[92:95]
buffer_load_dwordx4 v1, s[12:15], s43 offen offset:3072 sc1 lds
v_cvt_pk_bf16_f32 v143, v158, v159
s_waitcnt lgkmcnt(6)
M v[160:163], a[116:119], v[96:99], v[160:163]
v_exp_f32 v32, v32
M v[160:163], a[120:123], v[128:131], v[160:163]
ds_read_b128 a[148:151], v6 offset:36864
ds_read_b128 a[152:155], v6 offset:45056
M v[164:167], a[120:123], v[132:135], v[164:167]
v_exp_f32 v33, v33
M v[164:167], a[116:119], v[100:103], v[164:167]
v_cvt_pk_bf16_f32 v32, v32, v33
M v[168:171], a[116:119], v[104:107], v[168:171]
v_exp_f32 v34, v34
M v[168:171], a[120:123], v[136:139], v[168:171]
s_add_u32 s25, s25, 32768
s_cmp_eq_u32 s25, s27
M v[172:175], a[120:123], v[140:143], v[172:175]
v_exp_f32 v35, v35
M v[172:175], a[116:119], v[108:111], v[172:175]
v_cvt_pk_bf16_f32 v33, v34, v35
s_waitcnt lgkmcnt(6)
M a[96:99], a[112:115], v[96:99], a[96:99]
s_cselect_b32 s25, s28, s25
s_cselect_b32 s27, s56, s27
M a[96:99], a[112:115], v[128:131], a[96:99]
s_cselect_b32 s28, s57, s28
s_cselect_b32 s56, -1, s56
M v[176:179], a[124:127], v[96:99], v[176:179]
v_exp_f32 v48, v48
M v[176:179], a[128:131], v[128:131], v[176:179]
ds_read_b128 a[156:159], v6 offset:37888
ds_read_b128 a[160:163], v6 offset:46080
M v[180:183], a[128:131], v[132:135], v[180:183]
v_exp_f32 v49, v49
M v[180:183], a[124:127], v[100:103], v[180:183]
v_cvt_pk_bf16_f32 v34, v48, v49
M v[184:187], a[124:127], v[104:107], v[184:187]
v_exp_f32 v50, v50
M v[184:187], a[128:131], v[136:139], v[184:187]
s_add_u32 s26, s26, 32768
s_cmp_eq_u32 s26, s62
M v[188:191], a[128:131], v[140:143], v[188:191]
v_exp_f32 v51, v51
M v[188:191], a[124:127], v[108:111], v[188:191]
v_cvt_pk_bf16_f32 v35, v50, v51
s_waitcnt lgkmcnt(6)
M a[100:103], a[112:115], v[100:103], a[100:103]
s_cselect_b32 s26, s63, s26
s_cselect_b32 s62, s58, s62
M a[100:103], a[112:115], v[132:135], a[100:103]
s_cselect_b32 s63, s59, s63
s_cselect_b32 s58, -1, s58
M v[192:195], a[132:135], v[96:99], v[192:195]
v_exp_f32 v36, v36
M v[192:195], a[136:139], v[128:131], v[192:195]
ds_read_b128 a[164:167], v6 offset:38912
ds_read_b128 a[168:171], v6 offset:47104
M v[196:199], a[136:139], v[132:135], v[196:199]
v_exp_f32 v37, v37
M v[196:199], a[132:135], v[100:103], v[196:199]
v_cvt_pk_bf16_f32 v36, v36, v37
M v[200:203], a[132:135], v[104:107], v[200:203]
v_exp_f32 v38, v38
M v[200:203], a[136:139], v[136:139], v[200:203]
s_sub_u32 s33, s42, 1
s_cmp_le_u32 s33, 1
s_cselect_b32 s33, 0x4000, 0
v_add_u32 v3, s33, v3
M v[204:207], a[136:139], v[140:143], v[204:207]
v_exp_f32 v39, v39
M v[204:207], a[132:135], v[108:111], v[204:207]
v_cvt_pk_bf16_f32 v37, v38, v39
s_waitcnt lgkmcnt(6)
M a[104:107], a[112:115], v[104:107], a[104:107]
M a[104:107], a[112:115], v[136:139], a[104:107]
M v[208:211], a[140:143], v[96:99], v[208:211]
v_exp_f32 v52, v52
M v[208:211], a[144:147], v[128:131], v[208:211]
ds_read_b128 a[172:175], v6 offset:39936
ds_read_b128 a[176:179], v6 offset:48128
M v[212:215], a[144:147], v[132:135], v[212:215]
v_exp_f32 v53, v53
M v[212:215], a[140:143], v[100:103], v[212:215]
v_cvt_pk_bf16_f32 v38, v52, v53
M v[216:219], a[140:143], v[104:107], v[216:219]
v_exp_f32 v54, v54
M v[216:219], a[144:147], v[136:139], v[216:219]
M v[220:223], a[144:147], v[140:143], v[220:223]
v_exp_f32 v55, v55
M v[220:223], a[140:143], v[108:111], v[220:223]
v_cvt_pk_bf16_f32 v39, v54, v55
s_waitcnt lgkmcnt(6)
M a[108:111], a[112:115], v[108:111], a[108:111]
M a[108:111], a[112:115], v[140:143], a[108:111]
M v[224:227], a[148:151], v[96:99], v[224:227]
v_exp_f32 v40, v40
M v[224:227], a[152:155], v[128:131], v[224:227]
s_cmp_le_u32 s42, 1
s_cselect_b32 s33, 0x4000, 0
v_add_u32 v6, s33, v6
s_sub_u32 s42, s42, 1
M v[228:231], a[152:155], v[132:135], v[228:231]
v_exp_f32 v41, v41
M v[228:231], a[148:151], v[100:103], v[228:231]
v_cvt_pk_bf16_f32 v40, v40, v41
M v[232:235], a[148:151], v[104:107], v[232:235]
v_exp_f32 v42, v42
M v[232:235], a[152:155], v[136:139], v[232:235]
M v[236:239], a[152:155], v[140:143], v[236:239]
v_exp_f32 v43, v43
M v[236:239], a[148:151], v[108:111], v[236:239]
v_cvt_pk_bf16_f32 v41, v42, v43
s_waitcnt lgkmcnt(4)
M v[240:243], a[156:159], v[96:99], v[240:243]
v_exp_f32 v56, v56
M v[240:243], a[160:163], v[128:131], v[240:243]
M v[244:247], a[160:163], v[132:135], v[244:247]
v_exp_f32 v57, v57
M v[244:247], a[156:159], v[100:103], v[244:247]
v_cvt_pk_bf16_f32 v42, v56, v57
M v[248:251], a[156:159], v[104:107], v[248:251]
v_exp_f32 v58, v58
M v[248:251], a[160:163], v[136:139], v[248:251]
s_waitcnt vmcnt(0) lgkmcnt(0)
s_barrier
ds_read_b128 a[116:119], v2 offset:0
ds_read_b128 a[120:123], v2 offset:1024
M v[252:255], a[160:163], v[140:143], v[252:255]
v_exp_f32 v59, v59
M v[252:255], a[156:159], v[108:111], v[252:255]
v_cvt_pk_bf16_f32 v43, v58, v59
M a[64:67], a[164:167], v[96:99], a[64:67]
v_exp_f32 v44, v44
M a[64:67], a[168:171], v[128:131], a[64:67]
ds_read_b128 a[124:127], v2 offset:2048
ds_read_b128 a[128:131], v2 offset:3072
M a[68:71], a[168:171], v[132:135], a[68:71]
v_exp_f32 v45, v45
M a[68:71], a[164:167], v[100:103], a[68:71]
v_cvt_pk_bf16_f32 v44, v44, v45
M a[72:75], a[164:167], v[104:107], a[72:75]
v_exp_f32 v46, v46
M a[72:75], a[168:171], v[136:139], a[72:75]
ds_read_b128 a[132:135], v2 offset:4096
ds_read_b128 a[136:139], v2 offset:5120
M a[76:79], a[168:171], v[140:143], a[76:79]
v_exp_f32 v47, v47
M a[76:79], a[164:167], v[108:111], a[76:79]
v_cvt_pk_bf16_f32 v45, v46, v47
M a[80:83], a[172:175], v[96:99], a[80:83]
v_exp_f32 v60, v60
M a[80:83], a[176:179], v[128:131], a[80:83]
ds_read_b128 a[140:143], v2 offset:6144
ds_read_b128 a[144:147], v2 offset:7168
M a[84:87], a[176:179], v[132:135], a[84:87]
v_exp_f32 v61, v61
M a[84:87], a[172:175], v[100:103], a[84:87]
v_cvt_pk_bf16_f32 v46, v60, v61
M a[88:91], a[172:175], v[104:107], a[88:91]
v_exp_f32 v62, v62
M a[88:91], a[176:179], v[136:139], a[88:91]
M a[92:95], a[176:179], v[140:143], a[92:95]
v_exp_f32 v63, v63
M a[92:95], a[172:175], v[108:111], a[92:95]
v_cvt_pk_bf16_f32 v47, v62, v63
s_sub_u32 s30, s30, 1
s_cmp_lg_u32 s30, 0
s_cbranch_scc1 Lk2_l3
s_cmp_eq_u32 s23, 1
s_cbranch_scc1 Lk2_g1b
s_add_u32 m0, s29, 65536
s_waitcnt lgkmcnt(4)
M v[96:99], a[116:119], a[0:3], v[16:19]
v_exp_f32 v64, v64
M v[96:99], a[120:123], a[4:7], v[96:99]
ds_read_b128 a[148:151], v2 offset:8192
ds_read_b128 a[152:155], v2 offset:9216
M v[96:99], a[124:127], a[8:11], v[96:99]
v_exp_f32 v65, v65
M v[96:99], a[128:131], a[12:15], v[96:99]
buffer_load_dwordx4 v1, s[12:15], s25 offen offset:0 sc1 lds
s_add_u32 s32, s25, 4096
M v[100:103], a[128:131], a[28:31], 0
v_exp_f32 v66, v66
M v[100:103], a[124:127], a[24:27], v[100:103]
v_cvt_pk_bf16_f32 v64, v64, v65
M v[100:103], a[120:123], a[20:23], v[100:103]
v_exp_f32 v67, v67
M v[100:103], a[116:119], a[16:19], v[100:103]
buffer_load_dwordx4 v1, s[12:15], s25 offen offset:1024 sc1 lds
M v[104:107], a[116:119], a[32:35], 0
v_exp_f32 v80, v80
M v[104:107], a[120:123], a[36:39], v[104:107]
ds_read_b128 a[156:159], v2 offset:10240
ds_read_b128 a[160:163], v2 offset:11264
M v[104:107], a[124:127], a[40:43], v[104:107]
v_exp_f32 v81, v81
M v[104:107], a[128:131], a[44:47], v[104:107]
buffer_load_dwordx4 v1, s[12:15], s25 offen offset:2048 sc1 lds
M v[108:111], a[128:131], a[60:63], 0
v_exp_f32 v82, v82
M v[108:111], a[124:127], a[56:59], v[108:111]
v_cvt_pk_bf16_f32 v65, v66, v67
v_cvt_pk_bf16_f32 v66, v80, v81
M v[108:111], a[120:123], a[52:55], v[108:111]
v_exp_f32 v83, v83
M v[108:111], a[116:119], a[48:51], v[108:111]
buffer_load_dwordx4 v1, s[12:15], s25 offen offset:3072 sc1 lds
s_add_u32 m0, s29, 69632
s_waitcnt lgkmcnt(4)
v_exp_f32 v68, v68
ds_read_b128 a[164:167], v2 offset:12288
ds_read_b128 a[168:171], v2 offset:13312
v_exp_f32 v69, v69
buffer_load_dwordx4 v1, s[12:15], s32 offen offset:0 sc1 lds
M v[116:119], a[144:147], a[28:31], v[16:19]
v_exp_f32 v70, v70
M v[116:119], a[140:143], a[24:27], v[116:119]
v_cvt_pk_bf16_f32 v67, v82, v83
v_cvt_pk_bf16_f32 v68, v68, v69
M v[116:119], a[136:139], a[20:23], v[116:119]
v_exp_f32 v71, v71
M v[116:119], a[132:135], a[16:19], v[116:119]
buffer_load_dwordx4 v1, s[12:15], s32 offen offset:1024 sc1 lds
M v[120:123], a[132:135], a[32:35], 0
v_exp_f32 v84, v84
M v[120:123], a[136:139], a[36:39], v[120:123]
ds_read_b128 a[172:175], v2 offset:14336
ds_read_b128 a[176:179], v2 offset:15360
M v[120:123], a[140:143], a[40:43], v[120:123]
v_exp_f32 v85, v85
M v[120:123], a[144:147], a[44:47], v[120:123]
buffer_load_dwordx4 v1, s[12:15], s32 offen offset:2048 sc1 lds
M v[124:127], a[144:147], a[60:63], 0
v_exp_f32 v86, v86
M v[124:127], a[140:143], a[56:59], v[124:127]
v_cvt_pk_bf16_f32 v69, v70, v71
v_cvt_pk_bf16_f32 v70, v84, v85
M v[124:127], a[136:139], a[52:55], v[124:127]
v_exp_f32 v87, v87
M v[124:127], a[132:135], a[48:51], v[124:127]
buffer_load_dwordx4 v1, s[12:15], s32 offen offset:3072 sc1 lds
s_add_u32 m0, s29, 98304
s_waitcnt lgkmcnt(4)
v_exp_f32 v72, v72
ds_read_b128 a[116:119], v5 offset:32768
ds_read_b128 a[120:123], v5 offset:40960
v_exp_f32 v73, v73
buffer_load_dwordx4 v1, s[12:15], s26 offen offset:0 sc1 lds
s_add_u32 s43, s26, 4096
v_exp_f32 v74, v74
v_cvt_pk_bf16_f32 v71, v86, v87
v_cvt_pk_bf16_f32 v72, v72, v73
v_exp_f32 v75, v75
buffer_load_dwordx4 v1, s[12:15], s26 offen offset:1024 sc1 lds
M v[136:139], a[148:151], a[32:35], v[16:19]
v_exp_f32 v88, v88
M v[136:139], a[152:155], a[36:39], v[136:139]
ds_read_b128 a[124:127], v5 offset:33792
ds_read_b128 a[128:131], v5 offset:41984
M v[136:139], a[156:159], a[40:43], v[136:139]
v_exp_f32 v89, v89
M v[136:139], a[160:163], a[44:47], v[136:139]
buffer_load_dwordx4 v1, s[12:15], s26 offen offset:2048 sc1 lds
M v[140:143], a[160:163], a[60:63], 0
v_exp_f32 v90, v90
M v[140:143], a[156:159], a[56:59], v[140:143]
v_cvt_pk_bf16_f32 v73, v74, v75
v_cvt_pk_bf16_f32 v74, v88, v89
M v[140:143], a[152:155], a[52:55], v[140:143]
v_exp_f32 v91, v91
M v[140:143], a[148:151], a[48:51], v[140:143]
buffer_load_dwordx4 v1, s[12:15], s26 offen offset:3072 sc1 lds
s_add_u32 m0, s29, 102400
s_waitcnt lgkmcnt(4)
v_exp_f32 v76, v76
ds_read_b128 a[132:135], v5 offset:34816
ds_read_b128 a[136:139], v5 offset:43008
v_exp_f32 v77, v77
buffer_load_dwordx4 v1, s[12:15], s43 offen offset:0 sc1 lds
v_exp_f32 v78, v78
v_cvt_pk_bf16_f32 v75, v90, v91
v_cvt_pk_bf16_f32 v76, v76, v77
v_exp_f32 v79, v79
buffer_load_dwordx4 v1, s[12:15], s43 offen offset:1024 sc1 lds
v_exp_f32 v92, v92
ds_read_b128 a[140:143], v5 offset:35840
ds_read_b128 a[144:147], v5 offset:44032
v_exp_f32 v93, v93
buffer_load_dwordx4 v1, s[12:15], s43 offen offset:2048 sc1 lds
M v[156:159], a[176:179], a[60:63], v[16:19]
v_exp_f32 v94, v94
M v[156:159], a[172:175], a[56:59], v[156:159]
v_cvt_pk_bf16_f32 v77, v78, v79
v_cvt_pk_bf16_f32 v78, v92, v93
M v[156:159], a[168:171], a[52:55], v[156:159]
v_exp_f32 v95, v95
M v[156:159], a[164:167], a[48:51], v[156:159]
buffer_load_dwordx4 v1, s[12:15], s43 offen offset:3072 sc1 lds
v_cvt_pk_bf16_f32 v79, v94, v95
s_waitcnt lgkmcnt(6)
M v[160:163], a[116:119], v[32:35], v[160:163]
v_exp_f32 v96, v96
M v[160:163], a[120:123], v[64:67], v[160:163]
ds_read_b128 a[148:151], v5 offset:36864
ds_read_b128 a[152:155], v5 offset:45056
M v[164:167], a[120:123], v[68:71], v[164:167]
v_exp_f32 v97, v97
M v[164:167], a[116:119], v[36:39], v[164:167]
v_cvt_pk_bf16_f32 v96, v96, v97
M v[168:171], a[116:119], v[40:43], v[168:171]
v_exp_f32 v98, v98
M v[168:171], a[120:123], v[72:75], v[168:171]
s_add_u32 s25, s25, 32768
s_cmp_eq_u32 s25, s27
M v[172:175], a[120:123], v[76:79], v[172:175]
v_exp_f32 v99, v99
M v[172:175], a[116:119], v[44:47], v[172:175]
v_cvt_pk_bf16_f32 v97, v98, v99
s_waitcnt lgkmcnt(6)
M a[96:99], a[112:115], v[32:35], a[96:99]
s_cselect_b32 s25, s28, s25
s_cselect_b32 s27, s56, s27
M a[96:99], a[112:115], v[64:67], a[96:99]
s_cselect_b32 s28, s57, s28
s_cselect_b32 s56, -1, s56
M v[176:179], a[124:127], v[32:35], v[176:179]
M v[176:179], a[128:131], v[64:67], v[176:179]
ds_read_b128 a[156:159], v5 offset:37888
ds_read_b128 a[160:163], v5 offset:46080
M v[180:183], a[128:131], v[68:71], v[180:183]
M v[180:183], a[124:127], v[36:39], v[180:183]
v_mov_b32 v98, 0
M v[184:187], a[124:127], v[40:43], v[184:187]
M v[184:187], a[128:131], v[72:75], v[184:187]
s_add_u32 s26, s26, 32768
s_cmp_eq_u32 s26, s62
M v[188:191], a[128:131], v[76:79], v[188:191]
M v[188:191], a[124:127], v[44:47], v[188:191]
v_mov_b32 v99, 0
s_waitcnt lgkmcnt(6)
M a[100:103], a[112:115], v[36:39], a[100:103]
s_cselect_b32 s26, s63, s26
s_cselect_b32 s62, s58, s62
M a[100:103], a[112:115], v[68:71], a[100:103]
s_cselect_b32 s63, s59, s63
s_cselect_b32 s58, -1, s58
M v[192:195], a[132:135], v[32:35], v[192:195]
v_exp_f32 v100, v100
M v[192:195], a[136:139], v[64:67], v[192:195]
ds_read_b128 a[164:167], v5 offset:38912
ds_read_b128 a[168:171], v5 offset:47104
M v[196:199], a[136:139], v[68:71], v[196:199]
v_exp_f32 v101, v101
M v[196:199], a[132:135], v[36:39], v[196:199]
v_cvt_pk_bf16_f32 v100, v100, v101
M v[200:203], a[132:135], v[40:43], v[200:203]
v_exp_f32 v102, v102
M v[200:203], a[136:139], v[72:75], v[200:203]
s_sub_u32 s33, s42, 1
s_cmp_le_u32 s33, 1
s_cselect_b32 s33, 0x4000, 0
v_add_u32 v2, s33, v2
M v[204:207], a[136:139], v[76:79], v[204:207]
v_exp_f32 v103, v103
M v[204:207], a[132:135], v[44:47], v[204:207]
v_cvt_pk_bf16_f32 v101, v102, v103
s_waitcnt lgkmcnt(6)
M a[104:107], a[112:115], v[40:43], a[104:107]
M a[104:107], a[112:115], v[72:75], a[104:107]
M v[208:211], a[140:143], v[32:35], v[208:211]
v_exp_f32 v116, v116
M v[208:211], a[144:147], v[64:67], v[208:211]
ds_read_b128 a[172:175], v5 offset:39936
ds_read_b128 a[176:179], v5 offset:48128
M v[212:215], a[144:147], v[68:71], v[212:215]
v_exp_f32 v117, v117
M v[212:215], a[140:143], v[36:39], v[212:215]
v_cvt_pk_bf16_f32 v102, v116, v117
M v[216:219], a[140:143], v[40:43], v[216:219]
v_exp_f32 v118, v118
M v[216:219], a[144:147], v[72:75], v[216:219]
M v[220:223], a[144:147], v[76:79], v[220:223]
v_exp_f32 v119, v119
M v[220:223], a[140:143], v[44:47], v[220:223]
v_cvt_pk_bf16_f32 v103, v118, v119
s_waitcnt lgkmcnt(6)
M a[108:111], a[112:115], v[44:47], a[108:111]
M a[108:111], a[112:115], v[76:79], a[108:111]
M v[224:227], a[148:151], v[32:35], v[224:227]
v_exp_f32 v104, v104
M v[224:227], a[152:155], v[64:67], v[224:227]
s_cmp_le_u32 s42, 1
s_cselect_b32 s33, 0x4000, 0
v_add_u32 v5, s33, v5
s_sub_u32 s42, s42, 1
M v[228:231], a[152:155], v[68:71], v[228:231]
v_exp_f32 v105, v105
M v[228:231], a[148:151], v[36:39], v[228:231]
v_cvt_pk_bf16_f32 v104, v104, v105
M v[232:235], a[148:151], v[40:43], v[232:235]
v_exp_f32 v106, v106
M v[232:235], a[152:155], v[72:75], v[232:235]
M v[236:239], a[152:155], v[76:79], v[236:239]
v_exp_f32 v107, v107
M v[236:239], a[148:151], v[44:47], v[236:239]
v_cvt_pk_bf16_f32 v105, v106, v107
s_waitcnt lgkmcnt(4)
M v[240:243], a[156:159], v[32:35], v[240:243]
v_exp_f32 v120, v120
M v[240:243], a[160:163], v[64:67], v[240:243]
M v[244:247], a[160:163], v[68:71], v[244:247]
v_exp_f32 v121, v121
M v[244:247], a[156:159], v[36:39], v[244:247]
v_cvt_pk_bf16_f32 v106, v120, v121
M v[248:251], a[156:159], v[40:43], v[248:251]
v_exp_f32 v122, v122
M v[248:251], a[160:163], v[72:75], v[248:251]
s_waitcnt vmcnt(0) lgkmcnt(0)
s_barrier
ds_read_b128 a[116:119], v3 offset:0
ds_read_b128 a[120:123], v3 offset:1024
M v[252:255], a[160:163], v[76:79], v[252:255]
v_exp_f32 v123, v123
M v[252:255], a[156:159], v[44:47], v[252:255]
v_cvt_pk_bf16_f32 v107, v122, v123
M a[64:67], a[164:167], v[32:35], a[64:67]
v_exp_f32 v108, v108
M a[64:67], a[168:171], v[64:67], a[64:67]
ds_read_b128 a[124:127], v3 offset:2048
ds_read_b128 a[128:131], v3 offset:3072
M a[68:71], a[168:171], v[68:71], a[68:71]
v_exp_f32 v109, v109
M a[68:71], a[164:167], v[36:39], a[68:71]
v_cvt_pk_bf16_f32 v108, v108, v109
M a[72:75], a[164:167], v[40:43], a[72:75]
v_exp_f32 v110, v110
M a[72:75], a[168:171], v[72:75], a[72:75]
ds_read_b128 a[132:135], v3 offset:4096
ds_read_b128 a[136:139], v3 offset:5120
M a[76:79], a[168:171], v[76:79], a[76:79]
v_exp_f32 v111, v111
M a[76:79], a[164:167], v[44:47], a[76:79]
v_cvt_pk_bf16_f32 v109, v110, v111
M a[80:83], a[172:175], v[32:35], a[80:83]
v_exp_f32 v124, v124
M a[80:83], a[176:179], v[64:67], a[80:83]
ds_read_b128 a[140:143], v3 offset:6144
ds_read_b128 a[144:147], v3 offset:7168
M a[84:87], a[176:179], v[68:71], a[84:87]
v_exp_f32 v125, v125
M a[84:87], a[172:175], v[36:39], a[84:87]
v_cvt_pk_bf16_f32 v110, v124, v125
M a[88:91], a[172:175], v[40:43], a[88:91]
v_exp_f32 v126, v126
M a[88:91], a[176:179], v[72:75], a[88:91]
M a[92:95], a[176:179], v[76:79], a[92:95]
v_exp_f32 v127, v127
M a[92:95], a[172:175], v[44:47], a[92:95]
v_cvt_pk_bf16_f32 v111, v126, v127
s_add_u32 m0, s29, 0
s_nop 0
buffer_load_dwordx4 v1, s[12:15], s25 offen offset:0 sc1 lds
s_add_u32 s32, s25, 4096
buffer_load_dwordx4 v1, s[12:15], s25 offen offset:1024 sc1 lds
buffer_load_dwordx4 v1, s[12:15], s25 offen offset:2048 sc1 lds
buffer_load_dwordx4 v1, s[12:15], s25 offen offset:3072 sc1 lds
s_add_u32 m0, s29, 4096
s_nop 0
buffer_load_dwordx4 v1, s[12:15], s32 offen offset:0 sc1 lds
buffer_load_dwordx4 v1, s[12:15], s32 offen offset:1024 sc1 lds
buffer_load_dwordx4 v1, s[12:15], s32 offen offset:2048 sc1 lds
buffer_load_dwordx4 v1, s[12:15], s32 offen offset:3072 sc1 lds
s_add_u32 m0, s29, 32768
v_exp_f32 v136, v136
s_waitcnt lgkmcnt(7)
ds_read_b128 a[116:119], v6 offset:32768
s_waitcnt lgkmcnt(7)
ds_read_b128 a[120:123], v6 offset:40960
v_exp_f32 v137, v137
buffer_load_dwordx4 v1, s[12:15], s26 offen offset:0 sc1 lds
s_add_u32 s43, s26, 4096
v_exp_f32 v138, v138
v_cvt_pk_bf16_f32 v136, v136, v137
v_exp_f32 v139, v139
buffer_load_dwordx4 v1, s[12:15], s26 offen offset:1024 sc1 lds
s_waitcnt lgkmcnt(7)
ds_read_b128 a[124:127], v6 offset:33792
s_waitcnt lgkmcnt(7)
ds_read_b128 a[128:131], v6 offset:41984
buffer_load_dwordx4 v1, s[12:15], s26 offen offset:2048 sc1 lds
v_cvt_pk_bf16_f32 v137, v138, v139
v_mov_b32 v138, 0
buffer_load_dwordx4 v1, s[12:15], s26 offen offset:3072 sc1 lds
s_add_u32 m0, s29, 36864
v_exp_f32 v140, v140
s_waitcnt lgkmcnt(7)
ds_read_b128 a[132:135], v6 offset:34816
s_waitcnt lgkmcnt(7)
ds_read_b128 a[136:139], v6 offset:43008
v_exp_f32 v141, v141
buffer_load_dwordx4 v1, s[12:15], s43 offen offset:0 sc1 lds
v_exp_f32 v142, v142
v_mov_b32 v139, 0
v_cvt_pk_bf16_f32 v140, v140, v141
v_exp_f32 v143, v143
buffer_load_dwordx4 v1, s[12:15], s43 offen offset:1024 sc1 lds
v_exp_f32 v156, v156
s_waitcnt lgkmcnt(7)
ds_read_b128 a[140:143], v6 offset:35840
s_waitcnt lgkmcnt(7)
ds_read_b128 a[144:147], v6 offset:44032
v_exp_f32 v157, v157
buffer_load_dwordx4 v1, s[12:15], s43 offen offset:2048 sc1 lds
v_exp_f32 v158, v158
v_cvt_pk_bf16_f32 v141, v142, v143
v_cvt_pk_bf16_f32 v142, v156, v157
v_exp_f32 v159, v159
buffer_load_dwordx4 v1, s[12:15], s43 offen offset:3072 sc1 lds
v_cvt_pk_bf16_f32 v143, v158, v159
s_waitcnt lgkmcnt(6)
M v[160:163], a[116:119], v[96:99], v[160:163]
ds_read_b128 a[148:151], v6 offset:36864
ds_read_b128 a[152:155], v6 offset:45056
M v[164:167], a[116:119], v[100:103], v[164:167]
M v[168:171], a[116:119], v[104:107], v[168:171]
M v[168:171], a[120:123], v[136:139], v[168:171]
s_add_u32 s25, s25, 32768
s_cmp_eq_u32 s25, s27
M v[172:175], a[120:123], v[140:143], v[172:175]
M v[172:175], a[116:119], v[108:111], v[172:175]
s_waitcnt lgkmcnt(6)
M a[96:99], a[112:115], v[96:99], a[96:99]
s_cselect_b32 s25, s28, s25
s_cselect_b32 s27, s56, s27
s_cselect_b32 s28, s57, s28
s_cselect_b32 s56, -1, s56
M v[176:179], a[124:127], v[96:99], v[176:179]
ds_read_b128 a[156:159], v6 offset:37888
ds_read_b128 a[160:163], v6 offset:46080
M v[180:183], a[124:127], v[100:103], v[180:183]
M v[184:187], a[124:127], v[104:107], v[184:187]
M v[184:187], a[128:131], v[136:139], v[184:187]
s_add_u32 s26, s26, 32768
s_cmp_eq_u32 s26, s62
M v[188:191], a[128:131], v[140:143], v[188:191]
M v[188:191], a[124:127], v[108:111], v[188:191]
s_waitcnt lgkmcnt(6)
M a[100:103], a[112:115], v[100:103], a[100:103]
s_cselect_b32 s26, s63, s26
s_cselect_b32 s62, s58, s62
s_cselect_b32 s63, s59, s63
s_cselect_b32 s58, -1, s58
M v[192:195], a[132:135], v[96:99], v[192:195]
ds_read_b128 a[164:167], v6 offset:38912
ds_read_b128 a[168:171], v6 offset:47104
M v[196:199], a[132:135], v[100:103], v[196:199]
M v[200:203], a[132:135], v[104:107], v[200:203]
M v[200:203], a[136:139], v[136:139], v[200:203]
s_sub_u32 s33, s42, 1
s_cmp_le_u32 s33, 1
s_cselect_b32 s33, 0x4000, 0
v_add_u32 v3, s33, v3
M v[204:207], a[136:139], v[140:143], v[204:207]
M v[204:207], a[132:135], v[108:111], v[204:207]
s_waitcnt lgkmcnt(6)
M a[104:107], a[112:115], v[104:107], a[104:107]
M a[104:107], a[112:115], v[136:139], a[104:107]
M v[208:211], a[140:143], v[96:99], v[208:211]
ds_read_b128 a[172:175], v6 offset:39936
ds_read_b128 a[176:179], v6 offset:48128
M v[212:215], a[140:143], v[100:103], v[212:215]
M v[216:219], a[140:143], v[104:107], v[216:219]
M v[216:219], a[144:147], v[136:139], v[216:219]
M v[220:223], a[144:147], v[140:143], v[220:223]
M v[220:223], a[140:143], v[108:111], v[220:223]
s_waitcnt lgkmcnt(6)
M a[108:111], a[112:115], v[108:111], a[108:111]
M a[108:111], a[112:115], v[140:143], a[108:111]
M v[224:227], a[148:151], v[96:99], v[224:227]
s_cmp_le_u32 s42, 1
s_cselect_b32 s33, 0x4000, 0
v_add_u32 v6, s33, v6
s_sub_u32 s42, s42, 1
M v[228:231], a[148:151], v[100:103], v[228:231]
M v[232:235], a[148:151], v[104:107], v[232:235]
M v[232:235], a[152:155], v[136:139], v[232:235]
M v[236:239], a[152:155], v[140:143], v[236:239]
M v[236:239], a[148:151], v[108:111], v[236:239]
s_waitcnt lgkmcnt(4)
M v[240:243], a[156:159], v[96:99], v[240:243]
M v[244:247], a[156:159], v[100:103], v[244:247]
M v[248:251], a[156:159], v[104:107], v[248:251]
M v[248:251], a[160:163], v[136:139], v[248:251]
s_waitcnt vmcnt(0) lgkmcnt(0)
s_barrier
ds_read_b128 a[116:119], v2 offset:0
ds_read_b128 a[120:123], v2 offset:1024
M v[252:255], a[160:163], v[140:143], v[252:255]
M v[252:255], a[156:159], v[108:111], v[252:255]
M a[64:67], a[164:167], v[96:99], a[64:67]
ds_read_b128 a[124:127], v2 offset:2048
ds_read_b128 a[128:131], v2 offset:3072
M a[68:71], a[164:167], v[100:103], a[68:71]
M a[72:75], a[164:167], v[104:107], a[72:75]
M a[72:75], a[168:171], v[136:139], a[72:75]
ds_read_b128 a[132:135], v2 offset:4096
ds_read_b128 a[136:139], v2 offset:5120
M a[76:79], a[168:171], v[140:143], a[76:79]
M a[76:79], a[164:167], v[108:111], a[76:79]
M a[80:83], a[172:175], v[96:99], a[80:83]
ds_read_b128 a[140:143], v2 offset:6144
ds_read_b128 a[144:147], v2 offset:7168
M a[84:87], a[172:175], v[100:103], a[84:87]
M a[88:91], a[172:175], v[104:107], a[88:91]
M a[88:91], a[176:179], v[136:139], a[88:91]
M a[92:95], a[176:179], v[140:143], a[92:95]
M a[92:95], a[172:175], v[108:111], a[92:95]
s_and_b32 s3, s2, 3
s_lshl_b32 s3, s3, 2
s_bfe_u32 s27, s2, 0x20003
s_add_u32 s27, s3, s27
s_lshl_b32 s43, s27, 8
s_add_u32 s43, s43, 16789504
v_lshlrev_b32 v15, 2, v0
buffer_load_dword v7, v15, s[52:55], s43 offen sc1
s_lshl_b32 s33, s23, 14
s_add_u32 s34, s33, 131072
s_add_u32 s33, s33, 98304
v_add_u32 v2, s34, v1
v_add_u32 v3, s33, v1
s_mov_b32 s61, 0
s_bfe_u32 s3, s2, 0x10002
s_lshl_b32 s3, s3, 3
s_lshr_b32 s28, s2, 5
s_add_u32 s28, s3, s28
s_lshl_b32 s25, s27, 18
s_lshl_b32 s3, s101, 12
s_add_u32 s25, s25, s3
s_lshl_b32 s26, s28, 7
s_lshl_b32 s42, s101, 11
s_add_u32 s44, s4, 83886080
s_addc_u32 s45, s5, 0
s_mov_b32 s46, 4194304
s_mov_b32 s47, 0x00020000
s_mov_b32 s50, 2097152
s_mov_b32 s51, 0x00020000
s_lshl_b32 s3, s101, 4
v_lshrrev_b32 v96, 3, v0
v_and_b32 v97, 6, v96
ds_write_b128 v2, v[160:163] offset:0
v_and_b32 v98, 7, v0
ds_write_b128 v2, v[164:167] offset:1024
v_xor_b32 v97, v97, v98
ds_write_b128 v2, v[168:171] offset:2048
v_add_u32 v96, s3, v96
ds_write_b128 v2, v[172:175] offset:3072
v_lshlrev_b32 v96, 11, v96
ds_write_b128 v2, v[176:179] offset:4096
v_lshl_add_u32 v99, v97, 4, v96
v_add_u32 v100, 15360, v99
ds_write_b128 v2, v[180:183] offset:5120
s_waitcnt vmcnt(0) lgkmcnt(0)
s_barrier
ds_write_b128 v2, v[184:187] offset:6144
v_cmp_ne_u32 vcc, 1, v7
s_nop 0
s_cbranch_vccnz Lk3_spinb3
Lk3_gotb3:
s_add_u32 m0, s42, 16384
s_nop 0
buffer_load_dwordx4 v99, s[48:51], s26 offen offset:0 lds
ds_write_b128 v2, v[188:191] offset:7168
buffer_load_dwordx4 v100, s[48:51], s26 offen offset:1024 lds
ds_write_b128 v2, v[192:195] offset:8192
buffer_load_dwordx4 a[192:195], v1, s[44:47], s25 offen offset:0 sc1
buffer_load_dwordx4 a[196:199], v1, s[44:47], s25 offen offset:1024 sc1
ds_write_b128 v2, v[196:199] offset:9216
buffer_load_dwordx4 a[200:203], v1, s[44:47], s25 offen offset:2048 sc1
buffer_load_dwordx4 a[204:207], v1, s[44:47], s25 offen offset:3072 sc1
ds_write_b128 v2, v[200:203] offset:10240
s_add_u32 s25, s25, 16384
s_add_u32 s26, s26, 131072
ds_write_b128 v2, v[204:207] offset:11264
s_add_u32 m0, s42, 32768
s_nop 0
buffer_load_dwordx4 v99, s[48:51], s26 offen offset:0 lds
buffer_load_dwordx4 v100, s[48:51], s26 offen offset:1024 lds
ds_write_b128 v2, v[208:211] offset:12288
buffer_load_dwordx4 a[224:227], v1, s[44:47], s25 offen offset:0 sc1
ds_write_b128 v2, v[212:215] offset:13312
buffer_load_dwordx4 a[228:231], v1, s[44:47], s25 offen offset:1024 sc1
buffer_load_dwordx4 a[232:235], v1, s[44:47], s25 offen offset:2048 sc1
ds_write_b128 v2, v[216:219] offset:14336
buffer_load_dwordx4 a[236:239], v1, s[44:47], s25 offen offset:3072 sc1
s_add_u32 s25, s25, 16384
s_add_u32 s26, s26, 131072
ds_write_b128 v2, v[220:223] offset:15360
s_waitcnt lgkmcnt(0)
s_branch Lk2_mg1
Lk2_g1b:
s_add_u32 m0, s29, 65536
s_waitcnt lgkmcnt(4)
M v[96:99], a[116:119], a[0:3], 0
v_exp_f32 v64, v64
M v[96:99], a[120:123], a[4:7], v[96:99]
ds_read_b128 a[148:151], v2 offset:8192
ds_read_b128 a[152:155], v2 offset:9216
M v[96:99], a[124:127], a[8:11], v[96:99]
v_exp_f32 v65, v65
M v[96:99], a[128:131], a[12:15], v[96:99]
buffer_load_dwordx4 v1, s[12:15], s25 offen offset:0 sc1 lds
s_add_u32 s32, s25, 4096
M v[100:103], a[128:131], a[28:31], 0
v_exp_f32 v66, v66
M v[100:103], a[124:127], a[24:27], v[100:103]
v_cvt_pk_bf16_f32 v64, v64, v65
M v[100:103], a[120:123], a[20:23], v[100:103]
v_exp_f32 v67, v67
M v[100:103], a[116:119], a[16:19], v[100:103]
buffer_load_dwordx4 v1, s[12:15], s25 offen offset:1024 sc1 lds
M v[104:107], a[116:119], a[32:35], 0
v_exp_f32 v80, v80
M v[104:107], a[120:123], a[36:39], v[104:107]
ds_read_b128 a[156:159], v2 offset:10240
ds_read_b128 a[160:163], v2 offset:11264
M v[104:107], a[124:127], a[40:43], v[104:107]
v_exp_f32 v81, v81
M v[104:107], a[128:131], a[44:47], v[104:107]
buffer_load_dwordx4 v1, s[12:15], s25 offen offset:2048 sc1 lds
M v[108:111], a[128:131], a[60:63], 0
v_exp_f32 v82, v82
M v[108:111], a[124:127], a[56:59], v[108:111]
v_cvt_pk_bf16_f32 v65, v66, v67
v_cvt_pk_bf16_f32 v66, v80, v81
M v[108:111], a[120:123], a[52:55], v[108:111]
v_exp_f32 v83, v83
M v[108:111], a[116:119], a[48:51], v[108:111]
buffer_load_dwordx4 v1, s[12:15], s25 offen offset:3072 sc1 lds
s_add_u32 m0, s29, 69632
s_waitcnt lgkmcnt(4)
M v[112:115], a[132:135], a[0:3], 0
v_exp_f32 v68, v68
M v[112:115], a[136:139], a[4:7], v[112:115]
ds_read_b128 a[164:167], v2 offset:12288
ds_read_b128 a[168:171], v2 offset:13312
M v[112:115], a[140:143], a[8:11], v[112:115]
v_exp_f32 v69, v69
M v[112:115], a[144:147], a[12:15], v[112:115]
buffer_load_dwordx4 v1, s[12:15], s32 offen offset:0 sc1 lds
M v[116:119], a[144:147], a[28:31], 0
v_exp_f32 v70, v70
M v[116:119], a[140:143], a[24:27], v[116:119]
v_cvt_pk_bf16_f32 v67, v82, v83
v_cvt_pk_bf16_f32 v68, v68, v69
M v[116:119], a[136:139], a[20:23], v[116:119]
v_exp_f32 v71, v71
M v[116:119], a[132:135], a[16:19], v[116:119]
buffer_load_dwordx4 v1, s[12:15], s32 offen offset:1024 sc1 lds
M v[120:123], a[132:135], a[32:35], 0
v_exp_f32 v84, v84
M v[120:123], a[136:139], a[36:39], v[120:123]
ds_read_b128 a[172:175], v2 offset:14336
ds_read_b128 a[176:179], v2 offset:15360
M v[120:123], a[140:143], a[40:43], v[120:123]
v_exp_f32 v85, v85
M v[120:123], a[144:147], a[44:47], v[120:123]
buffer_load_dwordx4 v1, s[12:15], s32 offen offset:2048 sc1 lds
M v[124:127], a[144:147], a[60:63], 0
v_exp_f32 v86, v86
M v[124:127], a[140:143], a[56:59], v[124:127]
v_cvt_pk_bf16_f32 v69, v70, v71
v_cvt_pk_bf16_f32 v70, v84, v85
M v[124:127], a[136:139], a[52:55], v[124:127]
v_exp_f32 v87, v87
M v[124:127], a[132:135], a[48:51], v[124:127]
buffer_load_dwordx4 v1, s[12:15], s32 offen offset:3072 sc1 lds
s_add_u32 m0, s29, 98304
s_waitcnt lgkmcnt(4)
M v[128:131], a[148:151], a[0:3], 0
v_exp_f32 v72, v72
M v[128:131], a[152:155], a[4:7], v[128:131]
ds_read_b128 a[116:119], v5 offset:32768
ds_read_b128 a[120:123], v5 offset:40960
M v[128:131], a[156:159], a[8:11], v[128:131]
v_exp_f32 v73, v73
M v[128:131], a[160:163], a[12:15], v[128:131]
buffer_load_dwordx4 v1, s[12:15], s26 offen offset:0 sc1 lds
s_add_u32 s43, s26, 4096
M v[132:135], a[160:163], a[28:31], 0
v_exp_f32 v74, v74
M v[132:135], a[156:159], a[24:27], v[132:135]
v_cvt_pk_bf16_f32 v71, v86, v87
v_cvt_pk_bf16_f32 v72, v72, v73
M v[132:135], a[152:155], a[20:23], v[132:135]
v_exp_f32 v75, v75
M v[132:135], a[148:151], a[16:19], v[132:135]
buffer_load_dwordx4 v1, s[12:15], s26 offen offset:1024 sc1 lds
M v[136:139], a[148:151], a[32:35], 0
v_exp_f32 v88, v88
M v[136:139], a[152:155], a[36:39], v[136:139]
ds_read_b128 a[124:127], v5 offset:33792
ds_read_b128 a[128:131], v5 offset:41984
M v[136:139], a[156:159], a[40:43], v[136:139]
v_exp_f32 v89, v89
M v[136:139], a[160:163], a[44:47], v[136:139]
buffer_load_dwordx4 v1, s[12:15], s26 offen offset:2048 sc1 lds
M v[140:143], a[160:163], a[60:63], 0
v_exp_f32 v90, v90
M v[140:143], a[156:159], a[56:59], v[140:143]
v_cvt_pk_bf16_f32 v73, v74, v75
v_cvt_pk_bf16_f32 v74, v88, v89
M v[140:143], a[152:155], a[52:55], v[140:143]
v_exp_f32 v91, v91
M v[140:143], a[148:151], a[48:51], v[140:143]
buffer_load_dwordx4 v1, s[12:15], s26 offen offset:3072 sc1 lds
s_add_u32 m0, s29, 102400
s_waitcnt lgkmcnt(4)
M v[144:147], a[164:167], a[0:3], 0
v_exp_f32 v76, v76
M v[144:147], a[168:171], a[4:7], v[144:147]
ds_read_b128 a[132:135], v5 offset:34816
ds_read_b128 a[136:139], v5 offset:43008
M v[144:147], a[172:175], a[8:11], v[144:147]
v_exp_f32 v77, v77
M v[144:147], a[176:179], a[12:15], v[144:147]
buffer_load_dwordx4 v1, s[12:15], s43 offen offset:0 sc1 lds
M v[148:151], a[176:179], a[28:31], 0
v_exp_f32 v78, v78
M v[148:151], a[172:175], a[24:27], v[148:151]
v_cvt_pk_bf16_f32 v75, v90, v91
v_cvt_pk_bf16_f32 v76, v76, v77
M v[148:151], a[168:171], a[20:23], v[148:151]
v_exp_f32 v79, v79
M v[148:151], a[164:167], a[16:19], v[148:151]
buffer_load_dwordx4 v1, s[12:15], s43 offen offset:1024 sc1 lds
M v[152:155], a[164:167], a[32:35], 0
v_exp_f32 v92, v92
M v[152:155], a[168:171], a[36:39], v[152:155]
ds_read_b128 a[140:143], v5 offset:35840
ds_read_b128 a[144:147], v5 offset:44032
M v[152:155], a[172:175], a[40:43], v[152:155]
v_exp_f32 v93, v93
M v[152:155], a[176:179], a[44:47], v[152:155]
buffer_load_dwordx4 v1, s[12:15], s43 offen offset:2048 sc1 lds
M v[156:159], a[176:179], a[60:63], 0
v_exp_f32 v94, v94
M v[156:159], a[172:175], a[56:59], v[156:159]
v_cvt_pk_bf16_f32 v77, v78, v79
v_cvt_pk_bf16_f32 v78, v92, v93
M v[156:159], a[168:171], a[52:55], v[156:159]
v_exp_f32 v95, v95
M v[156:159], a[164:167], a[48:51], v[156:159]
buffer_load_dwordx4 v1, s[12:15], s43 offen offset:3072 sc1 lds
v_cvt_pk_bf16_f32 v79, v94, v95
s_waitcnt lgkmcnt(6)
M v[160:163], a[116:119], v[32:35], v[160:163]
v_exp_f32 v96, v96
M v[160:163], a[120:123], v[64:67], v[160:163]
ds_read_b128 a[148:151], v5 offset:36864
ds_read_b128 a[152:155], v5 offset:45056
M v[164:167], a[120:123], v[68:71], v[164:167]
v_exp_f32 v97, v97
M v[164:167], a[116:119], v[36:39], v[164:167]
v_cvt_pk_bf16_f32 v96, v96, v97
M v[168:171], a[116:119], v[40:43], v[168:171]
v_exp_f32 v98, v98
M v[168:171], a[120:123], v[72:75], v[168:171]
s_add_u32 s25, s25, 32768
s_cmp_eq_u32 s25, s27
M v[172:175], a[120:123], v[76:79], v[172:175]
v_exp_f32 v99, v99
M v[172:175], a[116:119], v[44:47], v[172:175]
v_cvt_pk_bf16_f32 v97, v98, v99
s_waitcnt lgkmcnt(6)
M a[96:99], a[112:115], v[32:35], a[96:99]
s_cselect_b32 s25, s28, s25
s_cselect_b32 s27, s56, s27
M a[96:99], a[112:115], v[64:67], a[96:99]
s_cselect_b32 s28, s57, s28
s_cselect_b32 s56, -1, s56
M v[176:179], a[124:127], v[32:35], v[176:179]
v_exp_f32 v112, v112
M v[176:179], a[128:131], v[64:67], v[176:179]
ds_read_b128 a[156:159], v5 offset:37888
ds_read_b128 a[160:163], v5 offset:46080
M v[180:183], a[128:131], v[68:71], v[180:183]
v_exp_f32 v113, v113
M v[180:183], a[124:127], v[36:39], v[180:183]
v_cvt_pk_bf16_f32 v98, v112, v113
M v[184:187], a[124:127], v[40:43], v[184:187]
v_exp_f32 v114, v114
M v[184:187], a[128:131], v[72:75], v[184:187]
s_add_u32 s26, s26, 32768
s_cmp_eq_u32 s26, s62
M v[188:191], a[128:131], v[76:79], v[188:191]
v_exp_f32 v115, v115
M v[188:191], a[124:127], v[44:47], v[188:191]
v_cvt_pk_bf16_f32 v99, v114, v115
s_waitcnt lgkmcnt(6)
M a[100:103], a[112:115], v[36:39], a[100:103]
s_cselect_b32 s26, s63, s26
s_cselect_b32 s62, s58, s62
M a[100:103], a[112:115], v[68:71], a[100:103]
s_cselect_b32 s63, s59, s63
s_cselect_b32 s58, -1, s58
M v[192:195], a[132:135], v[32:35], v[192:195]
v_exp_f32 v100, v100
M v[192:195], a[136:139], v[64:67], v[192:195]
ds_read_b128 a[164:167], v5 offset:38912
ds_read_b128 a[168:171], v5 offset:47104
M v[196:199], a[136:139], v[68:71], v[196:199]
v_exp_f32 v101, v101
M v[196:199], a[132:135], v[36:39], v[196:199]
v_cvt_pk_bf16_f32 v100, v100, v101
M v[200:203], a[132:135], v[40:43], v[200:203]
v_exp_f32 v102, v102
M v[200:203], a[136:139], v[72:75], v[200:203]
s_sub_u32 s33, s42, 1
s_cmp_le_u32 s33, 1
s_cselect_b32 s33, 0x4000, 0
v_add_u32 v2, s33, v2
M v[204:207], a[136:139], v[76:79], v[204:207]
v_exp_f32 v103, v103
M v[204:207], a[132:135], v[44:47], v[204:207]
v_cvt_pk_bf16_f32 v101, v102, v103
s_waitcnt lgkmcnt(6)
M a[104:107], a[112:115], v[40:43], a[104:107]
M a[104:107], a[112:115], v[72:75], a[104:107]
M v[208:211], a[140:143], v[32:35], v[208:211]
v_exp_f32 v116, v116
M v[208:211], a[144:147], v[64:67], v[208:211]
ds_read_b128 a[172:175], v5 offset:39936
ds_read_b128 a[176:179], v5 offset:48128
M v[212:215], a[144:147], v[68:71], v[212:215]
v_exp_f32 v117, v117
M v[212:215], a[140:143], v[36:39], v[212:215]
v_cvt_pk_bf16_f32 v102, v116, v117
M v[216:219], a[140:143], v[40:43], v[216:219]
v_exp_f32 v118, v118
M v[216:219], a[144:147], v[72:75], v[216:219]
M v[220:223], a[144:147], v[76:79], v[220:223]
v_exp_f32 v119, v119
M v[220:223], a[140:143], v[44:47], v[220:223]
v_cvt_pk_bf16_f32 v103, v118, v119
s_waitcnt lgkmcnt(6)
M a[108:111], a[112:115], v[44:47], a[108:111]
M a[108:111], a[112:115], v[76:79], a[108:111]
M v[224:227], a[148:151], v[32:35], v[224:227]
v_exp_f32 v104, v104
M v[224:227], a[152:155], v[64:67], v[224:227]
s_cmp_le_u32 s42, 1
s_cselect_b32 s33, 0x4000, 0
v_add_u32 v5, s33, v5
s_sub_u32 s42, s42, 1
M v[228:231], a[152:155], v[68:71], v[228:231]
v_exp_f32 v105, v105
M v[228:231], a[148:151], v[36:39], v[228:231]
v_cvt_pk_bf16_f32 v104, v104, v105
M v[232:235], a[148:151], v[40:43], v[232:235]
v_exp_f32 v106, v106
M v[232:235], a[152:155], v[72:75], v[232:235]
M v[236:239], a[152:155], v[76:79], v[236:239]
v_exp_f32 v107, v107
M v[236:239], a[148:151], v[44:47], v[236:239]
v_cvt_pk_bf16_f32 v105, v106, v107
s_waitcnt lgkmcnt(4)
M v[240:243], a[156:159], v[32:35], v[240:243]
v_exp_f32 v120, v120
M v[240:243], a[160:163], v[64:67], v[240:243]
M v[244:247], a[160:163], v[68:71], v[244:247]
v_exp_f32 v121, v121
M v[244:247], a[156:159], v[36:39], v[244:247]
v_cvt_pk_bf16_f32 v106, v120, v121
M v[248:251], a[156:159], v[40:43], v[248:251]
v_exp_f32 v122, v122
M v[248:251], a[160:163], v[72:75], v[248:251]
s_waitcnt vmcnt(0) lgkmcnt(0)
s_barrier
ds_read_b128 a[116:119], v3 offset:0
ds_read_b128 a[120:123], v3 offset:1024
M v[252:255], a[160:163], v[76:79], v[252:255]
v_exp_f32 v123, v123
M v[252:255], a[156:159], v[44:47], v[252:255]
v_cvt_pk_bf16_f32 v107, v122, v123
M a[64:67], a[164:167], v[32:35], a[64:67]
v_exp_f32 v108, v108
M a[64:67], a[168:171], v[64:67], a[64:67]
ds_read_b128 a[124:127], v3 offset:2048
ds_read_b128 a[128:131], v3 offset:3072
M a[68:71], a[168:171], v[68:71], a[68:71]
v_exp_f32 v109, v109
M a[68:71], a[164:167], v[36:39], a[68:71]
v_cvt_pk_bf16_f32 v108, v108, v109
M a[72:75], a[164:167], v[40:43], a[72:75]
v_exp_f32 v110, v110
M a[72:75], a[168:171], v[72:75], a[72:75]
ds_read_b128 a[132:135], v3 offset:4096
ds_read_b128 a[136:139], v3 offset:5120
M a[76:79], a[168:171], v[76:79], a[76:79]
v_exp_f32 v111, v111
M a[76:79], a[164:167], v[44:47], a[76:79]
v_cvt_pk_bf16_f32 v109, v110, v111
M a[80:83], a[172:175], v[32:35], a[80:83]
v_exp_f32 v124, v124
M a[80:83], a[176:179], v[64:67], a[80:83]
ds_read_b128 a[140:143], v3 offset:6144
ds_read_b128 a[144:147], v3 offset:7168
M a[84:87], a[176:179], v[68:71], a[84:87]
v_exp_f32 v125, v125
M a[84:87], a[172:175], v[36:39], a[84:87]
v_cvt_pk_bf16_f32 v110, v124, v125
M a[88:91], a[172:175], v[40:43], a[88:91]
v_exp_f32 v126, v126
M a[88:91], a[176:179], v[72:75], a[88:91]
M a[92:95], a[176:179], v[76:79], a[92:95]
v_exp_f32 v127, v127
M a[92:95], a[172:175], v[44:47], a[92:95]
v_cvt_pk_bf16_f32 v111, v126, v127
s_add_u32 m0, s29, 0
s_waitcnt lgkmcnt(4)
M v[32:35], a[116:119], a[0:3], v[16:19]
v_exp_f32 v128, v128
M v[32:35], a[120:123], a[4:7], v[32:35]
ds_read_b128 a[148:151], v3 offset:8192
ds_read_b128 a[152:155], v3 offset:9216
M v[32:35], a[124:127], a[8:11], v[32:35]
v_exp_f32 v129, v129
M v[32:35], a[128:131], a[12:15], v[32:35]
buffer_load_dwordx4 v1, s[12:15], s25 offen offset:0 sc1 lds
s_add_u32 s32, s25, 4096
M v[36:39], a[128:131], a[28:31], 0
v_exp_f32 v130, v130
M v[36:39], a[124:127], a[24:27], v[36:39]
v_cvt_pk_bf16_f32 v128, v128, v129
M v[36:39], a[120:123], a[20:23], v[36:39]
v_exp_f32 v131, v131
M v[36:39], a[116:119], a[16:19], v[36:39]
buffer_load_dwordx4 v1, s[12:15], s25 offen offset:1024 sc1 lds
M v[40:43], a[116:119], a[32:35], 0
v_exp_f32 v144, v144
M v[40:43], a[120:123], a[36:39], v[40:43]
ds_read_b128 a[156:159], v3 offset:10240
ds_read_b128 a[160:163], v3 offset:11264
M v[40:43], a[124:127], a[40:43], v[40:43]
v_exp_f32 v145, v145
M v[40:43], a[128:131], a[44:47], v[40:43]
buffer_load_dwordx4 v1, s[12:15], s25 offen offset:2048 sc1 lds
M v[44:47], a[128:131], a[60:63], 0
v_exp_f32 v146, v146
M v[44:47], a[124:127], a[56:59], v[44:47]
v_cvt_pk_bf16_f32 v129, v130, v131
v_cvt_pk_bf16_f32 v130, v144, v145
M v[44:47], a[120:123], a[52:55], v[44:47]
v_exp_f32 v147, v147
M v[44:47], a[116:119], a[48:51], v[44:47]
buffer_load_dwordx4 v1, s[12:15], s25 offen offset:3072 sc1 lds
s_add_u32 m0, s29, 4096
s_waitcnt lgkmcnt(4)
v_exp_f32 v132, v132
ds_read_b128 a[164:167], v3 offset:12288
ds_read_b128 a[168:171], v3 offset:13312
v_exp_f32 v133, v133
buffer_load_dwordx4 v1, s[12:15], s32 offen offset:0 sc1 lds
M v[52:55], a[144:147], a[28:31], v[16:19]
v_exp_f32 v134, v134
M v[52:55], a[140:143], a[24:27], v[52:55]
v_cvt_pk_bf16_f32 v131, v146, v147
v_cvt_pk_bf16_f32 v132, v132, v133
M v[52:55], a[136:139], a[20:23], v[52:55]
v_exp_f32 v135, v135
M v[52:55], a[132:135], a[16:19], v[52:55]
buffer_load_dwordx4 v1, s[12:15], s32 offen offset:1024 sc1 lds
M v[56:59], a[132:135], a[32:35], 0
v_exp_f32 v148, v148
M v[56:59], a[136:139], a[36:39], v[56:59]
ds_read_b128 a[172:175], v3 offset:14336
ds_read_b128 a[176:179], v3 offset:15360
M v[56:59], a[140:143], a[40:43], v[56:59]
v_exp_f32 v149, v149
M v[56:59], a[144:147], a[44:47], v[56:59]
buffer_load_dwordx4 v1, s[12:15], s32 offen offset:2048 sc1 lds
M v[60:63], a[144:147], a[60:63], 0
v_exp_f32 v150, v150
M v[60:63], a[140:143], a[56:59], v[60:63]
v_cvt_pk_bf16_f32 v133, v134, v135
v_cvt_pk_bf16_f32 v134, v148, v149
M v[60:63], a[136:139], a[52:55], v[60:63]
v_exp_f32 v151, v151
M v[60:63], a[132:135], a[48:51], v[60:63]
buffer_load_dwordx4 v1, s[12:15], s32 offen offset:3072 sc1 lds
s_add_u32 m0, s29, 32768
s_waitcnt lgkmcnt(4)
v_exp_f32 v136, v136
ds_read_b128 a[116:119], v6 offset:32768
ds_read_b128 a[120:123], v6 offset:40960
v_exp_f32 v137, v137
buffer_load_dwordx4 v1, s[12:15], s26 offen offset:0 sc1 lds
s_add_u32 s43, s26, 4096
v_exp_f32 v138, v138
v_cvt_pk_bf16_f32 v135, v150, v151
v_cvt_pk_bf16_f32 v136, v136, v137
v_exp_f32 v139, v139
buffer_load_dwordx4 v1, s[12:15], s26 offen offset:1024 sc1 lds
M v[72:75], a[148:151], a[32:35], v[16:19]
v_exp_f32 v152, v152
M v[72:75], a[152:155], a[36:39], v[72:75]
ds_read_b128 a[124:127], v6 offset:33792
ds_read_b128 a[128:131], v6 offset:41984
M v[72:75], a[156:159], a[40:43], v[72:75]
v_exp_f32 v153, v153
M v[72:75], a[160:163], a[44:47], v[72:75]
buffer_load_dwordx4 v1, s[12:15], s26 offen offset:2048 sc1 lds
M v[76:79], a[160:163], a[60:63], 0
v_exp_f32 v154, v154
M v[76:79], a[156:159], a[56:59], v[76:79]
v_cvt_pk_bf16_f32 v137, v138, v139
v_cvt_pk_bf16_f32 v138, v152, v153
M v[76:79], a[152:155], a[52:55], v[76:79]
v_exp_f32 v155, v155
M v[76:79], a[148:151], a[48:51], v[76:79]
buffer_load_dwordx4 v1, s[12:15], s26 offen offset:3072 sc1 lds
s_add_u32 m0, s29, 36864
s_waitcnt lgkmcnt(4)
v_exp_f32 v140, v140
ds_read_b128 a[132:135], v6 offset:34816
ds_read_b128 a[136:139], v6 offset:43008
v_exp_f32 v141, v141
buffer_load_dwordx4 v1, s[12:15], s43 offen offset:0 sc1 lds
v_exp_f32 v142, v142
v_cvt_pk_bf16_f32 v139, v154, v155
v_cvt_pk_bf16_f32 v140, v140, v141
v_exp_f32 v143, v143
buffer_load_dwordx4 v1, s[12:15], s43 offen offset:1024 sc1 lds
v_exp_f32 v156, v156
ds_read_b128 a[140:143], v6 offset:35840
ds_read_b128 a[144:147], v6 offset:44032
v_exp_f32 v157, v157
buffer_load_dwordx4 v1, s[12:15], s43 offen offset:2048 sc1 lds
M v[92:95], a[176:179], a[60:63], v[16:19]
v_exp_f32 v158, v158
M v[92:95], a[172:175], a[56:59], v[92:95]
v_cvt_pk_bf16_f32 v141, v142, v143
v_cvt_pk_bf16_f32 v142, v156, v157
M v[92:95], a[168:171], a[52:55], v[92:95]
v_exp_f32 v159, v159
M v[92:95], a[164:167], a[48:51], v[92:95]
buffer_load_dwordx4 v1, s[12:15], s43 offen offset:3072 sc1 lds
v_cvt_pk_bf16_f32 v143, v158, v159
s_waitcnt lgkmcnt(6)
M v[160:163], a[116:119], v[96:99], v[160:163]
v_exp_f32 v32, v32
M v[160:163], a[120:123], v[128:131], v[160:163]
ds_read_b128 a[148:151], v6 offset:36864
ds_read_b128 a[152:155], v6 offset:45056
M v[164:167], a[120:123], v[132:135], v[164:167]
v_exp_f32 v33, v33
M v[164:167], a[116:119], v[100:103], v[164:167]
v_cvt_pk_bf16_f32 v32, v32, v33
M v[168:171], a[116:119], v[104:107], v[168:171]
v_exp_f32 v34, v34
M v[168:171], a[120:123], v[136:139], v[168:171]
s_add_u32 s25, s25, 32768
s_cmp_eq_u32 s25, s27
M v[172:175], a[120:123], v[140:143], v[172:175]
v_exp_f32 v35, v35
M v[172:175], a[116:119], v[108:111], v[172:175]
v_cvt_pk_bf16_f32 v33, v34, v35
s_waitcnt lgkmcnt(6)
M a[96:99], a[112:115], v[96:99], a[96:99]
s_cselect_b32 s25, s28, s25
s_cselect_b32 s27, s56, s27
M a[96:99], a[112:115], v[128:131], a[96:99]
s_cselect_b32 s28, s57, s28
s_cselect_b32 s56, -1, s56
M v[176:179], a[124:127], v[96:99], v[176:179]
M v[176:179], a[128:131], v[128:131], v[176:179]
ds_read_b128 a[156:159], v6 offset:37888
ds_read_b128 a[160:163], v6 offset:46080
M v[180:183], a[128:131], v[132:135], v[180:183]
M v[180:183], a[124:127], v[100:103], v[180:183]
v_mov_b32 v34, 0
M v[184:187], a[124:127], v[104:107], v[184:187]
M v[184:187], a[128:131], v[136:139], v[184:187]
s_add_u32 s26, s26, 32768
s_cmp_eq_u32 s26, s62
M v[188:191], a[128:131], v[140:143], v[188:191]
M v[188:191], a[124:127], v[108:111], v[188:191]
v_mov_b32 v35, 0
s_waitcnt lgkmcnt(6)
M a[100:103], a[112:115], v[100:103], a[100:103]
s_cselect_b32 s26, s63, s26
s_cselect_b32 s62, s58, s62
M a[100:103], a[112:115], v[132:135], a[100:103]
s_cselect_b32 s63, s59, s63
s_cselect_b32 s58, -1, s58
M v[192:195], a[132:135], v[96:99], v[192:195]
v_exp_f32 v36, v36
M v[192:195], a[136:139], v[128:131], v[192:195]
ds_read_b128 a[164:167], v6 offset:38912
ds_read_b128 a[168:171], v6 offset:47104
M v[196:199], a[136:139], v[132:135], v[196:199]
v_exp_f32 v37, v37
M v[196:199], a[132:135], v[100:103], v[196:199]
v_cvt_pk_bf16_f32 v36, v36, v37
M v[200:203], a[132:135], v[104:107], v[200:203]
v_exp_f32 v38, v38
M v[200:203], a[136:139], v[136:139], v[200:203]
s_sub_u32 s33, s42, 1
s_cmp_le_u32 s33, 1
s_cselect_b32 s33, 0x4000, 0
v_add_u32 v3, s33, v3
M v[204:207], a[136:139], v[140:143], v[204:207]
v_exp_f32 v39, v39
M v[204:207], a[132:135], v[108:111], v[204:207]
v_cvt_pk_bf16_f32 v37, v38, v39
s_waitcnt lgkmcnt(6)
M a[104:107], a[112:115], v[104:107], a[104:107]
M a[104:107], a[112:115], v[136:139], a[104:107]
M v[208:211], a[140:143], v[96:99], v[208:211]
v_exp_f32 v52, v52
M v[208:211], a[144:147], v[128:131], v[208:211]
ds_read_b128 a[172:175], v6 offset:39936
ds_read_b128 a[176:179], v6 offset:48128
M v[212:215], a[144:147], v[132:135], v[212:215]
v_exp_f32 v53, v53
M v[212:215], a[140:143], v[100:103], v[212:215]
v_cvt_pk_bf16_f32 v38, v52, v53
M v[216:219], a[140:143], v[104:107], v[216:219]
v_exp_f32 v54, v54
M v[216:219], a[144:147], v[136:139], v[216:219]
M v[220:223], a[144:147], v[140:143], v[220:223]
v_exp_f32 v55, v55
M v[220:223], a[140:143], v[108:111], v[220:223]
v_cvt_pk_bf16_f32 v39, v54, v55
s_waitcnt lgkmcnt(6)
M a[108:111], a[112:115], v[108:111], a[108:111]
M a[108:111], a[112:115], v[140:143], a[108:111]
M v[224:227], a[148:151], v[96:99], v[224:227]
v_exp_f32 v40, v40
M v[224:227], a[152:155], v[128:131], v[224:227]
s_cmp_le_u32 s42, 1
s_cselect_b32 s33, 0x4000, 0
v_add_u32 v6, s33, v6
s_sub_u32 s42, s42, 1
M v[228:231], a[152:155], v[132:135], v[228:231]
v_exp_f32 v41, v41
M v[228:231], a[148:151], v[100:103], v[228:231]
v_cvt_pk_bf16_f32 v40, v40, v41
M v[232:235], a[148:151], v[104:107], v[232:235]
v_exp_f32 v42, v42
M v[232:235], a[152:155], v[136:139], v[232:235]
M v[236:239], a[152:155], v[140:143], v[236:239]
v_exp_f32 v43, v43
M v[236:239], a[148:151], v[108:111], v[236:239]
v_cvt_pk_bf16_f32 v41, v42, v43
s_waitcnt lgkmcnt(4)
M v[240:243], a[156:159], v[96:99], v[240:243]
v_exp_f32 v56, v56
M v[240:243], a[160:163], v[128:131], v[240:243]
M v[244:247], a[160:163], v[132:135], v[244:247]
v_exp_f32 v57, v57
M v[244:247], a[156:159], v[100:103], v[244:247]
v_cvt_pk_bf16_f32 v42, v56, v57
M v[248:251], a[156:159], v[104:107], v[248:251]
v_exp_f32 v58, v58
M v[248:251], a[160:163], v[136:139], v[248:251]
s_waitcnt vmcnt(0) lgkmcnt(0)
s_barrier
ds_read_b128 a[116:119], v2 offset:0
ds_read_b128 a[120:123], v2 offset:1024
M v[252:255], a[160:163], v[140:143], v[252:255]
v_exp_f32 v59, v59
M v[252:255], a[156:159], v[108:111], v[252:255]
v_cvt_pk_bf16_f32 v43, v58, v59
M a[64:67], a[164:167], v[96:99], a[64:67]
v_exp_f32 v44, v44
M a[64:67], a[168:171], v[128:131], a[64:67]
ds_read_b128 a[124:127], v2 offset:2048
ds_read_b128 a[128:131], v2 offset:3072
M a[68:71], a[168:171], v[132:135], a[68:71]
v_exp_f32 v45, v45
M a[68:71], a[164:167], v[100:103], a[68:71]
v_cvt_pk_bf16_f32 v44, v44, v45
M a[72:75], a[164:167], v[104:107], a[72:75]
v_exp_f32 v46, v46
M a[72:75], a[168:171], v[136:139], a[72:75]
ds_read_b128 a[132:135], v2 offset:4096
ds_read_b128 a[136:139], v2 offset:5120
M a[76:79], a[168:171], v[140:143], a[76:79]
v_exp_f32 v47, v47
M a[76:79], a[164:167], v[108:111], a[76:79]
v_cvt_pk_bf16_f32 v45, v46, v47
M a[80:83], a[172:175], v[96:99], a[80:83]
v_exp_f32 v60, v60
M a[80:83], a[176:179], v[128:131], a[80:83]
ds_read_b128 a[140:143], v2 offset:6144
ds_read_b128 a[144:147], v2 offset:7168
M a[84:87], a[176:179], v[132:135], a[84:87]
v_exp_f32 v61, v61
M a[84:87], a[172:175], v[100:103], a[84:87]
v_cvt_pk_bf16_f32 v46, v60, v61
M a[88:91], a[172:175], v[104:107], a[88:91]
v_exp_f32 v62, v62
M a[88:91], a[176:179], v[136:139], a[88:91]
M a[92:95], a[176:179], v[140:143], a[92:95]
v_exp_f32 v63, v63
M a[92:95], a[172:175], v[108:111], a[92:95]
v_cvt_pk_bf16_f32 v47, v62, v63
s_and_b32 s3, s2, 3
s_lshl_b32 s3, s3, 2
s_bfe_u32 s27, s2, 0x20003
s_add_u32 s27, s3, s27
s_lshl_b32 s43, s27, 8
s_add_u32 s43, s43, 16789504
v_lshlrev_b32 v15, 2, v0
buffer_load_dword v7, v15, s[52:55], s43 offen sc1
s_waitcnt lgkmcnt(7)
ds_read_b128 a[116:119], v5 offset:32768
s_waitcnt lgkmcnt(7)
ds_read_b128 a[120:123], v5 offset:40960
s_waitcnt lgkmcnt(7)
ds_read_b128 a[124:127], v5 offset:33792
s_waitcnt lgkmcnt(7)
ds_read_b128 a[128:131], v5 offset:41984
s_waitcnt lgkmcnt(7)
ds_read_b128 a[132:135], v5 offset:34816
s_waitcnt lgkmcnt(7)
ds_read_b128 a[136:139], v5 offset:43008
s_waitcnt lgkmcnt(7)
ds_read_b128 a[140:143], v5 offset:35840
s_waitcnt lgkmcnt(7)
ds_read_b128 a[144:147], v5 offset:44032
s_lshl_b32 s33, s23, 14
s_add_u32 s34, s33, 131072
s_add_u32 s33, s33, 98304
v_add_u32 v2, s34, v1
v_add_u32 v3, s33, v1
v_exp_f32 v72, v72
v_exp_f32 v73, v73
v_exp_f32 v74, v74
v_exp_f32 v75, v75
v_cvt_pk_bf16_f32 v72, v72, v73
v_cvt_pk_bf16_f32 v73, v74, v75
v_exp_f32 v76, v76
v_exp_f32 v77, v77
v_exp_f32 v78, v78
v_exp_f32 v79, v79
v_mov_b32 v74, 0
v_mov_b32 v75, 0
v_exp_f32 v92, v92
v_exp_f32 v93, v93
v_exp_f32 v94, v94
v_exp_f32 v95, v95
v_cvt_pk_bf16_f32 v76, v76, v77
v_cvt_pk_bf16_f32 v77, v78, v79
v_cvt_pk_bf16_f32 v78, v92, v93
v_cvt_pk_bf16_f32 v79, v94, v95
s_waitcnt lgkmcnt(6)
M v[160:163], a[116:119], v[32:35], v[160:163]
ds_read_b128 a[148:151], v5 offset:36864
ds_read_b128 a[152:155], v5 offset:45056
s_mov_b32 s61, 0
M v[164:167], a[116:119], v[36:39], v[164:167]
s_bfe_u32 s3, s2, 0x10002
M v[168:171], a[116:119], v[40:43], v[168:171]
M v[168:171], a[120:123], v[72:75], v[168:171]
s_lshl_b32 s3, s3, 3
M v[172:175], a[120:123], v[76:79], v[172:175]
M v[172:175], a[116:119], v[44:47], v[172:175]
s_waitcnt lgkmcnt(6)
s_lshr_b32 s28, s2, 5
M a[96:99], a[112:115], v[32:35], a[96:99]
M v[176:179], a[124:127], v[32:35], v[176:179]
ds_read_b128 a[156:159], v5 offset:37888
ds_read_b128 a[160:163], v5 offset:46080
s_add_u32 s28, s3, s28
s_lshl_b32 s25, s27, 18
M v[180:183], a[124:127], v[36:39], v[180:183]
M v[184:187], a[124:127], v[40:43], v[184:187]
s_lshl_b32 s3, s101, 12
M v[184:187], a[128:131], v[72:75], v[184:187]
M v[188:191], a[128:131], v[76:79], v[188:191]
s_add_u32 s25, s25, s3
M v[188:191], a[124:127], v[44:47], v[188:191]
s_waitcnt lgkmcnt(6)
M a[100:103], a[112:115], v[36:39], a[100:103]
M v[192:195], a[132:135], v[32:35], v[192:195]
s_lshl_b32 s26, s28, 7
ds_read_b128 a[164:167], v5 offset:38912
ds_read_b128 a[168:171], v5 offset:47104
s_lshl_b32 s42, s101, 11
M v[196:199], a[132:135], v[36:39], v[196:199]
M v[200:203], a[132:135], v[40:43], v[200:203]
s_add_u32 s44, s4, 83886080
s_addc_u32 s45, s5, 0
M v[200:203], a[136:139], v[72:75], v[200:203]
s_mov_b32 s46, 4194304
M v[204:207], a[136:139], v[76:79], v[204:207]
M v[204:207], a[132:135], v[44:47], v[204:207]
s_waitcnt lgkmcnt(6)
s_mov_b32 s47, 0x00020000
M a[104:107], a[112:115], v[40:43], a[104:107]
M a[104:107], a[112:115], v[72:75], a[104:107]
M v[208:211], a[140:143], v[32:35], v[208:211]
ds_read_b128 a[172:175], v5 offset:39936
ds_read_b128 a[176:179], v5 offset:48128
s_mov_b32 s50, 2097152
M v[212:215], a[140:143], v[36:39], v[212:215]
s_mov_b32 s51, 0x00020000
M v[216:219], a[140:143], v[40:43], v[216:219]
M v[216:219], a[144:147], v[72:75], v[216:219]
s_lshl_b32 s3, s101, 4
M v[220:223], a[144:147], v[76:79], v[220:223]
M v[220:223], a[140:143], v[44:47], v[220:223]
s_waitcnt lgkmcnt(6)
v_lshrrev_b32 v96, 3, v0
M a[108:111], a[112:115], v[44:47], a[108:111]
M a[108:111], a[112:115], v[76:79], a[108:111]
M v[224:227], a[148:151], v[32:35], v[224:227]
v_and_b32 v97, 6, v96
ds_write_b128 v2, v[160:163] offset:0
v_and_b32 v98, 7, v0
M v[228:231], a[148:151], v[36:39], v[228:231]
M v[232:235], a[148:151], v[40:43], v[232:235]
ds_write_b128 v2, v[164:167] offset:1024
v_xor_b32 v97, v97, v98
M v[232:235], a[152:155], v[72:75], v[232:235]
M v[236:239], a[152:155], v[76:79], v[236:239]
ds_write_b128 v2, v[168:171] offset:2048
v_add_u32 v96, s3, v96
M v[236:239], a[148:151], v[44:47], v[236:239]
s_waitcnt lgkmcnt(7)
M v[240:243], a[156:159], v[32:35], v[240:243]
ds_write_b128 v2, v[172:175] offset:3072
v_lshlrev_b32 v96, 11, v96
ds_write_b128 v2, v[176:179] offset:4096
v_lshl_add_u32 v99, v97, 4, v96
M v[244:247], a[156:159], v[36:39], v[244:247]
v_add_u32 v100, 15360, v99
M v[248:251], a[156:159], v[40:43], v[248:251]
ds_write_b128 v2, v[180:183] offset:5120
M v[248:251], a[160:163], v[72:75], v[248:251]
s_waitcnt vmcnt(0) lgkmcnt(0)
s_barrier
M v[252:255], a[160:163], v[76:79], v[252:255]
ds_write_b128 v2, v[184:187] offset:6144
v_cmp_ne_u32 vcc, 1, v7
s_nop 0
s_cbranch_vccnz Lk3_spinb2
Lk3_gotb2:
M v[252:255], a[156:159], v[44:47], v[252:255]
s_add_u32 m0, s42, 16384
s_nop 0
buffer_load_dwordx4 v99, s[48:51], s26 offen offset:0 lds
M a[64:67], a[164:167], v[32:35], a[64:67]
ds_write_b128 v2, v[188:191] offset:7168
buffer_load_dwordx4 v100, s[48:51], s26 offen offset:1024 lds
ds_write_b128 v2, v[192:195] offset:8192
buffer_load_dwordx4 a[192:195], v1, s[44:47], s25 offen offset:0 sc1
M a[68:71], a[164:167], v[36:39], a[68:71]
buffer_load_dwordx4 a[196:199], v1, s[44:47], s25 offen offset:1024 sc1
M a[72:75], a[164:167], v[40:43], a[72:75]
ds_write_b128 v2, v[196:199] offset:9216
buffer_load_dwordx4 a[200:203], v1, s[44:47], s25 offen offset:2048 sc1
M a[72:75], a[168:171], v[72:75], a[72:75]
buffer_load_dwordx4 a[204:207], v1, s[44:47], s25 offen offset:3072 sc1
M a[76:79], a[168:171], v[76:79], a[76:79]
ds_write_b128 v2, v[200:203] offset:10240
M a[76:79], a[164:167], v[44:47], a[76:79]
s_add_u32 s25, s25, 16384
s_add_u32 s26, s26, 131072
M a[80:83], a[172:175], v[32:35], a[80:83]
ds_write_b128 v2, v[204:207] offset:11264
s_add_u32 m0, s42, 32768
s_nop 0
buffer_load_dwordx4 v99, s[48:51], s26 offen offset:0 lds
buffer_load_dwordx4 v100, s[48:51], s26 offen offset:1024 lds
ds_write_b128 v2, v[208:211] offset:12288
buffer_load_dwordx4 a[224:227], v1, s[44:47], s25 offen offset:0 sc1
M a[84:87], a[172:175], v[36:39], a[84:87]
M a[88:91], a[172:175], v[40:43], a[88:91]
ds_write_b128 v2, v[212:215] offset:13312
buffer_load_dwordx4 a[228:231], v1, s[44:47], s25 offen offset:1024 sc1
M a[88:91], a[176:179], v[72:75], a[88:91]
buffer_load_dwordx4 a[232:235], v1, s[44:47], s25 offen offset:2048 sc1
M a[92:95], a[176:179], v[76:79], a[92:95]
ds_write_b128 v2, v[216:219] offset:14336
buffer_load_dwordx4 a[236:239], v1, s[44:47], s25 offen offset:3072 sc1
M a[92:95], a[172:175], v[44:47], a[92:95]
s_add_u32 s25, s25, 16384
s_add_u32 s26, s26, 131072
ds_write_b128 v2, v[220:223] offset:15360
s_waitcnt lgkmcnt(0)
Lk2_mg1:
s_lshl_b32 s33, s22, 10
s_add_u32 s33, s33, 28672
s_xor_b32 s34, s33, 2048
v_add_u32 v14, s33, v1
v_add_u32 v15, s34, v1
v_accvgpr_read_b32 v20, a96
v_accvgpr_read_b32 v21, a100
v_accvgpr_read_b32 v22, a104
v_accvgpr_read_b32 v23, a108
ds_write_b128 v14, v[20:23]
s_waitcnt lgkmcnt(0)
s_barrier
ds_read_b128 v[28:31], v15
ds_read_b128 v[32:35], v3 offset:0
ds_read_b128 v[36:39], v3 offset:1024
ds_read_b128 v[40:43], v3 offset:2048
ds_read_b128 v[44:47], v3 offset:3072
ds_read_b128 v[48:51], v3 offset:4096
ds_read_b128 v[52:55], v3 offset:5120
ds_read_b128 v[56:59], v3 offset:6144
ds_read_b128 v[60:63], v3 offset:7168
ds_read_b128 v[64:67], v3 offset:8192
ds_read_b128 v[68:71], v3 offset:9216
ds_read_b128 v[72:75], v3 offset:10240
ds_read_b128 v[76:79], v3 offset:11264
ds_read_b128 v[80:83], v3 offset:12288
ds_read_b128 v[84:87], v3 offset:13312
ds_read_b128 v[88:91], v3 offset:14336
ds_read_b128 v[92:95], v3 offset:15360
s_waitcnt lgkmcnt(15)
v_add_f32 v20, v20, v28
v_add_f32 v21, v21, v29
v_add_f32 v22, v22, v30
v_add_f32 v23, v23, v31
s_sub_u32 s35, 15, s21
v_rcp_f32 v8, v20
v_rcp_f32 v9, v21
v_rcp_f32 v10, v22
v_rcp_f32 v11, v23
v_subrev_u32 v20, 0x21800000, v20
v_subrev_u32 v21, 0x21800000, v21
v_subrev_u32 v22, 0x21800000, v22
v_subrev_u32 v23, 0x21800000, v23
v_max_u32 v12, v20, v21
v_max3_u32 v12, v12, v22, v23
s_mov_b32 s64, 0x207
s_lshl_b32 s33, s35, 20
s_lshl_b32 s34, s20, 15
s_add_u32 s33, s33, s34
s_lshl_b32 s34, s23, 13
s_add_u32 s36, s33, s34
s_add_u32 s37, s36, 4096
s_add_u32 s38, s36, 16384
s_add_u32 s39, s36, 20480
v_pk_add_f32 v[224:225], v[224:225], v[32:33]
v_pk_add_f32 v[226:227], v[226:227], v[34:35]
s_waitcnt lgkmcnt(11)
v_pk_add_f32 v[240:241], v[240:241], v[48:49]
v_pk_add_f32 v[242:243], v[242:243], v[50:51]
v_pk_mul_f32 v[224:225], v[224:225], v[8:9] op_sel:[0,0] op_sel_hi:[1,0]
v_pk_mul_f32 v[226:227], v[226:227], v[8:9] op_sel:[0,0] op_sel_hi:[1,0]
v_pk_mul_f32 v[240:241], v[240:241], v[8:9] op_sel:[0,0] op_sel_hi:[1,0]
v_pk_mul_f32 v[242:243], v[242:243], v[8:9] op_sel:[0,0] op_sel_hi:[1,0]
v_cvt_pk_bf16_f32 v224, v224, v225
v_cvt_pk_bf16_f32 v225, v226, v227
v_cvt_pk_bf16_f32 v226, v240, v241
v_cvt_pk_bf16_f32 v227, v242, v243
v_pk_add_f32 v[228:229], v[228:229], v[36:37]
v_pk_add_f32 v[230:231], v[230:231], v[38:39]
s_waitcnt lgkmcnt(10)
v_pk_add_f32 v[244:245], v[244:245], v[52:53]
v_pk_add_f32 v[246:247], v[246:247], v[54:55]
M v[24:27], a[112:115], v[224:227], 0
buffer_store_dwordx4 v[224:227], v1, s[16:19], s38 offen offset:0 sc1
v_pk_mul_f32 v[228:229], v[228:229], v[8:9] op_sel:[0,1] op_sel_hi:[1,1]
v_pk_mul_f32 v[230:231], v[230:231], v[8:9] op_sel:[0,1] op_sel_hi:[1,1]
v_pk_mul_f32 v[244:245], v[244:245], v[8:9] op_sel:[0,1] op_sel_hi:[1,1]
v_pk_mul_f32 v[246:247], v[246:247], v[8:9] op_sel:[0,1] op_sel_hi:[1,1]
v_cvt_pk_bf16_f32 v228, v228, v229
v_cvt_pk_bf16_f32 v229, v230, v231
v_cvt_pk_bf16_f32 v230, v244, v245
v_cvt_pk_bf16_f32 v231, v246, v247
v_pk_add_f32 v[232:233], v[232:233], v[40:41]
v_pk_add_f32 v[234:235], v[234:235], v[42:43]
s_waitcnt lgkmcnt(9)
v_pk_add_f32 v[248:249], v[248:249], v[56:57]
v_pk_add_f32 v[250:251], v[250:251], v[58:59]
M v[24:27], a[112:115], v[228:231], v[24:27]
buffer_store_dwordx4 v[228:231], v1, s[16:19], s38 offen offset:2048 sc1
v_pk_mul_f32 v[232:233], v[232:233], v[10:11] op_sel:[0,0] op_sel_hi:[1,0]
v_pk_mul_f32 v[234:235], v[234:235], v[10:11] op_sel:[0,0] op_sel_hi:[1,0]
v_pk_mul_f32 v[248:249], v[248:249], v[10:11] op_sel:[0,0] op_sel_hi:[1,0]
v_pk_mul_f32 v[250:251], v[250:251], v[10:11] op_sel:[0,0] op_sel_hi:[1,0]
v_cvt_pk_bf16_f32 v232, v232, v233
v_cvt_pk_bf16_f32 v233, v234, v235
v_cvt_pk_bf16_f32 v234, v248, v249
v_cvt_pk_bf16_f32 v235, v250, v251
v_pk_add_f32 v[236:237], v[236:237], v[44:45]
v_pk_add_f32 v[238:239], v[238:239], v[46:47]
s_waitcnt lgkmcnt(8)
v_pk_add_f32 v[252:253], v[252:253], v[60:61]
v_pk_add_f32 v[254:255], v[254:255], v[62:63]
M v[24:27], a[112:115], v[232:235], v[24:27]
buffer_store_dwordx4 v[232:235], v1, s[16:19], s39 offen offset:0 sc1
v_pk_mul_f32 v[236:237], v[236:237], v[10:11] op_sel:[0,1] op_sel_hi:[1,1]
v_pk_mul_f32 v[238:239], v[238:239], v[10:11] op_sel:[0,1] op_sel_hi:[1,1]
v_pk_mul_f32 v[252:253], v[252:253], v[10:11] op_sel:[0,1] op_sel_hi:[1,1]
v_pk_mul_f32 v[254:255], v[254:255], v[10:11] op_sel:[0,1] op_sel_hi:[1,1]
v_cvt_pk_bf16_f32 v236, v236, v237
v_cvt_pk_bf16_f32 v237, v238, v239
v_cvt_pk_bf16_f32 v238, v252, v253
v_cvt_pk_bf16_f32 v239, v254, v255
v_accvgpr_read_b32 v32, a64
v_accvgpr_read_b32 v33, a65
v_accvgpr_read_b32 v34, a66
v_accvgpr_read_b32 v35, a67
s_waitcnt lgkmcnt(7)
v_pk_add_f32 v[32:33], v[32:33], v[64:65]
v_pk_add_f32 v[34:35], v[34:35], v[66:67]
v_accvgpr_read_b32 v48, a80
v_accvgpr_read_b32 v49, a81
v_accvgpr_read_b32 v50, a82
v_accvgpr_read_b32 v51, a83
s_waitcnt lgkmcnt(3)
v_pk_add_f32 v[48:49], v[48:49], v[80:81]
v_pk_add_f32 v[50:51], v[50:51], v[82:83]
M v[24:27], a[112:115], v[236:239], v[24:27]
buffer_store_dwordx4 v[236:239], v1, s[16:19], s39 offen offset:2048 sc1
v_pk_mul_f32 v[32:33], v[32:33], v[8:9] op_sel:[0,0] op_sel_hi:[1,0]
v_pk_mul_f32 v[34:35], v[34:35], v[8:9] op_sel:[0,0] op_sel_hi:[1,0]
v_pk_mul_f32 v[48:49], v[48:49], v[8:9] op_sel:[0,0] op_sel_hi:[1,0]
v_pk_mul_f32 v[50:51], v[50:51], v[8:9] op_sel:[0,0] op_sel_hi:[1,0]
v_cvt_pk_bf16_f32 v32, v32, v33
v_cvt_pk_bf16_f32 v33, v34, v35
v_cvt_pk_bf16_f32 v34, v48, v49
v_cvt_pk_bf16_f32 v35, v50, v51
v_accvgpr_read_b32 v240, a68
v_accvgpr_read_b32 v241, a69
v_accvgpr_read_b32 v242, a70
v_accvgpr_read_b32 v243, a71
v_pk_add_f32 v[240:241], v[240:241], v[68:69]
v_pk_add_f32 v[242:243], v[242:243], v[70:71]
v_accvgpr_read_b32 v36, a84
v_accvgpr_read_b32 v37, a85
v_accvgpr_read_b32 v38, a86
v_accvgpr_read_b32 v39, a87
s_waitcnt lgkmcnt(2)
v_pk_add_f32 v[36:37], v[36:37], v[84:85]
v_pk_add_f32 v[38:39], v[38:39], v[86:87]
M v[24:27], a[112:115], v[32:35], v[24:27]
buffer_store_dwordx4 v[32:35], v1, s[16:19], s38 offen offset:1024 sc1
v_pk_mul_f32 v[240:241], v[240:241], v[8:9] op_sel:[0,1] op_sel_hi:[1,1]
v_pk_mul_f32 v[242:243], v[242:243], v[8:9] op_sel:[0,1] op_sel_hi:[1,1]
v_pk_mul_f32 v[36:37], v[36:37], v[8:9] op_sel:[0,1] op_sel_hi:[1,1]
v_pk_mul_f32 v[38:39], v[38:39], v[8:9] op_sel:[0,1] op_sel_hi:[1,1]
v_cvt_pk_bf16_f32 v240, v240, v241
v_cvt_pk_bf16_f32 v241, v242, v243
v_cvt_pk_bf16_f32 v242, v36, v37
v_cvt_pk_bf16_f32 v243, v38, v39
v_accvgpr_read_b32 v52, a72
v_accvgpr_read_b32 v53, a73
v_accvgpr_read_b32 v54, a74
v_accvgpr_read_b32 v55, a75
v_pk_add_f32 v[52:53], v[52:53], v[72:73]
v_pk_add_f32 v[54:55], v[54:55], v[74:75]
v_accvgpr_read_b32 v244, a88
v_accvgpr_read_b32 v245, a89
v_accvgpr_read_b32 v246, a90
v_accvgpr_read_b32 v247, a91
s_waitcnt lgkmcnt(1)
v_pk_add_f32 v[244:245], v[244:245], v[88:89]
v_pk_add_f32 v[246:247], v[246:247], v[90:91]
M v[24:27], a[112:115], v[240:243], v[24:27]
buffer_store_dwordx4 v[240:243], v1, s[16:19], s38 offen offset:3072 sc1
v_pk_mul_f32 v[52:53], v[52:53], v[10:11] op_sel:[0,0] op_sel_hi:[1,0]
v_pk_mul_f32 v[54:55], v[54:55], v[10:11] op_sel:[0,0] op_sel_hi:[1,0]
v_pk_mul_f32 v[244:245], v[244:245], v[10:11] op_sel:[0,0] op_sel_hi:[1,0]
v_pk_mul_f32 v[246:247], v[246:247], v[10:11] op_sel:[0,0] op_sel_hi:[1,0]
v_cvt_pk_bf16_f32 v52, v52, v53
v_cvt_pk_bf16_f32 v53, v54, v55
v_cvt_pk_bf16_f32 v54, v244, v245
v_cvt_pk_bf16_f32 v55, v246, v247
v_accvgpr_read_b32 v40, a76
v_accvgpr_read_b32 v41, a77
v_accvgpr_read_b32 v42, a78
v_accvgpr_read_b32 v43, a79
v_pk_add_f32 v[40:41], v[40:41], v[76:77]
v_pk_add_f32 v[42:43], v[42:43], v[78:79]
v_accvgpr_read_b32 v56, a92
v_accvgpr_read_b32 v57, a93
v_accvgpr_read_b32 v58, a94
v_accvgpr_read_b32 v59, a95
s_waitcnt lgkmcnt(0)
v_pk_add_f32 v[56:57], v[56:57], v[92:93]
v_pk_add_f32 v[58:59], v[58:59], v[94:95]
M v[24:27], a[112:115], v[52:55], v[24:27]
buffer_store_dwordx4 v[52:55], v1, s[16:19], s39 offen offset:1024 sc1
v_pk_mul_f32 v[40:41], v[40:41], v[10:11] op_sel:[0,1] op_sel_hi:[1,1]
v_pk_mul_f32 v[42:43], v[42:43], v[10:11] op_sel:[0,1] op_sel_hi:[1,1]
v_pk_mul_f32 v[56:57], v[56:57], v[10:11] op_sel:[0,1] op_sel_hi:[1,1]
v_pk_mul_f32 v[58:59], v[58:59], v[10:11] op_sel:[0,1] op_sel_hi:[1,1]
v_cvt_pk_bf16_f32 v40, v40, v41
v_cvt_pk_bf16_f32 v41, v42, v43
v_cvt_pk_bf16_f32 v42, v56, v57
v_cvt_pk_bf16_f32 v43, v58, v59
s_nop 1
M v[24:27], a[112:115], v[40:43], v[24:27]
buffer_store_dwordx4 v[40:43], v1, s[16:19], s39 offen offset:3072 sc1
v_cmp_lt_u32 vcc, 0x3c000000, v12
s_nop 5
v_cmp_class_f32 s[40:41], v24, s64
s_nop 0
s_or_b64 vcc, vcc, s[40:41]
s_cmp_lg_u64 vcc, 0
s_cselect_b32 s33, 2, 0
s_or_b32 s60, s60, s33
Lk2_chk:
s_cmp_eq_u32 s60, 0
s_cbranch_scc1 Lk2_done
s_sub_u32 s56, 15, s21
s_lshl_b32 s33, s24, 1
s_lshl_b32 s61, 3, s33
s_and_b32 s34, s60, 2
s_bitcmp1_b32 s60, 0
s_cselect_b32 s56, s21, s56
s_cselect_b32 s61, 15, s61
s_cselect_b32 s60, s34, 0
s_waitcnt vmcnt(0)
s_lshl_b32 s33, s20, 7
s_lshl_b32 s34, s56, 3
s_add_u32 s33, s33, s34
s_lshl_b32 s34, s23, 2
s_add_u32 s33, s33, s34
s_lshl_b32 s33, s33, 12
buffer_load_dwordx4 a[0:3], v1, s[8:11], s33 offen offset:0 sc1
buffer_load_dwordx4 a[4:7], v1, s[8:11], s33 offen offset:1024 sc1
buffer_load_dwordx4 a[8:11], v1, s[8:11], s33 offen offset:2048 sc1
buffer_load_dwordx4 a[12:15], v1, s[8:11], s33 offen offset:3072 sc1
s_add_u32 s33, s33, 4096
buffer_load_dwordx4 a[16:19], v1, s[8:11], s33 offen offset:0 sc1
buffer_load_dwordx4 a[20:23], v1, s[8:11], s33 offen offset:1024 sc1
buffer_load_dwordx4 a[24:27], v1, s[8:11], s33 offen offset:2048 sc1
buffer_load_dwordx4 a[28:31], v1, s[8:11], s33 offen offset:3072 sc1
s_add_u32 s33, s33, 4096
buffer_load_dwordx4 a[32:35], v1, s[8:11], s33 offen offset:0 sc1
buffer_load_dwordx4 a[36:39], v1, s[8:11], s33 offen offset:1024 sc1
buffer_load_dwordx4 a[40:43], v1, s[8:11], s33 offen offset:2048 sc1
buffer_load_dwordx4 a[44:47], v1, s[8:11], s33 offen offset:3072 sc1
s_add_u32 s33, s33, 4096
buffer_load_dwordx4 a[48:51], v1, s[8:11], s33 offen offset:0 sc1
buffer_load_dwordx4 a[52:55], v1, s[8:11], s33 offen offset:1024 sc1
buffer_load_dwordx4 a[56:59], v1, s[8:11], s33 offen offset:2048 sc1
buffer_load_dwordx4 a[60:63], v1, s[8:11], s33 offen offset:3072 sc1
v_accvgpr_write_b32 a64, 0
v_accvgpr_write_b32 a65, 0
v_accvgpr_write_b32 a66, 0
v_accvgpr_write_b32 a67, 0
v_accvgpr_write_b32 a68, 0
v_accvgpr_write_b32 a69, 0
v_accvgpr_write_b32 a70, 0
v_accvgpr_write_b32 a71, 0
v_accvgpr_write_b32 a72, 0
v_accvgpr_write_b32 a73, 0
v_accvgpr_write_b32 a74, 0
v_accvgpr_write_b32 a75, 0
v_accvgpr_write_b32 a76, 0
v_accvgpr_write_b32 a77, 0
v_accvgpr_write_b32 a78, 0
v_accvgpr_write_b32 a79, 0
v_accvgpr_write_b32 a80, 0
v_accvgpr_write_b32 a81, 0
v_accvgpr_write_b32 a82, 0
v_accvgpr_write_b32 a83, 0
v_accvgpr_write_b32 a84, 0
v_accvgpr_write_b32 a85, 0
v_accvgpr_write_b32 a86, 0
v_accvgpr_write_b32 a87, 0
v_accvgpr_write_b32 a88, 0
v_accvgpr_write_b32 a89, 0
v_accvgpr_write_b32 a90, 0
v_accvgpr_write_b32 a91, 0
v_accvgpr_write_b32 a92, 0
v_accvgpr_write_b32 a93, 0
v_accvgpr_write_b32 a94, 0
v_accvgpr_write_b32 a95, 0
v_accvgpr_write_b32 a96, 0
v_accvgpr_write_b32 a97, 0
v_accvgpr_write_b32 a98, 0
v_accvgpr_write_b32 a99, 0
v_accvgpr_write_b32 a100, 0
v_accvgpr_write_b32 a101, 0
v_accvgpr_write_b32 a102, 0
v_accvgpr_write_b32 a103, 0
v_accvgpr_write_b32 a104, 0
v_accvgpr_write_b32 a105, 0
v_accvgpr_write_b32 a106, 0
v_accvgpr_write_b32 a107, 0
v_accvgpr_write_b32 a108, 0
v_accvgpr_write_b32 a109, 0
v_accvgpr_write_b32 a110, 0
v_accvgpr_write_b32 a111, 0
v_mov_b32 v160, 0
v_mov_b32 v161, 0
v_mov_b32 v162, 0
v_mov_b32 v163, 0
v_mov_b32 v164, 0
v_mov_b32 v165, 0
v_mov_b32 v166, 0
v_mov_b32 v167, 0
v_mov_b32 v168, 0
v_mov_b32 v169, 0
v_mov_b32 v170, 0
v_mov_b32 v171, 0
v_mov_b32 v172, 0
v_mov_b32 v173, 0
v_mov_b32 v174, 0
v_mov_b32 v175, 0
v_mov_b32 v176, 0
v_mov_b32 v177, 0
v_mov_b32 v178, 0
v_mov_b32 v179, 0
v_mov_b32 v180, 0
v_mov_b32 v181, 0
v_mov_b32 v182, 0
v_mov_b32 v183, 0
v_mov_b32 v184, 0
v_mov_b32 v185, 0
v_mov_b32 v186, 0
v_mov_b32 v187, 0
v_mov_b32 v188, 0
v_mov_b32 v189, 0
v_mov_b32 v190, 0
v_mov_b32 v191, 0
v_mov_b32 v192, 0
v_mov_b32 v193, 0
v_mov_b32 v194, 0
v_mov_b32 v195, 0
v_mov_b32 v196, 0
v_mov_b32 v197, 0
v_mov_b32 v198, 0
v_mov_b32 v199, 0
v_mov_b32 v200, 0
v_mov_b32 v201, 0
v_mov_b32 v202, 0
v_mov_b32 v203, 0
v_mov_b32 v204, 0
v_mov_b32 v205, 0
v_mov_b32 v206, 0
v_mov_b32 v207, 0
v_mov_b32 v208, 0
v_mov_b32 v209, 0
v_mov_b32 v210, 0
v_mov_b32 v211, 0
v_mov_b32 v212, 0
v_mov_b32 v213, 0
v_mov_b32 v214, 0
v_mov_b32 v215, 0
v_mov_b32 v216, 0
v_mov_b32 v217, 0
v_mov_b32 v218, 0
v_mov_b32 v219, 0
v_mov_b32 v220, 0
v_mov_b32 v221, 0
v_mov_b32 v222, 0
v_mov_b32 v223, 0
v_mov_b32 v224, 0
v_mov_b32 v225, 0
v_mov_b32 v226, 0
v_mov_b32 v227, 0
v_mov_b32 v228, 0
v_mov_b32 v229, 0
v_mov_b32 v230, 0
v_mov_b32 v231, 0
v_mov_b32 v232, 0
v_mov_b32 v233, 0
v_mov_b32 v234, 0
v_mov_b32 v235, 0
v_mov_b32 v236, 0
v_mov_b32 v237, 0
v_mov_b32 v238, 0
v_mov_b32 v239, 0
v_mov_b32 v240, 0
v_mov_b32 v241, 0
v_mov_b32 v242, 0
v_mov_b32 v243, 0
v_mov_b32 v244, 0
v_mov_b32 v245, 0
v_mov_b32 v246, 0
v_mov_b32 v247, 0
v_mov_b32 v248, 0
v_mov_b32 v249, 0
v_mov_b32 v250, 0
v_mov_b32 v251, 0
v_mov_b32 v252, 0
v_mov_b32 v253, 0
v_mov_b32 v254, 0
v_mov_b32 v255, 0
v_mov_b32 v8, v4
v_mov_b32 v9, v4
v_mov_b32 v10, v4
v_mov_b32 v11, v4
s_lshl_b32 s57, s20, 20
s_lshl_b32 s58, s56, 7
s_lshl_b32 s59, s56, 1
s_add_u32 s59, s59, 2
Lslow_2:
s_add_u32 s35, s57, 0
buffer_load_dwordx4 v[96:99], v1, s[12:15], s35 offen offset:0 sc1
buffer_load_dwordx4 v[100:103], v1, s[12:15], s35 offen offset:1024 sc1
buffer_load_dwordx4 v[104:107], v1, s[12:15], s35 offen offset:2048 sc1
buffer_load_dwordx4 v[108:111], v1, s[12:15], s35 offen offset:3072 sc1
s_add_u32 s35, s57, 4096
buffer_load_dwordx4 v[112:115], v1, s[12:15], s35 offen offset:0 sc1
buffer_load_dwordx4 v[116:119], v1, s[12:15], s35 offen offset:1024 sc1
buffer_load_dwordx4 v[120:123], v1, s[12:15], s35 offen offset:2048 sc1
buffer_load_dwordx4 v[124:127], v1, s[12:15], s35 offen offset:3072 sc1
s_add_u32 s35, s57, 8192
buffer_load_dwordx4 v[128:131], v1, s[12:15], s35 offen offset:0 sc1
buffer_load_dwordx4 v[132:135], v1, s[12:15], s35 offen offset:1024 sc1
buffer_load_dwordx4 v[136:139], v1, s[12:15], s35 offen offset:2048 sc1
buffer_load_dwordx4 v[140:143], v1, s[12:15], s35 offen offset:3072 sc1
s_add_u32 s35, s57, 12288
buffer_load_dwordx4 v[144:147], v1, s[12:15], s35 offen offset:0 sc1
buffer_load_dwordx4 v[148:151], v1, s[12:15], s35 offen offset:1024 sc1
buffer_load_dwordx4 v[152:155], v1, s[12:15], s35 offen offset:2048 sc1
buffer_load_dwordx4 v[156:159], v1, s[12:15], s35 offen offset:3072 sc1
s_lshl_b32 s33, s23, 6
s_add_i32 s33, s33, s58
s_cmp_gt_i32 s33, 0
s_cselect_b32 s34, 0, 0xf149f2ca
s_cmp_lt_i32 s33, 0
s_cselect_b32 s33, 0xf149f2ca, 0
v_mov_b32 v20, s34
v_mov_b32 v21, s34
v_mov_b32 v22, s34
v_mov_b32 v23, s34
v_mov_b32 v28, s33
v_mov_b32 v29, s33
v_mov_b32 v30, s33
v_mov_b32 v31, s33
v_med3_f32 v24, v16, v20, v28
v_med3_f32 v25, v17, v20, v28
v_med3_f32 v26, v18, v20, v28
v_med3_f32 v27, v19, v20, v28
s_waitcnt vmcnt(0)
s_nop 0
M v[32:35], v[96:99], a[0:3], v[24:27]
M v[32:35], v[100:103], a[4:7], v[32:35]
M v[32:35], v[104:107], a[8:11], v[32:35]
M v[32:35], v[108:111], a[12:15], v[32:35]
M v[36:39], v[96:99], a[16:19], v[28:31]
M v[36:39], v[100:103], a[20:23], v[36:39]
M v[36:39], v[104:107], a[24:27], v[36:39]
M v[36:39], v[108:111], a[28:31], v[36:39]
M v[40:43], v[96:99], a[32:35], v[28:31]
M v[40:43], v[100:103], a[36:39], v[40:43]
M v[40:43], v[104:107], a[40:43], v[40:43]
M v[40:43], v[108:111], a[44:47], v[40:43]
M v[44:47], v[96:99], a[48:51], v[28:31]
M v[44:47], v[100:103], a[52:55], v[44:47]
M v[44:47], v[104:107], a[56:59], v[44:47]
M v[44:47], v[108:111], a[60:63], v[44:47]
M v[48:51], v[112:115], a[0:3], v[20:23]
M v[48:51], v[116:119], a[4:7], v[48:51]
M v[48:51], v[120:123], a[8:11], v[48:51]
M v[48:51], v[124:127], a[12:15], v[48:51]
M v[52:55], v[112:115], a[16:19], v[24:27]
M v[52:55], v[116:119], a[20:23], v[52:55]
M v[52:55], v[120:123], a[24:27], v[52:55]
M v[52:55], v[124:127], a[28:31], v[52:55]
M v[56:59], v[112:115], a[32:35], v[28:31]
M v[56:59], v[116:119], a[36:39], v[56:59]
M v[56:59], v[120:123], a[40:43], v[56:59]
M v[56:59], v[124:127], a[44:47], v[56:59]
M v[60:63], v[112:115], a[48:51], v[28:31]
M v[60:63], v[116:119], a[52:55], v[60:63]
M v[60:63], v[120:123], a[56:59], v[60:63]
M v[60:63], v[124:127], a[60:63], v[60:63]
M v[64:67], v[128:131], a[0:3], v[20:23]
M v[64:67], v[132:135], a[4:7], v[64:67]
M v[64:67], v[136:139], a[8:11], v[64:67]
M v[64:67], v[140:143], a[12:15], v[64:67]
M v[68:71], v[128:131], a[16:19], v[20:23]
M v[68:71], v[132:135], a[20:23], v[68:71]
M v[68:71], v[136:139], a[24:27], v[68:71]
M v[68:71], v[140:143], a[28:31], v[68:71]
M v[72:75], v[128:131], a[32:35], v[24:27]
M v[72:75], v[132:135], a[36:39], v[72:75]
M v[72:75], v[136:139], a[40:43], v[72:75]
M v[72:75], v[140:143], a[44:47], v[72:75]
M v[76:79], v[128:131], a[48:51], v[28:31]
M v[76:79], v[132:135], a[52:55], v[76:79]
M v[76:79], v[136:139], a[56:59], v[76:79]
M v[76:79], v[140:143], a[60:63], v[76:79]
M v[80:83], v[144:147], a[0:3], v[20:23]
M v[80:83], v[148:151], a[4:7], v[80:83]
M v[80:83], v[152:155], a[8:11], v[80:83]
M v[80:83], v[156:159], a[12:15], v[80:83]
M v[84:87], v[144:147], a[16:19], v[20:23]
M v[84:87], v[148:151], a[20:23], v[84:87]
M v[84:87], v[152:155], a[24:27], v[84:87]
M v[84:87], v[156:159], a[28:31], v[84:87]
M v[88:91], v[144:147], a[32:35], v[20:23]
M v[88:91], v[148:151], a[36:39], v[88:91]
M v[88:91], v[152:155], a[40:43], v[88:91]
M v[88:91], v[156:159], a[44:47], v[88:91]
M v[92:95], v[144:147], a[48:51], v[24:27]
M v[92:95], v[148:151], a[52:55], v[92:95]
M v[92:95], v[152:155], a[56:59], v[92:95]
M v[92:95], v[156:159], a[60:63], v[92:95]
s_nop 7
s_add_u32 s35, s57, 16384
buffer_load_dwordx4 v[96:99], v1, s[12:15], s35 offen offset:0 sc1
buffer_load_dwordx4 v[100:103], v1, s[12:15], s35 offen offset:1024 sc1
buffer_load_dwordx4 v[104:107], v1, s[12:15], s35 offen offset:2048 sc1
buffer_load_dwordx4 v[108:111], v1, s[12:15], s35 offen offset:3072 sc1
s_add_u32 s35, s57, 20480
buffer_load_dwordx4 v[112:115], v1, s[12:15], s35 offen offset:0 sc1
buffer_load_dwordx4 v[116:119], v1, s[12:15], s35 offen offset:1024 sc1
buffer_load_dwordx4 v[120:123], v1, s[12:15], s35 offen offset:2048 sc1
buffer_load_dwordx4 v[124:127], v1, s[12:15], s35 offen offset:3072 sc1
s_add_u32 s35, s57, 24576
buffer_load_dwordx4 v[128:131], v1, s[12:15], s35 offen offset:0 sc1
buffer_load_dwordx4 v[132:135], v1, s[12:15], s35 offen offset:1024 sc1
buffer_load_dwordx4 v[136:139], v1, s[12:15], s35 offen offset:2048 sc1
buffer_load_dwordx4 v[140:143], v1, s[12:15], s35 offen offset:3072 sc1
s_add_u32 s35, s57, 28672
buffer_load_dwordx4 v[144:147], v1, s[12:15], s35 offen offset:0 sc1
buffer_load_dwordx4 v[148:151], v1, s[12:15], s35 offen offset:1024 sc1
buffer_load_dwordx4 v[152:155], v1, s[12:15], s35 offen offset:2048 sc1
buffer_load_dwordx4 v[156:159], v1, s[12:15], s35 offen offset:3072 sc1
v_max3_f32 v13, v32, v33, v8
v_max3_f32 v13, v13, v34, v35
v_max3_f32 v13, v13, v48, v49
v_max3_f32 v13, v13, v50, v51
v_max3_f32 v13, v13, v64, v65
v_max3_f32 v13, v13, v66, v67
v_max3_f32 v13, v13, v80, v81
v_max3_f32 v13, v13, v82, v83
v_mov_b32 v14, v13
s_nop 1
v_permlane16_swap_b32 v13, v14
v_max_f32 v13, v13, v14
v_mov_b32 v14, v13
s_nop 1
v_permlane32_swap_b32 v13, v14
v_max_f32 v13, v13, v14
v_sub_f32 v12, v8, v13
v_exp_f32 v12, v12
v_mov_b32 v8, v13
v_sub_f32 v32, v32, v13
v_sub_f32 v33, v33, v13
v_sub_f32 v34, v34, v13
v_sub_f32 v35, v35, v13
v_sub_f32 v48, v48, v13
v_sub_f32 v49, v49, v13
v_sub_f32 v50, v50, v13
v_sub_f32 v51, v51, v13
v_sub_f32 v64, v64, v13
v_sub_f32 v65, v65, v13
v_sub_f32 v66, v66, v13
v_sub_f32 v67, v67, v13
v_sub_f32 v80, v80, v13
v_sub_f32 v81, v81, v13
v_sub_f32 v82, v82, v13
v_sub_f32 v83, v83, v13
v_mul_f32 v160, v160, v12
v_mul_f32 v161, v161, v12
v_mul_f32 v162, v162, v12
v_mul_f32 v163, v163, v12
v_mul_f32 v176, v176, v12
v_mul_f32 v177, v177, v12
v_mul_f32 v178, v178, v12
v_mul_f32 v179, v179, v12
v_mul_f32 v192, v192, v12
v_mul_f32 v193, v193, v12
v_mul_f32 v194, v194, v12
v_mul_f32 v195, v195, v12
v_mul_f32 v208, v208, v12
v_mul_f32 v209, v209, v12
v_mul_f32 v210, v210, v12
v_mul_f32 v211, v211, v12
v_mul_f32 v224, v224, v12
v_mul_f32 v225, v225, v12
v_mul_f32 v226, v226, v12
v_mul_f32 v227, v227, v12
v_mul_f32 v240, v240, v12
v_mul_f32 v241, v241, v12
v_mul_f32 v242, v242, v12
v_mul_f32 v243, v243, v12
v_accvgpr_read_b32 v14, a64
v_mul_f32 v14, v14, v12
v_accvgpr_write_b32 a64, v14
v_accvgpr_read_b32 v14, a65
v_mul_f32 v14, v14, v12
v_accvgpr_write_b32 a65, v14
v_accvgpr_read_b32 v14, a66
v_mul_f32 v14, v14, v12
v_accvgpr_write_b32 a66, v14
v_accvgpr_read_b32 v14, a67
v_mul_f32 v14, v14, v12
v_accvgpr_write_b32 a67, v14
v_accvgpr_read_b32 v14, a80
v_mul_f32 v14, v14, v12
v_accvgpr_write_b32 a80, v14
v_accvgpr_read_b32 v14, a81
v_mul_f32 v14, v14, v12
v_accvgpr_write_b32 a81, v14
v_accvgpr_read_b32 v14, a82
v_mul_f32 v14, v14, v12
v_accvgpr_write_b32 a82, v14
v_accvgpr_read_b32 v14, a83
v_mul_f32 v14, v14, v12
v_accvgpr_write_b32 a83, v14
v_accvgpr_read_b32 v14, a96
v_mul_f32 v14, v14, v12
v_accvgpr_write_b32 a96, v14
v_accvgpr_read_b32 v14, a97
v_mul_f32 v14, v14, v12
v_accvgpr_write_b32 a97, v14
v_accvgpr_read_b32 v14, a98
v_mul_f32 v14, v14, v12
v_accvgpr_write_b32 a98, v14
v_accvgpr_read_b32 v14, a99
v_mul_f32 v14, v14, v12
v_accvgpr_write_b32 a99, v14
v_max3_f32 v13, v36, v37, v9
v_max3_f32 v13, v13, v38, v39
v_max3_f32 v13, v13, v52, v53
v_max3_f32 v13, v13, v54, v55
v_max3_f32 v13, v13, v68, v69
v_max3_f32 v13, v13, v70, v71
v_max3_f32 v13, v13, v84, v85
v_max3_f32 v13, v13, v86, v87
v_mov_b32 v14, v13
s_nop 1
v_permlane16_swap_b32 v13, v14
v_max_f32 v13, v13, v14
v_mov_b32 v14, v13
s_nop 1
v_permlane32_swap_b32 v13, v14
v_max_f32 v13, v13, v14
v_sub_f32 v12, v9, v13
v_exp_f32 v12, v12
v_mov_b32 v9, v13
v_sub_f32 v36, v36, v13
v_sub_f32 v37, v37, v13
v_sub_f32 v38, v38, v13
v_sub_f32 v39, v39, v13
v_sub_f32 v52, v52, v13
v_sub_f32 v53, v53, v13
v_sub_f32 v54, v54, v13
v_sub_f32 v55, v55, v13
v_sub_f32 v68, v68, v13
v_sub_f32 v69, v69, v13
v_sub_f32 v70, v70, v13
v_sub_f32 v71, v71, v13
v_sub_f32 v84, v84, v13
v_sub_f32 v85, v85, v13
v_sub_f32 v86, v86, v13
v_sub_f32 v87, v87, v13
v_mul_f32 v164, v164, v12
v_mul_f32 v165, v165, v12
v_mul_f32 v166, v166, v12
v_mul_f32 v167, v167, v12
v_mul_f32 v180, v180, v12
v_mul_f32 v181, v181, v12
v_mul_f32 v182, v182, v12
v_mul_f32 v183, v183, v12
v_mul_f32 v196, v196, v12
v_mul_f32 v197, v197, v12
v_mul_f32 v198, v198, v12
v_mul_f32 v199, v199, v12
v_mul_f32 v212, v212, v12
v_mul_f32 v213, v213, v12
v_mul_f32 v214, v214, v12
v_mul_f32 v215, v215, v12
v_mul_f32 v228, v228, v12
v_mul_f32 v229, v229, v12
v_mul_f32 v230, v230, v12
v_mul_f32 v231, v231, v12
v_mul_f32 v244, v244, v12
v_mul_f32 v245, v245, v12
v_mul_f32 v246, v246, v12
v_mul_f32 v247, v247, v12
v_accvgpr_read_b32 v14, a68
v_mul_f32 v14, v14, v12
v_accvgpr_write_b32 a68, v14
v_accvgpr_read_b32 v14, a69
v_mul_f32 v14, v14, v12
v_accvgpr_write_b32 a69, v14
v_accvgpr_read_b32 v14, a70
v_mul_f32 v14, v14, v12
v_accvgpr_write_b32 a70, v14
v_accvgpr_read_b32 v14, a71
v_mul_f32 v14, v14, v12
v_accvgpr_write_b32 a71, v14
v_accvgpr_read_b32 v14, a84
v_mul_f32 v14, v14, v12
v_accvgpr_write_b32 a84, v14
v_accvgpr_read_b32 v14, a85
v_mul_f32 v14, v14, v12
v_accvgpr_write_b32 a85, v14
v_accvgpr_read_b32 v14, a86
v_mul_f32 v14, v14, v12
v_accvgpr_write_b32 a86, v14
v_accvgpr_read_b32 v14, a87
v_mul_f32 v14, v14, v12
v_accvgpr_write_b32 a87, v14
v_accvgpr_read_b32 v14, a100
v_mul_f32 v14, v14, v12
v_accvgpr_write_b32 a100, v14
v_accvgpr_read_b32 v14, a101
v_mul_f32 v14, v14, v12
v_accvgpr_write_b32 a101, v14
v_accvgpr_read_b32 v14, a102
v_mul_f32 v14, v14, v12
v_accvgpr_write_b32 a102, v14
v_accvgpr_read_b32 v14, a103
v_mul_f32 v14, v14, v12
v_accvgpr_write_b32 a103, v14
v_max3_f32 v13, v40, v41, v10
v_max3_f32 v13, v13, v42, v43
v_max3_f32 v13, v13, v56, v57
v_max3_f32 v13, v13, v58, v59
v_max3_f32 v13, v13, v72, v73
v_max3_f32 v13, v13, v74, v75
v_max3_f32 v13, v13, v88, v89
v_max3_f32 v13, v13, v90, v91
v_mov_b32 v14, v13
s_nop 1
v_permlane16_swap_b32 v13, v14
v_max_f32 v13, v13, v14
v_mov_b32 v14, v13
s_nop 1
v_permlane32_swap_b32 v13, v14
v_max_f32 v13, v13, v14
v_sub_f32 v12, v10, v13
v_exp_f32 v12, v12
v_mov_b32 v10, v13
v_sub_f32 v40, v40, v13
v_sub_f32 v41, v41, v13
v_sub_f32 v42, v42, v13
v_sub_f32 v43, v43, v13
v_sub_f32 v56, v56, v13
v_sub_f32 v57, v57, v13
v_sub_f32 v58, v58, v13
v_sub_f32 v59, v59, v13
v_sub_f32 v72, v72, v13
v_sub_f32 v73, v73, v13
v_sub_f32 v74, v74, v13
v_sub_f32 v75, v75, v13
v_sub_f32 v88, v88, v13
v_sub_f32 v89, v89, v13
v_sub_f32 v90, v90, v13
v_sub_f32 v91, v91, v13
v_mul_f32 v168, v168, v12
v_mul_f32 v169, v169, v12
v_mul_f32 v170, v170, v12
v_mul_f32 v171, v171, v12
v_mul_f32 v184, v184, v12
v_mul_f32 v185, v185, v12
v_mul_f32 v186, v186, v12
v_mul_f32 v187, v187, v12
v_mul_f32 v200, v200, v12
v_mul_f32 v201, v201, v12
v_mul_f32 v202, v202, v12
v_mul_f32 v203, v203, v12
v_mul_f32 v216, v216, v12
v_mul_f32 v217, v217, v12
v_mul_f32 v218, v218, v12
v_mul_f32 v219, v219, v12
v_mul_f32 v232, v232, v12
v_mul_f32 v233, v233, v12
v_mul_f32 v234, v234, v12
v_mul_f32 v235, v235, v12
v_mul_f32 v248, v248, v12
v_mul_f32 v249, v249, v12
v_mul_f32 v250, v250, v12
v_mul_f32 v251, v251, v12
v_accvgpr_read_b32 v14, a72
v_mul_f32 v14, v14, v12
v_accvgpr_write_b32 a72, v14
v_accvgpr_read_b32 v14, a73
v_mul_f32 v14, v14, v12
v_accvgpr_write_b32 a73, v14
v_accvgpr_read_b32 v14, a74
v_mul_f32 v14, v14, v12
v_accvgpr_write_b32 a74, v14
v_accvgpr_read_b32 v14, a75
v_mul_f32 v14, v14, v12
v_accvgpr_write_b32 a75, v14
v_accvgpr_read_b32 v14, a88
v_mul_f32 v14, v14, v12
v_accvgpr_write_b32 a88, v14
v_accvgpr_read_b32 v14, a89
v_mul_f32 v14, v14, v12
v_accvgpr_write_b32 a89, v14
v_accvgpr_read_b32 v14, a90
v_mul_f32 v14, v14, v12
v_accvgpr_write_b32 a90, v14
v_accvgpr_read_b32 v14, a91
v_mul_f32 v14, v14, v12
v_accvgpr_write_b32 a91, v14
v_accvgpr_read_b32 v14, a104
v_mul_f32 v14, v14, v12
v_accvgpr_write_b32 a104, v14
v_accvgpr_read_b32 v14, a105
v_mul_f32 v14, v14, v12
v_accvgpr_write_b32 a105, v14
v_accvgpr_read_b32 v14, a106
v_mul_f32 v14, v14, v12
v_accvgpr_write_b32 a106, v14
v_accvgpr_read_b32 v14, a107
v_mul_f32 v14, v14, v12
v_accvgpr_write_b32 a107, v14
v_max3_f32 v13, v44, v45, v11
v_max3_f32 v13, v13, v46, v47
v_max3_f32 v13, v13, v60, v61
v_max3_f32 v13, v13, v62, v63
v_max3_f32 v13, v13, v76, v77
v_max3_f32 v13, v13, v78, v79
v_max3_f32 v13, v13, v92, v93
v_max3_f32 v13, v13, v94, v95
v_mov_b32 v14, v13
s_nop 1
v_permlane16_swap_b32 v13, v14
v_max_f32 v13, v13, v14
v_mov_b32 v14, v13
s_nop 1
v_permlane32_swap_b32 v13, v14
v_max_f32 v13, v13, v14
v_sub_f32 v12, v11, v13
v_exp_f32 v12, v12
v_mov_b32 v11, v13
v_sub_f32 v44, v44, v13
v_sub_f32 v45, v45, v13
v_sub_f32 v46, v46, v13
v_sub_f32 v47, v47, v13
v_sub_f32 v60, v60, v13
v_sub_f32 v61, v61, v13
v_sub_f32 v62, v62, v13
v_sub_f32 v63, v63, v13
v_sub_f32 v76, v76, v13
v_sub_f32 v77, v77, v13
v_sub_f32 v78, v78, v13
v_sub_f32 v79, v79, v13
v_sub_f32 v92, v92, v13
v_sub_f32 v93, v93, v13
v_sub_f32 v94, v94, v13
v_sub_f32 v95, v95, v13
v_mul_f32 v172, v172, v12
v_mul_f32 v173, v173, v12
v_mul_f32 v174, v174, v12
v_mul_f32 v175, v175, v12
v_mul_f32 v188, v188, v12
v_mul_f32 v189, v189, v12
v_mul_f32 v190, v190, v12
v_mul_f32 v191, v191, v12
v_mul_f32 v204, v204, v12
v_mul_f32 v205, v205, v12
v_mul_f32 v206, v206, v12
v_mul_f32 v207, v207, v12
v_mul_f32 v220, v220, v12
v_mul_f32 v221, v221, v12
v_mul_f32 v222, v222, v12
v_mul_f32 v223, v223, v12
v_mul_f32 v236, v236, v12
v_mul_f32 v237, v237, v12
v_mul_f32 v238, v238, v12
v_mul_f32 v239, v239, v12
v_mul_f32 v252, v252, v12
v_mul_f32 v253, v253, v12
v_mul_f32 v254, v254, v12
v_mul_f32 v255, v255, v12
v_accvgpr_read_b32 v14, a76
v_mul_f32 v14, v14, v12
v_accvgpr_write_b32 a76, v14
v_accvgpr_read_b32 v14, a77
v_mul_f32 v14, v14, v12
v_accvgpr_write_b32 a77, v14
v_accvgpr_read_b32 v14, a78
v_mul_f32 v14, v14, v12
v_accvgpr_write_b32 a78, v14
v_accvgpr_read_b32 v14, a79
v_mul_f32 v14, v14, v12
v_accvgpr_write_b32 a79, v14
v_accvgpr_read_b32 v14, a92
v_mul_f32 v14, v14, v12
v_accvgpr_write_b32 a92, v14
v_accvgpr_read_b32 v14, a93
v_mul_f32 v14, v14, v12
v_accvgpr_write_b32 a93, v14
v_accvgpr_read_b32 v14, a94
v_mul_f32 v14, v14, v12
v_accvgpr_write_b32 a94, v14
v_accvgpr_read_b32 v14, a95
v_mul_f32 v14, v14, v12
v_accvgpr_write_b32 a95, v14
v_accvgpr_read_b32 v14, a108
v_mul_f32 v14, v14, v12
v_accvgpr_write_b32 a108, v14
v_accvgpr_read_b32 v14, a109
v_mul_f32 v14, v14, v12
v_accvgpr_write_b32 a109, v14
v_accvgpr_read_b32 v14, a110
v_mul_f32 v14, v14, v12
v_accvgpr_write_b32 a110, v14
v_accvgpr_read_b32 v14, a111
v_mul_f32 v14, v14, v12
v_accvgpr_write_b32 a111, v14
v_exp_f32 v32, v32
v_exp_f32 v33, v33
v_exp_f32 v34, v34
v_exp_f32 v35, v35
v_exp_f32 v48, v48
v_exp_f32 v49, v49
v_exp_f32 v50, v50
v_exp_f32 v51, v51
v_cvt_pk_bf16_f32 v32, v32, v33
v_cvt_pk_bf16_f32 v33, v34, v35
v_exp_f32 v36, v36
v_exp_f32 v37, v37
v_exp_f32 v38, v38
v_exp_f32 v39, v39
v_cvt_pk_bf16_f32 v34, v48, v49
v_cvt_pk_bf16_f32 v35, v50, v51
v_exp_f32 v52, v52
v_exp_f32 v53, v53
v_exp_f32 v54, v54
v_exp_f32 v55, v55
v_cvt_pk_bf16_f32 v36, v36, v37
v_cvt_pk_bf16_f32 v37, v38, v39
v_exp_f32 v40, v40
v_exp_f32 v41, v41
v_exp_f32 v42, v42
v_exp_f32 v43, v43
v_cvt_pk_bf16_f32 v38, v52, v53
v_cvt_pk_bf16_f32 v39, v54, v55
v_exp_f32 v56, v56
v_exp_f32 v57, v57
v_exp_f32 v58, v58
v_exp_f32 v59, v59
v_cvt_pk_bf16_f32 v40, v40, v41
v_cvt_pk_bf16_f32 v41, v42, v43
v_exp_f32 v44, v44
v_exp_f32 v45, v45
v_exp_f32 v46, v46
v_exp_f32 v47, v47
v_cvt_pk_bf16_f32 v42, v56, v57
v_cvt_pk_bf16_f32 v43, v58, v59
v_exp_f32 v60, v60
v_exp_f32 v61, v61
v_exp_f32 v62, v62
v_exp_f32 v63, v63
v_cvt_pk_bf16_f32 v44, v44, v45
v_cvt_pk_bf16_f32 v45, v46, v47
v_cvt_pk_bf16_f32 v46, v60, v61
v_cvt_pk_bf16_f32 v47, v62, v63
v_exp_f32 v64, v64
v_exp_f32 v65, v65
v_exp_f32 v66, v66
v_exp_f32 v67, v67
v_exp_f32 v80, v80
v_exp_f32 v81, v81
v_exp_f32 v82, v82
v_exp_f32 v83, v83
v_cvt_pk_bf16_f32 v64, v64, v65
v_cvt_pk_bf16_f32 v65, v66, v67
v_exp_f32 v68, v68
v_exp_f32 v69, v69
v_exp_f32 v70, v70
v_exp_f32 v71, v71
v_cvt_pk_bf16_f32 v66, v80, v81
v_cvt_pk_bf16_f32 v67, v82, v83
v_exp_f32 v84, v84
v_exp_f32 v85, v85
v_exp_f32 v86, v86
v_exp_f32 v87, v87
v_cvt_pk_bf16_f32 v68, v68, v69
v_cvt_pk_bf16_f32 v69, v70, v71
v_exp_f32 v72, v72
v_exp_f32 v73, v73
v_exp_f32 v74, v74
v_exp_f32 v75, v75
v_cvt_pk_bf16_f32 v70, v84, v85
v_cvt_pk_bf16_f32 v71, v86, v87
v_exp_f32 v88, v88
v_exp_f32 v89, v89
v_exp_f32 v90, v90
v_exp_f32 v91, v91
v_cvt_pk_bf16_f32 v72, v72, v73
v_cvt_pk_bf16_f32 v73, v74, v75
v_exp_f32 v76, v76
v_exp_f32 v77, v77
v_exp_f32 v78, v78
v_exp_f32 v79, v79
v_cvt_pk_bf16_f32 v74, v88, v89
v_cvt_pk_bf16_f32 v75, v90, v91
v_exp_f32 v92, v92
v_exp_f32 v93, v93
v_exp_f32 v94, v94
v_exp_f32 v95, v95
v_cvt_pk_bf16_f32 v76, v76, v77
v_cvt_pk_bf16_f32 v77, v78, v79
v_cvt_pk_bf16_f32 v78, v92, v93
v_cvt_pk_bf16_f32 v79, v94, v95
s_waitcnt vmcnt(0)
M a[96:99], a[112:115], v[32:35], a[96:99]
M a[100:103], a[112:115], v[36:39], a[100:103]
M a[104:107], a[112:115], v[40:43], a[104:107]
M a[108:111], a[112:115], v[44:47], a[108:111]
M v[160:163], v[96:99], v[32:35], v[160:163]
M v[164:167], v[96:99], v[36:39], v[164:167]
M v[168:171], v[96:99], v[40:43], v[168:171]
M v[172:175], v[96:99], v[44:47], v[172:175]
M v[176:179], v[100:103], v[32:35], v[176:179]
M v[180:183], v[100:103], v[36:39], v[180:183]
M v[184:187], v[100:103], v[40:43], v[184:187]
M v[188:191], v[100:103], v[44:47], v[188:191]
M v[192:195], v[104:107], v[32:35], v[192:195]
M v[196:199], v[104:107], v[36:39], v[196:199]
M v[200:203], v[104:107], v[40:43], v[200:203]
M v[204:207], v[104:107], v[44:47], v[204:207]
M v[208:211], v[108:111], v[32:35], v[208:211]
M v[212:215], v[108:111], v[36:39], v[212:215]
M v[216:219], v[108:111], v[40:43], v[216:219]
M v[220:223], v[108:111], v[44:47], v[220:223]
M v[224:227], v[112:115], v[32:35], v[224:227]
M v[228:231], v[112:115], v[36:39], v[228:231]
M v[232:235], v[112:115], v[40:43], v[232:235]
M v[236:239], v[112:115], v[44:47], v[236:239]
M v[240:243], v[116:119], v[32:35], v[240:243]
M v[244:247], v[116:119], v[36:39], v[244:247]
M v[248:251], v[116:119], v[40:43], v[248:251]
M v[252:255], v[116:119], v[44:47], v[252:255]
M a[64:67], v[120:123], v[32:35], a[64:67]
M a[68:71], v[120:123], v[36:39], a[68:71]
M a[72:75], v[120:123], v[40:43], a[72:75]
M a[76:79], v[120:123], v[44:47], a[76:79]
M a[80:83], v[124:127], v[32:35], a[80:83]
M a[84:87], v[124:127], v[36:39], a[84:87]
M a[88:91], v[124:127], v[40:43], a[88:91]
M a[92:95], v[124:127], v[44:47], a[92:95]
M a[96:99], a[112:115], v[64:67], a[96:99]
M a[100:103], a[112:115], v[68:71], a[100:103]
M a[104:107], a[112:115], v[72:75], a[104:107]
M a[108:111], a[112:115], v[76:79], a[108:111]
M v[160:163], v[128:131], v[64:67], v[160:163]
M v[164:167], v[128:131], v[68:71], v[164:167]
M v[168:171], v[128:131], v[72:75], v[168:171]
M v[172:175], v[128:131], v[76:79], v[172:175]
M v[176:179], v[132:135], v[64:67], v[176:179]
M v[180:183], v[132:135], v[68:71], v[180:183]
M v[184:187], v[132:135], v[72:75], v[184:187]
M v[188:191], v[132:135], v[76:79], v[188:191]
M v[192:195], v[136:139], v[64:67], v[192:195]
M v[196:199], v[136:139], v[68:71], v[196:199]
M v[200:203], v[136:139], v[72:75], v[200:203]
M v[204:207], v[136:139], v[76:79], v[204:207]
M v[208:211], v[140:143], v[64:67], v[208:211]
M v[212:215], v[140:143], v[68:71], v[212:215]
M v[216:219], v[140:143], v[72:75], v[216:219]
M v[220:223], v[140:143], v[76:79], v[220:223]
M v[224:227], v[144:147], v[64:67], v[224:227]
M v[228:231], v[144:147], v[68:71], v[228:231]
M v[232:235], v[144:147], v[72:75], v[232:235]
M v[236:239], v[144:147], v[76:79], v[236:239]
M v[240:243], v[148:151], v[64:67], v[240:243]
M v[244:247], v[148:151], v[68:71], v[244:247]
M v[248:251], v[148:151], v[72:75], v[248:251]
M v[252:255], v[148:151], v[76:79], v[252:255]
M a[64:67], v[152:155], v[64:67], a[64:67]
M a[68:71], v[152:155], v[68:71], a[68:71]
M a[72:75], v[152:155], v[72:75], a[72:75]
M a[76:79], v[152:155], v[76:79], a[76:79]
M a[80:83], v[156:159], v[64:67], a[80:83]
M a[84:87], v[156:159], v[68:71], a[84:87]
M a[88:91], v[156:159], v[72:75], a[88:91]
M a[92:95], v[156:159], v[76:79], a[92:95]
s_nop 7
s_add_u32 s57, s57, 32768
s_sub_u32 s58, s58, 64
s_sub_u32 s59, s59, 1
s_cmp_lg_u32 s59, 0
s_cbranch_scc1 Lslow_2
v_accvgpr_read_b32 v20, a96
v_accvgpr_read_b32 v21, a100
v_accvgpr_read_b32 v22, a104
v_accvgpr_read_b32 v23, a108
v_rcp_f32 v8, v20
v_rcp_f32 v9, v21
v_rcp_f32 v10, v22
v_rcp_f32 v11, v23
s_lshl_b32 s33, s56, 20
s_lshl_b32 s34, s20, 15
s_add_u32 s33, s33, s34
s_lshl_b32 s34, s23, 13
s_add_u32 s36, s33, s34
s_add_u32 s37, s36, 4096
s_add_u32 s38, s36, 16384
s_add_u32 s39, s36, 20480
v_pk_mul_f32 v[160:161], v[160:161], v[8:9] op_sel:[0,0] op_sel_hi:[1,0]
v_pk_mul_f32 v[162:163], v[162:163], v[8:9] op_sel:[0,0] op_sel_hi:[1,0]
v_pk_mul_f32 v[176:177], v[176:177], v[8:9] op_sel:[0,0] op_sel_hi:[1,0]
v_pk_mul_f32 v[178:179], v[178:179], v[8:9] op_sel:[0,0] op_sel_hi:[1,0]
v_cvt_pk_bf16_f32 v160, v160, v161
v_cvt_pk_bf16_f32 v161, v162, v163
v_cvt_pk_bf16_f32 v162, v176, v177
v_cvt_pk_bf16_f32 v163, v178, v179
v_pk_mul_f32 v[164:165], v[164:165], v[8:9] op_sel:[0,1] op_sel_hi:[1,1]
v_pk_mul_f32 v[166:167], v[166:167], v[8:9] op_sel:[0,1] op_sel_hi:[1,1]
v_pk_mul_f32 v[180:181], v[180:181], v[8:9] op_sel:[0,1] op_sel_hi:[1,1]
v_pk_mul_f32 v[182:183], v[182:183], v[8:9] op_sel:[0,1] op_sel_hi:[1,1]
v_cvt_pk_bf16_f32 v164, v164, v165
v_cvt_pk_bf16_f32 v165, v166, v167
v_cvt_pk_bf16_f32 v166, v180, v181
v_cvt_pk_bf16_f32 v167, v182, v183
v_pk_mul_f32 v[168:169], v[168:169], v[10:11] op_sel:[0,0] op_sel_hi:[1,0]
v_pk_mul_f32 v[170:171], v[170:171], v[10:11] op_sel:[0,0] op_sel_hi:[1,0]
v_pk_mul_f32 v[184:185], v[184:185], v[10:11] op_sel:[0,0] op_sel_hi:[1,0]
v_pk_mul_f32 v[186:187], v[186:187], v[10:11] op_sel:[0,0] op_sel_hi:[1,0]
v_cvt_pk_bf16_f32 v168, v168, v169
v_cvt_pk_bf16_f32 v169, v170, v171
v_cvt_pk_bf16_f32 v170, v184, v185
v_cvt_pk_bf16_f32 v171, v186, v187
v_pk_mul_f32 v[172:173], v[172:173], v[10:11] op_sel:[0,1] op_sel_hi:[1,1]
v_pk_mul_f32 v[174:175], v[174:175], v[10:11] op_sel:[0,1] op_sel_hi:[1,1]
v_pk_mul_f32 v[188:189], v[188:189], v[10:11] op_sel:[0,1] op_sel_hi:[1,1]
v_pk_mul_f32 v[190:191], v[190:191], v[10:11] op_sel:[0,1] op_sel_hi:[1,1]
v_cvt_pk_bf16_f32 v172, v172, v173
v_cvt_pk_bf16_f32 v173, v174, v175
v_cvt_pk_bf16_f32 v174, v188, v189
v_cvt_pk_bf16_f32 v175, v190, v191
v_pk_mul_f32 v[192:193], v[192:193], v[8:9] op_sel:[0,0] op_sel_hi:[1,0]
v_pk_mul_f32 v[194:195], v[194:195], v[8:9] op_sel:[0,0] op_sel_hi:[1,0]
v_pk_mul_f32 v[208:209], v[208:209], v[8:9] op_sel:[0,0] op_sel_hi:[1,0]
v_pk_mul_f32 v[210:211], v[210:211], v[8:9] op_sel:[0,0] op_sel_hi:[1,0]
v_cvt_pk_bf16_f32 v192, v192, v193
v_cvt_pk_bf16_f32 v193, v194, v195
v_cvt_pk_bf16_f32 v194, v208, v209
v_cvt_pk_bf16_f32 v195, v210, v211
v_pk_mul_f32 v[196:197], v[196:197], v[8:9] op_sel:[0,1] op_sel_hi:[1,1]
v_pk_mul_f32 v[198:199], v[198:199], v[8:9] op_sel:[0,1] op_sel_hi:[1,1]
v_pk_mul_f32 v[212:213], v[212:213], v[8:9] op_sel:[0,1] op_sel_hi:[1,1]
v_pk_mul_f32 v[214:215], v[214:215], v[8:9] op_sel:[0,1] op_sel_hi:[1,1]
v_cvt_pk_bf16_f32 v196, v196, v197
v_cvt_pk_bf16_f32 v197, v198, v199
v_cvt_pk_bf16_f32 v198, v212, v213
v_cvt_pk_bf16_f32 v199, v214, v215
v_pk_mul_f32 v[200:201], v[200:201], v[10:11] op_sel:[0,0] op_sel_hi:[1,0]
v_pk_mul_f32 v[202:203], v[202:203], v[10:11] op_sel:[0,0] op_sel_hi:[1,0]
v_pk_mul_f32 v[216:217], v[216:217], v[10:11] op_sel:[0,0] op_sel_hi:[1,0]
v_pk_mul_f32 v[218:219], v[218:219], v[10:11] op_sel:[0,0] op_sel_hi:[1,0]
v_cvt_pk_bf16_f32 v200, v200, v201
v_cvt_pk_bf16_f32 v201, v202, v203
v_cvt_pk_bf16_f32 v202, v216, v217
v_cvt_pk_bf16_f32 v203, v218, v219
v_pk_mul_f32 v[204:205], v[204:205], v[10:11] op_sel:[0,1] op_sel_hi:[1,1]
v_pk_mul_f32 v[206:207], v[206:207], v[10:11] op_sel:[0,1] op_sel_hi:[1,1]
v_pk_mul_f32 v[220:221], v[220:221], v[10:11] op_sel:[0,1] op_sel_hi:[1,1]
v_pk_mul_f32 v[222:223], v[222:223], v[10:11] op_sel:[0,1] op_sel_hi:[1,1]
v_cvt_pk_bf16_f32 v204, v204, v205
v_cvt_pk_bf16_f32 v205, v206, v207
v_cvt_pk_bf16_f32 v206, v220, v221
v_cvt_pk_bf16_f32 v207, v222, v223
v_pk_mul_f32 v[224:225], v[224:225], v[8:9] op_sel:[0,0] op_sel_hi:[1,0]
v_pk_mul_f32 v[226:227], v[226:227], v[8:9] op_sel:[0,0] op_sel_hi:[1,0]
v_pk_mul_f32 v[240:241], v[240:241], v[8:9] op_sel:[0,0] op_sel_hi:[1,0]
v_pk_mul_f32 v[242:243], v[242:243], v[8:9] op_sel:[0,0] op_sel_hi:[1,0]
v_cvt_pk_bf16_f32 v224, v224, v225
v_cvt_pk_bf16_f32 v225, v226, v227
v_cvt_pk_bf16_f32 v226, v240, v241
v_cvt_pk_bf16_f32 v227, v242, v243
v_pk_mul_f32 v[228:229], v[228:229], v[8:9] op_sel:[0,1] op_sel_hi:[1,1]
v_pk_mul_f32 v[230:231], v[230:231], v[8:9] op_sel:[0,1] op_sel_hi:[1,1]
v_pk_mul_f32 v[244:245], v[244:245], v[8:9] op_sel:[0,1] op_sel_hi:[1,1]
v_pk_mul_f32 v[246:247], v[246:247], v[8:9] op_sel:[0,1] op_sel_hi:[1,1]
v_cvt_pk_bf16_f32 v228, v228, v229
v_cvt_pk_bf16_f32 v229, v230, v231
v_cvt_pk_bf16_f32 v230, v244, v245
v_cvt_pk_bf16_f32 v231, v246, v247
v_pk_mul_f32 v[232:233], v[232:233], v[10:11] op_sel:[0,0] op_sel_hi:[1,0]
v_pk_mul_f32 v[234:235], v[234:235], v[10:11] op_sel:[0,0] op_sel_hi:[1,0]
v_pk_mul_f32 v[248:249], v[248:249], v[10:11] op_sel:[0,0] op_sel_hi:[1,0]
v_pk_mul_f32 v[250:251], v[250:251], v[10:11] op_sel:[0,0] op_sel_hi:[1,0]
v_cvt_pk_bf16_f32 v232, v232, v233
v_cvt_pk_bf16_f32 v233, v234, v235
v_cvt_pk_bf16_f32 v234, v248, v249
v_cvt_pk_bf16_f32 v235, v250, v251
v_pk_mul_f32 v[236:237], v[236:237], v[10:11] op_sel:[0,1] op_sel_hi:[1,1]
v_pk_mul_f32 v[238:239], v[238:239], v[10:11] op_sel:[0,1] op_sel_hi:[1,1]
v_pk_mul_f32 v[252:253], v[252:253], v[10:11] op_sel:[0,1] op_sel_hi:[1,1]
v_pk_mul_f32 v[254:255], v[254:255], v[10:11] op_sel:[0,1] op_sel_hi:[1,1]
v_cvt_pk_bf16_f32 v236, v236, v237
v_cvt_pk_bf16_f32 v237, v238, v239
v_cvt_pk_bf16_f32 v238, v252, v253
v_cvt_pk_bf16_f32 v239, v254, v255
v_accvgpr_read_b32 v176, a64
v_accvgpr_read_b32 v177, a65
v_accvgpr_read_b32 v178, a66
v_accvgpr_read_b32 v179, a67
v_accvgpr_read_b32 v180, a80
v_accvgpr_read_b32 v181, a81
v_accvgpr_read_b32 v182, a82
v_accvgpr_read_b32 v183, a83
v_pk_mul_f32 v[176:177], v[176:177], v[8:9] op_sel:[0,0] op_sel_hi:[1,0]
v_pk_mul_f32 v[178:179], v[178:179], v[8:9] op_sel:[0,0] op_sel_hi:[1,0]
v_pk_mul_f32 v[180:181], v[180:181], v[8:9] op_sel:[0,0] op_sel_hi:[1,0]
v_pk_mul_f32 v[182:183], v[182:183], v[8:9] op_sel:[0,0] op_sel_hi:[1,0]
v_cvt_pk_bf16_f32 v176, v176, v177
v_cvt_pk_bf16_f32 v177, v178, v179
v_cvt_pk_bf16_f32 v178, v180, v181
v_cvt_pk_bf16_f32 v179, v182, v183
v_accvgpr_read_b32 v184, a68
v_accvgpr_read_b32 v185, a69
v_accvgpr_read_b32 v186, a70
v_accvgpr_read_b32 v187, a71
v_accvgpr_read_b32 v188, a84
v_accvgpr_read_b32 v189, a85
v_accvgpr_read_b32 v190, a86
v_accvgpr_read_b32 v191, a87
v_pk_mul_f32 v[184:185], v[184:185], v[8:9] op_sel:[0,1] op_sel_hi:[1,1]
v_pk_mul_f32 v[186:187], v[186:187], v[8:9] op_sel:[0,1] op_sel_hi:[1,1]
v_pk_mul_f32 v[188:189], v[188:189], v[8:9] op_sel:[0,1] op_sel_hi:[1,1]
v_pk_mul_f32 v[190:191], v[190:191], v[8:9] op_sel:[0,1] op_sel_hi:[1,1]
v_cvt_pk_bf16_f32 v184, v184, v185
v_cvt_pk_bf16_f32 v185, v186, v187
v_cvt_pk_bf16_f32 v186, v188, v189
v_cvt_pk_bf16_f32 v187, v190, v191
v_accvgpr_read_b32 v208, a72
v_accvgpr_read_b32 v209, a73
v_accvgpr_read_b32 v210, a74
v_accvgpr_read_b32 v211, a75
v_accvgpr_read_b32 v212, a88
v_accvgpr_read_b32 v213, a89
v_accvgpr_read_b32 v214, a90
v_accvgpr_read_b32 v215, a91
v_pk_mul_f32 v[208:209], v[208:209], v[10:11] op_sel:[0,0] op_sel_hi:[1,0]
v_pk_mul_f32 v[210:211], v[210:211], v[10:11] op_sel:[0,0] op_sel_hi:[1,0]
v_pk_mul_f32 v[212:213], v[212:213], v[10:11] op_sel:[0,0] op_sel_hi:[1,0]
v_pk_mul_f32 v[214:215], v[214:215], v[10:11] op_sel:[0,0] op_sel_hi:[1,0]
v_cvt_pk_bf16_f32 v208, v208, v209
v_cvt_pk_bf16_f32 v209, v210, v211
v_cvt_pk_bf16_f32 v210, v212, v213
v_cvt_pk_bf16_f32 v211, v214, v215
v_accvgpr_read_b32 v216, a76
v_accvgpr_read_b32 v217, a77
v_accvgpr_read_b32 v218, a78
v_accvgpr_read_b32 v219, a79
v_accvgpr_read_b32 v220, a92
v_accvgpr_read_b32 v221, a93
v_accvgpr_read_b32 v222, a94
v_accvgpr_read_b32 v223, a95
v_pk_mul_f32 v[216:217], v[216:217], v[10:11] op_sel:[0,1] op_sel_hi:[1,1]
v_pk_mul_f32 v[218:219], v[218:219], v[10:11] op_sel:[0,1] op_sel_hi:[1,1]
v_pk_mul_f32 v[220:221], v[220:221], v[10:11] op_sel:[0,1] op_sel_hi:[1,1]
v_pk_mul_f32 v[222:223], v[222:223], v[10:11] op_sel:[0,1] op_sel_hi:[1,1]
v_cvt_pk_bf16_f32 v216, v216, v217
v_cvt_pk_bf16_f32 v217, v218, v219
v_cvt_pk_bf16_f32 v218, v220, v221
v_cvt_pk_bf16_f32 v219, v222, v223
s_bitcmp1_b32 s61, 0
s_cbranch_scc0 Lss_3
buffer_store_dwordx4 v[160:163], v1, s[16:19], s36 offen offset:0 sc1
buffer_store_dwordx4 v[164:167], v1, s[16:19], s36 offen offset:2048 sc1
buffer_store_dwordx4 v[168:171], v1, s[16:19], s37 offen offset:0 sc1
buffer_store_dwordx4 v[172:175], v1, s[16:19], s37 offen offset:2048 sc1
Lss_3:
s_bitcmp1_b32 s61, 1
s_cbranch_scc0 Lss_4
buffer_store_dwordx4 v[192:195], v1, s[16:19], s36 offen offset:1024 sc1
buffer_store_dwordx4 v[196:199], v1, s[16:19], s36 offen offset:3072 sc1
buffer_store_dwordx4 v[200:203], v1, s[16:19], s37 offen offset:1024 sc1
buffer_store_dwordx4 v[204:207], v1, s[16:19], s37 offen offset:3072 sc1
Lss_4:
s_bitcmp1_b32 s61, 2
s_cbranch_scc0 Lss_5
buffer_store_dwordx4 v[224:227], v1, s[16:19], s38 offen offset:0 sc1
buffer_store_dwordx4 v[228:231], v1, s[16:19], s38 offen offset:2048 sc1
buffer_store_dwordx4 v[232:235], v1, s[16:19], s39 offen offset:0 sc1
buffer_store_dwordx4 v[236:239], v1, s[16:19], s39 offen offset:2048 sc1
Lss_5:
s_bitcmp1_b32 s61, 3
s_cbranch_scc0 Lss_6
buffer_store_dwordx4 v[176:179], v1, s[16:19], s38 offen offset:1024 sc1
buffer_store_dwordx4 v[184:187], v1, s[16:19], s38 offen offset:3072 sc1
buffer_store_dwordx4 v[208:211], v1, s[16:19], s39 offen offset:1024 sc1
buffer_store_dwordx4 v[216:219], v1, s[16:19], s39 offen offset:3072 sc1
Lss_6:
s_branch Lk2_chk
Lk2_done:
s_lshl_b32 s33, s20, 4
s_add_u32 s33, s33, 16781312
s_sub_u32 s34, 15, s21
s_lshl_b32 s34, s34, 9
s_add_u32 s92, s33, s34
s_lshl_b32 s34, s22, 2
s_add_u32 s92, s92, s34
s_lshl_b32 s34, s21, 9
s_add_u32 s93, s33, s34
s_lshl_b32 s34, s23, 3
s_add_u32 s93, s93, s34
s_cmp_eq_u32 s24, 0
s_cselect_b32 s93, s93, s92
s_cselect_b32 s94, 4, 0
s_add_u32 s94, s94, s93
s_load_dwordx2 s[10:11], s[0:1], 40
s_load_dwordx2 s[14:15], s[0:1], 72
s_lshl_b32 s21, s27, 7
s_lshl_b32 s22, s28, 6
s_lshl_b32 s3, s101, 4
v_lshrrev_b32 v232, 3, v0
v_and_b32 v233, 6, v232
v_and_b32 v234, 7, v0
v_xor_b32 v233, v233, v234
v_add_u32 v232, s3, v232
v_lshlrev_b32 v232, 11, v232
v_lshl_add_u32 v6, v233, 4, v232
v_add_u32 v7, 15360, v6
s_add_u32 m0, s42, 49152
s_nop 0
buffer_load_dwordx4 v6, s[48:51], s26 offen offset:0 lds
buffer_load_dwordx4 v7, s[48:51], s26 offen offset:1024 lds
buffer_load_dwordx4 a[96:99], v1, s[44:47], s25 offen offset:0 sc1
buffer_load_dwordx4 a[100:103], v1, s[44:47], s25 offen offset:1024 sc1
buffer_load_dwordx4 a[104:107], v1, s[44:47], s25 offen offset:2048 sc1
buffer_load_dwordx4 a[108:111], v1, s[44:47], s25 offen offset:3072 sc1
s_add_u32 s25, s25, 16384
s_add_u32 s26, s26, 131072
s_add_u32 m0, s42, 65536
s_nop 0
buffer_load_dwordx4 v6, s[48:51], s26 offen offset:0 lds
buffer_load_dwordx4 v7, s[48:51], s26 offen offset:1024 lds
buffer_load_dwordx4 a[128:131], v1, s[44:47], s25 offen offset:0 sc1
buffer_load_dwordx4 a[132:135], v1, s[44:47], s25 offen offset:1024 sc1
buffer_load_dwordx4 a[136:139], v1, s[44:47], s25 offen offset:2048 sc1
buffer_load_dwordx4 a[140:143], v1, s[44:47], s25 offen offset:3072 sc1
s_add_u32 s25, s25, 16384
s_add_u32 s26, s26, 131072
v_lshrrev_b32 v232, 2, v0
v_and_b32 v234, 1, v0
v_bfe_u32 v237, v0, 1, 1
v_lshlrev_b32 v233, 7, v232
v_lshl_add_u32 v233, v234, 3, v233
v_and_b32 v236, 6, v232
v_add_u32 v235, 0, v237
v_xor_b32 v235, v235, v236
v_lshl_add_u32 v24, v235, 4, v233
v_add_u32 v28, 0x10000, v24
v_add_u32 v235, 2, v237
v_xor_b32 v235, v235, v236
v_lshl_add_u32 v25, v235, 4, v233
v_add_u32 v29, 0x10000, v25
v_add_u32 v235, 4, v237
v_xor_b32 v235, v235, v236
v_lshl_add_u32 v26, v235, 4, v233
v_add_u32 v30, 0x10000, v26
v_add_u32 v235, 6, v237
v_xor_b32 v235, v235, v236
v_lshl_add_u32 v27, v235, 4, v233
v_add_u32 v31, 0x10000, v27
s_waitcnt vmcnt(26)
s_barrier
ds_read_b64_tr_b16 a[32:33], v24 offset:16384
ds_read_b64_tr_b16 a[34:35], v24 offset:18432
ds_read_b64_tr_b16 a[36:37], v24 offset:20480
ds_read_b64_tr_b16 a[38:39], v24 offset:22528
ds_read_b64_tr_b16 a[40:41], v25 offset:16384
ds_read_b64_tr_b16 a[42:43], v25 offset:18432
ds_read_b64_tr_b16 a[44:45], v25 offset:20480
ds_read_b64_tr_b16 a[46:47], v25 offset:22528
ds_read_b64_tr_b16 a[48:49], v26 offset:16384
ds_read_b64_tr_b16 a[50:51], v26 offset:18432
ds_read_b64_tr_b16 a[52:53], v26 offset:20480
ds_read_b64_tr_b16 a[54:55], v26 offset:22528
ds_read_b64_tr_b16 a[56:57], v27 offset:16384
ds_read_b64_tr_b16 a[58:59], v27 offset:18432
ds_read_b64_tr_b16 a[60:61], v27 offset:20480
ds_read_b64_tr_b16 a[62:63], v27 offset:22528
s_and_b32 s40, s2, 3
s_bfe_u32 s36, s2, 0x30003
s_lshl_b32 s29, s36, 8
s_bfe_u32 s3, s2, 0x10002
s_lshl_b32 s3, s3, 2
s_lshr_b32 s37, s2, 6
s_add_u32 s3, s3, s37
s_lshl_b32 s13, s3, 8
s_lshl_b32 s30, s3, 7
s_lshl_b32 s3, s40, 5
s_add_u32 s30, s30, s3
s_lshl_b32 s41, s101, 12
s_lshl_b32 s12, s36, 21
s_lshr_b32 s3, s101, 1
s_lshl_b32 s3, s3, 20
s_add_u32 s12, s12, s3
s_and_b32 s3, s101, 1
s_lshl_b32 s3, s3, 13
s_add_u32 s12, s12, s3
s_lshl_b32 s62, s36, 10
s_lshl_b32 s3, s40, 7
s_add_u32 s62, s62, s3
s_add_u32 s62, s62, 16781312
s_bfe_u32 s3, s2, 0x10002
s_lshl_b32 s3, s3, 3
s_sub_u32 s39, 16, s3
s_lshl_b32 s38, s40, 4
s_add_u32 s3, s3, s38
s_lshl_b32 s3, s3, 14
s_add_u32 s12, s12, s3
s_lshl_b32 s3, s3, 3
s_add_u32 s13, s13, s3
s_mov_b32 s64, 4294721536
s_mov_b32 s65, 16384
s_add_u32 s8, s4, 67108864
s_addc_u32 s9, s5, 0
s_lshl_b32 s56, s2, 16
s_lshl_b32 s38, s101, 14
s_add_u32 s56, s56, s38
s_lshl_b32 s58, s2, 4
s_lshl_b32 s38, s101, 2
s_add_u32 s58, s58, s38
s_add_u32 s58, s58, 16777216
s_and_b32 s59, s58, 0xffffffcf
s_mov_b32 s61, 0
s_lshl_b32 s3, s101, 4
v_lshrrev_b32 v240, 4, v0
v_and_b32 v242, 15, v0
v_add_u32 v241, 0, v240
v_lshlrev_b32 v241, 1, v241
v_xor_b32 v241, v241, v242
v_add_u32 v243, s3, v240
v_lshlrev_b32 v243, 11, v243
v_lshl_add_u32 v243, v241, 4, v243
v_add_u32 v2, 0, v243
v_add_u32 v241, 4, v240
v_lshlrev_b32 v241, 1, v241
v_xor_b32 v241, v241, v242
v_add_u32 v243, s3, v240
v_lshlrev_b32 v243, 11, v243
v_lshl_add_u32 v243, v241, 4, v243
v_add_u32 v3, 7168, v243
v_add_u32 v241, 0, v240
v_lshlrev_b32 v241, 1, v241
v_xor_b32 v241, v241, v242
v_add_u32 v243, s3, v240
v_lshlrev_b32 v243, 11, v243
v_lshl_add_u32 v243, v241, 4, v243
v_add_u32 v4, 14336, v243
v_add_u32 v241, 4, v240
v_lshlrev_b32 v241, 1, v241
v_xor_b32 v241, v241, v242
v_add_u32 v243, s3, v240
v_lshlrev_b32 v243, 11, v243
v_lshl_add_u32 v243, v241, 4, v243
v_add_u32 v5, 21504, v243
v_lshlrev_b32 v233, 8, v232
v_lshl_add_u32 v233, v234, 3, v233
v_and_b32 v236, 7, v232
v_lshlrev_b32 v236, 1, v236
s_lshl_b32 s38, s40, 2
v_xor_b32 v236, s38, v236
v_add_u32 v235, 0, v237
v_xor_b32 v235, v235, v236
v_lshl_add_u32 v8, v235, 4, v233
v_add_u32 v16, 0x10000, v8
v_add_u32 v235, 2, v237
v_xor_b32 v235, v235, v236
v_lshl_add_u32 v9, v235, 4, v233
v_add_u32 v17, 0x10000, v9
v_add_u32 v235, 4, v237
v_xor_b32 v235, v235, v236
v_lshl_add_u32 v10, v235, 4, v233
v_add_u32 v18, 0x10000, v10
v_add_u32 v235, 6, v237
v_xor_b32 v235, v235, v236
v_lshl_add_u32 v11, v235, 4, v233
v_add_u32 v19, 0x10000, v11
v_add_u32 v235, 8, v237
v_xor_b32 v235, v235, v236
v_lshl_add_u32 v12, v235, 4, v233
v_add_u32 v20, 0x10000, v12
v_add_u32 v235, 10, v237
v_xor_b32 v235, v235, v236
v_lshl_add_u32 v13, v235, 4, v233
v_add_u32 v21, 0x10000, v13
v_add_u32 v235, 12, v237
v_xor_b32 v235, v235, v236
v_lshl_add_u32 v14, v235, 4, v233
v_add_u32 v22, 0x10000, v14
v_add_u32 v235, 14, v237
v_xor_b32 v235, v235, v236
v_lshl_add_u32 v15, v235, 4, v233
v_add_u32 v23, 0x10000, v15
v_mov_b32 v253, 0
v_mov_b32 v254, 1
v_and_b32 v255, 31, v0
v_lshlrev_b32 v255, 2, v255
v_lshrrev_b32 v252, 5, v0
v_lshl_add_u32 v255, v252, 9, v255
s_waitcnt lgkmcnt(0)
s_mov_b32 s16, s14
s_mov_b32 s17, s15
s_mov_b32 s18, 8388608
s_mov_b32 s19, 0x00020000
s_waitcnt vmcnt(20) lgkmcnt(0)
s_barrier
s_waitcnt vmcnt(12)
s_mov_b64 exec, 1
buffer_store_dword v254, v253, s[52:55], s92 offen sc1
buffer_store_dword v254, v253, s[52:55], s93 offen sc1
buffer_store_dword v254, v253, s[52:55], s94 offen sc1
s_mov_b64 exec, -1
M a[0:3], a[32:35], a[192:195], 0
s_add_u32 m0, s42, 81920
s_nop 0
buffer_load_dwordx4 v6, s[48:51], s26 offen offset:0 lds
ds_read_b64_tr_b16 v[160:161], v24 offset:32768
ds_read_b64_tr_b16 v[162:163], v24 offset:34816
M a[0:3], a[36:39], a[196:199], a[0:3]
buffer_load_dwordx4 v7, s[48:51], s26 offen offset:1024 lds
M a[4:7], a[44:47], a[196:199], 0
ds_read_b64_tr_b16 v[164:165], v24 offset:36864
ds_read_b64_tr_b16 v[166:167], v24 offset:38912
M a[4:7], a[40:43], a[192:195], a[4:7]
buffer_load_dwordx4 a[160:163], v1, s[44:47], s25 offen offset:0 sc1
M a[8:11], a[48:51], a[192:195], 0
ds_read_b64_tr_b16 v[168:169], v25 offset:32768
ds_read_b64_tr_b16 v[170:171], v25 offset:34816
M a[8:11], a[52:55], a[196:199], a[8:11]
buffer_load_dwordx4 a[164:167], v1, s[44:47], s25 offen offset:1024 sc1
M a[12:15], a[60:63], a[196:199], 0
ds_read_b64_tr_b16 v[172:173], v25 offset:36864
ds_read_b64_tr_b16 v[174:175], v25 offset:38912
M a[12:15], a[56:59], a[192:195], a[12:15]
buffer_load_dwordx4 a[168:171], v1, s[44:47], s25 offen offset:2048 sc1
M a[16:19], a[32:35], a[200:203], 0
ds_read_b64_tr_b16 v[176:177], v26 offset:32768
ds_read_b64_tr_b16 v[178:179], v26 offset:34816
M a[16:19], a[36:39], a[204:207], a[16:19]
buffer_load_dwordx4 a[172:175], v1, s[44:47], s25 offen offset:3072 sc1
M a[20:23], a[44:47], a[204:207], 0
ds_read_b64_tr_b16 v[180:181], v26 offset:36864
ds_read_b64_tr_b16 v[182:183], v26 offset:38912
M a[20:23], a[40:43], a[200:203], a[20:23]
s_add_u32 s25, s25, 16384
s_add_u32 s26, s26, 131072
M a[24:27], a[48:51], a[200:203], 0
ds_read_b64_tr_b16 v[184:185], v27 offset:32768
ds_read_b64_tr_b16 v[186:187], v27 offset:34816
M a[24:27], a[52:55], a[204:207], a[24:27]
ds_read_b64_tr_b16 v[188:189], v27 offset:36864
ds_read_b64_tr_b16 v[190:191], v27 offset:38912
M a[28:31], a[60:63], a[204:207], 0
M a[28:31], a[56:59], a[200:203], a[28:31]
s_waitcnt vmcnt(15) lgkmcnt(0)
s_barrier
M a[0:3], v[160:163], a[224:227], a[0:3]
s_add_u32 m0, s42, 98304
s_nop 0
buffer_load_dwordx4 v6, s[48:51], s26 offen offset:0 lds
ds_read_b64_tr_b16 a[32:33], v24 offset:49152
ds_read_b64_tr_b16 a[34:35], v24 offset:51200
M a[0:3], v[164:167], a[228:231], a[0:3]
buffer_load_dwordx4 v7, s[48:51], s26 offen offset:1024 lds
M a[4:7], v[172:175], a[228:231], a[4:7]
ds_read_b64_tr_b16 a[36:37], v24 offset:53248
ds_read_b64_tr_b16 a[38:39], v24 offset:55296
M a[4:7], v[168:171], a[224:227], a[4:7]
buffer_load_dwordx4 a[192:195], v1, s[44:47], s25 offen offset:0 sc1
M a[8:11], v[176:179], a[224:227], a[8:11]
ds_read_b64_tr_b16 a[40:41], v25 offset:49152
ds_read_b64_tr_b16 a[42:43], v25 offset:51200
M a[8:11], v[180:183], a[228:231], a[8:11]
buffer_load_dwordx4 a[196:199], v1, s[44:47], s25 offen offset:1024 sc1
M a[12:15], v[188:191], a[228:231], a[12:15]
ds_read_b64_tr_b16 a[44:45], v25 offset:53248
ds_read_b64_tr_b16 a[46:47], v25 offset:55296
M a[12:15], v[184:187], a[224:227], a[12:15]
buffer_load_dwordx4 a[200:203], v1, s[44:47], s25 offen offset:2048 sc1
M a[16:19], v[160:163], a[232:235], a[16:19]
ds_read_b64_tr_b16 a[48:49], v26 offset:49152
ds_read_b64_tr_b16 a[50:51], v26 offset:51200
M a[16:19], v[164:167], a[236:239], a[16:19]
buffer_load_dwordx4 a[204:207], v1, s[44:47], s25 offen offset:3072 sc1
M a[20:23], v[172:175], a[236:239], a[20:23]
ds_read_b64_tr_b16 a[52:53], v26 offset:53248
ds_read_b64_tr_b16 a[54:55], v26 offset:55296
M a[20:23], v[168:171], a[232:235], a[20:23]
s_add_u32 s25, s25, 16384
s_add_u32 s26, s26, 131072
M a[24:27], v[176:179], a[232:235], a[24:27]
ds_read_b64_tr_b16 a[56:57], v27 offset:49152
ds_read_b64_tr_b16 a[58:59], v27 offset:51200
M a[24:27], v[180:183], a[236:239], a[24:27]
ds_read_b64_tr_b16 a[60:61], v27 offset:53248
ds_read_b64_tr_b16 a[62:63], v27 offset:55296
M a[28:31], v[188:191], a[236:239], a[28:31]
M a[28:31], v[184:187], a[232:235], a[28:31]
s_waitcnt vmcnt(15) lgkmcnt(0)
s_barrier
M a[0:3], a[32:35], a[96:99], a[0:3]
s_add_u32 m0, s42, 114688
s_nop 0
buffer_load_dwordx4 v6, s[48:51], s26 offen offset:0 lds
ds_read_b64_tr_b16 v[160:161], v28 offset:0
ds_read_b64_tr_b16 v[162:163], v28 offset:2048
M a[0:3], a[36:39], a[100:103], a[0:3]
buffer_load_dwordx4 v7, s[48:51], s26 offen offset:1024 lds
M a[4:7], a[44:47], a[100:103], a[4:7]
ds_read_b64_tr_b16 v[164:165], v28 offset:4096
ds_read_b64_tr_b16 v[166:167], v28 offset:6144
M a[4:7], a[40:43], a[96:99], a[4:7]
buffer_load_dwordx4 a[224:227], v1, s[44:47], s25 offen offset:0 sc1
M a[8:11], a[48:51], a[96:99], a[8:11]
ds_read_b64_tr_b16 v[168:169], v29 offset:0
ds_read_b64_tr_b16 v[170:171], v29 offset:2048
M a[8:11], a[52:55], a[100:103], a[8:11]
buffer_load_dwordx4 a[228:231], v1, s[44:47], s25 offen offset:1024 sc1
M a[12:15], a[60:63], a[100:103], a[12:15]
ds_read_b64_tr_b16 v[172:173], v29 offset:4096
ds_read_b64_tr_b16 v[174:175], v29 offset:6144
M a[12:15], a[56:59], a[96:99], a[12:15]
buffer_load_dwordx4 a[232:235], v1, s[44:47], s25 offen offset:2048 sc1
ds_read_b64_tr_b16 v[176:177], v30 offset:0
ds_read_b64_tr_b16 v[178:179], v30 offset:2048
M a[16:19], a[32:35], a[104:107], a[16:19]
buffer_load_dwordx4 a[236:239], v1, s[44:47], s25 offen offset:3072 sc1
M a[16:19], a[36:39], a[108:111], a[16:19]
ds_read_b64_tr_b16 v[180:181], v30 offset:4096
ds_read_b64_tr_b16 v[182:183], v30 offset:6144
M a[20:23], a[44:47], a[108:111], a[20:23]
s_add_u32 s25, s25, 16384
s_add_u32 s26, s26, 131072
M a[20:23], a[40:43], a[104:107], a[20:23]
ds_read_b64_tr_b16 v[184:185], v31 offset:0
ds_read_b64_tr_b16 v[186:187], v31 offset:2048
M a[24:27], a[48:51], a[104:107], a[24:27]
buffer_load_dword v252, v255, s[52:55], s62 offen sc1
M a[24:27], a[52:55], a[108:111], a[24:27]
ds_read_b64_tr_b16 v[188:189], v31 offset:4096
ds_read_b64_tr_b16 v[190:191], v31 offset:6144
M a[28:31], a[60:63], a[108:111], a[28:31]
M a[28:31], a[56:59], a[104:107], a[28:31]
s_waitcnt vmcnt(13) lgkmcnt(0)
s_barrier
s_waitcnt vmcnt(0)
v_cmp_ne_u32 vcc, 1, v252
s_nop 0
s_cbranch_vccnz Lk3_spinft
Lk3_gotft:
M a[0:3], v[160:163], a[128:131], a[0:3]
s_mov_b32 s32, s25
s_mov_b32 s33, s26
s_mov_b64 s[34:35], s[44:45]
s_mov_b64 s[36:37], s[48:49]
s_mov_b64 s[44:45], s[8:9]
s_mov_b32 s46, 16777216
s_mov_b64 s[48:49], s[10:11]
s_mov_b32 s50, 8388608
s_mov_b32 s25, s12
s_mov_b32 s26, s13
s_add_u32 m0, s41, 0
s_nop 0
buffer_load_dwordx4 v2, s[48:51], s26 offen offset:0 lds
ds_read_b64_tr_b16 a[32:33], v28 offset:16384
ds_read_b64_tr_b16 a[34:35], v28 offset:18432
M a[0:3], v[164:167], a[132:135], a[0:3]
buffer_load_dwordx4 v3, s[48:51], s26 offen offset:1024 lds
ds_read_b64_tr_b16 a[36:37], v28 offset:20480
ds_read_b64_tr_b16 a[38:39], v28 offset:22528
M a[4:7], v[172:175], a[132:135], a[4:7]
buffer_load_dwordx4 v4, s[48:51], s26 offen offset:2048 lds
M a[4:7], v[168:171], a[128:131], a[4:7]
ds_read_b64_tr_b16 a[40:41], v29 offset:16384
ds_read_b64_tr_b16 a[42:43], v29 offset:18432
buffer_load_dwordx4 v5, s[48:51], s26 offen offset:3072 lds
M a[8:11], v[176:179], a[128:131], a[8:11]
ds_read_b64_tr_b16 a[44:45], v29 offset:20480
ds_read_b64_tr_b16 a[46:47], v29 offset:22528
M a[8:11], v[180:183], a[132:135], a[8:11]
buffer_load_dwordx4 a[96:99], v1, s[44:47], s25 offen offset:0 sc1
ds_read_b64_tr_b16 a[48:49], v30 offset:16384
ds_read_b64_tr_b16 a[50:51], v30 offset:18432
M a[12:15], v[188:191], a[132:135], a[12:15]
buffer_load_dwordx4 a[100:103], v1, s[44:47], s25 offen offset:1024 sc1
M a[12:15], v[184:187], a[128:131], a[12:15]
ds_read_b64_tr_b16 a[52:53], v30 offset:20480
ds_read_b64_tr_b16 a[54:55], v30 offset:22528
buffer_load_dwordx4 a[104:107], v1, s[44:47], s25 offen offset:2048 sc1
M a[16:19], v[160:163], a[136:139], a[16:19]
ds_read_b64_tr_b16 a[56:57], v31 offset:16384
ds_read_b64_tr_b16 a[58:59], v31 offset:18432
buffer_load_dwordx4 a[108:111], v1, s[44:47], s25 offen offset:3072 sc1
M a[16:19], v[164:167], a[140:143], a[16:19]
ds_read_b64_tr_b16 a[60:61], v31 offset:20480
ds_read_b64_tr_b16 a[62:63], v31 offset:22528
M a[20:23], v[172:175], a[140:143], a[20:23]
s_add_u32 s63, s25, 4096
buffer_load_dwordx4 a[112:115], v1, s[44:47], s63 offen offset:0 sc1
buffer_load_dwordx4 a[116:119], v1, s[44:47], s63 offen offset:1024 sc1
M a[20:23], v[168:171], a[136:139], a[20:23]
buffer_load_dwordx4 a[120:123], v1, s[44:47], s63 offen offset:2048 sc1
M a[24:27], v[176:179], a[136:139], a[24:27]
buffer_load_dwordx4 a[124:127], v1, s[44:47], s63 offen offset:3072 sc1
s_sub_u32 s39, s39, 1
s_cmp_eq_u32 s39, 0
s_cselect_b32 s3, s64, s65
M a[24:27], v[180:183], a[140:143], a[24:27]
s_add_u32 s25, s25, s3
s_lshl_b32 s3, s3, 3
s_add_u32 s26, s26, s3
M a[28:31], v[188:191], a[140:143], a[28:31]
M a[28:31], v[184:187], a[136:139], a[28:31]
s_waitcnt vmcnt(19) lgkmcnt(0)
s_barrier
M a[0:3], a[32:35], a[160:163], a[0:3]
s_add_u32 m0, s41, 16384
s_nop 0
buffer_load_dwordx4 v2, s[48:51], s26 offen offset:0 lds
ds_read_b64_tr_b16 v[160:161], v28 offset:32768
ds_read_b64_tr_b16 v[162:163], v28 offset:34816
M a[0:3], a[36:39], a[164:167], a[0:3]
buffer_load_dwordx4 v3, s[48:51], s26 offen offset:1024 lds
ds_read_b64_tr_b16 v[164:165], v28 offset:36864
ds_read_b64_tr_b16 v[166:167], v28 offset:38912
M a[4:7], a[44:47], a[164:167], a[4:7]
buffer_load_dwordx4 v4, s[48:51], s26 offen offset:2048 lds
M a[4:7], a[40:43], a[160:163], a[4:7]
ds_read_b64_tr_b16 v[168:169], v29 offset:32768
ds_read_b64_tr_b16 v[170:171], v29 offset:34816
buffer_load_dwordx4 v5, s[48:51], s26 offen offset:3072 lds
M a[8:11], a[48:51], a[160:163], a[8:11]
ds_read_b64_tr_b16 v[172:173], v29 offset:36864
ds_read_b64_tr_b16 v[174:175], v29 offset:38912
M a[8:11], a[52:55], a[164:167], a[8:11]
buffer_load_dwordx4 a[128:131], v1, s[44:47], s25 offen offset:0 sc1
ds_read_b64_tr_b16 v[176:177], v30 offset:32768
ds_read_b64_tr_b16 v[178:179], v30 offset:34816
M a[12:15], a[60:63], a[164:167], a[12:15]
buffer_load_dwordx4 a[132:135], v1, s[44:47], s25 offen offset:1024 sc1
M a[12:15], a[56:59], a[160:163], a[12:15]
ds_read_b64_tr_b16 v[180:181], v30 offset:36864
ds_read_b64_tr_b16 v[182:183], v30 offset:38912
buffer_load_dwordx4 a[136:139], v1, s[44:47], s25 offen offset:2048 sc1
M a[16:19], a[32:35], a[168:171], a[16:19]
ds_read_b64_tr_b16 v[184:185], v31 offset:32768
ds_read_b64_tr_b16 v[186:187], v31 offset:34816
buffer_load_dwordx4 a[140:143], v1, s[44:47], s25 offen offset:3072 sc1
M a[16:19], a[36:39], a[172:175], a[16:19]
ds_read_b64_tr_b16 v[188:189], v31 offset:36864
ds_read_b64_tr_b16 v[190:191], v31 offset:38912
M a[20:23], a[44:47], a[172:175], a[20:23]
s_add_u32 s63, s25, 4096
buffer_load_dwordx4 a[144:147], v1, s[44:47], s63 offen offset:0 sc1
buffer_load_dwordx4 a[148:151], v1, s[44:47], s63 offen offset:1024 sc1
M a[20:23], a[40:43], a[168:171], a[20:23]
buffer_load_dwordx4 a[152:155], v1, s[44:47], s63 offen offset:2048 sc1
M a[24:27], a[48:51], a[168:171], a[24:27]
buffer_load_dwordx4 a[156:159], v1, s[44:47], s63 offen offset:3072 sc1
s_sub_u32 s39, s39, 1
s_cmp_eq_u32 s39, 0
s_cselect_b32 s3, s64, s65
M a[24:27], a[52:55], a[172:175], a[24:27]
s_add_u32 s25, s25, s3
s_lshl_b32 s3, s3, 3
s_add_u32 s26, s26, s3
M a[28:31], a[60:63], a[172:175], a[28:31]
M a[28:31], a[56:59], a[168:171], a[28:31]
s_waitcnt vmcnt(25) lgkmcnt(0)
s_barrier
M a[0:3], v[160:163], a[192:195], a[0:3]
s_add_u32 m0, s41, 32768
s_nop 0
buffer_load_dwordx4 v2, s[48:51], s26 offen offset:0 lds
ds_read_b64_tr_b16 a[32:33], v28 offset:49152
ds_read_b64_tr_b16 a[34:35], v28 offset:51200
M a[0:3], v[164:167], a[196:199], a[0:3]
buffer_load_dwordx4 v3, s[48:51], s26 offen offset:1024 lds
ds_read_b64_tr_b16 a[36:37], v28 offset:53248
ds_read_b64_tr_b16 a[38:39], v28 offset:55296
M a[4:7], v[172:175], a[196:199], a[4:7]
buffer_load_dwordx4 v4, s[48:51], s26 offen offset:2048 lds
M a[4:7], v[168:171], a[192:195], a[4:7]
ds_read_b64_tr_b16 a[40:41], v29 offset:49152
ds_read_b64_tr_b16 a[42:43], v29 offset:51200
buffer_load_dwordx4 v5, s[48:51], s26 offen offset:3072 lds
M a[8:11], v[176:179], a[192:195], a[8:11]
ds_read_b64_tr_b16 a[44:45], v29 offset:53248
ds_read_b64_tr_b16 a[46:47], v29 offset:55296
M a[8:11], v[180:183], a[196:199], a[8:11]
buffer_load_dwordx4 a[160:163], v1, s[44:47], s25 offen offset:0 sc1
ds_read_b64_tr_b16 a[48:49], v30 offset:49152
ds_read_b64_tr_b16 a[50:51], v30 offset:51200
M a[12:15], v[188:191], a[196:199], a[12:15]
buffer_load_dwordx4 a[164:167], v1, s[44:47], s25 offen offset:1024 sc1
M a[12:15], v[184:187], a[192:195], a[12:15]
ds_read_b64_tr_b16 a[52:53], v30 offset:53248
ds_read_b64_tr_b16 a[54:55], v30 offset:55296
buffer_load_dwordx4 a[168:171], v1, s[44:47], s25 offen offset:2048 sc1
M a[16:19], v[160:163], a[200:203], a[16:19]
ds_read_b64_tr_b16 a[56:57], v31 offset:49152
ds_read_b64_tr_b16 a[58:59], v31 offset:51200
buffer_load_dwordx4 a[172:175], v1, s[44:47], s25 offen offset:3072 sc1
M a[16:19], v[164:167], a[204:207], a[16:19]
ds_read_b64_tr_b16 a[60:61], v31 offset:53248
ds_read_b64_tr_b16 a[62:63], v31 offset:55296
M a[20:23], v[172:175], a[204:207], a[20:23]
s_add_u32 s63, s25, 4096
buffer_load_dwordx4 a[176:179], v1, s[44:47], s63 offen offset:0 sc1
buffer_load_dwordx4 a[180:183], v1, s[44:47], s63 offen offset:1024 sc1
M a[20:23], v[168:171], a[200:203], a[20:23]
buffer_load_dwordx4 a[184:187], v1, s[44:47], s63 offen offset:2048 sc1
M a[24:27], v[176:179], a[200:203], a[24:27]
buffer_load_dwordx4 a[188:191], v1, s[44:47], s63 offen offset:3072 sc1
s_sub_u32 s39, s39, 1
s_cmp_eq_u32 s39, 0
s_cselect_b32 s3, s64, s65
M a[24:27], v[180:183], a[204:207], a[24:27]
s_add_u32 s25, s25, s3
s_lshl_b32 s3, s3, 3
s_add_u32 s26, s26, s3
M a[28:31], v[188:191], a[204:207], a[28:31]
M a[28:31], v[184:187], a[200:203], a[28:31]
s_waitcnt vmcnt(24) lgkmcnt(0)
s_barrier
M a[0:3], a[32:35], a[224:227], a[0:3]
s_add_u32 m0, s41, 49152
s_nop 0
buffer_load_dwordx4 v2, s[48:51], s26 offen offset:0 lds
ds_read_b64_tr_b16 v[160:161], v8 offset:0
ds_read_b64_tr_b16 v[162:163], v8 offset:4096
buffer_load_dwordx4 v3, s[48:51], s26 offen offset:1024 lds
M a[0:3], a[36:39], a[228:231], a[0:3]
ds_read_b64_tr_b16 v[164:165], v8 offset:8192
ds_read_b64_tr_b16 v[166:167], v8 offset:12288
buffer_load_dwordx4 v4, s[48:51], s26 offen offset:2048 lds
M a[4:7], a[44:47], a[228:231], a[4:7]
ds_read_b64_tr_b16 v[168:169], v9 offset:0
ds_read_b64_tr_b16 v[170:171], v9 offset:4096
buffer_load_dwordx4 v5, s[48:51], s26 offen offset:3072 lds
M a[4:7], a[40:43], a[224:227], a[4:7]
ds_read_b64_tr_b16 v[172:173], v9 offset:8192
ds_read_b64_tr_b16 v[174:175], v9 offset:12288
buffer_load_dwordx4 a[192:195], v1, s[44:47], s25 offen offset:0 sc1
M a[8:11], a[48:51], a[224:227], a[8:11]
ds_read_b64_tr_b16 v[176:177], v10 offset:0
ds_read_b64_tr_b16 v[178:179], v10 offset:4096
buffer_load_dwordx4 a[196:199], v1, s[44:47], s25 offen offset:1024 sc1
M a[8:11], a[52:55], a[228:231], a[8:11]
ds_read_b64_tr_b16 v[180:181], v10 offset:8192
ds_read_b64_tr_b16 v[182:183], v10 offset:12288
buffer_load_dwordx4 a[200:203], v1, s[44:47], s25 offen offset:2048 sc1
M a[12:15], a[60:63], a[228:231], a[12:15]
ds_read_b64_tr_b16 v[184:185], v11 offset:0
ds_read_b64_tr_b16 v[186:187], v11 offset:4096
buffer_load_dwordx4 a[204:207], v1, s[44:47], s25 offen offset:3072 sc1
M a[12:15], a[56:59], a[224:227], a[12:15]
ds_read_b64_tr_b16 v[188:189], v11 offset:8192
ds_read_b64_tr_b16 v[190:191], v11 offset:12288
s_add_u32 s63, s25, 4096
buffer_load_dwordx4 a[208:211], v1, s[44:47], s63 offen offset:0 sc1
ds_read_b64_tr_b16 v[192:193], v12 offset:0
ds_read_b64_tr_b16 v[194:195], v12 offset:4096
M a[16:19], a[32:35], a[232:235], a[16:19]
buffer_load_dwordx4 a[212:215], v1, s[44:47], s63 offen offset:1024 sc1
ds_read_b64_tr_b16 v[196:197], v12 offset:8192
ds_read_b64_tr_b16 v[198:199], v12 offset:12288
M a[16:19], a[36:39], a[236:239], a[16:19]
buffer_load_dwordx4 a[216:219], v1, s[44:47], s63 offen offset:2048 sc1
ds_read_b64_tr_b16 v[200:201], v13 offset:0
ds_read_b64_tr_b16 v[202:203], v13 offset:4096
M a[20:23], a[44:47], a[236:239], a[20:23]
buffer_load_dwordx4 a[220:223], v1, s[44:47], s63 offen offset:3072 sc1
ds_read_b64_tr_b16 v[204:205], v13 offset:8192
ds_read_b64_tr_b16 v[206:207], v13 offset:12288
M a[20:23], a[40:43], a[232:235], a[20:23]
s_sub_u32 s39, s39, 1
s_cmp_eq_u32 s39, 0
s_cselect_b32 s3, s64, s65
ds_read_b64_tr_b16 v[208:209], v14 offset:0
ds_read_b64_tr_b16 v[210:211], v14 offset:4096
M a[24:27], a[48:51], a[232:235], a[24:27]
s_add_u32 s25, s25, s3
s_lshl_b32 s3, s3, 3
s_add_u32 s26, s26, s3
ds_read_b64_tr_b16 v[212:213], v14 offset:8192
ds_read_b64_tr_b16 v[214:215], v14 offset:12288
M a[24:27], a[52:55], a[236:239], a[24:27]
ds_read_b64_tr_b16 v[216:217], v15 offset:0
ds_read_b64_tr_b16 v[218:219], v15 offset:4096
ds_read_b64_tr_b16 v[220:221], v15 offset:8192
ds_read_b64_tr_b16 v[222:223], v15 offset:12288
M a[28:31], a[60:63], a[236:239], a[28:31]
M a[28:31], a[56:59], a[232:235], a[28:31]
s_waitcnt vmcnt(24) lgkmcnt(0)
s_barrier
M v[32:35], v[160:163], a[96:99], 0
s_add_u32 m0, s41, 65536
s_nop 0
buffer_load_dwordx4 v2, s[48:51], s26 offen offset:0 lds
M v[32:35], v[164:167], a[100:103], v[32:35]
M v[36:39], v[172:175], a[100:103], 0
ds_read_b64_tr_b16 a[32:33], v8 offset:16384
ds_read_b64_tr_b16 a[34:35], v8 offset:20480
M v[36:39], v[168:171], a[96:99], v[36:39]
M v[40:43], v[176:179], a[96:99], 0
buffer_load_dwordx4 v3, s[48:51], s26 offen offset:1024 lds
M v[40:43], v[180:183], a[100:103], v[40:43]
M v[44:47], v[188:191], a[100:103], 0
ds_read_b64_tr_b16 a[36:37], v8 offset:24576
ds_read_b64_tr_b16 a[38:39], v8 offset:28672
M v[44:47], v[184:187], a[96:99], v[44:47]
M v[48:51], v[192:195], a[96:99], 0
buffer_load_dwordx4 v4, s[48:51], s26 offen offset:2048 lds
M v[48:51], v[196:199], a[100:103], v[48:51]
M v[52:55], v[204:207], a[100:103], 0
ds_read_b64_tr_b16 a[40:41], v9 offset:16384
ds_read_b64_tr_b16 a[42:43], v9 offset:20480
M v[52:55], v[200:203], a[96:99], v[52:55]
M v[56:59], v[208:211], a[96:99], 0
buffer_load_dwordx4 v5, s[48:51], s26 offen offset:3072 lds
M v[56:59], v[212:215], a[100:103], v[56:59]
M v[60:63], v[220:223], a[100:103], 0
ds_read_b64_tr_b16 a[44:45], v9 offset:24576
ds_read_b64_tr_b16 a[46:47], v9 offset:28672
M v[60:63], v[216:219], a[96:99], v[60:63]
M v[64:67], v[160:163], a[104:107], 0
buffer_load_dwordx4 a[224:227], v1, s[44:47], s25 offen offset:0 sc1
M v[64:67], v[164:167], a[108:111], v[64:67]
M v[68:71], v[172:175], a[108:111], 0
ds_read_b64_tr_b16 a[48:49], v10 offset:16384
ds_read_b64_tr_b16 a[50:51], v10 offset:20480
M v[68:71], v[168:171], a[104:107], v[68:71]
M v[72:75], v[176:179], a[104:107], 0
buffer_load_dwordx4 a[228:231], v1, s[44:47], s25 offen offset:1024 sc1
M v[72:75], v[180:183], a[108:111], v[72:75]
M v[76:79], v[188:191], a[108:111], 0
ds_read_b64_tr_b16 a[52:53], v10 offset:24576
ds_read_b64_tr_b16 a[54:55], v10 offset:28672
M v[76:79], v[184:187], a[104:107], v[76:79]
M v[80:83], v[192:195], a[104:107], 0
buffer_load_dwordx4 a[232:235], v1, s[44:47], s25 offen offset:2048 sc1
M v[80:83], v[196:199], a[108:111], v[80:83]
M v[84:87], v[204:207], a[108:111], 0
ds_read_b64_tr_b16 a[56:57], v11 offset:16384
ds_read_b64_tr_b16 a[58:59], v11 offset:20480
M v[84:87], v[200:203], a[104:107], v[84:87]
M v[88:91], v[208:211], a[104:107], 0
buffer_load_dwordx4 a[236:239], v1, s[44:47], s25 offen offset:3072 sc1
M v[88:91], v[212:215], a[108:111], v[88:91]
M v[92:95], v[220:223], a[108:111], 0
M v[92:95], v[216:219], a[104:107], v[92:95]
ds_read_b64_tr_b16 a[60:61], v11 offset:24576
ds_read_b64_tr_b16 a[62:63], v11 offset:28672
M v[96:99], v[160:163], a[112:115], 0
M v[96:99], v[164:167], a[116:119], v[96:99]
s_add_u32 s63, s25, 4096
buffer_load_dwordx4 a[240:243], v1, s[44:47], s63 offen offset:0 sc1
M v[100:103], v[172:175], a[116:119], 0
M v[100:103], v[168:171], a[112:115], v[100:103]
ds_read_b64_tr_b16 a[64:65], v12 offset:16384
ds_read_b64_tr_b16 a[66:67], v12 offset:20480
M v[104:107], v[176:179], a[112:115], 0
M v[104:107], v[180:183], a[116:119], v[104:107]
buffer_load_dwordx4 a[244:247], v1, s[44:47], s63 offen offset:1024 sc1
M v[108:111], v[188:191], a[116:119], 0
M v[108:111], v[184:187], a[112:115], v[108:111]
ds_read_b64_tr_b16 a[68:69], v12 offset:24576
ds_read_b64_tr_b16 a[70:71], v12 offset:28672
M v[112:115], v[192:195], a[112:115], 0
M v[112:115], v[196:199], a[116:119], v[112:115]
buffer_load_dwordx4 a[248:251], v1, s[44:47], s63 offen offset:2048 sc1
M v[116:119], v[204:207], a[116:119], 0
M v[116:119], v[200:203], a[112:115], v[116:119]
ds_read_b64_tr_b16 a[72:73], v13 offset:16384
ds_read_b64_tr_b16 a[74:75], v13 offset:20480
M v[120:123], v[208:211], a[112:115], 0
M v[120:123], v[212:215], a[116:119], v[120:123]
buffer_load_dwordx4 a[252:255], v1, s[44:47], s63 offen offset:3072 sc1
M v[124:127], v[220:223], a[116:119], 0
M v[124:127], v[216:219], a[112:115], v[124:127]
ds_read_b64_tr_b16 a[76:77], v13 offset:24576
ds_read_b64_tr_b16 a[78:79], v13 offset:28672
M v[128:131], v[160:163], a[120:123], 0
M v[128:131], v[164:167], a[124:127], v[128:131]
s_sub_u32 s39, s39, 1
s_cmp_eq_u32 s39, 0
s_cselect_b32 s3, s64, s65
M v[132:135], v[172:175], a[124:127], 0
M v[132:135], v[168:171], a[120:123], v[132:135]
ds_read_b64_tr_b16 a[80:81], v14 offset:16384
ds_read_b64_tr_b16 a[82:83], v14 offset:20480
M v[136:139], v[176:179], a[120:123], 0
M v[136:139], v[180:183], a[124:127], v[136:139]
s_add_u32 s25, s25, s3
s_lshl_b32 s3, s3, 3
s_add_u32 s26, s26, s3
M v[140:143], v[188:191], a[124:127], 0
M v[140:143], v[184:187], a[120:123], v[140:143]
ds_read_b64_tr_b16 a[84:85], v14 offset:24576
ds_read_b64_tr_b16 a[86:87], v14 offset:28672
M v[144:147], v[192:195], a[120:123], 0
M v[144:147], v[196:199], a[124:127], v[144:147]
ds_read_b64_tr_b16 a[88:89], v15 offset:16384
ds_read_b64_tr_b16 a[90:91], v15 offset:20480
M v[148:151], v[204:207], a[124:127], 0
M v[148:151], v[200:203], a[120:123], v[148:151]
ds_read_b64_tr_b16 a[92:93], v15 offset:24576
ds_read_b64_tr_b16 a[94:95], v15 offset:28672
M v[152:155], v[208:211], a[120:123], 0
M v[152:155], v[212:215], a[124:127], v[152:155]
M v[156:159], v[220:223], a[124:127], 0
M v[156:159], v[216:219], a[120:123], v[156:159]
s_waitcnt vmcnt(24) lgkmcnt(0)
s_barrier
M v[32:35], a[32:35], a[128:131], v[32:35]
s_add_u32 m0, s41, 81920
s_nop 0
buffer_load_dwordx4 v2, s[48:51], s26 offen offset:0 lds
M v[32:35], a[36:39], a[132:135], v[32:35]
M v[36:39], a[44:47], a[132:135], v[36:39]
ds_read_b64_tr_b16 v[160:161], v8 offset:32768
ds_read_b64_tr_b16 v[162:163], v8 offset:36864
M v[36:39], a[40:43], a[128:131], v[36:39]
M v[40:43], a[48:51], a[128:131], v[40:43]
buffer_load_dwordx4 v3, s[48:51], s26 offen offset:1024 lds
M v[40:43], a[52:55], a[132:135], v[40:43]
M v[44:47], a[60:63], a[132:135], v[44:47]
ds_read_b64_tr_b16 v[164:165], v8 offset:40960
ds_read_b64_tr_b16 v[166:167], v8 offset:45056
M v[44:47], a[56:59], a[128:131], v[44:47]
M v[48:51], a[64:67], a[128:131], v[48:51]
buffer_load_dwordx4 v4, s[48:51], s26 offen offset:2048 lds
M v[48:51], a[68:71], a[132:135], v[48:51]
M v[52:55], a[76:79], a[132:135], v[52:55]
ds_read_b64_tr_b16 v[168:169], v9 offset:32768
ds_read_b64_tr_b16 v[170:171], v9 offset:36864
M v[52:55], a[72:75], a[128:131], v[52:55]
M v[56:59], a[80:83], a[128:131], v[56:59]
buffer_load_dwordx4 v5, s[48:51], s26 offen offset:3072 lds
M v[56:59], a[84:87], a[132:135], v[56:59]
M v[60:63], a[92:95], a[132:135], v[60:63]
ds_read_b64_tr_b16 v[172:173], v9 offset:40960
ds_read_b64_tr_b16 v[174:175], v9 offset:45056
M v[60:63], a[88:91], a[128:131], v[60:63]
M v[64:67], a[32:35], a[136:139], v[64:67]
buffer_load_dwordx4 a[96:99], v1, s[44:47], s25 offen offset:0 sc1
M v[64:67], a[36:39], a[140:143], v[64:67]
M v[68:71], a[44:47], a[140:143], v[68:71]
ds_read_b64_tr_b16 v[176:177], v10 offset:32768
ds_read_b64_tr_b16 v[178:179], v10 offset:36864
M v[68:71], a[40:43], a[136:139], v[68:71]
M v[72:75], a[48:51], a[136:139], v[72:75]
buffer_load_dwordx4 a[100:103], v1, s[44:47], s25 offen offset:1024 sc1
M v[72:75], a[52:55], a[140:143], v[72:75]
M v[76:79], a[60:63], a[140:143], v[76:79]
ds_read_b64_tr_b16 v[180:181], v10 offset:40960
ds_read_b64_tr_b16 v[182:183], v10 offset:45056
M v[76:79], a[56:59], a[136:139], v[76:79]
M v[80:83], a[64:67], a[136:139], v[80:83]
buffer_load_dwordx4 a[104:107], v1, s[44:47], s25 offen offset:2048 sc1
M v[80:83], a[68:71], a[140:143], v[80:83]
M v[84:87], a[76:79], a[140:143], v[84:87]
ds_read_b64_tr_b16 v[184:185], v11 offset:32768
ds_read_b64_tr_b16 v[186:187], v11 offset:36864
M v[84:87], a[72:75], a[136:139], v[84:87]
M v[88:91], a[80:83], a[136:139], v[88:91]
buffer_load_dwordx4 a[108:111], v1, s[44:47], s25 offen offset:3072 sc1
M v[88:91], a[84:87], a[140:143], v[88:91]
M v[92:95], a[92:95], a[140:143], v[92:95]
M v[92:95], a[88:91], a[136:139], v[92:95]
ds_read_b64_tr_b16 v[188:189], v11 offset:40960
ds_read_b64_tr_b16 v[190:191], v11 offset:45056
M v[96:99], a[32:35], a[144:147], v[96:99]
M v[96:99], a[36:39], a[148:151], v[96:99]
s_add_u32 s63, s25, 4096
buffer_load_dwordx4 a[112:115], v1, s[44:47], s63 offen offset:0 sc1
M v[100:103], a[44:47], a[148:151], v[100:103]
M v[100:103], a[40:43], a[144:147], v[100:103]
ds_read_b64_tr_b16 v[192:193], v12 offset:32768
ds_read_b64_tr_b16 v[194:195], v12 offset:36864
M v[104:107], a[48:51], a[144:147], v[104:107]
M v[104:107], a[52:55], a[148:151], v[104:107]
buffer_load_dwordx4 a[116:119], v1, s[44:47], s63 offen offset:1024 sc1
M v[108:111], a[60:63], a[148:151], v[108:111]
M v[108:111], a[56:59], a[144:147], v[108:111]
ds_read_b64_tr_b16 v[196:197], v12 offset:40960
ds_read_b64_tr_b16 v[198:199], v12 offset:45056
M v[112:115], a[64:67], a[144:147], v[112:115]
M v[112:115], a[68:71], a[148:151], v[112:115]
buffer_load_dwordx4 a[120:123], v1, s[44:47], s63 offen offset:2048 sc1
M v[116:119], a[76:79], a[148:151], v[116:119]
M v[116:119], a[72:75], a[144:147], v[116:119]
ds_read_b64_tr_b16 v[200:201], v13 offset:32768
ds_read_b64_tr_b16 v[202:203], v13 offset:36864
M v[120:123], a[80:83], a[144:147], v[120:123]
M v[120:123], a[84:87], a[148:151], v[120:123]
buffer_load_dwordx4 a[124:127], v1, s[44:47], s63 offen offset:3072 sc1
M v[124:127], a[92:95], a[148:151], v[124:127]
M v[124:127], a[88:91], a[144:147], v[124:127]
ds_read_b64_tr_b16 v[204:205], v13 offset:40960
ds_read_b64_tr_b16 v[206:207], v13 offset:45056
M v[128:131], a[32:35], a[152:155], v[128:131]
M v[128:131], a[36:39], a[156:159], v[128:131]
s_sub_u32 s39, s39, 1
s_cmp_eq_u32 s39, 0
s_cselect_b32 s3, s64, s65
M v[132:135], a[44:47], a[156:159], v[132:135]
M v[132:135], a[40:43], a[152:155], v[132:135]
ds_read_b64_tr_b16 v[208:209], v14 offset:32768
ds_read_b64_tr_b16 v[210:211], v14 offset:36864
M v[136:139], a[48:51], a[152:155], v[136:139]
M v[136:139], a[52:55], a[156:159], v[136:139]
s_add_u32 s25, s25, s3
s_lshl_b32 s3, s3, 3
s_add_u32 s26, s26, s3
M v[140:143], a[60:63], a[156:159], v[140:143]
M v[140:143], a[56:59], a[152:155], v[140:143]
ds_read_b64_tr_b16 v[212:213], v14 offset:40960
ds_read_b64_tr_b16 v[214:215], v14 offset:45056
M v[144:147], a[64:67], a[152:155], v[144:147]
M v[144:147], a[68:71], a[156:159], v[144:147]
ds_read_b64_tr_b16 v[216:217], v15 offset:32768
ds_read_b64_tr_b16 v[218:219], v15 offset:36864
M v[148:151], a[76:79], a[156:159], v[148:151]
M v[148:151], a[72:75], a[152:155], v[148:151]
ds_read_b64_tr_b16 v[220:221], v15 offset:40960
ds_read_b64_tr_b16 v[222:223], v15 offset:45056
M v[152:155], a[80:83], a[152:155], v[152:155]
M v[152:155], a[84:87], a[156:159], v[152:155]
M v[156:159], a[92:95], a[156:159], v[156:159]
M v[156:159], a[88:91], a[152:155], v[156:159]
s_waitcnt vmcnt(24) lgkmcnt(0)
s_barrier
M v[32:35], v[160:163], a[160:163], v[32:35]
s_add_u32 m0, s41, 98304
s_nop 0
buffer_load_dwordx4 v2, s[48:51], s26 offen offset:0 lds
M v[32:35], v[164:167], a[164:167], v[32:35]
M v[36:39], v[172:175], a[164:167], v[36:39]
ds_read_b64_tr_b16 a[32:33], v8 offset:49152
ds_read_b64_tr_b16 a[34:35], v8 offset:53248
M v[36:39], v[168:171], a[160:163], v[36:39]
M v[40:43], v[176:179], a[160:163], v[40:43]
buffer_load_dwordx4 v3, s[48:51], s26 offen offset:1024 lds
M v[40:43], v[180:183], a[164:167], v[40:43]
M v[44:47], v[188:191], a[164:167], v[44:47]
ds_read_b64_tr_b16 a[36:37], v8 offset:57344
ds_read_b64_tr_b16 a[38:39], v8 offset:61440
M v[44:47], v[184:187], a[160:163], v[44:47]
M v[48:51], v[192:195], a[160:163], v[48:51]
buffer_load_dwordx4 v4, s[48:51], s26 offen offset:2048 lds
M v[48:51], v[196:199], a[164:167], v[48:51]
M v[52:55], v[204:207], a[164:167], v[52:55]
ds_read_b64_tr_b16 a[40:41], v9 offset:49152
ds_read_b64_tr_b16 a[42:43], v9 offset:53248
M v[52:55], v[200:203], a[160:163], v[52:55]
M v[56:59], v[208:211], a[160:163], v[56:59]
buffer_load_dwordx4 v5, s[48:51], s26 offen offset:3072 lds
M v[56:59], v[212:215], a[164:167], v[56:59]
M v[60:63], v[220:223], a[164:167], v[60:63]
ds_read_b64_tr_b16 a[44:45], v9 offset:57344
ds_read_b64_tr_b16 a[46:47], v9 offset:61440
M v[60:63], v[216:219], a[160:163], v[60:63]
M v[64:67], v[160:163], a[168:171], v[64:67]
buffer_load_dwordx4 a[128:131], v1, s[44:47], s25 offen offset:0 sc1
M v[64:67], v[164:167], a[172:175], v[64:67]
M v[68:71], v[172:175], a[172:175], v[68:71]
ds_read_b64_tr_b16 a[48:49], v10 offset:49152
ds_read_b64_tr_b16 a[50:51], v10 offset:53248
M v[68:71], v[168:171], a[168:171], v[68:71]
M v[72:75], v[176:179], a[168:171], v[72:75]
buffer_load_dwordx4 a[132:135], v1, s[44:47], s25 offen offset:1024 sc1
M v[72:75], v[180:183], a[172:175], v[72:75]
M v[76:79], v[188:191], a[172:175], v[76:79]
ds_read_b64_tr_b16 a[52:53], v10 offset:57344
ds_read_b64_tr_b16 a[54:55], v10 offset:61440
M v[76:79], v[184:187], a[168:171], v[76:79]
M v[80:83], v[192:195], a[168:171], v[80:83]
buffer_load_dwordx4 a[136:139], v1, s[44:47], s25 offen offset:2048 sc1
M v[80:83], v[196:199], a[172:175], v[80:83]
M v[84:87], v[204:207], a[172:175], v[84:87]
ds_read_b64_tr_b16 a[56:57], v11 offset:49152
ds_read_b64_tr_b16 a[58:59], v11 offset:53248
M v[84:87], v[200:203], a[168:171], v[84:87]
M v[88:91], v[208:211], a[168:171], v[88:91]
buffer_load_dwordx4 a[140:143], v1, s[44:47], s25 offen offset:3072 sc1
M v[88:91], v[212:215], a[172:175], v[88:91]
M v[92:95], v[220:223], a[172:175], v[92:95]
M v[92:95], v[216:219], a[168:171], v[92:95]
ds_read_b64_tr_b16 a[60:61], v11 offset:57344
ds_read_b64_tr_b16 a[62:63], v11 offset:61440
M v[96:99], v[160:163], a[176:179], v[96:99]
M v[96:99], v[164:167], a[180:183], v[96:99]
s_add_u32 s63, s25, 4096
buffer_load_dwordx4 a[144:147], v1, s[44:47], s63 offen offset:0 sc1
M v[100:103], v[172:175], a[180:183], v[100:103]
M v[100:103], v[168:171], a[176:179], v[100:103]
ds_read_b64_tr_b16 a[64:65], v12 offset:49152
ds_read_b64_tr_b16 a[66:67], v12 offset:53248
M v[104:107], v[176:179], a[176:179], v[104:107]
M v[104:107], v[180:183], a[180:183], v[104:107]
buffer_load_dwordx4 a[148:151], v1, s[44:47], s63 offen offset:1024 sc1
M v[108:111], v[188:191], a[180:183], v[108:111]
M v[108:111], v[184:187], a[176:179], v[108:111]
ds_read_b64_tr_b16 a[68:69], v12 offset:57344
ds_read_b64_tr_b16 a[70:71], v12 offset:61440
M v[112:115], v[192:195], a[176:179], v[112:115]
M v[112:115], v[196:199], a[180:183], v[112:115]
buffer_load_dwordx4 a[152:155], v1, s[44:47], s63 offen offset:2048 sc1
M v[116:119], v[204:207], a[180:183], v[116:119]
M v[116:119], v[200:203], a[176:179], v[116:119]
ds_read_b64_tr_b16 a[72:73], v13 offset:49152
ds_read_b64_tr_b16 a[74:75], v13 offset:53248
M v[120:123], v[208:211], a[176:179], v[120:123]
M v[120:123], v[212:215], a[180:183], v[120:123]
buffer_load_dwordx4 a[156:159], v1, s[44:47], s63 offen offset:3072 sc1
M v[124:127], v[220:223], a[180:183], v[124:127]
M v[124:127], v[216:219], a[176:179], v[124:127]
ds_read_b64_tr_b16 a[76:77], v13 offset:57344
ds_read_b64_tr_b16 a[78:79], v13 offset:61440
M v[128:131], v[160:163], a[184:187], v[128:131]
M v[128:131], v[164:167], a[188:191], v[128:131]
s_sub_u32 s39, s39, 1
s_cmp_eq_u32 s39, 0
s_cselect_b32 s3, s64, s65
M v[132:135], v[172:175], a[188:191], v[132:135]
M v[132:135], v[168:171], a[184:187], v[132:135]
ds_read_b64_tr_b16 a[80:81], v14 offset:49152
ds_read_b64_tr_b16 a[82:83], v14 offset:53248
M v[136:139], v[176:179], a[184:187], v[136:139]
M v[136:139], v[180:183], a[188:191], v[136:139]
s_add_u32 s25, s25, s3
s_lshl_b32 s3, s3, 3
s_add_u32 s26, s26, s3
M v[140:143], v[188:191], a[188:191], v[140:143]
M v[140:143], v[184:187], a[184:187], v[140:143]
ds_read_b64_tr_b16 a[84:85], v14 offset:57344
ds_read_b64_tr_b16 a[86:87], v14 offset:61440
M v[144:147], v[192:195], a[184:187], v[144:147]
M v[144:147], v[196:199], a[188:191], v[144:147]
ds_read_b64_tr_b16 a[88:89], v15 offset:49152
ds_read_b64_tr_b16 a[90:91], v15 offset:53248
M v[148:151], v[204:207], a[188:191], v[148:151]
M v[148:151], v[200:203], a[184:187], v[148:151]
ds_read_b64_tr_b16 a[92:93], v15 offset:57344
ds_read_b64_tr_b16 a[94:95], v15 offset:61440
M v[152:155], v[208:211], a[184:187], v[152:155]
M v[152:155], v[212:215], a[188:191], v[152:155]
M v[156:159], v[220:223], a[188:191], v[156:159]
M v[156:159], v[216:219], a[184:187], v[156:159]
s_waitcnt vmcnt(24) lgkmcnt(0)
s_barrier
M v[32:35], a[32:35], a[192:195], v[32:35]
s_add_u32 m0, s41, 114688
s_nop 0
buffer_load_dwordx4 v2, s[48:51], s26 offen offset:0 lds
M v[32:35], a[36:39], a[196:199], v[32:35]
M v[36:39], a[44:47], a[196:199], v[36:39]
ds_read_b64_tr_b16 v[160:161], v16 offset:0
ds_read_b64_tr_b16 v[162:163], v16 offset:4096
M v[36:39], a[40:43], a[192:195], v[36:39]
M v[40:43], a[48:51], a[192:195], v[40:43]
buffer_load_dwordx4 v3, s[48:51], s26 offen offset:1024 lds
M v[40:43], a[52:55], a[196:199], v[40:43]
M v[44:47], a[60:63], a[196:199], v[44:47]
ds_read_b64_tr_b16 v[164:165], v16 offset:8192
ds_read_b64_tr_b16 v[166:167], v16 offset:12288
M v[44:47], a[56:59], a[192:195], v[44:47]
M v[48:51], a[64:67], a[192:195], v[48:51]
buffer_load_dwordx4 v4, s[48:51], s26 offen offset:2048 lds
M v[48:51], a[68:71], a[196:199], v[48:51]
M v[52:55], a[76:79], a[196:199], v[52:55]
ds_read_b64_tr_b16 v[168:169], v17 offset:0
ds_read_b64_tr_b16 v[170:171], v17 offset:4096
M v[52:55], a[72:75], a[192:195], v[52:55]
M v[56:59], a[80:83], a[192:195], v[56:59]
buffer_load_dwordx4 v5, s[48:51], s26 offen offset:3072 lds
M v[56:59], a[84:87], a[196:199], v[56:59]
M v[60:63], a[92:95], a[196:199], v[60:63]
ds_read_b64_tr_b16 v[172:173], v17 offset:8192
ds_read_b64_tr_b16 v[174:175], v17 offset:12288
M v[60:63], a[88:91], a[192:195], v[60:63]
M v[64:67], a[32:35], a[200:203], v[64:67]
buffer_load_dwordx4 a[160:163], v1, s[44:47], s25 offen offset:0 sc1
M v[64:67], a[36:39], a[204:207], v[64:67]
M v[68:71], a[44:47], a[204:207], v[68:71]
ds_read_b64_tr_b16 v[176:177], v18 offset:0
ds_read_b64_tr_b16 v[178:179], v18 offset:4096
M v[68:71], a[40:43], a[200:203], v[68:71]
M v[72:75], a[48:51], a[200:203], v[72:75]
buffer_load_dwordx4 a[164:167], v1, s[44:47], s25 offen offset:1024 sc1
M v[72:75], a[52:55], a[204:207], v[72:75]
M v[76:79], a[60:63], a[204:207], v[76:79]
ds_read_b64_tr_b16 v[180:181], v18 offset:8192
ds_read_b64_tr_b16 v[182:183], v18 offset:12288
M v[76:79], a[56:59], a[200:203], v[76:79]
M v[80:83], a[64:67], a[200:203], v[80:83]
buffer_load_dwordx4 a[168:171], v1, s[44:47], s25 offen offset:2048 sc1
M v[80:83], a[68:71], a[204:207], v[80:83]
M v[84:87], a[76:79], a[204:207], v[84:87]
ds_read_b64_tr_b16 v[184:185], v19 offset:0
ds_read_b64_tr_b16 v[186:187], v19 offset:4096
M v[84:87], a[72:75], a[200:203], v[84:87]
M v[88:91], a[80:83], a[200:203], v[88:91]
buffer_load_dwordx4 a[172:175], v1, s[44:47], s25 offen offset:3072 sc1
M v[88:91], a[84:87], a[204:207], v[88:91]
M v[92:95], a[92:95], a[204:207], v[92:95]
M v[92:95], a[88:91], a[200:203], v[92:95]
ds_read_b64_tr_b16 v[188:189], v19 offset:8192
ds_read_b64_tr_b16 v[190:191], v19 offset:12288
M v[96:99], a[32:35], a[208:211], v[96:99]
M v[96:99], a[36:39], a[212:215], v[96:99]
s_add_u32 s63, s25, 4096
buffer_load_dwordx4 a[176:179], v1, s[44:47], s63 offen offset:0 sc1
M v[100:103], a[44:47], a[212:215], v[100:103]
M v[100:103], a[40:43], a[208:211], v[100:103]
ds_read_b64_tr_b16 v[192:193], v20 offset:0
ds_read_b64_tr_b16 v[194:195], v20 offset:4096
M v[104:107], a[48:51], a[208:211], v[104:107]
M v[104:107], a[52:55], a[212:215], v[104:107]
buffer_load_dwordx4 a[180:183], v1, s[44:47], s63 offen offset:1024 sc1
M v[108:111], a[60:63], a[212:215], v[108:111]
M v[108:111], a[56:59], a[208:211], v[108:111]
ds_read_b64_tr_b16 v[196:197], v20 offset:8192
ds_read_b64_tr_b16 v[198:199], v20 offset:12288
M v[112:115], a[64:67], a[208:211], v[112:115]
M v[112:115], a[68:71], a[212:215], v[112:115]
buffer_load_dwordx4 a[184:187], v1, s[44:47], s63 offen offset:2048 sc1
M v[116:119], a[76:79], a[212:215], v[116:119]
M v[116:119], a[72:75], a[208:211], v[116:119]
ds_read_b64_tr_b16 v[200:201], v21 offset:0
ds_read_b64_tr_b16 v[202:203], v21 offset:4096
M v[120:123], a[80:83], a[208:211], v[120:123]
M v[120:123], a[84:87], a[212:215], v[120:123]
buffer_load_dwordx4 a[188:191], v1, s[44:47], s63 offen offset:3072 sc1
M v[124:127], a[92:95], a[212:215], v[124:127]
M v[124:127], a[88:91], a[208:211], v[124:127]
ds_read_b64_tr_b16 v[204:205], v21 offset:8192
ds_read_b64_tr_b16 v[206:207], v21 offset:12288
M v[128:131], a[32:35], a[216:219], v[128:131]
M v[128:131], a[36:39], a[220:223], v[128:131]
s_sub_u32 s39, s39, 1
s_cmp_eq_u32 s39, 0
s_cselect_b32 s3, s64, s65
M v[132:135], a[44:47], a[220:223], v[132:135]
M v[132:135], a[40:43], a[216:219], v[132:135]
ds_read_b64_tr_b16 v[208:209], v22 offset:0
ds_read_b64_tr_b16 v[210:211], v22 offset:4096
M v[136:139], a[48:51], a[216:219], v[136:139]
M v[136:139], a[52:55], a[220:223], v[136:139]
s_add_u32 s25, s25, s3
s_lshl_b32 s3, s3, 3
s_add_u32 s26, s26, s3
M v[140:143], a[60:63], a[220:223], v[140:143]
M v[140:143], a[56:59], a[216:219], v[140:143]
ds_read_b64_tr_b16 v[212:213], v22 offset:8192
ds_read_b64_tr_b16 v[214:215], v22 offset:12288
M v[144:147], a[64:67], a[216:219], v[144:147]
M v[144:147], a[68:71], a[220:223], v[144:147]
ds_read_b64_tr_b16 v[216:217], v23 offset:0
ds_read_b64_tr_b16 v[218:219], v23 offset:4096
M v[148:151], a[76:79], a[220:223], v[148:151]
M v[148:151], a[72:75], a[216:219], v[148:151]
ds_read_b64_tr_b16 v[220:221], v23 offset:8192
ds_read_b64_tr_b16 v[222:223], v23 offset:12288
M v[152:155], a[80:83], a[216:219], v[152:155]
M v[152:155], a[84:87], a[220:223], v[152:155]
M v[156:159], a[92:95], a[220:223], v[156:159]
M v[156:159], a[88:91], a[216:219], v[156:159]
s_waitcnt vmcnt(24) lgkmcnt(0)
s_barrier
M v[32:35], v[160:163], a[224:227], v[32:35]
s_add_u32 m0, s41, 0
s_nop 0
buffer_load_dwordx4 v2, s[48:51], s26 offen offset:0 lds
M v[32:35], v[164:167], a[228:231], v[32:35]
M v[36:39], v[172:175], a[228:231], v[36:39]
ds_read_b64_tr_b16 a[32:33], v16 offset:16384
ds_read_b64_tr_b16 a[34:35], v16 offset:20480
M v[36:39], v[168:171], a[224:227], v[36:39]
M v[40:43], v[176:179], a[224:227], v[40:43]
buffer_load_dwordx4 v3, s[48:51], s26 offen offset:1024 lds
M v[40:43], v[180:183], a[228:231], v[40:43]
M v[44:47], v[188:191], a[228:231], v[44:47]
ds_read_b64_tr_b16 a[36:37], v16 offset:24576
ds_read_b64_tr_b16 a[38:39], v16 offset:28672
M v[44:47], v[184:187], a[224:227], v[44:47]
M v[48:51], v[192:195], a[224:227], v[48:51]
buffer_load_dwordx4 v4, s[48:51], s26 offen offset:2048 lds
M v[48:51], v[196:199], a[228:231], v[48:51]
M v[52:55], v[204:207], a[228:231], v[52:55]
ds_read_b64_tr_b16 a[40:41], v17 offset:16384
ds_read_b64_tr_b16 a[42:43], v17 offset:20480
M v[52:55], v[200:203], a[224:227], v[52:55]
M v[56:59], v[208:211], a[224:227], v[56:59]
buffer_load_dwordx4 v5, s[48:51], s26 offen offset:3072 lds
M v[56:59], v[212:215], a[228:231], v[56:59]
M v[60:63], v[220:223], a[228:231], v[60:63]
ds_read_b64_tr_b16 a[44:45], v17 offset:24576
ds_read_b64_tr_b16 a[46:47], v17 offset:28672
M v[60:63], v[216:219], a[224:227], v[60:63]
M v[64:67], v[160:163], a[232:235], v[64:67]
buffer_load_dwordx4 a[192:195], v1, s[44:47], s25 offen offset:0 sc1
M v[64:67], v[164:167], a[236:239], v[64:67]
M v[68:71], v[172:175], a[236:239], v[68:71]
ds_read_b64_tr_b16 a[48:49], v18 offset:16384
ds_read_b64_tr_b16 a[50:51], v18 offset:20480
M v[68:71], v[168:171], a[232:235], v[68:71]
M v[72:75], v[176:179], a[232:235], v[72:75]
buffer_load_dwordx4 a[196:199], v1, s[44:47], s25 offen offset:1024 sc1
M v[72:75], v[180:183], a[236:239], v[72:75]
M v[76:79], v[188:191], a[236:239], v[76:79]
ds_read_b64_tr_b16 a[52:53], v18 offset:24576
ds_read_b64_tr_b16 a[54:55], v18 offset:28672
M v[76:79], v[184:187], a[232:235], v[76:79]
M v[80:83], v[192:195], a[232:235], v[80:83]
buffer_load_dwordx4 a[200:203], v1, s[44:47], s25 offen offset:2048 sc1
M v[80:83], v[196:199], a[236:239], v[80:83]
M v[84:87], v[204:207], a[236:239], v[84:87]
ds_read_b64_tr_b16 a[56:57], v19 offset:16384
ds_read_b64_tr_b16 a[58:59], v19 offset:20480
M v[84:87], v[200:203], a[232:235], v[84:87]
M v[88:91], v[208:211], a[232:235], v[88:91]
buffer_load_dwordx4 a[204:207], v1, s[44:47], s25 offen offset:3072 sc1
M v[88:91], v[212:215], a[236:239], v[88:91]
M v[92:95], v[220:223], a[236:239], v[92:95]
M v[92:95], v[216:219], a[232:235], v[92:95]
ds_read_b64_tr_b16 a[60:61], v19 offset:24576
ds_read_b64_tr_b16 a[62:63], v19 offset:28672
M v[96:99], v[160:163], a[240:243], v[96:99]
M v[96:99], v[164:167], a[244:247], v[96:99]
s_add_u32 s63, s25, 4096
buffer_load_dwordx4 a[208:211], v1, s[44:47], s63 offen offset:0 sc1
M v[100:103], v[172:175], a[244:247], v[100:103]
M v[100:103], v[168:171], a[240:243], v[100:103]
ds_read_b64_tr_b16 a[64:65], v20 offset:16384
ds_read_b64_tr_b16 a[66:67], v20 offset:20480
M v[104:107], v[176:179], a[240:243], v[104:107]
M v[104:107], v[180:183], a[244:247], v[104:107]
buffer_load_dwordx4 a[212:215], v1, s[44:47], s63 offen offset:1024 sc1
M v[108:111], v[188:191], a[244:247], v[108:111]
M v[108:111], v[184:187], a[240:243], v[108:111]
ds_read_b64_tr_b16 a[68:69], v20 offset:24576
ds_read_b64_tr_b16 a[70:71], v20 offset:28672
M v[112:115], v[192:195], a[240:243], v[112:115]
M v[112:115], v[196:199], a[244:247], v[112:115]
buffer_load_dwordx4 a[216:219], v1, s[44:47], s63 offen offset:2048 sc1
M v[116:119], v[204:207], a[244:247], v[116:119]
M v[116:119], v[200:203], a[240:243], v[116:119]
ds_read_b64_tr_b16 a[72:73], v21 offset:16384
ds_read_b64_tr_b16 a[74:75], v21 offset:20480
M v[120:123], v[208:211], a[240:243], v[120:123]
M v[120:123], v[212:215], a[244:247], v[120:123]
buffer_load_dwordx4 a[220:223], v1, s[44:47], s63 offen offset:3072 sc1
M v[124:127], v[220:223], a[244:247], v[124:127]
M v[124:127], v[216:219], a[240:243], v[124:127]
ds_read_b64_tr_b16 a[76:77], v21 offset:24576
ds_read_b64_tr_b16 a[78:79], v21 offset:28672
M v[128:131], v[160:163], a[248:251], v[128:131]
M v[128:131], v[164:167], a[252:255], v[128:131]
s_sub_u32 s39, s39, 1
s_cmp_eq_u32 s39, 0
s_cselect_b32 s3, s64, s65
M v[132:135], v[172:175], a[252:255], v[132:135]
M v[132:135], v[168:171], a[248:251], v[132:135]
ds_read_b64_tr_b16 a[80:81], v22 offset:16384
ds_read_b64_tr_b16 a[82:83], v22 offset:20480
M v[136:139], v[176:179], a[248:251], v[136:139]
M v[136:139], v[180:183], a[252:255], v[136:139]
s_add_u32 s25, s25, s3
s_lshl_b32 s3, s3, 3
s_add_u32 s26, s26, s3
M v[140:143], v[188:191], a[252:255], v[140:143]
M v[140:143], v[184:187], a[248:251], v[140:143]
ds_read_b64_tr_b16 a[84:85], v22 offset:24576
ds_read_b64_tr_b16 a[86:87], v22 offset:28672
M v[144:147], v[192:195], a[248:251], v[144:147]
M v[144:147], v[196:199], a[252:255], v[144:147]
ds_read_b64_tr_b16 a[88:89], v23 offset:16384
ds_read_b64_tr_b16 a[90:91], v23 offset:20480
M v[148:151], v[204:207], a[252:255], v[148:151]
M v[148:151], v[200:203], a[248:251], v[148:151]
ds_read_b64_tr_b16 a[92:93], v23 offset:24576
ds_read_b64_tr_b16 a[94:95], v23 offset:28672
M v[152:155], v[208:211], a[248:251], v[152:155]
M v[152:155], v[212:215], a[252:255], v[152:155]
M v[156:159], v[220:223], a[252:255], v[156:159]
M v[156:159], v[216:219], a[248:251], v[156:159]
s_waitcnt vmcnt(24) lgkmcnt(0)
s_barrier
M v[32:35], a[32:35], a[96:99], v[32:35]
s_add_u32 m0, s41, 16384
s_nop 0
buffer_load_dwordx4 v2, s[48:51], s26 offen offset:0 lds
M v[32:35], a[36:39], a[100:103], v[32:35]
M v[36:39], a[44:47], a[100:103], v[36:39]
ds_read_b64_tr_b16 v[160:161], v16 offset:32768
ds_read_b64_tr_b16 v[162:163], v16 offset:36864
M v[36:39], a[40:43], a[96:99], v[36:39]
M v[40:43], a[48:51], a[96:99], v[40:43]
buffer_load_dwordx4 v3, s[48:51], s26 offen offset:1024 lds
M v[40:43], a[52:55], a[100:103], v[40:43]
M v[44:47], a[60:63], a[100:103], v[44:47]
ds_read_b64_tr_b16 v[164:165], v16 offset:40960
ds_read_b64_tr_b16 v[166:167], v16 offset:45056
M v[44:47], a[56:59], a[96:99], v[44:47]
M v[48:51], a[64:67], a[96:99], v[48:51]
buffer_load_dwordx4 v4, s[48:51], s26 offen offset:2048 lds
M v[48:51], a[68:71], a[100:103], v[48:51]
M v[52:55], a[76:79], a[100:103], v[52:55]
ds_read_b64_tr_b16 v[168:169], v17 offset:32768
ds_read_b64_tr_b16 v[170:171], v17 offset:36864
M v[52:55], a[72:75], a[96:99], v[52:55]
M v[56:59], a[80:83], a[96:99], v[56:59]
buffer_load_dwordx4 v5, s[48:51], s26 offen offset:3072 lds
M v[56:59], a[84:87], a[100:103], v[56:59]
M v[60:63], a[92:95], a[100:103], v[60:63]
ds_read_b64_tr_b16 v[172:173], v17 offset:40960
ds_read_b64_tr_b16 v[174:175], v17 offset:45056
M v[60:63], a[88:91], a[96:99], v[60:63]
M v[64:67], a[32:35], a[104:107], v[64:67]
buffer_load_dwordx4 a[224:227], v1, s[44:47], s25 offen offset:0 sc1
M v[64:67], a[36:39], a[108:111], v[64:67]
M v[68:71], a[44:47], a[108:111], v[68:71]
ds_read_b64_tr_b16 v[176:177], v18 offset:32768
ds_read_b64_tr_b16 v[178:179], v18 offset:36864
M v[68:71], a[40:43], a[104:107], v[68:71]
M v[72:75], a[48:51], a[104:107], v[72:75]
buffer_load_dwordx4 a[228:231], v1, s[44:47], s25 offen offset:1024 sc1
M v[72:75], a[52:55], a[108:111], v[72:75]
M v[76:79], a[60:63], a[108:111], v[76:79]
ds_read_b64_tr_b16 v[180:181], v18 offset:40960
ds_read_b64_tr_b16 v[182:183], v18 offset:45056
M v[76:79], a[56:59], a[104:107], v[76:79]
M v[80:83], a[64:67], a[104:107], v[80:83]
buffer_load_dwordx4 a[232:235], v1, s[44:47], s25 offen offset:2048 sc1
M v[80:83], a[68:71], a[108:111], v[80:83]
M v[84:87], a[76:79], a[108:111], v[84:87]
ds_read_b64_tr_b16 v[184:185], v19 offset:32768
ds_read_b64_tr_b16 v[186:187], v19 offset:36864
M v[84:87], a[72:75], a[104:107], v[84:87]
M v[88:91], a[80:83], a[104:107], v[88:91]
buffer_load_dwordx4 a[236:239], v1, s[44:47], s25 offen offset:3072 sc1
M v[88:91], a[84:87], a[108:111], v[88:91]
M v[92:95], a[92:95], a[108:111], v[92:95]
M v[92:95], a[88:91], a[104:107], v[92:95]
ds_read_b64_tr_b16 v[188:189], v19 offset:40960
ds_read_b64_tr_b16 v[190:191], v19 offset:45056
M v[96:99], a[32:35], a[112:115], v[96:99]
M v[96:99], a[36:39], a[116:119], v[96:99]
s_add_u32 s63, s25, 4096
buffer_load_dwordx4 a[240:243], v1, s[44:47], s63 offen offset:0 sc1
M v[100:103], a[44:47], a[116:119], v[100:103]
M v[100:103], a[40:43], a[112:115], v[100:103]
ds_read_b64_tr_b16 v[192:193], v20 offset:32768
ds_read_b64_tr_b16 v[194:195], v20 offset:36864
M v[104:107], a[48:51], a[112:115], v[104:107]
M v[104:107], a[52:55], a[116:119], v[104:107]
buffer_load_dwordx4 a[244:247], v1, s[44:47], s63 offen offset:1024 sc1
M v[108:111], a[60:63], a[116:119], v[108:111]
M v[108:111], a[56:59], a[112:115], v[108:111]
ds_read_b64_tr_b16 v[196:197], v20 offset:40960
ds_read_b64_tr_b16 v[198:199], v20 offset:45056
M v[112:115], a[64:67], a[112:115], v[112:115]
M v[112:115], a[68:71], a[116:119], v[112:115]
buffer_load_dwordx4 a[248:251], v1, s[44:47], s63 offen offset:2048 sc1
M v[116:119], a[76:79], a[116:119], v[116:119]
M v[116:119], a[72:75], a[112:115], v[116:119]
ds_read_b64_tr_b16 v[200:201], v21 offset:32768
ds_read_b64_tr_b16 v[202:203], v21 offset:36864
M v[120:123], a[80:83], a[112:115], v[120:123]
M v[120:123], a[84:87], a[116:119], v[120:123]
buffer_load_dwordx4 a[252:255], v1, s[44:47], s63 offen offset:3072 sc1
M v[124:127], a[92:95], a[116:119], v[124:127]
M v[124:127], a[88:91], a[112:115], v[124:127]
ds_read_b64_tr_b16 v[204:205], v21 offset:40960
ds_read_b64_tr_b16 v[206:207], v21 offset:45056
M v[128:131], a[32:35], a[120:123], v[128:131]
M v[128:131], a[36:39], a[124:127], v[128:131]
s_sub_u32 s39, s39, 1
s_cmp_eq_u32 s39, 0
s_cselect_b32 s3, s64, s65
M v[132:135], a[44:47], a[124:127], v[132:135]
M v[132:135], a[40:43], a[120:123], v[132:135]
ds_read_b64_tr_b16 v[208:209], v22 offset:32768
ds_read_b64_tr_b16 v[210:211], v22 offset:36864
M v[136:139], a[48:51], a[120:123], v[136:139]
M v[136:139], a[52:55], a[124:127], v[136:139]
s_add_u32 s25, s25, s3
s_lshl_b32 s3, s3, 3
s_add_u32 s26, s26, s3
M v[140:143], a[60:63], a[124:127], v[140:143]
M v[140:143], a[56:59], a[120:123], v[140:143]
ds_read_b64_tr_b16 v[212:213], v22 offset:40960
ds_read_b64_tr_b16 v[214:215], v22 offset:45056
M v[144:147], a[64:67], a[120:123], v[144:147]
M v[144:147], a[68:71], a[124:127], v[144:147]
ds_read_b64_tr_b16 v[216:217], v23 offset:32768
ds_read_b64_tr_b16 v[218:219], v23 offset:36864
M v[148:151], a[76:79], a[124:127], v[148:151]
M v[148:151], a[72:75], a[120:123], v[148:151]
ds_read_b64_tr_b16 v[220:221], v23 offset:40960
ds_read_b64_tr_b16 v[222:223], v23 offset:45056
M v[152:155], a[80:83], a[120:123], v[152:155]
M v[152:155], a[84:87], a[124:127], v[152:155]
M v[156:159], a[92:95], a[124:127], v[156:159]
M v[156:159], a[88:91], a[120:123], v[156:159]
s_waitcnt vmcnt(24) lgkmcnt(0)
s_barrier
M v[32:35], v[160:163], a[128:131], v[32:35]
s_add_u32 m0, s41, 32768
s_nop 0
buffer_load_dwordx4 v2, s[48:51], s26 offen offset:0 lds
M v[32:35], v[164:167], a[132:135], v[32:35]
M v[36:39], v[172:175], a[132:135], v[36:39]
ds_read_b64_tr_b16 a[32:33], v16 offset:49152
ds_read_b64_tr_b16 a[34:35], v16 offset:53248
M v[36:39], v[168:171], a[128:131], v[36:39]
M v[40:43], v[176:179], a[128:131], v[40:43]
buffer_load_dwordx4 v3, s[48:51], s26 offen offset:1024 lds
M v[40:43], v[180:183], a[132:135], v[40:43]
M v[44:47], v[188:191], a[132:135], v[44:47]
ds_read_b64_tr_b16 a[36:37], v16 offset:57344
ds_read_b64_tr_b16 a[38:39], v16 offset:61440
M v[44:47], v[184:187], a[128:131], v[44:47]
M v[48:51], v[192:195], a[128:131], v[48:51]
buffer_load_dwordx4 v4, s[48:51], s26 offen offset:2048 lds
M v[48:51], v[196:199], a[132:135], v[48:51]
M v[52:55], v[204:207], a[132:135], v[52:55]
ds_read_b64_tr_b16 a[40:41], v17 offset:49152
ds_read_b64_tr_b16 a[42:43], v17 offset:53248
M v[52:55], v[200:203], a[128:131], v[52:55]
M v[56:59], v[208:211], a[128:131], v[56:59]
buffer_load_dwordx4 v5, s[48:51], s26 offen offset:3072 lds
M v[56:59], v[212:215], a[132:135], v[56:59]
M v[60:63], v[220:223], a[132:135], v[60:63]
ds_read_b64_tr_b16 a[44:45], v17 offset:57344
ds_read_b64_tr_b16 a[46:47], v17 offset:61440
M v[60:63], v[216:219], a[128:131], v[60:63]
M v[64:67], v[160:163], a[136:139], v[64:67]
buffer_load_dwordx4 a[96:99], v1, s[44:47], s25 offen offset:0 sc1
M v[64:67], v[164:167], a[140:143], v[64:67]
M v[68:71], v[172:175], a[140:143], v[68:71]
ds_read_b64_tr_b16 a[48:49], v18 offset:49152
ds_read_b64_tr_b16 a[50:51], v18 offset:53248
M v[68:71], v[168:171], a[136:139], v[68:71]
M v[72:75], v[176:179], a[136:139], v[72:75]
buffer_load_dwordx4 a[100:103], v1, s[44:47], s25 offen offset:1024 sc1
M v[72:75], v[180:183], a[140:143], v[72:75]
M v[76:79], v[188:191], a[140:143], v[76:79]
ds_read_b64_tr_b16 a[52:53], v18 offset:57344
ds_read_b64_tr_b16 a[54:55], v18 offset:61440
M v[76:79], v[184:187], a[136:139], v[76:79]
M v[80:83], v[192:195], a[136:139], v[80:83]
buffer_load_dwordx4 a[104:107], v1, s[44:47], s25 offen offset:2048 sc1
M v[80:83], v[196:199], a[140:143], v[80:83]
M v[84:87], v[204:207], a[140:143], v[84:87]
ds_read_b64_tr_b16 a[56:57], v19 offset:49152
ds_read_b64_tr_b16 a[58:59], v19 offset:53248
M v[84:87], v[200:203], a[136:139], v[84:87]
M v[88:91], v[208:211], a[136:139], v[88:91]
buffer_load_dwordx4 a[108:111], v1, s[44:47], s25 offen offset:3072 sc1
M v[88:91], v[212:215], a[140:143], v[88:91]
M v[92:95], v[220:223], a[140:143], v[92:95]
M v[92:95], v[216:219], a[136:139], v[92:95]
ds_read_b64_tr_b16 a[60:61], v19 offset:57344
ds_read_b64_tr_b16 a[62:63], v19 offset:61440
M v[96:99], v[160:163], a[144:147], v[96:99]
M v[96:99], v[164:167], a[148:151], v[96:99]
s_add_u32 s63, s25, 4096
buffer_load_dwordx4 a[112:115], v1, s[44:47], s63 offen offset:0 sc1
M v[100:103], v[172:175], a[148:151], v[100:103]
M v[100:103], v[168:171], a[144:147], v[100:103]
ds_read_b64_tr_b16 a[64:65], v20 offset:49152
ds_read_b64_tr_b16 a[66:67], v20 offset:53248
M v[104:107], v[176:179], a[144:147], v[104:107]
M v[104:107], v[180:183], a[148:151], v[104:107]
buffer_load_dwordx4 a[116:119], v1, s[44:47], s63 offen offset:1024 sc1
M v[108:111], v[188:191], a[148:151], v[108:111]
M v[108:111], v[184:187], a[144:147], v[108:111]
ds_read_b64_tr_b16 a[68:69], v20 offset:57344
ds_read_b64_tr_b16 a[70:71], v20 offset:61440
M v[112:115], v[192:195], a[144:147], v[112:115]
M v[112:115], v[196:199], a[148:151], v[112:115]
buffer_load_dwordx4 a[120:123], v1, s[44:47], s63 offen offset:2048 sc1
M v[116:119], v[204:207], a[148:151], v[116:119]
M v[116:119], v[200:203], a[144:147], v[116:119]
ds_read_b64_tr_b16 a[72:73], v21 offset:49152
ds_read_b64_tr_b16 a[74:75], v21 offset:53248
M v[120:123], v[208:211], a[144:147], v[120:123]
M v[120:123], v[212:215], a[148:151], v[120:123]
buffer_load_dwordx4 a[124:127], v1, s[44:47], s63 offen offset:3072 sc1
M v[124:127], v[220:223], a[148:151], v[124:127]
M v[124:127], v[216:219], a[144:147], v[124:127]
ds_read_b64_tr_b16 a[76:77], v21 offset:57344
ds_read_b64_tr_b16 a[78:79], v21 offset:61440
M v[128:131], v[160:163], a[152:155], v[128:131]
M v[128:131], v[164:167], a[156:159], v[128:131]
s_sub_u32 s39, s39, 1
s_cmp_eq_u32 s39, 0
s_cselect_b32 s3, s64, s65
M v[132:135], v[172:175], a[156:159], v[132:135]
M v[132:135], v[168:171], a[152:155], v[132:135]
ds_read_b64_tr_b16 a[80:81], v22 offset:49152
ds_read_b64_tr_b16 a[82:83], v22 offset:53248
M v[136:139], v[176:179], a[152:155], v[136:139]
M v[136:139], v[180:183], a[156:159], v[136:139]
s_add_u32 s25, s25, s3
s_lshl_b32 s3, s3, 3
s_add_u32 s26, s26, s3
M v[140:143], v[188:191], a[156:159], v[140:143]
M v[140:143], v[184:187], a[152:155], v[140:143]
ds_read_b64_tr_b16 a[84:85], v22 offset:57344
ds_read_b64_tr_b16 a[86:87], v22 offset:61440
M v[144:147], v[192:195], a[152:155], v[144:147]
M v[144:147], v[196:199], a[156:159], v[144:147]
ds_read_b64_tr_b16 a[88:89], v23 offset:49152
ds_read_b64_tr_b16 a[90:91], v23 offset:53248
M v[148:151], v[204:207], a[156:159], v[148:151]
M v[148:151], v[200:203], a[152:155], v[148:151]
ds_read_b64_tr_b16 a[92:93], v23 offset:57344
ds_read_b64_tr_b16 a[94:95], v23 offset:61440
M v[152:155], v[208:211], a[152:155], v[152:155]
M v[152:155], v[212:215], a[156:159], v[152:155]
M v[156:159], v[220:223], a[156:159], v[156:159]
M v[156:159], v[216:219], a[152:155], v[156:159]
s_waitcnt vmcnt(24) lgkmcnt(0)
s_barrier
M v[32:35], a[32:35], a[160:163], v[32:35]
s_add_u32 m0, s41, 49152
s_nop 0
buffer_load_dwordx4 v2, s[48:51], s26 offen offset:0 lds
M v[32:35], a[36:39], a[164:167], v[32:35]
M v[36:39], a[44:47], a[164:167], v[36:39]
ds_read_b64_tr_b16 v[160:161], v8 offset:0
ds_read_b64_tr_b16 v[162:163], v8 offset:4096
M v[36:39], a[40:43], a[160:163], v[36:39]
M v[40:43], a[48:51], a[160:163], v[40:43]
buffer_load_dwordx4 v3, s[48:51], s26 offen offset:1024 lds
M v[40:43], a[52:55], a[164:167], v[40:43]
M v[44:47], a[60:63], a[164:167], v[44:47]
ds_read_b64_tr_b16 v[164:165], v8 offset:8192
ds_read_b64_tr_b16 v[166:167], v8 offset:12288
M v[44:47], a[56:59], a[160:163], v[44:47]
M v[48:51], a[64:67], a[160:163], v[48:51]
buffer_load_dwordx4 v4, s[48:51], s26 offen offset:2048 lds
M v[48:51], a[68:71], a[164:167], v[48:51]
M v[52:55], a[76:79], a[164:167], v[52:55]
ds_read_b64_tr_b16 v[168:169], v9 offset:0
ds_read_b64_tr_b16 v[170:171], v9 offset:4096
M v[52:55], a[72:75], a[160:163], v[52:55]
M v[56:59], a[80:83], a[160:163], v[56:59]
buffer_load_dwordx4 v5, s[48:51], s26 offen offset:3072 lds
M v[56:59], a[84:87], a[164:167], v[56:59]
M v[60:63], a[92:95], a[164:167], v[60:63]
ds_read_b64_tr_b16 v[172:173], v9 offset:8192
ds_read_b64_tr_b16 v[174:175], v9 offset:12288
M v[60:63], a[88:91], a[160:163], v[60:63]
M v[64:67], a[32:35], a[168:171], v[64:67]
buffer_load_dwordx4 a[128:131], v1, s[44:47], s25 offen offset:0 sc1
M v[64:67], a[36:39], a[172:175], v[64:67]
M v[68:71], a[44:47], a[172:175], v[68:71]
ds_read_b64_tr_b16 v[176:177], v10 offset:0
ds_read_b64_tr_b16 v[178:179], v10 offset:4096
M v[68:71], a[40:43], a[168:171], v[68:71]
M v[72:75], a[48:51], a[168:171], v[72:75]
buffer_load_dwordx4 a[132:135], v1, s[44:47], s25 offen offset:1024 sc1
M v[72:75], a[52:55], a[172:175], v[72:75]
M v[76:79], a[60:63], a[172:175], v[76:79]
ds_read_b64_tr_b16 v[180:181], v10 offset:8192
ds_read_b64_tr_b16 v[182:183], v10 offset:12288
M v[76:79], a[56:59], a[168:171], v[76:79]
M v[80:83], a[64:67], a[168:171], v[80:83]
buffer_load_dwordx4 a[136:139], v1, s[44:47], s25 offen offset:2048 sc1
M v[80:83], a[68:71], a[172:175], v[80:83]
M v[84:87], a[76:79], a[172:175], v[84:87]
ds_read_b64_tr_b16 v[184:185], v11 offset:0
ds_read_b64_tr_b16 v[186:187], v11 offset:4096
M v[84:87], a[72:75], a[168:171], v[84:87]
M v[88:91], a[80:83], a[168:171], v[88:91]
buffer_load_dwordx4 a[140:143], v1, s[44:47], s25 offen offset:3072 sc1
M v[88:91], a[84:87], a[172:175], v[88:91]
M v[92:95], a[92:95], a[172:175], v[92:95]
M v[92:95], a[88:91], a[168:171], v[92:95]
ds_read_b64_tr_b16 v[188:189], v11 offset:8192
ds_read_b64_tr_b16 v[190:191], v11 offset:12288
M v[96:99], a[32:35], a[176:179], v[96:99]
M v[96:99], a[36:39], a[180:183], v[96:99]
s_add_u32 s63, s25, 4096
buffer_load_dwordx4 a[144:147], v1, s[44:47], s63 offen offset:0 sc1
M v[100:103], a[44:47], a[180:183], v[100:103]
M v[100:103], a[40:43], a[176:179], v[100:103]
ds_read_b64_tr_b16 v[192:193], v12 offset:0
ds_read_b64_tr_b16 v[194:195], v12 offset:4096
M v[104:107], a[48:51], a[176:179], v[104:107]
M v[104:107], a[52:55], a[180:183], v[104:107]
buffer_load_dwordx4 a[148:151], v1, s[44:47], s63 offen offset:1024 sc1
M v[108:111], a[60:63], a[180:183], v[108:111]
M v[108:111], a[56:59], a[176:179], v[108:111]
ds_read_b64_tr_b16 v[196:197], v12 offset:8192
ds_read_b64_tr_b16 v[198:199], v12 offset:12288
M v[112:115], a[64:67], a[176:179], v[112:115]
M v[112:115], a[68:71], a[180:183], v[112:115]
buffer_load_dwordx4 a[152:155], v1, s[44:47], s63 offen offset:2048 sc1
M v[116:119], a[76:79], a[180:183], v[116:119]
M v[116:119], a[72:75], a[176:179], v[116:119]
ds_read_b64_tr_b16 v[200:201], v13 offset:0
ds_read_b64_tr_b16 v[202:203], v13 offset:4096
M v[120:123], a[80:83], a[176:179], v[120:123]
M v[120:123], a[84:87], a[180:183], v[120:123]
buffer_load_dwordx4 a[156:159], v1, s[44:47], s63 offen offset:3072 sc1
M v[124:127], a[92:95], a[180:183], v[124:127]
M v[124:127], a[88:91], a[176:179], v[124:127]
ds_read_b64_tr_b16 v[204:205], v13 offset:8192
ds_read_b64_tr_b16 v[206:207], v13 offset:12288
M v[128:131], a[32:35], a[184:187], v[128:131]
M v[128:131], a[36:39], a[188:191], v[128:131]
s_sub_u32 s39, s39, 1
s_cmp_eq_u32 s39, 0
s_cselect_b32 s3, s64, s65
M v[132:135], a[44:47], a[188:191], v[132:135]
M v[132:135], a[40:43], a[184:187], v[132:135]
ds_read_b64_tr_b16 v[208:209], v14 offset:0
ds_read_b64_tr_b16 v[210:211], v14 offset:4096
M v[136:139], a[48:51], a[184:187], v[136:139]
M v[136:139], a[52:55], a[188:191], v[136:139]
s_add_u32 s25, s25, s3
s_lshl_b32 s3, s3, 3
s_add_u32 s26, s26, s3
M v[140:143], a[60:63], a[188:191], v[140:143]
M v[140:143], a[56:59], a[184:187], v[140:143]
ds_read_b64_tr_b16 v[212:213], v14 offset:8192
ds_read_b64_tr_b16 v[214:215], v14 offset:12288
M v[144:147], a[64:67], a[184:187], v[144:147]
M v[144:147], a[68:71], a[188:191], v[144:147]
ds_read_b64_tr_b16 v[216:217], v15 offset:0
ds_read_b64_tr_b16 v[218:219], v15 offset:4096
M v[148:151], a[76:79], a[188:191], v[148:151]
M v[148:151], a[72:75], a[184:187], v[148:151]
ds_read_b64_tr_b16 v[220:221], v15 offset:8192
ds_read_b64_tr_b16 v[222:223], v15 offset:12288
M v[152:155], a[80:83], a[184:187], v[152:155]
M v[152:155], a[84:87], a[188:191], v[152:155]
M v[156:159], a[92:95], a[188:191], v[156:159]
M v[156:159], a[88:91], a[184:187], v[156:159]
s_waitcnt vmcnt(24) lgkmcnt(0)
s_barrier
M v[32:35], v[160:163], a[192:195], v[32:35]
s_add_u32 m0, s41, 65536
s_nop 0
buffer_load_dwordx4 v2, s[48:51], s26 offen offset:0 lds
M v[32:35], v[164:167], a[196:199], v[32:35]
M v[36:39], v[172:175], a[196:199], v[36:39]
ds_read_b64_tr_b16 a[32:33], v8 offset:16384
ds_read_b64_tr_b16 a[34:35], v8 offset:20480
M v[36:39], v[168:171], a[192:195], v[36:39]
M v[40:43], v[176:179], a[192:195], v[40:43]
buffer_load_dwordx4 v3, s[48:51], s26 offen offset:1024 lds
M v[40:43], v[180:183], a[196:199], v[40:43]
M v[44:47], v[188:191], a[196:199], v[44:47]
ds_read_b64_tr_b16 a[36:37], v8 offset:24576
ds_read_b64_tr_b16 a[38:39], v8 offset:28672
M v[44:47], v[184:187], a[192:195], v[44:47]
M v[48:51], v[192:195], a[192:195], v[48:51]
buffer_load_dwordx4 v4, s[48:51], s26 offen offset:2048 lds
M v[48:51], v[196:199], a[196:199], v[48:51]
M v[52:55], v[204:207], a[196:199], v[52:55]
ds_read_b64_tr_b16 a[40:41], v9 offset:16384
ds_read_b64_tr_b16 a[42:43], v9 offset:20480
M v[52:55], v[200:203], a[192:195], v[52:55]
M v[56:59], v[208:211], a[192:195], v[56:59]
buffer_load_dwordx4 v5, s[48:51], s26 offen offset:3072 lds
M v[56:59], v[212:215], a[196:199], v[56:59]
M v[60:63], v[220:223], a[196:199], v[60:63]
ds_read_b64_tr_b16 a[44:45], v9 offset:24576
ds_read_b64_tr_b16 a[46:47], v9 offset:28672
M v[60:63], v[216:219], a[192:195], v[60:63]
M v[64:67], v[160:163], a[200:203], v[64:67]
buffer_load_dwordx4 a[160:163], v1, s[44:47], s25 offen offset:0 sc1
M v[64:67], v[164:167], a[204:207], v[64:67]
M v[68:71], v[172:175], a[204:207], v[68:71]
ds_read_b64_tr_b16 a[48:49], v10 offset:16384
ds_read_b64_tr_b16 a[50:51], v10 offset:20480
M v[68:71], v[168:171], a[200:203], v[68:71]
M v[72:75], v[176:179], a[200:203], v[72:75]
buffer_load_dwordx4 a[164:167], v1, s[44:47], s25 offen offset:1024 sc1
M v[72:75], v[180:183], a[204:207], v[72:75]
M v[76:79], v[188:191], a[204:207], v[76:79]
ds_read_b64_tr_b16 a[52:53], v10 offset:24576
ds_read_b64_tr_b16 a[54:55], v10 offset:28672
M v[76:79], v[184:187], a[200:203], v[76:79]
M v[80:83], v[192:195], a[200:203], v[80:83]
buffer_load_dwordx4 a[168:171], v1, s[44:47], s25 offen offset:2048 sc1
M v[80:83], v[196:199], a[204:207], v[80:83]
M v[84:87], v[204:207], a[204:207], v[84:87]
ds_read_b64_tr_b16 a[56:57], v11 offset:16384
ds_read_b64_tr_b16 a[58:59], v11 offset:20480
M v[84:87], v[200:203], a[200:203], v[84:87]
M v[88:91], v[208:211], a[200:203], v[88:91]
buffer_load_dwordx4 a[172:175], v1, s[44:47], s25 offen offset:3072 sc1
M v[88:91], v[212:215], a[204:207], v[88:91]
M v[92:95], v[220:223], a[204:207], v[92:95]
M v[92:95], v[216:219], a[200:203], v[92:95]
ds_read_b64_tr_b16 a[60:61], v11 offset:24576
ds_read_b64_tr_b16 a[62:63], v11 offset:28672
M v[96:99], v[160:163], a[208:211], v[96:99]
M v[96:99], v[164:167], a[212:215], v[96:99]
s_add_u32 s63, s25, 4096
buffer_load_dwordx4 a[176:179], v1, s[44:47], s63 offen offset:0 sc1
M v[100:103], v[172:175], a[212:215], v[100:103]
M v[100:103], v[168:171], a[208:211], v[100:103]
ds_read_b64_tr_b16 a[64:65], v12 offset:16384
ds_read_b64_tr_b16 a[66:67], v12 offset:20480
M v[104:107], v[176:179], a[208:211], v[104:107]
M v[104:107], v[180:183], a[212:215], v[104:107]
buffer_load_dwordx4 a[180:183], v1, s[44:47], s63 offen offset:1024 sc1
M v[108:111], v[188:191], a[212:215], v[108:111]
M v[108:111], v[184:187], a[208:211], v[108:111]
ds_read_b64_tr_b16 a[68:69], v12 offset:24576
ds_read_b64_tr_b16 a[70:71], v12 offset:28672
M v[112:115], v[192:195], a[208:211], v[112:115]
M v[112:115], v[196:199], a[212:215], v[112:115]
buffer_load_dwordx4 a[184:187], v1, s[44:47], s63 offen offset:2048 sc1
M v[116:119], v[204:207], a[212:215], v[116:119]
M v[116:119], v[200:203], a[208:211], v[116:119]
ds_read_b64_tr_b16 a[72:73], v13 offset:16384
ds_read_b64_tr_b16 a[74:75], v13 offset:20480
M v[120:123], v[208:211], a[208:211], v[120:123]
M v[120:123], v[212:215], a[212:215], v[120:123]
buffer_load_dwordx4 a[188:191], v1, s[44:47], s63 offen offset:3072 sc1
M v[124:127], v[220:223], a[212:215], v[124:127]
M v[124:127], v[216:219], a[208:211], v[124:127]
ds_read_b64_tr_b16 a[76:77], v13 offset:24576
ds_read_b64_tr_b16 a[78:79], v13 offset:28672
M v[128:131], v[160:163], a[216:219], v[128:131]
M v[128:131], v[164:167], a[220:223], v[128:131]
s_sub_u32 s39, s39, 1
s_cmp_eq_u32 s39, 0
s_cselect_b32 s3, s64, s65
M v[132:135], v[172:175], a[220:223], v[132:135]
M v[132:135], v[168:171], a[216:219], v[132:135]
ds_read_b64_tr_b16 a[80:81], v14 offset:16384
ds_read_b64_tr_b16 a[82:83], v14 offset:20480
M v[136:139], v[176:179], a[216:219], v[136:139]
M v[136:139], v[180:183], a[220:223], v[136:139]
s_add_u32 s25, s25, s3
s_lshl_b32 s3, s3, 3
s_add_u32 s26, s26, s3
M v[140:143], v[188:191], a[220:223], v[140:143]
M v[140:143], v[184:187], a[216:219], v[140:143]
ds_read_b64_tr_b16 a[84:85], v14 offset:24576
ds_read_b64_tr_b16 a[86:87], v14 offset:28672
M v[144:147], v[192:195], a[216:219], v[144:147]
M v[144:147], v[196:199], a[220:223], v[144:147]
ds_read_b64_tr_b16 a[88:89], v15 offset:16384
ds_read_b64_tr_b16 a[90:91], v15 offset:20480
M v[148:151], v[204:207], a[220:223], v[148:151]
M v[148:151], v[200:203], a[216:219], v[148:151]
ds_read_b64_tr_b16 a[92:93], v15 offset:24576
ds_read_b64_tr_b16 a[94:95], v15 offset:28672
M v[152:155], v[208:211], a[216:219], v[152:155]
M v[152:155], v[212:215], a[220:223], v[152:155]
M v[156:159], v[220:223], a[220:223], v[156:159]
M v[156:159], v[216:219], a[216:219], v[156:159]
s_waitcnt vmcnt(24) lgkmcnt(0)
s_barrier
M v[32:35], a[32:35], a[224:227], v[32:35]
s_add_u32 m0, s41, 81920
s_nop 0
buffer_load_dwordx4 v2, s[48:51], s26 offen offset:0 lds
M v[32:35], a[36:39], a[228:231], v[32:35]
M v[36:39], a[44:47], a[228:231], v[36:39]
ds_read_b64_tr_b16 v[160:161], v8 offset:32768
ds_read_b64_tr_b16 v[162:163], v8 offset:36864
M v[36:39], a[40:43], a[224:227], v[36:39]
M v[40:43], a[48:51], a[224:227], v[40:43]
buffer_load_dwordx4 v3, s[48:51], s26 offen offset:1024 lds
M v[40:43], a[52:55], a[228:231], v[40:43]
M v[44:47], a[60:63], a[228:231], v[44:47]
ds_read_b64_tr_b16 v[164:165], v8 offset:40960
ds_read_b64_tr_b16 v[166:167], v8 offset:45056
M v[44:47], a[56:59], a[224:227], v[44:47]
M v[48:51], a[64:67], a[224:227], v[48:51]
buffer_load_dwordx4 v4, s[48:51], s26 offen offset:2048 lds
M v[48:51], a[68:71], a[228:231], v[48:51]
M v[52:55], a[76:79], a[228:231], v[52:55]
ds_read_b64_tr_b16 v[168:169], v9 offset:32768
ds_read_b64_tr_b16 v[170:171], v9 offset:36864
M v[52:55], a[72:75], a[224:227], v[52:55]
M v[56:59], a[80:83], a[224:227], v[56:59]
buffer_load_dwordx4 v5, s[48:51], s26 offen offset:3072 lds
M v[56:59], a[84:87], a[228:231], v[56:59]
M v[60:63], a[92:95], a[228:231], v[60:63]
ds_read_b64_tr_b16 v[172:173], v9 offset:40960
ds_read_b64_tr_b16 v[174:175], v9 offset:45056
M v[60:63], a[88:91], a[224:227], v[60:63]
M v[64:67], a[32:35], a[232:235], v[64:67]
buffer_load_dwordx4 a[192:195], v1, s[44:47], s25 offen offset:0 sc1
M v[64:67], a[36:39], a[236:239], v[64:67]
M v[68:71], a[44:47], a[236:239], v[68:71]
ds_read_b64_tr_b16 v[176:177], v10 offset:32768
ds_read_b64_tr_b16 v[178:179], v10 offset:36864
M v[68:71], a[40:43], a[232:235], v[68:71]
M v[72:75], a[48:51], a[232:235], v[72:75]
buffer_load_dwordx4 a[196:199], v1, s[44:47], s25 offen offset:1024 sc1
M v[72:75], a[52:55], a[236:239], v[72:75]
M v[76:79], a[60:63], a[236:239], v[76:79]
ds_read_b64_tr_b16 v[180:181], v10 offset:40960
ds_read_b64_tr_b16 v[182:183], v10 offset:45056
M v[76:79], a[56:59], a[232:235], v[76:79]
M v[80:83], a[64:67], a[232:235], v[80:83]
buffer_load_dwordx4 a[200:203], v1, s[44:47], s25 offen offset:2048 sc1
M v[80:83], a[68:71], a[236:239], v[80:83]
M v[84:87], a[76:79], a[236:239], v[84:87]
ds_read_b64_tr_b16 v[184:185], v11 offset:32768
ds_read_b64_tr_b16 v[186:187], v11 offset:36864
M v[84:87], a[72:75], a[232:235], v[84:87]
M v[88:91], a[80:83], a[232:235], v[88:91]
buffer_load_dwordx4 a[204:207], v1, s[44:47], s25 offen offset:3072 sc1
M v[88:91], a[84:87], a[236:239], v[88:91]
M v[92:95], a[92:95], a[236:239], v[92:95]
M v[92:95], a[88:91], a[232:235], v[92:95]
ds_read_b64_tr_b16 v[188:189], v11 offset:40960
ds_read_b64_tr_b16 v[190:191], v11 offset:45056
M v[96:99], a[32:35], a[240:243], v[96:99]
M v[96:99], a[36:39], a[244:247], v[96:99]
s_add_u32 s63, s25, 4096
buffer_load_dwordx4 a[208:211], v1, s[44:47], s63 offen offset:0 sc1
M v[100:103], a[44:47], a[244:247], v[100:103]
M v[100:103], a[40:43], a[240:243], v[100:103]
ds_read_b64_tr_b16 v[192:193], v12 offset:32768
ds_read_b64_tr_b16 v[194:195], v12 offset:36864
M v[104:107], a[48:51], a[240:243], v[104:107]
M v[104:107], a[52:55], a[244:247], v[104:107]
buffer_load_dwordx4 a[212:215], v1, s[44:47], s63 offen offset:1024 sc1
M v[108:111], a[60:63], a[244:247], v[108:111]
M v[108:111], a[56:59], a[240:243], v[108:111]
ds_read_b64_tr_b16 v[196:197], v12 offset:40960
ds_read_b64_tr_b16 v[198:199], v12 offset:45056
M v[112:115], a[64:67], a[240:243], v[112:115]
M v[112:115], a[68:71], a[244:247], v[112:115]
buffer_load_dwordx4 a[216:219], v1, s[44:47], s63 offen offset:2048 sc1
M v[116:119], a[76:79], a[244:247], v[116:119]
M v[116:119], a[72:75], a[240:243], v[116:119]
ds_read_b64_tr_b16 v[200:201], v13 offset:32768
ds_read_b64_tr_b16 v[202:203], v13 offset:36864
M v[120:123], a[80:83], a[240:243], v[120:123]
M v[120:123], a[84:87], a[244:247], v[120:123]
buffer_load_dwordx4 a[220:223], v1, s[44:47], s63 offen offset:3072 sc1
M v[124:127], a[92:95], a[244:247], v[124:127]
M v[124:127], a[88:91], a[240:243], v[124:127]
ds_read_b64_tr_b16 v[204:205], v13 offset:40960
ds_read_b64_tr_b16 v[206:207], v13 offset:45056
M v[128:131], a[32:35], a[248:251], v[128:131]
M v[128:131], a[36:39], a[252:255], v[128:131]
s_sub_u32 s39, s39, 1
s_cmp_eq_u32 s39, 0
s_cselect_b32 s3, s64, s65
M v[132:135], a[44:47], a[252:255], v[132:135]
M v[132:135], a[40:43], a[248:251], v[132:135]
ds_read_b64_tr_b16 v[208:209], v14 offset:32768
ds_read_b64_tr_b16 v[210:211], v14 offset:36864
M v[136:139], a[48:51], a[248:251], v[136:139]
M v[136:139], a[52:55], a[252:255], v[136:139]
s_add_u32 s25, s25, s3
s_lshl_b32 s3, s3, 3
s_add_u32 s26, s26, s3
M v[140:143], a[60:63], a[252:255], v[140:143]
M v[140:143], a[56:59], a[248:251], v[140:143]
ds_read_b64_tr_b16 v[212:213], v14 offset:40960
ds_read_b64_tr_b16 v[214:215], v14 offset:45056
M v[144:147], a[64:67], a[248:251], v[144:147]
M v[144:147], a[68:71], a[252:255], v[144:147]
ds_read_b64_tr_b16 v[216:217], v15 offset:32768
ds_read_b64_tr_b16 v[218:219], v15 offset:36864
M v[148:151], a[76:79], a[252:255], v[148:151]
M v[148:151], a[72:75], a[248:251], v[148:151]
ds_read_b64_tr_b16 v[220:221], v15 offset:40960
ds_read_b64_tr_b16 v[222:223], v15 offset:45056
M v[152:155], a[80:83], a[248:251], v[152:155]
M v[152:155], a[84:87], a[252:255], v[152:155]
M v[156:159], a[92:95], a[252:255], v[156:159]
M v[156:159], a[88:91], a[248:251], v[156:159]
s_waitcnt vmcnt(24) lgkmcnt(0)
s_barrier
M v[32:35], v[160:163], a[96:99], v[32:35]
s_add_u32 m0, s41, 98304
s_nop 0
buffer_load_dwordx4 v2, s[48:51], s26 offen offset:0 lds
M v[32:35], v[164:167], a[100:103], v[32:35]
M v[36:39], v[172:175], a[100:103], v[36:39]
ds_read_b64_tr_b16 a[32:33], v8 offset:49152
ds_read_b64_tr_b16 a[34:35], v8 offset:53248
M v[36:39], v[168:171], a[96:99], v[36:39]
M v[40:43], v[176:179], a[96:99], v[40:43]
buffer_load_dwordx4 v3, s[48:51], s26 offen offset:1024 lds
M v[40:43], v[180:183], a[100:103], v[40:43]
M v[44:47], v[188:191], a[100:103], v[44:47]
ds_read_b64_tr_b16 a[36:37], v8 offset:57344
ds_read_b64_tr_b16 a[38:39], v8 offset:61440
M v[44:47], v[184:187], a[96:99], v[44:47]
M v[48:51], v[192:195], a[96:99], v[48:51]
buffer_load_dwordx4 v4, s[48:51], s26 offen offset:2048 lds
M v[48:51], v[196:199], a[100:103], v[48:51]
M v[52:55], v[204:207], a[100:103], v[52:55]
ds_read_b64_tr_b16 a[40:41], v9 offset:49152
ds_read_b64_tr_b16 a[42:43], v9 offset:53248
M v[52:55], v[200:203], a[96:99], v[52:55]
M v[56:59], v[208:211], a[96:99], v[56:59]
buffer_load_dwordx4 v5, s[48:51], s26 offen offset:3072 lds
M v[56:59], v[212:215], a[100:103], v[56:59]
M v[60:63], v[220:223], a[100:103], v[60:63]
ds_read_b64_tr_b16 a[44:45], v9 offset:57344
ds_read_b64_tr_b16 a[46:47], v9 offset:61440
M v[60:63], v[216:219], a[96:99], v[60:63]
M v[64:67], v[160:163], a[104:107], v[64:67]
buffer_load_dwordx4 a[224:227], v1, s[44:47], s25 offen offset:0 sc1
M v[64:67], v[164:167], a[108:111], v[64:67]
M v[68:71], v[172:175], a[108:111], v[68:71]
ds_read_b64_tr_b16 a[48:49], v10 offset:49152
ds_read_b64_tr_b16 a[50:51], v10 offset:53248
M v[68:71], v[168:171], a[104:107], v[68:71]
M v[72:75], v[176:179], a[104:107], v[72:75]
buffer_load_dwordx4 a[228:231], v1, s[44:47], s25 offen offset:1024 sc1
M v[72:75], v[180:183], a[108:111], v[72:75]
M v[76:79], v[188:191], a[108:111], v[76:79]
ds_read_b64_tr_b16 a[52:53], v10 offset:57344
ds_read_b64_tr_b16 a[54:55], v10 offset:61440
M v[76:79], v[184:187], a[104:107], v[76:79]
M v[80:83], v[192:195], a[104:107], v[80:83]
buffer_load_dwordx4 a[232:235], v1, s[44:47], s25 offen offset:2048 sc1
M v[80:83], v[196:199], a[108:111], v[80:83]
M v[84:87], v[204:207], a[108:111], v[84:87]
ds_read_b64_tr_b16 a[56:57], v11 offset:49152
ds_read_b64_tr_b16 a[58:59], v11 offset:53248
M v[84:87], v[200:203], a[104:107], v[84:87]
M v[88:91], v[208:211], a[104:107], v[88:91]
buffer_load_dwordx4 a[236:239], v1, s[44:47], s25 offen offset:3072 sc1
M v[88:91], v[212:215], a[108:111], v[88:91]
M v[92:95], v[220:223], a[108:111], v[92:95]
M v[92:95], v[216:219], a[104:107], v[92:95]
ds_read_b64_tr_b16 a[60:61], v11 offset:57344
ds_read_b64_tr_b16 a[62:63], v11 offset:61440
M v[96:99], v[160:163], a[112:115], v[96:99]
M v[96:99], v[164:167], a[116:119], v[96:99]
s_add_u32 s63, s25, 4096
buffer_load_dwordx4 a[240:243], v1, s[44:47], s63 offen offset:0 sc1
M v[100:103], v[172:175], a[116:119], v[100:103]
M v[100:103], v[168:171], a[112:115], v[100:103]
ds_read_b64_tr_b16 a[64:65], v12 offset:49152
ds_read_b64_tr_b16 a[66:67], v12 offset:53248
M v[104:107], v[176:179], a[112:115], v[104:107]
M v[104:107], v[180:183], a[116:119], v[104:107]
buffer_load_dwordx4 a[244:247], v1, s[44:47], s63 offen offset:1024 sc1
M v[108:111], v[188:191], a[116:119], v[108:111]
M v[108:111], v[184:187], a[112:115], v[108:111]
ds_read_b64_tr_b16 a[68:69], v12 offset:57344
ds_read_b64_tr_b16 a[70:71], v12 offset:61440
M v[112:115], v[192:195], a[112:115], v[112:115]
M v[112:115], v[196:199], a[116:119], v[112:115]
buffer_load_dwordx4 a[248:251], v1, s[44:47], s63 offen offset:2048 sc1
M v[116:119], v[204:207], a[116:119], v[116:119]
M v[116:119], v[200:203], a[112:115], v[116:119]
ds_read_b64_tr_b16 a[72:73], v13 offset:49152
ds_read_b64_tr_b16 a[74:75], v13 offset:53248
M v[120:123], v[208:211], a[112:115], v[120:123]
M v[120:123], v[212:215], a[116:119], v[120:123]
buffer_load_dwordx4 a[252:255], v1, s[44:47], s63 offen offset:3072 sc1
M v[124:127], v[220:223], a[116:119], v[124:127]
M v[124:127], v[216:219], a[112:115], v[124:127]
ds_read_b64_tr_b16 a[76:77], v13 offset:57344
ds_read_b64_tr_b16 a[78:79], v13 offset:61440
M v[128:131], v[160:163], a[120:123], v[128:131]
M v[128:131], v[164:167], a[124:127], v[128:131]
s_sub_u32 s39, s39, 1
s_cmp_eq_u32 s39, 0
s_cselect_b32 s3, s64, s65
M v[132:135], v[172:175], a[124:127], v[132:135]
M v[132:135], v[168:171], a[120:123], v[132:135]
ds_read_b64_tr_b16 a[80:81], v14 offset:49152
ds_read_b64_tr_b16 a[82:83], v14 offset:53248
M v[136:139], v[176:179], a[120:123], v[136:139]
M v[136:139], v[180:183], a[124:127], v[136:139]
s_add_u32 s25, s25, s3
s_lshl_b32 s3, s3, 3
s_add_u32 s26, s26, s3
M v[140:143], v[188:191], a[124:127], v[140:143]
M v[140:143], v[184:187], a[120:123], v[140:143]
ds_read_b64_tr_b16 a[84:85], v14 offset:57344
ds_read_b64_tr_b16 a[86:87], v14 offset:61440
M v[144:147], v[192:195], a[120:123], v[144:147]
M v[144:147], v[196:199], a[124:127], v[144:147]
ds_read_b64_tr_b16 a[88:89], v15 offset:49152
ds_read_b64_tr_b16 a[90:91], v15 offset:53248
M v[148:151], v[204:207], a[124:127], v[148:151]
M v[148:151], v[200:203], a[120:123], v[148:151]
ds_read_b64_tr_b16 a[92:93], v15 offset:57344
ds_read_b64_tr_b16 a[94:95], v15 offset:61440
M v[152:155], v[208:211], a[120:123], v[152:155]
M v[152:155], v[212:215], a[124:127], v[152:155]
M v[156:159], v[220:223], a[124:127], v[156:159]
M v[156:159], v[216:219], a[120:123], v[156:159]
s_waitcnt vmcnt(24) lgkmcnt(0)
s_barrier
M v[32:35], a[32:35], a[128:131], v[32:35]
s_add_u32 m0, s41, 114688
s_nop 0
buffer_load_dwordx4 v2, s[48:51], s26 offen offset:0 lds
M v[32:35], a[36:39], a[132:135], v[32:35]
M v[36:39], a[44:47], a[132:135], v[36:39]
ds_read_b64_tr_b16 v[160:161], v16 offset:0
ds_read_b64_tr_b16 v[162:163], v16 offset:4096
M v[36:39], a[40:43], a[128:131], v[36:39]
M v[40:43], a[48:51], a[128:131], v[40:43]
buffer_load_dwordx4 v3, s[48:51], s26 offen offset:1024 lds
M v[40:43], a[52:55], a[132:135], v[40:43]
M v[44:47], a[60:63], a[132:135], v[44:47]
ds_read_b64_tr_b16 v[164:165], v16 offset:8192
ds_read_b64_tr_b16 v[166:167], v16 offset:12288
M v[44:47], a[56:59], a[128:131], v[44:47]
M v[48:51], a[64:67], a[128:131], v[48:51]
buffer_load_dwordx4 v4, s[48:51], s26 offen offset:2048 lds
M v[48:51], a[68:71], a[132:135], v[48:51]
M v[52:55], a[76:79], a[132:135], v[52:55]
ds_read_b64_tr_b16 v[168:169], v17 offset:0
ds_read_b64_tr_b16 v[170:171], v17 offset:4096
M v[52:55], a[72:75], a[128:131], v[52:55]
M v[56:59], a[80:83], a[128:131], v[56:59]
buffer_load_dwordx4 v5, s[48:51], s26 offen offset:3072 lds
M v[56:59], a[84:87], a[132:135], v[56:59]
M v[60:63], a[92:95], a[132:135], v[60:63]
ds_read_b64_tr_b16 v[172:173], v17 offset:8192
ds_read_b64_tr_b16 v[174:175], v17 offset:12288
M v[60:63], a[88:91], a[128:131], v[60:63]
M v[64:67], a[32:35], a[136:139], v[64:67]
buffer_load_dwordx4 a[96:99], v1, s[44:47], s25 offen offset:0 sc1
M v[64:67], a[36:39], a[140:143], v[64:67]
M v[68:71], a[44:47], a[140:143], v[68:71]
ds_read_b64_tr_b16 v[176:177], v18 offset:0
ds_read_b64_tr_b16 v[178:179], v18 offset:4096
M v[68:71], a[40:43], a[136:139], v[68:71]
M v[72:75], a[48:51], a[136:139], v[72:75]
buffer_load_dwordx4 a[100:103], v1, s[44:47], s25 offen offset:1024 sc1
M v[72:75], a[52:55], a[140:143], v[72:75]
M v[76:79], a[60:63], a[140:143], v[76:79]
ds_read_b64_tr_b16 v[180:181], v18 offset:8192
ds_read_b64_tr_b16 v[182:183], v18 offset:12288
M v[76:79], a[56:59], a[136:139], v[76:79]
M v[80:83], a[64:67], a[136:139], v[80:83]
buffer_load_dwordx4 a[104:107], v1, s[44:47], s25 offen offset:2048 sc1
M v[80:83], a[68:71], a[140:143], v[80:83]
M v[84:87], a[76:79], a[140:143], v[84:87]
ds_read_b64_tr_b16 v[184:185], v19 offset:0
ds_read_b64_tr_b16 v[186:187], v19 offset:4096
M v[84:87], a[72:75], a[136:139], v[84:87]
M v[88:91], a[80:83], a[136:139], v[88:91]
buffer_load_dwordx4 a[108:111], v1, s[44:47], s25 offen offset:3072 sc1
M v[88:91], a[84:87], a[140:143], v[88:91]
M v[92:95], a[92:95], a[140:143], v[92:95]
M v[92:95], a[88:91], a[136:139], v[92:95]
ds_read_b64_tr_b16 v[188:189], v19 offset:8192
ds_read_b64_tr_b16 v[190:191], v19 offset:12288
M v[96:99], a[32:35], a[144:147], v[96:99]
M v[96:99], a[36:39], a[148:151], v[96:99]
s_add_u32 s63, s25, 4096
buffer_load_dwordx4 a[112:115], v1, s[44:47], s63 offen offset:0 sc1
M v[100:103], a[44:47], a[148:151], v[100:103]
M v[100:103], a[40:43], a[144:147], v[100:103]
ds_read_b64_tr_b16 v[192:193], v20 offset:0
ds_read_b64_tr_b16 v[194:195], v20 offset:4096
M v[104:107], a[48:51], a[144:147], v[104:107]
M v[104:107], a[52:55], a[148:151], v[104:107]
buffer_load_dwordx4 a[116:119], v1, s[44:47], s63 offen offset:1024 sc1
M v[108:111], a[60:63], a[148:151], v[108:111]
M v[108:111], a[56:59], a[144:147], v[108:111]
ds_read_b64_tr_b16 v[196:197], v20 offset:8192
ds_read_b64_tr_b16 v[198:199], v20 offset:12288
M v[112:115], a[64:67], a[144:147], v[112:115]
M v[112:115], a[68:71], a[148:151], v[112:115]
buffer_load_dwordx4 a[120:123], v1, s[44:47], s63 offen offset:2048 sc1
M v[116:119], a[76:79], a[148:151], v[116:119]
M v[116:119], a[72:75], a[144:147], v[116:119]
ds_read_b64_tr_b16 v[200:201], v21 offset:0
ds_read_b64_tr_b16 v[202:203], v21 offset:4096
M v[120:123], a[80:83], a[144:147], v[120:123]
M v[120:123], a[84:87], a[148:151], v[120:123]
buffer_load_dwordx4 a[124:127], v1, s[44:47], s63 offen offset:3072 sc1
M v[124:127], a[92:95], a[148:151], v[124:127]
M v[124:127], a[88:91], a[144:147], v[124:127]
ds_read_b64_tr_b16 v[204:205], v21 offset:8192
ds_read_b64_tr_b16 v[206:207], v21 offset:12288
M v[128:131], a[32:35], a[152:155], v[128:131]
M v[128:131], a[36:39], a[156:159], v[128:131]
s_sub_u32 s39, s39, 1
s_cmp_eq_u32 s39, 0
s_cselect_b32 s3, s64, s65
M v[132:135], a[44:47], a[156:159], v[132:135]
M v[132:135], a[40:43], a[152:155], v[132:135]
ds_read_b64_tr_b16 v[208:209], v22 offset:0
ds_read_b64_tr_b16 v[210:211], v22 offset:4096
M v[136:139], a[48:51], a[152:155], v[136:139]
M v[136:139], a[52:55], a[156:159], v[136:139]
s_add_u32 s25, s25, s3
s_lshl_b32 s3, s3, 3
s_add_u32 s26, s26, s3
M v[140:143], a[60:63], a[156:159], v[140:143]
M v[140:143], a[56:59], a[152:155], v[140:143]
ds_read_b64_tr_b16 v[212:213], v22 offset:8192
ds_read_b64_tr_b16 v[214:215], v22 offset:12288
M v[144:147], a[64:67], a[152:155], v[144:147]
M v[144:147], a[68:71], a[156:159], v[144:147]
ds_read_b64_tr_b16 v[216:217], v23 offset:0
ds_read_b64_tr_b16 v[218:219], v23 offset:4096
M v[148:151], a[76:79], a[156:159], v[148:151]
M v[148:151], a[72:75], a[152:155], v[148:151]
ds_read_b64_tr_b16 v[220:221], v23 offset:8192
ds_read_b64_tr_b16 v[222:223], v23 offset:12288
M v[152:155], a[80:83], a[152:155], v[152:155]
M v[152:155], a[84:87], a[156:159], v[152:155]
M v[156:159], a[92:95], a[156:159], v[156:159]
M v[156:159], a[88:91], a[152:155], v[156:159]
s_waitcnt vmcnt(24) lgkmcnt(0)
s_barrier
M v[32:35], v[160:163], a[160:163], v[32:35]
s_mov_b64 s[44:45], s[34:35]
s_mov_b32 s46, 4194304
s_mov_b64 s[48:49], s[36:37]
s_mov_b32 s50, 2097152
s_mov_b32 s25, s32
s_mov_b32 s26, s33
s_add_u32 m0, s42, 0
s_nop 0
buffer_load_dwordx4 v6, s[48:51], s26 offen offset:0 lds
M v[32:35], v[164:167], a[164:167], v[32:35]
M v[36:39], v[172:175], a[164:167], v[36:39]
ds_read_b64_tr_b16 a[32:33], v16 offset:16384
ds_read_b64_tr_b16 a[34:35], v16 offset:20480
M v[36:39], v[168:171], a[160:163], v[36:39]
M v[40:43], v[176:179], a[160:163], v[40:43]
M v[40:43], v[180:183], a[164:167], v[40:43]
buffer_load_dwordx4 v7, s[48:51], s26 offen offset:1024 lds
M v[44:47], v[188:191], a[164:167], v[44:47]
M v[44:47], v[184:187], a[160:163], v[44:47]
M v[48:51], v[192:195], a[160:163], v[48:51]
ds_read_b64_tr_b16 a[36:37], v16 offset:24576
ds_read_b64_tr_b16 a[38:39], v16 offset:28672
M v[48:51], v[196:199], a[164:167], v[48:51]
M v[52:55], v[204:207], a[164:167], v[52:55]
buffer_load_dwordx4 a[128:131], v1, s[44:47], s25 offen offset:0 sc1
M v[52:55], v[200:203], a[160:163], v[52:55]
M v[56:59], v[208:211], a[160:163], v[56:59]
M v[56:59], v[212:215], a[164:167], v[56:59]
ds_read_b64_tr_b16 a[40:41], v17 offset:16384
ds_read_b64_tr_b16 a[42:43], v17 offset:20480
M v[60:63], v[220:223], a[164:167], v[60:63]
M v[60:63], v[216:219], a[160:163], v[60:63]
M v[64:67], v[160:163], a[168:171], v[64:67]
buffer_load_dwordx4 a[132:135], v1, s[44:47], s25 offen offset:1024 sc1
M v[64:67], v[164:167], a[172:175], v[64:67]
M v[68:71], v[172:175], a[172:175], v[68:71]
ds_read_b64_tr_b16 a[44:45], v17 offset:24576
ds_read_b64_tr_b16 a[46:47], v17 offset:28672
M v[68:71], v[168:171], a[168:171], v[68:71]
M v[72:75], v[176:179], a[168:171], v[72:75]
M v[72:75], v[180:183], a[172:175], v[72:75]
buffer_load_dwordx4 a[136:139], v1, s[44:47], s25 offen offset:2048 sc1
M v[76:79], v[188:191], a[172:175], v[76:79]
M v[76:79], v[184:187], a[168:171], v[76:79]
M v[80:83], v[192:195], a[168:171], v[80:83]
ds_read_b64_tr_b16 a[48:49], v18 offset:16384
ds_read_b64_tr_b16 a[50:51], v18 offset:20480
M v[80:83], v[196:199], a[172:175], v[80:83]
M v[84:87], v[204:207], a[172:175], v[84:87]
buffer_load_dwordx4 a[140:143], v1, s[44:47], s25 offen offset:3072 sc1
M v[84:87], v[200:203], a[168:171], v[84:87]
M v[88:91], v[208:211], a[168:171], v[88:91]
M v[88:91], v[212:215], a[172:175], v[88:91]
ds_read_b64_tr_b16 a[52:53], v18 offset:24576
ds_read_b64_tr_b16 a[54:55], v18 offset:28672
M v[92:95], v[220:223], a[172:175], v[92:95]
M v[92:95], v[216:219], a[168:171], v[92:95]
M v[96:99], v[160:163], a[176:179], v[96:99]
s_add_u32 s25, s25, 16384
s_add_u32 s26, s26, 131072
M v[96:99], v[164:167], a[180:183], v[96:99]
M v[100:103], v[172:175], a[180:183], v[100:103]
M v[100:103], v[168:171], a[176:179], v[100:103]
ds_read_b64_tr_b16 a[56:57], v19 offset:16384
ds_read_b64_tr_b16 a[58:59], v19 offset:20480
M v[104:107], v[176:179], a[176:179], v[104:107]
M v[104:107], v[180:183], a[180:183], v[104:107]
ds_read_b64_tr_b16 a[60:61], v19 offset:24576
ds_read_b64_tr_b16 a[62:63], v19 offset:28672
M v[108:111], v[188:191], a[180:183], v[108:111]
M v[108:111], v[184:187], a[176:179], v[108:111]
M v[112:115], v[192:195], a[176:179], v[112:115]
ds_read_b64_tr_b16 a[64:65], v20 offset:16384
ds_read_b64_tr_b16 a[66:67], v20 offset:20480
M v[112:115], v[196:199], a[180:183], v[112:115]
M v[116:119], v[204:207], a[180:183], v[116:119]
M v[116:119], v[200:203], a[176:179], v[116:119]
ds_read_b64_tr_b16 a[68:69], v20 offset:24576
ds_read_b64_tr_b16 a[70:71], v20 offset:28672
M v[120:123], v[208:211], a[176:179], v[120:123]
M v[120:123], v[212:215], a[180:183], v[120:123]
ds_read_b64_tr_b16 a[72:73], v21 offset:16384
ds_read_b64_tr_b16 a[74:75], v21 offset:20480
M v[124:127], v[220:223], a[180:183], v[124:127]
M v[124:127], v[216:219], a[176:179], v[124:127]
M v[128:131], v[160:163], a[184:187], v[128:131]
ds_read_b64_tr_b16 a[76:77], v21 offset:24576
ds_read_b64_tr_b16 a[78:79], v21 offset:28672
M v[128:131], v[164:167], a[188:191], v[128:131]
M v[132:135], v[172:175], a[188:191], v[132:135]
M v[132:135], v[168:171], a[184:187], v[132:135]
ds_read_b64_tr_b16 a[80:81], v22 offset:16384
ds_read_b64_tr_b16 a[82:83], v22 offset:20480
M v[136:139], v[176:179], a[184:187], v[136:139]
M v[136:139], v[180:183], a[188:191], v[136:139]
ds_read_b64_tr_b16 a[84:85], v22 offset:24576
ds_read_b64_tr_b16 a[86:87], v22 offset:28672
M v[140:143], v[188:191], a[188:191], v[140:143]
M v[140:143], v[184:187], a[184:187], v[140:143]
M v[144:147], v[192:195], a[184:187], v[144:147]
ds_read_b64_tr_b16 a[88:89], v23 offset:16384
ds_read_b64_tr_b16 a[90:91], v23 offset:20480
M v[144:147], v[196:199], a[188:191], v[144:147]
M v[148:151], v[204:207], a[188:191], v[148:151]
M v[148:151], v[200:203], a[184:187], v[148:151]
ds_read_b64_tr_b16 a[92:93], v23 offset:24576
ds_read_b64_tr_b16 a[94:95], v23 offset:28672
M v[152:155], v[208:211], a[184:187], v[152:155]
M v[152:155], v[212:215], a[188:191], v[152:155]
M v[156:159], v[220:223], a[188:191], v[156:159]
M v[156:159], v[216:219], a[184:187], v[156:159]
s_waitcnt vmcnt(18) lgkmcnt(0)
s_barrier
M v[32:35], a[32:35], a[192:195], v[32:35]
s_add_u32 m0, s42, 16384
s_nop 0
buffer_load_dwordx4 v6, s[48:51], s26 offen offset:0 lds
M v[32:35], a[36:39], a[196:199], v[32:35]
M v[36:39], a[44:47], a[196:199], v[36:39]
ds_read_b64_tr_b16 v[160:161], v16 offset:32768
ds_read_b64_tr_b16 v[162:163], v16 offset:36864
M v[36:39], a[40:43], a[192:195], v[36:39]
M v[40:43], a[48:51], a[192:195], v[40:43]
M v[40:43], a[52:55], a[196:199], v[40:43]
buffer_load_dwordx4 v7, s[48:51], s26 offen offset:1024 lds
M v[44:47], a[60:63], a[196:199], v[44:47]
M v[44:47], a[56:59], a[192:195], v[44:47]
M v[48:51], a[64:67], a[192:195], v[48:51]
ds_read_b64_tr_b16 v[164:165], v16 offset:40960
ds_read_b64_tr_b16 v[166:167], v16 offset:45056
M v[48:51], a[68:71], a[196:199], v[48:51]
M v[52:55], a[76:79], a[196:199], v[52:55]
buffer_load_dwordx4 a[160:163], v1, s[44:47], s25 offen offset:0 sc1
M v[52:55], a[72:75], a[192:195], v[52:55]
M v[56:59], a[80:83], a[192:195], v[56:59]
M v[56:59], a[84:87], a[196:199], v[56:59]
ds_read_b64_tr_b16 v[168:169], v17 offset:32768
ds_read_b64_tr_b16 v[170:171], v17 offset:36864
M v[60:63], a[92:95], a[196:199], v[60:63]
M v[60:63], a[88:91], a[192:195], v[60:63]
M v[64:67], a[32:35], a[200:203], v[64:67]
buffer_load_dwordx4 a[164:167], v1, s[44:47], s25 offen offset:1024 sc1
M v[64:67], a[36:39], a[204:207], v[64:67]
M v[68:71], a[44:47], a[204:207], v[68:71]
ds_read_b64_tr_b16 v[172:173], v17 offset:40960
ds_read_b64_tr_b16 v[174:175], v17 offset:45056
M v[68:71], a[40:43], a[200:203], v[68:71]
M v[72:75], a[48:51], a[200:203], v[72:75]
M v[72:75], a[52:55], a[204:207], v[72:75]
buffer_load_dwordx4 a[168:171], v1, s[44:47], s25 offen offset:2048 sc1
M v[76:79], a[60:63], a[204:207], v[76:79]
M v[76:79], a[56:59], a[200:203], v[76:79]
M v[80:83], a[64:67], a[200:203], v[80:83]
ds_read_b64_tr_b16 v[176:177], v18 offset:32768
ds_read_b64_tr_b16 v[178:179], v18 offset:36864
M v[80:83], a[68:71], a[204:207], v[80:83]
M v[84:87], a[76:79], a[204:207], v[84:87]
buffer_load_dwordx4 a[172:175], v1, s[44:47], s25 offen offset:3072 sc1
M v[84:87], a[72:75], a[200:203], v[84:87]
M v[88:91], a[80:83], a[200:203], v[88:91]
M v[88:91], a[84:87], a[204:207], v[88:91]
ds_read_b64_tr_b16 v[180:181], v18 offset:40960
ds_read_b64_tr_b16 v[182:183], v18 offset:45056
M v[92:95], a[92:95], a[204:207], v[92:95]
M v[92:95], a[88:91], a[200:203], v[92:95]
M v[96:99], a[32:35], a[208:211], v[96:99]
s_add_u32 s25, s25, 16384
s_add_u32 s26, s26, 131072
M v[96:99], a[36:39], a[212:215], v[96:99]
M v[100:103], a[44:47], a[212:215], v[100:103]
M v[100:103], a[40:43], a[208:211], v[100:103]
ds_read_b64_tr_b16 v[184:185], v19 offset:32768
ds_read_b64_tr_b16 v[186:187], v19 offset:36864
M v[104:107], a[48:51], a[208:211], v[104:107]
M v[104:107], a[52:55], a[212:215], v[104:107]
ds_read_b64_tr_b16 v[188:189], v19 offset:40960
ds_read_b64_tr_b16 v[190:191], v19 offset:45056
M v[108:111], a[60:63], a[212:215], v[108:111]
M v[108:111], a[56:59], a[208:211], v[108:111]
M v[112:115], a[64:67], a[208:211], v[112:115]
ds_read_b64_tr_b16 v[192:193], v20 offset:32768
ds_read_b64_tr_b16 v[194:195], v20 offset:36864
M v[112:115], a[68:71], a[212:215], v[112:115]
M v[116:119], a[76:79], a[212:215], v[116:119]
M v[116:119], a[72:75], a[208:211], v[116:119]
ds_read_b64_tr_b16 v[196:197], v20 offset:40960
ds_read_b64_tr_b16 v[198:199], v20 offset:45056
M v[120:123], a[80:83], a[208:211], v[120:123]
M v[120:123], a[84:87], a[212:215], v[120:123]
ds_read_b64_tr_b16 v[200:201], v21 offset:32768
ds_read_b64_tr_b16 v[202:203], v21 offset:36864
M v[124:127], a[92:95], a[212:215], v[124:127]
M v[124:127], a[88:91], a[208:211], v[124:127]
M v[128:131], a[32:35], a[216:219], v[128:131]
ds_read_b64_tr_b16 v[204:205], v21 offset:40960
ds_read_b64_tr_b16 v[206:207], v21 offset:45056
M v[128:131], a[36:39], a[220:223], v[128:131]
M v[132:135], a[44:47], a[220:223], v[132:135]
M v[132:135], a[40:43], a[216:219], v[132:135]
ds_read_b64_tr_b16 v[208:209], v22 offset:32768
ds_read_b64_tr_b16 v[210:211], v22 offset:36864
M v[136:139], a[48:51], a[216:219], v[136:139]
M v[136:139], a[52:55], a[220:223], v[136:139]
ds_read_b64_tr_b16 v[212:213], v22 offset:40960
ds_read_b64_tr_b16 v[214:215], v22 offset:45056
M v[140:143], a[60:63], a[220:223], v[140:143]
M v[140:143], a[56:59], a[216:219], v[140:143]
M v[144:147], a[64:67], a[216:219], v[144:147]
ds_read_b64_tr_b16 v[216:217], v23 offset:32768
ds_read_b64_tr_b16 v[218:219], v23 offset:36864
M v[144:147], a[68:71], a[220:223], v[144:147]
M v[148:151], a[76:79], a[220:223], v[148:151]
M v[148:151], a[72:75], a[216:219], v[148:151]
ds_read_b64_tr_b16 v[220:221], v23 offset:40960
ds_read_b64_tr_b16 v[222:223], v23 offset:45056
M v[152:155], a[80:83], a[216:219], v[152:155]
M v[152:155], a[84:87], a[220:223], v[152:155]
M v[156:159], a[92:95], a[220:223], v[156:159]
M v[156:159], a[88:91], a[216:219], v[156:159]
s_waitcnt vmcnt(12) lgkmcnt(0)
s_barrier
M v[32:35], v[160:163], a[224:227], v[32:35]
s_add_u32 m0, s42, 32768
s_nop 0
buffer_load_dwordx4 v6, s[48:51], s26 offen offset:0 lds
M v[32:35], v[164:167], a[228:231], v[32:35]
M v[36:39], v[172:175], a[228:231], v[36:39]
ds_read_b64_tr_b16 a[32:33], v16 offset:49152
ds_read_b64_tr_b16 a[34:35], v16 offset:53248
M v[36:39], v[168:171], a[224:227], v[36:39]
M v[40:43], v[176:179], a[224:227], v[40:43]
M v[40:43], v[180:183], a[228:231], v[40:43]
buffer_load_dwordx4 v7, s[48:51], s26 offen offset:1024 lds
M v[44:47], v[188:191], a[228:231], v[44:47]
M v[44:47], v[184:187], a[224:227], v[44:47]
M v[48:51], v[192:195], a[224:227], v[48:51]
ds_read_b64_tr_b16 a[36:37], v16 offset:57344
ds_read_b64_tr_b16 a[38:39], v16 offset:61440
M v[48:51], v[196:199], a[228:231], v[48:51]
M v[52:55], v[204:207], a[228:231], v[52:55]
buffer_load_dwordx4 a[192:195], v1, s[44:47], s25 offen offset:0 sc1
M v[52:55], v[200:203], a[224:227], v[52:55]
M v[56:59], v[208:211], a[224:227], v[56:59]
M v[56:59], v[212:215], a[228:231], v[56:59]
ds_read_b64_tr_b16 a[40:41], v17 offset:49152
ds_read_b64_tr_b16 a[42:43], v17 offset:53248
M v[60:63], v[220:223], a[228:231], v[60:63]
M v[60:63], v[216:219], a[224:227], v[60:63]
M v[64:67], v[160:163], a[232:235], v[64:67]
buffer_load_dwordx4 a[196:199], v1, s[44:47], s25 offen offset:1024 sc1
M v[64:67], v[164:167], a[236:239], v[64:67]
M v[68:71], v[172:175], a[236:239], v[68:71]
ds_read_b64_tr_b16 a[44:45], v17 offset:57344
ds_read_b64_tr_b16 a[46:47], v17 offset:61440
M v[68:71], v[168:171], a[232:235], v[68:71]
M v[72:75], v[176:179], a[232:235], v[72:75]
M v[72:75], v[180:183], a[236:239], v[72:75]
buffer_load_dwordx4 a[200:203], v1, s[44:47], s25 offen offset:2048 sc1
M v[76:79], v[188:191], a[236:239], v[76:79]
M v[76:79], v[184:187], a[232:235], v[76:79]
M v[80:83], v[192:195], a[232:235], v[80:83]
ds_read_b64_tr_b16 a[48:49], v18 offset:49152
ds_read_b64_tr_b16 a[50:51], v18 offset:53248
M v[80:83], v[196:199], a[236:239], v[80:83]
M v[84:87], v[204:207], a[236:239], v[84:87]
buffer_load_dwordx4 a[204:207], v1, s[44:47], s25 offen offset:3072 sc1
M v[84:87], v[200:203], a[232:235], v[84:87]
M v[88:91], v[208:211], a[232:235], v[88:91]
M v[88:91], v[212:215], a[236:239], v[88:91]
ds_read_b64_tr_b16 a[52:53], v18 offset:57344
ds_read_b64_tr_b16 a[54:55], v18 offset:61440
M v[92:95], v[220:223], a[236:239], v[92:95]
M v[92:95], v[216:219], a[232:235], v[92:95]
M v[96:99], v[160:163], a[240:243], v[96:99]
s_add_u32 s25, s25, 16384
s_add_u32 s26, s26, 131072
M v[96:99], v[164:167], a[244:247], v[96:99]
M v[100:103], v[172:175], a[244:247], v[100:103]
M v[100:103], v[168:171], a[240:243], v[100:103]
ds_read_b64_tr_b16 a[56:57], v19 offset:49152
ds_read_b64_tr_b16 a[58:59], v19 offset:53248
M v[104:107], v[176:179], a[240:243], v[104:107]
M v[104:107], v[180:183], a[244:247], v[104:107]
ds_read_b64_tr_b16 a[60:61], v19 offset:57344
ds_read_b64_tr_b16 a[62:63], v19 offset:61440
M v[108:111], v[188:191], a[244:247], v[108:111]
M v[108:111], v[184:187], a[240:243], v[108:111]
M v[112:115], v[192:195], a[240:243], v[112:115]
ds_read_b64_tr_b16 a[64:65], v20 offset:49152
ds_read_b64_tr_b16 a[66:67], v20 offset:53248
M v[112:115], v[196:199], a[244:247], v[112:115]
M v[116:119], v[204:207], a[244:247], v[116:119]
M v[116:119], v[200:203], a[240:243], v[116:119]
ds_read_b64_tr_b16 a[68:69], v20 offset:57344
ds_read_b64_tr_b16 a[70:71], v20 offset:61440
M v[120:123], v[208:211], a[240:243], v[120:123]
M v[120:123], v[212:215], a[244:247], v[120:123]
ds_read_b64_tr_b16 a[72:73], v21 offset:49152
ds_read_b64_tr_b16 a[74:75], v21 offset:53248
M v[124:127], v[220:223], a[244:247], v[124:127]
M v[124:127], v[216:219], a[240:243], v[124:127]
M v[128:131], v[160:163], a[248:251], v[128:131]
ds_read_b64_tr_b16 a[76:77], v21 offset:57344
ds_read_b64_tr_b16 a[78:79], v21 offset:61440
M v[128:131], v[164:167], a[252:255], v[128:131]
M v[132:135], v[172:175], a[252:255], v[132:135]
M v[132:135], v[168:171], a[248:251], v[132:135]
ds_read_b64_tr_b16 a[80:81], v22 offset:49152
ds_read_b64_tr_b16 a[82:83], v22 offset:53248
M v[136:139], v[176:179], a[248:251], v[136:139]
M v[136:139], v[180:183], a[252:255], v[136:139]
ds_read_b64_tr_b16 a[84:85], v22 offset:57344
ds_read_b64_tr_b16 a[86:87], v22 offset:61440
M v[140:143], v[188:191], a[252:255], v[140:143]
M v[140:143], v[184:187], a[248:251], v[140:143]
M v[144:147], v[192:195], a[248:251], v[144:147]
ds_read_b64_tr_b16 a[88:89], v23 offset:49152
ds_read_b64_tr_b16 a[90:91], v23 offset:53248
M v[144:147], v[196:199], a[252:255], v[144:147]
M v[148:151], v[204:207], a[252:255], v[148:151]
M v[148:151], v[200:203], a[248:251], v[148:151]
ds_read_b64_tr_b16 a[92:93], v23 offset:57344
ds_read_b64_tr_b16 a[94:95], v23 offset:61440
M v[152:155], v[208:211], a[248:251], v[152:155]
M v[152:155], v[212:215], a[252:255], v[152:155]
M v[156:159], v[220:223], a[252:255], v[156:159]
M v[156:159], v[216:219], a[248:251], v[156:159]
s_waitcnt vmcnt(12) lgkmcnt(0)
s_barrier
M v[32:35], a[32:35], a[96:99], v[32:35]
s_add_u32 m0, s42, 49152
s_nop 0
buffer_load_dwordx4 v6, s[48:51], s26 offen offset:0 lds
M v[32:35], a[36:39], a[100:103], v[32:35]
M v[36:39], a[44:47], a[100:103], v[36:39]
M v[36:39], a[40:43], a[96:99], v[36:39]
M v[40:43], a[48:51], a[96:99], v[40:43]
ds_read_b64_tr_b16 v[160:161], v24 offset:0
ds_read_b64_tr_b16 v[162:163], v24 offset:2048
M v[40:43], a[52:55], a[100:103], v[40:43]
M v[44:47], a[60:63], a[100:103], v[44:47]
M v[44:47], a[56:59], a[96:99], v[44:47]
M v[48:51], a[64:67], a[96:99], v[48:51]
buffer_load_dwordx4 v7, s[48:51], s26 offen offset:1024 lds
M v[48:51], a[68:71], a[100:103], v[48:51]
M v[52:55], a[76:79], a[100:103], v[52:55]
M v[52:55], a[72:75], a[96:99], v[52:55]
M v[56:59], a[80:83], a[96:99], v[56:59]
ds_read_b64_tr_b16 v[164:165], v24 offset:4096
ds_read_b64_tr_b16 v[166:167], v24 offset:6144
M v[56:59], a[84:87], a[100:103], v[56:59]
M v[60:63], a[92:95], a[100:103], v[60:63]
M v[60:63], a[88:91], a[96:99], v[60:63]
M v[64:67], a[32:35], a[104:107], v[64:67]
buffer_load_dwordx4 a[224:227], v1, s[44:47], s25 offen offset:0 sc1
M v[64:67], a[36:39], a[108:111], v[64:67]
M v[68:71], a[44:47], a[108:111], v[68:71]
v_cvt_pk_bf16_f32 v40, v40, v41
v_cvt_pk_bf16_f32 v41, v42, v43
M v[68:71], a[40:43], a[104:107], v[68:71]
v_cvt_pk_bf16_f32 v42, v44, v45
v_cvt_pk_bf16_f32 v43, v46, v47
M v[72:75], a[48:51], a[104:107], v[72:75]
ds_read_b64_tr_b16 v[168:169], v25 offset:0
ds_read_b64_tr_b16 v[170:171], v25 offset:2048
M v[72:75], a[52:55], a[108:111], v[72:75]
s_add_u32 s60, s56, 4096
buffer_store_dwordx4 v[40:43], v1, s[52:55], s60 offen offset:0 sc1
M v[76:79], a[60:63], a[108:111], v[76:79]
M v[76:79], a[56:59], a[104:107], v[76:79]
v_cvt_pk_bf16_f32 v48, v48, v49
v_cvt_pk_bf16_f32 v49, v50, v51
M v[80:83], a[64:67], a[104:107], v[80:83]
buffer_load_dwordx4 a[228:231], v1, s[44:47], s25 offen offset:1024 sc1
v_cvt_pk_bf16_f32 v50, v52, v53
v_cvt_pk_bf16_f32 v51, v54, v55
M v[80:83], a[68:71], a[108:111], v[80:83]
M v[84:87], a[76:79], a[108:111], v[84:87]
s_add_u32 s60, s56, 8192
buffer_store_dwordx4 v[48:51], v1, s[52:55], s60 offen offset:0 sc1
M v[84:87], a[72:75], a[104:107], v[84:87]
M v[88:91], a[80:83], a[104:107], v[88:91]
ds_read_b64_tr_b16 v[172:173], v25 offset:4096
ds_read_b64_tr_b16 v[174:175], v25 offset:6144
v_cvt_pk_bf16_f32 v56, v56, v57
v_cvt_pk_bf16_f32 v57, v58, v59
M v[88:91], a[84:87], a[108:111], v[88:91]
v_cvt_pk_bf16_f32 v58, v60, v61
v_cvt_pk_bf16_f32 v59, v62, v63
M v[92:95], a[92:95], a[108:111], v[92:95]
M v[92:95], a[88:91], a[104:107], v[92:95]
s_add_u32 s60, s56, 12288
buffer_store_dwordx4 v[56:59], v1, s[52:55], s60 offen offset:0 sc1
M v[96:99], a[32:35], a[112:115], v[96:99]
M v[96:99], a[36:39], a[116:119], v[96:99]
buffer_load_dwordx4 a[232:235], v1, s[44:47], s25 offen offset:2048 sc1
M v[100:103], a[44:47], a[116:119], v[100:103]
v_cvt_pk_bf16_f32 v72, v72, v73
v_cvt_pk_bf16_f32 v73, v74, v75
M v[100:103], a[40:43], a[112:115], v[100:103]
v_cvt_pk_bf16_f32 v74, v76, v77
v_cvt_pk_bf16_f32 v75, v78, v79
M v[104:107], a[48:51], a[112:115], v[104:107]
M v[104:107], a[52:55], a[116:119], v[104:107]
ds_read_b64_tr_b16 v[176:177], v26 offset:0
ds_read_b64_tr_b16 v[178:179], v26 offset:2048
s_add_u32 s60, s56, 4096
buffer_store_dwordx4 v[72:75], v1, s[52:55], s60 offen offset:1024 sc1
M v[108:111], a[60:63], a[116:119], v[108:111]
M v[108:111], a[56:59], a[112:115], v[108:111]
v_cvt_pk_bf16_f32 v80, v80, v81
v_cvt_pk_bf16_f32 v81, v82, v83
M v[112:115], a[64:67], a[112:115], v[112:115]
v_cvt_pk_bf16_f32 v82, v84, v85
v_cvt_pk_bf16_f32 v83, v86, v87
M v[112:115], a[68:71], a[116:119], v[112:115]
buffer_load_dwordx4 a[236:239], v1, s[44:47], s25 offen offset:3072 sc1
M v[116:119], a[76:79], a[116:119], v[116:119]
s_add_u32 s60, s56, 8192
buffer_store_dwordx4 v[80:83], v1, s[52:55], s60 offen offset:1024 sc1
M v[116:119], a[72:75], a[112:115], v[116:119]
M v[120:123], a[80:83], a[112:115], v[120:123]
v_cvt_pk_bf16_f32 v88, v88, v89
v_cvt_pk_bf16_f32 v89, v90, v91
M v[120:123], a[84:87], a[116:119], v[120:123]
ds_read_b64_tr_b16 v[180:181], v26 offset:4096
ds_read_b64_tr_b16 v[182:183], v26 offset:6144
v_cvt_pk_bf16_f32 v90, v92, v93
v_cvt_pk_bf16_f32 v91, v94, v95
M v[124:127], a[92:95], a[116:119], v[124:127]
M v[124:127], a[88:91], a[112:115], v[124:127]
s_add_u32 s60, s56, 12288
buffer_store_dwordx4 v[88:91], v1, s[52:55], s60 offen offset:1024 sc1
M v[128:131], a[32:35], a[120:123], v[128:131]
M v[128:131], a[36:39], a[124:127], v[128:131]
s_add_u32 s25, s25, 16384
s_add_u32 s26, s26, 131072
M v[132:135], a[44:47], a[124:127], v[132:135]
v_cvt_pk_bf16_f32 v104, v104, v105
v_cvt_pk_bf16_f32 v105, v106, v107
M v[132:135], a[40:43], a[120:123], v[132:135]
v_cvt_pk_bf16_f32 v106, v108, v109
v_cvt_pk_bf16_f32 v107, v110, v111
M v[136:139], a[48:51], a[120:123], v[136:139]
M v[136:139], a[52:55], a[124:127], v[136:139]
ds_read_b64_tr_b16 v[184:185], v27 offset:0
ds_read_b64_tr_b16 v[186:187], v27 offset:2048
s_add_u32 s60, s56, 4096
buffer_store_dwordx4 v[104:107], v1, s[52:55], s60 offen offset:2048 sc1
M v[140:143], a[60:63], a[124:127], v[140:143]
M v[140:143], a[56:59], a[120:123], v[140:143]
v_cvt_pk_bf16_f32 v112, v112, v113
v_cvt_pk_bf16_f32 v113, v114, v115
M v[144:147], a[64:67], a[120:123], v[144:147]
v_cvt_pk_bf16_f32 v114, v116, v117
v_cvt_pk_bf16_f32 v115, v118, v119
M v[144:147], a[68:71], a[124:127], v[144:147]
ds_read_b64_tr_b16 v[188:189], v27 offset:4096
ds_read_b64_tr_b16 v[190:191], v27 offset:6144
M v[148:151], a[76:79], a[124:127], v[148:151]
s_add_u32 s60, s56, 8192
buffer_store_dwordx4 v[112:115], v1, s[52:55], s60 offen offset:2048 sc1
M v[148:151], a[72:75], a[120:123], v[148:151]
M v[152:155], a[80:83], a[120:123], v[152:155]
v_cvt_pk_bf16_f32 v120, v120, v121
v_cvt_pk_bf16_f32 v121, v122, v123
M v[152:155], a[84:87], a[124:127], v[152:155]
v_cvt_pk_bf16_f32 v122, v124, v125
v_cvt_pk_bf16_f32 v123, v126, v127
M v[156:159], a[92:95], a[124:127], v[156:159]
M v[156:159], a[88:91], a[120:123], v[156:159]
s_add_u32 s60, s56, 12288
buffer_store_dwordx4 v[120:123], v1, s[52:55], s60 offen offset:2048 sc1
s_waitcnt vmcnt(21) lgkmcnt(0)
s_barrier
M a[0:3], v[160:163], a[128:131], a[0:3]
s_add_u32 m0, s42, 65536
s_nop 0
buffer_load_dwordx4 v6, s[48:51], s26 offen offset:0 lds
ds_read_b64_tr_b16 a[32:33], v24 offset:16384
ds_read_b64_tr_b16 a[34:35], v24 offset:18432
M a[0:3], v[164:167], a[132:135], a[0:3]
buffer_load_dwordx4 v7, s[48:51], s26 offen offset:1024 lds
M a[4:7], v[172:175], a[132:135], a[4:7]
ds_read_b64_tr_b16 a[36:37], v24 offset:20480
ds_read_b64_tr_b16 a[38:39], v24 offset:22528
buffer_load_dwordx4 a[96:99], v1, s[44:47], s25 offen offset:0 sc1
M a[4:7], v[168:171], a[128:131], a[4:7]
ds_read_b64_tr_b16 a[40:41], v25 offset:16384
ds_read_b64_tr_b16 a[42:43], v25 offset:18432
M a[8:11], v[176:179], a[128:131], a[8:11]
buffer_load_dwordx4 a[100:103], v1, s[44:47], s25 offen offset:1024 sc1
M a[8:11], v[180:183], a[132:135], a[8:11]
ds_read_b64_tr_b16 a[44:45], v25 offset:20480
ds_read_b64_tr_b16 a[46:47], v25 offset:22528
buffer_load_dwordx4 a[104:107], v1, s[44:47], s25 offen offset:2048 sc1
M a[12:15], v[188:191], a[132:135], a[12:15]
ds_read_b64_tr_b16 a[48:49], v26 offset:16384
ds_read_b64_tr_b16 a[50:51], v26 offset:18432
M a[12:15], v[184:187], a[128:131], a[12:15]
buffer_load_dwordx4 a[108:111], v1, s[44:47], s25 offen offset:3072 sc1
M a[16:19], v[160:163], a[136:139], a[16:19]
ds_read_b64_tr_b16 a[52:53], v26 offset:20480
ds_read_b64_tr_b16 a[54:55], v26 offset:22528
s_add_u32 s25, s25, 16384
s_add_u32 s26, s26, 131072
M a[16:19], v[164:167], a[140:143], a[16:19]
ds_read_b64_tr_b16 a[56:57], v27 offset:16384
ds_read_b64_tr_b16 a[58:59], v27 offset:18432
M a[20:23], v[172:175], a[140:143], a[20:23]
v_cvt_pk_bf16_f32 v136, v136, v137
v_cvt_pk_bf16_f32 v137, v138, v139
v_cvt_pk_bf16_f32 v138, v140, v141
v_cvt_pk_bf16_f32 v139, v142, v143
s_add_u32 s60, s56, 4096
buffer_store_dwordx4 v[136:139], v1, s[52:55], s60 offen offset:3072 sc1
M a[20:23], v[168:171], a[136:139], a[20:23]
ds_read_b64_tr_b16 a[60:61], v27 offset:20480
ds_read_b64_tr_b16 a[62:63], v27 offset:22528
v_cvt_pk_bf16_f32 v144, v144, v145
v_cvt_pk_bf16_f32 v145, v146, v147
v_cvt_pk_bf16_f32 v146, v148, v149
v_cvt_pk_bf16_f32 v147, v150, v151
s_add_u32 s60, s56, 8192
buffer_store_dwordx4 v[144:147], v1, s[52:55], s60 offen offset:3072 sc1
M a[24:27], v[176:179], a[136:139], a[24:27]
v_cvt_pk_bf16_f32 v152, v152, v153
v_cvt_pk_bf16_f32 v153, v154, v155
v_cvt_pk_bf16_f32 v154, v156, v157
v_cvt_pk_bf16_f32 v155, v158, v159
s_add_u32 s60, s56, 12288
buffer_store_dwordx4 v[152:155], v1, s[52:55], s60 offen offset:3072 sc1
M a[24:27], v[180:183], a[140:143], a[24:27]
v_and_b32 v11, 3, v0
v_lshlrev_b32 v11, 4, v11
M a[28:31], v[188:191], a[140:143], a[28:31]
M a[28:31], v[184:187], a[136:139], a[28:31]
s_waitcnt vmcnt(24) lgkmcnt(0)
s_barrier
s_waitcnt vmcnt(0)
s_mov_b64 exec, 1
buffer_store_dword v254, v253, s[52:55], s58 offen sc1
s_mov_b64 exec, -1
M a[0:3], a[32:35], a[160:163], a[0:3]
s_add_u32 m0, s42, 81920
s_nop 0
buffer_load_dwordx4 v6, s[48:51], s26 offen offset:0 lds
ds_read_b64_tr_b16 v[160:161], v24 offset:32768
ds_read_b64_tr_b16 v[162:163], v24 offset:34816
M a[0:3], a[36:39], a[164:167], a[0:3]
buffer_load_dwordx4 v7, s[48:51], s26 offen offset:1024 lds
M a[4:7], a[44:47], a[164:167], a[4:7]
ds_read_b64_tr_b16 v[164:165], v24 offset:36864
ds_read_b64_tr_b16 v[166:167], v24 offset:38912
M a[4:7], a[40:43], a[160:163], a[4:7]
buffer_load_dwordx4 a[128:131], v1, s[44:47], s25 offen offset:0 sc1
M a[8:11], a[48:51], a[160:163], a[8:11]
ds_read_b64_tr_b16 v[168:169], v25 offset:32768
ds_read_b64_tr_b16 v[170:171], v25 offset:34816
M a[8:11], a[52:55], a[164:167], a[8:11]
buffer_load_dwordx4 a[132:135], v1, s[44:47], s25 offen offset:1024 sc1
M a[12:15], a[60:63], a[164:167], a[12:15]
ds_read_b64_tr_b16 v[172:173], v25 offset:36864
ds_read_b64_tr_b16 v[174:175], v25 offset:38912
M a[12:15], a[56:59], a[160:163], a[12:15]
buffer_load_dwordx4 a[136:139], v1, s[44:47], s25 offen offset:2048 sc1
M a[16:19], a[32:35], a[168:171], a[16:19]
ds_read_b64_tr_b16 v[176:177], v26 offset:32768
ds_read_b64_tr_b16 v[178:179], v26 offset:34816
M a[16:19], a[36:39], a[172:175], a[16:19]
buffer_load_dwordx4 a[140:143], v1, s[44:47], s25 offen offset:3072 sc1
M a[20:23], a[44:47], a[172:175], a[20:23]
ds_read_b64_tr_b16 v[180:181], v26 offset:36864
ds_read_b64_tr_b16 v[182:183], v26 offset:38912
M a[20:23], a[40:43], a[168:171], a[20:23]
s_add_u32 s25, s25, 16384
s_add_u32 s26, s26, 131072
M a[24:27], a[48:51], a[168:171], a[24:27]
ds_read_b64_tr_b16 v[184:185], v27 offset:32768
ds_read_b64_tr_b16 v[186:187], v27 offset:34816
M a[24:27], a[52:55], a[172:175], a[24:27]
ds_read_b64_tr_b16 v[188:189], v27 offset:36864
ds_read_b64_tr_b16 v[190:191], v27 offset:38912
M a[28:31], a[60:63], a[172:175], a[28:31]
M a[28:31], a[56:59], a[168:171], a[28:31]
s_waitcnt vmcnt(21) lgkmcnt(0)
s_barrier
M a[0:3], v[160:163], a[192:195], a[0:3]
s_add_u32 m0, s42, 98304
s_nop 0
buffer_load_dwordx4 v6, s[48:51], s26 offen offset:0 lds
ds_read_b64_tr_b16 a[32:33], v24 offset:49152
ds_read_b64_tr_b16 a[34:35], v24 offset:51200
M a[0:3], v[164:167], a[196:199], a[0:3]
buffer_load_dwordx4 v7, s[48:51], s26 offen offset:1024 lds
M a[4:7], v[172:175], a[196:199], a[4:7]
ds_read_b64_tr_b16 a[36:37], v24 offset:53248
ds_read_b64_tr_b16 a[38:39], v24 offset:55296
M a[4:7], v[168:171], a[192:195], a[4:7]
buffer_load_dwordx4 a[160:163], v1, s[44:47], s25 offen offset:0 sc1
M a[8:11], v[176:179], a[192:195], a[8:11]
ds_read_b64_tr_b16 a[40:41], v25 offset:49152
ds_read_b64_tr_b16 a[42:43], v25 offset:51200
M a[8:11], v[180:183], a[196:199], a[8:11]
buffer_load_dwordx4 a[164:167], v1, s[44:47], s25 offen offset:1024 sc1
M a[12:15], v[188:191], a[196:199], a[12:15]
ds_read_b64_tr_b16 a[44:45], v25 offset:53248
ds_read_b64_tr_b16 a[46:47], v25 offset:55296
M a[12:15], v[184:187], a[192:195], a[12:15]
buffer_load_dwordx4 a[168:171], v1, s[44:47], s25 offen offset:2048 sc1
M a[16:19], v[160:163], a[200:203], a[16:19]
ds_read_b64_tr_b16 a[48:49], v26 offset:49152
ds_read_b64_tr_b16 a[50:51], v26 offset:51200
M a[16:19], v[164:167], a[204:207], a[16:19]
buffer_load_dwordx4 a[172:175], v1, s[44:47], s25 offen offset:3072 sc1
M a[20:23], v[172:175], a[204:207], a[20:23]
ds_read_b64_tr_b16 a[52:53], v26 offset:53248
ds_read_b64_tr_b16 a[54:55], v26 offset:55296
M a[20:23], v[168:171], a[200:203], a[20:23]
s_add_u32 s25, s25, 16384
s_add_u32 s26, s26, 131072
M a[24:27], v[176:179], a[200:203], a[24:27]
ds_read_b64_tr_b16 a[56:57], v27 offset:49152
ds_read_b64_tr_b16 a[58:59], v27 offset:51200
M a[24:27], v[180:183], a[204:207], a[24:27]
ds_read_b64_tr_b16 a[60:61], v27 offset:53248
ds_read_b64_tr_b16 a[62:63], v27 offset:55296
M a[28:31], v[188:191], a[204:207], a[28:31]
M a[28:31], v[184:187], a[200:203], a[28:31]
s_waitcnt vmcnt(16) lgkmcnt(0)
s_barrier
M a[0:3], a[32:35], a[224:227], a[0:3]
s_add_u32 m0, s42, 114688
s_nop 0
buffer_load_dwordx4 v6, s[48:51], s26 offen offset:0 lds
ds_read_b64_tr_b16 v[160:161], v28 offset:0
ds_read_b64_tr_b16 v[162:163], v28 offset:2048
M a[0:3], a[36:39], a[228:231], a[0:3]
buffer_load_dwordx4 v7, s[48:51], s26 offen offset:1024 lds
M a[4:7], a[44:47], a[228:231], a[4:7]
ds_read_b64_tr_b16 v[164:165], v28 offset:4096
ds_read_b64_tr_b16 v[166:167], v28 offset:6144
M a[4:7], a[40:43], a[224:227], a[4:7]
buffer_load_dwordx4 a[192:195], v1, s[44:47], s25 offen offset:0 sc1
M a[8:11], a[48:51], a[224:227], a[8:11]
ds_read_b64_tr_b16 v[168:169], v29 offset:0
ds_read_b64_tr_b16 v[170:171], v29 offset:2048
M a[8:11], a[52:55], a[228:231], a[8:11]
buffer_load_dwordx4 a[196:199], v1, s[44:47], s25 offen offset:1024 sc1
M a[12:15], a[60:63], a[228:231], a[12:15]
ds_read_b64_tr_b16 v[172:173], v29 offset:4096
ds_read_b64_tr_b16 v[174:175], v29 offset:6144
M a[12:15], a[56:59], a[224:227], a[12:15]
buffer_load_dwordx4 a[200:203], v1, s[44:47], s25 offen offset:2048 sc1
M a[16:19], a[32:35], a[232:235], a[16:19]
ds_read_b64_tr_b16 v[176:177], v30 offset:0
ds_read_b64_tr_b16 v[178:179], v30 offset:2048
M a[16:19], a[36:39], a[236:239], a[16:19]
buffer_load_dwordx4 a[204:207], v1, s[44:47], s25 offen offset:3072 sc1
M a[20:23], a[44:47], a[236:239], a[20:23]
ds_read_b64_tr_b16 v[180:181], v30 offset:4096
ds_read_b64_tr_b16 v[182:183], v30 offset:6144
M a[20:23], a[40:43], a[232:235], a[20:23]
s_add_u32 s25, s25, 16384
s_add_u32 s26, s26, 131072
M a[24:27], a[48:51], a[232:235], a[24:27]
ds_read_b64_tr_b16 v[184:185], v31 offset:0
ds_read_b64_tr_b16 v[186:187], v31 offset:2048
M a[24:27], a[52:55], a[236:239], a[24:27]
ds_read_b64_tr_b16 v[188:189], v31 offset:4096
ds_read_b64_tr_b16 v[190:191], v31 offset:6144
M a[28:31], a[60:63], a[236:239], a[28:31]
M a[28:31], a[56:59], a[232:235], a[28:31]
s_waitcnt vmcnt(12) lgkmcnt(0)
s_barrier
M a[0:3], v[160:163], a[96:99], a[0:3]
s_add_u32 m0, s42, 0
s_nop 0
buffer_load_dwordx4 v6, s[48:51], s26 offen offset:0 lds
ds_read_b64_tr_b16 a[32:33], v28 offset:16384
ds_read_b64_tr_b16 a[34:35], v28 offset:18432
M a[0:3], v[164:167], a[100:103], a[0:3]
buffer_load_dwordx4 v7, s[48:51], s26 offen offset:1024 lds
M a[4:7], v[172:175], a[100:103], a[4:7]
ds_read_b64_tr_b16 a[36:37], v28 offset:20480
ds_read_b64_tr_b16 a[38:39], v28 offset:22528
M a[4:7], v[168:171], a[96:99], a[4:7]
buffer_load_dwordx4 a[224:227], v1, s[44:47], s25 offen offset:0 sc1
M a[8:11], v[176:179], a[96:99], a[8:11]
ds_read_b64_tr_b16 a[40:41], v29 offset:16384
ds_read_b64_tr_b16 a[42:43], v29 offset:18432
M a[8:11], v[180:183], a[100:103], a[8:11]
buffer_load_dwordx4 a[228:231], v1, s[44:47], s25 offen offset:1024 sc1
M a[12:15], v[188:191], a[100:103], a[12:15]
ds_read_b64_tr_b16 a[44:45], v29 offset:20480
ds_read_b64_tr_b16 a[46:47], v29 offset:22528
M a[12:15], v[184:187], a[96:99], a[12:15]
buffer_load_dwordx4 a[232:235], v1, s[44:47], s25 offen offset:2048 sc1
M a[16:19], v[160:163], a[104:107], a[16:19]
ds_read_b64_tr_b16 a[48:49], v30 offset:16384
ds_read_b64_tr_b16 a[50:51], v30 offset:18432
M a[16:19], v[164:167], a[108:111], a[16:19]
buffer_load_dwordx4 a[236:239], v1, s[44:47], s25 offen offset:3072 sc1
M a[20:23], v[172:175], a[108:111], a[20:23]
ds_read_b64_tr_b16 a[52:53], v30 offset:20480
ds_read_b64_tr_b16 a[54:55], v30 offset:22528
M a[20:23], v[168:171], a[104:107], a[20:23]
s_add_u32 s25, s25, 16384
s_add_u32 s26, s26, 131072
M a[24:27], v[176:179], a[104:107], a[24:27]
ds_read_b64_tr_b16 a[56:57], v31 offset:16384
ds_read_b64_tr_b16 a[58:59], v31 offset:18432
M a[24:27], v[180:183], a[108:111], a[24:27]
ds_read_b64_tr_b16 a[60:61], v31 offset:20480
ds_read_b64_tr_b16 a[62:63], v31 offset:22528
M a[28:31], v[188:191], a[108:111], a[28:31]
M a[28:31], v[184:187], a[104:107], a[28:31]
s_waitcnt vmcnt(12) lgkmcnt(0)
s_barrier
M a[0:3], a[32:35], a[128:131], a[0:3]
ds_read_b64_tr_b16 v[160:161], v28 offset:32768
ds_read_b64_tr_b16 v[162:163], v28 offset:34816
M a[0:3], a[36:39], a[132:135], a[0:3]
ds_read_b64_tr_b16 v[164:165], v28 offset:36864
ds_read_b64_tr_b16 v[166:167], v28 offset:38912
M a[4:7], a[44:47], a[132:135], a[4:7]
M a[4:7], a[40:43], a[128:131], a[4:7]
ds_read_b64_tr_b16 v[168:169], v29 offset:32768
ds_read_b64_tr_b16 v[170:171], v29 offset:34816
M a[8:11], a[48:51], a[128:131], a[8:11]
M a[8:11], a[52:55], a[132:135], a[8:11]
ds_read_b64_tr_b16 v[172:173], v29 offset:36864
ds_read_b64_tr_b16 v[174:175], v29 offset:38912
M a[12:15], a[60:63], a[132:135], a[12:15]
M a[12:15], a[56:59], a[128:131], a[12:15]
ds_read_b64_tr_b16 v[176:177], v30 offset:32768
ds_read_b64_tr_b16 v[178:179], v30 offset:34816
M a[16:19], a[32:35], a[136:139], a[16:19]
ds_read_b64_tr_b16 v[180:181], v30 offset:36864
ds_read_b64_tr_b16 v[182:183], v30 offset:38912
M a[16:19], a[36:39], a[140:143], a[16:19]
M a[20:23], a[44:47], a[140:143], a[20:23]
ds_read_b64_tr_b16 v[184:185], v31 offset:32768
ds_read_b64_tr_b16 v[186:187], v31 offset:34816
M a[20:23], a[40:43], a[136:139], a[20:23]
M a[24:27], a[48:51], a[136:139], a[24:27]
ds_read_b64_tr_b16 v[188:189], v31 offset:36864
ds_read_b64_tr_b16 v[190:191], v31 offset:38912
M a[24:27], a[52:55], a[140:143], a[24:27]
M a[28:31], a[60:63], a[140:143], a[28:31]
M a[28:31], a[56:59], a[136:139], a[28:31]
s_waitcnt vmcnt(6) lgkmcnt(0)
s_barrier
M a[0:3], v[160:163], a[160:163], a[0:3]
buffer_load_dword v8, v11, s[52:55], s59 offen sc1
M a[0:3], v[164:167], a[164:167], a[0:3]
ds_read_b64_tr_b16 a[32:33], v28 offset:49152
ds_read_b64_tr_b16 a[34:35], v28 offset:51200
M a[4:7], v[172:175], a[164:167], a[4:7]
M a[4:7], v[168:171], a[160:163], a[4:7]
ds_read_b64_tr_b16 a[36:37], v28 offset:53248
ds_read_b64_tr_b16 a[38:39], v28 offset:55296
M a[8:11], v[176:179], a[160:163], a[8:11]
ds_read_b64_tr_b16 a[40:41], v29 offset:49152
ds_read_b64_tr_b16 a[42:43], v29 offset:51200
M a[8:11], v[180:183], a[164:167], a[8:11]
M a[12:15], v[188:191], a[164:167], a[12:15]
ds_read_b64_tr_b16 a[44:45], v29 offset:53248
ds_read_b64_tr_b16 a[46:47], v29 offset:55296
M a[12:15], v[184:187], a[160:163], a[12:15]
ds_read_b64_tr_b16 a[48:49], v30 offset:49152
ds_read_b64_tr_b16 a[50:51], v30 offset:51200
M a[16:19], v[160:163], a[168:171], a[16:19]
M a[16:19], v[164:167], a[172:175], a[16:19]
ds_read_b64_tr_b16 a[52:53], v30 offset:53248
ds_read_b64_tr_b16 a[54:55], v30 offset:55296
M a[20:23], v[172:175], a[172:175], a[20:23]
ds_read_b64_tr_b16 a[56:57], v31 offset:49152
ds_read_b64_tr_b16 a[58:59], v31 offset:51200
M a[20:23], v[168:171], a[168:171], a[20:23]
M a[24:27], v[176:179], a[168:171], a[24:27]
ds_read_b64_tr_b16 a[60:61], v31 offset:53248
ds_read_b64_tr_b16 a[62:63], v31 offset:55296
M a[24:27], v[180:183], a[172:175], a[24:27]
M a[28:31], v[188:191], a[172:175], a[28:31]
M a[28:31], v[184:187], a[168:171], a[28:31]
s_waitcnt vmcnt(1) lgkmcnt(0)
s_barrier
s_waitcnt vmcnt(0)
v_cmp_ne_u32 vcc, 1, v8
s_nop 0
s_cbranch_vccnz Lk3_spinfl
Lk3_gotfl:
M a[0:3], a[32:35], a[192:195], a[0:3]
s_xor_b32 s60, s56, 65536
s_add_u32 s60, s60, 4096
buffer_load_dwordx4 v[192:195], v1, s[52:55], s60 offen offset:0 sc1
ds_read_b64_tr_b16 v[160:161], v24 offset:0
ds_read_b64_tr_b16 v[162:163], v24 offset:2048
M a[0:3], a[36:39], a[196:199], a[0:3]
buffer_load_dwordx4 v[196:199], v1, s[52:55], s60 offen offset:1024 sc1
M a[4:7], a[44:47], a[196:199], a[4:7]
ds_read_b64_tr_b16 v[164:165], v24 offset:4096
ds_read_b64_tr_b16 v[166:167], v24 offset:6144
buffer_load_dwordx4 v[200:203], v1, s[52:55], s60 offen offset:2048 sc1
M a[4:7], a[40:43], a[192:195], a[4:7]
ds_read_b64_tr_b16 v[168:169], v25 offset:0
ds_read_b64_tr_b16 v[170:171], v25 offset:2048
M a[8:11], a[48:51], a[192:195], a[8:11]
buffer_load_dwordx4 v[204:207], v1, s[52:55], s60 offen offset:3072 sc1
ds_read_b64_tr_b16 v[172:173], v25 offset:4096
ds_read_b64_tr_b16 v[174:175], v25 offset:6144
M a[8:11], a[52:55], a[196:199], a[8:11]
s_xor_b32 s60, s56, 131072
s_add_u32 s60, s60, 8192
buffer_load_dwordx4 v[208:211], v1, s[52:55], s60 offen offset:0 sc1
M a[12:15], a[60:63], a[196:199], a[12:15]
ds_read_b64_tr_b16 v[176:177], v26 offset:0
ds_read_b64_tr_b16 v[178:179], v26 offset:2048
M a[12:15], a[56:59], a[192:195], a[12:15]
buffer_load_dwordx4 v[212:215], v1, s[52:55], s60 offen offset:1024 sc1
ds_read_b64_tr_b16 v[180:181], v26 offset:4096
ds_read_b64_tr_b16 v[182:183], v26 offset:6144
M a[16:19], a[32:35], a[200:203], a[16:19]
buffer_load_dwordx4 v[216:219], v1, s[52:55], s60 offen offset:2048 sc1
M a[16:19], a[36:39], a[204:207], a[16:19]
ds_read_b64_tr_b16 v[184:185], v27 offset:0
ds_read_b64_tr_b16 v[186:187], v27 offset:2048
buffer_load_dwordx4 v[220:223], v1, s[52:55], s60 offen offset:3072 sc1
M a[20:23], a[44:47], a[204:207], a[20:23]
ds_read_b64_tr_b16 v[188:189], v27 offset:4096
ds_read_b64_tr_b16 v[190:191], v27 offset:6144
M a[20:23], a[40:43], a[200:203], a[20:23]
s_xor_b32 s60, s56, 196608
s_add_u32 s60, s60, 12288
buffer_load_dwordx4 v[224:227], v1, s[52:55], s60 offen offset:0 sc1
buffer_load_dwordx4 v[228:231], v1, s[52:55], s60 offen offset:1024 sc1
M a[24:27], a[48:51], a[200:203], a[24:27]
buffer_load_dwordx4 v[232:235], v1, s[52:55], s60 offen offset:2048 sc1
M a[24:27], a[52:55], a[204:207], a[24:27]
buffer_load_dwordx4 v[236:239], v1, s[52:55], s60 offen offset:3072 sc1
M a[28:31], a[60:63], a[204:207], a[28:31]
M a[28:31], a[56:59], a[200:203], a[28:31]
s_waitcnt lgkmcnt(0)
M a[0:3], v[160:163], a[224:227], a[0:3]
M a[0:3], v[164:167], a[228:231], a[0:3]
M a[4:7], v[172:175], a[228:231], a[4:7]
M a[4:7], v[168:171], a[224:227], a[4:7]
M a[8:11], v[176:179], a[224:227], a[8:11]
M a[8:11], v[180:183], a[228:231], a[8:11]
M a[12:15], v[188:191], a[228:231], a[12:15]
M a[12:15], v[184:187], a[224:227], a[12:15]
M a[16:19], v[160:163], a[232:235], a[16:19]
M a[16:19], v[164:167], a[236:239], a[16:19]
M a[20:23], v[172:175], a[236:239], a[20:23]
M a[20:23], v[168:171], a[232:235], a[20:23]
M a[24:27], v[176:179], a[232:235], a[24:27]
M a[24:27], v[180:183], a[236:239], a[24:27]
M a[28:31], v[188:191], a[236:239], a[28:31]
M a[28:31], v[184:187], a[232:235], a[28:31]
v_bfe_u32 v8, v0, 4, 1
v_lshrrev_b32 v9, 5, v0
v_lshl_or_b32 v8, v8, 1, v9
v_and_b32 v9, 15, v0
v_lshlrev_b32 v9, 13, v9
v_lshl_add_u32 v8, v8, 4, v9
s_and_b32 s3, s101, 1
s_lshl_b32 s3, s3, 6
s_lshr_b32 s6, s101, 1
s_add_u32 s3, s3, s6
s_add_u32 s3, s3, s21
s_lshl_b32 s3, s3, 12
s_lshl_b32 s6, s22, 1
s_add_u32 s3, s3, s6
s_add_u32 s3, s3, 2048
v_accvgpr_read_b32 v20, a0
v_accvgpr_read_b32 v21, a1
v_accvgpr_read_b32 v22, a2
v_accvgpr_read_b32 v23, a3
v_accvgpr_read_b32 v24, a4
v_accvgpr_read_b32 v25, a5
v_accvgpr_read_b32 v26, a6
v_accvgpr_read_b32 v27, a7
v_cvt_pk_bf16_f32 v12, v20, v21
v_cvt_pk_bf16_f32 v13, v22, v23
v_cvt_pk_bf16_f32 v14, v24, v25
v_cvt_pk_bf16_f32 v15, v26, v27
s_nop 0
v_permlane16_swap_b32 v12, v14
v_permlane16_swap_b32 v13, v15
buffer_store_dwordx4 v[12:15], v8, s[16:19], s3 offen offset:0
v_accvgpr_read_b32 v20, a8
v_accvgpr_read_b32 v21, a9
v_accvgpr_read_b32 v22, a10
v_accvgpr_read_b32 v23, a11
v_accvgpr_read_b32 v24, a12
v_accvgpr_read_b32 v25, a13
v_accvgpr_read_b32 v26, a14
v_accvgpr_read_b32 v27, a15
v_cvt_pk_bf16_f32 v16, v20, v21
v_cvt_pk_bf16_f32 v17, v22, v23
v_cvt_pk_bf16_f32 v18, v24, v25
v_cvt_pk_bf16_f32 v19, v26, v27
s_nop 0
v_permlane16_swap_b32 v16, v18
v_permlane16_swap_b32 v17, v19
buffer_store_dwordx4 v[16:19], v8, s[16:19], s3 offen offset:64
s_add_u32 s3, s3, 131072
v_accvgpr_read_b32 v20, a16
v_accvgpr_read_b32 v21, a17
v_accvgpr_read_b32 v22, a18
v_accvgpr_read_b32 v23, a19
v_accvgpr_read_b32 v24, a20
v_accvgpr_read_b32 v25, a21
v_accvgpr_read_b32 v26, a22
v_accvgpr_read_b32 v27, a23
v_cvt_pk_bf16_f32 v12, v20, v21
v_cvt_pk_bf16_f32 v13, v22, v23
v_cvt_pk_bf16_f32 v14, v24, v25
v_cvt_pk_bf16_f32 v15, v26, v27
s_nop 0
v_permlane16_swap_b32 v12, v14
v_permlane16_swap_b32 v13, v15
buffer_store_dwordx4 v[12:15], v8, s[16:19], s3 offen offset:0
v_accvgpr_read_b32 v20, a24
v_accvgpr_read_b32 v21, a25
v_accvgpr_read_b32 v22, a26
v_accvgpr_read_b32 v23, a27
v_accvgpr_read_b32 v24, a28
v_accvgpr_read_b32 v25, a29
v_accvgpr_read_b32 v26, a30
v_accvgpr_read_b32 v27, a31
v_cvt_pk_bf16_f32 v16, v20, v21
v_cvt_pk_bf16_f32 v17, v22, v23
v_cvt_pk_bf16_f32 v18, v24, v25
v_cvt_pk_bf16_f32 v19, v26, v27
s_nop 0
v_permlane16_swap_b32 v16, v18
v_permlane16_swap_b32 v17, v19
buffer_store_dwordx4 v[16:19], v8, s[16:19], s3 offen offset:64
v_bfe_u32 v8, v0, 4, 1
v_lshrrev_b32 v9, 5, v0
v_lshl_or_b32 v8, v8, 1, v9
v_and_b32 v9, 15, v0
v_lshlrev_b32 v9, 12, v9
v_lshl_add_u32 v8, v8, 4, v9
s_lshl_b32 s3, s101, 6
s_add_u32 s3, s3, s29
s_lshl_b32 s3, s3, 12
s_lshl_b32 s6, s30, 1
s_add_u32 s3, s3, s6
s_mov_b32 s6, 0x00003f80
s_mov_b32 s7, 0x3f800000
s_waitcnt vmcnt(4)
v_dot2_f32_bf16 v32, v192, s6, v32
v_dot2_f32_bf16 v33, v192, s7, v33
v_dot2_f32_bf16 v34, v193, s6, v34
v_dot2_f32_bf16 v35, v193, s7, v35
v_dot2_f32_bf16 v36, v194, s6, v36
v_dot2_f32_bf16 v37, v194, s7, v37
v_dot2_f32_bf16 v38, v195, s6, v38
v_dot2_f32_bf16 v39, v195, s7, v39
v_dot2_f32_bf16 v32, v208, s6, v32
v_dot2_f32_bf16 v33, v208, s7, v33
v_dot2_f32_bf16 v34, v209, s6, v34
v_dot2_f32_bf16 v35, v209, s7, v35
v_dot2_f32_bf16 v36, v210, s6, v36
v_dot2_f32_bf16 v37, v210, s7, v37
v_dot2_f32_bf16 v38, v211, s6, v38
v_dot2_f32_bf16 v39, v211, s7, v39
v_dot2_f32_bf16 v32, v224, s6, v32
v_dot2_f32_bf16 v33, v224, s7, v33
v_dot2_f32_bf16 v34, v225, s6, v34
v_dot2_f32_bf16 v35, v225, s7, v35
v_dot2_f32_bf16 v36, v226, s6, v36
v_dot2_f32_bf16 v37, v226, s7, v37
v_dot2_f32_bf16 v38, v227, s6, v38
v_dot2_f32_bf16 v39, v227, s7, v39
v_cvt_pk_bf16_f32 v12, v32, v33
v_cvt_pk_bf16_f32 v13, v34, v35
v_cvt_pk_bf16_f32 v14, v36, v37
v_cvt_pk_bf16_f32 v15, v38, v39
s_nop 0
v_permlane16_swap_b32 v12, v14
v_permlane16_swap_b32 v13, v15
buffer_store_dwordx4 v[12:15], v8, s[16:19], s3 offen offset:0
s_add_u32 s3, s3, 65536
v_dot2_f32_bf16 v64, v196, s6, v64
v_dot2_f32_bf16 v65, v196, s7, v65
v_dot2_f32_bf16 v66, v197, s6, v66
v_dot2_f32_bf16 v67, v197, s7, v67
v_dot2_f32_bf16 v68, v198, s6, v68
v_dot2_f32_bf16 v69, v198, s7, v69
v_dot2_f32_bf16 v70, v199, s6, v70
v_dot2_f32_bf16 v71, v199, s7, v71
v_dot2_f32_bf16 v64, v212, s6, v64
v_dot2_f32_bf16 v65, v212, s7, v65
v_dot2_f32_bf16 v66, v213, s6, v66
v_dot2_f32_bf16 v67, v213, s7, v67
v_dot2_f32_bf16 v68, v214, s6, v68
v_dot2_f32_bf16 v69, v214, s7, v69
v_dot2_f32_bf16 v70, v215, s6, v70
v_dot2_f32_bf16 v71, v215, s7, v71
v_dot2_f32_bf16 v64, v228, s6, v64
v_dot2_f32_bf16 v65, v228, s7, v65
v_dot2_f32_bf16 v66, v229, s6, v66
v_dot2_f32_bf16 v67, v229, s7, v67
v_dot2_f32_bf16 v68, v230, s6, v68
v_dot2_f32_bf16 v69, v230, s7, v69
v_dot2_f32_bf16 v70, v231, s6, v70
v_dot2_f32_bf16 v71, v231, s7, v71
v_cvt_pk_bf16_f32 v16, v64, v65
v_cvt_pk_bf16_f32 v17, v66, v67
v_cvt_pk_bf16_f32 v18, v68, v69
v_cvt_pk_bf16_f32 v19, v70, v71
s_nop 0
v_permlane16_swap_b32 v16, v18
v_permlane16_swap_b32 v17, v19
buffer_store_dwordx4 v[16:19], v8, s[16:19], s3 offen offset:0
s_add_u32 s3, s3, 65536
v_dot2_f32_bf16 v96, v200, s6, v96
v_dot2_f32_bf16 v97, v200, s7, v97
v_dot2_f32_bf16 v98, v201, s6, v98
v_dot2_f32_bf16 v99, v201, s7, v99
v_dot2_f32_bf16 v100, v202, s6, v100
v_dot2_f32_bf16 v101, v202, s7, v101
v_dot2_f32_bf16 v102, v203, s6, v102
v_dot2_f32_bf16 v103, v203, s7, v103
v_dot2_f32_bf16 v96, v216, s6, v96
v_dot2_f32_bf16 v97, v216, s7, v97
v_dot2_f32_bf16 v98, v217, s6, v98
v_dot2_f32_bf16 v99, v217, s7, v99
v_dot2_f32_bf16 v100, v218, s6, v100
v_dot2_f32_bf16 v101, v218, s7, v101
v_dot2_f32_bf16 v102, v219, s6, v102
v_dot2_f32_bf16 v103, v219, s7, v103
v_dot2_f32_bf16 v96, v232, s6, v96
v_dot2_f32_bf16 v97, v232, s7, v97
v_dot2_f32_bf16 v98, v233, s6, v98
v_dot2_f32_bf16 v99, v233, s7, v99
v_dot2_f32_bf16 v100, v234, s6, v100
v_dot2_f32_bf16 v101, v234, s7, v101
v_dot2_f32_bf16 v102, v235, s6, v102
v_dot2_f32_bf16 v103, v235, s7, v103
v_cvt_pk_bf16_f32 v12, v96, v97
v_cvt_pk_bf16_f32 v13, v98, v99
v_cvt_pk_bf16_f32 v14, v100, v101
v_cvt_pk_bf16_f32 v15, v102, v103
s_nop 0
v_permlane16_swap_b32 v12, v14
v_permlane16_swap_b32 v13, v15
buffer_store_dwordx4 v[12:15], v8, s[16:19], s3 offen offset:0
s_add_u32 s3, s3, 65536
v_dot2_f32_bf16 v128, v204, s6, v128
v_dot2_f32_bf16 v129, v204, s7, v129
v_dot2_f32_bf16 v130, v205, s6, v130
v_dot2_f32_bf16 v131, v205, s7, v131
v_dot2_f32_bf16 v132, v206, s6, v132
v_dot2_f32_bf16 v133, v206, s7, v133
v_dot2_f32_bf16 v134, v207, s6, v134
v_dot2_f32_bf16 v135, v207, s7, v135
v_dot2_f32_bf16 v128, v220, s6, v128
v_dot2_f32_bf16 v129, v220, s7, v129
v_dot2_f32_bf16 v130, v221, s6, v130
v_dot2_f32_bf16 v131, v221, s7, v131
v_dot2_f32_bf16 v132, v222, s6, v132
v_dot2_f32_bf16 v133, v222, s7, v133
v_dot2_f32_bf16 v134, v223, s6, v134
v_dot2_f32_bf16 v135, v223, s7, v135
v_dot2_f32_bf16 v128, v236, s6, v128
v_dot2_f32_bf16 v129, v236, s7, v129
v_dot2_f32_bf16 v130, v237, s6, v130
v_dot2_f32_bf16 v131, v237, s7, v131
v_dot2_f32_bf16 v132, v238, s6, v132
v_dot2_f32_bf16 v133, v238, s7, v133
v_dot2_f32_bf16 v134, v239, s6, v134
v_dot2_f32_bf16 v135, v239, s7, v135
v_cvt_pk_bf16_f32 v16, v128, v129
v_cvt_pk_bf16_f32 v17, v130, v131
v_cvt_pk_bf16_f32 v18, v132, v133
v_cvt_pk_bf16_f32 v19, v134, v135
s_nop 0
v_permlane16_swap_b32 v16, v18
v_permlane16_swap_b32 v17, v19
buffer_store_dwordx4 v[16:19], v8, s[16:19], s3 offen offset:0
s_endpgm
Lk3_spinb0:
Lk3_spinb0_:
s_add_u32 s61, s61, 1
s_cmp_gt_u32 s61, 1048576
s_cbranch_scc1 Lk3_gotb0
s_sleep 2
buffer_load_dword v7, v15, s[52:55], s43 offen sc1
s_waitcnt vmcnt(0)
v_cmp_ne_u32 vcc, 1, v7
s_nop 0
s_cbranch_vccnz Lk3_spinb0_
s_branch Lk3_gotb0
Lk3_spinb1:
Lk3_spinb1_:
s_add_u32 s61, s61, 1
s_cmp_gt_u32 s61, 1048576
s_cbranch_scc1 Lk3_gotb1
s_sleep 2
buffer_load_dword v7, v15, s[52:55], s43 offen sc1
s_waitcnt vmcnt(0)
v_cmp_ne_u32 vcc, 1, v7
s_nop 0
s_cbranch_vccnz Lk3_spinb1_
s_branch Lk3_gotb1
Lk3_spinb2:
Lk3_spinb2_:
s_add_u32 s61, s61, 1
s_cmp_gt_u32 s61, 1048576
s_cbranch_scc1 Lk3_gotb2
s_sleep 2
buffer_load_dword v7, v15, s[52:55], s43 offen sc1
s_waitcnt vmcnt(0)
v_cmp_ne_u32 vcc, 1, v7
s_nop 0
s_cbranch_vccnz Lk3_spinb2_
s_branch Lk3_gotb2
Lk3_spinb3:
Lk3_spinb3_:
s_add_u32 s61, s61, 1
s_cmp_gt_u32 s61, 1048576
s_cbranch_scc1 Lk3_gotb3
s_sleep 2
buffer_load_dword v7, v15, s[52:55], s43 offen sc1
s_waitcnt vmcnt(0)
v_cmp_ne_u32 vcc, 1, v7
s_nop 0
s_cbranch_vccnz Lk3_spinb3_
s_branch Lk3_gotb3
Lk3_spinft:
s_add_u32 s61, s61, 1
s_cmp_gt_u32 s61, 1048576
s_cbranch_scc1 Lk3_gotft
s_sleep 2
buffer_load_dword v252, v255, s[52:55], s62 offen sc1
s_waitcnt vmcnt(0)
v_cmp_ne_u32 vcc, 1, v252
s_nop 0
s_cbranch_vccnz Lk3_spinft
s_branch Lk3_gotft
Lk3_spinfl:
s_add_u32 s61, s61, 1
s_cmp_gt_u32 s61, 1048576
s_cbranch_scc1 Lk3_gotfl
s_sleep 2
buffer_load_dword v8, v11, s[52:55], s59 offen sc1
s_waitcnt vmcnt(0)
v_cmp_ne_u32 vcc, 1, v8
s_nop 0
s_cbranch_vccnz Lk3_spinfl
s_branch Lk3_gotfl
Lc3:
.section .rodata,"a"
.p2align 6
.amdhsa_kernel concat_heads__compressed_kv_cla__sliding_local_dilated__prompt_kernel
  .amdhsa_next_free_vgpr 512
  .amdhsa_next_free_sgpr 102
  .amdhsa_accum_offset 256
  .amdhsa_group_segment_fixed_size 0
  .amdhsa_kernarg_size 96
  .amdhsa_user_sgpr_count 2
  .amdhsa_user_sgpr_kernarg_segment_ptr 1
  .amdhsa_system_sgpr_workgroup_id_x 1
.end_amdhsa_kernel
```

```asm
; @launch grid=(256,1,1) block=(256,1,1) lds=163840
.amdgcn_target "amdgcn-amd-amdhsa--gfx950"
.text
.macro M d, a, b, c
v_mfma_f32_16x16x32_bf16 \d, \a, \b, \c
.endm
.globl concat_heads__compressed_kv_cla__sliding_local_dilated__prompt_kernel
.p2align 8
.type concat_heads__compressed_kv_cla__sliding_local_dilated__prompt_kernel,@function
concat_heads__compressed_kv_cla__sliding_local_dilated__prompt_kernel:
s_cmp_lt_u32 s2, 256
s_cbranch_scc1 Lk1_go
s_endpgm
Lk1_go:
s_load_dwordx16 s[32:47], s[0:1], 0
s_load_dwordx2 s[48:49], s[0:1], 64
s_load_dwordx2 s[50:51], s[0:1], 88
s_load_dwordx2 s[90:91], s[0:1], 80
v_lshrrev_b32 v24, 6, v0
s_nop 0
v_readfirstlane_b32 s20, v24
v_and_b32 v0, 63, v0
v_lshlrev_b32 v1, 4, v0
s_mov_b32 s101, s20
s_lshr_b32 s21, s20, 1
s_and_b32 s22, s20, 1
s_lshl_b32 s29, s20, 12
s_and_b32 s3, s2, 1
s_lshl_b32 s3, s3, 2
s_bfe_u32 s6, s2, 0x20003
s_add_u32 s3, s3, s6
s_lshl_b32 s52, s3, 8
s_bfe_u32 s3, s2, 0x20001
s_lshl_b32 s3, s3, 2
s_bfe_u32 s7, s2, 0x20005
s_add_u32 s3, s3, s7
s_lshl_b32 s53, s3, 8
s_cmp_lt_u32 s2, 128
s_cselect_b32 s5, 11, 10
s_lshl_b32 s3, s21, 7
s_lshl_b32 s4, s22, 5
s_add_u32 s3, s3, s4
v_lshrrev_b32 v24, 3, v0
v_add_u32 v24, s3, v24
v_and_b32 v25, 7, v0
v_add_u32 v26, 0, v24
v_bfe_u32 v27, v26, 1, 3
v_xor_b32 v27, v27, v25
v_lshlrev_b32 v26, s5, v26
v_lshl_add_u32 v26, v27, 4, v26
v_subrev_u32 v2, 0, v26
v_add_u32 v26, 8, v24
v_bfe_u32 v27, v26, 1, 3
v_xor_b32 v27, v27, v25
v_lshlrev_b32 v26, s5, v26
v_lshl_add_u32 v26, v27, 4, v26
v_subrev_u32 v3, 1024, v26
v_add_u32 v26, 16, v24
v_bfe_u32 v27, v26, 1, 3
v_xor_b32 v27, v27, v25
v_lshlrev_b32 v26, s5, v26
v_lshl_add_u32 v26, v27, 4, v26
v_subrev_u32 v4, 2048, v26
v_add_u32 v26, 24, v24
v_bfe_u32 v27, v26, 1, 3
v_xor_b32 v27, v27, v25
v_lshlrev_b32 v26, s5, v26
v_lshl_add_u32 v26, v27, 4, v26
v_subrev_u32 v5, 3072, v26
s_lshl_b32 s3, s20, 3
v_lshrrev_b32 v24, 5, v0
v_add_u32 v24, s3, v24
v_and_b32 v25, 31, v0
v_add_u32 v26, 0, v24
v_and_b32 v27, 3, v26
v_lshlrev_b32 v27, 1, v27
v_and_or_b32 v27, v26, 8, v27
v_xor_b32 v27, v27, v25
v_lshlrev_b32 v26, 13, v26
v_lshl_add_u32 v26, v27, 4, v26
v_subrev_u32 v6, 0, v26
v_add_u32 v26, 2, v24
v_and_b32 v27, 3, v26
v_lshlrev_b32 v27, 1, v27
v_and_or_b32 v27, v26, 8, v27
v_xor_b32 v27, v27, v25
v_lshlrev_b32 v26, 13, v26
v_lshl_add_u32 v26, v27, 4, v26
v_subrev_u32 v7, 1024, v26
v_add_u32 v26, 4, v24
v_and_b32 v27, 3, v26
v_lshlrev_b32 v27, 1, v27
v_and_or_b32 v27, v26, 8, v27
v_xor_b32 v27, v27, v25
v_lshlrev_b32 v26, 13, v26
v_lshl_add_u32 v26, v27, 4, v26
v_subrev_u32 v8, 2048, v26
v_add_u32 v26, 6, v24
v_and_b32 v27, 3, v26
v_lshlrev_b32 v27, 1, v27
v_and_or_b32 v27, v26, 8, v27
v_xor_b32 v27, v27, v25
v_lshlrev_b32 v26, 13, v26
v_lshl_add_u32 v26, v27, 4, v26
v_subrev_u32 v9, 3072, v26
s_lshl_b32 s23, s52, s5
s_lshl_b32 s31, 64, s5
s_mov_b32 s26, s23
s_lshl_b32 s24, s53, 1
s_mov_b32 s28, s24
s_lshl_b32 s3, 1, s5
s_add_u32 s25, s23, s3
s_lshl_b32 s3, s3, 12
s_add_u32 s27, s24, s3
s_bfe_u32 s3, s2, 0x20001
s_and_b32 s4, s2, 1
s_lshl_b32 s4, s4, 1
s_add_u32 s3, s3, s4
s_and_b32 s3, s3, 3
s_sub_u32 s4, s5, 2
s_lshl_b32 s3, s3, s4
s_add_u32 s23, s23, s3
s_lshl_b32 s3, s3, 12
s_add_u32 s24, s24, s3
s_mov_b32 s95, s6
s_cmp_lt_u32 s2, 128
s_cselect_b32 s6, -1, 8
s_waitcnt lgkmcnt(0)
s_cmp_lt_u32 s2, 128
s_cselect_b64 s[8:9], s[32:33], s[34:35]
s_mov_b32 s10, 2097152
s_cselect_b32 s10, 4194304, s10
s_mov_b32 s11, 0x00020000
s_cselect_b64 s[12:13], s[36:37], s[38:39]
s_mov_b32 s14, 4194304
s_cselect_b32 s14, 8388608, s14
s_mov_b32 s15, 0x00020000
s_mov_b64 s[64:65], s[40:41]
s_add_u32 m0, s29, 65536
s_nop 0
buffer_load_dwordx4 v6, s[12:15], s24 offen offset:0 lds
buffer_load_dwordx4 v7, s[12:15], s24 offen offset:1024 lds
buffer_load_dwordx4 v8, s[12:15], s24 offen offset:2048 lds
buffer_load_dwordx4 v9, s[12:15], s24 offen offset:3072 lds
s_add_u32 s24, s24, 262144
s_add_u32 m0, s29, 0
s_nop 0
buffer_load_dwordx4 v2, s[8:11], s23 offen offset:0 lds
buffer_load_dwordx4 v3, s[8:11], s23 offen offset:1024 lds
buffer_load_dwordx4 v4, s[8:11], s23 offen offset:2048 lds
buffer_load_dwordx4 v5, s[8:11], s23 offen offset:3072 lds
s_add_u32 m0, s29, 81920
s_nop 0
buffer_load_dwordx4 v6, s[12:15], s24 offen offset:0 lds
buffer_load_dwordx4 v7, s[12:15], s24 offen offset:1024 lds
buffer_load_dwordx4 v8, s[12:15], s24 offen offset:2048 lds
buffer_load_dwordx4 v9, s[12:15], s24 offen offset:3072 lds
s_add_u32 s24, s24, 262144
s_cmp_eq_u32 s24, s27
s_cselect_b32 s24, s28, s24
s_sub_u32 s6, s6, 1
s_cmp_eq_u32 s6, 0
s_cselect_b64 s[12:13], s[64:65], s[12:13]
s_add_u32 s16, s50, 117440512
s_addc_u32 s17, s51, 0
s_mov_b32 s18, 16384
s_mov_b32 s19, 0x00020000
v_mov_b32 v24, 0
v_mov_b32 v25, 0
v_mov_b32 v26, 0
v_mov_b32 v27, 0
s_lshl_b32 s3, s2, 4
buffer_store_dwordx4 v[24:27], v24, s[16:19], s3 offen sc1
s_and_b32 s3, s2, 7
s_lshr_b32 s4, s2, 6
s_lshl_b32 s4, s4, 3
s_add_u32 s3, s3, s4
s_lshl_b32 s3, s3, 4
s_add_u32 s3, s3, 4096
s_bfe_u32 s4, s2, 0x30003
s_lshl_b32 s4, s4, 9
s_add_u32 s92, s3, s4
s_sub_u32 s4, 7680, s4
s_add_u32 s93, s3, s4
buffer_store_dwordx4 v[24:27], v24, s[16:19], s92 offen sc1
buffer_store_dwordx4 v[24:27], v24, s[16:19], s93 offen sc1
s_and_b32 s3, s2, 1
s_lshl_b32 s3, s3, 3
s_bfe_u32 s4, s2, 0x30003
s_add_u32 s92, s3, s4
s_bfe_u32 s3, s2, 0x20001
s_lshl_b32 s3, s3, 2
s_lshr_b32 s4, s2, 6
s_xor_b32 s4, s4, 2
s_add_u32 s93, s3, s4
s_lshl_b32 s92, s92, 8
s_lshl_b32 s93, s93, 4
s_add_u32 s92, s92, s93
s_add_u32 s92, s92, 12288
buffer_store_dwordx4 v[24:27], v24, s[16:19], s92 offen sc1
v_lshlrev_b32 v20, 7, v0
s_lshl_b32 s54, s2, 13
s_mov_b64 s[60:61], s[40:41]
s_mov_b32 s62, 0
s_cmp_eq_u32 s20, 1
s_cselect_b64 s[60:61], s[46:47], s[60:61]
s_cselect_b32 s62, 6291456, s62
s_cmp_eq_u32 s20, 2
s_cselect_b64 s[60:61], s[44:45], s[60:61]
s_cselect_b32 s62, 4194304, s62
s_cmp_eq_u32 s20, 3
s_cselect_b32 s62, 0, s62
s_mov_b32 s63, 0x00020000
s_mov_b32 s3, 0
s_cmp_eq_u32 s20, 1
s_cselect_b32 s3, 6291456, s3
s_cmp_eq_u32 s20, 2
s_cselect_b32 s3, 6291456, s3
s_sub_u32 s54, s54, s3
Lc0:
s_add_u32 m0, s29, 98304
s_nop 0
buffer_load_dwordx4 v6, s[12:15], s24 offen offset:0 lds
buffer_load_dwordx4 v7, s[12:15], s24 offen offset:1024 lds
buffer_load_dwordx4 v8, s[12:15], s24 offen offset:2048 lds
buffer_load_dwordx4 v9, s[12:15], s24 offen offset:3072 lds
s_add_u32 s24, s24, 262144
s_lshl_b32 s4, s21, 13
v_and_b32 v24, 15, v0
v_lshlrev_b32 v24, 7, v24
v_add_u32 v24, s4, v24
v_bfe_u32 v25, v0, 1, 3
v_lshrrev_b32 v26, 4, v0
v_xor_b32 v25, v25, v26
v_lshl_add_u32 v10, v25, 4, v24
v_xor_b32 v11, 64, v10
v_bfe_u32 v24, v0, 2, 2
v_lshl_add_u32 v29, v26, 3, v24
v_lshlrev_b32 v25, 9, v29
v_and_b32 v27, 1, v0
v_lshl_add_u32 v25, v27, 3, v25
v_add_u32 v25, 65536, v25
v_lshlrev_b32 v24, 1, v24
v_and_or_b32 v24, v29, 8, v24
v_bfe_u32 v26, v0, 1, 1
s_lshl_b32 s4, s22, 4
s_add_u32 s3, s4, 0
v_add_u32 v27, s3, v26
v_xor_b32 v27, v27, v24
v_lshl_add_u32 v12, v27, 4, v25
s_add_u32 s3, s4, 2
v_add_u32 v27, s3, v26
v_xor_b32 v27, v27, v24
v_lshl_add_u32 v13, v27, 4, v25
s_add_u32 s3, s4, 4
v_add_u32 v27, s3, v26
v_xor_b32 v27, v27, v24
v_lshl_add_u32 v14, v27, 4, v25
s_add_u32 s3, s4, 6
v_add_u32 v27, s3, v26
v_xor_b32 v27, v27, v24
v_lshl_add_u32 v15, v27, 4, v25
s_add_u32 s3, s4, 8
v_add_u32 v27, s3, v26
v_xor_b32 v27, v27, v24
v_lshl_add_u32 v16, v27, 4, v25
s_add_u32 s3, s4, 10
v_add_u32 v27, s3, v26
v_xor_b32 v27, v27, v24
v_lshl_add_u32 v17, v27, 4, v25
s_add_u32 s3, s4, 12
v_add_u32 v27, s3, v26
v_xor_b32 v27, v27, v24
v_lshl_add_u32 v18, v27, 4, v25
s_add_u32 s3, s4, 14
v_add_u32 v27, s3, v26
v_xor_b32 v27, v27, v24
v_lshl_add_u32 v19, v27, 4, v25
s_waitcnt vmcnt(8)
s_barrier
ds_read_b64_tr_b16 a[32:33], v12 offset:0
ds_read_b64_tr_b16 a[34:35], v12 offset:2048
ds_read_b64_tr_b16 a[40:41], v13 offset:0
ds_read_b64_tr_b16 a[42:43], v13 offset:2048
ds_read_b64_tr_b16 a[48:49], v14 offset:0
ds_read_b64_tr_b16 a[50:51], v14 offset:2048
ds_read_b64_tr_b16 a[56:57], v15 offset:0
ds_read_b64_tr_b16 a[58:59], v15 offset:2048
ds_read_b64_tr_b16 a[64:65], v16 offset:0
ds_read_b64_tr_b16 a[66:67], v16 offset:2048
ds_read_b64_tr_b16 a[72:73], v17 offset:0
ds_read_b64_tr_b16 a[74:75], v17 offset:2048
ds_read_b64_tr_b16 a[80:81], v18 offset:0
ds_read_b64_tr_b16 a[82:83], v18 offset:2048
ds_read_b64_tr_b16 a[88:89], v19 offset:0
ds_read_b64_tr_b16 a[90:91], v19 offset:2048
ds_read_b64_tr_b16 a[36:37], v12 offset:16384
ds_read_b64_tr_b16 a[38:39], v12 offset:18432
ds_read_b64_tr_b16 a[44:45], v13 offset:16384
ds_read_b64_tr_b16 a[46:47], v13 offset:18432
ds_read_b64_tr_b16 a[52:53], v14 offset:16384
ds_read_b64_tr_b16 a[54:55], v14 offset:18432
ds_read_b64_tr_b16 a[60:61], v15 offset:16384
ds_read_b64_tr_b16 a[62:63], v15 offset:18432
ds_read_b64_tr_b16 a[68:69], v16 offset:16384
ds_read_b64_tr_b16 a[70:71], v16 offset:18432
ds_read_b64_tr_b16 a[76:77], v17 offset:16384
ds_read_b64_tr_b16 a[78:79], v17 offset:18432
ds_read_b64_tr_b16 a[84:85], v18 offset:16384
ds_read_b64_tr_b16 a[86:87], v18 offset:18432
ds_read_b64_tr_b16 a[92:93], v19 offset:16384
ds_read_b64_tr_b16 a[94:95], v19 offset:18432
ds_read_b128 a[160:163], v10 offset:0
ds_read_b128 a[164:167], v11 offset:0
ds_read_b128 a[168:171], v10 offset:2048
ds_read_b128 a[172:175], v11 offset:2048
s_add_u32 m0, s29, 16384
s_add_u32 s3, s23, s31
s_nop 0
buffer_load_dwordx4 v2, s[8:11], s3 offen offset:0 lds
buffer_load_dwordx4 v3, s[8:11], s3 offen offset:1024 lds
buffer_load_dwordx4 v4, s[8:11], s3 offen offset:2048 lds
buffer_load_dwordx4 v5, s[8:11], s3 offen offset:3072 lds
s_add_u32 s23, s23, 128
s_cmp_eq_u32 s23, s25
s_cselect_b32 s23, s26, s23
s_add_u32 m0, s29, 114688
s_nop 0
buffer_load_dwordx4 v6, s[12:15], s24 offen offset:0 lds
buffer_load_dwordx4 v7, s[12:15], s24 offen offset:1024 lds
buffer_load_dwordx4 v8, s[12:15], s24 offen offset:2048 lds
buffer_load_dwordx4 v9, s[12:15], s24 offen offset:3072 lds
s_add_u32 s24, s24, 262144
s_cmp_eq_u32 s24, s27
s_cselect_b32 s24, s28, s24
s_sub_u32 s6, s6, 1
s_cmp_eq_u32 s6, 0
s_cselect_b64 s[12:13], s[64:65], s[12:13]
s_waitcnt vmcnt(8) lgkmcnt(0)
s_barrier
s_getpc_b64 s[92:93]
Lpc_1:
s_add_u32 s92, s92, Lc1-Lpc_1
s_addc_u32 s93, s93, 0
s_lshr_b32 s94, s2, 3
s_mul_i32 s94, s94, ((Lc3-Lc1)/32+127)&~127
v_lshlrev_b32 v24, 7, v0
v_add_u32 v24, s94, v24
v_min_u32 v24, Lc3-Lc1-4, v24
global_load_dword v21, v24, s[92:93]
Lc1:
s_cmp_lt_u32 s2, 128
s_cbranch_scc0 Lk1_kv
M v[32:35], a[32:35], a[160:163], 0
s_add_u32 m0, s29, 32768
s_nop 0
buffer_load_dwordx4 v2, s[8:11], s23 offen offset:0 lds
M v[32:35], a[36:39], a[164:167], v[32:35]
ds_read_b128 a[176:179], v10 offset:4096
ds_read_b128 a[180:183], v11 offset:4096
M v[36:39], a[44:47], a[164:167], 0
M v[36:39], a[40:43], a[160:163], v[36:39]
ds_read_b64_tr_b16 a[96:97], v12 offset:32768
ds_read_b64_tr_b16 a[98:99], v12 offset:34816
M v[40:43], a[48:51], a[160:163], 0
M v[40:43], a[52:55], a[164:167], v[40:43]
buffer_load_dwordx4 v3, s[8:11], s23 offen offset:1024 lds
M v[44:47], a[60:63], a[164:167], 0
M v[44:47], a[56:59], a[160:163], v[44:47]
ds_read_b64_tr_b16 a[104:105], v13 offset:32768
ds_read_b64_tr_b16 a[106:107], v13 offset:34816
M v[48:51], a[64:67], a[160:163], 0
M v[48:51], a[68:71], a[164:167], v[48:51]
buffer_load_dwordx4 v4, s[8:11], s23 offen offset:2048 lds
M v[52:55], a[76:79], a[164:167], 0
M v[52:55], a[72:75], a[160:163], v[52:55]
ds_read_b64_tr_b16 a[112:113], v14 offset:32768
ds_read_b64_tr_b16 a[114:115], v14 offset:34816
M v[56:59], a[80:83], a[160:163], 0
M v[56:59], a[84:87], a[164:167], v[56:59]
buffer_load_dwordx4 v5, s[8:11], s23 offen offset:3072 lds
M v[60:63], a[92:95], a[164:167], 0
M v[60:63], a[88:91], a[160:163], v[60:63]
ds_read_b64_tr_b16 a[120:121], v15 offset:32768
ds_read_b64_tr_b16 a[122:123], v15 offset:34816
M v[64:67], a[32:35], a[168:171], 0
M v[64:67], a[36:39], a[172:175], v[64:67]
ds_read_b128 a[184:187], v10 offset:6144
ds_read_b128 a[188:191], v11 offset:6144
M v[68:71], a[44:47], a[172:175], 0
s_add_u32 m0, s29, 65536
s_nop 0
buffer_load_dwordx4 v6, s[12:15], s24 offen offset:0 lds
M v[68:71], a[40:43], a[168:171], v[68:71]
ds_read_b64_tr_b16 a[128:129], v16 offset:32768
ds_read_b64_tr_b16 a[130:131], v16 offset:34816
M v[72:75], a[48:51], a[168:171], 0
M v[72:75], a[52:55], a[172:175], v[72:75]
M v[76:79], a[60:63], a[172:175], 0
buffer_load_dwordx4 v7, s[12:15], s24 offen offset:1024 lds
M v[76:79], a[56:59], a[168:171], v[76:79]
ds_read_b64_tr_b16 a[136:137], v17 offset:32768
ds_read_b64_tr_b16 a[138:139], v17 offset:34816
M v[80:83], a[64:67], a[168:171], 0
M v[80:83], a[68:71], a[172:175], v[80:83]
M v[84:87], a[76:79], a[172:175], 0
buffer_load_dwordx4 v8, s[12:15], s24 offen offset:2048 lds
M v[84:87], a[72:75], a[168:171], v[84:87]
ds_read_b64_tr_b16 a[144:145], v18 offset:32768
ds_read_b64_tr_b16 a[146:147], v18 offset:34816
M v[88:91], a[80:83], a[168:171], 0
M v[88:91], a[84:87], a[172:175], v[88:91]
M v[92:95], a[92:95], a[172:175], 0
buffer_load_dwordx4 v9, s[12:15], s24 offen offset:3072 lds
M v[92:95], a[88:91], a[168:171], v[92:95]
s_waitcnt lgkmcnt(15)
ds_read_b64_tr_b16 a[152:153], v19 offset:32768
ds_read_b64_tr_b16 a[154:155], v19 offset:34816
M v[96:99], a[32:35], a[176:179], 0
M v[96:99], a[36:39], a[180:183], v[96:99]
M v[100:103], a[44:47], a[180:183], 0
s_add_u32 s24, s24, 262144
M v[100:103], a[40:43], a[176:179], v[100:103]
M v[104:107], a[48:51], a[176:179], 0
M v[104:107], a[52:55], a[180:183], v[104:107]
M v[108:111], a[60:63], a[180:183], 0
M v[108:111], a[56:59], a[176:179], v[108:111]
s_waitcnt vmcnt(9) lgkmcnt(0)
s_barrier
ds_read_b128 a[160:163], v10 offset:16384
ds_read_b128 a[164:167], v11 offset:16384
M v[112:115], a[64:67], a[176:179], 0
s_add_u32 m0, s29, 49152
s_add_u32 s3, s23, s31
buffer_load_dwordx4 v2, s[8:11], s3 offen offset:0 lds
M v[112:115], a[68:71], a[180:183], v[112:115]
M v[116:119], a[76:79], a[180:183], 0
M v[116:119], a[72:75], a[176:179], v[116:119]
ds_read_b64_tr_b16 a[100:101], v12 offset:49152
ds_read_b64_tr_b16 a[102:103], v12 offset:51200
M v[120:123], a[80:83], a[176:179], 0
M v[120:123], a[84:87], a[180:183], v[120:123]
buffer_load_dwordx4 v3, s[8:11], s3 offen offset:1024 lds
M v[124:127], a[92:95], a[180:183], 0
M v[124:127], a[88:91], a[176:179], v[124:127]
M v[128:131], a[32:35], a[184:187], 0
M v[128:131], a[36:39], a[188:191], v[128:131]
ds_read_b128 a[168:171], v10 offset:18432
ds_read_b128 a[172:175], v11 offset:18432
ds_read_b64_tr_b16 a[108:109], v13 offset:49152
ds_read_b64_tr_b16 a[110:111], v13 offset:51200
M v[132:135], a[44:47], a[188:191], 0
M v[132:135], a[40:43], a[184:187], v[132:135]
buffer_load_dwordx4 v4, s[8:11], s3 offen offset:2048 lds
M v[136:139], a[48:51], a[184:187], 0
M v[136:139], a[52:55], a[188:191], v[136:139]
M v[140:143], a[60:63], a[188:191], 0
M v[140:143], a[56:59], a[184:187], v[140:143]
ds_read_b64_tr_b16 a[116:117], v14 offset:49152
ds_read_b64_tr_b16 a[118:119], v14 offset:51200
M v[144:147], a[64:67], a[184:187], 0
M v[144:147], a[68:71], a[188:191], v[144:147]
buffer_load_dwordx4 v5, s[8:11], s3 offen offset:3072 lds
M v[148:151], a[76:79], a[188:191], 0
M v[148:151], a[72:75], a[184:187], v[148:151]
M v[152:155], a[80:83], a[184:187], 0
M v[152:155], a[84:87], a[188:191], v[152:155]
ds_read_b64_tr_b16 a[124:125], v15 offset:49152
ds_read_b64_tr_b16 a[126:127], v15 offset:51200
M v[156:159], a[92:95], a[188:191], 0
s_add_u32 s23, s23, 128
s_cmp_eq_u32 s23, s25
s_cselect_b32 s23, s26, s23
M v[156:159], a[88:91], a[184:187], v[156:159]
s_waitcnt lgkmcnt(10)
M v[160:163], a[32:35], a[160:163], 0
M v[160:163], a[36:39], a[164:167], v[160:163]
ds_read_b128 a[176:179], v10 offset:20480
ds_read_b128 a[180:183], v11 offset:20480
M v[164:167], a[44:47], a[164:167], 0
M v[164:167], a[40:43], a[160:163], v[164:167]
ds_read_b64_tr_b16 a[132:133], v16 offset:49152
ds_read_b64_tr_b16 a[134:135], v16 offset:51200
M v[168:171], a[48:51], a[160:163], 0
M v[168:171], a[52:55], a[164:167], v[168:171]
s_add_u32 m0, s29, 81920
s_nop 0
buffer_load_dwordx4 v6, s[12:15], s24 offen offset:0 lds
M v[172:175], a[60:63], a[164:167], 0
M v[172:175], a[56:59], a[160:163], v[172:175]
M v[176:179], a[64:67], a[160:163], 0
M v[176:179], a[68:71], a[164:167], v[176:179]
ds_read_b64_tr_b16 a[140:141], v17 offset:49152
ds_read_b64_tr_b16 a[142:143], v17 offset:51200
M v[180:183], a[76:79], a[164:167], 0
M v[180:183], a[72:75], a[160:163], v[180:183]
buffer_load_dwordx4 v7, s[12:15], s24 offen offset:1024 lds
M v[184:187], a[80:83], a[160:163], 0
M v[184:187], a[84:87], a[164:167], v[184:187]
M v[188:191], a[92:95], a[164:167], 0
M v[188:191], a[88:91], a[160:163], v[188:191]
s_waitcnt lgkmcnt(12)
ds_read_b64_tr_b16 a[148:149], v18 offset:49152
ds_read_b64_tr_b16 a[150:151], v18 offset:51200
M v[192:195], a[32:35], a[168:171], 0
buffer_load_dwordx4 v8, s[12:15], s24 offen offset:2048 lds
M v[192:195], a[36:39], a[172:175], v[192:195]
ds_read_b128 a[184:187], v10 offset:22528
ds_read_b128 a[188:191], v11 offset:22528
M v[196:199], a[44:47], a[172:175], 0
M v[196:199], a[40:43], a[168:171], v[196:199]
M v[200:203], a[48:51], a[168:171], 0
M v[200:203], a[52:55], a[172:175], v[200:203]
ds_read_b64_tr_b16 a[156:157], v19 offset:49152
ds_read_b64_tr_b16 a[158:159], v19 offset:51200
M v[204:207], a[60:63], a[172:175], 0
buffer_load_dwordx4 v9, s[12:15], s24 offen offset:3072 lds
M v[204:207], a[56:59], a[168:171], v[204:207]
M v[208:211], a[64:67], a[168:171], 0
M v[208:211], a[68:71], a[172:175], v[208:211]
M v[212:215], a[76:79], a[172:175], 0
M v[212:215], a[72:75], a[168:171], v[212:215]
s_add_u32 s24, s24, 262144
s_cmp_eq_u32 s24, s27
s_cselect_b32 s24, s28, s24
s_sub_u32 s6, s6, 1
s_cmp_eq_u32 s6, 0
s_cselect_b64 s[12:13], s[64:65], s[12:13]
M v[216:219], a[80:83], a[168:171], 0
M v[216:219], a[84:87], a[172:175], v[216:219]
M v[220:223], a[92:95], a[172:175], 0
M v[220:223], a[88:91], a[168:171], v[220:223]
s_waitcnt lgkmcnt(10)
M v[224:227], a[32:35], a[176:179], 0
buffer_load_dword v21, v20, s[60:63], s54 offen
s_add_u32 s54, s54, 1048576
M v[224:227], a[36:39], a[180:183], v[224:227]
M v[228:231], a[44:47], a[180:183], 0
M v[228:231], a[40:43], a[176:179], v[228:231]
M v[232:235], a[48:51], a[176:179], 0
M v[232:235], a[52:55], a[180:183], v[232:235]
M v[236:239], a[60:63], a[180:183], 0
M v[236:239], a[56:59], a[176:179], v[236:239]
s_waitcnt vmcnt(9) lgkmcnt(0)
s_barrier
ds_read_b128 a[160:163], v10 offset:32768
ds_read_b128 a[164:167], v11 offset:32768
M v[240:243], a[64:67], a[176:179], 0
s_add_u32 m0, s29, 0
s_nop 0
buffer_load_dwordx4 v2, s[8:11], s23 offen offset:0 lds
M v[240:243], a[68:71], a[180:183], v[240:243]
M v[244:247], a[76:79], a[180:183], 0
M v[244:247], a[72:75], a[176:179], v[244:247]
M v[248:251], a[80:83], a[176:179], 0
M v[248:251], a[84:87], a[180:183], v[248:251]
buffer_load_dwordx4 v3, s[8:11], s23 offen offset:1024 lds
M v[252:255], a[92:95], a[180:183], 0
M v[252:255], a[88:91], a[176:179], v[252:255]
M a[0:3], a[32:35], a[184:187], 0
M a[0:3], a[36:39], a[188:191], a[0:3]
ds_read_b128 a[168:171], v10 offset:34816
ds_read_b128 a[172:175], v11 offset:34816
M a[4:7], a[44:47], a[188:191], 0
M a[4:7], a[40:43], a[184:187], a[4:7]
M a[8:11], a[48:51], a[184:187], 0
buffer_load_dwordx4 v4, s[8:11], s23 offen offset:2048 lds
M a[8:11], a[52:55], a[188:191], a[8:11]
M a[12:15], a[60:63], a[188:191], 0
M a[12:15], a[56:59], a[184:187], a[12:15]
M a[16:19], a[64:67], a[184:187], 0
M a[16:19], a[68:71], a[188:191], a[16:19]
buffer_load_dwordx4 v5, s[8:11], s23 offen offset:3072 lds
M a[20:23], a[76:79], a[188:191], 0
M a[20:23], a[72:75], a[184:187], a[20:23]
M a[24:27], a[80:83], a[184:187], 0
M a[24:27], a[84:87], a[188:191], a[24:27]
M a[28:31], a[92:95], a[188:191], 0
M a[28:31], a[88:91], a[184:187], a[28:31]
s_waitcnt lgkmcnt(2)
M v[32:35], a[96:99], a[160:163], v[32:35]
s_add_u32 m0, s29, 98304
s_nop 0
buffer_load_dwordx4 v6, s[12:15], s24 offen offset:0 lds
M v[32:35], a[100:103], a[164:167], v[32:35]
ds_read_b128 a[176:179], v10 offset:36864
ds_read_b128 a[180:183], v11 offset:36864
M v[36:39], a[108:111], a[164:167], v[36:39]
M v[36:39], a[104:107], a[160:163], v[36:39]
ds_read_b64_tr_b16 a[32:33], v12 offset:0
ds_read_b64_tr_b16 a[34:35], v12 offset:2048
M v[40:43], a[112:115], a[160:163], v[40:43]
M v[40:43], a[116:119], a[164:167], v[40:43]
M v[44:47], a[124:127], a[164:167], v[44:47]
M v[44:47], a[120:123], a[160:163], v[44:47]
ds_read_b64_tr_b16 a[40:41], v13 offset:0
ds_read_b64_tr_b16 a[42:43], v13 offset:2048
M v[48:51], a[128:131], a[160:163], v[48:51]
buffer_load_dwordx4 v7, s[12:15], s24 offen offset:1024 lds
M v[48:51], a[132:135], a[164:167], v[48:51]
M v[52:55], a[140:143], a[164:167], v[52:55]
M v[52:55], a[136:139], a[160:163], v[52:55]
ds_read_b64_tr_b16 a[48:49], v14 offset:0
ds_read_b64_tr_b16 a[50:51], v14 offset:2048
M v[56:59], a[144:147], a[160:163], v[56:59]
M v[56:59], a[148:151], a[164:167], v[56:59]
M v[60:63], a[156:159], a[164:167], v[60:63]
buffer_load_dwordx4 v8, s[12:15], s24 offen offset:2048 lds
M v[60:63], a[152:155], a[160:163], v[60:63]
s_waitcnt lgkmcnt(8)
ds_read_b64_tr_b16 a[56:57], v15 offset:0
ds_read_b64_tr_b16 a[58:59], v15 offset:2048
M v[64:67], a[96:99], a[168:171], v[64:67]
M v[64:67], a[100:103], a[172:175], v[64:67]
ds_read_b128 a[184:187], v10 offset:38912
ds_read_b128 a[188:191], v11 offset:38912
M v[68:71], a[108:111], a[172:175], v[68:71]
M v[68:71], a[104:107], a[168:171], v[68:71]
ds_read_b64_tr_b16 a[64:65], v16 offset:0
ds_read_b64_tr_b16 a[66:67], v16 offset:2048
M v[72:75], a[112:115], a[168:171], v[72:75]
M v[72:75], a[116:119], a[172:175], v[72:75]
M v[76:79], a[124:127], a[172:175], v[76:79]
M v[76:79], a[120:123], a[168:171], v[76:79]
ds_read_b64_tr_b16 a[72:73], v17 offset:0
ds_read_b64_tr_b16 a[74:75], v17 offset:2048
M v[80:83], a[128:131], a[168:171], v[80:83]
buffer_load_dwordx4 v9, s[12:15], s24 offen offset:3072 lds
M v[80:83], a[132:135], a[172:175], v[80:83]
M v[84:87], a[140:143], a[172:175], v[84:87]
M v[84:87], a[136:139], a[168:171], v[84:87]
ds_read_b64_tr_b16 a[80:81], v18 offset:0
ds_read_b64_tr_b16 a[82:83], v18 offset:2048
M v[88:91], a[144:147], a[168:171], v[88:91]
M v[88:91], a[148:151], a[172:175], v[88:91]
M v[92:95], a[156:159], a[172:175], v[92:95]
s_add_u32 s24, s24, 262144
M v[92:95], a[152:155], a[168:171], v[92:95]
s_waitcnt lgkmcnt(15)
ds_read_b64_tr_b16 a[88:89], v19 offset:0
ds_read_b64_tr_b16 a[90:91], v19 offset:2048
M v[96:99], a[96:99], a[176:179], v[96:99]
M v[96:99], a[100:103], a[180:183], v[96:99]
M v[100:103], a[108:111], a[180:183], v[100:103]
M v[100:103], a[104:107], a[176:179], v[100:103]
M v[104:107], a[112:115], a[176:179], v[104:107]
M v[104:107], a[116:119], a[180:183], v[104:107]
M v[108:111], a[124:127], a[180:183], v[108:111]
M v[108:111], a[120:123], a[176:179], v[108:111]
s_waitcnt vmcnt(9) lgkmcnt(0)
s_barrier
ds_read_b128 a[160:163], v10 offset:49152
ds_read_b128 a[164:167], v11 offset:49152
M v[112:115], a[128:131], a[176:179], v[112:115]
s_add_u32 m0, s29, 16384
s_add_u32 s3, s23, s31
buffer_load_dwordx4 v2, s[8:11], s3 offen offset:0 lds
M v[112:115], a[132:135], a[180:183], v[112:115]
M v[116:119], a[140:143], a[180:183], v[116:119]
M v[116:119], a[136:139], a[176:179], v[116:119]
ds_read_b64_tr_b16 a[36:37], v12 offset:16384
ds_read_b64_tr_b16 a[38:39], v12 offset:18432
M v[120:123], a[144:147], a[176:179], v[120:123]
M v[120:123], a[148:151], a[180:183], v[120:123]
buffer_load_dwordx4 v3, s[8:11], s3 offen offset:1024 lds
M v[124:127], a[156:159], a[180:183], v[124:127]
M v[124:127], a[152:155], a[176:179], v[124:127]
M v[128:131], a[96:99], a[184:187], v[128:131]
M v[128:131], a[100:103], a[188:191], v[128:131]
ds_read_b128 a[168:171], v10 offset:51200
ds_read_b128 a[172:175], v11 offset:51200
ds_read_b64_tr_b16 a[44:45], v13 offset:16384
ds_read_b64_tr_b16 a[46:47], v13 offset:18432
M v[132:135], a[108:111], a[188:191], v[132:135]
M v[132:135], a[104:107], a[184:187], v[132:135]
buffer_load_dwordx4 v4, s[8:11], s3 offen offset:2048 lds
M v[136:139], a[112:115], a[184:187], v[136:139]
M v[136:139], a[116:119], a[188:191], v[136:139]
M v[140:143], a[124:127], a[188:191], v[140:143]
M v[140:143], a[120:123], a[184:187], v[140:143]
ds_read_b64_tr_b16 a[52:53], v14 offset:16384
ds_read_b64_tr_b16 a[54:55], v14 offset:18432
M v[144:147], a[128:131], a[184:187], v[144:147]
M v[144:147], a[132:135], a[188:191], v[144:147]
buffer_load_dwordx4 v5, s[8:11], s3 offen offset:3072 lds
M v[148:151], a[140:143], a[188:191], v[148:151]
M v[148:151], a[136:139], a[184:187], v[148:151]
M v[152:155], a[144:147], a[184:187], v[152:155]
M v[152:155], a[148:151], a[188:191], v[152:155]
ds_read_b64_tr_b16 a[60:61], v15 offset:16384
ds_read_b64_tr_b16 a[62:63], v15 offset:18432
M v[156:159], a[156:159], a[188:191], v[156:159]
s_add_u32 s23, s23, 128
s_cmp_eq_u32 s23, s25
s_cselect_b32 s23, s26, s23
M v[156:159], a[152:155], a[184:187], v[156:159]
s_waitcnt lgkmcnt(10)
M v[160:163], a[96:99], a[160:163], v[160:163]
M v[160:163], a[100:103], a[164:167], v[160:163]
ds_read_b128 a[176:179], v10 offset:53248
ds_read_b128 a[180:183], v11 offset:53248
M v[164:167], a[108:111], a[164:167], v[164:167]
M v[164:167], a[104:107], a[160:163], v[164:167]
ds_read_b64_tr_b16 a[68:69], v16 offset:16384
ds_read_b64_tr_b16 a[70:71], v16 offset:18432
M v[168:171], a[112:115], a[160:163], v[168:171]
M v[168:171], a[116:119], a[164:167], v[168:171]
s_add_u32 m0, s29, 114688
s_nop 0
buffer_load_dwordx4 v6, s[12:15], s24 offen offset:0 lds
M v[172:175], a[124:127], a[164:167], v[172:175]
M v[172:175], a[120:123], a[160:163], v[172:175]
M v[176:179], a[128:131], a[160:163], v[176:179]
M v[176:179], a[132:135], a[164:167], v[176:179]
ds_read_b64_tr_b16 a[76:77], v17 offset:16384
ds_read_b64_tr_b16 a[78:79], v17 offset:18432
M v[180:183], a[140:143], a[164:167], v[180:183]
M v[180:183], a[136:139], a[160:163], v[180:183]
buffer_load_dwordx4 v7, s[12:15], s24 offen offset:1024 lds
M v[184:187], a[144:147], a[160:163], v[184:187]
M v[184:187], a[148:151], a[164:167], v[184:187]
M v[188:191], a[156:159], a[164:167], v[188:191]
M v[188:191], a[152:155], a[160:163], v[188:191]
s_waitcnt lgkmcnt(12)
ds_read_b64_tr_b16 a[84:85], v18 offset:16384
ds_read_b64_tr_b16 a[86:87], v18 offset:18432
M v[192:195], a[96:99], a[168:171], v[192:195]
buffer_load_dwordx4 v8, s[12:15], s24 offen offset:2048 lds
M v[192:195], a[100:103], a[172:175], v[192:195]
ds_read_b128 a[184:187], v10 offset:55296
ds_read_b128 a[188:191], v11 offset:55296
M v[196:199], a[108:111], a[172:175], v[196:199]
M v[196:199], a[104:107], a[168:171], v[196:199]
M v[200:203], a[112:115], a[168:171], v[200:203]
M v[200:203], a[116:119], a[172:175], v[200:203]
ds_read_b64_tr_b16 a[92:93], v19 offset:16384
ds_read_b64_tr_b16 a[94:95], v19 offset:18432
M v[204:207], a[124:127], a[172:175], v[204:207]
buffer_load_dwordx4 v9, s[12:15], s24 offen offset:3072 lds
M v[204:207], a[120:123], a[168:171], v[204:207]
M v[208:211], a[128:131], a[168:171], v[208:211]
M v[208:211], a[132:135], a[172:175], v[208:211]
M v[212:215], a[140:143], a[172:175], v[212:215]
M v[212:215], a[136:139], a[168:171], v[212:215]
s_add_u32 s24, s24, 262144
s_cmp_eq_u32 s24, s27
s_cselect_b32 s24, s28, s24
s_sub_u32 s6, s6, 1
s_cmp_eq_u32 s6, 0
s_cselect_b64 s[12:13], s[64:65], s[12:13]
M v[216:219], a[144:147], a[168:171], v[216:219]
M v[216:219], a[148:151], a[172:175], v[216:219]
M v[220:223], a[156:159], a[172:175], v[220:223]
M v[220:223], a[152:155], a[168:171], v[220:223]
s_waitcnt lgkmcnt(10)
M v[224:227], a[96:99], a[176:179], v[224:227]
buffer_load_dword v21, v20, s[60:63], s54 offen
s_add_u32 s54, s54, 1048576
M v[224:227], a[100:103], a[180:183], v[224:227]
M v[228:231], a[108:111], a[180:183], v[228:231]
M v[228:231], a[104:107], a[176:179], v[228:231]
M v[232:235], a[112:115], a[176:179], v[232:235]
M v[232:235], a[116:119], a[180:183], v[232:235]
M v[236:239], a[124:127], a[180:183], v[236:239]
M v[236:239], a[120:123], a[176:179], v[236:239]
s_waitcnt vmcnt(9) lgkmcnt(0)
s_barrier
ds_read_b128 a[160:163], v10 offset:0
ds_read_b128 a[164:167], v11 offset:0
M v[240:243], a[128:131], a[176:179], v[240:243]
s_add_u32 m0, s29, 32768
s_nop 0
buffer_load_dwordx4 v2, s[8:11], s23 offen offset:0 lds
M v[240:243], a[132:135], a[180:183], v[240:243]
M v[244:247], a[140:143], a[180:183], v[244:247]
M v[244:247], a[136:139], a[176:179], v[244:247]
M v[248:251], a[144:147], a[176:179], v[248:251]
M v[248:251], a[148:151], a[180:183], v[248:251]
buffer_load_dwordx4 v3, s[8:11], s23 offen offset:1024 lds
M v[252:255], a[156:159], a[180:183], v[252:255]
M v[252:255], a[152:155], a[176:179], v[252:255]
M a[0:3], a[96:99], a[184:187], a[0:3]
M a[0:3], a[100:103], a[188:191], a[0:3]
ds_read_b128 a[168:171], v10 offset:2048
ds_read_b128 a[172:175], v11 offset:2048
M a[4:7], a[108:111], a[188:191], a[4:7]
M a[4:7], a[104:107], a[184:187], a[4:7]
M a[8:11], a[112:115], a[184:187], a[8:11]
buffer_load_dwordx4 v4, s[8:11], s23 offen offset:2048 lds
M a[8:11], a[116:119], a[188:191], a[8:11]
M a[12:15], a[124:127], a[188:191], a[12:15]
M a[12:15], a[120:123], a[184:187], a[12:15]
M a[16:19], a[128:131], a[184:187], a[16:19]
M a[16:19], a[132:135], a[188:191], a[16:19]
buffer_load_dwordx4 v5, s[8:11], s23 offen offset:3072 lds
M a[20:23], a[140:143], a[188:191], a[20:23]
M a[20:23], a[136:139], a[184:187], a[20:23]
M a[24:27], a[144:147], a[184:187], a[24:27]
M a[24:27], a[148:151], a[188:191], a[24:27]
M a[28:31], a[156:159], a[188:191], a[28:31]
M a[28:31], a[152:155], a[184:187], a[28:31]
s_waitcnt lgkmcnt(2)
s_mov_b32 s30, 5
Lk1_ql:
M v[32:35], a[32:35], a[160:163], v[32:35]
s_add_u32 m0, s29, 65536
s_nop 0
buffer_load_dwordx4 v6, s[12:15], s24 offen offset:0 lds
M v[32:35], a[36:39], a[164:167], v[32:35]
ds_read_b128 a[176:179], v10 offset:4096
ds_read_b128 a[180:183], v11 offset:4096
M v[36:39], a[44:47], a[164:167], v[36:39]
M v[36:39], a[40:43], a[160:163], v[36:39]
ds_read_b64_tr_b16 a[96:97], v12 offset:32768
ds_read_b64_tr_b16 a[98:99], v12 offset:34816
M v[40:43], a[48:51], a[160:163], v[40:43]
M v[40:43], a[52:55], a[164:167], v[40:43]
M v[44:47], a[60:63], a[164:167], v[44:47]
M v[44:47], a[56:59], a[160:163], v[44:47]
ds_read_b64_tr_b16 a[104:105], v13 offset:32768
ds_read_b64_tr_b16 a[106:107], v13 offset:34816
M v[48:51], a[64:67], a[160:163], v[48:51]
buffer_load_dwordx4 v7, s[12:15], s24 offen offset:1024 lds
M v[48:51], a[68:71], a[164:167], v[48:51]
M v[52:55], a[76:79], a[164:167], v[52:55]
M v[52:55], a[72:75], a[160:163], v[52:55]
ds_read_b64_tr_b16 a[112:113], v14 offset:32768
ds_read_b64_tr_b16 a[114:115], v14 offset:34816
M v[56:59], a[80:83], a[160:163], v[56:59]
M v[56:59], a[84:87], a[164:167], v[56:59]
M v[60:63], a[92:95], a[164:167], v[60:63]
buffer_load_dwordx4 v8, s[12:15], s24 offen offset:2048 lds
M v[60:63], a[88:91], a[160:163], v[60:63]
s_waitcnt lgkmcnt(8)
ds_read_b64_tr_b16 a[120:121], v15 offset:32768
ds_read_b64_tr_b16 a[122:123], v15 offset:34816
M v[64:67], a[32:35], a[168:171], v[64:67]
M v[64:67], a[36:39], a[172:175], v[64:67]
ds_read_b128 a[184:187], v10 offset:6144
ds_read_b128 a[188:191], v11 offset:6144
M v[68:71], a[44:47], a[172:175], v[68:71]
M v[68:71], a[40:43], a[168:171], v[68:71]
ds_read_b64_tr_b16 a[128:129], v16 offset:32768
ds_read_b64_tr_b16 a[130:131], v16 offset:34816
M v[72:75], a[48:51], a[168:171], v[72:75]
M v[72:75], a[52:55], a[172:175], v[72:75]
M v[76:79], a[60:63], a[172:175], v[76:79]
M v[76:79], a[56:59], a[168:171], v[76:79]
ds_read_b64_tr_b16 a[136:137], v17 offset:32768
ds_read_b64_tr_b16 a[138:139], v17 offset:34816
M v[80:83], a[64:67], a[168:171], v[80:83]
buffer_load_dwordx4 v9, s[12:15], s24 offen offset:3072 lds
M v[80:83], a[68:71], a[172:175], v[80:83]
M v[84:87], a[76:79], a[172:175], v[84:87]
M v[84:87], a[72:75], a[168:171], v[84:87]
ds_read_b64_tr_b16 a[144:145], v18 offset:32768
ds_read_b64_tr_b16 a[146:147], v18 offset:34816
M v[88:91], a[80:83], a[168:171], v[88:91]
M v[88:91], a[84:87], a[172:175], v[88:91]
M v[92:95], a[92:95], a[172:175], v[92:95]
s_add_u32 s24, s24, 262144
M v[92:95], a[88:91], a[168:171], v[92:95]
s_waitcnt lgkmcnt(15)
ds_read_b64_tr_b16 a[152:153], v19 offset:32768
ds_read_b64_tr_b16 a[154:155], v19 offset:34816
M v[96:99], a[32:35], a[176:179], v[96:99]
M v[96:99], a[36:39], a[180:183], v[96:99]
M v[100:103], a[44:47], a[180:183], v[100:103]
M v[100:103], a[40:43], a[176:179], v[100:103]
M v[104:107], a[48:51], a[176:179], v[104:107]
M v[104:107], a[52:55], a[180:183], v[104:107]
M v[108:111], a[60:63], a[180:183], v[108:111]
M v[108:111], a[56:59], a[176:179], v[108:111]
s_waitcnt vmcnt(9) lgkmcnt(0)
s_barrier
ds_read_b128 a[160:163], v10 offset:16384
ds_read_b128 a[164:167], v11 offset:16384
M v[112:115], a[64:67], a[176:179], v[112:115]
s_add_u32 m0, s29, 49152
s_add_u32 s3, s23, s31
buffer_load_dwordx4 v2, s[8:11], s3 offen offset:0 lds
M v[112:115], a[68:71], a[180:183], v[112:115]
M v[116:119], a[76:79], a[180:183], v[116:119]
M v[116:119], a[72:75], a[176:179], v[116:119]
ds_read_b64_tr_b16 a[100:101], v12 offset:49152
ds_read_b64_tr_b16 a[102:103], v12 offset:51200
M v[120:123], a[80:83], a[176:179], v[120:123]
M v[120:123], a[84:87], a[180:183], v[120:123]
buffer_load_dwordx4 v3, s[8:11], s3 offen offset:1024 lds
M v[124:127], a[92:95], a[180:183], v[124:127]
M v[124:127], a[88:91], a[176:179], v[124:127]
M v[128:131], a[32:35], a[184:187], v[128:131]
M v[128:131], a[36:39], a[188:191], v[128:131]
ds_read_b128 a[168:171], v10 offset:18432
ds_read_b128 a[172:175], v11 offset:18432
ds_read_b64_tr_b16 a[108:109], v13 offset:49152
ds_read_b64_tr_b16 a[110:111], v13 offset:51200
M v[132:135], a[44:47], a[188:191], v[132:135]
M v[132:135], a[40:43], a[184:187], v[132:135]
buffer_load_dwordx4 v4, s[8:11], s3 offen offset:2048 lds
M v[136:139], a[48:51], a[184:187], v[136:139]
M v[136:139], a[52:55], a[188:191], v[136:139]
M v[140:143], a[60:63], a[188:191], v[140:143]
M v[140:143], a[56:59], a[184:187], v[140:143]
ds_read_b64_tr_b16 a[116:117], v14 offset:49152
ds_read_b64_tr_b16 a[118:119], v14 offset:51200
M v[144:147], a[64:67], a[184:187], v[144:147]
M v[144:147], a[68:71], a[188:191], v[144:147]
buffer_load_dwordx4 v5, s[8:11], s3 offen offset:3072 lds
M v[148:151], a[76:79], a[188:191], v[148:151]
M v[148:151], a[72:75], a[184:187], v[148:151]
M v[152:155], a[80:83], a[184:187], v[152:155]
M v[152:155], a[84:87], a[188:191], v[152:155]
ds_read_b64_tr_b16 a[124:125], v15 offset:49152
ds_read_b64_tr_b16 a[126:127], v15 offset:51200
M v[156:159], a[92:95], a[188:191], v[156:159]
s_add_u32 s23, s23, 128
s_cmp_eq_u32 s23, s25
s_cselect_b32 s23, s26, s23
M v[156:159], a[88:91], a[184:187], v[156:159]
s_waitcnt lgkmcnt(10)
M v[160:163], a[32:35], a[160:163], v[160:163]
M v[160:163], a[36:39], a[164:167], v[160:163]
ds_read_b128 a[176:179], v10 offset:20480
ds_read_b128 a[180:183], v11 offset:20480
M v[164:167], a[44:47], a[164:167], v[164:167]
M v[164:167], a[40:43], a[160:163], v[164:167]
ds_read_b64_tr_b16 a[132:133], v16 offset:49152
ds_read_b64_tr_b16 a[134:135], v16 offset:51200
M v[168:171], a[48:51], a[160:163], v[168:171]
M v[168:171], a[52:55], a[164:167], v[168:171]
s_add_u32 m0, s29, 81920
s_nop 0
buffer_load_dwordx4 v6, s[12:15], s24 offen offset:0 lds
M v[172:175], a[60:63], a[164:167], v[172:175]
M v[172:175], a[56:59], a[160:163], v[172:175]
M v[176:179], a[64:67], a[160:163], v[176:179]
M v[176:179], a[68:71], a[164:167], v[176:179]
ds_read_b64_tr_b16 a[140:141], v17 offset:49152
ds_read_b64_tr_b16 a[142:143], v17 offset:51200
M v[180:183], a[76:79], a[164:167], v[180:183]
M v[180:183], a[72:75], a[160:163], v[180:183]
buffer_load_dwordx4 v7, s[12:15], s24 offen offset:1024 lds
M v[184:187], a[80:83], a[160:163], v[184:187]
M v[184:187], a[84:87], a[164:167], v[184:187]
M v[188:191], a[92:95], a[164:167], v[188:191]
M v[188:191], a[88:91], a[160:163], v[188:191]
s_waitcnt lgkmcnt(12)
ds_read_b64_tr_b16 a[148:149], v18 offset:49152
ds_read_b64_tr_b16 a[150:151], v18 offset:51200
M v[192:195], a[32:35], a[168:171], v[192:195]
buffer_load_dwordx4 v8, s[12:15], s24 offen offset:2048 lds
M v[192:195], a[36:39], a[172:175], v[192:195]
ds_read_b128 a[184:187], v10 offset:22528
ds_read_b128 a[188:191], v11 offset:22528
M v[196:199], a[44:47], a[172:175], v[196:199]
M v[196:199], a[40:43], a[168:171], v[196:199]
M v[200:203], a[48:51], a[168:171], v[200:203]
M v[200:203], a[52:55], a[172:175], v[200:203]
ds_read_b64_tr_b16 a[156:157], v19 offset:49152
ds_read_b64_tr_b16 a[158:159], v19 offset:51200
M v[204:207], a[60:63], a[172:175], v[204:207]
buffer_load_dwordx4 v9, s[12:15], s24 offen offset:3072 lds
M v[204:207], a[56:59], a[168:171], v[204:207]
M v[208:211], a[64:67], a[168:171], v[208:211]
M v[208:211], a[68:71], a[172:175], v[208:211]
M v[212:215], a[76:79], a[172:175], v[212:215]
M v[212:215], a[72:75], a[168:171], v[212:215]
s_add_u32 s24, s24, 262144
s_cmp_eq_u32 s24, s27
s_cselect_b32 s24, s28, s24
s_sub_u32 s6, s6, 1
s_cmp_eq_u32 s6, 0
s_cselect_b64 s[12:13], s[64:65], s[12:13]
M v[216:219], a[80:83], a[168:171], v[216:219]
M v[216:219], a[84:87], a[172:175], v[216:219]
M v[220:223], a[92:95], a[172:175], v[220:223]
M v[220:223], a[88:91], a[168:171], v[220:223]
s_waitcnt lgkmcnt(10)
M v[224:227], a[32:35], a[176:179], v[224:227]
buffer_load_dword v21, v20, s[60:63], s54 offen
s_add_u32 s54, s54, 1048576
M v[224:227], a[36:39], a[180:183], v[224:227]
M v[228:231], a[44:47], a[180:183], v[228:231]
M v[228:231], a[40:43], a[176:179], v[228:231]
M v[232:235], a[48:51], a[176:179], v[232:235]
M v[232:235], a[52:55], a[180:183], v[232:235]
M v[236:239], a[60:63], a[180:183], v[236:239]
M v[236:239], a[56:59], a[176:179], v[236:239]
s_waitcnt vmcnt(9) lgkmcnt(0)
s_barrier
ds_read_b128 a[160:163], v10 offset:32768
ds_read_b128 a[164:167], v11 offset:32768
M v[240:243], a[64:67], a[176:179], v[240:243]
s_add_u32 m0, s29, 0
s_nop 0
buffer_load_dwordx4 v2, s[8:11], s23 offen offset:0 lds
M v[240:243], a[68:71], a[180:183], v[240:243]
M v[244:247], a[76:79], a[180:183], v[244:247]
M v[244:247], a[72:75], a[176:179], v[244:247]
M v[248:251], a[80:83], a[176:179], v[248:251]
M v[248:251], a[84:87], a[180:183], v[248:251]
buffer_load_dwordx4 v3, s[8:11], s23 offen offset:1024 lds
M v[252:255], a[92:95], a[180:183], v[252:255]
M v[252:255], a[88:91], a[176:179], v[252:255]
M a[0:3], a[32:35], a[184:187], a[0:3]
M a[0:3], a[36:39], a[188:191], a[0:3]
ds_read_b128 a[168:171], v10 offset:34816
ds_read_b128 a[172:175], v11 offset:34816
M a[4:7], a[44:47], a[188:191], a[4:7]
M a[4:7], a[40:43], a[184:187], a[4:7]
M a[8:11], a[48:51], a[184:187], a[8:11]
buffer_load_dwordx4 v4, s[8:11], s23 offen offset:2048 lds
M a[8:11], a[52:55], a[188:191], a[8:11]
M a[12:15], a[60:63], a[188:191], a[12:15]
M a[12:15], a[56:59], a[184:187], a[12:15]
M a[16:19], a[64:67], a[184:187], a[16:19]
M a[16:19], a[68:71], a[188:191], a[16:19]
buffer_load_dwordx4 v5, s[8:11], s23 offen offset:3072 lds
M a[20:23], a[76:79], a[188:191], a[20:23]
M a[20:23], a[72:75], a[184:187], a[20:23]
M a[24:27], a[80:83], a[184:187], a[24:27]
M a[24:27], a[84:87], a[188:191], a[24:27]
M a[28:31], a[92:95], a[188:191], a[28:31]
M a[28:31], a[88:91], a[184:187], a[28:31]
s_waitcnt lgkmcnt(2)
M v[32:35], a[96:99], a[160:163], v[32:35]
s_add_u32 m0, s29, 98304
s_nop 0
buffer_load_dwordx4 v6, s[12:15], s24 offen offset:0 lds
M v[32:35], a[100:103], a[164:167], v[32:35]
ds_read_b128 a[176:179], v10 offset:36864
ds_read_b128 a[180:183], v11 offset:36864
M v[36:39], a[108:111], a[164:167], v[36:39]
M v[36:39], a[104:107], a[160:163], v[36:39]
ds_read_b64_tr_b16 a[32:33], v12 offset:0
ds_read_b64_tr_b16 a[34:35], v12 offset:2048
M v[40:43], a[112:115], a[160:163], v[40:43]
M v[40:43], a[116:119], a[164:167], v[40:43]
M v[44:47], a[124:127], a[164:167], v[44:47]
M v[44:47], a[120:123], a[160:163], v[44:47]
ds_read_b64_tr_b16 a[40:41], v13 offset:0
ds_read_b64_tr_b16 a[42:43], v13 offset:2048
M v[48:51], a[128:131], a[160:163], v[48:51]
buffer_load_dwordx4 v7, s[12:15], s24 offen offset:1024 lds
M v[48:51], a[132:135], a[164:167], v[48:51]
M v[52:55], a[140:143], a[164:167], v[52:55]
M v[52:55], a[136:139], a[160:163], v[52:55]
ds_read_b64_tr_b16 a[48:49], v14 offset:0
ds_read_b64_tr_b16 a[50:51], v14 offset:2048
M v[56:59], a[144:147], a[160:163], v[56:59]
M v[56:59], a[148:151], a[164:167], v[56:59]
M v[60:63], a[156:159], a[164:167], v[60:63]
buffer_load_dwordx4 v8, s[12:15], s24 offen offset:2048 lds
M v[60:63], a[152:155], a[160:163], v[60:63]
s_waitcnt lgkmcnt(8)
ds_read_b64_tr_b16 a[56:57], v15 offset:0
ds_read_b64_tr_b16 a[58:59], v15 offset:2048
M v[64:67], a[96:99], a[168:171], v[64:67]
M v[64:67], a[100:103], a[172:175], v[64:67]
ds_read_b128 a[184:187], v10 offset:38912
ds_read_b128 a[188:191], v11 offset:38912
M v[68:71], a[108:111], a[172:175], v[68:71]
M v[68:71], a[104:107], a[168:171], v[68:71]
ds_read_b64_tr_b16 a[64:65], v16 offset:0
ds_read_b64_tr_b16 a[66:67], v16 offset:2048
M v[72:75], a[112:115], a[168:171], v[72:75]
M v[72:75], a[116:119], a[172:175], v[72:75]
M v[76:79], a[124:127], a[172:175], v[76:79]
M v[76:79], a[120:123], a[168:171], v[76:79]
ds_read_b64_tr_b16 a[72:73], v17 offset:0
ds_read_b64_tr_b16 a[74:75], v17 offset:2048
M v[80:83], a[128:131], a[168:171], v[80:83]
buffer_load_dwordx4 v9, s[12:15], s24 offen offset:3072 lds
M v[80:83], a[132:135], a[172:175], v[80:83]
M v[84:87], a[140:143], a[172:175], v[84:87]
M v[84:87], a[136:139], a[168:171], v[84:87]
ds_read_b64_tr_b16 a[80:81], v18 offset:0
ds_read_b64_tr_b16 a[82:83], v18 offset:2048
M v[88:91], a[144:147], a[168:171], v[88:91]
M v[88:91], a[148:151], a[172:175], v[88:91]
M v[92:95], a[156:159], a[172:175], v[92:95]
s_add_u32 s24, s24, 262144
M v[92:95], a[152:155], a[168:171], v[92:95]
s_waitcnt lgkmcnt(15)
ds_read_b64_tr_b16 a[88:89], v19 offset:0
ds_read_b64_tr_b16 a[90:91], v19 offset:2048
M v[96:99], a[96:99], a[176:179], v[96:99]
M v[96:99], a[100:103], a[180:183], v[96:99]
M v[100:103], a[108:111], a[180:183], v[100:103]
M v[100:103], a[104:107], a[176:179], v[100:103]
M v[104:107], a[112:115], a[176:179], v[104:107]
M v[104:107], a[116:119], a[180:183], v[104:107]
M v[108:111], a[124:127], a[180:183], v[108:111]
M v[108:111], a[120:123], a[176:179], v[108:111]
s_waitcnt vmcnt(9) lgkmcnt(0)
s_barrier
ds_read_b128 a[160:163], v10 offset:49152
ds_read_b128 a[164:167], v11 offset:49152
M v[112:115], a[128:131], a[176:179], v[112:115]
s_add_u32 m0, s29, 16384
s_add_u32 s3, s23, s31
buffer_load_dwordx4 v2, s[8:11], s3 offen offset:0 lds
M v[112:115], a[132:135], a[180:183], v[112:115]
M v[116:119], a[140:143], a[180:183], v[116:119]
M v[116:119], a[136:139], a[176:179], v[116:119]
ds_read_b64_tr_b16 a[36:37], v12 offset:16384
ds_read_b64_tr_b16 a[38:39], v12 offset:18432
M v[120:123], a[144:147], a[176:179], v[120:123]
M v[120:123], a[148:151], a[180:183], v[120:123]
buffer_load_dwordx4 v3, s[8:11], s3 offen offset:1024 lds
M v[124:127], a[156:159], a[180:183], v[124:127]
M v[124:127], a[152:155], a[176:179], v[124:127]
M v[128:131], a[96:99], a[184:187], v[128:131]
M v[128:131], a[100:103], a[188:191], v[128:131]
ds_read_b128 a[168:171], v10 offset:51200
ds_read_b128 a[172:175], v11 offset:51200
ds_read_b64_tr_b16 a[44:45], v13 offset:16384
ds_read_b64_tr_b16 a[46:47], v13 offset:18432
M v[132:135], a[108:111], a[188:191], v[132:135]
M v[132:135], a[104:107], a[184:187], v[132:135]
buffer_load_dwordx4 v4, s[8:11], s3 offen offset:2048 lds
M v[136:139], a[112:115], a[184:187], v[136:139]
M v[136:139], a[116:119], a[188:191], v[136:139]
M v[140:143], a[124:127], a[188:191], v[140:143]
M v[140:143], a[120:123], a[184:187], v[140:143]
ds_read_b64_tr_b16 a[52:53], v14 offset:16384
ds_read_b64_tr_b16 a[54:55], v14 offset:18432
M v[144:147], a[128:131], a[184:187], v[144:147]
M v[144:147], a[132:135], a[188:191], v[144:147]
buffer_load_dwordx4 v5, s[8:11], s3 offen offset:3072 lds
M v[148:151], a[140:143], a[188:191], v[148:151]
M v[148:151], a[136:139], a[184:187], v[148:151]
M v[152:155], a[144:147], a[184:187], v[152:155]
M v[152:155], a[148:151], a[188:191], v[152:155]
ds_read_b64_tr_b16 a[60:61], v15 offset:16384
ds_read_b64_tr_b16 a[62:63], v15 offset:18432
M v[156:159], a[156:159], a[188:191], v[156:159]
s_add_u32 s23, s23, 128
s_cmp_eq_u32 s23, s25
s_cselect_b32 s23, s26, s23
M v[156:159], a[152:155], a[184:187], v[156:159]
s_waitcnt lgkmcnt(10)
M v[160:163], a[96:99], a[160:163], v[160:163]
M v[160:163], a[100:103], a[164:167], v[160:163]
ds_read_b128 a[176:179], v10 offset:53248
ds_read_b128 a[180:183], v11 offset:53248
M v[164:167], a[108:111], a[164:167], v[164:167]
M v[164:167], a[104:107], a[160:163], v[164:167]
ds_read_b64_tr_b16 a[68:69], v16 offset:16384
ds_read_b64_tr_b16 a[70:71], v16 offset:18432
M v[168:171], a[112:115], a[160:163], v[168:171]
M v[168:171], a[116:119], a[164:167], v[168:171]
s_add_u32 m0, s29, 114688
s_nop 0
buffer_load_dwordx4 v6, s[12:15], s24 offen offset:0 lds
M v[172:175], a[124:127], a[164:167], v[172:175]
M v[172:175], a[120:123], a[160:163], v[172:175]
M v[176:179], a[128:131], a[160:163], v[176:179]
M v[176:179], a[132:135], a[164:167], v[176:179]
ds_read_b64_tr_b16 a[76:77], v17 offset:16384
ds_read_b64_tr_b16 a[78:79], v17 offset:18432
M v[180:183], a[140:143], a[164:167], v[180:183]
M v[180:183], a[136:139], a[160:163], v[180:183]
buffer_load_dwordx4 v7, s[12:15], s24 offen offset:1024 lds
M v[184:187], a[144:147], a[160:163], v[184:187]
M v[184:187], a[148:151], a[164:167], v[184:187]
M v[188:191], a[156:159], a[164:167], v[188:191]
M v[188:191], a[152:155], a[160:163], v[188:191]
s_waitcnt lgkmcnt(12)
ds_read_b64_tr_b16 a[84:85], v18 offset:16384
ds_read_b64_tr_b16 a[86:87], v18 offset:18432
M v[192:195], a[96:99], a[168:171], v[192:195]
buffer_load_dwordx4 v8, s[12:15], s24 offen offset:2048 lds
M v[192:195], a[100:103], a[172:175], v[192:195]
ds_read_b128 a[184:187], v10 offset:55296
ds_read_b128 a[188:191], v11 offset:55296
M v[196:199], a[108:111], a[172:175], v[196:199]
M v[196:199], a[104:107], a[168:171], v[196:199]
M v[200:203], a[112:115], a[168:171], v[200:203]
M v[200:203], a[116:119], a[172:175], v[200:203]
ds_read_b64_tr_b16 a[92:93], v19 offset:16384
ds_read_b64_tr_b16 a[94:95], v19 offset:18432
M v[204:207], a[124:127], a[172:175], v[204:207]
buffer_load_dwordx4 v9, s[12:15], s24 offen offset:3072 lds
M v[204:207], a[120:123], a[168:171], v[204:207]
M v[208:211], a[128:131], a[168:171], v[208:211]
M v[208:211], a[132:135], a[172:175], v[208:211]
M v[212:215], a[140:143], a[172:175], v[212:215]
M v[212:215], a[136:139], a[168:171], v[212:215]
s_add_u32 s24, s24, 262144
s_cmp_eq_u32 s24, s27
s_cselect_b32 s24, s28, s24
s_sub_u32 s6, s6, 1
s_cmp_eq_u32 s6, 0
s_cselect_b64 s[12:13], s[64:65], s[12:13]
M v[216:219], a[144:147], a[168:171], v[216:219]
M v[216:219], a[148:151], a[172:175], v[216:219]
M v[220:223], a[156:159], a[172:175], v[220:223]
M v[220:223], a[152:155], a[168:171], v[220:223]
s_waitcnt lgkmcnt(10)
M v[224:227], a[96:99], a[176:179], v[224:227]
buffer_load_dword v21, v20, s[60:63], s54 offen
s_add_u32 s54, s54, 1048576
M v[224:227], a[100:103], a[180:183], v[224:227]
M v[228:231], a[108:111], a[180:183], v[228:231]
M v[228:231], a[104:107], a[176:179], v[228:231]
M v[232:235], a[112:115], a[176:179], v[232:235]
M v[232:235], a[116:119], a[180:183], v[232:235]
M v[236:239], a[124:127], a[180:183], v[236:239]
M v[236:239], a[120:123], a[176:179], v[236:239]
s_waitcnt vmcnt(9) lgkmcnt(0)
s_barrier
ds_read_b128 a[160:163], v10 offset:0
ds_read_b128 a[164:167], v11 offset:0
M v[240:243], a[128:131], a[176:179], v[240:243]
s_add_u32 m0, s29, 32768
s_nop 0
buffer_load_dwordx4 v2, s[8:11], s23 offen offset:0 lds
M v[240:243], a[132:135], a[180:183], v[240:243]
M v[244:247], a[140:143], a[180:183], v[244:247]
M v[244:247], a[136:139], a[176:179], v[244:247]
M v[248:251], a[144:147], a[176:179], v[248:251]
M v[248:251], a[148:151], a[180:183], v[248:251]
buffer_load_dwordx4 v3, s[8:11], s23 offen offset:1024 lds
M v[252:255], a[156:159], a[180:183], v[252:255]
M v[252:255], a[152:155], a[176:179], v[252:255]
M a[0:3], a[96:99], a[184:187], a[0:3]
M a[0:3], a[100:103], a[188:191], a[0:3]
ds_read_b128 a[168:171], v10 offset:2048
ds_read_b128 a[172:175], v11 offset:2048
M a[4:7], a[108:111], a[188:191], a[4:7]
M a[4:7], a[104:107], a[184:187], a[4:7]
M a[8:11], a[112:115], a[184:187], a[8:11]
buffer_load_dwordx4 v4, s[8:11], s23 offen offset:2048 lds
M a[8:11], a[116:119], a[188:191], a[8:11]
M a[12:15], a[124:127], a[188:191], a[12:15]
M a[12:15], a[120:123], a[184:187], a[12:15]
M a[16:19], a[128:131], a[184:187], a[16:19]
M a[16:19], a[132:135], a[188:191], a[16:19]
buffer_load_dwordx4 v5, s[8:11], s23 offen offset:3072 lds
M a[20:23], a[140:143], a[188:191], a[20:23]
M a[20:23], a[136:139], a[184:187], a[20:23]
M a[24:27], a[144:147], a[184:187], a[24:27]
M a[24:27], a[148:151], a[188:191], a[24:27]
M a[28:31], a[156:159], a[188:191], a[28:31]
M a[28:31], a[152:155], a[184:187], a[28:31]
s_waitcnt lgkmcnt(2)
s_sub_u32 s30, s30, 1
s_cmp_lg_u32 s30, 0
s_cbranch_scc1 Lk1_ql
M v[32:35], a[32:35], a[160:163], v[32:35]
s_add_u32 m0, s29, 65536
s_nop 0
buffer_load_dwordx4 v6, s[12:15], s24 offen offset:0 lds
M v[32:35], a[36:39], a[164:167], v[32:35]
ds_read_b128 a[176:179], v10 offset:4096
ds_read_b128 a[180:183], v11 offset:4096
M v[36:39], a[44:47], a[164:167], v[36:39]
M v[36:39], a[40:43], a[160:163], v[36:39]
ds_read_b64_tr_b16 a[96:97], v12 offset:32768
ds_read_b64_tr_b16 a[98:99], v12 offset:34816
M v[40:43], a[48:51], a[160:163], v[40:43]
M v[40:43], a[52:55], a[164:167], v[40:43]
M v[44:47], a[60:63], a[164:167], v[44:47]
M v[44:47], a[56:59], a[160:163], v[44:47]
ds_read_b64_tr_b16 a[104:105], v13 offset:32768
ds_read_b64_tr_b16 a[106:107], v13 offset:34816
M v[48:51], a[64:67], a[160:163], v[48:51]
buffer_load_dwordx4 v7, s[12:15], s24 offen offset:1024 lds
M v[48:51], a[68:71], a[164:167], v[48:51]
M v[52:55], a[76:79], a[164:167], v[52:55]
M v[52:55], a[72:75], a[160:163], v[52:55]
ds_read_b64_tr_b16 a[112:113], v14 offset:32768
ds_read_b64_tr_b16 a[114:115], v14 offset:34816
M v[56:59], a[80:83], a[160:163], v[56:59]
M v[56:59], a[84:87], a[164:167], v[56:59]
M v[60:63], a[92:95], a[164:167], v[60:63]
buffer_load_dwordx4 v8, s[12:15], s24 offen offset:2048 lds
M v[60:63], a[88:91], a[160:163], v[60:63]
s_waitcnt lgkmcnt(8)
ds_read_b64_tr_b16 a[120:121], v15 offset:32768
ds_read_b64_tr_b16 a[122:123], v15 offset:34816
M v[64:67], a[32:35], a[168:171], v[64:67]
M v[64:67], a[36:39], a[172:175], v[64:67]
ds_read_b128 a[184:187], v10 offset:6144
ds_read_b128 a[188:191], v11 offset:6144
M v[68:71], a[44:47], a[172:175], v[68:71]
M v[68:71], a[40:43], a[168:171], v[68:71]
ds_read_b64_tr_b16 a[128:129], v16 offset:32768
ds_read_b64_tr_b16 a[130:131], v16 offset:34816
M v[72:75], a[48:51], a[168:171], v[72:75]
M v[72:75], a[52:55], a[172:175], v[72:75]
M v[76:79], a[60:63], a[172:175], v[76:79]
M v[76:79], a[56:59], a[168:171], v[76:79]
ds_read_b64_tr_b16 a[136:137], v17 offset:32768
ds_read_b64_tr_b16 a[138:139], v17 offset:34816
M v[80:83], a[64:67], a[168:171], v[80:83]
buffer_load_dwordx4 v9, s[12:15], s24 offen offset:3072 lds
M v[80:83], a[68:71], a[172:175], v[80:83]
M v[84:87], a[76:79], a[172:175], v[84:87]
M v[84:87], a[72:75], a[168:171], v[84:87]
ds_read_b64_tr_b16 a[144:145], v18 offset:32768
ds_read_b64_tr_b16 a[146:147], v18 offset:34816
M v[88:91], a[80:83], a[168:171], v[88:91]
M v[88:91], a[84:87], a[172:175], v[88:91]
M v[92:95], a[92:95], a[172:175], v[92:95]
s_add_u32 s24, s24, 262144
M v[92:95], a[88:91], a[168:171], v[92:95]
s_waitcnt lgkmcnt(15)
ds_read_b64_tr_b16 a[152:153], v19 offset:32768
ds_read_b64_tr_b16 a[154:155], v19 offset:34816
M v[96:99], a[32:35], a[176:179], v[96:99]
M v[96:99], a[36:39], a[180:183], v[96:99]
M v[100:103], a[44:47], a[180:183], v[100:103]
M v[100:103], a[40:43], a[176:179], v[100:103]
M v[104:107], a[48:51], a[176:179], v[104:107]
M v[104:107], a[52:55], a[180:183], v[104:107]
M v[108:111], a[60:63], a[180:183], v[108:111]
M v[108:111], a[56:59], a[176:179], v[108:111]
s_waitcnt vmcnt(9) lgkmcnt(0)
s_barrier
ds_read_b128 a[160:163], v10 offset:16384
ds_read_b128 a[164:167], v11 offset:16384
M v[112:115], a[64:67], a[176:179], v[112:115]
s_add_u32 m0, s29, 49152
s_add_u32 s3, s23, s31
buffer_load_dwordx4 v2, s[8:11], s3 offen offset:0 lds
M v[112:115], a[68:71], a[180:183], v[112:115]
M v[116:119], a[76:79], a[180:183], v[116:119]
M v[116:119], a[72:75], a[176:179], v[116:119]
ds_read_b64_tr_b16 a[100:101], v12 offset:49152
ds_read_b64_tr_b16 a[102:103], v12 offset:51200
M v[120:123], a[80:83], a[176:179], v[120:123]
M v[120:123], a[84:87], a[180:183], v[120:123]
buffer_load_dwordx4 v3, s[8:11], s3 offen offset:1024 lds
M v[124:127], a[92:95], a[180:183], v[124:127]
M v[124:127], a[88:91], a[176:179], v[124:127]
M v[128:131], a[32:35], a[184:187], v[128:131]
M v[128:131], a[36:39], a[188:191], v[128:131]
ds_read_b128 a[168:171], v10 offset:18432
ds_read_b128 a[172:175], v11 offset:18432
ds_read_b64_tr_b16 a[108:109], v13 offset:49152
ds_read_b64_tr_b16 a[110:111], v13 offset:51200
M v[132:135], a[44:47], a[188:191], v[132:135]
M v[132:135], a[40:43], a[184:187], v[132:135]
M v[136:139], a[48:51], a[184:187], v[136:139]
buffer_load_dwordx4 v4, s[8:11], s3 offen offset:2048 lds
M v[136:139], a[52:55], a[188:191], v[136:139]
M v[140:143], a[60:63], a[188:191], v[140:143]
M v[140:143], a[56:59], a[184:187], v[140:143]
ds_read_b64_tr_b16 a[116:117], v14 offset:49152
ds_read_b64_tr_b16 a[118:119], v14 offset:51200
M v[144:147], a[64:67], a[184:187], v[144:147]
M v[144:147], a[68:71], a[188:191], v[144:147]
M v[148:151], a[76:79], a[188:191], v[148:151]
buffer_load_dwordx4 v5, s[8:11], s3 offen offset:3072 lds
M v[148:151], a[72:75], a[184:187], v[148:151]
M v[152:155], a[80:83], a[184:187], v[152:155]
M v[152:155], a[84:87], a[188:191], v[152:155]
ds_read_b64_tr_b16 a[124:125], v15 offset:49152
ds_read_b64_tr_b16 a[126:127], v15 offset:51200
M v[156:159], a[92:95], a[188:191], v[156:159]
M v[156:159], a[88:91], a[184:187], v[156:159]
s_waitcnt lgkmcnt(10)
M v[160:163], a[32:35], a[160:163], v[160:163]
M v[160:163], a[36:39], a[164:167], v[160:163]
ds_read_b128 a[176:179], v10 offset:20480
ds_read_b128 a[180:183], v11 offset:20480
M v[164:167], a[44:47], a[164:167], v[164:167]
s_add_u32 s23, s23, 128
s_cmp_eq_u32 s23, s25
s_cselect_b32 s23, s26, s23
M v[164:167], a[40:43], a[160:163], v[164:167]
ds_read_b64_tr_b16 a[132:133], v16 offset:49152
ds_read_b64_tr_b16 a[134:135], v16 offset:51200
M v[168:171], a[48:51], a[160:163], v[168:171]
M v[168:171], a[52:55], a[164:167], v[168:171]
M v[172:175], a[60:63], a[164:167], v[172:175]
M v[172:175], a[56:59], a[160:163], v[172:175]
M v[176:179], a[64:67], a[160:163], v[176:179]
s_add_u32 m0, s29, 81920
s_nop 0
buffer_load_dwordx4 v6, s[12:15], s24 offen offset:0 lds
M v[176:179], a[68:71], a[164:167], v[176:179]
ds_read_b64_tr_b16 a[140:141], v17 offset:49152
ds_read_b64_tr_b16 a[142:143], v17 offset:51200
M v[180:183], a[76:79], a[164:167], v[180:183]
M v[180:183], a[72:75], a[160:163], v[180:183]
M v[184:187], a[80:83], a[160:163], v[184:187]
M v[184:187], a[84:87], a[164:167], v[184:187]
buffer_load_dwordx4 v7, s[12:15], s24 offen offset:1024 lds
M v[188:191], a[92:95], a[164:167], v[188:191]
M v[188:191], a[88:91], a[160:163], v[188:191]
s_waitcnt lgkmcnt(12)
ds_read_b64_tr_b16 a[148:149], v18 offset:49152
ds_read_b64_tr_b16 a[150:151], v18 offset:51200
M v[192:195], a[32:35], a[168:171], v[192:195]
M v[192:195], a[36:39], a[172:175], v[192:195]
ds_read_b128 a[184:187], v10 offset:22528
ds_read_b128 a[188:191], v11 offset:22528
M v[196:199], a[44:47], a[172:175], v[196:199]
M v[196:199], a[40:43], a[168:171], v[196:199]
M v[200:203], a[48:51], a[168:171], v[200:203]
buffer_load_dwordx4 v8, s[12:15], s24 offen offset:2048 lds
M v[200:203], a[52:55], a[172:175], v[200:203]
ds_read_b64_tr_b16 a[156:157], v19 offset:49152
ds_read_b64_tr_b16 a[158:159], v19 offset:51200
M v[204:207], a[60:63], a[172:175], v[204:207]
M v[204:207], a[56:59], a[168:171], v[204:207]
M v[208:211], a[64:67], a[168:171], v[208:211]
M v[208:211], a[68:71], a[172:175], v[208:211]
M v[212:215], a[76:79], a[172:175], v[212:215]
buffer_load_dwordx4 v9, s[12:15], s24 offen offset:3072 lds
M v[212:215], a[72:75], a[168:171], v[212:215]
M v[216:219], a[80:83], a[168:171], v[216:219]
M v[216:219], a[84:87], a[172:175], v[216:219]
M v[220:223], a[92:95], a[172:175], v[220:223]
M v[220:223], a[88:91], a[168:171], v[220:223]
s_waitcnt lgkmcnt(10)
M v[224:227], a[32:35], a[176:179], v[224:227]
s_add_u32 s24, s24, 262144
s_cmp_eq_u32 s24, s27
s_cselect_b32 s24, s28, s24
s_sub_u32 s6, s6, 1
s_cmp_eq_u32 s6, 0
s_cselect_b64 s[12:13], s[64:65], s[12:13]
M v[224:227], a[36:39], a[180:183], v[224:227]
M v[228:231], a[44:47], a[180:183], v[228:231]
M v[228:231], a[40:43], a[176:179], v[228:231]
M v[232:235], a[48:51], a[176:179], v[232:235]
M v[232:235], a[52:55], a[180:183], v[232:235]
M v[236:239], a[60:63], a[180:183], v[236:239]
M v[236:239], a[56:59], a[176:179], v[236:239]
s_waitcnt vmcnt(8) lgkmcnt(0)
s_barrier
ds_read_b128 a[160:163], v10 offset:32768
ds_read_b128 a[164:167], v11 offset:32768
M v[240:243], a[64:67], a[176:179], v[240:243]
s_add_u32 m0, s29, 0
s_nop 0
buffer_load_dwordx4 v2, s[8:11], s23 offen offset:0 lds
M v[240:243], a[68:71], a[180:183], v[240:243]
M v[244:247], a[76:79], a[180:183], v[244:247]
M v[244:247], a[72:75], a[176:179], v[244:247]
M v[248:251], a[80:83], a[176:179], v[248:251]
M v[248:251], a[84:87], a[180:183], v[248:251]
buffer_load_dwordx4 v3, s[8:11], s23 offen offset:1024 lds
M v[252:255], a[92:95], a[180:183], v[252:255]
M v[252:255], a[88:91], a[176:179], v[252:255]
M a[0:3], a[32:35], a[184:187], a[0:3]
M a[0:3], a[36:39], a[188:191], a[0:3]
ds_read_b128 a[168:171], v10 offset:34816
ds_read_b128 a[172:175], v11 offset:34816
M a[4:7], a[44:47], a[188:191], a[4:7]
M a[4:7], a[40:43], a[184:187], a[4:7]
M a[8:11], a[48:51], a[184:187], a[8:11]
buffer_load_dwordx4 v4, s[8:11], s23 offen offset:2048 lds
M a[8:11], a[52:55], a[188:191], a[8:11]
M a[12:15], a[60:63], a[188:191], a[12:15]
M a[12:15], a[56:59], a[184:187], a[12:15]
M a[16:19], a[64:67], a[184:187], a[16:19]
M a[16:19], a[68:71], a[188:191], a[16:19]
buffer_load_dwordx4 v5, s[8:11], s23 offen offset:3072 lds
M a[20:23], a[76:79], a[188:191], a[20:23]
M a[20:23], a[72:75], a[184:187], a[20:23]
M a[24:27], a[80:83], a[184:187], a[24:27]
M a[24:27], a[84:87], a[188:191], a[24:27]
M a[28:31], a[92:95], a[188:191], a[28:31]
M a[28:31], a[88:91], a[184:187], a[28:31]
s_waitcnt lgkmcnt(2)
M v[32:35], a[96:99], a[160:163], v[32:35]
s_add_u32 m0, s29, 98304
s_nop 0
buffer_load_dwordx4 v6, s[12:15], s24 offen offset:0 lds
M v[32:35], a[100:103], a[164:167], v[32:35]
ds_read_b128 a[176:179], v10 offset:36864
ds_read_b128 a[180:183], v11 offset:36864
M v[36:39], a[108:111], a[164:167], v[36:39]
M v[36:39], a[104:107], a[160:163], v[36:39]
ds_read_b64_tr_b16 a[32:33], v12 offset:0
ds_read_b64_tr_b16 a[34:35], v12 offset:2048
M v[40:43], a[112:115], a[160:163], v[40:43]
M v[40:43], a[116:119], a[164:167], v[40:43]
M v[44:47], a[124:127], a[164:167], v[44:47]
M v[44:47], a[120:123], a[160:163], v[44:47]
ds_read_b64_tr_b16 a[40:41], v13 offset:0
ds_read_b64_tr_b16 a[42:43], v13 offset:2048
M v[48:51], a[128:131], a[160:163], v[48:51]
buffer_load_dwordx4 v7, s[12:15], s24 offen offset:1024 lds
M v[48:51], a[132:135], a[164:167], v[48:51]
M v[52:55], a[140:143], a[164:167], v[52:55]
M v[52:55], a[136:139], a[160:163], v[52:55]
ds_read_b64_tr_b16 a[48:49], v14 offset:0
ds_read_b64_tr_b16 a[50:51], v14 offset:2048
M v[56:59], a[144:147], a[160:163], v[56:59]
M v[56:59], a[148:151], a[164:167], v[56:59]
M v[60:63], a[156:159], a[164:167], v[60:63]
buffer_load_dwordx4 v8, s[12:15], s24 offen offset:2048 lds
M v[60:63], a[152:155], a[160:163], v[60:63]
s_waitcnt lgkmcnt(8)
ds_read_b64_tr_b16 a[56:57], v15 offset:0
ds_read_b64_tr_b16 a[58:59], v15 offset:2048
M v[64:67], a[96:99], a[168:171], v[64:67]
M v[64:67], a[100:103], a[172:175], v[64:67]
ds_read_b128 a[184:187], v10 offset:38912
ds_read_b128 a[188:191], v11 offset:38912
M v[68:71], a[108:111], a[172:175], v[68:71]
M v[68:71], a[104:107], a[168:171], v[68:71]
ds_read_b64_tr_b16 a[64:65], v16 offset:0
ds_read_b64_tr_b16 a[66:67], v16 offset:2048
M v[72:75], a[112:115], a[168:171], v[72:75]
M v[72:75], a[116:119], a[172:175], v[72:75]
M v[76:79], a[124:127], a[172:175], v[76:79]
M v[76:79], a[120:123], a[168:171], v[76:79]
ds_read_b64_tr_b16 a[72:73], v17 offset:0
ds_read_b64_tr_b16 a[74:75], v17 offset:2048
M v[80:83], a[128:131], a[168:171], v[80:83]
buffer_load_dwordx4 v9, s[12:15], s24 offen offset:3072 lds
M v[80:83], a[132:135], a[172:175], v[80:83]
M v[84:87], a[140:143], a[172:175], v[84:87]
M v[84:87], a[136:139], a[168:171], v[84:87]
ds_read_b64_tr_b16 a[80:81], v18 offset:0
ds_read_b64_tr_b16 a[82:83], v18 offset:2048
M v[88:91], a[144:147], a[168:171], v[88:91]
M v[88:91], a[148:151], a[172:175], v[88:91]
M v[92:95], a[156:159], a[172:175], v[92:95]
s_add_u32 s24, s24, 262144
M v[92:95], a[152:155], a[168:171], v[92:95]
s_waitcnt lgkmcnt(15)
ds_read_b64_tr_b16 a[88:89], v19 offset:0
ds_read_b64_tr_b16 a[90:91], v19 offset:2048
M v[96:99], a[96:99], a[176:179], v[96:99]
M v[96:99], a[100:103], a[180:183], v[96:99]
M v[100:103], a[108:111], a[180:183], v[100:103]
M v[100:103], a[104:107], a[176:179], v[100:103]
M v[104:107], a[112:115], a[176:179], v[104:107]
M v[104:107], a[116:119], a[180:183], v[104:107]
M v[108:111], a[124:127], a[180:183], v[108:111]
M v[108:111], a[120:123], a[176:179], v[108:111]
s_waitcnt vmcnt(8) lgkmcnt(0)
s_barrier
ds_read_b128 a[160:163], v10 offset:49152
ds_read_b128 a[164:167], v11 offset:49152
M v[112:115], a[128:131], a[176:179], v[112:115]
s_add_u32 m0, s29, 16384
s_add_u32 s3, s23, s31
buffer_load_dwordx4 v2, s[8:11], s3 offen offset:0 lds
M v[112:115], a[132:135], a[180:183], v[112:115]
M v[116:119], a[140:143], a[180:183], v[116:119]
M v[116:119], a[136:139], a[176:179], v[116:119]
ds_read_b64_tr_b16 a[36:37], v12 offset:16384
ds_read_b64_tr_b16 a[38:39], v12 offset:18432
M v[120:123], a[144:147], a[176:179], v[120:123]
M v[120:123], a[148:151], a[180:183], v[120:123]
buffer_load_dwordx4 v3, s[8:11], s3 offen offset:1024 lds
M v[124:127], a[156:159], a[180:183], v[124:127]
M v[124:127], a[152:155], a[176:179], v[124:127]
M v[128:131], a[96:99], a[184:187], v[128:131]
M v[128:131], a[100:103], a[188:191], v[128:131]
ds_read_b128 a[168:171], v10 offset:51200
ds_read_b128 a[172:175], v11 offset:51200
ds_read_b64_tr_b16 a[44:45], v13 offset:16384
ds_read_b64_tr_b16 a[46:47], v13 offset:18432
M v[132:135], a[108:111], a[188:191], v[132:135]
M v[132:135], a[104:107], a[184:187], v[132:135]
M v[136:139], a[112:115], a[184:187], v[136:139]
buffer_load_dwordx4 v4, s[8:11], s3 offen offset:2048 lds
M v[136:139], a[116:119], a[188:191], v[136:139]
M v[140:143], a[124:127], a[188:191], v[140:143]
M v[140:143], a[120:123], a[184:187], v[140:143]
ds_read_b64_tr_b16 a[52:53], v14 offset:16384
ds_read_b64_tr_b16 a[54:55], v14 offset:18432
M v[144:147], a[128:131], a[184:187], v[144:147]
M v[144:147], a[132:135], a[188:191], v[144:147]
M v[148:151], a[140:143], a[188:191], v[148:151]
buffer_load_dwordx4 v5, s[8:11], s3 offen offset:3072 lds
M v[148:151], a[136:139], a[184:187], v[148:151]
M v[152:155], a[144:147], a[184:187], v[152:155]
M v[152:155], a[148:151], a[188:191], v[152:155]
ds_read_b64_tr_b16 a[60:61], v15 offset:16384
ds_read_b64_tr_b16 a[62:63], v15 offset:18432
M v[156:159], a[156:159], a[188:191], v[156:159]
M v[156:159], a[152:155], a[184:187], v[156:159]
s_waitcnt lgkmcnt(10)
M v[160:163], a[96:99], a[160:163], v[160:163]
M v[160:163], a[100:103], a[164:167], v[160:163]
ds_read_b128 a[176:179], v10 offset:53248
ds_read_b128 a[180:183], v11 offset:53248
M v[164:167], a[108:111], a[164:167], v[164:167]
s_add_u32 s23, s23, 128
s_cmp_eq_u32 s23, s25
s_cselect_b32 s23, s26, s23
M v[164:167], a[104:107], a[160:163], v[164:167]
ds_read_b64_tr_b16 a[68:69], v16 offset:16384
ds_read_b64_tr_b16 a[70:71], v16 offset:18432
M v[168:171], a[112:115], a[160:163], v[168:171]
M v[168:171], a[116:119], a[164:167], v[168:171]
M v[172:175], a[124:127], a[164:167], v[172:175]
M v[172:175], a[120:123], a[160:163], v[172:175]
M v[176:179], a[128:131], a[160:163], v[176:179]
s_add_u32 m0, s29, 114688
s_nop 0
buffer_load_dwordx4 v6, s[12:15], s24 offen offset:0 lds
M v[176:179], a[132:135], a[164:167], v[176:179]
ds_read_b64_tr_b16 a[76:77], v17 offset:16384
ds_read_b64_tr_b16 a[78:79], v17 offset:18432
M v[180:183], a[140:143], a[164:167], v[180:183]
M v[180:183], a[136:139], a[160:163], v[180:183]
M v[184:187], a[144:147], a[160:163], v[184:187]
M v[184:187], a[148:151], a[164:167], v[184:187]
buffer_load_dwordx4 v7, s[12:15], s24 offen offset:1024 lds
M v[188:191], a[156:159], a[164:167], v[188:191]
M v[188:191], a[152:155], a[160:163], v[188:191]
s_waitcnt lgkmcnt(12)
ds_read_b64_tr_b16 a[84:85], v18 offset:16384
ds_read_b64_tr_b16 a[86:87], v18 offset:18432
M v[192:195], a[96:99], a[168:171], v[192:195]
M v[192:195], a[100:103], a[172:175], v[192:195]
ds_read_b128 a[184:187], v10 offset:55296
ds_read_b128 a[188:191], v11 offset:55296
M v[196:199], a[108:111], a[172:175], v[196:199]
M v[196:199], a[104:107], a[168:171], v[196:199]
M v[200:203], a[112:115], a[168:171], v[200:203]
buffer_load_dwordx4 v8, s[12:15], s24 offen offset:2048 lds
M v[200:203], a[116:119], a[172:175], v[200:203]
ds_read_b64_tr_b16 a[92:93], v19 offset:16384
ds_read_b64_tr_b16 a[94:95], v19 offset:18432
M v[204:207], a[124:127], a[172:175], v[204:207]
M v[204:207], a[120:123], a[168:171], v[204:207]
M v[208:211], a[128:131], a[168:171], v[208:211]
M v[208:211], a[132:135], a[172:175], v[208:211]
M v[212:215], a[140:143], a[172:175], v[212:215]
buffer_load_dwordx4 v9, s[12:15], s24 offen offset:3072 lds
M v[212:215], a[136:139], a[168:171], v[212:215]
M v[216:219], a[144:147], a[168:171], v[216:219]
M v[216:219], a[148:151], a[172:175], v[216:219]
M v[220:223], a[156:159], a[172:175], v[220:223]
M v[220:223], a[152:155], a[168:171], v[220:223]
s_waitcnt lgkmcnt(10)
M v[224:227], a[96:99], a[176:179], v[224:227]
s_add_u32 s24, s24, 262144
s_cmp_eq_u32 s24, s27
s_cselect_b32 s24, s28, s24
s_sub_u32 s6, s6, 1
s_cmp_eq_u32 s6, 0
s_cselect_b64 s[12:13], s[64:65], s[12:13]
M v[224:227], a[100:103], a[180:183], v[224:227]
M v[228:231], a[108:111], a[180:183], v[228:231]
M v[228:231], a[104:107], a[176:179], v[228:231]
M v[232:235], a[112:115], a[176:179], v[232:235]
M v[232:235], a[116:119], a[180:183], v[232:235]
M v[236:239], a[124:127], a[180:183], v[236:239]
M v[236:239], a[120:123], a[176:179], v[236:239]
s_waitcnt vmcnt(8) lgkmcnt(0)
s_barrier
ds_read_b128 a[160:163], v10 offset:0
ds_read_b128 a[164:167], v11 offset:0
M v[240:243], a[128:131], a[176:179], v[240:243]
s_add_u32 m0, s29, 32768
s_nop 0
buffer_load_dwordx4 v2, s[8:11], s23 offen offset:0 lds
M v[240:243], a[132:135], a[180:183], v[240:243]
M v[244:247], a[140:143], a[180:183], v[244:247]
M v[244:247], a[136:139], a[176:179], v[244:247]
M v[248:251], a[144:147], a[176:179], v[248:251]
M v[248:251], a[148:151], a[180:183], v[248:251]
M v[252:255], a[156:159], a[180:183], v[252:255]
M v[252:255], a[152:155], a[176:179], v[252:255]
M a[0:3], a[96:99], a[184:187], a[0:3]
M a[0:3], a[100:103], a[188:191], a[0:3]
ds_read_b128 a[168:171], v10 offset:2048
ds_read_b128 a[172:175], v11 offset:2048
M a[4:7], a[108:111], a[188:191], a[4:7]
M a[4:7], a[104:107], a[184:187], a[4:7]
M a[8:11], a[112:115], a[184:187], a[8:11]
buffer_load_dwordx4 v3, s[8:11], s23 offen offset:1024 lds
M a[8:11], a[116:119], a[188:191], a[8:11]
M a[12:15], a[124:127], a[188:191], a[12:15]
M a[12:15], a[120:123], a[184:187], a[12:15]
M a[16:19], a[128:131], a[184:187], a[16:19]
M a[16:19], a[132:135], a[188:191], a[16:19]
M a[20:23], a[140:143], a[188:191], a[20:23]
M a[20:23], a[136:139], a[184:187], a[20:23]
M a[24:27], a[144:147], a[184:187], a[24:27]
M a[24:27], a[148:151], a[188:191], a[24:27]
M a[28:31], a[156:159], a[188:191], a[28:31]
M a[28:31], a[152:155], a[184:187], a[28:31]
s_waitcnt lgkmcnt(2)
M v[32:35], a[32:35], a[160:163], v[32:35]
buffer_load_dwordx4 v4, s[8:11], s23 offen offset:2048 lds
M v[32:35], a[36:39], a[164:167], v[32:35]
ds_read_b128 a[176:179], v10 offset:4096
ds_read_b128 a[180:183], v11 offset:4096
M v[36:39], a[44:47], a[164:167], v[36:39]
M v[36:39], a[40:43], a[160:163], v[36:39]
ds_read_b64_tr_b16 a[96:97], v12 offset:32768
ds_read_b64_tr_b16 a[98:99], v12 offset:34816
M v[40:43], a[48:51], a[160:163], v[40:43]
M v[40:43], a[52:55], a[164:167], v[40:43]
M v[44:47], a[60:63], a[164:167], v[44:47]
M v[44:47], a[56:59], a[160:163], v[44:47]
ds_read_b64_tr_b16 a[104:105], v13 offset:32768
ds_read_b64_tr_b16 a[106:107], v13 offset:34816
M v[48:51], a[64:67], a[160:163], v[48:51]
M v[48:51], a[68:71], a[164:167], v[48:51]
M v[52:55], a[76:79], a[164:167], v[52:55]
M v[52:55], a[72:75], a[160:163], v[52:55]
ds_read_b64_tr_b16 a[112:113], v14 offset:32768
ds_read_b64_tr_b16 a[114:115], v14 offset:34816
M v[56:59], a[80:83], a[160:163], v[56:59]
M v[56:59], a[84:87], a[164:167], v[56:59]
M v[60:63], a[92:95], a[164:167], v[60:63]
M v[60:63], a[88:91], a[160:163], v[60:63]
s_waitcnt lgkmcnt(8)
ds_read_b64_tr_b16 a[120:121], v15 offset:32768
ds_read_b64_tr_b16 a[122:123], v15 offset:34816
M v[64:67], a[32:35], a[168:171], v[64:67]
M v[64:67], a[36:39], a[172:175], v[64:67]
ds_read_b128 a[184:187], v10 offset:6144
ds_read_b128 a[188:191], v11 offset:6144
M v[68:71], a[44:47], a[172:175], v[68:71]
M v[68:71], a[40:43], a[168:171], v[68:71]
ds_read_b64_tr_b16 a[128:129], v16 offset:32768
ds_read_b64_tr_b16 a[130:131], v16 offset:34816
M v[72:75], a[48:51], a[168:171], v[72:75]
buffer_load_dwordx4 v5, s[8:11], s23 offen offset:3072 lds
M v[72:75], a[52:55], a[172:175], v[72:75]
M v[76:79], a[60:63], a[172:175], v[76:79]
M v[76:79], a[56:59], a[168:171], v[76:79]
ds_read_b64_tr_b16 a[136:137], v17 offset:32768
ds_read_b64_tr_b16 a[138:139], v17 offset:34816
M v[80:83], a[64:67], a[168:171], v[80:83]
M v[80:83], a[68:71], a[172:175], v[80:83]
M v[84:87], a[76:79], a[172:175], v[84:87]
M v[84:87], a[72:75], a[168:171], v[84:87]
ds_read_b64_tr_b16 a[144:145], v18 offset:32768
ds_read_b64_tr_b16 a[146:147], v18 offset:34816
M v[88:91], a[80:83], a[168:171], v[88:91]
M v[88:91], a[84:87], a[172:175], v[88:91]
M v[92:95], a[92:95], a[172:175], v[92:95]
M v[92:95], a[88:91], a[168:171], v[92:95]
s_waitcnt lgkmcnt(15)
ds_read_b64_tr_b16 a[152:153], v19 offset:32768
ds_read_b64_tr_b16 a[154:155], v19 offset:34816
M v[96:99], a[32:35], a[176:179], v[96:99]
M v[96:99], a[36:39], a[180:183], v[96:99]
M v[100:103], a[44:47], a[180:183], v[100:103]
M v[100:103], a[40:43], a[176:179], v[100:103]
M v[104:107], a[48:51], a[176:179], v[104:107]
M v[104:107], a[52:55], a[180:183], v[104:107]
M v[108:111], a[60:63], a[180:183], v[108:111]
M v[108:111], a[56:59], a[176:179], v[108:111]
s_waitcnt vmcnt(4) lgkmcnt(0)
s_barrier
ds_read_b128 a[160:163], v10 offset:16384
ds_read_b128 a[164:167], v11 offset:16384
M v[112:115], a[64:67], a[176:179], v[112:115]
s_add_u32 m0, s29, 49152
s_add_u32 s3, s23, s31
buffer_load_dwordx4 v2, s[8:11], s3 offen offset:0 lds
M v[112:115], a[68:71], a[180:183], v[112:115]
M v[116:119], a[76:79], a[180:183], v[116:119]
buffer_load_dwordx4 v3, s[8:11], s3 offen offset:1024 lds
M v[116:119], a[72:75], a[176:179], v[116:119]
ds_read_b64_tr_b16 a[100:101], v12 offset:49152
ds_read_b64_tr_b16 a[102:103], v12 offset:51200
M v[120:123], a[80:83], a[176:179], v[120:123]
buffer_load_dwordx4 v4, s[8:11], s3 offen offset:2048 lds
M v[120:123], a[84:87], a[180:183], v[120:123]
M v[124:127], a[92:95], a[180:183], v[124:127]
buffer_load_dwordx4 v5, s[8:11], s3 offen offset:3072 lds
M v[124:127], a[88:91], a[176:179], v[124:127]
M v[128:131], a[32:35], a[184:187], v[128:131]
M v[128:131], a[36:39], a[188:191], v[128:131]
ds_read_b128 a[168:171], v10 offset:18432
ds_read_b128 a[172:175], v11 offset:18432
ds_read_b64_tr_b16 a[108:109], v13 offset:49152
ds_read_b64_tr_b16 a[110:111], v13 offset:51200
M v[132:135], a[44:47], a[188:191], v[132:135]
M v[132:135], a[40:43], a[184:187], v[132:135]
M v[136:139], a[48:51], a[184:187], v[136:139]
s_and_b32 s3, s2, 1
s_lshl_b32 s3, s3, 3
s_bfe_u32 s4, s2, 0x30003
s_add_u32 s26, s3, s4
M v[136:139], a[52:55], a[188:191], v[136:139]
s_bfe_u32 s3, s2, 0x20001
s_lshl_b32 s3, s3, 2
s_lshr_b32 s4, s2, 6
M v[140:143], a[60:63], a[188:191], v[140:143]
s_xor_b32 s4, s4, 2
s_add_u32 s27, s3, s4
s_lshl_b32 s23, s26, 18
M v[140:143], a[56:59], a[184:187], v[140:143]
ds_read_b64_tr_b16 a[116:117], v14 offset:49152
ds_read_b64_tr_b16 a[118:119], v14 offset:51200
s_sub_u32 s24, s23, 32768
s_max_i32 s24, s24, 0
s_lshl_b32 s25, s27, 7
M v[144:147], a[64:67], a[184:187], v[144:147]
s_mov_b64 s[8:9], s[44:45]
s_mov_b32 s10, 4194304
s_mov_b64 s[12:13], s[46:47]
M v[144:147], a[68:71], a[188:191], v[144:147]
s_mov_b32 s14, 6291456
s_mov_b64 s[36:37], s[90:91]
s_mov_b32 s38, 256
M v[148:151], a[76:79], a[188:191], v[148:151]
s_mov_b32 s39, 0x00020000
s_lshl_b32 s28, s20, 9
s_mul_i32 s30, s20, 6144
M v[148:151], a[72:75], a[184:187], v[148:151]
s_lshl_b32 s3, s20, 5
v_lshrrev_b32 v24, 3, v0
v_and_b32 v25, 7, v0
M v[152:155], a[80:83], a[184:187], v[152:155]
v_add_u32 v28, s3, v24
v_add_u32 v26, 0, v28
v_bfe_u32 v27, v26, 1, 3
M v[152:155], a[84:87], a[188:191], v[152:155]
ds_read_b64_tr_b16 a[124:125], v15 offset:49152
ds_read_b64_tr_b16 a[126:127], v15 offset:51200
v_xor_b32 v27, v27, v25
v_lshlrev_b32 v26, 11, v26
v_lshl_add_u32 v26, v27, 4, v26
M v[156:159], a[92:95], a[188:191], v[156:159]
v_subrev_u32 v2, 0, v26
v_add_u32 v26, 8, v28
v_bfe_u32 v27, v26, 1, 3
M v[156:159], a[88:91], a[184:187], v[156:159]
s_waitcnt lgkmcnt(10)
v_xor_b32 v27, v27, v25
v_lshlrev_b32 v26, 11, v26
v_lshl_add_u32 v26, v27, 4, v26
M v[160:163], a[32:35], a[160:163], v[160:163]
v_subrev_u32 v3, 1024, v26
v_add_u32 v26, 16, v28
v_bfe_u32 v27, v26, 1, 3
M v[160:163], a[36:39], a[164:167], v[160:163]
ds_read_b128 a[176:179], v10 offset:20480
ds_read_b128 a[180:183], v11 offset:20480
v_xor_b32 v27, v27, v25
v_lshlrev_b32 v26, 11, v26
v_lshl_add_u32 v26, v27, 4, v26
M v[164:167], a[44:47], a[164:167], v[164:167]
v_subrev_u32 v4, 2048, v26
v_add_u32 v26, 24, v28
v_bfe_u32 v27, v26, 1, 3
M v[164:167], a[40:43], a[160:163], v[164:167]
ds_read_b64_tr_b16 a[132:133], v16 offset:49152
ds_read_b64_tr_b16 a[134:135], v16 offset:51200
v_xor_b32 v27, v27, v25
v_lshlrev_b32 v26, 11, v26
v_lshl_add_u32 v26, v27, 4, v26
M v[168:171], a[48:51], a[160:163], v[168:171]
v_subrev_u32 v5, 3072, v26
s_lshl_b32 s3, s20, 2
v_lshrrev_b32 v26, 5, v0
M v[168:171], a[52:55], a[164:167], v[168:171]
v_add_u32 v26, s3, v26
v_bfe_u32 v29, v0, 2, 3
v_bfe_u32 v27, v26, 1, 3
M v[172:175], a[60:63], a[164:167], v[172:175]
v_xor_b32 v27, v27, v29
v_lshlrev_b32 v27, 4, v27
v_and_b32 v30, 3, v0
M v[172:175], a[56:59], a[160:163], v[172:175]
v_lshl_add_u32 v27, v30, 2, v27
v_lshl_add_u32 v20, v26, 11, v27
v_add_u32 v26, 2, v26
M v[176:179], a[64:67], a[160:163], v[176:179]
v_bfe_u32 v27, v26, 1, 3
v_xor_b32 v27, v27, v29
v_lshlrev_b32 v27, 4, v27
M v[176:179], a[68:71], a[164:167], v[176:179]
ds_read_b64_tr_b16 a[140:141], v17 offset:49152
ds_read_b64_tr_b16 a[142:143], v17 offset:51200
v_and_b32 v30, 3, v0
v_lshl_add_u32 v27, v30, 2, v27
v_lshl_add_u32 v23, v26, 11, v27
M v[180:183], a[76:79], a[164:167], v[180:183]
v_subrev_u32 v23, 256, v23
s_mul_i32 s3, s20, 48
v_add_u32 v28, s3, v24
M v[180:183], a[72:75], a[160:163], v[180:183]
v_add_u32 v26, 0, v28
v_mul_u32_u24 v27, 0xaaab, v26
v_lshrrev_b32 v27, 17, v27
M v[184:187], a[80:83], a[160:163], v[184:187]
v_lshrrev_b32 v29, 1, v27
v_and_b32 v29, 4, v29
v_and_or_b32 v27, v27, 2, v29
M v[184:187], a[84:87], a[164:167], v[184:187]
v_xor_b32 v27, v27, v25
v_lshlrev_b32 v26, 11, v26
v_lshl_add_u32 v26, v27, 4, v26
M v[188:191], a[92:95], a[164:167], v[188:191]
v_subrev_u32 v6, 0, v26
v_add_u32 v26, 8, v28
v_mul_u32_u24 v27, 0xaaab, v26
M v[188:191], a[88:91], a[160:163], v[188:191]
s_waitcnt lgkmcnt(12)
ds_read_b64_tr_b16 a[148:149], v18 offset:49152
ds_read_b64_tr_b16 a[150:151], v18 offset:51200
v_lshrrev_b32 v27, 17, v27
v_lshrrev_b32 v29, 1, v27
v_and_b32 v29, 4, v29
M v[192:195], a[32:35], a[168:171], v[192:195]
v_and_or_b32 v27, v27, 2, v29
v_xor_b32 v27, v27, v25
v_lshlrev_b32 v26, 11, v26
M v[192:195], a[36:39], a[172:175], v[192:195]
ds_read_b128 a[184:187], v10 offset:22528
ds_read_b128 a[188:191], v11 offset:22528
v_lshl_add_u32 v26, v27, 4, v26
v_subrev_u32 v7, 1024, v26
v_add_u32 v26, 16, v28
M v[196:199], a[44:47], a[172:175], v[196:199]
v_mul_u32_u24 v27, 0xaaab, v26
v_lshrrev_b32 v27, 17, v27
v_lshrrev_b32 v29, 1, v27
M v[196:199], a[40:43], a[168:171], v[196:199]
v_and_b32 v29, 4, v29
v_and_or_b32 v27, v27, 2, v29
v_xor_b32 v27, v27, v25
M v[200:203], a[48:51], a[168:171], v[200:203]
v_lshlrev_b32 v26, 11, v26
v_lshl_add_u32 v26, v27, 4, v26
v_subrev_u32 v8, 2048, v26
M v[200:203], a[52:55], a[172:175], v[200:203]
ds_read_b64_tr_b16 a[156:157], v19 offset:49152
ds_read_b64_tr_b16 a[158:159], v19 offset:51200
v_add_u32 v26, 24, v28
v_mul_u32_u24 v27, 0xaaab, v26
v_lshrrev_b32 v27, 17, v27
M v[204:207], a[60:63], a[172:175], v[204:207]
v_lshrrev_b32 v29, 1, v27
v_and_b32 v29, 4, v29
v_and_or_b32 v27, v27, 2, v29
M v[204:207], a[56:59], a[168:171], v[204:207]
v_xor_b32 v27, v27, v25
v_lshlrev_b32 v26, 11, v26
v_lshl_add_u32 v26, v27, 4, v26
M v[208:211], a[64:67], a[168:171], v[208:211]
v_subrev_u32 v9, 3072, v26
v_add_u32 v26, 32, v28
v_mul_u32_u24 v27, 0xaaab, v26
M v[208:211], a[68:71], a[172:175], v[208:211]
v_lshrrev_b32 v27, 17, v27
v_lshrrev_b32 v29, 1, v27
v_and_b32 v29, 4, v29
M v[212:215], a[76:79], a[172:175], v[212:215]
v_and_or_b32 v27, v27, 2, v29
v_xor_b32 v27, v27, v25
v_lshlrev_b32 v26, 11, v26
M v[212:215], a[72:75], a[168:171], v[212:215]
v_lshl_add_u32 v26, v27, 4, v26
v_subrev_u32 v21, 0, v26
v_add_u32 v26, 40, v28
M v[216:219], a[80:83], a[168:171], v[216:219]
v_mul_u32_u24 v27, 0xaaab, v26
v_lshrrev_b32 v27, 17, v27
v_lshrrev_b32 v29, 1, v27
M v[216:219], a[84:87], a[172:175], v[216:219]
v_and_b32 v29, 4, v29
v_and_or_b32 v27, v27, 2, v29
v_xor_b32 v27, v27, v25
M v[220:223], a[92:95], a[172:175], v[220:223]
v_lshlrev_b32 v26, 11, v26
v_lshl_add_u32 v26, v27, 4, v26
v_subrev_u32 v22, 1024, v26
M v[220:223], a[88:91], a[168:171], v[220:223]
s_waitcnt lgkmcnt(10)
s_lshr_b32 s3, s53, 7
s_add_u32 s3, s3, s22
s_lshl_b32 s3, s3, 5
M v[224:227], a[32:35], a[176:179], v[224:227]
s_lshr_b32 s19, s52, 6
s_add_u32 s3, s3, s19
s_lshl_b32 s19, s21, 1
M v[224:227], a[36:39], a[180:183], v[224:227]
s_add_u32 s3, s3, s19
s_lshl_b32 s92, s3, 14
s_add_u32 s93, s92, 16384
M v[228:231], a[44:47], a[180:183], v[228:231]
s_add_u32 s16, s50, 0
s_addc_u32 s17, s51, 0
s_mov_b32 s18, 16777216
M v[228:231], a[40:43], a[176:179], v[228:231]
s_mov_b32 s19, 0x00020000
s_mov_b32 s4, 0x3e0293ee
s_mov_b32 s5, 0x3e0293ee
M v[232:235], a[48:51], a[176:179], v[232:235]
M v[232:235], a[52:55], a[180:183], v[232:235]
M v[236:239], a[60:63], a[180:183], v[236:239]
M v[236:239], a[56:59], a[176:179], v[236:239]
s_waitcnt vmcnt(4) lgkmcnt(0)
s_barrier
ds_read_b128 a[160:163], v10 offset:32768
ds_read_b128 a[164:167], v11 offset:32768
M v[240:243], a[64:67], a[176:179], v[240:243]
s_add_u32 m0, s28, 131072
s_nop 0
buffer_load_dword v20, s[8:11], s24 offen lds
M v[240:243], a[68:71], a[180:183], v[240:243]
M v[244:247], a[76:79], a[180:183], v[244:247]
M v[244:247], a[72:75], a[176:179], v[244:247]
M v[248:251], a[80:83], a[176:179], v[248:251]
buffer_load_dword v23, s[8:11], s24 offen offset:256 lds
s_add_u32 s24, s24, 128
M v[248:251], a[84:87], a[180:183], v[248:251]
M v[252:255], a[92:95], a[180:183], v[252:255]
M v[252:255], a[88:91], a[176:179], v[252:255]
M a[0:3], a[32:35], a[184:187], a[0:3]
M a[0:3], a[36:39], a[188:191], a[0:3]
ds_read_b128 a[168:171], v10 offset:34816
ds_read_b128 a[172:175], v11 offset:34816
M a[4:7], a[44:47], a[188:191], a[4:7]
s_add_u32 m0, s29, 133120
s_nop 0
buffer_load_dwordx4 v2, s[8:11], s23 offen offset:0 lds
M a[4:7], a[40:43], a[184:187], a[4:7]
M a[8:11], a[48:51], a[184:187], a[8:11]
M a[8:11], a[52:55], a[188:191], a[8:11]
M a[12:15], a[60:63], a[188:191], a[12:15]
buffer_load_dwordx4 v3, s[8:11], s23 offen offset:1024 lds
M a[12:15], a[56:59], a[184:187], a[12:15]
M a[16:19], a[64:67], a[184:187], a[16:19]
M a[16:19], a[68:71], a[188:191], a[16:19]
M a[20:23], a[76:79], a[188:191], a[20:23]
buffer_load_dwordx4 v4, s[8:11], s23 offen offset:2048 lds
M a[20:23], a[72:75], a[184:187], a[20:23]
M a[24:27], a[80:83], a[184:187], a[24:27]
M a[24:27], a[84:87], a[188:191], a[24:27]
M a[28:31], a[92:95], a[188:191], a[28:31]
M a[28:31], a[88:91], a[184:187], a[28:31]
s_waitcnt lgkmcnt(2)
M v[32:35], a[96:99], a[160:163], v[32:35]
buffer_load_dwordx4 v5, s[8:11], s23 offen offset:3072 lds
s_add_u32 s23, s23, 128
M v[32:35], a[100:103], a[164:167], v[32:35]
ds_read_b128 a[176:179], v10 offset:36864
ds_read_b128 a[180:183], v11 offset:36864
M v[36:39], a[108:111], a[164:167], v[36:39]
M v[36:39], a[104:107], a[160:163], v[36:39]
M v[40:43], a[112:115], a[160:163], v[40:43]
M v[40:43], a[116:119], a[164:167], v[40:43]
s_add_u32 m0, s30, 65536
s_nop 0
buffer_load_dwordx4 v6, s[12:15], s25 offen offset:0 lds
M v[44:47], a[124:127], a[164:167], v[44:47]
M v[44:47], a[120:123], a[160:163], v[44:47]
M v[48:51], a[128:131], a[160:163], v[48:51]
M v[48:51], a[132:135], a[164:167], v[48:51]
M v[52:55], a[140:143], a[164:167], v[52:55]
buffer_load_dwordx4 v7, s[12:15], s25 offen offset:1024 lds
M v[52:55], a[136:139], a[160:163], v[52:55]
M v[56:59], a[144:147], a[160:163], v[56:59]
M v[56:59], a[148:151], a[164:167], v[56:59]
M v[60:63], a[156:159], a[164:167], v[60:63]
buffer_load_dwordx4 v8, s[12:15], s25 offen offset:2048 lds
M v[60:63], a[152:155], a[160:163], v[60:63]
s_waitcnt lgkmcnt(2)
M v[64:67], a[96:99], a[168:171], v[64:67]
M v[64:67], a[100:103], a[172:175], v[64:67]
ds_read_b128 a[184:187], v10 offset:38912
ds_read_b128 a[188:191], v11 offset:38912
M v[68:71], a[108:111], a[172:175], v[68:71]
M v[68:71], a[104:107], a[168:171], v[68:71]
v_pk_mul_f32 v[32:33], v[32:33], s[4:5]
v_pk_mul_f32 v[34:35], v[34:35], s[4:5]
v_pk_mul_f32 v[36:37], v[36:37], s[4:5]
M v[72:75], a[112:115], a[168:171], v[72:75]
v_pk_mul_f32 v[38:39], v[38:39], s[4:5]
v_cvt_pk_bf16_f32 v32, v32, v33
M v[72:75], a[116:119], a[172:175], v[72:75]
buffer_load_dwordx4 v9, s[12:15], s25 offen offset:3072 lds
v_cvt_pk_bf16_f32 v33, v34, v35
v_cvt_pk_bf16_f32 v34, v36, v37
M v[76:79], a[124:127], a[172:175], v[76:79]
v_cvt_pk_bf16_f32 v35, v38, v39
v_pk_mul_f32 v[40:41], v[40:41], s[4:5]
v_pk_mul_f32 v[42:43], v[42:43], s[4:5]
M v[76:79], a[120:123], a[168:171], v[76:79]
v_pk_mul_f32 v[44:45], v[44:45], s[4:5]
v_pk_mul_f32 v[46:47], v[46:47], s[4:5]
M v[80:83], a[128:131], a[168:171], v[80:83]
v_cvt_pk_bf16_f32 v40, v40, v41
v_cvt_pk_bf16_f32 v41, v42, v43
M v[80:83], a[132:135], a[172:175], v[80:83]
s_add_u32 m0, s30, 69632
s_nop 0
buffer_load_dwordx4 v21, s[12:15], s25 offen offset:0 lds
v_cvt_pk_bf16_f32 v42, v44, v45
v_cvt_pk_bf16_f32 v43, v46, v47
M v[84:87], a[140:143], a[172:175], v[84:87]
v_pk_mul_f32 v[48:49], v[48:49], s[4:5]
v_pk_mul_f32 v[50:51], v[50:51], s[4:5]
v_pk_mul_f32 v[52:53], v[52:53], s[4:5]
M v[84:87], a[136:139], a[168:171], v[84:87]
v_pk_mul_f32 v[54:55], v[54:55], s[4:5]
v_cvt_pk_bf16_f32 v48, v48, v49
M v[88:91], a[144:147], a[168:171], v[88:91]
v_cvt_pk_bf16_f32 v49, v50, v51
v_cvt_pk_bf16_f32 v50, v52, v53
M v[88:91], a[148:151], a[172:175], v[88:91]
v_cvt_pk_bf16_f32 v51, v54, v55
v_pk_mul_f32 v[56:57], v[56:57], s[4:5]
v_pk_mul_f32 v[58:59], v[58:59], s[4:5]
M v[92:95], a[156:159], a[172:175], v[92:95]
buffer_load_dwordx4 v22, s[12:15], s25 offen offset:1024 lds
s_add_u32 s25, s25, 393216
v_pk_mul_f32 v[60:61], v[60:61], s[4:5]
v_pk_mul_f32 v[62:63], v[62:63], s[4:5]
M v[92:95], a[152:155], a[168:171], v[92:95]
s_waitcnt lgkmcnt(2)
v_cvt_pk_bf16_f32 v56, v56, v57
v_cvt_pk_bf16_f32 v57, v58, v59
M v[96:99], a[96:99], a[176:179], v[96:99]
v_cvt_pk_bf16_f32 v58, v60, v61
v_cvt_pk_bf16_f32 v59, v62, v63
M v[96:99], a[100:103], a[180:183], v[96:99]
M v[100:103], a[108:111], a[180:183], v[100:103]
M v[100:103], a[104:107], a[176:179], v[100:103]
v_pk_mul_f32 v[64:65], v[64:65], s[4:5]
v_pk_mul_f32 v[66:67], v[66:67], s[4:5]
v_pk_mul_f32 v[68:69], v[68:69], s[4:5]
M v[104:107], a[112:115], a[176:179], v[104:107]
s_add_u32 s94, s92, 0
buffer_store_dwordx4 v[32:35], v1, s[16:19], s94 offen offset:0 sc1
v_pk_mul_f32 v[70:71], v[70:71], s[4:5]
v_cvt_pk_bf16_f32 v64, v64, v65
M v[104:107], a[116:119], a[180:183], v[104:107]
v_cvt_pk_bf16_f32 v65, v66, v67
v_cvt_pk_bf16_f32 v66, v68, v69
M v[108:111], a[124:127], a[180:183], v[108:111]
v_cvt_pk_bf16_f32 v67, v70, v71
v_pk_mul_f32 v[72:73], v[72:73], s[4:5]
v_pk_mul_f32 v[74:75], v[74:75], s[4:5]
M v[108:111], a[120:123], a[176:179], v[108:111]
s_waitcnt vmcnt(13) lgkmcnt(0)
s_barrier
ds_read_b128 a[160:163], v10 offset:49152
ds_read_b128 a[164:167], v11 offset:49152
v_pk_mul_f32 v[76:77], v[76:77], s[4:5]
v_pk_mul_f32 v[78:79], v[78:79], s[4:5]
M v[112:115], a[128:131], a[176:179], v[112:115]
s_add_u32 m0, s28, 0
s_nop 0
buffer_load_dword v20, s[8:11], s24 offen lds
v_cvt_pk_bf16_f32 v72, v72, v73
v_cvt_pk_bf16_f32 v73, v74, v75
M v[112:115], a[132:135], a[180:183], v[112:115]
v_cvt_pk_bf16_f32 v74, v76, v77
v_cvt_pk_bf16_f32 v75, v78, v79
M v[116:119], a[140:143], a[180:183], v[116:119]
s_add_u32 s94, s92, 0
buffer_store_dwordx4 v[40:43], v1, s[16:19], s94 offen offset:1024 sc1
v_pk_mul_f32 v[80:81], v[80:81], s[4:5]
v_pk_mul_f32 v[82:83], v[82:83], s[4:5]
v_pk_mul_f32 v[84:85], v[84:85], s[4:5]
M v[116:119], a[136:139], a[176:179], v[116:119]
v_pk_mul_f32 v[86:87], v[86:87], s[4:5]
v_cvt_pk_bf16_f32 v80, v80, v81
M v[120:123], a[144:147], a[176:179], v[120:123]
buffer_load_dword v23, s[8:11], s24 offen offset:256 lds
s_add_u32 s24, s24, 128
v_cvt_pk_bf16_f32 v81, v82, v83
v_cvt_pk_bf16_f32 v82, v84, v85
M v[120:123], a[148:151], a[180:183], v[120:123]
v_cvt_pk_bf16_f32 v83, v86, v87
v_pk_mul_f32 v[88:89], v[88:89], s[4:5]
v_pk_mul_f32 v[90:91], v[90:91], s[4:5]
M v[124:127], a[156:159], a[180:183], v[124:127]
v_pk_mul_f32 v[92:93], v[92:93], s[4:5]
v_pk_mul_f32 v[94:95], v[94:95], s[4:5]
M v[124:127], a[152:155], a[176:179], v[124:127]
v_cvt_pk_bf16_f32 v88, v88, v89
v_cvt_pk_bf16_f32 v89, v90, v91
M v[128:131], a[96:99], a[184:187], v[128:131]
v_cvt_pk_bf16_f32 v90, v92, v93
v_cvt_pk_bf16_f32 v91, v94, v95
M v[128:131], a[100:103], a[188:191], v[128:131]
ds_read_b128 a[168:171], v10 offset:51200
ds_read_b128 a[172:175], v11 offset:51200
M v[132:135], a[108:111], a[188:191], v[132:135]
s_add_u32 s94, s92, 0
buffer_store_dwordx4 v[48:51], v1, s[16:19], s94 offen offset:2048 sc1
M v[132:135], a[104:107], a[184:187], v[132:135]
s_add_u32 m0, s29, 2048
s_nop 0
buffer_load_dwordx4 v2, s[8:11], s23 offen offset:0 lds
v_pk_mul_f32 v[96:97], v[96:97], s[4:5]
v_pk_mul_f32 v[98:99], v[98:99], s[4:5]
v_pk_mul_f32 v[100:101], v[100:101], s[4:5]
M v[136:139], a[112:115], a[184:187], v[136:139]
v_pk_mul_f32 v[102:103], v[102:103], s[4:5]
v_cvt_pk_bf16_f32 v96, v96, v97
M v[136:139], a[116:119], a[188:191], v[136:139]
v_cvt_pk_bf16_f32 v97, v98, v99
v_cvt_pk_bf16_f32 v98, v100, v101
M v[140:143], a[124:127], a[188:191], v[140:143]
v_cvt_pk_bf16_f32 v99, v102, v103
v_pk_mul_f32 v[104:105], v[104:105], s[4:5]
v_pk_mul_f32 v[106:107], v[106:107], s[4:5]
M v[140:143], a[120:123], a[184:187], v[140:143]
buffer_load_dwordx4 v3, s[8:11], s23 offen offset:1024 lds
v_pk_mul_f32 v[108:109], v[108:109], s[4:5]
v_pk_mul_f32 v[110:111], v[110:111], s[4:5]
M v[144:147], a[128:131], a[184:187], v[144:147]
s_add_u32 s94, s92, 0
buffer_store_dwordx4 v[56:59], v1, s[16:19], s94 offen offset:3072 sc1
v_cvt_pk_bf16_f32 v104, v104, v105
v_cvt_pk_bf16_f32 v105, v106, v107
M v[144:147], a[132:135], a[188:191], v[144:147]
v_cvt_pk_bf16_f32 v106, v108, v109
v_cvt_pk_bf16_f32 v107, v110, v111
M v[148:151], a[140:143], a[188:191], v[148:151]
v_pk_mul_f32 v[112:113], v[112:113], s[4:5]
v_pk_mul_f32 v[114:115], v[114:115], s[4:5]
v_pk_mul_f32 v[116:117], v[116:117], s[4:5]
M v[148:151], a[136:139], a[184:187], v[148:151]
v_pk_mul_f32 v[118:119], v[118:119], s[4:5]
v_cvt_pk_bf16_f32 v112, v112, v113
M v[152:155], a[144:147], a[184:187], v[152:155]
buffer_load_dwordx4 v4, s[8:11], s23 offen offset:2048 lds
v_cvt_pk_bf16_f32 v113, v114, v115
v_cvt_pk_bf16_f32 v114, v116, v117
M v[152:155], a[148:151], a[188:191], v[152:155]
v_cvt_pk_bf16_f32 v115, v118, v119
v_pk_mul_f32 v[120:121], v[120:121], s[4:5]
v_pk_mul_f32 v[122:123], v[122:123], s[4:5]
M v[156:159], a[156:159], a[188:191], v[156:159]
v_pk_mul_f32 v[124:125], v[124:125], s[4:5]
v_pk_mul_f32 v[126:127], v[126:127], s[4:5]
M v[156:159], a[152:155], a[184:187], v[156:159]
s_add_u32 s94, s92, 4096
buffer_store_dwordx4 v[64:67], v1, s[16:19], s94 offen offset:0 sc1
s_waitcnt lgkmcnt(2)
v_cvt_pk_bf16_f32 v120, v120, v121
v_cvt_pk_bf16_f32 v121, v122, v123
M v[160:163], a[96:99], a[160:163], v[160:163]
v_cvt_pk_bf16_f32 v122, v124, v125
v_cvt_pk_bf16_f32 v123, v126, v127
M v[160:163], a[100:103], a[164:167], v[160:163]
ds_read_b128 a[176:179], v10 offset:53248
ds_read_b128 a[180:183], v11 offset:53248
M v[164:167], a[108:111], a[164:167], v[164:167]
buffer_load_dwordx4 v5, s[8:11], s23 offen offset:3072 lds
s_add_u32 s23, s23, 128
M v[164:167], a[104:107], a[160:163], v[164:167]
v_pk_mul_f32 v[128:129], v[128:129], s[4:5]
v_pk_mul_f32 v[130:131], v[130:131], s[4:5]
v_pk_mul_f32 v[132:133], v[132:133], s[4:5]
M v[168:171], a[112:115], a[160:163], v[168:171]
v_pk_mul_f32 v[134:135], v[134:135], s[4:5]
v_cvt_pk_bf16_f32 v128, v128, v129
M v[168:171], a[116:119], a[164:167], v[168:171]
s_add_u32 s94, s92, 4096
buffer_store_dwordx4 v[72:75], v1, s[16:19], s94 offen offset:1024 sc1
v_cvt_pk_bf16_f32 v129, v130, v131
v_cvt_pk_bf16_f32 v130, v132, v133
M v[172:175], a[124:127], a[164:167], v[172:175]
v_cvt_pk_bf16_f32 v131, v134, v135
v_pk_mul_f32 v[136:137], v[136:137], s[4:5]
v_pk_mul_f32 v[138:139], v[138:139], s[4:5]
M v[172:175], a[120:123], a[160:163], v[172:175]
s_add_u32 m0, s30, 98304
s_nop 0
buffer_load_dwordx4 v6, s[12:15], s25 offen offset:0 lds
v_pk_mul_f32 v[140:141], v[140:141], s[4:5]
v_pk_mul_f32 v[142:143], v[142:143], s[4:5]
M v[176:179], a[128:131], a[160:163], v[176:179]
v_cvt_pk_bf16_f32 v136, v136, v137
v_cvt_pk_bf16_f32 v137, v138, v139
M v[176:179], a[132:135], a[164:167], v[176:179]
v_cvt_pk_bf16_f32 v138, v140, v141
v_cvt_pk_bf16_f32 v139, v142, v143
M v[180:183], a[140:143], a[164:167], v[180:183]
buffer_load_dwordx4 v7, s[12:15], s25 offen offset:1024 lds
v_pk_mul_f32 v[144:145], v[144:145], s[4:5]
v_pk_mul_f32 v[146:147], v[146:147], s[4:5]
v_pk_mul_f32 v[148:149], v[148:149], s[4:5]
M v[180:183], a[136:139], a[160:163], v[180:183]
v_pk_mul_f32 v[150:151], v[150:151], s[4:5]
v_cvt_pk_bf16_f32 v144, v144, v145
M v[184:187], a[144:147], a[160:163], v[184:187]
s_add_u32 s94, s92, 4096
buffer_store_dwordx4 v[80:83], v1, s[16:19], s94 offen offset:2048 sc1
v_cvt_pk_bf16_f32 v145, v146, v147
v_cvt_pk_bf16_f32 v146, v148, v149
M v[184:187], a[148:151], a[164:167], v[184:187]
v_cvt_pk_bf16_f32 v147, v150, v151
v_pk_mul_f32 v[152:153], v[152:153], s[4:5]
v_pk_mul_f32 v[154:155], v[154:155], s[4:5]
M v[188:191], a[156:159], a[164:167], v[188:191]
v_pk_mul_f32 v[156:157], v[156:157], s[4:5]
v_pk_mul_f32 v[158:159], v[158:159], s[4:5]
M v[188:191], a[152:155], a[160:163], v[188:191]
s_waitcnt lgkmcnt(2)
v_cvt_pk_bf16_f32 v152, v152, v153
v_cvt_pk_bf16_f32 v153, v154, v155
M v[192:195], a[96:99], a[168:171], v[192:195]
buffer_load_dwordx4 v8, s[12:15], s25 offen offset:2048 lds
v_cvt_pk_bf16_f32 v154, v156, v157
v_cvt_pk_bf16_f32 v155, v158, v159
M v[192:195], a[100:103], a[172:175], v[192:195]
ds_read_b128 a[184:187], v10 offset:55296
ds_read_b128 a[188:191], v11 offset:55296
M v[196:199], a[108:111], a[172:175], v[196:199]
M v[196:199], a[104:107], a[168:171], v[196:199]
s_add_u32 s94, s92, 4096
buffer_store_dwordx4 v[88:91], v1, s[16:19], s94 offen offset:3072 sc1
v_pk_mul_f32 v[160:161], v[160:161], s[4:5]
v_pk_mul_f32 v[162:163], v[162:163], s[4:5]
v_pk_mul_f32 v[164:165], v[164:165], s[4:5]
M v[200:203], a[112:115], a[168:171], v[200:203]
v_pk_mul_f32 v[166:167], v[166:167], s[4:5]
v_cvt_pk_bf16_f32 v160, v160, v161
M v[200:203], a[116:119], a[172:175], v[200:203]
v_cvt_pk_bf16_f32 v161, v162, v163
v_cvt_pk_bf16_f32 v162, v164, v165
M v[204:207], a[124:127], a[172:175], v[204:207]
buffer_load_dwordx4 v9, s[12:15], s25 offen offset:3072 lds
v_cvt_pk_bf16_f32 v163, v166, v167
v_pk_mul_f32 v[168:169], v[168:169], s[4:5]
v_pk_mul_f32 v[170:171], v[170:171], s[4:5]
M v[204:207], a[120:123], a[168:171], v[204:207]
v_pk_mul_f32 v[172:173], v[172:173], s[4:5]
v_pk_mul_f32 v[174:175], v[174:175], s[4:5]
M v[208:211], a[128:131], a[168:171], v[208:211]
v_cvt_pk_bf16_f32 v168, v168, v169
v_cvt_pk_bf16_f32 v169, v170, v171
M v[208:211], a[132:135], a[172:175], v[208:211]
v_cvt_pk_bf16_f32 v170, v172, v173
v_cvt_pk_bf16_f32 v171, v174, v175
M v[212:215], a[140:143], a[172:175], v[212:215]
s_add_u32 s94, s92, 8192
buffer_store_dwordx4 v[96:99], v1, s[16:19], s94 offen offset:0 sc1
v_pk_mul_f32 v[176:177], v[176:177], s[4:5]
v_pk_mul_f32 v[178:179], v[178:179], s[4:5]
v_pk_mul_f32 v[180:181], v[180:181], s[4:5]
M v[212:215], a[136:139], a[168:171], v[212:215]
s_add_u32 m0, s30, 102400
s_nop 0
buffer_load_dwordx4 v21, s[12:15], s25 offen offset:0 lds
v_pk_mul_f32 v[182:183], v[182:183], s[4:5]
v_cvt_pk_bf16_f32 v176, v176, v177
M v[216:219], a[144:147], a[168:171], v[216:219]
v_cvt_pk_bf16_f32 v177, v178, v179
v_cvt_pk_bf16_f32 v178, v180, v181
M v[216:219], a[148:151], a[172:175], v[216:219]
v_cvt_pk_bf16_f32 v179, v182, v183
v_pk_mul_f32 v[184:185], v[184:185], s[4:5]
v_pk_mul_f32 v[186:187], v[186:187], s[4:5]
M v[220:223], a[156:159], a[172:175], v[220:223]
v_pk_mul_f32 v[188:189], v[188:189], s[4:5]
v_pk_mul_f32 v[190:191], v[190:191], s[4:5]
M v[220:223], a[152:155], a[168:171], v[220:223]
s_waitcnt lgkmcnt(2)
v_cvt_pk_bf16_f32 v184, v184, v185
v_cvt_pk_bf16_f32 v185, v186, v187
M v[224:227], a[96:99], a[176:179], v[224:227]
s_add_u32 s94, s92, 8192
buffer_store_dwordx4 v[104:107], v1, s[16:19], s94 offen offset:1024 sc1
v_cvt_pk_bf16_f32 v186, v188, v189
v_cvt_pk_bf16_f32 v187, v190, v191
M v[224:227], a[100:103], a[180:183], v[224:227]
buffer_load_dwordx4 v22, s[12:15], s25 offen offset:1024 lds
s_add_u32 s25, s25, 393216
M v[228:231], a[108:111], a[180:183], v[228:231]
M v[228:231], a[104:107], a[176:179], v[228:231]
v_pk_mul_f32 v[192:193], v[192:193], s[4:5]
v_pk_mul_f32 v[194:195], v[194:195], s[4:5]
v_pk_mul_f32 v[196:197], v[196:197], s[4:5]
M v[232:235], a[112:115], a[176:179], v[232:235]
v_pk_mul_f32 v[198:199], v[198:199], s[4:5]
v_cvt_pk_bf16_f32 v192, v192, v193
M v[232:235], a[116:119], a[180:183], v[232:235]
v_cvt_pk_bf16_f32 v193, v194, v195
v_cvt_pk_bf16_f32 v194, v196, v197
M v[236:239], a[124:127], a[180:183], v[236:239]
v_cvt_pk_bf16_f32 v195, v198, v199
v_pk_mul_f32 v[200:201], v[200:201], s[4:5]
v_pk_mul_f32 v[202:203], v[202:203], s[4:5]
M v[236:239], a[120:123], a[176:179], v[236:239]
s_waitcnt vmcnt(63) lgkmcnt(0)
s_barrier
v_pk_mul_f32 v[204:205], v[204:205], s[4:5]
v_pk_mul_f32 v[206:207], v[206:207], s[4:5]
M v[240:243], a[128:131], a[176:179], v[240:243]
s_add_u32 s94, s92, 8192
buffer_store_dwordx4 v[112:115], v1, s[16:19], s94 offen offset:2048 sc1
v_cvt_pk_bf16_f32 v200, v200, v201
v_cvt_pk_bf16_f32 v201, v202, v203
M v[240:243], a[132:135], a[180:183], v[240:243]
s_add_u32 m0, s28, 18432
s_nop 0
buffer_load_dword v20, s[8:11], s24 offen lds
v_cvt_pk_bf16_f32 v202, v204, v205
v_cvt_pk_bf16_f32 v203, v206, v207
M v[244:247], a[140:143], a[180:183], v[244:247]
v_pk_mul_f32 v[208:209], v[208:209], s[4:5]
v_pk_mul_f32 v[210:211], v[210:211], s[4:5]
v_pk_mul_f32 v[212:213], v[212:213], s[4:5]
M v[244:247], a[136:139], a[176:179], v[244:247]
v_pk_mul_f32 v[214:215], v[214:215], s[4:5]
v_cvt_pk_bf16_f32 v208, v208, v209
M v[248:251], a[144:147], a[176:179], v[248:251]
buffer_load_dword v23, s[8:11], s24 offen offset:256 lds
s_add_u32 s24, s24, 128
v_cvt_pk_bf16_f32 v209, v210, v211
v_cvt_pk_bf16_f32 v210, v212, v213
M v[248:251], a[148:151], a[180:183], v[248:251]
v_cvt_pk_bf16_f32 v211, v214, v215
v_pk_mul_f32 v[216:217], v[216:217], s[4:5]
v_pk_mul_f32 v[218:219], v[218:219], s[4:5]
M v[252:255], a[156:159], a[180:183], v[252:255]
s_add_u32 s94, s92, 8192
buffer_store_dwordx4 v[120:123], v1, s[16:19], s94 offen offset:3072 sc1
v_pk_mul_f32 v[220:221], v[220:221], s[4:5]
v_pk_mul_f32 v[222:223], v[222:223], s[4:5]
M v[252:255], a[152:155], a[176:179], v[252:255]
v_cvt_pk_bf16_f32 v216, v216, v217
v_cvt_pk_bf16_f32 v217, v218, v219
M a[0:3], a[96:99], a[184:187], a[0:3]
v_cvt_pk_bf16_f32 v218, v220, v221
v_cvt_pk_bf16_f32 v219, v222, v223
M a[0:3], a[100:103], a[188:191], a[0:3]
M a[4:7], a[108:111], a[188:191], a[4:7]
s_add_u32 m0, s29, 20480
s_nop 0
buffer_load_dwordx4 v2, s[8:11], s23 offen offset:0 lds
M a[4:7], a[104:107], a[184:187], a[4:7]
v_pk_mul_f32 v[224:225], v[224:225], s[4:5]
v_pk_mul_f32 v[226:227], v[226:227], s[4:5]
v_pk_mul_f32 v[228:229], v[228:229], s[4:5]
M a[8:11], a[112:115], a[184:187], a[8:11]
v_pk_mul_f32 v[230:231], v[230:231], s[4:5]
v_cvt_pk_bf16_f32 v224, v224, v225
M a[8:11], a[116:119], a[188:191], a[8:11]
s_add_u32 s94, s92, 12288
buffer_store_dwordx4 v[128:131], v1, s[16:19], s94 offen offset:0 sc1
v_cvt_pk_bf16_f32 v225, v226, v227
v_cvt_pk_bf16_f32 v226, v228, v229
M a[12:15], a[124:127], a[188:191], a[12:15]
buffer_load_dwordx4 v3, s[8:11], s23 offen offset:1024 lds
v_cvt_pk_bf16_f32 v227, v230, v231
v_pk_mul_f32 v[232:233], v[232:233], s[4:5]
v_pk_mul_f32 v[234:235], v[234:235], s[4:5]
M a[12:15], a[120:123], a[184:187], a[12:15]
v_pk_mul_f32 v[236:237], v[236:237], s[4:5]
v_pk_mul_f32 v[238:239], v[238:239], s[4:5]
M a[16:19], a[128:131], a[184:187], a[16:19]
v_cvt_pk_bf16_f32 v232, v232, v233
v_cvt_pk_bf16_f32 v233, v234, v235
M a[16:19], a[132:135], a[188:191], a[16:19]
v_cvt_pk_bf16_f32 v234, v236, v237
v_cvt_pk_bf16_f32 v235, v238, v239
M a[20:23], a[140:143], a[188:191], a[20:23]
buffer_load_dwordx4 v4, s[8:11], s23 offen offset:2048 lds
v_pk_mul_f32 v[240:241], v[240:241], s[4:5]
v_pk_mul_f32 v[242:243], v[242:243], s[4:5]
v_pk_mul_f32 v[244:245], v[244:245], s[4:5]
M a[20:23], a[136:139], a[184:187], a[20:23]
v_pk_mul_f32 v[246:247], v[246:247], s[4:5]
v_cvt_pk_bf16_f32 v240, v240, v241
M a[24:27], a[144:147], a[184:187], a[24:27]
s_add_u32 s94, s92, 12288
buffer_store_dwordx4 v[136:139], v1, s[16:19], s94 offen offset:1024 sc1
v_cvt_pk_bf16_f32 v241, v242, v243
v_cvt_pk_bf16_f32 v242, v244, v245
M a[24:27], a[148:151], a[188:191], a[24:27]
v_cvt_pk_bf16_f32 v243, v246, v247
v_pk_mul_f32 v[248:249], v[248:249], s[4:5]
v_pk_mul_f32 v[250:251], v[250:251], s[4:5]
M a[28:31], a[156:159], a[188:191], a[28:31]
v_pk_mul_f32 v[252:253], v[252:253], s[4:5]
v_pk_mul_f32 v[254:255], v[254:255], s[4:5]
M a[28:31], a[152:155], a[184:187], a[28:31]
v_cvt_pk_bf16_f32 v248, v248, v249
v_cvt_pk_bf16_f32 v249, v250, v251
v_cvt_pk_bf16_f32 v250, v252, v253
v_cvt_pk_bf16_f32 v251, v254, v255
v_accvgpr_read_b32 v24, a0
v_accvgpr_read_b32 v25, a1
v_accvgpr_read_b32 v26, a2
v_accvgpr_read_b32 v27, a3
v_accvgpr_read_b32 v28, a4
v_accvgpr_read_b32 v29, a5
v_accvgpr_read_b32 v30, a6
v_accvgpr_read_b32 v31, a7
v_pk_mul_f32 v[24:25], v[24:25], s[4:5]
v_pk_mul_f32 v[26:27], v[26:27], s[4:5]
v_pk_mul_f32 v[28:29], v[28:29], s[4:5]
v_pk_mul_f32 v[30:31], v[30:31], s[4:5]
v_cvt_pk_bf16_f32 v36, v24, v25
v_cvt_pk_bf16_f32 v37, v26, v27
v_cvt_pk_bf16_f32 v38, v28, v29
v_cvt_pk_bf16_f32 v39, v30, v31
v_accvgpr_read_b32 v24, a8
v_accvgpr_read_b32 v25, a9
v_accvgpr_read_b32 v26, a10
v_accvgpr_read_b32 v27, a11
v_accvgpr_read_b32 v28, a12
v_accvgpr_read_b32 v29, a13
v_accvgpr_read_b32 v30, a14
v_accvgpr_read_b32 v31, a15
v_pk_mul_f32 v[24:25], v[24:25], s[4:5]
v_pk_mul_f32 v[26:27], v[26:27], s[4:5]
v_pk_mul_f32 v[28:29], v[28:29], s[4:5]
v_pk_mul_f32 v[30:31], v[30:31], s[4:5]
v_cvt_pk_bf16_f32 v44, v24, v25
v_cvt_pk_bf16_f32 v45, v26, v27
v_cvt_pk_bf16_f32 v46, v28, v29
v_cvt_pk_bf16_f32 v47, v30, v31
v_accvgpr_read_b32 v24, a16
v_accvgpr_read_b32 v25, a17
v_accvgpr_read_b32 v26, a18
v_accvgpr_read_b32 v27, a19
v_accvgpr_read_b32 v28, a20
v_accvgpr_read_b32 v29, a21
v_accvgpr_read_b32 v30, a22
v_accvgpr_read_b32 v31, a23
v_pk_mul_f32 v[24:25], v[24:25], s[4:5]
v_pk_mul_f32 v[26:27], v[26:27], s[4:5]
v_pk_mul_f32 v[28:29], v[28:29], s[4:5]
v_pk_mul_f32 v[30:31], v[30:31], s[4:5]
v_cvt_pk_bf16_f32 v52, v24, v25
v_cvt_pk_bf16_f32 v53, v26, v27
v_cvt_pk_bf16_f32 v54, v28, v29
v_cvt_pk_bf16_f32 v55, v30, v31
v_accvgpr_read_b32 v24, a24
v_accvgpr_read_b32 v25, a25
v_accvgpr_read_b32 v26, a26
v_accvgpr_read_b32 v27, a27
v_accvgpr_read_b32 v28, a28
v_accvgpr_read_b32 v29, a29
v_accvgpr_read_b32 v30, a30
v_accvgpr_read_b32 v31, a31
v_pk_mul_f32 v[24:25], v[24:25], s[4:5]
v_pk_mul_f32 v[26:27], v[26:27], s[4:5]
v_pk_mul_f32 v[28:29], v[28:29], s[4:5]
v_pk_mul_f32 v[30:31], v[30:31], s[4:5]
v_cvt_pk_bf16_f32 v60, v24, v25
v_cvt_pk_bf16_f32 v61, v26, v27
v_cvt_pk_bf16_f32 v62, v28, v29
v_cvt_pk_bf16_f32 v63, v30, v31
s_branch Lk1_b
Lk1_spin:
s_add_u32 s40, s40, 1
s_cmp_gt_u32 s40, 1048576
s_cbranch_scc1 Lk1_got
s_sleep 2
buffer_load_dword v126, v119, s[36:39], 0 offen offset:128 sc1
s_waitcnt vmcnt(0)
v_cmp_gt_u32 vcc, 0x80, v126
s_nop 0
s_cbranch_vccnz Lk1_spin
s_branch Lk1_got
Lk1_spinq:
s_add_u32 s40, s40, 1
s_cmp_gt_u32 s40, 1048576
s_cbranch_scc1 Lk1_gotq
s_sleep 2
buffer_load_dword v125, v119, s[36:39], 0 offen offset:0 sc1
s_waitcnt vmcnt(0)
v_cmp_gt_u32 vcc, 0x80, v125
s_nop 0
s_cbranch_vccnz Lk1_spinq
s_branch Lk1_gotq
Lk1_kv:
s_mov_b64 s[60:61], s[40:41]
s_mov_b32 s62, 4194304
s_and_b32 s3, s2, 127
s_lshl_b32 s3, s3, 2
s_add_u32 s3, s3, s20
s_mul_i32 s54, s3, 1024
M v[32:35], a[32:35], a[160:163], 0
s_add_u32 m0, s29, 32768
s_nop 0
buffer_load_dwordx4 v2, s[8:11], s23 offen offset:0 lds
M v[32:35], a[36:39], a[164:167], v[32:35]
ds_read_b128 a[176:179], v10 offset:4096
ds_read_b128 a[180:183], v11 offset:4096
M v[36:39], a[44:47], a[164:167], 0
M v[36:39], a[40:43], a[160:163], v[36:39]
ds_read_b64_tr_b16 a[96:97], v12 offset:32768
ds_read_b64_tr_b16 a[98:99], v12 offset:34816
M v[40:43], a[48:51], a[160:163], 0
M v[40:43], a[52:55], a[164:167], v[40:43]
buffer_load_dwordx4 v3, s[8:11], s23 offen offset:1024 lds
M v[44:47], a[60:63], a[164:167], 0
M v[44:47], a[56:59], a[160:163], v[44:47]
ds_read_b64_tr_b16 a[104:105], v13 offset:32768
ds_read_b64_tr_b16 a[106:107], v13 offset:34816
M v[48:51], a[64:67], a[160:163], 0
M v[48:51], a[68:71], a[164:167], v[48:51]
buffer_load_dwordx4 v4, s[8:11], s23 offen offset:2048 lds
M v[52:55], a[76:79], a[164:167], 0
M v[52:55], a[72:75], a[160:163], v[52:55]
ds_read_b64_tr_b16 a[112:113], v14 offset:32768
ds_read_b64_tr_b16 a[114:115], v14 offset:34816
M v[56:59], a[80:83], a[160:163], 0
M v[56:59], a[84:87], a[164:167], v[56:59]
buffer_load_dwordx4 v5, s[8:11], s23 offen offset:3072 lds
M v[60:63], a[92:95], a[164:167], 0
M v[60:63], a[88:91], a[160:163], v[60:63]
ds_read_b64_tr_b16 a[120:121], v15 offset:32768
ds_read_b64_tr_b16 a[122:123], v15 offset:34816
M v[64:67], a[32:35], a[168:171], 0
M v[64:67], a[36:39], a[172:175], v[64:67]
ds_read_b128 a[184:187], v10 offset:6144
ds_read_b128 a[188:191], v11 offset:6144
M v[68:71], a[44:47], a[172:175], 0
s_add_u32 m0, s29, 65536
s_nop 0
buffer_load_dwordx4 v6, s[12:15], s24 offen offset:0 lds
M v[68:71], a[40:43], a[168:171], v[68:71]
ds_read_b64_tr_b16 a[128:129], v16 offset:32768
ds_read_b64_tr_b16 a[130:131], v16 offset:34816
M v[72:75], a[48:51], a[168:171], 0
M v[72:75], a[52:55], a[172:175], v[72:75]
M v[76:79], a[60:63], a[172:175], 0
buffer_load_dwordx4 v7, s[12:15], s24 offen offset:1024 lds
M v[76:79], a[56:59], a[168:171], v[76:79]
ds_read_b64_tr_b16 a[136:137], v17 offset:32768
ds_read_b64_tr_b16 a[138:139], v17 offset:34816
M v[80:83], a[64:67], a[168:171], 0
M v[80:83], a[68:71], a[172:175], v[80:83]
M v[84:87], a[76:79], a[172:175], 0
buffer_load_dwordx4 v8, s[12:15], s24 offen offset:2048 lds
M v[84:87], a[72:75], a[168:171], v[84:87]
ds_read_b64_tr_b16 a[144:145], v18 offset:32768
ds_read_b64_tr_b16 a[146:147], v18 offset:34816
M v[88:91], a[80:83], a[168:171], 0
M v[88:91], a[84:87], a[172:175], v[88:91]
M v[92:95], a[92:95], a[172:175], 0
buffer_load_dwordx4 v9, s[12:15], s24 offen offset:3072 lds
M v[92:95], a[88:91], a[168:171], v[92:95]
s_waitcnt lgkmcnt(15)
ds_read_b64_tr_b16 a[152:153], v19 offset:32768
ds_read_b64_tr_b16 a[154:155], v19 offset:34816
M v[96:99], a[32:35], a[176:179], 0
M v[96:99], a[36:39], a[180:183], v[96:99]
M v[100:103], a[44:47], a[180:183], 0
s_add_u32 s24, s24, 262144
M v[100:103], a[40:43], a[176:179], v[100:103]
M v[104:107], a[48:51], a[176:179], 0
M v[104:107], a[52:55], a[180:183], v[104:107]
M v[108:111], a[60:63], a[180:183], 0
M v[108:111], a[56:59], a[176:179], v[108:111]
s_waitcnt vmcnt(9) lgkmcnt(0)
s_barrier
ds_read_b128 a[160:163], v10 offset:16384
ds_read_b128 a[164:167], v11 offset:16384
M v[112:115], a[64:67], a[176:179], 0
s_add_u32 m0, s29, 49152
s_add_u32 s3, s23, s31
buffer_load_dwordx4 v2, s[8:11], s3 offen offset:0 lds
M v[112:115], a[68:71], a[180:183], v[112:115]
M v[116:119], a[76:79], a[180:183], 0
M v[116:119], a[72:75], a[176:179], v[116:119]
ds_read_b64_tr_b16 a[100:101], v12 offset:49152
ds_read_b64_tr_b16 a[102:103], v12 offset:51200
M v[120:123], a[80:83], a[176:179], 0
M v[120:123], a[84:87], a[180:183], v[120:123]
buffer_load_dwordx4 v3, s[8:11], s3 offen offset:1024 lds
M v[124:127], a[92:95], a[180:183], 0
M v[124:127], a[88:91], a[176:179], v[124:127]
M v[128:131], a[32:35], a[184:187], 0
M v[128:131], a[36:39], a[188:191], v[128:131]
ds_read_b128 a[168:171], v10 offset:18432
ds_read_b128 a[172:175], v11 offset:18432
ds_read_b64_tr_b16 a[108:109], v13 offset:49152
ds_read_b64_tr_b16 a[110:111], v13 offset:51200
M v[132:135], a[44:47], a[188:191], 0
M v[132:135], a[40:43], a[184:187], v[132:135]
M v[136:139], a[48:51], a[184:187], 0
buffer_load_dwordx4 v4, s[8:11], s3 offen offset:2048 lds
M v[136:139], a[52:55], a[188:191], v[136:139]
M v[140:143], a[60:63], a[188:191], 0
M v[140:143], a[56:59], a[184:187], v[140:143]
ds_read_b64_tr_b16 a[116:117], v14 offset:49152
ds_read_b64_tr_b16 a[118:119], v14 offset:51200
M v[144:147], a[64:67], a[184:187], 0
M v[144:147], a[68:71], a[188:191], v[144:147]
M v[148:151], a[76:79], a[188:191], 0
buffer_load_dwordx4 v5, s[8:11], s3 offen offset:3072 lds
M v[148:151], a[72:75], a[184:187], v[148:151]
M v[152:155], a[80:83], a[184:187], 0
M v[152:155], a[84:87], a[188:191], v[152:155]
ds_read_b64_tr_b16 a[124:125], v15 offset:49152
ds_read_b64_tr_b16 a[126:127], v15 offset:51200
M v[156:159], a[92:95], a[188:191], 0
M v[156:159], a[88:91], a[184:187], v[156:159]
s_waitcnt lgkmcnt(10)
M v[160:163], a[32:35], a[160:163], 0
M v[160:163], a[36:39], a[164:167], v[160:163]
ds_read_b128 a[176:179], v10 offset:20480
ds_read_b128 a[180:183], v11 offset:20480
M v[164:167], a[44:47], a[164:167], 0
s_add_u32 s23, s23, 128
s_cmp_eq_u32 s23, s25
s_cselect_b32 s23, s26, s23
M v[164:167], a[40:43], a[160:163], v[164:167]
ds_read_b64_tr_b16 a[132:133], v16 offset:49152
ds_read_b64_tr_b16 a[134:135], v16 offset:51200
M v[168:171], a[48:51], a[160:163], 0
M v[168:171], a[52:55], a[164:167], v[168:171]
M v[172:175], a[60:63], a[164:167], 0
M v[172:175], a[56:59], a[160:163], v[172:175]
M v[176:179], a[64:67], a[160:163], 0
s_add_u32 m0, s29, 81920
s_nop 0
buffer_load_dwordx4 v6, s[12:15], s24 offen offset:0 lds
M v[176:179], a[68:71], a[164:167], v[176:179]
ds_read_b64_tr_b16 a[140:141], v17 offset:49152
ds_read_b64_tr_b16 a[142:143], v17 offset:51200
M v[180:183], a[76:79], a[164:167], 0
M v[180:183], a[72:75], a[160:163], v[180:183]
M v[184:187], a[80:83], a[160:163], 0
M v[184:187], a[84:87], a[164:167], v[184:187]
buffer_load_dwordx4 v7, s[12:15], s24 offen offset:1024 lds
M v[188:191], a[92:95], a[164:167], 0
M v[188:191], a[88:91], a[160:163], v[188:191]
s_waitcnt lgkmcnt(12)
ds_read_b64_tr_b16 a[148:149], v18 offset:49152
ds_read_b64_tr_b16 a[150:151], v18 offset:51200
M v[192:195], a[32:35], a[168:171], 0
M v[192:195], a[36:39], a[172:175], v[192:195]
ds_read_b128 a[184:187], v10 offset:22528
ds_read_b128 a[188:191], v11 offset:22528
M v[196:199], a[44:47], a[172:175], 0
M v[196:199], a[40:43], a[168:171], v[196:199]
M v[200:203], a[48:51], a[168:171], 0
buffer_load_dwordx4 v8, s[12:15], s24 offen offset:2048 lds
M v[200:203], a[52:55], a[172:175], v[200:203]
ds_read_b64_tr_b16 a[156:157], v19 offset:49152
ds_read_b64_tr_b16 a[158:159], v19 offset:51200
M v[204:207], a[60:63], a[172:175], 0
M v[204:207], a[56:59], a[168:171], v[204:207]
M v[208:211], a[64:67], a[168:171], 0
M v[208:211], a[68:71], a[172:175], v[208:211]
M v[212:215], a[76:79], a[172:175], 0
buffer_load_dwordx4 v9, s[12:15], s24 offen offset:3072 lds
M v[212:215], a[72:75], a[168:171], v[212:215]
M v[216:219], a[80:83], a[168:171], 0
M v[216:219], a[84:87], a[172:175], v[216:219]
M v[220:223], a[92:95], a[172:175], 0
M v[220:223], a[88:91], a[168:171], v[220:223]
s_waitcnt lgkmcnt(10)
M v[224:227], a[32:35], a[176:179], 0
s_add_u32 s24, s24, 262144
s_cmp_eq_u32 s24, s27
s_cselect_b32 s24, s28, s24
s_sub_u32 s6, s6, 1
s_cmp_eq_u32 s6, 0
s_cselect_b64 s[12:13], s[64:65], s[12:13]
M v[224:227], a[36:39], a[180:183], v[224:227]
M v[228:231], a[44:47], a[180:183], 0
M v[228:231], a[40:43], a[176:179], v[228:231]
M v[232:235], a[48:51], a[176:179], 0
M v[232:235], a[52:55], a[180:183], v[232:235]
M v[236:239], a[60:63], a[180:183], 0
M v[236:239], a[56:59], a[176:179], v[236:239]
s_waitcnt vmcnt(8) lgkmcnt(0)
s_barrier
ds_read_b128 a[160:163], v10 offset:32768
ds_read_b128 a[164:167], v11 offset:32768
M v[240:243], a[64:67], a[176:179], 0
s_add_u32 m0, s29, 0
s_nop 0
buffer_load_dwordx4 v2, s[8:11], s23 offen offset:0 lds
M v[240:243], a[68:71], a[180:183], v[240:243]
M v[244:247], a[76:79], a[180:183], 0
M v[244:247], a[72:75], a[176:179], v[244:247]
M v[248:251], a[80:83], a[176:179], 0
M v[248:251], a[84:87], a[180:183], v[248:251]
buffer_load_dwordx4 v3, s[8:11], s23 offen offset:1024 lds
M v[252:255], a[92:95], a[180:183], 0
M v[252:255], a[88:91], a[176:179], v[252:255]
M a[0:3], a[32:35], a[184:187], 0
M a[0:3], a[36:39], a[188:191], a[0:3]
ds_read_b128 a[168:171], v10 offset:34816
ds_read_b128 a[172:175], v11 offset:34816
M a[4:7], a[44:47], a[188:191], 0
M a[4:7], a[40:43], a[184:187], a[4:7]
M a[8:11], a[48:51], a[184:187], 0
buffer_load_dwordx4 v4, s[8:11], s23 offen offset:2048 lds
M a[8:11], a[52:55], a[188:191], a[8:11]
M a[12:15], a[60:63], a[188:191], 0
M a[12:15], a[56:59], a[184:187], a[12:15]
M a[16:19], a[64:67], a[184:187], 0
M a[16:19], a[68:71], a[188:191], a[16:19]
buffer_load_dwordx4 v5, s[8:11], s23 offen offset:3072 lds
M a[20:23], a[76:79], a[188:191], 0
M a[20:23], a[72:75], a[184:187], a[20:23]
M a[24:27], a[80:83], a[184:187], 0
M a[24:27], a[84:87], a[188:191], a[24:27]
M a[28:31], a[92:95], a[188:191], 0
M a[28:31], a[88:91], a[184:187], a[28:31]
s_waitcnt lgkmcnt(2)
M v[32:35], a[96:99], a[160:163], v[32:35]
s_add_u32 m0, s29, 98304
s_nop 0
buffer_load_dwordx4 v6, s[12:15], s24 offen offset:0 lds
M v[32:35], a[100:103], a[164:167], v[32:35]
ds_read_b128 a[176:179], v10 offset:36864
ds_read_b128 a[180:183], v11 offset:36864
M v[36:39], a[108:111], a[164:167], v[36:39]
M v[36:39], a[104:107], a[160:163], v[36:39]
ds_read_b64_tr_b16 a[32:33], v12 offset:0
ds_read_b64_tr_b16 a[34:35], v12 offset:2048
M v[40:43], a[112:115], a[160:163], v[40:43]
M v[40:43], a[116:119], a[164:167], v[40:43]
M v[44:47], a[124:127], a[164:167], v[44:47]
M v[44:47], a[120:123], a[160:163], v[44:47]
ds_read_b64_tr_b16 a[40:41], v13 offset:0
ds_read_b64_tr_b16 a[42:43], v13 offset:2048
M v[48:51], a[128:131], a[160:163], v[48:51]
buffer_load_dwordx4 v7, s[12:15], s24 offen offset:1024 lds
M v[48:51], a[132:135], a[164:167], v[48:51]
M v[52:55], a[140:143], a[164:167], v[52:55]
M v[52:55], a[136:139], a[160:163], v[52:55]
ds_read_b64_tr_b16 a[48:49], v14 offset:0
ds_read_b64_tr_b16 a[50:51], v14 offset:2048
M v[56:59], a[144:147], a[160:163], v[56:59]
M v[56:59], a[148:151], a[164:167], v[56:59]
M v[60:63], a[156:159], a[164:167], v[60:63]
buffer_load_dwordx4 v8, s[12:15], s24 offen offset:2048 lds
M v[60:63], a[152:155], a[160:163], v[60:63]
s_waitcnt lgkmcnt(8)
ds_read_b64_tr_b16 a[56:57], v15 offset:0
ds_read_b64_tr_b16 a[58:59], v15 offset:2048
M v[64:67], a[96:99], a[168:171], v[64:67]
M v[64:67], a[100:103], a[172:175], v[64:67]
ds_read_b128 a[184:187], v10 offset:38912
ds_read_b128 a[188:191], v11 offset:38912
M v[68:71], a[108:111], a[172:175], v[68:71]
M v[68:71], a[104:107], a[168:171], v[68:71]
ds_read_b64_tr_b16 a[64:65], v16 offset:0
ds_read_b64_tr_b16 a[66:67], v16 offset:2048
M v[72:75], a[112:115], a[168:171], v[72:75]
M v[72:75], a[116:119], a[172:175], v[72:75]
M v[76:79], a[124:127], a[172:175], v[76:79]
M v[76:79], a[120:123], a[168:171], v[76:79]
ds_read_b64_tr_b16 a[72:73], v17 offset:0
ds_read_b64_tr_b16 a[74:75], v17 offset:2048
M v[80:83], a[128:131], a[168:171], v[80:83]
buffer_load_dwordx4 v9, s[12:15], s24 offen offset:3072 lds
M v[80:83], a[132:135], a[172:175], v[80:83]
M v[84:87], a[140:143], a[172:175], v[84:87]
M v[84:87], a[136:139], a[168:171], v[84:87]
ds_read_b64_tr_b16 a[80:81], v18 offset:0
ds_read_b64_tr_b16 a[82:83], v18 offset:2048
M v[88:91], a[144:147], a[168:171], v[88:91]
M v[88:91], a[148:151], a[172:175], v[88:91]
M v[92:95], a[156:159], a[172:175], v[92:95]
s_add_u32 s24, s24, 262144
M v[92:95], a[152:155], a[168:171], v[92:95]
s_waitcnt lgkmcnt(15)
ds_read_b64_tr_b16 a[88:89], v19 offset:0
ds_read_b64_tr_b16 a[90:91], v19 offset:2048
M v[96:99], a[96:99], a[176:179], v[96:99]
M v[96:99], a[100:103], a[180:183], v[96:99]
M v[100:103], a[108:111], a[180:183], v[100:103]
M v[100:103], a[104:107], a[176:179], v[100:103]
M v[104:107], a[112:115], a[176:179], v[104:107]
M v[104:107], a[116:119], a[180:183], v[104:107]
M v[108:111], a[124:127], a[180:183], v[108:111]
M v[108:111], a[120:123], a[176:179], v[108:111]
s_waitcnt vmcnt(8) lgkmcnt(0)
s_barrier
ds_read_b128 a[160:163], v10 offset:49152
ds_read_b128 a[164:167], v11 offset:49152
M v[112:115], a[128:131], a[176:179], v[112:115]
s_add_u32 m0, s29, 16384
s_add_u32 s3, s23, s31
buffer_load_dwordx4 v2, s[8:11], s3 offen offset:0 lds
M v[112:115], a[132:135], a[180:183], v[112:115]
M v[116:119], a[140:143], a[180:183], v[116:119]
M v[116:119], a[136:139], a[176:179], v[116:119]
ds_read_b64_tr_b16 a[36:37], v12 offset:16384
ds_read_b64_tr_b16 a[38:39], v12 offset:18432
M v[120:123], a[144:147], a[176:179], v[120:123]
M v[120:123], a[148:151], a[180:183], v[120:123]
buffer_load_dwordx4 v3, s[8:11], s3 offen offset:1024 lds
M v[124:127], a[156:159], a[180:183], v[124:127]
M v[124:127], a[152:155], a[176:179], v[124:127]
M v[128:131], a[96:99], a[184:187], v[128:131]
M v[128:131], a[100:103], a[188:191], v[128:131]
ds_read_b128 a[168:171], v10 offset:51200
ds_read_b128 a[172:175], v11 offset:51200
ds_read_b64_tr_b16 a[44:45], v13 offset:16384
ds_read_b64_tr_b16 a[46:47], v13 offset:18432
M v[132:135], a[108:111], a[188:191], v[132:135]
M v[132:135], a[104:107], a[184:187], v[132:135]
M v[136:139], a[112:115], a[184:187], v[136:139]
buffer_load_dwordx4 v4, s[8:11], s3 offen offset:2048 lds
M v[136:139], a[116:119], a[188:191], v[136:139]
M v[140:143], a[124:127], a[188:191], v[140:143]
M v[140:143], a[120:123], a[184:187], v[140:143]
ds_read_b64_tr_b16 a[52:53], v14 offset:16384
ds_read_b64_tr_b16 a[54:55], v14 offset:18432
M v[144:147], a[128:131], a[184:187], v[144:147]
M v[144:147], a[132:135], a[188:191], v[144:147]
M v[148:151], a[140:143], a[188:191], v[148:151]
buffer_load_dwordx4 v5, s[8:11], s3 offen offset:3072 lds
M v[148:151], a[136:139], a[184:187], v[148:151]
M v[152:155], a[144:147], a[184:187], v[152:155]
M v[152:155], a[148:151], a[188:191], v[152:155]
ds_read_b64_tr_b16 a[60:61], v15 offset:16384
ds_read_b64_tr_b16 a[62:63], v15 offset:18432
M v[156:159], a[156:159], a[188:191], v[156:159]
M v[156:159], a[152:155], a[184:187], v[156:159]
s_waitcnt lgkmcnt(10)
M v[160:163], a[96:99], a[160:163], v[160:163]
M v[160:163], a[100:103], a[164:167], v[160:163]
ds_read_b128 a[176:179], v10 offset:53248
ds_read_b128 a[180:183], v11 offset:53248
M v[164:167], a[108:111], a[164:167], v[164:167]
s_add_u32 s23, s23, 128
s_cmp_eq_u32 s23, s25
s_cselect_b32 s23, s26, s23
M v[164:167], a[104:107], a[160:163], v[164:167]
ds_read_b64_tr_b16 a[68:69], v16 offset:16384
ds_read_b64_tr_b16 a[70:71], v16 offset:18432
M v[168:171], a[112:115], a[160:163], v[168:171]
M v[168:171], a[116:119], a[164:167], v[168:171]
M v[172:175], a[124:127], a[164:167], v[172:175]
M v[172:175], a[120:123], a[160:163], v[172:175]
M v[176:179], a[128:131], a[160:163], v[176:179]
s_add_u32 m0, s29, 114688
s_nop 0
buffer_load_dwordx4 v6, s[12:15], s24 offen offset:0 lds
M v[176:179], a[132:135], a[164:167], v[176:179]
ds_read_b64_tr_b16 a[76:77], v17 offset:16384
ds_read_b64_tr_b16 a[78:79], v17 offset:18432
M v[180:183], a[140:143], a[164:167], v[180:183]
M v[180:183], a[136:139], a[160:163], v[180:183]
M v[184:187], a[144:147], a[160:163], v[184:187]
M v[184:187], a[148:151], a[164:167], v[184:187]
buffer_load_dwordx4 v7, s[12:15], s24 offen offset:1024 lds
M v[188:191], a[156:159], a[164:167], v[188:191]
M v[188:191], a[152:155], a[160:163], v[188:191]
s_waitcnt lgkmcnt(12)
ds_read_b64_tr_b16 a[84:85], v18 offset:16384
ds_read_b64_tr_b16 a[86:87], v18 offset:18432
M v[192:195], a[96:99], a[168:171], v[192:195]
M v[192:195], a[100:103], a[172:175], v[192:195]
ds_read_b128 a[184:187], v10 offset:55296
ds_read_b128 a[188:191], v11 offset:55296
M v[196:199], a[108:111], a[172:175], v[196:199]
M v[196:199], a[104:107], a[168:171], v[196:199]
M v[200:203], a[112:115], a[168:171], v[200:203]
buffer_load_dwordx4 v8, s[12:15], s24 offen offset:2048 lds
M v[200:203], a[116:119], a[172:175], v[200:203]
ds_read_b64_tr_b16 a[92:93], v19 offset:16384
ds_read_b64_tr_b16 a[94:95], v19 offset:18432
M v[204:207], a[124:127], a[172:175], v[204:207]
M v[204:207], a[120:123], a[168:171], v[204:207]
M v[208:211], a[128:131], a[168:171], v[208:211]
M v[208:211], a[132:135], a[172:175], v[208:211]
M v[212:215], a[140:143], a[172:175], v[212:215]
buffer_load_dwordx4 v9, s[12:15], s24 offen offset:3072 lds
M v[212:215], a[136:139], a[168:171], v[212:215]
M v[216:219], a[144:147], a[168:171], v[216:219]
M v[216:219], a[148:151], a[172:175], v[216:219]
M v[220:223], a[156:159], a[172:175], v[220:223]
M v[220:223], a[152:155], a[168:171], v[220:223]
s_waitcnt lgkmcnt(10)
M v[224:227], a[96:99], a[176:179], v[224:227]
s_add_u32 s24, s24, 262144
s_cmp_eq_u32 s24, s27
s_cselect_b32 s24, s28, s24
s_sub_u32 s6, s6, 1
s_cmp_eq_u32 s6, 0
s_cselect_b64 s[12:13], s[64:65], s[12:13]
M v[224:227], a[100:103], a[180:183], v[224:227]
M v[228:231], a[108:111], a[180:183], v[228:231]
M v[228:231], a[104:107], a[176:179], v[228:231]
M v[232:235], a[112:115], a[176:179], v[232:235]
M v[232:235], a[116:119], a[180:183], v[232:235]
M v[236:239], a[124:127], a[180:183], v[236:239]
M v[236:239], a[120:123], a[176:179], v[236:239]
s_waitcnt vmcnt(8) lgkmcnt(0)
s_barrier
ds_read_b128 a[160:163], v10 offset:0
ds_read_b128 a[164:167], v11 offset:0
M v[240:243], a[128:131], a[176:179], v[240:243]
s_add_u32 m0, s29, 32768
s_nop 0
buffer_load_dwordx4 v2, s[8:11], s23 offen offset:0 lds
M v[240:243], a[132:135], a[180:183], v[240:243]
M v[244:247], a[140:143], a[180:183], v[244:247]
M v[244:247], a[136:139], a[176:179], v[244:247]
M v[248:251], a[144:147], a[176:179], v[248:251]
M v[248:251], a[148:151], a[180:183], v[248:251]
buffer_load_dwordx4 v3, s[8:11], s23 offen offset:1024 lds
M v[252:255], a[156:159], a[180:183], v[252:255]
M v[252:255], a[152:155], a[176:179], v[252:255]
M a[0:3], a[96:99], a[184:187], a[0:3]
M a[0:3], a[100:103], a[188:191], a[0:3]
ds_read_b128 a[168:171], v10 offset:2048
ds_read_b128 a[172:175], v11 offset:2048
M a[4:7], a[108:111], a[188:191], a[4:7]
M a[4:7], a[104:107], a[184:187], a[4:7]
M a[8:11], a[112:115], a[184:187], a[8:11]
buffer_load_dwordx4 v4, s[8:11], s23 offen offset:2048 lds
M a[8:11], a[116:119], a[188:191], a[8:11]
M a[12:15], a[124:127], a[188:191], a[12:15]
M a[12:15], a[120:123], a[184:187], a[12:15]
M a[16:19], a[128:131], a[184:187], a[16:19]
M a[16:19], a[132:135], a[188:191], a[16:19]
buffer_load_dwordx4 v5, s[8:11], s23 offen offset:3072 lds
M a[20:23], a[140:143], a[188:191], a[20:23]
M a[20:23], a[136:139], a[184:187], a[20:23]
M a[24:27], a[144:147], a[184:187], a[24:27]
M a[24:27], a[148:151], a[188:191], a[24:27]
M a[28:31], a[156:159], a[188:191], a[28:31]
M a[28:31], a[152:155], a[184:187], a[28:31]
s_waitcnt lgkmcnt(2)
s_mov_b32 s30, 2
Lk1_kl:
M v[32:35], a[32:35], a[160:163], v[32:35]
s_add_u32 m0, s29, 65536
s_nop 0
buffer_load_dwordx4 v6, s[12:15], s24 offen offset:0 lds
M v[32:35], a[36:39], a[164:167], v[32:35]
ds_read_b128 a[176:179], v10 offset:4096
ds_read_b128 a[180:183], v11 offset:4096
M v[36:39], a[44:47], a[164:167], v[36:39]
M v[36:39], a[40:43], a[160:163], v[36:39]
ds_read_b64_tr_b16 a[96:97], v12 offset:32768
ds_read_b64_tr_b16 a[98:99], v12 offset:34816
M v[40:43], a[48:51], a[160:163], v[40:43]
M v[40:43], a[52:55], a[164:167], v[40:43]
M v[44:47], a[60:63], a[164:167], v[44:47]
M v[44:47], a[56:59], a[160:163], v[44:47]
ds_read_b64_tr_b16 a[104:105], v13 offset:32768
ds_read_b64_tr_b16 a[106:107], v13 offset:34816
M v[48:51], a[64:67], a[160:163], v[48:51]
buffer_load_dwordx4 v7, s[12:15], s24 offen offset:1024 lds
M v[48:51], a[68:71], a[164:167], v[48:51]
M v[52:55], a[76:79], a[164:167], v[52:55]
M v[52:55], a[72:75], a[160:163], v[52:55]
ds_read_b64_tr_b16 a[112:113], v14 offset:32768
ds_read_b64_tr_b16 a[114:115], v14 offset:34816
M v[56:59], a[80:83], a[160:163], v[56:59]
M v[56:59], a[84:87], a[164:167], v[56:59]
M v[60:63], a[92:95], a[164:167], v[60:63]
buffer_load_dwordx4 v8, s[12:15], s24 offen offset:2048 lds
M v[60:63], a[88:91], a[160:163], v[60:63]
s_waitcnt lgkmcnt(8)
ds_read_b64_tr_b16 a[120:121], v15 offset:32768
ds_read_b64_tr_b16 a[122:123], v15 offset:34816
M v[64:67], a[32:35], a[168:171], v[64:67]
M v[64:67], a[36:39], a[172:175], v[64:67]
ds_read_b128 a[184:187], v10 offset:6144
ds_read_b128 a[188:191], v11 offset:6144
M v[68:71], a[44:47], a[172:175], v[68:71]
M v[68:71], a[40:43], a[168:171], v[68:71]
ds_read_b64_tr_b16 a[128:129], v16 offset:32768
ds_read_b64_tr_b16 a[130:131], v16 offset:34816
M v[72:75], a[48:51], a[168:171], v[72:75]
M v[72:75], a[52:55], a[172:175], v[72:75]
M v[76:79], a[60:63], a[172:175], v[76:79]
M v[76:79], a[56:59], a[168:171], v[76:79]
ds_read_b64_tr_b16 a[136:137], v17 offset:32768
ds_read_b64_tr_b16 a[138:139], v17 offset:34816
M v[80:83], a[64:67], a[168:171], v[80:83]
buffer_load_dwordx4 v9, s[12:15], s24 offen offset:3072 lds
M v[80:83], a[68:71], a[172:175], v[80:83]
M v[84:87], a[76:79], a[172:175], v[84:87]
M v[84:87], a[72:75], a[168:171], v[84:87]
ds_read_b64_tr_b16 a[144:145], v18 offset:32768
ds_read_b64_tr_b16 a[146:147], v18 offset:34816
M v[88:91], a[80:83], a[168:171], v[88:91]
M v[88:91], a[84:87], a[172:175], v[88:91]
M v[92:95], a[92:95], a[172:175], v[92:95]
s_add_u32 s24, s24, 262144
M v[92:95], a[88:91], a[168:171], v[92:95]
s_waitcnt lgkmcnt(15)
ds_read_b64_tr_b16 a[152:153], v19 offset:32768
ds_read_b64_tr_b16 a[154:155], v19 offset:34816
M v[96:99], a[32:35], a[176:179], v[96:99]
M v[96:99], a[36:39], a[180:183], v[96:99]
M v[100:103], a[44:47], a[180:183], v[100:103]
M v[100:103], a[40:43], a[176:179], v[100:103]
M v[104:107], a[48:51], a[176:179], v[104:107]
M v[104:107], a[52:55], a[180:183], v[104:107]
M v[108:111], a[60:63], a[180:183], v[108:111]
M v[108:111], a[56:59], a[176:179], v[108:111]
s_waitcnt vmcnt(8) lgkmcnt(0)
s_barrier
ds_read_b128 a[160:163], v10 offset:16384
ds_read_b128 a[164:167], v11 offset:16384
M v[112:115], a[64:67], a[176:179], v[112:115]
s_add_u32 m0, s29, 49152
s_add_u32 s3, s23, s31
buffer_load_dwordx4 v2, s[8:11], s3 offen offset:0 lds
M v[112:115], a[68:71], a[180:183], v[112:115]
M v[116:119], a[76:79], a[180:183], v[116:119]
M v[116:119], a[72:75], a[176:179], v[116:119]
ds_read_b64_tr_b16 a[100:101], v12 offset:49152
ds_read_b64_tr_b16 a[102:103], v12 offset:51200
M v[120:123], a[80:83], a[176:179], v[120:123]
M v[120:123], a[84:87], a[180:183], v[120:123]
buffer_load_dwordx4 v3, s[8:11], s3 offen offset:1024 lds
M v[124:127], a[92:95], a[180:183], v[124:127]
M v[124:127], a[88:91], a[176:179], v[124:127]
M v[128:131], a[32:35], a[184:187], v[128:131]
M v[128:131], a[36:39], a[188:191], v[128:131]
ds_read_b128 a[168:171], v10 offset:18432
ds_read_b128 a[172:175], v11 offset:18432
ds_read_b64_tr_b16 a[108:109], v13 offset:49152
ds_read_b64_tr_b16 a[110:111], v13 offset:51200
M v[132:135], a[44:47], a[188:191], v[132:135]
M v[132:135], a[40:43], a[184:187], v[132:135]
M v[136:139], a[48:51], a[184:187], v[136:139]
buffer_load_dwordx4 v4, s[8:11], s3 offen offset:2048 lds
M v[136:139], a[52:55], a[188:191], v[136:139]
M v[140:143], a[60:63], a[188:191], v[140:143]
M v[140:143], a[56:59], a[184:187], v[140:143]
ds_read_b64_tr_b16 a[116:117], v14 offset:49152
ds_read_b64_tr_b16 a[118:119], v14 offset:51200
M v[144:147], a[64:67], a[184:187], v[144:147]
M v[144:147], a[68:71], a[188:191], v[144:147]
M v[148:151], a[76:79], a[188:191], v[148:151]
buffer_load_dwordx4 v5, s[8:11], s3 offen offset:3072 lds
M v[148:151], a[72:75], a[184:187], v[148:151]
M v[152:155], a[80:83], a[184:187], v[152:155]
M v[152:155], a[84:87], a[188:191], v[152:155]
ds_read_b64_tr_b16 a[124:125], v15 offset:49152
ds_read_b64_tr_b16 a[126:127], v15 offset:51200
M v[156:159], a[92:95], a[188:191], v[156:159]
M v[156:159], a[88:91], a[184:187], v[156:159]
s_waitcnt lgkmcnt(10)
M v[160:163], a[32:35], a[160:163], v[160:163]
M v[160:163], a[36:39], a[164:167], v[160:163]
ds_read_b128 a[176:179], v10 offset:20480
ds_read_b128 a[180:183], v11 offset:20480
M v[164:167], a[44:47], a[164:167], v[164:167]
s_add_u32 s23, s23, 128
s_cmp_eq_u32 s23, s25
s_cselect_b32 s23, s26, s23
M v[164:167], a[40:43], a[160:163], v[164:167]
ds_read_b64_tr_b16 a[132:133], v16 offset:49152
ds_read_b64_tr_b16 a[134:135], v16 offset:51200
M v[168:171], a[48:51], a[160:163], v[168:171]
M v[168:171], a[52:55], a[164:167], v[168:171]
M v[172:175], a[60:63], a[164:167], v[172:175]
M v[172:175], a[56:59], a[160:163], v[172:175]
M v[176:179], a[64:67], a[160:163], v[176:179]
s_add_u32 m0, s29, 81920
s_nop 0
buffer_load_dwordx4 v6, s[12:15], s24 offen offset:0 lds
M v[176:179], a[68:71], a[164:167], v[176:179]
ds_read_b64_tr_b16 a[140:141], v17 offset:49152
ds_read_b64_tr_b16 a[142:143], v17 offset:51200
M v[180:183], a[76:79], a[164:167], v[180:183]
M v[180:183], a[72:75], a[160:163], v[180:183]
M v[184:187], a[80:83], a[160:163], v[184:187]
M v[184:187], a[84:87], a[164:167], v[184:187]
buffer_load_dwordx4 v7, s[12:15], s24 offen offset:1024 lds
M v[188:191], a[92:95], a[164:167], v[188:191]
M v[188:191], a[88:91], a[160:163], v[188:191]
s_waitcnt lgkmcnt(12)
ds_read_b64_tr_b16 a[148:149], v18 offset:49152
ds_read_b64_tr_b16 a[150:151], v18 offset:51200
M v[192:195], a[32:35], a[168:171], v[192:195]
M v[192:195], a[36:39], a[172:175], v[192:195]
ds_read_b128 a[184:187], v10 offset:22528
ds_read_b128 a[188:191], v11 offset:22528
M v[196:199], a[44:47], a[172:175], v[196:199]
M v[196:199], a[40:43], a[168:171], v[196:199]
M v[200:203], a[48:51], a[168:171], v[200:203]
buffer_load_dwordx4 v8, s[12:15], s24 offen offset:2048 lds
M v[200:203], a[52:55], a[172:175], v[200:203]
ds_read_b64_tr_b16 a[156:157], v19 offset:49152
ds_read_b64_tr_b16 a[158:159], v19 offset:51200
M v[204:207], a[60:63], a[172:175], v[204:207]
M v[204:207], a[56:59], a[168:171], v[204:207]
M v[208:211], a[64:67], a[168:171], v[208:211]
M v[208:211], a[68:71], a[172:175], v[208:211]
M v[212:215], a[76:79], a[172:175], v[212:215]
buffer_load_dwordx4 v9, s[12:15], s24 offen offset:3072 lds
M v[212:215], a[72:75], a[168:171], v[212:215]
M v[216:219], a[80:83], a[168:171], v[216:219]
M v[216:219], a[84:87], a[172:175], v[216:219]
M v[220:223], a[92:95], a[172:175], v[220:223]
M v[220:223], a[88:91], a[168:171], v[220:223]
s_waitcnt lgkmcnt(10)
M v[224:227], a[32:35], a[176:179], v[224:227]
s_add_u32 s24, s24, 262144
s_cmp_eq_u32 s24, s27
s_cselect_b32 s24, s28, s24
s_sub_u32 s6, s6, 1
s_cmp_eq_u32 s6, 0
s_cselect_b64 s[12:13], s[64:65], s[12:13]
M v[224:227], a[36:39], a[180:183], v[224:227]
M v[228:231], a[44:47], a[180:183], v[228:231]
M v[228:231], a[40:43], a[176:179], v[228:231]
M v[232:235], a[48:51], a[176:179], v[232:235]
M v[232:235], a[52:55], a[180:183], v[232:235]
M v[236:239], a[60:63], a[180:183], v[236:239]
M v[236:239], a[56:59], a[176:179], v[236:239]
s_waitcnt vmcnt(8) lgkmcnt(0)
s_barrier
ds_read_b128 a[160:163], v10 offset:32768
ds_read_b128 a[164:167], v11 offset:32768
M v[240:243], a[64:67], a[176:179], v[240:243]
s_add_u32 m0, s29, 0
s_nop 0
buffer_load_dwordx4 v2, s[8:11], s23 offen offset:0 lds
M v[240:243], a[68:71], a[180:183], v[240:243]
M v[244:247], a[76:79], a[180:183], v[244:247]
M v[244:247], a[72:75], a[176:179], v[244:247]
M v[248:251], a[80:83], a[176:179], v[248:251]
M v[248:251], a[84:87], a[180:183], v[248:251]
buffer_load_dwordx4 v3, s[8:11], s23 offen offset:1024 lds
M v[252:255], a[92:95], a[180:183], v[252:255]
M v[252:255], a[88:91], a[176:179], v[252:255]
M a[0:3], a[32:35], a[184:187], a[0:3]
M a[0:3], a[36:39], a[188:191], a[0:3]
ds_read_b128 a[168:171], v10 offset:34816
ds_read_b128 a[172:175], v11 offset:34816
M a[4:7], a[44:47], a[188:191], a[4:7]
M a[4:7], a[40:43], a[184:187], a[4:7]
M a[8:11], a[48:51], a[184:187], a[8:11]
buffer_load_dwordx4 v4, s[8:11], s23 offen offset:2048 lds
M a[8:11], a[52:55], a[188:191], a[8:11]
M a[12:15], a[60:63], a[188:191], a[12:15]
M a[12:15], a[56:59], a[184:187], a[12:15]
M a[16:19], a[64:67], a[184:187], a[16:19]
M a[16:19], a[68:71], a[188:191], a[16:19]
buffer_load_dwordx4 v5, s[8:11], s23 offen offset:3072 lds
M a[20:23], a[76:79], a[188:191], a[20:23]
M a[20:23], a[72:75], a[184:187], a[20:23]
M a[24:27], a[80:83], a[184:187], a[24:27]
M a[24:27], a[84:87], a[188:191], a[24:27]
M a[28:31], a[92:95], a[188:191], a[28:31]
M a[28:31], a[88:91], a[184:187], a[28:31]
s_waitcnt lgkmcnt(2)
M v[32:35], a[96:99], a[160:163], v[32:35]
s_add_u32 m0, s29, 98304
s_nop 0
buffer_load_dwordx4 v6, s[12:15], s24 offen offset:0 lds
M v[32:35], a[100:103], a[164:167], v[32:35]
ds_read_b128 a[176:179], v10 offset:36864
ds_read_b128 a[180:183], v11 offset:36864
M v[36:39], a[108:111], a[164:167], v[36:39]
M v[36:39], a[104:107], a[160:163], v[36:39]
ds_read_b64_tr_b16 a[32:33], v12 offset:0
ds_read_b64_tr_b16 a[34:35], v12 offset:2048
M v[40:43], a[112:115], a[160:163], v[40:43]
M v[40:43], a[116:119], a[164:167], v[40:43]
M v[44:47], a[124:127], a[164:167], v[44:47]
M v[44:47], a[120:123], a[160:163], v[44:47]
ds_read_b64_tr_b16 a[40:41], v13 offset:0
ds_read_b64_tr_b16 a[42:43], v13 offset:2048
M v[48:51], a[128:131], a[160:163], v[48:51]
buffer_load_dwordx4 v7, s[12:15], s24 offen offset:1024 lds
M v[48:51], a[132:135], a[164:167], v[48:51]
M v[52:55], a[140:143], a[164:167], v[52:55]
M v[52:55], a[136:139], a[160:163], v[52:55]
ds_read_b64_tr_b16 a[48:49], v14 offset:0
ds_read_b64_tr_b16 a[50:51], v14 offset:2048
M v[56:59], a[144:147], a[160:163], v[56:59]
M v[56:59], a[148:151], a[164:167], v[56:59]
M v[60:63], a[156:159], a[164:167], v[60:63]
buffer_load_dwordx4 v8, s[12:15], s24 offen offset:2048 lds
M v[60:63], a[152:155], a[160:163], v[60:63]
s_waitcnt lgkmcnt(8)
ds_read_b64_tr_b16 a[56:57], v15 offset:0
ds_read_b64_tr_b16 a[58:59], v15 offset:2048
M v[64:67], a[96:99], a[168:171], v[64:67]
M v[64:67], a[100:103], a[172:175], v[64:67]
ds_read_b128 a[184:187], v10 offset:38912
ds_read_b128 a[188:191], v11 offset:38912
M v[68:71], a[108:111], a[172:175], v[68:71]
M v[68:71], a[104:107], a[168:171], v[68:71]
ds_read_b64_tr_b16 a[64:65], v16 offset:0
ds_read_b64_tr_b16 a[66:67], v16 offset:2048
M v[72:75], a[112:115], a[168:171], v[72:75]
M v[72:75], a[116:119], a[172:175], v[72:75]
M v[76:79], a[124:127], a[172:175], v[76:79]
M v[76:79], a[120:123], a[168:171], v[76:79]
ds_read_b64_tr_b16 a[72:73], v17 offset:0
ds_read_b64_tr_b16 a[74:75], v17 offset:2048
M v[80:83], a[128:131], a[168:171], v[80:83]
buffer_load_dwordx4 v9, s[12:15], s24 offen offset:3072 lds
M v[80:83], a[132:135], a[172:175], v[80:83]
M v[84:87], a[140:143], a[172:175], v[84:87]
M v[84:87], a[136:139], a[168:171], v[84:87]
ds_read_b64_tr_b16 a[80:81], v18 offset:0
ds_read_b64_tr_b16 a[82:83], v18 offset:2048
M v[88:91], a[144:147], a[168:171], v[88:91]
M v[88:91], a[148:151], a[172:175], v[88:91]
M v[92:95], a[156:159], a[172:175], v[92:95]
s_add_u32 s24, s24, 262144
M v[92:95], a[152:155], a[168:171], v[92:95]
s_waitcnt lgkmcnt(15)
ds_read_b64_tr_b16 a[88:89], v19 offset:0
ds_read_b64_tr_b16 a[90:91], v19 offset:2048
M v[96:99], a[96:99], a[176:179], v[96:99]
M v[96:99], a[100:103], a[180:183], v[96:99]
M v[100:103], a[108:111], a[180:183], v[100:103]
M v[100:103], a[104:107], a[176:179], v[100:103]
M v[104:107], a[112:115], a[176:179], v[104:107]
M v[104:107], a[116:119], a[180:183], v[104:107]
M v[108:111], a[124:127], a[180:183], v[108:111]
M v[108:111], a[120:123], a[176:179], v[108:111]
s_waitcnt vmcnt(8) lgkmcnt(0)
s_barrier
ds_read_b128 a[160:163], v10 offset:49152
ds_read_b128 a[164:167], v11 offset:49152
M v[112:115], a[128:131], a[176:179], v[112:115]
s_add_u32 m0, s29, 16384
s_add_u32 s3, s23, s31
buffer_load_dwordx4 v2, s[8:11], s3 offen offset:0 lds
M v[112:115], a[132:135], a[180:183], v[112:115]
M v[116:119], a[140:143], a[180:183], v[116:119]
M v[116:119], a[136:139], a[176:179], v[116:119]
ds_read_b64_tr_b16 a[36:37], v12 offset:16384
ds_read_b64_tr_b16 a[38:39], v12 offset:18432
M v[120:123], a[144:147], a[176:179], v[120:123]
M v[120:123], a[148:151], a[180:183], v[120:123]
buffer_load_dwordx4 v3, s[8:11], s3 offen offset:1024 lds
M v[124:127], a[156:159], a[180:183], v[124:127]
M v[124:127], a[152:155], a[176:179], v[124:127]
M v[128:131], a[96:99], a[184:187], v[128:131]
M v[128:131], a[100:103], a[188:191], v[128:131]
ds_read_b128 a[168:171], v10 offset:51200
ds_read_b128 a[172:175], v11 offset:51200
ds_read_b64_tr_b16 a[44:45], v13 offset:16384
ds_read_b64_tr_b16 a[46:47], v13 offset:18432
M v[132:135], a[108:111], a[188:191], v[132:135]
M v[132:135], a[104:107], a[184:187], v[132:135]
M v[136:139], a[112:115], a[184:187], v[136:139]
buffer_load_dwordx4 v4, s[8:11], s3 offen offset:2048 lds
M v[136:139], a[116:119], a[188:191], v[136:139]
M v[140:143], a[124:127], a[188:191], v[140:143]
M v[140:143], a[120:123], a[184:187], v[140:143]
ds_read_b64_tr_b16 a[52:53], v14 offset:16384
ds_read_b64_tr_b16 a[54:55], v14 offset:18432
M v[144:147], a[128:131], a[184:187], v[144:147]
M v[144:147], a[132:135], a[188:191], v[144:147]
M v[148:151], a[140:143], a[188:191], v[148:151]
buffer_load_dwordx4 v5, s[8:11], s3 offen offset:3072 lds
M v[148:151], a[136:139], a[184:187], v[148:151]
M v[152:155], a[144:147], a[184:187], v[152:155]
M v[152:155], a[148:151], a[188:191], v[152:155]
ds_read_b64_tr_b16 a[60:61], v15 offset:16384
ds_read_b64_tr_b16 a[62:63], v15 offset:18432
M v[156:159], a[156:159], a[188:191], v[156:159]
M v[156:159], a[152:155], a[184:187], v[156:159]
s_waitcnt lgkmcnt(10)
M v[160:163], a[96:99], a[160:163], v[160:163]
M v[160:163], a[100:103], a[164:167], v[160:163]
ds_read_b128 a[176:179], v10 offset:53248
ds_read_b128 a[180:183], v11 offset:53248
M v[164:167], a[108:111], a[164:167], v[164:167]
s_add_u32 s23, s23, 128
s_cmp_eq_u32 s23, s25
s_cselect_b32 s23, s26, s23
M v[164:167], a[104:107], a[160:163], v[164:167]
ds_read_b64_tr_b16 a[68:69], v16 offset:16384
ds_read_b64_tr_b16 a[70:71], v16 offset:18432
M v[168:171], a[112:115], a[160:163], v[168:171]
M v[168:171], a[116:119], a[164:167], v[168:171]
M v[172:175], a[124:127], a[164:167], v[172:175]
M v[172:175], a[120:123], a[160:163], v[172:175]
M v[176:179], a[128:131], a[160:163], v[176:179]
s_add_u32 m0, s29, 114688
s_nop 0
buffer_load_dwordx4 v6, s[12:15], s24 offen offset:0 lds
M v[176:179], a[132:135], a[164:167], v[176:179]
ds_read_b64_tr_b16 a[76:77], v17 offset:16384
ds_read_b64_tr_b16 a[78:79], v17 offset:18432
M v[180:183], a[140:143], a[164:167], v[180:183]
M v[180:183], a[136:139], a[160:163], v[180:183]
M v[184:187], a[144:147], a[160:163], v[184:187]
M v[184:187], a[148:151], a[164:167], v[184:187]
buffer_load_dwordx4 v7, s[12:15], s24 offen offset:1024 lds
M v[188:191], a[156:159], a[164:167], v[188:191]
M v[188:191], a[152:155], a[160:163], v[188:191]
s_waitcnt lgkmcnt(12)
ds_read_b64_tr_b16 a[84:85], v18 offset:16384
ds_read_b64_tr_b16 a[86:87], v18 offset:18432
M v[192:195], a[96:99], a[168:171], v[192:195]
M v[192:195], a[100:103], a[172:175], v[192:195]
ds_read_b128 a[184:187], v10 offset:55296
ds_read_b128 a[188:191], v11 offset:55296
M v[196:199], a[108:111], a[172:175], v[196:199]
M v[196:199], a[104:107], a[168:171], v[196:199]
M v[200:203], a[112:115], a[168:171], v[200:203]
buffer_load_dwordx4 v8, s[12:15], s24 offen offset:2048 lds
M v[200:203], a[116:119], a[172:175], v[200:203]
ds_read_b64_tr_b16 a[92:93], v19 offset:16384
ds_read_b64_tr_b16 a[94:95], v19 offset:18432
M v[204:207], a[124:127], a[172:175], v[204:207]
M v[204:207], a[120:123], a[168:171], v[204:207]
M v[208:211], a[128:131], a[168:171], v[208:211]
M v[208:211], a[132:135], a[172:175], v[208:211]
M v[212:215], a[140:143], a[172:175], v[212:215]
buffer_load_dwordx4 v9, s[12:15], s24 offen offset:3072 lds
M v[212:215], a[136:139], a[168:171], v[212:215]
M v[216:219], a[144:147], a[168:171], v[216:219]
M v[216:219], a[148:151], a[172:175], v[216:219]
M v[220:223], a[156:159], a[172:175], v[220:223]
M v[220:223], a[152:155], a[168:171], v[220:223]
s_waitcnt lgkmcnt(10)
M v[224:227], a[96:99], a[176:179], v[224:227]
s_add_u32 s24, s24, 262144
s_cmp_eq_u32 s24, s27
s_cselect_b32 s24, s28, s24
s_sub_u32 s6, s6, 1
s_cmp_eq_u32 s6, 0
s_cselect_b64 s[12:13], s[64:65], s[12:13]
M v[224:227], a[100:103], a[180:183], v[224:227]
M v[228:231], a[108:111], a[180:183], v[228:231]
M v[228:231], a[104:107], a[176:179], v[228:231]
M v[232:235], a[112:115], a[176:179], v[232:235]
M v[232:235], a[116:119], a[180:183], v[232:235]
M v[236:239], a[124:127], a[180:183], v[236:239]
M v[236:239], a[120:123], a[176:179], v[236:239]
s_waitcnt vmcnt(8) lgkmcnt(0)
s_barrier
ds_read_b128 a[160:163], v10 offset:0
ds_read_b128 a[164:167], v11 offset:0
M v[240:243], a[128:131], a[176:179], v[240:243]
s_add_u32 m0, s29, 32768
s_nop 0
buffer_load_dwordx4 v2, s[8:11], s23 offen offset:0 lds
M v[240:243], a[132:135], a[180:183], v[240:243]
M v[244:247], a[140:143], a[180:183], v[244:247]
M v[244:247], a[136:139], a[176:179], v[244:247]
M v[248:251], a[144:147], a[176:179], v[248:251]
M v[248:251], a[148:151], a[180:183], v[248:251]
buffer_load_dwordx4 v3, s[8:11], s23 offen offset:1024 lds
M v[252:255], a[156:159], a[180:183], v[252:255]
M v[252:255], a[152:155], a[176:179], v[252:255]
M a[0:3], a[96:99], a[184:187], a[0:3]
M a[0:3], a[100:103], a[188:191], a[0:3]
ds_read_b128 a[168:171], v10 offset:2048
ds_read_b128 a[172:175], v11 offset:2048
M a[4:7], a[108:111], a[188:191], a[4:7]
M a[4:7], a[104:107], a[184:187], a[4:7]
M a[8:11], a[112:115], a[184:187], a[8:11]
buffer_load_dwordx4 v4, s[8:11], s23 offen offset:2048 lds
M a[8:11], a[116:119], a[188:191], a[8:11]
M a[12:15], a[124:127], a[188:191], a[12:15]
M a[12:15], a[120:123], a[184:187], a[12:15]
M a[16:19], a[128:131], a[184:187], a[16:19]
M a[16:19], a[132:135], a[188:191], a[16:19]
buffer_load_dwordx4 v5, s[8:11], s23 offen offset:3072 lds
M a[20:23], a[140:143], a[188:191], a[20:23]
M a[20:23], a[136:139], a[184:187], a[20:23]
M a[24:27], a[144:147], a[184:187], a[24:27]
M a[24:27], a[148:151], a[188:191], a[24:27]
M a[28:31], a[156:159], a[188:191], a[28:31]
M a[28:31], a[152:155], a[184:187], a[28:31]
s_waitcnt lgkmcnt(2)
s_sub_u32 s30, s30, 1
s_cmp_lg_u32 s30, 0
s_cbranch_scc1 Lk1_kl
M v[32:35], a[32:35], a[160:163], v[32:35]
s_add_u32 m0, s29, 65536
s_nop 0
buffer_load_dwordx4 v6, s[12:15], s24 offen offset:0 lds
M v[32:35], a[36:39], a[164:167], v[32:35]
ds_read_b128 a[176:179], v10 offset:4096
ds_read_b128 a[180:183], v11 offset:4096
M v[36:39], a[44:47], a[164:167], v[36:39]
M v[36:39], a[40:43], a[160:163], v[36:39]
ds_read_b64_tr_b16 a[96:97], v12 offset:32768
ds_read_b64_tr_b16 a[98:99], v12 offset:34816
M v[40:43], a[48:51], a[160:163], v[40:43]
M v[40:43], a[52:55], a[164:167], v[40:43]
M v[44:47], a[60:63], a[164:167], v[44:47]
M v[44:47], a[56:59], a[160:163], v[44:47]
ds_read_b64_tr_b16 a[104:105], v13 offset:32768
ds_read_b64_tr_b16 a[106:107], v13 offset:34816
M v[48:51], a[64:67], a[160:163], v[48:51]
buffer_load_dwordx4 v7, s[12:15], s24 offen offset:1024 lds
M v[48:51], a[68:71], a[164:167], v[48:51]
M v[52:55], a[76:79], a[164:167], v[52:55]
M v[52:55], a[72:75], a[160:163], v[52:55]
ds_read_b64_tr_b16 a[112:113], v14 offset:32768
ds_read_b64_tr_b16 a[114:115], v14 offset:34816
M v[56:59], a[80:83], a[160:163], v[56:59]
M v[56:59], a[84:87], a[164:167], v[56:59]
M v[60:63], a[92:95], a[164:167], v[60:63]
buffer_load_dwordx4 v8, s[12:15], s24 offen offset:2048 lds
M v[60:63], a[88:91], a[160:163], v[60:63]
s_waitcnt lgkmcnt(8)
ds_read_b64_tr_b16 a[120:121], v15 offset:32768
ds_read_b64_tr_b16 a[122:123], v15 offset:34816
M v[64:67], a[32:35], a[168:171], v[64:67]
M v[64:67], a[36:39], a[172:175], v[64:67]
ds_read_b128 a[184:187], v10 offset:6144
ds_read_b128 a[188:191], v11 offset:6144
M v[68:71], a[44:47], a[172:175], v[68:71]
M v[68:71], a[40:43], a[168:171], v[68:71]
ds_read_b64_tr_b16 a[128:129], v16 offset:32768
ds_read_b64_tr_b16 a[130:131], v16 offset:34816
M v[72:75], a[48:51], a[168:171], v[72:75]
M v[72:75], a[52:55], a[172:175], v[72:75]
M v[76:79], a[60:63], a[172:175], v[76:79]
M v[76:79], a[56:59], a[168:171], v[76:79]
ds_read_b64_tr_b16 a[136:137], v17 offset:32768
ds_read_b64_tr_b16 a[138:139], v17 offset:34816
M v[80:83], a[64:67], a[168:171], v[80:83]
buffer_load_dwordx4 v9, s[12:15], s24 offen offset:3072 lds
M v[80:83], a[68:71], a[172:175], v[80:83]
M v[84:87], a[76:79], a[172:175], v[84:87]
M v[84:87], a[72:75], a[168:171], v[84:87]
ds_read_b64_tr_b16 a[144:145], v18 offset:32768
ds_read_b64_tr_b16 a[146:147], v18 offset:34816
M v[88:91], a[80:83], a[168:171], v[88:91]
M v[88:91], a[84:87], a[172:175], v[88:91]
M v[92:95], a[92:95], a[172:175], v[92:95]
s_add_u32 s24, s24, 262144
M v[92:95], a[88:91], a[168:171], v[92:95]
s_waitcnt lgkmcnt(15)
ds_read_b64_tr_b16 a[152:153], v19 offset:32768
ds_read_b64_tr_b16 a[154:155], v19 offset:34816
M v[96:99], a[32:35], a[176:179], v[96:99]
M v[96:99], a[36:39], a[180:183], v[96:99]
M v[100:103], a[44:47], a[180:183], v[100:103]
M v[100:103], a[40:43], a[176:179], v[100:103]
M v[104:107], a[48:51], a[176:179], v[104:107]
M v[104:107], a[52:55], a[180:183], v[104:107]
M v[108:111], a[60:63], a[180:183], v[108:111]
M v[108:111], a[56:59], a[176:179], v[108:111]
s_waitcnt vmcnt(8) lgkmcnt(0)
s_barrier
ds_read_b128 a[160:163], v10 offset:16384
ds_read_b128 a[164:167], v11 offset:16384
M v[112:115], a[64:67], a[176:179], v[112:115]
s_add_u32 m0, s29, 49152
s_add_u32 s3, s23, s31
buffer_load_dwordx4 v2, s[8:11], s3 offen offset:0 lds
M v[112:115], a[68:71], a[180:183], v[112:115]
M v[116:119], a[76:79], a[180:183], v[116:119]
M v[116:119], a[72:75], a[176:179], v[116:119]
ds_read_b64_tr_b16 a[100:101], v12 offset:49152
ds_read_b64_tr_b16 a[102:103], v12 offset:51200
M v[120:123], a[80:83], a[176:179], v[120:123]
M v[120:123], a[84:87], a[180:183], v[120:123]
buffer_load_dwordx4 v3, s[8:11], s3 offen offset:1024 lds
M v[124:127], a[92:95], a[180:183], v[124:127]
M v[124:127], a[88:91], a[176:179], v[124:127]
M v[128:131], a[32:35], a[184:187], v[128:131]
M v[128:131], a[36:39], a[188:191], v[128:131]
ds_read_b128 a[168:171], v10 offset:18432
ds_read_b128 a[172:175], v11 offset:18432
ds_read_b64_tr_b16 a[108:109], v13 offset:49152
ds_read_b64_tr_b16 a[110:111], v13 offset:51200
M v[132:135], a[44:47], a[188:191], v[132:135]
M v[132:135], a[40:43], a[184:187], v[132:135]
M v[136:139], a[48:51], a[184:187], v[136:139]
buffer_load_dwordx4 v4, s[8:11], s3 offen offset:2048 lds
M v[136:139], a[52:55], a[188:191], v[136:139]
M v[140:143], a[60:63], a[188:191], v[140:143]
M v[140:143], a[56:59], a[184:187], v[140:143]
ds_read_b64_tr_b16 a[116:117], v14 offset:49152
ds_read_b64_tr_b16 a[118:119], v14 offset:51200
M v[144:147], a[64:67], a[184:187], v[144:147]
M v[144:147], a[68:71], a[188:191], v[144:147]
M v[148:151], a[76:79], a[188:191], v[148:151]
buffer_load_dwordx4 v5, s[8:11], s3 offen offset:3072 lds
M v[148:151], a[72:75], a[184:187], v[148:151]
M v[152:155], a[80:83], a[184:187], v[152:155]
s_lshr_b32 s95, s53, 7
s_add_u32 s95, s95, s22
M v[152:155], a[84:87], a[188:191], v[152:155]
ds_read_b64_tr_b16 a[124:125], v15 offset:49152
ds_read_b64_tr_b16 a[126:127], v15 offset:51200
s_lshl_b32 s95, s95, 5
s_lshr_b32 s19, s52, 6
M v[156:159], a[92:95], a[188:191], v[156:159]
s_add_u32 s95, s95, s19
s_lshl_b32 s19, s21, 1
M v[156:159], a[88:91], a[184:187], v[156:159]
s_waitcnt lgkmcnt(10)
s_add_u32 s95, s95, s19
s_lshl_b32 s92, s95, 15
M v[160:163], a[32:35], a[160:163], v[160:163]
s_add_u32 s93, s92, 32768
s_add_u32 s16, s50, 16777216
M v[160:163], a[36:39], a[164:167], v[160:163]
ds_read_b128 a[176:179], v10 offset:20480
ds_read_b128 a[180:183], v11 offset:20480
s_addc_u32 s17, s51, 0
s_mov_b32 s18, 33554432
M v[164:167], a[44:47], a[164:167], v[164:167]
s_add_u32 s23, s23, 128
s_cmp_eq_u32 s23, s25
s_cselect_b32 s23, s26, s23
s_mov_b32 s19, 0x00020000
M v[164:167], a[40:43], a[160:163], v[164:167]
ds_read_b64_tr_b16 a[132:133], v16 offset:49152
ds_read_b64_tr_b16 a[134:135], v16 offset:51200
M v[168:171], a[48:51], a[160:163], v[168:171]
M v[168:171], a[52:55], a[164:167], v[168:171]
M v[172:175], a[60:63], a[164:167], v[172:175]
M v[172:175], a[56:59], a[160:163], v[172:175]
M v[176:179], a[64:67], a[160:163], v[176:179]
s_add_u32 m0, s29, 81920
s_nop 0
buffer_load_dwordx4 v6, s[12:15], s24 offen offset:0 lds
M v[176:179], a[68:71], a[164:167], v[176:179]
ds_read_b64_tr_b16 a[140:141], v17 offset:49152
ds_read_b64_tr_b16 a[142:143], v17 offset:51200
M v[180:183], a[76:79], a[164:167], v[180:183]
M v[180:183], a[72:75], a[160:163], v[180:183]
M v[184:187], a[80:83], a[160:163], v[184:187]
M v[184:187], a[84:87], a[164:167], v[184:187]
buffer_load_dwordx4 v7, s[12:15], s24 offen offset:1024 lds
M v[188:191], a[92:95], a[164:167], v[188:191]
M v[188:191], a[88:91], a[160:163], v[188:191]
s_waitcnt lgkmcnt(12)
ds_read_b64_tr_b16 a[148:149], v18 offset:49152
ds_read_b64_tr_b16 a[150:151], v18 offset:51200
M v[192:195], a[32:35], a[168:171], v[192:195]
M v[192:195], a[36:39], a[172:175], v[192:195]
ds_read_b128 a[184:187], v10 offset:22528
ds_read_b128 a[188:191], v11 offset:22528
M v[196:199], a[44:47], a[172:175], v[196:199]
M v[196:199], a[40:43], a[168:171], v[196:199]
M v[200:203], a[48:51], a[168:171], v[200:203]
buffer_load_dwordx4 v8, s[12:15], s24 offen offset:2048 lds
M v[200:203], a[52:55], a[172:175], v[200:203]
ds_read_b64_tr_b16 a[156:157], v19 offset:49152
ds_read_b64_tr_b16 a[158:159], v19 offset:51200
M v[204:207], a[60:63], a[172:175], v[204:207]
M v[204:207], a[56:59], a[168:171], v[204:207]
M v[208:211], a[64:67], a[168:171], v[208:211]
M v[208:211], a[68:71], a[172:175], v[208:211]
M v[212:215], a[76:79], a[172:175], v[212:215]
buffer_load_dwordx4 v9, s[12:15], s24 offen offset:3072 lds
M v[212:215], a[72:75], a[168:171], v[212:215]
M v[216:219], a[80:83], a[168:171], v[216:219]
M v[216:219], a[84:87], a[172:175], v[216:219]
M v[220:223], a[92:95], a[172:175], v[220:223]
M v[220:223], a[88:91], a[168:171], v[220:223]
s_waitcnt lgkmcnt(10)
M v[224:227], a[32:35], a[176:179], v[224:227]
s_add_u32 s24, s24, 262144
s_cmp_eq_u32 s24, s27
s_cselect_b32 s24, s28, s24
s_sub_u32 s6, s6, 1
s_cmp_eq_u32 s6, 0
s_cselect_b64 s[12:13], s[64:65], s[12:13]
M v[224:227], a[36:39], a[180:183], v[224:227]
M v[228:231], a[44:47], a[180:183], v[228:231]
M v[228:231], a[40:43], a[176:179], v[228:231]
M v[232:235], a[48:51], a[176:179], v[232:235]
M v[232:235], a[52:55], a[180:183], v[232:235]
M v[236:239], a[60:63], a[180:183], v[236:239]
M v[236:239], a[56:59], a[176:179], v[236:239]
s_waitcnt vmcnt(8) lgkmcnt(0)
s_barrier
ds_read_b128 a[160:163], v10 offset:32768
ds_read_b128 a[164:167], v11 offset:32768
M v[240:243], a[64:67], a[176:179], v[240:243]
s_add_u32 m0, s29, 0
s_nop 0
buffer_load_dwordx4 v2, s[8:11], s23 offen offset:0 lds
M v[240:243], a[68:71], a[180:183], v[240:243]
M v[244:247], a[76:79], a[180:183], v[244:247]
M v[244:247], a[72:75], a[176:179], v[244:247]
M v[248:251], a[80:83], a[176:179], v[248:251]
M v[248:251], a[84:87], a[180:183], v[248:251]
buffer_load_dwordx4 v3, s[8:11], s23 offen offset:1024 lds
M v[252:255], a[92:95], a[180:183], v[252:255]
M v[252:255], a[88:91], a[176:179], v[252:255]
M a[0:3], a[32:35], a[184:187], a[0:3]
M a[0:3], a[36:39], a[188:191], a[0:3]
ds_read_b128 a[168:171], v10 offset:34816
ds_read_b128 a[172:175], v11 offset:34816
M a[4:7], a[44:47], a[188:191], a[4:7]
M a[4:7], a[40:43], a[184:187], a[4:7]
M a[8:11], a[48:51], a[184:187], a[8:11]
buffer_load_dwordx4 v4, s[8:11], s23 offen offset:2048 lds
M a[8:11], a[52:55], a[188:191], a[8:11]
M a[12:15], a[60:63], a[188:191], a[12:15]
M a[12:15], a[56:59], a[184:187], a[12:15]
M a[16:19], a[64:67], a[184:187], a[16:19]
M a[16:19], a[68:71], a[188:191], a[16:19]
buffer_load_dwordx4 v5, s[8:11], s23 offen offset:3072 lds
M a[20:23], a[76:79], a[188:191], a[20:23]
M a[20:23], a[72:75], a[184:187], a[20:23]
M a[24:27], a[80:83], a[184:187], a[24:27]
M a[24:27], a[84:87], a[188:191], a[24:27]
M a[28:31], a[92:95], a[188:191], a[28:31]
M a[28:31], a[88:91], a[184:187], a[28:31]
s_waitcnt lgkmcnt(2)
M v[32:35], a[96:99], a[160:163], v[32:35]
s_add_u32 m0, s29, 98304
s_nop 0
buffer_load_dwordx4 v6, s[12:15], s24 offen offset:0 lds
M v[32:35], a[100:103], a[164:167], v[32:35]
ds_read_b128 a[176:179], v10 offset:36864
ds_read_b128 a[180:183], v11 offset:36864
M v[36:39], a[108:111], a[164:167], v[36:39]
M v[36:39], a[104:107], a[160:163], v[36:39]
ds_read_b64_tr_b16 a[32:33], v12 offset:0
ds_read_b64_tr_b16 a[34:35], v12 offset:2048
M v[40:43], a[112:115], a[160:163], v[40:43]
M v[40:43], a[116:119], a[164:167], v[40:43]
M v[44:47], a[124:127], a[164:167], v[44:47]
M v[44:47], a[120:123], a[160:163], v[44:47]
ds_read_b64_tr_b16 a[40:41], v13 offset:0
ds_read_b64_tr_b16 a[42:43], v13 offset:2048
M v[48:51], a[128:131], a[160:163], v[48:51]
buffer_load_dwordx4 v7, s[12:15], s24 offen offset:1024 lds
M v[48:51], a[132:135], a[164:167], v[48:51]
M v[52:55], a[140:143], a[164:167], v[52:55]
M v[52:55], a[136:139], a[160:163], v[52:55]
ds_read_b64_tr_b16 a[48:49], v14 offset:0
ds_read_b64_tr_b16 a[50:51], v14 offset:2048
M v[56:59], a[144:147], a[160:163], v[56:59]
M v[56:59], a[148:151], a[164:167], v[56:59]
M v[60:63], a[156:159], a[164:167], v[60:63]
buffer_load_dwordx4 v8, s[12:15], s24 offen offset:2048 lds
M v[60:63], a[152:155], a[160:163], v[60:63]
s_waitcnt lgkmcnt(8)
ds_read_b64_tr_b16 a[56:57], v15 offset:0
ds_read_b64_tr_b16 a[58:59], v15 offset:2048
M v[64:67], a[96:99], a[168:171], v[64:67]
M v[64:67], a[100:103], a[172:175], v[64:67]
ds_read_b128 a[184:187], v10 offset:38912
ds_read_b128 a[188:191], v11 offset:38912
M v[68:71], a[108:111], a[172:175], v[68:71]
M v[68:71], a[104:107], a[168:171], v[68:71]
ds_read_b64_tr_b16 a[64:65], v16 offset:0
ds_read_b64_tr_b16 a[66:67], v16 offset:2048
v_cvt_pk_bf16_f32 v32, v32, v33
v_cvt_pk_bf16_f32 v33, v34, v35
M v[72:75], a[112:115], a[168:171], v[72:75]
v_cvt_pk_bf16_f32 v34, v36, v37
v_cvt_pk_bf16_f32 v35, v38, v39
M v[72:75], a[116:119], a[172:175], v[72:75]
v_cvt_pk_bf16_f32 v40, v40, v41
v_cvt_pk_bf16_f32 v41, v42, v43
M v[76:79], a[124:127], a[172:175], v[76:79]
buffer_load_dwordx4 v9, s[12:15], s24 offen offset:3072 lds
v_cvt_pk_bf16_f32 v42, v44, v45
v_cvt_pk_bf16_f32 v43, v46, v47
M v[76:79], a[120:123], a[168:171], v[76:79]
ds_read_b64_tr_b16 a[72:73], v17 offset:0
ds_read_b64_tr_b16 a[74:75], v17 offset:2048
v_cvt_pk_bf16_f32 v48, v48, v49
v_cvt_pk_bf16_f32 v49, v50, v51
M v[80:83], a[128:131], a[168:171], v[80:83]
v_cvt_pk_bf16_f32 v50, v52, v53
v_cvt_pk_bf16_f32 v51, v54, v55
M v[80:83], a[132:135], a[172:175], v[80:83]
v_cvt_pk_bf16_f32 v56, v56, v57
v_cvt_pk_bf16_f32 v57, v58, v59
M v[84:87], a[140:143], a[172:175], v[84:87]
v_cvt_pk_bf16_f32 v58, v60, v61
v_cvt_pk_bf16_f32 v59, v62, v63
M v[84:87], a[136:139], a[168:171], v[84:87]
ds_read_b64_tr_b16 a[80:81], v18 offset:0
ds_read_b64_tr_b16 a[82:83], v18 offset:2048
M v[88:91], a[144:147], a[168:171], v[88:91]
M v[88:91], a[148:151], a[172:175], v[88:91]
s_add_u32 s24, s24, 262144
M v[92:95], a[156:159], a[172:175], v[92:95]
s_add_u32 s94, s92, 0
buffer_store_dwordx4 v[32:35], v1, s[16:19], s94 offen offset:0 sc1
M v[92:95], a[152:155], a[168:171], v[92:95]
s_waitcnt lgkmcnt(15)
ds_read_b64_tr_b16 a[88:89], v19 offset:0
ds_read_b64_tr_b16 a[90:91], v19 offset:2048
M v[96:99], a[96:99], a[176:179], v[96:99]
M v[96:99], a[100:103], a[180:183], v[96:99]
M v[100:103], a[108:111], a[180:183], v[100:103]
M v[100:103], a[104:107], a[176:179], v[100:103]
v_cvt_pk_bf16_f32 v64, v64, v65
v_cvt_pk_bf16_f32 v65, v66, v67
M v[104:107], a[112:115], a[176:179], v[104:107]
v_cvt_pk_bf16_f32 v66, v68, v69
v_cvt_pk_bf16_f32 v67, v70, v71
M v[104:107], a[116:119], a[180:183], v[104:107]
v_cvt_pk_bf16_f32 v72, v72, v73
v_cvt_pk_bf16_f32 v73, v74, v75
M v[108:111], a[124:127], a[180:183], v[108:111]
v_cvt_pk_bf16_f32 v74, v76, v77
v_cvt_pk_bf16_f32 v75, v78, v79
M v[108:111], a[120:123], a[176:179], v[108:111]
s_waitcnt vmcnt(9) lgkmcnt(0)
s_barrier
ds_read_b128 a[160:163], v10 offset:49152
ds_read_b128 a[164:167], v11 offset:49152
v_cvt_pk_bf16_f32 v80, v80, v81
v_cvt_pk_bf16_f32 v81, v82, v83
M v[112:115], a[128:131], a[176:179], v[112:115]
s_add_u32 s94, s92, 0
buffer_store_dwordx4 v[40:43], v1, s[16:19], s94 offen offset:1024 sc1
v_cvt_pk_bf16_f32 v82, v84, v85
v_cvt_pk_bf16_f32 v83, v86, v87
M v[112:115], a[132:135], a[180:183], v[112:115]
s_add_u32 m0, s29, 16384
s_add_u32 s3, s23, s31
buffer_load_dwordx4 v2, s[8:11], s3 offen offset:0 lds
v_cvt_pk_bf16_f32 v88, v88, v89
v_cvt_pk_bf16_f32 v89, v90, v91
M v[116:119], a[140:143], a[180:183], v[116:119]
v_cvt_pk_bf16_f32 v90, v92, v93
v_cvt_pk_bf16_f32 v91, v94, v95
M v[116:119], a[136:139], a[176:179], v[116:119]
ds_read_b64_tr_b16 a[36:37], v12 offset:16384
ds_read_b64_tr_b16 a[38:39], v12 offset:18432
M v[120:123], a[144:147], a[176:179], v[120:123]
M v[120:123], a[148:151], a[180:183], v[120:123]
M v[124:127], a[156:159], a[180:183], v[124:127]
buffer_load_dwordx4 v3, s[8:11], s3 offen offset:1024 lds
M v[124:127], a[152:155], a[176:179], v[124:127]
M v[128:131], a[96:99], a[184:187], v[128:131]
M v[128:131], a[100:103], a[188:191], v[128:131]
ds_read_b128 a[168:171], v10 offset:51200
ds_read_b128 a[172:175], v11 offset:51200
ds_read_b64_tr_b16 a[44:45], v13 offset:16384
ds_read_b64_tr_b16 a[46:47], v13 offset:18432
M v[132:135], a[108:111], a[188:191], v[132:135]
M v[132:135], a[104:107], a[184:187], v[132:135]
s_add_u32 s94, s92, 0
buffer_store_dwordx4 v[48:51], v1, s[16:19], s94 offen offset:2048 sc1
v_cvt_pk_bf16_f32 v96, v96, v97
v_cvt_pk_bf16_f32 v97, v98, v99
M v[136:139], a[112:115], a[184:187], v[136:139]
v_cvt_pk_bf16_f32 v98, v100, v101
v_cvt_pk_bf16_f32 v99, v102, v103
M v[136:139], a[116:119], a[188:191], v[136:139]
buffer_load_dwordx4 v4, s[8:11], s3 offen offset:2048 lds
v_cvt_pk_bf16_f32 v104, v104, v105
v_cvt_pk_bf16_f32 v105, v106, v107
M v[140:143], a[124:127], a[188:191], v[140:143]
v_cvt_pk_bf16_f32 v106, v108, v109
v_cvt_pk_bf16_f32 v107, v110, v111
M v[140:143], a[120:123], a[184:187], v[140:143]
ds_read_b64_tr_b16 a[52:53], v14 offset:16384
ds_read_b64_tr_b16 a[54:55], v14 offset:18432
v_cvt_pk_bf16_f32 v112, v112, v113
v_cvt_pk_bf16_f32 v113, v114, v115
M v[144:147], a[128:131], a[184:187], v[144:147]
v_cvt_pk_bf16_f32 v114, v116, v117
v_cvt_pk_bf16_f32 v115, v118, v119
M v[144:147], a[132:135], a[188:191], v[144:147]
v_cvt_pk_bf16_f32 v120, v120, v121
v_cvt_pk_bf16_f32 v121, v122, v123
M v[148:151], a[140:143], a[188:191], v[148:151]
buffer_load_dwordx4 v5, s[8:11], s3 offen offset:3072 lds
v_cvt_pk_bf16_f32 v122, v124, v125
v_cvt_pk_bf16_f32 v123, v126, v127
M v[148:151], a[136:139], a[184:187], v[148:151]
M v[152:155], a[144:147], a[184:187], v[152:155]
M v[152:155], a[148:151], a[188:191], v[152:155]
ds_read_b64_tr_b16 a[60:61], v15 offset:16384
ds_read_b64_tr_b16 a[62:63], v15 offset:18432
M v[156:159], a[156:159], a[188:191], v[156:159]
s_add_u32 s94, s92, 0
buffer_store_dwordx4 v[56:59], v1, s[16:19], s94 offen offset:3072 sc1
M v[156:159], a[152:155], a[184:187], v[156:159]
s_waitcnt lgkmcnt(10)
M v[160:163], a[96:99], a[160:163], v[160:163]
M v[160:163], a[100:103], a[164:167], v[160:163]
ds_read_b128 a[176:179], v10 offset:53248
ds_read_b128 a[180:183], v11 offset:53248
M v[164:167], a[108:111], a[164:167], v[164:167]
s_add_u32 s23, s23, 128
s_cmp_eq_u32 s23, s25
s_cselect_b32 s23, s26, s23
M v[164:167], a[104:107], a[160:163], v[164:167]
ds_read_b64_tr_b16 a[68:69], v16 offset:16384
ds_read_b64_tr_b16 a[70:71], v16 offset:18432
v_cvt_pk_bf16_f32 v128, v128, v129
v_cvt_pk_bf16_f32 v129, v130, v131
M v[168:171], a[112:115], a[160:163], v[168:171]
v_cvt_pk_bf16_f32 v130, v132, v133
v_cvt_pk_bf16_f32 v131, v134, v135
M v[168:171], a[116:119], a[164:167], v[168:171]
v_cvt_pk_bf16_f32 v136, v136, v137
v_cvt_pk_bf16_f32 v137, v138, v139
M v[172:175], a[124:127], a[164:167], v[172:175]
v_cvt_pk_bf16_f32 v138, v140, v141
v_cvt_pk_bf16_f32 v139, v142, v143
M v[172:175], a[120:123], a[160:163], v[172:175]
v_cvt_pk_bf16_f32 v144, v144, v145
v_cvt_pk_bf16_f32 v145, v146, v147
M v[176:179], a[128:131], a[160:163], v[176:179]
s_add_u32 s94, s92, 4096
buffer_store_dwordx4 v[64:67], v1, s[16:19], s94 offen offset:0 sc1
v_cvt_pk_bf16_f32 v146, v148, v149
v_cvt_pk_bf16_f32 v147, v150, v151
M v[176:179], a[132:135], a[164:167], v[176:179]
ds_read_b64_tr_b16 a[76:77], v17 offset:16384
ds_read_b64_tr_b16 a[78:79], v17 offset:18432
v_cvt_pk_bf16_f32 v152, v152, v153
v_cvt_pk_bf16_f32 v153, v154, v155
M v[180:183], a[140:143], a[164:167], v[180:183]
s_add_u32 m0, s29, 114688
s_nop 0
buffer_load_dwordx4 v6, s[12:15], s24 offen offset:0 lds
v_cvt_pk_bf16_f32 v154, v156, v157
v_cvt_pk_bf16_f32 v155, v158, v159
M v[180:183], a[136:139], a[160:163], v[180:183]
M v[184:187], a[144:147], a[160:163], v[184:187]
v_accvgpr_write_b32 a192, v128
v_accvgpr_write_b32 a193, v129
v_accvgpr_write_b32 a194, v130
v_accvgpr_write_b32 a195, v131
M v[184:187], a[148:151], a[164:167], v[184:187]
v_accvgpr_write_b32 a196, v136
v_accvgpr_write_b32 a197, v137
v_accvgpr_write_b32 a198, v138
v_accvgpr_write_b32 a199, v139
M v[188:191], a[156:159], a[164:167], v[188:191]
buffer_load_dwordx4 v7, s[12:15], s24 offen offset:1024 lds
v_accvgpr_write_b32 a200, v144
v_accvgpr_write_b32 a201, v145
v_accvgpr_write_b32 a202, v146
v_accvgpr_write_b32 a203, v147
M v[188:191], a[152:155], a[160:163], v[188:191]
s_waitcnt lgkmcnt(12)
ds_read_b64_tr_b16 a[84:85], v18 offset:16384
ds_read_b64_tr_b16 a[86:87], v18 offset:18432
v_accvgpr_write_b32 a204, v152
v_accvgpr_write_b32 a205, v153
v_accvgpr_write_b32 a206, v154
v_accvgpr_write_b32 a207, v155
M v[192:195], a[96:99], a[168:171], v[192:195]
M v[192:195], a[100:103], a[172:175], v[192:195]
ds_read_b128 a[184:187], v10 offset:55296
ds_read_b128 a[188:191], v11 offset:55296
M v[196:199], a[108:111], a[172:175], v[196:199]
s_add_u32 s94, s92, 4096
buffer_store_dwordx4 v[72:75], v1, s[16:19], s94 offen offset:1024 sc1
M v[196:199], a[104:107], a[168:171], v[196:199]
v_cvt_pk_bf16_f32 v160, v160, v161
v_cvt_pk_bf16_f32 v161, v162, v163
M v[200:203], a[112:115], a[168:171], v[200:203]
v_cvt_pk_bf16_f32 v162, v164, v165
v_cvt_pk_bf16_f32 v163, v166, v167
M v[200:203], a[116:119], a[172:175], v[200:203]
ds_read_b64_tr_b16 a[92:93], v19 offset:16384
ds_read_b64_tr_b16 a[94:95], v19 offset:18432
v_cvt_pk_bf16_f32 v168, v168, v169
v_cvt_pk_bf16_f32 v169, v170, v171
M v[204:207], a[124:127], a[172:175], v[204:207]
buffer_load_dwordx4 v8, s[12:15], s24 offen offset:2048 lds
v_cvt_pk_bf16_f32 v170, v172, v173
v_cvt_pk_bf16_f32 v171, v174, v175
M v[204:207], a[120:123], a[168:171], v[204:207]
v_cvt_pk_bf16_f32 v176, v176, v177
v_cvt_pk_bf16_f32 v177, v178, v179
M v[208:211], a[128:131], a[168:171], v[208:211]
v_cvt_pk_bf16_f32 v178, v180, v181
v_cvt_pk_bf16_f32 v179, v182, v183
M v[208:211], a[132:135], a[172:175], v[208:211]
v_cvt_pk_bf16_f32 v184, v184, v185
v_cvt_pk_bf16_f32 v185, v186, v187
M v[212:215], a[140:143], a[172:175], v[212:215]
buffer_load_dwordx4 v9, s[12:15], s24 offen offset:3072 lds
v_cvt_pk_bf16_f32 v186, v188, v189
v_cvt_pk_bf16_f32 v187, v190, v191
M v[212:215], a[136:139], a[168:171], v[212:215]
M v[216:219], a[144:147], a[168:171], v[216:219]
v_accvgpr_write_b32 a208, v160
v_accvgpr_write_b32 a209, v161
v_accvgpr_write_b32 a210, v162
v_accvgpr_write_b32 a211, v163
M v[216:219], a[148:151], a[172:175], v[216:219]
s_add_u32 s94, s92, 4096
buffer_store_dwordx4 v[80:83], v1, s[16:19], s94 offen offset:2048 sc1
v_accvgpr_write_b32 a212, v168
v_accvgpr_write_b32 a213, v169
v_accvgpr_write_b32 a214, v170
v_accvgpr_write_b32 a215, v171
M v[220:223], a[156:159], a[172:175], v[220:223]
v_accvgpr_write_b32 a216, v176
v_accvgpr_write_b32 a217, v177
v_accvgpr_write_b32 a218, v178
v_accvgpr_write_b32 a219, v179
M v[220:223], a[152:155], a[168:171], v[220:223]
s_waitcnt lgkmcnt(10)
v_accvgpr_write_b32 a220, v184
v_accvgpr_write_b32 a221, v185
v_accvgpr_write_b32 a222, v186
v_accvgpr_write_b32 a223, v187
M v[224:227], a[96:99], a[176:179], v[224:227]
s_add_u32 s24, s24, 262144
s_cmp_eq_u32 s24, s27
s_cselect_b32 s24, s28, s24
s_sub_u32 s6, s6, 1
s_cmp_eq_u32 s6, 0
s_cselect_b64 s[12:13], s[64:65], s[12:13]
M v[224:227], a[100:103], a[180:183], v[224:227]
M v[228:231], a[108:111], a[180:183], v[228:231]
M v[228:231], a[104:107], a[176:179], v[228:231]
v_cvt_pk_bf16_f32 v192, v192, v193
v_cvt_pk_bf16_f32 v193, v194, v195
M v[232:235], a[112:115], a[176:179], v[232:235]
v_cvt_pk_bf16_f32 v194, v196, v197
v_cvt_pk_bf16_f32 v195, v198, v199
M v[232:235], a[116:119], a[180:183], v[232:235]
v_cvt_pk_bf16_f32 v200, v200, v201
v_cvt_pk_bf16_f32 v201, v202, v203
M v[236:239], a[124:127], a[180:183], v[236:239]
v_cvt_pk_bf16_f32 v202, v204, v205
v_cvt_pk_bf16_f32 v203, v206, v207
M v[236:239], a[120:123], a[176:179], v[236:239]
s_waitcnt vmcnt(15) lgkmcnt(0)
s_barrier
ds_read_b128 a[160:163], v10 offset:0
ds_read_b128 a[164:167], v11 offset:0
v_cvt_pk_bf16_f32 v208, v208, v209
v_cvt_pk_bf16_f32 v209, v210, v211
M v[240:243], a[128:131], a[176:179], v[240:243]
s_add_u32 s94, s92, 4096
buffer_store_dwordx4 v[88:91], v1, s[16:19], s94 offen offset:3072 sc1
v_cvt_pk_bf16_f32 v210, v212, v213
v_cvt_pk_bf16_f32 v211, v214, v215
M v[240:243], a[132:135], a[180:183], v[240:243]
s_add_u32 m0, s29, 32768
s_nop 0
buffer_load_dwordx4 v2, s[8:11], s23 offen offset:0 lds
v_cvt_pk_bf16_f32 v216, v216, v217
v_cvt_pk_bf16_f32 v217, v218, v219
M v[244:247], a[140:143], a[180:183], v[244:247]
v_cvt_pk_bf16_f32 v218, v220, v221
v_cvt_pk_bf16_f32 v219, v222, v223
M v[244:247], a[136:139], a[176:179], v[244:247]
M v[248:251], a[144:147], a[176:179], v[248:251]
v_accvgpr_write_b32 a224, v192
v_accvgpr_write_b32 a225, v193
v_accvgpr_write_b32 a226, v194
v_accvgpr_write_b32 a227, v195
M v[248:251], a[148:151], a[180:183], v[248:251]
buffer_load_dwordx4 v3, s[8:11], s23 offen offset:1024 lds
v_accvgpr_write_b32 a228, v200
v_accvgpr_write_b32 a229, v201
v_accvgpr_write_b32 a230, v202
v_accvgpr_write_b32 a231, v203
M v[252:255], a[156:159], a[180:183], v[252:255]
v_accvgpr_write_b32 a232, v208
v_accvgpr_write_b32 a233, v209
v_accvgpr_write_b32 a234, v210
v_accvgpr_write_b32 a235, v211
M v[252:255], a[152:155], a[176:179], v[252:255]
v_accvgpr_write_b32 a236, v216
v_accvgpr_write_b32 a237, v217
v_accvgpr_write_b32 a238, v218
v_accvgpr_write_b32 a239, v219
M a[0:3], a[96:99], a[184:187], a[0:3]
M a[0:3], a[100:103], a[188:191], a[0:3]
ds_read_b128 a[168:171], v10 offset:2048
ds_read_b128 a[172:175], v11 offset:2048
M a[4:7], a[108:111], a[188:191], a[4:7]
s_add_u32 s94, s92, 8192
buffer_store_dwordx4 v[96:99], v1, s[16:19], s94 offen offset:0 sc1
M a[4:7], a[104:107], a[184:187], a[4:7]
v_cvt_pk_bf16_f32 v224, v224, v225
v_cvt_pk_bf16_f32 v225, v226, v227
M a[8:11], a[112:115], a[184:187], a[8:11]
v_cvt_pk_bf16_f32 v226, v228, v229
v_cvt_pk_bf16_f32 v227, v230, v231
M a[8:11], a[116:119], a[188:191], a[8:11]
buffer_load_dwordx4 v4, s[8:11], s23 offen offset:2048 lds
v_cvt_pk_bf16_f32 v232, v232, v233
v_cvt_pk_bf16_f32 v233, v234, v235
M a[12:15], a[124:127], a[188:191], a[12:15]
v_cvt_pk_bf16_f32 v234, v236, v237
v_cvt_pk_bf16_f32 v235, v238, v239
M a[12:15], a[120:123], a[184:187], a[12:15]
v_cvt_pk_bf16_f32 v240, v240, v241
v_cvt_pk_bf16_f32 v241, v242, v243
M a[16:19], a[128:131], a[184:187], a[16:19]
v_cvt_pk_bf16_f32 v242, v244, v245
v_cvt_pk_bf16_f32 v243, v246, v247
M a[16:19], a[132:135], a[188:191], a[16:19]
buffer_load_dwordx4 v5, s[8:11], s23 offen offset:3072 lds
v_cvt_pk_bf16_f32 v248, v248, v249
v_cvt_pk_bf16_f32 v249, v250, v251
M a[20:23], a[140:143], a[188:191], a[20:23]
v_cvt_pk_bf16_f32 v250, v252, v253
v_cvt_pk_bf16_f32 v251, v254, v255
M a[20:23], a[136:139], a[184:187], a[20:23]
M a[24:27], a[144:147], a[184:187], a[24:27]
s_add_u32 s94, s92, 8192
buffer_store_dwordx4 v[104:107], v1, s[16:19], s94 offen offset:1024 sc1
v_accvgpr_write_b32 a240, v224
v_accvgpr_write_b32 a241, v225
v_accvgpr_write_b32 a242, v226
v_accvgpr_write_b32 a243, v227
M a[24:27], a[148:151], a[188:191], a[24:27]
v_accvgpr_write_b32 a244, v232
v_accvgpr_write_b32 a245, v233
v_accvgpr_write_b32 a246, v234
v_accvgpr_write_b32 a247, v235
M a[28:31], a[156:159], a[188:191], a[28:31]
v_accvgpr_write_b32 a248, v240
v_accvgpr_write_b32 a249, v241
v_accvgpr_write_b32 a250, v242
v_accvgpr_write_b32 a251, v243
M a[28:31], a[152:155], a[184:187], a[28:31]
s_waitcnt lgkmcnt(2)
v_accvgpr_write_b32 a252, v248
v_accvgpr_write_b32 a253, v249
v_accvgpr_write_b32 a254, v250
v_accvgpr_write_b32 a255, v251
M v[32:35], a[160:163], a[32:35], 0
s_add_u32 m0, s29, 65536
s_nop 0
buffer_load_dwordx4 v6, s[12:15], s24 offen offset:0 lds
M v[32:35], a[164:167], a[36:39], v[32:35]
ds_read_b128 a[176:179], v10 offset:4096
ds_read_b128 a[180:183], v11 offset:4096
M v[36:39], a[164:167], a[44:47], 0
M v[36:39], a[160:163], a[40:43], v[36:39]
ds_read_b64_tr_b16 a[96:97], v12 offset:32768
ds_read_b64_tr_b16 a[98:99], v12 offset:34816
M v[40:43], a[160:163], a[48:51], 0
M v[40:43], a[164:167], a[52:55], v[40:43]
M v[44:47], a[164:167], a[60:63], 0
buffer_load_dwordx4 v7, s[12:15], s24 offen offset:1024 lds
M v[44:47], a[160:163], a[56:59], v[44:47]
ds_read_b64_tr_b16 a[104:105], v13 offset:32768
ds_read_b64_tr_b16 a[106:107], v13 offset:34816
M v[48:51], a[160:163], a[64:67], 0
s_add_u32 s94, s92, 8192
buffer_store_dwordx4 v[112:115], v1, s[16:19], s94 offen offset:2048 sc1
M v[48:51], a[164:167], a[68:71], v[48:51]
M v[52:55], a[164:167], a[76:79], 0
M v[52:55], a[160:163], a[72:75], v[52:55]
ds_read_b64_tr_b16 a[112:113], v14 offset:32768
ds_read_b64_tr_b16 a[114:115], v14 offset:34816
M v[56:59], a[160:163], a[80:83], 0
M v[56:59], a[164:167], a[84:87], v[56:59]
M v[60:63], a[164:167], a[92:95], 0
buffer_load_dwordx4 v8, s[12:15], s24 offen offset:2048 lds
M v[60:63], a[160:163], a[88:91], v[60:63]
s_waitcnt lgkmcnt(8)
ds_read_b64_tr_b16 a[120:121], v15 offset:32768
ds_read_b64_tr_b16 a[122:123], v15 offset:34816
M v[64:67], a[168:171], a[32:35], 0
M v[64:67], a[172:175], a[36:39], v[64:67]
ds_read_b128 a[184:187], v10 offset:6144
ds_read_b128 a[188:191], v11 offset:6144
M v[68:71], a[172:175], a[44:47], 0
s_add_u32 s94, s92, 8192
buffer_store_dwordx4 v[120:123], v1, s[16:19], s94 offen offset:3072 sc1
M v[68:71], a[168:171], a[40:43], v[68:71]
ds_read_b64_tr_b16 a[128:129], v16 offset:32768
ds_read_b64_tr_b16 a[130:131], v16 offset:34816
M v[72:75], a[168:171], a[48:51], 0
v_accvgpr_read_b32 v24, a0
v_accvgpr_read_b32 v25, a1
M v[72:75], a[172:175], a[52:55], v[72:75]
v_accvgpr_read_b32 v26, a2
v_accvgpr_read_b32 v27, a3
M v[76:79], a[172:175], a[60:63], 0
v_accvgpr_read_b32 v28, a4
v_accvgpr_read_b32 v29, a5
M v[76:79], a[168:171], a[56:59], v[76:79]
ds_read_b64_tr_b16 a[136:137], v17 offset:32768
ds_read_b64_tr_b16 a[138:139], v17 offset:34816
v_accvgpr_read_b32 v30, a6
v_accvgpr_read_b32 v31, a7
M v[80:83], a[168:171], a[64:67], 0
buffer_load_dwordx4 v9, s[12:15], s24 offen offset:3072 lds
v_cvt_pk_bf16_f32 v24, v24, v25
v_cvt_pk_bf16_f32 v25, v26, v27
M v[80:83], a[172:175], a[68:71], v[80:83]
v_cvt_pk_bf16_f32 v26, v28, v29
v_cvt_pk_bf16_f32 v27, v30, v31
M v[84:87], a[172:175], a[76:79], 0
M v[84:87], a[168:171], a[72:75], v[84:87]
ds_read_b64_tr_b16 a[144:145], v18 offset:32768
ds_read_b64_tr_b16 a[146:147], v18 offset:34816
M v[88:91], a[168:171], a[80:83], 0
M v[88:91], a[172:175], a[84:87], v[88:91]
s_add_u32 s94, s93, 12288
buffer_store_dwordx4 v[24:27], v1, s[16:19], s94 offen offset:0 sc1
M v[92:95], a[172:175], a[92:95], 0
M v[92:95], a[168:171], a[88:91], v[92:95]
s_waitcnt lgkmcnt(15)
ds_read_b64_tr_b16 a[152:153], v19 offset:32768
ds_read_b64_tr_b16 a[154:155], v19 offset:34816
M v[96:99], a[176:179], a[32:35], 0
s_add_u32 s24, s24, 262144
M v[96:99], a[180:183], a[36:39], v[96:99]
M v[100:103], a[180:183], a[44:47], 0
M v[100:103], a[176:179], a[40:43], v[100:103]
M v[104:107], a[176:179], a[48:51], 0
M v[104:107], a[180:183], a[52:55], v[104:107]
M v[108:111], a[180:183], a[60:63], 0
M v[108:111], a[176:179], a[56:59], v[108:111]
s_waitcnt vmcnt(15) lgkmcnt(0)
s_barrier
ds_read_b128 a[160:163], v10 offset:16384
ds_read_b128 a[164:167], v11 offset:16384
M v[112:115], a[176:179], a[64:67], 0
s_add_u32 m0, s29, 49152
s_add_u32 s3, s23, s31
buffer_load_dwordx4 v2, s[8:11], s3 offen offset:0 lds
M v[112:115], a[180:183], a[68:71], v[112:115]
M v[116:119], a[180:183], a[76:79], 0
M v[116:119], a[176:179], a[72:75], v[116:119]
ds_read_b64_tr_b16 a[100:101], v12 offset:49152
ds_read_b64_tr_b16 a[102:103], v12 offset:51200
M v[120:123], a[176:179], a[80:83], 0
v_accvgpr_read_b32 v24, a8
v_accvgpr_read_b32 v25, a9
M v[120:123], a[180:183], a[84:87], v[120:123]
buffer_load_dwordx4 v3, s[8:11], s3 offen offset:1024 lds
v_accvgpr_read_b32 v26, a10
v_accvgpr_read_b32 v27, a11
M v[124:127], a[180:183], a[92:95], 0
v_accvgpr_read_b32 v28, a12
v_accvgpr_read_b32 v29, a13
M v[124:127], a[176:179], a[88:91], v[124:127]
v_accvgpr_read_b32 v30, a14
v_accvgpr_read_b32 v31, a15
M v[128:131], a[184:187], a[32:35], 0
v_cvt_pk_bf16_f32 v24, v24, v25
v_cvt_pk_bf16_f32 v25, v26, v27
M v[128:131], a[188:191], a[36:39], v[128:131]
ds_read_b128 a[168:171], v10 offset:18432
ds_read_b128 a[172:175], v11 offset:18432
ds_read_b64_tr_b16 a[108:109], v13 offset:49152
ds_read_b64_tr_b16 a[110:111], v13 offset:51200
v_cvt_pk_bf16_f32 v26, v28, v29
v_cvt_pk_bf16_f32 v27, v30, v31
M v[132:135], a[188:191], a[44:47], 0
M v[132:135], a[184:187], a[40:43], v[132:135]
M v[136:139], a[184:187], a[48:51], 0
buffer_load_dwordx4 v4, s[8:11], s3 offen offset:2048 lds
M v[136:139], a[188:191], a[52:55], v[136:139]
s_add_u32 s94, s93, 12288
buffer_store_dwordx4 v[24:27], v1, s[16:19], s94 offen offset:1024 sc1
M v[140:143], a[188:191], a[60:63], 0
M v[140:143], a[184:187], a[56:59], v[140:143]
ds_read_b64_tr_b16 a[116:117], v14 offset:49152
ds_read_b64_tr_b16 a[118:119], v14 offset:51200
M v[144:147], a[184:187], a[64:67], 0
M v[144:147], a[188:191], a[68:71], v[144:147]
M v[148:151], a[188:191], a[76:79], 0
buffer_load_dwordx4 v5, s[8:11], s3 offen offset:3072 lds
M v[148:151], a[184:187], a[72:75], v[148:151]
M v[152:155], a[184:187], a[80:83], 0
M v[152:155], a[188:191], a[84:87], v[152:155]
ds_read_b64_tr_b16 a[124:125], v15 offset:49152
ds_read_b64_tr_b16 a[126:127], v15 offset:51200
M v[156:159], a[188:191], a[92:95], 0
M v[156:159], a[184:187], a[88:91], v[156:159]
s_waitcnt lgkmcnt(10)
M v[160:163], a[160:163], a[32:35], 0
M v[160:163], a[164:167], a[36:39], v[160:163]
ds_read_b128 a[176:179], v10 offset:20480
ds_read_b128 a[180:183], v11 offset:20480
M v[164:167], a[164:167], a[44:47], 0
s_add_u32 s23, s23, 128
s_cmp_eq_u32 s23, s25
s_cselect_b32 s23, s26, s23
M v[164:167], a[160:163], a[40:43], v[164:167]
ds_read_b64_tr_b16 a[132:133], v16 offset:49152
ds_read_b64_tr_b16 a[134:135], v16 offset:51200
M v[168:171], a[160:163], a[48:51], 0
v_accvgpr_read_b32 v24, a16
v_accvgpr_read_b32 v25, a17
M v[168:171], a[164:167], a[52:55], v[168:171]
v_accvgpr_read_b32 v26, a18
v_accvgpr_read_b32 v27, a19
M v[172:175], a[164:167], a[60:63], 0
v_accvgpr_read_b32 v28, a20
v_accvgpr_read_b32 v29, a21
M v[172:175], a[160:163], a[56:59], v[172:175]
v_accvgpr_read_b32 v30, a22
v_accvgpr_read_b32 v31, a23
M v[176:179], a[160:163], a[64:67], 0
s_add_u32 m0, s29, 81920
s_nop 0
buffer_load_dwordx4 v6, s[12:15], s24 offen offset:0 lds
v_cvt_pk_bf16_f32 v24, v24, v25
v_cvt_pk_bf16_f32 v25, v26, v27
M v[176:179], a[164:167], a[68:71], v[176:179]
ds_read_b64_tr_b16 a[140:141], v17 offset:49152
ds_read_b64_tr_b16 a[142:143], v17 offset:51200
v_cvt_pk_bf16_f32 v26, v28, v29
v_cvt_pk_bf16_f32 v27, v30, v31
M v[180:183], a[164:167], a[76:79], 0
M v[180:183], a[160:163], a[72:75], v[180:183]
M v[184:187], a[160:163], a[80:83], 0
M v[184:187], a[164:167], a[84:87], v[184:187]
s_add_u32 s94, s93, 12288
buffer_store_dwordx4 v[24:27], v1, s[16:19], s94 offen offset:2048 sc1
M v[188:191], a[164:167], a[92:95], 0
buffer_load_dwordx4 v7, s[12:15], s24 offen offset:1024 lds
M v[188:191], a[160:163], a[88:91], v[188:191]
s_waitcnt lgkmcnt(12)
ds_read_b64_tr_b16 a[148:149], v18 offset:49152
ds_read_b64_tr_b16 a[150:151], v18 offset:51200
M v[192:195], a[168:171], a[32:35], 0
M v[192:195], a[172:175], a[36:39], v[192:195]
ds_read_b128 a[184:187], v10 offset:22528
ds_read_b128 a[188:191], v11 offset:22528
M v[196:199], a[172:175], a[44:47], 0
M v[196:199], a[168:171], a[40:43], v[196:199]
M v[200:203], a[168:171], a[48:51], 0
M v[200:203], a[172:175], a[52:55], v[200:203]
ds_read_b64_tr_b16 a[156:157], v19 offset:49152
ds_read_b64_tr_b16 a[158:159], v19 offset:51200
M v[204:207], a[172:175], a[60:63], 0
buffer_load_dwordx4 v8, s[12:15], s24 offen offset:2048 lds
M v[204:207], a[168:171], a[56:59], v[204:207]
M v[208:211], a[168:171], a[64:67], 0
M v[208:211], a[172:175], a[68:71], v[208:211]
M v[212:215], a[172:175], a[76:79], 0
buffer_load_dwordx4 v9, s[12:15], s24 offen offset:3072 lds
M v[212:215], a[168:171], a[72:75], v[212:215]
M v[216:219], a[168:171], a[80:83], 0
v_accvgpr_read_b32 v24, a24
v_accvgpr_read_b32 v25, a25
M v[216:219], a[172:175], a[84:87], v[216:219]
v_accvgpr_read_b32 v26, a26
v_accvgpr_read_b32 v27, a27
M v[220:223], a[172:175], a[92:95], 0
v_accvgpr_read_b32 v28, a28
v_accvgpr_read_b32 v29, a29
M v[220:223], a[168:171], a[88:91], v[220:223]
s_waitcnt lgkmcnt(10)
v_accvgpr_read_b32 v30, a30
v_accvgpr_read_b32 v31, a31
M v[224:227], a[176:179], a[32:35], 0
s_add_u32 s24, s24, 262144
s_cmp_eq_u32 s24, s27
s_cselect_b32 s24, s28, s24
s_sub_u32 s6, s6, 1
s_cmp_eq_u32 s6, 0
s_cselect_b64 s[12:13], s[64:65], s[12:13]
v_cvt_pk_bf16_f32 v24, v24, v25
v_cvt_pk_bf16_f32 v25, v26, v27
M v[224:227], a[180:183], a[36:39], v[224:227]
v_cvt_pk_bf16_f32 v26, v28, v29
v_cvt_pk_bf16_f32 v27, v30, v31
M v[228:231], a[180:183], a[44:47], 0
M v[228:231], a[176:179], a[40:43], v[228:231]
M v[232:235], a[176:179], a[48:51], 0
M v[232:235], a[180:183], a[52:55], v[232:235]
s_add_u32 s94, s93, 12288
buffer_store_dwordx4 v[24:27], v1, s[16:19], s94 offen offset:3072 sc1
M v[236:239], a[180:183], a[60:63], 0
M v[236:239], a[176:179], a[56:59], v[236:239]
s_waitcnt vmcnt(12) lgkmcnt(0)
s_barrier
ds_read_b128 a[160:163], v10 offset:32768
ds_read_b128 a[164:167], v11 offset:32768
M v[240:243], a[176:179], a[64:67], 0
s_add_u32 m0, s29, 0
s_nop 0
buffer_load_dwordx4 v2, s[8:11], s23 offen offset:0 lds
M v[240:243], a[180:183], a[68:71], v[240:243]
M v[244:247], a[180:183], a[76:79], 0
M v[244:247], a[176:179], a[72:75], v[244:247]
M v[248:251], a[176:179], a[80:83], 0
M v[248:251], a[180:183], a[84:87], v[248:251]
buffer_load_dwordx4 v3, s[8:11], s23 offen offset:1024 lds
M v[252:255], a[180:183], a[92:95], 0
M v[252:255], a[176:179], a[88:91], v[252:255]
M a[0:3], a[184:187], a[32:35], 0
M a[0:3], a[188:191], a[36:39], a[0:3]
ds_read_b128 a[168:171], v10 offset:34816
ds_read_b128 a[172:175], v11 offset:34816
M a[4:7], a[188:191], a[44:47], 0
M a[4:7], a[184:187], a[40:43], a[4:7]
M a[8:11], a[184:187], a[48:51], 0
buffer_load_dwordx4 v4, s[8:11], s23 offen offset:2048 lds
M a[8:11], a[188:191], a[52:55], a[8:11]
M a[12:15], a[188:191], a[60:63], 0
M a[12:15], a[184:187], a[56:59], a[12:15]
M a[16:19], a[184:187], a[64:67], 0
M a[16:19], a[188:191], a[68:71], a[16:19]
buffer_load_dwordx4 v5, s[8:11], s23 offen offset:3072 lds
M a[20:23], a[188:191], a[76:79], 0
M a[20:23], a[184:187], a[72:75], a[20:23]
M a[24:27], a[184:187], a[80:83], 0
M a[24:27], a[188:191], a[84:87], a[24:27]
M a[28:31], a[188:191], a[92:95], 0
M a[28:31], a[184:187], a[88:91], a[28:31]
s_waitcnt lgkmcnt(2)
M v[32:35], a[160:163], a[96:99], v[32:35]
s_add_u32 m0, s29, 98304
s_nop 0
buffer_load_dwordx4 v6, s[12:15], s24 offen offset:0 lds
M v[32:35], a[164:167], a[100:103], v[32:35]
ds_read_b128 a[176:179], v10 offset:36864
ds_read_b128 a[180:183], v11 offset:36864
M v[36:39], a[164:167], a[108:111], v[36:39]
M v[36:39], a[160:163], a[104:107], v[36:39]
ds_read_b64_tr_b16 a[32:33], v12 offset:0
ds_read_b64_tr_b16 a[34:35], v12 offset:2048
M v[40:43], a[160:163], a[112:115], v[40:43]
M v[40:43], a[164:167], a[116:119], v[40:43]
M v[44:47], a[164:167], a[124:127], v[44:47]
M v[44:47], a[160:163], a[120:123], v[44:47]
ds_read_b64_tr_b16 a[40:41], v13 offset:0
ds_read_b64_tr_b16 a[42:43], v13 offset:2048
M v[48:51], a[160:163], a[128:131], v[48:51]
s_add_u32 s94, s92, 12288
buffer_store_dwordx4 a[192:195], v1, s[16:19], s94 offen offset:0 sc1
M v[48:51], a[164:167], a[132:135], v[48:51]
buffer_load_dwordx4 v7, s[12:15], s24 offen offset:1024 lds
M v[52:55], a[164:167], a[140:143], v[52:55]
M v[52:55], a[160:163], a[136:139], v[52:55]
ds_read_b64_tr_b16 a[48:49], v14 offset:0
ds_read_b64_tr_b16 a[50:51], v14 offset:2048
M v[56:59], a[160:163], a[144:147], v[56:59]
M v[56:59], a[164:167], a[148:151], v[56:59]
M v[60:63], a[164:167], a[156:159], v[60:63]
M v[60:63], a[160:163], a[152:155], v[60:63]
s_waitcnt lgkmcnt(8)
ds_read_b64_tr_b16 a[56:57], v15 offset:0
ds_read_b64_tr_b16 a[58:59], v15 offset:2048
M v[64:67], a[168:171], a[96:99], v[64:67]
buffer_load_dwordx4 v8, s[12:15], s24 offen offset:2048 lds
M v[64:67], a[172:175], a[100:103], v[64:67]
ds_read_b128 a[184:187], v10 offset:38912
ds_read_b128 a[188:191], v11 offset:38912
M v[68:71], a[172:175], a[108:111], v[68:71]
M v[68:71], a[168:171], a[104:107], v[68:71]
ds_read_b64_tr_b16 a[64:65], v16 offset:0
ds_read_b64_tr_b16 a[66:67], v16 offset:2048
M v[72:75], a[168:171], a[112:115], v[72:75]
M v[72:75], a[172:175], a[116:119], v[72:75]
M v[76:79], a[172:175], a[124:127], v[76:79]
M v[76:79], a[168:171], a[120:123], v[76:79]
ds_read_b64_tr_b16 a[72:73], v17 offset:0
ds_read_b64_tr_b16 a[74:75], v17 offset:2048
M v[80:83], a[168:171], a[128:131], v[80:83]
buffer_load_dwordx4 v9, s[12:15], s24 offen offset:3072 lds
M v[80:83], a[172:175], a[132:135], v[80:83]
M v[84:87], a[172:175], a[140:143], v[84:87]
M v[84:87], a[168:171], a[136:139], v[84:87]
ds_read_b64_tr_b16 a[80:81], v18 offset:0
ds_read_b64_tr_b16 a[82:83], v18 offset:2048
M v[88:91], a[168:171], a[144:147], v[88:91]
M v[88:91], a[172:175], a[148:151], v[88:91]
M v[92:95], a[172:175], a[156:159], v[92:95]
s_add_u32 s24, s24, 262144
M v[92:95], a[168:171], a[152:155], v[92:95]
s_waitcnt lgkmcnt(15)
ds_read_b64_tr_b16 a[88:89], v19 offset:0
ds_read_b64_tr_b16 a[90:91], v19 offset:2048
M v[96:99], a[176:179], a[96:99], v[96:99]
M v[96:99], a[180:183], a[100:103], v[96:99]
M v[100:103], a[180:183], a[108:111], v[100:103]
M v[100:103], a[176:179], a[104:107], v[100:103]
M v[104:107], a[176:179], a[112:115], v[104:107]
s_add_u32 s94, s92, 12288
buffer_store_dwordx4 a[196:199], v1, s[16:19], s94 offen offset:1024 sc1
M v[104:107], a[180:183], a[116:119], v[104:107]
M v[108:111], a[180:183], a[124:127], v[108:111]
M v[108:111], a[176:179], a[120:123], v[108:111]
s_waitcnt vmcnt(11) lgkmcnt(0)
s_barrier
ds_read_b128 a[160:163], v10 offset:49152
ds_read_b128 a[164:167], v11 offset:49152
M v[112:115], a[176:179], a[128:131], v[112:115]
s_add_u32 m0, s29, 16384
s_add_u32 s3, s23, s31
buffer_load_dwordx4 v2, s[8:11], s3 offen offset:0 lds
M v[112:115], a[180:183], a[132:135], v[112:115]
M v[116:119], a[180:183], a[140:143], v[116:119]
M v[116:119], a[176:179], a[136:139], v[116:119]
ds_read_b64_tr_b16 a[36:37], v12 offset:16384
ds_read_b64_tr_b16 a[38:39], v12 offset:18432
M v[120:123], a[176:179], a[144:147], v[120:123]
M v[120:123], a[180:183], a[148:151], v[120:123]
buffer_load_dwordx4 v3, s[8:11], s3 offen offset:1024 lds
M v[124:127], a[180:183], a[156:159], v[124:127]
M v[124:127], a[176:179], a[152:155], v[124:127]
M v[128:131], a[184:187], a[96:99], v[128:131]
M v[128:131], a[188:191], a[100:103], v[128:131]
ds_read_b128 a[168:171], v10 offset:51200
ds_read_b128 a[172:175], v11 offset:51200
ds_read_b64_tr_b16 a[44:45], v13 offset:16384
ds_read_b64_tr_b16 a[46:47], v13 offset:18432
M v[132:135], a[188:191], a[108:111], v[132:135]
M v[132:135], a[184:187], a[104:107], v[132:135]
M v[136:139], a[184:187], a[112:115], v[136:139]
buffer_load_dwordx4 v4, s[8:11], s3 offen offset:2048 lds
M v[136:139], a[188:191], a[116:119], v[136:139]
M v[140:143], a[188:191], a[124:127], v[140:143]
M v[140:143], a[184:187], a[120:123], v[140:143]
ds_read_b64_tr_b16 a[52:53], v14 offset:16384
ds_read_b64_tr_b16 a[54:55], v14 offset:18432
M v[144:147], a[184:187], a[128:131], v[144:147]
M v[144:147], a[188:191], a[132:135], v[144:147]
buffer_load_dwordx4 v5, s[8:11], s3 offen offset:3072 lds
M v[148:151], a[188:191], a[140:143], v[148:151]
M v[148:151], a[184:187], a[136:139], v[148:151]
M v[152:155], a[184:187], a[144:147], v[152:155]
M v[152:155], a[188:191], a[148:151], v[152:155]
ds_read_b64_tr_b16 a[60:61], v15 offset:16384
ds_read_b64_tr_b16 a[62:63], v15 offset:18432
M v[156:159], a[188:191], a[156:159], v[156:159]
M v[156:159], a[184:187], a[152:155], v[156:159]
s_waitcnt lgkmcnt(10)
M v[160:163], a[160:163], a[96:99], v[160:163]
s_add_u32 s94, s92, 12288
buffer_store_dwordx4 a[200:203], v1, s[16:19], s94 offen offset:2048 sc1
M v[160:163], a[164:167], a[100:103], v[160:163]
ds_read_b128 a[176:179], v10 offset:53248
ds_read_b128 a[180:183], v11 offset:53248
M v[164:167], a[164:167], a[108:111], v[164:167]
s_add_u32 s23, s23, 128
s_cmp_eq_u32 s23, s25
s_cselect_b32 s23, s26, s23
M v[164:167], a[160:163], a[104:107], v[164:167]
ds_read_b64_tr_b16 a[68:69], v16 offset:16384
ds_read_b64_tr_b16 a[70:71], v16 offset:18432
M v[168:171], a[160:163], a[112:115], v[168:171]
M v[168:171], a[164:167], a[116:119], v[168:171]
M v[172:175], a[164:167], a[124:127], v[172:175]
M v[172:175], a[160:163], a[120:123], v[172:175]
M v[176:179], a[160:163], a[128:131], v[176:179]
s_add_u32 m0, s29, 114688
s_nop 0
buffer_load_dwordx4 v6, s[12:15], s24 offen offset:0 lds
M v[176:179], a[164:167], a[132:135], v[176:179]
ds_read_b64_tr_b16 a[76:77], v17 offset:16384
ds_read_b64_tr_b16 a[78:79], v17 offset:18432
M v[180:183], a[164:167], a[140:143], v[180:183]
M v[180:183], a[160:163], a[136:139], v[180:183]
M v[184:187], a[160:163], a[144:147], v[184:187]
M v[184:187], a[164:167], a[148:151], v[184:187]
buffer_load_dwordx4 v7, s[12:15], s24 offen offset:1024 lds
M v[188:191], a[164:167], a[156:159], v[188:191]
M v[188:191], a[160:163], a[152:155], v[188:191]
s_waitcnt lgkmcnt(12)
ds_read_b64_tr_b16 a[84:85], v18 offset:16384
ds_read_b64_tr_b16 a[86:87], v18 offset:18432
M v[192:195], a[168:171], a[96:99], v[192:195]
M v[192:195], a[172:175], a[100:103], v[192:195]
ds_read_b128 a[184:187], v10 offset:55296
ds_read_b128 a[188:191], v11 offset:55296
M v[196:199], a[172:175], a[108:111], v[196:199]
M v[196:199], a[168:171], a[104:107], v[196:199]
M v[200:203], a[168:171], a[112:115], v[200:203]
buffer_load_dwordx4 v8, s[12:15], s24 offen offset:2048 lds
M v[200:203], a[172:175], a[116:119], v[200:203]
ds_read_b64_tr_b16 a[92:93], v19 offset:16384
ds_read_b64_tr_b16 a[94:95], v19 offset:18432
M v[204:207], a[172:175], a[124:127], v[204:207]
M v[204:207], a[168:171], a[120:123], v[204:207]
M v[208:211], a[168:171], a[128:131], v[208:211]
M v[208:211], a[172:175], a[132:135], v[208:211]
buffer_load_dwordx4 v9, s[12:15], s24 offen offset:3072 lds
M v[212:215], a[172:175], a[140:143], v[212:215]
M v[212:215], a[168:171], a[136:139], v[212:215]
M v[216:219], a[168:171], a[144:147], v[216:219]
s_add_u32 s94, s92, 12288
buffer_store_dwordx4 a[204:207], v1, s[16:19], s94 offen offset:3072 sc1
M v[216:219], a[172:175], a[148:151], v[216:219]
M v[220:223], a[172:175], a[156:159], v[220:223]
M v[220:223], a[168:171], a[152:155], v[220:223]
s_waitcnt lgkmcnt(10)
M v[224:227], a[176:179], a[96:99], v[224:227]
s_add_u32 s24, s24, 262144
s_cmp_eq_u32 s24, s27
s_cselect_b32 s24, s28, s24
s_sub_u32 s6, s6, 1
s_cmp_eq_u32 s6, 0
s_cselect_b64 s[12:13], s[64:65], s[12:13]
M v[224:227], a[180:183], a[100:103], v[224:227]
M v[228:231], a[180:183], a[108:111], v[228:231]
M v[228:231], a[176:179], a[104:107], v[228:231]
M v[232:235], a[176:179], a[112:115], v[232:235]
M v[232:235], a[180:183], a[116:119], v[232:235]
M v[236:239], a[180:183], a[124:127], v[236:239]
M v[236:239], a[176:179], a[120:123], v[236:239]
s_waitcnt vmcnt(11) lgkmcnt(0)
s_barrier
ds_read_b128 a[160:163], v10 offset:0
ds_read_b128 a[164:167], v11 offset:0
M v[240:243], a[176:179], a[128:131], v[240:243]
s_add_u32 m0, s29, 32768
s_nop 0
buffer_load_dwordx4 v2, s[8:11], s23 offen offset:0 lds
M v[240:243], a[180:183], a[132:135], v[240:243]
M v[244:247], a[180:183], a[140:143], v[244:247]
M v[244:247], a[176:179], a[136:139], v[244:247]
M v[248:251], a[176:179], a[144:147], v[248:251]
M v[248:251], a[180:183], a[148:151], v[248:251]
buffer_load_dwordx4 v3, s[8:11], s23 offen offset:1024 lds
M v[252:255], a[180:183], a[156:159], v[252:255]
M v[252:255], a[176:179], a[152:155], v[252:255]
M a[0:3], a[184:187], a[96:99], a[0:3]
M a[0:3], a[188:191], a[100:103], a[0:3]
ds_read_b128 a[168:171], v10 offset:2048
ds_read_b128 a[172:175], v11 offset:2048
M a[4:7], a[188:191], a[108:111], a[4:7]
M a[4:7], a[184:187], a[104:107], a[4:7]
M a[8:11], a[184:187], a[112:115], a[8:11]
buffer_load_dwordx4 v4, s[8:11], s23 offen offset:2048 lds
M a[8:11], a[188:191], a[116:119], a[8:11]
M a[12:15], a[188:191], a[124:127], a[12:15]
M a[12:15], a[184:187], a[120:123], a[12:15]
M a[16:19], a[184:187], a[128:131], a[16:19]
M a[16:19], a[188:191], a[132:135], a[16:19]
buffer_load_dwordx4 v5, s[8:11], s23 offen offset:3072 lds
M a[20:23], a[188:191], a[140:143], a[20:23]
M a[20:23], a[184:187], a[136:139], a[20:23]
M a[24:27], a[184:187], a[144:147], a[24:27]
M a[24:27], a[188:191], a[148:151], a[24:27]
M a[28:31], a[188:191], a[156:159], a[28:31]
M a[28:31], a[184:187], a[152:155], a[28:31]
s_waitcnt lgkmcnt(2)
M v[32:35], a[160:163], a[32:35], v[32:35]
s_add_u32 m0, s29, 65536
s_nop 0
buffer_load_dwordx4 v6, s[12:15], s24 offen offset:0 lds
M v[32:35], a[164:167], a[36:39], v[32:35]
ds_read_b128 a[176:179], v10 offset:4096
ds_read_b128 a[180:183], v11 offset:4096
M v[36:39], a[164:167], a[44:47], v[36:39]
M v[36:39], a[160:163], a[40:43], v[36:39]
ds_read_b64_tr_b16 a[96:97], v12 offset:32768
ds_read_b64_tr_b16 a[98:99], v12 offset:34816
M v[40:43], a[160:163], a[48:51], v[40:43]
M v[40:43], a[164:167], a[52:55], v[40:43]
M v[44:47], a[164:167], a[60:63], v[44:47]
M v[44:47], a[160:163], a[56:59], v[44:47]
ds_read_b64_tr_b16 a[104:105], v13 offset:32768
ds_read_b64_tr_b16 a[106:107], v13 offset:34816
M v[48:51], a[160:163], a[64:67], v[48:51]
s_add_u32 s94, s93, 0
buffer_store_dwordx4 a[208:211], v1, s[16:19], s94 offen offset:0 sc1
M v[48:51], a[164:167], a[68:71], v[48:51]
buffer_load_dwordx4 v7, s[12:15], s24 offen offset:1024 lds
M v[52:55], a[164:167], a[76:79], v[52:55]
M v[52:55], a[160:163], a[72:75], v[52:55]
ds_read_b64_tr_b16 a[112:113], v14 offset:32768
ds_read_b64_tr_b16 a[114:115], v14 offset:34816
M v[56:59], a[160:163], a[80:83], v[56:59]
M v[56:59], a[164:167], a[84:87], v[56:59]
M v[60:63], a[164:167], a[92:95], v[60:63]
M v[60:63], a[160:163], a[88:91], v[60:63]
s_waitcnt lgkmcnt(8)
ds_read_b64_tr_b16 a[120:121], v15 offset:32768
ds_read_b64_tr_b16 a[122:123], v15 offset:34816
M v[64:67], a[168:171], a[32:35], v[64:67]
buffer_load_dwordx4 v8, s[12:15], s24 offen offset:2048 lds
M v[64:67], a[172:175], a[36:39], v[64:67]
ds_read_b128 a[184:187], v10 offset:6144
ds_read_b128 a[188:191], v11 offset:6144
M v[68:71], a[172:175], a[44:47], v[68:71]
M v[68:71], a[168:171], a[40:43], v[68:71]
ds_read_b64_tr_b16 a[128:129], v16 offset:32768
ds_read_b64_tr_b16 a[130:131], v16 offset:34816
M v[72:75], a[168:171], a[48:51], v[72:75]
M v[72:75], a[172:175], a[52:55], v[72:75]
M v[76:79], a[172:175], a[60:63], v[76:79]
M v[76:79], a[168:171], a[56:59], v[76:79]
ds_read_b64_tr_b16 a[136:137], v17 offset:32768
ds_read_b64_tr_b16 a[138:139], v17 offset:34816
M v[80:83], a[168:171], a[64:67], v[80:83]
buffer_load_dwordx4 v9, s[12:15], s24 offen offset:3072 lds
M v[80:83], a[172:175], a[68:71], v[80:83]
M v[84:87], a[172:175], a[76:79], v[84:87]
M v[84:87], a[168:171], a[72:75], v[84:87]
ds_read_b64_tr_b16 a[144:145], v18 offset:32768
ds_read_b64_tr_b16 a[146:147], v18 offset:34816
M v[88:91], a[168:171], a[80:83], v[88:91]
M v[88:91], a[172:175], a[84:87], v[88:91]
M v[92:95], a[172:175], a[92:95], v[92:95]
s_add_u32 s24, s24, 262144
M v[92:95], a[168:171], a[88:91], v[92:95]
s_waitcnt lgkmcnt(15)
ds_read_b64_tr_b16 a[152:153], v19 offset:32768
ds_read_b64_tr_b16 a[154:155], v19 offset:34816
M v[96:99], a[176:179], a[32:35], v[96:99]
M v[96:99], a[180:183], a[36:39], v[96:99]
M v[100:103], a[180:183], a[44:47], v[100:103]
M v[100:103], a[176:179], a[40:43], v[100:103]
M v[104:107], a[176:179], a[48:51], v[104:107]
s_add_u32 s94, s93, 0
buffer_store_dwordx4 a[212:215], v1, s[16:19], s94 offen offset:1024 sc1
M v[104:107], a[180:183], a[52:55], v[104:107]
M v[108:111], a[180:183], a[60:63], v[108:111]
M v[108:111], a[176:179], a[56:59], v[108:111]
s_waitcnt vmcnt(11) lgkmcnt(0)
s_barrier
ds_read_b128 a[160:163], v10 offset:16384
ds_read_b128 a[164:167], v11 offset:16384
M v[112:115], a[176:179], a[64:67], v[112:115]
s_add_u32 m0, s29, 49152
s_add_u32 s3, s23, s31
buffer_load_dwordx4 v2, s[8:11], s3 offen offset:0 lds
M v[112:115], a[180:183], a[68:71], v[112:115]
M v[116:119], a[180:183], a[76:79], v[116:119]
M v[116:119], a[176:179], a[72:75], v[116:119]
ds_read_b64_tr_b16 a[100:101], v12 offset:49152
ds_read_b64_tr_b16 a[102:103], v12 offset:51200
M v[120:123], a[176:179], a[80:83], v[120:123]
M v[120:123], a[180:183], a[84:87], v[120:123]
buffer_load_dwordx4 v3, s[8:11], s3 offen offset:1024 lds
M v[124:127], a[180:183], a[92:95], v[124:127]
M v[124:127], a[176:179], a[88:91], v[124:127]
M v[128:131], a[184:187], a[32:35], v[128:131]
M v[128:131], a[188:191], a[36:39], v[128:131]
ds_read_b128 a[168:171], v10 offset:18432
ds_read_b128 a[172:175], v11 offset:18432
ds_read_b64_tr_b16 a[108:109], v13 offset:49152
ds_read_b64_tr_b16 a[110:111], v13 offset:51200
M v[132:135], a[188:191], a[44:47], v[132:135]
M v[132:135], a[184:187], a[40:43], v[132:135]
M v[136:139], a[184:187], a[48:51], v[136:139]
buffer_load_dwordx4 v4, s[8:11], s3 offen offset:2048 lds
M v[136:139], a[188:191], a[52:55], v[136:139]
M v[140:143], a[188:191], a[60:63], v[140:143]
M v[140:143], a[184:187], a[56:59], v[140:143]
ds_read_b64_tr_b16 a[116:117], v14 offset:49152
ds_read_b64_tr_b16 a[118:119], v14 offset:51200
M v[144:147], a[184:187], a[64:67], v[144:147]
M v[144:147], a[188:191], a[68:71], v[144:147]
buffer_load_dwordx4 v5, s[8:11], s3 offen offset:3072 lds
M v[148:151], a[188:191], a[76:79], v[148:151]
M v[148:151], a[184:187], a[72:75], v[148:151]
M v[152:155], a[184:187], a[80:83], v[152:155]
M v[152:155], a[188:191], a[84:87], v[152:155]
ds_read_b64_tr_b16 a[124:125], v15 offset:49152
ds_read_b64_tr_b16 a[126:127], v15 offset:51200
M v[156:159], a[188:191], a[92:95], v[156:159]
M v[156:159], a[184:187], a[88:91], v[156:159]
s_waitcnt lgkmcnt(10)
M v[160:163], a[160:163], a[32:35], v[160:163]
s_add_u32 s94, s93, 0
buffer_store_dwordx4 a[216:219], v1, s[16:19], s94 offen offset:2048 sc1
M v[160:163], a[164:167], a[36:39], v[160:163]
ds_read_b128 a[176:179], v10 offset:20480
ds_read_b128 a[180:183], v11 offset:20480
M v[164:167], a[164:167], a[44:47], v[164:167]
s_add_u32 s23, s23, 128
s_cmp_eq_u32 s23, s25
s_cselect_b32 s23, s26, s23
M v[164:167], a[160:163], a[40:43], v[164:167]
ds_read_b64_tr_b16 a[132:133], v16 offset:49152
ds_read_b64_tr_b16 a[134:135], v16 offset:51200
M v[168:171], a[160:163], a[48:51], v[168:171]
M v[168:171], a[164:167], a[52:55], v[168:171]
M v[172:175], a[164:167], a[60:63], v[172:175]
M v[172:175], a[160:163], a[56:59], v[172:175]
M v[176:179], a[160:163], a[64:67], v[176:179]
s_add_u32 m0, s29, 81920
s_nop 0
buffer_load_dwordx4 v6, s[12:15], s24 offen offset:0 lds
M v[176:179], a[164:167], a[68:71], v[176:179]
ds_read_b64_tr_b16 a[140:141], v17 offset:49152
ds_read_b64_tr_b16 a[142:143], v17 offset:51200
M v[180:183], a[164:167], a[76:79], v[180:183]
M v[180:183], a[160:163], a[72:75], v[180:183]
M v[184:187], a[160:163], a[80:83], v[184:187]
M v[184:187], a[164:167], a[84:87], v[184:187]
buffer_load_dwordx4 v7, s[12:15], s24 offen offset:1024 lds
M v[188:191], a[164:167], a[92:95], v[188:191]
M v[188:191], a[160:163], a[88:91], v[188:191]
s_waitcnt lgkmcnt(12)
ds_read_b64_tr_b16 a[148:149], v18 offset:49152
ds_read_b64_tr_b16 a[150:151], v18 offset:51200
M v[192:195], a[168:171], a[32:35], v[192:195]
M v[192:195], a[172:175], a[36:39], v[192:195]
ds_read_b128 a[184:187], v10 offset:22528
ds_read_b128 a[188:191], v11 offset:22528
M v[196:199], a[172:175], a[44:47], v[196:199]
M v[196:199], a[168:171], a[40:43], v[196:199]
M v[200:203], a[168:171], a[48:51], v[200:203]
buffer_load_dwordx4 v8, s[12:15], s24 offen offset:2048 lds
M v[200:203], a[172:175], a[52:55], v[200:203]
ds_read_b64_tr_b16 a[156:157], v19 offset:49152
ds_read_b64_tr_b16 a[158:159], v19 offset:51200
M v[204:207], a[172:175], a[60:63], v[204:207]
M v[204:207], a[168:171], a[56:59], v[204:207]
M v[208:211], a[168:171], a[64:67], v[208:211]
M v[208:211], a[172:175], a[68:71], v[208:211]
buffer_load_dwordx4 v9, s[12:15], s24 offen offset:3072 lds
M v[212:215], a[172:175], a[76:79], v[212:215]
M v[212:215], a[168:171], a[72:75], v[212:215]
M v[216:219], a[168:171], a[80:83], v[216:219]
s_add_u32 s94, s93, 0
buffer_store_dwordx4 a[220:223], v1, s[16:19], s94 offen offset:3072 sc1
M v[216:219], a[172:175], a[84:87], v[216:219]
M v[220:223], a[172:175], a[92:95], v[220:223]
M v[220:223], a[168:171], a[88:91], v[220:223]
s_waitcnt lgkmcnt(10)
M v[224:227], a[176:179], a[32:35], v[224:227]
s_add_u32 s24, s24, 262144
s_cmp_eq_u32 s24, s27
s_cselect_b32 s24, s28, s24
s_sub_u32 s6, s6, 1
s_cmp_eq_u32 s6, 0
s_cselect_b64 s[12:13], s[64:65], s[12:13]
M v[224:227], a[180:183], a[36:39], v[224:227]
M v[228:231], a[180:183], a[44:47], v[228:231]
M v[228:231], a[176:179], a[40:43], v[228:231]
M v[232:235], a[176:179], a[48:51], v[232:235]
M v[232:235], a[180:183], a[52:55], v[232:235]
M v[236:239], a[180:183], a[60:63], v[236:239]
M v[236:239], a[176:179], a[56:59], v[236:239]
s_waitcnt vmcnt(11) lgkmcnt(0)
s_barrier
ds_read_b128 a[160:163], v10 offset:32768
ds_read_b128 a[164:167], v11 offset:32768
M v[240:243], a[176:179], a[64:67], v[240:243]
s_add_u32 m0, s29, 0
s_nop 0
buffer_load_dwordx4 v2, s[8:11], s23 offen offset:0 lds
M v[240:243], a[180:183], a[68:71], v[240:243]
M v[244:247], a[180:183], a[76:79], v[244:247]
M v[244:247], a[176:179], a[72:75], v[244:247]
M v[248:251], a[176:179], a[80:83], v[248:251]
M v[248:251], a[180:183], a[84:87], v[248:251]
buffer_load_dwordx4 v3, s[8:11], s23 offen offset:1024 lds
M v[252:255], a[180:183], a[92:95], v[252:255]
M v[252:255], a[176:179], a[88:91], v[252:255]
M a[0:3], a[184:187], a[32:35], a[0:3]
M a[0:3], a[188:191], a[36:39], a[0:3]
ds_read_b128 a[168:171], v10 offset:34816
ds_read_b128 a[172:175], v11 offset:34816
M a[4:7], a[188:191], a[44:47], a[4:7]
M a[4:7], a[184:187], a[40:43], a[4:7]
M a[8:11], a[184:187], a[48:51], a[8:11]
buffer_load_dwordx4 v4, s[8:11], s23 offen offset:2048 lds
M a[8:11], a[188:191], a[52:55], a[8:11]
M a[12:15], a[188:191], a[60:63], a[12:15]
M a[12:15], a[184:187], a[56:59], a[12:15]
M a[16:19], a[184:187], a[64:67], a[16:19]
M a[16:19], a[188:191], a[68:71], a[16:19]
buffer_load_dwordx4 v5, s[8:11], s23 offen offset:3072 lds
M a[20:23], a[188:191], a[76:79], a[20:23]
M a[20:23], a[184:187], a[72:75], a[20:23]
M a[24:27], a[184:187], a[80:83], a[24:27]
M a[24:27], a[188:191], a[84:87], a[24:27]
M a[28:31], a[188:191], a[92:95], a[28:31]
M a[28:31], a[184:187], a[88:91], a[28:31]
s_waitcnt lgkmcnt(2)
M v[32:35], a[160:163], a[96:99], v[32:35]
s_add_u32 m0, s29, 98304
s_nop 0
buffer_load_dwordx4 v6, s[12:15], s24 offen offset:0 lds
M v[32:35], a[164:167], a[100:103], v[32:35]
ds_read_b128 a[176:179], v10 offset:36864
ds_read_b128 a[180:183], v11 offset:36864
M v[36:39], a[164:167], a[108:111], v[36:39]
M v[36:39], a[160:163], a[104:107], v[36:39]
ds_read_b64_tr_b16 a[32:33], v12 offset:0
ds_read_b64_tr_b16 a[34:35], v12 offset:2048
M v[40:43], a[160:163], a[112:115], v[40:43]
M v[40:43], a[164:167], a[116:119], v[40:43]
M v[44:47], a[164:167], a[124:127], v[44:47]
M v[44:47], a[160:163], a[120:123], v[44:47]
ds_read_b64_tr_b16 a[40:41], v13 offset:0
ds_read_b64_tr_b16 a[42:43], v13 offset:2048
M v[48:51], a[160:163], a[128:131], v[48:51]
s_add_u32 s94, s93, 4096
buffer_store_dwordx4 a[224:227], v1, s[16:19], s94 offen offset:0 sc1
M v[48:51], a[164:167], a[132:135], v[48:51]
buffer_load_dwordx4 v7, s[12:15], s24 offen offset:1024 lds
M v[52:55], a[164:167], a[140:143], v[52:55]
M v[52:55], a[160:163], a[136:139], v[52:55]
ds_read_b64_tr_b16 a[48:49], v14 offset:0
ds_read_b64_tr_b16 a[50:51], v14 offset:2048
M v[56:59], a[160:163], a[144:147], v[56:59]
M v[56:59], a[164:167], a[148:151], v[56:59]
M v[60:63], a[164:167], a[156:159], v[60:63]
M v[60:63], a[160:163], a[152:155], v[60:63]
s_waitcnt lgkmcnt(8)
ds_read_b64_tr_b16 a[56:57], v15 offset:0
ds_read_b64_tr_b16 a[58:59], v15 offset:2048
M v[64:67], a[168:171], a[96:99], v[64:67]
buffer_load_dwordx4 v8, s[12:15], s24 offen offset:2048 lds
M v[64:67], a[172:175], a[100:103], v[64:67]
ds_read_b128 a[184:187], v10 offset:38912
ds_read_b128 a[188:191], v11 offset:38912
M v[68:71], a[172:175], a[108:111], v[68:71]
M v[68:71], a[168:171], a[104:107], v[68:71]
ds_read_b64_tr_b16 a[64:65], v16 offset:0
ds_read_b64_tr_b16 a[66:67], v16 offset:2048
M v[72:75], a[168:171], a[112:115], v[72:75]
M v[72:75], a[172:175], a[116:119], v[72:75]
M v[76:79], a[172:175], a[124:127], v[76:79]
M v[76:79], a[168:171], a[120:123], v[76:79]
ds_read_b64_tr_b16 a[72:73], v17 offset:0
ds_read_b64_tr_b16 a[74:75], v17 offset:2048
M v[80:83], a[168:171], a[128:131], v[80:83]
buffer_load_dwordx4 v9, s[12:15], s24 offen offset:3072 lds
M v[80:83], a[172:175], a[132:135], v[80:83]
M v[84:87], a[172:175], a[140:143], v[84:87]
M v[84:87], a[168:171], a[136:139], v[84:87]
ds_read_b64_tr_b16 a[80:81], v18 offset:0
ds_read_b64_tr_b16 a[82:83], v18 offset:2048
M v[88:91], a[168:171], a[144:147], v[88:91]
M v[88:91], a[172:175], a[148:151], v[88:91]
M v[92:95], a[172:175], a[156:159], v[92:95]
s_add_u32 s24, s24, 262144
M v[92:95], a[168:171], a[152:155], v[92:95]
s_waitcnt lgkmcnt(15)
ds_read_b64_tr_b16 a[88:89], v19 offset:0
ds_read_b64_tr_b16 a[90:91], v19 offset:2048
M v[96:99], a[176:179], a[96:99], v[96:99]
M v[96:99], a[180:183], a[100:103], v[96:99]
M v[100:103], a[180:183], a[108:111], v[100:103]
M v[100:103], a[176:179], a[104:107], v[100:103]
M v[104:107], a[176:179], a[112:115], v[104:107]
s_add_u32 s94, s93, 4096
buffer_store_dwordx4 a[228:231], v1, s[16:19], s94 offen offset:1024 sc1
M v[104:107], a[180:183], a[116:119], v[104:107]
M v[108:111], a[180:183], a[124:127], v[108:111]
M v[108:111], a[176:179], a[120:123], v[108:111]
s_waitcnt vmcnt(11) lgkmcnt(0)
s_barrier
ds_read_b128 a[160:163], v10 offset:49152
ds_read_b128 a[164:167], v11 offset:49152
M v[112:115], a[176:179], a[128:131], v[112:115]
s_add_u32 m0, s29, 16384
s_add_u32 s3, s23, s31
buffer_load_dwordx4 v2, s[8:11], s3 offen offset:0 lds
M v[112:115], a[180:183], a[132:135], v[112:115]
M v[116:119], a[180:183], a[140:143], v[116:119]
M v[116:119], a[176:179], a[136:139], v[116:119]
ds_read_b64_tr_b16 a[36:37], v12 offset:16384
ds_read_b64_tr_b16 a[38:39], v12 offset:18432
M v[120:123], a[176:179], a[144:147], v[120:123]
M v[120:123], a[180:183], a[148:151], v[120:123]
buffer_load_dwordx4 v3, s[8:11], s3 offen offset:1024 lds
M v[124:127], a[180:183], a[156:159], v[124:127]
M v[124:127], a[176:179], a[152:155], v[124:127]
M v[128:131], a[184:187], a[96:99], v[128:131]
M v[128:131], a[188:191], a[100:103], v[128:131]
ds_read_b128 a[168:171], v10 offset:51200
ds_read_b128 a[172:175], v11 offset:51200
ds_read_b64_tr_b16 a[44:45], v13 offset:16384
ds_read_b64_tr_b16 a[46:47], v13 offset:18432
M v[132:135], a[188:191], a[108:111], v[132:135]
M v[132:135], a[184:187], a[104:107], v[132:135]
M v[136:139], a[184:187], a[112:115], v[136:139]
buffer_load_dwordx4 v4, s[8:11], s3 offen offset:2048 lds
M v[136:139], a[188:191], a[116:119], v[136:139]
M v[140:143], a[188:191], a[124:127], v[140:143]
M v[140:143], a[184:187], a[120:123], v[140:143]
ds_read_b64_tr_b16 a[52:53], v14 offset:16384
ds_read_b64_tr_b16 a[54:55], v14 offset:18432
M v[144:147], a[184:187], a[128:131], v[144:147]
M v[144:147], a[188:191], a[132:135], v[144:147]
buffer_load_dwordx4 v5, s[8:11], s3 offen offset:3072 lds
M v[148:151], a[188:191], a[140:143], v[148:151]
M v[148:151], a[184:187], a[136:139], v[148:151]
M v[152:155], a[184:187], a[144:147], v[152:155]
M v[152:155], a[188:191], a[148:151], v[152:155]
ds_read_b64_tr_b16 a[60:61], v15 offset:16384
ds_read_b64_tr_b16 a[62:63], v15 offset:18432
M v[156:159], a[188:191], a[156:159], v[156:159]
M v[156:159], a[184:187], a[152:155], v[156:159]
s_waitcnt lgkmcnt(10)
M v[160:163], a[160:163], a[96:99], v[160:163]
s_add_u32 s94, s93, 4096
buffer_store_dwordx4 a[232:235], v1, s[16:19], s94 offen offset:2048 sc1
M v[160:163], a[164:167], a[100:103], v[160:163]
ds_read_b128 a[176:179], v10 offset:53248
ds_read_b128 a[180:183], v11 offset:53248
M v[164:167], a[164:167], a[108:111], v[164:167]
s_add_u32 s23, s23, 128
s_cmp_eq_u32 s23, s25
s_cselect_b32 s23, s26, s23
M v[164:167], a[160:163], a[104:107], v[164:167]
ds_read_b64_tr_b16 a[68:69], v16 offset:16384
ds_read_b64_tr_b16 a[70:71], v16 offset:18432
M v[168:171], a[160:163], a[112:115], v[168:171]
M v[168:171], a[164:167], a[116:119], v[168:171]
M v[172:175], a[164:167], a[124:127], v[172:175]
M v[172:175], a[160:163], a[120:123], v[172:175]
M v[176:179], a[160:163], a[128:131], v[176:179]
s_add_u32 m0, s29, 114688
s_nop 0
buffer_load_dwordx4 v6, s[12:15], s24 offen offset:0 lds
M v[176:179], a[164:167], a[132:135], v[176:179]
ds_read_b64_tr_b16 a[76:77], v17 offset:16384
ds_read_b64_tr_b16 a[78:79], v17 offset:18432
M v[180:183], a[164:167], a[140:143], v[180:183]
M v[180:183], a[160:163], a[136:139], v[180:183]
M v[184:187], a[160:163], a[144:147], v[184:187]
M v[184:187], a[164:167], a[148:151], v[184:187]
buffer_load_dwordx4 v7, s[12:15], s24 offen offset:1024 lds
M v[188:191], a[164:167], a[156:159], v[188:191]
M v[188:191], a[160:163], a[152:155], v[188:191]
s_waitcnt lgkmcnt(12)
ds_read_b64_tr_b16 a[84:85], v18 offset:16384
ds_read_b64_tr_b16 a[86:87], v18 offset:18432
M v[192:195], a[168:171], a[96:99], v[192:195]
M v[192:195], a[172:175], a[100:103], v[192:195]
ds_read_b128 a[184:187], v10 offset:55296
ds_read_b128 a[188:191], v11 offset:55296
M v[196:199], a[172:175], a[108:111], v[196:199]
M v[196:199], a[168:171], a[104:107], v[196:199]
M v[200:203], a[168:171], a[112:115], v[200:203]
buffer_load_dwordx4 v8, s[12:15], s24 offen offset:2048 lds
M v[200:203], a[172:175], a[116:119], v[200:203]
ds_read_b64_tr_b16 a[92:93], v19 offset:16384
ds_read_b64_tr_b16 a[94:95], v19 offset:18432
M v[204:207], a[172:175], a[124:127], v[204:207]
M v[204:207], a[168:171], a[120:123], v[204:207]
M v[208:211], a[168:171], a[128:131], v[208:211]
M v[208:211], a[172:175], a[132:135], v[208:211]
buffer_load_dwordx4 v9, s[12:15], s24 offen offset:3072 lds
M v[212:215], a[172:175], a[140:143], v[212:215]
M v[212:215], a[168:171], a[136:139], v[212:215]
M v[216:219], a[168:171], a[144:147], v[216:219]
s_add_u32 s94, s93, 4096
buffer_store_dwordx4 a[236:239], v1, s[16:19], s94 offen offset:3072 sc1
M v[216:219], a[172:175], a[148:151], v[216:219]
M v[220:223], a[172:175], a[156:159], v[220:223]
M v[220:223], a[168:171], a[152:155], v[220:223]
s_waitcnt lgkmcnt(10)
M v[224:227], a[176:179], a[96:99], v[224:227]
s_add_u32 s24, s24, 262144
s_cmp_eq_u32 s24, s27
s_cselect_b32 s24, s28, s24
s_sub_u32 s6, s6, 1
s_cmp_eq_u32 s6, 0
s_cselect_b64 s[12:13], s[64:65], s[12:13]
M v[224:227], a[180:183], a[100:103], v[224:227]
M v[228:231], a[180:183], a[108:111], v[228:231]
M v[228:231], a[176:179], a[104:107], v[228:231]
M v[232:235], a[176:179], a[112:115], v[232:235]
M v[232:235], a[180:183], a[116:119], v[232:235]
M v[236:239], a[180:183], a[124:127], v[236:239]
M v[236:239], a[176:179], a[120:123], v[236:239]
s_waitcnt vmcnt(11) lgkmcnt(0)
s_barrier
ds_read_b128 a[160:163], v10 offset:0
ds_read_b128 a[164:167], v11 offset:0
M v[240:243], a[176:179], a[128:131], v[240:243]
s_add_u32 m0, s29, 32768
s_nop 0
buffer_load_dwordx4 v2, s[8:11], s23 offen offset:0 lds
M v[240:243], a[180:183], a[132:135], v[240:243]
M v[244:247], a[180:183], a[140:143], v[244:247]
M v[244:247], a[176:179], a[136:139], v[244:247]
M v[248:251], a[176:179], a[144:147], v[248:251]
M v[248:251], a[180:183], a[148:151], v[248:251]
buffer_load_dwordx4 v3, s[8:11], s23 offen offset:1024 lds
M v[252:255], a[180:183], a[156:159], v[252:255]
M v[252:255], a[176:179], a[152:155], v[252:255]
M a[0:3], a[184:187], a[96:99], a[0:3]
M a[0:3], a[188:191], a[100:103], a[0:3]
ds_read_b128 a[168:171], v10 offset:2048
ds_read_b128 a[172:175], v11 offset:2048
M a[4:7], a[188:191], a[108:111], a[4:7]
M a[4:7], a[184:187], a[104:107], a[4:7]
M a[8:11], a[184:187], a[112:115], a[8:11]
buffer_load_dwordx4 v4, s[8:11], s23 offen offset:2048 lds
M a[8:11], a[188:191], a[116:119], a[8:11]
M a[12:15], a[188:191], a[124:127], a[12:15]
M a[12:15], a[184:187], a[120:123], a[12:15]
M a[16:19], a[184:187], a[128:131], a[16:19]
M a[16:19], a[188:191], a[132:135], a[16:19]
buffer_load_dwordx4 v5, s[8:11], s23 offen offset:3072 lds
M a[20:23], a[188:191], a[140:143], a[20:23]
M a[20:23], a[184:187], a[136:139], a[20:23]
M a[24:27], a[184:187], a[144:147], a[24:27]
M a[24:27], a[188:191], a[148:151], a[24:27]
M a[28:31], a[188:191], a[156:159], a[28:31]
M a[28:31], a[184:187], a[152:155], a[28:31]
s_waitcnt lgkmcnt(2)
M v[32:35], a[160:163], a[32:35], v[32:35]
s_add_u32 m0, s29, 65536
s_nop 0
buffer_load_dwordx4 v6, s[12:15], s24 offen offset:0 lds
M v[32:35], a[164:167], a[36:39], v[32:35]
ds_read_b128 a[176:179], v10 offset:4096
ds_read_b128 a[180:183], v11 offset:4096
M v[36:39], a[164:167], a[44:47], v[36:39]
M v[36:39], a[160:163], a[40:43], v[36:39]
ds_read_b64_tr_b16 a[96:97], v12 offset:32768
ds_read_b64_tr_b16 a[98:99], v12 offset:34816
M v[40:43], a[160:163], a[48:51], v[40:43]
M v[40:43], a[164:167], a[52:55], v[40:43]
M v[44:47], a[164:167], a[60:63], v[44:47]
M v[44:47], a[160:163], a[56:59], v[44:47]
ds_read_b64_tr_b16 a[104:105], v13 offset:32768
ds_read_b64_tr_b16 a[106:107], v13 offset:34816
M v[48:51], a[160:163], a[64:67], v[48:51]
s_add_u32 s94, s93, 8192
buffer_store_dwordx4 a[240:243], v1, s[16:19], s94 offen offset:0 sc1
M v[48:51], a[164:167], a[68:71], v[48:51]
buffer_load_dwordx4 v7, s[12:15], s24 offen offset:1024 lds
M v[52:55], a[164:167], a[76:79], v[52:55]
M v[52:55], a[160:163], a[72:75], v[52:55]
ds_read_b64_tr_b16 a[112:113], v14 offset:32768
ds_read_b64_tr_b16 a[114:115], v14 offset:34816
M v[56:59], a[160:163], a[80:83], v[56:59]
M v[56:59], a[164:167], a[84:87], v[56:59]
M v[60:63], a[164:167], a[92:95], v[60:63]
M v[60:63], a[160:163], a[88:91], v[60:63]
s_waitcnt lgkmcnt(8)
ds_read_b64_tr_b16 a[120:121], v15 offset:32768
ds_read_b64_tr_b16 a[122:123], v15 offset:34816
M v[64:67], a[168:171], a[32:35], v[64:67]
buffer_load_dwordx4 v8, s[12:15], s24 offen offset:2048 lds
M v[64:67], a[172:175], a[36:39], v[64:67]
ds_read_b128 a[184:187], v10 offset:6144
ds_read_b128 a[188:191], v11 offset:6144
M v[68:71], a[172:175], a[44:47], v[68:71]
M v[68:71], a[168:171], a[40:43], v[68:71]
ds_read_b64_tr_b16 a[128:129], v16 offset:32768
ds_read_b64_tr_b16 a[130:131], v16 offset:34816
M v[72:75], a[168:171], a[48:51], v[72:75]
M v[72:75], a[172:175], a[52:55], v[72:75]
M v[76:79], a[172:175], a[60:63], v[76:79]
M v[76:79], a[168:171], a[56:59], v[76:79]
ds_read_b64_tr_b16 a[136:137], v17 offset:32768
ds_read_b64_tr_b16 a[138:139], v17 offset:34816
M v[80:83], a[168:171], a[64:67], v[80:83]
buffer_load_dwordx4 v9, s[12:15], s24 offen offset:3072 lds
M v[80:83], a[172:175], a[68:71], v[80:83]
M v[84:87], a[172:175], a[76:79], v[84:87]
M v[84:87], a[168:171], a[72:75], v[84:87]
ds_read_b64_tr_b16 a[144:145], v18 offset:32768
ds_read_b64_tr_b16 a[146:147], v18 offset:34816
M v[88:91], a[168:171], a[80:83], v[88:91]
M v[88:91], a[172:175], a[84:87], v[88:91]
M v[92:95], a[172:175], a[92:95], v[92:95]
s_add_u32 s24, s24, 262144
M v[92:95], a[168:171], a[88:91], v[92:95]
s_waitcnt lgkmcnt(15)
ds_read_b64_tr_b16 a[152:153], v19 offset:32768
ds_read_b64_tr_b16 a[154:155], v19 offset:34816
M v[96:99], a[176:179], a[32:35], v[96:99]
M v[96:99], a[180:183], a[36:39], v[96:99]
M v[100:103], a[180:183], a[44:47], v[100:103]
M v[100:103], a[176:179], a[40:43], v[100:103]
M v[104:107], a[176:179], a[48:51], v[104:107]
s_add_u32 s94, s93, 8192
buffer_store_dwordx4 a[244:247], v1, s[16:19], s94 offen offset:1024 sc1
M v[104:107], a[180:183], a[52:55], v[104:107]
M v[108:111], a[180:183], a[60:63], v[108:111]
M v[108:111], a[176:179], a[56:59], v[108:111]
s_waitcnt vmcnt(11) lgkmcnt(0)
s_barrier
ds_read_b128 a[160:163], v10 offset:16384
ds_read_b128 a[164:167], v11 offset:16384
M v[112:115], a[176:179], a[64:67], v[112:115]
s_add_u32 m0, s29, 49152
s_add_u32 s3, s23, s31
buffer_load_dwordx4 v2, s[8:11], s3 offen offset:0 lds
M v[112:115], a[180:183], a[68:71], v[112:115]
M v[116:119], a[180:183], a[76:79], v[116:119]
M v[116:119], a[176:179], a[72:75], v[116:119]
ds_read_b64_tr_b16 a[100:101], v12 offset:49152
ds_read_b64_tr_b16 a[102:103], v12 offset:51200
M v[120:123], a[176:179], a[80:83], v[120:123]
M v[120:123], a[180:183], a[84:87], v[120:123]
buffer_load_dwordx4 v3, s[8:11], s3 offen offset:1024 lds
M v[124:127], a[180:183], a[92:95], v[124:127]
M v[124:127], a[176:179], a[88:91], v[124:127]
M v[128:131], a[184:187], a[32:35], v[128:131]
M v[128:131], a[188:191], a[36:39], v[128:131]
ds_read_b128 a[168:171], v10 offset:18432
ds_read_b128 a[172:175], v11 offset:18432
ds_read_b64_tr_b16 a[108:109], v13 offset:49152
ds_read_b64_tr_b16 a[110:111], v13 offset:51200
M v[132:135], a[188:191], a[44:47], v[132:135]
M v[132:135], a[184:187], a[40:43], v[132:135]
M v[136:139], a[184:187], a[48:51], v[136:139]
buffer_load_dwordx4 v4, s[8:11], s3 offen offset:2048 lds
M v[136:139], a[188:191], a[52:55], v[136:139]
M v[140:143], a[188:191], a[60:63], v[140:143]
M v[140:143], a[184:187], a[56:59], v[140:143]
ds_read_b64_tr_b16 a[116:117], v14 offset:49152
ds_read_b64_tr_b16 a[118:119], v14 offset:51200
M v[144:147], a[184:187], a[64:67], v[144:147]
M v[144:147], a[188:191], a[68:71], v[144:147]
buffer_load_dwordx4 v5, s[8:11], s3 offen offset:3072 lds
M v[148:151], a[188:191], a[76:79], v[148:151]
M v[148:151], a[184:187], a[72:75], v[148:151]
M v[152:155], a[184:187], a[80:83], v[152:155]
M v[152:155], a[188:191], a[84:87], v[152:155]
ds_read_b64_tr_b16 a[124:125], v15 offset:49152
ds_read_b64_tr_b16 a[126:127], v15 offset:51200
M v[156:159], a[188:191], a[92:95], v[156:159]
M v[156:159], a[184:187], a[88:91], v[156:159]
s_waitcnt lgkmcnt(10)
M v[160:163], a[160:163], a[32:35], v[160:163]
s_add_u32 s94, s93, 8192
buffer_store_dwordx4 a[248:251], v1, s[16:19], s94 offen offset:2048 sc1
M v[160:163], a[164:167], a[36:39], v[160:163]
ds_read_b128 a[176:179], v10 offset:20480
ds_read_b128 a[180:183], v11 offset:20480
M v[164:167], a[164:167], a[44:47], v[164:167]
s_add_u32 s23, s23, 128
s_cmp_eq_u32 s23, s25
s_cselect_b32 s23, s26, s23
M v[164:167], a[160:163], a[40:43], v[164:167]
ds_read_b64_tr_b16 a[132:133], v16 offset:49152
ds_read_b64_tr_b16 a[134:135], v16 offset:51200
M v[168:171], a[160:163], a[48:51], v[168:171]
M v[168:171], a[164:167], a[52:55], v[168:171]
M v[172:175], a[164:167], a[60:63], v[172:175]
M v[172:175], a[160:163], a[56:59], v[172:175]
M v[176:179], a[160:163], a[64:67], v[176:179]
s_add_u32 m0, s29, 81920
s_nop 0
buffer_load_dwordx4 v6, s[12:15], s24 offen offset:0 lds
M v[176:179], a[164:167], a[68:71], v[176:179]
ds_read_b64_tr_b16 a[140:141], v17 offset:49152
ds_read_b64_tr_b16 a[142:143], v17 offset:51200
M v[180:183], a[164:167], a[76:79], v[180:183]
M v[180:183], a[160:163], a[72:75], v[180:183]
M v[184:187], a[160:163], a[80:83], v[184:187]
M v[184:187], a[164:167], a[84:87], v[184:187]
buffer_load_dwordx4 v7, s[12:15], s24 offen offset:1024 lds
M v[188:191], a[164:167], a[92:95], v[188:191]
M v[188:191], a[160:163], a[88:91], v[188:191]
s_waitcnt lgkmcnt(12)
ds_read_b64_tr_b16 a[148:149], v18 offset:49152
ds_read_b64_tr_b16 a[150:151], v18 offset:51200
M v[192:195], a[168:171], a[32:35], v[192:195]
M v[192:195], a[172:175], a[36:39], v[192:195]
ds_read_b128 a[184:187], v10 offset:22528
ds_read_b128 a[188:191], v11 offset:22528
M v[196:199], a[172:175], a[44:47], v[196:199]
M v[196:199], a[168:171], a[40:43], v[196:199]
M v[200:203], a[168:171], a[48:51], v[200:203]
buffer_load_dwordx4 v8, s[12:15], s24 offen offset:2048 lds
M v[200:203], a[172:175], a[52:55], v[200:203]
ds_read_b64_tr_b16 a[156:157], v19 offset:49152
ds_read_b64_tr_b16 a[158:159], v19 offset:51200
M v[204:207], a[172:175], a[60:63], v[204:207]
M v[204:207], a[168:171], a[56:59], v[204:207]
M v[208:211], a[168:171], a[64:67], v[208:211]
M v[208:211], a[172:175], a[68:71], v[208:211]
buffer_load_dwordx4 v9, s[12:15], s24 offen offset:3072 lds
M v[212:215], a[172:175], a[76:79], v[212:215]
M v[212:215], a[168:171], a[72:75], v[212:215]
M v[216:219], a[168:171], a[80:83], v[216:219]
s_add_u32 s94, s93, 8192
buffer_store_dwordx4 a[252:255], v1, s[16:19], s94 offen offset:3072 sc1
M v[216:219], a[172:175], a[84:87], v[216:219]
M v[220:223], a[172:175], a[92:95], v[220:223]
M v[220:223], a[168:171], a[88:91], v[220:223]
s_waitcnt lgkmcnt(10)
M v[224:227], a[176:179], a[32:35], v[224:227]
s_add_u32 s24, s24, 262144
s_cmp_eq_u32 s24, s27
s_cselect_b32 s24, s28, s24
s_sub_u32 s6, s6, 1
s_cmp_eq_u32 s6, 0
s_cselect_b64 s[12:13], s[64:65], s[12:13]
M v[224:227], a[180:183], a[36:39], v[224:227]
M v[228:231], a[180:183], a[44:47], v[228:231]
M v[228:231], a[176:179], a[40:43], v[228:231]
M v[232:235], a[176:179], a[48:51], v[232:235]
M v[232:235], a[180:183], a[52:55], v[232:235]
M v[236:239], a[180:183], a[60:63], v[236:239]
M v[236:239], a[176:179], a[56:59], v[236:239]
s_waitcnt vmcnt(11) lgkmcnt(0)
s_barrier
ds_read_b128 a[160:163], v10 offset:32768
ds_read_b128 a[164:167], v11 offset:32768
M v[240:243], a[176:179], a[64:67], v[240:243]
s_add_u32 m0, s29, 0
s_nop 0
buffer_load_dwordx4 v2, s[8:11], s23 offen offset:0 lds
M v[240:243], a[180:183], a[68:71], v[240:243]
M v[244:247], a[180:183], a[76:79], v[244:247]
M v[244:247], a[176:179], a[72:75], v[244:247]
M v[248:251], a[176:179], a[80:83], v[248:251]
M v[248:251], a[180:183], a[84:87], v[248:251]
buffer_load_dwordx4 v3, s[8:11], s23 offen offset:1024 lds
M v[252:255], a[180:183], a[92:95], v[252:255]
M v[252:255], a[176:179], a[88:91], v[252:255]
M a[0:3], a[184:187], a[32:35], a[0:3]
M a[0:3], a[188:191], a[36:39], a[0:3]
ds_read_b128 a[168:171], v10 offset:34816
ds_read_b128 a[172:175], v11 offset:34816
M a[4:7], a[188:191], a[44:47], a[4:7]
M a[4:7], a[184:187], a[40:43], a[4:7]
M a[8:11], a[184:187], a[48:51], a[8:11]
buffer_load_dwordx4 v4, s[8:11], s23 offen offset:2048 lds
M a[8:11], a[188:191], a[52:55], a[8:11]
M a[12:15], a[188:191], a[60:63], a[12:15]
M a[12:15], a[184:187], a[56:59], a[12:15]
M a[16:19], a[184:187], a[64:67], a[16:19]
M a[16:19], a[188:191], a[68:71], a[16:19]
buffer_load_dwordx4 v5, s[8:11], s23 offen offset:3072 lds
M a[20:23], a[188:191], a[76:79], a[20:23]
M a[20:23], a[184:187], a[72:75], a[20:23]
M a[24:27], a[184:187], a[80:83], a[24:27]
M a[24:27], a[188:191], a[84:87], a[24:27]
M a[28:31], a[188:191], a[92:95], a[28:31]
M a[28:31], a[184:187], a[88:91], a[28:31]
s_waitcnt lgkmcnt(2)
M v[32:35], a[160:163], a[96:99], v[32:35]
s_add_u32 m0, s29, 98304
s_nop 0
buffer_load_dwordx4 v6, s[12:15], s24 offen offset:0 lds
M v[32:35], a[164:167], a[100:103], v[32:35]
ds_read_b128 a[176:179], v10 offset:36864
ds_read_b128 a[180:183], v11 offset:36864
M v[36:39], a[164:167], a[108:111], v[36:39]
M v[36:39], a[160:163], a[104:107], v[36:39]
ds_read_b64_tr_b16 a[32:33], v12 offset:0
ds_read_b64_tr_b16 a[34:35], v12 offset:2048
M v[40:43], a[160:163], a[112:115], v[40:43]
M v[40:43], a[164:167], a[116:119], v[40:43]
M v[44:47], a[164:167], a[124:127], v[44:47]
M v[44:47], a[160:163], a[120:123], v[44:47]
ds_read_b64_tr_b16 a[40:41], v13 offset:0
ds_read_b64_tr_b16 a[42:43], v13 offset:2048
M v[48:51], a[160:163], a[128:131], v[48:51]
buffer_load_dwordx4 v7, s[12:15], s24 offen offset:1024 lds
M v[48:51], a[164:167], a[132:135], v[48:51]
M v[52:55], a[164:167], a[140:143], v[52:55]
M v[52:55], a[160:163], a[136:139], v[52:55]
ds_read_b64_tr_b16 a[48:49], v14 offset:0
ds_read_b64_tr_b16 a[50:51], v14 offset:2048
M v[56:59], a[160:163], a[144:147], v[56:59]
M v[56:59], a[164:167], a[148:151], v[56:59]
M v[60:63], a[164:167], a[156:159], v[60:63]
buffer_load_dwordx4 v8, s[12:15], s24 offen offset:2048 lds
M v[60:63], a[160:163], a[152:155], v[60:63]
s_waitcnt lgkmcnt(8)
ds_read_b64_tr_b16 a[56:57], v15 offset:0
ds_read_b64_tr_b16 a[58:59], v15 offset:2048
M v[64:67], a[168:171], a[96:99], v[64:67]
M v[64:67], a[172:175], a[100:103], v[64:67]
ds_read_b128 a[184:187], v10 offset:38912
ds_read_b128 a[188:191], v11 offset:38912
M v[68:71], a[172:175], a[108:111], v[68:71]
M v[68:71], a[168:171], a[104:107], v[68:71]
ds_read_b64_tr_b16 a[64:65], v16 offset:0
ds_read_b64_tr_b16 a[66:67], v16 offset:2048
M v[72:75], a[168:171], a[112:115], v[72:75]
M v[72:75], a[172:175], a[116:119], v[72:75]
M v[76:79], a[172:175], a[124:127], v[76:79]
M v[76:79], a[168:171], a[120:123], v[76:79]
ds_read_b64_tr_b16 a[72:73], v17 offset:0
ds_read_b64_tr_b16 a[74:75], v17 offset:2048
M v[80:83], a[168:171], a[128:131], v[80:83]
buffer_load_dwordx4 v9, s[12:15], s24 offen offset:3072 lds
M v[80:83], a[172:175], a[132:135], v[80:83]
M v[84:87], a[172:175], a[140:143], v[84:87]
M v[84:87], a[168:171], a[136:139], v[84:87]
ds_read_b64_tr_b16 a[80:81], v18 offset:0
ds_read_b64_tr_b16 a[82:83], v18 offset:2048
M v[88:91], a[168:171], a[144:147], v[88:91]
M v[88:91], a[172:175], a[148:151], v[88:91]
M v[92:95], a[172:175], a[156:159], v[92:95]
s_add_u32 s24, s24, 262144
M v[92:95], a[168:171], a[152:155], v[92:95]
s_waitcnt lgkmcnt(15)
ds_read_b64_tr_b16 a[88:89], v19 offset:0
ds_read_b64_tr_b16 a[90:91], v19 offset:2048
M v[96:99], a[176:179], a[96:99], v[96:99]
M v[96:99], a[180:183], a[100:103], v[96:99]
M v[100:103], a[180:183], a[108:111], v[100:103]
M v[100:103], a[176:179], a[104:107], v[100:103]
M v[104:107], a[176:179], a[112:115], v[104:107]
M v[104:107], a[180:183], a[116:119], v[104:107]
M v[108:111], a[180:183], a[124:127], v[108:111]
M v[108:111], a[176:179], a[120:123], v[108:111]
s_waitcnt vmcnt(9) lgkmcnt(0)
s_barrier
ds_read_b128 a[160:163], v10 offset:49152
ds_read_b128 a[164:167], v11 offset:49152
M v[112:115], a[176:179], a[128:131], v[112:115]
s_add_u32 m0, s29, 16384
s_add_u32 s3, s23, s31
buffer_load_dwordx4 v2, s[8:11], s3 offen offset:0 lds
M v[112:115], a[180:183], a[132:135], v[112:115]
M v[116:119], a[180:183], a[140:143], v[116:119]
M v[116:119], a[176:179], a[136:139], v[116:119]
ds_read_b64_tr_b16 a[36:37], v12 offset:16384
ds_read_b64_tr_b16 a[38:39], v12 offset:18432
M v[120:123], a[176:179], a[144:147], v[120:123]
M v[120:123], a[180:183], a[148:151], v[120:123]
buffer_load_dwordx4 v3, s[8:11], s3 offen offset:1024 lds
M v[124:127], a[180:183], a[156:159], v[124:127]
M v[124:127], a[176:179], a[152:155], v[124:127]
M v[128:131], a[184:187], a[96:99], v[128:131]
M v[128:131], a[188:191], a[100:103], v[128:131]
ds_read_b128 a[168:171], v10 offset:51200
ds_read_b128 a[172:175], v11 offset:51200
ds_read_b64_tr_b16 a[44:45], v13 offset:16384
ds_read_b64_tr_b16 a[46:47], v13 offset:18432
M v[132:135], a[188:191], a[108:111], v[132:135]
M v[132:135], a[184:187], a[104:107], v[132:135]
M v[136:139], a[184:187], a[112:115], v[136:139]
buffer_load_dwordx4 v4, s[8:11], s3 offen offset:2048 lds
M v[136:139], a[188:191], a[116:119], v[136:139]
M v[140:143], a[188:191], a[124:127], v[140:143]
M v[140:143], a[184:187], a[120:123], v[140:143]
ds_read_b64_tr_b16 a[52:53], v14 offset:16384
ds_read_b64_tr_b16 a[54:55], v14 offset:18432
M v[144:147], a[184:187], a[128:131], v[144:147]
M v[144:147], a[188:191], a[132:135], v[144:147]
M v[148:151], a[188:191], a[140:143], v[148:151]
buffer_load_dwordx4 v5, s[8:11], s3 offen offset:3072 lds
M v[148:151], a[184:187], a[136:139], v[148:151]
M v[152:155], a[184:187], a[144:147], v[152:155]
M v[152:155], a[188:191], a[148:151], v[152:155]
ds_read_b64_tr_b16 a[60:61], v15 offset:16384
ds_read_b64_tr_b16 a[62:63], v15 offset:18432
M v[156:159], a[188:191], a[156:159], v[156:159]
M v[156:159], a[184:187], a[152:155], v[156:159]
s_waitcnt lgkmcnt(10)
M v[160:163], a[160:163], a[96:99], v[160:163]
M v[160:163], a[164:167], a[100:103], v[160:163]
ds_read_b128 a[176:179], v10 offset:53248
ds_read_b128 a[180:183], v11 offset:53248
M v[164:167], a[164:167], a[108:111], v[164:167]
s_add_u32 s23, s23, 128
s_cmp_eq_u32 s23, s25
s_cselect_b32 s23, s26, s23
M v[164:167], a[160:163], a[104:107], v[164:167]
ds_read_b64_tr_b16 a[68:69], v16 offset:16384
ds_read_b64_tr_b16 a[70:71], v16 offset:18432
M v[168:171], a[160:163], a[112:115], v[168:171]
M v[168:171], a[164:167], a[116:119], v[168:171]
M v[172:175], a[164:167], a[124:127], v[172:175]
M v[172:175], a[160:163], a[120:123], v[172:175]
M v[176:179], a[160:163], a[128:131], v[176:179]
s_add_u32 m0, s29, 114688
s_nop 0
buffer_load_dwordx4 v6, s[12:15], s24 offen offset:0 lds
M v[176:179], a[164:167], a[132:135], v[176:179]
ds_read_b64_tr_b16 a[76:77], v17 offset:16384
ds_read_b64_tr_b16 a[78:79], v17 offset:18432
M v[180:183], a[164:167], a[140:143], v[180:183]
M v[180:183], a[160:163], a[136:139], v[180:183]
M v[184:187], a[160:163], a[144:147], v[184:187]
M v[184:187], a[164:167], a[148:151], v[184:187]
buffer_load_dwordx4 v7, s[12:15], s24 offen offset:1024 lds
M v[188:191], a[164:167], a[156:159], v[188:191]
M v[188:191], a[160:163], a[152:155], v[188:191]
s_waitcnt lgkmcnt(12)
ds_read_b64_tr_b16 a[84:85], v18 offset:16384
ds_read_b64_tr_b16 a[86:87], v18 offset:18432
M v[192:195], a[168:171], a[96:99], v[192:195]
M v[192:195], a[172:175], a[100:103], v[192:195]
ds_read_b128 a[184:187], v10 offset:55296
ds_read_b128 a[188:191], v11 offset:55296
M v[196:199], a[172:175], a[108:111], v[196:199]
M v[196:199], a[168:171], a[104:107], v[196:199]
M v[200:203], a[168:171], a[112:115], v[200:203]
buffer_load_dwordx4 v8, s[12:15], s24 offen offset:2048 lds
M v[200:203], a[172:175], a[116:119], v[200:203]
ds_read_b64_tr_b16 a[92:93], v19 offset:16384
ds_read_b64_tr_b16 a[94:95], v19 offset:18432
M v[204:207], a[172:175], a[124:127], v[204:207]
M v[204:207], a[168:171], a[120:123], v[204:207]
M v[208:211], a[168:171], a[128:131], v[208:211]
M v[208:211], a[172:175], a[132:135], v[208:211]
M v[212:215], a[172:175], a[140:143], v[212:215]
buffer_load_dwordx4 v9, s[12:15], s24 offen offset:3072 lds
M v[212:215], a[168:171], a[136:139], v[212:215]
M v[216:219], a[168:171], a[144:147], v[216:219]
M v[216:219], a[172:175], a[148:151], v[216:219]
M v[220:223], a[172:175], a[156:159], v[220:223]
M v[220:223], a[168:171], a[152:155], v[220:223]
s_waitcnt lgkmcnt(10)
M v[224:227], a[176:179], a[96:99], v[224:227]
s_add_u32 s24, s24, 262144
s_cmp_eq_u32 s24, s27
s_cselect_b32 s24, s28, s24
s_sub_u32 s6, s6, 1
s_cmp_eq_u32 s6, 0
s_cselect_b64 s[12:13], s[64:65], s[12:13]
M v[224:227], a[180:183], a[100:103], v[224:227]
M v[228:231], a[180:183], a[108:111], v[228:231]
M v[228:231], a[176:179], a[104:107], v[228:231]
M v[232:235], a[176:179], a[112:115], v[232:235]
M v[232:235], a[180:183], a[116:119], v[232:235]
M v[236:239], a[180:183], a[124:127], v[236:239]
M v[236:239], a[176:179], a[120:123], v[236:239]
s_waitcnt vmcnt(8) lgkmcnt(0)
s_barrier
ds_read_b128 a[160:163], v10 offset:0
ds_read_b128 a[164:167], v11 offset:0
M v[240:243], a[176:179], a[128:131], v[240:243]
s_add_u32 m0, s29, 32768
s_nop 0
buffer_load_dwordx4 v2, s[8:11], s23 offen offset:0 lds
M v[240:243], a[180:183], a[132:135], v[240:243]
M v[244:247], a[180:183], a[140:143], v[244:247]
M v[244:247], a[176:179], a[136:139], v[244:247]
M v[248:251], a[176:179], a[144:147], v[248:251]
M v[248:251], a[180:183], a[148:151], v[248:251]
M v[252:255], a[180:183], a[156:159], v[252:255]
M v[252:255], a[176:179], a[152:155], v[252:255]
M a[0:3], a[184:187], a[96:99], a[0:3]
M a[0:3], a[188:191], a[100:103], a[0:3]
ds_read_b128 a[168:171], v10 offset:2048
ds_read_b128 a[172:175], v11 offset:2048
M a[4:7], a[188:191], a[108:111], a[4:7]
M a[4:7], a[184:187], a[104:107], a[4:7]
M a[8:11], a[184:187], a[112:115], a[8:11]
buffer_load_dwordx4 v3, s[8:11], s23 offen offset:1024 lds
M a[8:11], a[188:191], a[116:119], a[8:11]
M a[12:15], a[188:191], a[124:127], a[12:15]
M a[12:15], a[184:187], a[120:123], a[12:15]
M a[16:19], a[184:187], a[128:131], a[16:19]
M a[16:19], a[188:191], a[132:135], a[16:19]
M a[20:23], a[188:191], a[140:143], a[20:23]
M a[20:23], a[184:187], a[136:139], a[20:23]
M a[24:27], a[184:187], a[144:147], a[24:27]
M a[24:27], a[188:191], a[148:151], a[24:27]
M a[28:31], a[188:191], a[156:159], a[28:31]
M a[28:31], a[184:187], a[152:155], a[28:31]
s_waitcnt lgkmcnt(2)
M v[32:35], a[160:163], a[32:35], v[32:35]
buffer_load_dwordx4 v4, s[8:11], s23 offen offset:2048 lds
M v[32:35], a[164:167], a[36:39], v[32:35]
ds_read_b128 a[176:179], v10 offset:4096
ds_read_b128 a[180:183], v11 offset:4096
M v[36:39], a[164:167], a[44:47], v[36:39]
M v[36:39], a[160:163], a[40:43], v[36:39]
ds_read_b64_tr_b16 a[96:97], v12 offset:32768
ds_read_b64_tr_b16 a[98:99], v12 offset:34816
M v[40:43], a[160:163], a[48:51], v[40:43]
M v[40:43], a[164:167], a[52:55], v[40:43]
M v[44:47], a[164:167], a[60:63], v[44:47]
M v[44:47], a[160:163], a[56:59], v[44:47]
ds_read_b64_tr_b16 a[104:105], v13 offset:32768
ds_read_b64_tr_b16 a[106:107], v13 offset:34816
M v[48:51], a[160:163], a[64:67], v[48:51]
M v[48:51], a[164:167], a[68:71], v[48:51]
M v[52:55], a[164:167], a[76:79], v[52:55]
M v[52:55], a[160:163], a[72:75], v[52:55]
ds_read_b64_tr_b16 a[112:113], v14 offset:32768
ds_read_b64_tr_b16 a[114:115], v14 offset:34816
M v[56:59], a[160:163], a[80:83], v[56:59]
M v[56:59], a[164:167], a[84:87], v[56:59]
M v[60:63], a[164:167], a[92:95], v[60:63]
M v[60:63], a[160:163], a[88:91], v[60:63]
s_waitcnt lgkmcnt(8)
ds_read_b64_tr_b16 a[120:121], v15 offset:32768
ds_read_b64_tr_b16 a[122:123], v15 offset:34816
M v[64:67], a[168:171], a[32:35], v[64:67]
M v[64:67], a[172:175], a[36:39], v[64:67]
ds_read_b128 a[184:187], v10 offset:6144
ds_read_b128 a[188:191], v11 offset:6144
M v[68:71], a[172:175], a[44:47], v[68:71]
M v[68:71], a[168:171], a[40:43], v[68:71]
ds_read_b64_tr_b16 a[128:129], v16 offset:32768
ds_read_b64_tr_b16 a[130:131], v16 offset:34816
M v[72:75], a[168:171], a[48:51], v[72:75]
buffer_load_dwordx4 v5, s[8:11], s23 offen offset:3072 lds
M v[72:75], a[172:175], a[52:55], v[72:75]
M v[76:79], a[172:175], a[60:63], v[76:79]
M v[76:79], a[168:171], a[56:59], v[76:79]
ds_read_b64_tr_b16 a[136:137], v17 offset:32768
ds_read_b64_tr_b16 a[138:139], v17 offset:34816
M v[80:83], a[168:171], a[64:67], v[80:83]
M v[80:83], a[172:175], a[68:71], v[80:83]
M v[84:87], a[172:175], a[76:79], v[84:87]
M v[84:87], a[168:171], a[72:75], v[84:87]
ds_read_b64_tr_b16 a[144:145], v18 offset:32768
ds_read_b64_tr_b16 a[146:147], v18 offset:34816
M v[88:91], a[168:171], a[80:83], v[88:91]
M v[88:91], a[172:175], a[84:87], v[88:91]
M v[92:95], a[172:175], a[92:95], v[92:95]
M v[92:95], a[168:171], a[88:91], v[92:95]
s_waitcnt lgkmcnt(15)
ds_read_b64_tr_b16 a[152:153], v19 offset:32768
ds_read_b64_tr_b16 a[154:155], v19 offset:34816
M v[96:99], a[176:179], a[32:35], v[96:99]
M v[96:99], a[180:183], a[36:39], v[96:99]
M v[100:103], a[180:183], a[44:47], v[100:103]
M v[100:103], a[176:179], a[40:43], v[100:103]
M v[104:107], a[176:179], a[48:51], v[104:107]
M v[104:107], a[180:183], a[52:55], v[104:107]
M v[108:111], a[180:183], a[60:63], v[108:111]
M v[108:111], a[176:179], a[56:59], v[108:111]
s_waitcnt vmcnt(4) lgkmcnt(0)
s_barrier
ds_read_b128 a[160:163], v10 offset:16384
ds_read_b128 a[164:167], v11 offset:16384
M v[112:115], a[176:179], a[64:67], v[112:115]
s_add_u32 m0, s29, 49152
s_add_u32 s3, s23, s31
buffer_load_dwordx4 v2, s[8:11], s3 offen offset:0 lds
M v[112:115], a[180:183], a[68:71], v[112:115]
M v[116:119], a[180:183], a[76:79], v[116:119]
buffer_load_dwordx4 v3, s[8:11], s3 offen offset:1024 lds
M v[116:119], a[176:179], a[72:75], v[116:119]
ds_read_b64_tr_b16 a[100:101], v12 offset:49152
ds_read_b64_tr_b16 a[102:103], v12 offset:51200
M v[120:123], a[176:179], a[80:83], v[120:123]
buffer_load_dwordx4 v4, s[8:11], s3 offen offset:2048 lds
M v[120:123], a[180:183], a[84:87], v[120:123]
M v[124:127], a[180:183], a[92:95], v[124:127]
buffer_load_dwordx4 v5, s[8:11], s3 offen offset:3072 lds
M v[124:127], a[176:179], a[88:91], v[124:127]
M v[128:131], a[184:187], a[32:35], v[128:131]
M v[128:131], a[188:191], a[36:39], v[128:131]
ds_read_b128 a[168:171], v10 offset:18432
ds_read_b128 a[172:175], v11 offset:18432
ds_read_b64_tr_b16 a[108:109], v13 offset:49152
ds_read_b64_tr_b16 a[110:111], v13 offset:51200
M v[132:135], a[188:191], a[44:47], v[132:135]
M v[132:135], a[184:187], a[40:43], v[132:135]
M v[136:139], a[184:187], a[48:51], v[136:139]
s_and_b32 s3, s2, 1
s_lshl_b32 s3, s3, 3
s_bfe_u32 s4, s2, 0x30003
M v[136:139], a[188:191], a[52:55], v[136:139]
s_add_u32 s26, s3, s4
s_bfe_u32 s3, s2, 0x20001
s_lshl_b32 s3, s3, 2
M v[140:143], a[188:191], a[60:63], v[140:143]
s_lshr_b32 s4, s2, 6
s_xor_b32 s4, s4, 2
s_add_u32 s27, s3, s4
M v[140:143], a[184:187], a[56:59], v[140:143]
ds_read_b64_tr_b16 a[116:117], v14 offset:49152
ds_read_b64_tr_b16 a[118:119], v14 offset:51200
s_lshl_b32 s23, s26, 18
s_sub_u32 s24, s23, 32768
s_max_i32 s24, s24, 0
M v[144:147], a[184:187], a[64:67], v[144:147]
s_lshl_b32 s25, s27, 7
s_mov_b64 s[8:9], s[44:45]
s_mov_b32 s10, 4194304
M v[144:147], a[188:191], a[68:71], v[144:147]
s_mov_b64 s[12:13], s[46:47]
s_mov_b32 s14, 6291456
s_mov_b64 s[36:37], s[90:91]
M v[148:151], a[188:191], a[76:79], v[148:151]
s_mov_b32 s38, 256
s_mov_b32 s39, 0x00020000
s_lshl_b32 s28, s20, 9
M v[148:151], a[184:187], a[72:75], v[148:151]
s_mul_i32 s30, s20, 6144
s_lshl_b32 s3, s20, 5
v_lshrrev_b32 v24, 3, v0
M v[152:155], a[184:187], a[80:83], v[152:155]
v_and_b32 v25, 7, v0
v_add_u32 v28, s3, v24
v_add_u32 v26, 0, v28
M v[152:155], a[188:191], a[84:87], v[152:155]
ds_read_b64_tr_b16 a[124:125], v15 offset:49152
ds_read_b64_tr_b16 a[126:127], v15 offset:51200
v_bfe_u32 v27, v26, 1, 3
v_xor_b32 v27, v27, v25
v_lshlrev_b32 v26, 11, v26
M v[156:159], a[188:191], a[92:95], v[156:159]
v_lshl_add_u32 v26, v27, 4, v26
v_subrev_u32 v2, 0, v26
v_add_u32 v26, 8, v28
M v[156:159], a[184:187], a[88:91], v[156:159]
s_waitcnt lgkmcnt(10)
v_bfe_u32 v27, v26, 1, 3
v_xor_b32 v27, v27, v25
v_lshlrev_b32 v26, 11, v26
M v[160:163], a[160:163], a[32:35], v[160:163]
v_lshl_add_u32 v26, v27, 4, v26
v_subrev_u32 v3, 1024, v26
v_add_u32 v26, 16, v28
M v[160:163], a[164:167], a[36:39], v[160:163]
ds_read_b128 a[176:179], v10 offset:20480
ds_read_b128 a[180:183], v11 offset:20480
v_bfe_u32 v27, v26, 1, 3
v_xor_b32 v27, v27, v25
v_lshlrev_b32 v26, 11, v26
M v[164:167], a[164:167], a[44:47], v[164:167]
v_lshl_add_u32 v26, v27, 4, v26
v_subrev_u32 v4, 2048, v26
v_add_u32 v26, 24, v28
M v[164:167], a[160:163], a[40:43], v[164:167]
ds_read_b64_tr_b16 a[132:133], v16 offset:49152
ds_read_b64_tr_b16 a[134:135], v16 offset:51200
v_bfe_u32 v27, v26, 1, 3
v_xor_b32 v27, v27, v25
v_lshlrev_b32 v26, 11, v26
M v[168:171], a[160:163], a[48:51], v[168:171]
v_lshl_add_u32 v26, v27, 4, v26
v_subrev_u32 v5, 3072, v26
s_lshl_b32 s3, s20, 2
M v[168:171], a[164:167], a[52:55], v[168:171]
v_lshrrev_b32 v26, 5, v0
v_add_u32 v26, s3, v26
v_bfe_u32 v29, v0, 2, 3
M v[172:175], a[164:167], a[60:63], v[172:175]
v_bfe_u32 v27, v26, 1, 3
v_xor_b32 v27, v27, v29
v_lshlrev_b32 v27, 4, v27
M v[172:175], a[160:163], a[56:59], v[172:175]
v_and_b32 v30, 3, v0
v_lshl_add_u32 v27, v30, 2, v27
v_lshl_add_u32 v20, v26, 11, v27
M v[176:179], a[160:163], a[64:67], v[176:179]
v_add_u32 v26, 2, v26
v_bfe_u32 v27, v26, 1, 3
v_xor_b32 v27, v27, v29
M v[176:179], a[164:167], a[68:71], v[176:179]
ds_read_b64_tr_b16 a[140:141], v17 offset:49152
ds_read_b64_tr_b16 a[142:143], v17 offset:51200
v_lshlrev_b32 v27, 4, v27
v_and_b32 v30, 3, v0
v_lshl_add_u32 v27, v30, 2, v27
M v[180:183], a[164:167], a[76:79], v[180:183]
v_lshl_add_u32 v23, v26, 11, v27
v_subrev_u32 v23, 256, v23
s_mul_i32 s3, s20, 48
M v[180:183], a[160:163], a[72:75], v[180:183]
v_add_u32 v28, s3, v24
v_add_u32 v26, 0, v28
v_mul_u32_u24 v27, 0xaaab, v26
M v[184:187], a[160:163], a[80:83], v[184:187]
v_lshrrev_b32 v27, 17, v27
v_lshrrev_b32 v29, 1, v27
v_and_b32 v29, 4, v29
M v[184:187], a[164:167], a[84:87], v[184:187]
v_and_or_b32 v27, v27, 2, v29
v_xor_b32 v27, v27, v25
v_lshlrev_b32 v26, 11, v26
M v[188:191], a[164:167], a[92:95], v[188:191]
v_lshl_add_u32 v26, v27, 4, v26
v_subrev_u32 v6, 0, v26
v_add_u32 v26, 8, v28
M v[188:191], a[160:163], a[88:91], v[188:191]
s_waitcnt lgkmcnt(12)
ds_read_b64_tr_b16 a[148:149], v18 offset:49152
ds_read_b64_tr_b16 a[150:151], v18 offset:51200
v_mul_u32_u24 v27, 0xaaab, v26
v_lshrrev_b32 v27, 17, v27
v_lshrrev_b32 v29, 1, v27
M v[192:195], a[168:171], a[32:35], v[192:195]
v_and_b32 v29, 4, v29
v_and_or_b32 v27, v27, 2, v29
v_xor_b32 v27, v27, v25
M v[192:195], a[172:175], a[36:39], v[192:195]
ds_read_b128 a[184:187], v10 offset:22528
ds_read_b128 a[188:191], v11 offset:22528
v_lshlrev_b32 v26, 11, v26
v_lshl_add_u32 v26, v27, 4, v26
v_subrev_u32 v7, 1024, v26
M v[196:199], a[172:175], a[44:47], v[196:199]
v_add_u32 v26, 16, v28
v_mul_u32_u24 v27, 0xaaab, v26
v_lshrrev_b32 v27, 17, v27
M v[196:199], a[168:171], a[40:43], v[196:199]
v_lshrrev_b32 v29, 1, v27
v_and_b32 v29, 4, v29
v_and_or_b32 v27, v27, 2, v29
M v[200:203], a[168:171], a[48:51], v[200:203]
v_xor_b32 v27, v27, v25
v_lshlrev_b32 v26, 11, v26
v_lshl_add_u32 v26, v27, 4, v26
M v[200:203], a[172:175], a[52:55], v[200:203]
ds_read_b64_tr_b16 a[156:157], v19 offset:49152
ds_read_b64_tr_b16 a[158:159], v19 offset:51200
v_subrev_u32 v8, 2048, v26
v_add_u32 v26, 24, v28
v_mul_u32_u24 v27, 0xaaab, v26
M v[204:207], a[172:175], a[60:63], v[204:207]
v_lshrrev_b32 v27, 17, v27
v_lshrrev_b32 v29, 1, v27
v_and_b32 v29, 4, v29
M v[204:207], a[168:171], a[56:59], v[204:207]
v_and_or_b32 v27, v27, 2, v29
v_xor_b32 v27, v27, v25
v_lshlrev_b32 v26, 11, v26
M v[208:211], a[168:171], a[64:67], v[208:211]
v_lshl_add_u32 v26, v27, 4, v26
v_subrev_u32 v9, 3072, v26
v_add_u32 v26, 32, v28
M v[208:211], a[172:175], a[68:71], v[208:211]
v_mul_u32_u24 v27, 0xaaab, v26
v_lshrrev_b32 v27, 17, v27
v_lshrrev_b32 v29, 1, v27
M v[212:215], a[172:175], a[76:79], v[212:215]
v_and_b32 v29, 4, v29
v_and_or_b32 v27, v27, 2, v29
v_xor_b32 v27, v27, v25
M v[212:215], a[168:171], a[72:75], v[212:215]
v_lshlrev_b32 v26, 11, v26
v_lshl_add_u32 v26, v27, 4, v26
v_subrev_u32 v21, 0, v26
M v[216:219], a[168:171], a[80:83], v[216:219]
v_add_u32 v26, 40, v28
v_mul_u32_u24 v27, 0xaaab, v26
v_lshrrev_b32 v27, 17, v27
M v[216:219], a[172:175], a[84:87], v[216:219]
v_lshrrev_b32 v29, 1, v27
v_and_b32 v29, 4, v29
v_and_or_b32 v27, v27, 2, v29
M v[220:223], a[172:175], a[92:95], v[220:223]
v_xor_b32 v27, v27, v25
v_lshlrev_b32 v26, 11, v26
v_lshl_add_u32 v26, v27, 4, v26
M v[220:223], a[168:171], a[88:91], v[220:223]
s_waitcnt lgkmcnt(10)
v_subrev_u32 v22, 1024, v26
s_lshr_b32 s3, s53, 7
s_add_u32 s3, s3, s22
M v[224:227], a[176:179], a[32:35], v[224:227]
s_lshl_b32 s3, s3, 5
s_lshr_b32 s19, s52, 6
s_add_u32 s3, s3, s19
M v[224:227], a[180:183], a[36:39], v[224:227]
s_lshl_b32 s19, s21, 1
s_add_u32 s3, s3, s19
s_lshl_b32 s92, s3, 15
M v[228:231], a[180:183], a[44:47], v[228:231]
s_add_u32 s92, s92, 16384
s_add_u32 s93, s92, 32768
s_add_u32 s16, s50, 16777216
M v[228:231], a[176:179], a[40:43], v[228:231]
s_addc_u32 s17, s51, 0
s_mov_b32 s18, 33554432
s_mov_b32 s19, 0x00020000
M v[232:235], a[176:179], a[48:51], v[232:235]
M v[232:235], a[180:183], a[52:55], v[232:235]
M v[236:239], a[180:183], a[60:63], v[236:239]
M v[236:239], a[176:179], a[56:59], v[236:239]
s_waitcnt vmcnt(4) lgkmcnt(0)
s_barrier
ds_read_b128 a[160:163], v10 offset:32768
ds_read_b128 a[164:167], v11 offset:32768
M v[240:243], a[176:179], a[64:67], v[240:243]
s_add_u32 m0, s28, 131072
s_nop 0
buffer_load_dword v20, s[8:11], s24 offen lds
M v[240:243], a[180:183], a[68:71], v[240:243]
M v[244:247], a[180:183], a[76:79], v[244:247]
M v[244:247], a[176:179], a[72:75], v[244:247]
M v[248:251], a[176:179], a[80:83], v[248:251]
buffer_load_dword v23, s[8:11], s24 offen offset:256 lds
s_add_u32 s24, s24, 128
M v[248:251], a[180:183], a[84:87], v[248:251]
M v[252:255], a[180:183], a[92:95], v[252:255]
M v[252:255], a[176:179], a[88:91], v[252:255]
M a[0:3], a[184:187], a[32:35], a[0:3]
M a[0:3], a[188:191], a[36:39], a[0:3]
ds_read_b128 a[168:171], v10 offset:34816
ds_read_b128 a[172:175], v11 offset:34816
M a[4:7], a[188:191], a[44:47], a[4:7]
s_add_u32 m0, s29, 133120
s_nop 0
buffer_load_dwordx4 v2, s[8:11], s23 offen offset:0 lds
M a[4:7], a[184:187], a[40:43], a[4:7]
M a[8:11], a[184:187], a[48:51], a[8:11]
M a[8:11], a[188:191], a[52:55], a[8:11]
M a[12:15], a[188:191], a[60:63], a[12:15]
buffer_load_dwordx4 v3, s[8:11], s23 offen offset:1024 lds
M a[12:15], a[184:187], a[56:59], a[12:15]
M a[16:19], a[184:187], a[64:67], a[16:19]
M a[16:19], a[188:191], a[68:71], a[16:19]
M a[20:23], a[188:191], a[76:79], a[20:23]
buffer_load_dwordx4 v4, s[8:11], s23 offen offset:2048 lds
M a[20:23], a[184:187], a[72:75], a[20:23]
M a[24:27], a[184:187], a[80:83], a[24:27]
M a[24:27], a[188:191], a[84:87], a[24:27]
M a[28:31], a[188:191], a[92:95], a[28:31]
M a[28:31], a[184:187], a[88:91], a[28:31]
s_waitcnt lgkmcnt(2)
M v[32:35], a[160:163], a[96:99], v[32:35]
buffer_load_dwordx4 v5, s[8:11], s23 offen offset:3072 lds
s_add_u32 s23, s23, 128
M v[32:35], a[164:167], a[100:103], v[32:35]
ds_read_b128 a[176:179], v10 offset:36864
ds_read_b128 a[180:183], v11 offset:36864
M v[36:39], a[164:167], a[108:111], v[36:39]
M v[36:39], a[160:163], a[104:107], v[36:39]
M v[40:43], a[160:163], a[112:115], v[40:43]
M v[40:43], a[164:167], a[116:119], v[40:43]
s_add_u32 m0, s30, 65536
s_nop 0
buffer_load_dwordx4 v6, s[12:15], s25 offen offset:0 lds
M v[44:47], a[164:167], a[124:127], v[44:47]
M v[44:47], a[160:163], a[120:123], v[44:47]
M v[48:51], a[160:163], a[128:131], v[48:51]
M v[48:51], a[164:167], a[132:135], v[48:51]
M v[52:55], a[164:167], a[140:143], v[52:55]
buffer_load_dwordx4 v7, s[12:15], s25 offen offset:1024 lds
M v[52:55], a[160:163], a[136:139], v[52:55]
M v[56:59], a[160:163], a[144:147], v[56:59]
M v[56:59], a[164:167], a[148:151], v[56:59]
M v[60:63], a[164:167], a[156:159], v[60:63]
M v[60:63], a[160:163], a[152:155], v[60:63]
s_waitcnt lgkmcnt(2)
M v[64:67], a[168:171], a[96:99], v[64:67]
buffer_load_dwordx4 v8, s[12:15], s25 offen offset:2048 lds
M v[64:67], a[172:175], a[100:103], v[64:67]
ds_read_b128 a[184:187], v10 offset:38912
ds_read_b128 a[188:191], v11 offset:38912
M v[68:71], a[172:175], a[108:111], v[68:71]
M v[68:71], a[168:171], a[104:107], v[68:71]
M v[72:75], a[168:171], a[112:115], v[72:75]
M v[72:75], a[172:175], a[116:119], v[72:75]
buffer_load_dwordx4 v9, s[12:15], s25 offen offset:3072 lds
M v[76:79], a[172:175], a[124:127], v[76:79]
M v[76:79], a[168:171], a[120:123], v[76:79]
M v[80:83], a[168:171], a[128:131], v[80:83]
M v[80:83], a[172:175], a[132:135], v[80:83]
M v[84:87], a[172:175], a[140:143], v[84:87]
s_add_u32 m0, s30, 69632
s_nop 0
buffer_load_dwordx4 v21, s[12:15], s25 offen offset:0 lds
M v[84:87], a[168:171], a[136:139], v[84:87]
M v[88:91], a[168:171], a[144:147], v[88:91]
M v[88:91], a[172:175], a[148:151], v[88:91]
M v[92:95], a[172:175], a[156:159], v[92:95]
M v[92:95], a[168:171], a[152:155], v[92:95]
s_waitcnt lgkmcnt(2)
M v[96:99], a[176:179], a[96:99], v[96:99]
buffer_load_dwordx4 v22, s[12:15], s25 offen offset:1024 lds
s_add_u32 s25, s25, 393216
M v[96:99], a[180:183], a[100:103], v[96:99]
M v[100:103], a[180:183], a[108:111], v[100:103]
M v[100:103], a[176:179], a[104:107], v[100:103]
v_cvt_pk_bf16_f32 v32, v32, v33
v_cvt_pk_bf16_f32 v33, v34, v35
M v[104:107], a[176:179], a[112:115], v[104:107]
v_cvt_pk_bf16_f32 v34, v64, v65
v_cvt_pk_bf16_f32 v35, v66, v67
M v[104:107], a[180:183], a[116:119], v[104:107]
v_cvt_pk_bf16_f32 v64, v48, v49
M v[108:111], a[180:183], a[124:127], v[108:111]
v_cvt_pk_bf16_f32 v65, v50, v51
v_cvt_pk_bf16_f32 v66, v80, v81
M v[108:111], a[176:179], a[120:123], v[108:111]
s_waitcnt vmcnt(12) lgkmcnt(0)
s_barrier
ds_read_b128 a[160:163], v10 offset:49152
ds_read_b128 a[164:167], v11 offset:49152
v_cvt_pk_bf16_f32 v67, v82, v83
M v[112:115], a[176:179], a[128:131], v[112:115]
s_add_u32 m0, s28, 0
s_nop 0
buffer_load_dword v20, s[8:11], s24 offen lds
v_cvt_pk_bf16_f32 v48, v40, v41
v_cvt_pk_bf16_f32 v49, v42, v43
M v[112:115], a[180:183], a[132:135], v[112:115]
v_cvt_pk_bf16_f32 v50, v72, v73
v_cvt_pk_bf16_f32 v51, v74, v75
M v[116:119], a[180:183], a[140:143], v[116:119]
v_cvt_pk_bf16_f32 v80, v56, v57
M v[116:119], a[176:179], a[136:139], v[116:119]
buffer_load_dword v23, s[8:11], s24 offen offset:256 lds
s_add_u32 s24, s24, 128
v_cvt_pk_bf16_f32 v81, v58, v59
v_cvt_pk_bf16_f32 v82, v88, v89
M v[120:123], a[176:179], a[144:147], v[120:123]
v_cvt_pk_bf16_f32 v83, v90, v91
M v[120:123], a[180:183], a[148:151], v[120:123]
v_cvt_pk_bf16_f32 v40, v36, v37
v_cvt_pk_bf16_f32 v41, v38, v39
M v[124:127], a[180:183], a[156:159], v[124:127]
v_cvt_pk_bf16_f32 v42, v68, v69
v_cvt_pk_bf16_f32 v43, v70, v71
M v[124:127], a[176:179], a[152:155], v[124:127]
v_cvt_pk_bf16_f32 v72, v52, v53
M v[128:131], a[184:187], a[96:99], v[128:131]
s_add_u32 m0, s29, 2048
s_nop 0
buffer_load_dwordx4 v2, s[8:11], s23 offen offset:0 lds
v_cvt_pk_bf16_f32 v73, v54, v55
v_cvt_pk_bf16_f32 v74, v84, v85
M v[128:131], a[188:191], a[100:103], v[128:131]
ds_read_b128 a[168:171], v10 offset:51200
ds_read_b128 a[172:175], v11 offset:51200
v_cvt_pk_bf16_f32 v75, v86, v87
M v[132:135], a[188:191], a[108:111], v[132:135]
v_cvt_pk_bf16_f32 v56, v44, v45
v_cvt_pk_bf16_f32 v57, v46, v47
M v[132:135], a[184:187], a[104:107], v[132:135]
v_cvt_pk_bf16_f32 v58, v76, v77
v_cvt_pk_bf16_f32 v59, v78, v79
M v[136:139], a[184:187], a[112:115], v[136:139]
v_cvt_pk_bf16_f32 v88, v60, v61
M v[136:139], a[188:191], a[116:119], v[136:139]
buffer_load_dwordx4 v3, s[8:11], s23 offen offset:1024 lds
v_cvt_pk_bf16_f32 v89, v62, v63
v_cvt_pk_bf16_f32 v90, v92, v93
M v[140:143], a[188:191], a[124:127], v[140:143]
v_cvt_pk_bf16_f32 v91, v94, v95
M v[140:143], a[184:187], a[120:123], v[140:143]
M v[144:147], a[184:187], a[128:131], v[144:147]
buffer_load_dwordx4 v4, s[8:11], s23 offen offset:2048 lds
M v[144:147], a[188:191], a[132:135], v[144:147]
M v[148:151], a[188:191], a[140:143], v[148:151]
s_add_u32 s94, s92, 0
buffer_store_dwordx4 v[32:35], v1, s[16:19], s94 offen offset:0 sc1
M v[148:151], a[184:187], a[136:139], v[148:151]
M v[152:155], a[184:187], a[144:147], v[152:155]
M v[152:155], a[188:191], a[148:151], v[152:155]
buffer_load_dwordx4 v5, s[8:11], s23 offen offset:3072 lds
s_add_u32 s23, s23, 128
M v[156:159], a[188:191], a[156:159], v[156:159]
s_add_u32 s94, s92, 0
buffer_store_dwordx4 v[40:43], v1, s[16:19], s94 offen offset:1024 sc1
M v[156:159], a[184:187], a[152:155], v[156:159]
s_waitcnt lgkmcnt(2)
M v[160:163], a[160:163], a[96:99], v[160:163]
M v[160:163], a[164:167], a[100:103], v[160:163]
ds_read_b128 a[176:179], v10 offset:53248
ds_read_b128 a[180:183], v11 offset:53248
M v[164:167], a[164:167], a[108:111], v[164:167]
s_add_u32 s94, s92, 0
buffer_store_dwordx4 v[48:51], v1, s[16:19], s94 offen offset:2048 sc1
M v[164:167], a[160:163], a[104:107], v[164:167]
v_cvt_pk_bf16_f32 v96, v96, v97
v_cvt_pk_bf16_f32 v97, v98, v99
M v[168:171], a[160:163], a[112:115], v[168:171]
v_cvt_pk_bf16_f32 v98, v128, v129
v_cvt_pk_bf16_f32 v99, v130, v131
M v[168:171], a[164:167], a[116:119], v[168:171]
s_add_u32 m0, s30, 98304
s_nop 0
buffer_load_dwordx4 v6, s[12:15], s25 offen offset:0 lds
v_cvt_pk_bf16_f32 v128, v112, v113
M v[172:175], a[164:167], a[124:127], v[172:175]
s_add_u32 s94, s92, 0
buffer_store_dwordx4 v[56:59], v1, s[16:19], s94 offen offset:3072 sc1
v_cvt_pk_bf16_f32 v129, v114, v115
v_cvt_pk_bf16_f32 v130, v144, v145
M v[172:175], a[160:163], a[120:123], v[172:175]
v_cvt_pk_bf16_f32 v131, v146, v147
M v[176:179], a[160:163], a[128:131], v[176:179]
v_cvt_pk_bf16_f32 v112, v104, v105
v_cvt_pk_bf16_f32 v113, v106, v107
M v[176:179], a[164:167], a[132:135], v[176:179]
buffer_load_dwordx4 v7, s[12:15], s25 offen offset:1024 lds
v_cvt_pk_bf16_f32 v114, v136, v137
v_cvt_pk_bf16_f32 v115, v138, v139
M v[180:183], a[164:167], a[140:143], v[180:183]
s_add_u32 s94, s92, 4096
buffer_store_dwordx4 v[64:67], v1, s[16:19], s94 offen offset:0 sc1
v_cvt_pk_bf16_f32 v144, v120, v121
M v[180:183], a[160:163], a[136:139], v[180:183]
v_cvt_pk_bf16_f32 v145, v122, v123
v_cvt_pk_bf16_f32 v146, v152, v153
M v[184:187], a[160:163], a[144:147], v[184:187]
v_cvt_pk_bf16_f32 v147, v154, v155
M v[184:187], a[164:167], a[148:151], v[184:187]
v_cvt_pk_bf16_f32 v104, v100, v101
v_cvt_pk_bf16_f32 v105, v102, v103
M v[188:191], a[164:167], a[156:159], v[188:191]
s_add_u32 s94, s92, 4096
buffer_store_dwordx4 v[72:75], v1, s[16:19], s94 offen offset:1024 sc1
v_cvt_pk_bf16_f32 v106, v132, v133
v_cvt_pk_bf16_f32 v107, v134, v135
M v[188:191], a[160:163], a[152:155], v[188:191]
s_waitcnt lgkmcnt(2)
v_cvt_pk_bf16_f32 v136, v116, v117
M v[192:195], a[168:171], a[96:99], v[192:195]
buffer_load_dwordx4 v8, s[12:15], s25 offen offset:2048 lds
v_cvt_pk_bf16_f32 v137, v118, v119
v_cvt_pk_bf16_f32 v138, v148, v149
M v[192:195], a[172:175], a[100:103], v[192:195]
ds_read_b128 a[184:187], v10 offset:55296
ds_read_b128 a[188:191], v11 offset:55296
v_cvt_pk_bf16_f32 v139, v150, v151
M v[196:199], a[172:175], a[108:111], v[196:199]
s_add_u32 s94, s92, 4096
buffer_store_dwordx4 v[80:83], v1, s[16:19], s94 offen offset:2048 sc1
v_cvt_pk_bf16_f32 v120, v108, v109
v_cvt_pk_bf16_f32 v121, v110, v111
M v[196:199], a[168:171], a[104:107], v[196:199]
v_cvt_pk_bf16_f32 v122, v140, v141
v_cvt_pk_bf16_f32 v123, v142, v143
M v[200:203], a[168:171], a[112:115], v[200:203]
v_cvt_pk_bf16_f32 v152, v124, v125
M v[200:203], a[172:175], a[116:119], v[200:203]
v_cvt_pk_bf16_f32 v153, v126, v127
v_cvt_pk_bf16_f32 v154, v156, v157
M v[204:207], a[172:175], a[124:127], v[204:207]
s_add_u32 s94, s92, 4096
buffer_store_dwordx4 v[88:91], v1, s[16:19], s94 offen offset:3072 sc1
v_cvt_pk_bf16_f32 v155, v158, v159
M v[204:207], a[168:171], a[120:123], v[204:207]
buffer_load_dwordx4 v9, s[12:15], s25 offen offset:3072 lds
M v[208:211], a[168:171], a[128:131], v[208:211]
M v[208:211], a[172:175], a[132:135], v[208:211]
M v[212:215], a[172:175], a[140:143], v[212:215]
s_add_u32 m0, s30, 102400
s_nop 0
buffer_load_dwordx4 v21, s[12:15], s25 offen offset:0 lds
M v[212:215], a[168:171], a[136:139], v[212:215]
M v[216:219], a[168:171], a[144:147], v[216:219]
s_add_u32 s94, s92, 8192
buffer_store_dwordx4 v[96:99], v1, s[16:19], s94 offen offset:0 sc1
M v[216:219], a[172:175], a[148:151], v[216:219]
M v[220:223], a[172:175], a[156:159], v[220:223]
M v[220:223], a[168:171], a[152:155], v[220:223]
s_waitcnt lgkmcnt(2)
M v[224:227], a[176:179], a[96:99], v[224:227]
buffer_load_dwordx4 v22, s[12:15], s25 offen offset:1024 lds
s_add_u32 s25, s25, 393216
M v[224:227], a[180:183], a[100:103], v[224:227]
M v[228:231], a[180:183], a[108:111], v[228:231]
s_add_u32 s94, s92, 8192
buffer_store_dwordx4 v[104:107], v1, s[16:19], s94 offen offset:1024 sc1
M v[228:231], a[176:179], a[104:107], v[228:231]
v_cvt_pk_bf16_f32 v160, v160, v161
v_cvt_pk_bf16_f32 v161, v162, v163
M v[232:235], a[176:179], a[112:115], v[232:235]
v_cvt_pk_bf16_f32 v162, v192, v193
v_cvt_pk_bf16_f32 v163, v194, v195
M v[232:235], a[180:183], a[116:119], v[232:235]
v_cvt_pk_bf16_f32 v192, v176, v177
M v[236:239], a[180:183], a[124:127], v[236:239]
v_cvt_pk_bf16_f32 v193, v178, v179
v_cvt_pk_bf16_f32 v194, v208, v209
M v[236:239], a[176:179], a[120:123], v[236:239]
s_waitcnt vmcnt(63) lgkmcnt(0)
s_barrier
v_cvt_pk_bf16_f32 v195, v210, v211
M v[240:243], a[176:179], a[128:131], v[240:243]
s_add_u32 s94, s92, 8192
buffer_store_dwordx4 v[112:115], v1, s[16:19], s94 offen offset:2048 sc1
v_cvt_pk_bf16_f32 v176, v168, v169
v_cvt_pk_bf16_f32 v177, v170, v171
M v[240:243], a[180:183], a[132:135], v[240:243]
s_add_u32 m0, s28, 18432
s_nop 0
buffer_load_dword v20, s[8:11], s24 offen lds
v_cvt_pk_bf16_f32 v178, v200, v201
v_cvt_pk_bf16_f32 v179, v202, v203
M v[244:247], a[180:183], a[140:143], v[244:247]
v_cvt_pk_bf16_f32 v208, v184, v185
M v[244:247], a[176:179], a[136:139], v[244:247]
v_cvt_pk_bf16_f32 v209, v186, v187
v_cvt_pk_bf16_f32 v210, v216, v217
M v[248:251], a[176:179], a[144:147], v[248:251]
buffer_load_dword v23, s[8:11], s24 offen offset:256 lds
s_add_u32 s24, s24, 128
v_cvt_pk_bf16_f32 v211, v218, v219
M v[248:251], a[180:183], a[148:151], v[248:251]
v_cvt_pk_bf16_f32 v168, v164, v165
v_cvt_pk_bf16_f32 v169, v166, v167
M v[252:255], a[180:183], a[156:159], v[252:255]
s_add_u32 s94, s92, 8192
buffer_store_dwordx4 v[120:123], v1, s[16:19], s94 offen offset:3072 sc1
v_cvt_pk_bf16_f32 v170, v196, v197
v_cvt_pk_bf16_f32 v171, v198, v199
M v[252:255], a[176:179], a[152:155], v[252:255]
v_cvt_pk_bf16_f32 v200, v180, v181
M a[0:3], a[184:187], a[96:99], a[0:3]
v_cvt_pk_bf16_f32 v201, v182, v183
v_cvt_pk_bf16_f32 v202, v212, v213
M a[0:3], a[188:191], a[100:103], a[0:3]
v_cvt_pk_bf16_f32 v203, v214, v215
M a[4:7], a[188:191], a[108:111], a[4:7]
s_add_u32 m0, s29, 20480
s_nop 0
buffer_load_dwordx4 v2, s[8:11], s23 offen offset:0 lds
v_cvt_pk_bf16_f32 v184, v172, v173
v_cvt_pk_bf16_f32 v185, v174, v175
M a[4:7], a[184:187], a[104:107], a[4:7]
v_cvt_pk_bf16_f32 v186, v204, v205
v_cvt_pk_bf16_f32 v187, v206, v207
M a[8:11], a[184:187], a[112:115], a[8:11]
s_add_u32 s94, s92, 12288
buffer_store_dwordx4 v[128:131], v1, s[16:19], s94 offen offset:0 sc1
v_cvt_pk_bf16_f32 v216, v188, v189
M a[8:11], a[188:191], a[116:119], a[8:11]
v_cvt_pk_bf16_f32 v217, v190, v191
v_cvt_pk_bf16_f32 v218, v220, v221
M a[12:15], a[188:191], a[124:127], a[12:15]
buffer_load_dwordx4 v3, s[8:11], s23 offen offset:1024 lds
v_cvt_pk_bf16_f32 v219, v222, v223
M a[12:15], a[184:187], a[120:123], a[12:15]
M a[16:19], a[184:187], a[128:131], a[16:19]
M a[16:19], a[188:191], a[132:135], a[16:19]
M a[20:23], a[188:191], a[140:143], a[20:23]
s_add_u32 s94, s92, 12288
buffer_store_dwordx4 v[136:139], v1, s[16:19], s94 offen offset:1024 sc1
M a[20:23], a[184:187], a[136:139], a[20:23]
buffer_load_dwordx4 v4, s[8:11], s23 offen offset:2048 lds
M a[24:27], a[184:187], a[144:147], a[24:27]
M a[24:27], a[188:191], a[148:151], a[24:27]
M a[28:31], a[188:191], a[156:159], a[28:31]
M a[28:31], a[184:187], a[152:155], a[28:31]
v_accvgpr_read_b32 v24, a0
v_accvgpr_read_b32 v25, a1
v_accvgpr_read_b32 v26, a2
v_accvgpr_read_b32 v27, a3
v_cvt_pk_bf16_f32 v224, v224, v225
v_cvt_pk_bf16_f32 v225, v226, v227
v_cvt_pk_bf16_f32 v226, v24, v25
v_cvt_pk_bf16_f32 v227, v26, v27
v_accvgpr_read_b32 v24, a16
v_accvgpr_read_b32 v25, a17
v_accvgpr_read_b32 v26, a18
v_accvgpr_read_b32 v27, a19
v_cvt_pk_bf16_f32 v36, v240, v241
v_cvt_pk_bf16_f32 v37, v242, v243
v_cvt_pk_bf16_f32 v38, v24, v25
v_cvt_pk_bf16_f32 v39, v26, v27
v_accvgpr_read_b32 v24, a24
v_accvgpr_read_b32 v25, a25
v_accvgpr_read_b32 v26, a26
v_accvgpr_read_b32 v27, a27
v_cvt_pk_bf16_f32 v52, v248, v249
v_cvt_pk_bf16_f32 v53, v250, v251
v_cvt_pk_bf16_f32 v54, v24, v25
v_cvt_pk_bf16_f32 v55, v26, v27
v_accvgpr_read_b32 v24, a8
v_accvgpr_read_b32 v25, a9
v_accvgpr_read_b32 v26, a10
v_accvgpr_read_b32 v27, a11
v_cvt_pk_bf16_f32 v240, v232, v233
v_cvt_pk_bf16_f32 v241, v234, v235
v_cvt_pk_bf16_f32 v242, v24, v25
v_cvt_pk_bf16_f32 v243, v26, v27
v_accvgpr_read_b32 v28, a4
v_accvgpr_read_b32 v29, a5
v_accvgpr_read_b32 v30, a6
v_accvgpr_read_b32 v31, a7
v_cvt_pk_bf16_f32 v232, v228, v229
v_cvt_pk_bf16_f32 v233, v230, v231
v_cvt_pk_bf16_f32 v234, v28, v29
v_cvt_pk_bf16_f32 v235, v30, v31
v_accvgpr_read_b32 v28, a12
v_accvgpr_read_b32 v29, a13
v_accvgpr_read_b32 v30, a14
v_accvgpr_read_b32 v31, a15
v_cvt_pk_bf16_f32 v248, v236, v237
v_cvt_pk_bf16_f32 v249, v238, v239
v_cvt_pk_bf16_f32 v250, v28, v29
v_cvt_pk_bf16_f32 v251, v30, v31
v_accvgpr_read_b32 v28, a20
v_accvgpr_read_b32 v29, a21
v_accvgpr_read_b32 v30, a22
v_accvgpr_read_b32 v31, a23
v_cvt_pk_bf16_f32 v44, v244, v245
v_cvt_pk_bf16_f32 v45, v246, v247
v_cvt_pk_bf16_f32 v46, v28, v29
v_cvt_pk_bf16_f32 v47, v30, v31
v_accvgpr_read_b32 v28, a28
v_accvgpr_read_b32 v29, a29
v_accvgpr_read_b32 v30, a30
v_accvgpr_read_b32 v31, a31
v_cvt_pk_bf16_f32 v60, v252, v253
v_cvt_pk_bf16_f32 v61, v254, v255
v_cvt_pk_bf16_f32 v62, v28, v29
v_cvt_pk_bf16_f32 v63, v30, v31
Lk1_b:
v_and_b32 v24, 15, v0
v_lshlrev_b32 v24, 7, v24
v_bfe_u32 v25, v0, 1, 3
v_lshrrev_b32 v26, 4, v0
v_xor_b32 v25, v25, v26
v_lshl_add_u32 v10, v25, 4, v24
v_xor_b32 v11, 64, v10
v_add_u32 v12, 131072, v10
v_add_u32 v13, 131072, v11
v_bfe_u32 v24, v0, 2, 2
v_lshl_add_u32 v29, v26, 3, v24
v_mul_u32_u24 v25, 384, v29
v_and_b32 v27, 1, v0
v_lshl_add_u32 v25, v27, 3, v25
v_add_u32 v25, 36864, v25
v_lshrrev_b32 v24, 1, v29
v_and_b32 v24, 4, v24
v_and_or_b32 v24, v29, 2, v24
v_bfe_u32 v26, v0, 1, 1
s_mul_i32 s4, s20, 3
s_add_u32 s3, s4, 0
s_and_b32 s5, s3, 3
s_lshl_b32 s5, s5, 1
s_lshr_b32 s3, s3, 2
s_lshl_b32 s3, s3, 7
v_add_u32 v27, s5, v26
v_xor_b32 v27, v27, v24
v_lshl_add_u32 v27, v27, 4, v25
v_add_u32 v14, s3, v27
v_add_u32 v17, 61440, v14
s_add_u32 s3, s4, 1
s_and_b32 s5, s3, 3
s_lshl_b32 s5, s5, 1
s_lshr_b32 s3, s3, 2
s_lshl_b32 s3, s3, 7
v_add_u32 v27, s5, v26
v_xor_b32 v27, v27, v24
v_lshl_add_u32 v27, v27, 4, v25
v_add_u32 v15, s3, v27
v_add_u32 v18, 61440, v15
s_add_u32 s3, s4, 2
s_and_b32 s5, s3, 3
s_lshl_b32 s5, s5, 1
s_lshr_b32 s3, s3, 2
s_lshl_b32 s3, s3, 7
v_add_u32 v27, s5, v26
v_xor_b32 v27, v27, v24
v_lshl_add_u32 v27, v27, 4, v25
v_add_u32 v16, s3, v27
v_add_u32 v19, 61440, v16
s_waitcnt vmcnt(9)
s_barrier
ds_read_b64_tr_b16 a[176:177], v14 offset:28672
ds_read_b64_tr_b16 a[178:179], v14 offset:30208
ds_read_b64_tr_b16 a[184:185], v15 offset:28672
ds_read_b64_tr_b16 a[186:187], v15 offset:30208
ds_read_b64_tr_b16 a[192:193], v16 offset:28672
ds_read_b64_tr_b16 a[194:195], v16 offset:30208
ds_read_b64_tr_b16 a[180:181], v14 offset:40960
ds_read_b64_tr_b16 a[182:183], v14 offset:42496
ds_read_b64_tr_b16 a[188:189], v15 offset:40960
ds_read_b64_tr_b16 a[190:191], v15 offset:42496
ds_read_b64_tr_b16 a[196:197], v16 offset:40960
ds_read_b64_tr_b16 a[198:199], v16 offset:42496
ds_read_b128 a[224:227], v12 offset:0
ds_read_b128 a[228:231], v13 offset:0
ds_read_b128 a[232:235], v12 offset:2048
ds_read_b128 a[236:239], v13 offset:2048
ds_read_b128 a[240:243], v12 offset:4096
ds_read_b128 a[244:247], v13 offset:4096
s_waitcnt lgkmcnt(0)
s_barrier
M a[68:71], a[176:179], a[224:227], 0
ds_read_b128 a[248:251], v12 offset:6144
ds_read_b128 a[252:255], v13 offset:6144
M a[68:71], a[180:183], a[228:231], a[68:71]
buffer_load_dwordx4 v5, s[8:11], s23 offen offset:3072 lds
s_add_u32 s23, s23, 128
M a[72:75], a[188:191], a[228:231], 0
ds_read_b64_tr_b16 a[200:201], v17 offset:0
ds_read_b64_tr_b16 a[202:203], v17 offset:1536
M a[72:75], a[184:187], a[224:227], a[72:75]
M a[76:79], a[192:195], a[224:227], 0
s_add_u32 m0, s30, 36864
s_nop 0
buffer_load_dwordx4 v6, s[12:15], s25 offen offset:0 lds
M a[76:79], a[196:199], a[228:231], a[76:79]
M a[80:83], a[180:183], a[236:239], 0
ds_read_b128 a[224:227], v12 offset:8192
ds_read_b128 a[228:231], v13 offset:8192
M a[80:83], a[176:179], a[232:235], a[80:83]
buffer_load_dwordx4 v7, s[12:15], s25 offen offset:1024 lds
M a[84:87], a[184:187], a[232:235], 0
ds_read_b64_tr_b16 a[208:209], v18 offset:0
ds_read_b64_tr_b16 a[210:211], v18 offset:1536
M a[84:87], a[188:191], a[236:239], a[84:87]
M a[88:91], a[196:199], a[236:239], 0
buffer_load_dwordx4 v8, s[12:15], s25 offen offset:2048 lds
M a[88:91], a[192:195], a[232:235], a[88:91]
M a[92:95], a[176:179], a[240:243], 0
ds_read_b128 a[232:235], v12 offset:10240
ds_read_b128 a[236:239], v13 offset:10240
M a[92:95], a[180:183], a[244:247], a[92:95]
buffer_load_dwordx4 v9, s[12:15], s25 offen offset:3072 lds
M a[96:99], a[188:191], a[244:247], 0
ds_read_b64_tr_b16 a[216:217], v19 offset:0
ds_read_b64_tr_b16 a[218:219], v19 offset:1536
M a[96:99], a[184:187], a[240:243], a[96:99]
M a[100:103], a[192:195], a[240:243], 0
s_add_u32 m0, s30, 40960
s_nop 0
buffer_load_dwordx4 v21, s[12:15], s25 offen offset:0 lds
M a[100:103], a[196:199], a[244:247], a[100:103]
s_waitcnt lgkmcnt(10)
M a[104:107], a[180:183], a[252:255], 0
ds_read_b128 a[240:243], v12 offset:12288
ds_read_b128 a[244:247], v13 offset:12288
M a[104:107], a[176:179], a[248:251], a[104:107]
buffer_load_dwordx4 v22, s[12:15], s25 offen offset:1024 lds
s_add_u32 s25, s25, 393216
M a[108:111], a[184:187], a[248:251], 0
ds_read_b64_tr_b16 a[204:205], v17 offset:12288
ds_read_b64_tr_b16 a[206:207], v17 offset:13824
M a[108:111], a[188:191], a[252:255], a[108:111]
M a[112:115], a[196:199], a[252:255], 0
s_add_u32 m0, s30, 65536
s_nop 0
buffer_load_dwordx4 v6, s[12:15], s25 offen offset:0 lds
M a[112:115], a[192:195], a[248:251], a[112:115]
s_waitcnt lgkmcnt(10)
M a[116:119], a[176:179], a[224:227], 0
ds_read_b128 a[248:251], v12 offset:14336
ds_read_b128 a[252:255], v13 offset:14336
M a[116:119], a[180:183], a[228:231], a[116:119]
buffer_load_dwordx4 v7, s[12:15], s25 offen offset:1024 lds
M a[120:123], a[188:191], a[228:231], 0
ds_read_b64_tr_b16 a[212:213], v18 offset:12288
ds_read_b64_tr_b16 a[214:215], v18 offset:13824
M a[120:123], a[184:187], a[224:227], a[120:123]
M a[124:127], a[192:195], a[224:227], 0
buffer_load_dwordx4 v8, s[12:15], s25 offen offset:2048 lds
M a[124:127], a[196:199], a[228:231], a[124:127]
s_waitcnt lgkmcnt(10)
M a[128:131], a[180:183], a[236:239], 0
ds_read_b128 a[224:227], v12 offset:16384
ds_read_b128 a[228:231], v13 offset:16384
M a[128:131], a[176:179], a[232:235], a[128:131]
buffer_load_dwordx4 v9, s[12:15], s25 offen offset:3072 lds
M a[132:135], a[184:187], a[232:235], 0
ds_read_b64_tr_b16 a[220:221], v19 offset:12288
ds_read_b64_tr_b16 a[222:223], v19 offset:13824
M a[132:135], a[188:191], a[236:239], a[132:135]
M a[136:139], a[196:199], a[236:239], 0
s_add_u32 m0, s30, 69632
s_nop 0
buffer_load_dwordx4 v21, s[12:15], s25 offen offset:0 lds
M a[136:139], a[192:195], a[232:235], a[136:139]
s_waitcnt lgkmcnt(10)
M a[140:143], a[176:179], a[240:243], 0
buffer_load_dwordx4 v22, s[12:15], s25 offen offset:1024 lds
s_add_u32 s25, s25, 393216
M a[140:143], a[180:183], a[244:247], a[140:143]
M a[144:147], a[188:191], a[244:247], 0
M a[144:147], a[184:187], a[240:243], a[144:147]
M a[148:151], a[192:195], a[240:243], 0
s_waitcnt vmcnt(6) lgkmcnt(0)
s_barrier
ds_read_b128 a[232:235], v10 offset:0
ds_read_b128 a[236:239], v11 offset:0
M a[148:151], a[196:199], a[244:247], a[148:151]
s_add_u32 m0, s28, 131072
s_nop 0
buffer_load_dword v20, s[8:11], s24 offen lds
M a[152:155], a[180:183], a[252:255], 0
ds_read_b128 a[240:243], v10 offset:2048
ds_read_b128 a[244:247], v11 offset:2048
M a[152:155], a[176:179], a[248:251], a[152:155]
M a[156:159], a[184:187], a[248:251], 0
buffer_load_dword v23, s[8:11], s24 offen offset:256 lds
s_add_u32 s24, s24, 128
M a[156:159], a[188:191], a[252:255], a[156:159]
M a[160:163], a[196:199], a[252:255], 0
M a[160:163], a[192:195], a[248:251], a[160:163]
s_add_u32 m0, s29, 133120
s_nop 0
buffer_load_dwordx4 v2, s[8:11], s23 offen offset:0 lds
M a[164:167], a[176:179], a[224:227], 0
ds_read_b128 a[248:251], v10 offset:4096
ds_read_b128 a[252:255], v11 offset:4096
M a[164:167], a[180:183], a[228:231], a[164:167]
M a[168:171], a[188:191], a[228:231], 0
M a[168:171], a[184:187], a[224:227], a[168:171]
buffer_load_dwordx4 v3, s[8:11], s23 offen offset:1024 lds
M a[172:175], a[192:195], a[224:227], 0
M a[172:175], a[196:199], a[228:231], a[172:175]
s_waitcnt lgkmcnt(4)
M a[68:71], a[200:203], a[232:235], a[68:71]
ds_read_b128 a[224:227], v10 offset:6144
ds_read_b128 a[228:231], v11 offset:6144
M a[68:71], a[204:207], a[236:239], a[68:71]
buffer_load_dwordx4 v4, s[8:11], s23 offen offset:2048 lds
M a[72:75], a[212:215], a[236:239], a[72:75]
ds_read_b64_tr_b16 a[176:177], v14 offset:0
ds_read_b64_tr_b16 a[178:179], v14 offset:1536
M a[72:75], a[208:211], a[232:235], a[72:75]
M a[76:79], a[216:219], a[232:235], a[76:79]
buffer_load_dwordx4 v5, s[8:11], s23 offen offset:3072 lds
s_add_u32 s23, s23, 128
M a[76:79], a[220:223], a[236:239], a[76:79]
s_waitcnt lgkmcnt(6)
M a[80:83], a[204:207], a[244:247], a[80:83]
ds_read_b128 a[232:235], v10 offset:8192
ds_read_b128 a[236:239], v11 offset:8192
M a[80:83], a[200:203], a[240:243], a[80:83]
s_add_u32 m0, s30, 98304
s_nop 0
buffer_load_dwordx4 v6, s[12:15], s25 offen offset:0 lds
M a[84:87], a[208:211], a[240:243], a[84:87]
ds_read_b64_tr_b16 a[184:185], v15 offset:0
ds_read_b64_tr_b16 a[186:187], v15 offset:1536
M a[84:87], a[212:215], a[244:247], a[84:87]
M a[88:91], a[220:223], a[244:247], a[88:91]
buffer_load_dwordx4 v7, s[12:15], s25 offen offset:1024 lds
M a[88:91], a[216:219], a[240:243], a[88:91]
s_waitcnt lgkmcnt(8)
M a[92:95], a[200:203], a[248:251], a[92:95]
ds_read_b128 a[240:243], v10 offset:10240
ds_read_b128 a[244:247], v11 offset:10240
M a[92:95], a[204:207], a[252:255], a[92:95]
M a[96:99], a[212:215], a[252:255], a[96:99]
ds_read_b64_tr_b16 a[192:193], v16 offset:0
ds_read_b64_tr_b16 a[194:195], v16 offset:1536
M a[96:99], a[208:211], a[248:251], a[96:99]
buffer_load_dwordx4 v8, s[12:15], s25 offen offset:2048 lds
M a[100:103], a[216:219], a[248:251], a[100:103]
M a[100:103], a[220:223], a[252:255], a[100:103]
buffer_load_dwordx4 v9, s[12:15], s25 offen offset:3072 lds
s_waitcnt lgkmcnt(10)
M a[104:107], a[204:207], a[228:231], a[104:107]
ds_read_b128 a[248:251], v10 offset:12288
ds_read_b128 a[252:255], v11 offset:12288
M a[104:107], a[200:203], a[224:227], a[104:107]
M a[108:111], a[208:211], a[224:227], a[108:111]
ds_read_b64_tr_b16 a[180:181], v14 offset:12288
ds_read_b64_tr_b16 a[182:183], v14 offset:13824
M a[108:111], a[212:215], a[228:231], a[108:111]
s_add_u32 m0, s30, 102400
s_nop 0
buffer_load_dwordx4 v21, s[12:15], s25 offen offset:0 lds
M a[112:115], a[220:223], a[228:231], a[112:115]
M a[112:115], a[216:219], a[224:227], a[112:115]
buffer_load_dwordx4 v22, s[12:15], s25 offen offset:1024 lds
s_add_u32 s25, s25, 393216
s_waitcnt lgkmcnt(10)
M a[116:119], a[200:203], a[232:235], a[116:119]
ds_read_b128 a[224:227], v10 offset:14336
ds_read_b128 a[228:231], v11 offset:14336
M a[116:119], a[204:207], a[236:239], a[116:119]
M a[120:123], a[212:215], a[236:239], a[120:123]
ds_read_b64_tr_b16 a[188:189], v15 offset:12288
ds_read_b64_tr_b16 a[190:191], v15 offset:13824
M a[120:123], a[208:211], a[232:235], a[120:123]
M a[124:127], a[216:219], a[232:235], a[124:127]
s_add_u32 s94, s92, 12288
buffer_store_dwordx4 v[144:147], v1, s[16:19], s94 offen offset:2048 sc1
M a[124:127], a[220:223], a[236:239], a[124:127]
s_waitcnt lgkmcnt(10)
M a[128:131], a[204:207], a[244:247], a[128:131]
ds_read_b128 a[232:235], v10 offset:16384
ds_read_b128 a[236:239], v11 offset:16384
M a[128:131], a[200:203], a[240:243], a[128:131]
s_add_u32 s94, s92, 12288
buffer_store_dwordx4 v[152:155], v1, s[16:19], s94 offen offset:3072 sc1
M a[132:135], a[208:211], a[240:243], a[132:135]
ds_read_b64_tr_b16 a[196:197], v16 offset:12288
ds_read_b64_tr_b16 a[198:199], v16 offset:13824
M a[132:135], a[212:215], a[244:247], a[132:135]
M a[136:139], a[220:223], a[244:247], a[136:139]
s_add_u32 s94, s93, 0
buffer_store_dwordx4 v[160:163], v1, s[16:19], s94 offen offset:0 sc1
M a[136:139], a[216:219], a[240:243], a[136:139]
s_waitcnt lgkmcnt(10)
M a[140:143], a[200:203], a[248:251], a[140:143]
s_add_u32 s94, s93, 0
buffer_store_dwordx4 v[168:171], v1, s[16:19], s94 offen offset:1024 sc1
M a[140:143], a[204:207], a[252:255], a[140:143]
M a[144:147], a[212:215], a[252:255], a[144:147]
M a[144:147], a[208:211], a[248:251], a[144:147]
M a[148:151], a[216:219], a[248:251], a[148:151]
s_waitcnt vmcnt(16) lgkmcnt(0)
s_barrier
ds_read_b128 a[240:243], v10 offset:18432
ds_read_b128 a[244:247], v11 offset:18432
M a[148:151], a[220:223], a[252:255], a[148:151]
s_add_u32 m0, s28, 0
s_nop 0
buffer_load_dword v20, s[8:11], s24 offen lds
M a[152:155], a[204:207], a[228:231], a[152:155]
ds_read_b128 a[248:251], v10 offset:20480
ds_read_b128 a[252:255], v11 offset:20480
M a[152:155], a[200:203], a[224:227], a[152:155]
M a[156:159], a[208:211], a[224:227], a[156:159]
buffer_load_dword v23, s[8:11], s24 offen offset:256 lds
s_add_u32 s24, s24, 128
M a[156:159], a[212:215], a[228:231], a[156:159]
M a[160:163], a[220:223], a[228:231], a[160:163]
M a[160:163], a[216:219], a[224:227], a[160:163]
s_add_u32 m0, s29, 2048
s_nop 0
buffer_load_dwordx4 v2, s[8:11], s23 offen offset:0 lds
M a[164:167], a[200:203], a[232:235], a[164:167]
ds_read_b128 a[224:227], v10 offset:22528
ds_read_b128 a[228:231], v11 offset:22528
M a[164:167], a[204:207], a[236:239], a[164:167]
M a[168:171], a[212:215], a[236:239], a[168:171]
M a[168:171], a[208:211], a[232:235], a[168:171]
buffer_load_dwordx4 v3, s[8:11], s23 offen offset:1024 lds
M a[172:175], a[216:219], a[232:235], a[172:175]
M a[172:175], a[220:223], a[236:239], a[172:175]
s_waitcnt lgkmcnt(4)
M a[68:71], a[176:179], a[240:243], a[68:71]
ds_read_b128 a[232:235], v10 offset:24576
ds_read_b128 a[236:239], v11 offset:24576
M a[68:71], a[180:183], a[244:247], a[68:71]
buffer_load_dwordx4 v4, s[8:11], s23 offen offset:2048 lds
M a[72:75], a[188:191], a[244:247], a[72:75]
ds_read_b64_tr_b16 a[200:201], v14 offset:28672
ds_read_b64_tr_b16 a[202:203], v14 offset:30208
M a[72:75], a[184:187], a[240:243], a[72:75]
M a[76:79], a[192:195], a[240:243], a[76:79]
buffer_load_dwordx4 v5, s[8:11], s23 offen offset:3072 lds
s_add_u32 s23, s23, 128
M a[76:79], a[196:199], a[244:247], a[76:79]
s_waitcnt lgkmcnt(6)
M a[80:83], a[180:183], a[252:255], a[80:83]
ds_read_b128 a[240:243], v10 offset:26624
ds_read_b128 a[244:247], v11 offset:26624
M a[80:83], a[176:179], a[248:251], a[80:83]
s_add_u32 m0, s30, 36864
s_nop 0
buffer_load_dwordx4 v6, s[12:15], s25 offen offset:0 lds
M a[84:87], a[184:187], a[248:251], a[84:87]
ds_read_b64_tr_b16 a[208:209], v15 offset:28672
ds_read_b64_tr_b16 a[210:211], v15 offset:30208
M a[84:87], a[188:191], a[252:255], a[84:87]
M a[88:91], a[196:199], a[252:255], a[88:91]
buffer_load_dwordx4 v7, s[12:15], s25 offen offset:1024 lds
M a[88:91], a[192:195], a[248:251], a[88:91]
s_waitcnt lgkmcnt(8)
M a[92:95], a[176:179], a[224:227], a[92:95]
ds_read_b128 a[248:251], v10 offset:28672
ds_read_b128 a[252:255], v11 offset:28672
M a[92:95], a[180:183], a[228:231], a[92:95]
M a[96:99], a[188:191], a[228:231], a[96:99]
ds_read_b64_tr_b16 a[216:217], v16 offset:28672
ds_read_b64_tr_b16 a[218:219], v16 offset:30208
M a[96:99], a[184:187], a[224:227], a[96:99]
buffer_load_dwordx4 v8, s[12:15], s25 offen offset:2048 lds
M a[100:103], a[192:195], a[224:227], a[100:103]
M a[100:103], a[196:199], a[228:231], a[100:103]
buffer_load_dwordx4 v9, s[12:15], s25 offen offset:3072 lds
s_waitcnt lgkmcnt(10)
M a[104:107], a[180:183], a[236:239], a[104:107]
ds_read_b128 a[224:227], v10 offset:30720
ds_read_b128 a[228:231], v11 offset:30720
M a[104:107], a[176:179], a[232:235], a[104:107]
M a[108:111], a[184:187], a[232:235], a[108:111]
ds_read_b64_tr_b16 a[204:205], v14 offset:40960
ds_read_b64_tr_b16 a[206:207], v14 offset:42496
M a[108:111], a[188:191], a[236:239], a[108:111]
s_add_u32 m0, s30, 40960
s_nop 0
buffer_load_dwordx4 v21, s[12:15], s25 offen offset:0 lds
M a[112:115], a[196:199], a[236:239], a[112:115]
M a[112:115], a[192:195], a[232:235], a[112:115]
buffer_load_dwordx4 v22, s[12:15], s25 offen offset:1024 lds
s_add_u32 s25, s25, 393216
s_waitcnt lgkmcnt(10)
M a[116:119], a[176:179], a[240:243], a[116:119]
ds_read_b128 a[232:235], v10 offset:32768
ds_read_b128 a[236:239], v11 offset:32768
M a[116:119], a[180:183], a[244:247], a[116:119]
M a[120:123], a[188:191], a[244:247], a[120:123]
ds_read_b64_tr_b16 a[212:213], v15 offset:40960
ds_read_b64_tr_b16 a[214:215], v15 offset:42496
M a[120:123], a[184:187], a[240:243], a[120:123]
M a[124:127], a[192:195], a[240:243], a[124:127]
s_add_u32 s94, s93, 0
buffer_store_dwordx4 v[176:179], v1, s[16:19], s94 offen offset:2048 sc1
M a[124:127], a[196:199], a[244:247], a[124:127]
s_waitcnt lgkmcnt(10)
M a[128:131], a[180:183], a[252:255], a[128:131]
ds_read_b128 a[240:243], v10 offset:34816
ds_read_b128 a[244:247], v11 offset:34816
M a[128:131], a[176:179], a[248:251], a[128:131]
s_add_u32 s94, s93, 0
buffer_store_dwordx4 v[184:187], v1, s[16:19], s94 offen offset:3072 sc1
M a[132:135], a[184:187], a[248:251], a[132:135]
ds_read_b64_tr_b16 a[220:221], v16 offset:40960
ds_read_b64_tr_b16 a[222:223], v16 offset:42496
M a[132:135], a[188:191], a[252:255], a[132:135]
M a[136:139], a[196:199], a[252:255], a[136:139]
s_add_u32 s94, s93, 4096
buffer_store_dwordx4 v[192:195], v1, s[16:19], s94 offen offset:0 sc1
M a[136:139], a[192:195], a[248:251], a[136:139]
s_waitcnt lgkmcnt(10)
M a[140:143], a[176:179], a[224:227], a[140:143]
s_add_u32 s94, s93, 4096
buffer_store_dwordx4 v[200:203], v1, s[16:19], s94 offen offset:1024 sc1
M a[140:143], a[180:183], a[228:231], a[140:143]
M a[144:147], a[188:191], a[228:231], a[144:147]
M a[144:147], a[184:187], a[224:227], a[144:147]
M a[148:151], a[192:195], a[224:227], a[148:151]
s_waitcnt vmcnt(20) lgkmcnt(0)
s_barrier
ds_read_b128 a[248:251], v12 offset:0
ds_read_b128 a[252:255], v13 offset:0
M a[148:151], a[196:199], a[228:231], a[148:151]
s_add_u32 m0, s28, 18432
s_nop 0
buffer_load_dword v20, s[8:11], s24 offen lds
M a[152:155], a[180:183], a[236:239], a[152:155]
ds_read_b128 a[224:227], v12 offset:2048
ds_read_b128 a[228:231], v13 offset:2048
M a[152:155], a[176:179], a[232:235], a[152:155]
M a[156:159], a[184:187], a[232:235], a[156:159]
buffer_load_dword v23, s[8:11], s24 offen offset:256 lds
s_add_u32 s24, s24, 128
M a[156:159], a[188:191], a[236:239], a[156:159]
M a[160:163], a[196:199], a[236:239], a[160:163]
M a[160:163], a[192:195], a[232:235], a[160:163]
s_add_u32 m0, s29, 20480
s_nop 0
buffer_load_dwordx4 v2, s[8:11], s23 offen offset:0 lds
M a[164:167], a[176:179], a[240:243], a[164:167]
ds_read_b128 a[232:235], v12 offset:4096
ds_read_b128 a[236:239], v13 offset:4096
M a[164:167], a[180:183], a[244:247], a[164:167]
M a[168:171], a[188:191], a[244:247], a[168:171]
M a[168:171], a[184:187], a[240:243], a[168:171]
buffer_load_dwordx4 v3, s[8:11], s23 offen offset:1024 lds
M a[172:175], a[192:195], a[240:243], a[172:175]
M a[172:175], a[196:199], a[244:247], a[172:175]
s_waitcnt lgkmcnt(4)
M a[68:71], a[200:203], a[248:251], a[68:71]
ds_read_b128 a[240:243], v12 offset:6144
ds_read_b128 a[244:247], v13 offset:6144
M a[68:71], a[204:207], a[252:255], a[68:71]
buffer_load_dwordx4 v4, s[8:11], s23 offen offset:2048 lds
M a[72:75], a[212:215], a[252:255], a[72:75]
ds_read_b64_tr_b16 a[176:177], v17 offset:0
ds_read_b64_tr_b16 a[178:179], v17 offset:1536
M a[72:75], a[208:211], a[248:251], a[72:75]
M a[76:79], a[216:219], a[248:251], a[76:79]
buffer_load_dwordx4 v5, s[8:11], s23 offen offset:3072 lds
s_add_u32 s23, s23, 128
M a[76:79], a[220:223], a[252:255], a[76:79]
s_waitcnt lgkmcnt(6)
M a[80:83], a[204:207], a[228:231], a[80:83]
ds_read_b128 a[248:251], v12 offset:8192
ds_read_b128 a[252:255], v13 offset:8192
M a[80:83], a[200:203], a[224:227], a[80:83]
s_add_u32 m0, s30, 65536
s_nop 0
buffer_load_dwordx4 v6, s[12:15], s25 offen offset:0 lds
M a[84:87], a[208:211], a[224:227], a[84:87]
ds_read_b64_tr_b16 a[184:185], v18 offset:0
ds_read_b64_tr_b16 a[186:187], v18 offset:1536
M a[84:87], a[212:215], a[228:231], a[84:87]
M a[88:91], a[220:223], a[228:231], a[88:91]
buffer_load_dwordx4 v7, s[12:15], s25 offen offset:1024 lds
M a[88:91], a[216:219], a[224:227], a[88:91]
s_waitcnt lgkmcnt(8)
M a[92:95], a[200:203], a[232:235], a[92:95]
ds_read_b128 a[224:227], v12 offset:10240
ds_read_b128 a[228:231], v13 offset:10240
M a[92:95], a[204:207], a[236:239], a[92:95]
M a[96:99], a[212:215], a[236:239], a[96:99]
ds_read_b64_tr_b16 a[192:193], v19 offset:0
ds_read_b64_tr_b16 a[194:195], v19 offset:1536
M a[96:99], a[208:211], a[232:235], a[96:99]
buffer_load_dwordx4 v8, s[12:15], s25 offen offset:2048 lds
M a[100:103], a[216:219], a[232:235], a[100:103]
M a[100:103], a[220:223], a[236:239], a[100:103]
buffer_load_dwordx4 v9, s[12:15], s25 offen offset:3072 lds
s_waitcnt lgkmcnt(10)
M a[104:107], a[204:207], a[244:247], a[104:107]
ds_read_b128 a[232:235], v12 offset:12288
ds_read_b128 a[236:239], v13 offset:12288
M a[104:107], a[200:203], a[240:243], a[104:107]
M a[108:111], a[208:211], a[240:243], a[108:111]
ds_read_b64_tr_b16 a[180:181], v17 offset:12288
ds_read_b64_tr_b16 a[182:183], v17 offset:13824
M a[108:111], a[212:215], a[244:247], a[108:111]
s_add_u32 m0, s30, 69632
s_nop 0
buffer_load_dwordx4 v21, s[12:15], s25 offen offset:0 lds
M a[112:115], a[220:223], a[244:247], a[112:115]
M a[112:115], a[216:219], a[240:243], a[112:115]
buffer_load_dwordx4 v22, s[12:15], s25 offen offset:1024 lds
s_add_u32 s25, s25, 393216
s_waitcnt lgkmcnt(10)
M a[116:119], a[200:203], a[248:251], a[116:119]
ds_read_b128 a[240:243], v12 offset:14336
ds_read_b128 a[244:247], v13 offset:14336
M a[116:119], a[204:207], a[252:255], a[116:119]
M a[120:123], a[212:215], a[252:255], a[120:123]
ds_read_b64_tr_b16 a[188:189], v18 offset:12288
ds_read_b64_tr_b16 a[190:191], v18 offset:13824
M a[120:123], a[208:211], a[248:251], a[120:123]
M a[124:127], a[216:219], a[248:251], a[124:127]
s_add_u32 s94, s93, 4096
buffer_store_dwordx4 v[208:211], v1, s[16:19], s94 offen offset:2048 sc1
M a[124:127], a[220:223], a[252:255], a[124:127]
s_waitcnt lgkmcnt(10)
M a[128:131], a[204:207], a[228:231], a[128:131]
ds_read_b128 a[248:251], v12 offset:16384
ds_read_b128 a[252:255], v13 offset:16384
M a[128:131], a[200:203], a[224:227], a[128:131]
s_add_u32 s94, s93, 4096
buffer_store_dwordx4 v[216:219], v1, s[16:19], s94 offen offset:3072 sc1
M a[132:135], a[208:211], a[224:227], a[132:135]
ds_read_b64_tr_b16 a[196:197], v19 offset:12288
ds_read_b64_tr_b16 a[198:199], v19 offset:13824
M a[132:135], a[212:215], a[228:231], a[132:135]
M a[136:139], a[220:223], a[228:231], a[136:139]
s_add_u32 s94, s93, 8192
buffer_store_dwordx4 v[224:227], v1, s[16:19], s94 offen offset:0 sc1
M a[136:139], a[216:219], a[224:227], a[136:139]
s_waitcnt lgkmcnt(10)
M a[140:143], a[200:203], a[232:235], a[140:143]
s_add_u32 s94, s93, 8192
buffer_store_dwordx4 v[232:235], v1, s[16:19], s94 offen offset:1024 sc1
M a[140:143], a[204:207], a[236:239], a[140:143]
M a[144:147], a[212:215], a[236:239], a[144:147]
M a[144:147], a[208:211], a[232:235], a[144:147]
M a[148:151], a[216:219], a[232:235], a[148:151]
s_waitcnt vmcnt(20) lgkmcnt(0)
s_barrier
ds_read_b128 a[224:227], v10 offset:0
ds_read_b128 a[228:231], v11 offset:0
M a[148:151], a[220:223], a[236:239], a[148:151]
s_add_u32 m0, s28, 131072
s_nop 0
buffer_load_dword v20, s[8:11], s24 offen lds
M a[152:155], a[204:207], a[244:247], a[152:155]
ds_read_b128 a[232:235], v10 offset:2048
ds_read_b128 a[236:239], v11 offset:2048
M a[152:155], a[200:203], a[240:243], a[152:155]
M a[156:159], a[208:211], a[240:243], a[156:159]
buffer_load_dword v23, s[8:11], s24 offen offset:256 lds
s_add_u32 s24, s24, 128
M a[156:159], a[212:215], a[244:247], a[156:159]
M a[160:163], a[220:223], a[244:247], a[160:163]
M a[160:163], a[216:219], a[240:243], a[160:163]
s_add_u32 m0, s29, 133120
s_nop 0
buffer_load_dwordx4 v2, s[8:11], s23 offen offset:0 lds
M a[164:167], a[200:203], a[248:251], a[164:167]
ds_read_b128 a[240:243], v10 offset:4096
ds_read_b128 a[244:247], v11 offset:4096
M a[164:167], a[204:207], a[252:255], a[164:167]
M a[168:171], a[212:215], a[252:255], a[168:171]
M a[168:171], a[208:211], a[248:251], a[168:171]
buffer_load_dwordx4 v3, s[8:11], s23 offen offset:1024 lds
M a[172:175], a[216:219], a[248:251], a[172:175]
M a[172:175], a[220:223], a[252:255], a[172:175]
s_waitcnt lgkmcnt(4)
M a[68:71], a[176:179], a[224:227], a[68:71]
ds_read_b128 a[248:251], v10 offset:6144
ds_read_b128 a[252:255], v11 offset:6144
M a[68:71], a[180:183], a[228:231], a[68:71]
buffer_load_dwordx4 v4, s[8:11], s23 offen offset:2048 lds
M a[72:75], a[188:191], a[228:231], a[72:75]
ds_read_b64_tr_b16 a[200:201], v14 offset:0
ds_read_b64_tr_b16 a[202:203], v14 offset:1536
M a[72:75], a[184:187], a[224:227], a[72:75]
M a[76:79], a[192:195], a[224:227], a[76:79]
buffer_load_dwordx4 v5, s[8:11], s23 offen offset:3072 lds
s_add_u32 s23, s23, 128
M a[76:79], a[196:199], a[228:231], a[76:79]
s_waitcnt lgkmcnt(6)
M a[80:83], a[180:183], a[236:239], a[80:83]
ds_read_b128 a[224:227], v10 offset:8192
ds_read_b128 a[228:231], v11 offset:8192
M a[80:83], a[176:179], a[232:235], a[80:83]
s_add_u32 m0, s30, 98304
s_nop 0
buffer_load_dwordx4 v6, s[12:15], s25 offen offset:0 lds
M a[84:87], a[184:187], a[232:235], a[84:87]
ds_read_b64_tr_b16 a[208:209], v15 offset:0
ds_read_b64_tr_b16 a[210:211], v15 offset:1536
M a[84:87], a[188:191], a[236:239], a[84:87]
M a[88:91], a[196:199], a[236:239], a[88:91]
buffer_load_dwordx4 v7, s[12:15], s25 offen offset:1024 lds
M a[88:91], a[192:195], a[232:235], a[88:91]
s_waitcnt lgkmcnt(8)
M a[92:95], a[176:179], a[240:243], a[92:95]
ds_read_b128 a[232:235], v10 offset:10240
ds_read_b128 a[236:239], v11 offset:10240
M a[92:95], a[180:183], a[244:247], a[92:95]
M a[96:99], a[188:191], a[244:247], a[96:99]
ds_read_b64_tr_b16 a[216:217], v16 offset:0
ds_read_b64_tr_b16 a[218:219], v16 offset:1536
M a[96:99], a[184:187], a[240:243], a[96:99]
buffer_load_dwordx4 v8, s[12:15], s25 offen offset:2048 lds
M a[100:103], a[192:195], a[240:243], a[100:103]
M a[100:103], a[196:199], a[244:247], a[100:103]
buffer_load_dwordx4 v9, s[12:15], s25 offen offset:3072 lds
s_waitcnt lgkmcnt(10)
M a[104:107], a[180:183], a[252:255], a[104:107]
ds_read_b128 a[240:243], v10 offset:12288
ds_read_b128 a[244:247], v11 offset:12288
M a[104:107], a[176:179], a[248:251], a[104:107]
M a[108:111], a[184:187], a[248:251], a[108:111]
ds_read_b64_tr_b16 a[204:205], v14 offset:12288
ds_read_b64_tr_b16 a[206:207], v14 offset:13824
M a[108:111], a[188:191], a[252:255], a[108:111]
s_add_u32 m0, s30, 102400
s_nop 0
buffer_load_dwordx4 v21, s[12:15], s25 offen offset:0 lds
M a[112:115], a[196:199], a[252:255], a[112:115]
M a[112:115], a[192:195], a[248:251], a[112:115]
buffer_load_dwordx4 v22, s[12:15], s25 offen offset:1024 lds
s_add_u32 s25, s25, 393216
s_waitcnt lgkmcnt(10)
M a[116:119], a[176:179], a[224:227], a[116:119]
ds_read_b128 a[248:251], v10 offset:14336
ds_read_b128 a[252:255], v11 offset:14336
M a[116:119], a[180:183], a[228:231], a[116:119]
M a[120:123], a[188:191], a[228:231], a[120:123]
ds_read_b64_tr_b16 a[212:213], v15 offset:12288
ds_read_b64_tr_b16 a[214:215], v15 offset:13824
M a[120:123], a[184:187], a[224:227], a[120:123]
M a[124:127], a[192:195], a[224:227], a[124:127]
s_add_u32 s94, s93, 8192
buffer_store_dwordx4 v[240:243], v1, s[16:19], s94 offen offset:2048 sc1
M a[124:127], a[196:199], a[228:231], a[124:127]
s_waitcnt lgkmcnt(10)
M a[128:131], a[180:183], a[236:239], a[128:131]
ds_read_b128 a[224:227], v10 offset:16384
ds_read_b128 a[228:231], v11 offset:16384
M a[128:131], a[176:179], a[232:235], a[128:131]
s_add_u32 s94, s93, 8192
buffer_store_dwordx4 v[248:251], v1, s[16:19], s94 offen offset:3072 sc1
M a[132:135], a[184:187], a[232:235], a[132:135]
ds_read_b64_tr_b16 a[220:221], v16 offset:12288
ds_read_b64_tr_b16 a[222:223], v16 offset:13824
M a[132:135], a[188:191], a[236:239], a[132:135]
M a[136:139], a[196:199], a[236:239], a[136:139]
s_add_u32 s94, s93, 12288
buffer_store_dwordx4 v[36:39], v1, s[16:19], s94 offen offset:0 sc1
M a[136:139], a[192:195], a[232:235], a[136:139]
s_waitcnt lgkmcnt(10)
M a[140:143], a[176:179], a[240:243], a[140:143]
s_add_u32 s94, s93, 12288
buffer_store_dwordx4 v[44:47], v1, s[16:19], s94 offen offset:1024 sc1
M a[140:143], a[180:183], a[244:247], a[140:143]
M a[144:147], a[188:191], a[244:247], a[144:147]
M a[144:147], a[184:187], a[240:243], a[144:147]
M a[148:151], a[192:195], a[240:243], a[148:151]
s_waitcnt vmcnt(20) lgkmcnt(0)
s_barrier
ds_read_b128 a[232:235], v10 offset:18432
ds_read_b128 a[236:239], v11 offset:18432
M a[148:151], a[196:199], a[244:247], a[148:151]
s_add_u32 m0, s28, 0
s_nop 0
buffer_load_dword v20, s[8:11], s24 offen lds
M a[152:155], a[180:183], a[252:255], a[152:155]
ds_read_b128 a[240:243], v10 offset:20480
ds_read_b128 a[244:247], v11 offset:20480
M a[152:155], a[176:179], a[248:251], a[152:155]
M a[156:159], a[184:187], a[248:251], a[156:159]
buffer_load_dword v23, s[8:11], s24 offen offset:256 lds
s_add_u32 s24, s24, 128
M a[156:159], a[188:191], a[252:255], a[156:159]
M a[160:163], a[196:199], a[252:255], a[160:163]
M a[160:163], a[192:195], a[248:251], a[160:163]
s_add_u32 m0, s29, 2048
s_nop 0
buffer_load_dwordx4 v2, s[8:11], s23 offen offset:0 lds
M a[164:167], a[176:179], a[224:227], a[164:167]
ds_read_b128 a[248:251], v10 offset:22528
ds_read_b128 a[252:255], v11 offset:22528
M a[164:167], a[180:183], a[228:231], a[164:167]
M a[168:171], a[188:191], a[228:231], a[168:171]
M a[168:171], a[184:187], a[224:227], a[168:171]
buffer_load_dwordx4 v3, s[8:11], s23 offen offset:1024 lds
M a[172:175], a[192:195], a[224:227], a[172:175]
M a[172:175], a[196:199], a[228:231], a[172:175]
s_waitcnt lgkmcnt(4)
M a[68:71], a[200:203], a[232:235], a[68:71]
ds_read_b128 a[224:227], v10 offset:24576
ds_read_b128 a[228:231], v11 offset:24576
M a[68:71], a[204:207], a[236:239], a[68:71]
buffer_load_dwordx4 v4, s[8:11], s23 offen offset:2048 lds
M a[72:75], a[212:215], a[236:239], a[72:75]
ds_read_b64_tr_b16 a[176:177], v14 offset:28672
ds_read_b64_tr_b16 a[178:179], v14 offset:30208
M a[72:75], a[208:211], a[232:235], a[72:75]
M a[76:79], a[216:219], a[232:235], a[76:79]
buffer_load_dwordx4 v5, s[8:11], s23 offen offset:3072 lds
s_add_u32 s23, s23, 128
M a[76:79], a[220:223], a[236:239], a[76:79]
s_waitcnt lgkmcnt(6)
M a[80:83], a[204:207], a[244:247], a[80:83]
ds_read_b128 a[232:235], v10 offset:26624
ds_read_b128 a[236:239], v11 offset:26624
M a[80:83], a[200:203], a[240:243], a[80:83]
M a[84:87], a[208:211], a[240:243], a[84:87]
ds_read_b64_tr_b16 a[184:185], v15 offset:28672
ds_read_b64_tr_b16 a[186:187], v15 offset:30208
M a[84:87], a[212:215], a[244:247], a[84:87]
s_add_u32 m0, s30, 36864
s_nop 0
buffer_load_dwordx4 v6, s[12:15], s25 offen offset:0 lds
M a[88:91], a[220:223], a[244:247], a[88:91]
M a[88:91], a[216:219], a[240:243], a[88:91]
s_waitcnt lgkmcnt(8)
M a[92:95], a[200:203], a[248:251], a[92:95]
ds_read_b128 a[240:243], v10 offset:28672
ds_read_b128 a[244:247], v11 offset:28672
M a[92:95], a[204:207], a[252:255], a[92:95]
buffer_load_dwordx4 v7, s[12:15], s25 offen offset:1024 lds
M a[96:99], a[212:215], a[252:255], a[96:99]
ds_read_b64_tr_b16 a[192:193], v16 offset:28672
ds_read_b64_tr_b16 a[194:195], v16 offset:30208
M a[96:99], a[208:211], a[248:251], a[96:99]
M a[100:103], a[216:219], a[248:251], a[100:103]
buffer_load_dwordx4 v8, s[12:15], s25 offen offset:2048 lds
M a[100:103], a[220:223], a[252:255], a[100:103]
s_waitcnt lgkmcnt(10)
M a[104:107], a[204:207], a[228:231], a[104:107]
ds_read_b128 a[248:251], v10 offset:30720
ds_read_b128 a[252:255], v11 offset:30720
M a[104:107], a[200:203], a[224:227], a[104:107]
M a[108:111], a[208:211], a[224:227], a[108:111]
ds_read_b64_tr_b16 a[180:181], v14 offset:40960
ds_read_b64_tr_b16 a[182:183], v14 offset:42496
M a[108:111], a[212:215], a[228:231], a[108:111]
buffer_load_dwordx4 v9, s[12:15], s25 offen offset:3072 lds
M a[112:115], a[220:223], a[228:231], a[112:115]
M a[112:115], a[216:219], a[224:227], a[112:115]
s_waitcnt lgkmcnt(10)
M a[116:119], a[200:203], a[232:235], a[116:119]
ds_read_b128 a[224:227], v10 offset:32768
ds_read_b128 a[228:231], v11 offset:32768
M a[116:119], a[204:207], a[236:239], a[116:119]
s_add_u32 m0, s30, 40960
s_nop 0
buffer_load_dwordx4 v21, s[12:15], s25 offen offset:0 lds
M a[120:123], a[212:215], a[236:239], a[120:123]
ds_read_b64_tr_b16 a[188:189], v15 offset:40960
ds_read_b64_tr_b16 a[190:191], v15 offset:42496
M a[120:123], a[208:211], a[232:235], a[120:123]
M a[124:127], a[216:219], a[232:235], a[124:127]
buffer_load_dwordx4 v22, s[12:15], s25 offen offset:1024 lds
s_add_u32 s25, s25, 393216
M a[124:127], a[220:223], a[236:239], a[124:127]
s_waitcnt lgkmcnt(10)
M a[128:131], a[204:207], a[244:247], a[128:131]
ds_read_b128 a[232:235], v10 offset:34816
ds_read_b128 a[236:239], v11 offset:34816
M a[128:131], a[200:203], a[240:243], a[128:131]
M a[132:135], a[208:211], a[240:243], a[132:135]
ds_read_b64_tr_b16 a[196:197], v16 offset:40960
ds_read_b64_tr_b16 a[198:199], v16 offset:42496
M a[132:135], a[212:215], a[244:247], a[132:135]
s_add_u32 s94, s93, 12288
buffer_store_dwordx4 v[52:55], v1, s[16:19], s94 offen offset:2048 sc1
M a[136:139], a[220:223], a[244:247], a[136:139]
M a[136:139], a[216:219], a[240:243], a[136:139]
s_waitcnt lgkmcnt(10)
M a[140:143], a[200:203], a[248:251], a[140:143]
s_add_u32 s94, s93, 12288
buffer_store_dwordx4 v[60:63], v1, s[16:19], s94 offen offset:3072 sc1
M a[140:143], a[204:207], a[252:255], a[140:143]
M a[144:147], a[212:215], a[252:255], a[144:147]
M a[144:147], a[208:211], a[248:251], a[144:147]
M a[148:151], a[216:219], a[248:251], a[148:151]
s_waitcnt vmcnt(18) lgkmcnt(0)
s_barrier
ds_read_b128 a[240:243], v12 offset:0
ds_read_b128 a[244:247], v13 offset:0
M a[148:151], a[220:223], a[252:255], a[148:151]
s_add_u32 m0, s28, 18432
s_nop 0
buffer_load_dword v20, s[8:11], s24 offen lds
M a[152:155], a[204:207], a[228:231], a[152:155]
ds_read_b128 a[248:251], v12 offset:2048
ds_read_b128 a[252:255], v13 offset:2048
M a[152:155], a[200:203], a[224:227], a[152:155]
M a[156:159], a[208:211], a[224:227], a[156:159]
buffer_load_dword v23, s[8:11], s24 offen offset:256 lds
s_add_u32 s24, s24, 128
M a[156:159], a[212:215], a[228:231], a[156:159]
M a[160:163], a[220:223], a[228:231], a[160:163]
M a[160:163], a[216:219], a[224:227], a[160:163]
s_add_u32 m0, s29, 20480
s_nop 0
buffer_load_dwordx4 v2, s[8:11], s23 offen offset:0 lds
M a[164:167], a[200:203], a[232:235], a[164:167]
ds_read_b128 a[224:227], v12 offset:4096
ds_read_b128 a[228:231], v13 offset:4096
M a[164:167], a[204:207], a[236:239], a[164:167]
M a[168:171], a[212:215], a[236:239], a[168:171]
M a[168:171], a[208:211], a[232:235], a[168:171]
buffer_load_dwordx4 v3, s[8:11], s23 offen offset:1024 lds
M a[172:175], a[216:219], a[232:235], a[172:175]
M a[172:175], a[220:223], a[236:239], a[172:175]
s_waitcnt lgkmcnt(4)
M a[68:71], a[176:179], a[240:243], a[68:71]
ds_read_b128 a[232:235], v12 offset:6144
ds_read_b128 a[236:239], v13 offset:6144
M a[68:71], a[180:183], a[244:247], a[68:71]
buffer_load_dwordx4 v4, s[8:11], s23 offen offset:2048 lds
M a[72:75], a[188:191], a[244:247], a[72:75]
ds_read_b64_tr_b16 a[200:201], v17 offset:0
ds_read_b64_tr_b16 a[202:203], v17 offset:1536
M a[72:75], a[184:187], a[240:243], a[72:75]
M a[76:79], a[192:195], a[240:243], a[76:79]
M a[76:79], a[196:199], a[244:247], a[76:79]
buffer_load_dwordx4 v5, s[8:11], s23 offen offset:3072 lds
s_add_u32 s23, s23, 128
s_waitcnt lgkmcnt(6)
M a[80:83], a[180:183], a[252:255], a[80:83]
ds_read_b128 a[240:243], v12 offset:8192
ds_read_b128 a[244:247], v13 offset:8192
M a[80:83], a[176:179], a[248:251], a[80:83]
M a[84:87], a[184:187], a[248:251], a[84:87]
ds_read_b64_tr_b16 a[208:209], v18 offset:0
ds_read_b64_tr_b16 a[210:211], v18 offset:1536
M a[84:87], a[188:191], a[252:255], a[84:87]
M a[88:91], a[196:199], a[252:255], a[88:91]
s_add_u32 m0, s30, 65536
s_nop 0
buffer_load_dwordx4 v6, s[12:15], s25 offen offset:0 lds
M a[88:91], a[192:195], a[248:251], a[88:91]
s_waitcnt lgkmcnt(8)
M a[92:95], a[176:179], a[224:227], a[92:95]
ds_read_b128 a[248:251], v12 offset:10240
ds_read_b128 a[252:255], v13 offset:10240
M a[92:95], a[180:183], a[228:231], a[92:95]
M a[96:99], a[188:191], a[228:231], a[96:99]
ds_read_b64_tr_b16 a[216:217], v19 offset:0
ds_read_b64_tr_b16 a[218:219], v19 offset:1536
M a[96:99], a[184:187], a[224:227], a[96:99]
M a[100:103], a[192:195], a[224:227], a[100:103]
buffer_load_dwordx4 v7, s[12:15], s25 offen offset:1024 lds
M a[100:103], a[196:199], a[228:231], a[100:103]
s_waitcnt lgkmcnt(10)
M a[104:107], a[180:183], a[236:239], a[104:107]
ds_read_b128 a[224:227], v12 offset:12288
ds_read_b128 a[228:231], v13 offset:12288
M a[104:107], a[176:179], a[232:235], a[104:107]
M a[108:111], a[184:187], a[232:235], a[108:111]
ds_read_b64_tr_b16 a[204:205], v17 offset:12288
ds_read_b64_tr_b16 a[206:207], v17 offset:13824
M a[108:111], a[188:191], a[236:239], a[108:111]
buffer_load_dwordx4 v8, s[12:15], s25 offen offset:2048 lds
M a[112:115], a[196:199], a[236:239], a[112:115]
M a[112:115], a[192:195], a[232:235], a[112:115]
s_waitcnt lgkmcnt(10)
M a[116:119], a[176:179], a[240:243], a[116:119]
ds_read_b128 a[232:235], v12 offset:14336
ds_read_b128 a[236:239], v13 offset:14336
M a[116:119], a[180:183], a[244:247], a[116:119]
buffer_load_dwordx4 v9, s[12:15], s25 offen offset:3072 lds
M a[120:123], a[188:191], a[244:247], a[120:123]
ds_read_b64_tr_b16 a[212:213], v18 offset:12288
ds_read_b64_tr_b16 a[214:215], v18 offset:13824
M a[120:123], a[184:187], a[240:243], a[120:123]
M a[124:127], a[192:195], a[240:243], a[124:127]
M a[124:127], a[196:199], a[244:247], a[124:127]
s_waitcnt lgkmcnt(10)
M a[128:131], a[180:183], a[252:255], a[128:131]
ds_read_b128 a[240:243], v12 offset:16384
ds_read_b128 a[244:247], v13 offset:16384
M a[128:131], a[176:179], a[248:251], a[128:131]
s_add_u32 m0, s30, 69632
s_nop 0
buffer_load_dwordx4 v21, s[12:15], s25 offen offset:0 lds
M a[132:135], a[184:187], a[248:251], a[132:135]
ds_read_b64_tr_b16 a[220:221], v19 offset:12288
ds_read_b64_tr_b16 a[222:223], v19 offset:13824
M a[132:135], a[188:191], a[252:255], a[132:135]
M a[136:139], a[196:199], a[252:255], a[136:139]
M a[136:139], a[192:195], a[248:251], a[136:139]
buffer_load_dwordx4 v22, s[12:15], s25 offen offset:1024 lds
s_add_u32 s25, s25, 393216
s_waitcnt lgkmcnt(10)
M a[140:143], a[176:179], a[224:227], a[140:143]
M a[140:143], a[180:183], a[228:231], a[140:143]
M a[144:147], a[188:191], a[228:231], a[144:147]
M a[144:147], a[184:187], a[224:227], a[144:147]
M a[148:151], a[192:195], a[224:227], a[148:151]
s_waitcnt vmcnt(12) lgkmcnt(0)
s_barrier
ds_read_b128 a[248:251], v10 offset:0
ds_read_b128 a[252:255], v11 offset:0
s_cmp_lg_u32 s101, 0
s_cbranch_scc1 Lk1_arr
v_mov_b32 v127, 1
s_and_b32 s41, s2, 128
s_mov_b64 exec, 1
buffer_atomic_add v127, off, s[36:39], s41 sc1
s_mov_b64 exec, -1
Lk1_arr:
M a[148:151], a[196:199], a[228:231], a[148:151]
s_add_u32 m0, s28, 131072
s_nop 0
buffer_load_dword v20, s[8:11], s24 offen lds
M a[152:155], a[180:183], a[236:239], a[152:155]
ds_read_b128 a[224:227], v10 offset:2048
ds_read_b128 a[228:231], v11 offset:2048
M a[152:155], a[176:179], a[232:235], a[152:155]
M a[156:159], a[184:187], a[232:235], a[156:159]
buffer_load_dword v23, s[8:11], s24 offen offset:256 lds
s_add_u32 s24, s24, 128
M a[156:159], a[188:191], a[236:239], a[156:159]
M a[160:163], a[196:199], a[236:239], a[160:163]
M a[160:163], a[192:195], a[232:235], a[160:163]
s_add_u32 m0, s29, 133120
s_nop 0
buffer_load_dwordx4 v2, s[8:11], s23 offen offset:0 lds
M a[164:167], a[176:179], a[240:243], a[164:167]
ds_read_b128 a[232:235], v10 offset:4096
ds_read_b128 a[236:239], v11 offset:4096
M a[164:167], a[180:183], a[244:247], a[164:167]
M a[168:171], a[188:191], a[244:247], a[168:171]
M a[168:171], a[184:187], a[240:243], a[168:171]
buffer_load_dwordx4 v3, s[8:11], s23 offen offset:1024 lds
M a[172:175], a[192:195], a[240:243], a[172:175]
M a[172:175], a[196:199], a[244:247], a[172:175]
s_waitcnt lgkmcnt(4)
M a[68:71], a[200:203], a[248:251], a[68:71]
ds_read_b128 a[240:243], v10 offset:6144
ds_read_b128 a[244:247], v11 offset:6144
M a[68:71], a[204:207], a[252:255], a[68:71]
buffer_load_dwordx4 v4, s[8:11], s23 offen offset:2048 lds
M a[72:75], a[212:215], a[252:255], a[72:75]
ds_read_b64_tr_b16 a[176:177], v14 offset:0
ds_read_b64_tr_b16 a[178:179], v14 offset:1536
M a[72:75], a[208:211], a[248:251], a[72:75]
M a[76:79], a[216:219], a[248:251], a[76:79]
M a[76:79], a[220:223], a[252:255], a[76:79]
buffer_load_dwordx4 v5, s[8:11], s23 offen offset:3072 lds
s_add_u32 s23, s23, 128
s_waitcnt lgkmcnt(6)
M a[80:83], a[204:207], a[228:231], a[80:83]
ds_read_b128 a[248:251], v10 offset:8192
ds_read_b128 a[252:255], v11 offset:8192
M a[80:83], a[200:203], a[224:227], a[80:83]
M a[84:87], a[208:211], a[224:227], a[84:87]
ds_read_b64_tr_b16 a[184:185], v15 offset:0
ds_read_b64_tr_b16 a[186:187], v15 offset:1536
M a[84:87], a[212:215], a[228:231], a[84:87]
M a[88:91], a[220:223], a[228:231], a[88:91]
s_add_u32 m0, s30, 98304
s_nop 0
buffer_load_dwordx4 v6, s[12:15], s25 offen offset:0 lds
M a[88:91], a[216:219], a[224:227], a[88:91]
s_waitcnt lgkmcnt(8)
M a[92:95], a[200:203], a[232:235], a[92:95]
ds_read_b128 a[224:227], v10 offset:10240
ds_read_b128 a[228:231], v11 offset:10240
M a[92:95], a[204:207], a[236:239], a[92:95]
M a[96:99], a[212:215], a[236:239], a[96:99]
ds_read_b64_tr_b16 a[192:193], v16 offset:0
ds_read_b64_tr_b16 a[194:195], v16 offset:1536
M a[96:99], a[208:211], a[232:235], a[96:99]
M a[100:103], a[216:219], a[232:235], a[100:103]
buffer_load_dwordx4 v7, s[12:15], s25 offen offset:1024 lds
M a[100:103], a[220:223], a[236:239], a[100:103]
s_waitcnt lgkmcnt(10)
M a[104:107], a[204:207], a[244:247], a[104:107]
ds_read_b128 a[232:235], v10 offset:12288
ds_read_b128 a[236:239], v11 offset:12288
M a[104:107], a[200:203], a[240:243], a[104:107]
M a[108:111], a[208:211], a[240:243], a[108:111]
ds_read_b64_tr_b16 a[180:181], v14 offset:12288
ds_read_b64_tr_b16 a[182:183], v14 offset:13824
M a[108:111], a[212:215], a[244:247], a[108:111]
buffer_load_dwordx4 v8, s[12:15], s25 offen offset:2048 lds
M a[112:115], a[220:223], a[244:247], a[112:115]
M a[112:115], a[216:219], a[240:243], a[112:115]
s_waitcnt lgkmcnt(10)
M a[116:119], a[200:203], a[248:251], a[116:119]
ds_read_b128 a[240:243], v10 offset:14336
ds_read_b128 a[244:247], v11 offset:14336
M a[116:119], a[204:207], a[252:255], a[116:119]
buffer_load_dwordx4 v9, s[12:15], s25 offen offset:3072 lds
M a[120:123], a[212:215], a[252:255], a[120:123]
ds_read_b64_tr_b16 a[188:189], v15 offset:12288
ds_read_b64_tr_b16 a[190:191], v15 offset:13824
M a[120:123], a[208:211], a[248:251], a[120:123]
M a[124:127], a[216:219], a[248:251], a[124:127]
M a[124:127], a[220:223], a[252:255], a[124:127]
s_waitcnt lgkmcnt(10)
M a[128:131], a[204:207], a[228:231], a[128:131]
ds_read_b128 a[248:251], v10 offset:16384
ds_read_b128 a[252:255], v11 offset:16384
M a[128:131], a[200:203], a[224:227], a[128:131]
s_add_u32 m0, s30, 102400
s_nop 0
buffer_load_dwordx4 v21, s[12:15], s25 offen offset:0 lds
M a[132:135], a[208:211], a[224:227], a[132:135]
ds_read_b64_tr_b16 a[196:197], v16 offset:12288
ds_read_b64_tr_b16 a[198:199], v16 offset:13824
M a[132:135], a[212:215], a[228:231], a[132:135]
M a[136:139], a[220:223], a[228:231], a[136:139]
M a[136:139], a[216:219], a[224:227], a[136:139]
buffer_load_dwordx4 v22, s[12:15], s25 offen offset:1024 lds
s_add_u32 s25, s25, 393216
s_waitcnt lgkmcnt(10)
M a[140:143], a[200:203], a[232:235], a[140:143]
M a[140:143], a[204:207], a[236:239], a[140:143]
M a[144:147], a[212:215], a[236:239], a[144:147]
M a[144:147], a[208:211], a[232:235], a[144:147]
M a[148:151], a[216:219], a[232:235], a[148:151]
s_waitcnt vmcnt(12) lgkmcnt(0)
s_barrier
ds_read_b128 a[224:227], v10 offset:18432
ds_read_b128 a[228:231], v11 offset:18432
M a[148:151], a[220:223], a[236:239], a[148:151]
s_add_u32 m0, s28, 0
s_nop 0
buffer_load_dword v20, s[8:11], s24 offen lds
M a[152:155], a[204:207], a[244:247], a[152:155]
ds_read_b128 a[232:235], v10 offset:20480
ds_read_b128 a[236:239], v11 offset:20480
M a[152:155], a[200:203], a[240:243], a[152:155]
M a[156:159], a[208:211], a[240:243], a[156:159]
buffer_load_dword v23, s[8:11], s24 offen offset:256 lds
s_add_u32 s24, s24, 128
M a[156:159], a[212:215], a[244:247], a[156:159]
M a[160:163], a[220:223], a[244:247], a[160:163]
M a[160:163], a[216:219], a[240:243], a[160:163]
s_add_u32 m0, s29, 2048
s_nop 0
buffer_load_dwordx4 v2, s[8:11], s23 offen offset:0 lds
M a[164:167], a[200:203], a[248:251], a[164:167]
ds_read_b128 a[240:243], v10 offset:22528
ds_read_b128 a[244:247], v11 offset:22528
M a[164:167], a[204:207], a[252:255], a[164:167]
M a[168:171], a[212:215], a[252:255], a[168:171]
M a[168:171], a[208:211], a[248:251], a[168:171]
buffer_load_dwordx4 v3, s[8:11], s23 offen offset:1024 lds
M a[172:175], a[216:219], a[248:251], a[172:175]
M a[172:175], a[220:223], a[252:255], a[172:175]
s_waitcnt lgkmcnt(4)
M a[68:71], a[176:179], a[224:227], a[68:71]
ds_read_b128 a[248:251], v10 offset:24576
ds_read_b128 a[252:255], v11 offset:24576
v_mov_b32 v160, 0
v_mov_b32 v161, 0
M a[68:71], a[180:183], a[228:231], a[68:71]
buffer_load_dwordx4 v4, s[8:11], s23 offen offset:2048 lds
M a[72:75], a[188:191], a[228:231], a[72:75]
ds_read_b64_tr_b16 a[200:201], v14 offset:28672
ds_read_b64_tr_b16 a[202:203], v14 offset:30208
v_mov_b32 v162, 0
v_mov_b32 v163, 0
M a[72:75], a[184:187], a[224:227], a[72:75]
M a[76:79], a[192:195], a[224:227], a[76:79]
v_mov_b32 v164, 0
v_mov_b32 v165, 0
M a[76:79], a[196:199], a[228:231], a[76:79]
buffer_load_dwordx4 v5, s[8:11], s23 offen offset:3072 lds
s_add_u32 s23, s23, 128
s_waitcnt lgkmcnt(6)
M a[80:83], a[180:183], a[236:239], a[80:83]
ds_read_b128 a[224:227], v10 offset:26624
ds_read_b128 a[228:231], v11 offset:26624
v_mov_b32 v166, 0
v_mov_b32 v167, 0
M a[80:83], a[176:179], a[232:235], a[80:83]
M a[84:87], a[184:187], a[232:235], a[84:87]
ds_read_b64_tr_b16 a[208:209], v15 offset:28672
ds_read_b64_tr_b16 a[210:211], v15 offset:30208
M a[84:87], a[188:191], a[236:239], a[84:87]
v_mov_b32 v168, 0
v_mov_b32 v169, 0
M a[88:91], a[196:199], a[236:239], a[88:91]
s_add_u32 m0, s30, 36864
s_nop 0
buffer_load_dwordx4 v6, s[12:15], s25 offen offset:0 lds
M a[88:91], a[192:195], a[232:235], a[88:91]
s_waitcnt lgkmcnt(8)
v_mov_b32 v170, 0
v_mov_b32 v171, 0
M a[92:95], a[176:179], a[240:243], a[92:95]
ds_read_b128 a[232:235], v10 offset:28672
ds_read_b128 a[236:239], v11 offset:28672
M a[92:95], a[180:183], a[244:247], a[92:95]
v_mov_b32 v172, 0
v_mov_b32 v173, 0
M a[96:99], a[188:191], a[244:247], a[96:99]
ds_read_b64_tr_b16 a[216:217], v16 offset:28672
ds_read_b64_tr_b16 a[218:219], v16 offset:30208
M a[96:99], a[184:187], a[240:243], a[96:99]
v_mov_b32 v174, 0
v_mov_b32 v175, 0
M a[100:103], a[192:195], a[240:243], a[100:103]
buffer_load_dwordx4 v7, s[12:15], s25 offen offset:1024 lds
M a[100:103], a[196:199], a[244:247], a[100:103]
s_waitcnt lgkmcnt(10)
M a[104:107], a[180:183], a[252:255], a[104:107]
ds_read_b128 a[240:243], v10 offset:30720
ds_read_b128 a[244:247], v11 offset:30720
v_mov_b32 v176, 0
v_mov_b32 v177, 0
M a[104:107], a[176:179], a[248:251], a[104:107]
M a[108:111], a[184:187], a[248:251], a[108:111]
ds_read_b64_tr_b16 a[204:205], v14 offset:40960
ds_read_b64_tr_b16 a[206:207], v14 offset:42496
v_mov_b32 v178, 0
v_mov_b32 v179, 0
M a[108:111], a[188:191], a[252:255], a[108:111]
buffer_load_dwordx4 v8, s[12:15], s25 offen offset:2048 lds
M a[112:115], a[196:199], a[252:255], a[112:115]
v_mov_b32 v180, 0
v_mov_b32 v181, 0
M a[112:115], a[192:195], a[248:251], a[112:115]
s_waitcnt lgkmcnt(10)
M a[116:119], a[176:179], a[224:227], a[116:119]
ds_read_b128 a[248:251], v10 offset:32768
ds_read_b128 a[252:255], v11 offset:32768
v_mov_b32 v182, 0
v_mov_b32 v183, 0
M a[116:119], a[180:183], a[228:231], a[116:119]
buffer_load_dwordx4 v9, s[12:15], s25 offen offset:3072 lds
M a[120:123], a[188:191], a[228:231], a[120:123]
ds_read_b64_tr_b16 a[212:213], v15 offset:40960
ds_read_b64_tr_b16 a[214:215], v15 offset:42496
M a[120:123], a[184:187], a[224:227], a[120:123]
v_mov_b32 v184, 0
v_mov_b32 v185, 0
M a[124:127], a[192:195], a[224:227], a[124:127]
M a[124:127], a[196:199], a[228:231], a[124:127]
s_waitcnt lgkmcnt(10)
v_mov_b32 v186, 0
v_mov_b32 v187, 0
M a[128:131], a[180:183], a[236:239], a[128:131]
ds_read_b128 a[224:227], v10 offset:34816
ds_read_b128 a[228:231], v11 offset:34816
M a[128:131], a[176:179], a[232:235], a[128:131]
s_add_u32 m0, s30, 40960
s_nop 0
buffer_load_dwordx4 v21, s[12:15], s25 offen offset:0 lds
v_mov_b32 v188, 0
v_mov_b32 v189, 0
M a[132:135], a[184:187], a[232:235], a[132:135]
ds_read_b64_tr_b16 a[220:221], v16 offset:40960
ds_read_b64_tr_b16 a[222:223], v16 offset:42496
M a[132:135], a[188:191], a[236:239], a[132:135]
v_mov_b32 v190, 0
v_mov_b32 v191, 0
M a[136:139], a[196:199], a[236:239], a[136:139]
M a[136:139], a[192:195], a[232:235], a[136:139]
buffer_load_dwordx4 v22, s[12:15], s25 offen offset:1024 lds
s_add_u32 s25, s25, 393216
s_waitcnt lgkmcnt(10)
M a[140:143], a[176:179], a[240:243], a[140:143]
v_mov_b32 v192, 0
v_mov_b32 v193, 0
M a[140:143], a[180:183], a[244:247], a[140:143]
M a[144:147], a[188:191], a[244:247], a[144:147]
v_mov_b32 v194, 0
v_mov_b32 v195, 0
M a[144:147], a[184:187], a[240:243], a[144:147]
M a[148:151], a[192:195], a[240:243], a[148:151]
s_waitcnt vmcnt(12) lgkmcnt(0)
s_barrier
ds_read_b128 a[232:235], v12 offset:0
ds_read_b128 a[236:239], v13 offset:0
v_mov_b32 v196, 0
v_mov_b32 v197, 0
M a[148:151], a[196:199], a[244:247], a[148:151]
s_add_u32 m0, s28, 18432
s_nop 0
buffer_load_dword v20, s[8:11], s24 offen lds
M a[152:155], a[180:183], a[252:255], a[152:155]
ds_read_b128 a[240:243], v12 offset:2048
ds_read_b128 a[244:247], v13 offset:2048
v_mov_b32 v198, 0
v_mov_b32 v199, 0
M a[152:155], a[176:179], a[248:251], a[152:155]
M a[156:159], a[184:187], a[248:251], a[156:159]
buffer_load_dword v23, s[8:11], s24 offen offset:256 lds
s_add_u32 s24, s24, 128
M a[156:159], a[188:191], a[252:255], a[156:159]
v_mov_b32 v200, 0
v_mov_b32 v201, 0
M a[160:163], a[196:199], a[252:255], a[160:163]
M a[160:163], a[192:195], a[248:251], a[160:163]
s_add_u32 m0, s29, 20480
s_nop 0
buffer_load_dwordx4 v2, s[8:11], s23 offen offset:0 lds
v_mov_b32 v202, 0
v_mov_b32 v203, 0
M a[164:167], a[176:179], a[224:227], a[164:167]
ds_read_b128 a[248:251], v12 offset:4096
ds_read_b128 a[252:255], v13 offset:4096
M a[164:167], a[180:183], a[228:231], a[164:167]
v_mov_b32 v204, 0
v_mov_b32 v205, 0
M a[168:171], a[188:191], a[228:231], a[168:171]
M a[168:171], a[184:187], a[224:227], a[168:171]
buffer_load_dwordx4 v3, s[8:11], s23 offen offset:1024 lds
v_mov_b32 v206, 0
v_mov_b32 v207, 0
M a[172:175], a[192:195], a[224:227], a[172:175]
M a[172:175], a[196:199], a[228:231], a[172:175]
s_waitcnt lgkmcnt(4)
M a[68:71], a[200:203], a[232:235], a[68:71]
ds_read_b128 a[224:227], v12 offset:6144
ds_read_b128 a[228:231], v13 offset:6144
v_and_b32 v128, 15, v0
v_mul_u32_u24 v128, 400, v128
M a[68:71], a[204:207], a[236:239], a[68:71]
buffer_load_dwordx4 v4, s[8:11], s23 offen offset:2048 lds
M a[72:75], a[212:215], a[236:239], a[72:75]
ds_read_b64_tr_b16 a[176:177], v17 offset:0
ds_read_b64_tr_b16 a[178:179], v17 offset:1536
v_lshrrev_b32 v129, 4, v0
v_lshl_add_u32 v128, v129, 3, v128
M a[72:75], a[208:211], a[232:235], a[72:75]
M a[76:79], a[216:219], a[232:235], a[76:79]
s_mul_i32 s3, s20, 96
s_add_u32 s3, s3, 98304
M a[76:79], a[220:223], a[236:239], a[76:79]
buffer_load_dwordx4 v5, s[8:11], s23 offen offset:3072 lds
s_add_u32 s23, s23, 128
s_waitcnt lgkmcnt(6)
M a[80:83], a[204:207], a[244:247], a[80:83]
ds_read_b128 a[232:235], v12 offset:8192
ds_read_b128 a[236:239], v13 offset:8192
v_add_u32 v124, s3, v128
v_and_b32 v128, 15, v0
M a[80:83], a[200:203], a[240:243], a[80:83]
M a[84:87], a[208:211], a[240:243], a[84:87]
ds_read_b64_tr_b16 a[184:185], v18 offset:0
ds_read_b64_tr_b16 a[186:187], v18 offset:1536
v_lshrrev_b32 v129, 4, v0
s_add_u32 s3, s21, 16
M a[84:87], a[212:215], a[244:247], a[84:87]
M a[88:91], a[220:223], a[244:247], a[88:91]
s_add_u32 m0, s30, 65536
s_nop 0
buffer_load_dwordx4 v6, s[12:15], s25 offen offset:0 lds
v_lshl_add_u32 v130, v128, 1, s3
s_lshl_b32 s4, s22, 6
M a[88:91], a[216:219], a[240:243], a[88:91]
s_waitcnt lgkmcnt(8)
M a[92:95], a[200:203], a[248:251], a[92:95]
ds_read_b128 a[240:243], v12 offset:10240
ds_read_b128 a[244:247], v13 offset:10240
s_add_u32 s4, s4, 98304
v_mul_u32_u24 v120, 400, v130
M a[92:95], a[204:207], a[252:255], a[92:95]
M a[96:99], a[212:215], a[252:255], a[96:99]
ds_read_b64_tr_b16 a[192:193], v19 offset:0
ds_read_b64_tr_b16 a[194:195], v19 offset:1536
M a[96:99], a[208:211], a[248:251], a[96:99]
v_lshl_add_u32 v120, v129, 4, v120
v_add_u32 v120, s4, v120
M a[100:103], a[216:219], a[248:251], a[100:103]
buffer_load_dwordx4 v7, s[12:15], s25 offen offset:1024 lds
M a[100:103], a[220:223], a[252:255], a[100:103]
s_waitcnt lgkmcnt(10)
v_subrev_u32 v130, 32, v130
v_max_i32 v130, 0, v130
M a[104:107], a[204:207], a[228:231], a[104:107]
ds_read_b128 a[248:251], v12 offset:12288
ds_read_b128 a[252:255], v13 offset:12288
M a[104:107], a[200:203], a[224:227], a[104:107]
v_mul_u32_u24 v121, 400, v130
v_lshl_add_u32 v121, v129, 4, v121
M a[108:111], a[208:211], a[224:227], a[108:111]
ds_read_b64_tr_b16 a[180:181], v17 offset:12288
ds_read_b64_tr_b16 a[182:183], v17 offset:13824
M a[108:111], a[212:215], a[228:231], a[108:111]
buffer_load_dwordx4 v8, s[12:15], s25 offen offset:2048 lds
v_add_u32 v121, s4, v121
v_bfe_u32 v131, v0, 2, 2
M a[112:115], a[220:223], a[228:231], a[112:115]
M a[112:115], a[216:219], a[224:227], a[112:115]
s_waitcnt lgkmcnt(10)
v_lshl_add_u32 v131, v129, 2, v131
v_lshl_add_u32 v131, v131, 1, s3
M a[116:119], a[200:203], a[232:235], a[116:119]
ds_read_b128 a[224:227], v12 offset:14336
ds_read_b128 a[228:231], v13 offset:14336
M a[116:119], a[204:207], a[236:239], a[116:119]
buffer_load_dwordx4 v9, s[12:15], s25 offen offset:3072 lds
v_and_b32 v132, 3, v0
v_lshlrev_b32 v132, 3, v132
M a[120:123], a[212:215], a[236:239], a[120:123]
ds_read_b64_tr_b16 a[188:189], v18 offset:12288
ds_read_b64_tr_b16 a[190:191], v18 offset:13824
M a[120:123], a[208:211], a[232:235], a[120:123]
M a[124:127], a[216:219], a[232:235], a[124:127]
v_add_u32 v132, s4, v132
s_movk_i32 s5, 400
M a[124:127], a[220:223], a[236:239], a[124:127]
s_waitcnt lgkmcnt(10)
M a[128:131], a[204:207], a[244:247], a[128:131]
ds_read_b128 a[232:235], v12 offset:16384
ds_read_b128 a[236:239], v13 offset:16384
v_mad_u32_u24 v122, v131, s5, v132
v_subrev_u32 v131, 32, v131
M a[128:131], a[200:203], a[240:243], a[128:131]
s_add_u32 m0, s30, 69632
s_nop 0
buffer_load_dwordx4 v21, s[12:15], s25 offen offset:0 lds
M a[132:135], a[208:211], a[240:243], a[132:135]
ds_read_b64_tr_b16 a[196:197], v19 offset:12288
ds_read_b64_tr_b16 a[198:199], v19 offset:13824
v_max_i32 v131, 0, v131
v_mad_u32_u24 v123, v131, s5, v132
M a[132:135], a[212:215], a[244:247], a[132:135]
M a[136:139], a[220:223], a[244:247], a[136:139]
v_lshlrev_b32 v129, 2, v129
v_sub_u32 v128, v128, v129
M a[136:139], a[216:219], a[240:243], a[136:139]
buffer_load_dwordx4 v22, s[12:15], s25 offen offset:1024 lds
s_add_u32 s25, s25, 393216
s_waitcnt lgkmcnt(10)
M a[140:143], a[200:203], a[248:251], a[140:143]
v_mov_b32 v129, 0xf149f2ca
s_cmp_eq_u32 s26, 0
s_cselect_b32 s3, 0xf149f2ca, 0
M a[140:143], a[204:207], a[252:255], a[140:143]
M a[144:147], a[212:215], a[252:255], a[144:147]
v_cmp_lt_i32 vcc, -9, v128
s_nop 1
v_cndmask_b32 v144, 0, v129, vcc
M a[144:147], a[208:211], a[248:251], a[144:147]
M a[148:151], a[216:219], a[248:251], a[148:151]
s_waitcnt vmcnt(12) lgkmcnt(0)
s_barrier
ds_read_b128 a[240:243], v10 offset:0
ds_read_b128 a[244:247], v11 offset:0
M a[148:151], a[220:223], a[252:255], a[148:151]
s_add_u32 m0, s28, 131072
s_nop 0
buffer_load_dword v20, s[8:11], s24 offen lds
v_subrev_u32 v130, 0, v128
v_cmp_lt_u32 vcc, 7, v130
s_nop 1
v_cndmask_b32 v148, 0, v129, vcc
M a[152:155], a[204:207], a[228:231], a[152:155]
ds_read_b128 a[248:251], v10 offset:2048
ds_read_b128 a[252:255], v11 offset:2048
M a[152:155], a[200:203], a[224:227], a[152:155]
v_min_f32 v152, s3, v144
v_mov_b32 v156, 0x3f803f80
M a[156:159], a[208:211], a[224:227], a[156:159]
buffer_load_dword v23, s[8:11], s24 offen offset:256 lds
s_add_u32 s24, s24, 128
M a[156:159], a[212:215], a[228:231], a[156:159]
v_cmp_lt_i32 vcc, -8, v128
s_nop 1
v_cndmask_b32 v145, 0, v129, vcc
M a[160:163], a[220:223], a[228:231], a[160:163]
M a[160:163], a[216:219], a[224:227], a[160:163]
s_add_u32 m0, s29, 133120
s_nop 0
buffer_load_dwordx4 v2, s[8:11], s23 offen offset:0 lds
v_subrev_u32 v130, 1, v128
v_cmp_lt_u32 vcc, 7, v130
s_nop 1
v_cndmask_b32 v149, 0, v129, vcc
M a[164:167], a[200:203], a[232:235], a[164:167]
ds_read_b128 a[224:227], v10 offset:4096
ds_read_b128 a[228:231], v11 offset:4096
M a[164:167], a[204:207], a[236:239], a[164:167]
v_min_f32 v153, s3, v145
v_mov_b32 v157, 0x3f803f80
M a[168:171], a[212:215], a[236:239], a[168:171]
M a[168:171], a[208:211], a[232:235], a[168:171]
buffer_load_dwordx4 v3, s[8:11], s23 offen offset:1024 lds
v_cmp_lt_i32 vcc, -7, v128
s_nop 1
v_cndmask_b32 v146, 0, v129, vcc
M a[172:175], a[216:219], a[232:235], a[172:175]
M a[172:175], a[220:223], a[236:239], a[172:175]
s_waitcnt lgkmcnt(4)
M a[68:71], a[176:179], a[240:243], a[68:71]
ds_read_b128 a[232:235], v10 offset:6144
ds_read_b128 a[236:239], v11 offset:6144
v_subrev_u32 v130, 2, v128
v_cmp_lt_u32 vcc, 7, v130
s_nop 1
v_cndmask_b32 v150, 0, v129, vcc
M a[68:71], a[180:183], a[244:247], a[68:71]
buffer_load_dwordx4 v4, s[8:11], s23 offen offset:2048 lds
v_min_f32 v154, s3, v146
v_mov_b32 v158, 0x3f803f80
M a[72:75], a[188:191], a[244:247], a[72:75]
ds_read_b64_tr_b16 a[200:201], v14 offset:0
ds_read_b64_tr_b16 a[202:203], v14 offset:1536
M a[72:75], a[184:187], a[240:243], a[72:75]
v_cmp_lt_i32 vcc, -6, v128
s_nop 1
v_cndmask_b32 v147, 0, v129, vcc
M a[76:79], a[192:195], a[240:243], a[76:79]
v_subrev_u32 v130, 3, v128
v_cmp_lt_u32 vcc, 7, v130
s_nop 1
v_cndmask_b32 v151, 0, v129, vcc
M a[76:79], a[196:199], a[244:247], a[76:79]
buffer_load_dwordx4 v5, s[8:11], s23 offen offset:3072 lds
s_add_u32 s23, s23, 128
s_waitcnt lgkmcnt(6)
M a[80:83], a[180:183], a[252:255], a[80:83]
ds_read_b128 a[240:243], v10 offset:8192
ds_read_b128 a[244:247], v11 offset:8192
v_min_f32 v155, s3, v147
v_mov_b32 v159, 0x3f803f80
M a[80:83], a[176:179], a[248:251], a[80:83]
s_add_u32 s16, s50, 83886080
s_addc_u32 s17, s51, 0
M a[84:87], a[184:187], a[248:251], a[84:87]
ds_read_b64_tr_b16 a[208:209], v15 offset:0
ds_read_b64_tr_b16 a[210:211], v15 offset:1536
M a[84:87], a[188:191], a[252:255], a[84:87]
s_mov_b32 s18, 4194304
s_mov_b32 s19, 0x00020000
M a[88:91], a[196:199], a[252:255], a[88:91]
s_add_u32 m0, s30, 98304
s_nop 0
buffer_load_dwordx4 v6, s[12:15], s25 offen offset:0 lds
s_lshl_b32 s3, s26, 18
s_lshl_b32 s4, s27, 14
M a[88:91], a[192:195], a[248:251], a[88:91]
s_waitcnt lgkmcnt(8)
M a[92:95], a[176:179], a[224:227], a[92:95]
ds_read_b128 a[248:251], v10 offset:10240
ds_read_b128 a[252:255], v11 offset:10240
s_add_u32 s3, s3, s4
s_lshl_b32 s4, s21, 13
M a[92:95], a[180:183], a[228:231], a[92:95]
s_add_u32 s3, s3, s4
s_lshl_b32 s4, s22, 10
M a[96:99], a[188:191], a[228:231], a[96:99]
ds_read_b64_tr_b16 a[216:217], v16 offset:0
ds_read_b64_tr_b16 a[218:219], v16 offset:1536
M a[96:99], a[184:187], a[224:227], a[96:99]
s_add_u32 s6, s3, s4
s_mov_b32 s7, 0x3e8293ee
M a[100:103], a[192:195], a[224:227], a[100:103]
buffer_load_dwordx4 v7, s[12:15], s25 offen offset:1024 lds
s_lshl_b32 s65, s26, 8
s_lshl_b32 s3, s27, 4
M a[100:103], a[196:199], a[228:231], a[100:103]
s_waitcnt lgkmcnt(10)
M a[104:107], a[180:183], a[236:239], a[104:107]
ds_read_b128 a[224:227], v10 offset:12288
ds_read_b128 a[228:231], v11 offset:12288
s_add_u32 s65, s65, s3
s_lshl_b32 s3, s101, 2
M a[104:107], a[176:179], a[232:235], a[104:107]
s_add_u32 s65, s65, s3
s_add_u32 s65, s65, 16789504
M a[108:111], a[184:187], a[232:235], a[108:111]
ds_read_b64_tr_b16 a[204:205], v14 offset:12288
ds_read_b64_tr_b16 a[206:207], v14 offset:13824
M a[108:111], a[188:191], a[236:239], a[108:111]
buffer_load_dwordx4 v8, s[12:15], s25 offen offset:2048 lds
s_mov_b32 s40, 0
v_mov_b32 v119, 0
M a[112:115], a[196:199], a[236:239], a[112:115]
s_mov_b64 s[4:5], s[50:51]
s_and_b32 s20, s2, 7
M a[112:115], a[192:195], a[232:235], a[112:115]
s_waitcnt lgkmcnt(10)
M a[116:119], a[176:179], a[240:243], a[116:119]
ds_read_b128 a[232:235], v10 offset:14336
ds_read_b128 a[236:239], v11 offset:14336
s_lshr_b32 s33, s2, 6
s_lshl_b32 s33, s33, 3
M a[116:119], a[180:183], a[244:247], a[116:119]
buffer_load_dwordx4 v9, s[12:15], s25 offen offset:3072 lds
s_add_u32 s20, s20, s33
s_bfe_u32 s21, s2, 0x30003
M a[120:123], a[188:191], a[244:247], a[120:123]
ds_read_b64_tr_b16 a[212:213], v15 offset:12288
ds_read_b64_tr_b16 a[214:215], v15 offset:13824
M a[120:123], a[184:187], a[240:243], a[120:123]
s_sub_u32 s35, 15, s21
s_cmp_lt_u32 s101, 2
s_cselect_b32 s35, s21, s35
M a[124:127], a[192:195], a[240:243], a[124:127]
s_lshl_b32 s33, s20, 7
s_lshl_b32 s34, s35, 3
M a[124:127], a[196:199], a[244:247], a[124:127]
s_waitcnt lgkmcnt(10)
M a[128:131], a[180:183], a[252:255], a[128:131]
ds_read_b128 a[240:243], v10 offset:16384
ds_read_b128 a[244:247], v11 offset:16384
s_add_u32 s33, s33, s34
s_and_b32 s34, s101, 1
M a[128:131], a[176:179], a[248:251], a[128:131]
s_add_u32 m0, s30, 102400
s_nop 0
buffer_load_dwordx4 v21, s[12:15], s25 offen offset:0 lds
s_lshl_b32 s34, s34, 2
s_add_u32 s33, s33, s34
M a[132:135], a[184:187], a[248:251], a[132:135]
ds_read_b64_tr_b16 a[220:221], v16 offset:12288
ds_read_b64_tr_b16 a[222:223], v16 offset:13824
M a[132:135], a[188:191], a[252:255], a[132:135]
s_lshl_b32 s64, s33, 12
s_mov_b32 s44, s4
M a[136:139], a[196:199], a[252:255], a[136:139]
s_mov_b32 s45, s5
s_mov_b32 s46, 16777216
M a[136:139], a[192:195], a[248:251], a[136:139]
buffer_load_dwordx4 v22, s[12:15], s25 offen offset:1024 lds
s_add_u32 s25, s25, 393216
s_waitcnt lgkmcnt(10)
M a[140:143], a[176:179], a[224:227], a[140:143]
s_mov_b32 s47, 0x00020000
M a[140:143], a[180:183], a[228:231], a[140:143]
M a[144:147], a[188:191], a[228:231], a[144:147]
M a[144:147], a[184:187], a[224:227], a[144:147]
M a[148:151], a[192:195], a[224:227], a[148:151]
s_waitcnt vmcnt(12) lgkmcnt(0)
s_barrier
ds_read_b128 a[248:251], v10 offset:18432
ds_read_b128 a[252:255], v11 offset:18432
M a[148:151], a[196:199], a[228:231], a[148:151]
s_add_u32 m0, s28, 0
s_nop 0
buffer_load_dword v20, s[8:11], s24 offen lds
M a[152:155], a[180:183], a[236:239], a[152:155]
ds_read_b128 a[224:227], v10 offset:20480
ds_read_b128 a[228:231], v11 offset:20480
M a[152:155], a[176:179], a[232:235], a[152:155]
M a[156:159], a[184:187], a[232:235], a[156:159]
buffer_load_dword v23, s[8:11], s24 offen offset:256 lds
s_add_u32 s24, s24, 128
M a[156:159], a[188:191], a[236:239], a[156:159]
M a[160:163], a[196:199], a[236:239], a[160:163]
M a[160:163], a[192:195], a[232:235], a[160:163]
s_add_u32 m0, s29, 2048
s_nop 0
buffer_load_dwordx4 v2, s[8:11], s23 offen offset:0 lds
M a[164:167], a[176:179], a[240:243], a[164:167]
ds_read_b128 a[232:235], v10 offset:22528
ds_read_b128 a[236:239], v11 offset:22528
M a[164:167], a[180:183], a[244:247], a[164:167]
M a[168:171], a[188:191], a[244:247], a[168:171]
M a[168:171], a[184:187], a[240:243], a[168:171]
buffer_load_dwordx4 v3, s[8:11], s23 offen offset:1024 lds
M a[172:175], a[192:195], a[240:243], a[172:175]
M a[172:175], a[196:199], a[244:247], a[172:175]
s_waitcnt lgkmcnt(4)
M a[68:71], a[200:203], a[248:251], a[68:71]
ds_read_b128 a[240:243], v10 offset:24576
ds_read_b128 a[244:247], v11 offset:24576
M a[68:71], a[204:207], a[252:255], a[68:71]
buffer_load_dwordx4 v4, s[8:11], s23 offen offset:2048 lds
M a[72:75], a[212:215], a[252:255], a[72:75]
ds_read_b64_tr_b16 a[176:177], v14 offset:28672
ds_read_b64_tr_b16 a[178:179], v14 offset:30208
M a[72:75], a[208:211], a[248:251], a[72:75]
M a[76:79], a[216:219], a[248:251], a[76:79]
M a[76:79], a[220:223], a[252:255], a[76:79]
buffer_load_dwordx4 v5, s[8:11], s23 offen offset:3072 lds
s_add_u32 s23, s23, 128
s_waitcnt lgkmcnt(6)
M a[80:83], a[204:207], a[228:231], a[80:83]
ds_read_b128 a[248:251], v10 offset:26624
ds_read_b128 a[252:255], v11 offset:26624
M a[80:83], a[200:203], a[224:227], a[80:83]
M a[84:87], a[208:211], a[224:227], a[84:87]
ds_read_b64_tr_b16 a[184:185], v15 offset:28672
ds_read_b64_tr_b16 a[186:187], v15 offset:30208
M a[84:87], a[212:215], a[228:231], a[84:87]
M a[88:91], a[220:223], a[228:231], a[88:91]
s_add_u32 m0, s30, 36864
s_nop 0
buffer_load_dwordx4 v6, s[12:15], s25 offen offset:0 lds
M a[88:91], a[216:219], a[224:227], a[88:91]
s_waitcnt lgkmcnt(8)
M a[92:95], a[200:203], a[232:235], a[92:95]
ds_read_b128 a[224:227], v10 offset:28672
ds_read_b128 a[228:231], v11 offset:28672
M a[92:95], a[204:207], a[236:239], a[92:95]
M a[96:99], a[212:215], a[236:239], a[96:99]
ds_read_b64_tr_b16 a[192:193], v16 offset:28672
ds_read_b64_tr_b16 a[194:195], v16 offset:30208
M a[96:99], a[208:211], a[232:235], a[96:99]
M a[100:103], a[216:219], a[232:235], a[100:103]
buffer_load_dwordx4 v7, s[12:15], s25 offen offset:1024 lds
M a[100:103], a[220:223], a[236:239], a[100:103]
s_waitcnt lgkmcnt(10)
M a[104:107], a[204:207], a[244:247], a[104:107]
ds_read_b128 a[232:235], v10 offset:30720
ds_read_b128 a[236:239], v11 offset:30720
M a[104:107], a[200:203], a[240:243], a[104:107]
M a[108:111], a[208:211], a[240:243], a[108:111]
ds_read_b64_tr_b16 a[180:181], v14 offset:40960
ds_read_b64_tr_b16 a[182:183], v14 offset:42496
M a[108:111], a[212:215], a[244:247], a[108:111]
buffer_load_dwordx4 v8, s[12:15], s25 offen offset:2048 lds
M a[112:115], a[220:223], a[244:247], a[112:115]
M a[112:115], a[216:219], a[240:243], a[112:115]
s_waitcnt lgkmcnt(10)
M a[116:119], a[200:203], a[248:251], a[116:119]
ds_read_b128 a[240:243], v10 offset:32768
ds_read_b128 a[244:247], v11 offset:32768
M a[116:119], a[204:207], a[252:255], a[116:119]
buffer_load_dwordx4 v9, s[12:15], s25 offen offset:3072 lds
M a[120:123], a[212:215], a[252:255], a[120:123]
ds_read_b64_tr_b16 a[188:189], v15 offset:40960
ds_read_b64_tr_b16 a[190:191], v15 offset:42496
M a[120:123], a[208:211], a[248:251], a[120:123]
M a[124:127], a[216:219], a[248:251], a[124:127]
M a[124:127], a[220:223], a[252:255], a[124:127]
s_waitcnt lgkmcnt(10)
M a[128:131], a[204:207], a[228:231], a[128:131]
ds_read_b128 a[248:251], v10 offset:34816
ds_read_b128 a[252:255], v11 offset:34816
M a[128:131], a[200:203], a[224:227], a[128:131]
s_add_u32 m0, s30, 40960
s_nop 0
buffer_load_dwordx4 v21, s[12:15], s25 offen offset:0 lds
M a[132:135], a[208:211], a[224:227], a[132:135]
ds_read_b64_tr_b16 a[196:197], v16 offset:40960
ds_read_b64_tr_b16 a[198:199], v16 offset:42496
M a[132:135], a[212:215], a[228:231], a[132:135]
M a[136:139], a[220:223], a[228:231], a[136:139]
M a[136:139], a[216:219], a[224:227], a[136:139]
buffer_load_dwordx4 v22, s[12:15], s25 offen offset:1024 lds
s_add_u32 s25, s25, 393216
s_waitcnt lgkmcnt(10)
M a[140:143], a[200:203], a[232:235], a[140:143]
M a[140:143], a[204:207], a[236:239], a[140:143]
M a[144:147], a[212:215], a[236:239], a[144:147]
M a[144:147], a[208:211], a[232:235], a[144:147]
M a[148:151], a[216:219], a[232:235], a[148:151]
s_waitcnt vmcnt(12) lgkmcnt(0)
s_barrier
ds_read_b128 a[224:227], v12 offset:0
ds_read_b128 a[228:231], v13 offset:0
M a[148:151], a[220:223], a[236:239], a[148:151]
s_add_u32 m0, s28, 18432
s_nop 0
buffer_load_dword v20, s[8:11], s24 offen lds
M a[152:155], a[204:207], a[244:247], a[152:155]
ds_read_b128 a[232:235], v12 offset:2048
ds_read_b128 a[236:239], v13 offset:2048
M a[152:155], a[200:203], a[240:243], a[152:155]
M a[156:159], a[208:211], a[240:243], a[156:159]
buffer_load_dword v23, s[8:11], s24 offen offset:256 lds
s_add_u32 s24, s24, 128
M a[156:159], a[212:215], a[244:247], a[156:159]
M a[160:163], a[220:223], a[244:247], a[160:163]
M a[160:163], a[216:219], a[240:243], a[160:163]
s_add_u32 m0, s29, 20480
s_nop 0
buffer_load_dwordx4 v2, s[8:11], s23 offen offset:0 lds
M a[164:167], a[200:203], a[248:251], a[164:167]
ds_read_b128 a[240:243], v12 offset:4096
ds_read_b128 a[244:247], v13 offset:4096
M a[164:167], a[204:207], a[252:255], a[164:167]
M a[168:171], a[212:215], a[252:255], a[168:171]
M a[168:171], a[208:211], a[248:251], a[168:171]
buffer_load_dwordx4 v3, s[8:11], s23 offen offset:1024 lds
M a[172:175], a[216:219], a[248:251], a[172:175]
M a[172:175], a[220:223], a[252:255], a[172:175]
s_waitcnt lgkmcnt(4)
M a[68:71], a[176:179], a[224:227], a[68:71]
ds_read_b128 a[248:251], v12 offset:6144
ds_read_b128 a[252:255], v13 offset:6144
M a[68:71], a[180:183], a[228:231], a[68:71]
buffer_load_dwordx4 v4, s[8:11], s23 offen offset:2048 lds
M a[72:75], a[188:191], a[228:231], a[72:75]
ds_read_b64_tr_b16 a[200:201], v17 offset:0
ds_read_b64_tr_b16 a[202:203], v17 offset:1536
M a[72:75], a[184:187], a[224:227], a[72:75]
M a[76:79], a[192:195], a[224:227], a[76:79]
M a[76:79], a[196:199], a[228:231], a[76:79]
buffer_load_dwordx4 v5, s[8:11], s23 offen offset:3072 lds
s_add_u32 s23, s23, 128
s_waitcnt lgkmcnt(6)
M a[80:83], a[180:183], a[236:239], a[80:83]
ds_read_b128 a[224:227], v12 offset:8192
ds_read_b128 a[228:231], v13 offset:8192
M a[80:83], a[176:179], a[232:235], a[80:83]
M a[84:87], a[184:187], a[232:235], a[84:87]
ds_read_b64_tr_b16 a[208:209], v18 offset:0
ds_read_b64_tr_b16 a[210:211], v18 offset:1536
M a[84:87], a[188:191], a[236:239], a[84:87]
M a[88:91], a[196:199], a[236:239], a[88:91]
s_add_u32 m0, s30, 65536
s_nop 0
buffer_load_dwordx4 v6, s[12:15], s25 offen offset:0 lds
M a[88:91], a[192:195], a[232:235], a[88:91]
s_waitcnt lgkmcnt(8)
M a[92:95], a[176:179], a[240:243], a[92:95]
ds_read_b128 a[232:235], v12 offset:10240
ds_read_b128 a[236:239], v13 offset:10240
M a[92:95], a[180:183], a[244:247], a[92:95]
M a[96:99], a[188:191], a[244:247], a[96:99]
ds_read_b64_tr_b16 a[216:217], v19 offset:0
ds_read_b64_tr_b16 a[218:219], v19 offset:1536
M a[96:99], a[184:187], a[240:243], a[96:99]
buffer_load_dwordx4 v7, s[12:15], s25 offen offset:1024 lds
M a[100:103], a[192:195], a[240:243], a[100:103]
M a[100:103], a[196:199], a[244:247], a[100:103]
s_waitcnt lgkmcnt(10)
M a[104:107], a[180:183], a[252:255], a[104:107]
ds_read_b128 a[240:243], v12 offset:12288
ds_read_b128 a[244:247], v13 offset:12288
M a[104:107], a[176:179], a[248:251], a[104:107]
buffer_load_dwordx4 v8, s[12:15], s25 offen offset:2048 lds
M a[108:111], a[184:187], a[248:251], a[108:111]
ds_read_b64_tr_b16 a[204:205], v17 offset:12288
ds_read_b64_tr_b16 a[206:207], v17 offset:13824
M a[108:111], a[188:191], a[252:255], a[108:111]
M a[112:115], a[196:199], a[252:255], a[112:115]
M a[112:115], a[192:195], a[248:251], a[112:115]
buffer_load_dwordx4 v9, s[12:15], s25 offen offset:3072 lds
s_waitcnt lgkmcnt(10)
M a[116:119], a[176:179], a[224:227], a[116:119]
ds_read_b128 a[248:251], v12 offset:14336
ds_read_b128 a[252:255], v13 offset:14336
M a[116:119], a[180:183], a[228:231], a[116:119]
M a[120:123], a[188:191], a[228:231], a[120:123]
ds_read_b64_tr_b16 a[212:213], v18 offset:12288
ds_read_b64_tr_b16 a[214:215], v18 offset:13824
M a[120:123], a[184:187], a[224:227], a[120:123]
M a[124:127], a[192:195], a[224:227], a[124:127]
s_add_u32 m0, s30, 69632
s_nop 0
buffer_load_dwordx4 v21, s[12:15], s25 offen offset:0 lds
M a[124:127], a[196:199], a[228:231], a[124:127]
s_waitcnt lgkmcnt(10)
M a[128:131], a[180:183], a[236:239], a[128:131]
ds_read_b128 a[224:227], v12 offset:16384
ds_read_b128 a[228:231], v13 offset:16384
M a[128:131], a[176:179], a[232:235], a[128:131]
M a[132:135], a[184:187], a[232:235], a[132:135]
ds_read_b64_tr_b16 a[220:221], v19 offset:12288
ds_read_b64_tr_b16 a[222:223], v19 offset:13824
M a[132:135], a[188:191], a[236:239], a[132:135]
buffer_load_dwordx4 v22, s[12:15], s25 offen offset:1024 lds
s_add_u32 s25, s25, 393216
M a[136:139], a[196:199], a[236:239], a[136:139]
M a[136:139], a[192:195], a[232:235], a[136:139]
s_waitcnt lgkmcnt(10)
M a[140:143], a[176:179], a[240:243], a[140:143]
buffer_load_dword v125, v119, s[36:39], 0 offen sc1
M a[140:143], a[180:183], a[244:247], a[140:143]
M a[144:147], a[188:191], a[244:247], a[144:147]
M a[144:147], a[184:187], a[240:243], a[144:147]
M a[148:151], a[192:195], a[240:243], a[148:151]
s_waitcnt vmcnt(13) lgkmcnt(0)
s_barrier
ds_read_b128 a[232:235], v10 offset:0
ds_read_b128 a[236:239], v11 offset:0
s_waitcnt vmcnt(0)
v_cmp_gt_u32 vcc, 0x80, v125
s_nop 0
s_cbranch_vccnz Lk1_spinq
Lk1_gotq:
M a[148:151], a[196:199], a[244:247], a[148:151]
s_add_u32 m0, s28, 131072
s_nop 0
buffer_load_dword v20, s[8:11], s24 offen lds
M a[152:155], a[180:183], a[252:255], a[152:155]
ds_read_b128 a[240:243], v10 offset:2048
ds_read_b128 a[244:247], v11 offset:2048
M a[152:155], a[176:179], a[248:251], a[152:155]
M a[156:159], a[184:187], a[248:251], a[156:159]
buffer_load_dword v23, s[8:11], s24 offen offset:256 lds
s_add_u32 s24, s24, 128
M a[156:159], a[188:191], a[252:255], a[156:159]
M a[160:163], a[196:199], a[252:255], a[160:163]
M a[160:163], a[192:195], a[248:251], a[160:163]
s_add_u32 m0, s29, 133120
s_nop 0
buffer_load_dwordx4 v2, s[8:11], s23 offen offset:0 lds
M a[164:167], a[176:179], a[224:227], a[164:167]
ds_read_b128 a[248:251], v10 offset:4096
ds_read_b128 a[252:255], v11 offset:4096
M a[164:167], a[180:183], a[228:231], a[164:167]
M a[168:171], a[188:191], a[228:231], a[168:171]
M a[168:171], a[184:187], a[224:227], a[168:171]
buffer_load_dwordx4 v3, s[8:11], s23 offen offset:1024 lds
M a[172:175], a[192:195], a[224:227], a[172:175]
M a[172:175], a[196:199], a[228:231], a[172:175]
s_waitcnt lgkmcnt(4)
M a[68:71], a[200:203], a[232:235], a[68:71]
ds_read_b128 a[224:227], v10 offset:6144
ds_read_b128 a[228:231], v11 offset:6144
v_mov_b32 v208, 0
v_mov_b32 v209, 0
M a[68:71], a[204:207], a[236:239], a[68:71]
buffer_load_dwordx4 v4, s[8:11], s23 offen offset:2048 lds
M a[72:75], a[212:215], a[236:239], a[72:75]
ds_read_b64_tr_b16 a[176:177], v14 offset:0
ds_read_b64_tr_b16 a[178:179], v14 offset:1536
v_mov_b32 v210, 0
v_mov_b32 v211, 0
M a[72:75], a[208:211], a[232:235], a[72:75]
M a[76:79], a[216:219], a[232:235], a[76:79]
buffer_load_dwordx4 v5, s[8:11], s23 offen offset:3072 lds
s_add_u32 s23, s23, 128
v_mov_b32 v212, 0
v_mov_b32 v213, 0
M a[76:79], a[220:223], a[236:239], a[76:79]
s_waitcnt lgkmcnt(6)
M a[80:83], a[204:207], a[244:247], a[80:83]
ds_read_b128 a[232:235], v10 offset:8192
ds_read_b128 a[236:239], v11 offset:8192
v_mov_b32 v214, 0
v_mov_b32 v215, 0
M a[80:83], a[200:203], a[240:243], a[80:83]
M a[84:87], a[208:211], a[240:243], a[84:87]
ds_read_b64_tr_b16 a[184:185], v15 offset:0
ds_read_b64_tr_b16 a[186:187], v15 offset:1536
M a[84:87], a[212:215], a[244:247], a[84:87]
buffer_load_dwordx4 a[0:3], v1, s[44:47], s64 offen offset:0 sc1
v_mov_b32 v216, 0
v_mov_b32 v217, 0
M a[88:91], a[220:223], a[244:247], a[88:91]
M a[88:91], a[216:219], a[240:243], a[88:91]
s_waitcnt lgkmcnt(8)
v_mov_b32 v218, 0
v_mov_b32 v219, 0
M a[92:95], a[200:203], a[248:251], a[92:95]
ds_read_b128 a[240:243], v10 offset:10240
ds_read_b128 a[244:247], v11 offset:10240
M a[92:95], a[204:207], a[252:255], a[92:95]
buffer_load_dwordx4 a[4:7], v1, s[44:47], s64 offen offset:1024 sc1
v_mov_b32 v220, 0
v_mov_b32 v221, 0
M a[96:99], a[212:215], a[252:255], a[96:99]
ds_read_b64_tr_b16 a[192:193], v16 offset:0
ds_read_b64_tr_b16 a[194:195], v16 offset:1536
M a[96:99], a[208:211], a[248:251], a[96:99]
v_mov_b32 v222, 0
v_mov_b32 v223, 0
M a[100:103], a[216:219], a[248:251], a[100:103]
buffer_load_dwordx4 a[8:11], v1, s[44:47], s64 offen offset:2048 sc1
M a[100:103], a[220:223], a[252:255], a[100:103]
s_waitcnt lgkmcnt(10)
M a[104:107], a[204:207], a[228:231], a[104:107]
ds_read_b128 a[248:251], v10 offset:12288
ds_read_b128 a[252:255], v11 offset:12288
v_mov_b32 v224, 0
v_mov_b32 v225, 0
M a[104:107], a[200:203], a[224:227], a[104:107]
M a[108:111], a[208:211], a[224:227], a[108:111]
ds_read_b64_tr_b16 a[180:181], v14 offset:12288
ds_read_b64_tr_b16 a[182:183], v14 offset:13824
v_mov_b32 v226, 0
v_mov_b32 v227, 0
M a[108:111], a[212:215], a[228:231], a[108:111]
buffer_load_dwordx4 a[12:15], v1, s[44:47], s64 offen offset:3072 sc1
s_add_u32 s64, s64, 4096
M a[112:115], a[220:223], a[228:231], a[112:115]
v_mov_b32 v228, 0
v_mov_b32 v229, 0
M a[112:115], a[216:219], a[224:227], a[112:115]
s_waitcnt lgkmcnt(10)
M a[116:119], a[200:203], a[232:235], a[116:119]
ds_read_b128 a[224:227], v10 offset:14336
ds_read_b128 a[228:231], v11 offset:14336
v_mov_b32 v230, 0
v_mov_b32 v231, 0
M a[116:119], a[204:207], a[236:239], a[116:119]
buffer_load_dwordx4 a[16:19], v1, s[44:47], s64 offen offset:0 sc1
M a[120:123], a[212:215], a[236:239], a[120:123]
ds_read_b64_tr_b16 a[188:189], v15 offset:12288
ds_read_b64_tr_b16 a[190:191], v15 offset:13824
M a[120:123], a[208:211], a[232:235], a[120:123]
v_mov_b32 v232, 0
v_mov_b32 v233, 0
M a[124:127], a[216:219], a[232:235], a[124:127]
buffer_load_dwordx4 a[20:23], v1, s[44:47], s64 offen offset:1024 sc1
M a[124:127], a[220:223], a[236:239], a[124:127]
s_waitcnt lgkmcnt(10)
v_mov_b32 v234, 0
v_mov_b32 v235, 0
M a[128:131], a[204:207], a[244:247], a[128:131]
ds_read_b128 a[232:235], v10 offset:16384
ds_read_b128 a[236:239], v11 offset:16384
M a[128:131], a[200:203], a[240:243], a[128:131]
v_mov_b32 v236, 0
v_mov_b32 v237, 0
M a[132:135], a[208:211], a[240:243], a[132:135]
ds_read_b64_tr_b16 a[196:197], v16 offset:12288
ds_read_b64_tr_b16 a[198:199], v16 offset:13824
M a[132:135], a[212:215], a[244:247], a[132:135]
buffer_load_dwordx4 a[24:27], v1, s[44:47], s64 offen offset:2048 sc1
v_mov_b32 v238, 0
v_mov_b32 v239, 0
M a[136:139], a[220:223], a[244:247], a[136:139]
M a[136:139], a[216:219], a[240:243], a[136:139]
s_waitcnt lgkmcnt(10)
M a[140:143], a[200:203], a[248:251], a[140:143]
buffer_load_dwordx4 a[28:31], v1, s[44:47], s64 offen offset:3072 sc1
s_add_u32 s64, s64, 4096
v_mov_b32 v240, 0
v_mov_b32 v241, 0
M a[140:143], a[204:207], a[252:255], a[140:143]
M a[144:147], a[212:215], a[252:255], a[144:147]
v_mov_b32 v242, 0
v_mov_b32 v243, 0
M a[144:147], a[208:211], a[248:251], a[144:147]
M a[148:151], a[216:219], a[248:251], a[148:151]
s_waitcnt vmcnt(15) lgkmcnt(0)
s_barrier
ds_read_b128 a[240:243], v10 offset:18432
ds_read_b128 a[244:247], v11 offset:18432
v_mov_b32 v244, 0
v_mov_b32 v245, 0
M a[148:151], a[220:223], a[252:255], a[148:151]
buffer_load_dwordx4 a[32:35], v1, s[44:47], s64 offen offset:0 sc1
M a[152:155], a[204:207], a[228:231], a[152:155]
ds_read_b128 a[248:251], v10 offset:20480
ds_read_b128 a[252:255], v11 offset:20480
v_mov_b32 v246, 0
v_mov_b32 v247, 0
M a[152:155], a[200:203], a[224:227], a[152:155]
M a[156:159], a[208:211], a[224:227], a[156:159]
buffer_load_dwordx4 a[36:39], v1, s[44:47], s64 offen offset:1024 sc1
M a[156:159], a[212:215], a[228:231], a[156:159]
v_mov_b32 v248, 0
v_mov_b32 v249, 0
M a[160:163], a[220:223], a[228:231], a[160:163]
M a[160:163], a[216:219], a[224:227], a[160:163]
buffer_load_dwordx4 a[40:43], v1, s[44:47], s64 offen offset:2048 sc1
v_mov_b32 v250, 0
v_mov_b32 v251, 0
M a[164:167], a[200:203], a[232:235], a[164:167]
ds_read_b128 a[224:227], v10 offset:22528
ds_read_b128 a[228:231], v11 offset:22528
M a[164:167], a[204:207], a[236:239], a[164:167]
v_mov_b32 v252, 0
v_mov_b32 v253, 0
M a[168:171], a[212:215], a[236:239], a[168:171]
M a[168:171], a[208:211], a[232:235], a[168:171]
buffer_load_dwordx4 a[44:47], v1, s[44:47], s64 offen offset:3072 sc1
s_add_u32 s64, s64, 4096
v_mov_b32 v254, 0
v_mov_b32 v255, 0
M a[172:175], a[216:219], a[232:235], a[172:175]
M a[172:175], a[220:223], a[236:239], a[172:175]
s_waitcnt lgkmcnt(4)
M a[68:71], a[176:179], a[240:243], a[68:71]
ds_read_b128 a[232:235], v10 offset:24576
ds_read_b128 a[236:239], v11 offset:24576
s_mov_b32 s22, s101
s_and_b32 s23, s22, 1
M a[68:71], a[180:183], a[244:247], a[68:71]
buffer_load_dwordx4 a[48:51], v1, s[44:47], s64 offen offset:0 sc1
s_lshr_b32 s24, s22, 1
s_lshl_b32 s33, s24, 14
M a[72:75], a[188:191], a[244:247], a[72:75]
ds_read_b64_tr_b16 a[200:201], v14 offset:28672
ds_read_b64_tr_b16 a[202:203], v14 offset:30208
M a[72:75], a[184:187], a[240:243], a[72:75]
s_lshl_b32 s34, s23, 13
s_add_u32 s29, s33, s34
M a[76:79], a[192:195], a[240:243], a[76:79]
M a[76:79], a[196:199], a[244:247], a[76:79]
s_waitcnt lgkmcnt(6)
s_lshl_b32 s28, s20, 20
s_add_u32 s28, s28, s34
M a[80:83], a[180:183], a[252:255], a[80:83]
ds_read_b128 a[240:243], v10 offset:26624
ds_read_b128 a[244:247], v11 offset:26624
M a[80:83], a[176:179], a[248:251], a[80:83]
s_mov_b32 s25, s28
s_lshl_b32 s33, s21, 16
M a[84:87], a[184:187], a[248:251], a[84:87]
ds_read_b64_tr_b16 a[208:209], v15 offset:28672
ds_read_b64_tr_b16 a[210:211], v15 offset:30208
M a[84:87], a[188:191], a[252:255], a[84:87]
buffer_load_dwordx4 a[52:55], v1, s[44:47], s64 offen offset:1024 sc1
s_add_u32 s34, s28, s33
s_add_u32 s34, s34, 65536
M a[88:91], a[196:199], a[252:255], a[88:91]
M a[88:91], a[192:195], a[248:251], a[88:91]
s_waitcnt lgkmcnt(8)
s_add_u32 s32, s28, 491520
s_sub_u32 s33, s32, s33
M a[92:95], a[176:179], a[224:227], a[92:95]
ds_read_b128 a[248:251], v10 offset:28672
ds_read_b128 a[252:255], v11 offset:28672
M a[92:95], a[180:183], a[228:231], a[92:95]
s_add_u32 s33, s33, 491520
s_cmp_eq_u32 s24, 0
s_cselect_b32 s27, s34, s32
s_cselect_b32 s28, s32, s33
M a[96:99], a[188:191], a[228:231], a[96:99]
ds_read_b64_tr_b16 a[216:217], v16 offset:28672
ds_read_b64_tr_b16 a[218:219], v16 offset:30208
M a[96:99], a[184:187], a[224:227], a[96:99]
s_mov_b32 s56, s27
s_mov_b32 s57, s28
M a[100:103], a[192:195], a[224:227], a[100:103]
buffer_load_dwordx4 a[56:59], v1, s[44:47], s64 offen offset:2048 sc1
M a[100:103], a[196:199], a[228:231], a[100:103]
s_waitcnt lgkmcnt(10)
s_min_u32 s34, s34, s32
s_cmp_eq_u32 s34, s32
s_cselect_b32 s33, s33, s34
M a[104:107], a[180:183], a[236:239], a[104:107]
ds_read_b128 a[224:227], v10 offset:30720
ds_read_b128 a[228:231], v11 offset:30720
M a[104:107], a[176:179], a[232:235], a[104:107]
s_or_b32 s34, s34, 0x40000000
s_or_b32 s32, s25, 0x40000000
M a[108:111], a[184:187], a[232:235], a[108:111]
ds_read_b64_tr_b16 a[204:205], v14 offset:40960
ds_read_b64_tr_b16 a[206:207], v14 offset:42496
s_cmp_eq_u32 s24, 1
s_cselect_b32 s25, s32, s25
s_cselect_b32 s27, s34, s27
s_cselect_b32 s28, s33, s28
s_cselect_b32 s56, s56, -1
M a[108:111], a[188:191], a[236:239], a[108:111]
M a[112:115], a[196:199], a[236:239], a[112:115]
s_add_u32 s58, s56, 16384
s_add_u32 s59, s57, 16384
M a[112:115], a[192:195], a[232:235], a[112:115]
s_waitcnt lgkmcnt(10)
M a[116:119], a[176:179], a[240:243], a[116:119]
ds_read_b128 a[232:235], v10 offset:32768
ds_read_b128 a[236:239], v11 offset:32768
s_add_u32 s26, s25, 16384
s_add_u32 s62, s27, 16384
M a[116:119], a[180:183], a[244:247], a[116:119]
buffer_load_dwordx4 a[60:63], v1, s[44:47], s64 offen offset:3072 sc1
M a[120:123], a[188:191], a[244:247], a[120:123]
ds_read_b64_tr_b16 a[212:213], v15 offset:40960
ds_read_b64_tr_b16 a[214:215], v15 offset:42496
s_add_u32 s63, s28, 16384
s_lshl_b32 s31, s21, 7
M a[120:123], a[184:187], a[240:243], a[120:123]
M a[124:127], a[192:195], a[240:243], a[124:127]
s_cmp_eq_u32 s24, 0
s_cselect_b32 s31, s31, 960
M a[124:127], a[196:199], a[244:247], a[124:127]
s_waitcnt lgkmcnt(10)
M a[128:131], a[180:183], a[252:255], a[128:131]
ds_read_b128 a[240:243], v10 offset:34816
ds_read_b128 a[244:247], v11 offset:34816
s_mov_b32 s60, 0
s_add_u32 s12, s4, 16777216
s_addc_u32 s13, s5, 0
M a[128:131], a[176:179], a[248:251], a[128:131]
M a[132:135], a[184:187], a[248:251], a[132:135]
ds_read_b64_tr_b16 a[220:221], v16 offset:40960
ds_read_b64_tr_b16 a[222:223], v16 offset:42496
s_mov_b32 s14, 33554432
s_mov_b32 s15, 0x00020000
M a[132:135], a[188:191], a[252:255], a[132:135]
buffer_load_dword v126, v119, s[36:39], 0 offen offset:128 sc1
M a[136:139], a[196:199], a[252:255], a[136:139]
s_mov_b32 s8, s4
s_mov_b32 s9, s5
M a[136:139], a[192:195], a[248:251], a[136:139]
s_waitcnt lgkmcnt(10)
M a[140:143], a[176:179], a[224:227], a[140:143]
s_mov_b32 s10, 16777216
s_mov_b32 s11, 0x00020000
M a[140:143], a[180:183], a[228:231], a[140:143]
M a[144:147], a[188:191], a[228:231], a[144:147]
M a[144:147], a[184:187], a[224:227], a[144:147]
M a[148:151], a[192:195], a[224:227], a[148:151]
s_waitcnt vmcnt(17) lgkmcnt(0)
s_barrier
ds_read_b128 a[248:251], v12 offset:0
ds_read_b128 a[252:255], v13 offset:0
s_waitcnt vmcnt(0)
v_cmp_gt_u32 vcc, 0x80, v126
s_nop 0
s_cbranch_vccnz Lk1_spin
Lk1_got:
M a[148:151], a[196:199], a[228:231], a[148:151]
s_add_u32 m0, s29, 65536
s_add_u32 s32, s25, 4096
buffer_load_dwordx4 v1, s[12:15], s25 offen offset:0 sc1 lds
M a[152:155], a[180:183], a[236:239], a[152:155]
ds_read_b128 a[224:227], v12 offset:2048
ds_read_b128 a[228:231], v13 offset:2048
M a[152:155], a[176:179], a[232:235], a[152:155]
buffer_load_dwordx4 v1, s[12:15], s25 offen offset:1024 sc1 lds
M a[156:159], a[184:187], a[232:235], a[156:159]
M a[156:159], a[188:191], a[236:239], a[156:159]
buffer_load_dwordx4 v1, s[12:15], s25 offen offset:2048 sc1 lds
M a[160:163], a[196:199], a[236:239], a[160:163]
buffer_load_dwordx4 v1, s[12:15], s25 offen offset:3072 sc1 lds
M a[160:163], a[192:195], a[232:235], a[160:163]
M a[164:167], a[176:179], a[240:243], a[164:167]
ds_read_b128 a[232:235], v12 offset:4096
ds_read_b128 a[236:239], v13 offset:4096
M a[164:167], a[180:183], a[244:247], a[164:167]
s_add_u32 m0, s29, 69632
s_nop 0
buffer_load_dwordx4 v1, s[12:15], s32 offen offset:0 sc1 lds
M a[168:171], a[188:191], a[244:247], a[168:171]
buffer_load_dwordx4 v1, s[12:15], s32 offen offset:1024 sc1 lds
M a[168:171], a[184:187], a[240:243], a[168:171]
M a[172:175], a[192:195], a[240:243], a[172:175]
buffer_load_dwordx4 v1, s[12:15], s32 offen offset:2048 sc1 lds
M a[172:175], a[196:199], a[244:247], a[172:175]
s_waitcnt lgkmcnt(4)
M a[68:71], a[200:203], a[248:251], a[68:71]
ds_read_b128 a[240:243], v12 offset:6144
ds_read_b128 a[244:247], v13 offset:6144
M a[68:71], a[204:207], a[252:255], a[68:71]
buffer_load_dwordx4 v1, s[12:15], s32 offen offset:3072 sc1 lds
M a[72:75], a[212:215], a[252:255], a[72:75]
M a[72:75], a[208:211], a[248:251], a[72:75]
M a[76:79], a[216:219], a[248:251], a[76:79]
M a[76:79], a[220:223], a[252:255], a[76:79]
s_waitcnt lgkmcnt(4)
M a[80:83], a[204:207], a[228:231], a[80:83]
ds_read_b128 a[248:251], v12 offset:8192
ds_read_b128 a[252:255], v13 offset:8192
M a[80:83], a[200:203], a[224:227], a[80:83]
M a[84:87], a[208:211], a[224:227], a[84:87]
M a[84:87], a[212:215], a[228:231], a[84:87]
M a[88:91], a[220:223], a[228:231], a[88:91]
M a[88:91], a[216:219], a[224:227], a[88:91]
s_waitcnt lgkmcnt(4)
M a[92:95], a[200:203], a[232:235], a[92:95]
ds_read_b128 a[224:227], v12 offset:10240
ds_read_b128 a[228:231], v13 offset:10240
v_accvgpr_read_b32 v24, a68
v_accvgpr_read_b32 v25, a69
v_accvgpr_read_b32 v26, a70
M a[92:95], a[204:207], a[236:239], a[92:95]
v_accvgpr_read_b32 v27, a71
v_cvt_pk_bf16_f32 v24, v24, v25
v_cvt_pk_bf16_f32 v25, v26, v27
ds_write_b64 v124, v[24:25] offset:0
M a[96:99], a[212:215], a[236:239], a[96:99]
v_accvgpr_read_b32 v28, a72
v_accvgpr_read_b32 v29, a73
v_accvgpr_read_b32 v30, a74
M a[96:99], a[208:211], a[232:235], a[96:99]
v_accvgpr_read_b32 v31, a75
v_cvt_pk_bf16_f32 v28, v28, v29
v_cvt_pk_bf16_f32 v29, v30, v31
ds_write_b64 v124, v[28:29] offset:32
M a[100:103], a[216:219], a[232:235], a[100:103]
v_accvgpr_read_b32 v24, a76
v_accvgpr_read_b32 v25, a77
v_accvgpr_read_b32 v26, a78
M a[100:103], a[220:223], a[236:239], a[100:103]
s_waitcnt lgkmcnt(6)
v_accvgpr_read_b32 v27, a79
v_cvt_pk_bf16_f32 v24, v24, v25
v_cvt_pk_bf16_f32 v25, v26, v27
ds_write_b64 v124, v[24:25] offset:64
M a[104:107], a[204:207], a[244:247], a[104:107]
ds_read_b128 a[232:235], v12 offset:12288
ds_read_b128 a[236:239], v13 offset:12288
v_accvgpr_read_b32 v24, a80
v_accvgpr_read_b32 v25, a81
v_accvgpr_read_b32 v26, a82
M a[104:107], a[200:203], a[240:243], a[104:107]
v_accvgpr_read_b32 v27, a83
v_cvt_pk_bf16_f32 v24, v24, v25
v_cvt_pk_bf16_f32 v25, v26, v27
ds_write_b64 v124, v[24:25] offset:6400
M a[108:111], a[208:211], a[240:243], a[108:111]
v_accvgpr_read_b32 v28, a84
v_accvgpr_read_b32 v29, a85
v_accvgpr_read_b32 v30, a86
M a[108:111], a[212:215], a[244:247], a[108:111]
v_accvgpr_read_b32 v31, a87
v_cvt_pk_bf16_f32 v28, v28, v29
v_cvt_pk_bf16_f32 v29, v30, v31
ds_write_b64 v124, v[28:29] offset:6432
M a[112:115], a[220:223], a[244:247], a[112:115]
v_accvgpr_read_b32 v24, a88
v_accvgpr_read_b32 v25, a89
v_accvgpr_read_b32 v26, a90
M a[112:115], a[216:219], a[240:243], a[112:115]
s_waitcnt lgkmcnt(9)
v_accvgpr_read_b32 v27, a91
v_cvt_pk_bf16_f32 v24, v24, v25
v_cvt_pk_bf16_f32 v25, v26, v27
ds_write_b64 v124, v[24:25] offset:6464
M a[116:119], a[200:203], a[248:251], a[116:119]
ds_read_b128 a[240:243], v12 offset:14336
ds_read_b128 a[244:247], v13 offset:14336
v_accvgpr_read_b32 v24, a92
v_accvgpr_read_b32 v25, a93
v_accvgpr_read_b32 v26, a94
M a[116:119], a[204:207], a[252:255], a[116:119]
v_accvgpr_read_b32 v27, a95
v_cvt_pk_bf16_f32 v24, v24, v25
v_cvt_pk_bf16_f32 v25, v26, v27
ds_write_b64 v124, v[24:25] offset:12800
M a[120:123], a[212:215], a[252:255], a[120:123]
v_accvgpr_read_b32 v28, a96
v_accvgpr_read_b32 v29, a97
v_accvgpr_read_b32 v30, a98
M a[120:123], a[208:211], a[248:251], a[120:123]
v_accvgpr_read_b32 v31, a99
v_cvt_pk_bf16_f32 v28, v28, v29
v_cvt_pk_bf16_f32 v29, v30, v31
ds_write_b64 v124, v[28:29] offset:12832
M a[124:127], a[216:219], a[248:251], a[124:127]
v_accvgpr_read_b32 v24, a100
v_accvgpr_read_b32 v25, a101
v_accvgpr_read_b32 v26, a102
M a[124:127], a[220:223], a[252:255], a[124:127]
s_add_u32 s25, s25, 32768
s_cmp_eq_u32 s25, s27
s_cselect_b32 s25, s28, s25
s_cselect_b32 s27, s56, s27
s_cselect_b32 s28, s57, s28
s_cselect_b32 s56, -1, s56
s_waitcnt lgkmcnt(12)
v_accvgpr_read_b32 v27, a103
v_cvt_pk_bf16_f32 v24, v24, v25
v_cvt_pk_bf16_f32 v25, v26, v27
ds_write_b64 v124, v[24:25] offset:12864
M a[128:131], a[204:207], a[228:231], a[128:131]
ds_read_b128 a[248:251], v12 offset:16384
ds_read_b128 a[252:255], v13 offset:16384
v_accvgpr_read_b32 v24, a104
v_accvgpr_read_b32 v25, a105
v_accvgpr_read_b32 v26, a106
M a[128:131], a[200:203], a[224:227], a[128:131]
v_accvgpr_read_b32 v27, a107
v_cvt_pk_bf16_f32 v24, v24, v25
v_cvt_pk_bf16_f32 v25, v26, v27
ds_write_b64 v124, v[24:25] offset:19200
M a[132:135], a[208:211], a[224:227], a[132:135]
v_accvgpr_read_b32 v28, a108
v_accvgpr_read_b32 v29, a109
v_accvgpr_read_b32 v30, a110
M a[132:135], a[212:215], a[228:231], a[132:135]
v_accvgpr_read_b32 v31, a111
v_cvt_pk_bf16_f32 v28, v28, v29
v_cvt_pk_bf16_f32 v29, v30, v31
ds_write_b64 v124, v[28:29] offset:19232
M a[136:139], a[220:223], a[228:231], a[136:139]
v_accvgpr_read_b32 v24, a112
v_accvgpr_read_b32 v25, a113
v_accvgpr_read_b32 v26, a114
M a[136:139], a[216:219], a[224:227], a[136:139]
s_waitcnt lgkmcnt(12)
v_accvgpr_read_b32 v27, a115
v_cvt_pk_bf16_f32 v24, v24, v25
v_cvt_pk_bf16_f32 v25, v26, v27
ds_write_b64 v124, v[24:25] offset:19264
M a[140:143], a[200:203], a[232:235], a[140:143]
v_accvgpr_read_b32 v24, a116
v_accvgpr_read_b32 v25, a117
v_accvgpr_read_b32 v26, a118
M a[140:143], a[204:207], a[236:239], a[140:143]
v_accvgpr_read_b32 v27, a119
v_cvt_pk_bf16_f32 v24, v24, v25
v_cvt_pk_bf16_f32 v25, v26, v27
ds_write_b64 v124, v[24:25] offset:25600
M a[144:147], a[212:215], a[236:239], a[144:147]
v_accvgpr_read_b32 v28, a120
v_accvgpr_read_b32 v29, a121
v_accvgpr_read_b32 v30, a122
M a[144:147], a[208:211], a[232:235], a[144:147]
v_accvgpr_read_b32 v31, a123
v_cvt_pk_bf16_f32 v28, v28, v29
v_cvt_pk_bf16_f32 v29, v30, v31
ds_write_b64 v124, v[28:29] offset:25632
M a[148:151], a[216:219], a[232:235], a[148:151]
s_waitcnt lgkmcnt(0)
s_barrier
v_accvgpr_read_b32 v24, a124
v_accvgpr_read_b32 v25, a125
v_accvgpr_read_b32 v26, a126
M a[148:151], a[220:223], a[236:239], a[148:151]
v_accvgpr_read_b32 v27, a127
v_cvt_pk_bf16_f32 v24, v24, v25
v_cvt_pk_bf16_f32 v25, v26, v27
ds_write_b64 v124, v[24:25] offset:25664
v_accvgpr_read_b32 v24, a128
v_accvgpr_read_b32 v25, a129
v_accvgpr_read_b32 v26, a130
M a[152:155], a[204:207], a[244:247], a[152:155]
v_accvgpr_read_b32 v27, a131
v_cvt_pk_bf16_f32 v24, v24, v25
v_cvt_pk_bf16_f32 v25, v26, v27
M a[152:155], a[200:203], a[240:243], a[152:155]
ds_write_b64 v124, v[24:25] offset:32000
v_accvgpr_read_b32 v28, a132
v_accvgpr_read_b32 v29, a133
M a[156:159], a[208:211], a[240:243], a[156:159]
v_accvgpr_read_b32 v30, a134
v_accvgpr_read_b32 v31, a135
v_cvt_pk_bf16_f32 v28, v28, v29
M a[156:159], a[212:215], a[244:247], a[156:159]
v_cvt_pk_bf16_f32 v29, v30, v31
ds_write_b64 v124, v[28:29] offset:32032
v_accvgpr_read_b32 v24, a136
M a[160:163], a[220:223], a[244:247], a[160:163]
v_accvgpr_read_b32 v25, a137
v_accvgpr_read_b32 v26, a138
v_accvgpr_read_b32 v27, a139
M a[160:163], a[216:219], a[240:243], a[160:163]
v_cvt_pk_bf16_f32 v24, v24, v25
v_cvt_pk_bf16_f32 v25, v26, v27
ds_write_b64 v124, v[24:25] offset:32064
M a[164:167], a[200:203], a[248:251], a[164:167]
v_accvgpr_read_b32 v24, a140
v_accvgpr_read_b32 v25, a141
v_accvgpr_read_b32 v26, a142
M a[164:167], a[204:207], a[252:255], a[164:167]
v_accvgpr_read_b32 v27, a143
v_cvt_pk_bf16_f32 v24, v24, v25
v_cvt_pk_bf16_f32 v25, v26, v27
ds_write_b64 v124, v[24:25] offset:38400
M a[168:171], a[212:215], a[252:255], a[168:171]
v_accvgpr_read_b32 v28, a144
v_accvgpr_read_b32 v29, a145
v_accvgpr_read_b32 v30, a146
M a[168:171], a[208:211], a[248:251], a[168:171]
v_accvgpr_read_b32 v31, a147
v_cvt_pk_bf16_f32 v28, v28, v29
v_cvt_pk_bf16_f32 v29, v30, v31
ds_write_b64 v124, v[28:29] offset:38432
M a[172:175], a[216:219], a[248:251], a[172:175]
v_accvgpr_read_b32 v24, a148
v_accvgpr_read_b32 v25, a149
v_accvgpr_read_b32 v26, a150
M a[172:175], a[220:223], a[252:255], a[172:175]
v_accvgpr_read_b32 v27, a151
v_cvt_pk_bf16_f32 v24, v24, v25
v_cvt_pk_bf16_f32 v25, v26, v27
ds_write_b64 v124, v[24:25] offset:38464
s_mov_b64 s[44:45], s[42:43]
v_accvgpr_read_b32 v24, a152
v_accvgpr_read_b32 v25, a153
v_accvgpr_read_b32 v26, a154
v_accvgpr_read_b32 v27, a155
v_cvt_pk_bf16_f32 v24, v24, v25
v_cvt_pk_bf16_f32 v25, v26, v27
ds_write_b64 v124, v[24:25] offset:44800
v_accvgpr_read_b32 v28, a156
v_accvgpr_read_b32 v29, a157
v_accvgpr_read_b32 v30, a158
v_accvgpr_read_b32 v31, a159
v_cvt_pk_bf16_f32 v28, v28, v29
v_cvt_pk_bf16_f32 v29, v30, v31
ds_write_b64 v124, v[28:29] offset:44832
v_accvgpr_read_b32 v24, a160
v_accvgpr_read_b32 v25, a161
v_accvgpr_read_b32 v26, a162
v_accvgpr_read_b32 v27, a163
v_cvt_pk_bf16_f32 v24, v24, v25
v_cvt_pk_bf16_f32 v25, v26, v27
ds_write_b64 v124, v[24:25] offset:44864
v_accvgpr_read_b32 v24, a164
v_accvgpr_read_b32 v25, a165
v_accvgpr_read_b32 v26, a166
v_accvgpr_read_b32 v27, a167
v_cvt_pk_bf16_f32 v24, v24, v25
v_cvt_pk_bf16_f32 v25, v26, v27
ds_write_b64 v124, v[24:25] offset:51200
v_accvgpr_read_b32 v28, a168
v_accvgpr_read_b32 v29, a169
v_accvgpr_read_b32 v30, a170
v_accvgpr_read_b32 v31, a171
v_cvt_pk_bf16_f32 v28, v28, v29
v_cvt_pk_bf16_f32 v29, v30, v31
ds_write_b64 v124, v[28:29] offset:51232
v_accvgpr_read_b32 v24, a172
v_accvgpr_read_b32 v25, a173
v_accvgpr_read_b32 v26, a174
v_accvgpr_read_b32 v27, a175
v_cvt_pk_bf16_f32 v24, v24, v25
v_cvt_pk_bf16_f32 v25, v26, v27
ds_write_b64 v124, v[24:25] offset:51264
s_waitcnt lgkmcnt(0)
s_barrier
ds_read_b128 v[48:51], v121 offset:128
ds_read_b128 v[32:35], v120 offset:0
ds_read_b128 v[52:55], v120 offset:128
ds_read_b128 v[36:39], v120 offset:12800
ds_read_b128 v[56:59], v120 offset:12928
ds_read_b128 v[40:43], v120 offset:25600
ds_read_b128 v[60:63], v120 offset:25728
ds_read_b128 v[44:47], v120 offset:38400
ds_read_b128 v[64:67], v120 offset:38528
ds_read_b64_tr_b16 v[68:69], v123 offset:256
ds_read_b64_tr_b16 v[70:71], v122 offset:256
ds_read_b64_tr_b16 v[72:73], v122 offset:13056
ds_read_b64_tr_b16 v[74:75], v122 offset:25856
ds_read_b64_tr_b16 v[76:77], v122 offset:38656
ds_read_b64_tr_b16 v[78:79], v123 offset:288
ds_read_b64_tr_b16 v[80:81], v122 offset:288
ds_read_b64_tr_b16 v[82:83], v122 offset:13088
ds_read_b64_tr_b16 v[84:85], v122 offset:25888
ds_read_b64_tr_b16 v[86:87], v122 offset:38688
v_accvgpr_write_b32 a64, 0
v_accvgpr_write_b32 a65, 0
v_accvgpr_write_b32 a66, 0
v_accvgpr_write_b32 a67, 0
v_accvgpr_write_b32 a68, 0
v_accvgpr_write_b32 a69, 0
v_accvgpr_write_b32 a70, 0
v_accvgpr_write_b32 a71, 0
v_accvgpr_write_b32 a72, 0
v_accvgpr_write_b32 a73, 0
v_accvgpr_write_b32 a74, 0
v_accvgpr_write_b32 a75, 0
s_add_u32 m0, s29, 0
s_add_u32 s32, s25, 4096
buffer_load_dwordx4 v1, s[12:15], s25 offen offset:0 sc1 lds
v_accvgpr_write_b32 a76, 0
v_accvgpr_write_b32 a77, 0
v_accvgpr_write_b32 a78, 0
v_accvgpr_write_b32 a79, 0
v_accvgpr_write_b32 a80, 0
v_accvgpr_write_b32 a81, 0
v_accvgpr_write_b32 a82, 0
v_accvgpr_write_b32 a83, 0
v_accvgpr_write_b32 a84, 0
v_accvgpr_write_b32 a85, 0
v_accvgpr_write_b32 a86, 0
buffer_load_dwordx4 v1, s[12:15], s25 offen offset:1024 sc1 lds
v_accvgpr_write_b32 a87, 0
v_accvgpr_write_b32 a88, 0
v_accvgpr_write_b32 a89, 0
v_accvgpr_write_b32 a90, 0
v_accvgpr_write_b32 a91, 0
v_accvgpr_write_b32 a92, 0
v_accvgpr_write_b32 a93, 0
v_accvgpr_write_b32 a94, 0
v_accvgpr_write_b32 a95, 0
v_accvgpr_write_b32 a96, 0
buffer_load_dwordx4 v1, s[12:15], s25 offen offset:2048 sc1 lds
v_accvgpr_write_b32 a97, 0
v_accvgpr_write_b32 a98, 0
v_accvgpr_write_b32 a99, 0
v_accvgpr_write_b32 a100, 0
v_accvgpr_write_b32 a101, 0
v_accvgpr_write_b32 a102, 0
v_accvgpr_write_b32 a103, 0
v_accvgpr_write_b32 a104, 0
v_accvgpr_write_b32 a105, 0
v_accvgpr_write_b32 a106, 0
v_accvgpr_write_b32 a107, 0
buffer_load_dwordx4 v1, s[12:15], s25 offen offset:3072 sc1 lds
v_accvgpr_write_b32 a108, 0
v_accvgpr_write_b32 a109, 0
v_accvgpr_write_b32 a110, 0
v_accvgpr_write_b32 a111, 0
s_waitcnt lgkmcnt(15)
M v[88:91], v[48:51], v[32:35], v[152:155]
M v[92:95], v[52:55], v[32:35], v[148:151]
M v[96:99], v[52:55], v[36:39], v[144:147]
s_waitcnt lgkmcnt(14)
M v[100:103], v[56:59], v[36:39], v[148:151]
s_waitcnt lgkmcnt(13)
M v[104:107], v[56:59], v[40:43], v[144:147]
s_waitcnt lgkmcnt(12)
M v[108:111], v[60:63], v[40:43], v[148:151]
s_add_u32 m0, s29, 4096
s_nop 0
buffer_load_dwordx4 v1, s[12:15], s32 offen offset:0 sc1 lds
s_waitcnt lgkmcnt(11)
M v[112:115], v[60:63], v[44:47], v[144:147]
s_waitcnt lgkmcnt(10)
M v[116:119], v[64:67], v[44:47], v[148:151]
v_max3_f32 v136, v88, v89, v90
v_max3_f32 v136, v136, v91, v92
v_max3_f32 v136, v136, v93, v94
v_max_f32 v136, v136, v95
v_max3_f32 v137, v96, v97, v98
v_max3_f32 v137, v137, v99, v100
v_max3_f32 v137, v137, v101, v102
v_max_f32 v137, v137, v103
v_max3_f32 v138, v104, v105, v106
buffer_load_dwordx4 v1, s[12:15], s32 offen offset:1024 sc1 lds
v_max3_f32 v138, v138, v107, v108
v_max3_f32 v138, v138, v109, v110
v_max_f32 v138, v138, v111
v_max3_f32 v139, v112, v113, v114
v_max3_f32 v139, v139, v115, v116
v_max3_f32 v139, v139, v117, v118
v_max_f32 v139, v139, v119
v_mov_b32 v140, v136
v_mov_b32 v141, v137
v_mov_b32 v142, v138
buffer_load_dwordx4 v1, s[12:15], s32 offen offset:2048 sc1 lds
v_mov_b32 v143, v139
v_permlane16_swap_b32 v136, v140
v_permlane16_swap_b32 v137, v141
v_permlane16_swap_b32 v138, v142
v_permlane16_swap_b32 v139, v143
v_max_f32 v136, v136, v140
v_max_f32 v137, v137, v141
v_max_f32 v138, v138, v142
v_max_f32 v139, v139, v143
v_mov_b32 v140, v136
v_mov_b32 v141, v137
buffer_load_dwordx4 v1, s[12:15], s32 offen offset:3072 sc1 lds
v_mov_b32 v142, v138
v_mov_b32 v143, v139
v_permlane32_swap_b32 v136, v140
v_permlane32_swap_b32 v137, v141
v_permlane32_swap_b32 v138, v142
v_permlane32_swap_b32 v139, v143
v_max_f32 v136, v136, v140
v_max_f32 v137, v137, v141
v_max_f32 v138, v138, v142
v_max_f32 v139, v139, v143
s_add_u32 s25, s25, 32768
s_cmp_eq_u32 s25, s27
s_cselect_b32 s25, s28, s25
s_cselect_b32 s27, s56, s27
s_cselect_b32 s28, s57, s28
s_cselect_b32 s56, -1, s56
v_mul_f32 v136, s7, v136
v_mul_f32 v137, s7, v137
v_mul_f32 v138, s7, v138
v_mul_f32 v139, s7, v139
v_fma_f32 v88, v88, s7, -v136
v_fma_f32 v89, v89, s7, -v136
v_fma_f32 v90, v90, s7, -v136
v_fma_f32 v91, v91, s7, -v136
v_fma_f32 v92, v92, s7, -v136
v_fma_f32 v93, v93, s7, -v136
v_fma_f32 v94, v94, s7, -v136
s_add_u32 m0, s29, 32768
s_add_u32 s32, s26, 4096
buffer_load_dwordx4 v1, s[12:15], s26 offen offset:0 sc1 lds
v_fma_f32 v95, v95, s7, -v136
v_exp_f32 v88, v88
v_exp_f32 v89, v89
v_exp_f32 v90, v90
v_exp_f32 v91, v91
v_exp_f32 v92, v92
v_exp_f32 v93, v93
v_exp_f32 v94, v94
v_exp_f32 v95, v95
v_fma_f32 v96, v96, s7, -v137
v_fma_f32 v97, v97, s7, -v137
buffer_load_dwordx4 v1, s[12:15], s26 offen offset:1024 sc1 lds
v_fma_f32 v98, v98, s7, -v137
v_fma_f32 v99, v99, s7, -v137
v_fma_f32 v100, v100, s7, -v137
v_fma_f32 v101, v101, s7, -v137
v_fma_f32 v102, v102, s7, -v137
v_fma_f32 v103, v103, s7, -v137
v_exp_f32 v96, v96
v_exp_f32 v97, v97
v_exp_f32 v98, v98
v_exp_f32 v99, v99
buffer_load_dwordx4 v1, s[12:15], s26 offen offset:2048 sc1 lds
v_exp_f32 v100, v100
v_exp_f32 v101, v101
v_exp_f32 v102, v102
v_exp_f32 v103, v103
v_fma_f32 v104, v104, s7, -v138
v_fma_f32 v105, v105, s7, -v138
v_fma_f32 v106, v106, s7, -v138
v_fma_f32 v107, v107, s7, -v138
v_fma_f32 v108, v108, s7, -v138
v_fma_f32 v109, v109, s7, -v138
v_fma_f32 v110, v110, s7, -v138
buffer_load_dwordx4 v1, s[12:15], s26 offen offset:3072 sc1 lds
v_fma_f32 v111, v111, s7, -v138
v_exp_f32 v104, v104
v_exp_f32 v105, v105
v_exp_f32 v106, v106
v_exp_f32 v107, v107
v_exp_f32 v108, v108
v_exp_f32 v109, v109
v_exp_f32 v110, v110
v_exp_f32 v111, v111
v_fma_f32 v112, v112, s7, -v139
s_add_u32 m0, s29, 36864
s_nop 0
buffer_load_dwordx4 v1, s[12:15], s32 offen offset:0 sc1 lds
v_fma_f32 v113, v113, s7, -v139
v_fma_f32 v114, v114, s7, -v139
v_fma_f32 v115, v115, s7, -v139
v_fma_f32 v116, v116, s7, -v139
v_fma_f32 v117, v117, s7, -v139
v_fma_f32 v118, v118, s7, -v139
v_fma_f32 v119, v119, s7, -v139
v_exp_f32 v112, v112
v_exp_f32 v113, v113
v_exp_f32 v114, v114
v_exp_f32 v115, v115
buffer_load_dwordx4 v1, s[12:15], s32 offen offset:1024 sc1 lds
v_exp_f32 v116, v116
v_exp_f32 v117, v117
v_exp_f32 v118, v118
v_exp_f32 v119, v119
v_cvt_pk_bf16_f32 v88, v88, v89
v_cvt_pk_bf16_f32 v89, v90, v91
v_cvt_pk_bf16_f32 v90, v92, v93
v_cvt_pk_bf16_f32 v91, v94, v95
v_cvt_pk_bf16_f32 v96, v96, v97
v_cvt_pk_bf16_f32 v97, v98, v99
buffer_load_dwordx4 v1, s[12:15], s32 offen offset:2048 sc1 lds
v_cvt_pk_bf16_f32 v98, v100, v101
v_cvt_pk_bf16_f32 v99, v102, v103
v_cvt_pk_bf16_f32 v104, v104, v105
v_cvt_pk_bf16_f32 v105, v106, v107
v_cvt_pk_bf16_f32 v106, v108, v109
v_cvt_pk_bf16_f32 v107, v110, v111
v_cvt_pk_bf16_f32 v112, v112, v113
v_cvt_pk_bf16_f32 v113, v114, v115
v_cvt_pk_bf16_f32 v114, v116, v117
v_cvt_pk_bf16_f32 v115, v118, v119
M v[120:123], v[156:159], v[88:91], 0
buffer_load_dwordx4 v1, s[12:15], s32 offen offset:3072 sc1 lds
s_waitcnt lgkmcnt(8)
M v[32:35], v[68:71], v[88:91], 0
s_waitcnt lgkmcnt(3)
M v[36:39], v[78:81], v[88:91], 0
M v[124:127], v[156:159], v[96:99], 0
M v[40:43], v[70:73], v[96:99], 0
s_waitcnt lgkmcnt(2)
M v[44:47], v[80:83], v[96:99], 0
M v[128:131], v[156:159], v[104:107], 0
M v[48:51], v[72:75], v[104:107], 0
s_waitcnt lgkmcnt(1)
M v[52:55], v[82:85], v[104:107], 0
M v[132:135], v[156:159], v[112:115], 0
M v[56:59], v[74:77], v[112:115], 0
s_add_u32 s26, s26, 32768
s_cmp_eq_u32 s26, s62
s_cselect_b32 s26, s63, s26
s_cselect_b32 s62, s58, s62
s_cselect_b32 s63, s59, s63
s_cselect_b32 s58, -1, s58
s_waitcnt lgkmcnt(0)
M v[60:63], v[84:87], v[112:115], 0
v_rcp_f32 v120, v120
v_rcp_f32 v124, v124
v_rcp_f32 v128, v128
v_rcp_f32 v132, v132
v_pk_mul_f32 v[32:33], v[32:33], v[120:121] op_sel_hi:[1,0]
v_pk_mul_f32 v[34:35], v[34:35], v[120:121] op_sel_hi:[1,0]
v_pk_mul_f32 v[36:37], v[36:37], v[120:121] op_sel_hi:[1,0]
v_pk_mul_f32 v[38:39], v[38:39], v[120:121] op_sel_hi:[1,0]
v_cvt_pk_bf16_f32 v32, v32, v33
v_cvt_pk_bf16_f32 v33, v34, v35
v_cvt_pk_bf16_f32 v34, v36, v37
v_cvt_pk_bf16_f32 v35, v38, v39
s_add_u32 s3, s6, 0
buffer_store_dwordx4 v[32:35], v1, s[16:19], s3 offen sc1
v_pk_mul_f32 v[40:41], v[40:41], v[124:125] op_sel_hi:[1,0]
v_pk_mul_f32 v[42:43], v[42:43], v[124:125] op_sel_hi:[1,0]
v_pk_mul_f32 v[44:45], v[44:45], v[124:125] op_sel_hi:[1,0]
v_pk_mul_f32 v[46:47], v[46:47], v[124:125] op_sel_hi:[1,0]
v_cvt_pk_bf16_f32 v40, v40, v41
v_cvt_pk_bf16_f32 v41, v42, v43
v_cvt_pk_bf16_f32 v42, v44, v45
v_cvt_pk_bf16_f32 v43, v46, v47
s_add_u32 s3, s6, 2048
buffer_store_dwordx4 v[40:43], v1, s[16:19], s3 offen sc1
v_pk_mul_f32 v[48:49], v[48:49], v[128:129] op_sel_hi:[1,0]
v_pk_mul_f32 v[50:51], v[50:51], v[128:129] op_sel_hi:[1,0]
v_pk_mul_f32 v[52:53], v[52:53], v[128:129] op_sel_hi:[1,0]
v_pk_mul_f32 v[54:55], v[54:55], v[128:129] op_sel_hi:[1,0]
v_cvt_pk_bf16_f32 v48, v48, v49
v_cvt_pk_bf16_f32 v49, v50, v51
v_cvt_pk_bf16_f32 v50, v52, v53
v_cvt_pk_bf16_f32 v51, v54, v55
s_add_u32 s3, s6, 4096
buffer_store_dwordx4 v[48:51], v1, s[16:19], s3 offen sc1
v_pk_mul_f32 v[56:57], v[56:57], v[132:133] op_sel_hi:[1,0]
v_pk_mul_f32 v[58:59], v[58:59], v[132:133] op_sel_hi:[1,0]
v_pk_mul_f32 v[60:61], v[60:61], v[132:133] op_sel_hi:[1,0]
v_pk_mul_f32 v[62:63], v[62:63], v[132:133] op_sel_hi:[1,0]
v_cvt_pk_bf16_f32 v56, v56, v57
v_cvt_pk_bf16_f32 v57, v58, v59
v_cvt_pk_bf16_f32 v58, v60, v61
v_cvt_pk_bf16_f32 v59, v62, v63
s_add_u32 s3, s6, 6144
buffer_store_dwordx4 v[56:59], v1, s[16:19], s3 offen sc1
Lc2:
s_add_u32 s16, s4, 67108864
s_addc_u32 s17, s5, 0
s_mov_b32 s18, 16777216
s_mov_b32 s19, 0x00020000
s_add_u32 s52, s4, 100663296
s_addc_u32 s53, s5, 0
s_mov_b32 s54, 16793600
s_mov_b32 s55, 0x00020000
s_mov_b32 s46, 8388608
s_mov_b32 s47, 0x00020000
s_mov_b32 s50, 2097152
s_mov_b32 s51, 0x00020000
s_lshl_b32 s33, s24, 14
v_add_u32 v2, 0, v1
v_add_u32 v3, 0x10000, v2
v_mov_b32 v5, v2
v_mov_b32 v6, v3
v_and_b32 v8, 15, v0
v_bfe_u32 v9, v0, 4, 2
v_lshlrev_b32 v9, 2, v9
v_sub_u32 v8, v8, v9
v_mov_b32 v4, 0xf149f2ca
v_cmp_gt_i32 vcc, 0, v8
s_nop 1
v_cndmask_b32 v16, 0, v4, vcc
v_cmp_gt_i32 vcc, 1, v8
s_nop 1
v_cndmask_b32 v17, 0, v4, vcc
v_cmp_gt_i32 vcc, 2, v8
s_nop 1
v_cndmask_b32 v18, 0, v4, vcc
v_cmp_gt_i32 vcc, 3, v8
s_nop 1
v_cndmask_b32 v19, 0, v4, vcc
v_mov_b32 v8, 0x3f803f80
v_accvgpr_write_b32 a112, v8
v_accvgpr_write_b32 a113, v8
v_accvgpr_write_b32 a114, v8
v_accvgpr_write_b32 a115, v8
s_lshl_b32 s33, s23, 6
s_add_i32 s33, s33, s31
s_cmp_gt_i32 s33, 0
s_cselect_b32 s34, 0, 0xf149f2ca
s_cmp_lt_i32 s33, 0
s_cselect_b32 s33, 0xf149f2ca, 0
v_mov_b32 v20, s34
v_mov_b32 v21, s34
v_mov_b32 v22, s34
v_mov_b32 v23, s34
v_mov_b32 v28, s33
v_mov_b32 v29, s33
v_mov_b32 v30, s33
v_mov_b32 v31, s33
v_med3_f32 v24, v16, v20, v28
v_med3_f32 v25, v17, v20, v28
v_med3_f32 v26, v18, v20, v28
v_med3_f32 v27, v19, v20, v28
v_mov_b32 v12, 0
v_mov_b32 v13, 1
s_waitcnt vmcnt(20)
s_barrier
ds_read_b128 a[116:119], v3 offset:0
ds_read_b128 a[120:123], v3 offset:1024
ds_read_b128 a[124:127], v3 offset:2048
ds_read_b128 a[128:131], v3 offset:3072
ds_read_b128 a[132:135], v3 offset:4096
ds_read_b128 a[136:139], v3 offset:5120
ds_read_b128 a[140:143], v3 offset:6144
ds_read_b128 a[144:147], v3 offset:7168
s_waitcnt lgkmcnt(4)
M v[32:35], a[116:119], a[0:3], v[24:27]
M v[32:35], a[120:123], a[4:7], v[32:35]
ds_read_b128 a[148:151], v3 offset:8192
ds_read_b128 a[152:155], v3 offset:9216
M v[32:35], a[124:127], a[8:11], v[32:35]
M v[32:35], a[128:131], a[12:15], v[32:35]
M v[36:39], a[128:131], a[28:31], v[28:31]
M v[36:39], a[124:127], a[24:27], v[36:39]
M v[36:39], a[120:123], a[20:23], v[36:39]
M v[36:39], a[116:119], a[16:19], v[36:39]
M v[40:43], a[116:119], a[32:35], v[28:31]
M v[40:43], a[120:123], a[36:39], v[40:43]
ds_read_b128 a[156:159], v3 offset:10240
ds_read_b128 a[160:163], v3 offset:11264
M v[40:43], a[124:127], a[40:43], v[40:43]
M v[40:43], a[128:131], a[44:47], v[40:43]
M v[44:47], a[128:131], a[60:63], v[28:31]
M v[44:47], a[124:127], a[56:59], v[44:47]
M v[44:47], a[120:123], a[52:55], v[44:47]
M v[44:47], a[116:119], a[48:51], v[44:47]
s_waitcnt lgkmcnt(4)
M v[48:51], a[132:135], a[0:3], v[20:23]
M v[48:51], a[136:139], a[4:7], v[48:51]
ds_read_b128 a[164:167], v3 offset:12288
ds_read_b128 a[168:171], v3 offset:13312
M v[48:51], a[140:143], a[8:11], v[48:51]
M v[48:51], a[144:147], a[12:15], v[48:51]
M v[52:55], a[144:147], a[28:31], v[24:27]
M v[52:55], a[140:143], a[24:27], v[52:55]
M v[52:55], a[136:139], a[20:23], v[52:55]
M v[52:55], a[132:135], a[16:19], v[52:55]
M v[56:59], a[132:135], a[32:35], v[28:31]
M v[56:59], a[136:139], a[36:39], v[56:59]
ds_read_b128 a[172:175], v3 offset:14336
ds_read_b128 a[176:179], v3 offset:15360
M v[56:59], a[140:143], a[40:43], v[56:59]
M v[56:59], a[144:147], a[44:47], v[56:59]
M v[60:63], a[144:147], a[60:63], v[28:31]
M v[60:63], a[140:143], a[56:59], v[60:63]
M v[60:63], a[136:139], a[52:55], v[60:63]
M v[60:63], a[132:135], a[48:51], v[60:63]
s_waitcnt lgkmcnt(4)
M v[64:67], a[148:151], a[0:3], v[20:23]
M v[64:67], a[152:155], a[4:7], v[64:67]
M v[64:67], a[156:159], a[8:11], v[64:67]
M v[64:67], a[160:163], a[12:15], v[64:67]
M v[68:71], a[160:163], a[28:31], v[20:23]
M v[68:71], a[156:159], a[24:27], v[68:71]
M v[68:71], a[152:155], a[20:23], v[68:71]
M v[68:71], a[148:151], a[16:19], v[68:71]
M v[72:75], a[148:151], a[32:35], v[24:27]
M v[72:75], a[152:155], a[36:39], v[72:75]
M v[72:75], a[156:159], a[40:43], v[72:75]
M v[72:75], a[160:163], a[44:47], v[72:75]
M v[76:79], a[160:163], a[60:63], v[28:31]
M v[76:79], a[156:159], a[56:59], v[76:79]
s_waitcnt vmcnt(4) lgkmcnt(0)
s_barrier
ds_read_b128 a[116:119], v2 offset:0
ds_read_b128 a[120:123], v2 offset:1024
M v[76:79], a[152:155], a[52:55], v[76:79]
M v[76:79], a[148:151], a[48:51], v[76:79]
M v[80:83], a[164:167], a[0:3], v[20:23]
M v[80:83], a[168:171], a[4:7], v[80:83]
ds_read_b128 a[124:127], v2 offset:2048
ds_read_b128 a[128:131], v2 offset:3072
M v[80:83], a[172:175], a[8:11], v[80:83]
M v[80:83], a[176:179], a[12:15], v[80:83]
M v[84:87], a[176:179], a[28:31], v[20:23]
M v[84:87], a[172:175], a[24:27], v[84:87]
ds_read_b128 a[132:135], v2 offset:4096
ds_read_b128 a[136:139], v2 offset:5120
M v[84:87], a[168:171], a[20:23], v[84:87]
M v[84:87], a[164:167], a[16:19], v[84:87]
M v[88:91], a[164:167], a[32:35], v[20:23]
M v[88:91], a[168:171], a[36:39], v[88:91]
ds_read_b128 a[140:143], v2 offset:6144
ds_read_b128 a[144:147], v2 offset:7168
M v[88:91], a[172:175], a[40:43], v[88:91]
M v[88:91], a[176:179], a[44:47], v[88:91]
M v[92:95], a[176:179], a[60:63], v[24:27]
M v[92:95], a[172:175], a[56:59], v[92:95]
M v[92:95], a[168:171], a[52:55], v[92:95]
M v[92:95], a[164:167], a[48:51], v[92:95]
s_waitcnt vmcnt(0)
s_mov_b64 exec, 1
buffer_store_dword v13, v12, s[52:55], s65 offen sc1
s_mov_b64 exec, -1
v_exp_f32 v32, v32
v_exp_f32 v33, v33
v_exp_f32 v34, v34
v_exp_f32 v35, v35
v_exp_f32 v48, v48
v_exp_f32 v49, v49
v_exp_f32 v50, v50
v_exp_f32 v51, v51
v_cvt_pk_bf16_f32 v32, v32, v33
v_cvt_pk_bf16_f32 v33, v34, v35
v_exp_f32 v36, v36
v_exp_f32 v37, v37
v_exp_f32 v38, v38
v_exp_f32 v39, v39
v_cvt_pk_bf16_f32 v34, v48, v49
v_cvt_pk_bf16_f32 v35, v50, v51
v_exp_f32 v52, v52
v_exp_f32 v53, v53
v_exp_f32 v54, v54
v_exp_f32 v55, v55
v_cvt_pk_bf16_f32 v36, v36, v37
v_cvt_pk_bf16_f32 v37, v38, v39
v_exp_f32 v40, v40
v_exp_f32 v41, v41
v_exp_f32 v42, v42
v_exp_f32 v43, v43
v_cvt_pk_bf16_f32 v38, v52, v53
v_cvt_pk_bf16_f32 v39, v54, v55
v_exp_f32 v56, v56
v_exp_f32 v57, v57
v_exp_f32 v58, v58
v_exp_f32 v59, v59
v_cvt_pk_bf16_f32 v40, v40, v41
v_cvt_pk_bf16_f32 v41, v42, v43
v_exp_f32 v44, v44
v_exp_f32 v45, v45
v_exp_f32 v46, v46
v_exp_f32 v47, v47
v_cvt_pk_bf16_f32 v42, v56, v57
v_cvt_pk_bf16_f32 v43, v58, v59
v_exp_f32 v60, v60
v_exp_f32 v61, v61
v_exp_f32 v62, v62
v_exp_f32 v63, v63
v_cvt_pk_bf16_f32 v44, v44, v45
v_cvt_pk_bf16_f32 v45, v46, v47
v_cvt_pk_bf16_f32 v46, v60, v61
v_cvt_pk_bf16_f32 v47, v62, v63
s_cmp_eq_u32 s24, 1
s_cbranch_scc1 Lk2_g1
s_mov_b32 s30, s21
s_cmp_eq_u32 s21, 0
s_cbranch_scc1 Lk2_m2
Lk2_l1:
s_add_u32 m0, s29, 65536
s_waitcnt lgkmcnt(4)
M v[96:99], a[116:119], a[0:3], 0
v_exp_f32 v64, v64
M v[96:99], a[120:123], a[4:7], v[96:99]
ds_read_b128 a[148:151], v2 offset:8192
ds_read_b128 a[152:155], v2 offset:9216
M v[96:99], a[124:127], a[8:11], v[96:99]
v_exp_f32 v65, v65
M v[96:99], a[128:131], a[12:15], v[96:99]
buffer_load_dwordx4 v1, s[12:15], s25 offen offset:0 sc1 lds
s_add_u32 s32, s25, 4096
M v[100:103], a[128:131], a[28:31], 0
v_exp_f32 v66, v66
M v[100:103], a[124:127], a[24:27], v[100:103]
v_cvt_pk_bf16_f32 v64, v64, v65
M v[100:103], a[120:123], a[20:23], v[100:103]
v_exp_f32 v67, v67
M v[100:103], a[116:119], a[16:19], v[100:103]
buffer_load_dwordx4 v1, s[12:15], s25 offen offset:1024 sc1 lds
M v[104:107], a[116:119], a[32:35], 0
v_exp_f32 v80, v80
M v[104:107], a[120:123], a[36:39], v[104:107]
ds_read_b128 a[156:159], v2 offset:10240
ds_read_b128 a[160:163], v2 offset:11264
M v[104:107], a[124:127], a[40:43], v[104:107]
v_exp_f32 v81, v81
M v[104:107], a[128:131], a[44:47], v[104:107]
buffer_load_dwordx4 v1, s[12:15], s25 offen offset:2048 sc1 lds
M v[108:111], a[128:131], a[60:63], 0
v_exp_f32 v82, v82
M v[108:111], a[124:127], a[56:59], v[108:111]
v_cvt_pk_bf16_f32 v65, v66, v67
v_cvt_pk_bf16_f32 v66, v80, v81
M v[108:111], a[120:123], a[52:55], v[108:111]
v_exp_f32 v83, v83
M v[108:111], a[116:119], a[48:51], v[108:111]
buffer_load_dwordx4 v1, s[12:15], s25 offen offset:3072 sc1 lds
s_add_u32 m0, s29, 69632
s_waitcnt lgkmcnt(4)
M v[112:115], a[132:135], a[0:3], 0
v_exp_f32 v68, v68
M v[112:115], a[136:139], a[4:7], v[112:115]
ds_read_b128 a[164:167], v2 offset:12288
ds_read_b128 a[168:171], v2 offset:13312
M v[112:115], a[140:143], a[8:11], v[112:115]
v_exp_f32 v69, v69
M v[112:115], a[144:147], a[12:15], v[112:115]
buffer_load_dwordx4 v1, s[12:15], s32 offen offset:0 sc1 lds
M v[116:119], a[144:147], a[28:31], 0
v_exp_f32 v70, v70
M v[116:119], a[140:143], a[24:27], v[116:119]
v_cvt_pk_bf16_f32 v67, v82, v83
v_cvt_pk_bf16_f32 v68, v68, v69
M v[116:119], a[136:139], a[20:23], v[116:119]
v_exp_f32 v71, v71
M v[116:119], a[132:135], a[16:19], v[116:119]
buffer_load_dwordx4 v1, s[12:15], s32 offen offset:1024 sc1 lds
M v[120:123], a[132:135], a[32:35], 0
v_exp_f32 v84, v84
M v[120:123], a[136:139], a[36:39], v[120:123]
ds_read_b128 a[172:175], v2 offset:14336
ds_read_b128 a[176:179], v2 offset:15360
M v[120:123], a[140:143], a[40:43], v[120:123]
v_exp_f32 v85, v85
M v[120:123], a[144:147], a[44:47], v[120:123]
buffer_load_dwordx4 v1, s[12:15], s32 offen offset:2048 sc1 lds
M v[124:127], a[144:147], a[60:63], 0
v_exp_f32 v86, v86
M v[124:127], a[140:143], a[56:59], v[124:127]
v_cvt_pk_bf16_f32 v69, v70, v71
v_cvt_pk_bf16_f32 v70, v84, v85
M v[124:127], a[136:139], a[52:55], v[124:127]
v_exp_f32 v87, v87
M v[124:127], a[132:135], a[48:51], v[124:127]
buffer_load_dwordx4 v1, s[12:15], s32 offen offset:3072 sc1 lds
s_add_u32 m0, s29, 98304
s_waitcnt lgkmcnt(4)
M v[128:131], a[148:151], a[0:3], 0
v_exp_f32 v72, v72
M v[128:131], a[152:155], a[4:7], v[128:131]
ds_read_b128 a[116:119], v5 offset:32768
ds_read_b128 a[120:123], v5 offset:40960
M v[128:131], a[156:159], a[8:11], v[128:131]
v_exp_f32 v73, v73
M v[128:131], a[160:163], a[12:15], v[128:131]
buffer_load_dwordx4 v1, s[12:15], s26 offen offset:0 sc1 lds
s_add_u32 s43, s26, 4096
M v[132:135], a[160:163], a[28:31], 0
v_exp_f32 v74, v74
M v[132:135], a[156:159], a[24:27], v[132:135]
v_cvt_pk_bf16_f32 v71, v86, v87
v_cvt_pk_bf16_f32 v72, v72, v73
M v[132:135], a[152:155], a[20:23], v[132:135]
v_exp_f32 v75, v75
M v[132:135], a[148:151], a[16:19], v[132:135]
buffer_load_dwordx4 v1, s[12:15], s26 offen offset:1024 sc1 lds
M v[136:139], a[148:151], a[32:35], 0
v_exp_f32 v88, v88
M v[136:139], a[152:155], a[36:39], v[136:139]
ds_read_b128 a[124:127], v5 offset:33792
ds_read_b128 a[128:131], v5 offset:41984
M v[136:139], a[156:159], a[40:43], v[136:139]
v_exp_f32 v89, v89
M v[136:139], a[160:163], a[44:47], v[136:139]
buffer_load_dwordx4 v1, s[12:15], s26 offen offset:2048 sc1 lds
M v[140:143], a[160:163], a[60:63], 0
v_exp_f32 v90, v90
M v[140:143], a[156:159], a[56:59], v[140:143]
v_cvt_pk_bf16_f32 v73, v74, v75
v_cvt_pk_bf16_f32 v74, v88, v89
M v[140:143], a[152:155], a[52:55], v[140:143]
v_exp_f32 v91, v91
M v[140:143], a[148:151], a[48:51], v[140:143]
buffer_load_dwordx4 v1, s[12:15], s26 offen offset:3072 sc1 lds
s_add_u32 m0, s29, 102400
s_waitcnt lgkmcnt(4)
M v[144:147], a[164:167], a[0:3], 0
v_exp_f32 v76, v76
M v[144:147], a[168:171], a[4:7], v[144:147]
ds_read_b128 a[132:135], v5 offset:34816
ds_read_b128 a[136:139], v5 offset:43008
M v[144:147], a[172:175], a[8:11], v[144:147]
v_exp_f32 v77, v77
M v[144:147], a[176:179], a[12:15], v[144:147]
buffer_load_dwordx4 v1, s[12:15], s43 offen offset:0 sc1 lds
M v[148:151], a[176:179], a[28:31], 0
v_exp_f32 v78, v78
M v[148:151], a[172:175], a[24:27], v[148:151]
v_cvt_pk_bf16_f32 v75, v90, v91
v_cvt_pk_bf16_f32 v76, v76, v77
M v[148:151], a[168:171], a[20:23], v[148:151]
v_exp_f32 v79, v79
M v[148:151], a[164:167], a[16:19], v[148:151]
buffer_load_dwordx4 v1, s[12:15], s43 offen offset:1024 sc1 lds
M v[152:155], a[164:167], a[32:35], 0
v_exp_f32 v92, v92
M v[152:155], a[168:171], a[36:39], v[152:155]
ds_read_b128 a[140:143], v5 offset:35840
ds_read_b128 a[144:147], v5 offset:44032
M v[152:155], a[172:175], a[40:43], v[152:155]
v_exp_f32 v93, v93
M v[152:155], a[176:179], a[44:47], v[152:155]
buffer_load_dwordx4 v1, s[12:15], s43 offen offset:2048 sc1 lds
M v[156:159], a[176:179], a[60:63], 0
v_exp_f32 v94, v94
M v[156:159], a[172:175], a[56:59], v[156:159]
v_cvt_pk_bf16_f32 v77, v78, v79
v_cvt_pk_bf16_f32 v78, v92, v93
M v[156:159], a[168:171], a[52:55], v[156:159]
v_exp_f32 v95, v95
M v[156:159], a[164:167], a[48:51], v[156:159]
buffer_load_dwordx4 v1, s[12:15], s43 offen offset:3072 sc1 lds
v_cvt_pk_bf16_f32 v79, v94, v95
s_waitcnt lgkmcnt(6)
M v[160:163], a[116:119], v[32:35], v[160:163]
v_exp_f32 v96, v96
M v[160:163], a[120:123], v[64:67], v[160:163]
ds_read_b128 a[148:151], v5 offset:36864
ds_read_b128 a[152:155], v5 offset:45056
M v[164:167], a[120:123], v[68:71], v[164:167]
v_exp_f32 v97, v97
M v[164:167], a[116:119], v[36:39], v[164:167]
v_cvt_pk_bf16_f32 v96, v96, v97
M v[168:171], a[116:119], v[40:43], v[168:171]
v_exp_f32 v98, v98
M v[168:171], a[120:123], v[72:75], v[168:171]
s_add_u32 s25, s25, 32768
s_cmp_eq_u32 s25, s27
M v[172:175], a[120:123], v[76:79], v[172:175]
v_exp_f32 v99, v99
M v[172:175], a[116:119], v[44:47], v[172:175]
v_cvt_pk_bf16_f32 v97, v98, v99
s_waitcnt lgkmcnt(6)
M a[96:99], a[112:115], v[32:35], a[96:99]
s_cselect_b32 s25, s28, s25
s_cselect_b32 s27, -1, s27
M a[96:99], a[112:115], v[64:67], a[96:99]
s_add_u32 s26, s26, 32768
s_cmp_eq_u32 s26, s62
M v[176:179], a[124:127], v[32:35], v[176:179]
v_exp_f32 v112, v112
M v[176:179], a[128:131], v[64:67], v[176:179]
ds_read_b128 a[156:159], v5 offset:37888
ds_read_b128 a[160:163], v5 offset:46080
M v[180:183], a[128:131], v[68:71], v[180:183]
v_exp_f32 v113, v113
M v[180:183], a[124:127], v[36:39], v[180:183]
v_cvt_pk_bf16_f32 v98, v112, v113
M v[184:187], a[124:127], v[40:43], v[184:187]
v_exp_f32 v114, v114
M v[184:187], a[128:131], v[72:75], v[184:187]
s_cselect_b32 s26, s63, s26
s_cselect_b32 s62, -1, s62
M v[188:191], a[128:131], v[76:79], v[188:191]
v_exp_f32 v115, v115
M v[188:191], a[124:127], v[44:47], v[188:191]
v_cvt_pk_bf16_f32 v99, v114, v115
s_waitcnt lgkmcnt(6)
M a[100:103], a[112:115], v[36:39], a[100:103]
M a[100:103], a[112:115], v[68:71], a[100:103]
M v[192:195], a[132:135], v[32:35], v[192:195]
v_exp_f32 v100, v100
M v[192:195], a[136:139], v[64:67], v[192:195]
ds_read_b128 a[164:167], v5 offset:38912
ds_read_b128 a[168:171], v5 offset:47104
M v[196:199], a[136:139], v[68:71], v[196:199]
v_exp_f32 v101, v101
M v[196:199], a[132:135], v[36:39], v[196:199]
v_cvt_pk_bf16_f32 v100, v100, v101
M v[200:203], a[132:135], v[40:43], v[200:203]
v_exp_f32 v102, v102
M v[200:203], a[136:139], v[72:75], v[200:203]
M v[204:207], a[136:139], v[76:79], v[204:207]
v_exp_f32 v103, v103
M v[204:207], a[132:135], v[44:47], v[204:207]
v_cvt_pk_bf16_f32 v101, v102, v103
s_waitcnt lgkmcnt(6)
M a[104:107], a[112:115], v[40:43], a[104:107]
M a[104:107], a[112:115], v[72:75], a[104:107]
M v[208:211], a[140:143], v[32:35], v[208:211]
v_exp_f32 v116, v116
M v[208:211], a[144:147], v[64:67], v[208:211]
ds_read_b128 a[172:175], v5 offset:39936
ds_read_b128 a[176:179], v5 offset:48128
M v[212:215], a[144:147], v[68:71], v[212:215]
v_exp_f32 v117, v117
M v[212:215], a[140:143], v[36:39], v[212:215]
v_cvt_pk_bf16_f32 v102, v116, v117
M v[216:219], a[140:143], v[40:43], v[216:219]
v_exp_f32 v118, v118
M v[216:219], a[144:147], v[72:75], v[216:219]
M v[220:223], a[144:147], v[76:79], v[220:223]
v_exp_f32 v119, v119
M v[220:223], a[140:143], v[44:47], v[220:223]
v_cvt_pk_bf16_f32 v103, v118, v119
s_waitcnt lgkmcnt(6)
M a[108:111], a[112:115], v[44:47], a[108:111]
M a[108:111], a[112:115], v[76:79], a[108:111]
M v[224:227], a[148:151], v[32:35], v[224:227]
v_exp_f32 v104, v104
M v[224:227], a[152:155], v[64:67], v[224:227]
M v[228:231], a[152:155], v[68:71], v[228:231]
v_exp_f32 v105, v105
M v[228:231], a[148:151], v[36:39], v[228:231]
v_cvt_pk_bf16_f32 v104, v104, v105
M v[232:235], a[148:151], v[40:43], v[232:235]
v_exp_f32 v106, v106
M v[232:235], a[152:155], v[72:75], v[232:235]
M v[236:239], a[152:155], v[76:79], v[236:239]
v_exp_f32 v107, v107
M v[236:239], a[148:151], v[44:47], v[236:239]
v_cvt_pk_bf16_f32 v105, v106, v107
s_waitcnt lgkmcnt(4)
M v[240:243], a[156:159], v[32:35], v[240:243]
v_exp_f32 v120, v120
M v[240:243], a[160:163], v[64:67], v[240:243]
M v[244:247], a[160:163], v[68:71], v[244:247]
v_exp_f32 v121, v121
M v[244:247], a[156:159], v[36:39], v[244:247]
v_cvt_pk_bf16_f32 v106, v120, v121
M v[248:251], a[156:159], v[40:43], v[248:251]
v_exp_f32 v122, v122
M v[248:251], a[160:163], v[72:75], v[248:251]
s_waitcnt vmcnt(0) lgkmcnt(0)
s_barrier
ds_read_b128 a[116:119], v3 offset:0
ds_read_b128 a[120:123], v3 offset:1024
M v[252:255], a[160:163], v[76:79], v[252:255]
v_exp_f32 v123, v123
M v[252:255], a[156:159], v[44:47], v[252:255]
v_cvt_pk_bf16_f32 v107, v122, v123
M a[64:67], a[164:167], v[32:35], a[64:67]
v_exp_f32 v108, v108
M a[64:67], a[168:171], v[64:67], a[64:67]
ds_read_b128 a[124:127], v3 offset:2048
ds_read_b128 a[128:131], v3 offset:3072
M a[68:71], a[168:171], v[68:71], a[68:71]
v_exp_f32 v109, v109
M a[68:71], a[164:167], v[36:39], a[68:71]
v_cvt_pk_bf16_f32 v108, v108, v109
M a[72:75], a[164:167], v[40:43], a[72:75]
v_exp_f32 v110, v110
M a[72:75], a[168:171], v[72:75], a[72:75]
ds_read_b128 a[132:135], v3 offset:4096
ds_read_b128 a[136:139], v3 offset:5120
M a[76:79], a[168:171], v[76:79], a[76:79]
v_exp_f32 v111, v111
M a[76:79], a[164:167], v[44:47], a[76:79]
v_cvt_pk_bf16_f32 v109, v110, v111
M a[80:83], a[172:175], v[32:35], a[80:83]
v_exp_f32 v124, v124
M a[80:83], a[176:179], v[64:67], a[80:83]
ds_read_b128 a[140:143], v3 offset:6144
ds_read_b128 a[144:147], v3 offset:7168
M a[84:87], a[176:179], v[68:71], a[84:87]
v_exp_f32 v125, v125
M a[84:87], a[172:175], v[36:39], a[84:87]
v_cvt_pk_bf16_f32 v110, v124, v125
M a[88:91], a[172:175], v[40:43], a[88:91]
v_exp_f32 v126, v126
M a[88:91], a[176:179], v[72:75], a[88:91]
M a[92:95], a[176:179], v[76:79], a[92:95]
v_exp_f32 v127, v127
M a[92:95], a[172:175], v[44:47], a[92:95]
v_cvt_pk_bf16_f32 v111, v126, v127
s_sub_u32 s30, s30, 1
s_cmp_eq_u32 s30, 0
s_cbranch_scc1 Lk2_m1
s_add_u32 m0, s29, 0
s_waitcnt lgkmcnt(4)
M v[32:35], a[116:119], a[0:3], 0
v_exp_f32 v128, v128
M v[32:35], a[120:123], a[4:7], v[32:35]
ds_read_b128 a[148:151], v3 offset:8192
ds_read_b128 a[152:155], v3 offset:9216
M v[32:35], a[124:127], a[8:11], v[32:35]
v_exp_f32 v129, v129
M v[32:35], a[128:131], a[12:15], v[32:35]
buffer_load_dwordx4 v1, s[12:15], s25 offen offset:0 sc1 lds
s_add_u32 s32, s25, 4096
M v[36:39], a[128:131], a[28:31], 0
v_exp_f32 v130, v130
M v[36:39], a[124:127], a[24:27], v[36:39]
v_cvt_pk_bf16_f32 v128, v128, v129
M v[36:39], a[120:123], a[20:23], v[36:39]
v_exp_f32 v131, v131
M v[36:39], a[116:119], a[16:19], v[36:39]
buffer_load_dwordx4 v1, s[12:15], s25 offen offset:1024 sc1 lds
M v[40:43], a[116:119], a[32:35], 0
v_exp_f32 v144, v144
M v[40:43], a[120:123], a[36:39], v[40:43]
ds_read_b128 a[156:159], v3 offset:10240
ds_read_b128 a[160:163], v3 offset:11264
M v[40:43], a[124:127], a[40:43], v[40:43]
v_exp_f32 v145, v145
M v[40:43], a[128:131], a[44:47], v[40:43]
buffer_load_dwordx4 v1, s[12:15], s25 offen offset:2048 sc1 lds
M v[44:47], a[128:131], a[60:63], 0
v_exp_f32 v146, v146
M v[44:47], a[124:127], a[56:59], v[44:47]
v_cvt_pk_bf16_f32 v129, v130, v131
v_cvt_pk_bf16_f32 v130, v144, v145
M v[44:47], a[120:123], a[52:55], v[44:47]
v_exp_f32 v147, v147
M v[44:47], a[116:119], a[48:51], v[44:47]
buffer_load_dwordx4 v1, s[12:15], s25 offen offset:3072 sc1 lds
s_add_u32 m0, s29, 4096
s_waitcnt lgkmcnt(4)
M v[48:51], a[132:135], a[0:3], 0
v_exp_f32 v132, v132
M v[48:51], a[136:139], a[4:7], v[48:51]
ds_read_b128 a[164:167], v3 offset:12288
ds_read_b128 a[168:171], v3 offset:13312
M v[48:51], a[140:143], a[8:11], v[48:51]
v_exp_f32 v133, v133
M v[48:51], a[144:147], a[12:15], v[48:51]
buffer_load_dwordx4 v1, s[12:15], s32 offen offset:0 sc1 lds
M v[52:55], a[144:147], a[28:31], 0
v_exp_f32 v134, v134
M v[52:55], a[140:143], a[24:27], v[52:55]
v_cvt_pk_bf16_f32 v131, v146, v147
v_cvt_pk_bf16_f32 v132, v132, v133
M v[52:55], a[136:139], a[20:23], v[52:55]
v_exp_f32 v135, v135
M v[52:55], a[132:135], a[16:19], v[52:55]
buffer_load_dwordx4 v1, s[12:15], s32 offen offset:1024 sc1 lds
M v[56:59], a[132:135], a[32:35], 0
v_exp_f32 v148, v148
M v[56:59], a[136:139], a[36:39], v[56:59]
ds_read_b128 a[172:175], v3 offset:14336
ds_read_b128 a[176:179], v3 offset:15360
M v[56:59], a[140:143], a[40:43], v[56:59]
v_exp_f32 v149, v149
M v[56:59], a[144:147], a[44:47], v[56:59]
buffer_load_dwordx4 v1, s[12:15], s32 offen offset:2048 sc1 lds
M v[60:63], a[144:147], a[60:63], 0
v_exp_f32 v150, v150
M v[60:63], a[140:143], a[56:59], v[60:63]
v_cvt_pk_bf16_f32 v133, v134, v135
v_cvt_pk_bf16_f32 v134, v148, v149
M v[60:63], a[136:139], a[52:55], v[60:63]
v_exp_f32 v151, v151
M v[60:63], a[132:135], a[48:51], v[60:63]
buffer_load_dwordx4 v1, s[12:15], s32 offen offset:3072 sc1 lds
s_add_u32 m0, s29, 32768
s_waitcnt lgkmcnt(4)
M v[64:67], a[148:151], a[0:3], 0
v_exp_f32 v136, v136
M v[64:67], a[152:155], a[4:7], v[64:67]
ds_read_b128 a[116:119], v6 offset:32768
ds_read_b128 a[120:123], v6 offset:40960
M v[64:67], a[156:159], a[8:11], v[64:67]
v_exp_f32 v137, v137
M v[64:67], a[160:163], a[12:15], v[64:67]
buffer_load_dwordx4 v1, s[12:15], s26 offen offset:0 sc1 lds
s_add_u32 s43, s26, 4096
M v[68:71], a[160:163], a[28:31], 0
v_exp_f32 v138, v138
M v[68:71], a[156:159], a[24:27], v[68:71]
v_cvt_pk_bf16_f32 v135, v150, v151
v_cvt_pk_bf16_f32 v136, v136, v137
M v[68:71], a[152:155], a[20:23], v[68:71]
v_exp_f32 v139, v139
M v[68:71], a[148:151], a[16:19], v[68:71]
buffer_load_dwordx4 v1, s[12:15], s26 offen offset:1024 sc1 lds
M v[72:75], a[148:151], a[32:35], 0
v_exp_f32 v152, v152
M v[72:75], a[152:155], a[36:39], v[72:75]
ds_read_b128 a[124:127], v6 offset:33792
ds_read_b128 a[128:131], v6 offset:41984
M v[72:75], a[156:159], a[40:43], v[72:75]
v_exp_f32 v153, v153
M v[72:75], a[160:163], a[44:47], v[72:75]
buffer_load_dwordx4 v1, s[12:15], s26 offen offset:2048 sc1 lds
M v[76:79], a[160:163], a[60:63], 0
v_exp_f32 v154, v154
M v[76:79], a[156:159], a[56:59], v[76:79]
v_cvt_pk_bf16_f32 v137, v138, v139
v_cvt_pk_bf16_f32 v138, v152, v153
M v[76:79], a[152:155], a[52:55], v[76:79]
v_exp_f32 v155, v155
M v[76:79], a[148:151], a[48:51], v[76:79]
buffer_load_dwordx4 v1, s[12:15], s26 offen offset:3072 sc1 lds
s_add_u32 m0, s29, 36864
s_waitcnt lgkmcnt(4)
M v[80:83], a[164:167], a[0:3], 0
v_exp_f32 v140, v140
M v[80:83], a[168:171], a[4:7], v[80:83]
ds_read_b128 a[132:135], v6 offset:34816
ds_read_b128 a[136:139], v6 offset:43008
M v[80:83], a[172:175], a[8:11], v[80:83]
v_exp_f32 v141, v141
M v[80:83], a[176:179], a[12:15], v[80:83]
buffer_load_dwordx4 v1, s[12:15], s43 offen offset:0 sc1 lds
M v[84:87], a[176:179], a[28:31], 0
v_exp_f32 v142, v142
M v[84:87], a[172:175], a[24:27], v[84:87]
v_cvt_pk_bf16_f32 v139, v154, v155
v_cvt_pk_bf16_f32 v140, v140, v141
M v[84:87], a[168:171], a[20:23], v[84:87]
v_exp_f32 v143, v143
M v[84:87], a[164:167], a[16:19], v[84:87]
buffer_load_dwordx4 v1, s[12:15], s43 offen offset:1024 sc1 lds
M v[88:91], a[164:167], a[32:35], 0
v_exp_f32 v156, v156
M v[88:91], a[168:171], a[36:39], v[88:91]
ds_read_b128 a[140:143], v6 offset:35840
ds_read_b128 a[144:147], v6 offset:44032
M v[88:91], a[172:175], a[40:43], v[88:91]
v_exp_f32 v157, v157
M v[88:91], a[176:179], a[44:47], v[88:91]
buffer_load_dwordx4 v1, s[12:15], s43 offen offset:2048 sc1 lds
M v[92:95], a[176:179], a[60:63], 0
v_exp_f32 v158, v158
M v[92:95], a[172:175], a[56:59], v[92:95]
v_cvt_pk_bf16_f32 v141, v142, v143
v_cvt_pk_bf16_f32 v142, v156, v157
M v[92:95], a[168:171], a[52:55], v[92:95]
v_exp_f32 v159, v159
M v[92:95], a[164:167], a[48:51], v[92:95]
buffer_load_dwordx4 v1, s[12:15], s43 offen offset:3072 sc1 lds
v_cvt_pk_bf16_f32 v143, v158, v159
s_waitcnt lgkmcnt(6)
M v[160:163], a[116:119], v[96:99], v[160:163]
v_exp_f32 v32, v32
M v[160:163], a[120:123], v[128:131], v[160:163]
ds_read_b128 a[148:151], v6 offset:36864
ds_read_b128 a[152:155], v6 offset:45056
M v[164:167], a[120:123], v[132:135], v[164:167]
v_exp_f32 v33, v33
M v[164:167], a[116:119], v[100:103], v[164:167]
v_cvt_pk_bf16_f32 v32, v32, v33
M v[168:171], a[116:119], v[104:107], v[168:171]
v_exp_f32 v34, v34
M v[168:171], a[120:123], v[136:139], v[168:171]
s_add_u32 s25, s25, 32768
s_cmp_eq_u32 s25, s27
M v[172:175], a[120:123], v[140:143], v[172:175]
v_exp_f32 v35, v35
M v[172:175], a[116:119], v[108:111], v[172:175]
v_cvt_pk_bf16_f32 v33, v34, v35
s_waitcnt lgkmcnt(6)
M a[96:99], a[112:115], v[96:99], a[96:99]
s_cselect_b32 s25, s28, s25
s_cselect_b32 s27, -1, s27
M a[96:99], a[112:115], v[128:131], a[96:99]
s_add_u32 s26, s26, 32768
s_cmp_eq_u32 s26, s62
M v[176:179], a[124:127], v[96:99], v[176:179]
v_exp_f32 v48, v48
M v[176:179], a[128:131], v[128:131], v[176:179]
ds_read_b128 a[156:159], v6 offset:37888
ds_read_b128 a[160:163], v6 offset:46080
M v[180:183], a[128:131], v[132:135], v[180:183]
v_exp_f32 v49, v49
M v[180:183], a[124:127], v[100:103], v[180:183]
v_cvt_pk_bf16_f32 v34, v48, v49
M v[184:187], a[124:127], v[104:107], v[184:187]
v_exp_f32 v50, v50
M v[184:187], a[128:131], v[136:139], v[184:187]
s_cselect_b32 s26, s63, s26
s_cselect_b32 s62, -1, s62
M v[188:191], a[128:131], v[140:143], v[188:191]
v_exp_f32 v51, v51
M v[188:191], a[124:127], v[108:111], v[188:191]
v_cvt_pk_bf16_f32 v35, v50, v51
s_waitcnt lgkmcnt(6)
M a[100:103], a[112:115], v[100:103], a[100:103]
M a[100:103], a[112:115], v[132:135], a[100:103]
M v[192:195], a[132:135], v[96:99], v[192:195]
v_exp_f32 v36, v36
M v[192:195], a[136:139], v[128:131], v[192:195]
ds_read_b128 a[164:167], v6 offset:38912
ds_read_b128 a[168:171], v6 offset:47104
M v[196:199], a[136:139], v[132:135], v[196:199]
v_exp_f32 v37, v37
M v[196:199], a[132:135], v[100:103], v[196:199]
v_cvt_pk_bf16_f32 v36, v36, v37
M v[200:203], a[132:135], v[104:107], v[200:203]
v_exp_f32 v38, v38
M v[200:203], a[136:139], v[136:139], v[200:203]
M v[204:207], a[136:139], v[140:143], v[204:207]
v_exp_f32 v39, v39
M v[204:207], a[132:135], v[108:111], v[204:207]
v_cvt_pk_bf16_f32 v37, v38, v39
s_waitcnt lgkmcnt(6)
M a[104:107], a[112:115], v[104:107], a[104:107]
M a[104:107], a[112:115], v[136:139], a[104:107]
M v[208:211], a[140:143], v[96:99], v[208:211]
v_exp_f32 v52, v52
M v[208:211], a[144:147], v[128:131], v[208:211]
ds_read_b128 a[172:175], v6 offset:39936
ds_read_b128 a[176:179], v6 offset:48128
M v[212:215], a[144:147], v[132:135], v[212:215]
v_exp_f32 v53, v53
M v[212:215], a[140:143], v[100:103], v[212:215]
v_cvt_pk_bf16_f32 v38, v52, v53
M v[216:219], a[140:143], v[104:107], v[216:219]
v_exp_f32 v54, v54
M v[216:219], a[144:147], v[136:139], v[216:219]
M v[220:223], a[144:147], v[140:143], v[220:223]
v_exp_f32 v55, v55
M v[220:223], a[140:143], v[108:111], v[220:223]
v_cvt_pk_bf16_f32 v39, v54, v55
s_waitcnt lgkmcnt(6)
M a[108:111], a[112:115], v[108:111], a[108:111]
M a[108:111], a[112:115], v[140:143], a[108:111]
M v[224:227], a[148:151], v[96:99], v[224:227]
v_exp_f32 v40, v40
M v[224:227], a[152:155], v[128:131], v[224:227]
M v[228:231], a[152:155], v[132:135], v[228:231]
v_exp_f32 v41, v41
M v[228:231], a[148:151], v[100:103], v[228:231]
v_cvt_pk_bf16_f32 v40, v40, v41
M v[232:235], a[148:151], v[104:107], v[232:235]
v_exp_f32 v42, v42
M v[232:235], a[152:155], v[136:139], v[232:235]
M v[236:239], a[152:155], v[140:143], v[236:239]
v_exp_f32 v43, v43
M v[236:239], a[148:151], v[108:111], v[236:239]
v_cvt_pk_bf16_f32 v41, v42, v43
s_waitcnt lgkmcnt(4)
M v[240:243], a[156:159], v[96:99], v[240:243]
v_exp_f32 v56, v56
M v[240:243], a[160:163], v[128:131], v[240:243]
M v[244:247], a[160:163], v[132:135], v[244:247]
v_exp_f32 v57, v57
M v[244:247], a[156:159], v[100:103], v[244:247]
v_cvt_pk_bf16_f32 v42, v56, v57
M v[248:251], a[156:159], v[104:107], v[248:251]
v_exp_f32 v58, v58
M v[248:251], a[160:163], v[136:139], v[248:251]
s_waitcnt vmcnt(0) lgkmcnt(0)
s_barrier
ds_read_b128 a[116:119], v2 offset:0
ds_read_b128 a[120:123], v2 offset:1024
M v[252:255], a[160:163], v[140:143], v[252:255]
v_exp_f32 v59, v59
M v[252:255], a[156:159], v[108:111], v[252:255]
v_cvt_pk_bf16_f32 v43, v58, v59
M a[64:67], a[164:167], v[96:99], a[64:67]
v_exp_f32 v44, v44
M a[64:67], a[168:171], v[128:131], a[64:67]
ds_read_b128 a[124:127], v2 offset:2048
ds_read_b128 a[128:131], v2 offset:3072
M a[68:71], a[168:171], v[132:135], a[68:71]
v_exp_f32 v45, v45
M a[68:71], a[164:167], v[100:103], a[68:71]
v_cvt_pk_bf16_f32 v44, v44, v45
M a[72:75], a[164:167], v[104:107], a[72:75]
v_exp_f32 v46, v46
M a[72:75], a[168:171], v[136:139], a[72:75]
ds_read_b128 a[132:135], v2 offset:4096
ds_read_b128 a[136:139], v2 offset:5120
M a[76:79], a[168:171], v[140:143], a[76:79]
v_exp_f32 v47, v47
M a[76:79], a[164:167], v[108:111], a[76:79]
v_cvt_pk_bf16_f32 v45, v46, v47
M a[80:83], a[172:175], v[96:99], a[80:83]
v_exp_f32 v60, v60
M a[80:83], a[176:179], v[128:131], a[80:83]
ds_read_b128 a[140:143], v2 offset:6144
ds_read_b128 a[144:147], v2 offset:7168
M a[84:87], a[176:179], v[132:135], a[84:87]
v_exp_f32 v61, v61
M a[84:87], a[172:175], v[100:103], a[84:87]
v_cvt_pk_bf16_f32 v46, v60, v61
M a[88:91], a[172:175], v[104:107], a[88:91]
v_exp_f32 v62, v62
M a[88:91], a[176:179], v[136:139], a[88:91]
M a[92:95], a[176:179], v[140:143], a[92:95]
v_exp_f32 v63, v63
M a[92:95], a[172:175], v[108:111], a[92:95]
v_cvt_pk_bf16_f32 v47, v62, v63
s_branch Lk2_l1
Lk2_m1:
s_cmp_eq_u32 s23, 1
s_cbranch_scc1 Lk2_m1b
s_add_u32 m0, s29, 0
s_waitcnt lgkmcnt(4)
M v[32:35], a[116:119], a[0:3], v[16:19]
v_exp_f32 v128, v128
M v[32:35], a[120:123], a[4:7], v[32:35]
ds_read_b128 a[148:151], v3 offset:8192
ds_read_b128 a[152:155], v3 offset:9216
M v[32:35], a[124:127], a[8:11], v[32:35]
v_exp_f32 v129, v129
M v[32:35], a[128:131], a[12:15], v[32:35]
buffer_load_dwordx4 v1, s[12:15], s25 offen offset:0 sc1 lds
s_add_u32 s32, s25, 4096
M v[36:39], a[128:131], a[28:31], 0
v_exp_f32 v130, v130
M v[36:39], a[124:127], a[24:27], v[36:39]
v_cvt_pk_bf16_f32 v128, v128, v129
M v[36:39], a[120:123], a[20:23], v[36:39]
v_exp_f32 v131, v131
M v[36:39], a[116:119], a[16:19], v[36:39]
buffer_load_dwordx4 v1, s[12:15], s25 offen offset:1024 sc1 lds
M v[40:43], a[116:119], a[32:35], 0
v_exp_f32 v144, v144
M v[40:43], a[120:123], a[36:39], v[40:43]
ds_read_b128 a[156:159], v3 offset:10240
ds_read_b128 a[160:163], v3 offset:11264
M v[40:43], a[124:127], a[40:43], v[40:43]
v_exp_f32 v145, v145
M v[40:43], a[128:131], a[44:47], v[40:43]
buffer_load_dwordx4 v1, s[12:15], s25 offen offset:2048 sc1 lds
M v[44:47], a[128:131], a[60:63], 0
v_exp_f32 v146, v146
M v[44:47], a[124:127], a[56:59], v[44:47]
v_cvt_pk_bf16_f32 v129, v130, v131
v_cvt_pk_bf16_f32 v130, v144, v145
M v[44:47], a[120:123], a[52:55], v[44:47]
v_exp_f32 v147, v147
M v[44:47], a[116:119], a[48:51], v[44:47]
buffer_load_dwordx4 v1, s[12:15], s25 offen offset:3072 sc1 lds
s_add_u32 m0, s29, 4096
s_waitcnt lgkmcnt(4)
v_exp_f32 v132, v132
ds_read_b128 a[164:167], v3 offset:12288
ds_read_b128 a[168:171], v3 offset:13312
v_exp_f32 v133, v133
buffer_load_dwordx4 v1, s[12:15], s32 offen offset:0 sc1 lds
M v[52:55], a[144:147], a[28:31], v[16:19]
v_exp_f32 v134, v134
M v[52:55], a[140:143], a[24:27], v[52:55]
v_cvt_pk_bf16_f32 v131, v146, v147
v_cvt_pk_bf16_f32 v132, v132, v133
M v[52:55], a[136:139], a[20:23], v[52:55]
v_exp_f32 v135, v135
M v[52:55], a[132:135], a[16:19], v[52:55]
buffer_load_dwordx4 v1, s[12:15], s32 offen offset:1024 sc1 lds
M v[56:59], a[132:135], a[32:35], 0
v_exp_f32 v148, v148
M v[56:59], a[136:139], a[36:39], v[56:59]
ds_read_b128 a[172:175], v3 offset:14336
ds_read_b128 a[176:179], v3 offset:15360
M v[56:59], a[140:143], a[40:43], v[56:59]
v_exp_f32 v149, v149
M v[56:59], a[144:147], a[44:47], v[56:59]
buffer_load_dwordx4 v1, s[12:15], s32 offen offset:2048 sc1 lds
M v[60:63], a[144:147], a[60:63], 0
v_exp_f32 v150, v150
M v[60:63], a[140:143], a[56:59], v[60:63]
v_cvt_pk_bf16_f32 v133, v134, v135
v_cvt_pk_bf16_f32 v134, v148, v149
M v[60:63], a[136:139], a[52:55], v[60:63]
v_exp_f32 v151, v151
M v[60:63], a[132:135], a[48:51], v[60:63]
buffer_load_dwordx4 v1, s[12:15], s32 offen offset:3072 sc1 lds
s_add_u32 m0, s29, 32768
s_waitcnt lgkmcnt(4)
v_exp_f32 v136, v136
ds_read_b128 a[116:119], v6 offset:32768
ds_read_b128 a[120:123], v6 offset:40960
v_exp_f32 v137, v137
buffer_load_dwordx4 v1, s[12:15], s26 offen offset:0 sc1 lds
s_add_u32 s43, s26, 4096
v_exp_f32 v138, v138
v_cvt_pk_bf16_f32 v135, v150, v151
v_cvt_pk_bf16_f32 v136, v136, v137
v_exp_f32 v139, v139
buffer_load_dwordx4 v1, s[12:15], s26 offen offset:1024 sc1 lds
M v[72:75], a[148:151], a[32:35], v[16:19]
v_exp_f32 v152, v152
M v[72:75], a[152:155], a[36:39], v[72:75]
ds_read_b128 a[124:127], v6 offset:33792
ds_read_b128 a[128:131], v6 offset:41984
M v[72:75], a[156:159], a[40:43], v[72:75]
v_exp_f32 v153, v153
M v[72:75], a[160:163], a[44:47], v[72:75]
buffer_load_dwordx4 v1, s[12:15], s26 offen offset:2048 sc1 lds
M v[76:79], a[160:163], a[60:63], 0
v_exp_f32 v154, v154
M v[76:79], a[156:159], a[56:59], v[76:79]
v_cvt_pk_bf16_f32 v137, v138, v139
v_cvt_pk_bf16_f32 v138, v152, v153
M v[76:79], a[152:155], a[52:55], v[76:79]
v_exp_f32 v155, v155
M v[76:79], a[148:151], a[48:51], v[76:79]
buffer_load_dwordx4 v1, s[12:15], s26 offen offset:3072 sc1 lds
s_add_u32 m0, s29, 36864
s_waitcnt lgkmcnt(4)
v_exp_f32 v140, v140
ds_read_b128 a[132:135], v6 offset:34816
ds_read_b128 a[136:139], v6 offset:43008
v_exp_f32 v141, v141
buffer_load_dwordx4 v1, s[12:15], s43 offen offset:0 sc1 lds
v_exp_f32 v142, v142
v_cvt_pk_bf16_f32 v139, v154, v155
v_cvt_pk_bf16_f32 v140, v140, v141
v_exp_f32 v143, v143
buffer_load_dwordx4 v1, s[12:15], s43 offen offset:1024 sc1 lds
v_exp_f32 v156, v156
ds_read_b128 a[140:143], v6 offset:35840
ds_read_b128 a[144:147], v6 offset:44032
v_exp_f32 v157, v157
buffer_load_dwordx4 v1, s[12:15], s43 offen offset:2048 sc1 lds
M v[92:95], a[176:179], a[60:63], v[16:19]
v_exp_f32 v158, v158
M v[92:95], a[172:175], a[56:59], v[92:95]
v_cvt_pk_bf16_f32 v141, v142, v143
v_cvt_pk_bf16_f32 v142, v156, v157
M v[92:95], a[168:171], a[52:55], v[92:95]
v_exp_f32 v159, v159
M v[92:95], a[164:167], a[48:51], v[92:95]
buffer_load_dwordx4 v1, s[12:15], s43 offen offset:3072 sc1 lds
v_cvt_pk_bf16_f32 v143, v158, v159
s_waitcnt lgkmcnt(6)
M v[160:163], a[116:119], v[96:99], v[160:163]
v_exp_f32 v32, v32
M v[160:163], a[120:123], v[128:131], v[160:163]
ds_read_b128 a[148:151], v6 offset:36864
ds_read_b128 a[152:155], v6 offset:45056
M v[164:167], a[120:123], v[132:135], v[164:167]
v_exp_f32 v33, v33
M v[164:167], a[116:119], v[100:103], v[164:167]
v_cvt_pk_bf16_f32 v32, v32, v33
M v[168:171], a[116:119], v[104:107], v[168:171]
v_exp_f32 v34, v34
M v[168:171], a[120:123], v[136:139], v[168:171]
s_add_u32 s25, s25, 32768
s_cmp_eq_u32 s25, s27
M v[172:175], a[120:123], v[140:143], v[172:175]
v_exp_f32 v35, v35
M v[172:175], a[116:119], v[108:111], v[172:175]
v_cvt_pk_bf16_f32 v33, v34, v35
s_waitcnt lgkmcnt(6)
M a[96:99], a[112:115], v[96:99], a[96:99]
s_cselect_b32 s25, s28, s25
s_cselect_b32 s27, -1, s27
M a[96:99], a[112:115], v[128:131], a[96:99]
s_add_u32 s26, s26, 32768
s_cmp_eq_u32 s26, s62
M v[176:179], a[124:127], v[96:99], v[176:179]
M v[176:179], a[128:131], v[128:131], v[176:179]
ds_read_b128 a[156:159], v6 offset:37888
ds_read_b128 a[160:163], v6 offset:46080
M v[180:183], a[128:131], v[132:135], v[180:183]
M v[180:183], a[124:127], v[100:103], v[180:183]
v_mov_b32 v34, 0
M v[184:187], a[124:127], v[104:107], v[184:187]
M v[184:187], a[128:131], v[136:139], v[184:187]
s_cselect_b32 s26, s63, s26
s_cselect_b32 s62, -1, s62
M v[188:191], a[128:131], v[140:143], v[188:191]
M v[188:191], a[124:127], v[108:111], v[188:191]
v_mov_b32 v35, 0
s_waitcnt lgkmcnt(6)
M a[100:103], a[112:115], v[100:103], a[100:103]
M a[100:103], a[112:115], v[132:135], a[100:103]
M v[192:195], a[132:135], v[96:99], v[192:195]
v_exp_f32 v36, v36
M v[192:195], a[136:139], v[128:131], v[192:195]
ds_read_b128 a[164:167], v6 offset:38912
ds_read_b128 a[168:171], v6 offset:47104
M v[196:199], a[136:139], v[132:135], v[196:199]
v_exp_f32 v37, v37
M v[196:199], a[132:135], v[100:103], v[196:199]
v_cvt_pk_bf16_f32 v36, v36, v37
M v[200:203], a[132:135], v[104:107], v[200:203]
v_exp_f32 v38, v38
M v[200:203], a[136:139], v[136:139], v[200:203]
M v[204:207], a[136:139], v[140:143], v[204:207]
v_exp_f32 v39, v39
M v[204:207], a[132:135], v[108:111], v[204:207]
v_cvt_pk_bf16_f32 v37, v38, v39
s_waitcnt lgkmcnt(6)
M a[104:107], a[112:115], v[104:107], a[104:107]
M a[104:107], a[112:115], v[136:139], a[104:107]
M v[208:211], a[140:143], v[96:99], v[208:211]
v_exp_f32 v52, v52
M v[208:211], a[144:147], v[128:131], v[208:211]
ds_read_b128 a[172:175], v6 offset:39936
ds_read_b128 a[176:179], v6 offset:48128
M v[212:215], a[144:147], v[132:135], v[212:215]
v_exp_f32 v53, v53
M v[212:215], a[140:143], v[100:103], v[212:215]
v_cvt_pk_bf16_f32 v38, v52, v53
M v[216:219], a[140:143], v[104:107], v[216:219]
v_exp_f32 v54, v54
M v[216:219], a[144:147], v[136:139], v[216:219]
M v[220:223], a[144:147], v[140:143], v[220:223]
v_exp_f32 v55, v55
M v[220:223], a[140:143], v[108:111], v[220:223]
v_cvt_pk_bf16_f32 v39, v54, v55
s_waitcnt lgkmcnt(6)
M a[108:111], a[112:115], v[108:111], a[108:111]
M a[108:111], a[112:115], v[140:143], a[108:111]
M v[224:227], a[148:151], v[96:99], v[224:227]
v_exp_f32 v40, v40
M v[224:227], a[152:155], v[128:131], v[224:227]
M v[228:231], a[152:155], v[132:135], v[228:231]
v_exp_f32 v41, v41
M v[228:231], a[148:151], v[100:103], v[228:231]
v_cvt_pk_bf16_f32 v40, v40, v41
M v[232:235], a[148:151], v[104:107], v[232:235]
v_exp_f32 v42, v42
M v[232:235], a[152:155], v[136:139], v[232:235]
M v[236:239], a[152:155], v[140:143], v[236:239]
v_exp_f32 v43, v43
M v[236:239], a[148:151], v[108:111], v[236:239]
v_cvt_pk_bf16_f32 v41, v42, v43
s_waitcnt lgkmcnt(4)
M v[240:243], a[156:159], v[96:99], v[240:243]
v_exp_f32 v56, v56
M v[240:243], a[160:163], v[128:131], v[240:243]
M v[244:247], a[160:163], v[132:135], v[244:247]
v_exp_f32 v57, v57
M v[244:247], a[156:159], v[100:103], v[244:247]
v_cvt_pk_bf16_f32 v42, v56, v57
M v[248:251], a[156:159], v[104:107], v[248:251]
v_exp_f32 v58, v58
M v[248:251], a[160:163], v[136:139], v[248:251]
s_waitcnt vmcnt(0) lgkmcnt(0)
s_barrier
ds_read_b128 a[116:119], v2 offset:0
ds_read_b128 a[120:123], v2 offset:1024
M v[252:255], a[160:163], v[140:143], v[252:255]
v_exp_f32 v59, v59
M v[252:255], a[156:159], v[108:111], v[252:255]
v_cvt_pk_bf16_f32 v43, v58, v59
M a[64:67], a[164:167], v[96:99], a[64:67]
v_exp_f32 v44, v44
M a[64:67], a[168:171], v[128:131], a[64:67]
ds_read_b128 a[124:127], v2 offset:2048
ds_read_b128 a[128:131], v2 offset:3072
M a[68:71], a[168:171], v[132:135], a[68:71]
v_exp_f32 v45, v45
M a[68:71], a[164:167], v[100:103], a[68:71]
v_cvt_pk_bf16_f32 v44, v44, v45
M a[72:75], a[164:167], v[104:107], a[72:75]
v_exp_f32 v46, v46
M a[72:75], a[168:171], v[136:139], a[72:75]
ds_read_b128 a[132:135], v2 offset:4096
ds_read_b128 a[136:139], v2 offset:5120
M a[76:79], a[168:171], v[140:143], a[76:79]
v_exp_f32 v47, v47
M a[76:79], a[164:167], v[108:111], a[76:79]
v_cvt_pk_bf16_f32 v45, v46, v47
M a[80:83], a[172:175], v[96:99], a[80:83]
v_exp_f32 v60, v60
M a[80:83], a[176:179], v[128:131], a[80:83]
ds_read_b128 a[140:143], v2 offset:6144
ds_read_b128 a[144:147], v2 offset:7168
M a[84:87], a[176:179], v[132:135], a[84:87]
v_exp_f32 v61, v61
M a[84:87], a[172:175], v[100:103], a[84:87]
v_cvt_pk_bf16_f32 v46, v60, v61
M a[88:91], a[172:175], v[104:107], a[88:91]
v_exp_f32 v62, v62
M a[88:91], a[176:179], v[136:139], a[88:91]
M a[92:95], a[176:179], v[140:143], a[92:95]
v_exp_f32 v63, v63
M a[92:95], a[172:175], v[108:111], a[92:95]
v_cvt_pk_bf16_f32 v47, v62, v63
Lk2_m2a:
s_sub_u32 s35, 15, s21
s_lshl_b32 s33, s20, 7
s_lshl_b32 s34, s35, 3
s_add_u32 s33, s33, s34
s_lshl_b32 s34, s23, 2
s_add_u32 s33, s33, s34
s_lshl_b32 s33, s33, 12
buffer_load_dwordx4 a[180:183], v1, s[8:11], s33 offen offset:0 sc1
buffer_load_dwordx4 a[184:187], v1, s[8:11], s33 offen offset:1024 sc1
buffer_load_dwordx4 a[188:191], v1, s[8:11], s33 offen offset:2048 sc1
buffer_load_dwordx4 a[192:195], v1, s[8:11], s33 offen offset:3072 sc1
s_add_u32 s33, s33, 4096
buffer_load_dwordx4 a[196:199], v1, s[8:11], s33 offen offset:0 sc1
buffer_load_dwordx4 a[200:203], v1, s[8:11], s33 offen offset:1024 sc1
buffer_load_dwordx4 a[204:207], v1, s[8:11], s33 offen offset:2048 sc1
buffer_load_dwordx4 a[208:211], v1, s[8:11], s33 offen offset:3072 sc1
s_add_u32 s33, s33, 4096
buffer_load_dwordx4 a[212:215], v1, s[8:11], s33 offen offset:0 sc1
buffer_load_dwordx4 a[216:219], v1, s[8:11], s33 offen offset:1024 sc1
buffer_load_dwordx4 a[220:223], v1, s[8:11], s33 offen offset:2048 sc1
buffer_load_dwordx4 a[224:227], v1, s[8:11], s33 offen offset:3072 sc1
s_add_u32 s33, s33, 4096
buffer_load_dwordx4 a[228:231], v1, s[8:11], s33 offen offset:0 sc1
buffer_load_dwordx4 a[232:235], v1, s[8:11], s33 offen offset:1024 sc1
buffer_load_dwordx4 a[236:239], v1, s[8:11], s33 offen offset:2048 sc1
buffer_load_dwordx4 a[240:243], v1, s[8:11], s33 offen offset:3072 sc1
s_add_u32 m0, s29, 65536
s_nop 0
buffer_load_dwordx4 v1, s[12:15], s25 offen offset:0 sc1 lds
s_add_u32 s32, s25, 4096
buffer_load_dwordx4 v1, s[12:15], s25 offen offset:1024 sc1 lds
buffer_load_dwordx4 v1, s[12:15], s25 offen offset:2048 sc1 lds
buffer_load_dwordx4 v1, s[12:15], s25 offen offset:3072 sc1 lds
s_add_u32 m0, s29, 69632
s_nop 0
buffer_load_dwordx4 v1, s[12:15], s32 offen offset:0 sc1 lds
buffer_load_dwordx4 v1, s[12:15], s32 offen offset:1024 sc1 lds
buffer_load_dwordx4 v1, s[12:15], s32 offen offset:2048 sc1 lds
buffer_load_dwordx4 v1, s[12:15], s32 offen offset:3072 sc1 lds
s_add_u32 m0, s29, 98304
v_exp_f32 v72, v72
s_waitcnt lgkmcnt(7)
ds_read_b128 a[116:119], v5 offset:32768
s_waitcnt lgkmcnt(7)
ds_read_b128 a[120:123], v5 offset:40960
v_exp_f32 v73, v73
buffer_load_dwordx4 v1, s[12:15], s26 offen offset:0 sc1 lds
s_add_u32 s43, s26, 4096
v_exp_f32 v74, v74
v_cvt_pk_bf16_f32 v72, v72, v73
v_exp_f32 v75, v75
buffer_load_dwordx4 v1, s[12:15], s26 offen offset:1024 sc1 lds
s_waitcnt lgkmcnt(7)
ds_read_b128 a[124:127], v5 offset:33792
s_waitcnt lgkmcnt(7)
ds_read_b128 a[128:131], v5 offset:41984
buffer_load_dwordx4 v1, s[12:15], s26 offen offset:2048 sc1 lds
v_cvt_pk_bf16_f32 v73, v74, v75
v_mov_b32 v74, 0
buffer_load_dwordx4 v1, s[12:15], s26 offen offset:3072 sc1 lds
s_add_u32 m0, s29, 102400
v_exp_f32 v76, v76
s_waitcnt lgkmcnt(7)
ds_read_b128 a[132:135], v5 offset:34816
s_waitcnt lgkmcnt(7)
ds_read_b128 a[136:139], v5 offset:43008
v_exp_f32 v77, v77
buffer_load_dwordx4 v1, s[12:15], s43 offen offset:0 sc1 lds
v_exp_f32 v78, v78
v_mov_b32 v75, 0
v_cvt_pk_bf16_f32 v76, v76, v77
v_exp_f32 v79, v79
buffer_load_dwordx4 v1, s[12:15], s43 offen offset:1024 sc1 lds
v_exp_f32 v92, v92
s_waitcnt lgkmcnt(7)
ds_read_b128 a[140:143], v5 offset:35840
s_waitcnt lgkmcnt(7)
ds_read_b128 a[144:147], v5 offset:44032
v_exp_f32 v93, v93
buffer_load_dwordx4 v1, s[12:15], s43 offen offset:2048 sc1 lds
v_exp_f32 v94, v94
v_cvt_pk_bf16_f32 v77, v78, v79
v_cvt_pk_bf16_f32 v78, v92, v93
v_exp_f32 v95, v95
buffer_load_dwordx4 v1, s[12:15], s43 offen offset:3072 sc1 lds
v_cvt_pk_bf16_f32 v79, v94, v95
s_waitcnt lgkmcnt(6)
M v[160:163], a[116:119], v[32:35], v[160:163]
ds_read_b128 a[148:151], v5 offset:36864
ds_read_b128 a[152:155], v5 offset:45056
M v[164:167], a[116:119], v[36:39], v[164:167]
M v[168:171], a[116:119], v[40:43], v[168:171]
M v[168:171], a[120:123], v[72:75], v[168:171]
s_add_u32 s25, s25, 32768
s_cmp_eq_u32 s25, s27
M v[172:175], a[120:123], v[76:79], v[172:175]
M v[172:175], a[116:119], v[44:47], v[172:175]
s_waitcnt lgkmcnt(6)
M a[96:99], a[112:115], v[32:35], a[96:99]
s_cselect_b32 s25, s28, s25
s_cselect_b32 s27, -1, s27
s_add_u32 s26, s26, 32768
s_cmp_eq_u32 s26, s62
M v[176:179], a[124:127], v[32:35], v[176:179]
ds_read_b128 a[156:159], v5 offset:37888
ds_read_b128 a[160:163], v5 offset:46080
M v[180:183], a[124:127], v[36:39], v[180:183]
M v[184:187], a[124:127], v[40:43], v[184:187]
M v[184:187], a[128:131], v[72:75], v[184:187]
s_cselect_b32 s26, s63, s26
s_cselect_b32 s62, -1, s62
M v[188:191], a[128:131], v[76:79], v[188:191]
M v[188:191], a[124:127], v[44:47], v[188:191]
s_waitcnt lgkmcnt(6)
M a[100:103], a[112:115], v[36:39], a[100:103]
M v[192:195], a[132:135], v[32:35], v[192:195]
ds_read_b128 a[164:167], v5 offset:38912
ds_read_b128 a[168:171], v5 offset:47104
M v[196:199], a[132:135], v[36:39], v[196:199]
M v[200:203], a[132:135], v[40:43], v[200:203]
M v[200:203], a[136:139], v[72:75], v[200:203]
M v[204:207], a[136:139], v[76:79], v[204:207]
M v[204:207], a[132:135], v[44:47], v[204:207]
s_waitcnt lgkmcnt(6)
M a[104:107], a[112:115], v[40:43], a[104:107]
M a[104:107], a[112:115], v[72:75], a[104:107]
M v[208:211], a[140:143], v[32:35], v[208:211]
ds_read_b128 a[172:175], v5 offset:39936
ds_read_b128 a[176:179], v5 offset:48128
M v[212:215], a[140:143], v[36:39], v[212:215]
M v[216:219], a[140:143], v[40:43], v[216:219]
M v[216:219], a[144:147], v[72:75], v[216:219]
M v[220:223], a[144:147], v[76:79], v[220:223]
M v[220:223], a[140:143], v[44:47], v[220:223]
s_waitcnt lgkmcnt(6)
M a[108:111], a[112:115], v[44:47], a[108:111]
M a[108:111], a[112:115], v[76:79], a[108:111]
M v[224:227], a[148:151], v[32:35], v[224:227]
M v[228:231], a[148:151], v[36:39], v[228:231]
M v[232:235], a[148:151], v[40:43], v[232:235]
M v[232:235], a[152:155], v[72:75], v[232:235]
M v[236:239], a[152:155], v[76:79], v[236:239]
M v[236:239], a[148:151], v[44:47], v[236:239]
s_waitcnt lgkmcnt(4)
M v[240:243], a[156:159], v[32:35], v[240:243]
M v[244:247], a[156:159], v[36:39], v[244:247]
M v[248:251], a[156:159], v[40:43], v[248:251]
M v[248:251], a[160:163], v[72:75], v[248:251]
s_waitcnt vmcnt(0) lgkmcnt(0)
s_barrier
ds_read_b128 a[116:119], v3 offset:0
ds_read_b128 a[120:123], v3 offset:1024
M v[252:255], a[160:163], v[76:79], v[252:255]
M v[252:255], a[156:159], v[44:47], v[252:255]
M a[64:67], a[164:167], v[32:35], a[64:67]
ds_read_b128 a[124:127], v3 offset:2048
ds_read_b128 a[128:131], v3 offset:3072
M a[68:71], a[164:167], v[36:39], a[68:71]
M a[72:75], a[164:167], v[40:43], a[72:75]
M a[72:75], a[168:171], v[72:75], a[72:75]
ds_read_b128 a[132:135], v3 offset:4096
ds_read_b128 a[136:139], v3 offset:5120
M a[76:79], a[168:171], v[76:79], a[76:79]
M a[76:79], a[164:167], v[44:47], a[76:79]
M a[80:83], a[172:175], v[32:35], a[80:83]
ds_read_b128 a[140:143], v3 offset:6144
ds_read_b128 a[144:147], v3 offset:7168
M a[84:87], a[172:175], v[36:39], a[84:87]
M a[88:91], a[172:175], v[40:43], a[88:91]
M a[88:91], a[176:179], v[72:75], a[88:91]
M a[92:95], a[176:179], v[76:79], a[92:95]
M a[92:95], a[172:175], v[44:47], a[92:95]
s_waitcnt vmcnt(16)
s_add_u32 m0, s29, 0
s_waitcnt lgkmcnt(4)
M v[32:35], a[116:119], a[180:183], 0
M v[32:35], a[120:123], a[184:187], v[32:35]
ds_read_b128 a[148:151], v3 offset:8192
ds_read_b128 a[152:155], v3 offset:9216
M v[32:35], a[124:127], a[188:191], v[32:35]
M v[32:35], a[128:131], a[192:195], v[32:35]
buffer_load_dwordx4 v1, s[12:15], s25 offen offset:0 sc1 lds
s_add_u32 s32, s25, 4096
M v[36:39], a[128:131], a[208:211], 0
M v[36:39], a[124:127], a[204:207], v[36:39]
M v[36:39], a[120:123], a[200:203], v[36:39]
M v[36:39], a[116:119], a[196:199], v[36:39]
buffer_load_dwordx4 v1, s[12:15], s25 offen offset:1024 sc1 lds
M v[40:43], a[116:119], a[212:215], 0
M v[40:43], a[120:123], a[216:219], v[40:43]
ds_read_b128 a[156:159], v3 offset:10240
ds_read_b128 a[160:163], v3 offset:11264
M v[40:43], a[124:127], a[220:223], v[40:43]
M v[40:43], a[128:131], a[224:227], v[40:43]
buffer_load_dwordx4 v1, s[12:15], s25 offen offset:2048 sc1 lds
M v[44:47], a[128:131], a[240:243], 0
M v[44:47], a[124:127], a[236:239], v[44:47]
M v[44:47], a[120:123], a[232:235], v[44:47]
M v[44:47], a[116:119], a[228:231], v[44:47]
buffer_load_dwordx4 v1, s[12:15], s25 offen offset:3072 sc1 lds
s_add_u32 m0, s29, 4096
s_waitcnt lgkmcnt(4)
M v[48:51], a[132:135], a[180:183], 0
M v[48:51], a[136:139], a[184:187], v[48:51]
ds_read_b128 a[164:167], v3 offset:12288
ds_read_b128 a[168:171], v3 offset:13312
M v[48:51], a[140:143], a[188:191], v[48:51]
M v[48:51], a[144:147], a[192:195], v[48:51]
buffer_load_dwordx4 v1, s[12:15], s32 offen offset:0 sc1 lds
M v[52:55], a[144:147], a[208:211], 0
M v[52:55], a[140:143], a[204:207], v[52:55]
M v[52:55], a[136:139], a[200:203], v[52:55]
M v[52:55], a[132:135], a[196:199], v[52:55]
buffer_load_dwordx4 v1, s[12:15], s32 offen offset:1024 sc1 lds
M v[56:59], a[132:135], a[212:215], 0
M v[56:59], a[136:139], a[216:219], v[56:59]
ds_read_b128 a[172:175], v3 offset:14336
ds_read_b128 a[176:179], v3 offset:15360
M v[56:59], a[140:143], a[220:223], v[56:59]
M v[56:59], a[144:147], a[224:227], v[56:59]
buffer_load_dwordx4 v1, s[12:15], s32 offen offset:2048 sc1 lds
M v[60:63], a[144:147], a[240:243], 0
M v[60:63], a[140:143], a[236:239], v[60:63]
M v[60:63], a[136:139], a[232:235], v[60:63]
M v[60:63], a[132:135], a[228:231], v[60:63]
buffer_load_dwordx4 v1, s[12:15], s32 offen offset:3072 sc1 lds
s_add_u32 m0, s29, 32768
s_waitcnt lgkmcnt(4)
M v[64:67], a[148:151], a[180:183], 0
M v[64:67], a[152:155], a[184:187], v[64:67]
M v[64:67], a[156:159], a[188:191], v[64:67]
M v[64:67], a[160:163], a[192:195], v[64:67]
buffer_load_dwordx4 v1, s[12:15], s26 offen offset:0 sc1 lds
s_add_u32 s43, s26, 4096
M v[68:71], a[160:163], a[208:211], 0
M v[68:71], a[156:159], a[204:207], v[68:71]
M v[68:71], a[152:155], a[200:203], v[68:71]
M v[68:71], a[148:151], a[196:199], v[68:71]
buffer_load_dwordx4 v1, s[12:15], s26 offen offset:1024 sc1 lds
M v[72:75], a[148:151], a[212:215], 0
M v[72:75], a[152:155], a[216:219], v[72:75]
M v[72:75], a[156:159], a[220:223], v[72:75]
M v[72:75], a[160:163], a[224:227], v[72:75]
buffer_load_dwordx4 v1, s[12:15], s26 offen offset:2048 sc1 lds
M v[76:79], a[160:163], a[240:243], 0
M v[76:79], a[156:159], a[236:239], v[76:79]
M v[76:79], a[152:155], a[232:235], v[76:79]
M v[76:79], a[148:151], a[228:231], v[76:79]
buffer_load_dwordx4 v1, s[12:15], s26 offen offset:3072 sc1 lds
s_add_u32 m0, s29, 36864
s_waitcnt lgkmcnt(0)
M v[80:83], a[164:167], a[180:183], 0
M v[80:83], a[168:171], a[184:187], v[80:83]
M v[80:83], a[172:175], a[188:191], v[80:83]
M v[80:83], a[176:179], a[192:195], v[80:83]
buffer_load_dwordx4 v1, s[12:15], s43 offen offset:0 sc1 lds
M v[84:87], a[176:179], a[208:211], 0
M v[84:87], a[172:175], a[204:207], v[84:87]
M v[84:87], a[168:171], a[200:203], v[84:87]
M v[84:87], a[164:167], a[196:199], v[84:87]
buffer_load_dwordx4 v1, s[12:15], s43 offen offset:1024 sc1 lds
M v[88:91], a[164:167], a[212:215], 0
M v[88:91], a[168:171], a[216:219], v[88:91]
M v[88:91], a[172:175], a[220:223], v[88:91]
M v[88:91], a[176:179], a[224:227], v[88:91]
buffer_load_dwordx4 v1, s[12:15], s43 offen offset:2048 sc1 lds
M v[92:95], a[176:179], a[240:243], 0
M v[92:95], a[172:175], a[236:239], v[92:95]
M v[92:95], a[168:171], a[232:235], v[92:95]
M v[92:95], a[164:167], a[228:231], v[92:95]
buffer_load_dwordx4 v1, s[12:15], s43 offen offset:3072 sc1 lds
v_exp_f32 v32, v32
v_exp_f32 v33, v33
s_nop 0
v_cvt_pk_bf16_f32 v32, v32, v33
v_exp_f32 v34, v34
s_add_u32 s25, s25, 32768
s_cmp_eq_u32 s25, s27
v_exp_f32 v35, v35
s_nop 0
v_cvt_pk_bf16_f32 v33, v34, v35
s_cselect_b32 s25, s28, s25
s_cselect_b32 s27, -1, s27
s_add_u32 s26, s26, 32768
s_cmp_eq_u32 s26, s62
v_exp_f32 v48, v48
v_exp_f32 v49, v49
s_nop 0
v_cvt_pk_bf16_f32 v34, v48, v49
v_exp_f32 v50, v50
s_cselect_b32 s26, s63, s26
s_cselect_b32 s62, -1, s62
v_exp_f32 v51, v51
s_nop 0
v_cvt_pk_bf16_f32 v35, v50, v51
v_exp_f32 v36, v36
v_exp_f32 v37, v37
s_nop 0
v_cvt_pk_bf16_f32 v36, v36, v37
v_exp_f32 v38, v38
v_exp_f32 v39, v39
s_nop 0
v_cvt_pk_bf16_f32 v37, v38, v39
v_exp_f32 v52, v52
v_exp_f32 v53, v53
s_nop 0
v_cvt_pk_bf16_f32 v38, v52, v53
v_exp_f32 v54, v54
v_exp_f32 v55, v55
s_nop 0
v_cvt_pk_bf16_f32 v39, v54, v55
v_exp_f32 v40, v40
v_exp_f32 v41, v41
s_nop 0
v_cvt_pk_bf16_f32 v40, v40, v41
v_exp_f32 v42, v42
v_exp_f32 v43, v43
s_nop 0
v_cvt_pk_bf16_f32 v41, v42, v43
v_exp_f32 v56, v56
v_exp_f32 v57, v57
s_nop 0
v_cvt_pk_bf16_f32 v42, v56, v57
v_exp_f32 v58, v58
s_waitcnt vmcnt(0) lgkmcnt(0)
s_barrier
ds_read_b128 a[116:119], v2 offset:0
ds_read_b128 a[120:123], v2 offset:1024
v_exp_f32 v59, v59
s_nop 0
v_cvt_pk_bf16_f32 v43, v58, v59
v_exp_f32 v44, v44
ds_read_b128 a[124:127], v2 offset:2048
ds_read_b128 a[128:131], v2 offset:3072
v_exp_f32 v45, v45
s_nop 0
v_cvt_pk_bf16_f32 v44, v44, v45
v_exp_f32 v46, v46
ds_read_b128 a[132:135], v2 offset:4096
ds_read_b128 a[136:139], v2 offset:5120
v_exp_f32 v47, v47
s_nop 0
v_cvt_pk_bf16_f32 v45, v46, v47
v_exp_f32 v60, v60
ds_read_b128 a[140:143], v2 offset:6144
ds_read_b128 a[144:147], v2 offset:7168
v_exp_f32 v61, v61
s_nop 0
v_cvt_pk_bf16_f32 v46, v60, v61
v_exp_f32 v62, v62
v_exp_f32 v63, v63
s_nop 0
v_cvt_pk_bf16_f32 v47, v62, v63
s_branch Lk2_ea
Lk2_m2:
s_cmp_eq_u32 s23, 0
s_cbranch_scc1 Lk2_m2a
s_branch Lk2_m2b
Lk2_m1b:
s_add_u32 m0, s29, 0
s_waitcnt lgkmcnt(4)
M v[32:35], a[116:119], a[0:3], 0
v_exp_f32 v128, v128
M v[32:35], a[120:123], a[4:7], v[32:35]
ds_read_b128 a[148:151], v3 offset:8192
ds_read_b128 a[152:155], v3 offset:9216
M v[32:35], a[124:127], a[8:11], v[32:35]
v_exp_f32 v129, v129
M v[32:35], a[128:131], a[12:15], v[32:35]
buffer_load_dwordx4 v1, s[12:15], s25 offen offset:0 sc1 lds
s_add_u32 s32, s25, 4096
M v[36:39], a[128:131], a[28:31], 0
v_exp_f32 v130, v130
M v[36:39], a[124:127], a[24:27], v[36:39]
v_cvt_pk_bf16_f32 v128, v128, v129
M v[36:39], a[120:123], a[20:23], v[36:39]
v_exp_f32 v131, v131
M v[36:39], a[116:119], a[16:19], v[36:39]
buffer_load_dwordx4 v1, s[12:15], s25 offen offset:1024 sc1 lds
M v[40:43], a[116:119], a[32:35], 0
v_exp_f32 v144, v144
M v[40:43], a[120:123], a[36:39], v[40:43]
ds_read_b128 a[156:159], v3 offset:10240
ds_read_b128 a[160:163], v3 offset:11264
M v[40:43], a[124:127], a[40:43], v[40:43]
v_exp_f32 v145, v145
M v[40:43], a[128:131], a[44:47], v[40:43]
buffer_load_dwordx4 v1, s[12:15], s25 offen offset:2048 sc1 lds
M v[44:47], a[128:131], a[60:63], 0
v_exp_f32 v146, v146
M v[44:47], a[124:127], a[56:59], v[44:47]
v_cvt_pk_bf16_f32 v129, v130, v131
v_cvt_pk_bf16_f32 v130, v144, v145
M v[44:47], a[120:123], a[52:55], v[44:47]
v_exp_f32 v147, v147
M v[44:47], a[116:119], a[48:51], v[44:47]
buffer_load_dwordx4 v1, s[12:15], s25 offen offset:3072 sc1 lds
s_add_u32 m0, s29, 4096
s_waitcnt lgkmcnt(4)
M v[48:51], a[132:135], a[0:3], 0
v_exp_f32 v132, v132
M v[48:51], a[136:139], a[4:7], v[48:51]
ds_read_b128 a[164:167], v3 offset:12288
ds_read_b128 a[168:171], v3 offset:13312
M v[48:51], a[140:143], a[8:11], v[48:51]
v_exp_f32 v133, v133
M v[48:51], a[144:147], a[12:15], v[48:51]
buffer_load_dwordx4 v1, s[12:15], s32 offen offset:0 sc1 lds
M v[52:55], a[144:147], a[28:31], 0
v_exp_f32 v134, v134
M v[52:55], a[140:143], a[24:27], v[52:55]
v_cvt_pk_bf16_f32 v131, v146, v147
v_cvt_pk_bf16_f32 v132, v132, v133
M v[52:55], a[136:139], a[20:23], v[52:55]
v_exp_f32 v135, v135
M v[52:55], a[132:135], a[16:19], v[52:55]
buffer_load_dwordx4 v1, s[12:15], s32 offen offset:1024 sc1 lds
M v[56:59], a[132:135], a[32:35], 0
v_exp_f32 v148, v148
M v[56:59], a[136:139], a[36:39], v[56:59]
ds_read_b128 a[172:175], v3 offset:14336
ds_read_b128 a[176:179], v3 offset:15360
M v[56:59], a[140:143], a[40:43], v[56:59]
v_exp_f32 v149, v149
M v[56:59], a[144:147], a[44:47], v[56:59]
buffer_load_dwordx4 v1, s[12:15], s32 offen offset:2048 sc1 lds
M v[60:63], a[144:147], a[60:63], 0
v_exp_f32 v150, v150
M v[60:63], a[140:143], a[56:59], v[60:63]
v_cvt_pk_bf16_f32 v133, v134, v135
v_cvt_pk_bf16_f32 v134, v148, v149
M v[60:63], a[136:139], a[52:55], v[60:63]
v_exp_f32 v151, v151
M v[60:63], a[132:135], a[48:51], v[60:63]
buffer_load_dwordx4 v1, s[12:15], s32 offen offset:3072 sc1 lds
s_add_u32 m0, s29, 32768
s_waitcnt lgkmcnt(4)
M v[64:67], a[148:151], a[0:3], 0
v_exp_f32 v136, v136
M v[64:67], a[152:155], a[4:7], v[64:67]
ds_read_b128 a[116:119], v6 offset:32768
ds_read_b128 a[120:123], v6 offset:40960
M v[64:67], a[156:159], a[8:11], v[64:67]
v_exp_f32 v137, v137
M v[64:67], a[160:163], a[12:15], v[64:67]
buffer_load_dwordx4 v1, s[12:15], s26 offen offset:0 sc1 lds
s_add_u32 s43, s26, 4096
M v[68:71], a[160:163], a[28:31], 0
v_exp_f32 v138, v138
M v[68:71], a[156:159], a[24:27], v[68:71]
v_cvt_pk_bf16_f32 v135, v150, v151
v_cvt_pk_bf16_f32 v136, v136, v137
M v[68:71], a[152:155], a[20:23], v[68:71]
v_exp_f32 v139, v139
M v[68:71], a[148:151], a[16:19], v[68:71]
buffer_load_dwordx4 v1, s[12:15], s26 offen offset:1024 sc1 lds
M v[72:75], a[148:151], a[32:35], 0
v_exp_f32 v152, v152
M v[72:75], a[152:155], a[36:39], v[72:75]
ds_read_b128 a[124:127], v6 offset:33792
ds_read_b128 a[128:131], v6 offset:41984
M v[72:75], a[156:159], a[40:43], v[72:75]
v_exp_f32 v153, v153
M v[72:75], a[160:163], a[44:47], v[72:75]
buffer_load_dwordx4 v1, s[12:15], s26 offen offset:2048 sc1 lds
M v[76:79], a[160:163], a[60:63], 0
v_exp_f32 v154, v154
M v[76:79], a[156:159], a[56:59], v[76:79]
v_cvt_pk_bf16_f32 v137, v138, v139
v_cvt_pk_bf16_f32 v138, v152, v153
M v[76:79], a[152:155], a[52:55], v[76:79]
v_exp_f32 v155, v155
M v[76:79], a[148:151], a[48:51], v[76:79]
buffer_load_dwordx4 v1, s[12:15], s26 offen offset:3072 sc1 lds
s_add_u32 m0, s29, 36864
s_waitcnt lgkmcnt(4)
M v[80:83], a[164:167], a[0:3], 0
v_exp_f32 v140, v140
M v[80:83], a[168:171], a[4:7], v[80:83]
ds_read_b128 a[132:135], v6 offset:34816
ds_read_b128 a[136:139], v6 offset:43008
M v[80:83], a[172:175], a[8:11], v[80:83]
v_exp_f32 v141, v141
M v[80:83], a[176:179], a[12:15], v[80:83]
buffer_load_dwordx4 v1, s[12:15], s43 offen offset:0 sc1 lds
M v[84:87], a[176:179], a[28:31], 0
v_exp_f32 v142, v142
M v[84:87], a[172:175], a[24:27], v[84:87]
v_cvt_pk_bf16_f32 v139, v154, v155
v_cvt_pk_bf16_f32 v140, v140, v141
M v[84:87], a[168:171], a[20:23], v[84:87]
v_exp_f32 v143, v143
M v[84:87], a[164:167], a[16:19], v[84:87]
buffer_load_dwordx4 v1, s[12:15], s43 offen offset:1024 sc1 lds
M v[88:91], a[164:167], a[32:35], 0
v_exp_f32 v156, v156
M v[88:91], a[168:171], a[36:39], v[88:91]
ds_read_b128 a[140:143], v6 offset:35840
ds_read_b128 a[144:147], v6 offset:44032
M v[88:91], a[172:175], a[40:43], v[88:91]
v_exp_f32 v157, v157
M v[88:91], a[176:179], a[44:47], v[88:91]
buffer_load_dwordx4 v1, s[12:15], s43 offen offset:2048 sc1 lds
M v[92:95], a[176:179], a[60:63], 0
v_exp_f32 v158, v158
M v[92:95], a[172:175], a[56:59], v[92:95]
v_cvt_pk_bf16_f32 v141, v142, v143
v_cvt_pk_bf16_f32 v142, v156, v157
M v[92:95], a[168:171], a[52:55], v[92:95]
v_exp_f32 v159, v159
M v[92:95], a[164:167], a[48:51], v[92:95]
buffer_load_dwordx4 v1, s[12:15], s43 offen offset:3072 sc1 lds
v_cvt_pk_bf16_f32 v143, v158, v159
s_waitcnt lgkmcnt(6)
M v[160:163], a[116:119], v[96:99], v[160:163]
v_exp_f32 v32, v32
M v[160:163], a[120:123], v[128:131], v[160:163]
ds_read_b128 a[148:151], v6 offset:36864
ds_read_b128 a[152:155], v6 offset:45056
M v[164:167], a[120:123], v[132:135], v[164:167]
v_exp_f32 v33, v33
M v[164:167], a[116:119], v[100:103], v[164:167]
v_cvt_pk_bf16_f32 v32, v32, v33
M v[168:171], a[116:119], v[104:107], v[168:171]
v_exp_f32 v34, v34
M v[168:171], a[120:123], v[136:139], v[168:171]
s_add_u32 s25, s25, 32768
s_cmp_eq_u32 s25, s27
M v[172:175], a[120:123], v[140:143], v[172:175]
v_exp_f32 v35, v35
M v[172:175], a[116:119], v[108:111], v[172:175]
v_cvt_pk_bf16_f32 v33, v34, v35
s_waitcnt lgkmcnt(6)
M a[96:99], a[112:115], v[96:99], a[96:99]
s_cselect_b32 s25, s28, s25
s_cselect_b32 s27, -1, s27
M a[96:99], a[112:115], v[128:131], a[96:99]
s_add_u32 s26, s26, 32768
s_cmp_eq_u32 s26, s62
M v[176:179], a[124:127], v[96:99], v[176:179]
v_exp_f32 v48, v48
M v[176:179], a[128:131], v[128:131], v[176:179]
ds_read_b128 a[156:159], v6 offset:37888
ds_read_b128 a[160:163], v6 offset:46080
M v[180:183], a[128:131], v[132:135], v[180:183]
v_exp_f32 v49, v49
M v[180:183], a[124:127], v[100:103], v[180:183]
v_cvt_pk_bf16_f32 v34, v48, v49
M v[184:187], a[124:127], v[104:107], v[184:187]
v_exp_f32 v50, v50
M v[184:187], a[128:131], v[136:139], v[184:187]
s_cselect_b32 s26, s63, s26
s_cselect_b32 s62, -1, s62
M v[188:191], a[128:131], v[140:143], v[188:191]
v_exp_f32 v51, v51
M v[188:191], a[124:127], v[108:111], v[188:191]
v_cvt_pk_bf16_f32 v35, v50, v51
s_waitcnt lgkmcnt(6)
M a[100:103], a[112:115], v[100:103], a[100:103]
M a[100:103], a[112:115], v[132:135], a[100:103]
M v[192:195], a[132:135], v[96:99], v[192:195]
v_exp_f32 v36, v36
M v[192:195], a[136:139], v[128:131], v[192:195]
ds_read_b128 a[164:167], v6 offset:38912
ds_read_b128 a[168:171], v6 offset:47104
M v[196:199], a[136:139], v[132:135], v[196:199]
v_exp_f32 v37, v37
M v[196:199], a[132:135], v[100:103], v[196:199]
v_cvt_pk_bf16_f32 v36, v36, v37
M v[200:203], a[132:135], v[104:107], v[200:203]
v_exp_f32 v38, v38
M v[200:203], a[136:139], v[136:139], v[200:203]
M v[204:207], a[136:139], v[140:143], v[204:207]
v_exp_f32 v39, v39
M v[204:207], a[132:135], v[108:111], v[204:207]
v_cvt_pk_bf16_f32 v37, v38, v39
s_waitcnt lgkmcnt(6)
M a[104:107], a[112:115], v[104:107], a[104:107]
M a[104:107], a[112:115], v[136:139], a[104:107]
M v[208:211], a[140:143], v[96:99], v[208:211]
v_exp_f32 v52, v52
M v[208:211], a[144:147], v[128:131], v[208:211]
ds_read_b128 a[172:175], v6 offset:39936
ds_read_b128 a[176:179], v6 offset:48128
M v[212:215], a[144:147], v[132:135], v[212:215]
v_exp_f32 v53, v53
M v[212:215], a[140:143], v[100:103], v[212:215]
v_cvt_pk_bf16_f32 v38, v52, v53
M v[216:219], a[140:143], v[104:107], v[216:219]
v_exp_f32 v54, v54
M v[216:219], a[144:147], v[136:139], v[216:219]
M v[220:223], a[144:147], v[140:143], v[220:223]
v_exp_f32 v55, v55
M v[220:223], a[140:143], v[108:111], v[220:223]
v_cvt_pk_bf16_f32 v39, v54, v55
s_waitcnt lgkmcnt(6)
M a[108:111], a[112:115], v[108:111], a[108:111]
M a[108:111], a[112:115], v[140:143], a[108:111]
M v[224:227], a[148:151], v[96:99], v[224:227]
v_exp_f32 v40, v40
M v[224:227], a[152:155], v[128:131], v[224:227]
M v[228:231], a[152:155], v[132:135], v[228:231]
v_exp_f32 v41, v41
M v[228:231], a[148:151], v[100:103], v[228:231]
v_cvt_pk_bf16_f32 v40, v40, v41
M v[232:235], a[148:151], v[104:107], v[232:235]
v_exp_f32 v42, v42
M v[232:235], a[152:155], v[136:139], v[232:235]
M v[236:239], a[152:155], v[140:143], v[236:239]
v_exp_f32 v43, v43
M v[236:239], a[148:151], v[108:111], v[236:239]
v_cvt_pk_bf16_f32 v41, v42, v43
s_waitcnt lgkmcnt(4)
M v[240:243], a[156:159], v[96:99], v[240:243]
v_exp_f32 v56, v56
M v[240:243], a[160:163], v[128:131], v[240:243]
M v[244:247], a[160:163], v[132:135], v[244:247]
v_exp_f32 v57, v57
M v[244:247], a[156:159], v[100:103], v[244:247]
v_cvt_pk_bf16_f32 v42, v56, v57
M v[248:251], a[156:159], v[104:107], v[248:251]
v_exp_f32 v58, v58
M v[248:251], a[160:163], v[136:139], v[248:251]
s_waitcnt vmcnt(0) lgkmcnt(0)
s_barrier
ds_read_b128 a[116:119], v2 offset:0
ds_read_b128 a[120:123], v2 offset:1024
M v[252:255], a[160:163], v[140:143], v[252:255]
v_exp_f32 v59, v59
M v[252:255], a[156:159], v[108:111], v[252:255]
v_cvt_pk_bf16_f32 v43, v58, v59
M a[64:67], a[164:167], v[96:99], a[64:67]
v_exp_f32 v44, v44
M a[64:67], a[168:171], v[128:131], a[64:67]
ds_read_b128 a[124:127], v2 offset:2048
ds_read_b128 a[128:131], v2 offset:3072
M a[68:71], a[168:171], v[132:135], a[68:71]
v_exp_f32 v45, v45
M a[68:71], a[164:167], v[100:103], a[68:71]
v_cvt_pk_bf16_f32 v44, v44, v45
M a[72:75], a[164:167], v[104:107], a[72:75]
v_exp_f32 v46, v46
M a[72:75], a[168:171], v[136:139], a[72:75]
ds_read_b128 a[132:135], v2 offset:4096
ds_read_b128 a[136:139], v2 offset:5120
M a[76:79], a[168:171], v[140:143], a[76:79]
v_exp_f32 v47, v47
M a[76:79], a[164:167], v[108:111], a[76:79]
v_cvt_pk_bf16_f32 v45, v46, v47
M a[80:83], a[172:175], v[96:99], a[80:83]
v_exp_f32 v60, v60
M a[80:83], a[176:179], v[128:131], a[80:83]
ds_read_b128 a[140:143], v2 offset:6144
ds_read_b128 a[144:147], v2 offset:7168
M a[84:87], a[176:179], v[132:135], a[84:87]
v_exp_f32 v61, v61
M a[84:87], a[172:175], v[100:103], a[84:87]
v_cvt_pk_bf16_f32 v46, v60, v61
M a[88:91], a[172:175], v[104:107], a[88:91]
v_exp_f32 v62, v62
M a[88:91], a[176:179], v[136:139], a[88:91]
M a[92:95], a[176:179], v[140:143], a[92:95]
v_exp_f32 v63, v63
M a[92:95], a[172:175], v[108:111], a[92:95]
v_cvt_pk_bf16_f32 v47, v62, v63
Lk2_m2b:
s_sub_u32 s35, 15, s21
s_lshl_b32 s33, s20, 7
s_lshl_b32 s34, s35, 3
s_add_u32 s33, s33, s34
s_lshl_b32 s34, s23, 2
s_add_u32 s33, s33, s34
s_lshl_b32 s33, s33, 12
buffer_load_dwordx4 a[180:183], v1, s[8:11], s33 offen offset:0 sc1
buffer_load_dwordx4 a[184:187], v1, s[8:11], s33 offen offset:1024 sc1
buffer_load_dwordx4 a[188:191], v1, s[8:11], s33 offen offset:2048 sc1
buffer_load_dwordx4 a[192:195], v1, s[8:11], s33 offen offset:3072 sc1
s_add_u32 s33, s33, 4096
buffer_load_dwordx4 a[196:199], v1, s[8:11], s33 offen offset:0 sc1
buffer_load_dwordx4 a[200:203], v1, s[8:11], s33 offen offset:1024 sc1
buffer_load_dwordx4 a[204:207], v1, s[8:11], s33 offen offset:2048 sc1
buffer_load_dwordx4 a[208:211], v1, s[8:11], s33 offen offset:3072 sc1
s_add_u32 s33, s33, 4096
buffer_load_dwordx4 a[212:215], v1, s[8:11], s33 offen offset:0 sc1
buffer_load_dwordx4 a[216:219], v1, s[8:11], s33 offen offset:1024 sc1
buffer_load_dwordx4 a[220:223], v1, s[8:11], s33 offen offset:2048 sc1
buffer_load_dwordx4 a[224:227], v1, s[8:11], s33 offen offset:3072 sc1
s_add_u32 s33, s33, 4096
buffer_load_dwordx4 a[228:231], v1, s[8:11], s33 offen offset:0 sc1
buffer_load_dwordx4 a[232:235], v1, s[8:11], s33 offen offset:1024 sc1
buffer_load_dwordx4 a[236:239], v1, s[8:11], s33 offen offset:2048 sc1
buffer_load_dwordx4 a[240:243], v1, s[8:11], s33 offen offset:3072 sc1
s_add_u32 m0, s29, 65536
s_waitcnt lgkmcnt(4)
M v[96:99], a[116:119], a[0:3], v[16:19]
v_exp_f32 v64, v64
M v[96:99], a[120:123], a[4:7], v[96:99]
ds_read_b128 a[148:151], v2 offset:8192
ds_read_b128 a[152:155], v2 offset:9216
M v[96:99], a[124:127], a[8:11], v[96:99]
v_exp_f32 v65, v65
M v[96:99], a[128:131], a[12:15], v[96:99]
buffer_load_dwordx4 v1, s[12:15], s25 offen offset:0 sc1 lds
s_add_u32 s32, s25, 4096
M v[100:103], a[128:131], a[28:31], 0
v_exp_f32 v66, v66
M v[100:103], a[124:127], a[24:27], v[100:103]
v_cvt_pk_bf16_f32 v64, v64, v65
M v[100:103], a[120:123], a[20:23], v[100:103]
v_exp_f32 v67, v67
M v[100:103], a[116:119], a[16:19], v[100:103]
buffer_load_dwordx4 v1, s[12:15], s25 offen offset:1024 sc1 lds
M v[104:107], a[116:119], a[32:35], 0
v_exp_f32 v80, v80
M v[104:107], a[120:123], a[36:39], v[104:107]
ds_read_b128 a[156:159], v2 offset:10240
ds_read_b128 a[160:163], v2 offset:11264
M v[104:107], a[124:127], a[40:43], v[104:107]
v_exp_f32 v81, v81
M v[104:107], a[128:131], a[44:47], v[104:107]
buffer_load_dwordx4 v1, s[12:15], s25 offen offset:2048 sc1 lds
M v[108:111], a[128:131], a[60:63], 0
v_exp_f32 v82, v82
M v[108:111], a[124:127], a[56:59], v[108:111]
v_cvt_pk_bf16_f32 v65, v66, v67
v_cvt_pk_bf16_f32 v66, v80, v81
M v[108:111], a[120:123], a[52:55], v[108:111]
v_exp_f32 v83, v83
M v[108:111], a[116:119], a[48:51], v[108:111]
buffer_load_dwordx4 v1, s[12:15], s25 offen offset:3072 sc1 lds
s_add_u32 m0, s29, 69632
s_waitcnt lgkmcnt(4)
v_exp_f32 v68, v68
ds_read_b128 a[164:167], v2 offset:12288
ds_read_b128 a[168:171], v2 offset:13312
v_exp_f32 v69, v69
buffer_load_dwordx4 v1, s[12:15], s32 offen offset:0 sc1 lds
M v[116:119], a[144:147], a[28:31], v[16:19]
v_exp_f32 v70, v70
M v[116:119], a[140:143], a[24:27], v[116:119]
v_cvt_pk_bf16_f32 v67, v82, v83
v_cvt_pk_bf16_f32 v68, v68, v69
M v[116:119], a[136:139], a[20:23], v[116:119]
v_exp_f32 v71, v71
M v[116:119], a[132:135], a[16:19], v[116:119]
buffer_load_dwordx4 v1, s[12:15], s32 offen offset:1024 sc1 lds
M v[120:123], a[132:135], a[32:35], 0
v_exp_f32 v84, v84
M v[120:123], a[136:139], a[36:39], v[120:123]
ds_read_b128 a[172:175], v2 offset:14336
ds_read_b128 a[176:179], v2 offset:15360
M v[120:123], a[140:143], a[40:43], v[120:123]
v_exp_f32 v85, v85
M v[120:123], a[144:147], a[44:47], v[120:123]
buffer_load_dwordx4 v1, s[12:15], s32 offen offset:2048 sc1 lds
M v[124:127], a[144:147], a[60:63], 0
v_exp_f32 v86, v86
M v[124:127], a[140:143], a[56:59], v[124:127]
v_cvt_pk_bf16_f32 v69, v70, v71
v_cvt_pk_bf16_f32 v70, v84, v85
M v[124:127], a[136:139], a[52:55], v[124:127]
v_exp_f32 v87, v87
M v[124:127], a[132:135], a[48:51], v[124:127]
buffer_load_dwordx4 v1, s[12:15], s32 offen offset:3072 sc1 lds
s_add_u32 m0, s29, 98304
s_waitcnt lgkmcnt(4)
v_exp_f32 v72, v72
ds_read_b128 a[116:119], v5 offset:32768
ds_read_b128 a[120:123], v5 offset:40960
v_exp_f32 v73, v73
buffer_load_dwordx4 v1, s[12:15], s26 offen offset:0 sc1 lds
s_add_u32 s43, s26, 4096
v_exp_f32 v74, v74
v_cvt_pk_bf16_f32 v71, v86, v87
v_cvt_pk_bf16_f32 v72, v72, v73
v_exp_f32 v75, v75
buffer_load_dwordx4 v1, s[12:15], s26 offen offset:1024 sc1 lds
M v[136:139], a[148:151], a[32:35], v[16:19]
v_exp_f32 v88, v88
M v[136:139], a[152:155], a[36:39], v[136:139]
ds_read_b128 a[124:127], v5 offset:33792
ds_read_b128 a[128:131], v5 offset:41984
M v[136:139], a[156:159], a[40:43], v[136:139]
v_exp_f32 v89, v89
M v[136:139], a[160:163], a[44:47], v[136:139]
buffer_load_dwordx4 v1, s[12:15], s26 offen offset:2048 sc1 lds
M v[140:143], a[160:163], a[60:63], 0
v_exp_f32 v90, v90
M v[140:143], a[156:159], a[56:59], v[140:143]
v_cvt_pk_bf16_f32 v73, v74, v75
v_cvt_pk_bf16_f32 v74, v88, v89
M v[140:143], a[152:155], a[52:55], v[140:143]
v_exp_f32 v91, v91
M v[140:143], a[148:151], a[48:51], v[140:143]
buffer_load_dwordx4 v1, s[12:15], s26 offen offset:3072 sc1 lds
s_add_u32 m0, s29, 102400
s_waitcnt lgkmcnt(4)
v_exp_f32 v76, v76
ds_read_b128 a[132:135], v5 offset:34816
ds_read_b128 a[136:139], v5 offset:43008
v_exp_f32 v77, v77
buffer_load_dwordx4 v1, s[12:15], s43 offen offset:0 sc1 lds
v_exp_f32 v78, v78
v_cvt_pk_bf16_f32 v75, v90, v91
v_cvt_pk_bf16_f32 v76, v76, v77
v_exp_f32 v79, v79
buffer_load_dwordx4 v1, s[12:15], s43 offen offset:1024 sc1 lds
v_exp_f32 v92, v92
ds_read_b128 a[140:143], v5 offset:35840
ds_read_b128 a[144:147], v5 offset:44032
v_exp_f32 v93, v93
buffer_load_dwordx4 v1, s[12:15], s43 offen offset:2048 sc1 lds
M v[156:159], a[176:179], a[60:63], v[16:19]
v_exp_f32 v94, v94
M v[156:159], a[172:175], a[56:59], v[156:159]
v_cvt_pk_bf16_f32 v77, v78, v79
v_cvt_pk_bf16_f32 v78, v92, v93
M v[156:159], a[168:171], a[52:55], v[156:159]
v_exp_f32 v95, v95
M v[156:159], a[164:167], a[48:51], v[156:159]
buffer_load_dwordx4 v1, s[12:15], s43 offen offset:3072 sc1 lds
v_cvt_pk_bf16_f32 v79, v94, v95
s_waitcnt lgkmcnt(6)
M v[160:163], a[116:119], v[32:35], v[160:163]
v_exp_f32 v96, v96
M v[160:163], a[120:123], v[64:67], v[160:163]
ds_read_b128 a[148:151], v5 offset:36864
ds_read_b128 a[152:155], v5 offset:45056
M v[164:167], a[120:123], v[68:71], v[164:167]
v_exp_f32 v97, v97
M v[164:167], a[116:119], v[36:39], v[164:167]
v_cvt_pk_bf16_f32 v96, v96, v97
M v[168:171], a[116:119], v[40:43], v[168:171]
v_exp_f32 v98, v98
M v[168:171], a[120:123], v[72:75], v[168:171]
s_add_u32 s25, s25, 32768
s_cmp_eq_u32 s25, s27
M v[172:175], a[120:123], v[76:79], v[172:175]
v_exp_f32 v99, v99
M v[172:175], a[116:119], v[44:47], v[172:175]
v_cvt_pk_bf16_f32 v97, v98, v99
s_waitcnt lgkmcnt(6)
M a[96:99], a[112:115], v[32:35], a[96:99]
s_cselect_b32 s25, s28, s25
s_cselect_b32 s27, -1, s27
M a[96:99], a[112:115], v[64:67], a[96:99]
s_add_u32 s26, s26, 32768
s_cmp_eq_u32 s26, s62
M v[176:179], a[124:127], v[32:35], v[176:179]
M v[176:179], a[128:131], v[64:67], v[176:179]
ds_read_b128 a[156:159], v5 offset:37888
ds_read_b128 a[160:163], v5 offset:46080
M v[180:183], a[128:131], v[68:71], v[180:183]
M v[180:183], a[124:127], v[36:39], v[180:183]
v_mov_b32 v98, 0
M v[184:187], a[124:127], v[40:43], v[184:187]
M v[184:187], a[128:131], v[72:75], v[184:187]
s_cselect_b32 s26, s63, s26
s_cselect_b32 s62, -1, s62
M v[188:191], a[128:131], v[76:79], v[188:191]
M v[188:191], a[124:127], v[44:47], v[188:191]
v_mov_b32 v99, 0
s_waitcnt lgkmcnt(6)
M a[100:103], a[112:115], v[36:39], a[100:103]
M a[100:103], a[112:115], v[68:71], a[100:103]
M v[192:195], a[132:135], v[32:35], v[192:195]
v_exp_f32 v100, v100
M v[192:195], a[136:139], v[64:67], v[192:195]
ds_read_b128 a[164:167], v5 offset:38912
ds_read_b128 a[168:171], v5 offset:47104
M v[196:199], a[136:139], v[68:71], v[196:199]
v_exp_f32 v101, v101
M v[196:199], a[132:135], v[36:39], v[196:199]
v_cvt_pk_bf16_f32 v100, v100, v101
M v[200:203], a[132:135], v[40:43], v[200:203]
v_exp_f32 v102, v102
M v[200:203], a[136:139], v[72:75], v[200:203]
M v[204:207], a[136:139], v[76:79], v[204:207]
v_exp_f32 v103, v103
M v[204:207], a[132:135], v[44:47], v[204:207]
v_cvt_pk_bf16_f32 v101, v102, v103
s_waitcnt lgkmcnt(6)
M a[104:107], a[112:115], v[40:43], a[104:107]
M a[104:107], a[112:115], v[72:75], a[104:107]
M v[208:211], a[140:143], v[32:35], v[208:211]
v_exp_f32 v116, v116
M v[208:211], a[144:147], v[64:67], v[208:211]
ds_read_b128 a[172:175], v5 offset:39936
ds_read_b128 a[176:179], v5 offset:48128
M v[212:215], a[144:147], v[68:71], v[212:215]
v_exp_f32 v117, v117
M v[212:215], a[140:143], v[36:39], v[212:215]
v_cvt_pk_bf16_f32 v102, v116, v117
M v[216:219], a[140:143], v[40:43], v[216:219]
v_exp_f32 v118, v118
M v[216:219], a[144:147], v[72:75], v[216:219]
M v[220:223], a[144:147], v[76:79], v[220:223]
v_exp_f32 v119, v119
M v[220:223], a[140:143], v[44:47], v[220:223]
v_cvt_pk_bf16_f32 v103, v118, v119
s_waitcnt lgkmcnt(6)
M a[108:111], a[112:115], v[44:47], a[108:111]
M a[108:111], a[112:115], v[76:79], a[108:111]
M v[224:227], a[148:151], v[32:35], v[224:227]
v_exp_f32 v104, v104
M v[224:227], a[152:155], v[64:67], v[224:227]
M v[228:231], a[152:155], v[68:71], v[228:231]
v_exp_f32 v105, v105
M v[228:231], a[148:151], v[36:39], v[228:231]
v_cvt_pk_bf16_f32 v104, v104, v105
M v[232:235], a[148:151], v[40:43], v[232:235]
v_exp_f32 v106, v106
M v[232:235], a[152:155], v[72:75], v[232:235]
M v[236:239], a[152:155], v[76:79], v[236:239]
v_exp_f32 v107, v107
M v[236:239], a[148:151], v[44:47], v[236:239]
v_cvt_pk_bf16_f32 v105, v106, v107
s_waitcnt lgkmcnt(4)
M v[240:243], a[156:159], v[32:35], v[240:243]
v_exp_f32 v120, v120
M v[240:243], a[160:163], v[64:67], v[240:243]
M v[244:247], a[160:163], v[68:71], v[244:247]
v_exp_f32 v121, v121
M v[244:247], a[156:159], v[36:39], v[244:247]
v_cvt_pk_bf16_f32 v106, v120, v121
M v[248:251], a[156:159], v[40:43], v[248:251]
v_exp_f32 v122, v122
M v[248:251], a[160:163], v[72:75], v[248:251]
s_waitcnt vmcnt(0) lgkmcnt(0)
s_barrier
ds_read_b128 a[116:119], v3 offset:0
ds_read_b128 a[120:123], v3 offset:1024
M v[252:255], a[160:163], v[76:79], v[252:255]
v_exp_f32 v123, v123
M v[252:255], a[156:159], v[44:47], v[252:255]
v_cvt_pk_bf16_f32 v107, v122, v123
M a[64:67], a[164:167], v[32:35], a[64:67]
v_exp_f32 v108, v108
M a[64:67], a[168:171], v[64:67], a[64:67]
ds_read_b128 a[124:127], v3 offset:2048
ds_read_b128 a[128:131], v3 offset:3072
M a[68:71], a[168:171], v[68:71], a[68:71]
v_exp_f32 v109, v109
M a[68:71], a[164:167], v[36:39], a[68:71]
v_cvt_pk_bf16_f32 v108, v108, v109
M a[72:75], a[164:167], v[40:43], a[72:75]
v_exp_f32 v110, v110
M a[72:75], a[168:171], v[72:75], a[72:75]
ds_read_b128 a[132:135], v3 offset:4096
ds_read_b128 a[136:139], v3 offset:5120
M a[76:79], a[168:171], v[76:79], a[76:79]
v_exp_f32 v111, v111
M a[76:79], a[164:167], v[44:47], a[76:79]
v_cvt_pk_bf16_f32 v109, v110, v111
M a[80:83], a[172:175], v[32:35], a[80:83]
v_exp_f32 v124, v124
M a[80:83], a[176:179], v[64:67], a[80:83]
ds_read_b128 a[140:143], v3 offset:6144
ds_read_b128 a[144:147], v3 offset:7168
M a[84:87], a[176:179], v[68:71], a[84:87]
v_exp_f32 v125, v125
M a[84:87], a[172:175], v[36:39], a[84:87]
v_cvt_pk_bf16_f32 v110, v124, v125
M a[88:91], a[172:175], v[40:43], a[88:91]
v_exp_f32 v126, v126
M a[88:91], a[176:179], v[72:75], a[88:91]
M a[92:95], a[176:179], v[76:79], a[92:95]
v_exp_f32 v127, v127
M a[92:95], a[172:175], v[44:47], a[92:95]
v_cvt_pk_bf16_f32 v111, v126, v127
s_waitcnt vmcnt(16)
s_add_u32 m0, s29, 0
s_waitcnt lgkmcnt(4)
M v[32:35], a[116:119], a[180:183], 0
M v[32:35], a[120:123], a[184:187], v[32:35]
ds_read_b128 a[148:151], v3 offset:8192
ds_read_b128 a[152:155], v3 offset:9216
M v[32:35], a[124:127], a[188:191], v[32:35]
M v[32:35], a[128:131], a[192:195], v[32:35]
buffer_load_dwordx4 v1, s[12:15], s25 offen offset:0 sc1 lds
s_add_u32 s32, s25, 4096
M v[36:39], a[128:131], a[208:211], 0
M v[36:39], a[124:127], a[204:207], v[36:39]
M v[36:39], a[120:123], a[200:203], v[36:39]
M v[36:39], a[116:119], a[196:199], v[36:39]
buffer_load_dwordx4 v1, s[12:15], s25 offen offset:1024 sc1 lds
M v[40:43], a[116:119], a[212:215], 0
M v[40:43], a[120:123], a[216:219], v[40:43]
ds_read_b128 a[156:159], v3 offset:10240
ds_read_b128 a[160:163], v3 offset:11264
M v[40:43], a[124:127], a[220:223], v[40:43]
M v[40:43], a[128:131], a[224:227], v[40:43]
buffer_load_dwordx4 v1, s[12:15], s25 offen offset:2048 sc1 lds
M v[44:47], a[128:131], a[240:243], 0
M v[44:47], a[124:127], a[236:239], v[44:47]
M v[44:47], a[120:123], a[232:235], v[44:47]
M v[44:47], a[116:119], a[228:231], v[44:47]
buffer_load_dwordx4 v1, s[12:15], s25 offen offset:3072 sc1 lds
s_add_u32 m0, s29, 4096
s_waitcnt lgkmcnt(4)
M v[48:51], a[132:135], a[180:183], 0
M v[48:51], a[136:139], a[184:187], v[48:51]
ds_read_b128 a[164:167], v3 offset:12288
ds_read_b128 a[168:171], v3 offset:13312
M v[48:51], a[140:143], a[188:191], v[48:51]
M v[48:51], a[144:147], a[192:195], v[48:51]
buffer_load_dwordx4 v1, s[12:15], s32 offen offset:0 sc1 lds
M v[52:55], a[144:147], a[208:211], 0
M v[52:55], a[140:143], a[204:207], v[52:55]
M v[52:55], a[136:139], a[200:203], v[52:55]
M v[52:55], a[132:135], a[196:199], v[52:55]
buffer_load_dwordx4 v1, s[12:15], s32 offen offset:1024 sc1 lds
M v[56:59], a[132:135], a[212:215], 0
M v[56:59], a[136:139], a[216:219], v[56:59]
ds_read_b128 a[172:175], v3 offset:14336
ds_read_b128 a[176:179], v3 offset:15360
M v[56:59], a[140:143], a[220:223], v[56:59]
M v[56:59], a[144:147], a[224:227], v[56:59]
buffer_load_dwordx4 v1, s[12:15], s32 offen offset:2048 sc1 lds
M v[60:63], a[144:147], a[240:243], 0
M v[60:63], a[140:143], a[236:239], v[60:63]
M v[60:63], a[136:139], a[232:235], v[60:63]
M v[60:63], a[132:135], a[228:231], v[60:63]
buffer_load_dwordx4 v1, s[12:15], s32 offen offset:3072 sc1 lds
s_add_u32 m0, s29, 32768
s_waitcnt lgkmcnt(4)
M v[64:67], a[148:151], a[180:183], 0
v_exp_f32 v136, v136
M v[64:67], a[152:155], a[184:187], v[64:67]
ds_read_b128 a[116:119], v6 offset:32768
ds_read_b128 a[120:123], v6 offset:40960
M v[64:67], a[156:159], a[188:191], v[64:67]
v_exp_f32 v137, v137
M v[64:67], a[160:163], a[192:195], v[64:67]
buffer_load_dwordx4 v1, s[12:15], s26 offen offset:0 sc1 lds
s_add_u32 s43, s26, 4096
M v[68:71], a[160:163], a[208:211], 0
v_exp_f32 v138, v138
M v[68:71], a[156:159], a[204:207], v[68:71]
v_cvt_pk_bf16_f32 v136, v136, v137
M v[68:71], a[152:155], a[200:203], v[68:71]
v_exp_f32 v139, v139
M v[68:71], a[148:151], a[196:199], v[68:71]
buffer_load_dwordx4 v1, s[12:15], s26 offen offset:1024 sc1 lds
M v[72:75], a[148:151], a[212:215], 0
M v[72:75], a[152:155], a[216:219], v[72:75]
ds_read_b128 a[124:127], v6 offset:33792
ds_read_b128 a[128:131], v6 offset:41984
M v[72:75], a[156:159], a[220:223], v[72:75]
M v[72:75], a[160:163], a[224:227], v[72:75]
buffer_load_dwordx4 v1, s[12:15], s26 offen offset:2048 sc1 lds
M v[76:79], a[160:163], a[240:243], 0
M v[76:79], a[156:159], a[236:239], v[76:79]
v_cvt_pk_bf16_f32 v137, v138, v139
v_mov_b32 v138, 0
M v[76:79], a[152:155], a[232:235], v[76:79]
M v[76:79], a[148:151], a[228:231], v[76:79]
buffer_load_dwordx4 v1, s[12:15], s26 offen offset:3072 sc1 lds
s_add_u32 m0, s29, 36864
s_waitcnt lgkmcnt(4)
M v[80:83], a[164:167], a[180:183], 0
v_exp_f32 v140, v140
M v[80:83], a[168:171], a[184:187], v[80:83]
ds_read_b128 a[132:135], v6 offset:34816
ds_read_b128 a[136:139], v6 offset:43008
M v[80:83], a[172:175], a[188:191], v[80:83]
v_exp_f32 v141, v141
M v[80:83], a[176:179], a[192:195], v[80:83]
buffer_load_dwordx4 v1, s[12:15], s43 offen offset:0 sc1 lds
M v[84:87], a[176:179], a[208:211], 0
v_exp_f32 v142, v142
M v[84:87], a[172:175], a[204:207], v[84:87]
v_mov_b32 v139, 0
v_cvt_pk_bf16_f32 v140, v140, v141
M v[84:87], a[168:171], a[200:203], v[84:87]
v_exp_f32 v143, v143
M v[84:87], a[164:167], a[196:199], v[84:87]
buffer_load_dwordx4 v1, s[12:15], s43 offen offset:1024 sc1 lds
M v[88:91], a[164:167], a[212:215], 0
v_exp_f32 v156, v156
M v[88:91], a[168:171], a[216:219], v[88:91]
ds_read_b128 a[140:143], v6 offset:35840
ds_read_b128 a[144:147], v6 offset:44032
M v[88:91], a[172:175], a[220:223], v[88:91]
v_exp_f32 v157, v157
M v[88:91], a[176:179], a[224:227], v[88:91]
buffer_load_dwordx4 v1, s[12:15], s43 offen offset:2048 sc1 lds
M v[92:95], a[176:179], a[240:243], 0
v_exp_f32 v158, v158
M v[92:95], a[172:175], a[236:239], v[92:95]
v_cvt_pk_bf16_f32 v141, v142, v143
v_cvt_pk_bf16_f32 v142, v156, v157
M v[92:95], a[168:171], a[232:235], v[92:95]
v_exp_f32 v159, v159
M v[92:95], a[164:167], a[228:231], v[92:95]
buffer_load_dwordx4 v1, s[12:15], s43 offen offset:3072 sc1 lds
v_cvt_pk_bf16_f32 v143, v158, v159
s_waitcnt lgkmcnt(6)
M v[160:163], a[116:119], v[96:99], v[160:163]
v_exp_f32 v32, v32
ds_read_b128 a[148:151], v6 offset:36864
ds_read_b128 a[152:155], v6 offset:45056
v_exp_f32 v33, v33
M v[164:167], a[116:119], v[100:103], v[164:167]
v_cvt_pk_bf16_f32 v32, v32, v33
M v[168:171], a[116:119], v[104:107], v[168:171]
v_exp_f32 v34, v34
M v[168:171], a[120:123], v[136:139], v[168:171]
s_add_u32 s25, s25, 32768
s_cmp_eq_u32 s25, s27
M v[172:175], a[120:123], v[140:143], v[172:175]
v_exp_f32 v35, v35
M v[172:175], a[116:119], v[108:111], v[172:175]
v_cvt_pk_bf16_f32 v33, v34, v35
s_waitcnt lgkmcnt(6)
M a[96:99], a[112:115], v[96:99], a[96:99]
s_cselect_b32 s25, s28, s25
s_cselect_b32 s27, -1, s27
s_add_u32 s26, s26, 32768
s_cmp_eq_u32 s26, s62
M v[176:179], a[124:127], v[96:99], v[176:179]
v_exp_f32 v48, v48
ds_read_b128 a[156:159], v6 offset:37888
ds_read_b128 a[160:163], v6 offset:46080
v_exp_f32 v49, v49
M v[180:183], a[124:127], v[100:103], v[180:183]
v_cvt_pk_bf16_f32 v34, v48, v49
M v[184:187], a[124:127], v[104:107], v[184:187]
v_exp_f32 v50, v50
M v[184:187], a[128:131], v[136:139], v[184:187]
s_cselect_b32 s26, s63, s26
s_cselect_b32 s62, -1, s62
M v[188:191], a[128:131], v[140:143], v[188:191]
v_exp_f32 v51, v51
M v[188:191], a[124:127], v[108:111], v[188:191]
v_cvt_pk_bf16_f32 v35, v50, v51
s_waitcnt lgkmcnt(6)
M a[100:103], a[112:115], v[100:103], a[100:103]
M v[192:195], a[132:135], v[96:99], v[192:195]
v_exp_f32 v36, v36
ds_read_b128 a[164:167], v6 offset:38912
ds_read_b128 a[168:171], v6 offset:47104
v_exp_f32 v37, v37
M v[196:199], a[132:135], v[100:103], v[196:199]
v_cvt_pk_bf16_f32 v36, v36, v37
M v[200:203], a[132:135], v[104:107], v[200:203]
v_exp_f32 v38, v38
M v[200:203], a[136:139], v[136:139], v[200:203]
M v[204:207], a[136:139], v[140:143], v[204:207]
v_exp_f32 v39, v39
M v[204:207], a[132:135], v[108:111], v[204:207]
v_cvt_pk_bf16_f32 v37, v38, v39
s_waitcnt lgkmcnt(6)
M a[104:107], a[112:115], v[104:107], a[104:107]
M a[104:107], a[112:115], v[136:139], a[104:107]
M v[208:211], a[140:143], v[96:99], v[208:211]
v_exp_f32 v52, v52
ds_read_b128 a[172:175], v6 offset:39936
ds_read_b128 a[176:179], v6 offset:48128
v_exp_f32 v53, v53
M v[212:215], a[140:143], v[100:103], v[212:215]
v_cvt_pk_bf16_f32 v38, v52, v53
M v[216:219], a[140:143], v[104:107], v[216:219]
v_exp_f32 v54, v54
M v[216:219], a[144:147], v[136:139], v[216:219]
M v[220:223], a[144:147], v[140:143], v[220:223]
v_exp_f32 v55, v55
M v[220:223], a[140:143], v[108:111], v[220:223]
v_cvt_pk_bf16_f32 v39, v54, v55
s_waitcnt lgkmcnt(6)
M a[108:111], a[112:115], v[108:111], a[108:111]
M a[108:111], a[112:115], v[140:143], a[108:111]
M v[224:227], a[148:151], v[96:99], v[224:227]
v_exp_f32 v40, v40
v_exp_f32 v41, v41
M v[228:231], a[148:151], v[100:103], v[228:231]
v_cvt_pk_bf16_f32 v40, v40, v41
M v[232:235], a[148:151], v[104:107], v[232:235]
v_exp_f32 v42, v42
M v[232:235], a[152:155], v[136:139], v[232:235]
M v[236:239], a[152:155], v[140:143], v[236:239]
v_exp_f32 v43, v43
M v[236:239], a[148:151], v[108:111], v[236:239]
v_cvt_pk_bf16_f32 v41, v42, v43
s_waitcnt lgkmcnt(4)
M v[240:243], a[156:159], v[96:99], v[240:243]
v_exp_f32 v56, v56
v_exp_f32 v57, v57
M v[244:247], a[156:159], v[100:103], v[244:247]
v_cvt_pk_bf16_f32 v42, v56, v57
M v[248:251], a[156:159], v[104:107], v[248:251]
v_exp_f32 v58, v58
M v[248:251], a[160:163], v[136:139], v[248:251]
s_waitcnt vmcnt(0) lgkmcnt(0)
s_barrier
ds_read_b128 a[116:119], v2 offset:0
ds_read_b128 a[120:123], v2 offset:1024
M v[252:255], a[160:163], v[140:143], v[252:255]
v_exp_f32 v59, v59
M v[252:255], a[156:159], v[108:111], v[252:255]
v_cvt_pk_bf16_f32 v43, v58, v59
M a[64:67], a[164:167], v[96:99], a[64:67]
v_exp_f32 v44, v44
ds_read_b128 a[124:127], v2 offset:2048
ds_read_b128 a[128:131], v2 offset:3072
v_exp_f32 v45, v45
M a[68:71], a[164:167], v[100:103], a[68:71]
v_cvt_pk_bf16_f32 v44, v44, v45
M a[72:75], a[164:167], v[104:107], a[72:75]
v_exp_f32 v46, v46
M a[72:75], a[168:171], v[136:139], a[72:75]
ds_read_b128 a[132:135], v2 offset:4096
ds_read_b128 a[136:139], v2 offset:5120
M a[76:79], a[168:171], v[140:143], a[76:79]
v_exp_f32 v47, v47
M a[76:79], a[164:167], v[108:111], a[76:79]
v_cvt_pk_bf16_f32 v45, v46, v47
M a[80:83], a[172:175], v[96:99], a[80:83]
v_exp_f32 v60, v60
ds_read_b128 a[140:143], v2 offset:6144
ds_read_b128 a[144:147], v2 offset:7168
v_exp_f32 v61, v61
M a[84:87], a[172:175], v[100:103], a[84:87]
v_cvt_pk_bf16_f32 v46, v60, v61
M a[88:91], a[172:175], v[104:107], a[88:91]
v_exp_f32 v62, v62
M a[88:91], a[176:179], v[136:139], a[88:91]
M a[92:95], a[176:179], v[140:143], a[92:95]
v_exp_f32 v63, v63
M a[92:95], a[172:175], v[108:111], a[92:95]
v_cvt_pk_bf16_f32 v47, v62, v63
Lk2_ea:
v_accvgpr_read_b32 v20, a96
v_accvgpr_read_b32 v21, a100
v_accvgpr_read_b32 v22, a104
v_accvgpr_read_b32 v23, a108
v_rcp_f32 v8, v20
v_rcp_f32 v9, v21
v_rcp_f32 v10, v22
v_rcp_f32 v11, v23
v_subrev_u32 v20, 0x21800000, v20
v_subrev_u32 v21, 0x21800000, v21
v_subrev_u32 v22, 0x21800000, v22
v_subrev_u32 v23, 0x21800000, v23
v_max_u32 v12, v20, v21
v_max3_u32 v12, v12, v22, v23
s_mov_b32 s64, 0x207
s_lshl_b32 s33, s21, 20
s_lshl_b32 s34, s20, 15
s_add_u32 s33, s33, s34
s_lshl_b32 s34, s23, 13
s_add_u32 s36, s33, s34
s_add_u32 s37, s36, 4096
s_add_u32 s38, s36, 16384
s_add_u32 s39, s36, 20480
v_pk_mul_f32 v[160:161], v[160:161], v[8:9] op_sel:[0,0] op_sel_hi:[1,0]
v_pk_mul_f32 v[162:163], v[162:163], v[8:9] op_sel:[0,0] op_sel_hi:[1,0]
v_pk_mul_f32 v[176:177], v[176:177], v[8:9] op_sel:[0,0] op_sel_hi:[1,0]
v_pk_mul_f32 v[178:179], v[178:179], v[8:9] op_sel:[0,0] op_sel_hi:[1,0]
v_cvt_pk_bf16_f32 v160, v160, v161
v_cvt_pk_bf16_f32 v161, v162, v163
v_cvt_pk_bf16_f32 v162, v176, v177
v_cvt_pk_bf16_f32 v163, v178, v179
s_nop 1
M v[24:27], a[112:115], v[160:163], 0
buffer_store_dwordx4 v[160:163], v1, s[16:19], s36 offen offset:0 sc1
v_pk_mul_f32 v[164:165], v[164:165], v[8:9] op_sel:[0,1] op_sel_hi:[1,1]
v_pk_mul_f32 v[166:167], v[166:167], v[8:9] op_sel:[0,1] op_sel_hi:[1,1]
v_pk_mul_f32 v[180:181], v[180:181], v[8:9] op_sel:[0,1] op_sel_hi:[1,1]
v_pk_mul_f32 v[182:183], v[182:183], v[8:9] op_sel:[0,1] op_sel_hi:[1,1]
v_cvt_pk_bf16_f32 v164, v164, v165
v_cvt_pk_bf16_f32 v165, v166, v167
v_cvt_pk_bf16_f32 v166, v180, v181
v_cvt_pk_bf16_f32 v167, v182, v183
s_nop 1
M v[24:27], a[112:115], v[164:167], v[24:27]
buffer_store_dwordx4 v[164:167], v1, s[16:19], s36 offen offset:2048 sc1
v_pk_mul_f32 v[168:169], v[168:169], v[10:11] op_sel:[0,0] op_sel_hi:[1,0]
v_pk_mul_f32 v[170:171], v[170:171], v[10:11] op_sel:[0,0] op_sel_hi:[1,0]
v_pk_mul_f32 v[184:185], v[184:185], v[10:11] op_sel:[0,0] op_sel_hi:[1,0]
v_pk_mul_f32 v[186:187], v[186:187], v[10:11] op_sel:[0,0] op_sel_hi:[1,0]
v_cvt_pk_bf16_f32 v168, v168, v169
v_cvt_pk_bf16_f32 v169, v170, v171
v_cvt_pk_bf16_f32 v170, v184, v185
v_cvt_pk_bf16_f32 v171, v186, v187
s_nop 1
M v[24:27], a[112:115], v[168:171], v[24:27]
buffer_store_dwordx4 v[168:171], v1, s[16:19], s37 offen offset:0 sc1
v_pk_mul_f32 v[172:173], v[172:173], v[10:11] op_sel:[0,1] op_sel_hi:[1,1]
v_pk_mul_f32 v[174:175], v[174:175], v[10:11] op_sel:[0,1] op_sel_hi:[1,1]
v_pk_mul_f32 v[188:189], v[188:189], v[10:11] op_sel:[0,1] op_sel_hi:[1,1]
v_pk_mul_f32 v[190:191], v[190:191], v[10:11] op_sel:[0,1] op_sel_hi:[1,1]
v_cvt_pk_bf16_f32 v172, v172, v173
v_cvt_pk_bf16_f32 v173, v174, v175
v_cvt_pk_bf16_f32 v174, v188, v189
v_cvt_pk_bf16_f32 v175, v190, v191
s_nop 1
M v[24:27], a[112:115], v[172:175], v[24:27]
buffer_store_dwordx4 v[172:175], v1, s[16:19], s37 offen offset:2048 sc1
v_pk_mul_f32 v[192:193], v[192:193], v[8:9] op_sel:[0,0] op_sel_hi:[1,0]
v_pk_mul_f32 v[194:195], v[194:195], v[8:9] op_sel:[0,0] op_sel_hi:[1,0]
v_pk_mul_f32 v[208:209], v[208:209], v[8:9] op_sel:[0,0] op_sel_hi:[1,0]
v_pk_mul_f32 v[210:211], v[210:211], v[8:9] op_sel:[0,0] op_sel_hi:[1,0]
v_cvt_pk_bf16_f32 v192, v192, v193
v_cvt_pk_bf16_f32 v193, v194, v195
v_cvt_pk_bf16_f32 v194, v208, v209
v_cvt_pk_bf16_f32 v195, v210, v211
s_nop 1
M v[24:27], a[112:115], v[192:195], v[24:27]
buffer_store_dwordx4 v[192:195], v1, s[16:19], s36 offen offset:1024 sc1
v_pk_mul_f32 v[196:197], v[196:197], v[8:9] op_sel:[0,1] op_sel_hi:[1,1]
v_pk_mul_f32 v[198:199], v[198:199], v[8:9] op_sel:[0,1] op_sel_hi:[1,1]
v_pk_mul_f32 v[212:213], v[212:213], v[8:9] op_sel:[0,1] op_sel_hi:[1,1]
v_pk_mul_f32 v[214:215], v[214:215], v[8:9] op_sel:[0,1] op_sel_hi:[1,1]
v_cvt_pk_bf16_f32 v196, v196, v197
v_cvt_pk_bf16_f32 v197, v198, v199
v_cvt_pk_bf16_f32 v198, v212, v213
v_cvt_pk_bf16_f32 v199, v214, v215
s_nop 1
M v[24:27], a[112:115], v[196:199], v[24:27]
buffer_store_dwordx4 v[196:199], v1, s[16:19], s36 offen offset:3072 sc1
v_pk_mul_f32 v[200:201], v[200:201], v[10:11] op_sel:[0,0] op_sel_hi:[1,0]
v_pk_mul_f32 v[202:203], v[202:203], v[10:11] op_sel:[0,0] op_sel_hi:[1,0]
v_pk_mul_f32 v[216:217], v[216:217], v[10:11] op_sel:[0,0] op_sel_hi:[1,0]
v_pk_mul_f32 v[218:219], v[218:219], v[10:11] op_sel:[0,0] op_sel_hi:[1,0]
v_cvt_pk_bf16_f32 v200, v200, v201
v_cvt_pk_bf16_f32 v201, v202, v203
v_cvt_pk_bf16_f32 v202, v216, v217
v_cvt_pk_bf16_f32 v203, v218, v219
s_nop 1
M v[24:27], a[112:115], v[200:203], v[24:27]
buffer_store_dwordx4 v[200:203], v1, s[16:19], s37 offen offset:1024 sc1
v_pk_mul_f32 v[204:205], v[204:205], v[10:11] op_sel:[0,1] op_sel_hi:[1,1]
v_pk_mul_f32 v[206:207], v[206:207], v[10:11] op_sel:[0,1] op_sel_hi:[1,1]
v_pk_mul_f32 v[220:221], v[220:221], v[10:11] op_sel:[0,1] op_sel_hi:[1,1]
v_pk_mul_f32 v[222:223], v[222:223], v[10:11] op_sel:[0,1] op_sel_hi:[1,1]
v_cvt_pk_bf16_f32 v204, v204, v205
v_cvt_pk_bf16_f32 v205, v206, v207
v_cvt_pk_bf16_f32 v206, v220, v221
v_cvt_pk_bf16_f32 v207, v222, v223
s_nop 1
M v[24:27], a[112:115], v[204:207], v[24:27]
buffer_store_dwordx4 v[204:207], v1, s[16:19], s37 offen offset:3072 sc1
v_pk_mul_f32 v[224:225], v[224:225], v[8:9] op_sel:[0,0] op_sel_hi:[1,0]
v_pk_mul_f32 v[226:227], v[226:227], v[8:9] op_sel:[0,0] op_sel_hi:[1,0]
v_pk_mul_f32 v[240:241], v[240:241], v[8:9] op_sel:[0,0] op_sel_hi:[1,0]
v_pk_mul_f32 v[242:243], v[242:243], v[8:9] op_sel:[0,0] op_sel_hi:[1,0]
v_cvt_pk_bf16_f32 v224, v224, v225
v_cvt_pk_bf16_f32 v225, v226, v227
v_cvt_pk_bf16_f32 v226, v240, v241
v_cvt_pk_bf16_f32 v227, v242, v243
s_nop 1
M v[24:27], a[112:115], v[224:227], v[24:27]
buffer_store_dwordx4 v[224:227], v1, s[16:19], s38 offen offset:0 sc1
v_pk_mul_f32 v[228:229], v[228:229], v[8:9] op_sel:[0,1] op_sel_hi:[1,1]
v_pk_mul_f32 v[230:231], v[230:231], v[8:9] op_sel:[0,1] op_sel_hi:[1,1]
v_pk_mul_f32 v[244:245], v[244:245], v[8:9] op_sel:[0,1] op_sel_hi:[1,1]
v_pk_mul_f32 v[246:247], v[246:247], v[8:9] op_sel:[0,1] op_sel_hi:[1,1]
v_cvt_pk_bf16_f32 v228, v228, v229
v_cvt_pk_bf16_f32 v229, v230, v231
v_cvt_pk_bf16_f32 v230, v244, v245
v_cvt_pk_bf16_f32 v231, v246, v247
s_nop 1
M v[24:27], a[112:115], v[228:231], v[24:27]
buffer_store_dwordx4 v[228:231], v1, s[16:19], s38 offen offset:2048 sc1
v_pk_mul_f32 v[232:233], v[232:233], v[10:11] op_sel:[0,0] op_sel_hi:[1,0]
v_pk_mul_f32 v[234:235], v[234:235], v[10:11] op_sel:[0,0] op_sel_hi:[1,0]
v_pk_mul_f32 v[248:249], v[248:249], v[10:11] op_sel:[0,0] op_sel_hi:[1,0]
v_pk_mul_f32 v[250:251], v[250:251], v[10:11] op_sel:[0,0] op_sel_hi:[1,0]
v_cvt_pk_bf16_f32 v232, v232, v233
v_cvt_pk_bf16_f32 v233, v234, v235
v_cvt_pk_bf16_f32 v234, v248, v249
v_cvt_pk_bf16_f32 v235, v250, v251
s_nop 1
M v[24:27], a[112:115], v[232:235], v[24:27]
buffer_store_dwordx4 v[232:235], v1, s[16:19], s39 offen offset:0 sc1
v_pk_mul_f32 v[236:237], v[236:237], v[10:11] op_sel:[0,1] op_sel_hi:[1,1]
v_pk_mul_f32 v[238:239], v[238:239], v[10:11] op_sel:[0,1] op_sel_hi:[1,1]
v_pk_mul_f32 v[252:253], v[252:253], v[10:11] op_sel:[0,1] op_sel_hi:[1,1]
v_pk_mul_f32 v[254:255], v[254:255], v[10:11] op_sel:[0,1] op_sel_hi:[1,1]
v_cvt_pk_bf16_f32 v236, v236, v237
v_cvt_pk_bf16_f32 v237, v238, v239
v_cvt_pk_bf16_f32 v238, v252, v253
v_cvt_pk_bf16_f32 v239, v254, v255
v_accvgpr_read_b32 v176, a64
v_accvgpr_read_b32 v177, a65
v_accvgpr_read_b32 v178, a66
v_accvgpr_read_b32 v179, a67
v_accvgpr_read_b32 v180, a80
v_accvgpr_read_b32 v181, a81
v_accvgpr_read_b32 v182, a82
v_accvgpr_read_b32 v183, a83
M v[24:27], a[112:115], v[236:239], v[24:27]
buffer_store_dwordx4 v[236:239], v1, s[16:19], s39 offen offset:2048 sc1
v_pk_mul_f32 v[176:177], v[176:177], v[8:9] op_sel:[0,0] op_sel_hi:[1,0]
v_pk_mul_f32 v[178:179], v[178:179], v[8:9] op_sel:[0,0] op_sel_hi:[1,0]
v_pk_mul_f32 v[180:181], v[180:181], v[8:9] op_sel:[0,0] op_sel_hi:[1,0]
v_pk_mul_f32 v[182:183], v[182:183], v[8:9] op_sel:[0,0] op_sel_hi:[1,0]
v_cvt_pk_bf16_f32 v176, v176, v177
v_cvt_pk_bf16_f32 v177, v178, v179
v_cvt_pk_bf16_f32 v178, v180, v181
v_cvt_pk_bf16_f32 v179, v182, v183
v_accvgpr_read_b32 v184, a68
v_accvgpr_read_b32 v185, a69
v_accvgpr_read_b32 v186, a70
v_accvgpr_read_b32 v187, a71
v_accvgpr_read_b32 v188, a84
v_accvgpr_read_b32 v189, a85
v_accvgpr_read_b32 v190, a86
v_accvgpr_read_b32 v191, a87
M v[24:27], a[112:115], v[176:179], v[24:27]
buffer_store_dwordx4 v[176:179], v1, s[16:19], s38 offen offset:1024 sc1
v_pk_mul_f32 v[184:185], v[184:185], v[8:9] op_sel:[0,1] op_sel_hi:[1,1]
v_pk_mul_f32 v[186:187], v[186:187], v[8:9] op_sel:[0,1] op_sel_hi:[1,1]
v_pk_mul_f32 v[188:189], v[188:189], v[8:9] op_sel:[0,1] op_sel_hi:[1,1]
v_pk_mul_f32 v[190:191], v[190:191], v[8:9] op_sel:[0,1] op_sel_hi:[1,1]
v_cvt_pk_bf16_f32 v184, v184, v185
v_cvt_pk_bf16_f32 v185, v186, v187
v_cvt_pk_bf16_f32 v186, v188, v189
v_cvt_pk_bf16_f32 v187, v190, v191
v_accvgpr_read_b32 v208, a72
v_accvgpr_read_b32 v209, a73
v_accvgpr_read_b32 v210, a74
v_accvgpr_read_b32 v211, a75
v_accvgpr_read_b32 v212, a88
v_accvgpr_read_b32 v213, a89
v_accvgpr_read_b32 v214, a90
v_accvgpr_read_b32 v215, a91
M v[24:27], a[112:115], v[184:187], v[24:27]
buffer_store_dwordx4 v[184:187], v1, s[16:19], s38 offen offset:3072 sc1
v_pk_mul_f32 v[208:209], v[208:209], v[10:11] op_sel:[0,0] op_sel_hi:[1,0]
v_pk_mul_f32 v[210:211], v[210:211], v[10:11] op_sel:[0,0] op_sel_hi:[1,0]
v_pk_mul_f32 v[212:213], v[212:213], v[10:11] op_sel:[0,0] op_sel_hi:[1,0]
v_pk_mul_f32 v[214:215], v[214:215], v[10:11] op_sel:[0,0] op_sel_hi:[1,0]
v_cvt_pk_bf16_f32 v208, v208, v209
v_cvt_pk_bf16_f32 v209, v210, v211
v_cvt_pk_bf16_f32 v210, v212, v213
v_cvt_pk_bf16_f32 v211, v214, v215
v_accvgpr_read_b32 v216, a76
v_accvgpr_read_b32 v217, a77
v_accvgpr_read_b32 v218, a78
v_accvgpr_read_b32 v219, a79
v_accvgpr_read_b32 v220, a92
v_accvgpr_read_b32 v221, a93
v_accvgpr_read_b32 v222, a94
v_accvgpr_read_b32 v223, a95
M v[24:27], a[112:115], v[208:211], v[24:27]
buffer_store_dwordx4 v[208:211], v1, s[16:19], s39 offen offset:1024 sc1
v_pk_mul_f32 v[216:217], v[216:217], v[10:11] op_sel:[0,1] op_sel_hi:[1,1]
v_pk_mul_f32 v[218:219], v[218:219], v[10:11] op_sel:[0,1] op_sel_hi:[1,1]
v_pk_mul_f32 v[220:221], v[220:221], v[10:11] op_sel:[0,1] op_sel_hi:[1,1]
v_pk_mul_f32 v[222:223], v[222:223], v[10:11] op_sel:[0,1] op_sel_hi:[1,1]
v_cvt_pk_bf16_f32 v216, v216, v217
v_cvt_pk_bf16_f32 v217, v218, v219
v_cvt_pk_bf16_f32 v218, v220, v221
v_cvt_pk_bf16_f32 v219, v222, v223
s_nop 1
M v[24:27], a[112:115], v[216:219], v[24:27]
buffer_store_dwordx4 v[216:219], v1, s[16:19], s39 offen offset:3072 sc1
v_cmp_lt_u32 vcc, 0x3c000000, v12
s_nop 5
v_cmp_class_f32 s[40:41], v24, s64
s_nop 0
s_or_b64 vcc, vcc, s[40:41]
s_cmp_lg_u64 vcc, 0
s_cselect_b32 s33, 1, 0
s_or_b32 s60, s60, s33
s_sub_u32 s30, 7, s21
s_cmp_lg_u32 s30, 0
s_cbranch_scc1 Lk2_b0
s_and_b32 s3, s2, 3
s_lshl_b32 s3, s3, 2
s_bfe_u32 s27, s2, 0x20003
s_add_u32 s27, s3, s27
s_lshl_b32 s43, s27, 8
s_add_u32 s43, s43, 16789504
v_lshlrev_b32 v15, 2, v0
buffer_load_dword v7, v15, s[52:55], s43 offen sc1
s_waitcnt lgkmcnt(7)
ds_read_b128 a[116:119], v5 offset:36864
s_waitcnt lgkmcnt(7)
ds_read_b128 a[120:123], v5 offset:45056
s_waitcnt lgkmcnt(7)
ds_read_b128 a[124:127], v5 offset:37888
s_waitcnt lgkmcnt(7)
ds_read_b128 a[128:131], v5 offset:46080
s_waitcnt lgkmcnt(7)
ds_read_b128 a[132:135], v5 offset:38912
s_waitcnt lgkmcnt(7)
ds_read_b128 a[136:139], v5 offset:47104
s_waitcnt lgkmcnt(7)
ds_read_b128 a[140:143], v5 offset:39936
s_waitcnt lgkmcnt(7)
ds_read_b128 a[144:147], v5 offset:48128
s_lshl_b32 s33, s23, 14
s_add_u32 s34, s33, 98304
s_add_u32 s33, s33, 131072
v_add_u32 v2, s34, v1
v_add_u32 v3, s33, v1
v_exp_f32 v64, v64
v_exp_f32 v65, v65
v_exp_f32 v66, v66
v_exp_f32 v67, v67
v_exp_f32 v80, v80
v_exp_f32 v81, v81
v_exp_f32 v82, v82
v_exp_f32 v83, v83
v_cvt_pk_bf16_f32 v64, v64, v65
v_cvt_pk_bf16_f32 v65, v66, v67
v_exp_f32 v68, v68
v_exp_f32 v69, v69
v_exp_f32 v70, v70
v_exp_f32 v71, v71
v_cvt_pk_bf16_f32 v66, v80, v81
v_cvt_pk_bf16_f32 v67, v82, v83
v_exp_f32 v84, v84
v_exp_f32 v85, v85
v_exp_f32 v86, v86
v_exp_f32 v87, v87
v_cvt_pk_bf16_f32 v68, v68, v69
v_cvt_pk_bf16_f32 v69, v70, v71
v_exp_f32 v72, v72
v_exp_f32 v73, v73
v_exp_f32 v74, v74
v_exp_f32 v75, v75
v_cvt_pk_bf16_f32 v70, v84, v85
v_cvt_pk_bf16_f32 v71, v86, v87
v_exp_f32 v88, v88
v_exp_f32 v89, v89
v_exp_f32 v90, v90
v_exp_f32 v91, v91
v_cvt_pk_bf16_f32 v72, v72, v73
v_cvt_pk_bf16_f32 v73, v74, v75
v_exp_f32 v76, v76
v_exp_f32 v77, v77
v_exp_f32 v78, v78
v_exp_f32 v79, v79
v_cvt_pk_bf16_f32 v74, v88, v89
v_cvt_pk_bf16_f32 v75, v90, v91
v_exp_f32 v92, v92
v_exp_f32 v93, v93
v_exp_f32 v94, v94
v_exp_f32 v95, v95
v_cvt_pk_bf16_f32 v76, v76, v77
v_cvt_pk_bf16_f32 v77, v78, v79
v_cvt_pk_bf16_f32 v78, v92, v93
v_cvt_pk_bf16_f32 v79, v94, v95
s_waitcnt lgkmcnt(6)
M v[224:227], a[116:119], v[32:35], 0
M v[224:227], a[120:123], v[64:67], v[224:227]
ds_read_b128 a[148:151], v5 offset:32768
ds_read_b128 a[152:155], v5 offset:40960
s_mov_b32 s61, 0
M v[228:231], a[120:123], v[68:71], 0
M v[228:231], a[116:119], v[36:39], v[228:231]
s_bfe_u32 s3, s2, 0x10002
M v[232:235], a[116:119], v[40:43], 0
M v[232:235], a[120:123], v[72:75], v[232:235]
s_lshl_b32 s3, s3, 3
M v[236:239], a[120:123], v[76:79], 0
M v[236:239], a[116:119], v[44:47], v[236:239]
s_waitcnt lgkmcnt(6)
s_lshr_b32 s28, s2, 5
M a[96:99], a[112:115], v[32:35], 0
M a[96:99], a[112:115], v[64:67], a[96:99]
M v[240:243], a[124:127], v[32:35], 0
M v[240:243], a[128:131], v[64:67], v[240:243]
ds_read_b128 a[156:159], v5 offset:33792
ds_read_b128 a[160:163], v5 offset:41984
s_add_u32 s28, s3, s28
M v[244:247], a[128:131], v[68:71], 0
s_lshl_b32 s25, s27, 18
M v[244:247], a[124:127], v[36:39], v[244:247]
M v[248:251], a[124:127], v[40:43], 0
s_lshl_b32 s3, s101, 12
M v[248:251], a[128:131], v[72:75], v[248:251]
M v[252:255], a[128:131], v[76:79], 0
s_add_u32 s25, s25, s3
M v[252:255], a[124:127], v[44:47], v[252:255]
s_waitcnt lgkmcnt(6)
M a[100:103], a[112:115], v[36:39], 0
M a[100:103], a[112:115], v[68:71], a[100:103]
M a[64:67], a[132:135], v[32:35], 0
s_lshl_b32 s26, s28, 7
M a[64:67], a[136:139], v[64:67], a[64:67]
ds_read_b128 a[164:167], v5 offset:34816
ds_read_b128 a[168:171], v5 offset:43008
M a[68:71], a[136:139], v[68:71], 0
s_lshl_b32 s42, s101, 11
M a[68:71], a[132:135], v[36:39], a[68:71]
M a[72:75], a[132:135], v[40:43], 0
s_add_u32 s44, s4, 83886080
s_addc_u32 s45, s5, 0
M a[72:75], a[136:139], v[72:75], a[72:75]
s_mov_b32 s46, 4194304
M a[76:79], a[136:139], v[76:79], 0
M a[76:79], a[132:135], v[44:47], a[76:79]
s_waitcnt lgkmcnt(6)
s_mov_b32 s47, 0x00020000
M a[104:107], a[112:115], v[40:43], 0
M a[104:107], a[112:115], v[72:75], a[104:107]
M a[80:83], a[140:143], v[32:35], 0
M a[80:83], a[144:147], v[64:67], a[80:83]
ds_read_b128 a[172:175], v5 offset:35840
ds_read_b128 a[176:179], v5 offset:44032
s_mov_b32 s50, 2097152
M a[84:87], a[144:147], v[68:71], 0
M a[84:87], a[140:143], v[36:39], a[84:87]
s_mov_b32 s51, 0x00020000
M a[88:91], a[140:143], v[40:43], 0
M a[88:91], a[144:147], v[72:75], a[88:91]
s_lshl_b32 s3, s101, 4
M a[92:95], a[144:147], v[76:79], 0
M a[92:95], a[140:143], v[44:47], a[92:95]
s_waitcnt lgkmcnt(6)
v_lshrrev_b32 v96, 3, v0
M a[108:111], a[112:115], v[44:47], 0
M a[108:111], a[112:115], v[76:79], a[108:111]
M v[160:163], a[148:151], v[32:35], 0
v_and_b32 v97, 6, v96
M v[160:163], a[152:155], v[64:67], v[160:163]
M v[164:167], a[152:155], v[68:71], 0
ds_write_b128 v2, v[224:227] offset:0
v_and_b32 v98, 7, v0
M v[164:167], a[148:151], v[36:39], v[164:167]
M v[168:171], a[148:151], v[40:43], 0
ds_write_b128 v2, v[228:231] offset:1024
v_xor_b32 v97, v97, v98
M v[168:171], a[152:155], v[72:75], v[168:171]
M v[172:175], a[152:155], v[76:79], 0
ds_write_b128 v2, v[232:235] offset:2048
v_add_u32 v96, s3, v96
M v[172:175], a[148:151], v[44:47], v[172:175]
s_waitcnt lgkmcnt(7)
M v[176:179], a[156:159], v[32:35], 0
ds_write_b128 v2, v[236:239] offset:3072
v_lshlrev_b32 v96, 11, v96
M v[176:179], a[160:163], v[64:67], v[176:179]
M v[180:183], a[160:163], v[68:71], 0
ds_write_b128 v2, v[240:243] offset:4096
v_lshl_add_u32 v99, v97, 4, v96
M v[180:183], a[156:159], v[36:39], v[180:183]
v_add_u32 v100, 15360, v99
M v[184:187], a[156:159], v[40:43], 0
ds_write_b128 v2, v[244:247] offset:5120
M v[184:187], a[160:163], v[72:75], v[184:187]
s_waitcnt vmcnt(0) lgkmcnt(0)
s_barrier
M v[188:191], a[160:163], v[76:79], 0
ds_write_b128 v2, v[248:251] offset:6144
v_cmp_ne_u32 vcc, 1, v7
s_nop 0
s_cbranch_vccnz Lk3_spinb0
Lk3_gotb0:
M v[188:191], a[156:159], v[44:47], v[188:191]
s_add_u32 m0, s42, 16384
s_nop 0
buffer_load_dwordx4 v99, s[48:51], s26 offen offset:0 lds
M v[192:195], a[164:167], v[32:35], 0
ds_write_b128 v2, v[252:255] offset:7168
buffer_load_dwordx4 v100, s[48:51], s26 offen offset:1024 lds
M v[192:195], a[168:171], v[64:67], v[192:195]
M v[196:199], a[168:171], v[68:71], 0
ds_write_b128 v2, a[64:67] offset:8192
buffer_load_dwordx4 a[192:195], v1, s[44:47], s25 offen offset:0 sc1
M v[196:199], a[164:167], v[36:39], v[196:199]
buffer_load_dwordx4 a[196:199], v1, s[44:47], s25 offen offset:1024 sc1
M v[200:203], a[164:167], v[40:43], 0
ds_write_b128 v2, a[68:71] offset:9216
buffer_load_dwordx4 a[200:203], v1, s[44:47], s25 offen offset:2048 sc1
M v[200:203], a[168:171], v[72:75], v[200:203]
buffer_load_dwordx4 a[204:207], v1, s[44:47], s25 offen offset:3072 sc1
M v[204:207], a[168:171], v[76:79], 0
ds_write_b128 v2, a[72:75] offset:10240
M v[204:207], a[164:167], v[44:47], v[204:207]
s_add_u32 s25, s25, 16384
s_add_u32 s26, s26, 131072
M v[208:211], a[172:175], v[32:35], 0
ds_write_b128 v2, a[76:79] offset:11264
s_add_u32 m0, s42, 32768
s_nop 0
buffer_load_dwordx4 v99, s[48:51], s26 offen offset:0 lds
M v[208:211], a[176:179], v[64:67], v[208:211]
buffer_load_dwordx4 v100, s[48:51], s26 offen offset:1024 lds
M v[212:215], a[176:179], v[68:71], 0
ds_write_b128 v2, a[80:83] offset:12288
buffer_load_dwordx4 a[224:227], v1, s[44:47], s25 offen offset:0 sc1
M v[212:215], a[172:175], v[36:39], v[212:215]
M v[216:219], a[172:175], v[40:43], 0
ds_write_b128 v2, a[84:87] offset:13312
buffer_load_dwordx4 a[228:231], v1, s[44:47], s25 offen offset:1024 sc1
M v[216:219], a[176:179], v[72:75], v[216:219]
buffer_load_dwordx4 a[232:235], v1, s[44:47], s25 offen offset:2048 sc1
M v[220:223], a[176:179], v[76:79], 0
ds_write_b128 v2, a[88:91] offset:14336
buffer_load_dwordx4 a[236:239], v1, s[44:47], s25 offen offset:3072 sc1
M v[220:223], a[172:175], v[44:47], v[220:223]
s_add_u32 s25, s25, 16384
s_add_u32 s26, s26, 131072
ds_write_b128 v2, a[92:95] offset:15360
s_waitcnt lgkmcnt(0)
s_branch Lk2_merge
Lk2_b0:
s_add_u32 m0, s29, 65536
s_waitcnt lgkmcnt(4)
M v[96:99], a[116:119], a[180:183], 0
v_exp_f32 v64, v64
M v[96:99], a[120:123], a[184:187], v[96:99]
ds_read_b128 a[148:151], v2 offset:8192
ds_read_b128 a[152:155], v2 offset:9216
M v[96:99], a[124:127], a[188:191], v[96:99]
v_exp_f32 v65, v65
M v[96:99], a[128:131], a[192:195], v[96:99]
buffer_load_dwordx4 v1, s[12:15], s25 offen offset:0 sc1 lds
s_add_u32 s32, s25, 4096
M v[100:103], a[128:131], a[208:211], 0
v_exp_f32 v66, v66
M v[100:103], a[124:127], a[204:207], v[100:103]
v_cvt_pk_bf16_f32 v64, v64, v65
M v[100:103], a[120:123], a[200:203], v[100:103]
v_exp_f32 v67, v67
M v[100:103], a[116:119], a[196:199], v[100:103]
buffer_load_dwordx4 v1, s[12:15], s25 offen offset:1024 sc1 lds
M v[104:107], a[116:119], a[212:215], 0
v_exp_f32 v80, v80
M v[104:107], a[120:123], a[216:219], v[104:107]
ds_read_b128 a[156:159], v2 offset:10240
ds_read_b128 a[160:163], v2 offset:11264
M v[104:107], a[124:127], a[220:223], v[104:107]
v_exp_f32 v81, v81
M v[104:107], a[128:131], a[224:227], v[104:107]
buffer_load_dwordx4 v1, s[12:15], s25 offen offset:2048 sc1 lds
M v[108:111], a[128:131], a[240:243], 0
v_exp_f32 v82, v82
M v[108:111], a[124:127], a[236:239], v[108:111]
v_cvt_pk_bf16_f32 v65, v66, v67
v_cvt_pk_bf16_f32 v66, v80, v81
M v[108:111], a[120:123], a[232:235], v[108:111]
v_exp_f32 v83, v83
M v[108:111], a[116:119], a[228:231], v[108:111]
buffer_load_dwordx4 v1, s[12:15], s25 offen offset:3072 sc1 lds
s_add_u32 m0, s29, 69632
s_waitcnt lgkmcnt(4)
M v[112:115], a[132:135], a[180:183], 0
v_exp_f32 v68, v68
M v[112:115], a[136:139], a[184:187], v[112:115]
ds_read_b128 a[164:167], v2 offset:12288
ds_read_b128 a[168:171], v2 offset:13312
M v[112:115], a[140:143], a[188:191], v[112:115]
v_exp_f32 v69, v69
M v[112:115], a[144:147], a[192:195], v[112:115]
buffer_load_dwordx4 v1, s[12:15], s32 offen offset:0 sc1 lds
M v[116:119], a[144:147], a[208:211], 0
v_exp_f32 v70, v70
M v[116:119], a[140:143], a[204:207], v[116:119]
v_cvt_pk_bf16_f32 v67, v82, v83
v_cvt_pk_bf16_f32 v68, v68, v69
M v[116:119], a[136:139], a[200:203], v[116:119]
v_exp_f32 v71, v71
M v[116:119], a[132:135], a[196:199], v[116:119]
buffer_load_dwordx4 v1, s[12:15], s32 offen offset:1024 sc1 lds
M v[120:123], a[132:135], a[212:215], 0
v_exp_f32 v84, v84
M v[120:123], a[136:139], a[216:219], v[120:123]
ds_read_b128 a[172:175], v2 offset:14336
ds_read_b128 a[176:179], v2 offset:15360
M v[120:123], a[140:143], a[220:223], v[120:123]
v_exp_f32 v85, v85
M v[120:123], a[144:147], a[224:227], v[120:123]
buffer_load_dwordx4 v1, s[12:15], s32 offen offset:2048 sc1 lds
M v[124:127], a[144:147], a[240:243], 0
v_exp_f32 v86, v86
M v[124:127], a[140:143], a[236:239], v[124:127]
v_cvt_pk_bf16_f32 v69, v70, v71
v_cvt_pk_bf16_f32 v70, v84, v85
M v[124:127], a[136:139], a[232:235], v[124:127]
v_exp_f32 v87, v87
M v[124:127], a[132:135], a[228:231], v[124:127]
buffer_load_dwordx4 v1, s[12:15], s32 offen offset:3072 sc1 lds
s_add_u32 m0, s29, 98304
s_waitcnt lgkmcnt(4)
M v[128:131], a[148:151], a[180:183], 0
v_exp_f32 v72, v72
M v[128:131], a[152:155], a[184:187], v[128:131]
ds_read_b128 a[116:119], v5 offset:32768
ds_read_b128 a[120:123], v5 offset:40960
M v[128:131], a[156:159], a[188:191], v[128:131]
v_exp_f32 v73, v73
M v[128:131], a[160:163], a[192:195], v[128:131]
buffer_load_dwordx4 v1, s[12:15], s26 offen offset:0 sc1 lds
s_add_u32 s43, s26, 4096
M v[132:135], a[160:163], a[208:211], 0
v_exp_f32 v74, v74
M v[132:135], a[156:159], a[204:207], v[132:135]
v_cvt_pk_bf16_f32 v71, v86, v87
v_cvt_pk_bf16_f32 v72, v72, v73
M v[132:135], a[152:155], a[200:203], v[132:135]
v_exp_f32 v75, v75
M v[132:135], a[148:151], a[196:199], v[132:135]
buffer_load_dwordx4 v1, s[12:15], s26 offen offset:1024 sc1 lds
M v[136:139], a[148:151], a[212:215], 0
v_exp_f32 v88, v88
M v[136:139], a[152:155], a[216:219], v[136:139]
ds_read_b128 a[124:127], v5 offset:33792
ds_read_b128 a[128:131], v5 offset:41984
M v[136:139], a[156:159], a[220:223], v[136:139]
v_exp_f32 v89, v89
M v[136:139], a[160:163], a[224:227], v[136:139]
buffer_load_dwordx4 v1, s[12:15], s26 offen offset:2048 sc1 lds
M v[140:143], a[160:163], a[240:243], 0
v_exp_f32 v90, v90
M v[140:143], a[156:159], a[236:239], v[140:143]
v_cvt_pk_bf16_f32 v73, v74, v75
v_cvt_pk_bf16_f32 v74, v88, v89
M v[140:143], a[152:155], a[232:235], v[140:143]
v_exp_f32 v91, v91
M v[140:143], a[148:151], a[228:231], v[140:143]
buffer_load_dwordx4 v1, s[12:15], s26 offen offset:3072 sc1 lds
s_add_u32 m0, s29, 102400
s_waitcnt lgkmcnt(4)
M v[144:147], a[164:167], a[180:183], 0
v_exp_f32 v76, v76
M v[144:147], a[168:171], a[184:187], v[144:147]
ds_read_b128 a[132:135], v5 offset:34816
ds_read_b128 a[136:139], v5 offset:43008
M v[144:147], a[172:175], a[188:191], v[144:147]
v_exp_f32 v77, v77
M v[144:147], a[176:179], a[192:195], v[144:147]
buffer_load_dwordx4 v1, s[12:15], s43 offen offset:0 sc1 lds
M v[148:151], a[176:179], a[208:211], 0
v_exp_f32 v78, v78
M v[148:151], a[172:175], a[204:207], v[148:151]
v_cvt_pk_bf16_f32 v75, v90, v91
v_cvt_pk_bf16_f32 v76, v76, v77
M v[148:151], a[168:171], a[200:203], v[148:151]
v_exp_f32 v79, v79
M v[148:151], a[164:167], a[196:199], v[148:151]
buffer_load_dwordx4 v1, s[12:15], s43 offen offset:1024 sc1 lds
M v[152:155], a[164:167], a[212:215], 0
v_exp_f32 v92, v92
M v[152:155], a[168:171], a[216:219], v[152:155]
ds_read_b128 a[140:143], v5 offset:35840
ds_read_b128 a[144:147], v5 offset:44032
M v[152:155], a[172:175], a[220:223], v[152:155]
v_exp_f32 v93, v93
M v[152:155], a[176:179], a[224:227], v[152:155]
buffer_load_dwordx4 v1, s[12:15], s43 offen offset:2048 sc1 lds
M v[156:159], a[176:179], a[240:243], 0
v_exp_f32 v94, v94
M v[156:159], a[172:175], a[236:239], v[156:159]
v_cvt_pk_bf16_f32 v77, v78, v79
v_cvt_pk_bf16_f32 v78, v92, v93
M v[156:159], a[168:171], a[232:235], v[156:159]
v_exp_f32 v95, v95
M v[156:159], a[164:167], a[228:231], v[156:159]
buffer_load_dwordx4 v1, s[12:15], s43 offen offset:3072 sc1 lds
v_cvt_pk_bf16_f32 v79, v94, v95
s_waitcnt lgkmcnt(6)
M v[160:163], a[116:119], v[32:35], 0
v_exp_f32 v96, v96
M v[160:163], a[120:123], v[64:67], v[160:163]
ds_read_b128 a[148:151], v5 offset:36864
ds_read_b128 a[152:155], v5 offset:45056
M v[164:167], a[120:123], v[68:71], 0
v_exp_f32 v97, v97
M v[164:167], a[116:119], v[36:39], v[164:167]
v_cvt_pk_bf16_f32 v96, v96, v97
M v[168:171], a[116:119], v[40:43], 0
v_exp_f32 v98, v98
M v[168:171], a[120:123], v[72:75], v[168:171]
s_add_u32 s25, s25, 32768
s_cmp_eq_u32 s25, s27
M v[172:175], a[120:123], v[76:79], 0
v_exp_f32 v99, v99
M v[172:175], a[116:119], v[44:47], v[172:175]
v_cvt_pk_bf16_f32 v97, v98, v99
s_waitcnt lgkmcnt(6)
M a[96:99], a[112:115], v[32:35], 0
s_cselect_b32 s25, s28, s25
s_cselect_b32 s27, -1, s27
M a[96:99], a[112:115], v[64:67], a[96:99]
s_add_u32 s26, s26, 32768
s_cmp_eq_u32 s26, s62
M v[176:179], a[124:127], v[32:35], 0
v_exp_f32 v112, v112
M v[176:179], a[128:131], v[64:67], v[176:179]
ds_read_b128 a[156:159], v5 offset:37888
ds_read_b128 a[160:163], v5 offset:46080
M v[180:183], a[128:131], v[68:71], 0
v_exp_f32 v113, v113
M v[180:183], a[124:127], v[36:39], v[180:183]
v_cvt_pk_bf16_f32 v98, v112, v113
M v[184:187], a[124:127], v[40:43], 0
v_exp_f32 v114, v114
M v[184:187], a[128:131], v[72:75], v[184:187]
s_cselect_b32 s26, s63, s26
s_cselect_b32 s62, -1, s62
M v[188:191], a[128:131], v[76:79], 0
v_exp_f32 v115, v115
M v[188:191], a[124:127], v[44:47], v[188:191]
v_cvt_pk_bf16_f32 v99, v114, v115
s_waitcnt lgkmcnt(6)
M a[100:103], a[112:115], v[36:39], 0
M a[100:103], a[112:115], v[68:71], a[100:103]
M v[192:195], a[132:135], v[32:35], 0
v_exp_f32 v100, v100
M v[192:195], a[136:139], v[64:67], v[192:195]
ds_read_b128 a[164:167], v5 offset:38912
ds_read_b128 a[168:171], v5 offset:47104
M v[196:199], a[136:139], v[68:71], 0
v_exp_f32 v101, v101
M v[196:199], a[132:135], v[36:39], v[196:199]
v_cvt_pk_bf16_f32 v100, v100, v101
M v[200:203], a[132:135], v[40:43], 0
v_exp_f32 v102, v102
M v[200:203], a[136:139], v[72:75], v[200:203]
M v[204:207], a[136:139], v[76:79], 0
v_exp_f32 v103, v103
M v[204:207], a[132:135], v[44:47], v[204:207]
v_cvt_pk_bf16_f32 v101, v102, v103
s_waitcnt lgkmcnt(6)
M a[104:107], a[112:115], v[40:43], 0
M a[104:107], a[112:115], v[72:75], a[104:107]
M v[208:211], a[140:143], v[32:35], 0
v_exp_f32 v116, v116
M v[208:211], a[144:147], v[64:67], v[208:211]
ds_read_b128 a[172:175], v5 offset:39936
ds_read_b128 a[176:179], v5 offset:48128
M v[212:215], a[144:147], v[68:71], 0
v_exp_f32 v117, v117
M v[212:215], a[140:143], v[36:39], v[212:215]
v_cvt_pk_bf16_f32 v102, v116, v117
M v[216:219], a[140:143], v[40:43], 0
v_exp_f32 v118, v118
M v[216:219], a[144:147], v[72:75], v[216:219]
M v[220:223], a[144:147], v[76:79], 0
v_exp_f32 v119, v119
M v[220:223], a[140:143], v[44:47], v[220:223]
v_cvt_pk_bf16_f32 v103, v118, v119
s_waitcnt lgkmcnt(6)
M a[108:111], a[112:115], v[44:47], 0
M a[108:111], a[112:115], v[76:79], a[108:111]
M v[224:227], a[148:151], v[32:35], 0
v_exp_f32 v104, v104
M v[224:227], a[152:155], v[64:67], v[224:227]
M v[228:231], a[152:155], v[68:71], 0
v_exp_f32 v105, v105
M v[228:231], a[148:151], v[36:39], v[228:231]
v_cvt_pk_bf16_f32 v104, v104, v105
M v[232:235], a[148:151], v[40:43], 0
v_exp_f32 v106, v106
M v[232:235], a[152:155], v[72:75], v[232:235]
M v[236:239], a[152:155], v[76:79], 0
v_exp_f32 v107, v107
M v[236:239], a[148:151], v[44:47], v[236:239]
v_cvt_pk_bf16_f32 v105, v106, v107
s_waitcnt lgkmcnt(4)
M v[240:243], a[156:159], v[32:35], 0
v_exp_f32 v120, v120
M v[240:243], a[160:163], v[64:67], v[240:243]
M v[244:247], a[160:163], v[68:71], 0
v_exp_f32 v121, v121
M v[244:247], a[156:159], v[36:39], v[244:247]
v_cvt_pk_bf16_f32 v106, v120, v121
M v[248:251], a[156:159], v[40:43], 0
v_exp_f32 v122, v122
M v[248:251], a[160:163], v[72:75], v[248:251]
s_waitcnt vmcnt(0) lgkmcnt(0)
s_barrier
ds_read_b128 a[116:119], v3 offset:0
ds_read_b128 a[120:123], v3 offset:1024
M v[252:255], a[160:163], v[76:79], 0
v_exp_f32 v123, v123
M v[252:255], a[156:159], v[44:47], v[252:255]
v_cvt_pk_bf16_f32 v107, v122, v123
M a[64:67], a[164:167], v[32:35], 0
v_exp_f32 v108, v108
M a[64:67], a[168:171], v[64:67], a[64:67]
ds_read_b128 a[124:127], v3 offset:2048
ds_read_b128 a[128:131], v3 offset:3072
M a[68:71], a[168:171], v[68:71], 0
v_exp_f32 v109, v109
M a[68:71], a[164:167], v[36:39], a[68:71]
v_cvt_pk_bf16_f32 v108, v108, v109
M a[72:75], a[164:167], v[40:43], 0
v_exp_f32 v110, v110
M a[72:75], a[168:171], v[72:75], a[72:75]
ds_read_b128 a[132:135], v3 offset:4096
ds_read_b128 a[136:139], v3 offset:5120
M a[76:79], a[168:171], v[76:79], 0
v_exp_f32 v111, v111
M a[76:79], a[164:167], v[44:47], a[76:79]
v_cvt_pk_bf16_f32 v109, v110, v111
M a[80:83], a[172:175], v[32:35], 0
v_exp_f32 v124, v124
M a[80:83], a[176:179], v[64:67], a[80:83]
ds_read_b128 a[140:143], v3 offset:6144
ds_read_b128 a[144:147], v3 offset:7168
M a[84:87], a[176:179], v[68:71], 0
v_exp_f32 v125, v125
M a[84:87], a[172:175], v[36:39], a[84:87]
v_cvt_pk_bf16_f32 v110, v124, v125
M a[88:91], a[172:175], v[40:43], 0
v_exp_f32 v126, v126
M a[88:91], a[176:179], v[72:75], a[88:91]
M a[92:95], a[176:179], v[76:79], 0
v_exp_f32 v127, v127
M a[92:95], a[172:175], v[44:47], a[92:95]
v_cvt_pk_bf16_f32 v111, v126, v127
s_branch Lk2_l2b
Lk2_l2:
s_add_u32 m0, s29, 65536
s_waitcnt lgkmcnt(4)
M v[96:99], a[116:119], a[180:183], 0
v_exp_f32 v64, v64
M v[96:99], a[120:123], a[184:187], v[96:99]
ds_read_b128 a[148:151], v2 offset:8192
ds_read_b128 a[152:155], v2 offset:9216
M v[96:99], a[124:127], a[188:191], v[96:99]
v_exp_f32 v65, v65
M v[96:99], a[128:131], a[192:195], v[96:99]
buffer_load_dwordx4 v1, s[12:15], s25 offen offset:0 sc1 lds
s_add_u32 s32, s25, 4096
M v[100:103], a[128:131], a[208:211], 0
v_exp_f32 v66, v66
M v[100:103], a[124:127], a[204:207], v[100:103]
v_cvt_pk_bf16_f32 v64, v64, v65
M v[100:103], a[120:123], a[200:203], v[100:103]
v_exp_f32 v67, v67
M v[100:103], a[116:119], a[196:199], v[100:103]
buffer_load_dwordx4 v1, s[12:15], s25 offen offset:1024 sc1 lds
M v[104:107], a[116:119], a[212:215], 0
v_exp_f32 v80, v80
M v[104:107], a[120:123], a[216:219], v[104:107]
ds_read_b128 a[156:159], v2 offset:10240
ds_read_b128 a[160:163], v2 offset:11264
M v[104:107], a[124:127], a[220:223], v[104:107]
v_exp_f32 v81, v81
M v[104:107], a[128:131], a[224:227], v[104:107]
buffer_load_dwordx4 v1, s[12:15], s25 offen offset:2048 sc1 lds
M v[108:111], a[128:131], a[240:243], 0
v_exp_f32 v82, v82
M v[108:111], a[124:127], a[236:239], v[108:111]
v_cvt_pk_bf16_f32 v65, v66, v67
v_cvt_pk_bf16_f32 v66, v80, v81
M v[108:111], a[120:123], a[232:235], v[108:111]
v_exp_f32 v83, v83
M v[108:111], a[116:119], a[228:231], v[108:111]
buffer_load_dwordx4 v1, s[12:15], s25 offen offset:3072 sc1 lds
s_add_u32 m0, s29, 69632
s_waitcnt lgkmcnt(4)
M v[112:115], a[132:135], a[180:183], 0
v_exp_f32 v68, v68
M v[112:115], a[136:139], a[184:187], v[112:115]
ds_read_b128 a[164:167], v2 offset:12288
ds_read_b128 a[168:171], v2 offset:13312
M v[112:115], a[140:143], a[188:191], v[112:115]
v_exp_f32 v69, v69
M v[112:115], a[144:147], a[192:195], v[112:115]
buffer_load_dwordx4 v1, s[12:15], s32 offen offset:0 sc1 lds
M v[116:119], a[144:147], a[208:211], 0
v_exp_f32 v70, v70
M v[116:119], a[140:143], a[204:207], v[116:119]
v_cvt_pk_bf16_f32 v67, v82, v83
v_cvt_pk_bf16_f32 v68, v68, v69
M v[116:119], a[136:139], a[200:203], v[116:119]
v_exp_f32 v71, v71
M v[116:119], a[132:135], a[196:199], v[116:119]
buffer_load_dwordx4 v1, s[12:15], s32 offen offset:1024 sc1 lds
M v[120:123], a[132:135], a[212:215], 0
v_exp_f32 v84, v84
M v[120:123], a[136:139], a[216:219], v[120:123]
ds_read_b128 a[172:175], v2 offset:14336
ds_read_b128 a[176:179], v2 offset:15360
M v[120:123], a[140:143], a[220:223], v[120:123]
v_exp_f32 v85, v85
M v[120:123], a[144:147], a[224:227], v[120:123]
buffer_load_dwordx4 v1, s[12:15], s32 offen offset:2048 sc1 lds
M v[124:127], a[144:147], a[240:243], 0
v_exp_f32 v86, v86
M v[124:127], a[140:143], a[236:239], v[124:127]
v_cvt_pk_bf16_f32 v69, v70, v71
v_cvt_pk_bf16_f32 v70, v84, v85
M v[124:127], a[136:139], a[232:235], v[124:127]
v_exp_f32 v87, v87
M v[124:127], a[132:135], a[228:231], v[124:127]
buffer_load_dwordx4 v1, s[12:15], s32 offen offset:3072 sc1 lds
s_add_u32 m0, s29, 98304
s_waitcnt lgkmcnt(4)
M v[128:131], a[148:151], a[180:183], 0
v_exp_f32 v72, v72
M v[128:131], a[152:155], a[184:187], v[128:131]
ds_read_b128 a[116:119], v5 offset:32768
ds_read_b128 a[120:123], v5 offset:40960
M v[128:131], a[156:159], a[188:191], v[128:131]
v_exp_f32 v73, v73
M v[128:131], a[160:163], a[192:195], v[128:131]
buffer_load_dwordx4 v1, s[12:15], s26 offen offset:0 sc1 lds
s_add_u32 s43, s26, 4096
M v[132:135], a[160:163], a[208:211], 0
v_exp_f32 v74, v74
M v[132:135], a[156:159], a[204:207], v[132:135]
v_cvt_pk_bf16_f32 v71, v86, v87
v_cvt_pk_bf16_f32 v72, v72, v73
M v[132:135], a[152:155], a[200:203], v[132:135]
v_exp_f32 v75, v75
M v[132:135], a[148:151], a[196:199], v[132:135]
buffer_load_dwordx4 v1, s[12:15], s26 offen offset:1024 sc1 lds
M v[136:139], a[148:151], a[212:215], 0
v_exp_f32 v88, v88
M v[136:139], a[152:155], a[216:219], v[136:139]
ds_read_b128 a[124:127], v5 offset:33792
ds_read_b128 a[128:131], v5 offset:41984
M v[136:139], a[156:159], a[220:223], v[136:139]
v_exp_f32 v89, v89
M v[136:139], a[160:163], a[224:227], v[136:139]
buffer_load_dwordx4 v1, s[12:15], s26 offen offset:2048 sc1 lds
M v[140:143], a[160:163], a[240:243], 0
v_exp_f32 v90, v90
M v[140:143], a[156:159], a[236:239], v[140:143]
v_cvt_pk_bf16_f32 v73, v74, v75
v_cvt_pk_bf16_f32 v74, v88, v89
M v[140:143], a[152:155], a[232:235], v[140:143]
v_exp_f32 v91, v91
M v[140:143], a[148:151], a[228:231], v[140:143]
buffer_load_dwordx4 v1, s[12:15], s26 offen offset:3072 sc1 lds
s_add_u32 m0, s29, 102400
s_waitcnt lgkmcnt(4)
M v[144:147], a[164:167], a[180:183], 0
v_exp_f32 v76, v76
M v[144:147], a[168:171], a[184:187], v[144:147]
ds_read_b128 a[132:135], v5 offset:34816
ds_read_b128 a[136:139], v5 offset:43008
M v[144:147], a[172:175], a[188:191], v[144:147]
v_exp_f32 v77, v77
M v[144:147], a[176:179], a[192:195], v[144:147]
buffer_load_dwordx4 v1, s[12:15], s43 offen offset:0 sc1 lds
M v[148:151], a[176:179], a[208:211], 0
v_exp_f32 v78, v78
M v[148:151], a[172:175], a[204:207], v[148:151]
v_cvt_pk_bf16_f32 v75, v90, v91
v_cvt_pk_bf16_f32 v76, v76, v77
M v[148:151], a[168:171], a[200:203], v[148:151]
v_exp_f32 v79, v79
M v[148:151], a[164:167], a[196:199], v[148:151]
buffer_load_dwordx4 v1, s[12:15], s43 offen offset:1024 sc1 lds
M v[152:155], a[164:167], a[212:215], 0
v_exp_f32 v92, v92
M v[152:155], a[168:171], a[216:219], v[152:155]
ds_read_b128 a[140:143], v5 offset:35840
ds_read_b128 a[144:147], v5 offset:44032
M v[152:155], a[172:175], a[220:223], v[152:155]
v_exp_f32 v93, v93
M v[152:155], a[176:179], a[224:227], v[152:155]
buffer_load_dwordx4 v1, s[12:15], s43 offen offset:2048 sc1 lds
M v[156:159], a[176:179], a[240:243], 0
v_exp_f32 v94, v94
M v[156:159], a[172:175], a[236:239], v[156:159]
v_cvt_pk_bf16_f32 v77, v78, v79
v_cvt_pk_bf16_f32 v78, v92, v93
M v[156:159], a[168:171], a[232:235], v[156:159]
v_exp_f32 v95, v95
M v[156:159], a[164:167], a[228:231], v[156:159]
buffer_load_dwordx4 v1, s[12:15], s43 offen offset:3072 sc1 lds
v_cvt_pk_bf16_f32 v79, v94, v95
s_waitcnt lgkmcnt(6)
M v[160:163], a[116:119], v[32:35], v[160:163]
v_exp_f32 v96, v96
M v[160:163], a[120:123], v[64:67], v[160:163]
ds_read_b128 a[148:151], v5 offset:36864
ds_read_b128 a[152:155], v5 offset:45056
M v[164:167], a[120:123], v[68:71], v[164:167]
v_exp_f32 v97, v97
M v[164:167], a[116:119], v[36:39], v[164:167]
v_cvt_pk_bf16_f32 v96, v96, v97
M v[168:171], a[116:119], v[40:43], v[168:171]
v_exp_f32 v98, v98
M v[168:171], a[120:123], v[72:75], v[168:171]
s_add_u32 s25, s25, 32768
s_cmp_eq_u32 s25, s27
M v[172:175], a[120:123], v[76:79], v[172:175]
v_exp_f32 v99, v99
M v[172:175], a[116:119], v[44:47], v[172:175]
v_cvt_pk_bf16_f32 v97, v98, v99
s_waitcnt lgkmcnt(6)
M a[96:99], a[112:115], v[32:35], a[96:99]
s_cselect_b32 s25, s28, s25
s_cselect_b32 s27, -1, s27
M a[96:99], a[112:115], v[64:67], a[96:99]
s_add_u32 s26, s26, 32768
s_cmp_eq_u32 s26, s62
M v[176:179], a[124:127], v[32:35], v[176:179]
v_exp_f32 v112, v112
M v[176:179], a[128:131], v[64:67], v[176:179]
ds_read_b128 a[156:159], v5 offset:37888
ds_read_b128 a[160:163], v5 offset:46080
M v[180:183], a[128:131], v[68:71], v[180:183]
v_exp_f32 v113, v113
M v[180:183], a[124:127], v[36:39], v[180:183]
v_cvt_pk_bf16_f32 v98, v112, v113
M v[184:187], a[124:127], v[40:43], v[184:187]
v_exp_f32 v114, v114
M v[184:187], a[128:131], v[72:75], v[184:187]
s_cselect_b32 s26, s63, s26
s_cselect_b32 s62, -1, s62
M v[188:191], a[128:131], v[76:79], v[188:191]
v_exp_f32 v115, v115
M v[188:191], a[124:127], v[44:47], v[188:191]
v_cvt_pk_bf16_f32 v99, v114, v115
s_waitcnt lgkmcnt(6)
M a[100:103], a[112:115], v[36:39], a[100:103]
M a[100:103], a[112:115], v[68:71], a[100:103]
M v[192:195], a[132:135], v[32:35], v[192:195]
v_exp_f32 v100, v100
M v[192:195], a[136:139], v[64:67], v[192:195]
ds_read_b128 a[164:167], v5 offset:38912
ds_read_b128 a[168:171], v5 offset:47104
M v[196:199], a[136:139], v[68:71], v[196:199]
v_exp_f32 v101, v101
M v[196:199], a[132:135], v[36:39], v[196:199]
v_cvt_pk_bf16_f32 v100, v100, v101
M v[200:203], a[132:135], v[40:43], v[200:203]
v_exp_f32 v102, v102
M v[200:203], a[136:139], v[72:75], v[200:203]
M v[204:207], a[136:139], v[76:79], v[204:207]
v_exp_f32 v103, v103
M v[204:207], a[132:135], v[44:47], v[204:207]
v_cvt_pk_bf16_f32 v101, v102, v103
s_waitcnt lgkmcnt(6)
M a[104:107], a[112:115], v[40:43], a[104:107]
M a[104:107], a[112:115], v[72:75], a[104:107]
M v[208:211], a[140:143], v[32:35], v[208:211]
v_exp_f32 v116, v116
M v[208:211], a[144:147], v[64:67], v[208:211]
ds_read_b128 a[172:175], v5 offset:39936
ds_read_b128 a[176:179], v5 offset:48128
M v[212:215], a[144:147], v[68:71], v[212:215]
v_exp_f32 v117, v117
M v[212:215], a[140:143], v[36:39], v[212:215]
v_cvt_pk_bf16_f32 v102, v116, v117
M v[216:219], a[140:143], v[40:43], v[216:219]
v_exp_f32 v118, v118
M v[216:219], a[144:147], v[72:75], v[216:219]
M v[220:223], a[144:147], v[76:79], v[220:223]
v_exp_f32 v119, v119
M v[220:223], a[140:143], v[44:47], v[220:223]
v_cvt_pk_bf16_f32 v103, v118, v119
s_waitcnt lgkmcnt(6)
M a[108:111], a[112:115], v[44:47], a[108:111]
M a[108:111], a[112:115], v[76:79], a[108:111]
M v[224:227], a[148:151], v[32:35], v[224:227]
v_exp_f32 v104, v104
M v[224:227], a[152:155], v[64:67], v[224:227]
M v[228:231], a[152:155], v[68:71], v[228:231]
v_exp_f32 v105, v105
M v[228:231], a[148:151], v[36:39], v[228:231]
v_cvt_pk_bf16_f32 v104, v104, v105
M v[232:235], a[148:151], v[40:43], v[232:235]
v_exp_f32 v106, v106
M v[232:235], a[152:155], v[72:75], v[232:235]
M v[236:239], a[152:155], v[76:79], v[236:239]
v_exp_f32 v107, v107
M v[236:239], a[148:151], v[44:47], v[236:239]
v_cvt_pk_bf16_f32 v105, v106, v107
s_waitcnt lgkmcnt(4)
M v[240:243], a[156:159], v[32:35], v[240:243]
v_exp_f32 v120, v120
M v[240:243], a[160:163], v[64:67], v[240:243]
M v[244:247], a[160:163], v[68:71], v[244:247]
v_exp_f32 v121, v121
M v[244:247], a[156:159], v[36:39], v[244:247]
v_cvt_pk_bf16_f32 v106, v120, v121
M v[248:251], a[156:159], v[40:43], v[248:251]
v_exp_f32 v122, v122
M v[248:251], a[160:163], v[72:75], v[248:251]
s_waitcnt vmcnt(0) lgkmcnt(0)
s_barrier
ds_read_b128 a[116:119], v3 offset:0
ds_read_b128 a[120:123], v3 offset:1024
M v[252:255], a[160:163], v[76:79], v[252:255]
v_exp_f32 v123, v123
M v[252:255], a[156:159], v[44:47], v[252:255]
v_cvt_pk_bf16_f32 v107, v122, v123
M a[64:67], a[164:167], v[32:35], a[64:67]
v_exp_f32 v108, v108
M a[64:67], a[168:171], v[64:67], a[64:67]
ds_read_b128 a[124:127], v3 offset:2048
ds_read_b128 a[128:131], v3 offset:3072
M a[68:71], a[168:171], v[68:71], a[68:71]
v_exp_f32 v109, v109
M a[68:71], a[164:167], v[36:39], a[68:71]
v_cvt_pk_bf16_f32 v108, v108, v109
M a[72:75], a[164:167], v[40:43], a[72:75]
v_exp_f32 v110, v110
M a[72:75], a[168:171], v[72:75], a[72:75]
ds_read_b128 a[132:135], v3 offset:4096
ds_read_b128 a[136:139], v3 offset:5120
M a[76:79], a[168:171], v[76:79], a[76:79]
v_exp_f32 v111, v111
M a[76:79], a[164:167], v[44:47], a[76:79]
v_cvt_pk_bf16_f32 v109, v110, v111
M a[80:83], a[172:175], v[32:35], a[80:83]
v_exp_f32 v124, v124
M a[80:83], a[176:179], v[64:67], a[80:83]
ds_read_b128 a[140:143], v3 offset:6144
ds_read_b128 a[144:147], v3 offset:7168
M a[84:87], a[176:179], v[68:71], a[84:87]
v_exp_f32 v125, v125
M a[84:87], a[172:175], v[36:39], a[84:87]
v_cvt_pk_bf16_f32 v110, v124, v125
M a[88:91], a[172:175], v[40:43], a[88:91]
v_exp_f32 v126, v126
M a[88:91], a[176:179], v[72:75], a[88:91]
M a[92:95], a[176:179], v[76:79], a[92:95]
v_exp_f32 v127, v127
M a[92:95], a[172:175], v[44:47], a[92:95]
v_cvt_pk_bf16_f32 v111, v126, v127
Lk2_l2b:
s_add_u32 m0, s29, 0
s_waitcnt lgkmcnt(4)
M v[32:35], a[116:119], a[180:183], 0
v_exp_f32 v128, v128
M v[32:35], a[120:123], a[184:187], v[32:35]
ds_read_b128 a[148:151], v3 offset:8192
ds_read_b128 a[152:155], v3 offset:9216
M v[32:35], a[124:127], a[188:191], v[32:35]
v_exp_f32 v129, v129
M v[32:35], a[128:131], a[192:195], v[32:35]
buffer_load_dwordx4 v1, s[12:15], s25 offen offset:0 sc1 lds
s_add_u32 s32, s25, 4096
M v[36:39], a[128:131], a[208:211], 0
v_exp_f32 v130, v130
M v[36:39], a[124:127], a[204:207], v[36:39]
v_cvt_pk_bf16_f32 v128, v128, v129
M v[36:39], a[120:123], a[200:203], v[36:39]
v_exp_f32 v131, v131
M v[36:39], a[116:119], a[196:199], v[36:39]
buffer_load_dwordx4 v1, s[12:15], s25 offen offset:1024 sc1 lds
M v[40:43], a[116:119], a[212:215], 0
v_exp_f32 v144, v144
M v[40:43], a[120:123], a[216:219], v[40:43]
ds_read_b128 a[156:159], v3 offset:10240
ds_read_b128 a[160:163], v3 offset:11264
M v[40:43], a[124:127], a[220:223], v[40:43]
v_exp_f32 v145, v145
M v[40:43], a[128:131], a[224:227], v[40:43]
buffer_load_dwordx4 v1, s[12:15], s25 offen offset:2048 sc1 lds
M v[44:47], a[128:131], a[240:243], 0
v_exp_f32 v146, v146
M v[44:47], a[124:127], a[236:239], v[44:47]
v_cvt_pk_bf16_f32 v129, v130, v131
v_cvt_pk_bf16_f32 v130, v144, v145
M v[44:47], a[120:123], a[232:235], v[44:47]
v_exp_f32 v147, v147
M v[44:47], a[116:119], a[228:231], v[44:47]
buffer_load_dwordx4 v1, s[12:15], s25 offen offset:3072 sc1 lds
s_add_u32 m0, s29, 4096
s_waitcnt lgkmcnt(4)
M v[48:51], a[132:135], a[180:183], 0
v_exp_f32 v132, v132
M v[48:51], a[136:139], a[184:187], v[48:51]
ds_read_b128 a[164:167], v3 offset:12288
ds_read_b128 a[168:171], v3 offset:13312
M v[48:51], a[140:143], a[188:191], v[48:51]
v_exp_f32 v133, v133
M v[48:51], a[144:147], a[192:195], v[48:51]
buffer_load_dwordx4 v1, s[12:15], s32 offen offset:0 sc1 lds
M v[52:55], a[144:147], a[208:211], 0
v_exp_f32 v134, v134
M v[52:55], a[140:143], a[204:207], v[52:55]
v_cvt_pk_bf16_f32 v131, v146, v147
v_cvt_pk_bf16_f32 v132, v132, v133
M v[52:55], a[136:139], a[200:203], v[52:55]
v_exp_f32 v135, v135
M v[52:55], a[132:135], a[196:199], v[52:55]
buffer_load_dwordx4 v1, s[12:15], s32 offen offset:1024 sc1 lds
M v[56:59], a[132:135], a[212:215], 0
v_exp_f32 v148, v148
M v[56:59], a[136:139], a[216:219], v[56:59]
ds_read_b128 a[172:175], v3 offset:14336
ds_read_b128 a[176:179], v3 offset:15360
M v[56:59], a[140:143], a[220:223], v[56:59]
v_exp_f32 v149, v149
M v[56:59], a[144:147], a[224:227], v[56:59]
buffer_load_dwordx4 v1, s[12:15], s32 offen offset:2048 sc1 lds
M v[60:63], a[144:147], a[240:243], 0
v_exp_f32 v150, v150
M v[60:63], a[140:143], a[236:239], v[60:63]
v_cvt_pk_bf16_f32 v133, v134, v135
v_cvt_pk_bf16_f32 v134, v148, v149
M v[60:63], a[136:139], a[232:235], v[60:63]
v_exp_f32 v151, v151
M v[60:63], a[132:135], a[228:231], v[60:63]
buffer_load_dwordx4 v1, s[12:15], s32 offen offset:3072 sc1 lds
s_add_u32 m0, s29, 32768
s_waitcnt lgkmcnt(4)
M v[64:67], a[148:151], a[180:183], 0
v_exp_f32 v136, v136
M v[64:67], a[152:155], a[184:187], v[64:67]
ds_read_b128 a[116:119], v6 offset:32768
ds_read_b128 a[120:123], v6 offset:40960
M v[64:67], a[156:159], a[188:191], v[64:67]
v_exp_f32 v137, v137
M v[64:67], a[160:163], a[192:195], v[64:67]
buffer_load_dwordx4 v1, s[12:15], s26 offen offset:0 sc1 lds
s_add_u32 s43, s26, 4096
M v[68:71], a[160:163], a[208:211], 0
v_exp_f32 v138, v138
M v[68:71], a[156:159], a[204:207], v[68:71]
v_cvt_pk_bf16_f32 v135, v150, v151
v_cvt_pk_bf16_f32 v136, v136, v137
M v[68:71], a[152:155], a[200:203], v[68:71]
v_exp_f32 v139, v139
M v[68:71], a[148:151], a[196:199], v[68:71]
buffer_load_dwordx4 v1, s[12:15], s26 offen offset:1024 sc1 lds
M v[72:75], a[148:151], a[212:215], 0
v_exp_f32 v152, v152
M v[72:75], a[152:155], a[216:219], v[72:75]
ds_read_b128 a[124:127], v6 offset:33792
ds_read_b128 a[128:131], v6 offset:41984
M v[72:75], a[156:159], a[220:223], v[72:75]
v_exp_f32 v153, v153
M v[72:75], a[160:163], a[224:227], v[72:75]
buffer_load_dwordx4 v1, s[12:15], s26 offen offset:2048 sc1 lds
M v[76:79], a[160:163], a[240:243], 0
v_exp_f32 v154, v154
M v[76:79], a[156:159], a[236:239], v[76:79]
v_cvt_pk_bf16_f32 v137, v138, v139
v_cvt_pk_bf16_f32 v138, v152, v153
M v[76:79], a[152:155], a[232:235], v[76:79]
v_exp_f32 v155, v155
M v[76:79], a[148:151], a[228:231], v[76:79]
buffer_load_dwordx4 v1, s[12:15], s26 offen offset:3072 sc1 lds
s_add_u32 m0, s29, 36864
s_waitcnt lgkmcnt(4)
M v[80:83], a[164:167], a[180:183], 0
v_exp_f32 v140, v140
M v[80:83], a[168:171], a[184:187], v[80:83]
ds_read_b128 a[132:135], v6 offset:34816
ds_read_b128 a[136:139], v6 offset:43008
M v[80:83], a[172:175], a[188:191], v[80:83]
v_exp_f32 v141, v141
M v[80:83], a[176:179], a[192:195], v[80:83]
buffer_load_dwordx4 v1, s[12:15], s43 offen offset:0 sc1 lds
M v[84:87], a[176:179], a[208:211], 0
v_exp_f32 v142, v142
M v[84:87], a[172:175], a[204:207], v[84:87]
v_cvt_pk_bf16_f32 v139, v154, v155
v_cvt_pk_bf16_f32 v140, v140, v141
M v[84:87], a[168:171], a[200:203], v[84:87]
v_exp_f32 v143, v143
M v[84:87], a[164:167], a[196:199], v[84:87]
buffer_load_dwordx4 v1, s[12:15], s43 offen offset:1024 sc1 lds
M v[88:91], a[164:167], a[212:215], 0
v_exp_f32 v156, v156
M v[88:91], a[168:171], a[216:219], v[88:91]
ds_read_b128 a[140:143], v6 offset:35840
ds_read_b128 a[144:147], v6 offset:44032
M v[88:91], a[172:175], a[220:223], v[88:91]
v_exp_f32 v157, v157
M v[88:91], a[176:179], a[224:227], v[88:91]
buffer_load_dwordx4 v1, s[12:15], s43 offen offset:2048 sc1 lds
M v[92:95], a[176:179], a[240:243], 0
v_exp_f32 v158, v158
M v[92:95], a[172:175], a[236:239], v[92:95]
v_cvt_pk_bf16_f32 v141, v142, v143
v_cvt_pk_bf16_f32 v142, v156, v157
M v[92:95], a[168:171], a[232:235], v[92:95]
v_exp_f32 v159, v159
M v[92:95], a[164:167], a[228:231], v[92:95]
buffer_load_dwordx4 v1, s[12:15], s43 offen offset:3072 sc1 lds
v_cvt_pk_bf16_f32 v143, v158, v159
s_waitcnt lgkmcnt(6)
M v[160:163], a[116:119], v[96:99], v[160:163]
v_exp_f32 v32, v32
M v[160:163], a[120:123], v[128:131], v[160:163]
ds_read_b128 a[148:151], v6 offset:36864
ds_read_b128 a[152:155], v6 offset:45056
M v[164:167], a[120:123], v[132:135], v[164:167]
v_exp_f32 v33, v33
M v[164:167], a[116:119], v[100:103], v[164:167]
v_cvt_pk_bf16_f32 v32, v32, v33
M v[168:171], a[116:119], v[104:107], v[168:171]
v_exp_f32 v34, v34
M v[168:171], a[120:123], v[136:139], v[168:171]
s_add_u32 s25, s25, 32768
s_cmp_eq_u32 s25, s27
M v[172:175], a[120:123], v[140:143], v[172:175]
v_exp_f32 v35, v35
M v[172:175], a[116:119], v[108:111], v[172:175]
v_cvt_pk_bf16_f32 v33, v34, v35
s_waitcnt lgkmcnt(6)
M a[96:99], a[112:115], v[96:99], a[96:99]
s_cselect_b32 s25, s28, s25
s_cselect_b32 s27, -1, s27
M a[96:99], a[112:115], v[128:131], a[96:99]
s_add_u32 s26, s26, 32768
s_cmp_eq_u32 s26, s62
M v[176:179], a[124:127], v[96:99], v[176:179]
v_exp_f32 v48, v48
M v[176:179], a[128:131], v[128:131], v[176:179]
ds_read_b128 a[156:159], v6 offset:37888
ds_read_b128 a[160:163], v6 offset:46080
M v[180:183], a[128:131], v[132:135], v[180:183]
v_exp_f32 v49, v49
M v[180:183], a[124:127], v[100:103], v[180:183]
v_cvt_pk_bf16_f32 v34, v48, v49
M v[184:187], a[124:127], v[104:107], v[184:187]
v_exp_f32 v50, v50
M v[184:187], a[128:131], v[136:139], v[184:187]
s_cselect_b32 s26, s63, s26
s_cselect_b32 s62, -1, s62
M v[188:191], a[128:131], v[140:143], v[188:191]
v_exp_f32 v51, v51
M v[188:191], a[124:127], v[108:111], v[188:191]
v_cvt_pk_bf16_f32 v35, v50, v51
s_waitcnt lgkmcnt(6)
M a[100:103], a[112:115], v[100:103], a[100:103]
M a[100:103], a[112:115], v[132:135], a[100:103]
M v[192:195], a[132:135], v[96:99], v[192:195]
v_exp_f32 v36, v36
M v[192:195], a[136:139], v[128:131], v[192:195]
ds_read_b128 a[164:167], v6 offset:38912
ds_read_b128 a[168:171], v6 offset:47104
M v[196:199], a[136:139], v[132:135], v[196:199]
v_exp_f32 v37, v37
M v[196:199], a[132:135], v[100:103], v[196:199]
v_cvt_pk_bf16_f32 v36, v36, v37
M v[200:203], a[132:135], v[104:107], v[200:203]
v_exp_f32 v38, v38
M v[200:203], a[136:139], v[136:139], v[200:203]
M v[204:207], a[136:139], v[140:143], v[204:207]
v_exp_f32 v39, v39
M v[204:207], a[132:135], v[108:111], v[204:207]
v_cvt_pk_bf16_f32 v37, v38, v39
s_waitcnt lgkmcnt(6)
M a[104:107], a[112:115], v[104:107], a[104:107]
M a[104:107], a[112:115], v[136:139], a[104:107]
M v[208:211], a[140:143], v[96:99], v[208:211]
v_exp_f32 v52, v52
M v[208:211], a[144:147], v[128:131], v[208:211]
ds_read_b128 a[172:175], v6 offset:39936
ds_read_b128 a[176:179], v6 offset:48128
M v[212:215], a[144:147], v[132:135], v[212:215]
v_exp_f32 v53, v53
M v[212:215], a[140:143], v[100:103], v[212:215]
v_cvt_pk_bf16_f32 v38, v52, v53
M v[216:219], a[140:143], v[104:107], v[216:219]
v_exp_f32 v54, v54
M v[216:219], a[144:147], v[136:139], v[216:219]
M v[220:223], a[144:147], v[140:143], v[220:223]
v_exp_f32 v55, v55
M v[220:223], a[140:143], v[108:111], v[220:223]
v_cvt_pk_bf16_f32 v39, v54, v55
s_waitcnt lgkmcnt(6)
M a[108:111], a[112:115], v[108:111], a[108:111]
M a[108:111], a[112:115], v[140:143], a[108:111]
M v[224:227], a[148:151], v[96:99], v[224:227]
v_exp_f32 v40, v40
M v[224:227], a[152:155], v[128:131], v[224:227]
M v[228:231], a[152:155], v[132:135], v[228:231]
v_exp_f32 v41, v41
M v[228:231], a[148:151], v[100:103], v[228:231]
v_cvt_pk_bf16_f32 v40, v40, v41
M v[232:235], a[148:151], v[104:107], v[232:235]
v_exp_f32 v42, v42
M v[232:235], a[152:155], v[136:139], v[232:235]
M v[236:239], a[152:155], v[140:143], v[236:239]
v_exp_f32 v43, v43
M v[236:239], a[148:151], v[108:111], v[236:239]
v_cvt_pk_bf16_f32 v41, v42, v43
s_waitcnt lgkmcnt(4)
M v[240:243], a[156:159], v[96:99], v[240:243]
v_exp_f32 v56, v56
M v[240:243], a[160:163], v[128:131], v[240:243]
M v[244:247], a[160:163], v[132:135], v[244:247]
v_exp_f32 v57, v57
M v[244:247], a[156:159], v[100:103], v[244:247]
v_cvt_pk_bf16_f32 v42, v56, v57
M v[248:251], a[156:159], v[104:107], v[248:251]
v_exp_f32 v58, v58
M v[248:251], a[160:163], v[136:139], v[248:251]
s_waitcnt vmcnt(0) lgkmcnt(0)
s_barrier
ds_read_b128 a[116:119], v2 offset:0
ds_read_b128 a[120:123], v2 offset:1024
M v[252:255], a[160:163], v[140:143], v[252:255]
v_exp_f32 v59, v59
M v[252:255], a[156:159], v[108:111], v[252:255]
v_cvt_pk_bf16_f32 v43, v58, v59
M a[64:67], a[164:167], v[96:99], a[64:67]
v_exp_f32 v44, v44
M a[64:67], a[168:171], v[128:131], a[64:67]
ds_read_b128 a[124:127], v2 offset:2048
ds_read_b128 a[128:131], v2 offset:3072
M a[68:71], a[168:171], v[132:135], a[68:71]
v_exp_f32 v45, v45
M a[68:71], a[164:167], v[100:103], a[68:71]
v_cvt_pk_bf16_f32 v44, v44, v45
M a[72:75], a[164:167], v[104:107], a[72:75]
v_exp_f32 v46, v46
M a[72:75], a[168:171], v[136:139], a[72:75]
ds_read_b128 a[132:135], v2 offset:4096
ds_read_b128 a[136:139], v2 offset:5120
M a[76:79], a[168:171], v[140:143], a[76:79]
v_exp_f32 v47, v47
M a[76:79], a[164:167], v[108:111], a[76:79]
v_cvt_pk_bf16_f32 v45, v46, v47
M a[80:83], a[172:175], v[96:99], a[80:83]
v_exp_f32 v60, v60
M a[80:83], a[176:179], v[128:131], a[80:83]
ds_read_b128 a[140:143], v2 offset:6144
ds_read_b128 a[144:147], v2 offset:7168
M a[84:87], a[176:179], v[132:135], a[84:87]
v_exp_f32 v61, v61
M a[84:87], a[172:175], v[100:103], a[84:87]
v_cvt_pk_bf16_f32 v46, v60, v61
M a[88:91], a[172:175], v[104:107], a[88:91]
v_exp_f32 v62, v62
M a[88:91], a[176:179], v[136:139], a[88:91]
M a[92:95], a[176:179], v[140:143], a[92:95]
v_exp_f32 v63, v63
M a[92:95], a[172:175], v[108:111], a[92:95]
v_cvt_pk_bf16_f32 v47, v62, v63
s_sub_u32 s30, s30, 1
s_cmp_lg_u32 s30, 0
s_cbranch_scc1 Lk2_l2
s_and_b32 s3, s2, 3
s_lshl_b32 s3, s3, 2
s_bfe_u32 s27, s2, 0x20003
s_add_u32 s27, s3, s27
s_lshl_b32 s43, s27, 8
s_add_u32 s43, s43, 16789504
v_lshlrev_b32 v15, 2, v0
buffer_load_dword v7, v15, s[52:55], s43 offen sc1
s_waitcnt lgkmcnt(7)
ds_read_b128 a[116:119], v5 offset:36864
s_waitcnt lgkmcnt(7)
ds_read_b128 a[120:123], v5 offset:45056
s_waitcnt lgkmcnt(7)
ds_read_b128 a[124:127], v5 offset:37888
s_waitcnt lgkmcnt(7)
ds_read_b128 a[128:131], v5 offset:46080
s_waitcnt lgkmcnt(7)
ds_read_b128 a[132:135], v5 offset:38912
s_waitcnt lgkmcnt(7)
ds_read_b128 a[136:139], v5 offset:47104
s_waitcnt lgkmcnt(7)
ds_read_b128 a[140:143], v5 offset:39936
s_waitcnt lgkmcnt(7)
ds_read_b128 a[144:147], v5 offset:48128
s_lshl_b32 s33, s23, 14
s_add_u32 s34, s33, 98304
s_add_u32 s33, s33, 131072
v_add_u32 v2, s34, v1
v_add_u32 v3, s33, v1
v_exp_f32 v64, v64
v_exp_f32 v65, v65
v_exp_f32 v66, v66
v_exp_f32 v67, v67
v_exp_f32 v80, v80
v_exp_f32 v81, v81
v_exp_f32 v82, v82
v_exp_f32 v83, v83
v_cvt_pk_bf16_f32 v64, v64, v65
v_cvt_pk_bf16_f32 v65, v66, v67
v_exp_f32 v68, v68
v_exp_f32 v69, v69
v_exp_f32 v70, v70
v_exp_f32 v71, v71
v_cvt_pk_bf16_f32 v66, v80, v81
v_cvt_pk_bf16_f32 v67, v82, v83
v_exp_f32 v84, v84
v_exp_f32 v85, v85
v_exp_f32 v86, v86
v_exp_f32 v87, v87
v_cvt_pk_bf16_f32 v68, v68, v69
v_cvt_pk_bf16_f32 v69, v70, v71
v_exp_f32 v72, v72
v_exp_f32 v73, v73
v_exp_f32 v74, v74
v_exp_f32 v75, v75
v_cvt_pk_bf16_f32 v70, v84, v85
v_cvt_pk_bf16_f32 v71, v86, v87
v_exp_f32 v88, v88
v_exp_f32 v89, v89
v_exp_f32 v90, v90
v_exp_f32 v91, v91
v_cvt_pk_bf16_f32 v72, v72, v73
v_cvt_pk_bf16_f32 v73, v74, v75
v_exp_f32 v76, v76
v_exp_f32 v77, v77
v_exp_f32 v78, v78
v_exp_f32 v79, v79
v_cvt_pk_bf16_f32 v74, v88, v89
v_cvt_pk_bf16_f32 v75, v90, v91
v_exp_f32 v92, v92
v_exp_f32 v93, v93
v_exp_f32 v94, v94
v_exp_f32 v95, v95
v_cvt_pk_bf16_f32 v76, v76, v77
v_cvt_pk_bf16_f32 v77, v78, v79
v_cvt_pk_bf16_f32 v78, v92, v93
v_cvt_pk_bf16_f32 v79, v94, v95
s_waitcnt lgkmcnt(6)
M v[224:227], a[116:119], v[32:35], v[224:227]
M v[224:227], a[120:123], v[64:67], v[224:227]
ds_read_b128 a[148:151], v5 offset:32768
ds_read_b128 a[152:155], v5 offset:40960
s_mov_b32 s61, 0
M v[228:231], a[120:123], v[68:71], v[228:231]
M v[228:231], a[116:119], v[36:39], v[228:231]
s_bfe_u32 s3, s2, 0x10002
M v[232:235], a[116:119], v[40:43], v[232:235]
M v[232:235], a[120:123], v[72:75], v[232:235]
s_lshl_b32 s3, s3, 3
M v[236:239], a[120:123], v[76:79], v[236:239]
M v[236:239], a[116:119], v[44:47], v[236:239]
s_waitcnt lgkmcnt(6)
s_lshr_b32 s28, s2, 5
M a[96:99], a[112:115], v[32:35], a[96:99]
M a[96:99], a[112:115], v[64:67], a[96:99]
M v[240:243], a[124:127], v[32:35], v[240:243]
M v[240:243], a[128:131], v[64:67], v[240:243]
ds_read_b128 a[156:159], v5 offset:33792
ds_read_b128 a[160:163], v5 offset:41984
s_add_u32 s28, s3, s28
M v[244:247], a[128:131], v[68:71], v[244:247]
s_lshl_b32 s25, s27, 18
M v[244:247], a[124:127], v[36:39], v[244:247]
M v[248:251], a[124:127], v[40:43], v[248:251]
s_lshl_b32 s3, s101, 12
M v[248:251], a[128:131], v[72:75], v[248:251]
M v[252:255], a[128:131], v[76:79], v[252:255]
s_add_u32 s25, s25, s3
M v[252:255], a[124:127], v[44:47], v[252:255]
s_waitcnt lgkmcnt(6)
M a[100:103], a[112:115], v[36:39], a[100:103]
M a[100:103], a[112:115], v[68:71], a[100:103]
M a[64:67], a[132:135], v[32:35], a[64:67]
s_lshl_b32 s26, s28, 7
M a[64:67], a[136:139], v[64:67], a[64:67]
ds_read_b128 a[164:167], v5 offset:34816
ds_read_b128 a[168:171], v5 offset:43008
M a[68:71], a[136:139], v[68:71], a[68:71]
s_lshl_b32 s42, s101, 11
M a[68:71], a[132:135], v[36:39], a[68:71]
M a[72:75], a[132:135], v[40:43], a[72:75]
s_add_u32 s44, s4, 83886080
s_addc_u32 s45, s5, 0
M a[72:75], a[136:139], v[72:75], a[72:75]
s_mov_b32 s46, 4194304
M a[76:79], a[136:139], v[76:79], a[76:79]
M a[76:79], a[132:135], v[44:47], a[76:79]
s_waitcnt lgkmcnt(6)
s_mov_b32 s47, 0x00020000
M a[104:107], a[112:115], v[40:43], a[104:107]
M a[104:107], a[112:115], v[72:75], a[104:107]
M a[80:83], a[140:143], v[32:35], a[80:83]
M a[80:83], a[144:147], v[64:67], a[80:83]
ds_read_b128 a[172:175], v5 offset:35840
ds_read_b128 a[176:179], v5 offset:44032
s_mov_b32 s50, 2097152
M a[84:87], a[144:147], v[68:71], a[84:87]
M a[84:87], a[140:143], v[36:39], a[84:87]
s_mov_b32 s51, 0x00020000
M a[88:91], a[140:143], v[40:43], a[88:91]
M a[88:91], a[144:147], v[72:75], a[88:91]
s_lshl_b32 s3, s101, 4
M a[92:95], a[144:147], v[76:79], a[92:95]
M a[92:95], a[140:143], v[44:47], a[92:95]
s_waitcnt lgkmcnt(6)
v_lshrrev_b32 v96, 3, v0
M a[108:111], a[112:115], v[44:47], a[108:111]
M a[108:111], a[112:115], v[76:79], a[108:111]
M v[160:163], a[148:151], v[32:35], v[160:163]
v_and_b32 v97, 6, v96
M v[160:163], a[152:155], v[64:67], v[160:163]
M v[164:167], a[152:155], v[68:71], v[164:167]
ds_write_b128 v2, v[224:227] offset:0
v_and_b32 v98, 7, v0
M v[164:167], a[148:151], v[36:39], v[164:167]
M v[168:171], a[148:151], v[40:43], v[168:171]
ds_write_b128 v2, v[228:231] offset:1024
v_xor_b32 v97, v97, v98
M v[168:171], a[152:155], v[72:75], v[168:171]
M v[172:175], a[152:155], v[76:79], v[172:175]
ds_write_b128 v2, v[232:235] offset:2048
v_add_u32 v96, s3, v96
M v[172:175], a[148:151], v[44:47], v[172:175]
s_waitcnt lgkmcnt(7)
M v[176:179], a[156:159], v[32:35], v[176:179]
ds_write_b128 v2, v[236:239] offset:3072
v_lshlrev_b32 v96, 11, v96
M v[176:179], a[160:163], v[64:67], v[176:179]
M v[180:183], a[160:163], v[68:71], v[180:183]
ds_write_b128 v2, v[240:243] offset:4096
v_lshl_add_u32 v99, v97, 4, v96
M v[180:183], a[156:159], v[36:39], v[180:183]
v_add_u32 v100, 15360, v99
M v[184:187], a[156:159], v[40:43], v[184:187]
ds_write_b128 v2, v[244:247] offset:5120
M v[184:187], a[160:163], v[72:75], v[184:187]
s_waitcnt vmcnt(0) lgkmcnt(0)
s_barrier
M v[188:191], a[160:163], v[76:79], v[188:191]
ds_write_b128 v2, v[248:251] offset:6144
v_cmp_ne_u32 vcc, 1, v7
s_nop 0
s_cbranch_vccnz Lk3_spinb1
Lk3_gotb1:
M v[188:191], a[156:159], v[44:47], v[188:191]
s_add_u32 m0, s42, 16384
s_nop 0
buffer_load_dwordx4 v99, s[48:51], s26 offen offset:0 lds
M v[192:195], a[164:167], v[32:35], v[192:195]
ds_write_b128 v2, v[252:255] offset:7168
buffer_load_dwordx4 v100, s[48:51], s26 offen offset:1024 lds
M v[192:195], a[168:171], v[64:67], v[192:195]
M v[196:199], a[168:171], v[68:71], v[196:199]
ds_write_b128 v2, a[64:67] offset:8192
buffer_load_dwordx4 a[192:195], v1, s[44:47], s25 offen offset:0 sc1
M v[196:199], a[164:167], v[36:39], v[196:199]
buffer_load_dwordx4 a[196:199], v1, s[44:47], s25 offen offset:1024 sc1
M v[200:203], a[164:167], v[40:43], v[200:203]
ds_write_b128 v2, a[68:71] offset:9216
buffer_load_dwordx4 a[200:203], v1, s[44:47], s25 offen offset:2048 sc1
M v[200:203], a[168:171], v[72:75], v[200:203]
buffer_load_dwordx4 a[204:207], v1, s[44:47], s25 offen offset:3072 sc1
M v[204:207], a[168:171], v[76:79], v[204:207]
ds_write_b128 v2, a[72:75] offset:10240
M v[204:207], a[164:167], v[44:47], v[204:207]
s_add_u32 s25, s25, 16384
s_add_u32 s26, s26, 131072
M v[208:211], a[172:175], v[32:35], v[208:211]
ds_write_b128 v2, a[76:79] offset:11264
s_add_u32 m0, s42, 32768
s_nop 0
buffer_load_dwordx4 v99, s[48:51], s26 offen offset:0 lds
M v[208:211], a[176:179], v[64:67], v[208:211]
buffer_load_dwordx4 v100, s[48:51], s26 offen offset:1024 lds
M v[212:215], a[176:179], v[68:71], v[212:215]
ds_write_b128 v2, a[80:83] offset:12288
buffer_load_dwordx4 a[224:227], v1, s[44:47], s25 offen offset:0 sc1
M v[212:215], a[172:175], v[36:39], v[212:215]
M v[216:219], a[172:175], v[40:43], v[216:219]
ds_write_b128 v2, a[84:87] offset:13312
buffer_load_dwordx4 a[228:231], v1, s[44:47], s25 offen offset:1024 sc1
M v[216:219], a[176:179], v[72:75], v[216:219]
buffer_load_dwordx4 a[232:235], v1, s[44:47], s25 offen offset:2048 sc1
M v[220:223], a[176:179], v[76:79], v[220:223]
ds_write_b128 v2, a[88:91] offset:14336
buffer_load_dwordx4 a[236:239], v1, s[44:47], s25 offen offset:3072 sc1
M v[220:223], a[172:175], v[44:47], v[220:223]
s_add_u32 s25, s25, 16384
s_add_u32 s26, s26, 131072
ds_write_b128 v2, a[92:95] offset:15360
s_waitcnt lgkmcnt(0)
Lk2_merge:
s_lshl_b32 s33, s22, 10
s_add_u32 s33, s33, 28672
s_xor_b32 s34, s33, 2048
v_add_u32 v14, s33, v1
v_add_u32 v15, s34, v1
v_accvgpr_read_b32 v20, a96
v_accvgpr_read_b32 v21, a100
v_accvgpr_read_b32 v22, a104
v_accvgpr_read_b32 v23, a108
ds_write_b128 v14, v[20:23]
s_waitcnt lgkmcnt(0)
s_barrier
ds_read_b128 v[28:31], v15
ds_read_b128 v[32:35], v3 offset:0
ds_read_b128 v[36:39], v3 offset:1024
ds_read_b128 v[40:43], v3 offset:2048
ds_read_b128 v[44:47], v3 offset:3072
ds_read_b128 v[48:51], v3 offset:4096
ds_read_b128 v[52:55], v3 offset:5120
ds_read_b128 v[56:59], v3 offset:6144
ds_read_b128 v[60:63], v3 offset:7168
ds_read_b128 v[64:67], v3 offset:8192
ds_read_b128 v[68:71], v3 offset:9216
ds_read_b128 v[72:75], v3 offset:10240
ds_read_b128 v[76:79], v3 offset:11264
ds_read_b128 v[80:83], v3 offset:12288
ds_read_b128 v[84:87], v3 offset:13312
ds_read_b128 v[88:91], v3 offset:14336
ds_read_b128 v[92:95], v3 offset:15360
s_waitcnt lgkmcnt(15)
v_add_f32 v20, v20, v28
v_add_f32 v21, v21, v29
v_add_f32 v22, v22, v30
v_add_f32 v23, v23, v31
s_sub_u32 s35, 15, s21
v_rcp_f32 v8, v20
v_rcp_f32 v9, v21
v_rcp_f32 v10, v22
v_rcp_f32 v11, v23
v_subrev_u32 v20, 0x21800000, v20
v_subrev_u32 v21, 0x21800000, v21
v_subrev_u32 v22, 0x21800000, v22
v_subrev_u32 v23, 0x21800000, v23
v_max_u32 v12, v20, v21
v_max3_u32 v12, v12, v22, v23
s_mov_b32 s64, 0x207
s_lshl_b32 s33, s35, 20
s_lshl_b32 s34, s20, 15
s_add_u32 s33, s33, s34
s_lshl_b32 s34, s23, 13
s_add_u32 s36, s33, s34
s_add_u32 s37, s36, 4096
s_add_u32 s38, s36, 16384
s_add_u32 s39, s36, 20480
v_pk_add_f32 v[160:161], v[160:161], v[32:33]
v_pk_add_f32 v[162:163], v[162:163], v[34:35]
s_waitcnt lgkmcnt(11)
v_pk_add_f32 v[176:177], v[176:177], v[48:49]
v_pk_add_f32 v[178:179], v[178:179], v[50:51]
v_pk_mul_f32 v[160:161], v[160:161], v[8:9] op_sel:[0,0] op_sel_hi:[1,0]
v_pk_mul_f32 v[162:163], v[162:163], v[8:9] op_sel:[0,0] op_sel_hi:[1,0]
v_pk_mul_f32 v[176:177], v[176:177], v[8:9] op_sel:[0,0] op_sel_hi:[1,0]
v_pk_mul_f32 v[178:179], v[178:179], v[8:9] op_sel:[0,0] op_sel_hi:[1,0]
v_cvt_pk_bf16_f32 v160, v160, v161
v_cvt_pk_bf16_f32 v161, v162, v163
v_cvt_pk_bf16_f32 v162, v176, v177
v_cvt_pk_bf16_f32 v163, v178, v179
v_pk_add_f32 v[164:165], v[164:165], v[36:37]
v_pk_add_f32 v[166:167], v[166:167], v[38:39]
s_waitcnt lgkmcnt(10)
v_pk_add_f32 v[180:181], v[180:181], v[52:53]
v_pk_add_f32 v[182:183], v[182:183], v[54:55]
M v[24:27], a[112:115], v[160:163], 0
buffer_store_dwordx4 v[160:163], v1, s[16:19], s36 offen offset:0 sc1
v_pk_mul_f32 v[164:165], v[164:165], v[8:9] op_sel:[0,1] op_sel_hi:[1,1]
v_pk_mul_f32 v[166:167], v[166:167], v[8:9] op_sel:[0,1] op_sel_hi:[1,1]
v_pk_mul_f32 v[180:181], v[180:181], v[8:9] op_sel:[0,1] op_sel_hi:[1,1]
v_pk_mul_f32 v[182:183], v[182:183], v[8:9] op_sel:[0,1] op_sel_hi:[1,1]
v_cvt_pk_bf16_f32 v164, v164, v165
v_cvt_pk_bf16_f32 v165, v166, v167
v_cvt_pk_bf16_f32 v166, v180, v181
v_cvt_pk_bf16_f32 v167, v182, v183
v_pk_add_f32 v[168:169], v[168:169], v[40:41]
v_pk_add_f32 v[170:171], v[170:171], v[42:43]
s_waitcnt lgkmcnt(9)
v_pk_add_f32 v[184:185], v[184:185], v[56:57]
v_pk_add_f32 v[186:187], v[186:187], v[58:59]
M v[24:27], a[112:115], v[164:167], v[24:27]
buffer_store_dwordx4 v[164:167], v1, s[16:19], s36 offen offset:2048 sc1
v_pk_mul_f32 v[168:169], v[168:169], v[10:11] op_sel:[0,0] op_sel_hi:[1,0]
v_pk_mul_f32 v[170:171], v[170:171], v[10:11] op_sel:[0,0] op_sel_hi:[1,0]
v_pk_mul_f32 v[184:185], v[184:185], v[10:11] op_sel:[0,0] op_sel_hi:[1,0]
v_pk_mul_f32 v[186:187], v[186:187], v[10:11] op_sel:[0,0] op_sel_hi:[1,0]
v_cvt_pk_bf16_f32 v168, v168, v169
v_cvt_pk_bf16_f32 v169, v170, v171
v_cvt_pk_bf16_f32 v170, v184, v185
v_cvt_pk_bf16_f32 v171, v186, v187
v_pk_add_f32 v[172:173], v[172:173], v[44:45]
v_pk_add_f32 v[174:175], v[174:175], v[46:47]
s_waitcnt lgkmcnt(8)
v_pk_add_f32 v[188:189], v[188:189], v[60:61]
v_pk_add_f32 v[190:191], v[190:191], v[62:63]
M v[24:27], a[112:115], v[168:171], v[24:27]
buffer_store_dwordx4 v[168:171], v1, s[16:19], s37 offen offset:0 sc1
v_pk_mul_f32 v[172:173], v[172:173], v[10:11] op_sel:[0,1] op_sel_hi:[1,1]
v_pk_mul_f32 v[174:175], v[174:175], v[10:11] op_sel:[0,1] op_sel_hi:[1,1]
v_pk_mul_f32 v[188:189], v[188:189], v[10:11] op_sel:[0,1] op_sel_hi:[1,1]
v_pk_mul_f32 v[190:191], v[190:191], v[10:11] op_sel:[0,1] op_sel_hi:[1,1]
v_cvt_pk_bf16_f32 v172, v172, v173
v_cvt_pk_bf16_f32 v173, v174, v175
v_cvt_pk_bf16_f32 v174, v188, v189
v_cvt_pk_bf16_f32 v175, v190, v191
s_waitcnt lgkmcnt(7)
v_pk_add_f32 v[192:193], v[192:193], v[64:65]
v_pk_add_f32 v[194:195], v[194:195], v[66:67]
s_waitcnt lgkmcnt(3)
v_pk_add_f32 v[208:209], v[208:209], v[80:81]
v_pk_add_f32 v[210:211], v[210:211], v[82:83]
M v[24:27], a[112:115], v[172:175], v[24:27]
buffer_store_dwordx4 v[172:175], v1, s[16:19], s37 offen offset:2048 sc1
v_pk_mul_f32 v[192:193], v[192:193], v[8:9] op_sel:[0,0] op_sel_hi:[1,0]
v_pk_mul_f32 v[194:195], v[194:195], v[8:9] op_sel:[0,0] op_sel_hi:[1,0]
v_pk_mul_f32 v[208:209], v[208:209], v[8:9] op_sel:[0,0] op_sel_hi:[1,0]
v_pk_mul_f32 v[210:211], v[210:211], v[8:9] op_sel:[0,0] op_sel_hi:[1,0]
v_cvt_pk_bf16_f32 v192, v192, v193
v_cvt_pk_bf16_f32 v193, v194, v195
v_cvt_pk_bf16_f32 v194, v208, v209
v_cvt_pk_bf16_f32 v195, v210, v211
v_pk_add_f32 v[196:197], v[196:197], v[68:69]
v_pk_add_f32 v[198:199], v[198:199], v[70:71]
s_waitcnt lgkmcnt(2)
v_pk_add_f32 v[212:213], v[212:213], v[84:85]
v_pk_add_f32 v[214:215], v[214:215], v[86:87]
M v[24:27], a[112:115], v[192:195], v[24:27]
buffer_store_dwordx4 v[192:195], v1, s[16:19], s36 offen offset:1024 sc1
v_pk_mul_f32 v[196:197], v[196:197], v[8:9] op_sel:[0,1] op_sel_hi:[1,1]
v_pk_mul_f32 v[198:199], v[198:199], v[8:9] op_sel:[0,1] op_sel_hi:[1,1]
v_pk_mul_f32 v[212:213], v[212:213], v[8:9] op_sel:[0,1] op_sel_hi:[1,1]
v_pk_mul_f32 v[214:215], v[214:215], v[8:9] op_sel:[0,1] op_sel_hi:[1,1]
v_cvt_pk_bf16_f32 v196, v196, v197
v_cvt_pk_bf16_f32 v197, v198, v199
v_cvt_pk_bf16_f32 v198, v212, v213
v_cvt_pk_bf16_f32 v199, v214, v215
v_pk_add_f32 v[200:201], v[200:201], v[72:73]
v_pk_add_f32 v[202:203], v[202:203], v[74:75]
s_waitcnt lgkmcnt(1)
v_pk_add_f32 v[216:217], v[216:217], v[88:89]
v_pk_add_f32 v[218:219], v[218:219], v[90:91]
M v[24:27], a[112:115], v[196:199], v[24:27]
buffer_store_dwordx4 v[196:199], v1, s[16:19], s36 offen offset:3072 sc1
v_pk_mul_f32 v[200:201], v[200:201], v[10:11] op_sel:[0,0] op_sel_hi:[1,0]
v_pk_mul_f32 v[202:203], v[202:203], v[10:11] op_sel:[0,0] op_sel_hi:[1,0]
v_pk_mul_f32 v[216:217], v[216:217], v[10:11] op_sel:[0,0] op_sel_hi:[1,0]
v_pk_mul_f32 v[218:219], v[218:219], v[10:11] op_sel:[0,0] op_sel_hi:[1,0]
v_cvt_pk_bf16_f32 v200, v200, v201
v_cvt_pk_bf16_f32 v201, v202, v203
v_cvt_pk_bf16_f32 v202, v216, v217
v_cvt_pk_bf16_f32 v203, v218, v219
v_pk_add_f32 v[204:205], v[204:205], v[76:77]
v_pk_add_f32 v[206:207], v[206:207], v[78:79]
s_waitcnt lgkmcnt(0)
v_pk_add_f32 v[220:221], v[220:221], v[92:93]
v_pk_add_f32 v[222:223], v[222:223], v[94:95]
M v[24:27], a[112:115], v[200:203], v[24:27]
buffer_store_dwordx4 v[200:203], v1, s[16:19], s37 offen offset:1024 sc1
v_pk_mul_f32 v[204:205], v[204:205], v[10:11] op_sel:[0,1] op_sel_hi:[1,1]
v_pk_mul_f32 v[206:207], v[206:207], v[10:11] op_sel:[0,1] op_sel_hi:[1,1]
v_pk_mul_f32 v[220:221], v[220:221], v[10:11] op_sel:[0,1] op_sel_hi:[1,1]
v_pk_mul_f32 v[222:223], v[222:223], v[10:11] op_sel:[0,1] op_sel_hi:[1,1]
v_cvt_pk_bf16_f32 v204, v204, v205
v_cvt_pk_bf16_f32 v205, v206, v207
v_cvt_pk_bf16_f32 v206, v220, v221
v_cvt_pk_bf16_f32 v207, v222, v223
s_nop 1
M v[24:27], a[112:115], v[204:207], v[24:27]
buffer_store_dwordx4 v[204:207], v1, s[16:19], s37 offen offset:3072 sc1
v_cmp_lt_u32 vcc, 0x3c000000, v12
s_nop 5
v_cmp_class_f32 s[40:41], v24, s64
s_nop 0
s_or_b64 vcc, vcc, s[40:41]
s_cmp_lg_u64 vcc, 0
s_cselect_b32 s33, 2, 0
s_or_b32 s60, s60, s33
s_branch Lk2_chk
Lk2_wm:
s_lshl_b32 s33, s2, 1
s_add_u32 s33, s33, s23
s_lshl_b32 s34, s33, 12
s_lshl_b32 s33, s33, 14
v_lshlrev_b32 v8, 3, v1
v_lshlrev_b32 v9, 2, v1
buffer_load_dword a244, v8, s[44:47], s33 offen
s_add_u32 s33, s33, 8192
buffer_load_dword a245, v8, s[44:47], s33 offen
buffer_load_dword a246, v9, s[48:51], s34 offen
s_branch Lk2_l3b
Lk2_g1:
s_mov_b32 s30, 7
s_bfe_u32 s65, s2, 0x20003
s_add_u32 s65, s65, 2
s_lshl_b32 s42, s21, 1
s_min_u32 s42, s42, 13
s_add_u32 s42, s42, 2
s_sub_u32 s33, s42, 1
s_cmp_le_u32 s33, 1
s_cselect_b32 s33, 0x4000, 0
v_add_u32 v3, s33, v3
s_sub_u32 s42, s42, 1
Lk2_l3:
s_cmp_eq_u32 s30, s65
s_cbranch_scc1 Lk2_wm
Lk2_l3b:
s_add_u32 m0, s29, 65536
s_waitcnt lgkmcnt(4)
M v[96:99], a[116:119], a[0:3], 0
v_exp_f32 v64, v64
M v[96:99], a[120:123], a[4:7], v[96:99]
ds_read_b128 a[148:151], v2 offset:8192
ds_read_b128 a[152:155], v2 offset:9216
M v[96:99], a[124:127], a[8:11], v[96:99]
v_exp_f32 v65, v65
M v[96:99], a[128:131], a[12:15], v[96:99]
buffer_load_dwordx4 v1, s[12:15], s25 offen offset:0 sc1 lds
s_add_u32 s32, s25, 4096
M v[100:103], a[128:131], a[28:31], 0
v_exp_f32 v66, v66
M v[100:103], a[124:127], a[24:27], v[100:103]
v_cvt_pk_bf16_f32 v64, v64, v65
M v[100:103], a[120:123], a[20:23], v[100:103]
v_exp_f32 v67, v67
M v[100:103], a[116:119], a[16:19], v[100:103]
buffer_load_dwordx4 v1, s[12:15], s25 offen offset:1024 sc1 lds
M v[104:107], a[116:119], a[32:35], 0
v_exp_f32 v80, v80
M v[104:107], a[120:123], a[36:39], v[104:107]
ds_read_b128 a[156:159], v2 offset:10240
ds_read_b128 a[160:163], v2 offset:11264
M v[104:107], a[124:127], a[40:43], v[104:107]
v_exp_f32 v81, v81
M v[104:107], a[128:131], a[44:47], v[104:107]
buffer_load_dwordx4 v1, s[12:15], s25 offen offset:2048 sc1 lds
M v[108:111], a[128:131], a[60:63], 0
v_exp_f32 v82, v82
M v[108:111], a[124:127], a[56:59], v[108:111]
v_cvt_pk_bf16_f32 v65, v66, v67
v_cvt_pk_bf16_f32 v66, v80, v81
M v[108:111], a[120:123], a[52:55], v[108:111]
v_exp_f32 v83, v83
M v[108:111], a[116:119], a[48:51], v[108:111]
buffer_load_dwordx4 v1, s[12:15], s25 offen offset:3072 sc1 lds
s_add_u32 m0, s29, 69632
s_waitcnt lgkmcnt(4)
M v[112:115], a[132:135], a[0:3], 0
v_exp_f32 v68, v68
M v[112:115], a[136:139], a[4:7], v[112:115]
ds_read_b128 a[164:167], v2 offset:12288
ds_read_b128 a[168:171], v2 offset:13312
M v[112:115], a[140:143], a[8:11], v[112:115]
v_exp_f32 v69, v69
M v[112:115], a[144:147], a[12:15], v[112:115]
buffer_load_dwordx4 v1, s[12:15], s32 offen offset:0 sc1 lds
M v[116:119], a[144:147], a[28:31], 0
v_exp_f32 v70, v70
M v[116:119], a[140:143], a[24:27], v[116:119]
v_cvt_pk_bf16_f32 v67, v82, v83
v_cvt_pk_bf16_f32 v68, v68, v69
M v[116:119], a[136:139], a[20:23], v[116:119]
v_exp_f32 v71, v71
M v[116:119], a[132:135], a[16:19], v[116:119]
buffer_load_dwordx4 v1, s[12:15], s32 offen offset:1024 sc1 lds
M v[120:123], a[132:135], a[32:35], 0
v_exp_f32 v84, v84
M v[120:123], a[136:139], a[36:39], v[120:123]
ds_read_b128 a[172:175], v2 offset:14336
ds_read_b128 a[176:179], v2 offset:15360
M v[120:123], a[140:143], a[40:43], v[120:123]
v_exp_f32 v85, v85
M v[120:123], a[144:147], a[44:47], v[120:123]
buffer_load_dwordx4 v1, s[12:15], s32 offen offset:2048 sc1 lds
M v[124:127], a[144:147], a[60:63], 0
v_exp_f32 v86, v86
M v[124:127], a[140:143], a[56:59], v[124:127]
v_cvt_pk_bf16_f32 v69, v70, v71
v_cvt_pk_bf16_f32 v70, v84, v85
M v[124:127], a[136:139], a[52:55], v[124:127]
v_exp_f32 v87, v87
M v[124:127], a[132:135], a[48:51], v[124:127]
buffer_load_dwordx4 v1, s[12:15], s32 offen offset:3072 sc1 lds
s_add_u32 m0, s29, 98304
s_waitcnt lgkmcnt(4)
M v[128:131], a[148:151], a[0:3], 0
v_exp_f32 v72, v72
M v[128:131], a[152:155], a[4:7], v[128:131]
ds_read_b128 a[116:119], v5 offset:32768
ds_read_b128 a[120:123], v5 offset:40960
M v[128:131], a[156:159], a[8:11], v[128:131]
v_exp_f32 v73, v73
M v[128:131], a[160:163], a[12:15], v[128:131]
buffer_load_dwordx4 v1, s[12:15], s26 offen offset:0 sc1 lds
s_add_u32 s43, s26, 4096
M v[132:135], a[160:163], a[28:31], 0
v_exp_f32 v74, v74
M v[132:135], a[156:159], a[24:27], v[132:135]
v_cvt_pk_bf16_f32 v71, v86, v87
v_cvt_pk_bf16_f32 v72, v72, v73
M v[132:135], a[152:155], a[20:23], v[132:135]
v_exp_f32 v75, v75
M v[132:135], a[148:151], a[16:19], v[132:135]
buffer_load_dwordx4 v1, s[12:15], s26 offen offset:1024 sc1 lds
M v[136:139], a[148:151], a[32:35], 0
v_exp_f32 v88, v88
M v[136:139], a[152:155], a[36:39], v[136:139]
ds_read_b128 a[124:127], v5 offset:33792
ds_read_b128 a[128:131], v5 offset:41984
M v[136:139], a[156:159], a[40:43], v[136:139]
v_exp_f32 v89, v89
M v[136:139], a[160:163], a[44:47], v[136:139]
buffer_load_dwordx4 v1, s[12:15], s26 offen offset:2048 sc1 lds
M v[140:143], a[160:163], a[60:63], 0
v_exp_f32 v90, v90
M v[140:143], a[156:159], a[56:59], v[140:143]
v_cvt_pk_bf16_f32 v73, v74, v75
v_cvt_pk_bf16_f32 v74, v88, v89
M v[140:143], a[152:155], a[52:55], v[140:143]
v_exp_f32 v91, v91
M v[140:143], a[148:151], a[48:51], v[140:143]
buffer_load_dwordx4 v1, s[12:15], s26 offen offset:3072 sc1 lds
s_add_u32 m0, s29, 102400
s_waitcnt lgkmcnt(4)
M v[144:147], a[164:167], a[0:3], 0
v_exp_f32 v76, v76
M v[144:147], a[168:171], a[4:7], v[144:147]
ds_read_b128 a[132:135], v5 offset:34816
ds_read_b128 a[136:139], v5 offset:43008
M v[144:147], a[172:175], a[8:11], v[144:147]
v_exp_f32 v77, v77
M v[144:147], a[176:179], a[12:15], v[144:147]
buffer_load_dwordx4 v1, s[12:15], s43 offen offset:0 sc1 lds
M v[148:151], a[176:179], a[28:31], 0
v_exp_f32 v78, v78
M v[148:151], a[172:175], a[24:27], v[148:151]
v_cvt_pk_bf16_f32 v75, v90, v91
v_cvt_pk_bf16_f32 v76, v76, v77
M v[148:151], a[168:171], a[20:23], v[148:151]
v_exp_f32 v79, v79
M v[148:151], a[164:167], a[16:19], v[148:151]
buffer_load_dwordx4 v1, s[12:15], s43 offen offset:1024 sc1 lds
M v[152:155], a[164:167], a[32:35], 0
v_exp_f32 v92, v92
M v[152:155], a[168:171], a[36:39], v[152:155]
ds_read_b128 a[140:143], v5 offset:35840
ds_read_b128 a[144:147], v5 offset:44032
M v[152:155], a[172:175], a[40:43], v[152:155]
v_exp_f32 v93, v93
M v[152:155], a[176:179], a[44:47], v[152:155]
buffer_load_dwordx4 v1, s[12:15], s43 offen offset:2048 sc1 lds
M v[156:159], a[176:179], a[60:63], 0
v_exp_f32 v94, v94
M v[156:159], a[172:175], a[56:59], v[156:159]
v_cvt_pk_bf16_f32 v77, v78, v79
v_cvt_pk_bf16_f32 v78, v92, v93
M v[156:159], a[168:171], a[52:55], v[156:159]
v_exp_f32 v95, v95
M v[156:159], a[164:167], a[48:51], v[156:159]
buffer_load_dwordx4 v1, s[12:15], s43 offen offset:3072 sc1 lds
v_cvt_pk_bf16_f32 v79, v94, v95
s_waitcnt lgkmcnt(6)
M v[160:163], a[116:119], v[32:35], v[160:163]
v_exp_f32 v96, v96
M v[160:163], a[120:123], v[64:67], v[160:163]
ds_read_b128 a[148:151], v5 offset:36864
ds_read_b128 a[152:155], v5 offset:45056
M v[164:167], a[120:123], v[68:71], v[164:167]
v_exp_f32 v97, v97
M v[164:167], a[116:119], v[36:39], v[164:167]
v_cvt_pk_bf16_f32 v96, v96, v97
M v[168:171], a[116:119], v[40:43], v[168:171]
v_exp_f32 v98, v98
M v[168:171], a[120:123], v[72:75], v[168:171]
s_add_u32 s25, s25, 32768
s_cmp_eq_u32 s25, s27
M v[172:175], a[120:123], v[76:79], v[172:175]
v_exp_f32 v99, v99
M v[172:175], a[116:119], v[44:47], v[172:175]
v_cvt_pk_bf16_f32 v97, v98, v99
s_waitcnt lgkmcnt(6)
M a[96:99], a[112:115], v[32:35], a[96:99]
s_cselect_b32 s25, s28, s25
s_cselect_b32 s27, s56, s27
M a[96:99], a[112:115], v[64:67], a[96:99]
s_cselect_b32 s28, s57, s28
s_cselect_b32 s56, -1, s56
M v[176:179], a[124:127], v[32:35], v[176:179]
v_exp_f32 v112, v112
M v[176:179], a[128:131], v[64:67], v[176:179]
ds_read_b128 a[156:159], v5 offset:37888
ds_read_b128 a[160:163], v5 offset:46080
M v[180:183], a[128:131], v[68:71], v[180:183]
v_exp_f32 v113, v113
M v[180:183], a[124:127], v[36:39], v[180:183]
v_cvt_pk_bf16_f32 v98, v112, v113
M v[184:187], a[124:127], v[40:43], v[184:187]
v_exp_f32 v114, v114
M v[184:187], a[128:131], v[72:75], v[184:187]
s_add_u32 s26, s26, 32768
s_cmp_eq_u32 s26, s62
M v[188:191], a[128:131], v[76:79], v[188:191]
v_exp_f32 v115, v115
M v[188:191], a[124:127], v[44:47], v[188:191]
v_cvt_pk_bf16_f32 v99, v114, v115
s_waitcnt lgkmcnt(6)
M a[100:103], a[112:115], v[36:39], a[100:103]
s_cselect_b32 s26, s63, s26
s_cselect_b32 s62, s58, s62
M a[100:103], a[112:115], v[68:71], a[100:103]
s_cselect_b32 s63, s59, s63
s_cselect_b32 s58, -1, s58
M v[192:195], a[132:135], v[32:35], v[192:195]
v_exp_f32 v100, v100
M v[192:195], a[136:139], v[64:67], v[192:195]
ds_read_b128 a[164:167], v5 offset:38912
ds_read_b128 a[168:171], v5 offset:47104
M v[196:199], a[136:139], v[68:71], v[196:199]
v_exp_f32 v101, v101
M v[196:199], a[132:135], v[36:39], v[196:199]
v_cvt_pk_bf16_f32 v100, v100, v101
M v[200:203], a[132:135], v[40:43], v[200:203]
v_exp_f32 v102, v102
M v[200:203], a[136:139], v[72:75], v[200:203]
s_sub_u32 s33, s42, 1
s_cmp_le_u32 s33, 1
s_cselect_b32 s33, 0x4000, 0
v_add_u32 v2, s33, v2
M v[204:207], a[136:139], v[76:79], v[204:207]
v_exp_f32 v103, v103
M v[204:207], a[132:135], v[44:47], v[204:207]
v_cvt_pk_bf16_f32 v101, v102, v103
s_waitcnt lgkmcnt(6)
M a[104:107], a[112:115], v[40:43], a[104:107]
M a[104:107], a[112:115], v[72:75], a[104:107]
M v[208:211], a[140:143], v[32:35], v[208:211]
v_exp_f32 v116, v116
M v[208:211], a[144:147], v[64:67], v[208:211]
ds_read_b128 a[172:175], v5 offset:39936
ds_read_b128 a[176:179], v5 offset:48128
M v[212:215], a[144:147], v[68:71], v[212:215]
v_exp_f32 v117, v117
M v[212:215], a[140:143], v[36:39], v[212:215]
v_cvt_pk_bf16_f32 v102, v116, v117
M v[216:219], a[140:143], v[40:43], v[216:219]
v_exp_f32 v118, v118
M v[216:219], a[144:147], v[72:75], v[216:219]
M v[220:223], a[144:147], v[76:79], v[220:223]
v_exp_f32 v119, v119
M v[220:223], a[140:143], v[44:47], v[220:223]
v_cvt_pk_bf16_f32 v103, v118, v119
s_waitcnt lgkmcnt(6)
M a[108:111], a[112:115], v[44:47], a[108:111]
M a[108:111], a[112:115], v[76:79], a[108:111]
M v[224:227], a[148:151], v[32:35], v[224:227]
v_exp_f32 v104, v104
M v[224:227], a[152:155], v[64:67], v[224:227]
s_cmp_le_u32 s42, 1
s_cselect_b32 s33, 0x4000, 0
v_add_u32 v5, s33, v5
s_sub_u32 s42, s42, 1
M v[228:231], a[152:155], v[68:71], v[228:231]
v_exp_f32 v105, v105
M v[228:231], a[148:151], v[36:39], v[228:231]
v_cvt_pk_bf16_f32 v104, v104, v105
M v[232:235], a[148:151], v[40:43], v[232:235]
v_exp_f32 v106, v106
M v[232:235], a[152:155], v[72:75], v[232:235]
M v[236:239], a[152:155], v[76:79], v[236:239]
v_exp_f32 v107, v107
M v[236:239], a[148:151], v[44:47], v[236:239]
v_cvt_pk_bf16_f32 v105, v106, v107
s_waitcnt lgkmcnt(4)
M v[240:243], a[156:159], v[32:35], v[240:243]
v_exp_f32 v120, v120
M v[240:243], a[160:163], v[64:67], v[240:243]
M v[244:247], a[160:163], v[68:71], v[244:247]
v_exp_f32 v121, v121
M v[244:247], a[156:159], v[36:39], v[244:247]
v_cvt_pk_bf16_f32 v106, v120, v121
M v[248:251], a[156:159], v[40:43], v[248:251]
v_exp_f32 v122, v122
M v[248:251], a[160:163], v[72:75], v[248:251]
s_waitcnt vmcnt(0) lgkmcnt(0)
s_barrier
ds_read_b128 a[116:119], v3 offset:0
ds_read_b128 a[120:123], v3 offset:1024
M v[252:255], a[160:163], v[76:79], v[252:255]
v_exp_f32 v123, v123
M v[252:255], a[156:159], v[44:47], v[252:255]
v_cvt_pk_bf16_f32 v107, v122, v123
M a[64:67], a[164:167], v[32:35], a[64:67]
v_exp_f32 v108, v108
M a[64:67], a[168:171], v[64:67], a[64:67]
ds_read_b128 a[124:127], v3 offset:2048
ds_read_b128 a[128:131], v3 offset:3072
M a[68:71], a[168:171], v[68:71], a[68:71]
v_exp_f32 v109, v109
M a[68:71], a[164:167], v[36:39], a[68:71]
v_cvt_pk_bf16_f32 v108, v108, v109
M a[72:75], a[164:167], v[40:43], a[72:75]
v_exp_f32 v110, v110
M a[72:75], a[168:171], v[72:75], a[72:75]
ds_read_b128 a[132:135], v3 offset:4096
ds_read_b128 a[136:139], v3 offset:5120
M a[76:79], a[168:171], v[76:79], a[76:79]
v_exp_f32 v111, v111
M a[76:79], a[164:167], v[44:47], a[76:79]
v_cvt_pk_bf16_f32 v109, v110, v111
M a[80:83], a[172:175], v[32:35], a[80:83]
v_exp_f32 v124, v124
M a[80:83], a[176:179], v[64:67], a[80:83]
ds_read_b128 a[140:143], v3 offset:6144
ds_read_b128 a[144:147], v3 offset:7168
M a[84:87], a[176:179], v[68:71], a[84:87]
v_exp_f32 v125, v125
M a[84:87], a[172:175], v[36:39], a[84:87]
v_cvt_pk_bf16_f32 v110, v124, v125
M a[88:91], a[172:175], v[40:43], a[88:91]
v_exp_f32 v126, v126
M a[88:91], a[176:179], v[72:75], a[88:91]
M a[92:95], a[176:179], v[76:79], a[92:95]
v_exp_f32 v127, v127
M a[92:95], a[172:175], v[44:47], a[92:95]
v_cvt_pk_bf16_f32 v111, v126, v127
s_add_u32 m0, s29, 0
s_waitcnt lgkmcnt(4)
M v[32:35], a[116:119], a[0:3], 0
v_exp_f32 v128, v128
M v[32:35], a[120:123], a[4:7], v[32:35]
ds_read_b128 a[148:151], v3 offset:8192
ds_read_b128 a[152:155], v3 offset:9216
M v[32:35], a[124:127], a[8:11], v[32:35]
v_exp_f32 v129, v129
M v[32:35], a[128:131], a[12:15], v[32:35]
buffer_load_dwordx4 v1, s[12:15], s25 offen offset:0 sc1 lds
s_add_u32 s32, s25, 4096
M v[36:39], a[128:131], a[28:31], 0
v_exp_f32 v130, v130
M v[36:39], a[124:127], a[24:27], v[36:39]
v_cvt_pk_bf16_f32 v128, v128, v129
M v[36:39], a[120:123], a[20:23], v[36:39]
v_exp_f32 v131, v131
M v[36:39], a[116:119], a[16:19], v[36:39]
buffer_load_dwordx4 v1, s[12:15], s25 offen offset:1024 sc1 lds
M v[40:43], a[116:119], a[32:35], 0
v_exp_f32 v144, v144
M v[40:43], a[120:123], a[36:39], v[40:43]
ds_read_b128 a[156:159], v3 offset:10240
ds_read_b128 a[160:163], v3 offset:11264
M v[40:43], a[124:127], a[40:43], v[40:43]
v_exp_f32 v145, v145
M v[40:43], a[128:131], a[44:47], v[40:43]
buffer_load_dwordx4 v1, s[12:15], s25 offen offset:2048 sc1 lds
M v[44:47], a[128:131], a[60:63], 0
v_exp_f32 v146, v146
M v[44:47], a[124:127], a[56:59], v[44:47]
v_cvt_pk_bf16_f32 v129, v130, v131
v_cvt_pk_bf16_f32 v130, v144, v145
M v[44:47], a[120:123], a[52:55], v[44:47]
v_exp_f32 v147, v147
M v[44:47], a[116:119], a[48:51], v[44:47]
buffer_load_dwordx4 v1, s[12:15], s25 offen offset:3072 sc1 lds
s_add_u32 m0, s29, 4096
s_waitcnt lgkmcnt(4)
M v[48:51], a[132:135], a[0:3], 0
v_exp_f32 v132, v132
M v[48:51], a[136:139], a[4:7], v[48:51]
ds_read_b128 a[164:167], v3 offset:12288
ds_read_b128 a[168:171], v3 offset:13312
M v[48:51], a[140:143], a[8:11], v[48:51]
v_exp_f32 v133, v133
M v[48:51], a[144:147], a[12:15], v[48:51]
buffer_load_dwordx4 v1, s[12:15], s32 offen offset:0 sc1 lds
M v[52:55], a[144:147], a[28:31], 0
v_exp_f32 v134, v134
M v[52:55], a[140:143], a[24:27], v[52:55]
v_cvt_pk_bf16_f32 v131, v146, v147
v_cvt_pk_bf16_f32 v132, v132, v133
M v[52:55], a[136:139], a[20:23], v[52:55]
v_exp_f32 v135, v135
M v[52:55], a[132:135], a[16:19], v[52:55]
buffer_load_dwordx4 v1, s[12:15], s32 offen offset:1024 sc1 lds
M v[56:59], a[132:135], a[32:35], 0
v_exp_f32 v148, v148
M v[56:59], a[136:139], a[36:39], v[56:59]
ds_read_b128 a[172:175], v3 offset:14336
ds_read_b128 a[176:179], v3 offset:15360
M v[56:59], a[140:143], a[40:43], v[56:59]
v_exp_f32 v149, v149
M v[56:59], a[144:147], a[44:47], v[56:59]
buffer_load_dwordx4 v1, s[12:15], s32 offen offset:2048 sc1 lds
M v[60:63], a[144:147], a[60:63], 0
v_exp_f32 v150, v150
M v[60:63], a[140:143], a[56:59], v[60:63]
v_cvt_pk_bf16_f32 v133, v134, v135
v_cvt_pk_bf16_f32 v134, v148, v149
M v[60:63], a[136:139], a[52:55], v[60:63]
v_exp_f32 v151, v151
M v[60:63], a[132:135], a[48:51], v[60:63]
buffer_load_dwordx4 v1, s[12:15], s32 offen offset:3072 sc1 lds
s_add_u32 m0, s29, 32768
s_waitcnt lgkmcnt(4)
M v[64:67], a[148:151], a[0:3], 0
v_exp_f32 v136, v136
M v[64:67], a[152:155], a[4:7], v[64:67]
ds_read_b128 a[116:119], v6 offset:32768
ds_read_b128 a[120:123], v6 offset:40960
M v[64:67], a[156:159], a[8:11], v[64:67]
v_exp_f32 v137, v137
M v[64:67], a[160:163], a[12:15], v[64:67]
buffer_load_dwordx4 v1, s[12:15], s26 offen offset:0 sc1 lds
s_add_u32 s43, s26, 4096
M v[68:71], a[160:163], a[28:31], 0
v_exp_f32 v138, v138
M v[68:71], a[156:159], a[24:27], v[68:71]
v_cvt_pk_bf16_f32 v135, v150, v151
v_cvt_pk_bf16_f32 v136, v136, v137
M v[68:71], a[152:155], a[20:23], v[68:71]
v_exp_f32 v139, v139
M v[68:71], a[148:151], a[16:19], v[68:71]
buffer_load_dwordx4 v1, s[12:15], s26 offen offset:1024 sc1 lds
M v[72:75], a[148:151], a[32:35], 0
v_exp_f32 v152, v152
M v[72:75], a[152:155], a[36:39], v[72:75]
ds_read_b128 a[124:127], v6 offset:33792
ds_read_b128 a[128:131], v6 offset:41984
M v[72:75], a[156:159], a[40:43], v[72:75]
v_exp_f32 v153, v153
M v[72:75], a[160:163], a[44:47], v[72:75]
buffer_load_dwordx4 v1, s[12:15], s26 offen offset:2048 sc1 lds
M v[76:79], a[160:163], a[60:63], 0
v_exp_f32 v154, v154
M v[76:79], a[156:159], a[56:59], v[76:79]
v_cvt_pk_bf16_f32 v137, v138, v139
v_cvt_pk_bf16_f32 v138, v152, v153
M v[76:79], a[152:155], a[52:55], v[76:79]
v_exp_f32 v155, v155
M v[76:79], a[148:151], a[48:51], v[76:79]
buffer_load_dwordx4 v1, s[12:15], s26 offen offset:3072 sc1 lds
s_add_u32 m0, s29, 36864
s_waitcnt lgkmcnt(4)
M v[80:83], a[164:167], a[0:3], 0
v_exp_f32 v140, v140
M v[80:83], a[168:171], a[4:7], v[80:83]
ds_read_b128 a[132:135], v6 offset:34816
ds_read_b128 a[136:139], v6 offset:43008
M v[80:83], a[172:175], a[8:11], v[80:83]
v_exp_f32 v141, v141
M v[80:83], a[176:179], a[12:15], v[80:83]
buffer_load_dwordx4 v1, s[12:15], s43 offen offset:0 sc1 lds
M v[84:87], a[176:179], a[28:31], 0
v_exp_f32 v142, v142
M v[84:87], a[172:175], a[24:27], v[84:87]
v_cvt_pk_bf16_f32 v139, v154, v155
v_cvt_pk_bf16_f32 v140, v140, v141
M v[84:87], a[168:171], a[20:23], v[84:87]
v_exp_f32 v143, v143
M v[84:87], a[164:167], a[16:19], v[84:87]
buffer_load_dwordx4 v1, s[12:15], s43 offen offset:1024 sc1 lds
M v[88:91], a[164:167], a[32:35], 0
v_exp_f32 v156, v156
M v[88:91], a[168:171], a[36:39], v[88:91]
ds_read_b128 a[140:143], v6 offset:35840
ds_read_b128 a[144:147], v6 offset:44032
M v[88:91], a[172:175], a[40:43], v[88:91]
v_exp_f32 v157, v157
M v[88:91], a[176:179], a[44:47], v[88:91]
buffer_load_dwordx4 v1, s[12:15], s43 offen offset:2048 sc1 lds
M v[92:95], a[176:179], a[60:63], 0
v_exp_f32 v158, v158
M v[92:95], a[172:175], a[56:59], v[92:95]
v_cvt_pk_bf16_f32 v141, v142, v143
v_cvt_pk_bf16_f32 v142, v156, v157
M v[92:95], a[168:171], a[52:55], v[92:95]
v_exp_f32 v159, v159
M v[92:95], a[164:167], a[48:51], v[92:95]
buffer_load_dwordx4 v1, s[12:15], s43 offen offset:3072 sc1 lds
v_cvt_pk_bf16_f32 v143, v158, v159
s_waitcnt lgkmcnt(6)
M v[160:163], a[116:119], v[96:99], v[160:163]
v_exp_f32 v32, v32
M v[160:163], a[120:123], v[128:131], v[160:163]
ds_read_b128 a[148:151], v6 offset:36864
ds_read_b128 a[152:155], v6 offset:45056
M v[164:167], a[120:123], v[132:135], v[164:167]
v_exp_f32 v33, v33
M v[164:167], a[116:119], v[100:103], v[164:167]
v_cvt_pk_bf16_f32 v32, v32, v33
M v[168:171], a[116:119], v[104:107], v[168:171]
v_exp_f32 v34, v34
M v[168:171], a[120:123], v[136:139], v[168:171]
s_add_u32 s25, s25, 32768
s_cmp_eq_u32 s25, s27
M v[172:175], a[120:123], v[140:143], v[172:175]
v_exp_f32 v35, v35
M v[172:175], a[116:119], v[108:111], v[172:175]
v_cvt_pk_bf16_f32 v33, v34, v35
s_waitcnt lgkmcnt(6)
M a[96:99], a[112:115], v[96:99], a[96:99]
s_cselect_b32 s25, s28, s25
s_cselect_b32 s27, s56, s27
M a[96:99], a[112:115], v[128:131], a[96:99]
s_cselect_b32 s28, s57, s28
s_cselect_b32 s56, -1, s56
M v[176:179], a[124:127], v[96:99], v[176:179]
v_exp_f32 v48, v48
M v[176:179], a[128:131], v[128:131], v[176:179]
ds_read_b128 a[156:159], v6 offset:37888
ds_read_b128 a[160:163], v6 offset:46080
M v[180:183], a[128:131], v[132:135], v[180:183]
v_exp_f32 v49, v49
M v[180:183], a[124:127], v[100:103], v[180:183]
v_cvt_pk_bf16_f32 v34, v48, v49
M v[184:187], a[124:127], v[104:107], v[184:187]
v_exp_f32 v50, v50
M v[184:187], a[128:131], v[136:139], v[184:187]
s_add_u32 s26, s26, 32768
s_cmp_eq_u32 s26, s62
M v[188:191], a[128:131], v[140:143], v[188:191]
v_exp_f32 v51, v51
M v[188:191], a[124:127], v[108:111], v[188:191]
v_cvt_pk_bf16_f32 v35, v50, v51
s_waitcnt lgkmcnt(6)
M a[100:103], a[112:115], v[100:103], a[100:103]
s_cselect_b32 s26, s63, s26
s_cselect_b32 s62, s58, s62
M a[100:103], a[112:115], v[132:135], a[100:103]
s_cselect_b32 s63, s59, s63
s_cselect_b32 s58, -1, s58
M v[192:195], a[132:135], v[96:99], v[192:195]
v_exp_f32 v36, v36
M v[192:195], a[136:139], v[128:131], v[192:195]
ds_read_b128 a[164:167], v6 offset:38912
ds_read_b128 a[168:171], v6 offset:47104
M v[196:199], a[136:139], v[132:135], v[196:199]
v_exp_f32 v37, v37
M v[196:199], a[132:135], v[100:103], v[196:199]
v_cvt_pk_bf16_f32 v36, v36, v37
M v[200:203], a[132:135], v[104:107], v[200:203]
v_exp_f32 v38, v38
M v[200:203], a[136:139], v[136:139], v[200:203]
s_sub_u32 s33, s42, 1
s_cmp_le_u32 s33, 1
s_cselect_b32 s33, 0x4000, 0
v_add_u32 v3, s33, v3
M v[204:207], a[136:139], v[140:143], v[204:207]
v_exp_f32 v39, v39
M v[204:207], a[132:135], v[108:111], v[204:207]
v_cvt_pk_bf16_f32 v37, v38, v39
s_waitcnt lgkmcnt(6)
M a[104:107], a[112:115], v[104:107], a[104:107]
M a[104:107], a[112:115], v[136:139], a[104:107]
M v[208:211], a[140:143], v[96:99], v[208:211]
v_exp_f32 v52, v52
M v[208:211], a[144:147], v[128:131], v[208:211]
ds_read_b128 a[172:175], v6 offset:39936
ds_read_b128 a[176:179], v6 offset:48128
M v[212:215], a[144:147], v[132:135], v[212:215]
v_exp_f32 v53, v53
M v[212:215], a[140:143], v[100:103], v[212:215]
v_cvt_pk_bf16_f32 v38, v52, v53
M v[216:219], a[140:143], v[104:107], v[216:219]
v_exp_f32 v54, v54
M v[216:219], a[144:147], v[136:139], v[216:219]
M v[220:223], a[144:147], v[140:143], v[220:223]
v_exp_f32 v55, v55
M v[220:223], a[140:143], v[108:111], v[220:223]
v_cvt_pk_bf16_f32 v39, v54, v55
s_waitcnt lgkmcnt(6)
M a[108:111], a[112:115], v[108:111], a[108:111]
M a[108:111], a[112:115], v[140:143], a[108:111]
M v[224:227], a[148:151], v[96:99], v[224:227]
v_exp_f32 v40, v40
M v[224:227], a[152:155], v[128:131], v[224:227]
s_cmp_le_u32 s42, 1
s_cselect_b32 s33, 0x4000, 0
v_add_u32 v6, s33, v6
s_sub_u32 s42, s42, 1
M v[228:231], a[152:155], v[132:135], v[228:231]
v_exp_f32 v41, v41
M v[228:231], a[148:151], v[100:103], v[228:231]
v_cvt_pk_bf16_f32 v40, v40, v41
M v[232:235], a[148:151], v[104:107], v[232:235]
v_exp_f32 v42, v42
M v[232:235], a[152:155], v[136:139], v[232:235]
M v[236:239], a[152:155], v[140:143], v[236:239]
v_exp_f32 v43, v43
M v[236:239], a[148:151], v[108:111], v[236:239]
v_cvt_pk_bf16_f32 v41, v42, v43
s_waitcnt lgkmcnt(4)
M v[240:243], a[156:159], v[96:99], v[240:243]
v_exp_f32 v56, v56
M v[240:243], a[160:163], v[128:131], v[240:243]
M v[244:247], a[160:163], v[132:135], v[244:247]
v_exp_f32 v57, v57
M v[244:247], a[156:159], v[100:103], v[244:247]
v_cvt_pk_bf16_f32 v42, v56, v57
M v[248:251], a[156:159], v[104:107], v[248:251]
v_exp_f32 v58, v58
M v[248:251], a[160:163], v[136:139], v[248:251]
s_waitcnt vmcnt(0) lgkmcnt(0)
s_barrier
ds_read_b128 a[116:119], v2 offset:0
ds_read_b128 a[120:123], v2 offset:1024
M v[252:255], a[160:163], v[140:143], v[252:255]
v_exp_f32 v59, v59
M v[252:255], a[156:159], v[108:111], v[252:255]
v_cvt_pk_bf16_f32 v43, v58, v59
M a[64:67], a[164:167], v[96:99], a[64:67]
v_exp_f32 v44, v44
M a[64:67], a[168:171], v[128:131], a[64:67]
ds_read_b128 a[124:127], v2 offset:2048
ds_read_b128 a[128:131], v2 offset:3072
M a[68:71], a[168:171], v[132:135], a[68:71]
v_exp_f32 v45, v45
M a[68:71], a[164:167], v[100:103], a[68:71]
v_cvt_pk_bf16_f32 v44, v44, v45
M a[72:75], a[164:167], v[104:107], a[72:75]
v_exp_f32 v46, v46
M a[72:75], a[168:171], v[136:139], a[72:75]
ds_read_b128 a[132:135], v2 offset:4096
ds_read_b128 a[136:139], v2 offset:5120
M a[76:79], a[168:171], v[140:143], a[76:79]
v_exp_f32 v47, v47
M a[76:79], a[164:167], v[108:111], a[76:79]
v_cvt_pk_bf16_f32 v45, v46, v47
M a[80:83], a[172:175], v[96:99], a[80:83]
v_exp_f32 v60, v60
M a[80:83], a[176:179], v[128:131], a[80:83]
ds_read_b128 a[140:143], v2 offset:6144
ds_read_b128 a[144:147], v2 offset:7168
M a[84:87], a[176:179], v[132:135], a[84:87]
v_exp_f32 v61, v61
M a[84:87], a[172:175], v[100:103], a[84:87]
v_cvt_pk_bf16_f32 v46, v60, v61
M a[88:91], a[172:175], v[104:107], a[88:91]
v_exp_f32 v62, v62
M a[88:91], a[176:179], v[136:139], a[88:91]
M a[92:95], a[176:179], v[140:143], a[92:95]
v_exp_f32 v63, v63
M a[92:95], a[172:175], v[108:111], a[92:95]
v_cvt_pk_bf16_f32 v47, v62, v63
s_sub_u32 s30, s30, 1
s_cmp_lg_u32 s30, 0
s_cbranch_scc1 Lk2_l3
s_cmp_eq_u32 s23, 1
s_cbranch_scc1 Lk2_g1b
s_add_u32 m0, s29, 65536
s_waitcnt lgkmcnt(4)
M v[96:99], a[116:119], a[0:3], v[16:19]
v_exp_f32 v64, v64
M v[96:99], a[120:123], a[4:7], v[96:99]
ds_read_b128 a[148:151], v2 offset:8192
ds_read_b128 a[152:155], v2 offset:9216
M v[96:99], a[124:127], a[8:11], v[96:99]
v_exp_f32 v65, v65
M v[96:99], a[128:131], a[12:15], v[96:99]
buffer_load_dwordx4 v1, s[12:15], s25 offen offset:0 sc1 lds
s_add_u32 s32, s25, 4096
M v[100:103], a[128:131], a[28:31], 0
v_exp_f32 v66, v66
M v[100:103], a[124:127], a[24:27], v[100:103]
v_cvt_pk_bf16_f32 v64, v64, v65
M v[100:103], a[120:123], a[20:23], v[100:103]
v_exp_f32 v67, v67
M v[100:103], a[116:119], a[16:19], v[100:103]
buffer_load_dwordx4 v1, s[12:15], s25 offen offset:1024 sc1 lds
M v[104:107], a[116:119], a[32:35], 0
v_exp_f32 v80, v80
M v[104:107], a[120:123], a[36:39], v[104:107]
ds_read_b128 a[156:159], v2 offset:10240
ds_read_b128 a[160:163], v2 offset:11264
M v[104:107], a[124:127], a[40:43], v[104:107]
v_exp_f32 v81, v81
M v[104:107], a[128:131], a[44:47], v[104:107]
buffer_load_dwordx4 v1, s[12:15], s25 offen offset:2048 sc1 lds
M v[108:111], a[128:131], a[60:63], 0
v_exp_f32 v82, v82
M v[108:111], a[124:127], a[56:59], v[108:111]
v_cvt_pk_bf16_f32 v65, v66, v67
v_cvt_pk_bf16_f32 v66, v80, v81
M v[108:111], a[120:123], a[52:55], v[108:111]
v_exp_f32 v83, v83
M v[108:111], a[116:119], a[48:51], v[108:111]
buffer_load_dwordx4 v1, s[12:15], s25 offen offset:3072 sc1 lds
s_add_u32 m0, s29, 69632
s_waitcnt lgkmcnt(4)
v_exp_f32 v68, v68
ds_read_b128 a[164:167], v2 offset:12288
ds_read_b128 a[168:171], v2 offset:13312
v_exp_f32 v69, v69
buffer_load_dwordx4 v1, s[12:15], s32 offen offset:0 sc1 lds
M v[116:119], a[144:147], a[28:31], v[16:19]
v_exp_f32 v70, v70
M v[116:119], a[140:143], a[24:27], v[116:119]
v_cvt_pk_bf16_f32 v67, v82, v83
v_cvt_pk_bf16_f32 v68, v68, v69
M v[116:119], a[136:139], a[20:23], v[116:119]
v_exp_f32 v71, v71
M v[116:119], a[132:135], a[16:19], v[116:119]
buffer_load_dwordx4 v1, s[12:15], s32 offen offset:1024 sc1 lds
M v[120:123], a[132:135], a[32:35], 0
v_exp_f32 v84, v84
M v[120:123], a[136:139], a[36:39], v[120:123]
ds_read_b128 a[172:175], v2 offset:14336
ds_read_b128 a[176:179], v2 offset:15360
M v[120:123], a[140:143], a[40:43], v[120:123]
v_exp_f32 v85, v85
M v[120:123], a[144:147], a[44:47], v[120:123]
buffer_load_dwordx4 v1, s[12:15], s32 offen offset:2048 sc1 lds
M v[124:127], a[144:147], a[60:63], 0
v_exp_f32 v86, v86
M v[124:127], a[140:143], a[56:59], v[124:127]
v_cvt_pk_bf16_f32 v69, v70, v71
v_cvt_pk_bf16_f32 v70, v84, v85
M v[124:127], a[136:139], a[52:55], v[124:127]
v_exp_f32 v87, v87
M v[124:127], a[132:135], a[48:51], v[124:127]
buffer_load_dwordx4 v1, s[12:15], s32 offen offset:3072 sc1 lds
s_add_u32 m0, s29, 98304
s_waitcnt lgkmcnt(4)
v_exp_f32 v72, v72
ds_read_b128 a[116:119], v5 offset:32768
ds_read_b128 a[120:123], v5 offset:40960
v_exp_f32 v73, v73
buffer_load_dwordx4 v1, s[12:15], s26 offen offset:0 sc1 lds
s_add_u32 s43, s26, 4096
v_exp_f32 v74, v74
v_cvt_pk_bf16_f32 v71, v86, v87
v_cvt_pk_bf16_f32 v72, v72, v73
v_exp_f32 v75, v75
buffer_load_dwordx4 v1, s[12:15], s26 offen offset:1024 sc1 lds
M v[136:139], a[148:151], a[32:35], v[16:19]
v_exp_f32 v88, v88
M v[136:139], a[152:155], a[36:39], v[136:139]
ds_read_b128 a[124:127], v5 offset:33792
ds_read_b128 a[128:131], v5 offset:41984
M v[136:139], a[156:159], a[40:43], v[136:139]
v_exp_f32 v89, v89
M v[136:139], a[160:163], a[44:47], v[136:139]
buffer_load_dwordx4 v1, s[12:15], s26 offen offset:2048 sc1 lds
M v[140:143], a[160:163], a[60:63], 0
v_exp_f32 v90, v90
M v[140:143], a[156:159], a[56:59], v[140:143]
v_cvt_pk_bf16_f32 v73, v74, v75
v_cvt_pk_bf16_f32 v74, v88, v89
M v[140:143], a[152:155], a[52:55], v[140:143]
v_exp_f32 v91, v91
M v[140:143], a[148:151], a[48:51], v[140:143]
buffer_load_dwordx4 v1, s[12:15], s26 offen offset:3072 sc1 lds
s_add_u32 m0, s29, 102400
s_waitcnt lgkmcnt(4)
v_exp_f32 v76, v76
ds_read_b128 a[132:135], v5 offset:34816
ds_read_b128 a[136:139], v5 offset:43008
v_exp_f32 v77, v77
buffer_load_dwordx4 v1, s[12:15], s43 offen offset:0 sc1 lds
v_exp_f32 v78, v78
v_cvt_pk_bf16_f32 v75, v90, v91
v_cvt_pk_bf16_f32 v76, v76, v77
v_exp_f32 v79, v79
buffer_load_dwordx4 v1, s[12:15], s43 offen offset:1024 sc1 lds
v_exp_f32 v92, v92
ds_read_b128 a[140:143], v5 offset:35840
ds_read_b128 a[144:147], v5 offset:44032
v_exp_f32 v93, v93
buffer_load_dwordx4 v1, s[12:15], s43 offen offset:2048 sc1 lds
M v[156:159], a[176:179], a[60:63], v[16:19]
v_exp_f32 v94, v94
M v[156:159], a[172:175], a[56:59], v[156:159]
v_cvt_pk_bf16_f32 v77, v78, v79
v_cvt_pk_bf16_f32 v78, v92, v93
M v[156:159], a[168:171], a[52:55], v[156:159]
v_exp_f32 v95, v95
M v[156:159], a[164:167], a[48:51], v[156:159]
buffer_load_dwordx4 v1, s[12:15], s43 offen offset:3072 sc1 lds
v_cvt_pk_bf16_f32 v79, v94, v95
s_waitcnt lgkmcnt(6)
M v[160:163], a[116:119], v[32:35], v[160:163]
v_exp_f32 v96, v96
M v[160:163], a[120:123], v[64:67], v[160:163]
ds_read_b128 a[148:151], v5 offset:36864
ds_read_b128 a[152:155], v5 offset:45056
M v[164:167], a[120:123], v[68:71], v[164:167]
v_exp_f32 v97, v97
M v[164:167], a[116:119], v[36:39], v[164:167]
v_cvt_pk_bf16_f32 v96, v96, v97
M v[168:171], a[116:119], v[40:43], v[168:171]
v_exp_f32 v98, v98
M v[168:171], a[120:123], v[72:75], v[168:171]
s_add_u32 s25, s25, 32768
s_cmp_eq_u32 s25, s27
M v[172:175], a[120:123], v[76:79], v[172:175]
v_exp_f32 v99, v99
M v[172:175], a[116:119], v[44:47], v[172:175]
v_cvt_pk_bf16_f32 v97, v98, v99
s_waitcnt lgkmcnt(6)
M a[96:99], a[112:115], v[32:35], a[96:99]
s_cselect_b32 s25, s28, s25
s_cselect_b32 s27, s56, s27
M a[96:99], a[112:115], v[64:67], a[96:99]
s_cselect_b32 s28, s57, s28
s_cselect_b32 s56, -1, s56
M v[176:179], a[124:127], v[32:35], v[176:179]
M v[176:179], a[128:131], v[64:67], v[176:179]
ds_read_b128 a[156:159], v5 offset:37888
ds_read_b128 a[160:163], v5 offset:46080
M v[180:183], a[128:131], v[68:71], v[180:183]
M v[180:183], a[124:127], v[36:39], v[180:183]
v_mov_b32 v98, 0
M v[184:187], a[124:127], v[40:43], v[184:187]
M v[184:187], a[128:131], v[72:75], v[184:187]
s_add_u32 s26, s26, 32768
s_cmp_eq_u32 s26, s62
M v[188:191], a[128:131], v[76:79], v[188:191]
M v[188:191], a[124:127], v[44:47], v[188:191]
v_mov_b32 v99, 0
s_waitcnt lgkmcnt(6)
M a[100:103], a[112:115], v[36:39], a[100:103]
s_cselect_b32 s26, s63, s26
s_cselect_b32 s62, s58, s62
M a[100:103], a[112:115], v[68:71], a[100:103]
s_cselect_b32 s63, s59, s63
s_cselect_b32 s58, -1, s58
M v[192:195], a[132:135], v[32:35], v[192:195]
v_exp_f32 v100, v100
M v[192:195], a[136:139], v[64:67], v[192:195]
ds_read_b128 a[164:167], v5 offset:38912
ds_read_b128 a[168:171], v5 offset:47104
M v[196:199], a[136:139], v[68:71], v[196:199]
v_exp_f32 v101, v101
M v[196:199], a[132:135], v[36:39], v[196:199]
v_cvt_pk_bf16_f32 v100, v100, v101
M v[200:203], a[132:135], v[40:43], v[200:203]
v_exp_f32 v102, v102
M v[200:203], a[136:139], v[72:75], v[200:203]
s_sub_u32 s33, s42, 1
s_cmp_le_u32 s33, 1
s_cselect_b32 s33, 0x4000, 0
v_add_u32 v2, s33, v2
M v[204:207], a[136:139], v[76:79], v[204:207]
v_exp_f32 v103, v103
M v[204:207], a[132:135], v[44:47], v[204:207]
v_cvt_pk_bf16_f32 v101, v102, v103
s_waitcnt lgkmcnt(6)
M a[104:107], a[112:115], v[40:43], a[104:107]
M a[104:107], a[112:115], v[72:75], a[104:107]
M v[208:211], a[140:143], v[32:35], v[208:211]
v_exp_f32 v116, v116
M v[208:211], a[144:147], v[64:67], v[208:211]
ds_read_b128 a[172:175], v5 offset:39936
ds_read_b128 a[176:179], v5 offset:48128
M v[212:215], a[144:147], v[68:71], v[212:215]
v_exp_f32 v117, v117
M v[212:215], a[140:143], v[36:39], v[212:215]
v_cvt_pk_bf16_f32 v102, v116, v117
M v[216:219], a[140:143], v[40:43], v[216:219]
v_exp_f32 v118, v118
M v[216:219], a[144:147], v[72:75], v[216:219]
M v[220:223], a[144:147], v[76:79], v[220:223]
v_exp_f32 v119, v119
M v[220:223], a[140:143], v[44:47], v[220:223]
v_cvt_pk_bf16_f32 v103, v118, v119
s_waitcnt lgkmcnt(6)
M a[108:111], a[112:115], v[44:47], a[108:111]
M a[108:111], a[112:115], v[76:79], a[108:111]
M v[224:227], a[148:151], v[32:35], v[224:227]
v_exp_f32 v104, v104
M v[224:227], a[152:155], v[64:67], v[224:227]
s_cmp_le_u32 s42, 1
s_cselect_b32 s33, 0x4000, 0
v_add_u32 v5, s33, v5
s_sub_u32 s42, s42, 1
M v[228:231], a[152:155], v[68:71], v[228:231]
v_exp_f32 v105, v105
M v[228:231], a[148:151], v[36:39], v[228:231]
v_cvt_pk_bf16_f32 v104, v104, v105
M v[232:235], a[148:151], v[40:43], v[232:235]
v_exp_f32 v106, v106
M v[232:235], a[152:155], v[72:75], v[232:235]
M v[236:239], a[152:155], v[76:79], v[236:239]
v_exp_f32 v107, v107
M v[236:239], a[148:151], v[44:47], v[236:239]
v_cvt_pk_bf16_f32 v105, v106, v107
s_waitcnt lgkmcnt(4)
M v[240:243], a[156:159], v[32:35], v[240:243]
v_exp_f32 v120, v120
M v[240:243], a[160:163], v[64:67], v[240:243]
M v[244:247], a[160:163], v[68:71], v[244:247]
v_exp_f32 v121, v121
M v[244:247], a[156:159], v[36:39], v[244:247]
v_cvt_pk_bf16_f32 v106, v120, v121
M v[248:251], a[156:159], v[40:43], v[248:251]
v_exp_f32 v122, v122
M v[248:251], a[160:163], v[72:75], v[248:251]
s_waitcnt vmcnt(0) lgkmcnt(0)
s_barrier
ds_read_b128 a[116:119], v3 offset:0
ds_read_b128 a[120:123], v3 offset:1024
M v[252:255], a[160:163], v[76:79], v[252:255]
v_exp_f32 v123, v123
M v[252:255], a[156:159], v[44:47], v[252:255]
v_cvt_pk_bf16_f32 v107, v122, v123
M a[64:67], a[164:167], v[32:35], a[64:67]
v_exp_f32 v108, v108
M a[64:67], a[168:171], v[64:67], a[64:67]
ds_read_b128 a[124:127], v3 offset:2048
ds_read_b128 a[128:131], v3 offset:3072
M a[68:71], a[168:171], v[68:71], a[68:71]
v_exp_f32 v109, v109
M a[68:71], a[164:167], v[36:39], a[68:71]
v_cvt_pk_bf16_f32 v108, v108, v109
M a[72:75], a[164:167], v[40:43], a[72:75]
v_exp_f32 v110, v110
M a[72:75], a[168:171], v[72:75], a[72:75]
ds_read_b128 a[132:135], v3 offset:4096
ds_read_b128 a[136:139], v3 offset:5120
M a[76:79], a[168:171], v[76:79], a[76:79]
v_exp_f32 v111, v111
M a[76:79], a[164:167], v[44:47], a[76:79]
v_cvt_pk_bf16_f32 v109, v110, v111
M a[80:83], a[172:175], v[32:35], a[80:83]
v_exp_f32 v124, v124
M a[80:83], a[176:179], v[64:67], a[80:83]
ds_read_b128 a[140:143], v3 offset:6144
ds_read_b128 a[144:147], v3 offset:7168
M a[84:87], a[176:179], v[68:71], a[84:87]
v_exp_f32 v125, v125
M a[84:87], a[172:175], v[36:39], a[84:87]
v_cvt_pk_bf16_f32 v110, v124, v125
M a[88:91], a[172:175], v[40:43], a[88:91]
v_exp_f32 v126, v126
M a[88:91], a[176:179], v[72:75], a[88:91]
M a[92:95], a[176:179], v[76:79], a[92:95]
v_exp_f32 v127, v127
M a[92:95], a[172:175], v[44:47], a[92:95]
v_cvt_pk_bf16_f32 v111, v126, v127
s_add_u32 m0, s29, 0
s_nop 0
buffer_load_dwordx4 v1, s[12:15], s25 offen offset:0 sc1 lds
s_add_u32 s32, s25, 4096
buffer_load_dwordx4 v1, s[12:15], s25 offen offset:1024 sc1 lds
buffer_load_dwordx4 v1, s[12:15], s25 offen offset:2048 sc1 lds
buffer_load_dwordx4 v1, s[12:15], s25 offen offset:3072 sc1 lds
s_add_u32 m0, s29, 4096
s_nop 0
buffer_load_dwordx4 v1, s[12:15], s32 offen offset:0 sc1 lds
buffer_load_dwordx4 v1, s[12:15], s32 offen offset:1024 sc1 lds
buffer_load_dwordx4 v1, s[12:15], s32 offen offset:2048 sc1 lds
buffer_load_dwordx4 v1, s[12:15], s32 offen offset:3072 sc1 lds
s_add_u32 m0, s29, 32768
v_exp_f32 v136, v136
s_waitcnt lgkmcnt(7)
ds_read_b128 a[116:119], v6 offset:32768
s_waitcnt lgkmcnt(7)
ds_read_b128 a[120:123], v6 offset:40960
v_exp_f32 v137, v137
buffer_load_dwordx4 v1, s[12:15], s26 offen offset:0 sc1 lds
s_add_u32 s43, s26, 4096
v_exp_f32 v138, v138
v_cvt_pk_bf16_f32 v136, v136, v137
v_exp_f32 v139, v139
buffer_load_dwordx4 v1, s[12:15], s26 offen offset:1024 sc1 lds
s_waitcnt lgkmcnt(7)
ds_read_b128 a[124:127], v6 offset:33792
s_waitcnt lgkmcnt(7)
ds_read_b128 a[128:131], v6 offset:41984
buffer_load_dwordx4 v1, s[12:15], s26 offen offset:2048 sc1 lds
v_cvt_pk_bf16_f32 v137, v138, v139
v_mov_b32 v138, 0
buffer_load_dwordx4 v1, s[12:15], s26 offen offset:3072 sc1 lds
s_add_u32 m0, s29, 36864
v_exp_f32 v140, v140
s_waitcnt lgkmcnt(7)
ds_read_b128 a[132:135], v6 offset:34816
s_waitcnt lgkmcnt(7)
ds_read_b128 a[136:139], v6 offset:43008
v_exp_f32 v141, v141
buffer_load_dwordx4 v1, s[12:15], s43 offen offset:0 sc1 lds
v_exp_f32 v142, v142
v_mov_b32 v139, 0
v_cvt_pk_bf16_f32 v140, v140, v141
v_exp_f32 v143, v143
buffer_load_dwordx4 v1, s[12:15], s43 offen offset:1024 sc1 lds
v_exp_f32 v156, v156
s_waitcnt lgkmcnt(7)
ds_read_b128 a[140:143], v6 offset:35840
s_waitcnt lgkmcnt(7)
ds_read_b128 a[144:147], v6 offset:44032
v_exp_f32 v157, v157
buffer_load_dwordx4 v1, s[12:15], s43 offen offset:2048 sc1 lds
v_exp_f32 v158, v158
v_cvt_pk_bf16_f32 v141, v142, v143
v_cvt_pk_bf16_f32 v142, v156, v157
v_exp_f32 v159, v159
buffer_load_dwordx4 v1, s[12:15], s43 offen offset:3072 sc1 lds
v_cvt_pk_bf16_f32 v143, v158, v159
s_waitcnt lgkmcnt(6)
M v[160:163], a[116:119], v[96:99], v[160:163]
ds_read_b128 a[148:151], v6 offset:36864
ds_read_b128 a[152:155], v6 offset:45056
M v[164:167], a[116:119], v[100:103], v[164:167]
M v[168:171], a[116:119], v[104:107], v[168:171]
M v[168:171], a[120:123], v[136:139], v[168:171]
s_add_u32 s25, s25, 32768
s_cmp_eq_u32 s25, s27
M v[172:175], a[120:123], v[140:143], v[172:175]
M v[172:175], a[116:119], v[108:111], v[172:175]
s_waitcnt lgkmcnt(6)
M a[96:99], a[112:115], v[96:99], a[96:99]
s_cselect_b32 s25, s28, s25
s_cselect_b32 s27, s56, s27
s_cselect_b32 s28, s57, s28
s_cselect_b32 s56, -1, s56
M v[176:179], a[124:127], v[96:99], v[176:179]
ds_read_b128 a[156:159], v6 offset:37888
ds_read_b128 a[160:163], v6 offset:46080
M v[180:183], a[124:127], v[100:103], v[180:183]
M v[184:187], a[124:127], v[104:107], v[184:187]
M v[184:187], a[128:131], v[136:139], v[184:187]
s_add_u32 s26, s26, 32768
s_cmp_eq_u32 s26, s62
M v[188:191], a[128:131], v[140:143], v[188:191]
M v[188:191], a[124:127], v[108:111], v[188:191]
s_waitcnt lgkmcnt(6)
M a[100:103], a[112:115], v[100:103], a[100:103]
s_cselect_b32 s26, s63, s26
s_cselect_b32 s62, s58, s62
s_cselect_b32 s63, s59, s63
s_cselect_b32 s58, -1, s58
M v[192:195], a[132:135], v[96:99], v[192:195]
ds_read_b128 a[164:167], v6 offset:38912
ds_read_b128 a[168:171], v6 offset:47104
M v[196:199], a[132:135], v[100:103], v[196:199]
M v[200:203], a[132:135], v[104:107], v[200:203]
M v[200:203], a[136:139], v[136:139], v[200:203]
s_sub_u32 s33, s42, 1
s_cmp_le_u32 s33, 1
s_cselect_b32 s33, 0x4000, 0
v_add_u32 v3, s33, v3
M v[204:207], a[136:139], v[140:143], v[204:207]
M v[204:207], a[132:135], v[108:111], v[204:207]
s_waitcnt lgkmcnt(6)
M a[104:107], a[112:115], v[104:107], a[104:107]
M a[104:107], a[112:115], v[136:139], a[104:107]
M v[208:211], a[140:143], v[96:99], v[208:211]
ds_read_b128 a[172:175], v6 offset:39936
ds_read_b128 a[176:179], v6 offset:48128
M v[212:215], a[140:143], v[100:103], v[212:215]
M v[216:219], a[140:143], v[104:107], v[216:219]
M v[216:219], a[144:147], v[136:139], v[216:219]
M v[220:223], a[144:147], v[140:143], v[220:223]
M v[220:223], a[140:143], v[108:111], v[220:223]
s_waitcnt lgkmcnt(6)
M a[108:111], a[112:115], v[108:111], a[108:111]
M a[108:111], a[112:115], v[140:143], a[108:111]
M v[224:227], a[148:151], v[96:99], v[224:227]
s_cmp_le_u32 s42, 1
s_cselect_b32 s33, 0x4000, 0
v_add_u32 v6, s33, v6
s_sub_u32 s42, s42, 1
M v[228:231], a[148:151], v[100:103], v[228:231]
M v[232:235], a[148:151], v[104:107], v[232:235]
M v[232:235], a[152:155], v[136:139], v[232:235]
M v[236:239], a[152:155], v[140:143], v[236:239]
M v[236:239], a[148:151], v[108:111], v[236:239]
s_waitcnt lgkmcnt(4)
M v[240:243], a[156:159], v[96:99], v[240:243]
M v[244:247], a[156:159], v[100:103], v[244:247]
M v[248:251], a[156:159], v[104:107], v[248:251]
M v[248:251], a[160:163], v[136:139], v[248:251]
s_waitcnt vmcnt(0) lgkmcnt(0)
s_barrier
ds_read_b128 a[116:119], v2 offset:0
ds_read_b128 a[120:123], v2 offset:1024
M v[252:255], a[160:163], v[140:143], v[252:255]
M v[252:255], a[156:159], v[108:111], v[252:255]
M a[64:67], a[164:167], v[96:99], a[64:67]
ds_read_b128 a[124:127], v2 offset:2048
ds_read_b128 a[128:131], v2 offset:3072
M a[68:71], a[164:167], v[100:103], a[68:71]
M a[72:75], a[164:167], v[104:107], a[72:75]
M a[72:75], a[168:171], v[136:139], a[72:75]
ds_read_b128 a[132:135], v2 offset:4096
ds_read_b128 a[136:139], v2 offset:5120
M a[76:79], a[168:171], v[140:143], a[76:79]
M a[76:79], a[164:167], v[108:111], a[76:79]
M a[80:83], a[172:175], v[96:99], a[80:83]
ds_read_b128 a[140:143], v2 offset:6144
ds_read_b128 a[144:147], v2 offset:7168
M a[84:87], a[172:175], v[100:103], a[84:87]
M a[88:91], a[172:175], v[104:107], a[88:91]
M a[88:91], a[176:179], v[136:139], a[88:91]
M a[92:95], a[176:179], v[140:143], a[92:95]
M a[92:95], a[172:175], v[108:111], a[92:95]
s_and_b32 s3, s2, 3
s_lshl_b32 s3, s3, 2
s_bfe_u32 s27, s2, 0x20003
s_add_u32 s27, s3, s27
s_lshl_b32 s43, s27, 8
s_add_u32 s43, s43, 16789504
v_lshlrev_b32 v15, 2, v0
buffer_load_dword v7, v15, s[52:55], s43 offen sc1
s_lshl_b32 s33, s23, 14
s_add_u32 s34, s33, 131072
s_add_u32 s33, s33, 98304
v_add_u32 v2, s34, v1
v_add_u32 v3, s33, v1
s_mov_b32 s61, 0
s_bfe_u32 s3, s2, 0x10002
s_lshl_b32 s3, s3, 3
s_lshr_b32 s28, s2, 5
s_add_u32 s28, s3, s28
s_lshl_b32 s25, s27, 18
s_lshl_b32 s3, s101, 12
s_add_u32 s25, s25, s3
s_lshl_b32 s26, s28, 7
s_lshl_b32 s42, s101, 11
s_add_u32 s44, s4, 83886080
s_addc_u32 s45, s5, 0
s_mov_b32 s46, 4194304
s_mov_b32 s47, 0x00020000
s_mov_b32 s50, 2097152
s_mov_b32 s51, 0x00020000
s_lshl_b32 s3, s101, 4
v_lshrrev_b32 v96, 3, v0
v_and_b32 v97, 6, v96
ds_write_b128 v2, v[160:163] offset:0
v_and_b32 v98, 7, v0
ds_write_b128 v2, v[164:167] offset:1024
v_xor_b32 v97, v97, v98
ds_write_b128 v2, v[168:171] offset:2048
v_add_u32 v96, s3, v96
ds_write_b128 v2, v[172:175] offset:3072
v_lshlrev_b32 v96, 11, v96
ds_write_b128 v2, v[176:179] offset:4096
v_lshl_add_u32 v99, v97, 4, v96
v_add_u32 v100, 15360, v99
ds_write_b128 v2, v[180:183] offset:5120
s_waitcnt vmcnt(0) lgkmcnt(0)
s_barrier
ds_write_b128 v2, v[184:187] offset:6144
v_cmp_ne_u32 vcc, 1, v7
s_nop 0
s_cbranch_vccnz Lk3_spinb3
Lk3_gotb3:
s_add_u32 m0, s42, 16384
s_nop 0
buffer_load_dwordx4 v99, s[48:51], s26 offen offset:0 lds
ds_write_b128 v2, v[188:191] offset:7168
buffer_load_dwordx4 v100, s[48:51], s26 offen offset:1024 lds
ds_write_b128 v2, v[192:195] offset:8192
buffer_load_dwordx4 a[192:195], v1, s[44:47], s25 offen offset:0 sc1
buffer_load_dwordx4 a[196:199], v1, s[44:47], s25 offen offset:1024 sc1
ds_write_b128 v2, v[196:199] offset:9216
buffer_load_dwordx4 a[200:203], v1, s[44:47], s25 offen offset:2048 sc1
buffer_load_dwordx4 a[204:207], v1, s[44:47], s25 offen offset:3072 sc1
ds_write_b128 v2, v[200:203] offset:10240
s_add_u32 s25, s25, 16384
s_add_u32 s26, s26, 131072
ds_write_b128 v2, v[204:207] offset:11264
s_add_u32 m0, s42, 32768
s_nop 0
buffer_load_dwordx4 v99, s[48:51], s26 offen offset:0 lds
buffer_load_dwordx4 v100, s[48:51], s26 offen offset:1024 lds
ds_write_b128 v2, v[208:211] offset:12288
buffer_load_dwordx4 a[224:227], v1, s[44:47], s25 offen offset:0 sc1
ds_write_b128 v2, v[212:215] offset:13312
buffer_load_dwordx4 a[228:231], v1, s[44:47], s25 offen offset:1024 sc1
buffer_load_dwordx4 a[232:235], v1, s[44:47], s25 offen offset:2048 sc1
ds_write_b128 v2, v[216:219] offset:14336
buffer_load_dwordx4 a[236:239], v1, s[44:47], s25 offen offset:3072 sc1
s_add_u32 s25, s25, 16384
s_add_u32 s26, s26, 131072
ds_write_b128 v2, v[220:223] offset:15360
s_waitcnt lgkmcnt(0)
s_branch Lk2_mg1
Lk2_g1b:
s_add_u32 m0, s29, 65536
s_waitcnt lgkmcnt(4)
M v[96:99], a[116:119], a[0:3], 0
v_exp_f32 v64, v64
M v[96:99], a[120:123], a[4:7], v[96:99]
ds_read_b128 a[148:151], v2 offset:8192
ds_read_b128 a[152:155], v2 offset:9216
M v[96:99], a[124:127], a[8:11], v[96:99]
v_exp_f32 v65, v65
M v[96:99], a[128:131], a[12:15], v[96:99]
buffer_load_dwordx4 v1, s[12:15], s25 offen offset:0 sc1 lds
s_add_u32 s32, s25, 4096
M v[100:103], a[128:131], a[28:31], 0
v_exp_f32 v66, v66
M v[100:103], a[124:127], a[24:27], v[100:103]
v_cvt_pk_bf16_f32 v64, v64, v65
M v[100:103], a[120:123], a[20:23], v[100:103]
v_exp_f32 v67, v67
M v[100:103], a[116:119], a[16:19], v[100:103]
buffer_load_dwordx4 v1, s[12:15], s25 offen offset:1024 sc1 lds
M v[104:107], a[116:119], a[32:35], 0
v_exp_f32 v80, v80
M v[104:107], a[120:123], a[36:39], v[104:107]
ds_read_b128 a[156:159], v2 offset:10240
ds_read_b128 a[160:163], v2 offset:11264
M v[104:107], a[124:127], a[40:43], v[104:107]
v_exp_f32 v81, v81
M v[104:107], a[128:131], a[44:47], v[104:107]
buffer_load_dwordx4 v1, s[12:15], s25 offen offset:2048 sc1 lds
M v[108:111], a[128:131], a[60:63], 0
v_exp_f32 v82, v82
M v[108:111], a[124:127], a[56:59], v[108:111]
v_cvt_pk_bf16_f32 v65, v66, v67
v_cvt_pk_bf16_f32 v66, v80, v81
M v[108:111], a[120:123], a[52:55], v[108:111]
v_exp_f32 v83, v83
M v[108:111], a[116:119], a[48:51], v[108:111]
buffer_load_dwordx4 v1, s[12:15], s25 offen offset:3072 sc1 lds
s_add_u32 m0, s29, 69632
s_waitcnt lgkmcnt(4)
M v[112:115], a[132:135], a[0:3], 0
v_exp_f32 v68, v68
M v[112:115], a[136:139], a[4:7], v[112:115]
ds_read_b128 a[164:167], v2 offset:12288
ds_read_b128 a[168:171], v2 offset:13312
M v[112:115], a[140:143], a[8:11], v[112:115]
v_exp_f32 v69, v69
M v[112:115], a[144:147], a[12:15], v[112:115]
buffer_load_dwordx4 v1, s[12:15], s32 offen offset:0 sc1 lds
M v[116:119], a[144:147], a[28:31], 0
v_exp_f32 v70, v70
M v[116:119], a[140:143], a[24:27], v[116:119]
v_cvt_pk_bf16_f32 v67, v82, v83
v_cvt_pk_bf16_f32 v68, v68, v69
M v[116:119], a[136:139], a[20:23], v[116:119]
v_exp_f32 v71, v71
M v[116:119], a[132:135], a[16:19], v[116:119]
buffer_load_dwordx4 v1, s[12:15], s32 offen offset:1024 sc1 lds
M v[120:123], a[132:135], a[32:35], 0
v_exp_f32 v84, v84
M v[120:123], a[136:139], a[36:39], v[120:123]
ds_read_b128 a[172:175], v2 offset:14336
ds_read_b128 a[176:179], v2 offset:15360
M v[120:123], a[140:143], a[40:43], v[120:123]
v_exp_f32 v85, v85
M v[120:123], a[144:147], a[44:47], v[120:123]
buffer_load_dwordx4 v1, s[12:15], s32 offen offset:2048 sc1 lds
M v[124:127], a[144:147], a[60:63], 0
v_exp_f32 v86, v86
M v[124:127], a[140:143], a[56:59], v[124:127]
v_cvt_pk_bf16_f32 v69, v70, v71
v_cvt_pk_bf16_f32 v70, v84, v85
M v[124:127], a[136:139], a[52:55], v[124:127]
v_exp_f32 v87, v87
M v[124:127], a[132:135], a[48:51], v[124:127]
buffer_load_dwordx4 v1, s[12:15], s32 offen offset:3072 sc1 lds
s_add_u32 m0, s29, 98304
s_waitcnt lgkmcnt(4)
M v[128:131], a[148:151], a[0:3], 0
v_exp_f32 v72, v72
M v[128:131], a[152:155], a[4:7], v[128:131]
ds_read_b128 a[116:119], v5 offset:32768
ds_read_b128 a[120:123], v5 offset:40960
M v[128:131], a[156:159], a[8:11], v[128:131]
v_exp_f32 v73, v73
M v[128:131], a[160:163], a[12:15], v[128:131]
buffer_load_dwordx4 v1, s[12:15], s26 offen offset:0 sc1 lds
s_add_u32 s43, s26, 4096
M v[132:135], a[160:163], a[28:31], 0
v_exp_f32 v74, v74
M v[132:135], a[156:159], a[24:27], v[132:135]
v_cvt_pk_bf16_f32 v71, v86, v87
v_cvt_pk_bf16_f32 v72, v72, v73
M v[132:135], a[152:155], a[20:23], v[132:135]
v_exp_f32 v75, v75
M v[132:135], a[148:151], a[16:19], v[132:135]
buffer_load_dwordx4 v1, s[12:15], s26 offen offset:1024 sc1 lds
M v[136:139], a[148:151], a[32:35], 0
v_exp_f32 v88, v88
M v[136:139], a[152:155], a[36:39], v[136:139]
ds_read_b128 a[124:127], v5 offset:33792
ds_read_b128 a[128:131], v5 offset:41984
M v[136:139], a[156:159], a[40:43], v[136:139]
v_exp_f32 v89, v89
M v[136:139], a[160:163], a[44:47], v[136:139]
buffer_load_dwordx4 v1, s[12:15], s26 offen offset:2048 sc1 lds
M v[140:143], a[160:163], a[60:63], 0
v_exp_f32 v90, v90
M v[140:143], a[156:159], a[56:59], v[140:143]
v_cvt_pk_bf16_f32 v73, v74, v75
v_cvt_pk_bf16_f32 v74, v88, v89
M v[140:143], a[152:155], a[52:55], v[140:143]
v_exp_f32 v91, v91
M v[140:143], a[148:151], a[48:51], v[140:143]
buffer_load_dwordx4 v1, s[12:15], s26 offen offset:3072 sc1 lds
s_add_u32 m0, s29, 102400
s_waitcnt lgkmcnt(4)
M v[144:147], a[164:167], a[0:3], 0
v_exp_f32 v76, v76
M v[144:147], a[168:171], a[4:7], v[144:147]
ds_read_b128 a[132:135], v5 offset:34816
ds_read_b128 a[136:139], v5 offset:43008
M v[144:147], a[172:175], a[8:11], v[144:147]
v_exp_f32 v77, v77
M v[144:147], a[176:179], a[12:15], v[144:147]
buffer_load_dwordx4 v1, s[12:15], s43 offen offset:0 sc1 lds
M v[148:151], a[176:179], a[28:31], 0
v_exp_f32 v78, v78
M v[148:151], a[172:175], a[24:27], v[148:151]
v_cvt_pk_bf16_f32 v75, v90, v91
v_cvt_pk_bf16_f32 v76, v76, v77
M v[148:151], a[168:171], a[20:23], v[148:151]
v_exp_f32 v79, v79
M v[148:151], a[164:167], a[16:19], v[148:151]
buffer_load_dwordx4 v1, s[12:15], s43 offen offset:1024 sc1 lds
M v[152:155], a[164:167], a[32:35], 0
v_exp_f32 v92, v92
M v[152:155], a[168:171], a[36:39], v[152:155]
ds_read_b128 a[140:143], v5 offset:35840
ds_read_b128 a[144:147], v5 offset:44032
M v[152:155], a[172:175], a[40:43], v[152:155]
v_exp_f32 v93, v93
M v[152:155], a[176:179], a[44:47], v[152:155]
buffer_load_dwordx4 v1, s[12:15], s43 offen offset:2048 sc1 lds
M v[156:159], a[176:179], a[60:63], 0
v_exp_f32 v94, v94
M v[156:159], a[172:175], a[56:59], v[156:159]
v_cvt_pk_bf16_f32 v77, v78, v79
v_cvt_pk_bf16_f32 v78, v92, v93
M v[156:159], a[168:171], a[52:55], v[156:159]
v_exp_f32 v95, v95
M v[156:159], a[164:167], a[48:51], v[156:159]
buffer_load_dwordx4 v1, s[12:15], s43 offen offset:3072 sc1 lds
v_cvt_pk_bf16_f32 v79, v94, v95
s_waitcnt lgkmcnt(6)
M v[160:163], a[116:119], v[32:35], v[160:163]
v_exp_f32 v96, v96
M v[160:163], a[120:123], v[64:67], v[160:163]
ds_read_b128 a[148:151], v5 offset:36864
ds_read_b128 a[152:155], v5 offset:45056
M v[164:167], a[120:123], v[68:71], v[164:167]
v_exp_f32 v97, v97
M v[164:167], a[116:119], v[36:39], v[164:167]
v_cvt_pk_bf16_f32 v96, v96, v97
M v[168:171], a[116:119], v[40:43], v[168:171]
v_exp_f32 v98, v98
M v[168:171], a[120:123], v[72:75], v[168:171]
s_add_u32 s25, s25, 32768
s_cmp_eq_u32 s25, s27
M v[172:175], a[120:123], v[76:79], v[172:175]
v_exp_f32 v99, v99
M v[172:175], a[116:119], v[44:47], v[172:175]
v_cvt_pk_bf16_f32 v97, v98, v99
s_waitcnt lgkmcnt(6)
M a[96:99], a[112:115], v[32:35], a[96:99]
s_cselect_b32 s25, s28, s25
s_cselect_b32 s27, s56, s27
M a[96:99], a[112:115], v[64:67], a[96:99]
s_cselect_b32 s28, s57, s28
s_cselect_b32 s56, -1, s56
M v[176:179], a[124:127], v[32:35], v[176:179]
v_exp_f32 v112, v112
M v[176:179], a[128:131], v[64:67], v[176:179]
ds_read_b128 a[156:159], v5 offset:37888
ds_read_b128 a[160:163], v5 offset:46080
M v[180:183], a[128:131], v[68:71], v[180:183]
v_exp_f32 v113, v113
M v[180:183], a[124:127], v[36:39], v[180:183]
v_cvt_pk_bf16_f32 v98, v112, v113
M v[184:187], a[124:127], v[40:43], v[184:187]
v_exp_f32 v114, v114
M v[184:187], a[128:131], v[72:75], v[184:187]
s_add_u32 s26, s26, 32768
s_cmp_eq_u32 s26, s62
M v[188:191], a[128:131], v[76:79], v[188:191]
v_exp_f32 v115, v115
M v[188:191], a[124:127], v[44:47], v[188:191]
v_cvt_pk_bf16_f32 v99, v114, v115
s_waitcnt lgkmcnt(6)
M a[100:103], a[112:115], v[36:39], a[100:103]
s_cselect_b32 s26, s63, s26
s_cselect_b32 s62, s58, s62
M a[100:103], a[112:115], v[68:71], a[100:103]
s_cselect_b32 s63, s59, s63
s_cselect_b32 s58, -1, s58
M v[192:195], a[132:135], v[32:35], v[192:195]
v_exp_f32 v100, v100
M v[192:195], a[136:139], v[64:67], v[192:195]
ds_read_b128 a[164:167], v5 offset:38912
ds_read_b128 a[168:171], v5 offset:47104
M v[196:199], a[136:139], v[68:71], v[196:199]
v_exp_f32 v101, v101
M v[196:199], a[132:135], v[36:39], v[196:199]
v_cvt_pk_bf16_f32 v100, v100, v101
M v[200:203], a[132:135], v[40:43], v[200:203]
v_exp_f32 v102, v102
M v[200:203], a[136:139], v[72:75], v[200:203]
s_sub_u32 s33, s42, 1
s_cmp_le_u32 s33, 1
s_cselect_b32 s33, 0x4000, 0
v_add_u32 v2, s33, v2
M v[204:207], a[136:139], v[76:79], v[204:207]
v_exp_f32 v103, v103
M v[204:207], a[132:135], v[44:47], v[204:207]
v_cvt_pk_bf16_f32 v101, v102, v103
s_waitcnt lgkmcnt(6)
M a[104:107], a[112:115], v[40:43], a[104:107]
M a[104:107], a[112:115], v[72:75], a[104:107]
M v[208:211], a[140:143], v[32:35], v[208:211]
v_exp_f32 v116, v116
M v[208:211], a[144:147], v[64:67], v[208:211]
ds_read_b128 a[172:175], v5 offset:39936
ds_read_b128 a[176:179], v5 offset:48128
M v[212:215], a[144:147], v[68:71], v[212:215]
v_exp_f32 v117, v117
M v[212:215], a[140:143], v[36:39], v[212:215]
v_cvt_pk_bf16_f32 v102, v116, v117
M v[216:219], a[140:143], v[40:43], v[216:219]
v_exp_f32 v118, v118
M v[216:219], a[144:147], v[72:75], v[216:219]
M v[220:223], a[144:147], v[76:79], v[220:223]
v_exp_f32 v119, v119
M v[220:223], a[140:143], v[44:47], v[220:223]
v_cvt_pk_bf16_f32 v103, v118, v119
s_waitcnt lgkmcnt(6)
M a[108:111], a[112:115], v[44:47], a[108:111]
M a[108:111], a[112:115], v[76:79], a[108:111]
M v[224:227], a[148:151], v[32:35], v[224:227]
v_exp_f32 v104, v104
M v[224:227], a[152:155], v[64:67], v[224:227]
s_cmp_le_u32 s42, 1
s_cselect_b32 s33, 0x4000, 0
v_add_u32 v5, s33, v5
s_sub_u32 s42, s42, 1
M v[228:231], a[152:155], v[68:71], v[228:231]
v_exp_f32 v105, v105
M v[228:231], a[148:151], v[36:39], v[228:231]
v_cvt_pk_bf16_f32 v104, v104, v105
M v[232:235], a[148:151], v[40:43], v[232:235]
v_exp_f32 v106, v106
M v[232:235], a[152:155], v[72:75], v[232:235]
M v[236:239], a[152:155], v[76:79], v[236:239]
v_exp_f32 v107, v107
M v[236:239], a[148:151], v[44:47], v[236:239]
v_cvt_pk_bf16_f32 v105, v106, v107
s_waitcnt lgkmcnt(4)
M v[240:243], a[156:159], v[32:35], v[240:243]
v_exp_f32 v120, v120
M v[240:243], a[160:163], v[64:67], v[240:243]
M v[244:247], a[160:163], v[68:71], v[244:247]
v_exp_f32 v121, v121
M v[244:247], a[156:159], v[36:39], v[244:247]
v_cvt_pk_bf16_f32 v106, v120, v121
M v[248:251], a[156:159], v[40:43], v[248:251]
v_exp_f32 v122, v122
M v[248:251], a[160:163], v[72:75], v[248:251]
s_waitcnt vmcnt(0) lgkmcnt(0)
s_barrier
ds_read_b128 a[116:119], v3 offset:0
ds_read_b128 a[120:123], v3 offset:1024
M v[252:255], a[160:163], v[76:79], v[252:255]
v_exp_f32 v123, v123
M v[252:255], a[156:159], v[44:47], v[252:255]
v_cvt_pk_bf16_f32 v107, v122, v123
M a[64:67], a[164:167], v[32:35], a[64:67]
v_exp_f32 v108, v108
M a[64:67], a[168:171], v[64:67], a[64:67]
ds_read_b128 a[124:127], v3 offset:2048
ds_read_b128 a[128:131], v3 offset:3072
M a[68:71], a[168:171], v[68:71], a[68:71]
v_exp_f32 v109, v109
M a[68:71], a[164:167], v[36:39], a[68:71]
v_cvt_pk_bf16_f32 v108, v108, v109
M a[72:75], a[164:167], v[40:43], a[72:75]
v_exp_f32 v110, v110
M a[72:75], a[168:171], v[72:75], a[72:75]
ds_read_b128 a[132:135], v3 offset:4096
ds_read_b128 a[136:139], v3 offset:5120
M a[76:79], a[168:171], v[76:79], a[76:79]
v_exp_f32 v111, v111
M a[76:79], a[164:167], v[44:47], a[76:79]
v_cvt_pk_bf16_f32 v109, v110, v111
M a[80:83], a[172:175], v[32:35], a[80:83]
v_exp_f32 v124, v124
M a[80:83], a[176:179], v[64:67], a[80:83]
ds_read_b128 a[140:143], v3 offset:6144
ds_read_b128 a[144:147], v3 offset:7168
M a[84:87], a[176:179], v[68:71], a[84:87]
v_exp_f32 v125, v125
M a[84:87], a[172:175], v[36:39], a[84:87]
v_cvt_pk_bf16_f32 v110, v124, v125
M a[88:91], a[172:175], v[40:43], a[88:91]
v_exp_f32 v126, v126
M a[88:91], a[176:179], v[72:75], a[88:91]
M a[92:95], a[176:179], v[76:79], a[92:95]
v_exp_f32 v127, v127
M a[92:95], a[172:175], v[44:47], a[92:95]
v_cvt_pk_bf16_f32 v111, v126, v127
s_add_u32 m0, s29, 0
s_waitcnt lgkmcnt(4)
M v[32:35], a[116:119], a[0:3], v[16:19]
v_exp_f32 v128, v128
M v[32:35], a[120:123], a[4:7], v[32:35]
ds_read_b128 a[148:151], v3 offset:8192
ds_read_b128 a[152:155], v3 offset:9216
M v[32:35], a[124:127], a[8:11], v[32:35]
v_exp_f32 v129, v129
M v[32:35], a[128:131], a[12:15], v[32:35]
buffer_load_dwordx4 v1, s[12:15], s25 offen offset:0 sc1 lds
s_add_u32 s32, s25, 4096
M v[36:39], a[128:131], a[28:31], 0
v_exp_f32 v130, v130
M v[36:39], a[124:127], a[24:27], v[36:39]
v_cvt_pk_bf16_f32 v128, v128, v129
M v[36:39], a[120:123], a[20:23], v[36:39]
v_exp_f32 v131, v131
M v[36:39], a[116:119], a[16:19], v[36:39]
buffer_load_dwordx4 v1, s[12:15], s25 offen offset:1024 sc1 lds
M v[40:43], a[116:119], a[32:35], 0
v_exp_f32 v144, v144
M v[40:43], a[120:123], a[36:39], v[40:43]
ds_read_b128 a[156:159], v3 offset:10240
ds_read_b128 a[160:163], v3 offset:11264
M v[40:43], a[124:127], a[40:43], v[40:43]
v_exp_f32 v145, v145
M v[40:43], a[128:131], a[44:47], v[40:43]
buffer_load_dwordx4 v1, s[12:15], s25 offen offset:2048 sc1 lds
M v[44:47], a[128:131], a[60:63], 0
v_exp_f32 v146, v146
M v[44:47], a[124:127], a[56:59], v[44:47]
v_cvt_pk_bf16_f32 v129, v130, v131
v_cvt_pk_bf16_f32 v130, v144, v145
M v[44:47], a[120:123], a[52:55], v[44:47]
v_exp_f32 v147, v147
M v[44:47], a[116:119], a[48:51], v[44:47]
buffer_load_dwordx4 v1, s[12:15], s25 offen offset:3072 sc1 lds
s_add_u32 m0, s29, 4096
s_waitcnt lgkmcnt(4)
v_exp_f32 v132, v132
ds_read_b128 a[164:167], v3 offset:12288
ds_read_b128 a[168:171], v3 offset:13312
v_exp_f32 v133, v133
buffer_load_dwordx4 v1, s[12:15], s32 offen offset:0 sc1 lds
M v[52:55], a[144:147], a[28:31], v[16:19]
v_exp_f32 v134, v134
M v[52:55], a[140:143], a[24:27], v[52:55]
v_cvt_pk_bf16_f32 v131, v146, v147
v_cvt_pk_bf16_f32 v132, v132, v133
M v[52:55], a[136:139], a[20:23], v[52:55]
v_exp_f32 v135, v135
M v[52:55], a[132:135], a[16:19], v[52:55]
buffer_load_dwordx4 v1, s[12:15], s32 offen offset:1024 sc1 lds
M v[56:59], a[132:135], a[32:35], 0
v_exp_f32 v148, v148
M v[56:59], a[136:139], a[36:39], v[56:59]
ds_read_b128 a[172:175], v3 offset:14336
ds_read_b128 a[176:179], v3 offset:15360
M v[56:59], a[140:143], a[40:43], v[56:59]
v_exp_f32 v149, v149
M v[56:59], a[144:147], a[44:47], v[56:59]
buffer_load_dwordx4 v1, s[12:15], s32 offen offset:2048 sc1 lds
M v[60:63], a[144:147], a[60:63], 0
v_exp_f32 v150, v150
M v[60:63], a[140:143], a[56:59], v[60:63]
v_cvt_pk_bf16_f32 v133, v134, v135
v_cvt_pk_bf16_f32 v134, v148, v149
M v[60:63], a[136:139], a[52:55], v[60:63]
v_exp_f32 v151, v151
M v[60:63], a[132:135], a[48:51], v[60:63]
buffer_load_dwordx4 v1, s[12:15], s32 offen offset:3072 sc1 lds
s_add_u32 m0, s29, 32768
s_waitcnt lgkmcnt(4)
v_exp_f32 v136, v136
ds_read_b128 a[116:119], v6 offset:32768
ds_read_b128 a[120:123], v6 offset:40960
v_exp_f32 v137, v137
buffer_load_dwordx4 v1, s[12:15], s26 offen offset:0 sc1 lds
s_add_u32 s43, s26, 4096
v_exp_f32 v138, v138
v_cvt_pk_bf16_f32 v135, v150, v151
v_cvt_pk_bf16_f32 v136, v136, v137
v_exp_f32 v139, v139
buffer_load_dwordx4 v1, s[12:15], s26 offen offset:1024 sc1 lds
M v[72:75], a[148:151], a[32:35], v[16:19]
v_exp_f32 v152, v152
M v[72:75], a[152:155], a[36:39], v[72:75]
ds_read_b128 a[124:127], v6 offset:33792
ds_read_b128 a[128:131], v6 offset:41984
M v[72:75], a[156:159], a[40:43], v[72:75]
v_exp_f32 v153, v153
M v[72:75], a[160:163], a[44:47], v[72:75]
buffer_load_dwordx4 v1, s[12:15], s26 offen offset:2048 sc1 lds
M v[76:79], a[160:163], a[60:63], 0
v_exp_f32 v154, v154
M v[76:79], a[156:159], a[56:59], v[76:79]
v_cvt_pk_bf16_f32 v137, v138, v139
v_cvt_pk_bf16_f32 v138, v152, v153
M v[76:79], a[152:155], a[52:55], v[76:79]
v_exp_f32 v155, v155
M v[76:79], a[148:151], a[48:51], v[76:79]
buffer_load_dwordx4 v1, s[12:15], s26 offen offset:3072 sc1 lds
s_add_u32 m0, s29, 36864
s_waitcnt lgkmcnt(4)
v_exp_f32 v140, v140
ds_read_b128 a[132:135], v6 offset:34816
ds_read_b128 a[136:139], v6 offset:43008
v_exp_f32 v141, v141
buffer_load_dwordx4 v1, s[12:15], s43 offen offset:0 sc1 lds
v_exp_f32 v142, v142
v_cvt_pk_bf16_f32 v139, v154, v155
v_cvt_pk_bf16_f32 v140, v140, v141
v_exp_f32 v143, v143
buffer_load_dwordx4 v1, s[12:15], s43 offen offset:1024 sc1 lds
v_exp_f32 v156, v156
ds_read_b128 a[140:143], v6 offset:35840
ds_read_b128 a[144:147], v6 offset:44032
v_exp_f32 v157, v157
buffer_load_dwordx4 v1, s[12:15], s43 offen offset:2048 sc1 lds
M v[92:95], a[176:179], a[60:63], v[16:19]
v_exp_f32 v158, v158
M v[92:95], a[172:175], a[56:59], v[92:95]
v_cvt_pk_bf16_f32 v141, v142, v143
v_cvt_pk_bf16_f32 v142, v156, v157
M v[92:95], a[168:171], a[52:55], v[92:95]
v_exp_f32 v159, v159
M v[92:95], a[164:167], a[48:51], v[92:95]
buffer_load_dwordx4 v1, s[12:15], s43 offen offset:3072 sc1 lds
v_cvt_pk_bf16_f32 v143, v158, v159
s_waitcnt lgkmcnt(6)
M v[160:163], a[116:119], v[96:99], v[160:163]
v_exp_f32 v32, v32
M v[160:163], a[120:123], v[128:131], v[160:163]
ds_read_b128 a[148:151], v6 offset:36864
ds_read_b128 a[152:155], v6 offset:45056
M v[164:167], a[120:123], v[132:135], v[164:167]
v_exp_f32 v33, v33
M v[164:167], a[116:119], v[100:103], v[164:167]
v_cvt_pk_bf16_f32 v32, v32, v33
M v[168:171], a[116:119], v[104:107], v[168:171]
v_exp_f32 v34, v34
M v[168:171], a[120:123], v[136:139], v[168:171]
s_add_u32 s25, s25, 32768
s_cmp_eq_u32 s25, s27
M v[172:175], a[120:123], v[140:143], v[172:175]
v_exp_f32 v35, v35
M v[172:175], a[116:119], v[108:111], v[172:175]
v_cvt_pk_bf16_f32 v33, v34, v35
s_waitcnt lgkmcnt(6)
M a[96:99], a[112:115], v[96:99], a[96:99]
s_cselect_b32 s25, s28, s25
s_cselect_b32 s27, s56, s27
M a[96:99], a[112:115], v[128:131], a[96:99]
s_cselect_b32 s28, s57, s28
s_cselect_b32 s56, -1, s56
M v[176:179], a[124:127], v[96:99], v[176:179]
M v[176:179], a[128:131], v[128:131], v[176:179]
ds_read_b128 a[156:159], v6 offset:37888
ds_read_b128 a[160:163], v6 offset:46080
M v[180:183], a[128:131], v[132:135], v[180:183]
M v[180:183], a[124:127], v[100:103], v[180:183]
v_mov_b32 v34, 0
M v[184:187], a[124:127], v[104:107], v[184:187]
M v[184:187], a[128:131], v[136:139], v[184:187]
s_add_u32 s26, s26, 32768
s_cmp_eq_u32 s26, s62
M v[188:191], a[128:131], v[140:143], v[188:191]
M v[188:191], a[124:127], v[108:111], v[188:191]
v_mov_b32 v35, 0
s_waitcnt lgkmcnt(6)
M a[100:103], a[112:115], v[100:103], a[100:103]
s_cselect_b32 s26, s63, s26
s_cselect_b32 s62, s58, s62
M a[100:103], a[112:115], v[132:135], a[100:103]
s_cselect_b32 s63, s59, s63
s_cselect_b32 s58, -1, s58
M v[192:195], a[132:135], v[96:99], v[192:195]
v_exp_f32 v36, v36
M v[192:195], a[136:139], v[128:131], v[192:195]
ds_read_b128 a[164:167], v6 offset:38912
ds_read_b128 a[168:171], v6 offset:47104
M v[196:199], a[136:139], v[132:135], v[196:199]
v_exp_f32 v37, v37
M v[196:199], a[132:135], v[100:103], v[196:199]
v_cvt_pk_bf16_f32 v36, v36, v37
M v[200:203], a[132:135], v[104:107], v[200:203]
v_exp_f32 v38, v38
M v[200:203], a[136:139], v[136:139], v[200:203]
s_sub_u32 s33, s42, 1
s_cmp_le_u32 s33, 1
s_cselect_b32 s33, 0x4000, 0
v_add_u32 v3, s33, v3
M v[204:207], a[136:139], v[140:143], v[204:207]
v_exp_f32 v39, v39
M v[204:207], a[132:135], v[108:111], v[204:207]
v_cvt_pk_bf16_f32 v37, v38, v39
s_waitcnt lgkmcnt(6)
M a[104:107], a[112:115], v[104:107], a[104:107]
M a[104:107], a[112:115], v[136:139], a[104:107]
M v[208:211], a[140:143], v[96:99], v[208:211]
v_exp_f32 v52, v52
M v[208:211], a[144:147], v[128:131], v[208:211]
ds_read_b128 a[172:175], v6 offset:39936
ds_read_b128 a[176:179], v6 offset:48128
M v[212:215], a[144:147], v[132:135], v[212:215]
v_exp_f32 v53, v53
M v[212:215], a[140:143], v[100:103], v[212:215]
v_cvt_pk_bf16_f32 v38, v52, v53
M v[216:219], a[140:143], v[104:107], v[216:219]
v_exp_f32 v54, v54
M v[216:219], a[144:147], v[136:139], v[216:219]
M v[220:223], a[144:147], v[140:143], v[220:223]
v_exp_f32 v55, v55
M v[220:223], a[140:143], v[108:111], v[220:223]
v_cvt_pk_bf16_f32 v39, v54, v55
s_waitcnt lgkmcnt(6)
M a[108:111], a[112:115], v[108:111], a[108:111]
M a[108:111], a[112:115], v[140:143], a[108:111]
M v[224:227], a[148:151], v[96:99], v[224:227]
v_exp_f32 v40, v40
M v[224:227], a[152:155], v[128:131], v[224:227]
s_cmp_le_u32 s42, 1
s_cselect_b32 s33, 0x4000, 0
v_add_u32 v6, s33, v6
s_sub_u32 s42, s42, 1
M v[228:231], a[152:155], v[132:135], v[228:231]
v_exp_f32 v41, v41
M v[228:231], a[148:151], v[100:103], v[228:231]
v_cvt_pk_bf16_f32 v40, v40, v41
M v[232:235], a[148:151], v[104:107], v[232:235]
v_exp_f32 v42, v42
M v[232:235], a[152:155], v[136:139], v[232:235]
M v[236:239], a[152:155], v[140:143], v[236:239]
v_exp_f32 v43, v43
M v[236:239], a[148:151], v[108:111], v[236:239]
v_cvt_pk_bf16_f32 v41, v42, v43
s_waitcnt lgkmcnt(4)
M v[240:243], a[156:159], v[96:99], v[240:243]
v_exp_f32 v56, v56
M v[240:243], a[160:163], v[128:131], v[240:243]
M v[244:247], a[160:163], v[132:135], v[244:247]
v_exp_f32 v57, v57
M v[244:247], a[156:159], v[100:103], v[244:247]
v_cvt_pk_bf16_f32 v42, v56, v57
M v[248:251], a[156:159], v[104:107], v[248:251]
v_exp_f32 v58, v58
M v[248:251], a[160:163], v[136:139], v[248:251]
s_waitcnt vmcnt(0) lgkmcnt(0)
s_barrier
ds_read_b128 a[116:119], v2 offset:0
ds_read_b128 a[120:123], v2 offset:1024
M v[252:255], a[160:163], v[140:143], v[252:255]
v_exp_f32 v59, v59
M v[252:255], a[156:159], v[108:111], v[252:255]
v_cvt_pk_bf16_f32 v43, v58, v59
M a[64:67], a[164:167], v[96:99], a[64:67]
v_exp_f32 v44, v44
M a[64:67], a[168:171], v[128:131], a[64:67]
ds_read_b128 a[124:127], v2 offset:2048
ds_read_b128 a[128:131], v2 offset:3072
M a[68:71], a[168:171], v[132:135], a[68:71]
v_exp_f32 v45, v45
M a[68:71], a[164:167], v[100:103], a[68:71]
v_cvt_pk_bf16_f32 v44, v44, v45
M a[72:75], a[164:167], v[104:107], a[72:75]
v_exp_f32 v46, v46
M a[72:75], a[168:171], v[136:139], a[72:75]
ds_read_b128 a[132:135], v2 offset:4096
ds_read_b128 a[136:139], v2 offset:5120
M a[76:79], a[168:171], v[140:143], a[76:79]
v_exp_f32 v47, v47
M a[76:79], a[164:167], v[108:111], a[76:79]
v_cvt_pk_bf16_f32 v45, v46, v47
M a[80:83], a[172:175], v[96:99], a[80:83]
v_exp_f32 v60, v60
M a[80:83], a[176:179], v[128:131], a[80:83]
ds_read_b128 a[140:143], v2 offset:6144
ds_read_b128 a[144:147], v2 offset:7168
M a[84:87], a[176:179], v[132:135], a[84:87]
v_exp_f32 v61, v61
M a[84:87], a[172:175], v[100:103], a[84:87]
v_cvt_pk_bf16_f32 v46, v60, v61
M a[88:91], a[172:175], v[104:107], a[88:91]
v_exp_f32 v62, v62
M a[88:91], a[176:179], v[136:139], a[88:91]
M a[92:95], a[176:179], v[140:143], a[92:95]
v_exp_f32 v63, v63
M a[92:95], a[172:175], v[108:111], a[92:95]
v_cvt_pk_bf16_f32 v47, v62, v63
s_and_b32 s3, s2, 3
s_lshl_b32 s3, s3, 2
s_bfe_u32 s27, s2, 0x20003
s_add_u32 s27, s3, s27
s_lshl_b32 s43, s27, 8
s_add_u32 s43, s43, 16789504
v_lshlrev_b32 v15, 2, v0
buffer_load_dword v7, v15, s[52:55], s43 offen sc1
s_waitcnt lgkmcnt(7)
ds_read_b128 a[116:119], v5 offset:32768
s_waitcnt lgkmcnt(7)
ds_read_b128 a[120:123], v5 offset:40960
s_waitcnt lgkmcnt(7)
ds_read_b128 a[124:127], v5 offset:33792
s_waitcnt lgkmcnt(7)
ds_read_b128 a[128:131], v5 offset:41984
s_waitcnt lgkmcnt(7)
ds_read_b128 a[132:135], v5 offset:34816
s_waitcnt lgkmcnt(7)
ds_read_b128 a[136:139], v5 offset:43008
s_waitcnt lgkmcnt(7)
ds_read_b128 a[140:143], v5 offset:35840
s_waitcnt lgkmcnt(7)
ds_read_b128 a[144:147], v5 offset:44032
s_lshl_b32 s33, s23, 14
s_add_u32 s34, s33, 131072
s_add_u32 s33, s33, 98304
v_add_u32 v2, s34, v1
v_add_u32 v3, s33, v1
v_exp_f32 v72, v72
v_exp_f32 v73, v73
v_exp_f32 v74, v74
v_exp_f32 v75, v75
v_cvt_pk_bf16_f32 v72, v72, v73
v_cvt_pk_bf16_f32 v73, v74, v75
v_exp_f32 v76, v76
v_exp_f32 v77, v77
v_exp_f32 v78, v78
v_exp_f32 v79, v79
v_mov_b32 v74, 0
v_mov_b32 v75, 0
v_exp_f32 v92, v92
v_exp_f32 v93, v93
v_exp_f32 v94, v94
v_exp_f32 v95, v95
v_cvt_pk_bf16_f32 v76, v76, v77
v_cvt_pk_bf16_f32 v77, v78, v79
v_cvt_pk_bf16_f32 v78, v92, v93
v_cvt_pk_bf16_f32 v79, v94, v95
s_waitcnt lgkmcnt(6)
M v[160:163], a[116:119], v[32:35], v[160:163]
ds_read_b128 a[148:151], v5 offset:36864
ds_read_b128 a[152:155], v5 offset:45056
s_mov_b32 s61, 0
M v[164:167], a[116:119], v[36:39], v[164:167]
s_bfe_u32 s3, s2, 0x10002
M v[168:171], a[116:119], v[40:43], v[168:171]
M v[168:171], a[120:123], v[72:75], v[168:171]
s_lshl_b32 s3, s3, 3
M v[172:175], a[120:123], v[76:79], v[172:175]
M v[172:175], a[116:119], v[44:47], v[172:175]
s_waitcnt lgkmcnt(6)
s_lshr_b32 s28, s2, 5
M a[96:99], a[112:115], v[32:35], a[96:99]
M v[176:179], a[124:127], v[32:35], v[176:179]
ds_read_b128 a[156:159], v5 offset:37888
ds_read_b128 a[160:163], v5 offset:46080
s_add_u32 s28, s3, s28
s_lshl_b32 s25, s27, 18
M v[180:183], a[124:127], v[36:39], v[180:183]
M v[184:187], a[124:127], v[40:43], v[184:187]
s_lshl_b32 s3, s101, 12
M v[184:187], a[128:131], v[72:75], v[184:187]
M v[188:191], a[128:131], v[76:79], v[188:191]
s_add_u32 s25, s25, s3
M v[188:191], a[124:127], v[44:47], v[188:191]
s_waitcnt lgkmcnt(6)
M a[100:103], a[112:115], v[36:39], a[100:103]
M v[192:195], a[132:135], v[32:35], v[192:195]
s_lshl_b32 s26, s28, 7
ds_read_b128 a[164:167], v5 offset:38912
ds_read_b128 a[168:171], v5 offset:47104
s_lshl_b32 s42, s101, 11
M v[196:199], a[132:135], v[36:39], v[196:199]
M v[200:203], a[132:135], v[40:43], v[200:203]
s_add_u32 s44, s4, 83886080
s_addc_u32 s45, s5, 0
M v[200:203], a[136:139], v[72:75], v[200:203]
s_mov_b32 s46, 4194304
M v[204:207], a[136:139], v[76:79], v[204:207]
M v[204:207], a[132:135], v[44:47], v[204:207]
s_waitcnt lgkmcnt(6)
s_mov_b32 s47, 0x00020000
M a[104:107], a[112:115], v[40:43], a[104:107]
M a[104:107], a[112:115], v[72:75], a[104:107]
M v[208:211], a[140:143], v[32:35], v[208:211]
ds_read_b128 a[172:175], v5 offset:39936
ds_read_b128 a[176:179], v5 offset:48128
s_mov_b32 s50, 2097152
M v[212:215], a[140:143], v[36:39], v[212:215]
s_mov_b32 s51, 0x00020000
M v[216:219], a[140:143], v[40:43], v[216:219]
M v[216:219], a[144:147], v[72:75], v[216:219]
s_lshl_b32 s3, s101, 4
M v[220:223], a[144:147], v[76:79], v[220:223]
M v[220:223], a[140:143], v[44:47], v[220:223]
s_waitcnt lgkmcnt(6)
v_lshrrev_b32 v96, 3, v0
M a[108:111], a[112:115], v[44:47], a[108:111]
M a[108:111], a[112:115], v[76:79], a[108:111]
M v[224:227], a[148:151], v[32:35], v[224:227]
v_and_b32 v97, 6, v96
ds_write_b128 v2, v[160:163] offset:0
v_and_b32 v98, 7, v0
M v[228:231], a[148:151], v[36:39], v[228:231]
M v[232:235], a[148:151], v[40:43], v[232:235]
ds_write_b128 v2, v[164:167] offset:1024
v_xor_b32 v97, v97, v98
M v[232:235], a[152:155], v[72:75], v[232:235]
M v[236:239], a[152:155], v[76:79], v[236:239]
ds_write_b128 v2, v[168:171] offset:2048
v_add_u32 v96, s3, v96
M v[236:239], a[148:151], v[44:47], v[236:239]
s_waitcnt lgkmcnt(7)
M v[240:243], a[156:159], v[32:35], v[240:243]
ds_write_b128 v2, v[172:175] offset:3072
v_lshlrev_b32 v96, 11, v96
ds_write_b128 v2, v[176:179] offset:4096
v_lshl_add_u32 v99, v97, 4, v96
M v[244:247], a[156:159], v[36:39], v[244:247]
v_add_u32 v100, 15360, v99
M v[248:251], a[156:159], v[40:43], v[248:251]
ds_write_b128 v2, v[180:183] offset:5120
M v[248:251], a[160:163], v[72:75], v[248:251]
s_waitcnt vmcnt(0) lgkmcnt(0)
s_barrier
M v[252:255], a[160:163], v[76:79], v[252:255]
ds_write_b128 v2, v[184:187] offset:6144
v_cmp_ne_u32 vcc, 1, v7
s_nop 0
s_cbranch_vccnz Lk3_spinb2
Lk3_gotb2:
M v[252:255], a[156:159], v[44:47], v[252:255]
s_add_u32 m0, s42, 16384
s_nop 0
buffer_load_dwordx4 v99, s[48:51], s26 offen offset:0 lds
M a[64:67], a[164:167], v[32:35], a[64:67]
ds_write_b128 v2, v[188:191] offset:7168
buffer_load_dwordx4 v100, s[48:51], s26 offen offset:1024 lds
ds_write_b128 v2, v[192:195] offset:8192
buffer_load_dwordx4 a[192:195], v1, s[44:47], s25 offen offset:0 sc1
M a[68:71], a[164:167], v[36:39], a[68:71]
buffer_load_dwordx4 a[196:199], v1, s[44:47], s25 offen offset:1024 sc1
M a[72:75], a[164:167], v[40:43], a[72:75]
ds_write_b128 v2, v[196:199] offset:9216
buffer_load_dwordx4 a[200:203], v1, s[44:47], s25 offen offset:2048 sc1
M a[72:75], a[168:171], v[72:75], a[72:75]
buffer_load_dwordx4 a[204:207], v1, s[44:47], s25 offen offset:3072 sc1
M a[76:79], a[168:171], v[76:79], a[76:79]
ds_write_b128 v2, v[200:203] offset:10240
M a[76:79], a[164:167], v[44:47], a[76:79]
s_add_u32 s25, s25, 16384
s_add_u32 s26, s26, 131072
M a[80:83], a[172:175], v[32:35], a[80:83]
ds_write_b128 v2, v[204:207] offset:11264
s_add_u32 m0, s42, 32768
s_nop 0
buffer_load_dwordx4 v99, s[48:51], s26 offen offset:0 lds
buffer_load_dwordx4 v100, s[48:51], s26 offen offset:1024 lds
ds_write_b128 v2, v[208:211] offset:12288
buffer_load_dwordx4 a[224:227], v1, s[44:47], s25 offen offset:0 sc1
M a[84:87], a[172:175], v[36:39], a[84:87]
M a[88:91], a[172:175], v[40:43], a[88:91]
ds_write_b128 v2, v[212:215] offset:13312
buffer_load_dwordx4 a[228:231], v1, s[44:47], s25 offen offset:1024 sc1
M a[88:91], a[176:179], v[72:75], a[88:91]
buffer_load_dwordx4 a[232:235], v1, s[44:47], s25 offen offset:2048 sc1
M a[92:95], a[176:179], v[76:79], a[92:95]
ds_write_b128 v2, v[216:219] offset:14336
buffer_load_dwordx4 a[236:239], v1, s[44:47], s25 offen offset:3072 sc1
M a[92:95], a[172:175], v[44:47], a[92:95]
s_add_u32 s25, s25, 16384
s_add_u32 s26, s26, 131072
ds_write_b128 v2, v[220:223] offset:15360
s_waitcnt lgkmcnt(0)
Lk2_mg1:
s_lshl_b32 s33, s22, 10
s_add_u32 s33, s33, 28672
s_xor_b32 s34, s33, 2048
v_add_u32 v14, s33, v1
v_add_u32 v15, s34, v1
v_accvgpr_read_b32 v20, a96
v_accvgpr_read_b32 v21, a100
v_accvgpr_read_b32 v22, a104
v_accvgpr_read_b32 v23, a108
ds_write_b128 v14, v[20:23]
s_waitcnt lgkmcnt(0)
s_barrier
ds_read_b128 v[28:31], v15
ds_read_b128 v[32:35], v3 offset:0
ds_read_b128 v[36:39], v3 offset:1024
ds_read_b128 v[40:43], v3 offset:2048
ds_read_b128 v[44:47], v3 offset:3072
ds_read_b128 v[48:51], v3 offset:4096
ds_read_b128 v[52:55], v3 offset:5120
ds_read_b128 v[56:59], v3 offset:6144
ds_read_b128 v[60:63], v3 offset:7168
ds_read_b128 v[64:67], v3 offset:8192
ds_read_b128 v[68:71], v3 offset:9216
ds_read_b128 v[72:75], v3 offset:10240
ds_read_b128 v[76:79], v3 offset:11264
ds_read_b128 v[80:83], v3 offset:12288
ds_read_b128 v[84:87], v3 offset:13312
ds_read_b128 v[88:91], v3 offset:14336
ds_read_b128 v[92:95], v3 offset:15360
s_waitcnt lgkmcnt(15)
v_add_f32 v20, v20, v28
v_add_f32 v21, v21, v29
v_add_f32 v22, v22, v30
v_add_f32 v23, v23, v31
s_sub_u32 s35, 15, s21
v_rcp_f32 v8, v20
v_rcp_f32 v9, v21
v_rcp_f32 v10, v22
v_rcp_f32 v11, v23
v_subrev_u32 v20, 0x21800000, v20
v_subrev_u32 v21, 0x21800000, v21
v_subrev_u32 v22, 0x21800000, v22
v_subrev_u32 v23, 0x21800000, v23
v_max_u32 v12, v20, v21
v_max3_u32 v12, v12, v22, v23
s_mov_b32 s64, 0x207
s_lshl_b32 s33, s35, 20
s_lshl_b32 s34, s20, 15
s_add_u32 s33, s33, s34
s_lshl_b32 s34, s23, 13
s_add_u32 s36, s33, s34
s_add_u32 s37, s36, 4096
s_add_u32 s38, s36, 16384
s_add_u32 s39, s36, 20480
v_pk_add_f32 v[224:225], v[224:225], v[32:33]
v_pk_add_f32 v[226:227], v[226:227], v[34:35]
s_waitcnt lgkmcnt(11)
v_pk_add_f32 v[240:241], v[240:241], v[48:49]
v_pk_add_f32 v[242:243], v[242:243], v[50:51]
v_pk_mul_f32 v[224:225], v[224:225], v[8:9] op_sel:[0,0] op_sel_hi:[1,0]
v_pk_mul_f32 v[226:227], v[226:227], v[8:9] op_sel:[0,0] op_sel_hi:[1,0]
v_pk_mul_f32 v[240:241], v[240:241], v[8:9] op_sel:[0,0] op_sel_hi:[1,0]
v_pk_mul_f32 v[242:243], v[242:243], v[8:9] op_sel:[0,0] op_sel_hi:[1,0]
v_cvt_pk_bf16_f32 v224, v224, v225
v_cvt_pk_bf16_f32 v225, v226, v227
v_cvt_pk_bf16_f32 v226, v240, v241
v_cvt_pk_bf16_f32 v227, v242, v243
v_pk_add_f32 v[228:229], v[228:229], v[36:37]
v_pk_add_f32 v[230:231], v[230:231], v[38:39]
s_waitcnt lgkmcnt(10)
v_pk_add_f32 v[244:245], v[244:245], v[52:53]
v_pk_add_f32 v[246:247], v[246:247], v[54:55]
M v[24:27], a[112:115], v[224:227], 0
buffer_store_dwordx4 v[224:227], v1, s[16:19], s38 offen offset:0 sc1
v_pk_mul_f32 v[228:229], v[228:229], v[8:9] op_sel:[0,1] op_sel_hi:[1,1]
v_pk_mul_f32 v[230:231], v[230:231], v[8:9] op_sel:[0,1] op_sel_hi:[1,1]
v_pk_mul_f32 v[244:245], v[244:245], v[8:9] op_sel:[0,1] op_sel_hi:[1,1]
v_pk_mul_f32 v[246:247], v[246:247], v[8:9] op_sel:[0,1] op_sel_hi:[1,1]
v_cvt_pk_bf16_f32 v228, v228, v229
v_cvt_pk_bf16_f32 v229, v230, v231
v_cvt_pk_bf16_f32 v230, v244, v245
v_cvt_pk_bf16_f32 v231, v246, v247
v_pk_add_f32 v[232:233], v[232:233], v[40:41]
v_pk_add_f32 v[234:235], v[234:235], v[42:43]
s_waitcnt lgkmcnt(9)
v_pk_add_f32 v[248:249], v[248:249], v[56:57]
v_pk_add_f32 v[250:251], v[250:251], v[58:59]
M v[24:27], a[112:115], v[228:231], v[24:27]
buffer_store_dwordx4 v[228:231], v1, s[16:19], s38 offen offset:2048 sc1
v_pk_mul_f32 v[232:233], v[232:233], v[10:11] op_sel:[0,0] op_sel_hi:[1,0]
v_pk_mul_f32 v[234:235], v[234:235], v[10:11] op_sel:[0,0] op_sel_hi:[1,0]
v_pk_mul_f32 v[248:249], v[248:249], v[10:11] op_sel:[0,0] op_sel_hi:[1,0]
v_pk_mul_f32 v[250:251], v[250:251], v[10:11] op_sel:[0,0] op_sel_hi:[1,0]
v_cvt_pk_bf16_f32 v232, v232, v233
v_cvt_pk_bf16_f32 v233, v234, v235
v_cvt_pk_bf16_f32 v234, v248, v249
v_cvt_pk_bf16_f32 v235, v250, v251
v_pk_add_f32 v[236:237], v[236:237], v[44:45]
v_pk_add_f32 v[238:239], v[238:239], v[46:47]
s_waitcnt lgkmcnt(8)
v_pk_add_f32 v[252:253], v[252:253], v[60:61]
v_pk_add_f32 v[254:255], v[254:255], v[62:63]
M v[24:27], a[112:115], v[232:235], v[24:27]
buffer_store_dwordx4 v[232:235], v1, s[16:19], s39 offen offset:0 sc1
v_pk_mul_f32 v[236:237], v[236:237], v[10:11] op_sel:[0,1] op_sel_hi:[1,1]
v_pk_mul_f32 v[238:239], v[238:239], v[10:11] op_sel:[0,1] op_sel_hi:[1,1]
v_pk_mul_f32 v[252:253], v[252:253], v[10:11] op_sel:[0,1] op_sel_hi:[1,1]
v_pk_mul_f32 v[254:255], v[254:255], v[10:11] op_sel:[0,1] op_sel_hi:[1,1]
v_cvt_pk_bf16_f32 v236, v236, v237
v_cvt_pk_bf16_f32 v237, v238, v239
v_cvt_pk_bf16_f32 v238, v252, v253
v_cvt_pk_bf16_f32 v239, v254, v255
v_accvgpr_read_b32 v32, a64
v_accvgpr_read_b32 v33, a65
v_accvgpr_read_b32 v34, a66
v_accvgpr_read_b32 v35, a67
s_waitcnt lgkmcnt(7)
v_pk_add_f32 v[32:33], v[32:33], v[64:65]
v_pk_add_f32 v[34:35], v[34:35], v[66:67]
v_accvgpr_read_b32 v48, a80
v_accvgpr_read_b32 v49, a81
v_accvgpr_read_b32 v50, a82
v_accvgpr_read_b32 v51, a83
s_waitcnt lgkmcnt(3)
v_pk_add_f32 v[48:49], v[48:49], v[80:81]
v_pk_add_f32 v[50:51], v[50:51], v[82:83]
M v[24:27], a[112:115], v[236:239], v[24:27]
buffer_store_dwordx4 v[236:239], v1, s[16:19], s39 offen offset:2048 sc1
v_pk_mul_f32 v[32:33], v[32:33], v[8:9] op_sel:[0,0] op_sel_hi:[1,0]
v_pk_mul_f32 v[34:35], v[34:35], v[8:9] op_sel:[0,0] op_sel_hi:[1,0]
v_pk_mul_f32 v[48:49], v[48:49], v[8:9] op_sel:[0,0] op_sel_hi:[1,0]
v_pk_mul_f32 v[50:51], v[50:51], v[8:9] op_sel:[0,0] op_sel_hi:[1,0]
v_cvt_pk_bf16_f32 v32, v32, v33
v_cvt_pk_bf16_f32 v33, v34, v35
v_cvt_pk_bf16_f32 v34, v48, v49
v_cvt_pk_bf16_f32 v35, v50, v51
v_accvgpr_read_b32 v240, a68
v_accvgpr_read_b32 v241, a69
v_accvgpr_read_b32 v242, a70
v_accvgpr_read_b32 v243, a71
v_pk_add_f32 v[240:241], v[240:241], v[68:69]
v_pk_add_f32 v[242:243], v[242:243], v[70:71]
v_accvgpr_read_b32 v36, a84
v_accvgpr_read_b32 v37, a85
v_accvgpr_read_b32 v38, a86
v_accvgpr_read_b32 v39, a87
s_waitcnt lgkmcnt(2)
v_pk_add_f32 v[36:37], v[36:37], v[84:85]
v_pk_add_f32 v[38:39], v[38:39], v[86:87]
M v[24:27], a[112:115], v[32:35], v[24:27]
buffer_store_dwordx4 v[32:35], v1, s[16:19], s38 offen offset:1024 sc1
v_pk_mul_f32 v[240:241], v[240:241], v[8:9] op_sel:[0,1] op_sel_hi:[1,1]
v_pk_mul_f32 v[242:243], v[242:243], v[8:9] op_sel:[0,1] op_sel_hi:[1,1]
v_pk_mul_f32 v[36:37], v[36:37], v[8:9] op_sel:[0,1] op_sel_hi:[1,1]
v_pk_mul_f32 v[38:39], v[38:39], v[8:9] op_sel:[0,1] op_sel_hi:[1,1]
v_cvt_pk_bf16_f32 v240, v240, v241
v_cvt_pk_bf16_f32 v241, v242, v243
v_cvt_pk_bf16_f32 v242, v36, v37
v_cvt_pk_bf16_f32 v243, v38, v39
v_accvgpr_read_b32 v52, a72
v_accvgpr_read_b32 v53, a73
v_accvgpr_read_b32 v54, a74
v_accvgpr_read_b32 v55, a75
v_pk_add_f32 v[52:53], v[52:53], v[72:73]
v_pk_add_f32 v[54:55], v[54:55], v[74:75]
v_accvgpr_read_b32 v244, a88
v_accvgpr_read_b32 v245, a89
v_accvgpr_read_b32 v246, a90
v_accvgpr_read_b32 v247, a91
s_waitcnt lgkmcnt(1)
v_pk_add_f32 v[244:245], v[244:245], v[88:89]
v_pk_add_f32 v[246:247], v[246:247], v[90:91]
M v[24:27], a[112:115], v[240:243], v[24:27]
buffer_store_dwordx4 v[240:243], v1, s[16:19], s38 offen offset:3072 sc1
v_pk_mul_f32 v[52:53], v[52:53], v[10:11] op_sel:[0,0] op_sel_hi:[1,0]
v_pk_mul_f32 v[54:55], v[54:55], v[10:11] op_sel:[0,0] op_sel_hi:[1,0]
v_pk_mul_f32 v[244:245], v[244:245], v[10:11] op_sel:[0,0] op_sel_hi:[1,0]
v_pk_mul_f32 v[246:247], v[246:247], v[10:11] op_sel:[0,0] op_sel_hi:[1,0]
v_cvt_pk_bf16_f32 v52, v52, v53
v_cvt_pk_bf16_f32 v53, v54, v55
v_cvt_pk_bf16_f32 v54, v244, v245
v_cvt_pk_bf16_f32 v55, v246, v247
v_accvgpr_read_b32 v40, a76
v_accvgpr_read_b32 v41, a77
v_accvgpr_read_b32 v42, a78
v_accvgpr_read_b32 v43, a79
v_pk_add_f32 v[40:41], v[40:41], v[76:77]
v_pk_add_f32 v[42:43], v[42:43], v[78:79]
v_accvgpr_read_b32 v56, a92
v_accvgpr_read_b32 v57, a93
v_accvgpr_read_b32 v58, a94
v_accvgpr_read_b32 v59, a95
s_waitcnt lgkmcnt(0)
v_pk_add_f32 v[56:57], v[56:57], v[92:93]
v_pk_add_f32 v[58:59], v[58:59], v[94:95]
M v[24:27], a[112:115], v[52:55], v[24:27]
buffer_store_dwordx4 v[52:55], v1, s[16:19], s39 offen offset:1024 sc1
v_pk_mul_f32 v[40:41], v[40:41], v[10:11] op_sel:[0,1] op_sel_hi:[1,1]
v_pk_mul_f32 v[42:43], v[42:43], v[10:11] op_sel:[0,1] op_sel_hi:[1,1]
v_pk_mul_f32 v[56:57], v[56:57], v[10:11] op_sel:[0,1] op_sel_hi:[1,1]
v_pk_mul_f32 v[58:59], v[58:59], v[10:11] op_sel:[0,1] op_sel_hi:[1,1]
v_cvt_pk_bf16_f32 v40, v40, v41
v_cvt_pk_bf16_f32 v41, v42, v43
v_cvt_pk_bf16_f32 v42, v56, v57
v_cvt_pk_bf16_f32 v43, v58, v59
s_nop 1
M v[24:27], a[112:115], v[40:43], v[24:27]
buffer_store_dwordx4 v[40:43], v1, s[16:19], s39 offen offset:3072 sc1
v_cmp_lt_u32 vcc, 0x3c000000, v12
s_nop 5
v_cmp_class_f32 s[40:41], v24, s64
s_nop 0
s_or_b64 vcc, vcc, s[40:41]
s_cmp_lg_u64 vcc, 0
s_cselect_b32 s33, 2, 0
s_or_b32 s60, s60, s33
Lk2_chk:
s_cmp_eq_u32 s60, 0
s_cbranch_scc1 Lk2_done
s_sub_u32 s56, 15, s21
s_lshl_b32 s33, s24, 1
s_lshl_b32 s61, 3, s33
s_and_b32 s34, s60, 2
s_bitcmp1_b32 s60, 0
s_cselect_b32 s56, s21, s56
s_cselect_b32 s61, 15, s61
s_cselect_b32 s60, s34, 0
s_waitcnt vmcnt(0)
s_lshl_b32 s33, s20, 7
s_lshl_b32 s34, s56, 3
s_add_u32 s33, s33, s34
s_lshl_b32 s34, s23, 2
s_add_u32 s33, s33, s34
s_lshl_b32 s33, s33, 12
buffer_load_dwordx4 a[0:3], v1, s[8:11], s33 offen offset:0 sc1
buffer_load_dwordx4 a[4:7], v1, s[8:11], s33 offen offset:1024 sc1
buffer_load_dwordx4 a[8:11], v1, s[8:11], s33 offen offset:2048 sc1
buffer_load_dwordx4 a[12:15], v1, s[8:11], s33 offen offset:3072 sc1
s_add_u32 s33, s33, 4096
buffer_load_dwordx4 a[16:19], v1, s[8:11], s33 offen offset:0 sc1
buffer_load_dwordx4 a[20:23], v1, s[8:11], s33 offen offset:1024 sc1
buffer_load_dwordx4 a[24:27], v1, s[8:11], s33 offen offset:2048 sc1
buffer_load_dwordx4 a[28:31], v1, s[8:11], s33 offen offset:3072 sc1
s_add_u32 s33, s33, 4096
buffer_load_dwordx4 a[32:35], v1, s[8:11], s33 offen offset:0 sc1
buffer_load_dwordx4 a[36:39], v1, s[8:11], s33 offen offset:1024 sc1
buffer_load_dwordx4 a[40:43], v1, s[8:11], s33 offen offset:2048 sc1
buffer_load_dwordx4 a[44:47], v1, s[8:11], s33 offen offset:3072 sc1
s_add_u32 s33, s33, 4096
buffer_load_dwordx4 a[48:51], v1, s[8:11], s33 offen offset:0 sc1
buffer_load_dwordx4 a[52:55], v1, s[8:11], s33 offen offset:1024 sc1
buffer_load_dwordx4 a[56:59], v1, s[8:11], s33 offen offset:2048 sc1
buffer_load_dwordx4 a[60:63], v1, s[8:11], s33 offen offset:3072 sc1
v_accvgpr_write_b32 a64, 0
v_accvgpr_write_b32 a65, 0
v_accvgpr_write_b32 a66, 0
v_accvgpr_write_b32 a67, 0
v_accvgpr_write_b32 a68, 0
v_accvgpr_write_b32 a69, 0
v_accvgpr_write_b32 a70, 0
v_accvgpr_write_b32 a71, 0
v_accvgpr_write_b32 a72, 0
v_accvgpr_write_b32 a73, 0
v_accvgpr_write_b32 a74, 0
v_accvgpr_write_b32 a75, 0
v_accvgpr_write_b32 a76, 0
v_accvgpr_write_b32 a77, 0
v_accvgpr_write_b32 a78, 0
v_accvgpr_write_b32 a79, 0
v_accvgpr_write_b32 a80, 0
v_accvgpr_write_b32 a81, 0
v_accvgpr_write_b32 a82, 0
v_accvgpr_write_b32 a83, 0
v_accvgpr_write_b32 a84, 0
v_accvgpr_write_b32 a85, 0
v_accvgpr_write_b32 a86, 0
v_accvgpr_write_b32 a87, 0
v_accvgpr_write_b32 a88, 0
v_accvgpr_write_b32 a89, 0
v_accvgpr_write_b32 a90, 0
v_accvgpr_write_b32 a91, 0
v_accvgpr_write_b32 a92, 0
v_accvgpr_write_b32 a93, 0
v_accvgpr_write_b32 a94, 0
v_accvgpr_write_b32 a95, 0
v_accvgpr_write_b32 a96, 0
v_accvgpr_write_b32 a97, 0
v_accvgpr_write_b32 a98, 0
v_accvgpr_write_b32 a99, 0
v_accvgpr_write_b32 a100, 0
v_accvgpr_write_b32 a101, 0
v_accvgpr_write_b32 a102, 0
v_accvgpr_write_b32 a103, 0
v_accvgpr_write_b32 a104, 0
v_accvgpr_write_b32 a105, 0
v_accvgpr_write_b32 a106, 0
v_accvgpr_write_b32 a107, 0
v_accvgpr_write_b32 a108, 0
v_accvgpr_write_b32 a109, 0
v_accvgpr_write_b32 a110, 0
v_accvgpr_write_b32 a111, 0
v_mov_b32 v160, 0
v_mov_b32 v161, 0
v_mov_b32 v162, 0
v_mov_b32 v163, 0
v_mov_b32 v164, 0
v_mov_b32 v165, 0
v_mov_b32 v166, 0
v_mov_b32 v167, 0
v_mov_b32 v168, 0
v_mov_b32 v169, 0
v_mov_b32 v170, 0
v_mov_b32 v171, 0
v_mov_b32 v172, 0
v_mov_b32 v173, 0
v_mov_b32 v174, 0
v_mov_b32 v175, 0
v_mov_b32 v176, 0
v_mov_b32 v177, 0
v_mov_b32 v178, 0
v_mov_b32 v179, 0
v_mov_b32 v180, 0
v_mov_b32 v181, 0
v_mov_b32 v182, 0
v_mov_b32 v183, 0
v_mov_b32 v184, 0
v_mov_b32 v185, 0
v_mov_b32 v186, 0
v_mov_b32 v187, 0
v_mov_b32 v188, 0
v_mov_b32 v189, 0
v_mov_b32 v190, 0
v_mov_b32 v191, 0
v_mov_b32 v192, 0
v_mov_b32 v193, 0
v_mov_b32 v194, 0
v_mov_b32 v195, 0
v_mov_b32 v196, 0
v_mov_b32 v197, 0
v_mov_b32 v198, 0
v_mov_b32 v199, 0
v_mov_b32 v200, 0
v_mov_b32 v201, 0
v_mov_b32 v202, 0
v_mov_b32 v203, 0
v_mov_b32 v204, 0
v_mov_b32 v205, 0
v_mov_b32 v206, 0
v_mov_b32 v207, 0
v_mov_b32 v208, 0
v_mov_b32 v209, 0
v_mov_b32 v210, 0
v_mov_b32 v211, 0
v_mov_b32 v212, 0
v_mov_b32 v213, 0
v_mov_b32 v214, 0
v_mov_b32 v215, 0
v_mov_b32 v216, 0
v_mov_b32 v217, 0
v_mov_b32 v218, 0
v_mov_b32 v219, 0
v_mov_b32 v220, 0
v_mov_b32 v221, 0
v_mov_b32 v222, 0
v_mov_b32 v223, 0
v_mov_b32 v224, 0
v_mov_b32 v225, 0
v_mov_b32 v226, 0
v_mov_b32 v227, 0
v_mov_b32 v228, 0
v_mov_b32 v229, 0
v_mov_b32 v230, 0
v_mov_b32 v231, 0
v_mov_b32 v232, 0
v_mov_b32 v233, 0
v_mov_b32 v234, 0
v_mov_b32 v235, 0
v_mov_b32 v236, 0
v_mov_b32 v237, 0
v_mov_b32 v238, 0
v_mov_b32 v239, 0
v_mov_b32 v240, 0
v_mov_b32 v241, 0
v_mov_b32 v242, 0
v_mov_b32 v243, 0
v_mov_b32 v244, 0
v_mov_b32 v245, 0
v_mov_b32 v246, 0
v_mov_b32 v247, 0
v_mov_b32 v248, 0
v_mov_b32 v249, 0
v_mov_b32 v250, 0
v_mov_b32 v251, 0
v_mov_b32 v252, 0
v_mov_b32 v253, 0
v_mov_b32 v254, 0
v_mov_b32 v255, 0
v_mov_b32 v8, v4
v_mov_b32 v9, v4
v_mov_b32 v10, v4
v_mov_b32 v11, v4
s_lshl_b32 s57, s20, 20
s_lshl_b32 s58, s56, 7
s_lshl_b32 s59, s56, 1
s_add_u32 s59, s59, 2
Lslow_2:
s_add_u32 s35, s57, 0
buffer_load_dwordx4 v[96:99], v1, s[12:15], s35 offen offset:0 sc1
buffer_load_dwordx4 v[100:103], v1, s[12:15], s35 offen offset:1024 sc1
buffer_load_dwordx4 v[104:107], v1, s[12:15], s35 offen offset:2048 sc1
buffer_load_dwordx4 v[108:111], v1, s[12:15], s35 offen offset:3072 sc1
s_add_u32 s35, s57, 4096
buffer_load_dwordx4 v[112:115], v1, s[12:15], s35 offen offset:0 sc1
buffer_load_dwordx4 v[116:119], v1, s[12:15], s35 offen offset:1024 sc1
buffer_load_dwordx4 v[120:123], v1, s[12:15], s35 offen offset:2048 sc1
buffer_load_dwordx4 v[124:127], v1, s[12:15], s35 offen offset:3072 sc1
s_add_u32 s35, s57, 8192
buffer_load_dwordx4 v[128:131], v1, s[12:15], s35 offen offset:0 sc1
buffer_load_dwordx4 v[132:135], v1, s[12:15], s35 offen offset:1024 sc1
buffer_load_dwordx4 v[136:139], v1, s[12:15], s35 offen offset:2048 sc1
buffer_load_dwordx4 v[140:143], v1, s[12:15], s35 offen offset:3072 sc1
s_add_u32 s35, s57, 12288
buffer_load_dwordx4 v[144:147], v1, s[12:15], s35 offen offset:0 sc1
buffer_load_dwordx4 v[148:151], v1, s[12:15], s35 offen offset:1024 sc1
buffer_load_dwordx4 v[152:155], v1, s[12:15], s35 offen offset:2048 sc1
buffer_load_dwordx4 v[156:159], v1, s[12:15], s35 offen offset:3072 sc1
s_lshl_b32 s33, s23, 6
s_add_i32 s33, s33, s58
s_cmp_gt_i32 s33, 0
s_cselect_b32 s34, 0, 0xf149f2ca
s_cmp_lt_i32 s33, 0
s_cselect_b32 s33, 0xf149f2ca, 0
v_mov_b32 v20, s34
v_mov_b32 v21, s34
v_mov_b32 v22, s34
v_mov_b32 v23, s34
v_mov_b32 v28, s33
v_mov_b32 v29, s33
v_mov_b32 v30, s33
v_mov_b32 v31, s33
v_med3_f32 v24, v16, v20, v28
v_med3_f32 v25, v17, v20, v28
v_med3_f32 v26, v18, v20, v28
v_med3_f32 v27, v19, v20, v28
s_waitcnt vmcnt(0)
s_nop 0
M v[32:35], v[96:99], a[0:3], v[24:27]
M v[32:35], v[100:103], a[4:7], v[32:35]
M v[32:35], v[104:107], a[8:11], v[32:35]
M v[32:35], v[108:111], a[12:15], v[32:35]
M v[36:39], v[96:99], a[16:19], v[28:31]
M v[36:39], v[100:103], a[20:23], v[36:39]
M v[36:39], v[104:107], a[24:27], v[36:39]
M v[36:39], v[108:111], a[28:31], v[36:39]
M v[40:43], v[96:99], a[32:35], v[28:31]
M v[40:43], v[100:103], a[36:39], v[40:43]
M v[40:43], v[104:107], a[40:43], v[40:43]
M v[40:43], v[108:111], a[44:47], v[40:43]
M v[44:47], v[96:99], a[48:51], v[28:31]
M v[44:47], v[100:103], a[52:55], v[44:47]
M v[44:47], v[104:107], a[56:59], v[44:47]
M v[44:47], v[108:111], a[60:63], v[44:47]
M v[48:51], v[112:115], a[0:3], v[20:23]
M v[48:51], v[116:119], a[4:7], v[48:51]
M v[48:51], v[120:123], a[8:11], v[48:51]
M v[48:51], v[124:127], a[12:15], v[48:51]
M v[52:55], v[112:115], a[16:19], v[24:27]
M v[52:55], v[116:119], a[20:23], v[52:55]
M v[52:55], v[120:123], a[24:27], v[52:55]
M v[52:55], v[124:127], a[28:31], v[52:55]
M v[56:59], v[112:115], a[32:35], v[28:31]
M v[56:59], v[116:119], a[36:39], v[56:59]
M v[56:59], v[120:123], a[40:43], v[56:59]
M v[56:59], v[124:127], a[44:47], v[56:59]
M v[60:63], v[112:115], a[48:51], v[28:31]
M v[60:63], v[116:119], a[52:55], v[60:63]
M v[60:63], v[120:123], a[56:59], v[60:63]
M v[60:63], v[124:127], a[60:63], v[60:63]
M v[64:67], v[128:131], a[0:3], v[20:23]
M v[64:67], v[132:135], a[4:7], v[64:67]
M v[64:67], v[136:139], a[8:11], v[64:67]
M v[64:67], v[140:143], a[12:15], v[64:67]
M v[68:71], v[128:131], a[16:19], v[20:23]
M v[68:71], v[132:135], a[20:23], v[68:71]
M v[68:71], v[136:139], a[24:27], v[68:71]
M v[68:71], v[140:143], a[28:31], v[68:71]
M v[72:75], v[128:131], a[32:35], v[24:27]
M v[72:75], v[132:135], a[36:39], v[72:75]
M v[72:75], v[136:139], a[40:43], v[72:75]
M v[72:75], v[140:143], a[44:47], v[72:75]
M v[76:79], v[128:131], a[48:51], v[28:31]
M v[76:79], v[132:135], a[52:55], v[76:79]
M v[76:79], v[136:139], a[56:59], v[76:79]
M v[76:79], v[140:143], a[60:63], v[76:79]
M v[80:83], v[144:147], a[0:3], v[20:23]
M v[80:83], v[148:151], a[4:7], v[80:83]
M v[80:83], v[152:155], a[8:11], v[80:83]
M v[80:83], v[156:159], a[12:15], v[80:83]
M v[84:87], v[144:147], a[16:19], v[20:23]
M v[84:87], v[148:151], a[20:23], v[84:87]
M v[84:87], v[152:155], a[24:27], v[84:87]
M v[84:87], v[156:159], a[28:31], v[84:87]
M v[88:91], v[144:147], a[32:35], v[20:23]
M v[88:91], v[148:151], a[36:39], v[88:91]
M v[88:91], v[152:155], a[40:43], v[88:91]
M v[88:91], v[156:159], a[44:47], v[88:91]
M v[92:95], v[144:147], a[48:51], v[24:27]
M v[92:95], v[148:151], a[52:55], v[92:95]
M v[92:95], v[152:155], a[56:59], v[92:95]
M v[92:95], v[156:159], a[60:63], v[92:95]
s_nop 7
s_add_u32 s35, s57, 16384
buffer_load_dwordx4 v[96:99], v1, s[12:15], s35 offen offset:0 sc1
buffer_load_dwordx4 v[100:103], v1, s[12:15], s35 offen offset:1024 sc1
buffer_load_dwordx4 v[104:107], v1, s[12:15], s35 offen offset:2048 sc1
buffer_load_dwordx4 v[108:111], v1, s[12:15], s35 offen offset:3072 sc1
s_add_u32 s35, s57, 20480
buffer_load_dwordx4 v[112:115], v1, s[12:15], s35 offen offset:0 sc1
buffer_load_dwordx4 v[116:119], v1, s[12:15], s35 offen offset:1024 sc1
buffer_load_dwordx4 v[120:123], v1, s[12:15], s35 offen offset:2048 sc1
buffer_load_dwordx4 v[124:127], v1, s[12:15], s35 offen offset:3072 sc1
s_add_u32 s35, s57, 24576
buffer_load_dwordx4 v[128:131], v1, s[12:15], s35 offen offset:0 sc1
buffer_load_dwordx4 v[132:135], v1, s[12:15], s35 offen offset:1024 sc1
buffer_load_dwordx4 v[136:139], v1, s[12:15], s35 offen offset:2048 sc1
buffer_load_dwordx4 v[140:143], v1, s[12:15], s35 offen offset:3072 sc1
s_add_u32 s35, s57, 28672
buffer_load_dwordx4 v[144:147], v1, s[12:15], s35 offen offset:0 sc1
buffer_load_dwordx4 v[148:151], v1, s[12:15], s35 offen offset:1024 sc1
buffer_load_dwordx4 v[152:155], v1, s[12:15], s35 offen offset:2048 sc1
buffer_load_dwordx4 v[156:159], v1, s[12:15], s35 offen offset:3072 sc1
v_max3_f32 v13, v32, v33, v8
v_max3_f32 v13, v13, v34, v35
v_max3_f32 v13, v13, v48, v49
v_max3_f32 v13, v13, v50, v51
v_max3_f32 v13, v13, v64, v65
v_max3_f32 v13, v13, v66, v67
v_max3_f32 v13, v13, v80, v81
v_max3_f32 v13, v13, v82, v83
v_mov_b32 v14, v13
s_nop 1
v_permlane16_swap_b32 v13, v14
v_max_f32 v13, v13, v14
v_mov_b32 v14, v13
s_nop 1
v_permlane32_swap_b32 v13, v14
v_max_f32 v13, v13, v14
v_sub_f32 v12, v8, v13
v_exp_f32 v12, v12
v_mov_b32 v8, v13
v_sub_f32 v32, v32, v13
v_sub_f32 v33, v33, v13
v_sub_f32 v34, v34, v13
v_sub_f32 v35, v35, v13
v_sub_f32 v48, v48, v13
v_sub_f32 v49, v49, v13
v_sub_f32 v50, v50, v13
v_sub_f32 v51, v51, v13
v_sub_f32 v64, v64, v13
v_sub_f32 v65, v65, v13
v_sub_f32 v66, v66, v13
v_sub_f32 v67, v67, v13
v_sub_f32 v80, v80, v13
v_sub_f32 v81, v81, v13
v_sub_f32 v82, v82, v13
v_sub_f32 v83, v83, v13
v_mul_f32 v160, v160, v12
v_mul_f32 v161, v161, v12
v_mul_f32 v162, v162, v12
v_mul_f32 v163, v163, v12
v_mul_f32 v176, v176, v12
v_mul_f32 v177, v177, v12
v_mul_f32 v178, v178, v12
v_mul_f32 v179, v179, v12
v_mul_f32 v192, v192, v12
v_mul_f32 v193, v193, v12
v_mul_f32 v194, v194, v12
v_mul_f32 v195, v195, v12
v_mul_f32 v208, v208, v12
v_mul_f32 v209, v209, v12
v_mul_f32 v210, v210, v12
v_mul_f32 v211, v211, v12
v_mul_f32 v224, v224, v12
v_mul_f32 v225, v225, v12
v_mul_f32 v226, v226, v12
v_mul_f32 v227, v227, v12
v_mul_f32 v240, v240, v12
v_mul_f32 v241, v241, v12
v_mul_f32 v242, v242, v12
v_mul_f32 v243, v243, v12
v_accvgpr_read_b32 v14, a64
v_mul_f32 v14, v14, v12
v_accvgpr_write_b32 a64, v14
v_accvgpr_read_b32 v14, a65
v_mul_f32 v14, v14, v12
v_accvgpr_write_b32 a65, v14
v_accvgpr_read_b32 v14, a66
v_mul_f32 v14, v14, v12
v_accvgpr_write_b32 a66, v14
v_accvgpr_read_b32 v14, a67
v_mul_f32 v14, v14, v12
v_accvgpr_write_b32 a67, v14
v_accvgpr_read_b32 v14, a80
v_mul_f32 v14, v14, v12
v_accvgpr_write_b32 a80, v14
v_accvgpr_read_b32 v14, a81
v_mul_f32 v14, v14, v12
v_accvgpr_write_b32 a81, v14
v_accvgpr_read_b32 v14, a82
v_mul_f32 v14, v14, v12
v_accvgpr_write_b32 a82, v14
v_accvgpr_read_b32 v14, a83
v_mul_f32 v14, v14, v12
v_accvgpr_write_b32 a83, v14
v_accvgpr_read_b32 v14, a96
v_mul_f32 v14, v14, v12
v_accvgpr_write_b32 a96, v14
v_accvgpr_read_b32 v14, a97
v_mul_f32 v14, v14, v12
v_accvgpr_write_b32 a97, v14
v_accvgpr_read_b32 v14, a98
v_mul_f32 v14, v14, v12
v_accvgpr_write_b32 a98, v14
v_accvgpr_read_b32 v14, a99
v_mul_f32 v14, v14, v12
v_accvgpr_write_b32 a99, v14
v_max3_f32 v13, v36, v37, v9
v_max3_f32 v13, v13, v38, v39
v_max3_f32 v13, v13, v52, v53
v_max3_f32 v13, v13, v54, v55
v_max3_f32 v13, v13, v68, v69
v_max3_f32 v13, v13, v70, v71
v_max3_f32 v13, v13, v84, v85
v_max3_f32 v13, v13, v86, v87
v_mov_b32 v14, v13
s_nop 1
v_permlane16_swap_b32 v13, v14
v_max_f32 v13, v13, v14
v_mov_b32 v14, v13
s_nop 1
v_permlane32_swap_b32 v13, v14
v_max_f32 v13, v13, v14
v_sub_f32 v12, v9, v13
v_exp_f32 v12, v12
v_mov_b32 v9, v13
v_sub_f32 v36, v36, v13
v_sub_f32 v37, v37, v13
v_sub_f32 v38, v38, v13
v_sub_f32 v39, v39, v13
v_sub_f32 v52, v52, v13
v_sub_f32 v53, v53, v13
v_sub_f32 v54, v54, v13
v_sub_f32 v55, v55, v13
v_sub_f32 v68, v68, v13
v_sub_f32 v69, v69, v13
v_sub_f32 v70, v70, v13
v_sub_f32 v71, v71, v13
v_sub_f32 v84, v84, v13
v_sub_f32 v85, v85, v13
v_sub_f32 v86, v86, v13
v_sub_f32 v87, v87, v13
v_mul_f32 v164, v164, v12
v_mul_f32 v165, v165, v12
v_mul_f32 v166, v166, v12
v_mul_f32 v167, v167, v12
v_mul_f32 v180, v180, v12
v_mul_f32 v181, v181, v12
v_mul_f32 v182, v182, v12
v_mul_f32 v183, v183, v12
v_mul_f32 v196, v196, v12
v_mul_f32 v197, v197, v12
v_mul_f32 v198, v198, v12
v_mul_f32 v199, v199, v12
v_mul_f32 v212, v212, v12
v_mul_f32 v213, v213, v12
v_mul_f32 v214, v214, v12
v_mul_f32 v215, v215, v12
v_mul_f32 v228, v228, v12
v_mul_f32 v229, v229, v12
v_mul_f32 v230, v230, v12
v_mul_f32 v231, v231, v12
v_mul_f32 v244, v244, v12
v_mul_f32 v245, v245, v12
v_mul_f32 v246, v246, v12
v_mul_f32 v247, v247, v12
v_accvgpr_read_b32 v14, a68
v_mul_f32 v14, v14, v12
v_accvgpr_write_b32 a68, v14
v_accvgpr_read_b32 v14, a69
v_mul_f32 v14, v14, v12
v_accvgpr_write_b32 a69, v14
v_accvgpr_read_b32 v14, a70
v_mul_f32 v14, v14, v12
v_accvgpr_write_b32 a70, v14
v_accvgpr_read_b32 v14, a71
v_mul_f32 v14, v14, v12
v_accvgpr_write_b32 a71, v14
v_accvgpr_read_b32 v14, a84
v_mul_f32 v14, v14, v12
v_accvgpr_write_b32 a84, v14
v_accvgpr_read_b32 v14, a85
v_mul_f32 v14, v14, v12
v_accvgpr_write_b32 a85, v14
v_accvgpr_read_b32 v14, a86
v_mul_f32 v14, v14, v12
v_accvgpr_write_b32 a86, v14
v_accvgpr_read_b32 v14, a87
v_mul_f32 v14, v14, v12
v_accvgpr_write_b32 a87, v14
v_accvgpr_read_b32 v14, a100
v_mul_f32 v14, v14, v12
v_accvgpr_write_b32 a100, v14
v_accvgpr_read_b32 v14, a101
v_mul_f32 v14, v14, v12
v_accvgpr_write_b32 a101, v14
v_accvgpr_read_b32 v14, a102
v_mul_f32 v14, v14, v12
v_accvgpr_write_b32 a102, v14
v_accvgpr_read_b32 v14, a103
v_mul_f32 v14, v14, v12
v_accvgpr_write_b32 a103, v14
v_max3_f32 v13, v40, v41, v10
v_max3_f32 v13, v13, v42, v43
v_max3_f32 v13, v13, v56, v57
v_max3_f32 v13, v13, v58, v59
v_max3_f32 v13, v13, v72, v73
v_max3_f32 v13, v13, v74, v75
v_max3_f32 v13, v13, v88, v89
v_max3_f32 v13, v13, v90, v91
v_mov_b32 v14, v13
s_nop 1
v_permlane16_swap_b32 v13, v14
v_max_f32 v13, v13, v14
v_mov_b32 v14, v13
s_nop 1
v_permlane32_swap_b32 v13, v14
v_max_f32 v13, v13, v14
v_sub_f32 v12, v10, v13
v_exp_f32 v12, v12
v_mov_b32 v10, v13
v_sub_f32 v40, v40, v13
v_sub_f32 v41, v41, v13
v_sub_f32 v42, v42, v13
v_sub_f32 v43, v43, v13
v_sub_f32 v56, v56, v13
v_sub_f32 v57, v57, v13
v_sub_f32 v58, v58, v13
v_sub_f32 v59, v59, v13
v_sub_f32 v72, v72, v13
v_sub_f32 v73, v73, v13
v_sub_f32 v74, v74, v13
v_sub_f32 v75, v75, v13
v_sub_f32 v88, v88, v13
v_sub_f32 v89, v89, v13
v_sub_f32 v90, v90, v13
v_sub_f32 v91, v91, v13
v_mul_f32 v168, v168, v12
v_mul_f32 v169, v169, v12
v_mul_f32 v170, v170, v12
v_mul_f32 v171, v171, v12
v_mul_f32 v184, v184, v12
v_mul_f32 v185, v185, v12
v_mul_f32 v186, v186, v12
v_mul_f32 v187, v187, v12
v_mul_f32 v200, v200, v12
v_mul_f32 v201, v201, v12
v_mul_f32 v202, v202, v12
v_mul_f32 v203, v203, v12
v_mul_f32 v216, v216, v12
v_mul_f32 v217, v217, v12
v_mul_f32 v218, v218, v12
v_mul_f32 v219, v219, v12
v_mul_f32 v232, v232, v12
v_mul_f32 v233, v233, v12
v_mul_f32 v234, v234, v12
v_mul_f32 v235, v235, v12
v_mul_f32 v248, v248, v12
v_mul_f32 v249, v249, v12
v_mul_f32 v250, v250, v12
v_mul_f32 v251, v251, v12
v_accvgpr_read_b32 v14, a72
v_mul_f32 v14, v14, v12
v_accvgpr_write_b32 a72, v14
v_accvgpr_read_b32 v14, a73
v_mul_f32 v14, v14, v12
v_accvgpr_write_b32 a73, v14
v_accvgpr_read_b32 v14, a74
v_mul_f32 v14, v14, v12
v_accvgpr_write_b32 a74, v14
v_accvgpr_read_b32 v14, a75
v_mul_f32 v14, v14, v12
v_accvgpr_write_b32 a75, v14
v_accvgpr_read_b32 v14, a88
v_mul_f32 v14, v14, v12
v_accvgpr_write_b32 a88, v14
v_accvgpr_read_b32 v14, a89
v_mul_f32 v14, v14, v12
v_accvgpr_write_b32 a89, v14
v_accvgpr_read_b32 v14, a90
v_mul_f32 v14, v14, v12
v_accvgpr_write_b32 a90, v14
v_accvgpr_read_b32 v14, a91
v_mul_f32 v14, v14, v12
v_accvgpr_write_b32 a91, v14
v_accvgpr_read_b32 v14, a104
v_mul_f32 v14, v14, v12
v_accvgpr_write_b32 a104, v14
v_accvgpr_read_b32 v14, a105
v_mul_f32 v14, v14, v12
v_accvgpr_write_b32 a105, v14
v_accvgpr_read_b32 v14, a106
v_mul_f32 v14, v14, v12
v_accvgpr_write_b32 a106, v14
v_accvgpr_read_b32 v14, a107
v_mul_f32 v14, v14, v12
v_accvgpr_write_b32 a107, v14
v_max3_f32 v13, v44, v45, v11
v_max3_f32 v13, v13, v46, v47
v_max3_f32 v13, v13, v60, v61
v_max3_f32 v13, v13, v62, v63
v_max3_f32 v13, v13, v76, v77
v_max3_f32 v13, v13, v78, v79
v_max3_f32 v13, v13, v92, v93
v_max3_f32 v13, v13, v94, v95
v_mov_b32 v14, v13
s_nop 1
v_permlane16_swap_b32 v13, v14
v_max_f32 v13, v13, v14
v_mov_b32 v14, v13
s_nop 1
v_permlane32_swap_b32 v13, v14
v_max_f32 v13, v13, v14
v_sub_f32 v12, v11, v13
v_exp_f32 v12, v12
v_mov_b32 v11, v13
v_sub_f32 v44, v44, v13
v_sub_f32 v45, v45, v13
v_sub_f32 v46, v46, v13
v_sub_f32 v47, v47, v13
v_sub_f32 v60, v60, v13
v_sub_f32 v61, v61, v13
v_sub_f32 v62, v62, v13
v_sub_f32 v63, v63, v13
v_sub_f32 v76, v76, v13
v_sub_f32 v77, v77, v13
v_sub_f32 v78, v78, v13
v_sub_f32 v79, v79, v13
v_sub_f32 v92, v92, v13
v_sub_f32 v93, v93, v13
v_sub_f32 v94, v94, v13
v_sub_f32 v95, v95, v13
v_mul_f32 v172, v172, v12
v_mul_f32 v173, v173, v12
v_mul_f32 v174, v174, v12
v_mul_f32 v175, v175, v12
v_mul_f32 v188, v188, v12
v_mul_f32 v189, v189, v12
v_mul_f32 v190, v190, v12
v_mul_f32 v191, v191, v12
v_mul_f32 v204, v204, v12
v_mul_f32 v205, v205, v12
v_mul_f32 v206, v206, v12
v_mul_f32 v207, v207, v12
v_mul_f32 v220, v220, v12
v_mul_f32 v221, v221, v12
v_mul_f32 v222, v222, v12
v_mul_f32 v223, v223, v12
v_mul_f32 v236, v236, v12
v_mul_f32 v237, v237, v12
v_mul_f32 v238, v238, v12
v_mul_f32 v239, v239, v12
v_mul_f32 v252, v252, v12
v_mul_f32 v253, v253, v12
v_mul_f32 v254, v254, v12
v_mul_f32 v255, v255, v12
v_accvgpr_read_b32 v14, a76
v_mul_f32 v14, v14, v12
v_accvgpr_write_b32 a76, v14
v_accvgpr_read_b32 v14, a77
v_mul_f32 v14, v14, v12
v_accvgpr_write_b32 a77, v14
v_accvgpr_read_b32 v14, a78
v_mul_f32 v14, v14, v12
v_accvgpr_write_b32 a78, v14
v_accvgpr_read_b32 v14, a79
v_mul_f32 v14, v14, v12
v_accvgpr_write_b32 a79, v14
v_accvgpr_read_b32 v14, a92
v_mul_f32 v14, v14, v12
v_accvgpr_write_b32 a92, v14
v_accvgpr_read_b32 v14, a93
v_mul_f32 v14, v14, v12
v_accvgpr_write_b32 a93, v14
v_accvgpr_read_b32 v14, a94
v_mul_f32 v14, v14, v12
v_accvgpr_write_b32 a94, v14
v_accvgpr_read_b32 v14, a95
v_mul_f32 v14, v14, v12
v_accvgpr_write_b32 a95, v14
v_accvgpr_read_b32 v14, a108
v_mul_f32 v14, v14, v12
v_accvgpr_write_b32 a108, v14
v_accvgpr_read_b32 v14, a109
v_mul_f32 v14, v14, v12
v_accvgpr_write_b32 a109, v14
v_accvgpr_read_b32 v14, a110
v_mul_f32 v14, v14, v12
v_accvgpr_write_b32 a110, v14
v_accvgpr_read_b32 v14, a111
v_mul_f32 v14, v14, v12
v_accvgpr_write_b32 a111, v14
v_exp_f32 v32, v32
v_exp_f32 v33, v33
v_exp_f32 v34, v34
v_exp_f32 v35, v35
v_exp_f32 v48, v48
v_exp_f32 v49, v49
v_exp_f32 v50, v50
v_exp_f32 v51, v51
v_cvt_pk_bf16_f32 v32, v32, v33
v_cvt_pk_bf16_f32 v33, v34, v35
v_exp_f32 v36, v36
v_exp_f32 v37, v37
v_exp_f32 v38, v38
v_exp_f32 v39, v39
v_cvt_pk_bf16_f32 v34, v48, v49
v_cvt_pk_bf16_f32 v35, v50, v51
v_exp_f32 v52, v52
v_exp_f32 v53, v53
v_exp_f32 v54, v54
v_exp_f32 v55, v55
v_cvt_pk_bf16_f32 v36, v36, v37
v_cvt_pk_bf16_f32 v37, v38, v39
v_exp_f32 v40, v40
v_exp_f32 v41, v41
v_exp_f32 v42, v42
v_exp_f32 v43, v43
v_cvt_pk_bf16_f32 v38, v52, v53
v_cvt_pk_bf16_f32 v39, v54, v55
v_exp_f32 v56, v56
v_exp_f32 v57, v57
v_exp_f32 v58, v58
v_exp_f32 v59, v59
v_cvt_pk_bf16_f32 v40, v40, v41
v_cvt_pk_bf16_f32 v41, v42, v43
v_exp_f32 v44, v44
v_exp_f32 v45, v45
v_exp_f32 v46, v46
v_exp_f32 v47, v47
v_cvt_pk_bf16_f32 v42, v56, v57
v_cvt_pk_bf16_f32 v43, v58, v59
v_exp_f32 v60, v60
v_exp_f32 v61, v61
v_exp_f32 v62, v62
v_exp_f32 v63, v63
v_cvt_pk_bf16_f32 v44, v44, v45
v_cvt_pk_bf16_f32 v45, v46, v47
v_cvt_pk_bf16_f32 v46, v60, v61
v_cvt_pk_bf16_f32 v47, v62, v63
v_exp_f32 v64, v64
v_exp_f32 v65, v65
v_exp_f32 v66, v66
v_exp_f32 v67, v67
v_exp_f32 v80, v80
v_exp_f32 v81, v81
v_exp_f32 v82, v82
v_exp_f32 v83, v83
v_cvt_pk_bf16_f32 v64, v64, v65
v_cvt_pk_bf16_f32 v65, v66, v67
v_exp_f32 v68, v68
v_exp_f32 v69, v69
v_exp_f32 v70, v70
v_exp_f32 v71, v71
v_cvt_pk_bf16_f32 v66, v80, v81
v_cvt_pk_bf16_f32 v67, v82, v83
v_exp_f32 v84, v84
v_exp_f32 v85, v85
v_exp_f32 v86, v86
v_exp_f32 v87, v87
v_cvt_pk_bf16_f32 v68, v68, v69
v_cvt_pk_bf16_f32 v69, v70, v71
v_exp_f32 v72, v72
v_exp_f32 v73, v73
v_exp_f32 v74, v74
v_exp_f32 v75, v75
v_cvt_pk_bf16_f32 v70, v84, v85
v_cvt_pk_bf16_f32 v71, v86, v87
v_exp_f32 v88, v88
v_exp_f32 v89, v89
v_exp_f32 v90, v90
v_exp_f32 v91, v91
v_cvt_pk_bf16_f32 v72, v72, v73
v_cvt_pk_bf16_f32 v73, v74, v75
v_exp_f32 v76, v76
v_exp_f32 v77, v77
v_exp_f32 v78, v78
v_exp_f32 v79, v79
v_cvt_pk_bf16_f32 v74, v88, v89
v_cvt_pk_bf16_f32 v75, v90, v91
v_exp_f32 v92, v92
v_exp_f32 v93, v93
v_exp_f32 v94, v94
v_exp_f32 v95, v95
v_cvt_pk_bf16_f32 v76, v76, v77
v_cvt_pk_bf16_f32 v77, v78, v79
v_cvt_pk_bf16_f32 v78, v92, v93
v_cvt_pk_bf16_f32 v79, v94, v95
s_waitcnt vmcnt(0)
M a[96:99], a[112:115], v[32:35], a[96:99]
M a[100:103], a[112:115], v[36:39], a[100:103]
M a[104:107], a[112:115], v[40:43], a[104:107]
M a[108:111], a[112:115], v[44:47], a[108:111]
M v[160:163], v[96:99], v[32:35], v[160:163]
M v[164:167], v[96:99], v[36:39], v[164:167]
M v[168:171], v[96:99], v[40:43], v[168:171]
M v[172:175], v[96:99], v[44:47], v[172:175]
M v[176:179], v[100:103], v[32:35], v[176:179]
M v[180:183], v[100:103], v[36:39], v[180:183]
M v[184:187], v[100:103], v[40:43], v[184:187]
M v[188:191], v[100:103], v[44:47], v[188:191]
M v[192:195], v[104:107], v[32:35], v[192:195]
M v[196:199], v[104:107], v[36:39], v[196:199]
M v[200:203], v[104:107], v[40:43], v[200:203]
M v[204:207], v[104:107], v[44:47], v[204:207]
M v[208:211], v[108:111], v[32:35], v[208:211]
M v[212:215], v[108:111], v[36:39], v[212:215]
M v[216:219], v[108:111], v[40:43], v[216:219]
M v[220:223], v[108:111], v[44:47], v[220:223]
M v[224:227], v[112:115], v[32:35], v[224:227]
M v[228:231], v[112:115], v[36:39], v[228:231]
M v[232:235], v[112:115], v[40:43], v[232:235]
M v[236:239], v[112:115], v[44:47], v[236:239]
M v[240:243], v[116:119], v[32:35], v[240:243]
M v[244:247], v[116:119], v[36:39], v[244:247]
M v[248:251], v[116:119], v[40:43], v[248:251]
M v[252:255], v[116:119], v[44:47], v[252:255]
M a[64:67], v[120:123], v[32:35], a[64:67]
M a[68:71], v[120:123], v[36:39], a[68:71]
M a[72:75], v[120:123], v[40:43], a[72:75]
M a[76:79], v[120:123], v[44:47], a[76:79]
M a[80:83], v[124:127], v[32:35], a[80:83]
M a[84:87], v[124:127], v[36:39], a[84:87]
M a[88:91], v[124:127], v[40:43], a[88:91]
M a[92:95], v[124:127], v[44:47], a[92:95]
M a[96:99], a[112:115], v[64:67], a[96:99]
M a[100:103], a[112:115], v[68:71], a[100:103]
M a[104:107], a[112:115], v[72:75], a[104:107]
M a[108:111], a[112:115], v[76:79], a[108:111]
M v[160:163], v[128:131], v[64:67], v[160:163]
M v[164:167], v[128:131], v[68:71], v[164:167]
M v[168:171], v[128:131], v[72:75], v[168:171]
M v[172:175], v[128:131], v[76:79], v[172:175]
M v[176:179], v[132:135], v[64:67], v[176:179]
M v[180:183], v[132:135], v[68:71], v[180:183]
M v[184:187], v[132:135], v[72:75], v[184:187]
M v[188:191], v[132:135], v[76:79], v[188:191]
M v[192:195], v[136:139], v[64:67], v[192:195]
M v[196:199], v[136:139], v[68:71], v[196:199]
M v[200:203], v[136:139], v[72:75], v[200:203]
M v[204:207], v[136:139], v[76:79], v[204:207]
M v[208:211], v[140:143], v[64:67], v[208:211]
M v[212:215], v[140:143], v[68:71], v[212:215]
M v[216:219], v[140:143], v[72:75], v[216:219]
M v[220:223], v[140:143], v[76:79], v[220:223]
M v[224:227], v[144:147], v[64:67], v[224:227]
M v[228:231], v[144:147], v[68:71], v[228:231]
M v[232:235], v[144:147], v[72:75], v[232:235]
M v[236:239], v[144:147], v[76:79], v[236:239]
M v[240:243], v[148:151], v[64:67], v[240:243]
M v[244:247], v[148:151], v[68:71], v[244:247]
M v[248:251], v[148:151], v[72:75], v[248:251]
M v[252:255], v[148:151], v[76:79], v[252:255]
M a[64:67], v[152:155], v[64:67], a[64:67]
M a[68:71], v[152:155], v[68:71], a[68:71]
M a[72:75], v[152:155], v[72:75], a[72:75]
M a[76:79], v[152:155], v[76:79], a[76:79]
M a[80:83], v[156:159], v[64:67], a[80:83]
M a[84:87], v[156:159], v[68:71], a[84:87]
M a[88:91], v[156:159], v[72:75], a[88:91]
M a[92:95], v[156:159], v[76:79], a[92:95]
s_nop 7
s_add_u32 s57, s57, 32768
s_sub_u32 s58, s58, 64
s_sub_u32 s59, s59, 1
s_cmp_lg_u32 s59, 0
s_cbranch_scc1 Lslow_2
v_accvgpr_read_b32 v20, a96
v_accvgpr_read_b32 v21, a100
v_accvgpr_read_b32 v22, a104
v_accvgpr_read_b32 v23, a108
v_rcp_f32 v8, v20
v_rcp_f32 v9, v21
v_rcp_f32 v10, v22
v_rcp_f32 v11, v23
s_lshl_b32 s33, s56, 20
s_lshl_b32 s34, s20, 15
s_add_u32 s33, s33, s34
s_lshl_b32 s34, s23, 13
s_add_u32 s36, s33, s34
s_add_u32 s37, s36, 4096
s_add_u32 s38, s36, 16384
s_add_u32 s39, s36, 20480
v_pk_mul_f32 v[160:161], v[160:161], v[8:9] op_sel:[0,0] op_sel_hi:[1,0]
v_pk_mul_f32 v[162:163], v[162:163], v[8:9] op_sel:[0,0] op_sel_hi:[1,0]
v_pk_mul_f32 v[176:177], v[176:177], v[8:9] op_sel:[0,0] op_sel_hi:[1,0]
v_pk_mul_f32 v[178:179], v[178:179], v[8:9] op_sel:[0,0] op_sel_hi:[1,0]
v_cvt_pk_bf16_f32 v160, v160, v161
v_cvt_pk_bf16_f32 v161, v162, v163
v_cvt_pk_bf16_f32 v162, v176, v177
v_cvt_pk_bf16_f32 v163, v178, v179
v_pk_mul_f32 v[164:165], v[164:165], v[8:9] op_sel:[0,1] op_sel_hi:[1,1]
v_pk_mul_f32 v[166:167], v[166:167], v[8:9] op_sel:[0,1] op_sel_hi:[1,1]
v_pk_mul_f32 v[180:181], v[180:181], v[8:9] op_sel:[0,1] op_sel_hi:[1,1]
v_pk_mul_f32 v[182:183], v[182:183], v[8:9] op_sel:[0,1] op_sel_hi:[1,1]
v_cvt_pk_bf16_f32 v164, v164, v165
v_cvt_pk_bf16_f32 v165, v166, v167
v_cvt_pk_bf16_f32 v166, v180, v181
v_cvt_pk_bf16_f32 v167, v182, v183
v_pk_mul_f32 v[168:169], v[168:169], v[10:11] op_sel:[0,0] op_sel_hi:[1,0]
v_pk_mul_f32 v[170:171], v[170:171], v[10:11] op_sel:[0,0] op_sel_hi:[1,0]
v_pk_mul_f32 v[184:185], v[184:185], v[10:11] op_sel:[0,0] op_sel_hi:[1,0]
v_pk_mul_f32 v[186:187], v[186:187], v[10:11] op_sel:[0,0] op_sel_hi:[1,0]
v_cvt_pk_bf16_f32 v168, v168, v169
v_cvt_pk_bf16_f32 v169, v170, v171
v_cvt_pk_bf16_f32 v170, v184, v185
v_cvt_pk_bf16_f32 v171, v186, v187
v_pk_mul_f32 v[172:173], v[172:173], v[10:11] op_sel:[0,1] op_sel_hi:[1,1]
v_pk_mul_f32 v[174:175], v[174:175], v[10:11] op_sel:[0,1] op_sel_hi:[1,1]
v_pk_mul_f32 v[188:189], v[188:189], v[10:11] op_sel:[0,1] op_sel_hi:[1,1]
v_pk_mul_f32 v[190:191], v[190:191], v[10:11] op_sel:[0,1] op_sel_hi:[1,1]
v_cvt_pk_bf16_f32 v172, v172, v173
v_cvt_pk_bf16_f32 v173, v174, v175
v_cvt_pk_bf16_f32 v174, v188, v189
v_cvt_pk_bf16_f32 v175, v190, v191
v_pk_mul_f32 v[192:193], v[192:193], v[8:9] op_sel:[0,0] op_sel_hi:[1,0]
v_pk_mul_f32 v[194:195], v[194:195], v[8:9] op_sel:[0,0] op_sel_hi:[1,0]
v_pk_mul_f32 v[208:209], v[208:209], v[8:9] op_sel:[0,0] op_sel_hi:[1,0]
v_pk_mul_f32 v[210:211], v[210:211], v[8:9] op_sel:[0,0] op_sel_hi:[1,0]
v_cvt_pk_bf16_f32 v192, v192, v193
v_cvt_pk_bf16_f32 v193, v194, v195
v_cvt_pk_bf16_f32 v194, v208, v209
v_cvt_pk_bf16_f32 v195, v210, v211
v_pk_mul_f32 v[196:197], v[196:197], v[8:9] op_sel:[0,1] op_sel_hi:[1,1]
v_pk_mul_f32 v[198:199], v[198:199], v[8:9] op_sel:[0,1] op_sel_hi:[1,1]
v_pk_mul_f32 v[212:213], v[212:213], v[8:9] op_sel:[0,1] op_sel_hi:[1,1]
v_pk_mul_f32 v[214:215], v[214:215], v[8:9] op_sel:[0,1] op_sel_hi:[1,1]
v_cvt_pk_bf16_f32 v196, v196, v197
v_cvt_pk_bf16_f32 v197, v198, v199
v_cvt_pk_bf16_f32 v198, v212, v213
v_cvt_pk_bf16_f32 v199, v214, v215
v_pk_mul_f32 v[200:201], v[200:201], v[10:11] op_sel:[0,0] op_sel_hi:[1,0]
v_pk_mul_f32 v[202:203], v[202:203], v[10:11] op_sel:[0,0] op_sel_hi:[1,0]
v_pk_mul_f32 v[216:217], v[216:217], v[10:11] op_sel:[0,0] op_sel_hi:[1,0]
v_pk_mul_f32 v[218:219], v[218:219], v[10:11] op_sel:[0,0] op_sel_hi:[1,0]
v_cvt_pk_bf16_f32 v200, v200, v201
v_cvt_pk_bf16_f32 v201, v202, v203
v_cvt_pk_bf16_f32 v202, v216, v217
v_cvt_pk_bf16_f32 v203, v218, v219
v_pk_mul_f32 v[204:205], v[204:205], v[10:11] op_sel:[0,1] op_sel_hi:[1,1]
v_pk_mul_f32 v[206:207], v[206:207], v[10:11] op_sel:[0,1] op_sel_hi:[1,1]
v_pk_mul_f32 v[220:221], v[220:221], v[10:11] op_sel:[0,1] op_sel_hi:[1,1]
v_pk_mul_f32 v[222:223], v[222:223], v[10:11] op_sel:[0,1] op_sel_hi:[1,1]
v_cvt_pk_bf16_f32 v204, v204, v205
v_cvt_pk_bf16_f32 v205, v206, v207
v_cvt_pk_bf16_f32 v206, v220, v221
v_cvt_pk_bf16_f32 v207, v222, v223
v_pk_mul_f32 v[224:225], v[224:225], v[8:9] op_sel:[0,0] op_sel_hi:[1,0]
v_pk_mul_f32 v[226:227], v[226:227], v[8:9] op_sel:[0,0] op_sel_hi:[1,0]
v_pk_mul_f32 v[240:241], v[240:241], v[8:9] op_sel:[0,0] op_sel_hi:[1,0]
v_pk_mul_f32 v[242:243], v[242:243], v[8:9] op_sel:[0,0] op_sel_hi:[1,0]
v_cvt_pk_bf16_f32 v224, v224, v225
v_cvt_pk_bf16_f32 v225, v226, v227
v_cvt_pk_bf16_f32 v226, v240, v241
v_cvt_pk_bf16_f32 v227, v242, v243
v_pk_mul_f32 v[228:229], v[228:229], v[8:9] op_sel:[0,1] op_sel_hi:[1,1]
v_pk_mul_f32 v[230:231], v[230:231], v[8:9] op_sel:[0,1] op_sel_hi:[1,1]
v_pk_mul_f32 v[244:245], v[244:245], v[8:9] op_sel:[0,1] op_sel_hi:[1,1]
v_pk_mul_f32 v[246:247], v[246:247], v[8:9] op_sel:[0,1] op_sel_hi:[1,1]
v_cvt_pk_bf16_f32 v228, v228, v229
v_cvt_pk_bf16_f32 v229, v230, v231
v_cvt_pk_bf16_f32 v230, v244, v245
v_cvt_pk_bf16_f32 v231, v246, v247
v_pk_mul_f32 v[232:233], v[232:233], v[10:11] op_sel:[0,0] op_sel_hi:[1,0]
v_pk_mul_f32 v[234:235], v[234:235], v[10:11] op_sel:[0,0] op_sel_hi:[1,0]
v_pk_mul_f32 v[248:249], v[248:249], v[10:11] op_sel:[0,0] op_sel_hi:[1,0]
v_pk_mul_f32 v[250:251], v[250:251], v[10:11] op_sel:[0,0] op_sel_hi:[1,0]
v_cvt_pk_bf16_f32 v232, v232, v233
v_cvt_pk_bf16_f32 v233, v234, v235
v_cvt_pk_bf16_f32 v234, v248, v249
v_cvt_pk_bf16_f32 v235, v250, v251
v_pk_mul_f32 v[236:237], v[236:237], v[10:11] op_sel:[0,1] op_sel_hi:[1,1]
v_pk_mul_f32 v[238:239], v[238:239], v[10:11] op_sel:[0,1] op_sel_hi:[1,1]
v_pk_mul_f32 v[252:253], v[252:253], v[10:11] op_sel:[0,1] op_sel_hi:[1,1]
v_pk_mul_f32 v[254:255], v[254:255], v[10:11] op_sel:[0,1] op_sel_hi:[1,1]
v_cvt_pk_bf16_f32 v236, v236, v237
v_cvt_pk_bf16_f32 v237, v238, v239
v_cvt_pk_bf16_f32 v238, v252, v253
v_cvt_pk_bf16_f32 v239, v254, v255
v_accvgpr_read_b32 v176, a64
v_accvgpr_read_b32 v177, a65
v_accvgpr_read_b32 v178, a66
v_accvgpr_read_b32 v179, a67
v_accvgpr_read_b32 v180, a80
v_accvgpr_read_b32 v181, a81
v_accvgpr_read_b32 v182, a82
v_accvgpr_read_b32 v183, a83
v_pk_mul_f32 v[176:177], v[176:177], v[8:9] op_sel:[0,0] op_sel_hi:[1,0]
v_pk_mul_f32 v[178:179], v[178:179], v[8:9] op_sel:[0,0] op_sel_hi:[1,0]
v_pk_mul_f32 v[180:181], v[180:181], v[8:9] op_sel:[0,0] op_sel_hi:[1,0]
v_pk_mul_f32 v[182:183], v[182:183], v[8:9] op_sel:[0,0] op_sel_hi:[1,0]
v_cvt_pk_bf16_f32 v176, v176, v177
v_cvt_pk_bf16_f32 v177, v178, v179
v_cvt_pk_bf16_f32 v178, v180, v181
v_cvt_pk_bf16_f32 v179, v182, v183
v_accvgpr_read_b32 v184, a68
v_accvgpr_read_b32 v185, a69
v_accvgpr_read_b32 v186, a70
v_accvgpr_read_b32 v187, a71
v_accvgpr_read_b32 v188, a84
v_accvgpr_read_b32 v189, a85
v_accvgpr_read_b32 v190, a86
v_accvgpr_read_b32 v191, a87
v_pk_mul_f32 v[184:185], v[184:185], v[8:9] op_sel:[0,1] op_sel_hi:[1,1]
v_pk_mul_f32 v[186:187], v[186:187], v[8:9] op_sel:[0,1] op_sel_hi:[1,1]
v_pk_mul_f32 v[188:189], v[188:189], v[8:9] op_sel:[0,1] op_sel_hi:[1,1]
v_pk_mul_f32 v[190:191], v[190:191], v[8:9] op_sel:[0,1] op_sel_hi:[1,1]
v_cvt_pk_bf16_f32 v184, v184, v185
v_cvt_pk_bf16_f32 v185, v186, v187
v_cvt_pk_bf16_f32 v186, v188, v189
v_cvt_pk_bf16_f32 v187, v190, v191
v_accvgpr_read_b32 v208, a72
v_accvgpr_read_b32 v209, a73
v_accvgpr_read_b32 v210, a74
v_accvgpr_read_b32 v211, a75
v_accvgpr_read_b32 v212, a88
v_accvgpr_read_b32 v213, a89
v_accvgpr_read_b32 v214, a90
v_accvgpr_read_b32 v215, a91
v_pk_mul_f32 v[208:209], v[208:209], v[10:11] op_sel:[0,0] op_sel_hi:[1,0]
v_pk_mul_f32 v[210:211], v[210:211], v[10:11] op_sel:[0,0] op_sel_hi:[1,0]
v_pk_mul_f32 v[212:213], v[212:213], v[10:11] op_sel:[0,0] op_sel_hi:[1,0]
v_pk_mul_f32 v[214:215], v[214:215], v[10:11] op_sel:[0,0] op_sel_hi:[1,0]
v_cvt_pk_bf16_f32 v208, v208, v209
v_cvt_pk_bf16_f32 v209, v210, v211
v_cvt_pk_bf16_f32 v210, v212, v213
v_cvt_pk_bf16_f32 v211, v214, v215
v_accvgpr_read_b32 v216, a76
v_accvgpr_read_b32 v217, a77
v_accvgpr_read_b32 v218, a78
v_accvgpr_read_b32 v219, a79
v_accvgpr_read_b32 v220, a92
v_accvgpr_read_b32 v221, a93
v_accvgpr_read_b32 v222, a94
v_accvgpr_read_b32 v223, a95
v_pk_mul_f32 v[216:217], v[216:217], v[10:11] op_sel:[0,1] op_sel_hi:[1,1]
v_pk_mul_f32 v[218:219], v[218:219], v[10:11] op_sel:[0,1] op_sel_hi:[1,1]
v_pk_mul_f32 v[220:221], v[220:221], v[10:11] op_sel:[0,1] op_sel_hi:[1,1]
v_pk_mul_f32 v[222:223], v[222:223], v[10:11] op_sel:[0,1] op_sel_hi:[1,1]
v_cvt_pk_bf16_f32 v216, v216, v217
v_cvt_pk_bf16_f32 v217, v218, v219
v_cvt_pk_bf16_f32 v218, v220, v221
v_cvt_pk_bf16_f32 v219, v222, v223
s_bitcmp1_b32 s61, 0
s_cbranch_scc0 Lss_3
buffer_store_dwordx4 v[160:163], v1, s[16:19], s36 offen offset:0 sc1
buffer_store_dwordx4 v[164:167], v1, s[16:19], s36 offen offset:2048 sc1
buffer_store_dwordx4 v[168:171], v1, s[16:19], s37 offen offset:0 sc1
buffer_store_dwordx4 v[172:175], v1, s[16:19], s37 offen offset:2048 sc1
Lss_3:
s_bitcmp1_b32 s61, 1
s_cbranch_scc0 Lss_4
buffer_store_dwordx4 v[192:195], v1, s[16:19], s36 offen offset:1024 sc1
buffer_store_dwordx4 v[196:199], v1, s[16:19], s36 offen offset:3072 sc1
buffer_store_dwordx4 v[200:203], v1, s[16:19], s37 offen offset:1024 sc1
buffer_store_dwordx4 v[204:207], v1, s[16:19], s37 offen offset:3072 sc1
Lss_4:
s_bitcmp1_b32 s61, 2
s_cbranch_scc0 Lss_5
buffer_store_dwordx4 v[224:227], v1, s[16:19], s38 offen offset:0 sc1
buffer_store_dwordx4 v[228:231], v1, s[16:19], s38 offen offset:2048 sc1
buffer_store_dwordx4 v[232:235], v1, s[16:19], s39 offen offset:0 sc1
buffer_store_dwordx4 v[236:239], v1, s[16:19], s39 offen offset:2048 sc1
Lss_5:
s_bitcmp1_b32 s61, 3
s_cbranch_scc0 Lss_6
buffer_store_dwordx4 v[176:179], v1, s[16:19], s38 offen offset:1024 sc1
buffer_store_dwordx4 v[184:187], v1, s[16:19], s38 offen offset:3072 sc1
buffer_store_dwordx4 v[208:211], v1, s[16:19], s39 offen offset:1024 sc1
buffer_store_dwordx4 v[216:219], v1, s[16:19], s39 offen offset:3072 sc1
Lss_6:
s_branch Lk2_chk
Lk2_done:
s_lshl_b32 s33, s20, 4
s_add_u32 s33, s33, 16781312
s_sub_u32 s34, 15, s21
s_lshl_b32 s34, s34, 9
s_add_u32 s92, s33, s34
s_lshl_b32 s34, s22, 2
s_add_u32 s92, s92, s34
s_lshl_b32 s34, s21, 9
s_add_u32 s93, s33, s34
s_lshl_b32 s34, s23, 3
s_add_u32 s93, s93, s34
s_cmp_eq_u32 s24, 0
s_cselect_b32 s93, s93, s92
s_cselect_b32 s94, 4, 0
s_add_u32 s94, s94, s93
s_load_dwordx2 s[10:11], s[0:1], 40
s_load_dwordx2 s[14:15], s[0:1], 72
s_lshl_b32 s21, s27, 7
s_lshl_b32 s22, s28, 6
s_lshl_b32 s3, s101, 4
v_lshrrev_b32 v232, 3, v0
v_and_b32 v233, 6, v232
v_and_b32 v234, 7, v0
v_xor_b32 v233, v233, v234
v_add_u32 v232, s3, v232
v_lshlrev_b32 v232, 11, v232
v_lshl_add_u32 v6, v233, 4, v232
v_add_u32 v7, 15360, v6
s_add_u32 m0, s42, 49152
s_nop 0
buffer_load_dwordx4 v6, s[48:51], s26 offen offset:0 lds
buffer_load_dwordx4 v7, s[48:51], s26 offen offset:1024 lds
buffer_load_dwordx4 a[96:99], v1, s[44:47], s25 offen offset:0 sc1
buffer_load_dwordx4 a[100:103], v1, s[44:47], s25 offen offset:1024 sc1
buffer_load_dwordx4 a[104:107], v1, s[44:47], s25 offen offset:2048 sc1
buffer_load_dwordx4 a[108:111], v1, s[44:47], s25 offen offset:3072 sc1
s_add_u32 s25, s25, 16384
s_add_u32 s26, s26, 131072
s_add_u32 m0, s42, 65536
s_nop 0
buffer_load_dwordx4 v6, s[48:51], s26 offen offset:0 lds
buffer_load_dwordx4 v7, s[48:51], s26 offen offset:1024 lds
buffer_load_dwordx4 a[128:131], v1, s[44:47], s25 offen offset:0 sc1
buffer_load_dwordx4 a[132:135], v1, s[44:47], s25 offen offset:1024 sc1
buffer_load_dwordx4 a[136:139], v1, s[44:47], s25 offen offset:2048 sc1
buffer_load_dwordx4 a[140:143], v1, s[44:47], s25 offen offset:3072 sc1
s_add_u32 s25, s25, 16384
s_add_u32 s26, s26, 131072
v_lshrrev_b32 v232, 2, v0
v_and_b32 v234, 1, v0
v_bfe_u32 v237, v0, 1, 1
v_lshlrev_b32 v233, 7, v232
v_lshl_add_u32 v233, v234, 3, v233
v_and_b32 v236, 6, v232
v_add_u32 v235, 0, v237
v_xor_b32 v235, v235, v236
v_lshl_add_u32 v24, v235, 4, v233
v_add_u32 v28, 0x10000, v24
v_add_u32 v235, 2, v237
v_xor_b32 v235, v235, v236
v_lshl_add_u32 v25, v235, 4, v233
v_add_u32 v29, 0x10000, v25
v_add_u32 v235, 4, v237
v_xor_b32 v235, v235, v236
v_lshl_add_u32 v26, v235, 4, v233
v_add_u32 v30, 0x10000, v26
v_add_u32 v235, 6, v237
v_xor_b32 v235, v235, v236
v_lshl_add_u32 v27, v235, 4, v233
v_add_u32 v31, 0x10000, v27
s_waitcnt vmcnt(26)
s_barrier
ds_read_b64_tr_b16 a[32:33], v24 offset:16384
ds_read_b64_tr_b16 a[34:35], v24 offset:18432
ds_read_b64_tr_b16 a[36:37], v24 offset:20480
ds_read_b64_tr_b16 a[38:39], v24 offset:22528
ds_read_b64_tr_b16 a[40:41], v25 offset:16384
ds_read_b64_tr_b16 a[42:43], v25 offset:18432
ds_read_b64_tr_b16 a[44:45], v25 offset:20480
ds_read_b64_tr_b16 a[46:47], v25 offset:22528
ds_read_b64_tr_b16 a[48:49], v26 offset:16384
ds_read_b64_tr_b16 a[50:51], v26 offset:18432
ds_read_b64_tr_b16 a[52:53], v26 offset:20480
ds_read_b64_tr_b16 a[54:55], v26 offset:22528
ds_read_b64_tr_b16 a[56:57], v27 offset:16384
ds_read_b64_tr_b16 a[58:59], v27 offset:18432
ds_read_b64_tr_b16 a[60:61], v27 offset:20480
ds_read_b64_tr_b16 a[62:63], v27 offset:22528
s_and_b32 s40, s2, 3
s_bfe_u32 s36, s2, 0x30003
s_lshl_b32 s29, s36, 8
s_bfe_u32 s3, s2, 0x10002
s_lshl_b32 s3, s3, 2
s_lshr_b32 s37, s2, 6
s_add_u32 s3, s3, s37
s_lshl_b32 s13, s3, 8
s_lshl_b32 s30, s3, 7
s_lshl_b32 s3, s40, 5
s_add_u32 s30, s30, s3
s_lshl_b32 s41, s101, 12
s_lshl_b32 s12, s36, 21
s_lshr_b32 s3, s101, 1
s_lshl_b32 s3, s3, 20
s_add_u32 s12, s12, s3
s_and_b32 s3, s101, 1
s_lshl_b32 s3, s3, 13
s_add_u32 s12, s12, s3
s_lshl_b32 s62, s36, 10
s_lshl_b32 s3, s40, 7
s_add_u32 s62, s62, s3
s_add_u32 s62, s62, 16781312
s_bfe_u32 s3, s2, 0x10002
s_lshl_b32 s3, s3, 3
s_sub_u32 s39, 16, s3
s_lshl_b32 s38, s40, 4
s_add_u32 s3, s3, s38
s_lshl_b32 s3, s3, 14
s_add_u32 s12, s12, s3
s_lshl_b32 s3, s3, 3
s_add_u32 s13, s13, s3
s_mov_b32 s64, 4294721536
s_mov_b32 s65, 16384
s_add_u32 s8, s4, 67108864
s_addc_u32 s9, s5, 0
s_lshl_b32 s56, s2, 16
s_lshl_b32 s38, s101, 14
s_add_u32 s56, s56, s38
s_lshl_b32 s58, s2, 4
s_lshl_b32 s38, s101, 2
s_add_u32 s58, s58, s38
s_add_u32 s58, s58, 16777216
s_and_b32 s59, s58, 0xffffffcf
s_mov_b32 s61, 0
s_lshl_b32 s3, s101, 4
v_lshrrev_b32 v240, 4, v0
v_and_b32 v242, 15, v0
v_add_u32 v241, 0, v240
v_lshlrev_b32 v241, 1, v241
v_xor_b32 v241, v241, v242
v_add_u32 v243, s3, v240
v_lshlrev_b32 v243, 11, v243
v_lshl_add_u32 v243, v241, 4, v243
v_add_u32 v2, 0, v243
v_add_u32 v241, 4, v240
v_lshlrev_b32 v241, 1, v241
v_xor_b32 v241, v241, v242
v_add_u32 v243, s3, v240
v_lshlrev_b32 v243, 11, v243
v_lshl_add_u32 v243, v241, 4, v243
v_add_u32 v3, 7168, v243
v_add_u32 v241, 0, v240
v_lshlrev_b32 v241, 1, v241
v_xor_b32 v241, v241, v242
v_add_u32 v243, s3, v240
v_lshlrev_b32 v243, 11, v243
v_lshl_add_u32 v243, v241, 4, v243
v_add_u32 v4, 14336, v243
v_add_u32 v241, 4, v240
v_lshlrev_b32 v241, 1, v241
v_xor_b32 v241, v241, v242
v_add_u32 v243, s3, v240
v_lshlrev_b32 v243, 11, v243
v_lshl_add_u32 v243, v241, 4, v243
v_add_u32 v5, 21504, v243
v_lshlrev_b32 v233, 8, v232
v_lshl_add_u32 v233, v234, 3, v233
v_and_b32 v236, 7, v232
v_lshlrev_b32 v236, 1, v236
s_lshl_b32 s38, s40, 2
v_xor_b32 v236, s38, v236
v_add_u32 v235, 0, v237
v_xor_b32 v235, v235, v236
v_lshl_add_u32 v8, v235, 4, v233
v_add_u32 v16, 0x10000, v8
v_add_u32 v235, 2, v237
v_xor_b32 v235, v235, v236
v_lshl_add_u32 v9, v235, 4, v233
v_add_u32 v17, 0x10000, v9
v_add_u32 v235, 4, v237
v_xor_b32 v235, v235, v236
v_lshl_add_u32 v10, v235, 4, v233
v_add_u32 v18, 0x10000, v10
v_add_u32 v235, 6, v237
v_xor_b32 v235, v235, v236
v_lshl_add_u32 v11, v235, 4, v233
v_add_u32 v19, 0x10000, v11
v_add_u32 v235, 8, v237
v_xor_b32 v235, v235, v236
v_lshl_add_u32 v12, v235, 4, v233
v_add_u32 v20, 0x10000, v12
v_add_u32 v235, 10, v237
v_xor_b32 v235, v235, v236
v_lshl_add_u32 v13, v235, 4, v233
v_add_u32 v21, 0x10000, v13
v_add_u32 v235, 12, v237
v_xor_b32 v235, v235, v236
v_lshl_add_u32 v14, v235, 4, v233
v_add_u32 v22, 0x10000, v14
v_add_u32 v235, 14, v237
v_xor_b32 v235, v235, v236
v_lshl_add_u32 v15, v235, 4, v233
v_add_u32 v23, 0x10000, v15
v_mov_b32 v253, 0
v_mov_b32 v254, 1
v_and_b32 v255, 31, v0
v_lshlrev_b32 v255, 2, v255
v_lshrrev_b32 v252, 5, v0
v_lshl_add_u32 v255, v252, 9, v255
s_waitcnt lgkmcnt(0)
s_mov_b32 s16, s14
s_mov_b32 s17, s15
s_mov_b32 s18, 8388608
s_mov_b32 s19, 0x00020000
s_waitcnt vmcnt(20) lgkmcnt(0)
s_barrier
s_waitcnt vmcnt(12)
s_mov_b64 exec, 1
buffer_store_dword v254, v253, s[52:55], s92 offen sc1
buffer_store_dword v254, v253, s[52:55], s93 offen sc1
buffer_store_dword v254, v253, s[52:55], s94 offen sc1
s_mov_b64 exec, -1
M a[0:3], a[32:35], a[192:195], 0
s_add_u32 m0, s42, 81920
s_nop 0
buffer_load_dwordx4 v6, s[48:51], s26 offen offset:0 lds
ds_read_b64_tr_b16 v[160:161], v24 offset:32768
ds_read_b64_tr_b16 v[162:163], v24 offset:34816
M a[0:3], a[36:39], a[196:199], a[0:3]
buffer_load_dwordx4 v7, s[48:51], s26 offen offset:1024 lds
M a[4:7], a[44:47], a[196:199], 0
ds_read_b64_tr_b16 v[164:165], v24 offset:36864
ds_read_b64_tr_b16 v[166:167], v24 offset:38912
M a[4:7], a[40:43], a[192:195], a[4:7]
buffer_load_dwordx4 a[160:163], v1, s[44:47], s25 offen offset:0 sc1
M a[8:11], a[48:51], a[192:195], 0
ds_read_b64_tr_b16 v[168:169], v25 offset:32768
ds_read_b64_tr_b16 v[170:171], v25 offset:34816
M a[8:11], a[52:55], a[196:199], a[8:11]
buffer_load_dwordx4 a[164:167], v1, s[44:47], s25 offen offset:1024 sc1
M a[12:15], a[60:63], a[196:199], 0
ds_read_b64_tr_b16 v[172:173], v25 offset:36864
ds_read_b64_tr_b16 v[174:175], v25 offset:38912
M a[12:15], a[56:59], a[192:195], a[12:15]
buffer_load_dwordx4 a[168:171], v1, s[44:47], s25 offen offset:2048 sc1
M a[16:19], a[32:35], a[200:203], 0
ds_read_b64_tr_b16 v[176:177], v26 offset:32768
ds_read_b64_tr_b16 v[178:179], v26 offset:34816
M a[16:19], a[36:39], a[204:207], a[16:19]
buffer_load_dwordx4 a[172:175], v1, s[44:47], s25 offen offset:3072 sc1
M a[20:23], a[44:47], a[204:207], 0
ds_read_b64_tr_b16 v[180:181], v26 offset:36864
ds_read_b64_tr_b16 v[182:183], v26 offset:38912
M a[20:23], a[40:43], a[200:203], a[20:23]
s_add_u32 s25, s25, 16384
s_add_u32 s26, s26, 131072
M a[24:27], a[48:51], a[200:203], 0
ds_read_b64_tr_b16 v[184:185], v27 offset:32768
ds_read_b64_tr_b16 v[186:187], v27 offset:34816
M a[24:27], a[52:55], a[204:207], a[24:27]
ds_read_b64_tr_b16 v[188:189], v27 offset:36864
ds_read_b64_tr_b16 v[190:191], v27 offset:38912
M a[28:31], a[60:63], a[204:207], 0
M a[28:31], a[56:59], a[200:203], a[28:31]
s_waitcnt vmcnt(15) lgkmcnt(0)
s_barrier
M a[0:3], v[160:163], a[224:227], a[0:3]
s_add_u32 m0, s42, 98304
s_nop 0
buffer_load_dwordx4 v6, s[48:51], s26 offen offset:0 lds
ds_read_b64_tr_b16 a[32:33], v24 offset:49152
ds_read_b64_tr_b16 a[34:35], v24 offset:51200
M a[0:3], v[164:167], a[228:231], a[0:3]
buffer_load_dwordx4 v7, s[48:51], s26 offen offset:1024 lds
M a[4:7], v[172:175], a[228:231], a[4:7]
ds_read_b64_tr_b16 a[36:37], v24 offset:53248
ds_read_b64_tr_b16 a[38:39], v24 offset:55296
M a[4:7], v[168:171], a[224:227], a[4:7]
buffer_load_dwordx4 a[192:195], v1, s[44:47], s25 offen offset:0 sc1
M a[8:11], v[176:179], a[224:227], a[8:11]
ds_read_b64_tr_b16 a[40:41], v25 offset:49152
ds_read_b64_tr_b16 a[42:43], v25 offset:51200
M a[8:11], v[180:183], a[228:231], a[8:11]
buffer_load_dwordx4 a[196:199], v1, s[44:47], s25 offen offset:1024 sc1
M a[12:15], v[188:191], a[228:231], a[12:15]
ds_read_b64_tr_b16 a[44:45], v25 offset:53248
ds_read_b64_tr_b16 a[46:47], v25 offset:55296
M a[12:15], v[184:187], a[224:227], a[12:15]
buffer_load_dwordx4 a[200:203], v1, s[44:47], s25 offen offset:2048 sc1
M a[16:19], v[160:163], a[232:235], a[16:19]
ds_read_b64_tr_b16 a[48:49], v26 offset:49152
ds_read_b64_tr_b16 a[50:51], v26 offset:51200
M a[16:19], v[164:167], a[236:239], a[16:19]
buffer_load_dwordx4 a[204:207], v1, s[44:47], s25 offen offset:3072 sc1
M a[20:23], v[172:175], a[236:239], a[20:23]
ds_read_b64_tr_b16 a[52:53], v26 offset:53248
ds_read_b64_tr_b16 a[54:55], v26 offset:55296
M a[20:23], v[168:171], a[232:235], a[20:23]
s_add_u32 s25, s25, 16384
s_add_u32 s26, s26, 131072
M a[24:27], v[176:179], a[232:235], a[24:27]
ds_read_b64_tr_b16 a[56:57], v27 offset:49152
ds_read_b64_tr_b16 a[58:59], v27 offset:51200
M a[24:27], v[180:183], a[236:239], a[24:27]
ds_read_b64_tr_b16 a[60:61], v27 offset:53248
ds_read_b64_tr_b16 a[62:63], v27 offset:55296
M a[28:31], v[188:191], a[236:239], a[28:31]
M a[28:31], v[184:187], a[232:235], a[28:31]
s_waitcnt vmcnt(15) lgkmcnt(0)
s_barrier
M a[0:3], a[32:35], a[96:99], a[0:3]
s_add_u32 m0, s42, 114688
s_nop 0
buffer_load_dwordx4 v6, s[48:51], s26 offen offset:0 lds
ds_read_b64_tr_b16 v[160:161], v28 offset:0
ds_read_b64_tr_b16 v[162:163], v28 offset:2048
M a[0:3], a[36:39], a[100:103], a[0:3]
buffer_load_dwordx4 v7, s[48:51], s26 offen offset:1024 lds
M a[4:7], a[44:47], a[100:103], a[4:7]
ds_read_b64_tr_b16 v[164:165], v28 offset:4096
ds_read_b64_tr_b16 v[166:167], v28 offset:6144
M a[4:7], a[40:43], a[96:99], a[4:7]
buffer_load_dwordx4 a[224:227], v1, s[44:47], s25 offen offset:0 sc1
M a[8:11], a[48:51], a[96:99], a[8:11]
ds_read_b64_tr_b16 v[168:169], v29 offset:0
ds_read_b64_tr_b16 v[170:171], v29 offset:2048
M a[8:11], a[52:55], a[100:103], a[8:11]
buffer_load_dwordx4 a[228:231], v1, s[44:47], s25 offen offset:1024 sc1
M a[12:15], a[60:63], a[100:103], a[12:15]
ds_read_b64_tr_b16 v[172:173], v29 offset:4096
ds_read_b64_tr_b16 v[174:175], v29 offset:6144
M a[12:15], a[56:59], a[96:99], a[12:15]
buffer_load_dwordx4 a[232:235], v1, s[44:47], s25 offen offset:2048 sc1
ds_read_b64_tr_b16 v[176:177], v30 offset:0
ds_read_b64_tr_b16 v[178:179], v30 offset:2048
M a[16:19], a[32:35], a[104:107], a[16:19]
buffer_load_dwordx4 a[236:239], v1, s[44:47], s25 offen offset:3072 sc1
M a[16:19], a[36:39], a[108:111], a[16:19]
ds_read_b64_tr_b16 v[180:181], v30 offset:4096
ds_read_b64_tr_b16 v[182:183], v30 offset:6144
M a[20:23], a[44:47], a[108:111], a[20:23]
s_add_u32 s25, s25, 16384
s_add_u32 s26, s26, 131072
M a[20:23], a[40:43], a[104:107], a[20:23]
ds_read_b64_tr_b16 v[184:185], v31 offset:0
ds_read_b64_tr_b16 v[186:187], v31 offset:2048
M a[24:27], a[48:51], a[104:107], a[24:27]
buffer_load_dword v252, v255, s[52:55], s62 offen sc1
M a[24:27], a[52:55], a[108:111], a[24:27]
ds_read_b64_tr_b16 v[188:189], v31 offset:4096
ds_read_b64_tr_b16 v[190:191], v31 offset:6144
M a[28:31], a[60:63], a[108:111], a[28:31]
M a[28:31], a[56:59], a[104:107], a[28:31]
s_waitcnt vmcnt(13) lgkmcnt(0)
s_barrier
s_waitcnt vmcnt(0)
v_cmp_ne_u32 vcc, 1, v252
s_nop 0
s_cbranch_vccnz Lk3_spinft
Lk3_gotft:
M a[0:3], v[160:163], a[128:131], a[0:3]
s_mov_b32 s32, s25
s_mov_b32 s33, s26
s_mov_b64 s[34:35], s[44:45]
s_mov_b64 s[36:37], s[48:49]
s_mov_b64 s[44:45], s[8:9]
s_mov_b32 s46, 16777216
s_mov_b64 s[48:49], s[10:11]
s_mov_b32 s50, 8388608
s_mov_b32 s25, s12
s_mov_b32 s26, s13
s_add_u32 m0, s41, 0
s_nop 0
buffer_load_dwordx4 v2, s[48:51], s26 offen offset:0 lds
ds_read_b64_tr_b16 a[32:33], v28 offset:16384
ds_read_b64_tr_b16 a[34:35], v28 offset:18432
M a[0:3], v[164:167], a[132:135], a[0:3]
buffer_load_dwordx4 v3, s[48:51], s26 offen offset:1024 lds
ds_read_b64_tr_b16 a[36:37], v28 offset:20480
ds_read_b64_tr_b16 a[38:39], v28 offset:22528
M a[4:7], v[172:175], a[132:135], a[4:7]
buffer_load_dwordx4 v4, s[48:51], s26 offen offset:2048 lds
M a[4:7], v[168:171], a[128:131], a[4:7]
ds_read_b64_tr_b16 a[40:41], v29 offset:16384
ds_read_b64_tr_b16 a[42:43], v29 offset:18432
buffer_load_dwordx4 v5, s[48:51], s26 offen offset:3072 lds
M a[8:11], v[176:179], a[128:131], a[8:11]
ds_read_b64_tr_b16 a[44:45], v29 offset:20480
ds_read_b64_tr_b16 a[46:47], v29 offset:22528
M a[8:11], v[180:183], a[132:135], a[8:11]
buffer_load_dwordx4 a[96:99], v1, s[44:47], s25 offen offset:0 sc1
ds_read_b64_tr_b16 a[48:49], v30 offset:16384
ds_read_b64_tr_b16 a[50:51], v30 offset:18432
M a[12:15], v[188:191], a[132:135], a[12:15]
buffer_load_dwordx4 a[100:103], v1, s[44:47], s25 offen offset:1024 sc1
M a[12:15], v[184:187], a[128:131], a[12:15]
ds_read_b64_tr_b16 a[52:53], v30 offset:20480
ds_read_b64_tr_b16 a[54:55], v30 offset:22528
buffer_load_dwordx4 a[104:107], v1, s[44:47], s25 offen offset:2048 sc1
M a[16:19], v[160:163], a[136:139], a[16:19]
ds_read_b64_tr_b16 a[56:57], v31 offset:16384
ds_read_b64_tr_b16 a[58:59], v31 offset:18432
buffer_load_dwordx4 a[108:111], v1, s[44:47], s25 offen offset:3072 sc1
M a[16:19], v[164:167], a[140:143], a[16:19]
ds_read_b64_tr_b16 a[60:61], v31 offset:20480
ds_read_b64_tr_b16 a[62:63], v31 offset:22528
M a[20:23], v[172:175], a[140:143], a[20:23]
s_add_u32 s63, s25, 4096
buffer_load_dwordx4 a[112:115], v1, s[44:47], s63 offen offset:0 sc1
buffer_load_dwordx4 a[116:119], v1, s[44:47], s63 offen offset:1024 sc1
M a[20:23], v[168:171], a[136:139], a[20:23]
buffer_load_dwordx4 a[120:123], v1, s[44:47], s63 offen offset:2048 sc1
M a[24:27], v[176:179], a[136:139], a[24:27]
buffer_load_dwordx4 a[124:127], v1, s[44:47], s63 offen offset:3072 sc1
s_sub_u32 s39, s39, 1
s_cmp_eq_u32 s39, 0
s_cselect_b32 s3, s64, s65
M a[24:27], v[180:183], a[140:143], a[24:27]
s_add_u32 s25, s25, s3
s_lshl_b32 s3, s3, 3
s_add_u32 s26, s26, s3
M a[28:31], v[188:191], a[140:143], a[28:31]
M a[28:31], v[184:187], a[136:139], a[28:31]
s_waitcnt vmcnt(19) lgkmcnt(0)
s_barrier
M a[0:3], a[32:35], a[160:163], a[0:3]
s_add_u32 m0, s41, 16384
s_nop 0
buffer_load_dwordx4 v2, s[48:51], s26 offen offset:0 lds
ds_read_b64_tr_b16 v[160:161], v28 offset:32768
ds_read_b64_tr_b16 v[162:163], v28 offset:34816
M a[0:3], a[36:39], a[164:167], a[0:3]
buffer_load_dwordx4 v3, s[48:51], s26 offen offset:1024 lds
ds_read_b64_tr_b16 v[164:165], v28 offset:36864
ds_read_b64_tr_b16 v[166:167], v28 offset:38912
M a[4:7], a[44:47], a[164:167], a[4:7]
buffer_load_dwordx4 v4, s[48:51], s26 offen offset:2048 lds
M a[4:7], a[40:43], a[160:163], a[4:7]
ds_read_b64_tr_b16 v[168:169], v29 offset:32768
ds_read_b64_tr_b16 v[170:171], v29 offset:34816
buffer_load_dwordx4 v5, s[48:51], s26 offen offset:3072 lds
M a[8:11], a[48:51], a[160:163], a[8:11]
ds_read_b64_tr_b16 v[172:173], v29 offset:36864
ds_read_b64_tr_b16 v[174:175], v29 offset:38912
M a[8:11], a[52:55], a[164:167], a[8:11]
buffer_load_dwordx4 a[128:131], v1, s[44:47], s25 offen offset:0 sc1
ds_read_b64_tr_b16 v[176:177], v30 offset:32768
ds_read_b64_tr_b16 v[178:179], v30 offset:34816
M a[12:15], a[60:63], a[164:167], a[12:15]
buffer_load_dwordx4 a[132:135], v1, s[44:47], s25 offen offset:1024 sc1
M a[12:15], a[56:59], a[160:163], a[12:15]
ds_read_b64_tr_b16 v[180:181], v30 offset:36864
ds_read_b64_tr_b16 v[182:183], v30 offset:38912
buffer_load_dwordx4 a[136:139], v1, s[44:47], s25 offen offset:2048 sc1
M a[16:19], a[32:35], a[168:171], a[16:19]
ds_read_b64_tr_b16 v[184:185], v31 offset:32768
ds_read_b64_tr_b16 v[186:187], v31 offset:34816
buffer_load_dwordx4 a[140:143], v1, s[44:47], s25 offen offset:3072 sc1
M a[16:19], a[36:39], a[172:175], a[16:19]
ds_read_b64_tr_b16 v[188:189], v31 offset:36864
ds_read_b64_tr_b16 v[190:191], v31 offset:38912
M a[20:23], a[44:47], a[172:175], a[20:23]
s_add_u32 s63, s25, 4096
buffer_load_dwordx4 a[144:147], v1, s[44:47], s63 offen offset:0 sc1
buffer_load_dwordx4 a[148:151], v1, s[44:47], s63 offen offset:1024 sc1
M a[20:23], a[40:43], a[168:171], a[20:23]
buffer_load_dwordx4 a[152:155], v1, s[44:47], s63 offen offset:2048 sc1
M a[24:27], a[48:51], a[168:171], a[24:27]
buffer_load_dwordx4 a[156:159], v1, s[44:47], s63 offen offset:3072 sc1
s_sub_u32 s39, s39, 1
s_cmp_eq_u32 s39, 0
s_cselect_b32 s3, s64, s65
M a[24:27], a[52:55], a[172:175], a[24:27]
s_add_u32 s25, s25, s3
s_lshl_b32 s3, s3, 3
s_add_u32 s26, s26, s3
M a[28:31], a[60:63], a[172:175], a[28:31]
M a[28:31], a[56:59], a[168:171], a[28:31]
s_waitcnt vmcnt(25) lgkmcnt(0)
s_barrier
M a[0:3], v[160:163], a[192:195], a[0:3]
s_add_u32 m0, s41, 32768
s_nop 0
buffer_load_dwordx4 v2, s[48:51], s26 offen offset:0 lds
ds_read_b64_tr_b16 a[32:33], v28 offset:49152
ds_read_b64_tr_b16 a[34:35], v28 offset:51200
M a[0:3], v[164:167], a[196:199], a[0:3]
buffer_load_dwordx4 v3, s[48:51], s26 offen offset:1024 lds
ds_read_b64_tr_b16 a[36:37], v28 offset:53248
ds_read_b64_tr_b16 a[38:39], v28 offset:55296
M a[4:7], v[172:175], a[196:199], a[4:7]
buffer_load_dwordx4 v4, s[48:51], s26 offen offset:2048 lds
M a[4:7], v[168:171], a[192:195], a[4:7]
ds_read_b64_tr_b16 a[40:41], v29 offset:49152
ds_read_b64_tr_b16 a[42:43], v29 offset:51200
buffer_load_dwordx4 v5, s[48:51], s26 offen offset:3072 lds
M a[8:11], v[176:179], a[192:195], a[8:11]
ds_read_b64_tr_b16 a[44:45], v29 offset:53248
ds_read_b64_tr_b16 a[46:47], v29 offset:55296
M a[8:11], v[180:183], a[196:199], a[8:11]
buffer_load_dwordx4 a[160:163], v1, s[44:47], s25 offen offset:0 sc1
ds_read_b64_tr_b16 a[48:49], v30 offset:49152
ds_read_b64_tr_b16 a[50:51], v30 offset:51200
M a[12:15], v[188:191], a[196:199], a[12:15]
buffer_load_dwordx4 a[164:167], v1, s[44:47], s25 offen offset:1024 sc1
M a[12:15], v[184:187], a[192:195], a[12:15]
ds_read_b64_tr_b16 a[52:53], v30 offset:53248
ds_read_b64_tr_b16 a[54:55], v30 offset:55296
buffer_load_dwordx4 a[168:171], v1, s[44:47], s25 offen offset:2048 sc1
M a[16:19], v[160:163], a[200:203], a[16:19]
ds_read_b64_tr_b16 a[56:57], v31 offset:49152
ds_read_b64_tr_b16 a[58:59], v31 offset:51200
buffer_load_dwordx4 a[172:175], v1, s[44:47], s25 offen offset:3072 sc1
M a[16:19], v[164:167], a[204:207], a[16:19]
ds_read_b64_tr_b16 a[60:61], v31 offset:53248
ds_read_b64_tr_b16 a[62:63], v31 offset:55296
M a[20:23], v[172:175], a[204:207], a[20:23]
s_add_u32 s63, s25, 4096
buffer_load_dwordx4 a[176:179], v1, s[44:47], s63 offen offset:0 sc1
buffer_load_dwordx4 a[180:183], v1, s[44:47], s63 offen offset:1024 sc1
M a[20:23], v[168:171], a[200:203], a[20:23]
buffer_load_dwordx4 a[184:187], v1, s[44:47], s63 offen offset:2048 sc1
M a[24:27], v[176:179], a[200:203], a[24:27]
buffer_load_dwordx4 a[188:191], v1, s[44:47], s63 offen offset:3072 sc1
s_sub_u32 s39, s39, 1
s_cmp_eq_u32 s39, 0
s_cselect_b32 s3, s64, s65
M a[24:27], v[180:183], a[204:207], a[24:27]
s_add_u32 s25, s25, s3
s_lshl_b32 s3, s3, 3
s_add_u32 s26, s26, s3
M a[28:31], v[188:191], a[204:207], a[28:31]
M a[28:31], v[184:187], a[200:203], a[28:31]
s_waitcnt vmcnt(24) lgkmcnt(0)
s_barrier
M a[0:3], a[32:35], a[224:227], a[0:3]
s_add_u32 m0, s41, 49152
s_nop 0
buffer_load_dwordx4 v2, s[48:51], s26 offen offset:0 lds
ds_read_b64_tr_b16 v[160:161], v8 offset:0
ds_read_b64_tr_b16 v[162:163], v8 offset:4096
buffer_load_dwordx4 v3, s[48:51], s26 offen offset:1024 lds
M a[0:3], a[36:39], a[228:231], a[0:3]
ds_read_b64_tr_b16 v[164:165], v8 offset:8192
ds_read_b64_tr_b16 v[166:167], v8 offset:12288
buffer_load_dwordx4 v4, s[48:51], s26 offen offset:2048 lds
M a[4:7], a[44:47], a[228:231], a[4:7]
ds_read_b64_tr_b16 v[168:169], v9 offset:0
ds_read_b64_tr_b16 v[170:171], v9 offset:4096
buffer_load_dwordx4 v5, s[48:51], s26 offen offset:3072 lds
M a[4:7], a[40:43], a[224:227], a[4:7]
ds_read_b64_tr_b16 v[172:173], v9 offset:8192
ds_read_b64_tr_b16 v[174:175], v9 offset:12288
buffer_load_dwordx4 a[192:195], v1, s[44:47], s25 offen offset:0 sc1
M a[8:11], a[48:51], a[224:227], a[8:11]
ds_read_b64_tr_b16 v[176:177], v10 offset:0
ds_read_b64_tr_b16 v[178:179], v10 offset:4096
buffer_load_dwordx4 a[196:199], v1, s[44:47], s25 offen offset:1024 sc1
M a[8:11], a[52:55], a[228:231], a[8:11]
ds_read_b64_tr_b16 v[180:181], v10 offset:8192
ds_read_b64_tr_b16 v[182:183], v10 offset:12288
buffer_load_dwordx4 a[200:203], v1, s[44:47], s25 offen offset:2048 sc1
M a[12:15], a[60:63], a[228:231], a[12:15]
ds_read_b64_tr_b16 v[184:185], v11 offset:0
ds_read_b64_tr_b16 v[186:187], v11 offset:4096
buffer_load_dwordx4 a[204:207], v1, s[44:47], s25 offen offset:3072 sc1
M a[12:15], a[56:59], a[224:227], a[12:15]
ds_read_b64_tr_b16 v[188:189], v11 offset:8192
ds_read_b64_tr_b16 v[190:191], v11 offset:12288
s_add_u32 s63, s25, 4096
buffer_load_dwordx4 a[208:211], v1, s[44:47], s63 offen offset:0 sc1
ds_read_b64_tr_b16 v[192:193], v12 offset:0
ds_read_b64_tr_b16 v[194:195], v12 offset:4096
M a[16:19], a[32:35], a[232:235], a[16:19]
buffer_load_dwordx4 a[212:215], v1, s[44:47], s63 offen offset:1024 sc1
ds_read_b64_tr_b16 v[196:197], v12 offset:8192
ds_read_b64_tr_b16 v[198:199], v12 offset:12288
M a[16:19], a[36:39], a[236:239], a[16:19]
buffer_load_dwordx4 a[216:219], v1, s[44:47], s63 offen offset:2048 sc1
ds_read_b64_tr_b16 v[200:201], v13 offset:0
ds_read_b64_tr_b16 v[202:203], v13 offset:4096
M a[20:23], a[44:47], a[236:239], a[20:23]
buffer_load_dwordx4 a[220:223], v1, s[44:47], s63 offen offset:3072 sc1
ds_read_b64_tr_b16 v[204:205], v13 offset:8192
ds_read_b64_tr_b16 v[206:207], v13 offset:12288
M a[20:23], a[40:43], a[232:235], a[20:23]
s_sub_u32 s39, s39, 1
s_cmp_eq_u32 s39, 0
s_cselect_b32 s3, s64, s65
ds_read_b64_tr_b16 v[208:209], v14 offset:0
ds_read_b64_tr_b16 v[210:211], v14 offset:4096
M a[24:27], a[48:51], a[232:235], a[24:27]
s_add_u32 s25, s25, s3
s_lshl_b32 s3, s3, 3
s_add_u32 s26, s26, s3
ds_read_b64_tr_b16 v[212:213], v14 offset:8192
ds_read_b64_tr_b16 v[214:215], v14 offset:12288
M a[24:27], a[52:55], a[236:239], a[24:27]
ds_read_b64_tr_b16 v[216:217], v15 offset:0
ds_read_b64_tr_b16 v[218:219], v15 offset:4096
ds_read_b64_tr_b16 v[220:221], v15 offset:8192
ds_read_b64_tr_b16 v[222:223], v15 offset:12288
M a[28:31], a[60:63], a[236:239], a[28:31]
M a[28:31], a[56:59], a[232:235], a[28:31]
s_waitcnt vmcnt(24) lgkmcnt(0)
s_barrier
M v[32:35], v[160:163], a[96:99], 0
s_add_u32 m0, s41, 65536
s_nop 0
buffer_load_dwordx4 v2, s[48:51], s26 offen offset:0 lds
M v[32:35], v[164:167], a[100:103], v[32:35]
M v[36:39], v[172:175], a[100:103], 0
ds_read_b64_tr_b16 a[32:33], v8 offset:16384
ds_read_b64_tr_b16 a[34:35], v8 offset:20480
M v[36:39], v[168:171], a[96:99], v[36:39]
M v[40:43], v[176:179], a[96:99], 0
buffer_load_dwordx4 v3, s[48:51], s26 offen offset:1024 lds
M v[40:43], v[180:183], a[100:103], v[40:43]
M v[44:47], v[188:191], a[100:103], 0
ds_read_b64_tr_b16 a[36:37], v8 offset:24576
ds_read_b64_tr_b16 a[38:39], v8 offset:28672
M v[44:47], v[184:187], a[96:99], v[44:47]
M v[48:51], v[192:195], a[96:99], 0
buffer_load_dwordx4 v4, s[48:51], s26 offen offset:2048 lds
M v[48:51], v[196:199], a[100:103], v[48:51]
M v[52:55], v[204:207], a[100:103], 0
ds_read_b64_tr_b16 a[40:41], v9 offset:16384
ds_read_b64_tr_b16 a[42:43], v9 offset:20480
M v[52:55], v[200:203], a[96:99], v[52:55]
M v[56:59], v[208:211], a[96:99], 0
buffer_load_dwordx4 v5, s[48:51], s26 offen offset:3072 lds
M v[56:59], v[212:215], a[100:103], v[56:59]
M v[60:63], v[220:223], a[100:103], 0
ds_read_b64_tr_b16 a[44:45], v9 offset:24576
ds_read_b64_tr_b16 a[46:47], v9 offset:28672
M v[60:63], v[216:219], a[96:99], v[60:63]
M v[64:67], v[160:163], a[104:107], 0
buffer_load_dwordx4 a[224:227], v1, s[44:47], s25 offen offset:0 sc1
M v[64:67], v[164:167], a[108:111], v[64:67]
M v[68:71], v[172:175], a[108:111], 0
ds_read_b64_tr_b16 a[48:49], v10 offset:16384
ds_read_b64_tr_b16 a[50:51], v10 offset:20480
M v[68:71], v[168:171], a[104:107], v[68:71]
M v[72:75], v[176:179], a[104:107], 0
buffer_load_dwordx4 a[228:231], v1, s[44:47], s25 offen offset:1024 sc1
M v[72:75], v[180:183], a[108:111], v[72:75]
M v[76:79], v[188:191], a[108:111], 0
ds_read_b64_tr_b16 a[52:53], v10 offset:24576
ds_read_b64_tr_b16 a[54:55], v10 offset:28672
M v[76:79], v[184:187], a[104:107], v[76:79]
M v[80:83], v[192:195], a[104:107], 0
buffer_load_dwordx4 a[232:235], v1, s[44:47], s25 offen offset:2048 sc1
M v[80:83], v[196:199], a[108:111], v[80:83]
M v[84:87], v[204:207], a[108:111], 0
ds_read_b64_tr_b16 a[56:57], v11 offset:16384
ds_read_b64_tr_b16 a[58:59], v11 offset:20480
M v[84:87], v[200:203], a[104:107], v[84:87]
M v[88:91], v[208:211], a[104:107], 0
buffer_load_dwordx4 a[236:239], v1, s[44:47], s25 offen offset:3072 sc1
M v[88:91], v[212:215], a[108:111], v[88:91]
M v[92:95], v[220:223], a[108:111], 0
M v[92:95], v[216:219], a[104:107], v[92:95]
ds_read_b64_tr_b16 a[60:61], v11 offset:24576
ds_read_b64_tr_b16 a[62:63], v11 offset:28672
M v[96:99], v[160:163], a[112:115], 0
M v[96:99], v[164:167], a[116:119], v[96:99]
s_add_u32 s63, s25, 4096
buffer_load_dwordx4 a[240:243], v1, s[44:47], s63 offen offset:0 sc1
M v[100:103], v[172:175], a[116:119], 0
M v[100:103], v[168:171], a[112:115], v[100:103]
ds_read_b64_tr_b16 a[64:65], v12 offset:16384
ds_read_b64_tr_b16 a[66:67], v12 offset:20480
M v[104:107], v[176:179], a[112:115], 0
M v[104:107], v[180:183], a[116:119], v[104:107]
buffer_load_dwordx4 a[244:247], v1, s[44:47], s63 offen offset:1024 sc1
M v[108:111], v[188:191], a[116:119], 0
M v[108:111], v[184:187], a[112:115], v[108:111]
ds_read_b64_tr_b16 a[68:69], v12 offset:24576
ds_read_b64_tr_b16 a[70:71], v12 offset:28672
M v[112:115], v[192:195], a[112:115], 0
M v[112:115], v[196:199], a[116:119], v[112:115]
buffer_load_dwordx4 a[248:251], v1, s[44:47], s63 offen offset:2048 sc1
M v[116:119], v[204:207], a[116:119], 0
M v[116:119], v[200:203], a[112:115], v[116:119]
ds_read_b64_tr_b16 a[72:73], v13 offset:16384
ds_read_b64_tr_b16 a[74:75], v13 offset:20480
M v[120:123], v[208:211], a[112:115], 0
M v[120:123], v[212:215], a[116:119], v[120:123]
buffer_load_dwordx4 a[252:255], v1, s[44:47], s63 offen offset:3072 sc1
M v[124:127], v[220:223], a[116:119], 0
M v[124:127], v[216:219], a[112:115], v[124:127]
ds_read_b64_tr_b16 a[76:77], v13 offset:24576
ds_read_b64_tr_b16 a[78:79], v13 offset:28672
M v[128:131], v[160:163], a[120:123], 0
M v[128:131], v[164:167], a[124:127], v[128:131]
s_sub_u32 s39, s39, 1
s_cmp_eq_u32 s39, 0
s_cselect_b32 s3, s64, s65
M v[132:135], v[172:175], a[124:127], 0
M v[132:135], v[168:171], a[120:123], v[132:135]
ds_read_b64_tr_b16 a[80:81], v14 offset:16384
ds_read_b64_tr_b16 a[82:83], v14 offset:20480
M v[136:139], v[176:179], a[120:123], 0
M v[136:139], v[180:183], a[124:127], v[136:139]
s_add_u32 s25, s25, s3
s_lshl_b32 s3, s3, 3
s_add_u32 s26, s26, s3
M v[140:143], v[188:191], a[124:127], 0
M v[140:143], v[184:187], a[120:123], v[140:143]
ds_read_b64_tr_b16 a[84:85], v14 offset:24576
ds_read_b64_tr_b16 a[86:87], v14 offset:28672
M v[144:147], v[192:195], a[120:123], 0
M v[144:147], v[196:199], a[124:127], v[144:147]
ds_read_b64_tr_b16 a[88:89], v15 offset:16384
ds_read_b64_tr_b16 a[90:91], v15 offset:20480
M v[148:151], v[204:207], a[124:127], 0
M v[148:151], v[200:203], a[120:123], v[148:151]
ds_read_b64_tr_b16 a[92:93], v15 offset:24576
ds_read_b64_tr_b16 a[94:95], v15 offset:28672
M v[152:155], v[208:211], a[120:123], 0
M v[152:155], v[212:215], a[124:127], v[152:155]
M v[156:159], v[220:223], a[124:127], 0
M v[156:159], v[216:219], a[120:123], v[156:159]
s_waitcnt vmcnt(24) lgkmcnt(0)
s_barrier
M v[32:35], a[32:35], a[128:131], v[32:35]
s_add_u32 m0, s41, 81920
s_nop 0
buffer_load_dwordx4 v2, s[48:51], s26 offen offset:0 lds
M v[32:35], a[36:39], a[132:135], v[32:35]
M v[36:39], a[44:47], a[132:135], v[36:39]
ds_read_b64_tr_b16 v[160:161], v8 offset:32768
ds_read_b64_tr_b16 v[162:163], v8 offset:36864
M v[36:39], a[40:43], a[128:131], v[36:39]
M v[40:43], a[48:51], a[128:131], v[40:43]
buffer_load_dwordx4 v3, s[48:51], s26 offen offset:1024 lds
M v[40:43], a[52:55], a[132:135], v[40:43]
M v[44:47], a[60:63], a[132:135], v[44:47]
ds_read_b64_tr_b16 v[164:165], v8 offset:40960
ds_read_b64_tr_b16 v[166:167], v8 offset:45056
M v[44:47], a[56:59], a[128:131], v[44:47]
M v[48:51], a[64:67], a[128:131], v[48:51]
buffer_load_dwordx4 v4, s[48:51], s26 offen offset:2048 lds
M v[48:51], a[68:71], a[132:135], v[48:51]
M v[52:55], a[76:79], a[132:135], v[52:55]
ds_read_b64_tr_b16 v[168:169], v9 offset:32768
ds_read_b64_tr_b16 v[170:171], v9 offset:36864
M v[52:55], a[72:75], a[128:131], v[52:55]
M v[56:59], a[80:83], a[128:131], v[56:59]
buffer_load_dwordx4 v5, s[48:51], s26 offen offset:3072 lds
M v[56:59], a[84:87], a[132:135], v[56:59]
M v[60:63], a[92:95], a[132:135], v[60:63]
ds_read_b64_tr_b16 v[172:173], v9 offset:40960
ds_read_b64_tr_b16 v[174:175], v9 offset:45056
M v[60:63], a[88:91], a[128:131], v[60:63]
M v[64:67], a[32:35], a[136:139], v[64:67]
buffer_load_dwordx4 a[96:99], v1, s[44:47], s25 offen offset:0 sc1
M v[64:67], a[36:39], a[140:143], v[64:67]
M v[68:71], a[44:47], a[140:143], v[68:71]
ds_read_b64_tr_b16 v[176:177], v10 offset:32768
ds_read_b64_tr_b16 v[178:179], v10 offset:36864
M v[68:71], a[40:43], a[136:139], v[68:71]
M v[72:75], a[48:51], a[136:139], v[72:75]
buffer_load_dwordx4 a[100:103], v1, s[44:47], s25 offen offset:1024 sc1
M v[72:75], a[52:55], a[140:143], v[72:75]
M v[76:79], a[60:63], a[140:143], v[76:79]
ds_read_b64_tr_b16 v[180:181], v10 offset:40960
ds_read_b64_tr_b16 v[182:183], v10 offset:45056
M v[76:79], a[56:59], a[136:139], v[76:79]
M v[80:83], a[64:67], a[136:139], v[80:83]
buffer_load_dwordx4 a[104:107], v1, s[44:47], s25 offen offset:2048 sc1
M v[80:83], a[68:71], a[140:143], v[80:83]
M v[84:87], a[76:79], a[140:143], v[84:87]
ds_read_b64_tr_b16 v[184:185], v11 offset:32768
ds_read_b64_tr_b16 v[186:187], v11 offset:36864
M v[84:87], a[72:75], a[136:139], v[84:87]
M v[88:91], a[80:83], a[136:139], v[88:91]
buffer_load_dwordx4 a[108:111], v1, s[44:47], s25 offen offset:3072 sc1
M v[88:91], a[84:87], a[140:143], v[88:91]
M v[92:95], a[92:95], a[140:143], v[92:95]
M v[92:95], a[88:91], a[136:139], v[92:95]
ds_read_b64_tr_b16 v[188:189], v11 offset:40960
ds_read_b64_tr_b16 v[190:191], v11 offset:45056
M v[96:99], a[32:35], a[144:147], v[96:99]
M v[96:99], a[36:39], a[148:151], v[96:99]
s_add_u32 s63, s25, 4096
buffer_load_dwordx4 a[112:115], v1, s[44:47], s63 offen offset:0 sc1
M v[100:103], a[44:47], a[148:151], v[100:103]
M v[100:103], a[40:43], a[144:147], v[100:103]
ds_read_b64_tr_b16 v[192:193], v12 offset:32768
ds_read_b64_tr_b16 v[194:195], v12 offset:36864
M v[104:107], a[48:51], a[144:147], v[104:107]
M v[104:107], a[52:55], a[148:151], v[104:107]
buffer_load_dwordx4 a[116:119], v1, s[44:47], s63 offen offset:1024 sc1
M v[108:111], a[60:63], a[148:151], v[108:111]
M v[108:111], a[56:59], a[144:147], v[108:111]
ds_read_b64_tr_b16 v[196:197], v12 offset:40960
ds_read_b64_tr_b16 v[198:199], v12 offset:45056
M v[112:115], a[64:67], a[144:147], v[112:115]
M v[112:115], a[68:71], a[148:151], v[112:115]
buffer_load_dwordx4 a[120:123], v1, s[44:47], s63 offen offset:2048 sc1
M v[116:119], a[76:79], a[148:151], v[116:119]
M v[116:119], a[72:75], a[144:147], v[116:119]
ds_read_b64_tr_b16 v[200:201], v13 offset:32768
ds_read_b64_tr_b16 v[202:203], v13 offset:36864
M v[120:123], a[80:83], a[144:147], v[120:123]
M v[120:123], a[84:87], a[148:151], v[120:123]
buffer_load_dwordx4 a[124:127], v1, s[44:47], s63 offen offset:3072 sc1
M v[124:127], a[92:95], a[148:151], v[124:127]
M v[124:127], a[88:91], a[144:147], v[124:127]
ds_read_b64_tr_b16 v[204:205], v13 offset:40960
ds_read_b64_tr_b16 v[206:207], v13 offset:45056
M v[128:131], a[32:35], a[152:155], v[128:131]
M v[128:131], a[36:39], a[156:159], v[128:131]
s_sub_u32 s39, s39, 1
s_cmp_eq_u32 s39, 0
s_cselect_b32 s3, s64, s65
M v[132:135], a[44:47], a[156:159], v[132:135]
M v[132:135], a[40:43], a[152:155], v[132:135]
ds_read_b64_tr_b16 v[208:209], v14 offset:32768
ds_read_b64_tr_b16 v[210:211], v14 offset:36864
M v[136:139], a[48:51], a[152:155], v[136:139]
M v[136:139], a[52:55], a[156:159], v[136:139]
s_add_u32 s25, s25, s3
s_lshl_b32 s3, s3, 3
s_add_u32 s26, s26, s3
M v[140:143], a[60:63], a[156:159], v[140:143]
M v[140:143], a[56:59], a[152:155], v[140:143]
ds_read_b64_tr_b16 v[212:213], v14 offset:40960
ds_read_b64_tr_b16 v[214:215], v14 offset:45056
M v[144:147], a[64:67], a[152:155], v[144:147]
M v[144:147], a[68:71], a[156:159], v[144:147]
ds_read_b64_tr_b16 v[216:217], v15 offset:32768
ds_read_b64_tr_b16 v[218:219], v15 offset:36864
M v[148:151], a[76:79], a[156:159], v[148:151]
M v[148:151], a[72:75], a[152:155], v[148:151]
ds_read_b64_tr_b16 v[220:221], v15 offset:40960
ds_read_b64_tr_b16 v[222:223], v15 offset:45056
M v[152:155], a[80:83], a[152:155], v[152:155]
M v[152:155], a[84:87], a[156:159], v[152:155]
M v[156:159], a[92:95], a[156:159], v[156:159]
M v[156:159], a[88:91], a[152:155], v[156:159]
s_waitcnt vmcnt(24) lgkmcnt(0)
s_barrier
M v[32:35], v[160:163], a[160:163], v[32:35]
s_add_u32 m0, s41, 98304
s_nop 0
buffer_load_dwordx4 v2, s[48:51], s26 offen offset:0 lds
M v[32:35], v[164:167], a[164:167], v[32:35]
M v[36:39], v[172:175], a[164:167], v[36:39]
ds_read_b64_tr_b16 a[32:33], v8 offset:49152
ds_read_b64_tr_b16 a[34:35], v8 offset:53248
M v[36:39], v[168:171], a[160:163], v[36:39]
M v[40:43], v[176:179], a[160:163], v[40:43]
buffer_load_dwordx4 v3, s[48:51], s26 offen offset:1024 lds
M v[40:43], v[180:183], a[164:167], v[40:43]
M v[44:47], v[188:191], a[164:167], v[44:47]
ds_read_b64_tr_b16 a[36:37], v8 offset:57344
ds_read_b64_tr_b16 a[38:39], v8 offset:61440
M v[44:47], v[184:187], a[160:163], v[44:47]
M v[48:51], v[192:195], a[160:163], v[48:51]
buffer_load_dwordx4 v4, s[48:51], s26 offen offset:2048 lds
M v[48:51], v[196:199], a[164:167], v[48:51]
M v[52:55], v[204:207], a[164:167], v[52:55]
ds_read_b64_tr_b16 a[40:41], v9 offset:49152
ds_read_b64_tr_b16 a[42:43], v9 offset:53248
M v[52:55], v[200:203], a[160:163], v[52:55]
M v[56:59], v[208:211], a[160:163], v[56:59]
buffer_load_dwordx4 v5, s[48:51], s26 offen offset:3072 lds
M v[56:59], v[212:215], a[164:167], v[56:59]
M v[60:63], v[220:223], a[164:167], v[60:63]
ds_read_b64_tr_b16 a[44:45], v9 offset:57344
ds_read_b64_tr_b16 a[46:47], v9 offset:61440
M v[60:63], v[216:219], a[160:163], v[60:63]
M v[64:67], v[160:163], a[168:171], v[64:67]
buffer_load_dwordx4 a[128:131], v1, s[44:47], s25 offen offset:0 sc1
M v[64:67], v[164:167], a[172:175], v[64:67]
M v[68:71], v[172:175], a[172:175], v[68:71]
ds_read_b64_tr_b16 a[48:49], v10 offset:49152
ds_read_b64_tr_b16 a[50:51], v10 offset:53248
M v[68:71], v[168:171], a[168:171], v[68:71]
M v[72:75], v[176:179], a[168:171], v[72:75]
buffer_load_dwordx4 a[132:135], v1, s[44:47], s25 offen offset:1024 sc1
M v[72:75], v[180:183], a[172:175], v[72:75]
M v[76:79], v[188:191], a[172:175], v[76:79]
ds_read_b64_tr_b16 a[52:53], v10 offset:57344
ds_read_b64_tr_b16 a[54:55], v10 offset:61440
M v[76:79], v[184:187], a[168:171], v[76:79]
M v[80:83], v[192:195], a[168:171], v[80:83]
buffer_load_dwordx4 a[136:139], v1, s[44:47], s25 offen offset:2048 sc1
M v[80:83], v[196:199], a[172:175], v[80:83]
M v[84:87], v[204:207], a[172:175], v[84:87]
ds_read_b64_tr_b16 a[56:57], v11 offset:49152
ds_read_b64_tr_b16 a[58:59], v11 offset:53248
M v[84:87], v[200:203], a[168:171], v[84:87]
M v[88:91], v[208:211], a[168:171], v[88:91]
buffer_load_dwordx4 a[140:143], v1, s[44:47], s25 offen offset:3072 sc1
M v[88:91], v[212:215], a[172:175], v[88:91]
M v[92:95], v[220:223], a[172:175], v[92:95]
M v[92:95], v[216:219], a[168:171], v[92:95]
ds_read_b64_tr_b16 a[60:61], v11 offset:57344
ds_read_b64_tr_b16 a[62:63], v11 offset:61440
M v[96:99], v[160:163], a[176:179], v[96:99]
M v[96:99], v[164:167], a[180:183], v[96:99]
s_add_u32 s63, s25, 4096
buffer_load_dwordx4 a[144:147], v1, s[44:47], s63 offen offset:0 sc1
M v[100:103], v[172:175], a[180:183], v[100:103]
M v[100:103], v[168:171], a[176:179], v[100:103]
ds_read_b64_tr_b16 a[64:65], v12 offset:49152
ds_read_b64_tr_b16 a[66:67], v12 offset:53248
M v[104:107], v[176:179], a[176:179], v[104:107]
M v[104:107], v[180:183], a[180:183], v[104:107]
buffer_load_dwordx4 a[148:151], v1, s[44:47], s63 offen offset:1024 sc1
M v[108:111], v[188:191], a[180:183], v[108:111]
M v[108:111], v[184:187], a[176:179], v[108:111]
ds_read_b64_tr_b16 a[68:69], v12 offset:57344
ds_read_b64_tr_b16 a[70:71], v12 offset:61440
M v[112:115], v[192:195], a[176:179], v[112:115]
M v[112:115], v[196:199], a[180:183], v[112:115]
buffer_load_dwordx4 a[152:155], v1, s[44:47], s63 offen offset:2048 sc1
M v[116:119], v[204:207], a[180:183], v[116:119]
M v[116:119], v[200:203], a[176:179], v[116:119]
ds_read_b64_tr_b16 a[72:73], v13 offset:49152
ds_read_b64_tr_b16 a[74:75], v13 offset:53248
M v[120:123], v[208:211], a[176:179], v[120:123]
M v[120:123], v[212:215], a[180:183], v[120:123]
buffer_load_dwordx4 a[156:159], v1, s[44:47], s63 offen offset:3072 sc1
M v[124:127], v[220:223], a[180:183], v[124:127]
M v[124:127], v[216:219], a[176:179], v[124:127]
ds_read_b64_tr_b16 a[76:77], v13 offset:57344
ds_read_b64_tr_b16 a[78:79], v13 offset:61440
M v[128:131], v[160:163], a[184:187], v[128:131]
M v[128:131], v[164:167], a[188:191], v[128:131]
s_sub_u32 s39, s39, 1
s_cmp_eq_u32 s39, 0
s_cselect_b32 s3, s64, s65
M v[132:135], v[172:175], a[188:191], v[132:135]
M v[132:135], v[168:171], a[184:187], v[132:135]
ds_read_b64_tr_b16 a[80:81], v14 offset:49152
ds_read_b64_tr_b16 a[82:83], v14 offset:53248
M v[136:139], v[176:179], a[184:187], v[136:139]
M v[136:139], v[180:183], a[188:191], v[136:139]
s_add_u32 s25, s25, s3
s_lshl_b32 s3, s3, 3
s_add_u32 s26, s26, s3
M v[140:143], v[188:191], a[188:191], v[140:143]
M v[140:143], v[184:187], a[184:187], v[140:143]
ds_read_b64_tr_b16 a[84:85], v14 offset:57344
ds_read_b64_tr_b16 a[86:87], v14 offset:61440
M v[144:147], v[192:195], a[184:187], v[144:147]
M v[144:147], v[196:199], a[188:191], v[144:147]
ds_read_b64_tr_b16 a[88:89], v15 offset:49152
ds_read_b64_tr_b16 a[90:91], v15 offset:53248
M v[148:151], v[204:207], a[188:191], v[148:151]
M v[148:151], v[200:203], a[184:187], v[148:151]
ds_read_b64_tr_b16 a[92:93], v15 offset:57344
ds_read_b64_tr_b16 a[94:95], v15 offset:61440
M v[152:155], v[208:211], a[184:187], v[152:155]
M v[152:155], v[212:215], a[188:191], v[152:155]
M v[156:159], v[220:223], a[188:191], v[156:159]
M v[156:159], v[216:219], a[184:187], v[156:159]
s_waitcnt vmcnt(24) lgkmcnt(0)
s_barrier
M v[32:35], a[32:35], a[192:195], v[32:35]
s_add_u32 m0, s41, 114688
s_nop 0
buffer_load_dwordx4 v2, s[48:51], s26 offen offset:0 lds
M v[32:35], a[36:39], a[196:199], v[32:35]
M v[36:39], a[44:47], a[196:199], v[36:39]
ds_read_b64_tr_b16 v[160:161], v16 offset:0
ds_read_b64_tr_b16 v[162:163], v16 offset:4096
M v[36:39], a[40:43], a[192:195], v[36:39]
M v[40:43], a[48:51], a[192:195], v[40:43]
buffer_load_dwordx4 v3, s[48:51], s26 offen offset:1024 lds
M v[40:43], a[52:55], a[196:199], v[40:43]
M v[44:47], a[60:63], a[196:199], v[44:47]
ds_read_b64_tr_b16 v[164:165], v16 offset:8192
ds_read_b64_tr_b16 v[166:167], v16 offset:12288
M v[44:47], a[56:59], a[192:195], v[44:47]
M v[48:51], a[64:67], a[192:195], v[48:51]
buffer_load_dwordx4 v4, s[48:51], s26 offen offset:2048 lds
M v[48:51], a[68:71], a[196:199], v[48:51]
M v[52:55], a[76:79], a[196:199], v[52:55]
ds_read_b64_tr_b16 v[168:169], v17 offset:0
ds_read_b64_tr_b16 v[170:171], v17 offset:4096
M v[52:55], a[72:75], a[192:195], v[52:55]
M v[56:59], a[80:83], a[192:195], v[56:59]
buffer_load_dwordx4 v5, s[48:51], s26 offen offset:3072 lds
M v[56:59], a[84:87], a[196:199], v[56:59]
M v[60:63], a[92:95], a[196:199], v[60:63]
ds_read_b64_tr_b16 v[172:173], v17 offset:8192
ds_read_b64_tr_b16 v[174:175], v17 offset:12288
M v[60:63], a[88:91], a[192:195], v[60:63]
M v[64:67], a[32:35], a[200:203], v[64:67]
buffer_load_dwordx4 a[160:163], v1, s[44:47], s25 offen offset:0 sc1
M v[64:67], a[36:39], a[204:207], v[64:67]
M v[68:71], a[44:47], a[204:207], v[68:71]
ds_read_b64_tr_b16 v[176:177], v18 offset:0
ds_read_b64_tr_b16 v[178:179], v18 offset:4096
M v[68:71], a[40:43], a[200:203], v[68:71]
M v[72:75], a[48:51], a[200:203], v[72:75]
buffer_load_dwordx4 a[164:167], v1, s[44:47], s25 offen offset:1024 sc1
M v[72:75], a[52:55], a[204:207], v[72:75]
M v[76:79], a[60:63], a[204:207], v[76:79]
ds_read_b64_tr_b16 v[180:181], v18 offset:8192
ds_read_b64_tr_b16 v[182:183], v18 offset:12288
M v[76:79], a[56:59], a[200:203], v[76:79]
M v[80:83], a[64:67], a[200:203], v[80:83]
buffer_load_dwordx4 a[168:171], v1, s[44:47], s25 offen offset:2048 sc1
M v[80:83], a[68:71], a[204:207], v[80:83]
M v[84:87], a[76:79], a[204:207], v[84:87]
ds_read_b64_tr_b16 v[184:185], v19 offset:0
ds_read_b64_tr_b16 v[186:187], v19 offset:4096
M v[84:87], a[72:75], a[200:203], v[84:87]
M v[88:91], a[80:83], a[200:203], v[88:91]
buffer_load_dwordx4 a[172:175], v1, s[44:47], s25 offen offset:3072 sc1
M v[88:91], a[84:87], a[204:207], v[88:91]
M v[92:95], a[92:95], a[204:207], v[92:95]
M v[92:95], a[88:91], a[200:203], v[92:95]
ds_read_b64_tr_b16 v[188:189], v19 offset:8192
ds_read_b64_tr_b16 v[190:191], v19 offset:12288
M v[96:99], a[32:35], a[208:211], v[96:99]
M v[96:99], a[36:39], a[212:215], v[96:99]
s_add_u32 s63, s25, 4096
buffer_load_dwordx4 a[176:179], v1, s[44:47], s63 offen offset:0 sc1
M v[100:103], a[44:47], a[212:215], v[100:103]
M v[100:103], a[40:43], a[208:211], v[100:103]
ds_read_b64_tr_b16 v[192:193], v20 offset:0
ds_read_b64_tr_b16 v[194:195], v20 offset:4096
M v[104:107], a[48:51], a[208:211], v[104:107]
M v[104:107], a[52:55], a[212:215], v[104:107]
buffer_load_dwordx4 a[180:183], v1, s[44:47], s63 offen offset:1024 sc1
M v[108:111], a[60:63], a[212:215], v[108:111]
M v[108:111], a[56:59], a[208:211], v[108:111]
ds_read_b64_tr_b16 v[196:197], v20 offset:8192
ds_read_b64_tr_b16 v[198:199], v20 offset:12288
M v[112:115], a[64:67], a[208:211], v[112:115]
M v[112:115], a[68:71], a[212:215], v[112:115]
buffer_load_dwordx4 a[184:187], v1, s[44:47], s63 offen offset:2048 sc1
M v[116:119], a[76:79], a[212:215], v[116:119]
M v[116:119], a[72:75], a[208:211], v[116:119]
ds_read_b64_tr_b16 v[200:201], v21 offset:0
ds_read_b64_tr_b16 v[202:203], v21 offset:4096
M v[120:123], a[80:83], a[208:211], v[120:123]
M v[120:123], a[84:87], a[212:215], v[120:123]
buffer_load_dwordx4 a[188:191], v1, s[44:47], s63 offen offset:3072 sc1
M v[124:127], a[92:95], a[212:215], v[124:127]
M v[124:127], a[88:91], a[208:211], v[124:127]
ds_read_b64_tr_b16 v[204:205], v21 offset:8192
ds_read_b64_tr_b16 v[206:207], v21 offset:12288
M v[128:131], a[32:35], a[216:219], v[128:131]
M v[128:131], a[36:39], a[220:223], v[128:131]
s_sub_u32 s39, s39, 1
s_cmp_eq_u32 s39, 0
s_cselect_b32 s3, s64, s65
M v[132:135], a[44:47], a[220:223], v[132:135]
M v[132:135], a[40:43], a[216:219], v[132:135]
ds_read_b64_tr_b16 v[208:209], v22 offset:0
ds_read_b64_tr_b16 v[210:211], v22 offset:4096
M v[136:139], a[48:51], a[216:219], v[136:139]
M v[136:139], a[52:55], a[220:223], v[136:139]
s_add_u32 s25, s25, s3
s_lshl_b32 s3, s3, 3
s_add_u32 s26, s26, s3
M v[140:143], a[60:63], a[220:223], v[140:143]
M v[140:143], a[56:59], a[216:219], v[140:143]
ds_read_b64_tr_b16 v[212:213], v22 offset:8192
ds_read_b64_tr_b16 v[214:215], v22 offset:12288
M v[144:147], a[64:67], a[216:219], v[144:147]
M v[144:147], a[68:71], a[220:223], v[144:147]
ds_read_b64_tr_b16 v[216:217], v23 offset:0
ds_read_b64_tr_b16 v[218:219], v23 offset:4096
M v[148:151], a[76:79], a[220:223], v[148:151]
M v[148:151], a[72:75], a[216:219], v[148:151]
ds_read_b64_tr_b16 v[220:221], v23 offset:8192
ds_read_b64_tr_b16 v[222:223], v23 offset:12288
M v[152:155], a[80:83], a[216:219], v[152:155]
M v[152:155], a[84:87], a[220:223], v[152:155]
M v[156:159], a[92:95], a[220:223], v[156:159]
M v[156:159], a[88:91], a[216:219], v[156:159]
s_waitcnt vmcnt(24) lgkmcnt(0)
s_barrier
M v[32:35], v[160:163], a[224:227], v[32:35]
s_add_u32 m0, s41, 0
s_nop 0
buffer_load_dwordx4 v2, s[48:51], s26 offen offset:0 lds
M v[32:35], v[164:167], a[228:231], v[32:35]
M v[36:39], v[172:175], a[228:231], v[36:39]
ds_read_b64_tr_b16 a[32:33], v16 offset:16384
ds_read_b64_tr_b16 a[34:35], v16 offset:20480
M v[36:39], v[168:171], a[224:227], v[36:39]
M v[40:43], v[176:179], a[224:227], v[40:43]
buffer_load_dwordx4 v3, s[48:51], s26 offen offset:1024 lds
M v[40:43], v[180:183], a[228:231], v[40:43]
M v[44:47], v[188:191], a[228:231], v[44:47]
ds_read_b64_tr_b16 a[36:37], v16 offset:24576
ds_read_b64_tr_b16 a[38:39], v16 offset:28672
M v[44:47], v[184:187], a[224:227], v[44:47]
M v[48:51], v[192:195], a[224:227], v[48:51]
buffer_load_dwordx4 v4, s[48:51], s26 offen offset:2048 lds
M v[48:51], v[196:199], a[228:231], v[48:51]
M v[52:55], v[204:207], a[228:231], v[52:55]
ds_read_b64_tr_b16 a[40:41], v17 offset:16384
ds_read_b64_tr_b16 a[42:43], v17 offset:20480
M v[52:55], v[200:203], a[224:227], v[52:55]
M v[56:59], v[208:211], a[224:227], v[56:59]
buffer_load_dwordx4 v5, s[48:51], s26 offen offset:3072 lds
M v[56:59], v[212:215], a[228:231], v[56:59]
M v[60:63], v[220:223], a[228:231], v[60:63]
ds_read_b64_tr_b16 a[44:45], v17 offset:24576
ds_read_b64_tr_b16 a[46:47], v17 offset:28672
M v[60:63], v[216:219], a[224:227], v[60:63]
M v[64:67], v[160:163], a[232:235], v[64:67]
buffer_load_dwordx4 a[192:195], v1, s[44:47], s25 offen offset:0 sc1
M v[64:67], v[164:167], a[236:239], v[64:67]
M v[68:71], v[172:175], a[236:239], v[68:71]
ds_read_b64_tr_b16 a[48:49], v18 offset:16384
ds_read_b64_tr_b16 a[50:51], v18 offset:20480
M v[68:71], v[168:171], a[232:235], v[68:71]
M v[72:75], v[176:179], a[232:235], v[72:75]
buffer_load_dwordx4 a[196:199], v1, s[44:47], s25 offen offset:1024 sc1
M v[72:75], v[180:183], a[236:239], v[72:75]
M v[76:79], v[188:191], a[236:239], v[76:79]
ds_read_b64_tr_b16 a[52:53], v18 offset:24576
ds_read_b64_tr_b16 a[54:55], v18 offset:28672
M v[76:79], v[184:187], a[232:235], v[76:79]
M v[80:83], v[192:195], a[232:235], v[80:83]
buffer_load_dwordx4 a[200:203], v1, s[44:47], s25 offen offset:2048 sc1
M v[80:83], v[196:199], a[236:239], v[80:83]
M v[84:87], v[204:207], a[236:239], v[84:87]
ds_read_b64_tr_b16 a[56:57], v19 offset:16384
ds_read_b64_tr_b16 a[58:59], v19 offset:20480
M v[84:87], v[200:203], a[232:235], v[84:87]
M v[88:91], v[208:211], a[232:235], v[88:91]
buffer_load_dwordx4 a[204:207], v1, s[44:47], s25 offen offset:3072 sc1
M v[88:91], v[212:215], a[236:239], v[88:91]
M v[92:95], v[220:223], a[236:239], v[92:95]
M v[92:95], v[216:219], a[232:235], v[92:95]
ds_read_b64_tr_b16 a[60:61], v19 offset:24576
ds_read_b64_tr_b16 a[62:63], v19 offset:28672
M v[96:99], v[160:163], a[240:243], v[96:99]
M v[96:99], v[164:167], a[244:247], v[96:99]
s_add_u32 s63, s25, 4096
buffer_load_dwordx4 a[208:211], v1, s[44:47], s63 offen offset:0 sc1
M v[100:103], v[172:175], a[244:247], v[100:103]
M v[100:103], v[168:171], a[240:243], v[100:103]
ds_read_b64_tr_b16 a[64:65], v20 offset:16384
ds_read_b64_tr_b16 a[66:67], v20 offset:20480
M v[104:107], v[176:179], a[240:243], v[104:107]
M v[104:107], v[180:183], a[244:247], v[104:107]
buffer_load_dwordx4 a[212:215], v1, s[44:47], s63 offen offset:1024 sc1
M v[108:111], v[188:191], a[244:247], v[108:111]
M v[108:111], v[184:187], a[240:243], v[108:111]
ds_read_b64_tr_b16 a[68:69], v20 offset:24576
ds_read_b64_tr_b16 a[70:71], v20 offset:28672
M v[112:115], v[192:195], a[240:243], v[112:115]
M v[112:115], v[196:199], a[244:247], v[112:115]
buffer_load_dwordx4 a[216:219], v1, s[44:47], s63 offen offset:2048 sc1
M v[116:119], v[204:207], a[244:247], v[116:119]
M v[116:119], v[200:203], a[240:243], v[116:119]
ds_read_b64_tr_b16 a[72:73], v21 offset:16384
ds_read_b64_tr_b16 a[74:75], v21 offset:20480
M v[120:123], v[208:211], a[240:243], v[120:123]
M v[120:123], v[212:215], a[244:247], v[120:123]
buffer_load_dwordx4 a[220:223], v1, s[44:47], s63 offen offset:3072 sc1
M v[124:127], v[220:223], a[244:247], v[124:127]
M v[124:127], v[216:219], a[240:243], v[124:127]
ds_read_b64_tr_b16 a[76:77], v21 offset:24576
ds_read_b64_tr_b16 a[78:79], v21 offset:28672
M v[128:131], v[160:163], a[248:251], v[128:131]
M v[128:131], v[164:167], a[252:255], v[128:131]
s_sub_u32 s39, s39, 1
s_cmp_eq_u32 s39, 0
s_cselect_b32 s3, s64, s65
M v[132:135], v[172:175], a[252:255], v[132:135]
M v[132:135], v[168:171], a[248:251], v[132:135]
ds_read_b64_tr_b16 a[80:81], v22 offset:16384
ds_read_b64_tr_b16 a[82:83], v22 offset:20480
M v[136:139], v[176:179], a[248:251], v[136:139]
M v[136:139], v[180:183], a[252:255], v[136:139]
s_add_u32 s25, s25, s3
s_lshl_b32 s3, s3, 3
s_add_u32 s26, s26, s3
M v[140:143], v[188:191], a[252:255], v[140:143]
M v[140:143], v[184:187], a[248:251], v[140:143]
ds_read_b64_tr_b16 a[84:85], v22 offset:24576
ds_read_b64_tr_b16 a[86:87], v22 offset:28672
M v[144:147], v[192:195], a[248:251], v[144:147]
M v[144:147], v[196:199], a[252:255], v[144:147]
ds_read_b64_tr_b16 a[88:89], v23 offset:16384
ds_read_b64_tr_b16 a[90:91], v23 offset:20480
M v[148:151], v[204:207], a[252:255], v[148:151]
M v[148:151], v[200:203], a[248:251], v[148:151]
ds_read_b64_tr_b16 a[92:93], v23 offset:24576
ds_read_b64_tr_b16 a[94:95], v23 offset:28672
M v[152:155], v[208:211], a[248:251], v[152:155]
M v[152:155], v[212:215], a[252:255], v[152:155]
M v[156:159], v[220:223], a[252:255], v[156:159]
M v[156:159], v[216:219], a[248:251], v[156:159]
s_waitcnt vmcnt(24) lgkmcnt(0)
s_barrier
M v[32:35], a[32:35], a[96:99], v[32:35]
s_add_u32 m0, s41, 16384
s_nop 0
buffer_load_dwordx4 v2, s[48:51], s26 offen offset:0 lds
M v[32:35], a[36:39], a[100:103], v[32:35]
M v[36:39], a[44:47], a[100:103], v[36:39]
ds_read_b64_tr_b16 v[160:161], v16 offset:32768
ds_read_b64_tr_b16 v[162:163], v16 offset:36864
M v[36:39], a[40:43], a[96:99], v[36:39]
M v[40:43], a[48:51], a[96:99], v[40:43]
buffer_load_dwordx4 v3, s[48:51], s26 offen offset:1024 lds
M v[40:43], a[52:55], a[100:103], v[40:43]
M v[44:47], a[60:63], a[100:103], v[44:47]
ds_read_b64_tr_b16 v[164:165], v16 offset:40960
ds_read_b64_tr_b16 v[166:167], v16 offset:45056
M v[44:47], a[56:59], a[96:99], v[44:47]
M v[48:51], a[64:67], a[96:99], v[48:51]
buffer_load_dwordx4 v4, s[48:51], s26 offen offset:2048 lds
M v[48:51], a[68:71], a[100:103], v[48:51]
M v[52:55], a[76:79], a[100:103], v[52:55]
ds_read_b64_tr_b16 v[168:169], v17 offset:32768
ds_read_b64_tr_b16 v[170:171], v17 offset:36864
M v[52:55], a[72:75], a[96:99], v[52:55]
M v[56:59], a[80:83], a[96:99], v[56:59]
buffer_load_dwordx4 v5, s[48:51], s26 offen offset:3072 lds
M v[56:59], a[84:87], a[100:103], v[56:59]
M v[60:63], a[92:95], a[100:103], v[60:63]
ds_read_b64_tr_b16 v[172:173], v17 offset:40960
ds_read_b64_tr_b16 v[174:175], v17 offset:45056
M v[60:63], a[88:91], a[96:99], v[60:63]
M v[64:67], a[32:35], a[104:107], v[64:67]
buffer_load_dwordx4 a[224:227], v1, s[44:47], s25 offen offset:0 sc1
M v[64:67], a[36:39], a[108:111], v[64:67]
M v[68:71], a[44:47], a[108:111], v[68:71]
ds_read_b64_tr_b16 v[176:177], v18 offset:32768
ds_read_b64_tr_b16 v[178:179], v18 offset:36864
M v[68:71], a[40:43], a[104:107], v[68:71]
M v[72:75], a[48:51], a[104:107], v[72:75]
buffer_load_dwordx4 a[228:231], v1, s[44:47], s25 offen offset:1024 sc1
M v[72:75], a[52:55], a[108:111], v[72:75]
M v[76:79], a[60:63], a[108:111], v[76:79]
ds_read_b64_tr_b16 v[180:181], v18 offset:40960
ds_read_b64_tr_b16 v[182:183], v18 offset:45056
M v[76:79], a[56:59], a[104:107], v[76:79]
M v[80:83], a[64:67], a[104:107], v[80:83]
buffer_load_dwordx4 a[232:235], v1, s[44:47], s25 offen offset:2048 sc1
M v[80:83], a[68:71], a[108:111], v[80:83]
M v[84:87], a[76:79], a[108:111], v[84:87]
ds_read_b64_tr_b16 v[184:185], v19 offset:32768
ds_read_b64_tr_b16 v[186:187], v19 offset:36864
M v[84:87], a[72:75], a[104:107], v[84:87]
M v[88:91], a[80:83], a[104:107], v[88:91]
buffer_load_dwordx4 a[236:239], v1, s[44:47], s25 offen offset:3072 sc1
M v[88:91], a[84:87], a[108:111], v[88:91]
M v[92:95], a[92:95], a[108:111], v[92:95]
M v[92:95], a[88:91], a[104:107], v[92:95]
ds_read_b64_tr_b16 v[188:189], v19 offset:40960
ds_read_b64_tr_b16 v[190:191], v19 offset:45056
M v[96:99], a[32:35], a[112:115], v[96:99]
M v[96:99], a[36:39], a[116:119], v[96:99]
s_add_u32 s63, s25, 4096
buffer_load_dwordx4 a[240:243], v1, s[44:47], s63 offen offset:0 sc1
M v[100:103], a[44:47], a[116:119], v[100:103]
M v[100:103], a[40:43], a[112:115], v[100:103]
ds_read_b64_tr_b16 v[192:193], v20 offset:32768
ds_read_b64_tr_b16 v[194:195], v20 offset:36864
M v[104:107], a[48:51], a[112:115], v[104:107]
M v[104:107], a[52:55], a[116:119], v[104:107]
buffer_load_dwordx4 a[244:247], v1, s[44:47], s63 offen offset:1024 sc1
M v[108:111], a[60:63], a[116:119], v[108:111]
M v[108:111], a[56:59], a[112:115], v[108:111]
ds_read_b64_tr_b16 v[196:197], v20 offset:40960
ds_read_b64_tr_b16 v[198:199], v20 offset:45056
M v[112:115], a[64:67], a[112:115], v[112:115]
M v[112:115], a[68:71], a[116:119], v[112:115]
buffer_load_dwordx4 a[248:251], v1, s[44:47], s63 offen offset:2048 sc1
M v[116:119], a[76:79], a[116:119], v[116:119]
M v[116:119], a[72:75], a[112:115], v[116:119]
ds_read_b64_tr_b16 v[200:201], v21 offset:32768
ds_read_b64_tr_b16 v[202:203], v21 offset:36864
M v[120:123], a[80:83], a[112:115], v[120:123]
M v[120:123], a[84:87], a[116:119], v[120:123]
buffer_load_dwordx4 a[252:255], v1, s[44:47], s63 offen offset:3072 sc1
M v[124:127], a[92:95], a[116:119], v[124:127]
M v[124:127], a[88:91], a[112:115], v[124:127]
ds_read_b64_tr_b16 v[204:205], v21 offset:40960
ds_read_b64_tr_b16 v[206:207], v21 offset:45056
M v[128:131], a[32:35], a[120:123], v[128:131]
M v[128:131], a[36:39], a[124:127], v[128:131]
s_sub_u32 s39, s39, 1
s_cmp_eq_u32 s39, 0
s_cselect_b32 s3, s64, s65
M v[132:135], a[44:47], a[124:127], v[132:135]
M v[132:135], a[40:43], a[120:123], v[132:135]
ds_read_b64_tr_b16 v[208:209], v22 offset:32768
ds_read_b64_tr_b16 v[210:211], v22 offset:36864
M v[136:139], a[48:51], a[120:123], v[136:139]
M v[136:139], a[52:55], a[124:127], v[136:139]
s_add_u32 s25, s25, s3
s_lshl_b32 s3, s3, 3
s_add_u32 s26, s26, s3
M v[140:143], a[60:63], a[124:127], v[140:143]
M v[140:143], a[56:59], a[120:123], v[140:143]
ds_read_b64_tr_b16 v[212:213], v22 offset:40960
ds_read_b64_tr_b16 v[214:215], v22 offset:45056
M v[144:147], a[64:67], a[120:123], v[144:147]
M v[144:147], a[68:71], a[124:127], v[144:147]
ds_read_b64_tr_b16 v[216:217], v23 offset:32768
ds_read_b64_tr_b16 v[218:219], v23 offset:36864
M v[148:151], a[76:79], a[124:127], v[148:151]
M v[148:151], a[72:75], a[120:123], v[148:151]
ds_read_b64_tr_b16 v[220:221], v23 offset:40960
ds_read_b64_tr_b16 v[222:223], v23 offset:45056
M v[152:155], a[80:83], a[120:123], v[152:155]
M v[152:155], a[84:87], a[124:127], v[152:155]
M v[156:159], a[92:95], a[124:127], v[156:159]
M v[156:159], a[88:91], a[120:123], v[156:159]
s_waitcnt vmcnt(24) lgkmcnt(0)
s_barrier
M v[32:35], v[160:163], a[128:131], v[32:35]
s_add_u32 m0, s41, 32768
s_nop 0
buffer_load_dwordx4 v2, s[48:51], s26 offen offset:0 lds
M v[32:35], v[164:167], a[132:135], v[32:35]
M v[36:39], v[172:175], a[132:135], v[36:39]
ds_read_b64_tr_b16 a[32:33], v16 offset:49152
ds_read_b64_tr_b16 a[34:35], v16 offset:53248
M v[36:39], v[168:171], a[128:131], v[36:39]
M v[40:43], v[176:179], a[128:131], v[40:43]
buffer_load_dwordx4 v3, s[48:51], s26 offen offset:1024 lds
M v[40:43], v[180:183], a[132:135], v[40:43]
M v[44:47], v[188:191], a[132:135], v[44:47]
ds_read_b64_tr_b16 a[36:37], v16 offset:57344
ds_read_b64_tr_b16 a[38:39], v16 offset:61440
M v[44:47], v[184:187], a[128:131], v[44:47]
M v[48:51], v[192:195], a[128:131], v[48:51]
buffer_load_dwordx4 v4, s[48:51], s26 offen offset:2048 lds
M v[48:51], v[196:199], a[132:135], v[48:51]
M v[52:55], v[204:207], a[132:135], v[52:55]
ds_read_b64_tr_b16 a[40:41], v17 offset:49152
ds_read_b64_tr_b16 a[42:43], v17 offset:53248
M v[52:55], v[200:203], a[128:131], v[52:55]
M v[56:59], v[208:211], a[128:131], v[56:59]
buffer_load_dwordx4 v5, s[48:51], s26 offen offset:3072 lds
M v[56:59], v[212:215], a[132:135], v[56:59]
M v[60:63], v[220:223], a[132:135], v[60:63]
ds_read_b64_tr_b16 a[44:45], v17 offset:57344
ds_read_b64_tr_b16 a[46:47], v17 offset:61440
M v[60:63], v[216:219], a[128:131], v[60:63]
M v[64:67], v[160:163], a[136:139], v[64:67]
buffer_load_dwordx4 a[96:99], v1, s[44:47], s25 offen offset:0 sc1
M v[64:67], v[164:167], a[140:143], v[64:67]
M v[68:71], v[172:175], a[140:143], v[68:71]
ds_read_b64_tr_b16 a[48:49], v18 offset:49152
ds_read_b64_tr_b16 a[50:51], v18 offset:53248
M v[68:71], v[168:171], a[136:139], v[68:71]
M v[72:75], v[176:179], a[136:139], v[72:75]
buffer_load_dwordx4 a[100:103], v1, s[44:47], s25 offen offset:1024 sc1
M v[72:75], v[180:183], a[140:143], v[72:75]
M v[76:79], v[188:191], a[140:143], v[76:79]
ds_read_b64_tr_b16 a[52:53], v18 offset:57344
ds_read_b64_tr_b16 a[54:55], v18 offset:61440
M v[76:79], v[184:187], a[136:139], v[76:79]
M v[80:83], v[192:195], a[136:139], v[80:83]
buffer_load_dwordx4 a[104:107], v1, s[44:47], s25 offen offset:2048 sc1
M v[80:83], v[196:199], a[140:143], v[80:83]
M v[84:87], v[204:207], a[140:143], v[84:87]
ds_read_b64_tr_b16 a[56:57], v19 offset:49152
ds_read_b64_tr_b16 a[58:59], v19 offset:53248
M v[84:87], v[200:203], a[136:139], v[84:87]
M v[88:91], v[208:211], a[136:139], v[88:91]
buffer_load_dwordx4 a[108:111], v1, s[44:47], s25 offen offset:3072 sc1
M v[88:91], v[212:215], a[140:143], v[88:91]
M v[92:95], v[220:223], a[140:143], v[92:95]
M v[92:95], v[216:219], a[136:139], v[92:95]
ds_read_b64_tr_b16 a[60:61], v19 offset:57344
ds_read_b64_tr_b16 a[62:63], v19 offset:61440
M v[96:99], v[160:163], a[144:147], v[96:99]
M v[96:99], v[164:167], a[148:151], v[96:99]
s_add_u32 s63, s25, 4096
buffer_load_dwordx4 a[112:115], v1, s[44:47], s63 offen offset:0 sc1
M v[100:103], v[172:175], a[148:151], v[100:103]
M v[100:103], v[168:171], a[144:147], v[100:103]
ds_read_b64_tr_b16 a[64:65], v20 offset:49152
ds_read_b64_tr_b16 a[66:67], v20 offset:53248
M v[104:107], v[176:179], a[144:147], v[104:107]
M v[104:107], v[180:183], a[148:151], v[104:107]
buffer_load_dwordx4 a[116:119], v1, s[44:47], s63 offen offset:1024 sc1
M v[108:111], v[188:191], a[148:151], v[108:111]
M v[108:111], v[184:187], a[144:147], v[108:111]
ds_read_b64_tr_b16 a[68:69], v20 offset:57344
ds_read_b64_tr_b16 a[70:71], v20 offset:61440
M v[112:115], v[192:195], a[144:147], v[112:115]
M v[112:115], v[196:199], a[148:151], v[112:115]
buffer_load_dwordx4 a[120:123], v1, s[44:47], s63 offen offset:2048 sc1
M v[116:119], v[204:207], a[148:151], v[116:119]
M v[116:119], v[200:203], a[144:147], v[116:119]
ds_read_b64_tr_b16 a[72:73], v21 offset:49152
ds_read_b64_tr_b16 a[74:75], v21 offset:53248
M v[120:123], v[208:211], a[144:147], v[120:123]
M v[120:123], v[212:215], a[148:151], v[120:123]
buffer_load_dwordx4 a[124:127], v1, s[44:47], s63 offen offset:3072 sc1
M v[124:127], v[220:223], a[148:151], v[124:127]
M v[124:127], v[216:219], a[144:147], v[124:127]
ds_read_b64_tr_b16 a[76:77], v21 offset:57344
ds_read_b64_tr_b16 a[78:79], v21 offset:61440
M v[128:131], v[160:163], a[152:155], v[128:131]
M v[128:131], v[164:167], a[156:159], v[128:131]
s_sub_u32 s39, s39, 1
s_cmp_eq_u32 s39, 0
s_cselect_b32 s3, s64, s65
M v[132:135], v[172:175], a[156:159], v[132:135]
M v[132:135], v[168:171], a[152:155], v[132:135]
ds_read_b64_tr_b16 a[80:81], v22 offset:49152
ds_read_b64_tr_b16 a[82:83], v22 offset:53248
M v[136:139], v[176:179], a[152:155], v[136:139]
M v[136:139], v[180:183], a[156:159], v[136:139]
s_add_u32 s25, s25, s3
s_lshl_b32 s3, s3, 3
s_add_u32 s26, s26, s3
M v[140:143], v[188:191], a[156:159], v[140:143]
M v[140:143], v[184:187], a[152:155], v[140:143]
ds_read_b64_tr_b16 a[84:85], v22 offset:57344
ds_read_b64_tr_b16 a[86:87], v22 offset:61440
M v[144:147], v[192:195], a[152:155], v[144:147]
M v[144:147], v[196:199], a[156:159], v[144:147]
ds_read_b64_tr_b16 a[88:89], v23 offset:49152
ds_read_b64_tr_b16 a[90:91], v23 offset:53248
M v[148:151], v[204:207], a[156:159], v[148:151]
M v[148:151], v[200:203], a[152:155], v[148:151]
ds_read_b64_tr_b16 a[92:93], v23 offset:57344
ds_read_b64_tr_b16 a[94:95], v23 offset:61440
M v[152:155], v[208:211], a[152:155], v[152:155]
M v[152:155], v[212:215], a[156:159], v[152:155]
M v[156:159], v[220:223], a[156:159], v[156:159]
M v[156:159], v[216:219], a[152:155], v[156:159]
s_waitcnt vmcnt(24) lgkmcnt(0)
s_barrier
M v[32:35], a[32:35], a[160:163], v[32:35]
s_add_u32 m0, s41, 49152
s_nop 0
buffer_load_dwordx4 v2, s[48:51], s26 offen offset:0 lds
M v[32:35], a[36:39], a[164:167], v[32:35]
M v[36:39], a[44:47], a[164:167], v[36:39]
ds_read_b64_tr_b16 v[160:161], v8 offset:0
ds_read_b64_tr_b16 v[162:163], v8 offset:4096
M v[36:39], a[40:43], a[160:163], v[36:39]
M v[40:43], a[48:51], a[160:163], v[40:43]
buffer_load_dwordx4 v3, s[48:51], s26 offen offset:1024 lds
M v[40:43], a[52:55], a[164:167], v[40:43]
M v[44:47], a[60:63], a[164:167], v[44:47]
ds_read_b64_tr_b16 v[164:165], v8 offset:8192
ds_read_b64_tr_b16 v[166:167], v8 offset:12288
M v[44:47], a[56:59], a[160:163], v[44:47]
M v[48:51], a[64:67], a[160:163], v[48:51]
buffer_load_dwordx4 v4, s[48:51], s26 offen offset:2048 lds
M v[48:51], a[68:71], a[164:167], v[48:51]
M v[52:55], a[76:79], a[164:167], v[52:55]
ds_read_b64_tr_b16 v[168:169], v9 offset:0
ds_read_b64_tr_b16 v[170:171], v9 offset:4096
M v[52:55], a[72:75], a[160:163], v[52:55]
M v[56:59], a[80:83], a[160:163], v[56:59]
buffer_load_dwordx4 v5, s[48:51], s26 offen offset:3072 lds
M v[56:59], a[84:87], a[164:167], v[56:59]
M v[60:63], a[92:95], a[164:167], v[60:63]
ds_read_b64_tr_b16 v[172:173], v9 offset:8192
ds_read_b64_tr_b16 v[174:175], v9 offset:12288
M v[60:63], a[88:91], a[160:163], v[60:63]
M v[64:67], a[32:35], a[168:171], v[64:67]
buffer_load_dwordx4 a[128:131], v1, s[44:47], s25 offen offset:0 sc1
M v[64:67], a[36:39], a[172:175], v[64:67]
M v[68:71], a[44:47], a[172:175], v[68:71]
ds_read_b64_tr_b16 v[176:177], v10 offset:0
ds_read_b64_tr_b16 v[178:179], v10 offset:4096
M v[68:71], a[40:43], a[168:171], v[68:71]
M v[72:75], a[48:51], a[168:171], v[72:75]
buffer_load_dwordx4 a[132:135], v1, s[44:47], s25 offen offset:1024 sc1
M v[72:75], a[52:55], a[172:175], v[72:75]
M v[76:79], a[60:63], a[172:175], v[76:79]
ds_read_b64_tr_b16 v[180:181], v10 offset:8192
ds_read_b64_tr_b16 v[182:183], v10 offset:12288
M v[76:79], a[56:59], a[168:171], v[76:79]
M v[80:83], a[64:67], a[168:171], v[80:83]
buffer_load_dwordx4 a[136:139], v1, s[44:47], s25 offen offset:2048 sc1
M v[80:83], a[68:71], a[172:175], v[80:83]
M v[84:87], a[76:79], a[172:175], v[84:87]
ds_read_b64_tr_b16 v[184:185], v11 offset:0
ds_read_b64_tr_b16 v[186:187], v11 offset:4096
M v[84:87], a[72:75], a[168:171], v[84:87]
M v[88:91], a[80:83], a[168:171], v[88:91]
buffer_load_dwordx4 a[140:143], v1, s[44:47], s25 offen offset:3072 sc1
M v[88:91], a[84:87], a[172:175], v[88:91]
M v[92:95], a[92:95], a[172:175], v[92:95]
M v[92:95], a[88:91], a[168:171], v[92:95]
ds_read_b64_tr_b16 v[188:189], v11 offset:8192
ds_read_b64_tr_b16 v[190:191], v11 offset:12288
M v[96:99], a[32:35], a[176:179], v[96:99]
M v[96:99], a[36:39], a[180:183], v[96:99]
s_add_u32 s63, s25, 4096
buffer_load_dwordx4 a[144:147], v1, s[44:47], s63 offen offset:0 sc1
M v[100:103], a[44:47], a[180:183], v[100:103]
M v[100:103], a[40:43], a[176:179], v[100:103]
ds_read_b64_tr_b16 v[192:193], v12 offset:0
ds_read_b64_tr_b16 v[194:195], v12 offset:4096
M v[104:107], a[48:51], a[176:179], v[104:107]
M v[104:107], a[52:55], a[180:183], v[104:107]
buffer_load_dwordx4 a[148:151], v1, s[44:47], s63 offen offset:1024 sc1
M v[108:111], a[60:63], a[180:183], v[108:111]
M v[108:111], a[56:59], a[176:179], v[108:111]
ds_read_b64_tr_b16 v[196:197], v12 offset:8192
ds_read_b64_tr_b16 v[198:199], v12 offset:12288
M v[112:115], a[64:67], a[176:179], v[112:115]
M v[112:115], a[68:71], a[180:183], v[112:115]
buffer_load_dwordx4 a[152:155], v1, s[44:47], s63 offen offset:2048 sc1
M v[116:119], a[76:79], a[180:183], v[116:119]
M v[116:119], a[72:75], a[176:179], v[116:119]
ds_read_b64_tr_b16 v[200:201], v13 offset:0
ds_read_b64_tr_b16 v[202:203], v13 offset:4096
M v[120:123], a[80:83], a[176:179], v[120:123]
M v[120:123], a[84:87], a[180:183], v[120:123]
buffer_load_dwordx4 a[156:159], v1, s[44:47], s63 offen offset:3072 sc1
M v[124:127], a[92:95], a[180:183], v[124:127]
M v[124:127], a[88:91], a[176:179], v[124:127]
ds_read_b64_tr_b16 v[204:205], v13 offset:8192
ds_read_b64_tr_b16 v[206:207], v13 offset:12288
M v[128:131], a[32:35], a[184:187], v[128:131]
M v[128:131], a[36:39], a[188:191], v[128:131]
s_sub_u32 s39, s39, 1
s_cmp_eq_u32 s39, 0
s_cselect_b32 s3, s64, s65
M v[132:135], a[44:47], a[188:191], v[132:135]
M v[132:135], a[40:43], a[184:187], v[132:135]
ds_read_b64_tr_b16 v[208:209], v14 offset:0
ds_read_b64_tr_b16 v[210:211], v14 offset:4096
M v[136:139], a[48:51], a[184:187], v[136:139]
M v[136:139], a[52:55], a[188:191], v[136:139]
s_add_u32 s25, s25, s3
s_lshl_b32 s3, s3, 3
s_add_u32 s26, s26, s3
M v[140:143], a[60:63], a[188:191], v[140:143]
M v[140:143], a[56:59], a[184:187], v[140:143]
ds_read_b64_tr_b16 v[212:213], v14 offset:8192
ds_read_b64_tr_b16 v[214:215], v14 offset:12288
M v[144:147], a[64:67], a[184:187], v[144:147]
M v[144:147], a[68:71], a[188:191], v[144:147]
ds_read_b64_tr_b16 v[216:217], v15 offset:0
ds_read_b64_tr_b16 v[218:219], v15 offset:4096
M v[148:151], a[76:79], a[188:191], v[148:151]
M v[148:151], a[72:75], a[184:187], v[148:151]
ds_read_b64_tr_b16 v[220:221], v15 offset:8192
ds_read_b64_tr_b16 v[222:223], v15 offset:12288
M v[152:155], a[80:83], a[184:187], v[152:155]
M v[152:155], a[84:87], a[188:191], v[152:155]
M v[156:159], a[92:95], a[188:191], v[156:159]
M v[156:159], a[88:91], a[184:187], v[156:159]
s_waitcnt vmcnt(24) lgkmcnt(0)
s_barrier
M v[32:35], v[160:163], a[192:195], v[32:35]
s_add_u32 m0, s41, 65536
s_nop 0
buffer_load_dwordx4 v2, s[48:51], s26 offen offset:0 lds
M v[32:35], v[164:167], a[196:199], v[32:35]
M v[36:39], v[172:175], a[196:199], v[36:39]
ds_read_b64_tr_b16 a[32:33], v8 offset:16384
ds_read_b64_tr_b16 a[34:35], v8 offset:20480
M v[36:39], v[168:171], a[192:195], v[36:39]
M v[40:43], v[176:179], a[192:195], v[40:43]
buffer_load_dwordx4 v3, s[48:51], s26 offen offset:1024 lds
M v[40:43], v[180:183], a[196:199], v[40:43]
M v[44:47], v[188:191], a[196:199], v[44:47]
ds_read_b64_tr_b16 a[36:37], v8 offset:24576
ds_read_b64_tr_b16 a[38:39], v8 offset:28672
M v[44:47], v[184:187], a[192:195], v[44:47]
M v[48:51], v[192:195], a[192:195], v[48:51]
buffer_load_dwordx4 v4, s[48:51], s26 offen offset:2048 lds
M v[48:51], v[196:199], a[196:199], v[48:51]
M v[52:55], v[204:207], a[196:199], v[52:55]
ds_read_b64_tr_b16 a[40:41], v9 offset:16384
ds_read_b64_tr_b16 a[42:43], v9 offset:20480
M v[52:55], v[200:203], a[192:195], v[52:55]
M v[56:59], v[208:211], a[192:195], v[56:59]
buffer_load_dwordx4 v5, s[48:51], s26 offen offset:3072 lds
M v[56:59], v[212:215], a[196:199], v[56:59]
M v[60:63], v[220:223], a[196:199], v[60:63]
ds_read_b64_tr_b16 a[44:45], v9 offset:24576
ds_read_b64_tr_b16 a[46:47], v9 offset:28672
M v[60:63], v[216:219], a[192:195], v[60:63]
M v[64:67], v[160:163], a[200:203], v[64:67]
buffer_load_dwordx4 a[160:163], v1, s[44:47], s25 offen offset:0 sc1
M v[64:67], v[164:167], a[204:207], v[64:67]
M v[68:71], v[172:175], a[204:207], v[68:71]
ds_read_b64_tr_b16 a[48:49], v10 offset:16384
ds_read_b64_tr_b16 a[50:51], v10 offset:20480
M v[68:71], v[168:171], a[200:203], v[68:71]
M v[72:75], v[176:179], a[200:203], v[72:75]
buffer_load_dwordx4 a[164:167], v1, s[44:47], s25 offen offset:1024 sc1
M v[72:75], v[180:183], a[204:207], v[72:75]
M v[76:79], v[188:191], a[204:207], v[76:79]
ds_read_b64_tr_b16 a[52:53], v10 offset:24576
ds_read_b64_tr_b16 a[54:55], v10 offset:28672
M v[76:79], v[184:187], a[200:203], v[76:79]
M v[80:83], v[192:195], a[200:203], v[80:83]
buffer_load_dwordx4 a[168:171], v1, s[44:47], s25 offen offset:2048 sc1
M v[80:83], v[196:199], a[204:207], v[80:83]
M v[84:87], v[204:207], a[204:207], v[84:87]
ds_read_b64_tr_b16 a[56:57], v11 offset:16384
ds_read_b64_tr_b16 a[58:59], v11 offset:20480
M v[84:87], v[200:203], a[200:203], v[84:87]
M v[88:91], v[208:211], a[200:203], v[88:91]
buffer_load_dwordx4 a[172:175], v1, s[44:47], s25 offen offset:3072 sc1
M v[88:91], v[212:215], a[204:207], v[88:91]
M v[92:95], v[220:223], a[204:207], v[92:95]
M v[92:95], v[216:219], a[200:203], v[92:95]
ds_read_b64_tr_b16 a[60:61], v11 offset:24576
ds_read_b64_tr_b16 a[62:63], v11 offset:28672
M v[96:99], v[160:163], a[208:211], v[96:99]
M v[96:99], v[164:167], a[212:215], v[96:99]
s_add_u32 s63, s25, 4096
buffer_load_dwordx4 a[176:179], v1, s[44:47], s63 offen offset:0 sc1
M v[100:103], v[172:175], a[212:215], v[100:103]
M v[100:103], v[168:171], a[208:211], v[100:103]
ds_read_b64_tr_b16 a[64:65], v12 offset:16384
ds_read_b64_tr_b16 a[66:67], v12 offset:20480
M v[104:107], v[176:179], a[208:211], v[104:107]
M v[104:107], v[180:183], a[212:215], v[104:107]
buffer_load_dwordx4 a[180:183], v1, s[44:47], s63 offen offset:1024 sc1
M v[108:111], v[188:191], a[212:215], v[108:111]
M v[108:111], v[184:187], a[208:211], v[108:111]
ds_read_b64_tr_b16 a[68:69], v12 offset:24576
ds_read_b64_tr_b16 a[70:71], v12 offset:28672
M v[112:115], v[192:195], a[208:211], v[112:115]
M v[112:115], v[196:199], a[212:215], v[112:115]
buffer_load_dwordx4 a[184:187], v1, s[44:47], s63 offen offset:2048 sc1
M v[116:119], v[204:207], a[212:215], v[116:119]
M v[116:119], v[200:203], a[208:211], v[116:119]
ds_read_b64_tr_b16 a[72:73], v13 offset:16384
ds_read_b64_tr_b16 a[74:75], v13 offset:20480
M v[120:123], v[208:211], a[208:211], v[120:123]
M v[120:123], v[212:215], a[212:215], v[120:123]
buffer_load_dwordx4 a[188:191], v1, s[44:47], s63 offen offset:3072 sc1
M v[124:127], v[220:223], a[212:215], v[124:127]
M v[124:127], v[216:219], a[208:211], v[124:127]
ds_read_b64_tr_b16 a[76:77], v13 offset:24576
ds_read_b64_tr_b16 a[78:79], v13 offset:28672
M v[128:131], v[160:163], a[216:219], v[128:131]
M v[128:131], v[164:167], a[220:223], v[128:131]
s_sub_u32 s39, s39, 1
s_cmp_eq_u32 s39, 0
s_cselect_b32 s3, s64, s65
M v[132:135], v[172:175], a[220:223], v[132:135]
M v[132:135], v[168:171], a[216:219], v[132:135]
ds_read_b64_tr_b16 a[80:81], v14 offset:16384
ds_read_b64_tr_b16 a[82:83], v14 offset:20480
M v[136:139], v[176:179], a[216:219], v[136:139]
M v[136:139], v[180:183], a[220:223], v[136:139]
s_add_u32 s25, s25, s3
s_lshl_b32 s3, s3, 3
s_add_u32 s26, s26, s3
M v[140:143], v[188:191], a[220:223], v[140:143]
M v[140:143], v[184:187], a[216:219], v[140:143]
ds_read_b64_tr_b16 a[84:85], v14 offset:24576
ds_read_b64_tr_b16 a[86:87], v14 offset:28672
M v[144:147], v[192:195], a[216:219], v[144:147]
M v[144:147], v[196:199], a[220:223], v[144:147]
ds_read_b64_tr_b16 a[88:89], v15 offset:16384
ds_read_b64_tr_b16 a[90:91], v15 offset:20480
M v[148:151], v[204:207], a[220:223], v[148:151]
M v[148:151], v[200:203], a[216:219], v[148:151]
ds_read_b64_tr_b16 a[92:93], v15 offset:24576
ds_read_b64_tr_b16 a[94:95], v15 offset:28672
M v[152:155], v[208:211], a[216:219], v[152:155]
M v[152:155], v[212:215], a[220:223], v[152:155]
M v[156:159], v[220:223], a[220:223], v[156:159]
M v[156:159], v[216:219], a[216:219], v[156:159]
s_waitcnt vmcnt(24) lgkmcnt(0)
s_barrier
M v[32:35], a[32:35], a[224:227], v[32:35]
s_add_u32 m0, s41, 81920
s_nop 0
buffer_load_dwordx4 v2, s[48:51], s26 offen offset:0 lds
M v[32:35], a[36:39], a[228:231], v[32:35]
M v[36:39], a[44:47], a[228:231], v[36:39]
ds_read_b64_tr_b16 v[160:161], v8 offset:32768
ds_read_b64_tr_b16 v[162:163], v8 offset:36864
M v[36:39], a[40:43], a[224:227], v[36:39]
M v[40:43], a[48:51], a[224:227], v[40:43]
buffer_load_dwordx4 v3, s[48:51], s26 offen offset:1024 lds
M v[40:43], a[52:55], a[228:231], v[40:43]
M v[44:47], a[60:63], a[228:231], v[44:47]
ds_read_b64_tr_b16 v[164:165], v8 offset:40960
ds_read_b64_tr_b16 v[166:167], v8 offset:45056
M v[44:47], a[56:59], a[224:227], v[44:47]
M v[48:51], a[64:67], a[224:227], v[48:51]
buffer_load_dwordx4 v4, s[48:51], s26 offen offset:2048 lds
M v[48:51], a[68:71], a[228:231], v[48:51]
M v[52:55], a[76:79], a[228:231], v[52:55]
ds_read_b64_tr_b16 v[168:169], v9 offset:32768
ds_read_b64_tr_b16 v[170:171], v9 offset:36864
M v[52:55], a[72:75], a[224:227], v[52:55]
M v[56:59], a[80:83], a[224:227], v[56:59]
buffer_load_dwordx4 v5, s[48:51], s26 offen offset:3072 lds
M v[56:59], a[84:87], a[228:231], v[56:59]
M v[60:63], a[92:95], a[228:231], v[60:63]
ds_read_b64_tr_b16 v[172:173], v9 offset:40960
ds_read_b64_tr_b16 v[174:175], v9 offset:45056
M v[60:63], a[88:91], a[224:227], v[60:63]
M v[64:67], a[32:35], a[232:235], v[64:67]
buffer_load_dwordx4 a[192:195], v1, s[44:47], s25 offen offset:0 sc1
M v[64:67], a[36:39], a[236:239], v[64:67]
M v[68:71], a[44:47], a[236:239], v[68:71]
ds_read_b64_tr_b16 v[176:177], v10 offset:32768
ds_read_b64_tr_b16 v[178:179], v10 offset:36864
M v[68:71], a[40:43], a[232:235], v[68:71]
M v[72:75], a[48:51], a[232:235], v[72:75]
buffer_load_dwordx4 a[196:199], v1, s[44:47], s25 offen offset:1024 sc1
M v[72:75], a[52:55], a[236:239], v[72:75]
M v[76:79], a[60:63], a[236:239], v[76:79]
ds_read_b64_tr_b16 v[180:181], v10 offset:40960
ds_read_b64_tr_b16 v[182:183], v10 offset:45056
M v[76:79], a[56:59], a[232:235], v[76:79]
M v[80:83], a[64:67], a[232:235], v[80:83]
buffer_load_dwordx4 a[200:203], v1, s[44:47], s25 offen offset:2048 sc1
M v[80:83], a[68:71], a[236:239], v[80:83]
M v[84:87], a[76:79], a[236:239], v[84:87]
ds_read_b64_tr_b16 v[184:185], v11 offset:32768
ds_read_b64_tr_b16 v[186:187], v11 offset:36864
M v[84:87], a[72:75], a[232:235], v[84:87]
M v[88:91], a[80:83], a[232:235], v[88:91]
buffer_load_dwordx4 a[204:207], v1, s[44:47], s25 offen offset:3072 sc1
M v[88:91], a[84:87], a[236:239], v[88:91]
M v[92:95], a[92:95], a[236:239], v[92:95]
M v[92:95], a[88:91], a[232:235], v[92:95]
ds_read_b64_tr_b16 v[188:189], v11 offset:40960
ds_read_b64_tr_b16 v[190:191], v11 offset:45056
M v[96:99], a[32:35], a[240:243], v[96:99]
M v[96:99], a[36:39], a[244:247], v[96:99]
s_add_u32 s63, s25, 4096
buffer_load_dwordx4 a[208:211], v1, s[44:47], s63 offen offset:0 sc1
M v[100:103], a[44:47], a[244:247], v[100:103]
M v[100:103], a[40:43], a[240:243], v[100:103]
ds_read_b64_tr_b16 v[192:193], v12 offset:32768
ds_read_b64_tr_b16 v[194:195], v12 offset:36864
M v[104:107], a[48:51], a[240:243], v[104:107]
M v[104:107], a[52:55], a[244:247], v[104:107]
buffer_load_dwordx4 a[212:215], v1, s[44:47], s63 offen offset:1024 sc1
M v[108:111], a[60:63], a[244:247], v[108:111]
M v[108:111], a[56:59], a[240:243], v[108:111]
ds_read_b64_tr_b16 v[196:197], v12 offset:40960
ds_read_b64_tr_b16 v[198:199], v12 offset:45056
M v[112:115], a[64:67], a[240:243], v[112:115]
M v[112:115], a[68:71], a[244:247], v[112:115]
buffer_load_dwordx4 a[216:219], v1, s[44:47], s63 offen offset:2048 sc1
M v[116:119], a[76:79], a[244:247], v[116:119]
M v[116:119], a[72:75], a[240:243], v[116:119]
ds_read_b64_tr_b16 v[200:201], v13 offset:32768
ds_read_b64_tr_b16 v[202:203], v13 offset:36864
M v[120:123], a[80:83], a[240:243], v[120:123]
M v[120:123], a[84:87], a[244:247], v[120:123]
buffer_load_dwordx4 a[220:223], v1, s[44:47], s63 offen offset:3072 sc1
M v[124:127], a[92:95], a[244:247], v[124:127]
M v[124:127], a[88:91], a[240:243], v[124:127]
ds_read_b64_tr_b16 v[204:205], v13 offset:40960
ds_read_b64_tr_b16 v[206:207], v13 offset:45056
M v[128:131], a[32:35], a[248:251], v[128:131]
M v[128:131], a[36:39], a[252:255], v[128:131]
s_sub_u32 s39, s39, 1
s_cmp_eq_u32 s39, 0
s_cselect_b32 s3, s64, s65
M v[132:135], a[44:47], a[252:255], v[132:135]
M v[132:135], a[40:43], a[248:251], v[132:135]
ds_read_b64_tr_b16 v[208:209], v14 offset:32768
ds_read_b64_tr_b16 v[210:211], v14 offset:36864
M v[136:139], a[48:51], a[248:251], v[136:139]
M v[136:139], a[52:55], a[252:255], v[136:139]
s_add_u32 s25, s25, s3
s_lshl_b32 s3, s3, 3
s_add_u32 s26, s26, s3
M v[140:143], a[60:63], a[252:255], v[140:143]
M v[140:143], a[56:59], a[248:251], v[140:143]
ds_read_b64_tr_b16 v[212:213], v14 offset:40960
ds_read_b64_tr_b16 v[214:215], v14 offset:45056
M v[144:147], a[64:67], a[248:251], v[144:147]
M v[144:147], a[68:71], a[252:255], v[144:147]
ds_read_b64_tr_b16 v[216:217], v15 offset:32768
ds_read_b64_tr_b16 v[218:219], v15 offset:36864
M v[148:151], a[76:79], a[252:255], v[148:151]
M v[148:151], a[72:75], a[248:251], v[148:151]
ds_read_b64_tr_b16 v[220:221], v15 offset:40960
ds_read_b64_tr_b16 v[222:223], v15 offset:45056
M v[152:155], a[80:83], a[248:251], v[152:155]
M v[152:155], a[84:87], a[252:255], v[152:155]
M v[156:159], a[92:95], a[252:255], v[156:159]
M v[156:159], a[88:91], a[248:251], v[156:159]
s_waitcnt vmcnt(24) lgkmcnt(0)
s_barrier
M v[32:35], v[160:163], a[96:99], v[32:35]
s_add_u32 m0, s41, 98304
s_nop 0
buffer_load_dwordx4 v2, s[48:51], s26 offen offset:0 lds
M v[32:35], v[164:167], a[100:103], v[32:35]
M v[36:39], v[172:175], a[100:103], v[36:39]
ds_read_b64_tr_b16 a[32:33], v8 offset:49152
ds_read_b64_tr_b16 a[34:35], v8 offset:53248
M v[36:39], v[168:171], a[96:99], v[36:39]
M v[40:43], v[176:179], a[96:99], v[40:43]
buffer_load_dwordx4 v3, s[48:51], s26 offen offset:1024 lds
M v[40:43], v[180:183], a[100:103], v[40:43]
M v[44:47], v[188:191], a[100:103], v[44:47]
ds_read_b64_tr_b16 a[36:37], v8 offset:57344
ds_read_b64_tr_b16 a[38:39], v8 offset:61440
M v[44:47], v[184:187], a[96:99], v[44:47]
M v[48:51], v[192:195], a[96:99], v[48:51]
buffer_load_dwordx4 v4, s[48:51], s26 offen offset:2048 lds
M v[48:51], v[196:199], a[100:103], v[48:51]
M v[52:55], v[204:207], a[100:103], v[52:55]
ds_read_b64_tr_b16 a[40:41], v9 offset:49152
ds_read_b64_tr_b16 a[42:43], v9 offset:53248
M v[52:55], v[200:203], a[96:99], v[52:55]
M v[56:59], v[208:211], a[96:99], v[56:59]
buffer_load_dwordx4 v5, s[48:51], s26 offen offset:3072 lds
M v[56:59], v[212:215], a[100:103], v[56:59]
M v[60:63], v[220:223], a[100:103], v[60:63]
ds_read_b64_tr_b16 a[44:45], v9 offset:57344
ds_read_b64_tr_b16 a[46:47], v9 offset:61440
M v[60:63], v[216:219], a[96:99], v[60:63]
M v[64:67], v[160:163], a[104:107], v[64:67]
buffer_load_dwordx4 a[224:227], v1, s[44:47], s25 offen offset:0 sc1
M v[64:67], v[164:167], a[108:111], v[64:67]
M v[68:71], v[172:175], a[108:111], v[68:71]
ds_read_b64_tr_b16 a[48:49], v10 offset:49152
ds_read_b64_tr_b16 a[50:51], v10 offset:53248
M v[68:71], v[168:171], a[104:107], v[68:71]
M v[72:75], v[176:179], a[104:107], v[72:75]
buffer_load_dwordx4 a[228:231], v1, s[44:47], s25 offen offset:1024 sc1
M v[72:75], v[180:183], a[108:111], v[72:75]
M v[76:79], v[188:191], a[108:111], v[76:79]
ds_read_b64_tr_b16 a[52:53], v10 offset:57344
ds_read_b64_tr_b16 a[54:55], v10 offset:61440
M v[76:79], v[184:187], a[104:107], v[76:79]
M v[80:83], v[192:195], a[104:107], v[80:83]
buffer_load_dwordx4 a[232:235], v1, s[44:47], s25 offen offset:2048 sc1
M v[80:83], v[196:199], a[108:111], v[80:83]
M v[84:87], v[204:207], a[108:111], v[84:87]
ds_read_b64_tr_b16 a[56:57], v11 offset:49152
ds_read_b64_tr_b16 a[58:59], v11 offset:53248
M v[84:87], v[200:203], a[104:107], v[84:87]
M v[88:91], v[208:211], a[104:107], v[88:91]
buffer_load_dwordx4 a[236:239], v1, s[44:47], s25 offen offset:3072 sc1
M v[88:91], v[212:215], a[108:111], v[88:91]
M v[92:95], v[220:223], a[108:111], v[92:95]
M v[92:95], v[216:219], a[104:107], v[92:95]
ds_read_b64_tr_b16 a[60:61], v11 offset:57344
ds_read_b64_tr_b16 a[62:63], v11 offset:61440
M v[96:99], v[160:163], a[112:115], v[96:99]
M v[96:99], v[164:167], a[116:119], v[96:99]
s_add_u32 s63, s25, 4096
buffer_load_dwordx4 a[240:243], v1, s[44:47], s63 offen offset:0 sc1
M v[100:103], v[172:175], a[116:119], v[100:103]
M v[100:103], v[168:171], a[112:115], v[100:103]
ds_read_b64_tr_b16 a[64:65], v12 offset:49152
ds_read_b64_tr_b16 a[66:67], v12 offset:53248
M v[104:107], v[176:179], a[112:115], v[104:107]
M v[104:107], v[180:183], a[116:119], v[104:107]
buffer_load_dwordx4 a[244:247], v1, s[44:47], s63 offen offset:1024 sc1
M v[108:111], v[188:191], a[116:119], v[108:111]
M v[108:111], v[184:187], a[112:115], v[108:111]
ds_read_b64_tr_b16 a[68:69], v12 offset:57344
ds_read_b64_tr_b16 a[70:71], v12 offset:61440
M v[112:115], v[192:195], a[112:115], v[112:115]
M v[112:115], v[196:199], a[116:119], v[112:115]
buffer_load_dwordx4 a[248:251], v1, s[44:47], s63 offen offset:2048 sc1
M v[116:119], v[204:207], a[116:119], v[116:119]
M v[116:119], v[200:203], a[112:115], v[116:119]
ds_read_b64_tr_b16 a[72:73], v13 offset:49152
ds_read_b64_tr_b16 a[74:75], v13 offset:53248
M v[120:123], v[208:211], a[112:115], v[120:123]
M v[120:123], v[212:215], a[116:119], v[120:123]
buffer_load_dwordx4 a[252:255], v1, s[44:47], s63 offen offset:3072 sc1
M v[124:127], v[220:223], a[116:119], v[124:127]
M v[124:127], v[216:219], a[112:115], v[124:127]
ds_read_b64_tr_b16 a[76:77], v13 offset:57344
ds_read_b64_tr_b16 a[78:79], v13 offset:61440
M v[128:131], v[160:163], a[120:123], v[128:131]
M v[128:131], v[164:167], a[124:127], v[128:131]
s_sub_u32 s39, s39, 1
s_cmp_eq_u32 s39, 0
s_cselect_b32 s3, s64, s65
M v[132:135], v[172:175], a[124:127], v[132:135]
M v[132:135], v[168:171], a[120:123], v[132:135]
ds_read_b64_tr_b16 a[80:81], v14 offset:49152
ds_read_b64_tr_b16 a[82:83], v14 offset:53248
M v[136:139], v[176:179], a[120:123], v[136:139]
M v[136:139], v[180:183], a[124:127], v[136:139]
s_add_u32 s25, s25, s3
s_lshl_b32 s3, s3, 3
s_add_u32 s26, s26, s3
M v[140:143], v[188:191], a[124:127], v[140:143]
M v[140:143], v[184:187], a[120:123], v[140:143]
ds_read_b64_tr_b16 a[84:85], v14 offset:57344
ds_read_b64_tr_b16 a[86:87], v14 offset:61440
M v[144:147], v[192:195], a[120:123], v[144:147]
M v[144:147], v[196:199], a[124:127], v[144:147]
ds_read_b64_tr_b16 a[88:89], v15 offset:49152
ds_read_b64_tr_b16 a[90:91], v15 offset:53248
M v[148:151], v[204:207], a[124:127], v[148:151]
M v[148:151], v[200:203], a[120:123], v[148:151]
ds_read_b64_tr_b16 a[92:93], v15 offset:57344
ds_read_b64_tr_b16 a[94:95], v15 offset:61440
M v[152:155], v[208:211], a[120:123], v[152:155]
M v[152:155], v[212:215], a[124:127], v[152:155]
M v[156:159], v[220:223], a[124:127], v[156:159]
M v[156:159], v[216:219], a[120:123], v[156:159]
s_waitcnt vmcnt(24) lgkmcnt(0)
s_barrier
M v[32:35], a[32:35], a[128:131], v[32:35]
s_add_u32 m0, s41, 114688
s_nop 0
buffer_load_dwordx4 v2, s[48:51], s26 offen offset:0 lds
M v[32:35], a[36:39], a[132:135], v[32:35]
M v[36:39], a[44:47], a[132:135], v[36:39]
ds_read_b64_tr_b16 v[160:161], v16 offset:0
ds_read_b64_tr_b16 v[162:163], v16 offset:4096
M v[36:39], a[40:43], a[128:131], v[36:39]
M v[40:43], a[48:51], a[128:131], v[40:43]
buffer_load_dwordx4 v3, s[48:51], s26 offen offset:1024 lds
M v[40:43], a[52:55], a[132:135], v[40:43]
M v[44:47], a[60:63], a[132:135], v[44:47]
ds_read_b64_tr_b16 v[164:165], v16 offset:8192
ds_read_b64_tr_b16 v[166:167], v16 offset:12288
M v[44:47], a[56:59], a[128:131], v[44:47]
M v[48:51], a[64:67], a[128:131], v[48:51]
buffer_load_dwordx4 v4, s[48:51], s26 offen offset:2048 lds
M v[48:51], a[68:71], a[132:135], v[48:51]
M v[52:55], a[76:79], a[132:135], v[52:55]
ds_read_b64_tr_b16 v[168:169], v17 offset:0
ds_read_b64_tr_b16 v[170:171], v17 offset:4096
M v[52:55], a[72:75], a[128:131], v[52:55]
M v[56:59], a[80:83], a[128:131], v[56:59]
buffer_load_dwordx4 v5, s[48:51], s26 offen offset:3072 lds
M v[56:59], a[84:87], a[132:135], v[56:59]
M v[60:63], a[92:95], a[132:135], v[60:63]
ds_read_b64_tr_b16 v[172:173], v17 offset:8192
ds_read_b64_tr_b16 v[174:175], v17 offset:12288
M v[60:63], a[88:91], a[128:131], v[60:63]
M v[64:67], a[32:35], a[136:139], v[64:67]
buffer_load_dwordx4 a[96:99], v1, s[44:47], s25 offen offset:0 sc1
M v[64:67], a[36:39], a[140:143], v[64:67]
M v[68:71], a[44:47], a[140:143], v[68:71]
ds_read_b64_tr_b16 v[176:177], v18 offset:0
ds_read_b64_tr_b16 v[178:179], v18 offset:4096
M v[68:71], a[40:43], a[136:139], v[68:71]
M v[72:75], a[48:51], a[136:139], v[72:75]
buffer_load_dwordx4 a[100:103], v1, s[44:47], s25 offen offset:1024 sc1
M v[72:75], a[52:55], a[140:143], v[72:75]
M v[76:79], a[60:63], a[140:143], v[76:79]
ds_read_b64_tr_b16 v[180:181], v18 offset:8192
ds_read_b64_tr_b16 v[182:183], v18 offset:12288
M v[76:79], a[56:59], a[136:139], v[76:79]
M v[80:83], a[64:67], a[136:139], v[80:83]
buffer_load_dwordx4 a[104:107], v1, s[44:47], s25 offen offset:2048 sc1
M v[80:83], a[68:71], a[140:143], v[80:83]
M v[84:87], a[76:79], a[140:143], v[84:87]
ds_read_b64_tr_b16 v[184:185], v19 offset:0
ds_read_b64_tr_b16 v[186:187], v19 offset:4096
M v[84:87], a[72:75], a[136:139], v[84:87]
M v[88:91], a[80:83], a[136:139], v[88:91]
buffer_load_dwordx4 a[108:111], v1, s[44:47], s25 offen offset:3072 sc1
M v[88:91], a[84:87], a[140:143], v[88:91]
M v[92:95], a[92:95], a[140:143], v[92:95]
M v[92:95], a[88:91], a[136:139], v[92:95]
ds_read_b64_tr_b16 v[188:189], v19 offset:8192
ds_read_b64_tr_b16 v[190:191], v19 offset:12288
M v[96:99], a[32:35], a[144:147], v[96:99]
M v[96:99], a[36:39], a[148:151], v[96:99]
s_add_u32 s63, s25, 4096
buffer_load_dwordx4 a[112:115], v1, s[44:47], s63 offen offset:0 sc1
M v[100:103], a[44:47], a[148:151], v[100:103]
M v[100:103], a[40:43], a[144:147], v[100:103]
ds_read_b64_tr_b16 v[192:193], v20 offset:0
ds_read_b64_tr_b16 v[194:195], v20 offset:4096
M v[104:107], a[48:51], a[144:147], v[104:107]
M v[104:107], a[52:55], a[148:151], v[104:107]
buffer_load_dwordx4 a[116:119], v1, s[44:47], s63 offen offset:1024 sc1
M v[108:111], a[60:63], a[148:151], v[108:111]
M v[108:111], a[56:59], a[144:147], v[108:111]
ds_read_b64_tr_b16 v[196:197], v20 offset:8192
ds_read_b64_tr_b16 v[198:199], v20 offset:12288
M v[112:115], a[64:67], a[144:147], v[112:115]
M v[112:115], a[68:71], a[148:151], v[112:115]
buffer_load_dwordx4 a[120:123], v1, s[44:47], s63 offen offset:2048 sc1
M v[116:119], a[76:79], a[148:151], v[116:119]
M v[116:119], a[72:75], a[144:147], v[116:119]
ds_read_b64_tr_b16 v[200:201], v21 offset:0
ds_read_b64_tr_b16 v[202:203], v21 offset:4096
M v[120:123], a[80:83], a[144:147], v[120:123]
M v[120:123], a[84:87], a[148:151], v[120:123]
buffer_load_dwordx4 a[124:127], v1, s[44:47], s63 offen offset:3072 sc1
M v[124:127], a[92:95], a[148:151], v[124:127]
M v[124:127], a[88:91], a[144:147], v[124:127]
ds_read_b64_tr_b16 v[204:205], v21 offset:8192
ds_read_b64_tr_b16 v[206:207], v21 offset:12288
M v[128:131], a[32:35], a[152:155], v[128:131]
M v[128:131], a[36:39], a[156:159], v[128:131]
s_sub_u32 s39, s39, 1
s_cmp_eq_u32 s39, 0
s_cselect_b32 s3, s64, s65
M v[132:135], a[44:47], a[156:159], v[132:135]
M v[132:135], a[40:43], a[152:155], v[132:135]
ds_read_b64_tr_b16 v[208:209], v22 offset:0
ds_read_b64_tr_b16 v[210:211], v22 offset:4096
M v[136:139], a[48:51], a[152:155], v[136:139]
M v[136:139], a[52:55], a[156:159], v[136:139]
s_add_u32 s25, s25, s3
s_lshl_b32 s3, s3, 3
s_add_u32 s26, s26, s3
M v[140:143], a[60:63], a[156:159], v[140:143]
M v[140:143], a[56:59], a[152:155], v[140:143]
ds_read_b64_tr_b16 v[212:213], v22 offset:8192
ds_read_b64_tr_b16 v[214:215], v22 offset:12288
M v[144:147], a[64:67], a[152:155], v[144:147]
M v[144:147], a[68:71], a[156:159], v[144:147]
ds_read_b64_tr_b16 v[216:217], v23 offset:0
ds_read_b64_tr_b16 v[218:219], v23 offset:4096
M v[148:151], a[76:79], a[156:159], v[148:151]
M v[148:151], a[72:75], a[152:155], v[148:151]
ds_read_b64_tr_b16 v[220:221], v23 offset:8192
ds_read_b64_tr_b16 v[222:223], v23 offset:12288
M v[152:155], a[80:83], a[152:155], v[152:155]
M v[152:155], a[84:87], a[156:159], v[152:155]
M v[156:159], a[92:95], a[156:159], v[156:159]
M v[156:159], a[88:91], a[152:155], v[156:159]
s_waitcnt vmcnt(24) lgkmcnt(0)
s_barrier
M v[32:35], v[160:163], a[160:163], v[32:35]
s_mov_b64 s[44:45], s[34:35]
s_mov_b32 s46, 4194304
s_mov_b64 s[48:49], s[36:37]
s_mov_b32 s50, 2097152
s_mov_b32 s25, s32
s_mov_b32 s26, s33
s_add_u32 m0, s42, 0
s_nop 0
buffer_load_dwordx4 v6, s[48:51], s26 offen offset:0 lds
M v[32:35], v[164:167], a[164:167], v[32:35]
M v[36:39], v[172:175], a[164:167], v[36:39]
ds_read_b64_tr_b16 a[32:33], v16 offset:16384
ds_read_b64_tr_b16 a[34:35], v16 offset:20480
M v[36:39], v[168:171], a[160:163], v[36:39]
M v[40:43], v[176:179], a[160:163], v[40:43]
M v[40:43], v[180:183], a[164:167], v[40:43]
buffer_load_dwordx4 v7, s[48:51], s26 offen offset:1024 lds
M v[44:47], v[188:191], a[164:167], v[44:47]
M v[44:47], v[184:187], a[160:163], v[44:47]
M v[48:51], v[192:195], a[160:163], v[48:51]
ds_read_b64_tr_b16 a[36:37], v16 offset:24576
ds_read_b64_tr_b16 a[38:39], v16 offset:28672
M v[48:51], v[196:199], a[164:167], v[48:51]
M v[52:55], v[204:207], a[164:167], v[52:55]
buffer_load_dwordx4 a[128:131], v1, s[44:47], s25 offen offset:0 sc1
M v[52:55], v[200:203], a[160:163], v[52:55]
M v[56:59], v[208:211], a[160:163], v[56:59]
M v[56:59], v[212:215], a[164:167], v[56:59]
ds_read_b64_tr_b16 a[40:41], v17 offset:16384
ds_read_b64_tr_b16 a[42:43], v17 offset:20480
M v[60:63], v[220:223], a[164:167], v[60:63]
M v[60:63], v[216:219], a[160:163], v[60:63]
M v[64:67], v[160:163], a[168:171], v[64:67]
buffer_load_dwordx4 a[132:135], v1, s[44:47], s25 offen offset:1024 sc1
M v[64:67], v[164:167], a[172:175], v[64:67]
M v[68:71], v[172:175], a[172:175], v[68:71]
ds_read_b64_tr_b16 a[44:45], v17 offset:24576
ds_read_b64_tr_b16 a[46:47], v17 offset:28672
M v[68:71], v[168:171], a[168:171], v[68:71]
M v[72:75], v[176:179], a[168:171], v[72:75]
M v[72:75], v[180:183], a[172:175], v[72:75]
buffer_load_dwordx4 a[136:139], v1, s[44:47], s25 offen offset:2048 sc1
M v[76:79], v[188:191], a[172:175], v[76:79]
M v[76:79], v[184:187], a[168:171], v[76:79]
M v[80:83], v[192:195], a[168:171], v[80:83]
ds_read_b64_tr_b16 a[48:49], v18 offset:16384
ds_read_b64_tr_b16 a[50:51], v18 offset:20480
M v[80:83], v[196:199], a[172:175], v[80:83]
M v[84:87], v[204:207], a[172:175], v[84:87]
buffer_load_dwordx4 a[140:143], v1, s[44:47], s25 offen offset:3072 sc1
M v[84:87], v[200:203], a[168:171], v[84:87]
M v[88:91], v[208:211], a[168:171], v[88:91]
M v[88:91], v[212:215], a[172:175], v[88:91]
ds_read_b64_tr_b16 a[52:53], v18 offset:24576
ds_read_b64_tr_b16 a[54:55], v18 offset:28672
M v[92:95], v[220:223], a[172:175], v[92:95]
M v[92:95], v[216:219], a[168:171], v[92:95]
M v[96:99], v[160:163], a[176:179], v[96:99]
s_add_u32 s25, s25, 16384
s_add_u32 s26, s26, 131072
M v[96:99], v[164:167], a[180:183], v[96:99]
M v[100:103], v[172:175], a[180:183], v[100:103]
M v[100:103], v[168:171], a[176:179], v[100:103]
ds_read_b64_tr_b16 a[56:57], v19 offset:16384
ds_read_b64_tr_b16 a[58:59], v19 offset:20480
M v[104:107], v[176:179], a[176:179], v[104:107]
M v[104:107], v[180:183], a[180:183], v[104:107]
ds_read_b64_tr_b16 a[60:61], v19 offset:24576
ds_read_b64_tr_b16 a[62:63], v19 offset:28672
M v[108:111], v[188:191], a[180:183], v[108:111]
M v[108:111], v[184:187], a[176:179], v[108:111]
M v[112:115], v[192:195], a[176:179], v[112:115]
ds_read_b64_tr_b16 a[64:65], v20 offset:16384
ds_read_b64_tr_b16 a[66:67], v20 offset:20480
M v[112:115], v[196:199], a[180:183], v[112:115]
M v[116:119], v[204:207], a[180:183], v[116:119]
M v[116:119], v[200:203], a[176:179], v[116:119]
ds_read_b64_tr_b16 a[68:69], v20 offset:24576
ds_read_b64_tr_b16 a[70:71], v20 offset:28672
M v[120:123], v[208:211], a[176:179], v[120:123]
M v[120:123], v[212:215], a[180:183], v[120:123]
ds_read_b64_tr_b16 a[72:73], v21 offset:16384
ds_read_b64_tr_b16 a[74:75], v21 offset:20480
M v[124:127], v[220:223], a[180:183], v[124:127]
M v[124:127], v[216:219], a[176:179], v[124:127]
M v[128:131], v[160:163], a[184:187], v[128:131]
ds_read_b64_tr_b16 a[76:77], v21 offset:24576
ds_read_b64_tr_b16 a[78:79], v21 offset:28672
M v[128:131], v[164:167], a[188:191], v[128:131]
M v[132:135], v[172:175], a[188:191], v[132:135]
M v[132:135], v[168:171], a[184:187], v[132:135]
ds_read_b64_tr_b16 a[80:81], v22 offset:16384
ds_read_b64_tr_b16 a[82:83], v22 offset:20480
M v[136:139], v[176:179], a[184:187], v[136:139]
M v[136:139], v[180:183], a[188:191], v[136:139]
ds_read_b64_tr_b16 a[84:85], v22 offset:24576
ds_read_b64_tr_b16 a[86:87], v22 offset:28672
M v[140:143], v[188:191], a[188:191], v[140:143]
M v[140:143], v[184:187], a[184:187], v[140:143]
M v[144:147], v[192:195], a[184:187], v[144:147]
ds_read_b64_tr_b16 a[88:89], v23 offset:16384
ds_read_b64_tr_b16 a[90:91], v23 offset:20480
M v[144:147], v[196:199], a[188:191], v[144:147]
M v[148:151], v[204:207], a[188:191], v[148:151]
M v[148:151], v[200:203], a[184:187], v[148:151]
ds_read_b64_tr_b16 a[92:93], v23 offset:24576
ds_read_b64_tr_b16 a[94:95], v23 offset:28672
M v[152:155], v[208:211], a[184:187], v[152:155]
M v[152:155], v[212:215], a[188:191], v[152:155]
M v[156:159], v[220:223], a[188:191], v[156:159]
M v[156:159], v[216:219], a[184:187], v[156:159]
s_waitcnt vmcnt(18) lgkmcnt(0)
s_barrier
M v[32:35], a[32:35], a[192:195], v[32:35]
s_add_u32 m0, s42, 16384
s_nop 0
buffer_load_dwordx4 v6, s[48:51], s26 offen offset:0 lds
M v[32:35], a[36:39], a[196:199], v[32:35]
M v[36:39], a[44:47], a[196:199], v[36:39]
ds_read_b64_tr_b16 v[160:161], v16 offset:32768
ds_read_b64_tr_b16 v[162:163], v16 offset:36864
M v[36:39], a[40:43], a[192:195], v[36:39]
M v[40:43], a[48:51], a[192:195], v[40:43]
M v[40:43], a[52:55], a[196:199], v[40:43]
buffer_load_dwordx4 v7, s[48:51], s26 offen offset:1024 lds
M v[44:47], a[60:63], a[196:199], v[44:47]
M v[44:47], a[56:59], a[192:195], v[44:47]
M v[48:51], a[64:67], a[192:195], v[48:51]
ds_read_b64_tr_b16 v[164:165], v16 offset:40960
ds_read_b64_tr_b16 v[166:167], v16 offset:45056
M v[48:51], a[68:71], a[196:199], v[48:51]
M v[52:55], a[76:79], a[196:199], v[52:55]
buffer_load_dwordx4 a[160:163], v1, s[44:47], s25 offen offset:0 sc1
M v[52:55], a[72:75], a[192:195], v[52:55]
M v[56:59], a[80:83], a[192:195], v[56:59]
M v[56:59], a[84:87], a[196:199], v[56:59]
ds_read_b64_tr_b16 v[168:169], v17 offset:32768
ds_read_b64_tr_b16 v[170:171], v17 offset:36864
M v[60:63], a[92:95], a[196:199], v[60:63]
M v[60:63], a[88:91], a[192:195], v[60:63]
M v[64:67], a[32:35], a[200:203], v[64:67]
buffer_load_dwordx4 a[164:167], v1, s[44:47], s25 offen offset:1024 sc1
M v[64:67], a[36:39], a[204:207], v[64:67]
M v[68:71], a[44:47], a[204:207], v[68:71]
ds_read_b64_tr_b16 v[172:173], v17 offset:40960
ds_read_b64_tr_b16 v[174:175], v17 offset:45056
M v[68:71], a[40:43], a[200:203], v[68:71]
M v[72:75], a[48:51], a[200:203], v[72:75]
M v[72:75], a[52:55], a[204:207], v[72:75]
buffer_load_dwordx4 a[168:171], v1, s[44:47], s25 offen offset:2048 sc1
M v[76:79], a[60:63], a[204:207], v[76:79]
M v[76:79], a[56:59], a[200:203], v[76:79]
M v[80:83], a[64:67], a[200:203], v[80:83]
ds_read_b64_tr_b16 v[176:177], v18 offset:32768
ds_read_b64_tr_b16 v[178:179], v18 offset:36864
M v[80:83], a[68:71], a[204:207], v[80:83]
M v[84:87], a[76:79], a[204:207], v[84:87]
buffer_load_dwordx4 a[172:175], v1, s[44:47], s25 offen offset:3072 sc1
M v[84:87], a[72:75], a[200:203], v[84:87]
M v[88:91], a[80:83], a[200:203], v[88:91]
M v[88:91], a[84:87], a[204:207], v[88:91]
ds_read_b64_tr_b16 v[180:181], v18 offset:40960
ds_read_b64_tr_b16 v[182:183], v18 offset:45056
M v[92:95], a[92:95], a[204:207], v[92:95]
M v[92:95], a[88:91], a[200:203], v[92:95]
M v[96:99], a[32:35], a[208:211], v[96:99]
s_add_u32 s25, s25, 16384
s_add_u32 s26, s26, 131072
M v[96:99], a[36:39], a[212:215], v[96:99]
M v[100:103], a[44:47], a[212:215], v[100:103]
M v[100:103], a[40:43], a[208:211], v[100:103]
ds_read_b64_tr_b16 v[184:185], v19 offset:32768
ds_read_b64_tr_b16 v[186:187], v19 offset:36864
M v[104:107], a[48:51], a[208:211], v[104:107]
M v[104:107], a[52:55], a[212:215], v[104:107]
ds_read_b64_tr_b16 v[188:189], v19 offset:40960
ds_read_b64_tr_b16 v[190:191], v19 offset:45056
M v[108:111], a[60:63], a[212:215], v[108:111]
M v[108:111], a[56:59], a[208:211], v[108:111]
M v[112:115], a[64:67], a[208:211], v[112:115]
ds_read_b64_tr_b16 v[192:193], v20 offset:32768
ds_read_b64_tr_b16 v[194:195], v20 offset:36864
M v[112:115], a[68:71], a[212:215], v[112:115]
M v[116:119], a[76:79], a[212:215], v[116:119]
M v[116:119], a[72:75], a[208:211], v[116:119]
ds_read_b64_tr_b16 v[196:197], v20 offset:40960
ds_read_b64_tr_b16 v[198:199], v20 offset:45056
M v[120:123], a[80:83], a[208:211], v[120:123]
M v[120:123], a[84:87], a[212:215], v[120:123]
ds_read_b64_tr_b16 v[200:201], v21 offset:32768
ds_read_b64_tr_b16 v[202:203], v21 offset:36864
M v[124:127], a[92:95], a[212:215], v[124:127]
M v[124:127], a[88:91], a[208:211], v[124:127]
M v[128:131], a[32:35], a[216:219], v[128:131]
ds_read_b64_tr_b16 v[204:205], v21 offset:40960
ds_read_b64_tr_b16 v[206:207], v21 offset:45056
M v[128:131], a[36:39], a[220:223], v[128:131]
M v[132:135], a[44:47], a[220:223], v[132:135]
M v[132:135], a[40:43], a[216:219], v[132:135]
ds_read_b64_tr_b16 v[208:209], v22 offset:32768
ds_read_b64_tr_b16 v[210:211], v22 offset:36864
M v[136:139], a[48:51], a[216:219], v[136:139]
M v[136:139], a[52:55], a[220:223], v[136:139]
ds_read_b64_tr_b16 v[212:213], v22 offset:40960
ds_read_b64_tr_b16 v[214:215], v22 offset:45056
M v[140:143], a[60:63], a[220:223], v[140:143]
M v[140:143], a[56:59], a[216:219], v[140:143]
M v[144:147], a[64:67], a[216:219], v[144:147]
ds_read_b64_tr_b16 v[216:217], v23 offset:32768
ds_read_b64_tr_b16 v[218:219], v23 offset:36864
M v[144:147], a[68:71], a[220:223], v[144:147]
M v[148:151], a[76:79], a[220:223], v[148:151]
M v[148:151], a[72:75], a[216:219], v[148:151]
ds_read_b64_tr_b16 v[220:221], v23 offset:40960
ds_read_b64_tr_b16 v[222:223], v23 offset:45056
M v[152:155], a[80:83], a[216:219], v[152:155]
M v[152:155], a[84:87], a[220:223], v[152:155]
M v[156:159], a[92:95], a[220:223], v[156:159]
M v[156:159], a[88:91], a[216:219], v[156:159]
s_waitcnt vmcnt(12) lgkmcnt(0)
s_barrier
M v[32:35], v[160:163], a[224:227], v[32:35]
s_add_u32 m0, s42, 32768
s_nop 0
buffer_load_dwordx4 v6, s[48:51], s26 offen offset:0 lds
M v[32:35], v[164:167], a[228:231], v[32:35]
M v[36:39], v[172:175], a[228:231], v[36:39]
ds_read_b64_tr_b16 a[32:33], v16 offset:49152
ds_read_b64_tr_b16 a[34:35], v16 offset:53248
M v[36:39], v[168:171], a[224:227], v[36:39]
M v[40:43], v[176:179], a[224:227], v[40:43]
M v[40:43], v[180:183], a[228:231], v[40:43]
buffer_load_dwordx4 v7, s[48:51], s26 offen offset:1024 lds
M v[44:47], v[188:191], a[228:231], v[44:47]
M v[44:47], v[184:187], a[224:227], v[44:47]
M v[48:51], v[192:195], a[224:227], v[48:51]
ds_read_b64_tr_b16 a[36:37], v16 offset:57344
ds_read_b64_tr_b16 a[38:39], v16 offset:61440
M v[48:51], v[196:199], a[228:231], v[48:51]
M v[52:55], v[204:207], a[228:231], v[52:55]
buffer_load_dwordx4 a[192:195], v1, s[44:47], s25 offen offset:0 sc1
M v[52:55], v[200:203], a[224:227], v[52:55]
M v[56:59], v[208:211], a[224:227], v[56:59]
M v[56:59], v[212:215], a[228:231], v[56:59]
ds_read_b64_tr_b16 a[40:41], v17 offset:49152
ds_read_b64_tr_b16 a[42:43], v17 offset:53248
M v[60:63], v[220:223], a[228:231], v[60:63]
M v[60:63], v[216:219], a[224:227], v[60:63]
M v[64:67], v[160:163], a[232:235], v[64:67]
buffer_load_dwordx4 a[196:199], v1, s[44:47], s25 offen offset:1024 sc1
M v[64:67], v[164:167], a[236:239], v[64:67]
M v[68:71], v[172:175], a[236:239], v[68:71]
ds_read_b64_tr_b16 a[44:45], v17 offset:57344
ds_read_b64_tr_b16 a[46:47], v17 offset:61440
M v[68:71], v[168:171], a[232:235], v[68:71]
M v[72:75], v[176:179], a[232:235], v[72:75]
M v[72:75], v[180:183], a[236:239], v[72:75]
buffer_load_dwordx4 a[200:203], v1, s[44:47], s25 offen offset:2048 sc1
M v[76:79], v[188:191], a[236:239], v[76:79]
M v[76:79], v[184:187], a[232:235], v[76:79]
M v[80:83], v[192:195], a[232:235], v[80:83]
ds_read_b64_tr_b16 a[48:49], v18 offset:49152
ds_read_b64_tr_b16 a[50:51], v18 offset:53248
M v[80:83], v[196:199], a[236:239], v[80:83]
M v[84:87], v[204:207], a[236:239], v[84:87]
buffer_load_dwordx4 a[204:207], v1, s[44:47], s25 offen offset:3072 sc1
M v[84:87], v[200:203], a[232:235], v[84:87]
M v[88:91], v[208:211], a[232:235], v[88:91]
M v[88:91], v[212:215], a[236:239], v[88:91]
ds_read_b64_tr_b16 a[52:53], v18 offset:57344
ds_read_b64_tr_b16 a[54:55], v18 offset:61440
M v[92:95], v[220:223], a[236:239], v[92:95]
M v[92:95], v[216:219], a[232:235], v[92:95]
M v[96:99], v[160:163], a[240:243], v[96:99]
s_add_u32 s25, s25, 16384
s_add_u32 s26, s26, 131072
M v[96:99], v[164:167], a[244:247], v[96:99]
M v[100:103], v[172:175], a[244:247], v[100:103]
M v[100:103], v[168:171], a[240:243], v[100:103]
ds_read_b64_tr_b16 a[56:57], v19 offset:49152
ds_read_b64_tr_b16 a[58:59], v19 offset:53248
M v[104:107], v[176:179], a[240:243], v[104:107]
M v[104:107], v[180:183], a[244:247], v[104:107]
ds_read_b64_tr_b16 a[60:61], v19 offset:57344
ds_read_b64_tr_b16 a[62:63], v19 offset:61440
M v[108:111], v[188:191], a[244:247], v[108:111]
M v[108:111], v[184:187], a[240:243], v[108:111]
M v[112:115], v[192:195], a[240:243], v[112:115]
ds_read_b64_tr_b16 a[64:65], v20 offset:49152
ds_read_b64_tr_b16 a[66:67], v20 offset:53248
M v[112:115], v[196:199], a[244:247], v[112:115]
M v[116:119], v[204:207], a[244:247], v[116:119]
M v[116:119], v[200:203], a[240:243], v[116:119]
ds_read_b64_tr_b16 a[68:69], v20 offset:57344
ds_read_b64_tr_b16 a[70:71], v20 offset:61440
M v[120:123], v[208:211], a[240:243], v[120:123]
M v[120:123], v[212:215], a[244:247], v[120:123]
ds_read_b64_tr_b16 a[72:73], v21 offset:49152
ds_read_b64_tr_b16 a[74:75], v21 offset:53248
M v[124:127], v[220:223], a[244:247], v[124:127]
M v[124:127], v[216:219], a[240:243], v[124:127]
M v[128:131], v[160:163], a[248:251], v[128:131]
ds_read_b64_tr_b16 a[76:77], v21 offset:57344
ds_read_b64_tr_b16 a[78:79], v21 offset:61440
M v[128:131], v[164:167], a[252:255], v[128:131]
M v[132:135], v[172:175], a[252:255], v[132:135]
M v[132:135], v[168:171], a[248:251], v[132:135]
ds_read_b64_tr_b16 a[80:81], v22 offset:49152
ds_read_b64_tr_b16 a[82:83], v22 offset:53248
M v[136:139], v[176:179], a[248:251], v[136:139]
M v[136:139], v[180:183], a[252:255], v[136:139]
ds_read_b64_tr_b16 a[84:85], v22 offset:57344
ds_read_b64_tr_b16 a[86:87], v22 offset:61440
M v[140:143], v[188:191], a[252:255], v[140:143]
M v[140:143], v[184:187], a[248:251], v[140:143]
M v[144:147], v[192:195], a[248:251], v[144:147]
ds_read_b64_tr_b16 a[88:89], v23 offset:49152
ds_read_b64_tr_b16 a[90:91], v23 offset:53248
M v[144:147], v[196:199], a[252:255], v[144:147]
M v[148:151], v[204:207], a[252:255], v[148:151]
M v[148:151], v[200:203], a[248:251], v[148:151]
ds_read_b64_tr_b16 a[92:93], v23 offset:57344
ds_read_b64_tr_b16 a[94:95], v23 offset:61440
M v[152:155], v[208:211], a[248:251], v[152:155]
M v[152:155], v[212:215], a[252:255], v[152:155]
M v[156:159], v[220:223], a[252:255], v[156:159]
M v[156:159], v[216:219], a[248:251], v[156:159]
s_waitcnt vmcnt(12) lgkmcnt(0)
s_barrier
M v[32:35], a[32:35], a[96:99], v[32:35]
s_add_u32 m0, s42, 49152
s_nop 0
buffer_load_dwordx4 v6, s[48:51], s26 offen offset:0 lds
M v[32:35], a[36:39], a[100:103], v[32:35]
M v[36:39], a[44:47], a[100:103], v[36:39]
M v[36:39], a[40:43], a[96:99], v[36:39]
M v[40:43], a[48:51], a[96:99], v[40:43]
ds_read_b64_tr_b16 v[160:161], v24 offset:0
ds_read_b64_tr_b16 v[162:163], v24 offset:2048
M v[40:43], a[52:55], a[100:103], v[40:43]
M v[44:47], a[60:63], a[100:103], v[44:47]
M v[44:47], a[56:59], a[96:99], v[44:47]
M v[48:51], a[64:67], a[96:99], v[48:51]
buffer_load_dwordx4 v7, s[48:51], s26 offen offset:1024 lds
M v[48:51], a[68:71], a[100:103], v[48:51]
M v[52:55], a[76:79], a[100:103], v[52:55]
M v[52:55], a[72:75], a[96:99], v[52:55]
M v[56:59], a[80:83], a[96:99], v[56:59]
ds_read_b64_tr_b16 v[164:165], v24 offset:4096
ds_read_b64_tr_b16 v[166:167], v24 offset:6144
M v[56:59], a[84:87], a[100:103], v[56:59]
M v[60:63], a[92:95], a[100:103], v[60:63]
M v[60:63], a[88:91], a[96:99], v[60:63]
M v[64:67], a[32:35], a[104:107], v[64:67]
buffer_load_dwordx4 a[224:227], v1, s[44:47], s25 offen offset:0 sc1
M v[64:67], a[36:39], a[108:111], v[64:67]
M v[68:71], a[44:47], a[108:111], v[68:71]
v_cvt_pk_bf16_f32 v40, v40, v41
v_cvt_pk_bf16_f32 v41, v42, v43
M v[68:71], a[40:43], a[104:107], v[68:71]
v_cvt_pk_bf16_f32 v42, v44, v45
v_cvt_pk_bf16_f32 v43, v46, v47
M v[72:75], a[48:51], a[104:107], v[72:75]
ds_read_b64_tr_b16 v[168:169], v25 offset:0
ds_read_b64_tr_b16 v[170:171], v25 offset:2048
M v[72:75], a[52:55], a[108:111], v[72:75]
s_add_u32 s60, s56, 4096
buffer_store_dwordx4 v[40:43], v1, s[52:55], s60 offen offset:0 sc1
M v[76:79], a[60:63], a[108:111], v[76:79]
M v[76:79], a[56:59], a[104:107], v[76:79]
v_cvt_pk_bf16_f32 v48, v48, v49
v_cvt_pk_bf16_f32 v49, v50, v51
M v[80:83], a[64:67], a[104:107], v[80:83]
buffer_load_dwordx4 a[228:231], v1, s[44:47], s25 offen offset:1024 sc1
v_cvt_pk_bf16_f32 v50, v52, v53
v_cvt_pk_bf16_f32 v51, v54, v55
M v[80:83], a[68:71], a[108:111], v[80:83]
M v[84:87], a[76:79], a[108:111], v[84:87]
s_add_u32 s60, s56, 8192
buffer_store_dwordx4 v[48:51], v1, s[52:55], s60 offen offset:0 sc1
M v[84:87], a[72:75], a[104:107], v[84:87]
M v[88:91], a[80:83], a[104:107], v[88:91]
ds_read_b64_tr_b16 v[172:173], v25 offset:4096
ds_read_b64_tr_b16 v[174:175], v25 offset:6144
v_cvt_pk_bf16_f32 v56, v56, v57
v_cvt_pk_bf16_f32 v57, v58, v59
M v[88:91], a[84:87], a[108:111], v[88:91]
v_cvt_pk_bf16_f32 v58, v60, v61
v_cvt_pk_bf16_f32 v59, v62, v63
M v[92:95], a[92:95], a[108:111], v[92:95]
M v[92:95], a[88:91], a[104:107], v[92:95]
s_add_u32 s60, s56, 12288
buffer_store_dwordx4 v[56:59], v1, s[52:55], s60 offen offset:0 sc1
M v[96:99], a[32:35], a[112:115], v[96:99]
M v[96:99], a[36:39], a[116:119], v[96:99]
buffer_load_dwordx4 a[232:235], v1, s[44:47], s25 offen offset:2048 sc1
M v[100:103], a[44:47], a[116:119], v[100:103]
v_cvt_pk_bf16_f32 v72, v72, v73
v_cvt_pk_bf16_f32 v73, v74, v75
M v[100:103], a[40:43], a[112:115], v[100:103]
v_cvt_pk_bf16_f32 v74, v76, v77
v_cvt_pk_bf16_f32 v75, v78, v79
M v[104:107], a[48:51], a[112:115], v[104:107]
M v[104:107], a[52:55], a[116:119], v[104:107]
ds_read_b64_tr_b16 v[176:177], v26 offset:0
ds_read_b64_tr_b16 v[178:179], v26 offset:2048
s_add_u32 s60, s56, 4096
buffer_store_dwordx4 v[72:75], v1, s[52:55], s60 offen offset:1024 sc1
M v[108:111], a[60:63], a[116:119], v[108:111]
M v[108:111], a[56:59], a[112:115], v[108:111]
v_cvt_pk_bf16_f32 v80, v80, v81
v_cvt_pk_bf16_f32 v81, v82, v83
M v[112:115], a[64:67], a[112:115], v[112:115]
v_cvt_pk_bf16_f32 v82, v84, v85
v_cvt_pk_bf16_f32 v83, v86, v87
M v[112:115], a[68:71], a[116:119], v[112:115]
buffer_load_dwordx4 a[236:239], v1, s[44:47], s25 offen offset:3072 sc1
M v[116:119], a[76:79], a[116:119], v[116:119]
s_add_u32 s60, s56, 8192
buffer_store_dwordx4 v[80:83], v1, s[52:55], s60 offen offset:1024 sc1
M v[116:119], a[72:75], a[112:115], v[116:119]
M v[120:123], a[80:83], a[112:115], v[120:123]
v_cvt_pk_bf16_f32 v88, v88, v89
v_cvt_pk_bf16_f32 v89, v90, v91
M v[120:123], a[84:87], a[116:119], v[120:123]
ds_read_b64_tr_b16 v[180:181], v26 offset:4096
ds_read_b64_tr_b16 v[182:183], v26 offset:6144
v_cvt_pk_bf16_f32 v90, v92, v93
v_cvt_pk_bf16_f32 v91, v94, v95
M v[124:127], a[92:95], a[116:119], v[124:127]
M v[124:127], a[88:91], a[112:115], v[124:127]
s_add_u32 s60, s56, 12288
buffer_store_dwordx4 v[88:91], v1, s[52:55], s60 offen offset:1024 sc1
M v[128:131], a[32:35], a[120:123], v[128:131]
M v[128:131], a[36:39], a[124:127], v[128:131]
s_add_u32 s25, s25, 16384
s_add_u32 s26, s26, 131072
M v[132:135], a[44:47], a[124:127], v[132:135]
v_cvt_pk_bf16_f32 v104, v104, v105
v_cvt_pk_bf16_f32 v105, v106, v107
M v[132:135], a[40:43], a[120:123], v[132:135]
v_cvt_pk_bf16_f32 v106, v108, v109
v_cvt_pk_bf16_f32 v107, v110, v111
M v[136:139], a[48:51], a[120:123], v[136:139]
M v[136:139], a[52:55], a[124:127], v[136:139]
ds_read_b64_tr_b16 v[184:185], v27 offset:0
ds_read_b64_tr_b16 v[186:187], v27 offset:2048
s_add_u32 s60, s56, 4096
buffer_store_dwordx4 v[104:107], v1, s[52:55], s60 offen offset:2048 sc1
M v[140:143], a[60:63], a[124:127], v[140:143]
M v[140:143], a[56:59], a[120:123], v[140:143]
v_cvt_pk_bf16_f32 v112, v112, v113
v_cvt_pk_bf16_f32 v113, v114, v115
M v[144:147], a[64:67], a[120:123], v[144:147]
v_cvt_pk_bf16_f32 v114, v116, v117
v_cvt_pk_bf16_f32 v115, v118, v119
M v[144:147], a[68:71], a[124:127], v[144:147]
ds_read_b64_tr_b16 v[188:189], v27 offset:4096
ds_read_b64_tr_b16 v[190:191], v27 offset:6144
M v[148:151], a[76:79], a[124:127], v[148:151]
s_add_u32 s60, s56, 8192
buffer_store_dwordx4 v[112:115], v1, s[52:55], s60 offen offset:2048 sc1
M v[148:151], a[72:75], a[120:123], v[148:151]
M v[152:155], a[80:83], a[120:123], v[152:155]
v_cvt_pk_bf16_f32 v120, v120, v121
v_cvt_pk_bf16_f32 v121, v122, v123
M v[152:155], a[84:87], a[124:127], v[152:155]
v_cvt_pk_bf16_f32 v122, v124, v125
v_cvt_pk_bf16_f32 v123, v126, v127
M v[156:159], a[92:95], a[124:127], v[156:159]
M v[156:159], a[88:91], a[120:123], v[156:159]
s_add_u32 s60, s56, 12288
buffer_store_dwordx4 v[120:123], v1, s[52:55], s60 offen offset:2048 sc1
s_waitcnt vmcnt(21) lgkmcnt(0)
s_barrier
M a[0:3], v[160:163], a[128:131], a[0:3]
s_add_u32 m0, s42, 65536
s_nop 0
buffer_load_dwordx4 v6, s[48:51], s26 offen offset:0 lds
ds_read_b64_tr_b16 a[32:33], v24 offset:16384
ds_read_b64_tr_b16 a[34:35], v24 offset:18432
M a[0:3], v[164:167], a[132:135], a[0:3]
buffer_load_dwordx4 v7, s[48:51], s26 offen offset:1024 lds
M a[4:7], v[172:175], a[132:135], a[4:7]
ds_read_b64_tr_b16 a[36:37], v24 offset:20480
ds_read_b64_tr_b16 a[38:39], v24 offset:22528
buffer_load_dwordx4 a[96:99], v1, s[44:47], s25 offen offset:0 sc1
M a[4:7], v[168:171], a[128:131], a[4:7]
ds_read_b64_tr_b16 a[40:41], v25 offset:16384
ds_read_b64_tr_b16 a[42:43], v25 offset:18432
M a[8:11], v[176:179], a[128:131], a[8:11]
buffer_load_dwordx4 a[100:103], v1, s[44:47], s25 offen offset:1024 sc1
M a[8:11], v[180:183], a[132:135], a[8:11]
ds_read_b64_tr_b16 a[44:45], v25 offset:20480
ds_read_b64_tr_b16 a[46:47], v25 offset:22528
buffer_load_dwordx4 a[104:107], v1, s[44:47], s25 offen offset:2048 sc1
M a[12:15], v[188:191], a[132:135], a[12:15]
ds_read_b64_tr_b16 a[48:49], v26 offset:16384
ds_read_b64_tr_b16 a[50:51], v26 offset:18432
M a[12:15], v[184:187], a[128:131], a[12:15]
buffer_load_dwordx4 a[108:111], v1, s[44:47], s25 offen offset:3072 sc1
M a[16:19], v[160:163], a[136:139], a[16:19]
ds_read_b64_tr_b16 a[52:53], v26 offset:20480
ds_read_b64_tr_b16 a[54:55], v26 offset:22528
s_add_u32 s25, s25, 16384
s_add_u32 s26, s26, 131072
M a[16:19], v[164:167], a[140:143], a[16:19]
ds_read_b64_tr_b16 a[56:57], v27 offset:16384
ds_read_b64_tr_b16 a[58:59], v27 offset:18432
M a[20:23], v[172:175], a[140:143], a[20:23]
v_cvt_pk_bf16_f32 v136, v136, v137
v_cvt_pk_bf16_f32 v137, v138, v139
v_cvt_pk_bf16_f32 v138, v140, v141
v_cvt_pk_bf16_f32 v139, v142, v143
s_add_u32 s60, s56, 4096
buffer_store_dwordx4 v[136:139], v1, s[52:55], s60 offen offset:3072 sc1
M a[20:23], v[168:171], a[136:139], a[20:23]
ds_read_b64_tr_b16 a[60:61], v27 offset:20480
ds_read_b64_tr_b16 a[62:63], v27 offset:22528
v_cvt_pk_bf16_f32 v144, v144, v145
v_cvt_pk_bf16_f32 v145, v146, v147
v_cvt_pk_bf16_f32 v146, v148, v149
v_cvt_pk_bf16_f32 v147, v150, v151
s_add_u32 s60, s56, 8192
buffer_store_dwordx4 v[144:147], v1, s[52:55], s60 offen offset:3072 sc1
M a[24:27], v[176:179], a[136:139], a[24:27]
v_cvt_pk_bf16_f32 v152, v152, v153
v_cvt_pk_bf16_f32 v153, v154, v155
v_cvt_pk_bf16_f32 v154, v156, v157
v_cvt_pk_bf16_f32 v155, v158, v159
s_add_u32 s60, s56, 12288
buffer_store_dwordx4 v[152:155], v1, s[52:55], s60 offen offset:3072 sc1
M a[24:27], v[180:183], a[140:143], a[24:27]
v_and_b32 v11, 3, v0
v_lshlrev_b32 v11, 4, v11
M a[28:31], v[188:191], a[140:143], a[28:31]
M a[28:31], v[184:187], a[136:139], a[28:31]
s_waitcnt vmcnt(24) lgkmcnt(0)
s_barrier
s_waitcnt vmcnt(0)
s_mov_b64 exec, 1
buffer_store_dword v254, v253, s[52:55], s58 offen sc1
s_mov_b64 exec, -1
M a[0:3], a[32:35], a[160:163], a[0:3]
s_add_u32 m0, s42, 81920
s_nop 0
buffer_load_dwordx4 v6, s[48:51], s26 offen offset:0 lds
ds_read_b64_tr_b16 v[160:161], v24 offset:32768
ds_read_b64_tr_b16 v[162:163], v24 offset:34816
M a[0:3], a[36:39], a[164:167], a[0:3]
buffer_load_dwordx4 v7, s[48:51], s26 offen offset:1024 lds
M a[4:7], a[44:47], a[164:167], a[4:7]
ds_read_b64_tr_b16 v[164:165], v24 offset:36864
ds_read_b64_tr_b16 v[166:167], v24 offset:38912
M a[4:7], a[40:43], a[160:163], a[4:7]
buffer_load_dwordx4 a[128:131], v1, s[44:47], s25 offen offset:0 sc1
M a[8:11], a[48:51], a[160:163], a[8:11]
ds_read_b64_tr_b16 v[168:169], v25 offset:32768
ds_read_b64_tr_b16 v[170:171], v25 offset:34816
M a[8:11], a[52:55], a[164:167], a[8:11]
buffer_load_dwordx4 a[132:135], v1, s[44:47], s25 offen offset:1024 sc1
M a[12:15], a[60:63], a[164:167], a[12:15]
ds_read_b64_tr_b16 v[172:173], v25 offset:36864
ds_read_b64_tr_b16 v[174:175], v25 offset:38912
M a[12:15], a[56:59], a[160:163], a[12:15]
buffer_load_dwordx4 a[136:139], v1, s[44:47], s25 offen offset:2048 sc1
M a[16:19], a[32:35], a[168:171], a[16:19]
ds_read_b64_tr_b16 v[176:177], v26 offset:32768
ds_read_b64_tr_b16 v[178:179], v26 offset:34816
M a[16:19], a[36:39], a[172:175], a[16:19]
buffer_load_dwordx4 a[140:143], v1, s[44:47], s25 offen offset:3072 sc1
M a[20:23], a[44:47], a[172:175], a[20:23]
ds_read_b64_tr_b16 v[180:181], v26 offset:36864
ds_read_b64_tr_b16 v[182:183], v26 offset:38912
M a[20:23], a[40:43], a[168:171], a[20:23]
s_add_u32 s25, s25, 16384
s_add_u32 s26, s26, 131072
M a[24:27], a[48:51], a[168:171], a[24:27]
ds_read_b64_tr_b16 v[184:185], v27 offset:32768
ds_read_b64_tr_b16 v[186:187], v27 offset:34816
M a[24:27], a[52:55], a[172:175], a[24:27]
ds_read_b64_tr_b16 v[188:189], v27 offset:36864
ds_read_b64_tr_b16 v[190:191], v27 offset:38912
M a[28:31], a[60:63], a[172:175], a[28:31]
M a[28:31], a[56:59], a[168:171], a[28:31]
s_waitcnt vmcnt(21) lgkmcnt(0)
s_barrier
M a[0:3], v[160:163], a[192:195], a[0:3]
s_add_u32 m0, s42, 98304
s_nop 0
buffer_load_dwordx4 v6, s[48:51], s26 offen offset:0 lds
ds_read_b64_tr_b16 a[32:33], v24 offset:49152
ds_read_b64_tr_b16 a[34:35], v24 offset:51200
M a[0:3], v[164:167], a[196:199], a[0:3]
buffer_load_dwordx4 v7, s[48:51], s26 offen offset:1024 lds
M a[4:7], v[172:175], a[196:199], a[4:7]
ds_read_b64_tr_b16 a[36:37], v24 offset:53248
ds_read_b64_tr_b16 a[38:39], v24 offset:55296
M a[4:7], v[168:171], a[192:195], a[4:7]
buffer_load_dwordx4 a[160:163], v1, s[44:47], s25 offen offset:0 sc1
M a[8:11], v[176:179], a[192:195], a[8:11]
ds_read_b64_tr_b16 a[40:41], v25 offset:49152
ds_read_b64_tr_b16 a[42:43], v25 offset:51200
M a[8:11], v[180:183], a[196:199], a[8:11]
buffer_load_dwordx4 a[164:167], v1, s[44:47], s25 offen offset:1024 sc1
M a[12:15], v[188:191], a[196:199], a[12:15]
ds_read_b64_tr_b16 a[44:45], v25 offset:53248
ds_read_b64_tr_b16 a[46:47], v25 offset:55296
M a[12:15], v[184:187], a[192:195], a[12:15]
buffer_load_dwordx4 a[168:171], v1, s[44:47], s25 offen offset:2048 sc1
M a[16:19], v[160:163], a[200:203], a[16:19]
ds_read_b64_tr_b16 a[48:49], v26 offset:49152
ds_read_b64_tr_b16 a[50:51], v26 offset:51200
M a[16:19], v[164:167], a[204:207], a[16:19]
buffer_load_dwordx4 a[172:175], v1, s[44:47], s25 offen offset:3072 sc1
M a[20:23], v[172:175], a[204:207], a[20:23]
ds_read_b64_tr_b16 a[52:53], v26 offset:53248
ds_read_b64_tr_b16 a[54:55], v26 offset:55296
M a[20:23], v[168:171], a[200:203], a[20:23]
s_add_u32 s25, s25, 16384
s_add_u32 s26, s26, 131072
M a[24:27], v[176:179], a[200:203], a[24:27]
ds_read_b64_tr_b16 a[56:57], v27 offset:49152
ds_read_b64_tr_b16 a[58:59], v27 offset:51200
M a[24:27], v[180:183], a[204:207], a[24:27]
ds_read_b64_tr_b16 a[60:61], v27 offset:53248
ds_read_b64_tr_b16 a[62:63], v27 offset:55296
M a[28:31], v[188:191], a[204:207], a[28:31]
M a[28:31], v[184:187], a[200:203], a[28:31]
s_waitcnt vmcnt(16) lgkmcnt(0)
s_barrier
M a[0:3], a[32:35], a[224:227], a[0:3]
s_add_u32 m0, s42, 114688
s_nop 0
buffer_load_dwordx4 v6, s[48:51], s26 offen offset:0 lds
ds_read_b64_tr_b16 v[160:161], v28 offset:0
ds_read_b64_tr_b16 v[162:163], v28 offset:2048
M a[0:3], a[36:39], a[228:231], a[0:3]
buffer_load_dwordx4 v7, s[48:51], s26 offen offset:1024 lds
M a[4:7], a[44:47], a[228:231], a[4:7]
ds_read_b64_tr_b16 v[164:165], v28 offset:4096
ds_read_b64_tr_b16 v[166:167], v28 offset:6144
M a[4:7], a[40:43], a[224:227], a[4:7]
buffer_load_dwordx4 a[192:195], v1, s[44:47], s25 offen offset:0 sc1
M a[8:11], a[48:51], a[224:227], a[8:11]
ds_read_b64_tr_b16 v[168:169], v29 offset:0
ds_read_b64_tr_b16 v[170:171], v29 offset:2048
M a[8:11], a[52:55], a[228:231], a[8:11]
buffer_load_dwordx4 a[196:199], v1, s[44:47], s25 offen offset:1024 sc1
M a[12:15], a[60:63], a[228:231], a[12:15]
ds_read_b64_tr_b16 v[172:173], v29 offset:4096
ds_read_b64_tr_b16 v[174:175], v29 offset:6144
M a[12:15], a[56:59], a[224:227], a[12:15]
buffer_load_dwordx4 a[200:203], v1, s[44:47], s25 offen offset:2048 sc1
M a[16:19], a[32:35], a[232:235], a[16:19]
ds_read_b64_tr_b16 v[176:177], v30 offset:0
ds_read_b64_tr_b16 v[178:179], v30 offset:2048
M a[16:19], a[36:39], a[236:239], a[16:19]
buffer_load_dwordx4 a[204:207], v1, s[44:47], s25 offen offset:3072 sc1
M a[20:23], a[44:47], a[236:239], a[20:23]
ds_read_b64_tr_b16 v[180:181], v30 offset:4096
ds_read_b64_tr_b16 v[182:183], v30 offset:6144
M a[20:23], a[40:43], a[232:235], a[20:23]
s_add_u32 s25, s25, 16384
s_add_u32 s26, s26, 131072
M a[24:27], a[48:51], a[232:235], a[24:27]
ds_read_b64_tr_b16 v[184:185], v31 offset:0
ds_read_b64_tr_b16 v[186:187], v31 offset:2048
M a[24:27], a[52:55], a[236:239], a[24:27]
ds_read_b64_tr_b16 v[188:189], v31 offset:4096
ds_read_b64_tr_b16 v[190:191], v31 offset:6144
M a[28:31], a[60:63], a[236:239], a[28:31]
M a[28:31], a[56:59], a[232:235], a[28:31]
s_waitcnt vmcnt(12) lgkmcnt(0)
s_barrier
M a[0:3], v[160:163], a[96:99], a[0:3]
s_add_u32 m0, s42, 0
s_nop 0
buffer_load_dwordx4 v6, s[48:51], s26 offen offset:0 lds
ds_read_b64_tr_b16 a[32:33], v28 offset:16384
ds_read_b64_tr_b16 a[34:35], v28 offset:18432
M a[0:3], v[164:167], a[100:103], a[0:3]
buffer_load_dwordx4 v7, s[48:51], s26 offen offset:1024 lds
M a[4:7], v[172:175], a[100:103], a[4:7]
ds_read_b64_tr_b16 a[36:37], v28 offset:20480
ds_read_b64_tr_b16 a[38:39], v28 offset:22528
M a[4:7], v[168:171], a[96:99], a[4:7]
buffer_load_dwordx4 a[224:227], v1, s[44:47], s25 offen offset:0 sc1
M a[8:11], v[176:179], a[96:99], a[8:11]
ds_read_b64_tr_b16 a[40:41], v29 offset:16384
ds_read_b64_tr_b16 a[42:43], v29 offset:18432
M a[8:11], v[180:183], a[100:103], a[8:11]
buffer_load_dwordx4 a[228:231], v1, s[44:47], s25 offen offset:1024 sc1
M a[12:15], v[188:191], a[100:103], a[12:15]
ds_read_b64_tr_b16 a[44:45], v29 offset:20480
ds_read_b64_tr_b16 a[46:47], v29 offset:22528
M a[12:15], v[184:187], a[96:99], a[12:15]
buffer_load_dwordx4 a[232:235], v1, s[44:47], s25 offen offset:2048 sc1
M a[16:19], v[160:163], a[104:107], a[16:19]
ds_read_b64_tr_b16 a[48:49], v30 offset:16384
ds_read_b64_tr_b16 a[50:51], v30 offset:18432
M a[16:19], v[164:167], a[108:111], a[16:19]
buffer_load_dwordx4 a[236:239], v1, s[44:47], s25 offen offset:3072 sc1
M a[20:23], v[172:175], a[108:111], a[20:23]
ds_read_b64_tr_b16 a[52:53], v30 offset:20480
ds_read_b64_tr_b16 a[54:55], v30 offset:22528
M a[20:23], v[168:171], a[104:107], a[20:23]
s_add_u32 s25, s25, 16384
s_add_u32 s26, s26, 131072
M a[24:27], v[176:179], a[104:107], a[24:27]
ds_read_b64_tr_b16 a[56:57], v31 offset:16384
ds_read_b64_tr_b16 a[58:59], v31 offset:18432
M a[24:27], v[180:183], a[108:111], a[24:27]
ds_read_b64_tr_b16 a[60:61], v31 offset:20480
ds_read_b64_tr_b16 a[62:63], v31 offset:22528
M a[28:31], v[188:191], a[108:111], a[28:31]
M a[28:31], v[184:187], a[104:107], a[28:31]
s_waitcnt vmcnt(12) lgkmcnt(0)
s_barrier
M a[0:3], a[32:35], a[128:131], a[0:3]
ds_read_b64_tr_b16 v[160:161], v28 offset:32768
ds_read_b64_tr_b16 v[162:163], v28 offset:34816
M a[0:3], a[36:39], a[132:135], a[0:3]
ds_read_b64_tr_b16 v[164:165], v28 offset:36864
ds_read_b64_tr_b16 v[166:167], v28 offset:38912
M a[4:7], a[44:47], a[132:135], a[4:7]
M a[4:7], a[40:43], a[128:131], a[4:7]
ds_read_b64_tr_b16 v[168:169], v29 offset:32768
ds_read_b64_tr_b16 v[170:171], v29 offset:34816
M a[8:11], a[48:51], a[128:131], a[8:11]
M a[8:11], a[52:55], a[132:135], a[8:11]
ds_read_b64_tr_b16 v[172:173], v29 offset:36864
ds_read_b64_tr_b16 v[174:175], v29 offset:38912
M a[12:15], a[60:63], a[132:135], a[12:15]
M a[12:15], a[56:59], a[128:131], a[12:15]
ds_read_b64_tr_b16 v[176:177], v30 offset:32768
ds_read_b64_tr_b16 v[178:179], v30 offset:34816
M a[16:19], a[32:35], a[136:139], a[16:19]
ds_read_b64_tr_b16 v[180:181], v30 offset:36864
ds_read_b64_tr_b16 v[182:183], v30 offset:38912
M a[16:19], a[36:39], a[140:143], a[16:19]
M a[20:23], a[44:47], a[140:143], a[20:23]
ds_read_b64_tr_b16 v[184:185], v31 offset:32768
ds_read_b64_tr_b16 v[186:187], v31 offset:34816
M a[20:23], a[40:43], a[136:139], a[20:23]
M a[24:27], a[48:51], a[136:139], a[24:27]
ds_read_b64_tr_b16 v[188:189], v31 offset:36864
ds_read_b64_tr_b16 v[190:191], v31 offset:38912
M a[24:27], a[52:55], a[140:143], a[24:27]
M a[28:31], a[60:63], a[140:143], a[28:31]
M a[28:31], a[56:59], a[136:139], a[28:31]
s_waitcnt vmcnt(6) lgkmcnt(0)
s_barrier
M a[0:3], v[160:163], a[160:163], a[0:3]
buffer_load_dword v8, v11, s[52:55], s59 offen sc1
M a[0:3], v[164:167], a[164:167], a[0:3]
ds_read_b64_tr_b16 a[32:33], v28 offset:49152
ds_read_b64_tr_b16 a[34:35], v28 offset:51200
M a[4:7], v[172:175], a[164:167], a[4:7]
M a[4:7], v[168:171], a[160:163], a[4:7]
ds_read_b64_tr_b16 a[36:37], v28 offset:53248
ds_read_b64_tr_b16 a[38:39], v28 offset:55296
M a[8:11], v[176:179], a[160:163], a[8:11]
ds_read_b64_tr_b16 a[40:41], v29 offset:49152
ds_read_b64_tr_b16 a[42:43], v29 offset:51200
M a[8:11], v[180:183], a[164:167], a[8:11]
M a[12:15], v[188:191], a[164:167], a[12:15]
ds_read_b64_tr_b16 a[44:45], v29 offset:53248
ds_read_b64_tr_b16 a[46:47], v29 offset:55296
M a[12:15], v[184:187], a[160:163], a[12:15]
ds_read_b64_tr_b16 a[48:49], v30 offset:49152
ds_read_b64_tr_b16 a[50:51], v30 offset:51200
M a[16:19], v[160:163], a[168:171], a[16:19]
M a[16:19], v[164:167], a[172:175], a[16:19]
ds_read_b64_tr_b16 a[52:53], v30 offset:53248
ds_read_b64_tr_b16 a[54:55], v30 offset:55296
M a[20:23], v[172:175], a[172:175], a[20:23]
ds_read_b64_tr_b16 a[56:57], v31 offset:49152
ds_read_b64_tr_b16 a[58:59], v31 offset:51200
M a[20:23], v[168:171], a[168:171], a[20:23]
M a[24:27], v[176:179], a[168:171], a[24:27]
ds_read_b64_tr_b16 a[60:61], v31 offset:53248
ds_read_b64_tr_b16 a[62:63], v31 offset:55296
M a[24:27], v[180:183], a[172:175], a[24:27]
M a[28:31], v[188:191], a[172:175], a[28:31]
M a[28:31], v[184:187], a[168:171], a[28:31]
s_waitcnt vmcnt(1) lgkmcnt(0)
s_barrier
s_waitcnt vmcnt(0)
v_cmp_ne_u32 vcc, 1, v8
s_nop 0
s_cbranch_vccnz Lk3_spinfl
Lk3_gotfl:
M a[0:3], a[32:35], a[192:195], a[0:3]
s_xor_b32 s60, s56, 65536
s_add_u32 s60, s60, 4096
buffer_load_dwordx4 v[192:195], v1, s[52:55], s60 offen offset:0 sc1
ds_read_b64_tr_b16 v[160:161], v24 offset:0
ds_read_b64_tr_b16 v[162:163], v24 offset:2048
M a[0:3], a[36:39], a[196:199], a[0:3]
buffer_load_dwordx4 v[196:199], v1, s[52:55], s60 offen offset:1024 sc1
M a[4:7], a[44:47], a[196:199], a[4:7]
ds_read_b64_tr_b16 v[164:165], v24 offset:4096
ds_read_b64_tr_b16 v[166:167], v24 offset:6144
buffer_load_dwordx4 v[200:203], v1, s[52:55], s60 offen offset:2048 sc1
M a[4:7], a[40:43], a[192:195], a[4:7]
ds_read_b64_tr_b16 v[168:169], v25 offset:0
ds_read_b64_tr_b16 v[170:171], v25 offset:2048
M a[8:11], a[48:51], a[192:195], a[8:11]
buffer_load_dwordx4 v[204:207], v1, s[52:55], s60 offen offset:3072 sc1
ds_read_b64_tr_b16 v[172:173], v25 offset:4096
ds_read_b64_tr_b16 v[174:175], v25 offset:6144
M a[8:11], a[52:55], a[196:199], a[8:11]
s_xor_b32 s60, s56, 131072
s_add_u32 s60, s60, 8192
buffer_load_dwordx4 v[208:211], v1, s[52:55], s60 offen offset:0 sc1
M a[12:15], a[60:63], a[196:199], a[12:15]
ds_read_b64_tr_b16 v[176:177], v26 offset:0
ds_read_b64_tr_b16 v[178:179], v26 offset:2048
M a[12:15], a[56:59], a[192:195], a[12:15]
buffer_load_dwordx4 v[212:215], v1, s[52:55], s60 offen offset:1024 sc1
ds_read_b64_tr_b16 v[180:181], v26 offset:4096
ds_read_b64_tr_b16 v[182:183], v26 offset:6144
M a[16:19], a[32:35], a[200:203], a[16:19]
buffer_load_dwordx4 v[216:219], v1, s[52:55], s60 offen offset:2048 sc1
M a[16:19], a[36:39], a[204:207], a[16:19]
ds_read_b64_tr_b16 v[184:185], v27 offset:0
ds_read_b64_tr_b16 v[186:187], v27 offset:2048
buffer_load_dwordx4 v[220:223], v1, s[52:55], s60 offen offset:3072 sc1
M a[20:23], a[44:47], a[204:207], a[20:23]
ds_read_b64_tr_b16 v[188:189], v27 offset:4096
ds_read_b64_tr_b16 v[190:191], v27 offset:6144
M a[20:23], a[40:43], a[200:203], a[20:23]
s_xor_b32 s60, s56, 196608
s_add_u32 s60, s60, 12288
buffer_load_dwordx4 v[224:227], v1, s[52:55], s60 offen offset:0 sc1
buffer_load_dwordx4 v[228:231], v1, s[52:55], s60 offen offset:1024 sc1
M a[24:27], a[48:51], a[200:203], a[24:27]
buffer_load_dwordx4 v[232:235], v1, s[52:55], s60 offen offset:2048 sc1
M a[24:27], a[52:55], a[204:207], a[24:27]
buffer_load_dwordx4 v[236:239], v1, s[52:55], s60 offen offset:3072 sc1
M a[28:31], a[60:63], a[204:207], a[28:31]
M a[28:31], a[56:59], a[200:203], a[28:31]
s_waitcnt lgkmcnt(0)
M a[0:3], v[160:163], a[224:227], a[0:3]
M a[0:3], v[164:167], a[228:231], a[0:3]
M a[4:7], v[172:175], a[228:231], a[4:7]
M a[4:7], v[168:171], a[224:227], a[4:7]
M a[8:11], v[176:179], a[224:227], a[8:11]
M a[8:11], v[180:183], a[228:231], a[8:11]
M a[12:15], v[188:191], a[228:231], a[12:15]
M a[12:15], v[184:187], a[224:227], a[12:15]
M a[16:19], v[160:163], a[232:235], a[16:19]
M a[16:19], v[164:167], a[236:239], a[16:19]
M a[20:23], v[172:175], a[236:239], a[20:23]
M a[20:23], v[168:171], a[232:235], a[20:23]
M a[24:27], v[176:179], a[232:235], a[24:27]
M a[24:27], v[180:183], a[236:239], a[24:27]
M a[28:31], v[188:191], a[236:239], a[28:31]
M a[28:31], v[184:187], a[232:235], a[28:31]
v_bfe_u32 v8, v0, 4, 1
v_lshrrev_b32 v9, 5, v0
v_lshl_or_b32 v8, v8, 1, v9
v_and_b32 v9, 15, v0
v_lshlrev_b32 v9, 13, v9
v_lshl_add_u32 v8, v8, 4, v9
s_and_b32 s3, s101, 1
s_lshl_b32 s3, s3, 6
s_lshr_b32 s6, s101, 1
s_add_u32 s3, s3, s6
s_add_u32 s3, s3, s21
s_lshl_b32 s3, s3, 12
s_lshl_b32 s6, s22, 1
s_add_u32 s3, s3, s6
s_add_u32 s3, s3, 2048
v_accvgpr_read_b32 v20, a0
v_accvgpr_read_b32 v21, a1
v_accvgpr_read_b32 v22, a2
v_accvgpr_read_b32 v23, a3
v_accvgpr_read_b32 v24, a4
v_accvgpr_read_b32 v25, a5
v_accvgpr_read_b32 v26, a6
v_accvgpr_read_b32 v27, a7
v_cvt_pk_bf16_f32 v12, v20, v21
v_cvt_pk_bf16_f32 v13, v22, v23
v_cvt_pk_bf16_f32 v14, v24, v25
v_cvt_pk_bf16_f32 v15, v26, v27
s_nop 0
v_permlane16_swap_b32 v12, v14
v_permlane16_swap_b32 v13, v15
buffer_store_dwordx4 v[12:15], v8, s[16:19], s3 offen offset:0
v_accvgpr_read_b32 v20, a8
v_accvgpr_read_b32 v21, a9
v_accvgpr_read_b32 v22, a10
v_accvgpr_read_b32 v23, a11
v_accvgpr_read_b32 v24, a12
v_accvgpr_read_b32 v25, a13
v_accvgpr_read_b32 v26, a14
v_accvgpr_read_b32 v27, a15
v_cvt_pk_bf16_f32 v16, v20, v21
v_cvt_pk_bf16_f32 v17, v22, v23
v_cvt_pk_bf16_f32 v18, v24, v25
v_cvt_pk_bf16_f32 v19, v26, v27
s_nop 0
v_permlane16_swap_b32 v16, v18
v_permlane16_swap_b32 v17, v19
buffer_store_dwordx4 v[16:19], v8, s[16:19], s3 offen offset:64
s_add_u32 s3, s3, 131072
v_accvgpr_read_b32 v20, a16
v_accvgpr_read_b32 v21, a17
v_accvgpr_read_b32 v22, a18
v_accvgpr_read_b32 v23, a19
v_accvgpr_read_b32 v24, a20
v_accvgpr_read_b32 v25, a21
v_accvgpr_read_b32 v26, a22
v_accvgpr_read_b32 v27, a23
v_cvt_pk_bf16_f32 v12, v20, v21
v_cvt_pk_bf16_f32 v13, v22, v23
v_cvt_pk_bf16_f32 v14, v24, v25
v_cvt_pk_bf16_f32 v15, v26, v27
s_nop 0
v_permlane16_swap_b32 v12, v14
v_permlane16_swap_b32 v13, v15
buffer_store_dwordx4 v[12:15], v8, s[16:19], s3 offen offset:0
v_accvgpr_read_b32 v20, a24
v_accvgpr_read_b32 v21, a25
v_accvgpr_read_b32 v22, a26
v_accvgpr_read_b32 v23, a27
v_accvgpr_read_b32 v24, a28
v_accvgpr_read_b32 v25, a29
v_accvgpr_read_b32 v26, a30
v_accvgpr_read_b32 v27, a31
v_cvt_pk_bf16_f32 v16, v20, v21
v_cvt_pk_bf16_f32 v17, v22, v23
v_cvt_pk_bf16_f32 v18, v24, v25
v_cvt_pk_bf16_f32 v19, v26, v27
s_nop 0
v_permlane16_swap_b32 v16, v18
v_permlane16_swap_b32 v17, v19
buffer_store_dwordx4 v[16:19], v8, s[16:19], s3 offen offset:64
v_bfe_u32 v8, v0, 4, 1
v_lshrrev_b32 v9, 5, v0
v_lshl_or_b32 v8, v8, 1, v9
v_and_b32 v9, 15, v0
v_lshlrev_b32 v9, 12, v9
v_lshl_add_u32 v8, v8, 4, v9
s_lshl_b32 s3, s101, 6
s_add_u32 s3, s3, s29
s_lshl_b32 s3, s3, 12
s_lshl_b32 s6, s30, 1
s_add_u32 s3, s3, s6
s_mov_b32 s6, 0x00003f80
s_mov_b32 s7, 0x3f800000
s_waitcnt vmcnt(4)
v_dot2_f32_bf16 v32, v192, s6, v32
v_dot2_f32_bf16 v33, v192, s7, v33
v_dot2_f32_bf16 v34, v193, s6, v34
v_dot2_f32_bf16 v35, v193, s7, v35
v_dot2_f32_bf16 v36, v194, s6, v36
v_dot2_f32_bf16 v37, v194, s7, v37
v_dot2_f32_bf16 v38, v195, s6, v38
v_dot2_f32_bf16 v39, v195, s7, v39
v_dot2_f32_bf16 v32, v208, s6, v32
v_dot2_f32_bf16 v33, v208, s7, v33
v_dot2_f32_bf16 v34, v209, s6, v34
v_dot2_f32_bf16 v35, v209, s7, v35
v_dot2_f32_bf16 v36, v210, s6, v36
v_dot2_f32_bf16 v37, v210, s7, v37
v_dot2_f32_bf16 v38, v211, s6, v38
v_dot2_f32_bf16 v39, v211, s7, v39
v_dot2_f32_bf16 v32, v224, s6, v32
v_dot2_f32_bf16 v33, v224, s7, v33
v_dot2_f32_bf16 v34, v225, s6, v34
v_dot2_f32_bf16 v35, v225, s7, v35
v_dot2_f32_bf16 v36, v226, s6, v36
v_dot2_f32_bf16 v37, v226, s7, v37
v_dot2_f32_bf16 v38, v227, s6, v38
v_dot2_f32_bf16 v39, v227, s7, v39
v_cvt_pk_bf16_f32 v12, v32, v33
v_cvt_pk_bf16_f32 v13, v34, v35
v_cvt_pk_bf16_f32 v14, v36, v37
v_cvt_pk_bf16_f32 v15, v38, v39
s_nop 0
v_permlane16_swap_b32 v12, v14
v_permlane16_swap_b32 v13, v15
buffer_store_dwordx4 v[12:15], v8, s[16:19], s3 offen offset:0
s_add_u32 s3, s3, 65536
v_dot2_f32_bf16 v64, v196, s6, v64
v_dot2_f32_bf16 v65, v196, s7, v65
v_dot2_f32_bf16 v66, v197, s6, v66
v_dot2_f32_bf16 v67, v197, s7, v67
v_dot2_f32_bf16 v68, v198, s6, v68
v_dot2_f32_bf16 v69, v198, s7, v69
v_dot2_f32_bf16 v70, v199, s6, v70
v_dot2_f32_bf16 v71, v199, s7, v71
v_dot2_f32_bf16 v64, v212, s6, v64
v_dot2_f32_bf16 v65, v212, s7, v65
v_dot2_f32_bf16 v66, v213, s6, v66
v_dot2_f32_bf16 v67, v213, s7, v67
v_dot2_f32_bf16 v68, v214, s6, v68
v_dot2_f32_bf16 v69, v214, s7, v69
v_dot2_f32_bf16 v70, v215, s6, v70
v_dot2_f32_bf16 v71, v215, s7, v71
v_dot2_f32_bf16 v64, v228, s6, v64
v_dot2_f32_bf16 v65, v228, s7, v65
v_dot2_f32_bf16 v66, v229, s6, v66
v_dot2_f32_bf16 v67, v229, s7, v67
v_dot2_f32_bf16 v68, v230, s6, v68
v_dot2_f32_bf16 v69, v230, s7, v69
v_dot2_f32_bf16 v70, v231, s6, v70
v_dot2_f32_bf16 v71, v231, s7, v71
v_cvt_pk_bf16_f32 v16, v64, v65
v_cvt_pk_bf16_f32 v17, v66, v67
v_cvt_pk_bf16_f32 v18, v68, v69
v_cvt_pk_bf16_f32 v19, v70, v71
s_nop 0
v_permlane16_swap_b32 v16, v18
v_permlane16_swap_b32 v17, v19
buffer_store_dwordx4 v[16:19], v8, s[16:19], s3 offen offset:0
s_add_u32 s3, s3, 65536
v_dot2_f32_bf16 v96, v200, s6, v96
v_dot2_f32_bf16 v97, v200, s7, v97
v_dot2_f32_bf16 v98, v201, s6, v98
v_dot2_f32_bf16 v99, v201, s7, v99
v_dot2_f32_bf16 v100, v202, s6, v100
v_dot2_f32_bf16 v101, v202, s7, v101
v_dot2_f32_bf16 v102, v203, s6, v102
v_dot2_f32_bf16 v103, v203, s7, v103
v_dot2_f32_bf16 v96, v216, s6, v96
v_dot2_f32_bf16 v97, v216, s7, v97
v_dot2_f32_bf16 v98, v217, s6, v98
v_dot2_f32_bf16 v99, v217, s7, v99
v_dot2_f32_bf16 v100, v218, s6, v100
v_dot2_f32_bf16 v101, v218, s7, v101
v_dot2_f32_bf16 v102, v219, s6, v102
v_dot2_f32_bf16 v103, v219, s7, v103
v_dot2_f32_bf16 v96, v232, s6, v96
v_dot2_f32_bf16 v97, v232, s7, v97
v_dot2_f32_bf16 v98, v233, s6, v98
v_dot2_f32_bf16 v99, v233, s7, v99
v_dot2_f32_bf16 v100, v234, s6, v100
v_dot2_f32_bf16 v101, v234, s7, v101
v_dot2_f32_bf16 v102, v235, s6, v102
v_dot2_f32_bf16 v103, v235, s7, v103
v_cvt_pk_bf16_f32 v12, v96, v97
v_cvt_pk_bf16_f32 v13, v98, v99
v_cvt_pk_bf16_f32 v14, v100, v101
v_cvt_pk_bf16_f32 v15, v102, v103
s_nop 0
v_permlane16_swap_b32 v12, v14
v_permlane16_swap_b32 v13, v15
buffer_store_dwordx4 v[12:15], v8, s[16:19], s3 offen offset:0
s_add_u32 s3, s3, 65536
v_dot2_f32_bf16 v128, v204, s6, v128
v_dot2_f32_bf16 v129, v204, s7, v129
v_dot2_f32_bf16 v130, v205, s6, v130
v_dot2_f32_bf16 v131, v205, s7, v131
v_dot2_f32_bf16 v132, v206, s6, v132
v_dot2_f32_bf16 v133, v206, s7, v133
v_dot2_f32_bf16 v134, v207, s6, v134
v_dot2_f32_bf16 v135, v207, s7, v135
v_dot2_f32_bf16 v128, v220, s6, v128
v_dot2_f32_bf16 v129, v220, s7, v129
v_dot2_f32_bf16 v130, v221, s6, v130
v_dot2_f32_bf16 v131, v221, s7, v131
v_dot2_f32_bf16 v132, v222, s6, v132
v_dot2_f32_bf16 v133, v222, s7, v133
v_dot2_f32_bf16 v134, v223, s6, v134
v_dot2_f32_bf16 v135, v223, s7, v135
v_dot2_f32_bf16 v128, v236, s6, v128
v_dot2_f32_bf16 v129, v236, s7, v129
v_dot2_f32_bf16 v130, v237, s6, v130
v_dot2_f32_bf16 v131, v237, s7, v131
v_dot2_f32_bf16 v132, v238, s6, v132
v_dot2_f32_bf16 v133, v238, s7, v133
v_dot2_f32_bf16 v134, v239, s6, v134
v_dot2_f32_bf16 v135, v239, s7, v135
v_cvt_pk_bf16_f32 v16, v128, v129
v_cvt_pk_bf16_f32 v17, v130, v131
v_cvt_pk_bf16_f32 v18, v132, v133
v_cvt_pk_bf16_f32 v19, v134, v135
s_nop 0
v_permlane16_swap_b32 v16, v18
v_permlane16_swap_b32 v17, v19
buffer_store_dwordx4 v[16:19], v8, s[16:19], s3 offen offset:0
s_endpgm
Lk3_spinb0:
Lk3_spinb0_:
s_add_u32 s61, s61, 1
s_cmp_gt_u32 s61, 1048576
s_cbranch_scc1 Lk3_gotb0
s_sleep 2
buffer_load_dword v7, v15, s[52:55], s43 offen sc1
s_waitcnt vmcnt(0)
v_cmp_ne_u32 vcc, 1, v7
s_nop 0
s_cbranch_vccnz Lk3_spinb0_
s_branch Lk3_gotb0
Lk3_spinb1:
Lk3_spinb1_:
s_add_u32 s61, s61, 1
s_cmp_gt_u32 s61, 1048576
s_cbranch_scc1 Lk3_gotb1
s_sleep 2
buffer_load_dword v7, v15, s[52:55], s43 offen sc1
s_waitcnt vmcnt(0)
v_cmp_ne_u32 vcc, 1, v7
s_nop 0
s_cbranch_vccnz Lk3_spinb1_
s_branch Lk3_gotb1
Lk3_spinb2:
Lk3_spinb2_:
s_add_u32 s61, s61, 1
s_cmp_gt_u32 s61, 1048576
s_cbranch_scc1 Lk3_gotb2
s_sleep 2
buffer_load_dword v7, v15, s[52:55], s43 offen sc1
s_waitcnt vmcnt(0)
v_cmp_ne_u32 vcc, 1, v7
s_nop 0
s_cbranch_vccnz Lk3_spinb2_
s_branch Lk3_gotb2
Lk3_spinb3:
Lk3_spinb3_:
s_add_u32 s61, s61, 1
s_cmp_gt_u32 s61, 1048576
s_cbranch_scc1 Lk3_gotb3
s_sleep 2
buffer_load_dword v7, v15, s[52:55], s43 offen sc1
s_waitcnt vmcnt(0)
v_cmp_ne_u32 vcc, 1, v7
s_nop 0
s_cbranch_vccnz Lk3_spinb3_
s_branch Lk3_gotb3
Lk3_spinft:
s_add_u32 s61, s61, 1
s_cmp_gt_u32 s61, 1048576
s_cbranch_scc1 Lk3_gotft
s_sleep 2
buffer_load_dword v252, v255, s[52:55], s62 offen sc1
s_waitcnt vmcnt(0)
v_cmp_ne_u32 vcc, 1, v252
s_nop 0
s_cbranch_vccnz Lk3_spinft
s_branch Lk3_gotft
Lk3_spinfl:
s_add_u32 s61, s61, 1
s_cmp_gt_u32 s61, 1048576
s_cbranch_scc1 Lk3_gotfl
s_sleep 2
buffer_load_dword v8, v11, s[52:55], s59 offen sc1
s_waitcnt vmcnt(0)
v_cmp_ne_u32 vcc, 1, v8
s_nop 0
s_cbranch_vccnz Lk3_spinfl
s_branch Lk3_gotfl
Lc3:
.section .rodata,"a"
.p2align 6
.amdhsa_kernel concat_heads__compressed_kv_cla__sliding_local_dilated__prompt_kernel
  .amdhsa_next_free_vgpr 512
  .amdhsa_next_free_sgpr 102
  .amdhsa_accum_offset 256
  .amdhsa_group_segment_fixed_size 0
  .amdhsa_kernarg_size 96
  .amdhsa_user_sgpr_count 2
  .amdhsa_user_sgpr_kernarg_segment_ptr 1
  .amdhsa_system_sgpr_workgroup_id_x 1
.end_amdhsa_kernel
```

```asm
; @launch grid=(256,1,1) block=(256,1,1) lds=163840
.amdgcn_target "amdgcn-amd-amdhsa--gfx950"
.text
.macro M d, a, b, c
v_mfma_f32_16x16x32_bf16 \d, \a, \b, \c
.endm
.globl concat_heads__compressed_kv_cla__sliding_local_dilated__prompt_kernel
.p2align 8
.type concat_heads__compressed_kv_cla__sliding_local_dilated__prompt_kernel,@function
concat_heads__compressed_kv_cla__sliding_local_dilated__prompt_kernel:
s_cmp_lt_u32 s2, 256
s_cbranch_scc1 Lk1_go
s_endpgm
Lk1_go:
s_load_dwordx16 s[32:47], s[0:1], 0
s_load_dwordx2 s[48:49], s[0:1], 64
s_load_dwordx2 s[50:51], s[0:1], 88
s_load_dwordx2 s[90:91], s[0:1], 80
v_lshrrev_b32 v24, 6, v0
s_nop 0
v_readfirstlane_b32 s20, v24
v_and_b32 v0, 63, v0
v_lshlrev_b32 v1, 4, v0
s_mov_b32 s101, s20
s_lshr_b32 s21, s20, 1
s_and_b32 s22, s20, 1
s_lshl_b32 s29, s20, 12
s_and_b32 s3, s2, 1
s_lshl_b32 s3, s3, 2
s_bfe_u32 s6, s2, 0x20003
s_add_u32 s3, s3, s6
s_lshl_b32 s52, s3, 8
s_bfe_u32 s3, s2, 0x20001
s_lshl_b32 s3, s3, 2
s_bfe_u32 s7, s2, 0x20005
s_add_u32 s3, s3, s7
s_lshl_b32 s53, s3, 8
s_cmp_lt_u32 s2, 128
s_cselect_b32 s5, 11, 10
s_lshl_b32 s3, s21, 7
s_lshl_b32 s4, s22, 5
s_add_u32 s3, s3, s4
v_lshrrev_b32 v24, 3, v0
v_add_u32 v24, s3, v24
v_and_b32 v25, 7, v0
v_add_u32 v26, 0, v24
v_bfe_u32 v27, v26, 1, 3
v_xor_b32 v27, v27, v25
v_lshlrev_b32 v26, s5, v26
v_lshl_add_u32 v26, v27, 4, v26
v_subrev_u32 v2, 0, v26
v_add_u32 v26, 8, v24
v_bfe_u32 v27, v26, 1, 3
v_xor_b32 v27, v27, v25
v_lshlrev_b32 v26, s5, v26
v_lshl_add_u32 v26, v27, 4, v26
v_subrev_u32 v3, 1024, v26
v_add_u32 v26, 16, v24
v_bfe_u32 v27, v26, 1, 3
v_xor_b32 v27, v27, v25
v_lshlrev_b32 v26, s5, v26
v_lshl_add_u32 v26, v27, 4, v26
v_subrev_u32 v4, 2048, v26
v_add_u32 v26, 24, v24
v_bfe_u32 v27, v26, 1, 3
v_xor_b32 v27, v27, v25
v_lshlrev_b32 v26, s5, v26
v_lshl_add_u32 v26, v27, 4, v26
v_subrev_u32 v5, 3072, v26
s_lshl_b32 s3, s20, 3
v_lshrrev_b32 v24, 5, v0
v_add_u32 v24, s3, v24
v_and_b32 v25, 31, v0
v_add_u32 v26, 0, v24
v_and_b32 v27, 3, v26
v_lshlrev_b32 v27, 1, v27
v_and_or_b32 v27, v26, 8, v27
v_xor_b32 v27, v27, v25
v_lshlrev_b32 v26, 13, v26
v_lshl_add_u32 v26, v27, 4, v26
v_subrev_u32 v6, 0, v26
v_add_u32 v26, 2, v24
v_and_b32 v27, 3, v26
v_lshlrev_b32 v27, 1, v27
v_and_or_b32 v27, v26, 8, v27
v_xor_b32 v27, v27, v25
v_lshlrev_b32 v26, 13, v26
v_lshl_add_u32 v26, v27, 4, v26
v_subrev_u32 v7, 1024, v26
v_add_u32 v26, 4, v24
v_and_b32 v27, 3, v26
v_lshlrev_b32 v27, 1, v27
v_and_or_b32 v27, v26, 8, v27
v_xor_b32 v27, v27, v25
v_lshlrev_b32 v26, 13, v26
v_lshl_add_u32 v26, v27, 4, v26
v_subrev_u32 v8, 2048, v26
v_add_u32 v26, 6, v24
v_and_b32 v27, 3, v26
v_lshlrev_b32 v27, 1, v27
v_and_or_b32 v27, v26, 8, v27
v_xor_b32 v27, v27, v25
v_lshlrev_b32 v26, 13, v26
v_lshl_add_u32 v26, v27, 4, v26
v_subrev_u32 v9, 3072, v26
s_lshl_b32 s23, s52, s5
s_lshl_b32 s31, 64, s5
s_mov_b32 s26, s23
s_lshl_b32 s24, s53, 1
s_mov_b32 s28, s24
s_lshl_b32 s3, 1, s5
s_add_u32 s25, s23, s3
s_lshl_b32 s3, s3, 12
s_add_u32 s27, s24, s3
s_bfe_u32 s3, s2, 0x20001
s_and_b32 s4, s2, 1
s_lshl_b32 s4, s4, 1
s_add_u32 s3, s3, s4
s_and_b32 s3, s3, 3
s_sub_u32 s4, s5, 2
s_lshl_b32 s3, s3, s4
s_add_u32 s23, s23, s3
s_lshl_b32 s3, s3, 12
s_add_u32 s24, s24, s3
s_mov_b32 s95, s6
s_cmp_lt_u32 s2, 128
s_cselect_b32 s6, -1, 8
s_waitcnt lgkmcnt(0)
s_cmp_lt_u32 s2, 128
s_cselect_b64 s[8:9], s[32:33], s[34:35]
s_mov_b32 s10, 2097152
s_cselect_b32 s10, 4194304, s10
s_mov_b32 s11, 0x00020000
s_cselect_b64 s[12:13], s[36:37], s[38:39]
s_mov_b32 s14, 4194304
s_cselect_b32 s14, 8388608, s14
s_mov_b32 s15, 0x00020000
s_mov_b64 s[64:65], s[40:41]
s_add_u32 m0, s29, 65536
s_nop 0
buffer_load_dwordx4 v6, s[12:15], s24 offen offset:0 lds
buffer_load_dwordx4 v7, s[12:15], s24 offen offset:1024 lds
buffer_load_dwordx4 v8, s[12:15], s24 offen offset:2048 lds
buffer_load_dwordx4 v9, s[12:15], s24 offen offset:3072 lds
s_add_u32 s24, s24, 262144
s_add_u32 m0, s29, 0
s_nop 0
buffer_load_dwordx4 v2, s[8:11], s23 offen offset:0 lds
buffer_load_dwordx4 v3, s[8:11], s23 offen offset:1024 lds
buffer_load_dwordx4 v4, s[8:11], s23 offen offset:2048 lds
buffer_load_dwordx4 v5, s[8:11], s23 offen offset:3072 lds
s_add_u32 m0, s29, 81920
s_nop 0
buffer_load_dwordx4 v6, s[12:15], s24 offen offset:0 lds
buffer_load_dwordx4 v7, s[12:15], s24 offen offset:1024 lds
buffer_load_dwordx4 v8, s[12:15], s24 offen offset:2048 lds
buffer_load_dwordx4 v9, s[12:15], s24 offen offset:3072 lds
s_add_u32 s24, s24, 262144
s_cmp_eq_u32 s24, s27
s_cselect_b32 s24, s28, s24
s_sub_u32 s6, s6, 1
s_cmp_eq_u32 s6, 0
s_cselect_b64 s[12:13], s[64:65], s[12:13]
s_add_u32 s16, s50, 117440512
s_addc_u32 s17, s51, 0
s_mov_b32 s18, 16384
s_mov_b32 s19, 0x00020000
v_lshlrev_b32 v23, 20, v0
s_and_b32 s3, s2, 7
s_lshr_b32 s4, s2, 6
s_lshl_b32 s4, s4, 3
s_add_u32 s3, s3, s4
s_lshl_b32 s3, s3, 4
s_add_u32 s3, s3, 4096
s_bfe_u32 s4, s2, 0x30003
s_lshl_b32 s4, s4, 9
s_add_u32 s56, s3, s4
s_sub_u32 s4, 7680, s4
s_add_u32 s57, s3, s4
s_and_b32 s3, s2, 1
s_lshl_b32 s3, s3, 3
s_bfe_u32 s4, s2, 0x30003
s_add_u32 s58, s3, s4
s_bfe_u32 s3, s2, 0x20001
s_lshl_b32 s3, s3, 2
s_lshr_b32 s4, s2, 6
s_xor_b32 s4, s4, 3
s_add_u32 s59, s3, s4
s_lshl_b32 s58, s58, 8
s_lshl_b32 s59, s59, 4
s_add_u32 s58, s58, s59
s_add_u32 s58, s58, 12288
s_lshl_b32 s59, s2, 4
v_lshlrev_b32 v20, 7, v0
s_lshl_b32 s54, s2, 13
s_mov_b64 s[60:61], s[40:41]
s_mov_b32 s62, 0
s_cmp_eq_u32 s20, 1
s_cselect_b64 s[60:61], s[46:47], s[60:61]
s_cselect_b32 s62, 6291456, s62
s_cmp_eq_u32 s20, 2
s_cselect_b64 s[60:61], s[44:45], s[60:61]
s_cselect_b32 s62, 4194304, s62
s_cmp_eq_u32 s20, 3
s_cselect_b32 s62, 0, s62
s_mov_b32 s63, 0x00020000
s_mov_b32 s3, 0
s_cmp_eq_u32 s20, 1
s_cselect_b32 s3, 6291456, s3
s_cmp_eq_u32 s20, 2
s_cselect_b32 s3, 6291456, s3
s_sub_u32 s54, s54, s3
Lc0:
s_add_u32 m0, s29, 98304
s_nop 0
buffer_load_dwordx4 v6, s[12:15], s24 offen offset:0 lds
buffer_load_dwordx4 v7, s[12:15], s24 offen offset:1024 lds
buffer_load_dwordx4 v8, s[12:15], s24 offen offset:2048 lds
buffer_load_dwordx4 v9, s[12:15], s24 offen offset:3072 lds
s_add_u32 s24, s24, 262144
s_lshl_b32 s4, s21, 13
v_and_b32 v24, 15, v0
v_lshlrev_b32 v24, 7, v24
v_add_u32 v24, s4, v24
v_bfe_u32 v25, v0, 1, 3
v_lshrrev_b32 v26, 4, v0
v_xor_b32 v25, v25, v26
v_lshl_add_u32 v10, v25, 4, v24
v_xor_b32 v11, 64, v10
v_bfe_u32 v24, v0, 2, 2
v_lshl_add_u32 v29, v26, 3, v24
v_lshlrev_b32 v25, 9, v29
v_and_b32 v27, 1, v0
v_lshl_add_u32 v25, v27, 3, v25
v_add_u32 v25, 65536, v25
v_lshlrev_b32 v24, 1, v24
v_and_or_b32 v24, v29, 8, v24
v_bfe_u32 v26, v0, 1, 1
s_lshl_b32 s4, s22, 4
s_add_u32 s3, s4, 0
v_add_u32 v27, s3, v26
v_xor_b32 v27, v27, v24
v_lshl_add_u32 v12, v27, 4, v25
s_add_u32 s3, s4, 2
v_add_u32 v27, s3, v26
v_xor_b32 v27, v27, v24
v_lshl_add_u32 v13, v27, 4, v25
s_add_u32 s3, s4, 4
v_add_u32 v27, s3, v26
v_xor_b32 v27, v27, v24
v_lshl_add_u32 v14, v27, 4, v25
s_add_u32 s3, s4, 6
v_add_u32 v27, s3, v26
v_xor_b32 v27, v27, v24
v_lshl_add_u32 v15, v27, 4, v25
s_add_u32 s3, s4, 8
v_add_u32 v27, s3, v26
v_xor_b32 v27, v27, v24
v_lshl_add_u32 v16, v27, 4, v25
s_add_u32 s3, s4, 10
v_add_u32 v27, s3, v26
v_xor_b32 v27, v27, v24
v_lshl_add_u32 v17, v27, 4, v25
s_add_u32 s3, s4, 12
v_add_u32 v27, s3, v26
v_xor_b32 v27, v27, v24
v_lshl_add_u32 v18, v27, 4, v25
s_add_u32 s3, s4, 14
v_add_u32 v27, s3, v26
v_xor_b32 v27, v27, v24
v_lshl_add_u32 v19, v27, 4, v25
v_mov_b32 v28, 0
v_mov_b32 v29, 0
v_mov_b32 v30, 0
v_mov_b32 v31, 0
s_waitcnt vmcnt(4)
s_barrier
ds_read_b64_tr_b16 a[32:33], v12 offset:0
ds_read_b64_tr_b16 a[34:35], v12 offset:2048
ds_read_b64_tr_b16 a[40:41], v13 offset:0
ds_read_b64_tr_b16 a[42:43], v13 offset:2048
ds_read_b64_tr_b16 a[48:49], v14 offset:0
ds_read_b64_tr_b16 a[50:51], v14 offset:2048
ds_read_b64_tr_b16 a[56:57], v15 offset:0
ds_read_b64_tr_b16 a[58:59], v15 offset:2048
ds_read_b64_tr_b16 a[64:65], v16 offset:0
ds_read_b64_tr_b16 a[66:67], v16 offset:2048
ds_read_b64_tr_b16 a[72:73], v17 offset:0
ds_read_b64_tr_b16 a[74:75], v17 offset:2048
ds_read_b64_tr_b16 a[80:81], v18 offset:0
ds_read_b64_tr_b16 a[82:83], v18 offset:2048
ds_read_b64_tr_b16 a[88:89], v19 offset:0
ds_read_b64_tr_b16 a[90:91], v19 offset:2048
ds_read_b64_tr_b16 a[36:37], v12 offset:16384
ds_read_b64_tr_b16 a[38:39], v12 offset:18432
ds_read_b64_tr_b16 a[44:45], v13 offset:16384
ds_read_b64_tr_b16 a[46:47], v13 offset:18432
ds_read_b64_tr_b16 a[52:53], v14 offset:16384
ds_read_b64_tr_b16 a[54:55], v14 offset:18432
ds_read_b64_tr_b16 a[60:61], v15 offset:16384
ds_read_b64_tr_b16 a[62:63], v15 offset:18432
ds_read_b64_tr_b16 a[68:69], v16 offset:16384
ds_read_b64_tr_b16 a[70:71], v16 offset:18432
ds_read_b64_tr_b16 a[76:77], v17 offset:16384
ds_read_b64_tr_b16 a[78:79], v17 offset:18432
ds_read_b64_tr_b16 a[84:85], v18 offset:16384
ds_read_b64_tr_b16 a[86:87], v18 offset:18432
ds_read_b64_tr_b16 a[92:93], v19 offset:16384
ds_read_b64_tr_b16 a[94:95], v19 offset:18432
ds_read_b128 a[160:163], v10 offset:0
ds_read_b128 a[164:167], v11 offset:0
ds_read_b128 a[168:171], v10 offset:2048
ds_read_b128 a[172:175], v11 offset:2048
s_add_u32 m0, s29, 16384
s_add_u32 s3, s23, s31
s_nop 0
buffer_load_dwordx4 v2, s[8:11], s3 offen offset:0 lds
buffer_load_dwordx4 v3, s[8:11], s3 offen offset:1024 lds
buffer_load_dwordx4 v4, s[8:11], s3 offen offset:2048 lds
buffer_load_dwordx4 v5, s[8:11], s3 offen offset:3072 lds
s_add_u32 s23, s23, 128
s_cmp_eq_u32 s23, s25
s_cselect_b32 s23, s26, s23
s_add_u32 m0, s29, 114688
s_nop 0
buffer_load_dwordx4 v6, s[12:15], s24 offen offset:0 lds
buffer_load_dwordx4 v7, s[12:15], s24 offen offset:1024 lds
buffer_load_dwordx4 v8, s[12:15], s24 offen offset:2048 lds
buffer_load_dwordx4 v9, s[12:15], s24 offen offset:3072 lds
s_add_u32 s24, s24, 262144
s_cmp_eq_u32 s24, s27
s_cselect_b32 s24, s28, s24
s_sub_u32 s6, s6, 1
s_cmp_eq_u32 s6, 0
s_cselect_b64 s[12:13], s[64:65], s[12:13]
s_waitcnt vmcnt(8) lgkmcnt(0)
s_barrier
s_getpc_b64 s[92:93]
Lpc_1:
s_add_u32 s92, s92, Lc1-Lpc_1
s_addc_u32 s93, s93, 0
s_lshr_b32 s94, s2, 3
s_mul_i32 s94, s94, ((Lc3-Lc1)/32+127)&~127
v_lshlrev_b32 v24, 7, v0
v_add_u32 v24, s94, v24
v_min_u32 v24, Lc3-Lc1-4, v24
global_load_dword v21, v24, s[92:93]
Lc1:
s_cmp_lt_u32 s2, 128
s_cbranch_scc0 Lk1_kv
M v[32:35], a[32:35], a[160:163], 0
s_add_u32 m0, s29, 32768
s_nop 0
buffer_load_dwordx4 v2, s[8:11], s23 offen offset:0 lds
M v[32:35], a[36:39], a[164:167], v[32:35]
ds_read_b128 a[176:179], v10 offset:4096
ds_read_b128 a[180:183], v11 offset:4096
M v[36:39], a[44:47], a[164:167], 0
M v[36:39], a[40:43], a[160:163], v[36:39]
ds_read_b64_tr_b16 a[96:97], v12 offset:32768
ds_read_b64_tr_b16 a[98:99], v12 offset:34816
M v[40:43], a[48:51], a[160:163], 0
M v[40:43], a[52:55], a[164:167], v[40:43]
buffer_load_dwordx4 v3, s[8:11], s23 offen offset:1024 lds
M v[44:47], a[60:63], a[164:167], 0
M v[44:47], a[56:59], a[160:163], v[44:47]
ds_read_b64_tr_b16 a[104:105], v13 offset:32768
ds_read_b64_tr_b16 a[106:107], v13 offset:34816
M v[48:51], a[64:67], a[160:163], 0
M v[48:51], a[68:71], a[164:167], v[48:51]
buffer_load_dwordx4 v4, s[8:11], s23 offen offset:2048 lds
M v[52:55], a[76:79], a[164:167], 0
M v[52:55], a[72:75], a[160:163], v[52:55]
ds_read_b64_tr_b16 a[112:113], v14 offset:32768
ds_read_b64_tr_b16 a[114:115], v14 offset:34816
M v[56:59], a[80:83], a[160:163], 0
M v[56:59], a[84:87], a[164:167], v[56:59]
buffer_load_dwordx4 v5, s[8:11], s23 offen offset:3072 lds
M v[60:63], a[92:95], a[164:167], 0
M v[60:63], a[88:91], a[160:163], v[60:63]
ds_read_b64_tr_b16 a[120:121], v15 offset:32768
ds_read_b64_tr_b16 a[122:123], v15 offset:34816
M v[64:67], a[32:35], a[168:171], 0
M v[64:67], a[36:39], a[172:175], v[64:67]
ds_read_b128 a[184:187], v10 offset:6144
ds_read_b128 a[188:191], v11 offset:6144
M v[68:71], a[44:47], a[172:175], 0
s_add_u32 m0, s29, 65536
s_nop 0
buffer_load_dwordx4 v6, s[12:15], s24 offen offset:0 lds
M v[68:71], a[40:43], a[168:171], v[68:71]
ds_read_b64_tr_b16 a[128:129], v16 offset:32768
ds_read_b64_tr_b16 a[130:131], v16 offset:34816
M v[72:75], a[48:51], a[168:171], 0
M v[72:75], a[52:55], a[172:175], v[72:75]
M v[76:79], a[60:63], a[172:175], 0
buffer_load_dwordx4 v7, s[12:15], s24 offen offset:1024 lds
M v[76:79], a[56:59], a[168:171], v[76:79]
ds_read_b64_tr_b16 a[136:137], v17 offset:32768
ds_read_b64_tr_b16 a[138:139], v17 offset:34816
M v[80:83], a[64:67], a[168:171], 0
M v[80:83], a[68:71], a[172:175], v[80:83]
M v[84:87], a[76:79], a[172:175], 0
buffer_load_dwordx4 v8, s[12:15], s24 offen offset:2048 lds
M v[84:87], a[72:75], a[168:171], v[84:87]
ds_read_b64_tr_b16 a[144:145], v18 offset:32768
ds_read_b64_tr_b16 a[146:147], v18 offset:34816
M v[88:91], a[80:83], a[168:171], 0
M v[88:91], a[84:87], a[172:175], v[88:91]
M v[92:95], a[92:95], a[172:175], 0
buffer_load_dwordx4 v9, s[12:15], s24 offen offset:3072 lds
M v[92:95], a[88:91], a[168:171], v[92:95]
s_waitcnt lgkmcnt(15)
ds_read_b64_tr_b16 a[152:153], v19 offset:32768
ds_read_b64_tr_b16 a[154:155], v19 offset:34816
M v[96:99], a[32:35], a[176:179], 0
M v[96:99], a[36:39], a[180:183], v[96:99]
M v[100:103], a[44:47], a[180:183], 0
s_add_u32 s24, s24, 262144
M v[100:103], a[40:43], a[176:179], v[100:103]
M v[104:107], a[48:51], a[176:179], 0
M v[104:107], a[52:55], a[180:183], v[104:107]
M v[108:111], a[60:63], a[180:183], 0
M v[108:111], a[56:59], a[176:179], v[108:111]
s_waitcnt vmcnt(9) lgkmcnt(0)
s_barrier
ds_read_b128 a[160:163], v10 offset:16384
ds_read_b128 a[164:167], v11 offset:16384
M v[112:115], a[64:67], a[176:179], 0
s_add_u32 m0, s29, 49152
s_add_u32 s3, s23, s31
buffer_load_dwordx4 v2, s[8:11], s3 offen offset:0 lds
M v[112:115], a[68:71], a[180:183], v[112:115]
M v[116:119], a[76:79], a[180:183], 0
M v[116:119], a[72:75], a[176:179], v[116:119]
ds_read_b64_tr_b16 a[100:101], v12 offset:49152
ds_read_b64_tr_b16 a[102:103], v12 offset:51200
M v[120:123], a[80:83], a[176:179], 0
M v[120:123], a[84:87], a[180:183], v[120:123]
buffer_load_dwordx4 v3, s[8:11], s3 offen offset:1024 lds
M v[124:127], a[92:95], a[180:183], 0
M v[124:127], a[88:91], a[176:179], v[124:127]
M v[128:131], a[32:35], a[184:187], 0
M v[128:131], a[36:39], a[188:191], v[128:131]
ds_read_b128 a[168:171], v10 offset:18432
ds_read_b128 a[172:175], v11 offset:18432
ds_read_b64_tr_b16 a[108:109], v13 offset:49152
ds_read_b64_tr_b16 a[110:111], v13 offset:51200
M v[132:135], a[44:47], a[188:191], 0
M v[132:135], a[40:43], a[184:187], v[132:135]
buffer_load_dwordx4 v4, s[8:11], s3 offen offset:2048 lds
M v[136:139], a[48:51], a[184:187], 0
M v[136:139], a[52:55], a[188:191], v[136:139]
M v[140:143], a[60:63], a[188:191], 0
M v[140:143], a[56:59], a[184:187], v[140:143]
ds_read_b64_tr_b16 a[116:117], v14 offset:49152
ds_read_b64_tr_b16 a[118:119], v14 offset:51200
M v[144:147], a[64:67], a[184:187], 0
M v[144:147], a[68:71], a[188:191], v[144:147]
buffer_load_dwordx4 v5, s[8:11], s3 offen offset:3072 lds
M v[148:151], a[76:79], a[188:191], 0
M v[148:151], a[72:75], a[184:187], v[148:151]
M v[152:155], a[80:83], a[184:187], 0
M v[152:155], a[84:87], a[188:191], v[152:155]
ds_read_b64_tr_b16 a[124:125], v15 offset:49152
ds_read_b64_tr_b16 a[126:127], v15 offset:51200
M v[156:159], a[92:95], a[188:191], 0
s_add_u32 s23, s23, 128
s_cmp_eq_u32 s23, s25
s_cselect_b32 s23, s26, s23
M v[156:159], a[88:91], a[184:187], v[156:159]
s_waitcnt lgkmcnt(10)
M v[160:163], a[32:35], a[160:163], 0
M v[160:163], a[36:39], a[164:167], v[160:163]
ds_read_b128 a[176:179], v10 offset:20480
ds_read_b128 a[180:183], v11 offset:20480
M v[164:167], a[44:47], a[164:167], 0
M v[164:167], a[40:43], a[160:163], v[164:167]
ds_read_b64_tr_b16 a[132:133], v16 offset:49152
ds_read_b64_tr_b16 a[134:135], v16 offset:51200
M v[168:171], a[48:51], a[160:163], 0
M v[168:171], a[52:55], a[164:167], v[168:171]
s_add_u32 m0, s29, 81920
s_nop 0
buffer_load_dwordx4 v6, s[12:15], s24 offen offset:0 lds
M v[172:175], a[60:63], a[164:167], 0
M v[172:175], a[56:59], a[160:163], v[172:175]
M v[176:179], a[64:67], a[160:163], 0
M v[176:179], a[68:71], a[164:167], v[176:179]
ds_read_b64_tr_b16 a[140:141], v17 offset:49152
ds_read_b64_tr_b16 a[142:143], v17 offset:51200
M v[180:183], a[76:79], a[164:167], 0
M v[180:183], a[72:75], a[160:163], v[180:183]
buffer_load_dwordx4 v7, s[12:15], s24 offen offset:1024 lds
M v[184:187], a[80:83], a[160:163], 0
M v[184:187], a[84:87], a[164:167], v[184:187]
M v[188:191], a[92:95], a[164:167], 0
M v[188:191], a[88:91], a[160:163], v[188:191]
s_waitcnt lgkmcnt(12)
ds_read_b64_tr_b16 a[148:149], v18 offset:49152
ds_read_b64_tr_b16 a[150:151], v18 offset:51200
M v[192:195], a[32:35], a[168:171], 0
buffer_load_dwordx4 v8, s[12:15], s24 offen offset:2048 lds
M v[192:195], a[36:39], a[172:175], v[192:195]
ds_read_b128 a[184:187], v10 offset:22528
ds_read_b128 a[188:191], v11 offset:22528
M v[196:199], a[44:47], a[172:175], 0
M v[196:199], a[40:43], a[168:171], v[196:199]
M v[200:203], a[48:51], a[168:171], 0
M v[200:203], a[52:55], a[172:175], v[200:203]
ds_read_b64_tr_b16 a[156:157], v19 offset:49152
ds_read_b64_tr_b16 a[158:159], v19 offset:51200
M v[204:207], a[60:63], a[172:175], 0
buffer_load_dwordx4 v9, s[12:15], s24 offen offset:3072 lds
M v[204:207], a[56:59], a[168:171], v[204:207]
M v[208:211], a[64:67], a[168:171], 0
M v[208:211], a[68:71], a[172:175], v[208:211]
M v[212:215], a[76:79], a[172:175], 0
M v[212:215], a[72:75], a[168:171], v[212:215]
s_add_u32 s24, s24, 262144
s_cmp_eq_u32 s24, s27
s_cselect_b32 s24, s28, s24
s_sub_u32 s6, s6, 1
s_cmp_eq_u32 s6, 0
s_cselect_b64 s[12:13], s[64:65], s[12:13]
M v[216:219], a[80:83], a[168:171], 0
M v[216:219], a[84:87], a[172:175], v[216:219]
M v[220:223], a[92:95], a[172:175], 0
M v[220:223], a[88:91], a[168:171], v[220:223]
s_waitcnt lgkmcnt(10)
M v[224:227], a[32:35], a[176:179], 0
buffer_load_dword v21, v20, s[60:63], s54 offen
s_add_u32 s54, s54, 1048576
M v[224:227], a[36:39], a[180:183], v[224:227]
M v[228:231], a[44:47], a[180:183], 0
M v[228:231], a[40:43], a[176:179], v[228:231]
M v[232:235], a[48:51], a[176:179], 0
M v[232:235], a[52:55], a[180:183], v[232:235]
M v[236:239], a[60:63], a[180:183], 0
M v[236:239], a[56:59], a[176:179], v[236:239]
s_waitcnt vmcnt(9) lgkmcnt(0)
s_barrier
ds_read_b128 a[160:163], v10 offset:32768
ds_read_b128 a[164:167], v11 offset:32768
M v[240:243], a[64:67], a[176:179], 0
s_add_u32 m0, s29, 0
s_nop 0
buffer_load_dwordx4 v2, s[8:11], s23 offen offset:0 lds
M v[240:243], a[68:71], a[180:183], v[240:243]
M v[244:247], a[76:79], a[180:183], 0
M v[244:247], a[72:75], a[176:179], v[244:247]
M v[248:251], a[80:83], a[176:179], 0
M v[248:251], a[84:87], a[180:183], v[248:251]
buffer_load_dwordx4 v3, s[8:11], s23 offen offset:1024 lds
M v[252:255], a[92:95], a[180:183], 0
M v[252:255], a[88:91], a[176:179], v[252:255]
M a[0:3], a[32:35], a[184:187], 0
M a[0:3], a[36:39], a[188:191], a[0:3]
ds_read_b128 a[168:171], v10 offset:34816
ds_read_b128 a[172:175], v11 offset:34816
M a[4:7], a[44:47], a[188:191], 0
M a[4:7], a[40:43], a[184:187], a[4:7]
M a[8:11], a[48:51], a[184:187], 0
buffer_load_dwordx4 v4, s[8:11], s23 offen offset:2048 lds
M a[8:11], a[52:55], a[188:191], a[8:11]
M a[12:15], a[60:63], a[188:191], 0
M a[12:15], a[56:59], a[184:187], a[12:15]
M a[16:19], a[64:67], a[184:187], 0
M a[16:19], a[68:71], a[188:191], a[16:19]
buffer_load_dwordx4 v5, s[8:11], s23 offen offset:3072 lds
M a[20:23], a[76:79], a[188:191], 0
M a[20:23], a[72:75], a[184:187], a[20:23]
M a[24:27], a[80:83], a[184:187], 0
M a[24:27], a[84:87], a[188:191], a[24:27]
M a[28:31], a[92:95], a[188:191], 0
M a[28:31], a[88:91], a[184:187], a[28:31]
s_waitcnt lgkmcnt(2)
M v[32:35], a[96:99], a[160:163], v[32:35]
s_add_u32 m0, s29, 98304
s_nop 0
buffer_load_dwordx4 v6, s[12:15], s24 offen offset:0 lds
M v[32:35], a[100:103], a[164:167], v[32:35]
ds_read_b128 a[176:179], v10 offset:36864
ds_read_b128 a[180:183], v11 offset:36864
M v[36:39], a[108:111], a[164:167], v[36:39]
M v[36:39], a[104:107], a[160:163], v[36:39]
ds_read_b64_tr_b16 a[32:33], v12 offset:0
ds_read_b64_tr_b16 a[34:35], v12 offset:2048
M v[40:43], a[112:115], a[160:163], v[40:43]
M v[40:43], a[116:119], a[164:167], v[40:43]
M v[44:47], a[124:127], a[164:167], v[44:47]
M v[44:47], a[120:123], a[160:163], v[44:47]
ds_read_b64_tr_b16 a[40:41], v13 offset:0
ds_read_b64_tr_b16 a[42:43], v13 offset:2048
M v[48:51], a[128:131], a[160:163], v[48:51]
buffer_load_dwordx4 v7, s[12:15], s24 offen offset:1024 lds
M v[48:51], a[132:135], a[164:167], v[48:51]
M v[52:55], a[140:143], a[164:167], v[52:55]
M v[52:55], a[136:139], a[160:163], v[52:55]
ds_read_b64_tr_b16 a[48:49], v14 offset:0
ds_read_b64_tr_b16 a[50:51], v14 offset:2048
M v[56:59], a[144:147], a[160:163], v[56:59]
M v[56:59], a[148:151], a[164:167], v[56:59]
M v[60:63], a[156:159], a[164:167], v[60:63]
buffer_load_dwordx4 v8, s[12:15], s24 offen offset:2048 lds
M v[60:63], a[152:155], a[160:163], v[60:63]
s_waitcnt lgkmcnt(8)
ds_read_b64_tr_b16 a[56:57], v15 offset:0
ds_read_b64_tr_b16 a[58:59], v15 offset:2048
M v[64:67], a[96:99], a[168:171], v[64:67]
M v[64:67], a[100:103], a[172:175], v[64:67]
ds_read_b128 a[184:187], v10 offset:38912
ds_read_b128 a[188:191], v11 offset:38912
M v[68:71], a[108:111], a[172:175], v[68:71]
M v[68:71], a[104:107], a[168:171], v[68:71]
ds_read_b64_tr_b16 a[64:65], v16 offset:0
ds_read_b64_tr_b16 a[66:67], v16 offset:2048
M v[72:75], a[112:115], a[168:171], v[72:75]
M v[72:75], a[116:119], a[172:175], v[72:75]
M v[76:79], a[124:127], a[172:175], v[76:79]
M v[76:79], a[120:123], a[168:171], v[76:79]
ds_read_b64_tr_b16 a[72:73], v17 offset:0
ds_read_b64_tr_b16 a[74:75], v17 offset:2048
M v[80:83], a[128:131], a[168:171], v[80:83]
buffer_load_dwordx4 v9, s[12:15], s24 offen offset:3072 lds
M v[80:83], a[132:135], a[172:175], v[80:83]
M v[84:87], a[140:143], a[172:175], v[84:87]
M v[84:87], a[136:139], a[168:171], v[84:87]
ds_read_b64_tr_b16 a[80:81], v18 offset:0
ds_read_b64_tr_b16 a[82:83], v18 offset:2048
M v[88:91], a[144:147], a[168:171], v[88:91]
M v[88:91], a[148:151], a[172:175], v[88:91]
M v[92:95], a[156:159], a[172:175], v[92:95]
s_add_u32 s24, s24, 262144
M v[92:95], a[152:155], a[168:171], v[92:95]
s_waitcnt lgkmcnt(15)
ds_read_b64_tr_b16 a[88:89], v19 offset:0
ds_read_b64_tr_b16 a[90:91], v19 offset:2048
M v[96:99], a[96:99], a[176:179], v[96:99]
M v[96:99], a[100:103], a[180:183], v[96:99]
M v[100:103], a[108:111], a[180:183], v[100:103]
M v[100:103], a[104:107], a[176:179], v[100:103]
M v[104:107], a[112:115], a[176:179], v[104:107]
M v[104:107], a[116:119], a[180:183], v[104:107]
M v[108:111], a[124:127], a[180:183], v[108:111]
M v[108:111], a[120:123], a[176:179], v[108:111]
s_waitcnt vmcnt(9) lgkmcnt(0)
s_barrier
ds_read_b128 a[160:163], v10 offset:49152
ds_read_b128 a[164:167], v11 offset:49152
M v[112:115], a[128:131], a[176:179], v[112:115]
s_add_u32 m0, s29, 16384
s_add_u32 s3, s23, s31
buffer_load_dwordx4 v2, s[8:11], s3 offen offset:0 lds
M v[112:115], a[132:135], a[180:183], v[112:115]
M v[116:119], a[140:143], a[180:183], v[116:119]
M v[116:119], a[136:139], a[176:179], v[116:119]
ds_read_b64_tr_b16 a[36:37], v12 offset:16384
ds_read_b64_tr_b16 a[38:39], v12 offset:18432
M v[120:123], a[144:147], a[176:179], v[120:123]
M v[120:123], a[148:151], a[180:183], v[120:123]
buffer_load_dwordx4 v3, s[8:11], s3 offen offset:1024 lds
M v[124:127], a[156:159], a[180:183], v[124:127]
M v[124:127], a[152:155], a[176:179], v[124:127]
M v[128:131], a[96:99], a[184:187], v[128:131]
M v[128:131], a[100:103], a[188:191], v[128:131]
ds_read_b128 a[168:171], v10 offset:51200
ds_read_b128 a[172:175], v11 offset:51200
ds_read_b64_tr_b16 a[44:45], v13 offset:16384
ds_read_b64_tr_b16 a[46:47], v13 offset:18432
M v[132:135], a[108:111], a[188:191], v[132:135]
M v[132:135], a[104:107], a[184:187], v[132:135]
buffer_load_dwordx4 v4, s[8:11], s3 offen offset:2048 lds
M v[136:139], a[112:115], a[184:187], v[136:139]
M v[136:139], a[116:119], a[188:191], v[136:139]
M v[140:143], a[124:127], a[188:191], v[140:143]
M v[140:143], a[120:123], a[184:187], v[140:143]
ds_read_b64_tr_b16 a[52:53], v14 offset:16384
ds_read_b64_tr_b16 a[54:55], v14 offset:18432
M v[144:147], a[128:131], a[184:187], v[144:147]
buffer_load_dwordx4 v5, s[8:11], s3 offen offset:3072 lds
M v[144:147], a[132:135], a[188:191], v[144:147]
M v[148:151], a[140:143], a[188:191], v[148:151]
M v[148:151], a[136:139], a[184:187], v[148:151]
M v[152:155], a[144:147], a[184:187], v[152:155]
buffer_store_dwordx4 v[28:31], v23, s[16:19], s56 offen sc1
M v[152:155], a[148:151], a[188:191], v[152:155]
ds_read_b64_tr_b16 a[60:61], v15 offset:16384
ds_read_b64_tr_b16 a[62:63], v15 offset:18432
M v[156:159], a[156:159], a[188:191], v[156:159]
s_add_u32 s23, s23, 128
s_cmp_eq_u32 s23, s25
s_cselect_b32 s23, s26, s23
M v[156:159], a[152:155], a[184:187], v[156:159]
s_waitcnt lgkmcnt(10)
M v[160:163], a[96:99], a[160:163], v[160:163]
M v[160:163], a[100:103], a[164:167], v[160:163]
ds_read_b128 a[176:179], v10 offset:53248
ds_read_b128 a[180:183], v11 offset:53248
M v[164:167], a[108:111], a[164:167], v[164:167]
M v[164:167], a[104:107], a[160:163], v[164:167]
ds_read_b64_tr_b16 a[68:69], v16 offset:16384
ds_read_b64_tr_b16 a[70:71], v16 offset:18432
M v[168:171], a[112:115], a[160:163], v[168:171]
M v[168:171], a[116:119], a[164:167], v[168:171]
s_add_u32 m0, s29, 114688
s_nop 0
buffer_load_dwordx4 v6, s[12:15], s24 offen offset:0 lds
M v[172:175], a[124:127], a[164:167], v[172:175]
M v[172:175], a[120:123], a[160:163], v[172:175]
M v[176:179], a[128:131], a[160:163], v[176:179]
buffer_store_dwordx4 v[28:31], v23, s[16:19], s57 offen sc1
M v[176:179], a[132:135], a[164:167], v[176:179]
ds_read_b64_tr_b16 a[76:77], v17 offset:16384
ds_read_b64_tr_b16 a[78:79], v17 offset:18432
M v[180:183], a[140:143], a[164:167], v[180:183]
M v[180:183], a[136:139], a[160:163], v[180:183]
buffer_load_dwordx4 v7, s[12:15], s24 offen offset:1024 lds
M v[184:187], a[144:147], a[160:163], v[184:187]
M v[184:187], a[148:151], a[164:167], v[184:187]
M v[188:191], a[156:159], a[164:167], v[188:191]
M v[188:191], a[152:155], a[160:163], v[188:191]
s_waitcnt lgkmcnt(12)
ds_read_b64_tr_b16 a[84:85], v18 offset:16384
ds_read_b64_tr_b16 a[86:87], v18 offset:18432
M v[192:195], a[96:99], a[168:171], v[192:195]
buffer_load_dwordx4 v8, s[12:15], s24 offen offset:2048 lds
M v[192:195], a[100:103], a[172:175], v[192:195]
ds_read_b128 a[184:187], v10 offset:55296
ds_read_b128 a[188:191], v11 offset:55296
M v[196:199], a[108:111], a[172:175], v[196:199]
M v[196:199], a[104:107], a[168:171], v[196:199]
M v[200:203], a[112:115], a[168:171], v[200:203]
buffer_store_dwordx4 v[28:31], v23, s[16:19], s58 offen sc1
M v[200:203], a[116:119], a[172:175], v[200:203]
ds_read_b64_tr_b16 a[92:93], v19 offset:16384
ds_read_b64_tr_b16 a[94:95], v19 offset:18432
M v[204:207], a[124:127], a[172:175], v[204:207]
M v[204:207], a[120:123], a[168:171], v[204:207]
buffer_load_dwordx4 v9, s[12:15], s24 offen offset:3072 lds
M v[208:211], a[128:131], a[168:171], v[208:211]
M v[208:211], a[132:135], a[172:175], v[208:211]
M v[212:215], a[140:143], a[172:175], v[212:215]
M v[212:215], a[136:139], a[168:171], v[212:215]
s_add_u32 s24, s24, 262144
s_cmp_eq_u32 s24, s27
s_cselect_b32 s24, s28, s24
s_sub_u32 s6, s6, 1
s_cmp_eq_u32 s6, 0
s_cselect_b64 s[12:13], s[64:65], s[12:13]
M v[216:219], a[144:147], a[168:171], v[216:219]
M v[216:219], a[148:151], a[172:175], v[216:219]
M v[220:223], a[156:159], a[172:175], v[220:223]
M v[220:223], a[152:155], a[168:171], v[220:223]
s_waitcnt lgkmcnt(10)
M v[224:227], a[96:99], a[176:179], v[224:227]
buffer_store_dwordx4 v[28:31], v23, s[16:19], s59 offen sc1
M v[224:227], a[100:103], a[180:183], v[224:227]
buffer_load_dword v21, v20, s[60:63], s54 offen
s_add_u32 s54, s54, 1048576
M v[228:231], a[108:111], a[180:183], v[228:231]
M v[228:231], a[104:107], a[176:179], v[228:231]
M v[232:235], a[112:115], a[176:179], v[232:235]
M v[232:235], a[116:119], a[180:183], v[232:235]
M v[236:239], a[124:127], a[180:183], v[236:239]
M v[236:239], a[120:123], a[176:179], v[236:239]
s_waitcnt vmcnt(13) lgkmcnt(0)
s_barrier
ds_read_b128 a[160:163], v10 offset:0
ds_read_b128 a[164:167], v11 offset:0
M v[240:243], a[128:131], a[176:179], v[240:243]
s_add_u32 m0, s29, 32768
s_nop 0
buffer_load_dwordx4 v2, s[8:11], s23 offen offset:0 lds
M v[240:243], a[132:135], a[180:183], v[240:243]
M v[244:247], a[140:143], a[180:183], v[244:247]
M v[244:247], a[136:139], a[176:179], v[244:247]
M v[248:251], a[144:147], a[176:179], v[248:251]
M v[248:251], a[148:151], a[180:183], v[248:251]
buffer_load_dwordx4 v3, s[8:11], s23 offen offset:1024 lds
M v[252:255], a[156:159], a[180:183], v[252:255]
M v[252:255], a[152:155], a[176:179], v[252:255]
M a[0:3], a[96:99], a[184:187], a[0:3]
M a[0:3], a[100:103], a[188:191], a[0:3]
ds_read_b128 a[168:171], v10 offset:2048
ds_read_b128 a[172:175], v11 offset:2048
M a[4:7], a[108:111], a[188:191], a[4:7]
M a[4:7], a[104:107], a[184:187], a[4:7]
M a[8:11], a[112:115], a[184:187], a[8:11]
buffer_load_dwordx4 v4, s[8:11], s23 offen offset:2048 lds
M a[8:11], a[116:119], a[188:191], a[8:11]
M a[12:15], a[124:127], a[188:191], a[12:15]
M a[12:15], a[120:123], a[184:187], a[12:15]
M a[16:19], a[128:131], a[184:187], a[16:19]
M a[16:19], a[132:135], a[188:191], a[16:19]
buffer_load_dwordx4 v5, s[8:11], s23 offen offset:3072 lds
M a[20:23], a[140:143], a[188:191], a[20:23]
M a[20:23], a[136:139], a[184:187], a[20:23]
M a[24:27], a[144:147], a[184:187], a[24:27]
M a[24:27], a[148:151], a[188:191], a[24:27]
M a[28:31], a[156:159], a[188:191], a[28:31]
M a[28:31], a[152:155], a[184:187], a[28:31]
s_waitcnt lgkmcnt(2)
s_mov_b32 s30, 5
Lk1_ql:
M v[32:35], a[32:35], a[160:163], v[32:35]
s_add_u32 m0, s29, 65536
s_nop 0
buffer_load_dwordx4 v6, s[12:15], s24 offen offset:0 lds
M v[32:35], a[36:39], a[164:167], v[32:35]
ds_read_b128 a[176:179], v10 offset:4096
ds_read_b128 a[180:183], v11 offset:4096
M v[36:39], a[44:47], a[164:167], v[36:39]
M v[36:39], a[40:43], a[160:163], v[36:39]
ds_read_b64_tr_b16 a[96:97], v12 offset:32768
ds_read_b64_tr_b16 a[98:99], v12 offset:34816
M v[40:43], a[48:51], a[160:163], v[40:43]
M v[40:43], a[52:55], a[164:167], v[40:43]
M v[44:47], a[60:63], a[164:167], v[44:47]
M v[44:47], a[56:59], a[160:163], v[44:47]
ds_read_b64_tr_b16 a[104:105], v13 offset:32768
ds_read_b64_tr_b16 a[106:107], v13 offset:34816
M v[48:51], a[64:67], a[160:163], v[48:51]
buffer_load_dwordx4 v7, s[12:15], s24 offen offset:1024 lds
M v[48:51], a[68:71], a[164:167], v[48:51]
M v[52:55], a[76:79], a[164:167], v[52:55]
M v[52:55], a[72:75], a[160:163], v[52:55]
ds_read_b64_tr_b16 a[112:113], v14 offset:32768
ds_read_b64_tr_b16 a[114:115], v14 offset:34816
M v[56:59], a[80:83], a[160:163], v[56:59]
M v[56:59], a[84:87], a[164:167], v[56:59]
M v[60:63], a[92:95], a[164:167], v[60:63]
buffer_load_dwordx4 v8, s[12:15], s24 offen offset:2048 lds
M v[60:63], a[88:91], a[160:163], v[60:63]
s_waitcnt lgkmcnt(8)
ds_read_b64_tr_b16 a[120:121], v15 offset:32768
ds_read_b64_tr_b16 a[122:123], v15 offset:34816
M v[64:67], a[32:35], a[168:171], v[64:67]
M v[64:67], a[36:39], a[172:175], v[64:67]
ds_read_b128 a[184:187], v10 offset:6144
ds_read_b128 a[188:191], v11 offset:6144
M v[68:71], a[44:47], a[172:175], v[68:71]
M v[68:71], a[40:43], a[168:171], v[68:71]
ds_read_b64_tr_b16 a[128:129], v16 offset:32768
ds_read_b64_tr_b16 a[130:131], v16 offset:34816
M v[72:75], a[48:51], a[168:171], v[72:75]
M v[72:75], a[52:55], a[172:175], v[72:75]
M v[76:79], a[60:63], a[172:175], v[76:79]
M v[76:79], a[56:59], a[168:171], v[76:79]
ds_read_b64_tr_b16 a[136:137], v17 offset:32768
ds_read_b64_tr_b16 a[138:139], v17 offset:34816
M v[80:83], a[64:67], a[168:171], v[80:83]
buffer_load_dwordx4 v9, s[12:15], s24 offen offset:3072 lds
M v[80:83], a[68:71], a[172:175], v[80:83]
M v[84:87], a[76:79], a[172:175], v[84:87]
M v[84:87], a[72:75], a[168:171], v[84:87]
ds_read_b64_tr_b16 a[144:145], v18 offset:32768
ds_read_b64_tr_b16 a[146:147], v18 offset:34816
M v[88:91], a[80:83], a[168:171], v[88:91]
M v[88:91], a[84:87], a[172:175], v[88:91]
M v[92:95], a[92:95], a[172:175], v[92:95]
s_add_u32 s24, s24, 262144
M v[92:95], a[88:91], a[168:171], v[92:95]
s_waitcnt lgkmcnt(15)
ds_read_b64_tr_b16 a[152:153], v19 offset:32768
ds_read_b64_tr_b16 a[154:155], v19 offset:34816
M v[96:99], a[32:35], a[176:179], v[96:99]
M v[96:99], a[36:39], a[180:183], v[96:99]
M v[100:103], a[44:47], a[180:183], v[100:103]
M v[100:103], a[40:43], a[176:179], v[100:103]
M v[104:107], a[48:51], a[176:179], v[104:107]
M v[104:107], a[52:55], a[180:183], v[104:107]
M v[108:111], a[60:63], a[180:183], v[108:111]
M v[108:111], a[56:59], a[176:179], v[108:111]
s_waitcnt vmcnt(9) lgkmcnt(0)
s_barrier
ds_read_b128 a[160:163], v10 offset:16384
ds_read_b128 a[164:167], v11 offset:16384
M v[112:115], a[64:67], a[176:179], v[112:115]
s_add_u32 m0, s29, 49152
s_add_u32 s3, s23, s31
buffer_load_dwordx4 v2, s[8:11], s3 offen offset:0 lds
M v[112:115], a[68:71], a[180:183], v[112:115]
M v[116:119], a[76:79], a[180:183], v[116:119]
M v[116:119], a[72:75], a[176:179], v[116:119]
ds_read_b64_tr_b16 a[100:101], v12 offset:49152
ds_read_b64_tr_b16 a[102:103], v12 offset:51200
M v[120:123], a[80:83], a[176:179], v[120:123]
M v[120:123], a[84:87], a[180:183], v[120:123]
buffer_load_dwordx4 v3, s[8:11], s3 offen offset:1024 lds
M v[124:127], a[92:95], a[180:183], v[124:127]
M v[124:127], a[88:91], a[176:179], v[124:127]
M v[128:131], a[32:35], a[184:187], v[128:131]
M v[128:131], a[36:39], a[188:191], v[128:131]
ds_read_b128 a[168:171], v10 offset:18432
ds_read_b128 a[172:175], v11 offset:18432
ds_read_b64_tr_b16 a[108:109], v13 offset:49152
ds_read_b64_tr_b16 a[110:111], v13 offset:51200
M v[132:135], a[44:47], a[188:191], v[132:135]
M v[132:135], a[40:43], a[184:187], v[132:135]
buffer_load_dwordx4 v4, s[8:11], s3 offen offset:2048 lds
M v[136:139], a[48:51], a[184:187], v[136:139]
M v[136:139], a[52:55], a[188:191], v[136:139]
M v[140:143], a[60:63], a[188:191], v[140:143]
M v[140:143], a[56:59], a[184:187], v[140:143]
ds_read_b64_tr_b16 a[116:117], v14 offset:49152
ds_read_b64_tr_b16 a[118:119], v14 offset:51200
M v[144:147], a[64:67], a[184:187], v[144:147]
M v[144:147], a[68:71], a[188:191], v[144:147]
buffer_load_dwordx4 v5, s[8:11], s3 offen offset:3072 lds
M v[148:151], a[76:79], a[188:191], v[148:151]
M v[148:151], a[72:75], a[184:187], v[148:151]
M v[152:155], a[80:83], a[184:187], v[152:155]
M v[152:155], a[84:87], a[188:191], v[152:155]
ds_read_b64_tr_b16 a[124:125], v15 offset:49152
ds_read_b64_tr_b16 a[126:127], v15 offset:51200
M v[156:159], a[92:95], a[188:191], v[156:159]
s_add_u32 s23, s23, 128
s_cmp_eq_u32 s23, s25
s_cselect_b32 s23, s26, s23
M v[156:159], a[88:91], a[184:187], v[156:159]
s_waitcnt lgkmcnt(10)
M v[160:163], a[32:35], a[160:163], v[160:163]
M v[160:163], a[36:39], a[164:167], v[160:163]
ds_read_b128 a[176:179], v10 offset:20480
ds_read_b128 a[180:183], v11 offset:20480
M v[164:167], a[44:47], a[164:167], v[164:167]
M v[164:167], a[40:43], a[160:163], v[164:167]
ds_read_b64_tr_b16 a[132:133], v16 offset:49152
ds_read_b64_tr_b16 a[134:135], v16 offset:51200
M v[168:171], a[48:51], a[160:163], v[168:171]
M v[168:171], a[52:55], a[164:167], v[168:171]
s_add_u32 m0, s29, 81920
s_nop 0
buffer_load_dwordx4 v6, s[12:15], s24 offen offset:0 lds
M v[172:175], a[60:63], a[164:167], v[172:175]
M v[172:175], a[56:59], a[160:163], v[172:175]
M v[176:179], a[64:67], a[160:163], v[176:179]
M v[176:179], a[68:71], a[164:167], v[176:179]
ds_read_b64_tr_b16 a[140:141], v17 offset:49152
ds_read_b64_tr_b16 a[142:143], v17 offset:51200
M v[180:183], a[76:79], a[164:167], v[180:183]
M v[180:183], a[72:75], a[160:163], v[180:183]
buffer_load_dwordx4 v7, s[12:15], s24 offen offset:1024 lds
M v[184:187], a[80:83], a[160:163], v[184:187]
M v[184:187], a[84:87], a[164:167], v[184:187]
M v[188:191], a[92:95], a[164:167], v[188:191]
M v[188:191], a[88:91], a[160:163], v[188:191]
s_waitcnt lgkmcnt(12)
ds_read_b64_tr_b16 a[148:149], v18 offset:49152
ds_read_b64_tr_b16 a[150:151], v18 offset:51200
M v[192:195], a[32:35], a[168:171], v[192:195]
buffer_load_dwordx4 v8, s[12:15], s24 offen offset:2048 lds
M v[192:195], a[36:39], a[172:175], v[192:195]
ds_read_b128 a[184:187], v10 offset:22528
ds_read_b128 a[188:191], v11 offset:22528
M v[196:199], a[44:47], a[172:175], v[196:199]
M v[196:199], a[40:43], a[168:171], v[196:199]
M v[200:203], a[48:51], a[168:171], v[200:203]
M v[200:203], a[52:55], a[172:175], v[200:203]
ds_read_b64_tr_b16 a[156:157], v19 offset:49152
ds_read_b64_tr_b16 a[158:159], v19 offset:51200
M v[204:207], a[60:63], a[172:175], v[204:207]
buffer_load_dwordx4 v9, s[12:15], s24 offen offset:3072 lds
M v[204:207], a[56:59], a[168:171], v[204:207]
M v[208:211], a[64:67], a[168:171], v[208:211]
M v[208:211], a[68:71], a[172:175], v[208:211]
M v[212:215], a[76:79], a[172:175], v[212:215]
M v[212:215], a[72:75], a[168:171], v[212:215]
s_add_u32 s24, s24, 262144
s_cmp_eq_u32 s24, s27
s_cselect_b32 s24, s28, s24
s_sub_u32 s6, s6, 1
s_cmp_eq_u32 s6, 0
s_cselect_b64 s[12:13], s[64:65], s[12:13]
M v[216:219], a[80:83], a[168:171], v[216:219]
M v[216:219], a[84:87], a[172:175], v[216:219]
M v[220:223], a[92:95], a[172:175], v[220:223]
M v[220:223], a[88:91], a[168:171], v[220:223]
s_waitcnt lgkmcnt(10)
M v[224:227], a[32:35], a[176:179], v[224:227]
buffer_load_dword v21, v20, s[60:63], s54 offen
s_add_u32 s54, s54, 1048576
M v[224:227], a[36:39], a[180:183], v[224:227]
M v[228:231], a[44:47], a[180:183], v[228:231]
M v[228:231], a[40:43], a[176:179], v[228:231]
M v[232:235], a[48:51], a[176:179], v[232:235]
M v[232:235], a[52:55], a[180:183], v[232:235]
M v[236:239], a[60:63], a[180:183], v[236:239]
M v[236:239], a[56:59], a[176:179], v[236:239]
s_waitcnt vmcnt(9) lgkmcnt(0)
s_barrier
ds_read_b128 a[160:163], v10 offset:32768
ds_read_b128 a[164:167], v11 offset:32768
M v[240:243], a[64:67], a[176:179], v[240:243]
s_add_u32 m0, s29, 0
s_nop 0
buffer_load_dwordx4 v2, s[8:11], s23 offen offset:0 lds
M v[240:243], a[68:71], a[180:183], v[240:243]
M v[244:247], a[76:79], a[180:183], v[244:247]
M v[244:247], a[72:75], a[176:179], v[244:247]
M v[248:251], a[80:83], a[176:179], v[248:251]
M v[248:251], a[84:87], a[180:183], v[248:251]
buffer_load_dwordx4 v3, s[8:11], s23 offen offset:1024 lds
M v[252:255], a[92:95], a[180:183], v[252:255]
M v[252:255], a[88:91], a[176:179], v[252:255]
M a[0:3], a[32:35], a[184:187], a[0:3]
M a[0:3], a[36:39], a[188:191], a[0:3]
ds_read_b128 a[168:171], v10 offset:34816
ds_read_b128 a[172:175], v11 offset:34816
M a[4:7], a[44:47], a[188:191], a[4:7]
M a[4:7], a[40:43], a[184:187], a[4:7]
M a[8:11], a[48:51], a[184:187], a[8:11]
buffer_load_dwordx4 v4, s[8:11], s23 offen offset:2048 lds
M a[8:11], a[52:55], a[188:191], a[8:11]
M a[12:15], a[60:63], a[188:191], a[12:15]
M a[12:15], a[56:59], a[184:187], a[12:15]
M a[16:19], a[64:67], a[184:187], a[16:19]
M a[16:19], a[68:71], a[188:191], a[16:19]
buffer_load_dwordx4 v5, s[8:11], s23 offen offset:3072 lds
M a[20:23], a[76:79], a[188:191], a[20:23]
M a[20:23], a[72:75], a[184:187], a[20:23]
M a[24:27], a[80:83], a[184:187], a[24:27]
M a[24:27], a[84:87], a[188:191], a[24:27]
M a[28:31], a[92:95], a[188:191], a[28:31]
M a[28:31], a[88:91], a[184:187], a[28:31]
s_waitcnt lgkmcnt(2)
M v[32:35], a[96:99], a[160:163], v[32:35]
s_add_u32 m0, s29, 98304
s_nop 0
buffer_load_dwordx4 v6, s[12:15], s24 offen offset:0 lds
M v[32:35], a[100:103], a[164:167], v[32:35]
ds_read_b128 a[176:179], v10 offset:36864
ds_read_b128 a[180:183], v11 offset:36864
M v[36:39], a[108:111], a[164:167], v[36:39]
M v[36:39], a[104:107], a[160:163], v[36:39]
ds_read_b64_tr_b16 a[32:33], v12 offset:0
ds_read_b64_tr_b16 a[34:35], v12 offset:2048
M v[40:43], a[112:115], a[160:163], v[40:43]
M v[40:43], a[116:119], a[164:167], v[40:43]
M v[44:47], a[124:127], a[164:167], v[44:47]
M v[44:47], a[120:123], a[160:163], v[44:47]
ds_read_b64_tr_b16 a[40:41], v13 offset:0
ds_read_b64_tr_b16 a[42:43], v13 offset:2048
M v[48:51], a[128:131], a[160:163], v[48:51]
buffer_load_dwordx4 v7, s[12:15], s24 offen offset:1024 lds
M v[48:51], a[132:135], a[164:167], v[48:51]
M v[52:55], a[140:143], a[164:167], v[52:55]
M v[52:55], a[136:139], a[160:163], v[52:55]
ds_read_b64_tr_b16 a[48:49], v14 offset:0
ds_read_b64_tr_b16 a[50:51], v14 offset:2048
M v[56:59], a[144:147], a[160:163], v[56:59]
M v[56:59], a[148:151], a[164:167], v[56:59]
M v[60:63], a[156:159], a[164:167], v[60:63]
buffer_load_dwordx4 v8, s[12:15], s24 offen offset:2048 lds
M v[60:63], a[152:155], a[160:163], v[60:63]
s_waitcnt lgkmcnt(8)
ds_read_b64_tr_b16 a[56:57], v15 offset:0
ds_read_b64_tr_b16 a[58:59], v15 offset:2048
M v[64:67], a[96:99], a[168:171], v[64:67]
M v[64:67], a[100:103], a[172:175], v[64:67]
ds_read_b128 a[184:187], v10 offset:38912
ds_read_b128 a[188:191], v11 offset:38912
M v[68:71], a[108:111], a[172:175], v[68:71]
M v[68:71], a[104:107], a[168:171], v[68:71]
ds_read_b64_tr_b16 a[64:65], v16 offset:0
ds_read_b64_tr_b16 a[66:67], v16 offset:2048
M v[72:75], a[112:115], a[168:171], v[72:75]
M v[72:75], a[116:119], a[172:175], v[72:75]
M v[76:79], a[124:127], a[172:175], v[76:79]
M v[76:79], a[120:123], a[168:171], v[76:79]
ds_read_b64_tr_b16 a[72:73], v17 offset:0
ds_read_b64_tr_b16 a[74:75], v17 offset:2048
M v[80:83], a[128:131], a[168:171], v[80:83]
buffer_load_dwordx4 v9, s[12:15], s24 offen offset:3072 lds
M v[80:83], a[132:135], a[172:175], v[80:83]
M v[84:87], a[140:143], a[172:175], v[84:87]
M v[84:87], a[136:139], a[168:171], v[84:87]
ds_read_b64_tr_b16 a[80:81], v18 offset:0
ds_read_b64_tr_b16 a[82:83], v18 offset:2048
M v[88:91], a[144:147], a[168:171], v[88:91]
M v[88:91], a[148:151], a[172:175], v[88:91]
M v[92:95], a[156:159], a[172:175], v[92:95]
s_add_u32 s24, s24, 262144
M v[92:95], a[152:155], a[168:171], v[92:95]
s_waitcnt lgkmcnt(15)
ds_read_b64_tr_b16 a[88:89], v19 offset:0
ds_read_b64_tr_b16 a[90:91], v19 offset:2048
M v[96:99], a[96:99], a[176:179], v[96:99]
M v[96:99], a[100:103], a[180:183], v[96:99]
M v[100:103], a[108:111], a[180:183], v[100:103]
M v[100:103], a[104:107], a[176:179], v[100:103]
M v[104:107], a[112:115], a[176:179], v[104:107]
M v[104:107], a[116:119], a[180:183], v[104:107]
M v[108:111], a[124:127], a[180:183], v[108:111]
M v[108:111], a[120:123], a[176:179], v[108:111]
s_waitcnt vmcnt(9) lgkmcnt(0)
s_barrier
ds_read_b128 a[160:163], v10 offset:49152
ds_read_b128 a[164:167], v11 offset:49152
M v[112:115], a[128:131], a[176:179], v[112:115]
s_add_u32 m0, s29, 16384
s_add_u32 s3, s23, s31
buffer_load_dwordx4 v2, s[8:11], s3 offen offset:0 lds
M v[112:115], a[132:135], a[180:183], v[112:115]
M v[116:119], a[140:143], a[180:183], v[116:119]
M v[116:119], a[136:139], a[176:179], v[116:119]
ds_read_b64_tr_b16 a[36:37], v12 offset:16384
ds_read_b64_tr_b16 a[38:39], v12 offset:18432
M v[120:123], a[144:147], a[176:179], v[120:123]
M v[120:123], a[148:151], a[180:183], v[120:123]
buffer_load_dwordx4 v3, s[8:11], s3 offen offset:1024 lds
M v[124:127], a[156:159], a[180:183], v[124:127]
M v[124:127], a[152:155], a[176:179], v[124:127]
M v[128:131], a[96:99], a[184:187], v[128:131]
M v[128:131], a[100:103], a[188:191], v[128:131]
ds_read_b128 a[168:171], v10 offset:51200
ds_read_b128 a[172:175], v11 offset:51200
ds_read_b64_tr_b16 a[44:45], v13 offset:16384
ds_read_b64_tr_b16 a[46:47], v13 offset:18432
M v[132:135], a[108:111], a[188:191], v[132:135]
M v[132:135], a[104:107], a[184:187], v[132:135]
buffer_load_dwordx4 v4, s[8:11], s3 offen offset:2048 lds
M v[136:139], a[112:115], a[184:187], v[136:139]
M v[136:139], a[116:119], a[188:191], v[136:139]
M v[140:143], a[124:127], a[188:191], v[140:143]
M v[140:143], a[120:123], a[184:187], v[140:143]
ds_read_b64_tr_b16 a[52:53], v14 offset:16384
ds_read_b64_tr_b16 a[54:55], v14 offset:18432
M v[144:147], a[128:131], a[184:187], v[144:147]
M v[144:147], a[132:135], a[188:191], v[144:147]
buffer_load_dwordx4 v5, s[8:11], s3 offen offset:3072 lds
M v[148:151], a[140:143], a[188:191], v[148:151]
M v[148:151], a[136:139], a[184:187], v[148:151]
M v[152:155], a[144:147], a[184:187], v[152:155]
M v[152:155], a[148:151], a[188:191], v[152:155]
ds_read_b64_tr_b16 a[60:61], v15 offset:16384
ds_read_b64_tr_b16 a[62:63], v15 offset:18432
M v[156:159], a[156:159], a[188:191], v[156:159]
s_add_u32 s23, s23, 128
s_cmp_eq_u32 s23, s25
s_cselect_b32 s23, s26, s23
M v[156:159], a[152:155], a[184:187], v[156:159]
s_waitcnt lgkmcnt(10)
M v[160:163], a[96:99], a[160:163], v[160:163]
M v[160:163], a[100:103], a[164:167], v[160:163]
ds_read_b128 a[176:179], v10 offset:53248
ds_read_b128 a[180:183], v11 offset:53248
M v[164:167], a[108:111], a[164:167], v[164:167]
M v[164:167], a[104:107], a[160:163], v[164:167]
ds_read_b64_tr_b16 a[68:69], v16 offset:16384
ds_read_b64_tr_b16 a[70:71], v16 offset:18432
M v[168:171], a[112:115], a[160:163], v[168:171]
M v[168:171], a[116:119], a[164:167], v[168:171]
s_add_u32 m0, s29, 114688
s_nop 0
buffer_load_dwordx4 v6, s[12:15], s24 offen offset:0 lds
M v[172:175], a[124:127], a[164:167], v[172:175]
M v[172:175], a[120:123], a[160:163], v[172:175]
M v[176:179], a[128:131], a[160:163], v[176:179]
M v[176:179], a[132:135], a[164:167], v[176:179]
ds_read_b64_tr_b16 a[76:77], v17 offset:16384
ds_read_b64_tr_b16 a[78:79], v17 offset:18432
M v[180:183], a[140:143], a[164:167], v[180:183]
M v[180:183], a[136:139], a[160:163], v[180:183]
buffer_load_dwordx4 v7, s[12:15], s24 offen offset:1024 lds
M v[184:187], a[144:147], a[160:163], v[184:187]
M v[184:187], a[148:151], a[164:167], v[184:187]
M v[188:191], a[156:159], a[164:167], v[188:191]
M v[188:191], a[152:155], a[160:163], v[188:191]
s_waitcnt lgkmcnt(12)
ds_read_b64_tr_b16 a[84:85], v18 offset:16384
ds_read_b64_tr_b16 a[86:87], v18 offset:18432
M v[192:195], a[96:99], a[168:171], v[192:195]
buffer_load_dwordx4 v8, s[12:15], s24 offen offset:2048 lds
M v[192:195], a[100:103], a[172:175], v[192:195]
ds_read_b128 a[184:187], v10 offset:55296
ds_read_b128 a[188:191], v11 offset:55296
M v[196:199], a[108:111], a[172:175], v[196:199]
M v[196:199], a[104:107], a[168:171], v[196:199]
M v[200:203], a[112:115], a[168:171], v[200:203]
M v[200:203], a[116:119], a[172:175], v[200:203]
ds_read_b64_tr_b16 a[92:93], v19 offset:16384
ds_read_b64_tr_b16 a[94:95], v19 offset:18432
M v[204:207], a[124:127], a[172:175], v[204:207]
buffer_load_dwordx4 v9, s[12:15], s24 offen offset:3072 lds
M v[204:207], a[120:123], a[168:171], v[204:207]
M v[208:211], a[128:131], a[168:171], v[208:211]
M v[208:211], a[132:135], a[172:175], v[208:211]
M v[212:215], a[140:143], a[172:175], v[212:215]
M v[212:215], a[136:139], a[168:171], v[212:215]
s_add_u32 s24, s24, 262144
s_cmp_eq_u32 s24, s27
s_cselect_b32 s24, s28, s24
s_sub_u32 s6, s6, 1
s_cmp_eq_u32 s6, 0
s_cselect_b64 s[12:13], s[64:65], s[12:13]
M v[216:219], a[144:147], a[168:171], v[216:219]
M v[216:219], a[148:151], a[172:175], v[216:219]
M v[220:223], a[156:159], a[172:175], v[220:223]
M v[220:223], a[152:155], a[168:171], v[220:223]
s_waitcnt lgkmcnt(10)
M v[224:227], a[96:99], a[176:179], v[224:227]
buffer_load_dword v21, v20, s[60:63], s54 offen
s_add_u32 s54, s54, 1048576
M v[224:227], a[100:103], a[180:183], v[224:227]
M v[228:231], a[108:111], a[180:183], v[228:231]
M v[228:231], a[104:107], a[176:179], v[228:231]
M v[232:235], a[112:115], a[176:179], v[232:235]
M v[232:235], a[116:119], a[180:183], v[232:235]
M v[236:239], a[124:127], a[180:183], v[236:239]
M v[236:239], a[120:123], a[176:179], v[236:239]
s_waitcnt vmcnt(9) lgkmcnt(0)
s_barrier
ds_read_b128 a[160:163], v10 offset:0
ds_read_b128 a[164:167], v11 offset:0
M v[240:243], a[128:131], a[176:179], v[240:243]
s_add_u32 m0, s29, 32768
s_nop 0
buffer_load_dwordx4 v2, s[8:11], s23 offen offset:0 lds
M v[240:243], a[132:135], a[180:183], v[240:243]
M v[244:247], a[140:143], a[180:183], v[244:247]
M v[244:247], a[136:139], a[176:179], v[244:247]
M v[248:251], a[144:147], a[176:179], v[248:251]
M v[248:251], a[148:151], a[180:183], v[248:251]
buffer_load_dwordx4 v3, s[8:11], s23 offen offset:1024 lds
M v[252:255], a[156:159], a[180:183], v[252:255]
M v[252:255], a[152:155], a[176:179], v[252:255]
M a[0:3], a[96:99], a[184:187], a[0:3]
M a[0:3], a[100:103], a[188:191], a[0:3]
ds_read_b128 a[168:171], v10 offset:2048
ds_read_b128 a[172:175], v11 offset:2048
M a[4:7], a[108:111], a[188:191], a[4:7]
M a[4:7], a[104:107], a[184:187], a[4:7]
M a[8:11], a[112:115], a[184:187], a[8:11]
buffer_load_dwordx4 v4, s[8:11], s23 offen offset:2048 lds
M a[8:11], a[116:119], a[188:191], a[8:11]
M a[12:15], a[124:127], a[188:191], a[12:15]
M a[12:15], a[120:123], a[184:187], a[12:15]
M a[16:19], a[128:131], a[184:187], a[16:19]
M a[16:19], a[132:135], a[188:191], a[16:19]
buffer_load_dwordx4 v5, s[8:11], s23 offen offset:3072 lds
M a[20:23], a[140:143], a[188:191], a[20:23]
M a[20:23], a[136:139], a[184:187], a[20:23]
M a[24:27], a[144:147], a[184:187], a[24:27]
M a[24:27], a[148:151], a[188:191], a[24:27]
M a[28:31], a[156:159], a[188:191], a[28:31]
M a[28:31], a[152:155], a[184:187], a[28:31]
s_waitcnt lgkmcnt(2)
s_sub_u32 s30, s30, 1
s_cmp_lg_u32 s30, 0
s_cbranch_scc1 Lk1_ql
M v[32:35], a[32:35], a[160:163], v[32:35]
s_add_u32 m0, s29, 65536
s_nop 0
buffer_load_dwordx4 v6, s[12:15], s24 offen offset:0 lds
M v[32:35], a[36:39], a[164:167], v[32:35]
ds_read_b128 a[176:179], v10 offset:4096
ds_read_b128 a[180:183], v11 offset:4096
M v[36:39], a[44:47], a[164:167], v[36:39]
M v[36:39], a[40:43], a[160:163], v[36:39]
ds_read_b64_tr_b16 a[96:97], v12 offset:32768
ds_read_b64_tr_b16 a[98:99], v12 offset:34816
M v[40:43], a[48:51], a[160:163], v[40:43]
M v[40:43], a[52:55], a[164:167], v[40:43]
M v[44:47], a[60:63], a[164:167], v[44:47]
M v[44:47], a[56:59], a[160:163], v[44:47]
ds_read_b64_tr_b16 a[104:105], v13 offset:32768
ds_read_b64_tr_b16 a[106:107], v13 offset:34816
M v[48:51], a[64:67], a[160:163], v[48:51]
buffer_load_dwordx4 v7, s[12:15], s24 offen offset:1024 lds
M v[48:51], a[68:71], a[164:167], v[48:51]
M v[52:55], a[76:79], a[164:167], v[52:55]
M v[52:55], a[72:75], a[160:163], v[52:55]
ds_read_b64_tr_b16 a[112:113], v14 offset:32768
ds_read_b64_tr_b16 a[114:115], v14 offset:34816
M v[56:59], a[80:83], a[160:163], v[56:59]
M v[56:59], a[84:87], a[164:167], v[56:59]
M v[60:63], a[92:95], a[164:167], v[60:63]
buffer_load_dwordx4 v8, s[12:15], s24 offen offset:2048 lds
M v[60:63], a[88:91], a[160:163], v[60:63]
s_waitcnt lgkmcnt(8)
ds_read_b64_tr_b16 a[120:121], v15 offset:32768
ds_read_b64_tr_b16 a[122:123], v15 offset:34816
M v[64:67], a[32:35], a[168:171], v[64:67]
M v[64:67], a[36:39], a[172:175], v[64:67]
ds_read_b128 a[184:187], v10 offset:6144
ds_read_b128 a[188:191], v11 offset:6144
M v[68:71], a[44:47], a[172:175], v[68:71]
M v[68:71], a[40:43], a[168:171], v[68:71]
ds_read_b64_tr_b16 a[128:129], v16 offset:32768
ds_read_b64_tr_b16 a[130:131], v16 offset:34816
M v[72:75], a[48:51], a[168:171], v[72:75]
M v[72:75], a[52:55], a[172:175], v[72:75]
M v[76:79], a[60:63], a[172:175], v[76:79]
M v[76:79], a[56:59], a[168:171], v[76:79]
ds_read_b64_tr_b16 a[136:137], v17 offset:32768
ds_read_b64_tr_b16 a[138:139], v17 offset:34816
M v[80:83], a[64:67], a[168:171], v[80:83]
buffer_load_dwordx4 v9, s[12:15], s24 offen offset:3072 lds
M v[80:83], a[68:71], a[172:175], v[80:83]
M v[84:87], a[76:79], a[172:175], v[84:87]
M v[84:87], a[72:75], a[168:171], v[84:87]
ds_read_b64_tr_b16 a[144:145], v18 offset:32768
ds_read_b64_tr_b16 a[146:147], v18 offset:34816
M v[88:91], a[80:83], a[168:171], v[88:91]
M v[88:91], a[84:87], a[172:175], v[88:91]
M v[92:95], a[92:95], a[172:175], v[92:95]
s_add_u32 s24, s24, 262144
M v[92:95], a[88:91], a[168:171], v[92:95]
s_waitcnt lgkmcnt(15)
ds_read_b64_tr_b16 a[152:153], v19 offset:32768
ds_read_b64_tr_b16 a[154:155], v19 offset:34816
M v[96:99], a[32:35], a[176:179], v[96:99]
M v[96:99], a[36:39], a[180:183], v[96:99]
M v[100:103], a[44:47], a[180:183], v[100:103]
M v[100:103], a[40:43], a[176:179], v[100:103]
M v[104:107], a[48:51], a[176:179], v[104:107]
M v[104:107], a[52:55], a[180:183], v[104:107]
M v[108:111], a[60:63], a[180:183], v[108:111]
M v[108:111], a[56:59], a[176:179], v[108:111]
s_waitcnt vmcnt(9) lgkmcnt(0)
s_barrier
ds_read_b128 a[160:163], v10 offset:16384
ds_read_b128 a[164:167], v11 offset:16384
M v[112:115], a[64:67], a[176:179], v[112:115]
s_add_u32 m0, s29, 49152
s_add_u32 s3, s23, s31
buffer_load_dwordx4 v2, s[8:11], s3 offen offset:0 lds
M v[112:115], a[68:71], a[180:183], v[112:115]
M v[116:119], a[76:79], a[180:183], v[116:119]
M v[116:119], a[72:75], a[176:179], v[116:119]
ds_read_b64_tr_b16 a[100:101], v12 offset:49152
ds_read_b64_tr_b16 a[102:103], v12 offset:51200
M v[120:123], a[80:83], a[176:179], v[120:123]
M v[120:123], a[84:87], a[180:183], v[120:123]
buffer_load_dwordx4 v3, s[8:11], s3 offen offset:1024 lds
M v[124:127], a[92:95], a[180:183], v[124:127]
M v[124:127], a[88:91], a[176:179], v[124:127]
M v[128:131], a[32:35], a[184:187], v[128:131]
M v[128:131], a[36:39], a[188:191], v[128:131]
ds_read_b128 a[168:171], v10 offset:18432
ds_read_b128 a[172:175], v11 offset:18432
ds_read_b64_tr_b16 a[108:109], v13 offset:49152
ds_read_b64_tr_b16 a[110:111], v13 offset:51200
M v[132:135], a[44:47], a[188:191], v[132:135]
M v[132:135], a[40:43], a[184:187], v[132:135]
M v[136:139], a[48:51], a[184:187], v[136:139]
buffer_load_dwordx4 v4, s[8:11], s3 offen offset:2048 lds
M v[136:139], a[52:55], a[188:191], v[136:139]
M v[140:143], a[60:63], a[188:191], v[140:143]
M v[140:143], a[56:59], a[184:187], v[140:143]
ds_read_b64_tr_b16 a[116:117], v14 offset:49152
ds_read_b64_tr_b16 a[118:119], v14 offset:51200
M v[144:147], a[64:67], a[184:187], v[144:147]
M v[144:147], a[68:71], a[188:191], v[144:147]
M v[148:151], a[76:79], a[188:191], v[148:151]
buffer_load_dwordx4 v5, s[8:11], s3 offen offset:3072 lds
M v[148:151], a[72:75], a[184:187], v[148:151]
M v[152:155], a[80:83], a[184:187], v[152:155]
M v[152:155], a[84:87], a[188:191], v[152:155]
ds_read_b64_tr_b16 a[124:125], v15 offset:49152
ds_read_b64_tr_b16 a[126:127], v15 offset:51200
M v[156:159], a[92:95], a[188:191], v[156:159]
M v[156:159], a[88:91], a[184:187], v[156:159]
s_waitcnt lgkmcnt(10)
M v[160:163], a[32:35], a[160:163], v[160:163]
M v[160:163], a[36:39], a[164:167], v[160:163]
ds_read_b128 a[176:179], v10 offset:20480
ds_read_b128 a[180:183], v11 offset:20480
M v[164:167], a[44:47], a[164:167], v[164:167]
s_add_u32 s23, s23, 128
s_cmp_eq_u32 s23, s25
s_cselect_b32 s23, s26, s23
M v[164:167], a[40:43], a[160:163], v[164:167]
ds_read_b64_tr_b16 a[132:133], v16 offset:49152
ds_read_b64_tr_b16 a[134:135], v16 offset:51200
M v[168:171], a[48:51], a[160:163], v[168:171]
M v[168:171], a[52:55], a[164:167], v[168:171]
M v[172:175], a[60:63], a[164:167], v[172:175]
M v[172:175], a[56:59], a[160:163], v[172:175]
M v[176:179], a[64:67], a[160:163], v[176:179]
s_add_u32 m0, s29, 81920
s_nop 0
buffer_load_dwordx4 v6, s[12:15], s24 offen offset:0 lds
M v[176:179], a[68:71], a[164:167], v[176:179]
ds_read_b64_tr_b16 a[140:141], v17 offset:49152
ds_read_b64_tr_b16 a[142:143], v17 offset:51200
M v[180:183], a[76:79], a[164:167], v[180:183]
M v[180:183], a[72:75], a[160:163], v[180:183]
M v[184:187], a[80:83], a[160:163], v[184:187]
M v[184:187], a[84:87], a[164:167], v[184:187]
buffer_load_dwordx4 v7, s[12:15], s24 offen offset:1024 lds
M v[188:191], a[92:95], a[164:167], v[188:191]
M v[188:191], a[88:91], a[160:163], v[188:191]
s_waitcnt lgkmcnt(12)
ds_read_b64_tr_b16 a[148:149], v18 offset:49152
ds_read_b64_tr_b16 a[150:151], v18 offset:51200
M v[192:195], a[32:35], a[168:171], v[192:195]
M v[192:195], a[36:39], a[172:175], v[192:195]
ds_read_b128 a[184:187], v10 offset:22528
ds_read_b128 a[188:191], v11 offset:22528
M v[196:199], a[44:47], a[172:175], v[196:199]
M v[196:199], a[40:43], a[168:171], v[196:199]
M v[200:203], a[48:51], a[168:171], v[200:203]
buffer_load_dwordx4 v8, s[12:15], s24 offen offset:2048 lds
M v[200:203], a[52:55], a[172:175], v[200:203]
ds_read_b64_tr_b16 a[156:157], v19 offset:49152
ds_read_b64_tr_b16 a[158:159], v19 offset:51200
M v[204:207], a[60:63], a[172:175], v[204:207]
M v[204:207], a[56:59], a[168:171], v[204:207]
M v[208:211], a[64:67], a[168:171], v[208:211]
M v[208:211], a[68:71], a[172:175], v[208:211]
M v[212:215], a[76:79], a[172:175], v[212:215]
buffer_load_dwordx4 v9, s[12:15], s24 offen offset:3072 lds
M v[212:215], a[72:75], a[168:171], v[212:215]
M v[216:219], a[80:83], a[168:171], v[216:219]
M v[216:219], a[84:87], a[172:175], v[216:219]
M v[220:223], a[92:95], a[172:175], v[220:223]
M v[220:223], a[88:91], a[168:171], v[220:223]
s_waitcnt lgkmcnt(10)
M v[224:227], a[32:35], a[176:179], v[224:227]
s_add_u32 s24, s24, 262144
s_cmp_eq_u32 s24, s27
s_cselect_b32 s24, s28, s24
s_sub_u32 s6, s6, 1
s_cmp_eq_u32 s6, 0
s_cselect_b64 s[12:13], s[64:65], s[12:13]
M v[224:227], a[36:39], a[180:183], v[224:227]
M v[228:231], a[44:47], a[180:183], v[228:231]
M v[228:231], a[40:43], a[176:179], v[228:231]
M v[232:235], a[48:51], a[176:179], v[232:235]
M v[232:235], a[52:55], a[180:183], v[232:235]
M v[236:239], a[60:63], a[180:183], v[236:239]
M v[236:239], a[56:59], a[176:179], v[236:239]
s_waitcnt vmcnt(8) lgkmcnt(0)
s_barrier
ds_read_b128 a[160:163], v10 offset:32768
ds_read_b128 a[164:167], v11 offset:32768
M v[240:243], a[64:67], a[176:179], v[240:243]
s_add_u32 m0, s29, 0
s_nop 0
buffer_load_dwordx4 v2, s[8:11], s23 offen offset:0 lds
M v[240:243], a[68:71], a[180:183], v[240:243]
M v[244:247], a[76:79], a[180:183], v[244:247]
M v[244:247], a[72:75], a[176:179], v[244:247]
M v[248:251], a[80:83], a[176:179], v[248:251]
M v[248:251], a[84:87], a[180:183], v[248:251]
buffer_load_dwordx4 v3, s[8:11], s23 offen offset:1024 lds
M v[252:255], a[92:95], a[180:183], v[252:255]
M v[252:255], a[88:91], a[176:179], v[252:255]
M a[0:3], a[32:35], a[184:187], a[0:3]
M a[0:3], a[36:39], a[188:191], a[0:3]
ds_read_b128 a[168:171], v10 offset:34816
ds_read_b128 a[172:175], v11 offset:34816
M a[4:7], a[44:47], a[188:191], a[4:7]
M a[4:7], a[40:43], a[184:187], a[4:7]
M a[8:11], a[48:51], a[184:187], a[8:11]
buffer_load_dwordx4 v4, s[8:11], s23 offen offset:2048 lds
M a[8:11], a[52:55], a[188:191], a[8:11]
M a[12:15], a[60:63], a[188:191], a[12:15]
M a[12:15], a[56:59], a[184:187], a[12:15]
M a[16:19], a[64:67], a[184:187], a[16:19]
M a[16:19], a[68:71], a[188:191], a[16:19]
buffer_load_dwordx4 v5, s[8:11], s23 offen offset:3072 lds
M a[20:23], a[76:79], a[188:191], a[20:23]
M a[20:23], a[72:75], a[184:187], a[20:23]
M a[24:27], a[80:83], a[184:187], a[24:27]
M a[24:27], a[84:87], a[188:191], a[24:27]
M a[28:31], a[92:95], a[188:191], a[28:31]
M a[28:31], a[88:91], a[184:187], a[28:31]
s_waitcnt lgkmcnt(2)
M v[32:35], a[96:99], a[160:163], v[32:35]
s_add_u32 m0, s29, 98304
s_nop 0
buffer_load_dwordx4 v6, s[12:15], s24 offen offset:0 lds
M v[32:35], a[100:103], a[164:167], v[32:35]
ds_read_b128 a[176:179], v10 offset:36864
ds_read_b128 a[180:183], v11 offset:36864
M v[36:39], a[108:111], a[164:167], v[36:39]
M v[36:39], a[104:107], a[160:163], v[36:39]
ds_read_b64_tr_b16 a[32:33], v12 offset:0
ds_read_b64_tr_b16 a[34:35], v12 offset:2048
M v[40:43], a[112:115], a[160:163], v[40:43]
M v[40:43], a[116:119], a[164:167], v[40:43]
M v[44:47], a[124:127], a[164:167], v[44:47]
M v[44:47], a[120:123], a[160:163], v[44:47]
ds_read_b64_tr_b16 a[40:41], v13 offset:0
ds_read_b64_tr_b16 a[42:43], v13 offset:2048
M v[48:51], a[128:131], a[160:163], v[48:51]
buffer_load_dwordx4 v7, s[12:15], s24 offen offset:1024 lds
M v[48:51], a[132:135], a[164:167], v[48:51]
M v[52:55], a[140:143], a[164:167], v[52:55]
M v[52:55], a[136:139], a[160:163], v[52:55]
ds_read_b64_tr_b16 a[48:49], v14 offset:0
ds_read_b64_tr_b16 a[50:51], v14 offset:2048
M v[56:59], a[144:147], a[160:163], v[56:59]
M v[56:59], a[148:151], a[164:167], v[56:59]
M v[60:63], a[156:159], a[164:167], v[60:63]
buffer_load_dwordx4 v8, s[12:15], s24 offen offset:2048 lds
M v[60:63], a[152:155], a[160:163], v[60:63]
s_waitcnt lgkmcnt(8)
ds_read_b64_tr_b16 a[56:57], v15 offset:0
ds_read_b64_tr_b16 a[58:59], v15 offset:2048
M v[64:67], a[96:99], a[168:171], v[64:67]
M v[64:67], a[100:103], a[172:175], v[64:67]
ds_read_b128 a[184:187], v10 offset:38912
ds_read_b128 a[188:191], v11 offset:38912
M v[68:71], a[108:111], a[172:175], v[68:71]
M v[68:71], a[104:107], a[168:171], v[68:71]
ds_read_b64_tr_b16 a[64:65], v16 offset:0
ds_read_b64_tr_b16 a[66:67], v16 offset:2048
M v[72:75], a[112:115], a[168:171], v[72:75]
M v[72:75], a[116:119], a[172:175], v[72:75]
M v[76:79], a[124:127], a[172:175], v[76:79]
M v[76:79], a[120:123], a[168:171], v[76:79]
ds_read_b64_tr_b16 a[72:73], v17 offset:0
ds_read_b64_tr_b16 a[74:75], v17 offset:2048
M v[80:83], a[128:131], a[168:171], v[80:83]
buffer_load_dwordx4 v9, s[12:15], s24 offen offset:3072 lds
M v[80:83], a[132:135], a[172:175], v[80:83]
M v[84:87], a[140:143], a[172:175], v[84:87]
M v[84:87], a[136:139], a[168:171], v[84:87]
ds_read_b64_tr_b16 a[80:81], v18 offset:0
ds_read_b64_tr_b16 a[82:83], v18 offset:2048
M v[88:91], a[144:147], a[168:171], v[88:91]
M v[88:91], a[148:151], a[172:175], v[88:91]
M v[92:95], a[156:159], a[172:175], v[92:95]
s_add_u32 s24, s24, 262144
M v[92:95], a[152:155], a[168:171], v[92:95]
s_waitcnt lgkmcnt(15)
ds_read_b64_tr_b16 a[88:89], v19 offset:0
ds_read_b64_tr_b16 a[90:91], v19 offset:2048
M v[96:99], a[96:99], a[176:179], v[96:99]
M v[96:99], a[100:103], a[180:183], v[96:99]
M v[100:103], a[108:111], a[180:183], v[100:103]
M v[100:103], a[104:107], a[176:179], v[100:103]
M v[104:107], a[112:115], a[176:179], v[104:107]
M v[104:107], a[116:119], a[180:183], v[104:107]
M v[108:111], a[124:127], a[180:183], v[108:111]
M v[108:111], a[120:123], a[176:179], v[108:111]
s_waitcnt vmcnt(8) lgkmcnt(0)
s_barrier
ds_read_b128 a[160:163], v10 offset:49152
ds_read_b128 a[164:167], v11 offset:49152
M v[112:115], a[128:131], a[176:179], v[112:115]
s_add_u32 m0, s29, 16384
s_add_u32 s3, s23, s31
buffer_load_dwordx4 v2, s[8:11], s3 offen offset:0 lds
M v[112:115], a[132:135], a[180:183], v[112:115]
M v[116:119], a[140:143], a[180:183], v[116:119]
M v[116:119], a[136:139], a[176:179], v[116:119]
ds_read_b64_tr_b16 a[36:37], v12 offset:16384
ds_read_b64_tr_b16 a[38:39], v12 offset:18432
M v[120:123], a[144:147], a[176:179], v[120:123]
M v[120:123], a[148:151], a[180:183], v[120:123]
buffer_load_dwordx4 v3, s[8:11], s3 offen offset:1024 lds
M v[124:127], a[156:159], a[180:183], v[124:127]
M v[124:127], a[152:155], a[176:179], v[124:127]
M v[128:131], a[96:99], a[184:187], v[128:131]
M v[128:131], a[100:103], a[188:191], v[128:131]
ds_read_b128 a[168:171], v10 offset:51200
ds_read_b128 a[172:175], v11 offset:51200
ds_read_b64_tr_b16 a[44:45], v13 offset:16384
ds_read_b64_tr_b16 a[46:47], v13 offset:18432
M v[132:135], a[108:111], a[188:191], v[132:135]
M v[132:135], a[104:107], a[184:187], v[132:135]
M v[136:139], a[112:115], a[184:187], v[136:139]
buffer_load_dwordx4 v4, s[8:11], s3 offen offset:2048 lds
M v[136:139], a[116:119], a[188:191], v[136:139]
M v[140:143], a[124:127], a[188:191], v[140:143]
M v[140:143], a[120:123], a[184:187], v[140:143]
ds_read_b64_tr_b16 a[52:53], v14 offset:16384
ds_read_b64_tr_b16 a[54:55], v14 offset:18432
M v[144:147], a[128:131], a[184:187], v[144:147]
M v[144:147], a[132:135], a[188:191], v[144:147]
M v[148:151], a[140:143], a[188:191], v[148:151]
buffer_load_dwordx4 v5, s[8:11], s3 offen offset:3072 lds
M v[148:151], a[136:139], a[184:187], v[148:151]
M v[152:155], a[144:147], a[184:187], v[152:155]
M v[152:155], a[148:151], a[188:191], v[152:155]
ds_read_b64_tr_b16 a[60:61], v15 offset:16384
ds_read_b64_tr_b16 a[62:63], v15 offset:18432
M v[156:159], a[156:159], a[188:191], v[156:159]
M v[156:159], a[152:155], a[184:187], v[156:159]
s_waitcnt lgkmcnt(10)
M v[160:163], a[96:99], a[160:163], v[160:163]
M v[160:163], a[100:103], a[164:167], v[160:163]
ds_read_b128 a[176:179], v10 offset:53248
ds_read_b128 a[180:183], v11 offset:53248
M v[164:167], a[108:111], a[164:167], v[164:167]
s_add_u32 s23, s23, 128
s_cmp_eq_u32 s23, s25
s_cselect_b32 s23, s26, s23
M v[164:167], a[104:107], a[160:163], v[164:167]
ds_read_b64_tr_b16 a[68:69], v16 offset:16384
ds_read_b64_tr_b16 a[70:71], v16 offset:18432
M v[168:171], a[112:115], a[160:163], v[168:171]
M v[168:171], a[116:119], a[164:167], v[168:171]
M v[172:175], a[124:127], a[164:167], v[172:175]
M v[172:175], a[120:123], a[160:163], v[172:175]
M v[176:179], a[128:131], a[160:163], v[176:179]
s_add_u32 m0, s29, 114688
s_nop 0
buffer_load_dwordx4 v6, s[12:15], s24 offen offset:0 lds
M v[176:179], a[132:135], a[164:167], v[176:179]
ds_read_b64_tr_b16 a[76:77], v17 offset:16384
ds_read_b64_tr_b16 a[78:79], v17 offset:18432
M v[180:183], a[140:143], a[164:167], v[180:183]
M v[180:183], a[136:139], a[160:163], v[180:183]
M v[184:187], a[144:147], a[160:163], v[184:187]
M v[184:187], a[148:151], a[164:167], v[184:187]
buffer_load_dwordx4 v7, s[12:15], s24 offen offset:1024 lds
M v[188:191], a[156:159], a[164:167], v[188:191]
M v[188:191], a[152:155], a[160:163], v[188:191]
s_waitcnt lgkmcnt(12)
ds_read_b64_tr_b16 a[84:85], v18 offset:16384
ds_read_b64_tr_b16 a[86:87], v18 offset:18432
M v[192:195], a[96:99], a[168:171], v[192:195]
M v[192:195], a[100:103], a[172:175], v[192:195]
ds_read_b128 a[184:187], v10 offset:55296
ds_read_b128 a[188:191], v11 offset:55296
M v[196:199], a[108:111], a[172:175], v[196:199]
M v[196:199], a[104:107], a[168:171], v[196:199]
M v[200:203], a[112:115], a[168:171], v[200:203]
buffer_load_dwordx4 v8, s[12:15], s24 offen offset:2048 lds
M v[200:203], a[116:119], a[172:175], v[200:203]
ds_read_b64_tr_b16 a[92:93], v19 offset:16384
ds_read_b64_tr_b16 a[94:95], v19 offset:18432
M v[204:207], a[124:127], a[172:175], v[204:207]
M v[204:207], a[120:123], a[168:171], v[204:207]
M v[208:211], a[128:131], a[168:171], v[208:211]
M v[208:211], a[132:135], a[172:175], v[208:211]
M v[212:215], a[140:143], a[172:175], v[212:215]
buffer_load_dwordx4 v9, s[12:15], s24 offen offset:3072 lds
M v[212:215], a[136:139], a[168:171], v[212:215]
M v[216:219], a[144:147], a[168:171], v[216:219]
M v[216:219], a[148:151], a[172:175], v[216:219]
M v[220:223], a[156:159], a[172:175], v[220:223]
M v[220:223], a[152:155], a[168:171], v[220:223]
s_waitcnt lgkmcnt(10)
M v[224:227], a[96:99], a[176:179], v[224:227]
s_add_u32 s24, s24, 262144
s_cmp_eq_u32 s24, s27
s_cselect_b32 s24, s28, s24
s_sub_u32 s6, s6, 1
s_cmp_eq_u32 s6, 0
s_cselect_b64 s[12:13], s[64:65], s[12:13]
M v[224:227], a[100:103], a[180:183], v[224:227]
M v[228:231], a[108:111], a[180:183], v[228:231]
M v[228:231], a[104:107], a[176:179], v[228:231]
M v[232:235], a[112:115], a[176:179], v[232:235]
M v[232:235], a[116:119], a[180:183], v[232:235]
M v[236:239], a[124:127], a[180:183], v[236:239]
M v[236:239], a[120:123], a[176:179], v[236:239]
s_waitcnt vmcnt(8) lgkmcnt(0)
s_barrier
ds_read_b128 a[160:163], v10 offset:0
ds_read_b128 a[164:167], v11 offset:0
M v[240:243], a[128:131], a[176:179], v[240:243]
s_add_u32 m0, s29, 32768
s_nop 0
buffer_load_dwordx4 v2, s[8:11], s23 offen offset:0 lds
M v[240:243], a[132:135], a[180:183], v[240:243]
M v[244:247], a[140:143], a[180:183], v[244:247]
M v[244:247], a[136:139], a[176:179], v[244:247]
M v[248:251], a[144:147], a[176:179], v[248:251]
M v[248:251], a[148:151], a[180:183], v[248:251]
M v[252:255], a[156:159], a[180:183], v[252:255]
M v[252:255], a[152:155], a[176:179], v[252:255]
M a[0:3], a[96:99], a[184:187], a[0:3]
M a[0:3], a[100:103], a[188:191], a[0:3]
ds_read_b128 a[168:171], v10 offset:2048
ds_read_b128 a[172:175], v11 offset:2048
M a[4:7], a[108:111], a[188:191], a[4:7]
M a[4:7], a[104:107], a[184:187], a[4:7]
M a[8:11], a[112:115], a[184:187], a[8:11]
buffer_load_dwordx4 v3, s[8:11], s23 offen offset:1024 lds
M a[8:11], a[116:119], a[188:191], a[8:11]
M a[12:15], a[124:127], a[188:191], a[12:15]
M a[12:15], a[120:123], a[184:187], a[12:15]
M a[16:19], a[128:131], a[184:187], a[16:19]
M a[16:19], a[132:135], a[188:191], a[16:19]
M a[20:23], a[140:143], a[188:191], a[20:23]
M a[20:23], a[136:139], a[184:187], a[20:23]
M a[24:27], a[144:147], a[184:187], a[24:27]
M a[24:27], a[148:151], a[188:191], a[24:27]
M a[28:31], a[156:159], a[188:191], a[28:31]
M a[28:31], a[152:155], a[184:187], a[28:31]
s_waitcnt lgkmcnt(2)
M v[32:35], a[32:35], a[160:163], v[32:35]
buffer_load_dwordx4 v4, s[8:11], s23 offen offset:2048 lds
M v[32:35], a[36:39], a[164:167], v[32:35]
ds_read_b128 a[176:179], v10 offset:4096
ds_read_b128 a[180:183], v11 offset:4096
M v[36:39], a[44:47], a[164:167], v[36:39]
M v[36:39], a[40:43], a[160:163], v[36:39]
ds_read_b64_tr_b16 a[96:97], v12 offset:32768
ds_read_b64_tr_b16 a[98:99], v12 offset:34816
M v[40:43], a[48:51], a[160:163], v[40:43]
M v[40:43], a[52:55], a[164:167], v[40:43]
M v[44:47], a[60:63], a[164:167], v[44:47]
M v[44:47], a[56:59], a[160:163], v[44:47]
ds_read_b64_tr_b16 a[104:105], v13 offset:32768
ds_read_b64_tr_b16 a[106:107], v13 offset:34816
M v[48:51], a[64:67], a[160:163], v[48:51]
M v[48:51], a[68:71], a[164:167], v[48:51]
M v[52:55], a[76:79], a[164:167], v[52:55]
M v[52:55], a[72:75], a[160:163], v[52:55]
ds_read_b64_tr_b16 a[112:113], v14 offset:32768
ds_read_b64_tr_b16 a[114:115], v14 offset:34816
M v[56:59], a[80:83], a[160:163], v[56:59]
M v[56:59], a[84:87], a[164:167], v[56:59]
M v[60:63], a[92:95], a[164:167], v[60:63]
M v[60:63], a[88:91], a[160:163], v[60:63]
s_waitcnt lgkmcnt(8)
ds_read_b64_tr_b16 a[120:121], v15 offset:32768
ds_read_b64_tr_b16 a[122:123], v15 offset:34816
M v[64:67], a[32:35], a[168:171], v[64:67]
M v[64:67], a[36:39], a[172:175], v[64:67]
ds_read_b128 a[184:187], v10 offset:6144
ds_read_b128 a[188:191], v11 offset:6144
M v[68:71], a[44:47], a[172:175], v[68:71]
M v[68:71], a[40:43], a[168:171], v[68:71]
ds_read_b64_tr_b16 a[128:129], v16 offset:32768
ds_read_b64_tr_b16 a[130:131], v16 offset:34816
M v[72:75], a[48:51], a[168:171], v[72:75]
buffer_load_dwordx4 v5, s[8:11], s23 offen offset:3072 lds
M v[72:75], a[52:55], a[172:175], v[72:75]
M v[76:79], a[60:63], a[172:175], v[76:79]
M v[76:79], a[56:59], a[168:171], v[76:79]
ds_read_b64_tr_b16 a[136:137], v17 offset:32768
ds_read_b64_tr_b16 a[138:139], v17 offset:34816
M v[80:83], a[64:67], a[168:171], v[80:83]
M v[80:83], a[68:71], a[172:175], v[80:83]
M v[84:87], a[76:79], a[172:175], v[84:87]
M v[84:87], a[72:75], a[168:171], v[84:87]
ds_read_b64_tr_b16 a[144:145], v18 offset:32768
ds_read_b64_tr_b16 a[146:147], v18 offset:34816
M v[88:91], a[80:83], a[168:171], v[88:91]
M v[88:91], a[84:87], a[172:175], v[88:91]
M v[92:95], a[92:95], a[172:175], v[92:95]
M v[92:95], a[88:91], a[168:171], v[92:95]
s_waitcnt lgkmcnt(15)
ds_read_b64_tr_b16 a[152:153], v19 offset:32768
ds_read_b64_tr_b16 a[154:155], v19 offset:34816
M v[96:99], a[32:35], a[176:179], v[96:99]
M v[96:99], a[36:39], a[180:183], v[96:99]
M v[100:103], a[44:47], a[180:183], v[100:103]
M v[100:103], a[40:43], a[176:179], v[100:103]
M v[104:107], a[48:51], a[176:179], v[104:107]
M v[104:107], a[52:55], a[180:183], v[104:107]
M v[108:111], a[60:63], a[180:183], v[108:111]
M v[108:111], a[56:59], a[176:179], v[108:111]
s_waitcnt vmcnt(4) lgkmcnt(0)
s_barrier
ds_read_b128 a[160:163], v10 offset:16384
ds_read_b128 a[164:167], v11 offset:16384
M v[112:115], a[64:67], a[176:179], v[112:115]
s_add_u32 m0, s29, 49152
s_add_u32 s3, s23, s31
buffer_load_dwordx4 v2, s[8:11], s3 offen offset:0 lds
M v[112:115], a[68:71], a[180:183], v[112:115]
M v[116:119], a[76:79], a[180:183], v[116:119]
buffer_load_dwordx4 v3, s[8:11], s3 offen offset:1024 lds
M v[116:119], a[72:75], a[176:179], v[116:119]
ds_read_b64_tr_b16 a[100:101], v12 offset:49152
ds_read_b64_tr_b16 a[102:103], v12 offset:51200
M v[120:123], a[80:83], a[176:179], v[120:123]
buffer_load_dwordx4 v4, s[8:11], s3 offen offset:2048 lds
M v[120:123], a[84:87], a[180:183], v[120:123]
M v[124:127], a[92:95], a[180:183], v[124:127]
buffer_load_dwordx4 v5, s[8:11], s3 offen offset:3072 lds
M v[124:127], a[88:91], a[176:179], v[124:127]
M v[128:131], a[32:35], a[184:187], v[128:131]
M v[128:131], a[36:39], a[188:191], v[128:131]
ds_read_b128 a[168:171], v10 offset:18432
ds_read_b128 a[172:175], v11 offset:18432
ds_read_b64_tr_b16 a[108:109], v13 offset:49152
ds_read_b64_tr_b16 a[110:111], v13 offset:51200
M v[132:135], a[44:47], a[188:191], v[132:135]
M v[132:135], a[40:43], a[184:187], v[132:135]
M v[136:139], a[48:51], a[184:187], v[136:139]
s_and_b32 s3, s2, 1
s_lshl_b32 s3, s3, 3
s_bfe_u32 s4, s2, 0x30003
s_add_u32 s26, s3, s4
M v[136:139], a[52:55], a[188:191], v[136:139]
s_bfe_u32 s3, s2, 0x20001
s_lshl_b32 s3, s3, 2
s_lshr_b32 s4, s2, 6
M v[140:143], a[60:63], a[188:191], v[140:143]
s_xor_b32 s4, s4, 3
s_add_u32 s27, s3, s4
s_lshl_b32 s23, s26, 18
M v[140:143], a[56:59], a[184:187], v[140:143]
ds_read_b64_tr_b16 a[116:117], v14 offset:49152
ds_read_b64_tr_b16 a[118:119], v14 offset:51200
s_sub_u32 s24, s23, 32768
s_max_i32 s24, s24, 0
s_lshl_b32 s25, s27, 7
M v[144:147], a[64:67], a[184:187], v[144:147]
s_mov_b64 s[8:9], s[44:45]
s_mov_b32 s10, 4194304
s_mov_b64 s[12:13], s[46:47]
M v[144:147], a[68:71], a[188:191], v[144:147]
s_mov_b32 s14, 6291456
s_mov_b64 s[36:37], s[90:91]
s_mov_b32 s38, 256
M v[148:151], a[76:79], a[188:191], v[148:151]
s_mov_b32 s39, 0x00020000
s_lshl_b32 s28, s20, 9
s_mul_i32 s30, s20, 6144
M v[148:151], a[72:75], a[184:187], v[148:151]
s_lshl_b32 s3, s20, 5
v_lshrrev_b32 v24, 3, v0
v_and_b32 v25, 7, v0
M v[152:155], a[80:83], a[184:187], v[152:155]
v_add_u32 v28, s3, v24
v_add_u32 v26, 0, v28
v_bfe_u32 v27, v26, 1, 3
M v[152:155], a[84:87], a[188:191], v[152:155]
ds_read_b64_tr_b16 a[124:125], v15 offset:49152
ds_read_b64_tr_b16 a[126:127], v15 offset:51200
v_xor_b32 v27, v27, v25
v_lshlrev_b32 v26, 11, v26
v_lshl_add_u32 v26, v27, 4, v26
M v[156:159], a[92:95], a[188:191], v[156:159]
v_subrev_u32 v2, 0, v26
v_add_u32 v26, 8, v28
v_bfe_u32 v27, v26, 1, 3
M v[156:159], a[88:91], a[184:187], v[156:159]
s_waitcnt lgkmcnt(10)
v_xor_b32 v27, v27, v25
v_lshlrev_b32 v26, 11, v26
v_lshl_add_u32 v26, v27, 4, v26
M v[160:163], a[32:35], a[160:163], v[160:163]
v_subrev_u32 v3, 1024, v26
v_add_u32 v26, 16, v28
v_bfe_u32 v27, v26, 1, 3
M v[160:163], a[36:39], a[164:167], v[160:163]
ds_read_b128 a[176:179], v10 offset:20480
ds_read_b128 a[180:183], v11 offset:20480
v_xor_b32 v27, v27, v25
v_lshlrev_b32 v26, 11, v26
v_lshl_add_u32 v26, v27, 4, v26
M v[164:167], a[44:47], a[164:167], v[164:167]
v_subrev_u32 v4, 2048, v26
v_add_u32 v26, 24, v28
v_bfe_u32 v27, v26, 1, 3
M v[164:167], a[40:43], a[160:163], v[164:167]
ds_read_b64_tr_b16 a[132:133], v16 offset:49152
ds_read_b64_tr_b16 a[134:135], v16 offset:51200
v_xor_b32 v27, v27, v25
v_lshlrev_b32 v26, 11, v26
v_lshl_add_u32 v26, v27, 4, v26
M v[168:171], a[48:51], a[160:163], v[168:171]
v_subrev_u32 v5, 3072, v26
s_lshl_b32 s3, s20, 2
v_lshrrev_b32 v26, 5, v0
M v[168:171], a[52:55], a[164:167], v[168:171]
v_add_u32 v26, s3, v26
v_bfe_u32 v29, v0, 2, 3
v_bfe_u32 v27, v26, 1, 3
M v[172:175], a[60:63], a[164:167], v[172:175]
v_xor_b32 v27, v27, v29
v_lshlrev_b32 v27, 4, v27
v_and_b32 v30, 3, v0
M v[172:175], a[56:59], a[160:163], v[172:175]
v_lshl_add_u32 v27, v30, 2, v27
v_lshl_add_u32 v20, v26, 11, v27
v_add_u32 v26, 2, v26
M v[176:179], a[64:67], a[160:163], v[176:179]
v_bfe_u32 v27, v26, 1, 3
v_xor_b32 v27, v27, v29
v_lshlrev_b32 v27, 4, v27
M v[176:179], a[68:71], a[164:167], v[176:179]
ds_read_b64_tr_b16 a[140:141], v17 offset:49152
ds_read_b64_tr_b16 a[142:143], v17 offset:51200
v_and_b32 v30, 3, v0
v_lshl_add_u32 v27, v30, 2, v27
v_lshl_add_u32 v23, v26, 11, v27
M v[180:183], a[76:79], a[164:167], v[180:183]
v_subrev_u32 v23, 256, v23
s_mul_i32 s3, s20, 48
v_add_u32 v28, s3, v24
M v[180:183], a[72:75], a[160:163], v[180:183]
v_add_u32 v26, 0, v28
v_mul_u32_u24 v27, 0xaaab, v26
v_lshrrev_b32 v27, 17, v27
M v[184:187], a[80:83], a[160:163], v[184:187]
v_lshrrev_b32 v29, 1, v27
v_and_b32 v29, 4, v29
v_and_or_b32 v27, v27, 2, v29
M v[184:187], a[84:87], a[164:167], v[184:187]
v_xor_b32 v27, v27, v25
v_lshlrev_b32 v26, 11, v26
v_lshl_add_u32 v26, v27, 4, v26
M v[188:191], a[92:95], a[164:167], v[188:191]
v_subrev_u32 v6, 0, v26
v_add_u32 v26, 8, v28
v_mul_u32_u24 v27, 0xaaab, v26
M v[188:191], a[88:91], a[160:163], v[188:191]
s_waitcnt lgkmcnt(12)
ds_read_b64_tr_b16 a[148:149], v18 offset:49152
ds_read_b64_tr_b16 a[150:151], v18 offset:51200
v_lshrrev_b32 v27, 17, v27
v_lshrrev_b32 v29, 1, v27
v_and_b32 v29, 4, v29
M v[192:195], a[32:35], a[168:171], v[192:195]
v_and_or_b32 v27, v27, 2, v29
v_xor_b32 v27, v27, v25
v_lshlrev_b32 v26, 11, v26
M v[192:195], a[36:39], a[172:175], v[192:195]
ds_read_b128 a[184:187], v10 offset:22528
ds_read_b128 a[188:191], v11 offset:22528
v_lshl_add_u32 v26, v27, 4, v26
v_subrev_u32 v7, 1024, v26
v_add_u32 v26, 16, v28
M v[196:199], a[44:47], a[172:175], v[196:199]
v_mul_u32_u24 v27, 0xaaab, v26
v_lshrrev_b32 v27, 17, v27
v_lshrrev_b32 v29, 1, v27
M v[196:199], a[40:43], a[168:171], v[196:199]
v_and_b32 v29, 4, v29
v_and_or_b32 v27, v27, 2, v29
v_xor_b32 v27, v27, v25
M v[200:203], a[48:51], a[168:171], v[200:203]
v_lshlrev_b32 v26, 11, v26
v_lshl_add_u32 v26, v27, 4, v26
v_subrev_u32 v8, 2048, v26
M v[200:203], a[52:55], a[172:175], v[200:203]
ds_read_b64_tr_b16 a[156:157], v19 offset:49152
ds_read_b64_tr_b16 a[158:159], v19 offset:51200
v_add_u32 v26, 24, v28
v_mul_u32_u24 v27, 0xaaab, v26
v_lshrrev_b32 v27, 17, v27
M v[204:207], a[60:63], a[172:175], v[204:207]
v_lshrrev_b32 v29, 1, v27
v_and_b32 v29, 4, v29
v_and_or_b32 v27, v27, 2, v29
M v[204:207], a[56:59], a[168:171], v[204:207]
v_xor_b32 v27, v27, v25
v_lshlrev_b32 v26, 11, v26
v_lshl_add_u32 v26, v27, 4, v26
M v[208:211], a[64:67], a[168:171], v[208:211]
v_subrev_u32 v9, 3072, v26
v_add_u32 v26, 32, v28
v_mul_u32_u24 v27, 0xaaab, v26
M v[208:211], a[68:71], a[172:175], v[208:211]
v_lshrrev_b32 v27, 17, v27
v_lshrrev_b32 v29, 1, v27
v_and_b32 v29, 4, v29
M v[212:215], a[76:79], a[172:175], v[212:215]
v_and_or_b32 v27, v27, 2, v29
v_xor_b32 v27, v27, v25
v_lshlrev_b32 v26, 11, v26
M v[212:215], a[72:75], a[168:171], v[212:215]
v_lshl_add_u32 v26, v27, 4, v26
v_subrev_u32 v21, 0, v26
v_add_u32 v26, 40, v28
M v[216:219], a[80:83], a[168:171], v[216:219]
v_mul_u32_u24 v27, 0xaaab, v26
v_lshrrev_b32 v27, 17, v27
v_lshrrev_b32 v29, 1, v27
M v[216:219], a[84:87], a[172:175], v[216:219]
v_and_b32 v29, 4, v29
v_and_or_b32 v27, v27, 2, v29
v_xor_b32 v27, v27, v25
M v[220:223], a[92:95], a[172:175], v[220:223]
v_lshlrev_b32 v26, 11, v26
v_lshl_add_u32 v26, v27, 4, v26
v_subrev_u32 v22, 1024, v26
M v[220:223], a[88:91], a[168:171], v[220:223]
s_waitcnt lgkmcnt(10)
s_lshr_b32 s3, s53, 7
s_add_u32 s3, s3, s22
s_lshl_b32 s3, s3, 5
M v[224:227], a[32:35], a[176:179], v[224:227]
s_lshr_b32 s19, s52, 6
s_add_u32 s3, s3, s19
s_lshl_b32 s19, s21, 1
M v[224:227], a[36:39], a[180:183], v[224:227]
s_add_u32 s3, s3, s19
s_lshl_b32 s92, s3, 14
s_add_u32 s93, s92, 16384
M v[228:231], a[44:47], a[180:183], v[228:231]
s_add_u32 s16, s50, 0
s_addc_u32 s17, s51, 0
s_mov_b32 s18, 16777216
M v[228:231], a[40:43], a[176:179], v[228:231]
s_mov_b32 s19, 0x00020000
s_mov_b32 s4, 0x3e0293ee
s_mov_b32 s5, 0x3e0293ee
M v[232:235], a[48:51], a[176:179], v[232:235]
M v[232:235], a[52:55], a[180:183], v[232:235]
M v[236:239], a[60:63], a[180:183], v[236:239]
M v[236:239], a[56:59], a[176:179], v[236:239]
s_waitcnt vmcnt(4) lgkmcnt(0)
s_barrier
ds_read_b128 a[160:163], v10 offset:32768
ds_read_b128 a[164:167], v11 offset:32768
M v[240:243], a[64:67], a[176:179], v[240:243]
s_add_u32 m0, s28, 131072
s_nop 0
buffer_load_dword v20, s[8:11], s24 offen lds
M v[240:243], a[68:71], a[180:183], v[240:243]
M v[244:247], a[76:79], a[180:183], v[244:247]
M v[244:247], a[72:75], a[176:179], v[244:247]
M v[248:251], a[80:83], a[176:179], v[248:251]
buffer_load_dword v23, s[8:11], s24 offen offset:256 lds
s_add_u32 s24, s24, 128
M v[248:251], a[84:87], a[180:183], v[248:251]
M v[252:255], a[92:95], a[180:183], v[252:255]
M v[252:255], a[88:91], a[176:179], v[252:255]
M a[0:3], a[32:35], a[184:187], a[0:3]
M a[0:3], a[36:39], a[188:191], a[0:3]
ds_read_b128 a[168:171], v10 offset:34816
ds_read_b128 a[172:175], v11 offset:34816
M a[4:7], a[44:47], a[188:191], a[4:7]
s_add_u32 m0, s29, 133120
s_nop 0
buffer_load_dwordx4 v2, s[8:11], s23 offen offset:0 lds
M a[4:7], a[40:43], a[184:187], a[4:7]
M a[8:11], a[48:51], a[184:187], a[8:11]
M a[8:11], a[52:55], a[188:191], a[8:11]
M a[12:15], a[60:63], a[188:191], a[12:15]
buffer_load_dwordx4 v3, s[8:11], s23 offen offset:1024 lds
M a[12:15], a[56:59], a[184:187], a[12:15]
M a[16:19], a[64:67], a[184:187], a[16:19]
M a[16:19], a[68:71], a[188:191], a[16:19]
M a[20:23], a[76:79], a[188:191], a[20:23]
buffer_load_dwordx4 v4, s[8:11], s23 offen offset:2048 lds
M a[20:23], a[72:75], a[184:187], a[20:23]
M a[24:27], a[80:83], a[184:187], a[24:27]
M a[24:27], a[84:87], a[188:191], a[24:27]
M a[28:31], a[92:95], a[188:191], a[28:31]
M a[28:31], a[88:91], a[184:187], a[28:31]
s_waitcnt lgkmcnt(2)
M v[32:35], a[96:99], a[160:163], v[32:35]
buffer_load_dwordx4 v5, s[8:11], s23 offen offset:3072 lds
s_add_u32 s23, s23, 128
M v[32:35], a[100:103], a[164:167], v[32:35]
ds_read_b128 a[176:179], v10 offset:36864
ds_read_b128 a[180:183], v11 offset:36864
M v[36:39], a[108:111], a[164:167], v[36:39]
M v[36:39], a[104:107], a[160:163], v[36:39]
M v[40:43], a[112:115], a[160:163], v[40:43]
M v[40:43], a[116:119], a[164:167], v[40:43]
s_add_u32 m0, s30, 65536
s_nop 0
buffer_load_dwordx4 v6, s[12:15], s25 offen offset:0 lds
M v[44:47], a[124:127], a[164:167], v[44:47]
M v[44:47], a[120:123], a[160:163], v[44:47]
M v[48:51], a[128:131], a[160:163], v[48:51]
M v[48:51], a[132:135], a[164:167], v[48:51]
M v[52:55], a[140:143], a[164:167], v[52:55]
buffer_load_dwordx4 v7, s[12:15], s25 offen offset:1024 lds
M v[52:55], a[136:139], a[160:163], v[52:55]
M v[56:59], a[144:147], a[160:163], v[56:59]
M v[56:59], a[148:151], a[164:167], v[56:59]
M v[60:63], a[156:159], a[164:167], v[60:63]
buffer_load_dwordx4 v8, s[12:15], s25 offen offset:2048 lds
M v[60:63], a[152:155], a[160:163], v[60:63]
s_waitcnt lgkmcnt(2)
M v[64:67], a[96:99], a[168:171], v[64:67]
M v[64:67], a[100:103], a[172:175], v[64:67]
ds_read_b128 a[184:187], v10 offset:38912
ds_read_b128 a[188:191], v11 offset:38912
M v[68:71], a[108:111], a[172:175], v[68:71]
M v[68:71], a[104:107], a[168:171], v[68:71]
v_pk_mul_f32 v[32:33], v[32:33], s[4:5]
v_pk_mul_f32 v[34:35], v[34:35], s[4:5]
v_pk_mul_f32 v[36:37], v[36:37], s[4:5]
M v[72:75], a[112:115], a[168:171], v[72:75]
v_pk_mul_f32 v[38:39], v[38:39], s[4:5]
v_cvt_pk_bf16_f32 v32, v32, v33
M v[72:75], a[116:119], a[172:175], v[72:75]
buffer_load_dwordx4 v9, s[12:15], s25 offen offset:3072 lds
v_cvt_pk_bf16_f32 v33, v34, v35
v_cvt_pk_bf16_f32 v34, v36, v37
M v[76:79], a[124:127], a[172:175], v[76:79]
v_cvt_pk_bf16_f32 v35, v38, v39
v_pk_mul_f32 v[40:41], v[40:41], s[4:5]
v_pk_mul_f32 v[42:43], v[42:43], s[4:5]
M v[76:79], a[120:123], a[168:171], v[76:79]
v_pk_mul_f32 v[44:45], v[44:45], s[4:5]
v_pk_mul_f32 v[46:47], v[46:47], s[4:5]
M v[80:83], a[128:131], a[168:171], v[80:83]
v_cvt_pk_bf16_f32 v40, v40, v41
v_cvt_pk_bf16_f32 v41, v42, v43
M v[80:83], a[132:135], a[172:175], v[80:83]
s_add_u32 m0, s30, 69632
s_nop 0
buffer_load_dwordx4 v21, s[12:15], s25 offen offset:0 lds
v_cvt_pk_bf16_f32 v42, v44, v45
v_cvt_pk_bf16_f32 v43, v46, v47
M v[84:87], a[140:143], a[172:175], v[84:87]
v_pk_mul_f32 v[48:49], v[48:49], s[4:5]
v_pk_mul_f32 v[50:51], v[50:51], s[4:5]
v_pk_mul_f32 v[52:53], v[52:53], s[4:5]
M v[84:87], a[136:139], a[168:171], v[84:87]
v_pk_mul_f32 v[54:55], v[54:55], s[4:5]
v_cvt_pk_bf16_f32 v48, v48, v49
M v[88:91], a[144:147], a[168:171], v[88:91]
v_cvt_pk_bf16_f32 v49, v50, v51
v_cvt_pk_bf16_f32 v50, v52, v53
M v[88:91], a[148:151], a[172:175], v[88:91]
v_cvt_pk_bf16_f32 v51, v54, v55
v_pk_mul_f32 v[56:57], v[56:57], s[4:5]
v_pk_mul_f32 v[58:59], v[58:59], s[4:5]
M v[92:95], a[156:159], a[172:175], v[92:95]
buffer_load_dwordx4 v22, s[12:15], s25 offen offset:1024 lds
s_add_u32 s25, s25, 393216
v_pk_mul_f32 v[60:61], v[60:61], s[4:5]
v_pk_mul_f32 v[62:63], v[62:63], s[4:5]
M v[92:95], a[152:155], a[168:171], v[92:95]
s_waitcnt lgkmcnt(2)
v_cvt_pk_bf16_f32 v56, v56, v57
v_cvt_pk_bf16_f32 v57, v58, v59
M v[96:99], a[96:99], a[176:179], v[96:99]
v_cvt_pk_bf16_f32 v58, v60, v61
v_cvt_pk_bf16_f32 v59, v62, v63
M v[96:99], a[100:103], a[180:183], v[96:99]
M v[100:103], a[108:111], a[180:183], v[100:103]
M v[100:103], a[104:107], a[176:179], v[100:103]
v_pk_mul_f32 v[64:65], v[64:65], s[4:5]
v_pk_mul_f32 v[66:67], v[66:67], s[4:5]
v_pk_mul_f32 v[68:69], v[68:69], s[4:5]
M v[104:107], a[112:115], a[176:179], v[104:107]
s_add_u32 s94, s92, 0
buffer_store_dwordx4 v[32:35], v1, s[16:19], s94 offen offset:0 sc1
v_pk_mul_f32 v[70:71], v[70:71], s[4:5]
v_cvt_pk_bf16_f32 v64, v64, v65
M v[104:107], a[116:119], a[180:183], v[104:107]
v_cvt_pk_bf16_f32 v65, v66, v67
v_cvt_pk_bf16_f32 v66, v68, v69
M v[108:111], a[124:127], a[180:183], v[108:111]
v_cvt_pk_bf16_f32 v67, v70, v71
v_pk_mul_f32 v[72:73], v[72:73], s[4:5]
v_pk_mul_f32 v[74:75], v[74:75], s[4:5]
M v[108:111], a[120:123], a[176:179], v[108:111]
s_waitcnt vmcnt(13) lgkmcnt(0)
s_barrier
ds_read_b128 a[160:163], v10 offset:49152
ds_read_b128 a[164:167], v11 offset:49152
v_pk_mul_f32 v[76:77], v[76:77], s[4:5]
v_pk_mul_f32 v[78:79], v[78:79], s[4:5]
M v[112:115], a[128:131], a[176:179], v[112:115]
s_add_u32 m0, s28, 0
s_nop 0
buffer_load_dword v20, s[8:11], s24 offen lds
v_cvt_pk_bf16_f32 v72, v72, v73
v_cvt_pk_bf16_f32 v73, v74, v75
M v[112:115], a[132:135], a[180:183], v[112:115]
v_cvt_pk_bf16_f32 v74, v76, v77
v_cvt_pk_bf16_f32 v75, v78, v79
M v[116:119], a[140:143], a[180:183], v[116:119]
s_add_u32 s94, s92, 0
buffer_store_dwordx4 v[40:43], v1, s[16:19], s94 offen offset:1024 sc1
v_pk_mul_f32 v[80:81], v[80:81], s[4:5]
v_pk_mul_f32 v[82:83], v[82:83], s[4:5]
v_pk_mul_f32 v[84:85], v[84:85], s[4:5]
M v[116:119], a[136:139], a[176:179], v[116:119]
v_pk_mul_f32 v[86:87], v[86:87], s[4:5]
v_cvt_pk_bf16_f32 v80, v80, v81
M v[120:123], a[144:147], a[176:179], v[120:123]
buffer_load_dword v23, s[8:11], s24 offen offset:256 lds
s_add_u32 s24, s24, 128
v_cvt_pk_bf16_f32 v81, v82, v83
v_cvt_pk_bf16_f32 v82, v84, v85
M v[120:123], a[148:151], a[180:183], v[120:123]
v_cvt_pk_bf16_f32 v83, v86, v87
v_pk_mul_f32 v[88:89], v[88:89], s[4:5]
v_pk_mul_f32 v[90:91], v[90:91], s[4:5]
M v[124:127], a[156:159], a[180:183], v[124:127]
v_pk_mul_f32 v[92:93], v[92:93], s[4:5]
v_pk_mul_f32 v[94:95], v[94:95], s[4:5]
M v[124:127], a[152:155], a[176:179], v[124:127]
v_cvt_pk_bf16_f32 v88, v88, v89
v_cvt_pk_bf16_f32 v89, v90, v91
M v[128:131], a[96:99], a[184:187], v[128:131]
v_cvt_pk_bf16_f32 v90, v92, v93
v_cvt_pk_bf16_f32 v91, v94, v95
M v[128:131], a[100:103], a[188:191], v[128:131]
ds_read_b128 a[168:171], v10 offset:51200
ds_read_b128 a[172:175], v11 offset:51200
M v[132:135], a[108:111], a[188:191], v[132:135]
s_add_u32 s94, s92, 0
buffer_store_dwordx4 v[48:51], v1, s[16:19], s94 offen offset:2048 sc1
M v[132:135], a[104:107], a[184:187], v[132:135]
s_add_u32 m0, s29, 2048
s_nop 0
buffer_load_dwordx4 v2, s[8:11], s23 offen offset:0 lds
v_pk_mul_f32 v[96:97], v[96:97], s[4:5]
v_pk_mul_f32 v[98:99], v[98:99], s[4:5]
v_pk_mul_f32 v[100:101], v[100:101], s[4:5]
M v[136:139], a[112:115], a[184:187], v[136:139]
v_pk_mul_f32 v[102:103], v[102:103], s[4:5]
v_cvt_pk_bf16_f32 v96, v96, v97
M v[136:139], a[116:119], a[188:191], v[136:139]
v_cvt_pk_bf16_f32 v97, v98, v99
v_cvt_pk_bf16_f32 v98, v100, v101
M v[140:143], a[124:127], a[188:191], v[140:143]
v_cvt_pk_bf16_f32 v99, v102, v103
v_pk_mul_f32 v[104:105], v[104:105], s[4:5]
v_pk_mul_f32 v[106:107], v[106:107], s[4:5]
M v[140:143], a[120:123], a[184:187], v[140:143]
buffer_load_dwordx4 v3, s[8:11], s23 offen offset:1024 lds
v_pk_mul_f32 v[108:109], v[108:109], s[4:5]
v_pk_mul_f32 v[110:111], v[110:111], s[4:5]
M v[144:147], a[128:131], a[184:187], v[144:147]
s_add_u32 s94, s92, 0
buffer_store_dwordx4 v[56:59], v1, s[16:19], s94 offen offset:3072 sc1
v_cvt_pk_bf16_f32 v104, v104, v105
v_cvt_pk_bf16_f32 v105, v106, v107
M v[144:147], a[132:135], a[188:191], v[144:147]
v_cvt_pk_bf16_f32 v106, v108, v109
v_cvt_pk_bf16_f32 v107, v110, v111
M v[148:151], a[140:143], a[188:191], v[148:151]
v_pk_mul_f32 v[112:113], v[112:113], s[4:5]
v_pk_mul_f32 v[114:115], v[114:115], s[4:5]
v_pk_mul_f32 v[116:117], v[116:117], s[4:5]
M v[148:151], a[136:139], a[184:187], v[148:151]
v_pk_mul_f32 v[118:119], v[118:119], s[4:5]
v_cvt_pk_bf16_f32 v112, v112, v113
M v[152:155], a[144:147], a[184:187], v[152:155]
buffer_load_dwordx4 v4, s[8:11], s23 offen offset:2048 lds
v_cvt_pk_bf16_f32 v113, v114, v115
v_cvt_pk_bf16_f32 v114, v116, v117
M v[152:155], a[148:151], a[188:191], v[152:155]
v_cvt_pk_bf16_f32 v115, v118, v119
v_pk_mul_f32 v[120:121], v[120:121], s[4:5]
v_pk_mul_f32 v[122:123], v[122:123], s[4:5]
M v[156:159], a[156:159], a[188:191], v[156:159]
v_pk_mul_f32 v[124:125], v[124:125], s[4:5]
v_pk_mul_f32 v[126:127], v[126:127], s[4:5]
M v[156:159], a[152:155], a[184:187], v[156:159]
s_add_u32 s94, s92, 4096
buffer_store_dwordx4 v[64:67], v1, s[16:19], s94 offen offset:0 sc1
s_waitcnt lgkmcnt(2)
v_cvt_pk_bf16_f32 v120, v120, v121
v_cvt_pk_bf16_f32 v121, v122, v123
M v[160:163], a[96:99], a[160:163], v[160:163]
v_cvt_pk_bf16_f32 v122, v124, v125
v_cvt_pk_bf16_f32 v123, v126, v127
M v[160:163], a[100:103], a[164:167], v[160:163]
ds_read_b128 a[176:179], v10 offset:53248
ds_read_b128 a[180:183], v11 offset:53248
M v[164:167], a[108:111], a[164:167], v[164:167]
buffer_load_dwordx4 v5, s[8:11], s23 offen offset:3072 lds
s_add_u32 s23, s23, 128
M v[164:167], a[104:107], a[160:163], v[164:167]
v_pk_mul_f32 v[128:129], v[128:129], s[4:5]
v_pk_mul_f32 v[130:131], v[130:131], s[4:5]
v_pk_mul_f32 v[132:133], v[132:133], s[4:5]
M v[168:171], a[112:115], a[160:163], v[168:171]
v_pk_mul_f32 v[134:135], v[134:135], s[4:5]
v_cvt_pk_bf16_f32 v128, v128, v129
M v[168:171], a[116:119], a[164:167], v[168:171]
s_add_u32 s94, s92, 4096
buffer_store_dwordx4 v[72:75], v1, s[16:19], s94 offen offset:1024 sc1
v_cvt_pk_bf16_f32 v129, v130, v131
v_cvt_pk_bf16_f32 v130, v132, v133
M v[172:175], a[124:127], a[164:167], v[172:175]
v_cvt_pk_bf16_f32 v131, v134, v135
v_pk_mul_f32 v[136:137], v[136:137], s[4:5]
v_pk_mul_f32 v[138:139], v[138:139], s[4:5]
M v[172:175], a[120:123], a[160:163], v[172:175]
s_add_u32 m0, s30, 98304
s_nop 0
buffer_load_dwordx4 v6, s[12:15], s25 offen offset:0 lds
v_pk_mul_f32 v[140:141], v[140:141], s[4:5]
v_pk_mul_f32 v[142:143], v[142:143], s[4:5]
M v[176:179], a[128:131], a[160:163], v[176:179]
v_cvt_pk_bf16_f32 v136, v136, v137
v_cvt_pk_bf16_f32 v137, v138, v139
M v[176:179], a[132:135], a[164:167], v[176:179]
v_cvt_pk_bf16_f32 v138, v140, v141
v_cvt_pk_bf16_f32 v139, v142, v143
M v[180:183], a[140:143], a[164:167], v[180:183]
buffer_load_dwordx4 v7, s[12:15], s25 offen offset:1024 lds
v_pk_mul_f32 v[144:145], v[144:145], s[4:5]
v_pk_mul_f32 v[146:147], v[146:147], s[4:5]
v_pk_mul_f32 v[148:149], v[148:149], s[4:5]
M v[180:183], a[136:139], a[160:163], v[180:183]
v_pk_mul_f32 v[150:151], v[150:151], s[4:5]
v_cvt_pk_bf16_f32 v144, v144, v145
M v[184:187], a[144:147], a[160:163], v[184:187]
s_add_u32 s94, s92, 4096
buffer_store_dwordx4 v[80:83], v1, s[16:19], s94 offen offset:2048 sc1
v_cvt_pk_bf16_f32 v145, v146, v147
v_cvt_pk_bf16_f32 v146, v148, v149
M v[184:187], a[148:151], a[164:167], v[184:187]
v_cvt_pk_bf16_f32 v147, v150, v151
v_pk_mul_f32 v[152:153], v[152:153], s[4:5]
v_pk_mul_f32 v[154:155], v[154:155], s[4:5]
M v[188:191], a[156:159], a[164:167], v[188:191]
v_pk_mul_f32 v[156:157], v[156:157], s[4:5]
v_pk_mul_f32 v[158:159], v[158:159], s[4:5]
M v[188:191], a[152:155], a[160:163], v[188:191]
s_waitcnt lgkmcnt(2)
v_cvt_pk_bf16_f32 v152, v152, v153
v_cvt_pk_bf16_f32 v153, v154, v155
M v[192:195], a[96:99], a[168:171], v[192:195]
buffer_load_dwordx4 v8, s[12:15], s25 offen offset:2048 lds
v_cvt_pk_bf16_f32 v154, v156, v157
v_cvt_pk_bf16_f32 v155, v158, v159
M v[192:195], a[100:103], a[172:175], v[192:195]
ds_read_b128 a[184:187], v10 offset:55296
ds_read_b128 a[188:191], v11 offset:55296
M v[196:199], a[108:111], a[172:175], v[196:199]
M v[196:199], a[104:107], a[168:171], v[196:199]
s_add_u32 s94, s92, 4096
buffer_store_dwordx4 v[88:91], v1, s[16:19], s94 offen offset:3072 sc1
v_pk_mul_f32 v[160:161], v[160:161], s[4:5]
v_pk_mul_f32 v[162:163], v[162:163], s[4:5]
v_pk_mul_f32 v[164:165], v[164:165], s[4:5]
M v[200:203], a[112:115], a[168:171], v[200:203]
v_pk_mul_f32 v[166:167], v[166:167], s[4:5]
v_cvt_pk_bf16_f32 v160, v160, v161
M v[200:203], a[116:119], a[172:175], v[200:203]
v_cvt_pk_bf16_f32 v161, v162, v163
v_cvt_pk_bf16_f32 v162, v164, v165
M v[204:207], a[124:127], a[172:175], v[204:207]
buffer_load_dwordx4 v9, s[12:15], s25 offen offset:3072 lds
v_cvt_pk_bf16_f32 v163, v166, v167
v_pk_mul_f32 v[168:169], v[168:169], s[4:5]
v_pk_mul_f32 v[170:171], v[170:171], s[4:5]
M v[204:207], a[120:123], a[168:171], v[204:207]
v_pk_mul_f32 v[172:173], v[172:173], s[4:5]
v_pk_mul_f32 v[174:175], v[174:175], s[4:5]
M v[208:211], a[128:131], a[168:171], v[208:211]
v_cvt_pk_bf16_f32 v168, v168, v169
v_cvt_pk_bf16_f32 v169, v170, v171
M v[208:211], a[132:135], a[172:175], v[208:211]
v_cvt_pk_bf16_f32 v170, v172, v173
v_cvt_pk_bf16_f32 v171, v174, v175
M v[212:215], a[140:143], a[172:175], v[212:215]
s_add_u32 s94, s92, 8192
buffer_store_dwordx4 v[96:99], v1, s[16:19], s94 offen offset:0 sc1
v_pk_mul_f32 v[176:177], v[176:177], s[4:5]
v_pk_mul_f32 v[178:179], v[178:179], s[4:5]
v_pk_mul_f32 v[180:181], v[180:181], s[4:5]
M v[212:215], a[136:139], a[168:171], v[212:215]
s_add_u32 m0, s30, 102400
s_nop 0
buffer_load_dwordx4 v21, s[12:15], s25 offen offset:0 lds
v_pk_mul_f32 v[182:183], v[182:183], s[4:5]
v_cvt_pk_bf16_f32 v176, v176, v177
M v[216:219], a[144:147], a[168:171], v[216:219]
v_cvt_pk_bf16_f32 v177, v178, v179
v_cvt_pk_bf16_f32 v178, v180, v181
M v[216:219], a[148:151], a[172:175], v[216:219]
v_cvt_pk_bf16_f32 v179, v182, v183
v_pk_mul_f32 v[184:185], v[184:185], s[4:5]
v_pk_mul_f32 v[186:187], v[186:187], s[4:5]
M v[220:223], a[156:159], a[172:175], v[220:223]
v_pk_mul_f32 v[188:189], v[188:189], s[4:5]
v_pk_mul_f32 v[190:191], v[190:191], s[4:5]
M v[220:223], a[152:155], a[168:171], v[220:223]
s_waitcnt lgkmcnt(2)
v_cvt_pk_bf16_f32 v184, v184, v185
v_cvt_pk_bf16_f32 v185, v186, v187
M v[224:227], a[96:99], a[176:179], v[224:227]
s_add_u32 s94, s92, 8192
buffer_store_dwordx4 v[104:107], v1, s[16:19], s94 offen offset:1024 sc1
v_cvt_pk_bf16_f32 v186, v188, v189
v_cvt_pk_bf16_f32 v187, v190, v191
M v[224:227], a[100:103], a[180:183], v[224:227]
buffer_load_dwordx4 v22, s[12:15], s25 offen offset:1024 lds
s_add_u32 s25, s25, 393216
M v[228:231], a[108:111], a[180:183], v[228:231]
M v[228:231], a[104:107], a[176:179], v[228:231]
v_pk_mul_f32 v[192:193], v[192:193], s[4:5]
v_pk_mul_f32 v[194:195], v[194:195], s[4:5]
v_pk_mul_f32 v[196:197], v[196:197], s[4:5]
M v[232:235], a[112:115], a[176:179], v[232:235]
v_pk_mul_f32 v[198:199], v[198:199], s[4:5]
v_cvt_pk_bf16_f32 v192, v192, v193
M v[232:235], a[116:119], a[180:183], v[232:235]
v_cvt_pk_bf16_f32 v193, v194, v195
v_cvt_pk_bf16_f32 v194, v196, v197
M v[236:239], a[124:127], a[180:183], v[236:239]
v_cvt_pk_bf16_f32 v195, v198, v199
v_pk_mul_f32 v[200:201], v[200:201], s[4:5]
v_pk_mul_f32 v[202:203], v[202:203], s[4:5]
M v[236:239], a[120:123], a[176:179], v[236:239]
s_waitcnt vmcnt(63) lgkmcnt(0)
s_barrier
v_pk_mul_f32 v[204:205], v[204:205], s[4:5]
v_pk_mul_f32 v[206:207], v[206:207], s[4:5]
M v[240:243], a[128:131], a[176:179], v[240:243]
s_add_u32 s94, s92, 8192
buffer_store_dwordx4 v[112:115], v1, s[16:19], s94 offen offset:2048 sc1
v_cvt_pk_bf16_f32 v200, v200, v201
v_cvt_pk_bf16_f32 v201, v202, v203
M v[240:243], a[132:135], a[180:183], v[240:243]
s_add_u32 m0, s28, 18432
s_nop 0
buffer_load_dword v20, s[8:11], s24 offen lds
v_cvt_pk_bf16_f32 v202, v204, v205
v_cvt_pk_bf16_f32 v203, v206, v207
M v[244:247], a[140:143], a[180:183], v[244:247]
v_pk_mul_f32 v[208:209], v[208:209], s[4:5]
v_pk_mul_f32 v[210:211], v[210:211], s[4:5]
v_pk_mul_f32 v[212:213], v[212:213], s[4:5]
M v[244:247], a[136:139], a[176:179], v[244:247]
v_pk_mul_f32 v[214:215], v[214:215], s[4:5]
v_cvt_pk_bf16_f32 v208, v208, v209
M v[248:251], a[144:147], a[176:179], v[248:251]
buffer_load_dword v23, s[8:11], s24 offen offset:256 lds
s_add_u32 s24, s24, 128
v_cvt_pk_bf16_f32 v209, v210, v211
v_cvt_pk_bf16_f32 v210, v212, v213
M v[248:251], a[148:151], a[180:183], v[248:251]
v_cvt_pk_bf16_f32 v211, v214, v215
v_pk_mul_f32 v[216:217], v[216:217], s[4:5]
v_pk_mul_f32 v[218:219], v[218:219], s[4:5]
M v[252:255], a[156:159], a[180:183], v[252:255]
s_add_u32 s94, s92, 8192
buffer_store_dwordx4 v[120:123], v1, s[16:19], s94 offen offset:3072 sc1
v_pk_mul_f32 v[220:221], v[220:221], s[4:5]
v_pk_mul_f32 v[222:223], v[222:223], s[4:5]
M v[252:255], a[152:155], a[176:179], v[252:255]
v_cvt_pk_bf16_f32 v216, v216, v217
v_cvt_pk_bf16_f32 v217, v218, v219
M a[0:3], a[96:99], a[184:187], a[0:3]
v_cvt_pk_bf16_f32 v218, v220, v221
v_cvt_pk_bf16_f32 v219, v222, v223
M a[0:3], a[100:103], a[188:191], a[0:3]
M a[4:7], a[108:111], a[188:191], a[4:7]
s_add_u32 m0, s29, 20480
s_nop 0
buffer_load_dwordx4 v2, s[8:11], s23 offen offset:0 lds
M a[4:7], a[104:107], a[184:187], a[4:7]
v_pk_mul_f32 v[224:225], v[224:225], s[4:5]
v_pk_mul_f32 v[226:227], v[226:227], s[4:5]
v_pk_mul_f32 v[228:229], v[228:229], s[4:5]
M a[8:11], a[112:115], a[184:187], a[8:11]
v_pk_mul_f32 v[230:231], v[230:231], s[4:5]
v_cvt_pk_bf16_f32 v224, v224, v225
M a[8:11], a[116:119], a[188:191], a[8:11]
s_add_u32 s94, s92, 12288
buffer_store_dwordx4 v[128:131], v1, s[16:19], s94 offen offset:0 sc1
v_cvt_pk_bf16_f32 v225, v226, v227
v_cvt_pk_bf16_f32 v226, v228, v229
M a[12:15], a[124:127], a[188:191], a[12:15]
buffer_load_dwordx4 v3, s[8:11], s23 offen offset:1024 lds
v_cvt_pk_bf16_f32 v227, v230, v231
v_pk_mul_f32 v[232:233], v[232:233], s[4:5]
v_pk_mul_f32 v[234:235], v[234:235], s[4:5]
M a[12:15], a[120:123], a[184:187], a[12:15]
v_pk_mul_f32 v[236:237], v[236:237], s[4:5]
v_pk_mul_f32 v[238:239], v[238:239], s[4:5]
M a[16:19], a[128:131], a[184:187], a[16:19]
v_cvt_pk_bf16_f32 v232, v232, v233
v_cvt_pk_bf16_f32 v233, v234, v235
M a[16:19], a[132:135], a[188:191], a[16:19]
v_cvt_pk_bf16_f32 v234, v236, v237
v_cvt_pk_bf16_f32 v235, v238, v239
M a[20:23], a[140:143], a[188:191], a[20:23]
buffer_load_dwordx4 v4, s[8:11], s23 offen offset:2048 lds
v_pk_mul_f32 v[240:241], v[240:241], s[4:5]
v_pk_mul_f32 v[242:243], v[242:243], s[4:5]
v_pk_mul_f32 v[244:245], v[244:245], s[4:5]
M a[20:23], a[136:139], a[184:187], a[20:23]
v_pk_mul_f32 v[246:247], v[246:247], s[4:5]
v_cvt_pk_bf16_f32 v240, v240, v241
M a[24:27], a[144:147], a[184:187], a[24:27]
s_add_u32 s94, s92, 12288
buffer_store_dwordx4 v[136:139], v1, s[16:19], s94 offen offset:1024 sc1
v_cvt_pk_bf16_f32 v241, v242, v243
v_cvt_pk_bf16_f32 v242, v244, v245
M a[24:27], a[148:151], a[188:191], a[24:27]
v_cvt_pk_bf16_f32 v243, v246, v247
v_pk_mul_f32 v[248:249], v[248:249], s[4:5]
v_pk_mul_f32 v[250:251], v[250:251], s[4:5]
M a[28:31], a[156:159], a[188:191], a[28:31]
v_pk_mul_f32 v[252:253], v[252:253], s[4:5]
v_pk_mul_f32 v[254:255], v[254:255], s[4:5]
M a[28:31], a[152:155], a[184:187], a[28:31]
v_cvt_pk_bf16_f32 v248, v248, v249
v_cvt_pk_bf16_f32 v249, v250, v251
v_cvt_pk_bf16_f32 v250, v252, v253
v_cvt_pk_bf16_f32 v251, v254, v255
v_accvgpr_read_b32 v24, a0
v_accvgpr_read_b32 v25, a1
v_accvgpr_read_b32 v26, a2
v_accvgpr_read_b32 v27, a3
v_accvgpr_read_b32 v28, a4
v_accvgpr_read_b32 v29, a5
v_accvgpr_read_b32 v30, a6
v_accvgpr_read_b32 v31, a7
v_pk_mul_f32 v[24:25], v[24:25], s[4:5]
v_pk_mul_f32 v[26:27], v[26:27], s[4:5]
v_pk_mul_f32 v[28:29], v[28:29], s[4:5]
v_pk_mul_f32 v[30:31], v[30:31], s[4:5]
v_cvt_pk_bf16_f32 v36, v24, v25
v_cvt_pk_bf16_f32 v37, v26, v27
v_cvt_pk_bf16_f32 v38, v28, v29
v_cvt_pk_bf16_f32 v39, v30, v31
v_accvgpr_read_b32 v24, a8
v_accvgpr_read_b32 v25, a9
v_accvgpr_read_b32 v26, a10
v_accvgpr_read_b32 v27, a11
v_accvgpr_read_b32 v28, a12
v_accvgpr_read_b32 v29, a13
v_accvgpr_read_b32 v30, a14
v_accvgpr_read_b32 v31, a15
v_pk_mul_f32 v[24:25], v[24:25], s[4:5]
v_pk_mul_f32 v[26:27], v[26:27], s[4:5]
v_pk_mul_f32 v[28:29], v[28:29], s[4:5]
v_pk_mul_f32 v[30:31], v[30:31], s[4:5]
v_cvt_pk_bf16_f32 v44, v24, v25
v_cvt_pk_bf16_f32 v45, v26, v27
v_cvt_pk_bf16_f32 v46, v28, v29
v_cvt_pk_bf16_f32 v47, v30, v31
v_accvgpr_read_b32 v24, a16
v_accvgpr_read_b32 v25, a17
v_accvgpr_read_b32 v26, a18
v_accvgpr_read_b32 v27, a19
v_accvgpr_read_b32 v28, a20
v_accvgpr_read_b32 v29, a21
v_accvgpr_read_b32 v30, a22
v_accvgpr_read_b32 v31, a23
v_pk_mul_f32 v[24:25], v[24:25], s[4:5]
v_pk_mul_f32 v[26:27], v[26:27], s[4:5]
v_pk_mul_f32 v[28:29], v[28:29], s[4:5]
v_pk_mul_f32 v[30:31], v[30:31], s[4:5]
v_cvt_pk_bf16_f32 v52, v24, v25
v_cvt_pk_bf16_f32 v53, v26, v27
v_cvt_pk_bf16_f32 v54, v28, v29
v_cvt_pk_bf16_f32 v55, v30, v31
v_accvgpr_read_b32 v24, a24
v_accvgpr_read_b32 v25, a25
v_accvgpr_read_b32 v26, a26
v_accvgpr_read_b32 v27, a27
v_accvgpr_read_b32 v28, a28
v_accvgpr_read_b32 v29, a29
v_accvgpr_read_b32 v30, a30
v_accvgpr_read_b32 v31, a31
v_pk_mul_f32 v[24:25], v[24:25], s[4:5]
v_pk_mul_f32 v[26:27], v[26:27], s[4:5]
v_pk_mul_f32 v[28:29], v[28:29], s[4:5]
v_pk_mul_f32 v[30:31], v[30:31], s[4:5]
v_cvt_pk_bf16_f32 v60, v24, v25
v_cvt_pk_bf16_f32 v61, v26, v27
v_cvt_pk_bf16_f32 v62, v28, v29
v_cvt_pk_bf16_f32 v63, v30, v31
s_branch Lk1_b
Lk1_spin:
s_add_u32 s40, s40, 1
s_cmp_gt_u32 s40, 1048576
s_cbranch_scc1 Lk1_got
s_sleep 2
buffer_load_dword v126, v119, s[36:39], 0 offen offset:128 sc1
s_waitcnt vmcnt(0)
v_cmp_gt_u32 vcc, 0x80, v126
s_nop 0
s_cbranch_vccnz Lk1_spin
s_branch Lk1_got
Lk1_spinq:
s_add_u32 s40, s40, 1
s_cmp_gt_u32 s40, 1048576
s_cbranch_scc1 Lk1_gotq
s_sleep 2
buffer_load_dword v125, v119, s[36:39], 0 offen offset:0 sc1
s_waitcnt vmcnt(0)
v_cmp_gt_u32 vcc, 0x80, v125
s_nop 0
s_cbranch_vccnz Lk1_spinq
s_branch Lk1_gotq
Lk1_kv:
s_mov_b64 s[60:61], s[40:41]
s_mov_b32 s62, 4194304
s_and_b32 s3, s2, 127
s_lshl_b32 s3, s3, 2
s_add_u32 s3, s3, s20
s_mul_i32 s54, s3, 1024
M v[32:35], a[32:35], a[160:163], 0
s_add_u32 m0, s29, 32768
s_nop 0
buffer_load_dwordx4 v2, s[8:11], s23 offen offset:0 lds
M v[32:35], a[36:39], a[164:167], v[32:35]
ds_read_b128 a[176:179], v10 offset:4096
ds_read_b128 a[180:183], v11 offset:4096
M v[36:39], a[44:47], a[164:167], 0
M v[36:39], a[40:43], a[160:163], v[36:39]
ds_read_b64_tr_b16 a[96:97], v12 offset:32768
ds_read_b64_tr_b16 a[98:99], v12 offset:34816
M v[40:43], a[48:51], a[160:163], 0
M v[40:43], a[52:55], a[164:167], v[40:43]
buffer_load_dwordx4 v3, s[8:11], s23 offen offset:1024 lds
M v[44:47], a[60:63], a[164:167], 0
M v[44:47], a[56:59], a[160:163], v[44:47]
ds_read_b64_tr_b16 a[104:105], v13 offset:32768
ds_read_b64_tr_b16 a[106:107], v13 offset:34816
M v[48:51], a[64:67], a[160:163], 0
M v[48:51], a[68:71], a[164:167], v[48:51]
buffer_load_dwordx4 v4, s[8:11], s23 offen offset:2048 lds
M v[52:55], a[76:79], a[164:167], 0
M v[52:55], a[72:75], a[160:163], v[52:55]
ds_read_b64_tr_b16 a[112:113], v14 offset:32768
ds_read_b64_tr_b16 a[114:115], v14 offset:34816
M v[56:59], a[80:83], a[160:163], 0
M v[56:59], a[84:87], a[164:167], v[56:59]
buffer_load_dwordx4 v5, s[8:11], s23 offen offset:3072 lds
M v[60:63], a[92:95], a[164:167], 0
M v[60:63], a[88:91], a[160:163], v[60:63]
ds_read_b64_tr_b16 a[120:121], v15 offset:32768
ds_read_b64_tr_b16 a[122:123], v15 offset:34816
M v[64:67], a[32:35], a[168:171], 0
M v[64:67], a[36:39], a[172:175], v[64:67]
ds_read_b128 a[184:187], v10 offset:6144
ds_read_b128 a[188:191], v11 offset:6144
M v[68:71], a[44:47], a[172:175], 0
s_add_u32 m0, s29, 65536
s_nop 0
buffer_load_dwordx4 v6, s[12:15], s24 offen offset:0 lds
M v[68:71], a[40:43], a[168:171], v[68:71]
ds_read_b64_tr_b16 a[128:129], v16 offset:32768
ds_read_b64_tr_b16 a[130:131], v16 offset:34816
M v[72:75], a[48:51], a[168:171], 0
M v[72:75], a[52:55], a[172:175], v[72:75]
M v[76:79], a[60:63], a[172:175], 0
buffer_load_dwordx4 v7, s[12:15], s24 offen offset:1024 lds
M v[76:79], a[56:59], a[168:171], v[76:79]
ds_read_b64_tr_b16 a[136:137], v17 offset:32768
ds_read_b64_tr_b16 a[138:139], v17 offset:34816
M v[80:83], a[64:67], a[168:171], 0
M v[80:83], a[68:71], a[172:175], v[80:83]
M v[84:87], a[76:79], a[172:175], 0
buffer_load_dwordx4 v8, s[12:15], s24 offen offset:2048 lds
M v[84:87], a[72:75], a[168:171], v[84:87]
ds_read_b64_tr_b16 a[144:145], v18 offset:32768
ds_read_b64_tr_b16 a[146:147], v18 offset:34816
M v[88:91], a[80:83], a[168:171], 0
M v[88:91], a[84:87], a[172:175], v[88:91]
M v[92:95], a[92:95], a[172:175], 0
buffer_load_dwordx4 v9, s[12:15], s24 offen offset:3072 lds
M v[92:95], a[88:91], a[168:171], v[92:95]
s_waitcnt lgkmcnt(15)
ds_read_b64_tr_b16 a[152:153], v19 offset:32768
ds_read_b64_tr_b16 a[154:155], v19 offset:34816
M v[96:99], a[32:35], a[176:179], 0
M v[96:99], a[36:39], a[180:183], v[96:99]
M v[100:103], a[44:47], a[180:183], 0
s_add_u32 s24, s24, 262144
M v[100:103], a[40:43], a[176:179], v[100:103]
M v[104:107], a[48:51], a[176:179], 0
M v[104:107], a[52:55], a[180:183], v[104:107]
M v[108:111], a[60:63], a[180:183], 0
M v[108:111], a[56:59], a[176:179], v[108:111]
s_waitcnt vmcnt(9) lgkmcnt(0)
s_barrier
ds_read_b128 a[160:163], v10 offset:16384
ds_read_b128 a[164:167], v11 offset:16384
M v[112:115], a[64:67], a[176:179], 0
s_add_u32 m0, s29, 49152
s_add_u32 s3, s23, s31
buffer_load_dwordx4 v2, s[8:11], s3 offen offset:0 lds
M v[112:115], a[68:71], a[180:183], v[112:115]
M v[116:119], a[76:79], a[180:183], 0
M v[116:119], a[72:75], a[176:179], v[116:119]
ds_read_b64_tr_b16 a[100:101], v12 offset:49152
ds_read_b64_tr_b16 a[102:103], v12 offset:51200
M v[120:123], a[80:83], a[176:179], 0
M v[120:123], a[84:87], a[180:183], v[120:123]
buffer_load_dwordx4 v3, s[8:11], s3 offen offset:1024 lds
M v[124:127], a[92:95], a[180:183], 0
M v[124:127], a[88:91], a[176:179], v[124:127]
M v[128:131], a[32:35], a[184:187], 0
M v[128:131], a[36:39], a[188:191], v[128:131]
ds_read_b128 a[168:171], v10 offset:18432
ds_read_b128 a[172:175], v11 offset:18432
ds_read_b64_tr_b16 a[108:109], v13 offset:49152
ds_read_b64_tr_b16 a[110:111], v13 offset:51200
M v[132:135], a[44:47], a[188:191], 0
M v[132:135], a[40:43], a[184:187], v[132:135]
M v[136:139], a[48:51], a[184:187], 0
buffer_load_dwordx4 v4, s[8:11], s3 offen offset:2048 lds
M v[136:139], a[52:55], a[188:191], v[136:139]
M v[140:143], a[60:63], a[188:191], 0
M v[140:143], a[56:59], a[184:187], v[140:143]
ds_read_b64_tr_b16 a[116:117], v14 offset:49152
ds_read_b64_tr_b16 a[118:119], v14 offset:51200
M v[144:147], a[64:67], a[184:187], 0
M v[144:147], a[68:71], a[188:191], v[144:147]
M v[148:151], a[76:79], a[188:191], 0
buffer_load_dwordx4 v5, s[8:11], s3 offen offset:3072 lds
M v[148:151], a[72:75], a[184:187], v[148:151]
M v[152:155], a[80:83], a[184:187], 0
M v[152:155], a[84:87], a[188:191], v[152:155]
ds_read_b64_tr_b16 a[124:125], v15 offset:49152
ds_read_b64_tr_b16 a[126:127], v15 offset:51200
M v[156:159], a[92:95], a[188:191], 0
M v[156:159], a[88:91], a[184:187], v[156:159]
s_waitcnt lgkmcnt(10)
M v[160:163], a[32:35], a[160:163], 0
M v[160:163], a[36:39], a[164:167], v[160:163]
ds_read_b128 a[176:179], v10 offset:20480
ds_read_b128 a[180:183], v11 offset:20480
M v[164:167], a[44:47], a[164:167], 0
s_add_u32 s23, s23, 128
s_cmp_eq_u32 s23, s25
s_cselect_b32 s23, s26, s23
M v[164:167], a[40:43], a[160:163], v[164:167]
ds_read_b64_tr_b16 a[132:133], v16 offset:49152
ds_read_b64_tr_b16 a[134:135], v16 offset:51200
M v[168:171], a[48:51], a[160:163], 0
M v[168:171], a[52:55], a[164:167], v[168:171]
M v[172:175], a[60:63], a[164:167], 0
M v[172:175], a[56:59], a[160:163], v[172:175]
M v[176:179], a[64:67], a[160:163], 0
s_add_u32 m0, s29, 81920
s_nop 0
buffer_load_dwordx4 v6, s[12:15], s24 offen offset:0 lds
M v[176:179], a[68:71], a[164:167], v[176:179]
ds_read_b64_tr_b16 a[140:141], v17 offset:49152
ds_read_b64_tr_b16 a[142:143], v17 offset:51200
M v[180:183], a[76:79], a[164:167], 0
M v[180:183], a[72:75], a[160:163], v[180:183]
M v[184:187], a[80:83], a[160:163], 0
M v[184:187], a[84:87], a[164:167], v[184:187]
buffer_load_dwordx4 v7, s[12:15], s24 offen offset:1024 lds
M v[188:191], a[92:95], a[164:167], 0
M v[188:191], a[88:91], a[160:163], v[188:191]
s_waitcnt lgkmcnt(12)
ds_read_b64_tr_b16 a[148:149], v18 offset:49152
ds_read_b64_tr_b16 a[150:151], v18 offset:51200
M v[192:195], a[32:35], a[168:171], 0
M v[192:195], a[36:39], a[172:175], v[192:195]
ds_read_b128 a[184:187], v10 offset:22528
ds_read_b128 a[188:191], v11 offset:22528
M v[196:199], a[44:47], a[172:175], 0
M v[196:199], a[40:43], a[168:171], v[196:199]
M v[200:203], a[48:51], a[168:171], 0
buffer_load_dwordx4 v8, s[12:15], s24 offen offset:2048 lds
M v[200:203], a[52:55], a[172:175], v[200:203]
ds_read_b64_tr_b16 a[156:157], v19 offset:49152
ds_read_b64_tr_b16 a[158:159], v19 offset:51200
M v[204:207], a[60:63], a[172:175], 0
M v[204:207], a[56:59], a[168:171], v[204:207]
M v[208:211], a[64:67], a[168:171], 0
M v[208:211], a[68:71], a[172:175], v[208:211]
M v[212:215], a[76:79], a[172:175], 0
buffer_load_dwordx4 v9, s[12:15], s24 offen offset:3072 lds
M v[212:215], a[72:75], a[168:171], v[212:215]
M v[216:219], a[80:83], a[168:171], 0
M v[216:219], a[84:87], a[172:175], v[216:219]
M v[220:223], a[92:95], a[172:175], 0
M v[220:223], a[88:91], a[168:171], v[220:223]
s_waitcnt lgkmcnt(10)
M v[224:227], a[32:35], a[176:179], 0
s_add_u32 s24, s24, 262144
s_cmp_eq_u32 s24, s27
s_cselect_b32 s24, s28, s24
s_sub_u32 s6, s6, 1
s_cmp_eq_u32 s6, 0
s_cselect_b64 s[12:13], s[64:65], s[12:13]
M v[224:227], a[36:39], a[180:183], v[224:227]
M v[228:231], a[44:47], a[180:183], 0
M v[228:231], a[40:43], a[176:179], v[228:231]
M v[232:235], a[48:51], a[176:179], 0
M v[232:235], a[52:55], a[180:183], v[232:235]
M v[236:239], a[60:63], a[180:183], 0
M v[236:239], a[56:59], a[176:179], v[236:239]
s_waitcnt vmcnt(8) lgkmcnt(0)
s_barrier
ds_read_b128 a[160:163], v10 offset:32768
ds_read_b128 a[164:167], v11 offset:32768
M v[240:243], a[64:67], a[176:179], 0
s_add_u32 m0, s29, 0
s_nop 0
buffer_load_dwordx4 v2, s[8:11], s23 offen offset:0 lds
M v[240:243], a[68:71], a[180:183], v[240:243]
M v[244:247], a[76:79], a[180:183], 0
M v[244:247], a[72:75], a[176:179], v[244:247]
M v[248:251], a[80:83], a[176:179], 0
M v[248:251], a[84:87], a[180:183], v[248:251]
buffer_load_dwordx4 v3, s[8:11], s23 offen offset:1024 lds
M v[252:255], a[92:95], a[180:183], 0
M v[252:255], a[88:91], a[176:179], v[252:255]
M a[0:3], a[32:35], a[184:187], 0
M a[0:3], a[36:39], a[188:191], a[0:3]
ds_read_b128 a[168:171], v10 offset:34816
ds_read_b128 a[172:175], v11 offset:34816
M a[4:7], a[44:47], a[188:191], 0
M a[4:7], a[40:43], a[184:187], a[4:7]
M a[8:11], a[48:51], a[184:187], 0
buffer_load_dwordx4 v4, s[8:11], s23 offen offset:2048 lds
M a[8:11], a[52:55], a[188:191], a[8:11]
M a[12:15], a[60:63], a[188:191], 0
M a[12:15], a[56:59], a[184:187], a[12:15]
M a[16:19], a[64:67], a[184:187], 0
M a[16:19], a[68:71], a[188:191], a[16:19]
buffer_load_dwordx4 v5, s[8:11], s23 offen offset:3072 lds
M a[20:23], a[76:79], a[188:191], 0
M a[20:23], a[72:75], a[184:187], a[20:23]
M a[24:27], a[80:83], a[184:187], 0
M a[24:27], a[84:87], a[188:191], a[24:27]
M a[28:31], a[92:95], a[188:191], 0
M a[28:31], a[88:91], a[184:187], a[28:31]
s_waitcnt lgkmcnt(2)
M v[32:35], a[96:99], a[160:163], v[32:35]
s_add_u32 m0, s29, 98304
s_nop 0
buffer_load_dwordx4 v6, s[12:15], s24 offen offset:0 lds
M v[32:35], a[100:103], a[164:167], v[32:35]
ds_read_b128 a[176:179], v10 offset:36864
ds_read_b128 a[180:183], v11 offset:36864
M v[36:39], a[108:111], a[164:167], v[36:39]
M v[36:39], a[104:107], a[160:163], v[36:39]
ds_read_b64_tr_b16 a[32:33], v12 offset:0
ds_read_b64_tr_b16 a[34:35], v12 offset:2048
M v[40:43], a[112:115], a[160:163], v[40:43]
M v[40:43], a[116:119], a[164:167], v[40:43]
M v[44:47], a[124:127], a[164:167], v[44:47]
M v[44:47], a[120:123], a[160:163], v[44:47]
ds_read_b64_tr_b16 a[40:41], v13 offset:0
ds_read_b64_tr_b16 a[42:43], v13 offset:2048
M v[48:51], a[128:131], a[160:163], v[48:51]
buffer_load_dwordx4 v7, s[12:15], s24 offen offset:1024 lds
M v[48:51], a[132:135], a[164:167], v[48:51]
M v[52:55], a[140:143], a[164:167], v[52:55]
M v[52:55], a[136:139], a[160:163], v[52:55]
ds_read_b64_tr_b16 a[48:49], v14 offset:0
ds_read_b64_tr_b16 a[50:51], v14 offset:2048
M v[56:59], a[144:147], a[160:163], v[56:59]
M v[56:59], a[148:151], a[164:167], v[56:59]
M v[60:63], a[156:159], a[164:167], v[60:63]
buffer_load_dwordx4 v8, s[12:15], s24 offen offset:2048 lds
M v[60:63], a[152:155], a[160:163], v[60:63]
s_waitcnt lgkmcnt(8)
ds_read_b64_tr_b16 a[56:57], v15 offset:0
ds_read_b64_tr_b16 a[58:59], v15 offset:2048
M v[64:67], a[96:99], a[168:171], v[64:67]
M v[64:67], a[100:103], a[172:175], v[64:67]
ds_read_b128 a[184:187], v10 offset:38912
ds_read_b128 a[188:191], v11 offset:38912
M v[68:71], a[108:111], a[172:175], v[68:71]
M v[68:71], a[104:107], a[168:171], v[68:71]
ds_read_b64_tr_b16 a[64:65], v16 offset:0
ds_read_b64_tr_b16 a[66:67], v16 offset:2048
M v[72:75], a[112:115], a[168:171], v[72:75]
M v[72:75], a[116:119], a[172:175], v[72:75]
M v[76:79], a[124:127], a[172:175], v[76:79]
M v[76:79], a[120:123], a[168:171], v[76:79]
ds_read_b64_tr_b16 a[72:73], v17 offset:0
ds_read_b64_tr_b16 a[74:75], v17 offset:2048
M v[80:83], a[128:131], a[168:171], v[80:83]
buffer_load_dwordx4 v9, s[12:15], s24 offen offset:3072 lds
M v[80:83], a[132:135], a[172:175], v[80:83]
M v[84:87], a[140:143], a[172:175], v[84:87]
M v[84:87], a[136:139], a[168:171], v[84:87]
ds_read_b64_tr_b16 a[80:81], v18 offset:0
ds_read_b64_tr_b16 a[82:83], v18 offset:2048
M v[88:91], a[144:147], a[168:171], v[88:91]
M v[88:91], a[148:151], a[172:175], v[88:91]
M v[92:95], a[156:159], a[172:175], v[92:95]
s_add_u32 s24, s24, 262144
M v[92:95], a[152:155], a[168:171], v[92:95]
s_waitcnt lgkmcnt(15)
ds_read_b64_tr_b16 a[88:89], v19 offset:0
ds_read_b64_tr_b16 a[90:91], v19 offset:2048
M v[96:99], a[96:99], a[176:179], v[96:99]
M v[96:99], a[100:103], a[180:183], v[96:99]
M v[100:103], a[108:111], a[180:183], v[100:103]
M v[100:103], a[104:107], a[176:179], v[100:103]
M v[104:107], a[112:115], a[176:179], v[104:107]
M v[104:107], a[116:119], a[180:183], v[104:107]
M v[108:111], a[124:127], a[180:183], v[108:111]
M v[108:111], a[120:123], a[176:179], v[108:111]
s_waitcnt vmcnt(8) lgkmcnt(0)
s_barrier
ds_read_b128 a[160:163], v10 offset:49152
ds_read_b128 a[164:167], v11 offset:49152
M v[112:115], a[128:131], a[176:179], v[112:115]
s_add_u32 m0, s29, 16384
s_add_u32 s3, s23, s31
buffer_load_dwordx4 v2, s[8:11], s3 offen offset:0 lds
M v[112:115], a[132:135], a[180:183], v[112:115]
M v[116:119], a[140:143], a[180:183], v[116:119]
M v[116:119], a[136:139], a[176:179], v[116:119]
ds_read_b64_tr_b16 a[36:37], v12 offset:16384
ds_read_b64_tr_b16 a[38:39], v12 offset:18432
M v[120:123], a[144:147], a[176:179], v[120:123]
M v[120:123], a[148:151], a[180:183], v[120:123]
buffer_load_dwordx4 v3, s[8:11], s3 offen offset:1024 lds
M v[124:127], a[156:159], a[180:183], v[124:127]
M v[124:127], a[152:155], a[176:179], v[124:127]
M v[128:131], a[96:99], a[184:187], v[128:131]
M v[128:131], a[100:103], a[188:191], v[128:131]
ds_read_b128 a[168:171], v10 offset:51200
ds_read_b128 a[172:175], v11 offset:51200
ds_read_b64_tr_b16 a[44:45], v13 offset:16384
ds_read_b64_tr_b16 a[46:47], v13 offset:18432
M v[132:135], a[108:111], a[188:191], v[132:135]
M v[132:135], a[104:107], a[184:187], v[132:135]
buffer_load_dwordx4 v4, s[8:11], s3 offen offset:2048 lds
M v[136:139], a[112:115], a[184:187], v[136:139]
M v[136:139], a[116:119], a[188:191], v[136:139]
M v[140:143], a[124:127], a[188:191], v[140:143]
M v[140:143], a[120:123], a[184:187], v[140:143]
ds_read_b64_tr_b16 a[52:53], v14 offset:16384
ds_read_b64_tr_b16 a[54:55], v14 offset:18432
M v[144:147], a[128:131], a[184:187], v[144:147]
M v[144:147], a[132:135], a[188:191], v[144:147]
buffer_load_dwordx4 v5, s[8:11], s3 offen offset:3072 lds
M v[148:151], a[140:143], a[188:191], v[148:151]
M v[148:151], a[136:139], a[184:187], v[148:151]
M v[152:155], a[144:147], a[184:187], v[152:155]
buffer_store_dwordx4 v[28:31], v23, s[16:19], s56 offen sc1
M v[152:155], a[148:151], a[188:191], v[152:155]
ds_read_b64_tr_b16 a[60:61], v15 offset:16384
ds_read_b64_tr_b16 a[62:63], v15 offset:18432
M v[156:159], a[156:159], a[188:191], v[156:159]
M v[156:159], a[152:155], a[184:187], v[156:159]
s_waitcnt lgkmcnt(10)
M v[160:163], a[96:99], a[160:163], v[160:163]
s_add_u32 s23, s23, 128
s_cmp_eq_u32 s23, s25
s_cselect_b32 s23, s26, s23
M v[160:163], a[100:103], a[164:167], v[160:163]
ds_read_b128 a[176:179], v10 offset:53248
ds_read_b128 a[180:183], v11 offset:53248
M v[164:167], a[108:111], a[164:167], v[164:167]
M v[164:167], a[104:107], a[160:163], v[164:167]
ds_read_b64_tr_b16 a[68:69], v16 offset:16384
ds_read_b64_tr_b16 a[70:71], v16 offset:18432
M v[168:171], a[112:115], a[160:163], v[168:171]
M v[168:171], a[116:119], a[164:167], v[168:171]
M v[172:175], a[124:127], a[164:167], v[172:175]
M v[172:175], a[120:123], a[160:163], v[172:175]
s_add_u32 m0, s29, 114688
s_nop 0
buffer_load_dwordx4 v6, s[12:15], s24 offen offset:0 lds
M v[176:179], a[128:131], a[160:163], v[176:179]
buffer_store_dwordx4 v[28:31], v23, s[16:19], s57 offen sc1
M v[176:179], a[132:135], a[164:167], v[176:179]
ds_read_b64_tr_b16 a[76:77], v17 offset:16384
ds_read_b64_tr_b16 a[78:79], v17 offset:18432
M v[180:183], a[140:143], a[164:167], v[180:183]
M v[180:183], a[136:139], a[160:163], v[180:183]
M v[184:187], a[144:147], a[160:163], v[184:187]
M v[184:187], a[148:151], a[164:167], v[184:187]
buffer_load_dwordx4 v7, s[12:15], s24 offen offset:1024 lds
M v[188:191], a[156:159], a[164:167], v[188:191]
M v[188:191], a[152:155], a[160:163], v[188:191]
s_waitcnt lgkmcnt(12)
ds_read_b64_tr_b16 a[84:85], v18 offset:16384
ds_read_b64_tr_b16 a[86:87], v18 offset:18432
M v[192:195], a[96:99], a[168:171], v[192:195]
M v[192:195], a[100:103], a[172:175], v[192:195]
ds_read_b128 a[184:187], v10 offset:55296
ds_read_b128 a[188:191], v11 offset:55296
M v[196:199], a[108:111], a[172:175], v[196:199]
M v[196:199], a[104:107], a[168:171], v[196:199]
buffer_load_dwordx4 v8, s[12:15], s24 offen offset:2048 lds
M v[200:203], a[112:115], a[168:171], v[200:203]
buffer_store_dwordx4 v[28:31], v23, s[16:19], s58 offen sc1
M v[200:203], a[116:119], a[172:175], v[200:203]
ds_read_b64_tr_b16 a[92:93], v19 offset:16384
ds_read_b64_tr_b16 a[94:95], v19 offset:18432
M v[204:207], a[124:127], a[172:175], v[204:207]
M v[204:207], a[120:123], a[168:171], v[204:207]
M v[208:211], a[128:131], a[168:171], v[208:211]
M v[208:211], a[132:135], a[172:175], v[208:211]
M v[212:215], a[140:143], a[172:175], v[212:215]
buffer_load_dwordx4 v9, s[12:15], s24 offen offset:3072 lds
M v[212:215], a[136:139], a[168:171], v[212:215]
M v[216:219], a[144:147], a[168:171], v[216:219]
M v[216:219], a[148:151], a[172:175], v[216:219]
M v[220:223], a[156:159], a[172:175], v[220:223]
s_add_u32 s24, s24, 262144
s_cmp_eq_u32 s24, s27
s_cselect_b32 s24, s28, s24
s_sub_u32 s6, s6, 1
s_cmp_eq_u32 s6, 0
s_cselect_b64 s[12:13], s[64:65], s[12:13]
M v[220:223], a[152:155], a[168:171], v[220:223]
s_waitcnt lgkmcnt(10)
M v[224:227], a[96:99], a[176:179], v[224:227]
buffer_store_dwordx4 v[28:31], v23, s[16:19], s59 offen sc1
M v[224:227], a[100:103], a[180:183], v[224:227]
M v[228:231], a[108:111], a[180:183], v[228:231]
M v[228:231], a[104:107], a[176:179], v[228:231]
M v[232:235], a[112:115], a[176:179], v[232:235]
M v[232:235], a[116:119], a[180:183], v[232:235]
M v[236:239], a[124:127], a[180:183], v[236:239]
M v[236:239], a[120:123], a[176:179], v[236:239]
s_waitcnt vmcnt(12) lgkmcnt(0)
s_barrier
ds_read_b128 a[160:163], v10 offset:0
ds_read_b128 a[164:167], v11 offset:0
M v[240:243], a[128:131], a[176:179], v[240:243]
s_add_u32 m0, s29, 32768
s_nop 0
buffer_load_dwordx4 v2, s[8:11], s23 offen offset:0 lds
M v[240:243], a[132:135], a[180:183], v[240:243]
M v[244:247], a[140:143], a[180:183], v[244:247]
M v[244:247], a[136:139], a[176:179], v[244:247]
M v[248:251], a[144:147], a[176:179], v[248:251]
M v[248:251], a[148:151], a[180:183], v[248:251]
buffer_load_dwordx4 v3, s[8:11], s23 offen offset:1024 lds
M v[252:255], a[156:159], a[180:183], v[252:255]
M v[252:255], a[152:155], a[176:179], v[252:255]
M a[0:3], a[96:99], a[184:187], a[0:3]
M a[0:3], a[100:103], a[188:191], a[0:3]
ds_read_b128 a[168:171], v10 offset:2048
ds_read_b128 a[172:175], v11 offset:2048
M a[4:7], a[108:111], a[188:191], a[4:7]
M a[4:7], a[104:107], a[184:187], a[4:7]
M a[8:11], a[112:115], a[184:187], a[8:11]
buffer_load_dwordx4 v4, s[8:11], s23 offen offset:2048 lds
M a[8:11], a[116:119], a[188:191], a[8:11]
M a[12:15], a[124:127], a[188:191], a[12:15]
M a[12:15], a[120:123], a[184:187], a[12:15]
M a[16:19], a[128:131], a[184:187], a[16:19]
M a[16:19], a[132:135], a[188:191], a[16:19]
buffer_load_dwordx4 v5, s[8:11], s23 offen offset:3072 lds
M a[20:23], a[140:143], a[188:191], a[20:23]
M a[20:23], a[136:139], a[184:187], a[20:23]
M a[24:27], a[144:147], a[184:187], a[24:27]
M a[24:27], a[148:151], a[188:191], a[24:27]
M a[28:31], a[156:159], a[188:191], a[28:31]
M a[28:31], a[152:155], a[184:187], a[28:31]
s_waitcnt lgkmcnt(2)
s_mov_b32 s30, 2
Lk1_kl:
M v[32:35], a[32:35], a[160:163], v[32:35]
s_add_u32 m0, s29, 65536
s_nop 0
buffer_load_dwordx4 v6, s[12:15], s24 offen offset:0 lds
M v[32:35], a[36:39], a[164:167], v[32:35]
ds_read_b128 a[176:179], v10 offset:4096
ds_read_b128 a[180:183], v11 offset:4096
M v[36:39], a[44:47], a[164:167], v[36:39]
M v[36:39], a[40:43], a[160:163], v[36:39]
ds_read_b64_tr_b16 a[96:97], v12 offset:32768
ds_read_b64_tr_b16 a[98:99], v12 offset:34816
M v[40:43], a[48:51], a[160:163], v[40:43]
M v[40:43], a[52:55], a[164:167], v[40:43]
M v[44:47], a[60:63], a[164:167], v[44:47]
M v[44:47], a[56:59], a[160:163], v[44:47]
ds_read_b64_tr_b16 a[104:105], v13 offset:32768
ds_read_b64_tr_b16 a[106:107], v13 offset:34816
M v[48:51], a[64:67], a[160:163], v[48:51]
buffer_load_dwordx4 v7, s[12:15], s24 offen offset:1024 lds
M v[48:51], a[68:71], a[164:167], v[48:51]
M v[52:55], a[76:79], a[164:167], v[52:55]
M v[52:55], a[72:75], a[160:163], v[52:55]
ds_read_b64_tr_b16 a[112:113], v14 offset:32768
ds_read_b64_tr_b16 a[114:115], v14 offset:34816
M v[56:59], a[80:83], a[160:163], v[56:59]
M v[56:59], a[84:87], a[164:167], v[56:59]
M v[60:63], a[92:95], a[164:167], v[60:63]
buffer_load_dwordx4 v8, s[12:15], s24 offen offset:2048 lds
M v[60:63], a[88:91], a[160:163], v[60:63]
s_waitcnt lgkmcnt(8)
ds_read_b64_tr_b16 a[120:121], v15 offset:32768
ds_read_b64_tr_b16 a[122:123], v15 offset:34816
M v[64:67], a[32:35], a[168:171], v[64:67]
M v[64:67], a[36:39], a[172:175], v[64:67]
ds_read_b128 a[184:187], v10 offset:6144
ds_read_b128 a[188:191], v11 offset:6144
M v[68:71], a[44:47], a[172:175], v[68:71]
M v[68:71], a[40:43], a[168:171], v[68:71]
ds_read_b64_tr_b16 a[128:129], v16 offset:32768
ds_read_b64_tr_b16 a[130:131], v16 offset:34816
M v[72:75], a[48:51], a[168:171], v[72:75]
M v[72:75], a[52:55], a[172:175], v[72:75]
M v[76:79], a[60:63], a[172:175], v[76:79]
M v[76:79], a[56:59], a[168:171], v[76:79]
ds_read_b64_tr_b16 a[136:137], v17 offset:32768
ds_read_b64_tr_b16 a[138:139], v17 offset:34816
M v[80:83], a[64:67], a[168:171], v[80:83]
buffer_load_dwordx4 v9, s[12:15], s24 offen offset:3072 lds
M v[80:83], a[68:71], a[172:175], v[80:83]
M v[84:87], a[76:79], a[172:175], v[84:87]
M v[84:87], a[72:75], a[168:171], v[84:87]
ds_read_b64_tr_b16 a[144:145], v18 offset:32768
ds_read_b64_tr_b16 a[146:147], v18 offset:34816
M v[88:91], a[80:83], a[168:171], v[88:91]
M v[88:91], a[84:87], a[172:175], v[88:91]
M v[92:95], a[92:95], a[172:175], v[92:95]
s_add_u32 s24, s24, 262144
M v[92:95], a[88:91], a[168:171], v[92:95]
s_waitcnt lgkmcnt(15)
ds_read_b64_tr_b16 a[152:153], v19 offset:32768
ds_read_b64_tr_b16 a[154:155], v19 offset:34816
M v[96:99], a[32:35], a[176:179], v[96:99]
M v[96:99], a[36:39], a[180:183], v[96:99]
M v[100:103], a[44:47], a[180:183], v[100:103]
M v[100:103], a[40:43], a[176:179], v[100:103]
M v[104:107], a[48:51], a[176:179], v[104:107]
M v[104:107], a[52:55], a[180:183], v[104:107]
M v[108:111], a[60:63], a[180:183], v[108:111]
M v[108:111], a[56:59], a[176:179], v[108:111]
s_waitcnt vmcnt(8) lgkmcnt(0)
s_barrier
ds_read_b128 a[160:163], v10 offset:16384
ds_read_b128 a[164:167], v11 offset:16384
M v[112:115], a[64:67], a[176:179], v[112:115]
s_add_u32 m0, s29, 49152
s_add_u32 s3, s23, s31
buffer_load_dwordx4 v2, s[8:11], s3 offen offset:0 lds
M v[112:115], a[68:71], a[180:183], v[112:115]
M v[116:119], a[76:79], a[180:183], v[116:119]
M v[116:119], a[72:75], a[176:179], v[116:119]
ds_read_b64_tr_b16 a[100:101], v12 offset:49152
ds_read_b64_tr_b16 a[102:103], v12 offset:51200
M v[120:123], a[80:83], a[176:179], v[120:123]
M v[120:123], a[84:87], a[180:183], v[120:123]
buffer_load_dwordx4 v3, s[8:11], s3 offen offset:1024 lds
M v[124:127], a[92:95], a[180:183], v[124:127]
M v[124:127], a[88:91], a[176:179], v[124:127]
M v[128:131], a[32:35], a[184:187], v[128:131]
M v[128:131], a[36:39], a[188:191], v[128:131]
ds_read_b128 a[168:171], v10 offset:18432
ds_read_b128 a[172:175], v11 offset:18432
ds_read_b64_tr_b16 a[108:109], v13 offset:49152
ds_read_b64_tr_b16 a[110:111], v13 offset:51200
M v[132:135], a[44:47], a[188:191], v[132:135]
M v[132:135], a[40:43], a[184:187], v[132:135]
M v[136:139], a[48:51], a[184:187], v[136:139]
buffer_load_dwordx4 v4, s[8:11], s3 offen offset:2048 lds
M v[136:139], a[52:55], a[188:191], v[136:139]
M v[140:143], a[60:63], a[188:191], v[140:143]
M v[140:143], a[56:59], a[184:187], v[140:143]
ds_read_b64_tr_b16 a[116:117], v14 offset:49152
ds_read_b64_tr_b16 a[118:119], v14 offset:51200
M v[144:147], a[64:67], a[184:187], v[144:147]
M v[144:147], a[68:71], a[188:191], v[144:147]
M v[148:151], a[76:79], a[188:191], v[148:151]
buffer_load_dwordx4 v5, s[8:11], s3 offen offset:3072 lds
M v[148:151], a[72:75], a[184:187], v[148:151]
M v[152:155], a[80:83], a[184:187], v[152:155]
M v[152:155], a[84:87], a[188:191], v[152:155]
ds_read_b64_tr_b16 a[124:125], v15 offset:49152
ds_read_b64_tr_b16 a[126:127], v15 offset:51200
M v[156:159], a[92:95], a[188:191], v[156:159]
M v[156:159], a[88:91], a[184:187], v[156:159]
s_waitcnt lgkmcnt(10)
M v[160:163], a[32:35], a[160:163], v[160:163]
M v[160:163], a[36:39], a[164:167], v[160:163]
ds_read_b128 a[176:179], v10 offset:20480
ds_read_b128 a[180:183], v11 offset:20480
M v[164:167], a[44:47], a[164:167], v[164:167]
s_add_u32 s23, s23, 128
s_cmp_eq_u32 s23, s25
s_cselect_b32 s23, s26, s23
M v[164:167], a[40:43], a[160:163], v[164:167]
ds_read_b64_tr_b16 a[132:133], v16 offset:49152
ds_read_b64_tr_b16 a[134:135], v16 offset:51200
M v[168:171], a[48:51], a[160:163], v[168:171]
M v[168:171], a[52:55], a[164:167], v[168:171]
M v[172:175], a[60:63], a[164:167], v[172:175]
M v[172:175], a[56:59], a[160:163], v[172:175]
M v[176:179], a[64:67], a[160:163], v[176:179]
s_add_u32 m0, s29, 81920
s_nop 0
buffer_load_dwordx4 v6, s[12:15], s24 offen offset:0 lds
M v[176:179], a[68:71], a[164:167], v[176:179]
ds_read_b64_tr_b16 a[140:141], v17 offset:49152
ds_read_b64_tr_b16 a[142:143], v17 offset:51200
M v[180:183], a[76:79], a[164:167], v[180:183]
M v[180:183], a[72:75], a[160:163], v[180:183]
M v[184:187], a[80:83], a[160:163], v[184:187]
M v[184:187], a[84:87], a[164:167], v[184:187]
buffer_load_dwordx4 v7, s[12:15], s24 offen offset:1024 lds
M v[188:191], a[92:95], a[164:167], v[188:191]
M v[188:191], a[88:91], a[160:163], v[188:191]
s_waitcnt lgkmcnt(12)
ds_read_b64_tr_b16 a[148:149], v18 offset:49152
ds_read_b64_tr_b16 a[150:151], v18 offset:51200
M v[192:195], a[32:35], a[168:171], v[192:195]
M v[192:195], a[36:39], a[172:175], v[192:195]
ds_read_b128 a[184:187], v10 offset:22528
ds_read_b128 a[188:191], v11 offset:22528
M v[196:199], a[44:47], a[172:175], v[196:199]
M v[196:199], a[40:43], a[168:171], v[196:199]
M v[200:203], a[48:51], a[168:171], v[200:203]
buffer_load_dwordx4 v8, s[12:15], s24 offen offset:2048 lds
M v[200:203], a[52:55], a[172:175], v[200:203]
ds_read_b64_tr_b16 a[156:157], v19 offset:49152
ds_read_b64_tr_b16 a[158:159], v19 offset:51200
M v[204:207], a[60:63], a[172:175], v[204:207]
M v[204:207], a[56:59], a[168:171], v[204:207]
M v[208:211], a[64:67], a[168:171], v[208:211]
M v[208:211], a[68:71], a[172:175], v[208:211]
M v[212:215], a[76:79], a[172:175], v[212:215]
buffer_load_dwordx4 v9, s[12:15], s24 offen offset:3072 lds
M v[212:215], a[72:75], a[168:171], v[212:215]
M v[216:219], a[80:83], a[168:171], v[216:219]
M v[216:219], a[84:87], a[172:175], v[216:219]
M v[220:223], a[92:95], a[172:175], v[220:223]
M v[220:223], a[88:91], a[168:171], v[220:223]
s_waitcnt lgkmcnt(10)
M v[224:227], a[32:35], a[176:179], v[224:227]
s_add_u32 s24, s24, 262144
s_cmp_eq_u32 s24, s27
s_cselect_b32 s24, s28, s24
s_sub_u32 s6, s6, 1
s_cmp_eq_u32 s6, 0
s_cselect_b64 s[12:13], s[64:65], s[12:13]
M v[224:227], a[36:39], a[180:183], v[224:227]
M v[228:231], a[44:47], a[180:183], v[228:231]
M v[228:231], a[40:43], a[176:179], v[228:231]
M v[232:235], a[48:51], a[176:179], v[232:235]
M v[232:235], a[52:55], a[180:183], v[232:235]
M v[236:239], a[60:63], a[180:183], v[236:239]
M v[236:239], a[56:59], a[176:179], v[236:239]
s_waitcnt vmcnt(8) lgkmcnt(0)
s_barrier
ds_read_b128 a[160:163], v10 offset:32768
ds_read_b128 a[164:167], v11 offset:32768
M v[240:243], a[64:67], a[176:179], v[240:243]
s_add_u32 m0, s29, 0
s_nop 0
buffer_load_dwordx4 v2, s[8:11], s23 offen offset:0 lds
M v[240:243], a[68:71], a[180:183], v[240:243]
M v[244:247], a[76:79], a[180:183], v[244:247]
M v[244:247], a[72:75], a[176:179], v[244:247]
M v[248:251], a[80:83], a[176:179], v[248:251]
M v[248:251], a[84:87], a[180:183], v[248:251]
buffer_load_dwordx4 v3, s[8:11], s23 offen offset:1024 lds
M v[252:255], a[92:95], a[180:183], v[252:255]
M v[252:255], a[88:91], a[176:179], v[252:255]
M a[0:3], a[32:35], a[184:187], a[0:3]
M a[0:3], a[36:39], a[188:191], a[0:3]
ds_read_b128 a[168:171], v10 offset:34816
ds_read_b128 a[172:175], v11 offset:34816
M a[4:7], a[44:47], a[188:191], a[4:7]
M a[4:7], a[40:43], a[184:187], a[4:7]
M a[8:11], a[48:51], a[184:187], a[8:11]
buffer_load_dwordx4 v4, s[8:11], s23 offen offset:2048 lds
M a[8:11], a[52:55], a[188:191], a[8:11]
M a[12:15], a[60:63], a[188:191], a[12:15]
M a[12:15], a[56:59], a[184:187], a[12:15]
M a[16:19], a[64:67], a[184:187], a[16:19]
M a[16:19], a[68:71], a[188:191], a[16:19]
buffer_load_dwordx4 v5, s[8:11], s23 offen offset:3072 lds
M a[20:23], a[76:79], a[188:191], a[20:23]
M a[20:23], a[72:75], a[184:187], a[20:23]
M a[24:27], a[80:83], a[184:187], a[24:27]
M a[24:27], a[84:87], a[188:191], a[24:27]
M a[28:31], a[92:95], a[188:191], a[28:31]
M a[28:31], a[88:91], a[184:187], a[28:31]
s_waitcnt lgkmcnt(2)
M v[32:35], a[96:99], a[160:163], v[32:35]
s_add_u32 m0, s29, 98304
s_nop 0
buffer_load_dwordx4 v6, s[12:15], s24 offen offset:0 lds
M v[32:35], a[100:103], a[164:167], v[32:35]
ds_read_b128 a[176:179], v10 offset:36864
ds_read_b128 a[180:183], v11 offset:36864
M v[36:39], a[108:111], a[164:167], v[36:39]
M v[36:39], a[104:107], a[160:163], v[36:39]
ds_read_b64_tr_b16 a[32:33], v12 offset:0
ds_read_b64_tr_b16 a[34:35], v12 offset:2048
M v[40:43], a[112:115], a[160:163], v[40:43]
M v[40:43], a[116:119], a[164:167], v[40:43]
M v[44:47], a[124:127], a[164:167], v[44:47]
M v[44:47], a[120:123], a[160:163], v[44:47]
ds_read_b64_tr_b16 a[40:41], v13 offset:0
ds_read_b64_tr_b16 a[42:43], v13 offset:2048
M v[48:51], a[128:131], a[160:163], v[48:51]
buffer_load_dwordx4 v7, s[12:15], s24 offen offset:1024 lds
M v[48:51], a[132:135], a[164:167], v[48:51]
M v[52:55], a[140:143], a[164:167], v[52:55]
M v[52:55], a[136:139], a[160:163], v[52:55]
ds_read_b64_tr_b16 a[48:49], v14 offset:0
ds_read_b64_tr_b16 a[50:51], v14 offset:2048
M v[56:59], a[144:147], a[160:163], v[56:59]
M v[56:59], a[148:151], a[164:167], v[56:59]
M v[60:63], a[156:159], a[164:167], v[60:63]
buffer_load_dwordx4 v8, s[12:15], s24 offen offset:2048 lds
M v[60:63], a[152:155], a[160:163], v[60:63]
s_waitcnt lgkmcnt(8)
ds_read_b64_tr_b16 a[56:57], v15 offset:0
ds_read_b64_tr_b16 a[58:59], v15 offset:2048
M v[64:67], a[96:99], a[168:171], v[64:67]
M v[64:67], a[100:103], a[172:175], v[64:67]
ds_read_b128 a[184:187], v10 offset:38912
ds_read_b128 a[188:191], v11 offset:38912
M v[68:71], a[108:111], a[172:175], v[68:71]
M v[68:71], a[104:107], a[168:171], v[68:71]
ds_read_b64_tr_b16 a[64:65], v16 offset:0
ds_read_b64_tr_b16 a[66:67], v16 offset:2048
M v[72:75], a[112:115], a[168:171], v[72:75]
M v[72:75], a[116:119], a[172:175], v[72:75]
M v[76:79], a[124:127], a[172:175], v[76:79]
M v[76:79], a[120:123], a[168:171], v[76:79]
ds_read_b64_tr_b16 a[72:73], v17 offset:0
ds_read_b64_tr_b16 a[74:75], v17 offset:2048
M v[80:83], a[128:131], a[168:171], v[80:83]
buffer_load_dwordx4 v9, s[12:15], s24 offen offset:3072 lds
M v[80:83], a[132:135], a[172:175], v[80:83]
M v[84:87], a[140:143], a[172:175], v[84:87]
M v[84:87], a[136:139], a[168:171], v[84:87]
ds_read_b64_tr_b16 a[80:81], v18 offset:0
ds_read_b64_tr_b16 a[82:83], v18 offset:2048
M v[88:91], a[144:147], a[168:171], v[88:91]
M v[88:91], a[148:151], a[172:175], v[88:91]
M v[92:95], a[156:159], a[172:175], v[92:95]
s_add_u32 s24, s24, 262144
M v[92:95], a[152:155], a[168:171], v[92:95]
s_waitcnt lgkmcnt(15)
ds_read_b64_tr_b16 a[88:89], v19 offset:0
ds_read_b64_tr_b16 a[90:91], v19 offset:2048
M v[96:99], a[96:99], a[176:179], v[96:99]
M v[96:99], a[100:103], a[180:183], v[96:99]
M v[100:103], a[108:111], a[180:183], v[100:103]
M v[100:103], a[104:107], a[176:179], v[100:103]
M v[104:107], a[112:115], a[176:179], v[104:107]
M v[104:107], a[116:119], a[180:183], v[104:107]
M v[108:111], a[124:127], a[180:183], v[108:111]
M v[108:111], a[120:123], a[176:179], v[108:111]
s_waitcnt vmcnt(8) lgkmcnt(0)
s_barrier
ds_read_b128 a[160:163], v10 offset:49152
ds_read_b128 a[164:167], v11 offset:49152
M v[112:115], a[128:131], a[176:179], v[112:115]
s_add_u32 m0, s29, 16384
s_add_u32 s3, s23, s31
buffer_load_dwordx4 v2, s[8:11], s3 offen offset:0 lds
M v[112:115], a[132:135], a[180:183], v[112:115]
M v[116:119], a[140:143], a[180:183], v[116:119]
M v[116:119], a[136:139], a[176:179], v[116:119]
ds_read_b64_tr_b16 a[36:37], v12 offset:16384
ds_read_b64_tr_b16 a[38:39], v12 offset:18432
M v[120:123], a[144:147], a[176:179], v[120:123]
M v[120:123], a[148:151], a[180:183], v[120:123]
buffer_load_dwordx4 v3, s[8:11], s3 offen offset:1024 lds
M v[124:127], a[156:159], a[180:183], v[124:127]
M v[124:127], a[152:155], a[176:179], v[124:127]
M v[128:131], a[96:99], a[184:187], v[128:131]
M v[128:131], a[100:103], a[188:191], v[128:131]
ds_read_b128 a[168:171], v10 offset:51200
ds_read_b128 a[172:175], v11 offset:51200
ds_read_b64_tr_b16 a[44:45], v13 offset:16384
ds_read_b64_tr_b16 a[46:47], v13 offset:18432
M v[132:135], a[108:111], a[188:191], v[132:135]
M v[132:135], a[104:107], a[184:187], v[132:135]
M v[136:139], a[112:115], a[184:187], v[136:139]
buffer_load_dwordx4 v4, s[8:11], s3 offen offset:2048 lds
M v[136:139], a[116:119], a[188:191], v[136:139]
M v[140:143], a[124:127], a[188:191], v[140:143]
M v[140:143], a[120:123], a[184:187], v[140:143]
ds_read_b64_tr_b16 a[52:53], v14 offset:16384
ds_read_b64_tr_b16 a[54:55], v14 offset:18432
M v[144:147], a[128:131], a[184:187], v[144:147]
M v[144:147], a[132:135], a[188:191], v[144:147]
M v[148:151], a[140:143], a[188:191], v[148:151]
buffer_load_dwordx4 v5, s[8:11], s3 offen offset:3072 lds
M v[148:151], a[136:139], a[184:187], v[148:151]
M v[152:155], a[144:147], a[184:187], v[152:155]
M v[152:155], a[148:151], a[188:191], v[152:155]
ds_read_b64_tr_b16 a[60:61], v15 offset:16384
ds_read_b64_tr_b16 a[62:63], v15 offset:18432
M v[156:159], a[156:159], a[188:191], v[156:159]
M v[156:159], a[152:155], a[184:187], v[156:159]
s_waitcnt lgkmcnt(10)
M v[160:163], a[96:99], a[160:163], v[160:163]
M v[160:163], a[100:103], a[164:167], v[160:163]
ds_read_b128 a[176:179], v10 offset:53248
ds_read_b128 a[180:183], v11 offset:53248
M v[164:167], a[108:111], a[164:167], v[164:167]
s_add_u32 s23, s23, 128
s_cmp_eq_u32 s23, s25
s_cselect_b32 s23, s26, s23
M v[164:167], a[104:107], a[160:163], v[164:167]
ds_read_b64_tr_b16 a[68:69], v16 offset:16384
ds_read_b64_tr_b16 a[70:71], v16 offset:18432
M v[168:171], a[112:115], a[160:163], v[168:171]
M v[168:171], a[116:119], a[164:167], v[168:171]
M v[172:175], a[124:127], a[164:167], v[172:175]
M v[172:175], a[120:123], a[160:163], v[172:175]
M v[176:179], a[128:131], a[160:163], v[176:179]
s_add_u32 m0, s29, 114688
s_nop 0
buffer_load_dwordx4 v6, s[12:15], s24 offen offset:0 lds
M v[176:179], a[132:135], a[164:167], v[176:179]
ds_read_b64_tr_b16 a[76:77], v17 offset:16384
ds_read_b64_tr_b16 a[78:79], v17 offset:18432
M v[180:183], a[140:143], a[164:167], v[180:183]
M v[180:183], a[136:139], a[160:163], v[180:183]
M v[184:187], a[144:147], a[160:163], v[184:187]
M v[184:187], a[148:151], a[164:167], v[184:187]
buffer_load_dwordx4 v7, s[12:15], s24 offen offset:1024 lds
M v[188:191], a[156:159], a[164:167], v[188:191]
M v[188:191], a[152:155], a[160:163], v[188:191]
s_waitcnt lgkmcnt(12)
ds_read_b64_tr_b16 a[84:85], v18 offset:16384
ds_read_b64_tr_b16 a[86:87], v18 offset:18432
M v[192:195], a[96:99], a[168:171], v[192:195]
M v[192:195], a[100:103], a[172:175], v[192:195]
ds_read_b128 a[184:187], v10 offset:55296
ds_read_b128 a[188:191], v11 offset:55296
M v[196:199], a[108:111], a[172:175], v[196:199]
M v[196:199], a[104:107], a[168:171], v[196:199]
M v[200:203], a[112:115], a[168:171], v[200:203]
buffer_load_dwordx4 v8, s[12:15], s24 offen offset:2048 lds
M v[200:203], a[116:119], a[172:175], v[200:203]
ds_read_b64_tr_b16 a[92:93], v19 offset:16384
ds_read_b64_tr_b16 a[94:95], v19 offset:18432
M v[204:207], a[124:127], a[172:175], v[204:207]
M v[204:207], a[120:123], a[168:171], v[204:207]
M v[208:211], a[128:131], a[168:171], v[208:211]
M v[208:211], a[132:135], a[172:175], v[208:211]
M v[212:215], a[140:143], a[172:175], v[212:215]
buffer_load_dwordx4 v9, s[12:15], s24 offen offset:3072 lds
M v[212:215], a[136:139], a[168:171], v[212:215]
M v[216:219], a[144:147], a[168:171], v[216:219]
M v[216:219], a[148:151], a[172:175], v[216:219]
M v[220:223], a[156:159], a[172:175], v[220:223]
M v[220:223], a[152:155], a[168:171], v[220:223]
s_waitcnt lgkmcnt(10)
M v[224:227], a[96:99], a[176:179], v[224:227]
s_add_u32 s24, s24, 262144
s_cmp_eq_u32 s24, s27
s_cselect_b32 s24, s28, s24
s_sub_u32 s6, s6, 1
s_cmp_eq_u32 s6, 0
s_cselect_b64 s[12:13], s[64:65], s[12:13]
M v[224:227], a[100:103], a[180:183], v[224:227]
M v[228:231], a[108:111], a[180:183], v[228:231]
M v[228:231], a[104:107], a[176:179], v[228:231]
M v[232:235], a[112:115], a[176:179], v[232:235]
M v[232:235], a[116:119], a[180:183], v[232:235]
M v[236:239], a[124:127], a[180:183], v[236:239]
M v[236:239], a[120:123], a[176:179], v[236:239]
s_waitcnt vmcnt(8) lgkmcnt(0)
s_barrier
ds_read_b128 a[160:163], v10 offset:0
ds_read_b128 a[164:167], v11 offset:0
M v[240:243], a[128:131], a[176:179], v[240:243]
s_add_u32 m0, s29, 32768
s_nop 0
buffer_load_dwordx4 v2, s[8:11], s23 offen offset:0 lds
M v[240:243], a[132:135], a[180:183], v[240:243]
M v[244:247], a[140:143], a[180:183], v[244:247]
M v[244:247], a[136:139], a[176:179], v[244:247]
M v[248:251], a[144:147], a[176:179], v[248:251]
M v[248:251], a[148:151], a[180:183], v[248:251]
buffer_load_dwordx4 v3, s[8:11], s23 offen offset:1024 lds
M v[252:255], a[156:159], a[180:183], v[252:255]
M v[252:255], a[152:155], a[176:179], v[252:255]
M a[0:3], a[96:99], a[184:187], a[0:3]
M a[0:3], a[100:103], a[188:191], a[0:3]
ds_read_b128 a[168:171], v10 offset:2048
ds_read_b128 a[172:175], v11 offset:2048
M a[4:7], a[108:111], a[188:191], a[4:7]
M a[4:7], a[104:107], a[184:187], a[4:7]
M a[8:11], a[112:115], a[184:187], a[8:11]
buffer_load_dwordx4 v4, s[8:11], s23 offen offset:2048 lds
M a[8:11], a[116:119], a[188:191], a[8:11]
M a[12:15], a[124:127], a[188:191], a[12:15]
M a[12:15], a[120:123], a[184:187], a[12:15]
M a[16:19], a[128:131], a[184:187], a[16:19]
M a[16:19], a[132:135], a[188:191], a[16:19]
buffer_load_dwordx4 v5, s[8:11], s23 offen offset:3072 lds
M a[20:23], a[140:143], a[188:191], a[20:23]
M a[20:23], a[136:139], a[184:187], a[20:23]
M a[24:27], a[144:147], a[184:187], a[24:27]
M a[24:27], a[148:151], a[188:191], a[24:27]
M a[28:31], a[156:159], a[188:191], a[28:31]
M a[28:31], a[152:155], a[184:187], a[28:31]
s_waitcnt lgkmcnt(2)
s_sub_u32 s30, s30, 1
s_cmp_lg_u32 s30, 0
s_cbranch_scc1 Lk1_kl
M v[32:35], a[32:35], a[160:163], v[32:35]
s_add_u32 m0, s29, 65536
s_nop 0
buffer_load_dwordx4 v6, s[12:15], s24 offen offset:0 lds
M v[32:35], a[36:39], a[164:167], v[32:35]
ds_read_b128 a[176:179], v10 offset:4096
ds_read_b128 a[180:183], v11 offset:4096
M v[36:39], a[44:47], a[164:167], v[36:39]
M v[36:39], a[40:43], a[160:163], v[36:39]
ds_read_b64_tr_b16 a[96:97], v12 offset:32768
ds_read_b64_tr_b16 a[98:99], v12 offset:34816
M v[40:43], a[48:51], a[160:163], v[40:43]
M v[40:43], a[52:55], a[164:167], v[40:43]
M v[44:47], a[60:63], a[164:167], v[44:47]
M v[44:47], a[56:59], a[160:163], v[44:47]
ds_read_b64_tr_b16 a[104:105], v13 offset:32768
ds_read_b64_tr_b16 a[106:107], v13 offset:34816
M v[48:51], a[64:67], a[160:163], v[48:51]
buffer_load_dwordx4 v7, s[12:15], s24 offen offset:1024 lds
M v[48:51], a[68:71], a[164:167], v[48:51]
M v[52:55], a[76:79], a[164:167], v[52:55]
M v[52:55], a[72:75], a[160:163], v[52:55]
ds_read_b64_tr_b16 a[112:113], v14 offset:32768
ds_read_b64_tr_b16 a[114:115], v14 offset:34816
M v[56:59], a[80:83], a[160:163], v[56:59]
M v[56:59], a[84:87], a[164:167], v[56:59]
M v[60:63], a[92:95], a[164:167], v[60:63]
buffer_load_dwordx4 v8, s[12:15], s24 offen offset:2048 lds
M v[60:63], a[88:91], a[160:163], v[60:63]
s_waitcnt lgkmcnt(8)
ds_read_b64_tr_b16 a[120:121], v15 offset:32768
ds_read_b64_tr_b16 a[122:123], v15 offset:34816
M v[64:67], a[32:35], a[168:171], v[64:67]
M v[64:67], a[36:39], a[172:175], v[64:67]
ds_read_b128 a[184:187], v10 offset:6144
ds_read_b128 a[188:191], v11 offset:6144
M v[68:71], a[44:47], a[172:175], v[68:71]
M v[68:71], a[40:43], a[168:171], v[68:71]
ds_read_b64_tr_b16 a[128:129], v16 offset:32768
ds_read_b64_tr_b16 a[130:131], v16 offset:34816
M v[72:75], a[48:51], a[168:171], v[72:75]
M v[72:75], a[52:55], a[172:175], v[72:75]
M v[76:79], a[60:63], a[172:175], v[76:79]
M v[76:79], a[56:59], a[168:171], v[76:79]
ds_read_b64_tr_b16 a[136:137], v17 offset:32768
ds_read_b64_tr_b16 a[138:139], v17 offset:34816
M v[80:83], a[64:67], a[168:171], v[80:83]
buffer_load_dwordx4 v9, s[12:15], s24 offen offset:3072 lds
M v[80:83], a[68:71], a[172:175], v[80:83]
M v[84:87], a[76:79], a[172:175], v[84:87]
M v[84:87], a[72:75], a[168:171], v[84:87]
ds_read_b64_tr_b16 a[144:145], v18 offset:32768
ds_read_b64_tr_b16 a[146:147], v18 offset:34816
M v[88:91], a[80:83], a[168:171], v[88:91]
M v[88:91], a[84:87], a[172:175], v[88:91]
M v[92:95], a[92:95], a[172:175], v[92:95]
s_add_u32 s24, s24, 262144
M v[92:95], a[88:91], a[168:171], v[92:95]
s_waitcnt lgkmcnt(15)
ds_read_b64_tr_b16 a[152:153], v19 offset:32768
ds_read_b64_tr_b16 a[154:155], v19 offset:34816
M v[96:99], a[32:35], a[176:179], v[96:99]
M v[96:99], a[36:39], a[180:183], v[96:99]
M v[100:103], a[44:47], a[180:183], v[100:103]
M v[100:103], a[40:43], a[176:179], v[100:103]
M v[104:107], a[48:51], a[176:179], v[104:107]
M v[104:107], a[52:55], a[180:183], v[104:107]
M v[108:111], a[60:63], a[180:183], v[108:111]
M v[108:111], a[56:59], a[176:179], v[108:111]
s_waitcnt vmcnt(8) lgkmcnt(0)
s_barrier
ds_read_b128 a[160:163], v10 offset:16384
ds_read_b128 a[164:167], v11 offset:16384
M v[112:115], a[64:67], a[176:179], v[112:115]
s_add_u32 m0, s29, 49152
s_add_u32 s3, s23, s31
buffer_load_dwordx4 v2, s[8:11], s3 offen offset:0 lds
M v[112:115], a[68:71], a[180:183], v[112:115]
M v[116:119], a[76:79], a[180:183], v[116:119]
M v[116:119], a[72:75], a[176:179], v[116:119]
ds_read_b64_tr_b16 a[100:101], v12 offset:49152
ds_read_b64_tr_b16 a[102:103], v12 offset:51200
M v[120:123], a[80:83], a[176:179], v[120:123]
M v[120:123], a[84:87], a[180:183], v[120:123]
buffer_load_dwordx4 v3, s[8:11], s3 offen offset:1024 lds
M v[124:127], a[92:95], a[180:183], v[124:127]
M v[124:127], a[88:91], a[176:179], v[124:127]
M v[128:131], a[32:35], a[184:187], v[128:131]
M v[128:131], a[36:39], a[188:191], v[128:131]
ds_read_b128 a[168:171], v10 offset:18432
ds_read_b128 a[172:175], v11 offset:18432
ds_read_b64_tr_b16 a[108:109], v13 offset:49152
ds_read_b64_tr_b16 a[110:111], v13 offset:51200
M v[132:135], a[44:47], a[188:191], v[132:135]
M v[132:135], a[40:43], a[184:187], v[132:135]
M v[136:139], a[48:51], a[184:187], v[136:139]
buffer_load_dwordx4 v4, s[8:11], s3 offen offset:2048 lds
M v[136:139], a[52:55], a[188:191], v[136:139]
M v[140:143], a[60:63], a[188:191], v[140:143]
M v[140:143], a[56:59], a[184:187], v[140:143]
ds_read_b64_tr_b16 a[116:117], v14 offset:49152
ds_read_b64_tr_b16 a[118:119], v14 offset:51200
M v[144:147], a[64:67], a[184:187], v[144:147]
M v[144:147], a[68:71], a[188:191], v[144:147]
M v[148:151], a[76:79], a[188:191], v[148:151]
buffer_load_dwordx4 v5, s[8:11], s3 offen offset:3072 lds
M v[148:151], a[72:75], a[184:187], v[148:151]
M v[152:155], a[80:83], a[184:187], v[152:155]
s_lshr_b32 s95, s53, 7
s_add_u32 s95, s95, s22
M v[152:155], a[84:87], a[188:191], v[152:155]
ds_read_b64_tr_b16 a[124:125], v15 offset:49152
ds_read_b64_tr_b16 a[126:127], v15 offset:51200
s_lshl_b32 s95, s95, 5
s_lshr_b32 s19, s52, 6
M v[156:159], a[92:95], a[188:191], v[156:159]
s_add_u32 s95, s95, s19
s_lshl_b32 s19, s21, 1
M v[156:159], a[88:91], a[184:187], v[156:159]
s_waitcnt lgkmcnt(10)
s_add_u32 s95, s95, s19
s_lshl_b32 s92, s95, 15
M v[160:163], a[32:35], a[160:163], v[160:163]
s_add_u32 s93, s92, 32768
s_add_u32 s16, s50, 16777216
M v[160:163], a[36:39], a[164:167], v[160:163]
ds_read_b128 a[176:179], v10 offset:20480
ds_read_b128 a[180:183], v11 offset:20480
s_addc_u32 s17, s51, 0
s_mov_b32 s18, 33554432
M v[164:167], a[44:47], a[164:167], v[164:167]
s_add_u32 s23, s23, 128
s_cmp_eq_u32 s23, s25
s_cselect_b32 s23, s26, s23
s_mov_b32 s19, 0x00020000
M v[164:167], a[40:43], a[160:163], v[164:167]
ds_read_b64_tr_b16 a[132:133], v16 offset:49152
ds_read_b64_tr_b16 a[134:135], v16 offset:51200
M v[168:171], a[48:51], a[160:163], v[168:171]
M v[168:171], a[52:55], a[164:167], v[168:171]
M v[172:175], a[60:63], a[164:167], v[172:175]
M v[172:175], a[56:59], a[160:163], v[172:175]
M v[176:179], a[64:67], a[160:163], v[176:179]
s_add_u32 m0, s29, 81920
s_nop 0
buffer_load_dwordx4 v6, s[12:15], s24 offen offset:0 lds
M v[176:179], a[68:71], a[164:167], v[176:179]
ds_read_b64_tr_b16 a[140:141], v17 offset:49152
ds_read_b64_tr_b16 a[142:143], v17 offset:51200
M v[180:183], a[76:79], a[164:167], v[180:183]
M v[180:183], a[72:75], a[160:163], v[180:183]
M v[184:187], a[80:83], a[160:163], v[184:187]
M v[184:187], a[84:87], a[164:167], v[184:187]
buffer_load_dwordx4 v7, s[12:15], s24 offen offset:1024 lds
M v[188:191], a[92:95], a[164:167], v[188:191]
M v[188:191], a[88:91], a[160:163], v[188:191]
s_waitcnt lgkmcnt(12)
ds_read_b64_tr_b16 a[148:149], v18 offset:49152
ds_read_b64_tr_b16 a[150:151], v18 offset:51200
M v[192:195], a[32:35], a[168:171], v[192:195]
M v[192:195], a[36:39], a[172:175], v[192:195]
ds_read_b128 a[184:187], v10 offset:22528
ds_read_b128 a[188:191], v11 offset:22528
M v[196:199], a[44:47], a[172:175], v[196:199]
M v[196:199], a[40:43], a[168:171], v[196:199]
M v[200:203], a[48:51], a[168:171], v[200:203]
buffer_load_dwordx4 v8, s[12:15], s24 offen offset:2048 lds
M v[200:203], a[52:55], a[172:175], v[200:203]
ds_read_b64_tr_b16 a[156:157], v19 offset:49152
ds_read_b64_tr_b16 a[158:159], v19 offset:51200
M v[204:207], a[60:63], a[172:175], v[204:207]
M v[204:207], a[56:59], a[168:171], v[204:207]
M v[208:211], a[64:67], a[168:171], v[208:211]
M v[208:211], a[68:71], a[172:175], v[208:211]
M v[212:215], a[76:79], a[172:175], v[212:215]
buffer_load_dwordx4 v9, s[12:15], s24 offen offset:3072 lds
M v[212:215], a[72:75], a[168:171], v[212:215]
M v[216:219], a[80:83], a[168:171], v[216:219]
M v[216:219], a[84:87], a[172:175], v[216:219]
M v[220:223], a[92:95], a[172:175], v[220:223]
M v[220:223], a[88:91], a[168:171], v[220:223]
s_waitcnt lgkmcnt(10)
M v[224:227], a[32:35], a[176:179], v[224:227]
s_add_u32 s24, s24, 262144
s_cmp_eq_u32 s24, s27
s_cselect_b32 s24, s28, s24
s_sub_u32 s6, s6, 1
s_cmp_eq_u32 s6, 0
s_cselect_b64 s[12:13], s[64:65], s[12:13]
M v[224:227], a[36:39], a[180:183], v[224:227]
M v[228:231], a[44:47], a[180:183], v[228:231]
M v[228:231], a[40:43], a[176:179], v[228:231]
M v[232:235], a[48:51], a[176:179], v[232:235]
M v[232:235], a[52:55], a[180:183], v[232:235]
M v[236:239], a[60:63], a[180:183], v[236:239]
M v[236:239], a[56:59], a[176:179], v[236:239]
s_waitcnt vmcnt(8) lgkmcnt(0)
s_barrier
ds_read_b128 a[160:163], v10 offset:32768
ds_read_b128 a[164:167], v11 offset:32768
M v[240:243], a[64:67], a[176:179], v[240:243]
s_add_u32 m0, s29, 0
s_nop 0
buffer_load_dwordx4 v2, s[8:11], s23 offen offset:0 lds
M v[240:243], a[68:71], a[180:183], v[240:243]
M v[244:247], a[76:79], a[180:183], v[244:247]
M v[244:247], a[72:75], a[176:179], v[244:247]
M v[248:251], a[80:83], a[176:179], v[248:251]
M v[248:251], a[84:87], a[180:183], v[248:251]
buffer_load_dwordx4 v3, s[8:11], s23 offen offset:1024 lds
M v[252:255], a[92:95], a[180:183], v[252:255]
M v[252:255], a[88:91], a[176:179], v[252:255]
M a[0:3], a[32:35], a[184:187], a[0:3]
M a[0:3], a[36:39], a[188:191], a[0:3]
ds_read_b128 a[168:171], v10 offset:34816
ds_read_b128 a[172:175], v11 offset:34816
M a[4:7], a[44:47], a[188:191], a[4:7]
M a[4:7], a[40:43], a[184:187], a[4:7]
M a[8:11], a[48:51], a[184:187], a[8:11]
buffer_load_dwordx4 v4, s[8:11], s23 offen offset:2048 lds
M a[8:11], a[52:55], a[188:191], a[8:11]
M a[12:15], a[60:63], a[188:191], a[12:15]
M a[12:15], a[56:59], a[184:187], a[12:15]
M a[16:19], a[64:67], a[184:187], a[16:19]
M a[16:19], a[68:71], a[188:191], a[16:19]
buffer_load_dwordx4 v5, s[8:11], s23 offen offset:3072 lds
M a[20:23], a[76:79], a[188:191], a[20:23]
M a[20:23], a[72:75], a[184:187], a[20:23]
M a[24:27], a[80:83], a[184:187], a[24:27]
M a[24:27], a[84:87], a[188:191], a[24:27]
M a[28:31], a[92:95], a[188:191], a[28:31]
M a[28:31], a[88:91], a[184:187], a[28:31]
s_waitcnt lgkmcnt(2)
M v[32:35], a[96:99], a[160:163], v[32:35]
s_add_u32 m0, s29, 98304
s_nop 0
buffer_load_dwordx4 v6, s[12:15], s24 offen offset:0 lds
M v[32:35], a[100:103], a[164:167], v[32:35]
ds_read_b128 a[176:179], v10 offset:36864
ds_read_b128 a[180:183], v11 offset:36864
M v[36:39], a[108:111], a[164:167], v[36:39]
M v[36:39], a[104:107], a[160:163], v[36:39]
ds_read_b64_tr_b16 a[32:33], v12 offset:0
ds_read_b64_tr_b16 a[34:35], v12 offset:2048
M v[40:43], a[112:115], a[160:163], v[40:43]
M v[40:43], a[116:119], a[164:167], v[40:43]
M v[44:47], a[124:127], a[164:167], v[44:47]
M v[44:47], a[120:123], a[160:163], v[44:47]
ds_read_b64_tr_b16 a[40:41], v13 offset:0
ds_read_b64_tr_b16 a[42:43], v13 offset:2048
M v[48:51], a[128:131], a[160:163], v[48:51]
buffer_load_dwordx4 v7, s[12:15], s24 offen offset:1024 lds
M v[48:51], a[132:135], a[164:167], v[48:51]
M v[52:55], a[140:143], a[164:167], v[52:55]
M v[52:55], a[136:139], a[160:163], v[52:55]
ds_read_b64_tr_b16 a[48:49], v14 offset:0
ds_read_b64_tr_b16 a[50:51], v14 offset:2048
M v[56:59], a[144:147], a[160:163], v[56:59]
M v[56:59], a[148:151], a[164:167], v[56:59]
M v[60:63], a[156:159], a[164:167], v[60:63]
buffer_load_dwordx4 v8, s[12:15], s24 offen offset:2048 lds
M v[60:63], a[152:155], a[160:163], v[60:63]
s_waitcnt lgkmcnt(8)
ds_read_b64_tr_b16 a[56:57], v15 offset:0
ds_read_b64_tr_b16 a[58:59], v15 offset:2048
M v[64:67], a[96:99], a[168:171], v[64:67]
M v[64:67], a[100:103], a[172:175], v[64:67]
ds_read_b128 a[184:187], v10 offset:38912
ds_read_b128 a[188:191], v11 offset:38912
M v[68:71], a[108:111], a[172:175], v[68:71]
M v[68:71], a[104:107], a[168:171], v[68:71]
ds_read_b64_tr_b16 a[64:65], v16 offset:0
ds_read_b64_tr_b16 a[66:67], v16 offset:2048
v_cvt_pk_bf16_f32 v32, v32, v33
v_cvt_pk_bf16_f32 v33, v34, v35
M v[72:75], a[112:115], a[168:171], v[72:75]
v_cvt_pk_bf16_f32 v34, v36, v37
v_cvt_pk_bf16_f32 v35, v38, v39
M v[72:75], a[116:119], a[172:175], v[72:75]
v_cvt_pk_bf16_f32 v40, v40, v41
v_cvt_pk_bf16_f32 v41, v42, v43
M v[76:79], a[124:127], a[172:175], v[76:79]
buffer_load_dwordx4 v9, s[12:15], s24 offen offset:3072 lds
v_cvt_pk_bf16_f32 v42, v44, v45
v_cvt_pk_bf16_f32 v43, v46, v47
M v[76:79], a[120:123], a[168:171], v[76:79]
ds_read_b64_tr_b16 a[72:73], v17 offset:0
ds_read_b64_tr_b16 a[74:75], v17 offset:2048
v_cvt_pk_bf16_f32 v48, v48, v49
v_cvt_pk_bf16_f32 v49, v50, v51
M v[80:83], a[128:131], a[168:171], v[80:83]
v_cvt_pk_bf16_f32 v50, v52, v53
v_cvt_pk_bf16_f32 v51, v54, v55
M v[80:83], a[132:135], a[172:175], v[80:83]
v_cvt_pk_bf16_f32 v56, v56, v57
v_cvt_pk_bf16_f32 v57, v58, v59
M v[84:87], a[140:143], a[172:175], v[84:87]
v_cvt_pk_bf16_f32 v58, v60, v61
v_cvt_pk_bf16_f32 v59, v62, v63
M v[84:87], a[136:139], a[168:171], v[84:87]
ds_read_b64_tr_b16 a[80:81], v18 offset:0
ds_read_b64_tr_b16 a[82:83], v18 offset:2048
M v[88:91], a[144:147], a[168:171], v[88:91]
M v[88:91], a[148:151], a[172:175], v[88:91]
s_add_u32 s24, s24, 262144
M v[92:95], a[156:159], a[172:175], v[92:95]
s_add_u32 s94, s92, 0
buffer_store_dwordx4 v[32:35], v1, s[16:19], s94 offen offset:0 sc1
M v[92:95], a[152:155], a[168:171], v[92:95]
s_waitcnt lgkmcnt(15)
ds_read_b64_tr_b16 a[88:89], v19 offset:0
ds_read_b64_tr_b16 a[90:91], v19 offset:2048
M v[96:99], a[96:99], a[176:179], v[96:99]
M v[96:99], a[100:103], a[180:183], v[96:99]
M v[100:103], a[108:111], a[180:183], v[100:103]
M v[100:103], a[104:107], a[176:179], v[100:103]
v_cvt_pk_bf16_f32 v64, v64, v65
v_cvt_pk_bf16_f32 v65, v66, v67
M v[104:107], a[112:115], a[176:179], v[104:107]
v_cvt_pk_bf16_f32 v66, v68, v69
v_cvt_pk_bf16_f32 v67, v70, v71
M v[104:107], a[116:119], a[180:183], v[104:107]
v_cvt_pk_bf16_f32 v72, v72, v73
v_cvt_pk_bf16_f32 v73, v74, v75
M v[108:111], a[124:127], a[180:183], v[108:111]
v_cvt_pk_bf16_f32 v74, v76, v77
v_cvt_pk_bf16_f32 v75, v78, v79
M v[108:111], a[120:123], a[176:179], v[108:111]
s_waitcnt vmcnt(9) lgkmcnt(0)
s_barrier
ds_read_b128 a[160:163], v10 offset:49152
ds_read_b128 a[164:167], v11 offset:49152
v_cvt_pk_bf16_f32 v80, v80, v81
v_cvt_pk_bf16_f32 v81, v82, v83
M v[112:115], a[128:131], a[176:179], v[112:115]
s_add_u32 s94, s92, 0
buffer_store_dwordx4 v[40:43], v1, s[16:19], s94 offen offset:1024 sc1
v_cvt_pk_bf16_f32 v82, v84, v85
v_cvt_pk_bf16_f32 v83, v86, v87
M v[112:115], a[132:135], a[180:183], v[112:115]
s_add_u32 m0, s29, 16384
s_add_u32 s3, s23, s31
buffer_load_dwordx4 v2, s[8:11], s3 offen offset:0 lds
v_cvt_pk_bf16_f32 v88, v88, v89
v_cvt_pk_bf16_f32 v89, v90, v91
M v[116:119], a[140:143], a[180:183], v[116:119]
v_cvt_pk_bf16_f32 v90, v92, v93
v_cvt_pk_bf16_f32 v91, v94, v95
M v[116:119], a[136:139], a[176:179], v[116:119]
ds_read_b64_tr_b16 a[36:37], v12 offset:16384
ds_read_b64_tr_b16 a[38:39], v12 offset:18432
M v[120:123], a[144:147], a[176:179], v[120:123]
M v[120:123], a[148:151], a[180:183], v[120:123]
M v[124:127], a[156:159], a[180:183], v[124:127]
buffer_load_dwordx4 v3, s[8:11], s3 offen offset:1024 lds
M v[124:127], a[152:155], a[176:179], v[124:127]
M v[128:131], a[96:99], a[184:187], v[128:131]
M v[128:131], a[100:103], a[188:191], v[128:131]
ds_read_b128 a[168:171], v10 offset:51200
ds_read_b128 a[172:175], v11 offset:51200
ds_read_b64_tr_b16 a[44:45], v13 offset:16384
ds_read_b64_tr_b16 a[46:47], v13 offset:18432
M v[132:135], a[108:111], a[188:191], v[132:135]
M v[132:135], a[104:107], a[184:187], v[132:135]
s_add_u32 s94, s92, 0
buffer_store_dwordx4 v[48:51], v1, s[16:19], s94 offen offset:2048 sc1
v_cvt_pk_bf16_f32 v96, v96, v97
v_cvt_pk_bf16_f32 v97, v98, v99
M v[136:139], a[112:115], a[184:187], v[136:139]
v_cvt_pk_bf16_f32 v98, v100, v101
v_cvt_pk_bf16_f32 v99, v102, v103
M v[136:139], a[116:119], a[188:191], v[136:139]
buffer_load_dwordx4 v4, s[8:11], s3 offen offset:2048 lds
v_cvt_pk_bf16_f32 v104, v104, v105
v_cvt_pk_bf16_f32 v105, v106, v107
M v[140:143], a[124:127], a[188:191], v[140:143]
v_cvt_pk_bf16_f32 v106, v108, v109
v_cvt_pk_bf16_f32 v107, v110, v111
M v[140:143], a[120:123], a[184:187], v[140:143]
ds_read_b64_tr_b16 a[52:53], v14 offset:16384
ds_read_b64_tr_b16 a[54:55], v14 offset:18432
v_cvt_pk_bf16_f32 v112, v112, v113
v_cvt_pk_bf16_f32 v113, v114, v115
M v[144:147], a[128:131], a[184:187], v[144:147]
v_cvt_pk_bf16_f32 v114, v116, v117
v_cvt_pk_bf16_f32 v115, v118, v119
M v[144:147], a[132:135], a[188:191], v[144:147]
v_cvt_pk_bf16_f32 v120, v120, v121
v_cvt_pk_bf16_f32 v121, v122, v123
M v[148:151], a[140:143], a[188:191], v[148:151]
buffer_load_dwordx4 v5, s[8:11], s3 offen offset:3072 lds
v_cvt_pk_bf16_f32 v122, v124, v125
v_cvt_pk_bf16_f32 v123, v126, v127
M v[148:151], a[136:139], a[184:187], v[148:151]
M v[152:155], a[144:147], a[184:187], v[152:155]
M v[152:155], a[148:151], a[188:191], v[152:155]
ds_read_b64_tr_b16 a[60:61], v15 offset:16384
ds_read_b64_tr_b16 a[62:63], v15 offset:18432
M v[156:159], a[156:159], a[188:191], v[156:159]
s_add_u32 s94, s92, 0
buffer_store_dwordx4 v[56:59], v1, s[16:19], s94 offen offset:3072 sc1
M v[156:159], a[152:155], a[184:187], v[156:159]
s_waitcnt lgkmcnt(10)
M v[160:163], a[96:99], a[160:163], v[160:163]
M v[160:163], a[100:103], a[164:167], v[160:163]
ds_read_b128 a[176:179], v10 offset:53248
ds_read_b128 a[180:183], v11 offset:53248
M v[164:167], a[108:111], a[164:167], v[164:167]
s_add_u32 s23, s23, 128
s_cmp_eq_u32 s23, s25
s_cselect_b32 s23, s26, s23
M v[164:167], a[104:107], a[160:163], v[164:167]
ds_read_b64_tr_b16 a[68:69], v16 offset:16384
ds_read_b64_tr_b16 a[70:71], v16 offset:18432
v_cvt_pk_bf16_f32 v128, v128, v129
v_cvt_pk_bf16_f32 v129, v130, v131
M v[168:171], a[112:115], a[160:163], v[168:171]
v_cvt_pk_bf16_f32 v130, v132, v133
v_cvt_pk_bf16_f32 v131, v134, v135
M v[168:171], a[116:119], a[164:167], v[168:171]
v_cvt_pk_bf16_f32 v136, v136, v137
v_cvt_pk_bf16_f32 v137, v138, v139
M v[172:175], a[124:127], a[164:167], v[172:175]
v_cvt_pk_bf16_f32 v138, v140, v141
v_cvt_pk_bf16_f32 v139, v142, v143
M v[172:175], a[120:123], a[160:163], v[172:175]
v_cvt_pk_bf16_f32 v144, v144, v145
v_cvt_pk_bf16_f32 v145, v146, v147
M v[176:179], a[128:131], a[160:163], v[176:179]
s_add_u32 s94, s92, 4096
buffer_store_dwordx4 v[64:67], v1, s[16:19], s94 offen offset:0 sc1
v_cvt_pk_bf16_f32 v146, v148, v149
v_cvt_pk_bf16_f32 v147, v150, v151
M v[176:179], a[132:135], a[164:167], v[176:179]
ds_read_b64_tr_b16 a[76:77], v17 offset:16384
ds_read_b64_tr_b16 a[78:79], v17 offset:18432
v_cvt_pk_bf16_f32 v152, v152, v153
v_cvt_pk_bf16_f32 v153, v154, v155
M v[180:183], a[140:143], a[164:167], v[180:183]
s_add_u32 m0, s29, 114688
s_nop 0
buffer_load_dwordx4 v6, s[12:15], s24 offen offset:0 lds
v_cvt_pk_bf16_f32 v154, v156, v157
v_cvt_pk_bf16_f32 v155, v158, v159
M v[180:183], a[136:139], a[160:163], v[180:183]
M v[184:187], a[144:147], a[160:163], v[184:187]
v_accvgpr_write_b32 a192, v128
v_accvgpr_write_b32 a193, v129
v_accvgpr_write_b32 a194, v130
v_accvgpr_write_b32 a195, v131
M v[184:187], a[148:151], a[164:167], v[184:187]
v_accvgpr_write_b32 a196, v136
v_accvgpr_write_b32 a197, v137
v_accvgpr_write_b32 a198, v138
v_accvgpr_write_b32 a199, v139
M v[188:191], a[156:159], a[164:167], v[188:191]
buffer_load_dwordx4 v7, s[12:15], s24 offen offset:1024 lds
v_accvgpr_write_b32 a200, v144
v_accvgpr_write_b32 a201, v145
v_accvgpr_write_b32 a202, v146
v_accvgpr_write_b32 a203, v147
M v[188:191], a[152:155], a[160:163], v[188:191]
s_waitcnt lgkmcnt(12)
ds_read_b64_tr_b16 a[84:85], v18 offset:16384
ds_read_b64_tr_b16 a[86:87], v18 offset:18432
v_accvgpr_write_b32 a204, v152
v_accvgpr_write_b32 a205, v153
v_accvgpr_write_b32 a206, v154
v_accvgpr_write_b32 a207, v155
M v[192:195], a[96:99], a[168:171], v[192:195]
M v[192:195], a[100:103], a[172:175], v[192:195]
ds_read_b128 a[184:187], v10 offset:55296
ds_read_b128 a[188:191], v11 offset:55296
M v[196:199], a[108:111], a[172:175], v[196:199]
s_add_u32 s94, s92, 4096
buffer_store_dwordx4 v[72:75], v1, s[16:19], s94 offen offset:1024 sc1
M v[196:199], a[104:107], a[168:171], v[196:199]
v_cvt_pk_bf16_f32 v160, v160, v161
v_cvt_pk_bf16_f32 v161, v162, v163
M v[200:203], a[112:115], a[168:171], v[200:203]
v_cvt_pk_bf16_f32 v162, v164, v165
v_cvt_pk_bf16_f32 v163, v166, v167
M v[200:203], a[116:119], a[172:175], v[200:203]
ds_read_b64_tr_b16 a[92:93], v19 offset:16384
ds_read_b64_tr_b16 a[94:95], v19 offset:18432
v_cvt_pk_bf16_f32 v168, v168, v169
v_cvt_pk_bf16_f32 v169, v170, v171
M v[204:207], a[124:127], a[172:175], v[204:207]
buffer_load_dwordx4 v8, s[12:15], s24 offen offset:2048 lds
v_cvt_pk_bf16_f32 v170, v172, v173
v_cvt_pk_bf16_f32 v171, v174, v175
M v[204:207], a[120:123], a[168:171], v[204:207]
v_cvt_pk_bf16_f32 v176, v176, v177
v_cvt_pk_bf16_f32 v177, v178, v179
M v[208:211], a[128:131], a[168:171], v[208:211]
v_cvt_pk_bf16_f32 v178, v180, v181
v_cvt_pk_bf16_f32 v179, v182, v183
M v[208:211], a[132:135], a[172:175], v[208:211]
v_cvt_pk_bf16_f32 v184, v184, v185
v_cvt_pk_bf16_f32 v185, v186, v187
M v[212:215], a[140:143], a[172:175], v[212:215]
buffer_load_dwordx4 v9, s[12:15], s24 offen offset:3072 lds
v_cvt_pk_bf16_f32 v186, v188, v189
v_cvt_pk_bf16_f32 v187, v190, v191
M v[212:215], a[136:139], a[168:171], v[212:215]
M v[216:219], a[144:147], a[168:171], v[216:219]
v_accvgpr_write_b32 a208, v160
v_accvgpr_write_b32 a209, v161
v_accvgpr_write_b32 a210, v162
v_accvgpr_write_b32 a211, v163
M v[216:219], a[148:151], a[172:175], v[216:219]
s_add_u32 s94, s92, 4096
buffer_store_dwordx4 v[80:83], v1, s[16:19], s94 offen offset:2048 sc1
v_accvgpr_write_b32 a212, v168
v_accvgpr_write_b32 a213, v169
v_accvgpr_write_b32 a214, v170
v_accvgpr_write_b32 a215, v171
M v[220:223], a[156:159], a[172:175], v[220:223]
v_accvgpr_write_b32 a216, v176
v_accvgpr_write_b32 a217, v177
v_accvgpr_write_b32 a218, v178
v_accvgpr_write_b32 a219, v179
M v[220:223], a[152:155], a[168:171], v[220:223]
s_waitcnt lgkmcnt(10)
v_accvgpr_write_b32 a220, v184
v_accvgpr_write_b32 a221, v185
v_accvgpr_write_b32 a222, v186
v_accvgpr_write_b32 a223, v187
M v[224:227], a[96:99], a[176:179], v[224:227]
s_add_u32 s24, s24, 262144
s_cmp_eq_u32 s24, s27
s_cselect_b32 s24, s28, s24
s_sub_u32 s6, s6, 1
s_cmp_eq_u32 s6, 0
s_cselect_b64 s[12:13], s[64:65], s[12:13]
M v[224:227], a[100:103], a[180:183], v[224:227]
M v[228:231], a[108:111], a[180:183], v[228:231]
M v[228:231], a[104:107], a[176:179], v[228:231]
v_cvt_pk_bf16_f32 v192, v192, v193
v_cvt_pk_bf16_f32 v193, v194, v195
M v[232:235], a[112:115], a[176:179], v[232:235]
v_cvt_pk_bf16_f32 v194, v196, v197
v_cvt_pk_bf16_f32 v195, v198, v199
M v[232:235], a[116:119], a[180:183], v[232:235]
v_cvt_pk_bf16_f32 v200, v200, v201
v_cvt_pk_bf16_f32 v201, v202, v203
M v[236:239], a[124:127], a[180:183], v[236:239]
v_cvt_pk_bf16_f32 v202, v204, v205
v_cvt_pk_bf16_f32 v203, v206, v207
M v[236:239], a[120:123], a[176:179], v[236:239]
s_waitcnt vmcnt(15) lgkmcnt(0)
s_barrier
ds_read_b128 a[160:163], v10 offset:0
ds_read_b128 a[164:167], v11 offset:0
v_cvt_pk_bf16_f32 v208, v208, v209
v_cvt_pk_bf16_f32 v209, v210, v211
M v[240:243], a[128:131], a[176:179], v[240:243]
s_add_u32 s94, s92, 4096
buffer_store_dwordx4 v[88:91], v1, s[16:19], s94 offen offset:3072 sc1
v_cvt_pk_bf16_f32 v210, v212, v213
v_cvt_pk_bf16_f32 v211, v214, v215
M v[240:243], a[132:135], a[180:183], v[240:243]
s_add_u32 m0, s29, 32768
s_nop 0
buffer_load_dwordx4 v2, s[8:11], s23 offen offset:0 lds
v_cvt_pk_bf16_f32 v216, v216, v217
v_cvt_pk_bf16_f32 v217, v218, v219
M v[244:247], a[140:143], a[180:183], v[244:247]
v_cvt_pk_bf16_f32 v218, v220, v221
v_cvt_pk_bf16_f32 v219, v222, v223
M v[244:247], a[136:139], a[176:179], v[244:247]
M v[248:251], a[144:147], a[176:179], v[248:251]
v_accvgpr_write_b32 a224, v192
v_accvgpr_write_b32 a225, v193
v_accvgpr_write_b32 a226, v194
v_accvgpr_write_b32 a227, v195
M v[248:251], a[148:151], a[180:183], v[248:251]
buffer_load_dwordx4 v3, s[8:11], s23 offen offset:1024 lds
v_accvgpr_write_b32 a228, v200
v_accvgpr_write_b32 a229, v201
v_accvgpr_write_b32 a230, v202
v_accvgpr_write_b32 a231, v203
M v[252:255], a[156:159], a[180:183], v[252:255]
v_accvgpr_write_b32 a232, v208
v_accvgpr_write_b32 a233, v209
v_accvgpr_write_b32 a234, v210
v_accvgpr_write_b32 a235, v211
M v[252:255], a[152:155], a[176:179], v[252:255]
v_accvgpr_write_b32 a236, v216
v_accvgpr_write_b32 a237, v217
v_accvgpr_write_b32 a238, v218
v_accvgpr_write_b32 a239, v219
M a[0:3], a[96:99], a[184:187], a[0:3]
M a[0:3], a[100:103], a[188:191], a[0:3]
ds_read_b128 a[168:171], v10 offset:2048
ds_read_b128 a[172:175], v11 offset:2048
M a[4:7], a[108:111], a[188:191], a[4:7]
s_add_u32 s94, s92, 8192
buffer_store_dwordx4 v[96:99], v1, s[16:19], s94 offen offset:0 sc1
M a[4:7], a[104:107], a[184:187], a[4:7]
v_cvt_pk_bf16_f32 v224, v224, v225
v_cvt_pk_bf16_f32 v225, v226, v227
M a[8:11], a[112:115], a[184:187], a[8:11]
v_cvt_pk_bf16_f32 v226, v228, v229
v_cvt_pk_bf16_f32 v227, v230, v231
M a[8:11], a[116:119], a[188:191], a[8:11]
buffer_load_dwordx4 v4, s[8:11], s23 offen offset:2048 lds
v_cvt_pk_bf16_f32 v232, v232, v233
v_cvt_pk_bf16_f32 v233, v234, v235
M a[12:15], a[124:127], a[188:191], a[12:15]
v_cvt_pk_bf16_f32 v234, v236, v237
v_cvt_pk_bf16_f32 v235, v238, v239
M a[12:15], a[120:123], a[184:187], a[12:15]
v_cvt_pk_bf16_f32 v240, v240, v241
v_cvt_pk_bf16_f32 v241, v242, v243
M a[16:19], a[128:131], a[184:187], a[16:19]
v_cvt_pk_bf16_f32 v242, v244, v245
v_cvt_pk_bf16_f32 v243, v246, v247
M a[16:19], a[132:135], a[188:191], a[16:19]
buffer_load_dwordx4 v5, s[8:11], s23 offen offset:3072 lds
v_cvt_pk_bf16_f32 v248, v248, v249
v_cvt_pk_bf16_f32 v249, v250, v251
M a[20:23], a[140:143], a[188:191], a[20:23]
v_cvt_pk_bf16_f32 v250, v252, v253
v_cvt_pk_bf16_f32 v251, v254, v255
M a[20:23], a[136:139], a[184:187], a[20:23]
M a[24:27], a[144:147], a[184:187], a[24:27]
s_add_u32 s94, s92, 8192
buffer_store_dwordx4 v[104:107], v1, s[16:19], s94 offen offset:1024 sc1
v_accvgpr_write_b32 a240, v224
v_accvgpr_write_b32 a241, v225
v_accvgpr_write_b32 a242, v226
v_accvgpr_write_b32 a243, v227
M a[24:27], a[148:151], a[188:191], a[24:27]
v_accvgpr_write_b32 a244, v232
v_accvgpr_write_b32 a245, v233
v_accvgpr_write_b32 a246, v234
v_accvgpr_write_b32 a247, v235
M a[28:31], a[156:159], a[188:191], a[28:31]
v_accvgpr_write_b32 a248, v240
v_accvgpr_write_b32 a249, v241
v_accvgpr_write_b32 a250, v242
v_accvgpr_write_b32 a251, v243
M a[28:31], a[152:155], a[184:187], a[28:31]
s_waitcnt lgkmcnt(2)
v_accvgpr_write_b32 a252, v248
v_accvgpr_write_b32 a253, v249
v_accvgpr_write_b32 a254, v250
v_accvgpr_write_b32 a255, v251
M v[32:35], a[160:163], a[32:35], 0
s_add_u32 m0, s29, 65536
s_nop 0
buffer_load_dwordx4 v6, s[12:15], s24 offen offset:0 lds
M v[32:35], a[164:167], a[36:39], v[32:35]
ds_read_b128 a[176:179], v10 offset:4096
ds_read_b128 a[180:183], v11 offset:4096
M v[36:39], a[164:167], a[44:47], 0
M v[36:39], a[160:163], a[40:43], v[36:39]
ds_read_b64_tr_b16 a[96:97], v12 offset:32768
ds_read_b64_tr_b16 a[98:99], v12 offset:34816
M v[40:43], a[160:163], a[48:51], 0
M v[40:43], a[164:167], a[52:55], v[40:43]
M v[44:47], a[164:167], a[60:63], 0
buffer_load_dwordx4 v7, s[12:15], s24 offen offset:1024 lds
M v[44:47], a[160:163], a[56:59], v[44:47]
ds_read_b64_tr_b16 a[104:105], v13 offset:32768
ds_read_b64_tr_b16 a[106:107], v13 offset:34816
M v[48:51], a[160:163], a[64:67], 0
s_add_u32 s94, s92, 8192
buffer_store_dwordx4 v[112:115], v1, s[16:19], s94 offen offset:2048 sc1
M v[48:51], a[164:167], a[68:71], v[48:51]
M v[52:55], a[164:167], a[76:79], 0
M v[52:55], a[160:163], a[72:75], v[52:55]
ds_read_b64_tr_b16 a[112:113], v14 offset:32768
ds_read_b64_tr_b16 a[114:115], v14 offset:34816
M v[56:59], a[160:163], a[80:83], 0
M v[56:59], a[164:167], a[84:87], v[56:59]
M v[60:63], a[164:167], a[92:95], 0
buffer_load_dwordx4 v8, s[12:15], s24 offen offset:2048 lds
M v[60:63], a[160:163], a[88:91], v[60:63]
s_waitcnt lgkmcnt(8)
ds_read_b64_tr_b16 a[120:121], v15 offset:32768
ds_read_b64_tr_b16 a[122:123], v15 offset:34816
M v[64:67], a[168:171], a[32:35], 0
M v[64:67], a[172:175], a[36:39], v[64:67]
ds_read_b128 a[184:187], v10 offset:6144
ds_read_b128 a[188:191], v11 offset:6144
M v[68:71], a[172:175], a[44:47], 0
s_add_u32 s94, s92, 8192
buffer_store_dwordx4 v[120:123], v1, s[16:19], s94 offen offset:3072 sc1
M v[68:71], a[168:171], a[40:43], v[68:71]
ds_read_b64_tr_b16 a[128:129], v16 offset:32768
ds_read_b64_tr_b16 a[130:131], v16 offset:34816
M v[72:75], a[168:171], a[48:51], 0
v_accvgpr_read_b32 v24, a0
v_accvgpr_read_b32 v25, a1
M v[72:75], a[172:175], a[52:55], v[72:75]
v_accvgpr_read_b32 v26, a2
v_accvgpr_read_b32 v27, a3
M v[76:79], a[172:175], a[60:63], 0
v_accvgpr_read_b32 v28, a4
v_accvgpr_read_b32 v29, a5
M v[76:79], a[168:171], a[56:59], v[76:79]
ds_read_b64_tr_b16 a[136:137], v17 offset:32768
ds_read_b64_tr_b16 a[138:139], v17 offset:34816
v_accvgpr_read_b32 v30, a6
v_accvgpr_read_b32 v31, a7
M v[80:83], a[168:171], a[64:67], 0
buffer_load_dwordx4 v9, s[12:15], s24 offen offset:3072 lds
v_cvt_pk_bf16_f32 v24, v24, v25
v_cvt_pk_bf16_f32 v25, v26, v27
M v[80:83], a[172:175], a[68:71], v[80:83]
v_cvt_pk_bf16_f32 v26, v28, v29
v_cvt_pk_bf16_f32 v27, v30, v31
M v[84:87], a[172:175], a[76:79], 0
M v[84:87], a[168:171], a[72:75], v[84:87]
ds_read_b64_tr_b16 a[144:145], v18 offset:32768
ds_read_b64_tr_b16 a[146:147], v18 offset:34816
M v[88:91], a[168:171], a[80:83], 0
M v[88:91], a[172:175], a[84:87], v[88:91]
s_add_u32 s94, s93, 12288
buffer_store_dwordx4 v[24:27], v1, s[16:19], s94 offen offset:0 sc1
M v[92:95], a[172:175], a[92:95], 0
M v[92:95], a[168:171], a[88:91], v[92:95]
s_waitcnt lgkmcnt(15)
ds_read_b64_tr_b16 a[152:153], v19 offset:32768
ds_read_b64_tr_b16 a[154:155], v19 offset:34816
M v[96:99], a[176:179], a[32:35], 0
s_add_u32 s24, s24, 262144
M v[96:99], a[180:183], a[36:39], v[96:99]
M v[100:103], a[180:183], a[44:47], 0
M v[100:103], a[176:179], a[40:43], v[100:103]
M v[104:107], a[176:179], a[48:51], 0
M v[104:107], a[180:183], a[52:55], v[104:107]
M v[108:111], a[180:183], a[60:63], 0
M v[108:111], a[176:179], a[56:59], v[108:111]
s_waitcnt vmcnt(15) lgkmcnt(0)
s_barrier
ds_read_b128 a[160:163], v10 offset:16384
ds_read_b128 a[164:167], v11 offset:16384
M v[112:115], a[176:179], a[64:67], 0
s_add_u32 m0, s29, 49152
s_add_u32 s3, s23, s31
buffer_load_dwordx4 v2, s[8:11], s3 offen offset:0 lds
M v[112:115], a[180:183], a[68:71], v[112:115]
M v[116:119], a[180:183], a[76:79], 0
M v[116:119], a[176:179], a[72:75], v[116:119]
ds_read_b64_tr_b16 a[100:101], v12 offset:49152
ds_read_b64_tr_b16 a[102:103], v12 offset:51200
M v[120:123], a[176:179], a[80:83], 0
v_accvgpr_read_b32 v24, a8
v_accvgpr_read_b32 v25, a9
M v[120:123], a[180:183], a[84:87], v[120:123]
buffer_load_dwordx4 v3, s[8:11], s3 offen offset:1024 lds
v_accvgpr_read_b32 v26, a10
v_accvgpr_read_b32 v27, a11
M v[124:127], a[180:183], a[92:95], 0
v_accvgpr_read_b32 v28, a12
v_accvgpr_read_b32 v29, a13
M v[124:127], a[176:179], a[88:91], v[124:127]
v_accvgpr_read_b32 v30, a14
v_accvgpr_read_b32 v31, a15
M v[128:131], a[184:187], a[32:35], 0
v_cvt_pk_bf16_f32 v24, v24, v25
v_cvt_pk_bf16_f32 v25, v26, v27
M v[128:131], a[188:191], a[36:39], v[128:131]
ds_read_b128 a[168:171], v10 offset:18432
ds_read_b128 a[172:175], v11 offset:18432
ds_read_b64_tr_b16 a[108:109], v13 offset:49152
ds_read_b64_tr_b16 a[110:111], v13 offset:51200
v_cvt_pk_bf16_f32 v26, v28, v29
v_cvt_pk_bf16_f32 v27, v30, v31
M v[132:135], a[188:191], a[44:47], 0
M v[132:135], a[184:187], a[40:43], v[132:135]
M v[136:139], a[184:187], a[48:51], 0
buffer_load_dwordx4 v4, s[8:11], s3 offen offset:2048 lds
M v[136:139], a[188:191], a[52:55], v[136:139]
s_add_u32 s94, s93, 12288
buffer_store_dwordx4 v[24:27], v1, s[16:19], s94 offen offset:1024 sc1
M v[140:143], a[188:191], a[60:63], 0
M v[140:143], a[184:187], a[56:59], v[140:143]
ds_read_b64_tr_b16 a[116:117], v14 offset:49152
ds_read_b64_tr_b16 a[118:119], v14 offset:51200
M v[144:147], a[184:187], a[64:67], 0
M v[144:147], a[188:191], a[68:71], v[144:147]
M v[148:151], a[188:191], a[76:79], 0
buffer_load_dwordx4 v5, s[8:11], s3 offen offset:3072 lds
M v[148:151], a[184:187], a[72:75], v[148:151]
M v[152:155], a[184:187], a[80:83], 0
M v[152:155], a[188:191], a[84:87], v[152:155]
ds_read_b64_tr_b16 a[124:125], v15 offset:49152
ds_read_b64_tr_b16 a[126:127], v15 offset:51200
M v[156:159], a[188:191], a[92:95], 0
M v[156:159], a[184:187], a[88:91], v[156:159]
s_waitcnt lgkmcnt(10)
M v[160:163], a[160:163], a[32:35], 0
M v[160:163], a[164:167], a[36:39], v[160:163]
ds_read_b128 a[176:179], v10 offset:20480
ds_read_b128 a[180:183], v11 offset:20480
M v[164:167], a[164:167], a[44:47], 0
s_add_u32 s23, s23, 128
s_cmp_eq_u32 s23, s25
s_cselect_b32 s23, s26, s23
M v[164:167], a[160:163], a[40:43], v[164:167]
ds_read_b64_tr_b16 a[132:133], v16 offset:49152
ds_read_b64_tr_b16 a[134:135], v16 offset:51200
M v[168:171], a[160:163], a[48:51], 0
v_accvgpr_read_b32 v24, a16
v_accvgpr_read_b32 v25, a17
M v[168:171], a[164:167], a[52:55], v[168:171]
v_accvgpr_read_b32 v26, a18
v_accvgpr_read_b32 v27, a19
M v[172:175], a[164:167], a[60:63], 0
v_accvgpr_read_b32 v28, a20
v_accvgpr_read_b32 v29, a21
M v[172:175], a[160:163], a[56:59], v[172:175]
v_accvgpr_read_b32 v30, a22
v_accvgpr_read_b32 v31, a23
M v[176:179], a[160:163], a[64:67], 0
s_add_u32 m0, s29, 81920
s_nop 0
buffer_load_dwordx4 v6, s[12:15], s24 offen offset:0 lds
v_cvt_pk_bf16_f32 v24, v24, v25
v_cvt_pk_bf16_f32 v25, v26, v27
M v[176:179], a[164:167], a[68:71], v[176:179]
ds_read_b64_tr_b16 a[140:141], v17 offset:49152
ds_read_b64_tr_b16 a[142:143], v17 offset:51200
v_cvt_pk_bf16_f32 v26, v28, v29
v_cvt_pk_bf16_f32 v27, v30, v31
M v[180:183], a[164:167], a[76:79], 0
M v[180:183], a[160:163], a[72:75], v[180:183]
M v[184:187], a[160:163], a[80:83], 0
M v[184:187], a[164:167], a[84:87], v[184:187]
s_add_u32 s94, s93, 12288
buffer_store_dwordx4 v[24:27], v1, s[16:19], s94 offen offset:2048 sc1
M v[188:191], a[164:167], a[92:95], 0
buffer_load_dwordx4 v7, s[12:15], s24 offen offset:1024 lds
M v[188:191], a[160:163], a[88:91], v[188:191]
s_waitcnt lgkmcnt(12)
ds_read_b64_tr_b16 a[148:149], v18 offset:49152
ds_read_b64_tr_b16 a[150:151], v18 offset:51200
M v[192:195], a[168:171], a[32:35], 0
M v[192:195], a[172:175], a[36:39], v[192:195]
ds_read_b128 a[184:187], v10 offset:22528
ds_read_b128 a[188:191], v11 offset:22528
M v[196:199], a[172:175], a[44:47], 0
M v[196:199], a[168:171], a[40:43], v[196:199]
M v[200:203], a[168:171], a[48:51], 0
M v[200:203], a[172:175], a[52:55], v[200:203]
ds_read_b64_tr_b16 a[156:157], v19 offset:49152
ds_read_b64_tr_b16 a[158:159], v19 offset:51200
M v[204:207], a[172:175], a[60:63], 0
buffer_load_dwordx4 v8, s[12:15], s24 offen offset:2048 lds
M v[204:207], a[168:171], a[56:59], v[204:207]
M v[208:211], a[168:171], a[64:67], 0
M v[208:211], a[172:175], a[68:71], v[208:211]
M v[212:215], a[172:175], a[76:79], 0
buffer_load_dwordx4 v9, s[12:15], s24 offen offset:3072 lds
M v[212:215], a[168:171], a[72:75], v[212:215]
M v[216:219], a[168:171], a[80:83], 0
v_accvgpr_read_b32 v24, a24
v_accvgpr_read_b32 v25, a25
M v[216:219], a[172:175], a[84:87], v[216:219]
v_accvgpr_read_b32 v26, a26
v_accvgpr_read_b32 v27, a27
M v[220:223], a[172:175], a[92:95], 0
v_accvgpr_read_b32 v28, a28
v_accvgpr_read_b32 v29, a29
M v[220:223], a[168:171], a[88:91], v[220:223]
s_waitcnt lgkmcnt(10)
v_accvgpr_read_b32 v30, a30
v_accvgpr_read_b32 v31, a31
M v[224:227], a[176:179], a[32:35], 0
s_add_u32 s24, s24, 262144
s_cmp_eq_u32 s24, s27
s_cselect_b32 s24, s28, s24
s_sub_u32 s6, s6, 1
s_cmp_eq_u32 s6, 0
s_cselect_b64 s[12:13], s[64:65], s[12:13]
v_cvt_pk_bf16_f32 v24, v24, v25
v_cvt_pk_bf16_f32 v25, v26, v27
M v[224:227], a[180:183], a[36:39], v[224:227]
v_cvt_pk_bf16_f32 v26, v28, v29
v_cvt_pk_bf16_f32 v27, v30, v31
M v[228:231], a[180:183], a[44:47], 0
M v[228:231], a[176:179], a[40:43], v[228:231]
M v[232:235], a[176:179], a[48:51], 0
M v[232:235], a[180:183], a[52:55], v[232:235]
s_add_u32 s94, s93, 12288
buffer_store_dwordx4 v[24:27], v1, s[16:19], s94 offen offset:3072 sc1
M v[236:239], a[180:183], a[60:63], 0
M v[236:239], a[176:179], a[56:59], v[236:239]
s_waitcnt vmcnt(12) lgkmcnt(0)
s_barrier
ds_read_b128 a[160:163], v10 offset:32768
ds_read_b128 a[164:167], v11 offset:32768
M v[240:243], a[176:179], a[64:67], 0
s_add_u32 m0, s29, 0
s_nop 0
buffer_load_dwordx4 v2, s[8:11], s23 offen offset:0 lds
M v[240:243], a[180:183], a[68:71], v[240:243]
M v[244:247], a[180:183], a[76:79], 0
M v[244:247], a[176:179], a[72:75], v[244:247]
M v[248:251], a[176:179], a[80:83], 0
M v[248:251], a[180:183], a[84:87], v[248:251]
buffer_load_dwordx4 v3, s[8:11], s23 offen offset:1024 lds
M v[252:255], a[180:183], a[92:95], 0
M v[252:255], a[176:179], a[88:91], v[252:255]
M a[0:3], a[184:187], a[32:35], 0
M a[0:3], a[188:191], a[36:39], a[0:3]
ds_read_b128 a[168:171], v10 offset:34816
ds_read_b128 a[172:175], v11 offset:34816
M a[4:7], a[188:191], a[44:47], 0
M a[4:7], a[184:187], a[40:43], a[4:7]
M a[8:11], a[184:187], a[48:51], 0
buffer_load_dwordx4 v4, s[8:11], s23 offen offset:2048 lds
M a[8:11], a[188:191], a[52:55], a[8:11]
M a[12:15], a[188:191], a[60:63], 0
M a[12:15], a[184:187], a[56:59], a[12:15]
M a[16:19], a[184:187], a[64:67], 0
M a[16:19], a[188:191], a[68:71], a[16:19]
buffer_load_dwordx4 v5, s[8:11], s23 offen offset:3072 lds
M a[20:23], a[188:191], a[76:79], 0
M a[20:23], a[184:187], a[72:75], a[20:23]
M a[24:27], a[184:187], a[80:83], 0
M a[24:27], a[188:191], a[84:87], a[24:27]
M a[28:31], a[188:191], a[92:95], 0
M a[28:31], a[184:187], a[88:91], a[28:31]
s_waitcnt lgkmcnt(2)
M v[32:35], a[160:163], a[96:99], v[32:35]
s_add_u32 m0, s29, 98304
s_nop 0
buffer_load_dwordx4 v6, s[12:15], s24 offen offset:0 lds
M v[32:35], a[164:167], a[100:103], v[32:35]
ds_read_b128 a[176:179], v10 offset:36864
ds_read_b128 a[180:183], v11 offset:36864
M v[36:39], a[164:167], a[108:111], v[36:39]
M v[36:39], a[160:163], a[104:107], v[36:39]
ds_read_b64_tr_b16 a[32:33], v12 offset:0
ds_read_b64_tr_b16 a[34:35], v12 offset:2048
M v[40:43], a[160:163], a[112:115], v[40:43]
M v[40:43], a[164:167], a[116:119], v[40:43]
M v[44:47], a[164:167], a[124:127], v[44:47]
M v[44:47], a[160:163], a[120:123], v[44:47]
ds_read_b64_tr_b16 a[40:41], v13 offset:0
ds_read_b64_tr_b16 a[42:43], v13 offset:2048
M v[48:51], a[160:163], a[128:131], v[48:51]
s_add_u32 s94, s92, 12288
buffer_store_dwordx4 a[192:195], v1, s[16:19], s94 offen offset:0 sc1
M v[48:51], a[164:167], a[132:135], v[48:51]
buffer_load_dwordx4 v7, s[12:15], s24 offen offset:1024 lds
M v[52:55], a[164:167], a[140:143], v[52:55]
M v[52:55], a[160:163], a[136:139], v[52:55]
ds_read_b64_tr_b16 a[48:49], v14 offset:0
ds_read_b64_tr_b16 a[50:51], v14 offset:2048
M v[56:59], a[160:163], a[144:147], v[56:59]
M v[56:59], a[164:167], a[148:151], v[56:59]
M v[60:63], a[164:167], a[156:159], v[60:63]
M v[60:63], a[160:163], a[152:155], v[60:63]
s_waitcnt lgkmcnt(8)
ds_read_b64_tr_b16 a[56:57], v15 offset:0
ds_read_b64_tr_b16 a[58:59], v15 offset:2048
M v[64:67], a[168:171], a[96:99], v[64:67]
buffer_load_dwordx4 v8, s[12:15], s24 offen offset:2048 lds
M v[64:67], a[172:175], a[100:103], v[64:67]
ds_read_b128 a[184:187], v10 offset:38912
ds_read_b128 a[188:191], v11 offset:38912
M v[68:71], a[172:175], a[108:111], v[68:71]
M v[68:71], a[168:171], a[104:107], v[68:71]
ds_read_b64_tr_b16 a[64:65], v16 offset:0
ds_read_b64_tr_b16 a[66:67], v16 offset:2048
M v[72:75], a[168:171], a[112:115], v[72:75]
M v[72:75], a[172:175], a[116:119], v[72:75]
M v[76:79], a[172:175], a[124:127], v[76:79]
M v[76:79], a[168:171], a[120:123], v[76:79]
ds_read_b64_tr_b16 a[72:73], v17 offset:0
ds_read_b64_tr_b16 a[74:75], v17 offset:2048
M v[80:83], a[168:171], a[128:131], v[80:83]
buffer_load_dwordx4 v9, s[12:15], s24 offen offset:3072 lds
M v[80:83], a[172:175], a[132:135], v[80:83]
M v[84:87], a[172:175], a[140:143], v[84:87]
M v[84:87], a[168:171], a[136:139], v[84:87]
ds_read_b64_tr_b16 a[80:81], v18 offset:0
ds_read_b64_tr_b16 a[82:83], v18 offset:2048
M v[88:91], a[168:171], a[144:147], v[88:91]
M v[88:91], a[172:175], a[148:151], v[88:91]
M v[92:95], a[172:175], a[156:159], v[92:95]
s_add_u32 s24, s24, 262144
M v[92:95], a[168:171], a[152:155], v[92:95]
s_waitcnt lgkmcnt(15)
ds_read_b64_tr_b16 a[88:89], v19 offset:0
ds_read_b64_tr_b16 a[90:91], v19 offset:2048
M v[96:99], a[176:179], a[96:99], v[96:99]
M v[96:99], a[180:183], a[100:103], v[96:99]
M v[100:103], a[180:183], a[108:111], v[100:103]
M v[100:103], a[176:179], a[104:107], v[100:103]
M v[104:107], a[176:179], a[112:115], v[104:107]
s_add_u32 s94, s92, 12288
buffer_store_dwordx4 a[196:199], v1, s[16:19], s94 offen offset:1024 sc1
M v[104:107], a[180:183], a[116:119], v[104:107]
M v[108:111], a[180:183], a[124:127], v[108:111]
M v[108:111], a[176:179], a[120:123], v[108:111]
s_waitcnt vmcnt(11) lgkmcnt(0)
s_barrier
ds_read_b128 a[160:163], v10 offset:49152
ds_read_b128 a[164:167], v11 offset:49152
M v[112:115], a[176:179], a[128:131], v[112:115]
s_add_u32 m0, s29, 16384
s_add_u32 s3, s23, s31
buffer_load_dwordx4 v2, s[8:11], s3 offen offset:0 lds
M v[112:115], a[180:183], a[132:135], v[112:115]
M v[116:119], a[180:183], a[140:143], v[116:119]
M v[116:119], a[176:179], a[136:139], v[116:119]
ds_read_b64_tr_b16 a[36:37], v12 offset:16384
ds_read_b64_tr_b16 a[38:39], v12 offset:18432
M v[120:123], a[176:179], a[144:147], v[120:123]
M v[120:123], a[180:183], a[148:151], v[120:123]
buffer_load_dwordx4 v3, s[8:11], s3 offen offset:1024 lds
M v[124:127], a[180:183], a[156:159], v[124:127]
M v[124:127], a[176:179], a[152:155], v[124:127]
M v[128:131], a[184:187], a[96:99], v[128:131]
M v[128:131], a[188:191], a[100:103], v[128:131]
ds_read_b128 a[168:171], v10 offset:51200
ds_read_b128 a[172:175], v11 offset:51200
ds_read_b64_tr_b16 a[44:45], v13 offset:16384
ds_read_b64_tr_b16 a[46:47], v13 offset:18432
M v[132:135], a[188:191], a[108:111], v[132:135]
M v[132:135], a[184:187], a[104:107], v[132:135]
M v[136:139], a[184:187], a[112:115], v[136:139]
buffer_load_dwordx4 v4, s[8:11], s3 offen offset:2048 lds
M v[136:139], a[188:191], a[116:119], v[136:139]
M v[140:143], a[188:191], a[124:127], v[140:143]
M v[140:143], a[184:187], a[120:123], v[140:143]
ds_read_b64_tr_b16 a[52:53], v14 offset:16384
ds_read_b64_tr_b16 a[54:55], v14 offset:18432
M v[144:147], a[184:187], a[128:131], v[144:147]
M v[144:147], a[188:191], a[132:135], v[144:147]
buffer_load_dwordx4 v5, s[8:11], s3 offen offset:3072 lds
M v[148:151], a[188:191], a[140:143], v[148:151]
M v[148:151], a[184:187], a[136:139], v[148:151]
M v[152:155], a[184:187], a[144:147], v[152:155]
M v[152:155], a[188:191], a[148:151], v[152:155]
ds_read_b64_tr_b16 a[60:61], v15 offset:16384
ds_read_b64_tr_b16 a[62:63], v15 offset:18432
M v[156:159], a[188:191], a[156:159], v[156:159]
M v[156:159], a[184:187], a[152:155], v[156:159]
s_waitcnt lgkmcnt(10)
M v[160:163], a[160:163], a[96:99], v[160:163]
s_add_u32 s94, s92, 12288
buffer_store_dwordx4 a[200:203], v1, s[16:19], s94 offen offset:2048 sc1
M v[160:163], a[164:167], a[100:103], v[160:163]
ds_read_b128 a[176:179], v10 offset:53248
ds_read_b128 a[180:183], v11 offset:53248
M v[164:167], a[164:167], a[108:111], v[164:167]
s_add_u32 s23, s23, 128
s_cmp_eq_u32 s23, s25
s_cselect_b32 s23, s26, s23
M v[164:167], a[160:163], a[104:107], v[164:167]
ds_read_b64_tr_b16 a[68:69], v16 offset:16384
ds_read_b64_tr_b16 a[70:71], v16 offset:18432
M v[168:171], a[160:163], a[112:115], v[168:171]
M v[168:171], a[164:167], a[116:119], v[168:171]
M v[172:175], a[164:167], a[124:127], v[172:175]
M v[172:175], a[160:163], a[120:123], v[172:175]
M v[176:179], a[160:163], a[128:131], v[176:179]
s_add_u32 m0, s29, 114688
s_nop 0
buffer_load_dwordx4 v6, s[12:15], s24 offen offset:0 lds
M v[176:179], a[164:167], a[132:135], v[176:179]
ds_read_b64_tr_b16 a[76:77], v17 offset:16384
ds_read_b64_tr_b16 a[78:79], v17 offset:18432
M v[180:183], a[164:167], a[140:143], v[180:183]
M v[180:183], a[160:163], a[136:139], v[180:183]
M v[184:187], a[160:163], a[144:147], v[184:187]
M v[184:187], a[164:167], a[148:151], v[184:187]
buffer_load_dwordx4 v7, s[12:15], s24 offen offset:1024 lds
M v[188:191], a[164:167], a[156:159], v[188:191]
M v[188:191], a[160:163], a[152:155], v[188:191]
s_waitcnt lgkmcnt(12)
ds_read_b64_tr_b16 a[84:85], v18 offset:16384
ds_read_b64_tr_b16 a[86:87], v18 offset:18432
M v[192:195], a[168:171], a[96:99], v[192:195]
M v[192:195], a[172:175], a[100:103], v[192:195]
ds_read_b128 a[184:187], v10 offset:55296
ds_read_b128 a[188:191], v11 offset:55296
M v[196:199], a[172:175], a[108:111], v[196:199]
M v[196:199], a[168:171], a[104:107], v[196:199]
M v[200:203], a[168:171], a[112:115], v[200:203]
buffer_load_dwordx4 v8, s[12:15], s24 offen offset:2048 lds
M v[200:203], a[172:175], a[116:119], v[200:203]
ds_read_b64_tr_b16 a[92:93], v19 offset:16384
ds_read_b64_tr_b16 a[94:95], v19 offset:18432
M v[204:207], a[172:175], a[124:127], v[204:207]
M v[204:207], a[168:171], a[120:123], v[204:207]
M v[208:211], a[168:171], a[128:131], v[208:211]
M v[208:211], a[172:175], a[132:135], v[208:211]
buffer_load_dwordx4 v9, s[12:15], s24 offen offset:3072 lds
M v[212:215], a[172:175], a[140:143], v[212:215]
M v[212:215], a[168:171], a[136:139], v[212:215]
M v[216:219], a[168:171], a[144:147], v[216:219]
s_add_u32 s94, s92, 12288
buffer_store_dwordx4 a[204:207], v1, s[16:19], s94 offen offset:3072 sc1
M v[216:219], a[172:175], a[148:151], v[216:219]
M v[220:223], a[172:175], a[156:159], v[220:223]
M v[220:223], a[168:171], a[152:155], v[220:223]
s_waitcnt lgkmcnt(10)
M v[224:227], a[176:179], a[96:99], v[224:227]
s_add_u32 s24, s24, 262144
s_cmp_eq_u32 s24, s27
s_cselect_b32 s24, s28, s24
s_sub_u32 s6, s6, 1
s_cmp_eq_u32 s6, 0
s_cselect_b64 s[12:13], s[64:65], s[12:13]
M v[224:227], a[180:183], a[100:103], v[224:227]
M v[228:231], a[180:183], a[108:111], v[228:231]
M v[228:231], a[176:179], a[104:107], v[228:231]
M v[232:235], a[176:179], a[112:115], v[232:235]
M v[232:235], a[180:183], a[116:119], v[232:235]
M v[236:239], a[180:183], a[124:127], v[236:239]
M v[236:239], a[176:179], a[120:123], v[236:239]
s_waitcnt vmcnt(11) lgkmcnt(0)
s_barrier
ds_read_b128 a[160:163], v10 offset:0
ds_read_b128 a[164:167], v11 offset:0
M v[240:243], a[176:179], a[128:131], v[240:243]
s_add_u32 m0, s29, 32768
s_nop 0
buffer_load_dwordx4 v2, s[8:11], s23 offen offset:0 lds
M v[240:243], a[180:183], a[132:135], v[240:243]
M v[244:247], a[180:183], a[140:143], v[244:247]
M v[244:247], a[176:179], a[136:139], v[244:247]
M v[248:251], a[176:179], a[144:147], v[248:251]
M v[248:251], a[180:183], a[148:151], v[248:251]
buffer_load_dwordx4 v3, s[8:11], s23 offen offset:1024 lds
M v[252:255], a[180:183], a[156:159], v[252:255]
M v[252:255], a[176:179], a[152:155], v[252:255]
M a[0:3], a[184:187], a[96:99], a[0:3]
M a[0:3], a[188:191], a[100:103], a[0:3]
ds_read_b128 a[168:171], v10 offset:2048
ds_read_b128 a[172:175], v11 offset:2048
M a[4:7], a[188:191], a[108:111], a[4:7]
M a[4:7], a[184:187], a[104:107], a[4:7]
M a[8:11], a[184:187], a[112:115], a[8:11]
buffer_load_dwordx4 v4, s[8:11], s23 offen offset:2048 lds
M a[8:11], a[188:191], a[116:119], a[8:11]
M a[12:15], a[188:191], a[124:127], a[12:15]
M a[12:15], a[184:187], a[120:123], a[12:15]
M a[16:19], a[184:187], a[128:131], a[16:19]
M a[16:19], a[188:191], a[132:135], a[16:19]
buffer_load_dwordx4 v5, s[8:11], s23 offen offset:3072 lds
M a[20:23], a[188:191], a[140:143], a[20:23]
M a[20:23], a[184:187], a[136:139], a[20:23]
M a[24:27], a[184:187], a[144:147], a[24:27]
M a[24:27], a[188:191], a[148:151], a[24:27]
M a[28:31], a[188:191], a[156:159], a[28:31]
M a[28:31], a[184:187], a[152:155], a[28:31]
s_waitcnt lgkmcnt(2)
M v[32:35], a[160:163], a[32:35], v[32:35]
s_add_u32 m0, s29, 65536
s_nop 0
buffer_load_dwordx4 v6, s[12:15], s24 offen offset:0 lds
M v[32:35], a[164:167], a[36:39], v[32:35]
ds_read_b128 a[176:179], v10 offset:4096
ds_read_b128 a[180:183], v11 offset:4096
M v[36:39], a[164:167], a[44:47], v[36:39]
M v[36:39], a[160:163], a[40:43], v[36:39]
ds_read_b64_tr_b16 a[96:97], v12 offset:32768
ds_read_b64_tr_b16 a[98:99], v12 offset:34816
M v[40:43], a[160:163], a[48:51], v[40:43]
M v[40:43], a[164:167], a[52:55], v[40:43]
M v[44:47], a[164:167], a[60:63], v[44:47]
M v[44:47], a[160:163], a[56:59], v[44:47]
ds_read_b64_tr_b16 a[104:105], v13 offset:32768
ds_read_b64_tr_b16 a[106:107], v13 offset:34816
M v[48:51], a[160:163], a[64:67], v[48:51]
s_add_u32 s94, s93, 0
buffer_store_dwordx4 a[208:211], v1, s[16:19], s94 offen offset:0 sc1
M v[48:51], a[164:167], a[68:71], v[48:51]
buffer_load_dwordx4 v7, s[12:15], s24 offen offset:1024 lds
M v[52:55], a[164:167], a[76:79], v[52:55]
M v[52:55], a[160:163], a[72:75], v[52:55]
ds_read_b64_tr_b16 a[112:113], v14 offset:32768
ds_read_b64_tr_b16 a[114:115], v14 offset:34816
M v[56:59], a[160:163], a[80:83], v[56:59]
M v[56:59], a[164:167], a[84:87], v[56:59]
M v[60:63], a[164:167], a[92:95], v[60:63]
M v[60:63], a[160:163], a[88:91], v[60:63]
s_waitcnt lgkmcnt(8)
ds_read_b64_tr_b16 a[120:121], v15 offset:32768
ds_read_b64_tr_b16 a[122:123], v15 offset:34816
M v[64:67], a[168:171], a[32:35], v[64:67]
buffer_load_dwordx4 v8, s[12:15], s24 offen offset:2048 lds
M v[64:67], a[172:175], a[36:39], v[64:67]
ds_read_b128 a[184:187], v10 offset:6144
ds_read_b128 a[188:191], v11 offset:6144
M v[68:71], a[172:175], a[44:47], v[68:71]
M v[68:71], a[168:171], a[40:43], v[68:71]
ds_read_b64_tr_b16 a[128:129], v16 offset:32768
ds_read_b64_tr_b16 a[130:131], v16 offset:34816
M v[72:75], a[168:171], a[48:51], v[72:75]
M v[72:75], a[172:175], a[52:55], v[72:75]
M v[76:79], a[172:175], a[60:63], v[76:79]
M v[76:79], a[168:171], a[56:59], v[76:79]
ds_read_b64_tr_b16 a[136:137], v17 offset:32768
ds_read_b64_tr_b16 a[138:139], v17 offset:34816
M v[80:83], a[168:171], a[64:67], v[80:83]
buffer_load_dwordx4 v9, s[12:15], s24 offen offset:3072 lds
M v[80:83], a[172:175], a[68:71], v[80:83]
M v[84:87], a[172:175], a[76:79], v[84:87]
M v[84:87], a[168:171], a[72:75], v[84:87]
ds_read_b64_tr_b16 a[144:145], v18 offset:32768
ds_read_b64_tr_b16 a[146:147], v18 offset:34816
M v[88:91], a[168:171], a[80:83], v[88:91]
M v[88:91], a[172:175], a[84:87], v[88:91]
M v[92:95], a[172:175], a[92:95], v[92:95]
s_add_u32 s24, s24, 262144
M v[92:95], a[168:171], a[88:91], v[92:95]
s_waitcnt lgkmcnt(15)
ds_read_b64_tr_b16 a[152:153], v19 offset:32768
ds_read_b64_tr_b16 a[154:155], v19 offset:34816
M v[96:99], a[176:179], a[32:35], v[96:99]
M v[96:99], a[180:183], a[36:39], v[96:99]
M v[100:103], a[180:183], a[44:47], v[100:103]
M v[100:103], a[176:179], a[40:43], v[100:103]
M v[104:107], a[176:179], a[48:51], v[104:107]
s_add_u32 s94, s93, 0
buffer_store_dwordx4 a[212:215], v1, s[16:19], s94 offen offset:1024 sc1
M v[104:107], a[180:183], a[52:55], v[104:107]
M v[108:111], a[180:183], a[60:63], v[108:111]
M v[108:111], a[176:179], a[56:59], v[108:111]
s_waitcnt vmcnt(11) lgkmcnt(0)
s_barrier
ds_read_b128 a[160:163], v10 offset:16384
ds_read_b128 a[164:167], v11 offset:16384
M v[112:115], a[176:179], a[64:67], v[112:115]
s_add_u32 m0, s29, 49152
s_add_u32 s3, s23, s31
buffer_load_dwordx4 v2, s[8:11], s3 offen offset:0 lds
M v[112:115], a[180:183], a[68:71], v[112:115]
M v[116:119], a[180:183], a[76:79], v[116:119]
M v[116:119], a[176:179], a[72:75], v[116:119]
ds_read_b64_tr_b16 a[100:101], v12 offset:49152
ds_read_b64_tr_b16 a[102:103], v12 offset:51200
M v[120:123], a[176:179], a[80:83], v[120:123]
M v[120:123], a[180:183], a[84:87], v[120:123]
buffer_load_dwordx4 v3, s[8:11], s3 offen offset:1024 lds
M v[124:127], a[180:183], a[92:95], v[124:127]
M v[124:127], a[176:179], a[88:91], v[124:127]
M v[128:131], a[184:187], a[32:35], v[128:131]
M v[128:131], a[188:191], a[36:39], v[128:131]
ds_read_b128 a[168:171], v10 offset:18432
ds_read_b128 a[172:175], v11 offset:18432
ds_read_b64_tr_b16 a[108:109], v13 offset:49152
ds_read_b64_tr_b16 a[110:111], v13 offset:51200
M v[132:135], a[188:191], a[44:47], v[132:135]
M v[132:135], a[184:187], a[40:43], v[132:135]
M v[136:139], a[184:187], a[48:51], v[136:139]
buffer_load_dwordx4 v4, s[8:11], s3 offen offset:2048 lds
M v[136:139], a[188:191], a[52:55], v[136:139]
M v[140:143], a[188:191], a[60:63], v[140:143]
M v[140:143], a[184:187], a[56:59], v[140:143]
ds_read_b64_tr_b16 a[116:117], v14 offset:49152
ds_read_b64_tr_b16 a[118:119], v14 offset:51200
M v[144:147], a[184:187], a[64:67], v[144:147]
M v[144:147], a[188:191], a[68:71], v[144:147]
buffer_load_dwordx4 v5, s[8:11], s3 offen offset:3072 lds
M v[148:151], a[188:191], a[76:79], v[148:151]
M v[148:151], a[184:187], a[72:75], v[148:151]
M v[152:155], a[184:187], a[80:83], v[152:155]
M v[152:155], a[188:191], a[84:87], v[152:155]
ds_read_b64_tr_b16 a[124:125], v15 offset:49152
ds_read_b64_tr_b16 a[126:127], v15 offset:51200
M v[156:159], a[188:191], a[92:95], v[156:159]
M v[156:159], a[184:187], a[88:91], v[156:159]
s_waitcnt lgkmcnt(10)
M v[160:163], a[160:163], a[32:35], v[160:163]
s_add_u32 s94, s93, 0
buffer_store_dwordx4 a[216:219], v1, s[16:19], s94 offen offset:2048 sc1
M v[160:163], a[164:167], a[36:39], v[160:163]
ds_read_b128 a[176:179], v10 offset:20480
ds_read_b128 a[180:183], v11 offset:20480
M v[164:167], a[164:167], a[44:47], v[164:167]
s_add_u32 s23, s23, 128
s_cmp_eq_u32 s23, s25
s_cselect_b32 s23, s26, s23
M v[164:167], a[160:163], a[40:43], v[164:167]
ds_read_b64_tr_b16 a[132:133], v16 offset:49152
ds_read_b64_tr_b16 a[134:135], v16 offset:51200
M v[168:171], a[160:163], a[48:51], v[168:171]
M v[168:171], a[164:167], a[52:55], v[168:171]
M v[172:175], a[164:167], a[60:63], v[172:175]
M v[172:175], a[160:163], a[56:59], v[172:175]
M v[176:179], a[160:163], a[64:67], v[176:179]
s_add_u32 m0, s29, 81920
s_nop 0
buffer_load_dwordx4 v6, s[12:15], s24 offen offset:0 lds
M v[176:179], a[164:167], a[68:71], v[176:179]
ds_read_b64_tr_b16 a[140:141], v17 offset:49152
ds_read_b64_tr_b16 a[142:143], v17 offset:51200
M v[180:183], a[164:167], a[76:79], v[180:183]
M v[180:183], a[160:163], a[72:75], v[180:183]
M v[184:187], a[160:163], a[80:83], v[184:187]
M v[184:187], a[164:167], a[84:87], v[184:187]
buffer_load_dwordx4 v7, s[12:15], s24 offen offset:1024 lds
M v[188:191], a[164:167], a[92:95], v[188:191]
M v[188:191], a[160:163], a[88:91], v[188:191]
s_waitcnt lgkmcnt(12)
ds_read_b64_tr_b16 a[148:149], v18 offset:49152
ds_read_b64_tr_b16 a[150:151], v18 offset:51200
M v[192:195], a[168:171], a[32:35], v[192:195]
M v[192:195], a[172:175], a[36:39], v[192:195]
ds_read_b128 a[184:187], v10 offset:22528
ds_read_b128 a[188:191], v11 offset:22528
M v[196:199], a[172:175], a[44:47], v[196:199]
M v[196:199], a[168:171], a[40:43], v[196:199]
M v[200:203], a[168:171], a[48:51], v[200:203]
buffer_load_dwordx4 v8, s[12:15], s24 offen offset:2048 lds
M v[200:203], a[172:175], a[52:55], v[200:203]
ds_read_b64_tr_b16 a[156:157], v19 offset:49152
ds_read_b64_tr_b16 a[158:159], v19 offset:51200
M v[204:207], a[172:175], a[60:63], v[204:207]
M v[204:207], a[168:171], a[56:59], v[204:207]
M v[208:211], a[168:171], a[64:67], v[208:211]
M v[208:211], a[172:175], a[68:71], v[208:211]
buffer_load_dwordx4 v9, s[12:15], s24 offen offset:3072 lds
M v[212:215], a[172:175], a[76:79], v[212:215]
M v[212:215], a[168:171], a[72:75], v[212:215]
M v[216:219], a[168:171], a[80:83], v[216:219]
s_add_u32 s94, s93, 0
buffer_store_dwordx4 a[220:223], v1, s[16:19], s94 offen offset:3072 sc1
M v[216:219], a[172:175], a[84:87], v[216:219]
M v[220:223], a[172:175], a[92:95], v[220:223]
M v[220:223], a[168:171], a[88:91], v[220:223]
s_waitcnt lgkmcnt(10)
M v[224:227], a[176:179], a[32:35], v[224:227]
s_add_u32 s24, s24, 262144
s_cmp_eq_u32 s24, s27
s_cselect_b32 s24, s28, s24
s_sub_u32 s6, s6, 1
s_cmp_eq_u32 s6, 0
s_cselect_b64 s[12:13], s[64:65], s[12:13]
M v[224:227], a[180:183], a[36:39], v[224:227]
M v[228:231], a[180:183], a[44:47], v[228:231]
M v[228:231], a[176:179], a[40:43], v[228:231]
M v[232:235], a[176:179], a[48:51], v[232:235]
M v[232:235], a[180:183], a[52:55], v[232:235]
M v[236:239], a[180:183], a[60:63], v[236:239]
M v[236:239], a[176:179], a[56:59], v[236:239]
s_waitcnt vmcnt(11) lgkmcnt(0)
s_barrier
ds_read_b128 a[160:163], v10 offset:32768
ds_read_b128 a[164:167], v11 offset:32768
M v[240:243], a[176:179], a[64:67], v[240:243]
s_add_u32 m0, s29, 0
s_nop 0
buffer_load_dwordx4 v2, s[8:11], s23 offen offset:0 lds
M v[240:243], a[180:183], a[68:71], v[240:243]
M v[244:247], a[180:183], a[76:79], v[244:247]
M v[244:247], a[176:179], a[72:75], v[244:247]
M v[248:251], a[176:179], a[80:83], v[248:251]
M v[248:251], a[180:183], a[84:87], v[248:251]
buffer_load_dwordx4 v3, s[8:11], s23 offen offset:1024 lds
M v[252:255], a[180:183], a[92:95], v[252:255]
M v[252:255], a[176:179], a[88:91], v[252:255]
M a[0:3], a[184:187], a[32:35], a[0:3]
M a[0:3], a[188:191], a[36:39], a[0:3]
ds_read_b128 a[168:171], v10 offset:34816
ds_read_b128 a[172:175], v11 offset:34816
M a[4:7], a[188:191], a[44:47], a[4:7]
M a[4:7], a[184:187], a[40:43], a[4:7]
M a[8:11], a[184:187], a[48:51], a[8:11]
buffer_load_dwordx4 v4, s[8:11], s23 offen offset:2048 lds
M a[8:11], a[188:191], a[52:55], a[8:11]
M a[12:15], a[188:191], a[60:63], a[12:15]
M a[12:15], a[184:187], a[56:59], a[12:15]
M a[16:19], a[184:187], a[64:67], a[16:19]
M a[16:19], a[188:191], a[68:71], a[16:19]
buffer_load_dwordx4 v5, s[8:11], s23 offen offset:3072 lds
M a[20:23], a[188:191], a[76:79], a[20:23]
M a[20:23], a[184:187], a[72:75], a[20:23]
M a[24:27], a[184:187], a[80:83], a[24:27]
M a[24:27], a[188:191], a[84:87], a[24:27]
M a[28:31], a[188:191], a[92:95], a[28:31]
M a[28:31], a[184:187], a[88:91], a[28:31]
s_waitcnt lgkmcnt(2)
M v[32:35], a[160:163], a[96:99], v[32:35]
s_add_u32 m0, s29, 98304
s_nop 0
buffer_load_dwordx4 v6, s[12:15], s24 offen offset:0 lds
M v[32:35], a[164:167], a[100:103], v[32:35]
ds_read_b128 a[176:179], v10 offset:36864
ds_read_b128 a[180:183], v11 offset:36864
M v[36:39], a[164:167], a[108:111], v[36:39]
M v[36:39], a[160:163], a[104:107], v[36:39]
ds_read_b64_tr_b16 a[32:33], v12 offset:0
ds_read_b64_tr_b16 a[34:35], v12 offset:2048
M v[40:43], a[160:163], a[112:115], v[40:43]
M v[40:43], a[164:167], a[116:119], v[40:43]
M v[44:47], a[164:167], a[124:127], v[44:47]
M v[44:47], a[160:163], a[120:123], v[44:47]
ds_read_b64_tr_b16 a[40:41], v13 offset:0
ds_read_b64_tr_b16 a[42:43], v13 offset:2048
M v[48:51], a[160:163], a[128:131], v[48:51]
s_add_u32 s94, s93, 4096
buffer_store_dwordx4 a[224:227], v1, s[16:19], s94 offen offset:0 sc1
M v[48:51], a[164:167], a[132:135], v[48:51]
buffer_load_dwordx4 v7, s[12:15], s24 offen offset:1024 lds
M v[52:55], a[164:167], a[140:143], v[52:55]
M v[52:55], a[160:163], a[136:139], v[52:55]
ds_read_b64_tr_b16 a[48:49], v14 offset:0
ds_read_b64_tr_b16 a[50:51], v14 offset:2048
M v[56:59], a[160:163], a[144:147], v[56:59]
M v[56:59], a[164:167], a[148:151], v[56:59]
M v[60:63], a[164:167], a[156:159], v[60:63]
M v[60:63], a[160:163], a[152:155], v[60:63]
s_waitcnt lgkmcnt(8)
ds_read_b64_tr_b16 a[56:57], v15 offset:0
ds_read_b64_tr_b16 a[58:59], v15 offset:2048
M v[64:67], a[168:171], a[96:99], v[64:67]
buffer_load_dwordx4 v8, s[12:15], s24 offen offset:2048 lds
M v[64:67], a[172:175], a[100:103], v[64:67]
ds_read_b128 a[184:187], v10 offset:38912
ds_read_b128 a[188:191], v11 offset:38912
M v[68:71], a[172:175], a[108:111], v[68:71]
M v[68:71], a[168:171], a[104:107], v[68:71]
ds_read_b64_tr_b16 a[64:65], v16 offset:0
ds_read_b64_tr_b16 a[66:67], v16 offset:2048
M v[72:75], a[168:171], a[112:115], v[72:75]
M v[72:75], a[172:175], a[116:119], v[72:75]
M v[76:79], a[172:175], a[124:127], v[76:79]
M v[76:79], a[168:171], a[120:123], v[76:79]
ds_read_b64_tr_b16 a[72:73], v17 offset:0
ds_read_b64_tr_b16 a[74:75], v17 offset:2048
M v[80:83], a[168:171], a[128:131], v[80:83]
buffer_load_dwordx4 v9, s[12:15], s24 offen offset:3072 lds
M v[80:83], a[172:175], a[132:135], v[80:83]
M v[84:87], a[172:175], a[140:143], v[84:87]
M v[84:87], a[168:171], a[136:139], v[84:87]
ds_read_b64_tr_b16 a[80:81], v18 offset:0
ds_read_b64_tr_b16 a[82:83], v18 offset:2048
M v[88:91], a[168:171], a[144:147], v[88:91]
M v[88:91], a[172:175], a[148:151], v[88:91]
M v[92:95], a[172:175], a[156:159], v[92:95]
s_add_u32 s24, s24, 262144
M v[92:95], a[168:171], a[152:155], v[92:95]
s_waitcnt lgkmcnt(15)
ds_read_b64_tr_b16 a[88:89], v19 offset:0
ds_read_b64_tr_b16 a[90:91], v19 offset:2048
M v[96:99], a[176:179], a[96:99], v[96:99]
M v[96:99], a[180:183], a[100:103], v[96:99]
M v[100:103], a[180:183], a[108:111], v[100:103]
M v[100:103], a[176:179], a[104:107], v[100:103]
M v[104:107], a[176:179], a[112:115], v[104:107]
s_add_u32 s94, s93, 4096
buffer_store_dwordx4 a[228:231], v1, s[16:19], s94 offen offset:1024 sc1
M v[104:107], a[180:183], a[116:119], v[104:107]
M v[108:111], a[180:183], a[124:127], v[108:111]
M v[108:111], a[176:179], a[120:123], v[108:111]
s_waitcnt vmcnt(11) lgkmcnt(0)
s_barrier
ds_read_b128 a[160:163], v10 offset:49152
ds_read_b128 a[164:167], v11 offset:49152
M v[112:115], a[176:179], a[128:131], v[112:115]
s_add_u32 m0, s29, 16384
s_add_u32 s3, s23, s31
buffer_load_dwordx4 v2, s[8:11], s3 offen offset:0 lds
M v[112:115], a[180:183], a[132:135], v[112:115]
M v[116:119], a[180:183], a[140:143], v[116:119]
M v[116:119], a[176:179], a[136:139], v[116:119]
ds_read_b64_tr_b16 a[36:37], v12 offset:16384
ds_read_b64_tr_b16 a[38:39], v12 offset:18432
M v[120:123], a[176:179], a[144:147], v[120:123]
M v[120:123], a[180:183], a[148:151], v[120:123]
buffer_load_dwordx4 v3, s[8:11], s3 offen offset:1024 lds
M v[124:127], a[180:183], a[156:159], v[124:127]
M v[124:127], a[176:179], a[152:155], v[124:127]
M v[128:131], a[184:187], a[96:99], v[128:131]
M v[128:131], a[188:191], a[100:103], v[128:131]
ds_read_b128 a[168:171], v10 offset:51200
ds_read_b128 a[172:175], v11 offset:51200
ds_read_b64_tr_b16 a[44:45], v13 offset:16384
ds_read_b64_tr_b16 a[46:47], v13 offset:18432
M v[132:135], a[188:191], a[108:111], v[132:135]
M v[132:135], a[184:187], a[104:107], v[132:135]
M v[136:139], a[184:187], a[112:115], v[136:139]
buffer_load_dwordx4 v4, s[8:11], s3 offen offset:2048 lds
M v[136:139], a[188:191], a[116:119], v[136:139]
M v[140:143], a[188:191], a[124:127], v[140:143]
M v[140:143], a[184:187], a[120:123], v[140:143]
ds_read_b64_tr_b16 a[52:53], v14 offset:16384
ds_read_b64_tr_b16 a[54:55], v14 offset:18432
M v[144:147], a[184:187], a[128:131], v[144:147]
M v[144:147], a[188:191], a[132:135], v[144:147]
buffer_load_dwordx4 v5, s[8:11], s3 offen offset:3072 lds
M v[148:151], a[188:191], a[140:143], v[148:151]
M v[148:151], a[184:187], a[136:139], v[148:151]
M v[152:155], a[184:187], a[144:147], v[152:155]
M v[152:155], a[188:191], a[148:151], v[152:155]
ds_read_b64_tr_b16 a[60:61], v15 offset:16384
ds_read_b64_tr_b16 a[62:63], v15 offset:18432
M v[156:159], a[188:191], a[156:159], v[156:159]
M v[156:159], a[184:187], a[152:155], v[156:159]
s_waitcnt lgkmcnt(10)
M v[160:163], a[160:163], a[96:99], v[160:163]
s_add_u32 s94, s93, 4096
buffer_store_dwordx4 a[232:235], v1, s[16:19], s94 offen offset:2048 sc1
M v[160:163], a[164:167], a[100:103], v[160:163]
ds_read_b128 a[176:179], v10 offset:53248
ds_read_b128 a[180:183], v11 offset:53248
M v[164:167], a[164:167], a[108:111], v[164:167]
s_add_u32 s23, s23, 128
s_cmp_eq_u32 s23, s25
s_cselect_b32 s23, s26, s23
M v[164:167], a[160:163], a[104:107], v[164:167]
ds_read_b64_tr_b16 a[68:69], v16 offset:16384
ds_read_b64_tr_b16 a[70:71], v16 offset:18432
M v[168:171], a[160:163], a[112:115], v[168:171]
M v[168:171], a[164:167], a[116:119], v[168:171]
M v[172:175], a[164:167], a[124:127], v[172:175]
M v[172:175], a[160:163], a[120:123], v[172:175]
M v[176:179], a[160:163], a[128:131], v[176:179]
s_add_u32 m0, s29, 114688
s_nop 0
buffer_load_dwordx4 v6, s[12:15], s24 offen offset:0 lds
M v[176:179], a[164:167], a[132:135], v[176:179]
ds_read_b64_tr_b16 a[76:77], v17 offset:16384
ds_read_b64_tr_b16 a[78:79], v17 offset:18432
M v[180:183], a[164:167], a[140:143], v[180:183]
M v[180:183], a[160:163], a[136:139], v[180:183]
M v[184:187], a[160:163], a[144:147], v[184:187]
M v[184:187], a[164:167], a[148:151], v[184:187]
buffer_load_dwordx4 v7, s[12:15], s24 offen offset:1024 lds
M v[188:191], a[164:167], a[156:159], v[188:191]
M v[188:191], a[160:163], a[152:155], v[188:191]
s_waitcnt lgkmcnt(12)
ds_read_b64_tr_b16 a[84:85], v18 offset:16384
ds_read_b64_tr_b16 a[86:87], v18 offset:18432
M v[192:195], a[168:171], a[96:99], v[192:195]
M v[192:195], a[172:175], a[100:103], v[192:195]
ds_read_b128 a[184:187], v10 offset:55296
ds_read_b128 a[188:191], v11 offset:55296
M v[196:199], a[172:175], a[108:111], v[196:199]
M v[196:199], a[168:171], a[104:107], v[196:199]
M v[200:203], a[168:171], a[112:115], v[200:203]
buffer_load_dwordx4 v8, s[12:15], s24 offen offset:2048 lds
M v[200:203], a[172:175], a[116:119], v[200:203]
ds_read_b64_tr_b16 a[92:93], v19 offset:16384
ds_read_b64_tr_b16 a[94:95], v19 offset:18432
M v[204:207], a[172:175], a[124:127], v[204:207]
M v[204:207], a[168:171], a[120:123], v[204:207]
M v[208:211], a[168:171], a[128:131], v[208:211]
M v[208:211], a[172:175], a[132:135], v[208:211]
buffer_load_dwordx4 v9, s[12:15], s24 offen offset:3072 lds
M v[212:215], a[172:175], a[140:143], v[212:215]
M v[212:215], a[168:171], a[136:139], v[212:215]
M v[216:219], a[168:171], a[144:147], v[216:219]
s_add_u32 s94, s93, 4096
buffer_store_dwordx4 a[236:239], v1, s[16:19], s94 offen offset:3072 sc1
M v[216:219], a[172:175], a[148:151], v[216:219]
M v[220:223], a[172:175], a[156:159], v[220:223]
M v[220:223], a[168:171], a[152:155], v[220:223]
s_waitcnt lgkmcnt(10)
M v[224:227], a[176:179], a[96:99], v[224:227]
s_add_u32 s24, s24, 262144
s_cmp_eq_u32 s24, s27
s_cselect_b32 s24, s28, s24
s_sub_u32 s6, s6, 1
s_cmp_eq_u32 s6, 0
s_cselect_b64 s[12:13], s[64:65], s[12:13]
M v[224:227], a[180:183], a[100:103], v[224:227]
M v[228:231], a[180:183], a[108:111], v[228:231]
M v[228:231], a[176:179], a[104:107], v[228:231]
M v[232:235], a[176:179], a[112:115], v[232:235]
M v[232:235], a[180:183], a[116:119], v[232:235]
M v[236:239], a[180:183], a[124:127], v[236:239]
M v[236:239], a[176:179], a[120:123], v[236:239]
s_waitcnt vmcnt(11) lgkmcnt(0)
s_barrier
ds_read_b128 a[160:163], v10 offset:0
ds_read_b128 a[164:167], v11 offset:0
M v[240:243], a[176:179], a[128:131], v[240:243]
s_add_u32 m0, s29, 32768
s_nop 0
buffer_load_dwordx4 v2, s[8:11], s23 offen offset:0 lds
M v[240:243], a[180:183], a[132:135], v[240:243]
M v[244:247], a[180:183], a[140:143], v[244:247]
M v[244:247], a[176:179], a[136:139], v[244:247]
M v[248:251], a[176:179], a[144:147], v[248:251]
M v[248:251], a[180:183], a[148:151], v[248:251]
buffer_load_dwordx4 v3, s[8:11], s23 offen offset:1024 lds
M v[252:255], a[180:183], a[156:159], v[252:255]
M v[252:255], a[176:179], a[152:155], v[252:255]
M a[0:3], a[184:187], a[96:99], a[0:3]
M a[0:3], a[188:191], a[100:103], a[0:3]
ds_read_b128 a[168:171], v10 offset:2048
ds_read_b128 a[172:175], v11 offset:2048
M a[4:7], a[188:191], a[108:111], a[4:7]
M a[4:7], a[184:187], a[104:107], a[4:7]
M a[8:11], a[184:187], a[112:115], a[8:11]
buffer_load_dwordx4 v4, s[8:11], s23 offen offset:2048 lds
M a[8:11], a[188:191], a[116:119], a[8:11]
M a[12:15], a[188:191], a[124:127], a[12:15]
M a[12:15], a[184:187], a[120:123], a[12:15]
M a[16:19], a[184:187], a[128:131], a[16:19]
M a[16:19], a[188:191], a[132:135], a[16:19]
buffer_load_dwordx4 v5, s[8:11], s23 offen offset:3072 lds
M a[20:23], a[188:191], a[140:143], a[20:23]
M a[20:23], a[184:187], a[136:139], a[20:23]
M a[24:27], a[184:187], a[144:147], a[24:27]
M a[24:27], a[188:191], a[148:151], a[24:27]
M a[28:31], a[188:191], a[156:159], a[28:31]
M a[28:31], a[184:187], a[152:155], a[28:31]
s_waitcnt lgkmcnt(2)
M v[32:35], a[160:163], a[32:35], v[32:35]
s_add_u32 m0, s29, 65536
s_nop 0
buffer_load_dwordx4 v6, s[12:15], s24 offen offset:0 lds
M v[32:35], a[164:167], a[36:39], v[32:35]
ds_read_b128 a[176:179], v10 offset:4096
ds_read_b128 a[180:183], v11 offset:4096
M v[36:39], a[164:167], a[44:47], v[36:39]
M v[36:39], a[160:163], a[40:43], v[36:39]
ds_read_b64_tr_b16 a[96:97], v12 offset:32768
ds_read_b64_tr_b16 a[98:99], v12 offset:34816
M v[40:43], a[160:163], a[48:51], v[40:43]
M v[40:43], a[164:167], a[52:55], v[40:43]
M v[44:47], a[164:167], a[60:63], v[44:47]
M v[44:47], a[160:163], a[56:59], v[44:47]
ds_read_b64_tr_b16 a[104:105], v13 offset:32768
ds_read_b64_tr_b16 a[106:107], v13 offset:34816
M v[48:51], a[160:163], a[64:67], v[48:51]
s_add_u32 s94, s93, 8192
buffer_store_dwordx4 a[240:243], v1, s[16:19], s94 offen offset:0 sc1
M v[48:51], a[164:167], a[68:71], v[48:51]
buffer_load_dwordx4 v7, s[12:15], s24 offen offset:1024 lds
M v[52:55], a[164:167], a[76:79], v[52:55]
M v[52:55], a[160:163], a[72:75], v[52:55]
ds_read_b64_tr_b16 a[112:113], v14 offset:32768
ds_read_b64_tr_b16 a[114:115], v14 offset:34816
M v[56:59], a[160:163], a[80:83], v[56:59]
M v[56:59], a[164:167], a[84:87], v[56:59]
M v[60:63], a[164:167], a[92:95], v[60:63]
M v[60:63], a[160:163], a[88:91], v[60:63]
s_waitcnt lgkmcnt(8)
ds_read_b64_tr_b16 a[120:121], v15 offset:32768
ds_read_b64_tr_b16 a[122:123], v15 offset:34816
M v[64:67], a[168:171], a[32:35], v[64:67]
buffer_load_dwordx4 v8, s[12:15], s24 offen offset:2048 lds
M v[64:67], a[172:175], a[36:39], v[64:67]
ds_read_b128 a[184:187], v10 offset:6144
ds_read_b128 a[188:191], v11 offset:6144
M v[68:71], a[172:175], a[44:47], v[68:71]
M v[68:71], a[168:171], a[40:43], v[68:71]
ds_read_b64_tr_b16 a[128:129], v16 offset:32768
ds_read_b64_tr_b16 a[130:131], v16 offset:34816
M v[72:75], a[168:171], a[48:51], v[72:75]
M v[72:75], a[172:175], a[52:55], v[72:75]
M v[76:79], a[172:175], a[60:63], v[76:79]
M v[76:79], a[168:171], a[56:59], v[76:79]
ds_read_b64_tr_b16 a[136:137], v17 offset:32768
ds_read_b64_tr_b16 a[138:139], v17 offset:34816
M v[80:83], a[168:171], a[64:67], v[80:83]
buffer_load_dwordx4 v9, s[12:15], s24 offen offset:3072 lds
M v[80:83], a[172:175], a[68:71], v[80:83]
M v[84:87], a[172:175], a[76:79], v[84:87]
M v[84:87], a[168:171], a[72:75], v[84:87]
ds_read_b64_tr_b16 a[144:145], v18 offset:32768
ds_read_b64_tr_b16 a[146:147], v18 offset:34816
M v[88:91], a[168:171], a[80:83], v[88:91]
M v[88:91], a[172:175], a[84:87], v[88:91]
M v[92:95], a[172:175], a[92:95], v[92:95]
s_add_u32 s24, s24, 262144
M v[92:95], a[168:171], a[88:91], v[92:95]
s_waitcnt lgkmcnt(15)
ds_read_b64_tr_b16 a[152:153], v19 offset:32768
ds_read_b64_tr_b16 a[154:155], v19 offset:34816
M v[96:99], a[176:179], a[32:35], v[96:99]
M v[96:99], a[180:183], a[36:39], v[96:99]
M v[100:103], a[180:183], a[44:47], v[100:103]
M v[100:103], a[176:179], a[40:43], v[100:103]
M v[104:107], a[176:179], a[48:51], v[104:107]
s_add_u32 s94, s93, 8192
buffer_store_dwordx4 a[244:247], v1, s[16:19], s94 offen offset:1024 sc1
M v[104:107], a[180:183], a[52:55], v[104:107]
M v[108:111], a[180:183], a[60:63], v[108:111]
M v[108:111], a[176:179], a[56:59], v[108:111]
s_waitcnt vmcnt(11) lgkmcnt(0)
s_barrier
ds_read_b128 a[160:163], v10 offset:16384
ds_read_b128 a[164:167], v11 offset:16384
M v[112:115], a[176:179], a[64:67], v[112:115]
s_add_u32 m0, s29, 49152
s_add_u32 s3, s23, s31
buffer_load_dwordx4 v2, s[8:11], s3 offen offset:0 lds
M v[112:115], a[180:183], a[68:71], v[112:115]
M v[116:119], a[180:183], a[76:79], v[116:119]
M v[116:119], a[176:179], a[72:75], v[116:119]
ds_read_b64_tr_b16 a[100:101], v12 offset:49152
ds_read_b64_tr_b16 a[102:103], v12 offset:51200
M v[120:123], a[176:179], a[80:83], v[120:123]
M v[120:123], a[180:183], a[84:87], v[120:123]
buffer_load_dwordx4 v3, s[8:11], s3 offen offset:1024 lds
M v[124:127], a[180:183], a[92:95], v[124:127]
M v[124:127], a[176:179], a[88:91], v[124:127]
M v[128:131], a[184:187], a[32:35], v[128:131]
M v[128:131], a[188:191], a[36:39], v[128:131]
ds_read_b128 a[168:171], v10 offset:18432
ds_read_b128 a[172:175], v11 offset:18432
ds_read_b64_tr_b16 a[108:109], v13 offset:49152
ds_read_b64_tr_b16 a[110:111], v13 offset:51200
M v[132:135], a[188:191], a[44:47], v[132:135]
M v[132:135], a[184:187], a[40:43], v[132:135]
M v[136:139], a[184:187], a[48:51], v[136:139]
buffer_load_dwordx4 v4, s[8:11], s3 offen offset:2048 lds
M v[136:139], a[188:191], a[52:55], v[136:139]
M v[140:143], a[188:191], a[60:63], v[140:143]
M v[140:143], a[184:187], a[56:59], v[140:143]
ds_read_b64_tr_b16 a[116:117], v14 offset:49152
ds_read_b64_tr_b16 a[118:119], v14 offset:51200
M v[144:147], a[184:187], a[64:67], v[144:147]
M v[144:147], a[188:191], a[68:71], v[144:147]
buffer_load_dwordx4 v5, s[8:11], s3 offen offset:3072 lds
M v[148:151], a[188:191], a[76:79], v[148:151]
M v[148:151], a[184:187], a[72:75], v[148:151]
M v[152:155], a[184:187], a[80:83], v[152:155]
M v[152:155], a[188:191], a[84:87], v[152:155]
ds_read_b64_tr_b16 a[124:125], v15 offset:49152
ds_read_b64_tr_b16 a[126:127], v15 offset:51200
M v[156:159], a[188:191], a[92:95], v[156:159]
M v[156:159], a[184:187], a[88:91], v[156:159]
s_waitcnt lgkmcnt(10)
M v[160:163], a[160:163], a[32:35], v[160:163]
s_add_u32 s94, s93, 8192
buffer_store_dwordx4 a[248:251], v1, s[16:19], s94 offen offset:2048 sc1
M v[160:163], a[164:167], a[36:39], v[160:163]
ds_read_b128 a[176:179], v10 offset:20480
ds_read_b128 a[180:183], v11 offset:20480
M v[164:167], a[164:167], a[44:47], v[164:167]
s_add_u32 s23, s23, 128
s_cmp_eq_u32 s23, s25
s_cselect_b32 s23, s26, s23
M v[164:167], a[160:163], a[40:43], v[164:167]
ds_read_b64_tr_b16 a[132:133], v16 offset:49152
ds_read_b64_tr_b16 a[134:135], v16 offset:51200
M v[168:171], a[160:163], a[48:51], v[168:171]
M v[168:171], a[164:167], a[52:55], v[168:171]
M v[172:175], a[164:167], a[60:63], v[172:175]
M v[172:175], a[160:163], a[56:59], v[172:175]
M v[176:179], a[160:163], a[64:67], v[176:179]
s_add_u32 m0, s29, 81920
s_nop 0
buffer_load_dwordx4 v6, s[12:15], s24 offen offset:0 lds
M v[176:179], a[164:167], a[68:71], v[176:179]
ds_read_b64_tr_b16 a[140:141], v17 offset:49152
ds_read_b64_tr_b16 a[142:143], v17 offset:51200
M v[180:183], a[164:167], a[76:79], v[180:183]
M v[180:183], a[160:163], a[72:75], v[180:183]
M v[184:187], a[160:163], a[80:83], v[184:187]
M v[184:187], a[164:167], a[84:87], v[184:187]
buffer_load_dwordx4 v7, s[12:15], s24 offen offset:1024 lds
M v[188:191], a[164:167], a[92:95], v[188:191]
M v[188:191], a[160:163], a[88:91], v[188:191]
s_waitcnt lgkmcnt(12)
ds_read_b64_tr_b16 a[148:149], v18 offset:49152
ds_read_b64_tr_b16 a[150:151], v18 offset:51200
M v[192:195], a[168:171], a[32:35], v[192:195]
M v[192:195], a[172:175], a[36:39], v[192:195]
ds_read_b128 a[184:187], v10 offset:22528
ds_read_b128 a[188:191], v11 offset:22528
M v[196:199], a[172:175], a[44:47], v[196:199]
M v[196:199], a[168:171], a[40:43], v[196:199]
M v[200:203], a[168:171], a[48:51], v[200:203]
buffer_load_dwordx4 v8, s[12:15], s24 offen offset:2048 lds
M v[200:203], a[172:175], a[52:55], v[200:203]
ds_read_b64_tr_b16 a[156:157], v19 offset:49152
ds_read_b64_tr_b16 a[158:159], v19 offset:51200
M v[204:207], a[172:175], a[60:63], v[204:207]
M v[204:207], a[168:171], a[56:59], v[204:207]
M v[208:211], a[168:171], a[64:67], v[208:211]
M v[208:211], a[172:175], a[68:71], v[208:211]
buffer_load_dwordx4 v9, s[12:15], s24 offen offset:3072 lds
M v[212:215], a[172:175], a[76:79], v[212:215]
M v[212:215], a[168:171], a[72:75], v[212:215]
M v[216:219], a[168:171], a[80:83], v[216:219]
s_add_u32 s94, s93, 8192
buffer_store_dwordx4 a[252:255], v1, s[16:19], s94 offen offset:3072 sc1
M v[216:219], a[172:175], a[84:87], v[216:219]
M v[220:223], a[172:175], a[92:95], v[220:223]
M v[220:223], a[168:171], a[88:91], v[220:223]
s_waitcnt lgkmcnt(10)
M v[224:227], a[176:179], a[32:35], v[224:227]
s_add_u32 s24, s24, 262144
s_cmp_eq_u32 s24, s27
s_cselect_b32 s24, s28, s24
s_sub_u32 s6, s6, 1
s_cmp_eq_u32 s6, 0
s_cselect_b64 s[12:13], s[64:65], s[12:13]
M v[224:227], a[180:183], a[36:39], v[224:227]
M v[228:231], a[180:183], a[44:47], v[228:231]
M v[228:231], a[176:179], a[40:43], v[228:231]
M v[232:235], a[176:179], a[48:51], v[232:235]
M v[232:235], a[180:183], a[52:55], v[232:235]
M v[236:239], a[180:183], a[60:63], v[236:239]
M v[236:239], a[176:179], a[56:59], v[236:239]
s_waitcnt vmcnt(11) lgkmcnt(0)
s_barrier
ds_read_b128 a[160:163], v10 offset:32768
ds_read_b128 a[164:167], v11 offset:32768
M v[240:243], a[176:179], a[64:67], v[240:243]
s_add_u32 m0, s29, 0
s_nop 0
buffer_load_dwordx4 v2, s[8:11], s23 offen offset:0 lds
M v[240:243], a[180:183], a[68:71], v[240:243]
M v[244:247], a[180:183], a[76:79], v[244:247]
M v[244:247], a[176:179], a[72:75], v[244:247]
M v[248:251], a[176:179], a[80:83], v[248:251]
M v[248:251], a[180:183], a[84:87], v[248:251]
buffer_load_dwordx4 v3, s[8:11], s23 offen offset:1024 lds
M v[252:255], a[180:183], a[92:95], v[252:255]
M v[252:255], a[176:179], a[88:91], v[252:255]
M a[0:3], a[184:187], a[32:35], a[0:3]
M a[0:3], a[188:191], a[36:39], a[0:3]
ds_read_b128 a[168:171], v10 offset:34816
ds_read_b128 a[172:175], v11 offset:34816
M a[4:7], a[188:191], a[44:47], a[4:7]
M a[4:7], a[184:187], a[40:43], a[4:7]
M a[8:11], a[184:187], a[48:51], a[8:11]
buffer_load_dwordx4 v4, s[8:11], s23 offen offset:2048 lds
M a[8:11], a[188:191], a[52:55], a[8:11]
M a[12:15], a[188:191], a[60:63], a[12:15]
M a[12:15], a[184:187], a[56:59], a[12:15]
M a[16:19], a[184:187], a[64:67], a[16:19]
M a[16:19], a[188:191], a[68:71], a[16:19]
buffer_load_dwordx4 v5, s[8:11], s23 offen offset:3072 lds
M a[20:23], a[188:191], a[76:79], a[20:23]
M a[20:23], a[184:187], a[72:75], a[20:23]
M a[24:27], a[184:187], a[80:83], a[24:27]
M a[24:27], a[188:191], a[84:87], a[24:27]
M a[28:31], a[188:191], a[92:95], a[28:31]
M a[28:31], a[184:187], a[88:91], a[28:31]
s_waitcnt lgkmcnt(2)
M v[32:35], a[160:163], a[96:99], v[32:35]
s_add_u32 m0, s29, 98304
s_nop 0
buffer_load_dwordx4 v6, s[12:15], s24 offen offset:0 lds
M v[32:35], a[164:167], a[100:103], v[32:35]
ds_read_b128 a[176:179], v10 offset:36864
ds_read_b128 a[180:183], v11 offset:36864
M v[36:39], a[164:167], a[108:111], v[36:39]
M v[36:39], a[160:163], a[104:107], v[36:39]
ds_read_b64_tr_b16 a[32:33], v12 offset:0
ds_read_b64_tr_b16 a[34:35], v12 offset:2048
M v[40:43], a[160:163], a[112:115], v[40:43]
M v[40:43], a[164:167], a[116:119], v[40:43]
M v[44:47], a[164:167], a[124:127], v[44:47]
M v[44:47], a[160:163], a[120:123], v[44:47]
ds_read_b64_tr_b16 a[40:41], v13 offset:0
ds_read_b64_tr_b16 a[42:43], v13 offset:2048
M v[48:51], a[160:163], a[128:131], v[48:51]
buffer_load_dwordx4 v7, s[12:15], s24 offen offset:1024 lds
M v[48:51], a[164:167], a[132:135], v[48:51]
M v[52:55], a[164:167], a[140:143], v[52:55]
M v[52:55], a[160:163], a[136:139], v[52:55]
ds_read_b64_tr_b16 a[48:49], v14 offset:0
ds_read_b64_tr_b16 a[50:51], v14 offset:2048
M v[56:59], a[160:163], a[144:147], v[56:59]
M v[56:59], a[164:167], a[148:151], v[56:59]
M v[60:63], a[164:167], a[156:159], v[60:63]
buffer_load_dwordx4 v8, s[12:15], s24 offen offset:2048 lds
M v[60:63], a[160:163], a[152:155], v[60:63]
s_waitcnt lgkmcnt(8)
ds_read_b64_tr_b16 a[56:57], v15 offset:0
ds_read_b64_tr_b16 a[58:59], v15 offset:2048
M v[64:67], a[168:171], a[96:99], v[64:67]
M v[64:67], a[172:175], a[100:103], v[64:67]
ds_read_b128 a[184:187], v10 offset:38912
ds_read_b128 a[188:191], v11 offset:38912
M v[68:71], a[172:175], a[108:111], v[68:71]
M v[68:71], a[168:171], a[104:107], v[68:71]
ds_read_b64_tr_b16 a[64:65], v16 offset:0
ds_read_b64_tr_b16 a[66:67], v16 offset:2048
M v[72:75], a[168:171], a[112:115], v[72:75]
M v[72:75], a[172:175], a[116:119], v[72:75]
M v[76:79], a[172:175], a[124:127], v[76:79]
M v[76:79], a[168:171], a[120:123], v[76:79]
ds_read_b64_tr_b16 a[72:73], v17 offset:0
ds_read_b64_tr_b16 a[74:75], v17 offset:2048
M v[80:83], a[168:171], a[128:131], v[80:83]
buffer_load_dwordx4 v9, s[12:15], s24 offen offset:3072 lds
M v[80:83], a[172:175], a[132:135], v[80:83]
M v[84:87], a[172:175], a[140:143], v[84:87]
M v[84:87], a[168:171], a[136:139], v[84:87]
ds_read_b64_tr_b16 a[80:81], v18 offset:0
ds_read_b64_tr_b16 a[82:83], v18 offset:2048
M v[88:91], a[168:171], a[144:147], v[88:91]
M v[88:91], a[172:175], a[148:151], v[88:91]
M v[92:95], a[172:175], a[156:159], v[92:95]
s_add_u32 s24, s24, 262144
M v[92:95], a[168:171], a[152:155], v[92:95]
s_waitcnt lgkmcnt(15)
ds_read_b64_tr_b16 a[88:89], v19 offset:0
ds_read_b64_tr_b16 a[90:91], v19 offset:2048
M v[96:99], a[176:179], a[96:99], v[96:99]
M v[96:99], a[180:183], a[100:103], v[96:99]
M v[100:103], a[180:183], a[108:111], v[100:103]
M v[100:103], a[176:179], a[104:107], v[100:103]
M v[104:107], a[176:179], a[112:115], v[104:107]
M v[104:107], a[180:183], a[116:119], v[104:107]
M v[108:111], a[180:183], a[124:127], v[108:111]
M v[108:111], a[176:179], a[120:123], v[108:111]
s_waitcnt vmcnt(9) lgkmcnt(0)
s_barrier
ds_read_b128 a[160:163], v10 offset:49152
ds_read_b128 a[164:167], v11 offset:49152
M v[112:115], a[176:179], a[128:131], v[112:115]
s_add_u32 m0, s29, 16384
s_add_u32 s3, s23, s31
buffer_load_dwordx4 v2, s[8:11], s3 offen offset:0 lds
M v[112:115], a[180:183], a[132:135], v[112:115]
M v[116:119], a[180:183], a[140:143], v[116:119]
M v[116:119], a[176:179], a[136:139], v[116:119]
ds_read_b64_tr_b16 a[36:37], v12 offset:16384
ds_read_b64_tr_b16 a[38:39], v12 offset:18432
M v[120:123], a[176:179], a[144:147], v[120:123]
M v[120:123], a[180:183], a[148:151], v[120:123]
buffer_load_dwordx4 v3, s[8:11], s3 offen offset:1024 lds
M v[124:127], a[180:183], a[156:159], v[124:127]
M v[124:127], a[176:179], a[152:155], v[124:127]
M v[128:131], a[184:187], a[96:99], v[128:131]
M v[128:131], a[188:191], a[100:103], v[128:131]
ds_read_b128 a[168:171], v10 offset:51200
ds_read_b128 a[172:175], v11 offset:51200
ds_read_b64_tr_b16 a[44:45], v13 offset:16384
ds_read_b64_tr_b16 a[46:47], v13 offset:18432
M v[132:135], a[188:191], a[108:111], v[132:135]
M v[132:135], a[184:187], a[104:107], v[132:135]
M v[136:139], a[184:187], a[112:115], v[136:139]
buffer_load_dwordx4 v4, s[8:11], s3 offen offset:2048 lds
M v[136:139], a[188:191], a[116:119], v[136:139]
M v[140:143], a[188:191], a[124:127], v[140:143]
M v[140:143], a[184:187], a[120:123], v[140:143]
ds_read_b64_tr_b16 a[52:53], v14 offset:16384
ds_read_b64_tr_b16 a[54:55], v14 offset:18432
M v[144:147], a[184:187], a[128:131], v[144:147]
M v[144:147], a[188:191], a[132:135], v[144:147]
M v[148:151], a[188:191], a[140:143], v[148:151]
buffer_load_dwordx4 v5, s[8:11], s3 offen offset:3072 lds
M v[148:151], a[184:187], a[136:139], v[148:151]
M v[152:155], a[184:187], a[144:147], v[152:155]
M v[152:155], a[188:191], a[148:151], v[152:155]
ds_read_b64_tr_b16 a[60:61], v15 offset:16384
ds_read_b64_tr_b16 a[62:63], v15 offset:18432
M v[156:159], a[188:191], a[156:159], v[156:159]
M v[156:159], a[184:187], a[152:155], v[156:159]
s_waitcnt lgkmcnt(10)
M v[160:163], a[160:163], a[96:99], v[160:163]
M v[160:163], a[164:167], a[100:103], v[160:163]
ds_read_b128 a[176:179], v10 offset:53248
ds_read_b128 a[180:183], v11 offset:53248
M v[164:167], a[164:167], a[108:111], v[164:167]
s_add_u32 s23, s23, 128
s_cmp_eq_u32 s23, s25
s_cselect_b32 s23, s26, s23
M v[164:167], a[160:163], a[104:107], v[164:167]
ds_read_b64_tr_b16 a[68:69], v16 offset:16384
ds_read_b64_tr_b16 a[70:71], v16 offset:18432
M v[168:171], a[160:163], a[112:115], v[168:171]
M v[168:171], a[164:167], a[116:119], v[168:171]
M v[172:175], a[164:167], a[124:127], v[172:175]
M v[172:175], a[160:163], a[120:123], v[172:175]
M v[176:179], a[160:163], a[128:131], v[176:179]
s_add_u32 m0, s29, 114688
s_nop 0
buffer_load_dwordx4 v6, s[12:15], s24 offen offset:0 lds
M v[176:179], a[164:167], a[132:135], v[176:179]
ds_read_b64_tr_b16 a[76:77], v17 offset:16384
ds_read_b64_tr_b16 a[78:79], v17 offset:18432
M v[180:183], a[164:167], a[140:143], v[180:183]
M v[180:183], a[160:163], a[136:139], v[180:183]
M v[184:187], a[160:163], a[144:147], v[184:187]
M v[184:187], a[164:167], a[148:151], v[184:187]
buffer_load_dwordx4 v7, s[12:15], s24 offen offset:1024 lds
M v[188:191], a[164:167], a[156:159], v[188:191]
M v[188:191], a[160:163], a[152:155], v[188:191]
s_waitcnt lgkmcnt(12)
ds_read_b64_tr_b16 a[84:85], v18 offset:16384
ds_read_b64_tr_b16 a[86:87], v18 offset:18432
M v[192:195], a[168:171], a[96:99], v[192:195]
M v[192:195], a[172:175], a[100:103], v[192:195]
ds_read_b128 a[184:187], v10 offset:55296
ds_read_b128 a[188:191], v11 offset:55296
M v[196:199], a[172:175], a[108:111], v[196:199]
M v[196:199], a[168:171], a[104:107], v[196:199]
M v[200:203], a[168:171], a[112:115], v[200:203]
buffer_load_dwordx4 v8, s[12:15], s24 offen offset:2048 lds
M v[200:203], a[172:175], a[116:119], v[200:203]
ds_read_b64_tr_b16 a[92:93], v19 offset:16384
ds_read_b64_tr_b16 a[94:95], v19 offset:18432
M v[204:207], a[172:175], a[124:127], v[204:207]
M v[204:207], a[168:171], a[120:123], v[204:207]
M v[208:211], a[168:171], a[128:131], v[208:211]
M v[208:211], a[172:175], a[132:135], v[208:211]
M v[212:215], a[172:175], a[140:143], v[212:215]
buffer_load_dwordx4 v9, s[12:15], s24 offen offset:3072 lds
M v[212:215], a[168:171], a[136:139], v[212:215]
M v[216:219], a[168:171], a[144:147], v[216:219]
M v[216:219], a[172:175], a[148:151], v[216:219]
M v[220:223], a[172:175], a[156:159], v[220:223]
M v[220:223], a[168:171], a[152:155], v[220:223]
s_waitcnt lgkmcnt(10)
M v[224:227], a[176:179], a[96:99], v[224:227]
s_add_u32 s24, s24, 262144
s_cmp_eq_u32 s24, s27
s_cselect_b32 s24, s28, s24
s_sub_u32 s6, s6, 1
s_cmp_eq_u32 s6, 0
s_cselect_b64 s[12:13], s[64:65], s[12:13]
M v[224:227], a[180:183], a[100:103], v[224:227]
M v[228:231], a[180:183], a[108:111], v[228:231]
M v[228:231], a[176:179], a[104:107], v[228:231]
M v[232:235], a[176:179], a[112:115], v[232:235]
M v[232:235], a[180:183], a[116:119], v[232:235]
M v[236:239], a[180:183], a[124:127], v[236:239]
M v[236:239], a[176:179], a[120:123], v[236:239]
s_waitcnt vmcnt(8) lgkmcnt(0)
s_barrier
ds_read_b128 a[160:163], v10 offset:0
ds_read_b128 a[164:167], v11 offset:0
M v[240:243], a[176:179], a[128:131], v[240:243]
s_add_u32 m0, s29, 32768
s_nop 0
buffer_load_dwordx4 v2, s[8:11], s23 offen offset:0 lds
M v[240:243], a[180:183], a[132:135], v[240:243]
M v[244:247], a[180:183], a[140:143], v[244:247]
M v[244:247], a[176:179], a[136:139], v[244:247]
M v[248:251], a[176:179], a[144:147], v[248:251]
M v[248:251], a[180:183], a[148:151], v[248:251]
M v[252:255], a[180:183], a[156:159], v[252:255]
M v[252:255], a[176:179], a[152:155], v[252:255]
M a[0:3], a[184:187], a[96:99], a[0:3]
M a[0:3], a[188:191], a[100:103], a[0:3]
ds_read_b128 a[168:171], v10 offset:2048
ds_read_b128 a[172:175], v11 offset:2048
M a[4:7], a[188:191], a[108:111], a[4:7]
M a[4:7], a[184:187], a[104:107], a[4:7]
M a[8:11], a[184:187], a[112:115], a[8:11]
buffer_load_dwordx4 v3, s[8:11], s23 offen offset:1024 lds
M a[8:11], a[188:191], a[116:119], a[8:11]
M a[12:15], a[188:191], a[124:127], a[12:15]
M a[12:15], a[184:187], a[120:123], a[12:15]
M a[16:19], a[184:187], a[128:131], a[16:19]
M a[16:19], a[188:191], a[132:135], a[16:19]
M a[20:23], a[188:191], a[140:143], a[20:23]
M a[20:23], a[184:187], a[136:139], a[20:23]
M a[24:27], a[184:187], a[144:147], a[24:27]
M a[24:27], a[188:191], a[148:151], a[24:27]
M a[28:31], a[188:191], a[156:159], a[28:31]
M a[28:31], a[184:187], a[152:155], a[28:31]
s_waitcnt lgkmcnt(2)
M v[32:35], a[160:163], a[32:35], v[32:35]
buffer_load_dwordx4 v4, s[8:11], s23 offen offset:2048 lds
M v[32:35], a[164:167], a[36:39], v[32:35]
ds_read_b128 a[176:179], v10 offset:4096
ds_read_b128 a[180:183], v11 offset:4096
M v[36:39], a[164:167], a[44:47], v[36:39]
M v[36:39], a[160:163], a[40:43], v[36:39]
ds_read_b64_tr_b16 a[96:97], v12 offset:32768
ds_read_b64_tr_b16 a[98:99], v12 offset:34816
M v[40:43], a[160:163], a[48:51], v[40:43]
M v[40:43], a[164:167], a[52:55], v[40:43]
M v[44:47], a[164:167], a[60:63], v[44:47]
M v[44:47], a[160:163], a[56:59], v[44:47]
ds_read_b64_tr_b16 a[104:105], v13 offset:32768
ds_read_b64_tr_b16 a[106:107], v13 offset:34816
M v[48:51], a[160:163], a[64:67], v[48:51]
M v[48:51], a[164:167], a[68:71], v[48:51]
M v[52:55], a[164:167], a[76:79], v[52:55]
M v[52:55], a[160:163], a[72:75], v[52:55]
ds_read_b64_tr_b16 a[112:113], v14 offset:32768
ds_read_b64_tr_b16 a[114:115], v14 offset:34816
M v[56:59], a[160:163], a[80:83], v[56:59]
M v[56:59], a[164:167], a[84:87], v[56:59]
M v[60:63], a[164:167], a[92:95], v[60:63]
M v[60:63], a[160:163], a[88:91], v[60:63]
s_waitcnt lgkmcnt(8)
ds_read_b64_tr_b16 a[120:121], v15 offset:32768
ds_read_b64_tr_b16 a[122:123], v15 offset:34816
M v[64:67], a[168:171], a[32:35], v[64:67]
M v[64:67], a[172:175], a[36:39], v[64:67]
ds_read_b128 a[184:187], v10 offset:6144
ds_read_b128 a[188:191], v11 offset:6144
M v[68:71], a[172:175], a[44:47], v[68:71]
M v[68:71], a[168:171], a[40:43], v[68:71]
ds_read_b64_tr_b16 a[128:129], v16 offset:32768
ds_read_b64_tr_b16 a[130:131], v16 offset:34816
M v[72:75], a[168:171], a[48:51], v[72:75]
buffer_load_dwordx4 v5, s[8:11], s23 offen offset:3072 lds
M v[72:75], a[172:175], a[52:55], v[72:75]
M v[76:79], a[172:175], a[60:63], v[76:79]
M v[76:79], a[168:171], a[56:59], v[76:79]
ds_read_b64_tr_b16 a[136:137], v17 offset:32768
ds_read_b64_tr_b16 a[138:139], v17 offset:34816
M v[80:83], a[168:171], a[64:67], v[80:83]
M v[80:83], a[172:175], a[68:71], v[80:83]
M v[84:87], a[172:175], a[76:79], v[84:87]
M v[84:87], a[168:171], a[72:75], v[84:87]
ds_read_b64_tr_b16 a[144:145], v18 offset:32768
ds_read_b64_tr_b16 a[146:147], v18 offset:34816
M v[88:91], a[168:171], a[80:83], v[88:91]
M v[88:91], a[172:175], a[84:87], v[88:91]
M v[92:95], a[172:175], a[92:95], v[92:95]
M v[92:95], a[168:171], a[88:91], v[92:95]
s_waitcnt lgkmcnt(15)
ds_read_b64_tr_b16 a[152:153], v19 offset:32768
ds_read_b64_tr_b16 a[154:155], v19 offset:34816
M v[96:99], a[176:179], a[32:35], v[96:99]
M v[96:99], a[180:183], a[36:39], v[96:99]
M v[100:103], a[180:183], a[44:47], v[100:103]
M v[100:103], a[176:179], a[40:43], v[100:103]
M v[104:107], a[176:179], a[48:51], v[104:107]
M v[104:107], a[180:183], a[52:55], v[104:107]
M v[108:111], a[180:183], a[60:63], v[108:111]
M v[108:111], a[176:179], a[56:59], v[108:111]
s_waitcnt vmcnt(4) lgkmcnt(0)
s_barrier
ds_read_b128 a[160:163], v10 offset:16384
ds_read_b128 a[164:167], v11 offset:16384
M v[112:115], a[176:179], a[64:67], v[112:115]
s_add_u32 m0, s29, 49152
s_add_u32 s3, s23, s31
buffer_load_dwordx4 v2, s[8:11], s3 offen offset:0 lds
M v[112:115], a[180:183], a[68:71], v[112:115]
M v[116:119], a[180:183], a[76:79], v[116:119]
buffer_load_dwordx4 v3, s[8:11], s3 offen offset:1024 lds
M v[116:119], a[176:179], a[72:75], v[116:119]
ds_read_b64_tr_b16 a[100:101], v12 offset:49152
ds_read_b64_tr_b16 a[102:103], v12 offset:51200
M v[120:123], a[176:179], a[80:83], v[120:123]
buffer_load_dwordx4 v4, s[8:11], s3 offen offset:2048 lds
M v[120:123], a[180:183], a[84:87], v[120:123]
M v[124:127], a[180:183], a[92:95], v[124:127]
buffer_load_dwordx4 v5, s[8:11], s3 offen offset:3072 lds
M v[124:127], a[176:179], a[88:91], v[124:127]
M v[128:131], a[184:187], a[32:35], v[128:131]
M v[128:131], a[188:191], a[36:39], v[128:131]
ds_read_b128 a[168:171], v10 offset:18432
ds_read_b128 a[172:175], v11 offset:18432
ds_read_b64_tr_b16 a[108:109], v13 offset:49152
ds_read_b64_tr_b16 a[110:111], v13 offset:51200
M v[132:135], a[188:191], a[44:47], v[132:135]
M v[132:135], a[184:187], a[40:43], v[132:135]
M v[136:139], a[184:187], a[48:51], v[136:139]
s_and_b32 s3, s2, 1
s_lshl_b32 s3, s3, 3
s_bfe_u32 s4, s2, 0x30003
M v[136:139], a[188:191], a[52:55], v[136:139]
s_add_u32 s26, s3, s4
s_bfe_u32 s3, s2, 0x20001
s_lshl_b32 s3, s3, 2
M v[140:143], a[188:191], a[60:63], v[140:143]
s_lshr_b32 s4, s2, 6
s_xor_b32 s4, s4, 3
s_add_u32 s27, s3, s4
M v[140:143], a[184:187], a[56:59], v[140:143]
ds_read_b64_tr_b16 a[116:117], v14 offset:49152
ds_read_b64_tr_b16 a[118:119], v14 offset:51200
s_lshl_b32 s23, s26, 18
s_sub_u32 s24, s23, 32768
s_max_i32 s24, s24, 0
M v[144:147], a[184:187], a[64:67], v[144:147]
s_lshl_b32 s25, s27, 7
s_mov_b64 s[8:9], s[44:45]
s_mov_b32 s10, 4194304
M v[144:147], a[188:191], a[68:71], v[144:147]
s_mov_b64 s[12:13], s[46:47]
s_mov_b32 s14, 6291456
s_mov_b64 s[36:37], s[90:91]
M v[148:151], a[188:191], a[76:79], v[148:151]
s_mov_b32 s38, 256
s_mov_b32 s39, 0x00020000
s_lshl_b32 s28, s20, 9
M v[148:151], a[184:187], a[72:75], v[148:151]
s_mul_i32 s30, s20, 6144
s_lshl_b32 s3, s20, 5
v_lshrrev_b32 v24, 3, v0
M v[152:155], a[184:187], a[80:83], v[152:155]
v_and_b32 v25, 7, v0
v_add_u32 v28, s3, v24
v_add_u32 v26, 0, v28
M v[152:155], a[188:191], a[84:87], v[152:155]
ds_read_b64_tr_b16 a[124:125], v15 offset:49152
ds_read_b64_tr_b16 a[126:127], v15 offset:51200
v_bfe_u32 v27, v26, 1, 3
v_xor_b32 v27, v27, v25
v_lshlrev_b32 v26, 11, v26
M v[156:159], a[188:191], a[92:95], v[156:159]
v_lshl_add_u32 v26, v27, 4, v26
v_subrev_u32 v2, 0, v26
v_add_u32 v26, 8, v28
M v[156:159], a[184:187], a[88:91], v[156:159]
s_waitcnt lgkmcnt(10)
v_bfe_u32 v27, v26, 1, 3
v_xor_b32 v27, v27, v25
v_lshlrev_b32 v26, 11, v26
M v[160:163], a[160:163], a[32:35], v[160:163]
v_lshl_add_u32 v26, v27, 4, v26
v_subrev_u32 v3, 1024, v26
v_add_u32 v26, 16, v28
M v[160:163], a[164:167], a[36:39], v[160:163]
ds_read_b128 a[176:179], v10 offset:20480
ds_read_b128 a[180:183], v11 offset:20480
v_bfe_u32 v27, v26, 1, 3
v_xor_b32 v27, v27, v25
v_lshlrev_b32 v26, 11, v26
M v[164:167], a[164:167], a[44:47], v[164:167]
v_lshl_add_u32 v26, v27, 4, v26
v_subrev_u32 v4, 2048, v26
v_add_u32 v26, 24, v28
M v[164:167], a[160:163], a[40:43], v[164:167]
ds_read_b64_tr_b16 a[132:133], v16 offset:49152
ds_read_b64_tr_b16 a[134:135], v16 offset:51200
v_bfe_u32 v27, v26, 1, 3
v_xor_b32 v27, v27, v25
v_lshlrev_b32 v26, 11, v26
M v[168:171], a[160:163], a[48:51], v[168:171]
v_lshl_add_u32 v26, v27, 4, v26
v_subrev_u32 v5, 3072, v26
s_lshl_b32 s3, s20, 2
M v[168:171], a[164:167], a[52:55], v[168:171]
v_lshrrev_b32 v26, 5, v0
v_add_u32 v26, s3, v26
v_bfe_u32 v29, v0, 2, 3
M v[172:175], a[164:167], a[60:63], v[172:175]
v_bfe_u32 v27, v26, 1, 3
v_xor_b32 v27, v27, v29
v_lshlrev_b32 v27, 4, v27
M v[172:175], a[160:163], a[56:59], v[172:175]
v_and_b32 v30, 3, v0
v_lshl_add_u32 v27, v30, 2, v27
v_lshl_add_u32 v20, v26, 11, v27
M v[176:179], a[160:163], a[64:67], v[176:179]
v_add_u32 v26, 2, v26
v_bfe_u32 v27, v26, 1, 3
v_xor_b32 v27, v27, v29
M v[176:179], a[164:167], a[68:71], v[176:179]
ds_read_b64_tr_b16 a[140:141], v17 offset:49152
ds_read_b64_tr_b16 a[142:143], v17 offset:51200
v_lshlrev_b32 v27, 4, v27
v_and_b32 v30, 3, v0
v_lshl_add_u32 v27, v30, 2, v27
M v[180:183], a[164:167], a[76:79], v[180:183]
v_lshl_add_u32 v23, v26, 11, v27
v_subrev_u32 v23, 256, v23
s_mul_i32 s3, s20, 48
M v[180:183], a[160:163], a[72:75], v[180:183]
v_add_u32 v28, s3, v24
v_add_u32 v26, 0, v28
v_mul_u32_u24 v27, 0xaaab, v26
M v[184:187], a[160:163], a[80:83], v[184:187]
v_lshrrev_b32 v27, 17, v27
v_lshrrev_b32 v29, 1, v27
v_and_b32 v29, 4, v29
M v[184:187], a[164:167], a[84:87], v[184:187]
v_and_or_b32 v27, v27, 2, v29
v_xor_b32 v27, v27, v25
v_lshlrev_b32 v26, 11, v26
M v[188:191], a[164:167], a[92:95], v[188:191]
v_lshl_add_u32 v26, v27, 4, v26
v_subrev_u32 v6, 0, v26
v_add_u32 v26, 8, v28
M v[188:191], a[160:163], a[88:91], v[188:191]
s_waitcnt lgkmcnt(12)
ds_read_b64_tr_b16 a[148:149], v18 offset:49152
ds_read_b64_tr_b16 a[150:151], v18 offset:51200
v_mul_u32_u24 v27, 0xaaab, v26
v_lshrrev_b32 v27, 17, v27
v_lshrrev_b32 v29, 1, v27
M v[192:195], a[168:171], a[32:35], v[192:195]
v_and_b32 v29, 4, v29
v_and_or_b32 v27, v27, 2, v29
v_xor_b32 v27, v27, v25
M v[192:195], a[172:175], a[36:39], v[192:195]
ds_read_b128 a[184:187], v10 offset:22528
ds_read_b128 a[188:191], v11 offset:22528
v_lshlrev_b32 v26, 11, v26
v_lshl_add_u32 v26, v27, 4, v26
v_subrev_u32 v7, 1024, v26
M v[196:199], a[172:175], a[44:47], v[196:199]
v_add_u32 v26, 16, v28
v_mul_u32_u24 v27, 0xaaab, v26
v_lshrrev_b32 v27, 17, v27
M v[196:199], a[168:171], a[40:43], v[196:199]
v_lshrrev_b32 v29, 1, v27
v_and_b32 v29, 4, v29
v_and_or_b32 v27, v27, 2, v29
M v[200:203], a[168:171], a[48:51], v[200:203]
v_xor_b32 v27, v27, v25
v_lshlrev_b32 v26, 11, v26
v_lshl_add_u32 v26, v27, 4, v26
M v[200:203], a[172:175], a[52:55], v[200:203]
ds_read_b64_tr_b16 a[156:157], v19 offset:49152
ds_read_b64_tr_b16 a[158:159], v19 offset:51200
v_subrev_u32 v8, 2048, v26
v_add_u32 v26, 24, v28
v_mul_u32_u24 v27, 0xaaab, v26
M v[204:207], a[172:175], a[60:63], v[204:207]
v_lshrrev_b32 v27, 17, v27
v_lshrrev_b32 v29, 1, v27
v_and_b32 v29, 4, v29
M v[204:207], a[168:171], a[56:59], v[204:207]
v_and_or_b32 v27, v27, 2, v29
v_xor_b32 v27, v27, v25
v_lshlrev_b32 v26, 11, v26
M v[208:211], a[168:171], a[64:67], v[208:211]
v_lshl_add_u32 v26, v27, 4, v26
v_subrev_u32 v9, 3072, v26
v_add_u32 v26, 32, v28
M v[208:211], a[172:175], a[68:71], v[208:211]
v_mul_u32_u24 v27, 0xaaab, v26
v_lshrrev_b32 v27, 17, v27
v_lshrrev_b32 v29, 1, v27
M v[212:215], a[172:175], a[76:79], v[212:215]
v_and_b32 v29, 4, v29
v_and_or_b32 v27, v27, 2, v29
v_xor_b32 v27, v27, v25
M v[212:215], a[168:171], a[72:75], v[212:215]
v_lshlrev_b32 v26, 11, v26
v_lshl_add_u32 v26, v27, 4, v26
v_subrev_u32 v21, 0, v26
M v[216:219], a[168:171], a[80:83], v[216:219]
v_add_u32 v26, 40, v28
v_mul_u32_u24 v27, 0xaaab, v26
v_lshrrev_b32 v27, 17, v27
M v[216:219], a[172:175], a[84:87], v[216:219]
v_lshrrev_b32 v29, 1, v27
v_and_b32 v29, 4, v29
v_and_or_b32 v27, v27, 2, v29
M v[220:223], a[172:175], a[92:95], v[220:223]
v_xor_b32 v27, v27, v25
v_lshlrev_b32 v26, 11, v26
v_lshl_add_u32 v26, v27, 4, v26
M v[220:223], a[168:171], a[88:91], v[220:223]
s_waitcnt lgkmcnt(10)
v_subrev_u32 v22, 1024, v26
s_lshr_b32 s3, s53, 7
s_add_u32 s3, s3, s22
M v[224:227], a[176:179], a[32:35], v[224:227]
s_lshl_b32 s3, s3, 5
s_lshr_b32 s19, s52, 6
s_add_u32 s3, s3, s19
M v[224:227], a[180:183], a[36:39], v[224:227]
s_lshl_b32 s19, s21, 1
s_add_u32 s3, s3, s19
s_lshl_b32 s92, s3, 15
M v[228:231], a[180:183], a[44:47], v[228:231]
s_add_u32 s92, s92, 16384
s_add_u32 s93, s92, 32768
s_add_u32 s16, s50, 16777216
M v[228:231], a[176:179], a[40:43], v[228:231]
s_addc_u32 s17, s51, 0
s_mov_b32 s18, 33554432
s_mov_b32 s19, 0x00020000
M v[232:235], a[176:179], a[48:51], v[232:235]
M v[232:235], a[180:183], a[52:55], v[232:235]
M v[236:239], a[180:183], a[60:63], v[236:239]
M v[236:239], a[176:179], a[56:59], v[236:239]
s_waitcnt vmcnt(4) lgkmcnt(0)
s_barrier
ds_read_b128 a[160:163], v10 offset:32768
ds_read_b128 a[164:167], v11 offset:32768
M v[240:243], a[176:179], a[64:67], v[240:243]
s_add_u32 m0, s28, 131072
s_nop 0
buffer_load_dword v20, s[8:11], s24 offen lds
M v[240:243], a[180:183], a[68:71], v[240:243]
M v[244:247], a[180:183], a[76:79], v[244:247]
M v[244:247], a[176:179], a[72:75], v[244:247]
M v[248:251], a[176:179], a[80:83], v[248:251]
buffer_load_dword v23, s[8:11], s24 offen offset:256 lds
s_add_u32 s24, s24, 128
M v[248:251], a[180:183], a[84:87], v[248:251]
M v[252:255], a[180:183], a[92:95], v[252:255]
M v[252:255], a[176:179], a[88:91], v[252:255]
M a[0:3], a[184:187], a[32:35], a[0:3]
M a[0:3], a[188:191], a[36:39], a[0:3]
ds_read_b128 a[168:171], v10 offset:34816
ds_read_b128 a[172:175], v11 offset:34816
M a[4:7], a[188:191], a[44:47], a[4:7]
s_add_u32 m0, s29, 133120
s_nop 0
buffer_load_dwordx4 v2, s[8:11], s23 offen offset:0 lds
M a[4:7], a[184:187], a[40:43], a[4:7]
M a[8:11], a[184:187], a[48:51], a[8:11]
M a[8:11], a[188:191], a[52:55], a[8:11]
M a[12:15], a[188:191], a[60:63], a[12:15]
buffer_load_dwordx4 v3, s[8:11], s23 offen offset:1024 lds
M a[12:15], a[184:187], a[56:59], a[12:15]
M a[16:19], a[184:187], a[64:67], a[16:19]
M a[16:19], a[188:191], a[68:71], a[16:19]
M a[20:23], a[188:191], a[76:79], a[20:23]
buffer_load_dwordx4 v4, s[8:11], s23 offen offset:2048 lds
M a[20:23], a[184:187], a[72:75], a[20:23]
M a[24:27], a[184:187], a[80:83], a[24:27]
M a[24:27], a[188:191], a[84:87], a[24:27]
M a[28:31], a[188:191], a[92:95], a[28:31]
M a[28:31], a[184:187], a[88:91], a[28:31]
s_waitcnt lgkmcnt(2)
M v[32:35], a[160:163], a[96:99], v[32:35]
buffer_load_dwordx4 v5, s[8:11], s23 offen offset:3072 lds
s_add_u32 s23, s23, 128
M v[32:35], a[164:167], a[100:103], v[32:35]
ds_read_b128 a[176:179], v10 offset:36864
ds_read_b128 a[180:183], v11 offset:36864
M v[36:39], a[164:167], a[108:111], v[36:39]
M v[36:39], a[160:163], a[104:107], v[36:39]
M v[40:43], a[160:163], a[112:115], v[40:43]
M v[40:43], a[164:167], a[116:119], v[40:43]
s_add_u32 m0, s30, 65536
s_nop 0
buffer_load_dwordx4 v6, s[12:15], s25 offen offset:0 lds
M v[44:47], a[164:167], a[124:127], v[44:47]
M v[44:47], a[160:163], a[120:123], v[44:47]
M v[48:51], a[160:163], a[128:131], v[48:51]
M v[48:51], a[164:167], a[132:135], v[48:51]
M v[52:55], a[164:167], a[140:143], v[52:55]
buffer_load_dwordx4 v7, s[12:15], s25 offen offset:1024 lds
M v[52:55], a[160:163], a[136:139], v[52:55]
M v[56:59], a[160:163], a[144:147], v[56:59]
M v[56:59], a[164:167], a[148:151], v[56:59]
M v[60:63], a[164:167], a[156:159], v[60:63]
M v[60:63], a[160:163], a[152:155], v[60:63]
s_waitcnt lgkmcnt(2)
M v[64:67], a[168:171], a[96:99], v[64:67]
buffer_load_dwordx4 v8, s[12:15], s25 offen offset:2048 lds
M v[64:67], a[172:175], a[100:103], v[64:67]
ds_read_b128 a[184:187], v10 offset:38912
ds_read_b128 a[188:191], v11 offset:38912
M v[68:71], a[172:175], a[108:111], v[68:71]
M v[68:71], a[168:171], a[104:107], v[68:71]
M v[72:75], a[168:171], a[112:115], v[72:75]
M v[72:75], a[172:175], a[116:119], v[72:75]
buffer_load_dwordx4 v9, s[12:15], s25 offen offset:3072 lds
M v[76:79], a[172:175], a[124:127], v[76:79]
M v[76:79], a[168:171], a[120:123], v[76:79]
M v[80:83], a[168:171], a[128:131], v[80:83]
M v[80:83], a[172:175], a[132:135], v[80:83]
M v[84:87], a[172:175], a[140:143], v[84:87]
s_add_u32 m0, s30, 69632
s_nop 0
buffer_load_dwordx4 v21, s[12:15], s25 offen offset:0 lds
M v[84:87], a[168:171], a[136:139], v[84:87]
M v[88:91], a[168:171], a[144:147], v[88:91]
M v[88:91], a[172:175], a[148:151], v[88:91]
M v[92:95], a[172:175], a[156:159], v[92:95]
M v[92:95], a[168:171], a[152:155], v[92:95]
s_waitcnt lgkmcnt(2)
M v[96:99], a[176:179], a[96:99], v[96:99]
buffer_load_dwordx4 v22, s[12:15], s25 offen offset:1024 lds
s_add_u32 s25, s25, 393216
M v[96:99], a[180:183], a[100:103], v[96:99]
M v[100:103], a[180:183], a[108:111], v[100:103]
M v[100:103], a[176:179], a[104:107], v[100:103]
v_cvt_pk_bf16_f32 v32, v32, v33
v_cvt_pk_bf16_f32 v33, v34, v35
M v[104:107], a[176:179], a[112:115], v[104:107]
v_cvt_pk_bf16_f32 v34, v64, v65
v_cvt_pk_bf16_f32 v35, v66, v67
M v[104:107], a[180:183], a[116:119], v[104:107]
v_cvt_pk_bf16_f32 v64, v48, v49
M v[108:111], a[180:183], a[124:127], v[108:111]
v_cvt_pk_bf16_f32 v65, v50, v51
v_cvt_pk_bf16_f32 v66, v80, v81
M v[108:111], a[176:179], a[120:123], v[108:111]
s_waitcnt vmcnt(12) lgkmcnt(0)
s_barrier
ds_read_b128 a[160:163], v10 offset:49152
ds_read_b128 a[164:167], v11 offset:49152
v_cvt_pk_bf16_f32 v67, v82, v83
M v[112:115], a[176:179], a[128:131], v[112:115]
s_add_u32 m0, s28, 0
s_nop 0
buffer_load_dword v20, s[8:11], s24 offen lds
v_cvt_pk_bf16_f32 v48, v40, v41
v_cvt_pk_bf16_f32 v49, v42, v43
M v[112:115], a[180:183], a[132:135], v[112:115]
v_cvt_pk_bf16_f32 v50, v72, v73
v_cvt_pk_bf16_f32 v51, v74, v75
M v[116:119], a[180:183], a[140:143], v[116:119]
v_cvt_pk_bf16_f32 v80, v56, v57
M v[116:119], a[176:179], a[136:139], v[116:119]
buffer_load_dword v23, s[8:11], s24 offen offset:256 lds
s_add_u32 s24, s24, 128
v_cvt_pk_bf16_f32 v81, v58, v59
v_cvt_pk_bf16_f32 v82, v88, v89
M v[120:123], a[176:179], a[144:147], v[120:123]
v_cvt_pk_bf16_f32 v83, v90, v91
M v[120:123], a[180:183], a[148:151], v[120:123]
v_cvt_pk_bf16_f32 v40, v36, v37
v_cvt_pk_bf16_f32 v41, v38, v39
M v[124:127], a[180:183], a[156:159], v[124:127]
v_cvt_pk_bf16_f32 v42, v68, v69
v_cvt_pk_bf16_f32 v43, v70, v71
M v[124:127], a[176:179], a[152:155], v[124:127]
v_cvt_pk_bf16_f32 v72, v52, v53
M v[128:131], a[184:187], a[96:99], v[128:131]
s_add_u32 m0, s29, 2048
s_nop 0
buffer_load_dwordx4 v2, s[8:11], s23 offen offset:0 lds
v_cvt_pk_bf16_f32 v73, v54, v55
v_cvt_pk_bf16_f32 v74, v84, v85
M v[128:131], a[188:191], a[100:103], v[128:131]
ds_read_b128 a[168:171], v10 offset:51200
ds_read_b128 a[172:175], v11 offset:51200
v_cvt_pk_bf16_f32 v75, v86, v87
M v[132:135], a[188:191], a[108:111], v[132:135]
v_cvt_pk_bf16_f32 v56, v44, v45
v_cvt_pk_bf16_f32 v57, v46, v47
M v[132:135], a[184:187], a[104:107], v[132:135]
v_cvt_pk_bf16_f32 v58, v76, v77
v_cvt_pk_bf16_f32 v59, v78, v79
M v[136:139], a[184:187], a[112:115], v[136:139]
v_cvt_pk_bf16_f32 v88, v60, v61
M v[136:139], a[188:191], a[116:119], v[136:139]
buffer_load_dwordx4 v3, s[8:11], s23 offen offset:1024 lds
v_cvt_pk_bf16_f32 v89, v62, v63
v_cvt_pk_bf16_f32 v90, v92, v93
M v[140:143], a[188:191], a[124:127], v[140:143]
v_cvt_pk_bf16_f32 v91, v94, v95
M v[140:143], a[184:187], a[120:123], v[140:143]
M v[144:147], a[184:187], a[128:131], v[144:147]
buffer_load_dwordx4 v4, s[8:11], s23 offen offset:2048 lds
M v[144:147], a[188:191], a[132:135], v[144:147]
M v[148:151], a[188:191], a[140:143], v[148:151]
s_add_u32 s94, s92, 0
buffer_store_dwordx4 v[32:35], v1, s[16:19], s94 offen offset:0 sc1
M v[148:151], a[184:187], a[136:139], v[148:151]
M v[152:155], a[184:187], a[144:147], v[152:155]
M v[152:155], a[188:191], a[148:151], v[152:155]
buffer_load_dwordx4 v5, s[8:11], s23 offen offset:3072 lds
s_add_u32 s23, s23, 128
M v[156:159], a[188:191], a[156:159], v[156:159]
s_add_u32 s94, s92, 0
buffer_store_dwordx4 v[40:43], v1, s[16:19], s94 offen offset:1024 sc1
M v[156:159], a[184:187], a[152:155], v[156:159]
s_waitcnt lgkmcnt(2)
M v[160:163], a[160:163], a[96:99], v[160:163]
M v[160:163], a[164:167], a[100:103], v[160:163]
ds_read_b128 a[176:179], v10 offset:53248
ds_read_b128 a[180:183], v11 offset:53248
M v[164:167], a[164:167], a[108:111], v[164:167]
s_add_u32 s94, s92, 0
buffer_store_dwordx4 v[48:51], v1, s[16:19], s94 offen offset:2048 sc1
M v[164:167], a[160:163], a[104:107], v[164:167]
v_cvt_pk_bf16_f32 v96, v96, v97
v_cvt_pk_bf16_f32 v97, v98, v99
M v[168:171], a[160:163], a[112:115], v[168:171]
v_cvt_pk_bf16_f32 v98, v128, v129
v_cvt_pk_bf16_f32 v99, v130, v131
M v[168:171], a[164:167], a[116:119], v[168:171]
s_add_u32 m0, s30, 98304
s_nop 0
buffer_load_dwordx4 v6, s[12:15], s25 offen offset:0 lds
v_cvt_pk_bf16_f32 v128, v112, v113
M v[172:175], a[164:167], a[124:127], v[172:175]
s_add_u32 s94, s92, 0
buffer_store_dwordx4 v[56:59], v1, s[16:19], s94 offen offset:3072 sc1
v_cvt_pk_bf16_f32 v129, v114, v115
v_cvt_pk_bf16_f32 v130, v144, v145
M v[172:175], a[160:163], a[120:123], v[172:175]
v_cvt_pk_bf16_f32 v131, v146, v147
M v[176:179], a[160:163], a[128:131], v[176:179]
v_cvt_pk_bf16_f32 v112, v104, v105
v_cvt_pk_bf16_f32 v113, v106, v107
M v[176:179], a[164:167], a[132:135], v[176:179]
buffer_load_dwordx4 v7, s[12:15], s25 offen offset:1024 lds
v_cvt_pk_bf16_f32 v114, v136, v137
v_cvt_pk_bf16_f32 v115, v138, v139
M v[180:183], a[164:167], a[140:143], v[180:183]
s_add_u32 s94, s92, 4096
buffer_store_dwordx4 v[64:67], v1, s[16:19], s94 offen offset:0 sc1
v_cvt_pk_bf16_f32 v144, v120, v121
M v[180:183], a[160:163], a[136:139], v[180:183]
v_cvt_pk_bf16_f32 v145, v122, v123
v_cvt_pk_bf16_f32 v146, v152, v153
M v[184:187], a[160:163], a[144:147], v[184:187]
v_cvt_pk_bf16_f32 v147, v154, v155
M v[184:187], a[164:167], a[148:151], v[184:187]
v_cvt_pk_bf16_f32 v104, v100, v101
v_cvt_pk_bf16_f32 v105, v102, v103
M v[188:191], a[164:167], a[156:159], v[188:191]
s_add_u32 s94, s92, 4096
buffer_store_dwordx4 v[72:75], v1, s[16:19], s94 offen offset:1024 sc1
v_cvt_pk_bf16_f32 v106, v132, v133
v_cvt_pk_bf16_f32 v107, v134, v135
M v[188:191], a[160:163], a[152:155], v[188:191]
s_waitcnt lgkmcnt(2)
v_cvt_pk_bf16_f32 v136, v116, v117
M v[192:195], a[168:171], a[96:99], v[192:195]
buffer_load_dwordx4 v8, s[12:15], s25 offen offset:2048 lds
v_cvt_pk_bf16_f32 v137, v118, v119
v_cvt_pk_bf16_f32 v138, v148, v149
M v[192:195], a[172:175], a[100:103], v[192:195]
ds_read_b128 a[184:187], v10 offset:55296
ds_read_b128 a[188:191], v11 offset:55296
v_cvt_pk_bf16_f32 v139, v150, v151
M v[196:199], a[172:175], a[108:111], v[196:199]
s_add_u32 s94, s92, 4096
buffer_store_dwordx4 v[80:83], v1, s[16:19], s94 offen offset:2048 sc1
v_cvt_pk_bf16_f32 v120, v108, v109
v_cvt_pk_bf16_f32 v121, v110, v111
M v[196:199], a[168:171], a[104:107], v[196:199]
v_cvt_pk_bf16_f32 v122, v140, v141
v_cvt_pk_bf16_f32 v123, v142, v143
M v[200:203], a[168:171], a[112:115], v[200:203]
v_cvt_pk_bf16_f32 v152, v124, v125
M v[200:203], a[172:175], a[116:119], v[200:203]
v_cvt_pk_bf16_f32 v153, v126, v127
v_cvt_pk_bf16_f32 v154, v156, v157
M v[204:207], a[172:175], a[124:127], v[204:207]
s_add_u32 s94, s92, 4096
buffer_store_dwordx4 v[88:91], v1, s[16:19], s94 offen offset:3072 sc1
v_cvt_pk_bf16_f32 v155, v158, v159
M v[204:207], a[168:171], a[120:123], v[204:207]
buffer_load_dwordx4 v9, s[12:15], s25 offen offset:3072 lds
M v[208:211], a[168:171], a[128:131], v[208:211]
M v[208:211], a[172:175], a[132:135], v[208:211]
M v[212:215], a[172:175], a[140:143], v[212:215]
s_add_u32 m0, s30, 102400
s_nop 0
buffer_load_dwordx4 v21, s[12:15], s25 offen offset:0 lds
M v[212:215], a[168:171], a[136:139], v[212:215]
M v[216:219], a[168:171], a[144:147], v[216:219]
s_add_u32 s94, s92, 8192
buffer_store_dwordx4 v[96:99], v1, s[16:19], s94 offen offset:0 sc1
M v[216:219], a[172:175], a[148:151], v[216:219]
M v[220:223], a[172:175], a[156:159], v[220:223]
M v[220:223], a[168:171], a[152:155], v[220:223]
s_waitcnt lgkmcnt(2)
M v[224:227], a[176:179], a[96:99], v[224:227]
buffer_load_dwordx4 v22, s[12:15], s25 offen offset:1024 lds
s_add_u32 s25, s25, 393216
M v[224:227], a[180:183], a[100:103], v[224:227]
M v[228:231], a[180:183], a[108:111], v[228:231]
s_add_u32 s94, s92, 8192
buffer_store_dwordx4 v[104:107], v1, s[16:19], s94 offen offset:1024 sc1
M v[228:231], a[176:179], a[104:107], v[228:231]
v_cvt_pk_bf16_f32 v160, v160, v161
v_cvt_pk_bf16_f32 v161, v162, v163
M v[232:235], a[176:179], a[112:115], v[232:235]
v_cvt_pk_bf16_f32 v162, v192, v193
v_cvt_pk_bf16_f32 v163, v194, v195
M v[232:235], a[180:183], a[116:119], v[232:235]
v_cvt_pk_bf16_f32 v192, v176, v177
M v[236:239], a[180:183], a[124:127], v[236:239]
v_cvt_pk_bf16_f32 v193, v178, v179
v_cvt_pk_bf16_f32 v194, v208, v209
M v[236:239], a[176:179], a[120:123], v[236:239]
s_waitcnt vmcnt(63) lgkmcnt(0)
s_barrier
v_cvt_pk_bf16_f32 v195, v210, v211
M v[240:243], a[176:179], a[128:131], v[240:243]
s_add_u32 s94, s92, 8192
buffer_store_dwordx4 v[112:115], v1, s[16:19], s94 offen offset:2048 sc1
v_cvt_pk_bf16_f32 v176, v168, v169
v_cvt_pk_bf16_f32 v177, v170, v171
M v[240:243], a[180:183], a[132:135], v[240:243]
s_add_u32 m0, s28, 18432
s_nop 0
buffer_load_dword v20, s[8:11], s24 offen lds
v_cvt_pk_bf16_f32 v178, v200, v201
v_cvt_pk_bf16_f32 v179, v202, v203
M v[244:247], a[180:183], a[140:143], v[244:247]
v_cvt_pk_bf16_f32 v208, v184, v185
M v[244:247], a[176:179], a[136:139], v[244:247]
v_cvt_pk_bf16_f32 v209, v186, v187
v_cvt_pk_bf16_f32 v210, v216, v217
M v[248:251], a[176:179], a[144:147], v[248:251]
buffer_load_dword v23, s[8:11], s24 offen offset:256 lds
s_add_u32 s24, s24, 128
v_cvt_pk_bf16_f32 v211, v218, v219
M v[248:251], a[180:183], a[148:151], v[248:251]
v_cvt_pk_bf16_f32 v168, v164, v165
v_cvt_pk_bf16_f32 v169, v166, v167
M v[252:255], a[180:183], a[156:159], v[252:255]
s_add_u32 s94, s92, 8192
buffer_store_dwordx4 v[120:123], v1, s[16:19], s94 offen offset:3072 sc1
v_cvt_pk_bf16_f32 v170, v196, v197
v_cvt_pk_bf16_f32 v171, v198, v199
M v[252:255], a[176:179], a[152:155], v[252:255]
v_cvt_pk_bf16_f32 v200, v180, v181
M a[0:3], a[184:187], a[96:99], a[0:3]
v_cvt_pk_bf16_f32 v201, v182, v183
v_cvt_pk_bf16_f32 v202, v212, v213
M a[0:3], a[188:191], a[100:103], a[0:3]
v_cvt_pk_bf16_f32 v203, v214, v215
M a[4:7], a[188:191], a[108:111], a[4:7]
s_add_u32 m0, s29, 20480
s_nop 0
buffer_load_dwordx4 v2, s[8:11], s23 offen offset:0 lds
v_cvt_pk_bf16_f32 v184, v172, v173
v_cvt_pk_bf16_f32 v185, v174, v175
M a[4:7], a[184:187], a[104:107], a[4:7]
v_cvt_pk_bf16_f32 v186, v204, v205
v_cvt_pk_bf16_f32 v187, v206, v207
M a[8:11], a[184:187], a[112:115], a[8:11]
s_add_u32 s94, s92, 12288
buffer_store_dwordx4 v[128:131], v1, s[16:19], s94 offen offset:0 sc1
v_cvt_pk_bf16_f32 v216, v188, v189
M a[8:11], a[188:191], a[116:119], a[8:11]
v_cvt_pk_bf16_f32 v217, v190, v191
v_cvt_pk_bf16_f32 v218, v220, v221
M a[12:15], a[188:191], a[124:127], a[12:15]
buffer_load_dwordx4 v3, s[8:11], s23 offen offset:1024 lds
v_cvt_pk_bf16_f32 v219, v222, v223
M a[12:15], a[184:187], a[120:123], a[12:15]
M a[16:19], a[184:187], a[128:131], a[16:19]
M a[16:19], a[188:191], a[132:135], a[16:19]
M a[20:23], a[188:191], a[140:143], a[20:23]
s_add_u32 s94, s92, 12288
buffer_store_dwordx4 v[136:139], v1, s[16:19], s94 offen offset:1024 sc1
M a[20:23], a[184:187], a[136:139], a[20:23]
buffer_load_dwordx4 v4, s[8:11], s23 offen offset:2048 lds
M a[24:27], a[184:187], a[144:147], a[24:27]
M a[24:27], a[188:191], a[148:151], a[24:27]
M a[28:31], a[188:191], a[156:159], a[28:31]
M a[28:31], a[184:187], a[152:155], a[28:31]
v_accvgpr_read_b32 v24, a0
v_accvgpr_read_b32 v25, a1
v_accvgpr_read_b32 v26, a2
v_accvgpr_read_b32 v27, a3
v_cvt_pk_bf16_f32 v224, v224, v225
v_cvt_pk_bf16_f32 v225, v226, v227
v_cvt_pk_bf16_f32 v226, v24, v25
v_cvt_pk_bf16_f32 v227, v26, v27
v_accvgpr_read_b32 v24, a16
v_accvgpr_read_b32 v25, a17
v_accvgpr_read_b32 v26, a18
v_accvgpr_read_b32 v27, a19
v_cvt_pk_bf16_f32 v36, v240, v241
v_cvt_pk_bf16_f32 v37, v242, v243
v_cvt_pk_bf16_f32 v38, v24, v25
v_cvt_pk_bf16_f32 v39, v26, v27
v_accvgpr_read_b32 v24, a24
v_accvgpr_read_b32 v25, a25
v_accvgpr_read_b32 v26, a26
v_accvgpr_read_b32 v27, a27
v_cvt_pk_bf16_f32 v52, v248, v249
v_cvt_pk_bf16_f32 v53, v250, v251
v_cvt_pk_bf16_f32 v54, v24, v25
v_cvt_pk_bf16_f32 v55, v26, v27
v_accvgpr_read_b32 v24, a8
v_accvgpr_read_b32 v25, a9
v_accvgpr_read_b32 v26, a10
v_accvgpr_read_b32 v27, a11
v_cvt_pk_bf16_f32 v240, v232, v233
v_cvt_pk_bf16_f32 v241, v234, v235
v_cvt_pk_bf16_f32 v242, v24, v25
v_cvt_pk_bf16_f32 v243, v26, v27
v_accvgpr_read_b32 v28, a4
v_accvgpr_read_b32 v29, a5
v_accvgpr_read_b32 v30, a6
v_accvgpr_read_b32 v31, a7
v_cvt_pk_bf16_f32 v232, v228, v229
v_cvt_pk_bf16_f32 v233, v230, v231
v_cvt_pk_bf16_f32 v234, v28, v29
v_cvt_pk_bf16_f32 v235, v30, v31
v_accvgpr_read_b32 v28, a12
v_accvgpr_read_b32 v29, a13
v_accvgpr_read_b32 v30, a14
v_accvgpr_read_b32 v31, a15
v_cvt_pk_bf16_f32 v248, v236, v237
v_cvt_pk_bf16_f32 v249, v238, v239
v_cvt_pk_bf16_f32 v250, v28, v29
v_cvt_pk_bf16_f32 v251, v30, v31
v_accvgpr_read_b32 v28, a20
v_accvgpr_read_b32 v29, a21
v_accvgpr_read_b32 v30, a22
v_accvgpr_read_b32 v31, a23
v_cvt_pk_bf16_f32 v44, v244, v245
v_cvt_pk_bf16_f32 v45, v246, v247
v_cvt_pk_bf16_f32 v46, v28, v29
v_cvt_pk_bf16_f32 v47, v30, v31
v_accvgpr_read_b32 v28, a28
v_accvgpr_read_b32 v29, a29
v_accvgpr_read_b32 v30, a30
v_accvgpr_read_b32 v31, a31
v_cvt_pk_bf16_f32 v60, v252, v253
v_cvt_pk_bf16_f32 v61, v254, v255
v_cvt_pk_bf16_f32 v62, v28, v29
v_cvt_pk_bf16_f32 v63, v30, v31
Lk1_b:
v_and_b32 v24, 15, v0
v_lshlrev_b32 v24, 7, v24
v_bfe_u32 v25, v0, 1, 3
v_lshrrev_b32 v26, 4, v0
v_xor_b32 v25, v25, v26
v_lshl_add_u32 v10, v25, 4, v24
v_xor_b32 v11, 64, v10
v_add_u32 v12, 131072, v10
v_add_u32 v13, 131072, v11
v_bfe_u32 v24, v0, 2, 2
v_lshl_add_u32 v29, v26, 3, v24
v_mul_u32_u24 v25, 384, v29
v_and_b32 v27, 1, v0
v_lshl_add_u32 v25, v27, 3, v25
v_add_u32 v25, 36864, v25
v_lshrrev_b32 v24, 1, v29
v_and_b32 v24, 4, v24
v_and_or_b32 v24, v29, 2, v24
v_bfe_u32 v26, v0, 1, 1
s_mul_i32 s4, s20, 3
s_add_u32 s3, s4, 0
s_and_b32 s5, s3, 3
s_lshl_b32 s5, s5, 1
s_lshr_b32 s3, s3, 2
s_lshl_b32 s3, s3, 7
v_add_u32 v27, s5, v26
v_xor_b32 v27, v27, v24
v_lshl_add_u32 v27, v27, 4, v25
v_add_u32 v14, s3, v27
v_add_u32 v17, 61440, v14
s_add_u32 s3, s4, 1
s_and_b32 s5, s3, 3
s_lshl_b32 s5, s5, 1
s_lshr_b32 s3, s3, 2
s_lshl_b32 s3, s3, 7
v_add_u32 v27, s5, v26
v_xor_b32 v27, v27, v24
v_lshl_add_u32 v27, v27, 4, v25
v_add_u32 v15, s3, v27
v_add_u32 v18, 61440, v15
s_add_u32 s3, s4, 2
s_and_b32 s5, s3, 3
s_lshl_b32 s5, s5, 1
s_lshr_b32 s3, s3, 2
s_lshl_b32 s3, s3, 7
v_add_u32 v27, s5, v26
v_xor_b32 v27, v27, v24
v_lshl_add_u32 v27, v27, 4, v25
v_add_u32 v16, s3, v27
v_add_u32 v19, 61440, v16
s_waitcnt vmcnt(9)
s_barrier
ds_read_b64_tr_b16 a[176:177], v14 offset:28672
ds_read_b64_tr_b16 a[178:179], v14 offset:30208
ds_read_b64_tr_b16 a[184:185], v15 offset:28672
ds_read_b64_tr_b16 a[186:187], v15 offset:30208
ds_read_b64_tr_b16 a[192:193], v16 offset:28672
ds_read_b64_tr_b16 a[194:195], v16 offset:30208
ds_read_b64_tr_b16 a[180:181], v14 offset:40960
ds_read_b64_tr_b16 a[182:183], v14 offset:42496
ds_read_b64_tr_b16 a[188:189], v15 offset:40960
ds_read_b64_tr_b16 a[190:191], v15 offset:42496
ds_read_b64_tr_b16 a[196:197], v16 offset:40960
ds_read_b64_tr_b16 a[198:199], v16 offset:42496
ds_read_b128 a[224:227], v12 offset:0
ds_read_b128 a[228:231], v13 offset:0
ds_read_b128 a[232:235], v12 offset:2048
ds_read_b128 a[236:239], v13 offset:2048
ds_read_b128 a[240:243], v12 offset:4096
ds_read_b128 a[244:247], v13 offset:4096
s_waitcnt lgkmcnt(0)
s_barrier
M a[68:71], a[176:179], a[224:227], 0
ds_read_b128 a[248:251], v12 offset:6144
ds_read_b128 a[252:255], v13 offset:6144
M a[68:71], a[180:183], a[228:231], a[68:71]
buffer_load_dwordx4 v5, s[8:11], s23 offen offset:3072 lds
s_add_u32 s23, s23, 128
M a[72:75], a[188:191], a[228:231], 0
ds_read_b64_tr_b16 a[200:201], v17 offset:0
ds_read_b64_tr_b16 a[202:203], v17 offset:1536
M a[72:75], a[184:187], a[224:227], a[72:75]
M a[76:79], a[192:195], a[224:227], 0
s_add_u32 m0, s30, 36864
s_nop 0
buffer_load_dwordx4 v6, s[12:15], s25 offen offset:0 lds
M a[76:79], a[196:199], a[228:231], a[76:79]
M a[80:83], a[180:183], a[236:239], 0
ds_read_b128 a[224:227], v12 offset:8192
ds_read_b128 a[228:231], v13 offset:8192
M a[80:83], a[176:179], a[232:235], a[80:83]
buffer_load_dwordx4 v7, s[12:15], s25 offen offset:1024 lds
M a[84:87], a[184:187], a[232:235], 0
ds_read_b64_tr_b16 a[208:209], v18 offset:0
ds_read_b64_tr_b16 a[210:211], v18 offset:1536
M a[84:87], a[188:191], a[236:239], a[84:87]
M a[88:91], a[196:199], a[236:239], 0
buffer_load_dwordx4 v8, s[12:15], s25 offen offset:2048 lds
M a[88:91], a[192:195], a[232:235], a[88:91]
M a[92:95], a[176:179], a[240:243], 0
ds_read_b128 a[232:235], v12 offset:10240
ds_read_b128 a[236:239], v13 offset:10240
M a[92:95], a[180:183], a[244:247], a[92:95]
buffer_load_dwordx4 v9, s[12:15], s25 offen offset:3072 lds
M a[96:99], a[188:191], a[244:247], 0
ds_read_b64_tr_b16 a[216:217], v19 offset:0
ds_read_b64_tr_b16 a[218:219], v19 offset:1536
M a[96:99], a[184:187], a[240:243], a[96:99]
M a[100:103], a[192:195], a[240:243], 0
s_add_u32 m0, s30, 40960
s_nop 0
buffer_load_dwordx4 v21, s[12:15], s25 offen offset:0 lds
M a[100:103], a[196:199], a[244:247], a[100:103]
s_waitcnt lgkmcnt(10)
M a[104:107], a[180:183], a[252:255], 0
ds_read_b128 a[240:243], v12 offset:12288
ds_read_b128 a[244:247], v13 offset:12288
M a[104:107], a[176:179], a[248:251], a[104:107]
buffer_load_dwordx4 v22, s[12:15], s25 offen offset:1024 lds
s_add_u32 s25, s25, 393216
M a[108:111], a[184:187], a[248:251], 0
ds_read_b64_tr_b16 a[204:205], v17 offset:12288
ds_read_b64_tr_b16 a[206:207], v17 offset:13824
M a[108:111], a[188:191], a[252:255], a[108:111]
M a[112:115], a[196:199], a[252:255], 0
s_add_u32 m0, s30, 65536
s_nop 0
buffer_load_dwordx4 v6, s[12:15], s25 offen offset:0 lds
M a[112:115], a[192:195], a[248:251], a[112:115]
s_waitcnt lgkmcnt(10)
M a[116:119], a[176:179], a[224:227], 0
ds_read_b128 a[248:251], v12 offset:14336
ds_read_b128 a[252:255], v13 offset:14336
M a[116:119], a[180:183], a[228:231], a[116:119]
buffer_load_dwordx4 v7, s[12:15], s25 offen offset:1024 lds
M a[120:123], a[188:191], a[228:231], 0
ds_read_b64_tr_b16 a[212:213], v18 offset:12288
ds_read_b64_tr_b16 a[214:215], v18 offset:13824
M a[120:123], a[184:187], a[224:227], a[120:123]
M a[124:127], a[192:195], a[224:227], 0
buffer_load_dwordx4 v8, s[12:15], s25 offen offset:2048 lds
M a[124:127], a[196:199], a[228:231], a[124:127]
s_waitcnt lgkmcnt(10)
M a[128:131], a[180:183], a[236:239], 0
ds_read_b128 a[224:227], v12 offset:16384
ds_read_b128 a[228:231], v13 offset:16384
M a[128:131], a[176:179], a[232:235], a[128:131]
buffer_load_dwordx4 v9, s[12:15], s25 offen offset:3072 lds
M a[132:135], a[184:187], a[232:235], 0
ds_read_b64_tr_b16 a[220:221], v19 offset:12288
ds_read_b64_tr_b16 a[222:223], v19 offset:13824
M a[132:135], a[188:191], a[236:239], a[132:135]
M a[136:139], a[196:199], a[236:239], 0
s_add_u32 m0, s30, 69632
s_nop 0
buffer_load_dwordx4 v21, s[12:15], s25 offen offset:0 lds
M a[136:139], a[192:195], a[232:235], a[136:139]
s_waitcnt lgkmcnt(10)
M a[140:143], a[176:179], a[240:243], 0
buffer_load_dwordx4 v22, s[12:15], s25 offen offset:1024 lds
s_add_u32 s25, s25, 393216
M a[140:143], a[180:183], a[244:247], a[140:143]
M a[144:147], a[188:191], a[244:247], 0
M a[144:147], a[184:187], a[240:243], a[144:147]
M a[148:151], a[192:195], a[240:243], 0
s_waitcnt vmcnt(6) lgkmcnt(0)
s_barrier
ds_read_b128 a[232:235], v10 offset:0
ds_read_b128 a[236:239], v11 offset:0
M a[148:151], a[196:199], a[244:247], a[148:151]
s_add_u32 m0, s28, 131072
s_nop 0
buffer_load_dword v20, s[8:11], s24 offen lds
M a[152:155], a[180:183], a[252:255], 0
ds_read_b128 a[240:243], v10 offset:2048
ds_read_b128 a[244:247], v11 offset:2048
M a[152:155], a[176:179], a[248:251], a[152:155]
M a[156:159], a[184:187], a[248:251], 0
buffer_load_dword v23, s[8:11], s24 offen offset:256 lds
s_add_u32 s24, s24, 128
M a[156:159], a[188:191], a[252:255], a[156:159]
M a[160:163], a[196:199], a[252:255], 0
M a[160:163], a[192:195], a[248:251], a[160:163]
s_add_u32 m0, s29, 133120
s_nop 0
buffer_load_dwordx4 v2, s[8:11], s23 offen offset:0 lds
M a[164:167], a[176:179], a[224:227], 0
ds_read_b128 a[248:251], v10 offset:4096
ds_read_b128 a[252:255], v11 offset:4096
M a[164:167], a[180:183], a[228:231], a[164:167]
M a[168:171], a[188:191], a[228:231], 0
M a[168:171], a[184:187], a[224:227], a[168:171]
buffer_load_dwordx4 v3, s[8:11], s23 offen offset:1024 lds
M a[172:175], a[192:195], a[224:227], 0
M a[172:175], a[196:199], a[228:231], a[172:175]
s_waitcnt lgkmcnt(4)
M a[68:71], a[200:203], a[232:235], a[68:71]
ds_read_b128 a[224:227], v10 offset:6144
ds_read_b128 a[228:231], v11 offset:6144
M a[68:71], a[204:207], a[236:239], a[68:71]
buffer_load_dwordx4 v4, s[8:11], s23 offen offset:2048 lds
M a[72:75], a[212:215], a[236:239], a[72:75]
ds_read_b64_tr_b16 a[176:177], v14 offset:0
ds_read_b64_tr_b16 a[178:179], v14 offset:1536
M a[72:75], a[208:211], a[232:235], a[72:75]
M a[76:79], a[216:219], a[232:235], a[76:79]
buffer_load_dwordx4 v5, s[8:11], s23 offen offset:3072 lds
s_add_u32 s23, s23, 128
M a[76:79], a[220:223], a[236:239], a[76:79]
s_waitcnt lgkmcnt(6)
M a[80:83], a[204:207], a[244:247], a[80:83]
ds_read_b128 a[232:235], v10 offset:8192
ds_read_b128 a[236:239], v11 offset:8192
M a[80:83], a[200:203], a[240:243], a[80:83]
s_add_u32 m0, s30, 98304
s_nop 0
buffer_load_dwordx4 v6, s[12:15], s25 offen offset:0 lds
M a[84:87], a[208:211], a[240:243], a[84:87]
ds_read_b64_tr_b16 a[184:185], v15 offset:0
ds_read_b64_tr_b16 a[186:187], v15 offset:1536
M a[84:87], a[212:215], a[244:247], a[84:87]
M a[88:91], a[220:223], a[244:247], a[88:91]
buffer_load_dwordx4 v7, s[12:15], s25 offen offset:1024 lds
M a[88:91], a[216:219], a[240:243], a[88:91]
s_waitcnt lgkmcnt(8)
M a[92:95], a[200:203], a[248:251], a[92:95]
ds_read_b128 a[240:243], v10 offset:10240
ds_read_b128 a[244:247], v11 offset:10240
M a[92:95], a[204:207], a[252:255], a[92:95]
M a[96:99], a[212:215], a[252:255], a[96:99]
ds_read_b64_tr_b16 a[192:193], v16 offset:0
ds_read_b64_tr_b16 a[194:195], v16 offset:1536
M a[96:99], a[208:211], a[248:251], a[96:99]
buffer_load_dwordx4 v8, s[12:15], s25 offen offset:2048 lds
M a[100:103], a[216:219], a[248:251], a[100:103]
M a[100:103], a[220:223], a[252:255], a[100:103]
buffer_load_dwordx4 v9, s[12:15], s25 offen offset:3072 lds
s_waitcnt lgkmcnt(10)
M a[104:107], a[204:207], a[228:231], a[104:107]
ds_read_b128 a[248:251], v10 offset:12288
ds_read_b128 a[252:255], v11 offset:12288
M a[104:107], a[200:203], a[224:227], a[104:107]
M a[108:111], a[208:211], a[224:227], a[108:111]
ds_read_b64_tr_b16 a[180:181], v14 offset:12288
ds_read_b64_tr_b16 a[182:183], v14 offset:13824
M a[108:111], a[212:215], a[228:231], a[108:111]
s_add_u32 m0, s30, 102400
s_nop 0
buffer_load_dwordx4 v21, s[12:15], s25 offen offset:0 lds
M a[112:115], a[220:223], a[228:231], a[112:115]
M a[112:115], a[216:219], a[224:227], a[112:115]
buffer_load_dwordx4 v22, s[12:15], s25 offen offset:1024 lds
s_add_u32 s25, s25, 393216
s_waitcnt lgkmcnt(10)
M a[116:119], a[200:203], a[232:235], a[116:119]
ds_read_b128 a[224:227], v10 offset:14336
ds_read_b128 a[228:231], v11 offset:14336
M a[116:119], a[204:207], a[236:239], a[116:119]
M a[120:123], a[212:215], a[236:239], a[120:123]
ds_read_b64_tr_b16 a[188:189], v15 offset:12288
ds_read_b64_tr_b16 a[190:191], v15 offset:13824
M a[120:123], a[208:211], a[232:235], a[120:123]
M a[124:127], a[216:219], a[232:235], a[124:127]
s_add_u32 s94, s92, 12288
buffer_store_dwordx4 v[144:147], v1, s[16:19], s94 offen offset:2048 sc1
M a[124:127], a[220:223], a[236:239], a[124:127]
s_waitcnt lgkmcnt(10)
M a[128:131], a[204:207], a[244:247], a[128:131]
ds_read_b128 a[232:235], v10 offset:16384
ds_read_b128 a[236:239], v11 offset:16384
M a[128:131], a[200:203], a[240:243], a[128:131]
s_add_u32 s94, s92, 12288
buffer_store_dwordx4 v[152:155], v1, s[16:19], s94 offen offset:3072 sc1
M a[132:135], a[208:211], a[240:243], a[132:135]
ds_read_b64_tr_b16 a[196:197], v16 offset:12288
ds_read_b64_tr_b16 a[198:199], v16 offset:13824
M a[132:135], a[212:215], a[244:247], a[132:135]
M a[136:139], a[220:223], a[244:247], a[136:139]
s_add_u32 s94, s93, 0
buffer_store_dwordx4 v[160:163], v1, s[16:19], s94 offen offset:0 sc1
M a[136:139], a[216:219], a[240:243], a[136:139]
s_waitcnt lgkmcnt(10)
M a[140:143], a[200:203], a[248:251], a[140:143]
s_add_u32 s94, s93, 0
buffer_store_dwordx4 v[168:171], v1, s[16:19], s94 offen offset:1024 sc1
M a[140:143], a[204:207], a[252:255], a[140:143]
M a[144:147], a[212:215], a[252:255], a[144:147]
M a[144:147], a[208:211], a[248:251], a[144:147]
M a[148:151], a[216:219], a[248:251], a[148:151]
s_waitcnt vmcnt(16) lgkmcnt(0)
s_barrier
ds_read_b128 a[240:243], v10 offset:18432
ds_read_b128 a[244:247], v11 offset:18432
M a[148:151], a[220:223], a[252:255], a[148:151]
s_add_u32 m0, s28, 0
s_nop 0
buffer_load_dword v20, s[8:11], s24 offen lds
M a[152:155], a[204:207], a[228:231], a[152:155]
ds_read_b128 a[248:251], v10 offset:20480
ds_read_b128 a[252:255], v11 offset:20480
M a[152:155], a[200:203], a[224:227], a[152:155]
M a[156:159], a[208:211], a[224:227], a[156:159]
buffer_load_dword v23, s[8:11], s24 offen offset:256 lds
s_add_u32 s24, s24, 128
M a[156:159], a[212:215], a[228:231], a[156:159]
M a[160:163], a[220:223], a[228:231], a[160:163]
M a[160:163], a[216:219], a[224:227], a[160:163]
s_add_u32 m0, s29, 2048
s_nop 0
buffer_load_dwordx4 v2, s[8:11], s23 offen offset:0 lds
M a[164:167], a[200:203], a[232:235], a[164:167]
ds_read_b128 a[224:227], v10 offset:22528
ds_read_b128 a[228:231], v11 offset:22528
M a[164:167], a[204:207], a[236:239], a[164:167]
M a[168:171], a[212:215], a[236:239], a[168:171]
M a[168:171], a[208:211], a[232:235], a[168:171]
buffer_load_dwordx4 v3, s[8:11], s23 offen offset:1024 lds
M a[172:175], a[216:219], a[232:235], a[172:175]
M a[172:175], a[220:223], a[236:239], a[172:175]
s_waitcnt lgkmcnt(4)
M a[68:71], a[176:179], a[240:243], a[68:71]
ds_read_b128 a[232:235], v10 offset:24576
ds_read_b128 a[236:239], v11 offset:24576
M a[68:71], a[180:183], a[244:247], a[68:71]
buffer_load_dwordx4 v4, s[8:11], s23 offen offset:2048 lds
M a[72:75], a[188:191], a[244:247], a[72:75]
ds_read_b64_tr_b16 a[200:201], v14 offset:28672
ds_read_b64_tr_b16 a[202:203], v14 offset:30208
M a[72:75], a[184:187], a[240:243], a[72:75]
M a[76:79], a[192:195], a[240:243], a[76:79]
buffer_load_dwordx4 v5, s[8:11], s23 offen offset:3072 lds
s_add_u32 s23, s23, 128
M a[76:79], a[196:199], a[244:247], a[76:79]
s_waitcnt lgkmcnt(6)
M a[80:83], a[180:183], a[252:255], a[80:83]
ds_read_b128 a[240:243], v10 offset:26624
ds_read_b128 a[244:247], v11 offset:26624
M a[80:83], a[176:179], a[248:251], a[80:83]
s_add_u32 m0, s30, 36864
s_nop 0
buffer_load_dwordx4 v6, s[12:15], s25 offen offset:0 lds
M a[84:87], a[184:187], a[248:251], a[84:87]
ds_read_b64_tr_b16 a[208:209], v15 offset:28672
ds_read_b64_tr_b16 a[210:211], v15 offset:30208
M a[84:87], a[188:191], a[252:255], a[84:87]
M a[88:91], a[196:199], a[252:255], a[88:91]
buffer_load_dwordx4 v7, s[12:15], s25 offen offset:1024 lds
M a[88:91], a[192:195], a[248:251], a[88:91]
s_waitcnt lgkmcnt(8)
M a[92:95], a[176:179], a[224:227], a[92:95]
ds_read_b128 a[248:251], v10 offset:28672
ds_read_b128 a[252:255], v11 offset:28672
M a[92:95], a[180:183], a[228:231], a[92:95]
M a[96:99], a[188:191], a[228:231], a[96:99]
ds_read_b64_tr_b16 a[216:217], v16 offset:28672
ds_read_b64_tr_b16 a[218:219], v16 offset:30208
M a[96:99], a[184:187], a[224:227], a[96:99]
buffer_load_dwordx4 v8, s[12:15], s25 offen offset:2048 lds
M a[100:103], a[192:195], a[224:227], a[100:103]
M a[100:103], a[196:199], a[228:231], a[100:103]
buffer_load_dwordx4 v9, s[12:15], s25 offen offset:3072 lds
s_waitcnt lgkmcnt(10)
M a[104:107], a[180:183], a[236:239], a[104:107]
ds_read_b128 a[224:227], v10 offset:30720
ds_read_b128 a[228:231], v11 offset:30720
M a[104:107], a[176:179], a[232:235], a[104:107]
M a[108:111], a[184:187], a[232:235], a[108:111]
ds_read_b64_tr_b16 a[204:205], v14 offset:40960
ds_read_b64_tr_b16 a[206:207], v14 offset:42496
M a[108:111], a[188:191], a[236:239], a[108:111]
s_add_u32 m0, s30, 40960
s_nop 0
buffer_load_dwordx4 v21, s[12:15], s25 offen offset:0 lds
M a[112:115], a[196:199], a[236:239], a[112:115]
M a[112:115], a[192:195], a[232:235], a[112:115]
buffer_load_dwordx4 v22, s[12:15], s25 offen offset:1024 lds
s_add_u32 s25, s25, 393216
s_waitcnt lgkmcnt(10)
M a[116:119], a[176:179], a[240:243], a[116:119]
ds_read_b128 a[232:235], v10 offset:32768
ds_read_b128 a[236:239], v11 offset:32768
M a[116:119], a[180:183], a[244:247], a[116:119]
M a[120:123], a[188:191], a[244:247], a[120:123]
ds_read_b64_tr_b16 a[212:213], v15 offset:40960
ds_read_b64_tr_b16 a[214:215], v15 offset:42496
M a[120:123], a[184:187], a[240:243], a[120:123]
M a[124:127], a[192:195], a[240:243], a[124:127]
s_add_u32 s94, s93, 0
buffer_store_dwordx4 v[176:179], v1, s[16:19], s94 offen offset:2048 sc1
M a[124:127], a[196:199], a[244:247], a[124:127]
s_waitcnt lgkmcnt(10)
M a[128:131], a[180:183], a[252:255], a[128:131]
ds_read_b128 a[240:243], v10 offset:34816
ds_read_b128 a[244:247], v11 offset:34816
M a[128:131], a[176:179], a[248:251], a[128:131]
s_add_u32 s94, s93, 0
buffer_store_dwordx4 v[184:187], v1, s[16:19], s94 offen offset:3072 sc1
M a[132:135], a[184:187], a[248:251], a[132:135]
ds_read_b64_tr_b16 a[220:221], v16 offset:40960
ds_read_b64_tr_b16 a[222:223], v16 offset:42496
M a[132:135], a[188:191], a[252:255], a[132:135]
M a[136:139], a[196:199], a[252:255], a[136:139]
s_add_u32 s94, s93, 4096
buffer_store_dwordx4 v[192:195], v1, s[16:19], s94 offen offset:0 sc1
M a[136:139], a[192:195], a[248:251], a[136:139]
s_waitcnt lgkmcnt(10)
M a[140:143], a[176:179], a[224:227], a[140:143]
s_add_u32 s94, s93, 4096
buffer_store_dwordx4 v[200:203], v1, s[16:19], s94 offen offset:1024 sc1
M a[140:143], a[180:183], a[228:231], a[140:143]
M a[144:147], a[188:191], a[228:231], a[144:147]
M a[144:147], a[184:187], a[224:227], a[144:147]
M a[148:151], a[192:195], a[224:227], a[148:151]
s_waitcnt vmcnt(20) lgkmcnt(0)
s_barrier
ds_read_b128 a[248:251], v12 offset:0
ds_read_b128 a[252:255], v13 offset:0
M a[148:151], a[196:199], a[228:231], a[148:151]
s_add_u32 m0, s28, 18432
s_nop 0
buffer_load_dword v20, s[8:11], s24 offen lds
M a[152:155], a[180:183], a[236:239], a[152:155]
ds_read_b128 a[224:227], v12 offset:2048
ds_read_b128 a[228:231], v13 offset:2048
M a[152:155], a[176:179], a[232:235], a[152:155]
M a[156:159], a[184:187], a[232:235], a[156:159]
buffer_load_dword v23, s[8:11], s24 offen offset:256 lds
s_add_u32 s24, s24, 128
M a[156:159], a[188:191], a[236:239], a[156:159]
M a[160:163], a[196:199], a[236:239], a[160:163]
M a[160:163], a[192:195], a[232:235], a[160:163]
s_add_u32 m0, s29, 20480
s_nop 0
buffer_load_dwordx4 v2, s[8:11], s23 offen offset:0 lds
M a[164:167], a[176:179], a[240:243], a[164:167]
ds_read_b128 a[232:235], v12 offset:4096
ds_read_b128 a[236:239], v13 offset:4096
M a[164:167], a[180:183], a[244:247], a[164:167]
M a[168:171], a[188:191], a[244:247], a[168:171]
M a[168:171], a[184:187], a[240:243], a[168:171]
buffer_load_dwordx4 v3, s[8:11], s23 offen offset:1024 lds
M a[172:175], a[192:195], a[240:243], a[172:175]
M a[172:175], a[196:199], a[244:247], a[172:175]
s_waitcnt lgkmcnt(4)
M a[68:71], a[200:203], a[248:251], a[68:71]
ds_read_b128 a[240:243], v12 offset:6144
ds_read_b128 a[244:247], v13 offset:6144
M a[68:71], a[204:207], a[252:255], a[68:71]
buffer_load_dwordx4 v4, s[8:11], s23 offen offset:2048 lds
M a[72:75], a[212:215], a[252:255], a[72:75]
ds_read_b64_tr_b16 a[176:177], v17 offset:0
ds_read_b64_tr_b16 a[178:179], v17 offset:1536
M a[72:75], a[208:211], a[248:251], a[72:75]
M a[76:79], a[216:219], a[248:251], a[76:79]
buffer_load_dwordx4 v5, s[8:11], s23 offen offset:3072 lds
s_add_u32 s23, s23, 128
M a[76:79], a[220:223], a[252:255], a[76:79]
s_waitcnt lgkmcnt(6)
M a[80:83], a[204:207], a[228:231], a[80:83]
ds_read_b128 a[248:251], v12 offset:8192
ds_read_b128 a[252:255], v13 offset:8192
M a[80:83], a[200:203], a[224:227], a[80:83]
s_add_u32 m0, s30, 65536
s_nop 0
buffer_load_dwordx4 v6, s[12:15], s25 offen offset:0 lds
M a[84:87], a[208:211], a[224:227], a[84:87]
ds_read_b64_tr_b16 a[184:185], v18 offset:0
ds_read_b64_tr_b16 a[186:187], v18 offset:1536
M a[84:87], a[212:215], a[228:231], a[84:87]
M a[88:91], a[220:223], a[228:231], a[88:91]
buffer_load_dwordx4 v7, s[12:15], s25 offen offset:1024 lds
M a[88:91], a[216:219], a[224:227], a[88:91]
s_waitcnt lgkmcnt(8)
M a[92:95], a[200:203], a[232:235], a[92:95]
ds_read_b128 a[224:227], v12 offset:10240
ds_read_b128 a[228:231], v13 offset:10240
M a[92:95], a[204:207], a[236:239], a[92:95]
M a[96:99], a[212:215], a[236:239], a[96:99]
ds_read_b64_tr_b16 a[192:193], v19 offset:0
ds_read_b64_tr_b16 a[194:195], v19 offset:1536
M a[96:99], a[208:211], a[232:235], a[96:99]
buffer_load_dwordx4 v8, s[12:15], s25 offen offset:2048 lds
M a[100:103], a[216:219], a[232:235], a[100:103]
M a[100:103], a[220:223], a[236:239], a[100:103]
buffer_load_dwordx4 v9, s[12:15], s25 offen offset:3072 lds
s_waitcnt lgkmcnt(10)
M a[104:107], a[204:207], a[244:247], a[104:107]
ds_read_b128 a[232:235], v12 offset:12288
ds_read_b128 a[236:239], v13 offset:12288
M a[104:107], a[200:203], a[240:243], a[104:107]
M a[108:111], a[208:211], a[240:243], a[108:111]
ds_read_b64_tr_b16 a[180:181], v17 offset:12288
ds_read_b64_tr_b16 a[182:183], v17 offset:13824
M a[108:111], a[212:215], a[244:247], a[108:111]
s_add_u32 m0, s30, 69632
s_nop 0
buffer_load_dwordx4 v21, s[12:15], s25 offen offset:0 lds
M a[112:115], a[220:223], a[244:247], a[112:115]
M a[112:115], a[216:219], a[240:243], a[112:115]
buffer_load_dwordx4 v22, s[12:15], s25 offen offset:1024 lds
s_add_u32 s25, s25, 393216
s_waitcnt lgkmcnt(10)
M a[116:119], a[200:203], a[248:251], a[116:119]
ds_read_b128 a[240:243], v12 offset:14336
ds_read_b128 a[244:247], v13 offset:14336
M a[116:119], a[204:207], a[252:255], a[116:119]
M a[120:123], a[212:215], a[252:255], a[120:123]
ds_read_b64_tr_b16 a[188:189], v18 offset:12288
ds_read_b64_tr_b16 a[190:191], v18 offset:13824
M a[120:123], a[208:211], a[248:251], a[120:123]
M a[124:127], a[216:219], a[248:251], a[124:127]
s_add_u32 s94, s93, 4096
buffer_store_dwordx4 v[208:211], v1, s[16:19], s94 offen offset:2048 sc1
M a[124:127], a[220:223], a[252:255], a[124:127]
s_waitcnt lgkmcnt(10)
M a[128:131], a[204:207], a[228:231], a[128:131]
ds_read_b128 a[248:251], v12 offset:16384
ds_read_b128 a[252:255], v13 offset:16384
M a[128:131], a[200:203], a[224:227], a[128:131]
s_add_u32 s94, s93, 4096
buffer_store_dwordx4 v[216:219], v1, s[16:19], s94 offen offset:3072 sc1
M a[132:135], a[208:211], a[224:227], a[132:135]
ds_read_b64_tr_b16 a[196:197], v19 offset:12288
ds_read_b64_tr_b16 a[198:199], v19 offset:13824
M a[132:135], a[212:215], a[228:231], a[132:135]
M a[136:139], a[220:223], a[228:231], a[136:139]
s_add_u32 s94, s93, 8192
buffer_store_dwordx4 v[224:227], v1, s[16:19], s94 offen offset:0 sc1
M a[136:139], a[216:219], a[224:227], a[136:139]
s_waitcnt lgkmcnt(10)
M a[140:143], a[200:203], a[232:235], a[140:143]
s_add_u32 s94, s93, 8192
buffer_store_dwordx4 v[232:235], v1, s[16:19], s94 offen offset:1024 sc1
M a[140:143], a[204:207], a[236:239], a[140:143]
M a[144:147], a[212:215], a[236:239], a[144:147]
M a[144:147], a[208:211], a[232:235], a[144:147]
M a[148:151], a[216:219], a[232:235], a[148:151]
s_waitcnt vmcnt(20) lgkmcnt(0)
s_barrier
ds_read_b128 a[224:227], v10 offset:0
ds_read_b128 a[228:231], v11 offset:0
M a[148:151], a[220:223], a[236:239], a[148:151]
s_add_u32 m0, s28, 131072
s_nop 0
buffer_load_dword v20, s[8:11], s24 offen lds
M a[152:155], a[204:207], a[244:247], a[152:155]
ds_read_b128 a[232:235], v10 offset:2048
ds_read_b128 a[236:239], v11 offset:2048
M a[152:155], a[200:203], a[240:243], a[152:155]
M a[156:159], a[208:211], a[240:243], a[156:159]
buffer_load_dword v23, s[8:11], s24 offen offset:256 lds
s_add_u32 s24, s24, 128
M a[156:159], a[212:215], a[244:247], a[156:159]
M a[160:163], a[220:223], a[244:247], a[160:163]
M a[160:163], a[216:219], a[240:243], a[160:163]
s_add_u32 m0, s29, 133120
s_nop 0
buffer_load_dwordx4 v2, s[8:11], s23 offen offset:0 lds
M a[164:167], a[200:203], a[248:251], a[164:167]
ds_read_b128 a[240:243], v10 offset:4096
ds_read_b128 a[244:247], v11 offset:4096
M a[164:167], a[204:207], a[252:255], a[164:167]
M a[168:171], a[212:215], a[252:255], a[168:171]
M a[168:171], a[208:211], a[248:251], a[168:171]
buffer_load_dwordx4 v3, s[8:11], s23 offen offset:1024 lds
M a[172:175], a[216:219], a[248:251], a[172:175]
M a[172:175], a[220:223], a[252:255], a[172:175]
s_waitcnt lgkmcnt(4)
M a[68:71], a[176:179], a[224:227], a[68:71]
ds_read_b128 a[248:251], v10 offset:6144
ds_read_b128 a[252:255], v11 offset:6144
M a[68:71], a[180:183], a[228:231], a[68:71]
buffer_load_dwordx4 v4, s[8:11], s23 offen offset:2048 lds
M a[72:75], a[188:191], a[228:231], a[72:75]
ds_read_b64_tr_b16 a[200:201], v14 offset:0
ds_read_b64_tr_b16 a[202:203], v14 offset:1536
M a[72:75], a[184:187], a[224:227], a[72:75]
M a[76:79], a[192:195], a[224:227], a[76:79]
buffer_load_dwordx4 v5, s[8:11], s23 offen offset:3072 lds
s_add_u32 s23, s23, 128
M a[76:79], a[196:199], a[228:231], a[76:79]
s_waitcnt lgkmcnt(6)
M a[80:83], a[180:183], a[236:239], a[80:83]
ds_read_b128 a[224:227], v10 offset:8192
ds_read_b128 a[228:231], v11 offset:8192
M a[80:83], a[176:179], a[232:235], a[80:83]
s_add_u32 m0, s30, 98304
s_nop 0
buffer_load_dwordx4 v6, s[12:15], s25 offen offset:0 lds
M a[84:87], a[184:187], a[232:235], a[84:87]
ds_read_b64_tr_b16 a[208:209], v15 offset:0
ds_read_b64_tr_b16 a[210:211], v15 offset:1536
M a[84:87], a[188:191], a[236:239], a[84:87]
M a[88:91], a[196:199], a[236:239], a[88:91]
buffer_load_dwordx4 v7, s[12:15], s25 offen offset:1024 lds
M a[88:91], a[192:195], a[232:235], a[88:91]
s_waitcnt lgkmcnt(8)
M a[92:95], a[176:179], a[240:243], a[92:95]
ds_read_b128 a[232:235], v10 offset:10240
ds_read_b128 a[236:239], v11 offset:10240
M a[92:95], a[180:183], a[244:247], a[92:95]
M a[96:99], a[188:191], a[244:247], a[96:99]
ds_read_b64_tr_b16 a[216:217], v16 offset:0
ds_read_b64_tr_b16 a[218:219], v16 offset:1536
M a[96:99], a[184:187], a[240:243], a[96:99]
buffer_load_dwordx4 v8, s[12:15], s25 offen offset:2048 lds
M a[100:103], a[192:195], a[240:243], a[100:103]
M a[100:103], a[196:199], a[244:247], a[100:103]
buffer_load_dwordx4 v9, s[12:15], s25 offen offset:3072 lds
s_waitcnt lgkmcnt(10)
M a[104:107], a[180:183], a[252:255], a[104:107]
ds_read_b128 a[240:243], v10 offset:12288
ds_read_b128 a[244:247], v11 offset:12288
M a[104:107], a[176:179], a[248:251], a[104:107]
M a[108:111], a[184:187], a[248:251], a[108:111]
ds_read_b64_tr_b16 a[204:205], v14 offset:12288
ds_read_b64_tr_b16 a[206:207], v14 offset:13824
M a[108:111], a[188:191], a[252:255], a[108:111]
s_add_u32 m0, s30, 102400
s_nop 0
buffer_load_dwordx4 v21, s[12:15], s25 offen offset:0 lds
M a[112:115], a[196:199], a[252:255], a[112:115]
M a[112:115], a[192:195], a[248:251], a[112:115]
buffer_load_dwordx4 v22, s[12:15], s25 offen offset:1024 lds
s_add_u32 s25, s25, 393216
s_waitcnt lgkmcnt(10)
M a[116:119], a[176:179], a[224:227], a[116:119]
ds_read_b128 a[248:251], v10 offset:14336
ds_read_b128 a[252:255], v11 offset:14336
M a[116:119], a[180:183], a[228:231], a[116:119]
M a[120:123], a[188:191], a[228:231], a[120:123]
ds_read_b64_tr_b16 a[212:213], v15 offset:12288
ds_read_b64_tr_b16 a[214:215], v15 offset:13824
M a[120:123], a[184:187], a[224:227], a[120:123]
M a[124:127], a[192:195], a[224:227], a[124:127]
s_add_u32 s94, s93, 8192
buffer_store_dwordx4 v[240:243], v1, s[16:19], s94 offen offset:2048 sc1
M a[124:127], a[196:199], a[228:231], a[124:127]
s_waitcnt lgkmcnt(10)
M a[128:131], a[180:183], a[236:239], a[128:131]
ds_read_b128 a[224:227], v10 offset:16384
ds_read_b128 a[228:231], v11 offset:16384
M a[128:131], a[176:179], a[232:235], a[128:131]
s_add_u32 s94, s93, 8192
buffer_store_dwordx4 v[248:251], v1, s[16:19], s94 offen offset:3072 sc1
M a[132:135], a[184:187], a[232:235], a[132:135]
ds_read_b64_tr_b16 a[220:221], v16 offset:12288
ds_read_b64_tr_b16 a[222:223], v16 offset:13824
M a[132:135], a[188:191], a[236:239], a[132:135]
M a[136:139], a[196:199], a[236:239], a[136:139]
s_add_u32 s94, s93, 12288
buffer_store_dwordx4 v[36:39], v1, s[16:19], s94 offen offset:0 sc1
M a[136:139], a[192:195], a[232:235], a[136:139]
s_waitcnt lgkmcnt(10)
M a[140:143], a[176:179], a[240:243], a[140:143]
s_add_u32 s94, s93, 12288
buffer_store_dwordx4 v[44:47], v1, s[16:19], s94 offen offset:1024 sc1
M a[140:143], a[180:183], a[244:247], a[140:143]
M a[144:147], a[188:191], a[244:247], a[144:147]
M a[144:147], a[184:187], a[240:243], a[144:147]
M a[148:151], a[192:195], a[240:243], a[148:151]
s_waitcnt vmcnt(20) lgkmcnt(0)
s_barrier
ds_read_b128 a[232:235], v10 offset:18432
ds_read_b128 a[236:239], v11 offset:18432
M a[148:151], a[196:199], a[244:247], a[148:151]
s_add_u32 m0, s28, 0
s_nop 0
buffer_load_dword v20, s[8:11], s24 offen lds
M a[152:155], a[180:183], a[252:255], a[152:155]
ds_read_b128 a[240:243], v10 offset:20480
ds_read_b128 a[244:247], v11 offset:20480
M a[152:155], a[176:179], a[248:251], a[152:155]
M a[156:159], a[184:187], a[248:251], a[156:159]
buffer_load_dword v23, s[8:11], s24 offen offset:256 lds
s_add_u32 s24, s24, 128
M a[156:159], a[188:191], a[252:255], a[156:159]
M a[160:163], a[196:199], a[252:255], a[160:163]
M a[160:163], a[192:195], a[248:251], a[160:163]
s_add_u32 m0, s29, 2048
s_nop 0
buffer_load_dwordx4 v2, s[8:11], s23 offen offset:0 lds
M a[164:167], a[176:179], a[224:227], a[164:167]
ds_read_b128 a[248:251], v10 offset:22528
ds_read_b128 a[252:255], v11 offset:22528
M a[164:167], a[180:183], a[228:231], a[164:167]
M a[168:171], a[188:191], a[228:231], a[168:171]
M a[168:171], a[184:187], a[224:227], a[168:171]
buffer_load_dwordx4 v3, s[8:11], s23 offen offset:1024 lds
M a[172:175], a[192:195], a[224:227], a[172:175]
M a[172:175], a[196:199], a[228:231], a[172:175]
s_waitcnt lgkmcnt(4)
M a[68:71], a[200:203], a[232:235], a[68:71]
ds_read_b128 a[224:227], v10 offset:24576
ds_read_b128 a[228:231], v11 offset:24576
M a[68:71], a[204:207], a[236:239], a[68:71]
buffer_load_dwordx4 v4, s[8:11], s23 offen offset:2048 lds
M a[72:75], a[212:215], a[236:239], a[72:75]
ds_read_b64_tr_b16 a[176:177], v14 offset:28672
ds_read_b64_tr_b16 a[178:179], v14 offset:30208
M a[72:75], a[208:211], a[232:235], a[72:75]
M a[76:79], a[216:219], a[232:235], a[76:79]
buffer_load_dwordx4 v5, s[8:11], s23 offen offset:3072 lds
s_add_u32 s23, s23, 128
M a[76:79], a[220:223], a[236:239], a[76:79]
s_waitcnt lgkmcnt(6)
M a[80:83], a[204:207], a[244:247], a[80:83]
ds_read_b128 a[232:235], v10 offset:26624
ds_read_b128 a[236:239], v11 offset:26624
M a[80:83], a[200:203], a[240:243], a[80:83]
M a[84:87], a[208:211], a[240:243], a[84:87]
ds_read_b64_tr_b16 a[184:185], v15 offset:28672
ds_read_b64_tr_b16 a[186:187], v15 offset:30208
M a[84:87], a[212:215], a[244:247], a[84:87]
s_add_u32 m0, s30, 36864
s_nop 0
buffer_load_dwordx4 v6, s[12:15], s25 offen offset:0 lds
M a[88:91], a[220:223], a[244:247], a[88:91]
M a[88:91], a[216:219], a[240:243], a[88:91]
s_waitcnt lgkmcnt(8)
M a[92:95], a[200:203], a[248:251], a[92:95]
ds_read_b128 a[240:243], v10 offset:28672
ds_read_b128 a[244:247], v11 offset:28672
M a[92:95], a[204:207], a[252:255], a[92:95]
buffer_load_dwordx4 v7, s[12:15], s25 offen offset:1024 lds
M a[96:99], a[212:215], a[252:255], a[96:99]
ds_read_b64_tr_b16 a[192:193], v16 offset:28672
ds_read_b64_tr_b16 a[194:195], v16 offset:30208
M a[96:99], a[208:211], a[248:251], a[96:99]
M a[100:103], a[216:219], a[248:251], a[100:103]
buffer_load_dwordx4 v8, s[12:15], s25 offen offset:2048 lds
M a[100:103], a[220:223], a[252:255], a[100:103]
s_waitcnt lgkmcnt(10)
M a[104:107], a[204:207], a[228:231], a[104:107]
ds_read_b128 a[248:251], v10 offset:30720
ds_read_b128 a[252:255], v11 offset:30720
M a[104:107], a[200:203], a[224:227], a[104:107]
M a[108:111], a[208:211], a[224:227], a[108:111]
ds_read_b64_tr_b16 a[180:181], v14 offset:40960
ds_read_b64_tr_b16 a[182:183], v14 offset:42496
M a[108:111], a[212:215], a[228:231], a[108:111]
buffer_load_dwordx4 v9, s[12:15], s25 offen offset:3072 lds
M a[112:115], a[220:223], a[228:231], a[112:115]
M a[112:115], a[216:219], a[224:227], a[112:115]
s_waitcnt lgkmcnt(10)
M a[116:119], a[200:203], a[232:235], a[116:119]
ds_read_b128 a[224:227], v10 offset:32768
ds_read_b128 a[228:231], v11 offset:32768
M a[116:119], a[204:207], a[236:239], a[116:119]
s_add_u32 m0, s30, 40960
s_nop 0
buffer_load_dwordx4 v21, s[12:15], s25 offen offset:0 lds
M a[120:123], a[212:215], a[236:239], a[120:123]
ds_read_b64_tr_b16 a[188:189], v15 offset:40960
ds_read_b64_tr_b16 a[190:191], v15 offset:42496
M a[120:123], a[208:211], a[232:235], a[120:123]
M a[124:127], a[216:219], a[232:235], a[124:127]
buffer_load_dwordx4 v22, s[12:15], s25 offen offset:1024 lds
s_add_u32 s25, s25, 393216
M a[124:127], a[220:223], a[236:239], a[124:127]
s_waitcnt lgkmcnt(10)
M a[128:131], a[204:207], a[244:247], a[128:131]
ds_read_b128 a[232:235], v10 offset:34816
ds_read_b128 a[236:239], v11 offset:34816
M a[128:131], a[200:203], a[240:243], a[128:131]
M a[132:135], a[208:211], a[240:243], a[132:135]
ds_read_b64_tr_b16 a[196:197], v16 offset:40960
ds_read_b64_tr_b16 a[198:199], v16 offset:42496
M a[132:135], a[212:215], a[244:247], a[132:135]
s_add_u32 s94, s93, 12288
buffer_store_dwordx4 v[52:55], v1, s[16:19], s94 offen offset:2048 sc1
M a[136:139], a[220:223], a[244:247], a[136:139]
M a[136:139], a[216:219], a[240:243], a[136:139]
s_waitcnt lgkmcnt(10)
M a[140:143], a[200:203], a[248:251], a[140:143]
s_add_u32 s94, s93, 12288
buffer_store_dwordx4 v[60:63], v1, s[16:19], s94 offen offset:3072 sc1
M a[140:143], a[204:207], a[252:255], a[140:143]
M a[144:147], a[212:215], a[252:255], a[144:147]
M a[144:147], a[208:211], a[248:251], a[144:147]
M a[148:151], a[216:219], a[248:251], a[148:151]
s_waitcnt vmcnt(18) lgkmcnt(0)
s_barrier
ds_read_b128 a[240:243], v12 offset:0
ds_read_b128 a[244:247], v13 offset:0
M a[148:151], a[220:223], a[252:255], a[148:151]
s_add_u32 m0, s28, 18432
s_nop 0
buffer_load_dword v20, s[8:11], s24 offen lds
M a[152:155], a[204:207], a[228:231], a[152:155]
ds_read_b128 a[248:251], v12 offset:2048
ds_read_b128 a[252:255], v13 offset:2048
M a[152:155], a[200:203], a[224:227], a[152:155]
M a[156:159], a[208:211], a[224:227], a[156:159]
buffer_load_dword v23, s[8:11], s24 offen offset:256 lds
s_add_u32 s24, s24, 128
M a[156:159], a[212:215], a[228:231], a[156:159]
M a[160:163], a[220:223], a[228:231], a[160:163]
M a[160:163], a[216:219], a[224:227], a[160:163]
s_add_u32 m0, s29, 20480
s_nop 0
buffer_load_dwordx4 v2, s[8:11], s23 offen offset:0 lds
M a[164:167], a[200:203], a[232:235], a[164:167]
ds_read_b128 a[224:227], v12 offset:4096
ds_read_b128 a[228:231], v13 offset:4096
M a[164:167], a[204:207], a[236:239], a[164:167]
M a[168:171], a[212:215], a[236:239], a[168:171]
M a[168:171], a[208:211], a[232:235], a[168:171]
buffer_load_dwordx4 v3, s[8:11], s23 offen offset:1024 lds
M a[172:175], a[216:219], a[232:235], a[172:175]
M a[172:175], a[220:223], a[236:239], a[172:175]
s_waitcnt lgkmcnt(4)
M a[68:71], a[176:179], a[240:243], a[68:71]
ds_read_b128 a[232:235], v12 offset:6144
ds_read_b128 a[236:239], v13 offset:6144
M a[68:71], a[180:183], a[244:247], a[68:71]
buffer_load_dwordx4 v4, s[8:11], s23 offen offset:2048 lds
M a[72:75], a[188:191], a[244:247], a[72:75]
ds_read_b64_tr_b16 a[200:201], v17 offset:0
ds_read_b64_tr_b16 a[202:203], v17 offset:1536
M a[72:75], a[184:187], a[240:243], a[72:75]
M a[76:79], a[192:195], a[240:243], a[76:79]
M a[76:79], a[196:199], a[244:247], a[76:79]
buffer_load_dwordx4 v5, s[8:11], s23 offen offset:3072 lds
s_add_u32 s23, s23, 128
s_waitcnt lgkmcnt(6)
M a[80:83], a[180:183], a[252:255], a[80:83]
ds_read_b128 a[240:243], v12 offset:8192
ds_read_b128 a[244:247], v13 offset:8192
M a[80:83], a[176:179], a[248:251], a[80:83]
M a[84:87], a[184:187], a[248:251], a[84:87]
ds_read_b64_tr_b16 a[208:209], v18 offset:0
ds_read_b64_tr_b16 a[210:211], v18 offset:1536
M a[84:87], a[188:191], a[252:255], a[84:87]
M a[88:91], a[196:199], a[252:255], a[88:91]
s_add_u32 m0, s30, 65536
s_nop 0
buffer_load_dwordx4 v6, s[12:15], s25 offen offset:0 lds
M a[88:91], a[192:195], a[248:251], a[88:91]
s_waitcnt lgkmcnt(8)
M a[92:95], a[176:179], a[224:227], a[92:95]
ds_read_b128 a[248:251], v12 offset:10240
ds_read_b128 a[252:255], v13 offset:10240
M a[92:95], a[180:183], a[228:231], a[92:95]
M a[96:99], a[188:191], a[228:231], a[96:99]
ds_read_b64_tr_b16 a[216:217], v19 offset:0
ds_read_b64_tr_b16 a[218:219], v19 offset:1536
M a[96:99], a[184:187], a[224:227], a[96:99]
M a[100:103], a[192:195], a[224:227], a[100:103]
buffer_load_dwordx4 v7, s[12:15], s25 offen offset:1024 lds
M a[100:103], a[196:199], a[228:231], a[100:103]
s_waitcnt lgkmcnt(10)
M a[104:107], a[180:183], a[236:239], a[104:107]
ds_read_b128 a[224:227], v12 offset:12288
ds_read_b128 a[228:231], v13 offset:12288
M a[104:107], a[176:179], a[232:235], a[104:107]
M a[108:111], a[184:187], a[232:235], a[108:111]
ds_read_b64_tr_b16 a[204:205], v17 offset:12288
ds_read_b64_tr_b16 a[206:207], v17 offset:13824
M a[108:111], a[188:191], a[236:239], a[108:111]
buffer_load_dwordx4 v8, s[12:15], s25 offen offset:2048 lds
M a[112:115], a[196:199], a[236:239], a[112:115]
M a[112:115], a[192:195], a[232:235], a[112:115]
s_waitcnt lgkmcnt(10)
M a[116:119], a[176:179], a[240:243], a[116:119]
ds_read_b128 a[232:235], v12 offset:14336
ds_read_b128 a[236:239], v13 offset:14336
M a[116:119], a[180:183], a[244:247], a[116:119]
buffer_load_dwordx4 v9, s[12:15], s25 offen offset:3072 lds
M a[120:123], a[188:191], a[244:247], a[120:123]
ds_read_b64_tr_b16 a[212:213], v18 offset:12288
ds_read_b64_tr_b16 a[214:215], v18 offset:13824
M a[120:123], a[184:187], a[240:243], a[120:123]
M a[124:127], a[192:195], a[240:243], a[124:127]
M a[124:127], a[196:199], a[244:247], a[124:127]
s_waitcnt lgkmcnt(10)
M a[128:131], a[180:183], a[252:255], a[128:131]
ds_read_b128 a[240:243], v12 offset:16384
ds_read_b128 a[244:247], v13 offset:16384
M a[128:131], a[176:179], a[248:251], a[128:131]
s_add_u32 m0, s30, 69632
s_nop 0
buffer_load_dwordx4 v21, s[12:15], s25 offen offset:0 lds
M a[132:135], a[184:187], a[248:251], a[132:135]
ds_read_b64_tr_b16 a[220:221], v19 offset:12288
ds_read_b64_tr_b16 a[222:223], v19 offset:13824
M a[132:135], a[188:191], a[252:255], a[132:135]
M a[136:139], a[196:199], a[252:255], a[136:139]
M a[136:139], a[192:195], a[248:251], a[136:139]
buffer_load_dwordx4 v22, s[12:15], s25 offen offset:1024 lds
s_add_u32 s25, s25, 393216
s_waitcnt lgkmcnt(10)
M a[140:143], a[176:179], a[224:227], a[140:143]
M a[140:143], a[180:183], a[228:231], a[140:143]
M a[144:147], a[188:191], a[228:231], a[144:147]
M a[144:147], a[184:187], a[224:227], a[144:147]
M a[148:151], a[192:195], a[224:227], a[148:151]
s_waitcnt vmcnt(12) lgkmcnt(0)
s_barrier
ds_read_b128 a[248:251], v10 offset:0
ds_read_b128 a[252:255], v11 offset:0
s_cmp_lg_u32 s101, 0
s_cbranch_scc1 Lk1_arr
v_mov_b32 v127, 1
s_and_b32 s41, s2, 128
s_mov_b64 exec, 1
buffer_atomic_add v127, off, s[36:39], s41 sc1
s_mov_b64 exec, -1
Lk1_arr:
M a[148:151], a[196:199], a[228:231], a[148:151]
s_add_u32 m0, s28, 131072
s_nop 0
buffer_load_dword v20, s[8:11], s24 offen lds
M a[152:155], a[180:183], a[236:239], a[152:155]
ds_read_b128 a[224:227], v10 offset:2048
ds_read_b128 a[228:231], v11 offset:2048
M a[152:155], a[176:179], a[232:235], a[152:155]
M a[156:159], a[184:187], a[232:235], a[156:159]
buffer_load_dword v23, s[8:11], s24 offen offset:256 lds
s_add_u32 s24, s24, 128
M a[156:159], a[188:191], a[236:239], a[156:159]
M a[160:163], a[196:199], a[236:239], a[160:163]
M a[160:163], a[192:195], a[232:235], a[160:163]
s_add_u32 m0, s29, 133120
s_nop 0
buffer_load_dwordx4 v2, s[8:11], s23 offen offset:0 lds
M a[164:167], a[176:179], a[240:243], a[164:167]
ds_read_b128 a[232:235], v10 offset:4096
ds_read_b128 a[236:239], v11 offset:4096
M a[164:167], a[180:183], a[244:247], a[164:167]
M a[168:171], a[188:191], a[244:247], a[168:171]
M a[168:171], a[184:187], a[240:243], a[168:171]
buffer_load_dwordx4 v3, s[8:11], s23 offen offset:1024 lds
M a[172:175], a[192:195], a[240:243], a[172:175]
M a[172:175], a[196:199], a[244:247], a[172:175]
s_waitcnt lgkmcnt(4)
M a[68:71], a[200:203], a[248:251], a[68:71]
ds_read_b128 a[240:243], v10 offset:6144
ds_read_b128 a[244:247], v11 offset:6144
M a[68:71], a[204:207], a[252:255], a[68:71]
buffer_load_dwordx4 v4, s[8:11], s23 offen offset:2048 lds
M a[72:75], a[212:215], a[252:255], a[72:75]
ds_read_b64_tr_b16 a[176:177], v14 offset:0
ds_read_b64_tr_b16 a[178:179], v14 offset:1536
M a[72:75], a[208:211], a[248:251], a[72:75]
M a[76:79], a[216:219], a[248:251], a[76:79]
M a[76:79], a[220:223], a[252:255], a[76:79]
buffer_load_dwordx4 v5, s[8:11], s23 offen offset:3072 lds
s_add_u32 s23, s23, 128
s_waitcnt lgkmcnt(6)
M a[80:83], a[204:207], a[228:231], a[80:83]
ds_read_b128 a[248:251], v10 offset:8192
ds_read_b128 a[252:255], v11 offset:8192
M a[80:83], a[200:203], a[224:227], a[80:83]
M a[84:87], a[208:211], a[224:227], a[84:87]
ds_read_b64_tr_b16 a[184:185], v15 offset:0
ds_read_b64_tr_b16 a[186:187], v15 offset:1536
M a[84:87], a[212:215], a[228:231], a[84:87]
M a[88:91], a[220:223], a[228:231], a[88:91]
s_add_u32 m0, s30, 98304
s_nop 0
buffer_load_dwordx4 v6, s[12:15], s25 offen offset:0 lds
M a[88:91], a[216:219], a[224:227], a[88:91]
s_waitcnt lgkmcnt(8)
M a[92:95], a[200:203], a[232:235], a[92:95]
ds_read_b128 a[224:227], v10 offset:10240
ds_read_b128 a[228:231], v11 offset:10240
M a[92:95], a[204:207], a[236:239], a[92:95]
M a[96:99], a[212:215], a[236:239], a[96:99]
ds_read_b64_tr_b16 a[192:193], v16 offset:0
ds_read_b64_tr_b16 a[194:195], v16 offset:1536
M a[96:99], a[208:211], a[232:235], a[96:99]
M a[100:103], a[216:219], a[232:235], a[100:103]
buffer_load_dwordx4 v7, s[12:15], s25 offen offset:1024 lds
M a[100:103], a[220:223], a[236:239], a[100:103]
s_waitcnt lgkmcnt(10)
M a[104:107], a[204:207], a[244:247], a[104:107]
ds_read_b128 a[232:235], v10 offset:12288
ds_read_b128 a[236:239], v11 offset:12288
M a[104:107], a[200:203], a[240:243], a[104:107]
M a[108:111], a[208:211], a[240:243], a[108:111]
ds_read_b64_tr_b16 a[180:181], v14 offset:12288
ds_read_b64_tr_b16 a[182:183], v14 offset:13824
M a[108:111], a[212:215], a[244:247], a[108:111]
buffer_load_dwordx4 v8, s[12:15], s25 offen offset:2048 lds
M a[112:115], a[220:223], a[244:247], a[112:115]
M a[112:115], a[216:219], a[240:243], a[112:115]
s_waitcnt lgkmcnt(10)
M a[116:119], a[200:203], a[248:251], a[116:119]
ds_read_b128 a[240:243], v10 offset:14336
ds_read_b128 a[244:247], v11 offset:14336
M a[116:119], a[204:207], a[252:255], a[116:119]
buffer_load_dwordx4 v9, s[12:15], s25 offen offset:3072 lds
M a[120:123], a[212:215], a[252:255], a[120:123]
ds_read_b64_tr_b16 a[188:189], v15 offset:12288
ds_read_b64_tr_b16 a[190:191], v15 offset:13824
M a[120:123], a[208:211], a[248:251], a[120:123]
M a[124:127], a[216:219], a[248:251], a[124:127]
M a[124:127], a[220:223], a[252:255], a[124:127]
s_waitcnt lgkmcnt(10)
M a[128:131], a[204:207], a[228:231], a[128:131]
ds_read_b128 a[248:251], v10 offset:16384
ds_read_b128 a[252:255], v11 offset:16384
M a[128:131], a[200:203], a[224:227], a[128:131]
s_add_u32 m0, s30, 102400
s_nop 0
buffer_load_dwordx4 v21, s[12:15], s25 offen offset:0 lds
M a[132:135], a[208:211], a[224:227], a[132:135]
ds_read_b64_tr_b16 a[196:197], v16 offset:12288
ds_read_b64_tr_b16 a[198:199], v16 offset:13824
M a[132:135], a[212:215], a[228:231], a[132:135]
M a[136:139], a[220:223], a[228:231], a[136:139]
M a[136:139], a[216:219], a[224:227], a[136:139]
buffer_load_dwordx4 v22, s[12:15], s25 offen offset:1024 lds
s_add_u32 s25, s25, 393216
s_waitcnt lgkmcnt(10)
M a[140:143], a[200:203], a[232:235], a[140:143]
M a[140:143], a[204:207], a[236:239], a[140:143]
M a[144:147], a[212:215], a[236:239], a[144:147]
M a[144:147], a[208:211], a[232:235], a[144:147]
M a[148:151], a[216:219], a[232:235], a[148:151]
s_waitcnt vmcnt(12) lgkmcnt(0)
s_barrier
ds_read_b128 a[224:227], v10 offset:18432
ds_read_b128 a[228:231], v11 offset:18432
M a[148:151], a[220:223], a[236:239], a[148:151]
s_add_u32 m0, s28, 0
s_nop 0
buffer_load_dword v20, s[8:11], s24 offen lds
M a[152:155], a[204:207], a[244:247], a[152:155]
ds_read_b128 a[232:235], v10 offset:20480
ds_read_b128 a[236:239], v11 offset:20480
M a[152:155], a[200:203], a[240:243], a[152:155]
M a[156:159], a[208:211], a[240:243], a[156:159]
buffer_load_dword v23, s[8:11], s24 offen offset:256 lds
s_add_u32 s24, s24, 128
M a[156:159], a[212:215], a[244:247], a[156:159]
M a[160:163], a[220:223], a[244:247], a[160:163]
M a[160:163], a[216:219], a[240:243], a[160:163]
s_add_u32 m0, s29, 2048
s_nop 0
buffer_load_dwordx4 v2, s[8:11], s23 offen offset:0 lds
M a[164:167], a[200:203], a[248:251], a[164:167]
ds_read_b128 a[240:243], v10 offset:22528
ds_read_b128 a[244:247], v11 offset:22528
M a[164:167], a[204:207], a[252:255], a[164:167]
M a[168:171], a[212:215], a[252:255], a[168:171]
M a[168:171], a[208:211], a[248:251], a[168:171]
buffer_load_dwordx4 v3, s[8:11], s23 offen offset:1024 lds
M a[172:175], a[216:219], a[248:251], a[172:175]
M a[172:175], a[220:223], a[252:255], a[172:175]
s_waitcnt lgkmcnt(4)
M a[68:71], a[176:179], a[224:227], a[68:71]
ds_read_b128 a[248:251], v10 offset:24576
ds_read_b128 a[252:255], v11 offset:24576
v_mov_b32 v160, 0
v_mov_b32 v161, 0
M a[68:71], a[180:183], a[228:231], a[68:71]
buffer_load_dwordx4 v4, s[8:11], s23 offen offset:2048 lds
M a[72:75], a[188:191], a[228:231], a[72:75]
ds_read_b64_tr_b16 a[200:201], v14 offset:28672
ds_read_b64_tr_b16 a[202:203], v14 offset:30208
v_mov_b32 v162, 0
v_mov_b32 v163, 0
M a[72:75], a[184:187], a[224:227], a[72:75]
M a[76:79], a[192:195], a[224:227], a[76:79]
v_mov_b32 v164, 0
v_mov_b32 v165, 0
M a[76:79], a[196:199], a[228:231], a[76:79]
buffer_load_dwordx4 v5, s[8:11], s23 offen offset:3072 lds
s_add_u32 s23, s23, 128
s_waitcnt lgkmcnt(6)
M a[80:83], a[180:183], a[236:239], a[80:83]
ds_read_b128 a[224:227], v10 offset:26624
ds_read_b128 a[228:231], v11 offset:26624
v_mov_b32 v166, 0
v_mov_b32 v167, 0
M a[80:83], a[176:179], a[232:235], a[80:83]
M a[84:87], a[184:187], a[232:235], a[84:87]
ds_read_b64_tr_b16 a[208:209], v15 offset:28672
ds_read_b64_tr_b16 a[210:211], v15 offset:30208
M a[84:87], a[188:191], a[236:239], a[84:87]
v_mov_b32 v168, 0
v_mov_b32 v169, 0
M a[88:91], a[196:199], a[236:239], a[88:91]
s_add_u32 m0, s30, 36864
s_nop 0
buffer_load_dwordx4 v6, s[12:15], s25 offen offset:0 lds
M a[88:91], a[192:195], a[232:235], a[88:91]
s_waitcnt lgkmcnt(8)
v_mov_b32 v170, 0
v_mov_b32 v171, 0
M a[92:95], a[176:179], a[240:243], a[92:95]
ds_read_b128 a[232:235], v10 offset:28672
ds_read_b128 a[236:239], v11 offset:28672
M a[92:95], a[180:183], a[244:247], a[92:95]
v_mov_b32 v172, 0
v_mov_b32 v173, 0
M a[96:99], a[188:191], a[244:247], a[96:99]
ds_read_b64_tr_b16 a[216:217], v16 offset:28672
ds_read_b64_tr_b16 a[218:219], v16 offset:30208
M a[96:99], a[184:187], a[240:243], a[96:99]
v_mov_b32 v174, 0
v_mov_b32 v175, 0
M a[100:103], a[192:195], a[240:243], a[100:103]
buffer_load_dwordx4 v7, s[12:15], s25 offen offset:1024 lds
M a[100:103], a[196:199], a[244:247], a[100:103]
s_waitcnt lgkmcnt(10)
M a[104:107], a[180:183], a[252:255], a[104:107]
ds_read_b128 a[240:243], v10 offset:30720
ds_read_b128 a[244:247], v11 offset:30720
v_mov_b32 v176, 0
v_mov_b32 v177, 0
M a[104:107], a[176:179], a[248:251], a[104:107]
M a[108:111], a[184:187], a[248:251], a[108:111]
ds_read_b64_tr_b16 a[204:205], v14 offset:40960
ds_read_b64_tr_b16 a[206:207], v14 offset:42496
v_mov_b32 v178, 0
v_mov_b32 v179, 0
M a[108:111], a[188:191], a[252:255], a[108:111]
buffer_load_dwordx4 v8, s[12:15], s25 offen offset:2048 lds
M a[112:115], a[196:199], a[252:255], a[112:115]
v_mov_b32 v180, 0
v_mov_b32 v181, 0
M a[112:115], a[192:195], a[248:251], a[112:115]
s_waitcnt lgkmcnt(10)
M a[116:119], a[176:179], a[224:227], a[116:119]
ds_read_b128 a[248:251], v10 offset:32768
ds_read_b128 a[252:255], v11 offset:32768
v_mov_b32 v182, 0
v_mov_b32 v183, 0
M a[116:119], a[180:183], a[228:231], a[116:119]
buffer_load_dwordx4 v9, s[12:15], s25 offen offset:3072 lds
M a[120:123], a[188:191], a[228:231], a[120:123]
ds_read_b64_tr_b16 a[212:213], v15 offset:40960
ds_read_b64_tr_b16 a[214:215], v15 offset:42496
M a[120:123], a[184:187], a[224:227], a[120:123]
v_mov_b32 v184, 0
v_mov_b32 v185, 0
M a[124:127], a[192:195], a[224:227], a[124:127]
M a[124:127], a[196:199], a[228:231], a[124:127]
s_waitcnt lgkmcnt(10)
v_mov_b32 v186, 0
v_mov_b32 v187, 0
M a[128:131], a[180:183], a[236:239], a[128:131]
ds_read_b128 a[224:227], v10 offset:34816
ds_read_b128 a[228:231], v11 offset:34816
M a[128:131], a[176:179], a[232:235], a[128:131]
s_add_u32 m0, s30, 40960
s_nop 0
buffer_load_dwordx4 v21, s[12:15], s25 offen offset:0 lds
v_mov_b32 v188, 0
v_mov_b32 v189, 0
M a[132:135], a[184:187], a[232:235], a[132:135]
ds_read_b64_tr_b16 a[220:221], v16 offset:40960
ds_read_b64_tr_b16 a[222:223], v16 offset:42496
M a[132:135], a[188:191], a[236:239], a[132:135]
v_mov_b32 v190, 0
v_mov_b32 v191, 0
M a[136:139], a[196:199], a[236:239], a[136:139]
M a[136:139], a[192:195], a[232:235], a[136:139]
buffer_load_dwordx4 v22, s[12:15], s25 offen offset:1024 lds
s_add_u32 s25, s25, 393216
s_waitcnt lgkmcnt(10)
M a[140:143], a[176:179], a[240:243], a[140:143]
v_mov_b32 v192, 0
v_mov_b32 v193, 0
M a[140:143], a[180:183], a[244:247], a[140:143]
M a[144:147], a[188:191], a[244:247], a[144:147]
v_mov_b32 v194, 0
v_mov_b32 v195, 0
M a[144:147], a[184:187], a[240:243], a[144:147]
M a[148:151], a[192:195], a[240:243], a[148:151]
s_waitcnt vmcnt(12) lgkmcnt(0)
s_barrier
ds_read_b128 a[232:235], v12 offset:0
ds_read_b128 a[236:239], v13 offset:0
v_mov_b32 v196, 0
v_mov_b32 v197, 0
M a[148:151], a[196:199], a[244:247], a[148:151]
s_add_u32 m0, s28, 18432
s_nop 0
buffer_load_dword v20, s[8:11], s24 offen lds
M a[152:155], a[180:183], a[252:255], a[152:155]
ds_read_b128 a[240:243], v12 offset:2048
ds_read_b128 a[244:247], v13 offset:2048
v_mov_b32 v198, 0
v_mov_b32 v199, 0
M a[152:155], a[176:179], a[248:251], a[152:155]
M a[156:159], a[184:187], a[248:251], a[156:159]
buffer_load_dword v23, s[8:11], s24 offen offset:256 lds
s_add_u32 s24, s24, 128
M a[156:159], a[188:191], a[252:255], a[156:159]
v_mov_b32 v200, 0
v_mov_b32 v201, 0
M a[160:163], a[196:199], a[252:255], a[160:163]
M a[160:163], a[192:195], a[248:251], a[160:163]
s_add_u32 m0, s29, 20480
s_nop 0
buffer_load_dwordx4 v2, s[8:11], s23 offen offset:0 lds
v_mov_b32 v202, 0
v_mov_b32 v203, 0
M a[164:167], a[176:179], a[224:227], a[164:167]
ds_read_b128 a[248:251], v12 offset:4096
ds_read_b128 a[252:255], v13 offset:4096
M a[164:167], a[180:183], a[228:231], a[164:167]
v_mov_b32 v204, 0
v_mov_b32 v205, 0
M a[168:171], a[188:191], a[228:231], a[168:171]
M a[168:171], a[184:187], a[224:227], a[168:171]
buffer_load_dwordx4 v3, s[8:11], s23 offen offset:1024 lds
v_mov_b32 v206, 0
v_mov_b32 v207, 0
M a[172:175], a[192:195], a[224:227], a[172:175]
M a[172:175], a[196:199], a[228:231], a[172:175]
s_waitcnt lgkmcnt(4)
M a[68:71], a[200:203], a[232:235], a[68:71]
ds_read_b128 a[224:227], v12 offset:6144
ds_read_b128 a[228:231], v13 offset:6144
v_and_b32 v128, 15, v0
v_mul_u32_u24 v128, 400, v128
M a[68:71], a[204:207], a[236:239], a[68:71]
buffer_load_dwordx4 v4, s[8:11], s23 offen offset:2048 lds
M a[72:75], a[212:215], a[236:239], a[72:75]
ds_read_b64_tr_b16 a[176:177], v17 offset:0
ds_read_b64_tr_b16 a[178:179], v17 offset:1536
v_lshrrev_b32 v129, 4, v0
v_lshl_add_u32 v128, v129, 3, v128
M a[72:75], a[208:211], a[232:235], a[72:75]
M a[76:79], a[216:219], a[232:235], a[76:79]
s_mul_i32 s3, s20, 96
s_add_u32 s3, s3, 98304
M a[76:79], a[220:223], a[236:239], a[76:79]
buffer_load_dwordx4 v5, s[8:11], s23 offen offset:3072 lds
s_add_u32 s23, s23, 128
s_waitcnt lgkmcnt(6)
M a[80:83], a[204:207], a[244:247], a[80:83]
ds_read_b128 a[232:235], v12 offset:8192
ds_read_b128 a[236:239], v13 offset:8192
v_add_u32 v124, s3, v128
v_and_b32 v128, 15, v0
M a[80:83], a[200:203], a[240:243], a[80:83]
M a[84:87], a[208:211], a[240:243], a[84:87]
ds_read_b64_tr_b16 a[184:185], v18 offset:0
ds_read_b64_tr_b16 a[186:187], v18 offset:1536
v_lshrrev_b32 v129, 4, v0
s_add_u32 s3, s21, 16
M a[84:87], a[212:215], a[244:247], a[84:87]
M a[88:91], a[220:223], a[244:247], a[88:91]
s_add_u32 m0, s30, 65536
s_nop 0
buffer_load_dwordx4 v6, s[12:15], s25 offen offset:0 lds
v_lshl_add_u32 v130, v128, 1, s3
s_lshl_b32 s4, s22, 6
M a[88:91], a[216:219], a[240:243], a[88:91]
s_waitcnt lgkmcnt(8)
M a[92:95], a[200:203], a[248:251], a[92:95]
ds_read_b128 a[240:243], v12 offset:10240
ds_read_b128 a[244:247], v13 offset:10240
s_add_u32 s4, s4, 98304
v_mul_u32_u24 v120, 400, v130
M a[92:95], a[204:207], a[252:255], a[92:95]
M a[96:99], a[212:215], a[252:255], a[96:99]
ds_read_b64_tr_b16 a[192:193], v19 offset:0
ds_read_b64_tr_b16 a[194:195], v19 offset:1536
M a[96:99], a[208:211], a[248:251], a[96:99]
v_lshl_add_u32 v120, v129, 4, v120
v_add_u32 v120, s4, v120
M a[100:103], a[216:219], a[248:251], a[100:103]
buffer_load_dwordx4 v7, s[12:15], s25 offen offset:1024 lds
M a[100:103], a[220:223], a[252:255], a[100:103]
s_waitcnt lgkmcnt(10)
v_subrev_u32 v130, 32, v130
v_max_i32 v130, 0, v130
M a[104:107], a[204:207], a[228:231], a[104:107]
ds_read_b128 a[248:251], v12 offset:12288
ds_read_b128 a[252:255], v13 offset:12288
M a[104:107], a[200:203], a[224:227], a[104:107]
v_mul_u32_u24 v121, 400, v130
v_lshl_add_u32 v121, v129, 4, v121
M a[108:111], a[208:211], a[224:227], a[108:111]
ds_read_b64_tr_b16 a[180:181], v17 offset:12288
ds_read_b64_tr_b16 a[182:183], v17 offset:13824
M a[108:111], a[212:215], a[228:231], a[108:111]
buffer_load_dwordx4 v8, s[12:15], s25 offen offset:2048 lds
v_add_u32 v121, s4, v121
v_bfe_u32 v131, v0, 2, 2
M a[112:115], a[220:223], a[228:231], a[112:115]
M a[112:115], a[216:219], a[224:227], a[112:115]
s_waitcnt lgkmcnt(10)
v_lshl_add_u32 v131, v129, 2, v131
v_lshl_add_u32 v131, v131, 1, s3
M a[116:119], a[200:203], a[232:235], a[116:119]
ds_read_b128 a[224:227], v12 offset:14336
ds_read_b128 a[228:231], v13 offset:14336
M a[116:119], a[204:207], a[236:239], a[116:119]
buffer_load_dwordx4 v9, s[12:15], s25 offen offset:3072 lds
v_and_b32 v132, 3, v0
v_lshlrev_b32 v132, 3, v132
M a[120:123], a[212:215], a[236:239], a[120:123]
ds_read_b64_tr_b16 a[188:189], v18 offset:12288
ds_read_b64_tr_b16 a[190:191], v18 offset:13824
M a[120:123], a[208:211], a[232:235], a[120:123]
M a[124:127], a[216:219], a[232:235], a[124:127]
v_add_u32 v132, s4, v132
s_movk_i32 s5, 400
M a[124:127], a[220:223], a[236:239], a[124:127]
s_waitcnt lgkmcnt(10)
M a[128:131], a[204:207], a[244:247], a[128:131]
ds_read_b128 a[232:235], v12 offset:16384
ds_read_b128 a[236:239], v13 offset:16384
v_mad_u32_u24 v122, v131, s5, v132
v_subrev_u32 v131, 32, v131
M a[128:131], a[200:203], a[240:243], a[128:131]
s_add_u32 m0, s30, 69632
s_nop 0
buffer_load_dwordx4 v21, s[12:15], s25 offen offset:0 lds
M a[132:135], a[208:211], a[240:243], a[132:135]
ds_read_b64_tr_b16 a[196:197], v19 offset:12288
ds_read_b64_tr_b16 a[198:199], v19 offset:13824
v_max_i32 v131, 0, v131
v_mad_u32_u24 v123, v131, s5, v132
M a[132:135], a[212:215], a[244:247], a[132:135]
M a[136:139], a[220:223], a[244:247], a[136:139]
v_lshlrev_b32 v129, 2, v129
v_sub_u32 v128, v128, v129
M a[136:139], a[216:219], a[240:243], a[136:139]
buffer_load_dwordx4 v22, s[12:15], s25 offen offset:1024 lds
s_add_u32 s25, s25, 393216
s_waitcnt lgkmcnt(10)
M a[140:143], a[200:203], a[248:251], a[140:143]
v_mov_b32 v129, 0xf149f2ca
s_cmp_eq_u32 s26, 0
s_cselect_b32 s3, 0xf149f2ca, 0
M a[140:143], a[204:207], a[252:255], a[140:143]
M a[144:147], a[212:215], a[252:255], a[144:147]
v_cmp_lt_i32 vcc, -9, v128
s_nop 1
v_cndmask_b32 v144, 0, v129, vcc
M a[144:147], a[208:211], a[248:251], a[144:147]
M a[148:151], a[216:219], a[248:251], a[148:151]
s_waitcnt vmcnt(12) lgkmcnt(0)
s_barrier
ds_read_b128 a[240:243], v10 offset:0
ds_read_b128 a[244:247], v11 offset:0
M a[148:151], a[220:223], a[252:255], a[148:151]
s_add_u32 m0, s28, 131072
s_nop 0
buffer_load_dword v20, s[8:11], s24 offen lds
v_subrev_u32 v130, 0, v128
v_cmp_lt_u32 vcc, 7, v130
s_nop 1
v_cndmask_b32 v148, 0, v129, vcc
M a[152:155], a[204:207], a[228:231], a[152:155]
ds_read_b128 a[248:251], v10 offset:2048
ds_read_b128 a[252:255], v11 offset:2048
M a[152:155], a[200:203], a[224:227], a[152:155]
v_min_f32 v152, s3, v144
v_mov_b32 v156, 0x3f803f80
M a[156:159], a[208:211], a[224:227], a[156:159]
buffer_load_dword v23, s[8:11], s24 offen offset:256 lds
s_add_u32 s24, s24, 128
M a[156:159], a[212:215], a[228:231], a[156:159]
v_cmp_lt_i32 vcc, -8, v128
s_nop 1
v_cndmask_b32 v145, 0, v129, vcc
M a[160:163], a[220:223], a[228:231], a[160:163]
M a[160:163], a[216:219], a[224:227], a[160:163]
s_add_u32 m0, s29, 133120
s_nop 0
buffer_load_dwordx4 v2, s[8:11], s23 offen offset:0 lds
v_subrev_u32 v130, 1, v128
v_cmp_lt_u32 vcc, 7, v130
s_nop 1
v_cndmask_b32 v149, 0, v129, vcc
M a[164:167], a[200:203], a[232:235], a[164:167]
ds_read_b128 a[224:227], v10 offset:4096
ds_read_b128 a[228:231], v11 offset:4096
M a[164:167], a[204:207], a[236:239], a[164:167]
v_min_f32 v153, s3, v145
v_mov_b32 v157, 0x3f803f80
M a[168:171], a[212:215], a[236:239], a[168:171]
M a[168:171], a[208:211], a[232:235], a[168:171]
buffer_load_dwordx4 v3, s[8:11], s23 offen offset:1024 lds
v_cmp_lt_i32 vcc, -7, v128
s_nop 1
v_cndmask_b32 v146, 0, v129, vcc
M a[172:175], a[216:219], a[232:235], a[172:175]
M a[172:175], a[220:223], a[236:239], a[172:175]
s_waitcnt lgkmcnt(4)
M a[68:71], a[176:179], a[240:243], a[68:71]
ds_read_b128 a[232:235], v10 offset:6144
ds_read_b128 a[236:239], v11 offset:6144
v_subrev_u32 v130, 2, v128
v_cmp_lt_u32 vcc, 7, v130
s_nop 1
v_cndmask_b32 v150, 0, v129, vcc
M a[68:71], a[180:183], a[244:247], a[68:71]
buffer_load_dwordx4 v4, s[8:11], s23 offen offset:2048 lds
v_min_f32 v154, s3, v146
v_mov_b32 v158, 0x3f803f80
M a[72:75], a[188:191], a[244:247], a[72:75]
ds_read_b64_tr_b16 a[200:201], v14 offset:0
ds_read_b64_tr_b16 a[202:203], v14 offset:1536
M a[72:75], a[184:187], a[240:243], a[72:75]
v_cmp_lt_i32 vcc, -6, v128
s_nop 1
v_cndmask_b32 v147, 0, v129, vcc
M a[76:79], a[192:195], a[240:243], a[76:79]
v_subrev_u32 v130, 3, v128
v_cmp_lt_u32 vcc, 7, v130
s_nop 1
v_cndmask_b32 v151, 0, v129, vcc
M a[76:79], a[196:199], a[244:247], a[76:79]
buffer_load_dwordx4 v5, s[8:11], s23 offen offset:3072 lds
s_add_u32 s23, s23, 128
s_waitcnt lgkmcnt(6)
M a[80:83], a[180:183], a[252:255], a[80:83]
ds_read_b128 a[240:243], v10 offset:8192
ds_read_b128 a[244:247], v11 offset:8192
v_min_f32 v155, s3, v147
v_mov_b32 v159, 0x3f803f80
M a[80:83], a[176:179], a[248:251], a[80:83]
s_add_u32 s16, s50, 83886080
s_addc_u32 s17, s51, 0
M a[84:87], a[184:187], a[248:251], a[84:87]
ds_read_b64_tr_b16 a[208:209], v15 offset:0
ds_read_b64_tr_b16 a[210:211], v15 offset:1536
M a[84:87], a[188:191], a[252:255], a[84:87]
s_mov_b32 s18, 4194304
s_mov_b32 s19, 0x00020000
M a[88:91], a[196:199], a[252:255], a[88:91]
s_add_u32 m0, s30, 98304
s_nop 0
buffer_load_dwordx4 v6, s[12:15], s25 offen offset:0 lds
s_lshl_b32 s3, s26, 18
s_lshl_b32 s4, s27, 14
M a[88:91], a[192:195], a[248:251], a[88:91]
s_waitcnt lgkmcnt(8)
M a[92:95], a[176:179], a[224:227], a[92:95]
ds_read_b128 a[248:251], v10 offset:10240
ds_read_b128 a[252:255], v11 offset:10240
s_add_u32 s3, s3, s4
s_lshl_b32 s4, s21, 13
M a[92:95], a[180:183], a[228:231], a[92:95]
s_add_u32 s3, s3, s4
s_lshl_b32 s4, s22, 10
M a[96:99], a[188:191], a[228:231], a[96:99]
ds_read_b64_tr_b16 a[216:217], v16 offset:0
ds_read_b64_tr_b16 a[218:219], v16 offset:1536
M a[96:99], a[184:187], a[224:227], a[96:99]
s_add_u32 s6, s3, s4
s_mov_b32 s7, 0x3e8293ee
M a[100:103], a[192:195], a[224:227], a[100:103]
buffer_load_dwordx4 v7, s[12:15], s25 offen offset:1024 lds
s_lshl_b32 s65, s26, 8
s_lshl_b32 s3, s27, 4
M a[100:103], a[196:199], a[228:231], a[100:103]
s_waitcnt lgkmcnt(10)
M a[104:107], a[180:183], a[236:239], a[104:107]
ds_read_b128 a[224:227], v10 offset:12288
ds_read_b128 a[228:231], v11 offset:12288
s_add_u32 s65, s65, s3
s_lshl_b32 s3, s101, 2
M a[104:107], a[176:179], a[232:235], a[104:107]
s_add_u32 s65, s65, s3
s_add_u32 s65, s65, 16789504
M a[108:111], a[184:187], a[232:235], a[108:111]
ds_read_b64_tr_b16 a[204:205], v14 offset:12288
ds_read_b64_tr_b16 a[206:207], v14 offset:13824
M a[108:111], a[188:191], a[236:239], a[108:111]
buffer_load_dwordx4 v8, s[12:15], s25 offen offset:2048 lds
s_mov_b32 s40, 0
v_mov_b32 v119, 0
M a[112:115], a[196:199], a[236:239], a[112:115]
s_mov_b64 s[4:5], s[50:51]
s_and_b32 s20, s2, 7
M a[112:115], a[192:195], a[232:235], a[112:115]
s_waitcnt lgkmcnt(10)
M a[116:119], a[176:179], a[240:243], a[116:119]
ds_read_b128 a[232:235], v10 offset:14336
ds_read_b128 a[236:239], v11 offset:14336
s_lshr_b32 s33, s2, 6
s_lshl_b32 s33, s33, 3
M a[116:119], a[180:183], a[244:247], a[116:119]
buffer_load_dwordx4 v9, s[12:15], s25 offen offset:3072 lds
s_add_u32 s20, s20, s33
s_bfe_u32 s21, s2, 0x30003
M a[120:123], a[188:191], a[244:247], a[120:123]
ds_read_b64_tr_b16 a[212:213], v15 offset:12288
ds_read_b64_tr_b16 a[214:215], v15 offset:13824
M a[120:123], a[184:187], a[240:243], a[120:123]
s_sub_u32 s35, 15, s21
s_cmp_lt_u32 s101, 2
s_cselect_b32 s35, s21, s35
M a[124:127], a[192:195], a[240:243], a[124:127]
s_lshl_b32 s33, s20, 7
s_lshl_b32 s34, s35, 3
M a[124:127], a[196:199], a[244:247], a[124:127]
s_waitcnt lgkmcnt(10)
M a[128:131], a[180:183], a[252:255], a[128:131]
ds_read_b128 a[240:243], v10 offset:16384
ds_read_b128 a[244:247], v11 offset:16384
s_add_u32 s33, s33, s34
s_and_b32 s34, s101, 1
M a[128:131], a[176:179], a[248:251], a[128:131]
s_add_u32 m0, s30, 102400
s_nop 0
buffer_load_dwordx4 v21, s[12:15], s25 offen offset:0 lds
s_lshl_b32 s34, s34, 2
s_add_u32 s33, s33, s34
M a[132:135], a[184:187], a[248:251], a[132:135]
ds_read_b64_tr_b16 a[220:221], v16 offset:12288
ds_read_b64_tr_b16 a[222:223], v16 offset:13824
M a[132:135], a[188:191], a[252:255], a[132:135]
s_lshl_b32 s64, s33, 12
s_mov_b32 s44, s4
M a[136:139], a[196:199], a[252:255], a[136:139]
s_mov_b32 s45, s5
s_mov_b32 s46, 16777216
M a[136:139], a[192:195], a[248:251], a[136:139]
buffer_load_dwordx4 v22, s[12:15], s25 offen offset:1024 lds
s_add_u32 s25, s25, 393216
s_waitcnt lgkmcnt(10)
M a[140:143], a[176:179], a[224:227], a[140:143]
s_mov_b32 s47, 0x00020000
M a[140:143], a[180:183], a[228:231], a[140:143]
M a[144:147], a[188:191], a[228:231], a[144:147]
M a[144:147], a[184:187], a[224:227], a[144:147]
M a[148:151], a[192:195], a[224:227], a[148:151]
s_waitcnt vmcnt(12) lgkmcnt(0)
s_barrier
ds_read_b128 a[248:251], v10 offset:18432
ds_read_b128 a[252:255], v11 offset:18432
M a[148:151], a[196:199], a[228:231], a[148:151]
s_add_u32 m0, s28, 0
s_nop 0
buffer_load_dword v20, s[8:11], s24 offen lds
M a[152:155], a[180:183], a[236:239], a[152:155]
ds_read_b128 a[224:227], v10 offset:20480
ds_read_b128 a[228:231], v11 offset:20480
M a[152:155], a[176:179], a[232:235], a[152:155]
M a[156:159], a[184:187], a[232:235], a[156:159]
buffer_load_dword v23, s[8:11], s24 offen offset:256 lds
s_add_u32 s24, s24, 128
M a[156:159], a[188:191], a[236:239], a[156:159]
M a[160:163], a[196:199], a[236:239], a[160:163]
M a[160:163], a[192:195], a[232:235], a[160:163]
s_add_u32 m0, s29, 2048
s_nop 0
buffer_load_dwordx4 v2, s[8:11], s23 offen offset:0 lds
M a[164:167], a[176:179], a[240:243], a[164:167]
ds_read_b128 a[232:235], v10 offset:22528
ds_read_b128 a[236:239], v11 offset:22528
M a[164:167], a[180:183], a[244:247], a[164:167]
M a[168:171], a[188:191], a[244:247], a[168:171]
M a[168:171], a[184:187], a[240:243], a[168:171]
buffer_load_dwordx4 v3, s[8:11], s23 offen offset:1024 lds
M a[172:175], a[192:195], a[240:243], a[172:175]
M a[172:175], a[196:199], a[244:247], a[172:175]
s_waitcnt lgkmcnt(4)
M a[68:71], a[200:203], a[248:251], a[68:71]
ds_read_b128 a[240:243], v10 offset:24576
ds_read_b128 a[244:247], v11 offset:24576
M a[68:71], a[204:207], a[252:255], a[68:71]
buffer_load_dwordx4 v4, s[8:11], s23 offen offset:2048 lds
M a[72:75], a[212:215], a[252:255], a[72:75]
ds_read_b64_tr_b16 a[176:177], v14 offset:28672
ds_read_b64_tr_b16 a[178:179], v14 offset:30208
M a[72:75], a[208:211], a[248:251], a[72:75]
M a[76:79], a[216:219], a[248:251], a[76:79]
M a[76:79], a[220:223], a[252:255], a[76:79]
buffer_load_dwordx4 v5, s[8:11], s23 offen offset:3072 lds
s_add_u32 s23, s23, 128
s_waitcnt lgkmcnt(6)
M a[80:83], a[204:207], a[228:231], a[80:83]
ds_read_b128 a[248:251], v10 offset:26624
ds_read_b128 a[252:255], v11 offset:26624
M a[80:83], a[200:203], a[224:227], a[80:83]
M a[84:87], a[208:211], a[224:227], a[84:87]
ds_read_b64_tr_b16 a[184:185], v15 offset:28672
ds_read_b64_tr_b16 a[186:187], v15 offset:30208
M a[84:87], a[212:215], a[228:231], a[84:87]
M a[88:91], a[220:223], a[228:231], a[88:91]
s_add_u32 m0, s30, 36864
s_nop 0
buffer_load_dwordx4 v6, s[12:15], s25 offen offset:0 lds
M a[88:91], a[216:219], a[224:227], a[88:91]
s_waitcnt lgkmcnt(8)
M a[92:95], a[200:203], a[232:235], a[92:95]
ds_read_b128 a[224:227], v10 offset:28672
ds_read_b128 a[228:231], v11 offset:28672
M a[92:95], a[204:207], a[236:239], a[92:95]
M a[96:99], a[212:215], a[236:239], a[96:99]
ds_read_b64_tr_b16 a[192:193], v16 offset:28672
ds_read_b64_tr_b16 a[194:195], v16 offset:30208
M a[96:99], a[208:211], a[232:235], a[96:99]
M a[100:103], a[216:219], a[232:235], a[100:103]
buffer_load_dwordx4 v7, s[12:15], s25 offen offset:1024 lds
M a[100:103], a[220:223], a[236:239], a[100:103]
s_waitcnt lgkmcnt(10)
M a[104:107], a[204:207], a[244:247], a[104:107]
ds_read_b128 a[232:235], v10 offset:30720
ds_read_b128 a[236:239], v11 offset:30720
M a[104:107], a[200:203], a[240:243], a[104:107]
M a[108:111], a[208:211], a[240:243], a[108:111]
ds_read_b64_tr_b16 a[180:181], v14 offset:40960
ds_read_b64_tr_b16 a[182:183], v14 offset:42496
M a[108:111], a[212:215], a[244:247], a[108:111]
buffer_load_dwordx4 v8, s[12:15], s25 offen offset:2048 lds
M a[112:115], a[220:223], a[244:247], a[112:115]
M a[112:115], a[216:219], a[240:243], a[112:115]
s_waitcnt lgkmcnt(10)
M a[116:119], a[200:203], a[248:251], a[116:119]
ds_read_b128 a[240:243], v10 offset:32768
ds_read_b128 a[244:247], v11 offset:32768
M a[116:119], a[204:207], a[252:255], a[116:119]
buffer_load_dwordx4 v9, s[12:15], s25 offen offset:3072 lds
M a[120:123], a[212:215], a[252:255], a[120:123]
ds_read_b64_tr_b16 a[188:189], v15 offset:40960
ds_read_b64_tr_b16 a[190:191], v15 offset:42496
M a[120:123], a[208:211], a[248:251], a[120:123]
M a[124:127], a[216:219], a[248:251], a[124:127]
M a[124:127], a[220:223], a[252:255], a[124:127]
s_waitcnt lgkmcnt(10)
M a[128:131], a[204:207], a[228:231], a[128:131]
ds_read_b128 a[248:251], v10 offset:34816
ds_read_b128 a[252:255], v11 offset:34816
M a[128:131], a[200:203], a[224:227], a[128:131]
s_add_u32 m0, s30, 40960
s_nop 0
buffer_load_dwordx4 v21, s[12:15], s25 offen offset:0 lds
M a[132:135], a[208:211], a[224:227], a[132:135]
ds_read_b64_tr_b16 a[196:197], v16 offset:40960
ds_read_b64_tr_b16 a[198:199], v16 offset:42496
M a[132:135], a[212:215], a[228:231], a[132:135]
M a[136:139], a[220:223], a[228:231], a[136:139]
M a[136:139], a[216:219], a[224:227], a[136:139]
buffer_load_dwordx4 v22, s[12:15], s25 offen offset:1024 lds
s_add_u32 s25, s25, 393216
s_waitcnt lgkmcnt(10)
M a[140:143], a[200:203], a[232:235], a[140:143]
M a[140:143], a[204:207], a[236:239], a[140:143]
M a[144:147], a[212:215], a[236:239], a[144:147]
M a[144:147], a[208:211], a[232:235], a[144:147]
M a[148:151], a[216:219], a[232:235], a[148:151]
s_waitcnt vmcnt(12) lgkmcnt(0)
s_barrier
ds_read_b128 a[224:227], v12 offset:0
ds_read_b128 a[228:231], v13 offset:0
M a[148:151], a[220:223], a[236:239], a[148:151]
s_add_u32 m0, s28, 18432
s_nop 0
buffer_load_dword v20, s[8:11], s24 offen lds
M a[152:155], a[204:207], a[244:247], a[152:155]
ds_read_b128 a[232:235], v12 offset:2048
ds_read_b128 a[236:239], v13 offset:2048
M a[152:155], a[200:203], a[240:243], a[152:155]
M a[156:159], a[208:211], a[240:243], a[156:159]
buffer_load_dword v23, s[8:11], s24 offen offset:256 lds
s_add_u32 s24, s24, 128
M a[156:159], a[212:215], a[244:247], a[156:159]
M a[160:163], a[220:223], a[244:247], a[160:163]
M a[160:163], a[216:219], a[240:243], a[160:163]
s_add_u32 m0, s29, 20480
s_nop 0
buffer_load_dwordx4 v2, s[8:11], s23 offen offset:0 lds
M a[164:167], a[200:203], a[248:251], a[164:167]
ds_read_b128 a[240:243], v12 offset:4096
ds_read_b128 a[244:247], v13 offset:4096
M a[164:167], a[204:207], a[252:255], a[164:167]
M a[168:171], a[212:215], a[252:255], a[168:171]
M a[168:171], a[208:211], a[248:251], a[168:171]
buffer_load_dwordx4 v3, s[8:11], s23 offen offset:1024 lds
M a[172:175], a[216:219], a[248:251], a[172:175]
M a[172:175], a[220:223], a[252:255], a[172:175]
s_waitcnt lgkmcnt(4)
M a[68:71], a[176:179], a[224:227], a[68:71]
ds_read_b128 a[248:251], v12 offset:6144
ds_read_b128 a[252:255], v13 offset:6144
M a[68:71], a[180:183], a[228:231], a[68:71]
buffer_load_dwordx4 v4, s[8:11], s23 offen offset:2048 lds
M a[72:75], a[188:191], a[228:231], a[72:75]
ds_read_b64_tr_b16 a[200:201], v17 offset:0
ds_read_b64_tr_b16 a[202:203], v17 offset:1536
M a[72:75], a[184:187], a[224:227], a[72:75]
M a[76:79], a[192:195], a[224:227], a[76:79]
M a[76:79], a[196:199], a[228:231], a[76:79]
buffer_load_dwordx4 v5, s[8:11], s23 offen offset:3072 lds
s_add_u32 s23, s23, 128
s_waitcnt lgkmcnt(6)
M a[80:83], a[180:183], a[236:239], a[80:83]
ds_read_b128 a[224:227], v12 offset:8192
ds_read_b128 a[228:231], v13 offset:8192
M a[80:83], a[176:179], a[232:235], a[80:83]
M a[84:87], a[184:187], a[232:235], a[84:87]
ds_read_b64_tr_b16 a[208:209], v18 offset:0
ds_read_b64_tr_b16 a[210:211], v18 offset:1536
M a[84:87], a[188:191], a[236:239], a[84:87]
M a[88:91], a[196:199], a[236:239], a[88:91]
s_add_u32 m0, s30, 65536
s_nop 0
buffer_load_dwordx4 v6, s[12:15], s25 offen offset:0 lds
M a[88:91], a[192:195], a[232:235], a[88:91]
s_waitcnt lgkmcnt(8)
M a[92:95], a[176:179], a[240:243], a[92:95]
ds_read_b128 a[232:235], v12 offset:10240
ds_read_b128 a[236:239], v13 offset:10240
M a[92:95], a[180:183], a[244:247], a[92:95]
M a[96:99], a[188:191], a[244:247], a[96:99]
ds_read_b64_tr_b16 a[216:217], v19 offset:0
ds_read_b64_tr_b16 a[218:219], v19 offset:1536
M a[96:99], a[184:187], a[240:243], a[96:99]
buffer_load_dwordx4 v7, s[12:15], s25 offen offset:1024 lds
M a[100:103], a[192:195], a[240:243], a[100:103]
M a[100:103], a[196:199], a[244:247], a[100:103]
s_waitcnt lgkmcnt(10)
M a[104:107], a[180:183], a[252:255], a[104:107]
ds_read_b128 a[240:243], v12 offset:12288
ds_read_b128 a[244:247], v13 offset:12288
M a[104:107], a[176:179], a[248:251], a[104:107]
buffer_load_dwordx4 v8, s[12:15], s25 offen offset:2048 lds
M a[108:111], a[184:187], a[248:251], a[108:111]
ds_read_b64_tr_b16 a[204:205], v17 offset:12288
ds_read_b64_tr_b16 a[206:207], v17 offset:13824
M a[108:111], a[188:191], a[252:255], a[108:111]
M a[112:115], a[196:199], a[252:255], a[112:115]
M a[112:115], a[192:195], a[248:251], a[112:115]
buffer_load_dwordx4 v9, s[12:15], s25 offen offset:3072 lds
s_waitcnt lgkmcnt(10)
M a[116:119], a[176:179], a[224:227], a[116:119]
ds_read_b128 a[248:251], v12 offset:14336
ds_read_b128 a[252:255], v13 offset:14336
M a[116:119], a[180:183], a[228:231], a[116:119]
M a[120:123], a[188:191], a[228:231], a[120:123]
ds_read_b64_tr_b16 a[212:213], v18 offset:12288
ds_read_b64_tr_b16 a[214:215], v18 offset:13824
M a[120:123], a[184:187], a[224:227], a[120:123]
M a[124:127], a[192:195], a[224:227], a[124:127]
s_add_u32 m0, s30, 69632
s_nop 0
buffer_load_dwordx4 v21, s[12:15], s25 offen offset:0 lds
M a[124:127], a[196:199], a[228:231], a[124:127]
s_waitcnt lgkmcnt(10)
M a[128:131], a[180:183], a[236:239], a[128:131]
ds_read_b128 a[224:227], v12 offset:16384
ds_read_b128 a[228:231], v13 offset:16384
M a[128:131], a[176:179], a[232:235], a[128:131]
M a[132:135], a[184:187], a[232:235], a[132:135]
ds_read_b64_tr_b16 a[220:221], v19 offset:12288
ds_read_b64_tr_b16 a[222:223], v19 offset:13824
M a[132:135], a[188:191], a[236:239], a[132:135]
buffer_load_dwordx4 v22, s[12:15], s25 offen offset:1024 lds
s_add_u32 s25, s25, 393216
M a[136:139], a[196:199], a[236:239], a[136:139]
M a[136:139], a[192:195], a[232:235], a[136:139]
s_waitcnt lgkmcnt(10)
M a[140:143], a[176:179], a[240:243], a[140:143]
buffer_load_dword v125, v119, s[36:39], 0 offen sc1
M a[140:143], a[180:183], a[244:247], a[140:143]
M a[144:147], a[188:191], a[244:247], a[144:147]
M a[144:147], a[184:187], a[240:243], a[144:147]
M a[148:151], a[192:195], a[240:243], a[148:151]
s_waitcnt vmcnt(13) lgkmcnt(0)
s_barrier
ds_read_b128 a[232:235], v10 offset:0
ds_read_b128 a[236:239], v11 offset:0
s_waitcnt vmcnt(0)
v_cmp_gt_u32 vcc, 0x80, v125
s_nop 0
s_cbranch_vccnz Lk1_spinq
Lk1_gotq:
M a[148:151], a[196:199], a[244:247], a[148:151]
s_add_u32 m0, s28, 131072
s_nop 0
buffer_load_dword v20, s[8:11], s24 offen lds
M a[152:155], a[180:183], a[252:255], a[152:155]
ds_read_b128 a[240:243], v10 offset:2048
ds_read_b128 a[244:247], v11 offset:2048
M a[152:155], a[176:179], a[248:251], a[152:155]
M a[156:159], a[184:187], a[248:251], a[156:159]
buffer_load_dword v23, s[8:11], s24 offen offset:256 lds
s_add_u32 s24, s24, 128
M a[156:159], a[188:191], a[252:255], a[156:159]
M a[160:163], a[196:199], a[252:255], a[160:163]
M a[160:163], a[192:195], a[248:251], a[160:163]
s_add_u32 m0, s29, 133120
s_nop 0
buffer_load_dwordx4 v2, s[8:11], s23 offen offset:0 lds
M a[164:167], a[176:179], a[224:227], a[164:167]
ds_read_b128 a[248:251], v10 offset:4096
ds_read_b128 a[252:255], v11 offset:4096
M a[164:167], a[180:183], a[228:231], a[164:167]
M a[168:171], a[188:191], a[228:231], a[168:171]
M a[168:171], a[184:187], a[224:227], a[168:171]
buffer_load_dwordx4 v3, s[8:11], s23 offen offset:1024 lds
M a[172:175], a[192:195], a[224:227], a[172:175]
M a[172:175], a[196:199], a[228:231], a[172:175]
s_waitcnt lgkmcnt(4)
M a[68:71], a[200:203], a[232:235], a[68:71]
ds_read_b128 a[224:227], v10 offset:6144
ds_read_b128 a[228:231], v11 offset:6144
v_mov_b32 v208, 0
v_mov_b32 v209, 0
M a[68:71], a[204:207], a[236:239], a[68:71]
buffer_load_dwordx4 v4, s[8:11], s23 offen offset:2048 lds
M a[72:75], a[212:215], a[236:239], a[72:75]
ds_read_b64_tr_b16 a[176:177], v14 offset:0
ds_read_b64_tr_b16 a[178:179], v14 offset:1536
v_mov_b32 v210, 0
v_mov_b32 v211, 0
M a[72:75], a[208:211], a[232:235], a[72:75]
M a[76:79], a[216:219], a[232:235], a[76:79]
buffer_load_dwordx4 v5, s[8:11], s23 offen offset:3072 lds
s_add_u32 s23, s23, 128
v_mov_b32 v212, 0
v_mov_b32 v213, 0
M a[76:79], a[220:223], a[236:239], a[76:79]
s_waitcnt lgkmcnt(6)
M a[80:83], a[204:207], a[244:247], a[80:83]
ds_read_b128 a[232:235], v10 offset:8192
ds_read_b128 a[236:239], v11 offset:8192
v_mov_b32 v214, 0
v_mov_b32 v215, 0
M a[80:83], a[200:203], a[240:243], a[80:83]
M a[84:87], a[208:211], a[240:243], a[84:87]
ds_read_b64_tr_b16 a[184:185], v15 offset:0
ds_read_b64_tr_b16 a[186:187], v15 offset:1536
M a[84:87], a[212:215], a[244:247], a[84:87]
buffer_load_dwordx4 a[0:3], v1, s[44:47], s64 offen offset:0 sc1
v_mov_b32 v216, 0
v_mov_b32 v217, 0
M a[88:91], a[220:223], a[244:247], a[88:91]
M a[88:91], a[216:219], a[240:243], a[88:91]
s_waitcnt lgkmcnt(8)
v_mov_b32 v218, 0
v_mov_b32 v219, 0
M a[92:95], a[200:203], a[248:251], a[92:95]
ds_read_b128 a[240:243], v10 offset:10240
ds_read_b128 a[244:247], v11 offset:10240
M a[92:95], a[204:207], a[252:255], a[92:95]
buffer_load_dwordx4 a[4:7], v1, s[44:47], s64 offen offset:1024 sc1
v_mov_b32 v220, 0
v_mov_b32 v221, 0
M a[96:99], a[212:215], a[252:255], a[96:99]
ds_read_b64_tr_b16 a[192:193], v16 offset:0
ds_read_b64_tr_b16 a[194:195], v16 offset:1536
M a[96:99], a[208:211], a[248:251], a[96:99]
v_mov_b32 v222, 0
v_mov_b32 v223, 0
M a[100:103], a[216:219], a[248:251], a[100:103]
buffer_load_dwordx4 a[8:11], v1, s[44:47], s64 offen offset:2048 sc1
M a[100:103], a[220:223], a[252:255], a[100:103]
s_waitcnt lgkmcnt(10)
M a[104:107], a[204:207], a[228:231], a[104:107]
ds_read_b128 a[248:251], v10 offset:12288
ds_read_b128 a[252:255], v11 offset:12288
v_mov_b32 v224, 0
v_mov_b32 v225, 0
M a[104:107], a[200:203], a[224:227], a[104:107]
M a[108:111], a[208:211], a[224:227], a[108:111]
ds_read_b64_tr_b16 a[180:181], v14 offset:12288
ds_read_b64_tr_b16 a[182:183], v14 offset:13824
v_mov_b32 v226, 0
v_mov_b32 v227, 0
M a[108:111], a[212:215], a[228:231], a[108:111]
buffer_load_dwordx4 a[12:15], v1, s[44:47], s64 offen offset:3072 sc1
s_add_u32 s64, s64, 4096
M a[112:115], a[220:223], a[228:231], a[112:115]
v_mov_b32 v228, 0
v_mov_b32 v229, 0
M a[112:115], a[216:219], a[224:227], a[112:115]
s_waitcnt lgkmcnt(10)
M a[116:119], a[200:203], a[232:235], a[116:119]
ds_read_b128 a[224:227], v10 offset:14336
ds_read_b128 a[228:231], v11 offset:14336
v_mov_b32 v230, 0
v_mov_b32 v231, 0
M a[116:119], a[204:207], a[236:239], a[116:119]
buffer_load_dwordx4 a[16:19], v1, s[44:47], s64 offen offset:0 sc1
M a[120:123], a[212:215], a[236:239], a[120:123]
ds_read_b64_tr_b16 a[188:189], v15 offset:12288
ds_read_b64_tr_b16 a[190:191], v15 offset:13824
M a[120:123], a[208:211], a[232:235], a[120:123]
v_mov_b32 v232, 0
v_mov_b32 v233, 0
M a[124:127], a[216:219], a[232:235], a[124:127]
buffer_load_dwordx4 a[20:23], v1, s[44:47], s64 offen offset:1024 sc1
M a[124:127], a[220:223], a[236:239], a[124:127]
s_waitcnt lgkmcnt(10)
v_mov_b32 v234, 0
v_mov_b32 v235, 0
M a[128:131], a[204:207], a[244:247], a[128:131]
ds_read_b128 a[232:235], v10 offset:16384
ds_read_b128 a[236:239], v11 offset:16384
M a[128:131], a[200:203], a[240:243], a[128:131]
v_mov_b32 v236, 0
v_mov_b32 v237, 0
M a[132:135], a[208:211], a[240:243], a[132:135]
ds_read_b64_tr_b16 a[196:197], v16 offset:12288
ds_read_b64_tr_b16 a[198:199], v16 offset:13824
M a[132:135], a[212:215], a[244:247], a[132:135]
buffer_load_dwordx4 a[24:27], v1, s[44:47], s64 offen offset:2048 sc1
v_mov_b32 v238, 0
v_mov_b32 v239, 0
M a[136:139], a[220:223], a[244:247], a[136:139]
M a[136:139], a[216:219], a[240:243], a[136:139]
s_waitcnt lgkmcnt(10)
M a[140:143], a[200:203], a[248:251], a[140:143]
buffer_load_dwordx4 a[28:31], v1, s[44:47], s64 offen offset:3072 sc1
s_add_u32 s64, s64, 4096
v_mov_b32 v240, 0
v_mov_b32 v241, 0
M a[140:143], a[204:207], a[252:255], a[140:143]
M a[144:147], a[212:215], a[252:255], a[144:147]
v_mov_b32 v242, 0
v_mov_b32 v243, 0
M a[144:147], a[208:211], a[248:251], a[144:147]
M a[148:151], a[216:219], a[248:251], a[148:151]
s_waitcnt vmcnt(15) lgkmcnt(0)
s_barrier
ds_read_b128 a[240:243], v10 offset:18432
ds_read_b128 a[244:247], v11 offset:18432
v_mov_b32 v244, 0
v_mov_b32 v245, 0
M a[148:151], a[220:223], a[252:255], a[148:151]
buffer_load_dwordx4 a[32:35], v1, s[44:47], s64 offen offset:0 sc1
M a[152:155], a[204:207], a[228:231], a[152:155]
ds_read_b128 a[248:251], v10 offset:20480
ds_read_b128 a[252:255], v11 offset:20480
v_mov_b32 v246, 0
v_mov_b32 v247, 0
M a[152:155], a[200:203], a[224:227], a[152:155]
M a[156:159], a[208:211], a[224:227], a[156:159]
buffer_load_dwordx4 a[36:39], v1, s[44:47], s64 offen offset:1024 sc1
M a[156:159], a[212:215], a[228:231], a[156:159]
v_mov_b32 v248, 0
v_mov_b32 v249, 0
M a[160:163], a[220:223], a[228:231], a[160:163]
M a[160:163], a[216:219], a[224:227], a[160:163]
buffer_load_dwordx4 a[40:43], v1, s[44:47], s64 offen offset:2048 sc1
v_mov_b32 v250, 0
v_mov_b32 v251, 0
M a[164:167], a[200:203], a[232:235], a[164:167]
ds_read_b128 a[224:227], v10 offset:22528
ds_read_b128 a[228:231], v11 offset:22528
M a[164:167], a[204:207], a[236:239], a[164:167]
v_mov_b32 v252, 0
v_mov_b32 v253, 0
M a[168:171], a[212:215], a[236:239], a[168:171]
M a[168:171], a[208:211], a[232:235], a[168:171]
buffer_load_dwordx4 a[44:47], v1, s[44:47], s64 offen offset:3072 sc1
s_add_u32 s64, s64, 4096
v_mov_b32 v254, 0
v_mov_b32 v255, 0
M a[172:175], a[216:219], a[232:235], a[172:175]
M a[172:175], a[220:223], a[236:239], a[172:175]
s_waitcnt lgkmcnt(4)
M a[68:71], a[176:179], a[240:243], a[68:71]
ds_read_b128 a[232:235], v10 offset:24576
ds_read_b128 a[236:239], v11 offset:24576
s_mov_b32 s22, s101
s_and_b32 s23, s22, 1
M a[68:71], a[180:183], a[244:247], a[68:71]
buffer_load_dwordx4 a[48:51], v1, s[44:47], s64 offen offset:0 sc1
s_lshr_b32 s24, s22, 1
s_lshl_b32 s33, s24, 14
M a[72:75], a[188:191], a[244:247], a[72:75]
ds_read_b64_tr_b16 a[200:201], v14 offset:28672
ds_read_b64_tr_b16 a[202:203], v14 offset:30208
M a[72:75], a[184:187], a[240:243], a[72:75]
s_lshl_b32 s34, s23, 13
s_add_u32 s29, s33, s34
M a[76:79], a[192:195], a[240:243], a[76:79]
M a[76:79], a[196:199], a[244:247], a[76:79]
s_waitcnt lgkmcnt(6)
s_lshl_b32 s28, s20, 20
s_add_u32 s28, s28, s34
M a[80:83], a[180:183], a[252:255], a[80:83]
ds_read_b128 a[240:243], v10 offset:26624
ds_read_b128 a[244:247], v11 offset:26624
M a[80:83], a[176:179], a[248:251], a[80:83]
s_mov_b32 s25, s28
s_lshl_b32 s33, s21, 16
M a[84:87], a[184:187], a[248:251], a[84:87]
ds_read_b64_tr_b16 a[208:209], v15 offset:28672
ds_read_b64_tr_b16 a[210:211], v15 offset:30208
M a[84:87], a[188:191], a[252:255], a[84:87]
buffer_load_dwordx4 a[52:55], v1, s[44:47], s64 offen offset:1024 sc1
s_add_u32 s34, s28, s33
s_add_u32 s34, s34, 65536
M a[88:91], a[196:199], a[252:255], a[88:91]
M a[88:91], a[192:195], a[248:251], a[88:91]
s_waitcnt lgkmcnt(8)
s_add_u32 s32, s28, 491520
s_sub_u32 s33, s32, s33
M a[92:95], a[176:179], a[224:227], a[92:95]
ds_read_b128 a[248:251], v10 offset:28672
ds_read_b128 a[252:255], v11 offset:28672
M a[92:95], a[180:183], a[228:231], a[92:95]
s_add_u32 s33, s33, 491520
s_cmp_eq_u32 s24, 0
s_cselect_b32 s27, s34, s32
s_cselect_b32 s28, s32, s33
M a[96:99], a[188:191], a[228:231], a[96:99]
ds_read_b64_tr_b16 a[216:217], v16 offset:28672
ds_read_b64_tr_b16 a[218:219], v16 offset:30208
M a[96:99], a[184:187], a[224:227], a[96:99]
s_mov_b32 s56, s27
s_mov_b32 s57, s28
M a[100:103], a[192:195], a[224:227], a[100:103]
buffer_load_dwordx4 a[56:59], v1, s[44:47], s64 offen offset:2048 sc1
M a[100:103], a[196:199], a[228:231], a[100:103]
s_waitcnt lgkmcnt(10)
s_min_u32 s34, s34, s32
s_cmp_eq_u32 s34, s32
s_cselect_b32 s33, s33, s34
M a[104:107], a[180:183], a[236:239], a[104:107]
ds_read_b128 a[224:227], v10 offset:30720
ds_read_b128 a[228:231], v11 offset:30720
M a[104:107], a[176:179], a[232:235], a[104:107]
s_or_b32 s34, s34, 0x40000000
s_or_b32 s32, s25, 0x40000000
M a[108:111], a[184:187], a[232:235], a[108:111]
ds_read_b64_tr_b16 a[204:205], v14 offset:40960
ds_read_b64_tr_b16 a[206:207], v14 offset:42496
s_cmp_eq_u32 s24, 1
s_cselect_b32 s25, s32, s25
s_cselect_b32 s27, s34, s27
s_cselect_b32 s28, s33, s28
s_cselect_b32 s56, s56, -1
M a[108:111], a[188:191], a[236:239], a[108:111]
M a[112:115], a[196:199], a[236:239], a[112:115]
s_add_u32 s58, s56, 16384
s_add_u32 s59, s57, 16384
M a[112:115], a[192:195], a[232:235], a[112:115]
s_waitcnt lgkmcnt(10)
M a[116:119], a[176:179], a[240:243], a[116:119]
ds_read_b128 a[232:235], v10 offset:32768
ds_read_b128 a[236:239], v11 offset:32768
s_add_u32 s26, s25, 16384
s_add_u32 s62, s27, 16384
M a[116:119], a[180:183], a[244:247], a[116:119]
buffer_load_dwordx4 a[60:63], v1, s[44:47], s64 offen offset:3072 sc1
M a[120:123], a[188:191], a[244:247], a[120:123]
ds_read_b64_tr_b16 a[212:213], v15 offset:40960
ds_read_b64_tr_b16 a[214:215], v15 offset:42496
s_add_u32 s63, s28, 16384
s_lshl_b32 s31, s21, 7
M a[120:123], a[184:187], a[240:243], a[120:123]
M a[124:127], a[192:195], a[240:243], a[124:127]
s_cmp_eq_u32 s24, 0
s_cselect_b32 s31, s31, 960
M a[124:127], a[196:199], a[244:247], a[124:127]
s_waitcnt lgkmcnt(10)
M a[128:131], a[180:183], a[252:255], a[128:131]
ds_read_b128 a[240:243], v10 offset:34816
ds_read_b128 a[244:247], v11 offset:34816
s_mov_b32 s60, 0
s_add_u32 s12, s4, 16777216
s_addc_u32 s13, s5, 0
M a[128:131], a[176:179], a[248:251], a[128:131]
M a[132:135], a[184:187], a[248:251], a[132:135]
ds_read_b64_tr_b16 a[220:221], v16 offset:40960
ds_read_b64_tr_b16 a[222:223], v16 offset:42496
s_mov_b32 s14, 33554432
s_mov_b32 s15, 0x00020000
M a[132:135], a[188:191], a[252:255], a[132:135]
buffer_load_dword v126, v119, s[36:39], 0 offen offset:128 sc1
M a[136:139], a[196:199], a[252:255], a[136:139]
s_mov_b32 s8, s4
s_mov_b32 s9, s5
M a[136:139], a[192:195], a[248:251], a[136:139]
s_waitcnt lgkmcnt(10)
M a[140:143], a[176:179], a[224:227], a[140:143]
s_mov_b32 s10, 16777216
s_mov_b32 s11, 0x00020000
M a[140:143], a[180:183], a[228:231], a[140:143]
M a[144:147], a[188:191], a[228:231], a[144:147]
M a[144:147], a[184:187], a[224:227], a[144:147]
M a[148:151], a[192:195], a[224:227], a[148:151]
s_waitcnt vmcnt(17) lgkmcnt(0)
s_barrier
ds_read_b128 a[248:251], v12 offset:0
ds_read_b128 a[252:255], v13 offset:0
s_waitcnt vmcnt(0)
v_cmp_gt_u32 vcc, 0x80, v126
s_nop 0
s_cbranch_vccnz Lk1_spin
Lk1_got:
M a[148:151], a[196:199], a[228:231], a[148:151]
s_add_u32 m0, s29, 65536
s_add_u32 s32, s25, 4096
buffer_load_dwordx4 v1, s[12:15], s25 offen offset:0 sc1 lds
M a[152:155], a[180:183], a[236:239], a[152:155]
ds_read_b128 a[224:227], v12 offset:2048
ds_read_b128 a[228:231], v13 offset:2048
M a[152:155], a[176:179], a[232:235], a[152:155]
buffer_load_dwordx4 v1, s[12:15], s25 offen offset:1024 sc1 lds
M a[156:159], a[184:187], a[232:235], a[156:159]
M a[156:159], a[188:191], a[236:239], a[156:159]
buffer_load_dwordx4 v1, s[12:15], s25 offen offset:2048 sc1 lds
M a[160:163], a[196:199], a[236:239], a[160:163]
buffer_load_dwordx4 v1, s[12:15], s25 offen offset:3072 sc1 lds
M a[160:163], a[192:195], a[232:235], a[160:163]
M a[164:167], a[176:179], a[240:243], a[164:167]
ds_read_b128 a[232:235], v12 offset:4096
ds_read_b128 a[236:239], v13 offset:4096
M a[164:167], a[180:183], a[244:247], a[164:167]
s_add_u32 m0, s29, 69632
s_nop 0
buffer_load_dwordx4 v1, s[12:15], s32 offen offset:0 sc1 lds
M a[168:171], a[188:191], a[244:247], a[168:171]
buffer_load_dwordx4 v1, s[12:15], s32 offen offset:1024 sc1 lds
M a[168:171], a[184:187], a[240:243], a[168:171]
M a[172:175], a[192:195], a[240:243], a[172:175]
buffer_load_dwordx4 v1, s[12:15], s32 offen offset:2048 sc1 lds
M a[172:175], a[196:199], a[244:247], a[172:175]
s_waitcnt lgkmcnt(4)
M a[68:71], a[200:203], a[248:251], a[68:71]
ds_read_b128 a[240:243], v12 offset:6144
ds_read_b128 a[244:247], v13 offset:6144
M a[68:71], a[204:207], a[252:255], a[68:71]
buffer_load_dwordx4 v1, s[12:15], s32 offen offset:3072 sc1 lds
M a[72:75], a[212:215], a[252:255], a[72:75]
M a[72:75], a[208:211], a[248:251], a[72:75]
M a[76:79], a[216:219], a[248:251], a[76:79]
M a[76:79], a[220:223], a[252:255], a[76:79]
s_waitcnt lgkmcnt(4)
M a[80:83], a[204:207], a[228:231], a[80:83]
ds_read_b128 a[248:251], v12 offset:8192
ds_read_b128 a[252:255], v13 offset:8192
M a[80:83], a[200:203], a[224:227], a[80:83]
M a[84:87], a[208:211], a[224:227], a[84:87]
M a[84:87], a[212:215], a[228:231], a[84:87]
M a[88:91], a[220:223], a[228:231], a[88:91]
M a[88:91], a[216:219], a[224:227], a[88:91]
s_waitcnt lgkmcnt(4)
M a[92:95], a[200:203], a[232:235], a[92:95]
ds_read_b128 a[224:227], v12 offset:10240
ds_read_b128 a[228:231], v13 offset:10240
v_accvgpr_read_b32 v24, a68
v_accvgpr_read_b32 v25, a69
v_accvgpr_read_b32 v26, a70
M a[92:95], a[204:207], a[236:239], a[92:95]
v_accvgpr_read_b32 v27, a71
v_cvt_pk_bf16_f32 v24, v24, v25
v_cvt_pk_bf16_f32 v25, v26, v27
ds_write_b64 v124, v[24:25] offset:0
M a[96:99], a[212:215], a[236:239], a[96:99]
v_accvgpr_read_b32 v28, a72
v_accvgpr_read_b32 v29, a73
v_accvgpr_read_b32 v30, a74
M a[96:99], a[208:211], a[232:235], a[96:99]
v_accvgpr_read_b32 v31, a75
v_cvt_pk_bf16_f32 v28, v28, v29
v_cvt_pk_bf16_f32 v29, v30, v31
ds_write_b64 v124, v[28:29] offset:32
M a[100:103], a[216:219], a[232:235], a[100:103]
v_accvgpr_read_b32 v24, a76
v_accvgpr_read_b32 v25, a77
v_accvgpr_read_b32 v26, a78
M a[100:103], a[220:223], a[236:239], a[100:103]
s_waitcnt lgkmcnt(6)
v_accvgpr_read_b32 v27, a79
v_cvt_pk_bf16_f32 v24, v24, v25
v_cvt_pk_bf16_f32 v25, v26, v27
ds_write_b64 v124, v[24:25] offset:64
M a[104:107], a[204:207], a[244:247], a[104:107]
ds_read_b128 a[232:235], v12 offset:12288
ds_read_b128 a[236:239], v13 offset:12288
v_accvgpr_read_b32 v24, a80
v_accvgpr_read_b32 v25, a81
v_accvgpr_read_b32 v26, a82
M a[104:107], a[200:203], a[240:243], a[104:107]
v_accvgpr_read_b32 v27, a83
v_cvt_pk_bf16_f32 v24, v24, v25
v_cvt_pk_bf16_f32 v25, v26, v27
ds_write_b64 v124, v[24:25] offset:6400
M a[108:111], a[208:211], a[240:243], a[108:111]
v_accvgpr_read_b32 v28, a84
v_accvgpr_read_b32 v29, a85
v_accvgpr_read_b32 v30, a86
M a[108:111], a[212:215], a[244:247], a[108:111]
v_accvgpr_read_b32 v31, a87
v_cvt_pk_bf16_f32 v28, v28, v29
v_cvt_pk_bf16_f32 v29, v30, v31
ds_write_b64 v124, v[28:29] offset:6432
M a[112:115], a[220:223], a[244:247], a[112:115]
v_accvgpr_read_b32 v24, a88
v_accvgpr_read_b32 v25, a89
v_accvgpr_read_b32 v26, a90
M a[112:115], a[216:219], a[240:243], a[112:115]
s_waitcnt lgkmcnt(9)
v_accvgpr_read_b32 v27, a91
v_cvt_pk_bf16_f32 v24, v24, v25
v_cvt_pk_bf16_f32 v25, v26, v27
ds_write_b64 v124, v[24:25] offset:6464
M a[116:119], a[200:203], a[248:251], a[116:119]
ds_read_b128 a[240:243], v12 offset:14336
ds_read_b128 a[244:247], v13 offset:14336
v_accvgpr_read_b32 v24, a92
v_accvgpr_read_b32 v25, a93
v_accvgpr_read_b32 v26, a94
M a[116:119], a[204:207], a[252:255], a[116:119]
v_accvgpr_read_b32 v27, a95
v_cvt_pk_bf16_f32 v24, v24, v25
v_cvt_pk_bf16_f32 v25, v26, v27
ds_write_b64 v124, v[24:25] offset:12800
M a[120:123], a[212:215], a[252:255], a[120:123]
v_accvgpr_read_b32 v28, a96
v_accvgpr_read_b32 v29, a97
v_accvgpr_read_b32 v30, a98
M a[120:123], a[208:211], a[248:251], a[120:123]
v_accvgpr_read_b32 v31, a99
v_cvt_pk_bf16_f32 v28, v28, v29
v_cvt_pk_bf16_f32 v29, v30, v31
ds_write_b64 v124, v[28:29] offset:12832
M a[124:127], a[216:219], a[248:251], a[124:127]
v_accvgpr_read_b32 v24, a100
v_accvgpr_read_b32 v25, a101
v_accvgpr_read_b32 v26, a102
M a[124:127], a[220:223], a[252:255], a[124:127]
s_add_u32 s25, s25, 32768
s_cmp_eq_u32 s25, s27
s_cselect_b32 s25, s28, s25
s_cselect_b32 s27, s56, s27
s_cselect_b32 s28, s57, s28
s_cselect_b32 s56, -1, s56
s_waitcnt lgkmcnt(12)
v_accvgpr_read_b32 v27, a103
v_cvt_pk_bf16_f32 v24, v24, v25
v_cvt_pk_bf16_f32 v25, v26, v27
ds_write_b64 v124, v[24:25] offset:12864
M a[128:131], a[204:207], a[228:231], a[128:131]
ds_read_b128 a[248:251], v12 offset:16384
ds_read_b128 a[252:255], v13 offset:16384
v_accvgpr_read_b32 v24, a104
v_accvgpr_read_b32 v25, a105
v_accvgpr_read_b32 v26, a106
M a[128:131], a[200:203], a[224:227], a[128:131]
v_accvgpr_read_b32 v27, a107
v_cvt_pk_bf16_f32 v24, v24, v25
v_cvt_pk_bf16_f32 v25, v26, v27
ds_write_b64 v124, v[24:25] offset:19200
M a[132:135], a[208:211], a[224:227], a[132:135]
v_accvgpr_read_b32 v28, a108
v_accvgpr_read_b32 v29, a109
v_accvgpr_read_b32 v30, a110
M a[132:135], a[212:215], a[228:231], a[132:135]
v_accvgpr_read_b32 v31, a111
v_cvt_pk_bf16_f32 v28, v28, v29
v_cvt_pk_bf16_f32 v29, v30, v31
ds_write_b64 v124, v[28:29] offset:19232
M a[136:139], a[220:223], a[228:231], a[136:139]
v_accvgpr_read_b32 v24, a112
v_accvgpr_read_b32 v25, a113
v_accvgpr_read_b32 v26, a114
M a[136:139], a[216:219], a[224:227], a[136:139]
s_waitcnt lgkmcnt(12)
v_accvgpr_read_b32 v27, a115
v_cvt_pk_bf16_f32 v24, v24, v25
v_cvt_pk_bf16_f32 v25, v26, v27
ds_write_b64 v124, v[24:25] offset:19264
M a[140:143], a[200:203], a[232:235], a[140:143]
v_accvgpr_read_b32 v24, a116
v_accvgpr_read_b32 v25, a117
v_accvgpr_read_b32 v26, a118
M a[140:143], a[204:207], a[236:239], a[140:143]
v_accvgpr_read_b32 v27, a119
v_cvt_pk_bf16_f32 v24, v24, v25
v_cvt_pk_bf16_f32 v25, v26, v27
ds_write_b64 v124, v[24:25] offset:25600
M a[144:147], a[212:215], a[236:239], a[144:147]
v_accvgpr_read_b32 v28, a120
v_accvgpr_read_b32 v29, a121
v_accvgpr_read_b32 v30, a122
M a[144:147], a[208:211], a[232:235], a[144:147]
v_accvgpr_read_b32 v31, a123
v_cvt_pk_bf16_f32 v28, v28, v29
v_cvt_pk_bf16_f32 v29, v30, v31
ds_write_b64 v124, v[28:29] offset:25632
M a[148:151], a[216:219], a[232:235], a[148:151]
s_waitcnt lgkmcnt(0)
s_barrier
v_accvgpr_read_b32 v24, a124
v_accvgpr_read_b32 v25, a125
v_accvgpr_read_b32 v26, a126
M a[148:151], a[220:223], a[236:239], a[148:151]
v_accvgpr_read_b32 v27, a127
v_cvt_pk_bf16_f32 v24, v24, v25
v_cvt_pk_bf16_f32 v25, v26, v27
ds_write_b64 v124, v[24:25] offset:25664
v_accvgpr_read_b32 v24, a128
v_accvgpr_read_b32 v25, a129
v_accvgpr_read_b32 v26, a130
M a[152:155], a[204:207], a[244:247], a[152:155]
v_accvgpr_read_b32 v27, a131
v_cvt_pk_bf16_f32 v24, v24, v25
v_cvt_pk_bf16_f32 v25, v26, v27
M a[152:155], a[200:203], a[240:243], a[152:155]
ds_write_b64 v124, v[24:25] offset:32000
v_accvgpr_read_b32 v28, a132
v_accvgpr_read_b32 v29, a133
M a[156:159], a[208:211], a[240:243], a[156:159]
v_accvgpr_read_b32 v30, a134
v_accvgpr_read_b32 v31, a135
v_cvt_pk_bf16_f32 v28, v28, v29
M a[156:159], a[212:215], a[244:247], a[156:159]
v_cvt_pk_bf16_f32 v29, v30, v31
ds_write_b64 v124, v[28:29] offset:32032
v_accvgpr_read_b32 v24, a136
M a[160:163], a[220:223], a[244:247], a[160:163]
v_accvgpr_read_b32 v25, a137
v_accvgpr_read_b32 v26, a138
v_accvgpr_read_b32 v27, a139
M a[160:163], a[216:219], a[240:243], a[160:163]
v_cvt_pk_bf16_f32 v24, v24, v25
v_cvt_pk_bf16_f32 v25, v26, v27
ds_write_b64 v124, v[24:25] offset:32064
M a[164:167], a[200:203], a[248:251], a[164:167]
v_accvgpr_read_b32 v24, a140
v_accvgpr_read_b32 v25, a141
v_accvgpr_read_b32 v26, a142
M a[164:167], a[204:207], a[252:255], a[164:167]
v_accvgpr_read_b32 v27, a143
v_cvt_pk_bf16_f32 v24, v24, v25
v_cvt_pk_bf16_f32 v25, v26, v27
ds_write_b64 v124, v[24:25] offset:38400
M a[168:171], a[212:215], a[252:255], a[168:171]
v_accvgpr_read_b32 v28, a144
v_accvgpr_read_b32 v29, a145
v_accvgpr_read_b32 v30, a146
M a[168:171], a[208:211], a[248:251], a[168:171]
v_accvgpr_read_b32 v31, a147
v_cvt_pk_bf16_f32 v28, v28, v29
v_cvt_pk_bf16_f32 v29, v30, v31
ds_write_b64 v124, v[28:29] offset:38432
M a[172:175], a[216:219], a[248:251], a[172:175]
v_accvgpr_read_b32 v24, a148
v_accvgpr_read_b32 v25, a149
v_accvgpr_read_b32 v26, a150
M a[172:175], a[220:223], a[252:255], a[172:175]
v_accvgpr_read_b32 v27, a151
v_cvt_pk_bf16_f32 v24, v24, v25
v_cvt_pk_bf16_f32 v25, v26, v27
ds_write_b64 v124, v[24:25] offset:38464
s_mov_b64 s[44:45], s[42:43]
v_accvgpr_read_b32 v24, a152
v_accvgpr_read_b32 v25, a153
v_accvgpr_read_b32 v26, a154
v_accvgpr_read_b32 v27, a155
v_cvt_pk_bf16_f32 v24, v24, v25
v_cvt_pk_bf16_f32 v25, v26, v27
ds_write_b64 v124, v[24:25] offset:44800
v_accvgpr_read_b32 v28, a156
v_accvgpr_read_b32 v29, a157
v_accvgpr_read_b32 v30, a158
v_accvgpr_read_b32 v31, a159
v_cvt_pk_bf16_f32 v28, v28, v29
v_cvt_pk_bf16_f32 v29, v30, v31
ds_write_b64 v124, v[28:29] offset:44832
v_accvgpr_read_b32 v24, a160
v_accvgpr_read_b32 v25, a161
v_accvgpr_read_b32 v26, a162
v_accvgpr_read_b32 v27, a163
v_cvt_pk_bf16_f32 v24, v24, v25
v_cvt_pk_bf16_f32 v25, v26, v27
ds_write_b64 v124, v[24:25] offset:44864
v_accvgpr_read_b32 v24, a164
v_accvgpr_read_b32 v25, a165
v_accvgpr_read_b32 v26, a166
v_accvgpr_read_b32 v27, a167
v_cvt_pk_bf16_f32 v24, v24, v25
v_cvt_pk_bf16_f32 v25, v26, v27
ds_write_b64 v124, v[24:25] offset:51200
v_accvgpr_read_b32 v28, a168
v_accvgpr_read_b32 v29, a169
v_accvgpr_read_b32 v30, a170
v_accvgpr_read_b32 v31, a171
v_cvt_pk_bf16_f32 v28, v28, v29
v_cvt_pk_bf16_f32 v29, v30, v31
ds_write_b64 v124, v[28:29] offset:51232
v_accvgpr_read_b32 v24, a172
v_accvgpr_read_b32 v25, a173
v_accvgpr_read_b32 v26, a174
v_accvgpr_read_b32 v27, a175
v_cvt_pk_bf16_f32 v24, v24, v25
v_cvt_pk_bf16_f32 v25, v26, v27
ds_write_b64 v124, v[24:25] offset:51264
s_waitcnt lgkmcnt(0)
s_barrier
ds_read_b128 v[48:51], v121 offset:128
ds_read_b128 v[32:35], v120 offset:0
ds_read_b128 v[52:55], v120 offset:128
ds_read_b128 v[36:39], v120 offset:12800
ds_read_b128 v[56:59], v120 offset:12928
ds_read_b128 v[40:43], v120 offset:25600
ds_read_b128 v[60:63], v120 offset:25728
ds_read_b128 v[44:47], v120 offset:38400
ds_read_b128 v[64:67], v120 offset:38528
ds_read_b64_tr_b16 v[68:69], v123 offset:256
ds_read_b64_tr_b16 v[70:71], v122 offset:256
ds_read_b64_tr_b16 v[72:73], v122 offset:13056
ds_read_b64_tr_b16 v[74:75], v122 offset:25856
ds_read_b64_tr_b16 v[76:77], v122 offset:38656
ds_read_b64_tr_b16 v[78:79], v123 offset:288
ds_read_b64_tr_b16 v[80:81], v122 offset:288
ds_read_b64_tr_b16 v[82:83], v122 offset:13088
ds_read_b64_tr_b16 v[84:85], v122 offset:25888
ds_read_b64_tr_b16 v[86:87], v122 offset:38688
v_accvgpr_write_b32 a64, 0
v_accvgpr_write_b32 a65, 0
v_accvgpr_write_b32 a66, 0
v_accvgpr_write_b32 a67, 0
v_accvgpr_write_b32 a68, 0
v_accvgpr_write_b32 a69, 0
v_accvgpr_write_b32 a70, 0
v_accvgpr_write_b32 a71, 0
v_accvgpr_write_b32 a72, 0
v_accvgpr_write_b32 a73, 0
v_accvgpr_write_b32 a74, 0
v_accvgpr_write_b32 a75, 0
s_add_u32 m0, s29, 0
s_add_u32 s32, s25, 4096
buffer_load_dwordx4 v1, s[12:15], s25 offen offset:0 sc1 lds
v_accvgpr_write_b32 a76, 0
v_accvgpr_write_b32 a77, 0
v_accvgpr_write_b32 a78, 0
v_accvgpr_write_b32 a79, 0
v_accvgpr_write_b32 a80, 0
v_accvgpr_write_b32 a81, 0
v_accvgpr_write_b32 a82, 0
v_accvgpr_write_b32 a83, 0
v_accvgpr_write_b32 a84, 0
v_accvgpr_write_b32 a85, 0
v_accvgpr_write_b32 a86, 0
buffer_load_dwordx4 v1, s[12:15], s25 offen offset:1024 sc1 lds
v_accvgpr_write_b32 a87, 0
v_accvgpr_write_b32 a88, 0
v_accvgpr_write_b32 a89, 0
v_accvgpr_write_b32 a90, 0
v_accvgpr_write_b32 a91, 0
v_accvgpr_write_b32 a92, 0
v_accvgpr_write_b32 a93, 0
v_accvgpr_write_b32 a94, 0
v_accvgpr_write_b32 a95, 0
v_accvgpr_write_b32 a96, 0
buffer_load_dwordx4 v1, s[12:15], s25 offen offset:2048 sc1 lds
v_accvgpr_write_b32 a97, 0
v_accvgpr_write_b32 a98, 0
v_accvgpr_write_b32 a99, 0
v_accvgpr_write_b32 a100, 0
v_accvgpr_write_b32 a101, 0
v_accvgpr_write_b32 a102, 0
v_accvgpr_write_b32 a103, 0
v_accvgpr_write_b32 a104, 0
v_accvgpr_write_b32 a105, 0
v_accvgpr_write_b32 a106, 0
v_accvgpr_write_b32 a107, 0
buffer_load_dwordx4 v1, s[12:15], s25 offen offset:3072 sc1 lds
v_accvgpr_write_b32 a108, 0
v_accvgpr_write_b32 a109, 0
v_accvgpr_write_b32 a110, 0
v_accvgpr_write_b32 a111, 0
s_waitcnt lgkmcnt(15)
M v[88:91], v[48:51], v[32:35], v[152:155]
M v[92:95], v[52:55], v[32:35], v[148:151]
M v[96:99], v[52:55], v[36:39], v[144:147]
s_waitcnt lgkmcnt(14)
M v[100:103], v[56:59], v[36:39], v[148:151]
s_waitcnt lgkmcnt(13)
M v[104:107], v[56:59], v[40:43], v[144:147]
s_waitcnt lgkmcnt(12)
M v[108:111], v[60:63], v[40:43], v[148:151]
s_add_u32 m0, s29, 4096
s_nop 0
buffer_load_dwordx4 v1, s[12:15], s32 offen offset:0 sc1 lds
s_waitcnt lgkmcnt(11)
M v[112:115], v[60:63], v[44:47], v[144:147]
s_waitcnt lgkmcnt(10)
M v[116:119], v[64:67], v[44:47], v[148:151]
v_max3_f32 v136, v88, v89, v90
v_max3_f32 v136, v136, v91, v92
v_max3_f32 v136, v136, v93, v94
v_max_f32 v136, v136, v95
v_max3_f32 v137, v96, v97, v98
v_max3_f32 v137, v137, v99, v100
v_max3_f32 v137, v137, v101, v102
v_max_f32 v137, v137, v103
v_max3_f32 v138, v104, v105, v106
buffer_load_dwordx4 v1, s[12:15], s32 offen offset:1024 sc1 lds
v_max3_f32 v138, v138, v107, v108
v_max3_f32 v138, v138, v109, v110
v_max_f32 v138, v138, v111
v_max3_f32 v139, v112, v113, v114
v_max3_f32 v139, v139, v115, v116
v_max3_f32 v139, v139, v117, v118
v_max_f32 v139, v139, v119
v_mov_b32 v140, v136
v_mov_b32 v141, v137
v_mov_b32 v142, v138
buffer_load_dwordx4 v1, s[12:15], s32 offen offset:2048 sc1 lds
v_mov_b32 v143, v139
v_permlane16_swap_b32 v136, v140
v_permlane16_swap_b32 v137, v141
v_permlane16_swap_b32 v138, v142
v_permlane16_swap_b32 v139, v143
v_max_f32 v136, v136, v140
v_max_f32 v137, v137, v141
v_max_f32 v138, v138, v142
v_max_f32 v139, v139, v143
v_mov_b32 v140, v136
v_mov_b32 v141, v137
buffer_load_dwordx4 v1, s[12:15], s32 offen offset:3072 sc1 lds
v_mov_b32 v142, v138
v_mov_b32 v143, v139
v_permlane32_swap_b32 v136, v140
v_permlane32_swap_b32 v137, v141
v_permlane32_swap_b32 v138, v142
v_permlane32_swap_b32 v139, v143
v_max_f32 v136, v136, v140
v_max_f32 v137, v137, v141
v_max_f32 v138, v138, v142
v_max_f32 v139, v139, v143
s_add_u32 s25, s25, 32768
s_cmp_eq_u32 s25, s27
s_cselect_b32 s25, s28, s25
s_cselect_b32 s27, s56, s27
s_cselect_b32 s28, s57, s28
s_cselect_b32 s56, -1, s56
v_mul_f32 v136, s7, v136
v_mul_f32 v137, s7, v137
v_mul_f32 v138, s7, v138
v_mul_f32 v139, s7, v139
v_fma_f32 v88, v88, s7, -v136
v_fma_f32 v89, v89, s7, -v136
v_fma_f32 v90, v90, s7, -v136
v_fma_f32 v91, v91, s7, -v136
v_fma_f32 v92, v92, s7, -v136
v_fma_f32 v93, v93, s7, -v136
v_fma_f32 v94, v94, s7, -v136
s_add_u32 m0, s29, 32768
s_add_u32 s32, s26, 4096
buffer_load_dwordx4 v1, s[12:15], s26 offen offset:0 sc1 lds
v_fma_f32 v95, v95, s7, -v136
v_exp_f32 v88, v88
v_exp_f32 v89, v89
v_exp_f32 v90, v90
v_exp_f32 v91, v91
v_exp_f32 v92, v92
v_exp_f32 v93, v93
v_exp_f32 v94, v94
v_exp_f32 v95, v95
v_fma_f32 v96, v96, s7, -v137
v_fma_f32 v97, v97, s7, -v137
buffer_load_dwordx4 v1, s[12:15], s26 offen offset:1024 sc1 lds
v_fma_f32 v98, v98, s7, -v137
v_fma_f32 v99, v99, s7, -v137
v_fma_f32 v100, v100, s7, -v137
v_fma_f32 v101, v101, s7, -v137
v_fma_f32 v102, v102, s7, -v137
v_fma_f32 v103, v103, s7, -v137
v_exp_f32 v96, v96
v_exp_f32 v97, v97
v_exp_f32 v98, v98
v_exp_f32 v99, v99
buffer_load_dwordx4 v1, s[12:15], s26 offen offset:2048 sc1 lds
v_exp_f32 v100, v100
v_exp_f32 v101, v101
v_exp_f32 v102, v102
v_exp_f32 v103, v103
v_fma_f32 v104, v104, s7, -v138
v_fma_f32 v105, v105, s7, -v138
v_fma_f32 v106, v106, s7, -v138
v_fma_f32 v107, v107, s7, -v138
v_fma_f32 v108, v108, s7, -v138
v_fma_f32 v109, v109, s7, -v138
v_fma_f32 v110, v110, s7, -v138
buffer_load_dwordx4 v1, s[12:15], s26 offen offset:3072 sc1 lds
v_fma_f32 v111, v111, s7, -v138
v_exp_f32 v104, v104
v_exp_f32 v105, v105
v_exp_f32 v106, v106
v_exp_f32 v107, v107
v_exp_f32 v108, v108
v_exp_f32 v109, v109
v_exp_f32 v110, v110
v_exp_f32 v111, v111
v_fma_f32 v112, v112, s7, -v139
s_add_u32 m0, s29, 36864
s_nop 0
buffer_load_dwordx4 v1, s[12:15], s32 offen offset:0 sc1 lds
v_fma_f32 v113, v113, s7, -v139
v_fma_f32 v114, v114, s7, -v139
v_fma_f32 v115, v115, s7, -v139
v_fma_f32 v116, v116, s7, -v139
v_fma_f32 v117, v117, s7, -v139
v_fma_f32 v118, v118, s7, -v139
v_fma_f32 v119, v119, s7, -v139
v_exp_f32 v112, v112
v_exp_f32 v113, v113
v_exp_f32 v114, v114
v_exp_f32 v115, v115
buffer_load_dwordx4 v1, s[12:15], s32 offen offset:1024 sc1 lds
v_exp_f32 v116, v116
v_exp_f32 v117, v117
v_exp_f32 v118, v118
v_exp_f32 v119, v119
v_cvt_pk_bf16_f32 v88, v88, v89
v_cvt_pk_bf16_f32 v89, v90, v91
v_cvt_pk_bf16_f32 v90, v92, v93
v_cvt_pk_bf16_f32 v91, v94, v95
v_cvt_pk_bf16_f32 v96, v96, v97
v_cvt_pk_bf16_f32 v97, v98, v99
buffer_load_dwordx4 v1, s[12:15], s32 offen offset:2048 sc1 lds
v_cvt_pk_bf16_f32 v98, v100, v101
v_cvt_pk_bf16_f32 v99, v102, v103
v_cvt_pk_bf16_f32 v104, v104, v105
v_cvt_pk_bf16_f32 v105, v106, v107
v_cvt_pk_bf16_f32 v106, v108, v109
v_cvt_pk_bf16_f32 v107, v110, v111
v_cvt_pk_bf16_f32 v112, v112, v113
v_cvt_pk_bf16_f32 v113, v114, v115
v_cvt_pk_bf16_f32 v114, v116, v117
v_cvt_pk_bf16_f32 v115, v118, v119
M v[120:123], v[156:159], v[88:91], 0
buffer_load_dwordx4 v1, s[12:15], s32 offen offset:3072 sc1 lds
s_waitcnt lgkmcnt(8)
M v[32:35], v[68:71], v[88:91], 0
s_waitcnt lgkmcnt(3)
M v[36:39], v[78:81], v[88:91], 0
M v[124:127], v[156:159], v[96:99], 0
M v[40:43], v[70:73], v[96:99], 0
s_waitcnt lgkmcnt(2)
M v[44:47], v[80:83], v[96:99], 0
M v[128:131], v[156:159], v[104:107], 0
M v[48:51], v[72:75], v[104:107], 0
s_waitcnt lgkmcnt(1)
M v[52:55], v[82:85], v[104:107], 0
M v[132:135], v[156:159], v[112:115], 0
M v[56:59], v[74:77], v[112:115], 0
s_add_u32 s26, s26, 32768
s_cmp_eq_u32 s26, s62
s_cselect_b32 s26, s63, s26
s_cselect_b32 s62, s58, s62
s_cselect_b32 s63, s59, s63
s_cselect_b32 s58, -1, s58
s_waitcnt lgkmcnt(0)
M v[60:63], v[84:87], v[112:115], 0
v_rcp_f32 v120, v120
v_rcp_f32 v124, v124
v_rcp_f32 v128, v128
v_rcp_f32 v132, v132
v_pk_mul_f32 v[32:33], v[32:33], v[120:121] op_sel_hi:[1,0]
v_pk_mul_f32 v[34:35], v[34:35], v[120:121] op_sel_hi:[1,0]
v_pk_mul_f32 v[36:37], v[36:37], v[120:121] op_sel_hi:[1,0]
v_pk_mul_f32 v[38:39], v[38:39], v[120:121] op_sel_hi:[1,0]
v_cvt_pk_bf16_f32 v32, v32, v33
v_cvt_pk_bf16_f32 v33, v34, v35
v_cvt_pk_bf16_f32 v34, v36, v37
v_cvt_pk_bf16_f32 v35, v38, v39
s_add_u32 s3, s6, 0
buffer_store_dwordx4 v[32:35], v1, s[16:19], s3 offen sc1
v_pk_mul_f32 v[40:41], v[40:41], v[124:125] op_sel_hi:[1,0]
v_pk_mul_f32 v[42:43], v[42:43], v[124:125] op_sel_hi:[1,0]
v_pk_mul_f32 v[44:45], v[44:45], v[124:125] op_sel_hi:[1,0]
v_pk_mul_f32 v[46:47], v[46:47], v[124:125] op_sel_hi:[1,0]
v_cvt_pk_bf16_f32 v40, v40, v41
v_cvt_pk_bf16_f32 v41, v42, v43
v_cvt_pk_bf16_f32 v42, v44, v45
v_cvt_pk_bf16_f32 v43, v46, v47
s_add_u32 s3, s6, 2048
buffer_store_dwordx4 v[40:43], v1, s[16:19], s3 offen sc1
v_pk_mul_f32 v[48:49], v[48:49], v[128:129] op_sel_hi:[1,0]
v_pk_mul_f32 v[50:51], v[50:51], v[128:129] op_sel_hi:[1,0]
v_pk_mul_f32 v[52:53], v[52:53], v[128:129] op_sel_hi:[1,0]
v_pk_mul_f32 v[54:55], v[54:55], v[128:129] op_sel_hi:[1,0]
v_cvt_pk_bf16_f32 v48, v48, v49
v_cvt_pk_bf16_f32 v49, v50, v51
v_cvt_pk_bf16_f32 v50, v52, v53
v_cvt_pk_bf16_f32 v51, v54, v55
s_add_u32 s3, s6, 4096
buffer_store_dwordx4 v[48:51], v1, s[16:19], s3 offen sc1
v_pk_mul_f32 v[56:57], v[56:57], v[132:133] op_sel_hi:[1,0]
v_pk_mul_f32 v[58:59], v[58:59], v[132:133] op_sel_hi:[1,0]
v_pk_mul_f32 v[60:61], v[60:61], v[132:133] op_sel_hi:[1,0]
v_pk_mul_f32 v[62:63], v[62:63], v[132:133] op_sel_hi:[1,0]
v_cvt_pk_bf16_f32 v56, v56, v57
v_cvt_pk_bf16_f32 v57, v58, v59
v_cvt_pk_bf16_f32 v58, v60, v61
v_cvt_pk_bf16_f32 v59, v62, v63
s_add_u32 s3, s6, 6144
buffer_store_dwordx4 v[56:59], v1, s[16:19], s3 offen sc1
Lc2:
s_add_u32 s16, s4, 67108864
s_addc_u32 s17, s5, 0
s_mov_b32 s18, 16777216
s_mov_b32 s19, 0x00020000
s_add_u32 s52, s4, 100663296
s_addc_u32 s53, s5, 0
s_mov_b32 s54, 16793600
s_mov_b32 s55, 0x00020000
s_mov_b32 s46, 8388608
s_mov_b32 s47, 0x00020000
s_mov_b32 s50, 2097152
s_mov_b32 s51, 0x00020000
s_lshl_b32 s33, s24, 14
v_add_u32 v2, 0, v1
v_add_u32 v3, 0x10000, v2
v_mov_b32 v5, v2
v_mov_b32 v6, v3
v_and_b32 v8, 15, v0
v_bfe_u32 v9, v0, 4, 2
v_lshlrev_b32 v9, 2, v9
v_sub_u32 v8, v8, v9
v_mov_b32 v4, 0xf149f2ca
v_cmp_gt_i32 vcc, 0, v8
s_nop 1
v_cndmask_b32 v16, 0, v4, vcc
v_cmp_gt_i32 vcc, 1, v8
s_nop 1
v_cndmask_b32 v17, 0, v4, vcc
v_cmp_gt_i32 vcc, 2, v8
s_nop 1
v_cndmask_b32 v18, 0, v4, vcc
v_cmp_gt_i32 vcc, 3, v8
s_nop 1
v_cndmask_b32 v19, 0, v4, vcc
v_mov_b32 v8, 0x3f803f80
v_accvgpr_write_b32 a112, v8
v_accvgpr_write_b32 a113, v8
v_accvgpr_write_b32 a114, v8
v_accvgpr_write_b32 a115, v8
s_lshl_b32 s33, s23, 6
s_add_i32 s33, s33, s31
s_cmp_gt_i32 s33, 0
s_cselect_b32 s34, 0, 0xf149f2ca
s_cmp_lt_i32 s33, 0
s_cselect_b32 s33, 0xf149f2ca, 0
v_mov_b32 v20, s34
v_mov_b32 v21, s34
v_mov_b32 v22, s34
v_mov_b32 v23, s34
v_mov_b32 v28, s33
v_mov_b32 v29, s33
v_mov_b32 v30, s33
v_mov_b32 v31, s33
v_med3_f32 v24, v16, v20, v28
v_med3_f32 v25, v17, v20, v28
v_med3_f32 v26, v18, v20, v28
v_med3_f32 v27, v19, v20, v28
v_mov_b32 v12, 0
v_mov_b32 v13, 1
s_waitcnt vmcnt(20)
s_barrier
ds_read_b128 a[116:119], v3 offset:0
ds_read_b128 a[120:123], v3 offset:1024
ds_read_b128 a[124:127], v3 offset:2048
ds_read_b128 a[128:131], v3 offset:3072
ds_read_b128 a[132:135], v3 offset:4096
ds_read_b128 a[136:139], v3 offset:5120
ds_read_b128 a[140:143], v3 offset:6144
ds_read_b128 a[144:147], v3 offset:7168
s_waitcnt lgkmcnt(4)
M v[32:35], a[116:119], a[0:3], v[24:27]
M v[32:35], a[120:123], a[4:7], v[32:35]
ds_read_b128 a[148:151], v3 offset:8192
ds_read_b128 a[152:155], v3 offset:9216
M v[32:35], a[124:127], a[8:11], v[32:35]
M v[32:35], a[128:131], a[12:15], v[32:35]
M v[36:39], a[128:131], a[28:31], v[28:31]
M v[36:39], a[124:127], a[24:27], v[36:39]
M v[36:39], a[120:123], a[20:23], v[36:39]
M v[36:39], a[116:119], a[16:19], v[36:39]
M v[40:43], a[116:119], a[32:35], v[28:31]
M v[40:43], a[120:123], a[36:39], v[40:43]
ds_read_b128 a[156:159], v3 offset:10240
ds_read_b128 a[160:163], v3 offset:11264
M v[40:43], a[124:127], a[40:43], v[40:43]
M v[40:43], a[128:131], a[44:47], v[40:43]
M v[44:47], a[128:131], a[60:63], v[28:31]
M v[44:47], a[124:127], a[56:59], v[44:47]
M v[44:47], a[120:123], a[52:55], v[44:47]
M v[44:47], a[116:119], a[48:51], v[44:47]
s_waitcnt lgkmcnt(4)
M v[48:51], a[132:135], a[0:3], v[20:23]
M v[48:51], a[136:139], a[4:7], v[48:51]
ds_read_b128 a[164:167], v3 offset:12288
ds_read_b128 a[168:171], v3 offset:13312
M v[48:51], a[140:143], a[8:11], v[48:51]
M v[48:51], a[144:147], a[12:15], v[48:51]
M v[52:55], a[144:147], a[28:31], v[24:27]
M v[52:55], a[140:143], a[24:27], v[52:55]
M v[52:55], a[136:139], a[20:23], v[52:55]
M v[52:55], a[132:135], a[16:19], v[52:55]
M v[56:59], a[132:135], a[32:35], v[28:31]
M v[56:59], a[136:139], a[36:39], v[56:59]
ds_read_b128 a[172:175], v3 offset:14336
ds_read_b128 a[176:179], v3 offset:15360
M v[56:59], a[140:143], a[40:43], v[56:59]
M v[56:59], a[144:147], a[44:47], v[56:59]
M v[60:63], a[144:147], a[60:63], v[28:31]
M v[60:63], a[140:143], a[56:59], v[60:63]
M v[60:63], a[136:139], a[52:55], v[60:63]
M v[60:63], a[132:135], a[48:51], v[60:63]
s_waitcnt lgkmcnt(4)
M v[64:67], a[148:151], a[0:3], v[20:23]
M v[64:67], a[152:155], a[4:7], v[64:67]
M v[64:67], a[156:159], a[8:11], v[64:67]
M v[64:67], a[160:163], a[12:15], v[64:67]
M v[68:71], a[160:163], a[28:31], v[20:23]
M v[68:71], a[156:159], a[24:27], v[68:71]
M v[68:71], a[152:155], a[20:23], v[68:71]
M v[68:71], a[148:151], a[16:19], v[68:71]
M v[72:75], a[148:151], a[32:35], v[24:27]
M v[72:75], a[152:155], a[36:39], v[72:75]
M v[72:75], a[156:159], a[40:43], v[72:75]
M v[72:75], a[160:163], a[44:47], v[72:75]
M v[76:79], a[160:163], a[60:63], v[28:31]
M v[76:79], a[156:159], a[56:59], v[76:79]
s_waitcnt vmcnt(4) lgkmcnt(0)
s_barrier
ds_read_b128 a[116:119], v2 offset:0
ds_read_b128 a[120:123], v2 offset:1024
M v[76:79], a[152:155], a[52:55], v[76:79]
M v[76:79], a[148:151], a[48:51], v[76:79]
M v[80:83], a[164:167], a[0:3], v[20:23]
M v[80:83], a[168:171], a[4:7], v[80:83]
ds_read_b128 a[124:127], v2 offset:2048
ds_read_b128 a[128:131], v2 offset:3072
M v[80:83], a[172:175], a[8:11], v[80:83]
M v[80:83], a[176:179], a[12:15], v[80:83]
M v[84:87], a[176:179], a[28:31], v[20:23]
M v[84:87], a[172:175], a[24:27], v[84:87]
ds_read_b128 a[132:135], v2 offset:4096
ds_read_b128 a[136:139], v2 offset:5120
M v[84:87], a[168:171], a[20:23], v[84:87]
M v[84:87], a[164:167], a[16:19], v[84:87]
M v[88:91], a[164:167], a[32:35], v[20:23]
M v[88:91], a[168:171], a[36:39], v[88:91]
ds_read_b128 a[140:143], v2 offset:6144
ds_read_b128 a[144:147], v2 offset:7168
M v[88:91], a[172:175], a[40:43], v[88:91]
M v[88:91], a[176:179], a[44:47], v[88:91]
M v[92:95], a[176:179], a[60:63], v[24:27]
M v[92:95], a[172:175], a[56:59], v[92:95]
M v[92:95], a[168:171], a[52:55], v[92:95]
M v[92:95], a[164:167], a[48:51], v[92:95]
s_waitcnt vmcnt(0)
s_mov_b64 exec, 1
buffer_store_dword v13, v12, s[52:55], s65 offen sc1
s_mov_b64 exec, -1
v_exp_f32 v32, v32
v_exp_f32 v33, v33
v_exp_f32 v34, v34
v_exp_f32 v35, v35
v_exp_f32 v48, v48
v_exp_f32 v49, v49
v_exp_f32 v50, v50
v_exp_f32 v51, v51
v_cvt_pk_bf16_f32 v32, v32, v33
v_cvt_pk_bf16_f32 v33, v34, v35
v_exp_f32 v36, v36
v_exp_f32 v37, v37
v_exp_f32 v38, v38
v_exp_f32 v39, v39
v_cvt_pk_bf16_f32 v34, v48, v49
v_cvt_pk_bf16_f32 v35, v50, v51
v_exp_f32 v52, v52
v_exp_f32 v53, v53
v_exp_f32 v54, v54
v_exp_f32 v55, v55
v_cvt_pk_bf16_f32 v36, v36, v37
v_cvt_pk_bf16_f32 v37, v38, v39
v_exp_f32 v40, v40
v_exp_f32 v41, v41
v_exp_f32 v42, v42
v_exp_f32 v43, v43
v_cvt_pk_bf16_f32 v38, v52, v53
v_cvt_pk_bf16_f32 v39, v54, v55
v_exp_f32 v56, v56
v_exp_f32 v57, v57
v_exp_f32 v58, v58
v_exp_f32 v59, v59
v_cvt_pk_bf16_f32 v40, v40, v41
v_cvt_pk_bf16_f32 v41, v42, v43
v_exp_f32 v44, v44
v_exp_f32 v45, v45
v_exp_f32 v46, v46
v_exp_f32 v47, v47
v_cvt_pk_bf16_f32 v42, v56, v57
v_cvt_pk_bf16_f32 v43, v58, v59
v_exp_f32 v60, v60
v_exp_f32 v61, v61
v_exp_f32 v62, v62
v_exp_f32 v63, v63
v_cvt_pk_bf16_f32 v44, v44, v45
v_cvt_pk_bf16_f32 v45, v46, v47
v_cvt_pk_bf16_f32 v46, v60, v61
v_cvt_pk_bf16_f32 v47, v62, v63
s_cmp_eq_u32 s24, 1
s_cbranch_scc1 Lk2_g1
s_mov_b32 s30, s21
s_cmp_eq_u32 s21, 0
s_cbranch_scc1 Lk2_m2
Lk2_l1:
s_add_u32 m0, s29, 65536
s_waitcnt lgkmcnt(4)
M v[96:99], a[116:119], a[0:3], 0
v_exp_f32 v64, v64
M v[96:99], a[120:123], a[4:7], v[96:99]
ds_read_b128 a[148:151], v2 offset:8192
ds_read_b128 a[152:155], v2 offset:9216
M v[96:99], a[124:127], a[8:11], v[96:99]
v_exp_f32 v65, v65
M v[96:99], a[128:131], a[12:15], v[96:99]
buffer_load_dwordx4 v1, s[12:15], s25 offen offset:0 sc1 lds
s_add_u32 s32, s25, 4096
M v[100:103], a[128:131], a[28:31], 0
v_exp_f32 v66, v66
M v[100:103], a[124:127], a[24:27], v[100:103]
v_cvt_pk_bf16_f32 v64, v64, v65
M v[100:103], a[120:123], a[20:23], v[100:103]
v_exp_f32 v67, v67
M v[100:103], a[116:119], a[16:19], v[100:103]
buffer_load_dwordx4 v1, s[12:15], s25 offen offset:1024 sc1 lds
M v[104:107], a[116:119], a[32:35], 0
v_exp_f32 v80, v80
M v[104:107], a[120:123], a[36:39], v[104:107]
ds_read_b128 a[156:159], v2 offset:10240
ds_read_b128 a[160:163], v2 offset:11264
M v[104:107], a[124:127], a[40:43], v[104:107]
v_exp_f32 v81, v81
M v[104:107], a[128:131], a[44:47], v[104:107]
buffer_load_dwordx4 v1, s[12:15], s25 offen offset:2048 sc1 lds
M v[108:111], a[128:131], a[60:63], 0
v_exp_f32 v82, v82
M v[108:111], a[124:127], a[56:59], v[108:111]
v_cvt_pk_bf16_f32 v65, v66, v67
v_cvt_pk_bf16_f32 v66, v80, v81
M v[108:111], a[120:123], a[52:55], v[108:111]
v_exp_f32 v83, v83
M v[108:111], a[116:119], a[48:51], v[108:111]
buffer_load_dwordx4 v1, s[12:15], s25 offen offset:3072 sc1 lds
s_add_u32 m0, s29, 69632
s_waitcnt lgkmcnt(4)
M v[112:115], a[132:135], a[0:3], 0
v_exp_f32 v68, v68
M v[112:115], a[136:139], a[4:7], v[112:115]
ds_read_b128 a[164:167], v2 offset:12288
ds_read_b128 a[168:171], v2 offset:13312
M v[112:115], a[140:143], a[8:11], v[112:115]
v_exp_f32 v69, v69
M v[112:115], a[144:147], a[12:15], v[112:115]
buffer_load_dwordx4 v1, s[12:15], s32 offen offset:0 sc1 lds
M v[116:119], a[144:147], a[28:31], 0
v_exp_f32 v70, v70
M v[116:119], a[140:143], a[24:27], v[116:119]
v_cvt_pk_bf16_f32 v67, v82, v83
v_cvt_pk_bf16_f32 v68, v68, v69
M v[116:119], a[136:139], a[20:23], v[116:119]
v_exp_f32 v71, v71
M v[116:119], a[132:135], a[16:19], v[116:119]
buffer_load_dwordx4 v1, s[12:15], s32 offen offset:1024 sc1 lds
M v[120:123], a[132:135], a[32:35], 0
v_exp_f32 v84, v84
M v[120:123], a[136:139], a[36:39], v[120:123]
ds_read_b128 a[172:175], v2 offset:14336
ds_read_b128 a[176:179], v2 offset:15360
M v[120:123], a[140:143], a[40:43], v[120:123]
v_exp_f32 v85, v85
M v[120:123], a[144:147], a[44:47], v[120:123]
buffer_load_dwordx4 v1, s[12:15], s32 offen offset:2048 sc1 lds
M v[124:127], a[144:147], a[60:63], 0
v_exp_f32 v86, v86
M v[124:127], a[140:143], a[56:59], v[124:127]
v_cvt_pk_bf16_f32 v69, v70, v71
v_cvt_pk_bf16_f32 v70, v84, v85
M v[124:127], a[136:139], a[52:55], v[124:127]
v_exp_f32 v87, v87
M v[124:127], a[132:135], a[48:51], v[124:127]
buffer_load_dwordx4 v1, s[12:15], s32 offen offset:3072 sc1 lds
s_add_u32 m0, s29, 98304
s_waitcnt lgkmcnt(4)
M v[128:131], a[148:151], a[0:3], 0
v_exp_f32 v72, v72
M v[128:131], a[152:155], a[4:7], v[128:131]
ds_read_b128 a[116:119], v5 offset:32768
ds_read_b128 a[120:123], v5 offset:40960
M v[128:131], a[156:159], a[8:11], v[128:131]
v_exp_f32 v73, v73
M v[128:131], a[160:163], a[12:15], v[128:131]
buffer_load_dwordx4 v1, s[12:15], s26 offen offset:0 sc1 lds
s_add_u32 s43, s26, 4096
M v[132:135], a[160:163], a[28:31], 0
v_exp_f32 v74, v74
M v[132:135], a[156:159], a[24:27], v[132:135]
v_cvt_pk_bf16_f32 v71, v86, v87
v_cvt_pk_bf16_f32 v72, v72, v73
M v[132:135], a[152:155], a[20:23], v[132:135]
v_exp_f32 v75, v75
M v[132:135], a[148:151], a[16:19], v[132:135]
buffer_load_dwordx4 v1, s[12:15], s26 offen offset:1024 sc1 lds
M v[136:139], a[148:151], a[32:35], 0
v_exp_f32 v88, v88
M v[136:139], a[152:155], a[36:39], v[136:139]
ds_read_b128 a[124:127], v5 offset:33792
ds_read_b128 a[128:131], v5 offset:41984
M v[136:139], a[156:159], a[40:43], v[136:139]
v_exp_f32 v89, v89
M v[136:139], a[160:163], a[44:47], v[136:139]
buffer_load_dwordx4 v1, s[12:15], s26 offen offset:2048 sc1 lds
M v[140:143], a[160:163], a[60:63], 0
v_exp_f32 v90, v90
M v[140:143], a[156:159], a[56:59], v[140:143]
v_cvt_pk_bf16_f32 v73, v74, v75
v_cvt_pk_bf16_f32 v74, v88, v89
M v[140:143], a[152:155], a[52:55], v[140:143]
v_exp_f32 v91, v91
M v[140:143], a[148:151], a[48:51], v[140:143]
buffer_load_dwordx4 v1, s[12:15], s26 offen offset:3072 sc1 lds
s_add_u32 m0, s29, 102400
s_waitcnt lgkmcnt(4)
M v[144:147], a[164:167], a[0:3], 0
v_exp_f32 v76, v76
M v[144:147], a[168:171], a[4:7], v[144:147]
ds_read_b128 a[132:135], v5 offset:34816
ds_read_b128 a[136:139], v5 offset:43008
M v[144:147], a[172:175], a[8:11], v[144:147]
v_exp_f32 v77, v77
M v[144:147], a[176:179], a[12:15], v[144:147]
buffer_load_dwordx4 v1, s[12:15], s43 offen offset:0 sc1 lds
M v[148:151], a[176:179], a[28:31], 0
v_exp_f32 v78, v78
M v[148:151], a[172:175], a[24:27], v[148:151]
v_cvt_pk_bf16_f32 v75, v90, v91
v_cvt_pk_bf16_f32 v76, v76, v77
M v[148:151], a[168:171], a[20:23], v[148:151]
v_exp_f32 v79, v79
M v[148:151], a[164:167], a[16:19], v[148:151]
buffer_load_dwordx4 v1, s[12:15], s43 offen offset:1024 sc1 lds
M v[152:155], a[164:167], a[32:35], 0
v_exp_f32 v92, v92
M v[152:155], a[168:171], a[36:39], v[152:155]
ds_read_b128 a[140:143], v5 offset:35840
ds_read_b128 a[144:147], v5 offset:44032
M v[152:155], a[172:175], a[40:43], v[152:155]
v_exp_f32 v93, v93
M v[152:155], a[176:179], a[44:47], v[152:155]
buffer_load_dwordx4 v1, s[12:15], s43 offen offset:2048 sc1 lds
M v[156:159], a[176:179], a[60:63], 0
v_exp_f32 v94, v94
M v[156:159], a[172:175], a[56:59], v[156:159]
v_cvt_pk_bf16_f32 v77, v78, v79
v_cvt_pk_bf16_f32 v78, v92, v93
M v[156:159], a[168:171], a[52:55], v[156:159]
v_exp_f32 v95, v95
M v[156:159], a[164:167], a[48:51], v[156:159]
buffer_load_dwordx4 v1, s[12:15], s43 offen offset:3072 sc1 lds
v_cvt_pk_bf16_f32 v79, v94, v95
s_waitcnt lgkmcnt(6)
M v[160:163], a[116:119], v[32:35], v[160:163]
v_exp_f32 v96, v96
M v[160:163], a[120:123], v[64:67], v[160:163]
ds_read_b128 a[148:151], v5 offset:36864
ds_read_b128 a[152:155], v5 offset:45056
M v[164:167], a[120:123], v[68:71], v[164:167]
v_exp_f32 v97, v97
M v[164:167], a[116:119], v[36:39], v[164:167]
v_cvt_pk_bf16_f32 v96, v96, v97
M v[168:171], a[116:119], v[40:43], v[168:171]
v_exp_f32 v98, v98
M v[168:171], a[120:123], v[72:75], v[168:171]
s_add_u32 s25, s25, 32768
s_cmp_eq_u32 s25, s27
M v[172:175], a[120:123], v[76:79], v[172:175]
v_exp_f32 v99, v99
M v[172:175], a[116:119], v[44:47], v[172:175]
v_cvt_pk_bf16_f32 v97, v98, v99
s_waitcnt lgkmcnt(6)
M a[96:99], a[112:115], v[32:35], a[96:99]
s_cselect_b32 s25, s28, s25
s_cselect_b32 s27, -1, s27
M a[96:99], a[112:115], v[64:67], a[96:99]
s_add_u32 s26, s26, 32768
s_cmp_eq_u32 s26, s62
M v[176:179], a[124:127], v[32:35], v[176:179]
v_exp_f32 v112, v112
M v[176:179], a[128:131], v[64:67], v[176:179]
ds_read_b128 a[156:159], v5 offset:37888
ds_read_b128 a[160:163], v5 offset:46080
M v[180:183], a[128:131], v[68:71], v[180:183]
v_exp_f32 v113, v113
M v[180:183], a[124:127], v[36:39], v[180:183]
v_cvt_pk_bf16_f32 v98, v112, v113
M v[184:187], a[124:127], v[40:43], v[184:187]
v_exp_f32 v114, v114
M v[184:187], a[128:131], v[72:75], v[184:187]
s_cselect_b32 s26, s63, s26
s_cselect_b32 s62, -1, s62
M v[188:191], a[128:131], v[76:79], v[188:191]
v_exp_f32 v115, v115
M v[188:191], a[124:127], v[44:47], v[188:191]
v_cvt_pk_bf16_f32 v99, v114, v115
s_waitcnt lgkmcnt(6)
M a[100:103], a[112:115], v[36:39], a[100:103]
M a[100:103], a[112:115], v[68:71], a[100:103]
M v[192:195], a[132:135], v[32:35], v[192:195]
v_exp_f32 v100, v100
M v[192:195], a[136:139], v[64:67], v[192:195]
ds_read_b128 a[164:167], v5 offset:38912
ds_read_b128 a[168:171], v5 offset:47104
M v[196:199], a[136:139], v[68:71], v[196:199]
v_exp_f32 v101, v101
M v[196:199], a[132:135], v[36:39], v[196:199]
v_cvt_pk_bf16_f32 v100, v100, v101
M v[200:203], a[132:135], v[40:43], v[200:203]
v_exp_f32 v102, v102
M v[200:203], a[136:139], v[72:75], v[200:203]
M v[204:207], a[136:139], v[76:79], v[204:207]
v_exp_f32 v103, v103
M v[204:207], a[132:135], v[44:47], v[204:207]
v_cvt_pk_bf16_f32 v101, v102, v103
s_waitcnt lgkmcnt(6)
M a[104:107], a[112:115], v[40:43], a[104:107]
M a[104:107], a[112:115], v[72:75], a[104:107]
M v[208:211], a[140:143], v[32:35], v[208:211]
v_exp_f32 v116, v116
M v[208:211], a[144:147], v[64:67], v[208:211]
ds_read_b128 a[172:175], v5 offset:39936
ds_read_b128 a[176:179], v5 offset:48128
M v[212:215], a[144:147], v[68:71], v[212:215]
v_exp_f32 v117, v117
M v[212:215], a[140:143], v[36:39], v[212:215]
v_cvt_pk_bf16_f32 v102, v116, v117
M v[216:219], a[140:143], v[40:43], v[216:219]
v_exp_f32 v118, v118
M v[216:219], a[144:147], v[72:75], v[216:219]
M v[220:223], a[144:147], v[76:79], v[220:223]
v_exp_f32 v119, v119
M v[220:223], a[140:143], v[44:47], v[220:223]
v_cvt_pk_bf16_f32 v103, v118, v119
s_waitcnt lgkmcnt(6)
M a[108:111], a[112:115], v[44:47], a[108:111]
M a[108:111], a[112:115], v[76:79], a[108:111]
M v[224:227], a[148:151], v[32:35], v[224:227]
v_exp_f32 v104, v104
M v[224:227], a[152:155], v[64:67], v[224:227]
M v[228:231], a[152:155], v[68:71], v[228:231]
v_exp_f32 v105, v105
M v[228:231], a[148:151], v[36:39], v[228:231]
v_cvt_pk_bf16_f32 v104, v104, v105
M v[232:235], a[148:151], v[40:43], v[232:235]
v_exp_f32 v106, v106
M v[232:235], a[152:155], v[72:75], v[232:235]
M v[236:239], a[152:155], v[76:79], v[236:239]
v_exp_f32 v107, v107
M v[236:239], a[148:151], v[44:47], v[236:239]
v_cvt_pk_bf16_f32 v105, v106, v107
s_waitcnt lgkmcnt(4)
M v[240:243], a[156:159], v[32:35], v[240:243]
v_exp_f32 v120, v120
M v[240:243], a[160:163], v[64:67], v[240:243]
M v[244:247], a[160:163], v[68:71], v[244:247]
v_exp_f32 v121, v121
M v[244:247], a[156:159], v[36:39], v[244:247]
v_cvt_pk_bf16_f32 v106, v120, v121
M v[248:251], a[156:159], v[40:43], v[248:251]
v_exp_f32 v122, v122
M v[248:251], a[160:163], v[72:75], v[248:251]
s_waitcnt vmcnt(0) lgkmcnt(0)
s_barrier
ds_read_b128 a[116:119], v3 offset:0
ds_read_b128 a[120:123], v3 offset:1024
M v[252:255], a[160:163], v[76:79], v[252:255]
v_exp_f32 v123, v123
M v[252:255], a[156:159], v[44:47], v[252:255]
v_cvt_pk_bf16_f32 v107, v122, v123
M a[64:67], a[164:167], v[32:35], a[64:67]
v_exp_f32 v108, v108
M a[64:67], a[168:171], v[64:67], a[64:67]
ds_read_b128 a[124:127], v3 offset:2048
ds_read_b128 a[128:131], v3 offset:3072
M a[68:71], a[168:171], v[68:71], a[68:71]
v_exp_f32 v109, v109
M a[68:71], a[164:167], v[36:39], a[68:71]
v_cvt_pk_bf16_f32 v108, v108, v109
M a[72:75], a[164:167], v[40:43], a[72:75]
v_exp_f32 v110, v110
M a[72:75], a[168:171], v[72:75], a[72:75]
ds_read_b128 a[132:135], v3 offset:4096
ds_read_b128 a[136:139], v3 offset:5120
M a[76:79], a[168:171], v[76:79], a[76:79]
v_exp_f32 v111, v111
M a[76:79], a[164:167], v[44:47], a[76:79]
v_cvt_pk_bf16_f32 v109, v110, v111
M a[80:83], a[172:175], v[32:35], a[80:83]
v_exp_f32 v124, v124
M a[80:83], a[176:179], v[64:67], a[80:83]
ds_read_b128 a[140:143], v3 offset:6144
ds_read_b128 a[144:147], v3 offset:7168
M a[84:87], a[176:179], v[68:71], a[84:87]
v_exp_f32 v125, v125
M a[84:87], a[172:175], v[36:39], a[84:87]
v_cvt_pk_bf16_f32 v110, v124, v125
M a[88:91], a[172:175], v[40:43], a[88:91]
v_exp_f32 v126, v126
M a[88:91], a[176:179], v[72:75], a[88:91]
M a[92:95], a[176:179], v[76:79], a[92:95]
v_exp_f32 v127, v127
M a[92:95], a[172:175], v[44:47], a[92:95]
v_cvt_pk_bf16_f32 v111, v126, v127
s_sub_u32 s30, s30, 1
s_cmp_eq_u32 s30, 0
s_cbranch_scc1 Lk2_m1
s_add_u32 m0, s29, 0
s_waitcnt lgkmcnt(4)
M v[32:35], a[116:119], a[0:3], 0
v_exp_f32 v128, v128
M v[32:35], a[120:123], a[4:7], v[32:35]
ds_read_b128 a[148:151], v3 offset:8192
ds_read_b128 a[152:155], v3 offset:9216
M v[32:35], a[124:127], a[8:11], v[32:35]
v_exp_f32 v129, v129
M v[32:35], a[128:131], a[12:15], v[32:35]
buffer_load_dwordx4 v1, s[12:15], s25 offen offset:0 sc1 lds
s_add_u32 s32, s25, 4096
M v[36:39], a[128:131], a[28:31], 0
v_exp_f32 v130, v130
M v[36:39], a[124:127], a[24:27], v[36:39]
v_cvt_pk_bf16_f32 v128, v128, v129
M v[36:39], a[120:123], a[20:23], v[36:39]
v_exp_f32 v131, v131
M v[36:39], a[116:119], a[16:19], v[36:39]
buffer_load_dwordx4 v1, s[12:15], s25 offen offset:1024 sc1 lds
M v[40:43], a[116:119], a[32:35], 0
v_exp_f32 v144, v144
M v[40:43], a[120:123], a[36:39], v[40:43]
ds_read_b128 a[156:159], v3 offset:10240
ds_read_b128 a[160:163], v3 offset:11264
M v[40:43], a[124:127], a[40:43], v[40:43]
v_exp_f32 v145, v145
M v[40:43], a[128:131], a[44:47], v[40:43]
buffer_load_dwordx4 v1, s[12:15], s25 offen offset:2048 sc1 lds
M v[44:47], a[128:131], a[60:63], 0
v_exp_f32 v146, v146
M v[44:47], a[124:127], a[56:59], v[44:47]
v_cvt_pk_bf16_f32 v129, v130, v131
v_cvt_pk_bf16_f32 v130, v144, v145
M v[44:47], a[120:123], a[52:55], v[44:47]
v_exp_f32 v147, v147
M v[44:47], a[116:119], a[48:51], v[44:47]
buffer_load_dwordx4 v1, s[12:15], s25 offen offset:3072 sc1 lds
s_add_u32 m0, s29, 4096
s_waitcnt lgkmcnt(4)
M v[48:51], a[132:135], a[0:3], 0
v_exp_f32 v132, v132
M v[48:51], a[136:139], a[4:7], v[48:51]
ds_read_b128 a[164:167], v3 offset:12288
ds_read_b128 a[168:171], v3 offset:13312
M v[48:51], a[140:143], a[8:11], v[48:51]
v_exp_f32 v133, v133
M v[48:51], a[144:147], a[12:15], v[48:51]
buffer_load_dwordx4 v1, s[12:15], s32 offen offset:0 sc1 lds
M v[52:55], a[144:147], a[28:31], 0
v_exp_f32 v134, v134
M v[52:55], a[140:143], a[24:27], v[52:55]
v_cvt_pk_bf16_f32 v131, v146, v147
v_cvt_pk_bf16_f32 v132, v132, v133
M v[52:55], a[136:139], a[20:23], v[52:55]
v_exp_f32 v135, v135
M v[52:55], a[132:135], a[16:19], v[52:55]
buffer_load_dwordx4 v1, s[12:15], s32 offen offset:1024 sc1 lds
M v[56:59], a[132:135], a[32:35], 0
v_exp_f32 v148, v148
M v[56:59], a[136:139], a[36:39], v[56:59]
ds_read_b128 a[172:175], v3 offset:14336
ds_read_b128 a[176:179], v3 offset:15360
M v[56:59], a[140:143], a[40:43], v[56:59]
v_exp_f32 v149, v149
M v[56:59], a[144:147], a[44:47], v[56:59]
buffer_load_dwordx4 v1, s[12:15], s32 offen offset:2048 sc1 lds
M v[60:63], a[144:147], a[60:63], 0
v_exp_f32 v150, v150
M v[60:63], a[140:143], a[56:59], v[60:63]
v_cvt_pk_bf16_f32 v133, v134, v135
v_cvt_pk_bf16_f32 v134, v148, v149
M v[60:63], a[136:139], a[52:55], v[60:63]
v_exp_f32 v151, v151
M v[60:63], a[132:135], a[48:51], v[60:63]
buffer_load_dwordx4 v1, s[12:15], s32 offen offset:3072 sc1 lds
s_add_u32 m0, s29, 32768
s_waitcnt lgkmcnt(4)
M v[64:67], a[148:151], a[0:3], 0
v_exp_f32 v136, v136
M v[64:67], a[152:155], a[4:7], v[64:67]
ds_read_b128 a[116:119], v6 offset:32768
ds_read_b128 a[120:123], v6 offset:40960
M v[64:67], a[156:159], a[8:11], v[64:67]
v_exp_f32 v137, v137
M v[64:67], a[160:163], a[12:15], v[64:67]
buffer_load_dwordx4 v1, s[12:15], s26 offen offset:0 sc1 lds
s_add_u32 s43, s26, 4096
M v[68:71], a[160:163], a[28:31], 0
v_exp_f32 v138, v138
M v[68:71], a[156:159], a[24:27], v[68:71]
v_cvt_pk_bf16_f32 v135, v150, v151
v_cvt_pk_bf16_f32 v136, v136, v137
M v[68:71], a[152:155], a[20:23], v[68:71]
v_exp_f32 v139, v139
M v[68:71], a[148:151], a[16:19], v[68:71]
buffer_load_dwordx4 v1, s[12:15], s26 offen offset:1024 sc1 lds
M v[72:75], a[148:151], a[32:35], 0
v_exp_f32 v152, v152
M v[72:75], a[152:155], a[36:39], v[72:75]
ds_read_b128 a[124:127], v6 offset:33792
ds_read_b128 a[128:131], v6 offset:41984
M v[72:75], a[156:159], a[40:43], v[72:75]
v_exp_f32 v153, v153
M v[72:75], a[160:163], a[44:47], v[72:75]
buffer_load_dwordx4 v1, s[12:15], s26 offen offset:2048 sc1 lds
M v[76:79], a[160:163], a[60:63], 0
v_exp_f32 v154, v154
M v[76:79], a[156:159], a[56:59], v[76:79]
v_cvt_pk_bf16_f32 v137, v138, v139
v_cvt_pk_bf16_f32 v138, v152, v153
M v[76:79], a[152:155], a[52:55], v[76:79]
v_exp_f32 v155, v155
M v[76:79], a[148:151], a[48:51], v[76:79]
buffer_load_dwordx4 v1, s[12:15], s26 offen offset:3072 sc1 lds
s_add_u32 m0, s29, 36864
s_waitcnt lgkmcnt(4)
M v[80:83], a[164:167], a[0:3], 0
v_exp_f32 v140, v140
M v[80:83], a[168:171], a[4:7], v[80:83]
ds_read_b128 a[132:135], v6 offset:34816
ds_read_b128 a[136:139], v6 offset:43008
M v[80:83], a[172:175], a[8:11], v[80:83]
v_exp_f32 v141, v141
M v[80:83], a[176:179], a[12:15], v[80:83]
buffer_load_dwordx4 v1, s[12:15], s43 offen offset:0 sc1 lds
M v[84:87], a[176:179], a[28:31], 0
v_exp_f32 v142, v142
M v[84:87], a[172:175], a[24:27], v[84:87]
v_cvt_pk_bf16_f32 v139, v154, v155
v_cvt_pk_bf16_f32 v140, v140, v141
M v[84:87], a[168:171], a[20:23], v[84:87]
v_exp_f32 v143, v143
M v[84:87], a[164:167], a[16:19], v[84:87]
buffer_load_dwordx4 v1, s[12:15], s43 offen offset:1024 sc1 lds
M v[88:91], a[164:167], a[32:35], 0
v_exp_f32 v156, v156
M v[88:91], a[168:171], a[36:39], v[88:91]
ds_read_b128 a[140:143], v6 offset:35840
ds_read_b128 a[144:147], v6 offset:44032
M v[88:91], a[172:175], a[40:43], v[88:91]
v_exp_f32 v157, v157
M v[88:91], a[176:179], a[44:47], v[88:91]
buffer_load_dwordx4 v1, s[12:15], s43 offen offset:2048 sc1 lds
M v[92:95], a[176:179], a[60:63], 0
v_exp_f32 v158, v158
M v[92:95], a[172:175], a[56:59], v[92:95]
v_cvt_pk_bf16_f32 v141, v142, v143
v_cvt_pk_bf16_f32 v142, v156, v157
M v[92:95], a[168:171], a[52:55], v[92:95]
v_exp_f32 v159, v159
M v[92:95], a[164:167], a[48:51], v[92:95]
buffer_load_dwordx4 v1, s[12:15], s43 offen offset:3072 sc1 lds
v_cvt_pk_bf16_f32 v143, v158, v159
s_waitcnt lgkmcnt(6)
M v[160:163], a[116:119], v[96:99], v[160:163]
v_exp_f32 v32, v32
M v[160:163], a[120:123], v[128:131], v[160:163]
ds_read_b128 a[148:151], v6 offset:36864
ds_read_b128 a[152:155], v6 offset:45056
M v[164:167], a[120:123], v[132:135], v[164:167]
v_exp_f32 v33, v33
M v[164:167], a[116:119], v[100:103], v[164:167]
v_cvt_pk_bf16_f32 v32, v32, v33
M v[168:171], a[116:119], v[104:107], v[168:171]
v_exp_f32 v34, v34
M v[168:171], a[120:123], v[136:139], v[168:171]
s_add_u32 s25, s25, 32768
s_cmp_eq_u32 s25, s27
M v[172:175], a[120:123], v[140:143], v[172:175]
v_exp_f32 v35, v35
M v[172:175], a[116:119], v[108:111], v[172:175]
v_cvt_pk_bf16_f32 v33, v34, v35
s_waitcnt lgkmcnt(6)
M a[96:99], a[112:115], v[96:99], a[96:99]
s_cselect_b32 s25, s28, s25
s_cselect_b32 s27, -1, s27
M a[96:99], a[112:115], v[128:131], a[96:99]
s_add_u32 s26, s26, 32768
s_cmp_eq_u32 s26, s62
M v[176:179], a[124:127], v[96:99], v[176:179]
v_exp_f32 v48, v48
M v[176:179], a[128:131], v[128:131], v[176:179]
ds_read_b128 a[156:159], v6 offset:37888
ds_read_b128 a[160:163], v6 offset:46080
M v[180:183], a[128:131], v[132:135], v[180:183]
v_exp_f32 v49, v49
M v[180:183], a[124:127], v[100:103], v[180:183]
v_cvt_pk_bf16_f32 v34, v48, v49
M v[184:187], a[124:127], v[104:107], v[184:187]
v_exp_f32 v50, v50
M v[184:187], a[128:131], v[136:139], v[184:187]
s_cselect_b32 s26, s63, s26
s_cselect_b32 s62, -1, s62
M v[188:191], a[128:131], v[140:143], v[188:191]
v_exp_f32 v51, v51
M v[188:191], a[124:127], v[108:111], v[188:191]
v_cvt_pk_bf16_f32 v35, v50, v51
s_waitcnt lgkmcnt(6)
M a[100:103], a[112:115], v[100:103], a[100:103]
M a[100:103], a[112:115], v[132:135], a[100:103]
M v[192:195], a[132:135], v[96:99], v[192:195]
v_exp_f32 v36, v36
M v[192:195], a[136:139], v[128:131], v[192:195]
ds_read_b128 a[164:167], v6 offset:38912
ds_read_b128 a[168:171], v6 offset:47104
M v[196:199], a[136:139], v[132:135], v[196:199]
v_exp_f32 v37, v37
M v[196:199], a[132:135], v[100:103], v[196:199]
v_cvt_pk_bf16_f32 v36, v36, v37
M v[200:203], a[132:135], v[104:107], v[200:203]
v_exp_f32 v38, v38
M v[200:203], a[136:139], v[136:139], v[200:203]
M v[204:207], a[136:139], v[140:143], v[204:207]
v_exp_f32 v39, v39
M v[204:207], a[132:135], v[108:111], v[204:207]
v_cvt_pk_bf16_f32 v37, v38, v39
s_waitcnt lgkmcnt(6)
M a[104:107], a[112:115], v[104:107], a[104:107]
M a[104:107], a[112:115], v[136:139], a[104:107]
M v[208:211], a[140:143], v[96:99], v[208:211]
v_exp_f32 v52, v52
M v[208:211], a[144:147], v[128:131], v[208:211]
ds_read_b128 a[172:175], v6 offset:39936
ds_read_b128 a[176:179], v6 offset:48128
M v[212:215], a[144:147], v[132:135], v[212:215]
v_exp_f32 v53, v53
M v[212:215], a[140:143], v[100:103], v[212:215]
v_cvt_pk_bf16_f32 v38, v52, v53
M v[216:219], a[140:143], v[104:107], v[216:219]
v_exp_f32 v54, v54
M v[216:219], a[144:147], v[136:139], v[216:219]
M v[220:223], a[144:147], v[140:143], v[220:223]
v_exp_f32 v55, v55
M v[220:223], a[140:143], v[108:111], v[220:223]
v_cvt_pk_bf16_f32 v39, v54, v55
s_waitcnt lgkmcnt(6)
M a[108:111], a[112:115], v[108:111], a[108:111]
M a[108:111], a[112:115], v[140:143], a[108:111]
M v[224:227], a[148:151], v[96:99], v[224:227]
v_exp_f32 v40, v40
M v[224:227], a[152:155], v[128:131], v[224:227]
M v[228:231], a[152:155], v[132:135], v[228:231]
v_exp_f32 v41, v41
M v[228:231], a[148:151], v[100:103], v[228:231]
v_cvt_pk_bf16_f32 v40, v40, v41
M v[232:235], a[148:151], v[104:107], v[232:235]
v_exp_f32 v42, v42
M v[232:235], a[152:155], v[136:139], v[232:235]
M v[236:239], a[152:155], v[140:143], v[236:239]
v_exp_f32 v43, v43
M v[236:239], a[148:151], v[108:111], v[236:239]
v_cvt_pk_bf16_f32 v41, v42, v43
s_waitcnt lgkmcnt(4)
M v[240:243], a[156:159], v[96:99], v[240:243]
v_exp_f32 v56, v56
M v[240:243], a[160:163], v[128:131], v[240:243]
M v[244:247], a[160:163], v[132:135], v[244:247]
v_exp_f32 v57, v57
M v[244:247], a[156:159], v[100:103], v[244:247]
v_cvt_pk_bf16_f32 v42, v56, v57
M v[248:251], a[156:159], v[104:107], v[248:251]
v_exp_f32 v58, v58
M v[248:251], a[160:163], v[136:139], v[248:251]
s_waitcnt vmcnt(0) lgkmcnt(0)
s_barrier
ds_read_b128 a[116:119], v2 offset:0
ds_read_b128 a[120:123], v2 offset:1024
M v[252:255], a[160:163], v[140:143], v[252:255]
v_exp_f32 v59, v59
M v[252:255], a[156:159], v[108:111], v[252:255]
v_cvt_pk_bf16_f32 v43, v58, v59
M a[64:67], a[164:167], v[96:99], a[64:67]
v_exp_f32 v44, v44
M a[64:67], a[168:171], v[128:131], a[64:67]
ds_read_b128 a[124:127], v2 offset:2048
ds_read_b128 a[128:131], v2 offset:3072
M a[68:71], a[168:171], v[132:135], a[68:71]
v_exp_f32 v45, v45
M a[68:71], a[164:167], v[100:103], a[68:71]
v_cvt_pk_bf16_f32 v44, v44, v45
M a[72:75], a[164:167], v[104:107], a[72:75]
v_exp_f32 v46, v46
M a[72:75], a[168:171], v[136:139], a[72:75]
ds_read_b128 a[132:135], v2 offset:4096
ds_read_b128 a[136:139], v2 offset:5120
M a[76:79], a[168:171], v[140:143], a[76:79]
v_exp_f32 v47, v47
M a[76:79], a[164:167], v[108:111], a[76:79]
v_cvt_pk_bf16_f32 v45, v46, v47
M a[80:83], a[172:175], v[96:99], a[80:83]
v_exp_f32 v60, v60
M a[80:83], a[176:179], v[128:131], a[80:83]
ds_read_b128 a[140:143], v2 offset:6144
ds_read_b128 a[144:147], v2 offset:7168
M a[84:87], a[176:179], v[132:135], a[84:87]
v_exp_f32 v61, v61
M a[84:87], a[172:175], v[100:103], a[84:87]
v_cvt_pk_bf16_f32 v46, v60, v61
M a[88:91], a[172:175], v[104:107], a[88:91]
v_exp_f32 v62, v62
M a[88:91], a[176:179], v[136:139], a[88:91]
M a[92:95], a[176:179], v[140:143], a[92:95]
v_exp_f32 v63, v63
M a[92:95], a[172:175], v[108:111], a[92:95]
v_cvt_pk_bf16_f32 v47, v62, v63
s_branch Lk2_l1
Lk2_m1:
s_cmp_eq_u32 s23, 1
s_cbranch_scc1 Lk2_m1b
s_add_u32 m0, s29, 0
s_waitcnt lgkmcnt(4)
M v[32:35], a[116:119], a[0:3], v[16:19]
v_exp_f32 v128, v128
M v[32:35], a[120:123], a[4:7], v[32:35]
ds_read_b128 a[148:151], v3 offset:8192
ds_read_b128 a[152:155], v3 offset:9216
M v[32:35], a[124:127], a[8:11], v[32:35]
v_exp_f32 v129, v129
M v[32:35], a[128:131], a[12:15], v[32:35]
buffer_load_dwordx4 v1, s[12:15], s25 offen offset:0 sc1 lds
s_add_u32 s32, s25, 4096
M v[36:39], a[128:131], a[28:31], 0
v_exp_f32 v130, v130
M v[36:39], a[124:127], a[24:27], v[36:39]
v_cvt_pk_bf16_f32 v128, v128, v129
M v[36:39], a[120:123], a[20:23], v[36:39]
v_exp_f32 v131, v131
M v[36:39], a[116:119], a[16:19], v[36:39]
buffer_load_dwordx4 v1, s[12:15], s25 offen offset:1024 sc1 lds
M v[40:43], a[116:119], a[32:35], 0
v_exp_f32 v144, v144
M v[40:43], a[120:123], a[36:39], v[40:43]
ds_read_b128 a[156:159], v3 offset:10240
ds_read_b128 a[160:163], v3 offset:11264
M v[40:43], a[124:127], a[40:43], v[40:43]
v_exp_f32 v145, v145
M v[40:43], a[128:131], a[44:47], v[40:43]
buffer_load_dwordx4 v1, s[12:15], s25 offen offset:2048 sc1 lds
M v[44:47], a[128:131], a[60:63], 0
v_exp_f32 v146, v146
M v[44:47], a[124:127], a[56:59], v[44:47]
v_cvt_pk_bf16_f32 v129, v130, v131
v_cvt_pk_bf16_f32 v130, v144, v145
M v[44:47], a[120:123], a[52:55], v[44:47]
v_exp_f32 v147, v147
M v[44:47], a[116:119], a[48:51], v[44:47]
buffer_load_dwordx4 v1, s[12:15], s25 offen offset:3072 sc1 lds
s_add_u32 m0, s29, 4096
s_waitcnt lgkmcnt(4)
v_exp_f32 v132, v132
ds_read_b128 a[164:167], v3 offset:12288
ds_read_b128 a[168:171], v3 offset:13312
v_exp_f32 v133, v133
buffer_load_dwordx4 v1, s[12:15], s32 offen offset:0 sc1 lds
M v[52:55], a[144:147], a[28:31], v[16:19]
v_exp_f32 v134, v134
M v[52:55], a[140:143], a[24:27], v[52:55]
v_cvt_pk_bf16_f32 v131, v146, v147
v_cvt_pk_bf16_f32 v132, v132, v133
M v[52:55], a[136:139], a[20:23], v[52:55]
v_exp_f32 v135, v135
M v[52:55], a[132:135], a[16:19], v[52:55]
buffer_load_dwordx4 v1, s[12:15], s32 offen offset:1024 sc1 lds
M v[56:59], a[132:135], a[32:35], 0
v_exp_f32 v148, v148
M v[56:59], a[136:139], a[36:39], v[56:59]
ds_read_b128 a[172:175], v3 offset:14336
ds_read_b128 a[176:179], v3 offset:15360
M v[56:59], a[140:143], a[40:43], v[56:59]
v_exp_f32 v149, v149
M v[56:59], a[144:147], a[44:47], v[56:59]
buffer_load_dwordx4 v1, s[12:15], s32 offen offset:2048 sc1 lds
M v[60:63], a[144:147], a[60:63], 0
v_exp_f32 v150, v150
M v[60:63], a[140:143], a[56:59], v[60:63]
v_cvt_pk_bf16_f32 v133, v134, v135
v_cvt_pk_bf16_f32 v134, v148, v149
M v[60:63], a[136:139], a[52:55], v[60:63]
v_exp_f32 v151, v151
M v[60:63], a[132:135], a[48:51], v[60:63]
buffer_load_dwordx4 v1, s[12:15], s32 offen offset:3072 sc1 lds
s_add_u32 m0, s29, 32768
s_waitcnt lgkmcnt(4)
v_exp_f32 v136, v136
ds_read_b128 a[116:119], v6 offset:32768
ds_read_b128 a[120:123], v6 offset:40960
v_exp_f32 v137, v137
buffer_load_dwordx4 v1, s[12:15], s26 offen offset:0 sc1 lds
s_add_u32 s43, s26, 4096
v_exp_f32 v138, v138
v_cvt_pk_bf16_f32 v135, v150, v151
v_cvt_pk_bf16_f32 v136, v136, v137
v_exp_f32 v139, v139
buffer_load_dwordx4 v1, s[12:15], s26 offen offset:1024 sc1 lds
M v[72:75], a[148:151], a[32:35], v[16:19]
v_exp_f32 v152, v152
M v[72:75], a[152:155], a[36:39], v[72:75]
ds_read_b128 a[124:127], v6 offset:33792
ds_read_b128 a[128:131], v6 offset:41984
M v[72:75], a[156:159], a[40:43], v[72:75]
v_exp_f32 v153, v153
M v[72:75], a[160:163], a[44:47], v[72:75]
buffer_load_dwordx4 v1, s[12:15], s26 offen offset:2048 sc1 lds
M v[76:79], a[160:163], a[60:63], 0
v_exp_f32 v154, v154
M v[76:79], a[156:159], a[56:59], v[76:79]
v_cvt_pk_bf16_f32 v137, v138, v139
v_cvt_pk_bf16_f32 v138, v152, v153
M v[76:79], a[152:155], a[52:55], v[76:79]
v_exp_f32 v155, v155
M v[76:79], a[148:151], a[48:51], v[76:79]
buffer_load_dwordx4 v1, s[12:15], s26 offen offset:3072 sc1 lds
s_add_u32 m0, s29, 36864
s_waitcnt lgkmcnt(4)
v_exp_f32 v140, v140
ds_read_b128 a[132:135], v6 offset:34816
ds_read_b128 a[136:139], v6 offset:43008
v_exp_f32 v141, v141
buffer_load_dwordx4 v1, s[12:15], s43 offen offset:0 sc1 lds
v_exp_f32 v142, v142
v_cvt_pk_bf16_f32 v139, v154, v155
v_cvt_pk_bf16_f32 v140, v140, v141
v_exp_f32 v143, v143
buffer_load_dwordx4 v1, s[12:15], s43 offen offset:1024 sc1 lds
v_exp_f32 v156, v156
ds_read_b128 a[140:143], v6 offset:35840
ds_read_b128 a[144:147], v6 offset:44032
v_exp_f32 v157, v157
buffer_load_dwordx4 v1, s[12:15], s43 offen offset:2048 sc1 lds
M v[92:95], a[176:179], a[60:63], v[16:19]
v_exp_f32 v158, v158
M v[92:95], a[172:175], a[56:59], v[92:95]
v_cvt_pk_bf16_f32 v141, v142, v143
v_cvt_pk_bf16_f32 v142, v156, v157
M v[92:95], a[168:171], a[52:55], v[92:95]
v_exp_f32 v159, v159
M v[92:95], a[164:167], a[48:51], v[92:95]
buffer_load_dwordx4 v1, s[12:15], s43 offen offset:3072 sc1 lds
v_cvt_pk_bf16_f32 v143, v158, v159
s_waitcnt lgkmcnt(6)
M v[160:163], a[116:119], v[96:99], v[160:163]
v_exp_f32 v32, v32
M v[160:163], a[120:123], v[128:131], v[160:163]
ds_read_b128 a[148:151], v6 offset:36864
ds_read_b128 a[152:155], v6 offset:45056
M v[164:167], a[120:123], v[132:135], v[164:167]
v_exp_f32 v33, v33
M v[164:167], a[116:119], v[100:103], v[164:167]
v_cvt_pk_bf16_f32 v32, v32, v33
M v[168:171], a[116:119], v[104:107], v[168:171]
v_exp_f32 v34, v34
M v[168:171], a[120:123], v[136:139], v[168:171]
s_add_u32 s25, s25, 32768
s_cmp_eq_u32 s25, s27
M v[172:175], a[120:123], v[140:143], v[172:175]
v_exp_f32 v35, v35
M v[172:175], a[116:119], v[108:111], v[172:175]
v_cvt_pk_bf16_f32 v33, v34, v35
s_waitcnt lgkmcnt(6)
M a[96:99], a[112:115], v[96:99], a[96:99]
s_cselect_b32 s25, s28, s25
s_cselect_b32 s27, -1, s27
M a[96:99], a[112:115], v[128:131], a[96:99]
s_add_u32 s26, s26, 32768
s_cmp_eq_u32 s26, s62
M v[176:179], a[124:127], v[96:99], v[176:179]
M v[176:179], a[128:131], v[128:131], v[176:179]
ds_read_b128 a[156:159], v6 offset:37888
ds_read_b128 a[160:163], v6 offset:46080
M v[180:183], a[128:131], v[132:135], v[180:183]
M v[180:183], a[124:127], v[100:103], v[180:183]
v_mov_b32 v34, 0
M v[184:187], a[124:127], v[104:107], v[184:187]
M v[184:187], a[128:131], v[136:139], v[184:187]
s_cselect_b32 s26, s63, s26
s_cselect_b32 s62, -1, s62
M v[188:191], a[128:131], v[140:143], v[188:191]
M v[188:191], a[124:127], v[108:111], v[188:191]
v_mov_b32 v35, 0
s_waitcnt lgkmcnt(6)
M a[100:103], a[112:115], v[100:103], a[100:103]
M a[100:103], a[112:115], v[132:135], a[100:103]
M v[192:195], a[132:135], v[96:99], v[192:195]
v_exp_f32 v36, v36
M v[192:195], a[136:139], v[128:131], v[192:195]
ds_read_b128 a[164:167], v6 offset:38912
ds_read_b128 a[168:171], v6 offset:47104
M v[196:199], a[136:139], v[132:135], v[196:199]
v_exp_f32 v37, v37
M v[196:199], a[132:135], v[100:103], v[196:199]
v_cvt_pk_bf16_f32 v36, v36, v37
M v[200:203], a[132:135], v[104:107], v[200:203]
v_exp_f32 v38, v38
M v[200:203], a[136:139], v[136:139], v[200:203]
M v[204:207], a[136:139], v[140:143], v[204:207]
v_exp_f32 v39, v39
M v[204:207], a[132:135], v[108:111], v[204:207]
v_cvt_pk_bf16_f32 v37, v38, v39
s_waitcnt lgkmcnt(6)
M a[104:107], a[112:115], v[104:107], a[104:107]
M a[104:107], a[112:115], v[136:139], a[104:107]
M v[208:211], a[140:143], v[96:99], v[208:211]
v_exp_f32 v52, v52
M v[208:211], a[144:147], v[128:131], v[208:211]
ds_read_b128 a[172:175], v6 offset:39936
ds_read_b128 a[176:179], v6 offset:48128
M v[212:215], a[144:147], v[132:135], v[212:215]
v_exp_f32 v53, v53
M v[212:215], a[140:143], v[100:103], v[212:215]
v_cvt_pk_bf16_f32 v38, v52, v53
M v[216:219], a[140:143], v[104:107], v[216:219]
v_exp_f32 v54, v54
M v[216:219], a[144:147], v[136:139], v[216:219]
M v[220:223], a[144:147], v[140:143], v[220:223]
v_exp_f32 v55, v55
M v[220:223], a[140:143], v[108:111], v[220:223]
v_cvt_pk_bf16_f32 v39, v54, v55
s_waitcnt lgkmcnt(6)
M a[108:111], a[112:115], v[108:111], a[108:111]
M a[108:111], a[112:115], v[140:143], a[108:111]
M v[224:227], a[148:151], v[96:99], v[224:227]
v_exp_f32 v40, v40
M v[224:227], a[152:155], v[128:131], v[224:227]
M v[228:231], a[152:155], v[132:135], v[228:231]
v_exp_f32 v41, v41
M v[228:231], a[148:151], v[100:103], v[228:231]
v_cvt_pk_bf16_f32 v40, v40, v41
M v[232:235], a[148:151], v[104:107], v[232:235]
v_exp_f32 v42, v42
M v[232:235], a[152:155], v[136:139], v[232:235]
M v[236:239], a[152:155], v[140:143], v[236:239]
v_exp_f32 v43, v43
M v[236:239], a[148:151], v[108:111], v[236:239]
v_cvt_pk_bf16_f32 v41, v42, v43
s_waitcnt lgkmcnt(4)
M v[240:243], a[156:159], v[96:99], v[240:243]
v_exp_f32 v56, v56
M v[240:243], a[160:163], v[128:131], v[240:243]
M v[244:247], a[160:163], v[132:135], v[244:247]
v_exp_f32 v57, v57
M v[244:247], a[156:159], v[100:103], v[244:247]
v_cvt_pk_bf16_f32 v42, v56, v57
M v[248:251], a[156:159], v[104:107], v[248:251]
v_exp_f32 v58, v58
M v[248:251], a[160:163], v[136:139], v[248:251]
s_waitcnt vmcnt(0) lgkmcnt(0)
s_barrier
ds_read_b128 a[116:119], v2 offset:0
ds_read_b128 a[120:123], v2 offset:1024
M v[252:255], a[160:163], v[140:143], v[252:255]
v_exp_f32 v59, v59
M v[252:255], a[156:159], v[108:111], v[252:255]
v_cvt_pk_bf16_f32 v43, v58, v59
M a[64:67], a[164:167], v[96:99], a[64:67]
v_exp_f32 v44, v44
M a[64:67], a[168:171], v[128:131], a[64:67]
ds_read_b128 a[124:127], v2 offset:2048
ds_read_b128 a[128:131], v2 offset:3072
M a[68:71], a[168:171], v[132:135], a[68:71]
v_exp_f32 v45, v45
M a[68:71], a[164:167], v[100:103], a[68:71]
v_cvt_pk_bf16_f32 v44, v44, v45
M a[72:75], a[164:167], v[104:107], a[72:75]
v_exp_f32 v46, v46
M a[72:75], a[168:171], v[136:139], a[72:75]
ds_read_b128 a[132:135], v2 offset:4096
ds_read_b128 a[136:139], v2 offset:5120
M a[76:79], a[168:171], v[140:143], a[76:79]
v_exp_f32 v47, v47
M a[76:79], a[164:167], v[108:111], a[76:79]
v_cvt_pk_bf16_f32 v45, v46, v47
M a[80:83], a[172:175], v[96:99], a[80:83]
v_exp_f32 v60, v60
M a[80:83], a[176:179], v[128:131], a[80:83]
ds_read_b128 a[140:143], v2 offset:6144
ds_read_b128 a[144:147], v2 offset:7168
M a[84:87], a[176:179], v[132:135], a[84:87]
v_exp_f32 v61, v61
M a[84:87], a[172:175], v[100:103], a[84:87]
v_cvt_pk_bf16_f32 v46, v60, v61
M a[88:91], a[172:175], v[104:107], a[88:91]
v_exp_f32 v62, v62
M a[88:91], a[176:179], v[136:139], a[88:91]
M a[92:95], a[176:179], v[140:143], a[92:95]
v_exp_f32 v63, v63
M a[92:95], a[172:175], v[108:111], a[92:95]
v_cvt_pk_bf16_f32 v47, v62, v63
Lk2_m2a:
s_sub_u32 s35, 15, s21
s_lshl_b32 s33, s20, 7
s_lshl_b32 s34, s35, 3
s_add_u32 s33, s33, s34
s_lshl_b32 s34, s23, 2
s_add_u32 s33, s33, s34
s_lshl_b32 s33, s33, 12
buffer_load_dwordx4 a[180:183], v1, s[8:11], s33 offen offset:0 sc1
buffer_load_dwordx4 a[184:187], v1, s[8:11], s33 offen offset:1024 sc1
buffer_load_dwordx4 a[188:191], v1, s[8:11], s33 offen offset:2048 sc1
buffer_load_dwordx4 a[192:195], v1, s[8:11], s33 offen offset:3072 sc1
s_add_u32 s33, s33, 4096
buffer_load_dwordx4 a[196:199], v1, s[8:11], s33 offen offset:0 sc1
buffer_load_dwordx4 a[200:203], v1, s[8:11], s33 offen offset:1024 sc1
buffer_load_dwordx4 a[204:207], v1, s[8:11], s33 offen offset:2048 sc1
buffer_load_dwordx4 a[208:211], v1, s[8:11], s33 offen offset:3072 sc1
s_add_u32 s33, s33, 4096
buffer_load_dwordx4 a[212:215], v1, s[8:11], s33 offen offset:0 sc1
buffer_load_dwordx4 a[216:219], v1, s[8:11], s33 offen offset:1024 sc1
buffer_load_dwordx4 a[220:223], v1, s[8:11], s33 offen offset:2048 sc1
buffer_load_dwordx4 a[224:227], v1, s[8:11], s33 offen offset:3072 sc1
s_add_u32 s33, s33, 4096
buffer_load_dwordx4 a[228:231], v1, s[8:11], s33 offen offset:0 sc1
buffer_load_dwordx4 a[232:235], v1, s[8:11], s33 offen offset:1024 sc1
buffer_load_dwordx4 a[236:239], v1, s[8:11], s33 offen offset:2048 sc1
buffer_load_dwordx4 a[240:243], v1, s[8:11], s33 offen offset:3072 sc1
s_add_u32 m0, s29, 65536
s_nop 0
buffer_load_dwordx4 v1, s[12:15], s25 offen offset:0 sc1 lds
s_add_u32 s32, s25, 4096
buffer_load_dwordx4 v1, s[12:15], s25 offen offset:1024 sc1 lds
buffer_load_dwordx4 v1, s[12:15], s25 offen offset:2048 sc1 lds
buffer_load_dwordx4 v1, s[12:15], s25 offen offset:3072 sc1 lds
s_add_u32 m0, s29, 69632
s_nop 0
buffer_load_dwordx4 v1, s[12:15], s32 offen offset:0 sc1 lds
buffer_load_dwordx4 v1, s[12:15], s32 offen offset:1024 sc1 lds
buffer_load_dwordx4 v1, s[12:15], s32 offen offset:2048 sc1 lds
buffer_load_dwordx4 v1, s[12:15], s32 offen offset:3072 sc1 lds
s_add_u32 m0, s29, 98304
v_exp_f32 v72, v72
s_waitcnt lgkmcnt(7)
ds_read_b128 a[116:119], v5 offset:32768
s_waitcnt lgkmcnt(7)
ds_read_b128 a[120:123], v5 offset:40960
v_exp_f32 v73, v73
buffer_load_dwordx4 v1, s[12:15], s26 offen offset:0 sc1 lds
s_add_u32 s43, s26, 4096
v_exp_f32 v74, v74
v_cvt_pk_bf16_f32 v72, v72, v73
v_exp_f32 v75, v75
buffer_load_dwordx4 v1, s[12:15], s26 offen offset:1024 sc1 lds
s_waitcnt lgkmcnt(7)
ds_read_b128 a[124:127], v5 offset:33792
s_waitcnt lgkmcnt(7)
ds_read_b128 a[128:131], v5 offset:41984
buffer_load_dwordx4 v1, s[12:15], s26 offen offset:2048 sc1 lds
v_cvt_pk_bf16_f32 v73, v74, v75
v_mov_b32 v74, 0
buffer_load_dwordx4 v1, s[12:15], s26 offen offset:3072 sc1 lds
s_add_u32 m0, s29, 102400
v_exp_f32 v76, v76
s_waitcnt lgkmcnt(7)
ds_read_b128 a[132:135], v5 offset:34816
s_waitcnt lgkmcnt(7)
ds_read_b128 a[136:139], v5 offset:43008
v_exp_f32 v77, v77
buffer_load_dwordx4 v1, s[12:15], s43 offen offset:0 sc1 lds
v_exp_f32 v78, v78
v_mov_b32 v75, 0
v_cvt_pk_bf16_f32 v76, v76, v77
v_exp_f32 v79, v79
buffer_load_dwordx4 v1, s[12:15], s43 offen offset:1024 sc1 lds
v_exp_f32 v92, v92
s_waitcnt lgkmcnt(7)
ds_read_b128 a[140:143], v5 offset:35840
s_waitcnt lgkmcnt(7)
ds_read_b128 a[144:147], v5 offset:44032
v_exp_f32 v93, v93
buffer_load_dwordx4 v1, s[12:15], s43 offen offset:2048 sc1 lds
v_exp_f32 v94, v94
v_cvt_pk_bf16_f32 v77, v78, v79
v_cvt_pk_bf16_f32 v78, v92, v93
v_exp_f32 v95, v95
buffer_load_dwordx4 v1, s[12:15], s43 offen offset:3072 sc1 lds
v_cvt_pk_bf16_f32 v79, v94, v95
s_waitcnt lgkmcnt(6)
M v[160:163], a[116:119], v[32:35], v[160:163]
ds_read_b128 a[148:151], v5 offset:36864
ds_read_b128 a[152:155], v5 offset:45056
M v[164:167], a[116:119], v[36:39], v[164:167]
M v[168:171], a[116:119], v[40:43], v[168:171]
M v[168:171], a[120:123], v[72:75], v[168:171]
s_add_u32 s25, s25, 32768
s_cmp_eq_u32 s25, s27
M v[172:175], a[120:123], v[76:79], v[172:175]
M v[172:175], a[116:119], v[44:47], v[172:175]
s_waitcnt lgkmcnt(6)
M a[96:99], a[112:115], v[32:35], a[96:99]
s_cselect_b32 s25, s28, s25
s_cselect_b32 s27, -1, s27
s_add_u32 s26, s26, 32768
s_cmp_eq_u32 s26, s62
M v[176:179], a[124:127], v[32:35], v[176:179]
ds_read_b128 a[156:159], v5 offset:37888
ds_read_b128 a[160:163], v5 offset:46080
M v[180:183], a[124:127], v[36:39], v[180:183]
M v[184:187], a[124:127], v[40:43], v[184:187]
M v[184:187], a[128:131], v[72:75], v[184:187]
s_cselect_b32 s26, s63, s26
s_cselect_b32 s62, -1, s62
M v[188:191], a[128:131], v[76:79], v[188:191]
M v[188:191], a[124:127], v[44:47], v[188:191]
s_waitcnt lgkmcnt(6)
M a[100:103], a[112:115], v[36:39], a[100:103]
M v[192:195], a[132:135], v[32:35], v[192:195]
ds_read_b128 a[164:167], v5 offset:38912
ds_read_b128 a[168:171], v5 offset:47104
M v[196:199], a[132:135], v[36:39], v[196:199]
M v[200:203], a[132:135], v[40:43], v[200:203]
M v[200:203], a[136:139], v[72:75], v[200:203]
M v[204:207], a[136:139], v[76:79], v[204:207]
M v[204:207], a[132:135], v[44:47], v[204:207]
s_waitcnt lgkmcnt(6)
M a[104:107], a[112:115], v[40:43], a[104:107]
M a[104:107], a[112:115], v[72:75], a[104:107]
M v[208:211], a[140:143], v[32:35], v[208:211]
ds_read_b128 a[172:175], v5 offset:39936
ds_read_b128 a[176:179], v5 offset:48128
M v[212:215], a[140:143], v[36:39], v[212:215]
M v[216:219], a[140:143], v[40:43], v[216:219]
M v[216:219], a[144:147], v[72:75], v[216:219]
M v[220:223], a[144:147], v[76:79], v[220:223]
M v[220:223], a[140:143], v[44:47], v[220:223]
s_waitcnt lgkmcnt(6)
M a[108:111], a[112:115], v[44:47], a[108:111]
M a[108:111], a[112:115], v[76:79], a[108:111]
M v[224:227], a[148:151], v[32:35], v[224:227]
M v[228:231], a[148:151], v[36:39], v[228:231]
M v[232:235], a[148:151], v[40:43], v[232:235]
M v[232:235], a[152:155], v[72:75], v[232:235]
M v[236:239], a[152:155], v[76:79], v[236:239]
M v[236:239], a[148:151], v[44:47], v[236:239]
s_waitcnt lgkmcnt(4)
M v[240:243], a[156:159], v[32:35], v[240:243]
M v[244:247], a[156:159], v[36:39], v[244:247]
M v[248:251], a[156:159], v[40:43], v[248:251]
M v[248:251], a[160:163], v[72:75], v[248:251]
s_waitcnt vmcnt(0) lgkmcnt(0)
s_barrier
ds_read_b128 a[116:119], v3 offset:0
ds_read_b128 a[120:123], v3 offset:1024
M v[252:255], a[160:163], v[76:79], v[252:255]
M v[252:255], a[156:159], v[44:47], v[252:255]
M a[64:67], a[164:167], v[32:35], a[64:67]
ds_read_b128 a[124:127], v3 offset:2048
ds_read_b128 a[128:131], v3 offset:3072
M a[68:71], a[164:167], v[36:39], a[68:71]
M a[72:75], a[164:167], v[40:43], a[72:75]
M a[72:75], a[168:171], v[72:75], a[72:75]
ds_read_b128 a[132:135], v3 offset:4096
ds_read_b128 a[136:139], v3 offset:5120
M a[76:79], a[168:171], v[76:79], a[76:79]
M a[76:79], a[164:167], v[44:47], a[76:79]
M a[80:83], a[172:175], v[32:35], a[80:83]
ds_read_b128 a[140:143], v3 offset:6144
ds_read_b128 a[144:147], v3 offset:7168
M a[84:87], a[172:175], v[36:39], a[84:87]
M a[88:91], a[172:175], v[40:43], a[88:91]
M a[88:91], a[176:179], v[72:75], a[88:91]
M a[92:95], a[176:179], v[76:79], a[92:95]
M a[92:95], a[172:175], v[44:47], a[92:95]
s_waitcnt vmcnt(16)
s_add_u32 m0, s29, 0
s_waitcnt lgkmcnt(4)
M v[32:35], a[116:119], a[180:183], 0
M v[32:35], a[120:123], a[184:187], v[32:35]
ds_read_b128 a[148:151], v3 offset:8192
ds_read_b128 a[152:155], v3 offset:9216
M v[32:35], a[124:127], a[188:191], v[32:35]
M v[32:35], a[128:131], a[192:195], v[32:35]
buffer_load_dwordx4 v1, s[12:15], s25 offen offset:0 sc1 lds
s_add_u32 s32, s25, 4096
M v[36:39], a[128:131], a[208:211], 0
M v[36:39], a[124:127], a[204:207], v[36:39]
M v[36:39], a[120:123], a[200:203], v[36:39]
M v[36:39], a[116:119], a[196:199], v[36:39]
buffer_load_dwordx4 v1, s[12:15], s25 offen offset:1024 sc1 lds
M v[40:43], a[116:119], a[212:215], 0
M v[40:43], a[120:123], a[216:219], v[40:43]
ds_read_b128 a[156:159], v3 offset:10240
ds_read_b128 a[160:163], v3 offset:11264
M v[40:43], a[124:127], a[220:223], v[40:43]
M v[40:43], a[128:131], a[224:227], v[40:43]
buffer_load_dwordx4 v1, s[12:15], s25 offen offset:2048 sc1 lds
M v[44:47], a[128:131], a[240:243], 0
M v[44:47], a[124:127], a[236:239], v[44:47]
M v[44:47], a[120:123], a[232:235], v[44:47]
M v[44:47], a[116:119], a[228:231], v[44:47]
buffer_load_dwordx4 v1, s[12:15], s25 offen offset:3072 sc1 lds
s_add_u32 m0, s29, 4096
s_waitcnt lgkmcnt(4)
M v[48:51], a[132:135], a[180:183], 0
M v[48:51], a[136:139], a[184:187], v[48:51]
ds_read_b128 a[164:167], v3 offset:12288
ds_read_b128 a[168:171], v3 offset:13312
M v[48:51], a[140:143], a[188:191], v[48:51]
M v[48:51], a[144:147], a[192:195], v[48:51]
buffer_load_dwordx4 v1, s[12:15], s32 offen offset:0 sc1 lds
M v[52:55], a[144:147], a[208:211], 0
M v[52:55], a[140:143], a[204:207], v[52:55]
M v[52:55], a[136:139], a[200:203], v[52:55]
M v[52:55], a[132:135], a[196:199], v[52:55]
buffer_load_dwordx4 v1, s[12:15], s32 offen offset:1024 sc1 lds
M v[56:59], a[132:135], a[212:215], 0
M v[56:59], a[136:139], a[216:219], v[56:59]
ds_read_b128 a[172:175], v3 offset:14336
ds_read_b128 a[176:179], v3 offset:15360
M v[56:59], a[140:143], a[220:223], v[56:59]
M v[56:59], a[144:147], a[224:227], v[56:59]
buffer_load_dwordx4 v1, s[12:15], s32 offen offset:2048 sc1 lds
M v[60:63], a[144:147], a[240:243], 0
M v[60:63], a[140:143], a[236:239], v[60:63]
M v[60:63], a[136:139], a[232:235], v[60:63]
M v[60:63], a[132:135], a[228:231], v[60:63]
buffer_load_dwordx4 v1, s[12:15], s32 offen offset:3072 sc1 lds
s_add_u32 m0, s29, 32768
s_waitcnt lgkmcnt(4)
M v[64:67], a[148:151], a[180:183], 0
M v[64:67], a[152:155], a[184:187], v[64:67]
M v[64:67], a[156:159], a[188:191], v[64:67]
M v[64:67], a[160:163], a[192:195], v[64:67]
buffer_load_dwordx4 v1, s[12:15], s26 offen offset:0 sc1 lds
s_add_u32 s43, s26, 4096
M v[68:71], a[160:163], a[208:211], 0
M v[68:71], a[156:159], a[204:207], v[68:71]
M v[68:71], a[152:155], a[200:203], v[68:71]
M v[68:71], a[148:151], a[196:199], v[68:71]
buffer_load_dwordx4 v1, s[12:15], s26 offen offset:1024 sc1 lds
M v[72:75], a[148:151], a[212:215], 0
M v[72:75], a[152:155], a[216:219], v[72:75]
M v[72:75], a[156:159], a[220:223], v[72:75]
M v[72:75], a[160:163], a[224:227], v[72:75]
buffer_load_dwordx4 v1, s[12:15], s26 offen offset:2048 sc1 lds
M v[76:79], a[160:163], a[240:243], 0
M v[76:79], a[156:159], a[236:239], v[76:79]
M v[76:79], a[152:155], a[232:235], v[76:79]
M v[76:79], a[148:151], a[228:231], v[76:79]
buffer_load_dwordx4 v1, s[12:15], s26 offen offset:3072 sc1 lds
s_add_u32 m0, s29, 36864
s_waitcnt lgkmcnt(0)
M v[80:83], a[164:167], a[180:183], 0
M v[80:83], a[168:171], a[184:187], v[80:83]
M v[80:83], a[172:175], a[188:191], v[80:83]
M v[80:83], a[176:179], a[192:195], v[80:83]
buffer_load_dwordx4 v1, s[12:15], s43 offen offset:0 sc1 lds
M v[84:87], a[176:179], a[208:211], 0
M v[84:87], a[172:175], a[204:207], v[84:87]
M v[84:87], a[168:171], a[200:203], v[84:87]
M v[84:87], a[164:167], a[196:199], v[84:87]
buffer_load_dwordx4 v1, s[12:15], s43 offen offset:1024 sc1 lds
M v[88:91], a[164:167], a[212:215], 0
M v[88:91], a[168:171], a[216:219], v[88:91]
M v[88:91], a[172:175], a[220:223], v[88:91]
M v[88:91], a[176:179], a[224:227], v[88:91]
buffer_load_dwordx4 v1, s[12:15], s43 offen offset:2048 sc1 lds
M v[92:95], a[176:179], a[240:243], 0
M v[92:95], a[172:175], a[236:239], v[92:95]
M v[92:95], a[168:171], a[232:235], v[92:95]
M v[92:95], a[164:167], a[228:231], v[92:95]
buffer_load_dwordx4 v1, s[12:15], s43 offen offset:3072 sc1 lds
v_exp_f32 v32, v32
v_exp_f32 v33, v33
s_nop 0
v_cvt_pk_bf16_f32 v32, v32, v33
v_exp_f32 v34, v34
s_add_u32 s25, s25, 32768
s_cmp_eq_u32 s25, s27
v_exp_f32 v35, v35
s_nop 0
v_cvt_pk_bf16_f32 v33, v34, v35
s_cselect_b32 s25, s28, s25
s_cselect_b32 s27, -1, s27
s_add_u32 s26, s26, 32768
s_cmp_eq_u32 s26, s62
v_exp_f32 v48, v48
v_exp_f32 v49, v49
s_nop 0
v_cvt_pk_bf16_f32 v34, v48, v49
v_exp_f32 v50, v50
s_cselect_b32 s26, s63, s26
s_cselect_b32 s62, -1, s62
v_exp_f32 v51, v51
s_nop 0
v_cvt_pk_bf16_f32 v35, v50, v51
v_exp_f32 v36, v36
v_exp_f32 v37, v37
s_nop 0
v_cvt_pk_bf16_f32 v36, v36, v37
v_exp_f32 v38, v38
v_exp_f32 v39, v39
s_nop 0
v_cvt_pk_bf16_f32 v37, v38, v39
v_exp_f32 v52, v52
v_exp_f32 v53, v53
s_nop 0
v_cvt_pk_bf16_f32 v38, v52, v53
v_exp_f32 v54, v54
v_exp_f32 v55, v55
s_nop 0
v_cvt_pk_bf16_f32 v39, v54, v55
v_exp_f32 v40, v40
v_exp_f32 v41, v41
s_nop 0
v_cvt_pk_bf16_f32 v40, v40, v41
v_exp_f32 v42, v42
v_exp_f32 v43, v43
s_nop 0
v_cvt_pk_bf16_f32 v41, v42, v43
v_exp_f32 v56, v56
v_exp_f32 v57, v57
s_nop 0
v_cvt_pk_bf16_f32 v42, v56, v57
v_exp_f32 v58, v58
s_waitcnt vmcnt(0) lgkmcnt(0)
s_barrier
ds_read_b128 a[116:119], v2 offset:0
ds_read_b128 a[120:123], v2 offset:1024
v_exp_f32 v59, v59
s_nop 0
v_cvt_pk_bf16_f32 v43, v58, v59
v_exp_f32 v44, v44
ds_read_b128 a[124:127], v2 offset:2048
ds_read_b128 a[128:131], v2 offset:3072
v_exp_f32 v45, v45
s_nop 0
v_cvt_pk_bf16_f32 v44, v44, v45
v_exp_f32 v46, v46
ds_read_b128 a[132:135], v2 offset:4096
ds_read_b128 a[136:139], v2 offset:5120
v_exp_f32 v47, v47
s_nop 0
v_cvt_pk_bf16_f32 v45, v46, v47
v_exp_f32 v60, v60
ds_read_b128 a[140:143], v2 offset:6144
ds_read_b128 a[144:147], v2 offset:7168
v_exp_f32 v61, v61
s_nop 0
v_cvt_pk_bf16_f32 v46, v60, v61
v_exp_f32 v62, v62
v_exp_f32 v63, v63
s_nop 0
v_cvt_pk_bf16_f32 v47, v62, v63
s_branch Lk2_ea
Lk2_m2:
s_cmp_eq_u32 s23, 0
s_cbranch_scc1 Lk2_m2a
s_branch Lk2_m2b
Lk2_m1b:
s_add_u32 m0, s29, 0
s_waitcnt lgkmcnt(4)
M v[32:35], a[116:119], a[0:3], 0
v_exp_f32 v128, v128
M v[32:35], a[120:123], a[4:7], v[32:35]
ds_read_b128 a[148:151], v3 offset:8192
ds_read_b128 a[152:155], v3 offset:9216
M v[32:35], a[124:127], a[8:11], v[32:35]
v_exp_f32 v129, v129
M v[32:35], a[128:131], a[12:15], v[32:35]
buffer_load_dwordx4 v1, s[12:15], s25 offen offset:0 sc1 lds
s_add_u32 s32, s25, 4096
M v[36:39], a[128:131], a[28:31], 0
v_exp_f32 v130, v130
M v[36:39], a[124:127], a[24:27], v[36:39]
v_cvt_pk_bf16_f32 v128, v128, v129
M v[36:39], a[120:123], a[20:23], v[36:39]
v_exp_f32 v131, v131
M v[36:39], a[116:119], a[16:19], v[36:39]
buffer_load_dwordx4 v1, s[12:15], s25 offen offset:1024 sc1 lds
M v[40:43], a[116:119], a[32:35], 0
v_exp_f32 v144, v144
M v[40:43], a[120:123], a[36:39], v[40:43]
ds_read_b128 a[156:159], v3 offset:10240
ds_read_b128 a[160:163], v3 offset:11264
M v[40:43], a[124:127], a[40:43], v[40:43]
v_exp_f32 v145, v145
M v[40:43], a[128:131], a[44:47], v[40:43]
buffer_load_dwordx4 v1, s[12:15], s25 offen offset:2048 sc1 lds
M v[44:47], a[128:131], a[60:63], 0
v_exp_f32 v146, v146
M v[44:47], a[124:127], a[56:59], v[44:47]
v_cvt_pk_bf16_f32 v129, v130, v131
v_cvt_pk_bf16_f32 v130, v144, v145
M v[44:47], a[120:123], a[52:55], v[44:47]
v_exp_f32 v147, v147
M v[44:47], a[116:119], a[48:51], v[44:47]
buffer_load_dwordx4 v1, s[12:15], s25 offen offset:3072 sc1 lds
s_add_u32 m0, s29, 4096
s_waitcnt lgkmcnt(4)
M v[48:51], a[132:135], a[0:3], 0
v_exp_f32 v132, v132
M v[48:51], a[136:139], a[4:7], v[48:51]
ds_read_b128 a[164:167], v3 offset:12288
ds_read_b128 a[168:171], v3 offset:13312
M v[48:51], a[140:143], a[8:11], v[48:51]
v_exp_f32 v133, v133
M v[48:51], a[144:147], a[12:15], v[48:51]
buffer_load_dwordx4 v1, s[12:15], s32 offen offset:0 sc1 lds
M v[52:55], a[144:147], a[28:31], 0
v_exp_f32 v134, v134
M v[52:55], a[140:143], a[24:27], v[52:55]
v_cvt_pk_bf16_f32 v131, v146, v147
v_cvt_pk_bf16_f32 v132, v132, v133
M v[52:55], a[136:139], a[20:23], v[52:55]
v_exp_f32 v135, v135
M v[52:55], a[132:135], a[16:19], v[52:55]
buffer_load_dwordx4 v1, s[12:15], s32 offen offset:1024 sc1 lds
M v[56:59], a[132:135], a[32:35], 0
v_exp_f32 v148, v148
M v[56:59], a[136:139], a[36:39], v[56:59]
ds_read_b128 a[172:175], v3 offset:14336
ds_read_b128 a[176:179], v3 offset:15360
M v[56:59], a[140:143], a[40:43], v[56:59]
v_exp_f32 v149, v149
M v[56:59], a[144:147], a[44:47], v[56:59]
buffer_load_dwordx4 v1, s[12:15], s32 offen offset:2048 sc1 lds
M v[60:63], a[144:147], a[60:63], 0
v_exp_f32 v150, v150
M v[60:63], a[140:143], a[56:59], v[60:63]
v_cvt_pk_bf16_f32 v133, v134, v135
v_cvt_pk_bf16_f32 v134, v148, v149
M v[60:63], a[136:139], a[52:55], v[60:63]
v_exp_f32 v151, v151
M v[60:63], a[132:135], a[48:51], v[60:63]
buffer_load_dwordx4 v1, s[12:15], s32 offen offset:3072 sc1 lds
s_add_u32 m0, s29, 32768
s_waitcnt lgkmcnt(4)
M v[64:67], a[148:151], a[0:3], 0
v_exp_f32 v136, v136
M v[64:67], a[152:155], a[4:7], v[64:67]
ds_read_b128 a[116:119], v6 offset:32768
ds_read_b128 a[120:123], v6 offset:40960
M v[64:67], a[156:159], a[8:11], v[64:67]
v_exp_f32 v137, v137
M v[64:67], a[160:163], a[12:15], v[64:67]
buffer_load_dwordx4 v1, s[12:15], s26 offen offset:0 sc1 lds
s_add_u32 s43, s26, 4096
M v[68:71], a[160:163], a[28:31], 0
v_exp_f32 v138, v138
M v[68:71], a[156:159], a[24:27], v[68:71]
v_cvt_pk_bf16_f32 v135, v150, v151
v_cvt_pk_bf16_f32 v136, v136, v137
M v[68:71], a[152:155], a[20:23], v[68:71]
v_exp_f32 v139, v139
M v[68:71], a[148:151], a[16:19], v[68:71]
buffer_load_dwordx4 v1, s[12:15], s26 offen offset:1024 sc1 lds
M v[72:75], a[148:151], a[32:35], 0
v_exp_f32 v152, v152
M v[72:75], a[152:155], a[36:39], v[72:75]
ds_read_b128 a[124:127], v6 offset:33792
ds_read_b128 a[128:131], v6 offset:41984
M v[72:75], a[156:159], a[40:43], v[72:75]
v_exp_f32 v153, v153
M v[72:75], a[160:163], a[44:47], v[72:75]
buffer_load_dwordx4 v1, s[12:15], s26 offen offset:2048 sc1 lds
M v[76:79], a[160:163], a[60:63], 0
v_exp_f32 v154, v154
M v[76:79], a[156:159], a[56:59], v[76:79]
v_cvt_pk_bf16_f32 v137, v138, v139
v_cvt_pk_bf16_f32 v138, v152, v153
M v[76:79], a[152:155], a[52:55], v[76:79]
v_exp_f32 v155, v155
M v[76:79], a[148:151], a[48:51], v[76:79]
buffer_load_dwordx4 v1, s[12:15], s26 offen offset:3072 sc1 lds
s_add_u32 m0, s29, 36864
s_waitcnt lgkmcnt(4)
M v[80:83], a[164:167], a[0:3], 0
v_exp_f32 v140, v140
M v[80:83], a[168:171], a[4:7], v[80:83]
ds_read_b128 a[132:135], v6 offset:34816
ds_read_b128 a[136:139], v6 offset:43008
M v[80:83], a[172:175], a[8:11], v[80:83]
v_exp_f32 v141, v141
M v[80:83], a[176:179], a[12:15], v[80:83]
buffer_load_dwordx4 v1, s[12:15], s43 offen offset:0 sc1 lds
M v[84:87], a[176:179], a[28:31], 0
v_exp_f32 v142, v142
M v[84:87], a[172:175], a[24:27], v[84:87]
v_cvt_pk_bf16_f32 v139, v154, v155
v_cvt_pk_bf16_f32 v140, v140, v141
M v[84:87], a[168:171], a[20:23], v[84:87]
v_exp_f32 v143, v143
M v[84:87], a[164:167], a[16:19], v[84:87]
buffer_load_dwordx4 v1, s[12:15], s43 offen offset:1024 sc1 lds
M v[88:91], a[164:167], a[32:35], 0
v_exp_f32 v156, v156
M v[88:91], a[168:171], a[36:39], v[88:91]
ds_read_b128 a[140:143], v6 offset:35840
ds_read_b128 a[144:147], v6 offset:44032
M v[88:91], a[172:175], a[40:43], v[88:91]
v_exp_f32 v157, v157
M v[88:91], a[176:179], a[44:47], v[88:91]
buffer_load_dwordx4 v1, s[12:15], s43 offen offset:2048 sc1 lds
M v[92:95], a[176:179], a[60:63], 0
v_exp_f32 v158, v158
M v[92:95], a[172:175], a[56:59], v[92:95]
v_cvt_pk_bf16_f32 v141, v142, v143
v_cvt_pk_bf16_f32 v142, v156, v157
M v[92:95], a[168:171], a[52:55], v[92:95]
v_exp_f32 v159, v159
M v[92:95], a[164:167], a[48:51], v[92:95]
buffer_load_dwordx4 v1, s[12:15], s43 offen offset:3072 sc1 lds
v_cvt_pk_bf16_f32 v143, v158, v159
s_waitcnt lgkmcnt(6)
M v[160:163], a[116:119], v[96:99], v[160:163]
v_exp_f32 v32, v32
M v[160:163], a[120:123], v[128:131], v[160:163]
ds_read_b128 a[148:151], v6 offset:36864
ds_read_b128 a[152:155], v6 offset:45056
M v[164:167], a[120:123], v[132:135], v[164:167]
v_exp_f32 v33, v33
M v[164:167], a[116:119], v[100:103], v[164:167]
v_cvt_pk_bf16_f32 v32, v32, v33
M v[168:171], a[116:119], v[104:107], v[168:171]
v_exp_f32 v34, v34
M v[168:171], a[120:123], v[136:139], v[168:171]
s_add_u32 s25, s25, 32768
s_cmp_eq_u32 s25, s27
M v[172:175], a[120:123], v[140:143], v[172:175]
v_exp_f32 v35, v35
M v[172:175], a[116:119], v[108:111], v[172:175]
v_cvt_pk_bf16_f32 v33, v34, v35
s_waitcnt lgkmcnt(6)
M a[96:99], a[112:115], v[96:99], a[96:99]
s_cselect_b32 s25, s28, s25
s_cselect_b32 s27, -1, s27
M a[96:99], a[112:115], v[128:131], a[96:99]
s_add_u32 s26, s26, 32768
s_cmp_eq_u32 s26, s62
M v[176:179], a[124:127], v[96:99], v[176:179]
v_exp_f32 v48, v48
M v[176:179], a[128:131], v[128:131], v[176:179]
ds_read_b128 a[156:159], v6 offset:37888
ds_read_b128 a[160:163], v6 offset:46080
M v[180:183], a[128:131], v[132:135], v[180:183]
v_exp_f32 v49, v49
M v[180:183], a[124:127], v[100:103], v[180:183]
v_cvt_pk_bf16_f32 v34, v48, v49
M v[184:187], a[124:127], v[104:107], v[184:187]
v_exp_f32 v50, v50
M v[184:187], a[128:131], v[136:139], v[184:187]
s_cselect_b32 s26, s63, s26
s_cselect_b32 s62, -1, s62
M v[188:191], a[128:131], v[140:143], v[188:191]
v_exp_f32 v51, v51
M v[188:191], a[124:127], v[108:111], v[188:191]
v_cvt_pk_bf16_f32 v35, v50, v51
s_waitcnt lgkmcnt(6)
M a[100:103], a[112:115], v[100:103], a[100:103]
M a[100:103], a[112:115], v[132:135], a[100:103]
M v[192:195], a[132:135], v[96:99], v[192:195]
v_exp_f32 v36, v36
M v[192:195], a[136:139], v[128:131], v[192:195]
ds_read_b128 a[164:167], v6 offset:38912
ds_read_b128 a[168:171], v6 offset:47104
M v[196:199], a[136:139], v[132:135], v[196:199]
v_exp_f32 v37, v37
M v[196:199], a[132:135], v[100:103], v[196:199]
v_cvt_pk_bf16_f32 v36, v36, v37
M v[200:203], a[132:135], v[104:107], v[200:203]
v_exp_f32 v38, v38
M v[200:203], a[136:139], v[136:139], v[200:203]
M v[204:207], a[136:139], v[140:143], v[204:207]
v_exp_f32 v39, v39
M v[204:207], a[132:135], v[108:111], v[204:207]
v_cvt_pk_bf16_f32 v37, v38, v39
s_waitcnt lgkmcnt(6)
M a[104:107], a[112:115], v[104:107], a[104:107]
M a[104:107], a[112:115], v[136:139], a[104:107]
M v[208:211], a[140:143], v[96:99], v[208:211]
v_exp_f32 v52, v52
M v[208:211], a[144:147], v[128:131], v[208:211]
ds_read_b128 a[172:175], v6 offset:39936
ds_read_b128 a[176:179], v6 offset:48128
M v[212:215], a[144:147], v[132:135], v[212:215]
v_exp_f32 v53, v53
M v[212:215], a[140:143], v[100:103], v[212:215]
v_cvt_pk_bf16_f32 v38, v52, v53
M v[216:219], a[140:143], v[104:107], v[216:219]
v_exp_f32 v54, v54
M v[216:219], a[144:147], v[136:139], v[216:219]
M v[220:223], a[144:147], v[140:143], v[220:223]
v_exp_f32 v55, v55
M v[220:223], a[140:143], v[108:111], v[220:223]
v_cvt_pk_bf16_f32 v39, v54, v55
s_waitcnt lgkmcnt(6)
M a[108:111], a[112:115], v[108:111], a[108:111]
M a[108:111], a[112:115], v[140:143], a[108:111]
M v[224:227], a[148:151], v[96:99], v[224:227]
v_exp_f32 v40, v40
M v[224:227], a[152:155], v[128:131], v[224:227]
M v[228:231], a[152:155], v[132:135], v[228:231]
v_exp_f32 v41, v41
M v[228:231], a[148:151], v[100:103], v[228:231]
v_cvt_pk_bf16_f32 v40, v40, v41
M v[232:235], a[148:151], v[104:107], v[232:235]
v_exp_f32 v42, v42
M v[232:235], a[152:155], v[136:139], v[232:235]
M v[236:239], a[152:155], v[140:143], v[236:239]
v_exp_f32 v43, v43
M v[236:239], a[148:151], v[108:111], v[236:239]
v_cvt_pk_bf16_f32 v41, v42, v43
s_waitcnt lgkmcnt(4)
M v[240:243], a[156:159], v[96:99], v[240:243]
v_exp_f32 v56, v56
M v[240:243], a[160:163], v[128:131], v[240:243]
M v[244:247], a[160:163], v[132:135], v[244:247]
v_exp_f32 v57, v57
M v[244:247], a[156:159], v[100:103], v[244:247]
v_cvt_pk_bf16_f32 v42, v56, v57
M v[248:251], a[156:159], v[104:107], v[248:251]
v_exp_f32 v58, v58
M v[248:251], a[160:163], v[136:139], v[248:251]
s_waitcnt vmcnt(0) lgkmcnt(0)
s_barrier
ds_read_b128 a[116:119], v2 offset:0
ds_read_b128 a[120:123], v2 offset:1024
M v[252:255], a[160:163], v[140:143], v[252:255]
v_exp_f32 v59, v59
M v[252:255], a[156:159], v[108:111], v[252:255]
v_cvt_pk_bf16_f32 v43, v58, v59
M a[64:67], a[164:167], v[96:99], a[64:67]
v_exp_f32 v44, v44
M a[64:67], a[168:171], v[128:131], a[64:67]
ds_read_b128 a[124:127], v2 offset:2048
ds_read_b128 a[128:131], v2 offset:3072
M a[68:71], a[168:171], v[132:135], a[68:71]
v_exp_f32 v45, v45
M a[68:71], a[164:167], v[100:103], a[68:71]
v_cvt_pk_bf16_f32 v44, v44, v45
M a[72:75], a[164:167], v[104:107], a[72:75]
v_exp_f32 v46, v46
M a[72:75], a[168:171], v[136:139], a[72:75]
ds_read_b128 a[132:135], v2 offset:4096
ds_read_b128 a[136:139], v2 offset:5120
M a[76:79], a[168:171], v[140:143], a[76:79]
v_exp_f32 v47, v47
M a[76:79], a[164:167], v[108:111], a[76:79]
v_cvt_pk_bf16_f32 v45, v46, v47
M a[80:83], a[172:175], v[96:99], a[80:83]
v_exp_f32 v60, v60
M a[80:83], a[176:179], v[128:131], a[80:83]
ds_read_b128 a[140:143], v2 offset:6144
ds_read_b128 a[144:147], v2 offset:7168
M a[84:87], a[176:179], v[132:135], a[84:87]
v_exp_f32 v61, v61
M a[84:87], a[172:175], v[100:103], a[84:87]
v_cvt_pk_bf16_f32 v46, v60, v61
M a[88:91], a[172:175], v[104:107], a[88:91]
v_exp_f32 v62, v62
M a[88:91], a[176:179], v[136:139], a[88:91]
M a[92:95], a[176:179], v[140:143], a[92:95]
v_exp_f32 v63, v63
M a[92:95], a[172:175], v[108:111], a[92:95]
v_cvt_pk_bf16_f32 v47, v62, v63
Lk2_m2b:
s_sub_u32 s35, 15, s21
s_lshl_b32 s33, s20, 7
s_lshl_b32 s34, s35, 3
s_add_u32 s33, s33, s34
s_lshl_b32 s34, s23, 2
s_add_u32 s33, s33, s34
s_lshl_b32 s33, s33, 12
buffer_load_dwordx4 a[180:183], v1, s[8:11], s33 offen offset:0 sc1
buffer_load_dwordx4 a[184:187], v1, s[8:11], s33 offen offset:1024 sc1
buffer_load_dwordx4 a[188:191], v1, s[8:11], s33 offen offset:2048 sc1
buffer_load_dwordx4 a[192:195], v1, s[8:11], s33 offen offset:3072 sc1
s_add_u32 s33, s33, 4096
buffer_load_dwordx4 a[196:199], v1, s[8:11], s33 offen offset:0 sc1
buffer_load_dwordx4 a[200:203], v1, s[8:11], s33 offen offset:1024 sc1
buffer_load_dwordx4 a[204:207], v1, s[8:11], s33 offen offset:2048 sc1
buffer_load_dwordx4 a[208:211], v1, s[8:11], s33 offen offset:3072 sc1
s_add_u32 s33, s33, 4096
buffer_load_dwordx4 a[212:215], v1, s[8:11], s33 offen offset:0 sc1
buffer_load_dwordx4 a[216:219], v1, s[8:11], s33 offen offset:1024 sc1
buffer_load_dwordx4 a[220:223], v1, s[8:11], s33 offen offset:2048 sc1
buffer_load_dwordx4 a[224:227], v1, s[8:11], s33 offen offset:3072 sc1
s_add_u32 s33, s33, 4096
buffer_load_dwordx4 a[228:231], v1, s[8:11], s33 offen offset:0 sc1
buffer_load_dwordx4 a[232:235], v1, s[8:11], s33 offen offset:1024 sc1
buffer_load_dwordx4 a[236:239], v1, s[8:11], s33 offen offset:2048 sc1
buffer_load_dwordx4 a[240:243], v1, s[8:11], s33 offen offset:3072 sc1
s_add_u32 m0, s29, 65536
s_waitcnt lgkmcnt(4)
M v[96:99], a[116:119], a[0:3], v[16:19]
v_exp_f32 v64, v64
M v[96:99], a[120:123], a[4:7], v[96:99]
ds_read_b128 a[148:151], v2 offset:8192
ds_read_b128 a[152:155], v2 offset:9216
M v[96:99], a[124:127], a[8:11], v[96:99]
v_exp_f32 v65, v65
M v[96:99], a[128:131], a[12:15], v[96:99]
buffer_load_dwordx4 v1, s[12:15], s25 offen offset:0 sc1 lds
s_add_u32 s32, s25, 4096
M v[100:103], a[128:131], a[28:31], 0
v_exp_f32 v66, v66
M v[100:103], a[124:127], a[24:27], v[100:103]
v_cvt_pk_bf16_f32 v64, v64, v65
M v[100:103], a[120:123], a[20:23], v[100:103]
v_exp_f32 v67, v67
M v[100:103], a[116:119], a[16:19], v[100:103]
buffer_load_dwordx4 v1, s[12:15], s25 offen offset:1024 sc1 lds
M v[104:107], a[116:119], a[32:35], 0
v_exp_f32 v80, v80
M v[104:107], a[120:123], a[36:39], v[104:107]
ds_read_b128 a[156:159], v2 offset:10240
ds_read_b128 a[160:163], v2 offset:11264
M v[104:107], a[124:127], a[40:43], v[104:107]
v_exp_f32 v81, v81
M v[104:107], a[128:131], a[44:47], v[104:107]
buffer_load_dwordx4 v1, s[12:15], s25 offen offset:2048 sc1 lds
M v[108:111], a[128:131], a[60:63], 0
v_exp_f32 v82, v82
M v[108:111], a[124:127], a[56:59], v[108:111]
v_cvt_pk_bf16_f32 v65, v66, v67
v_cvt_pk_bf16_f32 v66, v80, v81
M v[108:111], a[120:123], a[52:55], v[108:111]
v_exp_f32 v83, v83
M v[108:111], a[116:119], a[48:51], v[108:111]
buffer_load_dwordx4 v1, s[12:15], s25 offen offset:3072 sc1 lds
s_add_u32 m0, s29, 69632
s_waitcnt lgkmcnt(4)
v_exp_f32 v68, v68
ds_read_b128 a[164:167], v2 offset:12288
ds_read_b128 a[168:171], v2 offset:13312
v_exp_f32 v69, v69
buffer_load_dwordx4 v1, s[12:15], s32 offen offset:0 sc1 lds
M v[116:119], a[144:147], a[28:31], v[16:19]
v_exp_f32 v70, v70
M v[116:119], a[140:143], a[24:27], v[116:119]
v_cvt_pk_bf16_f32 v67, v82, v83
v_cvt_pk_bf16_f32 v68, v68, v69
M v[116:119], a[136:139], a[20:23], v[116:119]
v_exp_f32 v71, v71
M v[116:119], a[132:135], a[16:19], v[116:119]
buffer_load_dwordx4 v1, s[12:15], s32 offen offset:1024 sc1 lds
M v[120:123], a[132:135], a[32:35], 0
v_exp_f32 v84, v84
M v[120:123], a[136:139], a[36:39], v[120:123]
ds_read_b128 a[172:175], v2 offset:14336
ds_read_b128 a[176:179], v2 offset:15360
M v[120:123], a[140:143], a[40:43], v[120:123]
v_exp_f32 v85, v85
M v[120:123], a[144:147], a[44:47], v[120:123]
buffer_load_dwordx4 v1, s[12:15], s32 offen offset:2048 sc1 lds
M v[124:127], a[144:147], a[60:63], 0
v_exp_f32 v86, v86
M v[124:127], a[140:143], a[56:59], v[124:127]
v_cvt_pk_bf16_f32 v69, v70, v71
v_cvt_pk_bf16_f32 v70, v84, v85
M v[124:127], a[136:139], a[52:55], v[124:127]
v_exp_f32 v87, v87
M v[124:127], a[132:135], a[48:51], v[124:127]
buffer_load_dwordx4 v1, s[12:15], s32 offen offset:3072 sc1 lds
s_add_u32 m0, s29, 98304
s_waitcnt lgkmcnt(4)
v_exp_f32 v72, v72
ds_read_b128 a[116:119], v5 offset:32768
ds_read_b128 a[120:123], v5 offset:40960
v_exp_f32 v73, v73
buffer_load_dwordx4 v1, s[12:15], s26 offen offset:0 sc1 lds
s_add_u32 s43, s26, 4096
v_exp_f32 v74, v74
v_cvt_pk_bf16_f32 v71, v86, v87
v_cvt_pk_bf16_f32 v72, v72, v73
v_exp_f32 v75, v75
buffer_load_dwordx4 v1, s[12:15], s26 offen offset:1024 sc1 lds
M v[136:139], a[148:151], a[32:35], v[16:19]
v_exp_f32 v88, v88
M v[136:139], a[152:155], a[36:39], v[136:139]
ds_read_b128 a[124:127], v5 offset:33792
ds_read_b128 a[128:131], v5 offset:41984
M v[136:139], a[156:159], a[40:43], v[136:139]
v_exp_f32 v89, v89
M v[136:139], a[160:163], a[44:47], v[136:139]
buffer_load_dwordx4 v1, s[12:15], s26 offen offset:2048 sc1 lds
M v[140:143], a[160:163], a[60:63], 0
v_exp_f32 v90, v90
M v[140:143], a[156:159], a[56:59], v[140:143]
v_cvt_pk_bf16_f32 v73, v74, v75
v_cvt_pk_bf16_f32 v74, v88, v89
M v[140:143], a[152:155], a[52:55], v[140:143]
v_exp_f32 v91, v91
M v[140:143], a[148:151], a[48:51], v[140:143]
buffer_load_dwordx4 v1, s[12:15], s26 offen offset:3072 sc1 lds
s_add_u32 m0, s29, 102400
s_waitcnt lgkmcnt(4)
v_exp_f32 v76, v76
ds_read_b128 a[132:135], v5 offset:34816
ds_read_b128 a[136:139], v5 offset:43008
v_exp_f32 v77, v77
buffer_load_dwordx4 v1, s[12:15], s43 offen offset:0 sc1 lds
v_exp_f32 v78, v78
v_cvt_pk_bf16_f32 v75, v90, v91
v_cvt_pk_bf16_f32 v76, v76, v77
v_exp_f32 v79, v79
buffer_load_dwordx4 v1, s[12:15], s43 offen offset:1024 sc1 lds
v_exp_f32 v92, v92
ds_read_b128 a[140:143], v5 offset:35840
ds_read_b128 a[144:147], v5 offset:44032
v_exp_f32 v93, v93
buffer_load_dwordx4 v1, s[12:15], s43 offen offset:2048 sc1 lds
M v[156:159], a[176:179], a[60:63], v[16:19]
v_exp_f32 v94, v94
M v[156:159], a[172:175], a[56:59], v[156:159]
v_cvt_pk_bf16_f32 v77, v78, v79
v_cvt_pk_bf16_f32 v78, v92, v93
M v[156:159], a[168:171], a[52:55], v[156:159]
v_exp_f32 v95, v95
M v[156:159], a[164:167], a[48:51], v[156:159]
buffer_load_dwordx4 v1, s[12:15], s43 offen offset:3072 sc1 lds
v_cvt_pk_bf16_f32 v79, v94, v95
s_waitcnt lgkmcnt(6)
M v[160:163], a[116:119], v[32:35], v[160:163]
v_exp_f32 v96, v96
M v[160:163], a[120:123], v[64:67], v[160:163]
ds_read_b128 a[148:151], v5 offset:36864
ds_read_b128 a[152:155], v5 offset:45056
M v[164:167], a[120:123], v[68:71], v[164:167]
v_exp_f32 v97, v97
M v[164:167], a[116:119], v[36:39], v[164:167]
v_cvt_pk_bf16_f32 v96, v96, v97
M v[168:171], a[116:119], v[40:43], v[168:171]
v_exp_f32 v98, v98
M v[168:171], a[120:123], v[72:75], v[168:171]
s_add_u32 s25, s25, 32768
s_cmp_eq_u32 s25, s27
M v[172:175], a[120:123], v[76:79], v[172:175]
v_exp_f32 v99, v99
M v[172:175], a[116:119], v[44:47], v[172:175]
v_cvt_pk_bf16_f32 v97, v98, v99
s_waitcnt lgkmcnt(6)
M a[96:99], a[112:115], v[32:35], a[96:99]
s_cselect_b32 s25, s28, s25
s_cselect_b32 s27, -1, s27
M a[96:99], a[112:115], v[64:67], a[96:99]
s_add_u32 s26, s26, 32768
s_cmp_eq_u32 s26, s62
M v[176:179], a[124:127], v[32:35], v[176:179]
M v[176:179], a[128:131], v[64:67], v[176:179]
ds_read_b128 a[156:159], v5 offset:37888
ds_read_b128 a[160:163], v5 offset:46080
M v[180:183], a[128:131], v[68:71], v[180:183]
M v[180:183], a[124:127], v[36:39], v[180:183]
v_mov_b32 v98, 0
M v[184:187], a[124:127], v[40:43], v[184:187]
M v[184:187], a[128:131], v[72:75], v[184:187]
s_cselect_b32 s26, s63, s26
s_cselect_b32 s62, -1, s62
M v[188:191], a[128:131], v[76:79], v[188:191]
M v[188:191], a[124:127], v[44:47], v[188:191]
v_mov_b32 v99, 0
s_waitcnt lgkmcnt(6)
M a[100:103], a[112:115], v[36:39], a[100:103]
M a[100:103], a[112:115], v[68:71], a[100:103]
M v[192:195], a[132:135], v[32:35], v[192:195]
v_exp_f32 v100, v100
M v[192:195], a[136:139], v[64:67], v[192:195]
ds_read_b128 a[164:167], v5 offset:38912
ds_read_b128 a[168:171], v5 offset:47104
M v[196:199], a[136:139], v[68:71], v[196:199]
v_exp_f32 v101, v101
M v[196:199], a[132:135], v[36:39], v[196:199]
v_cvt_pk_bf16_f32 v100, v100, v101
M v[200:203], a[132:135], v[40:43], v[200:203]
v_exp_f32 v102, v102
M v[200:203], a[136:139], v[72:75], v[200:203]
M v[204:207], a[136:139], v[76:79], v[204:207]
v_exp_f32 v103, v103
M v[204:207], a[132:135], v[44:47], v[204:207]
v_cvt_pk_bf16_f32 v101, v102, v103
s_waitcnt lgkmcnt(6)
M a[104:107], a[112:115], v[40:43], a[104:107]
M a[104:107], a[112:115], v[72:75], a[104:107]
M v[208:211], a[140:143], v[32:35], v[208:211]
v_exp_f32 v116, v116
M v[208:211], a[144:147], v[64:67], v[208:211]
ds_read_b128 a[172:175], v5 offset:39936
ds_read_b128 a[176:179], v5 offset:48128
M v[212:215], a[144:147], v[68:71], v[212:215]
v_exp_f32 v117, v117
M v[212:215], a[140:143], v[36:39], v[212:215]
v_cvt_pk_bf16_f32 v102, v116, v117
M v[216:219], a[140:143], v[40:43], v[216:219]
v_exp_f32 v118, v118
M v[216:219], a[144:147], v[72:75], v[216:219]
M v[220:223], a[144:147], v[76:79], v[220:223]
v_exp_f32 v119, v119
M v[220:223], a[140:143], v[44:47], v[220:223]
v_cvt_pk_bf16_f32 v103, v118, v119
s_waitcnt lgkmcnt(6)
M a[108:111], a[112:115], v[44:47], a[108:111]
M a[108:111], a[112:115], v[76:79], a[108:111]
M v[224:227], a[148:151], v[32:35], v[224:227]
v_exp_f32 v104, v104
M v[224:227], a[152:155], v[64:67], v[224:227]
M v[228:231], a[152:155], v[68:71], v[228:231]
v_exp_f32 v105, v105
M v[228:231], a[148:151], v[36:39], v[228:231]
v_cvt_pk_bf16_f32 v104, v104, v105
M v[232:235], a[148:151], v[40:43], v[232:235]
v_exp_f32 v106, v106
M v[232:235], a[152:155], v[72:75], v[232:235]
M v[236:239], a[152:155], v[76:79], v[236:239]
v_exp_f32 v107, v107
M v[236:239], a[148:151], v[44:47], v[236:239]
v_cvt_pk_bf16_f32 v105, v106, v107
s_waitcnt lgkmcnt(4)
M v[240:243], a[156:159], v[32:35], v[240:243]
v_exp_f32 v120, v120
M v[240:243], a[160:163], v[64:67], v[240:243]
M v[244:247], a[160:163], v[68:71], v[244:247]
v_exp_f32 v121, v121
M v[244:247], a[156:159], v[36:39], v[244:247]
v_cvt_pk_bf16_f32 v106, v120, v121
M v[248:251], a[156:159], v[40:43], v[248:251]
v_exp_f32 v122, v122
M v[248:251], a[160:163], v[72:75], v[248:251]
s_waitcnt vmcnt(0) lgkmcnt(0)
s_barrier
ds_read_b128 a[116:119], v3 offset:0
ds_read_b128 a[120:123], v3 offset:1024
M v[252:255], a[160:163], v[76:79], v[252:255]
v_exp_f32 v123, v123
M v[252:255], a[156:159], v[44:47], v[252:255]
v_cvt_pk_bf16_f32 v107, v122, v123
M a[64:67], a[164:167], v[32:35], a[64:67]
v_exp_f32 v108, v108
M a[64:67], a[168:171], v[64:67], a[64:67]
ds_read_b128 a[124:127], v3 offset:2048
ds_read_b128 a[128:131], v3 offset:3072
M a[68:71], a[168:171], v[68:71], a[68:71]
v_exp_f32 v109, v109
M a[68:71], a[164:167], v[36:39], a[68:71]
v_cvt_pk_bf16_f32 v108, v108, v109
M a[72:75], a[164:167], v[40:43], a[72:75]
v_exp_f32 v110, v110
M a[72:75], a[168:171], v[72:75], a[72:75]
ds_read_b128 a[132:135], v3 offset:4096
ds_read_b128 a[136:139], v3 offset:5120
M a[76:79], a[168:171], v[76:79], a[76:79]
v_exp_f32 v111, v111
M a[76:79], a[164:167], v[44:47], a[76:79]
v_cvt_pk_bf16_f32 v109, v110, v111
M a[80:83], a[172:175], v[32:35], a[80:83]
v_exp_f32 v124, v124
M a[80:83], a[176:179], v[64:67], a[80:83]
ds_read_b128 a[140:143], v3 offset:6144
ds_read_b128 a[144:147], v3 offset:7168
M a[84:87], a[176:179], v[68:71], a[84:87]
v_exp_f32 v125, v125
M a[84:87], a[172:175], v[36:39], a[84:87]
v_cvt_pk_bf16_f32 v110, v124, v125
M a[88:91], a[172:175], v[40:43], a[88:91]
v_exp_f32 v126, v126
M a[88:91], a[176:179], v[72:75], a[88:91]
M a[92:95], a[176:179], v[76:79], a[92:95]
v_exp_f32 v127, v127
M a[92:95], a[172:175], v[44:47], a[92:95]
v_cvt_pk_bf16_f32 v111, v126, v127
s_waitcnt vmcnt(16)
s_add_u32 m0, s29, 0
s_waitcnt lgkmcnt(4)
M v[32:35], a[116:119], a[180:183], 0
M v[32:35], a[120:123], a[184:187], v[32:35]
ds_read_b128 a[148:151], v3 offset:8192
ds_read_b128 a[152:155], v3 offset:9216
M v[32:35], a[124:127], a[188:191], v[32:35]
M v[32:35], a[128:131], a[192:195], v[32:35]
buffer_load_dwordx4 v1, s[12:15], s25 offen offset:0 sc1 lds
s_add_u32 s32, s25, 4096
M v[36:39], a[128:131], a[208:211], 0
M v[36:39], a[124:127], a[204:207], v[36:39]
M v[36:39], a[120:123], a[200:203], v[36:39]
M v[36:39], a[116:119], a[196:199], v[36:39]
buffer_load_dwordx4 v1, s[12:15], s25 offen offset:1024 sc1 lds
M v[40:43], a[116:119], a[212:215], 0
M v[40:43], a[120:123], a[216:219], v[40:43]
ds_read_b128 a[156:159], v3 offset:10240
ds_read_b128 a[160:163], v3 offset:11264
M v[40:43], a[124:127], a[220:223], v[40:43]
M v[40:43], a[128:131], a[224:227], v[40:43]
buffer_load_dwordx4 v1, s[12:15], s25 offen offset:2048 sc1 lds
M v[44:47], a[128:131], a[240:243], 0
M v[44:47], a[124:127], a[236:239], v[44:47]
M v[44:47], a[120:123], a[232:235], v[44:47]
M v[44:47], a[116:119], a[228:231], v[44:47]
buffer_load_dwordx4 v1, s[12:15], s25 offen offset:3072 sc1 lds
s_add_u32 m0, s29, 4096
s_waitcnt lgkmcnt(4)
M v[48:51], a[132:135], a[180:183], 0
M v[48:51], a[136:139], a[184:187], v[48:51]
ds_read_b128 a[164:167], v3 offset:12288
ds_read_b128 a[168:171], v3 offset:13312
M v[48:51], a[140:143], a[188:191], v[48:51]
M v[48:51], a[144:147], a[192:195], v[48:51]
buffer_load_dwordx4 v1, s[12:15], s32 offen offset:0 sc1 lds
M v[52:55], a[144:147], a[208:211], 0
M v[52:55], a[140:143], a[204:207], v[52:55]
M v[52:55], a[136:139], a[200:203], v[52:55]
M v[52:55], a[132:135], a[196:199], v[52:55]
buffer_load_dwordx4 v1, s[12:15], s32 offen offset:1024 sc1 lds
M v[56:59], a[132:135], a[212:215], 0
M v[56:59], a[136:139], a[216:219], v[56:59]
ds_read_b128 a[172:175], v3 offset:14336
ds_read_b128 a[176:179], v3 offset:15360
M v[56:59], a[140:143], a[220:223], v[56:59]
M v[56:59], a[144:147], a[224:227], v[56:59]
buffer_load_dwordx4 v1, s[12:15], s32 offen offset:2048 sc1 lds
M v[60:63], a[144:147], a[240:243], 0
M v[60:63], a[140:143], a[236:239], v[60:63]
M v[60:63], a[136:139], a[232:235], v[60:63]
M v[60:63], a[132:135], a[228:231], v[60:63]
buffer_load_dwordx4 v1, s[12:15], s32 offen offset:3072 sc1 lds
s_add_u32 m0, s29, 32768
s_waitcnt lgkmcnt(4)
M v[64:67], a[148:151], a[180:183], 0
v_exp_f32 v136, v136
M v[64:67], a[152:155], a[184:187], v[64:67]
ds_read_b128 a[116:119], v6 offset:32768
ds_read_b128 a[120:123], v6 offset:40960
M v[64:67], a[156:159], a[188:191], v[64:67]
v_exp_f32 v137, v137
M v[64:67], a[160:163], a[192:195], v[64:67]
buffer_load_dwordx4 v1, s[12:15], s26 offen offset:0 sc1 lds
s_add_u32 s43, s26, 4096
M v[68:71], a[160:163], a[208:211], 0
v_exp_f32 v138, v138
M v[68:71], a[156:159], a[204:207], v[68:71]
v_cvt_pk_bf16_f32 v136, v136, v137
M v[68:71], a[152:155], a[200:203], v[68:71]
v_exp_f32 v139, v139
M v[68:71], a[148:151], a[196:199], v[68:71]
buffer_load_dwordx4 v1, s[12:15], s26 offen offset:1024 sc1 lds
M v[72:75], a[148:151], a[212:215], 0
M v[72:75], a[152:155], a[216:219], v[72:75]
ds_read_b128 a[124:127], v6 offset:33792
ds_read_b128 a[128:131], v6 offset:41984
M v[72:75], a[156:159], a[220:223], v[72:75]
M v[72:75], a[160:163], a[224:227], v[72:75]
buffer_load_dwordx4 v1, s[12:15], s26 offen offset:2048 sc1 lds
M v[76:79], a[160:163], a[240:243], 0
M v[76:79], a[156:159], a[236:239], v[76:79]
v_cvt_pk_bf16_f32 v137, v138, v139
v_mov_b32 v138, 0
M v[76:79], a[152:155], a[232:235], v[76:79]
M v[76:79], a[148:151], a[228:231], v[76:79]
buffer_load_dwordx4 v1, s[12:15], s26 offen offset:3072 sc1 lds
s_add_u32 m0, s29, 36864
s_waitcnt lgkmcnt(4)
M v[80:83], a[164:167], a[180:183], 0
v_exp_f32 v140, v140
M v[80:83], a[168:171], a[184:187], v[80:83]
ds_read_b128 a[132:135], v6 offset:34816
ds_read_b128 a[136:139], v6 offset:43008
M v[80:83], a[172:175], a[188:191], v[80:83]
v_exp_f32 v141, v141
M v[80:83], a[176:179], a[192:195], v[80:83]
buffer_load_dwordx4 v1, s[12:15], s43 offen offset:0 sc1 lds
M v[84:87], a[176:179], a[208:211], 0
v_exp_f32 v142, v142
M v[84:87], a[172:175], a[204:207], v[84:87]
v_mov_b32 v139, 0
v_cvt_pk_bf16_f32 v140, v140, v141
M v[84:87], a[168:171], a[200:203], v[84:87]
v_exp_f32 v143, v143
M v[84:87], a[164:167], a[196:199], v[84:87]
buffer_load_dwordx4 v1, s[12:15], s43 offen offset:1024 sc1 lds
M v[88:91], a[164:167], a[212:215], 0
v_exp_f32 v156, v156
M v[88:91], a[168:171], a[216:219], v[88:91]
ds_read_b128 a[140:143], v6 offset:35840
ds_read_b128 a[144:147], v6 offset:44032
M v[88:91], a[172:175], a[220:223], v[88:91]
v_exp_f32 v157, v157
M v[88:91], a[176:179], a[224:227], v[88:91]
buffer_load_dwordx4 v1, s[12:15], s43 offen offset:2048 sc1 lds
M v[92:95], a[176:179], a[240:243], 0
v_exp_f32 v158, v158
M v[92:95], a[172:175], a[236:239], v[92:95]
v_cvt_pk_bf16_f32 v141, v142, v143
v_cvt_pk_bf16_f32 v142, v156, v157
M v[92:95], a[168:171], a[232:235], v[92:95]
v_exp_f32 v159, v159
M v[92:95], a[164:167], a[228:231], v[92:95]
buffer_load_dwordx4 v1, s[12:15], s43 offen offset:3072 sc1 lds
v_cvt_pk_bf16_f32 v143, v158, v159
s_waitcnt lgkmcnt(6)
M v[160:163], a[116:119], v[96:99], v[160:163]
v_exp_f32 v32, v32
ds_read_b128 a[148:151], v6 offset:36864
ds_read_b128 a[152:155], v6 offset:45056
v_exp_f32 v33, v33
M v[164:167], a[116:119], v[100:103], v[164:167]
v_cvt_pk_bf16_f32 v32, v32, v33
M v[168:171], a[116:119], v[104:107], v[168:171]
v_exp_f32 v34, v34
M v[168:171], a[120:123], v[136:139], v[168:171]
s_add_u32 s25, s25, 32768
s_cmp_eq_u32 s25, s27
M v[172:175], a[120:123], v[140:143], v[172:175]
v_exp_f32 v35, v35
M v[172:175], a[116:119], v[108:111], v[172:175]
v_cvt_pk_bf16_f32 v33, v34, v35
s_waitcnt lgkmcnt(6)
M a[96:99], a[112:115], v[96:99], a[96:99]
s_cselect_b32 s25, s28, s25
s_cselect_b32 s27, -1, s27
s_add_u32 s26, s26, 32768
s_cmp_eq_u32 s26, s62
M v[176:179], a[124:127], v[96:99], v[176:179]
v_exp_f32 v48, v48
ds_read_b128 a[156:159], v6 offset:37888
ds_read_b128 a[160:163], v6 offset:46080
v_exp_f32 v49, v49
M v[180:183], a[124:127], v[100:103], v[180:183]
v_cvt_pk_bf16_f32 v34, v48, v49
M v[184:187], a[124:127], v[104:107], v[184:187]
v_exp_f32 v50, v50
M v[184:187], a[128:131], v[136:139], v[184:187]
s_cselect_b32 s26, s63, s26
s_cselect_b32 s62, -1, s62
M v[188:191], a[128:131], v[140:143], v[188:191]
v_exp_f32 v51, v51
M v[188:191], a[124:127], v[108:111], v[188:191]
v_cvt_pk_bf16_f32 v35, v50, v51
s_waitcnt lgkmcnt(6)
M a[100:103], a[112:115], v[100:103], a[100:103]
M v[192:195], a[132:135], v[96:99], v[192:195]
v_exp_f32 v36, v36
ds_read_b128 a[164:167], v6 offset:38912
ds_read_b128 a[168:171], v6 offset:47104
v_exp_f32 v37, v37
M v[196:199], a[132:135], v[100:103], v[196:199]
v_cvt_pk_bf16_f32 v36, v36, v37
M v[200:203], a[132:135], v[104:107], v[200:203]
v_exp_f32 v38, v38
M v[200:203], a[136:139], v[136:139], v[200:203]
M v[204:207], a[136:139], v[140:143], v[204:207]
v_exp_f32 v39, v39
M v[204:207], a[132:135], v[108:111], v[204:207]
v_cvt_pk_bf16_f32 v37, v38, v39
s_waitcnt lgkmcnt(6)
M a[104:107], a[112:115], v[104:107], a[104:107]
M a[104:107], a[112:115], v[136:139], a[104:107]
M v[208:211], a[140:143], v[96:99], v[208:211]
v_exp_f32 v52, v52
ds_read_b128 a[172:175], v6 offset:39936
ds_read_b128 a[176:179], v6 offset:48128
v_exp_f32 v53, v53
M v[212:215], a[140:143], v[100:103], v[212:215]
v_cvt_pk_bf16_f32 v38, v52, v53
M v[216:219], a[140:143], v[104:107], v[216:219]
v_exp_f32 v54, v54
M v[216:219], a[144:147], v[136:139], v[216:219]
M v[220:223], a[144:147], v[140:143], v[220:223]
v_exp_f32 v55, v55
M v[220:223], a[140:143], v[108:111], v[220:223]
v_cvt_pk_bf16_f32 v39, v54, v55
s_waitcnt lgkmcnt(6)
M a[108:111], a[112:115], v[108:111], a[108:111]
M a[108:111], a[112:115], v[140:143], a[108:111]
M v[224:227], a[148:151], v[96:99], v[224:227]
v_exp_f32 v40, v40
v_exp_f32 v41, v41
M v[228:231], a[148:151], v[100:103], v[228:231]
v_cvt_pk_bf16_f32 v40, v40, v41
M v[232:235], a[148:151], v[104:107], v[232:235]
v_exp_f32 v42, v42
M v[232:235], a[152:155], v[136:139], v[232:235]
M v[236:239], a[152:155], v[140:143], v[236:239]
v_exp_f32 v43, v43
M v[236:239], a[148:151], v[108:111], v[236:239]
v_cvt_pk_bf16_f32 v41, v42, v43
s_waitcnt lgkmcnt(4)
M v[240:243], a[156:159], v[96:99], v[240:243]
v_exp_f32 v56, v56
v_exp_f32 v57, v57
M v[244:247], a[156:159], v[100:103], v[244:247]
v_cvt_pk_bf16_f32 v42, v56, v57
M v[248:251], a[156:159], v[104:107], v[248:251]
v_exp_f32 v58, v58
M v[248:251], a[160:163], v[136:139], v[248:251]
s_waitcnt vmcnt(0) lgkmcnt(0)
s_barrier
ds_read_b128 a[116:119], v2 offset:0
ds_read_b128 a[120:123], v2 offset:1024
M v[252:255], a[160:163], v[140:143], v[252:255]
v_exp_f32 v59, v59
M v[252:255], a[156:159], v[108:111], v[252:255]
v_cvt_pk_bf16_f32 v43, v58, v59
M a[64:67], a[164:167], v[96:99], a[64:67]
v_exp_f32 v44, v44
ds_read_b128 a[124:127], v2 offset:2048
ds_read_b128 a[128:131], v2 offset:3072
v_exp_f32 v45, v45
M a[68:71], a[164:167], v[100:103], a[68:71]
v_cvt_pk_bf16_f32 v44, v44, v45
M a[72:75], a[164:167], v[104:107], a[72:75]
v_exp_f32 v46, v46
M a[72:75], a[168:171], v[136:139], a[72:75]
ds_read_b128 a[132:135], v2 offset:4096
ds_read_b128 a[136:139], v2 offset:5120
M a[76:79], a[168:171], v[140:143], a[76:79]
v_exp_f32 v47, v47
M a[76:79], a[164:167], v[108:111], a[76:79]
v_cvt_pk_bf16_f32 v45, v46, v47
M a[80:83], a[172:175], v[96:99], a[80:83]
v_exp_f32 v60, v60
ds_read_b128 a[140:143], v2 offset:6144
ds_read_b128 a[144:147], v2 offset:7168
v_exp_f32 v61, v61
M a[84:87], a[172:175], v[100:103], a[84:87]
v_cvt_pk_bf16_f32 v46, v60, v61
M a[88:91], a[172:175], v[104:107], a[88:91]
v_exp_f32 v62, v62
M a[88:91], a[176:179], v[136:139], a[88:91]
M a[92:95], a[176:179], v[140:143], a[92:95]
v_exp_f32 v63, v63
M a[92:95], a[172:175], v[108:111], a[92:95]
v_cvt_pk_bf16_f32 v47, v62, v63
Lk2_ea:
v_accvgpr_read_b32 v20, a96
v_accvgpr_read_b32 v21, a100
v_accvgpr_read_b32 v22, a104
v_accvgpr_read_b32 v23, a108
v_rcp_f32 v8, v20
v_rcp_f32 v9, v21
v_rcp_f32 v10, v22
v_rcp_f32 v11, v23
v_subrev_u32 v20, 0x21800000, v20
v_subrev_u32 v21, 0x21800000, v21
v_subrev_u32 v22, 0x21800000, v22
v_subrev_u32 v23, 0x21800000, v23
v_max_u32 v12, v20, v21
v_max3_u32 v12, v12, v22, v23
s_mov_b32 s64, 0x207
s_lshl_b32 s33, s21, 20
s_lshl_b32 s34, s20, 15
s_add_u32 s33, s33, s34
s_lshl_b32 s34, s23, 13
s_add_u32 s36, s33, s34
s_add_u32 s37, s36, 4096
s_add_u32 s38, s36, 16384
s_add_u32 s39, s36, 20480
v_pk_mul_f32 v[160:161], v[160:161], v[8:9] op_sel:[0,0] op_sel_hi:[1,0]
v_pk_mul_f32 v[162:163], v[162:163], v[8:9] op_sel:[0,0] op_sel_hi:[1,0]
v_pk_mul_f32 v[176:177], v[176:177], v[8:9] op_sel:[0,0] op_sel_hi:[1,0]
v_pk_mul_f32 v[178:179], v[178:179], v[8:9] op_sel:[0,0] op_sel_hi:[1,0]
v_cvt_pk_bf16_f32 v160, v160, v161
v_cvt_pk_bf16_f32 v161, v162, v163
v_cvt_pk_bf16_f32 v162, v176, v177
v_cvt_pk_bf16_f32 v163, v178, v179
s_nop 1
M v[24:27], a[112:115], v[160:163], 0
buffer_store_dwordx4 v[160:163], v1, s[16:19], s36 offen offset:0 sc1
v_pk_mul_f32 v[164:165], v[164:165], v[8:9] op_sel:[0,1] op_sel_hi:[1,1]
v_pk_mul_f32 v[166:167], v[166:167], v[8:9] op_sel:[0,1] op_sel_hi:[1,1]
v_pk_mul_f32 v[180:181], v[180:181], v[8:9] op_sel:[0,1] op_sel_hi:[1,1]
v_pk_mul_f32 v[182:183], v[182:183], v[8:9] op_sel:[0,1] op_sel_hi:[1,1]
v_cvt_pk_bf16_f32 v164, v164, v165
v_cvt_pk_bf16_f32 v165, v166, v167
v_cvt_pk_bf16_f32 v166, v180, v181
v_cvt_pk_bf16_f32 v167, v182, v183
s_nop 1
M v[24:27], a[112:115], v[164:167], v[24:27]
buffer_store_dwordx4 v[164:167], v1, s[16:19], s36 offen offset:2048 sc1
v_pk_mul_f32 v[168:169], v[168:169], v[10:11] op_sel:[0,0] op_sel_hi:[1,0]
v_pk_mul_f32 v[170:171], v[170:171], v[10:11] op_sel:[0,0] op_sel_hi:[1,0]
v_pk_mul_f32 v[184:185], v[184:185], v[10:11] op_sel:[0,0] op_sel_hi:[1,0]
v_pk_mul_f32 v[186:187], v[186:187], v[10:11] op_sel:[0,0] op_sel_hi:[1,0]
v_cvt_pk_bf16_f32 v168, v168, v169
v_cvt_pk_bf16_f32 v169, v170, v171
v_cvt_pk_bf16_f32 v170, v184, v185
v_cvt_pk_bf16_f32 v171, v186, v187
s_nop 1
M v[24:27], a[112:115], v[168:171], v[24:27]
buffer_store_dwordx4 v[168:171], v1, s[16:19], s37 offen offset:0 sc1
v_pk_mul_f32 v[172:173], v[172:173], v[10:11] op_sel:[0,1] op_sel_hi:[1,1]
v_pk_mul_f32 v[174:175], v[174:175], v[10:11] op_sel:[0,1] op_sel_hi:[1,1]
v_pk_mul_f32 v[188:189], v[188:189], v[10:11] op_sel:[0,1] op_sel_hi:[1,1]
v_pk_mul_f32 v[190:191], v[190:191], v[10:11] op_sel:[0,1] op_sel_hi:[1,1]
v_cvt_pk_bf16_f32 v172, v172, v173
v_cvt_pk_bf16_f32 v173, v174, v175
v_cvt_pk_bf16_f32 v174, v188, v189
v_cvt_pk_bf16_f32 v175, v190, v191
s_nop 1
M v[24:27], a[112:115], v[172:175], v[24:27]
buffer_store_dwordx4 v[172:175], v1, s[16:19], s37 offen offset:2048 sc1
v_pk_mul_f32 v[192:193], v[192:193], v[8:9] op_sel:[0,0] op_sel_hi:[1,0]
v_pk_mul_f32 v[194:195], v[194:195], v[8:9] op_sel:[0,0] op_sel_hi:[1,0]
v_pk_mul_f32 v[208:209], v[208:209], v[8:9] op_sel:[0,0] op_sel_hi:[1,0]
v_pk_mul_f32 v[210:211], v[210:211], v[8:9] op_sel:[0,0] op_sel_hi:[1,0]
v_cvt_pk_bf16_f32 v192, v192, v193
v_cvt_pk_bf16_f32 v193, v194, v195
v_cvt_pk_bf16_f32 v194, v208, v209
v_cvt_pk_bf16_f32 v195, v210, v211
s_nop 1
M v[24:27], a[112:115], v[192:195], v[24:27]
buffer_store_dwordx4 v[192:195], v1, s[16:19], s36 offen offset:1024 sc1
v_pk_mul_f32 v[196:197], v[196:197], v[8:9] op_sel:[0,1] op_sel_hi:[1,1]
v_pk_mul_f32 v[198:199], v[198:199], v[8:9] op_sel:[0,1] op_sel_hi:[1,1]
v_pk_mul_f32 v[212:213], v[212:213], v[8:9] op_sel:[0,1] op_sel_hi:[1,1]
v_pk_mul_f32 v[214:215], v[214:215], v[8:9] op_sel:[0,1] op_sel_hi:[1,1]
v_cvt_pk_bf16_f32 v196, v196, v197
v_cvt_pk_bf16_f32 v197, v198, v199
v_cvt_pk_bf16_f32 v198, v212, v213
v_cvt_pk_bf16_f32 v199, v214, v215
s_nop 1
M v[24:27], a[112:115], v[196:199], v[24:27]
buffer_store_dwordx4 v[196:199], v1, s[16:19], s36 offen offset:3072 sc1
v_pk_mul_f32 v[200:201], v[200:201], v[10:11] op_sel:[0,0] op_sel_hi:[1,0]
v_pk_mul_f32 v[202:203], v[202:203], v[10:11] op_sel:[0,0] op_sel_hi:[1,0]
v_pk_mul_f32 v[216:217], v[216:217], v[10:11] op_sel:[0,0] op_sel_hi:[1,0]
v_pk_mul_f32 v[218:219], v[218:219], v[10:11] op_sel:[0,0] op_sel_hi:[1,0]
v_cvt_pk_bf16_f32 v200, v200, v201
v_cvt_pk_bf16_f32 v201, v202, v203
v_cvt_pk_bf16_f32 v202, v216, v217
v_cvt_pk_bf16_f32 v203, v218, v219
s_nop 1
M v[24:27], a[112:115], v[200:203], v[24:27]
buffer_store_dwordx4 v[200:203], v1, s[16:19], s37 offen offset:1024 sc1
v_pk_mul_f32 v[204:205], v[204:205], v[10:11] op_sel:[0,1] op_sel_hi:[1,1]
v_pk_mul_f32 v[206:207], v[206:207], v[10:11] op_sel:[0,1] op_sel_hi:[1,1]
v_pk_mul_f32 v[220:221], v[220:221], v[10:11] op_sel:[0,1] op_sel_hi:[1,1]
v_pk_mul_f32 v[222:223], v[222:223], v[10:11] op_sel:[0,1] op_sel_hi:[1,1]
v_cvt_pk_bf16_f32 v204, v204, v205
v_cvt_pk_bf16_f32 v205, v206, v207
v_cvt_pk_bf16_f32 v206, v220, v221
v_cvt_pk_bf16_f32 v207, v222, v223
s_nop 1
M v[24:27], a[112:115], v[204:207], v[24:27]
buffer_store_dwordx4 v[204:207], v1, s[16:19], s37 offen offset:3072 sc1
v_pk_mul_f32 v[224:225], v[224:225], v[8:9] op_sel:[0,0] op_sel_hi:[1,0]
v_pk_mul_f32 v[226:227], v[226:227], v[8:9] op_sel:[0,0] op_sel_hi:[1,0]
v_pk_mul_f32 v[240:241], v[240:241], v[8:9] op_sel:[0,0] op_sel_hi:[1,0]
v_pk_mul_f32 v[242:243], v[242:243], v[8:9] op_sel:[0,0] op_sel_hi:[1,0]
v_cvt_pk_bf16_f32 v224, v224, v225
v_cvt_pk_bf16_f32 v225, v226, v227
v_cvt_pk_bf16_f32 v226, v240, v241
v_cvt_pk_bf16_f32 v227, v242, v243
s_nop 1
M v[24:27], a[112:115], v[224:227], v[24:27]
buffer_store_dwordx4 v[224:227], v1, s[16:19], s38 offen offset:0 sc1
v_pk_mul_f32 v[228:229], v[228:229], v[8:9] op_sel:[0,1] op_sel_hi:[1,1]
v_pk_mul_f32 v[230:231], v[230:231], v[8:9] op_sel:[0,1] op_sel_hi:[1,1]
v_pk_mul_f32 v[244:245], v[244:245], v[8:9] op_sel:[0,1] op_sel_hi:[1,1]
v_pk_mul_f32 v[246:247], v[246:247], v[8:9] op_sel:[0,1] op_sel_hi:[1,1]
v_cvt_pk_bf16_f32 v228, v228, v229
v_cvt_pk_bf16_f32 v229, v230, v231
v_cvt_pk_bf16_f32 v230, v244, v245
v_cvt_pk_bf16_f32 v231, v246, v247
s_nop 1
M v[24:27], a[112:115], v[228:231], v[24:27]
buffer_store_dwordx4 v[228:231], v1, s[16:19], s38 offen offset:2048 sc1
v_pk_mul_f32 v[232:233], v[232:233], v[10:11] op_sel:[0,0] op_sel_hi:[1,0]
v_pk_mul_f32 v[234:235], v[234:235], v[10:11] op_sel:[0,0] op_sel_hi:[1,0]
v_pk_mul_f32 v[248:249], v[248:249], v[10:11] op_sel:[0,0] op_sel_hi:[1,0]
v_pk_mul_f32 v[250:251], v[250:251], v[10:11] op_sel:[0,0] op_sel_hi:[1,0]
v_cvt_pk_bf16_f32 v232, v232, v233
v_cvt_pk_bf16_f32 v233, v234, v235
v_cvt_pk_bf16_f32 v234, v248, v249
v_cvt_pk_bf16_f32 v235, v250, v251
s_nop 1
M v[24:27], a[112:115], v[232:235], v[24:27]
buffer_store_dwordx4 v[232:235], v1, s[16:19], s39 offen offset:0 sc1
v_pk_mul_f32 v[236:237], v[236:237], v[10:11] op_sel:[0,1] op_sel_hi:[1,1]
v_pk_mul_f32 v[238:239], v[238:239], v[10:11] op_sel:[0,1] op_sel_hi:[1,1]
v_pk_mul_f32 v[252:253], v[252:253], v[10:11] op_sel:[0,1] op_sel_hi:[1,1]
v_pk_mul_f32 v[254:255], v[254:255], v[10:11] op_sel:[0,1] op_sel_hi:[1,1]
v_cvt_pk_bf16_f32 v236, v236, v237
v_cvt_pk_bf16_f32 v237, v238, v239
v_cvt_pk_bf16_f32 v238, v252, v253
v_cvt_pk_bf16_f32 v239, v254, v255
v_accvgpr_read_b32 v176, a64
v_accvgpr_read_b32 v177, a65
v_accvgpr_read_b32 v178, a66
v_accvgpr_read_b32 v179, a67
v_accvgpr_read_b32 v180, a80
v_accvgpr_read_b32 v181, a81
v_accvgpr_read_b32 v182, a82
v_accvgpr_read_b32 v183, a83
M v[24:27], a[112:115], v[236:239], v[24:27]
buffer_store_dwordx4 v[236:239], v1, s[16:19], s39 offen offset:2048 sc1
v_pk_mul_f32 v[176:177], v[176:177], v[8:9] op_sel:[0,0] op_sel_hi:[1,0]
v_pk_mul_f32 v[178:179], v[178:179], v[8:9] op_sel:[0,0] op_sel_hi:[1,0]
v_pk_mul_f32 v[180:181], v[180:181], v[8:9] op_sel:[0,0] op_sel_hi:[1,0]
v_pk_mul_f32 v[182:183], v[182:183], v[8:9] op_sel:[0,0] op_sel_hi:[1,0]
v_cvt_pk_bf16_f32 v176, v176, v177
v_cvt_pk_bf16_f32 v177, v178, v179
v_cvt_pk_bf16_f32 v178, v180, v181
v_cvt_pk_bf16_f32 v179, v182, v183
v_accvgpr_read_b32 v184, a68
v_accvgpr_read_b32 v185, a69
v_accvgpr_read_b32 v186, a70
v_accvgpr_read_b32 v187, a71
v_accvgpr_read_b32 v188, a84
v_accvgpr_read_b32 v189, a85
v_accvgpr_read_b32 v190, a86
v_accvgpr_read_b32 v191, a87
M v[24:27], a[112:115], v[176:179], v[24:27]
buffer_store_dwordx4 v[176:179], v1, s[16:19], s38 offen offset:1024 sc1
v_pk_mul_f32 v[184:185], v[184:185], v[8:9] op_sel:[0,1] op_sel_hi:[1,1]
v_pk_mul_f32 v[186:187], v[186:187], v[8:9] op_sel:[0,1] op_sel_hi:[1,1]
v_pk_mul_f32 v[188:189], v[188:189], v[8:9] op_sel:[0,1] op_sel_hi:[1,1]
v_pk_mul_f32 v[190:191], v[190:191], v[8:9] op_sel:[0,1] op_sel_hi:[1,1]
v_cvt_pk_bf16_f32 v184, v184, v185
v_cvt_pk_bf16_f32 v185, v186, v187
v_cvt_pk_bf16_f32 v186, v188, v189
v_cvt_pk_bf16_f32 v187, v190, v191
v_accvgpr_read_b32 v208, a72
v_accvgpr_read_b32 v209, a73
v_accvgpr_read_b32 v210, a74
v_accvgpr_read_b32 v211, a75
v_accvgpr_read_b32 v212, a88
v_accvgpr_read_b32 v213, a89
v_accvgpr_read_b32 v214, a90
v_accvgpr_read_b32 v215, a91
M v[24:27], a[112:115], v[184:187], v[24:27]
buffer_store_dwordx4 v[184:187], v1, s[16:19], s38 offen offset:3072 sc1
v_pk_mul_f32 v[208:209], v[208:209], v[10:11] op_sel:[0,0] op_sel_hi:[1,0]
v_pk_mul_f32 v[210:211], v[210:211], v[10:11] op_sel:[0,0] op_sel_hi:[1,0]
v_pk_mul_f32 v[212:213], v[212:213], v[10:11] op_sel:[0,0] op_sel_hi:[1,0]
v_pk_mul_f32 v[214:215], v[214:215], v[10:11] op_sel:[0,0] op_sel_hi:[1,0]
v_cvt_pk_bf16_f32 v208, v208, v209
v_cvt_pk_bf16_f32 v209, v210, v211
v_cvt_pk_bf16_f32 v210, v212, v213
v_cvt_pk_bf16_f32 v211, v214, v215
v_accvgpr_read_b32 v216, a76
v_accvgpr_read_b32 v217, a77
v_accvgpr_read_b32 v218, a78
v_accvgpr_read_b32 v219, a79
v_accvgpr_read_b32 v220, a92
v_accvgpr_read_b32 v221, a93
v_accvgpr_read_b32 v222, a94
v_accvgpr_read_b32 v223, a95
M v[24:27], a[112:115], v[208:211], v[24:27]
buffer_store_dwordx4 v[208:211], v1, s[16:19], s39 offen offset:1024 sc1
v_pk_mul_f32 v[216:217], v[216:217], v[10:11] op_sel:[0,1] op_sel_hi:[1,1]
v_pk_mul_f32 v[218:219], v[218:219], v[10:11] op_sel:[0,1] op_sel_hi:[1,1]
v_pk_mul_f32 v[220:221], v[220:221], v[10:11] op_sel:[0,1] op_sel_hi:[1,1]
v_pk_mul_f32 v[222:223], v[222:223], v[10:11] op_sel:[0,1] op_sel_hi:[1,1]
v_cvt_pk_bf16_f32 v216, v216, v217
v_cvt_pk_bf16_f32 v217, v218, v219
v_cvt_pk_bf16_f32 v218, v220, v221
v_cvt_pk_bf16_f32 v219, v222, v223
s_nop 1
M v[24:27], a[112:115], v[216:219], v[24:27]
buffer_store_dwordx4 v[216:219], v1, s[16:19], s39 offen offset:3072 sc1
v_cmp_lt_u32 vcc, 0x3c000000, v12
s_nop 5
v_cmp_class_f32 s[40:41], v24, s64
s_nop 0
s_or_b64 vcc, vcc, s[40:41]
s_cmp_lg_u64 vcc, 0
s_cselect_b32 s33, 1, 0
s_or_b32 s60, s60, s33
s_sub_u32 s30, 7, s21
s_cmp_lg_u32 s30, 0
s_cbranch_scc1 Lk2_b0
s_and_b32 s3, s2, 3
s_lshl_b32 s3, s3, 2
s_bfe_u32 s27, s2, 0x20003
s_add_u32 s27, s3, s27
s_lshl_b32 s43, s27, 8
s_add_u32 s43, s43, 16789504
v_lshlrev_b32 v15, 2, v0
buffer_load_dword v7, v15, s[52:55], s43 offen sc1
s_waitcnt lgkmcnt(7)
ds_read_b128 a[116:119], v5 offset:36864
s_waitcnt lgkmcnt(7)
ds_read_b128 a[120:123], v5 offset:45056
s_waitcnt lgkmcnt(7)
ds_read_b128 a[124:127], v5 offset:37888
s_waitcnt lgkmcnt(7)
ds_read_b128 a[128:131], v5 offset:46080
s_waitcnt lgkmcnt(7)
ds_read_b128 a[132:135], v5 offset:38912
s_waitcnt lgkmcnt(7)
ds_read_b128 a[136:139], v5 offset:47104
s_waitcnt lgkmcnt(7)
ds_read_b128 a[140:143], v5 offset:39936
s_waitcnt lgkmcnt(7)
ds_read_b128 a[144:147], v5 offset:48128
s_lshl_b32 s33, s23, 14
s_add_u32 s34, s33, 98304
s_add_u32 s33, s33, 131072
v_add_u32 v2, s34, v1
v_add_u32 v3, s33, v1
v_exp_f32 v64, v64
v_exp_f32 v65, v65
v_exp_f32 v66, v66
v_exp_f32 v67, v67
v_exp_f32 v80, v80
v_exp_f32 v81, v81
v_exp_f32 v82, v82
v_exp_f32 v83, v83
v_cvt_pk_bf16_f32 v64, v64, v65
v_cvt_pk_bf16_f32 v65, v66, v67
v_exp_f32 v68, v68
v_exp_f32 v69, v69
v_exp_f32 v70, v70
v_exp_f32 v71, v71
v_cvt_pk_bf16_f32 v66, v80, v81
v_cvt_pk_bf16_f32 v67, v82, v83
v_exp_f32 v84, v84
v_exp_f32 v85, v85
v_exp_f32 v86, v86
v_exp_f32 v87, v87
v_cvt_pk_bf16_f32 v68, v68, v69
v_cvt_pk_bf16_f32 v69, v70, v71
v_exp_f32 v72, v72
v_exp_f32 v73, v73
v_exp_f32 v74, v74
v_exp_f32 v75, v75
v_cvt_pk_bf16_f32 v70, v84, v85
v_cvt_pk_bf16_f32 v71, v86, v87
v_exp_f32 v88, v88
v_exp_f32 v89, v89
v_exp_f32 v90, v90
v_exp_f32 v91, v91
v_cvt_pk_bf16_f32 v72, v72, v73
v_cvt_pk_bf16_f32 v73, v74, v75
v_exp_f32 v76, v76
v_exp_f32 v77, v77
v_exp_f32 v78, v78
v_exp_f32 v79, v79
v_cvt_pk_bf16_f32 v74, v88, v89
v_cvt_pk_bf16_f32 v75, v90, v91
v_exp_f32 v92, v92
v_exp_f32 v93, v93
v_exp_f32 v94, v94
v_exp_f32 v95, v95
v_cvt_pk_bf16_f32 v76, v76, v77
v_cvt_pk_bf16_f32 v77, v78, v79
v_cvt_pk_bf16_f32 v78, v92, v93
v_cvt_pk_bf16_f32 v79, v94, v95
s_waitcnt lgkmcnt(6)
M v[224:227], a[116:119], v[32:35], 0
M v[224:227], a[120:123], v[64:67], v[224:227]
ds_read_b128 a[148:151], v5 offset:32768
ds_read_b128 a[152:155], v5 offset:40960
s_mov_b32 s61, 0
M v[228:231], a[120:123], v[68:71], 0
M v[228:231], a[116:119], v[36:39], v[228:231]
s_bfe_u32 s3, s2, 0x10002
M v[232:235], a[116:119], v[40:43], 0
M v[232:235], a[120:123], v[72:75], v[232:235]
s_lshl_b32 s3, s3, 3
M v[236:239], a[120:123], v[76:79], 0
M v[236:239], a[116:119], v[44:47], v[236:239]
s_waitcnt lgkmcnt(6)
s_lshr_b32 s28, s2, 5
M a[96:99], a[112:115], v[32:35], 0
M a[96:99], a[112:115], v[64:67], a[96:99]
M v[240:243], a[124:127], v[32:35], 0
M v[240:243], a[128:131], v[64:67], v[240:243]
ds_read_b128 a[156:159], v5 offset:33792
ds_read_b128 a[160:163], v5 offset:41984
s_add_u32 s28, s3, s28
M v[244:247], a[128:131], v[68:71], 0
s_lshl_b32 s25, s27, 18
M v[244:247], a[124:127], v[36:39], v[244:247]
M v[248:251], a[124:127], v[40:43], 0
s_lshl_b32 s3, s101, 12
M v[248:251], a[128:131], v[72:75], v[248:251]
M v[252:255], a[128:131], v[76:79], 0
s_add_u32 s25, s25, s3
M v[252:255], a[124:127], v[44:47], v[252:255]
s_waitcnt lgkmcnt(6)
M a[100:103], a[112:115], v[36:39], 0
M a[100:103], a[112:115], v[68:71], a[100:103]
M a[64:67], a[132:135], v[32:35], 0
s_lshl_b32 s26, s28, 7
M a[64:67], a[136:139], v[64:67], a[64:67]
ds_read_b128 a[164:167], v5 offset:34816
ds_read_b128 a[168:171], v5 offset:43008
M a[68:71], a[136:139], v[68:71], 0
s_lshl_b32 s42, s101, 11
M a[68:71], a[132:135], v[36:39], a[68:71]
M a[72:75], a[132:135], v[40:43], 0
s_add_u32 s44, s4, 83886080
s_addc_u32 s45, s5, 0
M a[72:75], a[136:139], v[72:75], a[72:75]
s_mov_b32 s46, 4194304
M a[76:79], a[136:139], v[76:79], 0
M a[76:79], a[132:135], v[44:47], a[76:79]
s_waitcnt lgkmcnt(6)
s_mov_b32 s47, 0x00020000
M a[104:107], a[112:115], v[40:43], 0
M a[104:107], a[112:115], v[72:75], a[104:107]
M a[80:83], a[140:143], v[32:35], 0
M a[80:83], a[144:147], v[64:67], a[80:83]
ds_read_b128 a[172:175], v5 offset:35840
ds_read_b128 a[176:179], v5 offset:44032
s_mov_b32 s50, 2097152
M a[84:87], a[144:147], v[68:71], 0
M a[84:87], a[140:143], v[36:39], a[84:87]
s_mov_b32 s51, 0x00020000
M a[88:91], a[140:143], v[40:43], 0
M a[88:91], a[144:147], v[72:75], a[88:91]
s_lshl_b32 s3, s101, 4
M a[92:95], a[144:147], v[76:79], 0
M a[92:95], a[140:143], v[44:47], a[92:95]
s_waitcnt lgkmcnt(6)
v_lshrrev_b32 v96, 3, v0
M a[108:111], a[112:115], v[44:47], 0
M a[108:111], a[112:115], v[76:79], a[108:111]
M v[160:163], a[148:151], v[32:35], 0
v_and_b32 v97, 6, v96
M v[160:163], a[152:155], v[64:67], v[160:163]
M v[164:167], a[152:155], v[68:71], 0
ds_write_b128 v2, v[224:227] offset:0
v_and_b32 v98, 7, v0
M v[164:167], a[148:151], v[36:39], v[164:167]
M v[168:171], a[148:151], v[40:43], 0
ds_write_b128 v2, v[228:231] offset:1024
v_xor_b32 v97, v97, v98
M v[168:171], a[152:155], v[72:75], v[168:171]
M v[172:175], a[152:155], v[76:79], 0
ds_write_b128 v2, v[232:235] offset:2048
v_add_u32 v96, s3, v96
M v[172:175], a[148:151], v[44:47], v[172:175]
s_waitcnt lgkmcnt(7)
M v[176:179], a[156:159], v[32:35], 0
ds_write_b128 v2, v[236:239] offset:3072
v_lshlrev_b32 v96, 11, v96
M v[176:179], a[160:163], v[64:67], v[176:179]
M v[180:183], a[160:163], v[68:71], 0
ds_write_b128 v2, v[240:243] offset:4096
v_lshl_add_u32 v99, v97, 4, v96
M v[180:183], a[156:159], v[36:39], v[180:183]
v_add_u32 v100, 15360, v99
M v[184:187], a[156:159], v[40:43], 0
ds_write_b128 v2, v[244:247] offset:5120
M v[184:187], a[160:163], v[72:75], v[184:187]
s_waitcnt vmcnt(0) lgkmcnt(0)
s_barrier
M v[188:191], a[160:163], v[76:79], 0
ds_write_b128 v2, v[248:251] offset:6144
v_cmp_ne_u32 vcc, 1, v7
s_nop 0
s_cbranch_vccnz Lk3_spinb0
Lk3_gotb0:
M v[188:191], a[156:159], v[44:47], v[188:191]
s_add_u32 m0, s42, 16384
s_nop 0
buffer_load_dwordx4 v99, s[48:51], s26 offen offset:0 lds
M v[192:195], a[164:167], v[32:35], 0
ds_write_b128 v2, v[252:255] offset:7168
buffer_load_dwordx4 v100, s[48:51], s26 offen offset:1024 lds
M v[192:195], a[168:171], v[64:67], v[192:195]
M v[196:199], a[168:171], v[68:71], 0
ds_write_b128 v2, a[64:67] offset:8192
buffer_load_dwordx4 a[192:195], v1, s[44:47], s25 offen offset:0 sc1
M v[196:199], a[164:167], v[36:39], v[196:199]
buffer_load_dwordx4 a[196:199], v1, s[44:47], s25 offen offset:1024 sc1
M v[200:203], a[164:167], v[40:43], 0
ds_write_b128 v2, a[68:71] offset:9216
buffer_load_dwordx4 a[200:203], v1, s[44:47], s25 offen offset:2048 sc1
M v[200:203], a[168:171], v[72:75], v[200:203]
buffer_load_dwordx4 a[204:207], v1, s[44:47], s25 offen offset:3072 sc1
M v[204:207], a[168:171], v[76:79], 0
ds_write_b128 v2, a[72:75] offset:10240
M v[204:207], a[164:167], v[44:47], v[204:207]
s_add_u32 s25, s25, 16384
s_add_u32 s26, s26, 131072
M v[208:211], a[172:175], v[32:35], 0
ds_write_b128 v2, a[76:79] offset:11264
s_add_u32 m0, s42, 32768
s_nop 0
buffer_load_dwordx4 v99, s[48:51], s26 offen offset:0 lds
M v[208:211], a[176:179], v[64:67], v[208:211]
buffer_load_dwordx4 v100, s[48:51], s26 offen offset:1024 lds
M v[212:215], a[176:179], v[68:71], 0
ds_write_b128 v2, a[80:83] offset:12288
buffer_load_dwordx4 a[224:227], v1, s[44:47], s25 offen offset:0 sc1
M v[212:215], a[172:175], v[36:39], v[212:215]
M v[216:219], a[172:175], v[40:43], 0
ds_write_b128 v2, a[84:87] offset:13312
buffer_load_dwordx4 a[228:231], v1, s[44:47], s25 offen offset:1024 sc1
M v[216:219], a[176:179], v[72:75], v[216:219]
buffer_load_dwordx4 a[232:235], v1, s[44:47], s25 offen offset:2048 sc1
M v[220:223], a[176:179], v[76:79], 0
ds_write_b128 v2, a[88:91] offset:14336
buffer_load_dwordx4 a[236:239], v1, s[44:47], s25 offen offset:3072 sc1
M v[220:223], a[172:175], v[44:47], v[220:223]
s_add_u32 s25, s25, 16384
s_add_u32 s26, s26, 131072
ds_write_b128 v2, a[92:95] offset:15360
s_waitcnt lgkmcnt(0)
s_branch Lk2_merge
Lk2_b0:
s_add_u32 m0, s29, 65536
s_waitcnt lgkmcnt(4)
M v[96:99], a[116:119], a[180:183], 0
v_exp_f32 v64, v64
M v[96:99], a[120:123], a[184:187], v[96:99]
ds_read_b128 a[148:151], v2 offset:8192
ds_read_b128 a[152:155], v2 offset:9216
M v[96:99], a[124:127], a[188:191], v[96:99]
v_exp_f32 v65, v65
M v[96:99], a[128:131], a[192:195], v[96:99]
buffer_load_dwordx4 v1, s[12:15], s25 offen offset:0 sc1 lds
s_add_u32 s32, s25, 4096
M v[100:103], a[128:131], a[208:211], 0
v_exp_f32 v66, v66
M v[100:103], a[124:127], a[204:207], v[100:103]
v_cvt_pk_bf16_f32 v64, v64, v65
M v[100:103], a[120:123], a[200:203], v[100:103]
v_exp_f32 v67, v67
M v[100:103], a[116:119], a[196:199], v[100:103]
buffer_load_dwordx4 v1, s[12:15], s25 offen offset:1024 sc1 lds
M v[104:107], a[116:119], a[212:215], 0
v_exp_f32 v80, v80
M v[104:107], a[120:123], a[216:219], v[104:107]
ds_read_b128 a[156:159], v2 offset:10240
ds_read_b128 a[160:163], v2 offset:11264
M v[104:107], a[124:127], a[220:223], v[104:107]
v_exp_f32 v81, v81
M v[104:107], a[128:131], a[224:227], v[104:107]
buffer_load_dwordx4 v1, s[12:15], s25 offen offset:2048 sc1 lds
M v[108:111], a[128:131], a[240:243], 0
v_exp_f32 v82, v82
M v[108:111], a[124:127], a[236:239], v[108:111]
v_cvt_pk_bf16_f32 v65, v66, v67
v_cvt_pk_bf16_f32 v66, v80, v81
M v[108:111], a[120:123], a[232:235], v[108:111]
v_exp_f32 v83, v83
M v[108:111], a[116:119], a[228:231], v[108:111]
buffer_load_dwordx4 v1, s[12:15], s25 offen offset:3072 sc1 lds
s_add_u32 m0, s29, 69632
s_waitcnt lgkmcnt(4)
M v[112:115], a[132:135], a[180:183], 0
v_exp_f32 v68, v68
M v[112:115], a[136:139], a[184:187], v[112:115]
ds_read_b128 a[164:167], v2 offset:12288
ds_read_b128 a[168:171], v2 offset:13312
M v[112:115], a[140:143], a[188:191], v[112:115]
v_exp_f32 v69, v69
M v[112:115], a[144:147], a[192:195], v[112:115]
buffer_load_dwordx4 v1, s[12:15], s32 offen offset:0 sc1 lds
M v[116:119], a[144:147], a[208:211], 0
v_exp_f32 v70, v70
M v[116:119], a[140:143], a[204:207], v[116:119]
v_cvt_pk_bf16_f32 v67, v82, v83
v_cvt_pk_bf16_f32 v68, v68, v69
M v[116:119], a[136:139], a[200:203], v[116:119]
v_exp_f32 v71, v71
M v[116:119], a[132:135], a[196:199], v[116:119]
buffer_load_dwordx4 v1, s[12:15], s32 offen offset:1024 sc1 lds
M v[120:123], a[132:135], a[212:215], 0
v_exp_f32 v84, v84
M v[120:123], a[136:139], a[216:219], v[120:123]
ds_read_b128 a[172:175], v2 offset:14336
ds_read_b128 a[176:179], v2 offset:15360
M v[120:123], a[140:143], a[220:223], v[120:123]
v_exp_f32 v85, v85
M v[120:123], a[144:147], a[224:227], v[120:123]
buffer_load_dwordx4 v1, s[12:15], s32 offen offset:2048 sc1 lds
M v[124:127], a[144:147], a[240:243], 0
v_exp_f32 v86, v86
M v[124:127], a[140:143], a[236:239], v[124:127]
v_cvt_pk_bf16_f32 v69, v70, v71
v_cvt_pk_bf16_f32 v70, v84, v85
M v[124:127], a[136:139], a[232:235], v[124:127]
v_exp_f32 v87, v87
M v[124:127], a[132:135], a[228:231], v[124:127]
buffer_load_dwordx4 v1, s[12:15], s32 offen offset:3072 sc1 lds
s_add_u32 m0, s29, 98304
s_waitcnt lgkmcnt(4)
M v[128:131], a[148:151], a[180:183], 0
v_exp_f32 v72, v72
M v[128:131], a[152:155], a[184:187], v[128:131]
ds_read_b128 a[116:119], v5 offset:32768
ds_read_b128 a[120:123], v5 offset:40960
M v[128:131], a[156:159], a[188:191], v[128:131]
v_exp_f32 v73, v73
M v[128:131], a[160:163], a[192:195], v[128:131]
buffer_load_dwordx4 v1, s[12:15], s26 offen offset:0 sc1 lds
s_add_u32 s43, s26, 4096
M v[132:135], a[160:163], a[208:211], 0
v_exp_f32 v74, v74
M v[132:135], a[156:159], a[204:207], v[132:135]
v_cvt_pk_bf16_f32 v71, v86, v87
v_cvt_pk_bf16_f32 v72, v72, v73
M v[132:135], a[152:155], a[200:203], v[132:135]
v_exp_f32 v75, v75
M v[132:135], a[148:151], a[196:199], v[132:135]
buffer_load_dwordx4 v1, s[12:15], s26 offen offset:1024 sc1 lds
M v[136:139], a[148:151], a[212:215], 0
v_exp_f32 v88, v88
M v[136:139], a[152:155], a[216:219], v[136:139]
ds_read_b128 a[124:127], v5 offset:33792
ds_read_b128 a[128:131], v5 offset:41984
M v[136:139], a[156:159], a[220:223], v[136:139]
v_exp_f32 v89, v89
M v[136:139], a[160:163], a[224:227], v[136:139]
buffer_load_dwordx4 v1, s[12:15], s26 offen offset:2048 sc1 lds
M v[140:143], a[160:163], a[240:243], 0
v_exp_f32 v90, v90
M v[140:143], a[156:159], a[236:239], v[140:143]
v_cvt_pk_bf16_f32 v73, v74, v75
v_cvt_pk_bf16_f32 v74, v88, v89
M v[140:143], a[152:155], a[232:235], v[140:143]
v_exp_f32 v91, v91
M v[140:143], a[148:151], a[228:231], v[140:143]
buffer_load_dwordx4 v1, s[12:15], s26 offen offset:3072 sc1 lds
s_add_u32 m0, s29, 102400
s_waitcnt lgkmcnt(4)
M v[144:147], a[164:167], a[180:183], 0
v_exp_f32 v76, v76
M v[144:147], a[168:171], a[184:187], v[144:147]
ds_read_b128 a[132:135], v5 offset:34816
ds_read_b128 a[136:139], v5 offset:43008
M v[144:147], a[172:175], a[188:191], v[144:147]
v_exp_f32 v77, v77
M v[144:147], a[176:179], a[192:195], v[144:147]
buffer_load_dwordx4 v1, s[12:15], s43 offen offset:0 sc1 lds
M v[148:151], a[176:179], a[208:211], 0
v_exp_f32 v78, v78
M v[148:151], a[172:175], a[204:207], v[148:151]
v_cvt_pk_bf16_f32 v75, v90, v91
v_cvt_pk_bf16_f32 v76, v76, v77
M v[148:151], a[168:171], a[200:203], v[148:151]
v_exp_f32 v79, v79
M v[148:151], a[164:167], a[196:199], v[148:151]
buffer_load_dwordx4 v1, s[12:15], s43 offen offset:1024 sc1 lds
M v[152:155], a[164:167], a[212:215], 0
v_exp_f32 v92, v92
M v[152:155], a[168:171], a[216:219], v[152:155]
ds_read_b128 a[140:143], v5 offset:35840
ds_read_b128 a[144:147], v5 offset:44032
M v[152:155], a[172:175], a[220:223], v[152:155]
v_exp_f32 v93, v93
M v[152:155], a[176:179], a[224:227], v[152:155]
buffer_load_dwordx4 v1, s[12:15], s43 offen offset:2048 sc1 lds
M v[156:159], a[176:179], a[240:243], 0
v_exp_f32 v94, v94
M v[156:159], a[172:175], a[236:239], v[156:159]
v_cvt_pk_bf16_f32 v77, v78, v79
v_cvt_pk_bf16_f32 v78, v92, v93
M v[156:159], a[168:171], a[232:235], v[156:159]
v_exp_f32 v95, v95
M v[156:159], a[164:167], a[228:231], v[156:159]
buffer_load_dwordx4 v1, s[12:15], s43 offen offset:3072 sc1 lds
v_cvt_pk_bf16_f32 v79, v94, v95
s_waitcnt lgkmcnt(6)
M v[160:163], a[116:119], v[32:35], 0
v_exp_f32 v96, v96
M v[160:163], a[120:123], v[64:67], v[160:163]
ds_read_b128 a[148:151], v5 offset:36864
ds_read_b128 a[152:155], v5 offset:45056
M v[164:167], a[120:123], v[68:71], 0
v_exp_f32 v97, v97
M v[164:167], a[116:119], v[36:39], v[164:167]
v_cvt_pk_bf16_f32 v96, v96, v97
M v[168:171], a[116:119], v[40:43], 0
v_exp_f32 v98, v98
M v[168:171], a[120:123], v[72:75], v[168:171]
s_add_u32 s25, s25, 32768
s_cmp_eq_u32 s25, s27
M v[172:175], a[120:123], v[76:79], 0
v_exp_f32 v99, v99
M v[172:175], a[116:119], v[44:47], v[172:175]
v_cvt_pk_bf16_f32 v97, v98, v99
s_waitcnt lgkmcnt(6)
M a[96:99], a[112:115], v[32:35], 0
s_cselect_b32 s25, s28, s25
s_cselect_b32 s27, -1, s27
M a[96:99], a[112:115], v[64:67], a[96:99]
s_add_u32 s26, s26, 32768
s_cmp_eq_u32 s26, s62
M v[176:179], a[124:127], v[32:35], 0
v_exp_f32 v112, v112
M v[176:179], a[128:131], v[64:67], v[176:179]
ds_read_b128 a[156:159], v5 offset:37888
ds_read_b128 a[160:163], v5 offset:46080
M v[180:183], a[128:131], v[68:71], 0
v_exp_f32 v113, v113
M v[180:183], a[124:127], v[36:39], v[180:183]
v_cvt_pk_bf16_f32 v98, v112, v113
M v[184:187], a[124:127], v[40:43], 0
v_exp_f32 v114, v114
M v[184:187], a[128:131], v[72:75], v[184:187]
s_cselect_b32 s26, s63, s26
s_cselect_b32 s62, -1, s62
M v[188:191], a[128:131], v[76:79], 0
v_exp_f32 v115, v115
M v[188:191], a[124:127], v[44:47], v[188:191]
v_cvt_pk_bf16_f32 v99, v114, v115
s_waitcnt lgkmcnt(6)
M a[100:103], a[112:115], v[36:39], 0
M a[100:103], a[112:115], v[68:71], a[100:103]
M v[192:195], a[132:135], v[32:35], 0
v_exp_f32 v100, v100
M v[192:195], a[136:139], v[64:67], v[192:195]
ds_read_b128 a[164:167], v5 offset:38912
ds_read_b128 a[168:171], v5 offset:47104
M v[196:199], a[136:139], v[68:71], 0
v_exp_f32 v101, v101
M v[196:199], a[132:135], v[36:39], v[196:199]
v_cvt_pk_bf16_f32 v100, v100, v101
M v[200:203], a[132:135], v[40:43], 0
v_exp_f32 v102, v102
M v[200:203], a[136:139], v[72:75], v[200:203]
M v[204:207], a[136:139], v[76:79], 0
v_exp_f32 v103, v103
M v[204:207], a[132:135], v[44:47], v[204:207]
v_cvt_pk_bf16_f32 v101, v102, v103
s_waitcnt lgkmcnt(6)
M a[104:107], a[112:115], v[40:43], 0
M a[104:107], a[112:115], v[72:75], a[104:107]
M v[208:211], a[140:143], v[32:35], 0
v_exp_f32 v116, v116
M v[208:211], a[144:147], v[64:67], v[208:211]
ds_read_b128 a[172:175], v5 offset:39936
ds_read_b128 a[176:179], v5 offset:48128
M v[212:215], a[144:147], v[68:71], 0
v_exp_f32 v117, v117
M v[212:215], a[140:143], v[36:39], v[212:215]
v_cvt_pk_bf16_f32 v102, v116, v117
M v[216:219], a[140:143], v[40:43], 0
v_exp_f32 v118, v118
M v[216:219], a[144:147], v[72:75], v[216:219]
M v[220:223], a[144:147], v[76:79], 0
v_exp_f32 v119, v119
M v[220:223], a[140:143], v[44:47], v[220:223]
v_cvt_pk_bf16_f32 v103, v118, v119
s_waitcnt lgkmcnt(6)
M a[108:111], a[112:115], v[44:47], 0
M a[108:111], a[112:115], v[76:79], a[108:111]
M v[224:227], a[148:151], v[32:35], 0
v_exp_f32 v104, v104
M v[224:227], a[152:155], v[64:67], v[224:227]
M v[228:231], a[152:155], v[68:71], 0
v_exp_f32 v105, v105
M v[228:231], a[148:151], v[36:39], v[228:231]
v_cvt_pk_bf16_f32 v104, v104, v105
M v[232:235], a[148:151], v[40:43], 0
v_exp_f32 v106, v106
M v[232:235], a[152:155], v[72:75], v[232:235]
M v[236:239], a[152:155], v[76:79], 0
v_exp_f32 v107, v107
M v[236:239], a[148:151], v[44:47], v[236:239]
v_cvt_pk_bf16_f32 v105, v106, v107
s_waitcnt lgkmcnt(4)
M v[240:243], a[156:159], v[32:35], 0
v_exp_f32 v120, v120
M v[240:243], a[160:163], v[64:67], v[240:243]
M v[244:247], a[160:163], v[68:71], 0
v_exp_f32 v121, v121
M v[244:247], a[156:159], v[36:39], v[244:247]
v_cvt_pk_bf16_f32 v106, v120, v121
M v[248:251], a[156:159], v[40:43], 0
v_exp_f32 v122, v122
M v[248:251], a[160:163], v[72:75], v[248:251]
s_waitcnt vmcnt(0) lgkmcnt(0)
s_barrier
ds_read_b128 a[116:119], v3 offset:0
ds_read_b128 a[120:123], v3 offset:1024
M v[252:255], a[160:163], v[76:79], 0
v_exp_f32 v123, v123
M v[252:255], a[156:159], v[44:47], v[252:255]
v_cvt_pk_bf16_f32 v107, v122, v123
M a[64:67], a[164:167], v[32:35], 0
v_exp_f32 v108, v108
M a[64:67], a[168:171], v[64:67], a[64:67]
ds_read_b128 a[124:127], v3 offset:2048
ds_read_b128 a[128:131], v3 offset:3072
M a[68:71], a[168:171], v[68:71], 0
v_exp_f32 v109, v109
M a[68:71], a[164:167], v[36:39], a[68:71]
v_cvt_pk_bf16_f32 v108, v108, v109
M a[72:75], a[164:167], v[40:43], 0
v_exp_f32 v110, v110
M a[72:75], a[168:171], v[72:75], a[72:75]
ds_read_b128 a[132:135], v3 offset:4096
ds_read_b128 a[136:139], v3 offset:5120
M a[76:79], a[168:171], v[76:79], 0
v_exp_f32 v111, v111
M a[76:79], a[164:167], v[44:47], a[76:79]
v_cvt_pk_bf16_f32 v109, v110, v111
M a[80:83], a[172:175], v[32:35], 0
v_exp_f32 v124, v124
M a[80:83], a[176:179], v[64:67], a[80:83]
ds_read_b128 a[140:143], v3 offset:6144
ds_read_b128 a[144:147], v3 offset:7168
M a[84:87], a[176:179], v[68:71], 0
v_exp_f32 v125, v125
M a[84:87], a[172:175], v[36:39], a[84:87]
v_cvt_pk_bf16_f32 v110, v124, v125
M a[88:91], a[172:175], v[40:43], 0
v_exp_f32 v126, v126
M a[88:91], a[176:179], v[72:75], a[88:91]
M a[92:95], a[176:179], v[76:79], 0
v_exp_f32 v127, v127
M a[92:95], a[172:175], v[44:47], a[92:95]
v_cvt_pk_bf16_f32 v111, v126, v127
s_branch Lk2_l2b
Lk2_l2:
s_add_u32 m0, s29, 65536
s_waitcnt lgkmcnt(4)
M v[96:99], a[116:119], a[180:183], 0
v_exp_f32 v64, v64
M v[96:99], a[120:123], a[184:187], v[96:99]
ds_read_b128 a[148:151], v2 offset:8192
ds_read_b128 a[152:155], v2 offset:9216
M v[96:99], a[124:127], a[188:191], v[96:99]
v_exp_f32 v65, v65
M v[96:99], a[128:131], a[192:195], v[96:99]
buffer_load_dwordx4 v1, s[12:15], s25 offen offset:0 sc1 lds
s_add_u32 s32, s25, 4096
M v[100:103], a[128:131], a[208:211], 0
v_exp_f32 v66, v66
M v[100:103], a[124:127], a[204:207], v[100:103]
v_cvt_pk_bf16_f32 v64, v64, v65
M v[100:103], a[120:123], a[200:203], v[100:103]
v_exp_f32 v67, v67
M v[100:103], a[116:119], a[196:199], v[100:103]
buffer_load_dwordx4 v1, s[12:15], s25 offen offset:1024 sc1 lds
M v[104:107], a[116:119], a[212:215], 0
v_exp_f32 v80, v80
M v[104:107], a[120:123], a[216:219], v[104:107]
ds_read_b128 a[156:159], v2 offset:10240
ds_read_b128 a[160:163], v2 offset:11264
M v[104:107], a[124:127], a[220:223], v[104:107]
v_exp_f32 v81, v81
M v[104:107], a[128:131], a[224:227], v[104:107]
buffer_load_dwordx4 v1, s[12:15], s25 offen offset:2048 sc1 lds
M v[108:111], a[128:131], a[240:243], 0
v_exp_f32 v82, v82
M v[108:111], a[124:127], a[236:239], v[108:111]
v_cvt_pk_bf16_f32 v65, v66, v67
v_cvt_pk_bf16_f32 v66, v80, v81
M v[108:111], a[120:123], a[232:235], v[108:111]
v_exp_f32 v83, v83
M v[108:111], a[116:119], a[228:231], v[108:111]
buffer_load_dwordx4 v1, s[12:15], s25 offen offset:3072 sc1 lds
s_add_u32 m0, s29, 69632
s_waitcnt lgkmcnt(4)
M v[112:115], a[132:135], a[180:183], 0
v_exp_f32 v68, v68
M v[112:115], a[136:139], a[184:187], v[112:115]
ds_read_b128 a[164:167], v2 offset:12288
ds_read_b128 a[168:171], v2 offset:13312
M v[112:115], a[140:143], a[188:191], v[112:115]
v_exp_f32 v69, v69
M v[112:115], a[144:147], a[192:195], v[112:115]
buffer_load_dwordx4 v1, s[12:15], s32 offen offset:0 sc1 lds
M v[116:119], a[144:147], a[208:211], 0
v_exp_f32 v70, v70
M v[116:119], a[140:143], a[204:207], v[116:119]
v_cvt_pk_bf16_f32 v67, v82, v83
v_cvt_pk_bf16_f32 v68, v68, v69
M v[116:119], a[136:139], a[200:203], v[116:119]
v_exp_f32 v71, v71
M v[116:119], a[132:135], a[196:199], v[116:119]
buffer_load_dwordx4 v1, s[12:15], s32 offen offset:1024 sc1 lds
M v[120:123], a[132:135], a[212:215], 0
v_exp_f32 v84, v84
M v[120:123], a[136:139], a[216:219], v[120:123]
ds_read_b128 a[172:175], v2 offset:14336
ds_read_b128 a[176:179], v2 offset:15360
M v[120:123], a[140:143], a[220:223], v[120:123]
v_exp_f32 v85, v85
M v[120:123], a[144:147], a[224:227], v[120:123]
buffer_load_dwordx4 v1, s[12:15], s32 offen offset:2048 sc1 lds
M v[124:127], a[144:147], a[240:243], 0
v_exp_f32 v86, v86
M v[124:127], a[140:143], a[236:239], v[124:127]
v_cvt_pk_bf16_f32 v69, v70, v71
v_cvt_pk_bf16_f32 v70, v84, v85
M v[124:127], a[136:139], a[232:235], v[124:127]
v_exp_f32 v87, v87
M v[124:127], a[132:135], a[228:231], v[124:127]
buffer_load_dwordx4 v1, s[12:15], s32 offen offset:3072 sc1 lds
s_add_u32 m0, s29, 98304
s_waitcnt lgkmcnt(4)
M v[128:131], a[148:151], a[180:183], 0
v_exp_f32 v72, v72
M v[128:131], a[152:155], a[184:187], v[128:131]
ds_read_b128 a[116:119], v5 offset:32768
ds_read_b128 a[120:123], v5 offset:40960
M v[128:131], a[156:159], a[188:191], v[128:131]
v_exp_f32 v73, v73
M v[128:131], a[160:163], a[192:195], v[128:131]
buffer_load_dwordx4 v1, s[12:15], s26 offen offset:0 sc1 lds
s_add_u32 s43, s26, 4096
M v[132:135], a[160:163], a[208:211], 0
v_exp_f32 v74, v74
M v[132:135], a[156:159], a[204:207], v[132:135]
v_cvt_pk_bf16_f32 v71, v86, v87
v_cvt_pk_bf16_f32 v72, v72, v73
M v[132:135], a[152:155], a[200:203], v[132:135]
v_exp_f32 v75, v75
M v[132:135], a[148:151], a[196:199], v[132:135]
buffer_load_dwordx4 v1, s[12:15], s26 offen offset:1024 sc1 lds
M v[136:139], a[148:151], a[212:215], 0
v_exp_f32 v88, v88
M v[136:139], a[152:155], a[216:219], v[136:139]
ds_read_b128 a[124:127], v5 offset:33792
ds_read_b128 a[128:131], v5 offset:41984
M v[136:139], a[156:159], a[220:223], v[136:139]
v_exp_f32 v89, v89
M v[136:139], a[160:163], a[224:227], v[136:139]
buffer_load_dwordx4 v1, s[12:15], s26 offen offset:2048 sc1 lds
M v[140:143], a[160:163], a[240:243], 0
v_exp_f32 v90, v90
M v[140:143], a[156:159], a[236:239], v[140:143]
v_cvt_pk_bf16_f32 v73, v74, v75
v_cvt_pk_bf16_f32 v74, v88, v89
M v[140:143], a[152:155], a[232:235], v[140:143]
v_exp_f32 v91, v91
M v[140:143], a[148:151], a[228:231], v[140:143]
buffer_load_dwordx4 v1, s[12:15], s26 offen offset:3072 sc1 lds
s_add_u32 m0, s29, 102400
s_waitcnt lgkmcnt(4)
M v[144:147], a[164:167], a[180:183], 0
v_exp_f32 v76, v76
M v[144:147], a[168:171], a[184:187], v[144:147]
ds_read_b128 a[132:135], v5 offset:34816
ds_read_b128 a[136:139], v5 offset:43008
M v[144:147], a[172:175], a[188:191], v[144:147]
v_exp_f32 v77, v77
M v[144:147], a[176:179], a[192:195], v[144:147]
buffer_load_dwordx4 v1, s[12:15], s43 offen offset:0 sc1 lds
M v[148:151], a[176:179], a[208:211], 0
v_exp_f32 v78, v78
M v[148:151], a[172:175], a[204:207], v[148:151]
v_cvt_pk_bf16_f32 v75, v90, v91
v_cvt_pk_bf16_f32 v76, v76, v77
M v[148:151], a[168:171], a[200:203], v[148:151]
v_exp_f32 v79, v79
M v[148:151], a[164:167], a[196:199], v[148:151]
buffer_load_dwordx4 v1, s[12:15], s43 offen offset:1024 sc1 lds
M v[152:155], a[164:167], a[212:215], 0
v_exp_f32 v92, v92
M v[152:155], a[168:171], a[216:219], v[152:155]
ds_read_b128 a[140:143], v5 offset:35840
ds_read_b128 a[144:147], v5 offset:44032
M v[152:155], a[172:175], a[220:223], v[152:155]
v_exp_f32 v93, v93
M v[152:155], a[176:179], a[224:227], v[152:155]
buffer_load_dwordx4 v1, s[12:15], s43 offen offset:2048 sc1 lds
M v[156:159], a[176:179], a[240:243], 0
v_exp_f32 v94, v94
M v[156:159], a[172:175], a[236:239], v[156:159]
v_cvt_pk_bf16_f32 v77, v78, v79
v_cvt_pk_bf16_f32 v78, v92, v93
M v[156:159], a[168:171], a[232:235], v[156:159]
v_exp_f32 v95, v95
M v[156:159], a[164:167], a[228:231], v[156:159]
buffer_load_dwordx4 v1, s[12:15], s43 offen offset:3072 sc1 lds
v_cvt_pk_bf16_f32 v79, v94, v95
s_waitcnt lgkmcnt(6)
M v[160:163], a[116:119], v[32:35], v[160:163]
v_exp_f32 v96, v96
M v[160:163], a[120:123], v[64:67], v[160:163]
ds_read_b128 a[148:151], v5 offset:36864
ds_read_b128 a[152:155], v5 offset:45056
M v[164:167], a[120:123], v[68:71], v[164:167]
v_exp_f32 v97, v97
M v[164:167], a[116:119], v[36:39], v[164:167]
v_cvt_pk_bf16_f32 v96, v96, v97
M v[168:171], a[116:119], v[40:43], v[168:171]
v_exp_f32 v98, v98
M v[168:171], a[120:123], v[72:75], v[168:171]
s_add_u32 s25, s25, 32768
s_cmp_eq_u32 s25, s27
M v[172:175], a[120:123], v[76:79], v[172:175]
v_exp_f32 v99, v99
M v[172:175], a[116:119], v[44:47], v[172:175]
v_cvt_pk_bf16_f32 v97, v98, v99
s_waitcnt lgkmcnt(6)
M a[96:99], a[112:115], v[32:35], a[96:99]
s_cselect_b32 s25, s28, s25
s_cselect_b32 s27, -1, s27
M a[96:99], a[112:115], v[64:67], a[96:99]
s_add_u32 s26, s26, 32768
s_cmp_eq_u32 s26, s62
M v[176:179], a[124:127], v[32:35], v[176:179]
v_exp_f32 v112, v112
M v[176:179], a[128:131], v[64:67], v[176:179]
ds_read_b128 a[156:159], v5 offset:37888
ds_read_b128 a[160:163], v5 offset:46080
M v[180:183], a[128:131], v[68:71], v[180:183]
v_exp_f32 v113, v113
M v[180:183], a[124:127], v[36:39], v[180:183]
v_cvt_pk_bf16_f32 v98, v112, v113
M v[184:187], a[124:127], v[40:43], v[184:187]
v_exp_f32 v114, v114
M v[184:187], a[128:131], v[72:75], v[184:187]
s_cselect_b32 s26, s63, s26
s_cselect_b32 s62, -1, s62
M v[188:191], a[128:131], v[76:79], v[188:191]
v_exp_f32 v115, v115
M v[188:191], a[124:127], v[44:47], v[188:191]
v_cvt_pk_bf16_f32 v99, v114, v115
s_waitcnt lgkmcnt(6)
M a[100:103], a[112:115], v[36:39], a[100:103]
M a[100:103], a[112:115], v[68:71], a[100:103]
M v[192:195], a[132:135], v[32:35], v[192:195]
v_exp_f32 v100, v100
M v[192:195], a[136:139], v[64:67], v[192:195]
ds_read_b128 a[164:167], v5 offset:38912
ds_read_b128 a[168:171], v5 offset:47104
M v[196:199], a[136:139], v[68:71], v[196:199]
v_exp_f32 v101, v101
M v[196:199], a[132:135], v[36:39], v[196:199]
v_cvt_pk_bf16_f32 v100, v100, v101
M v[200:203], a[132:135], v[40:43], v[200:203]
v_exp_f32 v102, v102
M v[200:203], a[136:139], v[72:75], v[200:203]
M v[204:207], a[136:139], v[76:79], v[204:207]
v_exp_f32 v103, v103
M v[204:207], a[132:135], v[44:47], v[204:207]
v_cvt_pk_bf16_f32 v101, v102, v103
s_waitcnt lgkmcnt(6)
M a[104:107], a[112:115], v[40:43], a[104:107]
M a[104:107], a[112:115], v[72:75], a[104:107]
M v[208:211], a[140:143], v[32:35], v[208:211]
v_exp_f32 v116, v116
M v[208:211], a[144:147], v[64:67], v[208:211]
ds_read_b128 a[172:175], v5 offset:39936
ds_read_b128 a[176:179], v5 offset:48128
M v[212:215], a[144:147], v[68:71], v[212:215]
v_exp_f32 v117, v117
M v[212:215], a[140:143], v[36:39], v[212:215]
v_cvt_pk_bf16_f32 v102, v116, v117
M v[216:219], a[140:143], v[40:43], v[216:219]
v_exp_f32 v118, v118
M v[216:219], a[144:147], v[72:75], v[216:219]
M v[220:223], a[144:147], v[76:79], v[220:223]
v_exp_f32 v119, v119
M v[220:223], a[140:143], v[44:47], v[220:223]
v_cvt_pk_bf16_f32 v103, v118, v119
s_waitcnt lgkmcnt(6)
M a[108:111], a[112:115], v[44:47], a[108:111]
M a[108:111], a[112:115], v[76:79], a[108:111]
M v[224:227], a[148:151], v[32:35], v[224:227]
v_exp_f32 v104, v104
M v[224:227], a[152:155], v[64:67], v[224:227]
M v[228:231], a[152:155], v[68:71], v[228:231]
v_exp_f32 v105, v105
M v[228:231], a[148:151], v[36:39], v[228:231]
v_cvt_pk_bf16_f32 v104, v104, v105
M v[232:235], a[148:151], v[40:43], v[232:235]
v_exp_f32 v106, v106
M v[232:235], a[152:155], v[72:75], v[232:235]
M v[236:239], a[152:155], v[76:79], v[236:239]
v_exp_f32 v107, v107
M v[236:239], a[148:151], v[44:47], v[236:239]
v_cvt_pk_bf16_f32 v105, v106, v107
s_waitcnt lgkmcnt(4)
M v[240:243], a[156:159], v[32:35], v[240:243]
v_exp_f32 v120, v120
M v[240:243], a[160:163], v[64:67], v[240:243]
M v[244:247], a[160:163], v[68:71], v[244:247]
v_exp_f32 v121, v121
M v[244:247], a[156:159], v[36:39], v[244:247]
v_cvt_pk_bf16_f32 v106, v120, v121
M v[248:251], a[156:159], v[40:43], v[248:251]
v_exp_f32 v122, v122
M v[248:251], a[160:163], v[72:75], v[248:251]
s_waitcnt vmcnt(0) lgkmcnt(0)
s_barrier
ds_read_b128 a[116:119], v3 offset:0
ds_read_b128 a[120:123], v3 offset:1024
M v[252:255], a[160:163], v[76:79], v[252:255]
v_exp_f32 v123, v123
M v[252:255], a[156:159], v[44:47], v[252:255]
v_cvt_pk_bf16_f32 v107, v122, v123
M a[64:67], a[164:167], v[32:35], a[64:67]
v_exp_f32 v108, v108
M a[64:67], a[168:171], v[64:67], a[64:67]
ds_read_b128 a[124:127], v3 offset:2048
ds_read_b128 a[128:131], v3 offset:3072
M a[68:71], a[168:171], v[68:71], a[68:71]
v_exp_f32 v109, v109
M a[68:71], a[164:167], v[36:39], a[68:71]
v_cvt_pk_bf16_f32 v108, v108, v109
M a[72:75], a[164:167], v[40:43], a[72:75]
v_exp_f32 v110, v110
M a[72:75], a[168:171], v[72:75], a[72:75]
ds_read_b128 a[132:135], v3 offset:4096
ds_read_b128 a[136:139], v3 offset:5120
M a[76:79], a[168:171], v[76:79], a[76:79]
v_exp_f32 v111, v111
M a[76:79], a[164:167], v[44:47], a[76:79]
v_cvt_pk_bf16_f32 v109, v110, v111
M a[80:83], a[172:175], v[32:35], a[80:83]
v_exp_f32 v124, v124
M a[80:83], a[176:179], v[64:67], a[80:83]
ds_read_b128 a[140:143], v3 offset:6144
ds_read_b128 a[144:147], v3 offset:7168
M a[84:87], a[176:179], v[68:71], a[84:87]
v_exp_f32 v125, v125
M a[84:87], a[172:175], v[36:39], a[84:87]
v_cvt_pk_bf16_f32 v110, v124, v125
M a[88:91], a[172:175], v[40:43], a[88:91]
v_exp_f32 v126, v126
M a[88:91], a[176:179], v[72:75], a[88:91]
M a[92:95], a[176:179], v[76:79], a[92:95]
v_exp_f32 v127, v127
M a[92:95], a[172:175], v[44:47], a[92:95]
v_cvt_pk_bf16_f32 v111, v126, v127
Lk2_l2b:
s_add_u32 m0, s29, 0
s_waitcnt lgkmcnt(4)
M v[32:35], a[116:119], a[180:183], 0
v_exp_f32 v128, v128
M v[32:35], a[120:123], a[184:187], v[32:35]
ds_read_b128 a[148:151], v3 offset:8192
ds_read_b128 a[152:155], v3 offset:9216
M v[32:35], a[124:127], a[188:191], v[32:35]
v_exp_f32 v129, v129
M v[32:35], a[128:131], a[192:195], v[32:35]
buffer_load_dwordx4 v1, s[12:15], s25 offen offset:0 sc1 lds
s_add_u32 s32, s25, 4096
M v[36:39], a[128:131], a[208:211], 0
v_exp_f32 v130, v130
M v[36:39], a[124:127], a[204:207], v[36:39]
v_cvt_pk_bf16_f32 v128, v128, v129
M v[36:39], a[120:123], a[200:203], v[36:39]
v_exp_f32 v131, v131
M v[36:39], a[116:119], a[196:199], v[36:39]
buffer_load_dwordx4 v1, s[12:15], s25 offen offset:1024 sc1 lds
M v[40:43], a[116:119], a[212:215], 0
v_exp_f32 v144, v144
M v[40:43], a[120:123], a[216:219], v[40:43]
ds_read_b128 a[156:159], v3 offset:10240
ds_read_b128 a[160:163], v3 offset:11264
M v[40:43], a[124:127], a[220:223], v[40:43]
v_exp_f32 v145, v145
M v[40:43], a[128:131], a[224:227], v[40:43]
buffer_load_dwordx4 v1, s[12:15], s25 offen offset:2048 sc1 lds
M v[44:47], a[128:131], a[240:243], 0
v_exp_f32 v146, v146
M v[44:47], a[124:127], a[236:239], v[44:47]
v_cvt_pk_bf16_f32 v129, v130, v131
v_cvt_pk_bf16_f32 v130, v144, v145
M v[44:47], a[120:123], a[232:235], v[44:47]
v_exp_f32 v147, v147
M v[44:47], a[116:119], a[228:231], v[44:47]
buffer_load_dwordx4 v1, s[12:15], s25 offen offset:3072 sc1 lds
s_add_u32 m0, s29, 4096
s_waitcnt lgkmcnt(4)
M v[48:51], a[132:135], a[180:183], 0
v_exp_f32 v132, v132
M v[48:51], a[136:139], a[184:187], v[48:51]
ds_read_b128 a[164:167], v3 offset:12288
ds_read_b128 a[168:171], v3 offset:13312
M v[48:51], a[140:143], a[188:191], v[48:51]
v_exp_f32 v133, v133
M v[48:51], a[144:147], a[192:195], v[48:51]
buffer_load_dwordx4 v1, s[12:15], s32 offen offset:0 sc1 lds
M v[52:55], a[144:147], a[208:211], 0
v_exp_f32 v134, v134
M v[52:55], a[140:143], a[204:207], v[52:55]
v_cvt_pk_bf16_f32 v131, v146, v147
v_cvt_pk_bf16_f32 v132, v132, v133
M v[52:55], a[136:139], a[200:203], v[52:55]
v_exp_f32 v135, v135
M v[52:55], a[132:135], a[196:199], v[52:55]
buffer_load_dwordx4 v1, s[12:15], s32 offen offset:1024 sc1 lds
M v[56:59], a[132:135], a[212:215], 0
v_exp_f32 v148, v148
M v[56:59], a[136:139], a[216:219], v[56:59]
ds_read_b128 a[172:175], v3 offset:14336
ds_read_b128 a[176:179], v3 offset:15360
M v[56:59], a[140:143], a[220:223], v[56:59]
v_exp_f32 v149, v149
M v[56:59], a[144:147], a[224:227], v[56:59]
buffer_load_dwordx4 v1, s[12:15], s32 offen offset:2048 sc1 lds
M v[60:63], a[144:147], a[240:243], 0
v_exp_f32 v150, v150
M v[60:63], a[140:143], a[236:239], v[60:63]
v_cvt_pk_bf16_f32 v133, v134, v135
v_cvt_pk_bf16_f32 v134, v148, v149
M v[60:63], a[136:139], a[232:235], v[60:63]
v_exp_f32 v151, v151
M v[60:63], a[132:135], a[228:231], v[60:63]
buffer_load_dwordx4 v1, s[12:15], s32 offen offset:3072 sc1 lds
s_add_u32 m0, s29, 32768
s_waitcnt lgkmcnt(4)
M v[64:67], a[148:151], a[180:183], 0
v_exp_f32 v136, v136
M v[64:67], a[152:155], a[184:187], v[64:67]
ds_read_b128 a[116:119], v6 offset:32768
ds_read_b128 a[120:123], v6 offset:40960
M v[64:67], a[156:159], a[188:191], v[64:67]
v_exp_f32 v137, v137
M v[64:67], a[160:163], a[192:195], v[64:67]
buffer_load_dwordx4 v1, s[12:15], s26 offen offset:0 sc1 lds
s_add_u32 s43, s26, 4096
M v[68:71], a[160:163], a[208:211], 0
v_exp_f32 v138, v138
M v[68:71], a[156:159], a[204:207], v[68:71]
v_cvt_pk_bf16_f32 v135, v150, v151
v_cvt_pk_bf16_f32 v136, v136, v137
M v[68:71], a[152:155], a[200:203], v[68:71]
v_exp_f32 v139, v139
M v[68:71], a[148:151], a[196:199], v[68:71]
buffer_load_dwordx4 v1, s[12:15], s26 offen offset:1024 sc1 lds
M v[72:75], a[148:151], a[212:215], 0
v_exp_f32 v152, v152
M v[72:75], a[152:155], a[216:219], v[72:75]
ds_read_b128 a[124:127], v6 offset:33792
ds_read_b128 a[128:131], v6 offset:41984
M v[72:75], a[156:159], a[220:223], v[72:75]
v_exp_f32 v153, v153
M v[72:75], a[160:163], a[224:227], v[72:75]
buffer_load_dwordx4 v1, s[12:15], s26 offen offset:2048 sc1 lds
M v[76:79], a[160:163], a[240:243], 0
v_exp_f32 v154, v154
M v[76:79], a[156:159], a[236:239], v[76:79]
v_cvt_pk_bf16_f32 v137, v138, v139
v_cvt_pk_bf16_f32 v138, v152, v153
M v[76:79], a[152:155], a[232:235], v[76:79]
v_exp_f32 v155, v155
M v[76:79], a[148:151], a[228:231], v[76:79]
buffer_load_dwordx4 v1, s[12:15], s26 offen offset:3072 sc1 lds
s_add_u32 m0, s29, 36864
s_waitcnt lgkmcnt(4)
M v[80:83], a[164:167], a[180:183], 0
v_exp_f32 v140, v140
M v[80:83], a[168:171], a[184:187], v[80:83]
ds_read_b128 a[132:135], v6 offset:34816
ds_read_b128 a[136:139], v6 offset:43008
M v[80:83], a[172:175], a[188:191], v[80:83]
v_exp_f32 v141, v141
M v[80:83], a[176:179], a[192:195], v[80:83]
buffer_load_dwordx4 v1, s[12:15], s43 offen offset:0 sc1 lds
M v[84:87], a[176:179], a[208:211], 0
v_exp_f32 v142, v142
M v[84:87], a[172:175], a[204:207], v[84:87]
v_cvt_pk_bf16_f32 v139, v154, v155
v_cvt_pk_bf16_f32 v140, v140, v141
M v[84:87], a[168:171], a[200:203], v[84:87]
v_exp_f32 v143, v143
M v[84:87], a[164:167], a[196:199], v[84:87]
buffer_load_dwordx4 v1, s[12:15], s43 offen offset:1024 sc1 lds
M v[88:91], a[164:167], a[212:215], 0
v_exp_f32 v156, v156
M v[88:91], a[168:171], a[216:219], v[88:91]
ds_read_b128 a[140:143], v6 offset:35840
ds_read_b128 a[144:147], v6 offset:44032
M v[88:91], a[172:175], a[220:223], v[88:91]
v_exp_f32 v157, v157
M v[88:91], a[176:179], a[224:227], v[88:91]
buffer_load_dwordx4 v1, s[12:15], s43 offen offset:2048 sc1 lds
M v[92:95], a[176:179], a[240:243], 0
v_exp_f32 v158, v158
M v[92:95], a[172:175], a[236:239], v[92:95]
v_cvt_pk_bf16_f32 v141, v142, v143
v_cvt_pk_bf16_f32 v142, v156, v157
M v[92:95], a[168:171], a[232:235], v[92:95]
v_exp_f32 v159, v159
M v[92:95], a[164:167], a[228:231], v[92:95]
buffer_load_dwordx4 v1, s[12:15], s43 offen offset:3072 sc1 lds
v_cvt_pk_bf16_f32 v143, v158, v159
s_waitcnt lgkmcnt(6)
M v[160:163], a[116:119], v[96:99], v[160:163]
v_exp_f32 v32, v32
M v[160:163], a[120:123], v[128:131], v[160:163]
ds_read_b128 a[148:151], v6 offset:36864
ds_read_b128 a[152:155], v6 offset:45056
M v[164:167], a[120:123], v[132:135], v[164:167]
v_exp_f32 v33, v33
M v[164:167], a[116:119], v[100:103], v[164:167]
v_cvt_pk_bf16_f32 v32, v32, v33
M v[168:171], a[116:119], v[104:107], v[168:171]
v_exp_f32 v34, v34
M v[168:171], a[120:123], v[136:139], v[168:171]
s_add_u32 s25, s25, 32768
s_cmp_eq_u32 s25, s27
M v[172:175], a[120:123], v[140:143], v[172:175]
v_exp_f32 v35, v35
M v[172:175], a[116:119], v[108:111], v[172:175]
v_cvt_pk_bf16_f32 v33, v34, v35
s_waitcnt lgkmcnt(6)
M a[96:99], a[112:115], v[96:99], a[96:99]
s_cselect_b32 s25, s28, s25
s_cselect_b32 s27, -1, s27
M a[96:99], a[112:115], v[128:131], a[96:99]
s_add_u32 s26, s26, 32768
s_cmp_eq_u32 s26, s62
M v[176:179], a[124:127], v[96:99], v[176:179]
v_exp_f32 v48, v48
M v[176:179], a[128:131], v[128:131], v[176:179]
ds_read_b128 a[156:159], v6 offset:37888
ds_read_b128 a[160:163], v6 offset:46080
M v[180:183], a[128:131], v[132:135], v[180:183]
v_exp_f32 v49, v49
M v[180:183], a[124:127], v[100:103], v[180:183]
v_cvt_pk_bf16_f32 v34, v48, v49
M v[184:187], a[124:127], v[104:107], v[184:187]
v_exp_f32 v50, v50
M v[184:187], a[128:131], v[136:139], v[184:187]
s_cselect_b32 s26, s63, s26
s_cselect_b32 s62, -1, s62
M v[188:191], a[128:131], v[140:143], v[188:191]
v_exp_f32 v51, v51
M v[188:191], a[124:127], v[108:111], v[188:191]
v_cvt_pk_bf16_f32 v35, v50, v51
s_waitcnt lgkmcnt(6)
M a[100:103], a[112:115], v[100:103], a[100:103]
M a[100:103], a[112:115], v[132:135], a[100:103]
M v[192:195], a[132:135], v[96:99], v[192:195]
v_exp_f32 v36, v36
M v[192:195], a[136:139], v[128:131], v[192:195]
ds_read_b128 a[164:167], v6 offset:38912
ds_read_b128 a[168:171], v6 offset:47104
M v[196:199], a[136:139], v[132:135], v[196:199]
v_exp_f32 v37, v37
M v[196:199], a[132:135], v[100:103], v[196:199]
v_cvt_pk_bf16_f32 v36, v36, v37
M v[200:203], a[132:135], v[104:107], v[200:203]
v_exp_f32 v38, v38
M v[200:203], a[136:139], v[136:139], v[200:203]
M v[204:207], a[136:139], v[140:143], v[204:207]
v_exp_f32 v39, v39
M v[204:207], a[132:135], v[108:111], v[204:207]
v_cvt_pk_bf16_f32 v37, v38, v39
s_waitcnt lgkmcnt(6)
M a[104:107], a[112:115], v[104:107], a[104:107]
M a[104:107], a[112:115], v[136:139], a[104:107]
M v[208:211], a[140:143], v[96:99], v[208:211]
v_exp_f32 v52, v52
M v[208:211], a[144:147], v[128:131], v[208:211]
ds_read_b128 a[172:175], v6 offset:39936
ds_read_b128 a[176:179], v6 offset:48128
M v[212:215], a[144:147], v[132:135], v[212:215]
v_exp_f32 v53, v53
M v[212:215], a[140:143], v[100:103], v[212:215]
v_cvt_pk_bf16_f32 v38, v52, v53
M v[216:219], a[140:143], v[104:107], v[216:219]
v_exp_f32 v54, v54
M v[216:219], a[144:147], v[136:139], v[216:219]
M v[220:223], a[144:147], v[140:143], v[220:223]
v_exp_f32 v55, v55
M v[220:223], a[140:143], v[108:111], v[220:223]
v_cvt_pk_bf16_f32 v39, v54, v55
s_waitcnt lgkmcnt(6)
M a[108:111], a[112:115], v[108:111], a[108:111]
M a[108:111], a[112:115], v[140:143], a[108:111]
M v[224:227], a[148:151], v[96:99], v[224:227]
v_exp_f32 v40, v40
M v[224:227], a[152:155], v[128:131], v[224:227]
M v[228:231], a[152:155], v[132:135], v[228:231]
v_exp_f32 v41, v41
M v[228:231], a[148:151], v[100:103], v[228:231]
v_cvt_pk_bf16_f32 v40, v40, v41
M v[232:235], a[148:151], v[104:107], v[232:235]
v_exp_f32 v42, v42
M v[232:235], a[152:155], v[136:139], v[232:235]
M v[236:239], a[152:155], v[140:143], v[236:239]
v_exp_f32 v43, v43
M v[236:239], a[148:151], v[108:111], v[236:239]
v_cvt_pk_bf16_f32 v41, v42, v43
s_waitcnt lgkmcnt(4)
M v[240:243], a[156:159], v[96:99], v[240:243]
v_exp_f32 v56, v56
M v[240:243], a[160:163], v[128:131], v[240:243]
M v[244:247], a[160:163], v[132:135], v[244:247]
v_exp_f32 v57, v57
M v[244:247], a[156:159], v[100:103], v[244:247]
v_cvt_pk_bf16_f32 v42, v56, v57
M v[248:251], a[156:159], v[104:107], v[248:251]
v_exp_f32 v58, v58
M v[248:251], a[160:163], v[136:139], v[248:251]
s_waitcnt vmcnt(0) lgkmcnt(0)
s_barrier
ds_read_b128 a[116:119], v2 offset:0
ds_read_b128 a[120:123], v2 offset:1024
M v[252:255], a[160:163], v[140:143], v[252:255]
v_exp_f32 v59, v59
M v[252:255], a[156:159], v[108:111], v[252:255]
v_cvt_pk_bf16_f32 v43, v58, v59
M a[64:67], a[164:167], v[96:99], a[64:67]
v_exp_f32 v44, v44
M a[64:67], a[168:171], v[128:131], a[64:67]
ds_read_b128 a[124:127], v2 offset:2048
ds_read_b128 a[128:131], v2 offset:3072
M a[68:71], a[168:171], v[132:135], a[68:71]
v_exp_f32 v45, v45
M a[68:71], a[164:167], v[100:103], a[68:71]
v_cvt_pk_bf16_f32 v44, v44, v45
M a[72:75], a[164:167], v[104:107], a[72:75]
v_exp_f32 v46, v46
M a[72:75], a[168:171], v[136:139], a[72:75]
ds_read_b128 a[132:135], v2 offset:4096
ds_read_b128 a[136:139], v2 offset:5120
M a[76:79], a[168:171], v[140:143], a[76:79]
v_exp_f32 v47, v47
M a[76:79], a[164:167], v[108:111], a[76:79]
v_cvt_pk_bf16_f32 v45, v46, v47
M a[80:83], a[172:175], v[96:99], a[80:83]
v_exp_f32 v60, v60
M a[80:83], a[176:179], v[128:131], a[80:83]
ds_read_b128 a[140:143], v2 offset:6144
ds_read_b128 a[144:147], v2 offset:7168
M a[84:87], a[176:179], v[132:135], a[84:87]
v_exp_f32 v61, v61
M a[84:87], a[172:175], v[100:103], a[84:87]
v_cvt_pk_bf16_f32 v46, v60, v61
M a[88:91], a[172:175], v[104:107], a[88:91]
v_exp_f32 v62, v62
M a[88:91], a[176:179], v[136:139], a[88:91]
M a[92:95], a[176:179], v[140:143], a[92:95]
v_exp_f32 v63, v63
M a[92:95], a[172:175], v[108:111], a[92:95]
v_cvt_pk_bf16_f32 v47, v62, v63
s_sub_u32 s30, s30, 1
s_cmp_lg_u32 s30, 0
s_cbranch_scc1 Lk2_l2
s_and_b32 s3, s2, 3
s_lshl_b32 s3, s3, 2
s_bfe_u32 s27, s2, 0x20003
s_add_u32 s27, s3, s27
s_lshl_b32 s43, s27, 8
s_add_u32 s43, s43, 16789504
v_lshlrev_b32 v15, 2, v0
buffer_load_dword v7, v15, s[52:55], s43 offen sc1
s_waitcnt lgkmcnt(7)
ds_read_b128 a[116:119], v5 offset:36864
s_waitcnt lgkmcnt(7)
ds_read_b128 a[120:123], v5 offset:45056
s_waitcnt lgkmcnt(7)
ds_read_b128 a[124:127], v5 offset:37888
s_waitcnt lgkmcnt(7)
ds_read_b128 a[128:131], v5 offset:46080
s_waitcnt lgkmcnt(7)
ds_read_b128 a[132:135], v5 offset:38912
s_waitcnt lgkmcnt(7)
ds_read_b128 a[136:139], v5 offset:47104
s_waitcnt lgkmcnt(7)
ds_read_b128 a[140:143], v5 offset:39936
s_waitcnt lgkmcnt(7)
ds_read_b128 a[144:147], v5 offset:48128
s_lshl_b32 s33, s23, 14
s_add_u32 s34, s33, 98304
s_add_u32 s33, s33, 131072
v_add_u32 v2, s34, v1
v_add_u32 v3, s33, v1
v_exp_f32 v64, v64
v_exp_f32 v65, v65
v_exp_f32 v66, v66
v_exp_f32 v67, v67
v_exp_f32 v80, v80
v_exp_f32 v81, v81
v_exp_f32 v82, v82
v_exp_f32 v83, v83
v_cvt_pk_bf16_f32 v64, v64, v65
v_cvt_pk_bf16_f32 v65, v66, v67
v_exp_f32 v68, v68
v_exp_f32 v69, v69
v_exp_f32 v70, v70
v_exp_f32 v71, v71
v_cvt_pk_bf16_f32 v66, v80, v81
v_cvt_pk_bf16_f32 v67, v82, v83
v_exp_f32 v84, v84
v_exp_f32 v85, v85
v_exp_f32 v86, v86
v_exp_f32 v87, v87
v_cvt_pk_bf16_f32 v68, v68, v69
v_cvt_pk_bf16_f32 v69, v70, v71
v_exp_f32 v72, v72
v_exp_f32 v73, v73
v_exp_f32 v74, v74
v_exp_f32 v75, v75
v_cvt_pk_bf16_f32 v70, v84, v85
v_cvt_pk_bf16_f32 v71, v86, v87
v_exp_f32 v88, v88
v_exp_f32 v89, v89
v_exp_f32 v90, v90
v_exp_f32 v91, v91
v_cvt_pk_bf16_f32 v72, v72, v73
v_cvt_pk_bf16_f32 v73, v74, v75
v_exp_f32 v76, v76
v_exp_f32 v77, v77
v_exp_f32 v78, v78
v_exp_f32 v79, v79
v_cvt_pk_bf16_f32 v74, v88, v89
v_cvt_pk_bf16_f32 v75, v90, v91
v_exp_f32 v92, v92
v_exp_f32 v93, v93
v_exp_f32 v94, v94
v_exp_f32 v95, v95
v_cvt_pk_bf16_f32 v76, v76, v77
v_cvt_pk_bf16_f32 v77, v78, v79
v_cvt_pk_bf16_f32 v78, v92, v93
v_cvt_pk_bf16_f32 v79, v94, v95
s_waitcnt lgkmcnt(6)
M v[224:227], a[116:119], v[32:35], v[224:227]
M v[224:227], a[120:123], v[64:67], v[224:227]
ds_read_b128 a[148:151], v5 offset:32768
ds_read_b128 a[152:155], v5 offset:40960
s_mov_b32 s61, 0
M v[228:231], a[120:123], v[68:71], v[228:231]
M v[228:231], a[116:119], v[36:39], v[228:231]
s_bfe_u32 s3, s2, 0x10002
M v[232:235], a[116:119], v[40:43], v[232:235]
M v[232:235], a[120:123], v[72:75], v[232:235]
s_lshl_b32 s3, s3, 3
M v[236:239], a[120:123], v[76:79], v[236:239]
M v[236:239], a[116:119], v[44:47], v[236:239]
s_waitcnt lgkmcnt(6)
s_lshr_b32 s28, s2, 5
M a[96:99], a[112:115], v[32:35], a[96:99]
M a[96:99], a[112:115], v[64:67], a[96:99]
M v[240:243], a[124:127], v[32:35], v[240:243]
M v[240:243], a[128:131], v[64:67], v[240:243]
ds_read_b128 a[156:159], v5 offset:33792
ds_read_b128 a[160:163], v5 offset:41984
s_add_u32 s28, s3, s28
M v[244:247], a[128:131], v[68:71], v[244:247]
s_lshl_b32 s25, s27, 18
M v[244:247], a[124:127], v[36:39], v[244:247]
M v[248:251], a[124:127], v[40:43], v[248:251]
s_lshl_b32 s3, s101, 12
M v[248:251], a[128:131], v[72:75], v[248:251]
M v[252:255], a[128:131], v[76:79], v[252:255]
s_add_u32 s25, s25, s3
M v[252:255], a[124:127], v[44:47], v[252:255]
s_waitcnt lgkmcnt(6)
M a[100:103], a[112:115], v[36:39], a[100:103]
M a[100:103], a[112:115], v[68:71], a[100:103]
M a[64:67], a[132:135], v[32:35], a[64:67]
s_lshl_b32 s26, s28, 7
M a[64:67], a[136:139], v[64:67], a[64:67]
ds_read_b128 a[164:167], v5 offset:34816
ds_read_b128 a[168:171], v5 offset:43008
M a[68:71], a[136:139], v[68:71], a[68:71]
s_lshl_b32 s42, s101, 11
M a[68:71], a[132:135], v[36:39], a[68:71]
M a[72:75], a[132:135], v[40:43], a[72:75]
s_add_u32 s44, s4, 83886080
s_addc_u32 s45, s5, 0
M a[72:75], a[136:139], v[72:75], a[72:75]
s_mov_b32 s46, 4194304
M a[76:79], a[136:139], v[76:79], a[76:79]
M a[76:79], a[132:135], v[44:47], a[76:79]
s_waitcnt lgkmcnt(6)
s_mov_b32 s47, 0x00020000
M a[104:107], a[112:115], v[40:43], a[104:107]
M a[104:107], a[112:115], v[72:75], a[104:107]
M a[80:83], a[140:143], v[32:35], a[80:83]
M a[80:83], a[144:147], v[64:67], a[80:83]
ds_read_b128 a[172:175], v5 offset:35840
ds_read_b128 a[176:179], v5 offset:44032
s_mov_b32 s50, 2097152
M a[84:87], a[144:147], v[68:71], a[84:87]
M a[84:87], a[140:143], v[36:39], a[84:87]
s_mov_b32 s51, 0x00020000
M a[88:91], a[140:143], v[40:43], a[88:91]
M a[88:91], a[144:147], v[72:75], a[88:91]
s_lshl_b32 s3, s101, 4
M a[92:95], a[144:147], v[76:79], a[92:95]
M a[92:95], a[140:143], v[44:47], a[92:95]
s_waitcnt lgkmcnt(6)
v_lshrrev_b32 v96, 3, v0
M a[108:111], a[112:115], v[44:47], a[108:111]
M a[108:111], a[112:115], v[76:79], a[108:111]
M v[160:163], a[148:151], v[32:35], v[160:163]
v_and_b32 v97, 6, v96
M v[160:163], a[152:155], v[64:67], v[160:163]
M v[164:167], a[152:155], v[68:71], v[164:167]
ds_write_b128 v2, v[224:227] offset:0
v_and_b32 v98, 7, v0
M v[164:167], a[148:151], v[36:39], v[164:167]
M v[168:171], a[148:151], v[40:43], v[168:171]
ds_write_b128 v2, v[228:231] offset:1024
v_xor_b32 v97, v97, v98
M v[168:171], a[152:155], v[72:75], v[168:171]
M v[172:175], a[152:155], v[76:79], v[172:175]
ds_write_b128 v2, v[232:235] offset:2048
v_add_u32 v96, s3, v96
M v[172:175], a[148:151], v[44:47], v[172:175]
s_waitcnt lgkmcnt(7)
M v[176:179], a[156:159], v[32:35], v[176:179]
ds_write_b128 v2, v[236:239] offset:3072
v_lshlrev_b32 v96, 11, v96
M v[176:179], a[160:163], v[64:67], v[176:179]
M v[180:183], a[160:163], v[68:71], v[180:183]
ds_write_b128 v2, v[240:243] offset:4096
v_lshl_add_u32 v99, v97, 4, v96
M v[180:183], a[156:159], v[36:39], v[180:183]
v_add_u32 v100, 15360, v99
M v[184:187], a[156:159], v[40:43], v[184:187]
ds_write_b128 v2, v[244:247] offset:5120
M v[184:187], a[160:163], v[72:75], v[184:187]
s_waitcnt vmcnt(0) lgkmcnt(0)
s_barrier
M v[188:191], a[160:163], v[76:79], v[188:191]
ds_write_b128 v2, v[248:251] offset:6144
v_cmp_ne_u32 vcc, 1, v7
s_nop 0
s_cbranch_vccnz Lk3_spinb1
Lk3_gotb1:
M v[188:191], a[156:159], v[44:47], v[188:191]
s_add_u32 m0, s42, 16384
s_nop 0
buffer_load_dwordx4 v99, s[48:51], s26 offen offset:0 lds
M v[192:195], a[164:167], v[32:35], v[192:195]
ds_write_b128 v2, v[252:255] offset:7168
buffer_load_dwordx4 v100, s[48:51], s26 offen offset:1024 lds
M v[192:195], a[168:171], v[64:67], v[192:195]
M v[196:199], a[168:171], v[68:71], v[196:199]
ds_write_b128 v2, a[64:67] offset:8192
buffer_load_dwordx4 a[192:195], v1, s[44:47], s25 offen offset:0 sc1
M v[196:199], a[164:167], v[36:39], v[196:199]
buffer_load_dwordx4 a[196:199], v1, s[44:47], s25 offen offset:1024 sc1
M v[200:203], a[164:167], v[40:43], v[200:203]
ds_write_b128 v2, a[68:71] offset:9216
buffer_load_dwordx4 a[200:203], v1, s[44:47], s25 offen offset:2048 sc1
M v[200:203], a[168:171], v[72:75], v[200:203]
buffer_load_dwordx4 a[204:207], v1, s[44:47], s25 offen offset:3072 sc1
M v[204:207], a[168:171], v[76:79], v[204:207]
ds_write_b128 v2, a[72:75] offset:10240
M v[204:207], a[164:167], v[44:47], v[204:207]
s_add_u32 s25, s25, 16384
s_add_u32 s26, s26, 131072
M v[208:211], a[172:175], v[32:35], v[208:211]
ds_write_b128 v2, a[76:79] offset:11264
s_add_u32 m0, s42, 32768
s_nop 0
buffer_load_dwordx4 v99, s[48:51], s26 offen offset:0 lds
M v[208:211], a[176:179], v[64:67], v[208:211]
buffer_load_dwordx4 v100, s[48:51], s26 offen offset:1024 lds
M v[212:215], a[176:179], v[68:71], v[212:215]
ds_write_b128 v2, a[80:83] offset:12288
buffer_load_dwordx4 a[224:227], v1, s[44:47], s25 offen offset:0 sc1
M v[212:215], a[172:175], v[36:39], v[212:215]
M v[216:219], a[172:175], v[40:43], v[216:219]
ds_write_b128 v2, a[84:87] offset:13312
buffer_load_dwordx4 a[228:231], v1, s[44:47], s25 offen offset:1024 sc1
M v[216:219], a[176:179], v[72:75], v[216:219]
buffer_load_dwordx4 a[232:235], v1, s[44:47], s25 offen offset:2048 sc1
M v[220:223], a[176:179], v[76:79], v[220:223]
ds_write_b128 v2, a[88:91] offset:14336
buffer_load_dwordx4 a[236:239], v1, s[44:47], s25 offen offset:3072 sc1
M v[220:223], a[172:175], v[44:47], v[220:223]
s_add_u32 s25, s25, 16384
s_add_u32 s26, s26, 131072
ds_write_b128 v2, a[92:95] offset:15360
s_waitcnt lgkmcnt(0)
Lk2_merge:
s_lshl_b32 s33, s22, 10
s_add_u32 s33, s33, 28672
s_xor_b32 s34, s33, 2048
v_add_u32 v14, s33, v1
v_add_u32 v15, s34, v1
v_accvgpr_read_b32 v20, a96
v_accvgpr_read_b32 v21, a100
v_accvgpr_read_b32 v22, a104
v_accvgpr_read_b32 v23, a108
ds_write_b128 v14, v[20:23]
s_waitcnt lgkmcnt(0)
s_barrier
ds_read_b128 v[28:31], v15
ds_read_b128 v[32:35], v3 offset:0
ds_read_b128 v[36:39], v3 offset:1024
ds_read_b128 v[40:43], v3 offset:2048
ds_read_b128 v[44:47], v3 offset:3072
ds_read_b128 v[48:51], v3 offset:4096
ds_read_b128 v[52:55], v3 offset:5120
ds_read_b128 v[56:59], v3 offset:6144
ds_read_b128 v[60:63], v3 offset:7168
ds_read_b128 v[64:67], v3 offset:8192
ds_read_b128 v[68:71], v3 offset:9216
ds_read_b128 v[72:75], v3 offset:10240
ds_read_b128 v[76:79], v3 offset:11264
ds_read_b128 v[80:83], v3 offset:12288
ds_read_b128 v[84:87], v3 offset:13312
ds_read_b128 v[88:91], v3 offset:14336
ds_read_b128 v[92:95], v3 offset:15360
s_waitcnt lgkmcnt(15)
v_add_f32 v20, v20, v28
v_add_f32 v21, v21, v29
v_add_f32 v22, v22, v30
v_add_f32 v23, v23, v31
s_sub_u32 s35, 15, s21
v_rcp_f32 v8, v20
v_rcp_f32 v9, v21
v_rcp_f32 v10, v22
v_rcp_f32 v11, v23
v_subrev_u32 v20, 0x21800000, v20
v_subrev_u32 v21, 0x21800000, v21
v_subrev_u32 v22, 0x21800000, v22
v_subrev_u32 v23, 0x21800000, v23
v_max_u32 v12, v20, v21
v_max3_u32 v12, v12, v22, v23
s_mov_b32 s64, 0x207
s_lshl_b32 s33, s35, 20
s_lshl_b32 s34, s20, 15
s_add_u32 s33, s33, s34
s_lshl_b32 s34, s23, 13
s_add_u32 s36, s33, s34
s_add_u32 s37, s36, 4096
s_add_u32 s38, s36, 16384
s_add_u32 s39, s36, 20480
v_pk_add_f32 v[160:161], v[160:161], v[32:33]
v_pk_add_f32 v[162:163], v[162:163], v[34:35]
s_waitcnt lgkmcnt(11)
v_pk_add_f32 v[176:177], v[176:177], v[48:49]
v_pk_add_f32 v[178:179], v[178:179], v[50:51]
v_pk_mul_f32 v[160:161], v[160:161], v[8:9] op_sel:[0,0] op_sel_hi:[1,0]
v_pk_mul_f32 v[162:163], v[162:163], v[8:9] op_sel:[0,0] op_sel_hi:[1,0]
v_pk_mul_f32 v[176:177], v[176:177], v[8:9] op_sel:[0,0] op_sel_hi:[1,0]
v_pk_mul_f32 v[178:179], v[178:179], v[8:9] op_sel:[0,0] op_sel_hi:[1,0]
v_cvt_pk_bf16_f32 v160, v160, v161
v_cvt_pk_bf16_f32 v161, v162, v163
v_cvt_pk_bf16_f32 v162, v176, v177
v_cvt_pk_bf16_f32 v163, v178, v179
v_pk_add_f32 v[164:165], v[164:165], v[36:37]
v_pk_add_f32 v[166:167], v[166:167], v[38:39]
s_waitcnt lgkmcnt(10)
v_pk_add_f32 v[180:181], v[180:181], v[52:53]
v_pk_add_f32 v[182:183], v[182:183], v[54:55]
M v[24:27], a[112:115], v[160:163], 0
buffer_store_dwordx4 v[160:163], v1, s[16:19], s36 offen offset:0 sc1
v_pk_mul_f32 v[164:165], v[164:165], v[8:9] op_sel:[0,1] op_sel_hi:[1,1]
v_pk_mul_f32 v[166:167], v[166:167], v[8:9] op_sel:[0,1] op_sel_hi:[1,1]
v_pk_mul_f32 v[180:181], v[180:181], v[8:9] op_sel:[0,1] op_sel_hi:[1,1]
v_pk_mul_f32 v[182:183], v[182:183], v[8:9] op_sel:[0,1] op_sel_hi:[1,1]
v_cvt_pk_bf16_f32 v164, v164, v165
v_cvt_pk_bf16_f32 v165, v166, v167
v_cvt_pk_bf16_f32 v166, v180, v181
v_cvt_pk_bf16_f32 v167, v182, v183
v_pk_add_f32 v[168:169], v[168:169], v[40:41]
v_pk_add_f32 v[170:171], v[170:171], v[42:43]
s_waitcnt lgkmcnt(9)
v_pk_add_f32 v[184:185], v[184:185], v[56:57]
v_pk_add_f32 v[186:187], v[186:187], v[58:59]
M v[24:27], a[112:115], v[164:167], v[24:27]
buffer_store_dwordx4 v[164:167], v1, s[16:19], s36 offen offset:2048 sc1
v_pk_mul_f32 v[168:169], v[168:169], v[10:11] op_sel:[0,0] op_sel_hi:[1,0]
v_pk_mul_f32 v[170:171], v[170:171], v[10:11] op_sel:[0,0] op_sel_hi:[1,0]
v_pk_mul_f32 v[184:185], v[184:185], v[10:11] op_sel:[0,0] op_sel_hi:[1,0]
v_pk_mul_f32 v[186:187], v[186:187], v[10:11] op_sel:[0,0] op_sel_hi:[1,0]
v_cvt_pk_bf16_f32 v168, v168, v169
v_cvt_pk_bf16_f32 v169, v170, v171
v_cvt_pk_bf16_f32 v170, v184, v185
v_cvt_pk_bf16_f32 v171, v186, v187
v_pk_add_f32 v[172:173], v[172:173], v[44:45]
v_pk_add_f32 v[174:175], v[174:175], v[46:47]
s_waitcnt lgkmcnt(8)
v_pk_add_f32 v[188:189], v[188:189], v[60:61]
v_pk_add_f32 v[190:191], v[190:191], v[62:63]
M v[24:27], a[112:115], v[168:171], v[24:27]
buffer_store_dwordx4 v[168:171], v1, s[16:19], s37 offen offset:0 sc1
v_pk_mul_f32 v[172:173], v[172:173], v[10:11] op_sel:[0,1] op_sel_hi:[1,1]
v_pk_mul_f32 v[174:175], v[174:175], v[10:11] op_sel:[0,1] op_sel_hi:[1,1]
v_pk_mul_f32 v[188:189], v[188:189], v[10:11] op_sel:[0,1] op_sel_hi:[1,1]
v_pk_mul_f32 v[190:191], v[190:191], v[10:11] op_sel:[0,1] op_sel_hi:[1,1]
v_cvt_pk_bf16_f32 v172, v172, v173
v_cvt_pk_bf16_f32 v173, v174, v175
v_cvt_pk_bf16_f32 v174, v188, v189
v_cvt_pk_bf16_f32 v175, v190, v191
s_waitcnt lgkmcnt(7)
v_pk_add_f32 v[192:193], v[192:193], v[64:65]
v_pk_add_f32 v[194:195], v[194:195], v[66:67]
s_waitcnt lgkmcnt(3)
v_pk_add_f32 v[208:209], v[208:209], v[80:81]
v_pk_add_f32 v[210:211], v[210:211], v[82:83]
M v[24:27], a[112:115], v[172:175], v[24:27]
buffer_store_dwordx4 v[172:175], v1, s[16:19], s37 offen offset:2048 sc1
v_pk_mul_f32 v[192:193], v[192:193], v[8:9] op_sel:[0,0] op_sel_hi:[1,0]
v_pk_mul_f32 v[194:195], v[194:195], v[8:9] op_sel:[0,0] op_sel_hi:[1,0]
v_pk_mul_f32 v[208:209], v[208:209], v[8:9] op_sel:[0,0] op_sel_hi:[1,0]
v_pk_mul_f32 v[210:211], v[210:211], v[8:9] op_sel:[0,0] op_sel_hi:[1,0]
v_cvt_pk_bf16_f32 v192, v192, v193
v_cvt_pk_bf16_f32 v193, v194, v195
v_cvt_pk_bf16_f32 v194, v208, v209
v_cvt_pk_bf16_f32 v195, v210, v211
v_pk_add_f32 v[196:197], v[196:197], v[68:69]
v_pk_add_f32 v[198:199], v[198:199], v[70:71]
s_waitcnt lgkmcnt(2)
v_pk_add_f32 v[212:213], v[212:213], v[84:85]
v_pk_add_f32 v[214:215], v[214:215], v[86:87]
M v[24:27], a[112:115], v[192:195], v[24:27]
buffer_store_dwordx4 v[192:195], v1, s[16:19], s36 offen offset:1024 sc1
v_pk_mul_f32 v[196:197], v[196:197], v[8:9] op_sel:[0,1] op_sel_hi:[1,1]
v_pk_mul_f32 v[198:199], v[198:199], v[8:9] op_sel:[0,1] op_sel_hi:[1,1]
v_pk_mul_f32 v[212:213], v[212:213], v[8:9] op_sel:[0,1] op_sel_hi:[1,1]
v_pk_mul_f32 v[214:215], v[214:215], v[8:9] op_sel:[0,1] op_sel_hi:[1,1]
v_cvt_pk_bf16_f32 v196, v196, v197
v_cvt_pk_bf16_f32 v197, v198, v199
v_cvt_pk_bf16_f32 v198, v212, v213
v_cvt_pk_bf16_f32 v199, v214, v215
v_pk_add_f32 v[200:201], v[200:201], v[72:73]
v_pk_add_f32 v[202:203], v[202:203], v[74:75]
s_waitcnt lgkmcnt(1)
v_pk_add_f32 v[216:217], v[216:217], v[88:89]
v_pk_add_f32 v[218:219], v[218:219], v[90:91]
M v[24:27], a[112:115], v[196:199], v[24:27]
buffer_store_dwordx4 v[196:199], v1, s[16:19], s36 offen offset:3072 sc1
v_pk_mul_f32 v[200:201], v[200:201], v[10:11] op_sel:[0,0] op_sel_hi:[1,0]
v_pk_mul_f32 v[202:203], v[202:203], v[10:11] op_sel:[0,0] op_sel_hi:[1,0]
v_pk_mul_f32 v[216:217], v[216:217], v[10:11] op_sel:[0,0] op_sel_hi:[1,0]
v_pk_mul_f32 v[218:219], v[218:219], v[10:11] op_sel:[0,0] op_sel_hi:[1,0]
v_cvt_pk_bf16_f32 v200, v200, v201
v_cvt_pk_bf16_f32 v201, v202, v203
v_cvt_pk_bf16_f32 v202, v216, v217
v_cvt_pk_bf16_f32 v203, v218, v219
v_pk_add_f32 v[204:205], v[204:205], v[76:77]
v_pk_add_f32 v[206:207], v[206:207], v[78:79]
s_waitcnt lgkmcnt(0)
v_pk_add_f32 v[220:221], v[220:221], v[92:93]
v_pk_add_f32 v[222:223], v[222:223], v[94:95]
M v[24:27], a[112:115], v[200:203], v[24:27]
buffer_store_dwordx4 v[200:203], v1, s[16:19], s37 offen offset:1024 sc1
v_pk_mul_f32 v[204:205], v[204:205], v[10:11] op_sel:[0,1] op_sel_hi:[1,1]
v_pk_mul_f32 v[206:207], v[206:207], v[10:11] op_sel:[0,1] op_sel_hi:[1,1]
v_pk_mul_f32 v[220:221], v[220:221], v[10:11] op_sel:[0,1] op_sel_hi:[1,1]
v_pk_mul_f32 v[222:223], v[222:223], v[10:11] op_sel:[0,1] op_sel_hi:[1,1]
v_cvt_pk_bf16_f32 v204, v204, v205
v_cvt_pk_bf16_f32 v205, v206, v207
v_cvt_pk_bf16_f32 v206, v220, v221
v_cvt_pk_bf16_f32 v207, v222, v223
s_nop 1
M v[24:27], a[112:115], v[204:207], v[24:27]
buffer_store_dwordx4 v[204:207], v1, s[16:19], s37 offen offset:3072 sc1
v_cmp_lt_u32 vcc, 0x3c000000, v12
s_nop 5
v_cmp_class_f32 s[40:41], v24, s64
s_nop 0
s_or_b64 vcc, vcc, s[40:41]
s_cmp_lg_u64 vcc, 0
s_cselect_b32 s33, 2, 0
s_or_b32 s60, s60, s33
s_branch Lk2_chk
Lk2_wm:
s_lshl_b32 s33, s2, 1
s_add_u32 s33, s33, s23
s_lshl_b32 s34, s33, 12
s_lshl_b32 s33, s33, 14
v_lshlrev_b32 v8, 3, v1
v_lshlrev_b32 v9, 2, v1
buffer_load_dword a244, v8, s[44:47], s33 offen
s_add_u32 s33, s33, 8192
buffer_load_dword a245, v8, s[44:47], s33 offen
buffer_load_dword a246, v9, s[48:51], s34 offen
s_branch Lk2_l3b
Lk2_g1:
s_mov_b32 s30, 7
s_bfe_u32 s65, s2, 0x20003
s_add_u32 s65, s65, 2
s_lshl_b32 s42, s21, 1
s_min_u32 s42, s42, 13
s_add_u32 s42, s42, 2
s_sub_u32 s33, s42, 1
s_cmp_le_u32 s33, 1
s_cselect_b32 s33, 0x4000, 0
v_add_u32 v3, s33, v3
s_sub_u32 s42, s42, 1
Lk2_l3:
s_cmp_eq_u32 s30, s65
s_cbranch_scc1 Lk2_wm
Lk2_l3b:
s_add_u32 m0, s29, 65536
s_waitcnt lgkmcnt(4)
M v[96:99], a[116:119], a[0:3], 0
v_exp_f32 v64, v64
M v[96:99], a[120:123], a[4:7], v[96:99]
ds_read_b128 a[148:151], v2 offset:8192
ds_read_b128 a[152:155], v2 offset:9216
M v[96:99], a[124:127], a[8:11], v[96:99]
v_exp_f32 v65, v65
M v[96:99], a[128:131], a[12:15], v[96:99]
buffer_load_dwordx4 v1, s[12:15], s25 offen offset:0 sc1 lds
s_add_u32 s32, s25, 4096
M v[100:103], a[128:131], a[28:31], 0
v_exp_f32 v66, v66
M v[100:103], a[124:127], a[24:27], v[100:103]
v_cvt_pk_bf16_f32 v64, v64, v65
M v[100:103], a[120:123], a[20:23], v[100:103]
v_exp_f32 v67, v67
M v[100:103], a[116:119], a[16:19], v[100:103]
buffer_load_dwordx4 v1, s[12:15], s25 offen offset:1024 sc1 lds
M v[104:107], a[116:119], a[32:35], 0
v_exp_f32 v80, v80
M v[104:107], a[120:123], a[36:39], v[104:107]
ds_read_b128 a[156:159], v2 offset:10240
ds_read_b128 a[160:163], v2 offset:11264
M v[104:107], a[124:127], a[40:43], v[104:107]
v_exp_f32 v81, v81
M v[104:107], a[128:131], a[44:47], v[104:107]
buffer_load_dwordx4 v1, s[12:15], s25 offen offset:2048 sc1 lds
M v[108:111], a[128:131], a[60:63], 0
v_exp_f32 v82, v82
M v[108:111], a[124:127], a[56:59], v[108:111]
v_cvt_pk_bf16_f32 v65, v66, v67
v_cvt_pk_bf16_f32 v66, v80, v81
M v[108:111], a[120:123], a[52:55], v[108:111]
v_exp_f32 v83, v83
M v[108:111], a[116:119], a[48:51], v[108:111]
buffer_load_dwordx4 v1, s[12:15], s25 offen offset:3072 sc1 lds
s_add_u32 m0, s29, 69632
s_waitcnt lgkmcnt(4)
M v[112:115], a[132:135], a[0:3], 0
v_exp_f32 v68, v68
M v[112:115], a[136:139], a[4:7], v[112:115]
ds_read_b128 a[164:167], v2 offset:12288
ds_read_b128 a[168:171], v2 offset:13312
M v[112:115], a[140:143], a[8:11], v[112:115]
v_exp_f32 v69, v69
M v[112:115], a[144:147], a[12:15], v[112:115]
buffer_load_dwordx4 v1, s[12:15], s32 offen offset:0 sc1 lds
M v[116:119], a[144:147], a[28:31], 0
v_exp_f32 v70, v70
M v[116:119], a[140:143], a[24:27], v[116:119]
v_cvt_pk_bf16_f32 v67, v82, v83
v_cvt_pk_bf16_f32 v68, v68, v69
M v[116:119], a[136:139], a[20:23], v[116:119]
v_exp_f32 v71, v71
M v[116:119], a[132:135], a[16:19], v[116:119]
buffer_load_dwordx4 v1, s[12:15], s32 offen offset:1024 sc1 lds
M v[120:123], a[132:135], a[32:35], 0
v_exp_f32 v84, v84
M v[120:123], a[136:139], a[36:39], v[120:123]
ds_read_b128 a[172:175], v2 offset:14336
ds_read_b128 a[176:179], v2 offset:15360
M v[120:123], a[140:143], a[40:43], v[120:123]
v_exp_f32 v85, v85
M v[120:123], a[144:147], a[44:47], v[120:123]
buffer_load_dwordx4 v1, s[12:15], s32 offen offset:2048 sc1 lds
M v[124:127], a[144:147], a[60:63], 0
v_exp_f32 v86, v86
M v[124:127], a[140:143], a[56:59], v[124:127]
v_cvt_pk_bf16_f32 v69, v70, v71
v_cvt_pk_bf16_f32 v70, v84, v85
M v[124:127], a[136:139], a[52:55], v[124:127]
v_exp_f32 v87, v87
M v[124:127], a[132:135], a[48:51], v[124:127]
buffer_load_dwordx4 v1, s[12:15], s32 offen offset:3072 sc1 lds
s_add_u32 m0, s29, 98304
s_waitcnt lgkmcnt(4)
M v[128:131], a[148:151], a[0:3], 0
v_exp_f32 v72, v72
M v[128:131], a[152:155], a[4:7], v[128:131]
ds_read_b128 a[116:119], v5 offset:32768
ds_read_b128 a[120:123], v5 offset:40960
M v[128:131], a[156:159], a[8:11], v[128:131]
v_exp_f32 v73, v73
M v[128:131], a[160:163], a[12:15], v[128:131]
buffer_load_dwordx4 v1, s[12:15], s26 offen offset:0 sc1 lds
s_add_u32 s43, s26, 4096
M v[132:135], a[160:163], a[28:31], 0
v_exp_f32 v74, v74
M v[132:135], a[156:159], a[24:27], v[132:135]
v_cvt_pk_bf16_f32 v71, v86, v87
v_cvt_pk_bf16_f32 v72, v72, v73
M v[132:135], a[152:155], a[20:23], v[132:135]
v_exp_f32 v75, v75
M v[132:135], a[148:151], a[16:19], v[132:135]
buffer_load_dwordx4 v1, s[12:15], s26 offen offset:1024 sc1 lds
M v[136:139], a[148:151], a[32:35], 0
v_exp_f32 v88, v88
M v[136:139], a[152:155], a[36:39], v[136:139]
ds_read_b128 a[124:127], v5 offset:33792
ds_read_b128 a[128:131], v5 offset:41984
M v[136:139], a[156:159], a[40:43], v[136:139]
v_exp_f32 v89, v89
M v[136:139], a[160:163], a[44:47], v[136:139]
buffer_load_dwordx4 v1, s[12:15], s26 offen offset:2048 sc1 lds
M v[140:143], a[160:163], a[60:63], 0
v_exp_f32 v90, v90
M v[140:143], a[156:159], a[56:59], v[140:143]
v_cvt_pk_bf16_f32 v73, v74, v75
v_cvt_pk_bf16_f32 v74, v88, v89
M v[140:143], a[152:155], a[52:55], v[140:143]
v_exp_f32 v91, v91
M v[140:143], a[148:151], a[48:51], v[140:143]
buffer_load_dwordx4 v1, s[12:15], s26 offen offset:3072 sc1 lds
s_add_u32 m0, s29, 102400
s_waitcnt lgkmcnt(4)
M v[144:147], a[164:167], a[0:3], 0
v_exp_f32 v76, v76
M v[144:147], a[168:171], a[4:7], v[144:147]
ds_read_b128 a[132:135], v5 offset:34816
ds_read_b128 a[136:139], v5 offset:43008
M v[144:147], a[172:175], a[8:11], v[144:147]
v_exp_f32 v77, v77
M v[144:147], a[176:179], a[12:15], v[144:147]
buffer_load_dwordx4 v1, s[12:15], s43 offen offset:0 sc1 lds
M v[148:151], a[176:179], a[28:31], 0
v_exp_f32 v78, v78
M v[148:151], a[172:175], a[24:27], v[148:151]
v_cvt_pk_bf16_f32 v75, v90, v91
v_cvt_pk_bf16_f32 v76, v76, v77
M v[148:151], a[168:171], a[20:23], v[148:151]
v_exp_f32 v79, v79
M v[148:151], a[164:167], a[16:19], v[148:151]
buffer_load_dwordx4 v1, s[12:15], s43 offen offset:1024 sc1 lds
M v[152:155], a[164:167], a[32:35], 0
v_exp_f32 v92, v92
M v[152:155], a[168:171], a[36:39], v[152:155]
ds_read_b128 a[140:143], v5 offset:35840
ds_read_b128 a[144:147], v5 offset:44032
M v[152:155], a[172:175], a[40:43], v[152:155]
v_exp_f32 v93, v93
M v[152:155], a[176:179], a[44:47], v[152:155]
buffer_load_dwordx4 v1, s[12:15], s43 offen offset:2048 sc1 lds
M v[156:159], a[176:179], a[60:63], 0
v_exp_f32 v94, v94
M v[156:159], a[172:175], a[56:59], v[156:159]
v_cvt_pk_bf16_f32 v77, v78, v79
v_cvt_pk_bf16_f32 v78, v92, v93
M v[156:159], a[168:171], a[52:55], v[156:159]
v_exp_f32 v95, v95
M v[156:159], a[164:167], a[48:51], v[156:159]
buffer_load_dwordx4 v1, s[12:15], s43 offen offset:3072 sc1 lds
v_cvt_pk_bf16_f32 v79, v94, v95
s_waitcnt lgkmcnt(6)
M v[160:163], a[116:119], v[32:35], v[160:163]
v_exp_f32 v96, v96
M v[160:163], a[120:123], v[64:67], v[160:163]
ds_read_b128 a[148:151], v5 offset:36864
ds_read_b128 a[152:155], v5 offset:45056
M v[164:167], a[120:123], v[68:71], v[164:167]
v_exp_f32 v97, v97
M v[164:167], a[116:119], v[36:39], v[164:167]
v_cvt_pk_bf16_f32 v96, v96, v97
M v[168:171], a[116:119], v[40:43], v[168:171]
v_exp_f32 v98, v98
M v[168:171], a[120:123], v[72:75], v[168:171]
s_add_u32 s25, s25, 32768
s_cmp_eq_u32 s25, s27
M v[172:175], a[120:123], v[76:79], v[172:175]
v_exp_f32 v99, v99
M v[172:175], a[116:119], v[44:47], v[172:175]
v_cvt_pk_bf16_f32 v97, v98, v99
s_waitcnt lgkmcnt(6)
M a[96:99], a[112:115], v[32:35], a[96:99]
s_cselect_b32 s25, s28, s25
s_cselect_b32 s27, s56, s27
M a[96:99], a[112:115], v[64:67], a[96:99]
s_cselect_b32 s28, s57, s28
s_cselect_b32 s56, -1, s56
M v[176:179], a[124:127], v[32:35], v[176:179]
v_exp_f32 v112, v112
M v[176:179], a[128:131], v[64:67], v[176:179]
ds_read_b128 a[156:159], v5 offset:37888
ds_read_b128 a[160:163], v5 offset:46080
M v[180:183], a[128:131], v[68:71], v[180:183]
v_exp_f32 v113, v113
M v[180:183], a[124:127], v[36:39], v[180:183]
v_cvt_pk_bf16_f32 v98, v112, v113
M v[184:187], a[124:127], v[40:43], v[184:187]
v_exp_f32 v114, v114
M v[184:187], a[128:131], v[72:75], v[184:187]
s_add_u32 s26, s26, 32768
s_cmp_eq_u32 s26, s62
M v[188:191], a[128:131], v[76:79], v[188:191]
v_exp_f32 v115, v115
M v[188:191], a[124:127], v[44:47], v[188:191]
v_cvt_pk_bf16_f32 v99, v114, v115
s_waitcnt lgkmcnt(6)
M a[100:103], a[112:115], v[36:39], a[100:103]
s_cselect_b32 s26, s63, s26
s_cselect_b32 s62, s58, s62
M a[100:103], a[112:115], v[68:71], a[100:103]
s_cselect_b32 s63, s59, s63
s_cselect_b32 s58, -1, s58
M v[192:195], a[132:135], v[32:35], v[192:195]
v_exp_f32 v100, v100
M v[192:195], a[136:139], v[64:67], v[192:195]
ds_read_b128 a[164:167], v5 offset:38912
ds_read_b128 a[168:171], v5 offset:47104
M v[196:199], a[136:139], v[68:71], v[196:199]
v_exp_f32 v101, v101
M v[196:199], a[132:135], v[36:39], v[196:199]
v_cvt_pk_bf16_f32 v100, v100, v101
M v[200:203], a[132:135], v[40:43], v[200:203]
v_exp_f32 v102, v102
M v[200:203], a[136:139], v[72:75], v[200:203]
s_sub_u32 s33, s42, 1
s_cmp_le_u32 s33, 1
s_cselect_b32 s33, 0x4000, 0
v_add_u32 v2, s33, v2
M v[204:207], a[136:139], v[76:79], v[204:207]
v_exp_f32 v103, v103
M v[204:207], a[132:135], v[44:47], v[204:207]
v_cvt_pk_bf16_f32 v101, v102, v103
s_waitcnt lgkmcnt(6)
M a[104:107], a[112:115], v[40:43], a[104:107]
M a[104:107], a[112:115], v[72:75], a[104:107]
M v[208:211], a[140:143], v[32:35], v[208:211]
v_exp_f32 v116, v116
M v[208:211], a[144:147], v[64:67], v[208:211]
ds_read_b128 a[172:175], v5 offset:39936
ds_read_b128 a[176:179], v5 offset:48128
M v[212:215], a[144:147], v[68:71], v[212:215]
v_exp_f32 v117, v117
M v[212:215], a[140:143], v[36:39], v[212:215]
v_cvt_pk_bf16_f32 v102, v116, v117
M v[216:219], a[140:143], v[40:43], v[216:219]
v_exp_f32 v118, v118
M v[216:219], a[144:147], v[72:75], v[216:219]
M v[220:223], a[144:147], v[76:79], v[220:223]
v_exp_f32 v119, v119
M v[220:223], a[140:143], v[44:47], v[220:223]
v_cvt_pk_bf16_f32 v103, v118, v119
s_waitcnt lgkmcnt(6)
M a[108:111], a[112:115], v[44:47], a[108:111]
M a[108:111], a[112:115], v[76:79], a[108:111]
M v[224:227], a[148:151], v[32:35], v[224:227]
v_exp_f32 v104, v104
M v[224:227], a[152:155], v[64:67], v[224:227]
s_cmp_le_u32 s42, 1
s_cselect_b32 s33, 0x4000, 0
v_add_u32 v5, s33, v5
s_sub_u32 s42, s42, 1
M v[228:231], a[152:155], v[68:71], v[228:231]
v_exp_f32 v105, v105
M v[228:231], a[148:151], v[36:39], v[228:231]
v_cvt_pk_bf16_f32 v104, v104, v105
M v[232:235], a[148:151], v[40:43], v[232:235]
v_exp_f32 v106, v106
M v[232:235], a[152:155], v[72:75], v[232:235]
M v[236:239], a[152:155], v[76:79], v[236:239]
v_exp_f32 v107, v107
M v[236:239], a[148:151], v[44:47], v[236:239]
v_cvt_pk_bf16_f32 v105, v106, v107
s_waitcnt lgkmcnt(4)
M v[240:243], a[156:159], v[32:35], v[240:243]
v_exp_f32 v120, v120
M v[240:243], a[160:163], v[64:67], v[240:243]
M v[244:247], a[160:163], v[68:71], v[244:247]
v_exp_f32 v121, v121
M v[244:247], a[156:159], v[36:39], v[244:247]
v_cvt_pk_bf16_f32 v106, v120, v121
M v[248:251], a[156:159], v[40:43], v[248:251]
v_exp_f32 v122, v122
M v[248:251], a[160:163], v[72:75], v[248:251]
s_waitcnt vmcnt(0) lgkmcnt(0)
s_barrier
ds_read_b128 a[116:119], v3 offset:0
ds_read_b128 a[120:123], v3 offset:1024
M v[252:255], a[160:163], v[76:79], v[252:255]
v_exp_f32 v123, v123
M v[252:255], a[156:159], v[44:47], v[252:255]
v_cvt_pk_bf16_f32 v107, v122, v123
M a[64:67], a[164:167], v[32:35], a[64:67]
v_exp_f32 v108, v108
M a[64:67], a[168:171], v[64:67], a[64:67]
ds_read_b128 a[124:127], v3 offset:2048
ds_read_b128 a[128:131], v3 offset:3072
M a[68:71], a[168:171], v[68:71], a[68:71]
v_exp_f32 v109, v109
M a[68:71], a[164:167], v[36:39], a[68:71]
v_cvt_pk_bf16_f32 v108, v108, v109
M a[72:75], a[164:167], v[40:43], a[72:75]
v_exp_f32 v110, v110
M a[72:75], a[168:171], v[72:75], a[72:75]
ds_read_b128 a[132:135], v3 offset:4096
ds_read_b128 a[136:139], v3 offset:5120
M a[76:79], a[168:171], v[76:79], a[76:79]
v_exp_f32 v111, v111
M a[76:79], a[164:167], v[44:47], a[76:79]
v_cvt_pk_bf16_f32 v109, v110, v111
M a[80:83], a[172:175], v[32:35], a[80:83]
v_exp_f32 v124, v124
M a[80:83], a[176:179], v[64:67], a[80:83]
ds_read_b128 a[140:143], v3 offset:6144
ds_read_b128 a[144:147], v3 offset:7168
M a[84:87], a[176:179], v[68:71], a[84:87]
v_exp_f32 v125, v125
M a[84:87], a[172:175], v[36:39], a[84:87]
v_cvt_pk_bf16_f32 v110, v124, v125
M a[88:91], a[172:175], v[40:43], a[88:91]
v_exp_f32 v126, v126
M a[88:91], a[176:179], v[72:75], a[88:91]
M a[92:95], a[176:179], v[76:79], a[92:95]
v_exp_f32 v127, v127
M a[92:95], a[172:175], v[44:47], a[92:95]
v_cvt_pk_bf16_f32 v111, v126, v127
s_add_u32 m0, s29, 0
s_waitcnt lgkmcnt(4)
M v[32:35], a[116:119], a[0:3], 0
v_exp_f32 v128, v128
M v[32:35], a[120:123], a[4:7], v[32:35]
ds_read_b128 a[148:151], v3 offset:8192
ds_read_b128 a[152:155], v3 offset:9216
M v[32:35], a[124:127], a[8:11], v[32:35]
v_exp_f32 v129, v129
M v[32:35], a[128:131], a[12:15], v[32:35]
buffer_load_dwordx4 v1, s[12:15], s25 offen offset:0 sc1 lds
s_add_u32 s32, s25, 4096
M v[36:39], a[128:131], a[28:31], 0
v_exp_f32 v130, v130
M v[36:39], a[124:127], a[24:27], v[36:39]
v_cvt_pk_bf16_f32 v128, v128, v129
M v[36:39], a[120:123], a[20:23], v[36:39]
v_exp_f32 v131, v131
M v[36:39], a[116:119], a[16:19], v[36:39]
buffer_load_dwordx4 v1, s[12:15], s25 offen offset:1024 sc1 lds
M v[40:43], a[116:119], a[32:35], 0
v_exp_f32 v144, v144
M v[40:43], a[120:123], a[36:39], v[40:43]
ds_read_b128 a[156:159], v3 offset:10240
ds_read_b128 a[160:163], v3 offset:11264
M v[40:43], a[124:127], a[40:43], v[40:43]
v_exp_f32 v145, v145
M v[40:43], a[128:131], a[44:47], v[40:43]
buffer_load_dwordx4 v1, s[12:15], s25 offen offset:2048 sc1 lds
M v[44:47], a[128:131], a[60:63], 0
v_exp_f32 v146, v146
M v[44:47], a[124:127], a[56:59], v[44:47]
v_cvt_pk_bf16_f32 v129, v130, v131
v_cvt_pk_bf16_f32 v130, v144, v145
M v[44:47], a[120:123], a[52:55], v[44:47]
v_exp_f32 v147, v147
M v[44:47], a[116:119], a[48:51], v[44:47]
buffer_load_dwordx4 v1, s[12:15], s25 offen offset:3072 sc1 lds
s_add_u32 m0, s29, 4096
s_waitcnt lgkmcnt(4)
M v[48:51], a[132:135], a[0:3], 0
v_exp_f32 v132, v132
M v[48:51], a[136:139], a[4:7], v[48:51]
ds_read_b128 a[164:167], v3 offset:12288
ds_read_b128 a[168:171], v3 offset:13312
M v[48:51], a[140:143], a[8:11], v[48:51]
v_exp_f32 v133, v133
M v[48:51], a[144:147], a[12:15], v[48:51]
buffer_load_dwordx4 v1, s[12:15], s32 offen offset:0 sc1 lds
M v[52:55], a[144:147], a[28:31], 0
v_exp_f32 v134, v134
M v[52:55], a[140:143], a[24:27], v[52:55]
v_cvt_pk_bf16_f32 v131, v146, v147
v_cvt_pk_bf16_f32 v132, v132, v133
M v[52:55], a[136:139], a[20:23], v[52:55]
v_exp_f32 v135, v135
M v[52:55], a[132:135], a[16:19], v[52:55]
buffer_load_dwordx4 v1, s[12:15], s32 offen offset:1024 sc1 lds
M v[56:59], a[132:135], a[32:35], 0
v_exp_f32 v148, v148
M v[56:59], a[136:139], a[36:39], v[56:59]
ds_read_b128 a[172:175], v3 offset:14336
ds_read_b128 a[176:179], v3 offset:15360
M v[56:59], a[140:143], a[40:43], v[56:59]
v_exp_f32 v149, v149
M v[56:59], a[144:147], a[44:47], v[56:59]
buffer_load_dwordx4 v1, s[12:15], s32 offen offset:2048 sc1 lds
M v[60:63], a[144:147], a[60:63], 0
v_exp_f32 v150, v150
M v[60:63], a[140:143], a[56:59], v[60:63]
v_cvt_pk_bf16_f32 v133, v134, v135
v_cvt_pk_bf16_f32 v134, v148, v149
M v[60:63], a[136:139], a[52:55], v[60:63]
v_exp_f32 v151, v151
M v[60:63], a[132:135], a[48:51], v[60:63]
buffer_load_dwordx4 v1, s[12:15], s32 offen offset:3072 sc1 lds
s_add_u32 m0, s29, 32768
s_waitcnt lgkmcnt(4)
M v[64:67], a[148:151], a[0:3], 0
v_exp_f32 v136, v136
M v[64:67], a[152:155], a[4:7], v[64:67]
ds_read_b128 a[116:119], v6 offset:32768
ds_read_b128 a[120:123], v6 offset:40960
M v[64:67], a[156:159], a[8:11], v[64:67]
v_exp_f32 v137, v137
M v[64:67], a[160:163], a[12:15], v[64:67]
buffer_load_dwordx4 v1, s[12:15], s26 offen offset:0 sc1 lds
s_add_u32 s43, s26, 4096
M v[68:71], a[160:163], a[28:31], 0
v_exp_f32 v138, v138
M v[68:71], a[156:159], a[24:27], v[68:71]
v_cvt_pk_bf16_f32 v135, v150, v151
v_cvt_pk_bf16_f32 v136, v136, v137
M v[68:71], a[152:155], a[20:23], v[68:71]
v_exp_f32 v139, v139
M v[68:71], a[148:151], a[16:19], v[68:71]
buffer_load_dwordx4 v1, s[12:15], s26 offen offset:1024 sc1 lds
M v[72:75], a[148:151], a[32:35], 0
v_exp_f32 v152, v152
M v[72:75], a[152:155], a[36:39], v[72:75]
ds_read_b128 a[124:127], v6 offset:33792
ds_read_b128 a[128:131], v6 offset:41984
M v[72:75], a[156:159], a[40:43], v[72:75]
v_exp_f32 v153, v153
M v[72:75], a[160:163], a[44:47], v[72:75]
buffer_load_dwordx4 v1, s[12:15], s26 offen offset:2048 sc1 lds
M v[76:79], a[160:163], a[60:63], 0
v_exp_f32 v154, v154
M v[76:79], a[156:159], a[56:59], v[76:79]
v_cvt_pk_bf16_f32 v137, v138, v139
v_cvt_pk_bf16_f32 v138, v152, v153
M v[76:79], a[152:155], a[52:55], v[76:79]
v_exp_f32 v155, v155
M v[76:79], a[148:151], a[48:51], v[76:79]
buffer_load_dwordx4 v1, s[12:15], s26 offen offset:3072 sc1 lds
s_add_u32 m0, s29, 36864
s_waitcnt lgkmcnt(4)
M v[80:83], a[164:167], a[0:3], 0
v_exp_f32 v140, v140
M v[80:83], a[168:171], a[4:7], v[80:83]
ds_read_b128 a[132:135], v6 offset:34816
ds_read_b128 a[136:139], v6 offset:43008
M v[80:83], a[172:175], a[8:11], v[80:83]
v_exp_f32 v141, v141
M v[80:83], a[176:179], a[12:15], v[80:83]
buffer_load_dwordx4 v1, s[12:15], s43 offen offset:0 sc1 lds
M v[84:87], a[176:179], a[28:31], 0
v_exp_f32 v142, v142
M v[84:87], a[172:175], a[24:27], v[84:87]
v_cvt_pk_bf16_f32 v139, v154, v155
v_cvt_pk_bf16_f32 v140, v140, v141
M v[84:87], a[168:171], a[20:23], v[84:87]
v_exp_f32 v143, v143
M v[84:87], a[164:167], a[16:19], v[84:87]
buffer_load_dwordx4 v1, s[12:15], s43 offen offset:1024 sc1 lds
M v[88:91], a[164:167], a[32:35], 0
v_exp_f32 v156, v156
M v[88:91], a[168:171], a[36:39], v[88:91]
ds_read_b128 a[140:143], v6 offset:35840
ds_read_b128 a[144:147], v6 offset:44032
M v[88:91], a[172:175], a[40:43], v[88:91]
v_exp_f32 v157, v157
M v[88:91], a[176:179], a[44:47], v[88:91]
buffer_load_dwordx4 v1, s[12:15], s43 offen offset:2048 sc1 lds
M v[92:95], a[176:179], a[60:63], 0
v_exp_f32 v158, v158
M v[92:95], a[172:175], a[56:59], v[92:95]
v_cvt_pk_bf16_f32 v141, v142, v143
v_cvt_pk_bf16_f32 v142, v156, v157
M v[92:95], a[168:171], a[52:55], v[92:95]
v_exp_f32 v159, v159
M v[92:95], a[164:167], a[48:51], v[92:95]
buffer_load_dwordx4 v1, s[12:15], s43 offen offset:3072 sc1 lds
v_cvt_pk_bf16_f32 v143, v158, v159
s_waitcnt lgkmcnt(6)
M v[160:163], a[116:119], v[96:99], v[160:163]
v_exp_f32 v32, v32
M v[160:163], a[120:123], v[128:131], v[160:163]
ds_read_b128 a[148:151], v6 offset:36864
ds_read_b128 a[152:155], v6 offset:45056
M v[164:167], a[120:123], v[132:135], v[164:167]
v_exp_f32 v33, v33
M v[164:167], a[116:119], v[100:103], v[164:167]
v_cvt_pk_bf16_f32 v32, v32, v33
M v[168:171], a[116:119], v[104:107], v[168:171]
v_exp_f32 v34, v34
M v[168:171], a[120:123], v[136:139], v[168:171]
s_add_u32 s25, s25, 32768
s_cmp_eq_u32 s25, s27
M v[172:175], a[120:123], v[140:143], v[172:175]
v_exp_f32 v35, v35
M v[172:175], a[116:119], v[108:111], v[172:175]
v_cvt_pk_bf16_f32 v33, v34, v35
s_waitcnt lgkmcnt(6)
M a[96:99], a[112:115], v[96:99], a[96:99]
s_cselect_b32 s25, s28, s25
s_cselect_b32 s27, s56, s27
M a[96:99], a[112:115], v[128:131], a[96:99]
s_cselect_b32 s28, s57, s28
s_cselect_b32 s56, -1, s56
M v[176:179], a[124:127], v[96:99], v[176:179]
v_exp_f32 v48, v48
M v[176:179], a[128:131], v[128:131], v[176:179]
ds_read_b128 a[156:159], v6 offset:37888
ds_read_b128 a[160:163], v6 offset:46080
M v[180:183], a[128:131], v[132:135], v[180:183]
v_exp_f32 v49, v49
M v[180:183], a[124:127], v[100:103], v[180:183]
v_cvt_pk_bf16_f32 v34, v48, v49
M v[184:187], a[124:127], v[104:107], v[184:187]
v_exp_f32 v50, v50
M v[184:187], a[128:131], v[136:139], v[184:187]
s_add_u32 s26, s26, 32768
s_cmp_eq_u32 s26, s62
M v[188:191], a[128:131], v[140:143], v[188:191]
v_exp_f32 v51, v51
M v[188:191], a[124:127], v[108:111], v[188:191]
v_cvt_pk_bf16_f32 v35, v50, v51
s_waitcnt lgkmcnt(6)
M a[100:103], a[112:115], v[100:103], a[100:103]
s_cselect_b32 s26, s63, s26
s_cselect_b32 s62, s58, s62
M a[100:103], a[112:115], v[132:135], a[100:103]
s_cselect_b32 s63, s59, s63
s_cselect_b32 s58, -1, s58
M v[192:195], a[132:135], v[96:99], v[192:195]
v_exp_f32 v36, v36
M v[192:195], a[136:139], v[128:131], v[192:195]
ds_read_b128 a[164:167], v6 offset:38912
ds_read_b128 a[168:171], v6 offset:47104
M v[196:199], a[136:139], v[132:135], v[196:199]
v_exp_f32 v37, v37
M v[196:199], a[132:135], v[100:103], v[196:199]
v_cvt_pk_bf16_f32 v36, v36, v37
M v[200:203], a[132:135], v[104:107], v[200:203]
v_exp_f32 v38, v38
M v[200:203], a[136:139], v[136:139], v[200:203]
s_sub_u32 s33, s42, 1
s_cmp_le_u32 s33, 1
s_cselect_b32 s33, 0x4000, 0
v_add_u32 v3, s33, v3
M v[204:207], a[136:139], v[140:143], v[204:207]
v_exp_f32 v39, v39
M v[204:207], a[132:135], v[108:111], v[204:207]
v_cvt_pk_bf16_f32 v37, v38, v39
s_waitcnt lgkmcnt(6)
M a[104:107], a[112:115], v[104:107], a[104:107]
M a[104:107], a[112:115], v[136:139], a[104:107]
M v[208:211], a[140:143], v[96:99], v[208:211]
v_exp_f32 v52, v52
M v[208:211], a[144:147], v[128:131], v[208:211]
ds_read_b128 a[172:175], v6 offset:39936
ds_read_b128 a[176:179], v6 offset:48128
M v[212:215], a[144:147], v[132:135], v[212:215]
v_exp_f32 v53, v53
M v[212:215], a[140:143], v[100:103], v[212:215]
v_cvt_pk_bf16_f32 v38, v52, v53
M v[216:219], a[140:143], v[104:107], v[216:219]
v_exp_f32 v54, v54
M v[216:219], a[144:147], v[136:139], v[216:219]
M v[220:223], a[144:147], v[140:143], v[220:223]
v_exp_f32 v55, v55
M v[220:223], a[140:143], v[108:111], v[220:223]
v_cvt_pk_bf16_f32 v39, v54, v55
s_waitcnt lgkmcnt(6)
M a[108:111], a[112:115], v[108:111], a[108:111]
M a[108:111], a[112:115], v[140:143], a[108:111]
M v[224:227], a[148:151], v[96:99], v[224:227]
v_exp_f32 v40, v40
M v[224:227], a[152:155], v[128:131], v[224:227]
s_cmp_le_u32 s42, 1
s_cselect_b32 s33, 0x4000, 0
v_add_u32 v6, s33, v6
s_sub_u32 s42, s42, 1
M v[228:231], a[152:155], v[132:135], v[228:231]
v_exp_f32 v41, v41
M v[228:231], a[148:151], v[100:103], v[228:231]
v_cvt_pk_bf16_f32 v40, v40, v41
M v[232:235], a[148:151], v[104:107], v[232:235]
v_exp_f32 v42, v42
M v[232:235], a[152:155], v[136:139], v[232:235]
M v[236:239], a[152:155], v[140:143], v[236:239]
v_exp_f32 v43, v43
M v[236:239], a[148:151], v[108:111], v[236:239]
v_cvt_pk_bf16_f32 v41, v42, v43
s_waitcnt lgkmcnt(4)
M v[240:243], a[156:159], v[96:99], v[240:243]
v_exp_f32 v56, v56
M v[240:243], a[160:163], v[128:131], v[240:243]
M v[244:247], a[160:163], v[132:135], v[244:247]
v_exp_f32 v57, v57
M v[244:247], a[156:159], v[100:103], v[244:247]
v_cvt_pk_bf16_f32 v42, v56, v57
M v[248:251], a[156:159], v[104:107], v[248:251]
v_exp_f32 v58, v58
M v[248:251], a[160:163], v[136:139], v[248:251]
s_waitcnt vmcnt(0) lgkmcnt(0)
s_barrier
ds_read_b128 a[116:119], v2 offset:0
ds_read_b128 a[120:123], v2 offset:1024
M v[252:255], a[160:163], v[140:143], v[252:255]
v_exp_f32 v59, v59
M v[252:255], a[156:159], v[108:111], v[252:255]
v_cvt_pk_bf16_f32 v43, v58, v59
M a[64:67], a[164:167], v[96:99], a[64:67]
v_exp_f32 v44, v44
M a[64:67], a[168:171], v[128:131], a[64:67]
ds_read_b128 a[124:127], v2 offset:2048
ds_read_b128 a[128:131], v2 offset:3072
M a[68:71], a[168:171], v[132:135], a[68:71]
v_exp_f32 v45, v45
M a[68:71], a[164:167], v[100:103], a[68:71]
v_cvt_pk_bf16_f32 v44, v44, v45
M a[72:75], a[164:167], v[104:107], a[72:75]
v_exp_f32 v46, v46
M a[72:75], a[168:171], v[136:139], a[72:75]
ds_read_b128 a[132:135], v2 offset:4096
ds_read_b128 a[136:139], v2 offset:5120
M a[76:79], a[168:171], v[140:143], a[76:79]
v_exp_f32 v47, v47
M a[76:79], a[164:167], v[108:111], a[76:79]
v_cvt_pk_bf16_f32 v45, v46, v47
M a[80:83], a[172:175], v[96:99], a[80:83]
v_exp_f32 v60, v60
M a[80:83], a[176:179], v[128:131], a[80:83]
ds_read_b128 a[140:143], v2 offset:6144
ds_read_b128 a[144:147], v2 offset:7168
M a[84:87], a[176:179], v[132:135], a[84:87]
v_exp_f32 v61, v61
M a[84:87], a[172:175], v[100:103], a[84:87]
v_cvt_pk_bf16_f32 v46, v60, v61
M a[88:91], a[172:175], v[104:107], a[88:91]
v_exp_f32 v62, v62
M a[88:91], a[176:179], v[136:139], a[88:91]
M a[92:95], a[176:179], v[140:143], a[92:95]
v_exp_f32 v63, v63
M a[92:95], a[172:175], v[108:111], a[92:95]
v_cvt_pk_bf16_f32 v47, v62, v63
s_sub_u32 s30, s30, 1
s_cmp_lg_u32 s30, 0
s_cbranch_scc1 Lk2_l3
s_cmp_eq_u32 s23, 1
s_cbranch_scc1 Lk2_g1b
s_add_u32 m0, s29, 65536
s_waitcnt lgkmcnt(4)
M v[96:99], a[116:119], a[0:3], v[16:19]
v_exp_f32 v64, v64
M v[96:99], a[120:123], a[4:7], v[96:99]
ds_read_b128 a[148:151], v2 offset:8192
ds_read_b128 a[152:155], v2 offset:9216
M v[96:99], a[124:127], a[8:11], v[96:99]
v_exp_f32 v65, v65
M v[96:99], a[128:131], a[12:15], v[96:99]
buffer_load_dwordx4 v1, s[12:15], s25 offen offset:0 sc1 lds
s_add_u32 s32, s25, 4096
M v[100:103], a[128:131], a[28:31], 0
v_exp_f32 v66, v66
M v[100:103], a[124:127], a[24:27], v[100:103]
v_cvt_pk_bf16_f32 v64, v64, v65
M v[100:103], a[120:123], a[20:23], v[100:103]
v_exp_f32 v67, v67
M v[100:103], a[116:119], a[16:19], v[100:103]
buffer_load_dwordx4 v1, s[12:15], s25 offen offset:1024 sc1 lds
M v[104:107], a[116:119], a[32:35], 0
v_exp_f32 v80, v80
M v[104:107], a[120:123], a[36:39], v[104:107]
ds_read_b128 a[156:159], v2 offset:10240
ds_read_b128 a[160:163], v2 offset:11264
M v[104:107], a[124:127], a[40:43], v[104:107]
v_exp_f32 v81, v81
M v[104:107], a[128:131], a[44:47], v[104:107]
buffer_load_dwordx4 v1, s[12:15], s25 offen offset:2048 sc1 lds
M v[108:111], a[128:131], a[60:63], 0
v_exp_f32 v82, v82
M v[108:111], a[124:127], a[56:59], v[108:111]
v_cvt_pk_bf16_f32 v65, v66, v67
v_cvt_pk_bf16_f32 v66, v80, v81
M v[108:111], a[120:123], a[52:55], v[108:111]
v_exp_f32 v83, v83
M v[108:111], a[116:119], a[48:51], v[108:111]
buffer_load_dwordx4 v1, s[12:15], s25 offen offset:3072 sc1 lds
s_add_u32 m0, s29, 69632
s_waitcnt lgkmcnt(4)
v_exp_f32 v68, v68
ds_read_b128 a[164:167], v2 offset:12288
ds_read_b128 a[168:171], v2 offset:13312
v_exp_f32 v69, v69
buffer_load_dwordx4 v1, s[12:15], s32 offen offset:0 sc1 lds
M v[116:119], a[144:147], a[28:31], v[16:19]
v_exp_f32 v70, v70
M v[116:119], a[140:143], a[24:27], v[116:119]
v_cvt_pk_bf16_f32 v67, v82, v83
v_cvt_pk_bf16_f32 v68, v68, v69
M v[116:119], a[136:139], a[20:23], v[116:119]
v_exp_f32 v71, v71
M v[116:119], a[132:135], a[16:19], v[116:119]
buffer_load_dwordx4 v1, s[12:15], s32 offen offset:1024 sc1 lds
M v[120:123], a[132:135], a[32:35], 0
v_exp_f32 v84, v84
M v[120:123], a[136:139], a[36:39], v[120:123]
ds_read_b128 a[172:175], v2 offset:14336
ds_read_b128 a[176:179], v2 offset:15360
M v[120:123], a[140:143], a[40:43], v[120:123]
v_exp_f32 v85, v85
M v[120:123], a[144:147], a[44:47], v[120:123]
buffer_load_dwordx4 v1, s[12:15], s32 offen offset:2048 sc1 lds
M v[124:127], a[144:147], a[60:63], 0
v_exp_f32 v86, v86
M v[124:127], a[140:143], a[56:59], v[124:127]
v_cvt_pk_bf16_f32 v69, v70, v71
v_cvt_pk_bf16_f32 v70, v84, v85
M v[124:127], a[136:139], a[52:55], v[124:127]
v_exp_f32 v87, v87
M v[124:127], a[132:135], a[48:51], v[124:127]
buffer_load_dwordx4 v1, s[12:15], s32 offen offset:3072 sc1 lds
s_add_u32 m0, s29, 98304
s_waitcnt lgkmcnt(4)
v_exp_f32 v72, v72
ds_read_b128 a[116:119], v5 offset:32768
ds_read_b128 a[120:123], v5 offset:40960
v_exp_f32 v73, v73
buffer_load_dwordx4 v1, s[12:15], s26 offen offset:0 sc1 lds
s_add_u32 s43, s26, 4096
v_exp_f32 v74, v74
v_cvt_pk_bf16_f32 v71, v86, v87
v_cvt_pk_bf16_f32 v72, v72, v73
v_exp_f32 v75, v75
buffer_load_dwordx4 v1, s[12:15], s26 offen offset:1024 sc1 lds
M v[136:139], a[148:151], a[32:35], v[16:19]
v_exp_f32 v88, v88
M v[136:139], a[152:155], a[36:39], v[136:139]
ds_read_b128 a[124:127], v5 offset:33792
ds_read_b128 a[128:131], v5 offset:41984
M v[136:139], a[156:159], a[40:43], v[136:139]
v_exp_f32 v89, v89
M v[136:139], a[160:163], a[44:47], v[136:139]
buffer_load_dwordx4 v1, s[12:15], s26 offen offset:2048 sc1 lds
M v[140:143], a[160:163], a[60:63], 0
v_exp_f32 v90, v90
M v[140:143], a[156:159], a[56:59], v[140:143]
v_cvt_pk_bf16_f32 v73, v74, v75
v_cvt_pk_bf16_f32 v74, v88, v89
M v[140:143], a[152:155], a[52:55], v[140:143]
v_exp_f32 v91, v91
M v[140:143], a[148:151], a[48:51], v[140:143]
buffer_load_dwordx4 v1, s[12:15], s26 offen offset:3072 sc1 lds
s_add_u32 m0, s29, 102400
s_waitcnt lgkmcnt(4)
v_exp_f32 v76, v76
ds_read_b128 a[132:135], v5 offset:34816
ds_read_b128 a[136:139], v5 offset:43008
v_exp_f32 v77, v77
buffer_load_dwordx4 v1, s[12:15], s43 offen offset:0 sc1 lds
v_exp_f32 v78, v78
v_cvt_pk_bf16_f32 v75, v90, v91
v_cvt_pk_bf16_f32 v76, v76, v77
v_exp_f32 v79, v79
buffer_load_dwordx4 v1, s[12:15], s43 offen offset:1024 sc1 lds
v_exp_f32 v92, v92
ds_read_b128 a[140:143], v5 offset:35840
ds_read_b128 a[144:147], v5 offset:44032
v_exp_f32 v93, v93
buffer_load_dwordx4 v1, s[12:15], s43 offen offset:2048 sc1 lds
M v[156:159], a[176:179], a[60:63], v[16:19]
v_exp_f32 v94, v94
M v[156:159], a[172:175], a[56:59], v[156:159]
v_cvt_pk_bf16_f32 v77, v78, v79
v_cvt_pk_bf16_f32 v78, v92, v93
M v[156:159], a[168:171], a[52:55], v[156:159]
v_exp_f32 v95, v95
M v[156:159], a[164:167], a[48:51], v[156:159]
buffer_load_dwordx4 v1, s[12:15], s43 offen offset:3072 sc1 lds
v_cvt_pk_bf16_f32 v79, v94, v95
s_waitcnt lgkmcnt(6)
M v[160:163], a[116:119], v[32:35], v[160:163]
v_exp_f32 v96, v96
M v[160:163], a[120:123], v[64:67], v[160:163]
ds_read_b128 a[148:151], v5 offset:36864
ds_read_b128 a[152:155], v5 offset:45056
M v[164:167], a[120:123], v[68:71], v[164:167]
v_exp_f32 v97, v97
M v[164:167], a[116:119], v[36:39], v[164:167]
v_cvt_pk_bf16_f32 v96, v96, v97
M v[168:171], a[116:119], v[40:43], v[168:171]
v_exp_f32 v98, v98
M v[168:171], a[120:123], v[72:75], v[168:171]
s_add_u32 s25, s25, 32768
s_cmp_eq_u32 s25, s27
M v[172:175], a[120:123], v[76:79], v[172:175]
v_exp_f32 v99, v99
M v[172:175], a[116:119], v[44:47], v[172:175]
v_cvt_pk_bf16_f32 v97, v98, v99
s_waitcnt lgkmcnt(6)
M a[96:99], a[112:115], v[32:35], a[96:99]
s_cselect_b32 s25, s28, s25
s_cselect_b32 s27, s56, s27
M a[96:99], a[112:115], v[64:67], a[96:99]
s_cselect_b32 s28, s57, s28
s_cselect_b32 s56, -1, s56
M v[176:179], a[124:127], v[32:35], v[176:179]
M v[176:179], a[128:131], v[64:67], v[176:179]
ds_read_b128 a[156:159], v5 offset:37888
ds_read_b128 a[160:163], v5 offset:46080
M v[180:183], a[128:131], v[68:71], v[180:183]
M v[180:183], a[124:127], v[36:39], v[180:183]
v_mov_b32 v98, 0
M v[184:187], a[124:127], v[40:43], v[184:187]
M v[184:187], a[128:131], v[72:75], v[184:187]
s_add_u32 s26, s26, 32768
s_cmp_eq_u32 s26, s62
M v[188:191], a[128:131], v[76:79], v[188:191]
M v[188:191], a[124:127], v[44:47], v[188:191]
v_mov_b32 v99, 0
s_waitcnt lgkmcnt(6)
M a[100:103], a[112:115], v[36:39], a[100:103]
s_cselect_b32 s26, s63, s26
s_cselect_b32 s62, s58, s62
M a[100:103], a[112:115], v[68:71], a[100:103]
s_cselect_b32 s63, s59, s63
s_cselect_b32 s58, -1, s58
M v[192:195], a[132:135], v[32:35], v[192:195]
v_exp_f32 v100, v100
M v[192:195], a[136:139], v[64:67], v[192:195]
ds_read_b128 a[164:167], v5 offset:38912
ds_read_b128 a[168:171], v5 offset:47104
M v[196:199], a[136:139], v[68:71], v[196:199]
v_exp_f32 v101, v101
M v[196:199], a[132:135], v[36:39], v[196:199]
v_cvt_pk_bf16_f32 v100, v100, v101
M v[200:203], a[132:135], v[40:43], v[200:203]
v_exp_f32 v102, v102
M v[200:203], a[136:139], v[72:75], v[200:203]
s_sub_u32 s33, s42, 1
s_cmp_le_u32 s33, 1
s_cselect_b32 s33, 0x4000, 0
v_add_u32 v2, s33, v2
M v[204:207], a[136:139], v[76:79], v[204:207]
v_exp_f32 v103, v103
M v[204:207], a[132:135], v[44:47], v[204:207]
v_cvt_pk_bf16_f32 v101, v102, v103
s_waitcnt lgkmcnt(6)
M a[104:107], a[112:115], v[40:43], a[104:107]
M a[104:107], a[112:115], v[72:75], a[104:107]
M v[208:211], a[140:143], v[32:35], v[208:211]
v_exp_f32 v116, v116
M v[208:211], a[144:147], v[64:67], v[208:211]
ds_read_b128 a[172:175], v5 offset:39936
ds_read_b128 a[176:179], v5 offset:48128
M v[212:215], a[144:147], v[68:71], v[212:215]
v_exp_f32 v117, v117
M v[212:215], a[140:143], v[36:39], v[212:215]
v_cvt_pk_bf16_f32 v102, v116, v117
M v[216:219], a[140:143], v[40:43], v[216:219]
v_exp_f32 v118, v118
M v[216:219], a[144:147], v[72:75], v[216:219]
M v[220:223], a[144:147], v[76:79], v[220:223]
v_exp_f32 v119, v119
M v[220:223], a[140:143], v[44:47], v[220:223]
v_cvt_pk_bf16_f32 v103, v118, v119
s_waitcnt lgkmcnt(6)
M a[108:111], a[112:115], v[44:47], a[108:111]
M a[108:111], a[112:115], v[76:79], a[108:111]
M v[224:227], a[148:151], v[32:35], v[224:227]
v_exp_f32 v104, v104
M v[224:227], a[152:155], v[64:67], v[224:227]
s_cmp_le_u32 s42, 1
s_cselect_b32 s33, 0x4000, 0
v_add_u32 v5, s33, v5
s_sub_u32 s42, s42, 1
M v[228:231], a[152:155], v[68:71], v[228:231]
v_exp_f32 v105, v105
M v[228:231], a[148:151], v[36:39], v[228:231]
v_cvt_pk_bf16_f32 v104, v104, v105
M v[232:235], a[148:151], v[40:43], v[232:235]
v_exp_f32 v106, v106
M v[232:235], a[152:155], v[72:75], v[232:235]
M v[236:239], a[152:155], v[76:79], v[236:239]
v_exp_f32 v107, v107
M v[236:239], a[148:151], v[44:47], v[236:239]
v_cvt_pk_bf16_f32 v105, v106, v107
s_waitcnt lgkmcnt(4)
M v[240:243], a[156:159], v[32:35], v[240:243]
v_exp_f32 v120, v120
M v[240:243], a[160:163], v[64:67], v[240:243]
M v[244:247], a[160:163], v[68:71], v[244:247]
v_exp_f32 v121, v121
M v[244:247], a[156:159], v[36:39], v[244:247]
v_cvt_pk_bf16_f32 v106, v120, v121
M v[248:251], a[156:159], v[40:43], v[248:251]
v_exp_f32 v122, v122
M v[248:251], a[160:163], v[72:75], v[248:251]
s_waitcnt vmcnt(0) lgkmcnt(0)
s_barrier
ds_read_b128 a[116:119], v3 offset:0
ds_read_b128 a[120:123], v3 offset:1024
M v[252:255], a[160:163], v[76:79], v[252:255]
v_exp_f32 v123, v123
M v[252:255], a[156:159], v[44:47], v[252:255]
v_cvt_pk_bf16_f32 v107, v122, v123
M a[64:67], a[164:167], v[32:35], a[64:67]
v_exp_f32 v108, v108
M a[64:67], a[168:171], v[64:67], a[64:67]
ds_read_b128 a[124:127], v3 offset:2048
ds_read_b128 a[128:131], v3 offset:3072
M a[68:71], a[168:171], v[68:71], a[68:71]
v_exp_f32 v109, v109
M a[68:71], a[164:167], v[36:39], a[68:71]
v_cvt_pk_bf16_f32 v108, v108, v109
M a[72:75], a[164:167], v[40:43], a[72:75]
v_exp_f32 v110, v110
M a[72:75], a[168:171], v[72:75], a[72:75]
ds_read_b128 a[132:135], v3 offset:4096
ds_read_b128 a[136:139], v3 offset:5120
M a[76:79], a[168:171], v[76:79], a[76:79]
v_exp_f32 v111, v111
M a[76:79], a[164:167], v[44:47], a[76:79]
v_cvt_pk_bf16_f32 v109, v110, v111
M a[80:83], a[172:175], v[32:35], a[80:83]
v_exp_f32 v124, v124
M a[80:83], a[176:179], v[64:67], a[80:83]
ds_read_b128 a[140:143], v3 offset:6144
ds_read_b128 a[144:147], v3 offset:7168
M a[84:87], a[176:179], v[68:71], a[84:87]
v_exp_f32 v125, v125
M a[84:87], a[172:175], v[36:39], a[84:87]
v_cvt_pk_bf16_f32 v110, v124, v125
M a[88:91], a[172:175], v[40:43], a[88:91]
v_exp_f32 v126, v126
M a[88:91], a[176:179], v[72:75], a[88:91]
M a[92:95], a[176:179], v[76:79], a[92:95]
v_exp_f32 v127, v127
M a[92:95], a[172:175], v[44:47], a[92:95]
v_cvt_pk_bf16_f32 v111, v126, v127
s_add_u32 m0, s29, 0
s_nop 0
buffer_load_dwordx4 v1, s[12:15], s25 offen offset:0 sc1 lds
s_add_u32 s32, s25, 4096
buffer_load_dwordx4 v1, s[12:15], s25 offen offset:1024 sc1 lds
buffer_load_dwordx4 v1, s[12:15], s25 offen offset:2048 sc1 lds
buffer_load_dwordx4 v1, s[12:15], s25 offen offset:3072 sc1 lds
s_add_u32 m0, s29, 4096
s_nop 0
buffer_load_dwordx4 v1, s[12:15], s32 offen offset:0 sc1 lds
buffer_load_dwordx4 v1, s[12:15], s32 offen offset:1024 sc1 lds
buffer_load_dwordx4 v1, s[12:15], s32 offen offset:2048 sc1 lds
buffer_load_dwordx4 v1, s[12:15], s32 offen offset:3072 sc1 lds
s_add_u32 m0, s29, 32768
v_exp_f32 v136, v136
s_waitcnt lgkmcnt(7)
ds_read_b128 a[116:119], v6 offset:32768
s_waitcnt lgkmcnt(7)
ds_read_b128 a[120:123], v6 offset:40960
v_exp_f32 v137, v137
buffer_load_dwordx4 v1, s[12:15], s26 offen offset:0 sc1 lds
s_add_u32 s43, s26, 4096
v_exp_f32 v138, v138
v_cvt_pk_bf16_f32 v136, v136, v137
v_exp_f32 v139, v139
buffer_load_dwordx4 v1, s[12:15], s26 offen offset:1024 sc1 lds
s_waitcnt lgkmcnt(7)
ds_read_b128 a[124:127], v6 offset:33792
s_waitcnt lgkmcnt(7)
ds_read_b128 a[128:131], v6 offset:41984
buffer_load_dwordx4 v1, s[12:15], s26 offen offset:2048 sc1 lds
v_cvt_pk_bf16_f32 v137, v138, v139
v_mov_b32 v138, 0
buffer_load_dwordx4 v1, s[12:15], s26 offen offset:3072 sc1 lds
s_add_u32 m0, s29, 36864
v_exp_f32 v140, v140
s_waitcnt lgkmcnt(7)
ds_read_b128 a[132:135], v6 offset:34816
s_waitcnt lgkmcnt(7)
ds_read_b128 a[136:139], v6 offset:43008
v_exp_f32 v141, v141
buffer_load_dwordx4 v1, s[12:15], s43 offen offset:0 sc1 lds
v_exp_f32 v142, v142
v_mov_b32 v139, 0
v_cvt_pk_bf16_f32 v140, v140, v141
v_exp_f32 v143, v143
buffer_load_dwordx4 v1, s[12:15], s43 offen offset:1024 sc1 lds
v_exp_f32 v156, v156
s_waitcnt lgkmcnt(7)
ds_read_b128 a[140:143], v6 offset:35840
s_waitcnt lgkmcnt(7)
ds_read_b128 a[144:147], v6 offset:44032
v_exp_f32 v157, v157
buffer_load_dwordx4 v1, s[12:15], s43 offen offset:2048 sc1 lds
v_exp_f32 v158, v158
v_cvt_pk_bf16_f32 v141, v142, v143
v_cvt_pk_bf16_f32 v142, v156, v157
v_exp_f32 v159, v159
buffer_load_dwordx4 v1, s[12:15], s43 offen offset:3072 sc1 lds
v_cvt_pk_bf16_f32 v143, v158, v159
s_waitcnt lgkmcnt(6)
M v[160:163], a[116:119], v[96:99], v[160:163]
ds_read_b128 a[148:151], v6 offset:36864
ds_read_b128 a[152:155], v6 offset:45056
M v[164:167], a[116:119], v[100:103], v[164:167]
M v[168:171], a[116:119], v[104:107], v[168:171]
M v[168:171], a[120:123], v[136:139], v[168:171]
s_add_u32 s25, s25, 32768
s_cmp_eq_u32 s25, s27
M v[172:175], a[120:123], v[140:143], v[172:175]
M v[172:175], a[116:119], v[108:111], v[172:175]
s_waitcnt lgkmcnt(6)
M a[96:99], a[112:115], v[96:99], a[96:99]
s_cselect_b32 s25, s28, s25
s_cselect_b32 s27, s56, s27
s_cselect_b32 s28, s57, s28
s_cselect_b32 s56, -1, s56
M v[176:179], a[124:127], v[96:99], v[176:179]
ds_read_b128 a[156:159], v6 offset:37888
ds_read_b128 a[160:163], v6 offset:46080
M v[180:183], a[124:127], v[100:103], v[180:183]
M v[184:187], a[124:127], v[104:107], v[184:187]
M v[184:187], a[128:131], v[136:139], v[184:187]
s_add_u32 s26, s26, 32768
s_cmp_eq_u32 s26, s62
M v[188:191], a[128:131], v[140:143], v[188:191]
M v[188:191], a[124:127], v[108:111], v[188:191]
s_waitcnt lgkmcnt(6)
M a[100:103], a[112:115], v[100:103], a[100:103]
s_cselect_b32 s26, s63, s26
s_cselect_b32 s62, s58, s62
s_cselect_b32 s63, s59, s63
s_cselect_b32 s58, -1, s58
M v[192:195], a[132:135], v[96:99], v[192:195]
ds_read_b128 a[164:167], v6 offset:38912
ds_read_b128 a[168:171], v6 offset:47104
M v[196:199], a[132:135], v[100:103], v[196:199]
M v[200:203], a[132:135], v[104:107], v[200:203]
M v[200:203], a[136:139], v[136:139], v[200:203]
s_sub_u32 s33, s42, 1
s_cmp_le_u32 s33, 1
s_cselect_b32 s33, 0x4000, 0
v_add_u32 v3, s33, v3
M v[204:207], a[136:139], v[140:143], v[204:207]
M v[204:207], a[132:135], v[108:111], v[204:207]
s_waitcnt lgkmcnt(6)
M a[104:107], a[112:115], v[104:107], a[104:107]
M a[104:107], a[112:115], v[136:139], a[104:107]
M v[208:211], a[140:143], v[96:99], v[208:211]
ds_read_b128 a[172:175], v6 offset:39936
ds_read_b128 a[176:179], v6 offset:48128
M v[212:215], a[140:143], v[100:103], v[212:215]
M v[216:219], a[140:143], v[104:107], v[216:219]
M v[216:219], a[144:147], v[136:139], v[216:219]
M v[220:223], a[144:147], v[140:143], v[220:223]
M v[220:223], a[140:143], v[108:111], v[220:223]
s_waitcnt lgkmcnt(6)
M a[108:111], a[112:115], v[108:111], a[108:111]
M a[108:111], a[112:115], v[140:143], a[108:111]
M v[224:227], a[148:151], v[96:99], v[224:227]
s_cmp_le_u32 s42, 1
s_cselect_b32 s33, 0x4000, 0
v_add_u32 v6, s33, v6
s_sub_u32 s42, s42, 1
M v[228:231], a[148:151], v[100:103], v[228:231]
M v[232:235], a[148:151], v[104:107], v[232:235]
M v[232:235], a[152:155], v[136:139], v[232:235]
M v[236:239], a[152:155], v[140:143], v[236:239]
M v[236:239], a[148:151], v[108:111], v[236:239]
s_waitcnt lgkmcnt(4)
M v[240:243], a[156:159], v[96:99], v[240:243]
M v[244:247], a[156:159], v[100:103], v[244:247]
M v[248:251], a[156:159], v[104:107], v[248:251]
M v[248:251], a[160:163], v[136:139], v[248:251]
s_waitcnt vmcnt(0) lgkmcnt(0)
s_barrier
ds_read_b128 a[116:119], v2 offset:0
ds_read_b128 a[120:123], v2 offset:1024
M v[252:255], a[160:163], v[140:143], v[252:255]
M v[252:255], a[156:159], v[108:111], v[252:255]
M a[64:67], a[164:167], v[96:99], a[64:67]
ds_read_b128 a[124:127], v2 offset:2048
ds_read_b128 a[128:131], v2 offset:3072
M a[68:71], a[164:167], v[100:103], a[68:71]
M a[72:75], a[164:167], v[104:107], a[72:75]
M a[72:75], a[168:171], v[136:139], a[72:75]
ds_read_b128 a[132:135], v2 offset:4096
ds_read_b128 a[136:139], v2 offset:5120
M a[76:79], a[168:171], v[140:143], a[76:79]
M a[76:79], a[164:167], v[108:111], a[76:79]
M a[80:83], a[172:175], v[96:99], a[80:83]
ds_read_b128 a[140:143], v2 offset:6144
ds_read_b128 a[144:147], v2 offset:7168
M a[84:87], a[172:175], v[100:103], a[84:87]
M a[88:91], a[172:175], v[104:107], a[88:91]
M a[88:91], a[176:179], v[136:139], a[88:91]
M a[92:95], a[176:179], v[140:143], a[92:95]
M a[92:95], a[172:175], v[108:111], a[92:95]
s_and_b32 s3, s2, 3
s_lshl_b32 s3, s3, 2
s_bfe_u32 s27, s2, 0x20003
s_add_u32 s27, s3, s27
s_lshl_b32 s43, s27, 8
s_add_u32 s43, s43, 16789504
v_lshlrev_b32 v15, 2, v0
buffer_load_dword v7, v15, s[52:55], s43 offen sc1
s_lshl_b32 s33, s23, 14
s_add_u32 s34, s33, 131072
s_add_u32 s33, s33, 98304
v_add_u32 v2, s34, v1
v_add_u32 v3, s33, v1
s_mov_b32 s61, 0
s_bfe_u32 s3, s2, 0x10002
s_lshl_b32 s3, s3, 3
s_lshr_b32 s28, s2, 5
s_add_u32 s28, s3, s28
s_lshl_b32 s25, s27, 18
s_lshl_b32 s3, s101, 12
s_add_u32 s25, s25, s3
s_lshl_b32 s26, s28, 7
s_lshl_b32 s42, s101, 11
s_add_u32 s44, s4, 83886080
s_addc_u32 s45, s5, 0
s_mov_b32 s46, 4194304
s_mov_b32 s47, 0x00020000
s_mov_b32 s50, 2097152
s_mov_b32 s51, 0x00020000
s_lshl_b32 s3, s101, 4
v_lshrrev_b32 v96, 3, v0
v_and_b32 v97, 6, v96
ds_write_b128 v2, v[160:163] offset:0
v_and_b32 v98, 7, v0
ds_write_b128 v2, v[164:167] offset:1024
v_xor_b32 v97, v97, v98
ds_write_b128 v2, v[168:171] offset:2048
v_add_u32 v96, s3, v96
ds_write_b128 v2, v[172:175] offset:3072
v_lshlrev_b32 v96, 11, v96
ds_write_b128 v2, v[176:179] offset:4096
v_lshl_add_u32 v99, v97, 4, v96
v_add_u32 v100, 15360, v99
ds_write_b128 v2, v[180:183] offset:5120
s_waitcnt vmcnt(0) lgkmcnt(0)
s_barrier
ds_write_b128 v2, v[184:187] offset:6144
v_cmp_ne_u32 vcc, 1, v7
s_nop 0
s_cbranch_vccnz Lk3_spinb3
Lk3_gotb3:
s_add_u32 m0, s42, 16384
s_nop 0
buffer_load_dwordx4 v99, s[48:51], s26 offen offset:0 lds
ds_write_b128 v2, v[188:191] offset:7168
buffer_load_dwordx4 v100, s[48:51], s26 offen offset:1024 lds
ds_write_b128 v2, v[192:195] offset:8192
buffer_load_dwordx4 a[192:195], v1, s[44:47], s25 offen offset:0 sc1
buffer_load_dwordx4 a[196:199], v1, s[44:47], s25 offen offset:1024 sc1
ds_write_b128 v2, v[196:199] offset:9216
buffer_load_dwordx4 a[200:203], v1, s[44:47], s25 offen offset:2048 sc1
buffer_load_dwordx4 a[204:207], v1, s[44:47], s25 offen offset:3072 sc1
ds_write_b128 v2, v[200:203] offset:10240
s_add_u32 s25, s25, 16384
s_add_u32 s26, s26, 131072
ds_write_b128 v2, v[204:207] offset:11264
s_add_u32 m0, s42, 32768
s_nop 0
buffer_load_dwordx4 v99, s[48:51], s26 offen offset:0 lds
buffer_load_dwordx4 v100, s[48:51], s26 offen offset:1024 lds
ds_write_b128 v2, v[208:211] offset:12288
buffer_load_dwordx4 a[224:227], v1, s[44:47], s25 offen offset:0 sc1
ds_write_b128 v2, v[212:215] offset:13312
buffer_load_dwordx4 a[228:231], v1, s[44:47], s25 offen offset:1024 sc1
buffer_load_dwordx4 a[232:235], v1, s[44:47], s25 offen offset:2048 sc1
ds_write_b128 v2, v[216:219] offset:14336
buffer_load_dwordx4 a[236:239], v1, s[44:47], s25 offen offset:3072 sc1
s_add_u32 s25, s25, 16384
s_add_u32 s26, s26, 131072
ds_write_b128 v2, v[220:223] offset:15360
s_waitcnt lgkmcnt(0)
s_branch Lk2_mg1
Lk2_g1b:
s_add_u32 m0, s29, 65536
s_waitcnt lgkmcnt(4)
M v[96:99], a[116:119], a[0:3], 0
v_exp_f32 v64, v64
M v[96:99], a[120:123], a[4:7], v[96:99]
ds_read_b128 a[148:151], v2 offset:8192
ds_read_b128 a[152:155], v2 offset:9216
M v[96:99], a[124:127], a[8:11], v[96:99]
v_exp_f32 v65, v65
M v[96:99], a[128:131], a[12:15], v[96:99]
buffer_load_dwordx4 v1, s[12:15], s25 offen offset:0 sc1 lds
s_add_u32 s32, s25, 4096
M v[100:103], a[128:131], a[28:31], 0
v_exp_f32 v66, v66
M v[100:103], a[124:127], a[24:27], v[100:103]
v_cvt_pk_bf16_f32 v64, v64, v65
M v[100:103], a[120:123], a[20:23], v[100:103]
v_exp_f32 v67, v67
M v[100:103], a[116:119], a[16:19], v[100:103]
buffer_load_dwordx4 v1, s[12:15], s25 offen offset:1024 sc1 lds
M v[104:107], a[116:119], a[32:35], 0
v_exp_f32 v80, v80
M v[104:107], a[120:123], a[36:39], v[104:107]
ds_read_b128 a[156:159], v2 offset:10240
ds_read_b128 a[160:163], v2 offset:11264
M v[104:107], a[124:127], a[40:43], v[104:107]
v_exp_f32 v81, v81
M v[104:107], a[128:131], a[44:47], v[104:107]
buffer_load_dwordx4 v1, s[12:15], s25 offen offset:2048 sc1 lds
M v[108:111], a[128:131], a[60:63], 0
v_exp_f32 v82, v82
M v[108:111], a[124:127], a[56:59], v[108:111]
v_cvt_pk_bf16_f32 v65, v66, v67
v_cvt_pk_bf16_f32 v66, v80, v81
M v[108:111], a[120:123], a[52:55], v[108:111]
v_exp_f32 v83, v83
M v[108:111], a[116:119], a[48:51], v[108:111]
buffer_load_dwordx4 v1, s[12:15], s25 offen offset:3072 sc1 lds
s_add_u32 m0, s29, 69632
s_waitcnt lgkmcnt(4)
M v[112:115], a[132:135], a[0:3], 0
v_exp_f32 v68, v68
M v[112:115], a[136:139], a[4:7], v[112:115]
ds_read_b128 a[164:167], v2 offset:12288
ds_read_b128 a[168:171], v2 offset:13312
M v[112:115], a[140:143], a[8:11], v[112:115]
v_exp_f32 v69, v69
M v[112:115], a[144:147], a[12:15], v[112:115]
buffer_load_dwordx4 v1, s[12:15], s32 offen offset:0 sc1 lds
M v[116:119], a[144:147], a[28:31], 0
v_exp_f32 v70, v70
M v[116:119], a[140:143], a[24:27], v[116:119]
v_cvt_pk_bf16_f32 v67, v82, v83
v_cvt_pk_bf16_f32 v68, v68, v69
M v[116:119], a[136:139], a[20:23], v[116:119]
v_exp_f32 v71, v71
M v[116:119], a[132:135], a[16:19], v[116:119]
buffer_load_dwordx4 v1, s[12:15], s32 offen offset:1024 sc1 lds
M v[120:123], a[132:135], a[32:35], 0
v_exp_f32 v84, v84
M v[120:123], a[136:139], a[36:39], v[120:123]
ds_read_b128 a[172:175], v2 offset:14336
ds_read_b128 a[176:179], v2 offset:15360
M v[120:123], a[140:143], a[40:43], v[120:123]
v_exp_f32 v85, v85
M v[120:123], a[144:147], a[44:47], v[120:123]
buffer_load_dwordx4 v1, s[12:15], s32 offen offset:2048 sc1 lds
M v[124:127], a[144:147], a[60:63], 0
v_exp_f32 v86, v86
M v[124:127], a[140:143], a[56:59], v[124:127]
v_cvt_pk_bf16_f32 v69, v70, v71
v_cvt_pk_bf16_f32 v70, v84, v85
M v[124:127], a[136:139], a[52:55], v[124:127]
v_exp_f32 v87, v87
M v[124:127], a[132:135], a[48:51], v[124:127]
buffer_load_dwordx4 v1, s[12:15], s32 offen offset:3072 sc1 lds
s_add_u32 m0, s29, 98304
s_waitcnt lgkmcnt(4)
M v[128:131], a[148:151], a[0:3], 0
v_exp_f32 v72, v72
M v[128:131], a[152:155], a[4:7], v[128:131]
ds_read_b128 a[116:119], v5 offset:32768
ds_read_b128 a[120:123], v5 offset:40960
M v[128:131], a[156:159], a[8:11], v[128:131]
v_exp_f32 v73, v73
M v[128:131], a[160:163], a[12:15], v[128:131]
buffer_load_dwordx4 v1, s[12:15], s26 offen offset:0 sc1 lds
s_add_u32 s43, s26, 4096
M v[132:135], a[160:163], a[28:31], 0
v_exp_f32 v74, v74
M v[132:135], a[156:159], a[24:27], v[132:135]
v_cvt_pk_bf16_f32 v71, v86, v87
v_cvt_pk_bf16_f32 v72, v72, v73
M v[132:135], a[152:155], a[20:23], v[132:135]
v_exp_f32 v75, v75
M v[132:135], a[148:151], a[16:19], v[132:135]
buffer_load_dwordx4 v1, s[12:15], s26 offen offset:1024 sc1 lds
M v[136:139], a[148:151], a[32:35], 0
v_exp_f32 v88, v88
M v[136:139], a[152:155], a[36:39], v[136:139]
ds_read_b128 a[124:127], v5 offset:33792
ds_read_b128 a[128:131], v5 offset:41984
M v[136:139], a[156:159], a[40:43], v[136:139]
v_exp_f32 v89, v89
M v[136:139], a[160:163], a[44:47], v[136:139]
buffer_load_dwordx4 v1, s[12:15], s26 offen offset:2048 sc1 lds
M v[140:143], a[160:163], a[60:63], 0
v_exp_f32 v90, v90
M v[140:143], a[156:159], a[56:59], v[140:143]
v_cvt_pk_bf16_f32 v73, v74, v75
v_cvt_pk_bf16_f32 v74, v88, v89
M v[140:143], a[152:155], a[52:55], v[140:143]
v_exp_f32 v91, v91
M v[140:143], a[148:151], a[48:51], v[140:143]
buffer_load_dwordx4 v1, s[12:15], s26 offen offset:3072 sc1 lds
s_add_u32 m0, s29, 102400
s_waitcnt lgkmcnt(4)
M v[144:147], a[164:167], a[0:3], 0
v_exp_f32 v76, v76
M v[144:147], a[168:171], a[4:7], v[144:147]
ds_read_b128 a[132:135], v5 offset:34816
ds_read_b128 a[136:139], v5 offset:43008
M v[144:147], a[172:175], a[8:11], v[144:147]
v_exp_f32 v77, v77
M v[144:147], a[176:179], a[12:15], v[144:147]
buffer_load_dwordx4 v1, s[12:15], s43 offen offset:0 sc1 lds
M v[148:151], a[176:179], a[28:31], 0
v_exp_f32 v78, v78
M v[148:151], a[172:175], a[24:27], v[148:151]
v_cvt_pk_bf16_f32 v75, v90, v91
v_cvt_pk_bf16_f32 v76, v76, v77
M v[148:151], a[168:171], a[20:23], v[148:151]
v_exp_f32 v79, v79
M v[148:151], a[164:167], a[16:19], v[148:151]
buffer_load_dwordx4 v1, s[12:15], s43 offen offset:1024 sc1 lds
M v[152:155], a[164:167], a[32:35], 0
v_exp_f32 v92, v92
M v[152:155], a[168:171], a[36:39], v[152:155]
ds_read_b128 a[140:143], v5 offset:35840
ds_read_b128 a[144:147], v5 offset:44032
M v[152:155], a[172:175], a[40:43], v[152:155]
v_exp_f32 v93, v93
M v[152:155], a[176:179], a[44:47], v[152:155]
buffer_load_dwordx4 v1, s[12:15], s43 offen offset:2048 sc1 lds
M v[156:159], a[176:179], a[60:63], 0
v_exp_f32 v94, v94
M v[156:159], a[172:175], a[56:59], v[156:159]
v_cvt_pk_bf16_f32 v77, v78, v79
v_cvt_pk_bf16_f32 v78, v92, v93
M v[156:159], a[168:171], a[52:55], v[156:159]
v_exp_f32 v95, v95
M v[156:159], a[164:167], a[48:51], v[156:159]
buffer_load_dwordx4 v1, s[12:15], s43 offen offset:3072 sc1 lds
v_cvt_pk_bf16_f32 v79, v94, v95
s_waitcnt lgkmcnt(6)
M v[160:163], a[116:119], v[32:35], v[160:163]
v_exp_f32 v96, v96
M v[160:163], a[120:123], v[64:67], v[160:163]
ds_read_b128 a[148:151], v5 offset:36864
ds_read_b128 a[152:155], v5 offset:45056
M v[164:167], a[120:123], v[68:71], v[164:167]
v_exp_f32 v97, v97
M v[164:167], a[116:119], v[36:39], v[164:167]
v_cvt_pk_bf16_f32 v96, v96, v97
M v[168:171], a[116:119], v[40:43], v[168:171]
v_exp_f32 v98, v98
M v[168:171], a[120:123], v[72:75], v[168:171]
s_add_u32 s25, s25, 32768
s_cmp_eq_u32 s25, s27
M v[172:175], a[120:123], v[76:79], v[172:175]
v_exp_f32 v99, v99
M v[172:175], a[116:119], v[44:47], v[172:175]
v_cvt_pk_bf16_f32 v97, v98, v99
s_waitcnt lgkmcnt(6)
M a[96:99], a[112:115], v[32:35], a[96:99]
s_cselect_b32 s25, s28, s25
s_cselect_b32 s27, s56, s27
M a[96:99], a[112:115], v[64:67], a[96:99]
s_cselect_b32 s28, s57, s28
s_cselect_b32 s56, -1, s56
M v[176:179], a[124:127], v[32:35], v[176:179]
v_exp_f32 v112, v112
M v[176:179], a[128:131], v[64:67], v[176:179]
ds_read_b128 a[156:159], v5 offset:37888
ds_read_b128 a[160:163], v5 offset:46080
M v[180:183], a[128:131], v[68:71], v[180:183]
v_exp_f32 v113, v113
M v[180:183], a[124:127], v[36:39], v[180:183]
v_cvt_pk_bf16_f32 v98, v112, v113
M v[184:187], a[124:127], v[40:43], v[184:187]
v_exp_f32 v114, v114
M v[184:187], a[128:131], v[72:75], v[184:187]
s_add_u32 s26, s26, 32768
s_cmp_eq_u32 s26, s62
M v[188:191], a[128:131], v[76:79], v[188:191]
v_exp_f32 v115, v115
M v[188:191], a[124:127], v[44:47], v[188:191]
v_cvt_pk_bf16_f32 v99, v114, v115
s_waitcnt lgkmcnt(6)
M a[100:103], a[112:115], v[36:39], a[100:103]
s_cselect_b32 s26, s63, s26
s_cselect_b32 s62, s58, s62
M a[100:103], a[112:115], v[68:71], a[100:103]
s_cselect_b32 s63, s59, s63
s_cselect_b32 s58, -1, s58
M v[192:195], a[132:135], v[32:35], v[192:195]
v_exp_f32 v100, v100
M v[192:195], a[136:139], v[64:67], v[192:195]
ds_read_b128 a[164:167], v5 offset:38912
ds_read_b128 a[168:171], v5 offset:47104
M v[196:199], a[136:139], v[68:71], v[196:199]
v_exp_f32 v101, v101
M v[196:199], a[132:135], v[36:39], v[196:199]
v_cvt_pk_bf16_f32 v100, v100, v101
M v[200:203], a[132:135], v[40:43], v[200:203]
v_exp_f32 v102, v102
M v[200:203], a[136:139], v[72:75], v[200:203]
s_sub_u32 s33, s42, 1
s_cmp_le_u32 s33, 1
s_cselect_b32 s33, 0x4000, 0
v_add_u32 v2, s33, v2
M v[204:207], a[136:139], v[76:79], v[204:207]
v_exp_f32 v103, v103
M v[204:207], a[132:135], v[44:47], v[204:207]
v_cvt_pk_bf16_f32 v101, v102, v103
s_waitcnt lgkmcnt(6)
M a[104:107], a[112:115], v[40:43], a[104:107]
M a[104:107], a[112:115], v[72:75], a[104:107]
M v[208:211], a[140:143], v[32:35], v[208:211]
v_exp_f32 v116, v116
M v[208:211], a[144:147], v[64:67], v[208:211]
ds_read_b128 a[172:175], v5 offset:39936
ds_read_b128 a[176:179], v5 offset:48128
M v[212:215], a[144:147], v[68:71], v[212:215]
v_exp_f32 v117, v117
M v[212:215], a[140:143], v[36:39], v[212:215]
v_cvt_pk_bf16_f32 v102, v116, v117
M v[216:219], a[140:143], v[40:43], v[216:219]
v_exp_f32 v118, v118
M v[216:219], a[144:147], v[72:75], v[216:219]
M v[220:223], a[144:147], v[76:79], v[220:223]
v_exp_f32 v119, v119
M v[220:223], a[140:143], v[44:47], v[220:223]
v_cvt_pk_bf16_f32 v103, v118, v119
s_waitcnt lgkmcnt(6)
M a[108:111], a[112:115], v[44:47], a[108:111]
M a[108:111], a[112:115], v[76:79], a[108:111]
M v[224:227], a[148:151], v[32:35], v[224:227]
v_exp_f32 v104, v104
M v[224:227], a[152:155], v[64:67], v[224:227]
s_cmp_le_u32 s42, 1
s_cselect_b32 s33, 0x4000, 0
v_add_u32 v5, s33, v5
s_sub_u32 s42, s42, 1
M v[228:231], a[152:155], v[68:71], v[228:231]
v_exp_f32 v105, v105
M v[228:231], a[148:151], v[36:39], v[228:231]
v_cvt_pk_bf16_f32 v104, v104, v105
M v[232:235], a[148:151], v[40:43], v[232:235]
v_exp_f32 v106, v106
M v[232:235], a[152:155], v[72:75], v[232:235]
M v[236:239], a[152:155], v[76:79], v[236:239]
v_exp_f32 v107, v107
M v[236:239], a[148:151], v[44:47], v[236:239]
v_cvt_pk_bf16_f32 v105, v106, v107
s_waitcnt lgkmcnt(4)
M v[240:243], a[156:159], v[32:35], v[240:243]
v_exp_f32 v120, v120
M v[240:243], a[160:163], v[64:67], v[240:243]
M v[244:247], a[160:163], v[68:71], v[244:247]
v_exp_f32 v121, v121
M v[244:247], a[156:159], v[36:39], v[244:247]
v_cvt_pk_bf16_f32 v106, v120, v121
M v[248:251], a[156:159], v[40:43], v[248:251]
v_exp_f32 v122, v122
M v[248:251], a[160:163], v[72:75], v[248:251]
s_waitcnt vmcnt(0) lgkmcnt(0)
s_barrier
ds_read_b128 a[116:119], v3 offset:0
ds_read_b128 a[120:123], v3 offset:1024
M v[252:255], a[160:163], v[76:79], v[252:255]
v_exp_f32 v123, v123
M v[252:255], a[156:159], v[44:47], v[252:255]
v_cvt_pk_bf16_f32 v107, v122, v123
M a[64:67], a[164:167], v[32:35], a[64:67]
v_exp_f32 v108, v108
M a[64:67], a[168:171], v[64:67], a[64:67]
ds_read_b128 a[124:127], v3 offset:2048
ds_read_b128 a[128:131], v3 offset:3072
M a[68:71], a[168:171], v[68:71], a[68:71]
v_exp_f32 v109, v109
M a[68:71], a[164:167], v[36:39], a[68:71]
v_cvt_pk_bf16_f32 v108, v108, v109
M a[72:75], a[164:167], v[40:43], a[72:75]
v_exp_f32 v110, v110
M a[72:75], a[168:171], v[72:75], a[72:75]
ds_read_b128 a[132:135], v3 offset:4096
ds_read_b128 a[136:139], v3 offset:5120
M a[76:79], a[168:171], v[76:79], a[76:79]
v_exp_f32 v111, v111
M a[76:79], a[164:167], v[44:47], a[76:79]
v_cvt_pk_bf16_f32 v109, v110, v111
M a[80:83], a[172:175], v[32:35], a[80:83]
v_exp_f32 v124, v124
M a[80:83], a[176:179], v[64:67], a[80:83]
ds_read_b128 a[140:143], v3 offset:6144
ds_read_b128 a[144:147], v3 offset:7168
M a[84:87], a[176:179], v[68:71], a[84:87]
v_exp_f32 v125, v125
M a[84:87], a[172:175], v[36:39], a[84:87]
v_cvt_pk_bf16_f32 v110, v124, v125
M a[88:91], a[172:175], v[40:43], a[88:91]
v_exp_f32 v126, v126
M a[88:91], a[176:179], v[72:75], a[88:91]
M a[92:95], a[176:179], v[76:79], a[92:95]
v_exp_f32 v127, v127
M a[92:95], a[172:175], v[44:47], a[92:95]
v_cvt_pk_bf16_f32 v111, v126, v127
s_add_u32 m0, s29, 0
s_waitcnt lgkmcnt(4)
M v[32:35], a[116:119], a[0:3], v[16:19]
v_exp_f32 v128, v128
M v[32:35], a[120:123], a[4:7], v[32:35]
ds_read_b128 a[148:151], v3 offset:8192
ds_read_b128 a[152:155], v3 offset:9216
M v[32:35], a[124:127], a[8:11], v[32:35]
v_exp_f32 v129, v129
M v[32:35], a[128:131], a[12:15], v[32:35]
buffer_load_dwordx4 v1, s[12:15], s25 offen offset:0 sc1 lds
s_add_u32 s32, s25, 4096
M v[36:39], a[128:131], a[28:31], 0
v_exp_f32 v130, v130
M v[36:39], a[124:127], a[24:27], v[36:39]
v_cvt_pk_bf16_f32 v128, v128, v129
M v[36:39], a[120:123], a[20:23], v[36:39]
v_exp_f32 v131, v131
M v[36:39], a[116:119], a[16:19], v[36:39]
buffer_load_dwordx4 v1, s[12:15], s25 offen offset:1024 sc1 lds
M v[40:43], a[116:119], a[32:35], 0
v_exp_f32 v144, v144
M v[40:43], a[120:123], a[36:39], v[40:43]
ds_read_b128 a[156:159], v3 offset:10240
ds_read_b128 a[160:163], v3 offset:11264
M v[40:43], a[124:127], a[40:43], v[40:43]
v_exp_f32 v145, v145
M v[40:43], a[128:131], a[44:47], v[40:43]
buffer_load_dwordx4 v1, s[12:15], s25 offen offset:2048 sc1 lds
M v[44:47], a[128:131], a[60:63], 0
v_exp_f32 v146, v146
M v[44:47], a[124:127], a[56:59], v[44:47]
v_cvt_pk_bf16_f32 v129, v130, v131
v_cvt_pk_bf16_f32 v130, v144, v145
M v[44:47], a[120:123], a[52:55], v[44:47]
v_exp_f32 v147, v147
M v[44:47], a[116:119], a[48:51], v[44:47]
buffer_load_dwordx4 v1, s[12:15], s25 offen offset:3072 sc1 lds
s_add_u32 m0, s29, 4096
s_waitcnt lgkmcnt(4)
v_exp_f32 v132, v132
ds_read_b128 a[164:167], v3 offset:12288
ds_read_b128 a[168:171], v3 offset:13312
v_exp_f32 v133, v133
buffer_load_dwordx4 v1, s[12:15], s32 offen offset:0 sc1 lds
M v[52:55], a[144:147], a[28:31], v[16:19]
v_exp_f32 v134, v134
M v[52:55], a[140:143], a[24:27], v[52:55]
v_cvt_pk_bf16_f32 v131, v146, v147
v_cvt_pk_bf16_f32 v132, v132, v133
M v[52:55], a[136:139], a[20:23], v[52:55]
v_exp_f32 v135, v135
M v[52:55], a[132:135], a[16:19], v[52:55]
buffer_load_dwordx4 v1, s[12:15], s32 offen offset:1024 sc1 lds
M v[56:59], a[132:135], a[32:35], 0
v_exp_f32 v148, v148
M v[56:59], a[136:139], a[36:39], v[56:59]
ds_read_b128 a[172:175], v3 offset:14336
ds_read_b128 a[176:179], v3 offset:15360
M v[56:59], a[140:143], a[40:43], v[56:59]
v_exp_f32 v149, v149
M v[56:59], a[144:147], a[44:47], v[56:59]
buffer_load_dwordx4 v1, s[12:15], s32 offen offset:2048 sc1 lds
M v[60:63], a[144:147], a[60:63], 0
v_exp_f32 v150, v150
M v[60:63], a[140:143], a[56:59], v[60:63]
v_cvt_pk_bf16_f32 v133, v134, v135
v_cvt_pk_bf16_f32 v134, v148, v149
M v[60:63], a[136:139], a[52:55], v[60:63]
v_exp_f32 v151, v151
M v[60:63], a[132:135], a[48:51], v[60:63]
buffer_load_dwordx4 v1, s[12:15], s32 offen offset:3072 sc1 lds
s_add_u32 m0, s29, 32768
s_waitcnt lgkmcnt(4)
v_exp_f32 v136, v136
ds_read_b128 a[116:119], v6 offset:32768
ds_read_b128 a[120:123], v6 offset:40960
v_exp_f32 v137, v137
buffer_load_dwordx4 v1, s[12:15], s26 offen offset:0 sc1 lds
s_add_u32 s43, s26, 4096
v_exp_f32 v138, v138
v_cvt_pk_bf16_f32 v135, v150, v151
v_cvt_pk_bf16_f32 v136, v136, v137
v_exp_f32 v139, v139
buffer_load_dwordx4 v1, s[12:15], s26 offen offset:1024 sc1 lds
M v[72:75], a[148:151], a[32:35], v[16:19]
v_exp_f32 v152, v152
M v[72:75], a[152:155], a[36:39], v[72:75]
ds_read_b128 a[124:127], v6 offset:33792
ds_read_b128 a[128:131], v6 offset:41984
M v[72:75], a[156:159], a[40:43], v[72:75]
v_exp_f32 v153, v153
M v[72:75], a[160:163], a[44:47], v[72:75]
buffer_load_dwordx4 v1, s[12:15], s26 offen offset:2048 sc1 lds
M v[76:79], a[160:163], a[60:63], 0
v_exp_f32 v154, v154
M v[76:79], a[156:159], a[56:59], v[76:79]
v_cvt_pk_bf16_f32 v137, v138, v139
v_cvt_pk_bf16_f32 v138, v152, v153
M v[76:79], a[152:155], a[52:55], v[76:79]
v_exp_f32 v155, v155
M v[76:79], a[148:151], a[48:51], v[76:79]
buffer_load_dwordx4 v1, s[12:15], s26 offen offset:3072 sc1 lds
s_add_u32 m0, s29, 36864
s_waitcnt lgkmcnt(4)
v_exp_f32 v140, v140
ds_read_b128 a[132:135], v6 offset:34816
ds_read_b128 a[136:139], v6 offset:43008
v_exp_f32 v141, v141
buffer_load_dwordx4 v1, s[12:15], s43 offen offset:0 sc1 lds
v_exp_f32 v142, v142
v_cvt_pk_bf16_f32 v139, v154, v155
v_cvt_pk_bf16_f32 v140, v140, v141
v_exp_f32 v143, v143
buffer_load_dwordx4 v1, s[12:15], s43 offen offset:1024 sc1 lds
v_exp_f32 v156, v156
ds_read_b128 a[140:143], v6 offset:35840
ds_read_b128 a[144:147], v6 offset:44032
v_exp_f32 v157, v157
buffer_load_dwordx4 v1, s[12:15], s43 offen offset:2048 sc1 lds
M v[92:95], a[176:179], a[60:63], v[16:19]
v_exp_f32 v158, v158
M v[92:95], a[172:175], a[56:59], v[92:95]
v_cvt_pk_bf16_f32 v141, v142, v143
v_cvt_pk_bf16_f32 v142, v156, v157
M v[92:95], a[168:171], a[52:55], v[92:95]
v_exp_f32 v159, v159
M v[92:95], a[164:167], a[48:51], v[92:95]
buffer_load_dwordx4 v1, s[12:15], s43 offen offset:3072 sc1 lds
v_cvt_pk_bf16_f32 v143, v158, v159
s_waitcnt lgkmcnt(6)
M v[160:163], a[116:119], v[96:99], v[160:163]
v_exp_f32 v32, v32
M v[160:163], a[120:123], v[128:131], v[160:163]
ds_read_b128 a[148:151], v6 offset:36864
ds_read_b128 a[152:155], v6 offset:45056
M v[164:167], a[120:123], v[132:135], v[164:167]
v_exp_f32 v33, v33
M v[164:167], a[116:119], v[100:103], v[164:167]
v_cvt_pk_bf16_f32 v32, v32, v33
M v[168:171], a[116:119], v[104:107], v[168:171]
v_exp_f32 v34, v34
M v[168:171], a[120:123], v[136:139], v[168:171]
s_add_u32 s25, s25, 32768
s_cmp_eq_u32 s25, s27
M v[172:175], a[120:123], v[140:143], v[172:175]
v_exp_f32 v35, v35
M v[172:175], a[116:119], v[108:111], v[172:175]
v_cvt_pk_bf16_f32 v33, v34, v35
s_waitcnt lgkmcnt(6)
M a[96:99], a[112:115], v[96:99], a[96:99]
s_cselect_b32 s25, s28, s25
s_cselect_b32 s27, s56, s27
M a[96:99], a[112:115], v[128:131], a[96:99]
s_cselect_b32 s28, s57, s28
s_cselect_b32 s56, -1, s56
M v[176:179], a[124:127], v[96:99], v[176:179]
M v[176:179], a[128:131], v[128:131], v[176:179]
ds_read_b128 a[156:159], v6 offset:37888
ds_read_b128 a[160:163], v6 offset:46080
M v[180:183], a[128:131], v[132:135], v[180:183]
M v[180:183], a[124:127], v[100:103], v[180:183]
v_mov_b32 v34, 0
M v[184:187], a[124:127], v[104:107], v[184:187]
M v[184:187], a[128:131], v[136:139], v[184:187]
s_add_u32 s26, s26, 32768
s_cmp_eq_u32 s26, s62
M v[188:191], a[128:131], v[140:143], v[188:191]
M v[188:191], a[124:127], v[108:111], v[188:191]
v_mov_b32 v35, 0
s_waitcnt lgkmcnt(6)
M a[100:103], a[112:115], v[100:103], a[100:103]
s_cselect_b32 s26, s63, s26
s_cselect_b32 s62, s58, s62
M a[100:103], a[112:115], v[132:135], a[100:103]
s_cselect_b32 s63, s59, s63
s_cselect_b32 s58, -1, s58
M v[192:195], a[132:135], v[96:99], v[192:195]
v_exp_f32 v36, v36
M v[192:195], a[136:139], v[128:131], v[192:195]
ds_read_b128 a[164:167], v6 offset:38912
ds_read_b128 a[168:171], v6 offset:47104
M v[196:199], a[136:139], v[132:135], v[196:199]
v_exp_f32 v37, v37
M v[196:199], a[132:135], v[100:103], v[196:199]
v_cvt_pk_bf16_f32 v36, v36, v37
M v[200:203], a[132:135], v[104:107], v[200:203]
v_exp_f32 v38, v38
M v[200:203], a[136:139], v[136:139], v[200:203]
s_sub_u32 s33, s42, 1
s_cmp_le_u32 s33, 1
s_cselect_b32 s33, 0x4000, 0
v_add_u32 v3, s33, v3
M v[204:207], a[136:139], v[140:143], v[204:207]
v_exp_f32 v39, v39
M v[204:207], a[132:135], v[108:111], v[204:207]
v_cvt_pk_bf16_f32 v37, v38, v39
s_waitcnt lgkmcnt(6)
M a[104:107], a[112:115], v[104:107], a[104:107]
M a[104:107], a[112:115], v[136:139], a[104:107]
M v[208:211], a[140:143], v[96:99], v[208:211]
v_exp_f32 v52, v52
M v[208:211], a[144:147], v[128:131], v[208:211]
ds_read_b128 a[172:175], v6 offset:39936
ds_read_b128 a[176:179], v6 offset:48128
M v[212:215], a[144:147], v[132:135], v[212:215]
v_exp_f32 v53, v53
M v[212:215], a[140:143], v[100:103], v[212:215]
v_cvt_pk_bf16_f32 v38, v52, v53
M v[216:219], a[140:143], v[104:107], v[216:219]
v_exp_f32 v54, v54
M v[216:219], a[144:147], v[136:139], v[216:219]
M v[220:223], a[144:147], v[140:143], v[220:223]
v_exp_f32 v55, v55
M v[220:223], a[140:143], v[108:111], v[220:223]
v_cvt_pk_bf16_f32 v39, v54, v55
s_waitcnt lgkmcnt(6)
M a[108:111], a[112:115], v[108:111], a[108:111]
M a[108:111], a[112:115], v[140:143], a[108:111]
M v[224:227], a[148:151], v[96:99], v[224:227]
v_exp_f32 v40, v40
M v[224:227], a[152:155], v[128:131], v[224:227]
s_cmp_le_u32 s42, 1
s_cselect_b32 s33, 0x4000, 0
v_add_u32 v6, s33, v6
s_sub_u32 s42, s42, 1
M v[228:231], a[152:155], v[132:135], v[228:231]
v_exp_f32 v41, v41
M v[228:231], a[148:151], v[100:103], v[228:231]
v_cvt_pk_bf16_f32 v40, v40, v41
M v[232:235], a[148:151], v[104:107], v[232:235]
v_exp_f32 v42, v42
M v[232:235], a[152:155], v[136:139], v[232:235]
M v[236:239], a[152:155], v[140:143], v[236:239]
v_exp_f32 v43, v43
M v[236:239], a[148:151], v[108:111], v[236:239]
v_cvt_pk_bf16_f32 v41, v42, v43
s_waitcnt lgkmcnt(4)
M v[240:243], a[156:159], v[96:99], v[240:243]
v_exp_f32 v56, v56
M v[240:243], a[160:163], v[128:131], v[240:243]
M v[244:247], a[160:163], v[132:135], v[244:247]
v_exp_f32 v57, v57
M v[244:247], a[156:159], v[100:103], v[244:247]
v_cvt_pk_bf16_f32 v42, v56, v57
M v[248:251], a[156:159], v[104:107], v[248:251]
v_exp_f32 v58, v58
M v[248:251], a[160:163], v[136:139], v[248:251]
s_waitcnt vmcnt(0) lgkmcnt(0)
s_barrier
ds_read_b128 a[116:119], v2 offset:0
ds_read_b128 a[120:123], v2 offset:1024
M v[252:255], a[160:163], v[140:143], v[252:255]
v_exp_f32 v59, v59
M v[252:255], a[156:159], v[108:111], v[252:255]
v_cvt_pk_bf16_f32 v43, v58, v59
M a[64:67], a[164:167], v[96:99], a[64:67]
v_exp_f32 v44, v44
M a[64:67], a[168:171], v[128:131], a[64:67]
ds_read_b128 a[124:127], v2 offset:2048
ds_read_b128 a[128:131], v2 offset:3072
M a[68:71], a[168:171], v[132:135], a[68:71]
v_exp_f32 v45, v45
M a[68:71], a[164:167], v[100:103], a[68:71]
v_cvt_pk_bf16_f32 v44, v44, v45
M a[72:75], a[164:167], v[104:107], a[72:75]
v_exp_f32 v46, v46
M a[72:75], a[168:171], v[136:139], a[72:75]
ds_read_b128 a[132:135], v2 offset:4096
ds_read_b128 a[136:139], v2 offset:5120
M a[76:79], a[168:171], v[140:143], a[76:79]
v_exp_f32 v47, v47
M a[76:79], a[164:167], v[108:111], a[76:79]
v_cvt_pk_bf16_f32 v45, v46, v47
M a[80:83], a[172:175], v[96:99], a[80:83]
v_exp_f32 v60, v60
M a[80:83], a[176:179], v[128:131], a[80:83]
ds_read_b128 a[140:143], v2 offset:6144
ds_read_b128 a[144:147], v2 offset:7168
M a[84:87], a[176:179], v[132:135], a[84:87]
v_exp_f32 v61, v61
M a[84:87], a[172:175], v[100:103], a[84:87]
v_cvt_pk_bf16_f32 v46, v60, v61
M a[88:91], a[172:175], v[104:107], a[88:91]
v_exp_f32 v62, v62
M a[88:91], a[176:179], v[136:139], a[88:91]
M a[92:95], a[176:179], v[140:143], a[92:95]
v_exp_f32 v63, v63
M a[92:95], a[172:175], v[108:111], a[92:95]
v_cvt_pk_bf16_f32 v47, v62, v63
s_and_b32 s3, s2, 3
s_lshl_b32 s3, s3, 2
s_bfe_u32 s27, s2, 0x20003
s_add_u32 s27, s3, s27
s_lshl_b32 s43, s27, 8
s_add_u32 s43, s43, 16789504
v_lshlrev_b32 v15, 2, v0
buffer_load_dword v7, v15, s[52:55], s43 offen sc1
s_waitcnt lgkmcnt(7)
ds_read_b128 a[116:119], v5 offset:32768
s_waitcnt lgkmcnt(7)
ds_read_b128 a[120:123], v5 offset:40960
s_waitcnt lgkmcnt(7)
ds_read_b128 a[124:127], v5 offset:33792
s_waitcnt lgkmcnt(7)
ds_read_b128 a[128:131], v5 offset:41984
s_waitcnt lgkmcnt(7)
ds_read_b128 a[132:135], v5 offset:34816
s_waitcnt lgkmcnt(7)
ds_read_b128 a[136:139], v5 offset:43008
s_waitcnt lgkmcnt(7)
ds_read_b128 a[140:143], v5 offset:35840
s_waitcnt lgkmcnt(7)
ds_read_b128 a[144:147], v5 offset:44032
s_lshl_b32 s33, s23, 14
s_add_u32 s34, s33, 131072
s_add_u32 s33, s33, 98304
v_add_u32 v2, s34, v1
v_add_u32 v3, s33, v1
v_exp_f32 v72, v72
v_exp_f32 v73, v73
v_exp_f32 v74, v74
v_exp_f32 v75, v75
v_cvt_pk_bf16_f32 v72, v72, v73
v_cvt_pk_bf16_f32 v73, v74, v75
v_exp_f32 v76, v76
v_exp_f32 v77, v77
v_exp_f32 v78, v78
v_exp_f32 v79, v79
v_mov_b32 v74, 0
v_mov_b32 v75, 0
v_exp_f32 v92, v92
v_exp_f32 v93, v93
v_exp_f32 v94, v94
v_exp_f32 v95, v95
v_cvt_pk_bf16_f32 v76, v76, v77
v_cvt_pk_bf16_f32 v77, v78, v79
v_cvt_pk_bf16_f32 v78, v92, v93
v_cvt_pk_bf16_f32 v79, v94, v95
s_waitcnt lgkmcnt(6)
M v[160:163], a[116:119], v[32:35], v[160:163]
ds_read_b128 a[148:151], v5 offset:36864
ds_read_b128 a[152:155], v5 offset:45056
s_mov_b32 s61, 0
M v[164:167], a[116:119], v[36:39], v[164:167]
s_bfe_u32 s3, s2, 0x10002
M v[168:171], a[116:119], v[40:43], v[168:171]
M v[168:171], a[120:123], v[72:75], v[168:171]
s_lshl_b32 s3, s3, 3
M v[172:175], a[120:123], v[76:79], v[172:175]
M v[172:175], a[116:119], v[44:47], v[172:175]
s_waitcnt lgkmcnt(6)
s_lshr_b32 s28, s2, 5
M a[96:99], a[112:115], v[32:35], a[96:99]
M v[176:179], a[124:127], v[32:35], v[176:179]
ds_read_b128 a[156:159], v5 offset:37888
ds_read_b128 a[160:163], v5 offset:46080
s_add_u32 s28, s3, s28
s_lshl_b32 s25, s27, 18
M v[180:183], a[124:127], v[36:39], v[180:183]
M v[184:187], a[124:127], v[40:43], v[184:187]
s_lshl_b32 s3, s101, 12
M v[184:187], a[128:131], v[72:75], v[184:187]
M v[188:191], a[128:131], v[76:79], v[188:191]
s_add_u32 s25, s25, s3
M v[188:191], a[124:127], v[44:47], v[188:191]
s_waitcnt lgkmcnt(6)
M a[100:103], a[112:115], v[36:39], a[100:103]
M v[192:195], a[132:135], v[32:35], v[192:195]
s_lshl_b32 s26, s28, 7
ds_read_b128 a[164:167], v5 offset:38912
ds_read_b128 a[168:171], v5 offset:47104
s_lshl_b32 s42, s101, 11
M v[196:199], a[132:135], v[36:39], v[196:199]
M v[200:203], a[132:135], v[40:43], v[200:203]
s_add_u32 s44, s4, 83886080
s_addc_u32 s45, s5, 0
M v[200:203], a[136:139], v[72:75], v[200:203]
s_mov_b32 s46, 4194304
M v[204:207], a[136:139], v[76:79], v[204:207]
M v[204:207], a[132:135], v[44:47], v[204:207]
s_waitcnt lgkmcnt(6)
s_mov_b32 s47, 0x00020000
M a[104:107], a[112:115], v[40:43], a[104:107]
M a[104:107], a[112:115], v[72:75], a[104:107]
M v[208:211], a[140:143], v[32:35], v[208:211]
ds_read_b128 a[172:175], v5 offset:39936
ds_read_b128 a[176:179], v5 offset:48128
s_mov_b32 s50, 2097152
M v[212:215], a[140:143], v[36:39], v[212:215]
s_mov_b32 s51, 0x00020000
M v[216:219], a[140:143], v[40:43], v[216:219]
M v[216:219], a[144:147], v[72:75], v[216:219]
s_lshl_b32 s3, s101, 4
M v[220:223], a[144:147], v[76:79], v[220:223]
M v[220:223], a[140:143], v[44:47], v[220:223]
s_waitcnt lgkmcnt(6)
v_lshrrev_b32 v96, 3, v0
M a[108:111], a[112:115], v[44:47], a[108:111]
M a[108:111], a[112:115], v[76:79], a[108:111]
M v[224:227], a[148:151], v[32:35], v[224:227]
v_and_b32 v97, 6, v96
ds_write_b128 v2, v[160:163] offset:0
v_and_b32 v98, 7, v0
M v[228:231], a[148:151], v[36:39], v[228:231]
M v[232:235], a[148:151], v[40:43], v[232:235]
ds_write_b128 v2, v[164:167] offset:1024
v_xor_b32 v97, v97, v98
M v[232:235], a[152:155], v[72:75], v[232:235]
M v[236:239], a[152:155], v[76:79], v[236:239]
ds_write_b128 v2, v[168:171] offset:2048
v_add_u32 v96, s3, v96
M v[236:239], a[148:151], v[44:47], v[236:239]
s_waitcnt lgkmcnt(7)
M v[240:243], a[156:159], v[32:35], v[240:243]
ds_write_b128 v2, v[172:175] offset:3072
v_lshlrev_b32 v96, 11, v96
ds_write_b128 v2, v[176:179] offset:4096
v_lshl_add_u32 v99, v97, 4, v96
M v[244:247], a[156:159], v[36:39], v[244:247]
v_add_u32 v100, 15360, v99
M v[248:251], a[156:159], v[40:43], v[248:251]
ds_write_b128 v2, v[180:183] offset:5120
M v[248:251], a[160:163], v[72:75], v[248:251]
s_waitcnt vmcnt(0) lgkmcnt(0)
s_barrier
M v[252:255], a[160:163], v[76:79], v[252:255]
ds_write_b128 v2, v[184:187] offset:6144
v_cmp_ne_u32 vcc, 1, v7
s_nop 0
s_cbranch_vccnz Lk3_spinb2
Lk3_gotb2:
M v[252:255], a[156:159], v[44:47], v[252:255]
s_add_u32 m0, s42, 16384
s_nop 0
buffer_load_dwordx4 v99, s[48:51], s26 offen offset:0 lds
M a[64:67], a[164:167], v[32:35], a[64:67]
ds_write_b128 v2, v[188:191] offset:7168
buffer_load_dwordx4 v100, s[48:51], s26 offen offset:1024 lds
ds_write_b128 v2, v[192:195] offset:8192
buffer_load_dwordx4 a[192:195], v1, s[44:47], s25 offen offset:0 sc1
M a[68:71], a[164:167], v[36:39], a[68:71]
buffer_load_dwordx4 a[196:199], v1, s[44:47], s25 offen offset:1024 sc1
M a[72:75], a[164:167], v[40:43], a[72:75]
ds_write_b128 v2, v[196:199] offset:9216
buffer_load_dwordx4 a[200:203], v1, s[44:47], s25 offen offset:2048 sc1
M a[72:75], a[168:171], v[72:75], a[72:75]
buffer_load_dwordx4 a[204:207], v1, s[44:47], s25 offen offset:3072 sc1
M a[76:79], a[168:171], v[76:79], a[76:79]
ds_write_b128 v2, v[200:203] offset:10240
M a[76:79], a[164:167], v[44:47], a[76:79]
s_add_u32 s25, s25, 16384
s_add_u32 s26, s26, 131072
M a[80:83], a[172:175], v[32:35], a[80:83]
ds_write_b128 v2, v[204:207] offset:11264
s_add_u32 m0, s42, 32768
s_nop 0
buffer_load_dwordx4 v99, s[48:51], s26 offen offset:0 lds
buffer_load_dwordx4 v100, s[48:51], s26 offen offset:1024 lds
ds_write_b128 v2, v[208:211] offset:12288
buffer_load_dwordx4 a[224:227], v1, s[44:47], s25 offen offset:0 sc1
M a[84:87], a[172:175], v[36:39], a[84:87]
M a[88:91], a[172:175], v[40:43], a[88:91]
ds_write_b128 v2, v[212:215] offset:13312
buffer_load_dwordx4 a[228:231], v1, s[44:47], s25 offen offset:1024 sc1
M a[88:91], a[176:179], v[72:75], a[88:91]
buffer_load_dwordx4 a[232:235], v1, s[44:47], s25 offen offset:2048 sc1
M a[92:95], a[176:179], v[76:79], a[92:95]
ds_write_b128 v2, v[216:219] offset:14336
buffer_load_dwordx4 a[236:239], v1, s[44:47], s25 offen offset:3072 sc1
M a[92:95], a[172:175], v[44:47], a[92:95]
s_add_u32 s25, s25, 16384
s_add_u32 s26, s26, 131072
ds_write_b128 v2, v[220:223] offset:15360
s_waitcnt lgkmcnt(0)
Lk2_mg1:
s_lshl_b32 s33, s22, 10
s_add_u32 s33, s33, 28672
s_xor_b32 s34, s33, 2048
v_add_u32 v14, s33, v1
v_add_u32 v15, s34, v1
v_accvgpr_read_b32 v20, a96
v_accvgpr_read_b32 v21, a100
v_accvgpr_read_b32 v22, a104
v_accvgpr_read_b32 v23, a108
ds_write_b128 v14, v[20:23]
s_waitcnt lgkmcnt(0)
s_barrier
ds_read_b128 v[28:31], v15
ds_read_b128 v[32:35], v3 offset:0
ds_read_b128 v[36:39], v3 offset:1024
ds_read_b128 v[40:43], v3 offset:2048
ds_read_b128 v[44:47], v3 offset:3072
ds_read_b128 v[48:51], v3 offset:4096
ds_read_b128 v[52:55], v3 offset:5120
ds_read_b128 v[56:59], v3 offset:6144
ds_read_b128 v[60:63], v3 offset:7168
ds_read_b128 v[64:67], v3 offset:8192
ds_read_b128 v[68:71], v3 offset:9216
ds_read_b128 v[72:75], v3 offset:10240
ds_read_b128 v[76:79], v3 offset:11264
ds_read_b128 v[80:83], v3 offset:12288
ds_read_b128 v[84:87], v3 offset:13312
ds_read_b128 v[88:91], v3 offset:14336
ds_read_b128 v[92:95], v3 offset:15360
s_waitcnt lgkmcnt(15)
v_add_f32 v20, v20, v28
v_add_f32 v21, v21, v29
v_add_f32 v22, v22, v30
v_add_f32 v23, v23, v31
s_sub_u32 s35, 15, s21
v_rcp_f32 v8, v20
v_rcp_f32 v9, v21
v_rcp_f32 v10, v22
v_rcp_f32 v11, v23
v_subrev_u32 v20, 0x21800000, v20
v_subrev_u32 v21, 0x21800000, v21
v_subrev_u32 v22, 0x21800000, v22
v_subrev_u32 v23, 0x21800000, v23
v_max_u32 v12, v20, v21
v_max3_u32 v12, v12, v22, v23
s_mov_b32 s64, 0x207
s_lshl_b32 s33, s35, 20
s_lshl_b32 s34, s20, 15
s_add_u32 s33, s33, s34
s_lshl_b32 s34, s23, 13
s_add_u32 s36, s33, s34
s_add_u32 s37, s36, 4096
s_add_u32 s38, s36, 16384
s_add_u32 s39, s36, 20480
v_pk_add_f32 v[224:225], v[224:225], v[32:33]
v_pk_add_f32 v[226:227], v[226:227], v[34:35]
s_waitcnt lgkmcnt(11)
v_pk_add_f32 v[240:241], v[240:241], v[48:49]
v_pk_add_f32 v[242:243], v[242:243], v[50:51]
v_pk_mul_f32 v[224:225], v[224:225], v[8:9] op_sel:[0,0] op_sel_hi:[1,0]
v_pk_mul_f32 v[226:227], v[226:227], v[8:9] op_sel:[0,0] op_sel_hi:[1,0]
v_pk_mul_f32 v[240:241], v[240:241], v[8:9] op_sel:[0,0] op_sel_hi:[1,0]
v_pk_mul_f32 v[242:243], v[242:243], v[8:9] op_sel:[0,0] op_sel_hi:[1,0]
v_cvt_pk_bf16_f32 v224, v224, v225
v_cvt_pk_bf16_f32 v225, v226, v227
v_cvt_pk_bf16_f32 v226, v240, v241
v_cvt_pk_bf16_f32 v227, v242, v243
v_pk_add_f32 v[228:229], v[228:229], v[36:37]
v_pk_add_f32 v[230:231], v[230:231], v[38:39]
s_waitcnt lgkmcnt(10)
v_pk_add_f32 v[244:245], v[244:245], v[52:53]
v_pk_add_f32 v[246:247], v[246:247], v[54:55]
M v[24:27], a[112:115], v[224:227], 0
buffer_store_dwordx4 v[224:227], v1, s[16:19], s38 offen offset:0 sc1
v_pk_mul_f32 v[228:229], v[228:229], v[8:9] op_sel:[0,1] op_sel_hi:[1,1]
v_pk_mul_f32 v[230:231], v[230:231], v[8:9] op_sel:[0,1] op_sel_hi:[1,1]
v_pk_mul_f32 v[244:245], v[244:245], v[8:9] op_sel:[0,1] op_sel_hi:[1,1]
v_pk_mul_f32 v[246:247], v[246:247], v[8:9] op_sel:[0,1] op_sel_hi:[1,1]
v_cvt_pk_bf16_f32 v228, v228, v229
v_cvt_pk_bf16_f32 v229, v230, v231
v_cvt_pk_bf16_f32 v230, v244, v245
v_cvt_pk_bf16_f32 v231, v246, v247
v_pk_add_f32 v[232:233], v[232:233], v[40:41]
v_pk_add_f32 v[234:235], v[234:235], v[42:43]
s_waitcnt lgkmcnt(9)
v_pk_add_f32 v[248:249], v[248:249], v[56:57]
v_pk_add_f32 v[250:251], v[250:251], v[58:59]
M v[24:27], a[112:115], v[228:231], v[24:27]
buffer_store_dwordx4 v[228:231], v1, s[16:19], s38 offen offset:2048 sc1
v_pk_mul_f32 v[232:233], v[232:233], v[10:11] op_sel:[0,0] op_sel_hi:[1,0]
v_pk_mul_f32 v[234:235], v[234:235], v[10:11] op_sel:[0,0] op_sel_hi:[1,0]
v_pk_mul_f32 v[248:249], v[248:249], v[10:11] op_sel:[0,0] op_sel_hi:[1,0]
v_pk_mul_f32 v[250:251], v[250:251], v[10:11] op_sel:[0,0] op_sel_hi:[1,0]
v_cvt_pk_bf16_f32 v232, v232, v233
v_cvt_pk_bf16_f32 v233, v234, v235
v_cvt_pk_bf16_f32 v234, v248, v249
v_cvt_pk_bf16_f32 v235, v250, v251
v_pk_add_f32 v[236:237], v[236:237], v[44:45]
v_pk_add_f32 v[238:239], v[238:239], v[46:47]
s_waitcnt lgkmcnt(8)
v_pk_add_f32 v[252:253], v[252:253], v[60:61]
v_pk_add_f32 v[254:255], v[254:255], v[62:63]
M v[24:27], a[112:115], v[232:235], v[24:27]
buffer_store_dwordx4 v[232:235], v1, s[16:19], s39 offen offset:0 sc1
v_pk_mul_f32 v[236:237], v[236:237], v[10:11] op_sel:[0,1] op_sel_hi:[1,1]
v_pk_mul_f32 v[238:239], v[238:239], v[10:11] op_sel:[0,1] op_sel_hi:[1,1]
v_pk_mul_f32 v[252:253], v[252:253], v[10:11] op_sel:[0,1] op_sel_hi:[1,1]
v_pk_mul_f32 v[254:255], v[254:255], v[10:11] op_sel:[0,1] op_sel_hi:[1,1]
v_cvt_pk_bf16_f32 v236, v236, v237
v_cvt_pk_bf16_f32 v237, v238, v239
v_cvt_pk_bf16_f32 v238, v252, v253
v_cvt_pk_bf16_f32 v239, v254, v255
v_accvgpr_read_b32 v32, a64
v_accvgpr_read_b32 v33, a65
v_accvgpr_read_b32 v34, a66
v_accvgpr_read_b32 v35, a67
s_waitcnt lgkmcnt(7)
v_pk_add_f32 v[32:33], v[32:33], v[64:65]
v_pk_add_f32 v[34:35], v[34:35], v[66:67]
v_accvgpr_read_b32 v48, a80
v_accvgpr_read_b32 v49, a81
v_accvgpr_read_b32 v50, a82
v_accvgpr_read_b32 v51, a83
s_waitcnt lgkmcnt(3)
v_pk_add_f32 v[48:49], v[48:49], v[80:81]
v_pk_add_f32 v[50:51], v[50:51], v[82:83]
M v[24:27], a[112:115], v[236:239], v[24:27]
buffer_store_dwordx4 v[236:239], v1, s[16:19], s39 offen offset:2048 sc1
v_pk_mul_f32 v[32:33], v[32:33], v[8:9] op_sel:[0,0] op_sel_hi:[1,0]
v_pk_mul_f32 v[34:35], v[34:35], v[8:9] op_sel:[0,0] op_sel_hi:[1,0]
v_pk_mul_f32 v[48:49], v[48:49], v[8:9] op_sel:[0,0] op_sel_hi:[1,0]
v_pk_mul_f32 v[50:51], v[50:51], v[8:9] op_sel:[0,0] op_sel_hi:[1,0]
v_cvt_pk_bf16_f32 v32, v32, v33
v_cvt_pk_bf16_f32 v33, v34, v35
v_cvt_pk_bf16_f32 v34, v48, v49
v_cvt_pk_bf16_f32 v35, v50, v51
v_accvgpr_read_b32 v240, a68
v_accvgpr_read_b32 v241, a69
v_accvgpr_read_b32 v242, a70
v_accvgpr_read_b32 v243, a71
v_pk_add_f32 v[240:241], v[240:241], v[68:69]
v_pk_add_f32 v[242:243], v[242:243], v[70:71]
v_accvgpr_read_b32 v36, a84
v_accvgpr_read_b32 v37, a85
v_accvgpr_read_b32 v38, a86
v_accvgpr_read_b32 v39, a87
s_waitcnt lgkmcnt(2)
v_pk_add_f32 v[36:37], v[36:37], v[84:85]
v_pk_add_f32 v[38:39], v[38:39], v[86:87]
M v[24:27], a[112:115], v[32:35], v[24:27]
buffer_store_dwordx4 v[32:35], v1, s[16:19], s38 offen offset:1024 sc1
v_pk_mul_f32 v[240:241], v[240:241], v[8:9] op_sel:[0,1] op_sel_hi:[1,1]
v_pk_mul_f32 v[242:243], v[242:243], v[8:9] op_sel:[0,1] op_sel_hi:[1,1]
v_pk_mul_f32 v[36:37], v[36:37], v[8:9] op_sel:[0,1] op_sel_hi:[1,1]
v_pk_mul_f32 v[38:39], v[38:39], v[8:9] op_sel:[0,1] op_sel_hi:[1,1]
v_cvt_pk_bf16_f32 v240, v240, v241
v_cvt_pk_bf16_f32 v241, v242, v243
v_cvt_pk_bf16_f32 v242, v36, v37
v_cvt_pk_bf16_f32 v243, v38, v39
v_accvgpr_read_b32 v52, a72
v_accvgpr_read_b32 v53, a73
v_accvgpr_read_b32 v54, a74
v_accvgpr_read_b32 v55, a75
v_pk_add_f32 v[52:53], v[52:53], v[72:73]
v_pk_add_f32 v[54:55], v[54:55], v[74:75]
v_accvgpr_read_b32 v244, a88
v_accvgpr_read_b32 v245, a89
v_accvgpr_read_b32 v246, a90
v_accvgpr_read_b32 v247, a91
s_waitcnt lgkmcnt(1)
v_pk_add_f32 v[244:245], v[244:245], v[88:89]
v_pk_add_f32 v[246:247], v[246:247], v[90:91]
M v[24:27], a[112:115], v[240:243], v[24:27]
buffer_store_dwordx4 v[240:243], v1, s[16:19], s38 offen offset:3072 sc1
v_pk_mul_f32 v[52:53], v[52:53], v[10:11] op_sel:[0,0] op_sel_hi:[1,0]
v_pk_mul_f32 v[54:55], v[54:55], v[10:11] op_sel:[0,0] op_sel_hi:[1,0]
v_pk_mul_f32 v[244:245], v[244:245], v[10:11] op_sel:[0,0] op_sel_hi:[1,0]
v_pk_mul_f32 v[246:247], v[246:247], v[10:11] op_sel:[0,0] op_sel_hi:[1,0]
v_cvt_pk_bf16_f32 v52, v52, v53
v_cvt_pk_bf16_f32 v53, v54, v55
v_cvt_pk_bf16_f32 v54, v244, v245
v_cvt_pk_bf16_f32 v55, v246, v247
v_accvgpr_read_b32 v40, a76
v_accvgpr_read_b32 v41, a77
v_accvgpr_read_b32 v42, a78
v_accvgpr_read_b32 v43, a79
v_pk_add_f32 v[40:41], v[40:41], v[76:77]
v_pk_add_f32 v[42:43], v[42:43], v[78:79]
v_accvgpr_read_b32 v56, a92
v_accvgpr_read_b32 v57, a93
v_accvgpr_read_b32 v58, a94
v_accvgpr_read_b32 v59, a95
s_waitcnt lgkmcnt(0)
v_pk_add_f32 v[56:57], v[56:57], v[92:93]
v_pk_add_f32 v[58:59], v[58:59], v[94:95]
M v[24:27], a[112:115], v[52:55], v[24:27]
buffer_store_dwordx4 v[52:55], v1, s[16:19], s39 offen offset:1024 sc1
v_pk_mul_f32 v[40:41], v[40:41], v[10:11] op_sel:[0,1] op_sel_hi:[1,1]
v_pk_mul_f32 v[42:43], v[42:43], v[10:11] op_sel:[0,1] op_sel_hi:[1,1]
v_pk_mul_f32 v[56:57], v[56:57], v[10:11] op_sel:[0,1] op_sel_hi:[1,1]
v_pk_mul_f32 v[58:59], v[58:59], v[10:11] op_sel:[0,1] op_sel_hi:[1,1]
v_cvt_pk_bf16_f32 v40, v40, v41
v_cvt_pk_bf16_f32 v41, v42, v43
v_cvt_pk_bf16_f32 v42, v56, v57
v_cvt_pk_bf16_f32 v43, v58, v59
s_nop 1
M v[24:27], a[112:115], v[40:43], v[24:27]
buffer_store_dwordx4 v[40:43], v1, s[16:19], s39 offen offset:3072 sc1
v_cmp_lt_u32 vcc, 0x3c000000, v12
s_nop 5
v_cmp_class_f32 s[40:41], v24, s64
s_nop 0
s_or_b64 vcc, vcc, s[40:41]
s_cmp_lg_u64 vcc, 0
s_cselect_b32 s33, 2, 0
s_or_b32 s60, s60, s33
Lk2_chk:
s_cmp_eq_u32 s60, 0
s_cbranch_scc1 Lk2_done
s_sub_u32 s56, 15, s21
s_lshl_b32 s33, s24, 1
s_lshl_b32 s61, 3, s33
s_and_b32 s34, s60, 2
s_bitcmp1_b32 s60, 0
s_cselect_b32 s56, s21, s56
s_cselect_b32 s61, 15, s61
s_cselect_b32 s60, s34, 0
s_waitcnt vmcnt(0)
s_lshl_b32 s33, s20, 7
s_lshl_b32 s34, s56, 3
s_add_u32 s33, s33, s34
s_lshl_b32 s34, s23, 2
s_add_u32 s33, s33, s34
s_lshl_b32 s33, s33, 12
buffer_load_dwordx4 a[0:3], v1, s[8:11], s33 offen offset:0 sc1
buffer_load_dwordx4 a[4:7], v1, s[8:11], s33 offen offset:1024 sc1
buffer_load_dwordx4 a[8:11], v1, s[8:11], s33 offen offset:2048 sc1
buffer_load_dwordx4 a[12:15], v1, s[8:11], s33 offen offset:3072 sc1
s_add_u32 s33, s33, 4096
buffer_load_dwordx4 a[16:19], v1, s[8:11], s33 offen offset:0 sc1
buffer_load_dwordx4 a[20:23], v1, s[8:11], s33 offen offset:1024 sc1
buffer_load_dwordx4 a[24:27], v1, s[8:11], s33 offen offset:2048 sc1
buffer_load_dwordx4 a[28:31], v1, s[8:11], s33 offen offset:3072 sc1
s_add_u32 s33, s33, 4096
buffer_load_dwordx4 a[32:35], v1, s[8:11], s33 offen offset:0 sc1
buffer_load_dwordx4 a[36:39], v1, s[8:11], s33 offen offset:1024 sc1
buffer_load_dwordx4 a[40:43], v1, s[8:11], s33 offen offset:2048 sc1
buffer_load_dwordx4 a[44:47], v1, s[8:11], s33 offen offset:3072 sc1
s_add_u32 s33, s33, 4096
buffer_load_dwordx4 a[48:51], v1, s[8:11], s33 offen offset:0 sc1
buffer_load_dwordx4 a[52:55], v1, s[8:11], s33 offen offset:1024 sc1
buffer_load_dwordx4 a[56:59], v1, s[8:11], s33 offen offset:2048 sc1
buffer_load_dwordx4 a[60:63], v1, s[8:11], s33 offen offset:3072 sc1
v_accvgpr_write_b32 a64, 0
v_accvgpr_write_b32 a65, 0
v_accvgpr_write_b32 a66, 0
v_accvgpr_write_b32 a67, 0
v_accvgpr_write_b32 a68, 0
v_accvgpr_write_b32 a69, 0
v_accvgpr_write_b32 a70, 0
v_accvgpr_write_b32 a71, 0
v_accvgpr_write_b32 a72, 0
v_accvgpr_write_b32 a73, 0
v_accvgpr_write_b32 a74, 0
v_accvgpr_write_b32 a75, 0
v_accvgpr_write_b32 a76, 0
v_accvgpr_write_b32 a77, 0
v_accvgpr_write_b32 a78, 0
v_accvgpr_write_b32 a79, 0
v_accvgpr_write_b32 a80, 0
v_accvgpr_write_b32 a81, 0
v_accvgpr_write_b32 a82, 0
v_accvgpr_write_b32 a83, 0
v_accvgpr_write_b32 a84, 0
v_accvgpr_write_b32 a85, 0
v_accvgpr_write_b32 a86, 0
v_accvgpr_write_b32 a87, 0
v_accvgpr_write_b32 a88, 0
v_accvgpr_write_b32 a89, 0
v_accvgpr_write_b32 a90, 0
v_accvgpr_write_b32 a91, 0
v_accvgpr_write_b32 a92, 0
v_accvgpr_write_b32 a93, 0
v_accvgpr_write_b32 a94, 0
v_accvgpr_write_b32 a95, 0
v_accvgpr_write_b32 a96, 0
v_accvgpr_write_b32 a97, 0
v_accvgpr_write_b32 a98, 0
v_accvgpr_write_b32 a99, 0
v_accvgpr_write_b32 a100, 0
v_accvgpr_write_b32 a101, 0
v_accvgpr_write_b32 a102, 0
v_accvgpr_write_b32 a103, 0
v_accvgpr_write_b32 a104, 0
v_accvgpr_write_b32 a105, 0
v_accvgpr_write_b32 a106, 0
v_accvgpr_write_b32 a107, 0
v_accvgpr_write_b32 a108, 0
v_accvgpr_write_b32 a109, 0
v_accvgpr_write_b32 a110, 0
v_accvgpr_write_b32 a111, 0
v_mov_b32 v160, 0
v_mov_b32 v161, 0
v_mov_b32 v162, 0
v_mov_b32 v163, 0
v_mov_b32 v164, 0
v_mov_b32 v165, 0
v_mov_b32 v166, 0
v_mov_b32 v167, 0
v_mov_b32 v168, 0
v_mov_b32 v169, 0
v_mov_b32 v170, 0
v_mov_b32 v171, 0
v_mov_b32 v172, 0
v_mov_b32 v173, 0
v_mov_b32 v174, 0
v_mov_b32 v175, 0
v_mov_b32 v176, 0
v_mov_b32 v177, 0
v_mov_b32 v178, 0
v_mov_b32 v179, 0
v_mov_b32 v180, 0
v_mov_b32 v181, 0
v_mov_b32 v182, 0
v_mov_b32 v183, 0
v_mov_b32 v184, 0
v_mov_b32 v185, 0
v_mov_b32 v186, 0
v_mov_b32 v187, 0
v_mov_b32 v188, 0
v_mov_b32 v189, 0
v_mov_b32 v190, 0
v_mov_b32 v191, 0
v_mov_b32 v192, 0
v_mov_b32 v193, 0
v_mov_b32 v194, 0
v_mov_b32 v195, 0
v_mov_b32 v196, 0
v_mov_b32 v197, 0
v_mov_b32 v198, 0
v_mov_b32 v199, 0
v_mov_b32 v200, 0
v_mov_b32 v201, 0
v_mov_b32 v202, 0
v_mov_b32 v203, 0
v_mov_b32 v204, 0
v_mov_b32 v205, 0
v_mov_b32 v206, 0
v_mov_b32 v207, 0
v_mov_b32 v208, 0
v_mov_b32 v209, 0
v_mov_b32 v210, 0
v_mov_b32 v211, 0
v_mov_b32 v212, 0
v_mov_b32 v213, 0
v_mov_b32 v214, 0
v_mov_b32 v215, 0
v_mov_b32 v216, 0
v_mov_b32 v217, 0
v_mov_b32 v218, 0
v_mov_b32 v219, 0
v_mov_b32 v220, 0
v_mov_b32 v221, 0
v_mov_b32 v222, 0
v_mov_b32 v223, 0
v_mov_b32 v224, 0
v_mov_b32 v225, 0
v_mov_b32 v226, 0
v_mov_b32 v227, 0
v_mov_b32 v228, 0
v_mov_b32 v229, 0
v_mov_b32 v230, 0
v_mov_b32 v231, 0
v_mov_b32 v232, 0
v_mov_b32 v233, 0
v_mov_b32 v234, 0
v_mov_b32 v235, 0
v_mov_b32 v236, 0
v_mov_b32 v237, 0
v_mov_b32 v238, 0
v_mov_b32 v239, 0
v_mov_b32 v240, 0
v_mov_b32 v241, 0
v_mov_b32 v242, 0
v_mov_b32 v243, 0
v_mov_b32 v244, 0
v_mov_b32 v245, 0
v_mov_b32 v246, 0
v_mov_b32 v247, 0
v_mov_b32 v248, 0
v_mov_b32 v249, 0
v_mov_b32 v250, 0
v_mov_b32 v251, 0
v_mov_b32 v252, 0
v_mov_b32 v253, 0
v_mov_b32 v254, 0
v_mov_b32 v255, 0
v_mov_b32 v8, v4
v_mov_b32 v9, v4
v_mov_b32 v10, v4
v_mov_b32 v11, v4
s_lshl_b32 s57, s20, 20
s_lshl_b32 s58, s56, 7
s_lshl_b32 s59, s56, 1
s_add_u32 s59, s59, 2
Lslow_2:
s_add_u32 s35, s57, 0
buffer_load_dwordx4 v[96:99], v1, s[12:15], s35 offen offset:0 sc1
buffer_load_dwordx4 v[100:103], v1, s[12:15], s35 offen offset:1024 sc1
buffer_load_dwordx4 v[104:107], v1, s[12:15], s35 offen offset:2048 sc1
buffer_load_dwordx4 v[108:111], v1, s[12:15], s35 offen offset:3072 sc1
s_add_u32 s35, s57, 4096
buffer_load_dwordx4 v[112:115], v1, s[12:15], s35 offen offset:0 sc1
buffer_load_dwordx4 v[116:119], v1, s[12:15], s35 offen offset:1024 sc1
buffer_load_dwordx4 v[120:123], v1, s[12:15], s35 offen offset:2048 sc1
buffer_load_dwordx4 v[124:127], v1, s[12:15], s35 offen offset:3072 sc1
s_add_u32 s35, s57, 8192
buffer_load_dwordx4 v[128:131], v1, s[12:15], s35 offen offset:0 sc1
buffer_load_dwordx4 v[132:135], v1, s[12:15], s35 offen offset:1024 sc1
buffer_load_dwordx4 v[136:139], v1, s[12:15], s35 offen offset:2048 sc1
buffer_load_dwordx4 v[140:143], v1, s[12:15], s35 offen offset:3072 sc1
s_add_u32 s35, s57, 12288
buffer_load_dwordx4 v[144:147], v1, s[12:15], s35 offen offset:0 sc1
buffer_load_dwordx4 v[148:151], v1, s[12:15], s35 offen offset:1024 sc1
buffer_load_dwordx4 v[152:155], v1, s[12:15], s35 offen offset:2048 sc1
buffer_load_dwordx4 v[156:159], v1, s[12:15], s35 offen offset:3072 sc1
s_lshl_b32 s33, s23, 6
s_add_i32 s33, s33, s58
s_cmp_gt_i32 s33, 0
s_cselect_b32 s34, 0, 0xf149f2ca
s_cmp_lt_i32 s33, 0
s_cselect_b32 s33, 0xf149f2ca, 0
v_mov_b32 v20, s34
v_mov_b32 v21, s34
v_mov_b32 v22, s34
v_mov_b32 v23, s34
v_mov_b32 v28, s33
v_mov_b32 v29, s33
v_mov_b32 v30, s33
v_mov_b32 v31, s33
v_med3_f32 v24, v16, v20, v28
v_med3_f32 v25, v17, v20, v28
v_med3_f32 v26, v18, v20, v28
v_med3_f32 v27, v19, v20, v28
s_waitcnt vmcnt(0)
s_nop 0
M v[32:35], v[96:99], a[0:3], v[24:27]
M v[32:35], v[100:103], a[4:7], v[32:35]
M v[32:35], v[104:107], a[8:11], v[32:35]
M v[32:35], v[108:111], a[12:15], v[32:35]
M v[36:39], v[96:99], a[16:19], v[28:31]
M v[36:39], v[100:103], a[20:23], v[36:39]
M v[36:39], v[104:107], a[24:27], v[36:39]
M v[36:39], v[108:111], a[28:31], v[36:39]
M v[40:43], v[96:99], a[32:35], v[28:31]
M v[40:43], v[100:103], a[36:39], v[40:43]
M v[40:43], v[104:107], a[40:43], v[40:43]
M v[40:43], v[108:111], a[44:47], v[40:43]
M v[44:47], v[96:99], a[48:51], v[28:31]
M v[44:47], v[100:103], a[52:55], v[44:47]
M v[44:47], v[104:107], a[56:59], v[44:47]
M v[44:47], v[108:111], a[60:63], v[44:47]
M v[48:51], v[112:115], a[0:3], v[20:23]
M v[48:51], v[116:119], a[4:7], v[48:51]
M v[48:51], v[120:123], a[8:11], v[48:51]
M v[48:51], v[124:127], a[12:15], v[48:51]
M v[52:55], v[112:115], a[16:19], v[24:27]
M v[52:55], v[116:119], a[20:23], v[52:55]
M v[52:55], v[120:123], a[24:27], v[52:55]
M v[52:55], v[124:127], a[28:31], v[52:55]
M v[56:59], v[112:115], a[32:35], v[28:31]
M v[56:59], v[116:119], a[36:39], v[56:59]
M v[56:59], v[120:123], a[40:43], v[56:59]
M v[56:59], v[124:127], a[44:47], v[56:59]
M v[60:63], v[112:115], a[48:51], v[28:31]
M v[60:63], v[116:119], a[52:55], v[60:63]
M v[60:63], v[120:123], a[56:59], v[60:63]
M v[60:63], v[124:127], a[60:63], v[60:63]
M v[64:67], v[128:131], a[0:3], v[20:23]
M v[64:67], v[132:135], a[4:7], v[64:67]
M v[64:67], v[136:139], a[8:11], v[64:67]
M v[64:67], v[140:143], a[12:15], v[64:67]
M v[68:71], v[128:131], a[16:19], v[20:23]
M v[68:71], v[132:135], a[20:23], v[68:71]
M v[68:71], v[136:139], a[24:27], v[68:71]
M v[68:71], v[140:143], a[28:31], v[68:71]
M v[72:75], v[128:131], a[32:35], v[24:27]
M v[72:75], v[132:135], a[36:39], v[72:75]
M v[72:75], v[136:139], a[40:43], v[72:75]
M v[72:75], v[140:143], a[44:47], v[72:75]
M v[76:79], v[128:131], a[48:51], v[28:31]
M v[76:79], v[132:135], a[52:55], v[76:79]
M v[76:79], v[136:139], a[56:59], v[76:79]
M v[76:79], v[140:143], a[60:63], v[76:79]
M v[80:83], v[144:147], a[0:3], v[20:23]
M v[80:83], v[148:151], a[4:7], v[80:83]
M v[80:83], v[152:155], a[8:11], v[80:83]
M v[80:83], v[156:159], a[12:15], v[80:83]
M v[84:87], v[144:147], a[16:19], v[20:23]
M v[84:87], v[148:151], a[20:23], v[84:87]
M v[84:87], v[152:155], a[24:27], v[84:87]
M v[84:87], v[156:159], a[28:31], v[84:87]
M v[88:91], v[144:147], a[32:35], v[20:23]
M v[88:91], v[148:151], a[36:39], v[88:91]
M v[88:91], v[152:155], a[40:43], v[88:91]
M v[88:91], v[156:159], a[44:47], v[88:91]
M v[92:95], v[144:147], a[48:51], v[24:27]
M v[92:95], v[148:151], a[52:55], v[92:95]
M v[92:95], v[152:155], a[56:59], v[92:95]
M v[92:95], v[156:159], a[60:63], v[92:95]
s_nop 7
s_add_u32 s35, s57, 16384
buffer_load_dwordx4 v[96:99], v1, s[12:15], s35 offen offset:0 sc1
buffer_load_dwordx4 v[100:103], v1, s[12:15], s35 offen offset:1024 sc1
buffer_load_dwordx4 v[104:107], v1, s[12:15], s35 offen offset:2048 sc1
buffer_load_dwordx4 v[108:111], v1, s[12:15], s35 offen offset:3072 sc1
s_add_u32 s35, s57, 20480
buffer_load_dwordx4 v[112:115], v1, s[12:15], s35 offen offset:0 sc1
buffer_load_dwordx4 v[116:119], v1, s[12:15], s35 offen offset:1024 sc1
buffer_load_dwordx4 v[120:123], v1, s[12:15], s35 offen offset:2048 sc1
buffer_load_dwordx4 v[124:127], v1, s[12:15], s35 offen offset:3072 sc1
s_add_u32 s35, s57, 24576
buffer_load_dwordx4 v[128:131], v1, s[12:15], s35 offen offset:0 sc1
buffer_load_dwordx4 v[132:135], v1, s[12:15], s35 offen offset:1024 sc1
buffer_load_dwordx4 v[136:139], v1, s[12:15], s35 offen offset:2048 sc1
buffer_load_dwordx4 v[140:143], v1, s[12:15], s35 offen offset:3072 sc1
s_add_u32 s35, s57, 28672
buffer_load_dwordx4 v[144:147], v1, s[12:15], s35 offen offset:0 sc1
buffer_load_dwordx4 v[148:151], v1, s[12:15], s35 offen offset:1024 sc1
buffer_load_dwordx4 v[152:155], v1, s[12:15], s35 offen offset:2048 sc1
buffer_load_dwordx4 v[156:159], v1, s[12:15], s35 offen offset:3072 sc1
v_max3_f32 v13, v32, v33, v8
v_max3_f32 v13, v13, v34, v35
v_max3_f32 v13, v13, v48, v49
v_max3_f32 v13, v13, v50, v51
v_max3_f32 v13, v13, v64, v65
v_max3_f32 v13, v13, v66, v67
v_max3_f32 v13, v13, v80, v81
v_max3_f32 v13, v13, v82, v83
v_mov_b32 v14, v13
s_nop 1
v_permlane16_swap_b32 v13, v14
v_max_f32 v13, v13, v14
v_mov_b32 v14, v13
s_nop 1
v_permlane32_swap_b32 v13, v14
v_max_f32 v13, v13, v14
v_sub_f32 v12, v8, v13
v_exp_f32 v12, v12
v_mov_b32 v8, v13
v_sub_f32 v32, v32, v13
v_sub_f32 v33, v33, v13
v_sub_f32 v34, v34, v13
v_sub_f32 v35, v35, v13
v_sub_f32 v48, v48, v13
v_sub_f32 v49, v49, v13
v_sub_f32 v50, v50, v13
v_sub_f32 v51, v51, v13
v_sub_f32 v64, v64, v13
v_sub_f32 v65, v65, v13
v_sub_f32 v66, v66, v13
v_sub_f32 v67, v67, v13
v_sub_f32 v80, v80, v13
v_sub_f32 v81, v81, v13
v_sub_f32 v82, v82, v13
v_sub_f32 v83, v83, v13
v_mul_f32 v160, v160, v12
v_mul_f32 v161, v161, v12
v_mul_f32 v162, v162, v12
v_mul_f32 v163, v163, v12
v_mul_f32 v176, v176, v12
v_mul_f32 v177, v177, v12
v_mul_f32 v178, v178, v12
v_mul_f32 v179, v179, v12
v_mul_f32 v192, v192, v12
v_mul_f32 v193, v193, v12
v_mul_f32 v194, v194, v12
v_mul_f32 v195, v195, v12
v_mul_f32 v208, v208, v12
v_mul_f32 v209, v209, v12
v_mul_f32 v210, v210, v12
v_mul_f32 v211, v211, v12
v_mul_f32 v224, v224, v12
v_mul_f32 v225, v225, v12
v_mul_f32 v226, v226, v12
v_mul_f32 v227, v227, v12
v_mul_f32 v240, v240, v12
v_mul_f32 v241, v241, v12
v_mul_f32 v242, v242, v12
v_mul_f32 v243, v243, v12
v_accvgpr_read_b32 v14, a64
v_mul_f32 v14, v14, v12
v_accvgpr_write_b32 a64, v14
v_accvgpr_read_b32 v14, a65
v_mul_f32 v14, v14, v12
v_accvgpr_write_b32 a65, v14
v_accvgpr_read_b32 v14, a66
v_mul_f32 v14, v14, v12
v_accvgpr_write_b32 a66, v14
v_accvgpr_read_b32 v14, a67
v_mul_f32 v14, v14, v12
v_accvgpr_write_b32 a67, v14
v_accvgpr_read_b32 v14, a80
v_mul_f32 v14, v14, v12
v_accvgpr_write_b32 a80, v14
v_accvgpr_read_b32 v14, a81
v_mul_f32 v14, v14, v12
v_accvgpr_write_b32 a81, v14
v_accvgpr_read_b32 v14, a82
v_mul_f32 v14, v14, v12
v_accvgpr_write_b32 a82, v14
v_accvgpr_read_b32 v14, a83
v_mul_f32 v14, v14, v12
v_accvgpr_write_b32 a83, v14
v_accvgpr_read_b32 v14, a96
v_mul_f32 v14, v14, v12
v_accvgpr_write_b32 a96, v14
v_accvgpr_read_b32 v14, a97
v_mul_f32 v14, v14, v12
v_accvgpr_write_b32 a97, v14
v_accvgpr_read_b32 v14, a98
v_mul_f32 v14, v14, v12
v_accvgpr_write_b32 a98, v14
v_accvgpr_read_b32 v14, a99
v_mul_f32 v14, v14, v12
v_accvgpr_write_b32 a99, v14
v_max3_f32 v13, v36, v37, v9
v_max3_f32 v13, v13, v38, v39
v_max3_f32 v13, v13, v52, v53
v_max3_f32 v13, v13, v54, v55
v_max3_f32 v13, v13, v68, v69
v_max3_f32 v13, v13, v70, v71
v_max3_f32 v13, v13, v84, v85
v_max3_f32 v13, v13, v86, v87
v_mov_b32 v14, v13
s_nop 1
v_permlane16_swap_b32 v13, v14
v_max_f32 v13, v13, v14
v_mov_b32 v14, v13
s_nop 1
v_permlane32_swap_b32 v13, v14
v_max_f32 v13, v13, v14
v_sub_f32 v12, v9, v13
v_exp_f32 v12, v12
v_mov_b32 v9, v13
v_sub_f32 v36, v36, v13
v_sub_f32 v37, v37, v13
v_sub_f32 v38, v38, v13
v_sub_f32 v39, v39, v13
v_sub_f32 v52, v52, v13
v_sub_f32 v53, v53, v13
v_sub_f32 v54, v54, v13
v_sub_f32 v55, v55, v13
v_sub_f32 v68, v68, v13
v_sub_f32 v69, v69, v13
v_sub_f32 v70, v70, v13
v_sub_f32 v71, v71, v13
v_sub_f32 v84, v84, v13
v_sub_f32 v85, v85, v13
v_sub_f32 v86, v86, v13
v_sub_f32 v87, v87, v13
v_mul_f32 v164, v164, v12
v_mul_f32 v165, v165, v12
v_mul_f32 v166, v166, v12
v_mul_f32 v167, v167, v12
v_mul_f32 v180, v180, v12
v_mul_f32 v181, v181, v12
v_mul_f32 v182, v182, v12
v_mul_f32 v183, v183, v12
v_mul_f32 v196, v196, v12
v_mul_f32 v197, v197, v12
v_mul_f32 v198, v198, v12
v_mul_f32 v199, v199, v12
v_mul_f32 v212, v212, v12
v_mul_f32 v213, v213, v12
v_mul_f32 v214, v214, v12
v_mul_f32 v215, v215, v12
v_mul_f32 v228, v228, v12
v_mul_f32 v229, v229, v12
v_mul_f32 v230, v230, v12
v_mul_f32 v231, v231, v12
v_mul_f32 v244, v244, v12
v_mul_f32 v245, v245, v12
v_mul_f32 v246, v246, v12
v_mul_f32 v247, v247, v12
v_accvgpr_read_b32 v14, a68
v_mul_f32 v14, v14, v12
v_accvgpr_write_b32 a68, v14
v_accvgpr_read_b32 v14, a69
v_mul_f32 v14, v14, v12
v_accvgpr_write_b32 a69, v14
v_accvgpr_read_b32 v14, a70
v_mul_f32 v14, v14, v12
v_accvgpr_write_b32 a70, v14
v_accvgpr_read_b32 v14, a71
v_mul_f32 v14, v14, v12
v_accvgpr_write_b32 a71, v14
v_accvgpr_read_b32 v14, a84
v_mul_f32 v14, v14, v12
v_accvgpr_write_b32 a84, v14
v_accvgpr_read_b32 v14, a85
v_mul_f32 v14, v14, v12
v_accvgpr_write_b32 a85, v14
v_accvgpr_read_b32 v14, a86
v_mul_f32 v14, v14, v12
v_accvgpr_write_b32 a86, v14
v_accvgpr_read_b32 v14, a87
v_mul_f32 v14, v14, v12
v_accvgpr_write_b32 a87, v14
v_accvgpr_read_b32 v14, a100
v_mul_f32 v14, v14, v12
v_accvgpr_write_b32 a100, v14
v_accvgpr_read_b32 v14, a101
v_mul_f32 v14, v14, v12
v_accvgpr_write_b32 a101, v14
v_accvgpr_read_b32 v14, a102
v_mul_f32 v14, v14, v12
v_accvgpr_write_b32 a102, v14
v_accvgpr_read_b32 v14, a103
v_mul_f32 v14, v14, v12
v_accvgpr_write_b32 a103, v14
v_max3_f32 v13, v40, v41, v10
v_max3_f32 v13, v13, v42, v43
v_max3_f32 v13, v13, v56, v57
v_max3_f32 v13, v13, v58, v59
v_max3_f32 v13, v13, v72, v73
v_max3_f32 v13, v13, v74, v75
v_max3_f32 v13, v13, v88, v89
v_max3_f32 v13, v13, v90, v91
v_mov_b32 v14, v13
s_nop 1
v_permlane16_swap_b32 v13, v14
v_max_f32 v13, v13, v14
v_mov_b32 v14, v13
s_nop 1
v_permlane32_swap_b32 v13, v14
v_max_f32 v13, v13, v14
v_sub_f32 v12, v10, v13
v_exp_f32 v12, v12
v_mov_b32 v10, v13
v_sub_f32 v40, v40, v13
v_sub_f32 v41, v41, v13
v_sub_f32 v42, v42, v13
v_sub_f32 v43, v43, v13
v_sub_f32 v56, v56, v13
v_sub_f32 v57, v57, v13
v_sub_f32 v58, v58, v13
v_sub_f32 v59, v59, v13
v_sub_f32 v72, v72, v13
v_sub_f32 v73, v73, v13
v_sub_f32 v74, v74, v13
v_sub_f32 v75, v75, v13
v_sub_f32 v88, v88, v13
v_sub_f32 v89, v89, v13
v_sub_f32 v90, v90, v13
v_sub_f32 v91, v91, v13
v_mul_f32 v168, v168, v12
v_mul_f32 v169, v169, v12
v_mul_f32 v170, v170, v12
v_mul_f32 v171, v171, v12
v_mul_f32 v184, v184, v12
v_mul_f32 v185, v185, v12
v_mul_f32 v186, v186, v12
v_mul_f32 v187, v187, v12
v_mul_f32 v200, v200, v12
v_mul_f32 v201, v201, v12
v_mul_f32 v202, v202, v12
v_mul_f32 v203, v203, v12
v_mul_f32 v216, v216, v12
v_mul_f32 v217, v217, v12
v_mul_f32 v218, v218, v12
v_mul_f32 v219, v219, v12
v_mul_f32 v232, v232, v12
v_mul_f32 v233, v233, v12
v_mul_f32 v234, v234, v12
v_mul_f32 v235, v235, v12
v_mul_f32 v248, v248, v12
v_mul_f32 v249, v249, v12
v_mul_f32 v250, v250, v12
v_mul_f32 v251, v251, v12
v_accvgpr_read_b32 v14, a72
v_mul_f32 v14, v14, v12
v_accvgpr_write_b32 a72, v14
v_accvgpr_read_b32 v14, a73
v_mul_f32 v14, v14, v12
v_accvgpr_write_b32 a73, v14
v_accvgpr_read_b32 v14, a74
v_mul_f32 v14, v14, v12
v_accvgpr_write_b32 a74, v14
v_accvgpr_read_b32 v14, a75
v_mul_f32 v14, v14, v12
v_accvgpr_write_b32 a75, v14
v_accvgpr_read_b32 v14, a88
v_mul_f32 v14, v14, v12
v_accvgpr_write_b32 a88, v14
v_accvgpr_read_b32 v14, a89
v_mul_f32 v14, v14, v12
v_accvgpr_write_b32 a89, v14
v_accvgpr_read_b32 v14, a90
v_mul_f32 v14, v14, v12
v_accvgpr_write_b32 a90, v14
v_accvgpr_read_b32 v14, a91
v_mul_f32 v14, v14, v12
v_accvgpr_write_b32 a91, v14
v_accvgpr_read_b32 v14, a104
v_mul_f32 v14, v14, v12
v_accvgpr_write_b32 a104, v14
v_accvgpr_read_b32 v14, a105
v_mul_f32 v14, v14, v12
v_accvgpr_write_b32 a105, v14
v_accvgpr_read_b32 v14, a106
v_mul_f32 v14, v14, v12
v_accvgpr_write_b32 a106, v14
v_accvgpr_read_b32 v14, a107
v_mul_f32 v14, v14, v12
v_accvgpr_write_b32 a107, v14
v_max3_f32 v13, v44, v45, v11
v_max3_f32 v13, v13, v46, v47
v_max3_f32 v13, v13, v60, v61
v_max3_f32 v13, v13, v62, v63
v_max3_f32 v13, v13, v76, v77
v_max3_f32 v13, v13, v78, v79
v_max3_f32 v13, v13, v92, v93
v_max3_f32 v13, v13, v94, v95
v_mov_b32 v14, v13
s_nop 1
v_permlane16_swap_b32 v13, v14
v_max_f32 v13, v13, v14
v_mov_b32 v14, v13
s_nop 1
v_permlane32_swap_b32 v13, v14
v_max_f32 v13, v13, v14
v_sub_f32 v12, v11, v13
v_exp_f32 v12, v12
v_mov_b32 v11, v13
v_sub_f32 v44, v44, v13
v_sub_f32 v45, v45, v13
v_sub_f32 v46, v46, v13
v_sub_f32 v47, v47, v13
v_sub_f32 v60, v60, v13
v_sub_f32 v61, v61, v13
v_sub_f32 v62, v62, v13
v_sub_f32 v63, v63, v13
v_sub_f32 v76, v76, v13
v_sub_f32 v77, v77, v13
v_sub_f32 v78, v78, v13
v_sub_f32 v79, v79, v13
v_sub_f32 v92, v92, v13
v_sub_f32 v93, v93, v13
v_sub_f32 v94, v94, v13
v_sub_f32 v95, v95, v13
v_mul_f32 v172, v172, v12
v_mul_f32 v173, v173, v12
v_mul_f32 v174, v174, v12
v_mul_f32 v175, v175, v12
v_mul_f32 v188, v188, v12
v_mul_f32 v189, v189, v12
v_mul_f32 v190, v190, v12
v_mul_f32 v191, v191, v12
v_mul_f32 v204, v204, v12
v_mul_f32 v205, v205, v12
v_mul_f32 v206, v206, v12
v_mul_f32 v207, v207, v12
v_mul_f32 v220, v220, v12
v_mul_f32 v221, v221, v12
v_mul_f32 v222, v222, v12
v_mul_f32 v223, v223, v12
v_mul_f32 v236, v236, v12
v_mul_f32 v237, v237, v12
v_mul_f32 v238, v238, v12
v_mul_f32 v239, v239, v12
v_mul_f32 v252, v252, v12
v_mul_f32 v253, v253, v12
v_mul_f32 v254, v254, v12
v_mul_f32 v255, v255, v12
v_accvgpr_read_b32 v14, a76
v_mul_f32 v14, v14, v12
v_accvgpr_write_b32 a76, v14
v_accvgpr_read_b32 v14, a77
v_mul_f32 v14, v14, v12
v_accvgpr_write_b32 a77, v14
v_accvgpr_read_b32 v14, a78
v_mul_f32 v14, v14, v12
v_accvgpr_write_b32 a78, v14
v_accvgpr_read_b32 v14, a79
v_mul_f32 v14, v14, v12
v_accvgpr_write_b32 a79, v14
v_accvgpr_read_b32 v14, a92
v_mul_f32 v14, v14, v12
v_accvgpr_write_b32 a92, v14
v_accvgpr_read_b32 v14, a93
v_mul_f32 v14, v14, v12
v_accvgpr_write_b32 a93, v14
v_accvgpr_read_b32 v14, a94
v_mul_f32 v14, v14, v12
v_accvgpr_write_b32 a94, v14
v_accvgpr_read_b32 v14, a95
v_mul_f32 v14, v14, v12
v_accvgpr_write_b32 a95, v14
v_accvgpr_read_b32 v14, a108
v_mul_f32 v14, v14, v12
v_accvgpr_write_b32 a108, v14
v_accvgpr_read_b32 v14, a109
v_mul_f32 v14, v14, v12
v_accvgpr_write_b32 a109, v14
v_accvgpr_read_b32 v14, a110
v_mul_f32 v14, v14, v12
v_accvgpr_write_b32 a110, v14
v_accvgpr_read_b32 v14, a111
v_mul_f32 v14, v14, v12
v_accvgpr_write_b32 a111, v14
v_exp_f32 v32, v32
v_exp_f32 v33, v33
v_exp_f32 v34, v34
v_exp_f32 v35, v35
v_exp_f32 v48, v48
v_exp_f32 v49, v49
v_exp_f32 v50, v50
v_exp_f32 v51, v51
v_cvt_pk_bf16_f32 v32, v32, v33
v_cvt_pk_bf16_f32 v33, v34, v35
v_exp_f32 v36, v36
v_exp_f32 v37, v37
v_exp_f32 v38, v38
v_exp_f32 v39, v39
v_cvt_pk_bf16_f32 v34, v48, v49
v_cvt_pk_bf16_f32 v35, v50, v51
v_exp_f32 v52, v52
v_exp_f32 v53, v53
v_exp_f32 v54, v54
v_exp_f32 v55, v55
v_cvt_pk_bf16_f32 v36, v36, v37
v_cvt_pk_bf16_f32 v37, v38, v39
v_exp_f32 v40, v40
v_exp_f32 v41, v41
v_exp_f32 v42, v42
v_exp_f32 v43, v43
v_cvt_pk_bf16_f32 v38, v52, v53
v_cvt_pk_bf16_f32 v39, v54, v55
v_exp_f32 v56, v56
v_exp_f32 v57, v57
v_exp_f32 v58, v58
v_exp_f32 v59, v59
v_cvt_pk_bf16_f32 v40, v40, v41
v_cvt_pk_bf16_f32 v41, v42, v43
v_exp_f32 v44, v44
v_exp_f32 v45, v45
v_exp_f32 v46, v46
v_exp_f32 v47, v47
v_cvt_pk_bf16_f32 v42, v56, v57
v_cvt_pk_bf16_f32 v43, v58, v59
v_exp_f32 v60, v60
v_exp_f32 v61, v61
v_exp_f32 v62, v62
v_exp_f32 v63, v63
v_cvt_pk_bf16_f32 v44, v44, v45
v_cvt_pk_bf16_f32 v45, v46, v47
v_cvt_pk_bf16_f32 v46, v60, v61
v_cvt_pk_bf16_f32 v47, v62, v63
v_exp_f32 v64, v64
v_exp_f32 v65, v65
v_exp_f32 v66, v66
v_exp_f32 v67, v67
v_exp_f32 v80, v80
v_exp_f32 v81, v81
v_exp_f32 v82, v82
v_exp_f32 v83, v83
v_cvt_pk_bf16_f32 v64, v64, v65
v_cvt_pk_bf16_f32 v65, v66, v67
v_exp_f32 v68, v68
v_exp_f32 v69, v69
v_exp_f32 v70, v70
v_exp_f32 v71, v71
v_cvt_pk_bf16_f32 v66, v80, v81
v_cvt_pk_bf16_f32 v67, v82, v83
v_exp_f32 v84, v84
v_exp_f32 v85, v85
v_exp_f32 v86, v86
v_exp_f32 v87, v87
v_cvt_pk_bf16_f32 v68, v68, v69
v_cvt_pk_bf16_f32 v69, v70, v71
v_exp_f32 v72, v72
v_exp_f32 v73, v73
v_exp_f32 v74, v74
v_exp_f32 v75, v75
v_cvt_pk_bf16_f32 v70, v84, v85
v_cvt_pk_bf16_f32 v71, v86, v87
v_exp_f32 v88, v88
v_exp_f32 v89, v89
v_exp_f32 v90, v90
v_exp_f32 v91, v91
v_cvt_pk_bf16_f32 v72, v72, v73
v_cvt_pk_bf16_f32 v73, v74, v75
v_exp_f32 v76, v76
v_exp_f32 v77, v77
v_exp_f32 v78, v78
v_exp_f32 v79, v79
v_cvt_pk_bf16_f32 v74, v88, v89
v_cvt_pk_bf16_f32 v75, v90, v91
v_exp_f32 v92, v92
v_exp_f32 v93, v93
v_exp_f32 v94, v94
v_exp_f32 v95, v95
v_cvt_pk_bf16_f32 v76, v76, v77
v_cvt_pk_bf16_f32 v77, v78, v79
v_cvt_pk_bf16_f32 v78, v92, v93
v_cvt_pk_bf16_f32 v79, v94, v95
s_waitcnt vmcnt(0)
M a[96:99], a[112:115], v[32:35], a[96:99]
M a[100:103], a[112:115], v[36:39], a[100:103]
M a[104:107], a[112:115], v[40:43], a[104:107]
M a[108:111], a[112:115], v[44:47], a[108:111]
M v[160:163], v[96:99], v[32:35], v[160:163]
M v[164:167], v[96:99], v[36:39], v[164:167]
M v[168:171], v[96:99], v[40:43], v[168:171]
M v[172:175], v[96:99], v[44:47], v[172:175]
M v[176:179], v[100:103], v[32:35], v[176:179]
M v[180:183], v[100:103], v[36:39], v[180:183]
M v[184:187], v[100:103], v[40:43], v[184:187]
M v[188:191], v[100:103], v[44:47], v[188:191]
M v[192:195], v[104:107], v[32:35], v[192:195]
M v[196:199], v[104:107], v[36:39], v[196:199]
M v[200:203], v[104:107], v[40:43], v[200:203]
M v[204:207], v[104:107], v[44:47], v[204:207]
M v[208:211], v[108:111], v[32:35], v[208:211]
M v[212:215], v[108:111], v[36:39], v[212:215]
M v[216:219], v[108:111], v[40:43], v[216:219]
M v[220:223], v[108:111], v[44:47], v[220:223]
M v[224:227], v[112:115], v[32:35], v[224:227]
M v[228:231], v[112:115], v[36:39], v[228:231]
M v[232:235], v[112:115], v[40:43], v[232:235]
M v[236:239], v[112:115], v[44:47], v[236:239]
M v[240:243], v[116:119], v[32:35], v[240:243]
M v[244:247], v[116:119], v[36:39], v[244:247]
M v[248:251], v[116:119], v[40:43], v[248:251]
M v[252:255], v[116:119], v[44:47], v[252:255]
M a[64:67], v[120:123], v[32:35], a[64:67]
M a[68:71], v[120:123], v[36:39], a[68:71]
M a[72:75], v[120:123], v[40:43], a[72:75]
M a[76:79], v[120:123], v[44:47], a[76:79]
M a[80:83], v[124:127], v[32:35], a[80:83]
M a[84:87], v[124:127], v[36:39], a[84:87]
M a[88:91], v[124:127], v[40:43], a[88:91]
M a[92:95], v[124:127], v[44:47], a[92:95]
M a[96:99], a[112:115], v[64:67], a[96:99]
M a[100:103], a[112:115], v[68:71], a[100:103]
M a[104:107], a[112:115], v[72:75], a[104:107]
M a[108:111], a[112:115], v[76:79], a[108:111]
M v[160:163], v[128:131], v[64:67], v[160:163]
M v[164:167], v[128:131], v[68:71], v[164:167]
M v[168:171], v[128:131], v[72:75], v[168:171]
M v[172:175], v[128:131], v[76:79], v[172:175]
M v[176:179], v[132:135], v[64:67], v[176:179]
M v[180:183], v[132:135], v[68:71], v[180:183]
M v[184:187], v[132:135], v[72:75], v[184:187]
M v[188:191], v[132:135], v[76:79], v[188:191]
M v[192:195], v[136:139], v[64:67], v[192:195]
M v[196:199], v[136:139], v[68:71], v[196:199]
M v[200:203], v[136:139], v[72:75], v[200:203]
M v[204:207], v[136:139], v[76:79], v[204:207]
M v[208:211], v[140:143], v[64:67], v[208:211]
M v[212:215], v[140:143], v[68:71], v[212:215]
M v[216:219], v[140:143], v[72:75], v[216:219]
M v[220:223], v[140:143], v[76:79], v[220:223]
M v[224:227], v[144:147], v[64:67], v[224:227]
M v[228:231], v[144:147], v[68:71], v[228:231]
M v[232:235], v[144:147], v[72:75], v[232:235]
M v[236:239], v[144:147], v[76:79], v[236:239]
M v[240:243], v[148:151], v[64:67], v[240:243]
M v[244:247], v[148:151], v[68:71], v[244:247]
M v[248:251], v[148:151], v[72:75], v[248:251]
M v[252:255], v[148:151], v[76:79], v[252:255]
M a[64:67], v[152:155], v[64:67], a[64:67]
M a[68:71], v[152:155], v[68:71], a[68:71]
M a[72:75], v[152:155], v[72:75], a[72:75]
M a[76:79], v[152:155], v[76:79], a[76:79]
M a[80:83], v[156:159], v[64:67], a[80:83]
M a[84:87], v[156:159], v[68:71], a[84:87]
M a[88:91], v[156:159], v[72:75], a[88:91]
M a[92:95], v[156:159], v[76:79], a[92:95]
s_nop 7
s_add_u32 s57, s57, 32768
s_sub_u32 s58, s58, 64
s_sub_u32 s59, s59, 1
s_cmp_lg_u32 s59, 0
s_cbranch_scc1 Lslow_2
v_accvgpr_read_b32 v20, a96
v_accvgpr_read_b32 v21, a100
v_accvgpr_read_b32 v22, a104
v_accvgpr_read_b32 v23, a108
v_rcp_f32 v8, v20
v_rcp_f32 v9, v21
v_rcp_f32 v10, v22
v_rcp_f32 v11, v23
s_lshl_b32 s33, s56, 20
s_lshl_b32 s34, s20, 15
s_add_u32 s33, s33, s34
s_lshl_b32 s34, s23, 13
s_add_u32 s36, s33, s34
s_add_u32 s37, s36, 4096
s_add_u32 s38, s36, 16384
s_add_u32 s39, s36, 20480
v_pk_mul_f32 v[160:161], v[160:161], v[8:9] op_sel:[0,0] op_sel_hi:[1,0]
v_pk_mul_f32 v[162:163], v[162:163], v[8:9] op_sel:[0,0] op_sel_hi:[1,0]
v_pk_mul_f32 v[176:177], v[176:177], v[8:9] op_sel:[0,0] op_sel_hi:[1,0]
v_pk_mul_f32 v[178:179], v[178:179], v[8:9] op_sel:[0,0] op_sel_hi:[1,0]
v_cvt_pk_bf16_f32 v160, v160, v161
v_cvt_pk_bf16_f32 v161, v162, v163
v_cvt_pk_bf16_f32 v162, v176, v177
v_cvt_pk_bf16_f32 v163, v178, v179
v_pk_mul_f32 v[164:165], v[164:165], v[8:9] op_sel:[0,1] op_sel_hi:[1,1]
v_pk_mul_f32 v[166:167], v[166:167], v[8:9] op_sel:[0,1] op_sel_hi:[1,1]
v_pk_mul_f32 v[180:181], v[180:181], v[8:9] op_sel:[0,1] op_sel_hi:[1,1]
v_pk_mul_f32 v[182:183], v[182:183], v[8:9] op_sel:[0,1] op_sel_hi:[1,1]
v_cvt_pk_bf16_f32 v164, v164, v165
v_cvt_pk_bf16_f32 v165, v166, v167
v_cvt_pk_bf16_f32 v166, v180, v181
v_cvt_pk_bf16_f32 v167, v182, v183
v_pk_mul_f32 v[168:169], v[168:169], v[10:11] op_sel:[0,0] op_sel_hi:[1,0]
v_pk_mul_f32 v[170:171], v[170:171], v[10:11] op_sel:[0,0] op_sel_hi:[1,0]
v_pk_mul_f32 v[184:185], v[184:185], v[10:11] op_sel:[0,0] op_sel_hi:[1,0]
v_pk_mul_f32 v[186:187], v[186:187], v[10:11] op_sel:[0,0] op_sel_hi:[1,0]
v_cvt_pk_bf16_f32 v168, v168, v169
v_cvt_pk_bf16_f32 v169, v170, v171
v_cvt_pk_bf16_f32 v170, v184, v185
v_cvt_pk_bf16_f32 v171, v186, v187
v_pk_mul_f32 v[172:173], v[172:173], v[10:11] op_sel:[0,1] op_sel_hi:[1,1]
v_pk_mul_f32 v[174:175], v[174:175], v[10:11] op_sel:[0,1] op_sel_hi:[1,1]
v_pk_mul_f32 v[188:189], v[188:189], v[10:11] op_sel:[0,1] op_sel_hi:[1,1]
v_pk_mul_f32 v[190:191], v[190:191], v[10:11] op_sel:[0,1] op_sel_hi:[1,1]
v_cvt_pk_bf16_f32 v172, v172, v173
v_cvt_pk_bf16_f32 v173, v174, v175
v_cvt_pk_bf16_f32 v174, v188, v189
v_cvt_pk_bf16_f32 v175, v190, v191
v_pk_mul_f32 v[192:193], v[192:193], v[8:9] op_sel:[0,0] op_sel_hi:[1,0]
v_pk_mul_f32 v[194:195], v[194:195], v[8:9] op_sel:[0,0] op_sel_hi:[1,0]
v_pk_mul_f32 v[208:209], v[208:209], v[8:9] op_sel:[0,0] op_sel_hi:[1,0]
v_pk_mul_f32 v[210:211], v[210:211], v[8:9] op_sel:[0,0] op_sel_hi:[1,0]
v_cvt_pk_bf16_f32 v192, v192, v193
v_cvt_pk_bf16_f32 v193, v194, v195
v_cvt_pk_bf16_f32 v194, v208, v209
v_cvt_pk_bf16_f32 v195, v210, v211
v_pk_mul_f32 v[196:197], v[196:197], v[8:9] op_sel:[0,1] op_sel_hi:[1,1]
v_pk_mul_f32 v[198:199], v[198:199], v[8:9] op_sel:[0,1] op_sel_hi:[1,1]
v_pk_mul_f32 v[212:213], v[212:213], v[8:9] op_sel:[0,1] op_sel_hi:[1,1]
v_pk_mul_f32 v[214:215], v[214:215], v[8:9] op_sel:[0,1] op_sel_hi:[1,1]
v_cvt_pk_bf16_f32 v196, v196, v197
v_cvt_pk_bf16_f32 v197, v198, v199
v_cvt_pk_bf16_f32 v198, v212, v213
v_cvt_pk_bf16_f32 v199, v214, v215
v_pk_mul_f32 v[200:201], v[200:201], v[10:11] op_sel:[0,0] op_sel_hi:[1,0]
v_pk_mul_f32 v[202:203], v[202:203], v[10:11] op_sel:[0,0] op_sel_hi:[1,0]
v_pk_mul_f32 v[216:217], v[216:217], v[10:11] op_sel:[0,0] op_sel_hi:[1,0]
v_pk_mul_f32 v[218:219], v[218:219], v[10:11] op_sel:[0,0] op_sel_hi:[1,0]
v_cvt_pk_bf16_f32 v200, v200, v201
v_cvt_pk_bf16_f32 v201, v202, v203
v_cvt_pk_bf16_f32 v202, v216, v217
v_cvt_pk_bf16_f32 v203, v218, v219
v_pk_mul_f32 v[204:205], v[204:205], v[10:11] op_sel:[0,1] op_sel_hi:[1,1]
v_pk_mul_f32 v[206:207], v[206:207], v[10:11] op_sel:[0,1] op_sel_hi:[1,1]
v_pk_mul_f32 v[220:221], v[220:221], v[10:11] op_sel:[0,1] op_sel_hi:[1,1]
v_pk_mul_f32 v[222:223], v[222:223], v[10:11] op_sel:[0,1] op_sel_hi:[1,1]
v_cvt_pk_bf16_f32 v204, v204, v205
v_cvt_pk_bf16_f32 v205, v206, v207
v_cvt_pk_bf16_f32 v206, v220, v221
v_cvt_pk_bf16_f32 v207, v222, v223
v_pk_mul_f32 v[224:225], v[224:225], v[8:9] op_sel:[0,0] op_sel_hi:[1,0]
v_pk_mul_f32 v[226:227], v[226:227], v[8:9] op_sel:[0,0] op_sel_hi:[1,0]
v_pk_mul_f32 v[240:241], v[240:241], v[8:9] op_sel:[0,0] op_sel_hi:[1,0]
v_pk_mul_f32 v[242:243], v[242:243], v[8:9] op_sel:[0,0] op_sel_hi:[1,0]
v_cvt_pk_bf16_f32 v224, v224, v225
v_cvt_pk_bf16_f32 v225, v226, v227
v_cvt_pk_bf16_f32 v226, v240, v241
v_cvt_pk_bf16_f32 v227, v242, v243
v_pk_mul_f32 v[228:229], v[228:229], v[8:9] op_sel:[0,1] op_sel_hi:[1,1]
v_pk_mul_f32 v[230:231], v[230:231], v[8:9] op_sel:[0,1] op_sel_hi:[1,1]
v_pk_mul_f32 v[244:245], v[244:245], v[8:9] op_sel:[0,1] op_sel_hi:[1,1]
v_pk_mul_f32 v[246:247], v[246:247], v[8:9] op_sel:[0,1] op_sel_hi:[1,1]
v_cvt_pk_bf16_f32 v228, v228, v229
v_cvt_pk_bf16_f32 v229, v230, v231
v_cvt_pk_bf16_f32 v230, v244, v245
v_cvt_pk_bf16_f32 v231, v246, v247
v_pk_mul_f32 v[232:233], v[232:233], v[10:11] op_sel:[0,0] op_sel_hi:[1,0]
v_pk_mul_f32 v[234:235], v[234:235], v[10:11] op_sel:[0,0] op_sel_hi:[1,0]
v_pk_mul_f32 v[248:249], v[248:249], v[10:11] op_sel:[0,0] op_sel_hi:[1,0]
v_pk_mul_f32 v[250:251], v[250:251], v[10:11] op_sel:[0,0] op_sel_hi:[1,0]
v_cvt_pk_bf16_f32 v232, v232, v233
v_cvt_pk_bf16_f32 v233, v234, v235
v_cvt_pk_bf16_f32 v234, v248, v249
v_cvt_pk_bf16_f32 v235, v250, v251
v_pk_mul_f32 v[236:237], v[236:237], v[10:11] op_sel:[0,1] op_sel_hi:[1,1]
v_pk_mul_f32 v[238:239], v[238:239], v[10:11] op_sel:[0,1] op_sel_hi:[1,1]
v_pk_mul_f32 v[252:253], v[252:253], v[10:11] op_sel:[0,1] op_sel_hi:[1,1]
v_pk_mul_f32 v[254:255], v[254:255], v[10:11] op_sel:[0,1] op_sel_hi:[1,1]
v_cvt_pk_bf16_f32 v236, v236, v237
v_cvt_pk_bf16_f32 v237, v238, v239
v_cvt_pk_bf16_f32 v238, v252, v253
v_cvt_pk_bf16_f32 v239, v254, v255
v_accvgpr_read_b32 v176, a64
v_accvgpr_read_b32 v177, a65
v_accvgpr_read_b32 v178, a66
v_accvgpr_read_b32 v179, a67
v_accvgpr_read_b32 v180, a80
v_accvgpr_read_b32 v181, a81
v_accvgpr_read_b32 v182, a82
v_accvgpr_read_b32 v183, a83
v_pk_mul_f32 v[176:177], v[176:177], v[8:9] op_sel:[0,0] op_sel_hi:[1,0]
v_pk_mul_f32 v[178:179], v[178:179], v[8:9] op_sel:[0,0] op_sel_hi:[1,0]
v_pk_mul_f32 v[180:181], v[180:181], v[8:9] op_sel:[0,0] op_sel_hi:[1,0]
v_pk_mul_f32 v[182:183], v[182:183], v[8:9] op_sel:[0,0] op_sel_hi:[1,0]
v_cvt_pk_bf16_f32 v176, v176, v177
v_cvt_pk_bf16_f32 v177, v178, v179
v_cvt_pk_bf16_f32 v178, v180, v181
v_cvt_pk_bf16_f32 v179, v182, v183
v_accvgpr_read_b32 v184, a68
v_accvgpr_read_b32 v185, a69
v_accvgpr_read_b32 v186, a70
v_accvgpr_read_b32 v187, a71
v_accvgpr_read_b32 v188, a84
v_accvgpr_read_b32 v189, a85
v_accvgpr_read_b32 v190, a86
v_accvgpr_read_b32 v191, a87
v_pk_mul_f32 v[184:185], v[184:185], v[8:9] op_sel:[0,1] op_sel_hi:[1,1]
v_pk_mul_f32 v[186:187], v[186:187], v[8:9] op_sel:[0,1] op_sel_hi:[1,1]
v_pk_mul_f32 v[188:189], v[188:189], v[8:9] op_sel:[0,1] op_sel_hi:[1,1]
v_pk_mul_f32 v[190:191], v[190:191], v[8:9] op_sel:[0,1] op_sel_hi:[1,1]
v_cvt_pk_bf16_f32 v184, v184, v185
v_cvt_pk_bf16_f32 v185, v186, v187
v_cvt_pk_bf16_f32 v186, v188, v189
v_cvt_pk_bf16_f32 v187, v190, v191
v_accvgpr_read_b32 v208, a72
v_accvgpr_read_b32 v209, a73
v_accvgpr_read_b32 v210, a74
v_accvgpr_read_b32 v211, a75
v_accvgpr_read_b32 v212, a88
v_accvgpr_read_b32 v213, a89
v_accvgpr_read_b32 v214, a90
v_accvgpr_read_b32 v215, a91
v_pk_mul_f32 v[208:209], v[208:209], v[10:11] op_sel:[0,0] op_sel_hi:[1,0]
v_pk_mul_f32 v[210:211], v[210:211], v[10:11] op_sel:[0,0] op_sel_hi:[1,0]
v_pk_mul_f32 v[212:213], v[212:213], v[10:11] op_sel:[0,0] op_sel_hi:[1,0]
v_pk_mul_f32 v[214:215], v[214:215], v[10:11] op_sel:[0,0] op_sel_hi:[1,0]
v_cvt_pk_bf16_f32 v208, v208, v209
v_cvt_pk_bf16_f32 v209, v210, v211
v_cvt_pk_bf16_f32 v210, v212, v213
v_cvt_pk_bf16_f32 v211, v214, v215
v_accvgpr_read_b32 v216, a76
v_accvgpr_read_b32 v217, a77
v_accvgpr_read_b32 v218, a78
v_accvgpr_read_b32 v219, a79
v_accvgpr_read_b32 v220, a92
v_accvgpr_read_b32 v221, a93
v_accvgpr_read_b32 v222, a94
v_accvgpr_read_b32 v223, a95
v_pk_mul_f32 v[216:217], v[216:217], v[10:11] op_sel:[0,1] op_sel_hi:[1,1]
v_pk_mul_f32 v[218:219], v[218:219], v[10:11] op_sel:[0,1] op_sel_hi:[1,1]
v_pk_mul_f32 v[220:221], v[220:221], v[10:11] op_sel:[0,1] op_sel_hi:[1,1]
v_pk_mul_f32 v[222:223], v[222:223], v[10:11] op_sel:[0,1] op_sel_hi:[1,1]
v_cvt_pk_bf16_f32 v216, v216, v217
v_cvt_pk_bf16_f32 v217, v218, v219
v_cvt_pk_bf16_f32 v218, v220, v221
v_cvt_pk_bf16_f32 v219, v222, v223
s_bitcmp1_b32 s61, 0
s_cbranch_scc0 Lss_3
buffer_store_dwordx4 v[160:163], v1, s[16:19], s36 offen offset:0 sc1
buffer_store_dwordx4 v[164:167], v1, s[16:19], s36 offen offset:2048 sc1
buffer_store_dwordx4 v[168:171], v1, s[16:19], s37 offen offset:0 sc1
buffer_store_dwordx4 v[172:175], v1, s[16:19], s37 offen offset:2048 sc1
Lss_3:
s_bitcmp1_b32 s61, 1
s_cbranch_scc0 Lss_4
buffer_store_dwordx4 v[192:195], v1, s[16:19], s36 offen offset:1024 sc1
buffer_store_dwordx4 v[196:199], v1, s[16:19], s36 offen offset:3072 sc1
buffer_store_dwordx4 v[200:203], v1, s[16:19], s37 offen offset:1024 sc1
buffer_store_dwordx4 v[204:207], v1, s[16:19], s37 offen offset:3072 sc1
Lss_4:
s_bitcmp1_b32 s61, 2
s_cbranch_scc0 Lss_5
buffer_store_dwordx4 v[224:227], v1, s[16:19], s38 offen offset:0 sc1
buffer_store_dwordx4 v[228:231], v1, s[16:19], s38 offen offset:2048 sc1
buffer_store_dwordx4 v[232:235], v1, s[16:19], s39 offen offset:0 sc1
buffer_store_dwordx4 v[236:239], v1, s[16:19], s39 offen offset:2048 sc1
Lss_5:
s_bitcmp1_b32 s61, 3
s_cbranch_scc0 Lss_6
buffer_store_dwordx4 v[176:179], v1, s[16:19], s38 offen offset:1024 sc1
buffer_store_dwordx4 v[184:187], v1, s[16:19], s38 offen offset:3072 sc1
buffer_store_dwordx4 v[208:211], v1, s[16:19], s39 offen offset:1024 sc1
buffer_store_dwordx4 v[216:219], v1, s[16:19], s39 offen offset:3072 sc1
Lss_6:
s_branch Lk2_chk
Lk2_done:
s_lshl_b32 s33, s20, 4
s_add_u32 s33, s33, 16781312
s_sub_u32 s34, 15, s21
s_lshl_b32 s34, s34, 9
s_add_u32 s92, s33, s34
s_lshl_b32 s34, s22, 2
s_add_u32 s92, s92, s34
s_lshl_b32 s34, s21, 9
s_add_u32 s93, s33, s34
s_lshl_b32 s34, s23, 3
s_add_u32 s93, s93, s34
s_cmp_eq_u32 s24, 0
s_cselect_b32 s93, s93, s92
s_cselect_b32 s94, 4, 0
s_add_u32 s94, s94, s93
s_load_dwordx2 s[10:11], s[0:1], 40
s_load_dwordx2 s[14:15], s[0:1], 72
s_lshl_b32 s21, s27, 7
s_lshl_b32 s22, s28, 6
s_lshl_b32 s3, s101, 4
v_lshrrev_b32 v232, 3, v0
v_and_b32 v233, 6, v232
v_and_b32 v234, 7, v0
v_xor_b32 v233, v233, v234
v_add_u32 v232, s3, v232
v_lshlrev_b32 v232, 11, v232
v_lshl_add_u32 v6, v233, 4, v232
v_add_u32 v7, 15360, v6
s_add_u32 m0, s42, 49152
s_nop 0
buffer_load_dwordx4 v6, s[48:51], s26 offen offset:0 lds
buffer_load_dwordx4 v7, s[48:51], s26 offen offset:1024 lds
buffer_load_dwordx4 a[96:99], v1, s[44:47], s25 offen offset:0 sc1
buffer_load_dwordx4 a[100:103], v1, s[44:47], s25 offen offset:1024 sc1
buffer_load_dwordx4 a[104:107], v1, s[44:47], s25 offen offset:2048 sc1
buffer_load_dwordx4 a[108:111], v1, s[44:47], s25 offen offset:3072 sc1
s_add_u32 s25, s25, 16384
s_add_u32 s26, s26, 131072
s_add_u32 m0, s42, 65536
s_nop 0
buffer_load_dwordx4 v6, s[48:51], s26 offen offset:0 lds
buffer_load_dwordx4 v7, s[48:51], s26 offen offset:1024 lds
buffer_load_dwordx4 a[128:131], v1, s[44:47], s25 offen offset:0 sc1
buffer_load_dwordx4 a[132:135], v1, s[44:47], s25 offen offset:1024 sc1
buffer_load_dwordx4 a[136:139], v1, s[44:47], s25 offen offset:2048 sc1
buffer_load_dwordx4 a[140:143], v1, s[44:47], s25 offen offset:3072 sc1
s_add_u32 s25, s25, 16384
s_add_u32 s26, s26, 131072
v_lshrrev_b32 v232, 2, v0
v_and_b32 v234, 1, v0
v_bfe_u32 v237, v0, 1, 1
v_lshlrev_b32 v233, 7, v232
v_lshl_add_u32 v233, v234, 3, v233
v_and_b32 v236, 6, v232
v_add_u32 v235, 0, v237
v_xor_b32 v235, v235, v236
v_lshl_add_u32 v24, v235, 4, v233
v_add_u32 v28, 0x10000, v24
v_add_u32 v235, 2, v237
v_xor_b32 v235, v235, v236
v_lshl_add_u32 v25, v235, 4, v233
v_add_u32 v29, 0x10000, v25
v_add_u32 v235, 4, v237
v_xor_b32 v235, v235, v236
v_lshl_add_u32 v26, v235, 4, v233
v_add_u32 v30, 0x10000, v26
v_add_u32 v235, 6, v237
v_xor_b32 v235, v235, v236
v_lshl_add_u32 v27, v235, 4, v233
v_add_u32 v31, 0x10000, v27
s_waitcnt vmcnt(26)
s_barrier
ds_read_b64_tr_b16 a[32:33], v24 offset:16384
ds_read_b64_tr_b16 a[34:35], v24 offset:18432
ds_read_b64_tr_b16 a[36:37], v24 offset:20480
ds_read_b64_tr_b16 a[38:39], v24 offset:22528
ds_read_b64_tr_b16 a[40:41], v25 offset:16384
ds_read_b64_tr_b16 a[42:43], v25 offset:18432
ds_read_b64_tr_b16 a[44:45], v25 offset:20480
ds_read_b64_tr_b16 a[46:47], v25 offset:22528
ds_read_b64_tr_b16 a[48:49], v26 offset:16384
ds_read_b64_tr_b16 a[50:51], v26 offset:18432
ds_read_b64_tr_b16 a[52:53], v26 offset:20480
ds_read_b64_tr_b16 a[54:55], v26 offset:22528
ds_read_b64_tr_b16 a[56:57], v27 offset:16384
ds_read_b64_tr_b16 a[58:59], v27 offset:18432
ds_read_b64_tr_b16 a[60:61], v27 offset:20480
ds_read_b64_tr_b16 a[62:63], v27 offset:22528
s_and_b32 s40, s2, 3
s_bfe_u32 s36, s2, 0x30003
s_lshl_b32 s29, s36, 8
s_bfe_u32 s3, s2, 0x10002
s_lshl_b32 s3, s3, 2
s_lshr_b32 s37, s2, 6
s_add_u32 s3, s3, s37
s_lshl_b32 s13, s3, 8
s_lshl_b32 s30, s3, 7
s_lshl_b32 s3, s40, 5
s_add_u32 s30, s30, s3
s_lshl_b32 s41, s101, 12
s_lshl_b32 s12, s36, 21
s_lshr_b32 s3, s101, 1
s_lshl_b32 s3, s3, 20
s_add_u32 s12, s12, s3
s_and_b32 s3, s101, 1
s_lshl_b32 s3, s3, 13
s_add_u32 s12, s12, s3
s_lshl_b32 s62, s36, 10
s_lshl_b32 s3, s40, 7
s_add_u32 s62, s62, s3
s_add_u32 s62, s62, 16781312
s_bfe_u32 s3, s2, 0x10002
s_lshl_b32 s3, s3, 3
s_sub_u32 s39, 16, s3
s_lshl_b32 s38, s40, 4
s_add_u32 s3, s3, s38
s_lshl_b32 s3, s3, 14
s_add_u32 s12, s12, s3
s_lshl_b32 s3, s3, 3
s_add_u32 s13, s13, s3
s_mov_b32 s64, 4294721536
s_mov_b32 s65, 16384
s_add_u32 s8, s4, 67108864
s_addc_u32 s9, s5, 0
s_lshl_b32 s56, s2, 16
s_lshl_b32 s38, s101, 14
s_add_u32 s56, s56, s38
s_lshl_b32 s58, s2, 4
s_lshl_b32 s38, s101, 2
s_add_u32 s58, s58, s38
s_add_u32 s58, s58, 16777216
s_and_b32 s59, s58, 0xffffffcf
s_mov_b32 s61, 0
s_lshl_b32 s3, s101, 4
v_lshrrev_b32 v240, 4, v0
v_and_b32 v242, 15, v0
v_add_u32 v241, 0, v240
v_lshlrev_b32 v241, 1, v241
v_xor_b32 v241, v241, v242
v_add_u32 v243, s3, v240
v_lshlrev_b32 v243, 11, v243
v_lshl_add_u32 v243, v241, 4, v243
v_add_u32 v2, 0, v243
v_add_u32 v241, 4, v240
v_lshlrev_b32 v241, 1, v241
v_xor_b32 v241, v241, v242
v_add_u32 v243, s3, v240
v_lshlrev_b32 v243, 11, v243
v_lshl_add_u32 v243, v241, 4, v243
v_add_u32 v3, 7168, v243
v_add_u32 v241, 0, v240
v_lshlrev_b32 v241, 1, v241
v_xor_b32 v241, v241, v242
v_add_u32 v243, s3, v240
v_lshlrev_b32 v243, 11, v243
v_lshl_add_u32 v243, v241, 4, v243
v_add_u32 v4, 14336, v243
v_add_u32 v241, 4, v240
v_lshlrev_b32 v241, 1, v241
v_xor_b32 v241, v241, v242
v_add_u32 v243, s3, v240
v_lshlrev_b32 v243, 11, v243
v_lshl_add_u32 v243, v241, 4, v243
v_add_u32 v5, 21504, v243
v_lshlrev_b32 v233, 8, v232
v_lshl_add_u32 v233, v234, 3, v233
v_and_b32 v236, 7, v232
v_lshlrev_b32 v236, 1, v236
s_lshl_b32 s38, s40, 2
v_xor_b32 v236, s38, v236
v_add_u32 v235, 0, v237
v_xor_b32 v235, v235, v236
v_lshl_add_u32 v8, v235, 4, v233
v_add_u32 v16, 0x10000, v8
v_add_u32 v235, 2, v237
v_xor_b32 v235, v235, v236
v_lshl_add_u32 v9, v235, 4, v233
v_add_u32 v17, 0x10000, v9
v_add_u32 v235, 4, v237
v_xor_b32 v235, v235, v236
v_lshl_add_u32 v10, v235, 4, v233
v_add_u32 v18, 0x10000, v10
v_add_u32 v235, 6, v237
v_xor_b32 v235, v235, v236
v_lshl_add_u32 v11, v235, 4, v233
v_add_u32 v19, 0x10000, v11
v_add_u32 v235, 8, v237
v_xor_b32 v235, v235, v236
v_lshl_add_u32 v12, v235, 4, v233
v_add_u32 v20, 0x10000, v12
v_add_u32 v235, 10, v237
v_xor_b32 v235, v235, v236
v_lshl_add_u32 v13, v235, 4, v233
v_add_u32 v21, 0x10000, v13
v_add_u32 v235, 12, v237
v_xor_b32 v235, v235, v236
v_lshl_add_u32 v14, v235, 4, v233
v_add_u32 v22, 0x10000, v14
v_add_u32 v235, 14, v237
v_xor_b32 v235, v235, v236
v_lshl_add_u32 v15, v235, 4, v233
v_add_u32 v23, 0x10000, v15
v_mov_b32 v253, 0
v_mov_b32 v254, 1
v_and_b32 v255, 31, v0
v_lshlrev_b32 v255, 2, v255
v_lshrrev_b32 v252, 5, v0
v_lshl_add_u32 v255, v252, 9, v255
s_waitcnt lgkmcnt(0)
s_mov_b32 s16, s14
s_mov_b32 s17, s15
s_mov_b32 s18, 8388608
s_mov_b32 s19, 0x00020000
s_waitcnt vmcnt(20) lgkmcnt(0)
s_barrier
s_waitcnt vmcnt(12)
s_mov_b64 exec, 1
buffer_store_dword v254, v253, s[52:55], s92 offen sc1
buffer_store_dword v254, v253, s[52:55], s93 offen sc1
buffer_store_dword v254, v253, s[52:55], s94 offen sc1
s_mov_b64 exec, -1
M a[0:3], a[32:35], a[192:195], 0
s_add_u32 m0, s42, 81920
s_nop 0
buffer_load_dwordx4 v6, s[48:51], s26 offen offset:0 lds
ds_read_b64_tr_b16 v[160:161], v24 offset:32768
ds_read_b64_tr_b16 v[162:163], v24 offset:34816
M a[0:3], a[36:39], a[196:199], a[0:3]
buffer_load_dwordx4 v7, s[48:51], s26 offen offset:1024 lds
M a[4:7], a[44:47], a[196:199], 0
ds_read_b64_tr_b16 v[164:165], v24 offset:36864
ds_read_b64_tr_b16 v[166:167], v24 offset:38912
M a[4:7], a[40:43], a[192:195], a[4:7]
buffer_load_dwordx4 a[160:163], v1, s[44:47], s25 offen offset:0 sc1
M a[8:11], a[48:51], a[192:195], 0
ds_read_b64_tr_b16 v[168:169], v25 offset:32768
ds_read_b64_tr_b16 v[170:171], v25 offset:34816
M a[8:11], a[52:55], a[196:199], a[8:11]
buffer_load_dwordx4 a[164:167], v1, s[44:47], s25 offen offset:1024 sc1
M a[12:15], a[60:63], a[196:199], 0
ds_read_b64_tr_b16 v[172:173], v25 offset:36864
ds_read_b64_tr_b16 v[174:175], v25 offset:38912
M a[12:15], a[56:59], a[192:195], a[12:15]
buffer_load_dwordx4 a[168:171], v1, s[44:47], s25 offen offset:2048 sc1
M a[16:19], a[32:35], a[200:203], 0
ds_read_b64_tr_b16 v[176:177], v26 offset:32768
ds_read_b64_tr_b16 v[178:179], v26 offset:34816
M a[16:19], a[36:39], a[204:207], a[16:19]
buffer_load_dwordx4 a[172:175], v1, s[44:47], s25 offen offset:3072 sc1
M a[20:23], a[44:47], a[204:207], 0
ds_read_b64_tr_b16 v[180:181], v26 offset:36864
ds_read_b64_tr_b16 v[182:183], v26 offset:38912
M a[20:23], a[40:43], a[200:203], a[20:23]
s_add_u32 s25, s25, 16384
s_add_u32 s26, s26, 131072
M a[24:27], a[48:51], a[200:203], 0
ds_read_b64_tr_b16 v[184:185], v27 offset:32768
ds_read_b64_tr_b16 v[186:187], v27 offset:34816
M a[24:27], a[52:55], a[204:207], a[24:27]
ds_read_b64_tr_b16 v[188:189], v27 offset:36864
ds_read_b64_tr_b16 v[190:191], v27 offset:38912
M a[28:31], a[60:63], a[204:207], 0
M a[28:31], a[56:59], a[200:203], a[28:31]
s_waitcnt vmcnt(15) lgkmcnt(0)
s_barrier
M a[0:3], v[160:163], a[224:227], a[0:3]
s_add_u32 m0, s42, 98304
s_nop 0
buffer_load_dwordx4 v6, s[48:51], s26 offen offset:0 lds
ds_read_b64_tr_b16 a[32:33], v24 offset:49152
ds_read_b64_tr_b16 a[34:35], v24 offset:51200
M a[0:3], v[164:167], a[228:231], a[0:3]
buffer_load_dwordx4 v7, s[48:51], s26 offen offset:1024 lds
M a[4:7], v[172:175], a[228:231], a[4:7]
ds_read_b64_tr_b16 a[36:37], v24 offset:53248
ds_read_b64_tr_b16 a[38:39], v24 offset:55296
M a[4:7], v[168:171], a[224:227], a[4:7]
buffer_load_dwordx4 a[192:195], v1, s[44:47], s25 offen offset:0 sc1
M a[8:11], v[176:179], a[224:227], a[8:11]
ds_read_b64_tr_b16 a[40:41], v25 offset:49152
ds_read_b64_tr_b16 a[42:43], v25 offset:51200
M a[8:11], v[180:183], a[228:231], a[8:11]
buffer_load_dwordx4 a[196:199], v1, s[44:47], s25 offen offset:1024 sc1
M a[12:15], v[188:191], a[228:231], a[12:15]
ds_read_b64_tr_b16 a[44:45], v25 offset:53248
ds_read_b64_tr_b16 a[46:47], v25 offset:55296
M a[12:15], v[184:187], a[224:227], a[12:15]
buffer_load_dwordx4 a[200:203], v1, s[44:47], s25 offen offset:2048 sc1
M a[16:19], v[160:163], a[232:235], a[16:19]
ds_read_b64_tr_b16 a[48:49], v26 offset:49152
ds_read_b64_tr_b16 a[50:51], v26 offset:51200
M a[16:19], v[164:167], a[236:239], a[16:19]
buffer_load_dwordx4 a[204:207], v1, s[44:47], s25 offen offset:3072 sc1
M a[20:23], v[172:175], a[236:239], a[20:23]
ds_read_b64_tr_b16 a[52:53], v26 offset:53248
ds_read_b64_tr_b16 a[54:55], v26 offset:55296
M a[20:23], v[168:171], a[232:235], a[20:23]
s_add_u32 s25, s25, 16384
s_add_u32 s26, s26, 131072
M a[24:27], v[176:179], a[232:235], a[24:27]
ds_read_b64_tr_b16 a[56:57], v27 offset:49152
ds_read_b64_tr_b16 a[58:59], v27 offset:51200
M a[24:27], v[180:183], a[236:239], a[24:27]
ds_read_b64_tr_b16 a[60:61], v27 offset:53248
ds_read_b64_tr_b16 a[62:63], v27 offset:55296
M a[28:31], v[188:191], a[236:239], a[28:31]
M a[28:31], v[184:187], a[232:235], a[28:31]
s_waitcnt vmcnt(15) lgkmcnt(0)
s_barrier
M a[0:3], a[32:35], a[96:99], a[0:3]
s_add_u32 m0, s42, 114688
s_nop 0
buffer_load_dwordx4 v6, s[48:51], s26 offen offset:0 lds
ds_read_b64_tr_b16 v[160:161], v28 offset:0
ds_read_b64_tr_b16 v[162:163], v28 offset:2048
M a[0:3], a[36:39], a[100:103], a[0:3]
buffer_load_dwordx4 v7, s[48:51], s26 offen offset:1024 lds
M a[4:7], a[44:47], a[100:103], a[4:7]
ds_read_b64_tr_b16 v[164:165], v28 offset:4096
ds_read_b64_tr_b16 v[166:167], v28 offset:6144
M a[4:7], a[40:43], a[96:99], a[4:7]
buffer_load_dwordx4 a[224:227], v1, s[44:47], s25 offen offset:0 sc1
M a[8:11], a[48:51], a[96:99], a[8:11]
ds_read_b64_tr_b16 v[168:169], v29 offset:0
ds_read_b64_tr_b16 v[170:171], v29 offset:2048
M a[8:11], a[52:55], a[100:103], a[8:11]
buffer_load_dwordx4 a[228:231], v1, s[44:47], s25 offen offset:1024 sc1
M a[12:15], a[60:63], a[100:103], a[12:15]
ds_read_b64_tr_b16 v[172:173], v29 offset:4096
ds_read_b64_tr_b16 v[174:175], v29 offset:6144
M a[12:15], a[56:59], a[96:99], a[12:15]
buffer_load_dwordx4 a[232:235], v1, s[44:47], s25 offen offset:2048 sc1
ds_read_b64_tr_b16 v[176:177], v30 offset:0
ds_read_b64_tr_b16 v[178:179], v30 offset:2048
M a[16:19], a[32:35], a[104:107], a[16:19]
buffer_load_dwordx4 a[236:239], v1, s[44:47], s25 offen offset:3072 sc1
M a[16:19], a[36:39], a[108:111], a[16:19]
ds_read_b64_tr_b16 v[180:181], v30 offset:4096
ds_read_b64_tr_b16 v[182:183], v30 offset:6144
M a[20:23], a[44:47], a[108:111], a[20:23]
s_add_u32 s25, s25, 16384
s_add_u32 s26, s26, 131072
M a[20:23], a[40:43], a[104:107], a[20:23]
ds_read_b64_tr_b16 v[184:185], v31 offset:0
ds_read_b64_tr_b16 v[186:187], v31 offset:2048
M a[24:27], a[48:51], a[104:107], a[24:27]
buffer_load_dword v252, v255, s[52:55], s62 offen sc1
M a[24:27], a[52:55], a[108:111], a[24:27]
ds_read_b64_tr_b16 v[188:189], v31 offset:4096
ds_read_b64_tr_b16 v[190:191], v31 offset:6144
M a[28:31], a[60:63], a[108:111], a[28:31]
M a[28:31], a[56:59], a[104:107], a[28:31]
s_waitcnt vmcnt(13) lgkmcnt(0)
s_barrier
s_waitcnt vmcnt(0)
v_cmp_ne_u32 vcc, 1, v252
s_nop 0
s_cbranch_vccnz Lk3_spinft
Lk3_gotft:
M a[0:3], v[160:163], a[128:131], a[0:3]
s_mov_b32 s32, s25
s_mov_b32 s33, s26
s_mov_b64 s[34:35], s[44:45]
s_mov_b64 s[36:37], s[48:49]
s_mov_b64 s[44:45], s[8:9]
s_mov_b32 s46, 16777216
s_mov_b64 s[48:49], s[10:11]
s_mov_b32 s50, 8388608
s_mov_b32 s25, s12
s_mov_b32 s26, s13
s_add_u32 m0, s41, 0
s_nop 0
buffer_load_dwordx4 v2, s[48:51], s26 offen offset:0 lds
ds_read_b64_tr_b16 a[32:33], v28 offset:16384
ds_read_b64_tr_b16 a[34:35], v28 offset:18432
M a[0:3], v[164:167], a[132:135], a[0:3]
buffer_load_dwordx4 v3, s[48:51], s26 offen offset:1024 lds
ds_read_b64_tr_b16 a[36:37], v28 offset:20480
ds_read_b64_tr_b16 a[38:39], v28 offset:22528
M a[4:7], v[172:175], a[132:135], a[4:7]
buffer_load_dwordx4 v4, s[48:51], s26 offen offset:2048 lds
M a[4:7], v[168:171], a[128:131], a[4:7]
ds_read_b64_tr_b16 a[40:41], v29 offset:16384
ds_read_b64_tr_b16 a[42:43], v29 offset:18432
buffer_load_dwordx4 v5, s[48:51], s26 offen offset:3072 lds
M a[8:11], v[176:179], a[128:131], a[8:11]
ds_read_b64_tr_b16 a[44:45], v29 offset:20480
ds_read_b64_tr_b16 a[46:47], v29 offset:22528
M a[8:11], v[180:183], a[132:135], a[8:11]
buffer_load_dwordx4 a[96:99], v1, s[44:47], s25 offen offset:0 sc1
ds_read_b64_tr_b16 a[48:49], v30 offset:16384
ds_read_b64_tr_b16 a[50:51], v30 offset:18432
M a[12:15], v[188:191], a[132:135], a[12:15]
buffer_load_dwordx4 a[100:103], v1, s[44:47], s25 offen offset:1024 sc1
M a[12:15], v[184:187], a[128:131], a[12:15]
ds_read_b64_tr_b16 a[52:53], v30 offset:20480
ds_read_b64_tr_b16 a[54:55], v30 offset:22528
buffer_load_dwordx4 a[104:107], v1, s[44:47], s25 offen offset:2048 sc1
M a[16:19], v[160:163], a[136:139], a[16:19]
ds_read_b64_tr_b16 a[56:57], v31 offset:16384
ds_read_b64_tr_b16 a[58:59], v31 offset:18432
buffer_load_dwordx4 a[108:111], v1, s[44:47], s25 offen offset:3072 sc1
M a[16:19], v[164:167], a[140:143], a[16:19]
ds_read_b64_tr_b16 a[60:61], v31 offset:20480
ds_read_b64_tr_b16 a[62:63], v31 offset:22528
M a[20:23], v[172:175], a[140:143], a[20:23]
s_add_u32 s63, s25, 4096
buffer_load_dwordx4 a[112:115], v1, s[44:47], s63 offen offset:0 sc1
buffer_load_dwordx4 a[116:119], v1, s[44:47], s63 offen offset:1024 sc1
M a[20:23], v[168:171], a[136:139], a[20:23]
buffer_load_dwordx4 a[120:123], v1, s[44:47], s63 offen offset:2048 sc1
M a[24:27], v[176:179], a[136:139], a[24:27]
buffer_load_dwordx4 a[124:127], v1, s[44:47], s63 offen offset:3072 sc1
s_sub_u32 s39, s39, 1
s_cmp_eq_u32 s39, 0
s_cselect_b32 s3, s64, s65
M a[24:27], v[180:183], a[140:143], a[24:27]
s_add_u32 s25, s25, s3
s_lshl_b32 s3, s3, 3
s_add_u32 s26, s26, s3
M a[28:31], v[188:191], a[140:143], a[28:31]
M a[28:31], v[184:187], a[136:139], a[28:31]
s_waitcnt vmcnt(19) lgkmcnt(0)
s_barrier
M a[0:3], a[32:35], a[160:163], a[0:3]
s_add_u32 m0, s41, 16384
s_nop 0
buffer_load_dwordx4 v2, s[48:51], s26 offen offset:0 lds
ds_read_b64_tr_b16 v[160:161], v28 offset:32768
ds_read_b64_tr_b16 v[162:163], v28 offset:34816
M a[0:3], a[36:39], a[164:167], a[0:3]
buffer_load_dwordx4 v3, s[48:51], s26 offen offset:1024 lds
ds_read_b64_tr_b16 v[164:165], v28 offset:36864
ds_read_b64_tr_b16 v[166:167], v28 offset:38912
M a[4:7], a[44:47], a[164:167], a[4:7]
buffer_load_dwordx4 v4, s[48:51], s26 offen offset:2048 lds
M a[4:7], a[40:43], a[160:163], a[4:7]
ds_read_b64_tr_b16 v[168:169], v29 offset:32768
ds_read_b64_tr_b16 v[170:171], v29 offset:34816
buffer_load_dwordx4 v5, s[48:51], s26 offen offset:3072 lds
M a[8:11], a[48:51], a[160:163], a[8:11]
ds_read_b64_tr_b16 v[172:173], v29 offset:36864
ds_read_b64_tr_b16 v[174:175], v29 offset:38912
M a[8:11], a[52:55], a[164:167], a[8:11]
buffer_load_dwordx4 a[128:131], v1, s[44:47], s25 offen offset:0 sc1
ds_read_b64_tr_b16 v[176:177], v30 offset:32768
ds_read_b64_tr_b16 v[178:179], v30 offset:34816
M a[12:15], a[60:63], a[164:167], a[12:15]
buffer_load_dwordx4 a[132:135], v1, s[44:47], s25 offen offset:1024 sc1
M a[12:15], a[56:59], a[160:163], a[12:15]
ds_read_b64_tr_b16 v[180:181], v30 offset:36864
ds_read_b64_tr_b16 v[182:183], v30 offset:38912
buffer_load_dwordx4 a[136:139], v1, s[44:47], s25 offen offset:2048 sc1
M a[16:19], a[32:35], a[168:171], a[16:19]
ds_read_b64_tr_b16 v[184:185], v31 offset:32768
ds_read_b64_tr_b16 v[186:187], v31 offset:34816
buffer_load_dwordx4 a[140:143], v1, s[44:47], s25 offen offset:3072 sc1
M a[16:19], a[36:39], a[172:175], a[16:19]
ds_read_b64_tr_b16 v[188:189], v31 offset:36864
ds_read_b64_tr_b16 v[190:191], v31 offset:38912
M a[20:23], a[44:47], a[172:175], a[20:23]
s_add_u32 s63, s25, 4096
buffer_load_dwordx4 a[144:147], v1, s[44:47], s63 offen offset:0 sc1
buffer_load_dwordx4 a[148:151], v1, s[44:47], s63 offen offset:1024 sc1
M a[20:23], a[40:43], a[168:171], a[20:23]
buffer_load_dwordx4 a[152:155], v1, s[44:47], s63 offen offset:2048 sc1
M a[24:27], a[48:51], a[168:171], a[24:27]
buffer_load_dwordx4 a[156:159], v1, s[44:47], s63 offen offset:3072 sc1
s_sub_u32 s39, s39, 1
s_cmp_eq_u32 s39, 0
s_cselect_b32 s3, s64, s65
M a[24:27], a[52:55], a[172:175], a[24:27]
s_add_u32 s25, s25, s3
s_lshl_b32 s3, s3, 3
s_add_u32 s26, s26, s3
M a[28:31], a[60:63], a[172:175], a[28:31]
M a[28:31], a[56:59], a[168:171], a[28:31]
s_waitcnt vmcnt(25) lgkmcnt(0)
s_barrier
M a[0:3], v[160:163], a[192:195], a[0:3]
s_add_u32 m0, s41, 32768
s_nop 0
buffer_load_dwordx4 v2, s[48:51], s26 offen offset:0 lds
ds_read_b64_tr_b16 a[32:33], v28 offset:49152
ds_read_b64_tr_b16 a[34:35], v28 offset:51200
M a[0:3], v[164:167], a[196:199], a[0:3]
buffer_load_dwordx4 v3, s[48:51], s26 offen offset:1024 lds
ds_read_b64_tr_b16 a[36:37], v28 offset:53248
ds_read_b64_tr_b16 a[38:39], v28 offset:55296
M a[4:7], v[172:175], a[196:199], a[4:7]
buffer_load_dwordx4 v4, s[48:51], s26 offen offset:2048 lds
M a[4:7], v[168:171], a[192:195], a[4:7]
ds_read_b64_tr_b16 a[40:41], v29 offset:49152
ds_read_b64_tr_b16 a[42:43], v29 offset:51200
buffer_load_dwordx4 v5, s[48:51], s26 offen offset:3072 lds
M a[8:11], v[176:179], a[192:195], a[8:11]
ds_read_b64_tr_b16 a[44:45], v29 offset:53248
ds_read_b64_tr_b16 a[46:47], v29 offset:55296
M a[8:11], v[180:183], a[196:199], a[8:11]
buffer_load_dwordx4 a[160:163], v1, s[44:47], s25 offen offset:0 sc1
ds_read_b64_tr_b16 a[48:49], v30 offset:49152
ds_read_b64_tr_b16 a[50:51], v30 offset:51200
M a[12:15], v[188:191], a[196:199], a[12:15]
buffer_load_dwordx4 a[164:167], v1, s[44:47], s25 offen offset:1024 sc1
M a[12:15], v[184:187], a[192:195], a[12:15]
ds_read_b64_tr_b16 a[52:53], v30 offset:53248
ds_read_b64_tr_b16 a[54:55], v30 offset:55296
buffer_load_dwordx4 a[168:171], v1, s[44:47], s25 offen offset:2048 sc1
M a[16:19], v[160:163], a[200:203], a[16:19]
ds_read_b64_tr_b16 a[56:57], v31 offset:49152
ds_read_b64_tr_b16 a[58:59], v31 offset:51200
buffer_load_dwordx4 a[172:175], v1, s[44:47], s25 offen offset:3072 sc1
M a[16:19], v[164:167], a[204:207], a[16:19]
ds_read_b64_tr_b16 a[60:61], v31 offset:53248
ds_read_b64_tr_b16 a[62:63], v31 offset:55296
M a[20:23], v[172:175], a[204:207], a[20:23]
s_add_u32 s63, s25, 4096
buffer_load_dwordx4 a[176:179], v1, s[44:47], s63 offen offset:0 sc1
buffer_load_dwordx4 a[180:183], v1, s[44:47], s63 offen offset:1024 sc1
M a[20:23], v[168:171], a[200:203], a[20:23]
buffer_load_dwordx4 a[184:187], v1, s[44:47], s63 offen offset:2048 sc1
M a[24:27], v[176:179], a[200:203], a[24:27]
buffer_load_dwordx4 a[188:191], v1, s[44:47], s63 offen offset:3072 sc1
s_sub_u32 s39, s39, 1
s_cmp_eq_u32 s39, 0
s_cselect_b32 s3, s64, s65
M a[24:27], v[180:183], a[204:207], a[24:27]
s_add_u32 s25, s25, s3
s_lshl_b32 s3, s3, 3
s_add_u32 s26, s26, s3
M a[28:31], v[188:191], a[204:207], a[28:31]
M a[28:31], v[184:187], a[200:203], a[28:31]
s_waitcnt vmcnt(24) lgkmcnt(0)
s_barrier
M a[0:3], a[32:35], a[224:227], a[0:3]
s_add_u32 m0, s41, 49152
s_nop 0
buffer_load_dwordx4 v2, s[48:51], s26 offen offset:0 lds
ds_read_b64_tr_b16 v[160:161], v8 offset:0
ds_read_b64_tr_b16 v[162:163], v8 offset:4096
buffer_load_dwordx4 v3, s[48:51], s26 offen offset:1024 lds
M a[0:3], a[36:39], a[228:231], a[0:3]
ds_read_b64_tr_b16 v[164:165], v8 offset:8192
ds_read_b64_tr_b16 v[166:167], v8 offset:12288
buffer_load_dwordx4 v4, s[48:51], s26 offen offset:2048 lds
M a[4:7], a[44:47], a[228:231], a[4:7]
ds_read_b64_tr_b16 v[168:169], v9 offset:0
ds_read_b64_tr_b16 v[170:171], v9 offset:4096
buffer_load_dwordx4 v5, s[48:51], s26 offen offset:3072 lds
M a[4:7], a[40:43], a[224:227], a[4:7]
ds_read_b64_tr_b16 v[172:173], v9 offset:8192
ds_read_b64_tr_b16 v[174:175], v9 offset:12288
buffer_load_dwordx4 a[192:195], v1, s[44:47], s25 offen offset:0 sc1
M a[8:11], a[48:51], a[224:227], a[8:11]
ds_read_b64_tr_b16 v[176:177], v10 offset:0
ds_read_b64_tr_b16 v[178:179], v10 offset:4096
buffer_load_dwordx4 a[196:199], v1, s[44:47], s25 offen offset:1024 sc1
M a[8:11], a[52:55], a[228:231], a[8:11]
ds_read_b64_tr_b16 v[180:181], v10 offset:8192
ds_read_b64_tr_b16 v[182:183], v10 offset:12288
buffer_load_dwordx4 a[200:203], v1, s[44:47], s25 offen offset:2048 sc1
M a[12:15], a[60:63], a[228:231], a[12:15]
ds_read_b64_tr_b16 v[184:185], v11 offset:0
ds_read_b64_tr_b16 v[186:187], v11 offset:4096
buffer_load_dwordx4 a[204:207], v1, s[44:47], s25 offen offset:3072 sc1
M a[12:15], a[56:59], a[224:227], a[12:15]
ds_read_b64_tr_b16 v[188:189], v11 offset:8192
ds_read_b64_tr_b16 v[190:191], v11 offset:12288
s_add_u32 s63, s25, 4096
buffer_load_dwordx4 a[208:211], v1, s[44:47], s63 offen offset:0 sc1
ds_read_b64_tr_b16 v[192:193], v12 offset:0
ds_read_b64_tr_b16 v[194:195], v12 offset:4096
M a[16:19], a[32:35], a[232:235], a[16:19]
buffer_load_dwordx4 a[212:215], v1, s[44:47], s63 offen offset:1024 sc1
ds_read_b64_tr_b16 v[196:197], v12 offset:8192
ds_read_b64_tr_b16 v[198:199], v12 offset:12288
M a[16:19], a[36:39], a[236:239], a[16:19]
buffer_load_dwordx4 a[216:219], v1, s[44:47], s63 offen offset:2048 sc1
ds_read_b64_tr_b16 v[200:201], v13 offset:0
ds_read_b64_tr_b16 v[202:203], v13 offset:4096
M a[20:23], a[44:47], a[236:239], a[20:23]
buffer_load_dwordx4 a[220:223], v1, s[44:47], s63 offen offset:3072 sc1
ds_read_b64_tr_b16 v[204:205], v13 offset:8192
ds_read_b64_tr_b16 v[206:207], v13 offset:12288
M a[20:23], a[40:43], a[232:235], a[20:23]
s_sub_u32 s39, s39, 1
s_cmp_eq_u32 s39, 0
s_cselect_b32 s3, s64, s65
ds_read_b64_tr_b16 v[208:209], v14 offset:0
ds_read_b64_tr_b16 v[210:211], v14 offset:4096
M a[24:27], a[48:51], a[232:235], a[24:27]
s_add_u32 s25, s25, s3
s_lshl_b32 s3, s3, 3
s_add_u32 s26, s26, s3
ds_read_b64_tr_b16 v[212:213], v14 offset:8192
ds_read_b64_tr_b16 v[214:215], v14 offset:12288
M a[24:27], a[52:55], a[236:239], a[24:27]
ds_read_b64_tr_b16 v[216:217], v15 offset:0
ds_read_b64_tr_b16 v[218:219], v15 offset:4096
ds_read_b64_tr_b16 v[220:221], v15 offset:8192
ds_read_b64_tr_b16 v[222:223], v15 offset:12288
M a[28:31], a[60:63], a[236:239], a[28:31]
M a[28:31], a[56:59], a[232:235], a[28:31]
s_waitcnt vmcnt(24) lgkmcnt(0)
s_barrier
M v[32:35], v[160:163], a[96:99], 0
s_add_u32 m0, s41, 65536
s_nop 0
buffer_load_dwordx4 v2, s[48:51], s26 offen offset:0 lds
M v[32:35], v[164:167], a[100:103], v[32:35]
M v[36:39], v[172:175], a[100:103], 0
ds_read_b64_tr_b16 a[32:33], v8 offset:16384
ds_read_b64_tr_b16 a[34:35], v8 offset:20480
M v[36:39], v[168:171], a[96:99], v[36:39]
M v[40:43], v[176:179], a[96:99], 0
buffer_load_dwordx4 v3, s[48:51], s26 offen offset:1024 lds
M v[40:43], v[180:183], a[100:103], v[40:43]
M v[44:47], v[188:191], a[100:103], 0
ds_read_b64_tr_b16 a[36:37], v8 offset:24576
ds_read_b64_tr_b16 a[38:39], v8 offset:28672
M v[44:47], v[184:187], a[96:99], v[44:47]
M v[48:51], v[192:195], a[96:99], 0
buffer_load_dwordx4 v4, s[48:51], s26 offen offset:2048 lds
M v[48:51], v[196:199], a[100:103], v[48:51]
M v[52:55], v[204:207], a[100:103], 0
ds_read_b64_tr_b16 a[40:41], v9 offset:16384
ds_read_b64_tr_b16 a[42:43], v9 offset:20480
M v[52:55], v[200:203], a[96:99], v[52:55]
M v[56:59], v[208:211], a[96:99], 0
buffer_load_dwordx4 v5, s[48:51], s26 offen offset:3072 lds
M v[56:59], v[212:215], a[100:103], v[56:59]
M v[60:63], v[220:223], a[100:103], 0
ds_read_b64_tr_b16 a[44:45], v9 offset:24576
ds_read_b64_tr_b16 a[46:47], v9 offset:28672
M v[60:63], v[216:219], a[96:99], v[60:63]
M v[64:67], v[160:163], a[104:107], 0
buffer_load_dwordx4 a[224:227], v1, s[44:47], s25 offen offset:0 sc1
M v[64:67], v[164:167], a[108:111], v[64:67]
M v[68:71], v[172:175], a[108:111], 0
ds_read_b64_tr_b16 a[48:49], v10 offset:16384
ds_read_b64_tr_b16 a[50:51], v10 offset:20480
M v[68:71], v[168:171], a[104:107], v[68:71]
M v[72:75], v[176:179], a[104:107], 0
buffer_load_dwordx4 a[228:231], v1, s[44:47], s25 offen offset:1024 sc1
M v[72:75], v[180:183], a[108:111], v[72:75]
M v[76:79], v[188:191], a[108:111], 0
ds_read_b64_tr_b16 a[52:53], v10 offset:24576
ds_read_b64_tr_b16 a[54:55], v10 offset:28672
M v[76:79], v[184:187], a[104:107], v[76:79]
M v[80:83], v[192:195], a[104:107], 0
buffer_load_dwordx4 a[232:235], v1, s[44:47], s25 offen offset:2048 sc1
M v[80:83], v[196:199], a[108:111], v[80:83]
M v[84:87], v[204:207], a[108:111], 0
ds_read_b64_tr_b16 a[56:57], v11 offset:16384
ds_read_b64_tr_b16 a[58:59], v11 offset:20480
M v[84:87], v[200:203], a[104:107], v[84:87]
M v[88:91], v[208:211], a[104:107], 0
buffer_load_dwordx4 a[236:239], v1, s[44:47], s25 offen offset:3072 sc1
M v[88:91], v[212:215], a[108:111], v[88:91]
M v[92:95], v[220:223], a[108:111], 0
M v[92:95], v[216:219], a[104:107], v[92:95]
ds_read_b64_tr_b16 a[60:61], v11 offset:24576
ds_read_b64_tr_b16 a[62:63], v11 offset:28672
M v[96:99], v[160:163], a[112:115], 0
M v[96:99], v[164:167], a[116:119], v[96:99]
s_add_u32 s63, s25, 4096
buffer_load_dwordx4 a[240:243], v1, s[44:47], s63 offen offset:0 sc1
M v[100:103], v[172:175], a[116:119], 0
M v[100:103], v[168:171], a[112:115], v[100:103]
ds_read_b64_tr_b16 a[64:65], v12 offset:16384
ds_read_b64_tr_b16 a[66:67], v12 offset:20480
M v[104:107], v[176:179], a[112:115], 0
M v[104:107], v[180:183], a[116:119], v[104:107]
buffer_load_dwordx4 a[244:247], v1, s[44:47], s63 offen offset:1024 sc1
M v[108:111], v[188:191], a[116:119], 0
M v[108:111], v[184:187], a[112:115], v[108:111]
ds_read_b64_tr_b16 a[68:69], v12 offset:24576
ds_read_b64_tr_b16 a[70:71], v12 offset:28672
M v[112:115], v[192:195], a[112:115], 0
M v[112:115], v[196:199], a[116:119], v[112:115]
buffer_load_dwordx4 a[248:251], v1, s[44:47], s63 offen offset:2048 sc1
M v[116:119], v[204:207], a[116:119], 0
M v[116:119], v[200:203], a[112:115], v[116:119]
ds_read_b64_tr_b16 a[72:73], v13 offset:16384
ds_read_b64_tr_b16 a[74:75], v13 offset:20480
M v[120:123], v[208:211], a[112:115], 0
M v[120:123], v[212:215], a[116:119], v[120:123]
buffer_load_dwordx4 a[252:255], v1, s[44:47], s63 offen offset:3072 sc1
M v[124:127], v[220:223], a[116:119], 0
M v[124:127], v[216:219], a[112:115], v[124:127]
ds_read_b64_tr_b16 a[76:77], v13 offset:24576
ds_read_b64_tr_b16 a[78:79], v13 offset:28672
M v[128:131], v[160:163], a[120:123], 0
M v[128:131], v[164:167], a[124:127], v[128:131]
s_sub_u32 s39, s39, 1
s_cmp_eq_u32 s39, 0
s_cselect_b32 s3, s64, s65
M v[132:135], v[172:175], a[124:127], 0
M v[132:135], v[168:171], a[120:123], v[132:135]
ds_read_b64_tr_b16 a[80:81], v14 offset:16384
ds_read_b64_tr_b16 a[82:83], v14 offset:20480
M v[136:139], v[176:179], a[120:123], 0
M v[136:139], v[180:183], a[124:127], v[136:139]
s_add_u32 s25, s25, s3
s_lshl_b32 s3, s3, 3
s_add_u32 s26, s26, s3
M v[140:143], v[188:191], a[124:127], 0
M v[140:143], v[184:187], a[120:123], v[140:143]
ds_read_b64_tr_b16 a[84:85], v14 offset:24576
ds_read_b64_tr_b16 a[86:87], v14 offset:28672
M v[144:147], v[192:195], a[120:123], 0
M v[144:147], v[196:199], a[124:127], v[144:147]
ds_read_b64_tr_b16 a[88:89], v15 offset:16384
ds_read_b64_tr_b16 a[90:91], v15 offset:20480
M v[148:151], v[204:207], a[124:127], 0
M v[148:151], v[200:203], a[120:123], v[148:151]
ds_read_b64_tr_b16 a[92:93], v15 offset:24576
ds_read_b64_tr_b16 a[94:95], v15 offset:28672
M v[152:155], v[208:211], a[120:123], 0
M v[152:155], v[212:215], a[124:127], v[152:155]
M v[156:159], v[220:223], a[124:127], 0
M v[156:159], v[216:219], a[120:123], v[156:159]
s_waitcnt vmcnt(24) lgkmcnt(0)
s_barrier
M v[32:35], a[32:35], a[128:131], v[32:35]
s_add_u32 m0, s41, 81920
s_nop 0
buffer_load_dwordx4 v2, s[48:51], s26 offen offset:0 lds
M v[32:35], a[36:39], a[132:135], v[32:35]
M v[36:39], a[44:47], a[132:135], v[36:39]
ds_read_b64_tr_b16 v[160:161], v8 offset:32768
ds_read_b64_tr_b16 v[162:163], v8 offset:36864
M v[36:39], a[40:43], a[128:131], v[36:39]
M v[40:43], a[48:51], a[128:131], v[40:43]
buffer_load_dwordx4 v3, s[48:51], s26 offen offset:1024 lds
M v[40:43], a[52:55], a[132:135], v[40:43]
M v[44:47], a[60:63], a[132:135], v[44:47]
ds_read_b64_tr_b16 v[164:165], v8 offset:40960
ds_read_b64_tr_b16 v[166:167], v8 offset:45056
M v[44:47], a[56:59], a[128:131], v[44:47]
M v[48:51], a[64:67], a[128:131], v[48:51]
buffer_load_dwordx4 v4, s[48:51], s26 offen offset:2048 lds
M v[48:51], a[68:71], a[132:135], v[48:51]
M v[52:55], a[76:79], a[132:135], v[52:55]
ds_read_b64_tr_b16 v[168:169], v9 offset:32768
ds_read_b64_tr_b16 v[170:171], v9 offset:36864
M v[52:55], a[72:75], a[128:131], v[52:55]
M v[56:59], a[80:83], a[128:131], v[56:59]
buffer_load_dwordx4 v5, s[48:51], s26 offen offset:3072 lds
M v[56:59], a[84:87], a[132:135], v[56:59]
M v[60:63], a[92:95], a[132:135], v[60:63]
ds_read_b64_tr_b16 v[172:173], v9 offset:40960
ds_read_b64_tr_b16 v[174:175], v9 offset:45056
M v[60:63], a[88:91], a[128:131], v[60:63]
M v[64:67], a[32:35], a[136:139], v[64:67]
buffer_load_dwordx4 a[96:99], v1, s[44:47], s25 offen offset:0 sc1
M v[64:67], a[36:39], a[140:143], v[64:67]
M v[68:71], a[44:47], a[140:143], v[68:71]
ds_read_b64_tr_b16 v[176:177], v10 offset:32768
ds_read_b64_tr_b16 v[178:179], v10 offset:36864
M v[68:71], a[40:43], a[136:139], v[68:71]
M v[72:75], a[48:51], a[136:139], v[72:75]
buffer_load_dwordx4 a[100:103], v1, s[44:47], s25 offen offset:1024 sc1
M v[72:75], a[52:55], a[140:143], v[72:75]
M v[76:79], a[60:63], a[140:143], v[76:79]
ds_read_b64_tr_b16 v[180:181], v10 offset:40960
ds_read_b64_tr_b16 v[182:183], v10 offset:45056
M v[76:79], a[56:59], a[136:139], v[76:79]
M v[80:83], a[64:67], a[136:139], v[80:83]
buffer_load_dwordx4 a[104:107], v1, s[44:47], s25 offen offset:2048 sc1
M v[80:83], a[68:71], a[140:143], v[80:83]
M v[84:87], a[76:79], a[140:143], v[84:87]
ds_read_b64_tr_b16 v[184:185], v11 offset:32768
ds_read_b64_tr_b16 v[186:187], v11 offset:36864
M v[84:87], a[72:75], a[136:139], v[84:87]
M v[88:91], a[80:83], a[136:139], v[88:91]
buffer_load_dwordx4 a[108:111], v1, s[44:47], s25 offen offset:3072 sc1
M v[88:91], a[84:87], a[140:143], v[88:91]
M v[92:95], a[92:95], a[140:143], v[92:95]
M v[92:95], a[88:91], a[136:139], v[92:95]
ds_read_b64_tr_b16 v[188:189], v11 offset:40960
ds_read_b64_tr_b16 v[190:191], v11 offset:45056
M v[96:99], a[32:35], a[144:147], v[96:99]
M v[96:99], a[36:39], a[148:151], v[96:99]
s_add_u32 s63, s25, 4096
buffer_load_dwordx4 a[112:115], v1, s[44:47], s63 offen offset:0 sc1
M v[100:103], a[44:47], a[148:151], v[100:103]
M v[100:103], a[40:43], a[144:147], v[100:103]
ds_read_b64_tr_b16 v[192:193], v12 offset:32768
ds_read_b64_tr_b16 v[194:195], v12 offset:36864
M v[104:107], a[48:51], a[144:147], v[104:107]
M v[104:107], a[52:55], a[148:151], v[104:107]
buffer_load_dwordx4 a[116:119], v1, s[44:47], s63 offen offset:1024 sc1
M v[108:111], a[60:63], a[148:151], v[108:111]
M v[108:111], a[56:59], a[144:147], v[108:111]
ds_read_b64_tr_b16 v[196:197], v12 offset:40960
ds_read_b64_tr_b16 v[198:199], v12 offset:45056
M v[112:115], a[64:67], a[144:147], v[112:115]
M v[112:115], a[68:71], a[148:151], v[112:115]
buffer_load_dwordx4 a[120:123], v1, s[44:47], s63 offen offset:2048 sc1
M v[116:119], a[76:79], a[148:151], v[116:119]
M v[116:119], a[72:75], a[144:147], v[116:119]
ds_read_b64_tr_b16 v[200:201], v13 offset:32768
ds_read_b64_tr_b16 v[202:203], v13 offset:36864
M v[120:123], a[80:83], a[144:147], v[120:123]
M v[120:123], a[84:87], a[148:151], v[120:123]
buffer_load_dwordx4 a[124:127], v1, s[44:47], s63 offen offset:3072 sc1
M v[124:127], a[92:95], a[148:151], v[124:127]
M v[124:127], a[88:91], a[144:147], v[124:127]
ds_read_b64_tr_b16 v[204:205], v13 offset:40960
ds_read_b64_tr_b16 v[206:207], v13 offset:45056
M v[128:131], a[32:35], a[152:155], v[128:131]
M v[128:131], a[36:39], a[156:159], v[128:131]
s_sub_u32 s39, s39, 1
s_cmp_eq_u32 s39, 0
s_cselect_b32 s3, s64, s65
M v[132:135], a[44:47], a[156:159], v[132:135]
M v[132:135], a[40:43], a[152:155], v[132:135]
ds_read_b64_tr_b16 v[208:209], v14 offset:32768
ds_read_b64_tr_b16 v[210:211], v14 offset:36864
M v[136:139], a[48:51], a[152:155], v[136:139]
M v[136:139], a[52:55], a[156:159], v[136:139]
s_add_u32 s25, s25, s3
s_lshl_b32 s3, s3, 3
s_add_u32 s26, s26, s3
M v[140:143], a[60:63], a[156:159], v[140:143]
M v[140:143], a[56:59], a[152:155], v[140:143]
ds_read_b64_tr_b16 v[212:213], v14 offset:40960
ds_read_b64_tr_b16 v[214:215], v14 offset:45056
M v[144:147], a[64:67], a[152:155], v[144:147]
M v[144:147], a[68:71], a[156:159], v[144:147]
ds_read_b64_tr_b16 v[216:217], v15 offset:32768
ds_read_b64_tr_b16 v[218:219], v15 offset:36864
M v[148:151], a[76:79], a[156:159], v[148:151]
M v[148:151], a[72:75], a[152:155], v[148:151]
ds_read_b64_tr_b16 v[220:221], v15 offset:40960
ds_read_b64_tr_b16 v[222:223], v15 offset:45056
M v[152:155], a[80:83], a[152:155], v[152:155]
M v[152:155], a[84:87], a[156:159], v[152:155]
M v[156:159], a[92:95], a[156:159], v[156:159]
M v[156:159], a[88:91], a[152:155], v[156:159]
s_waitcnt vmcnt(24) lgkmcnt(0)
s_barrier
M v[32:35], v[160:163], a[160:163], v[32:35]
s_add_u32 m0, s41, 98304
s_nop 0
buffer_load_dwordx4 v2, s[48:51], s26 offen offset:0 lds
M v[32:35], v[164:167], a[164:167], v[32:35]
M v[36:39], v[172:175], a[164:167], v[36:39]
ds_read_b64_tr_b16 a[32:33], v8 offset:49152
ds_read_b64_tr_b16 a[34:35], v8 offset:53248
M v[36:39], v[168:171], a[160:163], v[36:39]
M v[40:43], v[176:179], a[160:163], v[40:43]
buffer_load_dwordx4 v3, s[48:51], s26 offen offset:1024 lds
M v[40:43], v[180:183], a[164:167], v[40:43]
M v[44:47], v[188:191], a[164:167], v[44:47]
ds_read_b64_tr_b16 a[36:37], v8 offset:57344
ds_read_b64_tr_b16 a[38:39], v8 offset:61440
M v[44:47], v[184:187], a[160:163], v[44:47]
M v[48:51], v[192:195], a[160:163], v[48:51]
buffer_load_dwordx4 v4, s[48:51], s26 offen offset:2048 lds
M v[48:51], v[196:199], a[164:167], v[48:51]
M v[52:55], v[204:207], a[164:167], v[52:55]
ds_read_b64_tr_b16 a[40:41], v9 offset:49152
ds_read_b64_tr_b16 a[42:43], v9 offset:53248
M v[52:55], v[200:203], a[160:163], v[52:55]
M v[56:59], v[208:211], a[160:163], v[56:59]
buffer_load_dwordx4 v5, s[48:51], s26 offen offset:3072 lds
M v[56:59], v[212:215], a[164:167], v[56:59]
M v[60:63], v[220:223], a[164:167], v[60:63]
ds_read_b64_tr_b16 a[44:45], v9 offset:57344
ds_read_b64_tr_b16 a[46:47], v9 offset:61440
M v[60:63], v[216:219], a[160:163], v[60:63]
M v[64:67], v[160:163], a[168:171], v[64:67]
buffer_load_dwordx4 a[128:131], v1, s[44:47], s25 offen offset:0 sc1
M v[64:67], v[164:167], a[172:175], v[64:67]
M v[68:71], v[172:175], a[172:175], v[68:71]
ds_read_b64_tr_b16 a[48:49], v10 offset:49152
ds_read_b64_tr_b16 a[50:51], v10 offset:53248
M v[68:71], v[168:171], a[168:171], v[68:71]
M v[72:75], v[176:179], a[168:171], v[72:75]
buffer_load_dwordx4 a[132:135], v1, s[44:47], s25 offen offset:1024 sc1
M v[72:75], v[180:183], a[172:175], v[72:75]
M v[76:79], v[188:191], a[172:175], v[76:79]
ds_read_b64_tr_b16 a[52:53], v10 offset:57344
ds_read_b64_tr_b16 a[54:55], v10 offset:61440
M v[76:79], v[184:187], a[168:171], v[76:79]
M v[80:83], v[192:195], a[168:171], v[80:83]
buffer_load_dwordx4 a[136:139], v1, s[44:47], s25 offen offset:2048 sc1
M v[80:83], v[196:199], a[172:175], v[80:83]
M v[84:87], v[204:207], a[172:175], v[84:87]
ds_read_b64_tr_b16 a[56:57], v11 offset:49152
ds_read_b64_tr_b16 a[58:59], v11 offset:53248
M v[84:87], v[200:203], a[168:171], v[84:87]
M v[88:91], v[208:211], a[168:171], v[88:91]
buffer_load_dwordx4 a[140:143], v1, s[44:47], s25 offen offset:3072 sc1
M v[88:91], v[212:215], a[172:175], v[88:91]
M v[92:95], v[220:223], a[172:175], v[92:95]
M v[92:95], v[216:219], a[168:171], v[92:95]
ds_read_b64_tr_b16 a[60:61], v11 offset:57344
ds_read_b64_tr_b16 a[62:63], v11 offset:61440
M v[96:99], v[160:163], a[176:179], v[96:99]
M v[96:99], v[164:167], a[180:183], v[96:99]
s_add_u32 s63, s25, 4096
buffer_load_dwordx4 a[144:147], v1, s[44:47], s63 offen offset:0 sc1
M v[100:103], v[172:175], a[180:183], v[100:103]
M v[100:103], v[168:171], a[176:179], v[100:103]
ds_read_b64_tr_b16 a[64:65], v12 offset:49152
ds_read_b64_tr_b16 a[66:67], v12 offset:53248
M v[104:107], v[176:179], a[176:179], v[104:107]
M v[104:107], v[180:183], a[180:183], v[104:107]
buffer_load_dwordx4 a[148:151], v1, s[44:47], s63 offen offset:1024 sc1
M v[108:111], v[188:191], a[180:183], v[108:111]
M v[108:111], v[184:187], a[176:179], v[108:111]
ds_read_b64_tr_b16 a[68:69], v12 offset:57344
ds_read_b64_tr_b16 a[70:71], v12 offset:61440
M v[112:115], v[192:195], a[176:179], v[112:115]
M v[112:115], v[196:199], a[180:183], v[112:115]
buffer_load_dwordx4 a[152:155], v1, s[44:47], s63 offen offset:2048 sc1
M v[116:119], v[204:207], a[180:183], v[116:119]
M v[116:119], v[200:203], a[176:179], v[116:119]
ds_read_b64_tr_b16 a[72:73], v13 offset:49152
ds_read_b64_tr_b16 a[74:75], v13 offset:53248
M v[120:123], v[208:211], a[176:179], v[120:123]
M v[120:123], v[212:215], a[180:183], v[120:123]
buffer_load_dwordx4 a[156:159], v1, s[44:47], s63 offen offset:3072 sc1
M v[124:127], v[220:223], a[180:183], v[124:127]
M v[124:127], v[216:219], a[176:179], v[124:127]
ds_read_b64_tr_b16 a[76:77], v13 offset:57344
ds_read_b64_tr_b16 a[78:79], v13 offset:61440
M v[128:131], v[160:163], a[184:187], v[128:131]
M v[128:131], v[164:167], a[188:191], v[128:131]
s_sub_u32 s39, s39, 1
s_cmp_eq_u32 s39, 0
s_cselect_b32 s3, s64, s65
M v[132:135], v[172:175], a[188:191], v[132:135]
M v[132:135], v[168:171], a[184:187], v[132:135]
ds_read_b64_tr_b16 a[80:81], v14 offset:49152
ds_read_b64_tr_b16 a[82:83], v14 offset:53248
M v[136:139], v[176:179], a[184:187], v[136:139]
M v[136:139], v[180:183], a[188:191], v[136:139]
s_add_u32 s25, s25, s3
s_lshl_b32 s3, s3, 3
s_add_u32 s26, s26, s3
M v[140:143], v[188:191], a[188:191], v[140:143]
M v[140:143], v[184:187], a[184:187], v[140:143]
ds_read_b64_tr_b16 a[84:85], v14 offset:57344
ds_read_b64_tr_b16 a[86:87], v14 offset:61440
M v[144:147], v[192:195], a[184:187], v[144:147]
M v[144:147], v[196:199], a[188:191], v[144:147]
ds_read_b64_tr_b16 a[88:89], v15 offset:49152
ds_read_b64_tr_b16 a[90:91], v15 offset:53248
M v[148:151], v[204:207], a[188:191], v[148:151]
M v[148:151], v[200:203], a[184:187], v[148:151]
ds_read_b64_tr_b16 a[92:93], v15 offset:57344
ds_read_b64_tr_b16 a[94:95], v15 offset:61440
M v[152:155], v[208:211], a[184:187], v[152:155]
M v[152:155], v[212:215], a[188:191], v[152:155]
M v[156:159], v[220:223], a[188:191], v[156:159]
M v[156:159], v[216:219], a[184:187], v[156:159]
s_waitcnt vmcnt(24) lgkmcnt(0)
s_barrier
M v[32:35], a[32:35], a[192:195], v[32:35]
s_add_u32 m0, s41, 114688
s_nop 0
buffer_load_dwordx4 v2, s[48:51], s26 offen offset:0 lds
M v[32:35], a[36:39], a[196:199], v[32:35]
M v[36:39], a[44:47], a[196:199], v[36:39]
ds_read_b64_tr_b16 v[160:161], v16 offset:0
ds_read_b64_tr_b16 v[162:163], v16 offset:4096
M v[36:39], a[40:43], a[192:195], v[36:39]
M v[40:43], a[48:51], a[192:195], v[40:43]
buffer_load_dwordx4 v3, s[48:51], s26 offen offset:1024 lds
M v[40:43], a[52:55], a[196:199], v[40:43]
M v[44:47], a[60:63], a[196:199], v[44:47]
ds_read_b64_tr_b16 v[164:165], v16 offset:8192
ds_read_b64_tr_b16 v[166:167], v16 offset:12288
M v[44:47], a[56:59], a[192:195], v[44:47]
M v[48:51], a[64:67], a[192:195], v[48:51]
buffer_load_dwordx4 v4, s[48:51], s26 offen offset:2048 lds
M v[48:51], a[68:71], a[196:199], v[48:51]
M v[52:55], a[76:79], a[196:199], v[52:55]
ds_read_b64_tr_b16 v[168:169], v17 offset:0
ds_read_b64_tr_b16 v[170:171], v17 offset:4096
M v[52:55], a[72:75], a[192:195], v[52:55]
M v[56:59], a[80:83], a[192:195], v[56:59]
buffer_load_dwordx4 v5, s[48:51], s26 offen offset:3072 lds
M v[56:59], a[84:87], a[196:199], v[56:59]
M v[60:63], a[92:95], a[196:199], v[60:63]
ds_read_b64_tr_b16 v[172:173], v17 offset:8192
ds_read_b64_tr_b16 v[174:175], v17 offset:12288
M v[60:63], a[88:91], a[192:195], v[60:63]
M v[64:67], a[32:35], a[200:203], v[64:67]
buffer_load_dwordx4 a[160:163], v1, s[44:47], s25 offen offset:0 sc1
M v[64:67], a[36:39], a[204:207], v[64:67]
M v[68:71], a[44:47], a[204:207], v[68:71]
ds_read_b64_tr_b16 v[176:177], v18 offset:0
ds_read_b64_tr_b16 v[178:179], v18 offset:4096
M v[68:71], a[40:43], a[200:203], v[68:71]
M v[72:75], a[48:51], a[200:203], v[72:75]
buffer_load_dwordx4 a[164:167], v1, s[44:47], s25 offen offset:1024 sc1
M v[72:75], a[52:55], a[204:207], v[72:75]
M v[76:79], a[60:63], a[204:207], v[76:79]
ds_read_b64_tr_b16 v[180:181], v18 offset:8192
ds_read_b64_tr_b16 v[182:183], v18 offset:12288
M v[76:79], a[56:59], a[200:203], v[76:79]
M v[80:83], a[64:67], a[200:203], v[80:83]
buffer_load_dwordx4 a[168:171], v1, s[44:47], s25 offen offset:2048 sc1
M v[80:83], a[68:71], a[204:207], v[80:83]
M v[84:87], a[76:79], a[204:207], v[84:87]
ds_read_b64_tr_b16 v[184:185], v19 offset:0
ds_read_b64_tr_b16 v[186:187], v19 offset:4096
M v[84:87], a[72:75], a[200:203], v[84:87]
M v[88:91], a[80:83], a[200:203], v[88:91]
buffer_load_dwordx4 a[172:175], v1, s[44:47], s25 offen offset:3072 sc1
M v[88:91], a[84:87], a[204:207], v[88:91]
M v[92:95], a[92:95], a[204:207], v[92:95]
M v[92:95], a[88:91], a[200:203], v[92:95]
ds_read_b64_tr_b16 v[188:189], v19 offset:8192
ds_read_b64_tr_b16 v[190:191], v19 offset:12288
M v[96:99], a[32:35], a[208:211], v[96:99]
M v[96:99], a[36:39], a[212:215], v[96:99]
s_add_u32 s63, s25, 4096
buffer_load_dwordx4 a[176:179], v1, s[44:47], s63 offen offset:0 sc1
M v[100:103], a[44:47], a[212:215], v[100:103]
M v[100:103], a[40:43], a[208:211], v[100:103]
ds_read_b64_tr_b16 v[192:193], v20 offset:0
ds_read_b64_tr_b16 v[194:195], v20 offset:4096
M v[104:107], a[48:51], a[208:211], v[104:107]
M v[104:107], a[52:55], a[212:215], v[104:107]
buffer_load_dwordx4 a[180:183], v1, s[44:47], s63 offen offset:1024 sc1
M v[108:111], a[60:63], a[212:215], v[108:111]
M v[108:111], a[56:59], a[208:211], v[108:111]
ds_read_b64_tr_b16 v[196:197], v20 offset:8192
ds_read_b64_tr_b16 v[198:199], v20 offset:12288
M v[112:115], a[64:67], a[208:211], v[112:115]
M v[112:115], a[68:71], a[212:215], v[112:115]
buffer_load_dwordx4 a[184:187], v1, s[44:47], s63 offen offset:2048 sc1
M v[116:119], a[76:79], a[212:215], v[116:119]
M v[116:119], a[72:75], a[208:211], v[116:119]
ds_read_b64_tr_b16 v[200:201], v21 offset:0
ds_read_b64_tr_b16 v[202:203], v21 offset:4096
M v[120:123], a[80:83], a[208:211], v[120:123]
M v[120:123], a[84:87], a[212:215], v[120:123]
buffer_load_dwordx4 a[188:191], v1, s[44:47], s63 offen offset:3072 sc1
M v[124:127], a[92:95], a[212:215], v[124:127]
M v[124:127], a[88:91], a[208:211], v[124:127]
ds_read_b64_tr_b16 v[204:205], v21 offset:8192
ds_read_b64_tr_b16 v[206:207], v21 offset:12288
M v[128:131], a[32:35], a[216:219], v[128:131]
M v[128:131], a[36:39], a[220:223], v[128:131]
s_sub_u32 s39, s39, 1
s_cmp_eq_u32 s39, 0
s_cselect_b32 s3, s64, s65
M v[132:135], a[44:47], a[220:223], v[132:135]
M v[132:135], a[40:43], a[216:219], v[132:135]
ds_read_b64_tr_b16 v[208:209], v22 offset:0
ds_read_b64_tr_b16 v[210:211], v22 offset:4096
M v[136:139], a[48:51], a[216:219], v[136:139]
M v[136:139], a[52:55], a[220:223], v[136:139]
s_add_u32 s25, s25, s3
s_lshl_b32 s3, s3, 3
s_add_u32 s26, s26, s3
M v[140:143], a[60:63], a[220:223], v[140:143]
M v[140:143], a[56:59], a[216:219], v[140:143]
ds_read_b64_tr_b16 v[212:213], v22 offset:8192
ds_read_b64_tr_b16 v[214:215], v22 offset:12288
M v[144:147], a[64:67], a[216:219], v[144:147]
M v[144:147], a[68:71], a[220:223], v[144:147]
ds_read_b64_tr_b16 v[216:217], v23 offset:0
ds_read_b64_tr_b16 v[218:219], v23 offset:4096
M v[148:151], a[76:79], a[220:223], v[148:151]
M v[148:151], a[72:75], a[216:219], v[148:151]
ds_read_b64_tr_b16 v[220:221], v23 offset:8192
ds_read_b64_tr_b16 v[222:223], v23 offset:12288
M v[152:155], a[80:83], a[216:219], v[152:155]
M v[152:155], a[84:87], a[220:223], v[152:155]
M v[156:159], a[92:95], a[220:223], v[156:159]
M v[156:159], a[88:91], a[216:219], v[156:159]
s_waitcnt vmcnt(24) lgkmcnt(0)
s_barrier
M v[32:35], v[160:163], a[224:227], v[32:35]
s_add_u32 m0, s41, 0
s_nop 0
buffer_load_dwordx4 v2, s[48:51], s26 offen offset:0 lds
M v[32:35], v[164:167], a[228:231], v[32:35]
M v[36:39], v[172:175], a[228:231], v[36:39]
ds_read_b64_tr_b16 a[32:33], v16 offset:16384
ds_read_b64_tr_b16 a[34:35], v16 offset:20480
M v[36:39], v[168:171], a[224:227], v[36:39]
M v[40:43], v[176:179], a[224:227], v[40:43]
buffer_load_dwordx4 v3, s[48:51], s26 offen offset:1024 lds
M v[40:43], v[180:183], a[228:231], v[40:43]
M v[44:47], v[188:191], a[228:231], v[44:47]
ds_read_b64_tr_b16 a[36:37], v16 offset:24576
ds_read_b64_tr_b16 a[38:39], v16 offset:28672
M v[44:47], v[184:187], a[224:227], v[44:47]
M v[48:51], v[192:195], a[224:227], v[48:51]
buffer_load_dwordx4 v4, s[48:51], s26 offen offset:2048 lds
M v[48:51], v[196:199], a[228:231], v[48:51]
M v[52:55], v[204:207], a[228:231], v[52:55]
ds_read_b64_tr_b16 a[40:41], v17 offset:16384
ds_read_b64_tr_b16 a[42:43], v17 offset:20480
M v[52:55], v[200:203], a[224:227], v[52:55]
M v[56:59], v[208:211], a[224:227], v[56:59]
buffer_load_dwordx4 v5, s[48:51], s26 offen offset:3072 lds
M v[56:59], v[212:215], a[228:231], v[56:59]
M v[60:63], v[220:223], a[228:231], v[60:63]
ds_read_b64_tr_b16 a[44:45], v17 offset:24576
ds_read_b64_tr_b16 a[46:47], v17 offset:28672
M v[60:63], v[216:219], a[224:227], v[60:63]
M v[64:67], v[160:163], a[232:235], v[64:67]
buffer_load_dwordx4 a[192:195], v1, s[44:47], s25 offen offset:0 sc1
M v[64:67], v[164:167], a[236:239], v[64:67]
M v[68:71], v[172:175], a[236:239], v[68:71]
ds_read_b64_tr_b16 a[48:49], v18 offset:16384
ds_read_b64_tr_b16 a[50:51], v18 offset:20480
M v[68:71], v[168:171], a[232:235], v[68:71]
M v[72:75], v[176:179], a[232:235], v[72:75]
buffer_load_dwordx4 a[196:199], v1, s[44:47], s25 offen offset:1024 sc1
M v[72:75], v[180:183], a[236:239], v[72:75]
M v[76:79], v[188:191], a[236:239], v[76:79]
ds_read_b64_tr_b16 a[52:53], v18 offset:24576
ds_read_b64_tr_b16 a[54:55], v18 offset:28672
M v[76:79], v[184:187], a[232:235], v[76:79]
M v[80:83], v[192:195], a[232:235], v[80:83]
buffer_load_dwordx4 a[200:203], v1, s[44:47], s25 offen offset:2048 sc1
M v[80:83], v[196:199], a[236:239], v[80:83]
M v[84:87], v[204:207], a[236:239], v[84:87]
ds_read_b64_tr_b16 a[56:57], v19 offset:16384
ds_read_b64_tr_b16 a[58:59], v19 offset:20480
M v[84:87], v[200:203], a[232:235], v[84:87]
M v[88:91], v[208:211], a[232:235], v[88:91]
buffer_load_dwordx4 a[204:207], v1, s[44:47], s25 offen offset:3072 sc1
M v[88:91], v[212:215], a[236:239], v[88:91]
M v[92:95], v[220:223], a[236:239], v[92:95]
M v[92:95], v[216:219], a[232:235], v[92:95]
ds_read_b64_tr_b16 a[60:61], v19 offset:24576
ds_read_b64_tr_b16 a[62:63], v19 offset:28672
M v[96:99], v[160:163], a[240:243], v[96:99]
M v[96:99], v[164:167], a[244:247], v[96:99]
s_add_u32 s63, s25, 4096
buffer_load_dwordx4 a[208:211], v1, s[44:47], s63 offen offset:0 sc1
M v[100:103], v[172:175], a[244:247], v[100:103]
M v[100:103], v[168:171], a[240:243], v[100:103]
ds_read_b64_tr_b16 a[64:65], v20 offset:16384
ds_read_b64_tr_b16 a[66:67], v20 offset:20480
M v[104:107], v[176:179], a[240:243], v[104:107]
M v[104:107], v[180:183], a[244:247], v[104:107]
buffer_load_dwordx4 a[212:215], v1, s[44:47], s63 offen offset:1024 sc1
M v[108:111], v[188:191], a[244:247], v[108:111]
M v[108:111], v[184:187], a[240:243], v[108:111]
ds_read_b64_tr_b16 a[68:69], v20 offset:24576
ds_read_b64_tr_b16 a[70:71], v20 offset:28672
M v[112:115], v[192:195], a[240:243], v[112:115]
M v[112:115], v[196:199], a[244:247], v[112:115]
buffer_load_dwordx4 a[216:219], v1, s[44:47], s63 offen offset:2048 sc1
M v[116:119], v[204:207], a[244:247], v[116:119]
M v[116:119], v[200:203], a[240:243], v[116:119]
ds_read_b64_tr_b16 a[72:73], v21 offset:16384
ds_read_b64_tr_b16 a[74:75], v21 offset:20480
M v[120:123], v[208:211], a[240:243], v[120:123]
M v[120:123], v[212:215], a[244:247], v[120:123]
buffer_load_dwordx4 a[220:223], v1, s[44:47], s63 offen offset:3072 sc1
M v[124:127], v[220:223], a[244:247], v[124:127]
M v[124:127], v[216:219], a[240:243], v[124:127]
ds_read_b64_tr_b16 a[76:77], v21 offset:24576
ds_read_b64_tr_b16 a[78:79], v21 offset:28672
M v[128:131], v[160:163], a[248:251], v[128:131]
M v[128:131], v[164:167], a[252:255], v[128:131]
s_sub_u32 s39, s39, 1
s_cmp_eq_u32 s39, 0
s_cselect_b32 s3, s64, s65
M v[132:135], v[172:175], a[252:255], v[132:135]
M v[132:135], v[168:171], a[248:251], v[132:135]
ds_read_b64_tr_b16 a[80:81], v22 offset:16384
ds_read_b64_tr_b16 a[82:83], v22 offset:20480
M v[136:139], v[176:179], a[248:251], v[136:139]
M v[136:139], v[180:183], a[252:255], v[136:139]
s_add_u32 s25, s25, s3
s_lshl_b32 s3, s3, 3
s_add_u32 s26, s26, s3
M v[140:143], v[188:191], a[252:255], v[140:143]
M v[140:143], v[184:187], a[248:251], v[140:143]
ds_read_b64_tr_b16 a[84:85], v22 offset:24576
ds_read_b64_tr_b16 a[86:87], v22 offset:28672
M v[144:147], v[192:195], a[248:251], v[144:147]
M v[144:147], v[196:199], a[252:255], v[144:147]
ds_read_b64_tr_b16 a[88:89], v23 offset:16384
ds_read_b64_tr_b16 a[90:91], v23 offset:20480
M v[148:151], v[204:207], a[252:255], v[148:151]
M v[148:151], v[200:203], a[248:251], v[148:151]
ds_read_b64_tr_b16 a[92:93], v23 offset:24576
ds_read_b64_tr_b16 a[94:95], v23 offset:28672
M v[152:155], v[208:211], a[248:251], v[152:155]
M v[152:155], v[212:215], a[252:255], v[152:155]
M v[156:159], v[220:223], a[252:255], v[156:159]
M v[156:159], v[216:219], a[248:251], v[156:159]
s_waitcnt vmcnt(24) lgkmcnt(0)
s_barrier
M v[32:35], a[32:35], a[96:99], v[32:35]
s_add_u32 m0, s41, 16384
s_nop 0
buffer_load_dwordx4 v2, s[48:51], s26 offen offset:0 lds
M v[32:35], a[36:39], a[100:103], v[32:35]
M v[36:39], a[44:47], a[100:103], v[36:39]
ds_read_b64_tr_b16 v[160:161], v16 offset:32768
ds_read_b64_tr_b16 v[162:163], v16 offset:36864
M v[36:39], a[40:43], a[96:99], v[36:39]
M v[40:43], a[48:51], a[96:99], v[40:43]
buffer_load_dwordx4 v3, s[48:51], s26 offen offset:1024 lds
M v[40:43], a[52:55], a[100:103], v[40:43]
M v[44:47], a[60:63], a[100:103], v[44:47]
ds_read_b64_tr_b16 v[164:165], v16 offset:40960
ds_read_b64_tr_b16 v[166:167], v16 offset:45056
M v[44:47], a[56:59], a[96:99], v[44:47]
M v[48:51], a[64:67], a[96:99], v[48:51]
buffer_load_dwordx4 v4, s[48:51], s26 offen offset:2048 lds
M v[48:51], a[68:71], a[100:103], v[48:51]
M v[52:55], a[76:79], a[100:103], v[52:55]
ds_read_b64_tr_b16 v[168:169], v17 offset:32768
ds_read_b64_tr_b16 v[170:171], v17 offset:36864
M v[52:55], a[72:75], a[96:99], v[52:55]
M v[56:59], a[80:83], a[96:99], v[56:59]
buffer_load_dwordx4 v5, s[48:51], s26 offen offset:3072 lds
M v[56:59], a[84:87], a[100:103], v[56:59]
M v[60:63], a[92:95], a[100:103], v[60:63]
ds_read_b64_tr_b16 v[172:173], v17 offset:40960
ds_read_b64_tr_b16 v[174:175], v17 offset:45056
M v[60:63], a[88:91], a[96:99], v[60:63]
M v[64:67], a[32:35], a[104:107], v[64:67]
buffer_load_dwordx4 a[224:227], v1, s[44:47], s25 offen offset:0 sc1
M v[64:67], a[36:39], a[108:111], v[64:67]
M v[68:71], a[44:47], a[108:111], v[68:71]
ds_read_b64_tr_b16 v[176:177], v18 offset:32768
ds_read_b64_tr_b16 v[178:179], v18 offset:36864
M v[68:71], a[40:43], a[104:107], v[68:71]
M v[72:75], a[48:51], a[104:107], v[72:75]
buffer_load_dwordx4 a[228:231], v1, s[44:47], s25 offen offset:1024 sc1
M v[72:75], a[52:55], a[108:111], v[72:75]
M v[76:79], a[60:63], a[108:111], v[76:79]
ds_read_b64_tr_b16 v[180:181], v18 offset:40960
ds_read_b64_tr_b16 v[182:183], v18 offset:45056
M v[76:79], a[56:59], a[104:107], v[76:79]
M v[80:83], a[64:67], a[104:107], v[80:83]
buffer_load_dwordx4 a[232:235], v1, s[44:47], s25 offen offset:2048 sc1
M v[80:83], a[68:71], a[108:111], v[80:83]
M v[84:87], a[76:79], a[108:111], v[84:87]
ds_read_b64_tr_b16 v[184:185], v19 offset:32768
ds_read_b64_tr_b16 v[186:187], v19 offset:36864
M v[84:87], a[72:75], a[104:107], v[84:87]
M v[88:91], a[80:83], a[104:107], v[88:91]
buffer_load_dwordx4 a[236:239], v1, s[44:47], s25 offen offset:3072 sc1
M v[88:91], a[84:87], a[108:111], v[88:91]
M v[92:95], a[92:95], a[108:111], v[92:95]
M v[92:95], a[88:91], a[104:107], v[92:95]
ds_read_b64_tr_b16 v[188:189], v19 offset:40960
ds_read_b64_tr_b16 v[190:191], v19 offset:45056
M v[96:99], a[32:35], a[112:115], v[96:99]
M v[96:99], a[36:39], a[116:119], v[96:99]
s_add_u32 s63, s25, 4096
buffer_load_dwordx4 a[240:243], v1, s[44:47], s63 offen offset:0 sc1
M v[100:103], a[44:47], a[116:119], v[100:103]
M v[100:103], a[40:43], a[112:115], v[100:103]
ds_read_b64_tr_b16 v[192:193], v20 offset:32768
ds_read_b64_tr_b16 v[194:195], v20 offset:36864
M v[104:107], a[48:51], a[112:115], v[104:107]
M v[104:107], a[52:55], a[116:119], v[104:107]
buffer_load_dwordx4 a[244:247], v1, s[44:47], s63 offen offset:1024 sc1
M v[108:111], a[60:63], a[116:119], v[108:111]
M v[108:111], a[56:59], a[112:115], v[108:111]
ds_read_b64_tr_b16 v[196:197], v20 offset:40960
ds_read_b64_tr_b16 v[198:199], v20 offset:45056
M v[112:115], a[64:67], a[112:115], v[112:115]
M v[112:115], a[68:71], a[116:119], v[112:115]
buffer_load_dwordx4 a[248:251], v1, s[44:47], s63 offen offset:2048 sc1
M v[116:119], a[76:79], a[116:119], v[116:119]
M v[116:119], a[72:75], a[112:115], v[116:119]
ds_read_b64_tr_b16 v[200:201], v21 offset:32768
ds_read_b64_tr_b16 v[202:203], v21 offset:36864
M v[120:123], a[80:83], a[112:115], v[120:123]
M v[120:123], a[84:87], a[116:119], v[120:123]
buffer_load_dwordx4 a[252:255], v1, s[44:47], s63 offen offset:3072 sc1
M v[124:127], a[92:95], a[116:119], v[124:127]
M v[124:127], a[88:91], a[112:115], v[124:127]
ds_read_b64_tr_b16 v[204:205], v21 offset:40960
ds_read_b64_tr_b16 v[206:207], v21 offset:45056
M v[128:131], a[32:35], a[120:123], v[128:131]
M v[128:131], a[36:39], a[124:127], v[128:131]
s_sub_u32 s39, s39, 1
s_cmp_eq_u32 s39, 0
s_cselect_b32 s3, s64, s65
M v[132:135], a[44:47], a[124:127], v[132:135]
M v[132:135], a[40:43], a[120:123], v[132:135]
ds_read_b64_tr_b16 v[208:209], v22 offset:32768
ds_read_b64_tr_b16 v[210:211], v22 offset:36864
M v[136:139], a[48:51], a[120:123], v[136:139]
M v[136:139], a[52:55], a[124:127], v[136:139]
s_add_u32 s25, s25, s3
s_lshl_b32 s3, s3, 3
s_add_u32 s26, s26, s3
M v[140:143], a[60:63], a[124:127], v[140:143]
M v[140:143], a[56:59], a[120:123], v[140:143]
ds_read_b64_tr_b16 v[212:213], v22 offset:40960
ds_read_b64_tr_b16 v[214:215], v22 offset:45056
M v[144:147], a[64:67], a[120:123], v[144:147]
M v[144:147], a[68:71], a[124:127], v[144:147]
ds_read_b64_tr_b16 v[216:217], v23 offset:32768
ds_read_b64_tr_b16 v[218:219], v23 offset:36864
M v[148:151], a[76:79], a[124:127], v[148:151]
M v[148:151], a[72:75], a[120:123], v[148:151]
ds_read_b64_tr_b16 v[220:221], v23 offset:40960
ds_read_b64_tr_b16 v[222:223], v23 offset:45056
M v[152:155], a[80:83], a[120:123], v[152:155]
M v[152:155], a[84:87], a[124:127], v[152:155]
M v[156:159], a[92:95], a[124:127], v[156:159]
M v[156:159], a[88:91], a[120:123], v[156:159]
s_waitcnt vmcnt(24) lgkmcnt(0)
s_barrier
M v[32:35], v[160:163], a[128:131], v[32:35]
s_add_u32 m0, s41, 32768
s_nop 0
buffer_load_dwordx4 v2, s[48:51], s26 offen offset:0 lds
M v[32:35], v[164:167], a[132:135], v[32:35]
M v[36:39], v[172:175], a[132:135], v[36:39]
ds_read_b64_tr_b16 a[32:33], v16 offset:49152
ds_read_b64_tr_b16 a[34:35], v16 offset:53248
M v[36:39], v[168:171], a[128:131], v[36:39]
M v[40:43], v[176:179], a[128:131], v[40:43]
buffer_load_dwordx4 v3, s[48:51], s26 offen offset:1024 lds
M v[40:43], v[180:183], a[132:135], v[40:43]
M v[44:47], v[188:191], a[132:135], v[44:47]
ds_read_b64_tr_b16 a[36:37], v16 offset:57344
ds_read_b64_tr_b16 a[38:39], v16 offset:61440
M v[44:47], v[184:187], a[128:131], v[44:47]
M v[48:51], v[192:195], a[128:131], v[48:51]
buffer_load_dwordx4 v4, s[48:51], s26 offen offset:2048 lds
M v[48:51], v[196:199], a[132:135], v[48:51]
M v[52:55], v[204:207], a[132:135], v[52:55]
ds_read_b64_tr_b16 a[40:41], v17 offset:49152
ds_read_b64_tr_b16 a[42:43], v17 offset:53248
M v[52:55], v[200:203], a[128:131], v[52:55]
M v[56:59], v[208:211], a[128:131], v[56:59]
buffer_load_dwordx4 v5, s[48:51], s26 offen offset:3072 lds
M v[56:59], v[212:215], a[132:135], v[56:59]
M v[60:63], v[220:223], a[132:135], v[60:63]
ds_read_b64_tr_b16 a[44:45], v17 offset:57344
ds_read_b64_tr_b16 a[46:47], v17 offset:61440
M v[60:63], v[216:219], a[128:131], v[60:63]
M v[64:67], v[160:163], a[136:139], v[64:67]
buffer_load_dwordx4 a[96:99], v1, s[44:47], s25 offen offset:0 sc1
M v[64:67], v[164:167], a[140:143], v[64:67]
M v[68:71], v[172:175], a[140:143], v[68:71]
ds_read_b64_tr_b16 a[48:49], v18 offset:49152
ds_read_b64_tr_b16 a[50:51], v18 offset:53248
M v[68:71], v[168:171], a[136:139], v[68:71]
M v[72:75], v[176:179], a[136:139], v[72:75]
buffer_load_dwordx4 a[100:103], v1, s[44:47], s25 offen offset:1024 sc1
M v[72:75], v[180:183], a[140:143], v[72:75]
M v[76:79], v[188:191], a[140:143], v[76:79]
ds_read_b64_tr_b16 a[52:53], v18 offset:57344
ds_read_b64_tr_b16 a[54:55], v18 offset:61440
M v[76:79], v[184:187], a[136:139], v[76:79]
M v[80:83], v[192:195], a[136:139], v[80:83]
buffer_load_dwordx4 a[104:107], v1, s[44:47], s25 offen offset:2048 sc1
M v[80:83], v[196:199], a[140:143], v[80:83]
M v[84:87], v[204:207], a[140:143], v[84:87]
ds_read_b64_tr_b16 a[56:57], v19 offset:49152
ds_read_b64_tr_b16 a[58:59], v19 offset:53248
M v[84:87], v[200:203], a[136:139], v[84:87]
M v[88:91], v[208:211], a[136:139], v[88:91]
buffer_load_dwordx4 a[108:111], v1, s[44:47], s25 offen offset:3072 sc1
M v[88:91], v[212:215], a[140:143], v[88:91]
M v[92:95], v[220:223], a[140:143], v[92:95]
M v[92:95], v[216:219], a[136:139], v[92:95]
ds_read_b64_tr_b16 a[60:61], v19 offset:57344
ds_read_b64_tr_b16 a[62:63], v19 offset:61440
M v[96:99], v[160:163], a[144:147], v[96:99]
M v[96:99], v[164:167], a[148:151], v[96:99]
s_add_u32 s63, s25, 4096
buffer_load_dwordx4 a[112:115], v1, s[44:47], s63 offen offset:0 sc1
M v[100:103], v[172:175], a[148:151], v[100:103]
M v[100:103], v[168:171], a[144:147], v[100:103]
ds_read_b64_tr_b16 a[64:65], v20 offset:49152
ds_read_b64_tr_b16 a[66:67], v20 offset:53248
M v[104:107], v[176:179], a[144:147], v[104:107]
M v[104:107], v[180:183], a[148:151], v[104:107]
buffer_load_dwordx4 a[116:119], v1, s[44:47], s63 offen offset:1024 sc1
M v[108:111], v[188:191], a[148:151], v[108:111]
M v[108:111], v[184:187], a[144:147], v[108:111]
ds_read_b64_tr_b16 a[68:69], v20 offset:57344
ds_read_b64_tr_b16 a[70:71], v20 offset:61440
M v[112:115], v[192:195], a[144:147], v[112:115]
M v[112:115], v[196:199], a[148:151], v[112:115]
buffer_load_dwordx4 a[120:123], v1, s[44:47], s63 offen offset:2048 sc1
M v[116:119], v[204:207], a[148:151], v[116:119]
M v[116:119], v[200:203], a[144:147], v[116:119]
ds_read_b64_tr_b16 a[72:73], v21 offset:49152
ds_read_b64_tr_b16 a[74:75], v21 offset:53248
M v[120:123], v[208:211], a[144:147], v[120:123]
M v[120:123], v[212:215], a[148:151], v[120:123]
buffer_load_dwordx4 a[124:127], v1, s[44:47], s63 offen offset:3072 sc1
M v[124:127], v[220:223], a[148:151], v[124:127]
M v[124:127], v[216:219], a[144:147], v[124:127]
ds_read_b64_tr_b16 a[76:77], v21 offset:57344
ds_read_b64_tr_b16 a[78:79], v21 offset:61440
M v[128:131], v[160:163], a[152:155], v[128:131]
M v[128:131], v[164:167], a[156:159], v[128:131]
s_sub_u32 s39, s39, 1
s_cmp_eq_u32 s39, 0
s_cselect_b32 s3, s64, s65
M v[132:135], v[172:175], a[156:159], v[132:135]
M v[132:135], v[168:171], a[152:155], v[132:135]
ds_read_b64_tr_b16 a[80:81], v22 offset:49152
ds_read_b64_tr_b16 a[82:83], v22 offset:53248
M v[136:139], v[176:179], a[152:155], v[136:139]
M v[136:139], v[180:183], a[156:159], v[136:139]
s_add_u32 s25, s25, s3
s_lshl_b32 s3, s3, 3
s_add_u32 s26, s26, s3
M v[140:143], v[188:191], a[156:159], v[140:143]
M v[140:143], v[184:187], a[152:155], v[140:143]
ds_read_b64_tr_b16 a[84:85], v22 offset:57344
ds_read_b64_tr_b16 a[86:87], v22 offset:61440
M v[144:147], v[192:195], a[152:155], v[144:147]
M v[144:147], v[196:199], a[156:159], v[144:147]
ds_read_b64_tr_b16 a[88:89], v23 offset:49152
ds_read_b64_tr_b16 a[90:91], v23 offset:53248
M v[148:151], v[204:207], a[156:159], v[148:151]
M v[148:151], v[200:203], a[152:155], v[148:151]
ds_read_b64_tr_b16 a[92:93], v23 offset:57344
ds_read_b64_tr_b16 a[94:95], v23 offset:61440
M v[152:155], v[208:211], a[152:155], v[152:155]
M v[152:155], v[212:215], a[156:159], v[152:155]
M v[156:159], v[220:223], a[156:159], v[156:159]
M v[156:159], v[216:219], a[152:155], v[156:159]
s_waitcnt vmcnt(24) lgkmcnt(0)
s_barrier
M v[32:35], a[32:35], a[160:163], v[32:35]
s_add_u32 m0, s41, 49152
s_nop 0
buffer_load_dwordx4 v2, s[48:51], s26 offen offset:0 lds
M v[32:35], a[36:39], a[164:167], v[32:35]
M v[36:39], a[44:47], a[164:167], v[36:39]
ds_read_b64_tr_b16 v[160:161], v8 offset:0
ds_read_b64_tr_b16 v[162:163], v8 offset:4096
M v[36:39], a[40:43], a[160:163], v[36:39]
M v[40:43], a[48:51], a[160:163], v[40:43]
buffer_load_dwordx4 v3, s[48:51], s26 offen offset:1024 lds
M v[40:43], a[52:55], a[164:167], v[40:43]
M v[44:47], a[60:63], a[164:167], v[44:47]
ds_read_b64_tr_b16 v[164:165], v8 offset:8192
ds_read_b64_tr_b16 v[166:167], v8 offset:12288
M v[44:47], a[56:59], a[160:163], v[44:47]
M v[48:51], a[64:67], a[160:163], v[48:51]
buffer_load_dwordx4 v4, s[48:51], s26 offen offset:2048 lds
M v[48:51], a[68:71], a[164:167], v[48:51]
M v[52:55], a[76:79], a[164:167], v[52:55]
ds_read_b64_tr_b16 v[168:169], v9 offset:0
ds_read_b64_tr_b16 v[170:171], v9 offset:4096
M v[52:55], a[72:75], a[160:163], v[52:55]
M v[56:59], a[80:83], a[160:163], v[56:59]
buffer_load_dwordx4 v5, s[48:51], s26 offen offset:3072 lds
M v[56:59], a[84:87], a[164:167], v[56:59]
M v[60:63], a[92:95], a[164:167], v[60:63]
ds_read_b64_tr_b16 v[172:173], v9 offset:8192
ds_read_b64_tr_b16 v[174:175], v9 offset:12288
M v[60:63], a[88:91], a[160:163], v[60:63]
M v[64:67], a[32:35], a[168:171], v[64:67]
buffer_load_dwordx4 a[128:131], v1, s[44:47], s25 offen offset:0 sc1
M v[64:67], a[36:39], a[172:175], v[64:67]
M v[68:71], a[44:47], a[172:175], v[68:71]
ds_read_b64_tr_b16 v[176:177], v10 offset:0
ds_read_b64_tr_b16 v[178:179], v10 offset:4096
M v[68:71], a[40:43], a[168:171], v[68:71]
M v[72:75], a[48:51], a[168:171], v[72:75]
buffer_load_dwordx4 a[132:135], v1, s[44:47], s25 offen offset:1024 sc1
M v[72:75], a[52:55], a[172:175], v[72:75]
M v[76:79], a[60:63], a[172:175], v[76:79]
ds_read_b64_tr_b16 v[180:181], v10 offset:8192
ds_read_b64_tr_b16 v[182:183], v10 offset:12288
M v[76:79], a[56:59], a[168:171], v[76:79]
M v[80:83], a[64:67], a[168:171], v[80:83]
buffer_load_dwordx4 a[136:139], v1, s[44:47], s25 offen offset:2048 sc1
M v[80:83], a[68:71], a[172:175], v[80:83]
M v[84:87], a[76:79], a[172:175], v[84:87]
ds_read_b64_tr_b16 v[184:185], v11 offset:0
ds_read_b64_tr_b16 v[186:187], v11 offset:4096
M v[84:87], a[72:75], a[168:171], v[84:87]
M v[88:91], a[80:83], a[168:171], v[88:91]
buffer_load_dwordx4 a[140:143], v1, s[44:47], s25 offen offset:3072 sc1
M v[88:91], a[84:87], a[172:175], v[88:91]
M v[92:95], a[92:95], a[172:175], v[92:95]
M v[92:95], a[88:91], a[168:171], v[92:95]
ds_read_b64_tr_b16 v[188:189], v11 offset:8192
ds_read_b64_tr_b16 v[190:191], v11 offset:12288
M v[96:99], a[32:35], a[176:179], v[96:99]
M v[96:99], a[36:39], a[180:183], v[96:99]
s_add_u32 s63, s25, 4096
buffer_load_dwordx4 a[144:147], v1, s[44:47], s63 offen offset:0 sc1
M v[100:103], a[44:47], a[180:183], v[100:103]
M v[100:103], a[40:43], a[176:179], v[100:103]
ds_read_b64_tr_b16 v[192:193], v12 offset:0
ds_read_b64_tr_b16 v[194:195], v12 offset:4096
M v[104:107], a[48:51], a[176:179], v[104:107]
M v[104:107], a[52:55], a[180:183], v[104:107]
buffer_load_dwordx4 a[148:151], v1, s[44:47], s63 offen offset:1024 sc1
M v[108:111], a[60:63], a[180:183], v[108:111]
M v[108:111], a[56:59], a[176:179], v[108:111]
ds_read_b64_tr_b16 v[196:197], v12 offset:8192
ds_read_b64_tr_b16 v[198:199], v12 offset:12288
M v[112:115], a[64:67], a[176:179], v[112:115]
M v[112:115], a[68:71], a[180:183], v[112:115]
buffer_load_dwordx4 a[152:155], v1, s[44:47], s63 offen offset:2048 sc1
M v[116:119], a[76:79], a[180:183], v[116:119]
M v[116:119], a[72:75], a[176:179], v[116:119]
ds_read_b64_tr_b16 v[200:201], v13 offset:0
ds_read_b64_tr_b16 v[202:203], v13 offset:4096
M v[120:123], a[80:83], a[176:179], v[120:123]
M v[120:123], a[84:87], a[180:183], v[120:123]
buffer_load_dwordx4 a[156:159], v1, s[44:47], s63 offen offset:3072 sc1
M v[124:127], a[92:95], a[180:183], v[124:127]
M v[124:127], a[88:91], a[176:179], v[124:127]
ds_read_b64_tr_b16 v[204:205], v13 offset:8192
ds_read_b64_tr_b16 v[206:207], v13 offset:12288
M v[128:131], a[32:35], a[184:187], v[128:131]
M v[128:131], a[36:39], a[188:191], v[128:131]
s_sub_u32 s39, s39, 1
s_cmp_eq_u32 s39, 0
s_cselect_b32 s3, s64, s65
M v[132:135], a[44:47], a[188:191], v[132:135]
M v[132:135], a[40:43], a[184:187], v[132:135]
ds_read_b64_tr_b16 v[208:209], v14 offset:0
ds_read_b64_tr_b16 v[210:211], v14 offset:4096
M v[136:139], a[48:51], a[184:187], v[136:139]
M v[136:139], a[52:55], a[188:191], v[136:139]
s_add_u32 s25, s25, s3
s_lshl_b32 s3, s3, 3
s_add_u32 s26, s26, s3
M v[140:143], a[60:63], a[188:191], v[140:143]
M v[140:143], a[56:59], a[184:187], v[140:143]
ds_read_b64_tr_b16 v[212:213], v14 offset:8192
ds_read_b64_tr_b16 v[214:215], v14 offset:12288
M v[144:147], a[64:67], a[184:187], v[144:147]
M v[144:147], a[68:71], a[188:191], v[144:147]
ds_read_b64_tr_b16 v[216:217], v15 offset:0
ds_read_b64_tr_b16 v[218:219], v15 offset:4096
M v[148:151], a[76:79], a[188:191], v[148:151]
M v[148:151], a[72:75], a[184:187], v[148:151]
ds_read_b64_tr_b16 v[220:221], v15 offset:8192
ds_read_b64_tr_b16 v[222:223], v15 offset:12288
M v[152:155], a[80:83], a[184:187], v[152:155]
M v[152:155], a[84:87], a[188:191], v[152:155]
M v[156:159], a[92:95], a[188:191], v[156:159]
M v[156:159], a[88:91], a[184:187], v[156:159]
s_waitcnt vmcnt(24) lgkmcnt(0)
s_barrier
M v[32:35], v[160:163], a[192:195], v[32:35]
s_add_u32 m0, s41, 65536
s_nop 0
buffer_load_dwordx4 v2, s[48:51], s26 offen offset:0 lds
M v[32:35], v[164:167], a[196:199], v[32:35]
M v[36:39], v[172:175], a[196:199], v[36:39]
ds_read_b64_tr_b16 a[32:33], v8 offset:16384
ds_read_b64_tr_b16 a[34:35], v8 offset:20480
M v[36:39], v[168:171], a[192:195], v[36:39]
M v[40:43], v[176:179], a[192:195], v[40:43]
buffer_load_dwordx4 v3, s[48:51], s26 offen offset:1024 lds
M v[40:43], v[180:183], a[196:199], v[40:43]
M v[44:47], v[188:191], a[196:199], v[44:47]
ds_read_b64_tr_b16 a[36:37], v8 offset:24576
ds_read_b64_tr_b16 a[38:39], v8 offset:28672
M v[44:47], v[184:187], a[192:195], v[44:47]
M v[48:51], v[192:195], a[192:195], v[48:51]
buffer_load_dwordx4 v4, s[48:51], s26 offen offset:2048 lds
M v[48:51], v[196:199], a[196:199], v[48:51]
M v[52:55], v[204:207], a[196:199], v[52:55]
ds_read_b64_tr_b16 a[40:41], v9 offset:16384
ds_read_b64_tr_b16 a[42:43], v9 offset:20480
M v[52:55], v[200:203], a[192:195], v[52:55]
M v[56:59], v[208:211], a[192:195], v[56:59]
buffer_load_dwordx4 v5, s[48:51], s26 offen offset:3072 lds
M v[56:59], v[212:215], a[196:199], v[56:59]
M v[60:63], v[220:223], a[196:199], v[60:63]
ds_read_b64_tr_b16 a[44:45], v9 offset:24576
ds_read_b64_tr_b16 a[46:47], v9 offset:28672
M v[60:63], v[216:219], a[192:195], v[60:63]
M v[64:67], v[160:163], a[200:203], v[64:67]
buffer_load_dwordx4 a[160:163], v1, s[44:47], s25 offen offset:0 sc1
M v[64:67], v[164:167], a[204:207], v[64:67]
M v[68:71], v[172:175], a[204:207], v[68:71]
ds_read_b64_tr_b16 a[48:49], v10 offset:16384
ds_read_b64_tr_b16 a[50:51], v10 offset:20480
M v[68:71], v[168:171], a[200:203], v[68:71]
M v[72:75], v[176:179], a[200:203], v[72:75]
buffer_load_dwordx4 a[164:167], v1, s[44:47], s25 offen offset:1024 sc1
M v[72:75], v[180:183], a[204:207], v[72:75]
M v[76:79], v[188:191], a[204:207], v[76:79]
ds_read_b64_tr_b16 a[52:53], v10 offset:24576
ds_read_b64_tr_b16 a[54:55], v10 offset:28672
M v[76:79], v[184:187], a[200:203], v[76:79]
M v[80:83], v[192:195], a[200:203], v[80:83]
buffer_load_dwordx4 a[168:171], v1, s[44:47], s25 offen offset:2048 sc1
M v[80:83], v[196:199], a[204:207], v[80:83]
M v[84:87], v[204:207], a[204:207], v[84:87]
ds_read_b64_tr_b16 a[56:57], v11 offset:16384
ds_read_b64_tr_b16 a[58:59], v11 offset:20480
M v[84:87], v[200:203], a[200:203], v[84:87]
M v[88:91], v[208:211], a[200:203], v[88:91]
buffer_load_dwordx4 a[172:175], v1, s[44:47], s25 offen offset:3072 sc1
M v[88:91], v[212:215], a[204:207], v[88:91]
M v[92:95], v[220:223], a[204:207], v[92:95]
M v[92:95], v[216:219], a[200:203], v[92:95]
ds_read_b64_tr_b16 a[60:61], v11 offset:24576
ds_read_b64_tr_b16 a[62:63], v11 offset:28672
M v[96:99], v[160:163], a[208:211], v[96:99]
M v[96:99], v[164:167], a[212:215], v[96:99]
s_add_u32 s63, s25, 4096
buffer_load_dwordx4 a[176:179], v1, s[44:47], s63 offen offset:0 sc1
M v[100:103], v[172:175], a[212:215], v[100:103]
M v[100:103], v[168:171], a[208:211], v[100:103]
ds_read_b64_tr_b16 a[64:65], v12 offset:16384
ds_read_b64_tr_b16 a[66:67], v12 offset:20480
M v[104:107], v[176:179], a[208:211], v[104:107]
M v[104:107], v[180:183], a[212:215], v[104:107]
buffer_load_dwordx4 a[180:183], v1, s[44:47], s63 offen offset:1024 sc1
M v[108:111], v[188:191], a[212:215], v[108:111]
M v[108:111], v[184:187], a[208:211], v[108:111]
ds_read_b64_tr_b16 a[68:69], v12 offset:24576
ds_read_b64_tr_b16 a[70:71], v12 offset:28672
M v[112:115], v[192:195], a[208:211], v[112:115]
M v[112:115], v[196:199], a[212:215], v[112:115]
buffer_load_dwordx4 a[184:187], v1, s[44:47], s63 offen offset:2048 sc1
M v[116:119], v[204:207], a[212:215], v[116:119]
M v[116:119], v[200:203], a[208:211], v[116:119]
ds_read_b64_tr_b16 a[72:73], v13 offset:16384
ds_read_b64_tr_b16 a[74:75], v13 offset:20480
M v[120:123], v[208:211], a[208:211], v[120:123]
M v[120:123], v[212:215], a[212:215], v[120:123]
buffer_load_dwordx4 a[188:191], v1, s[44:47], s63 offen offset:3072 sc1
M v[124:127], v[220:223], a[212:215], v[124:127]
M v[124:127], v[216:219], a[208:211], v[124:127]
ds_read_b64_tr_b16 a[76:77], v13 offset:24576
ds_read_b64_tr_b16 a[78:79], v13 offset:28672
M v[128:131], v[160:163], a[216:219], v[128:131]
M v[128:131], v[164:167], a[220:223], v[128:131]
s_sub_u32 s39, s39, 1
s_cmp_eq_u32 s39, 0
s_cselect_b32 s3, s64, s65
M v[132:135], v[172:175], a[220:223], v[132:135]
M v[132:135], v[168:171], a[216:219], v[132:135]
ds_read_b64_tr_b16 a[80:81], v14 offset:16384
ds_read_b64_tr_b16 a[82:83], v14 offset:20480
M v[136:139], v[176:179], a[216:219], v[136:139]
M v[136:139], v[180:183], a[220:223], v[136:139]
s_add_u32 s25, s25, s3
s_lshl_b32 s3, s3, 3
s_add_u32 s26, s26, s3
M v[140:143], v[188:191], a[220:223], v[140:143]
M v[140:143], v[184:187], a[216:219], v[140:143]
ds_read_b64_tr_b16 a[84:85], v14 offset:24576
ds_read_b64_tr_b16 a[86:87], v14 offset:28672
M v[144:147], v[192:195], a[216:219], v[144:147]
M v[144:147], v[196:199], a[220:223], v[144:147]
ds_read_b64_tr_b16 a[88:89], v15 offset:16384
ds_read_b64_tr_b16 a[90:91], v15 offset:20480
M v[148:151], v[204:207], a[220:223], v[148:151]
M v[148:151], v[200:203], a[216:219], v[148:151]
ds_read_b64_tr_b16 a[92:93], v15 offset:24576
ds_read_b64_tr_b16 a[94:95], v15 offset:28672
M v[152:155], v[208:211], a[216:219], v[152:155]
M v[152:155], v[212:215], a[220:223], v[152:155]
M v[156:159], v[220:223], a[220:223], v[156:159]
M v[156:159], v[216:219], a[216:219], v[156:159]
s_waitcnt vmcnt(24) lgkmcnt(0)
s_barrier
M v[32:35], a[32:35], a[224:227], v[32:35]
s_add_u32 m0, s41, 81920
s_nop 0
buffer_load_dwordx4 v2, s[48:51], s26 offen offset:0 lds
M v[32:35], a[36:39], a[228:231], v[32:35]
M v[36:39], a[44:47], a[228:231], v[36:39]
ds_read_b64_tr_b16 v[160:161], v8 offset:32768
ds_read_b64_tr_b16 v[162:163], v8 offset:36864
M v[36:39], a[40:43], a[224:227], v[36:39]
M v[40:43], a[48:51], a[224:227], v[40:43]
buffer_load_dwordx4 v3, s[48:51], s26 offen offset:1024 lds
M v[40:43], a[52:55], a[228:231], v[40:43]
M v[44:47], a[60:63], a[228:231], v[44:47]
ds_read_b64_tr_b16 v[164:165], v8 offset:40960
ds_read_b64_tr_b16 v[166:167], v8 offset:45056
M v[44:47], a[56:59], a[224:227], v[44:47]
M v[48:51], a[64:67], a[224:227], v[48:51]
buffer_load_dwordx4 v4, s[48:51], s26 offen offset:2048 lds
M v[48:51], a[68:71], a[228:231], v[48:51]
M v[52:55], a[76:79], a[228:231], v[52:55]
ds_read_b64_tr_b16 v[168:169], v9 offset:32768
ds_read_b64_tr_b16 v[170:171], v9 offset:36864
M v[52:55], a[72:75], a[224:227], v[52:55]
M v[56:59], a[80:83], a[224:227], v[56:59]
buffer_load_dwordx4 v5, s[48:51], s26 offen offset:3072 lds
M v[56:59], a[84:87], a[228:231], v[56:59]
M v[60:63], a[92:95], a[228:231], v[60:63]
ds_read_b64_tr_b16 v[172:173], v9 offset:40960
ds_read_b64_tr_b16 v[174:175], v9 offset:45056
M v[60:63], a[88:91], a[224:227], v[60:63]
M v[64:67], a[32:35], a[232:235], v[64:67]
buffer_load_dwordx4 a[192:195], v1, s[44:47], s25 offen offset:0 sc1
M v[64:67], a[36:39], a[236:239], v[64:67]
M v[68:71], a[44:47], a[236:239], v[68:71]
ds_read_b64_tr_b16 v[176:177], v10 offset:32768
ds_read_b64_tr_b16 v[178:179], v10 offset:36864
M v[68:71], a[40:43], a[232:235], v[68:71]
M v[72:75], a[48:51], a[232:235], v[72:75]
buffer_load_dwordx4 a[196:199], v1, s[44:47], s25 offen offset:1024 sc1
M v[72:75], a[52:55], a[236:239], v[72:75]
M v[76:79], a[60:63], a[236:239], v[76:79]
ds_read_b64_tr_b16 v[180:181], v10 offset:40960
ds_read_b64_tr_b16 v[182:183], v10 offset:45056
M v[76:79], a[56:59], a[232:235], v[76:79]
M v[80:83], a[64:67], a[232:235], v[80:83]
buffer_load_dwordx4 a[200:203], v1, s[44:47], s25 offen offset:2048 sc1
M v[80:83], a[68:71], a[236:239], v[80:83]
M v[84:87], a[76:79], a[236:239], v[84:87]
ds_read_b64_tr_b16 v[184:185], v11 offset:32768
ds_read_b64_tr_b16 v[186:187], v11 offset:36864
M v[84:87], a[72:75], a[232:235], v[84:87]
M v[88:91], a[80:83], a[232:235], v[88:91]
buffer_load_dwordx4 a[204:207], v1, s[44:47], s25 offen offset:3072 sc1
M v[88:91], a[84:87], a[236:239], v[88:91]
M v[92:95], a[92:95], a[236:239], v[92:95]
M v[92:95], a[88:91], a[232:235], v[92:95]
ds_read_b64_tr_b16 v[188:189], v11 offset:40960
ds_read_b64_tr_b16 v[190:191], v11 offset:45056
M v[96:99], a[32:35], a[240:243], v[96:99]
M v[96:99], a[36:39], a[244:247], v[96:99]
s_add_u32 s63, s25, 4096
buffer_load_dwordx4 a[208:211], v1, s[44:47], s63 offen offset:0 sc1
M v[100:103], a[44:47], a[244:247], v[100:103]
M v[100:103], a[40:43], a[240:243], v[100:103]
ds_read_b64_tr_b16 v[192:193], v12 offset:32768
ds_read_b64_tr_b16 v[194:195], v12 offset:36864
M v[104:107], a[48:51], a[240:243], v[104:107]
M v[104:107], a[52:55], a[244:247], v[104:107]
buffer_load_dwordx4 a[212:215], v1, s[44:47], s63 offen offset:1024 sc1
M v[108:111], a[60:63], a[244:247], v[108:111]
M v[108:111], a[56:59], a[240:243], v[108:111]
ds_read_b64_tr_b16 v[196:197], v12 offset:40960
ds_read_b64_tr_b16 v[198:199], v12 offset:45056
M v[112:115], a[64:67], a[240:243], v[112:115]
M v[112:115], a[68:71], a[244:247], v[112:115]
buffer_load_dwordx4 a[216:219], v1, s[44:47], s63 offen offset:2048 sc1
M v[116:119], a[76:79], a[244:247], v[116:119]
M v[116:119], a[72:75], a[240:243], v[116:119]
ds_read_b64_tr_b16 v[200:201], v13 offset:32768
ds_read_b64_tr_b16 v[202:203], v13 offset:36864
M v[120:123], a[80:83], a[240:243], v[120:123]
M v[120:123], a[84:87], a[244:247], v[120:123]
buffer_load_dwordx4 a[220:223], v1, s[44:47], s63 offen offset:3072 sc1
M v[124:127], a[92:95], a[244:247], v[124:127]
M v[124:127], a[88:91], a[240:243], v[124:127]
ds_read_b64_tr_b16 v[204:205], v13 offset:40960
ds_read_b64_tr_b16 v[206:207], v13 offset:45056
M v[128:131], a[32:35], a[248:251], v[128:131]
M v[128:131], a[36:39], a[252:255], v[128:131]
s_sub_u32 s39, s39, 1
s_cmp_eq_u32 s39, 0
s_cselect_b32 s3, s64, s65
M v[132:135], a[44:47], a[252:255], v[132:135]
M v[132:135], a[40:43], a[248:251], v[132:135]
ds_read_b64_tr_b16 v[208:209], v14 offset:32768
ds_read_b64_tr_b16 v[210:211], v14 offset:36864
M v[136:139], a[48:51], a[248:251], v[136:139]
M v[136:139], a[52:55], a[252:255], v[136:139]
s_add_u32 s25, s25, s3
s_lshl_b32 s3, s3, 3
s_add_u32 s26, s26, s3
M v[140:143], a[60:63], a[252:255], v[140:143]
M v[140:143], a[56:59], a[248:251], v[140:143]
ds_read_b64_tr_b16 v[212:213], v14 offset:40960
ds_read_b64_tr_b16 v[214:215], v14 offset:45056
M v[144:147], a[64:67], a[248:251], v[144:147]
M v[144:147], a[68:71], a[252:255], v[144:147]
ds_read_b64_tr_b16 v[216:217], v15 offset:32768
ds_read_b64_tr_b16 v[218:219], v15 offset:36864
M v[148:151], a[76:79], a[252:255], v[148:151]
M v[148:151], a[72:75], a[248:251], v[148:151]
ds_read_b64_tr_b16 v[220:221], v15 offset:40960
ds_read_b64_tr_b16 v[222:223], v15 offset:45056
M v[152:155], a[80:83], a[248:251], v[152:155]
M v[152:155], a[84:87], a[252:255], v[152:155]
M v[156:159], a[92:95], a[252:255], v[156:159]
M v[156:159], a[88:91], a[248:251], v[156:159]
s_waitcnt vmcnt(24) lgkmcnt(0)
s_barrier
M v[32:35], v[160:163], a[96:99], v[32:35]
s_add_u32 m0, s41, 98304
s_nop 0
buffer_load_dwordx4 v2, s[48:51], s26 offen offset:0 lds
M v[32:35], v[164:167], a[100:103], v[32:35]
M v[36:39], v[172:175], a[100:103], v[36:39]
ds_read_b64_tr_b16 a[32:33], v8 offset:49152
ds_read_b64_tr_b16 a[34:35], v8 offset:53248
M v[36:39], v[168:171], a[96:99], v[36:39]
M v[40:43], v[176:179], a[96:99], v[40:43]
buffer_load_dwordx4 v3, s[48:51], s26 offen offset:1024 lds
M v[40:43], v[180:183], a[100:103], v[40:43]
M v[44:47], v[188:191], a[100:103], v[44:47]
ds_read_b64_tr_b16 a[36:37], v8 offset:57344
ds_read_b64_tr_b16 a[38:39], v8 offset:61440
M v[44:47], v[184:187], a[96:99], v[44:47]
M v[48:51], v[192:195], a[96:99], v[48:51]
buffer_load_dwordx4 v4, s[48:51], s26 offen offset:2048 lds
M v[48:51], v[196:199], a[100:103], v[48:51]
M v[52:55], v[204:207], a[100:103], v[52:55]
ds_read_b64_tr_b16 a[40:41], v9 offset:49152
ds_read_b64_tr_b16 a[42:43], v9 offset:53248
M v[52:55], v[200:203], a[96:99], v[52:55]
M v[56:59], v[208:211], a[96:99], v[56:59]
buffer_load_dwordx4 v5, s[48:51], s26 offen offset:3072 lds
M v[56:59], v[212:215], a[100:103], v[56:59]
M v[60:63], v[220:223], a[100:103], v[60:63]
ds_read_b64_tr_b16 a[44:45], v9 offset:57344
ds_read_b64_tr_b16 a[46:47], v9 offset:61440
M v[60:63], v[216:219], a[96:99], v[60:63]
M v[64:67], v[160:163], a[104:107], v[64:67]
buffer_load_dwordx4 a[224:227], v1, s[44:47], s25 offen offset:0 sc1
M v[64:67], v[164:167], a[108:111], v[64:67]
M v[68:71], v[172:175], a[108:111], v[68:71]
ds_read_b64_tr_b16 a[48:49], v10 offset:49152
ds_read_b64_tr_b16 a[50:51], v10 offset:53248
M v[68:71], v[168:171], a[104:107], v[68:71]
M v[72:75], v[176:179], a[104:107], v[72:75]
buffer_load_dwordx4 a[228:231], v1, s[44:47], s25 offen offset:1024 sc1
M v[72:75], v[180:183], a[108:111], v[72:75]
M v[76:79], v[188:191], a[108:111], v[76:79]
ds_read_b64_tr_b16 a[52:53], v10 offset:57344
ds_read_b64_tr_b16 a[54:55], v10 offset:61440
M v[76:79], v[184:187], a[104:107], v[76:79]
M v[80:83], v[192:195], a[104:107], v[80:83]
buffer_load_dwordx4 a[232:235], v1, s[44:47], s25 offen offset:2048 sc1
M v[80:83], v[196:199], a[108:111], v[80:83]
M v[84:87], v[204:207], a[108:111], v[84:87]
ds_read_b64_tr_b16 a[56:57], v11 offset:49152
ds_read_b64_tr_b16 a[58:59], v11 offset:53248
M v[84:87], v[200:203], a[104:107], v[84:87]
M v[88:91], v[208:211], a[104:107], v[88:91]
buffer_load_dwordx4 a[236:239], v1, s[44:47], s25 offen offset:3072 sc1
M v[88:91], v[212:215], a[108:111], v[88:91]
M v[92:95], v[220:223], a[108:111], v[92:95]
M v[92:95], v[216:219], a[104:107], v[92:95]
ds_read_b64_tr_b16 a[60:61], v11 offset:57344
ds_read_b64_tr_b16 a[62:63], v11 offset:61440
M v[96:99], v[160:163], a[112:115], v[96:99]
M v[96:99], v[164:167], a[116:119], v[96:99]
s_add_u32 s63, s25, 4096
buffer_load_dwordx4 a[240:243], v1, s[44:47], s63 offen offset:0 sc1
M v[100:103], v[172:175], a[116:119], v[100:103]
M v[100:103], v[168:171], a[112:115], v[100:103]
ds_read_b64_tr_b16 a[64:65], v12 offset:49152
ds_read_b64_tr_b16 a[66:67], v12 offset:53248
M v[104:107], v[176:179], a[112:115], v[104:107]
M v[104:107], v[180:183], a[116:119], v[104:107]
buffer_load_dwordx4 a[244:247], v1, s[44:47], s63 offen offset:1024 sc1
M v[108:111], v[188:191], a[116:119], v[108:111]
M v[108:111], v[184:187], a[112:115], v[108:111]
ds_read_b64_tr_b16 a[68:69], v12 offset:57344
ds_read_b64_tr_b16 a[70:71], v12 offset:61440
M v[112:115], v[192:195], a[112:115], v[112:115]
M v[112:115], v[196:199], a[116:119], v[112:115]
buffer_load_dwordx4 a[248:251], v1, s[44:47], s63 offen offset:2048 sc1
M v[116:119], v[204:207], a[116:119], v[116:119]
M v[116:119], v[200:203], a[112:115], v[116:119]
ds_read_b64_tr_b16 a[72:73], v13 offset:49152
ds_read_b64_tr_b16 a[74:75], v13 offset:53248
M v[120:123], v[208:211], a[112:115], v[120:123]
M v[120:123], v[212:215], a[116:119], v[120:123]
buffer_load_dwordx4 a[252:255], v1, s[44:47], s63 offen offset:3072 sc1
M v[124:127], v[220:223], a[116:119], v[124:127]
M v[124:127], v[216:219], a[112:115], v[124:127]
ds_read_b64_tr_b16 a[76:77], v13 offset:57344
ds_read_b64_tr_b16 a[78:79], v13 offset:61440
M v[128:131], v[160:163], a[120:123], v[128:131]
M v[128:131], v[164:167], a[124:127], v[128:131]
s_sub_u32 s39, s39, 1
s_cmp_eq_u32 s39, 0
s_cselect_b32 s3, s64, s65
M v[132:135], v[172:175], a[124:127], v[132:135]
M v[132:135], v[168:171], a[120:123], v[132:135]
ds_read_b64_tr_b16 a[80:81], v14 offset:49152
ds_read_b64_tr_b16 a[82:83], v14 offset:53248
M v[136:139], v[176:179], a[120:123], v[136:139]
M v[136:139], v[180:183], a[124:127], v[136:139]
s_add_u32 s25, s25, s3
s_lshl_b32 s3, s3, 3
s_add_u32 s26, s26, s3
M v[140:143], v[188:191], a[124:127], v[140:143]
M v[140:143], v[184:187], a[120:123], v[140:143]
ds_read_b64_tr_b16 a[84:85], v14 offset:57344
ds_read_b64_tr_b16 a[86:87], v14 offset:61440
M v[144:147], v[192:195], a[120:123], v[144:147]
M v[144:147], v[196:199], a[124:127], v[144:147]
ds_read_b64_tr_b16 a[88:89], v15 offset:49152
ds_read_b64_tr_b16 a[90:91], v15 offset:53248
M v[148:151], v[204:207], a[124:127], v[148:151]
M v[148:151], v[200:203], a[120:123], v[148:151]
ds_read_b64_tr_b16 a[92:93], v15 offset:57344
ds_read_b64_tr_b16 a[94:95], v15 offset:61440
M v[152:155], v[208:211], a[120:123], v[152:155]
M v[152:155], v[212:215], a[124:127], v[152:155]
M v[156:159], v[220:223], a[124:127], v[156:159]
M v[156:159], v[216:219], a[120:123], v[156:159]
s_waitcnt vmcnt(24) lgkmcnt(0)
s_barrier
M v[32:35], a[32:35], a[128:131], v[32:35]
s_add_u32 m0, s41, 114688
s_nop 0
buffer_load_dwordx4 v2, s[48:51], s26 offen offset:0 lds
M v[32:35], a[36:39], a[132:135], v[32:35]
M v[36:39], a[44:47], a[132:135], v[36:39]
ds_read_b64_tr_b16 v[160:161], v16 offset:0
ds_read_b64_tr_b16 v[162:163], v16 offset:4096
M v[36:39], a[40:43], a[128:131], v[36:39]
M v[40:43], a[48:51], a[128:131], v[40:43]
buffer_load_dwordx4 v3, s[48:51], s26 offen offset:1024 lds
M v[40:43], a[52:55], a[132:135], v[40:43]
M v[44:47], a[60:63], a[132:135], v[44:47]
ds_read_b64_tr_b16 v[164:165], v16 offset:8192
ds_read_b64_tr_b16 v[166:167], v16 offset:12288
M v[44:47], a[56:59], a[128:131], v[44:47]
M v[48:51], a[64:67], a[128:131], v[48:51]
buffer_load_dwordx4 v4, s[48:51], s26 offen offset:2048 lds
M v[48:51], a[68:71], a[132:135], v[48:51]
M v[52:55], a[76:79], a[132:135], v[52:55]
ds_read_b64_tr_b16 v[168:169], v17 offset:0
ds_read_b64_tr_b16 v[170:171], v17 offset:4096
M v[52:55], a[72:75], a[128:131], v[52:55]
M v[56:59], a[80:83], a[128:131], v[56:59]
buffer_load_dwordx4 v5, s[48:51], s26 offen offset:3072 lds
M v[56:59], a[84:87], a[132:135], v[56:59]
M v[60:63], a[92:95], a[132:135], v[60:63]
ds_read_b64_tr_b16 v[172:173], v17 offset:8192
ds_read_b64_tr_b16 v[174:175], v17 offset:12288
M v[60:63], a[88:91], a[128:131], v[60:63]
M v[64:67], a[32:35], a[136:139], v[64:67]
buffer_load_dwordx4 a[96:99], v1, s[44:47], s25 offen offset:0 sc1
M v[64:67], a[36:39], a[140:143], v[64:67]
M v[68:71], a[44:47], a[140:143], v[68:71]
ds_read_b64_tr_b16 v[176:177], v18 offset:0
ds_read_b64_tr_b16 v[178:179], v18 offset:4096
M v[68:71], a[40:43], a[136:139], v[68:71]
M v[72:75], a[48:51], a[136:139], v[72:75]
buffer_load_dwordx4 a[100:103], v1, s[44:47], s25 offen offset:1024 sc1
M v[72:75], a[52:55], a[140:143], v[72:75]
M v[76:79], a[60:63], a[140:143], v[76:79]
ds_read_b64_tr_b16 v[180:181], v18 offset:8192
ds_read_b64_tr_b16 v[182:183], v18 offset:12288
M v[76:79], a[56:59], a[136:139], v[76:79]
M v[80:83], a[64:67], a[136:139], v[80:83]
buffer_load_dwordx4 a[104:107], v1, s[44:47], s25 offen offset:2048 sc1
M v[80:83], a[68:71], a[140:143], v[80:83]
M v[84:87], a[76:79], a[140:143], v[84:87]
ds_read_b64_tr_b16 v[184:185], v19 offset:0
ds_read_b64_tr_b16 v[186:187], v19 offset:4096
M v[84:87], a[72:75], a[136:139], v[84:87]
M v[88:91], a[80:83], a[136:139], v[88:91]
buffer_load_dwordx4 a[108:111], v1, s[44:47], s25 offen offset:3072 sc1
M v[88:91], a[84:87], a[140:143], v[88:91]
M v[92:95], a[92:95], a[140:143], v[92:95]
M v[92:95], a[88:91], a[136:139], v[92:95]
ds_read_b64_tr_b16 v[188:189], v19 offset:8192
ds_read_b64_tr_b16 v[190:191], v19 offset:12288
M v[96:99], a[32:35], a[144:147], v[96:99]
M v[96:99], a[36:39], a[148:151], v[96:99]
s_add_u32 s63, s25, 4096
buffer_load_dwordx4 a[112:115], v1, s[44:47], s63 offen offset:0 sc1
M v[100:103], a[44:47], a[148:151], v[100:103]
M v[100:103], a[40:43], a[144:147], v[100:103]
ds_read_b64_tr_b16 v[192:193], v20 offset:0
ds_read_b64_tr_b16 v[194:195], v20 offset:4096
M v[104:107], a[48:51], a[144:147], v[104:107]
M v[104:107], a[52:55], a[148:151], v[104:107]
buffer_load_dwordx4 a[116:119], v1, s[44:47], s63 offen offset:1024 sc1
M v[108:111], a[60:63], a[148:151], v[108:111]
M v[108:111], a[56:59], a[144:147], v[108:111]
ds_read_b64_tr_b16 v[196:197], v20 offset:8192
ds_read_b64_tr_b16 v[198:199], v20 offset:12288
M v[112:115], a[64:67], a[144:147], v[112:115]
M v[112:115], a[68:71], a[148:151], v[112:115]
buffer_load_dwordx4 a[120:123], v1, s[44:47], s63 offen offset:2048 sc1
M v[116:119], a[76:79], a[148:151], v[116:119]
M v[116:119], a[72:75], a[144:147], v[116:119]
ds_read_b64_tr_b16 v[200:201], v21 offset:0
ds_read_b64_tr_b16 v[202:203], v21 offset:4096
M v[120:123], a[80:83], a[144:147], v[120:123]
M v[120:123], a[84:87], a[148:151], v[120:123]
buffer_load_dwordx4 a[124:127], v1, s[44:47], s63 offen offset:3072 sc1
M v[124:127], a[92:95], a[148:151], v[124:127]
M v[124:127], a[88:91], a[144:147], v[124:127]
ds_read_b64_tr_b16 v[204:205], v21 offset:8192
ds_read_b64_tr_b16 v[206:207], v21 offset:12288
M v[128:131], a[32:35], a[152:155], v[128:131]
M v[128:131], a[36:39], a[156:159], v[128:131]
s_sub_u32 s39, s39, 1
s_cmp_eq_u32 s39, 0
s_cselect_b32 s3, s64, s65
M v[132:135], a[44:47], a[156:159], v[132:135]
M v[132:135], a[40:43], a[152:155], v[132:135]
ds_read_b64_tr_b16 v[208:209], v22 offset:0
ds_read_b64_tr_b16 v[210:211], v22 offset:4096
M v[136:139], a[48:51], a[152:155], v[136:139]
M v[136:139], a[52:55], a[156:159], v[136:139]
s_add_u32 s25, s25, s3
s_lshl_b32 s3, s3, 3
s_add_u32 s26, s26, s3
M v[140:143], a[60:63], a[156:159], v[140:143]
M v[140:143], a[56:59], a[152:155], v[140:143]
ds_read_b64_tr_b16 v[212:213], v22 offset:8192
ds_read_b64_tr_b16 v[214:215], v22 offset:12288
M v[144:147], a[64:67], a[152:155], v[144:147]
M v[144:147], a[68:71], a[156:159], v[144:147]
ds_read_b64_tr_b16 v[216:217], v23 offset:0
ds_read_b64_tr_b16 v[218:219], v23 offset:4096
M v[148:151], a[76:79], a[156:159], v[148:151]
M v[148:151], a[72:75], a[152:155], v[148:151]
ds_read_b64_tr_b16 v[220:221], v23 offset:8192
ds_read_b64_tr_b16 v[222:223], v23 offset:12288
M v[152:155], a[80:83], a[152:155], v[152:155]
M v[152:155], a[84:87], a[156:159], v[152:155]
M v[156:159], a[92:95], a[156:159], v[156:159]
M v[156:159], a[88:91], a[152:155], v[156:159]
s_waitcnt vmcnt(24) lgkmcnt(0)
s_barrier
M v[32:35], v[160:163], a[160:163], v[32:35]
s_mov_b64 s[44:45], s[34:35]
s_mov_b32 s46, 4194304
s_mov_b64 s[48:49], s[36:37]
s_mov_b32 s50, 2097152
s_mov_b32 s25, s32
s_mov_b32 s26, s33
s_add_u32 m0, s42, 0
s_nop 0
buffer_load_dwordx4 v6, s[48:51], s26 offen offset:0 lds
M v[32:35], v[164:167], a[164:167], v[32:35]
M v[36:39], v[172:175], a[164:167], v[36:39]
ds_read_b64_tr_b16 a[32:33], v16 offset:16384
ds_read_b64_tr_b16 a[34:35], v16 offset:20480
M v[36:39], v[168:171], a[160:163], v[36:39]
M v[40:43], v[176:179], a[160:163], v[40:43]
M v[40:43], v[180:183], a[164:167], v[40:43]
buffer_load_dwordx4 v7, s[48:51], s26 offen offset:1024 lds
M v[44:47], v[188:191], a[164:167], v[44:47]
M v[44:47], v[184:187], a[160:163], v[44:47]
M v[48:51], v[192:195], a[160:163], v[48:51]
ds_read_b64_tr_b16 a[36:37], v16 offset:24576
ds_read_b64_tr_b16 a[38:39], v16 offset:28672
M v[48:51], v[196:199], a[164:167], v[48:51]
M v[52:55], v[204:207], a[164:167], v[52:55]
buffer_load_dwordx4 a[128:131], v1, s[44:47], s25 offen offset:0 sc1
M v[52:55], v[200:203], a[160:163], v[52:55]
M v[56:59], v[208:211], a[160:163], v[56:59]
M v[56:59], v[212:215], a[164:167], v[56:59]
ds_read_b64_tr_b16 a[40:41], v17 offset:16384
ds_read_b64_tr_b16 a[42:43], v17 offset:20480
M v[60:63], v[220:223], a[164:167], v[60:63]
M v[60:63], v[216:219], a[160:163], v[60:63]
M v[64:67], v[160:163], a[168:171], v[64:67]
buffer_load_dwordx4 a[132:135], v1, s[44:47], s25 offen offset:1024 sc1
M v[64:67], v[164:167], a[172:175], v[64:67]
M v[68:71], v[172:175], a[172:175], v[68:71]
ds_read_b64_tr_b16 a[44:45], v17 offset:24576
ds_read_b64_tr_b16 a[46:47], v17 offset:28672
M v[68:71], v[168:171], a[168:171], v[68:71]
M v[72:75], v[176:179], a[168:171], v[72:75]
M v[72:75], v[180:183], a[172:175], v[72:75]
buffer_load_dwordx4 a[136:139], v1, s[44:47], s25 offen offset:2048 sc1
M v[76:79], v[188:191], a[172:175], v[76:79]
M v[76:79], v[184:187], a[168:171], v[76:79]
M v[80:83], v[192:195], a[168:171], v[80:83]
ds_read_b64_tr_b16 a[48:49], v18 offset:16384
ds_read_b64_tr_b16 a[50:51], v18 offset:20480
M v[80:83], v[196:199], a[172:175], v[80:83]
M v[84:87], v[204:207], a[172:175], v[84:87]
buffer_load_dwordx4 a[140:143], v1, s[44:47], s25 offen offset:3072 sc1
M v[84:87], v[200:203], a[168:171], v[84:87]
M v[88:91], v[208:211], a[168:171], v[88:91]
M v[88:91], v[212:215], a[172:175], v[88:91]
ds_read_b64_tr_b16 a[52:53], v18 offset:24576
ds_read_b64_tr_b16 a[54:55], v18 offset:28672
M v[92:95], v[220:223], a[172:175], v[92:95]
M v[92:95], v[216:219], a[168:171], v[92:95]
M v[96:99], v[160:163], a[176:179], v[96:99]
s_add_u32 s25, s25, 16384
s_add_u32 s26, s26, 131072
M v[96:99], v[164:167], a[180:183], v[96:99]
M v[100:103], v[172:175], a[180:183], v[100:103]
M v[100:103], v[168:171], a[176:179], v[100:103]
ds_read_b64_tr_b16 a[56:57], v19 offset:16384
ds_read_b64_tr_b16 a[58:59], v19 offset:20480
M v[104:107], v[176:179], a[176:179], v[104:107]
M v[104:107], v[180:183], a[180:183], v[104:107]
ds_read_b64_tr_b16 a[60:61], v19 offset:24576
ds_read_b64_tr_b16 a[62:63], v19 offset:28672
M v[108:111], v[188:191], a[180:183], v[108:111]
M v[108:111], v[184:187], a[176:179], v[108:111]
M v[112:115], v[192:195], a[176:179], v[112:115]
ds_read_b64_tr_b16 a[64:65], v20 offset:16384
ds_read_b64_tr_b16 a[66:67], v20 offset:20480
M v[112:115], v[196:199], a[180:183], v[112:115]
M v[116:119], v[204:207], a[180:183], v[116:119]
M v[116:119], v[200:203], a[176:179], v[116:119]
ds_read_b64_tr_b16 a[68:69], v20 offset:24576
ds_read_b64_tr_b16 a[70:71], v20 offset:28672
M v[120:123], v[208:211], a[176:179], v[120:123]
M v[120:123], v[212:215], a[180:183], v[120:123]
ds_read_b64_tr_b16 a[72:73], v21 offset:16384
ds_read_b64_tr_b16 a[74:75], v21 offset:20480
M v[124:127], v[220:223], a[180:183], v[124:127]
M v[124:127], v[216:219], a[176:179], v[124:127]
M v[128:131], v[160:163], a[184:187], v[128:131]
ds_read_b64_tr_b16 a[76:77], v21 offset:24576
ds_read_b64_tr_b16 a[78:79], v21 offset:28672
M v[128:131], v[164:167], a[188:191], v[128:131]
M v[132:135], v[172:175], a[188:191], v[132:135]
M v[132:135], v[168:171], a[184:187], v[132:135]
ds_read_b64_tr_b16 a[80:81], v22 offset:16384
ds_read_b64_tr_b16 a[82:83], v22 offset:20480
M v[136:139], v[176:179], a[184:187], v[136:139]
M v[136:139], v[180:183], a[188:191], v[136:139]
ds_read_b64_tr_b16 a[84:85], v22 offset:24576
ds_read_b64_tr_b16 a[86:87], v22 offset:28672
M v[140:143], v[188:191], a[188:191], v[140:143]
M v[140:143], v[184:187], a[184:187], v[140:143]
M v[144:147], v[192:195], a[184:187], v[144:147]
ds_read_b64_tr_b16 a[88:89], v23 offset:16384
ds_read_b64_tr_b16 a[90:91], v23 offset:20480
M v[144:147], v[196:199], a[188:191], v[144:147]
M v[148:151], v[204:207], a[188:191], v[148:151]
M v[148:151], v[200:203], a[184:187], v[148:151]
ds_read_b64_tr_b16 a[92:93], v23 offset:24576
ds_read_b64_tr_b16 a[94:95], v23 offset:28672
M v[152:155], v[208:211], a[184:187], v[152:155]
M v[152:155], v[212:215], a[188:191], v[152:155]
M v[156:159], v[220:223], a[188:191], v[156:159]
M v[156:159], v[216:219], a[184:187], v[156:159]
s_waitcnt vmcnt(18) lgkmcnt(0)
s_barrier
M v[32:35], a[32:35], a[192:195], v[32:35]
s_add_u32 m0, s42, 16384
s_nop 0
buffer_load_dwordx4 v6, s[48:51], s26 offen offset:0 lds
M v[32:35], a[36:39], a[196:199], v[32:35]
M v[36:39], a[44:47], a[196:199], v[36:39]
ds_read_b64_tr_b16 v[160:161], v16 offset:32768
ds_read_b64_tr_b16 v[162:163], v16 offset:36864
M v[36:39], a[40:43], a[192:195], v[36:39]
M v[40:43], a[48:51], a[192:195], v[40:43]
M v[40:43], a[52:55], a[196:199], v[40:43]
buffer_load_dwordx4 v7, s[48:51], s26 offen offset:1024 lds
M v[44:47], a[60:63], a[196:199], v[44:47]
M v[44:47], a[56:59], a[192:195], v[44:47]
M v[48:51], a[64:67], a[192:195], v[48:51]
ds_read_b64_tr_b16 v[164:165], v16 offset:40960
ds_read_b64_tr_b16 v[166:167], v16 offset:45056
M v[48:51], a[68:71], a[196:199], v[48:51]
M v[52:55], a[76:79], a[196:199], v[52:55]
buffer_load_dwordx4 a[160:163], v1, s[44:47], s25 offen offset:0 sc1
M v[52:55], a[72:75], a[192:195], v[52:55]
M v[56:59], a[80:83], a[192:195], v[56:59]
M v[56:59], a[84:87], a[196:199], v[56:59]
ds_read_b64_tr_b16 v[168:169], v17 offset:32768
ds_read_b64_tr_b16 v[170:171], v17 offset:36864
M v[60:63], a[92:95], a[196:199], v[60:63]
M v[60:63], a[88:91], a[192:195], v[60:63]
M v[64:67], a[32:35], a[200:203], v[64:67]
buffer_load_dwordx4 a[164:167], v1, s[44:47], s25 offen offset:1024 sc1
M v[64:67], a[36:39], a[204:207], v[64:67]
M v[68:71], a[44:47], a[204:207], v[68:71]
ds_read_b64_tr_b16 v[172:173], v17 offset:40960
ds_read_b64_tr_b16 v[174:175], v17 offset:45056
M v[68:71], a[40:43], a[200:203], v[68:71]
M v[72:75], a[48:51], a[200:203], v[72:75]
M v[72:75], a[52:55], a[204:207], v[72:75]
buffer_load_dwordx4 a[168:171], v1, s[44:47], s25 offen offset:2048 sc1
M v[76:79], a[60:63], a[204:207], v[76:79]
M v[76:79], a[56:59], a[200:203], v[76:79]
M v[80:83], a[64:67], a[200:203], v[80:83]
ds_read_b64_tr_b16 v[176:177], v18 offset:32768
ds_read_b64_tr_b16 v[178:179], v18 offset:36864
M v[80:83], a[68:71], a[204:207], v[80:83]
M v[84:87], a[76:79], a[204:207], v[84:87]
buffer_load_dwordx4 a[172:175], v1, s[44:47], s25 offen offset:3072 sc1
M v[84:87], a[72:75], a[200:203], v[84:87]
M v[88:91], a[80:83], a[200:203], v[88:91]
M v[88:91], a[84:87], a[204:207], v[88:91]
ds_read_b64_tr_b16 v[180:181], v18 offset:40960
ds_read_b64_tr_b16 v[182:183], v18 offset:45056
M v[92:95], a[92:95], a[204:207], v[92:95]
M v[92:95], a[88:91], a[200:203], v[92:95]
M v[96:99], a[32:35], a[208:211], v[96:99]
s_add_u32 s25, s25, 16384
s_add_u32 s26, s26, 131072
M v[96:99], a[36:39], a[212:215], v[96:99]
M v[100:103], a[44:47], a[212:215], v[100:103]
M v[100:103], a[40:43], a[208:211], v[100:103]
ds_read_b64_tr_b16 v[184:185], v19 offset:32768
ds_read_b64_tr_b16 v[186:187], v19 offset:36864
M v[104:107], a[48:51], a[208:211], v[104:107]
M v[104:107], a[52:55], a[212:215], v[104:107]
ds_read_b64_tr_b16 v[188:189], v19 offset:40960
ds_read_b64_tr_b16 v[190:191], v19 offset:45056
M v[108:111], a[60:63], a[212:215], v[108:111]
M v[108:111], a[56:59], a[208:211], v[108:111]
M v[112:115], a[64:67], a[208:211], v[112:115]
ds_read_b64_tr_b16 v[192:193], v20 offset:32768
ds_read_b64_tr_b16 v[194:195], v20 offset:36864
M v[112:115], a[68:71], a[212:215], v[112:115]
M v[116:119], a[76:79], a[212:215], v[116:119]
M v[116:119], a[72:75], a[208:211], v[116:119]
ds_read_b64_tr_b16 v[196:197], v20 offset:40960
ds_read_b64_tr_b16 v[198:199], v20 offset:45056
M v[120:123], a[80:83], a[208:211], v[120:123]
M v[120:123], a[84:87], a[212:215], v[120:123]
ds_read_b64_tr_b16 v[200:201], v21 offset:32768
ds_read_b64_tr_b16 v[202:203], v21 offset:36864
M v[124:127], a[92:95], a[212:215], v[124:127]
M v[124:127], a[88:91], a[208:211], v[124:127]
M v[128:131], a[32:35], a[216:219], v[128:131]
ds_read_b64_tr_b16 v[204:205], v21 offset:40960
ds_read_b64_tr_b16 v[206:207], v21 offset:45056
M v[128:131], a[36:39], a[220:223], v[128:131]
M v[132:135], a[44:47], a[220:223], v[132:135]
M v[132:135], a[40:43], a[216:219], v[132:135]
ds_read_b64_tr_b16 v[208:209], v22 offset:32768
ds_read_b64_tr_b16 v[210:211], v22 offset:36864
M v[136:139], a[48:51], a[216:219], v[136:139]
M v[136:139], a[52:55], a[220:223], v[136:139]
ds_read_b64_tr_b16 v[212:213], v22 offset:40960
ds_read_b64_tr_b16 v[214:215], v22 offset:45056
M v[140:143], a[60:63], a[220:223], v[140:143]
M v[140:143], a[56:59], a[216:219], v[140:143]
M v[144:147], a[64:67], a[216:219], v[144:147]
ds_read_b64_tr_b16 v[216:217], v23 offset:32768
ds_read_b64_tr_b16 v[218:219], v23 offset:36864
M v[144:147], a[68:71], a[220:223], v[144:147]
M v[148:151], a[76:79], a[220:223], v[148:151]
M v[148:151], a[72:75], a[216:219], v[148:151]
ds_read_b64_tr_b16 v[220:221], v23 offset:40960
ds_read_b64_tr_b16 v[222:223], v23 offset:45056
M v[152:155], a[80:83], a[216:219], v[152:155]
M v[152:155], a[84:87], a[220:223], v[152:155]
M v[156:159], a[92:95], a[220:223], v[156:159]
M v[156:159], a[88:91], a[216:219], v[156:159]
s_waitcnt vmcnt(12) lgkmcnt(0)
s_barrier
M v[32:35], v[160:163], a[224:227], v[32:35]
s_add_u32 m0, s42, 32768
s_nop 0
buffer_load_dwordx4 v6, s[48:51], s26 offen offset:0 lds
M v[32:35], v[164:167], a[228:231], v[32:35]
M v[36:39], v[172:175], a[228:231], v[36:39]
ds_read_b64_tr_b16 a[32:33], v16 offset:49152
ds_read_b64_tr_b16 a[34:35], v16 offset:53248
M v[36:39], v[168:171], a[224:227], v[36:39]
M v[40:43], v[176:179], a[224:227], v[40:43]
M v[40:43], v[180:183], a[228:231], v[40:43]
buffer_load_dwordx4 v7, s[48:51], s26 offen offset:1024 lds
M v[44:47], v[188:191], a[228:231], v[44:47]
M v[44:47], v[184:187], a[224:227], v[44:47]
M v[48:51], v[192:195], a[224:227], v[48:51]
ds_read_b64_tr_b16 a[36:37], v16 offset:57344
ds_read_b64_tr_b16 a[38:39], v16 offset:61440
M v[48:51], v[196:199], a[228:231], v[48:51]
M v[52:55], v[204:207], a[228:231], v[52:55]
buffer_load_dwordx4 a[192:195], v1, s[44:47], s25 offen offset:0 sc1
M v[52:55], v[200:203], a[224:227], v[52:55]
M v[56:59], v[208:211], a[224:227], v[56:59]
M v[56:59], v[212:215], a[228:231], v[56:59]
ds_read_b64_tr_b16 a[40:41], v17 offset:49152
ds_read_b64_tr_b16 a[42:43], v17 offset:53248
M v[60:63], v[220:223], a[228:231], v[60:63]
M v[60:63], v[216:219], a[224:227], v[60:63]
M v[64:67], v[160:163], a[232:235], v[64:67]
buffer_load_dwordx4 a[196:199], v1, s[44:47], s25 offen offset:1024 sc1
M v[64:67], v[164:167], a[236:239], v[64:67]
M v[68:71], v[172:175], a[236:239], v[68:71]
ds_read_b64_tr_b16 a[44:45], v17 offset:57344
ds_read_b64_tr_b16 a[46:47], v17 offset:61440
M v[68:71], v[168:171], a[232:235], v[68:71]
M v[72:75], v[176:179], a[232:235], v[72:75]
M v[72:75], v[180:183], a[236:239], v[72:75]
buffer_load_dwordx4 a[200:203], v1, s[44:47], s25 offen offset:2048 sc1
M v[76:79], v[188:191], a[236:239], v[76:79]
M v[76:79], v[184:187], a[232:235], v[76:79]
M v[80:83], v[192:195], a[232:235], v[80:83]
ds_read_b64_tr_b16 a[48:49], v18 offset:49152
ds_read_b64_tr_b16 a[50:51], v18 offset:53248
M v[80:83], v[196:199], a[236:239], v[80:83]
M v[84:87], v[204:207], a[236:239], v[84:87]
buffer_load_dwordx4 a[204:207], v1, s[44:47], s25 offen offset:3072 sc1
M v[84:87], v[200:203], a[232:235], v[84:87]
M v[88:91], v[208:211], a[232:235], v[88:91]
M v[88:91], v[212:215], a[236:239], v[88:91]
ds_read_b64_tr_b16 a[52:53], v18 offset:57344
ds_read_b64_tr_b16 a[54:55], v18 offset:61440
M v[92:95], v[220:223], a[236:239], v[92:95]
M v[92:95], v[216:219], a[232:235], v[92:95]
M v[96:99], v[160:163], a[240:243], v[96:99]
s_add_u32 s25, s25, 16384
s_add_u32 s26, s26, 131072
M v[96:99], v[164:167], a[244:247], v[96:99]
M v[100:103], v[172:175], a[244:247], v[100:103]
M v[100:103], v[168:171], a[240:243], v[100:103]
ds_read_b64_tr_b16 a[56:57], v19 offset:49152
ds_read_b64_tr_b16 a[58:59], v19 offset:53248
M v[104:107], v[176:179], a[240:243], v[104:107]
M v[104:107], v[180:183], a[244:247], v[104:107]
ds_read_b64_tr_b16 a[60:61], v19 offset:57344
ds_read_b64_tr_b16 a[62:63], v19 offset:61440
M v[108:111], v[188:191], a[244:247], v[108:111]
M v[108:111], v[184:187], a[240:243], v[108:111]
M v[112:115], v[192:195], a[240:243], v[112:115]
ds_read_b64_tr_b16 a[64:65], v20 offset:49152
ds_read_b64_tr_b16 a[66:67], v20 offset:53248
M v[112:115], v[196:199], a[244:247], v[112:115]
M v[116:119], v[204:207], a[244:247], v[116:119]
M v[116:119], v[200:203], a[240:243], v[116:119]
ds_read_b64_tr_b16 a[68:69], v20 offset:57344
ds_read_b64_tr_b16 a[70:71], v20 offset:61440
M v[120:123], v[208:211], a[240:243], v[120:123]
M v[120:123], v[212:215], a[244:247], v[120:123]
ds_read_b64_tr_b16 a[72:73], v21 offset:49152
ds_read_b64_tr_b16 a[74:75], v21 offset:53248
M v[124:127], v[220:223], a[244:247], v[124:127]
M v[124:127], v[216:219], a[240:243], v[124:127]
M v[128:131], v[160:163], a[248:251], v[128:131]
ds_read_b64_tr_b16 a[76:77], v21 offset:57344
ds_read_b64_tr_b16 a[78:79], v21 offset:61440
M v[128:131], v[164:167], a[252:255], v[128:131]
M v[132:135], v[172:175], a[252:255], v[132:135]
M v[132:135], v[168:171], a[248:251], v[132:135]
ds_read_b64_tr_b16 a[80:81], v22 offset:49152
ds_read_b64_tr_b16 a[82:83], v22 offset:53248
M v[136:139], v[176:179], a[248:251], v[136:139]
M v[136:139], v[180:183], a[252:255], v[136:139]
ds_read_b64_tr_b16 a[84:85], v22 offset:57344
ds_read_b64_tr_b16 a[86:87], v22 offset:61440
M v[140:143], v[188:191], a[252:255], v[140:143]
M v[140:143], v[184:187], a[248:251], v[140:143]
M v[144:147], v[192:195], a[248:251], v[144:147]
ds_read_b64_tr_b16 a[88:89], v23 offset:49152
ds_read_b64_tr_b16 a[90:91], v23 offset:53248
M v[144:147], v[196:199], a[252:255], v[144:147]
M v[148:151], v[204:207], a[252:255], v[148:151]
M v[148:151], v[200:203], a[248:251], v[148:151]
ds_read_b64_tr_b16 a[92:93], v23 offset:57344
ds_read_b64_tr_b16 a[94:95], v23 offset:61440
M v[152:155], v[208:211], a[248:251], v[152:155]
M v[152:155], v[212:215], a[252:255], v[152:155]
M v[156:159], v[220:223], a[252:255], v[156:159]
M v[156:159], v[216:219], a[248:251], v[156:159]
s_waitcnt vmcnt(12) lgkmcnt(0)
s_barrier
M v[32:35], a[32:35], a[96:99], v[32:35]
s_add_u32 m0, s42, 49152
s_nop 0
buffer_load_dwordx4 v6, s[48:51], s26 offen offset:0 lds
M v[32:35], a[36:39], a[100:103], v[32:35]
M v[36:39], a[44:47], a[100:103], v[36:39]
M v[36:39], a[40:43], a[96:99], v[36:39]
M v[40:43], a[48:51], a[96:99], v[40:43]
ds_read_b64_tr_b16 v[160:161], v24 offset:0
ds_read_b64_tr_b16 v[162:163], v24 offset:2048
M v[40:43], a[52:55], a[100:103], v[40:43]
M v[44:47], a[60:63], a[100:103], v[44:47]
M v[44:47], a[56:59], a[96:99], v[44:47]
M v[48:51], a[64:67], a[96:99], v[48:51]
buffer_load_dwordx4 v7, s[48:51], s26 offen offset:1024 lds
M v[48:51], a[68:71], a[100:103], v[48:51]
M v[52:55], a[76:79], a[100:103], v[52:55]
M v[52:55], a[72:75], a[96:99], v[52:55]
M v[56:59], a[80:83], a[96:99], v[56:59]
ds_read_b64_tr_b16 v[164:165], v24 offset:4096
ds_read_b64_tr_b16 v[166:167], v24 offset:6144
M v[56:59], a[84:87], a[100:103], v[56:59]
M v[60:63], a[92:95], a[100:103], v[60:63]
M v[60:63], a[88:91], a[96:99], v[60:63]
M v[64:67], a[32:35], a[104:107], v[64:67]
buffer_load_dwordx4 a[224:227], v1, s[44:47], s25 offen offset:0 sc1
M v[64:67], a[36:39], a[108:111], v[64:67]
M v[68:71], a[44:47], a[108:111], v[68:71]
v_cvt_pk_bf16_f32 v40, v40, v41
v_cvt_pk_bf16_f32 v41, v42, v43
M v[68:71], a[40:43], a[104:107], v[68:71]
v_cvt_pk_bf16_f32 v42, v44, v45
v_cvt_pk_bf16_f32 v43, v46, v47
M v[72:75], a[48:51], a[104:107], v[72:75]
ds_read_b64_tr_b16 v[168:169], v25 offset:0
ds_read_b64_tr_b16 v[170:171], v25 offset:2048
M v[72:75], a[52:55], a[108:111], v[72:75]
s_add_u32 s60, s56, 4096
buffer_store_dwordx4 v[40:43], v1, s[52:55], s60 offen offset:0 sc1
M v[76:79], a[60:63], a[108:111], v[76:79]
M v[76:79], a[56:59], a[104:107], v[76:79]
v_cvt_pk_bf16_f32 v48, v48, v49
v_cvt_pk_bf16_f32 v49, v50, v51
M v[80:83], a[64:67], a[104:107], v[80:83]
buffer_load_dwordx4 a[228:231], v1, s[44:47], s25 offen offset:1024 sc1
v_cvt_pk_bf16_f32 v50, v52, v53
v_cvt_pk_bf16_f32 v51, v54, v55
M v[80:83], a[68:71], a[108:111], v[80:83]
M v[84:87], a[76:79], a[108:111], v[84:87]
s_add_u32 s60, s56, 8192
buffer_store_dwordx4 v[48:51], v1, s[52:55], s60 offen offset:0 sc1
M v[84:87], a[72:75], a[104:107], v[84:87]
M v[88:91], a[80:83], a[104:107], v[88:91]
ds_read_b64_tr_b16 v[172:173], v25 offset:4096
ds_read_b64_tr_b16 v[174:175], v25 offset:6144
v_cvt_pk_bf16_f32 v56, v56, v57
v_cvt_pk_bf16_f32 v57, v58, v59
M v[88:91], a[84:87], a[108:111], v[88:91]
v_cvt_pk_bf16_f32 v58, v60, v61
v_cvt_pk_bf16_f32 v59, v62, v63
M v[92:95], a[92:95], a[108:111], v[92:95]
M v[92:95], a[88:91], a[104:107], v[92:95]
s_add_u32 s60, s56, 12288
buffer_store_dwordx4 v[56:59], v1, s[52:55], s60 offen offset:0 sc1
M v[96:99], a[32:35], a[112:115], v[96:99]
M v[96:99], a[36:39], a[116:119], v[96:99]
buffer_load_dwordx4 a[232:235], v1, s[44:47], s25 offen offset:2048 sc1
M v[100:103], a[44:47], a[116:119], v[100:103]
v_cvt_pk_bf16_f32 v72, v72, v73
v_cvt_pk_bf16_f32 v73, v74, v75
M v[100:103], a[40:43], a[112:115], v[100:103]
v_cvt_pk_bf16_f32 v74, v76, v77
v_cvt_pk_bf16_f32 v75, v78, v79
M v[104:107], a[48:51], a[112:115], v[104:107]
M v[104:107], a[52:55], a[116:119], v[104:107]
ds_read_b64_tr_b16 v[176:177], v26 offset:0
ds_read_b64_tr_b16 v[178:179], v26 offset:2048
s_add_u32 s60, s56, 4096
buffer_store_dwordx4 v[72:75], v1, s[52:55], s60 offen offset:1024 sc1
M v[108:111], a[60:63], a[116:119], v[108:111]
M v[108:111], a[56:59], a[112:115], v[108:111]
v_cvt_pk_bf16_f32 v80, v80, v81
v_cvt_pk_bf16_f32 v81, v82, v83
M v[112:115], a[64:67], a[112:115], v[112:115]
v_cvt_pk_bf16_f32 v82, v84, v85
v_cvt_pk_bf16_f32 v83, v86, v87
M v[112:115], a[68:71], a[116:119], v[112:115]
buffer_load_dwordx4 a[236:239], v1, s[44:47], s25 offen offset:3072 sc1
M v[116:119], a[76:79], a[116:119], v[116:119]
s_add_u32 s60, s56, 8192
buffer_store_dwordx4 v[80:83], v1, s[52:55], s60 offen offset:1024 sc1
M v[116:119], a[72:75], a[112:115], v[116:119]
M v[120:123], a[80:83], a[112:115], v[120:123]
v_cvt_pk_bf16_f32 v88, v88, v89
v_cvt_pk_bf16_f32 v89, v90, v91
M v[120:123], a[84:87], a[116:119], v[120:123]
ds_read_b64_tr_b16 v[180:181], v26 offset:4096
ds_read_b64_tr_b16 v[182:183], v26 offset:6144
v_cvt_pk_bf16_f32 v90, v92, v93
v_cvt_pk_bf16_f32 v91, v94, v95
M v[124:127], a[92:95], a[116:119], v[124:127]
M v[124:127], a[88:91], a[112:115], v[124:127]
s_add_u32 s60, s56, 12288
buffer_store_dwordx4 v[88:91], v1, s[52:55], s60 offen offset:1024 sc1
M v[128:131], a[32:35], a[120:123], v[128:131]
M v[128:131], a[36:39], a[124:127], v[128:131]
s_add_u32 s25, s25, 16384
s_add_u32 s26, s26, 131072
M v[132:135], a[44:47], a[124:127], v[132:135]
v_cvt_pk_bf16_f32 v104, v104, v105
v_cvt_pk_bf16_f32 v105, v106, v107
M v[132:135], a[40:43], a[120:123], v[132:135]
v_cvt_pk_bf16_f32 v106, v108, v109
v_cvt_pk_bf16_f32 v107, v110, v111
M v[136:139], a[48:51], a[120:123], v[136:139]
M v[136:139], a[52:55], a[124:127], v[136:139]
ds_read_b64_tr_b16 v[184:185], v27 offset:0
ds_read_b64_tr_b16 v[186:187], v27 offset:2048
s_add_u32 s60, s56, 4096
buffer_store_dwordx4 v[104:107], v1, s[52:55], s60 offen offset:2048 sc1
M v[140:143], a[60:63], a[124:127], v[140:143]
M v[140:143], a[56:59], a[120:123], v[140:143]
v_cvt_pk_bf16_f32 v112, v112, v113
v_cvt_pk_bf16_f32 v113, v114, v115
M v[144:147], a[64:67], a[120:123], v[144:147]
v_cvt_pk_bf16_f32 v114, v116, v117
v_cvt_pk_bf16_f32 v115, v118, v119
M v[144:147], a[68:71], a[124:127], v[144:147]
ds_read_b64_tr_b16 v[188:189], v27 offset:4096
ds_read_b64_tr_b16 v[190:191], v27 offset:6144
M v[148:151], a[76:79], a[124:127], v[148:151]
s_add_u32 s60, s56, 8192
buffer_store_dwordx4 v[112:115], v1, s[52:55], s60 offen offset:2048 sc1
M v[148:151], a[72:75], a[120:123], v[148:151]
M v[152:155], a[80:83], a[120:123], v[152:155]
v_cvt_pk_bf16_f32 v120, v120, v121
v_cvt_pk_bf16_f32 v121, v122, v123
M v[152:155], a[84:87], a[124:127], v[152:155]
v_cvt_pk_bf16_f32 v122, v124, v125
v_cvt_pk_bf16_f32 v123, v126, v127
M v[156:159], a[92:95], a[124:127], v[156:159]
M v[156:159], a[88:91], a[120:123], v[156:159]
s_add_u32 s60, s56, 12288
buffer_store_dwordx4 v[120:123], v1, s[52:55], s60 offen offset:2048 sc1
s_waitcnt vmcnt(21) lgkmcnt(0)
s_barrier
M a[0:3], v[160:163], a[128:131], a[0:3]
s_add_u32 m0, s42, 65536
s_nop 0
buffer_load_dwordx4 v6, s[48:51], s26 offen offset:0 lds
ds_read_b64_tr_b16 a[32:33], v24 offset:16384
ds_read_b64_tr_b16 a[34:35], v24 offset:18432
M a[0:3], v[164:167], a[132:135], a[0:3]
buffer_load_dwordx4 v7, s[48:51], s26 offen offset:1024 lds
M a[4:7], v[172:175], a[132:135], a[4:7]
ds_read_b64_tr_b16 a[36:37], v24 offset:20480
ds_read_b64_tr_b16 a[38:39], v24 offset:22528
buffer_load_dwordx4 a[96:99], v1, s[44:47], s25 offen offset:0 sc1
M a[4:7], v[168:171], a[128:131], a[4:7]
ds_read_b64_tr_b16 a[40:41], v25 offset:16384
ds_read_b64_tr_b16 a[42:43], v25 offset:18432
M a[8:11], v[176:179], a[128:131], a[8:11]
buffer_load_dwordx4 a[100:103], v1, s[44:47], s25 offen offset:1024 sc1
M a[8:11], v[180:183], a[132:135], a[8:11]
ds_read_b64_tr_b16 a[44:45], v25 offset:20480
ds_read_b64_tr_b16 a[46:47], v25 offset:22528
buffer_load_dwordx4 a[104:107], v1, s[44:47], s25 offen offset:2048 sc1
M a[12:15], v[188:191], a[132:135], a[12:15]
ds_read_b64_tr_b16 a[48:49], v26 offset:16384
ds_read_b64_tr_b16 a[50:51], v26 offset:18432
M a[12:15], v[184:187], a[128:131], a[12:15]
buffer_load_dwordx4 a[108:111], v1, s[44:47], s25 offen offset:3072 sc1
M a[16:19], v[160:163], a[136:139], a[16:19]
ds_read_b64_tr_b16 a[52:53], v26 offset:20480
ds_read_b64_tr_b16 a[54:55], v26 offset:22528
s_add_u32 s25, s25, 16384
s_add_u32 s26, s26, 131072
M a[16:19], v[164:167], a[140:143], a[16:19]
ds_read_b64_tr_b16 a[56:57], v27 offset:16384
ds_read_b64_tr_b16 a[58:59], v27 offset:18432
M a[20:23], v[172:175], a[140:143], a[20:23]
v_cvt_pk_bf16_f32 v136, v136, v137
v_cvt_pk_bf16_f32 v137, v138, v139
v_cvt_pk_bf16_f32 v138, v140, v141
v_cvt_pk_bf16_f32 v139, v142, v143
s_add_u32 s60, s56, 4096
buffer_store_dwordx4 v[136:139], v1, s[52:55], s60 offen offset:3072 sc1
M a[20:23], v[168:171], a[136:139], a[20:23]
ds_read_b64_tr_b16 a[60:61], v27 offset:20480
ds_read_b64_tr_b16 a[62:63], v27 offset:22528
v_cvt_pk_bf16_f32 v144, v144, v145
v_cvt_pk_bf16_f32 v145, v146, v147
v_cvt_pk_bf16_f32 v146, v148, v149
v_cvt_pk_bf16_f32 v147, v150, v151
s_add_u32 s60, s56, 8192
buffer_store_dwordx4 v[144:147], v1, s[52:55], s60 offen offset:3072 sc1
M a[24:27], v[176:179], a[136:139], a[24:27]
v_cvt_pk_bf16_f32 v152, v152, v153
v_cvt_pk_bf16_f32 v153, v154, v155
v_cvt_pk_bf16_f32 v154, v156, v157
v_cvt_pk_bf16_f32 v155, v158, v159
s_add_u32 s60, s56, 12288
buffer_store_dwordx4 v[152:155], v1, s[52:55], s60 offen offset:3072 sc1
M a[24:27], v[180:183], a[140:143], a[24:27]
v_and_b32 v11, 3, v0
v_lshlrev_b32 v11, 4, v11
M a[28:31], v[188:191], a[140:143], a[28:31]
M a[28:31], v[184:187], a[136:139], a[28:31]
s_waitcnt vmcnt(24) lgkmcnt(0)
s_barrier
s_waitcnt vmcnt(0)
s_mov_b64 exec, 1
buffer_store_dword v254, v253, s[52:55], s58 offen sc1
s_mov_b64 exec, -1
M a[0:3], a[32:35], a[160:163], a[0:3]
s_add_u32 m0, s42, 81920
s_nop 0
buffer_load_dwordx4 v6, s[48:51], s26 offen offset:0 lds
ds_read_b64_tr_b16 v[160:161], v24 offset:32768
ds_read_b64_tr_b16 v[162:163], v24 offset:34816
M a[0:3], a[36:39], a[164:167], a[0:3]
buffer_load_dwordx4 v7, s[48:51], s26 offen offset:1024 lds
M a[4:7], a[44:47], a[164:167], a[4:7]
ds_read_b64_tr_b16 v[164:165], v24 offset:36864
ds_read_b64_tr_b16 v[166:167], v24 offset:38912
M a[4:7], a[40:43], a[160:163], a[4:7]
buffer_load_dwordx4 a[128:131], v1, s[44:47], s25 offen offset:0 sc1
M a[8:11], a[48:51], a[160:163], a[8:11]
ds_read_b64_tr_b16 v[168:169], v25 offset:32768
ds_read_b64_tr_b16 v[170:171], v25 offset:34816
M a[8:11], a[52:55], a[164:167], a[8:11]
buffer_load_dwordx4 a[132:135], v1, s[44:47], s25 offen offset:1024 sc1
M a[12:15], a[60:63], a[164:167], a[12:15]
ds_read_b64_tr_b16 v[172:173], v25 offset:36864
ds_read_b64_tr_b16 v[174:175], v25 offset:38912
M a[12:15], a[56:59], a[160:163], a[12:15]
buffer_load_dwordx4 a[136:139], v1, s[44:47], s25 offen offset:2048 sc1
M a[16:19], a[32:35], a[168:171], a[16:19]
ds_read_b64_tr_b16 v[176:177], v26 offset:32768
ds_read_b64_tr_b16 v[178:179], v26 offset:34816
M a[16:19], a[36:39], a[172:175], a[16:19]
buffer_load_dwordx4 a[140:143], v1, s[44:47], s25 offen offset:3072 sc1
M a[20:23], a[44:47], a[172:175], a[20:23]
ds_read_b64_tr_b16 v[180:181], v26 offset:36864
ds_read_b64_tr_b16 v[182:183], v26 offset:38912
M a[20:23], a[40:43], a[168:171], a[20:23]
s_add_u32 s25, s25, 16384
s_add_u32 s26, s26, 131072
M a[24:27], a[48:51], a[168:171], a[24:27]
ds_read_b64_tr_b16 v[184:185], v27 offset:32768
ds_read_b64_tr_b16 v[186:187], v27 offset:34816
M a[24:27], a[52:55], a[172:175], a[24:27]
ds_read_b64_tr_b16 v[188:189], v27 offset:36864
ds_read_b64_tr_b16 v[190:191], v27 offset:38912
M a[28:31], a[60:63], a[172:175], a[28:31]
M a[28:31], a[56:59], a[168:171], a[28:31]
s_waitcnt vmcnt(21) lgkmcnt(0)
s_barrier
M a[0:3], v[160:163], a[192:195], a[0:3]
s_add_u32 m0, s42, 98304
s_nop 0
buffer_load_dwordx4 v6, s[48:51], s26 offen offset:0 lds
ds_read_b64_tr_b16 a[32:33], v24 offset:49152
ds_read_b64_tr_b16 a[34:35], v24 offset:51200
M a[0:3], v[164:167], a[196:199], a[0:3]
buffer_load_dwordx4 v7, s[48:51], s26 offen offset:1024 lds
M a[4:7], v[172:175], a[196:199], a[4:7]
ds_read_b64_tr_b16 a[36:37], v24 offset:53248
ds_read_b64_tr_b16 a[38:39], v24 offset:55296
M a[4:7], v[168:171], a[192:195], a[4:7]
buffer_load_dwordx4 a[160:163], v1, s[44:47], s25 offen offset:0 sc1
M a[8:11], v[176:179], a[192:195], a[8:11]
ds_read_b64_tr_b16 a[40:41], v25 offset:49152
ds_read_b64_tr_b16 a[42:43], v25 offset:51200
M a[8:11], v[180:183], a[196:199], a[8:11]
buffer_load_dwordx4 a[164:167], v1, s[44:47], s25 offen offset:1024 sc1
M a[12:15], v[188:191], a[196:199], a[12:15]
ds_read_b64_tr_b16 a[44:45], v25 offset:53248
ds_read_b64_tr_b16 a[46:47], v25 offset:55296
M a[12:15], v[184:187], a[192:195], a[12:15]
buffer_load_dwordx4 a[168:171], v1, s[44:47], s25 offen offset:2048 sc1
M a[16:19], v[160:163], a[200:203], a[16:19]
ds_read_b64_tr_b16 a[48:49], v26 offset:49152
ds_read_b64_tr_b16 a[50:51], v26 offset:51200
M a[16:19], v[164:167], a[204:207], a[16:19]
buffer_load_dwordx4 a[172:175], v1, s[44:47], s25 offen offset:3072 sc1
M a[20:23], v[172:175], a[204:207], a[20:23]
ds_read_b64_tr_b16 a[52:53], v26 offset:53248
ds_read_b64_tr_b16 a[54:55], v26 offset:55296
M a[20:23], v[168:171], a[200:203], a[20:23]
s_add_u32 s25, s25, 16384
s_add_u32 s26, s26, 131072
M a[24:27], v[176:179], a[200:203], a[24:27]
ds_read_b64_tr_b16 a[56:57], v27 offset:49152
ds_read_b64_tr_b16 a[58:59], v27 offset:51200
M a[24:27], v[180:183], a[204:207], a[24:27]
ds_read_b64_tr_b16 a[60:61], v27 offset:53248
ds_read_b64_tr_b16 a[62:63], v27 offset:55296
M a[28:31], v[188:191], a[204:207], a[28:31]
M a[28:31], v[184:187], a[200:203], a[28:31]
s_waitcnt vmcnt(16) lgkmcnt(0)
s_barrier
M a[0:3], a[32:35], a[224:227], a[0:3]
s_add_u32 m0, s42, 114688
s_nop 0
buffer_load_dwordx4 v6, s[48:51], s26 offen offset:0 lds
ds_read_b64_tr_b16 v[160:161], v28 offset:0
ds_read_b64_tr_b16 v[162:163], v28 offset:2048
M a[0:3], a[36:39], a[228:231], a[0:3]
buffer_load_dwordx4 v7, s[48:51], s26 offen offset:1024 lds
M a[4:7], a[44:47], a[228:231], a[4:7]
ds_read_b64_tr_b16 v[164:165], v28 offset:4096
ds_read_b64_tr_b16 v[166:167], v28 offset:6144
M a[4:7], a[40:43], a[224:227], a[4:7]
buffer_load_dwordx4 a[192:195], v1, s[44:47], s25 offen offset:0 sc1
M a[8:11], a[48:51], a[224:227], a[8:11]
ds_read_b64_tr_b16 v[168:169], v29 offset:0
ds_read_b64_tr_b16 v[170:171], v29 offset:2048
M a[8:11], a[52:55], a[228:231], a[8:11]
buffer_load_dwordx4 a[196:199], v1, s[44:47], s25 offen offset:1024 sc1
M a[12:15], a[60:63], a[228:231], a[12:15]
ds_read_b64_tr_b16 v[172:173], v29 offset:4096
ds_read_b64_tr_b16 v[174:175], v29 offset:6144
M a[12:15], a[56:59], a[224:227], a[12:15]
buffer_load_dwordx4 a[200:203], v1, s[44:47], s25 offen offset:2048 sc1
M a[16:19], a[32:35], a[232:235], a[16:19]
ds_read_b64_tr_b16 v[176:177], v30 offset:0
ds_read_b64_tr_b16 v[178:179], v30 offset:2048
M a[16:19], a[36:39], a[236:239], a[16:19]
buffer_load_dwordx4 a[204:207], v1, s[44:47], s25 offen offset:3072 sc1
M a[20:23], a[44:47], a[236:239], a[20:23]
ds_read_b64_tr_b16 v[180:181], v30 offset:4096
ds_read_b64_tr_b16 v[182:183], v30 offset:6144
M a[20:23], a[40:43], a[232:235], a[20:23]
s_add_u32 s25, s25, 16384
s_add_u32 s26, s26, 131072
M a[24:27], a[48:51], a[232:235], a[24:27]
ds_read_b64_tr_b16 v[184:185], v31 offset:0
ds_read_b64_tr_b16 v[186:187], v31 offset:2048
M a[24:27], a[52:55], a[236:239], a[24:27]
ds_read_b64_tr_b16 v[188:189], v31 offset:4096
ds_read_b64_tr_b16 v[190:191], v31 offset:6144
M a[28:31], a[60:63], a[236:239], a[28:31]
M a[28:31], a[56:59], a[232:235], a[28:31]
s_waitcnt vmcnt(12) lgkmcnt(0)
s_barrier
M a[0:3], v[160:163], a[96:99], a[0:3]
s_add_u32 m0, s42, 0
s_nop 0
buffer_load_dwordx4 v6, s[48:51], s26 offen offset:0 lds
ds_read_b64_tr_b16 a[32:33], v28 offset:16384
ds_read_b64_tr_b16 a[34:35], v28 offset:18432
M a[0:3], v[164:167], a[100:103], a[0:3]
buffer_load_dwordx4 v7, s[48:51], s26 offen offset:1024 lds
M a[4:7], v[172:175], a[100:103], a[4:7]
ds_read_b64_tr_b16 a[36:37], v28 offset:20480
ds_read_b64_tr_b16 a[38:39], v28 offset:22528
M a[4:7], v[168:171], a[96:99], a[4:7]
buffer_load_dwordx4 a[224:227], v1, s[44:47], s25 offen offset:0 sc1
M a[8:11], v[176:179], a[96:99], a[8:11]
ds_read_b64_tr_b16 a[40:41], v29 offset:16384
ds_read_b64_tr_b16 a[42:43], v29 offset:18432
M a[8:11], v[180:183], a[100:103], a[8:11]
buffer_load_dwordx4 a[228:231], v1, s[44:47], s25 offen offset:1024 sc1
M a[12:15], v[188:191], a[100:103], a[12:15]
ds_read_b64_tr_b16 a[44:45], v29 offset:20480
ds_read_b64_tr_b16 a[46:47], v29 offset:22528
M a[12:15], v[184:187], a[96:99], a[12:15]
buffer_load_dwordx4 a[232:235], v1, s[44:47], s25 offen offset:2048 sc1
M a[16:19], v[160:163], a[104:107], a[16:19]
ds_read_b64_tr_b16 a[48:49], v30 offset:16384
ds_read_b64_tr_b16 a[50:51], v30 offset:18432
M a[16:19], v[164:167], a[108:111], a[16:19]
buffer_load_dwordx4 a[236:239], v1, s[44:47], s25 offen offset:3072 sc1
M a[20:23], v[172:175], a[108:111], a[20:23]
ds_read_b64_tr_b16 a[52:53], v30 offset:20480
ds_read_b64_tr_b16 a[54:55], v30 offset:22528
M a[20:23], v[168:171], a[104:107], a[20:23]
s_add_u32 s25, s25, 16384
s_add_u32 s26, s26, 131072
M a[24:27], v[176:179], a[104:107], a[24:27]
ds_read_b64_tr_b16 a[56:57], v31 offset:16384
ds_read_b64_tr_b16 a[58:59], v31 offset:18432
M a[24:27], v[180:183], a[108:111], a[24:27]
ds_read_b64_tr_b16 a[60:61], v31 offset:20480
ds_read_b64_tr_b16 a[62:63], v31 offset:22528
M a[28:31], v[188:191], a[108:111], a[28:31]
M a[28:31], v[184:187], a[104:107], a[28:31]
s_waitcnt vmcnt(12) lgkmcnt(0)
s_barrier
M a[0:3], a[32:35], a[128:131], a[0:3]
ds_read_b64_tr_b16 v[160:161], v28 offset:32768
ds_read_b64_tr_b16 v[162:163], v28 offset:34816
M a[0:3], a[36:39], a[132:135], a[0:3]
ds_read_b64_tr_b16 v[164:165], v28 offset:36864
ds_read_b64_tr_b16 v[166:167], v28 offset:38912
M a[4:7], a[44:47], a[132:135], a[4:7]
M a[4:7], a[40:43], a[128:131], a[4:7]
ds_read_b64_tr_b16 v[168:169], v29 offset:32768
ds_read_b64_tr_b16 v[170:171], v29 offset:34816
M a[8:11], a[48:51], a[128:131], a[8:11]
M a[8:11], a[52:55], a[132:135], a[8:11]
ds_read_b64_tr_b16 v[172:173], v29 offset:36864
ds_read_b64_tr_b16 v[174:175], v29 offset:38912
M a[12:15], a[60:63], a[132:135], a[12:15]
M a[12:15], a[56:59], a[128:131], a[12:15]
ds_read_b64_tr_b16 v[176:177], v30 offset:32768
ds_read_b64_tr_b16 v[178:179], v30 offset:34816
M a[16:19], a[32:35], a[136:139], a[16:19]
ds_read_b64_tr_b16 v[180:181], v30 offset:36864
ds_read_b64_tr_b16 v[182:183], v30 offset:38912
M a[16:19], a[36:39], a[140:143], a[16:19]
M a[20:23], a[44:47], a[140:143], a[20:23]
ds_read_b64_tr_b16 v[184:185], v31 offset:32768
ds_read_b64_tr_b16 v[186:187], v31 offset:34816
M a[20:23], a[40:43], a[136:139], a[20:23]
M a[24:27], a[48:51], a[136:139], a[24:27]
ds_read_b64_tr_b16 v[188:189], v31 offset:36864
ds_read_b64_tr_b16 v[190:191], v31 offset:38912
M a[24:27], a[52:55], a[140:143], a[24:27]
M a[28:31], a[60:63], a[140:143], a[28:31]
M a[28:31], a[56:59], a[136:139], a[28:31]
s_waitcnt vmcnt(6) lgkmcnt(0)
s_barrier
M a[0:3], v[160:163], a[160:163], a[0:3]
buffer_load_dword v8, v11, s[52:55], s59 offen sc1
M a[0:3], v[164:167], a[164:167], a[0:3]
ds_read_b64_tr_b16 a[32:33], v28 offset:49152
ds_read_b64_tr_b16 a[34:35], v28 offset:51200
M a[4:7], v[172:175], a[164:167], a[4:7]
M a[4:7], v[168:171], a[160:163], a[4:7]
ds_read_b64_tr_b16 a[36:37], v28 offset:53248
ds_read_b64_tr_b16 a[38:39], v28 offset:55296
M a[8:11], v[176:179], a[160:163], a[8:11]
ds_read_b64_tr_b16 a[40:41], v29 offset:49152
ds_read_b64_tr_b16 a[42:43], v29 offset:51200
M a[8:11], v[180:183], a[164:167], a[8:11]
M a[12:15], v[188:191], a[164:167], a[12:15]
ds_read_b64_tr_b16 a[44:45], v29 offset:53248
ds_read_b64_tr_b16 a[46:47], v29 offset:55296
M a[12:15], v[184:187], a[160:163], a[12:15]
ds_read_b64_tr_b16 a[48:49], v30 offset:49152
ds_read_b64_tr_b16 a[50:51], v30 offset:51200
M a[16:19], v[160:163], a[168:171], a[16:19]
M a[16:19], v[164:167], a[172:175], a[16:19]
ds_read_b64_tr_b16 a[52:53], v30 offset:53248
ds_read_b64_tr_b16 a[54:55], v30 offset:55296
M a[20:23], v[172:175], a[172:175], a[20:23]
ds_read_b64_tr_b16 a[56:57], v31 offset:49152
ds_read_b64_tr_b16 a[58:59], v31 offset:51200
M a[20:23], v[168:171], a[168:171], a[20:23]
M a[24:27], v[176:179], a[168:171], a[24:27]
ds_read_b64_tr_b16 a[60:61], v31 offset:53248
ds_read_b64_tr_b16 a[62:63], v31 offset:55296
M a[24:27], v[180:183], a[172:175], a[24:27]
M a[28:31], v[188:191], a[172:175], a[28:31]
M a[28:31], v[184:187], a[168:171], a[28:31]
s_waitcnt vmcnt(1) lgkmcnt(0)
s_barrier
s_waitcnt vmcnt(0)
v_cmp_ne_u32 vcc, 1, v8
s_nop 0
s_cbranch_vccnz Lk3_spinfl
Lk3_gotfl:
M a[0:3], a[32:35], a[192:195], a[0:3]
s_xor_b32 s60, s56, 65536
s_add_u32 s60, s60, 4096
buffer_load_dwordx4 v[192:195], v1, s[52:55], s60 offen offset:0 sc1
ds_read_b64_tr_b16 v[160:161], v24 offset:0
ds_read_b64_tr_b16 v[162:163], v24 offset:2048
M a[0:3], a[36:39], a[196:199], a[0:3]
buffer_load_dwordx4 v[196:199], v1, s[52:55], s60 offen offset:1024 sc1
M a[4:7], a[44:47], a[196:199], a[4:7]
ds_read_b64_tr_b16 v[164:165], v24 offset:4096
ds_read_b64_tr_b16 v[166:167], v24 offset:6144
buffer_load_dwordx4 v[200:203], v1, s[52:55], s60 offen offset:2048 sc1
M a[4:7], a[40:43], a[192:195], a[4:7]
ds_read_b64_tr_b16 v[168:169], v25 offset:0
ds_read_b64_tr_b16 v[170:171], v25 offset:2048
M a[8:11], a[48:51], a[192:195], a[8:11]
buffer_load_dwordx4 v[204:207], v1, s[52:55], s60 offen offset:3072 sc1
ds_read_b64_tr_b16 v[172:173], v25 offset:4096
ds_read_b64_tr_b16 v[174:175], v25 offset:6144
M a[8:11], a[52:55], a[196:199], a[8:11]
s_xor_b32 s60, s56, 131072
s_add_u32 s60, s60, 8192
buffer_load_dwordx4 v[208:211], v1, s[52:55], s60 offen offset:0 sc1
M a[12:15], a[60:63], a[196:199], a[12:15]
ds_read_b64_tr_b16 v[176:177], v26 offset:0
ds_read_b64_tr_b16 v[178:179], v26 offset:2048
M a[12:15], a[56:59], a[192:195], a[12:15]
buffer_load_dwordx4 v[212:215], v1, s[52:55], s60 offen offset:1024 sc1
ds_read_b64_tr_b16 v[180:181], v26 offset:4096
ds_read_b64_tr_b16 v[182:183], v26 offset:6144
M a[16:19], a[32:35], a[200:203], a[16:19]
buffer_load_dwordx4 v[216:219], v1, s[52:55], s60 offen offset:2048 sc1
M a[16:19], a[36:39], a[204:207], a[16:19]
ds_read_b64_tr_b16 v[184:185], v27 offset:0
ds_read_b64_tr_b16 v[186:187], v27 offset:2048
buffer_load_dwordx4 v[220:223], v1, s[52:55], s60 offen offset:3072 sc1
M a[20:23], a[44:47], a[204:207], a[20:23]
ds_read_b64_tr_b16 v[188:189], v27 offset:4096
ds_read_b64_tr_b16 v[190:191], v27 offset:6144
M a[20:23], a[40:43], a[200:203], a[20:23]
s_xor_b32 s60, s56, 196608
s_add_u32 s60, s60, 12288
buffer_load_dwordx4 v[224:227], v1, s[52:55], s60 offen offset:0 sc1
buffer_load_dwordx4 v[228:231], v1, s[52:55], s60 offen offset:1024 sc1
M a[24:27], a[48:51], a[200:203], a[24:27]
buffer_load_dwordx4 v[232:235], v1, s[52:55], s60 offen offset:2048 sc1
M a[24:27], a[52:55], a[204:207], a[24:27]
buffer_load_dwordx4 v[236:239], v1, s[52:55], s60 offen offset:3072 sc1
M a[28:31], a[60:63], a[204:207], a[28:31]
M a[28:31], a[56:59], a[200:203], a[28:31]
s_waitcnt lgkmcnt(0)
M a[0:3], v[160:163], a[224:227], a[0:3]
M a[0:3], v[164:167], a[228:231], a[0:3]
M a[4:7], v[172:175], a[228:231], a[4:7]
M a[4:7], v[168:171], a[224:227], a[4:7]
M a[8:11], v[176:179], a[224:227], a[8:11]
M a[8:11], v[180:183], a[228:231], a[8:11]
M a[12:15], v[188:191], a[228:231], a[12:15]
M a[12:15], v[184:187], a[224:227], a[12:15]
M a[16:19], v[160:163], a[232:235], a[16:19]
M a[16:19], v[164:167], a[236:239], a[16:19]
M a[20:23], v[172:175], a[236:239], a[20:23]
M a[20:23], v[168:171], a[232:235], a[20:23]
M a[24:27], v[176:179], a[232:235], a[24:27]
M a[24:27], v[180:183], a[236:239], a[24:27]
M a[28:31], v[188:191], a[236:239], a[28:31]
M a[28:31], v[184:187], a[232:235], a[28:31]
v_bfe_u32 v8, v0, 4, 1
v_lshrrev_b32 v9, 5, v0
v_lshl_or_b32 v8, v8, 1, v9
v_and_b32 v9, 15, v0
v_lshlrev_b32 v9, 13, v9
v_lshl_add_u32 v8, v8, 4, v9
s_and_b32 s3, s101, 1
s_lshl_b32 s3, s3, 6
s_lshr_b32 s6, s101, 1
s_add_u32 s3, s3, s6
s_add_u32 s3, s3, s21
s_lshl_b32 s3, s3, 12
s_lshl_b32 s6, s22, 1
s_add_u32 s3, s3, s6
s_add_u32 s3, s3, 2048
v_accvgpr_read_b32 v20, a0
v_accvgpr_read_b32 v21, a1
v_accvgpr_read_b32 v22, a2
v_accvgpr_read_b32 v23, a3
v_accvgpr_read_b32 v24, a4
v_accvgpr_read_b32 v25, a5
v_accvgpr_read_b32 v26, a6
v_accvgpr_read_b32 v27, a7
v_cvt_pk_bf16_f32 v12, v20, v21
v_cvt_pk_bf16_f32 v13, v22, v23
v_cvt_pk_bf16_f32 v14, v24, v25
v_cvt_pk_bf16_f32 v15, v26, v27
s_nop 0
v_permlane16_swap_b32 v12, v14
v_permlane16_swap_b32 v13, v15
buffer_store_dwordx4 v[12:15], v8, s[16:19], s3 offen offset:0
v_accvgpr_read_b32 v20, a8
v_accvgpr_read_b32 v21, a9
v_accvgpr_read_b32 v22, a10
v_accvgpr_read_b32 v23, a11
v_accvgpr_read_b32 v24, a12
v_accvgpr_read_b32 v25, a13
v_accvgpr_read_b32 v26, a14
v_accvgpr_read_b32 v27, a15
v_cvt_pk_bf16_f32 v16, v20, v21
v_cvt_pk_bf16_f32 v17, v22, v23
v_cvt_pk_bf16_f32 v18, v24, v25
v_cvt_pk_bf16_f32 v19, v26, v27
s_nop 0
v_permlane16_swap_b32 v16, v18
v_permlane16_swap_b32 v17, v19
buffer_store_dwordx4 v[16:19], v8, s[16:19], s3 offen offset:64
s_add_u32 s3, s3, 131072
v_accvgpr_read_b32 v20, a16
v_accvgpr_read_b32 v21, a17
v_accvgpr_read_b32 v22, a18
v_accvgpr_read_b32 v23, a19
v_accvgpr_read_b32 v24, a20
v_accvgpr_read_b32 v25, a21
v_accvgpr_read_b32 v26, a22
v_accvgpr_read_b32 v27, a23
v_cvt_pk_bf16_f32 v12, v20, v21
v_cvt_pk_bf16_f32 v13, v22, v23
v_cvt_pk_bf16_f32 v14, v24, v25
v_cvt_pk_bf16_f32 v15, v26, v27
s_nop 0
v_permlane16_swap_b32 v12, v14
v_permlane16_swap_b32 v13, v15
buffer_store_dwordx4 v[12:15], v8, s[16:19], s3 offen offset:0
v_accvgpr_read_b32 v20, a24
v_accvgpr_read_b32 v21, a25
v_accvgpr_read_b32 v22, a26
v_accvgpr_read_b32 v23, a27
v_accvgpr_read_b32 v24, a28
v_accvgpr_read_b32 v25, a29
v_accvgpr_read_b32 v26, a30
v_accvgpr_read_b32 v27, a31
v_cvt_pk_bf16_f32 v16, v20, v21
v_cvt_pk_bf16_f32 v17, v22, v23
v_cvt_pk_bf16_f32 v18, v24, v25
v_cvt_pk_bf16_f32 v19, v26, v27
s_nop 0
v_permlane16_swap_b32 v16, v18
v_permlane16_swap_b32 v17, v19
buffer_store_dwordx4 v[16:19], v8, s[16:19], s3 offen offset:64
v_bfe_u32 v8, v0, 4, 1
v_lshrrev_b32 v9, 5, v0
v_lshl_or_b32 v8, v8, 1, v9
v_and_b32 v9, 15, v0
v_lshlrev_b32 v9, 12, v9
v_lshl_add_u32 v8, v8, 4, v9
s_lshl_b32 s3, s101, 6
s_add_u32 s3, s3, s29
s_lshl_b32 s3, s3, 12
s_lshl_b32 s6, s30, 1
s_add_u32 s3, s3, s6
s_mov_b32 s6, 0x00003f80
s_mov_b32 s7, 0x3f800000
s_waitcnt vmcnt(4)
v_dot2_f32_bf16 v32, v192, s6, v32
v_dot2_f32_bf16 v33, v192, s7, v33
v_dot2_f32_bf16 v34, v193, s6, v34
v_dot2_f32_bf16 v35, v193, s7, v35
v_dot2_f32_bf16 v36, v194, s6, v36
v_dot2_f32_bf16 v37, v194, s7, v37
v_dot2_f32_bf16 v38, v195, s6, v38
v_dot2_f32_bf16 v39, v195, s7, v39
v_dot2_f32_bf16 v32, v208, s6, v32
v_dot2_f32_bf16 v33, v208, s7, v33
v_dot2_f32_bf16 v34, v209, s6, v34
v_dot2_f32_bf16 v35, v209, s7, v35
v_dot2_f32_bf16 v36, v210, s6, v36
v_dot2_f32_bf16 v37, v210, s7, v37
v_dot2_f32_bf16 v38, v211, s6, v38
v_dot2_f32_bf16 v39, v211, s7, v39
v_dot2_f32_bf16 v32, v224, s6, v32
v_dot2_f32_bf16 v33, v224, s7, v33
v_dot2_f32_bf16 v34, v225, s6, v34
v_dot2_f32_bf16 v35, v225, s7, v35
v_dot2_f32_bf16 v36, v226, s6, v36
v_dot2_f32_bf16 v37, v226, s7, v37
v_dot2_f32_bf16 v38, v227, s6, v38
v_dot2_f32_bf16 v39, v227, s7, v39
v_cvt_pk_bf16_f32 v12, v32, v33
v_cvt_pk_bf16_f32 v13, v34, v35
v_cvt_pk_bf16_f32 v14, v36, v37
v_cvt_pk_bf16_f32 v15, v38, v39
s_nop 0
v_permlane16_swap_b32 v12, v14
v_permlane16_swap_b32 v13, v15
buffer_store_dwordx4 v[12:15], v8, s[16:19], s3 offen offset:0
s_add_u32 s3, s3, 65536
v_dot2_f32_bf16 v64, v196, s6, v64
v_dot2_f32_bf16 v65, v196, s7, v65
v_dot2_f32_bf16 v66, v197, s6, v66
v_dot2_f32_bf16 v67, v197, s7, v67
v_dot2_f32_bf16 v68, v198, s6, v68
v_dot2_f32_bf16 v69, v198, s7, v69
v_dot2_f32_bf16 v70, v199, s6, v70
v_dot2_f32_bf16 v71, v199, s7, v71
v_dot2_f32_bf16 v64, v212, s6, v64
v_dot2_f32_bf16 v65, v212, s7, v65
v_dot2_f32_bf16 v66, v213, s6, v66
v_dot2_f32_bf16 v67, v213, s7, v67
v_dot2_f32_bf16 v68, v214, s6, v68
v_dot2_f32_bf16 v69, v214, s7, v69
v_dot2_f32_bf16 v70, v215, s6, v70
v_dot2_f32_bf16 v71, v215, s7, v71
v_dot2_f32_bf16 v64, v228, s6, v64
v_dot2_f32_bf16 v65, v228, s7, v65
v_dot2_f32_bf16 v66, v229, s6, v66
v_dot2_f32_bf16 v67, v229, s7, v67
v_dot2_f32_bf16 v68, v230, s6, v68
v_dot2_f32_bf16 v69, v230, s7, v69
v_dot2_f32_bf16 v70, v231, s6, v70
v_dot2_f32_bf16 v71, v231, s7, v71
v_cvt_pk_bf16_f32 v16, v64, v65
v_cvt_pk_bf16_f32 v17, v66, v67
v_cvt_pk_bf16_f32 v18, v68, v69
v_cvt_pk_bf16_f32 v19, v70, v71
s_nop 0
v_permlane16_swap_b32 v16, v18
v_permlane16_swap_b32 v17, v19
buffer_store_dwordx4 v[16:19], v8, s[16:19], s3 offen offset:0
s_add_u32 s3, s3, 65536
v_dot2_f32_bf16 v96, v200, s6, v96
v_dot2_f32_bf16 v97, v200, s7, v97
v_dot2_f32_bf16 v98, v201, s6, v98
v_dot2_f32_bf16 v99, v201, s7, v99
v_dot2_f32_bf16 v100, v202, s6, v100
v_dot2_f32_bf16 v101, v202, s7, v101
v_dot2_f32_bf16 v102, v203, s6, v102
v_dot2_f32_bf16 v103, v203, s7, v103
v_dot2_f32_bf16 v96, v216, s6, v96
v_dot2_f32_bf16 v97, v216, s7, v97
v_dot2_f32_bf16 v98, v217, s6, v98
v_dot2_f32_bf16 v99, v217, s7, v99
v_dot2_f32_bf16 v100, v218, s6, v100
v_dot2_f32_bf16 v101, v218, s7, v101
v_dot2_f32_bf16 v102, v219, s6, v102
v_dot2_f32_bf16 v103, v219, s7, v103
v_dot2_f32_bf16 v96, v232, s6, v96
v_dot2_f32_bf16 v97, v232, s7, v97
v_dot2_f32_bf16 v98, v233, s6, v98
v_dot2_f32_bf16 v99, v233, s7, v99
v_dot2_f32_bf16 v100, v234, s6, v100
v_dot2_f32_bf16 v101, v234, s7, v101
v_dot2_f32_bf16 v102, v235, s6, v102
v_dot2_f32_bf16 v103, v235, s7, v103
v_cvt_pk_bf16_f32 v12, v96, v97
v_cvt_pk_bf16_f32 v13, v98, v99
v_cvt_pk_bf16_f32 v14, v100, v101
v_cvt_pk_bf16_f32 v15, v102, v103
s_nop 0
v_permlane16_swap_b32 v12, v14
v_permlane16_swap_b32 v13, v15
buffer_store_dwordx4 v[12:15], v8, s[16:19], s3 offen offset:0
s_add_u32 s3, s3, 65536
v_dot2_f32_bf16 v128, v204, s6, v128
v_dot2_f32_bf16 v129, v204, s7, v129
v_dot2_f32_bf16 v130, v205, s6, v130
v_dot2_f32_bf16 v131, v205, s7, v131
v_dot2_f32_bf16 v132, v206, s6, v132
v_dot2_f32_bf16 v133, v206, s7, v133
v_dot2_f32_bf16 v134, v207, s6, v134
v_dot2_f32_bf16 v135, v207, s7, v135
v_dot2_f32_bf16 v128, v220, s6, v128
v_dot2_f32_bf16 v129, v220, s7, v129
v_dot2_f32_bf16 v130, v221, s6, v130
v_dot2_f32_bf16 v131, v221, s7, v131
v_dot2_f32_bf16 v132, v222, s6, v132
v_dot2_f32_bf16 v133, v222, s7, v133
v_dot2_f32_bf16 v134, v223, s6, v134
v_dot2_f32_bf16 v135, v223, s7, v135
v_dot2_f32_bf16 v128, v236, s6, v128
v_dot2_f32_bf16 v129, v236, s7, v129
v_dot2_f32_bf16 v130, v237, s6, v130
v_dot2_f32_bf16 v131, v237, s7, v131
v_dot2_f32_bf16 v132, v238, s6, v132
v_dot2_f32_bf16 v133, v238, s7, v133
v_dot2_f32_bf16 v134, v239, s6, v134
v_dot2_f32_bf16 v135, v239, s7, v135
v_cvt_pk_bf16_f32 v16, v128, v129
v_cvt_pk_bf16_f32 v17, v130, v131
v_cvt_pk_bf16_f32 v18, v132, v133
v_cvt_pk_bf16_f32 v19, v134, v135
s_nop 0
v_permlane16_swap_b32 v16, v18
v_permlane16_swap_b32 v17, v19
buffer_store_dwordx4 v[16:19], v8, s[16:19], s3 offen offset:0
s_endpgm
Lk3_spinb0:
Lk3_spinb0_:
s_add_u32 s61, s61, 1
s_cmp_gt_u32 s61, 1048576
s_cbranch_scc1 Lk3_gotb0
s_sleep 2
buffer_load_dword v7, v15, s[52:55], s43 offen sc1
s_waitcnt vmcnt(0)
v_cmp_ne_u32 vcc, 1, v7
s_nop 0
s_cbranch_vccnz Lk3_spinb0_
s_branch Lk3_gotb0
Lk3_spinb1:
Lk3_spinb1_:
s_add_u32 s61, s61, 1
s_cmp_gt_u32 s61, 1048576
s_cbranch_scc1 Lk3_gotb1
s_sleep 2
buffer_load_dword v7, v15, s[52:55], s43 offen sc1
s_waitcnt vmcnt(0)
v_cmp_ne_u32 vcc, 1, v7
s_nop 0
s_cbranch_vccnz Lk3_spinb1_
s_branch Lk3_gotb1
Lk3_spinb2:
Lk3_spinb2_:
s_add_u32 s61, s61, 1
s_cmp_gt_u32 s61, 1048576
s_cbranch_scc1 Lk3_gotb2
s_sleep 2
buffer_load_dword v7, v15, s[52:55], s43 offen sc1
s_waitcnt vmcnt(0)
v_cmp_ne_u32 vcc, 1, v7
s_nop 0
s_cbranch_vccnz Lk3_spinb2_
s_branch Lk3_gotb2
Lk3_spinb3:
Lk3_spinb3_:
s_add_u32 s61, s61, 1
s_cmp_gt_u32 s61, 1048576
s_cbranch_scc1 Lk3_gotb3
s_sleep 2
buffer_load_dword v7, v15, s[52:55], s43 offen sc1
s_waitcnt vmcnt(0)
v_cmp_ne_u32 vcc, 1, v7
s_nop 0
s_cbranch_vccnz Lk3_spinb3_
s_branch Lk3_gotb3
Lk3_spinft:
s_add_u32 s61, s61, 1
s_cmp_gt_u32 s61, 1048576
s_cbranch_scc1 Lk3_gotft
s_sleep 2
buffer_load_dword v252, v255, s[52:55], s62 offen sc1
s_waitcnt vmcnt(0)
v_cmp_ne_u32 vcc, 1, v252
s_nop 0
s_cbranch_vccnz Lk3_spinft
s_branch Lk3_gotft
Lk3_spinfl:
s_add_u32 s61, s61, 1
s_cmp_gt_u32 s61, 1048576
s_cbranch_scc1 Lk3_gotfl
s_sleep 2
buffer_load_dword v8, v11, s[52:55], s59 offen sc1
s_waitcnt vmcnt(0)
v_cmp_ne_u32 vcc, 1, v8
s_nop 0
s_cbranch_vccnz Lk3_spinfl
s_branch Lk3_gotfl
Lc3:
.section .rodata,"a"
.p2align 6
.amdhsa_kernel concat_heads__compressed_kv_cla__sliding_local_dilated__prompt_kernel
  .amdhsa_next_free_vgpr 512
  .amdhsa_next_free_sgpr 102
  .amdhsa_accum_offset 256
  .amdhsa_group_segment_fixed_size 0
  .amdhsa_kernarg_size 96
  .amdhsa_user_sgpr_count 2
  .amdhsa_user_sgpr_kernarg_segment_ptr 1
  .amdhsa_system_sgpr_workgroup_id_x 1
.end_amdhsa_kernel
```

```asm
; @launch grid=(256,1,1) block=(256,1,1) lds=163840
.amdgcn_target "amdgcn-amd-amdhsa--gfx950"
.text
.macro M d, a, b, c
v_mfma_f32_16x16x32_bf16 \d, \a, \b, \c
.endm
.globl concat_heads__compressed_kv_cla__sliding_local_dilated__prompt_kernel
.p2align 8
.type concat_heads__compressed_kv_cla__sliding_local_dilated__prompt_kernel,@function
concat_heads__compressed_kv_cla__sliding_local_dilated__prompt_kernel:
s_cmp_lt_u32 s2, 256
s_cbranch_scc1 Lk1_go
s_endpgm
Lk1_go:
s_load_dwordx16 s[32:47], s[0:1], 0
s_load_dwordx2 s[48:49], s[0:1], 64
s_load_dwordx2 s[50:51], s[0:1], 88
s_load_dwordx2 s[90:91], s[0:1], 80
v_lshrrev_b32 v24, 6, v0
s_nop 0
v_readfirstlane_b32 s20, v24
v_and_b32 v0, 63, v0
v_lshlrev_b32 v1, 4, v0
s_mov_b32 s101, s20
s_getpc_b64 s[92:93]
Lpca:
s_add_u32 s92, s92, Lc00-Lpca
s_addc_u32 s93, s93, 0
s_lshr_b32 s94, s2, 3
s_lshl2_add_u32 s94, s94, s101
s_mul_i32 s94, s94, (((Lk1_b-Lc00)/128+127)&~127)
v_lshlrev_b32 v25, 7, v0
v_min_u32 v25, (((Lk1_b-Lc00)/128+127)&~127)-128, v25
v_add_u32 v25, s94, v25
v_min_u32 v25, Lk1_b-Lc00-4, v25
global_load_dword v21, v25, s[92:93]
Lc00:
s_lshr_b32 s21, s20, 1
s_and_b32 s22, s20, 1
s_lshl_b32 s29, s20, 12
s_and_b32 s3, s2, 1
s_lshl_b32 s3, s3, 2
s_bfe_u32 s6, s2, 0x20003
s_add_u32 s3, s3, s6
s_lshl_b32 s52, s3, 8
s_bfe_u32 s3, s2, 0x20001
s_lshl_b32 s3, s3, 2
s_bfe_u32 s7, s2, 0x20005
s_add_u32 s3, s3, s7
s_lshl_b32 s53, s3, 8
s_cmp_lt_u32 s2, 128
s_cselect_b32 s5, 11, 10
s_lshl_b32 s3, s21, 7
s_lshl_b32 s4, s22, 5
s_add_u32 s3, s3, s4
v_lshrrev_b32 v24, 3, v0
v_add_u32 v24, s3, v24
v_and_b32 v25, 7, v0
v_add_u32 v26, 0, v24
v_bfe_u32 v27, v26, 1, 3
v_xor_b32 v27, v27, v25
v_lshlrev_b32 v26, s5, v26
v_lshl_add_u32 v26, v27, 4, v26
v_subrev_u32 v2, 0, v26
v_add_u32 v26, 8, v24
v_bfe_u32 v27, v26, 1, 3
v_xor_b32 v27, v27, v25
v_lshlrev_b32 v26, s5, v26
v_lshl_add_u32 v26, v27, 4, v26
v_subrev_u32 v3, 1024, v26
v_add_u32 v26, 16, v24
v_bfe_u32 v27, v26, 1, 3
v_xor_b32 v27, v27, v25
v_lshlrev_b32 v26, s5, v26
v_lshl_add_u32 v26, v27, 4, v26
v_subrev_u32 v4, 2048, v26
v_add_u32 v26, 24, v24
v_bfe_u32 v27, v26, 1, 3
v_xor_b32 v27, v27, v25
v_lshlrev_b32 v26, s5, v26
v_lshl_add_u32 v26, v27, 4, v26
v_subrev_u32 v5, 3072, v26
s_lshl_b32 s3, s20, 3
v_lshrrev_b32 v24, 5, v0
v_add_u32 v24, s3, v24
v_and_b32 v25, 31, v0
v_add_u32 v26, 0, v24
v_and_b32 v27, 3, v26
v_lshlrev_b32 v27, 1, v27
v_and_or_b32 v27, v26, 8, v27
v_xor_b32 v27, v27, v25
v_lshlrev_b32 v26, 13, v26
v_lshl_add_u32 v26, v27, 4, v26
v_subrev_u32 v6, 0, v26
v_add_u32 v26, 2, v24
v_and_b32 v27, 3, v26
v_lshlrev_b32 v27, 1, v27
v_and_or_b32 v27, v26, 8, v27
v_xor_b32 v27, v27, v25
v_lshlrev_b32 v26, 13, v26
v_lshl_add_u32 v26, v27, 4, v26
v_subrev_u32 v7, 1024, v26
v_add_u32 v26, 4, v24
v_and_b32 v27, 3, v26
v_lshlrev_b32 v27, 1, v27
v_and_or_b32 v27, v26, 8, v27
v_xor_b32 v27, v27, v25
v_lshlrev_b32 v26, 13, v26
v_lshl_add_u32 v26, v27, 4, v26
v_subrev_u32 v8, 2048, v26
v_add_u32 v26, 6, v24
v_and_b32 v27, 3, v26
v_lshlrev_b32 v27, 1, v27
v_and_or_b32 v27, v26, 8, v27
v_xor_b32 v27, v27, v25
v_lshlrev_b32 v26, 13, v26
v_lshl_add_u32 v26, v27, 4, v26
v_subrev_u32 v9, 3072, v26
s_lshl_b32 s23, s52, s5
s_lshl_b32 s31, 64, s5
s_mov_b32 s26, s23
s_lshl_b32 s24, s53, 1
s_mov_b32 s28, s24
s_lshl_b32 s3, 1, s5
s_add_u32 s25, s23, s3
s_lshl_b32 s3, s3, 12
s_add_u32 s27, s24, s3
s_bfe_u32 s3, s2, 0x20001
s_and_b32 s4, s2, 1
s_lshl_b32 s4, s4, 1
s_add_u32 s3, s3, s4
s_and_b32 s3, s3, 3
s_sub_u32 s4, s5, 2
s_lshl_b32 s3, s3, s4
s_add_u32 s23, s23, s3
s_lshl_b32 s3, s3, 12
s_add_u32 s24, s24, s3
s_mov_b32 s95, s6
s_cmp_lt_u32 s2, 128
s_cselect_b32 s6, -1, 8
s_waitcnt lgkmcnt(0)
s_cmp_lt_u32 s2, 128
s_cselect_b64 s[8:9], s[32:33], s[34:35]
s_mov_b32 s10, 2097152
s_cselect_b32 s10, 4194304, s10
s_mov_b32 s11, 0x00020000
s_cselect_b64 s[12:13], s[36:37], s[38:39]
s_mov_b32 s14, 4194304
s_cselect_b32 s14, 8388608, s14
s_mov_b32 s15, 0x00020000
s_mov_b64 s[64:65], s[40:41]
s_add_u32 m0, s29, 65536
s_nop 0
buffer_load_dwordx4 v6, s[12:15], s24 offen offset:0 lds
buffer_load_dwordx4 v7, s[12:15], s24 offen offset:1024 lds
buffer_load_dwordx4 v8, s[12:15], s24 offen offset:2048 lds
buffer_load_dwordx4 v9, s[12:15], s24 offen offset:3072 lds
s_add_u32 s24, s24, 262144
s_add_u32 m0, s29, 0
s_nop 0
buffer_load_dwordx4 v2, s[8:11], s23 offen offset:0 lds
buffer_load_dwordx4 v3, s[8:11], s23 offen offset:1024 lds
buffer_load_dwordx4 v4, s[8:11], s23 offen offset:2048 lds
buffer_load_dwordx4 v5, s[8:11], s23 offen offset:3072 lds
s_add_u32 m0, s29, 81920
s_nop 0
buffer_load_dwordx4 v6, s[12:15], s24 offen offset:0 lds
buffer_load_dwordx4 v7, s[12:15], s24 offen offset:1024 lds
buffer_load_dwordx4 v8, s[12:15], s24 offen offset:2048 lds
buffer_load_dwordx4 v9, s[12:15], s24 offen offset:3072 lds
s_add_u32 s24, s24, 262144
s_cmp_eq_u32 s24, s27
s_cselect_b32 s24, s28, s24
s_sub_u32 s6, s6, 1
s_cmp_eq_u32 s6, 0
s_cselect_b64 s[12:13], s[64:65], s[12:13]
s_add_u32 s16, s50, 117440512
s_addc_u32 s17, s51, 0
s_mov_b32 s18, 16384
s_mov_b32 s19, 0x00020000
v_lshlrev_b32 v23, 20, v0
s_and_b32 s3, s2, 7
s_lshr_b32 s4, s2, 6
s_lshl_b32 s4, s4, 3
s_add_u32 s3, s3, s4
s_lshl_b32 s3, s3, 4
s_add_u32 s3, s3, 4096
s_bfe_u32 s4, s2, 0x30003
s_lshl_b32 s4, s4, 9
s_add_u32 s56, s3, s4
s_sub_u32 s4, 7680, s4
s_add_u32 s57, s3, s4
s_and_b32 s3, s2, 1
s_lshl_b32 s3, s3, 3
s_bfe_u32 s4, s2, 0x30003
s_add_u32 s58, s3, s4
s_bfe_u32 s3, s2, 0x20001
s_lshl_b32 s3, s3, 2
s_lshr_b32 s4, s2, 6
s_xor_b32 s4, s4, 3
s_add_u32 s59, s3, s4
s_lshl_b32 s58, s58, 8
s_lshl_b32 s59, s59, 4
s_add_u32 s58, s58, s59
s_add_u32 s58, s58, 12288
s_lshl_b32 s59, s2, 4
v_lshlrev_b32 v20, 7, v0
s_lshl_b32 s54, s2, 13
s_mov_b64 s[60:61], s[40:41]
s_mov_b32 s62, 0
s_cmp_eq_u32 s20, 1
s_cselect_b64 s[60:61], s[46:47], s[60:61]
s_cselect_b32 s62, 6291456, s62
s_cmp_eq_u32 s20, 2
s_cselect_b64 s[60:61], s[44:45], s[60:61]
s_cselect_b32 s62, 4194304, s62
s_cmp_eq_u32 s20, 3
s_cselect_b32 s62, 0, s62
s_mov_b32 s63, 0x00020000
s_mov_b32 s3, 0
s_cmp_eq_u32 s20, 1
s_cselect_b32 s3, 6291456, s3
s_cmp_eq_u32 s20, 2
s_cselect_b32 s3, 6291456, s3
s_sub_u32 s54, s54, s3
Lc0:
s_add_u32 m0, s29, 98304
s_nop 0
buffer_load_dwordx4 v6, s[12:15], s24 offen offset:0 lds
buffer_load_dwordx4 v7, s[12:15], s24 offen offset:1024 lds
buffer_load_dwordx4 v8, s[12:15], s24 offen offset:2048 lds
buffer_load_dwordx4 v9, s[12:15], s24 offen offset:3072 lds
s_add_u32 s24, s24, 262144
s_lshl_b32 s4, s21, 13
v_and_b32 v24, 15, v0
v_lshlrev_b32 v24, 7, v24
v_add_u32 v24, s4, v24
v_bfe_u32 v25, v0, 1, 3
v_lshrrev_b32 v26, 4, v0
v_xor_b32 v25, v25, v26
v_lshl_add_u32 v10, v25, 4, v24
v_xor_b32 v11, 64, v10
v_bfe_u32 v24, v0, 2, 2
v_lshl_add_u32 v29, v26, 3, v24
v_lshlrev_b32 v25, 9, v29
v_and_b32 v27, 1, v0
v_lshl_add_u32 v25, v27, 3, v25
v_add_u32 v25, 65536, v25
v_lshlrev_b32 v24, 1, v24
v_and_or_b32 v24, v29, 8, v24
v_bfe_u32 v26, v0, 1, 1
s_lshl_b32 s4, s22, 4
s_add_u32 s3, s4, 0
v_add_u32 v27, s3, v26
v_xor_b32 v27, v27, v24
v_lshl_add_u32 v12, v27, 4, v25
s_add_u32 s3, s4, 2
v_add_u32 v27, s3, v26
v_xor_b32 v27, v27, v24
v_lshl_add_u32 v13, v27, 4, v25
s_add_u32 s3, s4, 4
v_add_u32 v27, s3, v26
v_xor_b32 v27, v27, v24
v_lshl_add_u32 v14, v27, 4, v25
s_add_u32 s3, s4, 6
v_add_u32 v27, s3, v26
v_xor_b32 v27, v27, v24
v_lshl_add_u32 v15, v27, 4, v25
s_add_u32 s3, s4, 8
v_add_u32 v27, s3, v26
v_xor_b32 v27, v27, v24
v_lshl_add_u32 v16, v27, 4, v25
s_add_u32 s3, s4, 10
v_add_u32 v27, s3, v26
v_xor_b32 v27, v27, v24
v_lshl_add_u32 v17, v27, 4, v25
s_add_u32 s3, s4, 12
v_add_u32 v27, s3, v26
v_xor_b32 v27, v27, v24
v_lshl_add_u32 v18, v27, 4, v25
s_add_u32 s3, s4, 14
v_add_u32 v27, s3, v26
v_xor_b32 v27, v27, v24
v_lshl_add_u32 v19, v27, 4, v25
v_mov_b32 v28, 0
v_mov_b32 v29, 0
v_mov_b32 v30, 0
v_mov_b32 v31, 0
s_waitcnt vmcnt(4)
s_barrier
ds_read_b64_tr_b16 a[32:33], v12 offset:0
ds_read_b64_tr_b16 a[34:35], v12 offset:2048
ds_read_b64_tr_b16 a[40:41], v13 offset:0
ds_read_b64_tr_b16 a[42:43], v13 offset:2048
ds_read_b64_tr_b16 a[48:49], v14 offset:0
ds_read_b64_tr_b16 a[50:51], v14 offset:2048
ds_read_b64_tr_b16 a[56:57], v15 offset:0
ds_read_b64_tr_b16 a[58:59], v15 offset:2048
ds_read_b64_tr_b16 a[64:65], v16 offset:0
ds_read_b64_tr_b16 a[66:67], v16 offset:2048
ds_read_b64_tr_b16 a[72:73], v17 offset:0
ds_read_b64_tr_b16 a[74:75], v17 offset:2048
ds_read_b64_tr_b16 a[80:81], v18 offset:0
ds_read_b64_tr_b16 a[82:83], v18 offset:2048
ds_read_b64_tr_b16 a[88:89], v19 offset:0
ds_read_b64_tr_b16 a[90:91], v19 offset:2048
ds_read_b64_tr_b16 a[36:37], v12 offset:16384
ds_read_b64_tr_b16 a[38:39], v12 offset:18432
ds_read_b64_tr_b16 a[44:45], v13 offset:16384
ds_read_b64_tr_b16 a[46:47], v13 offset:18432
ds_read_b64_tr_b16 a[52:53], v14 offset:16384
ds_read_b64_tr_b16 a[54:55], v14 offset:18432
ds_read_b64_tr_b16 a[60:61], v15 offset:16384
ds_read_b64_tr_b16 a[62:63], v15 offset:18432
ds_read_b64_tr_b16 a[68:69], v16 offset:16384
ds_read_b64_tr_b16 a[70:71], v16 offset:18432
ds_read_b64_tr_b16 a[76:77], v17 offset:16384
ds_read_b64_tr_b16 a[78:79], v17 offset:18432
ds_read_b64_tr_b16 a[84:85], v18 offset:16384
ds_read_b64_tr_b16 a[86:87], v18 offset:18432
ds_read_b64_tr_b16 a[92:93], v19 offset:16384
ds_read_b64_tr_b16 a[94:95], v19 offset:18432
ds_read_b128 a[160:163], v10 offset:0
ds_read_b128 a[164:167], v11 offset:0
ds_read_b128 a[168:171], v10 offset:2048
ds_read_b128 a[172:175], v11 offset:2048
s_add_u32 m0, s29, 16384
s_add_u32 s3, s23, s31
s_nop 0
buffer_load_dwordx4 v2, s[8:11], s3 offen offset:0 lds
buffer_load_dwordx4 v3, s[8:11], s3 offen offset:1024 lds
buffer_load_dwordx4 v4, s[8:11], s3 offen offset:2048 lds
buffer_load_dwordx4 v5, s[8:11], s3 offen offset:3072 lds
s_add_u32 s23, s23, 128
s_cmp_eq_u32 s23, s25
s_cselect_b32 s23, s26, s23
s_add_u32 m0, s29, 114688
s_nop 0
buffer_load_dwordx4 v6, s[12:15], s24 offen offset:0 lds
buffer_load_dwordx4 v7, s[12:15], s24 offen offset:1024 lds
buffer_load_dwordx4 v8, s[12:15], s24 offen offset:2048 lds
buffer_load_dwordx4 v9, s[12:15], s24 offen offset:3072 lds
s_add_u32 s24, s24, 262144
s_cmp_eq_u32 s24, s27
s_cselect_b32 s24, s28, s24
s_sub_u32 s6, s6, 1
s_cmp_eq_u32 s6, 0
s_cselect_b64 s[12:13], s[64:65], s[12:13]
s_waitcnt vmcnt(8) lgkmcnt(0)
s_barrier
s_getpc_b64 s[92:93]
Lpcb:
s_add_u32 s92, s92, Lk1_b-Lpcb
s_addc_u32 s93, s93, 0
s_lshr_b32 s94, s2, 3
s_lshl2_add_u32 s94, s94, s101
s_mul_i32 s94, s94, (((Lc3-Lk1_b)/128+127)&~127)
v_lshlrev_b32 v24, 7, v0
v_min_u32 v24, (((Lc3-Lk1_b)/128+127)&~127)-128, v24
v_add_u32 v24, s94, v24
v_min_u32 v24, Lc3-Lk1_b-4, v24
global_load_dword v21, v24, s[92:93]
Lc1:
s_cmp_lt_u32 s2, 128
s_cbranch_scc0 Lk1_kv
M v[32:35], a[32:35], a[160:163], 0
s_add_u32 m0, s29, 32768
s_nop 0
buffer_load_dwordx4 v2, s[8:11], s23 offen offset:0 lds
M v[32:35], a[36:39], a[164:167], v[32:35]
ds_read_b128 a[176:179], v10 offset:4096
ds_read_b128 a[180:183], v11 offset:4096
M v[36:39], a[44:47], a[164:167], 0
M v[36:39], a[40:43], a[160:163], v[36:39]
ds_read_b64_tr_b16 a[96:97], v12 offset:32768
ds_read_b64_tr_b16 a[98:99], v12 offset:34816
M v[40:43], a[48:51], a[160:163], 0
M v[40:43], a[52:55], a[164:167], v[40:43]
buffer_load_dwordx4 v3, s[8:11], s23 offen offset:1024 lds
M v[44:47], a[60:63], a[164:167], 0
M v[44:47], a[56:59], a[160:163], v[44:47]
ds_read_b64_tr_b16 a[104:105], v13 offset:32768
ds_read_b64_tr_b16 a[106:107], v13 offset:34816
M v[48:51], a[64:67], a[160:163], 0
M v[48:51], a[68:71], a[164:167], v[48:51]
buffer_load_dwordx4 v4, s[8:11], s23 offen offset:2048 lds
M v[52:55], a[76:79], a[164:167], 0
M v[52:55], a[72:75], a[160:163], v[52:55]
ds_read_b64_tr_b16 a[112:113], v14 offset:32768
ds_read_b64_tr_b16 a[114:115], v14 offset:34816
M v[56:59], a[80:83], a[160:163], 0
M v[56:59], a[84:87], a[164:167], v[56:59]
buffer_load_dwordx4 v5, s[8:11], s23 offen offset:3072 lds
M v[60:63], a[92:95], a[164:167], 0
M v[60:63], a[88:91], a[160:163], v[60:63]
ds_read_b64_tr_b16 a[120:121], v15 offset:32768
ds_read_b64_tr_b16 a[122:123], v15 offset:34816
M v[64:67], a[32:35], a[168:171], 0
M v[64:67], a[36:39], a[172:175], v[64:67]
ds_read_b128 a[184:187], v10 offset:6144
ds_read_b128 a[188:191], v11 offset:6144
M v[68:71], a[44:47], a[172:175], 0
s_add_u32 m0, s29, 65536
s_nop 0
buffer_load_dwordx4 v6, s[12:15], s24 offen offset:0 lds
M v[68:71], a[40:43], a[168:171], v[68:71]
ds_read_b64_tr_b16 a[128:129], v16 offset:32768
ds_read_b64_tr_b16 a[130:131], v16 offset:34816
M v[72:75], a[48:51], a[168:171], 0
M v[72:75], a[52:55], a[172:175], v[72:75]
M v[76:79], a[60:63], a[172:175], 0
buffer_load_dwordx4 v7, s[12:15], s24 offen offset:1024 lds
M v[76:79], a[56:59], a[168:171], v[76:79]
ds_read_b64_tr_b16 a[136:137], v17 offset:32768
ds_read_b64_tr_b16 a[138:139], v17 offset:34816
M v[80:83], a[64:67], a[168:171], 0
M v[80:83], a[68:71], a[172:175], v[80:83]
M v[84:87], a[76:79], a[172:175], 0
buffer_load_dwordx4 v8, s[12:15], s24 offen offset:2048 lds
M v[84:87], a[72:75], a[168:171], v[84:87]
ds_read_b64_tr_b16 a[144:145], v18 offset:32768
ds_read_b64_tr_b16 a[146:147], v18 offset:34816
M v[88:91], a[80:83], a[168:171], 0
M v[88:91], a[84:87], a[172:175], v[88:91]
M v[92:95], a[92:95], a[172:175], 0
buffer_load_dwordx4 v9, s[12:15], s24 offen offset:3072 lds
M v[92:95], a[88:91], a[168:171], v[92:95]
s_waitcnt lgkmcnt(15)
ds_read_b64_tr_b16 a[152:153], v19 offset:32768
ds_read_b64_tr_b16 a[154:155], v19 offset:34816
M v[96:99], a[32:35], a[176:179], 0
M v[96:99], a[36:39], a[180:183], v[96:99]
M v[100:103], a[44:47], a[180:183], 0
s_add_u32 s24, s24, 262144
M v[100:103], a[40:43], a[176:179], v[100:103]
M v[104:107], a[48:51], a[176:179], 0
M v[104:107], a[52:55], a[180:183], v[104:107]
M v[108:111], a[60:63], a[180:183], 0
M v[108:111], a[56:59], a[176:179], v[108:111]
s_waitcnt vmcnt(9) lgkmcnt(0)
s_barrier
ds_read_b128 a[160:163], v10 offset:16384
ds_read_b128 a[164:167], v11 offset:16384
M v[112:115], a[64:67], a[176:179], 0
s_add_u32 m0, s29, 49152
s_add_u32 s3, s23, s31
buffer_load_dwordx4 v2, s[8:11], s3 offen offset:0 lds
M v[112:115], a[68:71], a[180:183], v[112:115]
M v[116:119], a[76:79], a[180:183], 0
M v[116:119], a[72:75], a[176:179], v[116:119]
ds_read_b64_tr_b16 a[100:101], v12 offset:49152
ds_read_b64_tr_b16 a[102:103], v12 offset:51200
M v[120:123], a[80:83], a[176:179], 0
M v[120:123], a[84:87], a[180:183], v[120:123]
buffer_load_dwordx4 v3, s[8:11], s3 offen offset:1024 lds
M v[124:127], a[92:95], a[180:183], 0
M v[124:127], a[88:91], a[176:179], v[124:127]
M v[128:131], a[32:35], a[184:187], 0
M v[128:131], a[36:39], a[188:191], v[128:131]
ds_read_b128 a[168:171], v10 offset:18432
ds_read_b128 a[172:175], v11 offset:18432
ds_read_b64_tr_b16 a[108:109], v13 offset:49152
ds_read_b64_tr_b16 a[110:111], v13 offset:51200
M v[132:135], a[44:47], a[188:191], 0
M v[132:135], a[40:43], a[184:187], v[132:135]
buffer_load_dwordx4 v4, s[8:11], s3 offen offset:2048 lds
M v[136:139], a[48:51], a[184:187], 0
M v[136:139], a[52:55], a[188:191], v[136:139]
M v[140:143], a[60:63], a[188:191], 0
M v[140:143], a[56:59], a[184:187], v[140:143]
ds_read_b64_tr_b16 a[116:117], v14 offset:49152
ds_read_b64_tr_b16 a[118:119], v14 offset:51200
M v[144:147], a[64:67], a[184:187], 0
M v[144:147], a[68:71], a[188:191], v[144:147]
buffer_load_dwordx4 v5, s[8:11], s3 offen offset:3072 lds
M v[148:151], a[76:79], a[188:191], 0
M v[148:151], a[72:75], a[184:187], v[148:151]
M v[152:155], a[80:83], a[184:187], 0
M v[152:155], a[84:87], a[188:191], v[152:155]
ds_read_b64_tr_b16 a[124:125], v15 offset:49152
ds_read_b64_tr_b16 a[126:127], v15 offset:51200
M v[156:159], a[92:95], a[188:191], 0
s_add_u32 s23, s23, 128
s_cmp_eq_u32 s23, s25
s_cselect_b32 s23, s26, s23
M v[156:159], a[88:91], a[184:187], v[156:159]
s_waitcnt lgkmcnt(10)
M v[160:163], a[32:35], a[160:163], 0
M v[160:163], a[36:39], a[164:167], v[160:163]
ds_read_b128 a[176:179], v10 offset:20480
ds_read_b128 a[180:183], v11 offset:20480
M v[164:167], a[44:47], a[164:167], 0
M v[164:167], a[40:43], a[160:163], v[164:167]
ds_read_b64_tr_b16 a[132:133], v16 offset:49152
ds_read_b64_tr_b16 a[134:135], v16 offset:51200
M v[168:171], a[48:51], a[160:163], 0
M v[168:171], a[52:55], a[164:167], v[168:171]
s_add_u32 m0, s29, 81920
s_nop 0
buffer_load_dwordx4 v6, s[12:15], s24 offen offset:0 lds
M v[172:175], a[60:63], a[164:167], 0
M v[172:175], a[56:59], a[160:163], v[172:175]
M v[176:179], a[64:67], a[160:163], 0
M v[176:179], a[68:71], a[164:167], v[176:179]
ds_read_b64_tr_b16 a[140:141], v17 offset:49152
ds_read_b64_tr_b16 a[142:143], v17 offset:51200
M v[180:183], a[76:79], a[164:167], 0
M v[180:183], a[72:75], a[160:163], v[180:183]
buffer_load_dwordx4 v7, s[12:15], s24 offen offset:1024 lds
M v[184:187], a[80:83], a[160:163], 0
M v[184:187], a[84:87], a[164:167], v[184:187]
M v[188:191], a[92:95], a[164:167], 0
M v[188:191], a[88:91], a[160:163], v[188:191]
s_waitcnt lgkmcnt(12)
ds_read_b64_tr_b16 a[148:149], v18 offset:49152
ds_read_b64_tr_b16 a[150:151], v18 offset:51200
M v[192:195], a[32:35], a[168:171], 0
buffer_load_dwordx4 v8, s[12:15], s24 offen offset:2048 lds
M v[192:195], a[36:39], a[172:175], v[192:195]
ds_read_b128 a[184:187], v10 offset:22528
ds_read_b128 a[188:191], v11 offset:22528
M v[196:199], a[44:47], a[172:175], 0
M v[196:199], a[40:43], a[168:171], v[196:199]
M v[200:203], a[48:51], a[168:171], 0
M v[200:203], a[52:55], a[172:175], v[200:203]
ds_read_b64_tr_b16 a[156:157], v19 offset:49152
ds_read_b64_tr_b16 a[158:159], v19 offset:51200
M v[204:207], a[60:63], a[172:175], 0
buffer_load_dwordx4 v9, s[12:15], s24 offen offset:3072 lds
M v[204:207], a[56:59], a[168:171], v[204:207]
M v[208:211], a[64:67], a[168:171], 0
M v[208:211], a[68:71], a[172:175], v[208:211]
M v[212:215], a[76:79], a[172:175], 0
M v[212:215], a[72:75], a[168:171], v[212:215]
s_add_u32 s24, s24, 262144
s_cmp_eq_u32 s24, s27
s_cselect_b32 s24, s28, s24
s_sub_u32 s6, s6, 1
s_cmp_eq_u32 s6, 0
s_cselect_b64 s[12:13], s[64:65], s[12:13]
M v[216:219], a[80:83], a[168:171], 0
M v[216:219], a[84:87], a[172:175], v[216:219]
M v[220:223], a[92:95], a[172:175], 0
M v[220:223], a[88:91], a[168:171], v[220:223]
s_waitcnt lgkmcnt(10)
M v[224:227], a[32:35], a[176:179], 0
buffer_load_dword v21, v20, s[60:63], s54 offen
s_add_u32 s54, s54, 1048576
M v[224:227], a[36:39], a[180:183], v[224:227]
M v[228:231], a[44:47], a[180:183], 0
M v[228:231], a[40:43], a[176:179], v[228:231]
M v[232:235], a[48:51], a[176:179], 0
M v[232:235], a[52:55], a[180:183], v[232:235]
M v[236:239], a[60:63], a[180:183], 0
M v[236:239], a[56:59], a[176:179], v[236:239]
s_waitcnt vmcnt(9) lgkmcnt(0)
s_barrier
ds_read_b128 a[160:163], v10 offset:32768
ds_read_b128 a[164:167], v11 offset:32768
M v[240:243], a[64:67], a[176:179], 0
s_add_u32 m0, s29, 0
s_nop 0
buffer_load_dwordx4 v2, s[8:11], s23 offen offset:0 lds
M v[240:243], a[68:71], a[180:183], v[240:243]
M v[244:247], a[76:79], a[180:183], 0
M v[244:247], a[72:75], a[176:179], v[244:247]
M v[248:251], a[80:83], a[176:179], 0
M v[248:251], a[84:87], a[180:183], v[248:251]
buffer_load_dwordx4 v3, s[8:11], s23 offen offset:1024 lds
M v[252:255], a[92:95], a[180:183], 0
M v[252:255], a[88:91], a[176:179], v[252:255]
M a[0:3], a[32:35], a[184:187], 0
M a[0:3], a[36:39], a[188:191], a[0:3]
ds_read_b128 a[168:171], v10 offset:34816
ds_read_b128 a[172:175], v11 offset:34816
M a[4:7], a[44:47], a[188:191], 0
M a[4:7], a[40:43], a[184:187], a[4:7]
M a[8:11], a[48:51], a[184:187], 0
buffer_load_dwordx4 v4, s[8:11], s23 offen offset:2048 lds
M a[8:11], a[52:55], a[188:191], a[8:11]
M a[12:15], a[60:63], a[188:191], 0
M a[12:15], a[56:59], a[184:187], a[12:15]
M a[16:19], a[64:67], a[184:187], 0
M a[16:19], a[68:71], a[188:191], a[16:19]
buffer_load_dwordx4 v5, s[8:11], s23 offen offset:3072 lds
M a[20:23], a[76:79], a[188:191], 0
M a[20:23], a[72:75], a[184:187], a[20:23]
M a[24:27], a[80:83], a[184:187], 0
M a[24:27], a[84:87], a[188:191], a[24:27]
M a[28:31], a[92:95], a[188:191], 0
M a[28:31], a[88:91], a[184:187], a[28:31]
s_waitcnt lgkmcnt(2)
M v[32:35], a[96:99], a[160:163], v[32:35]
s_add_u32 m0, s29, 98304
s_nop 0
buffer_load_dwordx4 v6, s[12:15], s24 offen offset:0 lds
M v[32:35], a[100:103], a[164:167], v[32:35]
ds_read_b128 a[176:179], v10 offset:36864
ds_read_b128 a[180:183], v11 offset:36864
M v[36:39], a[108:111], a[164:167], v[36:39]
M v[36:39], a[104:107], a[160:163], v[36:39]
ds_read_b64_tr_b16 a[32:33], v12 offset:0
ds_read_b64_tr_b16 a[34:35], v12 offset:2048
M v[40:43], a[112:115], a[160:163], v[40:43]
M v[40:43], a[116:119], a[164:167], v[40:43]
M v[44:47], a[124:127], a[164:167], v[44:47]
M v[44:47], a[120:123], a[160:163], v[44:47]
ds_read_b64_tr_b16 a[40:41], v13 offset:0
ds_read_b64_tr_b16 a[42:43], v13 offset:2048
M v[48:51], a[128:131], a[160:163], v[48:51]
buffer_load_dwordx4 v7, s[12:15], s24 offen offset:1024 lds
M v[48:51], a[132:135], a[164:167], v[48:51]
M v[52:55], a[140:143], a[164:167], v[52:55]
M v[52:55], a[136:139], a[160:163], v[52:55]
ds_read_b64_tr_b16 a[48:49], v14 offset:0
ds_read_b64_tr_b16 a[50:51], v14 offset:2048
M v[56:59], a[144:147], a[160:163], v[56:59]
M v[56:59], a[148:151], a[164:167], v[56:59]
M v[60:63], a[156:159], a[164:167], v[60:63]
buffer_load_dwordx4 v8, s[12:15], s24 offen offset:2048 lds
M v[60:63], a[152:155], a[160:163], v[60:63]
s_waitcnt lgkmcnt(8)
ds_read_b64_tr_b16 a[56:57], v15 offset:0
ds_read_b64_tr_b16 a[58:59], v15 offset:2048
M v[64:67], a[96:99], a[168:171], v[64:67]
M v[64:67], a[100:103], a[172:175], v[64:67]
ds_read_b128 a[184:187], v10 offset:38912
ds_read_b128 a[188:191], v11 offset:38912
M v[68:71], a[108:111], a[172:175], v[68:71]
M v[68:71], a[104:107], a[168:171], v[68:71]
ds_read_b64_tr_b16 a[64:65], v16 offset:0
ds_read_b64_tr_b16 a[66:67], v16 offset:2048
M v[72:75], a[112:115], a[168:171], v[72:75]
M v[72:75], a[116:119], a[172:175], v[72:75]
M v[76:79], a[124:127], a[172:175], v[76:79]
M v[76:79], a[120:123], a[168:171], v[76:79]
ds_read_b64_tr_b16 a[72:73], v17 offset:0
ds_read_b64_tr_b16 a[74:75], v17 offset:2048
M v[80:83], a[128:131], a[168:171], v[80:83]
buffer_load_dwordx4 v9, s[12:15], s24 offen offset:3072 lds
M v[80:83], a[132:135], a[172:175], v[80:83]
M v[84:87], a[140:143], a[172:175], v[84:87]
M v[84:87], a[136:139], a[168:171], v[84:87]
ds_read_b64_tr_b16 a[80:81], v18 offset:0
ds_read_b64_tr_b16 a[82:83], v18 offset:2048
M v[88:91], a[144:147], a[168:171], v[88:91]
M v[88:91], a[148:151], a[172:175], v[88:91]
M v[92:95], a[156:159], a[172:175], v[92:95]
s_add_u32 s24, s24, 262144
M v[92:95], a[152:155], a[168:171], v[92:95]
s_waitcnt lgkmcnt(15)
ds_read_b64_tr_b16 a[88:89], v19 offset:0
ds_read_b64_tr_b16 a[90:91], v19 offset:2048
M v[96:99], a[96:99], a[176:179], v[96:99]
M v[96:99], a[100:103], a[180:183], v[96:99]
M v[100:103], a[108:111], a[180:183], v[100:103]
M v[100:103], a[104:107], a[176:179], v[100:103]
M v[104:107], a[112:115], a[176:179], v[104:107]
M v[104:107], a[116:119], a[180:183], v[104:107]
M v[108:111], a[124:127], a[180:183], v[108:111]
M v[108:111], a[120:123], a[176:179], v[108:111]
s_waitcnt vmcnt(9) lgkmcnt(0)
s_barrier
ds_read_b128 a[160:163], v10 offset:49152
ds_read_b128 a[164:167], v11 offset:49152
M v[112:115], a[128:131], a[176:179], v[112:115]
s_add_u32 m0, s29, 16384
s_add_u32 s3, s23, s31
buffer_load_dwordx4 v2, s[8:11], s3 offen offset:0 lds
M v[112:115], a[132:135], a[180:183], v[112:115]
M v[116:119], a[140:143], a[180:183], v[116:119]
M v[116:119], a[136:139], a[176:179], v[116:119]
ds_read_b64_tr_b16 a[36:37], v12 offset:16384
ds_read_b64_tr_b16 a[38:39], v12 offset:18432
M v[120:123], a[144:147], a[176:179], v[120:123]
M v[120:123], a[148:151], a[180:183], v[120:123]
buffer_load_dwordx4 v3, s[8:11], s3 offen offset:1024 lds
M v[124:127], a[156:159], a[180:183], v[124:127]
M v[124:127], a[152:155], a[176:179], v[124:127]
M v[128:131], a[96:99], a[184:187], v[128:131]
M v[128:131], a[100:103], a[188:191], v[128:131]
ds_read_b128 a[168:171], v10 offset:51200
ds_read_b128 a[172:175], v11 offset:51200
ds_read_b64_tr_b16 a[44:45], v13 offset:16384
ds_read_b64_tr_b16 a[46:47], v13 offset:18432
M v[132:135], a[108:111], a[188:191], v[132:135]
M v[132:135], a[104:107], a[184:187], v[132:135]
buffer_load_dwordx4 v4, s[8:11], s3 offen offset:2048 lds
M v[136:139], a[112:115], a[184:187], v[136:139]
M v[136:139], a[116:119], a[188:191], v[136:139]
M v[140:143], a[124:127], a[188:191], v[140:143]
M v[140:143], a[120:123], a[184:187], v[140:143]
ds_read_b64_tr_b16 a[52:53], v14 offset:16384
ds_read_b64_tr_b16 a[54:55], v14 offset:18432
M v[144:147], a[128:131], a[184:187], v[144:147]
buffer_load_dwordx4 v5, s[8:11], s3 offen offset:3072 lds
M v[144:147], a[132:135], a[188:191], v[144:147]
M v[148:151], a[140:143], a[188:191], v[148:151]
M v[148:151], a[136:139], a[184:187], v[148:151]
M v[152:155], a[144:147], a[184:187], v[152:155]
buffer_store_dwordx4 v[28:31], v23, s[16:19], s56 offen sc1
M v[152:155], a[148:151], a[188:191], v[152:155]
ds_read_b64_tr_b16 a[60:61], v15 offset:16384
ds_read_b64_tr_b16 a[62:63], v15 offset:18432
M v[156:159], a[156:159], a[188:191], v[156:159]
s_add_u32 s23, s23, 128
s_cmp_eq_u32 s23, s25
s_cselect_b32 s23, s26, s23
M v[156:159], a[152:155], a[184:187], v[156:159]
s_waitcnt lgkmcnt(10)
M v[160:163], a[96:99], a[160:163], v[160:163]
M v[160:163], a[100:103], a[164:167], v[160:163]
ds_read_b128 a[176:179], v10 offset:53248
ds_read_b128 a[180:183], v11 offset:53248
M v[164:167], a[108:111], a[164:167], v[164:167]
M v[164:167], a[104:107], a[160:163], v[164:167]
ds_read_b64_tr_b16 a[68:69], v16 offset:16384
ds_read_b64_tr_b16 a[70:71], v16 offset:18432
M v[168:171], a[112:115], a[160:163], v[168:171]
M v[168:171], a[116:119], a[164:167], v[168:171]
s_add_u32 m0, s29, 114688
s_nop 0
buffer_load_dwordx4 v6, s[12:15], s24 offen offset:0 lds
M v[172:175], a[124:127], a[164:167], v[172:175]
M v[172:175], a[120:123], a[160:163], v[172:175]
M v[176:179], a[128:131], a[160:163], v[176:179]
buffer_store_dwordx4 v[28:31], v23, s[16:19], s57 offen sc1
M v[176:179], a[132:135], a[164:167], v[176:179]
ds_read_b64_tr_b16 a[76:77], v17 offset:16384
ds_read_b64_tr_b16 a[78:79], v17 offset:18432
M v[180:183], a[140:143], a[164:167], v[180:183]
M v[180:183], a[136:139], a[160:163], v[180:183]
buffer_load_dwordx4 v7, s[12:15], s24 offen offset:1024 lds
M v[184:187], a[144:147], a[160:163], v[184:187]
M v[184:187], a[148:151], a[164:167], v[184:187]
M v[188:191], a[156:159], a[164:167], v[188:191]
M v[188:191], a[152:155], a[160:163], v[188:191]
s_waitcnt lgkmcnt(12)
ds_read_b64_tr_b16 a[84:85], v18 offset:16384
ds_read_b64_tr_b16 a[86:87], v18 offset:18432
M v[192:195], a[96:99], a[168:171], v[192:195]
buffer_load_dwordx4 v8, s[12:15], s24 offen offset:2048 lds
M v[192:195], a[100:103], a[172:175], v[192:195]
ds_read_b128 a[184:187], v10 offset:55296
ds_read_b128 a[188:191], v11 offset:55296
M v[196:199], a[108:111], a[172:175], v[196:199]
M v[196:199], a[104:107], a[168:171], v[196:199]
M v[200:203], a[112:115], a[168:171], v[200:203]
buffer_store_dwordx4 v[28:31], v23, s[16:19], s58 offen sc1
M v[200:203], a[116:119], a[172:175], v[200:203]
ds_read_b64_tr_b16 a[92:93], v19 offset:16384
ds_read_b64_tr_b16 a[94:95], v19 offset:18432
M v[204:207], a[124:127], a[172:175], v[204:207]
M v[204:207], a[120:123], a[168:171], v[204:207]
buffer_load_dwordx4 v9, s[12:15], s24 offen offset:3072 lds
M v[208:211], a[128:131], a[168:171], v[208:211]
M v[208:211], a[132:135], a[172:175], v[208:211]
M v[212:215], a[140:143], a[172:175], v[212:215]
M v[212:215], a[136:139], a[168:171], v[212:215]
s_add_u32 s24, s24, 262144
s_cmp_eq_u32 s24, s27
s_cselect_b32 s24, s28, s24
s_sub_u32 s6, s6, 1
s_cmp_eq_u32 s6, 0
s_cselect_b64 s[12:13], s[64:65], s[12:13]
M v[216:219], a[144:147], a[168:171], v[216:219]
M v[216:219], a[148:151], a[172:175], v[216:219]
M v[220:223], a[156:159], a[172:175], v[220:223]
M v[220:223], a[152:155], a[168:171], v[220:223]
s_waitcnt lgkmcnt(10)
M v[224:227], a[96:99], a[176:179], v[224:227]
buffer_store_dwordx4 v[28:31], v23, s[16:19], s59 offen sc1
M v[224:227], a[100:103], a[180:183], v[224:227]
buffer_load_dword v21, v20, s[60:63], s54 offen
s_add_u32 s54, s54, 1048576
M v[228:231], a[108:111], a[180:183], v[228:231]
M v[228:231], a[104:107], a[176:179], v[228:231]
M v[232:235], a[112:115], a[176:179], v[232:235]
M v[232:235], a[116:119], a[180:183], v[232:235]
M v[236:239], a[124:127], a[180:183], v[236:239]
M v[236:239], a[120:123], a[176:179], v[236:239]
s_waitcnt vmcnt(13) lgkmcnt(0)
s_barrier
ds_read_b128 a[160:163], v10 offset:0
ds_read_b128 a[164:167], v11 offset:0
M v[240:243], a[128:131], a[176:179], v[240:243]
s_add_u32 m0, s29, 32768
s_nop 0
buffer_load_dwordx4 v2, s[8:11], s23 offen offset:0 lds
M v[240:243], a[132:135], a[180:183], v[240:243]
M v[244:247], a[140:143], a[180:183], v[244:247]
M v[244:247], a[136:139], a[176:179], v[244:247]
M v[248:251], a[144:147], a[176:179], v[248:251]
M v[248:251], a[148:151], a[180:183], v[248:251]
buffer_load_dwordx4 v3, s[8:11], s23 offen offset:1024 lds
M v[252:255], a[156:159], a[180:183], v[252:255]
M v[252:255], a[152:155], a[176:179], v[252:255]
M a[0:3], a[96:99], a[184:187], a[0:3]
M a[0:3], a[100:103], a[188:191], a[0:3]
ds_read_b128 a[168:171], v10 offset:2048
ds_read_b128 a[172:175], v11 offset:2048
M a[4:7], a[108:111], a[188:191], a[4:7]
M a[4:7], a[104:107], a[184:187], a[4:7]
M a[8:11], a[112:115], a[184:187], a[8:11]
buffer_load_dwordx4 v4, s[8:11], s23 offen offset:2048 lds
M a[8:11], a[116:119], a[188:191], a[8:11]
M a[12:15], a[124:127], a[188:191], a[12:15]
M a[12:15], a[120:123], a[184:187], a[12:15]
M a[16:19], a[128:131], a[184:187], a[16:19]
M a[16:19], a[132:135], a[188:191], a[16:19]
buffer_load_dwordx4 v5, s[8:11], s23 offen offset:3072 lds
M a[20:23], a[140:143], a[188:191], a[20:23]
M a[20:23], a[136:139], a[184:187], a[20:23]
M a[24:27], a[144:147], a[184:187], a[24:27]
M a[24:27], a[148:151], a[188:191], a[24:27]
M a[28:31], a[156:159], a[188:191], a[28:31]
M a[28:31], a[152:155], a[184:187], a[28:31]
s_waitcnt lgkmcnt(2)
s_mov_b32 s30, 5
Lk1_ql:
M v[32:35], a[32:35], a[160:163], v[32:35]
s_add_u32 m0, s29, 65536
s_nop 0
buffer_load_dwordx4 v6, s[12:15], s24 offen offset:0 lds
M v[32:35], a[36:39], a[164:167], v[32:35]
ds_read_b128 a[176:179], v10 offset:4096
ds_read_b128 a[180:183], v11 offset:4096
M v[36:39], a[44:47], a[164:167], v[36:39]
M v[36:39], a[40:43], a[160:163], v[36:39]
ds_read_b64_tr_b16 a[96:97], v12 offset:32768
ds_read_b64_tr_b16 a[98:99], v12 offset:34816
M v[40:43], a[48:51], a[160:163], v[40:43]
M v[40:43], a[52:55], a[164:167], v[40:43]
M v[44:47], a[60:63], a[164:167], v[44:47]
M v[44:47], a[56:59], a[160:163], v[44:47]
ds_read_b64_tr_b16 a[104:105], v13 offset:32768
ds_read_b64_tr_b16 a[106:107], v13 offset:34816
M v[48:51], a[64:67], a[160:163], v[48:51]
buffer_load_dwordx4 v7, s[12:15], s24 offen offset:1024 lds
M v[48:51], a[68:71], a[164:167], v[48:51]
M v[52:55], a[76:79], a[164:167], v[52:55]
M v[52:55], a[72:75], a[160:163], v[52:55]
ds_read_b64_tr_b16 a[112:113], v14 offset:32768
ds_read_b64_tr_b16 a[114:115], v14 offset:34816
M v[56:59], a[80:83], a[160:163], v[56:59]
M v[56:59], a[84:87], a[164:167], v[56:59]
M v[60:63], a[92:95], a[164:167], v[60:63]
buffer_load_dwordx4 v8, s[12:15], s24 offen offset:2048 lds
M v[60:63], a[88:91], a[160:163], v[60:63]
s_waitcnt lgkmcnt(8)
ds_read_b64_tr_b16 a[120:121], v15 offset:32768
ds_read_b64_tr_b16 a[122:123], v15 offset:34816
M v[64:67], a[32:35], a[168:171], v[64:67]
M v[64:67], a[36:39], a[172:175], v[64:67]
ds_read_b128 a[184:187], v10 offset:6144
ds_read_b128 a[188:191], v11 offset:6144
M v[68:71], a[44:47], a[172:175], v[68:71]
M v[68:71], a[40:43], a[168:171], v[68:71]
ds_read_b64_tr_b16 a[128:129], v16 offset:32768
ds_read_b64_tr_b16 a[130:131], v16 offset:34816
M v[72:75], a[48:51], a[168:171], v[72:75]
M v[72:75], a[52:55], a[172:175], v[72:75]
M v[76:79], a[60:63], a[172:175], v[76:79]
M v[76:79], a[56:59], a[168:171], v[76:79]
ds_read_b64_tr_b16 a[136:137], v17 offset:32768
ds_read_b64_tr_b16 a[138:139], v17 offset:34816
M v[80:83], a[64:67], a[168:171], v[80:83]
buffer_load_dwordx4 v9, s[12:15], s24 offen offset:3072 lds
M v[80:83], a[68:71], a[172:175], v[80:83]
M v[84:87], a[76:79], a[172:175], v[84:87]
M v[84:87], a[72:75], a[168:171], v[84:87]
ds_read_b64_tr_b16 a[144:145], v18 offset:32768
ds_read_b64_tr_b16 a[146:147], v18 offset:34816
M v[88:91], a[80:83], a[168:171], v[88:91]
M v[88:91], a[84:87], a[172:175], v[88:91]
M v[92:95], a[92:95], a[172:175], v[92:95]
s_add_u32 s24, s24, 262144
M v[92:95], a[88:91], a[168:171], v[92:95]
s_waitcnt lgkmcnt(15)
ds_read_b64_tr_b16 a[152:153], v19 offset:32768
ds_read_b64_tr_b16 a[154:155], v19 offset:34816
M v[96:99], a[32:35], a[176:179], v[96:99]
M v[96:99], a[36:39], a[180:183], v[96:99]
M v[100:103], a[44:47], a[180:183], v[100:103]
M v[100:103], a[40:43], a[176:179], v[100:103]
M v[104:107], a[48:51], a[176:179], v[104:107]
M v[104:107], a[52:55], a[180:183], v[104:107]
M v[108:111], a[60:63], a[180:183], v[108:111]
M v[108:111], a[56:59], a[176:179], v[108:111]
s_waitcnt vmcnt(9) lgkmcnt(0)
s_barrier
ds_read_b128 a[160:163], v10 offset:16384
ds_read_b128 a[164:167], v11 offset:16384
M v[112:115], a[64:67], a[176:179], v[112:115]
s_add_u32 m0, s29, 49152
s_add_u32 s3, s23, s31
buffer_load_dwordx4 v2, s[8:11], s3 offen offset:0 lds
M v[112:115], a[68:71], a[180:183], v[112:115]
M v[116:119], a[76:79], a[180:183], v[116:119]
M v[116:119], a[72:75], a[176:179], v[116:119]
ds_read_b64_tr_b16 a[100:101], v12 offset:49152
ds_read_b64_tr_b16 a[102:103], v12 offset:51200
M v[120:123], a[80:83], a[176:179], v[120:123]
M v[120:123], a[84:87], a[180:183], v[120:123]
buffer_load_dwordx4 v3, s[8:11], s3 offen offset:1024 lds
M v[124:127], a[92:95], a[180:183], v[124:127]
M v[124:127], a[88:91], a[176:179], v[124:127]
M v[128:131], a[32:35], a[184:187], v[128:131]
M v[128:131], a[36:39], a[188:191], v[128:131]
ds_read_b128 a[168:171], v10 offset:18432
ds_read_b128 a[172:175], v11 offset:18432
ds_read_b64_tr_b16 a[108:109], v13 offset:49152
ds_read_b64_tr_b16 a[110:111], v13 offset:51200
M v[132:135], a[44:47], a[188:191], v[132:135]
M v[132:135], a[40:43], a[184:187], v[132:135]
buffer_load_dwordx4 v4, s[8:11], s3 offen offset:2048 lds
M v[136:139], a[48:51], a[184:187], v[136:139]
M v[136:139], a[52:55], a[188:191], v[136:139]
M v[140:143], a[60:63], a[188:191], v[140:143]
M v[140:143], a[56:59], a[184:187], v[140:143]
ds_read_b64_tr_b16 a[116:117], v14 offset:49152
ds_read_b64_tr_b16 a[118:119], v14 offset:51200
M v[144:147], a[64:67], a[184:187], v[144:147]
M v[144:147], a[68:71], a[188:191], v[144:147]
buffer_load_dwordx4 v5, s[8:11], s3 offen offset:3072 lds
M v[148:151], a[76:79], a[188:191], v[148:151]
M v[148:151], a[72:75], a[184:187], v[148:151]
M v[152:155], a[80:83], a[184:187], v[152:155]
M v[152:155], a[84:87], a[188:191], v[152:155]
ds_read_b64_tr_b16 a[124:125], v15 offset:49152
ds_read_b64_tr_b16 a[126:127], v15 offset:51200
M v[156:159], a[92:95], a[188:191], v[156:159]
s_add_u32 s23, s23, 128
s_cmp_eq_u32 s23, s25
s_cselect_b32 s23, s26, s23
M v[156:159], a[88:91], a[184:187], v[156:159]
s_waitcnt lgkmcnt(10)
M v[160:163], a[32:35], a[160:163], v[160:163]
M v[160:163], a[36:39], a[164:167], v[160:163]
ds_read_b128 a[176:179], v10 offset:20480
ds_read_b128 a[180:183], v11 offset:20480
M v[164:167], a[44:47], a[164:167], v[164:167]
M v[164:167], a[40:43], a[160:163], v[164:167]
ds_read_b64_tr_b16 a[132:133], v16 offset:49152
ds_read_b64_tr_b16 a[134:135], v16 offset:51200
M v[168:171], a[48:51], a[160:163], v[168:171]
M v[168:171], a[52:55], a[164:167], v[168:171]
s_add_u32 m0, s29, 81920
s_nop 0
buffer_load_dwordx4 v6, s[12:15], s24 offen offset:0 lds
M v[172:175], a[60:63], a[164:167], v[172:175]
M v[172:175], a[56:59], a[160:163], v[172:175]
M v[176:179], a[64:67], a[160:163], v[176:179]
M v[176:179], a[68:71], a[164:167], v[176:179]
ds_read_b64_tr_b16 a[140:141], v17 offset:49152
ds_read_b64_tr_b16 a[142:143], v17 offset:51200
M v[180:183], a[76:79], a[164:167], v[180:183]
M v[180:183], a[72:75], a[160:163], v[180:183]
buffer_load_dwordx4 v7, s[12:15], s24 offen offset:1024 lds
M v[184:187], a[80:83], a[160:163], v[184:187]
M v[184:187], a[84:87], a[164:167], v[184:187]
M v[188:191], a[92:95], a[164:167], v[188:191]
M v[188:191], a[88:91], a[160:163], v[188:191]
s_waitcnt lgkmcnt(12)
ds_read_b64_tr_b16 a[148:149], v18 offset:49152
ds_read_b64_tr_b16 a[150:151], v18 offset:51200
M v[192:195], a[32:35], a[168:171], v[192:195]
buffer_load_dwordx4 v8, s[12:15], s24 offen offset:2048 lds
M v[192:195], a[36:39], a[172:175], v[192:195]
ds_read_b128 a[184:187], v10 offset:22528
ds_read_b128 a[188:191], v11 offset:22528
M v[196:199], a[44:47], a[172:175], v[196:199]
M v[196:199], a[40:43], a[168:171], v[196:199]
M v[200:203], a[48:51], a[168:171], v[200:203]
M v[200:203], a[52:55], a[172:175], v[200:203]
ds_read_b64_tr_b16 a[156:157], v19 offset:49152
ds_read_b64_tr_b16 a[158:159], v19 offset:51200
M v[204:207], a[60:63], a[172:175], v[204:207]
buffer_load_dwordx4 v9, s[12:15], s24 offen offset:3072 lds
M v[204:207], a[56:59], a[168:171], v[204:207]
M v[208:211], a[64:67], a[168:171], v[208:211]
M v[208:211], a[68:71], a[172:175], v[208:211]
M v[212:215], a[76:79], a[172:175], v[212:215]
M v[212:215], a[72:75], a[168:171], v[212:215]
s_add_u32 s24, s24, 262144
s_cmp_eq_u32 s24, s27
s_cselect_b32 s24, s28, s24
s_sub_u32 s6, s6, 1
s_cmp_eq_u32 s6, 0
s_cselect_b64 s[12:13], s[64:65], s[12:13]
M v[216:219], a[80:83], a[168:171], v[216:219]
M v[216:219], a[84:87], a[172:175], v[216:219]
M v[220:223], a[92:95], a[172:175], v[220:223]
M v[220:223], a[88:91], a[168:171], v[220:223]
s_waitcnt lgkmcnt(10)
M v[224:227], a[32:35], a[176:179], v[224:227]
buffer_load_dword v21, v20, s[60:63], s54 offen
s_add_u32 s54, s54, 1048576
M v[224:227], a[36:39], a[180:183], v[224:227]
M v[228:231], a[44:47], a[180:183], v[228:231]
M v[228:231], a[40:43], a[176:179], v[228:231]
M v[232:235], a[48:51], a[176:179], v[232:235]
M v[232:235], a[52:55], a[180:183], v[232:235]
M v[236:239], a[60:63], a[180:183], v[236:239]
M v[236:239], a[56:59], a[176:179], v[236:239]
s_waitcnt vmcnt(9) lgkmcnt(0)
s_barrier
ds_read_b128 a[160:163], v10 offset:32768
ds_read_b128 a[164:167], v11 offset:32768
M v[240:243], a[64:67], a[176:179], v[240:243]
s_add_u32 m0, s29, 0
s_nop 0
buffer_load_dwordx4 v2, s[8:11], s23 offen offset:0 lds
M v[240:243], a[68:71], a[180:183], v[240:243]
M v[244:247], a[76:79], a[180:183], v[244:247]
M v[244:247], a[72:75], a[176:179], v[244:247]
M v[248:251], a[80:83], a[176:179], v[248:251]
M v[248:251], a[84:87], a[180:183], v[248:251]
buffer_load_dwordx4 v3, s[8:11], s23 offen offset:1024 lds
M v[252:255], a[92:95], a[180:183], v[252:255]
M v[252:255], a[88:91], a[176:179], v[252:255]
M a[0:3], a[32:35], a[184:187], a[0:3]
M a[0:3], a[36:39], a[188:191], a[0:3]
ds_read_b128 a[168:171], v10 offset:34816
ds_read_b128 a[172:175], v11 offset:34816
M a[4:7], a[44:47], a[188:191], a[4:7]
M a[4:7], a[40:43], a[184:187], a[4:7]
M a[8:11], a[48:51], a[184:187], a[8:11]
buffer_load_dwordx4 v4, s[8:11], s23 offen offset:2048 lds
M a[8:11], a[52:55], a[188:191], a[8:11]
M a[12:15], a[60:63], a[188:191], a[12:15]
M a[12:15], a[56:59], a[184:187], a[12:15]
M a[16:19], a[64:67], a[184:187], a[16:19]
M a[16:19], a[68:71], a[188:191], a[16:19]
buffer_load_dwordx4 v5, s[8:11], s23 offen offset:3072 lds
M a[20:23], a[76:79], a[188:191], a[20:23]
M a[20:23], a[72:75], a[184:187], a[20:23]
M a[24:27], a[80:83], a[184:187], a[24:27]
M a[24:27], a[84:87], a[188:191], a[24:27]
M a[28:31], a[92:95], a[188:191], a[28:31]
M a[28:31], a[88:91], a[184:187], a[28:31]
s_waitcnt lgkmcnt(2)
M v[32:35], a[96:99], a[160:163], v[32:35]
s_add_u32 m0, s29, 98304
s_nop 0
buffer_load_dwordx4 v6, s[12:15], s24 offen offset:0 lds
M v[32:35], a[100:103], a[164:167], v[32:35]
ds_read_b128 a[176:179], v10 offset:36864
ds_read_b128 a[180:183], v11 offset:36864
M v[36:39], a[108:111], a[164:167], v[36:39]
M v[36:39], a[104:107], a[160:163], v[36:39]
ds_read_b64_tr_b16 a[32:33], v12 offset:0
ds_read_b64_tr_b16 a[34:35], v12 offset:2048
M v[40:43], a[112:115], a[160:163], v[40:43]
M v[40:43], a[116:119], a[164:167], v[40:43]
M v[44:47], a[124:127], a[164:167], v[44:47]
M v[44:47], a[120:123], a[160:163], v[44:47]
ds_read_b64_tr_b16 a[40:41], v13 offset:0
ds_read_b64_tr_b16 a[42:43], v13 offset:2048
M v[48:51], a[128:131], a[160:163], v[48:51]
buffer_load_dwordx4 v7, s[12:15], s24 offen offset:1024 lds
M v[48:51], a[132:135], a[164:167], v[48:51]
M v[52:55], a[140:143], a[164:167], v[52:55]
M v[52:55], a[136:139], a[160:163], v[52:55]
ds_read_b64_tr_b16 a[48:49], v14 offset:0
ds_read_b64_tr_b16 a[50:51], v14 offset:2048
M v[56:59], a[144:147], a[160:163], v[56:59]
M v[56:59], a[148:151], a[164:167], v[56:59]
M v[60:63], a[156:159], a[164:167], v[60:63]
buffer_load_dwordx4 v8, s[12:15], s24 offen offset:2048 lds
M v[60:63], a[152:155], a[160:163], v[60:63]
s_waitcnt lgkmcnt(8)
ds_read_b64_tr_b16 a[56:57], v15 offset:0
ds_read_b64_tr_b16 a[58:59], v15 offset:2048
M v[64:67], a[96:99], a[168:171], v[64:67]
M v[64:67], a[100:103], a[172:175], v[64:67]
ds_read_b128 a[184:187], v10 offset:38912
ds_read_b128 a[188:191], v11 offset:38912
M v[68:71], a[108:111], a[172:175], v[68:71]
M v[68:71], a[104:107], a[168:171], v[68:71]
ds_read_b64_tr_b16 a[64:65], v16 offset:0
ds_read_b64_tr_b16 a[66:67], v16 offset:2048
M v[72:75], a[112:115], a[168:171], v[72:75]
M v[72:75], a[116:119], a[172:175], v[72:75]
M v[76:79], a[124:127], a[172:175], v[76:79]
M v[76:79], a[120:123], a[168:171], v[76:79]
ds_read_b64_tr_b16 a[72:73], v17 offset:0
ds_read_b64_tr_b16 a[74:75], v17 offset:2048
M v[80:83], a[128:131], a[168:171], v[80:83]
buffer_load_dwordx4 v9, s[12:15], s24 offen offset:3072 lds
M v[80:83], a[132:135], a[172:175], v[80:83]
M v[84:87], a[140:143], a[172:175], v[84:87]
M v[84:87], a[136:139], a[168:171], v[84:87]
ds_read_b64_tr_b16 a[80:81], v18 offset:0
ds_read_b64_tr_b16 a[82:83], v18 offset:2048
M v[88:91], a[144:147], a[168:171], v[88:91]
M v[88:91], a[148:151], a[172:175], v[88:91]
M v[92:95], a[156:159], a[172:175], v[92:95]
s_add_u32 s24, s24, 262144
M v[92:95], a[152:155], a[168:171], v[92:95]
s_waitcnt lgkmcnt(15)
ds_read_b64_tr_b16 a[88:89], v19 offset:0
ds_read_b64_tr_b16 a[90:91], v19 offset:2048
M v[96:99], a[96:99], a[176:179], v[96:99]
M v[96:99], a[100:103], a[180:183], v[96:99]
M v[100:103], a[108:111], a[180:183], v[100:103]
M v[100:103], a[104:107], a[176:179], v[100:103]
M v[104:107], a[112:115], a[176:179], v[104:107]
M v[104:107], a[116:119], a[180:183], v[104:107]
M v[108:111], a[124:127], a[180:183], v[108:111]
M v[108:111], a[120:123], a[176:179], v[108:111]
s_waitcnt vmcnt(9) lgkmcnt(0)
s_barrier
ds_read_b128 a[160:163], v10 offset:49152
ds_read_b128 a[164:167], v11 offset:49152
M v[112:115], a[128:131], a[176:179], v[112:115]
s_add_u32 m0, s29, 16384
s_add_u32 s3, s23, s31
buffer_load_dwordx4 v2, s[8:11], s3 offen offset:0 lds
M v[112:115], a[132:135], a[180:183], v[112:115]
M v[116:119], a[140:143], a[180:183], v[116:119]
M v[116:119], a[136:139], a[176:179], v[116:119]
ds_read_b64_tr_b16 a[36:37], v12 offset:16384
ds_read_b64_tr_b16 a[38:39], v12 offset:18432
M v[120:123], a[144:147], a[176:179], v[120:123]
M v[120:123], a[148:151], a[180:183], v[120:123]
buffer_load_dwordx4 v3, s[8:11], s3 offen offset:1024 lds
M v[124:127], a[156:159], a[180:183], v[124:127]
M v[124:127], a[152:155], a[176:179], v[124:127]
M v[128:131], a[96:99], a[184:187], v[128:131]
M v[128:131], a[100:103], a[188:191], v[128:131]
ds_read_b128 a[168:171], v10 offset:51200
ds_read_b128 a[172:175], v11 offset:51200
ds_read_b64_tr_b16 a[44:45], v13 offset:16384
ds_read_b64_tr_b16 a[46:47], v13 offset:18432
M v[132:135], a[108:111], a[188:191], v[132:135]
M v[132:135], a[104:107], a[184:187], v[132:135]
buffer_load_dwordx4 v4, s[8:11], s3 offen offset:2048 lds
M v[136:139], a[112:115], a[184:187], v[136:139]
M v[136:139], a[116:119], a[188:191], v[136:139]
M v[140:143], a[124:127], a[188:191], v[140:143]
M v[140:143], a[120:123], a[184:187], v[140:143]
ds_read_b64_tr_b16 a[52:53], v14 offset:16384
ds_read_b64_tr_b16 a[54:55], v14 offset:18432
M v[144:147], a[128:131], a[184:187], v[144:147]
M v[144:147], a[132:135], a[188:191], v[144:147]
buffer_load_dwordx4 v5, s[8:11], s3 offen offset:3072 lds
M v[148:151], a[140:143], a[188:191], v[148:151]
M v[148:151], a[136:139], a[184:187], v[148:151]
M v[152:155], a[144:147], a[184:187], v[152:155]
M v[152:155], a[148:151], a[188:191], v[152:155]
ds_read_b64_tr_b16 a[60:61], v15 offset:16384
ds_read_b64_tr_b16 a[62:63], v15 offset:18432
M v[156:159], a[156:159], a[188:191], v[156:159]
s_add_u32 s23, s23, 128
s_cmp_eq_u32 s23, s25
s_cselect_b32 s23, s26, s23
M v[156:159], a[152:155], a[184:187], v[156:159]
s_waitcnt lgkmcnt(10)
M v[160:163], a[96:99], a[160:163], v[160:163]
M v[160:163], a[100:103], a[164:167], v[160:163]
ds_read_b128 a[176:179], v10 offset:53248
ds_read_b128 a[180:183], v11 offset:53248
M v[164:167], a[108:111], a[164:167], v[164:167]
M v[164:167], a[104:107], a[160:163], v[164:167]
ds_read_b64_tr_b16 a[68:69], v16 offset:16384
ds_read_b64_tr_b16 a[70:71], v16 offset:18432
M v[168:171], a[112:115], a[160:163], v[168:171]
M v[168:171], a[116:119], a[164:167], v[168:171]
s_add_u32 m0, s29, 114688
s_nop 0
buffer_load_dwordx4 v6, s[12:15], s24 offen offset:0 lds
M v[172:175], a[124:127], a[164:167], v[172:175]
M v[172:175], a[120:123], a[160:163], v[172:175]
M v[176:179], a[128:131], a[160:163], v[176:179]
M v[176:179], a[132:135], a[164:167], v[176:179]
ds_read_b64_tr_b16 a[76:77], v17 offset:16384
ds_read_b64_tr_b16 a[78:79], v17 offset:18432
M v[180:183], a[140:143], a[164:167], v[180:183]
M v[180:183], a[136:139], a[160:163], v[180:183]
buffer_load_dwordx4 v7, s[12:15], s24 offen offset:1024 lds
M v[184:187], a[144:147], a[160:163], v[184:187]
M v[184:187], a[148:151], a[164:167], v[184:187]
M v[188:191], a[156:159], a[164:167], v[188:191]
M v[188:191], a[152:155], a[160:163], v[188:191]
s_waitcnt lgkmcnt(12)
ds_read_b64_tr_b16 a[84:85], v18 offset:16384
ds_read_b64_tr_b16 a[86:87], v18 offset:18432
M v[192:195], a[96:99], a[168:171], v[192:195]
buffer_load_dwordx4 v8, s[12:15], s24 offen offset:2048 lds
M v[192:195], a[100:103], a[172:175], v[192:195]
ds_read_b128 a[184:187], v10 offset:55296
ds_read_b128 a[188:191], v11 offset:55296
M v[196:199], a[108:111], a[172:175], v[196:199]
M v[196:199], a[104:107], a[168:171], v[196:199]
M v[200:203], a[112:115], a[168:171], v[200:203]
M v[200:203], a[116:119], a[172:175], v[200:203]
ds_read_b64_tr_b16 a[92:93], v19 offset:16384
ds_read_b64_tr_b16 a[94:95], v19 offset:18432
M v[204:207], a[124:127], a[172:175], v[204:207]
buffer_load_dwordx4 v9, s[12:15], s24 offen offset:3072 lds
M v[204:207], a[120:123], a[168:171], v[204:207]
M v[208:211], a[128:131], a[168:171], v[208:211]
M v[208:211], a[132:135], a[172:175], v[208:211]
M v[212:215], a[140:143], a[172:175], v[212:215]
M v[212:215], a[136:139], a[168:171], v[212:215]
s_add_u32 s24, s24, 262144
s_cmp_eq_u32 s24, s27
s_cselect_b32 s24, s28, s24
s_sub_u32 s6, s6, 1
s_cmp_eq_u32 s6, 0
s_cselect_b64 s[12:13], s[64:65], s[12:13]
M v[216:219], a[144:147], a[168:171], v[216:219]
M v[216:219], a[148:151], a[172:175], v[216:219]
M v[220:223], a[156:159], a[172:175], v[220:223]
M v[220:223], a[152:155], a[168:171], v[220:223]
s_waitcnt lgkmcnt(10)
M v[224:227], a[96:99], a[176:179], v[224:227]
buffer_load_dword v21, v20, s[60:63], s54 offen
s_add_u32 s54, s54, 1048576
M v[224:227], a[100:103], a[180:183], v[224:227]
M v[228:231], a[108:111], a[180:183], v[228:231]
M v[228:231], a[104:107], a[176:179], v[228:231]
M v[232:235], a[112:115], a[176:179], v[232:235]
M v[232:235], a[116:119], a[180:183], v[232:235]
M v[236:239], a[124:127], a[180:183], v[236:239]
M v[236:239], a[120:123], a[176:179], v[236:239]
s_waitcnt vmcnt(9) lgkmcnt(0)
s_barrier
ds_read_b128 a[160:163], v10 offset:0
ds_read_b128 a[164:167], v11 offset:0
M v[240:243], a[128:131], a[176:179], v[240:243]
s_add_u32 m0, s29, 32768
s_nop 0
buffer_load_dwordx4 v2, s[8:11], s23 offen offset:0 lds
M v[240:243], a[132:135], a[180:183], v[240:243]
M v[244:247], a[140:143], a[180:183], v[244:247]
M v[244:247], a[136:139], a[176:179], v[244:247]
M v[248:251], a[144:147], a[176:179], v[248:251]
M v[248:251], a[148:151], a[180:183], v[248:251]
buffer_load_dwordx4 v3, s[8:11], s23 offen offset:1024 lds
M v[252:255], a[156:159], a[180:183], v[252:255]
M v[252:255], a[152:155], a[176:179], v[252:255]
M a[0:3], a[96:99], a[184:187], a[0:3]
M a[0:3], a[100:103], a[188:191], a[0:3]
ds_read_b128 a[168:171], v10 offset:2048
ds_read_b128 a[172:175], v11 offset:2048
M a[4:7], a[108:111], a[188:191], a[4:7]
M a[4:7], a[104:107], a[184:187], a[4:7]
M a[8:11], a[112:115], a[184:187], a[8:11]
buffer_load_dwordx4 v4, s[8:11], s23 offen offset:2048 lds
M a[8:11], a[116:119], a[188:191], a[8:11]
M a[12:15], a[124:127], a[188:191], a[12:15]
M a[12:15], a[120:123], a[184:187], a[12:15]
M a[16:19], a[128:131], a[184:187], a[16:19]
M a[16:19], a[132:135], a[188:191], a[16:19]
buffer_load_dwordx4 v5, s[8:11], s23 offen offset:3072 lds
M a[20:23], a[140:143], a[188:191], a[20:23]
M a[20:23], a[136:139], a[184:187], a[20:23]
M a[24:27], a[144:147], a[184:187], a[24:27]
M a[24:27], a[148:151], a[188:191], a[24:27]
M a[28:31], a[156:159], a[188:191], a[28:31]
M a[28:31], a[152:155], a[184:187], a[28:31]
s_waitcnt lgkmcnt(2)
s_sub_u32 s30, s30, 1
s_cmp_lg_u32 s30, 0
s_cbranch_scc1 Lk1_ql
M v[32:35], a[32:35], a[160:163], v[32:35]
s_add_u32 m0, s29, 65536
s_nop 0
buffer_load_dwordx4 v6, s[12:15], s24 offen offset:0 lds
M v[32:35], a[36:39], a[164:167], v[32:35]
ds_read_b128 a[176:179], v10 offset:4096
ds_read_b128 a[180:183], v11 offset:4096
M v[36:39], a[44:47], a[164:167], v[36:39]
M v[36:39], a[40:43], a[160:163], v[36:39]
ds_read_b64_tr_b16 a[96:97], v12 offset:32768
ds_read_b64_tr_b16 a[98:99], v12 offset:34816
M v[40:43], a[48:51], a[160:163], v[40:43]
M v[40:43], a[52:55], a[164:167], v[40:43]
M v[44:47], a[60:63], a[164:167], v[44:47]
M v[44:47], a[56:59], a[160:163], v[44:47]
ds_read_b64_tr_b16 a[104:105], v13 offset:32768
ds_read_b64_tr_b16 a[106:107], v13 offset:34816
M v[48:51], a[64:67], a[160:163], v[48:51]
buffer_load_dwordx4 v7, s[12:15], s24 offen offset:1024 lds
M v[48:51], a[68:71], a[164:167], v[48:51]
M v[52:55], a[76:79], a[164:167], v[52:55]
M v[52:55], a[72:75], a[160:163], v[52:55]
ds_read_b64_tr_b16 a[112:113], v14 offset:32768
ds_read_b64_tr_b16 a[114:115], v14 offset:34816
M v[56:59], a[80:83], a[160:163], v[56:59]
M v[56:59], a[84:87], a[164:167], v[56:59]
M v[60:63], a[92:95], a[164:167], v[60:63]
buffer_load_dwordx4 v8, s[12:15], s24 offen offset:2048 lds
M v[60:63], a[88:91], a[160:163], v[60:63]
s_waitcnt lgkmcnt(8)
ds_read_b64_tr_b16 a[120:121], v15 offset:32768
ds_read_b64_tr_b16 a[122:123], v15 offset:34816
M v[64:67], a[32:35], a[168:171], v[64:67]
M v[64:67], a[36:39], a[172:175], v[64:67]
ds_read_b128 a[184:187], v10 offset:6144
ds_read_b128 a[188:191], v11 offset:6144
M v[68:71], a[44:47], a[172:175], v[68:71]
M v[68:71], a[40:43], a[168:171], v[68:71]
ds_read_b64_tr_b16 a[128:129], v16 offset:32768
ds_read_b64_tr_b16 a[130:131], v16 offset:34816
M v[72:75], a[48:51], a[168:171], v[72:75]
M v[72:75], a[52:55], a[172:175], v[72:75]
M v[76:79], a[60:63], a[172:175], v[76:79]
M v[76:79], a[56:59], a[168:171], v[76:79]
ds_read_b64_tr_b16 a[136:137], v17 offset:32768
ds_read_b64_tr_b16 a[138:139], v17 offset:34816
M v[80:83], a[64:67], a[168:171], v[80:83]
buffer_load_dwordx4 v9, s[12:15], s24 offen offset:3072 lds
M v[80:83], a[68:71], a[172:175], v[80:83]
M v[84:87], a[76:79], a[172:175], v[84:87]
M v[84:87], a[72:75], a[168:171], v[84:87]
ds_read_b64_tr_b16 a[144:145], v18 offset:32768
ds_read_b64_tr_b16 a[146:147], v18 offset:34816
M v[88:91], a[80:83], a[168:171], v[88:91]
M v[88:91], a[84:87], a[172:175], v[88:91]
M v[92:95], a[92:95], a[172:175], v[92:95]
s_add_u32 s24, s24, 262144
M v[92:95], a[88:91], a[168:171], v[92:95]
s_waitcnt lgkmcnt(15)
ds_read_b64_tr_b16 a[152:153], v19 offset:32768
ds_read_b64_tr_b16 a[154:155], v19 offset:34816
M v[96:99], a[32:35], a[176:179], v[96:99]
M v[96:99], a[36:39], a[180:183], v[96:99]
M v[100:103], a[44:47], a[180:183], v[100:103]
M v[100:103], a[40:43], a[176:179], v[100:103]
M v[104:107], a[48:51], a[176:179], v[104:107]
M v[104:107], a[52:55], a[180:183], v[104:107]
M v[108:111], a[60:63], a[180:183], v[108:111]
M v[108:111], a[56:59], a[176:179], v[108:111]
s_waitcnt vmcnt(9) lgkmcnt(0)
s_barrier
ds_read_b128 a[160:163], v10 offset:16384
ds_read_b128 a[164:167], v11 offset:16384
M v[112:115], a[64:67], a[176:179], v[112:115]
s_add_u32 m0, s29, 49152
s_add_u32 s3, s23, s31
buffer_load_dwordx4 v2, s[8:11], s3 offen offset:0 lds
M v[112:115], a[68:71], a[180:183], v[112:115]
M v[116:119], a[76:79], a[180:183], v[116:119]
M v[116:119], a[72:75], a[176:179], v[116:119]
ds_read_b64_tr_b16 a[100:101], v12 offset:49152
ds_read_b64_tr_b16 a[102:103], v12 offset:51200
M v[120:123], a[80:83], a[176:179], v[120:123]
M v[120:123], a[84:87], a[180:183], v[120:123]
buffer_load_dwordx4 v3, s[8:11], s3 offen offset:1024 lds
M v[124:127], a[92:95], a[180:183], v[124:127]
M v[124:127], a[88:91], a[176:179], v[124:127]
M v[128:131], a[32:35], a[184:187], v[128:131]
M v[128:131], a[36:39], a[188:191], v[128:131]
ds_read_b128 a[168:171], v10 offset:18432
ds_read_b128 a[172:175], v11 offset:18432
ds_read_b64_tr_b16 a[108:109], v13 offset:49152
ds_read_b64_tr_b16 a[110:111], v13 offset:51200
M v[132:135], a[44:47], a[188:191], v[132:135]
M v[132:135], a[40:43], a[184:187], v[132:135]
M v[136:139], a[48:51], a[184:187], v[136:139]
buffer_load_dwordx4 v4, s[8:11], s3 offen offset:2048 lds
M v[136:139], a[52:55], a[188:191], v[136:139]
M v[140:143], a[60:63], a[188:191], v[140:143]
M v[140:143], a[56:59], a[184:187], v[140:143]
ds_read_b64_tr_b16 a[116:117], v14 offset:49152
ds_read_b64_tr_b16 a[118:119], v14 offset:51200
M v[144:147], a[64:67], a[184:187], v[144:147]
M v[144:147], a[68:71], a[188:191], v[144:147]
M v[148:151], a[76:79], a[188:191], v[148:151]
buffer_load_dwordx4 v5, s[8:11], s3 offen offset:3072 lds
M v[148:151], a[72:75], a[184:187], v[148:151]
M v[152:155], a[80:83], a[184:187], v[152:155]
M v[152:155], a[84:87], a[188:191], v[152:155]
ds_read_b64_tr_b16 a[124:125], v15 offset:49152
ds_read_b64_tr_b16 a[126:127], v15 offset:51200
M v[156:159], a[92:95], a[188:191], v[156:159]
M v[156:159], a[88:91], a[184:187], v[156:159]
s_waitcnt lgkmcnt(10)
M v[160:163], a[32:35], a[160:163], v[160:163]
M v[160:163], a[36:39], a[164:167], v[160:163]
ds_read_b128 a[176:179], v10 offset:20480
ds_read_b128 a[180:183], v11 offset:20480
M v[164:167], a[44:47], a[164:167], v[164:167]
s_add_u32 s23, s23, 128
s_cmp_eq_u32 s23, s25
s_cselect_b32 s23, s26, s23
M v[164:167], a[40:43], a[160:163], v[164:167]
ds_read_b64_tr_b16 a[132:133], v16 offset:49152
ds_read_b64_tr_b16 a[134:135], v16 offset:51200
M v[168:171], a[48:51], a[160:163], v[168:171]
M v[168:171], a[52:55], a[164:167], v[168:171]
M v[172:175], a[60:63], a[164:167], v[172:175]
M v[172:175], a[56:59], a[160:163], v[172:175]
M v[176:179], a[64:67], a[160:163], v[176:179]
s_add_u32 m0, s29, 81920
s_nop 0
buffer_load_dwordx4 v6, s[12:15], s24 offen offset:0 lds
M v[176:179], a[68:71], a[164:167], v[176:179]
ds_read_b64_tr_b16 a[140:141], v17 offset:49152
ds_read_b64_tr_b16 a[142:143], v17 offset:51200
M v[180:183], a[76:79], a[164:167], v[180:183]
M v[180:183], a[72:75], a[160:163], v[180:183]
M v[184:187], a[80:83], a[160:163], v[184:187]
M v[184:187], a[84:87], a[164:167], v[184:187]
buffer_load_dwordx4 v7, s[12:15], s24 offen offset:1024 lds
M v[188:191], a[92:95], a[164:167], v[188:191]
M v[188:191], a[88:91], a[160:163], v[188:191]
s_waitcnt lgkmcnt(12)
ds_read_b64_tr_b16 a[148:149], v18 offset:49152
ds_read_b64_tr_b16 a[150:151], v18 offset:51200
M v[192:195], a[32:35], a[168:171], v[192:195]
M v[192:195], a[36:39], a[172:175], v[192:195]
ds_read_b128 a[184:187], v10 offset:22528
ds_read_b128 a[188:191], v11 offset:22528
M v[196:199], a[44:47], a[172:175], v[196:199]
M v[196:199], a[40:43], a[168:171], v[196:199]
M v[200:203], a[48:51], a[168:171], v[200:203]
buffer_load_dwordx4 v8, s[12:15], s24 offen offset:2048 lds
M v[200:203], a[52:55], a[172:175], v[200:203]
ds_read_b64_tr_b16 a[156:157], v19 offset:49152
ds_read_b64_tr_b16 a[158:159], v19 offset:51200
M v[204:207], a[60:63], a[172:175], v[204:207]
M v[204:207], a[56:59], a[168:171], v[204:207]
M v[208:211], a[64:67], a[168:171], v[208:211]
M v[208:211], a[68:71], a[172:175], v[208:211]
M v[212:215], a[76:79], a[172:175], v[212:215]
buffer_load_dwordx4 v9, s[12:15], s24 offen offset:3072 lds
M v[212:215], a[72:75], a[168:171], v[212:215]
M v[216:219], a[80:83], a[168:171], v[216:219]
M v[216:219], a[84:87], a[172:175], v[216:219]
M v[220:223], a[92:95], a[172:175], v[220:223]
M v[220:223], a[88:91], a[168:171], v[220:223]
s_waitcnt lgkmcnt(10)
M v[224:227], a[32:35], a[176:179], v[224:227]
s_add_u32 s24, s24, 262144
s_cmp_eq_u32 s24, s27
s_cselect_b32 s24, s28, s24
s_sub_u32 s6, s6, 1
s_cmp_eq_u32 s6, 0
s_cselect_b64 s[12:13], s[64:65], s[12:13]
M v[224:227], a[36:39], a[180:183], v[224:227]
M v[228:231], a[44:47], a[180:183], v[228:231]
M v[228:231], a[40:43], a[176:179], v[228:231]
M v[232:235], a[48:51], a[176:179], v[232:235]
M v[232:235], a[52:55], a[180:183], v[232:235]
M v[236:239], a[60:63], a[180:183], v[236:239]
M v[236:239], a[56:59], a[176:179], v[236:239]
s_waitcnt vmcnt(8) lgkmcnt(0)
s_barrier
ds_read_b128 a[160:163], v10 offset:32768
ds_read_b128 a[164:167], v11 offset:32768
M v[240:243], a[64:67], a[176:179], v[240:243]
s_add_u32 m0, s29, 0
s_nop 0
buffer_load_dwordx4 v2, s[8:11], s23 offen offset:0 lds
M v[240:243], a[68:71], a[180:183], v[240:243]
M v[244:247], a[76:79], a[180:183], v[244:247]
M v[244:247], a[72:75], a[176:179], v[244:247]
M v[248:251], a[80:83], a[176:179], v[248:251]
M v[248:251], a[84:87], a[180:183], v[248:251]
buffer_load_dwordx4 v3, s[8:11], s23 offen offset:1024 lds
M v[252:255], a[92:95], a[180:183], v[252:255]
M v[252:255], a[88:91], a[176:179], v[252:255]
M a[0:3], a[32:35], a[184:187], a[0:3]
M a[0:3], a[36:39], a[188:191], a[0:3]
ds_read_b128 a[168:171], v10 offset:34816
ds_read_b128 a[172:175], v11 offset:34816
M a[4:7], a[44:47], a[188:191], a[4:7]
M a[4:7], a[40:43], a[184:187], a[4:7]
M a[8:11], a[48:51], a[184:187], a[8:11]
buffer_load_dwordx4 v4, s[8:11], s23 offen offset:2048 lds
M a[8:11], a[52:55], a[188:191], a[8:11]
M a[12:15], a[60:63], a[188:191], a[12:15]
M a[12:15], a[56:59], a[184:187], a[12:15]
M a[16:19], a[64:67], a[184:187], a[16:19]
M a[16:19], a[68:71], a[188:191], a[16:19]
buffer_load_dwordx4 v5, s[8:11], s23 offen offset:3072 lds
M a[20:23], a[76:79], a[188:191], a[20:23]
M a[20:23], a[72:75], a[184:187], a[20:23]
M a[24:27], a[80:83], a[184:187], a[24:27]
M a[24:27], a[84:87], a[188:191], a[24:27]
M a[28:31], a[92:95], a[188:191], a[28:31]
M a[28:31], a[88:91], a[184:187], a[28:31]
s_waitcnt lgkmcnt(2)
M v[32:35], a[96:99], a[160:163], v[32:35]
s_add_u32 m0, s29, 98304
s_nop 0
buffer_load_dwordx4 v6, s[12:15], s24 offen offset:0 lds
M v[32:35], a[100:103], a[164:167], v[32:35]
ds_read_b128 a[176:179], v10 offset:36864
ds_read_b128 a[180:183], v11 offset:36864
M v[36:39], a[108:111], a[164:167], v[36:39]
M v[36:39], a[104:107], a[160:163], v[36:39]
ds_read_b64_tr_b16 a[32:33], v12 offset:0
ds_read_b64_tr_b16 a[34:35], v12 offset:2048
M v[40:43], a[112:115], a[160:163], v[40:43]
M v[40:43], a[116:119], a[164:167], v[40:43]
M v[44:47], a[124:127], a[164:167], v[44:47]
M v[44:47], a[120:123], a[160:163], v[44:47]
ds_read_b64_tr_b16 a[40:41], v13 offset:0
ds_read_b64_tr_b16 a[42:43], v13 offset:2048
M v[48:51], a[128:131], a[160:163], v[48:51]
buffer_load_dwordx4 v7, s[12:15], s24 offen offset:1024 lds
M v[48:51], a[132:135], a[164:167], v[48:51]
M v[52:55], a[140:143], a[164:167], v[52:55]
M v[52:55], a[136:139], a[160:163], v[52:55]
ds_read_b64_tr_b16 a[48:49], v14 offset:0
ds_read_b64_tr_b16 a[50:51], v14 offset:2048
M v[56:59], a[144:147], a[160:163], v[56:59]
M v[56:59], a[148:151], a[164:167], v[56:59]
M v[60:63], a[156:159], a[164:167], v[60:63]
buffer_load_dwordx4 v8, s[12:15], s24 offen offset:2048 lds
M v[60:63], a[152:155], a[160:163], v[60:63]
s_waitcnt lgkmcnt(8)
ds_read_b64_tr_b16 a[56:57], v15 offset:0
ds_read_b64_tr_b16 a[58:59], v15 offset:2048
M v[64:67], a[96:99], a[168:171], v[64:67]
M v[64:67], a[100:103], a[172:175], v[64:67]
ds_read_b128 a[184:187], v10 offset:38912
ds_read_b128 a[188:191], v11 offset:38912
M v[68:71], a[108:111], a[172:175], v[68:71]
M v[68:71], a[104:107], a[168:171], v[68:71]
ds_read_b64_tr_b16 a[64:65], v16 offset:0
ds_read_b64_tr_b16 a[66:67], v16 offset:2048
M v[72:75], a[112:115], a[168:171], v[72:75]
M v[72:75], a[116:119], a[172:175], v[72:75]
M v[76:79], a[124:127], a[172:175], v[76:79]
M v[76:79], a[120:123], a[168:171], v[76:79]
ds_read_b64_tr_b16 a[72:73], v17 offset:0
ds_read_b64_tr_b16 a[74:75], v17 offset:2048
M v[80:83], a[128:131], a[168:171], v[80:83]
buffer_load_dwordx4 v9, s[12:15], s24 offen offset:3072 lds
M v[80:83], a[132:135], a[172:175], v[80:83]
M v[84:87], a[140:143], a[172:175], v[84:87]
M v[84:87], a[136:139], a[168:171], v[84:87]
ds_read_b64_tr_b16 a[80:81], v18 offset:0
ds_read_b64_tr_b16 a[82:83], v18 offset:2048
M v[88:91], a[144:147], a[168:171], v[88:91]
M v[88:91], a[148:151], a[172:175], v[88:91]
M v[92:95], a[156:159], a[172:175], v[92:95]
s_add_u32 s24, s24, 262144
M v[92:95], a[152:155], a[168:171], v[92:95]
s_waitcnt lgkmcnt(15)
ds_read_b64_tr_b16 a[88:89], v19 offset:0
ds_read_b64_tr_b16 a[90:91], v19 offset:2048
M v[96:99], a[96:99], a[176:179], v[96:99]
M v[96:99], a[100:103], a[180:183], v[96:99]
M v[100:103], a[108:111], a[180:183], v[100:103]
M v[100:103], a[104:107], a[176:179], v[100:103]
M v[104:107], a[112:115], a[176:179], v[104:107]
M v[104:107], a[116:119], a[180:183], v[104:107]
M v[108:111], a[124:127], a[180:183], v[108:111]
M v[108:111], a[120:123], a[176:179], v[108:111]
s_waitcnt vmcnt(8) lgkmcnt(0)
s_barrier
ds_read_b128 a[160:163], v10 offset:49152
ds_read_b128 a[164:167], v11 offset:49152
M v[112:115], a[128:131], a[176:179], v[112:115]
s_add_u32 m0, s29, 16384
s_add_u32 s3, s23, s31
buffer_load_dwordx4 v2, s[8:11], s3 offen offset:0 lds
M v[112:115], a[132:135], a[180:183], v[112:115]
M v[116:119], a[140:143], a[180:183], v[116:119]
M v[116:119], a[136:139], a[176:179], v[116:119]
ds_read_b64_tr_b16 a[36:37], v12 offset:16384
ds_read_b64_tr_b16 a[38:39], v12 offset:18432
M v[120:123], a[144:147], a[176:179], v[120:123]
M v[120:123], a[148:151], a[180:183], v[120:123]
buffer_load_dwordx4 v3, s[8:11], s3 offen offset:1024 lds
M v[124:127], a[156:159], a[180:183], v[124:127]
M v[124:127], a[152:155], a[176:179], v[124:127]
M v[128:131], a[96:99], a[184:187], v[128:131]
M v[128:131], a[100:103], a[188:191], v[128:131]
ds_read_b128 a[168:171], v10 offset:51200
ds_read_b128 a[172:175], v11 offset:51200
ds_read_b64_tr_b16 a[44:45], v13 offset:16384
ds_read_b64_tr_b16 a[46:47], v13 offset:18432
M v[132:135], a[108:111], a[188:191], v[132:135]
M v[132:135], a[104:107], a[184:187], v[132:135]
M v[136:139], a[112:115], a[184:187], v[136:139]
buffer_load_dwordx4 v4, s[8:11], s3 offen offset:2048 lds
M v[136:139], a[116:119], a[188:191], v[136:139]
M v[140:143], a[124:127], a[188:191], v[140:143]
M v[140:143], a[120:123], a[184:187], v[140:143]
ds_read_b64_tr_b16 a[52:53], v14 offset:16384
ds_read_b64_tr_b16 a[54:55], v14 offset:18432
M v[144:147], a[128:131], a[184:187], v[144:147]
M v[144:147], a[132:135], a[188:191], v[144:147]
M v[148:151], a[140:143], a[188:191], v[148:151]
buffer_load_dwordx4 v5, s[8:11], s3 offen offset:3072 lds
M v[148:151], a[136:139], a[184:187], v[148:151]
M v[152:155], a[144:147], a[184:187], v[152:155]
M v[152:155], a[148:151], a[188:191], v[152:155]
ds_read_b64_tr_b16 a[60:61], v15 offset:16384
ds_read_b64_tr_b16 a[62:63], v15 offset:18432
M v[156:159], a[156:159], a[188:191], v[156:159]
M v[156:159], a[152:155], a[184:187], v[156:159]
s_waitcnt lgkmcnt(10)
M v[160:163], a[96:99], a[160:163], v[160:163]
s_add_u32 s23, s23, 128
s_cmp_eq_u32 s23, s25
s_cselect_b32 s23, s26, s23
M v[160:163], a[100:103], a[164:167], v[160:163]
ds_read_b128 a[176:179], v10 offset:53248
ds_read_b128 a[180:183], v11 offset:53248
M v[164:167], a[108:111], a[164:167], v[164:167]
M v[164:167], a[104:107], a[160:163], v[164:167]
ds_read_b64_tr_b16 a[68:69], v16 offset:16384
ds_read_b64_tr_b16 a[70:71], v16 offset:18432
M v[168:171], a[112:115], a[160:163], v[168:171]
M v[168:171], a[116:119], a[164:167], v[168:171]
M v[172:175], a[124:127], a[164:167], v[172:175]
M v[172:175], a[120:123], a[160:163], v[172:175]
s_add_u32 m0, s29, 114688
s_nop 0
buffer_load_dwordx4 v6, s[12:15], s24 offen offset:0 lds
M v[176:179], a[128:131], a[160:163], v[176:179]
M v[176:179], a[132:135], a[164:167], v[176:179]
ds_read_b64_tr_b16 a[76:77], v17 offset:16384
ds_read_b64_tr_b16 a[78:79], v17 offset:18432
M v[180:183], a[140:143], a[164:167], v[180:183]
M v[180:183], a[136:139], a[160:163], v[180:183]
M v[184:187], a[144:147], a[160:163], v[184:187]
M v[184:187], a[148:151], a[164:167], v[184:187]
buffer_load_dwordx4 v7, s[12:15], s24 offen offset:1024 lds
M v[188:191], a[156:159], a[164:167], v[188:191]
M v[188:191], a[152:155], a[160:163], v[188:191]
s_waitcnt lgkmcnt(12)
ds_read_b64_tr_b16 a[84:85], v18 offset:16384
ds_read_b64_tr_b16 a[86:87], v18 offset:18432
M v[192:195], a[96:99], a[168:171], v[192:195]
M v[192:195], a[100:103], a[172:175], v[192:195]
ds_read_b128 a[184:187], v10 offset:55296
ds_read_b128 a[188:191], v11 offset:55296
M v[196:199], a[108:111], a[172:175], v[196:199]
M v[196:199], a[104:107], a[168:171], v[196:199]
buffer_load_dwordx4 v8, s[12:15], s24 offen offset:2048 lds
M v[200:203], a[112:115], a[168:171], v[200:203]
M v[200:203], a[116:119], a[172:175], v[200:203]
ds_read_b64_tr_b16 a[92:93], v19 offset:16384
ds_read_b64_tr_b16 a[94:95], v19 offset:18432
M v[204:207], a[124:127], a[172:175], v[204:207]
M v[204:207], a[120:123], a[168:171], v[204:207]
M v[208:211], a[128:131], a[168:171], v[208:211]
M v[208:211], a[132:135], a[172:175], v[208:211]
buffer_load_dwordx4 v9, s[12:15], s24 offen offset:3072 lds
M v[212:215], a[140:143], a[172:175], v[212:215]
s_getpc_b64 s[56:57]
Lpcc0:
s_add_u32 s56, s56, Lk1_b-Lpcc0
s_addc_u32 s57, s57, 0
s_lshr_b32 s58, s2, 3
s_lshl2_add_u32 s58, s58, s101
s_mul_i32 s58, s58, (((Lc2-Lk1_b)/128+127)&~127)
v_lshlrev_b32 v22, 7, v0
v_min_u32 v22, (((Lc2-Lk1_b)/128+127)&~127)-128, v22
v_add_u32 v22, s58, v22
v_min_u32 v22, Lc2-Lk1_b-4, v22
global_load_dword a255, v22, s[56:57]
M v[212:215], a[136:139], a[168:171], v[212:215]
M v[216:219], a[144:147], a[168:171], v[216:219]
M v[216:219], a[148:151], a[172:175], v[216:219]
M v[220:223], a[156:159], a[172:175], v[220:223]
M v[220:223], a[152:155], a[168:171], v[220:223]
s_waitcnt lgkmcnt(10)
M v[224:227], a[96:99], a[176:179], v[224:227]
s_add_u32 s24, s24, 262144
s_cmp_eq_u32 s24, s27
s_cselect_b32 s24, s28, s24
s_sub_u32 s6, s6, 1
s_cmp_eq_u32 s6, 0
s_cselect_b64 s[12:13], s[64:65], s[12:13]
M v[224:227], a[100:103], a[180:183], v[224:227]
M v[228:231], a[108:111], a[180:183], v[228:231]
M v[228:231], a[104:107], a[176:179], v[228:231]
M v[232:235], a[112:115], a[176:179], v[232:235]
M v[232:235], a[116:119], a[180:183], v[232:235]
M v[236:239], a[124:127], a[180:183], v[236:239]
M v[236:239], a[120:123], a[176:179], v[236:239]
s_waitcnt vmcnt(9) lgkmcnt(0)
s_barrier
ds_read_b128 a[160:163], v10 offset:0
ds_read_b128 a[164:167], v11 offset:0
M v[240:243], a[128:131], a[176:179], v[240:243]
s_add_u32 m0, s29, 32768
s_nop 0
buffer_load_dwordx4 v2, s[8:11], s23 offen offset:0 lds
M v[240:243], a[132:135], a[180:183], v[240:243]
M v[244:247], a[140:143], a[180:183], v[244:247]
M v[244:247], a[136:139], a[176:179], v[244:247]
M v[248:251], a[144:147], a[176:179], v[248:251]
M v[248:251], a[148:151], a[180:183], v[248:251]
M v[252:255], a[156:159], a[180:183], v[252:255]
M v[252:255], a[152:155], a[176:179], v[252:255]
M a[0:3], a[96:99], a[184:187], a[0:3]
M a[0:3], a[100:103], a[188:191], a[0:3]
ds_read_b128 a[168:171], v10 offset:2048
ds_read_b128 a[172:175], v11 offset:2048
M a[4:7], a[108:111], a[188:191], a[4:7]
M a[4:7], a[104:107], a[184:187], a[4:7]
M a[8:11], a[112:115], a[184:187], a[8:11]
buffer_load_dwordx4 v3, s[8:11], s23 offen offset:1024 lds
M a[8:11], a[116:119], a[188:191], a[8:11]
M a[12:15], a[124:127], a[188:191], a[12:15]
M a[12:15], a[120:123], a[184:187], a[12:15]
M a[16:19], a[128:131], a[184:187], a[16:19]
M a[16:19], a[132:135], a[188:191], a[16:19]
M a[20:23], a[140:143], a[188:191], a[20:23]
M a[20:23], a[136:139], a[184:187], a[20:23]
M a[24:27], a[144:147], a[184:187], a[24:27]
M a[24:27], a[148:151], a[188:191], a[24:27]
M a[28:31], a[156:159], a[188:191], a[28:31]
M a[28:31], a[152:155], a[184:187], a[28:31]
s_waitcnt lgkmcnt(2)
M v[32:35], a[32:35], a[160:163], v[32:35]
buffer_load_dwordx4 v4, s[8:11], s23 offen offset:2048 lds
M v[32:35], a[36:39], a[164:167], v[32:35]
ds_read_b128 a[176:179], v10 offset:4096
ds_read_b128 a[180:183], v11 offset:4096
M v[36:39], a[44:47], a[164:167], v[36:39]
M v[36:39], a[40:43], a[160:163], v[36:39]
ds_read_b64_tr_b16 a[96:97], v12 offset:32768
ds_read_b64_tr_b16 a[98:99], v12 offset:34816
M v[40:43], a[48:51], a[160:163], v[40:43]
M v[40:43], a[52:55], a[164:167], v[40:43]
M v[44:47], a[60:63], a[164:167], v[44:47]
M v[44:47], a[56:59], a[160:163], v[44:47]
ds_read_b64_tr_b16 a[104:105], v13 offset:32768
ds_read_b64_tr_b16 a[106:107], v13 offset:34816
M v[48:51], a[64:67], a[160:163], v[48:51]
M v[48:51], a[68:71], a[164:167], v[48:51]
M v[52:55], a[76:79], a[164:167], v[52:55]
M v[52:55], a[72:75], a[160:163], v[52:55]
ds_read_b64_tr_b16 a[112:113], v14 offset:32768
ds_read_b64_tr_b16 a[114:115], v14 offset:34816
M v[56:59], a[80:83], a[160:163], v[56:59]
M v[56:59], a[84:87], a[164:167], v[56:59]
M v[60:63], a[92:95], a[164:167], v[60:63]
M v[60:63], a[88:91], a[160:163], v[60:63]
s_waitcnt lgkmcnt(8)
ds_read_b64_tr_b16 a[120:121], v15 offset:32768
ds_read_b64_tr_b16 a[122:123], v15 offset:34816
M v[64:67], a[32:35], a[168:171], v[64:67]
M v[64:67], a[36:39], a[172:175], v[64:67]
ds_read_b128 a[184:187], v10 offset:6144
ds_read_b128 a[188:191], v11 offset:6144
M v[68:71], a[44:47], a[172:175], v[68:71]
M v[68:71], a[40:43], a[168:171], v[68:71]
ds_read_b64_tr_b16 a[128:129], v16 offset:32768
ds_read_b64_tr_b16 a[130:131], v16 offset:34816
M v[72:75], a[48:51], a[168:171], v[72:75]
buffer_load_dwordx4 v5, s[8:11], s23 offen offset:3072 lds
M v[72:75], a[52:55], a[172:175], v[72:75]
M v[76:79], a[60:63], a[172:175], v[76:79]
M v[76:79], a[56:59], a[168:171], v[76:79]
ds_read_b64_tr_b16 a[136:137], v17 offset:32768
ds_read_b64_tr_b16 a[138:139], v17 offset:34816
M v[80:83], a[64:67], a[168:171], v[80:83]
M v[80:83], a[68:71], a[172:175], v[80:83]
M v[84:87], a[76:79], a[172:175], v[84:87]
M v[84:87], a[72:75], a[168:171], v[84:87]
ds_read_b64_tr_b16 a[144:145], v18 offset:32768
ds_read_b64_tr_b16 a[146:147], v18 offset:34816
M v[88:91], a[80:83], a[168:171], v[88:91]
M v[88:91], a[84:87], a[172:175], v[88:91]
M v[92:95], a[92:95], a[172:175], v[92:95]
M v[92:95], a[88:91], a[168:171], v[92:95]
s_waitcnt lgkmcnt(15)
ds_read_b64_tr_b16 a[152:153], v19 offset:32768
ds_read_b64_tr_b16 a[154:155], v19 offset:34816
M v[96:99], a[32:35], a[176:179], v[96:99]
M v[96:99], a[36:39], a[180:183], v[96:99]
M v[100:103], a[44:47], a[180:183], v[100:103]
M v[100:103], a[40:43], a[176:179], v[100:103]
M v[104:107], a[48:51], a[176:179], v[104:107]
M v[104:107], a[52:55], a[180:183], v[104:107]
M v[108:111], a[60:63], a[180:183], v[108:111]
M v[108:111], a[56:59], a[176:179], v[108:111]
s_waitcnt vmcnt(5) lgkmcnt(0)
s_barrier
ds_read_b128 a[160:163], v10 offset:16384
ds_read_b128 a[164:167], v11 offset:16384
M v[112:115], a[64:67], a[176:179], v[112:115]
s_add_u32 m0, s29, 49152
s_add_u32 s3, s23, s31
buffer_load_dwordx4 v2, s[8:11], s3 offen offset:0 lds
M v[112:115], a[68:71], a[180:183], v[112:115]
M v[116:119], a[76:79], a[180:183], v[116:119]
buffer_load_dwordx4 v3, s[8:11], s3 offen offset:1024 lds
M v[116:119], a[72:75], a[176:179], v[116:119]
ds_read_b64_tr_b16 a[100:101], v12 offset:49152
ds_read_b64_tr_b16 a[102:103], v12 offset:51200
M v[120:123], a[80:83], a[176:179], v[120:123]
buffer_load_dwordx4 v4, s[8:11], s3 offen offset:2048 lds
M v[120:123], a[84:87], a[180:183], v[120:123]
M v[124:127], a[92:95], a[180:183], v[124:127]
buffer_load_dwordx4 v5, s[8:11], s3 offen offset:3072 lds
M v[124:127], a[88:91], a[176:179], v[124:127]
M v[128:131], a[32:35], a[184:187], v[128:131]
M v[128:131], a[36:39], a[188:191], v[128:131]
ds_read_b128 a[168:171], v10 offset:18432
ds_read_b128 a[172:175], v11 offset:18432
ds_read_b64_tr_b16 a[108:109], v13 offset:49152
ds_read_b64_tr_b16 a[110:111], v13 offset:51200
M v[132:135], a[44:47], a[188:191], v[132:135]
M v[132:135], a[40:43], a[184:187], v[132:135]
M v[136:139], a[48:51], a[184:187], v[136:139]
s_and_b32 s3, s2, 1
s_lshl_b32 s3, s3, 3
s_bfe_u32 s4, s2, 0x30003
s_add_u32 s26, s3, s4
M v[136:139], a[52:55], a[188:191], v[136:139]
s_bfe_u32 s3, s2, 0x20001
s_lshl_b32 s3, s3, 2
s_lshr_b32 s4, s2, 6
M v[140:143], a[60:63], a[188:191], v[140:143]
s_xor_b32 s4, s4, 3
s_add_u32 s27, s3, s4
s_lshl_b32 s23, s26, 18
M v[140:143], a[56:59], a[184:187], v[140:143]
ds_read_b64_tr_b16 a[116:117], v14 offset:49152
ds_read_b64_tr_b16 a[118:119], v14 offset:51200
s_sub_u32 s24, s23, 32768
s_max_i32 s24, s24, 0
s_lshl_b32 s25, s27, 7
M v[144:147], a[64:67], a[184:187], v[144:147]
s_mov_b64 s[8:9], s[44:45]
s_mov_b32 s10, 4194304
s_mov_b64 s[12:13], s[46:47]
M v[144:147], a[68:71], a[188:191], v[144:147]
s_mov_b32 s14, 6291456
s_mov_b64 s[36:37], s[90:91]
s_mov_b32 s38, 256
M v[148:151], a[76:79], a[188:191], v[148:151]
s_mov_b32 s39, 0x00020000
s_lshl_b32 s28, s20, 9
s_mul_i32 s30, s20, 6144
M v[148:151], a[72:75], a[184:187], v[148:151]
s_lshl_b32 s3, s20, 5
v_lshrrev_b32 v24, 3, v0
v_and_b32 v25, 7, v0
M v[152:155], a[80:83], a[184:187], v[152:155]
v_add_u32 v28, s3, v24
v_add_u32 v26, 0, v28
v_bfe_u32 v27, v26, 1, 3
M v[152:155], a[84:87], a[188:191], v[152:155]
ds_read_b64_tr_b16 a[124:125], v15 offset:49152
ds_read_b64_tr_b16 a[126:127], v15 offset:51200
v_xor_b32 v27, v27, v25
v_lshlrev_b32 v26, 11, v26
v_lshl_add_u32 v26, v27, 4, v26
M v[156:159], a[92:95], a[188:191], v[156:159]
v_subrev_u32 v2, 0, v26
v_add_u32 v26, 8, v28
v_bfe_u32 v27, v26, 1, 3
M v[156:159], a[88:91], a[184:187], v[156:159]
s_waitcnt lgkmcnt(10)
v_xor_b32 v27, v27, v25
v_lshlrev_b32 v26, 11, v26
v_lshl_add_u32 v26, v27, 4, v26
M v[160:163], a[32:35], a[160:163], v[160:163]
v_subrev_u32 v3, 1024, v26
v_add_u32 v26, 16, v28
v_bfe_u32 v27, v26, 1, 3
M v[160:163], a[36:39], a[164:167], v[160:163]
ds_read_b128 a[176:179], v10 offset:20480
ds_read_b128 a[180:183], v11 offset:20480
v_xor_b32 v27, v27, v25
v_lshlrev_b32 v26, 11, v26
v_lshl_add_u32 v26, v27, 4, v26
M v[164:167], a[44:47], a[164:167], v[164:167]
v_subrev_u32 v4, 2048, v26
v_add_u32 v26, 24, v28
v_bfe_u32 v27, v26, 1, 3
M v[164:167], a[40:43], a[160:163], v[164:167]
ds_read_b64_tr_b16 a[132:133], v16 offset:49152
ds_read_b64_tr_b16 a[134:135], v16 offset:51200
v_xor_b32 v27, v27, v25
v_lshlrev_b32 v26, 11, v26
v_lshl_add_u32 v26, v27, 4, v26
M v[168:171], a[48:51], a[160:163], v[168:171]
v_subrev_u32 v5, 3072, v26
s_lshl_b32 s3, s20, 2
v_lshrrev_b32 v26, 5, v0
M v[168:171], a[52:55], a[164:167], v[168:171]
v_add_u32 v26, s3, v26
v_bfe_u32 v29, v0, 2, 3
v_bfe_u32 v27, v26, 1, 3
M v[172:175], a[60:63], a[164:167], v[172:175]
v_xor_b32 v27, v27, v29
v_lshlrev_b32 v27, 4, v27
v_and_b32 v30, 3, v0
M v[172:175], a[56:59], a[160:163], v[172:175]
v_lshl_add_u32 v27, v30, 2, v27
v_lshl_add_u32 v20, v26, 11, v27
v_add_u32 v26, 2, v26
M v[176:179], a[64:67], a[160:163], v[176:179]
v_bfe_u32 v27, v26, 1, 3
v_xor_b32 v27, v27, v29
v_lshlrev_b32 v27, 4, v27
M v[176:179], a[68:71], a[164:167], v[176:179]
ds_read_b64_tr_b16 a[140:141], v17 offset:49152
ds_read_b64_tr_b16 a[142:143], v17 offset:51200
v_and_b32 v30, 3, v0
v_lshl_add_u32 v27, v30, 2, v27
v_lshl_add_u32 v23, v26, 11, v27
M v[180:183], a[76:79], a[164:167], v[180:183]
v_subrev_u32 v23, 256, v23
s_mul_i32 s3, s20, 48
v_add_u32 v28, s3, v24
M v[180:183], a[72:75], a[160:163], v[180:183]
v_add_u32 v26, 0, v28
v_mul_u32_u24 v27, 0xaaab, v26
v_lshrrev_b32 v27, 17, v27
M v[184:187], a[80:83], a[160:163], v[184:187]
v_lshrrev_b32 v29, 1, v27
v_and_b32 v29, 4, v29
v_and_or_b32 v27, v27, 2, v29
M v[184:187], a[84:87], a[164:167], v[184:187]
v_xor_b32 v27, v27, v25
v_lshlrev_b32 v26, 11, v26
v_lshl_add_u32 v26, v27, 4, v26
M v[188:191], a[92:95], a[164:167], v[188:191]
v_subrev_u32 v6, 0, v26
v_add_u32 v26, 8, v28
v_mul_u32_u24 v27, 0xaaab, v26
M v[188:191], a[88:91], a[160:163], v[188:191]
s_waitcnt lgkmcnt(12)
ds_read_b64_tr_b16 a[148:149], v18 offset:49152
ds_read_b64_tr_b16 a[150:151], v18 offset:51200
v_lshrrev_b32 v27, 17, v27
v_lshrrev_b32 v29, 1, v27
v_and_b32 v29, 4, v29
M v[192:195], a[32:35], a[168:171], v[192:195]
v_and_or_b32 v27, v27, 2, v29
v_xor_b32 v27, v27, v25
v_lshlrev_b32 v26, 11, v26
M v[192:195], a[36:39], a[172:175], v[192:195]
ds_read_b128 a[184:187], v10 offset:22528
ds_read_b128 a[188:191], v11 offset:22528
v_lshl_add_u32 v26, v27, 4, v26
v_subrev_u32 v7, 1024, v26
v_add_u32 v26, 16, v28
M v[196:199], a[44:47], a[172:175], v[196:199]
v_mul_u32_u24 v27, 0xaaab, v26
v_lshrrev_b32 v27, 17, v27
v_lshrrev_b32 v29, 1, v27
M v[196:199], a[40:43], a[168:171], v[196:199]
v_and_b32 v29, 4, v29
v_and_or_b32 v27, v27, 2, v29
v_xor_b32 v27, v27, v25
M v[200:203], a[48:51], a[168:171], v[200:203]
v_lshlrev_b32 v26, 11, v26
v_lshl_add_u32 v26, v27, 4, v26
v_subrev_u32 v8, 2048, v26
M v[200:203], a[52:55], a[172:175], v[200:203]
ds_read_b64_tr_b16 a[156:157], v19 offset:49152
ds_read_b64_tr_b16 a[158:159], v19 offset:51200
v_add_u32 v26, 24, v28
v_mul_u32_u24 v27, 0xaaab, v26
v_lshrrev_b32 v27, 17, v27
M v[204:207], a[60:63], a[172:175], v[204:207]
v_lshrrev_b32 v29, 1, v27
v_and_b32 v29, 4, v29
v_and_or_b32 v27, v27, 2, v29
M v[204:207], a[56:59], a[168:171], v[204:207]
v_xor_b32 v27, v27, v25
v_lshlrev_b32 v26, 11, v26
v_lshl_add_u32 v26, v27, 4, v26
M v[208:211], a[64:67], a[168:171], v[208:211]
v_subrev_u32 v9, 3072, v26
v_add_u32 v26, 32, v28
v_mul_u32_u24 v27, 0xaaab, v26
M v[208:211], a[68:71], a[172:175], v[208:211]
v_lshrrev_b32 v27, 17, v27
v_lshrrev_b32 v29, 1, v27
v_and_b32 v29, 4, v29
M v[212:215], a[76:79], a[172:175], v[212:215]
v_and_or_b32 v27, v27, 2, v29
v_xor_b32 v27, v27, v25
v_lshlrev_b32 v26, 11, v26
M v[212:215], a[72:75], a[168:171], v[212:215]
v_lshl_add_u32 v26, v27, 4, v26
v_subrev_u32 v21, 0, v26
v_add_u32 v26, 40, v28
M v[216:219], a[80:83], a[168:171], v[216:219]
v_mul_u32_u24 v27, 0xaaab, v26
v_lshrrev_b32 v27, 17, v27
v_lshrrev_b32 v29, 1, v27
M v[216:219], a[84:87], a[172:175], v[216:219]
v_and_b32 v29, 4, v29
v_and_or_b32 v27, v27, 2, v29
v_xor_b32 v27, v27, v25
M v[220:223], a[92:95], a[172:175], v[220:223]
v_lshlrev_b32 v26, 11, v26
v_lshl_add_u32 v26, v27, 4, v26
v_subrev_u32 v22, 1024, v26
M v[220:223], a[88:91], a[168:171], v[220:223]
s_waitcnt lgkmcnt(10)
s_lshr_b32 s3, s53, 7
s_add_u32 s3, s3, s22
s_lshl_b32 s3, s3, 5
M v[224:227], a[32:35], a[176:179], v[224:227]
s_lshr_b32 s19, s52, 6
s_add_u32 s3, s3, s19
s_lshl_b32 s19, s21, 1
M v[224:227], a[36:39], a[180:183], v[224:227]
s_add_u32 s3, s3, s19
s_lshl_b32 s92, s3, 14
s_add_u32 s93, s92, 16384
M v[228:231], a[44:47], a[180:183], v[228:231]
s_add_u32 s16, s50, 0
s_addc_u32 s17, s51, 0
s_mov_b32 s18, 16777216
M v[228:231], a[40:43], a[176:179], v[228:231]
s_mov_b32 s19, 0x00020000
s_mov_b32 s4, 0x3e0293ee
s_mov_b32 s5, 0x3e0293ee
M v[232:235], a[48:51], a[176:179], v[232:235]
M v[232:235], a[52:55], a[180:183], v[232:235]
M v[236:239], a[60:63], a[180:183], v[236:239]
M v[236:239], a[56:59], a[176:179], v[236:239]
s_waitcnt vmcnt(4) lgkmcnt(0)
s_barrier
ds_read_b128 a[160:163], v10 offset:32768
ds_read_b128 a[164:167], v11 offset:32768
M v[240:243], a[64:67], a[176:179], v[240:243]
s_add_u32 m0, s28, 131072
s_nop 0
buffer_load_dword v20, s[8:11], s24 offen lds
M v[240:243], a[68:71], a[180:183], v[240:243]
M v[244:247], a[76:79], a[180:183], v[244:247]
M v[244:247], a[72:75], a[176:179], v[244:247]
M v[248:251], a[80:83], a[176:179], v[248:251]
buffer_load_dword v23, s[8:11], s24 offen offset:256 lds
s_add_u32 s24, s24, 128
M v[248:251], a[84:87], a[180:183], v[248:251]
M v[252:255], a[92:95], a[180:183], v[252:255]
M v[252:255], a[88:91], a[176:179], v[252:255]
M a[0:3], a[32:35], a[184:187], a[0:3]
M a[0:3], a[36:39], a[188:191], a[0:3]
ds_read_b128 a[168:171], v10 offset:34816
ds_read_b128 a[172:175], v11 offset:34816
M a[4:7], a[44:47], a[188:191], a[4:7]
s_add_u32 m0, s29, 133120
s_nop 0
buffer_load_dwordx4 v2, s[8:11], s23 offen offset:0 lds
M a[4:7], a[40:43], a[184:187], a[4:7]
M a[8:11], a[48:51], a[184:187], a[8:11]
M a[8:11], a[52:55], a[188:191], a[8:11]
M a[12:15], a[60:63], a[188:191], a[12:15]
buffer_load_dwordx4 v3, s[8:11], s23 offen offset:1024 lds
M a[12:15], a[56:59], a[184:187], a[12:15]
M a[16:19], a[64:67], a[184:187], a[16:19]
M a[16:19], a[68:71], a[188:191], a[16:19]
M a[20:23], a[76:79], a[188:191], a[20:23]
buffer_load_dwordx4 v4, s[8:11], s23 offen offset:2048 lds
M a[20:23], a[72:75], a[184:187], a[20:23]
M a[24:27], a[80:83], a[184:187], a[24:27]
M a[24:27], a[84:87], a[188:191], a[24:27]
M a[28:31], a[92:95], a[188:191], a[28:31]
M a[28:31], a[88:91], a[184:187], a[28:31]
s_waitcnt lgkmcnt(2)
M v[32:35], a[96:99], a[160:163], v[32:35]
buffer_load_dwordx4 v5, s[8:11], s23 offen offset:3072 lds
s_add_u32 s23, s23, 128
M v[32:35], a[100:103], a[164:167], v[32:35]
ds_read_b128 a[176:179], v10 offset:36864
ds_read_b128 a[180:183], v11 offset:36864
M v[36:39], a[108:111], a[164:167], v[36:39]
M v[36:39], a[104:107], a[160:163], v[36:39]
M v[40:43], a[112:115], a[160:163], v[40:43]
M v[40:43], a[116:119], a[164:167], v[40:43]
s_add_u32 m0, s30, 65536
s_nop 0
buffer_load_dwordx4 v6, s[12:15], s25 offen offset:0 lds
M v[44:47], a[124:127], a[164:167], v[44:47]
M v[44:47], a[120:123], a[160:163], v[44:47]
M v[48:51], a[128:131], a[160:163], v[48:51]
M v[48:51], a[132:135], a[164:167], v[48:51]
M v[52:55], a[140:143], a[164:167], v[52:55]
buffer_load_dwordx4 v7, s[12:15], s25 offen offset:1024 lds
M v[52:55], a[136:139], a[160:163], v[52:55]
M v[56:59], a[144:147], a[160:163], v[56:59]
M v[56:59], a[148:151], a[164:167], v[56:59]
M v[60:63], a[156:159], a[164:167], v[60:63]
buffer_load_dwordx4 v8, s[12:15], s25 offen offset:2048 lds
M v[60:63], a[152:155], a[160:163], v[60:63]
s_waitcnt lgkmcnt(2)
M v[64:67], a[96:99], a[168:171], v[64:67]
M v[64:67], a[100:103], a[172:175], v[64:67]
ds_read_b128 a[184:187], v10 offset:38912
ds_read_b128 a[188:191], v11 offset:38912
M v[68:71], a[108:111], a[172:175], v[68:71]
M v[68:71], a[104:107], a[168:171], v[68:71]
v_pk_mul_f32 v[32:33], v[32:33], s[4:5]
v_pk_mul_f32 v[34:35], v[34:35], s[4:5]
v_pk_mul_f32 v[36:37], v[36:37], s[4:5]
M v[72:75], a[112:115], a[168:171], v[72:75]
v_pk_mul_f32 v[38:39], v[38:39], s[4:5]
v_cvt_pk_bf16_f32 v32, v32, v33
M v[72:75], a[116:119], a[172:175], v[72:75]
buffer_load_dwordx4 v9, s[12:15], s25 offen offset:3072 lds
v_cvt_pk_bf16_f32 v33, v34, v35
v_cvt_pk_bf16_f32 v34, v36, v37
M v[76:79], a[124:127], a[172:175], v[76:79]
v_cvt_pk_bf16_f32 v35, v38, v39
v_pk_mul_f32 v[40:41], v[40:41], s[4:5]
v_pk_mul_f32 v[42:43], v[42:43], s[4:5]
M v[76:79], a[120:123], a[168:171], v[76:79]
v_pk_mul_f32 v[44:45], v[44:45], s[4:5]
v_pk_mul_f32 v[46:47], v[46:47], s[4:5]
M v[80:83], a[128:131], a[168:171], v[80:83]
v_cvt_pk_bf16_f32 v40, v40, v41
v_cvt_pk_bf16_f32 v41, v42, v43
M v[80:83], a[132:135], a[172:175], v[80:83]
s_add_u32 m0, s30, 69632
s_nop 0
buffer_load_dwordx4 v21, s[12:15], s25 offen offset:0 lds
v_cvt_pk_bf16_f32 v42, v44, v45
v_cvt_pk_bf16_f32 v43, v46, v47
M v[84:87], a[140:143], a[172:175], v[84:87]
v_pk_mul_f32 v[48:49], v[48:49], s[4:5]
v_pk_mul_f32 v[50:51], v[50:51], s[4:5]
v_pk_mul_f32 v[52:53], v[52:53], s[4:5]
M v[84:87], a[136:139], a[168:171], v[84:87]
v_pk_mul_f32 v[54:55], v[54:55], s[4:5]
v_cvt_pk_bf16_f32 v48, v48, v49
M v[88:91], a[144:147], a[168:171], v[88:91]
v_cvt_pk_bf16_f32 v49, v50, v51
v_cvt_pk_bf16_f32 v50, v52, v53
M v[88:91], a[148:151], a[172:175], v[88:91]
v_cvt_pk_bf16_f32 v51, v54, v55
v_pk_mul_f32 v[56:57], v[56:57], s[4:5]
v_pk_mul_f32 v[58:59], v[58:59], s[4:5]
M v[92:95], a[156:159], a[172:175], v[92:95]
buffer_load_dwordx4 v22, s[12:15], s25 offen offset:1024 lds
s_add_u32 s25, s25, 393216
v_pk_mul_f32 v[60:61], v[60:61], s[4:5]
v_pk_mul_f32 v[62:63], v[62:63], s[4:5]
M v[92:95], a[152:155], a[168:171], v[92:95]
s_waitcnt lgkmcnt(2)
v_cvt_pk_bf16_f32 v56, v56, v57
v_cvt_pk_bf16_f32 v57, v58, v59
M v[96:99], a[96:99], a[176:179], v[96:99]
v_cvt_pk_bf16_f32 v58, v60, v61
v_cvt_pk_bf16_f32 v59, v62, v63
M v[96:99], a[100:103], a[180:183], v[96:99]
M v[100:103], a[108:111], a[180:183], v[100:103]
M v[100:103], a[104:107], a[176:179], v[100:103]
v_pk_mul_f32 v[64:65], v[64:65], s[4:5]
v_pk_mul_f32 v[66:67], v[66:67], s[4:5]
v_pk_mul_f32 v[68:69], v[68:69], s[4:5]
M v[104:107], a[112:115], a[176:179], v[104:107]
s_add_u32 s94, s92, 0
buffer_store_dwordx4 v[32:35], v1, s[16:19], s94 offen offset:0 sc1
v_pk_mul_f32 v[70:71], v[70:71], s[4:5]
v_cvt_pk_bf16_f32 v64, v64, v65
M v[104:107], a[116:119], a[180:183], v[104:107]
v_cvt_pk_bf16_f32 v65, v66, v67
v_cvt_pk_bf16_f32 v66, v68, v69
M v[108:111], a[124:127], a[180:183], v[108:111]
v_cvt_pk_bf16_f32 v67, v70, v71
v_pk_mul_f32 v[72:73], v[72:73], s[4:5]
v_pk_mul_f32 v[74:75], v[74:75], s[4:5]
M v[108:111], a[120:123], a[176:179], v[108:111]
s_waitcnt vmcnt(13) lgkmcnt(0)
s_barrier
ds_read_b128 a[160:163], v10 offset:49152
ds_read_b128 a[164:167], v11 offset:49152
v_pk_mul_f32 v[76:77], v[76:77], s[4:5]
v_pk_mul_f32 v[78:79], v[78:79], s[4:5]
M v[112:115], a[128:131], a[176:179], v[112:115]
s_add_u32 m0, s28, 0
s_nop 0
buffer_load_dword v20, s[8:11], s24 offen lds
v_cvt_pk_bf16_f32 v72, v72, v73
v_cvt_pk_bf16_f32 v73, v74, v75
M v[112:115], a[132:135], a[180:183], v[112:115]
v_cvt_pk_bf16_f32 v74, v76, v77
v_cvt_pk_bf16_f32 v75, v78, v79
M v[116:119], a[140:143], a[180:183], v[116:119]
s_add_u32 s94, s92, 0
buffer_store_dwordx4 v[40:43], v1, s[16:19], s94 offen offset:1024 sc1
v_pk_mul_f32 v[80:81], v[80:81], s[4:5]
v_pk_mul_f32 v[82:83], v[82:83], s[4:5]
v_pk_mul_f32 v[84:85], v[84:85], s[4:5]
M v[116:119], a[136:139], a[176:179], v[116:119]
v_pk_mul_f32 v[86:87], v[86:87], s[4:5]
v_cvt_pk_bf16_f32 v80, v80, v81
M v[120:123], a[144:147], a[176:179], v[120:123]
buffer_load_dword v23, s[8:11], s24 offen offset:256 lds
s_add_u32 s24, s24, 128
v_cvt_pk_bf16_f32 v81, v82, v83
v_cvt_pk_bf16_f32 v82, v84, v85
M v[120:123], a[148:151], a[180:183], v[120:123]
v_cvt_pk_bf16_f32 v83, v86, v87
v_pk_mul_f32 v[88:89], v[88:89], s[4:5]
v_pk_mul_f32 v[90:91], v[90:91], s[4:5]
M v[124:127], a[156:159], a[180:183], v[124:127]
v_pk_mul_f32 v[92:93], v[92:93], s[4:5]
v_pk_mul_f32 v[94:95], v[94:95], s[4:5]
M v[124:127], a[152:155], a[176:179], v[124:127]
v_cvt_pk_bf16_f32 v88, v88, v89
v_cvt_pk_bf16_f32 v89, v90, v91
M v[128:131], a[96:99], a[184:187], v[128:131]
v_cvt_pk_bf16_f32 v90, v92, v93
v_cvt_pk_bf16_f32 v91, v94, v95
M v[128:131], a[100:103], a[188:191], v[128:131]
ds_read_b128 a[168:171], v10 offset:51200
ds_read_b128 a[172:175], v11 offset:51200
M v[132:135], a[108:111], a[188:191], v[132:135]
s_add_u32 s94, s92, 0
buffer_store_dwordx4 v[48:51], v1, s[16:19], s94 offen offset:2048 sc1
M v[132:135], a[104:107], a[184:187], v[132:135]
s_add_u32 m0, s29, 2048
s_nop 0
buffer_load_dwordx4 v2, s[8:11], s23 offen offset:0 lds
v_pk_mul_f32 v[96:97], v[96:97], s[4:5]
v_pk_mul_f32 v[98:99], v[98:99], s[4:5]
v_pk_mul_f32 v[100:101], v[100:101], s[4:5]
M v[136:139], a[112:115], a[184:187], v[136:139]
v_pk_mul_f32 v[102:103], v[102:103], s[4:5]
v_cvt_pk_bf16_f32 v96, v96, v97
M v[136:139], a[116:119], a[188:191], v[136:139]
v_cvt_pk_bf16_f32 v97, v98, v99
v_cvt_pk_bf16_f32 v98, v100, v101
M v[140:143], a[124:127], a[188:191], v[140:143]
v_cvt_pk_bf16_f32 v99, v102, v103
v_pk_mul_f32 v[104:105], v[104:105], s[4:5]
v_pk_mul_f32 v[106:107], v[106:107], s[4:5]
M v[140:143], a[120:123], a[184:187], v[140:143]
buffer_load_dwordx4 v3, s[8:11], s23 offen offset:1024 lds
v_pk_mul_f32 v[108:109], v[108:109], s[4:5]
v_pk_mul_f32 v[110:111], v[110:111], s[4:5]
M v[144:147], a[128:131], a[184:187], v[144:147]
s_add_u32 s94, s92, 0
buffer_store_dwordx4 v[56:59], v1, s[16:19], s94 offen offset:3072 sc1
v_cvt_pk_bf16_f32 v104, v104, v105
v_cvt_pk_bf16_f32 v105, v106, v107
M v[144:147], a[132:135], a[188:191], v[144:147]
v_cvt_pk_bf16_f32 v106, v108, v109
v_cvt_pk_bf16_f32 v107, v110, v111
M v[148:151], a[140:143], a[188:191], v[148:151]
v_pk_mul_f32 v[112:113], v[112:113], s[4:5]
v_pk_mul_f32 v[114:115], v[114:115], s[4:5]
v_pk_mul_f32 v[116:117], v[116:117], s[4:5]
M v[148:151], a[136:139], a[184:187], v[148:151]
v_pk_mul_f32 v[118:119], v[118:119], s[4:5]
v_cvt_pk_bf16_f32 v112, v112, v113
M v[152:155], a[144:147], a[184:187], v[152:155]
buffer_load_dwordx4 v4, s[8:11], s23 offen offset:2048 lds
v_cvt_pk_bf16_f32 v113, v114, v115
v_cvt_pk_bf16_f32 v114, v116, v117
M v[152:155], a[148:151], a[188:191], v[152:155]
v_cvt_pk_bf16_f32 v115, v118, v119
v_pk_mul_f32 v[120:121], v[120:121], s[4:5]
v_pk_mul_f32 v[122:123], v[122:123], s[4:5]
M v[156:159], a[156:159], a[188:191], v[156:159]
v_pk_mul_f32 v[124:125], v[124:125], s[4:5]
v_pk_mul_f32 v[126:127], v[126:127], s[4:5]
M v[156:159], a[152:155], a[184:187], v[156:159]
s_add_u32 s94, s92, 4096
buffer_store_dwordx4 v[64:67], v1, s[16:19], s94 offen offset:0 sc1
s_waitcnt lgkmcnt(2)
v_cvt_pk_bf16_f32 v120, v120, v121
v_cvt_pk_bf16_f32 v121, v122, v123
M v[160:163], a[96:99], a[160:163], v[160:163]
v_cvt_pk_bf16_f32 v122, v124, v125
v_cvt_pk_bf16_f32 v123, v126, v127
M v[160:163], a[100:103], a[164:167], v[160:163]
ds_read_b128 a[176:179], v10 offset:53248
ds_read_b128 a[180:183], v11 offset:53248
M v[164:167], a[108:111], a[164:167], v[164:167]
buffer_load_dwordx4 v5, s[8:11], s23 offen offset:3072 lds
s_add_u32 s23, s23, 128
M v[164:167], a[104:107], a[160:163], v[164:167]
v_pk_mul_f32 v[128:129], v[128:129], s[4:5]
v_pk_mul_f32 v[130:131], v[130:131], s[4:5]
v_pk_mul_f32 v[132:133], v[132:133], s[4:5]
M v[168:171], a[112:115], a[160:163], v[168:171]
v_pk_mul_f32 v[134:135], v[134:135], s[4:5]
v_cvt_pk_bf16_f32 v128, v128, v129
M v[168:171], a[116:119], a[164:167], v[168:171]
s_add_u32 s94, s92, 4096
buffer_store_dwordx4 v[72:75], v1, s[16:19], s94 offen offset:1024 sc1
v_cvt_pk_bf16_f32 v129, v130, v131
v_cvt_pk_bf16_f32 v130, v132, v133
M v[172:175], a[124:127], a[164:167], v[172:175]
v_cvt_pk_bf16_f32 v131, v134, v135
v_pk_mul_f32 v[136:137], v[136:137], s[4:5]
v_pk_mul_f32 v[138:139], v[138:139], s[4:5]
M v[172:175], a[120:123], a[160:163], v[172:175]
s_add_u32 m0, s30, 98304
s_nop 0
buffer_load_dwordx4 v6, s[12:15], s25 offen offset:0 lds
v_pk_mul_f32 v[140:141], v[140:141], s[4:5]
v_pk_mul_f32 v[142:143], v[142:143], s[4:5]
M v[176:179], a[128:131], a[160:163], v[176:179]
v_cvt_pk_bf16_f32 v136, v136, v137
v_cvt_pk_bf16_f32 v137, v138, v139
M v[176:179], a[132:135], a[164:167], v[176:179]
v_cvt_pk_bf16_f32 v138, v140, v141
v_cvt_pk_bf16_f32 v139, v142, v143
M v[180:183], a[140:143], a[164:167], v[180:183]
buffer_load_dwordx4 v7, s[12:15], s25 offen offset:1024 lds
v_pk_mul_f32 v[144:145], v[144:145], s[4:5]
v_pk_mul_f32 v[146:147], v[146:147], s[4:5]
v_pk_mul_f32 v[148:149], v[148:149], s[4:5]
M v[180:183], a[136:139], a[160:163], v[180:183]
v_pk_mul_f32 v[150:151], v[150:151], s[4:5]
v_cvt_pk_bf16_f32 v144, v144, v145
M v[184:187], a[144:147], a[160:163], v[184:187]
s_add_u32 s94, s92, 4096
buffer_store_dwordx4 v[80:83], v1, s[16:19], s94 offen offset:2048 sc1
v_cvt_pk_bf16_f32 v145, v146, v147
v_cvt_pk_bf16_f32 v146, v148, v149
M v[184:187], a[148:151], a[164:167], v[184:187]
v_cvt_pk_bf16_f32 v147, v150, v151
v_pk_mul_f32 v[152:153], v[152:153], s[4:5]
v_pk_mul_f32 v[154:155], v[154:155], s[4:5]
M v[188:191], a[156:159], a[164:167], v[188:191]
v_pk_mul_f32 v[156:157], v[156:157], s[4:5]
v_pk_mul_f32 v[158:159], v[158:159], s[4:5]
M v[188:191], a[152:155], a[160:163], v[188:191]
s_waitcnt lgkmcnt(2)
v_cvt_pk_bf16_f32 v152, v152, v153
v_cvt_pk_bf16_f32 v153, v154, v155
M v[192:195], a[96:99], a[168:171], v[192:195]
buffer_load_dwordx4 v8, s[12:15], s25 offen offset:2048 lds
v_cvt_pk_bf16_f32 v154, v156, v157
v_cvt_pk_bf16_f32 v155, v158, v159
M v[192:195], a[100:103], a[172:175], v[192:195]
ds_read_b128 a[184:187], v10 offset:55296
ds_read_b128 a[188:191], v11 offset:55296
M v[196:199], a[108:111], a[172:175], v[196:199]
M v[196:199], a[104:107], a[168:171], v[196:199]
s_add_u32 s94, s92, 4096
buffer_store_dwordx4 v[88:91], v1, s[16:19], s94 offen offset:3072 sc1
v_pk_mul_f32 v[160:161], v[160:161], s[4:5]
v_pk_mul_f32 v[162:163], v[162:163], s[4:5]
v_pk_mul_f32 v[164:165], v[164:165], s[4:5]
M v[200:203], a[112:115], a[168:171], v[200:203]
v_pk_mul_f32 v[166:167], v[166:167], s[4:5]
v_cvt_pk_bf16_f32 v160, v160, v161
M v[200:203], a[116:119], a[172:175], v[200:203]
v_cvt_pk_bf16_f32 v161, v162, v163
v_cvt_pk_bf16_f32 v162, v164, v165
M v[204:207], a[124:127], a[172:175], v[204:207]
buffer_load_dwordx4 v9, s[12:15], s25 offen offset:3072 lds
v_cvt_pk_bf16_f32 v163, v166, v167
v_pk_mul_f32 v[168:169], v[168:169], s[4:5]
v_pk_mul_f32 v[170:171], v[170:171], s[4:5]
M v[204:207], a[120:123], a[168:171], v[204:207]
v_pk_mul_f32 v[172:173], v[172:173], s[4:5]
v_pk_mul_f32 v[174:175], v[174:175], s[4:5]
M v[208:211], a[128:131], a[168:171], v[208:211]
v_cvt_pk_bf16_f32 v168, v168, v169
v_cvt_pk_bf16_f32 v169, v170, v171
M v[208:211], a[132:135], a[172:175], v[208:211]
v_cvt_pk_bf16_f32 v170, v172, v173
v_cvt_pk_bf16_f32 v171, v174, v175
M v[212:215], a[140:143], a[172:175], v[212:215]
s_add_u32 s94, s92, 8192
buffer_store_dwordx4 v[96:99], v1, s[16:19], s94 offen offset:0 sc1
v_pk_mul_f32 v[176:177], v[176:177], s[4:5]
v_pk_mul_f32 v[178:179], v[178:179], s[4:5]
v_pk_mul_f32 v[180:181], v[180:181], s[4:5]
M v[212:215], a[136:139], a[168:171], v[212:215]
s_add_u32 m0, s30, 102400
s_nop 0
buffer_load_dwordx4 v21, s[12:15], s25 offen offset:0 lds
v_pk_mul_f32 v[182:183], v[182:183], s[4:5]
v_cvt_pk_bf16_f32 v176, v176, v177
M v[216:219], a[144:147], a[168:171], v[216:219]
v_cvt_pk_bf16_f32 v177, v178, v179
v_cvt_pk_bf16_f32 v178, v180, v181
M v[216:219], a[148:151], a[172:175], v[216:219]
v_cvt_pk_bf16_f32 v179, v182, v183
v_pk_mul_f32 v[184:185], v[184:185], s[4:5]
v_pk_mul_f32 v[186:187], v[186:187], s[4:5]
M v[220:223], a[156:159], a[172:175], v[220:223]
v_pk_mul_f32 v[188:189], v[188:189], s[4:5]
v_pk_mul_f32 v[190:191], v[190:191], s[4:5]
M v[220:223], a[152:155], a[168:171], v[220:223]
s_waitcnt lgkmcnt(2)
v_cvt_pk_bf16_f32 v184, v184, v185
v_cvt_pk_bf16_f32 v185, v186, v187
M v[224:227], a[96:99], a[176:179], v[224:227]
s_add_u32 s94, s92, 8192
buffer_store_dwordx4 v[104:107], v1, s[16:19], s94 offen offset:1024 sc1
v_cvt_pk_bf16_f32 v186, v188, v189
v_cvt_pk_bf16_f32 v187, v190, v191
M v[224:227], a[100:103], a[180:183], v[224:227]
buffer_load_dwordx4 v22, s[12:15], s25 offen offset:1024 lds
s_add_u32 s25, s25, 393216
M v[228:231], a[108:111], a[180:183], v[228:231]
M v[228:231], a[104:107], a[176:179], v[228:231]
v_pk_mul_f32 v[192:193], v[192:193], s[4:5]
v_pk_mul_f32 v[194:195], v[194:195], s[4:5]
v_pk_mul_f32 v[196:197], v[196:197], s[4:5]
M v[232:235], a[112:115], a[176:179], v[232:235]
v_pk_mul_f32 v[198:199], v[198:199], s[4:5]
v_cvt_pk_bf16_f32 v192, v192, v193
M v[232:235], a[116:119], a[180:183], v[232:235]
v_cvt_pk_bf16_f32 v193, v194, v195
v_cvt_pk_bf16_f32 v194, v196, v197
M v[236:239], a[124:127], a[180:183], v[236:239]
v_cvt_pk_bf16_f32 v195, v198, v199
v_pk_mul_f32 v[200:201], v[200:201], s[4:5]
v_pk_mul_f32 v[202:203], v[202:203], s[4:5]
M v[236:239], a[120:123], a[176:179], v[236:239]
s_waitcnt vmcnt(63) lgkmcnt(0)
s_barrier
v_pk_mul_f32 v[204:205], v[204:205], s[4:5]
v_pk_mul_f32 v[206:207], v[206:207], s[4:5]
M v[240:243], a[128:131], a[176:179], v[240:243]
s_add_u32 s94, s92, 8192
buffer_store_dwordx4 v[112:115], v1, s[16:19], s94 offen offset:2048 sc1
v_cvt_pk_bf16_f32 v200, v200, v201
v_cvt_pk_bf16_f32 v201, v202, v203
M v[240:243], a[132:135], a[180:183], v[240:243]
s_add_u32 m0, s28, 18432
s_nop 0
buffer_load_dword v20, s[8:11], s24 offen lds
v_cvt_pk_bf16_f32 v202, v204, v205
v_cvt_pk_bf16_f32 v203, v206, v207
M v[244:247], a[140:143], a[180:183], v[244:247]
v_pk_mul_f32 v[208:209], v[208:209], s[4:5]
v_pk_mul_f32 v[210:211], v[210:211], s[4:5]
v_pk_mul_f32 v[212:213], v[212:213], s[4:5]
M v[244:247], a[136:139], a[176:179], v[244:247]
v_pk_mul_f32 v[214:215], v[214:215], s[4:5]
v_cvt_pk_bf16_f32 v208, v208, v209
M v[248:251], a[144:147], a[176:179], v[248:251]
buffer_load_dword v23, s[8:11], s24 offen offset:256 lds
s_add_u32 s24, s24, 128
v_cvt_pk_bf16_f32 v209, v210, v211
v_cvt_pk_bf16_f32 v210, v212, v213
M v[248:251], a[148:151], a[180:183], v[248:251]
v_cvt_pk_bf16_f32 v211, v214, v215
v_pk_mul_f32 v[216:217], v[216:217], s[4:5]
v_pk_mul_f32 v[218:219], v[218:219], s[4:5]
M v[252:255], a[156:159], a[180:183], v[252:255]
s_add_u32 s94, s92, 8192
buffer_store_dwordx4 v[120:123], v1, s[16:19], s94 offen offset:3072 sc1
v_pk_mul_f32 v[220:221], v[220:221], s[4:5]
v_pk_mul_f32 v[222:223], v[222:223], s[4:5]
M v[252:255], a[152:155], a[176:179], v[252:255]
v_cvt_pk_bf16_f32 v216, v216, v217
v_cvt_pk_bf16_f32 v217, v218, v219
M a[0:3], a[96:99], a[184:187], a[0:3]
v_cvt_pk_bf16_f32 v218, v220, v221
v_cvt_pk_bf16_f32 v219, v222, v223
M a[0:3], a[100:103], a[188:191], a[0:3]
M a[4:7], a[108:111], a[188:191], a[4:7]
s_add_u32 m0, s29, 20480
s_nop 0
buffer_load_dwordx4 v2, s[8:11], s23 offen offset:0 lds
M a[4:7], a[104:107], a[184:187], a[4:7]
v_pk_mul_f32 v[224:225], v[224:225], s[4:5]
v_pk_mul_f32 v[226:227], v[226:227], s[4:5]
v_pk_mul_f32 v[228:229], v[228:229], s[4:5]
M a[8:11], a[112:115], a[184:187], a[8:11]
v_pk_mul_f32 v[230:231], v[230:231], s[4:5]
v_cvt_pk_bf16_f32 v224, v224, v225
M a[8:11], a[116:119], a[188:191], a[8:11]
s_add_u32 s94, s92, 12288
buffer_store_dwordx4 v[128:131], v1, s[16:19], s94 offen offset:0 sc1
v_cvt_pk_bf16_f32 v225, v226, v227
v_cvt_pk_bf16_f32 v226, v228, v229
M a[12:15], a[124:127], a[188:191], a[12:15]
buffer_load_dwordx4 v3, s[8:11], s23 offen offset:1024 lds
v_cvt_pk_bf16_f32 v227, v230, v231
v_pk_mul_f32 v[232:233], v[232:233], s[4:5]
v_pk_mul_f32 v[234:235], v[234:235], s[4:5]
M a[12:15], a[120:123], a[184:187], a[12:15]
v_pk_mul_f32 v[236:237], v[236:237], s[4:5]
v_pk_mul_f32 v[238:239], v[238:239], s[4:5]
M a[16:19], a[128:131], a[184:187], a[16:19]
v_cvt_pk_bf16_f32 v232, v232, v233
v_cvt_pk_bf16_f32 v233, v234, v235
M a[16:19], a[132:135], a[188:191], a[16:19]
v_cvt_pk_bf16_f32 v234, v236, v237
v_cvt_pk_bf16_f32 v235, v238, v239
M a[20:23], a[140:143], a[188:191], a[20:23]
buffer_load_dwordx4 v4, s[8:11], s23 offen offset:2048 lds
v_pk_mul_f32 v[240:241], v[240:241], s[4:5]
v_pk_mul_f32 v[242:243], v[242:243], s[4:5]
v_pk_mul_f32 v[244:245], v[244:245], s[4:5]
M a[20:23], a[136:139], a[184:187], a[20:23]
v_pk_mul_f32 v[246:247], v[246:247], s[4:5]
v_cvt_pk_bf16_f32 v240, v240, v241
M a[24:27], a[144:147], a[184:187], a[24:27]
s_add_u32 s94, s92, 12288
buffer_store_dwordx4 v[136:139], v1, s[16:19], s94 offen offset:1024 sc1
v_cvt_pk_bf16_f32 v241, v242, v243
v_cvt_pk_bf16_f32 v242, v244, v245
M a[24:27], a[148:151], a[188:191], a[24:27]
v_cvt_pk_bf16_f32 v243, v246, v247
v_pk_mul_f32 v[248:249], v[248:249], s[4:5]
v_pk_mul_f32 v[250:251], v[250:251], s[4:5]
M a[28:31], a[156:159], a[188:191], a[28:31]
v_pk_mul_f32 v[252:253], v[252:253], s[4:5]
v_pk_mul_f32 v[254:255], v[254:255], s[4:5]
M a[28:31], a[152:155], a[184:187], a[28:31]
v_cvt_pk_bf16_f32 v248, v248, v249
v_cvt_pk_bf16_f32 v249, v250, v251
v_cvt_pk_bf16_f32 v250, v252, v253
v_cvt_pk_bf16_f32 v251, v254, v255
v_accvgpr_read_b32 v24, a0
v_accvgpr_read_b32 v25, a1
v_accvgpr_read_b32 v26, a2
v_accvgpr_read_b32 v27, a3
v_accvgpr_read_b32 v28, a4
v_accvgpr_read_b32 v29, a5
v_accvgpr_read_b32 v30, a6
v_accvgpr_read_b32 v31, a7
v_pk_mul_f32 v[24:25], v[24:25], s[4:5]
v_pk_mul_f32 v[26:27], v[26:27], s[4:5]
v_pk_mul_f32 v[28:29], v[28:29], s[4:5]
v_pk_mul_f32 v[30:31], v[30:31], s[4:5]
v_cvt_pk_bf16_f32 v36, v24, v25
v_cvt_pk_bf16_f32 v37, v26, v27
v_cvt_pk_bf16_f32 v38, v28, v29
v_cvt_pk_bf16_f32 v39, v30, v31
v_accvgpr_read_b32 v24, a8
v_accvgpr_read_b32 v25, a9
v_accvgpr_read_b32 v26, a10
v_accvgpr_read_b32 v27, a11
v_accvgpr_read_b32 v28, a12
v_accvgpr_read_b32 v29, a13
v_accvgpr_read_b32 v30, a14
v_accvgpr_read_b32 v31, a15
v_pk_mul_f32 v[24:25], v[24:25], s[4:5]
v_pk_mul_f32 v[26:27], v[26:27], s[4:5]
v_pk_mul_f32 v[28:29], v[28:29], s[4:5]
v_pk_mul_f32 v[30:31], v[30:31], s[4:5]
v_cvt_pk_bf16_f32 v44, v24, v25
v_cvt_pk_bf16_f32 v45, v26, v27
v_cvt_pk_bf16_f32 v46, v28, v29
v_cvt_pk_bf16_f32 v47, v30, v31
v_accvgpr_read_b32 v24, a16
v_accvgpr_read_b32 v25, a17
v_accvgpr_read_b32 v26, a18
v_accvgpr_read_b32 v27, a19
v_accvgpr_read_b32 v28, a20
v_accvgpr_read_b32 v29, a21
v_accvgpr_read_b32 v30, a22
v_accvgpr_read_b32 v31, a23
v_pk_mul_f32 v[24:25], v[24:25], s[4:5]
v_pk_mul_f32 v[26:27], v[26:27], s[4:5]
v_pk_mul_f32 v[28:29], v[28:29], s[4:5]
v_pk_mul_f32 v[30:31], v[30:31], s[4:5]
v_cvt_pk_bf16_f32 v52, v24, v25
v_cvt_pk_bf16_f32 v53, v26, v27
v_cvt_pk_bf16_f32 v54, v28, v29
v_cvt_pk_bf16_f32 v55, v30, v31
v_accvgpr_read_b32 v24, a24
v_accvgpr_read_b32 v25, a25
v_accvgpr_read_b32 v26, a26
v_accvgpr_read_b32 v27, a27
v_accvgpr_read_b32 v28, a28
v_accvgpr_read_b32 v29, a29
v_accvgpr_read_b32 v30, a30
v_accvgpr_read_b32 v31, a31
v_pk_mul_f32 v[24:25], v[24:25], s[4:5]
v_pk_mul_f32 v[26:27], v[26:27], s[4:5]
v_pk_mul_f32 v[28:29], v[28:29], s[4:5]
v_pk_mul_f32 v[30:31], v[30:31], s[4:5]
v_cvt_pk_bf16_f32 v60, v24, v25
v_cvt_pk_bf16_f32 v61, v26, v27
v_cvt_pk_bf16_f32 v62, v28, v29
v_cvt_pk_bf16_f32 v63, v30, v31
s_branch Lk1_b
Lk1_spin:
s_add_u32 s40, s40, 1
s_cmp_gt_u32 s40, 1048576
s_cbranch_scc1 Lk1_got
s_sleep 2
buffer_load_dword v126, v119, s[36:39], 0 offen offset:128 sc1
s_waitcnt vmcnt(0)
v_cmp_gt_u32 vcc, 0x80, v126
s_nop 0
s_cbranch_vccnz Lk1_spin
s_branch Lk1_got
Lk1_spinq:
s_add_u32 s40, s40, 1
s_cmp_gt_u32 s40, 1048576
s_cbranch_scc1 Lk1_gotq
s_sleep 2
buffer_load_dword v125, v119, s[36:39], 0 offen offset:0 sc1
s_waitcnt vmcnt(0)
v_cmp_gt_u32 vcc, 0x80, v125
s_nop 0
s_cbranch_vccnz Lk1_spinq
s_branch Lk1_gotq
Lk1_kv:
s_mov_b64 s[60:61], s[40:41]
s_mov_b32 s62, 4194304
s_and_b32 s3, s2, 127
s_lshl_b32 s3, s3, 2
s_add_u32 s3, s3, s20
s_mul_i32 s54, s3, 1024
M v[32:35], a[32:35], a[160:163], 0
s_add_u32 m0, s29, 32768
s_nop 0
buffer_load_dwordx4 v2, s[8:11], s23 offen offset:0 lds
M v[32:35], a[36:39], a[164:167], v[32:35]
ds_read_b128 a[176:179], v10 offset:4096
ds_read_b128 a[180:183], v11 offset:4096
M v[36:39], a[44:47], a[164:167], 0
M v[36:39], a[40:43], a[160:163], v[36:39]
ds_read_b64_tr_b16 a[96:97], v12 offset:32768
ds_read_b64_tr_b16 a[98:99], v12 offset:34816
M v[40:43], a[48:51], a[160:163], 0
M v[40:43], a[52:55], a[164:167], v[40:43]
buffer_load_dwordx4 v3, s[8:11], s23 offen offset:1024 lds
M v[44:47], a[60:63], a[164:167], 0
M v[44:47], a[56:59], a[160:163], v[44:47]
ds_read_b64_tr_b16 a[104:105], v13 offset:32768
ds_read_b64_tr_b16 a[106:107], v13 offset:34816
M v[48:51], a[64:67], a[160:163], 0
M v[48:51], a[68:71], a[164:167], v[48:51]
buffer_load_dwordx4 v4, s[8:11], s23 offen offset:2048 lds
M v[52:55], a[76:79], a[164:167], 0
M v[52:55], a[72:75], a[160:163], v[52:55]
ds_read_b64_tr_b16 a[112:113], v14 offset:32768
ds_read_b64_tr_b16 a[114:115], v14 offset:34816
M v[56:59], a[80:83], a[160:163], 0
M v[56:59], a[84:87], a[164:167], v[56:59]
buffer_load_dwordx4 v5, s[8:11], s23 offen offset:3072 lds
M v[60:63], a[92:95], a[164:167], 0
M v[60:63], a[88:91], a[160:163], v[60:63]
ds_read_b64_tr_b16 a[120:121], v15 offset:32768
ds_read_b64_tr_b16 a[122:123], v15 offset:34816
M v[64:67], a[32:35], a[168:171], 0
M v[64:67], a[36:39], a[172:175], v[64:67]
ds_read_b128 a[184:187], v10 offset:6144
ds_read_b128 a[188:191], v11 offset:6144
M v[68:71], a[44:47], a[172:175], 0
s_add_u32 m0, s29, 65536
s_nop 0
buffer_load_dwordx4 v6, s[12:15], s24 offen offset:0 lds
M v[68:71], a[40:43], a[168:171], v[68:71]
ds_read_b64_tr_b16 a[128:129], v16 offset:32768
ds_read_b64_tr_b16 a[130:131], v16 offset:34816
M v[72:75], a[48:51], a[168:171], 0
M v[72:75], a[52:55], a[172:175], v[72:75]
M v[76:79], a[60:63], a[172:175], 0
buffer_load_dwordx4 v7, s[12:15], s24 offen offset:1024 lds
M v[76:79], a[56:59], a[168:171], v[76:79]
ds_read_b64_tr_b16 a[136:137], v17 offset:32768
ds_read_b64_tr_b16 a[138:139], v17 offset:34816
M v[80:83], a[64:67], a[168:171], 0
M v[80:83], a[68:71], a[172:175], v[80:83]
M v[84:87], a[76:79], a[172:175], 0
buffer_load_dwordx4 v8, s[12:15], s24 offen offset:2048 lds
M v[84:87], a[72:75], a[168:171], v[84:87]
ds_read_b64_tr_b16 a[144:145], v18 offset:32768
ds_read_b64_tr_b16 a[146:147], v18 offset:34816
M v[88:91], a[80:83], a[168:171], 0
M v[88:91], a[84:87], a[172:175], v[88:91]
M v[92:95], a[92:95], a[172:175], 0
buffer_load_dwordx4 v9, s[12:15], s24 offen offset:3072 lds
M v[92:95], a[88:91], a[168:171], v[92:95]
s_waitcnt lgkmcnt(15)
ds_read_b64_tr_b16 a[152:153], v19 offset:32768
ds_read_b64_tr_b16 a[154:155], v19 offset:34816
M v[96:99], a[32:35], a[176:179], 0
M v[96:99], a[36:39], a[180:183], v[96:99]
M v[100:103], a[44:47], a[180:183], 0
s_add_u32 s24, s24, 262144
M v[100:103], a[40:43], a[176:179], v[100:103]
M v[104:107], a[48:51], a[176:179], 0
M v[104:107], a[52:55], a[180:183], v[104:107]
M v[108:111], a[60:63], a[180:183], 0
M v[108:111], a[56:59], a[176:179], v[108:111]
s_waitcnt vmcnt(9) lgkmcnt(0)
s_barrier
ds_read_b128 a[160:163], v10 offset:16384
ds_read_b128 a[164:167], v11 offset:16384
M v[112:115], a[64:67], a[176:179], 0
s_add_u32 m0, s29, 49152
s_add_u32 s3, s23, s31
buffer_load_dwordx4 v2, s[8:11], s3 offen offset:0 lds
M v[112:115], a[68:71], a[180:183], v[112:115]
M v[116:119], a[76:79], a[180:183], 0
M v[116:119], a[72:75], a[176:179], v[116:119]
ds_read_b64_tr_b16 a[100:101], v12 offset:49152
ds_read_b64_tr_b16 a[102:103], v12 offset:51200
M v[120:123], a[80:83], a[176:179], 0
M v[120:123], a[84:87], a[180:183], v[120:123]
buffer_load_dwordx4 v3, s[8:11], s3 offen offset:1024 lds
M v[124:127], a[92:95], a[180:183], 0
M v[124:127], a[88:91], a[176:179], v[124:127]
M v[128:131], a[32:35], a[184:187], 0
M v[128:131], a[36:39], a[188:191], v[128:131]
ds_read_b128 a[168:171], v10 offset:18432
ds_read_b128 a[172:175], v11 offset:18432
ds_read_b64_tr_b16 a[108:109], v13 offset:49152
ds_read_b64_tr_b16 a[110:111], v13 offset:51200
M v[132:135], a[44:47], a[188:191], 0
M v[132:135], a[40:43], a[184:187], v[132:135]
M v[136:139], a[48:51], a[184:187], 0
buffer_load_dwordx4 v4, s[8:11], s3 offen offset:2048 lds
M v[136:139], a[52:55], a[188:191], v[136:139]
M v[140:143], a[60:63], a[188:191], 0
M v[140:143], a[56:59], a[184:187], v[140:143]
ds_read_b64_tr_b16 a[116:117], v14 offset:49152
ds_read_b64_tr_b16 a[118:119], v14 offset:51200
M v[144:147], a[64:67], a[184:187], 0
M v[144:147], a[68:71], a[188:191], v[144:147]
M v[148:151], a[76:79], a[188:191], 0
buffer_load_dwordx4 v5, s[8:11], s3 offen offset:3072 lds
M v[148:151], a[72:75], a[184:187], v[148:151]
M v[152:155], a[80:83], a[184:187], 0
M v[152:155], a[84:87], a[188:191], v[152:155]
ds_read_b64_tr_b16 a[124:125], v15 offset:49152
ds_read_b64_tr_b16 a[126:127], v15 offset:51200
M v[156:159], a[92:95], a[188:191], 0
M v[156:159], a[88:91], a[184:187], v[156:159]
s_waitcnt lgkmcnt(10)
M v[160:163], a[32:35], a[160:163], 0
M v[160:163], a[36:39], a[164:167], v[160:163]
ds_read_b128 a[176:179], v10 offset:20480
ds_read_b128 a[180:183], v11 offset:20480
M v[164:167], a[44:47], a[164:167], 0
s_add_u32 s23, s23, 128
s_cmp_eq_u32 s23, s25
s_cselect_b32 s23, s26, s23
M v[164:167], a[40:43], a[160:163], v[164:167]
ds_read_b64_tr_b16 a[132:133], v16 offset:49152
ds_read_b64_tr_b16 a[134:135], v16 offset:51200
M v[168:171], a[48:51], a[160:163], 0
M v[168:171], a[52:55], a[164:167], v[168:171]
M v[172:175], a[60:63], a[164:167], 0
M v[172:175], a[56:59], a[160:163], v[172:175]
M v[176:179], a[64:67], a[160:163], 0
s_add_u32 m0, s29, 81920
s_nop 0
buffer_load_dwordx4 v6, s[12:15], s24 offen offset:0 lds
M v[176:179], a[68:71], a[164:167], v[176:179]
ds_read_b64_tr_b16 a[140:141], v17 offset:49152
ds_read_b64_tr_b16 a[142:143], v17 offset:51200
M v[180:183], a[76:79], a[164:167], 0
M v[180:183], a[72:75], a[160:163], v[180:183]
M v[184:187], a[80:83], a[160:163], 0
M v[184:187], a[84:87], a[164:167], v[184:187]
buffer_load_dwordx4 v7, s[12:15], s24 offen offset:1024 lds
M v[188:191], a[92:95], a[164:167], 0
M v[188:191], a[88:91], a[160:163], v[188:191]
s_waitcnt lgkmcnt(12)
ds_read_b64_tr_b16 a[148:149], v18 offset:49152
ds_read_b64_tr_b16 a[150:151], v18 offset:51200
M v[192:195], a[32:35], a[168:171], 0
M v[192:195], a[36:39], a[172:175], v[192:195]
ds_read_b128 a[184:187], v10 offset:22528
ds_read_b128 a[188:191], v11 offset:22528
M v[196:199], a[44:47], a[172:175], 0
M v[196:199], a[40:43], a[168:171], v[196:199]
M v[200:203], a[48:51], a[168:171], 0
buffer_load_dwordx4 v8, s[12:15], s24 offen offset:2048 lds
M v[200:203], a[52:55], a[172:175], v[200:203]
ds_read_b64_tr_b16 a[156:157], v19 offset:49152
ds_read_b64_tr_b16 a[158:159], v19 offset:51200
M v[204:207], a[60:63], a[172:175], 0
M v[204:207], a[56:59], a[168:171], v[204:207]
M v[208:211], a[64:67], a[168:171], 0
M v[208:211], a[68:71], a[172:175], v[208:211]
M v[212:215], a[76:79], a[172:175], 0
buffer_load_dwordx4 v9, s[12:15], s24 offen offset:3072 lds
M v[212:215], a[72:75], a[168:171], v[212:215]
M v[216:219], a[80:83], a[168:171], 0
M v[216:219], a[84:87], a[172:175], v[216:219]
M v[220:223], a[92:95], a[172:175], 0
M v[220:223], a[88:91], a[168:171], v[220:223]
s_waitcnt lgkmcnt(10)
M v[224:227], a[32:35], a[176:179], 0
s_add_u32 s24, s24, 262144
s_cmp_eq_u32 s24, s27
s_cselect_b32 s24, s28, s24
s_sub_u32 s6, s6, 1
s_cmp_eq_u32 s6, 0
s_cselect_b64 s[12:13], s[64:65], s[12:13]
M v[224:227], a[36:39], a[180:183], v[224:227]
M v[228:231], a[44:47], a[180:183], 0
M v[228:231], a[40:43], a[176:179], v[228:231]
M v[232:235], a[48:51], a[176:179], 0
M v[232:235], a[52:55], a[180:183], v[232:235]
M v[236:239], a[60:63], a[180:183], 0
M v[236:239], a[56:59], a[176:179], v[236:239]
s_waitcnt vmcnt(8) lgkmcnt(0)
s_barrier
ds_read_b128 a[160:163], v10 offset:32768
ds_read_b128 a[164:167], v11 offset:32768
M v[240:243], a[64:67], a[176:179], 0
s_add_u32 m0, s29, 0
s_nop 0
buffer_load_dwordx4 v2, s[8:11], s23 offen offset:0 lds
M v[240:243], a[68:71], a[180:183], v[240:243]
M v[244:247], a[76:79], a[180:183], 0
M v[244:247], a[72:75], a[176:179], v[244:247]
M v[248:251], a[80:83], a[176:179], 0
M v[248:251], a[84:87], a[180:183], v[248:251]
buffer_load_dwordx4 v3, s[8:11], s23 offen offset:1024 lds
M v[252:255], a[92:95], a[180:183], 0
M v[252:255], a[88:91], a[176:179], v[252:255]
M a[0:3], a[32:35], a[184:187], 0
M a[0:3], a[36:39], a[188:191], a[0:3]
ds_read_b128 a[168:171], v10 offset:34816
ds_read_b128 a[172:175], v11 offset:34816
M a[4:7], a[44:47], a[188:191], 0
M a[4:7], a[40:43], a[184:187], a[4:7]
M a[8:11], a[48:51], a[184:187], 0
buffer_load_dwordx4 v4, s[8:11], s23 offen offset:2048 lds
M a[8:11], a[52:55], a[188:191], a[8:11]
M a[12:15], a[60:63], a[188:191], 0
M a[12:15], a[56:59], a[184:187], a[12:15]
M a[16:19], a[64:67], a[184:187], 0
M a[16:19], a[68:71], a[188:191], a[16:19]
buffer_load_dwordx4 v5, s[8:11], s23 offen offset:3072 lds
M a[20:23], a[76:79], a[188:191], 0
M a[20:23], a[72:75], a[184:187], a[20:23]
M a[24:27], a[80:83], a[184:187], 0
M a[24:27], a[84:87], a[188:191], a[24:27]
M a[28:31], a[92:95], a[188:191], 0
M a[28:31], a[88:91], a[184:187], a[28:31]
s_waitcnt lgkmcnt(2)
M v[32:35], a[96:99], a[160:163], v[32:35]
s_add_u32 m0, s29, 98304
s_nop 0
buffer_load_dwordx4 v6, s[12:15], s24 offen offset:0 lds
M v[32:35], a[100:103], a[164:167], v[32:35]
ds_read_b128 a[176:179], v10 offset:36864
ds_read_b128 a[180:183], v11 offset:36864
M v[36:39], a[108:111], a[164:167], v[36:39]
M v[36:39], a[104:107], a[160:163], v[36:39]
ds_read_b64_tr_b16 a[32:33], v12 offset:0
ds_read_b64_tr_b16 a[34:35], v12 offset:2048
M v[40:43], a[112:115], a[160:163], v[40:43]
M v[40:43], a[116:119], a[164:167], v[40:43]
M v[44:47], a[124:127], a[164:167], v[44:47]
M v[44:47], a[120:123], a[160:163], v[44:47]
ds_read_b64_tr_b16 a[40:41], v13 offset:0
ds_read_b64_tr_b16 a[42:43], v13 offset:2048
M v[48:51], a[128:131], a[160:163], v[48:51]
buffer_load_dwordx4 v7, s[12:15], s24 offen offset:1024 lds
M v[48:51], a[132:135], a[164:167], v[48:51]
M v[52:55], a[140:143], a[164:167], v[52:55]
M v[52:55], a[136:139], a[160:163], v[52:55]
ds_read_b64_tr_b16 a[48:49], v14 offset:0
ds_read_b64_tr_b16 a[50:51], v14 offset:2048
M v[56:59], a[144:147], a[160:163], v[56:59]
M v[56:59], a[148:151], a[164:167], v[56:59]
M v[60:63], a[156:159], a[164:167], v[60:63]
buffer_load_dwordx4 v8, s[12:15], s24 offen offset:2048 lds
M v[60:63], a[152:155], a[160:163], v[60:63]
s_waitcnt lgkmcnt(8)
ds_read_b64_tr_b16 a[56:57], v15 offset:0
ds_read_b64_tr_b16 a[58:59], v15 offset:2048
M v[64:67], a[96:99], a[168:171], v[64:67]
M v[64:67], a[100:103], a[172:175], v[64:67]
ds_read_b128 a[184:187], v10 offset:38912
ds_read_b128 a[188:191], v11 offset:38912
M v[68:71], a[108:111], a[172:175], v[68:71]
M v[68:71], a[104:107], a[168:171], v[68:71]
ds_read_b64_tr_b16 a[64:65], v16 offset:0
ds_read_b64_tr_b16 a[66:67], v16 offset:2048
M v[72:75], a[112:115], a[168:171], v[72:75]
M v[72:75], a[116:119], a[172:175], v[72:75]
M v[76:79], a[124:127], a[172:175], v[76:79]
M v[76:79], a[120:123], a[168:171], v[76:79]
ds_read_b64_tr_b16 a[72:73], v17 offset:0
ds_read_b64_tr_b16 a[74:75], v17 offset:2048
M v[80:83], a[128:131], a[168:171], v[80:83]
buffer_load_dwordx4 v9, s[12:15], s24 offen offset:3072 lds
M v[80:83], a[132:135], a[172:175], v[80:83]
M v[84:87], a[140:143], a[172:175], v[84:87]
M v[84:87], a[136:139], a[168:171], v[84:87]
ds_read_b64_tr_b16 a[80:81], v18 offset:0
ds_read_b64_tr_b16 a[82:83], v18 offset:2048
M v[88:91], a[144:147], a[168:171], v[88:91]
M v[88:91], a[148:151], a[172:175], v[88:91]
M v[92:95], a[156:159], a[172:175], v[92:95]
s_add_u32 s24, s24, 262144
M v[92:95], a[152:155], a[168:171], v[92:95]
s_waitcnt lgkmcnt(15)
ds_read_b64_tr_b16 a[88:89], v19 offset:0
ds_read_b64_tr_b16 a[90:91], v19 offset:2048
M v[96:99], a[96:99], a[176:179], v[96:99]
M v[96:99], a[100:103], a[180:183], v[96:99]
M v[100:103], a[108:111], a[180:183], v[100:103]
M v[100:103], a[104:107], a[176:179], v[100:103]
M v[104:107], a[112:115], a[176:179], v[104:107]
M v[104:107], a[116:119], a[180:183], v[104:107]
M v[108:111], a[124:127], a[180:183], v[108:111]
M v[108:111], a[120:123], a[176:179], v[108:111]
s_waitcnt vmcnt(8) lgkmcnt(0)
s_barrier
ds_read_b128 a[160:163], v10 offset:49152
ds_read_b128 a[164:167], v11 offset:49152
M v[112:115], a[128:131], a[176:179], v[112:115]
s_add_u32 m0, s29, 16384
s_add_u32 s3, s23, s31
buffer_load_dwordx4 v2, s[8:11], s3 offen offset:0 lds
M v[112:115], a[132:135], a[180:183], v[112:115]
M v[116:119], a[140:143], a[180:183], v[116:119]
M v[116:119], a[136:139], a[176:179], v[116:119]
ds_read_b64_tr_b16 a[36:37], v12 offset:16384
ds_read_b64_tr_b16 a[38:39], v12 offset:18432
M v[120:123], a[144:147], a[176:179], v[120:123]
M v[120:123], a[148:151], a[180:183], v[120:123]
buffer_load_dwordx4 v3, s[8:11], s3 offen offset:1024 lds
M v[124:127], a[156:159], a[180:183], v[124:127]
M v[124:127], a[152:155], a[176:179], v[124:127]
M v[128:131], a[96:99], a[184:187], v[128:131]
M v[128:131], a[100:103], a[188:191], v[128:131]
ds_read_b128 a[168:171], v10 offset:51200
ds_read_b128 a[172:175], v11 offset:51200
ds_read_b64_tr_b16 a[44:45], v13 offset:16384
ds_read_b64_tr_b16 a[46:47], v13 offset:18432
M v[132:135], a[108:111], a[188:191], v[132:135]
M v[132:135], a[104:107], a[184:187], v[132:135]
buffer_load_dwordx4 v4, s[8:11], s3 offen offset:2048 lds
M v[136:139], a[112:115], a[184:187], v[136:139]
M v[136:139], a[116:119], a[188:191], v[136:139]
M v[140:143], a[124:127], a[188:191], v[140:143]
M v[140:143], a[120:123], a[184:187], v[140:143]
ds_read_b64_tr_b16 a[52:53], v14 offset:16384
ds_read_b64_tr_b16 a[54:55], v14 offset:18432
M v[144:147], a[128:131], a[184:187], v[144:147]
M v[144:147], a[132:135], a[188:191], v[144:147]
buffer_load_dwordx4 v5, s[8:11], s3 offen offset:3072 lds
M v[148:151], a[140:143], a[188:191], v[148:151]
M v[148:151], a[136:139], a[184:187], v[148:151]
M v[152:155], a[144:147], a[184:187], v[152:155]
buffer_store_dwordx4 v[28:31], v23, s[16:19], s56 offen sc1
M v[152:155], a[148:151], a[188:191], v[152:155]
ds_read_b64_tr_b16 a[60:61], v15 offset:16384
ds_read_b64_tr_b16 a[62:63], v15 offset:18432
M v[156:159], a[156:159], a[188:191], v[156:159]
M v[156:159], a[152:155], a[184:187], v[156:159]
s_waitcnt lgkmcnt(10)
M v[160:163], a[96:99], a[160:163], v[160:163]
s_add_u32 s23, s23, 128
s_cmp_eq_u32 s23, s25
s_cselect_b32 s23, s26, s23
M v[160:163], a[100:103], a[164:167], v[160:163]
ds_read_b128 a[176:179], v10 offset:53248
ds_read_b128 a[180:183], v11 offset:53248
M v[164:167], a[108:111], a[164:167], v[164:167]
M v[164:167], a[104:107], a[160:163], v[164:167]
ds_read_b64_tr_b16 a[68:69], v16 offset:16384
ds_read_b64_tr_b16 a[70:71], v16 offset:18432
M v[168:171], a[112:115], a[160:163], v[168:171]
M v[168:171], a[116:119], a[164:167], v[168:171]
M v[172:175], a[124:127], a[164:167], v[172:175]
M v[172:175], a[120:123], a[160:163], v[172:175]
s_add_u32 m0, s29, 114688
s_nop 0
buffer_load_dwordx4 v6, s[12:15], s24 offen offset:0 lds
M v[176:179], a[128:131], a[160:163], v[176:179]
buffer_store_dwordx4 v[28:31], v23, s[16:19], s57 offen sc1
M v[176:179], a[132:135], a[164:167], v[176:179]
ds_read_b64_tr_b16 a[76:77], v17 offset:16384
ds_read_b64_tr_b16 a[78:79], v17 offset:18432
M v[180:183], a[140:143], a[164:167], v[180:183]
M v[180:183], a[136:139], a[160:163], v[180:183]
M v[184:187], a[144:147], a[160:163], v[184:187]
M v[184:187], a[148:151], a[164:167], v[184:187]
buffer_load_dwordx4 v7, s[12:15], s24 offen offset:1024 lds
M v[188:191], a[156:159], a[164:167], v[188:191]
M v[188:191], a[152:155], a[160:163], v[188:191]
s_waitcnt lgkmcnt(12)
ds_read_b64_tr_b16 a[84:85], v18 offset:16384
ds_read_b64_tr_b16 a[86:87], v18 offset:18432
M v[192:195], a[96:99], a[168:171], v[192:195]
M v[192:195], a[100:103], a[172:175], v[192:195]
ds_read_b128 a[184:187], v10 offset:55296
ds_read_b128 a[188:191], v11 offset:55296
M v[196:199], a[108:111], a[172:175], v[196:199]
M v[196:199], a[104:107], a[168:171], v[196:199]
buffer_load_dwordx4 v8, s[12:15], s24 offen offset:2048 lds
M v[200:203], a[112:115], a[168:171], v[200:203]
buffer_store_dwordx4 v[28:31], v23, s[16:19], s58 offen sc1
M v[200:203], a[116:119], a[172:175], v[200:203]
ds_read_b64_tr_b16 a[92:93], v19 offset:16384
ds_read_b64_tr_b16 a[94:95], v19 offset:18432
M v[204:207], a[124:127], a[172:175], v[204:207]
M v[204:207], a[120:123], a[168:171], v[204:207]
M v[208:211], a[128:131], a[168:171], v[208:211]
M v[208:211], a[132:135], a[172:175], v[208:211]
M v[212:215], a[140:143], a[172:175], v[212:215]
buffer_load_dwordx4 v9, s[12:15], s24 offen offset:3072 lds
M v[212:215], a[136:139], a[168:171], v[212:215]
M v[216:219], a[144:147], a[168:171], v[216:219]
M v[216:219], a[148:151], a[172:175], v[216:219]
M v[220:223], a[156:159], a[172:175], v[220:223]
s_add_u32 s24, s24, 262144
s_cmp_eq_u32 s24, s27
s_cselect_b32 s24, s28, s24
s_sub_u32 s6, s6, 1
s_cmp_eq_u32 s6, 0
s_cselect_b64 s[12:13], s[64:65], s[12:13]
M v[220:223], a[152:155], a[168:171], v[220:223]
s_waitcnt lgkmcnt(10)
M v[224:227], a[96:99], a[176:179], v[224:227]
buffer_store_dwordx4 v[28:31], v23, s[16:19], s59 offen sc1
M v[224:227], a[100:103], a[180:183], v[224:227]
M v[228:231], a[108:111], a[180:183], v[228:231]
M v[228:231], a[104:107], a[176:179], v[228:231]
M v[232:235], a[112:115], a[176:179], v[232:235]
M v[232:235], a[116:119], a[180:183], v[232:235]
M v[236:239], a[124:127], a[180:183], v[236:239]
M v[236:239], a[120:123], a[176:179], v[236:239]
s_waitcnt vmcnt(12) lgkmcnt(0)
s_barrier
ds_read_b128 a[160:163], v10 offset:0
ds_read_b128 a[164:167], v11 offset:0
M v[240:243], a[128:131], a[176:179], v[240:243]
s_add_u32 m0, s29, 32768
s_nop 0
buffer_load_dwordx4 v2, s[8:11], s23 offen offset:0 lds
M v[240:243], a[132:135], a[180:183], v[240:243]
M v[244:247], a[140:143], a[180:183], v[244:247]
M v[244:247], a[136:139], a[176:179], v[244:247]
M v[248:251], a[144:147], a[176:179], v[248:251]
M v[248:251], a[148:151], a[180:183], v[248:251]
buffer_load_dwordx4 v3, s[8:11], s23 offen offset:1024 lds
M v[252:255], a[156:159], a[180:183], v[252:255]
M v[252:255], a[152:155], a[176:179], v[252:255]
M a[0:3], a[96:99], a[184:187], a[0:3]
M a[0:3], a[100:103], a[188:191], a[0:3]
ds_read_b128 a[168:171], v10 offset:2048
ds_read_b128 a[172:175], v11 offset:2048
M a[4:7], a[108:111], a[188:191], a[4:7]
M a[4:7], a[104:107], a[184:187], a[4:7]
M a[8:11], a[112:115], a[184:187], a[8:11]
buffer_load_dwordx4 v4, s[8:11], s23 offen offset:2048 lds
M a[8:11], a[116:119], a[188:191], a[8:11]
M a[12:15], a[124:127], a[188:191], a[12:15]
M a[12:15], a[120:123], a[184:187], a[12:15]
M a[16:19], a[128:131], a[184:187], a[16:19]
M a[16:19], a[132:135], a[188:191], a[16:19]
buffer_load_dwordx4 v5, s[8:11], s23 offen offset:3072 lds
M a[20:23], a[140:143], a[188:191], a[20:23]
M a[20:23], a[136:139], a[184:187], a[20:23]
M a[24:27], a[144:147], a[184:187], a[24:27]
M a[24:27], a[148:151], a[188:191], a[24:27]
M a[28:31], a[156:159], a[188:191], a[28:31]
M a[28:31], a[152:155], a[184:187], a[28:31]
s_waitcnt lgkmcnt(2)
s_mov_b32 s30, 2
Lk1_kl:
M v[32:35], a[32:35], a[160:163], v[32:35]
s_add_u32 m0, s29, 65536
s_nop 0
buffer_load_dwordx4 v6, s[12:15], s24 offen offset:0 lds
M v[32:35], a[36:39], a[164:167], v[32:35]
ds_read_b128 a[176:179], v10 offset:4096
ds_read_b128 a[180:183], v11 offset:4096
M v[36:39], a[44:47], a[164:167], v[36:39]
M v[36:39], a[40:43], a[160:163], v[36:39]
ds_read_b64_tr_b16 a[96:97], v12 offset:32768
ds_read_b64_tr_b16 a[98:99], v12 offset:34816
M v[40:43], a[48:51], a[160:163], v[40:43]
M v[40:43], a[52:55], a[164:167], v[40:43]
M v[44:47], a[60:63], a[164:167], v[44:47]
M v[44:47], a[56:59], a[160:163], v[44:47]
ds_read_b64_tr_b16 a[104:105], v13 offset:32768
ds_read_b64_tr_b16 a[106:107], v13 offset:34816
M v[48:51], a[64:67], a[160:163], v[48:51]
buffer_load_dwordx4 v7, s[12:15], s24 offen offset:1024 lds
M v[48:51], a[68:71], a[164:167], v[48:51]
M v[52:55], a[76:79], a[164:167], v[52:55]
M v[52:55], a[72:75], a[160:163], v[52:55]
ds_read_b64_tr_b16 a[112:113], v14 offset:32768
ds_read_b64_tr_b16 a[114:115], v14 offset:34816
M v[56:59], a[80:83], a[160:163], v[56:59]
M v[56:59], a[84:87], a[164:167], v[56:59]
M v[60:63], a[92:95], a[164:167], v[60:63]
buffer_load_dwordx4 v8, s[12:15], s24 offen offset:2048 lds
M v[60:63], a[88:91], a[160:163], v[60:63]
s_waitcnt lgkmcnt(8)
ds_read_b64_tr_b16 a[120:121], v15 offset:32768
ds_read_b64_tr_b16 a[122:123], v15 offset:34816
M v[64:67], a[32:35], a[168:171], v[64:67]
M v[64:67], a[36:39], a[172:175], v[64:67]
ds_read_b128 a[184:187], v10 offset:6144
ds_read_b128 a[188:191], v11 offset:6144
M v[68:71], a[44:47], a[172:175], v[68:71]
M v[68:71], a[40:43], a[168:171], v[68:71]
ds_read_b64_tr_b16 a[128:129], v16 offset:32768
ds_read_b64_tr_b16 a[130:131], v16 offset:34816
M v[72:75], a[48:51], a[168:171], v[72:75]
M v[72:75], a[52:55], a[172:175], v[72:75]
M v[76:79], a[60:63], a[172:175], v[76:79]
M v[76:79], a[56:59], a[168:171], v[76:79]
ds_read_b64_tr_b16 a[136:137], v17 offset:32768
ds_read_b64_tr_b16 a[138:139], v17 offset:34816
M v[80:83], a[64:67], a[168:171], v[80:83]
buffer_load_dwordx4 v9, s[12:15], s24 offen offset:3072 lds
M v[80:83], a[68:71], a[172:175], v[80:83]
M v[84:87], a[76:79], a[172:175], v[84:87]
M v[84:87], a[72:75], a[168:171], v[84:87]
ds_read_b64_tr_b16 a[144:145], v18 offset:32768
ds_read_b64_tr_b16 a[146:147], v18 offset:34816
M v[88:91], a[80:83], a[168:171], v[88:91]
M v[88:91], a[84:87], a[172:175], v[88:91]
M v[92:95], a[92:95], a[172:175], v[92:95]
s_add_u32 s24, s24, 262144
M v[92:95], a[88:91], a[168:171], v[92:95]
s_waitcnt lgkmcnt(15)
ds_read_b64_tr_b16 a[152:153], v19 offset:32768
ds_read_b64_tr_b16 a[154:155], v19 offset:34816
M v[96:99], a[32:35], a[176:179], v[96:99]
M v[96:99], a[36:39], a[180:183], v[96:99]
M v[100:103], a[44:47], a[180:183], v[100:103]
M v[100:103], a[40:43], a[176:179], v[100:103]
M v[104:107], a[48:51], a[176:179], v[104:107]
M v[104:107], a[52:55], a[180:183], v[104:107]
M v[108:111], a[60:63], a[180:183], v[108:111]
M v[108:111], a[56:59], a[176:179], v[108:111]
s_waitcnt vmcnt(8) lgkmcnt(0)
s_barrier
ds_read_b128 a[160:163], v10 offset:16384
ds_read_b128 a[164:167], v11 offset:16384
M v[112:115], a[64:67], a[176:179], v[112:115]
s_add_u32 m0, s29, 49152
s_add_u32 s3, s23, s31
buffer_load_dwordx4 v2, s[8:11], s3 offen offset:0 lds
M v[112:115], a[68:71], a[180:183], v[112:115]
M v[116:119], a[76:79], a[180:183], v[116:119]
M v[116:119], a[72:75], a[176:179], v[116:119]
ds_read_b64_tr_b16 a[100:101], v12 offset:49152
ds_read_b64_tr_b16 a[102:103], v12 offset:51200
M v[120:123], a[80:83], a[176:179], v[120:123]
M v[120:123], a[84:87], a[180:183], v[120:123]
buffer_load_dwordx4 v3, s[8:11], s3 offen offset:1024 lds
M v[124:127], a[92:95], a[180:183], v[124:127]
M v[124:127], a[88:91], a[176:179], v[124:127]
M v[128:131], a[32:35], a[184:187], v[128:131]
M v[128:131], a[36:39], a[188:191], v[128:131]
ds_read_b128 a[168:171], v10 offset:18432
ds_read_b128 a[172:175], v11 offset:18432
ds_read_b64_tr_b16 a[108:109], v13 offset:49152
ds_read_b64_tr_b16 a[110:111], v13 offset:51200
M v[132:135], a[44:47], a[188:191], v[132:135]
M v[132:135], a[40:43], a[184:187], v[132:135]
M v[136:139], a[48:51], a[184:187], v[136:139]
buffer_load_dwordx4 v4, s[8:11], s3 offen offset:2048 lds
M v[136:139], a[52:55], a[188:191], v[136:139]
M v[140:143], a[60:63], a[188:191], v[140:143]
M v[140:143], a[56:59], a[184:187], v[140:143]
ds_read_b64_tr_b16 a[116:117], v14 offset:49152
ds_read_b64_tr_b16 a[118:119], v14 offset:51200
M v[144:147], a[64:67], a[184:187], v[144:147]
M v[144:147], a[68:71], a[188:191], v[144:147]
M v[148:151], a[76:79], a[188:191], v[148:151]
buffer_load_dwordx4 v5, s[8:11], s3 offen offset:3072 lds
M v[148:151], a[72:75], a[184:187], v[148:151]
M v[152:155], a[80:83], a[184:187], v[152:155]
M v[152:155], a[84:87], a[188:191], v[152:155]
ds_read_b64_tr_b16 a[124:125], v15 offset:49152
ds_read_b64_tr_b16 a[126:127], v15 offset:51200
M v[156:159], a[92:95], a[188:191], v[156:159]
M v[156:159], a[88:91], a[184:187], v[156:159]
s_waitcnt lgkmcnt(10)
M v[160:163], a[32:35], a[160:163], v[160:163]
M v[160:163], a[36:39], a[164:167], v[160:163]
ds_read_b128 a[176:179], v10 offset:20480
ds_read_b128 a[180:183], v11 offset:20480
M v[164:167], a[44:47], a[164:167], v[164:167]
s_add_u32 s23, s23, 128
s_cmp_eq_u32 s23, s25
s_cselect_b32 s23, s26, s23
M v[164:167], a[40:43], a[160:163], v[164:167]
ds_read_b64_tr_b16 a[132:133], v16 offset:49152
ds_read_b64_tr_b16 a[134:135], v16 offset:51200
M v[168:171], a[48:51], a[160:163], v[168:171]
M v[168:171], a[52:55], a[164:167], v[168:171]
M v[172:175], a[60:63], a[164:167], v[172:175]
M v[172:175], a[56:59], a[160:163], v[172:175]
M v[176:179], a[64:67], a[160:163], v[176:179]
s_add_u32 m0, s29, 81920
s_nop 0
buffer_load_dwordx4 v6, s[12:15], s24 offen offset:0 lds
M v[176:179], a[68:71], a[164:167], v[176:179]
ds_read_b64_tr_b16 a[140:141], v17 offset:49152
ds_read_b64_tr_b16 a[142:143], v17 offset:51200
M v[180:183], a[76:79], a[164:167], v[180:183]
M v[180:183], a[72:75], a[160:163], v[180:183]
M v[184:187], a[80:83], a[160:163], v[184:187]
M v[184:187], a[84:87], a[164:167], v[184:187]
buffer_load_dwordx4 v7, s[12:15], s24 offen offset:1024 lds
M v[188:191], a[92:95], a[164:167], v[188:191]
M v[188:191], a[88:91], a[160:163], v[188:191]
s_waitcnt lgkmcnt(12)
ds_read_b64_tr_b16 a[148:149], v18 offset:49152
ds_read_b64_tr_b16 a[150:151], v18 offset:51200
M v[192:195], a[32:35], a[168:171], v[192:195]
M v[192:195], a[36:39], a[172:175], v[192:195]
ds_read_b128 a[184:187], v10 offset:22528
ds_read_b128 a[188:191], v11 offset:22528
M v[196:199], a[44:47], a[172:175], v[196:199]
M v[196:199], a[40:43], a[168:171], v[196:199]
M v[200:203], a[48:51], a[168:171], v[200:203]
buffer_load_dwordx4 v8, s[12:15], s24 offen offset:2048 lds
M v[200:203], a[52:55], a[172:175], v[200:203]
ds_read_b64_tr_b16 a[156:157], v19 offset:49152
ds_read_b64_tr_b16 a[158:159], v19 offset:51200
M v[204:207], a[60:63], a[172:175], v[204:207]
M v[204:207], a[56:59], a[168:171], v[204:207]
M v[208:211], a[64:67], a[168:171], v[208:211]
M v[208:211], a[68:71], a[172:175], v[208:211]
M v[212:215], a[76:79], a[172:175], v[212:215]
buffer_load_dwordx4 v9, s[12:15], s24 offen offset:3072 lds
M v[212:215], a[72:75], a[168:171], v[212:215]
M v[216:219], a[80:83], a[168:171], v[216:219]
M v[216:219], a[84:87], a[172:175], v[216:219]
M v[220:223], a[92:95], a[172:175], v[220:223]
M v[220:223], a[88:91], a[168:171], v[220:223]
s_waitcnt lgkmcnt(10)
M v[224:227], a[32:35], a[176:179], v[224:227]
s_add_u32 s24, s24, 262144
s_cmp_eq_u32 s24, s27
s_cselect_b32 s24, s28, s24
s_sub_u32 s6, s6, 1
s_cmp_eq_u32 s6, 0
s_cselect_b64 s[12:13], s[64:65], s[12:13]
M v[224:227], a[36:39], a[180:183], v[224:227]
M v[228:231], a[44:47], a[180:183], v[228:231]
M v[228:231], a[40:43], a[176:179], v[228:231]
M v[232:235], a[48:51], a[176:179], v[232:235]
M v[232:235], a[52:55], a[180:183], v[232:235]
M v[236:239], a[60:63], a[180:183], v[236:239]
M v[236:239], a[56:59], a[176:179], v[236:239]
s_waitcnt vmcnt(8) lgkmcnt(0)
s_barrier
ds_read_b128 a[160:163], v10 offset:32768
ds_read_b128 a[164:167], v11 offset:32768
M v[240:243], a[64:67], a[176:179], v[240:243]
s_add_u32 m0, s29, 0
s_nop 0
buffer_load_dwordx4 v2, s[8:11], s23 offen offset:0 lds
M v[240:243], a[68:71], a[180:183], v[240:243]
M v[244:247], a[76:79], a[180:183], v[244:247]
M v[244:247], a[72:75], a[176:179], v[244:247]
M v[248:251], a[80:83], a[176:179], v[248:251]
M v[248:251], a[84:87], a[180:183], v[248:251]
buffer_load_dwordx4 v3, s[8:11], s23 offen offset:1024 lds
M v[252:255], a[92:95], a[180:183], v[252:255]
M v[252:255], a[88:91], a[176:179], v[252:255]
M a[0:3], a[32:35], a[184:187], a[0:3]
M a[0:3], a[36:39], a[188:191], a[0:3]
ds_read_b128 a[168:171], v10 offset:34816
ds_read_b128 a[172:175], v11 offset:34816
M a[4:7], a[44:47], a[188:191], a[4:7]
M a[4:7], a[40:43], a[184:187], a[4:7]
M a[8:11], a[48:51], a[184:187], a[8:11]
buffer_load_dwordx4 v4, s[8:11], s23 offen offset:2048 lds
M a[8:11], a[52:55], a[188:191], a[8:11]
M a[12:15], a[60:63], a[188:191], a[12:15]
M a[12:15], a[56:59], a[184:187], a[12:15]
M a[16:19], a[64:67], a[184:187], a[16:19]
M a[16:19], a[68:71], a[188:191], a[16:19]
buffer_load_dwordx4 v5, s[8:11], s23 offen offset:3072 lds
M a[20:23], a[76:79], a[188:191], a[20:23]
M a[20:23], a[72:75], a[184:187], a[20:23]
M a[24:27], a[80:83], a[184:187], a[24:27]
M a[24:27], a[84:87], a[188:191], a[24:27]
M a[28:31], a[92:95], a[188:191], a[28:31]
M a[28:31], a[88:91], a[184:187], a[28:31]
s_waitcnt lgkmcnt(2)
M v[32:35], a[96:99], a[160:163], v[32:35]
s_add_u32 m0, s29, 98304
s_nop 0
buffer_load_dwordx4 v6, s[12:15], s24 offen offset:0 lds
M v[32:35], a[100:103], a[164:167], v[32:35]
ds_read_b128 a[176:179], v10 offset:36864
ds_read_b128 a[180:183], v11 offset:36864
M v[36:39], a[108:111], a[164:167], v[36:39]
M v[36:39], a[104:107], a[160:163], v[36:39]
ds_read_b64_tr_b16 a[32:33], v12 offset:0
ds_read_b64_tr_b16 a[34:35], v12 offset:2048
M v[40:43], a[112:115], a[160:163], v[40:43]
M v[40:43], a[116:119], a[164:167], v[40:43]
M v[44:47], a[124:127], a[164:167], v[44:47]
M v[44:47], a[120:123], a[160:163], v[44:47]
ds_read_b64_tr_b16 a[40:41], v13 offset:0
ds_read_b64_tr_b16 a[42:43], v13 offset:2048
M v[48:51], a[128:131], a[160:163], v[48:51]
buffer_load_dwordx4 v7, s[12:15], s24 offen offset:1024 lds
M v[48:51], a[132:135], a[164:167], v[48:51]
M v[52:55], a[140:143], a[164:167], v[52:55]
M v[52:55], a[136:139], a[160:163], v[52:55]
ds_read_b64_tr_b16 a[48:49], v14 offset:0
ds_read_b64_tr_b16 a[50:51], v14 offset:2048
M v[56:59], a[144:147], a[160:163], v[56:59]
M v[56:59], a[148:151], a[164:167], v[56:59]
M v[60:63], a[156:159], a[164:167], v[60:63]
buffer_load_dwordx4 v8, s[12:15], s24 offen offset:2048 lds
M v[60:63], a[152:155], a[160:163], v[60:63]
s_waitcnt lgkmcnt(8)
ds_read_b64_tr_b16 a[56:57], v15 offset:0
ds_read_b64_tr_b16 a[58:59], v15 offset:2048
M v[64:67], a[96:99], a[168:171], v[64:67]
M v[64:67], a[100:103], a[172:175], v[64:67]
ds_read_b128 a[184:187], v10 offset:38912
ds_read_b128 a[188:191], v11 offset:38912
M v[68:71], a[108:111], a[172:175], v[68:71]
M v[68:71], a[104:107], a[168:171], v[68:71]
ds_read_b64_tr_b16 a[64:65], v16 offset:0
ds_read_b64_tr_b16 a[66:67], v16 offset:2048
M v[72:75], a[112:115], a[168:171], v[72:75]
M v[72:75], a[116:119], a[172:175], v[72:75]
M v[76:79], a[124:127], a[172:175], v[76:79]
M v[76:79], a[120:123], a[168:171], v[76:79]
ds_read_b64_tr_b16 a[72:73], v17 offset:0
ds_read_b64_tr_b16 a[74:75], v17 offset:2048
M v[80:83], a[128:131], a[168:171], v[80:83]
buffer_load_dwordx4 v9, s[12:15], s24 offen offset:3072 lds
M v[80:83], a[132:135], a[172:175], v[80:83]
M v[84:87], a[140:143], a[172:175], v[84:87]
M v[84:87], a[136:139], a[168:171], v[84:87]
ds_read_b64_tr_b16 a[80:81], v18 offset:0
ds_read_b64_tr_b16 a[82:83], v18 offset:2048
M v[88:91], a[144:147], a[168:171], v[88:91]
M v[88:91], a[148:151], a[172:175], v[88:91]
M v[92:95], a[156:159], a[172:175], v[92:95]
s_add_u32 s24, s24, 262144
M v[92:95], a[152:155], a[168:171], v[92:95]
s_waitcnt lgkmcnt(15)
ds_read_b64_tr_b16 a[88:89], v19 offset:0
ds_read_b64_tr_b16 a[90:91], v19 offset:2048
M v[96:99], a[96:99], a[176:179], v[96:99]
M v[96:99], a[100:103], a[180:183], v[96:99]
M v[100:103], a[108:111], a[180:183], v[100:103]
M v[100:103], a[104:107], a[176:179], v[100:103]
M v[104:107], a[112:115], a[176:179], v[104:107]
M v[104:107], a[116:119], a[180:183], v[104:107]
M v[108:111], a[124:127], a[180:183], v[108:111]
M v[108:111], a[120:123], a[176:179], v[108:111]
s_waitcnt vmcnt(8) lgkmcnt(0)
s_barrier
ds_read_b128 a[160:163], v10 offset:49152
ds_read_b128 a[164:167], v11 offset:49152
M v[112:115], a[128:131], a[176:179], v[112:115]
s_add_u32 m0, s29, 16384
s_add_u32 s3, s23, s31
buffer_load_dwordx4 v2, s[8:11], s3 offen offset:0 lds
M v[112:115], a[132:135], a[180:183], v[112:115]
M v[116:119], a[140:143], a[180:183], v[116:119]
M v[116:119], a[136:139], a[176:179], v[116:119]
ds_read_b64_tr_b16 a[36:37], v12 offset:16384
ds_read_b64_tr_b16 a[38:39], v12 offset:18432
M v[120:123], a[144:147], a[176:179], v[120:123]
M v[120:123], a[148:151], a[180:183], v[120:123]
buffer_load_dwordx4 v3, s[8:11], s3 offen offset:1024 lds
M v[124:127], a[156:159], a[180:183], v[124:127]
M v[124:127], a[152:155], a[176:179], v[124:127]
M v[128:131], a[96:99], a[184:187], v[128:131]
M v[128:131], a[100:103], a[188:191], v[128:131]
ds_read_b128 a[168:171], v10 offset:51200
ds_read_b128 a[172:175], v11 offset:51200
ds_read_b64_tr_b16 a[44:45], v13 offset:16384
ds_read_b64_tr_b16 a[46:47], v13 offset:18432
M v[132:135], a[108:111], a[188:191], v[132:135]
M v[132:135], a[104:107], a[184:187], v[132:135]
M v[136:139], a[112:115], a[184:187], v[136:139]
buffer_load_dwordx4 v4, s[8:11], s3 offen offset:2048 lds
M v[136:139], a[116:119], a[188:191], v[136:139]
M v[140:143], a[124:127], a[188:191], v[140:143]
M v[140:143], a[120:123], a[184:187], v[140:143]
ds_read_b64_tr_b16 a[52:53], v14 offset:16384
ds_read_b64_tr_b16 a[54:55], v14 offset:18432
M v[144:147], a[128:131], a[184:187], v[144:147]
M v[144:147], a[132:135], a[188:191], v[144:147]
M v[148:151], a[140:143], a[188:191], v[148:151]
buffer_load_dwordx4 v5, s[8:11], s3 offen offset:3072 lds
M v[148:151], a[136:139], a[184:187], v[148:151]
M v[152:155], a[144:147], a[184:187], v[152:155]
M v[152:155], a[148:151], a[188:191], v[152:155]
ds_read_b64_tr_b16 a[60:61], v15 offset:16384
ds_read_b64_tr_b16 a[62:63], v15 offset:18432
M v[156:159], a[156:159], a[188:191], v[156:159]
M v[156:159], a[152:155], a[184:187], v[156:159]
s_waitcnt lgkmcnt(10)
M v[160:163], a[96:99], a[160:163], v[160:163]
M v[160:163], a[100:103], a[164:167], v[160:163]
ds_read_b128 a[176:179], v10 offset:53248
ds_read_b128 a[180:183], v11 offset:53248
M v[164:167], a[108:111], a[164:167], v[164:167]
s_add_u32 s23, s23, 128
s_cmp_eq_u32 s23, s25
s_cselect_b32 s23, s26, s23
M v[164:167], a[104:107], a[160:163], v[164:167]
ds_read_b64_tr_b16 a[68:69], v16 offset:16384
ds_read_b64_tr_b16 a[70:71], v16 offset:18432
M v[168:171], a[112:115], a[160:163], v[168:171]
M v[168:171], a[116:119], a[164:167], v[168:171]
M v[172:175], a[124:127], a[164:167], v[172:175]
M v[172:175], a[120:123], a[160:163], v[172:175]
M v[176:179], a[128:131], a[160:163], v[176:179]
s_add_u32 m0, s29, 114688
s_nop 0
buffer_load_dwordx4 v6, s[12:15], s24 offen offset:0 lds
M v[176:179], a[132:135], a[164:167], v[176:179]
ds_read_b64_tr_b16 a[76:77], v17 offset:16384
ds_read_b64_tr_b16 a[78:79], v17 offset:18432
M v[180:183], a[140:143], a[164:167], v[180:183]
M v[180:183], a[136:139], a[160:163], v[180:183]
M v[184:187], a[144:147], a[160:163], v[184:187]
M v[184:187], a[148:151], a[164:167], v[184:187]
buffer_load_dwordx4 v7, s[12:15], s24 offen offset:1024 lds
M v[188:191], a[156:159], a[164:167], v[188:191]
M v[188:191], a[152:155], a[160:163], v[188:191]
s_waitcnt lgkmcnt(12)
ds_read_b64_tr_b16 a[84:85], v18 offset:16384
ds_read_b64_tr_b16 a[86:87], v18 offset:18432
M v[192:195], a[96:99], a[168:171], v[192:195]
M v[192:195], a[100:103], a[172:175], v[192:195]
ds_read_b128 a[184:187], v10 offset:55296
ds_read_b128 a[188:191], v11 offset:55296
M v[196:199], a[108:111], a[172:175], v[196:199]
M v[196:199], a[104:107], a[168:171], v[196:199]
M v[200:203], a[112:115], a[168:171], v[200:203]
buffer_load_dwordx4 v8, s[12:15], s24 offen offset:2048 lds
M v[200:203], a[116:119], a[172:175], v[200:203]
ds_read_b64_tr_b16 a[92:93], v19 offset:16384
ds_read_b64_tr_b16 a[94:95], v19 offset:18432
M v[204:207], a[124:127], a[172:175], v[204:207]
M v[204:207], a[120:123], a[168:171], v[204:207]
M v[208:211], a[128:131], a[168:171], v[208:211]
M v[208:211], a[132:135], a[172:175], v[208:211]
M v[212:215], a[140:143], a[172:175], v[212:215]
buffer_load_dwordx4 v9, s[12:15], s24 offen offset:3072 lds
M v[212:215], a[136:139], a[168:171], v[212:215]
M v[216:219], a[144:147], a[168:171], v[216:219]
M v[216:219], a[148:151], a[172:175], v[216:219]
M v[220:223], a[156:159], a[172:175], v[220:223]
M v[220:223], a[152:155], a[168:171], v[220:223]
s_waitcnt lgkmcnt(10)
M v[224:227], a[96:99], a[176:179], v[224:227]
s_add_u32 s24, s24, 262144
s_cmp_eq_u32 s24, s27
s_cselect_b32 s24, s28, s24
s_sub_u32 s6, s6, 1
s_cmp_eq_u32 s6, 0
s_cselect_b64 s[12:13], s[64:65], s[12:13]
M v[224:227], a[100:103], a[180:183], v[224:227]
M v[228:231], a[108:111], a[180:183], v[228:231]
M v[228:231], a[104:107], a[176:179], v[228:231]
M v[232:235], a[112:115], a[176:179], v[232:235]
M v[232:235], a[116:119], a[180:183], v[232:235]
M v[236:239], a[124:127], a[180:183], v[236:239]
M v[236:239], a[120:123], a[176:179], v[236:239]
s_waitcnt vmcnt(8) lgkmcnt(0)
s_barrier
ds_read_b128 a[160:163], v10 offset:0
ds_read_b128 a[164:167], v11 offset:0
M v[240:243], a[128:131], a[176:179], v[240:243]
s_add_u32 m0, s29, 32768
s_nop 0
buffer_load_dwordx4 v2, s[8:11], s23 offen offset:0 lds
M v[240:243], a[132:135], a[180:183], v[240:243]
M v[244:247], a[140:143], a[180:183], v[244:247]
M v[244:247], a[136:139], a[176:179], v[244:247]
M v[248:251], a[144:147], a[176:179], v[248:251]
M v[248:251], a[148:151], a[180:183], v[248:251]
buffer_load_dwordx4 v3, s[8:11], s23 offen offset:1024 lds
M v[252:255], a[156:159], a[180:183], v[252:255]
M v[252:255], a[152:155], a[176:179], v[252:255]
M a[0:3], a[96:99], a[184:187], a[0:3]
M a[0:3], a[100:103], a[188:191], a[0:3]
ds_read_b128 a[168:171], v10 offset:2048
ds_read_b128 a[172:175], v11 offset:2048
M a[4:7], a[108:111], a[188:191], a[4:7]
M a[4:7], a[104:107], a[184:187], a[4:7]
M a[8:11], a[112:115], a[184:187], a[8:11]
buffer_load_dwordx4 v4, s[8:11], s23 offen offset:2048 lds
M a[8:11], a[116:119], a[188:191], a[8:11]
M a[12:15], a[124:127], a[188:191], a[12:15]
M a[12:15], a[120:123], a[184:187], a[12:15]
M a[16:19], a[128:131], a[184:187], a[16:19]
M a[16:19], a[132:135], a[188:191], a[16:19]
buffer_load_dwordx4 v5, s[8:11], s23 offen offset:3072 lds
M a[20:23], a[140:143], a[188:191], a[20:23]
M a[20:23], a[136:139], a[184:187], a[20:23]
M a[24:27], a[144:147], a[184:187], a[24:27]
M a[24:27], a[148:151], a[188:191], a[24:27]
M a[28:31], a[156:159], a[188:191], a[28:31]
M a[28:31], a[152:155], a[184:187], a[28:31]
s_waitcnt lgkmcnt(2)
s_sub_u32 s30, s30, 1
s_cmp_lg_u32 s30, 0
s_cbranch_scc1 Lk1_kl
M v[32:35], a[32:35], a[160:163], v[32:35]
s_add_u32 m0, s29, 65536
s_nop 0
buffer_load_dwordx4 v6, s[12:15], s24 offen offset:0 lds
M v[32:35], a[36:39], a[164:167], v[32:35]
ds_read_b128 a[176:179], v10 offset:4096
ds_read_b128 a[180:183], v11 offset:4096
M v[36:39], a[44:47], a[164:167], v[36:39]
M v[36:39], a[40:43], a[160:163], v[36:39]
ds_read_b64_tr_b16 a[96:97], v12 offset:32768
ds_read_b64_tr_b16 a[98:99], v12 offset:34816
M v[40:43], a[48:51], a[160:163], v[40:43]
M v[40:43], a[52:55], a[164:167], v[40:43]
M v[44:47], a[60:63], a[164:167], v[44:47]
M v[44:47], a[56:59], a[160:163], v[44:47]
ds_read_b64_tr_b16 a[104:105], v13 offset:32768
ds_read_b64_tr_b16 a[106:107], v13 offset:34816
M v[48:51], a[64:67], a[160:163], v[48:51]
buffer_load_dwordx4 v7, s[12:15], s24 offen offset:1024 lds
M v[48:51], a[68:71], a[164:167], v[48:51]
M v[52:55], a[76:79], a[164:167], v[52:55]
M v[52:55], a[72:75], a[160:163], v[52:55]
ds_read_b64_tr_b16 a[112:113], v14 offset:32768
ds_read_b64_tr_b16 a[114:115], v14 offset:34816
M v[56:59], a[80:83], a[160:163], v[56:59]
M v[56:59], a[84:87], a[164:167], v[56:59]
M v[60:63], a[92:95], a[164:167], v[60:63]
buffer_load_dwordx4 v8, s[12:15], s24 offen offset:2048 lds
M v[60:63], a[88:91], a[160:163], v[60:63]
s_waitcnt lgkmcnt(8)
ds_read_b64_tr_b16 a[120:121], v15 offset:32768
ds_read_b64_tr_b16 a[122:123], v15 offset:34816
M v[64:67], a[32:35], a[168:171], v[64:67]
M v[64:67], a[36:39], a[172:175], v[64:67]
ds_read_b128 a[184:187], v10 offset:6144
ds_read_b128 a[188:191], v11 offset:6144
M v[68:71], a[44:47], a[172:175], v[68:71]
M v[68:71], a[40:43], a[168:171], v[68:71]
ds_read_b64_tr_b16 a[128:129], v16 offset:32768
ds_read_b64_tr_b16 a[130:131], v16 offset:34816
M v[72:75], a[48:51], a[168:171], v[72:75]
M v[72:75], a[52:55], a[172:175], v[72:75]
M v[76:79], a[60:63], a[172:175], v[76:79]
M v[76:79], a[56:59], a[168:171], v[76:79]
ds_read_b64_tr_b16 a[136:137], v17 offset:32768
ds_read_b64_tr_b16 a[138:139], v17 offset:34816
M v[80:83], a[64:67], a[168:171], v[80:83]
buffer_load_dwordx4 v9, s[12:15], s24 offen offset:3072 lds
M v[80:83], a[68:71], a[172:175], v[80:83]
M v[84:87], a[76:79], a[172:175], v[84:87]
M v[84:87], a[72:75], a[168:171], v[84:87]
ds_read_b64_tr_b16 a[144:145], v18 offset:32768
ds_read_b64_tr_b16 a[146:147], v18 offset:34816
M v[88:91], a[80:83], a[168:171], v[88:91]
M v[88:91], a[84:87], a[172:175], v[88:91]
M v[92:95], a[92:95], a[172:175], v[92:95]
s_add_u32 s24, s24, 262144
M v[92:95], a[88:91], a[168:171], v[92:95]
s_waitcnt lgkmcnt(15)
ds_read_b64_tr_b16 a[152:153], v19 offset:32768
ds_read_b64_tr_b16 a[154:155], v19 offset:34816
M v[96:99], a[32:35], a[176:179], v[96:99]
M v[96:99], a[36:39], a[180:183], v[96:99]
M v[100:103], a[44:47], a[180:183], v[100:103]
M v[100:103], a[40:43], a[176:179], v[100:103]
M v[104:107], a[48:51], a[176:179], v[104:107]
M v[104:107], a[52:55], a[180:183], v[104:107]
M v[108:111], a[60:63], a[180:183], v[108:111]
M v[108:111], a[56:59], a[176:179], v[108:111]
s_waitcnt vmcnt(8) lgkmcnt(0)
s_barrier
ds_read_b128 a[160:163], v10 offset:16384
ds_read_b128 a[164:167], v11 offset:16384
M v[112:115], a[64:67], a[176:179], v[112:115]
s_add_u32 m0, s29, 49152
s_add_u32 s3, s23, s31
buffer_load_dwordx4 v2, s[8:11], s3 offen offset:0 lds
M v[112:115], a[68:71], a[180:183], v[112:115]
M v[116:119], a[76:79], a[180:183], v[116:119]
M v[116:119], a[72:75], a[176:179], v[116:119]
ds_read_b64_tr_b16 a[100:101], v12 offset:49152
ds_read_b64_tr_b16 a[102:103], v12 offset:51200
M v[120:123], a[80:83], a[176:179], v[120:123]
M v[120:123], a[84:87], a[180:183], v[120:123]
buffer_load_dwordx4 v3, s[8:11], s3 offen offset:1024 lds
M v[124:127], a[92:95], a[180:183], v[124:127]
M v[124:127], a[88:91], a[176:179], v[124:127]
M v[128:131], a[32:35], a[184:187], v[128:131]
M v[128:131], a[36:39], a[188:191], v[128:131]
ds_read_b128 a[168:171], v10 offset:18432
ds_read_b128 a[172:175], v11 offset:18432
ds_read_b64_tr_b16 a[108:109], v13 offset:49152
ds_read_b64_tr_b16 a[110:111], v13 offset:51200
M v[132:135], a[44:47], a[188:191], v[132:135]
M v[132:135], a[40:43], a[184:187], v[132:135]
M v[136:139], a[48:51], a[184:187], v[136:139]
buffer_load_dwordx4 v4, s[8:11], s3 offen offset:2048 lds
M v[136:139], a[52:55], a[188:191], v[136:139]
M v[140:143], a[60:63], a[188:191], v[140:143]
M v[140:143], a[56:59], a[184:187], v[140:143]
ds_read_b64_tr_b16 a[116:117], v14 offset:49152
ds_read_b64_tr_b16 a[118:119], v14 offset:51200
M v[144:147], a[64:67], a[184:187], v[144:147]
M v[144:147], a[68:71], a[188:191], v[144:147]
M v[148:151], a[76:79], a[188:191], v[148:151]
buffer_load_dwordx4 v5, s[8:11], s3 offen offset:3072 lds
M v[148:151], a[72:75], a[184:187], v[148:151]
M v[152:155], a[80:83], a[184:187], v[152:155]
s_lshr_b32 s95, s53, 7
s_add_u32 s95, s95, s22
M v[152:155], a[84:87], a[188:191], v[152:155]
ds_read_b64_tr_b16 a[124:125], v15 offset:49152
ds_read_b64_tr_b16 a[126:127], v15 offset:51200
s_lshl_b32 s95, s95, 5
s_lshr_b32 s19, s52, 6
M v[156:159], a[92:95], a[188:191], v[156:159]
s_add_u32 s95, s95, s19
s_lshl_b32 s19, s21, 1
M v[156:159], a[88:91], a[184:187], v[156:159]
s_waitcnt lgkmcnt(10)
s_add_u32 s95, s95, s19
s_lshl_b32 s92, s95, 15
M v[160:163], a[32:35], a[160:163], v[160:163]
s_add_u32 s93, s92, 32768
s_add_u32 s16, s50, 16777216
M v[160:163], a[36:39], a[164:167], v[160:163]
ds_read_b128 a[176:179], v10 offset:20480
ds_read_b128 a[180:183], v11 offset:20480
s_addc_u32 s17, s51, 0
s_mov_b32 s18, 33554432
M v[164:167], a[44:47], a[164:167], v[164:167]
s_add_u32 s23, s23, 128
s_cmp_eq_u32 s23, s25
s_cselect_b32 s23, s26, s23
s_mov_b32 s19, 0x00020000
M v[164:167], a[40:43], a[160:163], v[164:167]
ds_read_b64_tr_b16 a[132:133], v16 offset:49152
ds_read_b64_tr_b16 a[134:135], v16 offset:51200
M v[168:171], a[48:51], a[160:163], v[168:171]
M v[168:171], a[52:55], a[164:167], v[168:171]
M v[172:175], a[60:63], a[164:167], v[172:175]
M v[172:175], a[56:59], a[160:163], v[172:175]
M v[176:179], a[64:67], a[160:163], v[176:179]
s_add_u32 m0, s29, 81920
s_nop 0
buffer_load_dwordx4 v6, s[12:15], s24 offen offset:0 lds
M v[176:179], a[68:71], a[164:167], v[176:179]
ds_read_b64_tr_b16 a[140:141], v17 offset:49152
ds_read_b64_tr_b16 a[142:143], v17 offset:51200
M v[180:183], a[76:79], a[164:167], v[180:183]
M v[180:183], a[72:75], a[160:163], v[180:183]
M v[184:187], a[80:83], a[160:163], v[184:187]
M v[184:187], a[84:87], a[164:167], v[184:187]
buffer_load_dwordx4 v7, s[12:15], s24 offen offset:1024 lds
M v[188:191], a[92:95], a[164:167], v[188:191]
M v[188:191], a[88:91], a[160:163], v[188:191]
s_waitcnt lgkmcnt(12)
ds_read_b64_tr_b16 a[148:149], v18 offset:49152
ds_read_b64_tr_b16 a[150:151], v18 offset:51200
M v[192:195], a[32:35], a[168:171], v[192:195]
M v[192:195], a[36:39], a[172:175], v[192:195]
ds_read_b128 a[184:187], v10 offset:22528
ds_read_b128 a[188:191], v11 offset:22528
M v[196:199], a[44:47], a[172:175], v[196:199]
M v[196:199], a[40:43], a[168:171], v[196:199]
M v[200:203], a[48:51], a[168:171], v[200:203]
buffer_load_dwordx4 v8, s[12:15], s24 offen offset:2048 lds
M v[200:203], a[52:55], a[172:175], v[200:203]
ds_read_b64_tr_b16 a[156:157], v19 offset:49152
ds_read_b64_tr_b16 a[158:159], v19 offset:51200
M v[204:207], a[60:63], a[172:175], v[204:207]
M v[204:207], a[56:59], a[168:171], v[204:207]
M v[208:211], a[64:67], a[168:171], v[208:211]
M v[208:211], a[68:71], a[172:175], v[208:211]
M v[212:215], a[76:79], a[172:175], v[212:215]
buffer_load_dwordx4 v9, s[12:15], s24 offen offset:3072 lds
M v[212:215], a[72:75], a[168:171], v[212:215]
M v[216:219], a[80:83], a[168:171], v[216:219]
M v[216:219], a[84:87], a[172:175], v[216:219]
M v[220:223], a[92:95], a[172:175], v[220:223]
M v[220:223], a[88:91], a[168:171], v[220:223]
s_waitcnt lgkmcnt(10)
M v[224:227], a[32:35], a[176:179], v[224:227]
s_add_u32 s24, s24, 262144
s_cmp_eq_u32 s24, s27
s_cselect_b32 s24, s28, s24
s_sub_u32 s6, s6, 1
s_cmp_eq_u32 s6, 0
s_cselect_b64 s[12:13], s[64:65], s[12:13]
M v[224:227], a[36:39], a[180:183], v[224:227]
M v[228:231], a[44:47], a[180:183], v[228:231]
M v[228:231], a[40:43], a[176:179], v[228:231]
M v[232:235], a[48:51], a[176:179], v[232:235]
M v[232:235], a[52:55], a[180:183], v[232:235]
M v[236:239], a[60:63], a[180:183], v[236:239]
M v[236:239], a[56:59], a[176:179], v[236:239]
s_waitcnt vmcnt(8) lgkmcnt(0)
s_barrier
ds_read_b128 a[160:163], v10 offset:32768
ds_read_b128 a[164:167], v11 offset:32768
M v[240:243], a[64:67], a[176:179], v[240:243]
s_add_u32 m0, s29, 0
s_nop 0
buffer_load_dwordx4 v2, s[8:11], s23 offen offset:0 lds
M v[240:243], a[68:71], a[180:183], v[240:243]
M v[244:247], a[76:79], a[180:183], v[244:247]
M v[244:247], a[72:75], a[176:179], v[244:247]
M v[248:251], a[80:83], a[176:179], v[248:251]
M v[248:251], a[84:87], a[180:183], v[248:251]
buffer_load_dwordx4 v3, s[8:11], s23 offen offset:1024 lds
M v[252:255], a[92:95], a[180:183], v[252:255]
M v[252:255], a[88:91], a[176:179], v[252:255]
M a[0:3], a[32:35], a[184:187], a[0:3]
M a[0:3], a[36:39], a[188:191], a[0:3]
ds_read_b128 a[168:171], v10 offset:34816
ds_read_b128 a[172:175], v11 offset:34816
M a[4:7], a[44:47], a[188:191], a[4:7]
M a[4:7], a[40:43], a[184:187], a[4:7]
M a[8:11], a[48:51], a[184:187], a[8:11]
buffer_load_dwordx4 v4, s[8:11], s23 offen offset:2048 lds
M a[8:11], a[52:55], a[188:191], a[8:11]
M a[12:15], a[60:63], a[188:191], a[12:15]
M a[12:15], a[56:59], a[184:187], a[12:15]
M a[16:19], a[64:67], a[184:187], a[16:19]
M a[16:19], a[68:71], a[188:191], a[16:19]
buffer_load_dwordx4 v5, s[8:11], s23 offen offset:3072 lds
M a[20:23], a[76:79], a[188:191], a[20:23]
M a[20:23], a[72:75], a[184:187], a[20:23]
M a[24:27], a[80:83], a[184:187], a[24:27]
M a[24:27], a[84:87], a[188:191], a[24:27]
M a[28:31], a[92:95], a[188:191], a[28:31]
M a[28:31], a[88:91], a[184:187], a[28:31]
s_waitcnt lgkmcnt(2)
M v[32:35], a[96:99], a[160:163], v[32:35]
s_add_u32 m0, s29, 98304
s_nop 0
buffer_load_dwordx4 v6, s[12:15], s24 offen offset:0 lds
M v[32:35], a[100:103], a[164:167], v[32:35]
ds_read_b128 a[176:179], v10 offset:36864
ds_read_b128 a[180:183], v11 offset:36864
M v[36:39], a[108:111], a[164:167], v[36:39]
M v[36:39], a[104:107], a[160:163], v[36:39]
ds_read_b64_tr_b16 a[32:33], v12 offset:0
ds_read_b64_tr_b16 a[34:35], v12 offset:2048
M v[40:43], a[112:115], a[160:163], v[40:43]
M v[40:43], a[116:119], a[164:167], v[40:43]
M v[44:47], a[124:127], a[164:167], v[44:47]
M v[44:47], a[120:123], a[160:163], v[44:47]
ds_read_b64_tr_b16 a[40:41], v13 offset:0
ds_read_b64_tr_b16 a[42:43], v13 offset:2048
M v[48:51], a[128:131], a[160:163], v[48:51]
buffer_load_dwordx4 v7, s[12:15], s24 offen offset:1024 lds
M v[48:51], a[132:135], a[164:167], v[48:51]
M v[52:55], a[140:143], a[164:167], v[52:55]
M v[52:55], a[136:139], a[160:163], v[52:55]
ds_read_b64_tr_b16 a[48:49], v14 offset:0
ds_read_b64_tr_b16 a[50:51], v14 offset:2048
M v[56:59], a[144:147], a[160:163], v[56:59]
M v[56:59], a[148:151], a[164:167], v[56:59]
M v[60:63], a[156:159], a[164:167], v[60:63]
buffer_load_dwordx4 v8, s[12:15], s24 offen offset:2048 lds
M v[60:63], a[152:155], a[160:163], v[60:63]
s_waitcnt lgkmcnt(8)
ds_read_b64_tr_b16 a[56:57], v15 offset:0
ds_read_b64_tr_b16 a[58:59], v15 offset:2048
M v[64:67], a[96:99], a[168:171], v[64:67]
M v[64:67], a[100:103], a[172:175], v[64:67]
ds_read_b128 a[184:187], v10 offset:38912
ds_read_b128 a[188:191], v11 offset:38912
M v[68:71], a[108:111], a[172:175], v[68:71]
M v[68:71], a[104:107], a[168:171], v[68:71]
ds_read_b64_tr_b16 a[64:65], v16 offset:0
ds_read_b64_tr_b16 a[66:67], v16 offset:2048
v_cvt_pk_bf16_f32 v32, v32, v33
v_cvt_pk_bf16_f32 v33, v34, v35
M v[72:75], a[112:115], a[168:171], v[72:75]
v_cvt_pk_bf16_f32 v34, v36, v37
v_cvt_pk_bf16_f32 v35, v38, v39
M v[72:75], a[116:119], a[172:175], v[72:75]
v_cvt_pk_bf16_f32 v40, v40, v41
v_cvt_pk_bf16_f32 v41, v42, v43
M v[76:79], a[124:127], a[172:175], v[76:79]
buffer_load_dwordx4 v9, s[12:15], s24 offen offset:3072 lds
v_cvt_pk_bf16_f32 v42, v44, v45
v_cvt_pk_bf16_f32 v43, v46, v47
M v[76:79], a[120:123], a[168:171], v[76:79]
ds_read_b64_tr_b16 a[72:73], v17 offset:0
ds_read_b64_tr_b16 a[74:75], v17 offset:2048
v_cvt_pk_bf16_f32 v48, v48, v49
v_cvt_pk_bf16_f32 v49, v50, v51
M v[80:83], a[128:131], a[168:171], v[80:83]
v_cvt_pk_bf16_f32 v50, v52, v53
v_cvt_pk_bf16_f32 v51, v54, v55
M v[80:83], a[132:135], a[172:175], v[80:83]
v_cvt_pk_bf16_f32 v56, v56, v57
v_cvt_pk_bf16_f32 v57, v58, v59
M v[84:87], a[140:143], a[172:175], v[84:87]
v_cvt_pk_bf16_f32 v58, v60, v61
v_cvt_pk_bf16_f32 v59, v62, v63
M v[84:87], a[136:139], a[168:171], v[84:87]
ds_read_b64_tr_b16 a[80:81], v18 offset:0
ds_read_b64_tr_b16 a[82:83], v18 offset:2048
M v[88:91], a[144:147], a[168:171], v[88:91]
M v[88:91], a[148:151], a[172:175], v[88:91]
s_add_u32 s24, s24, 262144
M v[92:95], a[156:159], a[172:175], v[92:95]
s_add_u32 s94, s92, 0
buffer_store_dwordx4 v[32:35], v1, s[16:19], s94 offen offset:0 sc1
M v[92:95], a[152:155], a[168:171], v[92:95]
s_waitcnt lgkmcnt(15)
ds_read_b64_tr_b16 a[88:89], v19 offset:0
ds_read_b64_tr_b16 a[90:91], v19 offset:2048
M v[96:99], a[96:99], a[176:179], v[96:99]
M v[96:99], a[100:103], a[180:183], v[96:99]
M v[100:103], a[108:111], a[180:183], v[100:103]
M v[100:103], a[104:107], a[176:179], v[100:103]
v_cvt_pk_bf16_f32 v64, v64, v65
v_cvt_pk_bf16_f32 v65, v66, v67
M v[104:107], a[112:115], a[176:179], v[104:107]
v_cvt_pk_bf16_f32 v66, v68, v69
v_cvt_pk_bf16_f32 v67, v70, v71
M v[104:107], a[116:119], a[180:183], v[104:107]
v_cvt_pk_bf16_f32 v72, v72, v73
v_cvt_pk_bf16_f32 v73, v74, v75
M v[108:111], a[124:127], a[180:183], v[108:111]
v_cvt_pk_bf16_f32 v74, v76, v77
v_cvt_pk_bf16_f32 v75, v78, v79
M v[108:111], a[120:123], a[176:179], v[108:111]
s_waitcnt vmcnt(9) lgkmcnt(0)
s_barrier
ds_read_b128 a[160:163], v10 offset:49152
ds_read_b128 a[164:167], v11 offset:49152
v_cvt_pk_bf16_f32 v80, v80, v81
v_cvt_pk_bf16_f32 v81, v82, v83
M v[112:115], a[128:131], a[176:179], v[112:115]
s_add_u32 s94, s92, 0
buffer_store_dwordx4 v[40:43], v1, s[16:19], s94 offen offset:1024 sc1
v_cvt_pk_bf16_f32 v82, v84, v85
v_cvt_pk_bf16_f32 v83, v86, v87
M v[112:115], a[132:135], a[180:183], v[112:115]
s_add_u32 m0, s29, 16384
s_add_u32 s3, s23, s31
buffer_load_dwordx4 v2, s[8:11], s3 offen offset:0 lds
v_cvt_pk_bf16_f32 v88, v88, v89
v_cvt_pk_bf16_f32 v89, v90, v91
M v[116:119], a[140:143], a[180:183], v[116:119]
v_cvt_pk_bf16_f32 v90, v92, v93
v_cvt_pk_bf16_f32 v91, v94, v95
M v[116:119], a[136:139], a[176:179], v[116:119]
ds_read_b64_tr_b16 a[36:37], v12 offset:16384
ds_read_b64_tr_b16 a[38:39], v12 offset:18432
M v[120:123], a[144:147], a[176:179], v[120:123]
M v[120:123], a[148:151], a[180:183], v[120:123]
M v[124:127], a[156:159], a[180:183], v[124:127]
buffer_load_dwordx4 v3, s[8:11], s3 offen offset:1024 lds
M v[124:127], a[152:155], a[176:179], v[124:127]
M v[128:131], a[96:99], a[184:187], v[128:131]
M v[128:131], a[100:103], a[188:191], v[128:131]
ds_read_b128 a[168:171], v10 offset:51200
ds_read_b128 a[172:175], v11 offset:51200
ds_read_b64_tr_b16 a[44:45], v13 offset:16384
ds_read_b64_tr_b16 a[46:47], v13 offset:18432
M v[132:135], a[108:111], a[188:191], v[132:135]
M v[132:135], a[104:107], a[184:187], v[132:135]
s_add_u32 s94, s92, 0
buffer_store_dwordx4 v[48:51], v1, s[16:19], s94 offen offset:2048 sc1
v_cvt_pk_bf16_f32 v96, v96, v97
v_cvt_pk_bf16_f32 v97, v98, v99
M v[136:139], a[112:115], a[184:187], v[136:139]
v_cvt_pk_bf16_f32 v98, v100, v101
v_cvt_pk_bf16_f32 v99, v102, v103
M v[136:139], a[116:119], a[188:191], v[136:139]
buffer_load_dwordx4 v4, s[8:11], s3 offen offset:2048 lds
v_cvt_pk_bf16_f32 v104, v104, v105
v_cvt_pk_bf16_f32 v105, v106, v107
M v[140:143], a[124:127], a[188:191], v[140:143]
v_cvt_pk_bf16_f32 v106, v108, v109
v_cvt_pk_bf16_f32 v107, v110, v111
M v[140:143], a[120:123], a[184:187], v[140:143]
ds_read_b64_tr_b16 a[52:53], v14 offset:16384
ds_read_b64_tr_b16 a[54:55], v14 offset:18432
v_cvt_pk_bf16_f32 v112, v112, v113
v_cvt_pk_bf16_f32 v113, v114, v115
M v[144:147], a[128:131], a[184:187], v[144:147]
v_cvt_pk_bf16_f32 v114, v116, v117
v_cvt_pk_bf16_f32 v115, v118, v119
M v[144:147], a[132:135], a[188:191], v[144:147]
v_cvt_pk_bf16_f32 v120, v120, v121
v_cvt_pk_bf16_f32 v121, v122, v123
M v[148:151], a[140:143], a[188:191], v[148:151]
buffer_load_dwordx4 v5, s[8:11], s3 offen offset:3072 lds
v_cvt_pk_bf16_f32 v122, v124, v125
v_cvt_pk_bf16_f32 v123, v126, v127
M v[148:151], a[136:139], a[184:187], v[148:151]
M v[152:155], a[144:147], a[184:187], v[152:155]
M v[152:155], a[148:151], a[188:191], v[152:155]
ds_read_b64_tr_b16 a[60:61], v15 offset:16384
ds_read_b64_tr_b16 a[62:63], v15 offset:18432
M v[156:159], a[156:159], a[188:191], v[156:159]
s_add_u32 s94, s92, 0
buffer_store_dwordx4 v[56:59], v1, s[16:19], s94 offen offset:3072 sc1
M v[156:159], a[152:155], a[184:187], v[156:159]
s_waitcnt lgkmcnt(10)
M v[160:163], a[96:99], a[160:163], v[160:163]
M v[160:163], a[100:103], a[164:167], v[160:163]
ds_read_b128 a[176:179], v10 offset:53248
ds_read_b128 a[180:183], v11 offset:53248
M v[164:167], a[108:111], a[164:167], v[164:167]
s_add_u32 s23, s23, 128
s_cmp_eq_u32 s23, s25
s_cselect_b32 s23, s26, s23
M v[164:167], a[104:107], a[160:163], v[164:167]
ds_read_b64_tr_b16 a[68:69], v16 offset:16384
ds_read_b64_tr_b16 a[70:71], v16 offset:18432
v_cvt_pk_bf16_f32 v128, v128, v129
v_cvt_pk_bf16_f32 v129, v130, v131
M v[168:171], a[112:115], a[160:163], v[168:171]
v_cvt_pk_bf16_f32 v130, v132, v133
v_cvt_pk_bf16_f32 v131, v134, v135
M v[168:171], a[116:119], a[164:167], v[168:171]
v_cvt_pk_bf16_f32 v136, v136, v137
v_cvt_pk_bf16_f32 v137, v138, v139
M v[172:175], a[124:127], a[164:167], v[172:175]
v_cvt_pk_bf16_f32 v138, v140, v141
v_cvt_pk_bf16_f32 v139, v142, v143
M v[172:175], a[120:123], a[160:163], v[172:175]
v_cvt_pk_bf16_f32 v144, v144, v145
v_cvt_pk_bf16_f32 v145, v146, v147
M v[176:179], a[128:131], a[160:163], v[176:179]
s_add_u32 s94, s92, 4096
buffer_store_dwordx4 v[64:67], v1, s[16:19], s94 offen offset:0 sc1
v_cvt_pk_bf16_f32 v146, v148, v149
v_cvt_pk_bf16_f32 v147, v150, v151
M v[176:179], a[132:135], a[164:167], v[176:179]
ds_read_b64_tr_b16 a[76:77], v17 offset:16384
ds_read_b64_tr_b16 a[78:79], v17 offset:18432
v_cvt_pk_bf16_f32 v152, v152, v153
v_cvt_pk_bf16_f32 v153, v154, v155
M v[180:183], a[140:143], a[164:167], v[180:183]
s_add_u32 m0, s29, 114688
s_nop 0
buffer_load_dwordx4 v6, s[12:15], s24 offen offset:0 lds
v_cvt_pk_bf16_f32 v154, v156, v157
v_cvt_pk_bf16_f32 v155, v158, v159
M v[180:183], a[136:139], a[160:163], v[180:183]
M v[184:187], a[144:147], a[160:163], v[184:187]
v_accvgpr_write_b32 a192, v128
v_accvgpr_write_b32 a193, v129
v_accvgpr_write_b32 a194, v130
v_accvgpr_write_b32 a195, v131
M v[184:187], a[148:151], a[164:167], v[184:187]
v_accvgpr_write_b32 a196, v136
v_accvgpr_write_b32 a197, v137
v_accvgpr_write_b32 a198, v138
v_accvgpr_write_b32 a199, v139
M v[188:191], a[156:159], a[164:167], v[188:191]
buffer_load_dwordx4 v7, s[12:15], s24 offen offset:1024 lds
v_accvgpr_write_b32 a200, v144
v_accvgpr_write_b32 a201, v145
v_accvgpr_write_b32 a202, v146
v_accvgpr_write_b32 a203, v147
M v[188:191], a[152:155], a[160:163], v[188:191]
s_waitcnt lgkmcnt(12)
ds_read_b64_tr_b16 a[84:85], v18 offset:16384
ds_read_b64_tr_b16 a[86:87], v18 offset:18432
v_accvgpr_write_b32 a204, v152
v_accvgpr_write_b32 a205, v153
v_accvgpr_write_b32 a206, v154
v_accvgpr_write_b32 a207, v155
M v[192:195], a[96:99], a[168:171], v[192:195]
M v[192:195], a[100:103], a[172:175], v[192:195]
ds_read_b128 a[184:187], v10 offset:55296
ds_read_b128 a[188:191], v11 offset:55296
M v[196:199], a[108:111], a[172:175], v[196:199]
s_add_u32 s94, s92, 4096
buffer_store_dwordx4 v[72:75], v1, s[16:19], s94 offen offset:1024 sc1
M v[196:199], a[104:107], a[168:171], v[196:199]
v_cvt_pk_bf16_f32 v160, v160, v161
v_cvt_pk_bf16_f32 v161, v162, v163
M v[200:203], a[112:115], a[168:171], v[200:203]
v_cvt_pk_bf16_f32 v162, v164, v165
v_cvt_pk_bf16_f32 v163, v166, v167
M v[200:203], a[116:119], a[172:175], v[200:203]
ds_read_b64_tr_b16 a[92:93], v19 offset:16384
ds_read_b64_tr_b16 a[94:95], v19 offset:18432
v_cvt_pk_bf16_f32 v168, v168, v169
v_cvt_pk_bf16_f32 v169, v170, v171
M v[204:207], a[124:127], a[172:175], v[204:207]
buffer_load_dwordx4 v8, s[12:15], s24 offen offset:2048 lds
v_cvt_pk_bf16_f32 v170, v172, v173
v_cvt_pk_bf16_f32 v171, v174, v175
M v[204:207], a[120:123], a[168:171], v[204:207]
v_cvt_pk_bf16_f32 v176, v176, v177
v_cvt_pk_bf16_f32 v177, v178, v179
M v[208:211], a[128:131], a[168:171], v[208:211]
v_cvt_pk_bf16_f32 v178, v180, v181
v_cvt_pk_bf16_f32 v179, v182, v183
M v[208:211], a[132:135], a[172:175], v[208:211]
v_cvt_pk_bf16_f32 v184, v184, v185
v_cvt_pk_bf16_f32 v185, v186, v187
M v[212:215], a[140:143], a[172:175], v[212:215]
buffer_load_dwordx4 v9, s[12:15], s24 offen offset:3072 lds
v_cvt_pk_bf16_f32 v186, v188, v189
v_cvt_pk_bf16_f32 v187, v190, v191
M v[212:215], a[136:139], a[168:171], v[212:215]
M v[216:219], a[144:147], a[168:171], v[216:219]
v_accvgpr_write_b32 a208, v160
v_accvgpr_write_b32 a209, v161
v_accvgpr_write_b32 a210, v162
v_accvgpr_write_b32 a211, v163
M v[216:219], a[148:151], a[172:175], v[216:219]
s_add_u32 s94, s92, 4096
buffer_store_dwordx4 v[80:83], v1, s[16:19], s94 offen offset:2048 sc1
v_accvgpr_write_b32 a212, v168
v_accvgpr_write_b32 a213, v169
v_accvgpr_write_b32 a214, v170
v_accvgpr_write_b32 a215, v171
M v[220:223], a[156:159], a[172:175], v[220:223]
v_accvgpr_write_b32 a216, v176
v_accvgpr_write_b32 a217, v177
v_accvgpr_write_b32 a218, v178
v_accvgpr_write_b32 a219, v179
M v[220:223], a[152:155], a[168:171], v[220:223]
s_waitcnt lgkmcnt(10)
v_accvgpr_write_b32 a220, v184
v_accvgpr_write_b32 a221, v185
v_accvgpr_write_b32 a222, v186
v_accvgpr_write_b32 a223, v187
M v[224:227], a[96:99], a[176:179], v[224:227]
s_add_u32 s24, s24, 262144
s_cmp_eq_u32 s24, s27
s_cselect_b32 s24, s28, s24
s_sub_u32 s6, s6, 1
s_cmp_eq_u32 s6, 0
s_cselect_b64 s[12:13], s[64:65], s[12:13]
M v[224:227], a[100:103], a[180:183], v[224:227]
M v[228:231], a[108:111], a[180:183], v[228:231]
M v[228:231], a[104:107], a[176:179], v[228:231]
v_cvt_pk_bf16_f32 v192, v192, v193
v_cvt_pk_bf16_f32 v193, v194, v195
M v[232:235], a[112:115], a[176:179], v[232:235]
v_cvt_pk_bf16_f32 v194, v196, v197
v_cvt_pk_bf16_f32 v195, v198, v199
M v[232:235], a[116:119], a[180:183], v[232:235]
v_cvt_pk_bf16_f32 v200, v200, v201
v_cvt_pk_bf16_f32 v201, v202, v203
M v[236:239], a[124:127], a[180:183], v[236:239]
v_cvt_pk_bf16_f32 v202, v204, v205
v_cvt_pk_bf16_f32 v203, v206, v207
M v[236:239], a[120:123], a[176:179], v[236:239]
s_waitcnt vmcnt(15) lgkmcnt(0)
s_barrier
ds_read_b128 a[160:163], v10 offset:0
ds_read_b128 a[164:167], v11 offset:0
v_cvt_pk_bf16_f32 v208, v208, v209
v_cvt_pk_bf16_f32 v209, v210, v211
M v[240:243], a[128:131], a[176:179], v[240:243]
s_add_u32 s94, s92, 4096
buffer_store_dwordx4 v[88:91], v1, s[16:19], s94 offen offset:3072 sc1
v_cvt_pk_bf16_f32 v210, v212, v213
v_cvt_pk_bf16_f32 v211, v214, v215
M v[240:243], a[132:135], a[180:183], v[240:243]
s_add_u32 m0, s29, 32768
s_nop 0
buffer_load_dwordx4 v2, s[8:11], s23 offen offset:0 lds
v_cvt_pk_bf16_f32 v216, v216, v217
v_cvt_pk_bf16_f32 v217, v218, v219
M v[244:247], a[140:143], a[180:183], v[244:247]
v_cvt_pk_bf16_f32 v218, v220, v221
v_cvt_pk_bf16_f32 v219, v222, v223
M v[244:247], a[136:139], a[176:179], v[244:247]
M v[248:251], a[144:147], a[176:179], v[248:251]
v_accvgpr_write_b32 a224, v192
v_accvgpr_write_b32 a225, v193
v_accvgpr_write_b32 a226, v194
v_accvgpr_write_b32 a227, v195
M v[248:251], a[148:151], a[180:183], v[248:251]
buffer_load_dwordx4 v3, s[8:11], s23 offen offset:1024 lds
v_accvgpr_write_b32 a228, v200
v_accvgpr_write_b32 a229, v201
v_accvgpr_write_b32 a230, v202
v_accvgpr_write_b32 a231, v203
M v[252:255], a[156:159], a[180:183], v[252:255]
v_accvgpr_write_b32 a232, v208
v_accvgpr_write_b32 a233, v209
v_accvgpr_write_b32 a234, v210
v_accvgpr_write_b32 a235, v211
M v[252:255], a[152:155], a[176:179], v[252:255]
v_accvgpr_write_b32 a236, v216
v_accvgpr_write_b32 a237, v217
v_accvgpr_write_b32 a238, v218
v_accvgpr_write_b32 a239, v219
M a[0:3], a[96:99], a[184:187], a[0:3]
M a[0:3], a[100:103], a[188:191], a[0:3]
ds_read_b128 a[168:171], v10 offset:2048
ds_read_b128 a[172:175], v11 offset:2048
M a[4:7], a[108:111], a[188:191], a[4:7]
s_add_u32 s94, s92, 8192
buffer_store_dwordx4 v[96:99], v1, s[16:19], s94 offen offset:0 sc1
M a[4:7], a[104:107], a[184:187], a[4:7]
v_cvt_pk_bf16_f32 v224, v224, v225
v_cvt_pk_bf16_f32 v225, v226, v227
M a[8:11], a[112:115], a[184:187], a[8:11]
v_cvt_pk_bf16_f32 v226, v228, v229
v_cvt_pk_bf16_f32 v227, v230, v231
M a[8:11], a[116:119], a[188:191], a[8:11]
buffer_load_dwordx4 v4, s[8:11], s23 offen offset:2048 lds
v_cvt_pk_bf16_f32 v232, v232, v233
v_cvt_pk_bf16_f32 v233, v234, v235
M a[12:15], a[124:127], a[188:191], a[12:15]
v_cvt_pk_bf16_f32 v234, v236, v237
v_cvt_pk_bf16_f32 v235, v238, v239
M a[12:15], a[120:123], a[184:187], a[12:15]
v_cvt_pk_bf16_f32 v240, v240, v241
v_cvt_pk_bf16_f32 v241, v242, v243
M a[16:19], a[128:131], a[184:187], a[16:19]
v_cvt_pk_bf16_f32 v242, v244, v245
v_cvt_pk_bf16_f32 v243, v246, v247
M a[16:19], a[132:135], a[188:191], a[16:19]
buffer_load_dwordx4 v5, s[8:11], s23 offen offset:3072 lds
v_cvt_pk_bf16_f32 v248, v248, v249
v_cvt_pk_bf16_f32 v249, v250, v251
M a[20:23], a[140:143], a[188:191], a[20:23]
v_cvt_pk_bf16_f32 v250, v252, v253
v_cvt_pk_bf16_f32 v251, v254, v255
M a[20:23], a[136:139], a[184:187], a[20:23]
M a[24:27], a[144:147], a[184:187], a[24:27]
s_add_u32 s94, s92, 8192
buffer_store_dwordx4 v[104:107], v1, s[16:19], s94 offen offset:1024 sc1
v_accvgpr_write_b32 a240, v224
v_accvgpr_write_b32 a241, v225
v_accvgpr_write_b32 a242, v226
v_accvgpr_write_b32 a243, v227
M a[24:27], a[148:151], a[188:191], a[24:27]
v_accvgpr_write_b32 a244, v232
v_accvgpr_write_b32 a245, v233
v_accvgpr_write_b32 a246, v234
v_accvgpr_write_b32 a247, v235
M a[28:31], a[156:159], a[188:191], a[28:31]
v_accvgpr_write_b32 a248, v240
v_accvgpr_write_b32 a249, v241
v_accvgpr_write_b32 a250, v242
v_accvgpr_write_b32 a251, v243
M a[28:31], a[152:155], a[184:187], a[28:31]
s_waitcnt lgkmcnt(2)
v_accvgpr_write_b32 a252, v248
v_accvgpr_write_b32 a253, v249
v_accvgpr_write_b32 a254, v250
v_accvgpr_write_b32 a255, v251
M v[32:35], a[160:163], a[32:35], 0
s_add_u32 m0, s29, 65536
s_nop 0
buffer_load_dwordx4 v6, s[12:15], s24 offen offset:0 lds
M v[32:35], a[164:167], a[36:39], v[32:35]
ds_read_b128 a[176:179], v10 offset:4096
ds_read_b128 a[180:183], v11 offset:4096
M v[36:39], a[164:167], a[44:47], 0
M v[36:39], a[160:163], a[40:43], v[36:39]
ds_read_b64_tr_b16 a[96:97], v12 offset:32768
ds_read_b64_tr_b16 a[98:99], v12 offset:34816
M v[40:43], a[160:163], a[48:51], 0
M v[40:43], a[164:167], a[52:55], v[40:43]
M v[44:47], a[164:167], a[60:63], 0
buffer_load_dwordx4 v7, s[12:15], s24 offen offset:1024 lds
M v[44:47], a[160:163], a[56:59], v[44:47]
ds_read_b64_tr_b16 a[104:105], v13 offset:32768
ds_read_b64_tr_b16 a[106:107], v13 offset:34816
M v[48:51], a[160:163], a[64:67], 0
s_add_u32 s94, s92, 8192
buffer_store_dwordx4 v[112:115], v1, s[16:19], s94 offen offset:2048 sc1
M v[48:51], a[164:167], a[68:71], v[48:51]
M v[52:55], a[164:167], a[76:79], 0
M v[52:55], a[160:163], a[72:75], v[52:55]
ds_read_b64_tr_b16 a[112:113], v14 offset:32768
ds_read_b64_tr_b16 a[114:115], v14 offset:34816
M v[56:59], a[160:163], a[80:83], 0
M v[56:59], a[164:167], a[84:87], v[56:59]
M v[60:63], a[164:167], a[92:95], 0
buffer_load_dwordx4 v8, s[12:15], s24 offen offset:2048 lds
M v[60:63], a[160:163], a[88:91], v[60:63]
s_waitcnt lgkmcnt(8)
ds_read_b64_tr_b16 a[120:121], v15 offset:32768
ds_read_b64_tr_b16 a[122:123], v15 offset:34816
M v[64:67], a[168:171], a[32:35], 0
M v[64:67], a[172:175], a[36:39], v[64:67]
ds_read_b128 a[184:187], v10 offset:6144
ds_read_b128 a[188:191], v11 offset:6144
M v[68:71], a[172:175], a[44:47], 0
s_add_u32 s94, s92, 8192
buffer_store_dwordx4 v[120:123], v1, s[16:19], s94 offen offset:3072 sc1
M v[68:71], a[168:171], a[40:43], v[68:71]
ds_read_b64_tr_b16 a[128:129], v16 offset:32768
ds_read_b64_tr_b16 a[130:131], v16 offset:34816
M v[72:75], a[168:171], a[48:51], 0
v_accvgpr_read_b32 v24, a0
v_accvgpr_read_b32 v25, a1
M v[72:75], a[172:175], a[52:55], v[72:75]
v_accvgpr_read_b32 v26, a2
v_accvgpr_read_b32 v27, a3
M v[76:79], a[172:175], a[60:63], 0
v_accvgpr_read_b32 v28, a4
v_accvgpr_read_b32 v29, a5
M v[76:79], a[168:171], a[56:59], v[76:79]
ds_read_b64_tr_b16 a[136:137], v17 offset:32768
ds_read_b64_tr_b16 a[138:139], v17 offset:34816
v_accvgpr_read_b32 v30, a6
v_accvgpr_read_b32 v31, a7
M v[80:83], a[168:171], a[64:67], 0
buffer_load_dwordx4 v9, s[12:15], s24 offen offset:3072 lds
v_cvt_pk_bf16_f32 v24, v24, v25
v_cvt_pk_bf16_f32 v25, v26, v27
M v[80:83], a[172:175], a[68:71], v[80:83]
v_cvt_pk_bf16_f32 v26, v28, v29
v_cvt_pk_bf16_f32 v27, v30, v31
M v[84:87], a[172:175], a[76:79], 0
M v[84:87], a[168:171], a[72:75], v[84:87]
ds_read_b64_tr_b16 a[144:145], v18 offset:32768
ds_read_b64_tr_b16 a[146:147], v18 offset:34816
M v[88:91], a[168:171], a[80:83], 0
M v[88:91], a[172:175], a[84:87], v[88:91]
s_add_u32 s94, s93, 12288
buffer_store_dwordx4 v[24:27], v1, s[16:19], s94 offen offset:0 sc1
M v[92:95], a[172:175], a[92:95], 0
M v[92:95], a[168:171], a[88:91], v[92:95]
s_waitcnt lgkmcnt(15)
ds_read_b64_tr_b16 a[152:153], v19 offset:32768
ds_read_b64_tr_b16 a[154:155], v19 offset:34816
M v[96:99], a[176:179], a[32:35], 0
s_add_u32 s24, s24, 262144
M v[96:99], a[180:183], a[36:39], v[96:99]
M v[100:103], a[180:183], a[44:47], 0
M v[100:103], a[176:179], a[40:43], v[100:103]
M v[104:107], a[176:179], a[48:51], 0
M v[104:107], a[180:183], a[52:55], v[104:107]
M v[108:111], a[180:183], a[60:63], 0
M v[108:111], a[176:179], a[56:59], v[108:111]
s_waitcnt vmcnt(15) lgkmcnt(0)
s_barrier
ds_read_b128 a[160:163], v10 offset:16384
ds_read_b128 a[164:167], v11 offset:16384
M v[112:115], a[176:179], a[64:67], 0
s_add_u32 m0, s29, 49152
s_add_u32 s3, s23, s31
buffer_load_dwordx4 v2, s[8:11], s3 offen offset:0 lds
M v[112:115], a[180:183], a[68:71], v[112:115]
M v[116:119], a[180:183], a[76:79], 0
M v[116:119], a[176:179], a[72:75], v[116:119]
ds_read_b64_tr_b16 a[100:101], v12 offset:49152
ds_read_b64_tr_b16 a[102:103], v12 offset:51200
M v[120:123], a[176:179], a[80:83], 0
v_accvgpr_read_b32 v24, a8
v_accvgpr_read_b32 v25, a9
M v[120:123], a[180:183], a[84:87], v[120:123]
buffer_load_dwordx4 v3, s[8:11], s3 offen offset:1024 lds
v_accvgpr_read_b32 v26, a10
v_accvgpr_read_b32 v27, a11
M v[124:127], a[180:183], a[92:95], 0
v_accvgpr_read_b32 v28, a12
v_accvgpr_read_b32 v29, a13
M v[124:127], a[176:179], a[88:91], v[124:127]
v_accvgpr_read_b32 v30, a14
v_accvgpr_read_b32 v31, a15
M v[128:131], a[184:187], a[32:35], 0
v_cvt_pk_bf16_f32 v24, v24, v25
v_cvt_pk_bf16_f32 v25, v26, v27
M v[128:131], a[188:191], a[36:39], v[128:131]
ds_read_b128 a[168:171], v10 offset:18432
ds_read_b128 a[172:175], v11 offset:18432
ds_read_b64_tr_b16 a[108:109], v13 offset:49152
ds_read_b64_tr_b16 a[110:111], v13 offset:51200
v_cvt_pk_bf16_f32 v26, v28, v29
v_cvt_pk_bf16_f32 v27, v30, v31
M v[132:135], a[188:191], a[44:47], 0
M v[132:135], a[184:187], a[40:43], v[132:135]
M v[136:139], a[184:187], a[48:51], 0
buffer_load_dwordx4 v4, s[8:11], s3 offen offset:2048 lds
M v[136:139], a[188:191], a[52:55], v[136:139]
s_add_u32 s94, s93, 12288
buffer_store_dwordx4 v[24:27], v1, s[16:19], s94 offen offset:1024 sc1
M v[140:143], a[188:191], a[60:63], 0
M v[140:143], a[184:187], a[56:59], v[140:143]
ds_read_b64_tr_b16 a[116:117], v14 offset:49152
ds_read_b64_tr_b16 a[118:119], v14 offset:51200
M v[144:147], a[184:187], a[64:67], 0
M v[144:147], a[188:191], a[68:71], v[144:147]
M v[148:151], a[188:191], a[76:79], 0
buffer_load_dwordx4 v5, s[8:11], s3 offen offset:3072 lds
M v[148:151], a[184:187], a[72:75], v[148:151]
M v[152:155], a[184:187], a[80:83], 0
M v[152:155], a[188:191], a[84:87], v[152:155]
ds_read_b64_tr_b16 a[124:125], v15 offset:49152
ds_read_b64_tr_b16 a[126:127], v15 offset:51200
M v[156:159], a[188:191], a[92:95], 0
M v[156:159], a[184:187], a[88:91], v[156:159]
s_waitcnt lgkmcnt(10)
M v[160:163], a[160:163], a[32:35], 0
M v[160:163], a[164:167], a[36:39], v[160:163]
ds_read_b128 a[176:179], v10 offset:20480
ds_read_b128 a[180:183], v11 offset:20480
M v[164:167], a[164:167], a[44:47], 0
s_add_u32 s23, s23, 128
s_cmp_eq_u32 s23, s25
s_cselect_b32 s23, s26, s23
M v[164:167], a[160:163], a[40:43], v[164:167]
ds_read_b64_tr_b16 a[132:133], v16 offset:49152
ds_read_b64_tr_b16 a[134:135], v16 offset:51200
M v[168:171], a[160:163], a[48:51], 0
v_accvgpr_read_b32 v24, a16
v_accvgpr_read_b32 v25, a17
M v[168:171], a[164:167], a[52:55], v[168:171]
v_accvgpr_read_b32 v26, a18
v_accvgpr_read_b32 v27, a19
M v[172:175], a[164:167], a[60:63], 0
v_accvgpr_read_b32 v28, a20
v_accvgpr_read_b32 v29, a21
M v[172:175], a[160:163], a[56:59], v[172:175]
v_accvgpr_read_b32 v30, a22
v_accvgpr_read_b32 v31, a23
M v[176:179], a[160:163], a[64:67], 0
s_add_u32 m0, s29, 81920
s_nop 0
buffer_load_dwordx4 v6, s[12:15], s24 offen offset:0 lds
v_cvt_pk_bf16_f32 v24, v24, v25
v_cvt_pk_bf16_f32 v25, v26, v27
M v[176:179], a[164:167], a[68:71], v[176:179]
ds_read_b64_tr_b16 a[140:141], v17 offset:49152
ds_read_b64_tr_b16 a[142:143], v17 offset:51200
v_cvt_pk_bf16_f32 v26, v28, v29
v_cvt_pk_bf16_f32 v27, v30, v31
M v[180:183], a[164:167], a[76:79], 0
M v[180:183], a[160:163], a[72:75], v[180:183]
M v[184:187], a[160:163], a[80:83], 0
M v[184:187], a[164:167], a[84:87], v[184:187]
s_add_u32 s94, s93, 12288
buffer_store_dwordx4 v[24:27], v1, s[16:19], s94 offen offset:2048 sc1
M v[188:191], a[164:167], a[92:95], 0
buffer_load_dwordx4 v7, s[12:15], s24 offen offset:1024 lds
M v[188:191], a[160:163], a[88:91], v[188:191]
s_waitcnt lgkmcnt(12)
ds_read_b64_tr_b16 a[148:149], v18 offset:49152
ds_read_b64_tr_b16 a[150:151], v18 offset:51200
M v[192:195], a[168:171], a[32:35], 0
M v[192:195], a[172:175], a[36:39], v[192:195]
ds_read_b128 a[184:187], v10 offset:22528
ds_read_b128 a[188:191], v11 offset:22528
M v[196:199], a[172:175], a[44:47], 0
M v[196:199], a[168:171], a[40:43], v[196:199]
M v[200:203], a[168:171], a[48:51], 0
M v[200:203], a[172:175], a[52:55], v[200:203]
ds_read_b64_tr_b16 a[156:157], v19 offset:49152
ds_read_b64_tr_b16 a[158:159], v19 offset:51200
M v[204:207], a[172:175], a[60:63], 0
buffer_load_dwordx4 v8, s[12:15], s24 offen offset:2048 lds
M v[204:207], a[168:171], a[56:59], v[204:207]
M v[208:211], a[168:171], a[64:67], 0
M v[208:211], a[172:175], a[68:71], v[208:211]
M v[212:215], a[172:175], a[76:79], 0
buffer_load_dwordx4 v9, s[12:15], s24 offen offset:3072 lds
M v[212:215], a[168:171], a[72:75], v[212:215]
M v[216:219], a[168:171], a[80:83], 0
v_accvgpr_read_b32 v24, a24
v_accvgpr_read_b32 v25, a25
M v[216:219], a[172:175], a[84:87], v[216:219]
v_accvgpr_read_b32 v26, a26
v_accvgpr_read_b32 v27, a27
M v[220:223], a[172:175], a[92:95], 0
v_accvgpr_read_b32 v28, a28
v_accvgpr_read_b32 v29, a29
M v[220:223], a[168:171], a[88:91], v[220:223]
s_waitcnt lgkmcnt(10)
v_accvgpr_read_b32 v30, a30
v_accvgpr_read_b32 v31, a31
M v[224:227], a[176:179], a[32:35], 0
s_add_u32 s24, s24, 262144
s_cmp_eq_u32 s24, s27
s_cselect_b32 s24, s28, s24
s_sub_u32 s6, s6, 1
s_cmp_eq_u32 s6, 0
s_cselect_b64 s[12:13], s[64:65], s[12:13]
v_cvt_pk_bf16_f32 v24, v24, v25
v_cvt_pk_bf16_f32 v25, v26, v27
M v[224:227], a[180:183], a[36:39], v[224:227]
v_cvt_pk_bf16_f32 v26, v28, v29
v_cvt_pk_bf16_f32 v27, v30, v31
M v[228:231], a[180:183], a[44:47], 0
M v[228:231], a[176:179], a[40:43], v[228:231]
M v[232:235], a[176:179], a[48:51], 0
M v[232:235], a[180:183], a[52:55], v[232:235]
s_add_u32 s94, s93, 12288
buffer_store_dwordx4 v[24:27], v1, s[16:19], s94 offen offset:3072 sc1
M v[236:239], a[180:183], a[60:63], 0
M v[236:239], a[176:179], a[56:59], v[236:239]
s_waitcnt vmcnt(12) lgkmcnt(0)
s_barrier
ds_read_b128 a[160:163], v10 offset:32768
ds_read_b128 a[164:167], v11 offset:32768
M v[240:243], a[176:179], a[64:67], 0
s_add_u32 m0, s29, 0
s_nop 0
buffer_load_dwordx4 v2, s[8:11], s23 offen offset:0 lds
M v[240:243], a[180:183], a[68:71], v[240:243]
M v[244:247], a[180:183], a[76:79], 0
M v[244:247], a[176:179], a[72:75], v[244:247]
M v[248:251], a[176:179], a[80:83], 0
M v[248:251], a[180:183], a[84:87], v[248:251]
buffer_load_dwordx4 v3, s[8:11], s23 offen offset:1024 lds
M v[252:255], a[180:183], a[92:95], 0
M v[252:255], a[176:179], a[88:91], v[252:255]
M a[0:3], a[184:187], a[32:35], 0
M a[0:3], a[188:191], a[36:39], a[0:3]
ds_read_b128 a[168:171], v10 offset:34816
ds_read_b128 a[172:175], v11 offset:34816
M a[4:7], a[188:191], a[44:47], 0
M a[4:7], a[184:187], a[40:43], a[4:7]
M a[8:11], a[184:187], a[48:51], 0
buffer_load_dwordx4 v4, s[8:11], s23 offen offset:2048 lds
M a[8:11], a[188:191], a[52:55], a[8:11]
M a[12:15], a[188:191], a[60:63], 0
M a[12:15], a[184:187], a[56:59], a[12:15]
M a[16:19], a[184:187], a[64:67], 0
M a[16:19], a[188:191], a[68:71], a[16:19]
buffer_load_dwordx4 v5, s[8:11], s23 offen offset:3072 lds
M a[20:23], a[188:191], a[76:79], 0
M a[20:23], a[184:187], a[72:75], a[20:23]
M a[24:27], a[184:187], a[80:83], 0
M a[24:27], a[188:191], a[84:87], a[24:27]
M a[28:31], a[188:191], a[92:95], 0
M a[28:31], a[184:187], a[88:91], a[28:31]
s_waitcnt lgkmcnt(2)
M v[32:35], a[160:163], a[96:99], v[32:35]
s_add_u32 m0, s29, 98304
s_nop 0
buffer_load_dwordx4 v6, s[12:15], s24 offen offset:0 lds
M v[32:35], a[164:167], a[100:103], v[32:35]
ds_read_b128 a[176:179], v10 offset:36864
ds_read_b128 a[180:183], v11 offset:36864
M v[36:39], a[164:167], a[108:111], v[36:39]
M v[36:39], a[160:163], a[104:107], v[36:39]
ds_read_b64_tr_b16 a[32:33], v12 offset:0
ds_read_b64_tr_b16 a[34:35], v12 offset:2048
M v[40:43], a[160:163], a[112:115], v[40:43]
M v[40:43], a[164:167], a[116:119], v[40:43]
M v[44:47], a[164:167], a[124:127], v[44:47]
M v[44:47], a[160:163], a[120:123], v[44:47]
ds_read_b64_tr_b16 a[40:41], v13 offset:0
ds_read_b64_tr_b16 a[42:43], v13 offset:2048
M v[48:51], a[160:163], a[128:131], v[48:51]
s_add_u32 s94, s92, 12288
buffer_store_dwordx4 a[192:195], v1, s[16:19], s94 offen offset:0 sc1
M v[48:51], a[164:167], a[132:135], v[48:51]
buffer_load_dwordx4 v7, s[12:15], s24 offen offset:1024 lds
M v[52:55], a[164:167], a[140:143], v[52:55]
M v[52:55], a[160:163], a[136:139], v[52:55]
ds_read_b64_tr_b16 a[48:49], v14 offset:0
ds_read_b64_tr_b16 a[50:51], v14 offset:2048
M v[56:59], a[160:163], a[144:147], v[56:59]
M v[56:59], a[164:167], a[148:151], v[56:59]
M v[60:63], a[164:167], a[156:159], v[60:63]
M v[60:63], a[160:163], a[152:155], v[60:63]
s_waitcnt lgkmcnt(8)
ds_read_b64_tr_b16 a[56:57], v15 offset:0
ds_read_b64_tr_b16 a[58:59], v15 offset:2048
M v[64:67], a[168:171], a[96:99], v[64:67]
buffer_load_dwordx4 v8, s[12:15], s24 offen offset:2048 lds
M v[64:67], a[172:175], a[100:103], v[64:67]
ds_read_b128 a[184:187], v10 offset:38912
ds_read_b128 a[188:191], v11 offset:38912
M v[68:71], a[172:175], a[108:111], v[68:71]
M v[68:71], a[168:171], a[104:107], v[68:71]
ds_read_b64_tr_b16 a[64:65], v16 offset:0
ds_read_b64_tr_b16 a[66:67], v16 offset:2048
M v[72:75], a[168:171], a[112:115], v[72:75]
M v[72:75], a[172:175], a[116:119], v[72:75]
M v[76:79], a[172:175], a[124:127], v[76:79]
M v[76:79], a[168:171], a[120:123], v[76:79]
ds_read_b64_tr_b16 a[72:73], v17 offset:0
ds_read_b64_tr_b16 a[74:75], v17 offset:2048
M v[80:83], a[168:171], a[128:131], v[80:83]
buffer_load_dwordx4 v9, s[12:15], s24 offen offset:3072 lds
M v[80:83], a[172:175], a[132:135], v[80:83]
M v[84:87], a[172:175], a[140:143], v[84:87]
M v[84:87], a[168:171], a[136:139], v[84:87]
ds_read_b64_tr_b16 a[80:81], v18 offset:0
ds_read_b64_tr_b16 a[82:83], v18 offset:2048
M v[88:91], a[168:171], a[144:147], v[88:91]
M v[88:91], a[172:175], a[148:151], v[88:91]
M v[92:95], a[172:175], a[156:159], v[92:95]
s_add_u32 s24, s24, 262144
M v[92:95], a[168:171], a[152:155], v[92:95]
s_waitcnt lgkmcnt(15)
ds_read_b64_tr_b16 a[88:89], v19 offset:0
ds_read_b64_tr_b16 a[90:91], v19 offset:2048
M v[96:99], a[176:179], a[96:99], v[96:99]
M v[96:99], a[180:183], a[100:103], v[96:99]
M v[100:103], a[180:183], a[108:111], v[100:103]
M v[100:103], a[176:179], a[104:107], v[100:103]
M v[104:107], a[176:179], a[112:115], v[104:107]
s_add_u32 s94, s92, 12288
buffer_store_dwordx4 a[196:199], v1, s[16:19], s94 offen offset:1024 sc1
M v[104:107], a[180:183], a[116:119], v[104:107]
M v[108:111], a[180:183], a[124:127], v[108:111]
M v[108:111], a[176:179], a[120:123], v[108:111]
s_waitcnt vmcnt(11) lgkmcnt(0)
s_barrier
ds_read_b128 a[160:163], v10 offset:49152
ds_read_b128 a[164:167], v11 offset:49152
M v[112:115], a[176:179], a[128:131], v[112:115]
s_add_u32 m0, s29, 16384
s_add_u32 s3, s23, s31
buffer_load_dwordx4 v2, s[8:11], s3 offen offset:0 lds
M v[112:115], a[180:183], a[132:135], v[112:115]
M v[116:119], a[180:183], a[140:143], v[116:119]
M v[116:119], a[176:179], a[136:139], v[116:119]
ds_read_b64_tr_b16 a[36:37], v12 offset:16384
ds_read_b64_tr_b16 a[38:39], v12 offset:18432
M v[120:123], a[176:179], a[144:147], v[120:123]
M v[120:123], a[180:183], a[148:151], v[120:123]
buffer_load_dwordx4 v3, s[8:11], s3 offen offset:1024 lds
M v[124:127], a[180:183], a[156:159], v[124:127]
M v[124:127], a[176:179], a[152:155], v[124:127]
M v[128:131], a[184:187], a[96:99], v[128:131]
M v[128:131], a[188:191], a[100:103], v[128:131]
ds_read_b128 a[168:171], v10 offset:51200
ds_read_b128 a[172:175], v11 offset:51200
ds_read_b64_tr_b16 a[44:45], v13 offset:16384
ds_read_b64_tr_b16 a[46:47], v13 offset:18432
M v[132:135], a[188:191], a[108:111], v[132:135]
M v[132:135], a[184:187], a[104:107], v[132:135]
M v[136:139], a[184:187], a[112:115], v[136:139]
buffer_load_dwordx4 v4, s[8:11], s3 offen offset:2048 lds
M v[136:139], a[188:191], a[116:119], v[136:139]
M v[140:143], a[188:191], a[124:127], v[140:143]
M v[140:143], a[184:187], a[120:123], v[140:143]
ds_read_b64_tr_b16 a[52:53], v14 offset:16384
ds_read_b64_tr_b16 a[54:55], v14 offset:18432
M v[144:147], a[184:187], a[128:131], v[144:147]
M v[144:147], a[188:191], a[132:135], v[144:147]
buffer_load_dwordx4 v5, s[8:11], s3 offen offset:3072 lds
M v[148:151], a[188:191], a[140:143], v[148:151]
M v[148:151], a[184:187], a[136:139], v[148:151]
M v[152:155], a[184:187], a[144:147], v[152:155]
M v[152:155], a[188:191], a[148:151], v[152:155]
ds_read_b64_tr_b16 a[60:61], v15 offset:16384
ds_read_b64_tr_b16 a[62:63], v15 offset:18432
M v[156:159], a[188:191], a[156:159], v[156:159]
M v[156:159], a[184:187], a[152:155], v[156:159]
s_waitcnt lgkmcnt(10)
M v[160:163], a[160:163], a[96:99], v[160:163]
s_add_u32 s94, s92, 12288
buffer_store_dwordx4 a[200:203], v1, s[16:19], s94 offen offset:2048 sc1
M v[160:163], a[164:167], a[100:103], v[160:163]
ds_read_b128 a[176:179], v10 offset:53248
ds_read_b128 a[180:183], v11 offset:53248
M v[164:167], a[164:167], a[108:111], v[164:167]
s_add_u32 s23, s23, 128
s_cmp_eq_u32 s23, s25
s_cselect_b32 s23, s26, s23
M v[164:167], a[160:163], a[104:107], v[164:167]
ds_read_b64_tr_b16 a[68:69], v16 offset:16384
ds_read_b64_tr_b16 a[70:71], v16 offset:18432
M v[168:171], a[160:163], a[112:115], v[168:171]
M v[168:171], a[164:167], a[116:119], v[168:171]
M v[172:175], a[164:167], a[124:127], v[172:175]
M v[172:175], a[160:163], a[120:123], v[172:175]
M v[176:179], a[160:163], a[128:131], v[176:179]
s_add_u32 m0, s29, 114688
s_nop 0
buffer_load_dwordx4 v6, s[12:15], s24 offen offset:0 lds
M v[176:179], a[164:167], a[132:135], v[176:179]
ds_read_b64_tr_b16 a[76:77], v17 offset:16384
ds_read_b64_tr_b16 a[78:79], v17 offset:18432
M v[180:183], a[164:167], a[140:143], v[180:183]
M v[180:183], a[160:163], a[136:139], v[180:183]
M v[184:187], a[160:163], a[144:147], v[184:187]
M v[184:187], a[164:167], a[148:151], v[184:187]
buffer_load_dwordx4 v7, s[12:15], s24 offen offset:1024 lds
M v[188:191], a[164:167], a[156:159], v[188:191]
M v[188:191], a[160:163], a[152:155], v[188:191]
s_waitcnt lgkmcnt(12)
ds_read_b64_tr_b16 a[84:85], v18 offset:16384
ds_read_b64_tr_b16 a[86:87], v18 offset:18432
M v[192:195], a[168:171], a[96:99], v[192:195]
M v[192:195], a[172:175], a[100:103], v[192:195]
ds_read_b128 a[184:187], v10 offset:55296
ds_read_b128 a[188:191], v11 offset:55296
M v[196:199], a[172:175], a[108:111], v[196:199]
M v[196:199], a[168:171], a[104:107], v[196:199]
M v[200:203], a[168:171], a[112:115], v[200:203]
buffer_load_dwordx4 v8, s[12:15], s24 offen offset:2048 lds
M v[200:203], a[172:175], a[116:119], v[200:203]
ds_read_b64_tr_b16 a[92:93], v19 offset:16384
ds_read_b64_tr_b16 a[94:95], v19 offset:18432
M v[204:207], a[172:175], a[124:127], v[204:207]
M v[204:207], a[168:171], a[120:123], v[204:207]
M v[208:211], a[168:171], a[128:131], v[208:211]
M v[208:211], a[172:175], a[132:135], v[208:211]
buffer_load_dwordx4 v9, s[12:15], s24 offen offset:3072 lds
M v[212:215], a[172:175], a[140:143], v[212:215]
M v[212:215], a[168:171], a[136:139], v[212:215]
M v[216:219], a[168:171], a[144:147], v[216:219]
s_add_u32 s94, s92, 12288
buffer_store_dwordx4 a[204:207], v1, s[16:19], s94 offen offset:3072 sc1
M v[216:219], a[172:175], a[148:151], v[216:219]
M v[220:223], a[172:175], a[156:159], v[220:223]
M v[220:223], a[168:171], a[152:155], v[220:223]
s_waitcnt lgkmcnt(10)
M v[224:227], a[176:179], a[96:99], v[224:227]
s_add_u32 s24, s24, 262144
s_cmp_eq_u32 s24, s27
s_cselect_b32 s24, s28, s24
s_sub_u32 s6, s6, 1
s_cmp_eq_u32 s6, 0
s_cselect_b64 s[12:13], s[64:65], s[12:13]
M v[224:227], a[180:183], a[100:103], v[224:227]
M v[228:231], a[180:183], a[108:111], v[228:231]
M v[228:231], a[176:179], a[104:107], v[228:231]
M v[232:235], a[176:179], a[112:115], v[232:235]
M v[232:235], a[180:183], a[116:119], v[232:235]
M v[236:239], a[180:183], a[124:127], v[236:239]
M v[236:239], a[176:179], a[120:123], v[236:239]
s_waitcnt vmcnt(11) lgkmcnt(0)
s_barrier
ds_read_b128 a[160:163], v10 offset:0
ds_read_b128 a[164:167], v11 offset:0
M v[240:243], a[176:179], a[128:131], v[240:243]
s_add_u32 m0, s29, 32768
s_nop 0
buffer_load_dwordx4 v2, s[8:11], s23 offen offset:0 lds
M v[240:243], a[180:183], a[132:135], v[240:243]
M v[244:247], a[180:183], a[140:143], v[244:247]
M v[244:247], a[176:179], a[136:139], v[244:247]
M v[248:251], a[176:179], a[144:147], v[248:251]
M v[248:251], a[180:183], a[148:151], v[248:251]
buffer_load_dwordx4 v3, s[8:11], s23 offen offset:1024 lds
M v[252:255], a[180:183], a[156:159], v[252:255]
M v[252:255], a[176:179], a[152:155], v[252:255]
M a[0:3], a[184:187], a[96:99], a[0:3]
M a[0:3], a[188:191], a[100:103], a[0:3]
ds_read_b128 a[168:171], v10 offset:2048
ds_read_b128 a[172:175], v11 offset:2048
M a[4:7], a[188:191], a[108:111], a[4:7]
M a[4:7], a[184:187], a[104:107], a[4:7]
M a[8:11], a[184:187], a[112:115], a[8:11]
buffer_load_dwordx4 v4, s[8:11], s23 offen offset:2048 lds
M a[8:11], a[188:191], a[116:119], a[8:11]
M a[12:15], a[188:191], a[124:127], a[12:15]
M a[12:15], a[184:187], a[120:123], a[12:15]
M a[16:19], a[184:187], a[128:131], a[16:19]
M a[16:19], a[188:191], a[132:135], a[16:19]
buffer_load_dwordx4 v5, s[8:11], s23 offen offset:3072 lds
M a[20:23], a[188:191], a[140:143], a[20:23]
M a[20:23], a[184:187], a[136:139], a[20:23]
M a[24:27], a[184:187], a[144:147], a[24:27]
M a[24:27], a[188:191], a[148:151], a[24:27]
M a[28:31], a[188:191], a[156:159], a[28:31]
M a[28:31], a[184:187], a[152:155], a[28:31]
s_waitcnt lgkmcnt(2)
M v[32:35], a[160:163], a[32:35], v[32:35]
s_add_u32 m0, s29, 65536
s_nop 0
buffer_load_dwordx4 v6, s[12:15], s24 offen offset:0 lds
M v[32:35], a[164:167], a[36:39], v[32:35]
ds_read_b128 a[176:179], v10 offset:4096
ds_read_b128 a[180:183], v11 offset:4096
M v[36:39], a[164:167], a[44:47], v[36:39]
M v[36:39], a[160:163], a[40:43], v[36:39]
ds_read_b64_tr_b16 a[96:97], v12 offset:32768
ds_read_b64_tr_b16 a[98:99], v12 offset:34816
M v[40:43], a[160:163], a[48:51], v[40:43]
M v[40:43], a[164:167], a[52:55], v[40:43]
M v[44:47], a[164:167], a[60:63], v[44:47]
M v[44:47], a[160:163], a[56:59], v[44:47]
ds_read_b64_tr_b16 a[104:105], v13 offset:32768
ds_read_b64_tr_b16 a[106:107], v13 offset:34816
M v[48:51], a[160:163], a[64:67], v[48:51]
s_add_u32 s94, s93, 0
buffer_store_dwordx4 a[208:211], v1, s[16:19], s94 offen offset:0 sc1
M v[48:51], a[164:167], a[68:71], v[48:51]
buffer_load_dwordx4 v7, s[12:15], s24 offen offset:1024 lds
M v[52:55], a[164:167], a[76:79], v[52:55]
M v[52:55], a[160:163], a[72:75], v[52:55]
ds_read_b64_tr_b16 a[112:113], v14 offset:32768
ds_read_b64_tr_b16 a[114:115], v14 offset:34816
M v[56:59], a[160:163], a[80:83], v[56:59]
M v[56:59], a[164:167], a[84:87], v[56:59]
M v[60:63], a[164:167], a[92:95], v[60:63]
M v[60:63], a[160:163], a[88:91], v[60:63]
s_waitcnt lgkmcnt(8)
ds_read_b64_tr_b16 a[120:121], v15 offset:32768
ds_read_b64_tr_b16 a[122:123], v15 offset:34816
M v[64:67], a[168:171], a[32:35], v[64:67]
buffer_load_dwordx4 v8, s[12:15], s24 offen offset:2048 lds
M v[64:67], a[172:175], a[36:39], v[64:67]
ds_read_b128 a[184:187], v10 offset:6144
ds_read_b128 a[188:191], v11 offset:6144
M v[68:71], a[172:175], a[44:47], v[68:71]
M v[68:71], a[168:171], a[40:43], v[68:71]
ds_read_b64_tr_b16 a[128:129], v16 offset:32768
ds_read_b64_tr_b16 a[130:131], v16 offset:34816
M v[72:75], a[168:171], a[48:51], v[72:75]
M v[72:75], a[172:175], a[52:55], v[72:75]
M v[76:79], a[172:175], a[60:63], v[76:79]
M v[76:79], a[168:171], a[56:59], v[76:79]
ds_read_b64_tr_b16 a[136:137], v17 offset:32768
ds_read_b64_tr_b16 a[138:139], v17 offset:34816
M v[80:83], a[168:171], a[64:67], v[80:83]
buffer_load_dwordx4 v9, s[12:15], s24 offen offset:3072 lds
M v[80:83], a[172:175], a[68:71], v[80:83]
M v[84:87], a[172:175], a[76:79], v[84:87]
M v[84:87], a[168:171], a[72:75], v[84:87]
ds_read_b64_tr_b16 a[144:145], v18 offset:32768
ds_read_b64_tr_b16 a[146:147], v18 offset:34816
M v[88:91], a[168:171], a[80:83], v[88:91]
M v[88:91], a[172:175], a[84:87], v[88:91]
M v[92:95], a[172:175], a[92:95], v[92:95]
s_add_u32 s24, s24, 262144
M v[92:95], a[168:171], a[88:91], v[92:95]
s_waitcnt lgkmcnt(15)
ds_read_b64_tr_b16 a[152:153], v19 offset:32768
ds_read_b64_tr_b16 a[154:155], v19 offset:34816
M v[96:99], a[176:179], a[32:35], v[96:99]
M v[96:99], a[180:183], a[36:39], v[96:99]
M v[100:103], a[180:183], a[44:47], v[100:103]
M v[100:103], a[176:179], a[40:43], v[100:103]
M v[104:107], a[176:179], a[48:51], v[104:107]
s_add_u32 s94, s93, 0
buffer_store_dwordx4 a[212:215], v1, s[16:19], s94 offen offset:1024 sc1
M v[104:107], a[180:183], a[52:55], v[104:107]
M v[108:111], a[180:183], a[60:63], v[108:111]
M v[108:111], a[176:179], a[56:59], v[108:111]
s_waitcnt vmcnt(11) lgkmcnt(0)
s_barrier
ds_read_b128 a[160:163], v10 offset:16384
ds_read_b128 a[164:167], v11 offset:16384
M v[112:115], a[176:179], a[64:67], v[112:115]
s_add_u32 m0, s29, 49152
s_add_u32 s3, s23, s31
buffer_load_dwordx4 v2, s[8:11], s3 offen offset:0 lds
M v[112:115], a[180:183], a[68:71], v[112:115]
M v[116:119], a[180:183], a[76:79], v[116:119]
M v[116:119], a[176:179], a[72:75], v[116:119]
ds_read_b64_tr_b16 a[100:101], v12 offset:49152
ds_read_b64_tr_b16 a[102:103], v12 offset:51200
M v[120:123], a[176:179], a[80:83], v[120:123]
M v[120:123], a[180:183], a[84:87], v[120:123]
buffer_load_dwordx4 v3, s[8:11], s3 offen offset:1024 lds
M v[124:127], a[180:183], a[92:95], v[124:127]
M v[124:127], a[176:179], a[88:91], v[124:127]
M v[128:131], a[184:187], a[32:35], v[128:131]
M v[128:131], a[188:191], a[36:39], v[128:131]
ds_read_b128 a[168:171], v10 offset:18432
ds_read_b128 a[172:175], v11 offset:18432
ds_read_b64_tr_b16 a[108:109], v13 offset:49152
ds_read_b64_tr_b16 a[110:111], v13 offset:51200
M v[132:135], a[188:191], a[44:47], v[132:135]
M v[132:135], a[184:187], a[40:43], v[132:135]
M v[136:139], a[184:187], a[48:51], v[136:139]
buffer_load_dwordx4 v4, s[8:11], s3 offen offset:2048 lds
M v[136:139], a[188:191], a[52:55], v[136:139]
M v[140:143], a[188:191], a[60:63], v[140:143]
M v[140:143], a[184:187], a[56:59], v[140:143]
ds_read_b64_tr_b16 a[116:117], v14 offset:49152
ds_read_b64_tr_b16 a[118:119], v14 offset:51200
M v[144:147], a[184:187], a[64:67], v[144:147]
M v[144:147], a[188:191], a[68:71], v[144:147]
buffer_load_dwordx4 v5, s[8:11], s3 offen offset:3072 lds
M v[148:151], a[188:191], a[76:79], v[148:151]
M v[148:151], a[184:187], a[72:75], v[148:151]
M v[152:155], a[184:187], a[80:83], v[152:155]
M v[152:155], a[188:191], a[84:87], v[152:155]
ds_read_b64_tr_b16 a[124:125], v15 offset:49152
ds_read_b64_tr_b16 a[126:127], v15 offset:51200
M v[156:159], a[188:191], a[92:95], v[156:159]
M v[156:159], a[184:187], a[88:91], v[156:159]
s_waitcnt lgkmcnt(10)
M v[160:163], a[160:163], a[32:35], v[160:163]
s_add_u32 s94, s93, 0
buffer_store_dwordx4 a[216:219], v1, s[16:19], s94 offen offset:2048 sc1
M v[160:163], a[164:167], a[36:39], v[160:163]
ds_read_b128 a[176:179], v10 offset:20480
ds_read_b128 a[180:183], v11 offset:20480
M v[164:167], a[164:167], a[44:47], v[164:167]
s_add_u32 s23, s23, 128
s_cmp_eq_u32 s23, s25
s_cselect_b32 s23, s26, s23
M v[164:167], a[160:163], a[40:43], v[164:167]
ds_read_b64_tr_b16 a[132:133], v16 offset:49152
ds_read_b64_tr_b16 a[134:135], v16 offset:51200
M v[168:171], a[160:163], a[48:51], v[168:171]
M v[168:171], a[164:167], a[52:55], v[168:171]
M v[172:175], a[164:167], a[60:63], v[172:175]
M v[172:175], a[160:163], a[56:59], v[172:175]
M v[176:179], a[160:163], a[64:67], v[176:179]
s_add_u32 m0, s29, 81920
s_nop 0
buffer_load_dwordx4 v6, s[12:15], s24 offen offset:0 lds
M v[176:179], a[164:167], a[68:71], v[176:179]
ds_read_b64_tr_b16 a[140:141], v17 offset:49152
ds_read_b64_tr_b16 a[142:143], v17 offset:51200
M v[180:183], a[164:167], a[76:79], v[180:183]
M v[180:183], a[160:163], a[72:75], v[180:183]
M v[184:187], a[160:163], a[80:83], v[184:187]
M v[184:187], a[164:167], a[84:87], v[184:187]
buffer_load_dwordx4 v7, s[12:15], s24 offen offset:1024 lds
M v[188:191], a[164:167], a[92:95], v[188:191]
M v[188:191], a[160:163], a[88:91], v[188:191]
s_waitcnt lgkmcnt(12)
ds_read_b64_tr_b16 a[148:149], v18 offset:49152
ds_read_b64_tr_b16 a[150:151], v18 offset:51200
M v[192:195], a[168:171], a[32:35], v[192:195]
M v[192:195], a[172:175], a[36:39], v[192:195]
ds_read_b128 a[184:187], v10 offset:22528
ds_read_b128 a[188:191], v11 offset:22528
M v[196:199], a[172:175], a[44:47], v[196:199]
M v[196:199], a[168:171], a[40:43], v[196:199]
M v[200:203], a[168:171], a[48:51], v[200:203]
buffer_load_dwordx4 v8, s[12:15], s24 offen offset:2048 lds
M v[200:203], a[172:175], a[52:55], v[200:203]
ds_read_b64_tr_b16 a[156:157], v19 offset:49152
ds_read_b64_tr_b16 a[158:159], v19 offset:51200
M v[204:207], a[172:175], a[60:63], v[204:207]
M v[204:207], a[168:171], a[56:59], v[204:207]
M v[208:211], a[168:171], a[64:67], v[208:211]
M v[208:211], a[172:175], a[68:71], v[208:211]
buffer_load_dwordx4 v9, s[12:15], s24 offen offset:3072 lds
M v[212:215], a[172:175], a[76:79], v[212:215]
M v[212:215], a[168:171], a[72:75], v[212:215]
M v[216:219], a[168:171], a[80:83], v[216:219]
s_add_u32 s94, s93, 0
buffer_store_dwordx4 a[220:223], v1, s[16:19], s94 offen offset:3072 sc1
M v[216:219], a[172:175], a[84:87], v[216:219]
M v[220:223], a[172:175], a[92:95], v[220:223]
M v[220:223], a[168:171], a[88:91], v[220:223]
s_waitcnt lgkmcnt(10)
M v[224:227], a[176:179], a[32:35], v[224:227]
s_add_u32 s24, s24, 262144
s_cmp_eq_u32 s24, s27
s_cselect_b32 s24, s28, s24
s_sub_u32 s6, s6, 1
s_cmp_eq_u32 s6, 0
s_cselect_b64 s[12:13], s[64:65], s[12:13]
M v[224:227], a[180:183], a[36:39], v[224:227]
M v[228:231], a[180:183], a[44:47], v[228:231]
M v[228:231], a[176:179], a[40:43], v[228:231]
M v[232:235], a[176:179], a[48:51], v[232:235]
M v[232:235], a[180:183], a[52:55], v[232:235]
M v[236:239], a[180:183], a[60:63], v[236:239]
M v[236:239], a[176:179], a[56:59], v[236:239]
s_waitcnt vmcnt(11) lgkmcnt(0)
s_barrier
ds_read_b128 a[160:163], v10 offset:32768
ds_read_b128 a[164:167], v11 offset:32768
M v[240:243], a[176:179], a[64:67], v[240:243]
s_add_u32 m0, s29, 0
s_nop 0
buffer_load_dwordx4 v2, s[8:11], s23 offen offset:0 lds
M v[240:243], a[180:183], a[68:71], v[240:243]
M v[244:247], a[180:183], a[76:79], v[244:247]
M v[244:247], a[176:179], a[72:75], v[244:247]
M v[248:251], a[176:179], a[80:83], v[248:251]
M v[248:251], a[180:183], a[84:87], v[248:251]
buffer_load_dwordx4 v3, s[8:11], s23 offen offset:1024 lds
M v[252:255], a[180:183], a[92:95], v[252:255]
M v[252:255], a[176:179], a[88:91], v[252:255]
M a[0:3], a[184:187], a[32:35], a[0:3]
M a[0:3], a[188:191], a[36:39], a[0:3]
ds_read_b128 a[168:171], v10 offset:34816
ds_read_b128 a[172:175], v11 offset:34816
M a[4:7], a[188:191], a[44:47], a[4:7]
M a[4:7], a[184:187], a[40:43], a[4:7]
M a[8:11], a[184:187], a[48:51], a[8:11]
buffer_load_dwordx4 v4, s[8:11], s23 offen offset:2048 lds
M a[8:11], a[188:191], a[52:55], a[8:11]
M a[12:15], a[188:191], a[60:63], a[12:15]
M a[12:15], a[184:187], a[56:59], a[12:15]
M a[16:19], a[184:187], a[64:67], a[16:19]
M a[16:19], a[188:191], a[68:71], a[16:19]
buffer_load_dwordx4 v5, s[8:11], s23 offen offset:3072 lds
M a[20:23], a[188:191], a[76:79], a[20:23]
M a[20:23], a[184:187], a[72:75], a[20:23]
M a[24:27], a[184:187], a[80:83], a[24:27]
M a[24:27], a[188:191], a[84:87], a[24:27]
M a[28:31], a[188:191], a[92:95], a[28:31]
M a[28:31], a[184:187], a[88:91], a[28:31]
s_waitcnt lgkmcnt(2)
M v[32:35], a[160:163], a[96:99], v[32:35]
s_add_u32 m0, s29, 98304
s_nop 0
buffer_load_dwordx4 v6, s[12:15], s24 offen offset:0 lds
M v[32:35], a[164:167], a[100:103], v[32:35]
ds_read_b128 a[176:179], v10 offset:36864
ds_read_b128 a[180:183], v11 offset:36864
M v[36:39], a[164:167], a[108:111], v[36:39]
M v[36:39], a[160:163], a[104:107], v[36:39]
ds_read_b64_tr_b16 a[32:33], v12 offset:0
ds_read_b64_tr_b16 a[34:35], v12 offset:2048
M v[40:43], a[160:163], a[112:115], v[40:43]
M v[40:43], a[164:167], a[116:119], v[40:43]
M v[44:47], a[164:167], a[124:127], v[44:47]
M v[44:47], a[160:163], a[120:123], v[44:47]
ds_read_b64_tr_b16 a[40:41], v13 offset:0
ds_read_b64_tr_b16 a[42:43], v13 offset:2048
M v[48:51], a[160:163], a[128:131], v[48:51]
s_add_u32 s94, s93, 4096
buffer_store_dwordx4 a[224:227], v1, s[16:19], s94 offen offset:0 sc1
M v[48:51], a[164:167], a[132:135], v[48:51]
buffer_load_dwordx4 v7, s[12:15], s24 offen offset:1024 lds
M v[52:55], a[164:167], a[140:143], v[52:55]
M v[52:55], a[160:163], a[136:139], v[52:55]
ds_read_b64_tr_b16 a[48:49], v14 offset:0
ds_read_b64_tr_b16 a[50:51], v14 offset:2048
M v[56:59], a[160:163], a[144:147], v[56:59]
M v[56:59], a[164:167], a[148:151], v[56:59]
M v[60:63], a[164:167], a[156:159], v[60:63]
M v[60:63], a[160:163], a[152:155], v[60:63]
s_waitcnt lgkmcnt(8)
ds_read_b64_tr_b16 a[56:57], v15 offset:0
ds_read_b64_tr_b16 a[58:59], v15 offset:2048
M v[64:67], a[168:171], a[96:99], v[64:67]
buffer_load_dwordx4 v8, s[12:15], s24 offen offset:2048 lds
M v[64:67], a[172:175], a[100:103], v[64:67]
ds_read_b128 a[184:187], v10 offset:38912
ds_read_b128 a[188:191], v11 offset:38912
M v[68:71], a[172:175], a[108:111], v[68:71]
M v[68:71], a[168:171], a[104:107], v[68:71]
ds_read_b64_tr_b16 a[64:65], v16 offset:0
ds_read_b64_tr_b16 a[66:67], v16 offset:2048
M v[72:75], a[168:171], a[112:115], v[72:75]
M v[72:75], a[172:175], a[116:119], v[72:75]
M v[76:79], a[172:175], a[124:127], v[76:79]
M v[76:79], a[168:171], a[120:123], v[76:79]
ds_read_b64_tr_b16 a[72:73], v17 offset:0
ds_read_b64_tr_b16 a[74:75], v17 offset:2048
M v[80:83], a[168:171], a[128:131], v[80:83]
buffer_load_dwordx4 v9, s[12:15], s24 offen offset:3072 lds
M v[80:83], a[172:175], a[132:135], v[80:83]
M v[84:87], a[172:175], a[140:143], v[84:87]
M v[84:87], a[168:171], a[136:139], v[84:87]
ds_read_b64_tr_b16 a[80:81], v18 offset:0
ds_read_b64_tr_b16 a[82:83], v18 offset:2048
M v[88:91], a[168:171], a[144:147], v[88:91]
M v[88:91], a[172:175], a[148:151], v[88:91]
M v[92:95], a[172:175], a[156:159], v[92:95]
s_add_u32 s24, s24, 262144
M v[92:95], a[168:171], a[152:155], v[92:95]
s_waitcnt lgkmcnt(15)
ds_read_b64_tr_b16 a[88:89], v19 offset:0
ds_read_b64_tr_b16 a[90:91], v19 offset:2048
M v[96:99], a[176:179], a[96:99], v[96:99]
M v[96:99], a[180:183], a[100:103], v[96:99]
M v[100:103], a[180:183], a[108:111], v[100:103]
M v[100:103], a[176:179], a[104:107], v[100:103]
M v[104:107], a[176:179], a[112:115], v[104:107]
s_add_u32 s94, s93, 4096
buffer_store_dwordx4 a[228:231], v1, s[16:19], s94 offen offset:1024 sc1
M v[104:107], a[180:183], a[116:119], v[104:107]
M v[108:111], a[180:183], a[124:127], v[108:111]
M v[108:111], a[176:179], a[120:123], v[108:111]
s_waitcnt vmcnt(11) lgkmcnt(0)
s_barrier
ds_read_b128 a[160:163], v10 offset:49152
ds_read_b128 a[164:167], v11 offset:49152
M v[112:115], a[176:179], a[128:131], v[112:115]
s_add_u32 m0, s29, 16384
s_add_u32 s3, s23, s31
buffer_load_dwordx4 v2, s[8:11], s3 offen offset:0 lds
M v[112:115], a[180:183], a[132:135], v[112:115]
M v[116:119], a[180:183], a[140:143], v[116:119]
M v[116:119], a[176:179], a[136:139], v[116:119]
ds_read_b64_tr_b16 a[36:37], v12 offset:16384
ds_read_b64_tr_b16 a[38:39], v12 offset:18432
M v[120:123], a[176:179], a[144:147], v[120:123]
M v[120:123], a[180:183], a[148:151], v[120:123]
buffer_load_dwordx4 v3, s[8:11], s3 offen offset:1024 lds
M v[124:127], a[180:183], a[156:159], v[124:127]
M v[124:127], a[176:179], a[152:155], v[124:127]
M v[128:131], a[184:187], a[96:99], v[128:131]
M v[128:131], a[188:191], a[100:103], v[128:131]
ds_read_b128 a[168:171], v10 offset:51200
ds_read_b128 a[172:175], v11 offset:51200
ds_read_b64_tr_b16 a[44:45], v13 offset:16384
ds_read_b64_tr_b16 a[46:47], v13 offset:18432
M v[132:135], a[188:191], a[108:111], v[132:135]
M v[132:135], a[184:187], a[104:107], v[132:135]
M v[136:139], a[184:187], a[112:115], v[136:139]
buffer_load_dwordx4 v4, s[8:11], s3 offen offset:2048 lds
M v[136:139], a[188:191], a[116:119], v[136:139]
M v[140:143], a[188:191], a[124:127], v[140:143]
M v[140:143], a[184:187], a[120:123], v[140:143]
ds_read_b64_tr_b16 a[52:53], v14 offset:16384
ds_read_b64_tr_b16 a[54:55], v14 offset:18432
M v[144:147], a[184:187], a[128:131], v[144:147]
M v[144:147], a[188:191], a[132:135], v[144:147]
buffer_load_dwordx4 v5, s[8:11], s3 offen offset:3072 lds
M v[148:151], a[188:191], a[140:143], v[148:151]
M v[148:151], a[184:187], a[136:139], v[148:151]
M v[152:155], a[184:187], a[144:147], v[152:155]
M v[152:155], a[188:191], a[148:151], v[152:155]
ds_read_b64_tr_b16 a[60:61], v15 offset:16384
ds_read_b64_tr_b16 a[62:63], v15 offset:18432
M v[156:159], a[188:191], a[156:159], v[156:159]
M v[156:159], a[184:187], a[152:155], v[156:159]
s_waitcnt lgkmcnt(10)
M v[160:163], a[160:163], a[96:99], v[160:163]
s_add_u32 s94, s93, 4096
buffer_store_dwordx4 a[232:235], v1, s[16:19], s94 offen offset:2048 sc1
M v[160:163], a[164:167], a[100:103], v[160:163]
ds_read_b128 a[176:179], v10 offset:53248
ds_read_b128 a[180:183], v11 offset:53248
M v[164:167], a[164:167], a[108:111], v[164:167]
s_add_u32 s23, s23, 128
s_cmp_eq_u32 s23, s25
s_cselect_b32 s23, s26, s23
M v[164:167], a[160:163], a[104:107], v[164:167]
ds_read_b64_tr_b16 a[68:69], v16 offset:16384
ds_read_b64_tr_b16 a[70:71], v16 offset:18432
M v[168:171], a[160:163], a[112:115], v[168:171]
M v[168:171], a[164:167], a[116:119], v[168:171]
M v[172:175], a[164:167], a[124:127], v[172:175]
M v[172:175], a[160:163], a[120:123], v[172:175]
M v[176:179], a[160:163], a[128:131], v[176:179]
s_add_u32 m0, s29, 114688
s_nop 0
buffer_load_dwordx4 v6, s[12:15], s24 offen offset:0 lds
M v[176:179], a[164:167], a[132:135], v[176:179]
ds_read_b64_tr_b16 a[76:77], v17 offset:16384
ds_read_b64_tr_b16 a[78:79], v17 offset:18432
M v[180:183], a[164:167], a[140:143], v[180:183]
M v[180:183], a[160:163], a[136:139], v[180:183]
M v[184:187], a[160:163], a[144:147], v[184:187]
M v[184:187], a[164:167], a[148:151], v[184:187]
buffer_load_dwordx4 v7, s[12:15], s24 offen offset:1024 lds
M v[188:191], a[164:167], a[156:159], v[188:191]
M v[188:191], a[160:163], a[152:155], v[188:191]
s_waitcnt lgkmcnt(12)
ds_read_b64_tr_b16 a[84:85], v18 offset:16384
ds_read_b64_tr_b16 a[86:87], v18 offset:18432
M v[192:195], a[168:171], a[96:99], v[192:195]
M v[192:195], a[172:175], a[100:103], v[192:195]
ds_read_b128 a[184:187], v10 offset:55296
ds_read_b128 a[188:191], v11 offset:55296
M v[196:199], a[172:175], a[108:111], v[196:199]
M v[196:199], a[168:171], a[104:107], v[196:199]
M v[200:203], a[168:171], a[112:115], v[200:203]
buffer_load_dwordx4 v8, s[12:15], s24 offen offset:2048 lds
M v[200:203], a[172:175], a[116:119], v[200:203]
ds_read_b64_tr_b16 a[92:93], v19 offset:16384
ds_read_b64_tr_b16 a[94:95], v19 offset:18432
M v[204:207], a[172:175], a[124:127], v[204:207]
M v[204:207], a[168:171], a[120:123], v[204:207]
M v[208:211], a[168:171], a[128:131], v[208:211]
M v[208:211], a[172:175], a[132:135], v[208:211]
buffer_load_dwordx4 v9, s[12:15], s24 offen offset:3072 lds
M v[212:215], a[172:175], a[140:143], v[212:215]
M v[212:215], a[168:171], a[136:139], v[212:215]
M v[216:219], a[168:171], a[144:147], v[216:219]
s_add_u32 s94, s93, 4096
buffer_store_dwordx4 a[236:239], v1, s[16:19], s94 offen offset:3072 sc1
M v[216:219], a[172:175], a[148:151], v[216:219]
M v[220:223], a[172:175], a[156:159], v[220:223]
M v[220:223], a[168:171], a[152:155], v[220:223]
s_waitcnt lgkmcnt(10)
M v[224:227], a[176:179], a[96:99], v[224:227]
s_add_u32 s24, s24, 262144
s_cmp_eq_u32 s24, s27
s_cselect_b32 s24, s28, s24
s_sub_u32 s6, s6, 1
s_cmp_eq_u32 s6, 0
s_cselect_b64 s[12:13], s[64:65], s[12:13]
M v[224:227], a[180:183], a[100:103], v[224:227]
M v[228:231], a[180:183], a[108:111], v[228:231]
M v[228:231], a[176:179], a[104:107], v[228:231]
M v[232:235], a[176:179], a[112:115], v[232:235]
M v[232:235], a[180:183], a[116:119], v[232:235]
M v[236:239], a[180:183], a[124:127], v[236:239]
M v[236:239], a[176:179], a[120:123], v[236:239]
s_waitcnt vmcnt(11) lgkmcnt(0)
s_barrier
ds_read_b128 a[160:163], v10 offset:0
ds_read_b128 a[164:167], v11 offset:0
M v[240:243], a[176:179], a[128:131], v[240:243]
s_add_u32 m0, s29, 32768
s_nop 0
buffer_load_dwordx4 v2, s[8:11], s23 offen offset:0 lds
M v[240:243], a[180:183], a[132:135], v[240:243]
M v[244:247], a[180:183], a[140:143], v[244:247]
M v[244:247], a[176:179], a[136:139], v[244:247]
M v[248:251], a[176:179], a[144:147], v[248:251]
M v[248:251], a[180:183], a[148:151], v[248:251]
buffer_load_dwordx4 v3, s[8:11], s23 offen offset:1024 lds
M v[252:255], a[180:183], a[156:159], v[252:255]
M v[252:255], a[176:179], a[152:155], v[252:255]
M a[0:3], a[184:187], a[96:99], a[0:3]
M a[0:3], a[188:191], a[100:103], a[0:3]
ds_read_b128 a[168:171], v10 offset:2048
ds_read_b128 a[172:175], v11 offset:2048
M a[4:7], a[188:191], a[108:111], a[4:7]
M a[4:7], a[184:187], a[104:107], a[4:7]
M a[8:11], a[184:187], a[112:115], a[8:11]
buffer_load_dwordx4 v4, s[8:11], s23 offen offset:2048 lds
M a[8:11], a[188:191], a[116:119], a[8:11]
M a[12:15], a[188:191], a[124:127], a[12:15]
M a[12:15], a[184:187], a[120:123], a[12:15]
M a[16:19], a[184:187], a[128:131], a[16:19]
M a[16:19], a[188:191], a[132:135], a[16:19]
buffer_load_dwordx4 v5, s[8:11], s23 offen offset:3072 lds
M a[20:23], a[188:191], a[140:143], a[20:23]
M a[20:23], a[184:187], a[136:139], a[20:23]
M a[24:27], a[184:187], a[144:147], a[24:27]
M a[24:27], a[188:191], a[148:151], a[24:27]
M a[28:31], a[188:191], a[156:159], a[28:31]
M a[28:31], a[184:187], a[152:155], a[28:31]
s_waitcnt lgkmcnt(2)
M v[32:35], a[160:163], a[32:35], v[32:35]
s_add_u32 m0, s29, 65536
s_nop 0
buffer_load_dwordx4 v6, s[12:15], s24 offen offset:0 lds
M v[32:35], a[164:167], a[36:39], v[32:35]
ds_read_b128 a[176:179], v10 offset:4096
ds_read_b128 a[180:183], v11 offset:4096
M v[36:39], a[164:167], a[44:47], v[36:39]
M v[36:39], a[160:163], a[40:43], v[36:39]
ds_read_b64_tr_b16 a[96:97], v12 offset:32768
ds_read_b64_tr_b16 a[98:99], v12 offset:34816
M v[40:43], a[160:163], a[48:51], v[40:43]
M v[40:43], a[164:167], a[52:55], v[40:43]
M v[44:47], a[164:167], a[60:63], v[44:47]
M v[44:47], a[160:163], a[56:59], v[44:47]
ds_read_b64_tr_b16 a[104:105], v13 offset:32768
ds_read_b64_tr_b16 a[106:107], v13 offset:34816
M v[48:51], a[160:163], a[64:67], v[48:51]
s_add_u32 s94, s93, 8192
buffer_store_dwordx4 a[240:243], v1, s[16:19], s94 offen offset:0 sc1
M v[48:51], a[164:167], a[68:71], v[48:51]
buffer_load_dwordx4 v7, s[12:15], s24 offen offset:1024 lds
M v[52:55], a[164:167], a[76:79], v[52:55]
M v[52:55], a[160:163], a[72:75], v[52:55]
ds_read_b64_tr_b16 a[112:113], v14 offset:32768
ds_read_b64_tr_b16 a[114:115], v14 offset:34816
M v[56:59], a[160:163], a[80:83], v[56:59]
M v[56:59], a[164:167], a[84:87], v[56:59]
M v[60:63], a[164:167], a[92:95], v[60:63]
M v[60:63], a[160:163], a[88:91], v[60:63]
s_waitcnt lgkmcnt(8)
ds_read_b64_tr_b16 a[120:121], v15 offset:32768
ds_read_b64_tr_b16 a[122:123], v15 offset:34816
M v[64:67], a[168:171], a[32:35], v[64:67]
buffer_load_dwordx4 v8, s[12:15], s24 offen offset:2048 lds
M v[64:67], a[172:175], a[36:39], v[64:67]
ds_read_b128 a[184:187], v10 offset:6144
ds_read_b128 a[188:191], v11 offset:6144
M v[68:71], a[172:175], a[44:47], v[68:71]
M v[68:71], a[168:171], a[40:43], v[68:71]
ds_read_b64_tr_b16 a[128:129], v16 offset:32768
ds_read_b64_tr_b16 a[130:131], v16 offset:34816
M v[72:75], a[168:171], a[48:51], v[72:75]
M v[72:75], a[172:175], a[52:55], v[72:75]
M v[76:79], a[172:175], a[60:63], v[76:79]
M v[76:79], a[168:171], a[56:59], v[76:79]
ds_read_b64_tr_b16 a[136:137], v17 offset:32768
ds_read_b64_tr_b16 a[138:139], v17 offset:34816
M v[80:83], a[168:171], a[64:67], v[80:83]
buffer_load_dwordx4 v9, s[12:15], s24 offen offset:3072 lds
M v[80:83], a[172:175], a[68:71], v[80:83]
M v[84:87], a[172:175], a[76:79], v[84:87]
M v[84:87], a[168:171], a[72:75], v[84:87]
ds_read_b64_tr_b16 a[144:145], v18 offset:32768
ds_read_b64_tr_b16 a[146:147], v18 offset:34816
M v[88:91], a[168:171], a[80:83], v[88:91]
M v[88:91], a[172:175], a[84:87], v[88:91]
M v[92:95], a[172:175], a[92:95], v[92:95]
s_add_u32 s24, s24, 262144
M v[92:95], a[168:171], a[88:91], v[92:95]
s_waitcnt lgkmcnt(15)
ds_read_b64_tr_b16 a[152:153], v19 offset:32768
ds_read_b64_tr_b16 a[154:155], v19 offset:34816
M v[96:99], a[176:179], a[32:35], v[96:99]
M v[96:99], a[180:183], a[36:39], v[96:99]
M v[100:103], a[180:183], a[44:47], v[100:103]
M v[100:103], a[176:179], a[40:43], v[100:103]
M v[104:107], a[176:179], a[48:51], v[104:107]
s_add_u32 s94, s93, 8192
buffer_store_dwordx4 a[244:247], v1, s[16:19], s94 offen offset:1024 sc1
M v[104:107], a[180:183], a[52:55], v[104:107]
M v[108:111], a[180:183], a[60:63], v[108:111]
M v[108:111], a[176:179], a[56:59], v[108:111]
s_waitcnt vmcnt(11) lgkmcnt(0)
s_barrier
ds_read_b128 a[160:163], v10 offset:16384
ds_read_b128 a[164:167], v11 offset:16384
M v[112:115], a[176:179], a[64:67], v[112:115]
s_add_u32 m0, s29, 49152
s_add_u32 s3, s23, s31
buffer_load_dwordx4 v2, s[8:11], s3 offen offset:0 lds
M v[112:115], a[180:183], a[68:71], v[112:115]
M v[116:119], a[180:183], a[76:79], v[116:119]
M v[116:119], a[176:179], a[72:75], v[116:119]
ds_read_b64_tr_b16 a[100:101], v12 offset:49152
ds_read_b64_tr_b16 a[102:103], v12 offset:51200
M v[120:123], a[176:179], a[80:83], v[120:123]
M v[120:123], a[180:183], a[84:87], v[120:123]
buffer_load_dwordx4 v3, s[8:11], s3 offen offset:1024 lds
M v[124:127], a[180:183], a[92:95], v[124:127]
M v[124:127], a[176:179], a[88:91], v[124:127]
M v[128:131], a[184:187], a[32:35], v[128:131]
M v[128:131], a[188:191], a[36:39], v[128:131]
ds_read_b128 a[168:171], v10 offset:18432
ds_read_b128 a[172:175], v11 offset:18432
ds_read_b64_tr_b16 a[108:109], v13 offset:49152
ds_read_b64_tr_b16 a[110:111], v13 offset:51200
M v[132:135], a[188:191], a[44:47], v[132:135]
M v[132:135], a[184:187], a[40:43], v[132:135]
M v[136:139], a[184:187], a[48:51], v[136:139]
buffer_load_dwordx4 v4, s[8:11], s3 offen offset:2048 lds
M v[136:139], a[188:191], a[52:55], v[136:139]
M v[140:143], a[188:191], a[60:63], v[140:143]
M v[140:143], a[184:187], a[56:59], v[140:143]
ds_read_b64_tr_b16 a[116:117], v14 offset:49152
ds_read_b64_tr_b16 a[118:119], v14 offset:51200
M v[144:147], a[184:187], a[64:67], v[144:147]
M v[144:147], a[188:191], a[68:71], v[144:147]
buffer_load_dwordx4 v5, s[8:11], s3 offen offset:3072 lds
M v[148:151], a[188:191], a[76:79], v[148:151]
M v[148:151], a[184:187], a[72:75], v[148:151]
M v[152:155], a[184:187], a[80:83], v[152:155]
M v[152:155], a[188:191], a[84:87], v[152:155]
ds_read_b64_tr_b16 a[124:125], v15 offset:49152
ds_read_b64_tr_b16 a[126:127], v15 offset:51200
M v[156:159], a[188:191], a[92:95], v[156:159]
M v[156:159], a[184:187], a[88:91], v[156:159]
s_waitcnt lgkmcnt(10)
M v[160:163], a[160:163], a[32:35], v[160:163]
s_add_u32 s94, s93, 8192
buffer_store_dwordx4 a[248:251], v1, s[16:19], s94 offen offset:2048 sc1
M v[160:163], a[164:167], a[36:39], v[160:163]
ds_read_b128 a[176:179], v10 offset:20480
ds_read_b128 a[180:183], v11 offset:20480
M v[164:167], a[164:167], a[44:47], v[164:167]
s_add_u32 s23, s23, 128
s_cmp_eq_u32 s23, s25
s_cselect_b32 s23, s26, s23
M v[164:167], a[160:163], a[40:43], v[164:167]
ds_read_b64_tr_b16 a[132:133], v16 offset:49152
ds_read_b64_tr_b16 a[134:135], v16 offset:51200
M v[168:171], a[160:163], a[48:51], v[168:171]
M v[168:171], a[164:167], a[52:55], v[168:171]
M v[172:175], a[164:167], a[60:63], v[172:175]
M v[172:175], a[160:163], a[56:59], v[172:175]
M v[176:179], a[160:163], a[64:67], v[176:179]
s_add_u32 m0, s29, 81920
s_nop 0
buffer_load_dwordx4 v6, s[12:15], s24 offen offset:0 lds
M v[176:179], a[164:167], a[68:71], v[176:179]
ds_read_b64_tr_b16 a[140:141], v17 offset:49152
ds_read_b64_tr_b16 a[142:143], v17 offset:51200
M v[180:183], a[164:167], a[76:79], v[180:183]
M v[180:183], a[160:163], a[72:75], v[180:183]
M v[184:187], a[160:163], a[80:83], v[184:187]
M v[184:187], a[164:167], a[84:87], v[184:187]
buffer_load_dwordx4 v7, s[12:15], s24 offen offset:1024 lds
M v[188:191], a[164:167], a[92:95], v[188:191]
M v[188:191], a[160:163], a[88:91], v[188:191]
s_waitcnt lgkmcnt(12)
ds_read_b64_tr_b16 a[148:149], v18 offset:49152
ds_read_b64_tr_b16 a[150:151], v18 offset:51200
M v[192:195], a[168:171], a[32:35], v[192:195]
M v[192:195], a[172:175], a[36:39], v[192:195]
ds_read_b128 a[184:187], v10 offset:22528
ds_read_b128 a[188:191], v11 offset:22528
M v[196:199], a[172:175], a[44:47], v[196:199]
M v[196:199], a[168:171], a[40:43], v[196:199]
M v[200:203], a[168:171], a[48:51], v[200:203]
buffer_load_dwordx4 v8, s[12:15], s24 offen offset:2048 lds
M v[200:203], a[172:175], a[52:55], v[200:203]
ds_read_b64_tr_b16 a[156:157], v19 offset:49152
ds_read_b64_tr_b16 a[158:159], v19 offset:51200
M v[204:207], a[172:175], a[60:63], v[204:207]
M v[204:207], a[168:171], a[56:59], v[204:207]
M v[208:211], a[168:171], a[64:67], v[208:211]
M v[208:211], a[172:175], a[68:71], v[208:211]
buffer_load_dwordx4 v9, s[12:15], s24 offen offset:3072 lds
M v[212:215], a[172:175], a[76:79], v[212:215]
M v[212:215], a[168:171], a[72:75], v[212:215]
M v[216:219], a[168:171], a[80:83], v[216:219]
s_add_u32 s94, s93, 8192
buffer_store_dwordx4 a[252:255], v1, s[16:19], s94 offen offset:3072 sc1
M v[216:219], a[172:175], a[84:87], v[216:219]
M v[220:223], a[172:175], a[92:95], v[220:223]
M v[220:223], a[168:171], a[88:91], v[220:223]
s_waitcnt lgkmcnt(10)
M v[224:227], a[176:179], a[32:35], v[224:227]
s_add_u32 s24, s24, 262144
s_cmp_eq_u32 s24, s27
s_cselect_b32 s24, s28, s24
s_sub_u32 s6, s6, 1
s_cmp_eq_u32 s6, 0
s_cselect_b64 s[12:13], s[64:65], s[12:13]
M v[224:227], a[180:183], a[36:39], v[224:227]
M v[228:231], a[180:183], a[44:47], v[228:231]
M v[228:231], a[176:179], a[40:43], v[228:231]
M v[232:235], a[176:179], a[48:51], v[232:235]
M v[232:235], a[180:183], a[52:55], v[232:235]
M v[236:239], a[180:183], a[60:63], v[236:239]
M v[236:239], a[176:179], a[56:59], v[236:239]
s_waitcnt vmcnt(11) lgkmcnt(0)
s_barrier
ds_read_b128 a[160:163], v10 offset:32768
ds_read_b128 a[164:167], v11 offset:32768
M v[240:243], a[176:179], a[64:67], v[240:243]
s_add_u32 m0, s29, 0
s_nop 0
buffer_load_dwordx4 v2, s[8:11], s23 offen offset:0 lds
M v[240:243], a[180:183], a[68:71], v[240:243]
M v[244:247], a[180:183], a[76:79], v[244:247]
M v[244:247], a[176:179], a[72:75], v[244:247]
M v[248:251], a[176:179], a[80:83], v[248:251]
M v[248:251], a[180:183], a[84:87], v[248:251]
buffer_load_dwordx4 v3, s[8:11], s23 offen offset:1024 lds
M v[252:255], a[180:183], a[92:95], v[252:255]
M v[252:255], a[176:179], a[88:91], v[252:255]
M a[0:3], a[184:187], a[32:35], a[0:3]
M a[0:3], a[188:191], a[36:39], a[0:3]
ds_read_b128 a[168:171], v10 offset:34816
ds_read_b128 a[172:175], v11 offset:34816
M a[4:7], a[188:191], a[44:47], a[4:7]
M a[4:7], a[184:187], a[40:43], a[4:7]
M a[8:11], a[184:187], a[48:51], a[8:11]
buffer_load_dwordx4 v4, s[8:11], s23 offen offset:2048 lds
M a[8:11], a[188:191], a[52:55], a[8:11]
M a[12:15], a[188:191], a[60:63], a[12:15]
M a[12:15], a[184:187], a[56:59], a[12:15]
M a[16:19], a[184:187], a[64:67], a[16:19]
M a[16:19], a[188:191], a[68:71], a[16:19]
buffer_load_dwordx4 v5, s[8:11], s23 offen offset:3072 lds
M a[20:23], a[188:191], a[76:79], a[20:23]
M a[20:23], a[184:187], a[72:75], a[20:23]
M a[24:27], a[184:187], a[80:83], a[24:27]
M a[24:27], a[188:191], a[84:87], a[24:27]
M a[28:31], a[188:191], a[92:95], a[28:31]
M a[28:31], a[184:187], a[88:91], a[28:31]
s_waitcnt lgkmcnt(2)
M v[32:35], a[160:163], a[96:99], v[32:35]
s_add_u32 m0, s29, 98304
s_nop 0
buffer_load_dwordx4 v6, s[12:15], s24 offen offset:0 lds
M v[32:35], a[164:167], a[100:103], v[32:35]
ds_read_b128 a[176:179], v10 offset:36864
ds_read_b128 a[180:183], v11 offset:36864
M v[36:39], a[164:167], a[108:111], v[36:39]
M v[36:39], a[160:163], a[104:107], v[36:39]
ds_read_b64_tr_b16 a[32:33], v12 offset:0
ds_read_b64_tr_b16 a[34:35], v12 offset:2048
M v[40:43], a[160:163], a[112:115], v[40:43]
M v[40:43], a[164:167], a[116:119], v[40:43]
M v[44:47], a[164:167], a[124:127], v[44:47]
M v[44:47], a[160:163], a[120:123], v[44:47]
ds_read_b64_tr_b16 a[40:41], v13 offset:0
ds_read_b64_tr_b16 a[42:43], v13 offset:2048
M v[48:51], a[160:163], a[128:131], v[48:51]
buffer_load_dwordx4 v7, s[12:15], s24 offen offset:1024 lds
M v[48:51], a[164:167], a[132:135], v[48:51]
M v[52:55], a[164:167], a[140:143], v[52:55]
M v[52:55], a[160:163], a[136:139], v[52:55]
ds_read_b64_tr_b16 a[48:49], v14 offset:0
ds_read_b64_tr_b16 a[50:51], v14 offset:2048
M v[56:59], a[160:163], a[144:147], v[56:59]
M v[56:59], a[164:167], a[148:151], v[56:59]
M v[60:63], a[164:167], a[156:159], v[60:63]
buffer_load_dwordx4 v8, s[12:15], s24 offen offset:2048 lds
M v[60:63], a[160:163], a[152:155], v[60:63]
s_waitcnt lgkmcnt(8)
ds_read_b64_tr_b16 a[56:57], v15 offset:0
ds_read_b64_tr_b16 a[58:59], v15 offset:2048
M v[64:67], a[168:171], a[96:99], v[64:67]
M v[64:67], a[172:175], a[100:103], v[64:67]
ds_read_b128 a[184:187], v10 offset:38912
ds_read_b128 a[188:191], v11 offset:38912
M v[68:71], a[172:175], a[108:111], v[68:71]
M v[68:71], a[168:171], a[104:107], v[68:71]
ds_read_b64_tr_b16 a[64:65], v16 offset:0
ds_read_b64_tr_b16 a[66:67], v16 offset:2048
M v[72:75], a[168:171], a[112:115], v[72:75]
M v[72:75], a[172:175], a[116:119], v[72:75]
M v[76:79], a[172:175], a[124:127], v[76:79]
M v[76:79], a[168:171], a[120:123], v[76:79]
ds_read_b64_tr_b16 a[72:73], v17 offset:0
ds_read_b64_tr_b16 a[74:75], v17 offset:2048
M v[80:83], a[168:171], a[128:131], v[80:83]
buffer_load_dwordx4 v9, s[12:15], s24 offen offset:3072 lds
M v[80:83], a[172:175], a[132:135], v[80:83]
M v[84:87], a[172:175], a[140:143], v[84:87]
M v[84:87], a[168:171], a[136:139], v[84:87]
ds_read_b64_tr_b16 a[80:81], v18 offset:0
ds_read_b64_tr_b16 a[82:83], v18 offset:2048
M v[88:91], a[168:171], a[144:147], v[88:91]
M v[88:91], a[172:175], a[148:151], v[88:91]
M v[92:95], a[172:175], a[156:159], v[92:95]
s_add_u32 s24, s24, 262144
M v[92:95], a[168:171], a[152:155], v[92:95]
s_waitcnt lgkmcnt(15)
ds_read_b64_tr_b16 a[88:89], v19 offset:0
ds_read_b64_tr_b16 a[90:91], v19 offset:2048
M v[96:99], a[176:179], a[96:99], v[96:99]
M v[96:99], a[180:183], a[100:103], v[96:99]
M v[100:103], a[180:183], a[108:111], v[100:103]
M v[100:103], a[176:179], a[104:107], v[100:103]
M v[104:107], a[176:179], a[112:115], v[104:107]
M v[104:107], a[180:183], a[116:119], v[104:107]
M v[108:111], a[180:183], a[124:127], v[108:111]
M v[108:111], a[176:179], a[120:123], v[108:111]
s_waitcnt vmcnt(9) lgkmcnt(0)
s_barrier
ds_read_b128 a[160:163], v10 offset:49152
ds_read_b128 a[164:167], v11 offset:49152
M v[112:115], a[176:179], a[128:131], v[112:115]
s_add_u32 m0, s29, 16384
s_add_u32 s3, s23, s31
buffer_load_dwordx4 v2, s[8:11], s3 offen offset:0 lds
M v[112:115], a[180:183], a[132:135], v[112:115]
M v[116:119], a[180:183], a[140:143], v[116:119]
M v[116:119], a[176:179], a[136:139], v[116:119]
ds_read_b64_tr_b16 a[36:37], v12 offset:16384
ds_read_b64_tr_b16 a[38:39], v12 offset:18432
M v[120:123], a[176:179], a[144:147], v[120:123]
M v[120:123], a[180:183], a[148:151], v[120:123]
buffer_load_dwordx4 v3, s[8:11], s3 offen offset:1024 lds
M v[124:127], a[180:183], a[156:159], v[124:127]
M v[124:127], a[176:179], a[152:155], v[124:127]
M v[128:131], a[184:187], a[96:99], v[128:131]
M v[128:131], a[188:191], a[100:103], v[128:131]
ds_read_b128 a[168:171], v10 offset:51200
ds_read_b128 a[172:175], v11 offset:51200
ds_read_b64_tr_b16 a[44:45], v13 offset:16384
ds_read_b64_tr_b16 a[46:47], v13 offset:18432
M v[132:135], a[188:191], a[108:111], v[132:135]
M v[132:135], a[184:187], a[104:107], v[132:135]
M v[136:139], a[184:187], a[112:115], v[136:139]
buffer_load_dwordx4 v4, s[8:11], s3 offen offset:2048 lds
M v[136:139], a[188:191], a[116:119], v[136:139]
M v[140:143], a[188:191], a[124:127], v[140:143]
M v[140:143], a[184:187], a[120:123], v[140:143]
ds_read_b64_tr_b16 a[52:53], v14 offset:16384
ds_read_b64_tr_b16 a[54:55], v14 offset:18432
M v[144:147], a[184:187], a[128:131], v[144:147]
M v[144:147], a[188:191], a[132:135], v[144:147]
M v[148:151], a[188:191], a[140:143], v[148:151]
buffer_load_dwordx4 v5, s[8:11], s3 offen offset:3072 lds
M v[148:151], a[184:187], a[136:139], v[148:151]
M v[152:155], a[184:187], a[144:147], v[152:155]
M v[152:155], a[188:191], a[148:151], v[152:155]
ds_read_b64_tr_b16 a[60:61], v15 offset:16384
ds_read_b64_tr_b16 a[62:63], v15 offset:18432
M v[156:159], a[188:191], a[156:159], v[156:159]
M v[156:159], a[184:187], a[152:155], v[156:159]
s_waitcnt lgkmcnt(10)
M v[160:163], a[160:163], a[96:99], v[160:163]
s_add_u32 s23, s23, 128
s_cmp_eq_u32 s23, s25
s_cselect_b32 s23, s26, s23
M v[160:163], a[164:167], a[100:103], v[160:163]
ds_read_b128 a[176:179], v10 offset:53248
ds_read_b128 a[180:183], v11 offset:53248
M v[164:167], a[164:167], a[108:111], v[164:167]
M v[164:167], a[160:163], a[104:107], v[164:167]
ds_read_b64_tr_b16 a[68:69], v16 offset:16384
ds_read_b64_tr_b16 a[70:71], v16 offset:18432
M v[168:171], a[160:163], a[112:115], v[168:171]
M v[168:171], a[164:167], a[116:119], v[168:171]
M v[172:175], a[164:167], a[124:127], v[172:175]
M v[172:175], a[160:163], a[120:123], v[172:175]
s_add_u32 m0, s29, 114688
s_nop 0
buffer_load_dwordx4 v6, s[12:15], s24 offen offset:0 lds
M v[176:179], a[160:163], a[128:131], v[176:179]
M v[176:179], a[164:167], a[132:135], v[176:179]
ds_read_b64_tr_b16 a[76:77], v17 offset:16384
ds_read_b64_tr_b16 a[78:79], v17 offset:18432
M v[180:183], a[164:167], a[140:143], v[180:183]
M v[180:183], a[160:163], a[136:139], v[180:183]
M v[184:187], a[160:163], a[144:147], v[184:187]
M v[184:187], a[164:167], a[148:151], v[184:187]
buffer_load_dwordx4 v7, s[12:15], s24 offen offset:1024 lds
M v[188:191], a[164:167], a[156:159], v[188:191]
M v[188:191], a[160:163], a[152:155], v[188:191]
s_waitcnt lgkmcnt(12)
ds_read_b64_tr_b16 a[84:85], v18 offset:16384
ds_read_b64_tr_b16 a[86:87], v18 offset:18432
M v[192:195], a[168:171], a[96:99], v[192:195]
M v[192:195], a[172:175], a[100:103], v[192:195]
ds_read_b128 a[184:187], v10 offset:55296
ds_read_b128 a[188:191], v11 offset:55296
M v[196:199], a[172:175], a[108:111], v[196:199]
M v[196:199], a[168:171], a[104:107], v[196:199]
buffer_load_dwordx4 v8, s[12:15], s24 offen offset:2048 lds
M v[200:203], a[168:171], a[112:115], v[200:203]
M v[200:203], a[172:175], a[116:119], v[200:203]
ds_read_b64_tr_b16 a[92:93], v19 offset:16384
ds_read_b64_tr_b16 a[94:95], v19 offset:18432
M v[204:207], a[172:175], a[124:127], v[204:207]
M v[204:207], a[168:171], a[120:123], v[204:207]
M v[208:211], a[168:171], a[128:131], v[208:211]
M v[208:211], a[172:175], a[132:135], v[208:211]
buffer_load_dwordx4 v9, s[12:15], s24 offen offset:3072 lds
M v[212:215], a[172:175], a[140:143], v[212:215]
s_getpc_b64 s[56:57]
Lpcc1:
s_add_u32 s56, s56, Lk1_b-Lpcc1
s_addc_u32 s57, s57, 0
s_lshr_b32 s58, s2, 3
s_lshl2_add_u32 s58, s58, s101
s_mul_i32 s58, s58, (((Lc2-Lk1_b)/128+127)&~127)
v_lshlrev_b32 v22, 7, v0
v_min_u32 v22, (((Lc2-Lk1_b)/128+127)&~127)-128, v22
v_add_u32 v22, s58, v22
v_min_u32 v22, Lc2-Lk1_b-4, v22
global_load_dword a255, v22, s[56:57]
M v[212:215], a[168:171], a[136:139], v[212:215]
M v[216:219], a[168:171], a[144:147], v[216:219]
M v[216:219], a[172:175], a[148:151], v[216:219]
M v[220:223], a[172:175], a[156:159], v[220:223]
M v[220:223], a[168:171], a[152:155], v[220:223]
s_waitcnt lgkmcnt(10)
M v[224:227], a[176:179], a[96:99], v[224:227]
s_add_u32 s24, s24, 262144
s_cmp_eq_u32 s24, s27
s_cselect_b32 s24, s28, s24
s_sub_u32 s6, s6, 1
s_cmp_eq_u32 s6, 0
s_cselect_b64 s[12:13], s[64:65], s[12:13]
M v[224:227], a[180:183], a[100:103], v[224:227]
M v[228:231], a[180:183], a[108:111], v[228:231]
M v[228:231], a[176:179], a[104:107], v[228:231]
M v[232:235], a[176:179], a[112:115], v[232:235]
M v[232:235], a[180:183], a[116:119], v[232:235]
M v[236:239], a[180:183], a[124:127], v[236:239]
M v[236:239], a[176:179], a[120:123], v[236:239]
s_waitcnt vmcnt(9) lgkmcnt(0)
s_barrier
ds_read_b128 a[160:163], v10 offset:0
ds_read_b128 a[164:167], v11 offset:0
M v[240:243], a[176:179], a[128:131], v[240:243]
s_add_u32 m0, s29, 32768
s_nop 0
buffer_load_dwordx4 v2, s[8:11], s23 offen offset:0 lds
M v[240:243], a[180:183], a[132:135], v[240:243]
M v[244:247], a[180:183], a[140:143], v[244:247]
M v[244:247], a[176:179], a[136:139], v[244:247]
M v[248:251], a[176:179], a[144:147], v[248:251]
M v[248:251], a[180:183], a[148:151], v[248:251]
M v[252:255], a[180:183], a[156:159], v[252:255]
M v[252:255], a[176:179], a[152:155], v[252:255]
M a[0:3], a[184:187], a[96:99], a[0:3]
M a[0:3], a[188:191], a[100:103], a[0:3]
ds_read_b128 a[168:171], v10 offset:2048
ds_read_b128 a[172:175], v11 offset:2048
M a[4:7], a[188:191], a[108:111], a[4:7]
M a[4:7], a[184:187], a[104:107], a[4:7]
M a[8:11], a[184:187], a[112:115], a[8:11]
buffer_load_dwordx4 v3, s[8:11], s23 offen offset:1024 lds
M a[8:11], a[188:191], a[116:119], a[8:11]
M a[12:15], a[188:191], a[124:127], a[12:15]
M a[12:15], a[184:187], a[120:123], a[12:15]
M a[16:19], a[184:187], a[128:131], a[16:19]
M a[16:19], a[188:191], a[132:135], a[16:19]
M a[20:23], a[188:191], a[140:143], a[20:23]
M a[20:23], a[184:187], a[136:139], a[20:23]
M a[24:27], a[184:187], a[144:147], a[24:27]
M a[24:27], a[188:191], a[148:151], a[24:27]
M a[28:31], a[188:191], a[156:159], a[28:31]
M a[28:31], a[184:187], a[152:155], a[28:31]
s_waitcnt lgkmcnt(2)
M v[32:35], a[160:163], a[32:35], v[32:35]
buffer_load_dwordx4 v4, s[8:11], s23 offen offset:2048 lds
M v[32:35], a[164:167], a[36:39], v[32:35]
ds_read_b128 a[176:179], v10 offset:4096
ds_read_b128 a[180:183], v11 offset:4096
M v[36:39], a[164:167], a[44:47], v[36:39]
M v[36:39], a[160:163], a[40:43], v[36:39]
ds_read_b64_tr_b16 a[96:97], v12 offset:32768
ds_read_b64_tr_b16 a[98:99], v12 offset:34816
M v[40:43], a[160:163], a[48:51], v[40:43]
M v[40:43], a[164:167], a[52:55], v[40:43]
M v[44:47], a[164:167], a[60:63], v[44:47]
M v[44:47], a[160:163], a[56:59], v[44:47]
ds_read_b64_tr_b16 a[104:105], v13 offset:32768
ds_read_b64_tr_b16 a[106:107], v13 offset:34816
M v[48:51], a[160:163], a[64:67], v[48:51]
M v[48:51], a[164:167], a[68:71], v[48:51]
M v[52:55], a[164:167], a[76:79], v[52:55]
M v[52:55], a[160:163], a[72:75], v[52:55]
ds_read_b64_tr_b16 a[112:113], v14 offset:32768
ds_read_b64_tr_b16 a[114:115], v14 offset:34816
M v[56:59], a[160:163], a[80:83], v[56:59]
M v[56:59], a[164:167], a[84:87], v[56:59]
M v[60:63], a[164:167], a[92:95], v[60:63]
M v[60:63], a[160:163], a[88:91], v[60:63]
s_waitcnt lgkmcnt(8)
ds_read_b64_tr_b16 a[120:121], v15 offset:32768
ds_read_b64_tr_b16 a[122:123], v15 offset:34816
M v[64:67], a[168:171], a[32:35], v[64:67]
M v[64:67], a[172:175], a[36:39], v[64:67]
ds_read_b128 a[184:187], v10 offset:6144
ds_read_b128 a[188:191], v11 offset:6144
M v[68:71], a[172:175], a[44:47], v[68:71]
M v[68:71], a[168:171], a[40:43], v[68:71]
ds_read_b64_tr_b16 a[128:129], v16 offset:32768
ds_read_b64_tr_b16 a[130:131], v16 offset:34816
M v[72:75], a[168:171], a[48:51], v[72:75]
buffer_load_dwordx4 v5, s[8:11], s23 offen offset:3072 lds
M v[72:75], a[172:175], a[52:55], v[72:75]
M v[76:79], a[172:175], a[60:63], v[76:79]
M v[76:79], a[168:171], a[56:59], v[76:79]
ds_read_b64_tr_b16 a[136:137], v17 offset:32768
ds_read_b64_tr_b16 a[138:139], v17 offset:34816
M v[80:83], a[168:171], a[64:67], v[80:83]
M v[80:83], a[172:175], a[68:71], v[80:83]
M v[84:87], a[172:175], a[76:79], v[84:87]
M v[84:87], a[168:171], a[72:75], v[84:87]
ds_read_b64_tr_b16 a[144:145], v18 offset:32768
ds_read_b64_tr_b16 a[146:147], v18 offset:34816
M v[88:91], a[168:171], a[80:83], v[88:91]
M v[88:91], a[172:175], a[84:87], v[88:91]
M v[92:95], a[172:175], a[92:95], v[92:95]
M v[92:95], a[168:171], a[88:91], v[92:95]
s_waitcnt lgkmcnt(15)
ds_read_b64_tr_b16 a[152:153], v19 offset:32768
ds_read_b64_tr_b16 a[154:155], v19 offset:34816
M v[96:99], a[176:179], a[32:35], v[96:99]
M v[96:99], a[180:183], a[36:39], v[96:99]
M v[100:103], a[180:183], a[44:47], v[100:103]
M v[100:103], a[176:179], a[40:43], v[100:103]
M v[104:107], a[176:179], a[48:51], v[104:107]
M v[104:107], a[180:183], a[52:55], v[104:107]
M v[108:111], a[180:183], a[60:63], v[108:111]
M v[108:111], a[176:179], a[56:59], v[108:111]
s_waitcnt vmcnt(5) lgkmcnt(0)
s_barrier
ds_read_b128 a[160:163], v10 offset:16384
ds_read_b128 a[164:167], v11 offset:16384
M v[112:115], a[176:179], a[64:67], v[112:115]
s_add_u32 m0, s29, 49152
s_add_u32 s3, s23, s31
buffer_load_dwordx4 v2, s[8:11], s3 offen offset:0 lds
M v[112:115], a[180:183], a[68:71], v[112:115]
M v[116:119], a[180:183], a[76:79], v[116:119]
buffer_load_dwordx4 v3, s[8:11], s3 offen offset:1024 lds
M v[116:119], a[176:179], a[72:75], v[116:119]
ds_read_b64_tr_b16 a[100:101], v12 offset:49152
ds_read_b64_tr_b16 a[102:103], v12 offset:51200
M v[120:123], a[176:179], a[80:83], v[120:123]
buffer_load_dwordx4 v4, s[8:11], s3 offen offset:2048 lds
M v[120:123], a[180:183], a[84:87], v[120:123]
M v[124:127], a[180:183], a[92:95], v[124:127]
buffer_load_dwordx4 v5, s[8:11], s3 offen offset:3072 lds
M v[124:127], a[176:179], a[88:91], v[124:127]
M v[128:131], a[184:187], a[32:35], v[128:131]
M v[128:131], a[188:191], a[36:39], v[128:131]
ds_read_b128 a[168:171], v10 offset:18432
ds_read_b128 a[172:175], v11 offset:18432
ds_read_b64_tr_b16 a[108:109], v13 offset:49152
ds_read_b64_tr_b16 a[110:111], v13 offset:51200
M v[132:135], a[188:191], a[44:47], v[132:135]
M v[132:135], a[184:187], a[40:43], v[132:135]
M v[136:139], a[184:187], a[48:51], v[136:139]
s_and_b32 s3, s2, 1
s_lshl_b32 s3, s3, 3
s_bfe_u32 s4, s2, 0x30003
M v[136:139], a[188:191], a[52:55], v[136:139]
s_add_u32 s26, s3, s4
s_bfe_u32 s3, s2, 0x20001
s_lshl_b32 s3, s3, 2
M v[140:143], a[188:191], a[60:63], v[140:143]
s_lshr_b32 s4, s2, 6
s_xor_b32 s4, s4, 3
s_add_u32 s27, s3, s4
M v[140:143], a[184:187], a[56:59], v[140:143]
ds_read_b64_tr_b16 a[116:117], v14 offset:49152
ds_read_b64_tr_b16 a[118:119], v14 offset:51200
s_lshl_b32 s23, s26, 18
s_sub_u32 s24, s23, 32768
s_max_i32 s24, s24, 0
M v[144:147], a[184:187], a[64:67], v[144:147]
s_lshl_b32 s25, s27, 7
s_mov_b64 s[8:9], s[44:45]
s_mov_b32 s10, 4194304
M v[144:147], a[188:191], a[68:71], v[144:147]
s_mov_b64 s[12:13], s[46:47]
s_mov_b32 s14, 6291456
s_mov_b64 s[36:37], s[90:91]
M v[148:151], a[188:191], a[76:79], v[148:151]
s_mov_b32 s38, 256
s_mov_b32 s39, 0x00020000
s_lshl_b32 s28, s20, 9
M v[148:151], a[184:187], a[72:75], v[148:151]
s_mul_i32 s30, s20, 6144
s_lshl_b32 s3, s20, 5
v_lshrrev_b32 v24, 3, v0
M v[152:155], a[184:187], a[80:83], v[152:155]
v_and_b32 v25, 7, v0
v_add_u32 v28, s3, v24
v_add_u32 v26, 0, v28
M v[152:155], a[188:191], a[84:87], v[152:155]
ds_read_b64_tr_b16 a[124:125], v15 offset:49152
ds_read_b64_tr_b16 a[126:127], v15 offset:51200
v_bfe_u32 v27, v26, 1, 3
v_xor_b32 v27, v27, v25
v_lshlrev_b32 v26, 11, v26
M v[156:159], a[188:191], a[92:95], v[156:159]
v_lshl_add_u32 v26, v27, 4, v26
v_subrev_u32 v2, 0, v26
v_add_u32 v26, 8, v28
M v[156:159], a[184:187], a[88:91], v[156:159]
s_waitcnt lgkmcnt(10)
v_bfe_u32 v27, v26, 1, 3
v_xor_b32 v27, v27, v25
v_lshlrev_b32 v26, 11, v26
M v[160:163], a[160:163], a[32:35], v[160:163]
v_lshl_add_u32 v26, v27, 4, v26
v_subrev_u32 v3, 1024, v26
v_add_u32 v26, 16, v28
M v[160:163], a[164:167], a[36:39], v[160:163]
ds_read_b128 a[176:179], v10 offset:20480
ds_read_b128 a[180:183], v11 offset:20480
v_bfe_u32 v27, v26, 1, 3
v_xor_b32 v27, v27, v25
v_lshlrev_b32 v26, 11, v26
M v[164:167], a[164:167], a[44:47], v[164:167]
v_lshl_add_u32 v26, v27, 4, v26
v_subrev_u32 v4, 2048, v26
v_add_u32 v26, 24, v28
M v[164:167], a[160:163], a[40:43], v[164:167]
ds_read_b64_tr_b16 a[132:133], v16 offset:49152
ds_read_b64_tr_b16 a[134:135], v16 offset:51200
v_bfe_u32 v27, v26, 1, 3
v_xor_b32 v27, v27, v25
v_lshlrev_b32 v26, 11, v26
M v[168:171], a[160:163], a[48:51], v[168:171]
v_lshl_add_u32 v26, v27, 4, v26
v_subrev_u32 v5, 3072, v26
s_lshl_b32 s3, s20, 2
M v[168:171], a[164:167], a[52:55], v[168:171]
v_lshrrev_b32 v26, 5, v0
v_add_u32 v26, s3, v26
v_bfe_u32 v29, v0, 2, 3
M v[172:175], a[164:167], a[60:63], v[172:175]
v_bfe_u32 v27, v26, 1, 3
v_xor_b32 v27, v27, v29
v_lshlrev_b32 v27, 4, v27
M v[172:175], a[160:163], a[56:59], v[172:175]
v_and_b32 v30, 3, v0
v_lshl_add_u32 v27, v30, 2, v27
v_lshl_add_u32 v20, v26, 11, v27
M v[176:179], a[160:163], a[64:67], v[176:179]
v_add_u32 v26, 2, v26
v_bfe_u32 v27, v26, 1, 3
v_xor_b32 v27, v27, v29
M v[176:179], a[164:167], a[68:71], v[176:179]
ds_read_b64_tr_b16 a[140:141], v17 offset:49152
ds_read_b64_tr_b16 a[142:143], v17 offset:51200
v_lshlrev_b32 v27, 4, v27
v_and_b32 v30, 3, v0
v_lshl_add_u32 v27, v30, 2, v27
M v[180:183], a[164:167], a[76:79], v[180:183]
v_lshl_add_u32 v23, v26, 11, v27
v_subrev_u32 v23, 256, v23
s_mul_i32 s3, s20, 48
M v[180:183], a[160:163], a[72:75], v[180:183]
v_add_u32 v28, s3, v24
v_add_u32 v26, 0, v28
v_mul_u32_u24 v27, 0xaaab, v26
M v[184:187], a[160:163], a[80:83], v[184:187]
v_lshrrev_b32 v27, 17, v27
v_lshrrev_b32 v29, 1, v27
v_and_b32 v29, 4, v29
M v[184:187], a[164:167], a[84:87], v[184:187]
v_and_or_b32 v27, v27, 2, v29
v_xor_b32 v27, v27, v25
v_lshlrev_b32 v26, 11, v26
M v[188:191], a[164:167], a[92:95], v[188:191]
v_lshl_add_u32 v26, v27, 4, v26
v_subrev_u32 v6, 0, v26
v_add_u32 v26, 8, v28
M v[188:191], a[160:163], a[88:91], v[188:191]
s_waitcnt lgkmcnt(12)
ds_read_b64_tr_b16 a[148:149], v18 offset:49152
ds_read_b64_tr_b16 a[150:151], v18 offset:51200
v_mul_u32_u24 v27, 0xaaab, v26
v_lshrrev_b32 v27, 17, v27
v_lshrrev_b32 v29, 1, v27
M v[192:195], a[168:171], a[32:35], v[192:195]
v_and_b32 v29, 4, v29
v_and_or_b32 v27, v27, 2, v29
v_xor_b32 v27, v27, v25
M v[192:195], a[172:175], a[36:39], v[192:195]
ds_read_b128 a[184:187], v10 offset:22528
ds_read_b128 a[188:191], v11 offset:22528
v_lshlrev_b32 v26, 11, v26
v_lshl_add_u32 v26, v27, 4, v26
v_subrev_u32 v7, 1024, v26
M v[196:199], a[172:175], a[44:47], v[196:199]
v_add_u32 v26, 16, v28
v_mul_u32_u24 v27, 0xaaab, v26
v_lshrrev_b32 v27, 17, v27
M v[196:199], a[168:171], a[40:43], v[196:199]
v_lshrrev_b32 v29, 1, v27
v_and_b32 v29, 4, v29
v_and_or_b32 v27, v27, 2, v29
M v[200:203], a[168:171], a[48:51], v[200:203]
v_xor_b32 v27, v27, v25
v_lshlrev_b32 v26, 11, v26
v_lshl_add_u32 v26, v27, 4, v26
M v[200:203], a[172:175], a[52:55], v[200:203]
ds_read_b64_tr_b16 a[156:157], v19 offset:49152
ds_read_b64_tr_b16 a[158:159], v19 offset:51200
v_subrev_u32 v8, 2048, v26
v_add_u32 v26, 24, v28
v_mul_u32_u24 v27, 0xaaab, v26
M v[204:207], a[172:175], a[60:63], v[204:207]
v_lshrrev_b32 v27, 17, v27
v_lshrrev_b32 v29, 1, v27
v_and_b32 v29, 4, v29
M v[204:207], a[168:171], a[56:59], v[204:207]
v_and_or_b32 v27, v27, 2, v29
v_xor_b32 v27, v27, v25
v_lshlrev_b32 v26, 11, v26
M v[208:211], a[168:171], a[64:67], v[208:211]
v_lshl_add_u32 v26, v27, 4, v26
v_subrev_u32 v9, 3072, v26
v_add_u32 v26, 32, v28
M v[208:211], a[172:175], a[68:71], v[208:211]
v_mul_u32_u24 v27, 0xaaab, v26
v_lshrrev_b32 v27, 17, v27
v_lshrrev_b32 v29, 1, v27
M v[212:215], a[172:175], a[76:79], v[212:215]
v_and_b32 v29, 4, v29
v_and_or_b32 v27, v27, 2, v29
v_xor_b32 v27, v27, v25
M v[212:215], a[168:171], a[72:75], v[212:215]
v_lshlrev_b32 v26, 11, v26
v_lshl_add_u32 v26, v27, 4, v26
v_subrev_u32 v21, 0, v26
M v[216:219], a[168:171], a[80:83], v[216:219]
v_add_u32 v26, 40, v28
v_mul_u32_u24 v27, 0xaaab, v26
v_lshrrev_b32 v27, 17, v27
M v[216:219], a[172:175], a[84:87], v[216:219]
v_lshrrev_b32 v29, 1, v27
v_and_b32 v29, 4, v29
v_and_or_b32 v27, v27, 2, v29
M v[220:223], a[172:175], a[92:95], v[220:223]
v_xor_b32 v27, v27, v25
v_lshlrev_b32 v26, 11, v26
v_lshl_add_u32 v26, v27, 4, v26
M v[220:223], a[168:171], a[88:91], v[220:223]
s_waitcnt lgkmcnt(10)
v_subrev_u32 v22, 1024, v26
s_lshr_b32 s3, s53, 7
s_add_u32 s3, s3, s22
M v[224:227], a[176:179], a[32:35], v[224:227]
s_lshl_b32 s3, s3, 5
s_lshr_b32 s19, s52, 6
s_add_u32 s3, s3, s19
M v[224:227], a[180:183], a[36:39], v[224:227]
s_lshl_b32 s19, s21, 1
s_add_u32 s3, s3, s19
s_lshl_b32 s92, s3, 15
M v[228:231], a[180:183], a[44:47], v[228:231]
s_add_u32 s92, s92, 16384
s_add_u32 s93, s92, 32768
s_add_u32 s16, s50, 16777216
M v[228:231], a[176:179], a[40:43], v[228:231]
s_addc_u32 s17, s51, 0
s_mov_b32 s18, 33554432
s_mov_b32 s19, 0x00020000
M v[232:235], a[176:179], a[48:51], v[232:235]
M v[232:235], a[180:183], a[52:55], v[232:235]
M v[236:239], a[180:183], a[60:63], v[236:239]
M v[236:239], a[176:179], a[56:59], v[236:239]
s_waitcnt vmcnt(4) lgkmcnt(0)
s_barrier
ds_read_b128 a[160:163], v10 offset:32768
ds_read_b128 a[164:167], v11 offset:32768
M v[240:243], a[176:179], a[64:67], v[240:243]
s_add_u32 m0, s28, 131072
s_nop 0
buffer_load_dword v20, s[8:11], s24 offen lds
M v[240:243], a[180:183], a[68:71], v[240:243]
M v[244:247], a[180:183], a[76:79], v[244:247]
M v[244:247], a[176:179], a[72:75], v[244:247]
M v[248:251], a[176:179], a[80:83], v[248:251]
buffer_load_dword v23, s[8:11], s24 offen offset:256 lds
s_add_u32 s24, s24, 128
M v[248:251], a[180:183], a[84:87], v[248:251]
M v[252:255], a[180:183], a[92:95], v[252:255]
M v[252:255], a[176:179], a[88:91], v[252:255]
M a[0:3], a[184:187], a[32:35], a[0:3]
M a[0:3], a[188:191], a[36:39], a[0:3]
ds_read_b128 a[168:171], v10 offset:34816
ds_read_b128 a[172:175], v11 offset:34816
M a[4:7], a[188:191], a[44:47], a[4:7]
s_add_u32 m0, s29, 133120
s_nop 0
buffer_load_dwordx4 v2, s[8:11], s23 offen offset:0 lds
M a[4:7], a[184:187], a[40:43], a[4:7]
M a[8:11], a[184:187], a[48:51], a[8:11]
M a[8:11], a[188:191], a[52:55], a[8:11]
M a[12:15], a[188:191], a[60:63], a[12:15]
buffer_load_dwordx4 v3, s[8:11], s23 offen offset:1024 lds
M a[12:15], a[184:187], a[56:59], a[12:15]
M a[16:19], a[184:187], a[64:67], a[16:19]
M a[16:19], a[188:191], a[68:71], a[16:19]
M a[20:23], a[188:191], a[76:79], a[20:23]
buffer_load_dwordx4 v4, s[8:11], s23 offen offset:2048 lds
M a[20:23], a[184:187], a[72:75], a[20:23]
M a[24:27], a[184:187], a[80:83], a[24:27]
M a[24:27], a[188:191], a[84:87], a[24:27]
M a[28:31], a[188:191], a[92:95], a[28:31]
M a[28:31], a[184:187], a[88:91], a[28:31]
s_waitcnt lgkmcnt(2)
M v[32:35], a[160:163], a[96:99], v[32:35]
buffer_load_dwordx4 v5, s[8:11], s23 offen offset:3072 lds
s_add_u32 s23, s23, 128
M v[32:35], a[164:167], a[100:103], v[32:35]
ds_read_b128 a[176:179], v10 offset:36864
ds_read_b128 a[180:183], v11 offset:36864
M v[36:39], a[164:167], a[108:111], v[36:39]
M v[36:39], a[160:163], a[104:107], v[36:39]
M v[40:43], a[160:163], a[112:115], v[40:43]
M v[40:43], a[164:167], a[116:119], v[40:43]
s_add_u32 m0, s30, 65536
s_nop 0
buffer_load_dwordx4 v6, s[12:15], s25 offen offset:0 lds
M v[44:47], a[164:167], a[124:127], v[44:47]
M v[44:47], a[160:163], a[120:123], v[44:47]
M v[48:51], a[160:163], a[128:131], v[48:51]
M v[48:51], a[164:167], a[132:135], v[48:51]
M v[52:55], a[164:167], a[140:143], v[52:55]
buffer_load_dwordx4 v7, s[12:15], s25 offen offset:1024 lds
M v[52:55], a[160:163], a[136:139], v[52:55]
M v[56:59], a[160:163], a[144:147], v[56:59]
M v[56:59], a[164:167], a[148:151], v[56:59]
M v[60:63], a[164:167], a[156:159], v[60:63]
M v[60:63], a[160:163], a[152:155], v[60:63]
s_waitcnt lgkmcnt(2)
M v[64:67], a[168:171], a[96:99], v[64:67]
buffer_load_dwordx4 v8, s[12:15], s25 offen offset:2048 lds
M v[64:67], a[172:175], a[100:103], v[64:67]
ds_read_b128 a[184:187], v10 offset:38912
ds_read_b128 a[188:191], v11 offset:38912
M v[68:71], a[172:175], a[108:111], v[68:71]
M v[68:71], a[168:171], a[104:107], v[68:71]
M v[72:75], a[168:171], a[112:115], v[72:75]
M v[72:75], a[172:175], a[116:119], v[72:75]
buffer_load_dwordx4 v9, s[12:15], s25 offen offset:3072 lds
M v[76:79], a[172:175], a[124:127], v[76:79]
M v[76:79], a[168:171], a[120:123], v[76:79]
M v[80:83], a[168:171], a[128:131], v[80:83]
M v[80:83], a[172:175], a[132:135], v[80:83]
M v[84:87], a[172:175], a[140:143], v[84:87]
s_add_u32 m0, s30, 69632
s_nop 0
buffer_load_dwordx4 v21, s[12:15], s25 offen offset:0 lds
M v[84:87], a[168:171], a[136:139], v[84:87]
M v[88:91], a[168:171], a[144:147], v[88:91]
M v[88:91], a[172:175], a[148:151], v[88:91]
M v[92:95], a[172:175], a[156:159], v[92:95]
M v[92:95], a[168:171], a[152:155], v[92:95]
s_waitcnt lgkmcnt(2)
M v[96:99], a[176:179], a[96:99], v[96:99]
buffer_load_dwordx4 v22, s[12:15], s25 offen offset:1024 lds
s_add_u32 s25, s25, 393216
M v[96:99], a[180:183], a[100:103], v[96:99]
M v[100:103], a[180:183], a[108:111], v[100:103]
M v[100:103], a[176:179], a[104:107], v[100:103]
v_cvt_pk_bf16_f32 v32, v32, v33
v_cvt_pk_bf16_f32 v33, v34, v35
M v[104:107], a[176:179], a[112:115], v[104:107]
v_cvt_pk_bf16_f32 v34, v64, v65
v_cvt_pk_bf16_f32 v35, v66, v67
M v[104:107], a[180:183], a[116:119], v[104:107]
v_cvt_pk_bf16_f32 v64, v48, v49
M v[108:111], a[180:183], a[124:127], v[108:111]
v_cvt_pk_bf16_f32 v65, v50, v51
v_cvt_pk_bf16_f32 v66, v80, v81
M v[108:111], a[176:179], a[120:123], v[108:111]
s_waitcnt vmcnt(12) lgkmcnt(0)
s_barrier
ds_read_b128 a[160:163], v10 offset:49152
ds_read_b128 a[164:167], v11 offset:49152
v_cvt_pk_bf16_f32 v67, v82, v83
M v[112:115], a[176:179], a[128:131], v[112:115]
s_add_u32 m0, s28, 0
s_nop 0
buffer_load_dword v20, s[8:11], s24 offen lds
v_cvt_pk_bf16_f32 v48, v40, v41
v_cvt_pk_bf16_f32 v49, v42, v43
M v[112:115], a[180:183], a[132:135], v[112:115]
v_cvt_pk_bf16_f32 v50, v72, v73
v_cvt_pk_bf16_f32 v51, v74, v75
M v[116:119], a[180:183], a[140:143], v[116:119]
v_cvt_pk_bf16_f32 v80, v56, v57
M v[116:119], a[176:179], a[136:139], v[116:119]
buffer_load_dword v23, s[8:11], s24 offen offset:256 lds
s_add_u32 s24, s24, 128
v_cvt_pk_bf16_f32 v81, v58, v59
v_cvt_pk_bf16_f32 v82, v88, v89
M v[120:123], a[176:179], a[144:147], v[120:123]
v_cvt_pk_bf16_f32 v83, v90, v91
M v[120:123], a[180:183], a[148:151], v[120:123]
v_cvt_pk_bf16_f32 v40, v36, v37
v_cvt_pk_bf16_f32 v41, v38, v39
M v[124:127], a[180:183], a[156:159], v[124:127]
v_cvt_pk_bf16_f32 v42, v68, v69
v_cvt_pk_bf16_f32 v43, v70, v71
M v[124:127], a[176:179], a[152:155], v[124:127]
v_cvt_pk_bf16_f32 v72, v52, v53
M v[128:131], a[184:187], a[96:99], v[128:131]
s_add_u32 m0, s29, 2048
s_nop 0
buffer_load_dwordx4 v2, s[8:11], s23 offen offset:0 lds
v_cvt_pk_bf16_f32 v73, v54, v55
v_cvt_pk_bf16_f32 v74, v84, v85
M v[128:131], a[188:191], a[100:103], v[128:131]
ds_read_b128 a[168:171], v10 offset:51200
ds_read_b128 a[172:175], v11 offset:51200
v_cvt_pk_bf16_f32 v75, v86, v87
M v[132:135], a[188:191], a[108:111], v[132:135]
v_cvt_pk_bf16_f32 v56, v44, v45
v_cvt_pk_bf16_f32 v57, v46, v47
M v[132:135], a[184:187], a[104:107], v[132:135]
v_cvt_pk_bf16_f32 v58, v76, v77
v_cvt_pk_bf16_f32 v59, v78, v79
M v[136:139], a[184:187], a[112:115], v[136:139]
v_cvt_pk_bf16_f32 v88, v60, v61
M v[136:139], a[188:191], a[116:119], v[136:139]
buffer_load_dwordx4 v3, s[8:11], s23 offen offset:1024 lds
v_cvt_pk_bf16_f32 v89, v62, v63
v_cvt_pk_bf16_f32 v90, v92, v93
M v[140:143], a[188:191], a[124:127], v[140:143]
v_cvt_pk_bf16_f32 v91, v94, v95
M v[140:143], a[184:187], a[120:123], v[140:143]
M v[144:147], a[184:187], a[128:131], v[144:147]
buffer_load_dwordx4 v4, s[8:11], s23 offen offset:2048 lds
M v[144:147], a[188:191], a[132:135], v[144:147]
M v[148:151], a[188:191], a[140:143], v[148:151]
s_add_u32 s94, s92, 0
buffer_store_dwordx4 v[32:35], v1, s[16:19], s94 offen offset:0 sc1
M v[148:151], a[184:187], a[136:139], v[148:151]
M v[152:155], a[184:187], a[144:147], v[152:155]
M v[152:155], a[188:191], a[148:151], v[152:155]
buffer_load_dwordx4 v5, s[8:11], s23 offen offset:3072 lds
s_add_u32 s23, s23, 128
M v[156:159], a[188:191], a[156:159], v[156:159]
s_add_u32 s94, s92, 0
buffer_store_dwordx4 v[40:43], v1, s[16:19], s94 offen offset:1024 sc1
M v[156:159], a[184:187], a[152:155], v[156:159]
s_waitcnt lgkmcnt(2)
M v[160:163], a[160:163], a[96:99], v[160:163]
M v[160:163], a[164:167], a[100:103], v[160:163]
ds_read_b128 a[176:179], v10 offset:53248
ds_read_b128 a[180:183], v11 offset:53248
M v[164:167], a[164:167], a[108:111], v[164:167]
s_add_u32 s94, s92, 0
buffer_store_dwordx4 v[48:51], v1, s[16:19], s94 offen offset:2048 sc1
M v[164:167], a[160:163], a[104:107], v[164:167]
v_cvt_pk_bf16_f32 v96, v96, v97
v_cvt_pk_bf16_f32 v97, v98, v99
M v[168:171], a[160:163], a[112:115], v[168:171]
v_cvt_pk_bf16_f32 v98, v128, v129
v_cvt_pk_bf16_f32 v99, v130, v131
M v[168:171], a[164:167], a[116:119], v[168:171]
s_add_u32 m0, s30, 98304
s_nop 0
buffer_load_dwordx4 v6, s[12:15], s25 offen offset:0 lds
v_cvt_pk_bf16_f32 v128, v112, v113
M v[172:175], a[164:167], a[124:127], v[172:175]
s_add_u32 s94, s92, 0
buffer_store_dwordx4 v[56:59], v1, s[16:19], s94 offen offset:3072 sc1
v_cvt_pk_bf16_f32 v129, v114, v115
v_cvt_pk_bf16_f32 v130, v144, v145
M v[172:175], a[160:163], a[120:123], v[172:175]
v_cvt_pk_bf16_f32 v131, v146, v147
M v[176:179], a[160:163], a[128:131], v[176:179]
v_cvt_pk_bf16_f32 v112, v104, v105
v_cvt_pk_bf16_f32 v113, v106, v107
M v[176:179], a[164:167], a[132:135], v[176:179]
buffer_load_dwordx4 v7, s[12:15], s25 offen offset:1024 lds
v_cvt_pk_bf16_f32 v114, v136, v137
v_cvt_pk_bf16_f32 v115, v138, v139
M v[180:183], a[164:167], a[140:143], v[180:183]
s_add_u32 s94, s92, 4096
buffer_store_dwordx4 v[64:67], v1, s[16:19], s94 offen offset:0 sc1
v_cvt_pk_bf16_f32 v144, v120, v121
M v[180:183], a[160:163], a[136:139], v[180:183]
v_cvt_pk_bf16_f32 v145, v122, v123
v_cvt_pk_bf16_f32 v146, v152, v153
M v[184:187], a[160:163], a[144:147], v[184:187]
v_cvt_pk_bf16_f32 v147, v154, v155
M v[184:187], a[164:167], a[148:151], v[184:187]
v_cvt_pk_bf16_f32 v104, v100, v101
v_cvt_pk_bf16_f32 v105, v102, v103
M v[188:191], a[164:167], a[156:159], v[188:191]
s_add_u32 s94, s92, 4096
buffer_store_dwordx4 v[72:75], v1, s[16:19], s94 offen offset:1024 sc1
v_cvt_pk_bf16_f32 v106, v132, v133
v_cvt_pk_bf16_f32 v107, v134, v135
M v[188:191], a[160:163], a[152:155], v[188:191]
s_waitcnt lgkmcnt(2)
v_cvt_pk_bf16_f32 v136, v116, v117
M v[192:195], a[168:171], a[96:99], v[192:195]
buffer_load_dwordx4 v8, s[12:15], s25 offen offset:2048 lds
v_cvt_pk_bf16_f32 v137, v118, v119
v_cvt_pk_bf16_f32 v138, v148, v149
M v[192:195], a[172:175], a[100:103], v[192:195]
ds_read_b128 a[184:187], v10 offset:55296
ds_read_b128 a[188:191], v11 offset:55296
v_cvt_pk_bf16_f32 v139, v150, v151
M v[196:199], a[172:175], a[108:111], v[196:199]
s_add_u32 s94, s92, 4096
buffer_store_dwordx4 v[80:83], v1, s[16:19], s94 offen offset:2048 sc1
v_cvt_pk_bf16_f32 v120, v108, v109
v_cvt_pk_bf16_f32 v121, v110, v111
M v[196:199], a[168:171], a[104:107], v[196:199]
v_cvt_pk_bf16_f32 v122, v140, v141
v_cvt_pk_bf16_f32 v123, v142, v143
M v[200:203], a[168:171], a[112:115], v[200:203]
v_cvt_pk_bf16_f32 v152, v124, v125
M v[200:203], a[172:175], a[116:119], v[200:203]
v_cvt_pk_bf16_f32 v153, v126, v127
v_cvt_pk_bf16_f32 v154, v156, v157
M v[204:207], a[172:175], a[124:127], v[204:207]
s_add_u32 s94, s92, 4096
buffer_store_dwordx4 v[88:91], v1, s[16:19], s94 offen offset:3072 sc1
v_cvt_pk_bf16_f32 v155, v158, v159
M v[204:207], a[168:171], a[120:123], v[204:207]
buffer_load_dwordx4 v9, s[12:15], s25 offen offset:3072 lds
M v[208:211], a[168:171], a[128:131], v[208:211]
M v[208:211], a[172:175], a[132:135], v[208:211]
M v[212:215], a[172:175], a[140:143], v[212:215]
s_add_u32 m0, s30, 102400
s_nop 0
buffer_load_dwordx4 v21, s[12:15], s25 offen offset:0 lds
M v[212:215], a[168:171], a[136:139], v[212:215]
M v[216:219], a[168:171], a[144:147], v[216:219]
s_add_u32 s94, s92, 8192
buffer_store_dwordx4 v[96:99], v1, s[16:19], s94 offen offset:0 sc1
M v[216:219], a[172:175], a[148:151], v[216:219]
M v[220:223], a[172:175], a[156:159], v[220:223]
M v[220:223], a[168:171], a[152:155], v[220:223]
s_waitcnt lgkmcnt(2)
M v[224:227], a[176:179], a[96:99], v[224:227]
buffer_load_dwordx4 v22, s[12:15], s25 offen offset:1024 lds
s_add_u32 s25, s25, 393216
M v[224:227], a[180:183], a[100:103], v[224:227]
M v[228:231], a[180:183], a[108:111], v[228:231]
s_add_u32 s94, s92, 8192
buffer_store_dwordx4 v[104:107], v1, s[16:19], s94 offen offset:1024 sc1
M v[228:231], a[176:179], a[104:107], v[228:231]
v_cvt_pk_bf16_f32 v160, v160, v161
v_cvt_pk_bf16_f32 v161, v162, v163
M v[232:235], a[176:179], a[112:115], v[232:235]
v_cvt_pk_bf16_f32 v162, v192, v193
v_cvt_pk_bf16_f32 v163, v194, v195
M v[232:235], a[180:183], a[116:119], v[232:235]
v_cvt_pk_bf16_f32 v192, v176, v177
M v[236:239], a[180:183], a[124:127], v[236:239]
v_cvt_pk_bf16_f32 v193, v178, v179
v_cvt_pk_bf16_f32 v194, v208, v209
M v[236:239], a[176:179], a[120:123], v[236:239]
s_waitcnt vmcnt(63) lgkmcnt(0)
s_barrier
v_cvt_pk_bf16_f32 v195, v210, v211
M v[240:243], a[176:179], a[128:131], v[240:243]
s_add_u32 s94, s92, 8192
buffer_store_dwordx4 v[112:115], v1, s[16:19], s94 offen offset:2048 sc1
v_cvt_pk_bf16_f32 v176, v168, v169
v_cvt_pk_bf16_f32 v177, v170, v171
M v[240:243], a[180:183], a[132:135], v[240:243]
s_add_u32 m0, s28, 18432
s_nop 0
buffer_load_dword v20, s[8:11], s24 offen lds
v_cvt_pk_bf16_f32 v178, v200, v201
v_cvt_pk_bf16_f32 v179, v202, v203
M v[244:247], a[180:183], a[140:143], v[244:247]
v_cvt_pk_bf16_f32 v208, v184, v185
M v[244:247], a[176:179], a[136:139], v[244:247]
v_cvt_pk_bf16_f32 v209, v186, v187
v_cvt_pk_bf16_f32 v210, v216, v217
M v[248:251], a[176:179], a[144:147], v[248:251]
buffer_load_dword v23, s[8:11], s24 offen offset:256 lds
s_add_u32 s24, s24, 128
v_cvt_pk_bf16_f32 v211, v218, v219
M v[248:251], a[180:183], a[148:151], v[248:251]
v_cvt_pk_bf16_f32 v168, v164, v165
v_cvt_pk_bf16_f32 v169, v166, v167
M v[252:255], a[180:183], a[156:159], v[252:255]
s_add_u32 s94, s92, 8192
buffer_store_dwordx4 v[120:123], v1, s[16:19], s94 offen offset:3072 sc1
v_cvt_pk_bf16_f32 v170, v196, v197
v_cvt_pk_bf16_f32 v171, v198, v199
M v[252:255], a[176:179], a[152:155], v[252:255]
v_cvt_pk_bf16_f32 v200, v180, v181
M a[0:3], a[184:187], a[96:99], a[0:3]
v_cvt_pk_bf16_f32 v201, v182, v183
v_cvt_pk_bf16_f32 v202, v212, v213
M a[0:3], a[188:191], a[100:103], a[0:3]
v_cvt_pk_bf16_f32 v203, v214, v215
M a[4:7], a[188:191], a[108:111], a[4:7]
s_add_u32 m0, s29, 20480
s_nop 0
buffer_load_dwordx4 v2, s[8:11], s23 offen offset:0 lds
v_cvt_pk_bf16_f32 v184, v172, v173
v_cvt_pk_bf16_f32 v185, v174, v175
M a[4:7], a[184:187], a[104:107], a[4:7]
v_cvt_pk_bf16_f32 v186, v204, v205
v_cvt_pk_bf16_f32 v187, v206, v207
M a[8:11], a[184:187], a[112:115], a[8:11]
s_add_u32 s94, s92, 12288
buffer_store_dwordx4 v[128:131], v1, s[16:19], s94 offen offset:0 sc1
v_cvt_pk_bf16_f32 v216, v188, v189
M a[8:11], a[188:191], a[116:119], a[8:11]
v_cvt_pk_bf16_f32 v217, v190, v191
v_cvt_pk_bf16_f32 v218, v220, v221
M a[12:15], a[188:191], a[124:127], a[12:15]
buffer_load_dwordx4 v3, s[8:11], s23 offen offset:1024 lds
v_cvt_pk_bf16_f32 v219, v222, v223
M a[12:15], a[184:187], a[120:123], a[12:15]
M a[16:19], a[184:187], a[128:131], a[16:19]
M a[16:19], a[188:191], a[132:135], a[16:19]
M a[20:23], a[188:191], a[140:143], a[20:23]
s_add_u32 s94, s92, 12288
buffer_store_dwordx4 v[136:139], v1, s[16:19], s94 offen offset:1024 sc1
M a[20:23], a[184:187], a[136:139], a[20:23]
buffer_load_dwordx4 v4, s[8:11], s23 offen offset:2048 lds
M a[24:27], a[184:187], a[144:147], a[24:27]
M a[24:27], a[188:191], a[148:151], a[24:27]
M a[28:31], a[188:191], a[156:159], a[28:31]
M a[28:31], a[184:187], a[152:155], a[28:31]
v_accvgpr_read_b32 v24, a0
v_accvgpr_read_b32 v25, a1
v_accvgpr_read_b32 v26, a2
v_accvgpr_read_b32 v27, a3
v_cvt_pk_bf16_f32 v224, v224, v225
v_cvt_pk_bf16_f32 v225, v226, v227
v_cvt_pk_bf16_f32 v226, v24, v25
v_cvt_pk_bf16_f32 v227, v26, v27
v_accvgpr_read_b32 v24, a16
v_accvgpr_read_b32 v25, a17
v_accvgpr_read_b32 v26, a18
v_accvgpr_read_b32 v27, a19
v_cvt_pk_bf16_f32 v36, v240, v241
v_cvt_pk_bf16_f32 v37, v242, v243
v_cvt_pk_bf16_f32 v38, v24, v25
v_cvt_pk_bf16_f32 v39, v26, v27
v_accvgpr_read_b32 v24, a24
v_accvgpr_read_b32 v25, a25
v_accvgpr_read_b32 v26, a26
v_accvgpr_read_b32 v27, a27
v_cvt_pk_bf16_f32 v52, v248, v249
v_cvt_pk_bf16_f32 v53, v250, v251
v_cvt_pk_bf16_f32 v54, v24, v25
v_cvt_pk_bf16_f32 v55, v26, v27
v_accvgpr_read_b32 v24, a8
v_accvgpr_read_b32 v25, a9
v_accvgpr_read_b32 v26, a10
v_accvgpr_read_b32 v27, a11
v_cvt_pk_bf16_f32 v240, v232, v233
v_cvt_pk_bf16_f32 v241, v234, v235
v_cvt_pk_bf16_f32 v242, v24, v25
v_cvt_pk_bf16_f32 v243, v26, v27
v_accvgpr_read_b32 v28, a4
v_accvgpr_read_b32 v29, a5
v_accvgpr_read_b32 v30, a6
v_accvgpr_read_b32 v31, a7
v_cvt_pk_bf16_f32 v232, v228, v229
v_cvt_pk_bf16_f32 v233, v230, v231
v_cvt_pk_bf16_f32 v234, v28, v29
v_cvt_pk_bf16_f32 v235, v30, v31
v_accvgpr_read_b32 v28, a12
v_accvgpr_read_b32 v29, a13
v_accvgpr_read_b32 v30, a14
v_accvgpr_read_b32 v31, a15
v_cvt_pk_bf16_f32 v248, v236, v237
v_cvt_pk_bf16_f32 v249, v238, v239
v_cvt_pk_bf16_f32 v250, v28, v29
v_cvt_pk_bf16_f32 v251, v30, v31
v_accvgpr_read_b32 v28, a20
v_accvgpr_read_b32 v29, a21
v_accvgpr_read_b32 v30, a22
v_accvgpr_read_b32 v31, a23
v_cvt_pk_bf16_f32 v44, v244, v245
v_cvt_pk_bf16_f32 v45, v246, v247
v_cvt_pk_bf16_f32 v46, v28, v29
v_cvt_pk_bf16_f32 v47, v30, v31
v_accvgpr_read_b32 v28, a28
v_accvgpr_read_b32 v29, a29
v_accvgpr_read_b32 v30, a30
v_accvgpr_read_b32 v31, a31
v_cvt_pk_bf16_f32 v60, v252, v253
v_cvt_pk_bf16_f32 v61, v254, v255
v_cvt_pk_bf16_f32 v62, v28, v29
v_cvt_pk_bf16_f32 v63, v30, v31
Lk1_b:
v_and_b32 v24, 15, v0
v_lshlrev_b32 v24, 7, v24
v_bfe_u32 v25, v0, 1, 3
v_lshrrev_b32 v26, 4, v0
v_xor_b32 v25, v25, v26
v_lshl_add_u32 v10, v25, 4, v24
v_xor_b32 v11, 64, v10
v_add_u32 v12, 131072, v10
v_add_u32 v13, 131072, v11
v_bfe_u32 v24, v0, 2, 2
v_lshl_add_u32 v29, v26, 3, v24
v_mul_u32_u24 v25, 384, v29
v_and_b32 v27, 1, v0
v_lshl_add_u32 v25, v27, 3, v25
v_add_u32 v25, 36864, v25
v_lshrrev_b32 v24, 1, v29
v_and_b32 v24, 4, v24
v_and_or_b32 v24, v29, 2, v24
v_bfe_u32 v26, v0, 1, 1
s_mul_i32 s4, s20, 3
s_add_u32 s3, s4, 0
s_and_b32 s5, s3, 3
s_lshl_b32 s5, s5, 1
s_lshr_b32 s3, s3, 2
s_lshl_b32 s3, s3, 7
v_add_u32 v27, s5, v26
v_xor_b32 v27, v27, v24
v_lshl_add_u32 v27, v27, 4, v25
v_add_u32 v14, s3, v27
v_add_u32 v17, 61440, v14
s_add_u32 s3, s4, 1
s_and_b32 s5, s3, 3
s_lshl_b32 s5, s5, 1
s_lshr_b32 s3, s3, 2
s_lshl_b32 s3, s3, 7
v_add_u32 v27, s5, v26
v_xor_b32 v27, v27, v24
v_lshl_add_u32 v27, v27, 4, v25
v_add_u32 v15, s3, v27
v_add_u32 v18, 61440, v15
s_add_u32 s3, s4, 2
s_and_b32 s5, s3, 3
s_lshl_b32 s5, s5, 1
s_lshr_b32 s3, s3, 2
s_lshl_b32 s3, s3, 7
v_add_u32 v27, s5, v26
v_xor_b32 v27, v27, v24
v_lshl_add_u32 v27, v27, 4, v25
v_add_u32 v16, s3, v27
v_add_u32 v19, 61440, v16
s_waitcnt vmcnt(9)
s_barrier
ds_read_b64_tr_b16 a[176:177], v14 offset:28672
ds_read_b64_tr_b16 a[178:179], v14 offset:30208
ds_read_b64_tr_b16 a[184:185], v15 offset:28672
ds_read_b64_tr_b16 a[186:187], v15 offset:30208
ds_read_b64_tr_b16 a[192:193], v16 offset:28672
ds_read_b64_tr_b16 a[194:195], v16 offset:30208
ds_read_b64_tr_b16 a[180:181], v14 offset:40960
ds_read_b64_tr_b16 a[182:183], v14 offset:42496
ds_read_b64_tr_b16 a[188:189], v15 offset:40960
ds_read_b64_tr_b16 a[190:191], v15 offset:42496
ds_read_b64_tr_b16 a[196:197], v16 offset:40960
ds_read_b64_tr_b16 a[198:199], v16 offset:42496
ds_read_b128 a[224:227], v12 offset:0
ds_read_b128 a[228:231], v13 offset:0
ds_read_b128 a[232:235], v12 offset:2048
ds_read_b128 a[236:239], v13 offset:2048
ds_read_b128 a[240:243], v12 offset:4096
ds_read_b128 a[244:247], v13 offset:4096
s_waitcnt lgkmcnt(0)
s_barrier
M a[68:71], a[176:179], a[224:227], 0
ds_read_b128 a[248:251], v12 offset:6144
ds_read_b128 a[252:255], v13 offset:6144
M a[68:71], a[180:183], a[228:231], a[68:71]
buffer_load_dwordx4 v5, s[8:11], s23 offen offset:3072 lds
s_add_u32 s23, s23, 128
M a[72:75], a[188:191], a[228:231], 0
ds_read_b64_tr_b16 a[200:201], v17 offset:0
ds_read_b64_tr_b16 a[202:203], v17 offset:1536
M a[72:75], a[184:187], a[224:227], a[72:75]
M a[76:79], a[192:195], a[224:227], 0
s_add_u32 m0, s30, 36864
s_nop 0
buffer_load_dwordx4 v6, s[12:15], s25 offen offset:0 lds
M a[76:79], a[196:199], a[228:231], a[76:79]
M a[80:83], a[180:183], a[236:239], 0
ds_read_b128 a[224:227], v12 offset:8192
ds_read_b128 a[228:231], v13 offset:8192
M a[80:83], a[176:179], a[232:235], a[80:83]
buffer_load_dwordx4 v7, s[12:15], s25 offen offset:1024 lds
M a[84:87], a[184:187], a[232:235], 0
ds_read_b64_tr_b16 a[208:209], v18 offset:0
ds_read_b64_tr_b16 a[210:211], v18 offset:1536
M a[84:87], a[188:191], a[236:239], a[84:87]
M a[88:91], a[196:199], a[236:239], 0
buffer_load_dwordx4 v8, s[12:15], s25 offen offset:2048 lds
M a[88:91], a[192:195], a[232:235], a[88:91]
M a[92:95], a[176:179], a[240:243], 0
ds_read_b128 a[232:235], v12 offset:10240
ds_read_b128 a[236:239], v13 offset:10240
M a[92:95], a[180:183], a[244:247], a[92:95]
buffer_load_dwordx4 v9, s[12:15], s25 offen offset:3072 lds
M a[96:99], a[188:191], a[244:247], 0
ds_read_b64_tr_b16 a[216:217], v19 offset:0
ds_read_b64_tr_b16 a[218:219], v19 offset:1536
M a[96:99], a[184:187], a[240:243], a[96:99]
M a[100:103], a[192:195], a[240:243], 0
s_add_u32 m0, s30, 40960
s_nop 0
buffer_load_dwordx4 v21, s[12:15], s25 offen offset:0 lds
M a[100:103], a[196:199], a[244:247], a[100:103]
s_waitcnt lgkmcnt(10)
M a[104:107], a[180:183], a[252:255], 0
ds_read_b128 a[240:243], v12 offset:12288
ds_read_b128 a[244:247], v13 offset:12288
M a[104:107], a[176:179], a[248:251], a[104:107]
buffer_load_dwordx4 v22, s[12:15], s25 offen offset:1024 lds
s_add_u32 s25, s25, 393216
M a[108:111], a[184:187], a[248:251], 0
ds_read_b64_tr_b16 a[204:205], v17 offset:12288
ds_read_b64_tr_b16 a[206:207], v17 offset:13824
M a[108:111], a[188:191], a[252:255], a[108:111]
M a[112:115], a[196:199], a[252:255], 0
s_add_u32 m0, s30, 65536
s_nop 0
buffer_load_dwordx4 v6, s[12:15], s25 offen offset:0 lds
M a[112:115], a[192:195], a[248:251], a[112:115]
s_waitcnt lgkmcnt(10)
M a[116:119], a[176:179], a[224:227], 0
ds_read_b128 a[248:251], v12 offset:14336
ds_read_b128 a[252:255], v13 offset:14336
M a[116:119], a[180:183], a[228:231], a[116:119]
buffer_load_dwordx4 v7, s[12:15], s25 offen offset:1024 lds
M a[120:123], a[188:191], a[228:231], 0
ds_read_b64_tr_b16 a[212:213], v18 offset:12288
ds_read_b64_tr_b16 a[214:215], v18 offset:13824
M a[120:123], a[184:187], a[224:227], a[120:123]
M a[124:127], a[192:195], a[224:227], 0
buffer_load_dwordx4 v8, s[12:15], s25 offen offset:2048 lds
M a[124:127], a[196:199], a[228:231], a[124:127]
s_waitcnt lgkmcnt(10)
M a[128:131], a[180:183], a[236:239], 0
ds_read_b128 a[224:227], v12 offset:16384
ds_read_b128 a[228:231], v13 offset:16384
M a[128:131], a[176:179], a[232:235], a[128:131]
buffer_load_dwordx4 v9, s[12:15], s25 offen offset:3072 lds
M a[132:135], a[184:187], a[232:235], 0
ds_read_b64_tr_b16 a[220:221], v19 offset:12288
ds_read_b64_tr_b16 a[222:223], v19 offset:13824
M a[132:135], a[188:191], a[236:239], a[132:135]
M a[136:139], a[196:199], a[236:239], 0
s_add_u32 m0, s30, 69632
s_nop 0
buffer_load_dwordx4 v21, s[12:15], s25 offen offset:0 lds
M a[136:139], a[192:195], a[232:235], a[136:139]
s_waitcnt lgkmcnt(10)
M a[140:143], a[176:179], a[240:243], 0
buffer_load_dwordx4 v22, s[12:15], s25 offen offset:1024 lds
s_add_u32 s25, s25, 393216
M a[140:143], a[180:183], a[244:247], a[140:143]
M a[144:147], a[188:191], a[244:247], 0
M a[144:147], a[184:187], a[240:243], a[144:147]
M a[148:151], a[192:195], a[240:243], 0
s_waitcnt vmcnt(6) lgkmcnt(0)
s_barrier
ds_read_b128 a[232:235], v10 offset:0
ds_read_b128 a[236:239], v11 offset:0
M a[148:151], a[196:199], a[244:247], a[148:151]
s_add_u32 m0, s28, 131072
s_nop 0
buffer_load_dword v20, s[8:11], s24 offen lds
M a[152:155], a[180:183], a[252:255], 0
ds_read_b128 a[240:243], v10 offset:2048
ds_read_b128 a[244:247], v11 offset:2048
M a[152:155], a[176:179], a[248:251], a[152:155]
M a[156:159], a[184:187], a[248:251], 0
buffer_load_dword v23, s[8:11], s24 offen offset:256 lds
s_add_u32 s24, s24, 128
M a[156:159], a[188:191], a[252:255], a[156:159]
M a[160:163], a[196:199], a[252:255], 0
M a[160:163], a[192:195], a[248:251], a[160:163]
s_add_u32 m0, s29, 133120
s_nop 0
buffer_load_dwordx4 v2, s[8:11], s23 offen offset:0 lds
M a[164:167], a[176:179], a[224:227], 0
ds_read_b128 a[248:251], v10 offset:4096
ds_read_b128 a[252:255], v11 offset:4096
M a[164:167], a[180:183], a[228:231], a[164:167]
M a[168:171], a[188:191], a[228:231], 0
M a[168:171], a[184:187], a[224:227], a[168:171]
buffer_load_dwordx4 v3, s[8:11], s23 offen offset:1024 lds
M a[172:175], a[192:195], a[224:227], 0
M a[172:175], a[196:199], a[228:231], a[172:175]
s_waitcnt lgkmcnt(4)
M a[68:71], a[200:203], a[232:235], a[68:71]
ds_read_b128 a[224:227], v10 offset:6144
ds_read_b128 a[228:231], v11 offset:6144
M a[68:71], a[204:207], a[236:239], a[68:71]
buffer_load_dwordx4 v4, s[8:11], s23 offen offset:2048 lds
M a[72:75], a[212:215], a[236:239], a[72:75]
ds_read_b64_tr_b16 a[176:177], v14 offset:0
ds_read_b64_tr_b16 a[178:179], v14 offset:1536
M a[72:75], a[208:211], a[232:235], a[72:75]
M a[76:79], a[216:219], a[232:235], a[76:79]
buffer_load_dwordx4 v5, s[8:11], s23 offen offset:3072 lds
s_add_u32 s23, s23, 128
M a[76:79], a[220:223], a[236:239], a[76:79]
s_waitcnt lgkmcnt(6)
M a[80:83], a[204:207], a[244:247], a[80:83]
ds_read_b128 a[232:235], v10 offset:8192
ds_read_b128 a[236:239], v11 offset:8192
M a[80:83], a[200:203], a[240:243], a[80:83]
s_add_u32 m0, s30, 98304
s_nop 0
buffer_load_dwordx4 v6, s[12:15], s25 offen offset:0 lds
M a[84:87], a[208:211], a[240:243], a[84:87]
ds_read_b64_tr_b16 a[184:185], v15 offset:0
ds_read_b64_tr_b16 a[186:187], v15 offset:1536
M a[84:87], a[212:215], a[244:247], a[84:87]
M a[88:91], a[220:223], a[244:247], a[88:91]
buffer_load_dwordx4 v7, s[12:15], s25 offen offset:1024 lds
M a[88:91], a[216:219], a[240:243], a[88:91]
s_waitcnt lgkmcnt(8)
M a[92:95], a[200:203], a[248:251], a[92:95]
ds_read_b128 a[240:243], v10 offset:10240
ds_read_b128 a[244:247], v11 offset:10240
M a[92:95], a[204:207], a[252:255], a[92:95]
M a[96:99], a[212:215], a[252:255], a[96:99]
ds_read_b64_tr_b16 a[192:193], v16 offset:0
ds_read_b64_tr_b16 a[194:195], v16 offset:1536
M a[96:99], a[208:211], a[248:251], a[96:99]
buffer_load_dwordx4 v8, s[12:15], s25 offen offset:2048 lds
M a[100:103], a[216:219], a[248:251], a[100:103]
M a[100:103], a[220:223], a[252:255], a[100:103]
buffer_load_dwordx4 v9, s[12:15], s25 offen offset:3072 lds
s_waitcnt lgkmcnt(10)
M a[104:107], a[204:207], a[228:231], a[104:107]
ds_read_b128 a[248:251], v10 offset:12288
ds_read_b128 a[252:255], v11 offset:12288
M a[104:107], a[200:203], a[224:227], a[104:107]
M a[108:111], a[208:211], a[224:227], a[108:111]
ds_read_b64_tr_b16 a[180:181], v14 offset:12288
ds_read_b64_tr_b16 a[182:183], v14 offset:13824
M a[108:111], a[212:215], a[228:231], a[108:111]
s_add_u32 m0, s30, 102400
s_nop 0
buffer_load_dwordx4 v21, s[12:15], s25 offen offset:0 lds
M a[112:115], a[220:223], a[228:231], a[112:115]
M a[112:115], a[216:219], a[224:227], a[112:115]
buffer_load_dwordx4 v22, s[12:15], s25 offen offset:1024 lds
s_add_u32 s25, s25, 393216
s_waitcnt lgkmcnt(10)
M a[116:119], a[200:203], a[232:235], a[116:119]
ds_read_b128 a[224:227], v10 offset:14336
ds_read_b128 a[228:231], v11 offset:14336
M a[116:119], a[204:207], a[236:239], a[116:119]
M a[120:123], a[212:215], a[236:239], a[120:123]
ds_read_b64_tr_b16 a[188:189], v15 offset:12288
ds_read_b64_tr_b16 a[190:191], v15 offset:13824
M a[120:123], a[208:211], a[232:235], a[120:123]
M a[124:127], a[216:219], a[232:235], a[124:127]
s_add_u32 s94, s92, 12288
buffer_store_dwordx4 v[144:147], v1, s[16:19], s94 offen offset:2048 sc1
M a[124:127], a[220:223], a[236:239], a[124:127]
s_waitcnt lgkmcnt(10)
M a[128:131], a[204:207], a[244:247], a[128:131]
ds_read_b128 a[232:235], v10 offset:16384
ds_read_b128 a[236:239], v11 offset:16384
M a[128:131], a[200:203], a[240:243], a[128:131]
s_add_u32 s94, s92, 12288
buffer_store_dwordx4 v[152:155], v1, s[16:19], s94 offen offset:3072 sc1
M a[132:135], a[208:211], a[240:243], a[132:135]
ds_read_b64_tr_b16 a[196:197], v16 offset:12288
ds_read_b64_tr_b16 a[198:199], v16 offset:13824
M a[132:135], a[212:215], a[244:247], a[132:135]
M a[136:139], a[220:223], a[244:247], a[136:139]
s_add_u32 s94, s93, 0
buffer_store_dwordx4 v[160:163], v1, s[16:19], s94 offen offset:0 sc1
M a[136:139], a[216:219], a[240:243], a[136:139]
s_waitcnt lgkmcnt(10)
M a[140:143], a[200:203], a[248:251], a[140:143]
s_add_u32 s94, s93, 0
buffer_store_dwordx4 v[168:171], v1, s[16:19], s94 offen offset:1024 sc1
M a[140:143], a[204:207], a[252:255], a[140:143]
M a[144:147], a[212:215], a[252:255], a[144:147]
M a[144:147], a[208:211], a[248:251], a[144:147]
M a[148:151], a[216:219], a[248:251], a[148:151]
s_waitcnt vmcnt(16) lgkmcnt(0)
s_barrier
ds_read_b128 a[240:243], v10 offset:18432
ds_read_b128 a[244:247], v11 offset:18432
M a[148:151], a[220:223], a[252:255], a[148:151]
s_add_u32 m0, s28, 0
s_nop 0
buffer_load_dword v20, s[8:11], s24 offen lds
M a[152:155], a[204:207], a[228:231], a[152:155]
ds_read_b128 a[248:251], v10 offset:20480
ds_read_b128 a[252:255], v11 offset:20480
M a[152:155], a[200:203], a[224:227], a[152:155]
M a[156:159], a[208:211], a[224:227], a[156:159]
buffer_load_dword v23, s[8:11], s24 offen offset:256 lds
s_add_u32 s24, s24, 128
M a[156:159], a[212:215], a[228:231], a[156:159]
M a[160:163], a[220:223], a[228:231], a[160:163]
M a[160:163], a[216:219], a[224:227], a[160:163]
s_add_u32 m0, s29, 2048
s_nop 0
buffer_load_dwordx4 v2, s[8:11], s23 offen offset:0 lds
M a[164:167], a[200:203], a[232:235], a[164:167]
ds_read_b128 a[224:227], v10 offset:22528
ds_read_b128 a[228:231], v11 offset:22528
M a[164:167], a[204:207], a[236:239], a[164:167]
M a[168:171], a[212:215], a[236:239], a[168:171]
M a[168:171], a[208:211], a[232:235], a[168:171]
buffer_load_dwordx4 v3, s[8:11], s23 offen offset:1024 lds
M a[172:175], a[216:219], a[232:235], a[172:175]
M a[172:175], a[220:223], a[236:239], a[172:175]
s_waitcnt lgkmcnt(4)
M a[68:71], a[176:179], a[240:243], a[68:71]
ds_read_b128 a[232:235], v10 offset:24576
ds_read_b128 a[236:239], v11 offset:24576
M a[68:71], a[180:183], a[244:247], a[68:71]
buffer_load_dwordx4 v4, s[8:11], s23 offen offset:2048 lds
M a[72:75], a[188:191], a[244:247], a[72:75]
ds_read_b64_tr_b16 a[200:201], v14 offset:28672
ds_read_b64_tr_b16 a[202:203], v14 offset:30208
M a[72:75], a[184:187], a[240:243], a[72:75]
M a[76:79], a[192:195], a[240:243], a[76:79]
buffer_load_dwordx4 v5, s[8:11], s23 offen offset:3072 lds
s_add_u32 s23, s23, 128
M a[76:79], a[196:199], a[244:247], a[76:79]
s_waitcnt lgkmcnt(6)
M a[80:83], a[180:183], a[252:255], a[80:83]
ds_read_b128 a[240:243], v10 offset:26624
ds_read_b128 a[244:247], v11 offset:26624
M a[80:83], a[176:179], a[248:251], a[80:83]
s_add_u32 m0, s30, 36864
s_nop 0
buffer_load_dwordx4 v6, s[12:15], s25 offen offset:0 lds
M a[84:87], a[184:187], a[248:251], a[84:87]
ds_read_b64_tr_b16 a[208:209], v15 offset:28672
ds_read_b64_tr_b16 a[210:211], v15 offset:30208
M a[84:87], a[188:191], a[252:255], a[84:87]
M a[88:91], a[196:199], a[252:255], a[88:91]
buffer_load_dwordx4 v7, s[12:15], s25 offen offset:1024 lds
M a[88:91], a[192:195], a[248:251], a[88:91]
s_waitcnt lgkmcnt(8)
M a[92:95], a[176:179], a[224:227], a[92:95]
ds_read_b128 a[248:251], v10 offset:28672
ds_read_b128 a[252:255], v11 offset:28672
M a[92:95], a[180:183], a[228:231], a[92:95]
M a[96:99], a[188:191], a[228:231], a[96:99]
ds_read_b64_tr_b16 a[216:217], v16 offset:28672
ds_read_b64_tr_b16 a[218:219], v16 offset:30208
M a[96:99], a[184:187], a[224:227], a[96:99]
buffer_load_dwordx4 v8, s[12:15], s25 offen offset:2048 lds
M a[100:103], a[192:195], a[224:227], a[100:103]
M a[100:103], a[196:199], a[228:231], a[100:103]
buffer_load_dwordx4 v9, s[12:15], s25 offen offset:3072 lds
s_waitcnt lgkmcnt(10)
M a[104:107], a[180:183], a[236:239], a[104:107]
ds_read_b128 a[224:227], v10 offset:30720
ds_read_b128 a[228:231], v11 offset:30720
M a[104:107], a[176:179], a[232:235], a[104:107]
M a[108:111], a[184:187], a[232:235], a[108:111]
ds_read_b64_tr_b16 a[204:205], v14 offset:40960
ds_read_b64_tr_b16 a[206:207], v14 offset:42496
M a[108:111], a[188:191], a[236:239], a[108:111]
s_add_u32 m0, s30, 40960
s_nop 0
buffer_load_dwordx4 v21, s[12:15], s25 offen offset:0 lds
M a[112:115], a[196:199], a[236:239], a[112:115]
M a[112:115], a[192:195], a[232:235], a[112:115]
buffer_load_dwordx4 v22, s[12:15], s25 offen offset:1024 lds
s_add_u32 s25, s25, 393216
s_waitcnt lgkmcnt(10)
M a[116:119], a[176:179], a[240:243], a[116:119]
ds_read_b128 a[232:235], v10 offset:32768
ds_read_b128 a[236:239], v11 offset:32768
M a[116:119], a[180:183], a[244:247], a[116:119]
M a[120:123], a[188:191], a[244:247], a[120:123]
ds_read_b64_tr_b16 a[212:213], v15 offset:40960
ds_read_b64_tr_b16 a[214:215], v15 offset:42496
M a[120:123], a[184:187], a[240:243], a[120:123]
M a[124:127], a[192:195], a[240:243], a[124:127]
s_add_u32 s94, s93, 0
buffer_store_dwordx4 v[176:179], v1, s[16:19], s94 offen offset:2048 sc1
M a[124:127], a[196:199], a[244:247], a[124:127]
s_waitcnt lgkmcnt(10)
M a[128:131], a[180:183], a[252:255], a[128:131]
ds_read_b128 a[240:243], v10 offset:34816
ds_read_b128 a[244:247], v11 offset:34816
M a[128:131], a[176:179], a[248:251], a[128:131]
s_add_u32 s94, s93, 0
buffer_store_dwordx4 v[184:187], v1, s[16:19], s94 offen offset:3072 sc1
M a[132:135], a[184:187], a[248:251], a[132:135]
ds_read_b64_tr_b16 a[220:221], v16 offset:40960
ds_read_b64_tr_b16 a[222:223], v16 offset:42496
M a[132:135], a[188:191], a[252:255], a[132:135]
M a[136:139], a[196:199], a[252:255], a[136:139]
s_add_u32 s94, s93, 4096
buffer_store_dwordx4 v[192:195], v1, s[16:19], s94 offen offset:0 sc1
M a[136:139], a[192:195], a[248:251], a[136:139]
s_waitcnt lgkmcnt(10)
M a[140:143], a[176:179], a[224:227], a[140:143]
s_add_u32 s94, s93, 4096
buffer_store_dwordx4 v[200:203], v1, s[16:19], s94 offen offset:1024 sc1
M a[140:143], a[180:183], a[228:231], a[140:143]
M a[144:147], a[188:191], a[228:231], a[144:147]
M a[144:147], a[184:187], a[224:227], a[144:147]
M a[148:151], a[192:195], a[224:227], a[148:151]
s_waitcnt vmcnt(20) lgkmcnt(0)
s_barrier
ds_read_b128 a[248:251], v12 offset:0
ds_read_b128 a[252:255], v13 offset:0
M a[148:151], a[196:199], a[228:231], a[148:151]
s_add_u32 m0, s28, 18432
s_nop 0
buffer_load_dword v20, s[8:11], s24 offen lds
M a[152:155], a[180:183], a[236:239], a[152:155]
ds_read_b128 a[224:227], v12 offset:2048
ds_read_b128 a[228:231], v13 offset:2048
M a[152:155], a[176:179], a[232:235], a[152:155]
M a[156:159], a[184:187], a[232:235], a[156:159]
buffer_load_dword v23, s[8:11], s24 offen offset:256 lds
s_add_u32 s24, s24, 128
M a[156:159], a[188:191], a[236:239], a[156:159]
M a[160:163], a[196:199], a[236:239], a[160:163]
M a[160:163], a[192:195], a[232:235], a[160:163]
s_add_u32 m0, s29, 20480
s_nop 0
buffer_load_dwordx4 v2, s[8:11], s23 offen offset:0 lds
M a[164:167], a[176:179], a[240:243], a[164:167]
ds_read_b128 a[232:235], v12 offset:4096
ds_read_b128 a[236:239], v13 offset:4096
M a[164:167], a[180:183], a[244:247], a[164:167]
M a[168:171], a[188:191], a[244:247], a[168:171]
M a[168:171], a[184:187], a[240:243], a[168:171]
buffer_load_dwordx4 v3, s[8:11], s23 offen offset:1024 lds
M a[172:175], a[192:195], a[240:243], a[172:175]
M a[172:175], a[196:199], a[244:247], a[172:175]
s_waitcnt lgkmcnt(4)
M a[68:71], a[200:203], a[248:251], a[68:71]
ds_read_b128 a[240:243], v12 offset:6144
ds_read_b128 a[244:247], v13 offset:6144
M a[68:71], a[204:207], a[252:255], a[68:71]
buffer_load_dwordx4 v4, s[8:11], s23 offen offset:2048 lds
M a[72:75], a[212:215], a[252:255], a[72:75]
ds_read_b64_tr_b16 a[176:177], v17 offset:0
ds_read_b64_tr_b16 a[178:179], v17 offset:1536
M a[72:75], a[208:211], a[248:251], a[72:75]
M a[76:79], a[216:219], a[248:251], a[76:79]
buffer_load_dwordx4 v5, s[8:11], s23 offen offset:3072 lds
s_add_u32 s23, s23, 128
M a[76:79], a[220:223], a[252:255], a[76:79]
s_waitcnt lgkmcnt(6)
M a[80:83], a[204:207], a[228:231], a[80:83]
ds_read_b128 a[248:251], v12 offset:8192
ds_read_b128 a[252:255], v13 offset:8192
M a[80:83], a[200:203], a[224:227], a[80:83]
s_add_u32 m0, s30, 65536
s_nop 0
buffer_load_dwordx4 v6, s[12:15], s25 offen offset:0 lds
M a[84:87], a[208:211], a[224:227], a[84:87]
ds_read_b64_tr_b16 a[184:185], v18 offset:0
ds_read_b64_tr_b16 a[186:187], v18 offset:1536
M a[84:87], a[212:215], a[228:231], a[84:87]
M a[88:91], a[220:223], a[228:231], a[88:91]
buffer_load_dwordx4 v7, s[12:15], s25 offen offset:1024 lds
M a[88:91], a[216:219], a[224:227], a[88:91]
s_waitcnt lgkmcnt(8)
M a[92:95], a[200:203], a[232:235], a[92:95]
ds_read_b128 a[224:227], v12 offset:10240
ds_read_b128 a[228:231], v13 offset:10240
M a[92:95], a[204:207], a[236:239], a[92:95]
M a[96:99], a[212:215], a[236:239], a[96:99]
ds_read_b64_tr_b16 a[192:193], v19 offset:0
ds_read_b64_tr_b16 a[194:195], v19 offset:1536
M a[96:99], a[208:211], a[232:235], a[96:99]
buffer_load_dwordx4 v8, s[12:15], s25 offen offset:2048 lds
M a[100:103], a[216:219], a[232:235], a[100:103]
M a[100:103], a[220:223], a[236:239], a[100:103]
buffer_load_dwordx4 v9, s[12:15], s25 offen offset:3072 lds
s_waitcnt lgkmcnt(10)
M a[104:107], a[204:207], a[244:247], a[104:107]
ds_read_b128 a[232:235], v12 offset:12288
ds_read_b128 a[236:239], v13 offset:12288
M a[104:107], a[200:203], a[240:243], a[104:107]
M a[108:111], a[208:211], a[240:243], a[108:111]
ds_read_b64_tr_b16 a[180:181], v17 offset:12288
ds_read_b64_tr_b16 a[182:183], v17 offset:13824
M a[108:111], a[212:215], a[244:247], a[108:111]
s_add_u32 m0, s30, 69632
s_nop 0
buffer_load_dwordx4 v21, s[12:15], s25 offen offset:0 lds
M a[112:115], a[220:223], a[244:247], a[112:115]
M a[112:115], a[216:219], a[240:243], a[112:115]
buffer_load_dwordx4 v22, s[12:15], s25 offen offset:1024 lds
s_add_u32 s25, s25, 393216
s_waitcnt lgkmcnt(10)
M a[116:119], a[200:203], a[248:251], a[116:119]
ds_read_b128 a[240:243], v12 offset:14336
ds_read_b128 a[244:247], v13 offset:14336
M a[116:119], a[204:207], a[252:255], a[116:119]
M a[120:123], a[212:215], a[252:255], a[120:123]
ds_read_b64_tr_b16 a[188:189], v18 offset:12288
ds_read_b64_tr_b16 a[190:191], v18 offset:13824
M a[120:123], a[208:211], a[248:251], a[120:123]
M a[124:127], a[216:219], a[248:251], a[124:127]
s_add_u32 s94, s93, 4096
buffer_store_dwordx4 v[208:211], v1, s[16:19], s94 offen offset:2048 sc1
M a[124:127], a[220:223], a[252:255], a[124:127]
s_waitcnt lgkmcnt(10)
M a[128:131], a[204:207], a[228:231], a[128:131]
ds_read_b128 a[248:251], v12 offset:16384
ds_read_b128 a[252:255], v13 offset:16384
M a[128:131], a[200:203], a[224:227], a[128:131]
s_add_u32 s94, s93, 4096
buffer_store_dwordx4 v[216:219], v1, s[16:19], s94 offen offset:3072 sc1
M a[132:135], a[208:211], a[224:227], a[132:135]
ds_read_b64_tr_b16 a[196:197], v19 offset:12288
ds_read_b64_tr_b16 a[198:199], v19 offset:13824
M a[132:135], a[212:215], a[228:231], a[132:135]
M a[136:139], a[220:223], a[228:231], a[136:139]
s_add_u32 s94, s93, 8192
buffer_store_dwordx4 v[224:227], v1, s[16:19], s94 offen offset:0 sc1
M a[136:139], a[216:219], a[224:227], a[136:139]
s_waitcnt lgkmcnt(10)
M a[140:143], a[200:203], a[232:235], a[140:143]
s_add_u32 s94, s93, 8192
buffer_store_dwordx4 v[232:235], v1, s[16:19], s94 offen offset:1024 sc1
M a[140:143], a[204:207], a[236:239], a[140:143]
M a[144:147], a[212:215], a[236:239], a[144:147]
M a[144:147], a[208:211], a[232:235], a[144:147]
M a[148:151], a[216:219], a[232:235], a[148:151]
s_waitcnt vmcnt(20) lgkmcnt(0)
s_barrier
ds_read_b128 a[224:227], v10 offset:0
ds_read_b128 a[228:231], v11 offset:0
M a[148:151], a[220:223], a[236:239], a[148:151]
s_add_u32 m0, s28, 131072
s_nop 0
buffer_load_dword v20, s[8:11], s24 offen lds
M a[152:155], a[204:207], a[244:247], a[152:155]
ds_read_b128 a[232:235], v10 offset:2048
ds_read_b128 a[236:239], v11 offset:2048
M a[152:155], a[200:203], a[240:243], a[152:155]
M a[156:159], a[208:211], a[240:243], a[156:159]
buffer_load_dword v23, s[8:11], s24 offen offset:256 lds
s_add_u32 s24, s24, 128
M a[156:159], a[212:215], a[244:247], a[156:159]
M a[160:163], a[220:223], a[244:247], a[160:163]
M a[160:163], a[216:219], a[240:243], a[160:163]
s_add_u32 m0, s29, 133120
s_nop 0
buffer_load_dwordx4 v2, s[8:11], s23 offen offset:0 lds
M a[164:167], a[200:203], a[248:251], a[164:167]
ds_read_b128 a[240:243], v10 offset:4096
ds_read_b128 a[244:247], v11 offset:4096
M a[164:167], a[204:207], a[252:255], a[164:167]
M a[168:171], a[212:215], a[252:255], a[168:171]
M a[168:171], a[208:211], a[248:251], a[168:171]
buffer_load_dwordx4 v3, s[8:11], s23 offen offset:1024 lds
M a[172:175], a[216:219], a[248:251], a[172:175]
M a[172:175], a[220:223], a[252:255], a[172:175]
s_waitcnt lgkmcnt(4)
M a[68:71], a[176:179], a[224:227], a[68:71]
ds_read_b128 a[248:251], v10 offset:6144
ds_read_b128 a[252:255], v11 offset:6144
M a[68:71], a[180:183], a[228:231], a[68:71]
buffer_load_dwordx4 v4, s[8:11], s23 offen offset:2048 lds
M a[72:75], a[188:191], a[228:231], a[72:75]
ds_read_b64_tr_b16 a[200:201], v14 offset:0
ds_read_b64_tr_b16 a[202:203], v14 offset:1536
M a[72:75], a[184:187], a[224:227], a[72:75]
M a[76:79], a[192:195], a[224:227], a[76:79]
buffer_load_dwordx4 v5, s[8:11], s23 offen offset:3072 lds
s_add_u32 s23, s23, 128
M a[76:79], a[196:199], a[228:231], a[76:79]
s_waitcnt lgkmcnt(6)
M a[80:83], a[180:183], a[236:239], a[80:83]
ds_read_b128 a[224:227], v10 offset:8192
ds_read_b128 a[228:231], v11 offset:8192
M a[80:83], a[176:179], a[232:235], a[80:83]
s_add_u32 m0, s30, 98304
s_nop 0
buffer_load_dwordx4 v6, s[12:15], s25 offen offset:0 lds
M a[84:87], a[184:187], a[232:235], a[84:87]
ds_read_b64_tr_b16 a[208:209], v15 offset:0
ds_read_b64_tr_b16 a[210:211], v15 offset:1536
M a[84:87], a[188:191], a[236:239], a[84:87]
M a[88:91], a[196:199], a[236:239], a[88:91]
buffer_load_dwordx4 v7, s[12:15], s25 offen offset:1024 lds
M a[88:91], a[192:195], a[232:235], a[88:91]
s_waitcnt lgkmcnt(8)
M a[92:95], a[176:179], a[240:243], a[92:95]
ds_read_b128 a[232:235], v10 offset:10240
ds_read_b128 a[236:239], v11 offset:10240
M a[92:95], a[180:183], a[244:247], a[92:95]
M a[96:99], a[188:191], a[244:247], a[96:99]
ds_read_b64_tr_b16 a[216:217], v16 offset:0
ds_read_b64_tr_b16 a[218:219], v16 offset:1536
M a[96:99], a[184:187], a[240:243], a[96:99]
buffer_load_dwordx4 v8, s[12:15], s25 offen offset:2048 lds
M a[100:103], a[192:195], a[240:243], a[100:103]
M a[100:103], a[196:199], a[244:247], a[100:103]
buffer_load_dwordx4 v9, s[12:15], s25 offen offset:3072 lds
s_waitcnt lgkmcnt(10)
M a[104:107], a[180:183], a[252:255], a[104:107]
ds_read_b128 a[240:243], v10 offset:12288
ds_read_b128 a[244:247], v11 offset:12288
M a[104:107], a[176:179], a[248:251], a[104:107]
M a[108:111], a[184:187], a[248:251], a[108:111]
ds_read_b64_tr_b16 a[204:205], v14 offset:12288
ds_read_b64_tr_b16 a[206:207], v14 offset:13824
M a[108:111], a[188:191], a[252:255], a[108:111]
s_add_u32 m0, s30, 102400
s_nop 0
buffer_load_dwordx4 v21, s[12:15], s25 offen offset:0 lds
M a[112:115], a[196:199], a[252:255], a[112:115]
M a[112:115], a[192:195], a[248:251], a[112:115]
buffer_load_dwordx4 v22, s[12:15], s25 offen offset:1024 lds
s_add_u32 s25, s25, 393216
s_waitcnt lgkmcnt(10)
M a[116:119], a[176:179], a[224:227], a[116:119]
ds_read_b128 a[248:251], v10 offset:14336
ds_read_b128 a[252:255], v11 offset:14336
M a[116:119], a[180:183], a[228:231], a[116:119]
M a[120:123], a[188:191], a[228:231], a[120:123]
ds_read_b64_tr_b16 a[212:213], v15 offset:12288
ds_read_b64_tr_b16 a[214:215], v15 offset:13824
M a[120:123], a[184:187], a[224:227], a[120:123]
M a[124:127], a[192:195], a[224:227], a[124:127]
s_add_u32 s94, s93, 8192
buffer_store_dwordx4 v[240:243], v1, s[16:19], s94 offen offset:2048 sc1
M a[124:127], a[196:199], a[228:231], a[124:127]
s_waitcnt lgkmcnt(10)
M a[128:131], a[180:183], a[236:239], a[128:131]
ds_read_b128 a[224:227], v10 offset:16384
ds_read_b128 a[228:231], v11 offset:16384
M a[128:131], a[176:179], a[232:235], a[128:131]
s_add_u32 s94, s93, 8192
buffer_store_dwordx4 v[248:251], v1, s[16:19], s94 offen offset:3072 sc1
M a[132:135], a[184:187], a[232:235], a[132:135]
ds_read_b64_tr_b16 a[220:221], v16 offset:12288
ds_read_b64_tr_b16 a[222:223], v16 offset:13824
M a[132:135], a[188:191], a[236:239], a[132:135]
M a[136:139], a[196:199], a[236:239], a[136:139]
s_add_u32 s94, s93, 12288
buffer_store_dwordx4 v[36:39], v1, s[16:19], s94 offen offset:0 sc1
M a[136:139], a[192:195], a[232:235], a[136:139]
s_waitcnt lgkmcnt(10)
M a[140:143], a[176:179], a[240:243], a[140:143]
s_add_u32 s94, s93, 12288
buffer_store_dwordx4 v[44:47], v1, s[16:19], s94 offen offset:1024 sc1
M a[140:143], a[180:183], a[244:247], a[140:143]
M a[144:147], a[188:191], a[244:247], a[144:147]
M a[144:147], a[184:187], a[240:243], a[144:147]
M a[148:151], a[192:195], a[240:243], a[148:151]
s_waitcnt vmcnt(20) lgkmcnt(0)
s_barrier
ds_read_b128 a[232:235], v10 offset:18432
ds_read_b128 a[236:239], v11 offset:18432
M a[148:151], a[196:199], a[244:247], a[148:151]
s_add_u32 m0, s28, 0
s_nop 0
buffer_load_dword v20, s[8:11], s24 offen lds
M a[152:155], a[180:183], a[252:255], a[152:155]
ds_read_b128 a[240:243], v10 offset:20480
ds_read_b128 a[244:247], v11 offset:20480
M a[152:155], a[176:179], a[248:251], a[152:155]
M a[156:159], a[184:187], a[248:251], a[156:159]
buffer_load_dword v23, s[8:11], s24 offen offset:256 lds
s_add_u32 s24, s24, 128
M a[156:159], a[188:191], a[252:255], a[156:159]
M a[160:163], a[196:199], a[252:255], a[160:163]
M a[160:163], a[192:195], a[248:251], a[160:163]
s_add_u32 m0, s29, 2048
s_nop 0
buffer_load_dwordx4 v2, s[8:11], s23 offen offset:0 lds
M a[164:167], a[176:179], a[224:227], a[164:167]
ds_read_b128 a[248:251], v10 offset:22528
ds_read_b128 a[252:255], v11 offset:22528
M a[164:167], a[180:183], a[228:231], a[164:167]
M a[168:171], a[188:191], a[228:231], a[168:171]
M a[168:171], a[184:187], a[224:227], a[168:171]
buffer_load_dwordx4 v3, s[8:11], s23 offen offset:1024 lds
M a[172:175], a[192:195], a[224:227], a[172:175]
M a[172:175], a[196:199], a[228:231], a[172:175]
s_waitcnt lgkmcnt(4)
M a[68:71], a[200:203], a[232:235], a[68:71]
ds_read_b128 a[224:227], v10 offset:24576
ds_read_b128 a[228:231], v11 offset:24576
M a[68:71], a[204:207], a[236:239], a[68:71]
buffer_load_dwordx4 v4, s[8:11], s23 offen offset:2048 lds
M a[72:75], a[212:215], a[236:239], a[72:75]
ds_read_b64_tr_b16 a[176:177], v14 offset:28672
ds_read_b64_tr_b16 a[178:179], v14 offset:30208
M a[72:75], a[208:211], a[232:235], a[72:75]
M a[76:79], a[216:219], a[232:235], a[76:79]
buffer_load_dwordx4 v5, s[8:11], s23 offen offset:3072 lds
s_add_u32 s23, s23, 128
M a[76:79], a[220:223], a[236:239], a[76:79]
s_waitcnt lgkmcnt(6)
M a[80:83], a[204:207], a[244:247], a[80:83]
ds_read_b128 a[232:235], v10 offset:26624
ds_read_b128 a[236:239], v11 offset:26624
M a[80:83], a[200:203], a[240:243], a[80:83]
M a[84:87], a[208:211], a[240:243], a[84:87]
ds_read_b64_tr_b16 a[184:185], v15 offset:28672
ds_read_b64_tr_b16 a[186:187], v15 offset:30208
M a[84:87], a[212:215], a[244:247], a[84:87]
s_add_u32 m0, s30, 36864
s_nop 0
buffer_load_dwordx4 v6, s[12:15], s25 offen offset:0 lds
M a[88:91], a[220:223], a[244:247], a[88:91]
M a[88:91], a[216:219], a[240:243], a[88:91]
s_waitcnt lgkmcnt(8)
M a[92:95], a[200:203], a[248:251], a[92:95]
ds_read_b128 a[240:243], v10 offset:28672
ds_read_b128 a[244:247], v11 offset:28672
M a[92:95], a[204:207], a[252:255], a[92:95]
buffer_load_dwordx4 v7, s[12:15], s25 offen offset:1024 lds
M a[96:99], a[212:215], a[252:255], a[96:99]
ds_read_b64_tr_b16 a[192:193], v16 offset:28672
ds_read_b64_tr_b16 a[194:195], v16 offset:30208
M a[96:99], a[208:211], a[248:251], a[96:99]
M a[100:103], a[216:219], a[248:251], a[100:103]
buffer_load_dwordx4 v8, s[12:15], s25 offen offset:2048 lds
M a[100:103], a[220:223], a[252:255], a[100:103]
s_waitcnt lgkmcnt(10)
M a[104:107], a[204:207], a[228:231], a[104:107]
ds_read_b128 a[248:251], v10 offset:30720
ds_read_b128 a[252:255], v11 offset:30720
M a[104:107], a[200:203], a[224:227], a[104:107]
M a[108:111], a[208:211], a[224:227], a[108:111]
ds_read_b64_tr_b16 a[180:181], v14 offset:40960
ds_read_b64_tr_b16 a[182:183], v14 offset:42496
M a[108:111], a[212:215], a[228:231], a[108:111]
buffer_load_dwordx4 v9, s[12:15], s25 offen offset:3072 lds
M a[112:115], a[220:223], a[228:231], a[112:115]
M a[112:115], a[216:219], a[224:227], a[112:115]
s_waitcnt lgkmcnt(10)
M a[116:119], a[200:203], a[232:235], a[116:119]
ds_read_b128 a[224:227], v10 offset:32768
ds_read_b128 a[228:231], v11 offset:32768
M a[116:119], a[204:207], a[236:239], a[116:119]
s_add_u32 m0, s30, 40960
s_nop 0
buffer_load_dwordx4 v21, s[12:15], s25 offen offset:0 lds
M a[120:123], a[212:215], a[236:239], a[120:123]
ds_read_b64_tr_b16 a[188:189], v15 offset:40960
ds_read_b64_tr_b16 a[190:191], v15 offset:42496
M a[120:123], a[208:211], a[232:235], a[120:123]
M a[124:127], a[216:219], a[232:235], a[124:127]
buffer_load_dwordx4 v22, s[12:15], s25 offen offset:1024 lds
s_add_u32 s25, s25, 393216
M a[124:127], a[220:223], a[236:239], a[124:127]
s_waitcnt lgkmcnt(10)
M a[128:131], a[204:207], a[244:247], a[128:131]
ds_read_b128 a[232:235], v10 offset:34816
ds_read_b128 a[236:239], v11 offset:34816
M a[128:131], a[200:203], a[240:243], a[128:131]
M a[132:135], a[208:211], a[240:243], a[132:135]
ds_read_b64_tr_b16 a[196:197], v16 offset:40960
ds_read_b64_tr_b16 a[198:199], v16 offset:42496
M a[132:135], a[212:215], a[244:247], a[132:135]
s_add_u32 s94, s93, 12288
buffer_store_dwordx4 v[52:55], v1, s[16:19], s94 offen offset:2048 sc1
M a[136:139], a[220:223], a[244:247], a[136:139]
M a[136:139], a[216:219], a[240:243], a[136:139]
s_waitcnt lgkmcnt(10)
M a[140:143], a[200:203], a[248:251], a[140:143]
s_add_u32 s94, s93, 12288
buffer_store_dwordx4 v[60:63], v1, s[16:19], s94 offen offset:3072 sc1
M a[140:143], a[204:207], a[252:255], a[140:143]
M a[144:147], a[212:215], a[252:255], a[144:147]
M a[144:147], a[208:211], a[248:251], a[144:147]
M a[148:151], a[216:219], a[248:251], a[148:151]
s_waitcnt vmcnt(18) lgkmcnt(0)
s_barrier
ds_read_b128 a[240:243], v12 offset:0
ds_read_b128 a[244:247], v13 offset:0
M a[148:151], a[220:223], a[252:255], a[148:151]
s_add_u32 m0, s28, 18432
s_nop 0
buffer_load_dword v20, s[8:11], s24 offen lds
M a[152:155], a[204:207], a[228:231], a[152:155]
ds_read_b128 a[248:251], v12 offset:2048
ds_read_b128 a[252:255], v13 offset:2048
M a[152:155], a[200:203], a[224:227], a[152:155]
M a[156:159], a[208:211], a[224:227], a[156:159]
buffer_load_dword v23, s[8:11], s24 offen offset:256 lds
s_add_u32 s24, s24, 128
M a[156:159], a[212:215], a[228:231], a[156:159]
M a[160:163], a[220:223], a[228:231], a[160:163]
M a[160:163], a[216:219], a[224:227], a[160:163]
s_add_u32 m0, s29, 20480
s_nop 0
buffer_load_dwordx4 v2, s[8:11], s23 offen offset:0 lds
M a[164:167], a[200:203], a[232:235], a[164:167]
ds_read_b128 a[224:227], v12 offset:4096
ds_read_b128 a[228:231], v13 offset:4096
M a[164:167], a[204:207], a[236:239], a[164:167]
M a[168:171], a[212:215], a[236:239], a[168:171]
M a[168:171], a[208:211], a[232:235], a[168:171]
buffer_load_dwordx4 v3, s[8:11], s23 offen offset:1024 lds
M a[172:175], a[216:219], a[232:235], a[172:175]
M a[172:175], a[220:223], a[236:239], a[172:175]
s_waitcnt lgkmcnt(4)
M a[68:71], a[176:179], a[240:243], a[68:71]
ds_read_b128 a[232:235], v12 offset:6144
ds_read_b128 a[236:239], v13 offset:6144
M a[68:71], a[180:183], a[244:247], a[68:71]
buffer_load_dwordx4 v4, s[8:11], s23 offen offset:2048 lds
M a[72:75], a[188:191], a[244:247], a[72:75]
ds_read_b64_tr_b16 a[200:201], v17 offset:0
ds_read_b64_tr_b16 a[202:203], v17 offset:1536
M a[72:75], a[184:187], a[240:243], a[72:75]
M a[76:79], a[192:195], a[240:243], a[76:79]
M a[76:79], a[196:199], a[244:247], a[76:79]
buffer_load_dwordx4 v5, s[8:11], s23 offen offset:3072 lds
s_add_u32 s23, s23, 128
s_waitcnt lgkmcnt(6)
M a[80:83], a[180:183], a[252:255], a[80:83]
ds_read_b128 a[240:243], v12 offset:8192
ds_read_b128 a[244:247], v13 offset:8192
M a[80:83], a[176:179], a[248:251], a[80:83]
M a[84:87], a[184:187], a[248:251], a[84:87]
ds_read_b64_tr_b16 a[208:209], v18 offset:0
ds_read_b64_tr_b16 a[210:211], v18 offset:1536
M a[84:87], a[188:191], a[252:255], a[84:87]
M a[88:91], a[196:199], a[252:255], a[88:91]
s_add_u32 m0, s30, 65536
s_nop 0
buffer_load_dwordx4 v6, s[12:15], s25 offen offset:0 lds
M a[88:91], a[192:195], a[248:251], a[88:91]
s_waitcnt lgkmcnt(8)
M a[92:95], a[176:179], a[224:227], a[92:95]
ds_read_b128 a[248:251], v12 offset:10240
ds_read_b128 a[252:255], v13 offset:10240
M a[92:95], a[180:183], a[228:231], a[92:95]
M a[96:99], a[188:191], a[228:231], a[96:99]
ds_read_b64_tr_b16 a[216:217], v19 offset:0
ds_read_b64_tr_b16 a[218:219], v19 offset:1536
M a[96:99], a[184:187], a[224:227], a[96:99]
M a[100:103], a[192:195], a[224:227], a[100:103]
buffer_load_dwordx4 v7, s[12:15], s25 offen offset:1024 lds
M a[100:103], a[196:199], a[228:231], a[100:103]
s_waitcnt lgkmcnt(10)
M a[104:107], a[180:183], a[236:239], a[104:107]
ds_read_b128 a[224:227], v12 offset:12288
ds_read_b128 a[228:231], v13 offset:12288
M a[104:107], a[176:179], a[232:235], a[104:107]
M a[108:111], a[184:187], a[232:235], a[108:111]
ds_read_b64_tr_b16 a[204:205], v17 offset:12288
ds_read_b64_tr_b16 a[206:207], v17 offset:13824
M a[108:111], a[188:191], a[236:239], a[108:111]
buffer_load_dwordx4 v8, s[12:15], s25 offen offset:2048 lds
M a[112:115], a[196:199], a[236:239], a[112:115]
M a[112:115], a[192:195], a[232:235], a[112:115]
s_waitcnt lgkmcnt(10)
M a[116:119], a[176:179], a[240:243], a[116:119]
ds_read_b128 a[232:235], v12 offset:14336
ds_read_b128 a[236:239], v13 offset:14336
M a[116:119], a[180:183], a[244:247], a[116:119]
buffer_load_dwordx4 v9, s[12:15], s25 offen offset:3072 lds
M a[120:123], a[188:191], a[244:247], a[120:123]
ds_read_b64_tr_b16 a[212:213], v18 offset:12288
ds_read_b64_tr_b16 a[214:215], v18 offset:13824
M a[120:123], a[184:187], a[240:243], a[120:123]
M a[124:127], a[192:195], a[240:243], a[124:127]
M a[124:127], a[196:199], a[244:247], a[124:127]
s_waitcnt lgkmcnt(10)
M a[128:131], a[180:183], a[252:255], a[128:131]
ds_read_b128 a[240:243], v12 offset:16384
ds_read_b128 a[244:247], v13 offset:16384
M a[128:131], a[176:179], a[248:251], a[128:131]
s_add_u32 m0, s30, 69632
s_nop 0
buffer_load_dwordx4 v21, s[12:15], s25 offen offset:0 lds
M a[132:135], a[184:187], a[248:251], a[132:135]
ds_read_b64_tr_b16 a[220:221], v19 offset:12288
ds_read_b64_tr_b16 a[222:223], v19 offset:13824
M a[132:135], a[188:191], a[252:255], a[132:135]
M a[136:139], a[196:199], a[252:255], a[136:139]
M a[136:139], a[192:195], a[248:251], a[136:139]
buffer_load_dwordx4 v22, s[12:15], s25 offen offset:1024 lds
s_add_u32 s25, s25, 393216
s_waitcnt lgkmcnt(10)
M a[140:143], a[176:179], a[224:227], a[140:143]
M a[140:143], a[180:183], a[228:231], a[140:143]
M a[144:147], a[188:191], a[228:231], a[144:147]
M a[144:147], a[184:187], a[224:227], a[144:147]
M a[148:151], a[192:195], a[224:227], a[148:151]
s_waitcnt vmcnt(12) lgkmcnt(0)
s_barrier
ds_read_b128 a[248:251], v10 offset:0
ds_read_b128 a[252:255], v11 offset:0
s_cmp_lg_u32 s101, 0
s_cbranch_scc1 Lk1_arr
v_mov_b32 v127, 1
s_and_b32 s41, s2, 128
s_mov_b64 exec, 1
buffer_atomic_add v127, off, s[36:39], s41 sc1
s_mov_b64 exec, -1
Lk1_arr:
M a[148:151], a[196:199], a[228:231], a[148:151]
s_add_u32 m0, s28, 131072
s_nop 0
buffer_load_dword v20, s[8:11], s24 offen lds
M a[152:155], a[180:183], a[236:239], a[152:155]
ds_read_b128 a[224:227], v10 offset:2048
ds_read_b128 a[228:231], v11 offset:2048
M a[152:155], a[176:179], a[232:235], a[152:155]
M a[156:159], a[184:187], a[232:235], a[156:159]
buffer_load_dword v23, s[8:11], s24 offen offset:256 lds
s_add_u32 s24, s24, 128
M a[156:159], a[188:191], a[236:239], a[156:159]
M a[160:163], a[196:199], a[236:239], a[160:163]
M a[160:163], a[192:195], a[232:235], a[160:163]
s_add_u32 m0, s29, 133120
s_nop 0
buffer_load_dwordx4 v2, s[8:11], s23 offen offset:0 lds
M a[164:167], a[176:179], a[240:243], a[164:167]
ds_read_b128 a[232:235], v10 offset:4096
ds_read_b128 a[236:239], v11 offset:4096
M a[164:167], a[180:183], a[244:247], a[164:167]
M a[168:171], a[188:191], a[244:247], a[168:171]
M a[168:171], a[184:187], a[240:243], a[168:171]
buffer_load_dwordx4 v3, s[8:11], s23 offen offset:1024 lds
M a[172:175], a[192:195], a[240:243], a[172:175]
M a[172:175], a[196:199], a[244:247], a[172:175]
s_waitcnt lgkmcnt(4)
M a[68:71], a[200:203], a[248:251], a[68:71]
ds_read_b128 a[240:243], v10 offset:6144
ds_read_b128 a[244:247], v11 offset:6144
M a[68:71], a[204:207], a[252:255], a[68:71]
buffer_load_dwordx4 v4, s[8:11], s23 offen offset:2048 lds
M a[72:75], a[212:215], a[252:255], a[72:75]
ds_read_b64_tr_b16 a[176:177], v14 offset:0
ds_read_b64_tr_b16 a[178:179], v14 offset:1536
M a[72:75], a[208:211], a[248:251], a[72:75]
M a[76:79], a[216:219], a[248:251], a[76:79]
M a[76:79], a[220:223], a[252:255], a[76:79]
buffer_load_dwordx4 v5, s[8:11], s23 offen offset:3072 lds
s_add_u32 s23, s23, 128
s_waitcnt lgkmcnt(6)
M a[80:83], a[204:207], a[228:231], a[80:83]
ds_read_b128 a[248:251], v10 offset:8192
ds_read_b128 a[252:255], v11 offset:8192
M a[80:83], a[200:203], a[224:227], a[80:83]
M a[84:87], a[208:211], a[224:227], a[84:87]
ds_read_b64_tr_b16 a[184:185], v15 offset:0
ds_read_b64_tr_b16 a[186:187], v15 offset:1536
M a[84:87], a[212:215], a[228:231], a[84:87]
M a[88:91], a[220:223], a[228:231], a[88:91]
s_add_u32 m0, s30, 98304
s_nop 0
buffer_load_dwordx4 v6, s[12:15], s25 offen offset:0 lds
M a[88:91], a[216:219], a[224:227], a[88:91]
s_waitcnt lgkmcnt(8)
M a[92:95], a[200:203], a[232:235], a[92:95]
ds_read_b128 a[224:227], v10 offset:10240
ds_read_b128 a[228:231], v11 offset:10240
M a[92:95], a[204:207], a[236:239], a[92:95]
M a[96:99], a[212:215], a[236:239], a[96:99]
ds_read_b64_tr_b16 a[192:193], v16 offset:0
ds_read_b64_tr_b16 a[194:195], v16 offset:1536
M a[96:99], a[208:211], a[232:235], a[96:99]
M a[100:103], a[216:219], a[232:235], a[100:103]
buffer_load_dwordx4 v7, s[12:15], s25 offen offset:1024 lds
M a[100:103], a[220:223], a[236:239], a[100:103]
s_waitcnt lgkmcnt(10)
M a[104:107], a[204:207], a[244:247], a[104:107]
ds_read_b128 a[232:235], v10 offset:12288
ds_read_b128 a[236:239], v11 offset:12288
M a[104:107], a[200:203], a[240:243], a[104:107]
M a[108:111], a[208:211], a[240:243], a[108:111]
ds_read_b64_tr_b16 a[180:181], v14 offset:12288
ds_read_b64_tr_b16 a[182:183], v14 offset:13824
M a[108:111], a[212:215], a[244:247], a[108:111]
buffer_load_dwordx4 v8, s[12:15], s25 offen offset:2048 lds
M a[112:115], a[220:223], a[244:247], a[112:115]
M a[112:115], a[216:219], a[240:243], a[112:115]
s_waitcnt lgkmcnt(10)
M a[116:119], a[200:203], a[248:251], a[116:119]
ds_read_b128 a[240:243], v10 offset:14336
ds_read_b128 a[244:247], v11 offset:14336
M a[116:119], a[204:207], a[252:255], a[116:119]
buffer_load_dwordx4 v9, s[12:15], s25 offen offset:3072 lds
M a[120:123], a[212:215], a[252:255], a[120:123]
ds_read_b64_tr_b16 a[188:189], v15 offset:12288
ds_read_b64_tr_b16 a[190:191], v15 offset:13824
M a[120:123], a[208:211], a[248:251], a[120:123]
M a[124:127], a[216:219], a[248:251], a[124:127]
M a[124:127], a[220:223], a[252:255], a[124:127]
s_waitcnt lgkmcnt(10)
M a[128:131], a[204:207], a[228:231], a[128:131]
ds_read_b128 a[248:251], v10 offset:16384
ds_read_b128 a[252:255], v11 offset:16384
M a[128:131], a[200:203], a[224:227], a[128:131]
s_add_u32 m0, s30, 102400
s_nop 0
buffer_load_dwordx4 v21, s[12:15], s25 offen offset:0 lds
M a[132:135], a[208:211], a[224:227], a[132:135]
ds_read_b64_tr_b16 a[196:197], v16 offset:12288
ds_read_b64_tr_b16 a[198:199], v16 offset:13824
M a[132:135], a[212:215], a[228:231], a[132:135]
M a[136:139], a[220:223], a[228:231], a[136:139]
M a[136:139], a[216:219], a[224:227], a[136:139]
buffer_load_dwordx4 v22, s[12:15], s25 offen offset:1024 lds
s_add_u32 s25, s25, 393216
s_waitcnt lgkmcnt(10)
M a[140:143], a[200:203], a[232:235], a[140:143]
M a[140:143], a[204:207], a[236:239], a[140:143]
M a[144:147], a[212:215], a[236:239], a[144:147]
M a[144:147], a[208:211], a[232:235], a[144:147]
M a[148:151], a[216:219], a[232:235], a[148:151]
s_waitcnt vmcnt(12) lgkmcnt(0)
s_barrier
ds_read_b128 a[224:227], v10 offset:18432
ds_read_b128 a[228:231], v11 offset:18432
M a[148:151], a[220:223], a[236:239], a[148:151]
s_add_u32 m0, s28, 0
s_nop 0
buffer_load_dword v20, s[8:11], s24 offen lds
M a[152:155], a[204:207], a[244:247], a[152:155]
ds_read_b128 a[232:235], v10 offset:20480
ds_read_b128 a[236:239], v11 offset:20480
M a[152:155], a[200:203], a[240:243], a[152:155]
M a[156:159], a[208:211], a[240:243], a[156:159]
buffer_load_dword v23, s[8:11], s24 offen offset:256 lds
s_add_u32 s24, s24, 128
M a[156:159], a[212:215], a[244:247], a[156:159]
M a[160:163], a[220:223], a[244:247], a[160:163]
M a[160:163], a[216:219], a[240:243], a[160:163]
s_add_u32 m0, s29, 2048
s_nop 0
buffer_load_dwordx4 v2, s[8:11], s23 offen offset:0 lds
M a[164:167], a[200:203], a[248:251], a[164:167]
ds_read_b128 a[240:243], v10 offset:22528
ds_read_b128 a[244:247], v11 offset:22528
M a[164:167], a[204:207], a[252:255], a[164:167]
M a[168:171], a[212:215], a[252:255], a[168:171]
M a[168:171], a[208:211], a[248:251], a[168:171]
buffer_load_dwordx4 v3, s[8:11], s23 offen offset:1024 lds
M a[172:175], a[216:219], a[248:251], a[172:175]
M a[172:175], a[220:223], a[252:255], a[172:175]
s_waitcnt lgkmcnt(4)
M a[68:71], a[176:179], a[224:227], a[68:71]
ds_read_b128 a[248:251], v10 offset:24576
ds_read_b128 a[252:255], v11 offset:24576
v_mov_b32 v160, 0
v_mov_b32 v161, 0
M a[68:71], a[180:183], a[228:231], a[68:71]
buffer_load_dwordx4 v4, s[8:11], s23 offen offset:2048 lds
M a[72:75], a[188:191], a[228:231], a[72:75]
ds_read_b64_tr_b16 a[200:201], v14 offset:28672
ds_read_b64_tr_b16 a[202:203], v14 offset:30208
v_mov_b32 v162, 0
v_mov_b32 v163, 0
M a[72:75], a[184:187], a[224:227], a[72:75]
M a[76:79], a[192:195], a[224:227], a[76:79]
v_mov_b32 v164, 0
v_mov_b32 v165, 0
M a[76:79], a[196:199], a[228:231], a[76:79]
buffer_load_dwordx4 v5, s[8:11], s23 offen offset:3072 lds
s_add_u32 s23, s23, 128
s_waitcnt lgkmcnt(6)
M a[80:83], a[180:183], a[236:239], a[80:83]
ds_read_b128 a[224:227], v10 offset:26624
ds_read_b128 a[228:231], v11 offset:26624
v_mov_b32 v166, 0
v_mov_b32 v167, 0
M a[80:83], a[176:179], a[232:235], a[80:83]
M a[84:87], a[184:187], a[232:235], a[84:87]
ds_read_b64_tr_b16 a[208:209], v15 offset:28672
ds_read_b64_tr_b16 a[210:211], v15 offset:30208
M a[84:87], a[188:191], a[236:239], a[84:87]
v_mov_b32 v168, 0
v_mov_b32 v169, 0
M a[88:91], a[196:199], a[236:239], a[88:91]
s_add_u32 m0, s30, 36864
s_nop 0
buffer_load_dwordx4 v6, s[12:15], s25 offen offset:0 lds
M a[88:91], a[192:195], a[232:235], a[88:91]
s_waitcnt lgkmcnt(8)
v_mov_b32 v170, 0
v_mov_b32 v171, 0
M a[92:95], a[176:179], a[240:243], a[92:95]
ds_read_b128 a[232:235], v10 offset:28672
ds_read_b128 a[236:239], v11 offset:28672
M a[92:95], a[180:183], a[244:247], a[92:95]
v_mov_b32 v172, 0
v_mov_b32 v173, 0
M a[96:99], a[188:191], a[244:247], a[96:99]
ds_read_b64_tr_b16 a[216:217], v16 offset:28672
ds_read_b64_tr_b16 a[218:219], v16 offset:30208
M a[96:99], a[184:187], a[240:243], a[96:99]
buffer_load_dwordx4 v7, s[12:15], s25 offen offset:1024 lds
v_mov_b32 v174, 0
v_mov_b32 v175, 0
M a[100:103], a[192:195], a[240:243], a[100:103]
M a[100:103], a[196:199], a[244:247], a[100:103]
s_waitcnt lgkmcnt(10)
M a[104:107], a[180:183], a[252:255], a[104:107]
ds_read_b128 a[240:243], v10 offset:30720
ds_read_b128 a[244:247], v11 offset:30720
v_mov_b32 v176, 0
v_mov_b32 v177, 0
M a[104:107], a[176:179], a[248:251], a[104:107]
buffer_load_dwordx4 v8, s[12:15], s25 offen offset:2048 lds
M a[108:111], a[184:187], a[248:251], a[108:111]
ds_read_b64_tr_b16 a[204:205], v14 offset:40960
ds_read_b64_tr_b16 a[206:207], v14 offset:42496
v_mov_b32 v178, 0
v_mov_b32 v179, 0
M a[108:111], a[188:191], a[252:255], a[108:111]
M a[112:115], a[196:199], a[252:255], a[112:115]
v_mov_b32 v180, 0
v_mov_b32 v181, 0
M a[112:115], a[192:195], a[248:251], a[112:115]
buffer_load_dwordx4 v9, s[12:15], s25 offen offset:3072 lds
s_waitcnt lgkmcnt(10)
M a[116:119], a[176:179], a[224:227], a[116:119]
ds_read_b128 a[248:251], v10 offset:32768
ds_read_b128 a[252:255], v11 offset:32768
v_mov_b32 v182, 0
v_mov_b32 v183, 0
M a[116:119], a[180:183], a[228:231], a[116:119]
M a[120:123], a[188:191], a[228:231], a[120:123]
ds_read_b64_tr_b16 a[212:213], v15 offset:40960
ds_read_b64_tr_b16 a[214:215], v15 offset:42496
M a[120:123], a[184:187], a[224:227], a[120:123]
v_mov_b32 v184, 0
v_mov_b32 v185, 0
M a[124:127], a[192:195], a[224:227], a[124:127]
s_add_u32 m0, s30, 40960
s_nop 0
buffer_load_dwordx4 v21, s[12:15], s25 offen offset:0 lds
M a[124:127], a[196:199], a[228:231], a[124:127]
s_waitcnt lgkmcnt(10)
v_mov_b32 v186, 0
v_mov_b32 v187, 0
M a[128:131], a[180:183], a[236:239], a[128:131]
ds_read_b128 a[224:227], v10 offset:34816
ds_read_b128 a[228:231], v11 offset:34816
M a[128:131], a[176:179], a[232:235], a[128:131]
v_mov_b32 v188, 0
v_mov_b32 v189, 0
M a[132:135], a[184:187], a[232:235], a[132:135]
ds_read_b64_tr_b16 a[220:221], v16 offset:40960
ds_read_b64_tr_b16 a[222:223], v16 offset:42496
M a[132:135], a[188:191], a[236:239], a[132:135]
buffer_load_dwordx4 v22, s[12:15], s25 offen offset:1024 lds
s_add_u32 s25, s25, 393216
v_mov_b32 v190, 0
v_mov_b32 v191, 0
M a[136:139], a[196:199], a[236:239], a[136:139]
M a[136:139], a[192:195], a[232:235], a[136:139]
s_waitcnt lgkmcnt(10)
M a[140:143], a[176:179], a[240:243], a[140:143]
s_getpc_b64 s[56:57]
Lpcd:
s_add_u32 s56, s56, Lc2-Lpcd
s_addc_u32 s57, s57, 0
s_lshr_b32 s58, s2, 3
s_lshl2_add_u32 s58, s58, s101
s_mul_i32 s58, s58, (((Lk2_chk-Lc2)/128+127)&~127)
v_lshlrev_b32 v116, 7, v0
v_min_u32 v116, (((Lk2_chk-Lc2)/128+127)&~127)-128, v116
v_add_u32 v116, s58, v116
v_min_u32 v116, Lk2_chk-Lc2-4, v116
global_load_dword v117, v116, s[56:57]
v_mov_b32 v192, 0
v_mov_b32 v193, 0
M a[140:143], a[180:183], a[244:247], a[140:143]
M a[144:147], a[188:191], a[244:247], a[144:147]
v_mov_b32 v194, 0
v_mov_b32 v195, 0
M a[144:147], a[184:187], a[240:243], a[144:147]
M a[148:151], a[192:195], a[240:243], a[148:151]
s_waitcnt vmcnt(13) lgkmcnt(0)
s_barrier
ds_read_b128 a[232:235], v12 offset:0
ds_read_b128 a[236:239], v13 offset:0
v_mov_b32 v196, 0
v_mov_b32 v197, 0
M a[148:151], a[196:199], a[244:247], a[148:151]
s_add_u32 m0, s28, 18432
s_nop 0
buffer_load_dword v20, s[8:11], s24 offen lds
M a[152:155], a[180:183], a[252:255], a[152:155]
ds_read_b128 a[240:243], v12 offset:2048
ds_read_b128 a[244:247], v13 offset:2048
v_mov_b32 v198, 0
v_mov_b32 v199, 0
M a[152:155], a[176:179], a[248:251], a[152:155]
M a[156:159], a[184:187], a[248:251], a[156:159]
buffer_load_dword v23, s[8:11], s24 offen offset:256 lds
s_add_u32 s24, s24, 128
M a[156:159], a[188:191], a[252:255], a[156:159]
v_mov_b32 v200, 0
v_mov_b32 v201, 0
M a[160:163], a[196:199], a[252:255], a[160:163]
M a[160:163], a[192:195], a[248:251], a[160:163]
s_add_u32 m0, s29, 20480
s_nop 0
buffer_load_dwordx4 v2, s[8:11], s23 offen offset:0 lds
v_mov_b32 v202, 0
v_mov_b32 v203, 0
M a[164:167], a[176:179], a[224:227], a[164:167]
ds_read_b128 a[248:251], v12 offset:4096
ds_read_b128 a[252:255], v13 offset:4096
M a[164:167], a[180:183], a[228:231], a[164:167]
v_mov_b32 v204, 0
v_mov_b32 v205, 0
M a[168:171], a[188:191], a[228:231], a[168:171]
M a[168:171], a[184:187], a[224:227], a[168:171]
buffer_load_dwordx4 v3, s[8:11], s23 offen offset:1024 lds
v_mov_b32 v206, 0
v_mov_b32 v207, 0
M a[172:175], a[192:195], a[224:227], a[172:175]
M a[172:175], a[196:199], a[228:231], a[172:175]
s_waitcnt lgkmcnt(4)
M a[68:71], a[200:203], a[232:235], a[68:71]
ds_read_b128 a[224:227], v12 offset:6144
ds_read_b128 a[228:231], v13 offset:6144
v_and_b32 v128, 15, v0
v_mul_u32_u24 v128, 400, v128
M a[68:71], a[204:207], a[236:239], a[68:71]
buffer_load_dwordx4 v4, s[8:11], s23 offen offset:2048 lds
M a[72:75], a[212:215], a[236:239], a[72:75]
ds_read_b64_tr_b16 a[176:177], v17 offset:0
ds_read_b64_tr_b16 a[178:179], v17 offset:1536
v_lshrrev_b32 v129, 4, v0
v_lshl_add_u32 v128, v129, 3, v128
M a[72:75], a[208:211], a[232:235], a[72:75]
M a[76:79], a[216:219], a[232:235], a[76:79]
s_mul_i32 s3, s20, 96
s_add_u32 s3, s3, 98304
M a[76:79], a[220:223], a[236:239], a[76:79]
buffer_load_dwordx4 v5, s[8:11], s23 offen offset:3072 lds
s_add_u32 s23, s23, 128
s_waitcnt lgkmcnt(6)
M a[80:83], a[204:207], a[244:247], a[80:83]
ds_read_b128 a[232:235], v12 offset:8192
ds_read_b128 a[236:239], v13 offset:8192
v_add_u32 v124, s3, v128
v_and_b32 v128, 15, v0
M a[80:83], a[200:203], a[240:243], a[80:83]
M a[84:87], a[208:211], a[240:243], a[84:87]
ds_read_b64_tr_b16 a[184:185], v18 offset:0
ds_read_b64_tr_b16 a[186:187], v18 offset:1536
v_lshrrev_b32 v129, 4, v0
s_add_u32 s3, s21, 16
M a[84:87], a[212:215], a[244:247], a[84:87]
M a[88:91], a[220:223], a[244:247], a[88:91]
s_add_u32 m0, s30, 65536
s_nop 0
buffer_load_dwordx4 v6, s[12:15], s25 offen offset:0 lds
v_lshl_add_u32 v130, v128, 1, s3
s_lshl_b32 s4, s22, 6
M a[88:91], a[216:219], a[240:243], a[88:91]
s_waitcnt lgkmcnt(8)
M a[92:95], a[200:203], a[248:251], a[92:95]
ds_read_b128 a[240:243], v12 offset:10240
ds_read_b128 a[244:247], v13 offset:10240
s_add_u32 s4, s4, 98304
v_mul_u32_u24 v120, 400, v130
M a[92:95], a[204:207], a[252:255], a[92:95]
M a[96:99], a[212:215], a[252:255], a[96:99]
ds_read_b64_tr_b16 a[192:193], v19 offset:0
ds_read_b64_tr_b16 a[194:195], v19 offset:1536
M a[96:99], a[208:211], a[248:251], a[96:99]
v_lshl_add_u32 v120, v129, 4, v120
v_add_u32 v120, s4, v120
M a[100:103], a[216:219], a[248:251], a[100:103]
buffer_load_dwordx4 v7, s[12:15], s25 offen offset:1024 lds
M a[100:103], a[220:223], a[252:255], a[100:103]
s_waitcnt lgkmcnt(10)
v_subrev_u32 v130, 32, v130
v_max_i32 v130, 0, v130
M a[104:107], a[204:207], a[228:231], a[104:107]
ds_read_b128 a[248:251], v12 offset:12288
ds_read_b128 a[252:255], v13 offset:12288
M a[104:107], a[200:203], a[224:227], a[104:107]
v_mul_u32_u24 v121, 400, v130
v_lshl_add_u32 v121, v129, 4, v121
M a[108:111], a[208:211], a[224:227], a[108:111]
ds_read_b64_tr_b16 a[180:181], v17 offset:12288
ds_read_b64_tr_b16 a[182:183], v17 offset:13824
M a[108:111], a[212:215], a[228:231], a[108:111]
buffer_load_dwordx4 v8, s[12:15], s25 offen offset:2048 lds
v_add_u32 v121, s4, v121
v_bfe_u32 v131, v0, 2, 2
M a[112:115], a[220:223], a[228:231], a[112:115]
M a[112:115], a[216:219], a[224:227], a[112:115]
s_waitcnt lgkmcnt(10)
v_lshl_add_u32 v131, v129, 2, v131
v_lshl_add_u32 v131, v131, 1, s3
M a[116:119], a[200:203], a[232:235], a[116:119]
ds_read_b128 a[224:227], v12 offset:14336
ds_read_b128 a[228:231], v13 offset:14336
M a[116:119], a[204:207], a[236:239], a[116:119]
buffer_load_dwordx4 v9, s[12:15], s25 offen offset:3072 lds
v_and_b32 v132, 3, v0
v_lshlrev_b32 v132, 3, v132
M a[120:123], a[212:215], a[236:239], a[120:123]
ds_read_b64_tr_b16 a[188:189], v18 offset:12288
ds_read_b64_tr_b16 a[190:191], v18 offset:13824
M a[120:123], a[208:211], a[232:235], a[120:123]
M a[124:127], a[216:219], a[232:235], a[124:127]
v_add_u32 v132, s4, v132
s_movk_i32 s5, 400
M a[124:127], a[220:223], a[236:239], a[124:127]
s_waitcnt lgkmcnt(10)
M a[128:131], a[204:207], a[244:247], a[128:131]
ds_read_b128 a[232:235], v12 offset:16384
ds_read_b128 a[236:239], v13 offset:16384
v_mad_u32_u24 v122, v131, s5, v132
v_subrev_u32 v131, 32, v131
M a[128:131], a[200:203], a[240:243], a[128:131]
s_add_u32 m0, s30, 69632
s_nop 0
buffer_load_dwordx4 v21, s[12:15], s25 offen offset:0 lds
M a[132:135], a[208:211], a[240:243], a[132:135]
ds_read_b64_tr_b16 a[196:197], v19 offset:12288
ds_read_b64_tr_b16 a[198:199], v19 offset:13824
v_max_i32 v131, 0, v131
v_mad_u32_u24 v123, v131, s5, v132
M a[132:135], a[212:215], a[244:247], a[132:135]
M a[136:139], a[220:223], a[244:247], a[136:139]
v_lshlrev_b32 v129, 2, v129
v_sub_u32 v128, v128, v129
M a[136:139], a[216:219], a[240:243], a[136:139]
buffer_load_dwordx4 v22, s[12:15], s25 offen offset:1024 lds
s_add_u32 s25, s25, 393216
s_waitcnt lgkmcnt(10)
M a[140:143], a[200:203], a[248:251], a[140:143]
v_mov_b32 v129, 0xf149f2ca
s_cmp_eq_u32 s26, 0
s_cselect_b32 s3, 0xf149f2ca, 0
M a[140:143], a[204:207], a[252:255], a[140:143]
M a[144:147], a[212:215], a[252:255], a[144:147]
v_cmp_lt_i32 vcc, -9, v128
s_nop 1
v_cndmask_b32 v144, 0, v129, vcc
M a[144:147], a[208:211], a[248:251], a[144:147]
M a[148:151], a[216:219], a[248:251], a[148:151]
s_waitcnt vmcnt(13) lgkmcnt(0)
s_barrier
ds_read_b128 a[240:243], v10 offset:0
ds_read_b128 a[244:247], v11 offset:0
M a[148:151], a[220:223], a[252:255], a[148:151]
s_add_u32 m0, s28, 131072
s_nop 0
buffer_load_dword v20, s[8:11], s24 offen lds
v_subrev_u32 v130, 0, v128
v_cmp_lt_u32 vcc, 7, v130
s_nop 1
v_cndmask_b32 v148, 0, v129, vcc
M a[152:155], a[204:207], a[228:231], a[152:155]
ds_read_b128 a[248:251], v10 offset:2048
ds_read_b128 a[252:255], v11 offset:2048
M a[152:155], a[200:203], a[224:227], a[152:155]
v_min_f32 v152, s3, v144
v_mov_b32 v156, 0x3f803f80
M a[156:159], a[208:211], a[224:227], a[156:159]
buffer_load_dword v23, s[8:11], s24 offen offset:256 lds
s_add_u32 s24, s24, 128
M a[156:159], a[212:215], a[228:231], a[156:159]
v_cmp_lt_i32 vcc, -8, v128
s_nop 1
v_cndmask_b32 v145, 0, v129, vcc
M a[160:163], a[220:223], a[228:231], a[160:163]
M a[160:163], a[216:219], a[224:227], a[160:163]
s_add_u32 m0, s29, 133120
s_nop 0
buffer_load_dwordx4 v2, s[8:11], s23 offen offset:0 lds
v_subrev_u32 v130, 1, v128
v_cmp_lt_u32 vcc, 7, v130
s_nop 1
v_cndmask_b32 v149, 0, v129, vcc
M a[164:167], a[200:203], a[232:235], a[164:167]
ds_read_b128 a[224:227], v10 offset:4096
ds_read_b128 a[228:231], v11 offset:4096
M a[164:167], a[204:207], a[236:239], a[164:167]
v_min_f32 v153, s3, v145
v_mov_b32 v157, 0x3f803f80
M a[168:171], a[212:215], a[236:239], a[168:171]
M a[168:171], a[208:211], a[232:235], a[168:171]
buffer_load_dwordx4 v3, s[8:11], s23 offen offset:1024 lds
v_cmp_lt_i32 vcc, -7, v128
s_nop 1
v_cndmask_b32 v146, 0, v129, vcc
M a[172:175], a[216:219], a[232:235], a[172:175]
M a[172:175], a[220:223], a[236:239], a[172:175]
s_waitcnt lgkmcnt(4)
M a[68:71], a[176:179], a[240:243], a[68:71]
ds_read_b128 a[232:235], v10 offset:6144
ds_read_b128 a[236:239], v11 offset:6144
v_subrev_u32 v130, 2, v128
v_cmp_lt_u32 vcc, 7, v130
s_nop 1
v_cndmask_b32 v150, 0, v129, vcc
M a[68:71], a[180:183], a[244:247], a[68:71]
buffer_load_dwordx4 v4, s[8:11], s23 offen offset:2048 lds
v_min_f32 v154, s3, v146
v_mov_b32 v158, 0x3f803f80
M a[72:75], a[188:191], a[244:247], a[72:75]
ds_read_b64_tr_b16 a[200:201], v14 offset:0
ds_read_b64_tr_b16 a[202:203], v14 offset:1536
M a[72:75], a[184:187], a[240:243], a[72:75]
v_cmp_lt_i32 vcc, -6, v128
s_nop 1
v_cndmask_b32 v147, 0, v129, vcc
M a[76:79], a[192:195], a[240:243], a[76:79]
v_subrev_u32 v130, 3, v128
v_cmp_lt_u32 vcc, 7, v130
s_nop 1
v_cndmask_b32 v151, 0, v129, vcc
M a[76:79], a[196:199], a[244:247], a[76:79]
buffer_load_dwordx4 v5, s[8:11], s23 offen offset:3072 lds
s_add_u32 s23, s23, 128
s_waitcnt lgkmcnt(6)
M a[80:83], a[180:183], a[252:255], a[80:83]
ds_read_b128 a[240:243], v10 offset:8192
ds_read_b128 a[244:247], v11 offset:8192
v_min_f32 v155, s3, v147
v_mov_b32 v159, 0x3f803f80
M a[80:83], a[176:179], a[248:251], a[80:83]
s_add_u32 s16, s50, 83886080
s_addc_u32 s17, s51, 0
M a[84:87], a[184:187], a[248:251], a[84:87]
ds_read_b64_tr_b16 a[208:209], v15 offset:0
ds_read_b64_tr_b16 a[210:211], v15 offset:1536
M a[84:87], a[188:191], a[252:255], a[84:87]
s_mov_b32 s18, 4194304
s_mov_b32 s19, 0x00020000
M a[88:91], a[196:199], a[252:255], a[88:91]
s_add_u32 m0, s30, 98304
s_nop 0
buffer_load_dwordx4 v6, s[12:15], s25 offen offset:0 lds
s_lshl_b32 s3, s26, 18
s_lshl_b32 s4, s27, 14
M a[88:91], a[192:195], a[248:251], a[88:91]
s_waitcnt lgkmcnt(8)
M a[92:95], a[176:179], a[224:227], a[92:95]
ds_read_b128 a[248:251], v10 offset:10240
ds_read_b128 a[252:255], v11 offset:10240
s_add_u32 s3, s3, s4
s_lshl_b32 s4, s21, 13
M a[92:95], a[180:183], a[228:231], a[92:95]
s_add_u32 s3, s3, s4
s_lshl_b32 s4, s22, 10
M a[96:99], a[188:191], a[228:231], a[96:99]
ds_read_b64_tr_b16 a[216:217], v16 offset:0
ds_read_b64_tr_b16 a[218:219], v16 offset:1536
M a[96:99], a[184:187], a[224:227], a[96:99]
s_add_u32 s6, s3, s4
s_mov_b32 s7, 0x3e8293ee
M a[100:103], a[192:195], a[224:227], a[100:103]
buffer_load_dwordx4 v7, s[12:15], s25 offen offset:1024 lds
s_lshl_b32 s65, s26, 8
s_lshl_b32 s3, s27, 4
M a[100:103], a[196:199], a[228:231], a[100:103]
s_waitcnt lgkmcnt(10)
M a[104:107], a[180:183], a[236:239], a[104:107]
ds_read_b128 a[224:227], v10 offset:12288
ds_read_b128 a[228:231], v11 offset:12288
s_add_u32 s65, s65, s3
s_lshl_b32 s3, s101, 2
M a[104:107], a[176:179], a[232:235], a[104:107]
s_add_u32 s65, s65, s3
s_add_u32 s65, s65, 16789504
M a[108:111], a[184:187], a[232:235], a[108:111]
ds_read_b64_tr_b16 a[204:205], v14 offset:12288
ds_read_b64_tr_b16 a[206:207], v14 offset:13824
M a[108:111], a[188:191], a[236:239], a[108:111]
buffer_load_dwordx4 v8, s[12:15], s25 offen offset:2048 lds
s_mov_b32 s40, 0
v_mov_b32 v119, 0
M a[112:115], a[196:199], a[236:239], a[112:115]
s_mov_b64 s[4:5], s[50:51]
s_and_b32 s20, s2, 7
M a[112:115], a[192:195], a[232:235], a[112:115]
s_waitcnt lgkmcnt(10)
M a[116:119], a[176:179], a[240:243], a[116:119]
ds_read_b128 a[232:235], v10 offset:14336
ds_read_b128 a[236:239], v11 offset:14336
s_lshr_b32 s33, s2, 6
s_lshl_b32 s33, s33, 3
M a[116:119], a[180:183], a[244:247], a[116:119]
buffer_load_dwordx4 v9, s[12:15], s25 offen offset:3072 lds
s_add_u32 s20, s20, s33
s_bfe_u32 s21, s2, 0x30003
M a[120:123], a[188:191], a[244:247], a[120:123]
ds_read_b64_tr_b16 a[212:213], v15 offset:12288
ds_read_b64_tr_b16 a[214:215], v15 offset:13824
M a[120:123], a[184:187], a[240:243], a[120:123]
s_sub_u32 s35, 15, s21
s_cmp_lt_u32 s101, 2
s_cselect_b32 s35, s21, s35
M a[124:127], a[192:195], a[240:243], a[124:127]
s_lshl_b32 s33, s20, 7
s_lshl_b32 s34, s35, 3
M a[124:127], a[196:199], a[244:247], a[124:127]
s_waitcnt lgkmcnt(10)
M a[128:131], a[180:183], a[252:255], a[128:131]
ds_read_b128 a[240:243], v10 offset:16384
ds_read_b128 a[244:247], v11 offset:16384
s_add_u32 s33, s33, s34
s_and_b32 s34, s101, 1
M a[128:131], a[176:179], a[248:251], a[128:131]
s_add_u32 m0, s30, 102400
s_nop 0
buffer_load_dwordx4 v21, s[12:15], s25 offen offset:0 lds
s_lshl_b32 s34, s34, 2
s_add_u32 s33, s33, s34
M a[132:135], a[184:187], a[248:251], a[132:135]
ds_read_b64_tr_b16 a[220:221], v16 offset:12288
ds_read_b64_tr_b16 a[222:223], v16 offset:13824
M a[132:135], a[188:191], a[252:255], a[132:135]
s_lshl_b32 s64, s33, 12
s_mov_b32 s44, s4
M a[136:139], a[196:199], a[252:255], a[136:139]
s_mov_b32 s45, s5
s_mov_b32 s46, 16777216
M a[136:139], a[192:195], a[248:251], a[136:139]
buffer_load_dwordx4 v22, s[12:15], s25 offen offset:1024 lds
s_add_u32 s25, s25, 393216
s_waitcnt lgkmcnt(10)
M a[140:143], a[176:179], a[224:227], a[140:143]
s_mov_b32 s47, 0x00020000
M a[140:143], a[180:183], a[228:231], a[140:143]
M a[144:147], a[188:191], a[228:231], a[144:147]
M a[144:147], a[184:187], a[224:227], a[144:147]
M a[148:151], a[192:195], a[224:227], a[148:151]
s_waitcnt vmcnt(12) lgkmcnt(0)
s_barrier
ds_read_b128 a[248:251], v10 offset:18432
ds_read_b128 a[252:255], v11 offset:18432
M a[148:151], a[196:199], a[228:231], a[148:151]
s_add_u32 m0, s28, 0
s_nop 0
buffer_load_dword v20, s[8:11], s24 offen lds
M a[152:155], a[180:183], a[236:239], a[152:155]
ds_read_b128 a[224:227], v10 offset:20480
ds_read_b128 a[228:231], v11 offset:20480
M a[152:155], a[176:179], a[232:235], a[152:155]
M a[156:159], a[184:187], a[232:235], a[156:159]
buffer_load_dword v23, s[8:11], s24 offen offset:256 lds
s_add_u32 s24, s24, 128
M a[156:159], a[188:191], a[236:239], a[156:159]
M a[160:163], a[196:199], a[236:239], a[160:163]
M a[160:163], a[192:195], a[232:235], a[160:163]
s_add_u32 m0, s29, 2048
s_nop 0
buffer_load_dwordx4 v2, s[8:11], s23 offen offset:0 lds
M a[164:167], a[176:179], a[240:243], a[164:167]
ds_read_b128 a[232:235], v10 offset:22528
ds_read_b128 a[236:239], v11 offset:22528
M a[164:167], a[180:183], a[244:247], a[164:167]
M a[168:171], a[188:191], a[244:247], a[168:171]
M a[168:171], a[184:187], a[240:243], a[168:171]
buffer_load_dwordx4 v3, s[8:11], s23 offen offset:1024 lds
M a[172:175], a[192:195], a[240:243], a[172:175]
M a[172:175], a[196:199], a[244:247], a[172:175]
s_waitcnt lgkmcnt(4)
M a[68:71], a[200:203], a[248:251], a[68:71]
ds_read_b128 a[240:243], v10 offset:24576
ds_read_b128 a[244:247], v11 offset:24576
M a[68:71], a[204:207], a[252:255], a[68:71]
buffer_load_dwordx4 v4, s[8:11], s23 offen offset:2048 lds
M a[72:75], a[212:215], a[252:255], a[72:75]
ds_read_b64_tr_b16 a[176:177], v14 offset:28672
ds_read_b64_tr_b16 a[178:179], v14 offset:30208
M a[72:75], a[208:211], a[248:251], a[72:75]
M a[76:79], a[216:219], a[248:251], a[76:79]
M a[76:79], a[220:223], a[252:255], a[76:79]
buffer_load_dwordx4 v5, s[8:11], s23 offen offset:3072 lds
s_add_u32 s23, s23, 128
s_waitcnt lgkmcnt(6)
M a[80:83], a[204:207], a[228:231], a[80:83]
ds_read_b128 a[248:251], v10 offset:26624
ds_read_b128 a[252:255], v11 offset:26624
M a[80:83], a[200:203], a[224:227], a[80:83]
M a[84:87], a[208:211], a[224:227], a[84:87]
ds_read_b64_tr_b16 a[184:185], v15 offset:28672
ds_read_b64_tr_b16 a[186:187], v15 offset:30208
M a[84:87], a[212:215], a[228:231], a[84:87]
M a[88:91], a[220:223], a[228:231], a[88:91]
s_add_u32 m0, s30, 36864
s_nop 0
buffer_load_dwordx4 v6, s[12:15], s25 offen offset:0 lds
M a[88:91], a[216:219], a[224:227], a[88:91]
s_waitcnt lgkmcnt(8)
M a[92:95], a[200:203], a[232:235], a[92:95]
ds_read_b128 a[224:227], v10 offset:28672
ds_read_b128 a[228:231], v11 offset:28672
M a[92:95], a[204:207], a[236:239], a[92:95]
M a[96:99], a[212:215], a[236:239], a[96:99]
ds_read_b64_tr_b16 a[192:193], v16 offset:28672
ds_read_b64_tr_b16 a[194:195], v16 offset:30208
M a[96:99], a[208:211], a[232:235], a[96:99]
M a[100:103], a[216:219], a[232:235], a[100:103]
buffer_load_dwordx4 v7, s[12:15], s25 offen offset:1024 lds
M a[100:103], a[220:223], a[236:239], a[100:103]
s_waitcnt lgkmcnt(10)
M a[104:107], a[204:207], a[244:247], a[104:107]
ds_read_b128 a[232:235], v10 offset:30720
ds_read_b128 a[236:239], v11 offset:30720
M a[104:107], a[200:203], a[240:243], a[104:107]
M a[108:111], a[208:211], a[240:243], a[108:111]
ds_read_b64_tr_b16 a[180:181], v14 offset:40960
ds_read_b64_tr_b16 a[182:183], v14 offset:42496
M a[108:111], a[212:215], a[244:247], a[108:111]
buffer_load_dwordx4 v8, s[12:15], s25 offen offset:2048 lds
M a[112:115], a[220:223], a[244:247], a[112:115]
M a[112:115], a[216:219], a[240:243], a[112:115]
s_waitcnt lgkmcnt(10)
M a[116:119], a[200:203], a[248:251], a[116:119]
ds_read_b128 a[240:243], v10 offset:32768
ds_read_b128 a[244:247], v11 offset:32768
M a[116:119], a[204:207], a[252:255], a[116:119]
buffer_load_dwordx4 v9, s[12:15], s25 offen offset:3072 lds
M a[120:123], a[212:215], a[252:255], a[120:123]
ds_read_b64_tr_b16 a[188:189], v15 offset:40960
ds_read_b64_tr_b16 a[190:191], v15 offset:42496
M a[120:123], a[208:211], a[248:251], a[120:123]
M a[124:127], a[216:219], a[248:251], a[124:127]
M a[124:127], a[220:223], a[252:255], a[124:127]
s_waitcnt lgkmcnt(10)
M a[128:131], a[204:207], a[228:231], a[128:131]
ds_read_b128 a[248:251], v10 offset:34816
ds_read_b128 a[252:255], v11 offset:34816
M a[128:131], a[200:203], a[224:227], a[128:131]
s_add_u32 m0, s30, 40960
s_nop 0
buffer_load_dwordx4 v21, s[12:15], s25 offen offset:0 lds
M a[132:135], a[208:211], a[224:227], a[132:135]
ds_read_b64_tr_b16 a[196:197], v16 offset:40960
ds_read_b64_tr_b16 a[198:199], v16 offset:42496
M a[132:135], a[212:215], a[228:231], a[132:135]
M a[136:139], a[220:223], a[228:231], a[136:139]
M a[136:139], a[216:219], a[224:227], a[136:139]
buffer_load_dwordx4 v22, s[12:15], s25 offen offset:1024 lds
s_add_u32 s25, s25, 393216
s_waitcnt lgkmcnt(10)
M a[140:143], a[200:203], a[232:235], a[140:143]
M a[140:143], a[204:207], a[236:239], a[140:143]
M a[144:147], a[212:215], a[236:239], a[144:147]
M a[144:147], a[208:211], a[232:235], a[144:147]
M a[148:151], a[216:219], a[232:235], a[148:151]
s_waitcnt vmcnt(12) lgkmcnt(0)
s_barrier
ds_read_b128 a[224:227], v12 offset:0
ds_read_b128 a[228:231], v13 offset:0
M a[148:151], a[220:223], a[236:239], a[148:151]
s_add_u32 m0, s28, 18432
s_nop 0
buffer_load_dword v20, s[8:11], s24 offen lds
M a[152:155], a[204:207], a[244:247], a[152:155]
ds_read_b128 a[232:235], v12 offset:2048
ds_read_b128 a[236:239], v13 offset:2048
M a[152:155], a[200:203], a[240:243], a[152:155]
M a[156:159], a[208:211], a[240:243], a[156:159]
buffer_load_dword v23, s[8:11], s24 offen offset:256 lds
s_add_u32 s24, s24, 128
M a[156:159], a[212:215], a[244:247], a[156:159]
M a[160:163], a[220:223], a[244:247], a[160:163]
M a[160:163], a[216:219], a[240:243], a[160:163]
s_add_u32 m0, s29, 20480
s_nop 0
buffer_load_dwordx4 v2, s[8:11], s23 offen offset:0 lds
M a[164:167], a[200:203], a[248:251], a[164:167]
ds_read_b128 a[240:243], v12 offset:4096
ds_read_b128 a[244:247], v13 offset:4096
M a[164:167], a[204:207], a[252:255], a[164:167]
M a[168:171], a[212:215], a[252:255], a[168:171]
M a[168:171], a[208:211], a[248:251], a[168:171]
buffer_load_dwordx4 v3, s[8:11], s23 offen offset:1024 lds
M a[172:175], a[216:219], a[248:251], a[172:175]
M a[172:175], a[220:223], a[252:255], a[172:175]
s_waitcnt lgkmcnt(4)
M a[68:71], a[176:179], a[224:227], a[68:71]
ds_read_b128 a[248:251], v12 offset:6144
ds_read_b128 a[252:255], v13 offset:6144
M a[68:71], a[180:183], a[228:231], a[68:71]
buffer_load_dwordx4 v4, s[8:11], s23 offen offset:2048 lds
M a[72:75], a[188:191], a[228:231], a[72:75]
ds_read_b64_tr_b16 a[200:201], v17 offset:0
ds_read_b64_tr_b16 a[202:203], v17 offset:1536
M a[72:75], a[184:187], a[224:227], a[72:75]
M a[76:79], a[192:195], a[224:227], a[76:79]
M a[76:79], a[196:199], a[228:231], a[76:79]
buffer_load_dwordx4 v5, s[8:11], s23 offen offset:3072 lds
s_add_u32 s23, s23, 128
s_waitcnt lgkmcnt(6)
M a[80:83], a[180:183], a[236:239], a[80:83]
ds_read_b128 a[224:227], v12 offset:8192
ds_read_b128 a[228:231], v13 offset:8192
M a[80:83], a[176:179], a[232:235], a[80:83]
M a[84:87], a[184:187], a[232:235], a[84:87]
ds_read_b64_tr_b16 a[208:209], v18 offset:0
ds_read_b64_tr_b16 a[210:211], v18 offset:1536
M a[84:87], a[188:191], a[236:239], a[84:87]
M a[88:91], a[196:199], a[236:239], a[88:91]
s_add_u32 m0, s30, 65536
s_nop 0
buffer_load_dwordx4 v6, s[12:15], s25 offen offset:0 lds
M a[88:91], a[192:195], a[232:235], a[88:91]
s_waitcnt lgkmcnt(8)
M a[92:95], a[176:179], a[240:243], a[92:95]
ds_read_b128 a[232:235], v12 offset:10240
ds_read_b128 a[236:239], v13 offset:10240
M a[92:95], a[180:183], a[244:247], a[92:95]
M a[96:99], a[188:191], a[244:247], a[96:99]
ds_read_b64_tr_b16 a[216:217], v19 offset:0
ds_read_b64_tr_b16 a[218:219], v19 offset:1536
M a[96:99], a[184:187], a[240:243], a[96:99]
buffer_load_dwordx4 v7, s[12:15], s25 offen offset:1024 lds
M a[100:103], a[192:195], a[240:243], a[100:103]
M a[100:103], a[196:199], a[244:247], a[100:103]
s_waitcnt lgkmcnt(10)
M a[104:107], a[180:183], a[252:255], a[104:107]
ds_read_b128 a[240:243], v12 offset:12288
ds_read_b128 a[244:247], v13 offset:12288
M a[104:107], a[176:179], a[248:251], a[104:107]
buffer_load_dwordx4 v8, s[12:15], s25 offen offset:2048 lds
M a[108:111], a[184:187], a[248:251], a[108:111]
ds_read_b64_tr_b16 a[204:205], v17 offset:12288
ds_read_b64_tr_b16 a[206:207], v17 offset:13824
M a[108:111], a[188:191], a[252:255], a[108:111]
M a[112:115], a[196:199], a[252:255], a[112:115]
M a[112:115], a[192:195], a[248:251], a[112:115]
buffer_load_dwordx4 v9, s[12:15], s25 offen offset:3072 lds
s_waitcnt lgkmcnt(10)
M a[116:119], a[176:179], a[224:227], a[116:119]
ds_read_b128 a[248:251], v12 offset:14336
ds_read_b128 a[252:255], v13 offset:14336
M a[116:119], a[180:183], a[228:231], a[116:119]
M a[120:123], a[188:191], a[228:231], a[120:123]
ds_read_b64_tr_b16 a[212:213], v18 offset:12288
ds_read_b64_tr_b16 a[214:215], v18 offset:13824
M a[120:123], a[184:187], a[224:227], a[120:123]
M a[124:127], a[192:195], a[224:227], a[124:127]
s_add_u32 m0, s30, 69632
s_nop 0
buffer_load_dwordx4 v21, s[12:15], s25 offen offset:0 lds
M a[124:127], a[196:199], a[228:231], a[124:127]
s_waitcnt lgkmcnt(10)
M a[128:131], a[180:183], a[236:239], a[128:131]
ds_read_b128 a[224:227], v12 offset:16384
ds_read_b128 a[228:231], v13 offset:16384
M a[128:131], a[176:179], a[232:235], a[128:131]
M a[132:135], a[184:187], a[232:235], a[132:135]
ds_read_b64_tr_b16 a[220:221], v19 offset:12288
ds_read_b64_tr_b16 a[222:223], v19 offset:13824
M a[132:135], a[188:191], a[236:239], a[132:135]
buffer_load_dwordx4 v22, s[12:15], s25 offen offset:1024 lds
s_add_u32 s25, s25, 393216
M a[136:139], a[196:199], a[236:239], a[136:139]
M a[136:139], a[192:195], a[232:235], a[136:139]
s_waitcnt lgkmcnt(10)
M a[140:143], a[176:179], a[240:243], a[140:143]
buffer_load_dword v125, v119, s[36:39], 0 offen sc1
M a[140:143], a[180:183], a[244:247], a[140:143]
M a[144:147], a[188:191], a[244:247], a[144:147]
M a[144:147], a[184:187], a[240:243], a[144:147]
M a[148:151], a[192:195], a[240:243], a[148:151]
s_waitcnt vmcnt(13) lgkmcnt(0)
s_barrier
ds_read_b128 a[232:235], v10 offset:0
ds_read_b128 a[236:239], v11 offset:0
s_waitcnt vmcnt(0)
v_cmp_gt_u32 vcc, 0x80, v125
s_nop 0
s_cbranch_vccnz Lk1_spinq
Lk1_gotq:
M a[148:151], a[196:199], a[244:247], a[148:151]
s_add_u32 m0, s28, 131072
s_nop 0
buffer_load_dword v20, s[8:11], s24 offen lds
M a[152:155], a[180:183], a[252:255], a[152:155]
ds_read_b128 a[240:243], v10 offset:2048
ds_read_b128 a[244:247], v11 offset:2048
M a[152:155], a[176:179], a[248:251], a[152:155]
M a[156:159], a[184:187], a[248:251], a[156:159]
buffer_load_dword v23, s[8:11], s24 offen offset:256 lds
s_add_u32 s24, s24, 128
M a[156:159], a[188:191], a[252:255], a[156:159]
M a[160:163], a[196:199], a[252:255], a[160:163]
M a[160:163], a[192:195], a[248:251], a[160:163]
s_add_u32 m0, s29, 133120
s_nop 0
buffer_load_dwordx4 v2, s[8:11], s23 offen offset:0 lds
M a[164:167], a[176:179], a[224:227], a[164:167]
ds_read_b128 a[248:251], v10 offset:4096
ds_read_b128 a[252:255], v11 offset:4096
M a[164:167], a[180:183], a[228:231], a[164:167]
M a[168:171], a[188:191], a[228:231], a[168:171]
M a[168:171], a[184:187], a[224:227], a[168:171]
buffer_load_dwordx4 v3, s[8:11], s23 offen offset:1024 lds
M a[172:175], a[192:195], a[224:227], a[172:175]
M a[172:175], a[196:199], a[228:231], a[172:175]
s_waitcnt lgkmcnt(4)
M a[68:71], a[200:203], a[232:235], a[68:71]
ds_read_b128 a[224:227], v10 offset:6144
ds_read_b128 a[228:231], v11 offset:6144
v_mov_b32 v208, 0
v_mov_b32 v209, 0
M a[68:71], a[204:207], a[236:239], a[68:71]
buffer_load_dwordx4 v4, s[8:11], s23 offen offset:2048 lds
M a[72:75], a[212:215], a[236:239], a[72:75]
ds_read_b64_tr_b16 a[176:177], v14 offset:0
ds_read_b64_tr_b16 a[178:179], v14 offset:1536
v_mov_b32 v210, 0
v_mov_b32 v211, 0
M a[72:75], a[208:211], a[232:235], a[72:75]
M a[76:79], a[216:219], a[232:235], a[76:79]
buffer_load_dwordx4 v5, s[8:11], s23 offen offset:3072 lds
s_add_u32 s23, s23, 128
v_mov_b32 v212, 0
v_mov_b32 v213, 0
M a[76:79], a[220:223], a[236:239], a[76:79]
s_waitcnt lgkmcnt(6)
M a[80:83], a[204:207], a[244:247], a[80:83]
ds_read_b128 a[232:235], v10 offset:8192
ds_read_b128 a[236:239], v11 offset:8192
v_mov_b32 v214, 0
v_mov_b32 v215, 0
M a[80:83], a[200:203], a[240:243], a[80:83]
M a[84:87], a[208:211], a[240:243], a[84:87]
ds_read_b64_tr_b16 a[184:185], v15 offset:0
ds_read_b64_tr_b16 a[186:187], v15 offset:1536
M a[84:87], a[212:215], a[244:247], a[84:87]
buffer_load_dwordx4 a[0:3], v1, s[44:47], s64 offen offset:0 sc1
v_mov_b32 v216, 0
v_mov_b32 v217, 0
M a[88:91], a[220:223], a[244:247], a[88:91]
M a[88:91], a[216:219], a[240:243], a[88:91]
s_waitcnt lgkmcnt(8)
v_mov_b32 v218, 0
v_mov_b32 v219, 0
M a[92:95], a[200:203], a[248:251], a[92:95]
ds_read_b128 a[240:243], v10 offset:10240
ds_read_b128 a[244:247], v11 offset:10240
M a[92:95], a[204:207], a[252:255], a[92:95]
buffer_load_dwordx4 a[4:7], v1, s[44:47], s64 offen offset:1024 sc1
v_mov_b32 v220, 0
v_mov_b32 v221, 0
M a[96:99], a[212:215], a[252:255], a[96:99]
ds_read_b64_tr_b16 a[192:193], v16 offset:0
ds_read_b64_tr_b16 a[194:195], v16 offset:1536
M a[96:99], a[208:211], a[248:251], a[96:99]
v_mov_b32 v222, 0
v_mov_b32 v223, 0
M a[100:103], a[216:219], a[248:251], a[100:103]
buffer_load_dwordx4 a[8:11], v1, s[44:47], s64 offen offset:2048 sc1
M a[100:103], a[220:223], a[252:255], a[100:103]
s_waitcnt lgkmcnt(10)
M a[104:107], a[204:207], a[228:231], a[104:107]
ds_read_b128 a[248:251], v10 offset:12288
ds_read_b128 a[252:255], v11 offset:12288
v_mov_b32 v224, 0
v_mov_b32 v225, 0
M a[104:107], a[200:203], a[224:227], a[104:107]
M a[108:111], a[208:211], a[224:227], a[108:111]
ds_read_b64_tr_b16 a[180:181], v14 offset:12288
ds_read_b64_tr_b16 a[182:183], v14 offset:13824
v_mov_b32 v226, 0
v_mov_b32 v227, 0
M a[108:111], a[212:215], a[228:231], a[108:111]
buffer_load_dwordx4 a[12:15], v1, s[44:47], s64 offen offset:3072 sc1
s_add_u32 s64, s64, 4096
M a[112:115], a[220:223], a[228:231], a[112:115]
v_mov_b32 v228, 0
v_mov_b32 v229, 0
M a[112:115], a[216:219], a[224:227], a[112:115]
s_waitcnt lgkmcnt(10)
M a[116:119], a[200:203], a[232:235], a[116:119]
ds_read_b128 a[224:227], v10 offset:14336
ds_read_b128 a[228:231], v11 offset:14336
v_mov_b32 v230, 0
v_mov_b32 v231, 0
M a[116:119], a[204:207], a[236:239], a[116:119]
buffer_load_dwordx4 a[16:19], v1, s[44:47], s64 offen offset:0 sc1
M a[120:123], a[212:215], a[236:239], a[120:123]
ds_read_b64_tr_b16 a[188:189], v15 offset:12288
ds_read_b64_tr_b16 a[190:191], v15 offset:13824
M a[120:123], a[208:211], a[232:235], a[120:123]
v_mov_b32 v232, 0
v_mov_b32 v233, 0
M a[124:127], a[216:219], a[232:235], a[124:127]
buffer_load_dwordx4 a[20:23], v1, s[44:47], s64 offen offset:1024 sc1
M a[124:127], a[220:223], a[236:239], a[124:127]
s_waitcnt lgkmcnt(10)
v_mov_b32 v234, 0
v_mov_b32 v235, 0
M a[128:131], a[204:207], a[244:247], a[128:131]
ds_read_b128 a[232:235], v10 offset:16384
ds_read_b128 a[236:239], v11 offset:16384
M a[128:131], a[200:203], a[240:243], a[128:131]
v_mov_b32 v236, 0
v_mov_b32 v237, 0
M a[132:135], a[208:211], a[240:243], a[132:135]
ds_read_b64_tr_b16 a[196:197], v16 offset:12288
ds_read_b64_tr_b16 a[198:199], v16 offset:13824
M a[132:135], a[212:215], a[244:247], a[132:135]
buffer_load_dwordx4 a[24:27], v1, s[44:47], s64 offen offset:2048 sc1
v_mov_b32 v238, 0
v_mov_b32 v239, 0
M a[136:139], a[220:223], a[244:247], a[136:139]
M a[136:139], a[216:219], a[240:243], a[136:139]
s_waitcnt lgkmcnt(10)
M a[140:143], a[200:203], a[248:251], a[140:143]
buffer_load_dwordx4 a[28:31], v1, s[44:47], s64 offen offset:3072 sc1
s_add_u32 s64, s64, 4096
v_mov_b32 v240, 0
v_mov_b32 v241, 0
M a[140:143], a[204:207], a[252:255], a[140:143]
M a[144:147], a[212:215], a[252:255], a[144:147]
v_mov_b32 v242, 0
v_mov_b32 v243, 0
M a[144:147], a[208:211], a[248:251], a[144:147]
M a[148:151], a[216:219], a[248:251], a[148:151]
s_waitcnt vmcnt(15) lgkmcnt(0)
s_barrier
ds_read_b128 a[240:243], v10 offset:18432
ds_read_b128 a[244:247], v11 offset:18432
v_mov_b32 v244, 0
v_mov_b32 v245, 0
M a[148:151], a[220:223], a[252:255], a[148:151]
buffer_load_dwordx4 a[32:35], v1, s[44:47], s64 offen offset:0 sc1
M a[152:155], a[204:207], a[228:231], a[152:155]
ds_read_b128 a[248:251], v10 offset:20480
ds_read_b128 a[252:255], v11 offset:20480
v_mov_b32 v246, 0
v_mov_b32 v247, 0
M a[152:155], a[200:203], a[224:227], a[152:155]
M a[156:159], a[208:211], a[224:227], a[156:159]
buffer_load_dwordx4 a[36:39], v1, s[44:47], s64 offen offset:1024 sc1
M a[156:159], a[212:215], a[228:231], a[156:159]
v_mov_b32 v248, 0
v_mov_b32 v249, 0
M a[160:163], a[220:223], a[228:231], a[160:163]
M a[160:163], a[216:219], a[224:227], a[160:163]
buffer_load_dwordx4 a[40:43], v1, s[44:47], s64 offen offset:2048 sc1
v_mov_b32 v250, 0
v_mov_b32 v251, 0
M a[164:167], a[200:203], a[232:235], a[164:167]
ds_read_b128 a[224:227], v10 offset:22528
ds_read_b128 a[228:231], v11 offset:22528
M a[164:167], a[204:207], a[236:239], a[164:167]
v_mov_b32 v252, 0
v_mov_b32 v253, 0
M a[168:171], a[212:215], a[236:239], a[168:171]
M a[168:171], a[208:211], a[232:235], a[168:171]
buffer_load_dwordx4 a[44:47], v1, s[44:47], s64 offen offset:3072 sc1
s_add_u32 s64, s64, 4096
v_mov_b32 v254, 0
v_mov_b32 v255, 0
M a[172:175], a[216:219], a[232:235], a[172:175]
M a[172:175], a[220:223], a[236:239], a[172:175]
s_waitcnt lgkmcnt(4)
M a[68:71], a[176:179], a[240:243], a[68:71]
ds_read_b128 a[232:235], v10 offset:24576
ds_read_b128 a[236:239], v11 offset:24576
s_mov_b32 s22, s101
s_and_b32 s23, s22, 1
M a[68:71], a[180:183], a[244:247], a[68:71]
buffer_load_dwordx4 a[48:51], v1, s[44:47], s64 offen offset:0 sc1
s_lshr_b32 s24, s22, 1
s_lshl_b32 s33, s24, 14
M a[72:75], a[188:191], a[244:247], a[72:75]
ds_read_b64_tr_b16 a[200:201], v14 offset:28672
ds_read_b64_tr_b16 a[202:203], v14 offset:30208
M a[72:75], a[184:187], a[240:243], a[72:75]
s_lshl_b32 s34, s23, 13
s_add_u32 s29, s33, s34
M a[76:79], a[192:195], a[240:243], a[76:79]
M a[76:79], a[196:199], a[244:247], a[76:79]
s_waitcnt lgkmcnt(6)
s_lshl_b32 s28, s20, 20
s_add_u32 s28, s28, s34
M a[80:83], a[180:183], a[252:255], a[80:83]
ds_read_b128 a[240:243], v10 offset:26624
ds_read_b128 a[244:247], v11 offset:26624
M a[80:83], a[176:179], a[248:251], a[80:83]
s_mov_b32 s25, s28
s_lshl_b32 s33, s21, 16
M a[84:87], a[184:187], a[248:251], a[84:87]
ds_read_b64_tr_b16 a[208:209], v15 offset:28672
ds_read_b64_tr_b16 a[210:211], v15 offset:30208
M a[84:87], a[188:191], a[252:255], a[84:87]
buffer_load_dwordx4 a[52:55], v1, s[44:47], s64 offen offset:1024 sc1
s_add_u32 s34, s28, s33
s_add_u32 s34, s34, 65536
M a[88:91], a[196:199], a[252:255], a[88:91]
M a[88:91], a[192:195], a[248:251], a[88:91]
s_waitcnt lgkmcnt(8)
s_add_u32 s32, s28, 491520
s_sub_u32 s33, s32, s33
M a[92:95], a[176:179], a[224:227], a[92:95]
ds_read_b128 a[248:251], v10 offset:28672
ds_read_b128 a[252:255], v11 offset:28672
M a[92:95], a[180:183], a[228:231], a[92:95]
s_add_u32 s33, s33, 491520
s_cmp_eq_u32 s24, 0
s_cselect_b32 s27, s34, s32
s_cselect_b32 s28, s32, s33
M a[96:99], a[188:191], a[228:231], a[96:99]
ds_read_b64_tr_b16 a[216:217], v16 offset:28672
ds_read_b64_tr_b16 a[218:219], v16 offset:30208
M a[96:99], a[184:187], a[224:227], a[96:99]
s_mov_b32 s56, s27
s_mov_b32 s57, s28
M a[100:103], a[192:195], a[224:227], a[100:103]
buffer_load_dwordx4 a[56:59], v1, s[44:47], s64 offen offset:2048 sc1
M a[100:103], a[196:199], a[228:231], a[100:103]
s_waitcnt lgkmcnt(10)
s_min_u32 s34, s34, s32
s_cmp_eq_u32 s34, s32
s_cselect_b32 s33, s33, s34
M a[104:107], a[180:183], a[236:239], a[104:107]
ds_read_b128 a[224:227], v10 offset:30720
ds_read_b128 a[228:231], v11 offset:30720
M a[104:107], a[176:179], a[232:235], a[104:107]
s_or_b32 s34, s34, 0x40000000
s_or_b32 s32, s25, 0x40000000
M a[108:111], a[184:187], a[232:235], a[108:111]
ds_read_b64_tr_b16 a[204:205], v14 offset:40960
ds_read_b64_tr_b16 a[206:207], v14 offset:42496
s_cmp_eq_u32 s24, 1
s_cselect_b32 s25, s32, s25
s_cselect_b32 s27, s34, s27
s_cselect_b32 s28, s33, s28
s_cselect_b32 s56, s56, -1
M a[108:111], a[188:191], a[236:239], a[108:111]
M a[112:115], a[196:199], a[236:239], a[112:115]
s_add_u32 s58, s56, 16384
s_add_u32 s59, s57, 16384
M a[112:115], a[192:195], a[232:235], a[112:115]
s_waitcnt lgkmcnt(10)
M a[116:119], a[176:179], a[240:243], a[116:119]
ds_read_b128 a[232:235], v10 offset:32768
ds_read_b128 a[236:239], v11 offset:32768
s_add_u32 s26, s25, 16384
s_add_u32 s62, s27, 16384
M a[116:119], a[180:183], a[244:247], a[116:119]
buffer_load_dwordx4 a[60:63], v1, s[44:47], s64 offen offset:3072 sc1
M a[120:123], a[188:191], a[244:247], a[120:123]
ds_read_b64_tr_b16 a[212:213], v15 offset:40960
ds_read_b64_tr_b16 a[214:215], v15 offset:42496
s_add_u32 s63, s28, 16384
s_lshl_b32 s31, s21, 7
M a[120:123], a[184:187], a[240:243], a[120:123]
M a[124:127], a[192:195], a[240:243], a[124:127]
s_cmp_eq_u32 s24, 0
s_cselect_b32 s31, s31, 960
M a[124:127], a[196:199], a[244:247], a[124:127]
s_waitcnt lgkmcnt(10)
M a[128:131], a[180:183], a[252:255], a[128:131]
ds_read_b128 a[240:243], v10 offset:34816
ds_read_b128 a[244:247], v11 offset:34816
s_mov_b32 s60, 0
s_add_u32 s12, s4, 16777216
s_addc_u32 s13, s5, 0
M a[128:131], a[176:179], a[248:251], a[128:131]
M a[132:135], a[184:187], a[248:251], a[132:135]
ds_read_b64_tr_b16 a[220:221], v16 offset:40960
ds_read_b64_tr_b16 a[222:223], v16 offset:42496
s_mov_b32 s14, 33554432
s_mov_b32 s15, 0x00020000
M a[132:135], a[188:191], a[252:255], a[132:135]
buffer_load_dword v126, v119, s[36:39], 0 offen offset:128 sc1
M a[136:139], a[196:199], a[252:255], a[136:139]
s_mov_b32 s8, s4
s_mov_b32 s9, s5
M a[136:139], a[192:195], a[248:251], a[136:139]
s_waitcnt lgkmcnt(10)
M a[140:143], a[176:179], a[224:227], a[140:143]
s_mov_b32 s10, 16777216
s_mov_b32 s11, 0x00020000
M a[140:143], a[180:183], a[228:231], a[140:143]
M a[144:147], a[188:191], a[228:231], a[144:147]
M a[144:147], a[184:187], a[224:227], a[144:147]
M a[148:151], a[192:195], a[224:227], a[148:151]
s_waitcnt vmcnt(17) lgkmcnt(0)
s_barrier
ds_read_b128 a[248:251], v12 offset:0
ds_read_b128 a[252:255], v13 offset:0
s_waitcnt vmcnt(0)
v_cmp_gt_u32 vcc, 0x80, v126
s_nop 0
s_cbranch_vccnz Lk1_spin
Lk1_got:
M a[148:151], a[196:199], a[228:231], a[148:151]
s_add_u32 m0, s29, 65536
s_add_u32 s32, s25, 4096
buffer_load_dwordx4 v1, s[12:15], s25 offen offset:0 sc1 lds
M a[152:155], a[180:183], a[236:239], a[152:155]
ds_read_b128 a[224:227], v12 offset:2048
ds_read_b128 a[228:231], v13 offset:2048
M a[152:155], a[176:179], a[232:235], a[152:155]
buffer_load_dwordx4 v1, s[12:15], s25 offen offset:1024 sc1 lds
M a[156:159], a[184:187], a[232:235], a[156:159]
M a[156:159], a[188:191], a[236:239], a[156:159]
buffer_load_dwordx4 v1, s[12:15], s25 offen offset:2048 sc1 lds
M a[160:163], a[196:199], a[236:239], a[160:163]
buffer_load_dwordx4 v1, s[12:15], s25 offen offset:3072 sc1 lds
M a[160:163], a[192:195], a[232:235], a[160:163]
M a[164:167], a[176:179], a[240:243], a[164:167]
ds_read_b128 a[232:235], v12 offset:4096
ds_read_b128 a[236:239], v13 offset:4096
M a[164:167], a[180:183], a[244:247], a[164:167]
s_add_u32 m0, s29, 69632
s_nop 0
buffer_load_dwordx4 v1, s[12:15], s32 offen offset:0 sc1 lds
M a[168:171], a[188:191], a[244:247], a[168:171]
buffer_load_dwordx4 v1, s[12:15], s32 offen offset:1024 sc1 lds
M a[168:171], a[184:187], a[240:243], a[168:171]
M a[172:175], a[192:195], a[240:243], a[172:175]
buffer_load_dwordx4 v1, s[12:15], s32 offen offset:2048 sc1 lds
M a[172:175], a[196:199], a[244:247], a[172:175]
s_waitcnt lgkmcnt(4)
M a[68:71], a[200:203], a[248:251], a[68:71]
ds_read_b128 a[240:243], v12 offset:6144
ds_read_b128 a[244:247], v13 offset:6144
M a[68:71], a[204:207], a[252:255], a[68:71]
buffer_load_dwordx4 v1, s[12:15], s32 offen offset:3072 sc1 lds
M a[72:75], a[212:215], a[252:255], a[72:75]
M a[72:75], a[208:211], a[248:251], a[72:75]
M a[76:79], a[216:219], a[248:251], a[76:79]
M a[76:79], a[220:223], a[252:255], a[76:79]
s_waitcnt lgkmcnt(4)
M a[80:83], a[204:207], a[228:231], a[80:83]
ds_read_b128 a[248:251], v12 offset:8192
ds_read_b128 a[252:255], v13 offset:8192
M a[80:83], a[200:203], a[224:227], a[80:83]
M a[84:87], a[208:211], a[224:227], a[84:87]
M a[84:87], a[212:215], a[228:231], a[84:87]
M a[88:91], a[220:223], a[228:231], a[88:91]
M a[88:91], a[216:219], a[224:227], a[88:91]
s_waitcnt lgkmcnt(4)
M a[92:95], a[200:203], a[232:235], a[92:95]
ds_read_b128 a[224:227], v12 offset:10240
ds_read_b128 a[228:231], v13 offset:10240
v_accvgpr_read_b32 v24, a68
v_accvgpr_read_b32 v25, a69
v_accvgpr_read_b32 v26, a70
M a[92:95], a[204:207], a[236:239], a[92:95]
v_accvgpr_read_b32 v27, a71
v_cvt_pk_bf16_f32 v24, v24, v25
v_cvt_pk_bf16_f32 v25, v26, v27
ds_write_b64 v124, v[24:25] offset:0
M a[96:99], a[212:215], a[236:239], a[96:99]
v_accvgpr_read_b32 v28, a72
v_accvgpr_read_b32 v29, a73
v_accvgpr_read_b32 v30, a74
M a[96:99], a[208:211], a[232:235], a[96:99]
v_accvgpr_read_b32 v31, a75
v_cvt_pk_bf16_f32 v28, v28, v29
v_cvt_pk_bf16_f32 v29, v30, v31
ds_write_b64 v124, v[28:29] offset:32
M a[100:103], a[216:219], a[232:235], a[100:103]
v_accvgpr_read_b32 v24, a76
v_accvgpr_read_b32 v25, a77
v_accvgpr_read_b32 v26, a78
M a[100:103], a[220:223], a[236:239], a[100:103]
s_waitcnt lgkmcnt(6)
v_accvgpr_read_b32 v27, a79
v_cvt_pk_bf16_f32 v24, v24, v25
v_cvt_pk_bf16_f32 v25, v26, v27
ds_write_b64 v124, v[24:25] offset:64
M a[104:107], a[204:207], a[244:247], a[104:107]
ds_read_b128 a[232:235], v12 offset:12288
ds_read_b128 a[236:239], v13 offset:12288
v_accvgpr_read_b32 v24, a80
v_accvgpr_read_b32 v25, a81
v_accvgpr_read_b32 v26, a82
M a[104:107], a[200:203], a[240:243], a[104:107]
v_accvgpr_read_b32 v27, a83
v_cvt_pk_bf16_f32 v24, v24, v25
v_cvt_pk_bf16_f32 v25, v26, v27
ds_write_b64 v124, v[24:25] offset:6400
M a[108:111], a[208:211], a[240:243], a[108:111]
v_accvgpr_read_b32 v28, a84
v_accvgpr_read_b32 v29, a85
v_accvgpr_read_b32 v30, a86
M a[108:111], a[212:215], a[244:247], a[108:111]
v_accvgpr_read_b32 v31, a87
v_cvt_pk_bf16_f32 v28, v28, v29
v_cvt_pk_bf16_f32 v29, v30, v31
ds_write_b64 v124, v[28:29] offset:6432
M a[112:115], a[220:223], a[244:247], a[112:115]
v_accvgpr_read_b32 v24, a88
v_accvgpr_read_b32 v25, a89
v_accvgpr_read_b32 v26, a90
M a[112:115], a[216:219], a[240:243], a[112:115]
s_waitcnt lgkmcnt(9)
v_accvgpr_read_b32 v27, a91
v_cvt_pk_bf16_f32 v24, v24, v25
v_cvt_pk_bf16_f32 v25, v26, v27
ds_write_b64 v124, v[24:25] offset:6464
M a[116:119], a[200:203], a[248:251], a[116:119]
ds_read_b128 a[240:243], v12 offset:14336
ds_read_b128 a[244:247], v13 offset:14336
v_accvgpr_read_b32 v24, a92
v_accvgpr_read_b32 v25, a93
v_accvgpr_read_b32 v26, a94
M a[116:119], a[204:207], a[252:255], a[116:119]
v_accvgpr_read_b32 v27, a95
v_cvt_pk_bf16_f32 v24, v24, v25
v_cvt_pk_bf16_f32 v25, v26, v27
ds_write_b64 v124, v[24:25] offset:12800
M a[120:123], a[212:215], a[252:255], a[120:123]
v_accvgpr_read_b32 v28, a96
v_accvgpr_read_b32 v29, a97
v_accvgpr_read_b32 v30, a98
M a[120:123], a[208:211], a[248:251], a[120:123]
v_accvgpr_read_b32 v31, a99
v_cvt_pk_bf16_f32 v28, v28, v29
v_cvt_pk_bf16_f32 v29, v30, v31
ds_write_b64 v124, v[28:29] offset:12832
M a[124:127], a[216:219], a[248:251], a[124:127]
v_accvgpr_read_b32 v24, a100
v_accvgpr_read_b32 v25, a101
v_accvgpr_read_b32 v26, a102
M a[124:127], a[220:223], a[252:255], a[124:127]
s_add_u32 s25, s25, 32768
s_cmp_eq_u32 s25, s27
s_cselect_b32 s25, s28, s25
s_cselect_b32 s27, s56, s27
s_cselect_b32 s28, s57, s28
s_cselect_b32 s56, -1, s56
s_waitcnt lgkmcnt(12)
v_accvgpr_read_b32 v27, a103
v_cvt_pk_bf16_f32 v24, v24, v25
v_cvt_pk_bf16_f32 v25, v26, v27
ds_write_b64 v124, v[24:25] offset:12864
M a[128:131], a[204:207], a[228:231], a[128:131]
ds_read_b128 a[248:251], v12 offset:16384
ds_read_b128 a[252:255], v13 offset:16384
v_accvgpr_read_b32 v24, a104
v_accvgpr_read_b32 v25, a105
v_accvgpr_read_b32 v26, a106
M a[128:131], a[200:203], a[224:227], a[128:131]
v_accvgpr_read_b32 v27, a107
v_cvt_pk_bf16_f32 v24, v24, v25
v_cvt_pk_bf16_f32 v25, v26, v27
ds_write_b64 v124, v[24:25] offset:19200
M a[132:135], a[208:211], a[224:227], a[132:135]
v_accvgpr_read_b32 v28, a108
v_accvgpr_read_b32 v29, a109
v_accvgpr_read_b32 v30, a110
M a[132:135], a[212:215], a[228:231], a[132:135]
v_accvgpr_read_b32 v31, a111
v_cvt_pk_bf16_f32 v28, v28, v29
v_cvt_pk_bf16_f32 v29, v30, v31
ds_write_b64 v124, v[28:29] offset:19232
M a[136:139], a[220:223], a[228:231], a[136:139]
v_accvgpr_read_b32 v24, a112
v_accvgpr_read_b32 v25, a113
v_accvgpr_read_b32 v26, a114
M a[136:139], a[216:219], a[224:227], a[136:139]
s_waitcnt lgkmcnt(12)
v_accvgpr_read_b32 v27, a115
v_cvt_pk_bf16_f32 v24, v24, v25
v_cvt_pk_bf16_f32 v25, v26, v27
ds_write_b64 v124, v[24:25] offset:19264
M a[140:143], a[200:203], a[232:235], a[140:143]
v_accvgpr_read_b32 v24, a116
v_accvgpr_read_b32 v25, a117
v_accvgpr_read_b32 v26, a118
M a[140:143], a[204:207], a[236:239], a[140:143]
v_accvgpr_read_b32 v27, a119
v_cvt_pk_bf16_f32 v24, v24, v25
v_cvt_pk_bf16_f32 v25, v26, v27
ds_write_b64 v124, v[24:25] offset:25600
M a[144:147], a[212:215], a[236:239], a[144:147]
v_accvgpr_read_b32 v28, a120
v_accvgpr_read_b32 v29, a121
v_accvgpr_read_b32 v30, a122
M a[144:147], a[208:211], a[232:235], a[144:147]
v_accvgpr_read_b32 v31, a123
v_cvt_pk_bf16_f32 v28, v28, v29
v_cvt_pk_bf16_f32 v29, v30, v31
ds_write_b64 v124, v[28:29] offset:25632
M a[148:151], a[216:219], a[232:235], a[148:151]
s_waitcnt lgkmcnt(0)
s_barrier
v_accvgpr_read_b32 v24, a124
v_accvgpr_read_b32 v25, a125
v_accvgpr_read_b32 v26, a126
M a[148:151], a[220:223], a[236:239], a[148:151]
v_accvgpr_read_b32 v27, a127
v_cvt_pk_bf16_f32 v24, v24, v25
v_cvt_pk_bf16_f32 v25, v26, v27
ds_write_b64 v124, v[24:25] offset:25664
v_accvgpr_read_b32 v24, a128
v_accvgpr_read_b32 v25, a129
v_accvgpr_read_b32 v26, a130
M a[152:155], a[204:207], a[244:247], a[152:155]
v_accvgpr_read_b32 v27, a131
v_cvt_pk_bf16_f32 v24, v24, v25
v_cvt_pk_bf16_f32 v25, v26, v27
M a[152:155], a[200:203], a[240:243], a[152:155]
ds_write_b64 v124, v[24:25] offset:32000
v_accvgpr_read_b32 v28, a132
v_accvgpr_read_b32 v29, a133
M a[156:159], a[208:211], a[240:243], a[156:159]
v_accvgpr_read_b32 v30, a134
v_accvgpr_read_b32 v31, a135
v_cvt_pk_bf16_f32 v28, v28, v29
M a[156:159], a[212:215], a[244:247], a[156:159]
v_cvt_pk_bf16_f32 v29, v30, v31
ds_write_b64 v124, v[28:29] offset:32032
v_accvgpr_read_b32 v24, a136
M a[160:163], a[220:223], a[244:247], a[160:163]
v_accvgpr_read_b32 v25, a137
v_accvgpr_read_b32 v26, a138
v_accvgpr_read_b32 v27, a139
M a[160:163], a[216:219], a[240:243], a[160:163]
v_cvt_pk_bf16_f32 v24, v24, v25
v_cvt_pk_bf16_f32 v25, v26, v27
ds_write_b64 v124, v[24:25] offset:32064
M a[164:167], a[200:203], a[248:251], a[164:167]
v_accvgpr_read_b32 v24, a140
v_accvgpr_read_b32 v25, a141
v_accvgpr_read_b32 v26, a142
M a[164:167], a[204:207], a[252:255], a[164:167]
v_accvgpr_read_b32 v27, a143
v_cvt_pk_bf16_f32 v24, v24, v25
v_cvt_pk_bf16_f32 v25, v26, v27
ds_write_b64 v124, v[24:25] offset:38400
M a[168:171], a[212:215], a[252:255], a[168:171]
v_accvgpr_read_b32 v28, a144
v_accvgpr_read_b32 v29, a145
v_accvgpr_read_b32 v30, a146
M a[168:171], a[208:211], a[248:251], a[168:171]
v_accvgpr_read_b32 v31, a147
v_cvt_pk_bf16_f32 v28, v28, v29
v_cvt_pk_bf16_f32 v29, v30, v31
ds_write_b64 v124, v[28:29] offset:38432
M a[172:175], a[216:219], a[248:251], a[172:175]
v_accvgpr_read_b32 v24, a148
v_accvgpr_read_b32 v25, a149
v_accvgpr_read_b32 v26, a150
M a[172:175], a[220:223], a[252:255], a[172:175]
v_accvgpr_read_b32 v27, a151
v_cvt_pk_bf16_f32 v24, v24, v25
v_cvt_pk_bf16_f32 v25, v26, v27
ds_write_b64 v124, v[24:25] offset:38464
s_mov_b64 s[44:45], s[42:43]
v_accvgpr_read_b32 v24, a152
v_accvgpr_read_b32 v25, a153
v_accvgpr_read_b32 v26, a154
v_accvgpr_read_b32 v27, a155
v_cvt_pk_bf16_f32 v24, v24, v25
v_cvt_pk_bf16_f32 v25, v26, v27
ds_write_b64 v124, v[24:25] offset:44800
v_accvgpr_read_b32 v28, a156
v_accvgpr_read_b32 v29, a157
v_accvgpr_read_b32 v30, a158
v_accvgpr_read_b32 v31, a159
v_cvt_pk_bf16_f32 v28, v28, v29
v_cvt_pk_bf16_f32 v29, v30, v31
ds_write_b64 v124, v[28:29] offset:44832
v_accvgpr_read_b32 v24, a160
v_accvgpr_read_b32 v25, a161
v_accvgpr_read_b32 v26, a162
v_accvgpr_read_b32 v27, a163
v_cvt_pk_bf16_f32 v24, v24, v25
v_cvt_pk_bf16_f32 v25, v26, v27
ds_write_b64 v124, v[24:25] offset:44864
v_accvgpr_read_b32 v24, a164
v_accvgpr_read_b32 v25, a165
v_accvgpr_read_b32 v26, a166
v_accvgpr_read_b32 v27, a167
v_cvt_pk_bf16_f32 v24, v24, v25
v_cvt_pk_bf16_f32 v25, v26, v27
ds_write_b64 v124, v[24:25] offset:51200
v_accvgpr_read_b32 v28, a168
v_accvgpr_read_b32 v29, a169
v_accvgpr_read_b32 v30, a170
v_accvgpr_read_b32 v31, a171
v_cvt_pk_bf16_f32 v28, v28, v29
v_cvt_pk_bf16_f32 v29, v30, v31
ds_write_b64 v124, v[28:29] offset:51232
v_accvgpr_read_b32 v24, a172
v_accvgpr_read_b32 v25, a173
v_accvgpr_read_b32 v26, a174
v_accvgpr_read_b32 v27, a175
v_cvt_pk_bf16_f32 v24, v24, v25
v_cvt_pk_bf16_f32 v25, v26, v27
ds_write_b64 v124, v[24:25] offset:51264
s_waitcnt lgkmcnt(0)
s_barrier
ds_read_b128 v[48:51], v121 offset:128
ds_read_b128 v[32:35], v120 offset:0
ds_read_b128 v[52:55], v120 offset:128
ds_read_b128 v[36:39], v120 offset:12800
ds_read_b128 v[56:59], v120 offset:12928
ds_read_b128 v[40:43], v120 offset:25600
ds_read_b128 v[60:63], v120 offset:25728
ds_read_b128 v[44:47], v120 offset:38400
ds_read_b128 v[64:67], v120 offset:38528
ds_read_b64_tr_b16 v[68:69], v123 offset:256
ds_read_b64_tr_b16 v[70:71], v122 offset:256
ds_read_b64_tr_b16 v[72:73], v122 offset:13056
ds_read_b64_tr_b16 v[74:75], v122 offset:25856
ds_read_b64_tr_b16 v[76:77], v122 offset:38656
ds_read_b64_tr_b16 v[78:79], v123 offset:288
ds_read_b64_tr_b16 v[80:81], v122 offset:288
ds_read_b64_tr_b16 v[82:83], v122 offset:13088
ds_read_b64_tr_b16 v[84:85], v122 offset:25888
ds_read_b64_tr_b16 v[86:87], v122 offset:38688
v_accvgpr_write_b32 a64, 0
v_accvgpr_write_b32 a65, 0
v_accvgpr_write_b32 a66, 0
v_accvgpr_write_b32 a67, 0
v_accvgpr_write_b32 a68, 0
v_accvgpr_write_b32 a69, 0
v_accvgpr_write_b32 a70, 0
v_accvgpr_write_b32 a71, 0
v_accvgpr_write_b32 a72, 0
v_accvgpr_write_b32 a73, 0
v_accvgpr_write_b32 a74, 0
v_accvgpr_write_b32 a75, 0
s_add_u32 m0, s29, 0
s_add_u32 s32, s25, 4096
buffer_load_dwordx4 v1, s[12:15], s25 offen offset:0 sc1 lds
v_accvgpr_write_b32 a76, 0
v_accvgpr_write_b32 a77, 0
v_accvgpr_write_b32 a78, 0
v_accvgpr_write_b32 a79, 0
v_accvgpr_write_b32 a80, 0
v_accvgpr_write_b32 a81, 0
v_accvgpr_write_b32 a82, 0
v_accvgpr_write_b32 a83, 0
v_accvgpr_write_b32 a84, 0
v_accvgpr_write_b32 a85, 0
v_accvgpr_write_b32 a86, 0
buffer_load_dwordx4 v1, s[12:15], s25 offen offset:1024 sc1 lds
v_accvgpr_write_b32 a87, 0
v_accvgpr_write_b32 a88, 0
v_accvgpr_write_b32 a89, 0
v_accvgpr_write_b32 a90, 0
v_accvgpr_write_b32 a91, 0
v_accvgpr_write_b32 a92, 0
v_accvgpr_write_b32 a93, 0
v_accvgpr_write_b32 a94, 0
v_accvgpr_write_b32 a95, 0
v_accvgpr_write_b32 a96, 0
buffer_load_dwordx4 v1, s[12:15], s25 offen offset:2048 sc1 lds
v_accvgpr_write_b32 a97, 0
v_accvgpr_write_b32 a98, 0
v_accvgpr_write_b32 a99, 0
v_accvgpr_write_b32 a100, 0
v_accvgpr_write_b32 a101, 0
v_accvgpr_write_b32 a102, 0
v_accvgpr_write_b32 a103, 0
v_accvgpr_write_b32 a104, 0
v_accvgpr_write_b32 a105, 0
v_accvgpr_write_b32 a106, 0
v_accvgpr_write_b32 a107, 0
buffer_load_dwordx4 v1, s[12:15], s25 offen offset:3072 sc1 lds
v_accvgpr_write_b32 a108, 0
v_accvgpr_write_b32 a109, 0
v_accvgpr_write_b32 a110, 0
v_accvgpr_write_b32 a111, 0
s_waitcnt lgkmcnt(15)
M v[88:91], v[48:51], v[32:35], v[152:155]
M v[92:95], v[52:55], v[32:35], v[148:151]
M v[96:99], v[52:55], v[36:39], v[144:147]
s_waitcnt lgkmcnt(14)
M v[100:103], v[56:59], v[36:39], v[148:151]
s_waitcnt lgkmcnt(13)
M v[104:107], v[56:59], v[40:43], v[144:147]
s_waitcnt lgkmcnt(12)
M v[108:111], v[60:63], v[40:43], v[148:151]
s_add_u32 m0, s29, 4096
s_nop 0
buffer_load_dwordx4 v1, s[12:15], s32 offen offset:0 sc1 lds
s_waitcnt lgkmcnt(11)
M v[112:115], v[60:63], v[44:47], v[144:147]
s_waitcnt lgkmcnt(10)
M v[116:119], v[64:67], v[44:47], v[148:151]
v_max3_f32 v136, v88, v89, v90
v_max3_f32 v136, v136, v91, v92
v_max3_f32 v136, v136, v93, v94
v_max_f32 v136, v136, v95
v_max3_f32 v137, v96, v97, v98
v_max3_f32 v137, v137, v99, v100
v_max3_f32 v137, v137, v101, v102
v_max_f32 v137, v137, v103
v_max3_f32 v138, v104, v105, v106
buffer_load_dwordx4 v1, s[12:15], s32 offen offset:1024 sc1 lds
v_max3_f32 v138, v138, v107, v108
v_max3_f32 v138, v138, v109, v110
v_max_f32 v138, v138, v111
v_max3_f32 v139, v112, v113, v114
v_max3_f32 v139, v139, v115, v116
v_max3_f32 v139, v139, v117, v118
v_max_f32 v139, v139, v119
v_mov_b32 v140, v136
v_mov_b32 v141, v137
v_mov_b32 v142, v138
buffer_load_dwordx4 v1, s[12:15], s32 offen offset:2048 sc1 lds
v_mov_b32 v143, v139
v_permlane16_swap_b32 v136, v140
v_permlane16_swap_b32 v137, v141
v_permlane16_swap_b32 v138, v142
v_permlane16_swap_b32 v139, v143
v_max_f32 v136, v136, v140
v_max_f32 v137, v137, v141
v_max_f32 v138, v138, v142
v_max_f32 v139, v139, v143
v_mov_b32 v140, v136
v_mov_b32 v141, v137
buffer_load_dwordx4 v1, s[12:15], s32 offen offset:3072 sc1 lds
v_mov_b32 v142, v138
v_mov_b32 v143, v139
v_permlane32_swap_b32 v136, v140
v_permlane32_swap_b32 v137, v141
v_permlane32_swap_b32 v138, v142
v_permlane32_swap_b32 v139, v143
v_max_f32 v136, v136, v140
v_max_f32 v137, v137, v141
v_max_f32 v138, v138, v142
v_max_f32 v139, v139, v143
s_add_u32 s25, s25, 32768
s_cmp_eq_u32 s25, s27
s_cselect_b32 s25, s28, s25
s_cselect_b32 s27, s56, s27
s_cselect_b32 s28, s57, s28
s_cselect_b32 s56, -1, s56
v_mul_f32 v136, s7, v136
v_mul_f32 v137, s7, v137
v_mul_f32 v138, s7, v138
v_mul_f32 v139, s7, v139
v_fma_f32 v88, v88, s7, -v136
v_fma_f32 v89, v89, s7, -v136
v_fma_f32 v90, v90, s7, -v136
v_fma_f32 v91, v91, s7, -v136
v_fma_f32 v92, v92, s7, -v136
v_fma_f32 v93, v93, s7, -v136
v_fma_f32 v94, v94, s7, -v136
s_add_u32 m0, s29, 32768
s_add_u32 s32, s26, 4096
buffer_load_dwordx4 v1, s[12:15], s26 offen offset:0 sc1 lds
v_fma_f32 v95, v95, s7, -v136
v_exp_f32 v88, v88
v_exp_f32 v89, v89
v_exp_f32 v90, v90
v_exp_f32 v91, v91
v_exp_f32 v92, v92
v_exp_f32 v93, v93
v_exp_f32 v94, v94
v_exp_f32 v95, v95
v_fma_f32 v96, v96, s7, -v137
v_fma_f32 v97, v97, s7, -v137
buffer_load_dwordx4 v1, s[12:15], s26 offen offset:1024 sc1 lds
v_fma_f32 v98, v98, s7, -v137
v_fma_f32 v99, v99, s7, -v137
v_fma_f32 v100, v100, s7, -v137
v_fma_f32 v101, v101, s7, -v137
v_fma_f32 v102, v102, s7, -v137
v_fma_f32 v103, v103, s7, -v137
v_exp_f32 v96, v96
v_exp_f32 v97, v97
v_exp_f32 v98, v98
v_exp_f32 v99, v99
buffer_load_dwordx4 v1, s[12:15], s26 offen offset:2048 sc1 lds
v_exp_f32 v100, v100
v_exp_f32 v101, v101
v_exp_f32 v102, v102
v_exp_f32 v103, v103
v_fma_f32 v104, v104, s7, -v138
v_fma_f32 v105, v105, s7, -v138
v_fma_f32 v106, v106, s7, -v138
v_fma_f32 v107, v107, s7, -v138
v_fma_f32 v108, v108, s7, -v138
v_fma_f32 v109, v109, s7, -v138
v_fma_f32 v110, v110, s7, -v138
buffer_load_dwordx4 v1, s[12:15], s26 offen offset:3072 sc1 lds
v_fma_f32 v111, v111, s7, -v138
v_exp_f32 v104, v104
v_exp_f32 v105, v105
v_exp_f32 v106, v106
v_exp_f32 v107, v107
v_exp_f32 v108, v108
v_exp_f32 v109, v109
v_exp_f32 v110, v110
v_exp_f32 v111, v111
v_fma_f32 v112, v112, s7, -v139
s_add_u32 m0, s29, 36864
s_nop 0
buffer_load_dwordx4 v1, s[12:15], s32 offen offset:0 sc1 lds
v_fma_f32 v113, v113, s7, -v139
v_fma_f32 v114, v114, s7, -v139
v_fma_f32 v115, v115, s7, -v139
v_fma_f32 v116, v116, s7, -v139
v_fma_f32 v117, v117, s7, -v139
v_fma_f32 v118, v118, s7, -v139
v_fma_f32 v119, v119, s7, -v139
v_exp_f32 v112, v112
v_exp_f32 v113, v113
v_exp_f32 v114, v114
v_exp_f32 v115, v115
buffer_load_dwordx4 v1, s[12:15], s32 offen offset:1024 sc1 lds
v_exp_f32 v116, v116
v_exp_f32 v117, v117
v_exp_f32 v118, v118
v_exp_f32 v119, v119
v_cvt_pk_bf16_f32 v88, v88, v89
v_cvt_pk_bf16_f32 v89, v90, v91
v_cvt_pk_bf16_f32 v90, v92, v93
v_cvt_pk_bf16_f32 v91, v94, v95
v_cvt_pk_bf16_f32 v96, v96, v97
v_cvt_pk_bf16_f32 v97, v98, v99
buffer_load_dwordx4 v1, s[12:15], s32 offen offset:2048 sc1 lds
v_cvt_pk_bf16_f32 v98, v100, v101
v_cvt_pk_bf16_f32 v99, v102, v103
v_cvt_pk_bf16_f32 v104, v104, v105
v_cvt_pk_bf16_f32 v105, v106, v107
v_cvt_pk_bf16_f32 v106, v108, v109
v_cvt_pk_bf16_f32 v107, v110, v111
v_cvt_pk_bf16_f32 v112, v112, v113
v_cvt_pk_bf16_f32 v113, v114, v115
v_cvt_pk_bf16_f32 v114, v116, v117
v_cvt_pk_bf16_f32 v115, v118, v119
M v[120:123], v[156:159], v[88:91], 0
buffer_load_dwordx4 v1, s[12:15], s32 offen offset:3072 sc1 lds
s_waitcnt lgkmcnt(8)
M v[32:35], v[68:71], v[88:91], 0
s_waitcnt lgkmcnt(3)
M v[36:39], v[78:81], v[88:91], 0
M v[124:127], v[156:159], v[96:99], 0
M v[40:43], v[70:73], v[96:99], 0
s_waitcnt lgkmcnt(2)
M v[44:47], v[80:83], v[96:99], 0
M v[128:131], v[156:159], v[104:107], 0
M v[48:51], v[72:75], v[104:107], 0
s_waitcnt lgkmcnt(1)
M v[52:55], v[82:85], v[104:107], 0
M v[132:135], v[156:159], v[112:115], 0
M v[56:59], v[74:77], v[112:115], 0
s_add_u32 s26, s26, 32768
s_cmp_eq_u32 s26, s62
s_cselect_b32 s26, s63, s26
s_cselect_b32 s62, s58, s62
s_cselect_b32 s63, s59, s63
s_cselect_b32 s58, -1, s58
s_waitcnt lgkmcnt(0)
M v[60:63], v[84:87], v[112:115], 0
v_rcp_f32 v120, v120
v_rcp_f32 v124, v124
v_rcp_f32 v128, v128
v_rcp_f32 v132, v132
v_pk_mul_f32 v[32:33], v[32:33], v[120:121] op_sel_hi:[1,0]
v_pk_mul_f32 v[34:35], v[34:35], v[120:121] op_sel_hi:[1,0]
v_pk_mul_f32 v[36:37], v[36:37], v[120:121] op_sel_hi:[1,0]
v_pk_mul_f32 v[38:39], v[38:39], v[120:121] op_sel_hi:[1,0]
v_cvt_pk_bf16_f32 v32, v32, v33
v_cvt_pk_bf16_f32 v33, v34, v35
v_cvt_pk_bf16_f32 v34, v36, v37
v_cvt_pk_bf16_f32 v35, v38, v39
s_add_u32 s3, s6, 0
buffer_store_dwordx4 v[32:35], v1, s[16:19], s3 offen sc1
v_pk_mul_f32 v[40:41], v[40:41], v[124:125] op_sel_hi:[1,0]
v_pk_mul_f32 v[42:43], v[42:43], v[124:125] op_sel_hi:[1,0]
v_pk_mul_f32 v[44:45], v[44:45], v[124:125] op_sel_hi:[1,0]
v_pk_mul_f32 v[46:47], v[46:47], v[124:125] op_sel_hi:[1,0]
v_cvt_pk_bf16_f32 v40, v40, v41
v_cvt_pk_bf16_f32 v41, v42, v43
v_cvt_pk_bf16_f32 v42, v44, v45
v_cvt_pk_bf16_f32 v43, v46, v47
s_add_u32 s3, s6, 2048
buffer_store_dwordx4 v[40:43], v1, s[16:19], s3 offen sc1
v_pk_mul_f32 v[48:49], v[48:49], v[128:129] op_sel_hi:[1,0]
v_pk_mul_f32 v[50:51], v[50:51], v[128:129] op_sel_hi:[1,0]
v_pk_mul_f32 v[52:53], v[52:53], v[128:129] op_sel_hi:[1,0]
v_pk_mul_f32 v[54:55], v[54:55], v[128:129] op_sel_hi:[1,0]
v_cvt_pk_bf16_f32 v48, v48, v49
v_cvt_pk_bf16_f32 v49, v50, v51
v_cvt_pk_bf16_f32 v50, v52, v53
v_cvt_pk_bf16_f32 v51, v54, v55
s_add_u32 s3, s6, 4096
buffer_store_dwordx4 v[48:51], v1, s[16:19], s3 offen sc1
v_pk_mul_f32 v[56:57], v[56:57], v[132:133] op_sel_hi:[1,0]
v_pk_mul_f32 v[58:59], v[58:59], v[132:133] op_sel_hi:[1,0]
v_pk_mul_f32 v[60:61], v[60:61], v[132:133] op_sel_hi:[1,0]
v_pk_mul_f32 v[62:63], v[62:63], v[132:133] op_sel_hi:[1,0]
v_cvt_pk_bf16_f32 v56, v56, v57
v_cvt_pk_bf16_f32 v57, v58, v59
v_cvt_pk_bf16_f32 v58, v60, v61
v_cvt_pk_bf16_f32 v59, v62, v63
s_add_u32 s3, s6, 6144
buffer_store_dwordx4 v[56:59], v1, s[16:19], s3 offen sc1
Lc2:
s_add_u32 s16, s4, 67108864
s_addc_u32 s17, s5, 0
s_mov_b32 s18, 16777216
s_mov_b32 s19, 0x00020000
s_add_u32 s52, s4, 100663296
s_addc_u32 s53, s5, 0
s_mov_b32 s54, 16793600
s_mov_b32 s55, 0x00020000
s_mov_b32 s46, 8388608
s_mov_b32 s47, 0x00020000
s_mov_b32 s50, 2097152
s_mov_b32 s51, 0x00020000
s_lshl_b32 s33, s24, 14
v_add_u32 v2, 0, v1
v_add_u32 v3, 0x10000, v2
v_mov_b32 v5, v2
v_mov_b32 v6, v3
v_and_b32 v8, 15, v0
v_bfe_u32 v9, v0, 4, 2
v_lshlrev_b32 v9, 2, v9
v_sub_u32 v8, v8, v9
v_mov_b32 v4, 0xf149f2ca
v_cmp_gt_i32 vcc, 0, v8
s_nop 1
v_cndmask_b32 v16, 0, v4, vcc
v_cmp_gt_i32 vcc, 1, v8
s_nop 1
v_cndmask_b32 v17, 0, v4, vcc
v_cmp_gt_i32 vcc, 2, v8
s_nop 1
v_cndmask_b32 v18, 0, v4, vcc
v_cmp_gt_i32 vcc, 3, v8
s_nop 1
v_cndmask_b32 v19, 0, v4, vcc
v_mov_b32 v8, 0x3f803f80
v_accvgpr_write_b32 a112, v8
v_accvgpr_write_b32 a113, v8
v_accvgpr_write_b32 a114, v8
v_accvgpr_write_b32 a115, v8
s_lshl_b32 s33, s23, 6
s_add_i32 s33, s33, s31
s_cmp_gt_i32 s33, 0
s_cselect_b32 s34, 0, 0xf149f2ca
s_cmp_lt_i32 s33, 0
s_cselect_b32 s33, 0xf149f2ca, 0
v_mov_b32 v20, s34
v_mov_b32 v21, s34
v_mov_b32 v22, s34
v_mov_b32 v23, s34
v_mov_b32 v28, s33
v_mov_b32 v29, s33
v_mov_b32 v30, s33
v_mov_b32 v31, s33
v_med3_f32 v24, v16, v20, v28
v_med3_f32 v25, v17, v20, v28
v_med3_f32 v26, v18, v20, v28
v_med3_f32 v27, v19, v20, v28
v_mov_b32 v12, 0
v_mov_b32 v13, 1
s_waitcnt vmcnt(20)
s_barrier
ds_read_b128 a[116:119], v3 offset:0
ds_read_b128 a[120:123], v3 offset:1024
ds_read_b128 a[124:127], v3 offset:2048
ds_read_b128 a[128:131], v3 offset:3072
ds_read_b128 a[132:135], v3 offset:4096
ds_read_b128 a[136:139], v3 offset:5120
ds_read_b128 a[140:143], v3 offset:6144
ds_read_b128 a[144:147], v3 offset:7168
s_waitcnt lgkmcnt(4)
M v[32:35], a[116:119], a[0:3], v[24:27]
M v[32:35], a[120:123], a[4:7], v[32:35]
ds_read_b128 a[148:151], v3 offset:8192
ds_read_b128 a[152:155], v3 offset:9216
M v[32:35], a[124:127], a[8:11], v[32:35]
M v[32:35], a[128:131], a[12:15], v[32:35]
M v[36:39], a[128:131], a[28:31], v[28:31]
M v[36:39], a[124:127], a[24:27], v[36:39]
M v[36:39], a[120:123], a[20:23], v[36:39]
M v[36:39], a[116:119], a[16:19], v[36:39]
M v[40:43], a[116:119], a[32:35], v[28:31]
M v[40:43], a[120:123], a[36:39], v[40:43]
ds_read_b128 a[156:159], v3 offset:10240
ds_read_b128 a[160:163], v3 offset:11264
M v[40:43], a[124:127], a[40:43], v[40:43]
M v[40:43], a[128:131], a[44:47], v[40:43]
M v[44:47], a[128:131], a[60:63], v[28:31]
M v[44:47], a[124:127], a[56:59], v[44:47]
M v[44:47], a[120:123], a[52:55], v[44:47]
M v[44:47], a[116:119], a[48:51], v[44:47]
s_waitcnt lgkmcnt(4)
M v[48:51], a[132:135], a[0:3], v[20:23]
M v[48:51], a[136:139], a[4:7], v[48:51]
ds_read_b128 a[164:167], v3 offset:12288
ds_read_b128 a[168:171], v3 offset:13312
M v[48:51], a[140:143], a[8:11], v[48:51]
M v[48:51], a[144:147], a[12:15], v[48:51]
M v[52:55], a[144:147], a[28:31], v[24:27]
M v[52:55], a[140:143], a[24:27], v[52:55]
M v[52:55], a[136:139], a[20:23], v[52:55]
M v[52:55], a[132:135], a[16:19], v[52:55]
M v[56:59], a[132:135], a[32:35], v[28:31]
M v[56:59], a[136:139], a[36:39], v[56:59]
ds_read_b128 a[172:175], v3 offset:14336
ds_read_b128 a[176:179], v3 offset:15360
M v[56:59], a[140:143], a[40:43], v[56:59]
M v[56:59], a[144:147], a[44:47], v[56:59]
M v[60:63], a[144:147], a[60:63], v[28:31]
M v[60:63], a[140:143], a[56:59], v[60:63]
M v[60:63], a[136:139], a[52:55], v[60:63]
M v[60:63], a[132:135], a[48:51], v[60:63]
s_waitcnt lgkmcnt(4)
M v[64:67], a[148:151], a[0:3], v[20:23]
M v[64:67], a[152:155], a[4:7], v[64:67]
M v[64:67], a[156:159], a[8:11], v[64:67]
M v[64:67], a[160:163], a[12:15], v[64:67]
M v[68:71], a[160:163], a[28:31], v[20:23]
M v[68:71], a[156:159], a[24:27], v[68:71]
M v[68:71], a[152:155], a[20:23], v[68:71]
M v[68:71], a[148:151], a[16:19], v[68:71]
M v[72:75], a[148:151], a[32:35], v[24:27]
M v[72:75], a[152:155], a[36:39], v[72:75]
M v[72:75], a[156:159], a[40:43], v[72:75]
M v[72:75], a[160:163], a[44:47], v[72:75]
M v[76:79], a[160:163], a[60:63], v[28:31]
M v[76:79], a[156:159], a[56:59], v[76:79]
s_waitcnt vmcnt(4) lgkmcnt(0)
s_barrier
ds_read_b128 a[116:119], v2 offset:0
ds_read_b128 a[120:123], v2 offset:1024
M v[76:79], a[152:155], a[52:55], v[76:79]
M v[76:79], a[148:151], a[48:51], v[76:79]
M v[80:83], a[164:167], a[0:3], v[20:23]
M v[80:83], a[168:171], a[4:7], v[80:83]
ds_read_b128 a[124:127], v2 offset:2048
ds_read_b128 a[128:131], v2 offset:3072
M v[80:83], a[172:175], a[8:11], v[80:83]
M v[80:83], a[176:179], a[12:15], v[80:83]
M v[84:87], a[176:179], a[28:31], v[20:23]
M v[84:87], a[172:175], a[24:27], v[84:87]
ds_read_b128 a[132:135], v2 offset:4096
ds_read_b128 a[136:139], v2 offset:5120
M v[84:87], a[168:171], a[20:23], v[84:87]
M v[84:87], a[164:167], a[16:19], v[84:87]
M v[88:91], a[164:167], a[32:35], v[20:23]
M v[88:91], a[168:171], a[36:39], v[88:91]
ds_read_b128 a[140:143], v2 offset:6144
ds_read_b128 a[144:147], v2 offset:7168
M v[88:91], a[172:175], a[40:43], v[88:91]
M v[88:91], a[176:179], a[44:47], v[88:91]
M v[92:95], a[176:179], a[60:63], v[24:27]
M v[92:95], a[172:175], a[56:59], v[92:95]
M v[92:95], a[168:171], a[52:55], v[92:95]
M v[92:95], a[164:167], a[48:51], v[92:95]
s_waitcnt vmcnt(0)
s_mov_b64 exec, 1
buffer_store_dword v13, v12, s[52:55], s65 offen sc1
s_mov_b64 exec, -1
v_exp_f32 v32, v32
v_exp_f32 v33, v33
v_exp_f32 v34, v34
v_exp_f32 v35, v35
v_exp_f32 v48, v48
v_exp_f32 v49, v49
v_exp_f32 v50, v50
v_exp_f32 v51, v51
v_cvt_pk_bf16_f32 v32, v32, v33
v_cvt_pk_bf16_f32 v33, v34, v35
v_exp_f32 v36, v36
v_exp_f32 v37, v37
v_exp_f32 v38, v38
v_exp_f32 v39, v39
v_cvt_pk_bf16_f32 v34, v48, v49
v_cvt_pk_bf16_f32 v35, v50, v51
v_exp_f32 v52, v52
v_exp_f32 v53, v53
v_exp_f32 v54, v54
v_exp_f32 v55, v55
v_cvt_pk_bf16_f32 v36, v36, v37
v_cvt_pk_bf16_f32 v37, v38, v39
v_exp_f32 v40, v40
v_exp_f32 v41, v41
v_exp_f32 v42, v42
v_exp_f32 v43, v43
v_cvt_pk_bf16_f32 v38, v52, v53
v_cvt_pk_bf16_f32 v39, v54, v55
v_exp_f32 v56, v56
v_exp_f32 v57, v57
v_exp_f32 v58, v58
v_exp_f32 v59, v59
v_cvt_pk_bf16_f32 v40, v40, v41
v_cvt_pk_bf16_f32 v41, v42, v43
v_exp_f32 v44, v44
v_exp_f32 v45, v45
v_exp_f32 v46, v46
v_exp_f32 v47, v47
v_cvt_pk_bf16_f32 v42, v56, v57
v_cvt_pk_bf16_f32 v43, v58, v59
v_exp_f32 v60, v60
v_exp_f32 v61, v61
v_exp_f32 v62, v62
v_exp_f32 v63, v63
v_cvt_pk_bf16_f32 v44, v44, v45
v_cvt_pk_bf16_f32 v45, v46, v47
v_cvt_pk_bf16_f32 v46, v60, v61
v_cvt_pk_bf16_f32 v47, v62, v63
s_cmp_eq_u32 s24, 1
s_cbranch_scc1 Lk2_g1
s_mov_b32 s30, s21
s_cmp_eq_u32 s21, 0
s_cbranch_scc1 Lk2_m2
Lk2_l1:
s_add_u32 m0, s29, 65536
s_waitcnt lgkmcnt(4)
M v[96:99], a[116:119], a[0:3], 0
v_exp_f32 v64, v64
M v[96:99], a[120:123], a[4:7], v[96:99]
ds_read_b128 a[148:151], v2 offset:8192
ds_read_b128 a[152:155], v2 offset:9216
M v[96:99], a[124:127], a[8:11], v[96:99]
v_exp_f32 v65, v65
M v[96:99], a[128:131], a[12:15], v[96:99]
buffer_load_dwordx4 v1, s[12:15], s25 offen offset:0 sc1 lds
s_add_u32 s32, s25, 4096
M v[100:103], a[128:131], a[28:31], 0
v_exp_f32 v66, v66
M v[100:103], a[124:127], a[24:27], v[100:103]
v_cvt_pk_bf16_f32 v64, v64, v65
M v[100:103], a[120:123], a[20:23], v[100:103]
v_exp_f32 v67, v67
M v[100:103], a[116:119], a[16:19], v[100:103]
buffer_load_dwordx4 v1, s[12:15], s25 offen offset:1024 sc1 lds
M v[104:107], a[116:119], a[32:35], 0
v_exp_f32 v80, v80
M v[104:107], a[120:123], a[36:39], v[104:107]
ds_read_b128 a[156:159], v2 offset:10240
ds_read_b128 a[160:163], v2 offset:11264
M v[104:107], a[124:127], a[40:43], v[104:107]
v_exp_f32 v81, v81
M v[104:107], a[128:131], a[44:47], v[104:107]
buffer_load_dwordx4 v1, s[12:15], s25 offen offset:2048 sc1 lds
M v[108:111], a[128:131], a[60:63], 0
v_exp_f32 v82, v82
M v[108:111], a[124:127], a[56:59], v[108:111]
v_cvt_pk_bf16_f32 v65, v66, v67
v_cvt_pk_bf16_f32 v66, v80, v81
M v[108:111], a[120:123], a[52:55], v[108:111]
v_exp_f32 v83, v83
M v[108:111], a[116:119], a[48:51], v[108:111]
buffer_load_dwordx4 v1, s[12:15], s25 offen offset:3072 sc1 lds
s_add_u32 m0, s29, 69632
s_waitcnt lgkmcnt(4)
M v[112:115], a[132:135], a[0:3], 0
v_exp_f32 v68, v68
M v[112:115], a[136:139], a[4:7], v[112:115]
ds_read_b128 a[164:167], v2 offset:12288
ds_read_b128 a[168:171], v2 offset:13312
M v[112:115], a[140:143], a[8:11], v[112:115]
v_exp_f32 v69, v69
M v[112:115], a[144:147], a[12:15], v[112:115]
buffer_load_dwordx4 v1, s[12:15], s32 offen offset:0 sc1 lds
M v[116:119], a[144:147], a[28:31], 0
v_exp_f32 v70, v70
M v[116:119], a[140:143], a[24:27], v[116:119]
v_cvt_pk_bf16_f32 v67, v82, v83
v_cvt_pk_bf16_f32 v68, v68, v69
M v[116:119], a[136:139], a[20:23], v[116:119]
v_exp_f32 v71, v71
M v[116:119], a[132:135], a[16:19], v[116:119]
buffer_load_dwordx4 v1, s[12:15], s32 offen offset:1024 sc1 lds
M v[120:123], a[132:135], a[32:35], 0
v_exp_f32 v84, v84
M v[120:123], a[136:139], a[36:39], v[120:123]
ds_read_b128 a[172:175], v2 offset:14336
ds_read_b128 a[176:179], v2 offset:15360
M v[120:123], a[140:143], a[40:43], v[120:123]
v_exp_f32 v85, v85
M v[120:123], a[144:147], a[44:47], v[120:123]
buffer_load_dwordx4 v1, s[12:15], s32 offen offset:2048 sc1 lds
M v[124:127], a[144:147], a[60:63], 0
v_exp_f32 v86, v86
M v[124:127], a[140:143], a[56:59], v[124:127]
v_cvt_pk_bf16_f32 v69, v70, v71
v_cvt_pk_bf16_f32 v70, v84, v85
M v[124:127], a[136:139], a[52:55], v[124:127]
v_exp_f32 v87, v87
M v[124:127], a[132:135], a[48:51], v[124:127]
buffer_load_dwordx4 v1, s[12:15], s32 offen offset:3072 sc1 lds
s_add_u32 m0, s29, 98304
s_waitcnt lgkmcnt(4)
M v[128:131], a[148:151], a[0:3], 0
v_exp_f32 v72, v72
M v[128:131], a[152:155], a[4:7], v[128:131]
ds_read_b128 a[116:119], v5 offset:32768
ds_read_b128 a[120:123], v5 offset:40960
M v[128:131], a[156:159], a[8:11], v[128:131]
v_exp_f32 v73, v73
M v[128:131], a[160:163], a[12:15], v[128:131]
buffer_load_dwordx4 v1, s[12:15], s26 offen offset:0 sc1 lds
s_add_u32 s43, s26, 4096
M v[132:135], a[160:163], a[28:31], 0
v_exp_f32 v74, v74
M v[132:135], a[156:159], a[24:27], v[132:135]
v_cvt_pk_bf16_f32 v71, v86, v87
v_cvt_pk_bf16_f32 v72, v72, v73
M v[132:135], a[152:155], a[20:23], v[132:135]
v_exp_f32 v75, v75
M v[132:135], a[148:151], a[16:19], v[132:135]
buffer_load_dwordx4 v1, s[12:15], s26 offen offset:1024 sc1 lds
M v[136:139], a[148:151], a[32:35], 0
v_exp_f32 v88, v88
M v[136:139], a[152:155], a[36:39], v[136:139]
ds_read_b128 a[124:127], v5 offset:33792
ds_read_b128 a[128:131], v5 offset:41984
M v[136:139], a[156:159], a[40:43], v[136:139]
v_exp_f32 v89, v89
M v[136:139], a[160:163], a[44:47], v[136:139]
buffer_load_dwordx4 v1, s[12:15], s26 offen offset:2048 sc1 lds
M v[140:143], a[160:163], a[60:63], 0
v_exp_f32 v90, v90
M v[140:143], a[156:159], a[56:59], v[140:143]
v_cvt_pk_bf16_f32 v73, v74, v75
v_cvt_pk_bf16_f32 v74, v88, v89
M v[140:143], a[152:155], a[52:55], v[140:143]
v_exp_f32 v91, v91
M v[140:143], a[148:151], a[48:51], v[140:143]
buffer_load_dwordx4 v1, s[12:15], s26 offen offset:3072 sc1 lds
s_add_u32 m0, s29, 102400
s_waitcnt lgkmcnt(4)
M v[144:147], a[164:167], a[0:3], 0
v_exp_f32 v76, v76
M v[144:147], a[168:171], a[4:7], v[144:147]
ds_read_b128 a[132:135], v5 offset:34816
ds_read_b128 a[136:139], v5 offset:43008
M v[144:147], a[172:175], a[8:11], v[144:147]
v_exp_f32 v77, v77
M v[144:147], a[176:179], a[12:15], v[144:147]
buffer_load_dwordx4 v1, s[12:15], s43 offen offset:0 sc1 lds
M v[148:151], a[176:179], a[28:31], 0
v_exp_f32 v78, v78
M v[148:151], a[172:175], a[24:27], v[148:151]
v_cvt_pk_bf16_f32 v75, v90, v91
v_cvt_pk_bf16_f32 v76, v76, v77
M v[148:151], a[168:171], a[20:23], v[148:151]
v_exp_f32 v79, v79
M v[148:151], a[164:167], a[16:19], v[148:151]
buffer_load_dwordx4 v1, s[12:15], s43 offen offset:1024 sc1 lds
M v[152:155], a[164:167], a[32:35], 0
v_exp_f32 v92, v92
M v[152:155], a[168:171], a[36:39], v[152:155]
ds_read_b128 a[140:143], v5 offset:35840
ds_read_b128 a[144:147], v5 offset:44032
M v[152:155], a[172:175], a[40:43], v[152:155]
v_exp_f32 v93, v93
M v[152:155], a[176:179], a[44:47], v[152:155]
buffer_load_dwordx4 v1, s[12:15], s43 offen offset:2048 sc1 lds
M v[156:159], a[176:179], a[60:63], 0
v_exp_f32 v94, v94
M v[156:159], a[172:175], a[56:59], v[156:159]
v_cvt_pk_bf16_f32 v77, v78, v79
v_cvt_pk_bf16_f32 v78, v92, v93
M v[156:159], a[168:171], a[52:55], v[156:159]
v_exp_f32 v95, v95
M v[156:159], a[164:167], a[48:51], v[156:159]
buffer_load_dwordx4 v1, s[12:15], s43 offen offset:3072 sc1 lds
v_cvt_pk_bf16_f32 v79, v94, v95
s_waitcnt lgkmcnt(6)
M v[160:163], a[116:119], v[32:35], v[160:163]
v_exp_f32 v96, v96
M v[160:163], a[120:123], v[64:67], v[160:163]
ds_read_b128 a[148:151], v5 offset:36864
ds_read_b128 a[152:155], v5 offset:45056
M v[164:167], a[120:123], v[68:71], v[164:167]
v_exp_f32 v97, v97
M v[164:167], a[116:119], v[36:39], v[164:167]
v_cvt_pk_bf16_f32 v96, v96, v97
M v[168:171], a[116:119], v[40:43], v[168:171]
v_exp_f32 v98, v98
M v[168:171], a[120:123], v[72:75], v[168:171]
s_add_u32 s25, s25, 32768
s_cmp_eq_u32 s25, s27
M v[172:175], a[120:123], v[76:79], v[172:175]
v_exp_f32 v99, v99
M v[172:175], a[116:119], v[44:47], v[172:175]
v_cvt_pk_bf16_f32 v97, v98, v99
s_waitcnt lgkmcnt(6)
M a[96:99], a[112:115], v[32:35], a[96:99]
s_cselect_b32 s25, s28, s25
s_cselect_b32 s27, -1, s27
M a[96:99], a[112:115], v[64:67], a[96:99]
s_add_u32 s26, s26, 32768
s_cmp_eq_u32 s26, s62
M v[176:179], a[124:127], v[32:35], v[176:179]
v_exp_f32 v112, v112
M v[176:179], a[128:131], v[64:67], v[176:179]
ds_read_b128 a[156:159], v5 offset:37888
ds_read_b128 a[160:163], v5 offset:46080
M v[180:183], a[128:131], v[68:71], v[180:183]
v_exp_f32 v113, v113
M v[180:183], a[124:127], v[36:39], v[180:183]
v_cvt_pk_bf16_f32 v98, v112, v113
M v[184:187], a[124:127], v[40:43], v[184:187]
v_exp_f32 v114, v114
M v[184:187], a[128:131], v[72:75], v[184:187]
s_cselect_b32 s26, s63, s26
s_cselect_b32 s62, -1, s62
M v[188:191], a[128:131], v[76:79], v[188:191]
v_exp_f32 v115, v115
M v[188:191], a[124:127], v[44:47], v[188:191]
v_cvt_pk_bf16_f32 v99, v114, v115
s_waitcnt lgkmcnt(6)
M a[100:103], a[112:115], v[36:39], a[100:103]
M a[100:103], a[112:115], v[68:71], a[100:103]
M v[192:195], a[132:135], v[32:35], v[192:195]
v_exp_f32 v100, v100
M v[192:195], a[136:139], v[64:67], v[192:195]
ds_read_b128 a[164:167], v5 offset:38912
ds_read_b128 a[168:171], v5 offset:47104
M v[196:199], a[136:139], v[68:71], v[196:199]
v_exp_f32 v101, v101
M v[196:199], a[132:135], v[36:39], v[196:199]
v_cvt_pk_bf16_f32 v100, v100, v101
M v[200:203], a[132:135], v[40:43], v[200:203]
v_exp_f32 v102, v102
M v[200:203], a[136:139], v[72:75], v[200:203]
M v[204:207], a[136:139], v[76:79], v[204:207]
v_exp_f32 v103, v103
M v[204:207], a[132:135], v[44:47], v[204:207]
v_cvt_pk_bf16_f32 v101, v102, v103
s_waitcnt lgkmcnt(6)
M a[104:107], a[112:115], v[40:43], a[104:107]
M a[104:107], a[112:115], v[72:75], a[104:107]
M v[208:211], a[140:143], v[32:35], v[208:211]
v_exp_f32 v116, v116
M v[208:211], a[144:147], v[64:67], v[208:211]
ds_read_b128 a[172:175], v5 offset:39936
ds_read_b128 a[176:179], v5 offset:48128
M v[212:215], a[144:147], v[68:71], v[212:215]
v_exp_f32 v117, v117
M v[212:215], a[140:143], v[36:39], v[212:215]
v_cvt_pk_bf16_f32 v102, v116, v117
M v[216:219], a[140:143], v[40:43], v[216:219]
v_exp_f32 v118, v118
M v[216:219], a[144:147], v[72:75], v[216:219]
M v[220:223], a[144:147], v[76:79], v[220:223]
v_exp_f32 v119, v119
M v[220:223], a[140:143], v[44:47], v[220:223]
v_cvt_pk_bf16_f32 v103, v118, v119
s_waitcnt lgkmcnt(6)
M a[108:111], a[112:115], v[44:47], a[108:111]
M a[108:111], a[112:115], v[76:79], a[108:111]
M v[224:227], a[148:151], v[32:35], v[224:227]
v_exp_f32 v104, v104
M v[224:227], a[152:155], v[64:67], v[224:227]
M v[228:231], a[152:155], v[68:71], v[228:231]
v_exp_f32 v105, v105
M v[228:231], a[148:151], v[36:39], v[228:231]
v_cvt_pk_bf16_f32 v104, v104, v105
M v[232:235], a[148:151], v[40:43], v[232:235]
v_exp_f32 v106, v106
M v[232:235], a[152:155], v[72:75], v[232:235]
M v[236:239], a[152:155], v[76:79], v[236:239]
v_exp_f32 v107, v107
M v[236:239], a[148:151], v[44:47], v[236:239]
v_cvt_pk_bf16_f32 v105, v106, v107
s_waitcnt lgkmcnt(4)
M v[240:243], a[156:159], v[32:35], v[240:243]
v_exp_f32 v120, v120
M v[240:243], a[160:163], v[64:67], v[240:243]
M v[244:247], a[160:163], v[68:71], v[244:247]
v_exp_f32 v121, v121
M v[244:247], a[156:159], v[36:39], v[244:247]
v_cvt_pk_bf16_f32 v106, v120, v121
M v[248:251], a[156:159], v[40:43], v[248:251]
v_exp_f32 v122, v122
M v[248:251], a[160:163], v[72:75], v[248:251]
s_waitcnt vmcnt(0) lgkmcnt(0)
s_barrier
ds_read_b128 a[116:119], v3 offset:0
ds_read_b128 a[120:123], v3 offset:1024
M v[252:255], a[160:163], v[76:79], v[252:255]
v_exp_f32 v123, v123
M v[252:255], a[156:159], v[44:47], v[252:255]
v_cvt_pk_bf16_f32 v107, v122, v123
M a[64:67], a[164:167], v[32:35], a[64:67]
v_exp_f32 v108, v108
M a[64:67], a[168:171], v[64:67], a[64:67]
ds_read_b128 a[124:127], v3 offset:2048
ds_read_b128 a[128:131], v3 offset:3072
M a[68:71], a[168:171], v[68:71], a[68:71]
v_exp_f32 v109, v109
M a[68:71], a[164:167], v[36:39], a[68:71]
v_cvt_pk_bf16_f32 v108, v108, v109
M a[72:75], a[164:167], v[40:43], a[72:75]
v_exp_f32 v110, v110
M a[72:75], a[168:171], v[72:75], a[72:75]
ds_read_b128 a[132:135], v3 offset:4096
ds_read_b128 a[136:139], v3 offset:5120
M a[76:79], a[168:171], v[76:79], a[76:79]
v_exp_f32 v111, v111
M a[76:79], a[164:167], v[44:47], a[76:79]
v_cvt_pk_bf16_f32 v109, v110, v111
M a[80:83], a[172:175], v[32:35], a[80:83]
v_exp_f32 v124, v124
M a[80:83], a[176:179], v[64:67], a[80:83]
ds_read_b128 a[140:143], v3 offset:6144
ds_read_b128 a[144:147], v3 offset:7168
M a[84:87], a[176:179], v[68:71], a[84:87]
v_exp_f32 v125, v125
M a[84:87], a[172:175], v[36:39], a[84:87]
v_cvt_pk_bf16_f32 v110, v124, v125
M a[88:91], a[172:175], v[40:43], a[88:91]
v_exp_f32 v126, v126
M a[88:91], a[176:179], v[72:75], a[88:91]
M a[92:95], a[176:179], v[76:79], a[92:95]
v_exp_f32 v127, v127
M a[92:95], a[172:175], v[44:47], a[92:95]
v_cvt_pk_bf16_f32 v111, v126, v127
s_sub_u32 s30, s30, 1
s_cmp_eq_u32 s30, 0
s_cbranch_scc1 Lk2_m1
s_add_u32 m0, s29, 0
s_waitcnt lgkmcnt(4)
M v[32:35], a[116:119], a[0:3], 0
v_exp_f32 v128, v128
M v[32:35], a[120:123], a[4:7], v[32:35]
ds_read_b128 a[148:151], v3 offset:8192
ds_read_b128 a[152:155], v3 offset:9216
M v[32:35], a[124:127], a[8:11], v[32:35]
v_exp_f32 v129, v129
M v[32:35], a[128:131], a[12:15], v[32:35]
buffer_load_dwordx4 v1, s[12:15], s25 offen offset:0 sc1 lds
s_add_u32 s32, s25, 4096
M v[36:39], a[128:131], a[28:31], 0
v_exp_f32 v130, v130
M v[36:39], a[124:127], a[24:27], v[36:39]
v_cvt_pk_bf16_f32 v128, v128, v129
M v[36:39], a[120:123], a[20:23], v[36:39]
v_exp_f32 v131, v131
M v[36:39], a[116:119], a[16:19], v[36:39]
buffer_load_dwordx4 v1, s[12:15], s25 offen offset:1024 sc1 lds
M v[40:43], a[116:119], a[32:35], 0
v_exp_f32 v144, v144
M v[40:43], a[120:123], a[36:39], v[40:43]
ds_read_b128 a[156:159], v3 offset:10240
ds_read_b128 a[160:163], v3 offset:11264
M v[40:43], a[124:127], a[40:43], v[40:43]
v_exp_f32 v145, v145
M v[40:43], a[128:131], a[44:47], v[40:43]
buffer_load_dwordx4 v1, s[12:15], s25 offen offset:2048 sc1 lds
M v[44:47], a[128:131], a[60:63], 0
v_exp_f32 v146, v146
M v[44:47], a[124:127], a[56:59], v[44:47]
v_cvt_pk_bf16_f32 v129, v130, v131
v_cvt_pk_bf16_f32 v130, v144, v145
M v[44:47], a[120:123], a[52:55], v[44:47]
v_exp_f32 v147, v147
M v[44:47], a[116:119], a[48:51], v[44:47]
buffer_load_dwordx4 v1, s[12:15], s25 offen offset:3072 sc1 lds
s_add_u32 m0, s29, 4096
s_waitcnt lgkmcnt(4)
M v[48:51], a[132:135], a[0:3], 0
v_exp_f32 v132, v132
M v[48:51], a[136:139], a[4:7], v[48:51]
ds_read_b128 a[164:167], v3 offset:12288
ds_read_b128 a[168:171], v3 offset:13312
M v[48:51], a[140:143], a[8:11], v[48:51]
v_exp_f32 v133, v133
M v[48:51], a[144:147], a[12:15], v[48:51]
buffer_load_dwordx4 v1, s[12:15], s32 offen offset:0 sc1 lds
M v[52:55], a[144:147], a[28:31], 0
v_exp_f32 v134, v134
M v[52:55], a[140:143], a[24:27], v[52:55]
v_cvt_pk_bf16_f32 v131, v146, v147
v_cvt_pk_bf16_f32 v132, v132, v133
M v[52:55], a[136:139], a[20:23], v[52:55]
v_exp_f32 v135, v135
M v[52:55], a[132:135], a[16:19], v[52:55]
buffer_load_dwordx4 v1, s[12:15], s32 offen offset:1024 sc1 lds
M v[56:59], a[132:135], a[32:35], 0
v_exp_f32 v148, v148
M v[56:59], a[136:139], a[36:39], v[56:59]
ds_read_b128 a[172:175], v3 offset:14336
ds_read_b128 a[176:179], v3 offset:15360
M v[56:59], a[140:143], a[40:43], v[56:59]
v_exp_f32 v149, v149
M v[56:59], a[144:147], a[44:47], v[56:59]
buffer_load_dwordx4 v1, s[12:15], s32 offen offset:2048 sc1 lds
M v[60:63], a[144:147], a[60:63], 0
v_exp_f32 v150, v150
M v[60:63], a[140:143], a[56:59], v[60:63]
v_cvt_pk_bf16_f32 v133, v134, v135
v_cvt_pk_bf16_f32 v134, v148, v149
M v[60:63], a[136:139], a[52:55], v[60:63]
v_exp_f32 v151, v151
M v[60:63], a[132:135], a[48:51], v[60:63]
buffer_load_dwordx4 v1, s[12:15], s32 offen offset:3072 sc1 lds
s_add_u32 m0, s29, 32768
s_waitcnt lgkmcnt(4)
M v[64:67], a[148:151], a[0:3], 0
v_exp_f32 v136, v136
M v[64:67], a[152:155], a[4:7], v[64:67]
ds_read_b128 a[116:119], v6 offset:32768
ds_read_b128 a[120:123], v6 offset:40960
M v[64:67], a[156:159], a[8:11], v[64:67]
v_exp_f32 v137, v137
M v[64:67], a[160:163], a[12:15], v[64:67]
buffer_load_dwordx4 v1, s[12:15], s26 offen offset:0 sc1 lds
s_add_u32 s43, s26, 4096
M v[68:71], a[160:163], a[28:31], 0
v_exp_f32 v138, v138
M v[68:71], a[156:159], a[24:27], v[68:71]
v_cvt_pk_bf16_f32 v135, v150, v151
v_cvt_pk_bf16_f32 v136, v136, v137
M v[68:71], a[152:155], a[20:23], v[68:71]
v_exp_f32 v139, v139
M v[68:71], a[148:151], a[16:19], v[68:71]
buffer_load_dwordx4 v1, s[12:15], s26 offen offset:1024 sc1 lds
M v[72:75], a[148:151], a[32:35], 0
v_exp_f32 v152, v152
M v[72:75], a[152:155], a[36:39], v[72:75]
ds_read_b128 a[124:127], v6 offset:33792
ds_read_b128 a[128:131], v6 offset:41984
M v[72:75], a[156:159], a[40:43], v[72:75]
v_exp_f32 v153, v153
M v[72:75], a[160:163], a[44:47], v[72:75]
buffer_load_dwordx4 v1, s[12:15], s26 offen offset:2048 sc1 lds
M v[76:79], a[160:163], a[60:63], 0
v_exp_f32 v154, v154
M v[76:79], a[156:159], a[56:59], v[76:79]
v_cvt_pk_bf16_f32 v137, v138, v139
v_cvt_pk_bf16_f32 v138, v152, v153
M v[76:79], a[152:155], a[52:55], v[76:79]
v_exp_f32 v155, v155
M v[76:79], a[148:151], a[48:51], v[76:79]
buffer_load_dwordx4 v1, s[12:15], s26 offen offset:3072 sc1 lds
s_add_u32 m0, s29, 36864
s_waitcnt lgkmcnt(4)
M v[80:83], a[164:167], a[0:3], 0
v_exp_f32 v140, v140
M v[80:83], a[168:171], a[4:7], v[80:83]
ds_read_b128 a[132:135], v6 offset:34816
ds_read_b128 a[136:139], v6 offset:43008
M v[80:83], a[172:175], a[8:11], v[80:83]
v_exp_f32 v141, v141
M v[80:83], a[176:179], a[12:15], v[80:83]
buffer_load_dwordx4 v1, s[12:15], s43 offen offset:0 sc1 lds
M v[84:87], a[176:179], a[28:31], 0
v_exp_f32 v142, v142
M v[84:87], a[172:175], a[24:27], v[84:87]
v_cvt_pk_bf16_f32 v139, v154, v155
v_cvt_pk_bf16_f32 v140, v140, v141
M v[84:87], a[168:171], a[20:23], v[84:87]
v_exp_f32 v143, v143
M v[84:87], a[164:167], a[16:19], v[84:87]
buffer_load_dwordx4 v1, s[12:15], s43 offen offset:1024 sc1 lds
M v[88:91], a[164:167], a[32:35], 0
v_exp_f32 v156, v156
M v[88:91], a[168:171], a[36:39], v[88:91]
ds_read_b128 a[140:143], v6 offset:35840
ds_read_b128 a[144:147], v6 offset:44032
M v[88:91], a[172:175], a[40:43], v[88:91]
v_exp_f32 v157, v157
M v[88:91], a[176:179], a[44:47], v[88:91]
buffer_load_dwordx4 v1, s[12:15], s43 offen offset:2048 sc1 lds
M v[92:95], a[176:179], a[60:63], 0
v_exp_f32 v158, v158
M v[92:95], a[172:175], a[56:59], v[92:95]
v_cvt_pk_bf16_f32 v141, v142, v143
v_cvt_pk_bf16_f32 v142, v156, v157
M v[92:95], a[168:171], a[52:55], v[92:95]
v_exp_f32 v159, v159
M v[92:95], a[164:167], a[48:51], v[92:95]
buffer_load_dwordx4 v1, s[12:15], s43 offen offset:3072 sc1 lds
v_cvt_pk_bf16_f32 v143, v158, v159
s_waitcnt lgkmcnt(6)
M v[160:163], a[116:119], v[96:99], v[160:163]
v_exp_f32 v32, v32
M v[160:163], a[120:123], v[128:131], v[160:163]
ds_read_b128 a[148:151], v6 offset:36864
ds_read_b128 a[152:155], v6 offset:45056
M v[164:167], a[120:123], v[132:135], v[164:167]
v_exp_f32 v33, v33
M v[164:167], a[116:119], v[100:103], v[164:167]
v_cvt_pk_bf16_f32 v32, v32, v33
M v[168:171], a[116:119], v[104:107], v[168:171]
v_exp_f32 v34, v34
M v[168:171], a[120:123], v[136:139], v[168:171]
s_add_u32 s25, s25, 32768
s_cmp_eq_u32 s25, s27
M v[172:175], a[120:123], v[140:143], v[172:175]
v_exp_f32 v35, v35
M v[172:175], a[116:119], v[108:111], v[172:175]
v_cvt_pk_bf16_f32 v33, v34, v35
s_waitcnt lgkmcnt(6)
M a[96:99], a[112:115], v[96:99], a[96:99]
s_cselect_b32 s25, s28, s25
s_cselect_b32 s27, -1, s27
M a[96:99], a[112:115], v[128:131], a[96:99]
s_add_u32 s26, s26, 32768
s_cmp_eq_u32 s26, s62
M v[176:179], a[124:127], v[96:99], v[176:179]
v_exp_f32 v48, v48
M v[176:179], a[128:131], v[128:131], v[176:179]
ds_read_b128 a[156:159], v6 offset:37888
ds_read_b128 a[160:163], v6 offset:46080
M v[180:183], a[128:131], v[132:135], v[180:183]
v_exp_f32 v49, v49
M v[180:183], a[124:127], v[100:103], v[180:183]
v_cvt_pk_bf16_f32 v34, v48, v49
M v[184:187], a[124:127], v[104:107], v[184:187]
v_exp_f32 v50, v50
M v[184:187], a[128:131], v[136:139], v[184:187]
s_cselect_b32 s26, s63, s26
s_cselect_b32 s62, -1, s62
M v[188:191], a[128:131], v[140:143], v[188:191]
v_exp_f32 v51, v51
M v[188:191], a[124:127], v[108:111], v[188:191]
v_cvt_pk_bf16_f32 v35, v50, v51
s_waitcnt lgkmcnt(6)
M a[100:103], a[112:115], v[100:103], a[100:103]
M a[100:103], a[112:115], v[132:135], a[100:103]
M v[192:195], a[132:135], v[96:99], v[192:195]
v_exp_f32 v36, v36
M v[192:195], a[136:139], v[128:131], v[192:195]
ds_read_b128 a[164:167], v6 offset:38912
ds_read_b128 a[168:171], v6 offset:47104
M v[196:199], a[136:139], v[132:135], v[196:199]
v_exp_f32 v37, v37
M v[196:199], a[132:135], v[100:103], v[196:199]
v_cvt_pk_bf16_f32 v36, v36, v37
M v[200:203], a[132:135], v[104:107], v[200:203]
v_exp_f32 v38, v38
M v[200:203], a[136:139], v[136:139], v[200:203]
M v[204:207], a[136:139], v[140:143], v[204:207]
v_exp_f32 v39, v39
M v[204:207], a[132:135], v[108:111], v[204:207]
v_cvt_pk_bf16_f32 v37, v38, v39
s_waitcnt lgkmcnt(6)
M a[104:107], a[112:115], v[104:107], a[104:107]
M a[104:107], a[112:115], v[136:139], a[104:107]
M v[208:211], a[140:143], v[96:99], v[208:211]
v_exp_f32 v52, v52
M v[208:211], a[144:147], v[128:131], v[208:211]
ds_read_b128 a[172:175], v6 offset:39936
ds_read_b128 a[176:179], v6 offset:48128
M v[212:215], a[144:147], v[132:135], v[212:215]
v_exp_f32 v53, v53
M v[212:215], a[140:143], v[100:103], v[212:215]
v_cvt_pk_bf16_f32 v38, v52, v53
M v[216:219], a[140:143], v[104:107], v[216:219]
v_exp_f32 v54, v54
M v[216:219], a[144:147], v[136:139], v[216:219]
M v[220:223], a[144:147], v[140:143], v[220:223]
v_exp_f32 v55, v55
M v[220:223], a[140:143], v[108:111], v[220:223]
v_cvt_pk_bf16_f32 v39, v54, v55
s_waitcnt lgkmcnt(6)
M a[108:111], a[112:115], v[108:111], a[108:111]
M a[108:111], a[112:115], v[140:143], a[108:111]
M v[224:227], a[148:151], v[96:99], v[224:227]
v_exp_f32 v40, v40
M v[224:227], a[152:155], v[128:131], v[224:227]
M v[228:231], a[152:155], v[132:135], v[228:231]
v_exp_f32 v41, v41
M v[228:231], a[148:151], v[100:103], v[228:231]
v_cvt_pk_bf16_f32 v40, v40, v41
M v[232:235], a[148:151], v[104:107], v[232:235]
v_exp_f32 v42, v42
M v[232:235], a[152:155], v[136:139], v[232:235]
M v[236:239], a[152:155], v[140:143], v[236:239]
v_exp_f32 v43, v43
M v[236:239], a[148:151], v[108:111], v[236:239]
v_cvt_pk_bf16_f32 v41, v42, v43
s_waitcnt lgkmcnt(4)
M v[240:243], a[156:159], v[96:99], v[240:243]
v_exp_f32 v56, v56
M v[240:243], a[160:163], v[128:131], v[240:243]
M v[244:247], a[160:163], v[132:135], v[244:247]
v_exp_f32 v57, v57
M v[244:247], a[156:159], v[100:103], v[244:247]
v_cvt_pk_bf16_f32 v42, v56, v57
M v[248:251], a[156:159], v[104:107], v[248:251]
v_exp_f32 v58, v58
M v[248:251], a[160:163], v[136:139], v[248:251]
s_waitcnt vmcnt(0) lgkmcnt(0)
s_barrier
ds_read_b128 a[116:119], v2 offset:0
ds_read_b128 a[120:123], v2 offset:1024
M v[252:255], a[160:163], v[140:143], v[252:255]
v_exp_f32 v59, v59
M v[252:255], a[156:159], v[108:111], v[252:255]
v_cvt_pk_bf16_f32 v43, v58, v59
M a[64:67], a[164:167], v[96:99], a[64:67]
v_exp_f32 v44, v44
M a[64:67], a[168:171], v[128:131], a[64:67]
ds_read_b128 a[124:127], v2 offset:2048
ds_read_b128 a[128:131], v2 offset:3072
M a[68:71], a[168:171], v[132:135], a[68:71]
v_exp_f32 v45, v45
M a[68:71], a[164:167], v[100:103], a[68:71]
v_cvt_pk_bf16_f32 v44, v44, v45
M a[72:75], a[164:167], v[104:107], a[72:75]
v_exp_f32 v46, v46
M a[72:75], a[168:171], v[136:139], a[72:75]
ds_read_b128 a[132:135], v2 offset:4096
ds_read_b128 a[136:139], v2 offset:5120
M a[76:79], a[168:171], v[140:143], a[76:79]
v_exp_f32 v47, v47
M a[76:79], a[164:167], v[108:111], a[76:79]
v_cvt_pk_bf16_f32 v45, v46, v47
M a[80:83], a[172:175], v[96:99], a[80:83]
v_exp_f32 v60, v60
M a[80:83], a[176:179], v[128:131], a[80:83]
ds_read_b128 a[140:143], v2 offset:6144
ds_read_b128 a[144:147], v2 offset:7168
M a[84:87], a[176:179], v[132:135], a[84:87]
v_exp_f32 v61, v61
M a[84:87], a[172:175], v[100:103], a[84:87]
v_cvt_pk_bf16_f32 v46, v60, v61
M a[88:91], a[172:175], v[104:107], a[88:91]
v_exp_f32 v62, v62
M a[88:91], a[176:179], v[136:139], a[88:91]
M a[92:95], a[176:179], v[140:143], a[92:95]
v_exp_f32 v63, v63
M a[92:95], a[172:175], v[108:111], a[92:95]
v_cvt_pk_bf16_f32 v47, v62, v63
s_branch Lk2_l1
Lk2_m1:
s_cmp_eq_u32 s23, 1
s_cbranch_scc1 Lk2_m1b
s_add_u32 m0, s29, 0
s_waitcnt lgkmcnt(4)
M v[32:35], a[116:119], a[0:3], v[16:19]
v_exp_f32 v128, v128
M v[32:35], a[120:123], a[4:7], v[32:35]
ds_read_b128 a[148:151], v3 offset:8192
ds_read_b128 a[152:155], v3 offset:9216
M v[32:35], a[124:127], a[8:11], v[32:35]
v_exp_f32 v129, v129
M v[32:35], a[128:131], a[12:15], v[32:35]
buffer_load_dwordx4 v1, s[12:15], s25 offen offset:0 sc1 lds
s_add_u32 s32, s25, 4096
M v[36:39], a[128:131], a[28:31], 0
v_exp_f32 v130, v130
M v[36:39], a[124:127], a[24:27], v[36:39]
v_cvt_pk_bf16_f32 v128, v128, v129
M v[36:39], a[120:123], a[20:23], v[36:39]
v_exp_f32 v131, v131
M v[36:39], a[116:119], a[16:19], v[36:39]
buffer_load_dwordx4 v1, s[12:15], s25 offen offset:1024 sc1 lds
M v[40:43], a[116:119], a[32:35], 0
v_exp_f32 v144, v144
M v[40:43], a[120:123], a[36:39], v[40:43]
ds_read_b128 a[156:159], v3 offset:10240
ds_read_b128 a[160:163], v3 offset:11264
M v[40:43], a[124:127], a[40:43], v[40:43]
v_exp_f32 v145, v145
M v[40:43], a[128:131], a[44:47], v[40:43]
buffer_load_dwordx4 v1, s[12:15], s25 offen offset:2048 sc1 lds
M v[44:47], a[128:131], a[60:63], 0
v_exp_f32 v146, v146
M v[44:47], a[124:127], a[56:59], v[44:47]
v_cvt_pk_bf16_f32 v129, v130, v131
v_cvt_pk_bf16_f32 v130, v144, v145
M v[44:47], a[120:123], a[52:55], v[44:47]
v_exp_f32 v147, v147
M v[44:47], a[116:119], a[48:51], v[44:47]
buffer_load_dwordx4 v1, s[12:15], s25 offen offset:3072 sc1 lds
s_add_u32 m0, s29, 4096
s_waitcnt lgkmcnt(4)
v_exp_f32 v132, v132
ds_read_b128 a[164:167], v3 offset:12288
ds_read_b128 a[168:171], v3 offset:13312
v_exp_f32 v133, v133
buffer_load_dwordx4 v1, s[12:15], s32 offen offset:0 sc1 lds
M v[52:55], a[144:147], a[28:31], v[16:19]
v_exp_f32 v134, v134
M v[52:55], a[140:143], a[24:27], v[52:55]
v_cvt_pk_bf16_f32 v131, v146, v147
v_cvt_pk_bf16_f32 v132, v132, v133
M v[52:55], a[136:139], a[20:23], v[52:55]
v_exp_f32 v135, v135
M v[52:55], a[132:135], a[16:19], v[52:55]
buffer_load_dwordx4 v1, s[12:15], s32 offen offset:1024 sc1 lds
M v[56:59], a[132:135], a[32:35], 0
v_exp_f32 v148, v148
M v[56:59], a[136:139], a[36:39], v[56:59]
ds_read_b128 a[172:175], v3 offset:14336
ds_read_b128 a[176:179], v3 offset:15360
M v[56:59], a[140:143], a[40:43], v[56:59]
v_exp_f32 v149, v149
M v[56:59], a[144:147], a[44:47], v[56:59]
buffer_load_dwordx4 v1, s[12:15], s32 offen offset:2048 sc1 lds
M v[60:63], a[144:147], a[60:63], 0
v_exp_f32 v150, v150
M v[60:63], a[140:143], a[56:59], v[60:63]
v_cvt_pk_bf16_f32 v133, v134, v135
v_cvt_pk_bf16_f32 v134, v148, v149
M v[60:63], a[136:139], a[52:55], v[60:63]
v_exp_f32 v151, v151
M v[60:63], a[132:135], a[48:51], v[60:63]
buffer_load_dwordx4 v1, s[12:15], s32 offen offset:3072 sc1 lds
s_add_u32 m0, s29, 32768
s_waitcnt lgkmcnt(4)
v_exp_f32 v136, v136
ds_read_b128 a[116:119], v6 offset:32768
ds_read_b128 a[120:123], v6 offset:40960
v_exp_f32 v137, v137
buffer_load_dwordx4 v1, s[12:15], s26 offen offset:0 sc1 lds
s_add_u32 s43, s26, 4096
v_exp_f32 v138, v138
v_cvt_pk_bf16_f32 v135, v150, v151
v_cvt_pk_bf16_f32 v136, v136, v137
v_exp_f32 v139, v139
buffer_load_dwordx4 v1, s[12:15], s26 offen offset:1024 sc1 lds
M v[72:75], a[148:151], a[32:35], v[16:19]
v_exp_f32 v152, v152
M v[72:75], a[152:155], a[36:39], v[72:75]
ds_read_b128 a[124:127], v6 offset:33792
ds_read_b128 a[128:131], v6 offset:41984
M v[72:75], a[156:159], a[40:43], v[72:75]
v_exp_f32 v153, v153
M v[72:75], a[160:163], a[44:47], v[72:75]
buffer_load_dwordx4 v1, s[12:15], s26 offen offset:2048 sc1 lds
M v[76:79], a[160:163], a[60:63], 0
v_exp_f32 v154, v154
M v[76:79], a[156:159], a[56:59], v[76:79]
v_cvt_pk_bf16_f32 v137, v138, v139
v_cvt_pk_bf16_f32 v138, v152, v153
M v[76:79], a[152:155], a[52:55], v[76:79]
v_exp_f32 v155, v155
M v[76:79], a[148:151], a[48:51], v[76:79]
buffer_load_dwordx4 v1, s[12:15], s26 offen offset:3072 sc1 lds
s_add_u32 m0, s29, 36864
s_waitcnt lgkmcnt(4)
v_exp_f32 v140, v140
ds_read_b128 a[132:135], v6 offset:34816
ds_read_b128 a[136:139], v6 offset:43008
v_exp_f32 v141, v141
buffer_load_dwordx4 v1, s[12:15], s43 offen offset:0 sc1 lds
v_exp_f32 v142, v142
v_cvt_pk_bf16_f32 v139, v154, v155
v_cvt_pk_bf16_f32 v140, v140, v141
v_exp_f32 v143, v143
buffer_load_dwordx4 v1, s[12:15], s43 offen offset:1024 sc1 lds
v_exp_f32 v156, v156
ds_read_b128 a[140:143], v6 offset:35840
ds_read_b128 a[144:147], v6 offset:44032
v_exp_f32 v157, v157
buffer_load_dwordx4 v1, s[12:15], s43 offen offset:2048 sc1 lds
M v[92:95], a[176:179], a[60:63], v[16:19]
v_exp_f32 v158, v158
M v[92:95], a[172:175], a[56:59], v[92:95]
v_cvt_pk_bf16_f32 v141, v142, v143
v_cvt_pk_bf16_f32 v142, v156, v157
M v[92:95], a[168:171], a[52:55], v[92:95]
v_exp_f32 v159, v159
M v[92:95], a[164:167], a[48:51], v[92:95]
buffer_load_dwordx4 v1, s[12:15], s43 offen offset:3072 sc1 lds
v_cvt_pk_bf16_f32 v143, v158, v159
s_waitcnt lgkmcnt(6)
M v[160:163], a[116:119], v[96:99], v[160:163]
v_exp_f32 v32, v32
M v[160:163], a[120:123], v[128:131], v[160:163]
ds_read_b128 a[148:151], v6 offset:36864
ds_read_b128 a[152:155], v6 offset:45056
M v[164:167], a[120:123], v[132:135], v[164:167]
v_exp_f32 v33, v33
M v[164:167], a[116:119], v[100:103], v[164:167]
v_cvt_pk_bf16_f32 v32, v32, v33
M v[168:171], a[116:119], v[104:107], v[168:171]
v_exp_f32 v34, v34
M v[168:171], a[120:123], v[136:139], v[168:171]
s_add_u32 s25, s25, 32768
s_cmp_eq_u32 s25, s27
M v[172:175], a[120:123], v[140:143], v[172:175]
v_exp_f32 v35, v35
M v[172:175], a[116:119], v[108:111], v[172:175]
v_cvt_pk_bf16_f32 v33, v34, v35
s_waitcnt lgkmcnt(6)
M a[96:99], a[112:115], v[96:99], a[96:99]
s_cselect_b32 s25, s28, s25
s_cselect_b32 s27, -1, s27
M a[96:99], a[112:115], v[128:131], a[96:99]
s_add_u32 s26, s26, 32768
s_cmp_eq_u32 s26, s62
M v[176:179], a[124:127], v[96:99], v[176:179]
M v[176:179], a[128:131], v[128:131], v[176:179]
ds_read_b128 a[156:159], v6 offset:37888
ds_read_b128 a[160:163], v6 offset:46080
M v[180:183], a[128:131], v[132:135], v[180:183]
M v[180:183], a[124:127], v[100:103], v[180:183]
v_mov_b32 v34, 0
M v[184:187], a[124:127], v[104:107], v[184:187]
M v[184:187], a[128:131], v[136:139], v[184:187]
s_cselect_b32 s26, s63, s26
s_cselect_b32 s62, -1, s62
M v[188:191], a[128:131], v[140:143], v[188:191]
M v[188:191], a[124:127], v[108:111], v[188:191]
v_mov_b32 v35, 0
s_waitcnt lgkmcnt(6)
M a[100:103], a[112:115], v[100:103], a[100:103]
M a[100:103], a[112:115], v[132:135], a[100:103]
M v[192:195], a[132:135], v[96:99], v[192:195]
v_exp_f32 v36, v36
M v[192:195], a[136:139], v[128:131], v[192:195]
ds_read_b128 a[164:167], v6 offset:38912
ds_read_b128 a[168:171], v6 offset:47104
M v[196:199], a[136:139], v[132:135], v[196:199]
v_exp_f32 v37, v37
M v[196:199], a[132:135], v[100:103], v[196:199]
v_cvt_pk_bf16_f32 v36, v36, v37
M v[200:203], a[132:135], v[104:107], v[200:203]
v_exp_f32 v38, v38
M v[200:203], a[136:139], v[136:139], v[200:203]
M v[204:207], a[136:139], v[140:143], v[204:207]
v_exp_f32 v39, v39
M v[204:207], a[132:135], v[108:111], v[204:207]
v_cvt_pk_bf16_f32 v37, v38, v39
s_waitcnt lgkmcnt(6)
M a[104:107], a[112:115], v[104:107], a[104:107]
M a[104:107], a[112:115], v[136:139], a[104:107]
M v[208:211], a[140:143], v[96:99], v[208:211]
v_exp_f32 v52, v52
M v[208:211], a[144:147], v[128:131], v[208:211]
ds_read_b128 a[172:175], v6 offset:39936
ds_read_b128 a[176:179], v6 offset:48128
M v[212:215], a[144:147], v[132:135], v[212:215]
v_exp_f32 v53, v53
M v[212:215], a[140:143], v[100:103], v[212:215]
v_cvt_pk_bf16_f32 v38, v52, v53
M v[216:219], a[140:143], v[104:107], v[216:219]
v_exp_f32 v54, v54
M v[216:219], a[144:147], v[136:139], v[216:219]
M v[220:223], a[144:147], v[140:143], v[220:223]
v_exp_f32 v55, v55
M v[220:223], a[140:143], v[108:111], v[220:223]
v_cvt_pk_bf16_f32 v39, v54, v55
s_waitcnt lgkmcnt(6)
M a[108:111], a[112:115], v[108:111], a[108:111]
M a[108:111], a[112:115], v[140:143], a[108:111]
M v[224:227], a[148:151], v[96:99], v[224:227]
v_exp_f32 v40, v40
M v[224:227], a[152:155], v[128:131], v[224:227]
M v[228:231], a[152:155], v[132:135], v[228:231]
v_exp_f32 v41, v41
M v[228:231], a[148:151], v[100:103], v[228:231]
v_cvt_pk_bf16_f32 v40, v40, v41
M v[232:235], a[148:151], v[104:107], v[232:235]
v_exp_f32 v42, v42
M v[232:235], a[152:155], v[136:139], v[232:235]
M v[236:239], a[152:155], v[140:143], v[236:239]
v_exp_f32 v43, v43
M v[236:239], a[148:151], v[108:111], v[236:239]
v_cvt_pk_bf16_f32 v41, v42, v43
s_waitcnt lgkmcnt(4)
M v[240:243], a[156:159], v[96:99], v[240:243]
v_exp_f32 v56, v56
M v[240:243], a[160:163], v[128:131], v[240:243]
M v[244:247], a[160:163], v[132:135], v[244:247]
v_exp_f32 v57, v57
M v[244:247], a[156:159], v[100:103], v[244:247]
v_cvt_pk_bf16_f32 v42, v56, v57
M v[248:251], a[156:159], v[104:107], v[248:251]
v_exp_f32 v58, v58
M v[248:251], a[160:163], v[136:139], v[248:251]
s_waitcnt vmcnt(0) lgkmcnt(0)
s_barrier
ds_read_b128 a[116:119], v2 offset:0
ds_read_b128 a[120:123], v2 offset:1024
M v[252:255], a[160:163], v[140:143], v[252:255]
v_exp_f32 v59, v59
M v[252:255], a[156:159], v[108:111], v[252:255]
v_cvt_pk_bf16_f32 v43, v58, v59
M a[64:67], a[164:167], v[96:99], a[64:67]
v_exp_f32 v44, v44
M a[64:67], a[168:171], v[128:131], a[64:67]
ds_read_b128 a[124:127], v2 offset:2048
ds_read_b128 a[128:131], v2 offset:3072
M a[68:71], a[168:171], v[132:135], a[68:71]
v_exp_f32 v45, v45
M a[68:71], a[164:167], v[100:103], a[68:71]
v_cvt_pk_bf16_f32 v44, v44, v45
M a[72:75], a[164:167], v[104:107], a[72:75]
v_exp_f32 v46, v46
M a[72:75], a[168:171], v[136:139], a[72:75]
ds_read_b128 a[132:135], v2 offset:4096
ds_read_b128 a[136:139], v2 offset:5120
M a[76:79], a[168:171], v[140:143], a[76:79]
v_exp_f32 v47, v47
M a[76:79], a[164:167], v[108:111], a[76:79]
v_cvt_pk_bf16_f32 v45, v46, v47
M a[80:83], a[172:175], v[96:99], a[80:83]
v_exp_f32 v60, v60
M a[80:83], a[176:179], v[128:131], a[80:83]
ds_read_b128 a[140:143], v2 offset:6144
ds_read_b128 a[144:147], v2 offset:7168
M a[84:87], a[176:179], v[132:135], a[84:87]
v_exp_f32 v61, v61
M a[84:87], a[172:175], v[100:103], a[84:87]
v_cvt_pk_bf16_f32 v46, v60, v61
M a[88:91], a[172:175], v[104:107], a[88:91]
v_exp_f32 v62, v62
M a[88:91], a[176:179], v[136:139], a[88:91]
M a[92:95], a[176:179], v[140:143], a[92:95]
v_exp_f32 v63, v63
M a[92:95], a[172:175], v[108:111], a[92:95]
v_cvt_pk_bf16_f32 v47, v62, v63
Lk2_m2a:
s_sub_u32 s35, 15, s21
s_lshl_b32 s33, s20, 7
s_lshl_b32 s34, s35, 3
s_add_u32 s33, s33, s34
s_lshl_b32 s34, s23, 2
s_add_u32 s33, s33, s34
s_lshl_b32 s33, s33, 12
buffer_load_dwordx4 a[180:183], v1, s[8:11], s33 offen offset:0 sc1
buffer_load_dwordx4 a[184:187], v1, s[8:11], s33 offen offset:1024 sc1
buffer_load_dwordx4 a[188:191], v1, s[8:11], s33 offen offset:2048 sc1
buffer_load_dwordx4 a[192:195], v1, s[8:11], s33 offen offset:3072 sc1
s_add_u32 s33, s33, 4096
buffer_load_dwordx4 a[196:199], v1, s[8:11], s33 offen offset:0 sc1
buffer_load_dwordx4 a[200:203], v1, s[8:11], s33 offen offset:1024 sc1
buffer_load_dwordx4 a[204:207], v1, s[8:11], s33 offen offset:2048 sc1
buffer_load_dwordx4 a[208:211], v1, s[8:11], s33 offen offset:3072 sc1
s_add_u32 s33, s33, 4096
buffer_load_dwordx4 a[212:215], v1, s[8:11], s33 offen offset:0 sc1
buffer_load_dwordx4 a[216:219], v1, s[8:11], s33 offen offset:1024 sc1
buffer_load_dwordx4 a[220:223], v1, s[8:11], s33 offen offset:2048 sc1
buffer_load_dwordx4 a[224:227], v1, s[8:11], s33 offen offset:3072 sc1
s_add_u32 s33, s33, 4096
buffer_load_dwordx4 a[228:231], v1, s[8:11], s33 offen offset:0 sc1
buffer_load_dwordx4 a[232:235], v1, s[8:11], s33 offen offset:1024 sc1
buffer_load_dwordx4 a[236:239], v1, s[8:11], s33 offen offset:2048 sc1
buffer_load_dwordx4 a[240:243], v1, s[8:11], s33 offen offset:3072 sc1
s_add_u32 m0, s29, 65536
s_nop 0
buffer_load_dwordx4 v1, s[12:15], s25 offen offset:0 sc1 lds
s_add_u32 s32, s25, 4096
buffer_load_dwordx4 v1, s[12:15], s25 offen offset:1024 sc1 lds
buffer_load_dwordx4 v1, s[12:15], s25 offen offset:2048 sc1 lds
buffer_load_dwordx4 v1, s[12:15], s25 offen offset:3072 sc1 lds
s_add_u32 m0, s29, 69632
s_nop 0
buffer_load_dwordx4 v1, s[12:15], s32 offen offset:0 sc1 lds
buffer_load_dwordx4 v1, s[12:15], s32 offen offset:1024 sc1 lds
buffer_load_dwordx4 v1, s[12:15], s32 offen offset:2048 sc1 lds
buffer_load_dwordx4 v1, s[12:15], s32 offen offset:3072 sc1 lds
s_add_u32 m0, s29, 98304
v_exp_f32 v72, v72
s_waitcnt lgkmcnt(7)
ds_read_b128 a[116:119], v5 offset:32768
s_waitcnt lgkmcnt(7)
ds_read_b128 a[120:123], v5 offset:40960
v_exp_f32 v73, v73
buffer_load_dwordx4 v1, s[12:15], s26 offen offset:0 sc1 lds
s_add_u32 s43, s26, 4096
v_exp_f32 v74, v74
v_cvt_pk_bf16_f32 v72, v72, v73
v_exp_f32 v75, v75
buffer_load_dwordx4 v1, s[12:15], s26 offen offset:1024 sc1 lds
s_waitcnt lgkmcnt(7)
ds_read_b128 a[124:127], v5 offset:33792
s_waitcnt lgkmcnt(7)
ds_read_b128 a[128:131], v5 offset:41984
buffer_load_dwordx4 v1, s[12:15], s26 offen offset:2048 sc1 lds
v_cvt_pk_bf16_f32 v73, v74, v75
v_mov_b32 v74, 0
buffer_load_dwordx4 v1, s[12:15], s26 offen offset:3072 sc1 lds
s_add_u32 m0, s29, 102400
v_exp_f32 v76, v76
s_waitcnt lgkmcnt(7)
ds_read_b128 a[132:135], v5 offset:34816
s_waitcnt lgkmcnt(7)
ds_read_b128 a[136:139], v5 offset:43008
v_exp_f32 v77, v77
buffer_load_dwordx4 v1, s[12:15], s43 offen offset:0 sc1 lds
v_exp_f32 v78, v78
v_mov_b32 v75, 0
v_cvt_pk_bf16_f32 v76, v76, v77
v_exp_f32 v79, v79
buffer_load_dwordx4 v1, s[12:15], s43 offen offset:1024 sc1 lds
v_exp_f32 v92, v92
s_waitcnt lgkmcnt(7)
ds_read_b128 a[140:143], v5 offset:35840
s_waitcnt lgkmcnt(7)
ds_read_b128 a[144:147], v5 offset:44032
v_exp_f32 v93, v93
buffer_load_dwordx4 v1, s[12:15], s43 offen offset:2048 sc1 lds
v_exp_f32 v94, v94
v_cvt_pk_bf16_f32 v77, v78, v79
v_cvt_pk_bf16_f32 v78, v92, v93
v_exp_f32 v95, v95
buffer_load_dwordx4 v1, s[12:15], s43 offen offset:3072 sc1 lds
v_cvt_pk_bf16_f32 v79, v94, v95
s_waitcnt lgkmcnt(6)
M v[160:163], a[116:119], v[32:35], v[160:163]
ds_read_b128 a[148:151], v5 offset:36864
ds_read_b128 a[152:155], v5 offset:45056
M v[164:167], a[116:119], v[36:39], v[164:167]
M v[168:171], a[116:119], v[40:43], v[168:171]
M v[168:171], a[120:123], v[72:75], v[168:171]
s_add_u32 s25, s25, 32768
s_cmp_eq_u32 s25, s27
M v[172:175], a[120:123], v[76:79], v[172:175]
M v[172:175], a[116:119], v[44:47], v[172:175]
s_waitcnt lgkmcnt(6)
M a[96:99], a[112:115], v[32:35], a[96:99]
s_cselect_b32 s25, s28, s25
s_cselect_b32 s27, -1, s27
s_add_u32 s26, s26, 32768
s_cmp_eq_u32 s26, s62
M v[176:179], a[124:127], v[32:35], v[176:179]
ds_read_b128 a[156:159], v5 offset:37888
ds_read_b128 a[160:163], v5 offset:46080
M v[180:183], a[124:127], v[36:39], v[180:183]
M v[184:187], a[124:127], v[40:43], v[184:187]
M v[184:187], a[128:131], v[72:75], v[184:187]
s_cselect_b32 s26, s63, s26
s_cselect_b32 s62, -1, s62
M v[188:191], a[128:131], v[76:79], v[188:191]
M v[188:191], a[124:127], v[44:47], v[188:191]
s_waitcnt lgkmcnt(6)
M a[100:103], a[112:115], v[36:39], a[100:103]
M v[192:195], a[132:135], v[32:35], v[192:195]
ds_read_b128 a[164:167], v5 offset:38912
ds_read_b128 a[168:171], v5 offset:47104
M v[196:199], a[132:135], v[36:39], v[196:199]
M v[200:203], a[132:135], v[40:43], v[200:203]
M v[200:203], a[136:139], v[72:75], v[200:203]
M v[204:207], a[136:139], v[76:79], v[204:207]
M v[204:207], a[132:135], v[44:47], v[204:207]
s_waitcnt lgkmcnt(6)
M a[104:107], a[112:115], v[40:43], a[104:107]
M a[104:107], a[112:115], v[72:75], a[104:107]
M v[208:211], a[140:143], v[32:35], v[208:211]
ds_read_b128 a[172:175], v5 offset:39936
ds_read_b128 a[176:179], v5 offset:48128
M v[212:215], a[140:143], v[36:39], v[212:215]
M v[216:219], a[140:143], v[40:43], v[216:219]
M v[216:219], a[144:147], v[72:75], v[216:219]
M v[220:223], a[144:147], v[76:79], v[220:223]
M v[220:223], a[140:143], v[44:47], v[220:223]
s_waitcnt lgkmcnt(6)
M a[108:111], a[112:115], v[44:47], a[108:111]
M a[108:111], a[112:115], v[76:79], a[108:111]
M v[224:227], a[148:151], v[32:35], v[224:227]
M v[228:231], a[148:151], v[36:39], v[228:231]
M v[232:235], a[148:151], v[40:43], v[232:235]
M v[232:235], a[152:155], v[72:75], v[232:235]
M v[236:239], a[152:155], v[76:79], v[236:239]
M v[236:239], a[148:151], v[44:47], v[236:239]
s_waitcnt lgkmcnt(4)
M v[240:243], a[156:159], v[32:35], v[240:243]
M v[244:247], a[156:159], v[36:39], v[244:247]
M v[248:251], a[156:159], v[40:43], v[248:251]
M v[248:251], a[160:163], v[72:75], v[248:251]
s_waitcnt vmcnt(0) lgkmcnt(0)
s_barrier
ds_read_b128 a[116:119], v3 offset:0
ds_read_b128 a[120:123], v3 offset:1024
M v[252:255], a[160:163], v[76:79], v[252:255]
M v[252:255], a[156:159], v[44:47], v[252:255]
M a[64:67], a[164:167], v[32:35], a[64:67]
ds_read_b128 a[124:127], v3 offset:2048
ds_read_b128 a[128:131], v3 offset:3072
M a[68:71], a[164:167], v[36:39], a[68:71]
M a[72:75], a[164:167], v[40:43], a[72:75]
M a[72:75], a[168:171], v[72:75], a[72:75]
ds_read_b128 a[132:135], v3 offset:4096
ds_read_b128 a[136:139], v3 offset:5120
M a[76:79], a[168:171], v[76:79], a[76:79]
M a[76:79], a[164:167], v[44:47], a[76:79]
M a[80:83], a[172:175], v[32:35], a[80:83]
ds_read_b128 a[140:143], v3 offset:6144
ds_read_b128 a[144:147], v3 offset:7168
M a[84:87], a[172:175], v[36:39], a[84:87]
M a[88:91], a[172:175], v[40:43], a[88:91]
M a[88:91], a[176:179], v[72:75], a[88:91]
M a[92:95], a[176:179], v[76:79], a[92:95]
M a[92:95], a[172:175], v[44:47], a[92:95]
s_waitcnt vmcnt(16)
s_add_u32 m0, s29, 0
s_waitcnt lgkmcnt(4)
M v[32:35], a[116:119], a[180:183], 0
M v[32:35], a[120:123], a[184:187], v[32:35]
ds_read_b128 a[148:151], v3 offset:8192
ds_read_b128 a[152:155], v3 offset:9216
M v[32:35], a[124:127], a[188:191], v[32:35]
M v[32:35], a[128:131], a[192:195], v[32:35]
buffer_load_dwordx4 v1, s[12:15], s25 offen offset:0 sc1 lds
s_add_u32 s32, s25, 4096
M v[36:39], a[128:131], a[208:211], 0
M v[36:39], a[124:127], a[204:207], v[36:39]
M v[36:39], a[120:123], a[200:203], v[36:39]
M v[36:39], a[116:119], a[196:199], v[36:39]
buffer_load_dwordx4 v1, s[12:15], s25 offen offset:1024 sc1 lds
M v[40:43], a[116:119], a[212:215], 0
M v[40:43], a[120:123], a[216:219], v[40:43]
ds_read_b128 a[156:159], v3 offset:10240
ds_read_b128 a[160:163], v3 offset:11264
M v[40:43], a[124:127], a[220:223], v[40:43]
M v[40:43], a[128:131], a[224:227], v[40:43]
buffer_load_dwordx4 v1, s[12:15], s25 offen offset:2048 sc1 lds
M v[44:47], a[128:131], a[240:243], 0
M v[44:47], a[124:127], a[236:239], v[44:47]
M v[44:47], a[120:123], a[232:235], v[44:47]
M v[44:47], a[116:119], a[228:231], v[44:47]
buffer_load_dwordx4 v1, s[12:15], s25 offen offset:3072 sc1 lds
s_add_u32 m0, s29, 4096
s_waitcnt lgkmcnt(4)
M v[48:51], a[132:135], a[180:183], 0
M v[48:51], a[136:139], a[184:187], v[48:51]
ds_read_b128 a[164:167], v3 offset:12288
ds_read_b128 a[168:171], v3 offset:13312
M v[48:51], a[140:143], a[188:191], v[48:51]
M v[48:51], a[144:147], a[192:195], v[48:51]
buffer_load_dwordx4 v1, s[12:15], s32 offen offset:0 sc1 lds
M v[52:55], a[144:147], a[208:211], 0
M v[52:55], a[140:143], a[204:207], v[52:55]
M v[52:55], a[136:139], a[200:203], v[52:55]
M v[52:55], a[132:135], a[196:199], v[52:55]
buffer_load_dwordx4 v1, s[12:15], s32 offen offset:1024 sc1 lds
M v[56:59], a[132:135], a[212:215], 0
M v[56:59], a[136:139], a[216:219], v[56:59]
ds_read_b128 a[172:175], v3 offset:14336
ds_read_b128 a[176:179], v3 offset:15360
M v[56:59], a[140:143], a[220:223], v[56:59]
M v[56:59], a[144:147], a[224:227], v[56:59]
buffer_load_dwordx4 v1, s[12:15], s32 offen offset:2048 sc1 lds
M v[60:63], a[144:147], a[240:243], 0
M v[60:63], a[140:143], a[236:239], v[60:63]
M v[60:63], a[136:139], a[232:235], v[60:63]
M v[60:63], a[132:135], a[228:231], v[60:63]
buffer_load_dwordx4 v1, s[12:15], s32 offen offset:3072 sc1 lds
s_add_u32 m0, s29, 32768
s_waitcnt lgkmcnt(4)
M v[64:67], a[148:151], a[180:183], 0
M v[64:67], a[152:155], a[184:187], v[64:67]
M v[64:67], a[156:159], a[188:191], v[64:67]
M v[64:67], a[160:163], a[192:195], v[64:67]
buffer_load_dwordx4 v1, s[12:15], s26 offen offset:0 sc1 lds
s_add_u32 s43, s26, 4096
M v[68:71], a[160:163], a[208:211], 0
M v[68:71], a[156:159], a[204:207], v[68:71]
M v[68:71], a[152:155], a[200:203], v[68:71]
M v[68:71], a[148:151], a[196:199], v[68:71]
buffer_load_dwordx4 v1, s[12:15], s26 offen offset:1024 sc1 lds
M v[72:75], a[148:151], a[212:215], 0
M v[72:75], a[152:155], a[216:219], v[72:75]
M v[72:75], a[156:159], a[220:223], v[72:75]
M v[72:75], a[160:163], a[224:227], v[72:75]
buffer_load_dwordx4 v1, s[12:15], s26 offen offset:2048 sc1 lds
M v[76:79], a[160:163], a[240:243], 0
M v[76:79], a[156:159], a[236:239], v[76:79]
M v[76:79], a[152:155], a[232:235], v[76:79]
M v[76:79], a[148:151], a[228:231], v[76:79]
buffer_load_dwordx4 v1, s[12:15], s26 offen offset:3072 sc1 lds
s_add_u32 m0, s29, 36864
s_waitcnt lgkmcnt(0)
M v[80:83], a[164:167], a[180:183], 0
M v[80:83], a[168:171], a[184:187], v[80:83]
M v[80:83], a[172:175], a[188:191], v[80:83]
M v[80:83], a[176:179], a[192:195], v[80:83]
buffer_load_dwordx4 v1, s[12:15], s43 offen offset:0 sc1 lds
M v[84:87], a[176:179], a[208:211], 0
M v[84:87], a[172:175], a[204:207], v[84:87]
M v[84:87], a[168:171], a[200:203], v[84:87]
M v[84:87], a[164:167], a[196:199], v[84:87]
buffer_load_dwordx4 v1, s[12:15], s43 offen offset:1024 sc1 lds
M v[88:91], a[164:167], a[212:215], 0
M v[88:91], a[168:171], a[216:219], v[88:91]
M v[88:91], a[172:175], a[220:223], v[88:91]
M v[88:91], a[176:179], a[224:227], v[88:91]
buffer_load_dwordx4 v1, s[12:15], s43 offen offset:2048 sc1 lds
M v[92:95], a[176:179], a[240:243], 0
M v[92:95], a[172:175], a[236:239], v[92:95]
M v[92:95], a[168:171], a[232:235], v[92:95]
M v[92:95], a[164:167], a[228:231], v[92:95]
buffer_load_dwordx4 v1, s[12:15], s43 offen offset:3072 sc1 lds
v_exp_f32 v32, v32
v_exp_f32 v33, v33
s_nop 0
v_cvt_pk_bf16_f32 v32, v32, v33
v_exp_f32 v34, v34
s_add_u32 s25, s25, 32768
s_cmp_eq_u32 s25, s27
v_exp_f32 v35, v35
s_nop 0
v_cvt_pk_bf16_f32 v33, v34, v35
s_cselect_b32 s25, s28, s25
s_cselect_b32 s27, -1, s27
s_add_u32 s26, s26, 32768
s_cmp_eq_u32 s26, s62
v_exp_f32 v48, v48
v_exp_f32 v49, v49
s_nop 0
v_cvt_pk_bf16_f32 v34, v48, v49
v_exp_f32 v50, v50
s_cselect_b32 s26, s63, s26
s_cselect_b32 s62, -1, s62
v_exp_f32 v51, v51
s_nop 0
v_cvt_pk_bf16_f32 v35, v50, v51
v_exp_f32 v36, v36
v_exp_f32 v37, v37
s_nop 0
v_cvt_pk_bf16_f32 v36, v36, v37
v_exp_f32 v38, v38
v_exp_f32 v39, v39
s_nop 0
v_cvt_pk_bf16_f32 v37, v38, v39
v_exp_f32 v52, v52
v_exp_f32 v53, v53
s_nop 0
v_cvt_pk_bf16_f32 v38, v52, v53
v_exp_f32 v54, v54
v_exp_f32 v55, v55
s_nop 0
v_cvt_pk_bf16_f32 v39, v54, v55
v_exp_f32 v40, v40
v_exp_f32 v41, v41
s_nop 0
v_cvt_pk_bf16_f32 v40, v40, v41
v_exp_f32 v42, v42
v_exp_f32 v43, v43
s_nop 0
v_cvt_pk_bf16_f32 v41, v42, v43
v_exp_f32 v56, v56
v_exp_f32 v57, v57
s_nop 0
v_cvt_pk_bf16_f32 v42, v56, v57
v_exp_f32 v58, v58
s_waitcnt vmcnt(0) lgkmcnt(0)
s_barrier
ds_read_b128 a[116:119], v2 offset:0
ds_read_b128 a[120:123], v2 offset:1024
v_exp_f32 v59, v59
s_nop 0
v_cvt_pk_bf16_f32 v43, v58, v59
v_exp_f32 v44, v44
ds_read_b128 a[124:127], v2 offset:2048
ds_read_b128 a[128:131], v2 offset:3072
v_exp_f32 v45, v45
s_nop 0
v_cvt_pk_bf16_f32 v44, v44, v45
v_exp_f32 v46, v46
ds_read_b128 a[132:135], v2 offset:4096
ds_read_b128 a[136:139], v2 offset:5120
v_exp_f32 v47, v47
s_nop 0
v_cvt_pk_bf16_f32 v45, v46, v47
v_exp_f32 v60, v60
ds_read_b128 a[140:143], v2 offset:6144
ds_read_b128 a[144:147], v2 offset:7168
v_exp_f32 v61, v61
s_nop 0
v_cvt_pk_bf16_f32 v46, v60, v61
v_exp_f32 v62, v62
v_exp_f32 v63, v63
s_nop 0
v_cvt_pk_bf16_f32 v47, v62, v63
s_branch Lk2_ea
Lk2_m2:
s_cmp_eq_u32 s23, 0
s_cbranch_scc1 Lk2_m2a
s_branch Lk2_m2b
Lk2_m1b:
s_add_u32 m0, s29, 0
s_waitcnt lgkmcnt(4)
M v[32:35], a[116:119], a[0:3], 0
v_exp_f32 v128, v128
M v[32:35], a[120:123], a[4:7], v[32:35]
ds_read_b128 a[148:151], v3 offset:8192
ds_read_b128 a[152:155], v3 offset:9216
M v[32:35], a[124:127], a[8:11], v[32:35]
v_exp_f32 v129, v129
M v[32:35], a[128:131], a[12:15], v[32:35]
buffer_load_dwordx4 v1, s[12:15], s25 offen offset:0 sc1 lds
s_add_u32 s32, s25, 4096
M v[36:39], a[128:131], a[28:31], 0
v_exp_f32 v130, v130
M v[36:39], a[124:127], a[24:27], v[36:39]
v_cvt_pk_bf16_f32 v128, v128, v129
M v[36:39], a[120:123], a[20:23], v[36:39]
v_exp_f32 v131, v131
M v[36:39], a[116:119], a[16:19], v[36:39]
buffer_load_dwordx4 v1, s[12:15], s25 offen offset:1024 sc1 lds
M v[40:43], a[116:119], a[32:35], 0
v_exp_f32 v144, v144
M v[40:43], a[120:123], a[36:39], v[40:43]
ds_read_b128 a[156:159], v3 offset:10240
ds_read_b128 a[160:163], v3 offset:11264
M v[40:43], a[124:127], a[40:43], v[40:43]
v_exp_f32 v145, v145
M v[40:43], a[128:131], a[44:47], v[40:43]
buffer_load_dwordx4 v1, s[12:15], s25 offen offset:2048 sc1 lds
M v[44:47], a[128:131], a[60:63], 0
v_exp_f32 v146, v146
M v[44:47], a[124:127], a[56:59], v[44:47]
v_cvt_pk_bf16_f32 v129, v130, v131
v_cvt_pk_bf16_f32 v130, v144, v145
M v[44:47], a[120:123], a[52:55], v[44:47]
v_exp_f32 v147, v147
M v[44:47], a[116:119], a[48:51], v[44:47]
buffer_load_dwordx4 v1, s[12:15], s25 offen offset:3072 sc1 lds
s_add_u32 m0, s29, 4096
s_waitcnt lgkmcnt(4)
M v[48:51], a[132:135], a[0:3], 0
v_exp_f32 v132, v132
M v[48:51], a[136:139], a[4:7], v[48:51]
ds_read_b128 a[164:167], v3 offset:12288
ds_read_b128 a[168:171], v3 offset:13312
M v[48:51], a[140:143], a[8:11], v[48:51]
v_exp_f32 v133, v133
M v[48:51], a[144:147], a[12:15], v[48:51]
buffer_load_dwordx4 v1, s[12:15], s32 offen offset:0 sc1 lds
M v[52:55], a[144:147], a[28:31], 0
v_exp_f32 v134, v134
M v[52:55], a[140:143], a[24:27], v[52:55]
v_cvt_pk_bf16_f32 v131, v146, v147
v_cvt_pk_bf16_f32 v132, v132, v133
M v[52:55], a[136:139], a[20:23], v[52:55]
v_exp_f32 v135, v135
M v[52:55], a[132:135], a[16:19], v[52:55]
buffer_load_dwordx4 v1, s[12:15], s32 offen offset:1024 sc1 lds
M v[56:59], a[132:135], a[32:35], 0
v_exp_f32 v148, v148
M v[56:59], a[136:139], a[36:39], v[56:59]
ds_read_b128 a[172:175], v3 offset:14336
ds_read_b128 a[176:179], v3 offset:15360
M v[56:59], a[140:143], a[40:43], v[56:59]
v_exp_f32 v149, v149
M v[56:59], a[144:147], a[44:47], v[56:59]
buffer_load_dwordx4 v1, s[12:15], s32 offen offset:2048 sc1 lds
M v[60:63], a[144:147], a[60:63], 0
v_exp_f32 v150, v150
M v[60:63], a[140:143], a[56:59], v[60:63]
v_cvt_pk_bf16_f32 v133, v134, v135
v_cvt_pk_bf16_f32 v134, v148, v149
M v[60:63], a[136:139], a[52:55], v[60:63]
v_exp_f32 v151, v151
M v[60:63], a[132:135], a[48:51], v[60:63]
buffer_load_dwordx4 v1, s[12:15], s32 offen offset:3072 sc1 lds
s_add_u32 m0, s29, 32768
s_waitcnt lgkmcnt(4)
M v[64:67], a[148:151], a[0:3], 0
v_exp_f32 v136, v136
M v[64:67], a[152:155], a[4:7], v[64:67]
ds_read_b128 a[116:119], v6 offset:32768
ds_read_b128 a[120:123], v6 offset:40960
M v[64:67], a[156:159], a[8:11], v[64:67]
v_exp_f32 v137, v137
M v[64:67], a[160:163], a[12:15], v[64:67]
buffer_load_dwordx4 v1, s[12:15], s26 offen offset:0 sc1 lds
s_add_u32 s43, s26, 4096
M v[68:71], a[160:163], a[28:31], 0
v_exp_f32 v138, v138
M v[68:71], a[156:159], a[24:27], v[68:71]
v_cvt_pk_bf16_f32 v135, v150, v151
v_cvt_pk_bf16_f32 v136, v136, v137
M v[68:71], a[152:155], a[20:23], v[68:71]
v_exp_f32 v139, v139
M v[68:71], a[148:151], a[16:19], v[68:71]
buffer_load_dwordx4 v1, s[12:15], s26 offen offset:1024 sc1 lds
M v[72:75], a[148:151], a[32:35], 0
v_exp_f32 v152, v152
M v[72:75], a[152:155], a[36:39], v[72:75]
ds_read_b128 a[124:127], v6 offset:33792
ds_read_b128 a[128:131], v6 offset:41984
M v[72:75], a[156:159], a[40:43], v[72:75]
v_exp_f32 v153, v153
M v[72:75], a[160:163], a[44:47], v[72:75]
buffer_load_dwordx4 v1, s[12:15], s26 offen offset:2048 sc1 lds
M v[76:79], a[160:163], a[60:63], 0
v_exp_f32 v154, v154
M v[76:79], a[156:159], a[56:59], v[76:79]
v_cvt_pk_bf16_f32 v137, v138, v139
v_cvt_pk_bf16_f32 v138, v152, v153
M v[76:79], a[152:155], a[52:55], v[76:79]
v_exp_f32 v155, v155
M v[76:79], a[148:151], a[48:51], v[76:79]
buffer_load_dwordx4 v1, s[12:15], s26 offen offset:3072 sc1 lds
s_add_u32 m0, s29, 36864
s_waitcnt lgkmcnt(4)
M v[80:83], a[164:167], a[0:3], 0
v_exp_f32 v140, v140
M v[80:83], a[168:171], a[4:7], v[80:83]
ds_read_b128 a[132:135], v6 offset:34816
ds_read_b128 a[136:139], v6 offset:43008
M v[80:83], a[172:175], a[8:11], v[80:83]
v_exp_f32 v141, v141
M v[80:83], a[176:179], a[12:15], v[80:83]
buffer_load_dwordx4 v1, s[12:15], s43 offen offset:0 sc1 lds
M v[84:87], a[176:179], a[28:31], 0
v_exp_f32 v142, v142
M v[84:87], a[172:175], a[24:27], v[84:87]
v_cvt_pk_bf16_f32 v139, v154, v155
v_cvt_pk_bf16_f32 v140, v140, v141
M v[84:87], a[168:171], a[20:23], v[84:87]
v_exp_f32 v143, v143
M v[84:87], a[164:167], a[16:19], v[84:87]
buffer_load_dwordx4 v1, s[12:15], s43 offen offset:1024 sc1 lds
M v[88:91], a[164:167], a[32:35], 0
v_exp_f32 v156, v156
M v[88:91], a[168:171], a[36:39], v[88:91]
ds_read_b128 a[140:143], v6 offset:35840
ds_read_b128 a[144:147], v6 offset:44032
M v[88:91], a[172:175], a[40:43], v[88:91]
v_exp_f32 v157, v157
M v[88:91], a[176:179], a[44:47], v[88:91]
buffer_load_dwordx4 v1, s[12:15], s43 offen offset:2048 sc1 lds
M v[92:95], a[176:179], a[60:63], 0
v_exp_f32 v158, v158
M v[92:95], a[172:175], a[56:59], v[92:95]
v_cvt_pk_bf16_f32 v141, v142, v143
v_cvt_pk_bf16_f32 v142, v156, v157
M v[92:95], a[168:171], a[52:55], v[92:95]
v_exp_f32 v159, v159
M v[92:95], a[164:167], a[48:51], v[92:95]
buffer_load_dwordx4 v1, s[12:15], s43 offen offset:3072 sc1 lds
v_cvt_pk_bf16_f32 v143, v158, v159
s_waitcnt lgkmcnt(6)
M v[160:163], a[116:119], v[96:99], v[160:163]
v_exp_f32 v32, v32
M v[160:163], a[120:123], v[128:131], v[160:163]
ds_read_b128 a[148:151], v6 offset:36864
ds_read_b128 a[152:155], v6 offset:45056
M v[164:167], a[120:123], v[132:135], v[164:167]
v_exp_f32 v33, v33
M v[164:167], a[116:119], v[100:103], v[164:167]
v_cvt_pk_bf16_f32 v32, v32, v33
M v[168:171], a[116:119], v[104:107], v[168:171]
v_exp_f32 v34, v34
M v[168:171], a[120:123], v[136:139], v[168:171]
s_add_u32 s25, s25, 32768
s_cmp_eq_u32 s25, s27
M v[172:175], a[120:123], v[140:143], v[172:175]
v_exp_f32 v35, v35
M v[172:175], a[116:119], v[108:111], v[172:175]
v_cvt_pk_bf16_f32 v33, v34, v35
s_waitcnt lgkmcnt(6)
M a[96:99], a[112:115], v[96:99], a[96:99]
s_cselect_b32 s25, s28, s25
s_cselect_b32 s27, -1, s27
M a[96:99], a[112:115], v[128:131], a[96:99]
s_add_u32 s26, s26, 32768
s_cmp_eq_u32 s26, s62
M v[176:179], a[124:127], v[96:99], v[176:179]
v_exp_f32 v48, v48
M v[176:179], a[128:131], v[128:131], v[176:179]
ds_read_b128 a[156:159], v6 offset:37888
ds_read_b128 a[160:163], v6 offset:46080
M v[180:183], a[128:131], v[132:135], v[180:183]
v_exp_f32 v49, v49
M v[180:183], a[124:127], v[100:103], v[180:183]
v_cvt_pk_bf16_f32 v34, v48, v49
M v[184:187], a[124:127], v[104:107], v[184:187]
v_exp_f32 v50, v50
M v[184:187], a[128:131], v[136:139], v[184:187]
s_cselect_b32 s26, s63, s26
s_cselect_b32 s62, -1, s62
M v[188:191], a[128:131], v[140:143], v[188:191]
v_exp_f32 v51, v51
M v[188:191], a[124:127], v[108:111], v[188:191]
v_cvt_pk_bf16_f32 v35, v50, v51
s_waitcnt lgkmcnt(6)
M a[100:103], a[112:115], v[100:103], a[100:103]
M a[100:103], a[112:115], v[132:135], a[100:103]
M v[192:195], a[132:135], v[96:99], v[192:195]
v_exp_f32 v36, v36
M v[192:195], a[136:139], v[128:131], v[192:195]
ds_read_b128 a[164:167], v6 offset:38912
ds_read_b128 a[168:171], v6 offset:47104
M v[196:199], a[136:139], v[132:135], v[196:199]
v_exp_f32 v37, v37
M v[196:199], a[132:135], v[100:103], v[196:199]
v_cvt_pk_bf16_f32 v36, v36, v37
M v[200:203], a[132:135], v[104:107], v[200:203]
v_exp_f32 v38, v38
M v[200:203], a[136:139], v[136:139], v[200:203]
M v[204:207], a[136:139], v[140:143], v[204:207]
v_exp_f32 v39, v39
M v[204:207], a[132:135], v[108:111], v[204:207]
v_cvt_pk_bf16_f32 v37, v38, v39
s_waitcnt lgkmcnt(6)
M a[104:107], a[112:115], v[104:107], a[104:107]
M a[104:107], a[112:115], v[136:139], a[104:107]
M v[208:211], a[140:143], v[96:99], v[208:211]
v_exp_f32 v52, v52
M v[208:211], a[144:147], v[128:131], v[208:211]
ds_read_b128 a[172:175], v6 offset:39936
ds_read_b128 a[176:179], v6 offset:48128
M v[212:215], a[144:147], v[132:135], v[212:215]
v_exp_f32 v53, v53
M v[212:215], a[140:143], v[100:103], v[212:215]
v_cvt_pk_bf16_f32 v38, v52, v53
M v[216:219], a[140:143], v[104:107], v[216:219]
v_exp_f32 v54, v54
M v[216:219], a[144:147], v[136:139], v[216:219]
M v[220:223], a[144:147], v[140:143], v[220:223]
v_exp_f32 v55, v55
M v[220:223], a[140:143], v[108:111], v[220:223]
v_cvt_pk_bf16_f32 v39, v54, v55
s_waitcnt lgkmcnt(6)
M a[108:111], a[112:115], v[108:111], a[108:111]
M a[108:111], a[112:115], v[140:143], a[108:111]
M v[224:227], a[148:151], v[96:99], v[224:227]
v_exp_f32 v40, v40
M v[224:227], a[152:155], v[128:131], v[224:227]
M v[228:231], a[152:155], v[132:135], v[228:231]
v_exp_f32 v41, v41
M v[228:231], a[148:151], v[100:103], v[228:231]
v_cvt_pk_bf16_f32 v40, v40, v41
M v[232:235], a[148:151], v[104:107], v[232:235]
v_exp_f32 v42, v42
M v[232:235], a[152:155], v[136:139], v[232:235]
M v[236:239], a[152:155], v[140:143], v[236:239]
v_exp_f32 v43, v43
M v[236:239], a[148:151], v[108:111], v[236:239]
v_cvt_pk_bf16_f32 v41, v42, v43
s_waitcnt lgkmcnt(4)
M v[240:243], a[156:159], v[96:99], v[240:243]
v_exp_f32 v56, v56
M v[240:243], a[160:163], v[128:131], v[240:243]
M v[244:247], a[160:163], v[132:135], v[244:247]
v_exp_f32 v57, v57
M v[244:247], a[156:159], v[100:103], v[244:247]
v_cvt_pk_bf16_f32 v42, v56, v57
M v[248:251], a[156:159], v[104:107], v[248:251]
v_exp_f32 v58, v58
M v[248:251], a[160:163], v[136:139], v[248:251]
s_waitcnt vmcnt(0) lgkmcnt(0)
s_barrier
ds_read_b128 a[116:119], v2 offset:0
ds_read_b128 a[120:123], v2 offset:1024
M v[252:255], a[160:163], v[140:143], v[252:255]
v_exp_f32 v59, v59
M v[252:255], a[156:159], v[108:111], v[252:255]
v_cvt_pk_bf16_f32 v43, v58, v59
M a[64:67], a[164:167], v[96:99], a[64:67]
v_exp_f32 v44, v44
M a[64:67], a[168:171], v[128:131], a[64:67]
ds_read_b128 a[124:127], v2 offset:2048
ds_read_b128 a[128:131], v2 offset:3072
M a[68:71], a[168:171], v[132:135], a[68:71]
v_exp_f32 v45, v45
M a[68:71], a[164:167], v[100:103], a[68:71]
v_cvt_pk_bf16_f32 v44, v44, v45
M a[72:75], a[164:167], v[104:107], a[72:75]
v_exp_f32 v46, v46
M a[72:75], a[168:171], v[136:139], a[72:75]
ds_read_b128 a[132:135], v2 offset:4096
ds_read_b128 a[136:139], v2 offset:5120
M a[76:79], a[168:171], v[140:143], a[76:79]
v_exp_f32 v47, v47
M a[76:79], a[164:167], v[108:111], a[76:79]
v_cvt_pk_bf16_f32 v45, v46, v47
M a[80:83], a[172:175], v[96:99], a[80:83]
v_exp_f32 v60, v60
M a[80:83], a[176:179], v[128:131], a[80:83]
ds_read_b128 a[140:143], v2 offset:6144
ds_read_b128 a[144:147], v2 offset:7168
M a[84:87], a[176:179], v[132:135], a[84:87]
v_exp_f32 v61, v61
M a[84:87], a[172:175], v[100:103], a[84:87]
v_cvt_pk_bf16_f32 v46, v60, v61
M a[88:91], a[172:175], v[104:107], a[88:91]
v_exp_f32 v62, v62
M a[88:91], a[176:179], v[136:139], a[88:91]
M a[92:95], a[176:179], v[140:143], a[92:95]
v_exp_f32 v63, v63
M a[92:95], a[172:175], v[108:111], a[92:95]
v_cvt_pk_bf16_f32 v47, v62, v63
Lk2_m2b:
s_sub_u32 s35, 15, s21
s_lshl_b32 s33, s20, 7
s_lshl_b32 s34, s35, 3
s_add_u32 s33, s33, s34
s_lshl_b32 s34, s23, 2
s_add_u32 s33, s33, s34
s_lshl_b32 s33, s33, 12
buffer_load_dwordx4 a[180:183], v1, s[8:11], s33 offen offset:0 sc1
buffer_load_dwordx4 a[184:187], v1, s[8:11], s33 offen offset:1024 sc1
buffer_load_dwordx4 a[188:191], v1, s[8:11], s33 offen offset:2048 sc1
buffer_load_dwordx4 a[192:195], v1, s[8:11], s33 offen offset:3072 sc1
s_add_u32 s33, s33, 4096
buffer_load_dwordx4 a[196:199], v1, s[8:11], s33 offen offset:0 sc1
buffer_load_dwordx4 a[200:203], v1, s[8:11], s33 offen offset:1024 sc1
buffer_load_dwordx4 a[204:207], v1, s[8:11], s33 offen offset:2048 sc1
buffer_load_dwordx4 a[208:211], v1, s[8:11], s33 offen offset:3072 sc1
s_add_u32 s33, s33, 4096
buffer_load_dwordx4 a[212:215], v1, s[8:11], s33 offen offset:0 sc1
buffer_load_dwordx4 a[216:219], v1, s[8:11], s33 offen offset:1024 sc1
buffer_load_dwordx4 a[220:223], v1, s[8:11], s33 offen offset:2048 sc1
buffer_load_dwordx4 a[224:227], v1, s[8:11], s33 offen offset:3072 sc1
s_add_u32 s33, s33, 4096
buffer_load_dwordx4 a[228:231], v1, s[8:11], s33 offen offset:0 sc1
buffer_load_dwordx4 a[232:235], v1, s[8:11], s33 offen offset:1024 sc1
buffer_load_dwordx4 a[236:239], v1, s[8:11], s33 offen offset:2048 sc1
buffer_load_dwordx4 a[240:243], v1, s[8:11], s33 offen offset:3072 sc1
s_add_u32 m0, s29, 65536
s_waitcnt lgkmcnt(4)
M v[96:99], a[116:119], a[0:3], v[16:19]
v_exp_f32 v64, v64
M v[96:99], a[120:123], a[4:7], v[96:99]
ds_read_b128 a[148:151], v2 offset:8192
ds_read_b128 a[152:155], v2 offset:9216
M v[96:99], a[124:127], a[8:11], v[96:99]
v_exp_f32 v65, v65
M v[96:99], a[128:131], a[12:15], v[96:99]
buffer_load_dwordx4 v1, s[12:15], s25 offen offset:0 sc1 lds
s_add_u32 s32, s25, 4096
M v[100:103], a[128:131], a[28:31], 0
v_exp_f32 v66, v66
M v[100:103], a[124:127], a[24:27], v[100:103]
v_cvt_pk_bf16_f32 v64, v64, v65
M v[100:103], a[120:123], a[20:23], v[100:103]
v_exp_f32 v67, v67
M v[100:103], a[116:119], a[16:19], v[100:103]
buffer_load_dwordx4 v1, s[12:15], s25 offen offset:1024 sc1 lds
M v[104:107], a[116:119], a[32:35], 0
v_exp_f32 v80, v80
M v[104:107], a[120:123], a[36:39], v[104:107]
ds_read_b128 a[156:159], v2 offset:10240
ds_read_b128 a[160:163], v2 offset:11264
M v[104:107], a[124:127], a[40:43], v[104:107]
v_exp_f32 v81, v81
M v[104:107], a[128:131], a[44:47], v[104:107]
buffer_load_dwordx4 v1, s[12:15], s25 offen offset:2048 sc1 lds
M v[108:111], a[128:131], a[60:63], 0
v_exp_f32 v82, v82
M v[108:111], a[124:127], a[56:59], v[108:111]
v_cvt_pk_bf16_f32 v65, v66, v67
v_cvt_pk_bf16_f32 v66, v80, v81
M v[108:111], a[120:123], a[52:55], v[108:111]
v_exp_f32 v83, v83
M v[108:111], a[116:119], a[48:51], v[108:111]
buffer_load_dwordx4 v1, s[12:15], s25 offen offset:3072 sc1 lds
s_add_u32 m0, s29, 69632
s_waitcnt lgkmcnt(4)
v_exp_f32 v68, v68
ds_read_b128 a[164:167], v2 offset:12288
ds_read_b128 a[168:171], v2 offset:13312
v_exp_f32 v69, v69
buffer_load_dwordx4 v1, s[12:15], s32 offen offset:0 sc1 lds
M v[116:119], a[144:147], a[28:31], v[16:19]
v_exp_f32 v70, v70
M v[116:119], a[140:143], a[24:27], v[116:119]
v_cvt_pk_bf16_f32 v67, v82, v83
v_cvt_pk_bf16_f32 v68, v68, v69
M v[116:119], a[136:139], a[20:23], v[116:119]
v_exp_f32 v71, v71
M v[116:119], a[132:135], a[16:19], v[116:119]
buffer_load_dwordx4 v1, s[12:15], s32 offen offset:1024 sc1 lds
M v[120:123], a[132:135], a[32:35], 0
v_exp_f32 v84, v84
M v[120:123], a[136:139], a[36:39], v[120:123]
ds_read_b128 a[172:175], v2 offset:14336
ds_read_b128 a[176:179], v2 offset:15360
M v[120:123], a[140:143], a[40:43], v[120:123]
v_exp_f32 v85, v85
M v[120:123], a[144:147], a[44:47], v[120:123]
buffer_load_dwordx4 v1, s[12:15], s32 offen offset:2048 sc1 lds
M v[124:127], a[144:147], a[60:63], 0
v_exp_f32 v86, v86
M v[124:127], a[140:143], a[56:59], v[124:127]
v_cvt_pk_bf16_f32 v69, v70, v71
v_cvt_pk_bf16_f32 v70, v84, v85
M v[124:127], a[136:139], a[52:55], v[124:127]
v_exp_f32 v87, v87
M v[124:127], a[132:135], a[48:51], v[124:127]
buffer_load_dwordx4 v1, s[12:15], s32 offen offset:3072 sc1 lds
s_add_u32 m0, s29, 98304
s_waitcnt lgkmcnt(4)
v_exp_f32 v72, v72
ds_read_b128 a[116:119], v5 offset:32768
ds_read_b128 a[120:123], v5 offset:40960
v_exp_f32 v73, v73
buffer_load_dwordx4 v1, s[12:15], s26 offen offset:0 sc1 lds
s_add_u32 s43, s26, 4096
v_exp_f32 v74, v74
v_cvt_pk_bf16_f32 v71, v86, v87
v_cvt_pk_bf16_f32 v72, v72, v73
v_exp_f32 v75, v75
buffer_load_dwordx4 v1, s[12:15], s26 offen offset:1024 sc1 lds
M v[136:139], a[148:151], a[32:35], v[16:19]
v_exp_f32 v88, v88
M v[136:139], a[152:155], a[36:39], v[136:139]
ds_read_b128 a[124:127], v5 offset:33792
ds_read_b128 a[128:131], v5 offset:41984
M v[136:139], a[156:159], a[40:43], v[136:139]
v_exp_f32 v89, v89
M v[136:139], a[160:163], a[44:47], v[136:139]
buffer_load_dwordx4 v1, s[12:15], s26 offen offset:2048 sc1 lds
M v[140:143], a[160:163], a[60:63], 0
v_exp_f32 v90, v90
M v[140:143], a[156:159], a[56:59], v[140:143]
v_cvt_pk_bf16_f32 v73, v74, v75
v_cvt_pk_bf16_f32 v74, v88, v89
M v[140:143], a[152:155], a[52:55], v[140:143]
v_exp_f32 v91, v91
M v[140:143], a[148:151], a[48:51], v[140:143]
buffer_load_dwordx4 v1, s[12:15], s26 offen offset:3072 sc1 lds
s_add_u32 m0, s29, 102400
s_waitcnt lgkmcnt(4)
v_exp_f32 v76, v76
ds_read_b128 a[132:135], v5 offset:34816
ds_read_b128 a[136:139], v5 offset:43008
v_exp_f32 v77, v77
buffer_load_dwordx4 v1, s[12:15], s43 offen offset:0 sc1 lds
v_exp_f32 v78, v78
v_cvt_pk_bf16_f32 v75, v90, v91
v_cvt_pk_bf16_f32 v76, v76, v77
v_exp_f32 v79, v79
buffer_load_dwordx4 v1, s[12:15], s43 offen offset:1024 sc1 lds
v_exp_f32 v92, v92
ds_read_b128 a[140:143], v5 offset:35840
ds_read_b128 a[144:147], v5 offset:44032
v_exp_f32 v93, v93
buffer_load_dwordx4 v1, s[12:15], s43 offen offset:2048 sc1 lds
M v[156:159], a[176:179], a[60:63], v[16:19]
v_exp_f32 v94, v94
M v[156:159], a[172:175], a[56:59], v[156:159]
v_cvt_pk_bf16_f32 v77, v78, v79
v_cvt_pk_bf16_f32 v78, v92, v93
M v[156:159], a[168:171], a[52:55], v[156:159]
v_exp_f32 v95, v95
M v[156:159], a[164:167], a[48:51], v[156:159]
buffer_load_dwordx4 v1, s[12:15], s43 offen offset:3072 sc1 lds
v_cvt_pk_bf16_f32 v79, v94, v95
s_waitcnt lgkmcnt(6)
M v[160:163], a[116:119], v[32:35], v[160:163]
v_exp_f32 v96, v96
M v[160:163], a[120:123], v[64:67], v[160:163]
ds_read_b128 a[148:151], v5 offset:36864
ds_read_b128 a[152:155], v5 offset:45056
M v[164:167], a[120:123], v[68:71], v[164:167]
v_exp_f32 v97, v97
M v[164:167], a[116:119], v[36:39], v[164:167]
v_cvt_pk_bf16_f32 v96, v96, v97
M v[168:171], a[116:119], v[40:43], v[168:171]
v_exp_f32 v98, v98
M v[168:171], a[120:123], v[72:75], v[168:171]
s_add_u32 s25, s25, 32768
s_cmp_eq_u32 s25, s27
M v[172:175], a[120:123], v[76:79], v[172:175]
v_exp_f32 v99, v99
M v[172:175], a[116:119], v[44:47], v[172:175]
v_cvt_pk_bf16_f32 v97, v98, v99
s_waitcnt lgkmcnt(6)
M a[96:99], a[112:115], v[32:35], a[96:99]
s_cselect_b32 s25, s28, s25
s_cselect_b32 s27, -1, s27
M a[96:99], a[112:115], v[64:67], a[96:99]
s_add_u32 s26, s26, 32768
s_cmp_eq_u32 s26, s62
M v[176:179], a[124:127], v[32:35], v[176:179]
M v[176:179], a[128:131], v[64:67], v[176:179]
ds_read_b128 a[156:159], v5 offset:37888
ds_read_b128 a[160:163], v5 offset:46080
M v[180:183], a[128:131], v[68:71], v[180:183]
M v[180:183], a[124:127], v[36:39], v[180:183]
v_mov_b32 v98, 0
M v[184:187], a[124:127], v[40:43], v[184:187]
M v[184:187], a[128:131], v[72:75], v[184:187]
s_cselect_b32 s26, s63, s26
s_cselect_b32 s62, -1, s62
M v[188:191], a[128:131], v[76:79], v[188:191]
M v[188:191], a[124:127], v[44:47], v[188:191]
v_mov_b32 v99, 0
s_waitcnt lgkmcnt(6)
M a[100:103], a[112:115], v[36:39], a[100:103]
M a[100:103], a[112:115], v[68:71], a[100:103]
M v[192:195], a[132:135], v[32:35], v[192:195]
v_exp_f32 v100, v100
M v[192:195], a[136:139], v[64:67], v[192:195]
ds_read_b128 a[164:167], v5 offset:38912
ds_read_b128 a[168:171], v5 offset:47104
M v[196:199], a[136:139], v[68:71], v[196:199]
v_exp_f32 v101, v101
M v[196:199], a[132:135], v[36:39], v[196:199]
v_cvt_pk_bf16_f32 v100, v100, v101
M v[200:203], a[132:135], v[40:43], v[200:203]
v_exp_f32 v102, v102
M v[200:203], a[136:139], v[72:75], v[200:203]
M v[204:207], a[136:139], v[76:79], v[204:207]
v_exp_f32 v103, v103
M v[204:207], a[132:135], v[44:47], v[204:207]
v_cvt_pk_bf16_f32 v101, v102, v103
s_waitcnt lgkmcnt(6)
M a[104:107], a[112:115], v[40:43], a[104:107]
M a[104:107], a[112:115], v[72:75], a[104:107]
M v[208:211], a[140:143], v[32:35], v[208:211]
v_exp_f32 v116, v116
M v[208:211], a[144:147], v[64:67], v[208:211]
ds_read_b128 a[172:175], v5 offset:39936
ds_read_b128 a[176:179], v5 offset:48128
M v[212:215], a[144:147], v[68:71], v[212:215]
v_exp_f32 v117, v117
M v[212:215], a[140:143], v[36:39], v[212:215]
v_cvt_pk_bf16_f32 v102, v116, v117
M v[216:219], a[140:143], v[40:43], v[216:219]
v_exp_f32 v118, v118
M v[216:219], a[144:147], v[72:75], v[216:219]
M v[220:223], a[144:147], v[76:79], v[220:223]
v_exp_f32 v119, v119
M v[220:223], a[140:143], v[44:47], v[220:223]
v_cvt_pk_bf16_f32 v103, v118, v119
s_waitcnt lgkmcnt(6)
M a[108:111], a[112:115], v[44:47], a[108:111]
M a[108:111], a[112:115], v[76:79], a[108:111]
M v[224:227], a[148:151], v[32:35], v[224:227]
v_exp_f32 v104, v104
M v[224:227], a[152:155], v[64:67], v[224:227]
M v[228:231], a[152:155], v[68:71], v[228:231]
v_exp_f32 v105, v105
M v[228:231], a[148:151], v[36:39], v[228:231]
v_cvt_pk_bf16_f32 v104, v104, v105
M v[232:235], a[148:151], v[40:43], v[232:235]
v_exp_f32 v106, v106
M v[232:235], a[152:155], v[72:75], v[232:235]
M v[236:239], a[152:155], v[76:79], v[236:239]
v_exp_f32 v107, v107
M v[236:239], a[148:151], v[44:47], v[236:239]
v_cvt_pk_bf16_f32 v105, v106, v107
s_waitcnt lgkmcnt(4)
M v[240:243], a[156:159], v[32:35], v[240:243]
v_exp_f32 v120, v120
M v[240:243], a[160:163], v[64:67], v[240:243]
M v[244:247], a[160:163], v[68:71], v[244:247]
v_exp_f32 v121, v121
M v[244:247], a[156:159], v[36:39], v[244:247]
v_cvt_pk_bf16_f32 v106, v120, v121
M v[248:251], a[156:159], v[40:43], v[248:251]
v_exp_f32 v122, v122
M v[248:251], a[160:163], v[72:75], v[248:251]
s_waitcnt vmcnt(0) lgkmcnt(0)
s_barrier
ds_read_b128 a[116:119], v3 offset:0
ds_read_b128 a[120:123], v3 offset:1024
M v[252:255], a[160:163], v[76:79], v[252:255]
v_exp_f32 v123, v123
M v[252:255], a[156:159], v[44:47], v[252:255]
v_cvt_pk_bf16_f32 v107, v122, v123
M a[64:67], a[164:167], v[32:35], a[64:67]
v_exp_f32 v108, v108
M a[64:67], a[168:171], v[64:67], a[64:67]
ds_read_b128 a[124:127], v3 offset:2048
ds_read_b128 a[128:131], v3 offset:3072
M a[68:71], a[168:171], v[68:71], a[68:71]
v_exp_f32 v109, v109
M a[68:71], a[164:167], v[36:39], a[68:71]
v_cvt_pk_bf16_f32 v108, v108, v109
M a[72:75], a[164:167], v[40:43], a[72:75]
v_exp_f32 v110, v110
M a[72:75], a[168:171], v[72:75], a[72:75]
ds_read_b128 a[132:135], v3 offset:4096
ds_read_b128 a[136:139], v3 offset:5120
M a[76:79], a[168:171], v[76:79], a[76:79]
v_exp_f32 v111, v111
M a[76:79], a[164:167], v[44:47], a[76:79]
v_cvt_pk_bf16_f32 v109, v110, v111
M a[80:83], a[172:175], v[32:35], a[80:83]
v_exp_f32 v124, v124
M a[80:83], a[176:179], v[64:67], a[80:83]
ds_read_b128 a[140:143], v3 offset:6144
ds_read_b128 a[144:147], v3 offset:7168
M a[84:87], a[176:179], v[68:71], a[84:87]
v_exp_f32 v125, v125
M a[84:87], a[172:175], v[36:39], a[84:87]
v_cvt_pk_bf16_f32 v110, v124, v125
M a[88:91], a[172:175], v[40:43], a[88:91]
v_exp_f32 v126, v126
M a[88:91], a[176:179], v[72:75], a[88:91]
M a[92:95], a[176:179], v[76:79], a[92:95]
v_exp_f32 v127, v127
M a[92:95], a[172:175], v[44:47], a[92:95]
v_cvt_pk_bf16_f32 v111, v126, v127
s_waitcnt vmcnt(16)
s_add_u32 m0, s29, 0
s_waitcnt lgkmcnt(4)
M v[32:35], a[116:119], a[180:183], 0
M v[32:35], a[120:123], a[184:187], v[32:35]
ds_read_b128 a[148:151], v3 offset:8192
ds_read_b128 a[152:155], v3 offset:9216
M v[32:35], a[124:127], a[188:191], v[32:35]
M v[32:35], a[128:131], a[192:195], v[32:35]
buffer_load_dwordx4 v1, s[12:15], s25 offen offset:0 sc1 lds
s_add_u32 s32, s25, 4096
M v[36:39], a[128:131], a[208:211], 0
M v[36:39], a[124:127], a[204:207], v[36:39]
M v[36:39], a[120:123], a[200:203], v[36:39]
M v[36:39], a[116:119], a[196:199], v[36:39]
buffer_load_dwordx4 v1, s[12:15], s25 offen offset:1024 sc1 lds
M v[40:43], a[116:119], a[212:215], 0
M v[40:43], a[120:123], a[216:219], v[40:43]
ds_read_b128 a[156:159], v3 offset:10240
ds_read_b128 a[160:163], v3 offset:11264
M v[40:43], a[124:127], a[220:223], v[40:43]
M v[40:43], a[128:131], a[224:227], v[40:43]
buffer_load_dwordx4 v1, s[12:15], s25 offen offset:2048 sc1 lds
M v[44:47], a[128:131], a[240:243], 0
M v[44:47], a[124:127], a[236:239], v[44:47]
M v[44:47], a[120:123], a[232:235], v[44:47]
M v[44:47], a[116:119], a[228:231], v[44:47]
buffer_load_dwordx4 v1, s[12:15], s25 offen offset:3072 sc1 lds
s_add_u32 m0, s29, 4096
s_waitcnt lgkmcnt(4)
M v[48:51], a[132:135], a[180:183], 0
M v[48:51], a[136:139], a[184:187], v[48:51]
ds_read_b128 a[164:167], v3 offset:12288
ds_read_b128 a[168:171], v3 offset:13312
M v[48:51], a[140:143], a[188:191], v[48:51]
M v[48:51], a[144:147], a[192:195], v[48:51]
buffer_load_dwordx4 v1, s[12:15], s32 offen offset:0 sc1 lds
M v[52:55], a[144:147], a[208:211], 0
M v[52:55], a[140:143], a[204:207], v[52:55]
M v[52:55], a[136:139], a[200:203], v[52:55]
M v[52:55], a[132:135], a[196:199], v[52:55]
buffer_load_dwordx4 v1, s[12:15], s32 offen offset:1024 sc1 lds
M v[56:59], a[132:135], a[212:215], 0
M v[56:59], a[136:139], a[216:219], v[56:59]
ds_read_b128 a[172:175], v3 offset:14336
ds_read_b128 a[176:179], v3 offset:15360
M v[56:59], a[140:143], a[220:223], v[56:59]
M v[56:59], a[144:147], a[224:227], v[56:59]
buffer_load_dwordx4 v1, s[12:15], s32 offen offset:2048 sc1 lds
M v[60:63], a[144:147], a[240:243], 0
M v[60:63], a[140:143], a[236:239], v[60:63]
M v[60:63], a[136:139], a[232:235], v[60:63]
M v[60:63], a[132:135], a[228:231], v[60:63]
buffer_load_dwordx4 v1, s[12:15], s32 offen offset:3072 sc1 lds
s_add_u32 m0, s29, 32768
s_waitcnt lgkmcnt(4)
M v[64:67], a[148:151], a[180:183], 0
v_exp_f32 v136, v136
M v[64:67], a[152:155], a[184:187], v[64:67]
ds_read_b128 a[116:119], v6 offset:32768
ds_read_b128 a[120:123], v6 offset:40960
M v[64:67], a[156:159], a[188:191], v[64:67]
v_exp_f32 v137, v137
M v[64:67], a[160:163], a[192:195], v[64:67]
buffer_load_dwordx4 v1, s[12:15], s26 offen offset:0 sc1 lds
s_add_u32 s43, s26, 4096
M v[68:71], a[160:163], a[208:211], 0
v_exp_f32 v138, v138
M v[68:71], a[156:159], a[204:207], v[68:71]
v_cvt_pk_bf16_f32 v136, v136, v137
M v[68:71], a[152:155], a[200:203], v[68:71]
v_exp_f32 v139, v139
M v[68:71], a[148:151], a[196:199], v[68:71]
buffer_load_dwordx4 v1, s[12:15], s26 offen offset:1024 sc1 lds
M v[72:75], a[148:151], a[212:215], 0
M v[72:75], a[152:155], a[216:219], v[72:75]
ds_read_b128 a[124:127], v6 offset:33792
ds_read_b128 a[128:131], v6 offset:41984
M v[72:75], a[156:159], a[220:223], v[72:75]
M v[72:75], a[160:163], a[224:227], v[72:75]
buffer_load_dwordx4 v1, s[12:15], s26 offen offset:2048 sc1 lds
M v[76:79], a[160:163], a[240:243], 0
M v[76:79], a[156:159], a[236:239], v[76:79]
v_cvt_pk_bf16_f32 v137, v138, v139
v_mov_b32 v138, 0
M v[76:79], a[152:155], a[232:235], v[76:79]
M v[76:79], a[148:151], a[228:231], v[76:79]
buffer_load_dwordx4 v1, s[12:15], s26 offen offset:3072 sc1 lds
s_add_u32 m0, s29, 36864
s_waitcnt lgkmcnt(4)
M v[80:83], a[164:167], a[180:183], 0
v_exp_f32 v140, v140
M v[80:83], a[168:171], a[184:187], v[80:83]
ds_read_b128 a[132:135], v6 offset:34816
ds_read_b128 a[136:139], v6 offset:43008
M v[80:83], a[172:175], a[188:191], v[80:83]
v_exp_f32 v141, v141
M v[80:83], a[176:179], a[192:195], v[80:83]
buffer_load_dwordx4 v1, s[12:15], s43 offen offset:0 sc1 lds
M v[84:87], a[176:179], a[208:211], 0
v_exp_f32 v142, v142
M v[84:87], a[172:175], a[204:207], v[84:87]
v_mov_b32 v139, 0
v_cvt_pk_bf16_f32 v140, v140, v141
M v[84:87], a[168:171], a[200:203], v[84:87]
v_exp_f32 v143, v143
M v[84:87], a[164:167], a[196:199], v[84:87]
buffer_load_dwordx4 v1, s[12:15], s43 offen offset:1024 sc1 lds
M v[88:91], a[164:167], a[212:215], 0
v_exp_f32 v156, v156
M v[88:91], a[168:171], a[216:219], v[88:91]
ds_read_b128 a[140:143], v6 offset:35840
ds_read_b128 a[144:147], v6 offset:44032
M v[88:91], a[172:175], a[220:223], v[88:91]
v_exp_f32 v157, v157
M v[88:91], a[176:179], a[224:227], v[88:91]
buffer_load_dwordx4 v1, s[12:15], s43 offen offset:2048 sc1 lds
M v[92:95], a[176:179], a[240:243], 0
v_exp_f32 v158, v158
M v[92:95], a[172:175], a[236:239], v[92:95]
v_cvt_pk_bf16_f32 v141, v142, v143
v_cvt_pk_bf16_f32 v142, v156, v157
M v[92:95], a[168:171], a[232:235], v[92:95]
v_exp_f32 v159, v159
M v[92:95], a[164:167], a[228:231], v[92:95]
buffer_load_dwordx4 v1, s[12:15], s43 offen offset:3072 sc1 lds
v_cvt_pk_bf16_f32 v143, v158, v159
s_waitcnt lgkmcnt(6)
M v[160:163], a[116:119], v[96:99], v[160:163]
v_exp_f32 v32, v32
ds_read_b128 a[148:151], v6 offset:36864
ds_read_b128 a[152:155], v6 offset:45056
v_exp_f32 v33, v33
M v[164:167], a[116:119], v[100:103], v[164:167]
v_cvt_pk_bf16_f32 v32, v32, v33
M v[168:171], a[116:119], v[104:107], v[168:171]
v_exp_f32 v34, v34
M v[168:171], a[120:123], v[136:139], v[168:171]
s_add_u32 s25, s25, 32768
s_cmp_eq_u32 s25, s27
M v[172:175], a[120:123], v[140:143], v[172:175]
v_exp_f32 v35, v35
M v[172:175], a[116:119], v[108:111], v[172:175]
v_cvt_pk_bf16_f32 v33, v34, v35
s_waitcnt lgkmcnt(6)
M a[96:99], a[112:115], v[96:99], a[96:99]
s_cselect_b32 s25, s28, s25
s_cselect_b32 s27, -1, s27
s_add_u32 s26, s26, 32768
s_cmp_eq_u32 s26, s62
M v[176:179], a[124:127], v[96:99], v[176:179]
v_exp_f32 v48, v48
ds_read_b128 a[156:159], v6 offset:37888
ds_read_b128 a[160:163], v6 offset:46080
v_exp_f32 v49, v49
M v[180:183], a[124:127], v[100:103], v[180:183]
v_cvt_pk_bf16_f32 v34, v48, v49
M v[184:187], a[124:127], v[104:107], v[184:187]
v_exp_f32 v50, v50
M v[184:187], a[128:131], v[136:139], v[184:187]
s_cselect_b32 s26, s63, s26
s_cselect_b32 s62, -1, s62
M v[188:191], a[128:131], v[140:143], v[188:191]
v_exp_f32 v51, v51
M v[188:191], a[124:127], v[108:111], v[188:191]
v_cvt_pk_bf16_f32 v35, v50, v51
s_waitcnt lgkmcnt(6)
M a[100:103], a[112:115], v[100:103], a[100:103]
M v[192:195], a[132:135], v[96:99], v[192:195]
v_exp_f32 v36, v36
ds_read_b128 a[164:167], v6 offset:38912
ds_read_b128 a[168:171], v6 offset:47104
v_exp_f32 v37, v37
M v[196:199], a[132:135], v[100:103], v[196:199]
v_cvt_pk_bf16_f32 v36, v36, v37
M v[200:203], a[132:135], v[104:107], v[200:203]
v_exp_f32 v38, v38
M v[200:203], a[136:139], v[136:139], v[200:203]
M v[204:207], a[136:139], v[140:143], v[204:207]
v_exp_f32 v39, v39
M v[204:207], a[132:135], v[108:111], v[204:207]
v_cvt_pk_bf16_f32 v37, v38, v39
s_waitcnt lgkmcnt(6)
M a[104:107], a[112:115], v[104:107], a[104:107]
M a[104:107], a[112:115], v[136:139], a[104:107]
M v[208:211], a[140:143], v[96:99], v[208:211]
v_exp_f32 v52, v52
ds_read_b128 a[172:175], v6 offset:39936
ds_read_b128 a[176:179], v6 offset:48128
v_exp_f32 v53, v53
M v[212:215], a[140:143], v[100:103], v[212:215]
v_cvt_pk_bf16_f32 v38, v52, v53
M v[216:219], a[140:143], v[104:107], v[216:219]
v_exp_f32 v54, v54
M v[216:219], a[144:147], v[136:139], v[216:219]
M v[220:223], a[144:147], v[140:143], v[220:223]
v_exp_f32 v55, v55
M v[220:223], a[140:143], v[108:111], v[220:223]
v_cvt_pk_bf16_f32 v39, v54, v55
s_waitcnt lgkmcnt(6)
M a[108:111], a[112:115], v[108:111], a[108:111]
M a[108:111], a[112:115], v[140:143], a[108:111]
M v[224:227], a[148:151], v[96:99], v[224:227]
v_exp_f32 v40, v40
v_exp_f32 v41, v41
M v[228:231], a[148:151], v[100:103], v[228:231]
v_cvt_pk_bf16_f32 v40, v40, v41
M v[232:235], a[148:151], v[104:107], v[232:235]
v_exp_f32 v42, v42
M v[232:235], a[152:155], v[136:139], v[232:235]
M v[236:239], a[152:155], v[140:143], v[236:239]
v_exp_f32 v43, v43
M v[236:239], a[148:151], v[108:111], v[236:239]
v_cvt_pk_bf16_f32 v41, v42, v43
s_waitcnt lgkmcnt(4)
M v[240:243], a[156:159], v[96:99], v[240:243]
v_exp_f32 v56, v56
v_exp_f32 v57, v57
M v[244:247], a[156:159], v[100:103], v[244:247]
v_cvt_pk_bf16_f32 v42, v56, v57
M v[248:251], a[156:159], v[104:107], v[248:251]
v_exp_f32 v58, v58
M v[248:251], a[160:163], v[136:139], v[248:251]
s_waitcnt vmcnt(0) lgkmcnt(0)
s_barrier
ds_read_b128 a[116:119], v2 offset:0
ds_read_b128 a[120:123], v2 offset:1024
M v[252:255], a[160:163], v[140:143], v[252:255]
v_exp_f32 v59, v59
M v[252:255], a[156:159], v[108:111], v[252:255]
v_cvt_pk_bf16_f32 v43, v58, v59
M a[64:67], a[164:167], v[96:99], a[64:67]
v_exp_f32 v44, v44
ds_read_b128 a[124:127], v2 offset:2048
ds_read_b128 a[128:131], v2 offset:3072
v_exp_f32 v45, v45
M a[68:71], a[164:167], v[100:103], a[68:71]
v_cvt_pk_bf16_f32 v44, v44, v45
M a[72:75], a[164:167], v[104:107], a[72:75]
v_exp_f32 v46, v46
M a[72:75], a[168:171], v[136:139], a[72:75]
ds_read_b128 a[132:135], v2 offset:4096
ds_read_b128 a[136:139], v2 offset:5120
M a[76:79], a[168:171], v[140:143], a[76:79]
v_exp_f32 v47, v47
M a[76:79], a[164:167], v[108:111], a[76:79]
v_cvt_pk_bf16_f32 v45, v46, v47
M a[80:83], a[172:175], v[96:99], a[80:83]
v_exp_f32 v60, v60
ds_read_b128 a[140:143], v2 offset:6144
ds_read_b128 a[144:147], v2 offset:7168
v_exp_f32 v61, v61
M a[84:87], a[172:175], v[100:103], a[84:87]
v_cvt_pk_bf16_f32 v46, v60, v61
M a[88:91], a[172:175], v[104:107], a[88:91]
v_exp_f32 v62, v62
M a[88:91], a[176:179], v[136:139], a[88:91]
M a[92:95], a[176:179], v[140:143], a[92:95]
v_exp_f32 v63, v63
M a[92:95], a[172:175], v[108:111], a[92:95]
v_cvt_pk_bf16_f32 v47, v62, v63
Lk2_ea:
v_accvgpr_read_b32 v20, a96
v_accvgpr_read_b32 v21, a100
v_accvgpr_read_b32 v22, a104
v_accvgpr_read_b32 v23, a108
v_rcp_f32 v8, v20
v_rcp_f32 v9, v21
v_rcp_f32 v10, v22
v_rcp_f32 v11, v23
v_subrev_u32 v20, 0x21800000, v20
v_subrev_u32 v21, 0x21800000, v21
v_subrev_u32 v22, 0x21800000, v22
v_subrev_u32 v23, 0x21800000, v23
v_max_u32 v12, v20, v21
v_max3_u32 v12, v12, v22, v23
s_mov_b32 s64, 0x207
s_lshl_b32 s33, s21, 20
s_lshl_b32 s34, s20, 15
s_add_u32 s33, s33, s34
s_lshl_b32 s34, s23, 13
s_add_u32 s36, s33, s34
s_add_u32 s37, s36, 4096
s_add_u32 s38, s36, 16384
s_add_u32 s39, s36, 20480
v_pk_mul_f32 v[160:161], v[160:161], v[8:9] op_sel:[0,0] op_sel_hi:[1,0]
v_pk_mul_f32 v[162:163], v[162:163], v[8:9] op_sel:[0,0] op_sel_hi:[1,0]
v_pk_mul_f32 v[176:177], v[176:177], v[8:9] op_sel:[0,0] op_sel_hi:[1,0]
v_pk_mul_f32 v[178:179], v[178:179], v[8:9] op_sel:[0,0] op_sel_hi:[1,0]
v_cvt_pk_bf16_f32 v160, v160, v161
v_cvt_pk_bf16_f32 v161, v162, v163
v_cvt_pk_bf16_f32 v162, v176, v177
v_cvt_pk_bf16_f32 v163, v178, v179
s_nop 1
M v[24:27], a[112:115], v[160:163], 0
buffer_store_dwordx4 v[160:163], v1, s[16:19], s36 offen offset:0 sc1
v_pk_mul_f32 v[164:165], v[164:165], v[8:9] op_sel:[0,1] op_sel_hi:[1,1]
v_pk_mul_f32 v[166:167], v[166:167], v[8:9] op_sel:[0,1] op_sel_hi:[1,1]
v_pk_mul_f32 v[180:181], v[180:181], v[8:9] op_sel:[0,1] op_sel_hi:[1,1]
v_pk_mul_f32 v[182:183], v[182:183], v[8:9] op_sel:[0,1] op_sel_hi:[1,1]
v_cvt_pk_bf16_f32 v164, v164, v165
v_cvt_pk_bf16_f32 v165, v166, v167
v_cvt_pk_bf16_f32 v166, v180, v181
v_cvt_pk_bf16_f32 v167, v182, v183
s_nop 1
M v[24:27], a[112:115], v[164:167], v[24:27]
buffer_store_dwordx4 v[164:167], v1, s[16:19], s36 offen offset:2048 sc1
v_pk_mul_f32 v[168:169], v[168:169], v[10:11] op_sel:[0,0] op_sel_hi:[1,0]
v_pk_mul_f32 v[170:171], v[170:171], v[10:11] op_sel:[0,0] op_sel_hi:[1,0]
v_pk_mul_f32 v[184:185], v[184:185], v[10:11] op_sel:[0,0] op_sel_hi:[1,0]
v_pk_mul_f32 v[186:187], v[186:187], v[10:11] op_sel:[0,0] op_sel_hi:[1,0]
v_cvt_pk_bf16_f32 v168, v168, v169
v_cvt_pk_bf16_f32 v169, v170, v171
v_cvt_pk_bf16_f32 v170, v184, v185
v_cvt_pk_bf16_f32 v171, v186, v187
s_nop 1
M v[24:27], a[112:115], v[168:171], v[24:27]
buffer_store_dwordx4 v[168:171], v1, s[16:19], s37 offen offset:0 sc1
v_pk_mul_f32 v[172:173], v[172:173], v[10:11] op_sel:[0,1] op_sel_hi:[1,1]
v_pk_mul_f32 v[174:175], v[174:175], v[10:11] op_sel:[0,1] op_sel_hi:[1,1]
v_pk_mul_f32 v[188:189], v[188:189], v[10:11] op_sel:[0,1] op_sel_hi:[1,1]
v_pk_mul_f32 v[190:191], v[190:191], v[10:11] op_sel:[0,1] op_sel_hi:[1,1]
v_cvt_pk_bf16_f32 v172, v172, v173
v_cvt_pk_bf16_f32 v173, v174, v175
v_cvt_pk_bf16_f32 v174, v188, v189
v_cvt_pk_bf16_f32 v175, v190, v191
s_nop 1
M v[24:27], a[112:115], v[172:175], v[24:27]
buffer_store_dwordx4 v[172:175], v1, s[16:19], s37 offen offset:2048 sc1
v_pk_mul_f32 v[192:193], v[192:193], v[8:9] op_sel:[0,0] op_sel_hi:[1,0]
v_pk_mul_f32 v[194:195], v[194:195], v[8:9] op_sel:[0,0] op_sel_hi:[1,0]
v_pk_mul_f32 v[208:209], v[208:209], v[8:9] op_sel:[0,0] op_sel_hi:[1,0]
v_pk_mul_f32 v[210:211], v[210:211], v[8:9] op_sel:[0,0] op_sel_hi:[1,0]
v_cvt_pk_bf16_f32 v192, v192, v193
v_cvt_pk_bf16_f32 v193, v194, v195
v_cvt_pk_bf16_f32 v194, v208, v209
v_cvt_pk_bf16_f32 v195, v210, v211
s_nop 1
M v[24:27], a[112:115], v[192:195], v[24:27]
buffer_store_dwordx4 v[192:195], v1, s[16:19], s36 offen offset:1024 sc1
v_pk_mul_f32 v[196:197], v[196:197], v[8:9] op_sel:[0,1] op_sel_hi:[1,1]
v_pk_mul_f32 v[198:199], v[198:199], v[8:9] op_sel:[0,1] op_sel_hi:[1,1]
v_pk_mul_f32 v[212:213], v[212:213], v[8:9] op_sel:[0,1] op_sel_hi:[1,1]
v_pk_mul_f32 v[214:215], v[214:215], v[8:9] op_sel:[0,1] op_sel_hi:[1,1]
v_cvt_pk_bf16_f32 v196, v196, v197
v_cvt_pk_bf16_f32 v197, v198, v199
v_cvt_pk_bf16_f32 v198, v212, v213
v_cvt_pk_bf16_f32 v199, v214, v215
s_nop 1
M v[24:27], a[112:115], v[196:199], v[24:27]
buffer_store_dwordx4 v[196:199], v1, s[16:19], s36 offen offset:3072 sc1
v_pk_mul_f32 v[200:201], v[200:201], v[10:11] op_sel:[0,0] op_sel_hi:[1,0]
v_pk_mul_f32 v[202:203], v[202:203], v[10:11] op_sel:[0,0] op_sel_hi:[1,0]
v_pk_mul_f32 v[216:217], v[216:217], v[10:11] op_sel:[0,0] op_sel_hi:[1,0]
v_pk_mul_f32 v[218:219], v[218:219], v[10:11] op_sel:[0,0] op_sel_hi:[1,0]
v_cvt_pk_bf16_f32 v200, v200, v201
v_cvt_pk_bf16_f32 v201, v202, v203
v_cvt_pk_bf16_f32 v202, v216, v217
v_cvt_pk_bf16_f32 v203, v218, v219
s_nop 1
M v[24:27], a[112:115], v[200:203], v[24:27]
buffer_store_dwordx4 v[200:203], v1, s[16:19], s37 offen offset:1024 sc1
v_pk_mul_f32 v[204:205], v[204:205], v[10:11] op_sel:[0,1] op_sel_hi:[1,1]
v_pk_mul_f32 v[206:207], v[206:207], v[10:11] op_sel:[0,1] op_sel_hi:[1,1]
v_pk_mul_f32 v[220:221], v[220:221], v[10:11] op_sel:[0,1] op_sel_hi:[1,1]
v_pk_mul_f32 v[222:223], v[222:223], v[10:11] op_sel:[0,1] op_sel_hi:[1,1]
v_cvt_pk_bf16_f32 v204, v204, v205
v_cvt_pk_bf16_f32 v205, v206, v207
v_cvt_pk_bf16_f32 v206, v220, v221
v_cvt_pk_bf16_f32 v207, v222, v223
s_nop 1
M v[24:27], a[112:115], v[204:207], v[24:27]
buffer_store_dwordx4 v[204:207], v1, s[16:19], s37 offen offset:3072 sc1
v_pk_mul_f32 v[224:225], v[224:225], v[8:9] op_sel:[0,0] op_sel_hi:[1,0]
v_pk_mul_f32 v[226:227], v[226:227], v[8:9] op_sel:[0,0] op_sel_hi:[1,0]
v_pk_mul_f32 v[240:241], v[240:241], v[8:9] op_sel:[0,0] op_sel_hi:[1,0]
v_pk_mul_f32 v[242:243], v[242:243], v[8:9] op_sel:[0,0] op_sel_hi:[1,0]
v_cvt_pk_bf16_f32 v224, v224, v225
v_cvt_pk_bf16_f32 v225, v226, v227
v_cvt_pk_bf16_f32 v226, v240, v241
v_cvt_pk_bf16_f32 v227, v242, v243
s_nop 1
M v[24:27], a[112:115], v[224:227], v[24:27]
buffer_store_dwordx4 v[224:227], v1, s[16:19], s38 offen offset:0 sc1
v_pk_mul_f32 v[228:229], v[228:229], v[8:9] op_sel:[0,1] op_sel_hi:[1,1]
v_pk_mul_f32 v[230:231], v[230:231], v[8:9] op_sel:[0,1] op_sel_hi:[1,1]
v_pk_mul_f32 v[244:245], v[244:245], v[8:9] op_sel:[0,1] op_sel_hi:[1,1]
v_pk_mul_f32 v[246:247], v[246:247], v[8:9] op_sel:[0,1] op_sel_hi:[1,1]
v_cvt_pk_bf16_f32 v228, v228, v229
v_cvt_pk_bf16_f32 v229, v230, v231
v_cvt_pk_bf16_f32 v230, v244, v245
v_cvt_pk_bf16_f32 v231, v246, v247
s_nop 1
M v[24:27], a[112:115], v[228:231], v[24:27]
buffer_store_dwordx4 v[228:231], v1, s[16:19], s38 offen offset:2048 sc1
v_pk_mul_f32 v[232:233], v[232:233], v[10:11] op_sel:[0,0] op_sel_hi:[1,0]
v_pk_mul_f32 v[234:235], v[234:235], v[10:11] op_sel:[0,0] op_sel_hi:[1,0]
v_pk_mul_f32 v[248:249], v[248:249], v[10:11] op_sel:[0,0] op_sel_hi:[1,0]
v_pk_mul_f32 v[250:251], v[250:251], v[10:11] op_sel:[0,0] op_sel_hi:[1,0]
v_cvt_pk_bf16_f32 v232, v232, v233
v_cvt_pk_bf16_f32 v233, v234, v235
v_cvt_pk_bf16_f32 v234, v248, v249
v_cvt_pk_bf16_f32 v235, v250, v251
s_nop 1
M v[24:27], a[112:115], v[232:235], v[24:27]
buffer_store_dwordx4 v[232:235], v1, s[16:19], s39 offen offset:0 sc1
v_pk_mul_f32 v[236:237], v[236:237], v[10:11] op_sel:[0,1] op_sel_hi:[1,1]
v_pk_mul_f32 v[238:239], v[238:239], v[10:11] op_sel:[0,1] op_sel_hi:[1,1]
v_pk_mul_f32 v[252:253], v[252:253], v[10:11] op_sel:[0,1] op_sel_hi:[1,1]
v_pk_mul_f32 v[254:255], v[254:255], v[10:11] op_sel:[0,1] op_sel_hi:[1,1]
v_cvt_pk_bf16_f32 v236, v236, v237
v_cvt_pk_bf16_f32 v237, v238, v239
v_cvt_pk_bf16_f32 v238, v252, v253
v_cvt_pk_bf16_f32 v239, v254, v255
v_accvgpr_read_b32 v176, a64
v_accvgpr_read_b32 v177, a65
v_accvgpr_read_b32 v178, a66
v_accvgpr_read_b32 v179, a67
v_accvgpr_read_b32 v180, a80
v_accvgpr_read_b32 v181, a81
v_accvgpr_read_b32 v182, a82
v_accvgpr_read_b32 v183, a83
M v[24:27], a[112:115], v[236:239], v[24:27]
buffer_store_dwordx4 v[236:239], v1, s[16:19], s39 offen offset:2048 sc1
v_pk_mul_f32 v[176:177], v[176:177], v[8:9] op_sel:[0,0] op_sel_hi:[1,0]
v_pk_mul_f32 v[178:179], v[178:179], v[8:9] op_sel:[0,0] op_sel_hi:[1,0]
v_pk_mul_f32 v[180:181], v[180:181], v[8:9] op_sel:[0,0] op_sel_hi:[1,0]
v_pk_mul_f32 v[182:183], v[182:183], v[8:9] op_sel:[0,0] op_sel_hi:[1,0]
v_cvt_pk_bf16_f32 v176, v176, v177
v_cvt_pk_bf16_f32 v177, v178, v179
v_cvt_pk_bf16_f32 v178, v180, v181
v_cvt_pk_bf16_f32 v179, v182, v183
v_accvgpr_read_b32 v184, a68
v_accvgpr_read_b32 v185, a69
v_accvgpr_read_b32 v186, a70
v_accvgpr_read_b32 v187, a71
v_accvgpr_read_b32 v188, a84
v_accvgpr_read_b32 v189, a85
v_accvgpr_read_b32 v190, a86
v_accvgpr_read_b32 v191, a87
M v[24:27], a[112:115], v[176:179], v[24:27]
buffer_store_dwordx4 v[176:179], v1, s[16:19], s38 offen offset:1024 sc1
v_pk_mul_f32 v[184:185], v[184:185], v[8:9] op_sel:[0,1] op_sel_hi:[1,1]
v_pk_mul_f32 v[186:187], v[186:187], v[8:9] op_sel:[0,1] op_sel_hi:[1,1]
v_pk_mul_f32 v[188:189], v[188:189], v[8:9] op_sel:[0,1] op_sel_hi:[1,1]
v_pk_mul_f32 v[190:191], v[190:191], v[8:9] op_sel:[0,1] op_sel_hi:[1,1]
v_cvt_pk_bf16_f32 v184, v184, v185
v_cvt_pk_bf16_f32 v185, v186, v187
v_cvt_pk_bf16_f32 v186, v188, v189
v_cvt_pk_bf16_f32 v187, v190, v191
v_accvgpr_read_b32 v208, a72
v_accvgpr_read_b32 v209, a73
v_accvgpr_read_b32 v210, a74
v_accvgpr_read_b32 v211, a75
v_accvgpr_read_b32 v212, a88
v_accvgpr_read_b32 v213, a89
v_accvgpr_read_b32 v214, a90
v_accvgpr_read_b32 v215, a91
M v[24:27], a[112:115], v[184:187], v[24:27]
buffer_store_dwordx4 v[184:187], v1, s[16:19], s38 offen offset:3072 sc1
v_pk_mul_f32 v[208:209], v[208:209], v[10:11] op_sel:[0,0] op_sel_hi:[1,0]
v_pk_mul_f32 v[210:211], v[210:211], v[10:11] op_sel:[0,0] op_sel_hi:[1,0]
v_pk_mul_f32 v[212:213], v[212:213], v[10:11] op_sel:[0,0] op_sel_hi:[1,0]
v_pk_mul_f32 v[214:215], v[214:215], v[10:11] op_sel:[0,0] op_sel_hi:[1,0]
v_cvt_pk_bf16_f32 v208, v208, v209
v_cvt_pk_bf16_f32 v209, v210, v211
v_cvt_pk_bf16_f32 v210, v212, v213
v_cvt_pk_bf16_f32 v211, v214, v215
v_accvgpr_read_b32 v216, a76
v_accvgpr_read_b32 v217, a77
v_accvgpr_read_b32 v218, a78
v_accvgpr_read_b32 v219, a79
v_accvgpr_read_b32 v220, a92
v_accvgpr_read_b32 v221, a93
v_accvgpr_read_b32 v222, a94
v_accvgpr_read_b32 v223, a95
M v[24:27], a[112:115], v[208:211], v[24:27]
buffer_store_dwordx4 v[208:211], v1, s[16:19], s39 offen offset:1024 sc1
v_pk_mul_f32 v[216:217], v[216:217], v[10:11] op_sel:[0,1] op_sel_hi:[1,1]
v_pk_mul_f32 v[218:219], v[218:219], v[10:11] op_sel:[0,1] op_sel_hi:[1,1]
v_pk_mul_f32 v[220:221], v[220:221], v[10:11] op_sel:[0,1] op_sel_hi:[1,1]
v_pk_mul_f32 v[222:223], v[222:223], v[10:11] op_sel:[0,1] op_sel_hi:[1,1]
v_cvt_pk_bf16_f32 v216, v216, v217
v_cvt_pk_bf16_f32 v217, v218, v219
v_cvt_pk_bf16_f32 v218, v220, v221
v_cvt_pk_bf16_f32 v219, v222, v223
s_nop 1
M v[24:27], a[112:115], v[216:219], v[24:27]
buffer_store_dwordx4 v[216:219], v1, s[16:19], s39 offen offset:3072 sc1
v_cmp_lt_u32 vcc, 0x3c000000, v12
s_nop 5
v_cmp_class_f32 s[40:41], v24, s64
s_nop 0
s_or_b64 vcc, vcc, s[40:41]
s_cmp_lg_u64 vcc, 0
s_cselect_b32 s33, 1, 0
s_or_b32 s60, s60, s33
s_sub_u32 s30, 7, s21
s_cmp_lg_u32 s30, 0
s_cbranch_scc1 Lk2_b0
s_and_b32 s3, s2, 3
s_lshl_b32 s3, s3, 2
s_bfe_u32 s27, s2, 0x20003
s_add_u32 s27, s3, s27
s_lshl_b32 s43, s27, 8
s_add_u32 s43, s43, 16789504
v_lshlrev_b32 v15, 2, v0
buffer_load_dword v7, v15, s[52:55], s43 offen sc1
s_waitcnt lgkmcnt(7)
ds_read_b128 a[116:119], v5 offset:36864
s_waitcnt lgkmcnt(7)
ds_read_b128 a[120:123], v5 offset:45056
s_waitcnt lgkmcnt(7)
ds_read_b128 a[124:127], v5 offset:37888
s_waitcnt lgkmcnt(7)
ds_read_b128 a[128:131], v5 offset:46080
s_waitcnt lgkmcnt(7)
ds_read_b128 a[132:135], v5 offset:38912
s_waitcnt lgkmcnt(7)
ds_read_b128 a[136:139], v5 offset:47104
s_waitcnt lgkmcnt(7)
ds_read_b128 a[140:143], v5 offset:39936
s_waitcnt lgkmcnt(7)
ds_read_b128 a[144:147], v5 offset:48128
s_lshl_b32 s33, s23, 14
s_add_u32 s34, s33, 98304
s_add_u32 s33, s33, 131072
v_add_u32 v2, s34, v1
v_add_u32 v3, s33, v1
v_exp_f32 v64, v64
v_exp_f32 v65, v65
v_exp_f32 v66, v66
v_exp_f32 v67, v67
v_exp_f32 v80, v80
v_exp_f32 v81, v81
v_exp_f32 v82, v82
v_exp_f32 v83, v83
v_cvt_pk_bf16_f32 v64, v64, v65
v_cvt_pk_bf16_f32 v65, v66, v67
v_exp_f32 v68, v68
v_exp_f32 v69, v69
v_exp_f32 v70, v70
v_exp_f32 v71, v71
v_cvt_pk_bf16_f32 v66, v80, v81
v_cvt_pk_bf16_f32 v67, v82, v83
v_exp_f32 v84, v84
v_exp_f32 v85, v85
v_exp_f32 v86, v86
v_exp_f32 v87, v87
v_cvt_pk_bf16_f32 v68, v68, v69
v_cvt_pk_bf16_f32 v69, v70, v71
v_exp_f32 v72, v72
v_exp_f32 v73, v73
v_exp_f32 v74, v74
v_exp_f32 v75, v75
v_cvt_pk_bf16_f32 v70, v84, v85
v_cvt_pk_bf16_f32 v71, v86, v87
v_exp_f32 v88, v88
v_exp_f32 v89, v89
v_exp_f32 v90, v90
v_exp_f32 v91, v91
v_cvt_pk_bf16_f32 v72, v72, v73
v_cvt_pk_bf16_f32 v73, v74, v75
v_exp_f32 v76, v76
v_exp_f32 v77, v77
v_exp_f32 v78, v78
v_exp_f32 v79, v79
v_cvt_pk_bf16_f32 v74, v88, v89
v_cvt_pk_bf16_f32 v75, v90, v91
v_exp_f32 v92, v92
v_exp_f32 v93, v93
v_exp_f32 v94, v94
v_exp_f32 v95, v95
v_cvt_pk_bf16_f32 v76, v76, v77
v_cvt_pk_bf16_f32 v77, v78, v79
v_cvt_pk_bf16_f32 v78, v92, v93
v_cvt_pk_bf16_f32 v79, v94, v95
s_waitcnt lgkmcnt(6)
M v[224:227], a[116:119], v[32:35], 0
M v[224:227], a[120:123], v[64:67], v[224:227]
ds_read_b128 a[148:151], v5 offset:32768
ds_read_b128 a[152:155], v5 offset:40960
s_mov_b32 s61, 0
M v[228:231], a[120:123], v[68:71], 0
M v[228:231], a[116:119], v[36:39], v[228:231]
s_bfe_u32 s3, s2, 0x10002
M v[232:235], a[116:119], v[40:43], 0
M v[232:235], a[120:123], v[72:75], v[232:235]
s_lshl_b32 s3, s3, 3
M v[236:239], a[120:123], v[76:79], 0
M v[236:239], a[116:119], v[44:47], v[236:239]
s_waitcnt lgkmcnt(6)
s_lshr_b32 s28, s2, 5
M a[96:99], a[112:115], v[32:35], 0
M a[96:99], a[112:115], v[64:67], a[96:99]
M v[240:243], a[124:127], v[32:35], 0
M v[240:243], a[128:131], v[64:67], v[240:243]
ds_read_b128 a[156:159], v5 offset:33792
ds_read_b128 a[160:163], v5 offset:41984
s_add_u32 s28, s3, s28
M v[244:247], a[128:131], v[68:71], 0
s_lshl_b32 s25, s27, 18
M v[244:247], a[124:127], v[36:39], v[244:247]
M v[248:251], a[124:127], v[40:43], 0
s_lshl_b32 s3, s101, 12
M v[248:251], a[128:131], v[72:75], v[248:251]
M v[252:255], a[128:131], v[76:79], 0
s_add_u32 s25, s25, s3
M v[252:255], a[124:127], v[44:47], v[252:255]
s_waitcnt lgkmcnt(6)
M a[100:103], a[112:115], v[36:39], 0
M a[100:103], a[112:115], v[68:71], a[100:103]
M a[64:67], a[132:135], v[32:35], 0
s_lshl_b32 s26, s28, 7
M a[64:67], a[136:139], v[64:67], a[64:67]
ds_read_b128 a[164:167], v5 offset:34816
ds_read_b128 a[168:171], v5 offset:43008
M a[68:71], a[136:139], v[68:71], 0
s_lshl_b32 s42, s101, 11
M a[68:71], a[132:135], v[36:39], a[68:71]
M a[72:75], a[132:135], v[40:43], 0
s_add_u32 s44, s4, 83886080
s_addc_u32 s45, s5, 0
M a[72:75], a[136:139], v[72:75], a[72:75]
s_mov_b32 s46, 4194304
M a[76:79], a[136:139], v[76:79], 0
M a[76:79], a[132:135], v[44:47], a[76:79]
s_waitcnt lgkmcnt(6)
s_mov_b32 s47, 0x00020000
M a[104:107], a[112:115], v[40:43], 0
M a[104:107], a[112:115], v[72:75], a[104:107]
M a[80:83], a[140:143], v[32:35], 0
M a[80:83], a[144:147], v[64:67], a[80:83]
ds_read_b128 a[172:175], v5 offset:35840
ds_read_b128 a[176:179], v5 offset:44032
s_mov_b32 s50, 2097152
M a[84:87], a[144:147], v[68:71], 0
M a[84:87], a[140:143], v[36:39], a[84:87]
s_mov_b32 s51, 0x00020000
M a[88:91], a[140:143], v[40:43], 0
M a[88:91], a[144:147], v[72:75], a[88:91]
s_lshl_b32 s3, s101, 4
M a[92:95], a[144:147], v[76:79], 0
M a[92:95], a[140:143], v[44:47], a[92:95]
s_waitcnt lgkmcnt(6)
v_lshrrev_b32 v96, 3, v0
M a[108:111], a[112:115], v[44:47], 0
M a[108:111], a[112:115], v[76:79], a[108:111]
M v[160:163], a[148:151], v[32:35], 0
v_and_b32 v97, 6, v96
M v[160:163], a[152:155], v[64:67], v[160:163]
M v[164:167], a[152:155], v[68:71], 0
ds_write_b128 v2, v[224:227] offset:0
v_and_b32 v98, 7, v0
M v[164:167], a[148:151], v[36:39], v[164:167]
M v[168:171], a[148:151], v[40:43], 0
ds_write_b128 v2, v[228:231] offset:1024
v_xor_b32 v97, v97, v98
M v[168:171], a[152:155], v[72:75], v[168:171]
M v[172:175], a[152:155], v[76:79], 0
ds_write_b128 v2, v[232:235] offset:2048
v_add_u32 v96, s3, v96
M v[172:175], a[148:151], v[44:47], v[172:175]
s_waitcnt lgkmcnt(7)
M v[176:179], a[156:159], v[32:35], 0
ds_write_b128 v2, v[236:239] offset:3072
v_lshlrev_b32 v96, 11, v96
M v[176:179], a[160:163], v[64:67], v[176:179]
M v[180:183], a[160:163], v[68:71], 0
ds_write_b128 v2, v[240:243] offset:4096
v_lshl_add_u32 v99, v97, 4, v96
M v[180:183], a[156:159], v[36:39], v[180:183]
v_add_u32 v100, 15360, v99
M v[184:187], a[156:159], v[40:43], 0
ds_write_b128 v2, v[244:247] offset:5120
M v[184:187], a[160:163], v[72:75], v[184:187]
s_waitcnt vmcnt(0) lgkmcnt(0)
s_barrier
M v[188:191], a[160:163], v[76:79], 0
ds_write_b128 v2, v[248:251] offset:6144
v_cmp_ne_u32 vcc, 1, v7
s_nop 0
s_cbranch_vccnz Lk3_spinb0
Lk3_gotb0:
M v[188:191], a[156:159], v[44:47], v[188:191]
s_add_u32 m0, s42, 16384
s_nop 0
buffer_load_dwordx4 v99, s[48:51], s26 offen offset:0 lds
M v[192:195], a[164:167], v[32:35], 0
ds_write_b128 v2, v[252:255] offset:7168
buffer_load_dwordx4 v100, s[48:51], s26 offen offset:1024 lds
M v[192:195], a[168:171], v[64:67], v[192:195]
M v[196:199], a[168:171], v[68:71], 0
ds_write_b128 v2, a[64:67] offset:8192
buffer_load_dwordx4 a[192:195], v1, s[44:47], s25 offen offset:0 sc1
M v[196:199], a[164:167], v[36:39], v[196:199]
buffer_load_dwordx4 a[196:199], v1, s[44:47], s25 offen offset:1024 sc1
M v[200:203], a[164:167], v[40:43], 0
ds_write_b128 v2, a[68:71] offset:9216
buffer_load_dwordx4 a[200:203], v1, s[44:47], s25 offen offset:2048 sc1
M v[200:203], a[168:171], v[72:75], v[200:203]
buffer_load_dwordx4 a[204:207], v1, s[44:47], s25 offen offset:3072 sc1
M v[204:207], a[168:171], v[76:79], 0
ds_write_b128 v2, a[72:75] offset:10240
M v[204:207], a[164:167], v[44:47], v[204:207]
s_add_u32 s25, s25, 16384
s_add_u32 s26, s26, 131072
M v[208:211], a[172:175], v[32:35], 0
ds_write_b128 v2, a[76:79] offset:11264
s_add_u32 m0, s42, 32768
s_nop 0
buffer_load_dwordx4 v99, s[48:51], s26 offen offset:0 lds
M v[208:211], a[176:179], v[64:67], v[208:211]
buffer_load_dwordx4 v100, s[48:51], s26 offen offset:1024 lds
M v[212:215], a[176:179], v[68:71], 0
ds_write_b128 v2, a[80:83] offset:12288
buffer_load_dwordx4 a[224:227], v1, s[44:47], s25 offen offset:0 sc1
M v[212:215], a[172:175], v[36:39], v[212:215]
M v[216:219], a[172:175], v[40:43], 0
ds_write_b128 v2, a[84:87] offset:13312
buffer_load_dwordx4 a[228:231], v1, s[44:47], s25 offen offset:1024 sc1
M v[216:219], a[176:179], v[72:75], v[216:219]
buffer_load_dwordx4 a[232:235], v1, s[44:47], s25 offen offset:2048 sc1
M v[220:223], a[176:179], v[76:79], 0
ds_write_b128 v2, a[88:91] offset:14336
buffer_load_dwordx4 a[236:239], v1, s[44:47], s25 offen offset:3072 sc1
M v[220:223], a[172:175], v[44:47], v[220:223]
s_add_u32 s25, s25, 16384
s_add_u32 s26, s26, 131072
ds_write_b128 v2, a[92:95] offset:15360
s_waitcnt lgkmcnt(0)
s_branch Lk2_merge
Lk2_b0:
s_add_u32 m0, s29, 65536
s_waitcnt lgkmcnt(4)
M v[96:99], a[116:119], a[180:183], 0
v_exp_f32 v64, v64
M v[96:99], a[120:123], a[184:187], v[96:99]
ds_read_b128 a[148:151], v2 offset:8192
ds_read_b128 a[152:155], v2 offset:9216
M v[96:99], a[124:127], a[188:191], v[96:99]
v_exp_f32 v65, v65
M v[96:99], a[128:131], a[192:195], v[96:99]
buffer_load_dwordx4 v1, s[12:15], s25 offen offset:0 sc1 lds
s_add_u32 s32, s25, 4096
M v[100:103], a[128:131], a[208:211], 0
v_exp_f32 v66, v66
M v[100:103], a[124:127], a[204:207], v[100:103]
v_cvt_pk_bf16_f32 v64, v64, v65
M v[100:103], a[120:123], a[200:203], v[100:103]
v_exp_f32 v67, v67
M v[100:103], a[116:119], a[196:199], v[100:103]
buffer_load_dwordx4 v1, s[12:15], s25 offen offset:1024 sc1 lds
M v[104:107], a[116:119], a[212:215], 0
v_exp_f32 v80, v80
M v[104:107], a[120:123], a[216:219], v[104:107]
ds_read_b128 a[156:159], v2 offset:10240
ds_read_b128 a[160:163], v2 offset:11264
M v[104:107], a[124:127], a[220:223], v[104:107]
v_exp_f32 v81, v81
M v[104:107], a[128:131], a[224:227], v[104:107]
buffer_load_dwordx4 v1, s[12:15], s25 offen offset:2048 sc1 lds
M v[108:111], a[128:131], a[240:243], 0
v_exp_f32 v82, v82
M v[108:111], a[124:127], a[236:239], v[108:111]
v_cvt_pk_bf16_f32 v65, v66, v67
v_cvt_pk_bf16_f32 v66, v80, v81
M v[108:111], a[120:123], a[232:235], v[108:111]
v_exp_f32 v83, v83
M v[108:111], a[116:119], a[228:231], v[108:111]
buffer_load_dwordx4 v1, s[12:15], s25 offen offset:3072 sc1 lds
s_add_u32 m0, s29, 69632
s_waitcnt lgkmcnt(4)
M v[112:115], a[132:135], a[180:183], 0
v_exp_f32 v68, v68
M v[112:115], a[136:139], a[184:187], v[112:115]
ds_read_b128 a[164:167], v2 offset:12288
ds_read_b128 a[168:171], v2 offset:13312
M v[112:115], a[140:143], a[188:191], v[112:115]
v_exp_f32 v69, v69
M v[112:115], a[144:147], a[192:195], v[112:115]
buffer_load_dwordx4 v1, s[12:15], s32 offen offset:0 sc1 lds
M v[116:119], a[144:147], a[208:211], 0
v_exp_f32 v70, v70
M v[116:119], a[140:143], a[204:207], v[116:119]
v_cvt_pk_bf16_f32 v67, v82, v83
v_cvt_pk_bf16_f32 v68, v68, v69
M v[116:119], a[136:139], a[200:203], v[116:119]
v_exp_f32 v71, v71
M v[116:119], a[132:135], a[196:199], v[116:119]
buffer_load_dwordx4 v1, s[12:15], s32 offen offset:1024 sc1 lds
M v[120:123], a[132:135], a[212:215], 0
v_exp_f32 v84, v84
M v[120:123], a[136:139], a[216:219], v[120:123]
ds_read_b128 a[172:175], v2 offset:14336
ds_read_b128 a[176:179], v2 offset:15360
M v[120:123], a[140:143], a[220:223], v[120:123]
v_exp_f32 v85, v85
M v[120:123], a[144:147], a[224:227], v[120:123]
buffer_load_dwordx4 v1, s[12:15], s32 offen offset:2048 sc1 lds
M v[124:127], a[144:147], a[240:243], 0
v_exp_f32 v86, v86
M v[124:127], a[140:143], a[236:239], v[124:127]
v_cvt_pk_bf16_f32 v69, v70, v71
v_cvt_pk_bf16_f32 v70, v84, v85
M v[124:127], a[136:139], a[232:235], v[124:127]
v_exp_f32 v87, v87
M v[124:127], a[132:135], a[228:231], v[124:127]
buffer_load_dwordx4 v1, s[12:15], s32 offen offset:3072 sc1 lds
s_add_u32 m0, s29, 98304
s_waitcnt lgkmcnt(4)
M v[128:131], a[148:151], a[180:183], 0
v_exp_f32 v72, v72
M v[128:131], a[152:155], a[184:187], v[128:131]
ds_read_b128 a[116:119], v5 offset:32768
ds_read_b128 a[120:123], v5 offset:40960
M v[128:131], a[156:159], a[188:191], v[128:131]
v_exp_f32 v73, v73
M v[128:131], a[160:163], a[192:195], v[128:131]
buffer_load_dwordx4 v1, s[12:15], s26 offen offset:0 sc1 lds
s_add_u32 s43, s26, 4096
M v[132:135], a[160:163], a[208:211], 0
v_exp_f32 v74, v74
M v[132:135], a[156:159], a[204:207], v[132:135]
v_cvt_pk_bf16_f32 v71, v86, v87
v_cvt_pk_bf16_f32 v72, v72, v73
M v[132:135], a[152:155], a[200:203], v[132:135]
v_exp_f32 v75, v75
M v[132:135], a[148:151], a[196:199], v[132:135]
buffer_load_dwordx4 v1, s[12:15], s26 offen offset:1024 sc1 lds
M v[136:139], a[148:151], a[212:215], 0
v_exp_f32 v88, v88
M v[136:139], a[152:155], a[216:219], v[136:139]
ds_read_b128 a[124:127], v5 offset:33792
ds_read_b128 a[128:131], v5 offset:41984
M v[136:139], a[156:159], a[220:223], v[136:139]
v_exp_f32 v89, v89
M v[136:139], a[160:163], a[224:227], v[136:139]
buffer_load_dwordx4 v1, s[12:15], s26 offen offset:2048 sc1 lds
M v[140:143], a[160:163], a[240:243], 0
v_exp_f32 v90, v90
M v[140:143], a[156:159], a[236:239], v[140:143]
v_cvt_pk_bf16_f32 v73, v74, v75
v_cvt_pk_bf16_f32 v74, v88, v89
M v[140:143], a[152:155], a[232:235], v[140:143]
v_exp_f32 v91, v91
M v[140:143], a[148:151], a[228:231], v[140:143]
buffer_load_dwordx4 v1, s[12:15], s26 offen offset:3072 sc1 lds
s_add_u32 m0, s29, 102400
s_waitcnt lgkmcnt(4)
M v[144:147], a[164:167], a[180:183], 0
v_exp_f32 v76, v76
M v[144:147], a[168:171], a[184:187], v[144:147]
ds_read_b128 a[132:135], v5 offset:34816
ds_read_b128 a[136:139], v5 offset:43008
M v[144:147], a[172:175], a[188:191], v[144:147]
v_exp_f32 v77, v77
M v[144:147], a[176:179], a[192:195], v[144:147]
buffer_load_dwordx4 v1, s[12:15], s43 offen offset:0 sc1 lds
M v[148:151], a[176:179], a[208:211], 0
v_exp_f32 v78, v78
M v[148:151], a[172:175], a[204:207], v[148:151]
v_cvt_pk_bf16_f32 v75, v90, v91
v_cvt_pk_bf16_f32 v76, v76, v77
M v[148:151], a[168:171], a[200:203], v[148:151]
v_exp_f32 v79, v79
M v[148:151], a[164:167], a[196:199], v[148:151]
buffer_load_dwordx4 v1, s[12:15], s43 offen offset:1024 sc1 lds
M v[152:155], a[164:167], a[212:215], 0
v_exp_f32 v92, v92
M v[152:155], a[168:171], a[216:219], v[152:155]
ds_read_b128 a[140:143], v5 offset:35840
ds_read_b128 a[144:147], v5 offset:44032
M v[152:155], a[172:175], a[220:223], v[152:155]
v_exp_f32 v93, v93
M v[152:155], a[176:179], a[224:227], v[152:155]
buffer_load_dwordx4 v1, s[12:15], s43 offen offset:2048 sc1 lds
M v[156:159], a[176:179], a[240:243], 0
v_exp_f32 v94, v94
M v[156:159], a[172:175], a[236:239], v[156:159]
v_cvt_pk_bf16_f32 v77, v78, v79
v_cvt_pk_bf16_f32 v78, v92, v93
M v[156:159], a[168:171], a[232:235], v[156:159]
v_exp_f32 v95, v95
M v[156:159], a[164:167], a[228:231], v[156:159]
buffer_load_dwordx4 v1, s[12:15], s43 offen offset:3072 sc1 lds
v_cvt_pk_bf16_f32 v79, v94, v95
s_waitcnt lgkmcnt(6)
M v[160:163], a[116:119], v[32:35], 0
v_exp_f32 v96, v96
M v[160:163], a[120:123], v[64:67], v[160:163]
ds_read_b128 a[148:151], v5 offset:36864
ds_read_b128 a[152:155], v5 offset:45056
M v[164:167], a[120:123], v[68:71], 0
v_exp_f32 v97, v97
M v[164:167], a[116:119], v[36:39], v[164:167]
v_cvt_pk_bf16_f32 v96, v96, v97
M v[168:171], a[116:119], v[40:43], 0
v_exp_f32 v98, v98
M v[168:171], a[120:123], v[72:75], v[168:171]
s_add_u32 s25, s25, 32768
s_cmp_eq_u32 s25, s27
M v[172:175], a[120:123], v[76:79], 0
v_exp_f32 v99, v99
M v[172:175], a[116:119], v[44:47], v[172:175]
v_cvt_pk_bf16_f32 v97, v98, v99
s_waitcnt lgkmcnt(6)
M a[96:99], a[112:115], v[32:35], 0
s_cselect_b32 s25, s28, s25
s_cselect_b32 s27, -1, s27
M a[96:99], a[112:115], v[64:67], a[96:99]
s_add_u32 s26, s26, 32768
s_cmp_eq_u32 s26, s62
M v[176:179], a[124:127], v[32:35], 0
v_exp_f32 v112, v112
M v[176:179], a[128:131], v[64:67], v[176:179]
ds_read_b128 a[156:159], v5 offset:37888
ds_read_b128 a[160:163], v5 offset:46080
M v[180:183], a[128:131], v[68:71], 0
v_exp_f32 v113, v113
M v[180:183], a[124:127], v[36:39], v[180:183]
v_cvt_pk_bf16_f32 v98, v112, v113
M v[184:187], a[124:127], v[40:43], 0
v_exp_f32 v114, v114
M v[184:187], a[128:131], v[72:75], v[184:187]
s_cselect_b32 s26, s63, s26
s_cselect_b32 s62, -1, s62
M v[188:191], a[128:131], v[76:79], 0
v_exp_f32 v115, v115
M v[188:191], a[124:127], v[44:47], v[188:191]
v_cvt_pk_bf16_f32 v99, v114, v115
s_waitcnt lgkmcnt(6)
M a[100:103], a[112:115], v[36:39], 0
M a[100:103], a[112:115], v[68:71], a[100:103]
M v[192:195], a[132:135], v[32:35], 0
v_exp_f32 v100, v100
M v[192:195], a[136:139], v[64:67], v[192:195]
ds_read_b128 a[164:167], v5 offset:38912
ds_read_b128 a[168:171], v5 offset:47104
M v[196:199], a[136:139], v[68:71], 0
v_exp_f32 v101, v101
M v[196:199], a[132:135], v[36:39], v[196:199]
v_cvt_pk_bf16_f32 v100, v100, v101
M v[200:203], a[132:135], v[40:43], 0
v_exp_f32 v102, v102
M v[200:203], a[136:139], v[72:75], v[200:203]
M v[204:207], a[136:139], v[76:79], 0
v_exp_f32 v103, v103
M v[204:207], a[132:135], v[44:47], v[204:207]
v_cvt_pk_bf16_f32 v101, v102, v103
s_waitcnt lgkmcnt(6)
M a[104:107], a[112:115], v[40:43], 0
M a[104:107], a[112:115], v[72:75], a[104:107]
M v[208:211], a[140:143], v[32:35], 0
v_exp_f32 v116, v116
M v[208:211], a[144:147], v[64:67], v[208:211]
ds_read_b128 a[172:175], v5 offset:39936
ds_read_b128 a[176:179], v5 offset:48128
M v[212:215], a[144:147], v[68:71], 0
v_exp_f32 v117, v117
M v[212:215], a[140:143], v[36:39], v[212:215]
v_cvt_pk_bf16_f32 v102, v116, v117
M v[216:219], a[140:143], v[40:43], 0
v_exp_f32 v118, v118
M v[216:219], a[144:147], v[72:75], v[216:219]
M v[220:223], a[144:147], v[76:79], 0
v_exp_f32 v119, v119
M v[220:223], a[140:143], v[44:47], v[220:223]
v_cvt_pk_bf16_f32 v103, v118, v119
s_waitcnt lgkmcnt(6)
M a[108:111], a[112:115], v[44:47], 0
M a[108:111], a[112:115], v[76:79], a[108:111]
M v[224:227], a[148:151], v[32:35], 0
v_exp_f32 v104, v104
M v[224:227], a[152:155], v[64:67], v[224:227]
M v[228:231], a[152:155], v[68:71], 0
v_exp_f32 v105, v105
M v[228:231], a[148:151], v[36:39], v[228:231]
v_cvt_pk_bf16_f32 v104, v104, v105
M v[232:235], a[148:151], v[40:43], 0
v_exp_f32 v106, v106
M v[232:235], a[152:155], v[72:75], v[232:235]
M v[236:239], a[152:155], v[76:79], 0
v_exp_f32 v107, v107
M v[236:239], a[148:151], v[44:47], v[236:239]
v_cvt_pk_bf16_f32 v105, v106, v107
s_waitcnt lgkmcnt(4)
M v[240:243], a[156:159], v[32:35], 0
v_exp_f32 v120, v120
M v[240:243], a[160:163], v[64:67], v[240:243]
M v[244:247], a[160:163], v[68:71], 0
v_exp_f32 v121, v121
M v[244:247], a[156:159], v[36:39], v[244:247]
v_cvt_pk_bf16_f32 v106, v120, v121
M v[248:251], a[156:159], v[40:43], 0
v_exp_f32 v122, v122
M v[248:251], a[160:163], v[72:75], v[248:251]
s_waitcnt vmcnt(0) lgkmcnt(0)
s_barrier
ds_read_b128 a[116:119], v3 offset:0
ds_read_b128 a[120:123], v3 offset:1024
M v[252:255], a[160:163], v[76:79], 0
v_exp_f32 v123, v123
M v[252:255], a[156:159], v[44:47], v[252:255]
v_cvt_pk_bf16_f32 v107, v122, v123
M a[64:67], a[164:167], v[32:35], 0
v_exp_f32 v108, v108
M a[64:67], a[168:171], v[64:67], a[64:67]
ds_read_b128 a[124:127], v3 offset:2048
ds_read_b128 a[128:131], v3 offset:3072
M a[68:71], a[168:171], v[68:71], 0
v_exp_f32 v109, v109
M a[68:71], a[164:167], v[36:39], a[68:71]
v_cvt_pk_bf16_f32 v108, v108, v109
M a[72:75], a[164:167], v[40:43], 0
v_exp_f32 v110, v110
M a[72:75], a[168:171], v[72:75], a[72:75]
ds_read_b128 a[132:135], v3 offset:4096
ds_read_b128 a[136:139], v3 offset:5120
M a[76:79], a[168:171], v[76:79], 0
v_exp_f32 v111, v111
M a[76:79], a[164:167], v[44:47], a[76:79]
v_cvt_pk_bf16_f32 v109, v110, v111
M a[80:83], a[172:175], v[32:35], 0
v_exp_f32 v124, v124
M a[80:83], a[176:179], v[64:67], a[80:83]
ds_read_b128 a[140:143], v3 offset:6144
ds_read_b128 a[144:147], v3 offset:7168
M a[84:87], a[176:179], v[68:71], 0
v_exp_f32 v125, v125
M a[84:87], a[172:175], v[36:39], a[84:87]
v_cvt_pk_bf16_f32 v110, v124, v125
M a[88:91], a[172:175], v[40:43], 0
v_exp_f32 v126, v126
M a[88:91], a[176:179], v[72:75], a[88:91]
M a[92:95], a[176:179], v[76:79], 0
v_exp_f32 v127, v127
M a[92:95], a[172:175], v[44:47], a[92:95]
v_cvt_pk_bf16_f32 v111, v126, v127
s_branch Lk2_l2b
Lk2_l2:
s_add_u32 m0, s29, 65536
s_waitcnt lgkmcnt(4)
M v[96:99], a[116:119], a[180:183], 0
v_exp_f32 v64, v64
M v[96:99], a[120:123], a[184:187], v[96:99]
ds_read_b128 a[148:151], v2 offset:8192
ds_read_b128 a[152:155], v2 offset:9216
M v[96:99], a[124:127], a[188:191], v[96:99]
v_exp_f32 v65, v65
M v[96:99], a[128:131], a[192:195], v[96:99]
buffer_load_dwordx4 v1, s[12:15], s25 offen offset:0 sc1 lds
s_add_u32 s32, s25, 4096
M v[100:103], a[128:131], a[208:211], 0
v_exp_f32 v66, v66
M v[100:103], a[124:127], a[204:207], v[100:103]
v_cvt_pk_bf16_f32 v64, v64, v65
M v[100:103], a[120:123], a[200:203], v[100:103]
v_exp_f32 v67, v67
M v[100:103], a[116:119], a[196:199], v[100:103]
buffer_load_dwordx4 v1, s[12:15], s25 offen offset:1024 sc1 lds
M v[104:107], a[116:119], a[212:215], 0
v_exp_f32 v80, v80
M v[104:107], a[120:123], a[216:219], v[104:107]
ds_read_b128 a[156:159], v2 offset:10240
ds_read_b128 a[160:163], v2 offset:11264
M v[104:107], a[124:127], a[220:223], v[104:107]
v_exp_f32 v81, v81
M v[104:107], a[128:131], a[224:227], v[104:107]
buffer_load_dwordx4 v1, s[12:15], s25 offen offset:2048 sc1 lds
M v[108:111], a[128:131], a[240:243], 0
v_exp_f32 v82, v82
M v[108:111], a[124:127], a[236:239], v[108:111]
v_cvt_pk_bf16_f32 v65, v66, v67
v_cvt_pk_bf16_f32 v66, v80, v81
M v[108:111], a[120:123], a[232:235], v[108:111]
v_exp_f32 v83, v83
M v[108:111], a[116:119], a[228:231], v[108:111]
buffer_load_dwordx4 v1, s[12:15], s25 offen offset:3072 sc1 lds
s_add_u32 m0, s29, 69632
s_waitcnt lgkmcnt(4)
M v[112:115], a[132:135], a[180:183], 0
v_exp_f32 v68, v68
M v[112:115], a[136:139], a[184:187], v[112:115]
ds_read_b128 a[164:167], v2 offset:12288
ds_read_b128 a[168:171], v2 offset:13312
M v[112:115], a[140:143], a[188:191], v[112:115]
v_exp_f32 v69, v69
M v[112:115], a[144:147], a[192:195], v[112:115]
buffer_load_dwordx4 v1, s[12:15], s32 offen offset:0 sc1 lds
M v[116:119], a[144:147], a[208:211], 0
v_exp_f32 v70, v70
M v[116:119], a[140:143], a[204:207], v[116:119]
v_cvt_pk_bf16_f32 v67, v82, v83
v_cvt_pk_bf16_f32 v68, v68, v69
M v[116:119], a[136:139], a[200:203], v[116:119]
v_exp_f32 v71, v71
M v[116:119], a[132:135], a[196:199], v[116:119]
buffer_load_dwordx4 v1, s[12:15], s32 offen offset:1024 sc1 lds
M v[120:123], a[132:135], a[212:215], 0
v_exp_f32 v84, v84
M v[120:123], a[136:139], a[216:219], v[120:123]
ds_read_b128 a[172:175], v2 offset:14336
ds_read_b128 a[176:179], v2 offset:15360
M v[120:123], a[140:143], a[220:223], v[120:123]
v_exp_f32 v85, v85
M v[120:123], a[144:147], a[224:227], v[120:123]
buffer_load_dwordx4 v1, s[12:15], s32 offen offset:2048 sc1 lds
M v[124:127], a[144:147], a[240:243], 0
v_exp_f32 v86, v86
M v[124:127], a[140:143], a[236:239], v[124:127]
v_cvt_pk_bf16_f32 v69, v70, v71
v_cvt_pk_bf16_f32 v70, v84, v85
M v[124:127], a[136:139], a[232:235], v[124:127]
v_exp_f32 v87, v87
M v[124:127], a[132:135], a[228:231], v[124:127]
buffer_load_dwordx4 v1, s[12:15], s32 offen offset:3072 sc1 lds
s_add_u32 m0, s29, 98304
s_waitcnt lgkmcnt(4)
M v[128:131], a[148:151], a[180:183], 0
v_exp_f32 v72, v72
M v[128:131], a[152:155], a[184:187], v[128:131]
ds_read_b128 a[116:119], v5 offset:32768
ds_read_b128 a[120:123], v5 offset:40960
M v[128:131], a[156:159], a[188:191], v[128:131]
v_exp_f32 v73, v73
M v[128:131], a[160:163], a[192:195], v[128:131]
buffer_load_dwordx4 v1, s[12:15], s26 offen offset:0 sc1 lds
s_add_u32 s43, s26, 4096
M v[132:135], a[160:163], a[208:211], 0
v_exp_f32 v74, v74
M v[132:135], a[156:159], a[204:207], v[132:135]
v_cvt_pk_bf16_f32 v71, v86, v87
v_cvt_pk_bf16_f32 v72, v72, v73
M v[132:135], a[152:155], a[200:203], v[132:135]
v_exp_f32 v75, v75
M v[132:135], a[148:151], a[196:199], v[132:135]
buffer_load_dwordx4 v1, s[12:15], s26 offen offset:1024 sc1 lds
M v[136:139], a[148:151], a[212:215], 0
v_exp_f32 v88, v88
M v[136:139], a[152:155], a[216:219], v[136:139]
ds_read_b128 a[124:127], v5 offset:33792
ds_read_b128 a[128:131], v5 offset:41984
M v[136:139], a[156:159], a[220:223], v[136:139]
v_exp_f32 v89, v89
M v[136:139], a[160:163], a[224:227], v[136:139]
buffer_load_dwordx4 v1, s[12:15], s26 offen offset:2048 sc1 lds
M v[140:143], a[160:163], a[240:243], 0
v_exp_f32 v90, v90
M v[140:143], a[156:159], a[236:239], v[140:143]
v_cvt_pk_bf16_f32 v73, v74, v75
v_cvt_pk_bf16_f32 v74, v88, v89
M v[140:143], a[152:155], a[232:235], v[140:143]
v_exp_f32 v91, v91
M v[140:143], a[148:151], a[228:231], v[140:143]
buffer_load_dwordx4 v1, s[12:15], s26 offen offset:3072 sc1 lds
s_add_u32 m0, s29, 102400
s_waitcnt lgkmcnt(4)
M v[144:147], a[164:167], a[180:183], 0
v_exp_f32 v76, v76
M v[144:147], a[168:171], a[184:187], v[144:147]
ds_read_b128 a[132:135], v5 offset:34816
ds_read_b128 a[136:139], v5 offset:43008
M v[144:147], a[172:175], a[188:191], v[144:147]
v_exp_f32 v77, v77
M v[144:147], a[176:179], a[192:195], v[144:147]
buffer_load_dwordx4 v1, s[12:15], s43 offen offset:0 sc1 lds
M v[148:151], a[176:179], a[208:211], 0
v_exp_f32 v78, v78
M v[148:151], a[172:175], a[204:207], v[148:151]
v_cvt_pk_bf16_f32 v75, v90, v91
v_cvt_pk_bf16_f32 v76, v76, v77
M v[148:151], a[168:171], a[200:203], v[148:151]
v_exp_f32 v79, v79
M v[148:151], a[164:167], a[196:199], v[148:151]
buffer_load_dwordx4 v1, s[12:15], s43 offen offset:1024 sc1 lds
M v[152:155], a[164:167], a[212:215], 0
v_exp_f32 v92, v92
M v[152:155], a[168:171], a[216:219], v[152:155]
ds_read_b128 a[140:143], v5 offset:35840
ds_read_b128 a[144:147], v5 offset:44032
M v[152:155], a[172:175], a[220:223], v[152:155]
v_exp_f32 v93, v93
M v[152:155], a[176:179], a[224:227], v[152:155]
buffer_load_dwordx4 v1, s[12:15], s43 offen offset:2048 sc1 lds
M v[156:159], a[176:179], a[240:243], 0
v_exp_f32 v94, v94
M v[156:159], a[172:175], a[236:239], v[156:159]
v_cvt_pk_bf16_f32 v77, v78, v79
v_cvt_pk_bf16_f32 v78, v92, v93
M v[156:159], a[168:171], a[232:235], v[156:159]
v_exp_f32 v95, v95
M v[156:159], a[164:167], a[228:231], v[156:159]
buffer_load_dwordx4 v1, s[12:15], s43 offen offset:3072 sc1 lds
v_cvt_pk_bf16_f32 v79, v94, v95
s_waitcnt lgkmcnt(6)
M v[160:163], a[116:119], v[32:35], v[160:163]
v_exp_f32 v96, v96
M v[160:163], a[120:123], v[64:67], v[160:163]
ds_read_b128 a[148:151], v5 offset:36864
ds_read_b128 a[152:155], v5 offset:45056
M v[164:167], a[120:123], v[68:71], v[164:167]
v_exp_f32 v97, v97
M v[164:167], a[116:119], v[36:39], v[164:167]
v_cvt_pk_bf16_f32 v96, v96, v97
M v[168:171], a[116:119], v[40:43], v[168:171]
v_exp_f32 v98, v98
M v[168:171], a[120:123], v[72:75], v[168:171]
s_add_u32 s25, s25, 32768
s_cmp_eq_u32 s25, s27
M v[172:175], a[120:123], v[76:79], v[172:175]
v_exp_f32 v99, v99
M v[172:175], a[116:119], v[44:47], v[172:175]
v_cvt_pk_bf16_f32 v97, v98, v99
s_waitcnt lgkmcnt(6)
M a[96:99], a[112:115], v[32:35], a[96:99]
s_cselect_b32 s25, s28, s25
s_cselect_b32 s27, -1, s27
M a[96:99], a[112:115], v[64:67], a[96:99]
s_add_u32 s26, s26, 32768
s_cmp_eq_u32 s26, s62
M v[176:179], a[124:127], v[32:35], v[176:179]
v_exp_f32 v112, v112
M v[176:179], a[128:131], v[64:67], v[176:179]
ds_read_b128 a[156:159], v5 offset:37888
ds_read_b128 a[160:163], v5 offset:46080
M v[180:183], a[128:131], v[68:71], v[180:183]
v_exp_f32 v113, v113
M v[180:183], a[124:127], v[36:39], v[180:183]
v_cvt_pk_bf16_f32 v98, v112, v113
M v[184:187], a[124:127], v[40:43], v[184:187]
v_exp_f32 v114, v114
M v[184:187], a[128:131], v[72:75], v[184:187]
s_cselect_b32 s26, s63, s26
s_cselect_b32 s62, -1, s62
M v[188:191], a[128:131], v[76:79], v[188:191]
v_exp_f32 v115, v115
M v[188:191], a[124:127], v[44:47], v[188:191]
v_cvt_pk_bf16_f32 v99, v114, v115
s_waitcnt lgkmcnt(6)
M a[100:103], a[112:115], v[36:39], a[100:103]
M a[100:103], a[112:115], v[68:71], a[100:103]
M v[192:195], a[132:135], v[32:35], v[192:195]
v_exp_f32 v100, v100
M v[192:195], a[136:139], v[64:67], v[192:195]
ds_read_b128 a[164:167], v5 offset:38912
ds_read_b128 a[168:171], v5 offset:47104
M v[196:199], a[136:139], v[68:71], v[196:199]
v_exp_f32 v101, v101
M v[196:199], a[132:135], v[36:39], v[196:199]
v_cvt_pk_bf16_f32 v100, v100, v101
M v[200:203], a[132:135], v[40:43], v[200:203]
v_exp_f32 v102, v102
M v[200:203], a[136:139], v[72:75], v[200:203]
M v[204:207], a[136:139], v[76:79], v[204:207]
v_exp_f32 v103, v103
M v[204:207], a[132:135], v[44:47], v[204:207]
v_cvt_pk_bf16_f32 v101, v102, v103
s_waitcnt lgkmcnt(6)
M a[104:107], a[112:115], v[40:43], a[104:107]
M a[104:107], a[112:115], v[72:75], a[104:107]
M v[208:211], a[140:143], v[32:35], v[208:211]
v_exp_f32 v116, v116
M v[208:211], a[144:147], v[64:67], v[208:211]
ds_read_b128 a[172:175], v5 offset:39936
ds_read_b128 a[176:179], v5 offset:48128
M v[212:215], a[144:147], v[68:71], v[212:215]
v_exp_f32 v117, v117
M v[212:215], a[140:143], v[36:39], v[212:215]
v_cvt_pk_bf16_f32 v102, v116, v117
M v[216:219], a[140:143], v[40:43], v[216:219]
v_exp_f32 v118, v118
M v[216:219], a[144:147], v[72:75], v[216:219]
M v[220:223], a[144:147], v[76:79], v[220:223]
v_exp_f32 v119, v119
M v[220:223], a[140:143], v[44:47], v[220:223]
v_cvt_pk_bf16_f32 v103, v118, v119
s_waitcnt lgkmcnt(6)
M a[108:111], a[112:115], v[44:47], a[108:111]
M a[108:111], a[112:115], v[76:79], a[108:111]
M v[224:227], a[148:151], v[32:35], v[224:227]
v_exp_f32 v104, v104
M v[224:227], a[152:155], v[64:67], v[224:227]
M v[228:231], a[152:155], v[68:71], v[228:231]
v_exp_f32 v105, v105
M v[228:231], a[148:151], v[36:39], v[228:231]
v_cvt_pk_bf16_f32 v104, v104, v105
M v[232:235], a[148:151], v[40:43], v[232:235]
v_exp_f32 v106, v106
M v[232:235], a[152:155], v[72:75], v[232:235]
M v[236:239], a[152:155], v[76:79], v[236:239]
v_exp_f32 v107, v107
M v[236:239], a[148:151], v[44:47], v[236:239]
v_cvt_pk_bf16_f32 v105, v106, v107
s_waitcnt lgkmcnt(4)
M v[240:243], a[156:159], v[32:35], v[240:243]
v_exp_f32 v120, v120
M v[240:243], a[160:163], v[64:67], v[240:243]
M v[244:247], a[160:163], v[68:71], v[244:247]
v_exp_f32 v121, v121
M v[244:247], a[156:159], v[36:39], v[244:247]
v_cvt_pk_bf16_f32 v106, v120, v121
M v[248:251], a[156:159], v[40:43], v[248:251]
v_exp_f32 v122, v122
M v[248:251], a[160:163], v[72:75], v[248:251]
s_waitcnt vmcnt(0) lgkmcnt(0)
s_barrier
ds_read_b128 a[116:119], v3 offset:0
ds_read_b128 a[120:123], v3 offset:1024
M v[252:255], a[160:163], v[76:79], v[252:255]
v_exp_f32 v123, v123
M v[252:255], a[156:159], v[44:47], v[252:255]
v_cvt_pk_bf16_f32 v107, v122, v123
M a[64:67], a[164:167], v[32:35], a[64:67]
v_exp_f32 v108, v108
M a[64:67], a[168:171], v[64:67], a[64:67]
ds_read_b128 a[124:127], v3 offset:2048
ds_read_b128 a[128:131], v3 offset:3072
M a[68:71], a[168:171], v[68:71], a[68:71]
v_exp_f32 v109, v109
M a[68:71], a[164:167], v[36:39], a[68:71]
v_cvt_pk_bf16_f32 v108, v108, v109
M a[72:75], a[164:167], v[40:43], a[72:75]
v_exp_f32 v110, v110
M a[72:75], a[168:171], v[72:75], a[72:75]
ds_read_b128 a[132:135], v3 offset:4096
ds_read_b128 a[136:139], v3 offset:5120
M a[76:79], a[168:171], v[76:79], a[76:79]
v_exp_f32 v111, v111
M a[76:79], a[164:167], v[44:47], a[76:79]
v_cvt_pk_bf16_f32 v109, v110, v111
M a[80:83], a[172:175], v[32:35], a[80:83]
v_exp_f32 v124, v124
M a[80:83], a[176:179], v[64:67], a[80:83]
ds_read_b128 a[140:143], v3 offset:6144
ds_read_b128 a[144:147], v3 offset:7168
M a[84:87], a[176:179], v[68:71], a[84:87]
v_exp_f32 v125, v125
M a[84:87], a[172:175], v[36:39], a[84:87]
v_cvt_pk_bf16_f32 v110, v124, v125
M a[88:91], a[172:175], v[40:43], a[88:91]
v_exp_f32 v126, v126
M a[88:91], a[176:179], v[72:75], a[88:91]
M a[92:95], a[176:179], v[76:79], a[92:95]
v_exp_f32 v127, v127
M a[92:95], a[172:175], v[44:47], a[92:95]
v_cvt_pk_bf16_f32 v111, v126, v127
Lk2_l2b:
s_add_u32 m0, s29, 0
s_waitcnt lgkmcnt(4)
M v[32:35], a[116:119], a[180:183], 0
v_exp_f32 v128, v128
M v[32:35], a[120:123], a[184:187], v[32:35]
ds_read_b128 a[148:151], v3 offset:8192
ds_read_b128 a[152:155], v3 offset:9216
M v[32:35], a[124:127], a[188:191], v[32:35]
v_exp_f32 v129, v129
M v[32:35], a[128:131], a[192:195], v[32:35]
buffer_load_dwordx4 v1, s[12:15], s25 offen offset:0 sc1 lds
s_add_u32 s32, s25, 4096
M v[36:39], a[128:131], a[208:211], 0
v_exp_f32 v130, v130
M v[36:39], a[124:127], a[204:207], v[36:39]
v_cvt_pk_bf16_f32 v128, v128, v129
M v[36:39], a[120:123], a[200:203], v[36:39]
v_exp_f32 v131, v131
M v[36:39], a[116:119], a[196:199], v[36:39]
buffer_load_dwordx4 v1, s[12:15], s25 offen offset:1024 sc1 lds
M v[40:43], a[116:119], a[212:215], 0
v_exp_f32 v144, v144
M v[40:43], a[120:123], a[216:219], v[40:43]
ds_read_b128 a[156:159], v3 offset:10240
ds_read_b128 a[160:163], v3 offset:11264
M v[40:43], a[124:127], a[220:223], v[40:43]
v_exp_f32 v145, v145
M v[40:43], a[128:131], a[224:227], v[40:43]
buffer_load_dwordx4 v1, s[12:15], s25 offen offset:2048 sc1 lds
M v[44:47], a[128:131], a[240:243], 0
v_exp_f32 v146, v146
M v[44:47], a[124:127], a[236:239], v[44:47]
v_cvt_pk_bf16_f32 v129, v130, v131
v_cvt_pk_bf16_f32 v130, v144, v145
M v[44:47], a[120:123], a[232:235], v[44:47]
v_exp_f32 v147, v147
M v[44:47], a[116:119], a[228:231], v[44:47]
buffer_load_dwordx4 v1, s[12:15], s25 offen offset:3072 sc1 lds
s_add_u32 m0, s29, 4096
s_waitcnt lgkmcnt(4)
M v[48:51], a[132:135], a[180:183], 0
v_exp_f32 v132, v132
M v[48:51], a[136:139], a[184:187], v[48:51]
ds_read_b128 a[164:167], v3 offset:12288
ds_read_b128 a[168:171], v3 offset:13312
M v[48:51], a[140:143], a[188:191], v[48:51]
v_exp_f32 v133, v133
M v[48:51], a[144:147], a[192:195], v[48:51]
buffer_load_dwordx4 v1, s[12:15], s32 offen offset:0 sc1 lds
M v[52:55], a[144:147], a[208:211], 0
v_exp_f32 v134, v134
M v[52:55], a[140:143], a[204:207], v[52:55]
v_cvt_pk_bf16_f32 v131, v146, v147
v_cvt_pk_bf16_f32 v132, v132, v133
M v[52:55], a[136:139], a[200:203], v[52:55]
v_exp_f32 v135, v135
M v[52:55], a[132:135], a[196:199], v[52:55]
buffer_load_dwordx4 v1, s[12:15], s32 offen offset:1024 sc1 lds
M v[56:59], a[132:135], a[212:215], 0
v_exp_f32 v148, v148
M v[56:59], a[136:139], a[216:219], v[56:59]
ds_read_b128 a[172:175], v3 offset:14336
ds_read_b128 a[176:179], v3 offset:15360
M v[56:59], a[140:143], a[220:223], v[56:59]
v_exp_f32 v149, v149
M v[56:59], a[144:147], a[224:227], v[56:59]
buffer_load_dwordx4 v1, s[12:15], s32 offen offset:2048 sc1 lds
M v[60:63], a[144:147], a[240:243], 0
v_exp_f32 v150, v150
M v[60:63], a[140:143], a[236:239], v[60:63]
v_cvt_pk_bf16_f32 v133, v134, v135
v_cvt_pk_bf16_f32 v134, v148, v149
M v[60:63], a[136:139], a[232:235], v[60:63]
v_exp_f32 v151, v151
M v[60:63], a[132:135], a[228:231], v[60:63]
buffer_load_dwordx4 v1, s[12:15], s32 offen offset:3072 sc1 lds
s_add_u32 m0, s29, 32768
s_waitcnt lgkmcnt(4)
M v[64:67], a[148:151], a[180:183], 0
v_exp_f32 v136, v136
M v[64:67], a[152:155], a[184:187], v[64:67]
ds_read_b128 a[116:119], v6 offset:32768
ds_read_b128 a[120:123], v6 offset:40960
M v[64:67], a[156:159], a[188:191], v[64:67]
v_exp_f32 v137, v137
M v[64:67], a[160:163], a[192:195], v[64:67]
buffer_load_dwordx4 v1, s[12:15], s26 offen offset:0 sc1 lds
s_add_u32 s43, s26, 4096
M v[68:71], a[160:163], a[208:211], 0
v_exp_f32 v138, v138
M v[68:71], a[156:159], a[204:207], v[68:71]
v_cvt_pk_bf16_f32 v135, v150, v151
v_cvt_pk_bf16_f32 v136, v136, v137
M v[68:71], a[152:155], a[200:203], v[68:71]
v_exp_f32 v139, v139
M v[68:71], a[148:151], a[196:199], v[68:71]
buffer_load_dwordx4 v1, s[12:15], s26 offen offset:1024 sc1 lds
M v[72:75], a[148:151], a[212:215], 0
v_exp_f32 v152, v152
M v[72:75], a[152:155], a[216:219], v[72:75]
ds_read_b128 a[124:127], v6 offset:33792
ds_read_b128 a[128:131], v6 offset:41984
M v[72:75], a[156:159], a[220:223], v[72:75]
v_exp_f32 v153, v153
M v[72:75], a[160:163], a[224:227], v[72:75]
buffer_load_dwordx4 v1, s[12:15], s26 offen offset:2048 sc1 lds
M v[76:79], a[160:163], a[240:243], 0
v_exp_f32 v154, v154
M v[76:79], a[156:159], a[236:239], v[76:79]
v_cvt_pk_bf16_f32 v137, v138, v139
v_cvt_pk_bf16_f32 v138, v152, v153
M v[76:79], a[152:155], a[232:235], v[76:79]
v_exp_f32 v155, v155
M v[76:79], a[148:151], a[228:231], v[76:79]
buffer_load_dwordx4 v1, s[12:15], s26 offen offset:3072 sc1 lds
s_add_u32 m0, s29, 36864
s_waitcnt lgkmcnt(4)
M v[80:83], a[164:167], a[180:183], 0
v_exp_f32 v140, v140
M v[80:83], a[168:171], a[184:187], v[80:83]
ds_read_b128 a[132:135], v6 offset:34816
ds_read_b128 a[136:139], v6 offset:43008
M v[80:83], a[172:175], a[188:191], v[80:83]
v_exp_f32 v141, v141
M v[80:83], a[176:179], a[192:195], v[80:83]
buffer_load_dwordx4 v1, s[12:15], s43 offen offset:0 sc1 lds
M v[84:87], a[176:179], a[208:211], 0
v_exp_f32 v142, v142
M v[84:87], a[172:175], a[204:207], v[84:87]
v_cvt_pk_bf16_f32 v139, v154, v155
v_cvt_pk_bf16_f32 v140, v140, v141
M v[84:87], a[168:171], a[200:203], v[84:87]
v_exp_f32 v143, v143
M v[84:87], a[164:167], a[196:199], v[84:87]
buffer_load_dwordx4 v1, s[12:15], s43 offen offset:1024 sc1 lds
M v[88:91], a[164:167], a[212:215], 0
v_exp_f32 v156, v156
M v[88:91], a[168:171], a[216:219], v[88:91]
ds_read_b128 a[140:143], v6 offset:35840
ds_read_b128 a[144:147], v6 offset:44032
M v[88:91], a[172:175], a[220:223], v[88:91]
v_exp_f32 v157, v157
M v[88:91], a[176:179], a[224:227], v[88:91]
buffer_load_dwordx4 v1, s[12:15], s43 offen offset:2048 sc1 lds
M v[92:95], a[176:179], a[240:243], 0
v_exp_f32 v158, v158
M v[92:95], a[172:175], a[236:239], v[92:95]
v_cvt_pk_bf16_f32 v141, v142, v143
v_cvt_pk_bf16_f32 v142, v156, v157
M v[92:95], a[168:171], a[232:235], v[92:95]
v_exp_f32 v159, v159
M v[92:95], a[164:167], a[228:231], v[92:95]
buffer_load_dwordx4 v1, s[12:15], s43 offen offset:3072 sc1 lds
v_cvt_pk_bf16_f32 v143, v158, v159
s_waitcnt lgkmcnt(6)
M v[160:163], a[116:119], v[96:99], v[160:163]
v_exp_f32 v32, v32
M v[160:163], a[120:123], v[128:131], v[160:163]
ds_read_b128 a[148:151], v6 offset:36864
ds_read_b128 a[152:155], v6 offset:45056
M v[164:167], a[120:123], v[132:135], v[164:167]
v_exp_f32 v33, v33
M v[164:167], a[116:119], v[100:103], v[164:167]
v_cvt_pk_bf16_f32 v32, v32, v33
M v[168:171], a[116:119], v[104:107], v[168:171]
v_exp_f32 v34, v34
M v[168:171], a[120:123], v[136:139], v[168:171]
s_add_u32 s25, s25, 32768
s_cmp_eq_u32 s25, s27
M v[172:175], a[120:123], v[140:143], v[172:175]
v_exp_f32 v35, v35
M v[172:175], a[116:119], v[108:111], v[172:175]
v_cvt_pk_bf16_f32 v33, v34, v35
s_waitcnt lgkmcnt(6)
M a[96:99], a[112:115], v[96:99], a[96:99]
s_cselect_b32 s25, s28, s25
s_cselect_b32 s27, -1, s27
M a[96:99], a[112:115], v[128:131], a[96:99]
s_add_u32 s26, s26, 32768
s_cmp_eq_u32 s26, s62
M v[176:179], a[124:127], v[96:99], v[176:179]
v_exp_f32 v48, v48
M v[176:179], a[128:131], v[128:131], v[176:179]
ds_read_b128 a[156:159], v6 offset:37888
ds_read_b128 a[160:163], v6 offset:46080
M v[180:183], a[128:131], v[132:135], v[180:183]
v_exp_f32 v49, v49
M v[180:183], a[124:127], v[100:103], v[180:183]
v_cvt_pk_bf16_f32 v34, v48, v49
M v[184:187], a[124:127], v[104:107], v[184:187]
v_exp_f32 v50, v50
M v[184:187], a[128:131], v[136:139], v[184:187]
s_cselect_b32 s26, s63, s26
s_cselect_b32 s62, -1, s62
M v[188:191], a[128:131], v[140:143], v[188:191]
v_exp_f32 v51, v51
M v[188:191], a[124:127], v[108:111], v[188:191]
v_cvt_pk_bf16_f32 v35, v50, v51
s_waitcnt lgkmcnt(6)
M a[100:103], a[112:115], v[100:103], a[100:103]
M a[100:103], a[112:115], v[132:135], a[100:103]
M v[192:195], a[132:135], v[96:99], v[192:195]
v_exp_f32 v36, v36
M v[192:195], a[136:139], v[128:131], v[192:195]
ds_read_b128 a[164:167], v6 offset:38912
ds_read_b128 a[168:171], v6 offset:47104
M v[196:199], a[136:139], v[132:135], v[196:199]
v_exp_f32 v37, v37
M v[196:199], a[132:135], v[100:103], v[196:199]
v_cvt_pk_bf16_f32 v36, v36, v37
M v[200:203], a[132:135], v[104:107], v[200:203]
v_exp_f32 v38, v38
M v[200:203], a[136:139], v[136:139], v[200:203]
M v[204:207], a[136:139], v[140:143], v[204:207]
v_exp_f32 v39, v39
M v[204:207], a[132:135], v[108:111], v[204:207]
v_cvt_pk_bf16_f32 v37, v38, v39
s_waitcnt lgkmcnt(6)
M a[104:107], a[112:115], v[104:107], a[104:107]
M a[104:107], a[112:115], v[136:139], a[104:107]
M v[208:211], a[140:143], v[96:99], v[208:211]
v_exp_f32 v52, v52
M v[208:211], a[144:147], v[128:131], v[208:211]
ds_read_b128 a[172:175], v6 offset:39936
ds_read_b128 a[176:179], v6 offset:48128
M v[212:215], a[144:147], v[132:135], v[212:215]
v_exp_f32 v53, v53
M v[212:215], a[140:143], v[100:103], v[212:215]
v_cvt_pk_bf16_f32 v38, v52, v53
M v[216:219], a[140:143], v[104:107], v[216:219]
v_exp_f32 v54, v54
M v[216:219], a[144:147], v[136:139], v[216:219]
M v[220:223], a[144:147], v[140:143], v[220:223]
v_exp_f32 v55, v55
M v[220:223], a[140:143], v[108:111], v[220:223]
v_cvt_pk_bf16_f32 v39, v54, v55
s_waitcnt lgkmcnt(6)
M a[108:111], a[112:115], v[108:111], a[108:111]
M a[108:111], a[112:115], v[140:143], a[108:111]
M v[224:227], a[148:151], v[96:99], v[224:227]
v_exp_f32 v40, v40
M v[224:227], a[152:155], v[128:131], v[224:227]
M v[228:231], a[152:155], v[132:135], v[228:231]
v_exp_f32 v41, v41
M v[228:231], a[148:151], v[100:103], v[228:231]
v_cvt_pk_bf16_f32 v40, v40, v41
M v[232:235], a[148:151], v[104:107], v[232:235]
v_exp_f32 v42, v42
M v[232:235], a[152:155], v[136:139], v[232:235]
M v[236:239], a[152:155], v[140:143], v[236:239]
v_exp_f32 v43, v43
M v[236:239], a[148:151], v[108:111], v[236:239]
v_cvt_pk_bf16_f32 v41, v42, v43
s_waitcnt lgkmcnt(4)
M v[240:243], a[156:159], v[96:99], v[240:243]
v_exp_f32 v56, v56
M v[240:243], a[160:163], v[128:131], v[240:243]
M v[244:247], a[160:163], v[132:135], v[244:247]
v_exp_f32 v57, v57
M v[244:247], a[156:159], v[100:103], v[244:247]
v_cvt_pk_bf16_f32 v42, v56, v57
M v[248:251], a[156:159], v[104:107], v[248:251]
v_exp_f32 v58, v58
M v[248:251], a[160:163], v[136:139], v[248:251]
s_waitcnt vmcnt(0) lgkmcnt(0)
s_barrier
ds_read_b128 a[116:119], v2 offset:0
ds_read_b128 a[120:123], v2 offset:1024
M v[252:255], a[160:163], v[140:143], v[252:255]
v_exp_f32 v59, v59
M v[252:255], a[156:159], v[108:111], v[252:255]
v_cvt_pk_bf16_f32 v43, v58, v59
M a[64:67], a[164:167], v[96:99], a[64:67]
v_exp_f32 v44, v44
M a[64:67], a[168:171], v[128:131], a[64:67]
ds_read_b128 a[124:127], v2 offset:2048
ds_read_b128 a[128:131], v2 offset:3072
M a[68:71], a[168:171], v[132:135], a[68:71]
v_exp_f32 v45, v45
M a[68:71], a[164:167], v[100:103], a[68:71]
v_cvt_pk_bf16_f32 v44, v44, v45
M a[72:75], a[164:167], v[104:107], a[72:75]
v_exp_f32 v46, v46
M a[72:75], a[168:171], v[136:139], a[72:75]
ds_read_b128 a[132:135], v2 offset:4096
ds_read_b128 a[136:139], v2 offset:5120
M a[76:79], a[168:171], v[140:143], a[76:79]
v_exp_f32 v47, v47
M a[76:79], a[164:167], v[108:111], a[76:79]
v_cvt_pk_bf16_f32 v45, v46, v47
M a[80:83], a[172:175], v[96:99], a[80:83]
v_exp_f32 v60, v60
M a[80:83], a[176:179], v[128:131], a[80:83]
ds_read_b128 a[140:143], v2 offset:6144
ds_read_b128 a[144:147], v2 offset:7168
M a[84:87], a[176:179], v[132:135], a[84:87]
v_exp_f32 v61, v61
M a[84:87], a[172:175], v[100:103], a[84:87]
v_cvt_pk_bf16_f32 v46, v60, v61
M a[88:91], a[172:175], v[104:107], a[88:91]
v_exp_f32 v62, v62
M a[88:91], a[176:179], v[136:139], a[88:91]
M a[92:95], a[176:179], v[140:143], a[92:95]
v_exp_f32 v63, v63
M a[92:95], a[172:175], v[108:111], a[92:95]
v_cvt_pk_bf16_f32 v47, v62, v63
s_sub_u32 s30, s30, 1
s_cmp_lg_u32 s30, 0
s_cbranch_scc1 Lk2_l2
s_and_b32 s3, s2, 3
s_lshl_b32 s3, s3, 2
s_bfe_u32 s27, s2, 0x20003
s_add_u32 s27, s3, s27
s_lshl_b32 s43, s27, 8
s_add_u32 s43, s43, 16789504
v_lshlrev_b32 v15, 2, v0
buffer_load_dword v7, v15, s[52:55], s43 offen sc1
s_waitcnt lgkmcnt(7)
ds_read_b128 a[116:119], v5 offset:36864
s_waitcnt lgkmcnt(7)
ds_read_b128 a[120:123], v5 offset:45056
s_waitcnt lgkmcnt(7)
ds_read_b128 a[124:127], v5 offset:37888
s_waitcnt lgkmcnt(7)
ds_read_b128 a[128:131], v5 offset:46080
s_waitcnt lgkmcnt(7)
ds_read_b128 a[132:135], v5 offset:38912
s_waitcnt lgkmcnt(7)
ds_read_b128 a[136:139], v5 offset:47104
s_waitcnt lgkmcnt(7)
ds_read_b128 a[140:143], v5 offset:39936
s_waitcnt lgkmcnt(7)
ds_read_b128 a[144:147], v5 offset:48128
s_lshl_b32 s33, s23, 14
s_add_u32 s34, s33, 98304
s_add_u32 s33, s33, 131072
v_add_u32 v2, s34, v1
v_add_u32 v3, s33, v1
v_exp_f32 v64, v64
v_exp_f32 v65, v65
v_exp_f32 v66, v66
v_exp_f32 v67, v67
v_exp_f32 v80, v80
v_exp_f32 v81, v81
v_exp_f32 v82, v82
v_exp_f32 v83, v83
v_cvt_pk_bf16_f32 v64, v64, v65
v_cvt_pk_bf16_f32 v65, v66, v67
v_exp_f32 v68, v68
v_exp_f32 v69, v69
v_exp_f32 v70, v70
v_exp_f32 v71, v71
v_cvt_pk_bf16_f32 v66, v80, v81
v_cvt_pk_bf16_f32 v67, v82, v83
v_exp_f32 v84, v84
v_exp_f32 v85, v85
v_exp_f32 v86, v86
v_exp_f32 v87, v87
v_cvt_pk_bf16_f32 v68, v68, v69
v_cvt_pk_bf16_f32 v69, v70, v71
v_exp_f32 v72, v72
v_exp_f32 v73, v73
v_exp_f32 v74, v74
v_exp_f32 v75, v75
v_cvt_pk_bf16_f32 v70, v84, v85
v_cvt_pk_bf16_f32 v71, v86, v87
v_exp_f32 v88, v88
v_exp_f32 v89, v89
v_exp_f32 v90, v90
v_exp_f32 v91, v91
v_cvt_pk_bf16_f32 v72, v72, v73
v_cvt_pk_bf16_f32 v73, v74, v75
v_exp_f32 v76, v76
v_exp_f32 v77, v77
v_exp_f32 v78, v78
v_exp_f32 v79, v79
v_cvt_pk_bf16_f32 v74, v88, v89
v_cvt_pk_bf16_f32 v75, v90, v91
v_exp_f32 v92, v92
v_exp_f32 v93, v93
v_exp_f32 v94, v94
v_exp_f32 v95, v95
v_cvt_pk_bf16_f32 v76, v76, v77
v_cvt_pk_bf16_f32 v77, v78, v79
v_cvt_pk_bf16_f32 v78, v92, v93
v_cvt_pk_bf16_f32 v79, v94, v95
s_waitcnt lgkmcnt(6)
M v[224:227], a[116:119], v[32:35], v[224:227]
M v[224:227], a[120:123], v[64:67], v[224:227]
ds_read_b128 a[148:151], v5 offset:32768
ds_read_b128 a[152:155], v5 offset:40960
s_mov_b32 s61, 0
M v[228:231], a[120:123], v[68:71], v[228:231]
M v[228:231], a[116:119], v[36:39], v[228:231]
s_bfe_u32 s3, s2, 0x10002
M v[232:235], a[116:119], v[40:43], v[232:235]
M v[232:235], a[120:123], v[72:75], v[232:235]
s_lshl_b32 s3, s3, 3
M v[236:239], a[120:123], v[76:79], v[236:239]
M v[236:239], a[116:119], v[44:47], v[236:239]
s_waitcnt lgkmcnt(6)
s_lshr_b32 s28, s2, 5
M a[96:99], a[112:115], v[32:35], a[96:99]
M a[96:99], a[112:115], v[64:67], a[96:99]
M v[240:243], a[124:127], v[32:35], v[240:243]
M v[240:243], a[128:131], v[64:67], v[240:243]
ds_read_b128 a[156:159], v5 offset:33792
ds_read_b128 a[160:163], v5 offset:41984
s_add_u32 s28, s3, s28
M v[244:247], a[128:131], v[68:71], v[244:247]
s_lshl_b32 s25, s27, 18
M v[244:247], a[124:127], v[36:39], v[244:247]
M v[248:251], a[124:127], v[40:43], v[248:251]
s_lshl_b32 s3, s101, 12
M v[248:251], a[128:131], v[72:75], v[248:251]
M v[252:255], a[128:131], v[76:79], v[252:255]
s_add_u32 s25, s25, s3
M v[252:255], a[124:127], v[44:47], v[252:255]
s_waitcnt lgkmcnt(6)
M a[100:103], a[112:115], v[36:39], a[100:103]
M a[100:103], a[112:115], v[68:71], a[100:103]
M a[64:67], a[132:135], v[32:35], a[64:67]
s_lshl_b32 s26, s28, 7
M a[64:67], a[136:139], v[64:67], a[64:67]
ds_read_b128 a[164:167], v5 offset:34816
ds_read_b128 a[168:171], v5 offset:43008
M a[68:71], a[136:139], v[68:71], a[68:71]
s_lshl_b32 s42, s101, 11
M a[68:71], a[132:135], v[36:39], a[68:71]
M a[72:75], a[132:135], v[40:43], a[72:75]
s_add_u32 s44, s4, 83886080
s_addc_u32 s45, s5, 0
M a[72:75], a[136:139], v[72:75], a[72:75]
s_mov_b32 s46, 4194304
M a[76:79], a[136:139], v[76:79], a[76:79]
M a[76:79], a[132:135], v[44:47], a[76:79]
s_waitcnt lgkmcnt(6)
s_mov_b32 s47, 0x00020000
M a[104:107], a[112:115], v[40:43], a[104:107]
M a[104:107], a[112:115], v[72:75], a[104:107]
M a[80:83], a[140:143], v[32:35], a[80:83]
M a[80:83], a[144:147], v[64:67], a[80:83]
ds_read_b128 a[172:175], v5 offset:35840
ds_read_b128 a[176:179], v5 offset:44032
s_mov_b32 s50, 2097152
M a[84:87], a[144:147], v[68:71], a[84:87]
M a[84:87], a[140:143], v[36:39], a[84:87]
s_mov_b32 s51, 0x00020000
M a[88:91], a[140:143], v[40:43], a[88:91]
M a[88:91], a[144:147], v[72:75], a[88:91]
s_lshl_b32 s3, s101, 4
M a[92:95], a[144:147], v[76:79], a[92:95]
M a[92:95], a[140:143], v[44:47], a[92:95]
s_waitcnt lgkmcnt(6)
v_lshrrev_b32 v96, 3, v0
M a[108:111], a[112:115], v[44:47], a[108:111]
M a[108:111], a[112:115], v[76:79], a[108:111]
M v[160:163], a[148:151], v[32:35], v[160:163]
v_and_b32 v97, 6, v96
M v[160:163], a[152:155], v[64:67], v[160:163]
M v[164:167], a[152:155], v[68:71], v[164:167]
ds_write_b128 v2, v[224:227] offset:0
v_and_b32 v98, 7, v0
M v[164:167], a[148:151], v[36:39], v[164:167]
M v[168:171], a[148:151], v[40:43], v[168:171]
ds_write_b128 v2, v[228:231] offset:1024
v_xor_b32 v97, v97, v98
M v[168:171], a[152:155], v[72:75], v[168:171]
M v[172:175], a[152:155], v[76:79], v[172:175]
ds_write_b128 v2, v[232:235] offset:2048
v_add_u32 v96, s3, v96
M v[172:175], a[148:151], v[44:47], v[172:175]
s_waitcnt lgkmcnt(7)
M v[176:179], a[156:159], v[32:35], v[176:179]
ds_write_b128 v2, v[236:239] offset:3072
v_lshlrev_b32 v96, 11, v96
M v[176:179], a[160:163], v[64:67], v[176:179]
M v[180:183], a[160:163], v[68:71], v[180:183]
ds_write_b128 v2, v[240:243] offset:4096
v_lshl_add_u32 v99, v97, 4, v96
M v[180:183], a[156:159], v[36:39], v[180:183]
v_add_u32 v100, 15360, v99
M v[184:187], a[156:159], v[40:43], v[184:187]
ds_write_b128 v2, v[244:247] offset:5120
M v[184:187], a[160:163], v[72:75], v[184:187]
s_waitcnt vmcnt(0) lgkmcnt(0)
s_barrier
M v[188:191], a[160:163], v[76:79], v[188:191]
ds_write_b128 v2, v[248:251] offset:6144
v_cmp_ne_u32 vcc, 1, v7
s_nop 0
s_cbranch_vccnz Lk3_spinb1
Lk3_gotb1:
M v[188:191], a[156:159], v[44:47], v[188:191]
s_add_u32 m0, s42, 16384
s_nop 0
buffer_load_dwordx4 v99, s[48:51], s26 offen offset:0 lds
M v[192:195], a[164:167], v[32:35], v[192:195]
ds_write_b128 v2, v[252:255] offset:7168
buffer_load_dwordx4 v100, s[48:51], s26 offen offset:1024 lds
M v[192:195], a[168:171], v[64:67], v[192:195]
M v[196:199], a[168:171], v[68:71], v[196:199]
ds_write_b128 v2, a[64:67] offset:8192
buffer_load_dwordx4 a[192:195], v1, s[44:47], s25 offen offset:0 sc1
M v[196:199], a[164:167], v[36:39], v[196:199]
buffer_load_dwordx4 a[196:199], v1, s[44:47], s25 offen offset:1024 sc1
M v[200:203], a[164:167], v[40:43], v[200:203]
ds_write_b128 v2, a[68:71] offset:9216
buffer_load_dwordx4 a[200:203], v1, s[44:47], s25 offen offset:2048 sc1
M v[200:203], a[168:171], v[72:75], v[200:203]
buffer_load_dwordx4 a[204:207], v1, s[44:47], s25 offen offset:3072 sc1
M v[204:207], a[168:171], v[76:79], v[204:207]
ds_write_b128 v2, a[72:75] offset:10240
M v[204:207], a[164:167], v[44:47], v[204:207]
s_add_u32 s25, s25, 16384
s_add_u32 s26, s26, 131072
M v[208:211], a[172:175], v[32:35], v[208:211]
ds_write_b128 v2, a[76:79] offset:11264
s_add_u32 m0, s42, 32768
s_nop 0
buffer_load_dwordx4 v99, s[48:51], s26 offen offset:0 lds
M v[208:211], a[176:179], v[64:67], v[208:211]
buffer_load_dwordx4 v100, s[48:51], s26 offen offset:1024 lds
M v[212:215], a[176:179], v[68:71], v[212:215]
ds_write_b128 v2, a[80:83] offset:12288
buffer_load_dwordx4 a[224:227], v1, s[44:47], s25 offen offset:0 sc1
M v[212:215], a[172:175], v[36:39], v[212:215]
M v[216:219], a[172:175], v[40:43], v[216:219]
ds_write_b128 v2, a[84:87] offset:13312
buffer_load_dwordx4 a[228:231], v1, s[44:47], s25 offen offset:1024 sc1
M v[216:219], a[176:179], v[72:75], v[216:219]
buffer_load_dwordx4 a[232:235], v1, s[44:47], s25 offen offset:2048 sc1
M v[220:223], a[176:179], v[76:79], v[220:223]
ds_write_b128 v2, a[88:91] offset:14336
buffer_load_dwordx4 a[236:239], v1, s[44:47], s25 offen offset:3072 sc1
M v[220:223], a[172:175], v[44:47], v[220:223]
s_add_u32 s25, s25, 16384
s_add_u32 s26, s26, 131072
ds_write_b128 v2, a[92:95] offset:15360
s_waitcnt lgkmcnt(0)
Lk2_merge:
s_lshl_b32 s33, s22, 10
s_add_u32 s33, s33, 28672
s_xor_b32 s34, s33, 2048
v_add_u32 v14, s33, v1
v_add_u32 v15, s34, v1
v_accvgpr_read_b32 v20, a96
v_accvgpr_read_b32 v21, a100
v_accvgpr_read_b32 v22, a104
v_accvgpr_read_b32 v23, a108
ds_write_b128 v14, v[20:23]
s_waitcnt lgkmcnt(0)
s_barrier
ds_read_b128 v[28:31], v15
ds_read_b128 v[32:35], v3 offset:0
ds_read_b128 v[36:39], v3 offset:1024
ds_read_b128 v[40:43], v3 offset:2048
ds_read_b128 v[44:47], v3 offset:3072
ds_read_b128 v[48:51], v3 offset:4096
ds_read_b128 v[52:55], v3 offset:5120
ds_read_b128 v[56:59], v3 offset:6144
ds_read_b128 v[60:63], v3 offset:7168
ds_read_b128 v[64:67], v3 offset:8192
ds_read_b128 v[68:71], v3 offset:9216
ds_read_b128 v[72:75], v3 offset:10240
ds_read_b128 v[76:79], v3 offset:11264
ds_read_b128 v[80:83], v3 offset:12288
ds_read_b128 v[84:87], v3 offset:13312
ds_read_b128 v[88:91], v3 offset:14336
ds_read_b128 v[92:95], v3 offset:15360
s_waitcnt lgkmcnt(15)
v_add_f32 v20, v20, v28
v_add_f32 v21, v21, v29
v_add_f32 v22, v22, v30
v_add_f32 v23, v23, v31
s_sub_u32 s35, 15, s21
v_rcp_f32 v8, v20
v_rcp_f32 v9, v21
v_rcp_f32 v10, v22
v_rcp_f32 v11, v23
v_subrev_u32 v20, 0x21800000, v20
v_subrev_u32 v21, 0x21800000, v21
v_subrev_u32 v22, 0x21800000, v22
v_subrev_u32 v23, 0x21800000, v23
v_max_u32 v12, v20, v21
v_max3_u32 v12, v12, v22, v23
s_mov_b32 s64, 0x207
s_lshl_b32 s33, s35, 20
s_lshl_b32 s34, s20, 15
s_add_u32 s33, s33, s34
s_lshl_b32 s34, s23, 13
s_add_u32 s36, s33, s34
s_add_u32 s37, s36, 4096
s_add_u32 s38, s36, 16384
s_add_u32 s39, s36, 20480
v_pk_add_f32 v[160:161], v[160:161], v[32:33]
v_pk_add_f32 v[162:163], v[162:163], v[34:35]
s_waitcnt lgkmcnt(11)
v_pk_add_f32 v[176:177], v[176:177], v[48:49]
v_pk_add_f32 v[178:179], v[178:179], v[50:51]
v_pk_mul_f32 v[160:161], v[160:161], v[8:9] op_sel:[0,0] op_sel_hi:[1,0]
v_pk_mul_f32 v[162:163], v[162:163], v[8:9] op_sel:[0,0] op_sel_hi:[1,0]
v_pk_mul_f32 v[176:177], v[176:177], v[8:9] op_sel:[0,0] op_sel_hi:[1,0]
v_pk_mul_f32 v[178:179], v[178:179], v[8:9] op_sel:[0,0] op_sel_hi:[1,0]
v_cvt_pk_bf16_f32 v160, v160, v161
v_cvt_pk_bf16_f32 v161, v162, v163
v_cvt_pk_bf16_f32 v162, v176, v177
v_cvt_pk_bf16_f32 v163, v178, v179
v_pk_add_f32 v[164:165], v[164:165], v[36:37]
v_pk_add_f32 v[166:167], v[166:167], v[38:39]
s_waitcnt lgkmcnt(10)
v_pk_add_f32 v[180:181], v[180:181], v[52:53]
v_pk_add_f32 v[182:183], v[182:183], v[54:55]
M v[24:27], a[112:115], v[160:163], 0
buffer_store_dwordx4 v[160:163], v1, s[16:19], s36 offen offset:0 sc1
v_pk_mul_f32 v[164:165], v[164:165], v[8:9] op_sel:[0,1] op_sel_hi:[1,1]
v_pk_mul_f32 v[166:167], v[166:167], v[8:9] op_sel:[0,1] op_sel_hi:[1,1]
v_pk_mul_f32 v[180:181], v[180:181], v[8:9] op_sel:[0,1] op_sel_hi:[1,1]
v_pk_mul_f32 v[182:183], v[182:183], v[8:9] op_sel:[0,1] op_sel_hi:[1,1]
v_cvt_pk_bf16_f32 v164, v164, v165
v_cvt_pk_bf16_f32 v165, v166, v167
v_cvt_pk_bf16_f32 v166, v180, v181
v_cvt_pk_bf16_f32 v167, v182, v183
v_pk_add_f32 v[168:169], v[168:169], v[40:41]
v_pk_add_f32 v[170:171], v[170:171], v[42:43]
s_waitcnt lgkmcnt(9)
v_pk_add_f32 v[184:185], v[184:185], v[56:57]
v_pk_add_f32 v[186:187], v[186:187], v[58:59]
M v[24:27], a[112:115], v[164:167], v[24:27]
buffer_store_dwordx4 v[164:167], v1, s[16:19], s36 offen offset:2048 sc1
v_pk_mul_f32 v[168:169], v[168:169], v[10:11] op_sel:[0,0] op_sel_hi:[1,0]
v_pk_mul_f32 v[170:171], v[170:171], v[10:11] op_sel:[0,0] op_sel_hi:[1,0]
v_pk_mul_f32 v[184:185], v[184:185], v[10:11] op_sel:[0,0] op_sel_hi:[1,0]
v_pk_mul_f32 v[186:187], v[186:187], v[10:11] op_sel:[0,0] op_sel_hi:[1,0]
v_cvt_pk_bf16_f32 v168, v168, v169
v_cvt_pk_bf16_f32 v169, v170, v171
v_cvt_pk_bf16_f32 v170, v184, v185
v_cvt_pk_bf16_f32 v171, v186, v187
v_pk_add_f32 v[172:173], v[172:173], v[44:45]
v_pk_add_f32 v[174:175], v[174:175], v[46:47]
s_waitcnt lgkmcnt(8)
v_pk_add_f32 v[188:189], v[188:189], v[60:61]
v_pk_add_f32 v[190:191], v[190:191], v[62:63]
M v[24:27], a[112:115], v[168:171], v[24:27]
buffer_store_dwordx4 v[168:171], v1, s[16:19], s37 offen offset:0 sc1
v_pk_mul_f32 v[172:173], v[172:173], v[10:11] op_sel:[0,1] op_sel_hi:[1,1]
v_pk_mul_f32 v[174:175], v[174:175], v[10:11] op_sel:[0,1] op_sel_hi:[1,1]
v_pk_mul_f32 v[188:189], v[188:189], v[10:11] op_sel:[0,1] op_sel_hi:[1,1]
v_pk_mul_f32 v[190:191], v[190:191], v[10:11] op_sel:[0,1] op_sel_hi:[1,1]
v_cvt_pk_bf16_f32 v172, v172, v173
v_cvt_pk_bf16_f32 v173, v174, v175
v_cvt_pk_bf16_f32 v174, v188, v189
v_cvt_pk_bf16_f32 v175, v190, v191
s_waitcnt lgkmcnt(7)
v_pk_add_f32 v[192:193], v[192:193], v[64:65]
v_pk_add_f32 v[194:195], v[194:195], v[66:67]
s_waitcnt lgkmcnt(3)
v_pk_add_f32 v[208:209], v[208:209], v[80:81]
v_pk_add_f32 v[210:211], v[210:211], v[82:83]
M v[24:27], a[112:115], v[172:175], v[24:27]
buffer_store_dwordx4 v[172:175], v1, s[16:19], s37 offen offset:2048 sc1
v_pk_mul_f32 v[192:193], v[192:193], v[8:9] op_sel:[0,0] op_sel_hi:[1,0]
v_pk_mul_f32 v[194:195], v[194:195], v[8:9] op_sel:[0,0] op_sel_hi:[1,0]
v_pk_mul_f32 v[208:209], v[208:209], v[8:9] op_sel:[0,0] op_sel_hi:[1,0]
v_pk_mul_f32 v[210:211], v[210:211], v[8:9] op_sel:[0,0] op_sel_hi:[1,0]
v_cvt_pk_bf16_f32 v192, v192, v193
v_cvt_pk_bf16_f32 v193, v194, v195
v_cvt_pk_bf16_f32 v194, v208, v209
v_cvt_pk_bf16_f32 v195, v210, v211
v_pk_add_f32 v[196:197], v[196:197], v[68:69]
v_pk_add_f32 v[198:199], v[198:199], v[70:71]
s_waitcnt lgkmcnt(2)
v_pk_add_f32 v[212:213], v[212:213], v[84:85]
v_pk_add_f32 v[214:215], v[214:215], v[86:87]
M v[24:27], a[112:115], v[192:195], v[24:27]
buffer_store_dwordx4 v[192:195], v1, s[16:19], s36 offen offset:1024 sc1
v_pk_mul_f32 v[196:197], v[196:197], v[8:9] op_sel:[0,1] op_sel_hi:[1,1]
v_pk_mul_f32 v[198:199], v[198:199], v[8:9] op_sel:[0,1] op_sel_hi:[1,1]
v_pk_mul_f32 v[212:213], v[212:213], v[8:9] op_sel:[0,1] op_sel_hi:[1,1]
v_pk_mul_f32 v[214:215], v[214:215], v[8:9] op_sel:[0,1] op_sel_hi:[1,1]
v_cvt_pk_bf16_f32 v196, v196, v197
v_cvt_pk_bf16_f32 v197, v198, v199
v_cvt_pk_bf16_f32 v198, v212, v213
v_cvt_pk_bf16_f32 v199, v214, v215
v_pk_add_f32 v[200:201], v[200:201], v[72:73]
v_pk_add_f32 v[202:203], v[202:203], v[74:75]
s_waitcnt lgkmcnt(1)
v_pk_add_f32 v[216:217], v[216:217], v[88:89]
v_pk_add_f32 v[218:219], v[218:219], v[90:91]
M v[24:27], a[112:115], v[196:199], v[24:27]
buffer_store_dwordx4 v[196:199], v1, s[16:19], s36 offen offset:3072 sc1
v_pk_mul_f32 v[200:201], v[200:201], v[10:11] op_sel:[0,0] op_sel_hi:[1,0]
v_pk_mul_f32 v[202:203], v[202:203], v[10:11] op_sel:[0,0] op_sel_hi:[1,0]
v_pk_mul_f32 v[216:217], v[216:217], v[10:11] op_sel:[0,0] op_sel_hi:[1,0]
v_pk_mul_f32 v[218:219], v[218:219], v[10:11] op_sel:[0,0] op_sel_hi:[1,0]
v_cvt_pk_bf16_f32 v200, v200, v201
v_cvt_pk_bf16_f32 v201, v202, v203
v_cvt_pk_bf16_f32 v202, v216, v217
v_cvt_pk_bf16_f32 v203, v218, v219
v_pk_add_f32 v[204:205], v[204:205], v[76:77]
v_pk_add_f32 v[206:207], v[206:207], v[78:79]
s_waitcnt lgkmcnt(0)
v_pk_add_f32 v[220:221], v[220:221], v[92:93]
v_pk_add_f32 v[222:223], v[222:223], v[94:95]
M v[24:27], a[112:115], v[200:203], v[24:27]
buffer_store_dwordx4 v[200:203], v1, s[16:19], s37 offen offset:1024 sc1
v_pk_mul_f32 v[204:205], v[204:205], v[10:11] op_sel:[0,1] op_sel_hi:[1,1]
v_pk_mul_f32 v[206:207], v[206:207], v[10:11] op_sel:[0,1] op_sel_hi:[1,1]
v_pk_mul_f32 v[220:221], v[220:221], v[10:11] op_sel:[0,1] op_sel_hi:[1,1]
v_pk_mul_f32 v[222:223], v[222:223], v[10:11] op_sel:[0,1] op_sel_hi:[1,1]
v_cvt_pk_bf16_f32 v204, v204, v205
v_cvt_pk_bf16_f32 v205, v206, v207
v_cvt_pk_bf16_f32 v206, v220, v221
v_cvt_pk_bf16_f32 v207, v222, v223
s_nop 1
M v[24:27], a[112:115], v[204:207], v[24:27]
buffer_store_dwordx4 v[204:207], v1, s[16:19], s37 offen offset:3072 sc1
v_cmp_lt_u32 vcc, 0x3c000000, v12
s_nop 5
v_cmp_class_f32 s[40:41], v24, s64
s_nop 0
s_or_b64 vcc, vcc, s[40:41]
s_cmp_lg_u64 vcc, 0
s_cselect_b32 s33, 2, 0
s_or_b32 s60, s60, s33
s_branch Lk2_chk
Lk2_wm:
s_lshl_b32 s33, s2, 1
s_add_u32 s33, s33, s23
s_lshl_b32 s34, s33, 12
s_lshl_b32 s33, s33, 14
v_lshlrev_b32 v8, 3, v1
v_lshlrev_b32 v9, 2, v1
buffer_load_dword a244, v8, s[44:47], s33 offen
s_add_u32 s33, s33, 8192
buffer_load_dword a245, v8, s[44:47], s33 offen
buffer_load_dword a246, v9, s[48:51], s34 offen
s_branch Lk2_l3b
Lk2_g1:
s_mov_b32 s30, 7
s_bfe_u32 s65, s2, 0x20003
s_add_u32 s65, s65, 2
s_lshl_b32 s42, s21, 1
s_min_u32 s42, s42, 13
s_add_u32 s42, s42, 2
s_sub_u32 s33, s42, 1
s_cmp_le_u32 s33, 1
s_cselect_b32 s33, 0x4000, 0
v_add_u32 v3, s33, v3
s_sub_u32 s42, s42, 1
Lk2_l3:
s_cmp_eq_u32 s30, s65
s_cbranch_scc1 Lk2_wm
Lk2_l3b:
s_add_u32 m0, s29, 65536
s_waitcnt lgkmcnt(4)
M v[96:99], a[116:119], a[0:3], 0
v_exp_f32 v64, v64
M v[96:99], a[120:123], a[4:7], v[96:99]
ds_read_b128 a[148:151], v2 offset:8192
ds_read_b128 a[152:155], v2 offset:9216
M v[96:99], a[124:127], a[8:11], v[96:99]
v_exp_f32 v65, v65
M v[96:99], a[128:131], a[12:15], v[96:99]
buffer_load_dwordx4 v1, s[12:15], s25 offen offset:0 sc1 lds
s_add_u32 s32, s25, 4096
M v[100:103], a[128:131], a[28:31], 0
v_exp_f32 v66, v66
M v[100:103], a[124:127], a[24:27], v[100:103]
v_cvt_pk_bf16_f32 v64, v64, v65
M v[100:103], a[120:123], a[20:23], v[100:103]
v_exp_f32 v67, v67
M v[100:103], a[116:119], a[16:19], v[100:103]
buffer_load_dwordx4 v1, s[12:15], s25 offen offset:1024 sc1 lds
M v[104:107], a[116:119], a[32:35], 0
v_exp_f32 v80, v80
M v[104:107], a[120:123], a[36:39], v[104:107]
ds_read_b128 a[156:159], v2 offset:10240
ds_read_b128 a[160:163], v2 offset:11264
M v[104:107], a[124:127], a[40:43], v[104:107]
v_exp_f32 v81, v81
M v[104:107], a[128:131], a[44:47], v[104:107]
buffer_load_dwordx4 v1, s[12:15], s25 offen offset:2048 sc1 lds
M v[108:111], a[128:131], a[60:63], 0
v_exp_f32 v82, v82
M v[108:111], a[124:127], a[56:59], v[108:111]
v_cvt_pk_bf16_f32 v65, v66, v67
v_cvt_pk_bf16_f32 v66, v80, v81
M v[108:111], a[120:123], a[52:55], v[108:111]
v_exp_f32 v83, v83
M v[108:111], a[116:119], a[48:51], v[108:111]
buffer_load_dwordx4 v1, s[12:15], s25 offen offset:3072 sc1 lds
s_add_u32 m0, s29, 69632
s_waitcnt lgkmcnt(4)
M v[112:115], a[132:135], a[0:3], 0
v_exp_f32 v68, v68
M v[112:115], a[136:139], a[4:7], v[112:115]
ds_read_b128 a[164:167], v2 offset:12288
ds_read_b128 a[168:171], v2 offset:13312
M v[112:115], a[140:143], a[8:11], v[112:115]
v_exp_f32 v69, v69
M v[112:115], a[144:147], a[12:15], v[112:115]
buffer_load_dwordx4 v1, s[12:15], s32 offen offset:0 sc1 lds
M v[116:119], a[144:147], a[28:31], 0
v_exp_f32 v70, v70
M v[116:119], a[140:143], a[24:27], v[116:119]
v_cvt_pk_bf16_f32 v67, v82, v83
v_cvt_pk_bf16_f32 v68, v68, v69
M v[116:119], a[136:139], a[20:23], v[116:119]
v_exp_f32 v71, v71
M v[116:119], a[132:135], a[16:19], v[116:119]
buffer_load_dwordx4 v1, s[12:15], s32 offen offset:1024 sc1 lds
M v[120:123], a[132:135], a[32:35], 0
v_exp_f32 v84, v84
M v[120:123], a[136:139], a[36:39], v[120:123]
ds_read_b128 a[172:175], v2 offset:14336
ds_read_b128 a[176:179], v2 offset:15360
M v[120:123], a[140:143], a[40:43], v[120:123]
v_exp_f32 v85, v85
M v[120:123], a[144:147], a[44:47], v[120:123]
buffer_load_dwordx4 v1, s[12:15], s32 offen offset:2048 sc1 lds
M v[124:127], a[144:147], a[60:63], 0
v_exp_f32 v86, v86
M v[124:127], a[140:143], a[56:59], v[124:127]
v_cvt_pk_bf16_f32 v69, v70, v71
v_cvt_pk_bf16_f32 v70, v84, v85
M v[124:127], a[136:139], a[52:55], v[124:127]
v_exp_f32 v87, v87
M v[124:127], a[132:135], a[48:51], v[124:127]
buffer_load_dwordx4 v1, s[12:15], s32 offen offset:3072 sc1 lds
s_add_u32 m0, s29, 98304
s_waitcnt lgkmcnt(4)
M v[128:131], a[148:151], a[0:3], 0
v_exp_f32 v72, v72
M v[128:131], a[152:155], a[4:7], v[128:131]
ds_read_b128 a[116:119], v5 offset:32768
ds_read_b128 a[120:123], v5 offset:40960
M v[128:131], a[156:159], a[8:11], v[128:131]
v_exp_f32 v73, v73
M v[128:131], a[160:163], a[12:15], v[128:131]
buffer_load_dwordx4 v1, s[12:15], s26 offen offset:0 sc1 lds
s_add_u32 s43, s26, 4096
M v[132:135], a[160:163], a[28:31], 0
v_exp_f32 v74, v74
M v[132:135], a[156:159], a[24:27], v[132:135]
v_cvt_pk_bf16_f32 v71, v86, v87
v_cvt_pk_bf16_f32 v72, v72, v73
M v[132:135], a[152:155], a[20:23], v[132:135]
v_exp_f32 v75, v75
M v[132:135], a[148:151], a[16:19], v[132:135]
buffer_load_dwordx4 v1, s[12:15], s26 offen offset:1024 sc1 lds
M v[136:139], a[148:151], a[32:35], 0
v_exp_f32 v88, v88
M v[136:139], a[152:155], a[36:39], v[136:139]
ds_read_b128 a[124:127], v5 offset:33792
ds_read_b128 a[128:131], v5 offset:41984
M v[136:139], a[156:159], a[40:43], v[136:139]
v_exp_f32 v89, v89
M v[136:139], a[160:163], a[44:47], v[136:139]
buffer_load_dwordx4 v1, s[12:15], s26 offen offset:2048 sc1 lds
M v[140:143], a[160:163], a[60:63], 0
v_exp_f32 v90, v90
M v[140:143], a[156:159], a[56:59], v[140:143]
v_cvt_pk_bf16_f32 v73, v74, v75
v_cvt_pk_bf16_f32 v74, v88, v89
M v[140:143], a[152:155], a[52:55], v[140:143]
v_exp_f32 v91, v91
M v[140:143], a[148:151], a[48:51], v[140:143]
buffer_load_dwordx4 v1, s[12:15], s26 offen offset:3072 sc1 lds
s_add_u32 m0, s29, 102400
s_waitcnt lgkmcnt(4)
M v[144:147], a[164:167], a[0:3], 0
v_exp_f32 v76, v76
M v[144:147], a[168:171], a[4:7], v[144:147]
ds_read_b128 a[132:135], v5 offset:34816
ds_read_b128 a[136:139], v5 offset:43008
M v[144:147], a[172:175], a[8:11], v[144:147]
v_exp_f32 v77, v77
M v[144:147], a[176:179], a[12:15], v[144:147]
buffer_load_dwordx4 v1, s[12:15], s43 offen offset:0 sc1 lds
M v[148:151], a[176:179], a[28:31], 0
v_exp_f32 v78, v78
M v[148:151], a[172:175], a[24:27], v[148:151]
v_cvt_pk_bf16_f32 v75, v90, v91
v_cvt_pk_bf16_f32 v76, v76, v77
M v[148:151], a[168:171], a[20:23], v[148:151]
v_exp_f32 v79, v79
M v[148:151], a[164:167], a[16:19], v[148:151]
buffer_load_dwordx4 v1, s[12:15], s43 offen offset:1024 sc1 lds
M v[152:155], a[164:167], a[32:35], 0
v_exp_f32 v92, v92
M v[152:155], a[168:171], a[36:39], v[152:155]
ds_read_b128 a[140:143], v5 offset:35840
ds_read_b128 a[144:147], v5 offset:44032
M v[152:155], a[172:175], a[40:43], v[152:155]
v_exp_f32 v93, v93
M v[152:155], a[176:179], a[44:47], v[152:155]
buffer_load_dwordx4 v1, s[12:15], s43 offen offset:2048 sc1 lds
M v[156:159], a[176:179], a[60:63], 0
v_exp_f32 v94, v94
M v[156:159], a[172:175], a[56:59], v[156:159]
v_cvt_pk_bf16_f32 v77, v78, v79
v_cvt_pk_bf16_f32 v78, v92, v93
M v[156:159], a[168:171], a[52:55], v[156:159]
v_exp_f32 v95, v95
M v[156:159], a[164:167], a[48:51], v[156:159]
buffer_load_dwordx4 v1, s[12:15], s43 offen offset:3072 sc1 lds
v_cvt_pk_bf16_f32 v79, v94, v95
s_waitcnt lgkmcnt(6)
M v[160:163], a[116:119], v[32:35], v[160:163]
v_exp_f32 v96, v96
M v[160:163], a[120:123], v[64:67], v[160:163]
ds_read_b128 a[148:151], v5 offset:36864
ds_read_b128 a[152:155], v5 offset:45056
M v[164:167], a[120:123], v[68:71], v[164:167]
v_exp_f32 v97, v97
M v[164:167], a[116:119], v[36:39], v[164:167]
v_cvt_pk_bf16_f32 v96, v96, v97
M v[168:171], a[116:119], v[40:43], v[168:171]
v_exp_f32 v98, v98
M v[168:171], a[120:123], v[72:75], v[168:171]
s_add_u32 s25, s25, 32768
s_cmp_eq_u32 s25, s27
M v[172:175], a[120:123], v[76:79], v[172:175]
v_exp_f32 v99, v99
M v[172:175], a[116:119], v[44:47], v[172:175]
v_cvt_pk_bf16_f32 v97, v98, v99
s_waitcnt lgkmcnt(6)
M a[96:99], a[112:115], v[32:35], a[96:99]
s_cselect_b32 s25, s28, s25
s_cselect_b32 s27, s56, s27
M a[96:99], a[112:115], v[64:67], a[96:99]
s_cselect_b32 s28, s57, s28
s_cselect_b32 s56, -1, s56
M v[176:179], a[124:127], v[32:35], v[176:179]
v_exp_f32 v112, v112
M v[176:179], a[128:131], v[64:67], v[176:179]
ds_read_b128 a[156:159], v5 offset:37888
ds_read_b128 a[160:163], v5 offset:46080
M v[180:183], a[128:131], v[68:71], v[180:183]
v_exp_f32 v113, v113
M v[180:183], a[124:127], v[36:39], v[180:183]
v_cvt_pk_bf16_f32 v98, v112, v113
M v[184:187], a[124:127], v[40:43], v[184:187]
v_exp_f32 v114, v114
M v[184:187], a[128:131], v[72:75], v[184:187]
s_add_u32 s26, s26, 32768
s_cmp_eq_u32 s26, s62
M v[188:191], a[128:131], v[76:79], v[188:191]
v_exp_f32 v115, v115
M v[188:191], a[124:127], v[44:47], v[188:191]
v_cvt_pk_bf16_f32 v99, v114, v115
s_waitcnt lgkmcnt(6)
M a[100:103], a[112:115], v[36:39], a[100:103]
s_cselect_b32 s26, s63, s26
s_cselect_b32 s62, s58, s62
M a[100:103], a[112:115], v[68:71], a[100:103]
s_cselect_b32 s63, s59, s63
s_cselect_b32 s58, -1, s58
M v[192:195], a[132:135], v[32:35], v[192:195]
v_exp_f32 v100, v100
M v[192:195], a[136:139], v[64:67], v[192:195]
ds_read_b128 a[164:167], v5 offset:38912
ds_read_b128 a[168:171], v5 offset:47104
M v[196:199], a[136:139], v[68:71], v[196:199]
v_exp_f32 v101, v101
M v[196:199], a[132:135], v[36:39], v[196:199]
v_cvt_pk_bf16_f32 v100, v100, v101
M v[200:203], a[132:135], v[40:43], v[200:203]
v_exp_f32 v102, v102
M v[200:203], a[136:139], v[72:75], v[200:203]
s_sub_u32 s33, s42, 1
s_cmp_le_u32 s33, 1
s_cselect_b32 s33, 0x4000, 0
v_add_u32 v2, s33, v2
M v[204:207], a[136:139], v[76:79], v[204:207]
v_exp_f32 v103, v103
M v[204:207], a[132:135], v[44:47], v[204:207]
v_cvt_pk_bf16_f32 v101, v102, v103
s_waitcnt lgkmcnt(6)
M a[104:107], a[112:115], v[40:43], a[104:107]
M a[104:107], a[112:115], v[72:75], a[104:107]
M v[208:211], a[140:143], v[32:35], v[208:211]
v_exp_f32 v116, v116
M v[208:211], a[144:147], v[64:67], v[208:211]
ds_read_b128 a[172:175], v5 offset:39936
ds_read_b128 a[176:179], v5 offset:48128
M v[212:215], a[144:147], v[68:71], v[212:215]
v_exp_f32 v117, v117
M v[212:215], a[140:143], v[36:39], v[212:215]
v_cvt_pk_bf16_f32 v102, v116, v117
M v[216:219], a[140:143], v[40:43], v[216:219]
v_exp_f32 v118, v118
M v[216:219], a[144:147], v[72:75], v[216:219]
M v[220:223], a[144:147], v[76:79], v[220:223]
v_exp_f32 v119, v119
M v[220:223], a[140:143], v[44:47], v[220:223]
v_cvt_pk_bf16_f32 v103, v118, v119
s_waitcnt lgkmcnt(6)
M a[108:111], a[112:115], v[44:47], a[108:111]
M a[108:111], a[112:115], v[76:79], a[108:111]
M v[224:227], a[148:151], v[32:35], v[224:227]
v_exp_f32 v104, v104
M v[224:227], a[152:155], v[64:67], v[224:227]
s_cmp_le_u32 s42, 1
s_cselect_b32 s33, 0x4000, 0
v_add_u32 v5, s33, v5
s_sub_u32 s42, s42, 1
M v[228:231], a[152:155], v[68:71], v[228:231]
v_exp_f32 v105, v105
M v[228:231], a[148:151], v[36:39], v[228:231]
v_cvt_pk_bf16_f32 v104, v104, v105
M v[232:235], a[148:151], v[40:43], v[232:235]
v_exp_f32 v106, v106
M v[232:235], a[152:155], v[72:75], v[232:235]
M v[236:239], a[152:155], v[76:79], v[236:239]
v_exp_f32 v107, v107
M v[236:239], a[148:151], v[44:47], v[236:239]
v_cvt_pk_bf16_f32 v105, v106, v107
s_waitcnt lgkmcnt(4)
M v[240:243], a[156:159], v[32:35], v[240:243]
v_exp_f32 v120, v120
M v[240:243], a[160:163], v[64:67], v[240:243]
M v[244:247], a[160:163], v[68:71], v[244:247]
v_exp_f32 v121, v121
M v[244:247], a[156:159], v[36:39], v[244:247]
v_cvt_pk_bf16_f32 v106, v120, v121
M v[248:251], a[156:159], v[40:43], v[248:251]
v_exp_f32 v122, v122
M v[248:251], a[160:163], v[72:75], v[248:251]
s_waitcnt vmcnt(0) lgkmcnt(0)
s_barrier
ds_read_b128 a[116:119], v3 offset:0
ds_read_b128 a[120:123], v3 offset:1024
M v[252:255], a[160:163], v[76:79], v[252:255]
v_exp_f32 v123, v123
M v[252:255], a[156:159], v[44:47], v[252:255]
v_cvt_pk_bf16_f32 v107, v122, v123
M a[64:67], a[164:167], v[32:35], a[64:67]
v_exp_f32 v108, v108
M a[64:67], a[168:171], v[64:67], a[64:67]
ds_read_b128 a[124:127], v3 offset:2048
ds_read_b128 a[128:131], v3 offset:3072
M a[68:71], a[168:171], v[68:71], a[68:71]
v_exp_f32 v109, v109
M a[68:71], a[164:167], v[36:39], a[68:71]
v_cvt_pk_bf16_f32 v108, v108, v109
M a[72:75], a[164:167], v[40:43], a[72:75]
v_exp_f32 v110, v110
M a[72:75], a[168:171], v[72:75], a[72:75]
ds_read_b128 a[132:135], v3 offset:4096
ds_read_b128 a[136:139], v3 offset:5120
M a[76:79], a[168:171], v[76:79], a[76:79]
v_exp_f32 v111, v111
M a[76:79], a[164:167], v[44:47], a[76:79]
v_cvt_pk_bf16_f32 v109, v110, v111
M a[80:83], a[172:175], v[32:35], a[80:83]
v_exp_f32 v124, v124
M a[80:83], a[176:179], v[64:67], a[80:83]
ds_read_b128 a[140:143], v3 offset:6144
ds_read_b128 a[144:147], v3 offset:7168
M a[84:87], a[176:179], v[68:71], a[84:87]
v_exp_f32 v125, v125
M a[84:87], a[172:175], v[36:39], a[84:87]
v_cvt_pk_bf16_f32 v110, v124, v125
M a[88:91], a[172:175], v[40:43], a[88:91]
v_exp_f32 v126, v126
M a[88:91], a[176:179], v[72:75], a[88:91]
M a[92:95], a[176:179], v[76:79], a[92:95]
v_exp_f32 v127, v127
M a[92:95], a[172:175], v[44:47], a[92:95]
v_cvt_pk_bf16_f32 v111, v126, v127
s_add_u32 m0, s29, 0
s_waitcnt lgkmcnt(4)
M v[32:35], a[116:119], a[0:3], 0
v_exp_f32 v128, v128
M v[32:35], a[120:123], a[4:7], v[32:35]
ds_read_b128 a[148:151], v3 offset:8192
ds_read_b128 a[152:155], v3 offset:9216
M v[32:35], a[124:127], a[8:11], v[32:35]
v_exp_f32 v129, v129
M v[32:35], a[128:131], a[12:15], v[32:35]
buffer_load_dwordx4 v1, s[12:15], s25 offen offset:0 sc1 lds
s_add_u32 s32, s25, 4096
M v[36:39], a[128:131], a[28:31], 0
v_exp_f32 v130, v130
M v[36:39], a[124:127], a[24:27], v[36:39]
v_cvt_pk_bf16_f32 v128, v128, v129
M v[36:39], a[120:123], a[20:23], v[36:39]
v_exp_f32 v131, v131
M v[36:39], a[116:119], a[16:19], v[36:39]
buffer_load_dwordx4 v1, s[12:15], s25 offen offset:1024 sc1 lds
M v[40:43], a[116:119], a[32:35], 0
v_exp_f32 v144, v144
M v[40:43], a[120:123], a[36:39], v[40:43]
ds_read_b128 a[156:159], v3 offset:10240
ds_read_b128 a[160:163], v3 offset:11264
M v[40:43], a[124:127], a[40:43], v[40:43]
v_exp_f32 v145, v145
M v[40:43], a[128:131], a[44:47], v[40:43]
buffer_load_dwordx4 v1, s[12:15], s25 offen offset:2048 sc1 lds
M v[44:47], a[128:131], a[60:63], 0
v_exp_f32 v146, v146
M v[44:47], a[124:127], a[56:59], v[44:47]
v_cvt_pk_bf16_f32 v129, v130, v131
v_cvt_pk_bf16_f32 v130, v144, v145
M v[44:47], a[120:123], a[52:55], v[44:47]
v_exp_f32 v147, v147
M v[44:47], a[116:119], a[48:51], v[44:47]
buffer_load_dwordx4 v1, s[12:15], s25 offen offset:3072 sc1 lds
s_add_u32 m0, s29, 4096
s_waitcnt lgkmcnt(4)
M v[48:51], a[132:135], a[0:3], 0
v_exp_f32 v132, v132
M v[48:51], a[136:139], a[4:7], v[48:51]
ds_read_b128 a[164:167], v3 offset:12288
ds_read_b128 a[168:171], v3 offset:13312
M v[48:51], a[140:143], a[8:11], v[48:51]
v_exp_f32 v133, v133
M v[48:51], a[144:147], a[12:15], v[48:51]
buffer_load_dwordx4 v1, s[12:15], s32 offen offset:0 sc1 lds
M v[52:55], a[144:147], a[28:31], 0
v_exp_f32 v134, v134
M v[52:55], a[140:143], a[24:27], v[52:55]
v_cvt_pk_bf16_f32 v131, v146, v147
v_cvt_pk_bf16_f32 v132, v132, v133
M v[52:55], a[136:139], a[20:23], v[52:55]
v_exp_f32 v135, v135
M v[52:55], a[132:135], a[16:19], v[52:55]
buffer_load_dwordx4 v1, s[12:15], s32 offen offset:1024 sc1 lds
M v[56:59], a[132:135], a[32:35], 0
v_exp_f32 v148, v148
M v[56:59], a[136:139], a[36:39], v[56:59]
ds_read_b128 a[172:175], v3 offset:14336
ds_read_b128 a[176:179], v3 offset:15360
M v[56:59], a[140:143], a[40:43], v[56:59]
v_exp_f32 v149, v149
M v[56:59], a[144:147], a[44:47], v[56:59]
buffer_load_dwordx4 v1, s[12:15], s32 offen offset:2048 sc1 lds
M v[60:63], a[144:147], a[60:63], 0
v_exp_f32 v150, v150
M v[60:63], a[140:143], a[56:59], v[60:63]
v_cvt_pk_bf16_f32 v133, v134, v135
v_cvt_pk_bf16_f32 v134, v148, v149
M v[60:63], a[136:139], a[52:55], v[60:63]
v_exp_f32 v151, v151
M v[60:63], a[132:135], a[48:51], v[60:63]
buffer_load_dwordx4 v1, s[12:15], s32 offen offset:3072 sc1 lds
s_add_u32 m0, s29, 32768
s_waitcnt lgkmcnt(4)
M v[64:67], a[148:151], a[0:3], 0
v_exp_f32 v136, v136
M v[64:67], a[152:155], a[4:7], v[64:67]
ds_read_b128 a[116:119], v6 offset:32768
ds_read_b128 a[120:123], v6 offset:40960
M v[64:67], a[156:159], a[8:11], v[64:67]
v_exp_f32 v137, v137
M v[64:67], a[160:163], a[12:15], v[64:67]
buffer_load_dwordx4 v1, s[12:15], s26 offen offset:0 sc1 lds
s_add_u32 s43, s26, 4096
M v[68:71], a[160:163], a[28:31], 0
v_exp_f32 v138, v138
M v[68:71], a[156:159], a[24:27], v[68:71]
v_cvt_pk_bf16_f32 v135, v150, v151
v_cvt_pk_bf16_f32 v136, v136, v137
M v[68:71], a[152:155], a[20:23], v[68:71]
v_exp_f32 v139, v139
M v[68:71], a[148:151], a[16:19], v[68:71]
buffer_load_dwordx4 v1, s[12:15], s26 offen offset:1024 sc1 lds
M v[72:75], a[148:151], a[32:35], 0
v_exp_f32 v152, v152
M v[72:75], a[152:155], a[36:39], v[72:75]
ds_read_b128 a[124:127], v6 offset:33792
ds_read_b128 a[128:131], v6 offset:41984
M v[72:75], a[156:159], a[40:43], v[72:75]
v_exp_f32 v153, v153
M v[72:75], a[160:163], a[44:47], v[72:75]
buffer_load_dwordx4 v1, s[12:15], s26 offen offset:2048 sc1 lds
M v[76:79], a[160:163], a[60:63], 0
v_exp_f32 v154, v154
M v[76:79], a[156:159], a[56:59], v[76:79]
v_cvt_pk_bf16_f32 v137, v138, v139
v_cvt_pk_bf16_f32 v138, v152, v153
M v[76:79], a[152:155], a[52:55], v[76:79]
v_exp_f32 v155, v155
M v[76:79], a[148:151], a[48:51], v[76:79]
buffer_load_dwordx4 v1, s[12:15], s26 offen offset:3072 sc1 lds
s_add_u32 m0, s29, 36864
s_waitcnt lgkmcnt(4)
M v[80:83], a[164:167], a[0:3], 0
v_exp_f32 v140, v140
M v[80:83], a[168:171], a[4:7], v[80:83]
ds_read_b128 a[132:135], v6 offset:34816
ds_read_b128 a[136:139], v6 offset:43008
M v[80:83], a[172:175], a[8:11], v[80:83]
v_exp_f32 v141, v141
M v[80:83], a[176:179], a[12:15], v[80:83]
buffer_load_dwordx4 v1, s[12:15], s43 offen offset:0 sc1 lds
M v[84:87], a[176:179], a[28:31], 0
v_exp_f32 v142, v142
M v[84:87], a[172:175], a[24:27], v[84:87]
v_cvt_pk_bf16_f32 v139, v154, v155
v_cvt_pk_bf16_f32 v140, v140, v141
M v[84:87], a[168:171], a[20:23], v[84:87]
v_exp_f32 v143, v143
M v[84:87], a[164:167], a[16:19], v[84:87]
buffer_load_dwordx4 v1, s[12:15], s43 offen offset:1024 sc1 lds
M v[88:91], a[164:167], a[32:35], 0
v_exp_f32 v156, v156
M v[88:91], a[168:171], a[36:39], v[88:91]
ds_read_b128 a[140:143], v6 offset:35840
ds_read_b128 a[144:147], v6 offset:44032
M v[88:91], a[172:175], a[40:43], v[88:91]
v_exp_f32 v157, v157
M v[88:91], a[176:179], a[44:47], v[88:91]
buffer_load_dwordx4 v1, s[12:15], s43 offen offset:2048 sc1 lds
M v[92:95], a[176:179], a[60:63], 0
v_exp_f32 v158, v158
M v[92:95], a[172:175], a[56:59], v[92:95]
v_cvt_pk_bf16_f32 v141, v142, v143
v_cvt_pk_bf16_f32 v142, v156, v157
M v[92:95], a[168:171], a[52:55], v[92:95]
v_exp_f32 v159, v159
M v[92:95], a[164:167], a[48:51], v[92:95]
buffer_load_dwordx4 v1, s[12:15], s43 offen offset:3072 sc1 lds
v_cvt_pk_bf16_f32 v143, v158, v159
s_waitcnt lgkmcnt(6)
M v[160:163], a[116:119], v[96:99], v[160:163]
v_exp_f32 v32, v32
M v[160:163], a[120:123], v[128:131], v[160:163]
ds_read_b128 a[148:151], v6 offset:36864
ds_read_b128 a[152:155], v6 offset:45056
M v[164:167], a[120:123], v[132:135], v[164:167]
v_exp_f32 v33, v33
M v[164:167], a[116:119], v[100:103], v[164:167]
v_cvt_pk_bf16_f32 v32, v32, v33
M v[168:171], a[116:119], v[104:107], v[168:171]
v_exp_f32 v34, v34
M v[168:171], a[120:123], v[136:139], v[168:171]
s_add_u32 s25, s25, 32768
s_cmp_eq_u32 s25, s27
M v[172:175], a[120:123], v[140:143], v[172:175]
v_exp_f32 v35, v35
M v[172:175], a[116:119], v[108:111], v[172:175]
v_cvt_pk_bf16_f32 v33, v34, v35
s_waitcnt lgkmcnt(6)
M a[96:99], a[112:115], v[96:99], a[96:99]
s_cselect_b32 s25, s28, s25
s_cselect_b32 s27, s56, s27
M a[96:99], a[112:115], v[128:131], a[96:99]
s_cselect_b32 s28, s57, s28
s_cselect_b32 s56, -1, s56
M v[176:179], a[124:127], v[96:99], v[176:179]
v_exp_f32 v48, v48
M v[176:179], a[128:131], v[128:131], v[176:179]
ds_read_b128 a[156:159], v6 offset:37888
ds_read_b128 a[160:163], v6 offset:46080
M v[180:183], a[128:131], v[132:135], v[180:183]
v_exp_f32 v49, v49
M v[180:183], a[124:127], v[100:103], v[180:183]
v_cvt_pk_bf16_f32 v34, v48, v49
M v[184:187], a[124:127], v[104:107], v[184:187]
v_exp_f32 v50, v50
M v[184:187], a[128:131], v[136:139], v[184:187]
s_add_u32 s26, s26, 32768
s_cmp_eq_u32 s26, s62
M v[188:191], a[128:131], v[140:143], v[188:191]
v_exp_f32 v51, v51
M v[188:191], a[124:127], v[108:111], v[188:191]
v_cvt_pk_bf16_f32 v35, v50, v51
s_waitcnt lgkmcnt(6)
M a[100:103], a[112:115], v[100:103], a[100:103]
s_cselect_b32 s26, s63, s26
s_cselect_b32 s62, s58, s62
M a[100:103], a[112:115], v[132:135], a[100:103]
s_cselect_b32 s63, s59, s63
s_cselect_b32 s58, -1, s58
M v[192:195], a[132:135], v[96:99], v[192:195]
v_exp_f32 v36, v36
M v[192:195], a[136:139], v[128:131], v[192:195]
ds_read_b128 a[164:167], v6 offset:38912
ds_read_b128 a[168:171], v6 offset:47104
M v[196:199], a[136:139], v[132:135], v[196:199]
v_exp_f32 v37, v37
M v[196:199], a[132:135], v[100:103], v[196:199]
v_cvt_pk_bf16_f32 v36, v36, v37
M v[200:203], a[132:135], v[104:107], v[200:203]
v_exp_f32 v38, v38
M v[200:203], a[136:139], v[136:139], v[200:203]
s_sub_u32 s33, s42, 1
s_cmp_le_u32 s33, 1
s_cselect_b32 s33, 0x4000, 0
v_add_u32 v3, s33, v3
M v[204:207], a[136:139], v[140:143], v[204:207]
v_exp_f32 v39, v39
M v[204:207], a[132:135], v[108:111], v[204:207]
v_cvt_pk_bf16_f32 v37, v38, v39
s_waitcnt lgkmcnt(6)
M a[104:107], a[112:115], v[104:107], a[104:107]
M a[104:107], a[112:115], v[136:139], a[104:107]
M v[208:211], a[140:143], v[96:99], v[208:211]
v_exp_f32 v52, v52
M v[208:211], a[144:147], v[128:131], v[208:211]
ds_read_b128 a[172:175], v6 offset:39936
ds_read_b128 a[176:179], v6 offset:48128
M v[212:215], a[144:147], v[132:135], v[212:215]
v_exp_f32 v53, v53
M v[212:215], a[140:143], v[100:103], v[212:215]
v_cvt_pk_bf16_f32 v38, v52, v53
M v[216:219], a[140:143], v[104:107], v[216:219]
v_exp_f32 v54, v54
M v[216:219], a[144:147], v[136:139], v[216:219]
M v[220:223], a[144:147], v[140:143], v[220:223]
v_exp_f32 v55, v55
M v[220:223], a[140:143], v[108:111], v[220:223]
v_cvt_pk_bf16_f32 v39, v54, v55
s_waitcnt lgkmcnt(6)
M a[108:111], a[112:115], v[108:111], a[108:111]
M a[108:111], a[112:115], v[140:143], a[108:111]
M v[224:227], a[148:151], v[96:99], v[224:227]
v_exp_f32 v40, v40
M v[224:227], a[152:155], v[128:131], v[224:227]
s_cmp_le_u32 s42, 1
s_cselect_b32 s33, 0x4000, 0
v_add_u32 v6, s33, v6
s_sub_u32 s42, s42, 1
M v[228:231], a[152:155], v[132:135], v[228:231]
v_exp_f32 v41, v41
M v[228:231], a[148:151], v[100:103], v[228:231]
v_cvt_pk_bf16_f32 v40, v40, v41
M v[232:235], a[148:151], v[104:107], v[232:235]
v_exp_f32 v42, v42
M v[232:235], a[152:155], v[136:139], v[232:235]
M v[236:239], a[152:155], v[140:143], v[236:239]
v_exp_f32 v43, v43
M v[236:239], a[148:151], v[108:111], v[236:239]
v_cvt_pk_bf16_f32 v41, v42, v43
s_waitcnt lgkmcnt(4)
M v[240:243], a[156:159], v[96:99], v[240:243]
v_exp_f32 v56, v56
M v[240:243], a[160:163], v[128:131], v[240:243]
M v[244:247], a[160:163], v[132:135], v[244:247]
v_exp_f32 v57, v57
M v[244:247], a[156:159], v[100:103], v[244:247]
v_cvt_pk_bf16_f32 v42, v56, v57
M v[248:251], a[156:159], v[104:107], v[248:251]
v_exp_f32 v58, v58
M v[248:251], a[160:163], v[136:139], v[248:251]
s_waitcnt vmcnt(0) lgkmcnt(0)
s_barrier
ds_read_b128 a[116:119], v2 offset:0
ds_read_b128 a[120:123], v2 offset:1024
M v[252:255], a[160:163], v[140:143], v[252:255]
v_exp_f32 v59, v59
M v[252:255], a[156:159], v[108:111], v[252:255]
v_cvt_pk_bf16_f32 v43, v58, v59
M a[64:67], a[164:167], v[96:99], a[64:67]
v_exp_f32 v44, v44
M a[64:67], a[168:171], v[128:131], a[64:67]
ds_read_b128 a[124:127], v2 offset:2048
ds_read_b128 a[128:131], v2 offset:3072
M a[68:71], a[168:171], v[132:135], a[68:71]
v_exp_f32 v45, v45
M a[68:71], a[164:167], v[100:103], a[68:71]
v_cvt_pk_bf16_f32 v44, v44, v45
M a[72:75], a[164:167], v[104:107], a[72:75]
v_exp_f32 v46, v46
M a[72:75], a[168:171], v[136:139], a[72:75]
ds_read_b128 a[132:135], v2 offset:4096
ds_read_b128 a[136:139], v2 offset:5120
M a[76:79], a[168:171], v[140:143], a[76:79]
v_exp_f32 v47, v47
M a[76:79], a[164:167], v[108:111], a[76:79]
v_cvt_pk_bf16_f32 v45, v46, v47
M a[80:83], a[172:175], v[96:99], a[80:83]
v_exp_f32 v60, v60
M a[80:83], a[176:179], v[128:131], a[80:83]
ds_read_b128 a[140:143], v2 offset:6144
ds_read_b128 a[144:147], v2 offset:7168
M a[84:87], a[176:179], v[132:135], a[84:87]
v_exp_f32 v61, v61
M a[84:87], a[172:175], v[100:103], a[84:87]
v_cvt_pk_bf16_f32 v46, v60, v61
M a[88:91], a[172:175], v[104:107], a[88:91]
v_exp_f32 v62, v62
M a[88:91], a[176:179], v[136:139], a[88:91]
M a[92:95], a[176:179], v[140:143], a[92:95]
v_exp_f32 v63, v63
M a[92:95], a[172:175], v[108:111], a[92:95]
v_cvt_pk_bf16_f32 v47, v62, v63
s_sub_u32 s30, s30, 1
s_cmp_lg_u32 s30, 0
s_cbranch_scc1 Lk2_l3
s_cmp_eq_u32 s23, 1
s_cbranch_scc1 Lk2_g1b
s_sub_u32 s39, s101, 2
s_getpc_b64 s[36:37]
Lpce00:
s_add_u32 s36, s36, Lk2_done-Lpce00
s_addc_u32 s37, s37, 0
s_lshr_b32 s38, s2, 3
s_lshl2_add_u32 s38, s38, s101
s_mul_i32 s38, s38, (((Lc3-Lk2_done)/128+127)&~127)
v_lshlrev_b32 v8, 7, v0
v_min_u32 v8, (((Lc3-Lk2_done)/128+127)&~127)-128, v8
v_add_u32 v8, s38, v8
v_min_u32 v8, Lc3-Lk2_done-4, v8
global_load_dword a247, v8, s[36:37]
s_getpc_b64 s[36:37]
Lpce01:
s_add_u32 s36, s36, Lk2_done-Lpce01
s_addc_u32 s37, s37, 0
s_lshr_b32 s38, s2, 3
s_lshl2_add_u32 s38, s38, s39
s_mul_i32 s38, s38, (((Lc3-Lk2_done)/128+127)&~127)
v_lshlrev_b32 v8, 7, v0
v_min_u32 v8, (((Lc3-Lk2_done)/128+127)&~127)-128, v8
v_add_u32 v8, s38, v8
v_min_u32 v8, Lc3-Lk2_done-4, v8
global_load_dword a248, v8, s[36:37]
s_add_u32 m0, s29, 65536
s_waitcnt lgkmcnt(4)
M v[96:99], a[116:119], a[0:3], v[16:19]
v_exp_f32 v64, v64
M v[96:99], a[120:123], a[4:7], v[96:99]
ds_read_b128 a[148:151], v2 offset:8192
ds_read_b128 a[152:155], v2 offset:9216
M v[96:99], a[124:127], a[8:11], v[96:99]
v_exp_f32 v65, v65
M v[96:99], a[128:131], a[12:15], v[96:99]
buffer_load_dwordx4 v1, s[12:15], s25 offen offset:0 sc1 lds
s_add_u32 s32, s25, 4096
M v[100:103], a[128:131], a[28:31], 0
v_exp_f32 v66, v66
M v[100:103], a[124:127], a[24:27], v[100:103]
v_cvt_pk_bf16_f32 v64, v64, v65
M v[100:103], a[120:123], a[20:23], v[100:103]
v_exp_f32 v67, v67
M v[100:103], a[116:119], a[16:19], v[100:103]
buffer_load_dwordx4 v1, s[12:15], s25 offen offset:1024 sc1 lds
M v[104:107], a[116:119], a[32:35], 0
v_exp_f32 v80, v80
M v[104:107], a[120:123], a[36:39], v[104:107]
ds_read_b128 a[156:159], v2 offset:10240
ds_read_b128 a[160:163], v2 offset:11264
M v[104:107], a[124:127], a[40:43], v[104:107]
v_exp_f32 v81, v81
M v[104:107], a[128:131], a[44:47], v[104:107]
buffer_load_dwordx4 v1, s[12:15], s25 offen offset:2048 sc1 lds
M v[108:111], a[128:131], a[60:63], 0
v_exp_f32 v82, v82
M v[108:111], a[124:127], a[56:59], v[108:111]
v_cvt_pk_bf16_f32 v65, v66, v67
v_cvt_pk_bf16_f32 v66, v80, v81
M v[108:111], a[120:123], a[52:55], v[108:111]
v_exp_f32 v83, v83
M v[108:111], a[116:119], a[48:51], v[108:111]
buffer_load_dwordx4 v1, s[12:15], s25 offen offset:3072 sc1 lds
s_add_u32 m0, s29, 69632
s_waitcnt lgkmcnt(4)
v_exp_f32 v68, v68
ds_read_b128 a[164:167], v2 offset:12288
ds_read_b128 a[168:171], v2 offset:13312
v_exp_f32 v69, v69
buffer_load_dwordx4 v1, s[12:15], s32 offen offset:0 sc1 lds
M v[116:119], a[144:147], a[28:31], v[16:19]
v_exp_f32 v70, v70
M v[116:119], a[140:143], a[24:27], v[116:119]
v_cvt_pk_bf16_f32 v67, v82, v83
v_cvt_pk_bf16_f32 v68, v68, v69
M v[116:119], a[136:139], a[20:23], v[116:119]
v_exp_f32 v71, v71
M v[116:119], a[132:135], a[16:19], v[116:119]
buffer_load_dwordx4 v1, s[12:15], s32 offen offset:1024 sc1 lds
M v[120:123], a[132:135], a[32:35], 0
v_exp_f32 v84, v84
M v[120:123], a[136:139], a[36:39], v[120:123]
ds_read_b128 a[172:175], v2 offset:14336
ds_read_b128 a[176:179], v2 offset:15360
M v[120:123], a[140:143], a[40:43], v[120:123]
v_exp_f32 v85, v85
M v[120:123], a[144:147], a[44:47], v[120:123]
buffer_load_dwordx4 v1, s[12:15], s32 offen offset:2048 sc1 lds
M v[124:127], a[144:147], a[60:63], 0
v_exp_f32 v86, v86
M v[124:127], a[140:143], a[56:59], v[124:127]
v_cvt_pk_bf16_f32 v69, v70, v71
v_cvt_pk_bf16_f32 v70, v84, v85
M v[124:127], a[136:139], a[52:55], v[124:127]
v_exp_f32 v87, v87
M v[124:127], a[132:135], a[48:51], v[124:127]
buffer_load_dwordx4 v1, s[12:15], s32 offen offset:3072 sc1 lds
s_add_u32 m0, s29, 98304
s_waitcnt lgkmcnt(4)
v_exp_f32 v72, v72
ds_read_b128 a[116:119], v5 offset:32768
ds_read_b128 a[120:123], v5 offset:40960
v_exp_f32 v73, v73
buffer_load_dwordx4 v1, s[12:15], s26 offen offset:0 sc1 lds
s_add_u32 s43, s26, 4096
v_exp_f32 v74, v74
v_cvt_pk_bf16_f32 v71, v86, v87
v_cvt_pk_bf16_f32 v72, v72, v73
v_exp_f32 v75, v75
buffer_load_dwordx4 v1, s[12:15], s26 offen offset:1024 sc1 lds
M v[136:139], a[148:151], a[32:35], v[16:19]
v_exp_f32 v88, v88
M v[136:139], a[152:155], a[36:39], v[136:139]
ds_read_b128 a[124:127], v5 offset:33792
ds_read_b128 a[128:131], v5 offset:41984
M v[136:139], a[156:159], a[40:43], v[136:139]
v_exp_f32 v89, v89
M v[136:139], a[160:163], a[44:47], v[136:139]
buffer_load_dwordx4 v1, s[12:15], s26 offen offset:2048 sc1 lds
M v[140:143], a[160:163], a[60:63], 0
v_exp_f32 v90, v90
M v[140:143], a[156:159], a[56:59], v[140:143]
v_cvt_pk_bf16_f32 v73, v74, v75
v_cvt_pk_bf16_f32 v74, v88, v89
M v[140:143], a[152:155], a[52:55], v[140:143]
v_exp_f32 v91, v91
M v[140:143], a[148:151], a[48:51], v[140:143]
buffer_load_dwordx4 v1, s[12:15], s26 offen offset:3072 sc1 lds
s_add_u32 m0, s29, 102400
s_waitcnt lgkmcnt(4)
v_exp_f32 v76, v76
ds_read_b128 a[132:135], v5 offset:34816
ds_read_b128 a[136:139], v5 offset:43008
v_exp_f32 v77, v77
buffer_load_dwordx4 v1, s[12:15], s43 offen offset:0 sc1 lds
v_exp_f32 v78, v78
v_cvt_pk_bf16_f32 v75, v90, v91
v_cvt_pk_bf16_f32 v76, v76, v77
v_exp_f32 v79, v79
buffer_load_dwordx4 v1, s[12:15], s43 offen offset:1024 sc1 lds
v_exp_f32 v92, v92
ds_read_b128 a[140:143], v5 offset:35840
ds_read_b128 a[144:147], v5 offset:44032
v_exp_f32 v93, v93
buffer_load_dwordx4 v1, s[12:15], s43 offen offset:2048 sc1 lds
M v[156:159], a[176:179], a[60:63], v[16:19]
v_exp_f32 v94, v94
M v[156:159], a[172:175], a[56:59], v[156:159]
v_cvt_pk_bf16_f32 v77, v78, v79
v_cvt_pk_bf16_f32 v78, v92, v93
M v[156:159], a[168:171], a[52:55], v[156:159]
v_exp_f32 v95, v95
M v[156:159], a[164:167], a[48:51], v[156:159]
buffer_load_dwordx4 v1, s[12:15], s43 offen offset:3072 sc1 lds
v_cvt_pk_bf16_f32 v79, v94, v95
s_waitcnt lgkmcnt(6)
M v[160:163], a[116:119], v[32:35], v[160:163]
v_exp_f32 v96, v96
M v[160:163], a[120:123], v[64:67], v[160:163]
ds_read_b128 a[148:151], v5 offset:36864
ds_read_b128 a[152:155], v5 offset:45056
M v[164:167], a[120:123], v[68:71], v[164:167]
v_exp_f32 v97, v97
M v[164:167], a[116:119], v[36:39], v[164:167]
v_cvt_pk_bf16_f32 v96, v96, v97
M v[168:171], a[116:119], v[40:43], v[168:171]
v_exp_f32 v98, v98
M v[168:171], a[120:123], v[72:75], v[168:171]
s_add_u32 s25, s25, 32768
s_cmp_eq_u32 s25, s27
M v[172:175], a[120:123], v[76:79], v[172:175]
v_exp_f32 v99, v99
M v[172:175], a[116:119], v[44:47], v[172:175]
v_cvt_pk_bf16_f32 v97, v98, v99
s_waitcnt lgkmcnt(6)
M a[96:99], a[112:115], v[32:35], a[96:99]
s_cselect_b32 s25, s28, s25
s_cselect_b32 s27, s56, s27
M a[96:99], a[112:115], v[64:67], a[96:99]
s_cselect_b32 s28, s57, s28
s_cselect_b32 s56, -1, s56
M v[176:179], a[124:127], v[32:35], v[176:179]
M v[176:179], a[128:131], v[64:67], v[176:179]
ds_read_b128 a[156:159], v5 offset:37888
ds_read_b128 a[160:163], v5 offset:46080
M v[180:183], a[128:131], v[68:71], v[180:183]
M v[180:183], a[124:127], v[36:39], v[180:183]
v_mov_b32 v98, 0
M v[184:187], a[124:127], v[40:43], v[184:187]
M v[184:187], a[128:131], v[72:75], v[184:187]
s_add_u32 s26, s26, 32768
s_cmp_eq_u32 s26, s62
M v[188:191], a[128:131], v[76:79], v[188:191]
M v[188:191], a[124:127], v[44:47], v[188:191]
v_mov_b32 v99, 0
s_waitcnt lgkmcnt(6)
M a[100:103], a[112:115], v[36:39], a[100:103]
s_cselect_b32 s26, s63, s26
s_cselect_b32 s62, s58, s62
M a[100:103], a[112:115], v[68:71], a[100:103]
s_cselect_b32 s63, s59, s63
s_cselect_b32 s58, -1, s58
M v[192:195], a[132:135], v[32:35], v[192:195]
v_exp_f32 v100, v100
M v[192:195], a[136:139], v[64:67], v[192:195]
ds_read_b128 a[164:167], v5 offset:38912
ds_read_b128 a[168:171], v5 offset:47104
M v[196:199], a[136:139], v[68:71], v[196:199]
v_exp_f32 v101, v101
M v[196:199], a[132:135], v[36:39], v[196:199]
v_cvt_pk_bf16_f32 v100, v100, v101
M v[200:203], a[132:135], v[40:43], v[200:203]
v_exp_f32 v102, v102
M v[200:203], a[136:139], v[72:75], v[200:203]
s_sub_u32 s33, s42, 1
s_cmp_le_u32 s33, 1
s_cselect_b32 s33, 0x4000, 0
v_add_u32 v2, s33, v2
M v[204:207], a[136:139], v[76:79], v[204:207]
v_exp_f32 v103, v103
M v[204:207], a[132:135], v[44:47], v[204:207]
v_cvt_pk_bf16_f32 v101, v102, v103
s_waitcnt lgkmcnt(6)
M a[104:107], a[112:115], v[40:43], a[104:107]
M a[104:107], a[112:115], v[72:75], a[104:107]
M v[208:211], a[140:143], v[32:35], v[208:211]
v_exp_f32 v116, v116
M v[208:211], a[144:147], v[64:67], v[208:211]
ds_read_b128 a[172:175], v5 offset:39936
ds_read_b128 a[176:179], v5 offset:48128
M v[212:215], a[144:147], v[68:71], v[212:215]
v_exp_f32 v117, v117
M v[212:215], a[140:143], v[36:39], v[212:215]
v_cvt_pk_bf16_f32 v102, v116, v117
M v[216:219], a[140:143], v[40:43], v[216:219]
v_exp_f32 v118, v118
M v[216:219], a[144:147], v[72:75], v[216:219]
M v[220:223], a[144:147], v[76:79], v[220:223]
v_exp_f32 v119, v119
M v[220:223], a[140:143], v[44:47], v[220:223]
v_cvt_pk_bf16_f32 v103, v118, v119
s_waitcnt lgkmcnt(6)
M a[108:111], a[112:115], v[44:47], a[108:111]
M a[108:111], a[112:115], v[76:79], a[108:111]
M v[224:227], a[148:151], v[32:35], v[224:227]
v_exp_f32 v104, v104
M v[224:227], a[152:155], v[64:67], v[224:227]
s_cmp_le_u32 s42, 1
s_cselect_b32 s33, 0x4000, 0
v_add_u32 v5, s33, v5
s_sub_u32 s42, s42, 1
M v[228:231], a[152:155], v[68:71], v[228:231]
v_exp_f32 v105, v105
M v[228:231], a[148:151], v[36:39], v[228:231]
v_cvt_pk_bf16_f32 v104, v104, v105
M v[232:235], a[148:151], v[40:43], v[232:235]
v_exp_f32 v106, v106
M v[232:235], a[152:155], v[72:75], v[232:235]
M v[236:239], a[152:155], v[76:79], v[236:239]
v_exp_f32 v107, v107
M v[236:239], a[148:151], v[44:47], v[236:239]
v_cvt_pk_bf16_f32 v105, v106, v107
s_waitcnt lgkmcnt(4)
M v[240:243], a[156:159], v[32:35], v[240:243]
v_exp_f32 v120, v120
M v[240:243], a[160:163], v[64:67], v[240:243]
M v[244:247], a[160:163], v[68:71], v[244:247]
v_exp_f32 v121, v121
M v[244:247], a[156:159], v[36:39], v[244:247]
v_cvt_pk_bf16_f32 v106, v120, v121
M v[248:251], a[156:159], v[40:43], v[248:251]
v_exp_f32 v122, v122
M v[248:251], a[160:163], v[72:75], v[248:251]
s_waitcnt vmcnt(0) lgkmcnt(0)
s_barrier
ds_read_b128 a[116:119], v3 offset:0
ds_read_b128 a[120:123], v3 offset:1024
M v[252:255], a[160:163], v[76:79], v[252:255]
v_exp_f32 v123, v123
M v[252:255], a[156:159], v[44:47], v[252:255]
v_cvt_pk_bf16_f32 v107, v122, v123
M a[64:67], a[164:167], v[32:35], a[64:67]
v_exp_f32 v108, v108
M a[64:67], a[168:171], v[64:67], a[64:67]
ds_read_b128 a[124:127], v3 offset:2048
ds_read_b128 a[128:131], v3 offset:3072
M a[68:71], a[168:171], v[68:71], a[68:71]
v_exp_f32 v109, v109
M a[68:71], a[164:167], v[36:39], a[68:71]
v_cvt_pk_bf16_f32 v108, v108, v109
M a[72:75], a[164:167], v[40:43], a[72:75]
v_exp_f32 v110, v110
M a[72:75], a[168:171], v[72:75], a[72:75]
ds_read_b128 a[132:135], v3 offset:4096
ds_read_b128 a[136:139], v3 offset:5120
M a[76:79], a[168:171], v[76:79], a[76:79]
v_exp_f32 v111, v111
M a[76:79], a[164:167], v[44:47], a[76:79]
v_cvt_pk_bf16_f32 v109, v110, v111
M a[80:83], a[172:175], v[32:35], a[80:83]
v_exp_f32 v124, v124
M a[80:83], a[176:179], v[64:67], a[80:83]
ds_read_b128 a[140:143], v3 offset:6144
ds_read_b128 a[144:147], v3 offset:7168
M a[84:87], a[176:179], v[68:71], a[84:87]
v_exp_f32 v125, v125
M a[84:87], a[172:175], v[36:39], a[84:87]
v_cvt_pk_bf16_f32 v110, v124, v125
M a[88:91], a[172:175], v[40:43], a[88:91]
v_exp_f32 v126, v126
M a[88:91], a[176:179], v[72:75], a[88:91]
M a[92:95], a[176:179], v[76:79], a[92:95]
v_exp_f32 v127, v127
M a[92:95], a[172:175], v[44:47], a[92:95]
v_cvt_pk_bf16_f32 v111, v126, v127
s_add_u32 m0, s29, 0
s_nop 0
buffer_load_dwordx4 v1, s[12:15], s25 offen offset:0 sc1 lds
s_add_u32 s32, s25, 4096
buffer_load_dwordx4 v1, s[12:15], s25 offen offset:1024 sc1 lds
buffer_load_dwordx4 v1, s[12:15], s25 offen offset:2048 sc1 lds
buffer_load_dwordx4 v1, s[12:15], s25 offen offset:3072 sc1 lds
s_add_u32 m0, s29, 4096
s_nop 0
buffer_load_dwordx4 v1, s[12:15], s32 offen offset:0 sc1 lds
buffer_load_dwordx4 v1, s[12:15], s32 offen offset:1024 sc1 lds
buffer_load_dwordx4 v1, s[12:15], s32 offen offset:2048 sc1 lds
buffer_load_dwordx4 v1, s[12:15], s32 offen offset:3072 sc1 lds
s_add_u32 m0, s29, 32768
v_exp_f32 v136, v136
s_waitcnt lgkmcnt(7)
ds_read_b128 a[116:119], v6 offset:32768
s_waitcnt lgkmcnt(7)
ds_read_b128 a[120:123], v6 offset:40960
v_exp_f32 v137, v137
buffer_load_dwordx4 v1, s[12:15], s26 offen offset:0 sc1 lds
s_add_u32 s43, s26, 4096
v_exp_f32 v138, v138
v_cvt_pk_bf16_f32 v136, v136, v137
v_exp_f32 v139, v139
buffer_load_dwordx4 v1, s[12:15], s26 offen offset:1024 sc1 lds
s_waitcnt lgkmcnt(7)
ds_read_b128 a[124:127], v6 offset:33792
s_waitcnt lgkmcnt(7)
ds_read_b128 a[128:131], v6 offset:41984
buffer_load_dwordx4 v1, s[12:15], s26 offen offset:2048 sc1 lds
v_cvt_pk_bf16_f32 v137, v138, v139
v_mov_b32 v138, 0
buffer_load_dwordx4 v1, s[12:15], s26 offen offset:3072 sc1 lds
s_add_u32 m0, s29, 36864
v_exp_f32 v140, v140
s_waitcnt lgkmcnt(7)
ds_read_b128 a[132:135], v6 offset:34816
s_waitcnt lgkmcnt(7)
ds_read_b128 a[136:139], v6 offset:43008
v_exp_f32 v141, v141
buffer_load_dwordx4 v1, s[12:15], s43 offen offset:0 sc1 lds
v_exp_f32 v142, v142
v_mov_b32 v139, 0
v_cvt_pk_bf16_f32 v140, v140, v141
v_exp_f32 v143, v143
buffer_load_dwordx4 v1, s[12:15], s43 offen offset:1024 sc1 lds
v_exp_f32 v156, v156
s_waitcnt lgkmcnt(7)
ds_read_b128 a[140:143], v6 offset:35840
s_waitcnt lgkmcnt(7)
ds_read_b128 a[144:147], v6 offset:44032
v_exp_f32 v157, v157
buffer_load_dwordx4 v1, s[12:15], s43 offen offset:2048 sc1 lds
v_exp_f32 v158, v158
v_cvt_pk_bf16_f32 v141, v142, v143
v_cvt_pk_bf16_f32 v142, v156, v157
v_exp_f32 v159, v159
buffer_load_dwordx4 v1, s[12:15], s43 offen offset:3072 sc1 lds
v_cvt_pk_bf16_f32 v143, v158, v159
s_waitcnt lgkmcnt(6)
M v[160:163], a[116:119], v[96:99], v[160:163]
ds_read_b128 a[148:151], v6 offset:36864
ds_read_b128 a[152:155], v6 offset:45056
M v[164:167], a[116:119], v[100:103], v[164:167]
M v[168:171], a[116:119], v[104:107], v[168:171]
M v[168:171], a[120:123], v[136:139], v[168:171]
s_add_u32 s25, s25, 32768
s_cmp_eq_u32 s25, s27
M v[172:175], a[120:123], v[140:143], v[172:175]
M v[172:175], a[116:119], v[108:111], v[172:175]
s_waitcnt lgkmcnt(6)
M a[96:99], a[112:115], v[96:99], a[96:99]
s_cselect_b32 s25, s28, s25
s_cselect_b32 s27, s56, s27
s_cselect_b32 s28, s57, s28
s_cselect_b32 s56, -1, s56
M v[176:179], a[124:127], v[96:99], v[176:179]
ds_read_b128 a[156:159], v6 offset:37888
ds_read_b128 a[160:163], v6 offset:46080
M v[180:183], a[124:127], v[100:103], v[180:183]
M v[184:187], a[124:127], v[104:107], v[184:187]
M v[184:187], a[128:131], v[136:139], v[184:187]
s_add_u32 s26, s26, 32768
s_cmp_eq_u32 s26, s62
M v[188:191], a[128:131], v[140:143], v[188:191]
M v[188:191], a[124:127], v[108:111], v[188:191]
s_waitcnt lgkmcnt(6)
M a[100:103], a[112:115], v[100:103], a[100:103]
s_cselect_b32 s26, s63, s26
s_cselect_b32 s62, s58, s62
s_cselect_b32 s63, s59, s63
s_cselect_b32 s58, -1, s58
M v[192:195], a[132:135], v[96:99], v[192:195]
ds_read_b128 a[164:167], v6 offset:38912
ds_read_b128 a[168:171], v6 offset:47104
M v[196:199], a[132:135], v[100:103], v[196:199]
M v[200:203], a[132:135], v[104:107], v[200:203]
M v[200:203], a[136:139], v[136:139], v[200:203]
s_sub_u32 s33, s42, 1
s_cmp_le_u32 s33, 1
s_cselect_b32 s33, 0x4000, 0
v_add_u32 v3, s33, v3
M v[204:207], a[136:139], v[140:143], v[204:207]
M v[204:207], a[132:135], v[108:111], v[204:207]
s_waitcnt lgkmcnt(6)
M a[104:107], a[112:115], v[104:107], a[104:107]
M a[104:107], a[112:115], v[136:139], a[104:107]
M v[208:211], a[140:143], v[96:99], v[208:211]
ds_read_b128 a[172:175], v6 offset:39936
ds_read_b128 a[176:179], v6 offset:48128
M v[212:215], a[140:143], v[100:103], v[212:215]
M v[216:219], a[140:143], v[104:107], v[216:219]
M v[216:219], a[144:147], v[136:139], v[216:219]
M v[220:223], a[144:147], v[140:143], v[220:223]
M v[220:223], a[140:143], v[108:111], v[220:223]
s_waitcnt lgkmcnt(6)
M a[108:111], a[112:115], v[108:111], a[108:111]
M a[108:111], a[112:115], v[140:143], a[108:111]
M v[224:227], a[148:151], v[96:99], v[224:227]
s_cmp_le_u32 s42, 1
s_cselect_b32 s33, 0x4000, 0
v_add_u32 v6, s33, v6
s_sub_u32 s42, s42, 1
M v[228:231], a[148:151], v[100:103], v[228:231]
M v[232:235], a[148:151], v[104:107], v[232:235]
M v[232:235], a[152:155], v[136:139], v[232:235]
M v[236:239], a[152:155], v[140:143], v[236:239]
M v[236:239], a[148:151], v[108:111], v[236:239]
s_waitcnt lgkmcnt(4)
M v[240:243], a[156:159], v[96:99], v[240:243]
M v[244:247], a[156:159], v[100:103], v[244:247]
M v[248:251], a[156:159], v[104:107], v[248:251]
M v[248:251], a[160:163], v[136:139], v[248:251]
s_waitcnt vmcnt(0) lgkmcnt(0)
s_barrier
ds_read_b128 a[116:119], v2 offset:0
ds_read_b128 a[120:123], v2 offset:1024
M v[252:255], a[160:163], v[140:143], v[252:255]
M v[252:255], a[156:159], v[108:111], v[252:255]
M a[64:67], a[164:167], v[96:99], a[64:67]
ds_read_b128 a[124:127], v2 offset:2048
ds_read_b128 a[128:131], v2 offset:3072
M a[68:71], a[164:167], v[100:103], a[68:71]
M a[72:75], a[164:167], v[104:107], a[72:75]
M a[72:75], a[168:171], v[136:139], a[72:75]
ds_read_b128 a[132:135], v2 offset:4096
ds_read_b128 a[136:139], v2 offset:5120
M a[76:79], a[168:171], v[140:143], a[76:79]
M a[76:79], a[164:167], v[108:111], a[76:79]
M a[80:83], a[172:175], v[96:99], a[80:83]
ds_read_b128 a[140:143], v2 offset:6144
ds_read_b128 a[144:147], v2 offset:7168
M a[84:87], a[172:175], v[100:103], a[84:87]
M a[88:91], a[172:175], v[104:107], a[88:91]
M a[88:91], a[176:179], v[136:139], a[88:91]
M a[92:95], a[176:179], v[140:143], a[92:95]
M a[92:95], a[172:175], v[108:111], a[92:95]
s_and_b32 s3, s2, 3
s_lshl_b32 s3, s3, 2
s_bfe_u32 s27, s2, 0x20003
s_add_u32 s27, s3, s27
s_lshl_b32 s43, s27, 8
s_add_u32 s43, s43, 16789504
v_lshlrev_b32 v15, 2, v0
buffer_load_dword v7, v15, s[52:55], s43 offen sc1
s_lshl_b32 s33, s23, 14
s_add_u32 s34, s33, 131072
s_add_u32 s33, s33, 98304
v_add_u32 v2, s34, v1
v_add_u32 v3, s33, v1
s_mov_b32 s61, 0
s_bfe_u32 s3, s2, 0x10002
s_lshl_b32 s3, s3, 3
s_lshr_b32 s28, s2, 5
s_add_u32 s28, s3, s28
s_lshl_b32 s25, s27, 18
s_lshl_b32 s3, s101, 12
s_add_u32 s25, s25, s3
s_lshl_b32 s26, s28, 7
s_lshl_b32 s42, s101, 11
s_add_u32 s44, s4, 83886080
s_addc_u32 s45, s5, 0
s_mov_b32 s46, 4194304
s_mov_b32 s47, 0x00020000
s_mov_b32 s50, 2097152
s_mov_b32 s51, 0x00020000
s_lshl_b32 s3, s101, 4
v_lshrrev_b32 v96, 3, v0
v_and_b32 v97, 6, v96
ds_write_b128 v2, v[160:163] offset:0
v_and_b32 v98, 7, v0
ds_write_b128 v2, v[164:167] offset:1024
v_xor_b32 v97, v97, v98
ds_write_b128 v2, v[168:171] offset:2048
v_add_u32 v96, s3, v96
ds_write_b128 v2, v[172:175] offset:3072
v_lshlrev_b32 v96, 11, v96
ds_write_b128 v2, v[176:179] offset:4096
v_lshl_add_u32 v99, v97, 4, v96
v_add_u32 v100, 15360, v99
ds_write_b128 v2, v[180:183] offset:5120
s_waitcnt vmcnt(0) lgkmcnt(0)
s_barrier
ds_write_b128 v2, v[184:187] offset:6144
v_cmp_ne_u32 vcc, 1, v7
s_nop 0
s_cbranch_vccnz Lk3_spinb3
Lk3_gotb3:
s_add_u32 m0, s42, 16384
s_nop 0
buffer_load_dwordx4 v99, s[48:51], s26 offen offset:0 lds
ds_write_b128 v2, v[188:191] offset:7168
buffer_load_dwordx4 v100, s[48:51], s26 offen offset:1024 lds
ds_write_b128 v2, v[192:195] offset:8192
buffer_load_dwordx4 a[192:195], v1, s[44:47], s25 offen offset:0 sc1
buffer_load_dwordx4 a[196:199], v1, s[44:47], s25 offen offset:1024 sc1
ds_write_b128 v2, v[196:199] offset:9216
buffer_load_dwordx4 a[200:203], v1, s[44:47], s25 offen offset:2048 sc1
buffer_load_dwordx4 a[204:207], v1, s[44:47], s25 offen offset:3072 sc1
ds_write_b128 v2, v[200:203] offset:10240
s_add_u32 s25, s25, 16384
s_add_u32 s26, s26, 131072
ds_write_b128 v2, v[204:207] offset:11264
s_add_u32 m0, s42, 32768
s_nop 0
buffer_load_dwordx4 v99, s[48:51], s26 offen offset:0 lds
buffer_load_dwordx4 v100, s[48:51], s26 offen offset:1024 lds
ds_write_b128 v2, v[208:211] offset:12288
buffer_load_dwordx4 a[224:227], v1, s[44:47], s25 offen offset:0 sc1
ds_write_b128 v2, v[212:215] offset:13312
buffer_load_dwordx4 a[228:231], v1, s[44:47], s25 offen offset:1024 sc1
buffer_load_dwordx4 a[232:235], v1, s[44:47], s25 offen offset:2048 sc1
ds_write_b128 v2, v[216:219] offset:14336
buffer_load_dwordx4 a[236:239], v1, s[44:47], s25 offen offset:3072 sc1
s_add_u32 s25, s25, 16384
s_add_u32 s26, s26, 131072
ds_write_b128 v2, v[220:223] offset:15360
s_waitcnt lgkmcnt(0)
s_branch Lk2_mg1
Lk2_g1b:
s_sub_u32 s39, s101, 2
s_getpc_b64 s[36:37]
Lpce10:
s_add_u32 s36, s36, Lk2_done-Lpce10
s_addc_u32 s37, s37, 0
s_lshr_b32 s38, s2, 3
s_lshl2_add_u32 s38, s38, s101
s_mul_i32 s38, s38, (((Lc3-Lk2_done)/128+127)&~127)
v_lshlrev_b32 v8, 7, v0
v_min_u32 v8, (((Lc3-Lk2_done)/128+127)&~127)-128, v8
v_add_u32 v8, s38, v8
v_min_u32 v8, Lc3-Lk2_done-4, v8
global_load_dword a247, v8, s[36:37]
s_getpc_b64 s[36:37]
Lpce11:
s_add_u32 s36, s36, Lk2_done-Lpce11
s_addc_u32 s37, s37, 0
s_lshr_b32 s38, s2, 3
s_lshl2_add_u32 s38, s38, s39
s_mul_i32 s38, s38, (((Lc3-Lk2_done)/128+127)&~127)
v_lshlrev_b32 v8, 7, v0
v_min_u32 v8, (((Lc3-Lk2_done)/128+127)&~127)-128, v8
v_add_u32 v8, s38, v8
v_min_u32 v8, Lc3-Lk2_done-4, v8
global_load_dword a248, v8, s[36:37]
s_add_u32 m0, s29, 65536
s_waitcnt lgkmcnt(4)
M v[96:99], a[116:119], a[0:3], 0
v_exp_f32 v64, v64
M v[96:99], a[120:123], a[4:7], v[96:99]
ds_read_b128 a[148:151], v2 offset:8192
ds_read_b128 a[152:155], v2 offset:9216
M v[96:99], a[124:127], a[8:11], v[96:99]
v_exp_f32 v65, v65
M v[96:99], a[128:131], a[12:15], v[96:99]
buffer_load_dwordx4 v1, s[12:15], s25 offen offset:0 sc1 lds
s_add_u32 s32, s25, 4096
M v[100:103], a[128:131], a[28:31], 0
v_exp_f32 v66, v66
M v[100:103], a[124:127], a[24:27], v[100:103]
v_cvt_pk_bf16_f32 v64, v64, v65
M v[100:103], a[120:123], a[20:23], v[100:103]
v_exp_f32 v67, v67
M v[100:103], a[116:119], a[16:19], v[100:103]
buffer_load_dwordx4 v1, s[12:15], s25 offen offset:1024 sc1 lds
M v[104:107], a[116:119], a[32:35], 0
v_exp_f32 v80, v80
M v[104:107], a[120:123], a[36:39], v[104:107]
ds_read_b128 a[156:159], v2 offset:10240
ds_read_b128 a[160:163], v2 offset:11264
M v[104:107], a[124:127], a[40:43], v[104:107]
v_exp_f32 v81, v81
M v[104:107], a[128:131], a[44:47], v[104:107]
buffer_load_dwordx4 v1, s[12:15], s25 offen offset:2048 sc1 lds
M v[108:111], a[128:131], a[60:63], 0
v_exp_f32 v82, v82
M v[108:111], a[124:127], a[56:59], v[108:111]
v_cvt_pk_bf16_f32 v65, v66, v67
v_cvt_pk_bf16_f32 v66, v80, v81
M v[108:111], a[120:123], a[52:55], v[108:111]
v_exp_f32 v83, v83
M v[108:111], a[116:119], a[48:51], v[108:111]
buffer_load_dwordx4 v1, s[12:15], s25 offen offset:3072 sc1 lds
s_add_u32 m0, s29, 69632
s_waitcnt lgkmcnt(4)
M v[112:115], a[132:135], a[0:3], 0
v_exp_f32 v68, v68
M v[112:115], a[136:139], a[4:7], v[112:115]
ds_read_b128 a[164:167], v2 offset:12288
ds_read_b128 a[168:171], v2 offset:13312
M v[112:115], a[140:143], a[8:11], v[112:115]
v_exp_f32 v69, v69
M v[112:115], a[144:147], a[12:15], v[112:115]
buffer_load_dwordx4 v1, s[12:15], s32 offen offset:0 sc1 lds
M v[116:119], a[144:147], a[28:31], 0
v_exp_f32 v70, v70
M v[116:119], a[140:143], a[24:27], v[116:119]
v_cvt_pk_bf16_f32 v67, v82, v83
v_cvt_pk_bf16_f32 v68, v68, v69
M v[116:119], a[136:139], a[20:23], v[116:119]
v_exp_f32 v71, v71
M v[116:119], a[132:135], a[16:19], v[116:119]
buffer_load_dwordx4 v1, s[12:15], s32 offen offset:1024 sc1 lds
M v[120:123], a[132:135], a[32:35], 0
v_exp_f32 v84, v84
M v[120:123], a[136:139], a[36:39], v[120:123]
ds_read_b128 a[172:175], v2 offset:14336
ds_read_b128 a[176:179], v2 offset:15360
M v[120:123], a[140:143], a[40:43], v[120:123]
v_exp_f32 v85, v85
M v[120:123], a[144:147], a[44:47], v[120:123]
buffer_load_dwordx4 v1, s[12:15], s32 offen offset:2048 sc1 lds
M v[124:127], a[144:147], a[60:63], 0
v_exp_f32 v86, v86
M v[124:127], a[140:143], a[56:59], v[124:127]
v_cvt_pk_bf16_f32 v69, v70, v71
v_cvt_pk_bf16_f32 v70, v84, v85
M v[124:127], a[136:139], a[52:55], v[124:127]
v_exp_f32 v87, v87
M v[124:127], a[132:135], a[48:51], v[124:127]
buffer_load_dwordx4 v1, s[12:15], s32 offen offset:3072 sc1 lds
s_add_u32 m0, s29, 98304
s_waitcnt lgkmcnt(4)
M v[128:131], a[148:151], a[0:3], 0
v_exp_f32 v72, v72
M v[128:131], a[152:155], a[4:7], v[128:131]
ds_read_b128 a[116:119], v5 offset:32768
ds_read_b128 a[120:123], v5 offset:40960
M v[128:131], a[156:159], a[8:11], v[128:131]
v_exp_f32 v73, v73
M v[128:131], a[160:163], a[12:15], v[128:131]
buffer_load_dwordx4 v1, s[12:15], s26 offen offset:0 sc1 lds
s_add_u32 s43, s26, 4096
M v[132:135], a[160:163], a[28:31], 0
v_exp_f32 v74, v74
M v[132:135], a[156:159], a[24:27], v[132:135]
v_cvt_pk_bf16_f32 v71, v86, v87
v_cvt_pk_bf16_f32 v72, v72, v73
M v[132:135], a[152:155], a[20:23], v[132:135]
v_exp_f32 v75, v75
M v[132:135], a[148:151], a[16:19], v[132:135]
buffer_load_dwordx4 v1, s[12:15], s26 offen offset:1024 sc1 lds
M v[136:139], a[148:151], a[32:35], 0
v_exp_f32 v88, v88
M v[136:139], a[152:155], a[36:39], v[136:139]
ds_read_b128 a[124:127], v5 offset:33792
ds_read_b128 a[128:131], v5 offset:41984
M v[136:139], a[156:159], a[40:43], v[136:139]
v_exp_f32 v89, v89
M v[136:139], a[160:163], a[44:47], v[136:139]
buffer_load_dwordx4 v1, s[12:15], s26 offen offset:2048 sc1 lds
M v[140:143], a[160:163], a[60:63], 0
v_exp_f32 v90, v90
M v[140:143], a[156:159], a[56:59], v[140:143]
v_cvt_pk_bf16_f32 v73, v74, v75
v_cvt_pk_bf16_f32 v74, v88, v89
M v[140:143], a[152:155], a[52:55], v[140:143]
v_exp_f32 v91, v91
M v[140:143], a[148:151], a[48:51], v[140:143]
buffer_load_dwordx4 v1, s[12:15], s26 offen offset:3072 sc1 lds
s_add_u32 m0, s29, 102400
s_waitcnt lgkmcnt(4)
M v[144:147], a[164:167], a[0:3], 0
v_exp_f32 v76, v76
M v[144:147], a[168:171], a[4:7], v[144:147]
ds_read_b128 a[132:135], v5 offset:34816
ds_read_b128 a[136:139], v5 offset:43008
M v[144:147], a[172:175], a[8:11], v[144:147]
v_exp_f32 v77, v77
M v[144:147], a[176:179], a[12:15], v[144:147]
buffer_load_dwordx4 v1, s[12:15], s43 offen offset:0 sc1 lds
M v[148:151], a[176:179], a[28:31], 0
v_exp_f32 v78, v78
M v[148:151], a[172:175], a[24:27], v[148:151]
v_cvt_pk_bf16_f32 v75, v90, v91
v_cvt_pk_bf16_f32 v76, v76, v77
M v[148:151], a[168:171], a[20:23], v[148:151]
v_exp_f32 v79, v79
M v[148:151], a[164:167], a[16:19], v[148:151]
buffer_load_dwordx4 v1, s[12:15], s43 offen offset:1024 sc1 lds
M v[152:155], a[164:167], a[32:35], 0
v_exp_f32 v92, v92
M v[152:155], a[168:171], a[36:39], v[152:155]
ds_read_b128 a[140:143], v5 offset:35840
ds_read_b128 a[144:147], v5 offset:44032
M v[152:155], a[172:175], a[40:43], v[152:155]
v_exp_f32 v93, v93
M v[152:155], a[176:179], a[44:47], v[152:155]
buffer_load_dwordx4 v1, s[12:15], s43 offen offset:2048 sc1 lds
M v[156:159], a[176:179], a[60:63], 0
v_exp_f32 v94, v94
M v[156:159], a[172:175], a[56:59], v[156:159]
v_cvt_pk_bf16_f32 v77, v78, v79
v_cvt_pk_bf16_f32 v78, v92, v93
M v[156:159], a[168:171], a[52:55], v[156:159]
v_exp_f32 v95, v95
M v[156:159], a[164:167], a[48:51], v[156:159]
buffer_load_dwordx4 v1, s[12:15], s43 offen offset:3072 sc1 lds
v_cvt_pk_bf16_f32 v79, v94, v95
s_waitcnt lgkmcnt(6)
M v[160:163], a[116:119], v[32:35], v[160:163]
v_exp_f32 v96, v96
M v[160:163], a[120:123], v[64:67], v[160:163]
ds_read_b128 a[148:151], v5 offset:36864
ds_read_b128 a[152:155], v5 offset:45056
M v[164:167], a[120:123], v[68:71], v[164:167]
v_exp_f32 v97, v97
M v[164:167], a[116:119], v[36:39], v[164:167]
v_cvt_pk_bf16_f32 v96, v96, v97
M v[168:171], a[116:119], v[40:43], v[168:171]
v_exp_f32 v98, v98
M v[168:171], a[120:123], v[72:75], v[168:171]
s_add_u32 s25, s25, 32768
s_cmp_eq_u32 s25, s27
M v[172:175], a[120:123], v[76:79], v[172:175]
v_exp_f32 v99, v99
M v[172:175], a[116:119], v[44:47], v[172:175]
v_cvt_pk_bf16_f32 v97, v98, v99
s_waitcnt lgkmcnt(6)
M a[96:99], a[112:115], v[32:35], a[96:99]
s_cselect_b32 s25, s28, s25
s_cselect_b32 s27, s56, s27
M a[96:99], a[112:115], v[64:67], a[96:99]
s_cselect_b32 s28, s57, s28
s_cselect_b32 s56, -1, s56
M v[176:179], a[124:127], v[32:35], v[176:179]
v_exp_f32 v112, v112
M v[176:179], a[128:131], v[64:67], v[176:179]
ds_read_b128 a[156:159], v5 offset:37888
ds_read_b128 a[160:163], v5 offset:46080
M v[180:183], a[128:131], v[68:71], v[180:183]
v_exp_f32 v113, v113
M v[180:183], a[124:127], v[36:39], v[180:183]
v_cvt_pk_bf16_f32 v98, v112, v113
M v[184:187], a[124:127], v[40:43], v[184:187]
v_exp_f32 v114, v114
M v[184:187], a[128:131], v[72:75], v[184:187]
s_add_u32 s26, s26, 32768
s_cmp_eq_u32 s26, s62
M v[188:191], a[128:131], v[76:79], v[188:191]
v_exp_f32 v115, v115
M v[188:191], a[124:127], v[44:47], v[188:191]
v_cvt_pk_bf16_f32 v99, v114, v115
s_waitcnt lgkmcnt(6)
M a[100:103], a[112:115], v[36:39], a[100:103]
s_cselect_b32 s26, s63, s26
s_cselect_b32 s62, s58, s62
M a[100:103], a[112:115], v[68:71], a[100:103]
s_cselect_b32 s63, s59, s63
s_cselect_b32 s58, -1, s58
M v[192:195], a[132:135], v[32:35], v[192:195]
v_exp_f32 v100, v100
M v[192:195], a[136:139], v[64:67], v[192:195]
ds_read_b128 a[164:167], v5 offset:38912
ds_read_b128 a[168:171], v5 offset:47104
M v[196:199], a[136:139], v[68:71], v[196:199]
v_exp_f32 v101, v101
M v[196:199], a[132:135], v[36:39], v[196:199]
v_cvt_pk_bf16_f32 v100, v100, v101
M v[200:203], a[132:135], v[40:43], v[200:203]
v_exp_f32 v102, v102
M v[200:203], a[136:139], v[72:75], v[200:203]
s_sub_u32 s33, s42, 1
s_cmp_le_u32 s33, 1
s_cselect_b32 s33, 0x4000, 0
v_add_u32 v2, s33, v2
M v[204:207], a[136:139], v[76:79], v[204:207]
v_exp_f32 v103, v103
M v[204:207], a[132:135], v[44:47], v[204:207]
v_cvt_pk_bf16_f32 v101, v102, v103
s_waitcnt lgkmcnt(6)
M a[104:107], a[112:115], v[40:43], a[104:107]
M a[104:107], a[112:115], v[72:75], a[104:107]
M v[208:211], a[140:143], v[32:35], v[208:211]
v_exp_f32 v116, v116
M v[208:211], a[144:147], v[64:67], v[208:211]
ds_read_b128 a[172:175], v5 offset:39936
ds_read_b128 a[176:179], v5 offset:48128
M v[212:215], a[144:147], v[68:71], v[212:215]
v_exp_f32 v117, v117
M v[212:215], a[140:143], v[36:39], v[212:215]
v_cvt_pk_bf16_f32 v102, v116, v117
M v[216:219], a[140:143], v[40:43], v[216:219]
v_exp_f32 v118, v118
M v[216:219], a[144:147], v[72:75], v[216:219]
M v[220:223], a[144:147], v[76:79], v[220:223]
v_exp_f32 v119, v119
M v[220:223], a[140:143], v[44:47], v[220:223]
v_cvt_pk_bf16_f32 v103, v118, v119
s_waitcnt lgkmcnt(6)
M a[108:111], a[112:115], v[44:47], a[108:111]
M a[108:111], a[112:115], v[76:79], a[108:111]
M v[224:227], a[148:151], v[32:35], v[224:227]
v_exp_f32 v104, v104
M v[224:227], a[152:155], v[64:67], v[224:227]
s_cmp_le_u32 s42, 1
s_cselect_b32 s33, 0x4000, 0
v_add_u32 v5, s33, v5
s_sub_u32 s42, s42, 1
M v[228:231], a[152:155], v[68:71], v[228:231]
v_exp_f32 v105, v105
M v[228:231], a[148:151], v[36:39], v[228:231]
v_cvt_pk_bf16_f32 v104, v104, v105
M v[232:235], a[148:151], v[40:43], v[232:235]
v_exp_f32 v106, v106
M v[232:235], a[152:155], v[72:75], v[232:235]
M v[236:239], a[152:155], v[76:79], v[236:239]
v_exp_f32 v107, v107
M v[236:239], a[148:151], v[44:47], v[236:239]
v_cvt_pk_bf16_f32 v105, v106, v107
s_waitcnt lgkmcnt(4)
M v[240:243], a[156:159], v[32:35], v[240:243]
v_exp_f32 v120, v120
M v[240:243], a[160:163], v[64:67], v[240:243]
M v[244:247], a[160:163], v[68:71], v[244:247]
v_exp_f32 v121, v121
M v[244:247], a[156:159], v[36:39], v[244:247]
v_cvt_pk_bf16_f32 v106, v120, v121
M v[248:251], a[156:159], v[40:43], v[248:251]
v_exp_f32 v122, v122
M v[248:251], a[160:163], v[72:75], v[248:251]
s_waitcnt vmcnt(0) lgkmcnt(0)
s_barrier
ds_read_b128 a[116:119], v3 offset:0
ds_read_b128 a[120:123], v3 offset:1024
M v[252:255], a[160:163], v[76:79], v[252:255]
v_exp_f32 v123, v123
M v[252:255], a[156:159], v[44:47], v[252:255]
v_cvt_pk_bf16_f32 v107, v122, v123
M a[64:67], a[164:167], v[32:35], a[64:67]
v_exp_f32 v108, v108
M a[64:67], a[168:171], v[64:67], a[64:67]
ds_read_b128 a[124:127], v3 offset:2048
ds_read_b128 a[128:131], v3 offset:3072
M a[68:71], a[168:171], v[68:71], a[68:71]
v_exp_f32 v109, v109
M a[68:71], a[164:167], v[36:39], a[68:71]
v_cvt_pk_bf16_f32 v108, v108, v109
M a[72:75], a[164:167], v[40:43], a[72:75]
v_exp_f32 v110, v110
M a[72:75], a[168:171], v[72:75], a[72:75]
ds_read_b128 a[132:135], v3 offset:4096
ds_read_b128 a[136:139], v3 offset:5120
M a[76:79], a[168:171], v[76:79], a[76:79]
v_exp_f32 v111, v111
M a[76:79], a[164:167], v[44:47], a[76:79]
v_cvt_pk_bf16_f32 v109, v110, v111
M a[80:83], a[172:175], v[32:35], a[80:83]
v_exp_f32 v124, v124
M a[80:83], a[176:179], v[64:67], a[80:83]
ds_read_b128 a[140:143], v3 offset:6144
ds_read_b128 a[144:147], v3 offset:7168
M a[84:87], a[176:179], v[68:71], a[84:87]
v_exp_f32 v125, v125
M a[84:87], a[172:175], v[36:39], a[84:87]
v_cvt_pk_bf16_f32 v110, v124, v125
M a[88:91], a[172:175], v[40:43], a[88:91]
v_exp_f32 v126, v126
M a[88:91], a[176:179], v[72:75], a[88:91]
M a[92:95], a[176:179], v[76:79], a[92:95]
v_exp_f32 v127, v127
M a[92:95], a[172:175], v[44:47], a[92:95]
v_cvt_pk_bf16_f32 v111, v126, v127
s_add_u32 m0, s29, 0
s_waitcnt lgkmcnt(4)
M v[32:35], a[116:119], a[0:3], v[16:19]
v_exp_f32 v128, v128
M v[32:35], a[120:123], a[4:7], v[32:35]
ds_read_b128 a[148:151], v3 offset:8192
ds_read_b128 a[152:155], v3 offset:9216
M v[32:35], a[124:127], a[8:11], v[32:35]
v_exp_f32 v129, v129
M v[32:35], a[128:131], a[12:15], v[32:35]
buffer_load_dwordx4 v1, s[12:15], s25 offen offset:0 sc1 lds
s_add_u32 s32, s25, 4096
M v[36:39], a[128:131], a[28:31], 0
v_exp_f32 v130, v130
M v[36:39], a[124:127], a[24:27], v[36:39]
v_cvt_pk_bf16_f32 v128, v128, v129
M v[36:39], a[120:123], a[20:23], v[36:39]
v_exp_f32 v131, v131
M v[36:39], a[116:119], a[16:19], v[36:39]
buffer_load_dwordx4 v1, s[12:15], s25 offen offset:1024 sc1 lds
M v[40:43], a[116:119], a[32:35], 0
v_exp_f32 v144, v144
M v[40:43], a[120:123], a[36:39], v[40:43]
ds_read_b128 a[156:159], v3 offset:10240
ds_read_b128 a[160:163], v3 offset:11264
M v[40:43], a[124:127], a[40:43], v[40:43]
v_exp_f32 v145, v145
M v[40:43], a[128:131], a[44:47], v[40:43]
buffer_load_dwordx4 v1, s[12:15], s25 offen offset:2048 sc1 lds
M v[44:47], a[128:131], a[60:63], 0
v_exp_f32 v146, v146
M v[44:47], a[124:127], a[56:59], v[44:47]
v_cvt_pk_bf16_f32 v129, v130, v131
v_cvt_pk_bf16_f32 v130, v144, v145
M v[44:47], a[120:123], a[52:55], v[44:47]
v_exp_f32 v147, v147
M v[44:47], a[116:119], a[48:51], v[44:47]
buffer_load_dwordx4 v1, s[12:15], s25 offen offset:3072 sc1 lds
s_add_u32 m0, s29, 4096
s_waitcnt lgkmcnt(4)
v_exp_f32 v132, v132
ds_read_b128 a[164:167], v3 offset:12288
ds_read_b128 a[168:171], v3 offset:13312
v_exp_f32 v133, v133
buffer_load_dwordx4 v1, s[12:15], s32 offen offset:0 sc1 lds
M v[52:55], a[144:147], a[28:31], v[16:19]
v_exp_f32 v134, v134
M v[52:55], a[140:143], a[24:27], v[52:55]
v_cvt_pk_bf16_f32 v131, v146, v147
v_cvt_pk_bf16_f32 v132, v132, v133
M v[52:55], a[136:139], a[20:23], v[52:55]
v_exp_f32 v135, v135
M v[52:55], a[132:135], a[16:19], v[52:55]
buffer_load_dwordx4 v1, s[12:15], s32 offen offset:1024 sc1 lds
M v[56:59], a[132:135], a[32:35], 0
v_exp_f32 v148, v148
M v[56:59], a[136:139], a[36:39], v[56:59]
ds_read_b128 a[172:175], v3 offset:14336
ds_read_b128 a[176:179], v3 offset:15360
M v[56:59], a[140:143], a[40:43], v[56:59]
v_exp_f32 v149, v149
M v[56:59], a[144:147], a[44:47], v[56:59]
buffer_load_dwordx4 v1, s[12:15], s32 offen offset:2048 sc1 lds
M v[60:63], a[144:147], a[60:63], 0
v_exp_f32 v150, v150
M v[60:63], a[140:143], a[56:59], v[60:63]
v_cvt_pk_bf16_f32 v133, v134, v135
v_cvt_pk_bf16_f32 v134, v148, v149
M v[60:63], a[136:139], a[52:55], v[60:63]
v_exp_f32 v151, v151
M v[60:63], a[132:135], a[48:51], v[60:63]
buffer_load_dwordx4 v1, s[12:15], s32 offen offset:3072 sc1 lds
s_add_u32 m0, s29, 32768
s_waitcnt lgkmcnt(4)
v_exp_f32 v136, v136
ds_read_b128 a[116:119], v6 offset:32768
ds_read_b128 a[120:123], v6 offset:40960
v_exp_f32 v137, v137
buffer_load_dwordx4 v1, s[12:15], s26 offen offset:0 sc1 lds
s_add_u32 s43, s26, 4096
v_exp_f32 v138, v138
v_cvt_pk_bf16_f32 v135, v150, v151
v_cvt_pk_bf16_f32 v136, v136, v137
v_exp_f32 v139, v139
buffer_load_dwordx4 v1, s[12:15], s26 offen offset:1024 sc1 lds
M v[72:75], a[148:151], a[32:35], v[16:19]
v_exp_f32 v152, v152
M v[72:75], a[152:155], a[36:39], v[72:75]
ds_read_b128 a[124:127], v6 offset:33792
ds_read_b128 a[128:131], v6 offset:41984
M v[72:75], a[156:159], a[40:43], v[72:75]
v_exp_f32 v153, v153
M v[72:75], a[160:163], a[44:47], v[72:75]
buffer_load_dwordx4 v1, s[12:15], s26 offen offset:2048 sc1 lds
M v[76:79], a[160:163], a[60:63], 0
v_exp_f32 v154, v154
M v[76:79], a[156:159], a[56:59], v[76:79]
v_cvt_pk_bf16_f32 v137, v138, v139
v_cvt_pk_bf16_f32 v138, v152, v153
M v[76:79], a[152:155], a[52:55], v[76:79]
v_exp_f32 v155, v155
M v[76:79], a[148:151], a[48:51], v[76:79]
buffer_load_dwordx4 v1, s[12:15], s26 offen offset:3072 sc1 lds
s_add_u32 m0, s29, 36864
s_waitcnt lgkmcnt(4)
v_exp_f32 v140, v140
ds_read_b128 a[132:135], v6 offset:34816
ds_read_b128 a[136:139], v6 offset:43008
v_exp_f32 v141, v141
buffer_load_dwordx4 v1, s[12:15], s43 offen offset:0 sc1 lds
v_exp_f32 v142, v142
v_cvt_pk_bf16_f32 v139, v154, v155
v_cvt_pk_bf16_f32 v140, v140, v141
v_exp_f32 v143, v143
buffer_load_dwordx4 v1, s[12:15], s43 offen offset:1024 sc1 lds
v_exp_f32 v156, v156
ds_read_b128 a[140:143], v6 offset:35840
ds_read_b128 a[144:147], v6 offset:44032
v_exp_f32 v157, v157
buffer_load_dwordx4 v1, s[12:15], s43 offen offset:2048 sc1 lds
M v[92:95], a[176:179], a[60:63], v[16:19]
v_exp_f32 v158, v158
M v[92:95], a[172:175], a[56:59], v[92:95]
v_cvt_pk_bf16_f32 v141, v142, v143
v_cvt_pk_bf16_f32 v142, v156, v157
M v[92:95], a[168:171], a[52:55], v[92:95]
v_exp_f32 v159, v159
M v[92:95], a[164:167], a[48:51], v[92:95]
buffer_load_dwordx4 v1, s[12:15], s43 offen offset:3072 sc1 lds
v_cvt_pk_bf16_f32 v143, v158, v159
s_waitcnt lgkmcnt(6)
M v[160:163], a[116:119], v[96:99], v[160:163]
v_exp_f32 v32, v32
M v[160:163], a[120:123], v[128:131], v[160:163]
ds_read_b128 a[148:151], v6 offset:36864
ds_read_b128 a[152:155], v6 offset:45056
M v[164:167], a[120:123], v[132:135], v[164:167]
v_exp_f32 v33, v33
M v[164:167], a[116:119], v[100:103], v[164:167]
v_cvt_pk_bf16_f32 v32, v32, v33
M v[168:171], a[116:119], v[104:107], v[168:171]
v_exp_f32 v34, v34
M v[168:171], a[120:123], v[136:139], v[168:171]
s_add_u32 s25, s25, 32768
s_cmp_eq_u32 s25, s27
M v[172:175], a[120:123], v[140:143], v[172:175]
v_exp_f32 v35, v35
M v[172:175], a[116:119], v[108:111], v[172:175]
v_cvt_pk_bf16_f32 v33, v34, v35
s_waitcnt lgkmcnt(6)
M a[96:99], a[112:115], v[96:99], a[96:99]
s_cselect_b32 s25, s28, s25
s_cselect_b32 s27, s56, s27
M a[96:99], a[112:115], v[128:131], a[96:99]
s_cselect_b32 s28, s57, s28
s_cselect_b32 s56, -1, s56
M v[176:179], a[124:127], v[96:99], v[176:179]
M v[176:179], a[128:131], v[128:131], v[176:179]
ds_read_b128 a[156:159], v6 offset:37888
ds_read_b128 a[160:163], v6 offset:46080
M v[180:183], a[128:131], v[132:135], v[180:183]
M v[180:183], a[124:127], v[100:103], v[180:183]
v_mov_b32 v34, 0
M v[184:187], a[124:127], v[104:107], v[184:187]
M v[184:187], a[128:131], v[136:139], v[184:187]
s_add_u32 s26, s26, 32768
s_cmp_eq_u32 s26, s62
M v[188:191], a[128:131], v[140:143], v[188:191]
M v[188:191], a[124:127], v[108:111], v[188:191]
v_mov_b32 v35, 0
s_waitcnt lgkmcnt(6)
M a[100:103], a[112:115], v[100:103], a[100:103]
s_cselect_b32 s26, s63, s26
s_cselect_b32 s62, s58, s62
M a[100:103], a[112:115], v[132:135], a[100:103]
s_cselect_b32 s63, s59, s63
s_cselect_b32 s58, -1, s58
M v[192:195], a[132:135], v[96:99], v[192:195]
v_exp_f32 v36, v36
M v[192:195], a[136:139], v[128:131], v[192:195]
ds_read_b128 a[164:167], v6 offset:38912
ds_read_b128 a[168:171], v6 offset:47104
M v[196:199], a[136:139], v[132:135], v[196:199]
v_exp_f32 v37, v37
M v[196:199], a[132:135], v[100:103], v[196:199]
v_cvt_pk_bf16_f32 v36, v36, v37
M v[200:203], a[132:135], v[104:107], v[200:203]
v_exp_f32 v38, v38
M v[200:203], a[136:139], v[136:139], v[200:203]
s_sub_u32 s33, s42, 1
s_cmp_le_u32 s33, 1
s_cselect_b32 s33, 0x4000, 0
v_add_u32 v3, s33, v3
M v[204:207], a[136:139], v[140:143], v[204:207]
v_exp_f32 v39, v39
M v[204:207], a[132:135], v[108:111], v[204:207]
v_cvt_pk_bf16_f32 v37, v38, v39
s_waitcnt lgkmcnt(6)
M a[104:107], a[112:115], v[104:107], a[104:107]
M a[104:107], a[112:115], v[136:139], a[104:107]
M v[208:211], a[140:143], v[96:99], v[208:211]
v_exp_f32 v52, v52
M v[208:211], a[144:147], v[128:131], v[208:211]
ds_read_b128 a[172:175], v6 offset:39936
ds_read_b128 a[176:179], v6 offset:48128
M v[212:215], a[144:147], v[132:135], v[212:215]
v_exp_f32 v53, v53
M v[212:215], a[140:143], v[100:103], v[212:215]
v_cvt_pk_bf16_f32 v38, v52, v53
M v[216:219], a[140:143], v[104:107], v[216:219]
v_exp_f32 v54, v54
M v[216:219], a[144:147], v[136:139], v[216:219]
M v[220:223], a[144:147], v[140:143], v[220:223]
v_exp_f32 v55, v55
M v[220:223], a[140:143], v[108:111], v[220:223]
v_cvt_pk_bf16_f32 v39, v54, v55
s_waitcnt lgkmcnt(6)
M a[108:111], a[112:115], v[108:111], a[108:111]
M a[108:111], a[112:115], v[140:143], a[108:111]
M v[224:227], a[148:151], v[96:99], v[224:227]
v_exp_f32 v40, v40
M v[224:227], a[152:155], v[128:131], v[224:227]
s_cmp_le_u32 s42, 1
s_cselect_b32 s33, 0x4000, 0
v_add_u32 v6, s33, v6
s_sub_u32 s42, s42, 1
M v[228:231], a[152:155], v[132:135], v[228:231]
v_exp_f32 v41, v41
M v[228:231], a[148:151], v[100:103], v[228:231]
v_cvt_pk_bf16_f32 v40, v40, v41
M v[232:235], a[148:151], v[104:107], v[232:235]
v_exp_f32 v42, v42
M v[232:235], a[152:155], v[136:139], v[232:235]
M v[236:239], a[152:155], v[140:143], v[236:239]
v_exp_f32 v43, v43
M v[236:239], a[148:151], v[108:111], v[236:239]
v_cvt_pk_bf16_f32 v41, v42, v43
s_waitcnt lgkmcnt(4)
M v[240:243], a[156:159], v[96:99], v[240:243]
v_exp_f32 v56, v56
M v[240:243], a[160:163], v[128:131], v[240:243]
M v[244:247], a[160:163], v[132:135], v[244:247]
v_exp_f32 v57, v57
M v[244:247], a[156:159], v[100:103], v[244:247]
v_cvt_pk_bf16_f32 v42, v56, v57
M v[248:251], a[156:159], v[104:107], v[248:251]
v_exp_f32 v58, v58
M v[248:251], a[160:163], v[136:139], v[248:251]
s_waitcnt vmcnt(0) lgkmcnt(0)
s_barrier
ds_read_b128 a[116:119], v2 offset:0
ds_read_b128 a[120:123], v2 offset:1024
M v[252:255], a[160:163], v[140:143], v[252:255]
v_exp_f32 v59, v59
M v[252:255], a[156:159], v[108:111], v[252:255]
v_cvt_pk_bf16_f32 v43, v58, v59
M a[64:67], a[164:167], v[96:99], a[64:67]
v_exp_f32 v44, v44
M a[64:67], a[168:171], v[128:131], a[64:67]
ds_read_b128 a[124:127], v2 offset:2048
ds_read_b128 a[128:131], v2 offset:3072
M a[68:71], a[168:171], v[132:135], a[68:71]
v_exp_f32 v45, v45
M a[68:71], a[164:167], v[100:103], a[68:71]
v_cvt_pk_bf16_f32 v44, v44, v45
M a[72:75], a[164:167], v[104:107], a[72:75]
v_exp_f32 v46, v46
M a[72:75], a[168:171], v[136:139], a[72:75]
ds_read_b128 a[132:135], v2 offset:4096
ds_read_b128 a[136:139], v2 offset:5120
M a[76:79], a[168:171], v[140:143], a[76:79]
v_exp_f32 v47, v47
M a[76:79], a[164:167], v[108:111], a[76:79]
v_cvt_pk_bf16_f32 v45, v46, v47
M a[80:83], a[172:175], v[96:99], a[80:83]
v_exp_f32 v60, v60
M a[80:83], a[176:179], v[128:131], a[80:83]
ds_read_b128 a[140:143], v2 offset:6144
ds_read_b128 a[144:147], v2 offset:7168
M a[84:87], a[176:179], v[132:135], a[84:87]
v_exp_f32 v61, v61
M a[84:87], a[172:175], v[100:103], a[84:87]
v_cvt_pk_bf16_f32 v46, v60, v61
M a[88:91], a[172:175], v[104:107], a[88:91]
v_exp_f32 v62, v62
M a[88:91], a[176:179], v[136:139], a[88:91]
M a[92:95], a[176:179], v[140:143], a[92:95]
v_exp_f32 v63, v63
M a[92:95], a[172:175], v[108:111], a[92:95]
v_cvt_pk_bf16_f32 v47, v62, v63
s_and_b32 s3, s2, 3
s_lshl_b32 s3, s3, 2
s_bfe_u32 s27, s2, 0x20003
s_add_u32 s27, s3, s27
s_lshl_b32 s43, s27, 8
s_add_u32 s43, s43, 16789504
v_lshlrev_b32 v15, 2, v0
buffer_load_dword v7, v15, s[52:55], s43 offen sc1
s_waitcnt lgkmcnt(7)
ds_read_b128 a[116:119], v5 offset:32768
s_waitcnt lgkmcnt(7)
ds_read_b128 a[120:123], v5 offset:40960
s_waitcnt lgkmcnt(7)
ds_read_b128 a[124:127], v5 offset:33792
s_waitcnt lgkmcnt(7)
ds_read_b128 a[128:131], v5 offset:41984
s_waitcnt lgkmcnt(7)
ds_read_b128 a[132:135], v5 offset:34816
s_waitcnt lgkmcnt(7)
ds_read_b128 a[136:139], v5 offset:43008
s_waitcnt lgkmcnt(7)
ds_read_b128 a[140:143], v5 offset:35840
s_waitcnt lgkmcnt(7)
ds_read_b128 a[144:147], v5 offset:44032
s_lshl_b32 s33, s23, 14
s_add_u32 s34, s33, 131072
s_add_u32 s33, s33, 98304
v_add_u32 v2, s34, v1
v_add_u32 v3, s33, v1
v_exp_f32 v72, v72
v_exp_f32 v73, v73
v_exp_f32 v74, v74
v_exp_f32 v75, v75
v_cvt_pk_bf16_f32 v72, v72, v73
v_cvt_pk_bf16_f32 v73, v74, v75
v_exp_f32 v76, v76
v_exp_f32 v77, v77
v_exp_f32 v78, v78
v_exp_f32 v79, v79
v_mov_b32 v74, 0
v_mov_b32 v75, 0
v_exp_f32 v92, v92
v_exp_f32 v93, v93
v_exp_f32 v94, v94
v_exp_f32 v95, v95
v_cvt_pk_bf16_f32 v76, v76, v77
v_cvt_pk_bf16_f32 v77, v78, v79
v_cvt_pk_bf16_f32 v78, v92, v93
v_cvt_pk_bf16_f32 v79, v94, v95
s_waitcnt lgkmcnt(6)
M v[160:163], a[116:119], v[32:35], v[160:163]
ds_read_b128 a[148:151], v5 offset:36864
ds_read_b128 a[152:155], v5 offset:45056
s_mov_b32 s61, 0
M v[164:167], a[116:119], v[36:39], v[164:167]
s_bfe_u32 s3, s2, 0x10002
M v[168:171], a[116:119], v[40:43], v[168:171]
M v[168:171], a[120:123], v[72:75], v[168:171]
s_lshl_b32 s3, s3, 3
M v[172:175], a[120:123], v[76:79], v[172:175]
M v[172:175], a[116:119], v[44:47], v[172:175]
s_waitcnt lgkmcnt(6)
s_lshr_b32 s28, s2, 5
M a[96:99], a[112:115], v[32:35], a[96:99]
M v[176:179], a[124:127], v[32:35], v[176:179]
ds_read_b128 a[156:159], v5 offset:37888
ds_read_b128 a[160:163], v5 offset:46080
s_add_u32 s28, s3, s28
s_lshl_b32 s25, s27, 18
M v[180:183], a[124:127], v[36:39], v[180:183]
M v[184:187], a[124:127], v[40:43], v[184:187]
s_lshl_b32 s3, s101, 12
M v[184:187], a[128:131], v[72:75], v[184:187]
M v[188:191], a[128:131], v[76:79], v[188:191]
s_add_u32 s25, s25, s3
M v[188:191], a[124:127], v[44:47], v[188:191]
s_waitcnt lgkmcnt(6)
M a[100:103], a[112:115], v[36:39], a[100:103]
M v[192:195], a[132:135], v[32:35], v[192:195]
s_lshl_b32 s26, s28, 7
ds_read_b128 a[164:167], v5 offset:38912
ds_read_b128 a[168:171], v5 offset:47104
s_lshl_b32 s42, s101, 11
M v[196:199], a[132:135], v[36:39], v[196:199]
M v[200:203], a[132:135], v[40:43], v[200:203]
s_add_u32 s44, s4, 83886080
s_addc_u32 s45, s5, 0
M v[200:203], a[136:139], v[72:75], v[200:203]
s_mov_b32 s46, 4194304
M v[204:207], a[136:139], v[76:79], v[204:207]
M v[204:207], a[132:135], v[44:47], v[204:207]
s_waitcnt lgkmcnt(6)
s_mov_b32 s47, 0x00020000
M a[104:107], a[112:115], v[40:43], a[104:107]
M a[104:107], a[112:115], v[72:75], a[104:107]
M v[208:211], a[140:143], v[32:35], v[208:211]
ds_read_b128 a[172:175], v5 offset:39936
ds_read_b128 a[176:179], v5 offset:48128
s_mov_b32 s50, 2097152
M v[212:215], a[140:143], v[36:39], v[212:215]
s_mov_b32 s51, 0x00020000
M v[216:219], a[140:143], v[40:43], v[216:219]
M v[216:219], a[144:147], v[72:75], v[216:219]
s_lshl_b32 s3, s101, 4
M v[220:223], a[144:147], v[76:79], v[220:223]
M v[220:223], a[140:143], v[44:47], v[220:223]
s_waitcnt lgkmcnt(6)
v_lshrrev_b32 v96, 3, v0
M a[108:111], a[112:115], v[44:47], a[108:111]
M a[108:111], a[112:115], v[76:79], a[108:111]
M v[224:227], a[148:151], v[32:35], v[224:227]
v_and_b32 v97, 6, v96
ds_write_b128 v2, v[160:163] offset:0
v_and_b32 v98, 7, v0
M v[228:231], a[148:151], v[36:39], v[228:231]
M v[232:235], a[148:151], v[40:43], v[232:235]
ds_write_b128 v2, v[164:167] offset:1024
v_xor_b32 v97, v97, v98
M v[232:235], a[152:155], v[72:75], v[232:235]
M v[236:239], a[152:155], v[76:79], v[236:239]
ds_write_b128 v2, v[168:171] offset:2048
v_add_u32 v96, s3, v96
M v[236:239], a[148:151], v[44:47], v[236:239]
s_waitcnt lgkmcnt(7)
M v[240:243], a[156:159], v[32:35], v[240:243]
ds_write_b128 v2, v[172:175] offset:3072
v_lshlrev_b32 v96, 11, v96
ds_write_b128 v2, v[176:179] offset:4096
v_lshl_add_u32 v99, v97, 4, v96
M v[244:247], a[156:159], v[36:39], v[244:247]
v_add_u32 v100, 15360, v99
M v[248:251], a[156:159], v[40:43], v[248:251]
ds_write_b128 v2, v[180:183] offset:5120
M v[248:251], a[160:163], v[72:75], v[248:251]
s_waitcnt vmcnt(0) lgkmcnt(0)
s_barrier
M v[252:255], a[160:163], v[76:79], v[252:255]
ds_write_b128 v2, v[184:187] offset:6144
v_cmp_ne_u32 vcc, 1, v7
s_nop 0
s_cbranch_vccnz Lk3_spinb2
Lk3_gotb2:
M v[252:255], a[156:159], v[44:47], v[252:255]
s_add_u32 m0, s42, 16384
s_nop 0
buffer_load_dwordx4 v99, s[48:51], s26 offen offset:0 lds
M a[64:67], a[164:167], v[32:35], a[64:67]
ds_write_b128 v2, v[188:191] offset:7168
buffer_load_dwordx4 v100, s[48:51], s26 offen offset:1024 lds
ds_write_b128 v2, v[192:195] offset:8192
buffer_load_dwordx4 a[192:195], v1, s[44:47], s25 offen offset:0 sc1
M a[68:71], a[164:167], v[36:39], a[68:71]
buffer_load_dwordx4 a[196:199], v1, s[44:47], s25 offen offset:1024 sc1
M a[72:75], a[164:167], v[40:43], a[72:75]
ds_write_b128 v2, v[196:199] offset:9216
buffer_load_dwordx4 a[200:203], v1, s[44:47], s25 offen offset:2048 sc1
M a[72:75], a[168:171], v[72:75], a[72:75]
buffer_load_dwordx4 a[204:207], v1, s[44:47], s25 offen offset:3072 sc1
M a[76:79], a[168:171], v[76:79], a[76:79]
ds_write_b128 v2, v[200:203] offset:10240
M a[76:79], a[164:167], v[44:47], a[76:79]
s_add_u32 s25, s25, 16384
s_add_u32 s26, s26, 131072
M a[80:83], a[172:175], v[32:35], a[80:83]
ds_write_b128 v2, v[204:207] offset:11264
s_add_u32 m0, s42, 32768
s_nop 0
buffer_load_dwordx4 v99, s[48:51], s26 offen offset:0 lds
buffer_load_dwordx4 v100, s[48:51], s26 offen offset:1024 lds
ds_write_b128 v2, v[208:211] offset:12288
buffer_load_dwordx4 a[224:227], v1, s[44:47], s25 offen offset:0 sc1
M a[84:87], a[172:175], v[36:39], a[84:87]
M a[88:91], a[172:175], v[40:43], a[88:91]
ds_write_b128 v2, v[212:215] offset:13312
buffer_load_dwordx4 a[228:231], v1, s[44:47], s25 offen offset:1024 sc1
M a[88:91], a[176:179], v[72:75], a[88:91]
buffer_load_dwordx4 a[232:235], v1, s[44:47], s25 offen offset:2048 sc1
M a[92:95], a[176:179], v[76:79], a[92:95]
ds_write_b128 v2, v[216:219] offset:14336
buffer_load_dwordx4 a[236:239], v1, s[44:47], s25 offen offset:3072 sc1
M a[92:95], a[172:175], v[44:47], a[92:95]
s_add_u32 s25, s25, 16384
s_add_u32 s26, s26, 131072
ds_write_b128 v2, v[220:223] offset:15360
s_waitcnt lgkmcnt(0)
Lk2_mg1:
s_lshl_b32 s33, s22, 10
s_add_u32 s33, s33, 28672
s_xor_b32 s34, s33, 2048
v_add_u32 v14, s33, v1
v_add_u32 v15, s34, v1
v_accvgpr_read_b32 v20, a96
v_accvgpr_read_b32 v21, a100
v_accvgpr_read_b32 v22, a104
v_accvgpr_read_b32 v23, a108
ds_write_b128 v14, v[20:23]
s_waitcnt lgkmcnt(0)
s_barrier
ds_read_b128 v[28:31], v15
ds_read_b128 v[32:35], v3 offset:0
ds_read_b128 v[36:39], v3 offset:1024
ds_read_b128 v[40:43], v3 offset:2048
ds_read_b128 v[44:47], v3 offset:3072
ds_read_b128 v[48:51], v3 offset:4096
ds_read_b128 v[52:55], v3 offset:5120
ds_read_b128 v[56:59], v3 offset:6144
ds_read_b128 v[60:63], v3 offset:7168
ds_read_b128 v[64:67], v3 offset:8192
ds_read_b128 v[68:71], v3 offset:9216
ds_read_b128 v[72:75], v3 offset:10240
ds_read_b128 v[76:79], v3 offset:11264
ds_read_b128 v[80:83], v3 offset:12288
ds_read_b128 v[84:87], v3 offset:13312
ds_read_b128 v[88:91], v3 offset:14336
ds_read_b128 v[92:95], v3 offset:15360
s_waitcnt lgkmcnt(15)
v_add_f32 v20, v20, v28
v_add_f32 v21, v21, v29
v_add_f32 v22, v22, v30
v_add_f32 v23, v23, v31
s_sub_u32 s35, 15, s21
v_rcp_f32 v8, v20
v_rcp_f32 v9, v21
v_rcp_f32 v10, v22
v_rcp_f32 v11, v23
v_subrev_u32 v20, 0x21800000, v20
v_subrev_u32 v21, 0x21800000, v21
v_subrev_u32 v22, 0x21800000, v22
v_subrev_u32 v23, 0x21800000, v23
v_max_u32 v12, v20, v21
v_max3_u32 v12, v12, v22, v23
s_mov_b32 s64, 0x207
s_lshl_b32 s33, s35, 20
s_lshl_b32 s34, s20, 15
s_add_u32 s33, s33, s34
s_lshl_b32 s34, s23, 13
s_add_u32 s36, s33, s34
s_add_u32 s37, s36, 4096
s_add_u32 s38, s36, 16384
s_add_u32 s39, s36, 20480
v_pk_add_f32 v[224:225], v[224:225], v[32:33]
v_pk_add_f32 v[226:227], v[226:227], v[34:35]
s_waitcnt lgkmcnt(11)
v_pk_add_f32 v[240:241], v[240:241], v[48:49]
v_pk_add_f32 v[242:243], v[242:243], v[50:51]
v_pk_mul_f32 v[224:225], v[224:225], v[8:9] op_sel:[0,0] op_sel_hi:[1,0]
v_pk_mul_f32 v[226:227], v[226:227], v[8:9] op_sel:[0,0] op_sel_hi:[1,0]
v_pk_mul_f32 v[240:241], v[240:241], v[8:9] op_sel:[0,0] op_sel_hi:[1,0]
v_pk_mul_f32 v[242:243], v[242:243], v[8:9] op_sel:[0,0] op_sel_hi:[1,0]
v_cvt_pk_bf16_f32 v224, v224, v225
v_cvt_pk_bf16_f32 v225, v226, v227
v_cvt_pk_bf16_f32 v226, v240, v241
v_cvt_pk_bf16_f32 v227, v242, v243
v_pk_add_f32 v[228:229], v[228:229], v[36:37]
v_pk_add_f32 v[230:231], v[230:231], v[38:39]
s_waitcnt lgkmcnt(10)
v_pk_add_f32 v[244:245], v[244:245], v[52:53]
v_pk_add_f32 v[246:247], v[246:247], v[54:55]
M v[24:27], a[112:115], v[224:227], 0
buffer_store_dwordx4 v[224:227], v1, s[16:19], s38 offen offset:0 sc1
v_pk_mul_f32 v[228:229], v[228:229], v[8:9] op_sel:[0,1] op_sel_hi:[1,1]
v_pk_mul_f32 v[230:231], v[230:231], v[8:9] op_sel:[0,1] op_sel_hi:[1,1]
v_pk_mul_f32 v[244:245], v[244:245], v[8:9] op_sel:[0,1] op_sel_hi:[1,1]
v_pk_mul_f32 v[246:247], v[246:247], v[8:9] op_sel:[0,1] op_sel_hi:[1,1]
v_cvt_pk_bf16_f32 v228, v228, v229
v_cvt_pk_bf16_f32 v229, v230, v231
v_cvt_pk_bf16_f32 v230, v244, v245
v_cvt_pk_bf16_f32 v231, v246, v247
v_pk_add_f32 v[232:233], v[232:233], v[40:41]
v_pk_add_f32 v[234:235], v[234:235], v[42:43]
s_waitcnt lgkmcnt(9)
v_pk_add_f32 v[248:249], v[248:249], v[56:57]
v_pk_add_f32 v[250:251], v[250:251], v[58:59]
M v[24:27], a[112:115], v[228:231], v[24:27]
buffer_store_dwordx4 v[228:231], v1, s[16:19], s38 offen offset:2048 sc1
v_pk_mul_f32 v[232:233], v[232:233], v[10:11] op_sel:[0,0] op_sel_hi:[1,0]
v_pk_mul_f32 v[234:235], v[234:235], v[10:11] op_sel:[0,0] op_sel_hi:[1,0]
v_pk_mul_f32 v[248:249], v[248:249], v[10:11] op_sel:[0,0] op_sel_hi:[1,0]
v_pk_mul_f32 v[250:251], v[250:251], v[10:11] op_sel:[0,0] op_sel_hi:[1,0]
v_cvt_pk_bf16_f32 v232, v232, v233
v_cvt_pk_bf16_f32 v233, v234, v235
v_cvt_pk_bf16_f32 v234, v248, v249
v_cvt_pk_bf16_f32 v235, v250, v251
v_pk_add_f32 v[236:237], v[236:237], v[44:45]
v_pk_add_f32 v[238:239], v[238:239], v[46:47]
s_waitcnt lgkmcnt(8)
v_pk_add_f32 v[252:253], v[252:253], v[60:61]
v_pk_add_f32 v[254:255], v[254:255], v[62:63]
M v[24:27], a[112:115], v[232:235], v[24:27]
buffer_store_dwordx4 v[232:235], v1, s[16:19], s39 offen offset:0 sc1
v_pk_mul_f32 v[236:237], v[236:237], v[10:11] op_sel:[0,1] op_sel_hi:[1,1]
v_pk_mul_f32 v[238:239], v[238:239], v[10:11] op_sel:[0,1] op_sel_hi:[1,1]
v_pk_mul_f32 v[252:253], v[252:253], v[10:11] op_sel:[0,1] op_sel_hi:[1,1]
v_pk_mul_f32 v[254:255], v[254:255], v[10:11] op_sel:[0,1] op_sel_hi:[1,1]
v_cvt_pk_bf16_f32 v236, v236, v237
v_cvt_pk_bf16_f32 v237, v238, v239
v_cvt_pk_bf16_f32 v238, v252, v253
v_cvt_pk_bf16_f32 v239, v254, v255
v_accvgpr_read_b32 v32, a64
v_accvgpr_read_b32 v33, a65
v_accvgpr_read_b32 v34, a66
v_accvgpr_read_b32 v35, a67
s_waitcnt lgkmcnt(7)
v_pk_add_f32 v[32:33], v[32:33], v[64:65]
v_pk_add_f32 v[34:35], v[34:35], v[66:67]
v_accvgpr_read_b32 v48, a80
v_accvgpr_read_b32 v49, a81
v_accvgpr_read_b32 v50, a82
v_accvgpr_read_b32 v51, a83
s_waitcnt lgkmcnt(3)
v_pk_add_f32 v[48:49], v[48:49], v[80:81]
v_pk_add_f32 v[50:51], v[50:51], v[82:83]
M v[24:27], a[112:115], v[236:239], v[24:27]
buffer_store_dwordx4 v[236:239], v1, s[16:19], s39 offen offset:2048 sc1
v_pk_mul_f32 v[32:33], v[32:33], v[8:9] op_sel:[0,0] op_sel_hi:[1,0]
v_pk_mul_f32 v[34:35], v[34:35], v[8:9] op_sel:[0,0] op_sel_hi:[1,0]
v_pk_mul_f32 v[48:49], v[48:49], v[8:9] op_sel:[0,0] op_sel_hi:[1,0]
v_pk_mul_f32 v[50:51], v[50:51], v[8:9] op_sel:[0,0] op_sel_hi:[1,0]
v_cvt_pk_bf16_f32 v32, v32, v33
v_cvt_pk_bf16_f32 v33, v34, v35
v_cvt_pk_bf16_f32 v34, v48, v49
v_cvt_pk_bf16_f32 v35, v50, v51
v_accvgpr_read_b32 v240, a68
v_accvgpr_read_b32 v241, a69
v_accvgpr_read_b32 v242, a70
v_accvgpr_read_b32 v243, a71
v_pk_add_f32 v[240:241], v[240:241], v[68:69]
v_pk_add_f32 v[242:243], v[242:243], v[70:71]
v_accvgpr_read_b32 v36, a84
v_accvgpr_read_b32 v37, a85
v_accvgpr_read_b32 v38, a86
v_accvgpr_read_b32 v39, a87
s_waitcnt lgkmcnt(2)
v_pk_add_f32 v[36:37], v[36:37], v[84:85]
v_pk_add_f32 v[38:39], v[38:39], v[86:87]
M v[24:27], a[112:115], v[32:35], v[24:27]
buffer_store_dwordx4 v[32:35], v1, s[16:19], s38 offen offset:1024 sc1
v_pk_mul_f32 v[240:241], v[240:241], v[8:9] op_sel:[0,1] op_sel_hi:[1,1]
v_pk_mul_f32 v[242:243], v[242:243], v[8:9] op_sel:[0,1] op_sel_hi:[1,1]
v_pk_mul_f32 v[36:37], v[36:37], v[8:9] op_sel:[0,1] op_sel_hi:[1,1]
v_pk_mul_f32 v[38:39], v[38:39], v[8:9] op_sel:[0,1] op_sel_hi:[1,1]
v_cvt_pk_bf16_f32 v240, v240, v241
v_cvt_pk_bf16_f32 v241, v242, v243
v_cvt_pk_bf16_f32 v242, v36, v37
v_cvt_pk_bf16_f32 v243, v38, v39
v_accvgpr_read_b32 v52, a72
v_accvgpr_read_b32 v53, a73
v_accvgpr_read_b32 v54, a74
v_accvgpr_read_b32 v55, a75
v_pk_add_f32 v[52:53], v[52:53], v[72:73]
v_pk_add_f32 v[54:55], v[54:55], v[74:75]
v_accvgpr_read_b32 v244, a88
v_accvgpr_read_b32 v245, a89
v_accvgpr_read_b32 v246, a90
v_accvgpr_read_b32 v247, a91
s_waitcnt lgkmcnt(1)
v_pk_add_f32 v[244:245], v[244:245], v[88:89]
v_pk_add_f32 v[246:247], v[246:247], v[90:91]
M v[24:27], a[112:115], v[240:243], v[24:27]
buffer_store_dwordx4 v[240:243], v1, s[16:19], s38 offen offset:3072 sc1
v_pk_mul_f32 v[52:53], v[52:53], v[10:11] op_sel:[0,0] op_sel_hi:[1,0]
v_pk_mul_f32 v[54:55], v[54:55], v[10:11] op_sel:[0,0] op_sel_hi:[1,0]
v_pk_mul_f32 v[244:245], v[244:245], v[10:11] op_sel:[0,0] op_sel_hi:[1,0]
v_pk_mul_f32 v[246:247], v[246:247], v[10:11] op_sel:[0,0] op_sel_hi:[1,0]
v_cvt_pk_bf16_f32 v52, v52, v53
v_cvt_pk_bf16_f32 v53, v54, v55
v_cvt_pk_bf16_f32 v54, v244, v245
v_cvt_pk_bf16_f32 v55, v246, v247
v_accvgpr_read_b32 v40, a76
v_accvgpr_read_b32 v41, a77
v_accvgpr_read_b32 v42, a78
v_accvgpr_read_b32 v43, a79
v_pk_add_f32 v[40:41], v[40:41], v[76:77]
v_pk_add_f32 v[42:43], v[42:43], v[78:79]
v_accvgpr_read_b32 v56, a92
v_accvgpr_read_b32 v57, a93
v_accvgpr_read_b32 v58, a94
v_accvgpr_read_b32 v59, a95
s_waitcnt lgkmcnt(0)
v_pk_add_f32 v[56:57], v[56:57], v[92:93]
v_pk_add_f32 v[58:59], v[58:59], v[94:95]
M v[24:27], a[112:115], v[52:55], v[24:27]
buffer_store_dwordx4 v[52:55], v1, s[16:19], s39 offen offset:1024 sc1
v_pk_mul_f32 v[40:41], v[40:41], v[10:11] op_sel:[0,1] op_sel_hi:[1,1]
v_pk_mul_f32 v[42:43], v[42:43], v[10:11] op_sel:[0,1] op_sel_hi:[1,1]
v_pk_mul_f32 v[56:57], v[56:57], v[10:11] op_sel:[0,1] op_sel_hi:[1,1]
v_pk_mul_f32 v[58:59], v[58:59], v[10:11] op_sel:[0,1] op_sel_hi:[1,1]
v_cvt_pk_bf16_f32 v40, v40, v41
v_cvt_pk_bf16_f32 v41, v42, v43
v_cvt_pk_bf16_f32 v42, v56, v57
v_cvt_pk_bf16_f32 v43, v58, v59
s_nop 1
M v[24:27], a[112:115], v[40:43], v[24:27]
buffer_store_dwordx4 v[40:43], v1, s[16:19], s39 offen offset:3072 sc1
v_cmp_lt_u32 vcc, 0x3c000000, v12
s_nop 5
v_cmp_class_f32 s[40:41], v24, s64
s_nop 0
s_or_b64 vcc, vcc, s[40:41]
s_cmp_lg_u64 vcc, 0
s_cselect_b32 s33, 2, 0
s_or_b32 s60, s60, s33
Lk2_chk:
s_cmp_eq_u32 s60, 0
s_cbranch_scc1 Lk2_done
s_sub_u32 s56, 15, s21
s_lshl_b32 s33, s24, 1
s_lshl_b32 s61, 3, s33
s_and_b32 s34, s60, 2
s_bitcmp1_b32 s60, 0
s_cselect_b32 s56, s21, s56
s_cselect_b32 s61, 15, s61
s_cselect_b32 s60, s34, 0
s_waitcnt vmcnt(0)
s_lshl_b32 s33, s20, 7
s_lshl_b32 s34, s56, 3
s_add_u32 s33, s33, s34
s_lshl_b32 s34, s23, 2
s_add_u32 s33, s33, s34
s_lshl_b32 s33, s33, 12
buffer_load_dwordx4 a[0:3], v1, s[8:11], s33 offen offset:0 sc1
buffer_load_dwordx4 a[4:7], v1, s[8:11], s33 offen offset:1024 sc1
buffer_load_dwordx4 a[8:11], v1, s[8:11], s33 offen offset:2048 sc1
buffer_load_dwordx4 a[12:15], v1, s[8:11], s33 offen offset:3072 sc1
s_add_u32 s33, s33, 4096
buffer_load_dwordx4 a[16:19], v1, s[8:11], s33 offen offset:0 sc1
buffer_load_dwordx4 a[20:23], v1, s[8:11], s33 offen offset:1024 sc1
buffer_load_dwordx4 a[24:27], v1, s[8:11], s33 offen offset:2048 sc1
buffer_load_dwordx4 a[28:31], v1, s[8:11], s33 offen offset:3072 sc1
s_add_u32 s33, s33, 4096
buffer_load_dwordx4 a[32:35], v1, s[8:11], s33 offen offset:0 sc1
buffer_load_dwordx4 a[36:39], v1, s[8:11], s33 offen offset:1024 sc1
buffer_load_dwordx4 a[40:43], v1, s[8:11], s33 offen offset:2048 sc1
buffer_load_dwordx4 a[44:47], v1, s[8:11], s33 offen offset:3072 sc1
s_add_u32 s33, s33, 4096
buffer_load_dwordx4 a[48:51], v1, s[8:11], s33 offen offset:0 sc1
buffer_load_dwordx4 a[52:55], v1, s[8:11], s33 offen offset:1024 sc1
buffer_load_dwordx4 a[56:59], v1, s[8:11], s33 offen offset:2048 sc1
buffer_load_dwordx4 a[60:63], v1, s[8:11], s33 offen offset:3072 sc1
v_accvgpr_write_b32 a64, 0
v_accvgpr_write_b32 a65, 0
v_accvgpr_write_b32 a66, 0
v_accvgpr_write_b32 a67, 0
v_accvgpr_write_b32 a68, 0
v_accvgpr_write_b32 a69, 0
v_accvgpr_write_b32 a70, 0
v_accvgpr_write_b32 a71, 0
v_accvgpr_write_b32 a72, 0
v_accvgpr_write_b32 a73, 0
v_accvgpr_write_b32 a74, 0
v_accvgpr_write_b32 a75, 0
v_accvgpr_write_b32 a76, 0
v_accvgpr_write_b32 a77, 0
v_accvgpr_write_b32 a78, 0
v_accvgpr_write_b32 a79, 0
v_accvgpr_write_b32 a80, 0
v_accvgpr_write_b32 a81, 0
v_accvgpr_write_b32 a82, 0
v_accvgpr_write_b32 a83, 0
v_accvgpr_write_b32 a84, 0
v_accvgpr_write_b32 a85, 0
v_accvgpr_write_b32 a86, 0
v_accvgpr_write_b32 a87, 0
v_accvgpr_write_b32 a88, 0
v_accvgpr_write_b32 a89, 0
v_accvgpr_write_b32 a90, 0
v_accvgpr_write_b32 a91, 0
v_accvgpr_write_b32 a92, 0
v_accvgpr_write_b32 a93, 0
v_accvgpr_write_b32 a94, 0
v_accvgpr_write_b32 a95, 0
v_accvgpr_write_b32 a96, 0
v_accvgpr_write_b32 a97, 0
v_accvgpr_write_b32 a98, 0
v_accvgpr_write_b32 a99, 0
v_accvgpr_write_b32 a100, 0
v_accvgpr_write_b32 a101, 0
v_accvgpr_write_b32 a102, 0
v_accvgpr_write_b32 a103, 0
v_accvgpr_write_b32 a104, 0
v_accvgpr_write_b32 a105, 0
v_accvgpr_write_b32 a106, 0
v_accvgpr_write_b32 a107, 0
v_accvgpr_write_b32 a108, 0
v_accvgpr_write_b32 a109, 0
v_accvgpr_write_b32 a110, 0
v_accvgpr_write_b32 a111, 0
v_mov_b32 v160, 0
v_mov_b32 v161, 0
v_mov_b32 v162, 0
v_mov_b32 v163, 0
v_mov_b32 v164, 0
v_mov_b32 v165, 0
v_mov_b32 v166, 0
v_mov_b32 v167, 0
v_mov_b32 v168, 0
v_mov_b32 v169, 0
v_mov_b32 v170, 0
v_mov_b32 v171, 0
v_mov_b32 v172, 0
v_mov_b32 v173, 0
v_mov_b32 v174, 0
v_mov_b32 v175, 0
v_mov_b32 v176, 0
v_mov_b32 v177, 0
v_mov_b32 v178, 0
v_mov_b32 v179, 0
v_mov_b32 v180, 0
v_mov_b32 v181, 0
v_mov_b32 v182, 0
v_mov_b32 v183, 0
v_mov_b32 v184, 0
v_mov_b32 v185, 0
v_mov_b32 v186, 0
v_mov_b32 v187, 0
v_mov_b32 v188, 0
v_mov_b32 v189, 0
v_mov_b32 v190, 0
v_mov_b32 v191, 0
v_mov_b32 v192, 0
v_mov_b32 v193, 0
v_mov_b32 v194, 0
v_mov_b32 v195, 0
v_mov_b32 v196, 0
v_mov_b32 v197, 0
v_mov_b32 v198, 0
v_mov_b32 v199, 0
v_mov_b32 v200, 0
v_mov_b32 v201, 0
v_mov_b32 v202, 0
v_mov_b32 v203, 0
v_mov_b32 v204, 0
v_mov_b32 v205, 0
v_mov_b32 v206, 0
v_mov_b32 v207, 0
v_mov_b32 v208, 0
v_mov_b32 v209, 0
v_mov_b32 v210, 0
v_mov_b32 v211, 0
v_mov_b32 v212, 0
v_mov_b32 v213, 0
v_mov_b32 v214, 0
v_mov_b32 v215, 0
v_mov_b32 v216, 0
v_mov_b32 v217, 0
v_mov_b32 v218, 0
v_mov_b32 v219, 0
v_mov_b32 v220, 0
v_mov_b32 v221, 0
v_mov_b32 v222, 0
v_mov_b32 v223, 0
v_mov_b32 v224, 0
v_mov_b32 v225, 0
v_mov_b32 v226, 0
v_mov_b32 v227, 0
v_mov_b32 v228, 0
v_mov_b32 v229, 0
v_mov_b32 v230, 0
v_mov_b32 v231, 0
v_mov_b32 v232, 0
v_mov_b32 v233, 0
v_mov_b32 v234, 0
v_mov_b32 v235, 0
v_mov_b32 v236, 0
v_mov_b32 v237, 0
v_mov_b32 v238, 0
v_mov_b32 v239, 0
v_mov_b32 v240, 0
v_mov_b32 v241, 0
v_mov_b32 v242, 0
v_mov_b32 v243, 0
v_mov_b32 v244, 0
v_mov_b32 v245, 0
v_mov_b32 v246, 0
v_mov_b32 v247, 0
v_mov_b32 v248, 0
v_mov_b32 v249, 0
v_mov_b32 v250, 0
v_mov_b32 v251, 0
v_mov_b32 v252, 0
v_mov_b32 v253, 0
v_mov_b32 v254, 0
v_mov_b32 v255, 0
v_mov_b32 v8, v4
v_mov_b32 v9, v4
v_mov_b32 v10, v4
v_mov_b32 v11, v4
s_lshl_b32 s57, s20, 20
s_lshl_b32 s58, s56, 7
s_lshl_b32 s59, s56, 1
s_add_u32 s59, s59, 2
Lslow_1:
s_add_u32 s35, s57, 0
buffer_load_dwordx4 v[96:99], v1, s[12:15], s35 offen offset:0 sc1
buffer_load_dwordx4 v[100:103], v1, s[12:15], s35 offen offset:1024 sc1
buffer_load_dwordx4 v[104:107], v1, s[12:15], s35 offen offset:2048 sc1
buffer_load_dwordx4 v[108:111], v1, s[12:15], s35 offen offset:3072 sc1
s_add_u32 s35, s57, 4096
buffer_load_dwordx4 v[112:115], v1, s[12:15], s35 offen offset:0 sc1
buffer_load_dwordx4 v[116:119], v1, s[12:15], s35 offen offset:1024 sc1
buffer_load_dwordx4 v[120:123], v1, s[12:15], s35 offen offset:2048 sc1
buffer_load_dwordx4 v[124:127], v1, s[12:15], s35 offen offset:3072 sc1
s_add_u32 s35, s57, 8192
buffer_load_dwordx4 v[128:131], v1, s[12:15], s35 offen offset:0 sc1
buffer_load_dwordx4 v[132:135], v1, s[12:15], s35 offen offset:1024 sc1
buffer_load_dwordx4 v[136:139], v1, s[12:15], s35 offen offset:2048 sc1
buffer_load_dwordx4 v[140:143], v1, s[12:15], s35 offen offset:3072 sc1
s_add_u32 s35, s57, 12288
buffer_load_dwordx4 v[144:147], v1, s[12:15], s35 offen offset:0 sc1
buffer_load_dwordx4 v[148:151], v1, s[12:15], s35 offen offset:1024 sc1
buffer_load_dwordx4 v[152:155], v1, s[12:15], s35 offen offset:2048 sc1
buffer_load_dwordx4 v[156:159], v1, s[12:15], s35 offen offset:3072 sc1
s_lshl_b32 s33, s23, 6
s_add_i32 s33, s33, s58
s_cmp_gt_i32 s33, 0
s_cselect_b32 s34, 0, 0xf149f2ca
s_cmp_lt_i32 s33, 0
s_cselect_b32 s33, 0xf149f2ca, 0
v_mov_b32 v20, s34
v_mov_b32 v21, s34
v_mov_b32 v22, s34
v_mov_b32 v23, s34
v_mov_b32 v28, s33
v_mov_b32 v29, s33
v_mov_b32 v30, s33
v_mov_b32 v31, s33
v_med3_f32 v24, v16, v20, v28
v_med3_f32 v25, v17, v20, v28
v_med3_f32 v26, v18, v20, v28
v_med3_f32 v27, v19, v20, v28
s_waitcnt vmcnt(0)
s_nop 0
M v[32:35], v[96:99], a[0:3], v[24:27]
M v[32:35], v[100:103], a[4:7], v[32:35]
M v[32:35], v[104:107], a[8:11], v[32:35]
M v[32:35], v[108:111], a[12:15], v[32:35]
M v[36:39], v[96:99], a[16:19], v[28:31]
M v[36:39], v[100:103], a[20:23], v[36:39]
M v[36:39], v[104:107], a[24:27], v[36:39]
M v[36:39], v[108:111], a[28:31], v[36:39]
M v[40:43], v[96:99], a[32:35], v[28:31]
M v[40:43], v[100:103], a[36:39], v[40:43]
M v[40:43], v[104:107], a[40:43], v[40:43]
M v[40:43], v[108:111], a[44:47], v[40:43]
M v[44:47], v[96:99], a[48:51], v[28:31]
M v[44:47], v[100:103], a[52:55], v[44:47]
M v[44:47], v[104:107], a[56:59], v[44:47]
M v[44:47], v[108:111], a[60:63], v[44:47]
M v[48:51], v[112:115], a[0:3], v[20:23]
M v[48:51], v[116:119], a[4:7], v[48:51]
M v[48:51], v[120:123], a[8:11], v[48:51]
M v[48:51], v[124:127], a[12:15], v[48:51]
M v[52:55], v[112:115], a[16:19], v[24:27]
M v[52:55], v[116:119], a[20:23], v[52:55]
M v[52:55], v[120:123], a[24:27], v[52:55]
M v[52:55], v[124:127], a[28:31], v[52:55]
M v[56:59], v[112:115], a[32:35], v[28:31]
M v[56:59], v[116:119], a[36:39], v[56:59]
M v[56:59], v[120:123], a[40:43], v[56:59]
M v[56:59], v[124:127], a[44:47], v[56:59]
M v[60:63], v[112:115], a[48:51], v[28:31]
M v[60:63], v[116:119], a[52:55], v[60:63]
M v[60:63], v[120:123], a[56:59], v[60:63]
M v[60:63], v[124:127], a[60:63], v[60:63]
M v[64:67], v[128:131], a[0:3], v[20:23]
M v[64:67], v[132:135], a[4:7], v[64:67]
M v[64:67], v[136:139], a[8:11], v[64:67]
M v[64:67], v[140:143], a[12:15], v[64:67]
M v[68:71], v[128:131], a[16:19], v[20:23]
M v[68:71], v[132:135], a[20:23], v[68:71]
M v[68:71], v[136:139], a[24:27], v[68:71]
M v[68:71], v[140:143], a[28:31], v[68:71]
M v[72:75], v[128:131], a[32:35], v[24:27]
M v[72:75], v[132:135], a[36:39], v[72:75]
M v[72:75], v[136:139], a[40:43], v[72:75]
M v[72:75], v[140:143], a[44:47], v[72:75]
M v[76:79], v[128:131], a[48:51], v[28:31]
M v[76:79], v[132:135], a[52:55], v[76:79]
M v[76:79], v[136:139], a[56:59], v[76:79]
M v[76:79], v[140:143], a[60:63], v[76:79]
M v[80:83], v[144:147], a[0:3], v[20:23]
M v[80:83], v[148:151], a[4:7], v[80:83]
M v[80:83], v[152:155], a[8:11], v[80:83]
M v[80:83], v[156:159], a[12:15], v[80:83]
M v[84:87], v[144:147], a[16:19], v[20:23]
M v[84:87], v[148:151], a[20:23], v[84:87]
M v[84:87], v[152:155], a[24:27], v[84:87]
M v[84:87], v[156:159], a[28:31], v[84:87]
M v[88:91], v[144:147], a[32:35], v[20:23]
M v[88:91], v[148:151], a[36:39], v[88:91]
M v[88:91], v[152:155], a[40:43], v[88:91]
M v[88:91], v[156:159], a[44:47], v[88:91]
M v[92:95], v[144:147], a[48:51], v[24:27]
M v[92:95], v[148:151], a[52:55], v[92:95]
M v[92:95], v[152:155], a[56:59], v[92:95]
M v[92:95], v[156:159], a[60:63], v[92:95]
s_nop 7
s_add_u32 s35, s57, 16384
buffer_load_dwordx4 v[96:99], v1, s[12:15], s35 offen offset:0 sc1
buffer_load_dwordx4 v[100:103], v1, s[12:15], s35 offen offset:1024 sc1
buffer_load_dwordx4 v[104:107], v1, s[12:15], s35 offen offset:2048 sc1
buffer_load_dwordx4 v[108:111], v1, s[12:15], s35 offen offset:3072 sc1
s_add_u32 s35, s57, 20480
buffer_load_dwordx4 v[112:115], v1, s[12:15], s35 offen offset:0 sc1
buffer_load_dwordx4 v[116:119], v1, s[12:15], s35 offen offset:1024 sc1
buffer_load_dwordx4 v[120:123], v1, s[12:15], s35 offen offset:2048 sc1
buffer_load_dwordx4 v[124:127], v1, s[12:15], s35 offen offset:3072 sc1
s_add_u32 s35, s57, 24576
buffer_load_dwordx4 v[128:131], v1, s[12:15], s35 offen offset:0 sc1
buffer_load_dwordx4 v[132:135], v1, s[12:15], s35 offen offset:1024 sc1
buffer_load_dwordx4 v[136:139], v1, s[12:15], s35 offen offset:2048 sc1
buffer_load_dwordx4 v[140:143], v1, s[12:15], s35 offen offset:3072 sc1
s_add_u32 s35, s57, 28672
buffer_load_dwordx4 v[144:147], v1, s[12:15], s35 offen offset:0 sc1
buffer_load_dwordx4 v[148:151], v1, s[12:15], s35 offen offset:1024 sc1
buffer_load_dwordx4 v[152:155], v1, s[12:15], s35 offen offset:2048 sc1
buffer_load_dwordx4 v[156:159], v1, s[12:15], s35 offen offset:3072 sc1
v_max3_f32 v13, v32, v33, v8
v_max3_f32 v13, v13, v34, v35
v_max3_f32 v13, v13, v48, v49
v_max3_f32 v13, v13, v50, v51
v_max3_f32 v13, v13, v64, v65
v_max3_f32 v13, v13, v66, v67
v_max3_f32 v13, v13, v80, v81
v_max3_f32 v13, v13, v82, v83
v_mov_b32 v14, v13
s_nop 1
v_permlane16_swap_b32 v13, v14
v_max_f32 v13, v13, v14
v_mov_b32 v14, v13
s_nop 1
v_permlane32_swap_b32 v13, v14
v_max_f32 v13, v13, v14
v_sub_f32 v12, v8, v13
v_exp_f32 v12, v12
v_mov_b32 v8, v13
v_sub_f32 v32, v32, v13
v_sub_f32 v33, v33, v13
v_sub_f32 v34, v34, v13
v_sub_f32 v35, v35, v13
v_sub_f32 v48, v48, v13
v_sub_f32 v49, v49, v13
v_sub_f32 v50, v50, v13
v_sub_f32 v51, v51, v13
v_sub_f32 v64, v64, v13
v_sub_f32 v65, v65, v13
v_sub_f32 v66, v66, v13
v_sub_f32 v67, v67, v13
v_sub_f32 v80, v80, v13
v_sub_f32 v81, v81, v13
v_sub_f32 v82, v82, v13
v_sub_f32 v83, v83, v13
v_mul_f32 v160, v160, v12
v_mul_f32 v161, v161, v12
v_mul_f32 v162, v162, v12
v_mul_f32 v163, v163, v12
v_mul_f32 v176, v176, v12
v_mul_f32 v177, v177, v12
v_mul_f32 v178, v178, v12
v_mul_f32 v179, v179, v12
v_mul_f32 v192, v192, v12
v_mul_f32 v193, v193, v12
v_mul_f32 v194, v194, v12
v_mul_f32 v195, v195, v12
v_mul_f32 v208, v208, v12
v_mul_f32 v209, v209, v12
v_mul_f32 v210, v210, v12
v_mul_f32 v211, v211, v12
v_mul_f32 v224, v224, v12
v_mul_f32 v225, v225, v12
v_mul_f32 v226, v226, v12
v_mul_f32 v227, v227, v12
v_mul_f32 v240, v240, v12
v_mul_f32 v241, v241, v12
v_mul_f32 v242, v242, v12
v_mul_f32 v243, v243, v12
v_accvgpr_read_b32 v14, a64
v_mul_f32 v14, v14, v12
v_accvgpr_write_b32 a64, v14
v_accvgpr_read_b32 v14, a65
v_mul_f32 v14, v14, v12
v_accvgpr_write_b32 a65, v14
v_accvgpr_read_b32 v14, a66
v_mul_f32 v14, v14, v12
v_accvgpr_write_b32 a66, v14
v_accvgpr_read_b32 v14, a67
v_mul_f32 v14, v14, v12
v_accvgpr_write_b32 a67, v14
v_accvgpr_read_b32 v14, a80
v_mul_f32 v14, v14, v12
v_accvgpr_write_b32 a80, v14
v_accvgpr_read_b32 v14, a81
v_mul_f32 v14, v14, v12
v_accvgpr_write_b32 a81, v14
v_accvgpr_read_b32 v14, a82
v_mul_f32 v14, v14, v12
v_accvgpr_write_b32 a82, v14
v_accvgpr_read_b32 v14, a83
v_mul_f32 v14, v14, v12
v_accvgpr_write_b32 a83, v14
v_accvgpr_read_b32 v14, a96
v_mul_f32 v14, v14, v12
v_accvgpr_write_b32 a96, v14
v_accvgpr_read_b32 v14, a97
v_mul_f32 v14, v14, v12
v_accvgpr_write_b32 a97, v14
v_accvgpr_read_b32 v14, a98
v_mul_f32 v14, v14, v12
v_accvgpr_write_b32 a98, v14
v_accvgpr_read_b32 v14, a99
v_mul_f32 v14, v14, v12
v_accvgpr_write_b32 a99, v14
v_max3_f32 v13, v36, v37, v9
v_max3_f32 v13, v13, v38, v39
v_max3_f32 v13, v13, v52, v53
v_max3_f32 v13, v13, v54, v55
v_max3_f32 v13, v13, v68, v69
v_max3_f32 v13, v13, v70, v71
v_max3_f32 v13, v13, v84, v85
v_max3_f32 v13, v13, v86, v87
v_mov_b32 v14, v13
s_nop 1
v_permlane16_swap_b32 v13, v14
v_max_f32 v13, v13, v14
v_mov_b32 v14, v13
s_nop 1
v_permlane32_swap_b32 v13, v14
v_max_f32 v13, v13, v14
v_sub_f32 v12, v9, v13
v_exp_f32 v12, v12
v_mov_b32 v9, v13
v_sub_f32 v36, v36, v13
v_sub_f32 v37, v37, v13
v_sub_f32 v38, v38, v13
v_sub_f32 v39, v39, v13
v_sub_f32 v52, v52, v13
v_sub_f32 v53, v53, v13
v_sub_f32 v54, v54, v13
v_sub_f32 v55, v55, v13
v_sub_f32 v68, v68, v13
v_sub_f32 v69, v69, v13
v_sub_f32 v70, v70, v13
v_sub_f32 v71, v71, v13
v_sub_f32 v84, v84, v13
v_sub_f32 v85, v85, v13
v_sub_f32 v86, v86, v13
v_sub_f32 v87, v87, v13
v_mul_f32 v164, v164, v12
v_mul_f32 v165, v165, v12
v_mul_f32 v166, v166, v12
v_mul_f32 v167, v167, v12
v_mul_f32 v180, v180, v12
v_mul_f32 v181, v181, v12
v_mul_f32 v182, v182, v12
v_mul_f32 v183, v183, v12
v_mul_f32 v196, v196, v12
v_mul_f32 v197, v197, v12
v_mul_f32 v198, v198, v12
v_mul_f32 v199, v199, v12
v_mul_f32 v212, v212, v12
v_mul_f32 v213, v213, v12
v_mul_f32 v214, v214, v12
v_mul_f32 v215, v215, v12
v_mul_f32 v228, v228, v12
v_mul_f32 v229, v229, v12
v_mul_f32 v230, v230, v12
v_mul_f32 v231, v231, v12
v_mul_f32 v244, v244, v12
v_mul_f32 v245, v245, v12
v_mul_f32 v246, v246, v12
v_mul_f32 v247, v247, v12
v_accvgpr_read_b32 v14, a68
v_mul_f32 v14, v14, v12
v_accvgpr_write_b32 a68, v14
v_accvgpr_read_b32 v14, a69
v_mul_f32 v14, v14, v12
v_accvgpr_write_b32 a69, v14
v_accvgpr_read_b32 v14, a70
v_mul_f32 v14, v14, v12
v_accvgpr_write_b32 a70, v14
v_accvgpr_read_b32 v14, a71
v_mul_f32 v14, v14, v12
v_accvgpr_write_b32 a71, v14
v_accvgpr_read_b32 v14, a84
v_mul_f32 v14, v14, v12
v_accvgpr_write_b32 a84, v14
v_accvgpr_read_b32 v14, a85
v_mul_f32 v14, v14, v12
v_accvgpr_write_b32 a85, v14
v_accvgpr_read_b32 v14, a86
v_mul_f32 v14, v14, v12
v_accvgpr_write_b32 a86, v14
v_accvgpr_read_b32 v14, a87
v_mul_f32 v14, v14, v12
v_accvgpr_write_b32 a87, v14
v_accvgpr_read_b32 v14, a100
v_mul_f32 v14, v14, v12
v_accvgpr_write_b32 a100, v14
v_accvgpr_read_b32 v14, a101
v_mul_f32 v14, v14, v12
v_accvgpr_write_b32 a101, v14
v_accvgpr_read_b32 v14, a102
v_mul_f32 v14, v14, v12
v_accvgpr_write_b32 a102, v14
v_accvgpr_read_b32 v14, a103
v_mul_f32 v14, v14, v12
v_accvgpr_write_b32 a103, v14
v_max3_f32 v13, v40, v41, v10
v_max3_f32 v13, v13, v42, v43
v_max3_f32 v13, v13, v56, v57
v_max3_f32 v13, v13, v58, v59
v_max3_f32 v13, v13, v72, v73
v_max3_f32 v13, v13, v74, v75
v_max3_f32 v13, v13, v88, v89
v_max3_f32 v13, v13, v90, v91
v_mov_b32 v14, v13
s_nop 1
v_permlane16_swap_b32 v13, v14
v_max_f32 v13, v13, v14
v_mov_b32 v14, v13
s_nop 1
v_permlane32_swap_b32 v13, v14
v_max_f32 v13, v13, v14
v_sub_f32 v12, v10, v13
v_exp_f32 v12, v12
v_mov_b32 v10, v13
v_sub_f32 v40, v40, v13
v_sub_f32 v41, v41, v13
v_sub_f32 v42, v42, v13
v_sub_f32 v43, v43, v13
v_sub_f32 v56, v56, v13
v_sub_f32 v57, v57, v13
v_sub_f32 v58, v58, v13
v_sub_f32 v59, v59, v13
v_sub_f32 v72, v72, v13
v_sub_f32 v73, v73, v13
v_sub_f32 v74, v74, v13
v_sub_f32 v75, v75, v13
v_sub_f32 v88, v88, v13
v_sub_f32 v89, v89, v13
v_sub_f32 v90, v90, v13
v_sub_f32 v91, v91, v13
v_mul_f32 v168, v168, v12
v_mul_f32 v169, v169, v12
v_mul_f32 v170, v170, v12
v_mul_f32 v171, v171, v12
v_mul_f32 v184, v184, v12
v_mul_f32 v185, v185, v12
v_mul_f32 v186, v186, v12
v_mul_f32 v187, v187, v12
v_mul_f32 v200, v200, v12
v_mul_f32 v201, v201, v12
v_mul_f32 v202, v202, v12
v_mul_f32 v203, v203, v12
v_mul_f32 v216, v216, v12
v_mul_f32 v217, v217, v12
v_mul_f32 v218, v218, v12
v_mul_f32 v219, v219, v12
v_mul_f32 v232, v232, v12
v_mul_f32 v233, v233, v12
v_mul_f32 v234, v234, v12
v_mul_f32 v235, v235, v12
v_mul_f32 v248, v248, v12
v_mul_f32 v249, v249, v12
v_mul_f32 v250, v250, v12
v_mul_f32 v251, v251, v12
v_accvgpr_read_b32 v14, a72
v_mul_f32 v14, v14, v12
v_accvgpr_write_b32 a72, v14
v_accvgpr_read_b32 v14, a73
v_mul_f32 v14, v14, v12
v_accvgpr_write_b32 a73, v14
v_accvgpr_read_b32 v14, a74
v_mul_f32 v14, v14, v12
v_accvgpr_write_b32 a74, v14
v_accvgpr_read_b32 v14, a75
v_mul_f32 v14, v14, v12
v_accvgpr_write_b32 a75, v14
v_accvgpr_read_b32 v14, a88
v_mul_f32 v14, v14, v12
v_accvgpr_write_b32 a88, v14
v_accvgpr_read_b32 v14, a89
v_mul_f32 v14, v14, v12
v_accvgpr_write_b32 a89, v14
v_accvgpr_read_b32 v14, a90
v_mul_f32 v14, v14, v12
v_accvgpr_write_b32 a90, v14
v_accvgpr_read_b32 v14, a91
v_mul_f32 v14, v14, v12
v_accvgpr_write_b32 a91, v14
v_accvgpr_read_b32 v14, a104
v_mul_f32 v14, v14, v12
v_accvgpr_write_b32 a104, v14
v_accvgpr_read_b32 v14, a105
v_mul_f32 v14, v14, v12
v_accvgpr_write_b32 a105, v14
v_accvgpr_read_b32 v14, a106
v_mul_f32 v14, v14, v12
v_accvgpr_write_b32 a106, v14
v_accvgpr_read_b32 v14, a107
v_mul_f32 v14, v14, v12
v_accvgpr_write_b32 a107, v14
v_max3_f32 v13, v44, v45, v11
v_max3_f32 v13, v13, v46, v47
v_max3_f32 v13, v13, v60, v61
v_max3_f32 v13, v13, v62, v63
v_max3_f32 v13, v13, v76, v77
v_max3_f32 v13, v13, v78, v79
v_max3_f32 v13, v13, v92, v93
v_max3_f32 v13, v13, v94, v95
v_mov_b32 v14, v13
s_nop 1
v_permlane16_swap_b32 v13, v14
v_max_f32 v13, v13, v14
v_mov_b32 v14, v13
s_nop 1
v_permlane32_swap_b32 v13, v14
v_max_f32 v13, v13, v14
v_sub_f32 v12, v11, v13
v_exp_f32 v12, v12
v_mov_b32 v11, v13
v_sub_f32 v44, v44, v13
v_sub_f32 v45, v45, v13
v_sub_f32 v46, v46, v13
v_sub_f32 v47, v47, v13
v_sub_f32 v60, v60, v13
v_sub_f32 v61, v61, v13
v_sub_f32 v62, v62, v13
v_sub_f32 v63, v63, v13
v_sub_f32 v76, v76, v13
v_sub_f32 v77, v77, v13
v_sub_f32 v78, v78, v13
v_sub_f32 v79, v79, v13
v_sub_f32 v92, v92, v13
v_sub_f32 v93, v93, v13
v_sub_f32 v94, v94, v13
v_sub_f32 v95, v95, v13
v_mul_f32 v172, v172, v12
v_mul_f32 v173, v173, v12
v_mul_f32 v174, v174, v12
v_mul_f32 v175, v175, v12
v_mul_f32 v188, v188, v12
v_mul_f32 v189, v189, v12
v_mul_f32 v190, v190, v12
v_mul_f32 v191, v191, v12
v_mul_f32 v204, v204, v12
v_mul_f32 v205, v205, v12
v_mul_f32 v206, v206, v12
v_mul_f32 v207, v207, v12
v_mul_f32 v220, v220, v12
v_mul_f32 v221, v221, v12
v_mul_f32 v222, v222, v12
v_mul_f32 v223, v223, v12
v_mul_f32 v236, v236, v12
v_mul_f32 v237, v237, v12
v_mul_f32 v238, v238, v12
v_mul_f32 v239, v239, v12
v_mul_f32 v252, v252, v12
v_mul_f32 v253, v253, v12
v_mul_f32 v254, v254, v12
v_mul_f32 v255, v255, v12
v_accvgpr_read_b32 v14, a76
v_mul_f32 v14, v14, v12
v_accvgpr_write_b32 a76, v14
v_accvgpr_read_b32 v14, a77
v_mul_f32 v14, v14, v12
v_accvgpr_write_b32 a77, v14
v_accvgpr_read_b32 v14, a78
v_mul_f32 v14, v14, v12
v_accvgpr_write_b32 a78, v14
v_accvgpr_read_b32 v14, a79
v_mul_f32 v14, v14, v12
v_accvgpr_write_b32 a79, v14
v_accvgpr_read_b32 v14, a92
v_mul_f32 v14, v14, v12
v_accvgpr_write_b32 a92, v14
v_accvgpr_read_b32 v14, a93
v_mul_f32 v14, v14, v12
v_accvgpr_write_b32 a93, v14
v_accvgpr_read_b32 v14, a94
v_mul_f32 v14, v14, v12
v_accvgpr_write_b32 a94, v14
v_accvgpr_read_b32 v14, a95
v_mul_f32 v14, v14, v12
v_accvgpr_write_b32 a95, v14
v_accvgpr_read_b32 v14, a108
v_mul_f32 v14, v14, v12
v_accvgpr_write_b32 a108, v14
v_accvgpr_read_b32 v14, a109
v_mul_f32 v14, v14, v12
v_accvgpr_write_b32 a109, v14
v_accvgpr_read_b32 v14, a110
v_mul_f32 v14, v14, v12
v_accvgpr_write_b32 a110, v14
v_accvgpr_read_b32 v14, a111
v_mul_f32 v14, v14, v12
v_accvgpr_write_b32 a111, v14
v_exp_f32 v32, v32
v_exp_f32 v33, v33
v_exp_f32 v34, v34
v_exp_f32 v35, v35
v_exp_f32 v48, v48
v_exp_f32 v49, v49
v_exp_f32 v50, v50
v_exp_f32 v51, v51
v_cvt_pk_bf16_f32 v32, v32, v33
v_cvt_pk_bf16_f32 v33, v34, v35
v_exp_f32 v36, v36
v_exp_f32 v37, v37
v_exp_f32 v38, v38
v_exp_f32 v39, v39
v_cvt_pk_bf16_f32 v34, v48, v49
v_cvt_pk_bf16_f32 v35, v50, v51
v_exp_f32 v52, v52
v_exp_f32 v53, v53
v_exp_f32 v54, v54
v_exp_f32 v55, v55
v_cvt_pk_bf16_f32 v36, v36, v37
v_cvt_pk_bf16_f32 v37, v38, v39
v_exp_f32 v40, v40
v_exp_f32 v41, v41
v_exp_f32 v42, v42
v_exp_f32 v43, v43
v_cvt_pk_bf16_f32 v38, v52, v53
v_cvt_pk_bf16_f32 v39, v54, v55
v_exp_f32 v56, v56
v_exp_f32 v57, v57
v_exp_f32 v58, v58
v_exp_f32 v59, v59
v_cvt_pk_bf16_f32 v40, v40, v41
v_cvt_pk_bf16_f32 v41, v42, v43
v_exp_f32 v44, v44
v_exp_f32 v45, v45
v_exp_f32 v46, v46
v_exp_f32 v47, v47
v_cvt_pk_bf16_f32 v42, v56, v57
v_cvt_pk_bf16_f32 v43, v58, v59
v_exp_f32 v60, v60
v_exp_f32 v61, v61
v_exp_f32 v62, v62
v_exp_f32 v63, v63
v_cvt_pk_bf16_f32 v44, v44, v45
v_cvt_pk_bf16_f32 v45, v46, v47
v_cvt_pk_bf16_f32 v46, v60, v61
v_cvt_pk_bf16_f32 v47, v62, v63
v_exp_f32 v64, v64
v_exp_f32 v65, v65
v_exp_f32 v66, v66
v_exp_f32 v67, v67
v_exp_f32 v80, v80
v_exp_f32 v81, v81
v_exp_f32 v82, v82
v_exp_f32 v83, v83
v_cvt_pk_bf16_f32 v64, v64, v65
v_cvt_pk_bf16_f32 v65, v66, v67
v_exp_f32 v68, v68
v_exp_f32 v69, v69
v_exp_f32 v70, v70
v_exp_f32 v71, v71
v_cvt_pk_bf16_f32 v66, v80, v81
v_cvt_pk_bf16_f32 v67, v82, v83
v_exp_f32 v84, v84
v_exp_f32 v85, v85
v_exp_f32 v86, v86
v_exp_f32 v87, v87
v_cvt_pk_bf16_f32 v68, v68, v69
v_cvt_pk_bf16_f32 v69, v70, v71
v_exp_f32 v72, v72
v_exp_f32 v73, v73
v_exp_f32 v74, v74
v_exp_f32 v75, v75
v_cvt_pk_bf16_f32 v70, v84, v85
v_cvt_pk_bf16_f32 v71, v86, v87
v_exp_f32 v88, v88
v_exp_f32 v89, v89
v_exp_f32 v90, v90
v_exp_f32 v91, v91
v_cvt_pk_bf16_f32 v72, v72, v73
v_cvt_pk_bf16_f32 v73, v74, v75
v_exp_f32 v76, v76
v_exp_f32 v77, v77
v_exp_f32 v78, v78
v_exp_f32 v79, v79
v_cvt_pk_bf16_f32 v74, v88, v89
v_cvt_pk_bf16_f32 v75, v90, v91
v_exp_f32 v92, v92
v_exp_f32 v93, v93
v_exp_f32 v94, v94
v_exp_f32 v95, v95
v_cvt_pk_bf16_f32 v76, v76, v77
v_cvt_pk_bf16_f32 v77, v78, v79
v_cvt_pk_bf16_f32 v78, v92, v93
v_cvt_pk_bf16_f32 v79, v94, v95
s_waitcnt vmcnt(0)
M a[96:99], a[112:115], v[32:35], a[96:99]
M a[100:103], a[112:115], v[36:39], a[100:103]
M a[104:107], a[112:115], v[40:43], a[104:107]
M a[108:111], a[112:115], v[44:47], a[108:111]
M v[160:163], v[96:99], v[32:35], v[160:163]
M v[164:167], v[96:99], v[36:39], v[164:167]
M v[168:171], v[96:99], v[40:43], v[168:171]
M v[172:175], v[96:99], v[44:47], v[172:175]
M v[176:179], v[100:103], v[32:35], v[176:179]
M v[180:183], v[100:103], v[36:39], v[180:183]
M v[184:187], v[100:103], v[40:43], v[184:187]
M v[188:191], v[100:103], v[44:47], v[188:191]
M v[192:195], v[104:107], v[32:35], v[192:195]
M v[196:199], v[104:107], v[36:39], v[196:199]
M v[200:203], v[104:107], v[40:43], v[200:203]
M v[204:207], v[104:107], v[44:47], v[204:207]
M v[208:211], v[108:111], v[32:35], v[208:211]
M v[212:215], v[108:111], v[36:39], v[212:215]
M v[216:219], v[108:111], v[40:43], v[216:219]
M v[220:223], v[108:111], v[44:47], v[220:223]
M v[224:227], v[112:115], v[32:35], v[224:227]
M v[228:231], v[112:115], v[36:39], v[228:231]
M v[232:235], v[112:115], v[40:43], v[232:235]
M v[236:239], v[112:115], v[44:47], v[236:239]
M v[240:243], v[116:119], v[32:35], v[240:243]
M v[244:247], v[116:119], v[36:39], v[244:247]
M v[248:251], v[116:119], v[40:43], v[248:251]
M v[252:255], v[116:119], v[44:47], v[252:255]
M a[64:67], v[120:123], v[32:35], a[64:67]
M a[68:71], v[120:123], v[36:39], a[68:71]
M a[72:75], v[120:123], v[40:43], a[72:75]
M a[76:79], v[120:123], v[44:47], a[76:79]
M a[80:83], v[124:127], v[32:35], a[80:83]
M a[84:87], v[124:127], v[36:39], a[84:87]
M a[88:91], v[124:127], v[40:43], a[88:91]
M a[92:95], v[124:127], v[44:47], a[92:95]
M a[96:99], a[112:115], v[64:67], a[96:99]
M a[100:103], a[112:115], v[68:71], a[100:103]
M a[104:107], a[112:115], v[72:75], a[104:107]
M a[108:111], a[112:115], v[76:79], a[108:111]
M v[160:163], v[128:131], v[64:67], v[160:163]
M v[164:167], v[128:131], v[68:71], v[164:167]
M v[168:171], v[128:131], v[72:75], v[168:171]
M v[172:175], v[128:131], v[76:79], v[172:175]
M v[176:179], v[132:135], v[64:67], v[176:179]
M v[180:183], v[132:135], v[68:71], v[180:183]
M v[184:187], v[132:135], v[72:75], v[184:187]
M v[188:191], v[132:135], v[76:79], v[188:191]
M v[192:195], v[136:139], v[64:67], v[192:195]
M v[196:199], v[136:139], v[68:71], v[196:199]
M v[200:203], v[136:139], v[72:75], v[200:203]
M v[204:207], v[136:139], v[76:79], v[204:207]
M v[208:211], v[140:143], v[64:67], v[208:211]
M v[212:215], v[140:143], v[68:71], v[212:215]
M v[216:219], v[140:143], v[72:75], v[216:219]
M v[220:223], v[140:143], v[76:79], v[220:223]
M v[224:227], v[144:147], v[64:67], v[224:227]
M v[228:231], v[144:147], v[68:71], v[228:231]
M v[232:235], v[144:147], v[72:75], v[232:235]
M v[236:239], v[144:147], v[76:79], v[236:239]
M v[240:243], v[148:151], v[64:67], v[240:243]
M v[244:247], v[148:151], v[68:71], v[244:247]
M v[248:251], v[148:151], v[72:75], v[248:251]
M v[252:255], v[148:151], v[76:79], v[252:255]
M a[64:67], v[152:155], v[64:67], a[64:67]
M a[68:71], v[152:155], v[68:71], a[68:71]
M a[72:75], v[152:155], v[72:75], a[72:75]
M a[76:79], v[152:155], v[76:79], a[76:79]
M a[80:83], v[156:159], v[64:67], a[80:83]
M a[84:87], v[156:159], v[68:71], a[84:87]
M a[88:91], v[156:159], v[72:75], a[88:91]
M a[92:95], v[156:159], v[76:79], a[92:95]
s_nop 7
s_add_u32 s57, s57, 32768
s_sub_u32 s58, s58, 64
s_sub_u32 s59, s59, 1
s_cmp_lg_u32 s59, 0
s_cbranch_scc1 Lslow_1
v_accvgpr_read_b32 v20, a96
v_accvgpr_read_b32 v21, a100
v_accvgpr_read_b32 v22, a104
v_accvgpr_read_b32 v23, a108
v_rcp_f32 v8, v20
v_rcp_f32 v9, v21
v_rcp_f32 v10, v22
v_rcp_f32 v11, v23
s_lshl_b32 s33, s56, 20
s_lshl_b32 s34, s20, 15
s_add_u32 s33, s33, s34
s_lshl_b32 s34, s23, 13
s_add_u32 s36, s33, s34
s_add_u32 s37, s36, 4096
s_add_u32 s38, s36, 16384
s_add_u32 s39, s36, 20480
v_pk_mul_f32 v[160:161], v[160:161], v[8:9] op_sel:[0,0] op_sel_hi:[1,0]
v_pk_mul_f32 v[162:163], v[162:163], v[8:9] op_sel:[0,0] op_sel_hi:[1,0]
v_pk_mul_f32 v[176:177], v[176:177], v[8:9] op_sel:[0,0] op_sel_hi:[1,0]
v_pk_mul_f32 v[178:179], v[178:179], v[8:9] op_sel:[0,0] op_sel_hi:[1,0]
v_cvt_pk_bf16_f32 v160, v160, v161
v_cvt_pk_bf16_f32 v161, v162, v163
v_cvt_pk_bf16_f32 v162, v176, v177
v_cvt_pk_bf16_f32 v163, v178, v179
v_pk_mul_f32 v[164:165], v[164:165], v[8:9] op_sel:[0,1] op_sel_hi:[1,1]
v_pk_mul_f32 v[166:167], v[166:167], v[8:9] op_sel:[0,1] op_sel_hi:[1,1]
v_pk_mul_f32 v[180:181], v[180:181], v[8:9] op_sel:[0,1] op_sel_hi:[1,1]
v_pk_mul_f32 v[182:183], v[182:183], v[8:9] op_sel:[0,1] op_sel_hi:[1,1]
v_cvt_pk_bf16_f32 v164, v164, v165
v_cvt_pk_bf16_f32 v165, v166, v167
v_cvt_pk_bf16_f32 v166, v180, v181
v_cvt_pk_bf16_f32 v167, v182, v183
v_pk_mul_f32 v[168:169], v[168:169], v[10:11] op_sel:[0,0] op_sel_hi:[1,0]
v_pk_mul_f32 v[170:171], v[170:171], v[10:11] op_sel:[0,0] op_sel_hi:[1,0]
v_pk_mul_f32 v[184:185], v[184:185], v[10:11] op_sel:[0,0] op_sel_hi:[1,0]
v_pk_mul_f32 v[186:187], v[186:187], v[10:11] op_sel:[0,0] op_sel_hi:[1,0]
v_cvt_pk_bf16_f32 v168, v168, v169
v_cvt_pk_bf16_f32 v169, v170, v171
v_cvt_pk_bf16_f32 v170, v184, v185
v_cvt_pk_bf16_f32 v171, v186, v187
v_pk_mul_f32 v[172:173], v[172:173], v[10:11] op_sel:[0,1] op_sel_hi:[1,1]
v_pk_mul_f32 v[174:175], v[174:175], v[10:11] op_sel:[0,1] op_sel_hi:[1,1]
v_pk_mul_f32 v[188:189], v[188:189], v[10:11] op_sel:[0,1] op_sel_hi:[1,1]
v_pk_mul_f32 v[190:191], v[190:191], v[10:11] op_sel:[0,1] op_sel_hi:[1,1]
v_cvt_pk_bf16_f32 v172, v172, v173
v_cvt_pk_bf16_f32 v173, v174, v175
v_cvt_pk_bf16_f32 v174, v188, v189
v_cvt_pk_bf16_f32 v175, v190, v191
v_pk_mul_f32 v[192:193], v[192:193], v[8:9] op_sel:[0,0] op_sel_hi:[1,0]
v_pk_mul_f32 v[194:195], v[194:195], v[8:9] op_sel:[0,0] op_sel_hi:[1,0]
v_pk_mul_f32 v[208:209], v[208:209], v[8:9] op_sel:[0,0] op_sel_hi:[1,0]
v_pk_mul_f32 v[210:211], v[210:211], v[8:9] op_sel:[0,0] op_sel_hi:[1,0]
v_cvt_pk_bf16_f32 v192, v192, v193
v_cvt_pk_bf16_f32 v193, v194, v195
v_cvt_pk_bf16_f32 v194, v208, v209
v_cvt_pk_bf16_f32 v195, v210, v211
v_pk_mul_f32 v[196:197], v[196:197], v[8:9] op_sel:[0,1] op_sel_hi:[1,1]
v_pk_mul_f32 v[198:199], v[198:199], v[8:9] op_sel:[0,1] op_sel_hi:[1,1]
v_pk_mul_f32 v[212:213], v[212:213], v[8:9] op_sel:[0,1] op_sel_hi:[1,1]
v_pk_mul_f32 v[214:215], v[214:215], v[8:9] op_sel:[0,1] op_sel_hi:[1,1]
v_cvt_pk_bf16_f32 v196, v196, v197
v_cvt_pk_bf16_f32 v197, v198, v199
v_cvt_pk_bf16_f32 v198, v212, v213
v_cvt_pk_bf16_f32 v199, v214, v215
v_pk_mul_f32 v[200:201], v[200:201], v[10:11] op_sel:[0,0] op_sel_hi:[1,0]
v_pk_mul_f32 v[202:203], v[202:203], v[10:11] op_sel:[0,0] op_sel_hi:[1,0]
v_pk_mul_f32 v[216:217], v[216:217], v[10:11] op_sel:[0,0] op_sel_hi:[1,0]
v_pk_mul_f32 v[218:219], v[218:219], v[10:11] op_sel:[0,0] op_sel_hi:[1,0]
v_cvt_pk_bf16_f32 v200, v200, v201
v_cvt_pk_bf16_f32 v201, v202, v203
v_cvt_pk_bf16_f32 v202, v216, v217
v_cvt_pk_bf16_f32 v203, v218, v219
v_pk_mul_f32 v[204:205], v[204:205], v[10:11] op_sel:[0,1] op_sel_hi:[1,1]
v_pk_mul_f32 v[206:207], v[206:207], v[10:11] op_sel:[0,1] op_sel_hi:[1,1]
v_pk_mul_f32 v[220:221], v[220:221], v[10:11] op_sel:[0,1] op_sel_hi:[1,1]
v_pk_mul_f32 v[222:223], v[222:223], v[10:11] op_sel:[0,1] op_sel_hi:[1,1]
v_cvt_pk_bf16_f32 v204, v204, v205
v_cvt_pk_bf16_f32 v205, v206, v207
v_cvt_pk_bf16_f32 v206, v220, v221
v_cvt_pk_bf16_f32 v207, v222, v223
v_pk_mul_f32 v[224:225], v[224:225], v[8:9] op_sel:[0,0] op_sel_hi:[1,0]
v_pk_mul_f32 v[226:227], v[226:227], v[8:9] op_sel:[0,0] op_sel_hi:[1,0]
v_pk_mul_f32 v[240:241], v[240:241], v[8:9] op_sel:[0,0] op_sel_hi:[1,0]
v_pk_mul_f32 v[242:243], v[242:243], v[8:9] op_sel:[0,0] op_sel_hi:[1,0]
v_cvt_pk_bf16_f32 v224, v224, v225
v_cvt_pk_bf16_f32 v225, v226, v227
v_cvt_pk_bf16_f32 v226, v240, v241
v_cvt_pk_bf16_f32 v227, v242, v243
v_pk_mul_f32 v[228:229], v[228:229], v[8:9] op_sel:[0,1] op_sel_hi:[1,1]
v_pk_mul_f32 v[230:231], v[230:231], v[8:9] op_sel:[0,1] op_sel_hi:[1,1]
v_pk_mul_f32 v[244:245], v[244:245], v[8:9] op_sel:[0,1] op_sel_hi:[1,1]
v_pk_mul_f32 v[246:247], v[246:247], v[8:9] op_sel:[0,1] op_sel_hi:[1,1]
v_cvt_pk_bf16_f32 v228, v228, v229
v_cvt_pk_bf16_f32 v229, v230, v231
v_cvt_pk_bf16_f32 v230, v244, v245
v_cvt_pk_bf16_f32 v231, v246, v247
v_pk_mul_f32 v[232:233], v[232:233], v[10:11] op_sel:[0,0] op_sel_hi:[1,0]
v_pk_mul_f32 v[234:235], v[234:235], v[10:11] op_sel:[0,0] op_sel_hi:[1,0]
v_pk_mul_f32 v[248:249], v[248:249], v[10:11] op_sel:[0,0] op_sel_hi:[1,0]
v_pk_mul_f32 v[250:251], v[250:251], v[10:11] op_sel:[0,0] op_sel_hi:[1,0]
v_cvt_pk_bf16_f32 v232, v232, v233
v_cvt_pk_bf16_f32 v233, v234, v235
v_cvt_pk_bf16_f32 v234, v248, v249
v_cvt_pk_bf16_f32 v235, v250, v251
v_pk_mul_f32 v[236:237], v[236:237], v[10:11] op_sel:[0,1] op_sel_hi:[1,1]
v_pk_mul_f32 v[238:239], v[238:239], v[10:11] op_sel:[0,1] op_sel_hi:[1,1]
v_pk_mul_f32 v[252:253], v[252:253], v[10:11] op_sel:[0,1] op_sel_hi:[1,1]
v_pk_mul_f32 v[254:255], v[254:255], v[10:11] op_sel:[0,1] op_sel_hi:[1,1]
v_cvt_pk_bf16_f32 v236, v236, v237
v_cvt_pk_bf16_f32 v237, v238, v239
v_cvt_pk_bf16_f32 v238, v252, v253
v_cvt_pk_bf16_f32 v239, v254, v255
v_accvgpr_read_b32 v176, a64
v_accvgpr_read_b32 v177, a65
v_accvgpr_read_b32 v178, a66
v_accvgpr_read_b32 v179, a67
v_accvgpr_read_b32 v180, a80
v_accvgpr_read_b32 v181, a81
v_accvgpr_read_b32 v182, a82
v_accvgpr_read_b32 v183, a83
v_pk_mul_f32 v[176:177], v[176:177], v[8:9] op_sel:[0,0] op_sel_hi:[1,0]
v_pk_mul_f32 v[178:179], v[178:179], v[8:9] op_sel:[0,0] op_sel_hi:[1,0]
v_pk_mul_f32 v[180:181], v[180:181], v[8:9] op_sel:[0,0] op_sel_hi:[1,0]
v_pk_mul_f32 v[182:183], v[182:183], v[8:9] op_sel:[0,0] op_sel_hi:[1,0]
v_cvt_pk_bf16_f32 v176, v176, v177
v_cvt_pk_bf16_f32 v177, v178, v179
v_cvt_pk_bf16_f32 v178, v180, v181
v_cvt_pk_bf16_f32 v179, v182, v183
v_accvgpr_read_b32 v184, a68
v_accvgpr_read_b32 v185, a69
v_accvgpr_read_b32 v186, a70
v_accvgpr_read_b32 v187, a71
v_accvgpr_read_b32 v188, a84
v_accvgpr_read_b32 v189, a85
v_accvgpr_read_b32 v190, a86
v_accvgpr_read_b32 v191, a87
v_pk_mul_f32 v[184:185], v[184:185], v[8:9] op_sel:[0,1] op_sel_hi:[1,1]
v_pk_mul_f32 v[186:187], v[186:187], v[8:9] op_sel:[0,1] op_sel_hi:[1,1]
v_pk_mul_f32 v[188:189], v[188:189], v[8:9] op_sel:[0,1] op_sel_hi:[1,1]
v_pk_mul_f32 v[190:191], v[190:191], v[8:9] op_sel:[0,1] op_sel_hi:[1,1]
v_cvt_pk_bf16_f32 v184, v184, v185
v_cvt_pk_bf16_f32 v185, v186, v187
v_cvt_pk_bf16_f32 v186, v188, v189
v_cvt_pk_bf16_f32 v187, v190, v191
v_accvgpr_read_b32 v208, a72
v_accvgpr_read_b32 v209, a73
v_accvgpr_read_b32 v210, a74
v_accvgpr_read_b32 v211, a75
v_accvgpr_read_b32 v212, a88
v_accvgpr_read_b32 v213, a89
v_accvgpr_read_b32 v214, a90
v_accvgpr_read_b32 v215, a91
v_pk_mul_f32 v[208:209], v[208:209], v[10:11] op_sel:[0,0] op_sel_hi:[1,0]
v_pk_mul_f32 v[210:211], v[210:211], v[10:11] op_sel:[0,0] op_sel_hi:[1,0]
v_pk_mul_f32 v[212:213], v[212:213], v[10:11] op_sel:[0,0] op_sel_hi:[1,0]
v_pk_mul_f32 v[214:215], v[214:215], v[10:11] op_sel:[0,0] op_sel_hi:[1,0]
v_cvt_pk_bf16_f32 v208, v208, v209
v_cvt_pk_bf16_f32 v209, v210, v211
v_cvt_pk_bf16_f32 v210, v212, v213
v_cvt_pk_bf16_f32 v211, v214, v215
v_accvgpr_read_b32 v216, a76
v_accvgpr_read_b32 v217, a77
v_accvgpr_read_b32 v218, a78
v_accvgpr_read_b32 v219, a79
v_accvgpr_read_b32 v220, a92
v_accvgpr_read_b32 v221, a93
v_accvgpr_read_b32 v222, a94
v_accvgpr_read_b32 v223, a95
v_pk_mul_f32 v[216:217], v[216:217], v[10:11] op_sel:[0,1] op_sel_hi:[1,1]
v_pk_mul_f32 v[218:219], v[218:219], v[10:11] op_sel:[0,1] op_sel_hi:[1,1]
v_pk_mul_f32 v[220:221], v[220:221], v[10:11] op_sel:[0,1] op_sel_hi:[1,1]
v_pk_mul_f32 v[222:223], v[222:223], v[10:11] op_sel:[0,1] op_sel_hi:[1,1]
v_cvt_pk_bf16_f32 v216, v216, v217
v_cvt_pk_bf16_f32 v217, v218, v219
v_cvt_pk_bf16_f32 v218, v220, v221
v_cvt_pk_bf16_f32 v219, v222, v223
s_bitcmp1_b32 s61, 0
s_cbranch_scc0 Lss_2
buffer_store_dwordx4 v[160:163], v1, s[16:19], s36 offen offset:0 sc1
buffer_store_dwordx4 v[164:167], v1, s[16:19], s36 offen offset:2048 sc1
buffer_store_dwordx4 v[168:171], v1, s[16:19], s37 offen offset:0 sc1
buffer_store_dwordx4 v[172:175], v1, s[16:19], s37 offen offset:2048 sc1
Lss_2:
s_bitcmp1_b32 s61, 1
s_cbranch_scc0 Lss_3
buffer_store_dwordx4 v[192:195], v1, s[16:19], s36 offen offset:1024 sc1
buffer_store_dwordx4 v[196:199], v1, s[16:19], s36 offen offset:3072 sc1
buffer_store_dwordx4 v[200:203], v1, s[16:19], s37 offen offset:1024 sc1
buffer_store_dwordx4 v[204:207], v1, s[16:19], s37 offen offset:3072 sc1
Lss_3:
s_bitcmp1_b32 s61, 2
s_cbranch_scc0 Lss_4
buffer_store_dwordx4 v[224:227], v1, s[16:19], s38 offen offset:0 sc1
buffer_store_dwordx4 v[228:231], v1, s[16:19], s38 offen offset:2048 sc1
buffer_store_dwordx4 v[232:235], v1, s[16:19], s39 offen offset:0 sc1
buffer_store_dwordx4 v[236:239], v1, s[16:19], s39 offen offset:2048 sc1
Lss_4:
s_bitcmp1_b32 s61, 3
s_cbranch_scc0 Lss_5
buffer_store_dwordx4 v[176:179], v1, s[16:19], s38 offen offset:1024 sc1
buffer_store_dwordx4 v[184:187], v1, s[16:19], s38 offen offset:3072 sc1
buffer_store_dwordx4 v[208:211], v1, s[16:19], s39 offen offset:1024 sc1
buffer_store_dwordx4 v[216:219], v1, s[16:19], s39 offen offset:3072 sc1
Lss_5:
s_branch Lk2_chk
Lk2_done:
s_lshl_b32 s33, s20, 4
s_add_u32 s33, s33, 16781312
s_sub_u32 s34, 15, s21
s_lshl_b32 s34, s34, 9
s_add_u32 s92, s33, s34
s_lshl_b32 s34, s22, 2
s_add_u32 s92, s92, s34
s_lshl_b32 s34, s21, 9
s_add_u32 s93, s33, s34
s_lshl_b32 s34, s23, 3
s_add_u32 s93, s93, s34
s_cmp_eq_u32 s24, 0
s_cselect_b32 s93, s93, s92
s_cselect_b32 s94, 4, 0
s_add_u32 s94, s94, s93
s_load_dwordx2 s[10:11], s[0:1], 40
s_load_dwordx2 s[14:15], s[0:1], 72
s_lshl_b32 s21, s27, 7
s_lshl_b32 s22, s28, 6
s_lshl_b32 s3, s101, 4
v_lshrrev_b32 v232, 3, v0
v_and_b32 v233, 6, v232
v_and_b32 v234, 7, v0
v_xor_b32 v233, v233, v234
v_add_u32 v232, s3, v232
v_lshlrev_b32 v232, 11, v232
v_lshl_add_u32 v6, v233, 4, v232
v_add_u32 v7, 15360, v6
s_add_u32 m0, s42, 49152
s_nop 0
buffer_load_dwordx4 v6, s[48:51], s26 offen offset:0 lds
buffer_load_dwordx4 v7, s[48:51], s26 offen offset:1024 lds
buffer_load_dwordx4 a[96:99], v1, s[44:47], s25 offen offset:0 sc1
buffer_load_dwordx4 a[100:103], v1, s[44:47], s25 offen offset:1024 sc1
buffer_load_dwordx4 a[104:107], v1, s[44:47], s25 offen offset:2048 sc1
buffer_load_dwordx4 a[108:111], v1, s[44:47], s25 offen offset:3072 sc1
s_add_u32 s25, s25, 16384
s_add_u32 s26, s26, 131072
s_add_u32 m0, s42, 65536
s_nop 0
buffer_load_dwordx4 v6, s[48:51], s26 offen offset:0 lds
buffer_load_dwordx4 v7, s[48:51], s26 offen offset:1024 lds
buffer_load_dwordx4 a[128:131], v1, s[44:47], s25 offen offset:0 sc1
buffer_load_dwordx4 a[132:135], v1, s[44:47], s25 offen offset:1024 sc1
buffer_load_dwordx4 a[136:139], v1, s[44:47], s25 offen offset:2048 sc1
buffer_load_dwordx4 a[140:143], v1, s[44:47], s25 offen offset:3072 sc1
s_add_u32 s25, s25, 16384
s_add_u32 s26, s26, 131072
v_lshrrev_b32 v232, 2, v0
v_and_b32 v234, 1, v0
v_bfe_u32 v237, v0, 1, 1
v_lshlrev_b32 v233, 7, v232
v_lshl_add_u32 v233, v234, 3, v233
v_and_b32 v236, 6, v232
v_add_u32 v235, 0, v237
v_xor_b32 v235, v235, v236
v_lshl_add_u32 v24, v235, 4, v233
v_add_u32 v28, 0x10000, v24
v_add_u32 v235, 2, v237
v_xor_b32 v235, v235, v236
v_lshl_add_u32 v25, v235, 4, v233
v_add_u32 v29, 0x10000, v25
v_add_u32 v235, 4, v237
v_xor_b32 v235, v235, v236
v_lshl_add_u32 v26, v235, 4, v233
v_add_u32 v30, 0x10000, v26
v_add_u32 v235, 6, v237
v_xor_b32 v235, v235, v236
v_lshl_add_u32 v27, v235, 4, v233
v_add_u32 v31, 0x10000, v27
s_waitcnt vmcnt(26)
s_barrier
ds_read_b64_tr_b16 a[32:33], v24 offset:16384
ds_read_b64_tr_b16 a[34:35], v24 offset:18432
ds_read_b64_tr_b16 a[36:37], v24 offset:20480
ds_read_b64_tr_b16 a[38:39], v24 offset:22528
ds_read_b64_tr_b16 a[40:41], v25 offset:16384
ds_read_b64_tr_b16 a[42:43], v25 offset:18432
ds_read_b64_tr_b16 a[44:45], v25 offset:20480
ds_read_b64_tr_b16 a[46:47], v25 offset:22528
ds_read_b64_tr_b16 a[48:49], v26 offset:16384
ds_read_b64_tr_b16 a[50:51], v26 offset:18432
ds_read_b64_tr_b16 a[52:53], v26 offset:20480
ds_read_b64_tr_b16 a[54:55], v26 offset:22528
ds_read_b64_tr_b16 a[56:57], v27 offset:16384
ds_read_b64_tr_b16 a[58:59], v27 offset:18432
ds_read_b64_tr_b16 a[60:61], v27 offset:20480
ds_read_b64_tr_b16 a[62:63], v27 offset:22528
s_and_b32 s40, s2, 3
s_bfe_u32 s36, s2, 0x30003
s_lshl_b32 s29, s36, 8
s_bfe_u32 s3, s2, 0x10002
s_lshl_b32 s3, s3, 2
s_lshr_b32 s37, s2, 6
s_add_u32 s3, s3, s37
s_lshl_b32 s13, s3, 8
s_lshl_b32 s30, s3, 7
s_lshl_b32 s3, s40, 5
s_add_u32 s30, s30, s3
s_lshl_b32 s41, s101, 12
s_lshl_b32 s12, s36, 21
s_lshr_b32 s3, s101, 1
s_lshl_b32 s3, s3, 20
s_add_u32 s12, s12, s3
s_and_b32 s3, s101, 1
s_lshl_b32 s3, s3, 13
s_add_u32 s12, s12, s3
s_lshl_b32 s62, s36, 10
s_lshl_b32 s3, s40, 7
s_add_u32 s62, s62, s3
s_add_u32 s62, s62, 16781312
s_bfe_u32 s3, s2, 0x10002
s_lshl_b32 s3, s3, 3
s_sub_u32 s39, 16, s3
s_lshl_b32 s38, s40, 4
s_add_u32 s3, s3, s38
s_lshl_b32 s3, s3, 14
s_add_u32 s12, s12, s3
s_lshl_b32 s3, s3, 3
s_add_u32 s13, s13, s3
s_mov_b32 s64, 4294721536
s_mov_b32 s65, 16384
s_add_u32 s8, s4, 67108864
s_addc_u32 s9, s5, 0
s_lshl_b32 s56, s2, 16
s_lshl_b32 s38, s101, 14
s_add_u32 s56, s56, s38
s_lshl_b32 s58, s2, 4
s_lshl_b32 s38, s101, 2
s_add_u32 s58, s58, s38
s_add_u32 s58, s58, 16777216
s_and_b32 s59, s58, 0xffffffcf
s_mov_b32 s61, 0
s_lshl_b32 s3, s101, 4
v_lshrrev_b32 v240, 4, v0
v_and_b32 v242, 15, v0
v_add_u32 v241, 0, v240
v_lshlrev_b32 v241, 1, v241
v_xor_b32 v241, v241, v242
v_add_u32 v243, s3, v240
v_lshlrev_b32 v243, 11, v243
v_lshl_add_u32 v243, v241, 4, v243
v_add_u32 v2, 0, v243
v_add_u32 v241, 4, v240
v_lshlrev_b32 v241, 1, v241
v_xor_b32 v241, v241, v242
v_add_u32 v243, s3, v240
v_lshlrev_b32 v243, 11, v243
v_lshl_add_u32 v243, v241, 4, v243
v_add_u32 v3, 7168, v243
v_add_u32 v241, 0, v240
v_lshlrev_b32 v241, 1, v241
v_xor_b32 v241, v241, v242
v_add_u32 v243, s3, v240
v_lshlrev_b32 v243, 11, v243
v_lshl_add_u32 v243, v241, 4, v243
v_add_u32 v4, 14336, v243
v_add_u32 v241, 4, v240
v_lshlrev_b32 v241, 1, v241
v_xor_b32 v241, v241, v242
v_add_u32 v243, s3, v240
v_lshlrev_b32 v243, 11, v243
v_lshl_add_u32 v243, v241, 4, v243
v_add_u32 v5, 21504, v243
v_lshlrev_b32 v233, 8, v232
v_lshl_add_u32 v233, v234, 3, v233
v_and_b32 v236, 7, v232
v_lshlrev_b32 v236, 1, v236
s_lshl_b32 s38, s40, 2
v_xor_b32 v236, s38, v236
v_add_u32 v235, 0, v237
v_xor_b32 v235, v235, v236
v_lshl_add_u32 v8, v235, 4, v233
v_add_u32 v16, 0x10000, v8
v_add_u32 v235, 2, v237
v_xor_b32 v235, v235, v236
v_lshl_add_u32 v9, v235, 4, v233
v_add_u32 v17, 0x10000, v9
v_add_u32 v235, 4, v237
v_xor_b32 v235, v235, v236
v_lshl_add_u32 v10, v235, 4, v233
v_add_u32 v18, 0x10000, v10
v_add_u32 v235, 6, v237
v_xor_b32 v235, v235, v236
v_lshl_add_u32 v11, v235, 4, v233
v_add_u32 v19, 0x10000, v11
v_add_u32 v235, 8, v237
v_xor_b32 v235, v235, v236
v_lshl_add_u32 v12, v235, 4, v233
v_add_u32 v20, 0x10000, v12
v_add_u32 v235, 10, v237
v_xor_b32 v235, v235, v236
v_lshl_add_u32 v13, v235, 4, v233
v_add_u32 v21, 0x10000, v13
v_add_u32 v235, 12, v237
v_xor_b32 v235, v235, v236
v_lshl_add_u32 v14, v235, 4, v233
v_add_u32 v22, 0x10000, v14
v_add_u32 v235, 14, v237
v_xor_b32 v235, v235, v236
v_lshl_add_u32 v15, v235, 4, v233
v_add_u32 v23, 0x10000, v15
v_mov_b32 v253, 0
v_mov_b32 v254, 1
v_and_b32 v255, 31, v0
v_lshlrev_b32 v255, 2, v255
v_lshrrev_b32 v252, 5, v0
v_lshl_add_u32 v255, v252, 9, v255
s_waitcnt lgkmcnt(0)
s_mov_b32 s16, s14
s_mov_b32 s17, s15
s_mov_b32 s18, 8388608
s_mov_b32 s19, 0x00020000
s_waitcnt vmcnt(20) lgkmcnt(0)
s_barrier
s_waitcnt vmcnt(12)
s_mov_b64 exec, 1
buffer_store_dword v254, v253, s[52:55], s92 offen sc1
buffer_store_dword v254, v253, s[52:55], s93 offen sc1
buffer_store_dword v254, v253, s[52:55], s94 offen sc1
s_mov_b64 exec, -1
M a[0:3], a[32:35], a[192:195], 0
s_add_u32 m0, s42, 81920
s_nop 0
buffer_load_dwordx4 v6, s[48:51], s26 offen offset:0 lds
ds_read_b64_tr_b16 v[160:161], v24 offset:32768
ds_read_b64_tr_b16 v[162:163], v24 offset:34816
M a[0:3], a[36:39], a[196:199], a[0:3]
buffer_load_dwordx4 v7, s[48:51], s26 offen offset:1024 lds
M a[4:7], a[44:47], a[196:199], 0
ds_read_b64_tr_b16 v[164:165], v24 offset:36864
ds_read_b64_tr_b16 v[166:167], v24 offset:38912
M a[4:7], a[40:43], a[192:195], a[4:7]
buffer_load_dwordx4 a[160:163], v1, s[44:47], s25 offen offset:0 sc1
M a[8:11], a[48:51], a[192:195], 0
ds_read_b64_tr_b16 v[168:169], v25 offset:32768
ds_read_b64_tr_b16 v[170:171], v25 offset:34816
M a[8:11], a[52:55], a[196:199], a[8:11]
buffer_load_dwordx4 a[164:167], v1, s[44:47], s25 offen offset:1024 sc1
M a[12:15], a[60:63], a[196:199], 0
ds_read_b64_tr_b16 v[172:173], v25 offset:36864
ds_read_b64_tr_b16 v[174:175], v25 offset:38912
M a[12:15], a[56:59], a[192:195], a[12:15]
buffer_load_dwordx4 a[168:171], v1, s[44:47], s25 offen offset:2048 sc1
M a[16:19], a[32:35], a[200:203], 0
ds_read_b64_tr_b16 v[176:177], v26 offset:32768
ds_read_b64_tr_b16 v[178:179], v26 offset:34816
M a[16:19], a[36:39], a[204:207], a[16:19]
buffer_load_dwordx4 a[172:175], v1, s[44:47], s25 offen offset:3072 sc1
M a[20:23], a[44:47], a[204:207], 0
ds_read_b64_tr_b16 v[180:181], v26 offset:36864
ds_read_b64_tr_b16 v[182:183], v26 offset:38912
M a[20:23], a[40:43], a[200:203], a[20:23]
s_add_u32 s25, s25, 16384
s_add_u32 s26, s26, 131072
M a[24:27], a[48:51], a[200:203], 0
ds_read_b64_tr_b16 v[184:185], v27 offset:32768
ds_read_b64_tr_b16 v[186:187], v27 offset:34816
M a[24:27], a[52:55], a[204:207], a[24:27]
ds_read_b64_tr_b16 v[188:189], v27 offset:36864
ds_read_b64_tr_b16 v[190:191], v27 offset:38912
M a[28:31], a[60:63], a[204:207], 0
M a[28:31], a[56:59], a[200:203], a[28:31]
s_waitcnt vmcnt(15) lgkmcnt(0)
s_barrier
M a[0:3], v[160:163], a[224:227], a[0:3]
s_add_u32 m0, s42, 98304
s_nop 0
buffer_load_dwordx4 v6, s[48:51], s26 offen offset:0 lds
ds_read_b64_tr_b16 a[32:33], v24 offset:49152
ds_read_b64_tr_b16 a[34:35], v24 offset:51200
M a[0:3], v[164:167], a[228:231], a[0:3]
buffer_load_dwordx4 v7, s[48:51], s26 offen offset:1024 lds
M a[4:7], v[172:175], a[228:231], a[4:7]
ds_read_b64_tr_b16 a[36:37], v24 offset:53248
ds_read_b64_tr_b16 a[38:39], v24 offset:55296
M a[4:7], v[168:171], a[224:227], a[4:7]
buffer_load_dwordx4 a[192:195], v1, s[44:47], s25 offen offset:0 sc1
M a[8:11], v[176:179], a[224:227], a[8:11]
ds_read_b64_tr_b16 a[40:41], v25 offset:49152
ds_read_b64_tr_b16 a[42:43], v25 offset:51200
M a[8:11], v[180:183], a[228:231], a[8:11]
buffer_load_dwordx4 a[196:199], v1, s[44:47], s25 offen offset:1024 sc1
M a[12:15], v[188:191], a[228:231], a[12:15]
ds_read_b64_tr_b16 a[44:45], v25 offset:53248
ds_read_b64_tr_b16 a[46:47], v25 offset:55296
M a[12:15], v[184:187], a[224:227], a[12:15]
buffer_load_dwordx4 a[200:203], v1, s[44:47], s25 offen offset:2048 sc1
M a[16:19], v[160:163], a[232:235], a[16:19]
ds_read_b64_tr_b16 a[48:49], v26 offset:49152
ds_read_b64_tr_b16 a[50:51], v26 offset:51200
M a[16:19], v[164:167], a[236:239], a[16:19]
buffer_load_dwordx4 a[204:207], v1, s[44:47], s25 offen offset:3072 sc1
M a[20:23], v[172:175], a[236:239], a[20:23]
ds_read_b64_tr_b16 a[52:53], v26 offset:53248
ds_read_b64_tr_b16 a[54:55], v26 offset:55296
M a[20:23], v[168:171], a[232:235], a[20:23]
s_add_u32 s25, s25, 16384
s_add_u32 s26, s26, 131072
M a[24:27], v[176:179], a[232:235], a[24:27]
ds_read_b64_tr_b16 a[56:57], v27 offset:49152
ds_read_b64_tr_b16 a[58:59], v27 offset:51200
M a[24:27], v[180:183], a[236:239], a[24:27]
ds_read_b64_tr_b16 a[60:61], v27 offset:53248
ds_read_b64_tr_b16 a[62:63], v27 offset:55296
M a[28:31], v[188:191], a[236:239], a[28:31]
M a[28:31], v[184:187], a[232:235], a[28:31]
s_waitcnt vmcnt(15) lgkmcnt(0)
s_barrier
M a[0:3], a[32:35], a[96:99], a[0:3]
s_add_u32 m0, s42, 114688
s_nop 0
buffer_load_dwordx4 v6, s[48:51], s26 offen offset:0 lds
ds_read_b64_tr_b16 v[160:161], v28 offset:0
ds_read_b64_tr_b16 v[162:163], v28 offset:2048
M a[0:3], a[36:39], a[100:103], a[0:3]
buffer_load_dwordx4 v7, s[48:51], s26 offen offset:1024 lds
M a[4:7], a[44:47], a[100:103], a[4:7]
ds_read_b64_tr_b16 v[164:165], v28 offset:4096
ds_read_b64_tr_b16 v[166:167], v28 offset:6144
M a[4:7], a[40:43], a[96:99], a[4:7]
buffer_load_dwordx4 a[224:227], v1, s[44:47], s25 offen offset:0 sc1
M a[8:11], a[48:51], a[96:99], a[8:11]
ds_read_b64_tr_b16 v[168:169], v29 offset:0
ds_read_b64_tr_b16 v[170:171], v29 offset:2048
M a[8:11], a[52:55], a[100:103], a[8:11]
buffer_load_dwordx4 a[228:231], v1, s[44:47], s25 offen offset:1024 sc1
M a[12:15], a[60:63], a[100:103], a[12:15]
ds_read_b64_tr_b16 v[172:173], v29 offset:4096
ds_read_b64_tr_b16 v[174:175], v29 offset:6144
M a[12:15], a[56:59], a[96:99], a[12:15]
buffer_load_dwordx4 a[232:235], v1, s[44:47], s25 offen offset:2048 sc1
ds_read_b64_tr_b16 v[176:177], v30 offset:0
ds_read_b64_tr_b16 v[178:179], v30 offset:2048
M a[16:19], a[32:35], a[104:107], a[16:19]
buffer_load_dwordx4 a[236:239], v1, s[44:47], s25 offen offset:3072 sc1
M a[16:19], a[36:39], a[108:111], a[16:19]
ds_read_b64_tr_b16 v[180:181], v30 offset:4096
ds_read_b64_tr_b16 v[182:183], v30 offset:6144
M a[20:23], a[44:47], a[108:111], a[20:23]
s_add_u32 s25, s25, 16384
s_add_u32 s26, s26, 131072
M a[20:23], a[40:43], a[104:107], a[20:23]
ds_read_b64_tr_b16 v[184:185], v31 offset:0
ds_read_b64_tr_b16 v[186:187], v31 offset:2048
M a[24:27], a[48:51], a[104:107], a[24:27]
buffer_load_dword v252, v255, s[52:55], s62 offen sc1
M a[24:27], a[52:55], a[108:111], a[24:27]
ds_read_b64_tr_b16 v[188:189], v31 offset:4096
ds_read_b64_tr_b16 v[190:191], v31 offset:6144
M a[28:31], a[60:63], a[108:111], a[28:31]
M a[28:31], a[56:59], a[104:107], a[28:31]
s_waitcnt vmcnt(13) lgkmcnt(0)
s_barrier
s_waitcnt vmcnt(0)
v_cmp_ne_u32 vcc, 1, v252
s_nop 0
s_cbranch_vccnz Lk3_spinft
Lk3_gotft:
M a[0:3], v[160:163], a[128:131], a[0:3]
s_mov_b32 s32, s25
s_mov_b32 s33, s26
s_mov_b64 s[34:35], s[44:45]
s_mov_b64 s[36:37], s[48:49]
s_mov_b64 s[44:45], s[8:9]
s_mov_b32 s46, 16777216
s_mov_b64 s[48:49], s[10:11]
s_mov_b32 s50, 8388608
s_mov_b32 s25, s12
s_mov_b32 s26, s13
s_add_u32 m0, s41, 0
s_nop 0
buffer_load_dwordx4 v2, s[48:51], s26 offen offset:0 lds
ds_read_b64_tr_b16 a[32:33], v28 offset:16384
ds_read_b64_tr_b16 a[34:35], v28 offset:18432
M a[0:3], v[164:167], a[132:135], a[0:3]
buffer_load_dwordx4 v3, s[48:51], s26 offen offset:1024 lds
ds_read_b64_tr_b16 a[36:37], v28 offset:20480
ds_read_b64_tr_b16 a[38:39], v28 offset:22528
M a[4:7], v[172:175], a[132:135], a[4:7]
buffer_load_dwordx4 v4, s[48:51], s26 offen offset:2048 lds
M a[4:7], v[168:171], a[128:131], a[4:7]
ds_read_b64_tr_b16 a[40:41], v29 offset:16384
ds_read_b64_tr_b16 a[42:43], v29 offset:18432
buffer_load_dwordx4 v5, s[48:51], s26 offen offset:3072 lds
M a[8:11], v[176:179], a[128:131], a[8:11]
ds_read_b64_tr_b16 a[44:45], v29 offset:20480
ds_read_b64_tr_b16 a[46:47], v29 offset:22528
M a[8:11], v[180:183], a[132:135], a[8:11]
buffer_load_dwordx4 a[96:99], v1, s[44:47], s25 offen offset:0 sc1
ds_read_b64_tr_b16 a[48:49], v30 offset:16384
ds_read_b64_tr_b16 a[50:51], v30 offset:18432
M a[12:15], v[188:191], a[132:135], a[12:15]
buffer_load_dwordx4 a[100:103], v1, s[44:47], s25 offen offset:1024 sc1
M a[12:15], v[184:187], a[128:131], a[12:15]
ds_read_b64_tr_b16 a[52:53], v30 offset:20480
ds_read_b64_tr_b16 a[54:55], v30 offset:22528
buffer_load_dwordx4 a[104:107], v1, s[44:47], s25 offen offset:2048 sc1
M a[16:19], v[160:163], a[136:139], a[16:19]
ds_read_b64_tr_b16 a[56:57], v31 offset:16384
ds_read_b64_tr_b16 a[58:59], v31 offset:18432
buffer_load_dwordx4 a[108:111], v1, s[44:47], s25 offen offset:3072 sc1
M a[16:19], v[164:167], a[140:143], a[16:19]
ds_read_b64_tr_b16 a[60:61], v31 offset:20480
ds_read_b64_tr_b16 a[62:63], v31 offset:22528
M a[20:23], v[172:175], a[140:143], a[20:23]
s_add_u32 s63, s25, 4096
buffer_load_dwordx4 a[112:115], v1, s[44:47], s63 offen offset:0 sc1
buffer_load_dwordx4 a[116:119], v1, s[44:47], s63 offen offset:1024 sc1
M a[20:23], v[168:171], a[136:139], a[20:23]
buffer_load_dwordx4 a[120:123], v1, s[44:47], s63 offen offset:2048 sc1
M a[24:27], v[176:179], a[136:139], a[24:27]
buffer_load_dwordx4 a[124:127], v1, s[44:47], s63 offen offset:3072 sc1
s_sub_u32 s39, s39, 1
s_cmp_eq_u32 s39, 0
s_cselect_b32 s3, s64, s65
M a[24:27], v[180:183], a[140:143], a[24:27]
s_add_u32 s25, s25, s3
s_lshl_b32 s3, s3, 3
s_add_u32 s26, s26, s3
M a[28:31], v[188:191], a[140:143], a[28:31]
M a[28:31], v[184:187], a[136:139], a[28:31]
s_waitcnt vmcnt(19) lgkmcnt(0)
s_barrier
M a[0:3], a[32:35], a[160:163], a[0:3]
s_add_u32 m0, s41, 16384
s_nop 0
buffer_load_dwordx4 v2, s[48:51], s26 offen offset:0 lds
ds_read_b64_tr_b16 v[160:161], v28 offset:32768
ds_read_b64_tr_b16 v[162:163], v28 offset:34816
M a[0:3], a[36:39], a[164:167], a[0:3]
buffer_load_dwordx4 v3, s[48:51], s26 offen offset:1024 lds
ds_read_b64_tr_b16 v[164:165], v28 offset:36864
ds_read_b64_tr_b16 v[166:167], v28 offset:38912
M a[4:7], a[44:47], a[164:167], a[4:7]
buffer_load_dwordx4 v4, s[48:51], s26 offen offset:2048 lds
M a[4:7], a[40:43], a[160:163], a[4:7]
ds_read_b64_tr_b16 v[168:169], v29 offset:32768
ds_read_b64_tr_b16 v[170:171], v29 offset:34816
buffer_load_dwordx4 v5, s[48:51], s26 offen offset:3072 lds
M a[8:11], a[48:51], a[160:163], a[8:11]
ds_read_b64_tr_b16 v[172:173], v29 offset:36864
ds_read_b64_tr_b16 v[174:175], v29 offset:38912
M a[8:11], a[52:55], a[164:167], a[8:11]
buffer_load_dwordx4 a[128:131], v1, s[44:47], s25 offen offset:0 sc1
ds_read_b64_tr_b16 v[176:177], v30 offset:32768
ds_read_b64_tr_b16 v[178:179], v30 offset:34816
M a[12:15], a[60:63], a[164:167], a[12:15]
buffer_load_dwordx4 a[132:135], v1, s[44:47], s25 offen offset:1024 sc1
M a[12:15], a[56:59], a[160:163], a[12:15]
ds_read_b64_tr_b16 v[180:181], v30 offset:36864
ds_read_b64_tr_b16 v[182:183], v30 offset:38912
buffer_load_dwordx4 a[136:139], v1, s[44:47], s25 offen offset:2048 sc1
M a[16:19], a[32:35], a[168:171], a[16:19]
ds_read_b64_tr_b16 v[184:185], v31 offset:32768
ds_read_b64_tr_b16 v[186:187], v31 offset:34816
buffer_load_dwordx4 a[140:143], v1, s[44:47], s25 offen offset:3072 sc1
M a[16:19], a[36:39], a[172:175], a[16:19]
ds_read_b64_tr_b16 v[188:189], v31 offset:36864
ds_read_b64_tr_b16 v[190:191], v31 offset:38912
M a[20:23], a[44:47], a[172:175], a[20:23]
s_add_u32 s63, s25, 4096
buffer_load_dwordx4 a[144:147], v1, s[44:47], s63 offen offset:0 sc1
buffer_load_dwordx4 a[148:151], v1, s[44:47], s63 offen offset:1024 sc1
M a[20:23], a[40:43], a[168:171], a[20:23]
buffer_load_dwordx4 a[152:155], v1, s[44:47], s63 offen offset:2048 sc1
M a[24:27], a[48:51], a[168:171], a[24:27]
buffer_load_dwordx4 a[156:159], v1, s[44:47], s63 offen offset:3072 sc1
s_sub_u32 s39, s39, 1
s_cmp_eq_u32 s39, 0
s_cselect_b32 s3, s64, s65
M a[24:27], a[52:55], a[172:175], a[24:27]
s_add_u32 s25, s25, s3
s_lshl_b32 s3, s3, 3
s_add_u32 s26, s26, s3
M a[28:31], a[60:63], a[172:175], a[28:31]
M a[28:31], a[56:59], a[168:171], a[28:31]
s_waitcnt vmcnt(25) lgkmcnt(0)
s_barrier
M a[0:3], v[160:163], a[192:195], a[0:3]
s_add_u32 m0, s41, 32768
s_nop 0
buffer_load_dwordx4 v2, s[48:51], s26 offen offset:0 lds
ds_read_b64_tr_b16 a[32:33], v28 offset:49152
ds_read_b64_tr_b16 a[34:35], v28 offset:51200
M a[0:3], v[164:167], a[196:199], a[0:3]
buffer_load_dwordx4 v3, s[48:51], s26 offen offset:1024 lds
ds_read_b64_tr_b16 a[36:37], v28 offset:53248
ds_read_b64_tr_b16 a[38:39], v28 offset:55296
M a[4:7], v[172:175], a[196:199], a[4:7]
buffer_load_dwordx4 v4, s[48:51], s26 offen offset:2048 lds
M a[4:7], v[168:171], a[192:195], a[4:7]
ds_read_b64_tr_b16 a[40:41], v29 offset:49152
ds_read_b64_tr_b16 a[42:43], v29 offset:51200
buffer_load_dwordx4 v5, s[48:51], s26 offen offset:3072 lds
M a[8:11], v[176:179], a[192:195], a[8:11]
ds_read_b64_tr_b16 a[44:45], v29 offset:53248
ds_read_b64_tr_b16 a[46:47], v29 offset:55296
M a[8:11], v[180:183], a[196:199], a[8:11]
buffer_load_dwordx4 a[160:163], v1, s[44:47], s25 offen offset:0 sc1
ds_read_b64_tr_b16 a[48:49], v30 offset:49152
ds_read_b64_tr_b16 a[50:51], v30 offset:51200
M a[12:15], v[188:191], a[196:199], a[12:15]
buffer_load_dwordx4 a[164:167], v1, s[44:47], s25 offen offset:1024 sc1
M a[12:15], v[184:187], a[192:195], a[12:15]
ds_read_b64_tr_b16 a[52:53], v30 offset:53248
ds_read_b64_tr_b16 a[54:55], v30 offset:55296
buffer_load_dwordx4 a[168:171], v1, s[44:47], s25 offen offset:2048 sc1
M a[16:19], v[160:163], a[200:203], a[16:19]
ds_read_b64_tr_b16 a[56:57], v31 offset:49152
ds_read_b64_tr_b16 a[58:59], v31 offset:51200
buffer_load_dwordx4 a[172:175], v1, s[44:47], s25 offen offset:3072 sc1
M a[16:19], v[164:167], a[204:207], a[16:19]
ds_read_b64_tr_b16 a[60:61], v31 offset:53248
ds_read_b64_tr_b16 a[62:63], v31 offset:55296
M a[20:23], v[172:175], a[204:207], a[20:23]
s_add_u32 s63, s25, 4096
buffer_load_dwordx4 a[176:179], v1, s[44:47], s63 offen offset:0 sc1
buffer_load_dwordx4 a[180:183], v1, s[44:47], s63 offen offset:1024 sc1
M a[20:23], v[168:171], a[200:203], a[20:23]
buffer_load_dwordx4 a[184:187], v1, s[44:47], s63 offen offset:2048 sc1
M a[24:27], v[176:179], a[200:203], a[24:27]
buffer_load_dwordx4 a[188:191], v1, s[44:47], s63 offen offset:3072 sc1
s_sub_u32 s39, s39, 1
s_cmp_eq_u32 s39, 0
s_cselect_b32 s3, s64, s65
M a[24:27], v[180:183], a[204:207], a[24:27]
s_add_u32 s25, s25, s3
s_lshl_b32 s3, s3, 3
s_add_u32 s26, s26, s3
M a[28:31], v[188:191], a[204:207], a[28:31]
M a[28:31], v[184:187], a[200:203], a[28:31]
s_waitcnt vmcnt(24) lgkmcnt(0)
s_barrier
M a[0:3], a[32:35], a[224:227], a[0:3]
s_add_u32 m0, s41, 49152
s_nop 0
buffer_load_dwordx4 v2, s[48:51], s26 offen offset:0 lds
ds_read_b64_tr_b16 v[160:161], v8 offset:0
ds_read_b64_tr_b16 v[162:163], v8 offset:4096
buffer_load_dwordx4 v3, s[48:51], s26 offen offset:1024 lds
M a[0:3], a[36:39], a[228:231], a[0:3]
ds_read_b64_tr_b16 v[164:165], v8 offset:8192
ds_read_b64_tr_b16 v[166:167], v8 offset:12288
buffer_load_dwordx4 v4, s[48:51], s26 offen offset:2048 lds
M a[4:7], a[44:47], a[228:231], a[4:7]
ds_read_b64_tr_b16 v[168:169], v9 offset:0
ds_read_b64_tr_b16 v[170:171], v9 offset:4096
buffer_load_dwordx4 v5, s[48:51], s26 offen offset:3072 lds
M a[4:7], a[40:43], a[224:227], a[4:7]
ds_read_b64_tr_b16 v[172:173], v9 offset:8192
ds_read_b64_tr_b16 v[174:175], v9 offset:12288
buffer_load_dwordx4 a[192:195], v1, s[44:47], s25 offen offset:0 sc1
M a[8:11], a[48:51], a[224:227], a[8:11]
ds_read_b64_tr_b16 v[176:177], v10 offset:0
ds_read_b64_tr_b16 v[178:179], v10 offset:4096
buffer_load_dwordx4 a[196:199], v1, s[44:47], s25 offen offset:1024 sc1
M a[8:11], a[52:55], a[228:231], a[8:11]
ds_read_b64_tr_b16 v[180:181], v10 offset:8192
ds_read_b64_tr_b16 v[182:183], v10 offset:12288
buffer_load_dwordx4 a[200:203], v1, s[44:47], s25 offen offset:2048 sc1
M a[12:15], a[60:63], a[228:231], a[12:15]
ds_read_b64_tr_b16 v[184:185], v11 offset:0
ds_read_b64_tr_b16 v[186:187], v11 offset:4096
buffer_load_dwordx4 a[204:207], v1, s[44:47], s25 offen offset:3072 sc1
M a[12:15], a[56:59], a[224:227], a[12:15]
ds_read_b64_tr_b16 v[188:189], v11 offset:8192
ds_read_b64_tr_b16 v[190:191], v11 offset:12288
s_add_u32 s63, s25, 4096
buffer_load_dwordx4 a[208:211], v1, s[44:47], s63 offen offset:0 sc1
ds_read_b64_tr_b16 v[192:193], v12 offset:0
ds_read_b64_tr_b16 v[194:195], v12 offset:4096
M a[16:19], a[32:35], a[232:235], a[16:19]
buffer_load_dwordx4 a[212:215], v1, s[44:47], s63 offen offset:1024 sc1
ds_read_b64_tr_b16 v[196:197], v12 offset:8192
ds_read_b64_tr_b16 v[198:199], v12 offset:12288
M a[16:19], a[36:39], a[236:239], a[16:19]
buffer_load_dwordx4 a[216:219], v1, s[44:47], s63 offen offset:2048 sc1
ds_read_b64_tr_b16 v[200:201], v13 offset:0
ds_read_b64_tr_b16 v[202:203], v13 offset:4096
M a[20:23], a[44:47], a[236:239], a[20:23]
buffer_load_dwordx4 a[220:223], v1, s[44:47], s63 offen offset:3072 sc1
ds_read_b64_tr_b16 v[204:205], v13 offset:8192
ds_read_b64_tr_b16 v[206:207], v13 offset:12288
M a[20:23], a[40:43], a[232:235], a[20:23]
s_sub_u32 s39, s39, 1
s_cmp_eq_u32 s39, 0
s_cselect_b32 s3, s64, s65
ds_read_b64_tr_b16 v[208:209], v14 offset:0
ds_read_b64_tr_b16 v[210:211], v14 offset:4096
M a[24:27], a[48:51], a[232:235], a[24:27]
s_add_u32 s25, s25, s3
s_lshl_b32 s3, s3, 3
s_add_u32 s26, s26, s3
ds_read_b64_tr_b16 v[212:213], v14 offset:8192
ds_read_b64_tr_b16 v[214:215], v14 offset:12288
M a[24:27], a[52:55], a[236:239], a[24:27]
ds_read_b64_tr_b16 v[216:217], v15 offset:0
ds_read_b64_tr_b16 v[218:219], v15 offset:4096
ds_read_b64_tr_b16 v[220:221], v15 offset:8192
ds_read_b64_tr_b16 v[222:223], v15 offset:12288
M a[28:31], a[60:63], a[236:239], a[28:31]
M a[28:31], a[56:59], a[232:235], a[28:31]
s_waitcnt vmcnt(24) lgkmcnt(0)
s_barrier
M v[32:35], v[160:163], a[96:99], 0
s_add_u32 m0, s41, 65536
s_nop 0
buffer_load_dwordx4 v2, s[48:51], s26 offen offset:0 lds
M v[32:35], v[164:167], a[100:103], v[32:35]
M v[36:39], v[172:175], a[100:103], 0
ds_read_b64_tr_b16 a[32:33], v8 offset:16384
ds_read_b64_tr_b16 a[34:35], v8 offset:20480
M v[36:39], v[168:171], a[96:99], v[36:39]
M v[40:43], v[176:179], a[96:99], 0
buffer_load_dwordx4 v3, s[48:51], s26 offen offset:1024 lds
M v[40:43], v[180:183], a[100:103], v[40:43]
M v[44:47], v[188:191], a[100:103], 0
ds_read_b64_tr_b16 a[36:37], v8 offset:24576
ds_read_b64_tr_b16 a[38:39], v8 offset:28672
M v[44:47], v[184:187], a[96:99], v[44:47]
M v[48:51], v[192:195], a[96:99], 0
buffer_load_dwordx4 v4, s[48:51], s26 offen offset:2048 lds
M v[48:51], v[196:199], a[100:103], v[48:51]
M v[52:55], v[204:207], a[100:103], 0
ds_read_b64_tr_b16 a[40:41], v9 offset:16384
ds_read_b64_tr_b16 a[42:43], v9 offset:20480
M v[52:55], v[200:203], a[96:99], v[52:55]
M v[56:59], v[208:211], a[96:99], 0
buffer_load_dwordx4 v5, s[48:51], s26 offen offset:3072 lds
M v[56:59], v[212:215], a[100:103], v[56:59]
M v[60:63], v[220:223], a[100:103], 0
ds_read_b64_tr_b16 a[44:45], v9 offset:24576
ds_read_b64_tr_b16 a[46:47], v9 offset:28672
M v[60:63], v[216:219], a[96:99], v[60:63]
M v[64:67], v[160:163], a[104:107], 0
buffer_load_dwordx4 a[224:227], v1, s[44:47], s25 offen offset:0 sc1
M v[64:67], v[164:167], a[108:111], v[64:67]
M v[68:71], v[172:175], a[108:111], 0
ds_read_b64_tr_b16 a[48:49], v10 offset:16384
ds_read_b64_tr_b16 a[50:51], v10 offset:20480
M v[68:71], v[168:171], a[104:107], v[68:71]
M v[72:75], v[176:179], a[104:107], 0
buffer_load_dwordx4 a[228:231], v1, s[44:47], s25 offen offset:1024 sc1
M v[72:75], v[180:183], a[108:111], v[72:75]
M v[76:79], v[188:191], a[108:111], 0
ds_read_b64_tr_b16 a[52:53], v10 offset:24576
ds_read_b64_tr_b16 a[54:55], v10 offset:28672
M v[76:79], v[184:187], a[104:107], v[76:79]
M v[80:83], v[192:195], a[104:107], 0
buffer_load_dwordx4 a[232:235], v1, s[44:47], s25 offen offset:2048 sc1
M v[80:83], v[196:199], a[108:111], v[80:83]
M v[84:87], v[204:207], a[108:111], 0
ds_read_b64_tr_b16 a[56:57], v11 offset:16384
ds_read_b64_tr_b16 a[58:59], v11 offset:20480
M v[84:87], v[200:203], a[104:107], v[84:87]
M v[88:91], v[208:211], a[104:107], 0
buffer_load_dwordx4 a[236:239], v1, s[44:47], s25 offen offset:3072 sc1
M v[88:91], v[212:215], a[108:111], v[88:91]
M v[92:95], v[220:223], a[108:111], 0
M v[92:95], v[216:219], a[104:107], v[92:95]
ds_read_b64_tr_b16 a[60:61], v11 offset:24576
ds_read_b64_tr_b16 a[62:63], v11 offset:28672
M v[96:99], v[160:163], a[112:115], 0
M v[96:99], v[164:167], a[116:119], v[96:99]
s_add_u32 s63, s25, 4096
buffer_load_dwordx4 a[240:243], v1, s[44:47], s63 offen offset:0 sc1
M v[100:103], v[172:175], a[116:119], 0
M v[100:103], v[168:171], a[112:115], v[100:103]
ds_read_b64_tr_b16 a[64:65], v12 offset:16384
ds_read_b64_tr_b16 a[66:67], v12 offset:20480
M v[104:107], v[176:179], a[112:115], 0
M v[104:107], v[180:183], a[116:119], v[104:107]
buffer_load_dwordx4 a[244:247], v1, s[44:47], s63 offen offset:1024 sc1
M v[108:111], v[188:191], a[116:119], 0
M v[108:111], v[184:187], a[112:115], v[108:111]
ds_read_b64_tr_b16 a[68:69], v12 offset:24576
ds_read_b64_tr_b16 a[70:71], v12 offset:28672
M v[112:115], v[192:195], a[112:115], 0
M v[112:115], v[196:199], a[116:119], v[112:115]
buffer_load_dwordx4 a[248:251], v1, s[44:47], s63 offen offset:2048 sc1
M v[116:119], v[204:207], a[116:119], 0
M v[116:119], v[200:203], a[112:115], v[116:119]
ds_read_b64_tr_b16 a[72:73], v13 offset:16384
ds_read_b64_tr_b16 a[74:75], v13 offset:20480
M v[120:123], v[208:211], a[112:115], 0
M v[120:123], v[212:215], a[116:119], v[120:123]
buffer_load_dwordx4 a[252:255], v1, s[44:47], s63 offen offset:3072 sc1
M v[124:127], v[220:223], a[116:119], 0
M v[124:127], v[216:219], a[112:115], v[124:127]
ds_read_b64_tr_b16 a[76:77], v13 offset:24576
ds_read_b64_tr_b16 a[78:79], v13 offset:28672
M v[128:131], v[160:163], a[120:123], 0
M v[128:131], v[164:167], a[124:127], v[128:131]
s_sub_u32 s39, s39, 1
s_cmp_eq_u32 s39, 0
s_cselect_b32 s3, s64, s65
M v[132:135], v[172:175], a[124:127], 0
M v[132:135], v[168:171], a[120:123], v[132:135]
ds_read_b64_tr_b16 a[80:81], v14 offset:16384
ds_read_b64_tr_b16 a[82:83], v14 offset:20480
M v[136:139], v[176:179], a[120:123], 0
M v[136:139], v[180:183], a[124:127], v[136:139]
s_add_u32 s25, s25, s3
s_lshl_b32 s3, s3, 3
s_add_u32 s26, s26, s3
M v[140:143], v[188:191], a[124:127], 0
M v[140:143], v[184:187], a[120:123], v[140:143]
ds_read_b64_tr_b16 a[84:85], v14 offset:24576
ds_read_b64_tr_b16 a[86:87], v14 offset:28672
M v[144:147], v[192:195], a[120:123], 0
M v[144:147], v[196:199], a[124:127], v[144:147]
ds_read_b64_tr_b16 a[88:89], v15 offset:16384
ds_read_b64_tr_b16 a[90:91], v15 offset:20480
M v[148:151], v[204:207], a[124:127], 0
M v[148:151], v[200:203], a[120:123], v[148:151]
ds_read_b64_tr_b16 a[92:93], v15 offset:24576
ds_read_b64_tr_b16 a[94:95], v15 offset:28672
M v[152:155], v[208:211], a[120:123], 0
M v[152:155], v[212:215], a[124:127], v[152:155]
M v[156:159], v[220:223], a[124:127], 0
M v[156:159], v[216:219], a[120:123], v[156:159]
s_waitcnt vmcnt(24) lgkmcnt(0)
s_barrier
M v[32:35], a[32:35], a[128:131], v[32:35]
s_add_u32 m0, s41, 81920
s_nop 0
buffer_load_dwordx4 v2, s[48:51], s26 offen offset:0 lds
M v[32:35], a[36:39], a[132:135], v[32:35]
M v[36:39], a[44:47], a[132:135], v[36:39]
ds_read_b64_tr_b16 v[160:161], v8 offset:32768
ds_read_b64_tr_b16 v[162:163], v8 offset:36864
M v[36:39], a[40:43], a[128:131], v[36:39]
M v[40:43], a[48:51], a[128:131], v[40:43]
buffer_load_dwordx4 v3, s[48:51], s26 offen offset:1024 lds
M v[40:43], a[52:55], a[132:135], v[40:43]
M v[44:47], a[60:63], a[132:135], v[44:47]
ds_read_b64_tr_b16 v[164:165], v8 offset:40960
ds_read_b64_tr_b16 v[166:167], v8 offset:45056
M v[44:47], a[56:59], a[128:131], v[44:47]
M v[48:51], a[64:67], a[128:131], v[48:51]
buffer_load_dwordx4 v4, s[48:51], s26 offen offset:2048 lds
M v[48:51], a[68:71], a[132:135], v[48:51]
M v[52:55], a[76:79], a[132:135], v[52:55]
ds_read_b64_tr_b16 v[168:169], v9 offset:32768
ds_read_b64_tr_b16 v[170:171], v9 offset:36864
M v[52:55], a[72:75], a[128:131], v[52:55]
M v[56:59], a[80:83], a[128:131], v[56:59]
buffer_load_dwordx4 v5, s[48:51], s26 offen offset:3072 lds
M v[56:59], a[84:87], a[132:135], v[56:59]
M v[60:63], a[92:95], a[132:135], v[60:63]
ds_read_b64_tr_b16 v[172:173], v9 offset:40960
ds_read_b64_tr_b16 v[174:175], v9 offset:45056
M v[60:63], a[88:91], a[128:131], v[60:63]
M v[64:67], a[32:35], a[136:139], v[64:67]
buffer_load_dwordx4 a[96:99], v1, s[44:47], s25 offen offset:0 sc1
M v[64:67], a[36:39], a[140:143], v[64:67]
M v[68:71], a[44:47], a[140:143], v[68:71]
ds_read_b64_tr_b16 v[176:177], v10 offset:32768
ds_read_b64_tr_b16 v[178:179], v10 offset:36864
M v[68:71], a[40:43], a[136:139], v[68:71]
M v[72:75], a[48:51], a[136:139], v[72:75]
buffer_load_dwordx4 a[100:103], v1, s[44:47], s25 offen offset:1024 sc1
M v[72:75], a[52:55], a[140:143], v[72:75]
M v[76:79], a[60:63], a[140:143], v[76:79]
ds_read_b64_tr_b16 v[180:181], v10 offset:40960
ds_read_b64_tr_b16 v[182:183], v10 offset:45056
M v[76:79], a[56:59], a[136:139], v[76:79]
M v[80:83], a[64:67], a[136:139], v[80:83]
buffer_load_dwordx4 a[104:107], v1, s[44:47], s25 offen offset:2048 sc1
M v[80:83], a[68:71], a[140:143], v[80:83]
M v[84:87], a[76:79], a[140:143], v[84:87]
ds_read_b64_tr_b16 v[184:185], v11 offset:32768
ds_read_b64_tr_b16 v[186:187], v11 offset:36864
M v[84:87], a[72:75], a[136:139], v[84:87]
M v[88:91], a[80:83], a[136:139], v[88:91]
buffer_load_dwordx4 a[108:111], v1, s[44:47], s25 offen offset:3072 sc1
M v[88:91], a[84:87], a[140:143], v[88:91]
M v[92:95], a[92:95], a[140:143], v[92:95]
M v[92:95], a[88:91], a[136:139], v[92:95]
ds_read_b64_tr_b16 v[188:189], v11 offset:40960
ds_read_b64_tr_b16 v[190:191], v11 offset:45056
M v[96:99], a[32:35], a[144:147], v[96:99]
M v[96:99], a[36:39], a[148:151], v[96:99]
s_add_u32 s63, s25, 4096
buffer_load_dwordx4 a[112:115], v1, s[44:47], s63 offen offset:0 sc1
M v[100:103], a[44:47], a[148:151], v[100:103]
M v[100:103], a[40:43], a[144:147], v[100:103]
ds_read_b64_tr_b16 v[192:193], v12 offset:32768
ds_read_b64_tr_b16 v[194:195], v12 offset:36864
M v[104:107], a[48:51], a[144:147], v[104:107]
M v[104:107], a[52:55], a[148:151], v[104:107]
buffer_load_dwordx4 a[116:119], v1, s[44:47], s63 offen offset:1024 sc1
M v[108:111], a[60:63], a[148:151], v[108:111]
M v[108:111], a[56:59], a[144:147], v[108:111]
ds_read_b64_tr_b16 v[196:197], v12 offset:40960
ds_read_b64_tr_b16 v[198:199], v12 offset:45056
M v[112:115], a[64:67], a[144:147], v[112:115]
M v[112:115], a[68:71], a[148:151], v[112:115]
buffer_load_dwordx4 a[120:123], v1, s[44:47], s63 offen offset:2048 sc1
M v[116:119], a[76:79], a[148:151], v[116:119]
M v[116:119], a[72:75], a[144:147], v[116:119]
ds_read_b64_tr_b16 v[200:201], v13 offset:32768
ds_read_b64_tr_b16 v[202:203], v13 offset:36864
M v[120:123], a[80:83], a[144:147], v[120:123]
M v[120:123], a[84:87], a[148:151], v[120:123]
buffer_load_dwordx4 a[124:127], v1, s[44:47], s63 offen offset:3072 sc1
M v[124:127], a[92:95], a[148:151], v[124:127]
M v[124:127], a[88:91], a[144:147], v[124:127]
ds_read_b64_tr_b16 v[204:205], v13 offset:40960
ds_read_b64_tr_b16 v[206:207], v13 offset:45056
M v[128:131], a[32:35], a[152:155], v[128:131]
M v[128:131], a[36:39], a[156:159], v[128:131]
s_sub_u32 s39, s39, 1
s_cmp_eq_u32 s39, 0
s_cselect_b32 s3, s64, s65
M v[132:135], a[44:47], a[156:159], v[132:135]
M v[132:135], a[40:43], a[152:155], v[132:135]
ds_read_b64_tr_b16 v[208:209], v14 offset:32768
ds_read_b64_tr_b16 v[210:211], v14 offset:36864
M v[136:139], a[48:51], a[152:155], v[136:139]
M v[136:139], a[52:55], a[156:159], v[136:139]
s_add_u32 s25, s25, s3
s_lshl_b32 s3, s3, 3
s_add_u32 s26, s26, s3
M v[140:143], a[60:63], a[156:159], v[140:143]
M v[140:143], a[56:59], a[152:155], v[140:143]
ds_read_b64_tr_b16 v[212:213], v14 offset:40960
ds_read_b64_tr_b16 v[214:215], v14 offset:45056
M v[144:147], a[64:67], a[152:155], v[144:147]
M v[144:147], a[68:71], a[156:159], v[144:147]
ds_read_b64_tr_b16 v[216:217], v15 offset:32768
ds_read_b64_tr_b16 v[218:219], v15 offset:36864
M v[148:151], a[76:79], a[156:159], v[148:151]
M v[148:151], a[72:75], a[152:155], v[148:151]
ds_read_b64_tr_b16 v[220:221], v15 offset:40960
ds_read_b64_tr_b16 v[222:223], v15 offset:45056
M v[152:155], a[80:83], a[152:155], v[152:155]
M v[152:155], a[84:87], a[156:159], v[152:155]
M v[156:159], a[92:95], a[156:159], v[156:159]
M v[156:159], a[88:91], a[152:155], v[156:159]
s_waitcnt vmcnt(24) lgkmcnt(0)
s_barrier
M v[32:35], v[160:163], a[160:163], v[32:35]
s_add_u32 m0, s41, 98304
s_nop 0
buffer_load_dwordx4 v2, s[48:51], s26 offen offset:0 lds
M v[32:35], v[164:167], a[164:167], v[32:35]
M v[36:39], v[172:175], a[164:167], v[36:39]
ds_read_b64_tr_b16 a[32:33], v8 offset:49152
ds_read_b64_tr_b16 a[34:35], v8 offset:53248
M v[36:39], v[168:171], a[160:163], v[36:39]
M v[40:43], v[176:179], a[160:163], v[40:43]
buffer_load_dwordx4 v3, s[48:51], s26 offen offset:1024 lds
M v[40:43], v[180:183], a[164:167], v[40:43]
M v[44:47], v[188:191], a[164:167], v[44:47]
ds_read_b64_tr_b16 a[36:37], v8 offset:57344
ds_read_b64_tr_b16 a[38:39], v8 offset:61440
M v[44:47], v[184:187], a[160:163], v[44:47]
M v[48:51], v[192:195], a[160:163], v[48:51]
buffer_load_dwordx4 v4, s[48:51], s26 offen offset:2048 lds
M v[48:51], v[196:199], a[164:167], v[48:51]
M v[52:55], v[204:207], a[164:167], v[52:55]
ds_read_b64_tr_b16 a[40:41], v9 offset:49152
ds_read_b64_tr_b16 a[42:43], v9 offset:53248
M v[52:55], v[200:203], a[160:163], v[52:55]
M v[56:59], v[208:211], a[160:163], v[56:59]
buffer_load_dwordx4 v5, s[48:51], s26 offen offset:3072 lds
M v[56:59], v[212:215], a[164:167], v[56:59]
M v[60:63], v[220:223], a[164:167], v[60:63]
ds_read_b64_tr_b16 a[44:45], v9 offset:57344
ds_read_b64_tr_b16 a[46:47], v9 offset:61440
M v[60:63], v[216:219], a[160:163], v[60:63]
M v[64:67], v[160:163], a[168:171], v[64:67]
buffer_load_dwordx4 a[128:131], v1, s[44:47], s25 offen offset:0 sc1
M v[64:67], v[164:167], a[172:175], v[64:67]
M v[68:71], v[172:175], a[172:175], v[68:71]
ds_read_b64_tr_b16 a[48:49], v10 offset:49152
ds_read_b64_tr_b16 a[50:51], v10 offset:53248
M v[68:71], v[168:171], a[168:171], v[68:71]
M v[72:75], v[176:179], a[168:171], v[72:75]
buffer_load_dwordx4 a[132:135], v1, s[44:47], s25 offen offset:1024 sc1
M v[72:75], v[180:183], a[172:175], v[72:75]
M v[76:79], v[188:191], a[172:175], v[76:79]
ds_read_b64_tr_b16 a[52:53], v10 offset:57344
ds_read_b64_tr_b16 a[54:55], v10 offset:61440
M v[76:79], v[184:187], a[168:171], v[76:79]
M v[80:83], v[192:195], a[168:171], v[80:83]
buffer_load_dwordx4 a[136:139], v1, s[44:47], s25 offen offset:2048 sc1
M v[80:83], v[196:199], a[172:175], v[80:83]
M v[84:87], v[204:207], a[172:175], v[84:87]
ds_read_b64_tr_b16 a[56:57], v11 offset:49152
ds_read_b64_tr_b16 a[58:59], v11 offset:53248
M v[84:87], v[200:203], a[168:171], v[84:87]
M v[88:91], v[208:211], a[168:171], v[88:91]
buffer_load_dwordx4 a[140:143], v1, s[44:47], s25 offen offset:3072 sc1
M v[88:91], v[212:215], a[172:175], v[88:91]
M v[92:95], v[220:223], a[172:175], v[92:95]
M v[92:95], v[216:219], a[168:171], v[92:95]
ds_read_b64_tr_b16 a[60:61], v11 offset:57344
ds_read_b64_tr_b16 a[62:63], v11 offset:61440
M v[96:99], v[160:163], a[176:179], v[96:99]
M v[96:99], v[164:167], a[180:183], v[96:99]
s_add_u32 s63, s25, 4096
buffer_load_dwordx4 a[144:147], v1, s[44:47], s63 offen offset:0 sc1
M v[100:103], v[172:175], a[180:183], v[100:103]
M v[100:103], v[168:171], a[176:179], v[100:103]
ds_read_b64_tr_b16 a[64:65], v12 offset:49152
ds_read_b64_tr_b16 a[66:67], v12 offset:53248
M v[104:107], v[176:179], a[176:179], v[104:107]
M v[104:107], v[180:183], a[180:183], v[104:107]
buffer_load_dwordx4 a[148:151], v1, s[44:47], s63 offen offset:1024 sc1
M v[108:111], v[188:191], a[180:183], v[108:111]
M v[108:111], v[184:187], a[176:179], v[108:111]
ds_read_b64_tr_b16 a[68:69], v12 offset:57344
ds_read_b64_tr_b16 a[70:71], v12 offset:61440
M v[112:115], v[192:195], a[176:179], v[112:115]
M v[112:115], v[196:199], a[180:183], v[112:115]
buffer_load_dwordx4 a[152:155], v1, s[44:47], s63 offen offset:2048 sc1
M v[116:119], v[204:207], a[180:183], v[116:119]
M v[116:119], v[200:203], a[176:179], v[116:119]
ds_read_b64_tr_b16 a[72:73], v13 offset:49152
ds_read_b64_tr_b16 a[74:75], v13 offset:53248
M v[120:123], v[208:211], a[176:179], v[120:123]
M v[120:123], v[212:215], a[180:183], v[120:123]
buffer_load_dwordx4 a[156:159], v1, s[44:47], s63 offen offset:3072 sc1
M v[124:127], v[220:223], a[180:183], v[124:127]
M v[124:127], v[216:219], a[176:179], v[124:127]
ds_read_b64_tr_b16 a[76:77], v13 offset:57344
ds_read_b64_tr_b16 a[78:79], v13 offset:61440
M v[128:131], v[160:163], a[184:187], v[128:131]
M v[128:131], v[164:167], a[188:191], v[128:131]
s_sub_u32 s39, s39, 1
s_cmp_eq_u32 s39, 0
s_cselect_b32 s3, s64, s65
M v[132:135], v[172:175], a[188:191], v[132:135]
M v[132:135], v[168:171], a[184:187], v[132:135]
ds_read_b64_tr_b16 a[80:81], v14 offset:49152
ds_read_b64_tr_b16 a[82:83], v14 offset:53248
M v[136:139], v[176:179], a[184:187], v[136:139]
M v[136:139], v[180:183], a[188:191], v[136:139]
s_add_u32 s25, s25, s3
s_lshl_b32 s3, s3, 3
s_add_u32 s26, s26, s3
M v[140:143], v[188:191], a[188:191], v[140:143]
M v[140:143], v[184:187], a[184:187], v[140:143]
ds_read_b64_tr_b16 a[84:85], v14 offset:57344
ds_read_b64_tr_b16 a[86:87], v14 offset:61440
M v[144:147], v[192:195], a[184:187], v[144:147]
M v[144:147], v[196:199], a[188:191], v[144:147]
ds_read_b64_tr_b16 a[88:89], v15 offset:49152
ds_read_b64_tr_b16 a[90:91], v15 offset:53248
M v[148:151], v[204:207], a[188:191], v[148:151]
M v[148:151], v[200:203], a[184:187], v[148:151]
ds_read_b64_tr_b16 a[92:93], v15 offset:57344
ds_read_b64_tr_b16 a[94:95], v15 offset:61440
M v[152:155], v[208:211], a[184:187], v[152:155]
M v[152:155], v[212:215], a[188:191], v[152:155]
M v[156:159], v[220:223], a[188:191], v[156:159]
M v[156:159], v[216:219], a[184:187], v[156:159]
s_waitcnt vmcnt(24) lgkmcnt(0)
s_barrier
M v[32:35], a[32:35], a[192:195], v[32:35]
s_add_u32 m0, s41, 114688
s_nop 0
buffer_load_dwordx4 v2, s[48:51], s26 offen offset:0 lds
M v[32:35], a[36:39], a[196:199], v[32:35]
M v[36:39], a[44:47], a[196:199], v[36:39]
ds_read_b64_tr_b16 v[160:161], v16 offset:0
ds_read_b64_tr_b16 v[162:163], v16 offset:4096
M v[36:39], a[40:43], a[192:195], v[36:39]
M v[40:43], a[48:51], a[192:195], v[40:43]
buffer_load_dwordx4 v3, s[48:51], s26 offen offset:1024 lds
M v[40:43], a[52:55], a[196:199], v[40:43]
M v[44:47], a[60:63], a[196:199], v[44:47]
ds_read_b64_tr_b16 v[164:165], v16 offset:8192
ds_read_b64_tr_b16 v[166:167], v16 offset:12288
M v[44:47], a[56:59], a[192:195], v[44:47]
M v[48:51], a[64:67], a[192:195], v[48:51]
buffer_load_dwordx4 v4, s[48:51], s26 offen offset:2048 lds
M v[48:51], a[68:71], a[196:199], v[48:51]
M v[52:55], a[76:79], a[196:199], v[52:55]
ds_read_b64_tr_b16 v[168:169], v17 offset:0
ds_read_b64_tr_b16 v[170:171], v17 offset:4096
M v[52:55], a[72:75], a[192:195], v[52:55]
M v[56:59], a[80:83], a[192:195], v[56:59]
buffer_load_dwordx4 v5, s[48:51], s26 offen offset:3072 lds
M v[56:59], a[84:87], a[196:199], v[56:59]
M v[60:63], a[92:95], a[196:199], v[60:63]
ds_read_b64_tr_b16 v[172:173], v17 offset:8192
ds_read_b64_tr_b16 v[174:175], v17 offset:12288
M v[60:63], a[88:91], a[192:195], v[60:63]
M v[64:67], a[32:35], a[200:203], v[64:67]
buffer_load_dwordx4 a[160:163], v1, s[44:47], s25 offen offset:0 sc1
M v[64:67], a[36:39], a[204:207], v[64:67]
M v[68:71], a[44:47], a[204:207], v[68:71]
ds_read_b64_tr_b16 v[176:177], v18 offset:0
ds_read_b64_tr_b16 v[178:179], v18 offset:4096
M v[68:71], a[40:43], a[200:203], v[68:71]
M v[72:75], a[48:51], a[200:203], v[72:75]
buffer_load_dwordx4 a[164:167], v1, s[44:47], s25 offen offset:1024 sc1
M v[72:75], a[52:55], a[204:207], v[72:75]
M v[76:79], a[60:63], a[204:207], v[76:79]
ds_read_b64_tr_b16 v[180:181], v18 offset:8192
ds_read_b64_tr_b16 v[182:183], v18 offset:12288
M v[76:79], a[56:59], a[200:203], v[76:79]
M v[80:83], a[64:67], a[200:203], v[80:83]
buffer_load_dwordx4 a[168:171], v1, s[44:47], s25 offen offset:2048 sc1
M v[80:83], a[68:71], a[204:207], v[80:83]
M v[84:87], a[76:79], a[204:207], v[84:87]
ds_read_b64_tr_b16 v[184:185], v19 offset:0
ds_read_b64_tr_b16 v[186:187], v19 offset:4096
M v[84:87], a[72:75], a[200:203], v[84:87]
M v[88:91], a[80:83], a[200:203], v[88:91]
buffer_load_dwordx4 a[172:175], v1, s[44:47], s25 offen offset:3072 sc1
M v[88:91], a[84:87], a[204:207], v[88:91]
M v[92:95], a[92:95], a[204:207], v[92:95]
M v[92:95], a[88:91], a[200:203], v[92:95]
ds_read_b64_tr_b16 v[188:189], v19 offset:8192
ds_read_b64_tr_b16 v[190:191], v19 offset:12288
M v[96:99], a[32:35], a[208:211], v[96:99]
M v[96:99], a[36:39], a[212:215], v[96:99]
s_add_u32 s63, s25, 4096
buffer_load_dwordx4 a[176:179], v1, s[44:47], s63 offen offset:0 sc1
M v[100:103], a[44:47], a[212:215], v[100:103]
M v[100:103], a[40:43], a[208:211], v[100:103]
ds_read_b64_tr_b16 v[192:193], v20 offset:0
ds_read_b64_tr_b16 v[194:195], v20 offset:4096
M v[104:107], a[48:51], a[208:211], v[104:107]
M v[104:107], a[52:55], a[212:215], v[104:107]
buffer_load_dwordx4 a[180:183], v1, s[44:47], s63 offen offset:1024 sc1
M v[108:111], a[60:63], a[212:215], v[108:111]
M v[108:111], a[56:59], a[208:211], v[108:111]
ds_read_b64_tr_b16 v[196:197], v20 offset:8192
ds_read_b64_tr_b16 v[198:199], v20 offset:12288
M v[112:115], a[64:67], a[208:211], v[112:115]
M v[112:115], a[68:71], a[212:215], v[112:115]
buffer_load_dwordx4 a[184:187], v1, s[44:47], s63 offen offset:2048 sc1
M v[116:119], a[76:79], a[212:215], v[116:119]
M v[116:119], a[72:75], a[208:211], v[116:119]
ds_read_b64_tr_b16 v[200:201], v21 offset:0
ds_read_b64_tr_b16 v[202:203], v21 offset:4096
M v[120:123], a[80:83], a[208:211], v[120:123]
M v[120:123], a[84:87], a[212:215], v[120:123]
buffer_load_dwordx4 a[188:191], v1, s[44:47], s63 offen offset:3072 sc1
M v[124:127], a[92:95], a[212:215], v[124:127]
M v[124:127], a[88:91], a[208:211], v[124:127]
ds_read_b64_tr_b16 v[204:205], v21 offset:8192
ds_read_b64_tr_b16 v[206:207], v21 offset:12288
M v[128:131], a[32:35], a[216:219], v[128:131]
M v[128:131], a[36:39], a[220:223], v[128:131]
s_sub_u32 s39, s39, 1
s_cmp_eq_u32 s39, 0
s_cselect_b32 s3, s64, s65
M v[132:135], a[44:47], a[220:223], v[132:135]
M v[132:135], a[40:43], a[216:219], v[132:135]
ds_read_b64_tr_b16 v[208:209], v22 offset:0
ds_read_b64_tr_b16 v[210:211], v22 offset:4096
M v[136:139], a[48:51], a[216:219], v[136:139]
M v[136:139], a[52:55], a[220:223], v[136:139]
s_add_u32 s25, s25, s3
s_lshl_b32 s3, s3, 3
s_add_u32 s26, s26, s3
M v[140:143], a[60:63], a[220:223], v[140:143]
M v[140:143], a[56:59], a[216:219], v[140:143]
ds_read_b64_tr_b16 v[212:213], v22 offset:8192
ds_read_b64_tr_b16 v[214:215], v22 offset:12288
M v[144:147], a[64:67], a[216:219], v[144:147]
M v[144:147], a[68:71], a[220:223], v[144:147]
ds_read_b64_tr_b16 v[216:217], v23 offset:0
ds_read_b64_tr_b16 v[218:219], v23 offset:4096
M v[148:151], a[76:79], a[220:223], v[148:151]
M v[148:151], a[72:75], a[216:219], v[148:151]
ds_read_b64_tr_b16 v[220:221], v23 offset:8192
ds_read_b64_tr_b16 v[222:223], v23 offset:12288
M v[152:155], a[80:83], a[216:219], v[152:155]
M v[152:155], a[84:87], a[220:223], v[152:155]
M v[156:159], a[92:95], a[220:223], v[156:159]
M v[156:159], a[88:91], a[216:219], v[156:159]
s_waitcnt vmcnt(24) lgkmcnt(0)
s_barrier
M v[32:35], v[160:163], a[224:227], v[32:35]
s_add_u32 m0, s41, 0
s_nop 0
buffer_load_dwordx4 v2, s[48:51], s26 offen offset:0 lds
M v[32:35], v[164:167], a[228:231], v[32:35]
M v[36:39], v[172:175], a[228:231], v[36:39]
ds_read_b64_tr_b16 a[32:33], v16 offset:16384
ds_read_b64_tr_b16 a[34:35], v16 offset:20480
M v[36:39], v[168:171], a[224:227], v[36:39]
M v[40:43], v[176:179], a[224:227], v[40:43]
buffer_load_dwordx4 v3, s[48:51], s26 offen offset:1024 lds
M v[40:43], v[180:183], a[228:231], v[40:43]
M v[44:47], v[188:191], a[228:231], v[44:47]
ds_read_b64_tr_b16 a[36:37], v16 offset:24576
ds_read_b64_tr_b16 a[38:39], v16 offset:28672
M v[44:47], v[184:187], a[224:227], v[44:47]
M v[48:51], v[192:195], a[224:227], v[48:51]
buffer_load_dwordx4 v4, s[48:51], s26 offen offset:2048 lds
M v[48:51], v[196:199], a[228:231], v[48:51]
M v[52:55], v[204:207], a[228:231], v[52:55]
ds_read_b64_tr_b16 a[40:41], v17 offset:16384
ds_read_b64_tr_b16 a[42:43], v17 offset:20480
M v[52:55], v[200:203], a[224:227], v[52:55]
M v[56:59], v[208:211], a[224:227], v[56:59]
buffer_load_dwordx4 v5, s[48:51], s26 offen offset:3072 lds
M v[56:59], v[212:215], a[228:231], v[56:59]
M v[60:63], v[220:223], a[228:231], v[60:63]
ds_read_b64_tr_b16 a[44:45], v17 offset:24576
ds_read_b64_tr_b16 a[46:47], v17 offset:28672
M v[60:63], v[216:219], a[224:227], v[60:63]
M v[64:67], v[160:163], a[232:235], v[64:67]
buffer_load_dwordx4 a[192:195], v1, s[44:47], s25 offen offset:0 sc1
M v[64:67], v[164:167], a[236:239], v[64:67]
M v[68:71], v[172:175], a[236:239], v[68:71]
ds_read_b64_tr_b16 a[48:49], v18 offset:16384
ds_read_b64_tr_b16 a[50:51], v18 offset:20480
M v[68:71], v[168:171], a[232:235], v[68:71]
M v[72:75], v[176:179], a[232:235], v[72:75]
buffer_load_dwordx4 a[196:199], v1, s[44:47], s25 offen offset:1024 sc1
M v[72:75], v[180:183], a[236:239], v[72:75]
M v[76:79], v[188:191], a[236:239], v[76:79]
ds_read_b64_tr_b16 a[52:53], v18 offset:24576
ds_read_b64_tr_b16 a[54:55], v18 offset:28672
M v[76:79], v[184:187], a[232:235], v[76:79]
M v[80:83], v[192:195], a[232:235], v[80:83]
buffer_load_dwordx4 a[200:203], v1, s[44:47], s25 offen offset:2048 sc1
M v[80:83], v[196:199], a[236:239], v[80:83]
M v[84:87], v[204:207], a[236:239], v[84:87]
ds_read_b64_tr_b16 a[56:57], v19 offset:16384
ds_read_b64_tr_b16 a[58:59], v19 offset:20480
M v[84:87], v[200:203], a[232:235], v[84:87]
M v[88:91], v[208:211], a[232:235], v[88:91]
buffer_load_dwordx4 a[204:207], v1, s[44:47], s25 offen offset:3072 sc1
M v[88:91], v[212:215], a[236:239], v[88:91]
M v[92:95], v[220:223], a[236:239], v[92:95]
M v[92:95], v[216:219], a[232:235], v[92:95]
ds_read_b64_tr_b16 a[60:61], v19 offset:24576
ds_read_b64_tr_b16 a[62:63], v19 offset:28672
M v[96:99], v[160:163], a[240:243], v[96:99]
M v[96:99], v[164:167], a[244:247], v[96:99]
s_add_u32 s63, s25, 4096
buffer_load_dwordx4 a[208:211], v1, s[44:47], s63 offen offset:0 sc1
M v[100:103], v[172:175], a[244:247], v[100:103]
M v[100:103], v[168:171], a[240:243], v[100:103]
ds_read_b64_tr_b16 a[64:65], v20 offset:16384
ds_read_b64_tr_b16 a[66:67], v20 offset:20480
M v[104:107], v[176:179], a[240:243], v[104:107]
M v[104:107], v[180:183], a[244:247], v[104:107]
buffer_load_dwordx4 a[212:215], v1, s[44:47], s63 offen offset:1024 sc1
M v[108:111], v[188:191], a[244:247], v[108:111]
M v[108:111], v[184:187], a[240:243], v[108:111]
ds_read_b64_tr_b16 a[68:69], v20 offset:24576
ds_read_b64_tr_b16 a[70:71], v20 offset:28672
M v[112:115], v[192:195], a[240:243], v[112:115]
M v[112:115], v[196:199], a[244:247], v[112:115]
buffer_load_dwordx4 a[216:219], v1, s[44:47], s63 offen offset:2048 sc1
M v[116:119], v[204:207], a[244:247], v[116:119]
M v[116:119], v[200:203], a[240:243], v[116:119]
ds_read_b64_tr_b16 a[72:73], v21 offset:16384
ds_read_b64_tr_b16 a[74:75], v21 offset:20480
M v[120:123], v[208:211], a[240:243], v[120:123]
M v[120:123], v[212:215], a[244:247], v[120:123]
buffer_load_dwordx4 a[220:223], v1, s[44:47], s63 offen offset:3072 sc1
M v[124:127], v[220:223], a[244:247], v[124:127]
M v[124:127], v[216:219], a[240:243], v[124:127]
ds_read_b64_tr_b16 a[76:77], v21 offset:24576
ds_read_b64_tr_b16 a[78:79], v21 offset:28672
M v[128:131], v[160:163], a[248:251], v[128:131]
M v[128:131], v[164:167], a[252:255], v[128:131]
s_sub_u32 s39, s39, 1
s_cmp_eq_u32 s39, 0
s_cselect_b32 s3, s64, s65
M v[132:135], v[172:175], a[252:255], v[132:135]
M v[132:135], v[168:171], a[248:251], v[132:135]
ds_read_b64_tr_b16 a[80:81], v22 offset:16384
ds_read_b64_tr_b16 a[82:83], v22 offset:20480
M v[136:139], v[176:179], a[248:251], v[136:139]
M v[136:139], v[180:183], a[252:255], v[136:139]
s_add_u32 s25, s25, s3
s_lshl_b32 s3, s3, 3
s_add_u32 s26, s26, s3
M v[140:143], v[188:191], a[252:255], v[140:143]
M v[140:143], v[184:187], a[248:251], v[140:143]
ds_read_b64_tr_b16 a[84:85], v22 offset:24576
ds_read_b64_tr_b16 a[86:87], v22 offset:28672
M v[144:147], v[192:195], a[248:251], v[144:147]
M v[144:147], v[196:199], a[252:255], v[144:147]
ds_read_b64_tr_b16 a[88:89], v23 offset:16384
ds_read_b64_tr_b16 a[90:91], v23 offset:20480
M v[148:151], v[204:207], a[252:255], v[148:151]
M v[148:151], v[200:203], a[248:251], v[148:151]
ds_read_b64_tr_b16 a[92:93], v23 offset:24576
ds_read_b64_tr_b16 a[94:95], v23 offset:28672
M v[152:155], v[208:211], a[248:251], v[152:155]
M v[152:155], v[212:215], a[252:255], v[152:155]
M v[156:159], v[220:223], a[252:255], v[156:159]
M v[156:159], v[216:219], a[248:251], v[156:159]
s_waitcnt vmcnt(24) lgkmcnt(0)
s_barrier
M v[32:35], a[32:35], a[96:99], v[32:35]
s_add_u32 m0, s41, 16384
s_nop 0
buffer_load_dwordx4 v2, s[48:51], s26 offen offset:0 lds
M v[32:35], a[36:39], a[100:103], v[32:35]
M v[36:39], a[44:47], a[100:103], v[36:39]
ds_read_b64_tr_b16 v[160:161], v16 offset:32768
ds_read_b64_tr_b16 v[162:163], v16 offset:36864
M v[36:39], a[40:43], a[96:99], v[36:39]
M v[40:43], a[48:51], a[96:99], v[40:43]
buffer_load_dwordx4 v3, s[48:51], s26 offen offset:1024 lds
M v[40:43], a[52:55], a[100:103], v[40:43]
M v[44:47], a[60:63], a[100:103], v[44:47]
ds_read_b64_tr_b16 v[164:165], v16 offset:40960
ds_read_b64_tr_b16 v[166:167], v16 offset:45056
M v[44:47], a[56:59], a[96:99], v[44:47]
M v[48:51], a[64:67], a[96:99], v[48:51]
buffer_load_dwordx4 v4, s[48:51], s26 offen offset:2048 lds
M v[48:51], a[68:71], a[100:103], v[48:51]
M v[52:55], a[76:79], a[100:103], v[52:55]
ds_read_b64_tr_b16 v[168:169], v17 offset:32768
ds_read_b64_tr_b16 v[170:171], v17 offset:36864
M v[52:55], a[72:75], a[96:99], v[52:55]
M v[56:59], a[80:83], a[96:99], v[56:59]
buffer_load_dwordx4 v5, s[48:51], s26 offen offset:3072 lds
M v[56:59], a[84:87], a[100:103], v[56:59]
M v[60:63], a[92:95], a[100:103], v[60:63]
ds_read_b64_tr_b16 v[172:173], v17 offset:40960
ds_read_b64_tr_b16 v[174:175], v17 offset:45056
M v[60:63], a[88:91], a[96:99], v[60:63]
M v[64:67], a[32:35], a[104:107], v[64:67]
buffer_load_dwordx4 a[224:227], v1, s[44:47], s25 offen offset:0 sc1
M v[64:67], a[36:39], a[108:111], v[64:67]
M v[68:71], a[44:47], a[108:111], v[68:71]
ds_read_b64_tr_b16 v[176:177], v18 offset:32768
ds_read_b64_tr_b16 v[178:179], v18 offset:36864
M v[68:71], a[40:43], a[104:107], v[68:71]
M v[72:75], a[48:51], a[104:107], v[72:75]
buffer_load_dwordx4 a[228:231], v1, s[44:47], s25 offen offset:1024 sc1
M v[72:75], a[52:55], a[108:111], v[72:75]
M v[76:79], a[60:63], a[108:111], v[76:79]
ds_read_b64_tr_b16 v[180:181], v18 offset:40960
ds_read_b64_tr_b16 v[182:183], v18 offset:45056
M v[76:79], a[56:59], a[104:107], v[76:79]
M v[80:83], a[64:67], a[104:107], v[80:83]
buffer_load_dwordx4 a[232:235], v1, s[44:47], s25 offen offset:2048 sc1
M v[80:83], a[68:71], a[108:111], v[80:83]
M v[84:87], a[76:79], a[108:111], v[84:87]
ds_read_b64_tr_b16 v[184:185], v19 offset:32768
ds_read_b64_tr_b16 v[186:187], v19 offset:36864
M v[84:87], a[72:75], a[104:107], v[84:87]
M v[88:91], a[80:83], a[104:107], v[88:91]
buffer_load_dwordx4 a[236:239], v1, s[44:47], s25 offen offset:3072 sc1
M v[88:91], a[84:87], a[108:111], v[88:91]
M v[92:95], a[92:95], a[108:111], v[92:95]
M v[92:95], a[88:91], a[104:107], v[92:95]
ds_read_b64_tr_b16 v[188:189], v19 offset:40960
ds_read_b64_tr_b16 v[190:191], v19 offset:45056
M v[96:99], a[32:35], a[112:115], v[96:99]
M v[96:99], a[36:39], a[116:119], v[96:99]
s_add_u32 s63, s25, 4096
buffer_load_dwordx4 a[240:243], v1, s[44:47], s63 offen offset:0 sc1
M v[100:103], a[44:47], a[116:119], v[100:103]
M v[100:103], a[40:43], a[112:115], v[100:103]
ds_read_b64_tr_b16 v[192:193], v20 offset:32768
ds_read_b64_tr_b16 v[194:195], v20 offset:36864
M v[104:107], a[48:51], a[112:115], v[104:107]
M v[104:107], a[52:55], a[116:119], v[104:107]
buffer_load_dwordx4 a[244:247], v1, s[44:47], s63 offen offset:1024 sc1
M v[108:111], a[60:63], a[116:119], v[108:111]
M v[108:111], a[56:59], a[112:115], v[108:111]
ds_read_b64_tr_b16 v[196:197], v20 offset:40960
ds_read_b64_tr_b16 v[198:199], v20 offset:45056
M v[112:115], a[64:67], a[112:115], v[112:115]
M v[112:115], a[68:71], a[116:119], v[112:115]
buffer_load_dwordx4 a[248:251], v1, s[44:47], s63 offen offset:2048 sc1
M v[116:119], a[76:79], a[116:119], v[116:119]
M v[116:119], a[72:75], a[112:115], v[116:119]
ds_read_b64_tr_b16 v[200:201], v21 offset:32768
ds_read_b64_tr_b16 v[202:203], v21 offset:36864
M v[120:123], a[80:83], a[112:115], v[120:123]
M v[120:123], a[84:87], a[116:119], v[120:123]
buffer_load_dwordx4 a[252:255], v1, s[44:47], s63 offen offset:3072 sc1
M v[124:127], a[92:95], a[116:119], v[124:127]
M v[124:127], a[88:91], a[112:115], v[124:127]
ds_read_b64_tr_b16 v[204:205], v21 offset:40960
ds_read_b64_tr_b16 v[206:207], v21 offset:45056
M v[128:131], a[32:35], a[120:123], v[128:131]
M v[128:131], a[36:39], a[124:127], v[128:131]
s_sub_u32 s39, s39, 1
s_cmp_eq_u32 s39, 0
s_cselect_b32 s3, s64, s65
M v[132:135], a[44:47], a[124:127], v[132:135]
M v[132:135], a[40:43], a[120:123], v[132:135]
ds_read_b64_tr_b16 v[208:209], v22 offset:32768
ds_read_b64_tr_b16 v[210:211], v22 offset:36864
M v[136:139], a[48:51], a[120:123], v[136:139]
M v[136:139], a[52:55], a[124:127], v[136:139]
s_add_u32 s25, s25, s3
s_lshl_b32 s3, s3, 3
s_add_u32 s26, s26, s3
M v[140:143], a[60:63], a[124:127], v[140:143]
M v[140:143], a[56:59], a[120:123], v[140:143]
ds_read_b64_tr_b16 v[212:213], v22 offset:40960
ds_read_b64_tr_b16 v[214:215], v22 offset:45056
M v[144:147], a[64:67], a[120:123], v[144:147]
M v[144:147], a[68:71], a[124:127], v[144:147]
ds_read_b64_tr_b16 v[216:217], v23 offset:32768
ds_read_b64_tr_b16 v[218:219], v23 offset:36864
M v[148:151], a[76:79], a[124:127], v[148:151]
M v[148:151], a[72:75], a[120:123], v[148:151]
ds_read_b64_tr_b16 v[220:221], v23 offset:40960
ds_read_b64_tr_b16 v[222:223], v23 offset:45056
M v[152:155], a[80:83], a[120:123], v[152:155]
M v[152:155], a[84:87], a[124:127], v[152:155]
M v[156:159], a[92:95], a[124:127], v[156:159]
M v[156:159], a[88:91], a[120:123], v[156:159]
s_waitcnt vmcnt(24) lgkmcnt(0)
s_barrier
M v[32:35], v[160:163], a[128:131], v[32:35]
s_add_u32 m0, s41, 32768
s_nop 0
buffer_load_dwordx4 v2, s[48:51], s26 offen offset:0 lds
M v[32:35], v[164:167], a[132:135], v[32:35]
M v[36:39], v[172:175], a[132:135], v[36:39]
ds_read_b64_tr_b16 a[32:33], v16 offset:49152
ds_read_b64_tr_b16 a[34:35], v16 offset:53248
M v[36:39], v[168:171], a[128:131], v[36:39]
M v[40:43], v[176:179], a[128:131], v[40:43]
buffer_load_dwordx4 v3, s[48:51], s26 offen offset:1024 lds
M v[40:43], v[180:183], a[132:135], v[40:43]
M v[44:47], v[188:191], a[132:135], v[44:47]
ds_read_b64_tr_b16 a[36:37], v16 offset:57344
ds_read_b64_tr_b16 a[38:39], v16 offset:61440
M v[44:47], v[184:187], a[128:131], v[44:47]
M v[48:51], v[192:195], a[128:131], v[48:51]
buffer_load_dwordx4 v4, s[48:51], s26 offen offset:2048 lds
M v[48:51], v[196:199], a[132:135], v[48:51]
M v[52:55], v[204:207], a[132:135], v[52:55]
ds_read_b64_tr_b16 a[40:41], v17 offset:49152
ds_read_b64_tr_b16 a[42:43], v17 offset:53248
M v[52:55], v[200:203], a[128:131], v[52:55]
M v[56:59], v[208:211], a[128:131], v[56:59]
buffer_load_dwordx4 v5, s[48:51], s26 offen offset:3072 lds
M v[56:59], v[212:215], a[132:135], v[56:59]
M v[60:63], v[220:223], a[132:135], v[60:63]
ds_read_b64_tr_b16 a[44:45], v17 offset:57344
ds_read_b64_tr_b16 a[46:47], v17 offset:61440
M v[60:63], v[216:219], a[128:131], v[60:63]
M v[64:67], v[160:163], a[136:139], v[64:67]
buffer_load_dwordx4 a[96:99], v1, s[44:47], s25 offen offset:0 sc1
M v[64:67], v[164:167], a[140:143], v[64:67]
M v[68:71], v[172:175], a[140:143], v[68:71]
ds_read_b64_tr_b16 a[48:49], v18 offset:49152
ds_read_b64_tr_b16 a[50:51], v18 offset:53248
M v[68:71], v[168:171], a[136:139], v[68:71]
M v[72:75], v[176:179], a[136:139], v[72:75]
buffer_load_dwordx4 a[100:103], v1, s[44:47], s25 offen offset:1024 sc1
M v[72:75], v[180:183], a[140:143], v[72:75]
M v[76:79], v[188:191], a[140:143], v[76:79]
ds_read_b64_tr_b16 a[52:53], v18 offset:57344
ds_read_b64_tr_b16 a[54:55], v18 offset:61440
M v[76:79], v[184:187], a[136:139], v[76:79]
M v[80:83], v[192:195], a[136:139], v[80:83]
buffer_load_dwordx4 a[104:107], v1, s[44:47], s25 offen offset:2048 sc1
M v[80:83], v[196:199], a[140:143], v[80:83]
M v[84:87], v[204:207], a[140:143], v[84:87]
ds_read_b64_tr_b16 a[56:57], v19 offset:49152
ds_read_b64_tr_b16 a[58:59], v19 offset:53248
M v[84:87], v[200:203], a[136:139], v[84:87]
M v[88:91], v[208:211], a[136:139], v[88:91]
buffer_load_dwordx4 a[108:111], v1, s[44:47], s25 offen offset:3072 sc1
M v[88:91], v[212:215], a[140:143], v[88:91]
M v[92:95], v[220:223], a[140:143], v[92:95]
M v[92:95], v[216:219], a[136:139], v[92:95]
ds_read_b64_tr_b16 a[60:61], v19 offset:57344
ds_read_b64_tr_b16 a[62:63], v19 offset:61440
M v[96:99], v[160:163], a[144:147], v[96:99]
M v[96:99], v[164:167], a[148:151], v[96:99]
s_add_u32 s63, s25, 4096
buffer_load_dwordx4 a[112:115], v1, s[44:47], s63 offen offset:0 sc1
M v[100:103], v[172:175], a[148:151], v[100:103]
M v[100:103], v[168:171], a[144:147], v[100:103]
ds_read_b64_tr_b16 a[64:65], v20 offset:49152
ds_read_b64_tr_b16 a[66:67], v20 offset:53248
M v[104:107], v[176:179], a[144:147], v[104:107]
M v[104:107], v[180:183], a[148:151], v[104:107]
buffer_load_dwordx4 a[116:119], v1, s[44:47], s63 offen offset:1024 sc1
M v[108:111], v[188:191], a[148:151], v[108:111]
M v[108:111], v[184:187], a[144:147], v[108:111]
ds_read_b64_tr_b16 a[68:69], v20 offset:57344
ds_read_b64_tr_b16 a[70:71], v20 offset:61440
M v[112:115], v[192:195], a[144:147], v[112:115]
M v[112:115], v[196:199], a[148:151], v[112:115]
buffer_load_dwordx4 a[120:123], v1, s[44:47], s63 offen offset:2048 sc1
M v[116:119], v[204:207], a[148:151], v[116:119]
M v[116:119], v[200:203], a[144:147], v[116:119]
ds_read_b64_tr_b16 a[72:73], v21 offset:49152
ds_read_b64_tr_b16 a[74:75], v21 offset:53248
M v[120:123], v[208:211], a[144:147], v[120:123]
M v[120:123], v[212:215], a[148:151], v[120:123]
buffer_load_dwordx4 a[124:127], v1, s[44:47], s63 offen offset:3072 sc1
M v[124:127], v[220:223], a[148:151], v[124:127]
M v[124:127], v[216:219], a[144:147], v[124:127]
ds_read_b64_tr_b16 a[76:77], v21 offset:57344
ds_read_b64_tr_b16 a[78:79], v21 offset:61440
M v[128:131], v[160:163], a[152:155], v[128:131]
M v[128:131], v[164:167], a[156:159], v[128:131]
s_sub_u32 s39, s39, 1
s_cmp_eq_u32 s39, 0
s_cselect_b32 s3, s64, s65
M v[132:135], v[172:175], a[156:159], v[132:135]
M v[132:135], v[168:171], a[152:155], v[132:135]
ds_read_b64_tr_b16 a[80:81], v22 offset:49152
ds_read_b64_tr_b16 a[82:83], v22 offset:53248
M v[136:139], v[176:179], a[152:155], v[136:139]
M v[136:139], v[180:183], a[156:159], v[136:139]
s_add_u32 s25, s25, s3
s_lshl_b32 s3, s3, 3
s_add_u32 s26, s26, s3
M v[140:143], v[188:191], a[156:159], v[140:143]
M v[140:143], v[184:187], a[152:155], v[140:143]
ds_read_b64_tr_b16 a[84:85], v22 offset:57344
ds_read_b64_tr_b16 a[86:87], v22 offset:61440
M v[144:147], v[192:195], a[152:155], v[144:147]
M v[144:147], v[196:199], a[156:159], v[144:147]
ds_read_b64_tr_b16 a[88:89], v23 offset:49152
ds_read_b64_tr_b16 a[90:91], v23 offset:53248
M v[148:151], v[204:207], a[156:159], v[148:151]
M v[148:151], v[200:203], a[152:155], v[148:151]
ds_read_b64_tr_b16 a[92:93], v23 offset:57344
ds_read_b64_tr_b16 a[94:95], v23 offset:61440
M v[152:155], v[208:211], a[152:155], v[152:155]
M v[152:155], v[212:215], a[156:159], v[152:155]
M v[156:159], v[220:223], a[156:159], v[156:159]
M v[156:159], v[216:219], a[152:155], v[156:159]
s_waitcnt vmcnt(24) lgkmcnt(0)
s_barrier
M v[32:35], a[32:35], a[160:163], v[32:35]
s_add_u32 m0, s41, 49152
s_nop 0
buffer_load_dwordx4 v2, s[48:51], s26 offen offset:0 lds
M v[32:35], a[36:39], a[164:167], v[32:35]
M v[36:39], a[44:47], a[164:167], v[36:39]
ds_read_b64_tr_b16 v[160:161], v8 offset:0
ds_read_b64_tr_b16 v[162:163], v8 offset:4096
M v[36:39], a[40:43], a[160:163], v[36:39]
M v[40:43], a[48:51], a[160:163], v[40:43]
buffer_load_dwordx4 v3, s[48:51], s26 offen offset:1024 lds
M v[40:43], a[52:55], a[164:167], v[40:43]
M v[44:47], a[60:63], a[164:167], v[44:47]
ds_read_b64_tr_b16 v[164:165], v8 offset:8192
ds_read_b64_tr_b16 v[166:167], v8 offset:12288
M v[44:47], a[56:59], a[160:163], v[44:47]
M v[48:51], a[64:67], a[160:163], v[48:51]
buffer_load_dwordx4 v4, s[48:51], s26 offen offset:2048 lds
M v[48:51], a[68:71], a[164:167], v[48:51]
M v[52:55], a[76:79], a[164:167], v[52:55]
ds_read_b64_tr_b16 v[168:169], v9 offset:0
ds_read_b64_tr_b16 v[170:171], v9 offset:4096
M v[52:55], a[72:75], a[160:163], v[52:55]
M v[56:59], a[80:83], a[160:163], v[56:59]
buffer_load_dwordx4 v5, s[48:51], s26 offen offset:3072 lds
M v[56:59], a[84:87], a[164:167], v[56:59]
M v[60:63], a[92:95], a[164:167], v[60:63]
ds_read_b64_tr_b16 v[172:173], v9 offset:8192
ds_read_b64_tr_b16 v[174:175], v9 offset:12288
M v[60:63], a[88:91], a[160:163], v[60:63]
M v[64:67], a[32:35], a[168:171], v[64:67]
buffer_load_dwordx4 a[128:131], v1, s[44:47], s25 offen offset:0 sc1
M v[64:67], a[36:39], a[172:175], v[64:67]
M v[68:71], a[44:47], a[172:175], v[68:71]
ds_read_b64_tr_b16 v[176:177], v10 offset:0
ds_read_b64_tr_b16 v[178:179], v10 offset:4096
M v[68:71], a[40:43], a[168:171], v[68:71]
M v[72:75], a[48:51], a[168:171], v[72:75]
buffer_load_dwordx4 a[132:135], v1, s[44:47], s25 offen offset:1024 sc1
M v[72:75], a[52:55], a[172:175], v[72:75]
M v[76:79], a[60:63], a[172:175], v[76:79]
ds_read_b64_tr_b16 v[180:181], v10 offset:8192
ds_read_b64_tr_b16 v[182:183], v10 offset:12288
M v[76:79], a[56:59], a[168:171], v[76:79]
M v[80:83], a[64:67], a[168:171], v[80:83]
buffer_load_dwordx4 a[136:139], v1, s[44:47], s25 offen offset:2048 sc1
M v[80:83], a[68:71], a[172:175], v[80:83]
M v[84:87], a[76:79], a[172:175], v[84:87]
ds_read_b64_tr_b16 v[184:185], v11 offset:0
ds_read_b64_tr_b16 v[186:187], v11 offset:4096
M v[84:87], a[72:75], a[168:171], v[84:87]
M v[88:91], a[80:83], a[168:171], v[88:91]
buffer_load_dwordx4 a[140:143], v1, s[44:47], s25 offen offset:3072 sc1
M v[88:91], a[84:87], a[172:175], v[88:91]
M v[92:95], a[92:95], a[172:175], v[92:95]
M v[92:95], a[88:91], a[168:171], v[92:95]
ds_read_b64_tr_b16 v[188:189], v11 offset:8192
ds_read_b64_tr_b16 v[190:191], v11 offset:12288
M v[96:99], a[32:35], a[176:179], v[96:99]
M v[96:99], a[36:39], a[180:183], v[96:99]
s_add_u32 s63, s25, 4096
buffer_load_dwordx4 a[144:147], v1, s[44:47], s63 offen offset:0 sc1
M v[100:103], a[44:47], a[180:183], v[100:103]
M v[100:103], a[40:43], a[176:179], v[100:103]
ds_read_b64_tr_b16 v[192:193], v12 offset:0
ds_read_b64_tr_b16 v[194:195], v12 offset:4096
M v[104:107], a[48:51], a[176:179], v[104:107]
M v[104:107], a[52:55], a[180:183], v[104:107]
buffer_load_dwordx4 a[148:151], v1, s[44:47], s63 offen offset:1024 sc1
M v[108:111], a[60:63], a[180:183], v[108:111]
M v[108:111], a[56:59], a[176:179], v[108:111]
ds_read_b64_tr_b16 v[196:197], v12 offset:8192
ds_read_b64_tr_b16 v[198:199], v12 offset:12288
M v[112:115], a[64:67], a[176:179], v[112:115]
M v[112:115], a[68:71], a[180:183], v[112:115]
buffer_load_dwordx4 a[152:155], v1, s[44:47], s63 offen offset:2048 sc1
M v[116:119], a[76:79], a[180:183], v[116:119]
M v[116:119], a[72:75], a[176:179], v[116:119]
ds_read_b64_tr_b16 v[200:201], v13 offset:0
ds_read_b64_tr_b16 v[202:203], v13 offset:4096
M v[120:123], a[80:83], a[176:179], v[120:123]
M v[120:123], a[84:87], a[180:183], v[120:123]
buffer_load_dwordx4 a[156:159], v1, s[44:47], s63 offen offset:3072 sc1
M v[124:127], a[92:95], a[180:183], v[124:127]
M v[124:127], a[88:91], a[176:179], v[124:127]
ds_read_b64_tr_b16 v[204:205], v13 offset:8192
ds_read_b64_tr_b16 v[206:207], v13 offset:12288
M v[128:131], a[32:35], a[184:187], v[128:131]
M v[128:131], a[36:39], a[188:191], v[128:131]
s_sub_u32 s39, s39, 1
s_cmp_eq_u32 s39, 0
s_cselect_b32 s3, s64, s65
M v[132:135], a[44:47], a[188:191], v[132:135]
M v[132:135], a[40:43], a[184:187], v[132:135]
ds_read_b64_tr_b16 v[208:209], v14 offset:0
ds_read_b64_tr_b16 v[210:211], v14 offset:4096
M v[136:139], a[48:51], a[184:187], v[136:139]
M v[136:139], a[52:55], a[188:191], v[136:139]
s_add_u32 s25, s25, s3
s_lshl_b32 s3, s3, 3
s_add_u32 s26, s26, s3
M v[140:143], a[60:63], a[188:191], v[140:143]
M v[140:143], a[56:59], a[184:187], v[140:143]
ds_read_b64_tr_b16 v[212:213], v14 offset:8192
ds_read_b64_tr_b16 v[214:215], v14 offset:12288
M v[144:147], a[64:67], a[184:187], v[144:147]
M v[144:147], a[68:71], a[188:191], v[144:147]
ds_read_b64_tr_b16 v[216:217], v15 offset:0
ds_read_b64_tr_b16 v[218:219], v15 offset:4096
M v[148:151], a[76:79], a[188:191], v[148:151]
M v[148:151], a[72:75], a[184:187], v[148:151]
ds_read_b64_tr_b16 v[220:221], v15 offset:8192
ds_read_b64_tr_b16 v[222:223], v15 offset:12288
M v[152:155], a[80:83], a[184:187], v[152:155]
M v[152:155], a[84:87], a[188:191], v[152:155]
M v[156:159], a[92:95], a[188:191], v[156:159]
M v[156:159], a[88:91], a[184:187], v[156:159]
s_waitcnt vmcnt(24) lgkmcnt(0)
s_barrier
M v[32:35], v[160:163], a[192:195], v[32:35]
s_add_u32 m0, s41, 65536
s_nop 0
buffer_load_dwordx4 v2, s[48:51], s26 offen offset:0 lds
M v[32:35], v[164:167], a[196:199], v[32:35]
M v[36:39], v[172:175], a[196:199], v[36:39]
ds_read_b64_tr_b16 a[32:33], v8 offset:16384
ds_read_b64_tr_b16 a[34:35], v8 offset:20480
M v[36:39], v[168:171], a[192:195], v[36:39]
M v[40:43], v[176:179], a[192:195], v[40:43]
buffer_load_dwordx4 v3, s[48:51], s26 offen offset:1024 lds
M v[40:43], v[180:183], a[196:199], v[40:43]
M v[44:47], v[188:191], a[196:199], v[44:47]
ds_read_b64_tr_b16 a[36:37], v8 offset:24576
ds_read_b64_tr_b16 a[38:39], v8 offset:28672
M v[44:47], v[184:187], a[192:195], v[44:47]
M v[48:51], v[192:195], a[192:195], v[48:51]
buffer_load_dwordx4 v4, s[48:51], s26 offen offset:2048 lds
M v[48:51], v[196:199], a[196:199], v[48:51]
M v[52:55], v[204:207], a[196:199], v[52:55]
ds_read_b64_tr_b16 a[40:41], v9 offset:16384
ds_read_b64_tr_b16 a[42:43], v9 offset:20480
M v[52:55], v[200:203], a[192:195], v[52:55]
M v[56:59], v[208:211], a[192:195], v[56:59]
buffer_load_dwordx4 v5, s[48:51], s26 offen offset:3072 lds
M v[56:59], v[212:215], a[196:199], v[56:59]
M v[60:63], v[220:223], a[196:199], v[60:63]
ds_read_b64_tr_b16 a[44:45], v9 offset:24576
ds_read_b64_tr_b16 a[46:47], v9 offset:28672
M v[60:63], v[216:219], a[192:195], v[60:63]
M v[64:67], v[160:163], a[200:203], v[64:67]
buffer_load_dwordx4 a[160:163], v1, s[44:47], s25 offen offset:0 sc1
M v[64:67], v[164:167], a[204:207], v[64:67]
M v[68:71], v[172:175], a[204:207], v[68:71]
ds_read_b64_tr_b16 a[48:49], v10 offset:16384
ds_read_b64_tr_b16 a[50:51], v10 offset:20480
M v[68:71], v[168:171], a[200:203], v[68:71]
M v[72:75], v[176:179], a[200:203], v[72:75]
buffer_load_dwordx4 a[164:167], v1, s[44:47], s25 offen offset:1024 sc1
M v[72:75], v[180:183], a[204:207], v[72:75]
M v[76:79], v[188:191], a[204:207], v[76:79]
ds_read_b64_tr_b16 a[52:53], v10 offset:24576
ds_read_b64_tr_b16 a[54:55], v10 offset:28672
M v[76:79], v[184:187], a[200:203], v[76:79]
M v[80:83], v[192:195], a[200:203], v[80:83]
buffer_load_dwordx4 a[168:171], v1, s[44:47], s25 offen offset:2048 sc1
M v[80:83], v[196:199], a[204:207], v[80:83]
M v[84:87], v[204:207], a[204:207], v[84:87]
ds_read_b64_tr_b16 a[56:57], v11 offset:16384
ds_read_b64_tr_b16 a[58:59], v11 offset:20480
M v[84:87], v[200:203], a[200:203], v[84:87]
M v[88:91], v[208:211], a[200:203], v[88:91]
buffer_load_dwordx4 a[172:175], v1, s[44:47], s25 offen offset:3072 sc1
M v[88:91], v[212:215], a[204:207], v[88:91]
M v[92:95], v[220:223], a[204:207], v[92:95]
M v[92:95], v[216:219], a[200:203], v[92:95]
ds_read_b64_tr_b16 a[60:61], v11 offset:24576
ds_read_b64_tr_b16 a[62:63], v11 offset:28672
M v[96:99], v[160:163], a[208:211], v[96:99]
M v[96:99], v[164:167], a[212:215], v[96:99]
s_add_u32 s63, s25, 4096
buffer_load_dwordx4 a[176:179], v1, s[44:47], s63 offen offset:0 sc1
M v[100:103], v[172:175], a[212:215], v[100:103]
M v[100:103], v[168:171], a[208:211], v[100:103]
ds_read_b64_tr_b16 a[64:65], v12 offset:16384
ds_read_b64_tr_b16 a[66:67], v12 offset:20480
M v[104:107], v[176:179], a[208:211], v[104:107]
M v[104:107], v[180:183], a[212:215], v[104:107]
buffer_load_dwordx4 a[180:183], v1, s[44:47], s63 offen offset:1024 sc1
M v[108:111], v[188:191], a[212:215], v[108:111]
M v[108:111], v[184:187], a[208:211], v[108:111]
ds_read_b64_tr_b16 a[68:69], v12 offset:24576
ds_read_b64_tr_b16 a[70:71], v12 offset:28672
M v[112:115], v[192:195], a[208:211], v[112:115]
M v[112:115], v[196:199], a[212:215], v[112:115]
buffer_load_dwordx4 a[184:187], v1, s[44:47], s63 offen offset:2048 sc1
M v[116:119], v[204:207], a[212:215], v[116:119]
M v[116:119], v[200:203], a[208:211], v[116:119]
ds_read_b64_tr_b16 a[72:73], v13 offset:16384
ds_read_b64_tr_b16 a[74:75], v13 offset:20480
M v[120:123], v[208:211], a[208:211], v[120:123]
M v[120:123], v[212:215], a[212:215], v[120:123]
buffer_load_dwordx4 a[188:191], v1, s[44:47], s63 offen offset:3072 sc1
M v[124:127], v[220:223], a[212:215], v[124:127]
M v[124:127], v[216:219], a[208:211], v[124:127]
ds_read_b64_tr_b16 a[76:77], v13 offset:24576
ds_read_b64_tr_b16 a[78:79], v13 offset:28672
M v[128:131], v[160:163], a[216:219], v[128:131]
M v[128:131], v[164:167], a[220:223], v[128:131]
s_sub_u32 s39, s39, 1
s_cmp_eq_u32 s39, 0
s_cselect_b32 s3, s64, s65
M v[132:135], v[172:175], a[220:223], v[132:135]
M v[132:135], v[168:171], a[216:219], v[132:135]
ds_read_b64_tr_b16 a[80:81], v14 offset:16384
ds_read_b64_tr_b16 a[82:83], v14 offset:20480
M v[136:139], v[176:179], a[216:219], v[136:139]
M v[136:139], v[180:183], a[220:223], v[136:139]
s_add_u32 s25, s25, s3
s_lshl_b32 s3, s3, 3
s_add_u32 s26, s26, s3
M v[140:143], v[188:191], a[220:223], v[140:143]
M v[140:143], v[184:187], a[216:219], v[140:143]
ds_read_b64_tr_b16 a[84:85], v14 offset:24576
ds_read_b64_tr_b16 a[86:87], v14 offset:28672
M v[144:147], v[192:195], a[216:219], v[144:147]
M v[144:147], v[196:199], a[220:223], v[144:147]
ds_read_b64_tr_b16 a[88:89], v15 offset:16384
ds_read_b64_tr_b16 a[90:91], v15 offset:20480
M v[148:151], v[204:207], a[220:223], v[148:151]
M v[148:151], v[200:203], a[216:219], v[148:151]
ds_read_b64_tr_b16 a[92:93], v15 offset:24576
ds_read_b64_tr_b16 a[94:95], v15 offset:28672
M v[152:155], v[208:211], a[216:219], v[152:155]
M v[152:155], v[212:215], a[220:223], v[152:155]
M v[156:159], v[220:223], a[220:223], v[156:159]
M v[156:159], v[216:219], a[216:219], v[156:159]
s_waitcnt vmcnt(24) lgkmcnt(0)
s_barrier
M v[32:35], a[32:35], a[224:227], v[32:35]
s_add_u32 m0, s41, 81920
s_nop 0
buffer_load_dwordx4 v2, s[48:51], s26 offen offset:0 lds
M v[32:35], a[36:39], a[228:231], v[32:35]
M v[36:39], a[44:47], a[228:231], v[36:39]
ds_read_b64_tr_b16 v[160:161], v8 offset:32768
ds_read_b64_tr_b16 v[162:163], v8 offset:36864
M v[36:39], a[40:43], a[224:227], v[36:39]
M v[40:43], a[48:51], a[224:227], v[40:43]
buffer_load_dwordx4 v3, s[48:51], s26 offen offset:1024 lds
M v[40:43], a[52:55], a[228:231], v[40:43]
M v[44:47], a[60:63], a[228:231], v[44:47]
ds_read_b64_tr_b16 v[164:165], v8 offset:40960
ds_read_b64_tr_b16 v[166:167], v8 offset:45056
M v[44:47], a[56:59], a[224:227], v[44:47]
M v[48:51], a[64:67], a[224:227], v[48:51]
buffer_load_dwordx4 v4, s[48:51], s26 offen offset:2048 lds
M v[48:51], a[68:71], a[228:231], v[48:51]
M v[52:55], a[76:79], a[228:231], v[52:55]
ds_read_b64_tr_b16 v[168:169], v9 offset:32768
ds_read_b64_tr_b16 v[170:171], v9 offset:36864
M v[52:55], a[72:75], a[224:227], v[52:55]
M v[56:59], a[80:83], a[224:227], v[56:59]
buffer_load_dwordx4 v5, s[48:51], s26 offen offset:3072 lds
M v[56:59], a[84:87], a[228:231], v[56:59]
M v[60:63], a[92:95], a[228:231], v[60:63]
ds_read_b64_tr_b16 v[172:173], v9 offset:40960
ds_read_b64_tr_b16 v[174:175], v9 offset:45056
M v[60:63], a[88:91], a[224:227], v[60:63]
M v[64:67], a[32:35], a[232:235], v[64:67]
buffer_load_dwordx4 a[192:195], v1, s[44:47], s25 offen offset:0 sc1
M v[64:67], a[36:39], a[236:239], v[64:67]
M v[68:71], a[44:47], a[236:239], v[68:71]
ds_read_b64_tr_b16 v[176:177], v10 offset:32768
ds_read_b64_tr_b16 v[178:179], v10 offset:36864
M v[68:71], a[40:43], a[232:235], v[68:71]
M v[72:75], a[48:51], a[232:235], v[72:75]
buffer_load_dwordx4 a[196:199], v1, s[44:47], s25 offen offset:1024 sc1
M v[72:75], a[52:55], a[236:239], v[72:75]
M v[76:79], a[60:63], a[236:239], v[76:79]
ds_read_b64_tr_b16 v[180:181], v10 offset:40960
ds_read_b64_tr_b16 v[182:183], v10 offset:45056
M v[76:79], a[56:59], a[232:235], v[76:79]
M v[80:83], a[64:67], a[232:235], v[80:83]
buffer_load_dwordx4 a[200:203], v1, s[44:47], s25 offen offset:2048 sc1
M v[80:83], a[68:71], a[236:239], v[80:83]
M v[84:87], a[76:79], a[236:239], v[84:87]
ds_read_b64_tr_b16 v[184:185], v11 offset:32768
ds_read_b64_tr_b16 v[186:187], v11 offset:36864
M v[84:87], a[72:75], a[232:235], v[84:87]
M v[88:91], a[80:83], a[232:235], v[88:91]
buffer_load_dwordx4 a[204:207], v1, s[44:47], s25 offen offset:3072 sc1
M v[88:91], a[84:87], a[236:239], v[88:91]
M v[92:95], a[92:95], a[236:239], v[92:95]
M v[92:95], a[88:91], a[232:235], v[92:95]
ds_read_b64_tr_b16 v[188:189], v11 offset:40960
ds_read_b64_tr_b16 v[190:191], v11 offset:45056
M v[96:99], a[32:35], a[240:243], v[96:99]
M v[96:99], a[36:39], a[244:247], v[96:99]
s_add_u32 s63, s25, 4096
buffer_load_dwordx4 a[208:211], v1, s[44:47], s63 offen offset:0 sc1
M v[100:103], a[44:47], a[244:247], v[100:103]
M v[100:103], a[40:43], a[240:243], v[100:103]
ds_read_b64_tr_b16 v[192:193], v12 offset:32768
ds_read_b64_tr_b16 v[194:195], v12 offset:36864
M v[104:107], a[48:51], a[240:243], v[104:107]
M v[104:107], a[52:55], a[244:247], v[104:107]
buffer_load_dwordx4 a[212:215], v1, s[44:47], s63 offen offset:1024 sc1
M v[108:111], a[60:63], a[244:247], v[108:111]
M v[108:111], a[56:59], a[240:243], v[108:111]
ds_read_b64_tr_b16 v[196:197], v12 offset:40960
ds_read_b64_tr_b16 v[198:199], v12 offset:45056
M v[112:115], a[64:67], a[240:243], v[112:115]
M v[112:115], a[68:71], a[244:247], v[112:115]
buffer_load_dwordx4 a[216:219], v1, s[44:47], s63 offen offset:2048 sc1
M v[116:119], a[76:79], a[244:247], v[116:119]
M v[116:119], a[72:75], a[240:243], v[116:119]
ds_read_b64_tr_b16 v[200:201], v13 offset:32768
ds_read_b64_tr_b16 v[202:203], v13 offset:36864
M v[120:123], a[80:83], a[240:243], v[120:123]
M v[120:123], a[84:87], a[244:247], v[120:123]
buffer_load_dwordx4 a[220:223], v1, s[44:47], s63 offen offset:3072 sc1
M v[124:127], a[92:95], a[244:247], v[124:127]
M v[124:127], a[88:91], a[240:243], v[124:127]
ds_read_b64_tr_b16 v[204:205], v13 offset:40960
ds_read_b64_tr_b16 v[206:207], v13 offset:45056
M v[128:131], a[32:35], a[248:251], v[128:131]
M v[128:131], a[36:39], a[252:255], v[128:131]
s_sub_u32 s39, s39, 1
s_cmp_eq_u32 s39, 0
s_cselect_b32 s3, s64, s65
M v[132:135], a[44:47], a[252:255], v[132:135]
M v[132:135], a[40:43], a[248:251], v[132:135]
ds_read_b64_tr_b16 v[208:209], v14 offset:32768
ds_read_b64_tr_b16 v[210:211], v14 offset:36864
M v[136:139], a[48:51], a[248:251], v[136:139]
M v[136:139], a[52:55], a[252:255], v[136:139]
s_add_u32 s25, s25, s3
s_lshl_b32 s3, s3, 3
s_add_u32 s26, s26, s3
M v[140:143], a[60:63], a[252:255], v[140:143]
M v[140:143], a[56:59], a[248:251], v[140:143]
ds_read_b64_tr_b16 v[212:213], v14 offset:40960
ds_read_b64_tr_b16 v[214:215], v14 offset:45056
M v[144:147], a[64:67], a[248:251], v[144:147]
M v[144:147], a[68:71], a[252:255], v[144:147]
ds_read_b64_tr_b16 v[216:217], v15 offset:32768
ds_read_b64_tr_b16 v[218:219], v15 offset:36864
M v[148:151], a[76:79], a[252:255], v[148:151]
M v[148:151], a[72:75], a[248:251], v[148:151]
ds_read_b64_tr_b16 v[220:221], v15 offset:40960
ds_read_b64_tr_b16 v[222:223], v15 offset:45056
M v[152:155], a[80:83], a[248:251], v[152:155]
M v[152:155], a[84:87], a[252:255], v[152:155]
M v[156:159], a[92:95], a[252:255], v[156:159]
M v[156:159], a[88:91], a[248:251], v[156:159]
s_waitcnt vmcnt(24) lgkmcnt(0)
s_barrier
M v[32:35], v[160:163], a[96:99], v[32:35]
s_add_u32 m0, s41, 98304
s_nop 0
buffer_load_dwordx4 v2, s[48:51], s26 offen offset:0 lds
M v[32:35], v[164:167], a[100:103], v[32:35]
M v[36:39], v[172:175], a[100:103], v[36:39]
ds_read_b64_tr_b16 a[32:33], v8 offset:49152
ds_read_b64_tr_b16 a[34:35], v8 offset:53248
M v[36:39], v[168:171], a[96:99], v[36:39]
M v[40:43], v[176:179], a[96:99], v[40:43]
buffer_load_dwordx4 v3, s[48:51], s26 offen offset:1024 lds
M v[40:43], v[180:183], a[100:103], v[40:43]
M v[44:47], v[188:191], a[100:103], v[44:47]
ds_read_b64_tr_b16 a[36:37], v8 offset:57344
ds_read_b64_tr_b16 a[38:39], v8 offset:61440
M v[44:47], v[184:187], a[96:99], v[44:47]
M v[48:51], v[192:195], a[96:99], v[48:51]
buffer_load_dwordx4 v4, s[48:51], s26 offen offset:2048 lds
M v[48:51], v[196:199], a[100:103], v[48:51]
M v[52:55], v[204:207], a[100:103], v[52:55]
ds_read_b64_tr_b16 a[40:41], v9 offset:49152
ds_read_b64_tr_b16 a[42:43], v9 offset:53248
M v[52:55], v[200:203], a[96:99], v[52:55]
M v[56:59], v[208:211], a[96:99], v[56:59]
buffer_load_dwordx4 v5, s[48:51], s26 offen offset:3072 lds
M v[56:59], v[212:215], a[100:103], v[56:59]
M v[60:63], v[220:223], a[100:103], v[60:63]
ds_read_b64_tr_b16 a[44:45], v9 offset:57344
ds_read_b64_tr_b16 a[46:47], v9 offset:61440
M v[60:63], v[216:219], a[96:99], v[60:63]
M v[64:67], v[160:163], a[104:107], v[64:67]
buffer_load_dwordx4 a[224:227], v1, s[44:47], s25 offen offset:0 sc1
M v[64:67], v[164:167], a[108:111], v[64:67]
M v[68:71], v[172:175], a[108:111], v[68:71]
ds_read_b64_tr_b16 a[48:49], v10 offset:49152
ds_read_b64_tr_b16 a[50:51], v10 offset:53248
M v[68:71], v[168:171], a[104:107], v[68:71]
M v[72:75], v[176:179], a[104:107], v[72:75]
buffer_load_dwordx4 a[228:231], v1, s[44:47], s25 offen offset:1024 sc1
M v[72:75], v[180:183], a[108:111], v[72:75]
M v[76:79], v[188:191], a[108:111], v[76:79]
ds_read_b64_tr_b16 a[52:53], v10 offset:57344
ds_read_b64_tr_b16 a[54:55], v10 offset:61440
M v[76:79], v[184:187], a[104:107], v[76:79]
M v[80:83], v[192:195], a[104:107], v[80:83]
buffer_load_dwordx4 a[232:235], v1, s[44:47], s25 offen offset:2048 sc1
M v[80:83], v[196:199], a[108:111], v[80:83]
M v[84:87], v[204:207], a[108:111], v[84:87]
ds_read_b64_tr_b16 a[56:57], v11 offset:49152
ds_read_b64_tr_b16 a[58:59], v11 offset:53248
M v[84:87], v[200:203], a[104:107], v[84:87]
M v[88:91], v[208:211], a[104:107], v[88:91]
buffer_load_dwordx4 a[236:239], v1, s[44:47], s25 offen offset:3072 sc1
M v[88:91], v[212:215], a[108:111], v[88:91]
M v[92:95], v[220:223], a[108:111], v[92:95]
M v[92:95], v[216:219], a[104:107], v[92:95]
ds_read_b64_tr_b16 a[60:61], v11 offset:57344
ds_read_b64_tr_b16 a[62:63], v11 offset:61440
M v[96:99], v[160:163], a[112:115], v[96:99]
M v[96:99], v[164:167], a[116:119], v[96:99]
s_add_u32 s63, s25, 4096
buffer_load_dwordx4 a[240:243], v1, s[44:47], s63 offen offset:0 sc1
M v[100:103], v[172:175], a[116:119], v[100:103]
M v[100:103], v[168:171], a[112:115], v[100:103]
ds_read_b64_tr_b16 a[64:65], v12 offset:49152
ds_read_b64_tr_b16 a[66:67], v12 offset:53248
M v[104:107], v[176:179], a[112:115], v[104:107]
M v[104:107], v[180:183], a[116:119], v[104:107]
buffer_load_dwordx4 a[244:247], v1, s[44:47], s63 offen offset:1024 sc1
M v[108:111], v[188:191], a[116:119], v[108:111]
M v[108:111], v[184:187], a[112:115], v[108:111]
ds_read_b64_tr_b16 a[68:69], v12 offset:57344
ds_read_b64_tr_b16 a[70:71], v12 offset:61440
M v[112:115], v[192:195], a[112:115], v[112:115]
M v[112:115], v[196:199], a[116:119], v[112:115]
buffer_load_dwordx4 a[248:251], v1, s[44:47], s63 offen offset:2048 sc1
M v[116:119], v[204:207], a[116:119], v[116:119]
M v[116:119], v[200:203], a[112:115], v[116:119]
ds_read_b64_tr_b16 a[72:73], v13 offset:49152
ds_read_b64_tr_b16 a[74:75], v13 offset:53248
M v[120:123], v[208:211], a[112:115], v[120:123]
M v[120:123], v[212:215], a[116:119], v[120:123]
buffer_load_dwordx4 a[252:255], v1, s[44:47], s63 offen offset:3072 sc1
M v[124:127], v[220:223], a[116:119], v[124:127]
M v[124:127], v[216:219], a[112:115], v[124:127]
ds_read_b64_tr_b16 a[76:77], v13 offset:57344
ds_read_b64_tr_b16 a[78:79], v13 offset:61440
M v[128:131], v[160:163], a[120:123], v[128:131]
M v[128:131], v[164:167], a[124:127], v[128:131]
s_sub_u32 s39, s39, 1
s_cmp_eq_u32 s39, 0
s_cselect_b32 s3, s64, s65
M v[132:135], v[172:175], a[124:127], v[132:135]
M v[132:135], v[168:171], a[120:123], v[132:135]
ds_read_b64_tr_b16 a[80:81], v14 offset:49152
ds_read_b64_tr_b16 a[82:83], v14 offset:53248
M v[136:139], v[176:179], a[120:123], v[136:139]
M v[136:139], v[180:183], a[124:127], v[136:139]
s_add_u32 s25, s25, s3
s_lshl_b32 s3, s3, 3
s_add_u32 s26, s26, s3
M v[140:143], v[188:191], a[124:127], v[140:143]
M v[140:143], v[184:187], a[120:123], v[140:143]
ds_read_b64_tr_b16 a[84:85], v14 offset:57344
ds_read_b64_tr_b16 a[86:87], v14 offset:61440
M v[144:147], v[192:195], a[120:123], v[144:147]
M v[144:147], v[196:199], a[124:127], v[144:147]
ds_read_b64_tr_b16 a[88:89], v15 offset:49152
ds_read_b64_tr_b16 a[90:91], v15 offset:53248
M v[148:151], v[204:207], a[124:127], v[148:151]
M v[148:151], v[200:203], a[120:123], v[148:151]
ds_read_b64_tr_b16 a[92:93], v15 offset:57344
ds_read_b64_tr_b16 a[94:95], v15 offset:61440
M v[152:155], v[208:211], a[120:123], v[152:155]
M v[152:155], v[212:215], a[124:127], v[152:155]
M v[156:159], v[220:223], a[124:127], v[156:159]
M v[156:159], v[216:219], a[120:123], v[156:159]
s_waitcnt vmcnt(24) lgkmcnt(0)
s_barrier
M v[32:35], a[32:35], a[128:131], v[32:35]
s_add_u32 m0, s41, 114688
s_nop 0
buffer_load_dwordx4 v2, s[48:51], s26 offen offset:0 lds
M v[32:35], a[36:39], a[132:135], v[32:35]
M v[36:39], a[44:47], a[132:135], v[36:39]
ds_read_b64_tr_b16 v[160:161], v16 offset:0
ds_read_b64_tr_b16 v[162:163], v16 offset:4096
M v[36:39], a[40:43], a[128:131], v[36:39]
M v[40:43], a[48:51], a[128:131], v[40:43]
buffer_load_dwordx4 v3, s[48:51], s26 offen offset:1024 lds
M v[40:43], a[52:55], a[132:135], v[40:43]
M v[44:47], a[60:63], a[132:135], v[44:47]
ds_read_b64_tr_b16 v[164:165], v16 offset:8192
ds_read_b64_tr_b16 v[166:167], v16 offset:12288
M v[44:47], a[56:59], a[128:131], v[44:47]
M v[48:51], a[64:67], a[128:131], v[48:51]
buffer_load_dwordx4 v4, s[48:51], s26 offen offset:2048 lds
M v[48:51], a[68:71], a[132:135], v[48:51]
M v[52:55], a[76:79], a[132:135], v[52:55]
ds_read_b64_tr_b16 v[168:169], v17 offset:0
ds_read_b64_tr_b16 v[170:171], v17 offset:4096
M v[52:55], a[72:75], a[128:131], v[52:55]
M v[56:59], a[80:83], a[128:131], v[56:59]
buffer_load_dwordx4 v5, s[48:51], s26 offen offset:3072 lds
M v[56:59], a[84:87], a[132:135], v[56:59]
M v[60:63], a[92:95], a[132:135], v[60:63]
ds_read_b64_tr_b16 v[172:173], v17 offset:8192
ds_read_b64_tr_b16 v[174:175], v17 offset:12288
M v[60:63], a[88:91], a[128:131], v[60:63]
M v[64:67], a[32:35], a[136:139], v[64:67]
buffer_load_dwordx4 a[96:99], v1, s[44:47], s25 offen offset:0 sc1
M v[64:67], a[36:39], a[140:143], v[64:67]
M v[68:71], a[44:47], a[140:143], v[68:71]
ds_read_b64_tr_b16 v[176:177], v18 offset:0
ds_read_b64_tr_b16 v[178:179], v18 offset:4096
M v[68:71], a[40:43], a[136:139], v[68:71]
M v[72:75], a[48:51], a[136:139], v[72:75]
buffer_load_dwordx4 a[100:103], v1, s[44:47], s25 offen offset:1024 sc1
M v[72:75], a[52:55], a[140:143], v[72:75]
M v[76:79], a[60:63], a[140:143], v[76:79]
ds_read_b64_tr_b16 v[180:181], v18 offset:8192
ds_read_b64_tr_b16 v[182:183], v18 offset:12288
M v[76:79], a[56:59], a[136:139], v[76:79]
M v[80:83], a[64:67], a[136:139], v[80:83]
buffer_load_dwordx4 a[104:107], v1, s[44:47], s25 offen offset:2048 sc1
M v[80:83], a[68:71], a[140:143], v[80:83]
M v[84:87], a[76:79], a[140:143], v[84:87]
ds_read_b64_tr_b16 v[184:185], v19 offset:0
ds_read_b64_tr_b16 v[186:187], v19 offset:4096
M v[84:87], a[72:75], a[136:139], v[84:87]
M v[88:91], a[80:83], a[136:139], v[88:91]
buffer_load_dwordx4 a[108:111], v1, s[44:47], s25 offen offset:3072 sc1
M v[88:91], a[84:87], a[140:143], v[88:91]
M v[92:95], a[92:95], a[140:143], v[92:95]
M v[92:95], a[88:91], a[136:139], v[92:95]
ds_read_b64_tr_b16 v[188:189], v19 offset:8192
ds_read_b64_tr_b16 v[190:191], v19 offset:12288
M v[96:99], a[32:35], a[144:147], v[96:99]
M v[96:99], a[36:39], a[148:151], v[96:99]
s_add_u32 s63, s25, 4096
buffer_load_dwordx4 a[112:115], v1, s[44:47], s63 offen offset:0 sc1
M v[100:103], a[44:47], a[148:151], v[100:103]
M v[100:103], a[40:43], a[144:147], v[100:103]
ds_read_b64_tr_b16 v[192:193], v20 offset:0
ds_read_b64_tr_b16 v[194:195], v20 offset:4096
M v[104:107], a[48:51], a[144:147], v[104:107]
M v[104:107], a[52:55], a[148:151], v[104:107]
buffer_load_dwordx4 a[116:119], v1, s[44:47], s63 offen offset:1024 sc1
M v[108:111], a[60:63], a[148:151], v[108:111]
M v[108:111], a[56:59], a[144:147], v[108:111]
ds_read_b64_tr_b16 v[196:197], v20 offset:8192
ds_read_b64_tr_b16 v[198:199], v20 offset:12288
M v[112:115], a[64:67], a[144:147], v[112:115]
M v[112:115], a[68:71], a[148:151], v[112:115]
buffer_load_dwordx4 a[120:123], v1, s[44:47], s63 offen offset:2048 sc1
M v[116:119], a[76:79], a[148:151], v[116:119]
M v[116:119], a[72:75], a[144:147], v[116:119]
ds_read_b64_tr_b16 v[200:201], v21 offset:0
ds_read_b64_tr_b16 v[202:203], v21 offset:4096
M v[120:123], a[80:83], a[144:147], v[120:123]
M v[120:123], a[84:87], a[148:151], v[120:123]
buffer_load_dwordx4 a[124:127], v1, s[44:47], s63 offen offset:3072 sc1
M v[124:127], a[92:95], a[148:151], v[124:127]
M v[124:127], a[88:91], a[144:147], v[124:127]
ds_read_b64_tr_b16 v[204:205], v21 offset:8192
ds_read_b64_tr_b16 v[206:207], v21 offset:12288
M v[128:131], a[32:35], a[152:155], v[128:131]
M v[128:131], a[36:39], a[156:159], v[128:131]
s_sub_u32 s39, s39, 1
s_cmp_eq_u32 s39, 0
s_cselect_b32 s3, s64, s65
M v[132:135], a[44:47], a[156:159], v[132:135]
M v[132:135], a[40:43], a[152:155], v[132:135]
ds_read_b64_tr_b16 v[208:209], v22 offset:0
ds_read_b64_tr_b16 v[210:211], v22 offset:4096
M v[136:139], a[48:51], a[152:155], v[136:139]
M v[136:139], a[52:55], a[156:159], v[136:139]
s_add_u32 s25, s25, s3
s_lshl_b32 s3, s3, 3
s_add_u32 s26, s26, s3
M v[140:143], a[60:63], a[156:159], v[140:143]
M v[140:143], a[56:59], a[152:155], v[140:143]
ds_read_b64_tr_b16 v[212:213], v22 offset:8192
ds_read_b64_tr_b16 v[214:215], v22 offset:12288
M v[144:147], a[64:67], a[152:155], v[144:147]
M v[144:147], a[68:71], a[156:159], v[144:147]
ds_read_b64_tr_b16 v[216:217], v23 offset:0
ds_read_b64_tr_b16 v[218:219], v23 offset:4096
M v[148:151], a[76:79], a[156:159], v[148:151]
M v[148:151], a[72:75], a[152:155], v[148:151]
ds_read_b64_tr_b16 v[220:221], v23 offset:8192
ds_read_b64_tr_b16 v[222:223], v23 offset:12288
M v[152:155], a[80:83], a[152:155], v[152:155]
M v[152:155], a[84:87], a[156:159], v[152:155]
M v[156:159], a[92:95], a[156:159], v[156:159]
M v[156:159], a[88:91], a[152:155], v[156:159]
s_waitcnt vmcnt(24) lgkmcnt(0)
s_barrier
M v[32:35], v[160:163], a[160:163], v[32:35]
s_mov_b64 s[44:45], s[34:35]
s_mov_b32 s46, 4194304
s_mov_b64 s[48:49], s[36:37]
s_mov_b32 s50, 2097152
s_mov_b32 s25, s32
s_mov_b32 s26, s33
s_add_u32 m0, s42, 0
s_nop 0
buffer_load_dwordx4 v6, s[48:51], s26 offen offset:0 lds
M v[32:35], v[164:167], a[164:167], v[32:35]
M v[36:39], v[172:175], a[164:167], v[36:39]
ds_read_b64_tr_b16 a[32:33], v16 offset:16384
ds_read_b64_tr_b16 a[34:35], v16 offset:20480
M v[36:39], v[168:171], a[160:163], v[36:39]
M v[40:43], v[176:179], a[160:163], v[40:43]
M v[40:43], v[180:183], a[164:167], v[40:43]
buffer_load_dwordx4 v7, s[48:51], s26 offen offset:1024 lds
M v[44:47], v[188:191], a[164:167], v[44:47]
M v[44:47], v[184:187], a[160:163], v[44:47]
M v[48:51], v[192:195], a[160:163], v[48:51]
ds_read_b64_tr_b16 a[36:37], v16 offset:24576
ds_read_b64_tr_b16 a[38:39], v16 offset:28672
M v[48:51], v[196:199], a[164:167], v[48:51]
M v[52:55], v[204:207], a[164:167], v[52:55]
buffer_load_dwordx4 a[128:131], v1, s[44:47], s25 offen offset:0 sc1
M v[52:55], v[200:203], a[160:163], v[52:55]
M v[56:59], v[208:211], a[160:163], v[56:59]
M v[56:59], v[212:215], a[164:167], v[56:59]
ds_read_b64_tr_b16 a[40:41], v17 offset:16384
ds_read_b64_tr_b16 a[42:43], v17 offset:20480
M v[60:63], v[220:223], a[164:167], v[60:63]
M v[60:63], v[216:219], a[160:163], v[60:63]
M v[64:67], v[160:163], a[168:171], v[64:67]
buffer_load_dwordx4 a[132:135], v1, s[44:47], s25 offen offset:1024 sc1
M v[64:67], v[164:167], a[172:175], v[64:67]
M v[68:71], v[172:175], a[172:175], v[68:71]
ds_read_b64_tr_b16 a[44:45], v17 offset:24576
ds_read_b64_tr_b16 a[46:47], v17 offset:28672
M v[68:71], v[168:171], a[168:171], v[68:71]
M v[72:75], v[176:179], a[168:171], v[72:75]
M v[72:75], v[180:183], a[172:175], v[72:75]
buffer_load_dwordx4 a[136:139], v1, s[44:47], s25 offen offset:2048 sc1
M v[76:79], v[188:191], a[172:175], v[76:79]
M v[76:79], v[184:187], a[168:171], v[76:79]
M v[80:83], v[192:195], a[168:171], v[80:83]
ds_read_b64_tr_b16 a[48:49], v18 offset:16384
ds_read_b64_tr_b16 a[50:51], v18 offset:20480
M v[80:83], v[196:199], a[172:175], v[80:83]
M v[84:87], v[204:207], a[172:175], v[84:87]
buffer_load_dwordx4 a[140:143], v1, s[44:47], s25 offen offset:3072 sc1
M v[84:87], v[200:203], a[168:171], v[84:87]
M v[88:91], v[208:211], a[168:171], v[88:91]
M v[88:91], v[212:215], a[172:175], v[88:91]
ds_read_b64_tr_b16 a[52:53], v18 offset:24576
ds_read_b64_tr_b16 a[54:55], v18 offset:28672
M v[92:95], v[220:223], a[172:175], v[92:95]
M v[92:95], v[216:219], a[168:171], v[92:95]
M v[96:99], v[160:163], a[176:179], v[96:99]
s_add_u32 s25, s25, 16384
s_add_u32 s26, s26, 131072
M v[96:99], v[164:167], a[180:183], v[96:99]
M v[100:103], v[172:175], a[180:183], v[100:103]
M v[100:103], v[168:171], a[176:179], v[100:103]
ds_read_b64_tr_b16 a[56:57], v19 offset:16384
ds_read_b64_tr_b16 a[58:59], v19 offset:20480
M v[104:107], v[176:179], a[176:179], v[104:107]
M v[104:107], v[180:183], a[180:183], v[104:107]
ds_read_b64_tr_b16 a[60:61], v19 offset:24576
ds_read_b64_tr_b16 a[62:63], v19 offset:28672
M v[108:111], v[188:191], a[180:183], v[108:111]
M v[108:111], v[184:187], a[176:179], v[108:111]
M v[112:115], v[192:195], a[176:179], v[112:115]
ds_read_b64_tr_b16 a[64:65], v20 offset:16384
ds_read_b64_tr_b16 a[66:67], v20 offset:20480
M v[112:115], v[196:199], a[180:183], v[112:115]
M v[116:119], v[204:207], a[180:183], v[116:119]
M v[116:119], v[200:203], a[176:179], v[116:119]
ds_read_b64_tr_b16 a[68:69], v20 offset:24576
ds_read_b64_tr_b16 a[70:71], v20 offset:28672
M v[120:123], v[208:211], a[176:179], v[120:123]
M v[120:123], v[212:215], a[180:183], v[120:123]
ds_read_b64_tr_b16 a[72:73], v21 offset:16384
ds_read_b64_tr_b16 a[74:75], v21 offset:20480
M v[124:127], v[220:223], a[180:183], v[124:127]
M v[124:127], v[216:219], a[176:179], v[124:127]
M v[128:131], v[160:163], a[184:187], v[128:131]
ds_read_b64_tr_b16 a[76:77], v21 offset:24576
ds_read_b64_tr_b16 a[78:79], v21 offset:28672
M v[128:131], v[164:167], a[188:191], v[128:131]
M v[132:135], v[172:175], a[188:191], v[132:135]
M v[132:135], v[168:171], a[184:187], v[132:135]
ds_read_b64_tr_b16 a[80:81], v22 offset:16384
ds_read_b64_tr_b16 a[82:83], v22 offset:20480
M v[136:139], v[176:179], a[184:187], v[136:139]
M v[136:139], v[180:183], a[188:191], v[136:139]
ds_read_b64_tr_b16 a[84:85], v22 offset:24576
ds_read_b64_tr_b16 a[86:87], v22 offset:28672
M v[140:143], v[188:191], a[188:191], v[140:143]
M v[140:143], v[184:187], a[184:187], v[140:143]
M v[144:147], v[192:195], a[184:187], v[144:147]
ds_read_b64_tr_b16 a[88:89], v23 offset:16384
ds_read_b64_tr_b16 a[90:91], v23 offset:20480
M v[144:147], v[196:199], a[188:191], v[144:147]
M v[148:151], v[204:207], a[188:191], v[148:151]
M v[148:151], v[200:203], a[184:187], v[148:151]
ds_read_b64_tr_b16 a[92:93], v23 offset:24576
ds_read_b64_tr_b16 a[94:95], v23 offset:28672
M v[152:155], v[208:211], a[184:187], v[152:155]
M v[152:155], v[212:215], a[188:191], v[152:155]
M v[156:159], v[220:223], a[188:191], v[156:159]
M v[156:159], v[216:219], a[184:187], v[156:159]
s_waitcnt vmcnt(18) lgkmcnt(0)
s_barrier
M v[32:35], a[32:35], a[192:195], v[32:35]
s_add_u32 m0, s42, 16384
s_nop 0
buffer_load_dwordx4 v6, s[48:51], s26 offen offset:0 lds
M v[32:35], a[36:39], a[196:199], v[32:35]
M v[36:39], a[44:47], a[196:199], v[36:39]
ds_read_b64_tr_b16 v[160:161], v16 offset:32768
ds_read_b64_tr_b16 v[162:163], v16 offset:36864
M v[36:39], a[40:43], a[192:195], v[36:39]
M v[40:43], a[48:51], a[192:195], v[40:43]
M v[40:43], a[52:55], a[196:199], v[40:43]
buffer_load_dwordx4 v7, s[48:51], s26 offen offset:1024 lds
M v[44:47], a[60:63], a[196:199], v[44:47]
M v[44:47], a[56:59], a[192:195], v[44:47]
M v[48:51], a[64:67], a[192:195], v[48:51]
ds_read_b64_tr_b16 v[164:165], v16 offset:40960
ds_read_b64_tr_b16 v[166:167], v16 offset:45056
M v[48:51], a[68:71], a[196:199], v[48:51]
M v[52:55], a[76:79], a[196:199], v[52:55]
buffer_load_dwordx4 a[160:163], v1, s[44:47], s25 offen offset:0 sc1
M v[52:55], a[72:75], a[192:195], v[52:55]
M v[56:59], a[80:83], a[192:195], v[56:59]
M v[56:59], a[84:87], a[196:199], v[56:59]
ds_read_b64_tr_b16 v[168:169], v17 offset:32768
ds_read_b64_tr_b16 v[170:171], v17 offset:36864
M v[60:63], a[92:95], a[196:199], v[60:63]
M v[60:63], a[88:91], a[192:195], v[60:63]
M v[64:67], a[32:35], a[200:203], v[64:67]
buffer_load_dwordx4 a[164:167], v1, s[44:47], s25 offen offset:1024 sc1
M v[64:67], a[36:39], a[204:207], v[64:67]
M v[68:71], a[44:47], a[204:207], v[68:71]
ds_read_b64_tr_b16 v[172:173], v17 offset:40960
ds_read_b64_tr_b16 v[174:175], v17 offset:45056
M v[68:71], a[40:43], a[200:203], v[68:71]
M v[72:75], a[48:51], a[200:203], v[72:75]
M v[72:75], a[52:55], a[204:207], v[72:75]
buffer_load_dwordx4 a[168:171], v1, s[44:47], s25 offen offset:2048 sc1
M v[76:79], a[60:63], a[204:207], v[76:79]
M v[76:79], a[56:59], a[200:203], v[76:79]
M v[80:83], a[64:67], a[200:203], v[80:83]
ds_read_b64_tr_b16 v[176:177], v18 offset:32768
ds_read_b64_tr_b16 v[178:179], v18 offset:36864
M v[80:83], a[68:71], a[204:207], v[80:83]
M v[84:87], a[76:79], a[204:207], v[84:87]
buffer_load_dwordx4 a[172:175], v1, s[44:47], s25 offen offset:3072 sc1
M v[84:87], a[72:75], a[200:203], v[84:87]
M v[88:91], a[80:83], a[200:203], v[88:91]
M v[88:91], a[84:87], a[204:207], v[88:91]
ds_read_b64_tr_b16 v[180:181], v18 offset:40960
ds_read_b64_tr_b16 v[182:183], v18 offset:45056
M v[92:95], a[92:95], a[204:207], v[92:95]
M v[92:95], a[88:91], a[200:203], v[92:95]
M v[96:99], a[32:35], a[208:211], v[96:99]
s_add_u32 s25, s25, 16384
s_add_u32 s26, s26, 131072
M v[96:99], a[36:39], a[212:215], v[96:99]
M v[100:103], a[44:47], a[212:215], v[100:103]
M v[100:103], a[40:43], a[208:211], v[100:103]
ds_read_b64_tr_b16 v[184:185], v19 offset:32768
ds_read_b64_tr_b16 v[186:187], v19 offset:36864
M v[104:107], a[48:51], a[208:211], v[104:107]
M v[104:107], a[52:55], a[212:215], v[104:107]
ds_read_b64_tr_b16 v[188:189], v19 offset:40960
ds_read_b64_tr_b16 v[190:191], v19 offset:45056
M v[108:111], a[60:63], a[212:215], v[108:111]
M v[108:111], a[56:59], a[208:211], v[108:111]
M v[112:115], a[64:67], a[208:211], v[112:115]
ds_read_b64_tr_b16 v[192:193], v20 offset:32768
ds_read_b64_tr_b16 v[194:195], v20 offset:36864
M v[112:115], a[68:71], a[212:215], v[112:115]
M v[116:119], a[76:79], a[212:215], v[116:119]
M v[116:119], a[72:75], a[208:211], v[116:119]
ds_read_b64_tr_b16 v[196:197], v20 offset:40960
ds_read_b64_tr_b16 v[198:199], v20 offset:45056
M v[120:123], a[80:83], a[208:211], v[120:123]
M v[120:123], a[84:87], a[212:215], v[120:123]
ds_read_b64_tr_b16 v[200:201], v21 offset:32768
ds_read_b64_tr_b16 v[202:203], v21 offset:36864
M v[124:127], a[92:95], a[212:215], v[124:127]
M v[124:127], a[88:91], a[208:211], v[124:127]
M v[128:131], a[32:35], a[216:219], v[128:131]
ds_read_b64_tr_b16 v[204:205], v21 offset:40960
ds_read_b64_tr_b16 v[206:207], v21 offset:45056
M v[128:131], a[36:39], a[220:223], v[128:131]
M v[132:135], a[44:47], a[220:223], v[132:135]
M v[132:135], a[40:43], a[216:219], v[132:135]
ds_read_b64_tr_b16 v[208:209], v22 offset:32768
ds_read_b64_tr_b16 v[210:211], v22 offset:36864
M v[136:139], a[48:51], a[216:219], v[136:139]
M v[136:139], a[52:55], a[220:223], v[136:139]
ds_read_b64_tr_b16 v[212:213], v22 offset:40960
ds_read_b64_tr_b16 v[214:215], v22 offset:45056
M v[140:143], a[60:63], a[220:223], v[140:143]
M v[140:143], a[56:59], a[216:219], v[140:143]
M v[144:147], a[64:67], a[216:219], v[144:147]
ds_read_b64_tr_b16 v[216:217], v23 offset:32768
ds_read_b64_tr_b16 v[218:219], v23 offset:36864
M v[144:147], a[68:71], a[220:223], v[144:147]
M v[148:151], a[76:79], a[220:223], v[148:151]
M v[148:151], a[72:75], a[216:219], v[148:151]
ds_read_b64_tr_b16 v[220:221], v23 offset:40960
ds_read_b64_tr_b16 v[222:223], v23 offset:45056
M v[152:155], a[80:83], a[216:219], v[152:155]
M v[152:155], a[84:87], a[220:223], v[152:155]
M v[156:159], a[92:95], a[220:223], v[156:159]
M v[156:159], a[88:91], a[216:219], v[156:159]
s_waitcnt vmcnt(12) lgkmcnt(0)
s_barrier
M v[32:35], v[160:163], a[224:227], v[32:35]
s_add_u32 m0, s42, 32768
s_nop 0
buffer_load_dwordx4 v6, s[48:51], s26 offen offset:0 lds
M v[32:35], v[164:167], a[228:231], v[32:35]
M v[36:39], v[172:175], a[228:231], v[36:39]
ds_read_b64_tr_b16 a[32:33], v16 offset:49152
ds_read_b64_tr_b16 a[34:35], v16 offset:53248
M v[36:39], v[168:171], a[224:227], v[36:39]
M v[40:43], v[176:179], a[224:227], v[40:43]
M v[40:43], v[180:183], a[228:231], v[40:43]
buffer_load_dwordx4 v7, s[48:51], s26 offen offset:1024 lds
M v[44:47], v[188:191], a[228:231], v[44:47]
M v[44:47], v[184:187], a[224:227], v[44:47]
M v[48:51], v[192:195], a[224:227], v[48:51]
ds_read_b64_tr_b16 a[36:37], v16 offset:57344
ds_read_b64_tr_b16 a[38:39], v16 offset:61440
M v[48:51], v[196:199], a[228:231], v[48:51]
M v[52:55], v[204:207], a[228:231], v[52:55]
buffer_load_dwordx4 a[192:195], v1, s[44:47], s25 offen offset:0 sc1
M v[52:55], v[200:203], a[224:227], v[52:55]
M v[56:59], v[208:211], a[224:227], v[56:59]
M v[56:59], v[212:215], a[228:231], v[56:59]
ds_read_b64_tr_b16 a[40:41], v17 offset:49152
ds_read_b64_tr_b16 a[42:43], v17 offset:53248
M v[60:63], v[220:223], a[228:231], v[60:63]
M v[60:63], v[216:219], a[224:227], v[60:63]
M v[64:67], v[160:163], a[232:235], v[64:67]
buffer_load_dwordx4 a[196:199], v1, s[44:47], s25 offen offset:1024 sc1
M v[64:67], v[164:167], a[236:239], v[64:67]
M v[68:71], v[172:175], a[236:239], v[68:71]
ds_read_b64_tr_b16 a[44:45], v17 offset:57344
ds_read_b64_tr_b16 a[46:47], v17 offset:61440
M v[68:71], v[168:171], a[232:235], v[68:71]
M v[72:75], v[176:179], a[232:235], v[72:75]
M v[72:75], v[180:183], a[236:239], v[72:75]
buffer_load_dwordx4 a[200:203], v1, s[44:47], s25 offen offset:2048 sc1
M v[76:79], v[188:191], a[236:239], v[76:79]
M v[76:79], v[184:187], a[232:235], v[76:79]
M v[80:83], v[192:195], a[232:235], v[80:83]
ds_read_b64_tr_b16 a[48:49], v18 offset:49152
ds_read_b64_tr_b16 a[50:51], v18 offset:53248
M v[80:83], v[196:199], a[236:239], v[80:83]
M v[84:87], v[204:207], a[236:239], v[84:87]
buffer_load_dwordx4 a[204:207], v1, s[44:47], s25 offen offset:3072 sc1
M v[84:87], v[200:203], a[232:235], v[84:87]
M v[88:91], v[208:211], a[232:235], v[88:91]
M v[88:91], v[212:215], a[236:239], v[88:91]
ds_read_b64_tr_b16 a[52:53], v18 offset:57344
ds_read_b64_tr_b16 a[54:55], v18 offset:61440
M v[92:95], v[220:223], a[236:239], v[92:95]
M v[92:95], v[216:219], a[232:235], v[92:95]
M v[96:99], v[160:163], a[240:243], v[96:99]
s_add_u32 s25, s25, 16384
s_add_u32 s26, s26, 131072
M v[96:99], v[164:167], a[244:247], v[96:99]
M v[100:103], v[172:175], a[244:247], v[100:103]
M v[100:103], v[168:171], a[240:243], v[100:103]
ds_read_b64_tr_b16 a[56:57], v19 offset:49152
ds_read_b64_tr_b16 a[58:59], v19 offset:53248
M v[104:107], v[176:179], a[240:243], v[104:107]
M v[104:107], v[180:183], a[244:247], v[104:107]
ds_read_b64_tr_b16 a[60:61], v19 offset:57344
ds_read_b64_tr_b16 a[62:63], v19 offset:61440
M v[108:111], v[188:191], a[244:247], v[108:111]
M v[108:111], v[184:187], a[240:243], v[108:111]
M v[112:115], v[192:195], a[240:243], v[112:115]
ds_read_b64_tr_b16 a[64:65], v20 offset:49152
ds_read_b64_tr_b16 a[66:67], v20 offset:53248
M v[112:115], v[196:199], a[244:247], v[112:115]
M v[116:119], v[204:207], a[244:247], v[116:119]
M v[116:119], v[200:203], a[240:243], v[116:119]
ds_read_b64_tr_b16 a[68:69], v20 offset:57344
ds_read_b64_tr_b16 a[70:71], v20 offset:61440
M v[120:123], v[208:211], a[240:243], v[120:123]
M v[120:123], v[212:215], a[244:247], v[120:123]
ds_read_b64_tr_b16 a[72:73], v21 offset:49152
ds_read_b64_tr_b16 a[74:75], v21 offset:53248
M v[124:127], v[220:223], a[244:247], v[124:127]
M v[124:127], v[216:219], a[240:243], v[124:127]
M v[128:131], v[160:163], a[248:251], v[128:131]
ds_read_b64_tr_b16 a[76:77], v21 offset:57344
ds_read_b64_tr_b16 a[78:79], v21 offset:61440
M v[128:131], v[164:167], a[252:255], v[128:131]
M v[132:135], v[172:175], a[252:255], v[132:135]
M v[132:135], v[168:171], a[248:251], v[132:135]
ds_read_b64_tr_b16 a[80:81], v22 offset:49152
ds_read_b64_tr_b16 a[82:83], v22 offset:53248
M v[136:139], v[176:179], a[248:251], v[136:139]
M v[136:139], v[180:183], a[252:255], v[136:139]
ds_read_b64_tr_b16 a[84:85], v22 offset:57344
ds_read_b64_tr_b16 a[86:87], v22 offset:61440
M v[140:143], v[188:191], a[252:255], v[140:143]
M v[140:143], v[184:187], a[248:251], v[140:143]
M v[144:147], v[192:195], a[248:251], v[144:147]
ds_read_b64_tr_b16 a[88:89], v23 offset:49152
ds_read_b64_tr_b16 a[90:91], v23 offset:53248
M v[144:147], v[196:199], a[252:255], v[144:147]
M v[148:151], v[204:207], a[252:255], v[148:151]
M v[148:151], v[200:203], a[248:251], v[148:151]
ds_read_b64_tr_b16 a[92:93], v23 offset:57344
ds_read_b64_tr_b16 a[94:95], v23 offset:61440
M v[152:155], v[208:211], a[248:251], v[152:155]
M v[152:155], v[212:215], a[252:255], v[152:155]
M v[156:159], v[220:223], a[252:255], v[156:159]
M v[156:159], v[216:219], a[248:251], v[156:159]
s_waitcnt vmcnt(12) lgkmcnt(0)
s_barrier
M v[32:35], a[32:35], a[96:99], v[32:35]
s_add_u32 m0, s42, 49152
s_nop 0
buffer_load_dwordx4 v6, s[48:51], s26 offen offset:0 lds
M v[32:35], a[36:39], a[100:103], v[32:35]
M v[36:39], a[44:47], a[100:103], v[36:39]
M v[36:39], a[40:43], a[96:99], v[36:39]
M v[40:43], a[48:51], a[96:99], v[40:43]
ds_read_b64_tr_b16 v[160:161], v24 offset:0
ds_read_b64_tr_b16 v[162:163], v24 offset:2048
M v[40:43], a[52:55], a[100:103], v[40:43]
M v[44:47], a[60:63], a[100:103], v[44:47]
M v[44:47], a[56:59], a[96:99], v[44:47]
M v[48:51], a[64:67], a[96:99], v[48:51]
buffer_load_dwordx4 v7, s[48:51], s26 offen offset:1024 lds
M v[48:51], a[68:71], a[100:103], v[48:51]
M v[52:55], a[76:79], a[100:103], v[52:55]
M v[52:55], a[72:75], a[96:99], v[52:55]
M v[56:59], a[80:83], a[96:99], v[56:59]
ds_read_b64_tr_b16 v[164:165], v24 offset:4096
ds_read_b64_tr_b16 v[166:167], v24 offset:6144
M v[56:59], a[84:87], a[100:103], v[56:59]
M v[60:63], a[92:95], a[100:103], v[60:63]
M v[60:63], a[88:91], a[96:99], v[60:63]
M v[64:67], a[32:35], a[104:107], v[64:67]
buffer_load_dwordx4 a[224:227], v1, s[44:47], s25 offen offset:0 sc1
M v[64:67], a[36:39], a[108:111], v[64:67]
M v[68:71], a[44:47], a[108:111], v[68:71]
v_cvt_pk_bf16_f32 v40, v40, v41
v_cvt_pk_bf16_f32 v41, v42, v43
M v[68:71], a[40:43], a[104:107], v[68:71]
v_cvt_pk_bf16_f32 v42, v44, v45
v_cvt_pk_bf16_f32 v43, v46, v47
M v[72:75], a[48:51], a[104:107], v[72:75]
ds_read_b64_tr_b16 v[168:169], v25 offset:0
ds_read_b64_tr_b16 v[170:171], v25 offset:2048
M v[72:75], a[52:55], a[108:111], v[72:75]
s_add_u32 s60, s56, 4096
buffer_store_dwordx4 v[40:43], v1, s[52:55], s60 offen offset:0 sc1
M v[76:79], a[60:63], a[108:111], v[76:79]
M v[76:79], a[56:59], a[104:107], v[76:79]
v_cvt_pk_bf16_f32 v48, v48, v49
v_cvt_pk_bf16_f32 v49, v50, v51
M v[80:83], a[64:67], a[104:107], v[80:83]
buffer_load_dwordx4 a[228:231], v1, s[44:47], s25 offen offset:1024 sc1
v_cvt_pk_bf16_f32 v50, v52, v53
v_cvt_pk_bf16_f32 v51, v54, v55
M v[80:83], a[68:71], a[108:111], v[80:83]
M v[84:87], a[76:79], a[108:111], v[84:87]
s_add_u32 s60, s56, 8192
buffer_store_dwordx4 v[48:51], v1, s[52:55], s60 offen offset:0 sc1
M v[84:87], a[72:75], a[104:107], v[84:87]
M v[88:91], a[80:83], a[104:107], v[88:91]
ds_read_b64_tr_b16 v[172:173], v25 offset:4096
ds_read_b64_tr_b16 v[174:175], v25 offset:6144
v_cvt_pk_bf16_f32 v56, v56, v57
v_cvt_pk_bf16_f32 v57, v58, v59
M v[88:91], a[84:87], a[108:111], v[88:91]
v_cvt_pk_bf16_f32 v58, v60, v61
v_cvt_pk_bf16_f32 v59, v62, v63
M v[92:95], a[92:95], a[108:111], v[92:95]
M v[92:95], a[88:91], a[104:107], v[92:95]
s_add_u32 s60, s56, 12288
buffer_store_dwordx4 v[56:59], v1, s[52:55], s60 offen offset:0 sc1
M v[96:99], a[32:35], a[112:115], v[96:99]
M v[96:99], a[36:39], a[116:119], v[96:99]
buffer_load_dwordx4 a[232:235], v1, s[44:47], s25 offen offset:2048 sc1
M v[100:103], a[44:47], a[116:119], v[100:103]
v_cvt_pk_bf16_f32 v72, v72, v73
v_cvt_pk_bf16_f32 v73, v74, v75
M v[100:103], a[40:43], a[112:115], v[100:103]
v_cvt_pk_bf16_f32 v74, v76, v77
v_cvt_pk_bf16_f32 v75, v78, v79
M v[104:107], a[48:51], a[112:115], v[104:107]
M v[104:107], a[52:55], a[116:119], v[104:107]
ds_read_b64_tr_b16 v[176:177], v26 offset:0
ds_read_b64_tr_b16 v[178:179], v26 offset:2048
s_add_u32 s60, s56, 4096
buffer_store_dwordx4 v[72:75], v1, s[52:55], s60 offen offset:1024 sc1
M v[108:111], a[60:63], a[116:119], v[108:111]
M v[108:111], a[56:59], a[112:115], v[108:111]
v_cvt_pk_bf16_f32 v80, v80, v81
v_cvt_pk_bf16_f32 v81, v82, v83
M v[112:115], a[64:67], a[112:115], v[112:115]
v_cvt_pk_bf16_f32 v82, v84, v85
v_cvt_pk_bf16_f32 v83, v86, v87
M v[112:115], a[68:71], a[116:119], v[112:115]
buffer_load_dwordx4 a[236:239], v1, s[44:47], s25 offen offset:3072 sc1
M v[116:119], a[76:79], a[116:119], v[116:119]
s_add_u32 s60, s56, 8192
buffer_store_dwordx4 v[80:83], v1, s[52:55], s60 offen offset:1024 sc1
M v[116:119], a[72:75], a[112:115], v[116:119]
M v[120:123], a[80:83], a[112:115], v[120:123]
v_cvt_pk_bf16_f32 v88, v88, v89
v_cvt_pk_bf16_f32 v89, v90, v91
M v[120:123], a[84:87], a[116:119], v[120:123]
ds_read_b64_tr_b16 v[180:181], v26 offset:4096
ds_read_b64_tr_b16 v[182:183], v26 offset:6144
v_cvt_pk_bf16_f32 v90, v92, v93
v_cvt_pk_bf16_f32 v91, v94, v95
M v[124:127], a[92:95], a[116:119], v[124:127]
M v[124:127], a[88:91], a[112:115], v[124:127]
s_add_u32 s60, s56, 12288
buffer_store_dwordx4 v[88:91], v1, s[52:55], s60 offen offset:1024 sc1
M v[128:131], a[32:35], a[120:123], v[128:131]
M v[128:131], a[36:39], a[124:127], v[128:131]
s_add_u32 s25, s25, 16384
s_add_u32 s26, s26, 131072
M v[132:135], a[44:47], a[124:127], v[132:135]
v_cvt_pk_bf16_f32 v104, v104, v105
v_cvt_pk_bf16_f32 v105, v106, v107
M v[132:135], a[40:43], a[120:123], v[132:135]
v_cvt_pk_bf16_f32 v106, v108, v109
v_cvt_pk_bf16_f32 v107, v110, v111
M v[136:139], a[48:51], a[120:123], v[136:139]
M v[136:139], a[52:55], a[124:127], v[136:139]
ds_read_b64_tr_b16 v[184:185], v27 offset:0
ds_read_b64_tr_b16 v[186:187], v27 offset:2048
s_add_u32 s60, s56, 4096
buffer_store_dwordx4 v[104:107], v1, s[52:55], s60 offen offset:2048 sc1
M v[140:143], a[60:63], a[124:127], v[140:143]
M v[140:143], a[56:59], a[120:123], v[140:143]
v_cvt_pk_bf16_f32 v112, v112, v113
v_cvt_pk_bf16_f32 v113, v114, v115
M v[144:147], a[64:67], a[120:123], v[144:147]
v_cvt_pk_bf16_f32 v114, v116, v117
v_cvt_pk_bf16_f32 v115, v118, v119
M v[144:147], a[68:71], a[124:127], v[144:147]
ds_read_b64_tr_b16 v[188:189], v27 offset:4096
ds_read_b64_tr_b16 v[190:191], v27 offset:6144
M v[148:151], a[76:79], a[124:127], v[148:151]
s_add_u32 s60, s56, 8192
buffer_store_dwordx4 v[112:115], v1, s[52:55], s60 offen offset:2048 sc1
M v[148:151], a[72:75], a[120:123], v[148:151]
M v[152:155], a[80:83], a[120:123], v[152:155]
v_cvt_pk_bf16_f32 v120, v120, v121
v_cvt_pk_bf16_f32 v121, v122, v123
M v[152:155], a[84:87], a[124:127], v[152:155]
v_cvt_pk_bf16_f32 v122, v124, v125
v_cvt_pk_bf16_f32 v123, v126, v127
M v[156:159], a[92:95], a[124:127], v[156:159]
M v[156:159], a[88:91], a[120:123], v[156:159]
s_add_u32 s60, s56, 12288
buffer_store_dwordx4 v[120:123], v1, s[52:55], s60 offen offset:2048 sc1
s_waitcnt vmcnt(21) lgkmcnt(0)
s_barrier
M a[0:3], v[160:163], a[128:131], a[0:3]
s_add_u32 m0, s42, 65536
s_nop 0
buffer_load_dwordx4 v6, s[48:51], s26 offen offset:0 lds
ds_read_b64_tr_b16 a[32:33], v24 offset:16384
ds_read_b64_tr_b16 a[34:35], v24 offset:18432
M a[0:3], v[164:167], a[132:135], a[0:3]
buffer_load_dwordx4 v7, s[48:51], s26 offen offset:1024 lds
M a[4:7], v[172:175], a[132:135], a[4:7]
ds_read_b64_tr_b16 a[36:37], v24 offset:20480
ds_read_b64_tr_b16 a[38:39], v24 offset:22528
buffer_load_dwordx4 a[96:99], v1, s[44:47], s25 offen offset:0 sc1
M a[4:7], v[168:171], a[128:131], a[4:7]
ds_read_b64_tr_b16 a[40:41], v25 offset:16384
ds_read_b64_tr_b16 a[42:43], v25 offset:18432
M a[8:11], v[176:179], a[128:131], a[8:11]
buffer_load_dwordx4 a[100:103], v1, s[44:47], s25 offen offset:1024 sc1
M a[8:11], v[180:183], a[132:135], a[8:11]
ds_read_b64_tr_b16 a[44:45], v25 offset:20480
ds_read_b64_tr_b16 a[46:47], v25 offset:22528
buffer_load_dwordx4 a[104:107], v1, s[44:47], s25 offen offset:2048 sc1
M a[12:15], v[188:191], a[132:135], a[12:15]
ds_read_b64_tr_b16 a[48:49], v26 offset:16384
ds_read_b64_tr_b16 a[50:51], v26 offset:18432
M a[12:15], v[184:187], a[128:131], a[12:15]
buffer_load_dwordx4 a[108:111], v1, s[44:47], s25 offen offset:3072 sc1
M a[16:19], v[160:163], a[136:139], a[16:19]
ds_read_b64_tr_b16 a[52:53], v26 offset:20480
ds_read_b64_tr_b16 a[54:55], v26 offset:22528
s_add_u32 s25, s25, 16384
s_add_u32 s26, s26, 131072
M a[16:19], v[164:167], a[140:143], a[16:19]
ds_read_b64_tr_b16 a[56:57], v27 offset:16384
ds_read_b64_tr_b16 a[58:59], v27 offset:18432
M a[20:23], v[172:175], a[140:143], a[20:23]
v_cvt_pk_bf16_f32 v136, v136, v137
v_cvt_pk_bf16_f32 v137, v138, v139
v_cvt_pk_bf16_f32 v138, v140, v141
v_cvt_pk_bf16_f32 v139, v142, v143
s_add_u32 s60, s56, 4096
buffer_store_dwordx4 v[136:139], v1, s[52:55], s60 offen offset:3072 sc1
M a[20:23], v[168:171], a[136:139], a[20:23]
ds_read_b64_tr_b16 a[60:61], v27 offset:20480
ds_read_b64_tr_b16 a[62:63], v27 offset:22528
v_cvt_pk_bf16_f32 v144, v144, v145
v_cvt_pk_bf16_f32 v145, v146, v147
v_cvt_pk_bf16_f32 v146, v148, v149
v_cvt_pk_bf16_f32 v147, v150, v151
s_add_u32 s60, s56, 8192
buffer_store_dwordx4 v[144:147], v1, s[52:55], s60 offen offset:3072 sc1
M a[24:27], v[176:179], a[136:139], a[24:27]
v_cvt_pk_bf16_f32 v152, v152, v153
v_cvt_pk_bf16_f32 v153, v154, v155
v_cvt_pk_bf16_f32 v154, v156, v157
v_cvt_pk_bf16_f32 v155, v158, v159
s_add_u32 s60, s56, 12288
buffer_store_dwordx4 v[152:155], v1, s[52:55], s60 offen offset:3072 sc1
M a[24:27], v[180:183], a[140:143], a[24:27]
v_and_b32 v11, 3, v0
v_lshlrev_b32 v11, 4, v11
M a[28:31], v[188:191], a[140:143], a[28:31]
M a[28:31], v[184:187], a[136:139], a[28:31]
s_waitcnt vmcnt(24) lgkmcnt(0)
s_barrier
s_waitcnt vmcnt(0)
s_mov_b64 exec, 1
buffer_store_dword v254, v253, s[52:55], s58 offen sc1
s_mov_b64 exec, -1
M a[0:3], a[32:35], a[160:163], a[0:3]
s_add_u32 m0, s42, 81920
s_nop 0
buffer_load_dwordx4 v6, s[48:51], s26 offen offset:0 lds
ds_read_b64_tr_b16 v[160:161], v24 offset:32768
ds_read_b64_tr_b16 v[162:163], v24 offset:34816
M a[0:3], a[36:39], a[164:167], a[0:3]
buffer_load_dwordx4 v7, s[48:51], s26 offen offset:1024 lds
M a[4:7], a[44:47], a[164:167], a[4:7]
ds_read_b64_tr_b16 v[164:165], v24 offset:36864
ds_read_b64_tr_b16 v[166:167], v24 offset:38912
M a[4:7], a[40:43], a[160:163], a[4:7]
buffer_load_dwordx4 a[128:131], v1, s[44:47], s25 offen offset:0 sc1
M a[8:11], a[48:51], a[160:163], a[8:11]
ds_read_b64_tr_b16 v[168:169], v25 offset:32768
ds_read_b64_tr_b16 v[170:171], v25 offset:34816
M a[8:11], a[52:55], a[164:167], a[8:11]
buffer_load_dwordx4 a[132:135], v1, s[44:47], s25 offen offset:1024 sc1
M a[12:15], a[60:63], a[164:167], a[12:15]
ds_read_b64_tr_b16 v[172:173], v25 offset:36864
ds_read_b64_tr_b16 v[174:175], v25 offset:38912
M a[12:15], a[56:59], a[160:163], a[12:15]
buffer_load_dwordx4 a[136:139], v1, s[44:47], s25 offen offset:2048 sc1
M a[16:19], a[32:35], a[168:171], a[16:19]
ds_read_b64_tr_b16 v[176:177], v26 offset:32768
ds_read_b64_tr_b16 v[178:179], v26 offset:34816
M a[16:19], a[36:39], a[172:175], a[16:19]
buffer_load_dwordx4 a[140:143], v1, s[44:47], s25 offen offset:3072 sc1
M a[20:23], a[44:47], a[172:175], a[20:23]
ds_read_b64_tr_b16 v[180:181], v26 offset:36864
ds_read_b64_tr_b16 v[182:183], v26 offset:38912
M a[20:23], a[40:43], a[168:171], a[20:23]
s_add_u32 s25, s25, 16384
s_add_u32 s26, s26, 131072
M a[24:27], a[48:51], a[168:171], a[24:27]
ds_read_b64_tr_b16 v[184:185], v27 offset:32768
ds_read_b64_tr_b16 v[186:187], v27 offset:34816
M a[24:27], a[52:55], a[172:175], a[24:27]
ds_read_b64_tr_b16 v[188:189], v27 offset:36864
ds_read_b64_tr_b16 v[190:191], v27 offset:38912
M a[28:31], a[60:63], a[172:175], a[28:31]
M a[28:31], a[56:59], a[168:171], a[28:31]
s_waitcnt vmcnt(21) lgkmcnt(0)
s_barrier
M a[0:3], v[160:163], a[192:195], a[0:3]
s_add_u32 m0, s42, 98304
s_nop 0
buffer_load_dwordx4 v6, s[48:51], s26 offen offset:0 lds
ds_read_b64_tr_b16 a[32:33], v24 offset:49152
ds_read_b64_tr_b16 a[34:35], v24 offset:51200
M a[0:3], v[164:167], a[196:199], a[0:3]
buffer_load_dwordx4 v7, s[48:51], s26 offen offset:1024 lds
M a[4:7], v[172:175], a[196:199], a[4:7]
ds_read_b64_tr_b16 a[36:37], v24 offset:53248
ds_read_b64_tr_b16 a[38:39], v24 offset:55296
M a[4:7], v[168:171], a[192:195], a[4:7]
buffer_load_dwordx4 a[160:163], v1, s[44:47], s25 offen offset:0 sc1
M a[8:11], v[176:179], a[192:195], a[8:11]
ds_read_b64_tr_b16 a[40:41], v25 offset:49152
ds_read_b64_tr_b16 a[42:43], v25 offset:51200
M a[8:11], v[180:183], a[196:199], a[8:11]
buffer_load_dwordx4 a[164:167], v1, s[44:47], s25 offen offset:1024 sc1
M a[12:15], v[188:191], a[196:199], a[12:15]
ds_read_b64_tr_b16 a[44:45], v25 offset:53248
ds_read_b64_tr_b16 a[46:47], v25 offset:55296
M a[12:15], v[184:187], a[192:195], a[12:15]
buffer_load_dwordx4 a[168:171], v1, s[44:47], s25 offen offset:2048 sc1
M a[16:19], v[160:163], a[200:203], a[16:19]
ds_read_b64_tr_b16 a[48:49], v26 offset:49152
ds_read_b64_tr_b16 a[50:51], v26 offset:51200
M a[16:19], v[164:167], a[204:207], a[16:19]
buffer_load_dwordx4 a[172:175], v1, s[44:47], s25 offen offset:3072 sc1
M a[20:23], v[172:175], a[204:207], a[20:23]
ds_read_b64_tr_b16 a[52:53], v26 offset:53248
ds_read_b64_tr_b16 a[54:55], v26 offset:55296
M a[20:23], v[168:171], a[200:203], a[20:23]
s_add_u32 s25, s25, 16384
s_add_u32 s26, s26, 131072
M a[24:27], v[176:179], a[200:203], a[24:27]
ds_read_b64_tr_b16 a[56:57], v27 offset:49152
ds_read_b64_tr_b16 a[58:59], v27 offset:51200
M a[24:27], v[180:183], a[204:207], a[24:27]
ds_read_b64_tr_b16 a[60:61], v27 offset:53248
ds_read_b64_tr_b16 a[62:63], v27 offset:55296
M a[28:31], v[188:191], a[204:207], a[28:31]
M a[28:31], v[184:187], a[200:203], a[28:31]
s_waitcnt vmcnt(16) lgkmcnt(0)
s_barrier
M a[0:3], a[32:35], a[224:227], a[0:3]
s_add_u32 m0, s42, 114688
s_nop 0
buffer_load_dwordx4 v6, s[48:51], s26 offen offset:0 lds
ds_read_b64_tr_b16 v[160:161], v28 offset:0
ds_read_b64_tr_b16 v[162:163], v28 offset:2048
M a[0:3], a[36:39], a[228:231], a[0:3]
buffer_load_dwordx4 v7, s[48:51], s26 offen offset:1024 lds
M a[4:7], a[44:47], a[228:231], a[4:7]
ds_read_b64_tr_b16 v[164:165], v28 offset:4096
ds_read_b64_tr_b16 v[166:167], v28 offset:6144
M a[4:7], a[40:43], a[224:227], a[4:7]
buffer_load_dwordx4 a[192:195], v1, s[44:47], s25 offen offset:0 sc1
M a[8:11], a[48:51], a[224:227], a[8:11]
ds_read_b64_tr_b16 v[168:169], v29 offset:0
ds_read_b64_tr_b16 v[170:171], v29 offset:2048
M a[8:11], a[52:55], a[228:231], a[8:11]
buffer_load_dwordx4 a[196:199], v1, s[44:47], s25 offen offset:1024 sc1
M a[12:15], a[60:63], a[228:231], a[12:15]
ds_read_b64_tr_b16 v[172:173], v29 offset:4096
ds_read_b64_tr_b16 v[174:175], v29 offset:6144
M a[12:15], a[56:59], a[224:227], a[12:15]
buffer_load_dwordx4 a[200:203], v1, s[44:47], s25 offen offset:2048 sc1
M a[16:19], a[32:35], a[232:235], a[16:19]
ds_read_b64_tr_b16 v[176:177], v30 offset:0
ds_read_b64_tr_b16 v[178:179], v30 offset:2048
M a[16:19], a[36:39], a[236:239], a[16:19]
buffer_load_dwordx4 a[204:207], v1, s[44:47], s25 offen offset:3072 sc1
M a[20:23], a[44:47], a[236:239], a[20:23]
ds_read_b64_tr_b16 v[180:181], v30 offset:4096
ds_read_b64_tr_b16 v[182:183], v30 offset:6144
M a[20:23], a[40:43], a[232:235], a[20:23]
s_add_u32 s25, s25, 16384
s_add_u32 s26, s26, 131072
M a[24:27], a[48:51], a[232:235], a[24:27]
ds_read_b64_tr_b16 v[184:185], v31 offset:0
ds_read_b64_tr_b16 v[186:187], v31 offset:2048
M a[24:27], a[52:55], a[236:239], a[24:27]
ds_read_b64_tr_b16 v[188:189], v31 offset:4096
ds_read_b64_tr_b16 v[190:191], v31 offset:6144
M a[28:31], a[60:63], a[236:239], a[28:31]
M a[28:31], a[56:59], a[232:235], a[28:31]
s_waitcnt vmcnt(12) lgkmcnt(0)
s_barrier
M a[0:3], v[160:163], a[96:99], a[0:3]
s_add_u32 m0, s42, 0
s_nop 0
buffer_load_dwordx4 v6, s[48:51], s26 offen offset:0 lds
ds_read_b64_tr_b16 a[32:33], v28 offset:16384
ds_read_b64_tr_b16 a[34:35], v28 offset:18432
M a[0:3], v[164:167], a[100:103], a[0:3]
buffer_load_dwordx4 v7, s[48:51], s26 offen offset:1024 lds
M a[4:7], v[172:175], a[100:103], a[4:7]
ds_read_b64_tr_b16 a[36:37], v28 offset:20480
ds_read_b64_tr_b16 a[38:39], v28 offset:22528
M a[4:7], v[168:171], a[96:99], a[4:7]
buffer_load_dwordx4 a[224:227], v1, s[44:47], s25 offen offset:0 sc1
M a[8:11], v[176:179], a[96:99], a[8:11]
ds_read_b64_tr_b16 a[40:41], v29 offset:16384
ds_read_b64_tr_b16 a[42:43], v29 offset:18432
M a[8:11], v[180:183], a[100:103], a[8:11]
buffer_load_dwordx4 a[228:231], v1, s[44:47], s25 offen offset:1024 sc1
M a[12:15], v[188:191], a[100:103], a[12:15]
ds_read_b64_tr_b16 a[44:45], v29 offset:20480
ds_read_b64_tr_b16 a[46:47], v29 offset:22528
M a[12:15], v[184:187], a[96:99], a[12:15]
buffer_load_dwordx4 a[232:235], v1, s[44:47], s25 offen offset:2048 sc1
M a[16:19], v[160:163], a[104:107], a[16:19]
ds_read_b64_tr_b16 a[48:49], v30 offset:16384
ds_read_b64_tr_b16 a[50:51], v30 offset:18432
M a[16:19], v[164:167], a[108:111], a[16:19]
buffer_load_dwordx4 a[236:239], v1, s[44:47], s25 offen offset:3072 sc1
M a[20:23], v[172:175], a[108:111], a[20:23]
ds_read_b64_tr_b16 a[52:53], v30 offset:20480
ds_read_b64_tr_b16 a[54:55], v30 offset:22528
M a[20:23], v[168:171], a[104:107], a[20:23]
s_add_u32 s25, s25, 16384
s_add_u32 s26, s26, 131072
M a[24:27], v[176:179], a[104:107], a[24:27]
ds_read_b64_tr_b16 a[56:57], v31 offset:16384
ds_read_b64_tr_b16 a[58:59], v31 offset:18432
M a[24:27], v[180:183], a[108:111], a[24:27]
ds_read_b64_tr_b16 a[60:61], v31 offset:20480
ds_read_b64_tr_b16 a[62:63], v31 offset:22528
M a[28:31], v[188:191], a[108:111], a[28:31]
M a[28:31], v[184:187], a[104:107], a[28:31]
s_waitcnt vmcnt(12) lgkmcnt(0)
s_barrier
M a[0:3], a[32:35], a[128:131], a[0:3]
ds_read_b64_tr_b16 v[160:161], v28 offset:32768
ds_read_b64_tr_b16 v[162:163], v28 offset:34816
M a[0:3], a[36:39], a[132:135], a[0:3]
ds_read_b64_tr_b16 v[164:165], v28 offset:36864
ds_read_b64_tr_b16 v[166:167], v28 offset:38912
M a[4:7], a[44:47], a[132:135], a[4:7]
M a[4:7], a[40:43], a[128:131], a[4:7]
ds_read_b64_tr_b16 v[168:169], v29 offset:32768
ds_read_b64_tr_b16 v[170:171], v29 offset:34816
M a[8:11], a[48:51], a[128:131], a[8:11]
M a[8:11], a[52:55], a[132:135], a[8:11]
ds_read_b64_tr_b16 v[172:173], v29 offset:36864
ds_read_b64_tr_b16 v[174:175], v29 offset:38912
M a[12:15], a[60:63], a[132:135], a[12:15]
M a[12:15], a[56:59], a[128:131], a[12:15]
ds_read_b64_tr_b16 v[176:177], v30 offset:32768
ds_read_b64_tr_b16 v[178:179], v30 offset:34816
M a[16:19], a[32:35], a[136:139], a[16:19]
ds_read_b64_tr_b16 v[180:181], v30 offset:36864
ds_read_b64_tr_b16 v[182:183], v30 offset:38912
M a[16:19], a[36:39], a[140:143], a[16:19]
M a[20:23], a[44:47], a[140:143], a[20:23]
ds_read_b64_tr_b16 v[184:185], v31 offset:32768
ds_read_b64_tr_b16 v[186:187], v31 offset:34816
M a[20:23], a[40:43], a[136:139], a[20:23]
M a[24:27], a[48:51], a[136:139], a[24:27]
ds_read_b64_tr_b16 v[188:189], v31 offset:36864
ds_read_b64_tr_b16 v[190:191], v31 offset:38912
M a[24:27], a[52:55], a[140:143], a[24:27]
M a[28:31], a[60:63], a[140:143], a[28:31]
M a[28:31], a[56:59], a[136:139], a[28:31]
s_waitcnt vmcnt(6) lgkmcnt(0)
s_barrier
M a[0:3], v[160:163], a[160:163], a[0:3]
buffer_load_dword v8, v11, s[52:55], s59 offen sc1
M a[0:3], v[164:167], a[164:167], a[0:3]
ds_read_b64_tr_b16 a[32:33], v28 offset:49152
ds_read_b64_tr_b16 a[34:35], v28 offset:51200
M a[4:7], v[172:175], a[164:167], a[4:7]
M a[4:7], v[168:171], a[160:163], a[4:7]
ds_read_b64_tr_b16 a[36:37], v28 offset:53248
ds_read_b64_tr_b16 a[38:39], v28 offset:55296
M a[8:11], v[176:179], a[160:163], a[8:11]
ds_read_b64_tr_b16 a[40:41], v29 offset:49152
ds_read_b64_tr_b16 a[42:43], v29 offset:51200
M a[8:11], v[180:183], a[164:167], a[8:11]
M a[12:15], v[188:191], a[164:167], a[12:15]
ds_read_b64_tr_b16 a[44:45], v29 offset:53248
ds_read_b64_tr_b16 a[46:47], v29 offset:55296
M a[12:15], v[184:187], a[160:163], a[12:15]
ds_read_b64_tr_b16 a[48:49], v30 offset:49152
ds_read_b64_tr_b16 a[50:51], v30 offset:51200
M a[16:19], v[160:163], a[168:171], a[16:19]
M a[16:19], v[164:167], a[172:175], a[16:19]
ds_read_b64_tr_b16 a[52:53], v30 offset:53248
ds_read_b64_tr_b16 a[54:55], v30 offset:55296
M a[20:23], v[172:175], a[172:175], a[20:23]
ds_read_b64_tr_b16 a[56:57], v31 offset:49152
ds_read_b64_tr_b16 a[58:59], v31 offset:51200
M a[20:23], v[168:171], a[168:171], a[20:23]
M a[24:27], v[176:179], a[168:171], a[24:27]
ds_read_b64_tr_b16 a[60:61], v31 offset:53248
ds_read_b64_tr_b16 a[62:63], v31 offset:55296
M a[24:27], v[180:183], a[172:175], a[24:27]
M a[28:31], v[188:191], a[172:175], a[28:31]
M a[28:31], v[184:187], a[168:171], a[28:31]
s_waitcnt vmcnt(1) lgkmcnt(0)
s_barrier
s_waitcnt vmcnt(0)
v_cmp_ne_u32 vcc, 1, v8
s_nop 0
s_cbranch_vccnz Lk3_spinfl
Lk3_gotfl:
M a[0:3], a[32:35], a[192:195], a[0:3]
s_xor_b32 s60, s56, 65536
s_add_u32 s60, s60, 4096
buffer_load_dwordx4 v[192:195], v1, s[52:55], s60 offen offset:0 sc1
ds_read_b64_tr_b16 v[160:161], v24 offset:0
ds_read_b64_tr_b16 v[162:163], v24 offset:2048
M a[0:3], a[36:39], a[196:199], a[0:3]
buffer_load_dwordx4 v[196:199], v1, s[52:55], s60 offen offset:1024 sc1
M a[4:7], a[44:47], a[196:199], a[4:7]
ds_read_b64_tr_b16 v[164:165], v24 offset:4096
ds_read_b64_tr_b16 v[166:167], v24 offset:6144
buffer_load_dwordx4 v[200:203], v1, s[52:55], s60 offen offset:2048 sc1
M a[4:7], a[40:43], a[192:195], a[4:7]
ds_read_b64_tr_b16 v[168:169], v25 offset:0
ds_read_b64_tr_b16 v[170:171], v25 offset:2048
M a[8:11], a[48:51], a[192:195], a[8:11]
buffer_load_dwordx4 v[204:207], v1, s[52:55], s60 offen offset:3072 sc1
ds_read_b64_tr_b16 v[172:173], v25 offset:4096
ds_read_b64_tr_b16 v[174:175], v25 offset:6144
M a[8:11], a[52:55], a[196:199], a[8:11]
s_xor_b32 s60, s56, 131072
s_add_u32 s60, s60, 8192
buffer_load_dwordx4 v[208:211], v1, s[52:55], s60 offen offset:0 sc1
M a[12:15], a[60:63], a[196:199], a[12:15]
ds_read_b64_tr_b16 v[176:177], v26 offset:0
ds_read_b64_tr_b16 v[178:179], v26 offset:2048
M a[12:15], a[56:59], a[192:195], a[12:15]
buffer_load_dwordx4 v[212:215], v1, s[52:55], s60 offen offset:1024 sc1
ds_read_b64_tr_b16 v[180:181], v26 offset:4096
ds_read_b64_tr_b16 v[182:183], v26 offset:6144
M a[16:19], a[32:35], a[200:203], a[16:19]
buffer_load_dwordx4 v[216:219], v1, s[52:55], s60 offen offset:2048 sc1
M a[16:19], a[36:39], a[204:207], a[16:19]
ds_read_b64_tr_b16 v[184:185], v27 offset:0
ds_read_b64_tr_b16 v[186:187], v27 offset:2048
buffer_load_dwordx4 v[220:223], v1, s[52:55], s60 offen offset:3072 sc1
M a[20:23], a[44:47], a[204:207], a[20:23]
ds_read_b64_tr_b16 v[188:189], v27 offset:4096
ds_read_b64_tr_b16 v[190:191], v27 offset:6144
M a[20:23], a[40:43], a[200:203], a[20:23]
s_xor_b32 s60, s56, 196608
s_add_u32 s60, s60, 12288
buffer_load_dwordx4 v[224:227], v1, s[52:55], s60 offen offset:0 sc1
buffer_load_dwordx4 v[228:231], v1, s[52:55], s60 offen offset:1024 sc1
M a[24:27], a[48:51], a[200:203], a[24:27]
buffer_load_dwordx4 v[232:235], v1, s[52:55], s60 offen offset:2048 sc1
M a[24:27], a[52:55], a[204:207], a[24:27]
buffer_load_dwordx4 v[236:239], v1, s[52:55], s60 offen offset:3072 sc1
M a[28:31], a[60:63], a[204:207], a[28:31]
M a[28:31], a[56:59], a[200:203], a[28:31]
s_waitcnt lgkmcnt(0)
M a[0:3], v[160:163], a[224:227], a[0:3]
M a[0:3], v[164:167], a[228:231], a[0:3]
M a[4:7], v[172:175], a[228:231], a[4:7]
M a[4:7], v[168:171], a[224:227], a[4:7]
M a[8:11], v[176:179], a[224:227], a[8:11]
M a[8:11], v[180:183], a[228:231], a[8:11]
M a[12:15], v[188:191], a[228:231], a[12:15]
M a[12:15], v[184:187], a[224:227], a[12:15]
M a[16:19], v[160:163], a[232:235], a[16:19]
M a[16:19], v[164:167], a[236:239], a[16:19]
M a[20:23], v[172:175], a[236:239], a[20:23]
M a[20:23], v[168:171], a[232:235], a[20:23]
M a[24:27], v[176:179], a[232:235], a[24:27]
M a[24:27], v[180:183], a[236:239], a[24:27]
M a[28:31], v[188:191], a[236:239], a[28:31]
M a[28:31], v[184:187], a[232:235], a[28:31]
v_bfe_u32 v8, v0, 4, 1
v_lshrrev_b32 v9, 5, v0
v_lshl_or_b32 v8, v8, 1, v9
v_and_b32 v9, 15, v0
v_lshlrev_b32 v9, 13, v9
v_lshl_add_u32 v8, v8, 4, v9
s_and_b32 s3, s101, 1
s_lshl_b32 s3, s3, 6
s_lshr_b32 s6, s101, 1
s_add_u32 s3, s3, s6
s_add_u32 s3, s3, s21
s_lshl_b32 s3, s3, 12
s_lshl_b32 s6, s22, 1
s_add_u32 s3, s3, s6
s_add_u32 s3, s3, 2048
v_accvgpr_read_b32 v20, a0
v_accvgpr_read_b32 v21, a1
v_accvgpr_read_b32 v22, a2
v_accvgpr_read_b32 v23, a3
v_accvgpr_read_b32 v24, a4
v_accvgpr_read_b32 v25, a5
v_accvgpr_read_b32 v26, a6
v_accvgpr_read_b32 v27, a7
v_cvt_pk_bf16_f32 v12, v20, v21
v_cvt_pk_bf16_f32 v13, v22, v23
v_cvt_pk_bf16_f32 v14, v24, v25
v_cvt_pk_bf16_f32 v15, v26, v27
s_nop 0
v_permlane16_swap_b32 v12, v14
v_permlane16_swap_b32 v13, v15
buffer_store_dwordx4 v[12:15], v8, s[16:19], s3 offen offset:0
v_accvgpr_read_b32 v20, a8
v_accvgpr_read_b32 v21, a9
v_accvgpr_read_b32 v22, a10
v_accvgpr_read_b32 v23, a11
v_accvgpr_read_b32 v24, a12
v_accvgpr_read_b32 v25, a13
v_accvgpr_read_b32 v26, a14
v_accvgpr_read_b32 v27, a15
v_cvt_pk_bf16_f32 v16, v20, v21
v_cvt_pk_bf16_f32 v17, v22, v23
v_cvt_pk_bf16_f32 v18, v24, v25
v_cvt_pk_bf16_f32 v19, v26, v27
s_nop 0
v_permlane16_swap_b32 v16, v18
v_permlane16_swap_b32 v17, v19
buffer_store_dwordx4 v[16:19], v8, s[16:19], s3 offen offset:64
s_add_u32 s3, s3, 131072
v_accvgpr_read_b32 v20, a16
v_accvgpr_read_b32 v21, a17
v_accvgpr_read_b32 v22, a18
v_accvgpr_read_b32 v23, a19
v_accvgpr_read_b32 v24, a20
v_accvgpr_read_b32 v25, a21
v_accvgpr_read_b32 v26, a22
v_accvgpr_read_b32 v27, a23
v_cvt_pk_bf16_f32 v12, v20, v21
v_cvt_pk_bf16_f32 v13, v22, v23
v_cvt_pk_bf16_f32 v14, v24, v25
v_cvt_pk_bf16_f32 v15, v26, v27
s_nop 0
v_permlane16_swap_b32 v12, v14
v_permlane16_swap_b32 v13, v15
buffer_store_dwordx4 v[12:15], v8, s[16:19], s3 offen offset:0
v_accvgpr_read_b32 v20, a24
v_accvgpr_read_b32 v21, a25
v_accvgpr_read_b32 v22, a26
v_accvgpr_read_b32 v23, a27
v_accvgpr_read_b32 v24, a28
v_accvgpr_read_b32 v25, a29
v_accvgpr_read_b32 v26, a30
v_accvgpr_read_b32 v27, a31
v_cvt_pk_bf16_f32 v16, v20, v21
v_cvt_pk_bf16_f32 v17, v22, v23
v_cvt_pk_bf16_f32 v18, v24, v25
v_cvt_pk_bf16_f32 v19, v26, v27
s_nop 0
v_permlane16_swap_b32 v16, v18
v_permlane16_swap_b32 v17, v19
buffer_store_dwordx4 v[16:19], v8, s[16:19], s3 offen offset:64
v_bfe_u32 v8, v0, 4, 1
v_lshrrev_b32 v9, 5, v0
v_lshl_or_b32 v8, v8, 1, v9
v_and_b32 v9, 15, v0
v_lshlrev_b32 v9, 12, v9
v_lshl_add_u32 v8, v8, 4, v9
s_lshl_b32 s3, s101, 6
s_add_u32 s3, s3, s29
s_lshl_b32 s3, s3, 12
s_lshl_b32 s6, s30, 1
s_add_u32 s3, s3, s6
s_mov_b32 s6, 0x00003f80
s_mov_b32 s7, 0x3f800000
s_waitcnt vmcnt(4)
v_dot2_f32_bf16 v32, v192, s6, v32
v_dot2_f32_bf16 v33, v192, s7, v33
v_dot2_f32_bf16 v34, v193, s6, v34
v_dot2_f32_bf16 v35, v193, s7, v35
v_dot2_f32_bf16 v36, v194, s6, v36
v_dot2_f32_bf16 v37, v194, s7, v37
v_dot2_f32_bf16 v38, v195, s6, v38
v_dot2_f32_bf16 v39, v195, s7, v39
v_dot2_f32_bf16 v32, v208, s6, v32
v_dot2_f32_bf16 v33, v208, s7, v33
v_dot2_f32_bf16 v34, v209, s6, v34
v_dot2_f32_bf16 v35, v209, s7, v35
v_dot2_f32_bf16 v36, v210, s6, v36
v_dot2_f32_bf16 v37, v210, s7, v37
v_dot2_f32_bf16 v38, v211, s6, v38
v_dot2_f32_bf16 v39, v211, s7, v39
v_dot2_f32_bf16 v32, v224, s6, v32
v_dot2_f32_bf16 v33, v224, s7, v33
v_dot2_f32_bf16 v34, v225, s6, v34
v_dot2_f32_bf16 v35, v225, s7, v35
v_dot2_f32_bf16 v36, v226, s6, v36
v_dot2_f32_bf16 v37, v226, s7, v37
v_dot2_f32_bf16 v38, v227, s6, v38
v_dot2_f32_bf16 v39, v227, s7, v39
v_cvt_pk_bf16_f32 v12, v32, v33
v_cvt_pk_bf16_f32 v13, v34, v35
v_cvt_pk_bf16_f32 v14, v36, v37
v_cvt_pk_bf16_f32 v15, v38, v39
s_nop 0
v_permlane16_swap_b32 v12, v14
v_permlane16_swap_b32 v13, v15
buffer_store_dwordx4 v[12:15], v8, s[16:19], s3 offen offset:0
s_add_u32 s3, s3, 65536
v_dot2_f32_bf16 v64, v196, s6, v64
v_dot2_f32_bf16 v65, v196, s7, v65
v_dot2_f32_bf16 v66, v197, s6, v66
v_dot2_f32_bf16 v67, v197, s7, v67
v_dot2_f32_bf16 v68, v198, s6, v68
v_dot2_f32_bf16 v69, v198, s7, v69
v_dot2_f32_bf16 v70, v199, s6, v70
v_dot2_f32_bf16 v71, v199, s7, v71
v_dot2_f32_bf16 v64, v212, s6, v64
v_dot2_f32_bf16 v65, v212, s7, v65
v_dot2_f32_bf16 v66, v213, s6, v66
v_dot2_f32_bf16 v67, v213, s7, v67
v_dot2_f32_bf16 v68, v214, s6, v68
v_dot2_f32_bf16 v69, v214, s7, v69
v_dot2_f32_bf16 v70, v215, s6, v70
v_dot2_f32_bf16 v71, v215, s7, v71
v_dot2_f32_bf16 v64, v228, s6, v64
v_dot2_f32_bf16 v65, v228, s7, v65
v_dot2_f32_bf16 v66, v229, s6, v66
v_dot2_f32_bf16 v67, v229, s7, v67
v_dot2_f32_bf16 v68, v230, s6, v68
v_dot2_f32_bf16 v69, v230, s7, v69
v_dot2_f32_bf16 v70, v231, s6, v70
v_dot2_f32_bf16 v71, v231, s7, v71
v_cvt_pk_bf16_f32 v16, v64, v65
v_cvt_pk_bf16_f32 v17, v66, v67
v_cvt_pk_bf16_f32 v18, v68, v69
v_cvt_pk_bf16_f32 v19, v70, v71
s_nop 0
v_permlane16_swap_b32 v16, v18
v_permlane16_swap_b32 v17, v19
buffer_store_dwordx4 v[16:19], v8, s[16:19], s3 offen offset:0
s_add_u32 s3, s3, 65536
v_dot2_f32_bf16 v96, v200, s6, v96
v_dot2_f32_bf16 v97, v200, s7, v97
v_dot2_f32_bf16 v98, v201, s6, v98
v_dot2_f32_bf16 v99, v201, s7, v99
v_dot2_f32_bf16 v100, v202, s6, v100
v_dot2_f32_bf16 v101, v202, s7, v101
v_dot2_f32_bf16 v102, v203, s6, v102
v_dot2_f32_bf16 v103, v203, s7, v103
v_dot2_f32_bf16 v96, v216, s6, v96
v_dot2_f32_bf16 v97, v216, s7, v97
v_dot2_f32_bf16 v98, v217, s6, v98
v_dot2_f32_bf16 v99, v217, s7, v99
v_dot2_f32_bf16 v100, v218, s6, v100
v_dot2_f32_bf16 v101, v218, s7, v101
v_dot2_f32_bf16 v102, v219, s6, v102
v_dot2_f32_bf16 v103, v219, s7, v103
v_dot2_f32_bf16 v96, v232, s6, v96
v_dot2_f32_bf16 v97, v232, s7, v97
v_dot2_f32_bf16 v98, v233, s6, v98
v_dot2_f32_bf16 v99, v233, s7, v99
v_dot2_f32_bf16 v100, v234, s6, v100
v_dot2_f32_bf16 v101, v234, s7, v101
v_dot2_f32_bf16 v102, v235, s6, v102
v_dot2_f32_bf16 v103, v235, s7, v103
v_cvt_pk_bf16_f32 v12, v96, v97
v_cvt_pk_bf16_f32 v13, v98, v99
v_cvt_pk_bf16_f32 v14, v100, v101
v_cvt_pk_bf16_f32 v15, v102, v103
s_nop 0
v_permlane16_swap_b32 v12, v14
v_permlane16_swap_b32 v13, v15
buffer_store_dwordx4 v[12:15], v8, s[16:19], s3 offen offset:0
s_add_u32 s3, s3, 65536
v_dot2_f32_bf16 v128, v204, s6, v128
v_dot2_f32_bf16 v129, v204, s7, v129
v_dot2_f32_bf16 v130, v205, s6, v130
v_dot2_f32_bf16 v131, v205, s7, v131
v_dot2_f32_bf16 v132, v206, s6, v132
v_dot2_f32_bf16 v133, v206, s7, v133
v_dot2_f32_bf16 v134, v207, s6, v134
v_dot2_f32_bf16 v135, v207, s7, v135
v_dot2_f32_bf16 v128, v220, s6, v128
v_dot2_f32_bf16 v129, v220, s7, v129
v_dot2_f32_bf16 v130, v221, s6, v130
v_dot2_f32_bf16 v131, v221, s7, v131
v_dot2_f32_bf16 v132, v222, s6, v132
v_dot2_f32_bf16 v133, v222, s7, v133
v_dot2_f32_bf16 v134, v223, s6, v134
v_dot2_f32_bf16 v135, v223, s7, v135
v_dot2_f32_bf16 v128, v236, s6, v128
v_dot2_f32_bf16 v129, v236, s7, v129
v_dot2_f32_bf16 v130, v237, s6, v130
v_dot2_f32_bf16 v131, v237, s7, v131
v_dot2_f32_bf16 v132, v238, s6, v132
v_dot2_f32_bf16 v133, v238, s7, v133
v_dot2_f32_bf16 v134, v239, s6, v134
v_dot2_f32_bf16 v135, v239, s7, v135
v_cvt_pk_bf16_f32 v16, v128, v129
v_cvt_pk_bf16_f32 v17, v130, v131
v_cvt_pk_bf16_f32 v18, v132, v133
v_cvt_pk_bf16_f32 v19, v134, v135
s_nop 0
v_permlane16_swap_b32 v16, v18
v_permlane16_swap_b32 v17, v19
buffer_store_dwordx4 v[16:19], v8, s[16:19], s3 offen offset:0
s_endpgm
Lk3_spinb0:
Lk3_spinb0_:
s_add_u32 s61, s61, 1
s_cmp_gt_u32 s61, 1048576
s_cbranch_scc1 Lk3_gotb0
s_sleep 2
buffer_load_dword v7, v15, s[52:55], s43 offen sc1
s_waitcnt vmcnt(0)
v_cmp_ne_u32 vcc, 1, v7
s_nop 0
s_cbranch_vccnz Lk3_spinb0_
s_branch Lk3_gotb0
Lk3_spinb1:
Lk3_spinb1_:
s_add_u32 s61, s61, 1
s_cmp_gt_u32 s61, 1048576
s_cbranch_scc1 Lk3_gotb1
s_sleep 2
buffer_load_dword v7, v15, s[52:55], s43 offen sc1
s_waitcnt vmcnt(0)
v_cmp_ne_u32 vcc, 1, v7
s_nop 0
s_cbranch_vccnz Lk3_spinb1_
s_branch Lk3_gotb1
Lk3_spinb2:
Lk3_spinb2_:
s_add_u32 s61, s61, 1
s_cmp_gt_u32 s61, 1048576
s_cbranch_scc1 Lk3_gotb2
s_sleep 2
buffer_load_dword v7, v15, s[52:55], s43 offen sc1
s_waitcnt vmcnt(0)
v_cmp_ne_u32 vcc, 1, v7
s_nop 0
s_cbranch_vccnz Lk3_spinb2_
s_branch Lk3_gotb2
Lk3_spinb3:
Lk3_spinb3_:
s_add_u32 s61, s61, 1
s_cmp_gt_u32 s61, 1048576
s_cbranch_scc1 Lk3_gotb3
s_sleep 2
buffer_load_dword v7, v15, s[52:55], s43 offen sc1
s_waitcnt vmcnt(0)
v_cmp_ne_u32 vcc, 1, v7
s_nop 0
s_cbranch_vccnz Lk3_spinb3_
s_branch Lk3_gotb3
Lk3_spinft:
s_add_u32 s61, s61, 1
s_cmp_gt_u32 s61, 1048576
s_cbranch_scc1 Lk3_gotft
s_sleep 2
buffer_load_dword v252, v255, s[52:55], s62 offen sc1
s_waitcnt vmcnt(0)
v_cmp_ne_u32 vcc, 1, v252
s_nop 0
s_cbranch_vccnz Lk3_spinft
s_branch Lk3_gotft
Lk3_spinfl:
s_add_u32 s61, s61, 1
s_cmp_gt_u32 s61, 1048576
s_cbranch_scc1 Lk3_gotfl
s_sleep 2
buffer_load_dword v8, v11, s[52:55], s59 offen sc1
s_waitcnt vmcnt(0)
v_cmp_ne_u32 vcc, 1, v8
s_nop 0
s_cbranch_vccnz Lk3_spinfl
s_branch Lk3_gotfl
Lc3:
.section .rodata,"a"
.p2align 6
.amdhsa_kernel concat_heads__compressed_kv_cla__sliding_local_dilated__prompt_kernel
  .amdhsa_next_free_vgpr 512
  .amdhsa_next_free_sgpr 102
  .amdhsa_accum_offset 256
  .amdhsa_group_segment_fixed_size 0
  .amdhsa_kernarg_size 96
  .amdhsa_user_sgpr_count 2
  .amdhsa_user_sgpr_kernarg_segment_ptr 1
  .amdhsa_system_sgpr_workgroup_id_x 1
.end_amdhsa_kernel
```

```asm
; @launch grid=(256,1,1) block=(256,1,1) lds=163840
.amdgcn_target "amdgcn-amd-amdhsa--gfx950"
.text
.macro M d, a, b, c
v_mfma_f32_16x16x32_bf16 \d, \a, \b, \c
.endm
.globl concat_heads__compressed_kv_cla__sliding_local_dilated__prompt_kernel
.p2align 8
.type concat_heads__compressed_kv_cla__sliding_local_dilated__prompt_kernel,@function
concat_heads__compressed_kv_cla__sliding_local_dilated__prompt_kernel:
s_cmp_lt_u32 s2, 256
s_cbranch_scc1 Lk1_go
s_endpgm
Lk1_go:
s_load_dwordx16 s[32:47], s[0:1], 0
s_load_dwordx2 s[48:49], s[0:1], 64
s_load_dwordx2 s[50:51], s[0:1], 88
s_load_dwordx2 s[90:91], s[0:1], 80
v_lshrrev_b32 v24, 6, v0
s_nop 0
v_readfirstlane_b32 s20, v24
v_and_b32 v0, 63, v0
v_lshlrev_b32 v1, 4, v0
s_mov_b32 s101, s20
s_getpc_b64 s[92:93]
Lpca:
s_add_u32 s92, s92, Lc00-Lpca
s_addc_u32 s93, s93, 0
s_lshr_b32 s94, s2, 3
s_lshl2_add_u32 s94, s94, s101
s_mul_i32 s94, s94, (((Lk1_b-Lc00)/128+127)&~127)
v_lshlrev_b32 v25, 7, v0
v_min_u32 v25, (((Lk1_b-Lc00)/128+127)&~127)-128, v25
v_add_u32 v25, s94, v25
v_min_u32 v25, Lk1_b-Lc00-4, v25
global_load_dword v21, v25, s[92:93]
Lc00:
s_lshr_b32 s21, s20, 1
s_and_b32 s22, s20, 1
s_lshl_b32 s29, s20, 12
s_and_b32 s3, s2, 1
s_lshl_b32 s3, s3, 2
s_bfe_u32 s6, s2, 0x20003
s_add_u32 s3, s3, s6
s_lshl_b32 s52, s3, 8
s_bfe_u32 s3, s2, 0x20001
s_lshl_b32 s3, s3, 2
s_bfe_u32 s7, s2, 0x20005
s_add_u32 s3, s3, s7
s_lshl_b32 s53, s3, 8
s_cmp_lt_u32 s2, 128
s_cselect_b32 s5, 11, 10
s_lshl_b32 s3, s21, 7
s_lshl_b32 s4, s22, 5
s_add_u32 s3, s3, s4
v_lshrrev_b32 v24, 3, v0
v_add_u32 v24, s3, v24
v_and_b32 v25, 7, v0
v_add_u32 v26, 0, v24
v_bfe_u32 v27, v26, 1, 3
v_xor_b32 v27, v27, v25
v_lshlrev_b32 v26, s5, v26
v_lshl_add_u32 v26, v27, 4, v26
v_subrev_u32 v2, 0, v26
v_add_u32 v26, 8, v24
v_bfe_u32 v27, v26, 1, 3
v_xor_b32 v27, v27, v25
v_lshlrev_b32 v26, s5, v26
v_lshl_add_u32 v26, v27, 4, v26
v_subrev_u32 v3, 1024, v26
v_add_u32 v26, 16, v24
v_bfe_u32 v27, v26, 1, 3
v_xor_b32 v27, v27, v25
v_lshlrev_b32 v26, s5, v26
v_lshl_add_u32 v26, v27, 4, v26
v_subrev_u32 v4, 2048, v26
v_add_u32 v26, 24, v24
v_bfe_u32 v27, v26, 1, 3
v_xor_b32 v27, v27, v25
v_lshlrev_b32 v26, s5, v26
v_lshl_add_u32 v26, v27, 4, v26
v_subrev_u32 v5, 3072, v26
s_lshl_b32 s3, s20, 3
v_lshrrev_b32 v24, 5, v0
v_add_u32 v24, s3, v24
v_and_b32 v25, 31, v0
v_add_u32 v26, 0, v24
v_and_b32 v27, 3, v26
v_lshlrev_b32 v27, 1, v27
v_and_or_b32 v27, v26, 8, v27
v_xor_b32 v27, v27, v25
v_lshlrev_b32 v26, 13, v26
v_lshl_add_u32 v26, v27, 4, v26
v_subrev_u32 v6, 0, v26
v_add_u32 v26, 2, v24
v_and_b32 v27, 3, v26
v_lshlrev_b32 v27, 1, v27
v_and_or_b32 v27, v26, 8, v27
v_xor_b32 v27, v27, v25
v_lshlrev_b32 v26, 13, v26
v_lshl_add_u32 v26, v27, 4, v26
v_subrev_u32 v7, 1024, v26
v_add_u32 v26, 4, v24
v_and_b32 v27, 3, v26
v_lshlrev_b32 v27, 1, v27
v_and_or_b32 v27, v26, 8, v27
v_xor_b32 v27, v27, v25
v_lshlrev_b32 v26, 13, v26
v_lshl_add_u32 v26, v27, 4, v26
v_subrev_u32 v8, 2048, v26
v_add_u32 v26, 6, v24
v_and_b32 v27, 3, v26
v_lshlrev_b32 v27, 1, v27
v_and_or_b32 v27, v26, 8, v27
v_xor_b32 v27, v27, v25
v_lshlrev_b32 v26, 13, v26
v_lshl_add_u32 v26, v27, 4, v26
v_subrev_u32 v9, 3072, v26
s_lshl_b32 s23, s52, s5
s_lshl_b32 s31, 64, s5
s_mov_b32 s26, s23
s_lshl_b32 s24, s53, 1
s_mov_b32 s28, s24
s_lshl_b32 s3, 1, s5
s_add_u32 s25, s23, s3
s_lshl_b32 s3, s3, 12
s_add_u32 s27, s24, s3
s_bfe_u32 s3, s2, 0x20001
s_and_b32 s4, s2, 1
s_lshl_b32 s4, s4, 1
s_add_u32 s3, s3, s4
s_and_b32 s3, s3, 3
s_sub_u32 s4, s5, 2
s_lshl_b32 s3, s3, s4
s_add_u32 s23, s23, s3
s_lshl_b32 s3, s3, 12
s_add_u32 s24, s24, s3
s_mov_b32 s95, s6
s_cmp_lt_u32 s2, 128
s_cselect_b32 s6, -1, 8
s_waitcnt lgkmcnt(0)
s_cmp_lt_u32 s2, 128
s_cselect_b64 s[8:9], s[32:33], s[34:35]
s_mov_b32 s10, 2097152
s_cselect_b32 s10, 4194304, s10
s_mov_b32 s11, 0x00020000
s_cselect_b64 s[12:13], s[36:37], s[38:39]
s_mov_b32 s14, 4194304
s_cselect_b32 s14, 8388608, s14
s_mov_b32 s15, 0x00020000
s_mov_b64 s[64:65], s[40:41]
s_add_u32 m0, s29, 65536
s_nop 0
buffer_load_dwordx4 v6, s[12:15], s24 offen offset:0 lds
buffer_load_dwordx4 v7, s[12:15], s24 offen offset:1024 lds
buffer_load_dwordx4 v8, s[12:15], s24 offen offset:2048 lds
buffer_load_dwordx4 v9, s[12:15], s24 offen offset:3072 lds
s_add_u32 s24, s24, 262144
s_add_u32 m0, s29, 0
s_nop 0
buffer_load_dwordx4 v2, s[8:11], s23 offen offset:0 lds
buffer_load_dwordx4 v3, s[8:11], s23 offen offset:1024 lds
buffer_load_dwordx4 v4, s[8:11], s23 offen offset:2048 lds
buffer_load_dwordx4 v5, s[8:11], s23 offen offset:3072 lds
s_add_u32 m0, s29, 81920
s_nop 0
buffer_load_dwordx4 v6, s[12:15], s24 offen offset:0 lds
buffer_load_dwordx4 v7, s[12:15], s24 offen offset:1024 lds
buffer_load_dwordx4 v8, s[12:15], s24 offen offset:2048 lds
buffer_load_dwordx4 v9, s[12:15], s24 offen offset:3072 lds
s_add_u32 s24, s24, 262144
s_cmp_eq_u32 s24, s27
s_cselect_b32 s24, s28, s24
s_sub_u32 s6, s6, 1
s_cmp_eq_u32 s6, 0
s_cselect_b64 s[12:13], s[64:65], s[12:13]
s_add_u32 s16, s50, 117440512
s_addc_u32 s17, s51, 0
s_mov_b32 s18, 16384
s_mov_b32 s19, 0x00020000
v_lshlrev_b32 v23, 20, v0
s_and_b32 s3, s2, 7
s_lshr_b32 s4, s2, 6
s_lshl_b32 s4, s4, 3
s_add_u32 s3, s3, s4
s_lshl_b32 s3, s3, 4
s_add_u32 s3, s3, 4096
s_bfe_u32 s4, s2, 0x30003
s_lshl_b32 s4, s4, 9
s_add_u32 s56, s3, s4
s_sub_u32 s4, 7680, s4
s_add_u32 s57, s3, s4
s_and_b32 s3, s2, 1
s_lshl_b32 s3, s3, 3
s_bfe_u32 s4, s2, 0x30003
s_add_u32 s58, s3, s4
s_bfe_u32 s3, s2, 0x20001
s_lshl_b32 s3, s3, 2
s_lshr_b32 s4, s2, 6
s_xor_b32 s4, s4, 3
s_add_u32 s59, s3, s4
s_lshl_b32 s58, s58, 8
s_lshl_b32 s59, s59, 4
s_add_u32 s58, s58, s59
s_add_u32 s58, s58, 12288
s_lshl_b32 s59, s2, 4
v_lshlrev_b32 v20, 7, v0
s_lshl_b32 s54, s2, 13
s_mov_b64 s[60:61], s[40:41]
s_mov_b32 s62, 0
s_cmp_eq_u32 s20, 1
s_cselect_b64 s[60:61], s[46:47], s[60:61]
s_cselect_b32 s62, 6291456, s62
s_cmp_eq_u32 s20, 2
s_cselect_b64 s[60:61], s[44:45], s[60:61]
s_cselect_b32 s62, 4194304, s62
s_cmp_eq_u32 s20, 3
s_cselect_b32 s62, 0, s62
s_mov_b32 s63, 0x00020000
s_mov_b32 s3, 0
s_cmp_eq_u32 s20, 1
s_cselect_b32 s3, 6291456, s3
s_cmp_eq_u32 s20, 2
s_cselect_b32 s3, 6291456, s3
s_sub_u32 s54, s54, s3
Lc0:
s_add_u32 m0, s29, 98304
s_nop 0
buffer_load_dwordx4 v6, s[12:15], s24 offen offset:0 lds
buffer_load_dwordx4 v7, s[12:15], s24 offen offset:1024 lds
buffer_load_dwordx4 v8, s[12:15], s24 offen offset:2048 lds
buffer_load_dwordx4 v9, s[12:15], s24 offen offset:3072 lds
s_add_u32 s24, s24, 262144
s_lshl_b32 s4, s21, 13
v_and_b32 v24, 15, v0
v_lshlrev_b32 v24, 7, v24
v_add_u32 v24, s4, v24
v_bfe_u32 v25, v0, 1, 3
v_lshrrev_b32 v26, 4, v0
v_xor_b32 v25, v25, v26
v_lshl_add_u32 v10, v25, 4, v24
v_xor_b32 v11, 64, v10
v_bfe_u32 v24, v0, 2, 2
v_lshl_add_u32 v29, v26, 3, v24
v_lshlrev_b32 v25, 9, v29
v_and_b32 v27, 1, v0
v_lshl_add_u32 v25, v27, 3, v25
v_add_u32 v25, 65536, v25
v_lshlrev_b32 v24, 1, v24
v_and_or_b32 v24, v29, 8, v24
v_bfe_u32 v26, v0, 1, 1
s_lshl_b32 s4, s22, 4
s_add_u32 s3, s4, 0
v_add_u32 v27, s3, v26
v_xor_b32 v27, v27, v24
v_lshl_add_u32 v12, v27, 4, v25
s_add_u32 s3, s4, 2
v_add_u32 v27, s3, v26
v_xor_b32 v27, v27, v24
v_lshl_add_u32 v13, v27, 4, v25
s_add_u32 s3, s4, 4
v_add_u32 v27, s3, v26
v_xor_b32 v27, v27, v24
v_lshl_add_u32 v14, v27, 4, v25
s_add_u32 s3, s4, 6
v_add_u32 v27, s3, v26
v_xor_b32 v27, v27, v24
v_lshl_add_u32 v15, v27, 4, v25
s_add_u32 s3, s4, 8
v_add_u32 v27, s3, v26
v_xor_b32 v27, v27, v24
v_lshl_add_u32 v16, v27, 4, v25
s_add_u32 s3, s4, 10
v_add_u32 v27, s3, v26
v_xor_b32 v27, v27, v24
v_lshl_add_u32 v17, v27, 4, v25
s_add_u32 s3, s4, 12
v_add_u32 v27, s3, v26
v_xor_b32 v27, v27, v24
v_lshl_add_u32 v18, v27, 4, v25
s_add_u32 s3, s4, 14
v_add_u32 v27, s3, v26
v_xor_b32 v27, v27, v24
v_lshl_add_u32 v19, v27, 4, v25
v_mov_b32 v28, 0
v_mov_b32 v29, 0
v_mov_b32 v30, 0
v_mov_b32 v31, 0
s_waitcnt vmcnt(4)
s_barrier
ds_read_b64_tr_b16 a[32:33], v12 offset:0
ds_read_b64_tr_b16 a[34:35], v12 offset:2048
ds_read_b64_tr_b16 a[40:41], v13 offset:0
ds_read_b64_tr_b16 a[42:43], v13 offset:2048
ds_read_b64_tr_b16 a[48:49], v14 offset:0
ds_read_b64_tr_b16 a[50:51], v14 offset:2048
ds_read_b64_tr_b16 a[56:57], v15 offset:0
ds_read_b64_tr_b16 a[58:59], v15 offset:2048
ds_read_b64_tr_b16 a[64:65], v16 offset:0
ds_read_b64_tr_b16 a[66:67], v16 offset:2048
ds_read_b64_tr_b16 a[72:73], v17 offset:0
ds_read_b64_tr_b16 a[74:75], v17 offset:2048
ds_read_b64_tr_b16 a[80:81], v18 offset:0
ds_read_b64_tr_b16 a[82:83], v18 offset:2048
ds_read_b64_tr_b16 a[88:89], v19 offset:0
ds_read_b64_tr_b16 a[90:91], v19 offset:2048
ds_read_b64_tr_b16 a[36:37], v12 offset:16384
ds_read_b64_tr_b16 a[38:39], v12 offset:18432
ds_read_b64_tr_b16 a[44:45], v13 offset:16384
ds_read_b64_tr_b16 a[46:47], v13 offset:18432
ds_read_b64_tr_b16 a[52:53], v14 offset:16384
ds_read_b64_tr_b16 a[54:55], v14 offset:18432
ds_read_b64_tr_b16 a[60:61], v15 offset:16384
ds_read_b64_tr_b16 a[62:63], v15 offset:18432
ds_read_b64_tr_b16 a[68:69], v16 offset:16384
ds_read_b64_tr_b16 a[70:71], v16 offset:18432
ds_read_b64_tr_b16 a[76:77], v17 offset:16384
ds_read_b64_tr_b16 a[78:79], v17 offset:18432
ds_read_b64_tr_b16 a[84:85], v18 offset:16384
ds_read_b64_tr_b16 a[86:87], v18 offset:18432
ds_read_b64_tr_b16 a[92:93], v19 offset:16384
ds_read_b64_tr_b16 a[94:95], v19 offset:18432
ds_read_b128 a[160:163], v10 offset:0
ds_read_b128 a[164:167], v11 offset:0
ds_read_b128 a[168:171], v10 offset:2048
ds_read_b128 a[172:175], v11 offset:2048
s_add_u32 m0, s29, 16384
s_add_u32 s3, s23, s31
s_nop 0
buffer_load_dwordx4 v2, s[8:11], s3 offen offset:0 lds
buffer_load_dwordx4 v3, s[8:11], s3 offen offset:1024 lds
buffer_load_dwordx4 v4, s[8:11], s3 offen offset:2048 lds
buffer_load_dwordx4 v5, s[8:11], s3 offen offset:3072 lds
s_add_u32 s23, s23, 128
s_cmp_eq_u32 s23, s25
s_cselect_b32 s23, s26, s23
s_add_u32 m0, s29, 114688
s_nop 0
buffer_load_dwordx4 v6, s[12:15], s24 offen offset:0 lds
buffer_load_dwordx4 v7, s[12:15], s24 offen offset:1024 lds
buffer_load_dwordx4 v8, s[12:15], s24 offen offset:2048 lds
buffer_load_dwordx4 v9, s[12:15], s24 offen offset:3072 lds
s_add_u32 s24, s24, 262144
s_cmp_eq_u32 s24, s27
s_cselect_b32 s24, s28, s24
s_sub_u32 s6, s6, 1
s_cmp_eq_u32 s6, 0
s_cselect_b64 s[12:13], s[64:65], s[12:13]
s_waitcnt vmcnt(8) lgkmcnt(0)
s_barrier
s_getpc_b64 s[92:93]
Lpcb:
s_add_u32 s92, s92, Lk1_b-Lpcb
s_addc_u32 s93, s93, 0
s_lshr_b32 s94, s2, 3
s_lshl2_add_u32 s94, s94, s101
s_mul_i32 s94, s94, (((Lc3-Lk1_b)/128+127)&~127)
v_lshlrev_b32 v24, 7, v0
v_min_u32 v24, (((Lc3-Lk1_b)/128+127)&~127)-128, v24
v_add_u32 v24, s94, v24
v_min_u32 v24, Lc3-Lk1_b-4, v24
global_load_dword v21, v24, s[92:93]
Lc1:
s_cmp_lt_u32 s2, 128
s_cbranch_scc0 Lk1_kv
M v[32:35], a[32:35], a[160:163], 0
s_add_u32 m0, s29, 32768
s_nop 0
buffer_load_dwordx4 v2, s[8:11], s23 offen offset:0 lds
M v[32:35], a[36:39], a[164:167], v[32:35]
ds_read_b128 a[176:179], v10 offset:4096
ds_read_b128 a[180:183], v11 offset:4096
M v[36:39], a[44:47], a[164:167], 0
M v[36:39], a[40:43], a[160:163], v[36:39]
ds_read_b64_tr_b16 a[96:97], v12 offset:32768
ds_read_b64_tr_b16 a[98:99], v12 offset:34816
M v[40:43], a[48:51], a[160:163], 0
M v[40:43], a[52:55], a[164:167], v[40:43]
buffer_load_dwordx4 v3, s[8:11], s23 offen offset:1024 lds
M v[44:47], a[60:63], a[164:167], 0
M v[44:47], a[56:59], a[160:163], v[44:47]
ds_read_b64_tr_b16 a[104:105], v13 offset:32768
ds_read_b64_tr_b16 a[106:107], v13 offset:34816
M v[48:51], a[64:67], a[160:163], 0
M v[48:51], a[68:71], a[164:167], v[48:51]
buffer_load_dwordx4 v4, s[8:11], s23 offen offset:2048 lds
M v[52:55], a[76:79], a[164:167], 0
M v[52:55], a[72:75], a[160:163], v[52:55]
ds_read_b64_tr_b16 a[112:113], v14 offset:32768
ds_read_b64_tr_b16 a[114:115], v14 offset:34816
M v[56:59], a[80:83], a[160:163], 0
M v[56:59], a[84:87], a[164:167], v[56:59]
buffer_load_dwordx4 v5, s[8:11], s23 offen offset:3072 lds
M v[60:63], a[92:95], a[164:167], 0
M v[60:63], a[88:91], a[160:163], v[60:63]
ds_read_b64_tr_b16 a[120:121], v15 offset:32768
ds_read_b64_tr_b16 a[122:123], v15 offset:34816
M v[64:67], a[32:35], a[168:171], 0
M v[64:67], a[36:39], a[172:175], v[64:67]
ds_read_b128 a[184:187], v10 offset:6144
ds_read_b128 a[188:191], v11 offset:6144
M v[68:71], a[44:47], a[172:175], 0
s_add_u32 m0, s29, 65536
s_nop 0
buffer_load_dwordx4 v6, s[12:15], s24 offen offset:0 lds
M v[68:71], a[40:43], a[168:171], v[68:71]
ds_read_b64_tr_b16 a[128:129], v16 offset:32768
ds_read_b64_tr_b16 a[130:131], v16 offset:34816
M v[72:75], a[48:51], a[168:171], 0
M v[72:75], a[52:55], a[172:175], v[72:75]
M v[76:79], a[60:63], a[172:175], 0
buffer_load_dwordx4 v7, s[12:15], s24 offen offset:1024 lds
M v[76:79], a[56:59], a[168:171], v[76:79]
ds_read_b64_tr_b16 a[136:137], v17 offset:32768
ds_read_b64_tr_b16 a[138:139], v17 offset:34816
M v[80:83], a[64:67], a[168:171], 0
M v[80:83], a[68:71], a[172:175], v[80:83]
M v[84:87], a[76:79], a[172:175], 0
buffer_load_dwordx4 v8, s[12:15], s24 offen offset:2048 lds
M v[84:87], a[72:75], a[168:171], v[84:87]
ds_read_b64_tr_b16 a[144:145], v18 offset:32768
ds_read_b64_tr_b16 a[146:147], v18 offset:34816
M v[88:91], a[80:83], a[168:171], 0
M v[88:91], a[84:87], a[172:175], v[88:91]
M v[92:95], a[92:95], a[172:175], 0
buffer_load_dwordx4 v9, s[12:15], s24 offen offset:3072 lds
M v[92:95], a[88:91], a[168:171], v[92:95]
s_waitcnt lgkmcnt(15)
ds_read_b64_tr_b16 a[152:153], v19 offset:32768
ds_read_b64_tr_b16 a[154:155], v19 offset:34816
M v[96:99], a[32:35], a[176:179], 0
M v[96:99], a[36:39], a[180:183], v[96:99]
M v[100:103], a[44:47], a[180:183], 0
s_add_u32 s24, s24, 262144
M v[100:103], a[40:43], a[176:179], v[100:103]
M v[104:107], a[48:51], a[176:179], 0
M v[104:107], a[52:55], a[180:183], v[104:107]
M v[108:111], a[60:63], a[180:183], 0
M v[108:111], a[56:59], a[176:179], v[108:111]
s_waitcnt vmcnt(9) lgkmcnt(0)
s_barrier
ds_read_b128 a[160:163], v10 offset:16384
ds_read_b128 a[164:167], v11 offset:16384
M v[112:115], a[64:67], a[176:179], 0
s_add_u32 m0, s29, 49152
s_add_u32 s3, s23, s31
buffer_load_dwordx4 v2, s[8:11], s3 offen offset:0 lds
M v[112:115], a[68:71], a[180:183], v[112:115]
M v[116:119], a[76:79], a[180:183], 0
M v[116:119], a[72:75], a[176:179], v[116:119]
ds_read_b64_tr_b16 a[100:101], v12 offset:49152
ds_read_b64_tr_b16 a[102:103], v12 offset:51200
M v[120:123], a[80:83], a[176:179], 0
M v[120:123], a[84:87], a[180:183], v[120:123]
buffer_load_dwordx4 v3, s[8:11], s3 offen offset:1024 lds
M v[124:127], a[92:95], a[180:183], 0
M v[124:127], a[88:91], a[176:179], v[124:127]
M v[128:131], a[32:35], a[184:187], 0
M v[128:131], a[36:39], a[188:191], v[128:131]
ds_read_b128 a[168:171], v10 offset:18432
ds_read_b128 a[172:175], v11 offset:18432
ds_read_b64_tr_b16 a[108:109], v13 offset:49152
ds_read_b64_tr_b16 a[110:111], v13 offset:51200
M v[132:135], a[44:47], a[188:191], 0
M v[132:135], a[40:43], a[184:187], v[132:135]
buffer_load_dwordx4 v4, s[8:11], s3 offen offset:2048 lds
M v[136:139], a[48:51], a[184:187], 0
M v[136:139], a[52:55], a[188:191], v[136:139]
M v[140:143], a[60:63], a[188:191], 0
M v[140:143], a[56:59], a[184:187], v[140:143]
ds_read_b64_tr_b16 a[116:117], v14 offset:49152
ds_read_b64_tr_b16 a[118:119], v14 offset:51200
M v[144:147], a[64:67], a[184:187], 0
M v[144:147], a[68:71], a[188:191], v[144:147]
buffer_load_dwordx4 v5, s[8:11], s3 offen offset:3072 lds
M v[148:151], a[76:79], a[188:191], 0
M v[148:151], a[72:75], a[184:187], v[148:151]
M v[152:155], a[80:83], a[184:187], 0
M v[152:155], a[84:87], a[188:191], v[152:155]
ds_read_b64_tr_b16 a[124:125], v15 offset:49152
ds_read_b64_tr_b16 a[126:127], v15 offset:51200
M v[156:159], a[92:95], a[188:191], 0
s_add_u32 s23, s23, 128
s_cmp_eq_u32 s23, s25
s_cselect_b32 s23, s26, s23
M v[156:159], a[88:91], a[184:187], v[156:159]
s_waitcnt lgkmcnt(10)
M v[160:163], a[32:35], a[160:163], 0
M v[160:163], a[36:39], a[164:167], v[160:163]
ds_read_b128 a[176:179], v10 offset:20480
ds_read_b128 a[180:183], v11 offset:20480
M v[164:167], a[44:47], a[164:167], 0
M v[164:167], a[40:43], a[160:163], v[164:167]
ds_read_b64_tr_b16 a[132:133], v16 offset:49152
ds_read_b64_tr_b16 a[134:135], v16 offset:51200
M v[168:171], a[48:51], a[160:163], 0
M v[168:171], a[52:55], a[164:167], v[168:171]
s_add_u32 m0, s29, 81920
s_nop 0
buffer_load_dwordx4 v6, s[12:15], s24 offen offset:0 lds
M v[172:175], a[60:63], a[164:167], 0
M v[172:175], a[56:59], a[160:163], v[172:175]
M v[176:179], a[64:67], a[160:163], 0
M v[176:179], a[68:71], a[164:167], v[176:179]
ds_read_b64_tr_b16 a[140:141], v17 offset:49152
ds_read_b64_tr_b16 a[142:143], v17 offset:51200
M v[180:183], a[76:79], a[164:167], 0
M v[180:183], a[72:75], a[160:163], v[180:183]
buffer_load_dwordx4 v7, s[12:15], s24 offen offset:1024 lds
M v[184:187], a[80:83], a[160:163], 0
M v[184:187], a[84:87], a[164:167], v[184:187]
M v[188:191], a[92:95], a[164:167], 0
M v[188:191], a[88:91], a[160:163], v[188:191]
s_waitcnt lgkmcnt(12)
ds_read_b64_tr_b16 a[148:149], v18 offset:49152
ds_read_b64_tr_b16 a[150:151], v18 offset:51200
M v[192:195], a[32:35], a[168:171], 0
buffer_load_dwordx4 v8, s[12:15], s24 offen offset:2048 lds
M v[192:195], a[36:39], a[172:175], v[192:195]
ds_read_b128 a[184:187], v10 offset:22528
ds_read_b128 a[188:191], v11 offset:22528
M v[196:199], a[44:47], a[172:175], 0
M v[196:199], a[40:43], a[168:171], v[196:199]
M v[200:203], a[48:51], a[168:171], 0
M v[200:203], a[52:55], a[172:175], v[200:203]
ds_read_b64_tr_b16 a[156:157], v19 offset:49152
ds_read_b64_tr_b16 a[158:159], v19 offset:51200
M v[204:207], a[60:63], a[172:175], 0
buffer_load_dwordx4 v9, s[12:15], s24 offen offset:3072 lds
M v[204:207], a[56:59], a[168:171], v[204:207]
M v[208:211], a[64:67], a[168:171], 0
M v[208:211], a[68:71], a[172:175], v[208:211]
M v[212:215], a[76:79], a[172:175], 0
M v[212:215], a[72:75], a[168:171], v[212:215]
s_add_u32 s24, s24, 262144
s_cmp_eq_u32 s24, s27
s_cselect_b32 s24, s28, s24
s_sub_u32 s6, s6, 1
s_cmp_eq_u32 s6, 0
s_cselect_b64 s[12:13], s[64:65], s[12:13]
M v[216:219], a[80:83], a[168:171], 0
M v[216:219], a[84:87], a[172:175], v[216:219]
M v[220:223], a[92:95], a[172:175], 0
M v[220:223], a[88:91], a[168:171], v[220:223]
s_waitcnt lgkmcnt(10)
M v[224:227], a[32:35], a[176:179], 0
buffer_load_dword v21, v20, s[60:63], s54 offen
s_add_u32 s54, s54, 1048576
M v[224:227], a[36:39], a[180:183], v[224:227]
M v[228:231], a[44:47], a[180:183], 0
M v[228:231], a[40:43], a[176:179], v[228:231]
M v[232:235], a[48:51], a[176:179], 0
M v[232:235], a[52:55], a[180:183], v[232:235]
M v[236:239], a[60:63], a[180:183], 0
M v[236:239], a[56:59], a[176:179], v[236:239]
s_waitcnt vmcnt(9) lgkmcnt(0)
s_barrier
ds_read_b128 a[160:163], v10 offset:32768
ds_read_b128 a[164:167], v11 offset:32768
M v[240:243], a[64:67], a[176:179], 0
s_add_u32 m0, s29, 0
s_nop 0
buffer_load_dwordx4 v2, s[8:11], s23 offen offset:0 lds
M v[240:243], a[68:71], a[180:183], v[240:243]
M v[244:247], a[76:79], a[180:183], 0
M v[244:247], a[72:75], a[176:179], v[244:247]
M v[248:251], a[80:83], a[176:179], 0
M v[248:251], a[84:87], a[180:183], v[248:251]
buffer_load_dwordx4 v3, s[8:11], s23 offen offset:1024 lds
M v[252:255], a[92:95], a[180:183], 0
M v[252:255], a[88:91], a[176:179], v[252:255]
M a[0:3], a[32:35], a[184:187], 0
M a[0:3], a[36:39], a[188:191], a[0:3]
ds_read_b128 a[168:171], v10 offset:34816
ds_read_b128 a[172:175], v11 offset:34816
M a[4:7], a[44:47], a[188:191], 0
M a[4:7], a[40:43], a[184:187], a[4:7]
M a[8:11], a[48:51], a[184:187], 0
buffer_load_dwordx4 v4, s[8:11], s23 offen offset:2048 lds
M a[8:11], a[52:55], a[188:191], a[8:11]
M a[12:15], a[60:63], a[188:191], 0
M a[12:15], a[56:59], a[184:187], a[12:15]
M a[16:19], a[64:67], a[184:187], 0
M a[16:19], a[68:71], a[188:191], a[16:19]
buffer_load_dwordx4 v5, s[8:11], s23 offen offset:3072 lds
M a[20:23], a[76:79], a[188:191], 0
M a[20:23], a[72:75], a[184:187], a[20:23]
M a[24:27], a[80:83], a[184:187], 0
M a[24:27], a[84:87], a[188:191], a[24:27]
M a[28:31], a[92:95], a[188:191], 0
M a[28:31], a[88:91], a[184:187], a[28:31]
s_waitcnt lgkmcnt(2)
M v[32:35], a[96:99], a[160:163], v[32:35]
s_add_u32 m0, s29, 98304
s_nop 0
buffer_load_dwordx4 v6, s[12:15], s24 offen offset:0 lds
M v[32:35], a[100:103], a[164:167], v[32:35]
ds_read_b128 a[176:179], v10 offset:36864
ds_read_b128 a[180:183], v11 offset:36864
M v[36:39], a[108:111], a[164:167], v[36:39]
M v[36:39], a[104:107], a[160:163], v[36:39]
ds_read_b64_tr_b16 a[32:33], v12 offset:0
ds_read_b64_tr_b16 a[34:35], v12 offset:2048
M v[40:43], a[112:115], a[160:163], v[40:43]
M v[40:43], a[116:119], a[164:167], v[40:43]
M v[44:47], a[124:127], a[164:167], v[44:47]
M v[44:47], a[120:123], a[160:163], v[44:47]
ds_read_b64_tr_b16 a[40:41], v13 offset:0
ds_read_b64_tr_b16 a[42:43], v13 offset:2048
M v[48:51], a[128:131], a[160:163], v[48:51]
buffer_load_dwordx4 v7, s[12:15], s24 offen offset:1024 lds
M v[48:51], a[132:135], a[164:167], v[48:51]
M v[52:55], a[140:143], a[164:167], v[52:55]
M v[52:55], a[136:139], a[160:163], v[52:55]
ds_read_b64_tr_b16 a[48:49], v14 offset:0
ds_read_b64_tr_b16 a[50:51], v14 offset:2048
M v[56:59], a[144:147], a[160:163], v[56:59]
M v[56:59], a[148:151], a[164:167], v[56:59]
M v[60:63], a[156:159], a[164:167], v[60:63]
buffer_load_dwordx4 v8, s[12:15], s24 offen offset:2048 lds
M v[60:63], a[152:155], a[160:163], v[60:63]
s_waitcnt lgkmcnt(8)
ds_read_b64_tr_b16 a[56:57], v15 offset:0
ds_read_b64_tr_b16 a[58:59], v15 offset:2048
M v[64:67], a[96:99], a[168:171], v[64:67]
M v[64:67], a[100:103], a[172:175], v[64:67]
ds_read_b128 a[184:187], v10 offset:38912
ds_read_b128 a[188:191], v11 offset:38912
M v[68:71], a[108:111], a[172:175], v[68:71]
M v[68:71], a[104:107], a[168:171], v[68:71]
ds_read_b64_tr_b16 a[64:65], v16 offset:0
ds_read_b64_tr_b16 a[66:67], v16 offset:2048
M v[72:75], a[112:115], a[168:171], v[72:75]
M v[72:75], a[116:119], a[172:175], v[72:75]
M v[76:79], a[124:127], a[172:175], v[76:79]
M v[76:79], a[120:123], a[168:171], v[76:79]
ds_read_b64_tr_b16 a[72:73], v17 offset:0
ds_read_b64_tr_b16 a[74:75], v17 offset:2048
M v[80:83], a[128:131], a[168:171], v[80:83]
buffer_load_dwordx4 v9, s[12:15], s24 offen offset:3072 lds
M v[80:83], a[132:135], a[172:175], v[80:83]
M v[84:87], a[140:143], a[172:175], v[84:87]
M v[84:87], a[136:139], a[168:171], v[84:87]
ds_read_b64_tr_b16 a[80:81], v18 offset:0
ds_read_b64_tr_b16 a[82:83], v18 offset:2048
M v[88:91], a[144:147], a[168:171], v[88:91]
M v[88:91], a[148:151], a[172:175], v[88:91]
M v[92:95], a[156:159], a[172:175], v[92:95]
s_add_u32 s24, s24, 262144
M v[92:95], a[152:155], a[168:171], v[92:95]
s_waitcnt lgkmcnt(15)
ds_read_b64_tr_b16 a[88:89], v19 offset:0
ds_read_b64_tr_b16 a[90:91], v19 offset:2048
M v[96:99], a[96:99], a[176:179], v[96:99]
M v[96:99], a[100:103], a[180:183], v[96:99]
M v[100:103], a[108:111], a[180:183], v[100:103]
M v[100:103], a[104:107], a[176:179], v[100:103]
M v[104:107], a[112:115], a[176:179], v[104:107]
M v[104:107], a[116:119], a[180:183], v[104:107]
M v[108:111], a[124:127], a[180:183], v[108:111]
M v[108:111], a[120:123], a[176:179], v[108:111]
s_waitcnt vmcnt(9) lgkmcnt(0)
s_barrier
ds_read_b128 a[160:163], v10 offset:49152
ds_read_b128 a[164:167], v11 offset:49152
M v[112:115], a[128:131], a[176:179], v[112:115]
s_add_u32 m0, s29, 16384
s_add_u32 s3, s23, s31
buffer_load_dwordx4 v2, s[8:11], s3 offen offset:0 lds
M v[112:115], a[132:135], a[180:183], v[112:115]
M v[116:119], a[140:143], a[180:183], v[116:119]
M v[116:119], a[136:139], a[176:179], v[116:119]
ds_read_b64_tr_b16 a[36:37], v12 offset:16384
ds_read_b64_tr_b16 a[38:39], v12 offset:18432
M v[120:123], a[144:147], a[176:179], v[120:123]
M v[120:123], a[148:151], a[180:183], v[120:123]
buffer_load_dwordx4 v3, s[8:11], s3 offen offset:1024 lds
M v[124:127], a[156:159], a[180:183], v[124:127]
M v[124:127], a[152:155], a[176:179], v[124:127]
M v[128:131], a[96:99], a[184:187], v[128:131]
M v[128:131], a[100:103], a[188:191], v[128:131]
ds_read_b128 a[168:171], v10 offset:51200
ds_read_b128 a[172:175], v11 offset:51200
ds_read_b64_tr_b16 a[44:45], v13 offset:16384
ds_read_b64_tr_b16 a[46:47], v13 offset:18432
M v[132:135], a[108:111], a[188:191], v[132:135]
M v[132:135], a[104:107], a[184:187], v[132:135]
buffer_load_dwordx4 v4, s[8:11], s3 offen offset:2048 lds
M v[136:139], a[112:115], a[184:187], v[136:139]
M v[136:139], a[116:119], a[188:191], v[136:139]
M v[140:143], a[124:127], a[188:191], v[140:143]
M v[140:143], a[120:123], a[184:187], v[140:143]
ds_read_b64_tr_b16 a[52:53], v14 offset:16384
ds_read_b64_tr_b16 a[54:55], v14 offset:18432
M v[144:147], a[128:131], a[184:187], v[144:147]
buffer_load_dwordx4 v5, s[8:11], s3 offen offset:3072 lds
M v[144:147], a[132:135], a[188:191], v[144:147]
M v[148:151], a[140:143], a[188:191], v[148:151]
M v[148:151], a[136:139], a[184:187], v[148:151]
M v[152:155], a[144:147], a[184:187], v[152:155]
buffer_store_dwordx4 v[28:31], v23, s[16:19], s56 offen sc1
M v[152:155], a[148:151], a[188:191], v[152:155]
ds_read_b64_tr_b16 a[60:61], v15 offset:16384
ds_read_b64_tr_b16 a[62:63], v15 offset:18432
M v[156:159], a[156:159], a[188:191], v[156:159]
s_add_u32 s23, s23, 128
s_cmp_eq_u32 s23, s25
s_cselect_b32 s23, s26, s23
M v[156:159], a[152:155], a[184:187], v[156:159]
s_waitcnt lgkmcnt(10)
M v[160:163], a[96:99], a[160:163], v[160:163]
M v[160:163], a[100:103], a[164:167], v[160:163]
ds_read_b128 a[176:179], v10 offset:53248
ds_read_b128 a[180:183], v11 offset:53248
M v[164:167], a[108:111], a[164:167], v[164:167]
M v[164:167], a[104:107], a[160:163], v[164:167]
ds_read_b64_tr_b16 a[68:69], v16 offset:16384
ds_read_b64_tr_b16 a[70:71], v16 offset:18432
M v[168:171], a[112:115], a[160:163], v[168:171]
M v[168:171], a[116:119], a[164:167], v[168:171]
s_add_u32 m0, s29, 114688
s_nop 0
buffer_load_dwordx4 v6, s[12:15], s24 offen offset:0 lds
M v[172:175], a[124:127], a[164:167], v[172:175]
M v[172:175], a[120:123], a[160:163], v[172:175]
M v[176:179], a[128:131], a[160:163], v[176:179]
buffer_store_dwordx4 v[28:31], v23, s[16:19], s57 offen sc1
M v[176:179], a[132:135], a[164:167], v[176:179]
ds_read_b64_tr_b16 a[76:77], v17 offset:16384
ds_read_b64_tr_b16 a[78:79], v17 offset:18432
M v[180:183], a[140:143], a[164:167], v[180:183]
M v[180:183], a[136:139], a[160:163], v[180:183]
buffer_load_dwordx4 v7, s[12:15], s24 offen offset:1024 lds
M v[184:187], a[144:147], a[160:163], v[184:187]
M v[184:187], a[148:151], a[164:167], v[184:187]
M v[188:191], a[156:159], a[164:167], v[188:191]
M v[188:191], a[152:155], a[160:163], v[188:191]
s_waitcnt lgkmcnt(12)
ds_read_b64_tr_b16 a[84:85], v18 offset:16384
ds_read_b64_tr_b16 a[86:87], v18 offset:18432
M v[192:195], a[96:99], a[168:171], v[192:195]
buffer_load_dwordx4 v8, s[12:15], s24 offen offset:2048 lds
M v[192:195], a[100:103], a[172:175], v[192:195]
ds_read_b128 a[184:187], v10 offset:55296
ds_read_b128 a[188:191], v11 offset:55296
M v[196:199], a[108:111], a[172:175], v[196:199]
M v[196:199], a[104:107], a[168:171], v[196:199]
M v[200:203], a[112:115], a[168:171], v[200:203]
buffer_store_dwordx4 v[28:31], v23, s[16:19], s58 offen sc1
M v[200:203], a[116:119], a[172:175], v[200:203]
ds_read_b64_tr_b16 a[92:93], v19 offset:16384
ds_read_b64_tr_b16 a[94:95], v19 offset:18432
M v[204:207], a[124:127], a[172:175], v[204:207]
M v[204:207], a[120:123], a[168:171], v[204:207]
buffer_load_dwordx4 v9, s[12:15], s24 offen offset:3072 lds
M v[208:211], a[128:131], a[168:171], v[208:211]
M v[208:211], a[132:135], a[172:175], v[208:211]
M v[212:215], a[140:143], a[172:175], v[212:215]
M v[212:215], a[136:139], a[168:171], v[212:215]
s_add_u32 s24, s24, 262144
s_cmp_eq_u32 s24, s27
s_cselect_b32 s24, s28, s24
s_sub_u32 s6, s6, 1
s_cmp_eq_u32 s6, 0
s_cselect_b64 s[12:13], s[64:65], s[12:13]
M v[216:219], a[144:147], a[168:171], v[216:219]
M v[216:219], a[148:151], a[172:175], v[216:219]
M v[220:223], a[156:159], a[172:175], v[220:223]
M v[220:223], a[152:155], a[168:171], v[220:223]
s_waitcnt lgkmcnt(10)
M v[224:227], a[96:99], a[176:179], v[224:227]
buffer_store_dwordx4 v[28:31], v23, s[16:19], s59 offen sc1
M v[224:227], a[100:103], a[180:183], v[224:227]
buffer_load_dword v21, v20, s[60:63], s54 offen
s_add_u32 s54, s54, 1048576
M v[228:231], a[108:111], a[180:183], v[228:231]
M v[228:231], a[104:107], a[176:179], v[228:231]
M v[232:235], a[112:115], a[176:179], v[232:235]
M v[232:235], a[116:119], a[180:183], v[232:235]
M v[236:239], a[124:127], a[180:183], v[236:239]
M v[236:239], a[120:123], a[176:179], v[236:239]
s_waitcnt vmcnt(13) lgkmcnt(0)
s_barrier
ds_read_b128 a[160:163], v10 offset:0
ds_read_b128 a[164:167], v11 offset:0
M v[240:243], a[128:131], a[176:179], v[240:243]
s_add_u32 m0, s29, 32768
s_nop 0
buffer_load_dwordx4 v2, s[8:11], s23 offen offset:0 lds
M v[240:243], a[132:135], a[180:183], v[240:243]
M v[244:247], a[140:143], a[180:183], v[244:247]
M v[244:247], a[136:139], a[176:179], v[244:247]
M v[248:251], a[144:147], a[176:179], v[248:251]
M v[248:251], a[148:151], a[180:183], v[248:251]
buffer_load_dwordx4 v3, s[8:11], s23 offen offset:1024 lds
M v[252:255], a[156:159], a[180:183], v[252:255]
M v[252:255], a[152:155], a[176:179], v[252:255]
M a[0:3], a[96:99], a[184:187], a[0:3]
M a[0:3], a[100:103], a[188:191], a[0:3]
ds_read_b128 a[168:171], v10 offset:2048
ds_read_b128 a[172:175], v11 offset:2048
M a[4:7], a[108:111], a[188:191], a[4:7]
M a[4:7], a[104:107], a[184:187], a[4:7]
M a[8:11], a[112:115], a[184:187], a[8:11]
buffer_load_dwordx4 v4, s[8:11], s23 offen offset:2048 lds
M a[8:11], a[116:119], a[188:191], a[8:11]
M a[12:15], a[124:127], a[188:191], a[12:15]
M a[12:15], a[120:123], a[184:187], a[12:15]
M a[16:19], a[128:131], a[184:187], a[16:19]
M a[16:19], a[132:135], a[188:191], a[16:19]
buffer_load_dwordx4 v5, s[8:11], s23 offen offset:3072 lds
M a[20:23], a[140:143], a[188:191], a[20:23]
M a[20:23], a[136:139], a[184:187], a[20:23]
M a[24:27], a[144:147], a[184:187], a[24:27]
M a[24:27], a[148:151], a[188:191], a[24:27]
M a[28:31], a[156:159], a[188:191], a[28:31]
M a[28:31], a[152:155], a[184:187], a[28:31]
s_waitcnt lgkmcnt(2)
s_mov_b32 s30, 5
Lk1_ql:
M v[32:35], a[32:35], a[160:163], v[32:35]
s_add_u32 m0, s29, 65536
s_nop 0
buffer_load_dwordx4 v6, s[12:15], s24 offen offset:0 lds
M v[32:35], a[36:39], a[164:167], v[32:35]
ds_read_b128 a[176:179], v10 offset:4096
ds_read_b128 a[180:183], v11 offset:4096
M v[36:39], a[44:47], a[164:167], v[36:39]
M v[36:39], a[40:43], a[160:163], v[36:39]
ds_read_b64_tr_b16 a[96:97], v12 offset:32768
ds_read_b64_tr_b16 a[98:99], v12 offset:34816
M v[40:43], a[48:51], a[160:163], v[40:43]
M v[40:43], a[52:55], a[164:167], v[40:43]
M v[44:47], a[60:63], a[164:167], v[44:47]
M v[44:47], a[56:59], a[160:163], v[44:47]
ds_read_b64_tr_b16 a[104:105], v13 offset:32768
ds_read_b64_tr_b16 a[106:107], v13 offset:34816
M v[48:51], a[64:67], a[160:163], v[48:51]
buffer_load_dwordx4 v7, s[12:15], s24 offen offset:1024 lds
M v[48:51], a[68:71], a[164:167], v[48:51]
M v[52:55], a[76:79], a[164:167], v[52:55]
M v[52:55], a[72:75], a[160:163], v[52:55]
ds_read_b64_tr_b16 a[112:113], v14 offset:32768
ds_read_b64_tr_b16 a[114:115], v14 offset:34816
M v[56:59], a[80:83], a[160:163], v[56:59]
M v[56:59], a[84:87], a[164:167], v[56:59]
M v[60:63], a[92:95], a[164:167], v[60:63]
buffer_load_dwordx4 v8, s[12:15], s24 offen offset:2048 lds
M v[60:63], a[88:91], a[160:163], v[60:63]
s_waitcnt lgkmcnt(8)
ds_read_b64_tr_b16 a[120:121], v15 offset:32768
ds_read_b64_tr_b16 a[122:123], v15 offset:34816
M v[64:67], a[32:35], a[168:171], v[64:67]
M v[64:67], a[36:39], a[172:175], v[64:67]
ds_read_b128 a[184:187], v10 offset:6144
ds_read_b128 a[188:191], v11 offset:6144
M v[68:71], a[44:47], a[172:175], v[68:71]
M v[68:71], a[40:43], a[168:171], v[68:71]
ds_read_b64_tr_b16 a[128:129], v16 offset:32768
ds_read_b64_tr_b16 a[130:131], v16 offset:34816
M v[72:75], a[48:51], a[168:171], v[72:75]
M v[72:75], a[52:55], a[172:175], v[72:75]
M v[76:79], a[60:63], a[172:175], v[76:79]
M v[76:79], a[56:59], a[168:171], v[76:79]
ds_read_b64_tr_b16 a[136:137], v17 offset:32768
ds_read_b64_tr_b16 a[138:139], v17 offset:34816
M v[80:83], a[64:67], a[168:171], v[80:83]
buffer_load_dwordx4 v9, s[12:15], s24 offen offset:3072 lds
M v[80:83], a[68:71], a[172:175], v[80:83]
M v[84:87], a[76:79], a[172:175], v[84:87]
M v[84:87], a[72:75], a[168:171], v[84:87]
ds_read_b64_tr_b16 a[144:145], v18 offset:32768
ds_read_b64_tr_b16 a[146:147], v18 offset:34816
M v[88:91], a[80:83], a[168:171], v[88:91]
M v[88:91], a[84:87], a[172:175], v[88:91]
M v[92:95], a[92:95], a[172:175], v[92:95]
s_add_u32 s24, s24, 262144
M v[92:95], a[88:91], a[168:171], v[92:95]
s_waitcnt lgkmcnt(15)
ds_read_b64_tr_b16 a[152:153], v19 offset:32768
ds_read_b64_tr_b16 a[154:155], v19 offset:34816
M v[96:99], a[32:35], a[176:179], v[96:99]
M v[96:99], a[36:39], a[180:183], v[96:99]
M v[100:103], a[44:47], a[180:183], v[100:103]
M v[100:103], a[40:43], a[176:179], v[100:103]
M v[104:107], a[48:51], a[176:179], v[104:107]
M v[104:107], a[52:55], a[180:183], v[104:107]
M v[108:111], a[60:63], a[180:183], v[108:111]
M v[108:111], a[56:59], a[176:179], v[108:111]
s_waitcnt vmcnt(9) lgkmcnt(0)
s_barrier
ds_read_b128 a[160:163], v10 offset:16384
ds_read_b128 a[164:167], v11 offset:16384
M v[112:115], a[64:67], a[176:179], v[112:115]
s_add_u32 m0, s29, 49152
s_add_u32 s3, s23, s31
buffer_load_dwordx4 v2, s[8:11], s3 offen offset:0 lds
M v[112:115], a[68:71], a[180:183], v[112:115]
M v[116:119], a[76:79], a[180:183], v[116:119]
M v[116:119], a[72:75], a[176:179], v[116:119]
ds_read_b64_tr_b16 a[100:101], v12 offset:49152
ds_read_b64_tr_b16 a[102:103], v12 offset:51200
M v[120:123], a[80:83], a[176:179], v[120:123]
M v[120:123], a[84:87], a[180:183], v[120:123]
buffer_load_dwordx4 v3, s[8:11], s3 offen offset:1024 lds
M v[124:127], a[92:95], a[180:183], v[124:127]
M v[124:127], a[88:91], a[176:179], v[124:127]
M v[128:131], a[32:35], a[184:187], v[128:131]
M v[128:131], a[36:39], a[188:191], v[128:131]
ds_read_b128 a[168:171], v10 offset:18432
ds_read_b128 a[172:175], v11 offset:18432
ds_read_b64_tr_b16 a[108:109], v13 offset:49152
ds_read_b64_tr_b16 a[110:111], v13 offset:51200
M v[132:135], a[44:47], a[188:191], v[132:135]
M v[132:135], a[40:43], a[184:187], v[132:135]
buffer_load_dwordx4 v4, s[8:11], s3 offen offset:2048 lds
M v[136:139], a[48:51], a[184:187], v[136:139]
M v[136:139], a[52:55], a[188:191], v[136:139]
M v[140:143], a[60:63], a[188:191], v[140:143]
M v[140:143], a[56:59], a[184:187], v[140:143]
ds_read_b64_tr_b16 a[116:117], v14 offset:49152
ds_read_b64_tr_b16 a[118:119], v14 offset:51200
M v[144:147], a[64:67], a[184:187], v[144:147]
M v[144:147], a[68:71], a[188:191], v[144:147]
buffer_load_dwordx4 v5, s[8:11], s3 offen offset:3072 lds
M v[148:151], a[76:79], a[188:191], v[148:151]
M v[148:151], a[72:75], a[184:187], v[148:151]
M v[152:155], a[80:83], a[184:187], v[152:155]
M v[152:155], a[84:87], a[188:191], v[152:155]
ds_read_b64_tr_b16 a[124:125], v15 offset:49152
ds_read_b64_tr_b16 a[126:127], v15 offset:51200
M v[156:159], a[92:95], a[188:191], v[156:159]
s_add_u32 s23, s23, 128
s_cmp_eq_u32 s23, s25
s_cselect_b32 s23, s26, s23
M v[156:159], a[88:91], a[184:187], v[156:159]
s_waitcnt lgkmcnt(10)
M v[160:163], a[32:35], a[160:163], v[160:163]
M v[160:163], a[36:39], a[164:167], v[160:163]
ds_read_b128 a[176:179], v10 offset:20480
ds_read_b128 a[180:183], v11 offset:20480
M v[164:167], a[44:47], a[164:167], v[164:167]
M v[164:167], a[40:43], a[160:163], v[164:167]
ds_read_b64_tr_b16 a[132:133], v16 offset:49152
ds_read_b64_tr_b16 a[134:135], v16 offset:51200
M v[168:171], a[48:51], a[160:163], v[168:171]
M v[168:171], a[52:55], a[164:167], v[168:171]
s_add_u32 m0, s29, 81920
s_nop 0
buffer_load_dwordx4 v6, s[12:15], s24 offen offset:0 lds
M v[172:175], a[60:63], a[164:167], v[172:175]
M v[172:175], a[56:59], a[160:163], v[172:175]
M v[176:179], a[64:67], a[160:163], v[176:179]
M v[176:179], a[68:71], a[164:167], v[176:179]
ds_read_b64_tr_b16 a[140:141], v17 offset:49152
ds_read_b64_tr_b16 a[142:143], v17 offset:51200
M v[180:183], a[76:79], a[164:167], v[180:183]
M v[180:183], a[72:75], a[160:163], v[180:183]
buffer_load_dwordx4 v7, s[12:15], s24 offen offset:1024 lds
M v[184:187], a[80:83], a[160:163], v[184:187]
M v[184:187], a[84:87], a[164:167], v[184:187]
M v[188:191], a[92:95], a[164:167], v[188:191]
M v[188:191], a[88:91], a[160:163], v[188:191]
s_waitcnt lgkmcnt(12)
ds_read_b64_tr_b16 a[148:149], v18 offset:49152
ds_read_b64_tr_b16 a[150:151], v18 offset:51200
M v[192:195], a[32:35], a[168:171], v[192:195]
buffer_load_dwordx4 v8, s[12:15], s24 offen offset:2048 lds
M v[192:195], a[36:39], a[172:175], v[192:195]
ds_read_b128 a[184:187], v10 offset:22528
ds_read_b128 a[188:191], v11 offset:22528
M v[196:199], a[44:47], a[172:175], v[196:199]
M v[196:199], a[40:43], a[168:171], v[196:199]
M v[200:203], a[48:51], a[168:171], v[200:203]
M v[200:203], a[52:55], a[172:175], v[200:203]
ds_read_b64_tr_b16 a[156:157], v19 offset:49152
ds_read_b64_tr_b16 a[158:159], v19 offset:51200
M v[204:207], a[60:63], a[172:175], v[204:207]
buffer_load_dwordx4 v9, s[12:15], s24 offen offset:3072 lds
M v[204:207], a[56:59], a[168:171], v[204:207]
M v[208:211], a[64:67], a[168:171], v[208:211]
M v[208:211], a[68:71], a[172:175], v[208:211]
M v[212:215], a[76:79], a[172:175], v[212:215]
M v[212:215], a[72:75], a[168:171], v[212:215]
s_add_u32 s24, s24, 262144
s_cmp_eq_u32 s24, s27
s_cselect_b32 s24, s28, s24
s_sub_u32 s6, s6, 1
s_cmp_eq_u32 s6, 0
s_cselect_b64 s[12:13], s[64:65], s[12:13]
M v[216:219], a[80:83], a[168:171], v[216:219]
M v[216:219], a[84:87], a[172:175], v[216:219]
M v[220:223], a[92:95], a[172:175], v[220:223]
M v[220:223], a[88:91], a[168:171], v[220:223]
s_waitcnt lgkmcnt(10)
M v[224:227], a[32:35], a[176:179], v[224:227]
buffer_load_dword v21, v20, s[60:63], s54 offen
s_add_u32 s54, s54, 1048576
M v[224:227], a[36:39], a[180:183], v[224:227]
M v[228:231], a[44:47], a[180:183], v[228:231]
M v[228:231], a[40:43], a[176:179], v[228:231]
M v[232:235], a[48:51], a[176:179], v[232:235]
M v[232:235], a[52:55], a[180:183], v[232:235]
M v[236:239], a[60:63], a[180:183], v[236:239]
M v[236:239], a[56:59], a[176:179], v[236:239]
s_waitcnt vmcnt(9) lgkmcnt(0)
s_barrier
ds_read_b128 a[160:163], v10 offset:32768
ds_read_b128 a[164:167], v11 offset:32768
M v[240:243], a[64:67], a[176:179], v[240:243]
s_add_u32 m0, s29, 0
s_nop 0
buffer_load_dwordx4 v2, s[8:11], s23 offen offset:0 lds
M v[240:243], a[68:71], a[180:183], v[240:243]
M v[244:247], a[76:79], a[180:183], v[244:247]
M v[244:247], a[72:75], a[176:179], v[244:247]
M v[248:251], a[80:83], a[176:179], v[248:251]
M v[248:251], a[84:87], a[180:183], v[248:251]
buffer_load_dwordx4 v3, s[8:11], s23 offen offset:1024 lds
M v[252:255], a[92:95], a[180:183], v[252:255]
M v[252:255], a[88:91], a[176:179], v[252:255]
M a[0:3], a[32:35], a[184:187], a[0:3]
M a[0:3], a[36:39], a[188:191], a[0:3]
ds_read_b128 a[168:171], v10 offset:34816
ds_read_b128 a[172:175], v11 offset:34816
M a[4:7], a[44:47], a[188:191], a[4:7]
M a[4:7], a[40:43], a[184:187], a[4:7]
M a[8:11], a[48:51], a[184:187], a[8:11]
buffer_load_dwordx4 v4, s[8:11], s23 offen offset:2048 lds
M a[8:11], a[52:55], a[188:191], a[8:11]
M a[12:15], a[60:63], a[188:191], a[12:15]
M a[12:15], a[56:59], a[184:187], a[12:15]
M a[16:19], a[64:67], a[184:187], a[16:19]
M a[16:19], a[68:71], a[188:191], a[16:19]
buffer_load_dwordx4 v5, s[8:11], s23 offen offset:3072 lds
M a[20:23], a[76:79], a[188:191], a[20:23]
M a[20:23], a[72:75], a[184:187], a[20:23]
M a[24:27], a[80:83], a[184:187], a[24:27]
M a[24:27], a[84:87], a[188:191], a[24:27]
M a[28:31], a[92:95], a[188:191], a[28:31]
M a[28:31], a[88:91], a[184:187], a[28:31]
s_waitcnt lgkmcnt(2)
M v[32:35], a[96:99], a[160:163], v[32:35]
s_add_u32 m0, s29, 98304
s_nop 0
buffer_load_dwordx4 v6, s[12:15], s24 offen offset:0 lds
M v[32:35], a[100:103], a[164:167], v[32:35]
ds_read_b128 a[176:179], v10 offset:36864
ds_read_b128 a[180:183], v11 offset:36864
M v[36:39], a[108:111], a[164:167], v[36:39]
M v[36:39], a[104:107], a[160:163], v[36:39]
ds_read_b64_tr_b16 a[32:33], v12 offset:0
ds_read_b64_tr_b16 a[34:35], v12 offset:2048
M v[40:43], a[112:115], a[160:163], v[40:43]
M v[40:43], a[116:119], a[164:167], v[40:43]
M v[44:47], a[124:127], a[164:167], v[44:47]
M v[44:47], a[120:123], a[160:163], v[44:47]
ds_read_b64_tr_b16 a[40:41], v13 offset:0
ds_read_b64_tr_b16 a[42:43], v13 offset:2048
M v[48:51], a[128:131], a[160:163], v[48:51]
buffer_load_dwordx4 v7, s[12:15], s24 offen offset:1024 lds
M v[48:51], a[132:135], a[164:167], v[48:51]
M v[52:55], a[140:143], a[164:167], v[52:55]
M v[52:55], a[136:139], a[160:163], v[52:55]
ds_read_b64_tr_b16 a[48:49], v14 offset:0
ds_read_b64_tr_b16 a[50:51], v14 offset:2048
M v[56:59], a[144:147], a[160:163], v[56:59]
M v[56:59], a[148:151], a[164:167], v[56:59]
M v[60:63], a[156:159], a[164:167], v[60:63]
buffer_load_dwordx4 v8, s[12:15], s24 offen offset:2048 lds
M v[60:63], a[152:155], a[160:163], v[60:63]
s_waitcnt lgkmcnt(8)
ds_read_b64_tr_b16 a[56:57], v15 offset:0
ds_read_b64_tr_b16 a[58:59], v15 offset:2048
M v[64:67], a[96:99], a[168:171], v[64:67]
M v[64:67], a[100:103], a[172:175], v[64:67]
ds_read_b128 a[184:187], v10 offset:38912
ds_read_b128 a[188:191], v11 offset:38912
M v[68:71], a[108:111], a[172:175], v[68:71]
M v[68:71], a[104:107], a[168:171], v[68:71]
ds_read_b64_tr_b16 a[64:65], v16 offset:0
ds_read_b64_tr_b16 a[66:67], v16 offset:2048
M v[72:75], a[112:115], a[168:171], v[72:75]
M v[72:75], a[116:119], a[172:175], v[72:75]
M v[76:79], a[124:127], a[172:175], v[76:79]
M v[76:79], a[120:123], a[168:171], v[76:79]
ds_read_b64_tr_b16 a[72:73], v17 offset:0
ds_read_b64_tr_b16 a[74:75], v17 offset:2048
M v[80:83], a[128:131], a[168:171], v[80:83]
buffer_load_dwordx4 v9, s[12:15], s24 offen offset:3072 lds
M v[80:83], a[132:135], a[172:175], v[80:83]
M v[84:87], a[140:143], a[172:175], v[84:87]
M v[84:87], a[136:139], a[168:171], v[84:87]
ds_read_b64_tr_b16 a[80:81], v18 offset:0
ds_read_b64_tr_b16 a[82:83], v18 offset:2048
M v[88:91], a[144:147], a[168:171], v[88:91]
M v[88:91], a[148:151], a[172:175], v[88:91]
M v[92:95], a[156:159], a[172:175], v[92:95]
s_add_u32 s24, s24, 262144
M v[92:95], a[152:155], a[168:171], v[92:95]
s_waitcnt lgkmcnt(15)
ds_read_b64_tr_b16 a[88:89], v19 offset:0
ds_read_b64_tr_b16 a[90:91], v19 offset:2048
M v[96:99], a[96:99], a[176:179], v[96:99]
M v[96:99], a[100:103], a[180:183], v[96:99]
M v[100:103], a[108:111], a[180:183], v[100:103]
M v[100:103], a[104:107], a[176:179], v[100:103]
M v[104:107], a[112:115], a[176:179], v[104:107]
M v[104:107], a[116:119], a[180:183], v[104:107]
M v[108:111], a[124:127], a[180:183], v[108:111]
M v[108:111], a[120:123], a[176:179], v[108:111]
s_waitcnt vmcnt(9) lgkmcnt(0)
s_barrier
ds_read_b128 a[160:163], v10 offset:49152
ds_read_b128 a[164:167], v11 offset:49152
M v[112:115], a[128:131], a[176:179], v[112:115]
s_add_u32 m0, s29, 16384
s_add_u32 s3, s23, s31
buffer_load_dwordx4 v2, s[8:11], s3 offen offset:0 lds
M v[112:115], a[132:135], a[180:183], v[112:115]
M v[116:119], a[140:143], a[180:183], v[116:119]
M v[116:119], a[136:139], a[176:179], v[116:119]
ds_read_b64_tr_b16 a[36:37], v12 offset:16384
ds_read_b64_tr_b16 a[38:39], v12 offset:18432
M v[120:123], a[144:147], a[176:179], v[120:123]
M v[120:123], a[148:151], a[180:183], v[120:123]
buffer_load_dwordx4 v3, s[8:11], s3 offen offset:1024 lds
M v[124:127], a[156:159], a[180:183], v[124:127]
M v[124:127], a[152:155], a[176:179], v[124:127]
M v[128:131], a[96:99], a[184:187], v[128:131]
M v[128:131], a[100:103], a[188:191], v[128:131]
ds_read_b128 a[168:171], v10 offset:51200
ds_read_b128 a[172:175], v11 offset:51200
ds_read_b64_tr_b16 a[44:45], v13 offset:16384
ds_read_b64_tr_b16 a[46:47], v13 offset:18432
M v[132:135], a[108:111], a[188:191], v[132:135]
M v[132:135], a[104:107], a[184:187], v[132:135]
buffer_load_dwordx4 v4, s[8:11], s3 offen offset:2048 lds
M v[136:139], a[112:115], a[184:187], v[136:139]
M v[136:139], a[116:119], a[188:191], v[136:139]
M v[140:143], a[124:127], a[188:191], v[140:143]
M v[140:143], a[120:123], a[184:187], v[140:143]
ds_read_b64_tr_b16 a[52:53], v14 offset:16384
ds_read_b64_tr_b16 a[54:55], v14 offset:18432
M v[144:147], a[128:131], a[184:187], v[144:147]
M v[144:147], a[132:135], a[188:191], v[144:147]
buffer_load_dwordx4 v5, s[8:11], s3 offen offset:3072 lds
M v[148:151], a[140:143], a[188:191], v[148:151]
M v[148:151], a[136:139], a[184:187], v[148:151]
M v[152:155], a[144:147], a[184:187], v[152:155]
M v[152:155], a[148:151], a[188:191], v[152:155]
ds_read_b64_tr_b16 a[60:61], v15 offset:16384
ds_read_b64_tr_b16 a[62:63], v15 offset:18432
M v[156:159], a[156:159], a[188:191], v[156:159]
s_add_u32 s23, s23, 128
s_cmp_eq_u32 s23, s25
s_cselect_b32 s23, s26, s23
M v[156:159], a[152:155], a[184:187], v[156:159]
s_waitcnt lgkmcnt(10)
M v[160:163], a[96:99], a[160:163], v[160:163]
M v[160:163], a[100:103], a[164:167], v[160:163]
ds_read_b128 a[176:179], v10 offset:53248
ds_read_b128 a[180:183], v11 offset:53248
M v[164:167], a[108:111], a[164:167], v[164:167]
M v[164:167], a[104:107], a[160:163], v[164:167]
ds_read_b64_tr_b16 a[68:69], v16 offset:16384
ds_read_b64_tr_b16 a[70:71], v16 offset:18432
M v[168:171], a[112:115], a[160:163], v[168:171]
M v[168:171], a[116:119], a[164:167], v[168:171]
s_add_u32 m0, s29, 114688
s_nop 0
buffer_load_dwordx4 v6, s[12:15], s24 offen offset:0 lds
M v[172:175], a[124:127], a[164:167], v[172:175]
M v[172:175], a[120:123], a[160:163], v[172:175]
M v[176:179], a[128:131], a[160:163], v[176:179]
M v[176:179], a[132:135], a[164:167], v[176:179]
ds_read_b64_tr_b16 a[76:77], v17 offset:16384
ds_read_b64_tr_b16 a[78:79], v17 offset:18432
M v[180:183], a[140:143], a[164:167], v[180:183]
M v[180:183], a[136:139], a[160:163], v[180:183]
buffer_load_dwordx4 v7, s[12:15], s24 offen offset:1024 lds
M v[184:187], a[144:147], a[160:163], v[184:187]
M v[184:187], a[148:151], a[164:167], v[184:187]
M v[188:191], a[156:159], a[164:167], v[188:191]
M v[188:191], a[152:155], a[160:163], v[188:191]
s_waitcnt lgkmcnt(12)
ds_read_b64_tr_b16 a[84:85], v18 offset:16384
ds_read_b64_tr_b16 a[86:87], v18 offset:18432
M v[192:195], a[96:99], a[168:171], v[192:195]
buffer_load_dwordx4 v8, s[12:15], s24 offen offset:2048 lds
M v[192:195], a[100:103], a[172:175], v[192:195]
ds_read_b128 a[184:187], v10 offset:55296
ds_read_b128 a[188:191], v11 offset:55296
M v[196:199], a[108:111], a[172:175], v[196:199]
M v[196:199], a[104:107], a[168:171], v[196:199]
M v[200:203], a[112:115], a[168:171], v[200:203]
M v[200:203], a[116:119], a[172:175], v[200:203]
ds_read_b64_tr_b16 a[92:93], v19 offset:16384
ds_read_b64_tr_b16 a[94:95], v19 offset:18432
M v[204:207], a[124:127], a[172:175], v[204:207]
buffer_load_dwordx4 v9, s[12:15], s24 offen offset:3072 lds
M v[204:207], a[120:123], a[168:171], v[204:207]
M v[208:211], a[128:131], a[168:171], v[208:211]
M v[208:211], a[132:135], a[172:175], v[208:211]
M v[212:215], a[140:143], a[172:175], v[212:215]
M v[212:215], a[136:139], a[168:171], v[212:215]
s_add_u32 s24, s24, 262144
s_cmp_eq_u32 s24, s27
s_cselect_b32 s24, s28, s24
s_sub_u32 s6, s6, 1
s_cmp_eq_u32 s6, 0
s_cselect_b64 s[12:13], s[64:65], s[12:13]
M v[216:219], a[144:147], a[168:171], v[216:219]
M v[216:219], a[148:151], a[172:175], v[216:219]
M v[220:223], a[156:159], a[172:175], v[220:223]
M v[220:223], a[152:155], a[168:171], v[220:223]
s_waitcnt lgkmcnt(10)
M v[224:227], a[96:99], a[176:179], v[224:227]
buffer_load_dword v21, v20, s[60:63], s54 offen
s_add_u32 s54, s54, 1048576
M v[224:227], a[100:103], a[180:183], v[224:227]
M v[228:231], a[108:111], a[180:183], v[228:231]
M v[228:231], a[104:107], a[176:179], v[228:231]
M v[232:235], a[112:115], a[176:179], v[232:235]
M v[232:235], a[116:119], a[180:183], v[232:235]
M v[236:239], a[124:127], a[180:183], v[236:239]
M v[236:239], a[120:123], a[176:179], v[236:239]
s_waitcnt vmcnt(9) lgkmcnt(0)
s_barrier
ds_read_b128 a[160:163], v10 offset:0
ds_read_b128 a[164:167], v11 offset:0
M v[240:243], a[128:131], a[176:179], v[240:243]
s_add_u32 m0, s29, 32768
s_nop 0
buffer_load_dwordx4 v2, s[8:11], s23 offen offset:0 lds
M v[240:243], a[132:135], a[180:183], v[240:243]
M v[244:247], a[140:143], a[180:183], v[244:247]
M v[244:247], a[136:139], a[176:179], v[244:247]
M v[248:251], a[144:147], a[176:179], v[248:251]
M v[248:251], a[148:151], a[180:183], v[248:251]
buffer_load_dwordx4 v3, s[8:11], s23 offen offset:1024 lds
M v[252:255], a[156:159], a[180:183], v[252:255]
M v[252:255], a[152:155], a[176:179], v[252:255]
M a[0:3], a[96:99], a[184:187], a[0:3]
M a[0:3], a[100:103], a[188:191], a[0:3]
ds_read_b128 a[168:171], v10 offset:2048
ds_read_b128 a[172:175], v11 offset:2048
M a[4:7], a[108:111], a[188:191], a[4:7]
M a[4:7], a[104:107], a[184:187], a[4:7]
M a[8:11], a[112:115], a[184:187], a[8:11]
buffer_load_dwordx4 v4, s[8:11], s23 offen offset:2048 lds
M a[8:11], a[116:119], a[188:191], a[8:11]
M a[12:15], a[124:127], a[188:191], a[12:15]
M a[12:15], a[120:123], a[184:187], a[12:15]
M a[16:19], a[128:131], a[184:187], a[16:19]
M a[16:19], a[132:135], a[188:191], a[16:19]
buffer_load_dwordx4 v5, s[8:11], s23 offen offset:3072 lds
M a[20:23], a[140:143], a[188:191], a[20:23]
M a[20:23], a[136:139], a[184:187], a[20:23]
M a[24:27], a[144:147], a[184:187], a[24:27]
M a[24:27], a[148:151], a[188:191], a[24:27]
M a[28:31], a[156:159], a[188:191], a[28:31]
M a[28:31], a[152:155], a[184:187], a[28:31]
s_waitcnt lgkmcnt(2)
s_sub_u32 s30, s30, 1
s_cmp_lg_u32 s30, 0
s_cbranch_scc1 Lk1_ql
M v[32:35], a[32:35], a[160:163], v[32:35]
s_add_u32 m0, s29, 65536
s_nop 0
buffer_load_dwordx4 v6, s[12:15], s24 offen offset:0 lds
M v[32:35], a[36:39], a[164:167], v[32:35]
ds_read_b128 a[176:179], v10 offset:4096
ds_read_b128 a[180:183], v11 offset:4096
M v[36:39], a[44:47], a[164:167], v[36:39]
M v[36:39], a[40:43], a[160:163], v[36:39]
ds_read_b64_tr_b16 a[96:97], v12 offset:32768
ds_read_b64_tr_b16 a[98:99], v12 offset:34816
M v[40:43], a[48:51], a[160:163], v[40:43]
M v[40:43], a[52:55], a[164:167], v[40:43]
M v[44:47], a[60:63], a[164:167], v[44:47]
M v[44:47], a[56:59], a[160:163], v[44:47]
ds_read_b64_tr_b16 a[104:105], v13 offset:32768
ds_read_b64_tr_b16 a[106:107], v13 offset:34816
M v[48:51], a[64:67], a[160:163], v[48:51]
buffer_load_dwordx4 v7, s[12:15], s24 offen offset:1024 lds
M v[48:51], a[68:71], a[164:167], v[48:51]
M v[52:55], a[76:79], a[164:167], v[52:55]
M v[52:55], a[72:75], a[160:163], v[52:55]
ds_read_b64_tr_b16 a[112:113], v14 offset:32768
ds_read_b64_tr_b16 a[114:115], v14 offset:34816
M v[56:59], a[80:83], a[160:163], v[56:59]
M v[56:59], a[84:87], a[164:167], v[56:59]
M v[60:63], a[92:95], a[164:167], v[60:63]
buffer_load_dwordx4 v8, s[12:15], s24 offen offset:2048 lds
M v[60:63], a[88:91], a[160:163], v[60:63]
s_waitcnt lgkmcnt(8)
ds_read_b64_tr_b16 a[120:121], v15 offset:32768
ds_read_b64_tr_b16 a[122:123], v15 offset:34816
M v[64:67], a[32:35], a[168:171], v[64:67]
M v[64:67], a[36:39], a[172:175], v[64:67]
ds_read_b128 a[184:187], v10 offset:6144
ds_read_b128 a[188:191], v11 offset:6144
M v[68:71], a[44:47], a[172:175], v[68:71]
M v[68:71], a[40:43], a[168:171], v[68:71]
ds_read_b64_tr_b16 a[128:129], v16 offset:32768
ds_read_b64_tr_b16 a[130:131], v16 offset:34816
M v[72:75], a[48:51], a[168:171], v[72:75]
M v[72:75], a[52:55], a[172:175], v[72:75]
M v[76:79], a[60:63], a[172:175], v[76:79]
M v[76:79], a[56:59], a[168:171], v[76:79]
ds_read_b64_tr_b16 a[136:137], v17 offset:32768
ds_read_b64_tr_b16 a[138:139], v17 offset:34816
M v[80:83], a[64:67], a[168:171], v[80:83]
buffer_load_dwordx4 v9, s[12:15], s24 offen offset:3072 lds
M v[80:83], a[68:71], a[172:175], v[80:83]
M v[84:87], a[76:79], a[172:175], v[84:87]
M v[84:87], a[72:75], a[168:171], v[84:87]
ds_read_b64_tr_b16 a[144:145], v18 offset:32768
ds_read_b64_tr_b16 a[146:147], v18 offset:34816
M v[88:91], a[80:83], a[168:171], v[88:91]
M v[88:91], a[84:87], a[172:175], v[88:91]
M v[92:95], a[92:95], a[172:175], v[92:95]
s_add_u32 s24, s24, 262144
M v[92:95], a[88:91], a[168:171], v[92:95]
s_waitcnt lgkmcnt(15)
ds_read_b64_tr_b16 a[152:153], v19 offset:32768
ds_read_b64_tr_b16 a[154:155], v19 offset:34816
M v[96:99], a[32:35], a[176:179], v[96:99]
M v[96:99], a[36:39], a[180:183], v[96:99]
M v[100:103], a[44:47], a[180:183], v[100:103]
M v[100:103], a[40:43], a[176:179], v[100:103]
M v[104:107], a[48:51], a[176:179], v[104:107]
M v[104:107], a[52:55], a[180:183], v[104:107]
M v[108:111], a[60:63], a[180:183], v[108:111]
M v[108:111], a[56:59], a[176:179], v[108:111]
s_waitcnt vmcnt(9) lgkmcnt(0)
s_barrier
ds_read_b128 a[160:163], v10 offset:16384
ds_read_b128 a[164:167], v11 offset:16384
M v[112:115], a[64:67], a[176:179], v[112:115]
s_add_u32 m0, s29, 49152
s_add_u32 s3, s23, s31
buffer_load_dwordx4 v2, s[8:11], s3 offen offset:0 lds
M v[112:115], a[68:71], a[180:183], v[112:115]
M v[116:119], a[76:79], a[180:183], v[116:119]
M v[116:119], a[72:75], a[176:179], v[116:119]
ds_read_b64_tr_b16 a[100:101], v12 offset:49152
ds_read_b64_tr_b16 a[102:103], v12 offset:51200
M v[120:123], a[80:83], a[176:179], v[120:123]
M v[120:123], a[84:87], a[180:183], v[120:123]
buffer_load_dwordx4 v3, s[8:11], s3 offen offset:1024 lds
M v[124:127], a[92:95], a[180:183], v[124:127]
M v[124:127], a[88:91], a[176:179], v[124:127]
M v[128:131], a[32:35], a[184:187], v[128:131]
M v[128:131], a[36:39], a[188:191], v[128:131]
ds_read_b128 a[168:171], v10 offset:18432
ds_read_b128 a[172:175], v11 offset:18432
ds_read_b64_tr_b16 a[108:109], v13 offset:49152
ds_read_b64_tr_b16 a[110:111], v13 offset:51200
M v[132:135], a[44:47], a[188:191], v[132:135]
M v[132:135], a[40:43], a[184:187], v[132:135]
M v[136:139], a[48:51], a[184:187], v[136:139]
buffer_load_dwordx4 v4, s[8:11], s3 offen offset:2048 lds
M v[136:139], a[52:55], a[188:191], v[136:139]
M v[140:143], a[60:63], a[188:191], v[140:143]
M v[140:143], a[56:59], a[184:187], v[140:143]
ds_read_b64_tr_b16 a[116:117], v14 offset:49152
ds_read_b64_tr_b16 a[118:119], v14 offset:51200
M v[144:147], a[64:67], a[184:187], v[144:147]
M v[144:147], a[68:71], a[188:191], v[144:147]
M v[148:151], a[76:79], a[188:191], v[148:151]
buffer_load_dwordx4 v5, s[8:11], s3 offen offset:3072 lds
M v[148:151], a[72:75], a[184:187], v[148:151]
M v[152:155], a[80:83], a[184:187], v[152:155]
M v[152:155], a[84:87], a[188:191], v[152:155]
ds_read_b64_tr_b16 a[124:125], v15 offset:49152
ds_read_b64_tr_b16 a[126:127], v15 offset:51200
M v[156:159], a[92:95], a[188:191], v[156:159]
M v[156:159], a[88:91], a[184:187], v[156:159]
s_waitcnt lgkmcnt(10)
M v[160:163], a[32:35], a[160:163], v[160:163]
M v[160:163], a[36:39], a[164:167], v[160:163]
ds_read_b128 a[176:179], v10 offset:20480
ds_read_b128 a[180:183], v11 offset:20480
M v[164:167], a[44:47], a[164:167], v[164:167]
s_add_u32 s23, s23, 128
s_cmp_eq_u32 s23, s25
s_cselect_b32 s23, s26, s23
M v[164:167], a[40:43], a[160:163], v[164:167]
ds_read_b64_tr_b16 a[132:133], v16 offset:49152
ds_read_b64_tr_b16 a[134:135], v16 offset:51200
M v[168:171], a[48:51], a[160:163], v[168:171]
M v[168:171], a[52:55], a[164:167], v[168:171]
M v[172:175], a[60:63], a[164:167], v[172:175]
M v[172:175], a[56:59], a[160:163], v[172:175]
M v[176:179], a[64:67], a[160:163], v[176:179]
s_add_u32 m0, s29, 81920
s_nop 0
buffer_load_dwordx4 v6, s[12:15], s24 offen offset:0 lds
M v[176:179], a[68:71], a[164:167], v[176:179]
ds_read_b64_tr_b16 a[140:141], v17 offset:49152
ds_read_b64_tr_b16 a[142:143], v17 offset:51200
M v[180:183], a[76:79], a[164:167], v[180:183]
M v[180:183], a[72:75], a[160:163], v[180:183]
M v[184:187], a[80:83], a[160:163], v[184:187]
M v[184:187], a[84:87], a[164:167], v[184:187]
buffer_load_dwordx4 v7, s[12:15], s24 offen offset:1024 lds
M v[188:191], a[92:95], a[164:167], v[188:191]
M v[188:191], a[88:91], a[160:163], v[188:191]
s_waitcnt lgkmcnt(12)
ds_read_b64_tr_b16 a[148:149], v18 offset:49152
ds_read_b64_tr_b16 a[150:151], v18 offset:51200
M v[192:195], a[32:35], a[168:171], v[192:195]
M v[192:195], a[36:39], a[172:175], v[192:195]
ds_read_b128 a[184:187], v10 offset:22528
ds_read_b128 a[188:191], v11 offset:22528
M v[196:199], a[44:47], a[172:175], v[196:199]
M v[196:199], a[40:43], a[168:171], v[196:199]
M v[200:203], a[48:51], a[168:171], v[200:203]
buffer_load_dwordx4 v8, s[12:15], s24 offen offset:2048 lds
M v[200:203], a[52:55], a[172:175], v[200:203]
ds_read_b64_tr_b16 a[156:157], v19 offset:49152
ds_read_b64_tr_b16 a[158:159], v19 offset:51200
M v[204:207], a[60:63], a[172:175], v[204:207]
M v[204:207], a[56:59], a[168:171], v[204:207]
M v[208:211], a[64:67], a[168:171], v[208:211]
M v[208:211], a[68:71], a[172:175], v[208:211]
M v[212:215], a[76:79], a[172:175], v[212:215]
buffer_load_dwordx4 v9, s[12:15], s24 offen offset:3072 lds
M v[212:215], a[72:75], a[168:171], v[212:215]
M v[216:219], a[80:83], a[168:171], v[216:219]
M v[216:219], a[84:87], a[172:175], v[216:219]
M v[220:223], a[92:95], a[172:175], v[220:223]
M v[220:223], a[88:91], a[168:171], v[220:223]
s_waitcnt lgkmcnt(10)
M v[224:227], a[32:35], a[176:179], v[224:227]
s_add_u32 s24, s24, 262144
s_cmp_eq_u32 s24, s27
s_cselect_b32 s24, s28, s24
s_sub_u32 s6, s6, 1
s_cmp_eq_u32 s6, 0
s_cselect_b64 s[12:13], s[64:65], s[12:13]
M v[224:227], a[36:39], a[180:183], v[224:227]
M v[228:231], a[44:47], a[180:183], v[228:231]
M v[228:231], a[40:43], a[176:179], v[228:231]
M v[232:235], a[48:51], a[176:179], v[232:235]
M v[232:235], a[52:55], a[180:183], v[232:235]
M v[236:239], a[60:63], a[180:183], v[236:239]
M v[236:239], a[56:59], a[176:179], v[236:239]
s_waitcnt vmcnt(8) lgkmcnt(0)
s_barrier
ds_read_b128 a[160:163], v10 offset:32768
ds_read_b128 a[164:167], v11 offset:32768
M v[240:243], a[64:67], a[176:179], v[240:243]
s_add_u32 m0, s29, 0
s_nop 0
buffer_load_dwordx4 v2, s[8:11], s23 offen offset:0 lds
M v[240:243], a[68:71], a[180:183], v[240:243]
M v[244:247], a[76:79], a[180:183], v[244:247]
M v[244:247], a[72:75], a[176:179], v[244:247]
M v[248:251], a[80:83], a[176:179], v[248:251]
M v[248:251], a[84:87], a[180:183], v[248:251]
buffer_load_dwordx4 v3, s[8:11], s23 offen offset:1024 lds
M v[252:255], a[92:95], a[180:183], v[252:255]
M v[252:255], a[88:91], a[176:179], v[252:255]
M a[0:3], a[32:35], a[184:187], a[0:3]
M a[0:3], a[36:39], a[188:191], a[0:3]
ds_read_b128 a[168:171], v10 offset:34816
ds_read_b128 a[172:175], v11 offset:34816
M a[4:7], a[44:47], a[188:191], a[4:7]
M a[4:7], a[40:43], a[184:187], a[4:7]
M a[8:11], a[48:51], a[184:187], a[8:11]
buffer_load_dwordx4 v4, s[8:11], s23 offen offset:2048 lds
M a[8:11], a[52:55], a[188:191], a[8:11]
M a[12:15], a[60:63], a[188:191], a[12:15]
M a[12:15], a[56:59], a[184:187], a[12:15]
M a[16:19], a[64:67], a[184:187], a[16:19]
M a[16:19], a[68:71], a[188:191], a[16:19]
buffer_load_dwordx4 v5, s[8:11], s23 offen offset:3072 lds
M a[20:23], a[76:79], a[188:191], a[20:23]
M a[20:23], a[72:75], a[184:187], a[20:23]
M a[24:27], a[80:83], a[184:187], a[24:27]
M a[24:27], a[84:87], a[188:191], a[24:27]
M a[28:31], a[92:95], a[188:191], a[28:31]
M a[28:31], a[88:91], a[184:187], a[28:31]
s_waitcnt lgkmcnt(2)
M v[32:35], a[96:99], a[160:163], v[32:35]
s_add_u32 m0, s29, 98304
s_nop 0
buffer_load_dwordx4 v6, s[12:15], s24 offen offset:0 lds
M v[32:35], a[100:103], a[164:167], v[32:35]
ds_read_b128 a[176:179], v10 offset:36864
ds_read_b128 a[180:183], v11 offset:36864
M v[36:39], a[108:111], a[164:167], v[36:39]
M v[36:39], a[104:107], a[160:163], v[36:39]
ds_read_b64_tr_b16 a[32:33], v12 offset:0
ds_read_b64_tr_b16 a[34:35], v12 offset:2048
M v[40:43], a[112:115], a[160:163], v[40:43]
M v[40:43], a[116:119], a[164:167], v[40:43]
M v[44:47], a[124:127], a[164:167], v[44:47]
M v[44:47], a[120:123], a[160:163], v[44:47]
ds_read_b64_tr_b16 a[40:41], v13 offset:0
ds_read_b64_tr_b16 a[42:43], v13 offset:2048
M v[48:51], a[128:131], a[160:163], v[48:51]
buffer_load_dwordx4 v7, s[12:15], s24 offen offset:1024 lds
M v[48:51], a[132:135], a[164:167], v[48:51]
M v[52:55], a[140:143], a[164:167], v[52:55]
M v[52:55], a[136:139], a[160:163], v[52:55]
ds_read_b64_tr_b16 a[48:49], v14 offset:0
ds_read_b64_tr_b16 a[50:51], v14 offset:2048
M v[56:59], a[144:147], a[160:163], v[56:59]
M v[56:59], a[148:151], a[164:167], v[56:59]
M v[60:63], a[156:159], a[164:167], v[60:63]
buffer_load_dwordx4 v8, s[12:15], s24 offen offset:2048 lds
M v[60:63], a[152:155], a[160:163], v[60:63]
s_waitcnt lgkmcnt(8)
ds_read_b64_tr_b16 a[56:57], v15 offset:0
ds_read_b64_tr_b16 a[58:59], v15 offset:2048
M v[64:67], a[96:99], a[168:171], v[64:67]
M v[64:67], a[100:103], a[172:175], v[64:67]
ds_read_b128 a[184:187], v10 offset:38912
ds_read_b128 a[188:191], v11 offset:38912
M v[68:71], a[108:111], a[172:175], v[68:71]
M v[68:71], a[104:107], a[168:171], v[68:71]
ds_read_b64_tr_b16 a[64:65], v16 offset:0
ds_read_b64_tr_b16 a[66:67], v16 offset:2048
M v[72:75], a[112:115], a[168:171], v[72:75]
M v[72:75], a[116:119], a[172:175], v[72:75]
M v[76:79], a[124:127], a[172:175], v[76:79]
M v[76:79], a[120:123], a[168:171], v[76:79]
ds_read_b64_tr_b16 a[72:73], v17 offset:0
ds_read_b64_tr_b16 a[74:75], v17 offset:2048
M v[80:83], a[128:131], a[168:171], v[80:83]
buffer_load_dwordx4 v9, s[12:15], s24 offen offset:3072 lds
M v[80:83], a[132:135], a[172:175], v[80:83]
M v[84:87], a[140:143], a[172:175], v[84:87]
M v[84:87], a[136:139], a[168:171], v[84:87]
ds_read_b64_tr_b16 a[80:81], v18 offset:0
ds_read_b64_tr_b16 a[82:83], v18 offset:2048
M v[88:91], a[144:147], a[168:171], v[88:91]
M v[88:91], a[148:151], a[172:175], v[88:91]
M v[92:95], a[156:159], a[172:175], v[92:95]
s_add_u32 s24, s24, 262144
M v[92:95], a[152:155], a[168:171], v[92:95]
s_waitcnt lgkmcnt(15)
ds_read_b64_tr_b16 a[88:89], v19 offset:0
ds_read_b64_tr_b16 a[90:91], v19 offset:2048
M v[96:99], a[96:99], a[176:179], v[96:99]
M v[96:99], a[100:103], a[180:183], v[96:99]
M v[100:103], a[108:111], a[180:183], v[100:103]
M v[100:103], a[104:107], a[176:179], v[100:103]
M v[104:107], a[112:115], a[176:179], v[104:107]
M v[104:107], a[116:119], a[180:183], v[104:107]
M v[108:111], a[124:127], a[180:183], v[108:111]
M v[108:111], a[120:123], a[176:179], v[108:111]
s_waitcnt vmcnt(8) lgkmcnt(0)
s_barrier
ds_read_b128 a[160:163], v10 offset:49152
ds_read_b128 a[164:167], v11 offset:49152
M v[112:115], a[128:131], a[176:179], v[112:115]
s_add_u32 m0, s29, 16384
s_add_u32 s3, s23, s31
buffer_load_dwordx4 v2, s[8:11], s3 offen offset:0 lds
M v[112:115], a[132:135], a[180:183], v[112:115]
M v[116:119], a[140:143], a[180:183], v[116:119]
M v[116:119], a[136:139], a[176:179], v[116:119]
ds_read_b64_tr_b16 a[36:37], v12 offset:16384
ds_read_b64_tr_b16 a[38:39], v12 offset:18432
M v[120:123], a[144:147], a[176:179], v[120:123]
M v[120:123], a[148:151], a[180:183], v[120:123]
buffer_load_dwordx4 v3, s[8:11], s3 offen offset:1024 lds
M v[124:127], a[156:159], a[180:183], v[124:127]
M v[124:127], a[152:155], a[176:179], v[124:127]
M v[128:131], a[96:99], a[184:187], v[128:131]
M v[128:131], a[100:103], a[188:191], v[128:131]
ds_read_b128 a[168:171], v10 offset:51200
ds_read_b128 a[172:175], v11 offset:51200
ds_read_b64_tr_b16 a[44:45], v13 offset:16384
ds_read_b64_tr_b16 a[46:47], v13 offset:18432
M v[132:135], a[108:111], a[188:191], v[132:135]
M v[132:135], a[104:107], a[184:187], v[132:135]
M v[136:139], a[112:115], a[184:187], v[136:139]
buffer_load_dwordx4 v4, s[8:11], s3 offen offset:2048 lds
M v[136:139], a[116:119], a[188:191], v[136:139]
M v[140:143], a[124:127], a[188:191], v[140:143]
M v[140:143], a[120:123], a[184:187], v[140:143]
ds_read_b64_tr_b16 a[52:53], v14 offset:16384
ds_read_b64_tr_b16 a[54:55], v14 offset:18432
M v[144:147], a[128:131], a[184:187], v[144:147]
M v[144:147], a[132:135], a[188:191], v[144:147]
M v[148:151], a[140:143], a[188:191], v[148:151]
buffer_load_dwordx4 v5, s[8:11], s3 offen offset:3072 lds
M v[148:151], a[136:139], a[184:187], v[148:151]
M v[152:155], a[144:147], a[184:187], v[152:155]
M v[152:155], a[148:151], a[188:191], v[152:155]
ds_read_b64_tr_b16 a[60:61], v15 offset:16384
ds_read_b64_tr_b16 a[62:63], v15 offset:18432
M v[156:159], a[156:159], a[188:191], v[156:159]
M v[156:159], a[152:155], a[184:187], v[156:159]
s_waitcnt lgkmcnt(10)
M v[160:163], a[96:99], a[160:163], v[160:163]
s_add_u32 s23, s23, 128
s_cmp_eq_u32 s23, s25
s_cselect_b32 s23, s26, s23
M v[160:163], a[100:103], a[164:167], v[160:163]
ds_read_b128 a[176:179], v10 offset:53248
ds_read_b128 a[180:183], v11 offset:53248
M v[164:167], a[108:111], a[164:167], v[164:167]
M v[164:167], a[104:107], a[160:163], v[164:167]
ds_read_b64_tr_b16 a[68:69], v16 offset:16384
ds_read_b64_tr_b16 a[70:71], v16 offset:18432
M v[168:171], a[112:115], a[160:163], v[168:171]
M v[168:171], a[116:119], a[164:167], v[168:171]
M v[172:175], a[124:127], a[164:167], v[172:175]
M v[172:175], a[120:123], a[160:163], v[172:175]
s_add_u32 m0, s29, 114688
s_nop 0
buffer_load_dwordx4 v6, s[12:15], s24 offen offset:0 lds
M v[176:179], a[128:131], a[160:163], v[176:179]
M v[176:179], a[132:135], a[164:167], v[176:179]
ds_read_b64_tr_b16 a[76:77], v17 offset:16384
ds_read_b64_tr_b16 a[78:79], v17 offset:18432
M v[180:183], a[140:143], a[164:167], v[180:183]
M v[180:183], a[136:139], a[160:163], v[180:183]
M v[184:187], a[144:147], a[160:163], v[184:187]
M v[184:187], a[148:151], a[164:167], v[184:187]
buffer_load_dwordx4 v7, s[12:15], s24 offen offset:1024 lds
M v[188:191], a[156:159], a[164:167], v[188:191]
M v[188:191], a[152:155], a[160:163], v[188:191]
s_waitcnt lgkmcnt(12)
ds_read_b64_tr_b16 a[84:85], v18 offset:16384
ds_read_b64_tr_b16 a[86:87], v18 offset:18432
M v[192:195], a[96:99], a[168:171], v[192:195]
M v[192:195], a[100:103], a[172:175], v[192:195]
ds_read_b128 a[184:187], v10 offset:55296
ds_read_b128 a[188:191], v11 offset:55296
M v[196:199], a[108:111], a[172:175], v[196:199]
M v[196:199], a[104:107], a[168:171], v[196:199]
buffer_load_dwordx4 v8, s[12:15], s24 offen offset:2048 lds
M v[200:203], a[112:115], a[168:171], v[200:203]
M v[200:203], a[116:119], a[172:175], v[200:203]
ds_read_b64_tr_b16 a[92:93], v19 offset:16384
ds_read_b64_tr_b16 a[94:95], v19 offset:18432
M v[204:207], a[124:127], a[172:175], v[204:207]
M v[204:207], a[120:123], a[168:171], v[204:207]
M v[208:211], a[128:131], a[168:171], v[208:211]
M v[208:211], a[132:135], a[172:175], v[208:211]
buffer_load_dwordx4 v9, s[12:15], s24 offen offset:3072 lds
M v[212:215], a[140:143], a[172:175], v[212:215]
s_getpc_b64 s[56:57]
Lpcc0:
s_add_u32 s56, s56, Lk1_b-Lpcc0
s_addc_u32 s57, s57, 0
s_lshr_b32 s58, s2, 3
s_lshl2_add_u32 s58, s58, s101
s_mul_i32 s58, s58, (((Lc2-Lk1_b)/128+127)&~127)
v_lshlrev_b32 v22, 7, v0
v_min_u32 v22, (((Lc2-Lk1_b)/128+127)&~127)-128, v22
v_add_u32 v22, s58, v22
v_min_u32 v22, Lc2-Lk1_b-4, v22
global_load_dword a255, v22, s[56:57]
M v[212:215], a[136:139], a[168:171], v[212:215]
M v[216:219], a[144:147], a[168:171], v[216:219]
M v[216:219], a[148:151], a[172:175], v[216:219]
M v[220:223], a[156:159], a[172:175], v[220:223]
M v[220:223], a[152:155], a[168:171], v[220:223]
s_waitcnt lgkmcnt(10)
M v[224:227], a[96:99], a[176:179], v[224:227]
s_add_u32 s24, s24, 262144
s_cmp_eq_u32 s24, s27
s_cselect_b32 s24, s28, s24
s_sub_u32 s6, s6, 1
s_cmp_eq_u32 s6, 0
s_cselect_b64 s[12:13], s[64:65], s[12:13]
M v[224:227], a[100:103], a[180:183], v[224:227]
M v[228:231], a[108:111], a[180:183], v[228:231]
M v[228:231], a[104:107], a[176:179], v[228:231]
M v[232:235], a[112:115], a[176:179], v[232:235]
M v[232:235], a[116:119], a[180:183], v[232:235]
M v[236:239], a[124:127], a[180:183], v[236:239]
M v[236:239], a[120:123], a[176:179], v[236:239]
s_waitcnt vmcnt(9) lgkmcnt(0)
s_barrier
ds_read_b128 a[160:163], v10 offset:0
ds_read_b128 a[164:167], v11 offset:0
M v[240:243], a[128:131], a[176:179], v[240:243]
s_add_u32 m0, s29, 32768
s_nop 0
buffer_load_dwordx4 v2, s[8:11], s23 offen offset:0 lds
M v[240:243], a[132:135], a[180:183], v[240:243]
M v[244:247], a[140:143], a[180:183], v[244:247]
M v[244:247], a[136:139], a[176:179], v[244:247]
M v[248:251], a[144:147], a[176:179], v[248:251]
M v[248:251], a[148:151], a[180:183], v[248:251]
M v[252:255], a[156:159], a[180:183], v[252:255]
M v[252:255], a[152:155], a[176:179], v[252:255]
M a[0:3], a[96:99], a[184:187], a[0:3]
M a[0:3], a[100:103], a[188:191], a[0:3]
ds_read_b128 a[168:171], v10 offset:2048
ds_read_b128 a[172:175], v11 offset:2048
M a[4:7], a[108:111], a[188:191], a[4:7]
M a[4:7], a[104:107], a[184:187], a[4:7]
M a[8:11], a[112:115], a[184:187], a[8:11]
buffer_load_dwordx4 v3, s[8:11], s23 offen offset:1024 lds
M a[8:11], a[116:119], a[188:191], a[8:11]
M a[12:15], a[124:127], a[188:191], a[12:15]
M a[12:15], a[120:123], a[184:187], a[12:15]
M a[16:19], a[128:131], a[184:187], a[16:19]
M a[16:19], a[132:135], a[188:191], a[16:19]
M a[20:23], a[140:143], a[188:191], a[20:23]
M a[20:23], a[136:139], a[184:187], a[20:23]
M a[24:27], a[144:147], a[184:187], a[24:27]
M a[24:27], a[148:151], a[188:191], a[24:27]
M a[28:31], a[156:159], a[188:191], a[28:31]
M a[28:31], a[152:155], a[184:187], a[28:31]
s_waitcnt lgkmcnt(2)
M v[32:35], a[32:35], a[160:163], v[32:35]
buffer_load_dwordx4 v4, s[8:11], s23 offen offset:2048 lds
M v[32:35], a[36:39], a[164:167], v[32:35]
ds_read_b128 a[176:179], v10 offset:4096
ds_read_b128 a[180:183], v11 offset:4096
M v[36:39], a[44:47], a[164:167], v[36:39]
M v[36:39], a[40:43], a[160:163], v[36:39]
ds_read_b64_tr_b16 a[96:97], v12 offset:32768
ds_read_b64_tr_b16 a[98:99], v12 offset:34816
M v[40:43], a[48:51], a[160:163], v[40:43]
M v[40:43], a[52:55], a[164:167], v[40:43]
M v[44:47], a[60:63], a[164:167], v[44:47]
M v[44:47], a[56:59], a[160:163], v[44:47]
ds_read_b64_tr_b16 a[104:105], v13 offset:32768
ds_read_b64_tr_b16 a[106:107], v13 offset:34816
M v[48:51], a[64:67], a[160:163], v[48:51]
M v[48:51], a[68:71], a[164:167], v[48:51]
M v[52:55], a[76:79], a[164:167], v[52:55]
M v[52:55], a[72:75], a[160:163], v[52:55]
ds_read_b64_tr_b16 a[112:113], v14 offset:32768
ds_read_b64_tr_b16 a[114:115], v14 offset:34816
M v[56:59], a[80:83], a[160:163], v[56:59]
M v[56:59], a[84:87], a[164:167], v[56:59]
M v[60:63], a[92:95], a[164:167], v[60:63]
M v[60:63], a[88:91], a[160:163], v[60:63]
s_waitcnt lgkmcnt(8)
ds_read_b64_tr_b16 a[120:121], v15 offset:32768
ds_read_b64_tr_b16 a[122:123], v15 offset:34816
M v[64:67], a[32:35], a[168:171], v[64:67]
M v[64:67], a[36:39], a[172:175], v[64:67]
ds_read_b128 a[184:187], v10 offset:6144
ds_read_b128 a[188:191], v11 offset:6144
M v[68:71], a[44:47], a[172:175], v[68:71]
M v[68:71], a[40:43], a[168:171], v[68:71]
ds_read_b64_tr_b16 a[128:129], v16 offset:32768
ds_read_b64_tr_b16 a[130:131], v16 offset:34816
M v[72:75], a[48:51], a[168:171], v[72:75]
buffer_load_dwordx4 v5, s[8:11], s23 offen offset:3072 lds
M v[72:75], a[52:55], a[172:175], v[72:75]
M v[76:79], a[60:63], a[172:175], v[76:79]
M v[76:79], a[56:59], a[168:171], v[76:79]
ds_read_b64_tr_b16 a[136:137], v17 offset:32768
ds_read_b64_tr_b16 a[138:139], v17 offset:34816
M v[80:83], a[64:67], a[168:171], v[80:83]
M v[80:83], a[68:71], a[172:175], v[80:83]
M v[84:87], a[76:79], a[172:175], v[84:87]
M v[84:87], a[72:75], a[168:171], v[84:87]
ds_read_b64_tr_b16 a[144:145], v18 offset:32768
ds_read_b64_tr_b16 a[146:147], v18 offset:34816
M v[88:91], a[80:83], a[168:171], v[88:91]
M v[88:91], a[84:87], a[172:175], v[88:91]
M v[92:95], a[92:95], a[172:175], v[92:95]
M v[92:95], a[88:91], a[168:171], v[92:95]
s_waitcnt lgkmcnt(15)
ds_read_b64_tr_b16 a[152:153], v19 offset:32768
ds_read_b64_tr_b16 a[154:155], v19 offset:34816
M v[96:99], a[32:35], a[176:179], v[96:99]
M v[96:99], a[36:39], a[180:183], v[96:99]
M v[100:103], a[44:47], a[180:183], v[100:103]
M v[100:103], a[40:43], a[176:179], v[100:103]
M v[104:107], a[48:51], a[176:179], v[104:107]
M v[104:107], a[52:55], a[180:183], v[104:107]
M v[108:111], a[60:63], a[180:183], v[108:111]
M v[108:111], a[56:59], a[176:179], v[108:111]
s_waitcnt vmcnt(5) lgkmcnt(0)
s_barrier
ds_read_b128 a[160:163], v10 offset:16384
ds_read_b128 a[164:167], v11 offset:16384
M v[112:115], a[64:67], a[176:179], v[112:115]
s_add_u32 m0, s29, 49152
s_add_u32 s3, s23, s31
buffer_load_dwordx4 v2, s[8:11], s3 offen offset:0 lds
M v[112:115], a[68:71], a[180:183], v[112:115]
M v[116:119], a[76:79], a[180:183], v[116:119]
buffer_load_dwordx4 v3, s[8:11], s3 offen offset:1024 lds
M v[116:119], a[72:75], a[176:179], v[116:119]
ds_read_b64_tr_b16 a[100:101], v12 offset:49152
ds_read_b64_tr_b16 a[102:103], v12 offset:51200
M v[120:123], a[80:83], a[176:179], v[120:123]
buffer_load_dwordx4 v4, s[8:11], s3 offen offset:2048 lds
M v[120:123], a[84:87], a[180:183], v[120:123]
M v[124:127], a[92:95], a[180:183], v[124:127]
buffer_load_dwordx4 v5, s[8:11], s3 offen offset:3072 lds
M v[124:127], a[88:91], a[176:179], v[124:127]
M v[128:131], a[32:35], a[184:187], v[128:131]
M v[128:131], a[36:39], a[188:191], v[128:131]
ds_read_b128 a[168:171], v10 offset:18432
ds_read_b128 a[172:175], v11 offset:18432
ds_read_b64_tr_b16 a[108:109], v13 offset:49152
ds_read_b64_tr_b16 a[110:111], v13 offset:51200
M v[132:135], a[44:47], a[188:191], v[132:135]
M v[132:135], a[40:43], a[184:187], v[132:135]
M v[136:139], a[48:51], a[184:187], v[136:139]
s_and_b32 s3, s2, 1
s_lshl_b32 s3, s3, 3
s_bfe_u32 s4, s2, 0x30003
s_add_u32 s26, s3, s4
M v[136:139], a[52:55], a[188:191], v[136:139]
s_bfe_u32 s3, s2, 0x20001
s_lshl_b32 s3, s3, 2
s_lshr_b32 s4, s2, 6
M v[140:143], a[60:63], a[188:191], v[140:143]
s_xor_b32 s4, s4, 3
s_add_u32 s27, s3, s4
s_lshl_b32 s23, s26, 18
M v[140:143], a[56:59], a[184:187], v[140:143]
ds_read_b64_tr_b16 a[116:117], v14 offset:49152
ds_read_b64_tr_b16 a[118:119], v14 offset:51200
s_sub_u32 s24, s23, 32768
s_max_i32 s24, s24, 0
s_lshl_b32 s25, s27, 7
M v[144:147], a[64:67], a[184:187], v[144:147]
s_mov_b64 s[8:9], s[44:45]
s_mov_b32 s10, 4194304
s_mov_b64 s[12:13], s[46:47]
M v[144:147], a[68:71], a[188:191], v[144:147]
s_mov_b32 s14, 6291456
s_mov_b64 s[36:37], s[90:91]
s_mov_b32 s38, 256
M v[148:151], a[76:79], a[188:191], v[148:151]
s_mov_b32 s39, 0x00020000
s_lshl_b32 s28, s20, 9
s_mul_i32 s30, s20, 6144
M v[148:151], a[72:75], a[184:187], v[148:151]
s_lshl_b32 s3, s20, 5
v_lshrrev_b32 v24, 3, v0
v_and_b32 v25, 7, v0
M v[152:155], a[80:83], a[184:187], v[152:155]
v_add_u32 v28, s3, v24
v_add_u32 v26, 0, v28
v_bfe_u32 v27, v26, 1, 3
M v[152:155], a[84:87], a[188:191], v[152:155]
ds_read_b64_tr_b16 a[124:125], v15 offset:49152
ds_read_b64_tr_b16 a[126:127], v15 offset:51200
v_xor_b32 v27, v27, v25
v_lshlrev_b32 v26, 11, v26
v_lshl_add_u32 v26, v27, 4, v26
M v[156:159], a[92:95], a[188:191], v[156:159]
v_subrev_u32 v2, 0, v26
v_add_u32 v26, 8, v28
v_bfe_u32 v27, v26, 1, 3
M v[156:159], a[88:91], a[184:187], v[156:159]
s_waitcnt lgkmcnt(10)
v_xor_b32 v27, v27, v25
v_lshlrev_b32 v26, 11, v26
v_lshl_add_u32 v26, v27, 4, v26
M v[160:163], a[32:35], a[160:163], v[160:163]
v_subrev_u32 v3, 1024, v26
v_add_u32 v26, 16, v28
v_bfe_u32 v27, v26, 1, 3
M v[160:163], a[36:39], a[164:167], v[160:163]
ds_read_b128 a[176:179], v10 offset:20480
ds_read_b128 a[180:183], v11 offset:20480
v_xor_b32 v27, v27, v25
v_lshlrev_b32 v26, 11, v26
v_lshl_add_u32 v26, v27, 4, v26
M v[164:167], a[44:47], a[164:167], v[164:167]
v_subrev_u32 v4, 2048, v26
v_add_u32 v26, 24, v28
v_bfe_u32 v27, v26, 1, 3
M v[164:167], a[40:43], a[160:163], v[164:167]
ds_read_b64_tr_b16 a[132:133], v16 offset:49152
ds_read_b64_tr_b16 a[134:135], v16 offset:51200
v_xor_b32 v27, v27, v25
v_lshlrev_b32 v26, 11, v26
v_lshl_add_u32 v26, v27, 4, v26
M v[168:171], a[48:51], a[160:163], v[168:171]
v_subrev_u32 v5, 3072, v26
s_lshl_b32 s3, s20, 2
v_lshrrev_b32 v26, 5, v0
M v[168:171], a[52:55], a[164:167], v[168:171]
v_add_u32 v26, s3, v26
v_bfe_u32 v29, v0, 2, 3
v_bfe_u32 v27, v26, 1, 3
M v[172:175], a[60:63], a[164:167], v[172:175]
v_xor_b32 v27, v27, v29
v_lshlrev_b32 v27, 4, v27
v_and_b32 v30, 3, v0
M v[172:175], a[56:59], a[160:163], v[172:175]
v_lshl_add_u32 v27, v30, 2, v27
v_lshl_add_u32 v20, v26, 11, v27
v_add_u32 v26, 2, v26
M v[176:179], a[64:67], a[160:163], v[176:179]
v_bfe_u32 v27, v26, 1, 3
v_xor_b32 v27, v27, v29
v_lshlrev_b32 v27, 4, v27
M v[176:179], a[68:71], a[164:167], v[176:179]
ds_read_b64_tr_b16 a[140:141], v17 offset:49152
ds_read_b64_tr_b16 a[142:143], v17 offset:51200
v_and_b32 v30, 3, v0
v_lshl_add_u32 v27, v30, 2, v27
v_lshl_add_u32 v23, v26, 11, v27
M v[180:183], a[76:79], a[164:167], v[180:183]
v_subrev_u32 v23, 256, v23
s_mul_i32 s3, s20, 48
v_add_u32 v28, s3, v24
M v[180:183], a[72:75], a[160:163], v[180:183]
v_add_u32 v26, 0, v28
v_mul_u32_u24 v27, 0xaaab, v26
v_lshrrev_b32 v27, 17, v27
M v[184:187], a[80:83], a[160:163], v[184:187]
v_lshrrev_b32 v29, 1, v27
v_and_b32 v29, 4, v29
v_and_or_b32 v27, v27, 2, v29
M v[184:187], a[84:87], a[164:167], v[184:187]
v_xor_b32 v27, v27, v25
v_lshlrev_b32 v26, 11, v26
v_lshl_add_u32 v26, v27, 4, v26
M v[188:191], a[92:95], a[164:167], v[188:191]
v_subrev_u32 v6, 0, v26
v_add_u32 v26, 8, v28
v_mul_u32_u24 v27, 0xaaab, v26
M v[188:191], a[88:91], a[160:163], v[188:191]
s_waitcnt lgkmcnt(12)
ds_read_b64_tr_b16 a[148:149], v18 offset:49152
ds_read_b64_tr_b16 a[150:151], v18 offset:51200
v_lshrrev_b32 v27, 17, v27
v_lshrrev_b32 v29, 1, v27
v_and_b32 v29, 4, v29
M v[192:195], a[32:35], a[168:171], v[192:195]
v_and_or_b32 v27, v27, 2, v29
v_xor_b32 v27, v27, v25
v_lshlrev_b32 v26, 11, v26
M v[192:195], a[36:39], a[172:175], v[192:195]
ds_read_b128 a[184:187], v10 offset:22528
ds_read_b128 a[188:191], v11 offset:22528
v_lshl_add_u32 v26, v27, 4, v26
v_subrev_u32 v7, 1024, v26
v_add_u32 v26, 16, v28
M v[196:199], a[44:47], a[172:175], v[196:199]
v_mul_u32_u24 v27, 0xaaab, v26
v_lshrrev_b32 v27, 17, v27
v_lshrrev_b32 v29, 1, v27
M v[196:199], a[40:43], a[168:171], v[196:199]
v_and_b32 v29, 4, v29
v_and_or_b32 v27, v27, 2, v29
v_xor_b32 v27, v27, v25
M v[200:203], a[48:51], a[168:171], v[200:203]
v_lshlrev_b32 v26, 11, v26
v_lshl_add_u32 v26, v27, 4, v26
v_subrev_u32 v8, 2048, v26
M v[200:203], a[52:55], a[172:175], v[200:203]
ds_read_b64_tr_b16 a[156:157], v19 offset:49152
ds_read_b64_tr_b16 a[158:159], v19 offset:51200
v_add_u32 v26, 24, v28
v_mul_u32_u24 v27, 0xaaab, v26
v_lshrrev_b32 v27, 17, v27
M v[204:207], a[60:63], a[172:175], v[204:207]
v_lshrrev_b32 v29, 1, v27
v_and_b32 v29, 4, v29
v_and_or_b32 v27, v27, 2, v29
M v[204:207], a[56:59], a[168:171], v[204:207]
v_xor_b32 v27, v27, v25
v_lshlrev_b32 v26, 11, v26
v_lshl_add_u32 v26, v27, 4, v26
M v[208:211], a[64:67], a[168:171], v[208:211]
v_subrev_u32 v9, 3072, v26
v_add_u32 v26, 32, v28
v_mul_u32_u24 v27, 0xaaab, v26
M v[208:211], a[68:71], a[172:175], v[208:211]
v_lshrrev_b32 v27, 17, v27
v_lshrrev_b32 v29, 1, v27
v_and_b32 v29, 4, v29
M v[212:215], a[76:79], a[172:175], v[212:215]
v_and_or_b32 v27, v27, 2, v29
v_xor_b32 v27, v27, v25
v_lshlrev_b32 v26, 11, v26
M v[212:215], a[72:75], a[168:171], v[212:215]
v_lshl_add_u32 v26, v27, 4, v26
v_subrev_u32 v21, 0, v26
v_add_u32 v26, 40, v28
M v[216:219], a[80:83], a[168:171], v[216:219]
v_mul_u32_u24 v27, 0xaaab, v26
v_lshrrev_b32 v27, 17, v27
v_lshrrev_b32 v29, 1, v27
M v[216:219], a[84:87], a[172:175], v[216:219]
v_and_b32 v29, 4, v29
v_and_or_b32 v27, v27, 2, v29
v_xor_b32 v27, v27, v25
M v[220:223], a[92:95], a[172:175], v[220:223]
v_lshlrev_b32 v26, 11, v26
v_lshl_add_u32 v26, v27, 4, v26
v_subrev_u32 v22, 1024, v26
M v[220:223], a[88:91], a[168:171], v[220:223]
s_waitcnt lgkmcnt(10)
s_lshr_b32 s3, s53, 7
s_add_u32 s3, s3, s22
s_lshl_b32 s3, s3, 5
M v[224:227], a[32:35], a[176:179], v[224:227]
s_lshr_b32 s19, s52, 6
s_add_u32 s3, s3, s19
s_lshl_b32 s19, s21, 1
M v[224:227], a[36:39], a[180:183], v[224:227]
s_add_u32 s3, s3, s19
s_lshl_b32 s92, s3, 14
s_add_u32 s93, s92, 16384
M v[228:231], a[44:47], a[180:183], v[228:231]
s_add_u32 s16, s50, 0
s_addc_u32 s17, s51, 0
s_mov_b32 s18, 16777216
M v[228:231], a[40:43], a[176:179], v[228:231]
s_mov_b32 s19, 0x00020000
s_mov_b32 s4, 0x3e0293ee
s_mov_b32 s5, 0x3e0293ee
M v[232:235], a[48:51], a[176:179], v[232:235]
M v[232:235], a[52:55], a[180:183], v[232:235]
M v[236:239], a[60:63], a[180:183], v[236:239]
M v[236:239], a[56:59], a[176:179], v[236:239]
s_waitcnt vmcnt(4) lgkmcnt(0)
s_barrier
ds_read_b128 a[160:163], v10 offset:32768
ds_read_b128 a[164:167], v11 offset:32768
M v[240:243], a[64:67], a[176:179], v[240:243]
s_add_u32 m0, s28, 131072
s_nop 0
buffer_load_dword v20, s[8:11], s24 offen lds
M v[240:243], a[68:71], a[180:183], v[240:243]
M v[244:247], a[76:79], a[180:183], v[244:247]
M v[244:247], a[72:75], a[176:179], v[244:247]
M v[248:251], a[80:83], a[176:179], v[248:251]
buffer_load_dword v23, s[8:11], s24 offen offset:256 lds
s_add_u32 s24, s24, 128
M v[248:251], a[84:87], a[180:183], v[248:251]
M v[252:255], a[92:95], a[180:183], v[252:255]
M v[252:255], a[88:91], a[176:179], v[252:255]
M a[0:3], a[32:35], a[184:187], a[0:3]
M a[0:3], a[36:39], a[188:191], a[0:3]
ds_read_b128 a[168:171], v10 offset:34816
ds_read_b128 a[172:175], v11 offset:34816
M a[4:7], a[44:47], a[188:191], a[4:7]
s_add_u32 m0, s29, 133120
s_nop 0
buffer_load_dwordx4 v2, s[8:11], s23 offen offset:0 lds
M a[4:7], a[40:43], a[184:187], a[4:7]
M a[8:11], a[48:51], a[184:187], a[8:11]
M a[8:11], a[52:55], a[188:191], a[8:11]
M a[12:15], a[60:63], a[188:191], a[12:15]
buffer_load_dwordx4 v3, s[8:11], s23 offen offset:1024 lds
M a[12:15], a[56:59], a[184:187], a[12:15]
M a[16:19], a[64:67], a[184:187], a[16:19]
M a[16:19], a[68:71], a[188:191], a[16:19]
M a[20:23], a[76:79], a[188:191], a[20:23]
buffer_load_dwordx4 v4, s[8:11], s23 offen offset:2048 lds
M a[20:23], a[72:75], a[184:187], a[20:23]
M a[24:27], a[80:83], a[184:187], a[24:27]
M a[24:27], a[84:87], a[188:191], a[24:27]
M a[28:31], a[92:95], a[188:191], a[28:31]
M a[28:31], a[88:91], a[184:187], a[28:31]
s_waitcnt lgkmcnt(2)
M v[32:35], a[96:99], a[160:163], v[32:35]
buffer_load_dwordx4 v5, s[8:11], s23 offen offset:3072 lds
s_add_u32 s23, s23, 128
M v[32:35], a[100:103], a[164:167], v[32:35]
ds_read_b128 a[176:179], v10 offset:36864
ds_read_b128 a[180:183], v11 offset:36864
M v[36:39], a[108:111], a[164:167], v[36:39]
M v[36:39], a[104:107], a[160:163], v[36:39]
M v[40:43], a[112:115], a[160:163], v[40:43]
M v[40:43], a[116:119], a[164:167], v[40:43]
s_add_u32 m0, s30, 65536
s_nop 0
buffer_load_dwordx4 v6, s[12:15], s25 offen offset:0 lds
M v[44:47], a[124:127], a[164:167], v[44:47]
M v[44:47], a[120:123], a[160:163], v[44:47]
M v[48:51], a[128:131], a[160:163], v[48:51]
M v[48:51], a[132:135], a[164:167], v[48:51]
M v[52:55], a[140:143], a[164:167], v[52:55]
buffer_load_dwordx4 v7, s[12:15], s25 offen offset:1024 lds
M v[52:55], a[136:139], a[160:163], v[52:55]
M v[56:59], a[144:147], a[160:163], v[56:59]
M v[56:59], a[148:151], a[164:167], v[56:59]
M v[60:63], a[156:159], a[164:167], v[60:63]
buffer_load_dwordx4 v8, s[12:15], s25 offen offset:2048 lds
M v[60:63], a[152:155], a[160:163], v[60:63]
s_waitcnt lgkmcnt(2)
M v[64:67], a[96:99], a[168:171], v[64:67]
M v[64:67], a[100:103], a[172:175], v[64:67]
ds_read_b128 a[184:187], v10 offset:38912
ds_read_b128 a[188:191], v11 offset:38912
M v[68:71], a[108:111], a[172:175], v[68:71]
M v[68:71], a[104:107], a[168:171], v[68:71]
v_pk_mul_f32 v[32:33], v[32:33], s[4:5]
v_pk_mul_f32 v[34:35], v[34:35], s[4:5]
v_pk_mul_f32 v[36:37], v[36:37], s[4:5]
M v[72:75], a[112:115], a[168:171], v[72:75]
v_pk_mul_f32 v[38:39], v[38:39], s[4:5]
v_cvt_pk_bf16_f32 v32, v32, v33
M v[72:75], a[116:119], a[172:175], v[72:75]
buffer_load_dwordx4 v9, s[12:15], s25 offen offset:3072 lds
v_cvt_pk_bf16_f32 v33, v34, v35
v_cvt_pk_bf16_f32 v34, v36, v37
M v[76:79], a[124:127], a[172:175], v[76:79]
v_cvt_pk_bf16_f32 v35, v38, v39
v_pk_mul_f32 v[40:41], v[40:41], s[4:5]
v_pk_mul_f32 v[42:43], v[42:43], s[4:5]
M v[76:79], a[120:123], a[168:171], v[76:79]
v_pk_mul_f32 v[44:45], v[44:45], s[4:5]
v_pk_mul_f32 v[46:47], v[46:47], s[4:5]
M v[80:83], a[128:131], a[168:171], v[80:83]
v_cvt_pk_bf16_f32 v40, v40, v41
v_cvt_pk_bf16_f32 v41, v42, v43
M v[80:83], a[132:135], a[172:175], v[80:83]
s_add_u32 m0, s30, 69632
s_nop 0
buffer_load_dwordx4 v21, s[12:15], s25 offen offset:0 lds
v_cvt_pk_bf16_f32 v42, v44, v45
v_cvt_pk_bf16_f32 v43, v46, v47
M v[84:87], a[140:143], a[172:175], v[84:87]
v_pk_mul_f32 v[48:49], v[48:49], s[4:5]
v_pk_mul_f32 v[50:51], v[50:51], s[4:5]
v_pk_mul_f32 v[52:53], v[52:53], s[4:5]
M v[84:87], a[136:139], a[168:171], v[84:87]
v_pk_mul_f32 v[54:55], v[54:55], s[4:5]
v_cvt_pk_bf16_f32 v48, v48, v49
M v[88:91], a[144:147], a[168:171], v[88:91]
v_cvt_pk_bf16_f32 v49, v50, v51
v_cvt_pk_bf16_f32 v50, v52, v53
M v[88:91], a[148:151], a[172:175], v[88:91]
v_cvt_pk_bf16_f32 v51, v54, v55
v_pk_mul_f32 v[56:57], v[56:57], s[4:5]
v_pk_mul_f32 v[58:59], v[58:59], s[4:5]
M v[92:95], a[156:159], a[172:175], v[92:95]
buffer_load_dwordx4 v22, s[12:15], s25 offen offset:1024 lds
s_add_u32 s25, s25, 393216
v_pk_mul_f32 v[60:61], v[60:61], s[4:5]
v_pk_mul_f32 v[62:63], v[62:63], s[4:5]
M v[92:95], a[152:155], a[168:171], v[92:95]
s_waitcnt lgkmcnt(2)
v_cvt_pk_bf16_f32 v56, v56, v57
v_cvt_pk_bf16_f32 v57, v58, v59
M v[96:99], a[96:99], a[176:179], v[96:99]
v_cvt_pk_bf16_f32 v58, v60, v61
v_cvt_pk_bf16_f32 v59, v62, v63
M v[96:99], a[100:103], a[180:183], v[96:99]
M v[100:103], a[108:111], a[180:183], v[100:103]
M v[100:103], a[104:107], a[176:179], v[100:103]
v_pk_mul_f32 v[64:65], v[64:65], s[4:5]
v_pk_mul_f32 v[66:67], v[66:67], s[4:5]
v_pk_mul_f32 v[68:69], v[68:69], s[4:5]
M v[104:107], a[112:115], a[176:179], v[104:107]
s_add_u32 s94, s92, 0
buffer_store_dwordx4 v[32:35], v1, s[16:19], s94 offen offset:0 sc1
v_pk_mul_f32 v[70:71], v[70:71], s[4:5]
v_cvt_pk_bf16_f32 v64, v64, v65
M v[104:107], a[116:119], a[180:183], v[104:107]
v_cvt_pk_bf16_f32 v65, v66, v67
v_cvt_pk_bf16_f32 v66, v68, v69
M v[108:111], a[124:127], a[180:183], v[108:111]
v_cvt_pk_bf16_f32 v67, v70, v71
v_pk_mul_f32 v[72:73], v[72:73], s[4:5]
v_pk_mul_f32 v[74:75], v[74:75], s[4:5]
M v[108:111], a[120:123], a[176:179], v[108:111]
s_waitcnt vmcnt(13) lgkmcnt(0)
s_barrier
ds_read_b128 a[160:163], v10 offset:49152
ds_read_b128 a[164:167], v11 offset:49152
v_pk_mul_f32 v[76:77], v[76:77], s[4:5]
v_pk_mul_f32 v[78:79], v[78:79], s[4:5]
M v[112:115], a[128:131], a[176:179], v[112:115]
s_add_u32 m0, s28, 0
s_nop 0
buffer_load_dword v20, s[8:11], s24 offen lds
v_cvt_pk_bf16_f32 v72, v72, v73
v_cvt_pk_bf16_f32 v73, v74, v75
M v[112:115], a[132:135], a[180:183], v[112:115]
v_cvt_pk_bf16_f32 v74, v76, v77
v_cvt_pk_bf16_f32 v75, v78, v79
M v[116:119], a[140:143], a[180:183], v[116:119]
s_add_u32 s94, s92, 0
buffer_store_dwordx4 v[40:43], v1, s[16:19], s94 offen offset:1024 sc1
v_pk_mul_f32 v[80:81], v[80:81], s[4:5]
v_pk_mul_f32 v[82:83], v[82:83], s[4:5]
v_pk_mul_f32 v[84:85], v[84:85], s[4:5]
M v[116:119], a[136:139], a[176:179], v[116:119]
v_pk_mul_f32 v[86:87], v[86:87], s[4:5]
v_cvt_pk_bf16_f32 v80, v80, v81
M v[120:123], a[144:147], a[176:179], v[120:123]
buffer_load_dword v23, s[8:11], s24 offen offset:256 lds
s_add_u32 s24, s24, 128
v_cvt_pk_bf16_f32 v81, v82, v83
v_cvt_pk_bf16_f32 v82, v84, v85
M v[120:123], a[148:151], a[180:183], v[120:123]
v_cvt_pk_bf16_f32 v83, v86, v87
v_pk_mul_f32 v[88:89], v[88:89], s[4:5]
v_pk_mul_f32 v[90:91], v[90:91], s[4:5]
M v[124:127], a[156:159], a[180:183], v[124:127]
v_pk_mul_f32 v[92:93], v[92:93], s[4:5]
v_pk_mul_f32 v[94:95], v[94:95], s[4:5]
M v[124:127], a[152:155], a[176:179], v[124:127]
v_cvt_pk_bf16_f32 v88, v88, v89
v_cvt_pk_bf16_f32 v89, v90, v91
M v[128:131], a[96:99], a[184:187], v[128:131]
v_cvt_pk_bf16_f32 v90, v92, v93
v_cvt_pk_bf16_f32 v91, v94, v95
M v[128:131], a[100:103], a[188:191], v[128:131]
ds_read_b128 a[168:171], v10 offset:51200
ds_read_b128 a[172:175], v11 offset:51200
M v[132:135], a[108:111], a[188:191], v[132:135]
s_add_u32 s94, s92, 0
buffer_store_dwordx4 v[48:51], v1, s[16:19], s94 offen offset:2048 sc1
M v[132:135], a[104:107], a[184:187], v[132:135]
s_add_u32 m0, s29, 2048
s_nop 0
buffer_load_dwordx4 v2, s[8:11], s23 offen offset:0 lds
v_pk_mul_f32 v[96:97], v[96:97], s[4:5]
v_pk_mul_f32 v[98:99], v[98:99], s[4:5]
v_pk_mul_f32 v[100:101], v[100:101], s[4:5]
M v[136:139], a[112:115], a[184:187], v[136:139]
v_pk_mul_f32 v[102:103], v[102:103], s[4:5]
v_cvt_pk_bf16_f32 v96, v96, v97
M v[136:139], a[116:119], a[188:191], v[136:139]
v_cvt_pk_bf16_f32 v97, v98, v99
v_cvt_pk_bf16_f32 v98, v100, v101
M v[140:143], a[124:127], a[188:191], v[140:143]
v_cvt_pk_bf16_f32 v99, v102, v103
v_pk_mul_f32 v[104:105], v[104:105], s[4:5]
v_pk_mul_f32 v[106:107], v[106:107], s[4:5]
M v[140:143], a[120:123], a[184:187], v[140:143]
buffer_load_dwordx4 v3, s[8:11], s23 offen offset:1024 lds
v_pk_mul_f32 v[108:109], v[108:109], s[4:5]
v_pk_mul_f32 v[110:111], v[110:111], s[4:5]
M v[144:147], a[128:131], a[184:187], v[144:147]
s_add_u32 s94, s92, 0
buffer_store_dwordx4 v[56:59], v1, s[16:19], s94 offen offset:3072 sc1
v_cvt_pk_bf16_f32 v104, v104, v105
v_cvt_pk_bf16_f32 v105, v106, v107
M v[144:147], a[132:135], a[188:191], v[144:147]
v_cvt_pk_bf16_f32 v106, v108, v109
v_cvt_pk_bf16_f32 v107, v110, v111
M v[148:151], a[140:143], a[188:191], v[148:151]
v_pk_mul_f32 v[112:113], v[112:113], s[4:5]
v_pk_mul_f32 v[114:115], v[114:115], s[4:5]
v_pk_mul_f32 v[116:117], v[116:117], s[4:5]
M v[148:151], a[136:139], a[184:187], v[148:151]
v_pk_mul_f32 v[118:119], v[118:119], s[4:5]
v_cvt_pk_bf16_f32 v112, v112, v113
M v[152:155], a[144:147], a[184:187], v[152:155]
buffer_load_dwordx4 v4, s[8:11], s23 offen offset:2048 lds
v_cvt_pk_bf16_f32 v113, v114, v115
v_cvt_pk_bf16_f32 v114, v116, v117
M v[152:155], a[148:151], a[188:191], v[152:155]
v_cvt_pk_bf16_f32 v115, v118, v119
v_pk_mul_f32 v[120:121], v[120:121], s[4:5]
v_pk_mul_f32 v[122:123], v[122:123], s[4:5]
M v[156:159], a[156:159], a[188:191], v[156:159]
v_pk_mul_f32 v[124:125], v[124:125], s[4:5]
v_pk_mul_f32 v[126:127], v[126:127], s[4:5]
M v[156:159], a[152:155], a[184:187], v[156:159]
s_add_u32 s94, s92, 4096
buffer_store_dwordx4 v[64:67], v1, s[16:19], s94 offen offset:0 sc1
s_waitcnt lgkmcnt(2)
v_cvt_pk_bf16_f32 v120, v120, v121
v_cvt_pk_bf16_f32 v121, v122, v123
M v[160:163], a[96:99], a[160:163], v[160:163]
v_cvt_pk_bf16_f32 v122, v124, v125
v_cvt_pk_bf16_f32 v123, v126, v127
M v[160:163], a[100:103], a[164:167], v[160:163]
ds_read_b128 a[176:179], v10 offset:53248
ds_read_b128 a[180:183], v11 offset:53248
M v[164:167], a[108:111], a[164:167], v[164:167]
buffer_load_dwordx4 v5, s[8:11], s23 offen offset:3072 lds
s_add_u32 s23, s23, 128
M v[164:167], a[104:107], a[160:163], v[164:167]
v_pk_mul_f32 v[128:129], v[128:129], s[4:5]
v_pk_mul_f32 v[130:131], v[130:131], s[4:5]
v_pk_mul_f32 v[132:133], v[132:133], s[4:5]
M v[168:171], a[112:115], a[160:163], v[168:171]
v_pk_mul_f32 v[134:135], v[134:135], s[4:5]
v_cvt_pk_bf16_f32 v128, v128, v129
M v[168:171], a[116:119], a[164:167], v[168:171]
s_add_u32 s94, s92, 4096
buffer_store_dwordx4 v[72:75], v1, s[16:19], s94 offen offset:1024 sc1
v_cvt_pk_bf16_f32 v129, v130, v131
v_cvt_pk_bf16_f32 v130, v132, v133
M v[172:175], a[124:127], a[164:167], v[172:175]
v_cvt_pk_bf16_f32 v131, v134, v135
v_pk_mul_f32 v[136:137], v[136:137], s[4:5]
v_pk_mul_f32 v[138:139], v[138:139], s[4:5]
M v[172:175], a[120:123], a[160:163], v[172:175]
s_add_u32 m0, s30, 98304
s_nop 0
buffer_load_dwordx4 v6, s[12:15], s25 offen offset:0 lds
v_pk_mul_f32 v[140:141], v[140:141], s[4:5]
v_pk_mul_f32 v[142:143], v[142:143], s[4:5]
M v[176:179], a[128:131], a[160:163], v[176:179]
v_cvt_pk_bf16_f32 v136, v136, v137
v_cvt_pk_bf16_f32 v137, v138, v139
M v[176:179], a[132:135], a[164:167], v[176:179]
v_cvt_pk_bf16_f32 v138, v140, v141
v_cvt_pk_bf16_f32 v139, v142, v143
M v[180:183], a[140:143], a[164:167], v[180:183]
buffer_load_dwordx4 v7, s[12:15], s25 offen offset:1024 lds
v_pk_mul_f32 v[144:145], v[144:145], s[4:5]
v_pk_mul_f32 v[146:147], v[146:147], s[4:5]
v_pk_mul_f32 v[148:149], v[148:149], s[4:5]
M v[180:183], a[136:139], a[160:163], v[180:183]
v_pk_mul_f32 v[150:151], v[150:151], s[4:5]
v_cvt_pk_bf16_f32 v144, v144, v145
M v[184:187], a[144:147], a[160:163], v[184:187]
s_add_u32 s94, s92, 4096
buffer_store_dwordx4 v[80:83], v1, s[16:19], s94 offen offset:2048 sc1
v_cvt_pk_bf16_f32 v145, v146, v147
v_cvt_pk_bf16_f32 v146, v148, v149
M v[184:187], a[148:151], a[164:167], v[184:187]
v_cvt_pk_bf16_f32 v147, v150, v151
v_pk_mul_f32 v[152:153], v[152:153], s[4:5]
v_pk_mul_f32 v[154:155], v[154:155], s[4:5]
M v[188:191], a[156:159], a[164:167], v[188:191]
v_pk_mul_f32 v[156:157], v[156:157], s[4:5]
v_pk_mul_f32 v[158:159], v[158:159], s[4:5]
M v[188:191], a[152:155], a[160:163], v[188:191]
s_waitcnt lgkmcnt(2)
v_cvt_pk_bf16_f32 v152, v152, v153
v_cvt_pk_bf16_f32 v153, v154, v155
M v[192:195], a[96:99], a[168:171], v[192:195]
buffer_load_dwordx4 v8, s[12:15], s25 offen offset:2048 lds
v_cvt_pk_bf16_f32 v154, v156, v157
v_cvt_pk_bf16_f32 v155, v158, v159
M v[192:195], a[100:103], a[172:175], v[192:195]
ds_read_b128 a[184:187], v10 offset:55296
ds_read_b128 a[188:191], v11 offset:55296
M v[196:199], a[108:111], a[172:175], v[196:199]
M v[196:199], a[104:107], a[168:171], v[196:199]
s_add_u32 s94, s92, 4096
buffer_store_dwordx4 v[88:91], v1, s[16:19], s94 offen offset:3072 sc1
v_pk_mul_f32 v[160:161], v[160:161], s[4:5]
v_pk_mul_f32 v[162:163], v[162:163], s[4:5]
v_pk_mul_f32 v[164:165], v[164:165], s[4:5]
M v[200:203], a[112:115], a[168:171], v[200:203]
v_pk_mul_f32 v[166:167], v[166:167], s[4:5]
v_cvt_pk_bf16_f32 v160, v160, v161
M v[200:203], a[116:119], a[172:175], v[200:203]
v_cvt_pk_bf16_f32 v161, v162, v163
v_cvt_pk_bf16_f32 v162, v164, v165
M v[204:207], a[124:127], a[172:175], v[204:207]
buffer_load_dwordx4 v9, s[12:15], s25 offen offset:3072 lds
v_cvt_pk_bf16_f32 v163, v166, v167
v_pk_mul_f32 v[168:169], v[168:169], s[4:5]
v_pk_mul_f32 v[170:171], v[170:171], s[4:5]
M v[204:207], a[120:123], a[168:171], v[204:207]
v_pk_mul_f32 v[172:173], v[172:173], s[4:5]
v_pk_mul_f32 v[174:175], v[174:175], s[4:5]
M v[208:211], a[128:131], a[168:171], v[208:211]
v_cvt_pk_bf16_f32 v168, v168, v169
v_cvt_pk_bf16_f32 v169, v170, v171
M v[208:211], a[132:135], a[172:175], v[208:211]
v_cvt_pk_bf16_f32 v170, v172, v173
v_cvt_pk_bf16_f32 v171, v174, v175
M v[212:215], a[140:143], a[172:175], v[212:215]
s_add_u32 s94, s92, 8192
buffer_store_dwordx4 v[96:99], v1, s[16:19], s94 offen offset:0 sc1
v_pk_mul_f32 v[176:177], v[176:177], s[4:5]
v_pk_mul_f32 v[178:179], v[178:179], s[4:5]
v_pk_mul_f32 v[180:181], v[180:181], s[4:5]
M v[212:215], a[136:139], a[168:171], v[212:215]
s_add_u32 m0, s30, 102400
s_nop 0
buffer_load_dwordx4 v21, s[12:15], s25 offen offset:0 lds
v_pk_mul_f32 v[182:183], v[182:183], s[4:5]
v_cvt_pk_bf16_f32 v176, v176, v177
M v[216:219], a[144:147], a[168:171], v[216:219]
v_cvt_pk_bf16_f32 v177, v178, v179
v_cvt_pk_bf16_f32 v178, v180, v181
M v[216:219], a[148:151], a[172:175], v[216:219]
v_cvt_pk_bf16_f32 v179, v182, v183
v_pk_mul_f32 v[184:185], v[184:185], s[4:5]
v_pk_mul_f32 v[186:187], v[186:187], s[4:5]
M v[220:223], a[156:159], a[172:175], v[220:223]
v_pk_mul_f32 v[188:189], v[188:189], s[4:5]
v_pk_mul_f32 v[190:191], v[190:191], s[4:5]
M v[220:223], a[152:155], a[168:171], v[220:223]
s_waitcnt lgkmcnt(2)
v_cvt_pk_bf16_f32 v184, v184, v185
v_cvt_pk_bf16_f32 v185, v186, v187
M v[224:227], a[96:99], a[176:179], v[224:227]
s_add_u32 s94, s92, 8192
buffer_store_dwordx4 v[104:107], v1, s[16:19], s94 offen offset:1024 sc1
v_cvt_pk_bf16_f32 v186, v188, v189
v_cvt_pk_bf16_f32 v187, v190, v191
M v[224:227], a[100:103], a[180:183], v[224:227]
buffer_load_dwordx4 v22, s[12:15], s25 offen offset:1024 lds
s_add_u32 s25, s25, 393216
M v[228:231], a[108:111], a[180:183], v[228:231]
M v[228:231], a[104:107], a[176:179], v[228:231]
v_pk_mul_f32 v[192:193], v[192:193], s[4:5]
v_pk_mul_f32 v[194:195], v[194:195], s[4:5]
v_pk_mul_f32 v[196:197], v[196:197], s[4:5]
M v[232:235], a[112:115], a[176:179], v[232:235]
v_pk_mul_f32 v[198:199], v[198:199], s[4:5]
v_cvt_pk_bf16_f32 v192, v192, v193
M v[232:235], a[116:119], a[180:183], v[232:235]
v_cvt_pk_bf16_f32 v193, v194, v195
v_cvt_pk_bf16_f32 v194, v196, v197
M v[236:239], a[124:127], a[180:183], v[236:239]
v_cvt_pk_bf16_f32 v195, v198, v199
v_pk_mul_f32 v[200:201], v[200:201], s[4:5]
v_pk_mul_f32 v[202:203], v[202:203], s[4:5]
M v[236:239], a[120:123], a[176:179], v[236:239]
s_waitcnt vmcnt(63) lgkmcnt(0)
s_barrier
v_pk_mul_f32 v[204:205], v[204:205], s[4:5]
v_pk_mul_f32 v[206:207], v[206:207], s[4:5]
M v[240:243], a[128:131], a[176:179], v[240:243]
s_add_u32 s94, s92, 8192
buffer_store_dwordx4 v[112:115], v1, s[16:19], s94 offen offset:2048 sc1
v_cvt_pk_bf16_f32 v200, v200, v201
v_cvt_pk_bf16_f32 v201, v202, v203
M v[240:243], a[132:135], a[180:183], v[240:243]
s_add_u32 m0, s28, 18432
s_nop 0
buffer_load_dword v20, s[8:11], s24 offen lds
v_cvt_pk_bf16_f32 v202, v204, v205
v_cvt_pk_bf16_f32 v203, v206, v207
M v[244:247], a[140:143], a[180:183], v[244:247]
v_pk_mul_f32 v[208:209], v[208:209], s[4:5]
v_pk_mul_f32 v[210:211], v[210:211], s[4:5]
v_pk_mul_f32 v[212:213], v[212:213], s[4:5]
M v[244:247], a[136:139], a[176:179], v[244:247]
v_pk_mul_f32 v[214:215], v[214:215], s[4:5]
v_cvt_pk_bf16_f32 v208, v208, v209
M v[248:251], a[144:147], a[176:179], v[248:251]
buffer_load_dword v23, s[8:11], s24 offen offset:256 lds
s_add_u32 s24, s24, 128
v_cvt_pk_bf16_f32 v209, v210, v211
v_cvt_pk_bf16_f32 v210, v212, v213
M v[248:251], a[148:151], a[180:183], v[248:251]
v_cvt_pk_bf16_f32 v211, v214, v215
v_pk_mul_f32 v[216:217], v[216:217], s[4:5]
v_pk_mul_f32 v[218:219], v[218:219], s[4:5]
M v[252:255], a[156:159], a[180:183], v[252:255]
s_add_u32 s94, s92, 8192
buffer_store_dwordx4 v[120:123], v1, s[16:19], s94 offen offset:3072 sc1
v_pk_mul_f32 v[220:221], v[220:221], s[4:5]
v_pk_mul_f32 v[222:223], v[222:223], s[4:5]
M v[252:255], a[152:155], a[176:179], v[252:255]
v_cvt_pk_bf16_f32 v216, v216, v217
v_cvt_pk_bf16_f32 v217, v218, v219
M a[0:3], a[96:99], a[184:187], a[0:3]
v_cvt_pk_bf16_f32 v218, v220, v221
v_cvt_pk_bf16_f32 v219, v222, v223
M a[0:3], a[100:103], a[188:191], a[0:3]
M a[4:7], a[108:111], a[188:191], a[4:7]
s_add_u32 m0, s29, 20480
s_nop 0
buffer_load_dwordx4 v2, s[8:11], s23 offen offset:0 lds
M a[4:7], a[104:107], a[184:187], a[4:7]
v_pk_mul_f32 v[224:225], v[224:225], s[4:5]
v_pk_mul_f32 v[226:227], v[226:227], s[4:5]
v_pk_mul_f32 v[228:229], v[228:229], s[4:5]
M a[8:11], a[112:115], a[184:187], a[8:11]
v_pk_mul_f32 v[230:231], v[230:231], s[4:5]
v_cvt_pk_bf16_f32 v224, v224, v225
M a[8:11], a[116:119], a[188:191], a[8:11]
s_add_u32 s94, s92, 12288
buffer_store_dwordx4 v[128:131], v1, s[16:19], s94 offen offset:0 sc1
v_cvt_pk_bf16_f32 v225, v226, v227
v_cvt_pk_bf16_f32 v226, v228, v229
M a[12:15], a[124:127], a[188:191], a[12:15]
buffer_load_dwordx4 v3, s[8:11], s23 offen offset:1024 lds
v_cvt_pk_bf16_f32 v227, v230, v231
v_pk_mul_f32 v[232:233], v[232:233], s[4:5]
v_pk_mul_f32 v[234:235], v[234:235], s[4:5]
M a[12:15], a[120:123], a[184:187], a[12:15]
v_pk_mul_f32 v[236:237], v[236:237], s[4:5]
v_pk_mul_f32 v[238:239], v[238:239], s[4:5]
M a[16:19], a[128:131], a[184:187], a[16:19]
v_cvt_pk_bf16_f32 v232, v232, v233
v_cvt_pk_bf16_f32 v233, v234, v235
M a[16:19], a[132:135], a[188:191], a[16:19]
v_cvt_pk_bf16_f32 v234, v236, v237
v_cvt_pk_bf16_f32 v235, v238, v239
M a[20:23], a[140:143], a[188:191], a[20:23]
buffer_load_dwordx4 v4, s[8:11], s23 offen offset:2048 lds
v_pk_mul_f32 v[240:241], v[240:241], s[4:5]
v_pk_mul_f32 v[242:243], v[242:243], s[4:5]
v_pk_mul_f32 v[244:245], v[244:245], s[4:5]
M a[20:23], a[136:139], a[184:187], a[20:23]
v_pk_mul_f32 v[246:247], v[246:247], s[4:5]
v_cvt_pk_bf16_f32 v240, v240, v241
M a[24:27], a[144:147], a[184:187], a[24:27]
s_add_u32 s94, s92, 12288
buffer_store_dwordx4 v[136:139], v1, s[16:19], s94 offen offset:1024 sc1
v_cvt_pk_bf16_f32 v241, v242, v243
v_cvt_pk_bf16_f32 v242, v244, v245
M a[24:27], a[148:151], a[188:191], a[24:27]
v_cvt_pk_bf16_f32 v243, v246, v247
v_pk_mul_f32 v[248:249], v[248:249], s[4:5]
v_pk_mul_f32 v[250:251], v[250:251], s[4:5]
M a[28:31], a[156:159], a[188:191], a[28:31]
v_pk_mul_f32 v[252:253], v[252:253], s[4:5]
v_pk_mul_f32 v[254:255], v[254:255], s[4:5]
M a[28:31], a[152:155], a[184:187], a[28:31]
v_cvt_pk_bf16_f32 v248, v248, v249
v_cvt_pk_bf16_f32 v249, v250, v251
v_cvt_pk_bf16_f32 v250, v252, v253
v_cvt_pk_bf16_f32 v251, v254, v255
v_accvgpr_read_b32 v24, a0
v_accvgpr_read_b32 v25, a1
v_accvgpr_read_b32 v26, a2
v_accvgpr_read_b32 v27, a3
v_accvgpr_read_b32 v28, a4
v_accvgpr_read_b32 v29, a5
v_accvgpr_read_b32 v30, a6
v_accvgpr_read_b32 v31, a7
v_pk_mul_f32 v[24:25], v[24:25], s[4:5]
v_pk_mul_f32 v[26:27], v[26:27], s[4:5]
v_pk_mul_f32 v[28:29], v[28:29], s[4:5]
v_pk_mul_f32 v[30:31], v[30:31], s[4:5]
v_cvt_pk_bf16_f32 v36, v24, v25
v_cvt_pk_bf16_f32 v37, v26, v27
v_cvt_pk_bf16_f32 v38, v28, v29
v_cvt_pk_bf16_f32 v39, v30, v31
v_accvgpr_read_b32 v24, a8
v_accvgpr_read_b32 v25, a9
v_accvgpr_read_b32 v26, a10
v_accvgpr_read_b32 v27, a11
v_accvgpr_read_b32 v28, a12
v_accvgpr_read_b32 v29, a13
v_accvgpr_read_b32 v30, a14
v_accvgpr_read_b32 v31, a15
v_pk_mul_f32 v[24:25], v[24:25], s[4:5]
v_pk_mul_f32 v[26:27], v[26:27], s[4:5]
v_pk_mul_f32 v[28:29], v[28:29], s[4:5]
v_pk_mul_f32 v[30:31], v[30:31], s[4:5]
v_cvt_pk_bf16_f32 v44, v24, v25
v_cvt_pk_bf16_f32 v45, v26, v27
v_cvt_pk_bf16_f32 v46, v28, v29
v_cvt_pk_bf16_f32 v47, v30, v31
v_accvgpr_read_b32 v24, a16
v_accvgpr_read_b32 v25, a17
v_accvgpr_read_b32 v26, a18
v_accvgpr_read_b32 v27, a19
v_accvgpr_read_b32 v28, a20
v_accvgpr_read_b32 v29, a21
v_accvgpr_read_b32 v30, a22
v_accvgpr_read_b32 v31, a23
v_pk_mul_f32 v[24:25], v[24:25], s[4:5]
v_pk_mul_f32 v[26:27], v[26:27], s[4:5]
v_pk_mul_f32 v[28:29], v[28:29], s[4:5]
v_pk_mul_f32 v[30:31], v[30:31], s[4:5]
v_cvt_pk_bf16_f32 v52, v24, v25
v_cvt_pk_bf16_f32 v53, v26, v27
v_cvt_pk_bf16_f32 v54, v28, v29
v_cvt_pk_bf16_f32 v55, v30, v31
v_accvgpr_read_b32 v24, a24
v_accvgpr_read_b32 v25, a25
v_accvgpr_read_b32 v26, a26
v_accvgpr_read_b32 v27, a27
v_accvgpr_read_b32 v28, a28
v_accvgpr_read_b32 v29, a29
v_accvgpr_read_b32 v30, a30
v_accvgpr_read_b32 v31, a31
v_pk_mul_f32 v[24:25], v[24:25], s[4:5]
v_pk_mul_f32 v[26:27], v[26:27], s[4:5]
v_pk_mul_f32 v[28:29], v[28:29], s[4:5]
v_pk_mul_f32 v[30:31], v[30:31], s[4:5]
v_cvt_pk_bf16_f32 v60, v24, v25
v_cvt_pk_bf16_f32 v61, v26, v27
v_cvt_pk_bf16_f32 v62, v28, v29
v_cvt_pk_bf16_f32 v63, v30, v31
s_branch Lk1_b
Lk1_spin:
s_add_u32 s40, s40, 1
s_cmp_gt_u32 s40, 1048576
s_cbranch_scc1 Lk1_got
s_sleep 2
buffer_load_dword v126, v119, s[36:39], 0 offen offset:128 sc1
s_waitcnt vmcnt(0)
v_cmp_gt_u32 vcc, 0x80, v126
s_nop 0
s_cbranch_vccnz Lk1_spin
s_branch Lk1_got
Lk1_spinq:
s_add_u32 s40, s40, 1
s_cmp_gt_u32 s40, 1048576
s_cbranch_scc1 Lk1_gotq
s_sleep 2
buffer_load_dword v125, v119, s[36:39], 0 offen offset:0 sc1
s_waitcnt vmcnt(0)
v_cmp_gt_u32 vcc, 0x80, v125
s_nop 0
s_cbranch_vccnz Lk1_spinq
s_branch Lk1_gotq
Lk1_kv:
s_mov_b64 s[60:61], s[40:41]
s_mov_b32 s62, 4194304
s_and_b32 s3, s2, 127
s_lshl_b32 s3, s3, 2
s_add_u32 s3, s3, s20
s_mul_i32 s54, s3, 1024
M v[32:35], a[32:35], a[160:163], 0
s_add_u32 m0, s29, 32768
s_nop 0
buffer_load_dwordx4 v2, s[8:11], s23 offen offset:0 lds
M v[32:35], a[36:39], a[164:167], v[32:35]
ds_read_b128 a[176:179], v10 offset:4096
ds_read_b128 a[180:183], v11 offset:4096
M v[36:39], a[44:47], a[164:167], 0
M v[36:39], a[40:43], a[160:163], v[36:39]
ds_read_b64_tr_b16 a[96:97], v12 offset:32768
ds_read_b64_tr_b16 a[98:99], v12 offset:34816
M v[40:43], a[48:51], a[160:163], 0
M v[40:43], a[52:55], a[164:167], v[40:43]
buffer_load_dwordx4 v3, s[8:11], s23 offen offset:1024 lds
M v[44:47], a[60:63], a[164:167], 0
M v[44:47], a[56:59], a[160:163], v[44:47]
ds_read_b64_tr_b16 a[104:105], v13 offset:32768
ds_read_b64_tr_b16 a[106:107], v13 offset:34816
M v[48:51], a[64:67], a[160:163], 0
M v[48:51], a[68:71], a[164:167], v[48:51]
buffer_load_dwordx4 v4, s[8:11], s23 offen offset:2048 lds
M v[52:55], a[76:79], a[164:167], 0
M v[52:55], a[72:75], a[160:163], v[52:55]
ds_read_b64_tr_b16 a[112:113], v14 offset:32768
ds_read_b64_tr_b16 a[114:115], v14 offset:34816
M v[56:59], a[80:83], a[160:163], 0
M v[56:59], a[84:87], a[164:167], v[56:59]
buffer_load_dwordx4 v5, s[8:11], s23 offen offset:3072 lds
M v[60:63], a[92:95], a[164:167], 0
M v[60:63], a[88:91], a[160:163], v[60:63]
ds_read_b64_tr_b16 a[120:121], v15 offset:32768
ds_read_b64_tr_b16 a[122:123], v15 offset:34816
M v[64:67], a[32:35], a[168:171], 0
M v[64:67], a[36:39], a[172:175], v[64:67]
ds_read_b128 a[184:187], v10 offset:6144
ds_read_b128 a[188:191], v11 offset:6144
M v[68:71], a[44:47], a[172:175], 0
s_add_u32 m0, s29, 65536
s_nop 0
buffer_load_dwordx4 v6, s[12:15], s24 offen offset:0 lds
M v[68:71], a[40:43], a[168:171], v[68:71]
ds_read_b64_tr_b16 a[128:129], v16 offset:32768
ds_read_b64_tr_b16 a[130:131], v16 offset:34816
M v[72:75], a[48:51], a[168:171], 0
M v[72:75], a[52:55], a[172:175], v[72:75]
M v[76:79], a[60:63], a[172:175], 0
buffer_load_dwordx4 v7, s[12:15], s24 offen offset:1024 lds
M v[76:79], a[56:59], a[168:171], v[76:79]
ds_read_b64_tr_b16 a[136:137], v17 offset:32768
ds_read_b64_tr_b16 a[138:139], v17 offset:34816
M v[80:83], a[64:67], a[168:171], 0
M v[80:83], a[68:71], a[172:175], v[80:83]
M v[84:87], a[76:79], a[172:175], 0
buffer_load_dwordx4 v8, s[12:15], s24 offen offset:2048 lds
M v[84:87], a[72:75], a[168:171], v[84:87]
ds_read_b64_tr_b16 a[144:145], v18 offset:32768
ds_read_b64_tr_b16 a[146:147], v18 offset:34816
M v[88:91], a[80:83], a[168:171], 0
M v[88:91], a[84:87], a[172:175], v[88:91]
M v[92:95], a[92:95], a[172:175], 0
buffer_load_dwordx4 v9, s[12:15], s24 offen offset:3072 lds
M v[92:95], a[88:91], a[168:171], v[92:95]
s_waitcnt lgkmcnt(15)
ds_read_b64_tr_b16 a[152:153], v19 offset:32768
ds_read_b64_tr_b16 a[154:155], v19 offset:34816
M v[96:99], a[32:35], a[176:179], 0
M v[96:99], a[36:39], a[180:183], v[96:99]
M v[100:103], a[44:47], a[180:183], 0
s_add_u32 s24, s24, 262144
M v[100:103], a[40:43], a[176:179], v[100:103]
M v[104:107], a[48:51], a[176:179], 0
M v[104:107], a[52:55], a[180:183], v[104:107]
M v[108:111], a[60:63], a[180:183], 0
M v[108:111], a[56:59], a[176:179], v[108:111]
s_waitcnt vmcnt(9) lgkmcnt(0)
s_barrier
ds_read_b128 a[160:163], v10 offset:16384
ds_read_b128 a[164:167], v11 offset:16384
M v[112:115], a[64:67], a[176:179], 0
s_add_u32 m0, s29, 49152
s_add_u32 s3, s23, s31
buffer_load_dwordx4 v2, s[8:11], s3 offen offset:0 lds
M v[112:115], a[68:71], a[180:183], v[112:115]
M v[116:119], a[76:79], a[180:183], 0
M v[116:119], a[72:75], a[176:179], v[116:119]
ds_read_b64_tr_b16 a[100:101], v12 offset:49152
ds_read_b64_tr_b16 a[102:103], v12 offset:51200
M v[120:123], a[80:83], a[176:179], 0
M v[120:123], a[84:87], a[180:183], v[120:123]
buffer_load_dwordx4 v3, s[8:11], s3 offen offset:1024 lds
M v[124:127], a[92:95], a[180:183], 0
M v[124:127], a[88:91], a[176:179], v[124:127]
M v[128:131], a[32:35], a[184:187], 0
M v[128:131], a[36:39], a[188:191], v[128:131]
ds_read_b128 a[168:171], v10 offset:18432
ds_read_b128 a[172:175], v11 offset:18432
ds_read_b64_tr_b16 a[108:109], v13 offset:49152
ds_read_b64_tr_b16 a[110:111], v13 offset:51200
M v[132:135], a[44:47], a[188:191], 0
M v[132:135], a[40:43], a[184:187], v[132:135]
M v[136:139], a[48:51], a[184:187], 0
buffer_load_dwordx4 v4, s[8:11], s3 offen offset:2048 lds
M v[136:139], a[52:55], a[188:191], v[136:139]
M v[140:143], a[60:63], a[188:191], 0
M v[140:143], a[56:59], a[184:187], v[140:143]
ds_read_b64_tr_b16 a[116:117], v14 offset:49152
ds_read_b64_tr_b16 a[118:119], v14 offset:51200
M v[144:147], a[64:67], a[184:187], 0
M v[144:147], a[68:71], a[188:191], v[144:147]
M v[148:151], a[76:79], a[188:191], 0
buffer_load_dwordx4 v5, s[8:11], s3 offen offset:3072 lds
M v[148:151], a[72:75], a[184:187], v[148:151]
M v[152:155], a[80:83], a[184:187], 0
M v[152:155], a[84:87], a[188:191], v[152:155]
ds_read_b64_tr_b16 a[124:125], v15 offset:49152
ds_read_b64_tr_b16 a[126:127], v15 offset:51200
M v[156:159], a[92:95], a[188:191], 0
M v[156:159], a[88:91], a[184:187], v[156:159]
s_waitcnt lgkmcnt(10)
M v[160:163], a[32:35], a[160:163], 0
M v[160:163], a[36:39], a[164:167], v[160:163]
ds_read_b128 a[176:179], v10 offset:20480
ds_read_b128 a[180:183], v11 offset:20480
M v[164:167], a[44:47], a[164:167], 0
s_add_u32 s23, s23, 128
s_cmp_eq_u32 s23, s25
s_cselect_b32 s23, s26, s23
M v[164:167], a[40:43], a[160:163], v[164:167]
ds_read_b64_tr_b16 a[132:133], v16 offset:49152
ds_read_b64_tr_b16 a[134:135], v16 offset:51200
M v[168:171], a[48:51], a[160:163], 0
M v[168:171], a[52:55], a[164:167], v[168:171]
M v[172:175], a[60:63], a[164:167], 0
M v[172:175], a[56:59], a[160:163], v[172:175]
M v[176:179], a[64:67], a[160:163], 0
s_add_u32 m0, s29, 81920
s_nop 0
buffer_load_dwordx4 v6, s[12:15], s24 offen offset:0 lds
M v[176:179], a[68:71], a[164:167], v[176:179]
ds_read_b64_tr_b16 a[140:141], v17 offset:49152
ds_read_b64_tr_b16 a[142:143], v17 offset:51200
M v[180:183], a[76:79], a[164:167], 0
M v[180:183], a[72:75], a[160:163], v[180:183]
M v[184:187], a[80:83], a[160:163], 0
M v[184:187], a[84:87], a[164:167], v[184:187]
buffer_load_dwordx4 v7, s[12:15], s24 offen offset:1024 lds
M v[188:191], a[92:95], a[164:167], 0
M v[188:191], a[88:91], a[160:163], v[188:191]
s_waitcnt lgkmcnt(12)
ds_read_b64_tr_b16 a[148:149], v18 offset:49152
ds_read_b64_tr_b16 a[150:151], v18 offset:51200
M v[192:195], a[32:35], a[168:171], 0
M v[192:195], a[36:39], a[172:175], v[192:195]
ds_read_b128 a[184:187], v10 offset:22528
ds_read_b128 a[188:191], v11 offset:22528
M v[196:199], a[44:47], a[172:175], 0
M v[196:199], a[40:43], a[168:171], v[196:199]
M v[200:203], a[48:51], a[168:171], 0
buffer_load_dwordx4 v8, s[12:15], s24 offen offset:2048 lds
M v[200:203], a[52:55], a[172:175], v[200:203]
ds_read_b64_tr_b16 a[156:157], v19 offset:49152
ds_read_b64_tr_b16 a[158:159], v19 offset:51200
M v[204:207], a[60:63], a[172:175], 0
M v[204:207], a[56:59], a[168:171], v[204:207]
M v[208:211], a[64:67], a[168:171], 0
M v[208:211], a[68:71], a[172:175], v[208:211]
M v[212:215], a[76:79], a[172:175], 0
buffer_load_dwordx4 v9, s[12:15], s24 offen offset:3072 lds
M v[212:215], a[72:75], a[168:171], v[212:215]
M v[216:219], a[80:83], a[168:171], 0
M v[216:219], a[84:87], a[172:175], v[216:219]
M v[220:223], a[92:95], a[172:175], 0
M v[220:223], a[88:91], a[168:171], v[220:223]
s_waitcnt lgkmcnt(10)
M v[224:227], a[32:35], a[176:179], 0
s_add_u32 s24, s24, 262144
s_cmp_eq_u32 s24, s27
s_cselect_b32 s24, s28, s24
s_sub_u32 s6, s6, 1
s_cmp_eq_u32 s6, 0
s_cselect_b64 s[12:13], s[64:65], s[12:13]
M v[224:227], a[36:39], a[180:183], v[224:227]
M v[228:231], a[44:47], a[180:183], 0
M v[228:231], a[40:43], a[176:179], v[228:231]
M v[232:235], a[48:51], a[176:179], 0
M v[232:235], a[52:55], a[180:183], v[232:235]
M v[236:239], a[60:63], a[180:183], 0
M v[236:239], a[56:59], a[176:179], v[236:239]
s_waitcnt vmcnt(8) lgkmcnt(0)
s_barrier
ds_read_b128 a[160:163], v10 offset:32768
ds_read_b128 a[164:167], v11 offset:32768
M v[240:243], a[64:67], a[176:179], 0
s_add_u32 m0, s29, 0
s_nop 0
buffer_load_dwordx4 v2, s[8:11], s23 offen offset:0 lds
M v[240:243], a[68:71], a[180:183], v[240:243]
M v[244:247], a[76:79], a[180:183], 0
M v[244:247], a[72:75], a[176:179], v[244:247]
M v[248:251], a[80:83], a[176:179], 0
M v[248:251], a[84:87], a[180:183], v[248:251]
buffer_load_dwordx4 v3, s[8:11], s23 offen offset:1024 lds
M v[252:255], a[92:95], a[180:183], 0
M v[252:255], a[88:91], a[176:179], v[252:255]
M a[0:3], a[32:35], a[184:187], 0
M a[0:3], a[36:39], a[188:191], a[0:3]
ds_read_b128 a[168:171], v10 offset:34816
ds_read_b128 a[172:175], v11 offset:34816
M a[4:7], a[44:47], a[188:191], 0
M a[4:7], a[40:43], a[184:187], a[4:7]
M a[8:11], a[48:51], a[184:187], 0
buffer_load_dwordx4 v4, s[8:11], s23 offen offset:2048 lds
M a[8:11], a[52:55], a[188:191], a[8:11]
M a[12:15], a[60:63], a[188:191], 0
M a[12:15], a[56:59], a[184:187], a[12:15]
M a[16:19], a[64:67], a[184:187], 0
M a[16:19], a[68:71], a[188:191], a[16:19]
buffer_load_dwordx4 v5, s[8:11], s23 offen offset:3072 lds
M a[20:23], a[76:79], a[188:191], 0
M a[20:23], a[72:75], a[184:187], a[20:23]
M a[24:27], a[80:83], a[184:187], 0
M a[24:27], a[84:87], a[188:191], a[24:27]
M a[28:31], a[92:95], a[188:191], 0
M a[28:31], a[88:91], a[184:187], a[28:31]
s_waitcnt lgkmcnt(2)
M v[32:35], a[96:99], a[160:163], v[32:35]
s_add_u32 m0, s29, 98304
s_nop 0
buffer_load_dwordx4 v6, s[12:15], s24 offen offset:0 lds
M v[32:35], a[100:103], a[164:167], v[32:35]
ds_read_b128 a[176:179], v10 offset:36864
ds_read_b128 a[180:183], v11 offset:36864
M v[36:39], a[108:111], a[164:167], v[36:39]
M v[36:39], a[104:107], a[160:163], v[36:39]
ds_read_b64_tr_b16 a[32:33], v12 offset:0
ds_read_b64_tr_b16 a[34:35], v12 offset:2048
M v[40:43], a[112:115], a[160:163], v[40:43]
M v[40:43], a[116:119], a[164:167], v[40:43]
M v[44:47], a[124:127], a[164:167], v[44:47]
M v[44:47], a[120:123], a[160:163], v[44:47]
ds_read_b64_tr_b16 a[40:41], v13 offset:0
ds_read_b64_tr_b16 a[42:43], v13 offset:2048
M v[48:51], a[128:131], a[160:163], v[48:51]
buffer_load_dwordx4 v7, s[12:15], s24 offen offset:1024 lds
M v[48:51], a[132:135], a[164:167], v[48:51]
M v[52:55], a[140:143], a[164:167], v[52:55]
M v[52:55], a[136:139], a[160:163], v[52:55]
ds_read_b64_tr_b16 a[48:49], v14 offset:0
ds_read_b64_tr_b16 a[50:51], v14 offset:2048
M v[56:59], a[144:147], a[160:163], v[56:59]
M v[56:59], a[148:151], a[164:167], v[56:59]
M v[60:63], a[156:159], a[164:167], v[60:63]
buffer_load_dwordx4 v8, s[12:15], s24 offen offset:2048 lds
M v[60:63], a[152:155], a[160:163], v[60:63]
s_waitcnt lgkmcnt(8)
ds_read_b64_tr_b16 a[56:57], v15 offset:0
ds_read_b64_tr_b16 a[58:59], v15 offset:2048
M v[64:67], a[96:99], a[168:171], v[64:67]
M v[64:67], a[100:103], a[172:175], v[64:67]
ds_read_b128 a[184:187], v10 offset:38912
ds_read_b128 a[188:191], v11 offset:38912
M v[68:71], a[108:111], a[172:175], v[68:71]
M v[68:71], a[104:107], a[168:171], v[68:71]
ds_read_b64_tr_b16 a[64:65], v16 offset:0
ds_read_b64_tr_b16 a[66:67], v16 offset:2048
M v[72:75], a[112:115], a[168:171], v[72:75]
M v[72:75], a[116:119], a[172:175], v[72:75]
M v[76:79], a[124:127], a[172:175], v[76:79]
M v[76:79], a[120:123], a[168:171], v[76:79]
ds_read_b64_tr_b16 a[72:73], v17 offset:0
ds_read_b64_tr_b16 a[74:75], v17 offset:2048
M v[80:83], a[128:131], a[168:171], v[80:83]
buffer_load_dwordx4 v9, s[12:15], s24 offen offset:3072 lds
M v[80:83], a[132:135], a[172:175], v[80:83]
M v[84:87], a[140:143], a[172:175], v[84:87]
M v[84:87], a[136:139], a[168:171], v[84:87]
ds_read_b64_tr_b16 a[80:81], v18 offset:0
ds_read_b64_tr_b16 a[82:83], v18 offset:2048
M v[88:91], a[144:147], a[168:171], v[88:91]
M v[88:91], a[148:151], a[172:175], v[88:91]
M v[92:95], a[156:159], a[172:175], v[92:95]
s_add_u32 s24, s24, 262144
M v[92:95], a[152:155], a[168:171], v[92:95]
s_waitcnt lgkmcnt(15)
ds_read_b64_tr_b16 a[88:89], v19 offset:0
ds_read_b64_tr_b16 a[90:91], v19 offset:2048
M v[96:99], a[96:99], a[176:179], v[96:99]
M v[96:99], a[100:103], a[180:183], v[96:99]
M v[100:103], a[108:111], a[180:183], v[100:103]
M v[100:103], a[104:107], a[176:179], v[100:103]
M v[104:107], a[112:115], a[176:179], v[104:107]
M v[104:107], a[116:119], a[180:183], v[104:107]
M v[108:111], a[124:127], a[180:183], v[108:111]
M v[108:111], a[120:123], a[176:179], v[108:111]
s_waitcnt vmcnt(8) lgkmcnt(0)
s_barrier
ds_read_b128 a[160:163], v10 offset:49152
ds_read_b128 a[164:167], v11 offset:49152
M v[112:115], a[128:131], a[176:179], v[112:115]
s_add_u32 m0, s29, 16384
s_add_u32 s3, s23, s31
buffer_load_dwordx4 v2, s[8:11], s3 offen offset:0 lds
M v[112:115], a[132:135], a[180:183], v[112:115]
M v[116:119], a[140:143], a[180:183], v[116:119]
M v[116:119], a[136:139], a[176:179], v[116:119]
ds_read_b64_tr_b16 a[36:37], v12 offset:16384
ds_read_b64_tr_b16 a[38:39], v12 offset:18432
M v[120:123], a[144:147], a[176:179], v[120:123]
M v[120:123], a[148:151], a[180:183], v[120:123]
buffer_load_dwordx4 v3, s[8:11], s3 offen offset:1024 lds
M v[124:127], a[156:159], a[180:183], v[124:127]
M v[124:127], a[152:155], a[176:179], v[124:127]
M v[128:131], a[96:99], a[184:187], v[128:131]
M v[128:131], a[100:103], a[188:191], v[128:131]
ds_read_b128 a[168:171], v10 offset:51200
ds_read_b128 a[172:175], v11 offset:51200
ds_read_b64_tr_b16 a[44:45], v13 offset:16384
ds_read_b64_tr_b16 a[46:47], v13 offset:18432
M v[132:135], a[108:111], a[188:191], v[132:135]
M v[132:135], a[104:107], a[184:187], v[132:135]
buffer_load_dwordx4 v4, s[8:11], s3 offen offset:2048 lds
M v[136:139], a[112:115], a[184:187], v[136:139]
M v[136:139], a[116:119], a[188:191], v[136:139]
M v[140:143], a[124:127], a[188:191], v[140:143]
M v[140:143], a[120:123], a[184:187], v[140:143]
ds_read_b64_tr_b16 a[52:53], v14 offset:16384
ds_read_b64_tr_b16 a[54:55], v14 offset:18432
M v[144:147], a[128:131], a[184:187], v[144:147]
M v[144:147], a[132:135], a[188:191], v[144:147]
buffer_load_dwordx4 v5, s[8:11], s3 offen offset:3072 lds
M v[148:151], a[140:143], a[188:191], v[148:151]
M v[148:151], a[136:139], a[184:187], v[148:151]
M v[152:155], a[144:147], a[184:187], v[152:155]
buffer_store_dwordx4 v[28:31], v23, s[16:19], s56 offen sc1
M v[152:155], a[148:151], a[188:191], v[152:155]
ds_read_b64_tr_b16 a[60:61], v15 offset:16384
ds_read_b64_tr_b16 a[62:63], v15 offset:18432
M v[156:159], a[156:159], a[188:191], v[156:159]
M v[156:159], a[152:155], a[184:187], v[156:159]
s_waitcnt lgkmcnt(10)
M v[160:163], a[96:99], a[160:163], v[160:163]
s_add_u32 s23, s23, 128
s_cmp_eq_u32 s23, s25
s_cselect_b32 s23, s26, s23
M v[160:163], a[100:103], a[164:167], v[160:163]
ds_read_b128 a[176:179], v10 offset:53248
ds_read_b128 a[180:183], v11 offset:53248
M v[164:167], a[108:111], a[164:167], v[164:167]
M v[164:167], a[104:107], a[160:163], v[164:167]
ds_read_b64_tr_b16 a[68:69], v16 offset:16384
ds_read_b64_tr_b16 a[70:71], v16 offset:18432
M v[168:171], a[112:115], a[160:163], v[168:171]
M v[168:171], a[116:119], a[164:167], v[168:171]
M v[172:175], a[124:127], a[164:167], v[172:175]
M v[172:175], a[120:123], a[160:163], v[172:175]
s_add_u32 m0, s29, 114688
s_nop 0
buffer_load_dwordx4 v6, s[12:15], s24 offen offset:0 lds
M v[176:179], a[128:131], a[160:163], v[176:179]
buffer_store_dwordx4 v[28:31], v23, s[16:19], s57 offen sc1
M v[176:179], a[132:135], a[164:167], v[176:179]
ds_read_b64_tr_b16 a[76:77], v17 offset:16384
ds_read_b64_tr_b16 a[78:79], v17 offset:18432
M v[180:183], a[140:143], a[164:167], v[180:183]
M v[180:183], a[136:139], a[160:163], v[180:183]
M v[184:187], a[144:147], a[160:163], v[184:187]
M v[184:187], a[148:151], a[164:167], v[184:187]
buffer_load_dwordx4 v7, s[12:15], s24 offen offset:1024 lds
M v[188:191], a[156:159], a[164:167], v[188:191]
M v[188:191], a[152:155], a[160:163], v[188:191]
s_waitcnt lgkmcnt(12)
ds_read_b64_tr_b16 a[84:85], v18 offset:16384
ds_read_b64_tr_b16 a[86:87], v18 offset:18432
M v[192:195], a[96:99], a[168:171], v[192:195]
M v[192:195], a[100:103], a[172:175], v[192:195]
ds_read_b128 a[184:187], v10 offset:55296
ds_read_b128 a[188:191], v11 offset:55296
M v[196:199], a[108:111], a[172:175], v[196:199]
M v[196:199], a[104:107], a[168:171], v[196:199]
buffer_load_dwordx4 v8, s[12:15], s24 offen offset:2048 lds
M v[200:203], a[112:115], a[168:171], v[200:203]
buffer_store_dwordx4 v[28:31], v23, s[16:19], s58 offen sc1
M v[200:203], a[116:119], a[172:175], v[200:203]
ds_read_b64_tr_b16 a[92:93], v19 offset:16384
ds_read_b64_tr_b16 a[94:95], v19 offset:18432
M v[204:207], a[124:127], a[172:175], v[204:207]
M v[204:207], a[120:123], a[168:171], v[204:207]
M v[208:211], a[128:131], a[168:171], v[208:211]
M v[208:211], a[132:135], a[172:175], v[208:211]
M v[212:215], a[140:143], a[172:175], v[212:215]
buffer_load_dwordx4 v9, s[12:15], s24 offen offset:3072 lds
M v[212:215], a[136:139], a[168:171], v[212:215]
M v[216:219], a[144:147], a[168:171], v[216:219]
M v[216:219], a[148:151], a[172:175], v[216:219]
M v[220:223], a[156:159], a[172:175], v[220:223]
s_add_u32 s24, s24, 262144
s_cmp_eq_u32 s24, s27
s_cselect_b32 s24, s28, s24
s_sub_u32 s6, s6, 1
s_cmp_eq_u32 s6, 0
s_cselect_b64 s[12:13], s[64:65], s[12:13]
M v[220:223], a[152:155], a[168:171], v[220:223]
s_waitcnt lgkmcnt(10)
M v[224:227], a[96:99], a[176:179], v[224:227]
buffer_store_dwordx4 v[28:31], v23, s[16:19], s59 offen sc1
M v[224:227], a[100:103], a[180:183], v[224:227]
M v[228:231], a[108:111], a[180:183], v[228:231]
M v[228:231], a[104:107], a[176:179], v[228:231]
M v[232:235], a[112:115], a[176:179], v[232:235]
M v[232:235], a[116:119], a[180:183], v[232:235]
M v[236:239], a[124:127], a[180:183], v[236:239]
M v[236:239], a[120:123], a[176:179], v[236:239]
s_waitcnt vmcnt(12) lgkmcnt(0)
s_barrier
ds_read_b128 a[160:163], v10 offset:0
ds_read_b128 a[164:167], v11 offset:0
M v[240:243], a[128:131], a[176:179], v[240:243]
s_add_u32 m0, s29, 32768
s_nop 0
buffer_load_dwordx4 v2, s[8:11], s23 offen offset:0 lds
M v[240:243], a[132:135], a[180:183], v[240:243]
M v[244:247], a[140:143], a[180:183], v[244:247]
M v[244:247], a[136:139], a[176:179], v[244:247]
M v[248:251], a[144:147], a[176:179], v[248:251]
M v[248:251], a[148:151], a[180:183], v[248:251]
buffer_load_dwordx4 v3, s[8:11], s23 offen offset:1024 lds
M v[252:255], a[156:159], a[180:183], v[252:255]
M v[252:255], a[152:155], a[176:179], v[252:255]
M a[0:3], a[96:99], a[184:187], a[0:3]
M a[0:3], a[100:103], a[188:191], a[0:3]
ds_read_b128 a[168:171], v10 offset:2048
ds_read_b128 a[172:175], v11 offset:2048
M a[4:7], a[108:111], a[188:191], a[4:7]
M a[4:7], a[104:107], a[184:187], a[4:7]
M a[8:11], a[112:115], a[184:187], a[8:11]
buffer_load_dwordx4 v4, s[8:11], s23 offen offset:2048 lds
M a[8:11], a[116:119], a[188:191], a[8:11]
M a[12:15], a[124:127], a[188:191], a[12:15]
M a[12:15], a[120:123], a[184:187], a[12:15]
M a[16:19], a[128:131], a[184:187], a[16:19]
M a[16:19], a[132:135], a[188:191], a[16:19]
buffer_load_dwordx4 v5, s[8:11], s23 offen offset:3072 lds
M a[20:23], a[140:143], a[188:191], a[20:23]
M a[20:23], a[136:139], a[184:187], a[20:23]
M a[24:27], a[144:147], a[184:187], a[24:27]
M a[24:27], a[148:151], a[188:191], a[24:27]
M a[28:31], a[156:159], a[188:191], a[28:31]
M a[28:31], a[152:155], a[184:187], a[28:31]
s_waitcnt lgkmcnt(2)
s_mov_b32 s30, 2
Lk1_kl:
M v[32:35], a[32:35], a[160:163], v[32:35]
s_add_u32 m0, s29, 65536
s_nop 0
buffer_load_dwordx4 v6, s[12:15], s24 offen offset:0 lds
M v[32:35], a[36:39], a[164:167], v[32:35]
ds_read_b128 a[176:179], v10 offset:4096
ds_read_b128 a[180:183], v11 offset:4096
M v[36:39], a[44:47], a[164:167], v[36:39]
M v[36:39], a[40:43], a[160:163], v[36:39]
ds_read_b64_tr_b16 a[96:97], v12 offset:32768
ds_read_b64_tr_b16 a[98:99], v12 offset:34816
M v[40:43], a[48:51], a[160:163], v[40:43]
M v[40:43], a[52:55], a[164:167], v[40:43]
M v[44:47], a[60:63], a[164:167], v[44:47]
M v[44:47], a[56:59], a[160:163], v[44:47]
ds_read_b64_tr_b16 a[104:105], v13 offset:32768
ds_read_b64_tr_b16 a[106:107], v13 offset:34816
M v[48:51], a[64:67], a[160:163], v[48:51]
buffer_load_dwordx4 v7, s[12:15], s24 offen offset:1024 lds
M v[48:51], a[68:71], a[164:167], v[48:51]
M v[52:55], a[76:79], a[164:167], v[52:55]
M v[52:55], a[72:75], a[160:163], v[52:55]
ds_read_b64_tr_b16 a[112:113], v14 offset:32768
ds_read_b64_tr_b16 a[114:115], v14 offset:34816
M v[56:59], a[80:83], a[160:163], v[56:59]
M v[56:59], a[84:87], a[164:167], v[56:59]
M v[60:63], a[92:95], a[164:167], v[60:63]
buffer_load_dwordx4 v8, s[12:15], s24 offen offset:2048 lds
M v[60:63], a[88:91], a[160:163], v[60:63]
s_waitcnt lgkmcnt(8)
ds_read_b64_tr_b16 a[120:121], v15 offset:32768
ds_read_b64_tr_b16 a[122:123], v15 offset:34816
M v[64:67], a[32:35], a[168:171], v[64:67]
M v[64:67], a[36:39], a[172:175], v[64:67]
ds_read_b128 a[184:187], v10 offset:6144
ds_read_b128 a[188:191], v11 offset:6144
M v[68:71], a[44:47], a[172:175], v[68:71]
M v[68:71], a[40:43], a[168:171], v[68:71]
ds_read_b64_tr_b16 a[128:129], v16 offset:32768
ds_read_b64_tr_b16 a[130:131], v16 offset:34816
M v[72:75], a[48:51], a[168:171], v[72:75]
M v[72:75], a[52:55], a[172:175], v[72:75]
M v[76:79], a[60:63], a[172:175], v[76:79]
M v[76:79], a[56:59], a[168:171], v[76:79]
ds_read_b64_tr_b16 a[136:137], v17 offset:32768
ds_read_b64_tr_b16 a[138:139], v17 offset:34816
M v[80:83], a[64:67], a[168:171], v[80:83]
buffer_load_dwordx4 v9, s[12:15], s24 offen offset:3072 lds
M v[80:83], a[68:71], a[172:175], v[80:83]
M v[84:87], a[76:79], a[172:175], v[84:87]
M v[84:87], a[72:75], a[168:171], v[84:87]
ds_read_b64_tr_b16 a[144:145], v18 offset:32768
ds_read_b64_tr_b16 a[146:147], v18 offset:34816
M v[88:91], a[80:83], a[168:171], v[88:91]
M v[88:91], a[84:87], a[172:175], v[88:91]
M v[92:95], a[92:95], a[172:175], v[92:95]
s_add_u32 s24, s24, 262144
M v[92:95], a[88:91], a[168:171], v[92:95]
s_waitcnt lgkmcnt(15)
ds_read_b64_tr_b16 a[152:153], v19 offset:32768
ds_read_b64_tr_b16 a[154:155], v19 offset:34816
M v[96:99], a[32:35], a[176:179], v[96:99]
M v[96:99], a[36:39], a[180:183], v[96:99]
M v[100:103], a[44:47], a[180:183], v[100:103]
M v[100:103], a[40:43], a[176:179], v[100:103]
M v[104:107], a[48:51], a[176:179], v[104:107]
M v[104:107], a[52:55], a[180:183], v[104:107]
M v[108:111], a[60:63], a[180:183], v[108:111]
M v[108:111], a[56:59], a[176:179], v[108:111]
s_waitcnt vmcnt(8) lgkmcnt(0)
s_barrier
ds_read_b128 a[160:163], v10 offset:16384
ds_read_b128 a[164:167], v11 offset:16384
M v[112:115], a[64:67], a[176:179], v[112:115]
s_add_u32 m0, s29, 49152
s_add_u32 s3, s23, s31
buffer_load_dwordx4 v2, s[8:11], s3 offen offset:0 lds
M v[112:115], a[68:71], a[180:183], v[112:115]
M v[116:119], a[76:79], a[180:183], v[116:119]
M v[116:119], a[72:75], a[176:179], v[116:119]
ds_read_b64_tr_b16 a[100:101], v12 offset:49152
ds_read_b64_tr_b16 a[102:103], v12 offset:51200
M v[120:123], a[80:83], a[176:179], v[120:123]
M v[120:123], a[84:87], a[180:183], v[120:123]
buffer_load_dwordx4 v3, s[8:11], s3 offen offset:1024 lds
M v[124:127], a[92:95], a[180:183], v[124:127]
M v[124:127], a[88:91], a[176:179], v[124:127]
M v[128:131], a[32:35], a[184:187], v[128:131]
M v[128:131], a[36:39], a[188:191], v[128:131]
ds_read_b128 a[168:171], v10 offset:18432
ds_read_b128 a[172:175], v11 offset:18432
ds_read_b64_tr_b16 a[108:109], v13 offset:49152
ds_read_b64_tr_b16 a[110:111], v13 offset:51200
M v[132:135], a[44:47], a[188:191], v[132:135]
M v[132:135], a[40:43], a[184:187], v[132:135]
M v[136:139], a[48:51], a[184:187], v[136:139]
buffer_load_dwordx4 v4, s[8:11], s3 offen offset:2048 lds
M v[136:139], a[52:55], a[188:191], v[136:139]
M v[140:143], a[60:63], a[188:191], v[140:143]
M v[140:143], a[56:59], a[184:187], v[140:143]
ds_read_b64_tr_b16 a[116:117], v14 offset:49152
ds_read_b64_tr_b16 a[118:119], v14 offset:51200
M v[144:147], a[64:67], a[184:187], v[144:147]
M v[144:147], a[68:71], a[188:191], v[144:147]
M v[148:151], a[76:79], a[188:191], v[148:151]
buffer_load_dwordx4 v5, s[8:11], s3 offen offset:3072 lds
M v[148:151], a[72:75], a[184:187], v[148:151]
M v[152:155], a[80:83], a[184:187], v[152:155]
M v[152:155], a[84:87], a[188:191], v[152:155]
ds_read_b64_tr_b16 a[124:125], v15 offset:49152
ds_read_b64_tr_b16 a[126:127], v15 offset:51200
M v[156:159], a[92:95], a[188:191], v[156:159]
M v[156:159], a[88:91], a[184:187], v[156:159]
s_waitcnt lgkmcnt(10)
M v[160:163], a[32:35], a[160:163], v[160:163]
M v[160:163], a[36:39], a[164:167], v[160:163]
ds_read_b128 a[176:179], v10 offset:20480
ds_read_b128 a[180:183], v11 offset:20480
M v[164:167], a[44:47], a[164:167], v[164:167]
s_add_u32 s23, s23, 128
s_cmp_eq_u32 s23, s25
s_cselect_b32 s23, s26, s23
M v[164:167], a[40:43], a[160:163], v[164:167]
ds_read_b64_tr_b16 a[132:133], v16 offset:49152
ds_read_b64_tr_b16 a[134:135], v16 offset:51200
M v[168:171], a[48:51], a[160:163], v[168:171]
M v[168:171], a[52:55], a[164:167], v[168:171]
M v[172:175], a[60:63], a[164:167], v[172:175]
M v[172:175], a[56:59], a[160:163], v[172:175]
M v[176:179], a[64:67], a[160:163], v[176:179]
s_add_u32 m0, s29, 81920
s_nop 0
buffer_load_dwordx4 v6, s[12:15], s24 offen offset:0 lds
M v[176:179], a[68:71], a[164:167], v[176:179]
ds_read_b64_tr_b16 a[140:141], v17 offset:49152
ds_read_b64_tr_b16 a[142:143], v17 offset:51200
M v[180:183], a[76:79], a[164:167], v[180:183]
M v[180:183], a[72:75], a[160:163], v[180:183]
M v[184:187], a[80:83], a[160:163], v[184:187]
M v[184:187], a[84:87], a[164:167], v[184:187]
buffer_load_dwordx4 v7, s[12:15], s24 offen offset:1024 lds
M v[188:191], a[92:95], a[164:167], v[188:191]
M v[188:191], a[88:91], a[160:163], v[188:191]
s_waitcnt lgkmcnt(12)
ds_read_b64_tr_b16 a[148:149], v18 offset:49152
ds_read_b64_tr_b16 a[150:151], v18 offset:51200
M v[192:195], a[32:35], a[168:171], v[192:195]
M v[192:195], a[36:39], a[172:175], v[192:195]
ds_read_b128 a[184:187], v10 offset:22528
ds_read_b128 a[188:191], v11 offset:22528
M v[196:199], a[44:47], a[172:175], v[196:199]
M v[196:199], a[40:43], a[168:171], v[196:199]
M v[200:203], a[48:51], a[168:171], v[200:203]
buffer_load_dwordx4 v8, s[12:15], s24 offen offset:2048 lds
M v[200:203], a[52:55], a[172:175], v[200:203]
ds_read_b64_tr_b16 a[156:157], v19 offset:49152
ds_read_b64_tr_b16 a[158:159], v19 offset:51200
M v[204:207], a[60:63], a[172:175], v[204:207]
M v[204:207], a[56:59], a[168:171], v[204:207]
M v[208:211], a[64:67], a[168:171], v[208:211]
M v[208:211], a[68:71], a[172:175], v[208:211]
M v[212:215], a[76:79], a[172:175], v[212:215]
buffer_load_dwordx4 v9, s[12:15], s24 offen offset:3072 lds
M v[212:215], a[72:75], a[168:171], v[212:215]
M v[216:219], a[80:83], a[168:171], v[216:219]
M v[216:219], a[84:87], a[172:175], v[216:219]
M v[220:223], a[92:95], a[172:175], v[220:223]
M v[220:223], a[88:91], a[168:171], v[220:223]
s_waitcnt lgkmcnt(10)
M v[224:227], a[32:35], a[176:179], v[224:227]
s_add_u32 s24, s24, 262144
s_cmp_eq_u32 s24, s27
s_cselect_b32 s24, s28, s24
s_sub_u32 s6, s6, 1
s_cmp_eq_u32 s6, 0
s_cselect_b64 s[12:13], s[64:65], s[12:13]
M v[224:227], a[36:39], a[180:183], v[224:227]
M v[228:231], a[44:47], a[180:183], v[228:231]
M v[228:231], a[40:43], a[176:179], v[228:231]
M v[232:235], a[48:51], a[176:179], v[232:235]
M v[232:235], a[52:55], a[180:183], v[232:235]
M v[236:239], a[60:63], a[180:183], v[236:239]
M v[236:239], a[56:59], a[176:179], v[236:239]
s_waitcnt vmcnt(8) lgkmcnt(0)
s_barrier
ds_read_b128 a[160:163], v10 offset:32768
ds_read_b128 a[164:167], v11 offset:32768
M v[240:243], a[64:67], a[176:179], v[240:243]
s_add_u32 m0, s29, 0
s_nop 0
buffer_load_dwordx4 v2, s[8:11], s23 offen offset:0 lds
M v[240:243], a[68:71], a[180:183], v[240:243]
M v[244:247], a[76:79], a[180:183], v[244:247]
M v[244:247], a[72:75], a[176:179], v[244:247]
M v[248:251], a[80:83], a[176:179], v[248:251]
M v[248:251], a[84:87], a[180:183], v[248:251]
buffer_load_dwordx4 v3, s[8:11], s23 offen offset:1024 lds
M v[252:255], a[92:95], a[180:183], v[252:255]
M v[252:255], a[88:91], a[176:179], v[252:255]
M a[0:3], a[32:35], a[184:187], a[0:3]
M a[0:3], a[36:39], a[188:191], a[0:3]
ds_read_b128 a[168:171], v10 offset:34816
ds_read_b128 a[172:175], v11 offset:34816
M a[4:7], a[44:47], a[188:191], a[4:7]
M a[4:7], a[40:43], a[184:187], a[4:7]
M a[8:11], a[48:51], a[184:187], a[8:11]
buffer_load_dwordx4 v4, s[8:11], s23 offen offset:2048 lds
M a[8:11], a[52:55], a[188:191], a[8:11]
M a[12:15], a[60:63], a[188:191], a[12:15]
M a[12:15], a[56:59], a[184:187], a[12:15]
M a[16:19], a[64:67], a[184:187], a[16:19]
M a[16:19], a[68:71], a[188:191], a[16:19]
buffer_load_dwordx4 v5, s[8:11], s23 offen offset:3072 lds
M a[20:23], a[76:79], a[188:191], a[20:23]
M a[20:23], a[72:75], a[184:187], a[20:23]
M a[24:27], a[80:83], a[184:187], a[24:27]
M a[24:27], a[84:87], a[188:191], a[24:27]
M a[28:31], a[92:95], a[188:191], a[28:31]
M a[28:31], a[88:91], a[184:187], a[28:31]
s_waitcnt lgkmcnt(2)
M v[32:35], a[96:99], a[160:163], v[32:35]
s_add_u32 m0, s29, 98304
s_nop 0
buffer_load_dwordx4 v6, s[12:15], s24 offen offset:0 lds
M v[32:35], a[100:103], a[164:167], v[32:35]
ds_read_b128 a[176:179], v10 offset:36864
ds_read_b128 a[180:183], v11 offset:36864
M v[36:39], a[108:111], a[164:167], v[36:39]
M v[36:39], a[104:107], a[160:163], v[36:39]
ds_read_b64_tr_b16 a[32:33], v12 offset:0
ds_read_b64_tr_b16 a[34:35], v12 offset:2048
M v[40:43], a[112:115], a[160:163], v[40:43]
M v[40:43], a[116:119], a[164:167], v[40:43]
M v[44:47], a[124:127], a[164:167], v[44:47]
M v[44:47], a[120:123], a[160:163], v[44:47]
ds_read_b64_tr_b16 a[40:41], v13 offset:0
ds_read_b64_tr_b16 a[42:43], v13 offset:2048
M v[48:51], a[128:131], a[160:163], v[48:51]
buffer_load_dwordx4 v7, s[12:15], s24 offen offset:1024 lds
M v[48:51], a[132:135], a[164:167], v[48:51]
M v[52:55], a[140:143], a[164:167], v[52:55]
M v[52:55], a[136:139], a[160:163], v[52:55]
ds_read_b64_tr_b16 a[48:49], v14 offset:0
ds_read_b64_tr_b16 a[50:51], v14 offset:2048
M v[56:59], a[144:147], a[160:163], v[56:59]
M v[56:59], a[148:151], a[164:167], v[56:59]
M v[60:63], a[156:159], a[164:167], v[60:63]
buffer_load_dwordx4 v8, s[12:15], s24 offen offset:2048 lds
M v[60:63], a[152:155], a[160:163], v[60:63]
s_waitcnt lgkmcnt(8)
ds_read_b64_tr_b16 a[56:57], v15 offset:0
ds_read_b64_tr_b16 a[58:59], v15 offset:2048
M v[64:67], a[96:99], a[168:171], v[64:67]
M v[64:67], a[100:103], a[172:175], v[64:67]
ds_read_b128 a[184:187], v10 offset:38912
ds_read_b128 a[188:191], v11 offset:38912
M v[68:71], a[108:111], a[172:175], v[68:71]
M v[68:71], a[104:107], a[168:171], v[68:71]
ds_read_b64_tr_b16 a[64:65], v16 offset:0
ds_read_b64_tr_b16 a[66:67], v16 offset:2048
M v[72:75], a[112:115], a[168:171], v[72:75]
M v[72:75], a[116:119], a[172:175], v[72:75]
M v[76:79], a[124:127], a[172:175], v[76:79]
M v[76:79], a[120:123], a[168:171], v[76:79]
ds_read_b64_tr_b16 a[72:73], v17 offset:0
ds_read_b64_tr_b16 a[74:75], v17 offset:2048
M v[80:83], a[128:131], a[168:171], v[80:83]
buffer_load_dwordx4 v9, s[12:15], s24 offen offset:3072 lds
M v[80:83], a[132:135], a[172:175], v[80:83]
M v[84:87], a[140:143], a[172:175], v[84:87]
M v[84:87], a[136:139], a[168:171], v[84:87]
ds_read_b64_tr_b16 a[80:81], v18 offset:0
ds_read_b64_tr_b16 a[82:83], v18 offset:2048
M v[88:91], a[144:147], a[168:171], v[88:91]
M v[88:91], a[148:151], a[172:175], v[88:91]
M v[92:95], a[156:159], a[172:175], v[92:95]
s_add_u32 s24, s24, 262144
M v[92:95], a[152:155], a[168:171], v[92:95]
s_waitcnt lgkmcnt(15)
ds_read_b64_tr_b16 a[88:89], v19 offset:0
ds_read_b64_tr_b16 a[90:91], v19 offset:2048
M v[96:99], a[96:99], a[176:179], v[96:99]
M v[96:99], a[100:103], a[180:183], v[96:99]
M v[100:103], a[108:111], a[180:183], v[100:103]
M v[100:103], a[104:107], a[176:179], v[100:103]
M v[104:107], a[112:115], a[176:179], v[104:107]
M v[104:107], a[116:119], a[180:183], v[104:107]
M v[108:111], a[124:127], a[180:183], v[108:111]
M v[108:111], a[120:123], a[176:179], v[108:111]
s_waitcnt vmcnt(8) lgkmcnt(0)
s_barrier
ds_read_b128 a[160:163], v10 offset:49152
ds_read_b128 a[164:167], v11 offset:49152
M v[112:115], a[128:131], a[176:179], v[112:115]
s_add_u32 m0, s29, 16384
s_add_u32 s3, s23, s31
buffer_load_dwordx4 v2, s[8:11], s3 offen offset:0 lds
M v[112:115], a[132:135], a[180:183], v[112:115]
M v[116:119], a[140:143], a[180:183], v[116:119]
M v[116:119], a[136:139], a[176:179], v[116:119]
ds_read_b64_tr_b16 a[36:37], v12 offset:16384
ds_read_b64_tr_b16 a[38:39], v12 offset:18432
M v[120:123], a[144:147], a[176:179], v[120:123]
M v[120:123], a[148:151], a[180:183], v[120:123]
buffer_load_dwordx4 v3, s[8:11], s3 offen offset:1024 lds
M v[124:127], a[156:159], a[180:183], v[124:127]
M v[124:127], a[152:155], a[176:179], v[124:127]
M v[128:131], a[96:99], a[184:187], v[128:131]
M v[128:131], a[100:103], a[188:191], v[128:131]
ds_read_b128 a[168:171], v10 offset:51200
ds_read_b128 a[172:175], v11 offset:51200
ds_read_b64_tr_b16 a[44:45], v13 offset:16384
ds_read_b64_tr_b16 a[46:47], v13 offset:18432
M v[132:135], a[108:111], a[188:191], v[132:135]
M v[132:135], a[104:107], a[184:187], v[132:135]
M v[136:139], a[112:115], a[184:187], v[136:139]
buffer_load_dwordx4 v4, s[8:11], s3 offen offset:2048 lds
M v[136:139], a[116:119], a[188:191], v[136:139]
M v[140:143], a[124:127], a[188:191], v[140:143]
M v[140:143], a[120:123], a[184:187], v[140:143]
ds_read_b64_tr_b16 a[52:53], v14 offset:16384
ds_read_b64_tr_b16 a[54:55], v14 offset:18432
M v[144:147], a[128:131], a[184:187], v[144:147]
M v[144:147], a[132:135], a[188:191], v[144:147]
M v[148:151], a[140:143], a[188:191], v[148:151]
buffer_load_dwordx4 v5, s[8:11], s3 offen offset:3072 lds
M v[148:151], a[136:139], a[184:187], v[148:151]
M v[152:155], a[144:147], a[184:187], v[152:155]
M v[152:155], a[148:151], a[188:191], v[152:155]
ds_read_b64_tr_b16 a[60:61], v15 offset:16384
ds_read_b64_tr_b16 a[62:63], v15 offset:18432
M v[156:159], a[156:159], a[188:191], v[156:159]
M v[156:159], a[152:155], a[184:187], v[156:159]
s_waitcnt lgkmcnt(10)
M v[160:163], a[96:99], a[160:163], v[160:163]
M v[160:163], a[100:103], a[164:167], v[160:163]
ds_read_b128 a[176:179], v10 offset:53248
ds_read_b128 a[180:183], v11 offset:53248
M v[164:167], a[108:111], a[164:167], v[164:167]
s_add_u32 s23, s23, 128
s_cmp_eq_u32 s23, s25
s_cselect_b32 s23, s26, s23
M v[164:167], a[104:107], a[160:163], v[164:167]
ds_read_b64_tr_b16 a[68:69], v16 offset:16384
ds_read_b64_tr_b16 a[70:71], v16 offset:18432
M v[168:171], a[112:115], a[160:163], v[168:171]
M v[168:171], a[116:119], a[164:167], v[168:171]
M v[172:175], a[124:127], a[164:167], v[172:175]
M v[172:175], a[120:123], a[160:163], v[172:175]
M v[176:179], a[128:131], a[160:163], v[176:179]
s_add_u32 m0, s29, 114688
s_nop 0
buffer_load_dwordx4 v6, s[12:15], s24 offen offset:0 lds
M v[176:179], a[132:135], a[164:167], v[176:179]
ds_read_b64_tr_b16 a[76:77], v17 offset:16384
ds_read_b64_tr_b16 a[78:79], v17 offset:18432
M v[180:183], a[140:143], a[164:167], v[180:183]
M v[180:183], a[136:139], a[160:163], v[180:183]
M v[184:187], a[144:147], a[160:163], v[184:187]
M v[184:187], a[148:151], a[164:167], v[184:187]
buffer_load_dwordx4 v7, s[12:15], s24 offen offset:1024 lds
M v[188:191], a[156:159], a[164:167], v[188:191]
M v[188:191], a[152:155], a[160:163], v[188:191]
s_waitcnt lgkmcnt(12)
ds_read_b64_tr_b16 a[84:85], v18 offset:16384
ds_read_b64_tr_b16 a[86:87], v18 offset:18432
M v[192:195], a[96:99], a[168:171], v[192:195]
M v[192:195], a[100:103], a[172:175], v[192:195]
ds_read_b128 a[184:187], v10 offset:55296
ds_read_b128 a[188:191], v11 offset:55296
M v[196:199], a[108:111], a[172:175], v[196:199]
M v[196:199], a[104:107], a[168:171], v[196:199]
M v[200:203], a[112:115], a[168:171], v[200:203]
buffer_load_dwordx4 v8, s[12:15], s24 offen offset:2048 lds
M v[200:203], a[116:119], a[172:175], v[200:203]
ds_read_b64_tr_b16 a[92:93], v19 offset:16384
ds_read_b64_tr_b16 a[94:95], v19 offset:18432
M v[204:207], a[124:127], a[172:175], v[204:207]
M v[204:207], a[120:123], a[168:171], v[204:207]
M v[208:211], a[128:131], a[168:171], v[208:211]
M v[208:211], a[132:135], a[172:175], v[208:211]
M v[212:215], a[140:143], a[172:175], v[212:215]
buffer_load_dwordx4 v9, s[12:15], s24 offen offset:3072 lds
M v[212:215], a[136:139], a[168:171], v[212:215]
M v[216:219], a[144:147], a[168:171], v[216:219]
M v[216:219], a[148:151], a[172:175], v[216:219]
M v[220:223], a[156:159], a[172:175], v[220:223]
M v[220:223], a[152:155], a[168:171], v[220:223]
s_waitcnt lgkmcnt(10)
M v[224:227], a[96:99], a[176:179], v[224:227]
s_add_u32 s24, s24, 262144
s_cmp_eq_u32 s24, s27
s_cselect_b32 s24, s28, s24
s_sub_u32 s6, s6, 1
s_cmp_eq_u32 s6, 0
s_cselect_b64 s[12:13], s[64:65], s[12:13]
M v[224:227], a[100:103], a[180:183], v[224:227]
M v[228:231], a[108:111], a[180:183], v[228:231]
M v[228:231], a[104:107], a[176:179], v[228:231]
M v[232:235], a[112:115], a[176:179], v[232:235]
M v[232:235], a[116:119], a[180:183], v[232:235]
M v[236:239], a[124:127], a[180:183], v[236:239]
M v[236:239], a[120:123], a[176:179], v[236:239]
s_waitcnt vmcnt(8) lgkmcnt(0)
s_barrier
ds_read_b128 a[160:163], v10 offset:0
ds_read_b128 a[164:167], v11 offset:0
M v[240:243], a[128:131], a[176:179], v[240:243]
s_add_u32 m0, s29, 32768
s_nop 0
buffer_load_dwordx4 v2, s[8:11], s23 offen offset:0 lds
M v[240:243], a[132:135], a[180:183], v[240:243]
M v[244:247], a[140:143], a[180:183], v[244:247]
M v[244:247], a[136:139], a[176:179], v[244:247]
M v[248:251], a[144:147], a[176:179], v[248:251]
M v[248:251], a[148:151], a[180:183], v[248:251]
buffer_load_dwordx4 v3, s[8:11], s23 offen offset:1024 lds
M v[252:255], a[156:159], a[180:183], v[252:255]
M v[252:255], a[152:155], a[176:179], v[252:255]
M a[0:3], a[96:99], a[184:187], a[0:3]
M a[0:3], a[100:103], a[188:191], a[0:3]
ds_read_b128 a[168:171], v10 offset:2048
ds_read_b128 a[172:175], v11 offset:2048
M a[4:7], a[108:111], a[188:191], a[4:7]
M a[4:7], a[104:107], a[184:187], a[4:7]
M a[8:11], a[112:115], a[184:187], a[8:11]
buffer_load_dwordx4 v4, s[8:11], s23 offen offset:2048 lds
M a[8:11], a[116:119], a[188:191], a[8:11]
M a[12:15], a[124:127], a[188:191], a[12:15]
M a[12:15], a[120:123], a[184:187], a[12:15]
M a[16:19], a[128:131], a[184:187], a[16:19]
M a[16:19], a[132:135], a[188:191], a[16:19]
buffer_load_dwordx4 v5, s[8:11], s23 offen offset:3072 lds
M a[20:23], a[140:143], a[188:191], a[20:23]
M a[20:23], a[136:139], a[184:187], a[20:23]
M a[24:27], a[144:147], a[184:187], a[24:27]
M a[24:27], a[148:151], a[188:191], a[24:27]
M a[28:31], a[156:159], a[188:191], a[28:31]
M a[28:31], a[152:155], a[184:187], a[28:31]
s_waitcnt lgkmcnt(2)
s_sub_u32 s30, s30, 1
s_cmp_lg_u32 s30, 0
s_cbranch_scc1 Lk1_kl
M v[32:35], a[32:35], a[160:163], v[32:35]
s_add_u32 m0, s29, 65536
s_nop 0
buffer_load_dwordx4 v6, s[12:15], s24 offen offset:0 lds
M v[32:35], a[36:39], a[164:167], v[32:35]
ds_read_b128 a[176:179], v10 offset:4096
ds_read_b128 a[180:183], v11 offset:4096
M v[36:39], a[44:47], a[164:167], v[36:39]
M v[36:39], a[40:43], a[160:163], v[36:39]
ds_read_b64_tr_b16 a[96:97], v12 offset:32768
ds_read_b64_tr_b16 a[98:99], v12 offset:34816
M v[40:43], a[48:51], a[160:163], v[40:43]
M v[40:43], a[52:55], a[164:167], v[40:43]
M v[44:47], a[60:63], a[164:167], v[44:47]
M v[44:47], a[56:59], a[160:163], v[44:47]
ds_read_b64_tr_b16 a[104:105], v13 offset:32768
ds_read_b64_tr_b16 a[106:107], v13 offset:34816
M v[48:51], a[64:67], a[160:163], v[48:51]
buffer_load_dwordx4 v7, s[12:15], s24 offen offset:1024 lds
M v[48:51], a[68:71], a[164:167], v[48:51]
M v[52:55], a[76:79], a[164:167], v[52:55]
M v[52:55], a[72:75], a[160:163], v[52:55]
ds_read_b64_tr_b16 a[112:113], v14 offset:32768
ds_read_b64_tr_b16 a[114:115], v14 offset:34816
M v[56:59], a[80:83], a[160:163], v[56:59]
M v[56:59], a[84:87], a[164:167], v[56:59]
M v[60:63], a[92:95], a[164:167], v[60:63]
buffer_load_dwordx4 v8, s[12:15], s24 offen offset:2048 lds
M v[60:63], a[88:91], a[160:163], v[60:63]
s_waitcnt lgkmcnt(8)
ds_read_b64_tr_b16 a[120:121], v15 offset:32768
ds_read_b64_tr_b16 a[122:123], v15 offset:34816
M v[64:67], a[32:35], a[168:171], v[64:67]
M v[64:67], a[36:39], a[172:175], v[64:67]
ds_read_b128 a[184:187], v10 offset:6144
ds_read_b128 a[188:191], v11 offset:6144
M v[68:71], a[44:47], a[172:175], v[68:71]
M v[68:71], a[40:43], a[168:171], v[68:71]
ds_read_b64_tr_b16 a[128:129], v16 offset:32768
ds_read_b64_tr_b16 a[130:131], v16 offset:34816
M v[72:75], a[48:51], a[168:171], v[72:75]
M v[72:75], a[52:55], a[172:175], v[72:75]
M v[76:79], a[60:63], a[172:175], v[76:79]
M v[76:79], a[56:59], a[168:171], v[76:79]
ds_read_b64_tr_b16 a[136:137], v17 offset:32768
ds_read_b64_tr_b16 a[138:139], v17 offset:34816
M v[80:83], a[64:67], a[168:171], v[80:83]
buffer_load_dwordx4 v9, s[12:15], s24 offen offset:3072 lds
M v[80:83], a[68:71], a[172:175], v[80:83]
M v[84:87], a[76:79], a[172:175], v[84:87]
M v[84:87], a[72:75], a[168:171], v[84:87]
ds_read_b64_tr_b16 a[144:145], v18 offset:32768
ds_read_b64_tr_b16 a[146:147], v18 offset:34816
M v[88:91], a[80:83], a[168:171], v[88:91]
M v[88:91], a[84:87], a[172:175], v[88:91]
M v[92:95], a[92:95], a[172:175], v[92:95]
s_add_u32 s24, s24, 262144
M v[92:95], a[88:91], a[168:171], v[92:95]
s_waitcnt lgkmcnt(15)
ds_read_b64_tr_b16 a[152:153], v19 offset:32768
ds_read_b64_tr_b16 a[154:155], v19 offset:34816
M v[96:99], a[32:35], a[176:179], v[96:99]
M v[96:99], a[36:39], a[180:183], v[96:99]
M v[100:103], a[44:47], a[180:183], v[100:103]
M v[100:103], a[40:43], a[176:179], v[100:103]
M v[104:107], a[48:51], a[176:179], v[104:107]
M v[104:107], a[52:55], a[180:183], v[104:107]
M v[108:111], a[60:63], a[180:183], v[108:111]
M v[108:111], a[56:59], a[176:179], v[108:111]
s_waitcnt vmcnt(8) lgkmcnt(0)
s_barrier
ds_read_b128 a[160:163], v10 offset:16384
ds_read_b128 a[164:167], v11 offset:16384
M v[112:115], a[64:67], a[176:179], v[112:115]
s_add_u32 m0, s29, 49152
s_add_u32 s3, s23, s31
buffer_load_dwordx4 v2, s[8:11], s3 offen offset:0 lds
M v[112:115], a[68:71], a[180:183], v[112:115]
M v[116:119], a[76:79], a[180:183], v[116:119]
M v[116:119], a[72:75], a[176:179], v[116:119]
ds_read_b64_tr_b16 a[100:101], v12 offset:49152
ds_read_b64_tr_b16 a[102:103], v12 offset:51200
M v[120:123], a[80:83], a[176:179], v[120:123]
M v[120:123], a[84:87], a[180:183], v[120:123]
buffer_load_dwordx4 v3, s[8:11], s3 offen offset:1024 lds
M v[124:127], a[92:95], a[180:183], v[124:127]
M v[124:127], a[88:91], a[176:179], v[124:127]
M v[128:131], a[32:35], a[184:187], v[128:131]
M v[128:131], a[36:39], a[188:191], v[128:131]
ds_read_b128 a[168:171], v10 offset:18432
ds_read_b128 a[172:175], v11 offset:18432
ds_read_b64_tr_b16 a[108:109], v13 offset:49152
ds_read_b64_tr_b16 a[110:111], v13 offset:51200
M v[132:135], a[44:47], a[188:191], v[132:135]
M v[132:135], a[40:43], a[184:187], v[132:135]
M v[136:139], a[48:51], a[184:187], v[136:139]
buffer_load_dwordx4 v4, s[8:11], s3 offen offset:2048 lds
M v[136:139], a[52:55], a[188:191], v[136:139]
M v[140:143], a[60:63], a[188:191], v[140:143]
M v[140:143], a[56:59], a[184:187], v[140:143]
ds_read_b64_tr_b16 a[116:117], v14 offset:49152
ds_read_b64_tr_b16 a[118:119], v14 offset:51200
M v[144:147], a[64:67], a[184:187], v[144:147]
M v[144:147], a[68:71], a[188:191], v[144:147]
M v[148:151], a[76:79], a[188:191], v[148:151]
buffer_load_dwordx4 v5, s[8:11], s3 offen offset:3072 lds
M v[148:151], a[72:75], a[184:187], v[148:151]
M v[152:155], a[80:83], a[184:187], v[152:155]
s_lshr_b32 s95, s53, 7
s_add_u32 s95, s95, s22
M v[152:155], a[84:87], a[188:191], v[152:155]
ds_read_b64_tr_b16 a[124:125], v15 offset:49152
ds_read_b64_tr_b16 a[126:127], v15 offset:51200
s_lshl_b32 s95, s95, 5
s_lshr_b32 s19, s52, 6
M v[156:159], a[92:95], a[188:191], v[156:159]
s_add_u32 s95, s95, s19
s_lshl_b32 s19, s21, 1
M v[156:159], a[88:91], a[184:187], v[156:159]
s_waitcnt lgkmcnt(10)
s_add_u32 s95, s95, s19
s_lshl_b32 s92, s95, 15
M v[160:163], a[32:35], a[160:163], v[160:163]
s_add_u32 s93, s92, 32768
s_add_u32 s16, s50, 16777216
M v[160:163], a[36:39], a[164:167], v[160:163]
ds_read_b128 a[176:179], v10 offset:20480
ds_read_b128 a[180:183], v11 offset:20480
s_addc_u32 s17, s51, 0
s_mov_b32 s18, 33554432
M v[164:167], a[44:47], a[164:167], v[164:167]
s_add_u32 s23, s23, 128
s_cmp_eq_u32 s23, s25
s_cselect_b32 s23, s26, s23
s_mov_b32 s19, 0x00020000
M v[164:167], a[40:43], a[160:163], v[164:167]
ds_read_b64_tr_b16 a[132:133], v16 offset:49152
ds_read_b64_tr_b16 a[134:135], v16 offset:51200
M v[168:171], a[48:51], a[160:163], v[168:171]
M v[168:171], a[52:55], a[164:167], v[168:171]
M v[172:175], a[60:63], a[164:167], v[172:175]
M v[172:175], a[56:59], a[160:163], v[172:175]
M v[176:179], a[64:67], a[160:163], v[176:179]
s_add_u32 m0, s29, 81920
s_nop 0
buffer_load_dwordx4 v6, s[12:15], s24 offen offset:0 lds
M v[176:179], a[68:71], a[164:167], v[176:179]
ds_read_b64_tr_b16 a[140:141], v17 offset:49152
ds_read_b64_tr_b16 a[142:143], v17 offset:51200
M v[180:183], a[76:79], a[164:167], v[180:183]
M v[180:183], a[72:75], a[160:163], v[180:183]
M v[184:187], a[80:83], a[160:163], v[184:187]
M v[184:187], a[84:87], a[164:167], v[184:187]
buffer_load_dwordx4 v7, s[12:15], s24 offen offset:1024 lds
M v[188:191], a[92:95], a[164:167], v[188:191]
M v[188:191], a[88:91], a[160:163], v[188:191]
s_waitcnt lgkmcnt(12)
ds_read_b64_tr_b16 a[148:149], v18 offset:49152
ds_read_b64_tr_b16 a[150:151], v18 offset:51200
M v[192:195], a[32:35], a[168:171], v[192:195]
M v[192:195], a[36:39], a[172:175], v[192:195]
ds_read_b128 a[184:187], v10 offset:22528
ds_read_b128 a[188:191], v11 offset:22528
M v[196:199], a[44:47], a[172:175], v[196:199]
M v[196:199], a[40:43], a[168:171], v[196:199]
M v[200:203], a[48:51], a[168:171], v[200:203]
buffer_load_dwordx4 v8, s[12:15], s24 offen offset:2048 lds
M v[200:203], a[52:55], a[172:175], v[200:203]
ds_read_b64_tr_b16 a[156:157], v19 offset:49152
ds_read_b64_tr_b16 a[158:159], v19 offset:51200
M v[204:207], a[60:63], a[172:175], v[204:207]
M v[204:207], a[56:59], a[168:171], v[204:207]
M v[208:211], a[64:67], a[168:171], v[208:211]
M v[208:211], a[68:71], a[172:175], v[208:211]
M v[212:215], a[76:79], a[172:175], v[212:215]
buffer_load_dwordx4 v9, s[12:15], s24 offen offset:3072 lds
M v[212:215], a[72:75], a[168:171], v[212:215]
M v[216:219], a[80:83], a[168:171], v[216:219]
M v[216:219], a[84:87], a[172:175], v[216:219]
M v[220:223], a[92:95], a[172:175], v[220:223]
M v[220:223], a[88:91], a[168:171], v[220:223]
s_waitcnt lgkmcnt(10)
M v[224:227], a[32:35], a[176:179], v[224:227]
s_add_u32 s24, s24, 262144
s_cmp_eq_u32 s24, s27
s_cselect_b32 s24, s28, s24
s_sub_u32 s6, s6, 1
s_cmp_eq_u32 s6, 0
s_cselect_b64 s[12:13], s[64:65], s[12:13]
M v[224:227], a[36:39], a[180:183], v[224:227]
M v[228:231], a[44:47], a[180:183], v[228:231]
M v[228:231], a[40:43], a[176:179], v[228:231]
M v[232:235], a[48:51], a[176:179], v[232:235]
M v[232:235], a[52:55], a[180:183], v[232:235]
M v[236:239], a[60:63], a[180:183], v[236:239]
M v[236:239], a[56:59], a[176:179], v[236:239]
s_waitcnt vmcnt(8) lgkmcnt(0)
s_barrier
ds_read_b128 a[160:163], v10 offset:32768
ds_read_b128 a[164:167], v11 offset:32768
M v[240:243], a[64:67], a[176:179], v[240:243]
s_add_u32 m0, s29, 0
s_nop 0
buffer_load_dwordx4 v2, s[8:11], s23 offen offset:0 lds
M v[240:243], a[68:71], a[180:183], v[240:243]
M v[244:247], a[76:79], a[180:183], v[244:247]
M v[244:247], a[72:75], a[176:179], v[244:247]
M v[248:251], a[80:83], a[176:179], v[248:251]
M v[248:251], a[84:87], a[180:183], v[248:251]
buffer_load_dwordx4 v3, s[8:11], s23 offen offset:1024 lds
M v[252:255], a[92:95], a[180:183], v[252:255]
M v[252:255], a[88:91], a[176:179], v[252:255]
M a[0:3], a[32:35], a[184:187], a[0:3]
M a[0:3], a[36:39], a[188:191], a[0:3]
ds_read_b128 a[168:171], v10 offset:34816
ds_read_b128 a[172:175], v11 offset:34816
M a[4:7], a[44:47], a[188:191], a[4:7]
M a[4:7], a[40:43], a[184:187], a[4:7]
M a[8:11], a[48:51], a[184:187], a[8:11]
buffer_load_dwordx4 v4, s[8:11], s23 offen offset:2048 lds
M a[8:11], a[52:55], a[188:191], a[8:11]
M a[12:15], a[60:63], a[188:191], a[12:15]
M a[12:15], a[56:59], a[184:187], a[12:15]
M a[16:19], a[64:67], a[184:187], a[16:19]
M a[16:19], a[68:71], a[188:191], a[16:19]
buffer_load_dwordx4 v5, s[8:11], s23 offen offset:3072 lds
M a[20:23], a[76:79], a[188:191], a[20:23]
M a[20:23], a[72:75], a[184:187], a[20:23]
M a[24:27], a[80:83], a[184:187], a[24:27]
M a[24:27], a[84:87], a[188:191], a[24:27]
M a[28:31], a[92:95], a[188:191], a[28:31]
M a[28:31], a[88:91], a[184:187], a[28:31]
s_waitcnt lgkmcnt(2)
M v[32:35], a[96:99], a[160:163], v[32:35]
s_add_u32 m0, s29, 98304
s_nop 0
buffer_load_dwordx4 v6, s[12:15], s24 offen offset:0 lds
M v[32:35], a[100:103], a[164:167], v[32:35]
ds_read_b128 a[176:179], v10 offset:36864
ds_read_b128 a[180:183], v11 offset:36864
M v[36:39], a[108:111], a[164:167], v[36:39]
M v[36:39], a[104:107], a[160:163], v[36:39]
ds_read_b64_tr_b16 a[32:33], v12 offset:0
ds_read_b64_tr_b16 a[34:35], v12 offset:2048
M v[40:43], a[112:115], a[160:163], v[40:43]
M v[40:43], a[116:119], a[164:167], v[40:43]
M v[44:47], a[124:127], a[164:167], v[44:47]
M v[44:47], a[120:123], a[160:163], v[44:47]
ds_read_b64_tr_b16 a[40:41], v13 offset:0
ds_read_b64_tr_b16 a[42:43], v13 offset:2048
M v[48:51], a[128:131], a[160:163], v[48:51]
buffer_load_dwordx4 v7, s[12:15], s24 offen offset:1024 lds
M v[48:51], a[132:135], a[164:167], v[48:51]
M v[52:55], a[140:143], a[164:167], v[52:55]
M v[52:55], a[136:139], a[160:163], v[52:55]
ds_read_b64_tr_b16 a[48:49], v14 offset:0
ds_read_b64_tr_b16 a[50:51], v14 offset:2048
M v[56:59], a[144:147], a[160:163], v[56:59]
M v[56:59], a[148:151], a[164:167], v[56:59]
M v[60:63], a[156:159], a[164:167], v[60:63]
buffer_load_dwordx4 v8, s[12:15], s24 offen offset:2048 lds
M v[60:63], a[152:155], a[160:163], v[60:63]
s_waitcnt lgkmcnt(8)
ds_read_b64_tr_b16 a[56:57], v15 offset:0
ds_read_b64_tr_b16 a[58:59], v15 offset:2048
M v[64:67], a[96:99], a[168:171], v[64:67]
M v[64:67], a[100:103], a[172:175], v[64:67]
ds_read_b128 a[184:187], v10 offset:38912
ds_read_b128 a[188:191], v11 offset:38912
M v[68:71], a[108:111], a[172:175], v[68:71]
M v[68:71], a[104:107], a[168:171], v[68:71]
ds_read_b64_tr_b16 a[64:65], v16 offset:0
ds_read_b64_tr_b16 a[66:67], v16 offset:2048
v_cvt_pk_bf16_f32 v32, v32, v33
v_cvt_pk_bf16_f32 v33, v34, v35
M v[72:75], a[112:115], a[168:171], v[72:75]
v_cvt_pk_bf16_f32 v34, v36, v37
v_cvt_pk_bf16_f32 v35, v38, v39
M v[72:75], a[116:119], a[172:175], v[72:75]
v_cvt_pk_bf16_f32 v40, v40, v41
v_cvt_pk_bf16_f32 v41, v42, v43
M v[76:79], a[124:127], a[172:175], v[76:79]
buffer_load_dwordx4 v9, s[12:15], s24 offen offset:3072 lds
v_cvt_pk_bf16_f32 v42, v44, v45
v_cvt_pk_bf16_f32 v43, v46, v47
M v[76:79], a[120:123], a[168:171], v[76:79]
ds_read_b64_tr_b16 a[72:73], v17 offset:0
ds_read_b64_tr_b16 a[74:75], v17 offset:2048
v_cvt_pk_bf16_f32 v48, v48, v49
v_cvt_pk_bf16_f32 v49, v50, v51
M v[80:83], a[128:131], a[168:171], v[80:83]
v_cvt_pk_bf16_f32 v50, v52, v53
v_cvt_pk_bf16_f32 v51, v54, v55
M v[80:83], a[132:135], a[172:175], v[80:83]
v_cvt_pk_bf16_f32 v56, v56, v57
v_cvt_pk_bf16_f32 v57, v58, v59
M v[84:87], a[140:143], a[172:175], v[84:87]
v_cvt_pk_bf16_f32 v58, v60, v61
v_cvt_pk_bf16_f32 v59, v62, v63
M v[84:87], a[136:139], a[168:171], v[84:87]
ds_read_b64_tr_b16 a[80:81], v18 offset:0
ds_read_b64_tr_b16 a[82:83], v18 offset:2048
M v[88:91], a[144:147], a[168:171], v[88:91]
M v[88:91], a[148:151], a[172:175], v[88:91]
s_add_u32 s24, s24, 262144
M v[92:95], a[156:159], a[172:175], v[92:95]
s_add_u32 s94, s92, 0
buffer_store_dwordx4 v[32:35], v1, s[16:19], s94 offen offset:0 sc1
M v[92:95], a[152:155], a[168:171], v[92:95]
s_waitcnt lgkmcnt(15)
ds_read_b64_tr_b16 a[88:89], v19 offset:0
ds_read_b64_tr_b16 a[90:91], v19 offset:2048
M v[96:99], a[96:99], a[176:179], v[96:99]
M v[96:99], a[100:103], a[180:183], v[96:99]
M v[100:103], a[108:111], a[180:183], v[100:103]
M v[100:103], a[104:107], a[176:179], v[100:103]
v_cvt_pk_bf16_f32 v64, v64, v65
v_cvt_pk_bf16_f32 v65, v66, v67
M v[104:107], a[112:115], a[176:179], v[104:107]
v_cvt_pk_bf16_f32 v66, v68, v69
v_cvt_pk_bf16_f32 v67, v70, v71
M v[104:107], a[116:119], a[180:183], v[104:107]
v_cvt_pk_bf16_f32 v72, v72, v73
v_cvt_pk_bf16_f32 v73, v74, v75
M v[108:111], a[124:127], a[180:183], v[108:111]
v_cvt_pk_bf16_f32 v74, v76, v77
v_cvt_pk_bf16_f32 v75, v78, v79
M v[108:111], a[120:123], a[176:179], v[108:111]
s_waitcnt vmcnt(9) lgkmcnt(0)
s_barrier
ds_read_b128 a[160:163], v10 offset:49152
ds_read_b128 a[164:167], v11 offset:49152
v_cvt_pk_bf16_f32 v80, v80, v81
v_cvt_pk_bf16_f32 v81, v82, v83
M v[112:115], a[128:131], a[176:179], v[112:115]
s_add_u32 s94, s92, 0
buffer_store_dwordx4 v[40:43], v1, s[16:19], s94 offen offset:1024 sc1
v_cvt_pk_bf16_f32 v82, v84, v85
v_cvt_pk_bf16_f32 v83, v86, v87
M v[112:115], a[132:135], a[180:183], v[112:115]
s_add_u32 m0, s29, 16384
s_add_u32 s3, s23, s31
buffer_load_dwordx4 v2, s[8:11], s3 offen offset:0 lds
v_cvt_pk_bf16_f32 v88, v88, v89
v_cvt_pk_bf16_f32 v89, v90, v91
M v[116:119], a[140:143], a[180:183], v[116:119]
v_cvt_pk_bf16_f32 v90, v92, v93
v_cvt_pk_bf16_f32 v91, v94, v95
M v[116:119], a[136:139], a[176:179], v[116:119]
ds_read_b64_tr_b16 a[36:37], v12 offset:16384
ds_read_b64_tr_b16 a[38:39], v12 offset:18432
M v[120:123], a[144:147], a[176:179], v[120:123]
M v[120:123], a[148:151], a[180:183], v[120:123]
M v[124:127], a[156:159], a[180:183], v[124:127]
buffer_load_dwordx4 v3, s[8:11], s3 offen offset:1024 lds
M v[124:127], a[152:155], a[176:179], v[124:127]
M v[128:131], a[96:99], a[184:187], v[128:131]
M v[128:131], a[100:103], a[188:191], v[128:131]
ds_read_b128 a[168:171], v10 offset:51200
ds_read_b128 a[172:175], v11 offset:51200
ds_read_b64_tr_b16 a[44:45], v13 offset:16384
ds_read_b64_tr_b16 a[46:47], v13 offset:18432
M v[132:135], a[108:111], a[188:191], v[132:135]
M v[132:135], a[104:107], a[184:187], v[132:135]
s_add_u32 s94, s92, 0
buffer_store_dwordx4 v[48:51], v1, s[16:19], s94 offen offset:2048 sc1
v_cvt_pk_bf16_f32 v96, v96, v97
v_cvt_pk_bf16_f32 v97, v98, v99
M v[136:139], a[112:115], a[184:187], v[136:139]
v_cvt_pk_bf16_f32 v98, v100, v101
v_cvt_pk_bf16_f32 v99, v102, v103
M v[136:139], a[116:119], a[188:191], v[136:139]
buffer_load_dwordx4 v4, s[8:11], s3 offen offset:2048 lds
v_cvt_pk_bf16_f32 v104, v104, v105
v_cvt_pk_bf16_f32 v105, v106, v107
M v[140:143], a[124:127], a[188:191], v[140:143]
v_cvt_pk_bf16_f32 v106, v108, v109
v_cvt_pk_bf16_f32 v107, v110, v111
M v[140:143], a[120:123], a[184:187], v[140:143]
ds_read_b64_tr_b16 a[52:53], v14 offset:16384
ds_read_b64_tr_b16 a[54:55], v14 offset:18432
v_cvt_pk_bf16_f32 v112, v112, v113
v_cvt_pk_bf16_f32 v113, v114, v115
M v[144:147], a[128:131], a[184:187], v[144:147]
v_cvt_pk_bf16_f32 v114, v116, v117
v_cvt_pk_bf16_f32 v115, v118, v119
M v[144:147], a[132:135], a[188:191], v[144:147]
v_cvt_pk_bf16_f32 v120, v120, v121
v_cvt_pk_bf16_f32 v121, v122, v123
M v[148:151], a[140:143], a[188:191], v[148:151]
buffer_load_dwordx4 v5, s[8:11], s3 offen offset:3072 lds
v_cvt_pk_bf16_f32 v122, v124, v125
v_cvt_pk_bf16_f32 v123, v126, v127
M v[148:151], a[136:139], a[184:187], v[148:151]
M v[152:155], a[144:147], a[184:187], v[152:155]
M v[152:155], a[148:151], a[188:191], v[152:155]
ds_read_b64_tr_b16 a[60:61], v15 offset:16384
ds_read_b64_tr_b16 a[62:63], v15 offset:18432
M v[156:159], a[156:159], a[188:191], v[156:159]
s_add_u32 s94, s92, 0
buffer_store_dwordx4 v[56:59], v1, s[16:19], s94 offen offset:3072 sc1
M v[156:159], a[152:155], a[184:187], v[156:159]
s_waitcnt lgkmcnt(10)
M v[160:163], a[96:99], a[160:163], v[160:163]
M v[160:163], a[100:103], a[164:167], v[160:163]
ds_read_b128 a[176:179], v10 offset:53248
ds_read_b128 a[180:183], v11 offset:53248
M v[164:167], a[108:111], a[164:167], v[164:167]
s_add_u32 s23, s23, 128
s_cmp_eq_u32 s23, s25
s_cselect_b32 s23, s26, s23
M v[164:167], a[104:107], a[160:163], v[164:167]
ds_read_b64_tr_b16 a[68:69], v16 offset:16384
ds_read_b64_tr_b16 a[70:71], v16 offset:18432
v_cvt_pk_bf16_f32 v128, v128, v129
v_cvt_pk_bf16_f32 v129, v130, v131
M v[168:171], a[112:115], a[160:163], v[168:171]
v_cvt_pk_bf16_f32 v130, v132, v133
v_cvt_pk_bf16_f32 v131, v134, v135
M v[168:171], a[116:119], a[164:167], v[168:171]
v_cvt_pk_bf16_f32 v136, v136, v137
v_cvt_pk_bf16_f32 v137, v138, v139
M v[172:175], a[124:127], a[164:167], v[172:175]
v_cvt_pk_bf16_f32 v138, v140, v141
v_cvt_pk_bf16_f32 v139, v142, v143
M v[172:175], a[120:123], a[160:163], v[172:175]
v_cvt_pk_bf16_f32 v144, v144, v145
v_cvt_pk_bf16_f32 v145, v146, v147
M v[176:179], a[128:131], a[160:163], v[176:179]
s_add_u32 s94, s92, 4096
buffer_store_dwordx4 v[64:67], v1, s[16:19], s94 offen offset:0 sc1
v_cvt_pk_bf16_f32 v146, v148, v149
v_cvt_pk_bf16_f32 v147, v150, v151
M v[176:179], a[132:135], a[164:167], v[176:179]
ds_read_b64_tr_b16 a[76:77], v17 offset:16384
ds_read_b64_tr_b16 a[78:79], v17 offset:18432
v_cvt_pk_bf16_f32 v152, v152, v153
v_cvt_pk_bf16_f32 v153, v154, v155
M v[180:183], a[140:143], a[164:167], v[180:183]
s_add_u32 m0, s29, 114688
s_nop 0
buffer_load_dwordx4 v6, s[12:15], s24 offen offset:0 lds
v_cvt_pk_bf16_f32 v154, v156, v157
v_cvt_pk_bf16_f32 v155, v158, v159
M v[180:183], a[136:139], a[160:163], v[180:183]
M v[184:187], a[144:147], a[160:163], v[184:187]
v_accvgpr_write_b32 a192, v128
v_accvgpr_write_b32 a193, v129
v_accvgpr_write_b32 a194, v130
v_accvgpr_write_b32 a195, v131
M v[184:187], a[148:151], a[164:167], v[184:187]
v_accvgpr_write_b32 a196, v136
v_accvgpr_write_b32 a197, v137
v_accvgpr_write_b32 a198, v138
v_accvgpr_write_b32 a199, v139
M v[188:191], a[156:159], a[164:167], v[188:191]
buffer_load_dwordx4 v7, s[12:15], s24 offen offset:1024 lds
v_accvgpr_write_b32 a200, v144
v_accvgpr_write_b32 a201, v145
v_accvgpr_write_b32 a202, v146
v_accvgpr_write_b32 a203, v147
M v[188:191], a[152:155], a[160:163], v[188:191]
s_waitcnt lgkmcnt(12)
ds_read_b64_tr_b16 a[84:85], v18 offset:16384
ds_read_b64_tr_b16 a[86:87], v18 offset:18432
v_accvgpr_write_b32 a204, v152
v_accvgpr_write_b32 a205, v153
v_accvgpr_write_b32 a206, v154
v_accvgpr_write_b32 a207, v155
M v[192:195], a[96:99], a[168:171], v[192:195]
M v[192:195], a[100:103], a[172:175], v[192:195]
ds_read_b128 a[184:187], v10 offset:55296
ds_read_b128 a[188:191], v11 offset:55296
M v[196:199], a[108:111], a[172:175], v[196:199]
s_add_u32 s94, s92, 4096
buffer_store_dwordx4 v[72:75], v1, s[16:19], s94 offen offset:1024 sc1
M v[196:199], a[104:107], a[168:171], v[196:199]
v_cvt_pk_bf16_f32 v160, v160, v161
v_cvt_pk_bf16_f32 v161, v162, v163
M v[200:203], a[112:115], a[168:171], v[200:203]
v_cvt_pk_bf16_f32 v162, v164, v165
v_cvt_pk_bf16_f32 v163, v166, v167
M v[200:203], a[116:119], a[172:175], v[200:203]
ds_read_b64_tr_b16 a[92:93], v19 offset:16384
ds_read_b64_tr_b16 a[94:95], v19 offset:18432
v_cvt_pk_bf16_f32 v168, v168, v169
v_cvt_pk_bf16_f32 v169, v170, v171
M v[204:207], a[124:127], a[172:175], v[204:207]
buffer_load_dwordx4 v8, s[12:15], s24 offen offset:2048 lds
v_cvt_pk_bf16_f32 v170, v172, v173
v_cvt_pk_bf16_f32 v171, v174, v175
M v[204:207], a[120:123], a[168:171], v[204:207]
v_cvt_pk_bf16_f32 v176, v176, v177
v_cvt_pk_bf16_f32 v177, v178, v179
M v[208:211], a[128:131], a[168:171], v[208:211]
v_cvt_pk_bf16_f32 v178, v180, v181
v_cvt_pk_bf16_f32 v179, v182, v183
M v[208:211], a[132:135], a[172:175], v[208:211]
v_cvt_pk_bf16_f32 v184, v184, v185
v_cvt_pk_bf16_f32 v185, v186, v187
M v[212:215], a[140:143], a[172:175], v[212:215]
buffer_load_dwordx4 v9, s[12:15], s24 offen offset:3072 lds
v_cvt_pk_bf16_f32 v186, v188, v189
v_cvt_pk_bf16_f32 v187, v190, v191
M v[212:215], a[136:139], a[168:171], v[212:215]
M v[216:219], a[144:147], a[168:171], v[216:219]
v_accvgpr_write_b32 a208, v160
v_accvgpr_write_b32 a209, v161
v_accvgpr_write_b32 a210, v162
v_accvgpr_write_b32 a211, v163
M v[216:219], a[148:151], a[172:175], v[216:219]
s_add_u32 s94, s92, 4096
buffer_store_dwordx4 v[80:83], v1, s[16:19], s94 offen offset:2048 sc1
v_accvgpr_write_b32 a212, v168
v_accvgpr_write_b32 a213, v169
v_accvgpr_write_b32 a214, v170
v_accvgpr_write_b32 a215, v171
M v[220:223], a[156:159], a[172:175], v[220:223]
v_accvgpr_write_b32 a216, v176
v_accvgpr_write_b32 a217, v177
v_accvgpr_write_b32 a218, v178
v_accvgpr_write_b32 a219, v179
M v[220:223], a[152:155], a[168:171], v[220:223]
s_waitcnt lgkmcnt(10)
v_accvgpr_write_b32 a220, v184
v_accvgpr_write_b32 a221, v185
v_accvgpr_write_b32 a222, v186
v_accvgpr_write_b32 a223, v187
M v[224:227], a[96:99], a[176:179], v[224:227]
s_add_u32 s24, s24, 262144
s_cmp_eq_u32 s24, s27
s_cselect_b32 s24, s28, s24
s_sub_u32 s6, s6, 1
s_cmp_eq_u32 s6, 0
s_cselect_b64 s[12:13], s[64:65], s[12:13]
M v[224:227], a[100:103], a[180:183], v[224:227]
M v[228:231], a[108:111], a[180:183], v[228:231]
M v[228:231], a[104:107], a[176:179], v[228:231]
v_cvt_pk_bf16_f32 v192, v192, v193
v_cvt_pk_bf16_f32 v193, v194, v195
M v[232:235], a[112:115], a[176:179], v[232:235]
v_cvt_pk_bf16_f32 v194, v196, v197
v_cvt_pk_bf16_f32 v195, v198, v199
M v[232:235], a[116:119], a[180:183], v[232:235]
v_cvt_pk_bf16_f32 v200, v200, v201
v_cvt_pk_bf16_f32 v201, v202, v203
M v[236:239], a[124:127], a[180:183], v[236:239]
v_cvt_pk_bf16_f32 v202, v204, v205
v_cvt_pk_bf16_f32 v203, v206, v207
M v[236:239], a[120:123], a[176:179], v[236:239]
s_waitcnt vmcnt(15) lgkmcnt(0)
s_barrier
ds_read_b128 a[160:163], v10 offset:0
ds_read_b128 a[164:167], v11 offset:0
v_cvt_pk_bf16_f32 v208, v208, v209
v_cvt_pk_bf16_f32 v209, v210, v211
M v[240:243], a[128:131], a[176:179], v[240:243]
s_add_u32 s94, s92, 4096
buffer_store_dwordx4 v[88:91], v1, s[16:19], s94 offen offset:3072 sc1
v_cvt_pk_bf16_f32 v210, v212, v213
v_cvt_pk_bf16_f32 v211, v214, v215
M v[240:243], a[132:135], a[180:183], v[240:243]
s_add_u32 m0, s29, 32768
s_nop 0
buffer_load_dwordx4 v2, s[8:11], s23 offen offset:0 lds
v_cvt_pk_bf16_f32 v216, v216, v217
v_cvt_pk_bf16_f32 v217, v218, v219
M v[244:247], a[140:143], a[180:183], v[244:247]
v_cvt_pk_bf16_f32 v218, v220, v221
v_cvt_pk_bf16_f32 v219, v222, v223
M v[244:247], a[136:139], a[176:179], v[244:247]
M v[248:251], a[144:147], a[176:179], v[248:251]
v_accvgpr_write_b32 a224, v192
v_accvgpr_write_b32 a225, v193
v_accvgpr_write_b32 a226, v194
v_accvgpr_write_b32 a227, v195
M v[248:251], a[148:151], a[180:183], v[248:251]
buffer_load_dwordx4 v3, s[8:11], s23 offen offset:1024 lds
v_accvgpr_write_b32 a228, v200
v_accvgpr_write_b32 a229, v201
v_accvgpr_write_b32 a230, v202
v_accvgpr_write_b32 a231, v203
M v[252:255], a[156:159], a[180:183], v[252:255]
v_accvgpr_write_b32 a232, v208
v_accvgpr_write_b32 a233, v209
v_accvgpr_write_b32 a234, v210
v_accvgpr_write_b32 a235, v211
M v[252:255], a[152:155], a[176:179], v[252:255]
v_accvgpr_write_b32 a236, v216
v_accvgpr_write_b32 a237, v217
v_accvgpr_write_b32 a238, v218
v_accvgpr_write_b32 a239, v219
M a[0:3], a[96:99], a[184:187], a[0:3]
M a[0:3], a[100:103], a[188:191], a[0:3]
ds_read_b128 a[168:171], v10 offset:2048
ds_read_b128 a[172:175], v11 offset:2048
M a[4:7], a[108:111], a[188:191], a[4:7]
s_add_u32 s94, s92, 8192
buffer_store_dwordx4 v[96:99], v1, s[16:19], s94 offen offset:0 sc1
M a[4:7], a[104:107], a[184:187], a[4:7]
v_cvt_pk_bf16_f32 v224, v224, v225
v_cvt_pk_bf16_f32 v225, v226, v227
M a[8:11], a[112:115], a[184:187], a[8:11]
v_cvt_pk_bf16_f32 v226, v228, v229
v_cvt_pk_bf16_f32 v227, v230, v231
M a[8:11], a[116:119], a[188:191], a[8:11]
buffer_load_dwordx4 v4, s[8:11], s23 offen offset:2048 lds
v_cvt_pk_bf16_f32 v232, v232, v233
v_cvt_pk_bf16_f32 v233, v234, v235
M a[12:15], a[124:127], a[188:191], a[12:15]
v_cvt_pk_bf16_f32 v234, v236, v237
v_cvt_pk_bf16_f32 v235, v238, v239
M a[12:15], a[120:123], a[184:187], a[12:15]
v_cvt_pk_bf16_f32 v240, v240, v241
v_cvt_pk_bf16_f32 v241, v242, v243
M a[16:19], a[128:131], a[184:187], a[16:19]
v_cvt_pk_bf16_f32 v242, v244, v245
v_cvt_pk_bf16_f32 v243, v246, v247
M a[16:19], a[132:135], a[188:191], a[16:19]
buffer_load_dwordx4 v5, s[8:11], s23 offen offset:3072 lds
v_cvt_pk_bf16_f32 v248, v248, v249
v_cvt_pk_bf16_f32 v249, v250, v251
M a[20:23], a[140:143], a[188:191], a[20:23]
v_cvt_pk_bf16_f32 v250, v252, v253
v_cvt_pk_bf16_f32 v251, v254, v255
M a[20:23], a[136:139], a[184:187], a[20:23]
M a[24:27], a[144:147], a[184:187], a[24:27]
s_add_u32 s94, s92, 8192
buffer_store_dwordx4 v[104:107], v1, s[16:19], s94 offen offset:1024 sc1
v_accvgpr_write_b32 a240, v224
v_accvgpr_write_b32 a241, v225
v_accvgpr_write_b32 a242, v226
v_accvgpr_write_b32 a243, v227
M a[24:27], a[148:151], a[188:191], a[24:27]
v_accvgpr_write_b32 a244, v232
v_accvgpr_write_b32 a245, v233
v_accvgpr_write_b32 a246, v234
v_accvgpr_write_b32 a247, v235
M a[28:31], a[156:159], a[188:191], a[28:31]
v_accvgpr_write_b32 a248, v240
v_accvgpr_write_b32 a249, v241
v_accvgpr_write_b32 a250, v242
v_accvgpr_write_b32 a251, v243
M a[28:31], a[152:155], a[184:187], a[28:31]
s_waitcnt lgkmcnt(2)
v_accvgpr_write_b32 a252, v248
v_accvgpr_write_b32 a253, v249
v_accvgpr_write_b32 a254, v250
v_accvgpr_write_b32 a255, v251
M v[32:35], a[160:163], a[32:35], 0
s_add_u32 m0, s29, 65536
s_nop 0
buffer_load_dwordx4 v6, s[12:15], s24 offen offset:0 lds
M v[32:35], a[164:167], a[36:39], v[32:35]
ds_read_b128 a[176:179], v10 offset:4096
ds_read_b128 a[180:183], v11 offset:4096
M v[36:39], a[164:167], a[44:47], 0
M v[36:39], a[160:163], a[40:43], v[36:39]
ds_read_b64_tr_b16 a[96:97], v12 offset:32768
ds_read_b64_tr_b16 a[98:99], v12 offset:34816
M v[40:43], a[160:163], a[48:51], 0
M v[40:43], a[164:167], a[52:55], v[40:43]
M v[44:47], a[164:167], a[60:63], 0
buffer_load_dwordx4 v7, s[12:15], s24 offen offset:1024 lds
M v[44:47], a[160:163], a[56:59], v[44:47]
ds_read_b64_tr_b16 a[104:105], v13 offset:32768
ds_read_b64_tr_b16 a[106:107], v13 offset:34816
M v[48:51], a[160:163], a[64:67], 0
s_add_u32 s94, s92, 8192
buffer_store_dwordx4 v[112:115], v1, s[16:19], s94 offen offset:2048 sc1
M v[48:51], a[164:167], a[68:71], v[48:51]
M v[52:55], a[164:167], a[76:79], 0
M v[52:55], a[160:163], a[72:75], v[52:55]
ds_read_b64_tr_b16 a[112:113], v14 offset:32768
ds_read_b64_tr_b16 a[114:115], v14 offset:34816
M v[56:59], a[160:163], a[80:83], 0
M v[56:59], a[164:167], a[84:87], v[56:59]
M v[60:63], a[164:167], a[92:95], 0
buffer_load_dwordx4 v8, s[12:15], s24 offen offset:2048 lds
M v[60:63], a[160:163], a[88:91], v[60:63]
s_waitcnt lgkmcnt(8)
ds_read_b64_tr_b16 a[120:121], v15 offset:32768
ds_read_b64_tr_b16 a[122:123], v15 offset:34816
M v[64:67], a[168:171], a[32:35], 0
M v[64:67], a[172:175], a[36:39], v[64:67]
ds_read_b128 a[184:187], v10 offset:6144
ds_read_b128 a[188:191], v11 offset:6144
M v[68:71], a[172:175], a[44:47], 0
s_add_u32 s94, s92, 8192
buffer_store_dwordx4 v[120:123], v1, s[16:19], s94 offen offset:3072 sc1
M v[68:71], a[168:171], a[40:43], v[68:71]
ds_read_b64_tr_b16 a[128:129], v16 offset:32768
ds_read_b64_tr_b16 a[130:131], v16 offset:34816
M v[72:75], a[168:171], a[48:51], 0
v_accvgpr_read_b32 v24, a0
v_accvgpr_read_b32 v25, a1
M v[72:75], a[172:175], a[52:55], v[72:75]
v_accvgpr_read_b32 v26, a2
v_accvgpr_read_b32 v27, a3
M v[76:79], a[172:175], a[60:63], 0
v_accvgpr_read_b32 v28, a4
v_accvgpr_read_b32 v29, a5
M v[76:79], a[168:171], a[56:59], v[76:79]
ds_read_b64_tr_b16 a[136:137], v17 offset:32768
ds_read_b64_tr_b16 a[138:139], v17 offset:34816
v_accvgpr_read_b32 v30, a6
v_accvgpr_read_b32 v31, a7
M v[80:83], a[168:171], a[64:67], 0
buffer_load_dwordx4 v9, s[12:15], s24 offen offset:3072 lds
v_cvt_pk_bf16_f32 v24, v24, v25
v_cvt_pk_bf16_f32 v25, v26, v27
M v[80:83], a[172:175], a[68:71], v[80:83]
v_cvt_pk_bf16_f32 v26, v28, v29
v_cvt_pk_bf16_f32 v27, v30, v31
M v[84:87], a[172:175], a[76:79], 0
M v[84:87], a[168:171], a[72:75], v[84:87]
ds_read_b64_tr_b16 a[144:145], v18 offset:32768
ds_read_b64_tr_b16 a[146:147], v18 offset:34816
M v[88:91], a[168:171], a[80:83], 0
M v[88:91], a[172:175], a[84:87], v[88:91]
s_add_u32 s94, s93, 12288
buffer_store_dwordx4 v[24:27], v1, s[16:19], s94 offen offset:0 sc1
M v[92:95], a[172:175], a[92:95], 0
M v[92:95], a[168:171], a[88:91], v[92:95]
s_waitcnt lgkmcnt(15)
ds_read_b64_tr_b16 a[152:153], v19 offset:32768
ds_read_b64_tr_b16 a[154:155], v19 offset:34816
M v[96:99], a[176:179], a[32:35], 0
s_add_u32 s24, s24, 262144
M v[96:99], a[180:183], a[36:39], v[96:99]
M v[100:103], a[180:183], a[44:47], 0
M v[100:103], a[176:179], a[40:43], v[100:103]
M v[104:107], a[176:179], a[48:51], 0
M v[104:107], a[180:183], a[52:55], v[104:107]
M v[108:111], a[180:183], a[60:63], 0
M v[108:111], a[176:179], a[56:59], v[108:111]
s_waitcnt vmcnt(15) lgkmcnt(0)
s_barrier
ds_read_b128 a[160:163], v10 offset:16384
ds_read_b128 a[164:167], v11 offset:16384
M v[112:115], a[176:179], a[64:67], 0
s_add_u32 m0, s29, 49152
s_add_u32 s3, s23, s31
buffer_load_dwordx4 v2, s[8:11], s3 offen offset:0 lds
M v[112:115], a[180:183], a[68:71], v[112:115]
M v[116:119], a[180:183], a[76:79], 0
M v[116:119], a[176:179], a[72:75], v[116:119]
ds_read_b64_tr_b16 a[100:101], v12 offset:49152
ds_read_b64_tr_b16 a[102:103], v12 offset:51200
M v[120:123], a[176:179], a[80:83], 0
v_accvgpr_read_b32 v24, a8
v_accvgpr_read_b32 v25, a9
M v[120:123], a[180:183], a[84:87], v[120:123]
buffer_load_dwordx4 v3, s[8:11], s3 offen offset:1024 lds
v_accvgpr_read_b32 v26, a10
v_accvgpr_read_b32 v27, a11
M v[124:127], a[180:183], a[92:95], 0
v_accvgpr_read_b32 v28, a12
v_accvgpr_read_b32 v29, a13
M v[124:127], a[176:179], a[88:91], v[124:127]
v_accvgpr_read_b32 v30, a14
v_accvgpr_read_b32 v31, a15
M v[128:131], a[184:187], a[32:35], 0
v_cvt_pk_bf16_f32 v24, v24, v25
v_cvt_pk_bf16_f32 v25, v26, v27
M v[128:131], a[188:191], a[36:39], v[128:131]
ds_read_b128 a[168:171], v10 offset:18432
ds_read_b128 a[172:175], v11 offset:18432
ds_read_b64_tr_b16 a[108:109], v13 offset:49152
ds_read_b64_tr_b16 a[110:111], v13 offset:51200
v_cvt_pk_bf16_f32 v26, v28, v29
v_cvt_pk_bf16_f32 v27, v30, v31
M v[132:135], a[188:191], a[44:47], 0
M v[132:135], a[184:187], a[40:43], v[132:135]
M v[136:139], a[184:187], a[48:51], 0
buffer_load_dwordx4 v4, s[8:11], s3 offen offset:2048 lds
M v[136:139], a[188:191], a[52:55], v[136:139]
s_add_u32 s94, s93, 12288
buffer_store_dwordx4 v[24:27], v1, s[16:19], s94 offen offset:1024 sc1
M v[140:143], a[188:191], a[60:63], 0
M v[140:143], a[184:187], a[56:59], v[140:143]
ds_read_b64_tr_b16 a[116:117], v14 offset:49152
ds_read_b64_tr_b16 a[118:119], v14 offset:51200
M v[144:147], a[184:187], a[64:67], 0
M v[144:147], a[188:191], a[68:71], v[144:147]
M v[148:151], a[188:191], a[76:79], 0
buffer_load_dwordx4 v5, s[8:11], s3 offen offset:3072 lds
M v[148:151], a[184:187], a[72:75], v[148:151]
M v[152:155], a[184:187], a[80:83], 0
M v[152:155], a[188:191], a[84:87], v[152:155]
ds_read_b64_tr_b16 a[124:125], v15 offset:49152
ds_read_b64_tr_b16 a[126:127], v15 offset:51200
M v[156:159], a[188:191], a[92:95], 0
M v[156:159], a[184:187], a[88:91], v[156:159]
s_waitcnt lgkmcnt(10)
M v[160:163], a[160:163], a[32:35], 0
M v[160:163], a[164:167], a[36:39], v[160:163]
ds_read_b128 a[176:179], v10 offset:20480
ds_read_b128 a[180:183], v11 offset:20480
M v[164:167], a[164:167], a[44:47], 0
s_add_u32 s23, s23, 128
s_cmp_eq_u32 s23, s25
s_cselect_b32 s23, s26, s23
M v[164:167], a[160:163], a[40:43], v[164:167]
ds_read_b64_tr_b16 a[132:133], v16 offset:49152
ds_read_b64_tr_b16 a[134:135], v16 offset:51200
M v[168:171], a[160:163], a[48:51], 0
v_accvgpr_read_b32 v24, a16
v_accvgpr_read_b32 v25, a17
M v[168:171], a[164:167], a[52:55], v[168:171]
v_accvgpr_read_b32 v26, a18
v_accvgpr_read_b32 v27, a19
M v[172:175], a[164:167], a[60:63], 0
v_accvgpr_read_b32 v28, a20
v_accvgpr_read_b32 v29, a21
M v[172:175], a[160:163], a[56:59], v[172:175]
v_accvgpr_read_b32 v30, a22
v_accvgpr_read_b32 v31, a23
M v[176:179], a[160:163], a[64:67], 0
s_add_u32 m0, s29, 81920
s_nop 0
buffer_load_dwordx4 v6, s[12:15], s24 offen offset:0 lds
v_cvt_pk_bf16_f32 v24, v24, v25
v_cvt_pk_bf16_f32 v25, v26, v27
M v[176:179], a[164:167], a[68:71], v[176:179]
ds_read_b64_tr_b16 a[140:141], v17 offset:49152
ds_read_b64_tr_b16 a[142:143], v17 offset:51200
v_cvt_pk_bf16_f32 v26, v28, v29
v_cvt_pk_bf16_f32 v27, v30, v31
M v[180:183], a[164:167], a[76:79], 0
M v[180:183], a[160:163], a[72:75], v[180:183]
M v[184:187], a[160:163], a[80:83], 0
M v[184:187], a[164:167], a[84:87], v[184:187]
s_add_u32 s94, s93, 12288
buffer_store_dwordx4 v[24:27], v1, s[16:19], s94 offen offset:2048 sc1
M v[188:191], a[164:167], a[92:95], 0
buffer_load_dwordx4 v7, s[12:15], s24 offen offset:1024 lds
M v[188:191], a[160:163], a[88:91], v[188:191]
s_waitcnt lgkmcnt(12)
ds_read_b64_tr_b16 a[148:149], v18 offset:49152
ds_read_b64_tr_b16 a[150:151], v18 offset:51200
M v[192:195], a[168:171], a[32:35], 0
M v[192:195], a[172:175], a[36:39], v[192:195]
ds_read_b128 a[184:187], v10 offset:22528
ds_read_b128 a[188:191], v11 offset:22528
M v[196:199], a[172:175], a[44:47], 0
M v[196:199], a[168:171], a[40:43], v[196:199]
M v[200:203], a[168:171], a[48:51], 0
M v[200:203], a[172:175], a[52:55], v[200:203]
ds_read_b64_tr_b16 a[156:157], v19 offset:49152
ds_read_b64_tr_b16 a[158:159], v19 offset:51200
M v[204:207], a[172:175], a[60:63], 0
buffer_load_dwordx4 v8, s[12:15], s24 offen offset:2048 lds
M v[204:207], a[168:171], a[56:59], v[204:207]
M v[208:211], a[168:171], a[64:67], 0
M v[208:211], a[172:175], a[68:71], v[208:211]
M v[212:215], a[172:175], a[76:79], 0
buffer_load_dwordx4 v9, s[12:15], s24 offen offset:3072 lds
M v[212:215], a[168:171], a[72:75], v[212:215]
M v[216:219], a[168:171], a[80:83], 0
v_accvgpr_read_b32 v24, a24
v_accvgpr_read_b32 v25, a25
M v[216:219], a[172:175], a[84:87], v[216:219]
v_accvgpr_read_b32 v26, a26
v_accvgpr_read_b32 v27, a27
M v[220:223], a[172:175], a[92:95], 0
v_accvgpr_read_b32 v28, a28
v_accvgpr_read_b32 v29, a29
M v[220:223], a[168:171], a[88:91], v[220:223]
s_waitcnt lgkmcnt(10)
v_accvgpr_read_b32 v30, a30
v_accvgpr_read_b32 v31, a31
M v[224:227], a[176:179], a[32:35], 0
s_add_u32 s24, s24, 262144
s_cmp_eq_u32 s24, s27
s_cselect_b32 s24, s28, s24
s_sub_u32 s6, s6, 1
s_cmp_eq_u32 s6, 0
s_cselect_b64 s[12:13], s[64:65], s[12:13]
v_cvt_pk_bf16_f32 v24, v24, v25
v_cvt_pk_bf16_f32 v25, v26, v27
M v[224:227], a[180:183], a[36:39], v[224:227]
v_cvt_pk_bf16_f32 v26, v28, v29
v_cvt_pk_bf16_f32 v27, v30, v31
M v[228:231], a[180:183], a[44:47], 0
M v[228:231], a[176:179], a[40:43], v[228:231]
M v[232:235], a[176:179], a[48:51], 0
M v[232:235], a[180:183], a[52:55], v[232:235]
s_add_u32 s94, s93, 12288
buffer_store_dwordx4 v[24:27], v1, s[16:19], s94 offen offset:3072 sc1
M v[236:239], a[180:183], a[60:63], 0
M v[236:239], a[176:179], a[56:59], v[236:239]
s_waitcnt vmcnt(12) lgkmcnt(0)
s_barrier
ds_read_b128 a[160:163], v10 offset:32768
ds_read_b128 a[164:167], v11 offset:32768
M v[240:243], a[176:179], a[64:67], 0
s_add_u32 m0, s29, 0
s_nop 0
buffer_load_dwordx4 v2, s[8:11], s23 offen offset:0 lds
M v[240:243], a[180:183], a[68:71], v[240:243]
M v[244:247], a[180:183], a[76:79], 0
M v[244:247], a[176:179], a[72:75], v[244:247]
M v[248:251], a[176:179], a[80:83], 0
M v[248:251], a[180:183], a[84:87], v[248:251]
buffer_load_dwordx4 v3, s[8:11], s23 offen offset:1024 lds
M v[252:255], a[180:183], a[92:95], 0
M v[252:255], a[176:179], a[88:91], v[252:255]
M a[0:3], a[184:187], a[32:35], 0
M a[0:3], a[188:191], a[36:39], a[0:3]
ds_read_b128 a[168:171], v10 offset:34816
ds_read_b128 a[172:175], v11 offset:34816
M a[4:7], a[188:191], a[44:47], 0
M a[4:7], a[184:187], a[40:43], a[4:7]
M a[8:11], a[184:187], a[48:51], 0
buffer_load_dwordx4 v4, s[8:11], s23 offen offset:2048 lds
M a[8:11], a[188:191], a[52:55], a[8:11]
M a[12:15], a[188:191], a[60:63], 0
M a[12:15], a[184:187], a[56:59], a[12:15]
M a[16:19], a[184:187], a[64:67], 0
M a[16:19], a[188:191], a[68:71], a[16:19]
buffer_load_dwordx4 v5, s[8:11], s23 offen offset:3072 lds
M a[20:23], a[188:191], a[76:79], 0
M a[20:23], a[184:187], a[72:75], a[20:23]
M a[24:27], a[184:187], a[80:83], 0
M a[24:27], a[188:191], a[84:87], a[24:27]
M a[28:31], a[188:191], a[92:95], 0
M a[28:31], a[184:187], a[88:91], a[28:31]
s_waitcnt lgkmcnt(2)
M v[32:35], a[160:163], a[96:99], v[32:35]
s_add_u32 m0, s29, 98304
s_nop 0
buffer_load_dwordx4 v6, s[12:15], s24 offen offset:0 lds
M v[32:35], a[164:167], a[100:103], v[32:35]
ds_read_b128 a[176:179], v10 offset:36864
ds_read_b128 a[180:183], v11 offset:36864
M v[36:39], a[164:167], a[108:111], v[36:39]
M v[36:39], a[160:163], a[104:107], v[36:39]
ds_read_b64_tr_b16 a[32:33], v12 offset:0
ds_read_b64_tr_b16 a[34:35], v12 offset:2048
M v[40:43], a[160:163], a[112:115], v[40:43]
M v[40:43], a[164:167], a[116:119], v[40:43]
M v[44:47], a[164:167], a[124:127], v[44:47]
M v[44:47], a[160:163], a[120:123], v[44:47]
ds_read_b64_tr_b16 a[40:41], v13 offset:0
ds_read_b64_tr_b16 a[42:43], v13 offset:2048
M v[48:51], a[160:163], a[128:131], v[48:51]
s_add_u32 s94, s92, 12288
buffer_store_dwordx4 a[192:195], v1, s[16:19], s94 offen offset:0 sc1
M v[48:51], a[164:167], a[132:135], v[48:51]
buffer_load_dwordx4 v7, s[12:15], s24 offen offset:1024 lds
M v[52:55], a[164:167], a[140:143], v[52:55]
M v[52:55], a[160:163], a[136:139], v[52:55]
ds_read_b64_tr_b16 a[48:49], v14 offset:0
ds_read_b64_tr_b16 a[50:51], v14 offset:2048
M v[56:59], a[160:163], a[144:147], v[56:59]
M v[56:59], a[164:167], a[148:151], v[56:59]
M v[60:63], a[164:167], a[156:159], v[60:63]
M v[60:63], a[160:163], a[152:155], v[60:63]
s_waitcnt lgkmcnt(8)
ds_read_b64_tr_b16 a[56:57], v15 offset:0
ds_read_b64_tr_b16 a[58:59], v15 offset:2048
M v[64:67], a[168:171], a[96:99], v[64:67]
buffer_load_dwordx4 v8, s[12:15], s24 offen offset:2048 lds
M v[64:67], a[172:175], a[100:103], v[64:67]
ds_read_b128 a[184:187], v10 offset:38912
ds_read_b128 a[188:191], v11 offset:38912
M v[68:71], a[172:175], a[108:111], v[68:71]
M v[68:71], a[168:171], a[104:107], v[68:71]
ds_read_b64_tr_b16 a[64:65], v16 offset:0
ds_read_b64_tr_b16 a[66:67], v16 offset:2048
M v[72:75], a[168:171], a[112:115], v[72:75]
M v[72:75], a[172:175], a[116:119], v[72:75]
M v[76:79], a[172:175], a[124:127], v[76:79]
M v[76:79], a[168:171], a[120:123], v[76:79]
ds_read_b64_tr_b16 a[72:73], v17 offset:0
ds_read_b64_tr_b16 a[74:75], v17 offset:2048
M v[80:83], a[168:171], a[128:131], v[80:83]
buffer_load_dwordx4 v9, s[12:15], s24 offen offset:3072 lds
M v[80:83], a[172:175], a[132:135], v[80:83]
M v[84:87], a[172:175], a[140:143], v[84:87]
M v[84:87], a[168:171], a[136:139], v[84:87]
ds_read_b64_tr_b16 a[80:81], v18 offset:0
ds_read_b64_tr_b16 a[82:83], v18 offset:2048
M v[88:91], a[168:171], a[144:147], v[88:91]
M v[88:91], a[172:175], a[148:151], v[88:91]
M v[92:95], a[172:175], a[156:159], v[92:95]
s_add_u32 s24, s24, 262144
M v[92:95], a[168:171], a[152:155], v[92:95]
s_waitcnt lgkmcnt(15)
ds_read_b64_tr_b16 a[88:89], v19 offset:0
ds_read_b64_tr_b16 a[90:91], v19 offset:2048
M v[96:99], a[176:179], a[96:99], v[96:99]
M v[96:99], a[180:183], a[100:103], v[96:99]
M v[100:103], a[180:183], a[108:111], v[100:103]
M v[100:103], a[176:179], a[104:107], v[100:103]
M v[104:107], a[176:179], a[112:115], v[104:107]
s_add_u32 s94, s92, 12288
buffer_store_dwordx4 a[196:199], v1, s[16:19], s94 offen offset:1024 sc1
M v[104:107], a[180:183], a[116:119], v[104:107]
M v[108:111], a[180:183], a[124:127], v[108:111]
M v[108:111], a[176:179], a[120:123], v[108:111]
s_waitcnt vmcnt(11) lgkmcnt(0)
s_barrier
ds_read_b128 a[160:163], v10 offset:49152
ds_read_b128 a[164:167], v11 offset:49152
M v[112:115], a[176:179], a[128:131], v[112:115]
s_add_u32 m0, s29, 16384
s_add_u32 s3, s23, s31
buffer_load_dwordx4 v2, s[8:11], s3 offen offset:0 lds
M v[112:115], a[180:183], a[132:135], v[112:115]
M v[116:119], a[180:183], a[140:143], v[116:119]
M v[116:119], a[176:179], a[136:139], v[116:119]
ds_read_b64_tr_b16 a[36:37], v12 offset:16384
ds_read_b64_tr_b16 a[38:39], v12 offset:18432
M v[120:123], a[176:179], a[144:147], v[120:123]
M v[120:123], a[180:183], a[148:151], v[120:123]
buffer_load_dwordx4 v3, s[8:11], s3 offen offset:1024 lds
M v[124:127], a[180:183], a[156:159], v[124:127]
M v[124:127], a[176:179], a[152:155], v[124:127]
M v[128:131], a[184:187], a[96:99], v[128:131]
M v[128:131], a[188:191], a[100:103], v[128:131]
ds_read_b128 a[168:171], v10 offset:51200
ds_read_b128 a[172:175], v11 offset:51200
ds_read_b64_tr_b16 a[44:45], v13 offset:16384
ds_read_b64_tr_b16 a[46:47], v13 offset:18432
M v[132:135], a[188:191], a[108:111], v[132:135]
M v[132:135], a[184:187], a[104:107], v[132:135]
M v[136:139], a[184:187], a[112:115], v[136:139]
buffer_load_dwordx4 v4, s[8:11], s3 offen offset:2048 lds
M v[136:139], a[188:191], a[116:119], v[136:139]
M v[140:143], a[188:191], a[124:127], v[140:143]
M v[140:143], a[184:187], a[120:123], v[140:143]
ds_read_b64_tr_b16 a[52:53], v14 offset:16384
ds_read_b64_tr_b16 a[54:55], v14 offset:18432
M v[144:147], a[184:187], a[128:131], v[144:147]
M v[144:147], a[188:191], a[132:135], v[144:147]
buffer_load_dwordx4 v5, s[8:11], s3 offen offset:3072 lds
M v[148:151], a[188:191], a[140:143], v[148:151]
M v[148:151], a[184:187], a[136:139], v[148:151]
M v[152:155], a[184:187], a[144:147], v[152:155]
M v[152:155], a[188:191], a[148:151], v[152:155]
ds_read_b64_tr_b16 a[60:61], v15 offset:16384
ds_read_b64_tr_b16 a[62:63], v15 offset:18432
M v[156:159], a[188:191], a[156:159], v[156:159]
M v[156:159], a[184:187], a[152:155], v[156:159]
s_waitcnt lgkmcnt(10)
M v[160:163], a[160:163], a[96:99], v[160:163]
s_add_u32 s94, s92, 12288
buffer_store_dwordx4 a[200:203], v1, s[16:19], s94 offen offset:2048 sc1
M v[160:163], a[164:167], a[100:103], v[160:163]
ds_read_b128 a[176:179], v10 offset:53248
ds_read_b128 a[180:183], v11 offset:53248
M v[164:167], a[164:167], a[108:111], v[164:167]
s_add_u32 s23, s23, 128
s_cmp_eq_u32 s23, s25
s_cselect_b32 s23, s26, s23
M v[164:167], a[160:163], a[104:107], v[164:167]
ds_read_b64_tr_b16 a[68:69], v16 offset:16384
ds_read_b64_tr_b16 a[70:71], v16 offset:18432
M v[168:171], a[160:163], a[112:115], v[168:171]
M v[168:171], a[164:167], a[116:119], v[168:171]
M v[172:175], a[164:167], a[124:127], v[172:175]
M v[172:175], a[160:163], a[120:123], v[172:175]
M v[176:179], a[160:163], a[128:131], v[176:179]
s_add_u32 m0, s29, 114688
s_nop 0
buffer_load_dwordx4 v6, s[12:15], s24 offen offset:0 lds
M v[176:179], a[164:167], a[132:135], v[176:179]
ds_read_b64_tr_b16 a[76:77], v17 offset:16384
ds_read_b64_tr_b16 a[78:79], v17 offset:18432
M v[180:183], a[164:167], a[140:143], v[180:183]
M v[180:183], a[160:163], a[136:139], v[180:183]
M v[184:187], a[160:163], a[144:147], v[184:187]
M v[184:187], a[164:167], a[148:151], v[184:187]
buffer_load_dwordx4 v7, s[12:15], s24 offen offset:1024 lds
M v[188:191], a[164:167], a[156:159], v[188:191]
M v[188:191], a[160:163], a[152:155], v[188:191]
s_waitcnt lgkmcnt(12)
ds_read_b64_tr_b16 a[84:85], v18 offset:16384
ds_read_b64_tr_b16 a[86:87], v18 offset:18432
M v[192:195], a[168:171], a[96:99], v[192:195]
M v[192:195], a[172:175], a[100:103], v[192:195]
ds_read_b128 a[184:187], v10 offset:55296
ds_read_b128 a[188:191], v11 offset:55296
M v[196:199], a[172:175], a[108:111], v[196:199]
M v[196:199], a[168:171], a[104:107], v[196:199]
M v[200:203], a[168:171], a[112:115], v[200:203]
buffer_load_dwordx4 v8, s[12:15], s24 offen offset:2048 lds
M v[200:203], a[172:175], a[116:119], v[200:203]
ds_read_b64_tr_b16 a[92:93], v19 offset:16384
ds_read_b64_tr_b16 a[94:95], v19 offset:18432
M v[204:207], a[172:175], a[124:127], v[204:207]
M v[204:207], a[168:171], a[120:123], v[204:207]
M v[208:211], a[168:171], a[128:131], v[208:211]
M v[208:211], a[172:175], a[132:135], v[208:211]
buffer_load_dwordx4 v9, s[12:15], s24 offen offset:3072 lds
M v[212:215], a[172:175], a[140:143], v[212:215]
M v[212:215], a[168:171], a[136:139], v[212:215]
M v[216:219], a[168:171], a[144:147], v[216:219]
s_add_u32 s94, s92, 12288
buffer_store_dwordx4 a[204:207], v1, s[16:19], s94 offen offset:3072 sc1
M v[216:219], a[172:175], a[148:151], v[216:219]
M v[220:223], a[172:175], a[156:159], v[220:223]
M v[220:223], a[168:171], a[152:155], v[220:223]
s_waitcnt lgkmcnt(10)
M v[224:227], a[176:179], a[96:99], v[224:227]
s_add_u32 s24, s24, 262144
s_cmp_eq_u32 s24, s27
s_cselect_b32 s24, s28, s24
s_sub_u32 s6, s6, 1
s_cmp_eq_u32 s6, 0
s_cselect_b64 s[12:13], s[64:65], s[12:13]
M v[224:227], a[180:183], a[100:103], v[224:227]
M v[228:231], a[180:183], a[108:111], v[228:231]
M v[228:231], a[176:179], a[104:107], v[228:231]
M v[232:235], a[176:179], a[112:115], v[232:235]
M v[232:235], a[180:183], a[116:119], v[232:235]
M v[236:239], a[180:183], a[124:127], v[236:239]
M v[236:239], a[176:179], a[120:123], v[236:239]
s_waitcnt vmcnt(11) lgkmcnt(0)
s_barrier
ds_read_b128 a[160:163], v10 offset:0
ds_read_b128 a[164:167], v11 offset:0
M v[240:243], a[176:179], a[128:131], v[240:243]
s_add_u32 m0, s29, 32768
s_nop 0
buffer_load_dwordx4 v2, s[8:11], s23 offen offset:0 lds
M v[240:243], a[180:183], a[132:135], v[240:243]
M v[244:247], a[180:183], a[140:143], v[244:247]
M v[244:247], a[176:179], a[136:139], v[244:247]
M v[248:251], a[176:179], a[144:147], v[248:251]
M v[248:251], a[180:183], a[148:151], v[248:251]
buffer_load_dwordx4 v3, s[8:11], s23 offen offset:1024 lds
M v[252:255], a[180:183], a[156:159], v[252:255]
M v[252:255], a[176:179], a[152:155], v[252:255]
M a[0:3], a[184:187], a[96:99], a[0:3]
M a[0:3], a[188:191], a[100:103], a[0:3]
ds_read_b128 a[168:171], v10 offset:2048
ds_read_b128 a[172:175], v11 offset:2048
M a[4:7], a[188:191], a[108:111], a[4:7]
M a[4:7], a[184:187], a[104:107], a[4:7]
M a[8:11], a[184:187], a[112:115], a[8:11]
buffer_load_dwordx4 v4, s[8:11], s23 offen offset:2048 lds
M a[8:11], a[188:191], a[116:119], a[8:11]
M a[12:15], a[188:191], a[124:127], a[12:15]
M a[12:15], a[184:187], a[120:123], a[12:15]
M a[16:19], a[184:187], a[128:131], a[16:19]
M a[16:19], a[188:191], a[132:135], a[16:19]
buffer_load_dwordx4 v5, s[8:11], s23 offen offset:3072 lds
M a[20:23], a[188:191], a[140:143], a[20:23]
M a[20:23], a[184:187], a[136:139], a[20:23]
M a[24:27], a[184:187], a[144:147], a[24:27]
M a[24:27], a[188:191], a[148:151], a[24:27]
M a[28:31], a[188:191], a[156:159], a[28:31]
M a[28:31], a[184:187], a[152:155], a[28:31]
s_waitcnt lgkmcnt(2)
M v[32:35], a[160:163], a[32:35], v[32:35]
s_add_u32 m0, s29, 65536
s_nop 0
buffer_load_dwordx4 v6, s[12:15], s24 offen offset:0 lds
M v[32:35], a[164:167], a[36:39], v[32:35]
ds_read_b128 a[176:179], v10 offset:4096
ds_read_b128 a[180:183], v11 offset:4096
M v[36:39], a[164:167], a[44:47], v[36:39]
M v[36:39], a[160:163], a[40:43], v[36:39]
ds_read_b64_tr_b16 a[96:97], v12 offset:32768
ds_read_b64_tr_b16 a[98:99], v12 offset:34816
M v[40:43], a[160:163], a[48:51], v[40:43]
M v[40:43], a[164:167], a[52:55], v[40:43]
M v[44:47], a[164:167], a[60:63], v[44:47]
M v[44:47], a[160:163], a[56:59], v[44:47]
ds_read_b64_tr_b16 a[104:105], v13 offset:32768
ds_read_b64_tr_b16 a[106:107], v13 offset:34816
M v[48:51], a[160:163], a[64:67], v[48:51]
s_add_u32 s94, s93, 0
buffer_store_dwordx4 a[208:211], v1, s[16:19], s94 offen offset:0 sc1
M v[48:51], a[164:167], a[68:71], v[48:51]
buffer_load_dwordx4 v7, s[12:15], s24 offen offset:1024 lds
M v[52:55], a[164:167], a[76:79], v[52:55]
M v[52:55], a[160:163], a[72:75], v[52:55]
ds_read_b64_tr_b16 a[112:113], v14 offset:32768
ds_read_b64_tr_b16 a[114:115], v14 offset:34816
M v[56:59], a[160:163], a[80:83], v[56:59]
M v[56:59], a[164:167], a[84:87], v[56:59]
M v[60:63], a[164:167], a[92:95], v[60:63]
M v[60:63], a[160:163], a[88:91], v[60:63]
s_waitcnt lgkmcnt(8)
ds_read_b64_tr_b16 a[120:121], v15 offset:32768
ds_read_b64_tr_b16 a[122:123], v15 offset:34816
M v[64:67], a[168:171], a[32:35], v[64:67]
buffer_load_dwordx4 v8, s[12:15], s24 offen offset:2048 lds
M v[64:67], a[172:175], a[36:39], v[64:67]
ds_read_b128 a[184:187], v10 offset:6144
ds_read_b128 a[188:191], v11 offset:6144
M v[68:71], a[172:175], a[44:47], v[68:71]
M v[68:71], a[168:171], a[40:43], v[68:71]
ds_read_b64_tr_b16 a[128:129], v16 offset:32768
ds_read_b64_tr_b16 a[130:131], v16 offset:34816
M v[72:75], a[168:171], a[48:51], v[72:75]
M v[72:75], a[172:175], a[52:55], v[72:75]
M v[76:79], a[172:175], a[60:63], v[76:79]
M v[76:79], a[168:171], a[56:59], v[76:79]
ds_read_b64_tr_b16 a[136:137], v17 offset:32768
ds_read_b64_tr_b16 a[138:139], v17 offset:34816
M v[80:83], a[168:171], a[64:67], v[80:83]
buffer_load_dwordx4 v9, s[12:15], s24 offen offset:3072 lds
M v[80:83], a[172:175], a[68:71], v[80:83]
M v[84:87], a[172:175], a[76:79], v[84:87]
M v[84:87], a[168:171], a[72:75], v[84:87]
ds_read_b64_tr_b16 a[144:145], v18 offset:32768
ds_read_b64_tr_b16 a[146:147], v18 offset:34816
M v[88:91], a[168:171], a[80:83], v[88:91]
M v[88:91], a[172:175], a[84:87], v[88:91]
M v[92:95], a[172:175], a[92:95], v[92:95]
s_add_u32 s24, s24, 262144
M v[92:95], a[168:171], a[88:91], v[92:95]
s_waitcnt lgkmcnt(15)
ds_read_b64_tr_b16 a[152:153], v19 offset:32768
ds_read_b64_tr_b16 a[154:155], v19 offset:34816
M v[96:99], a[176:179], a[32:35], v[96:99]
M v[96:99], a[180:183], a[36:39], v[96:99]
M v[100:103], a[180:183], a[44:47], v[100:103]
M v[100:103], a[176:179], a[40:43], v[100:103]
M v[104:107], a[176:179], a[48:51], v[104:107]
s_add_u32 s94, s93, 0
buffer_store_dwordx4 a[212:215], v1, s[16:19], s94 offen offset:1024 sc1
M v[104:107], a[180:183], a[52:55], v[104:107]
M v[108:111], a[180:183], a[60:63], v[108:111]
M v[108:111], a[176:179], a[56:59], v[108:111]
s_waitcnt vmcnt(11) lgkmcnt(0)
s_barrier
ds_read_b128 a[160:163], v10 offset:16384
ds_read_b128 a[164:167], v11 offset:16384
M v[112:115], a[176:179], a[64:67], v[112:115]
s_add_u32 m0, s29, 49152
s_add_u32 s3, s23, s31
buffer_load_dwordx4 v2, s[8:11], s3 offen offset:0 lds
M v[112:115], a[180:183], a[68:71], v[112:115]
M v[116:119], a[180:183], a[76:79], v[116:119]
M v[116:119], a[176:179], a[72:75], v[116:119]
ds_read_b64_tr_b16 a[100:101], v12 offset:49152
ds_read_b64_tr_b16 a[102:103], v12 offset:51200
M v[120:123], a[176:179], a[80:83], v[120:123]
M v[120:123], a[180:183], a[84:87], v[120:123]
buffer_load_dwordx4 v3, s[8:11], s3 offen offset:1024 lds
M v[124:127], a[180:183], a[92:95], v[124:127]
M v[124:127], a[176:179], a[88:91], v[124:127]
M v[128:131], a[184:187], a[32:35], v[128:131]
M v[128:131], a[188:191], a[36:39], v[128:131]
ds_read_b128 a[168:171], v10 offset:18432
ds_read_b128 a[172:175], v11 offset:18432
ds_read_b64_tr_b16 a[108:109], v13 offset:49152
ds_read_b64_tr_b16 a[110:111], v13 offset:51200
M v[132:135], a[188:191], a[44:47], v[132:135]
M v[132:135], a[184:187], a[40:43], v[132:135]
M v[136:139], a[184:187], a[48:51], v[136:139]
buffer_load_dwordx4 v4, s[8:11], s3 offen offset:2048 lds
M v[136:139], a[188:191], a[52:55], v[136:139]
M v[140:143], a[188:191], a[60:63], v[140:143]
M v[140:143], a[184:187], a[56:59], v[140:143]
ds_read_b64_tr_b16 a[116:117], v14 offset:49152
ds_read_b64_tr_b16 a[118:119], v14 offset:51200
M v[144:147], a[184:187], a[64:67], v[144:147]
M v[144:147], a[188:191], a[68:71], v[144:147]
buffer_load_dwordx4 v5, s[8:11], s3 offen offset:3072 lds
M v[148:151], a[188:191], a[76:79], v[148:151]
M v[148:151], a[184:187], a[72:75], v[148:151]
M v[152:155], a[184:187], a[80:83], v[152:155]
M v[152:155], a[188:191], a[84:87], v[152:155]
ds_read_b64_tr_b16 a[124:125], v15 offset:49152
ds_read_b64_tr_b16 a[126:127], v15 offset:51200
M v[156:159], a[188:191], a[92:95], v[156:159]
M v[156:159], a[184:187], a[88:91], v[156:159]
s_waitcnt lgkmcnt(10)
M v[160:163], a[160:163], a[32:35], v[160:163]
s_add_u32 s94, s93, 0
buffer_store_dwordx4 a[216:219], v1, s[16:19], s94 offen offset:2048 sc1
M v[160:163], a[164:167], a[36:39], v[160:163]
ds_read_b128 a[176:179], v10 offset:20480
ds_read_b128 a[180:183], v11 offset:20480
M v[164:167], a[164:167], a[44:47], v[164:167]
s_add_u32 s23, s23, 128
s_cmp_eq_u32 s23, s25
s_cselect_b32 s23, s26, s23
M v[164:167], a[160:163], a[40:43], v[164:167]
ds_read_b64_tr_b16 a[132:133], v16 offset:49152
ds_read_b64_tr_b16 a[134:135], v16 offset:51200
M v[168:171], a[160:163], a[48:51], v[168:171]
M v[168:171], a[164:167], a[52:55], v[168:171]
M v[172:175], a[164:167], a[60:63], v[172:175]
M v[172:175], a[160:163], a[56:59], v[172:175]
M v[176:179], a[160:163], a[64:67], v[176:179]
s_add_u32 m0, s29, 81920
s_nop 0
buffer_load_dwordx4 v6, s[12:15], s24 offen offset:0 lds
M v[176:179], a[164:167], a[68:71], v[176:179]
ds_read_b64_tr_b16 a[140:141], v17 offset:49152
ds_read_b64_tr_b16 a[142:143], v17 offset:51200
M v[180:183], a[164:167], a[76:79], v[180:183]
M v[180:183], a[160:163], a[72:75], v[180:183]
M v[184:187], a[160:163], a[80:83], v[184:187]
M v[184:187], a[164:167], a[84:87], v[184:187]
buffer_load_dwordx4 v7, s[12:15], s24 offen offset:1024 lds
M v[188:191], a[164:167], a[92:95], v[188:191]
M v[188:191], a[160:163], a[88:91], v[188:191]
s_waitcnt lgkmcnt(12)
ds_read_b64_tr_b16 a[148:149], v18 offset:49152
ds_read_b64_tr_b16 a[150:151], v18 offset:51200
M v[192:195], a[168:171], a[32:35], v[192:195]
M v[192:195], a[172:175], a[36:39], v[192:195]
ds_read_b128 a[184:187], v10 offset:22528
ds_read_b128 a[188:191], v11 offset:22528
M v[196:199], a[172:175], a[44:47], v[196:199]
M v[196:199], a[168:171], a[40:43], v[196:199]
M v[200:203], a[168:171], a[48:51], v[200:203]
buffer_load_dwordx4 v8, s[12:15], s24 offen offset:2048 lds
M v[200:203], a[172:175], a[52:55], v[200:203]
ds_read_b64_tr_b16 a[156:157], v19 offset:49152
ds_read_b64_tr_b16 a[158:159], v19 offset:51200
M v[204:207], a[172:175], a[60:63], v[204:207]
M v[204:207], a[168:171], a[56:59], v[204:207]
M v[208:211], a[168:171], a[64:67], v[208:211]
M v[208:211], a[172:175], a[68:71], v[208:211]
buffer_load_dwordx4 v9, s[12:15], s24 offen offset:3072 lds
M v[212:215], a[172:175], a[76:79], v[212:215]
M v[212:215], a[168:171], a[72:75], v[212:215]
M v[216:219], a[168:171], a[80:83], v[216:219]
s_add_u32 s94, s93, 0
buffer_store_dwordx4 a[220:223], v1, s[16:19], s94 offen offset:3072 sc1
M v[216:219], a[172:175], a[84:87], v[216:219]
M v[220:223], a[172:175], a[92:95], v[220:223]
M v[220:223], a[168:171], a[88:91], v[220:223]
s_waitcnt lgkmcnt(10)
M v[224:227], a[176:179], a[32:35], v[224:227]
s_add_u32 s24, s24, 262144
s_cmp_eq_u32 s24, s27
s_cselect_b32 s24, s28, s24
s_sub_u32 s6, s6, 1
s_cmp_eq_u32 s6, 0
s_cselect_b64 s[12:13], s[64:65], s[12:13]
M v[224:227], a[180:183], a[36:39], v[224:227]
M v[228:231], a[180:183], a[44:47], v[228:231]
M v[228:231], a[176:179], a[40:43], v[228:231]
M v[232:235], a[176:179], a[48:51], v[232:235]
M v[232:235], a[180:183], a[52:55], v[232:235]
M v[236:239], a[180:183], a[60:63], v[236:239]
M v[236:239], a[176:179], a[56:59], v[236:239]
s_waitcnt vmcnt(11) lgkmcnt(0)
s_barrier
ds_read_b128 a[160:163], v10 offset:32768
ds_read_b128 a[164:167], v11 offset:32768
M v[240:243], a[176:179], a[64:67], v[240:243]
s_add_u32 m0, s29, 0
s_nop 0
buffer_load_dwordx4 v2, s[8:11], s23 offen offset:0 lds
M v[240:243], a[180:183], a[68:71], v[240:243]
M v[244:247], a[180:183], a[76:79], v[244:247]
M v[244:247], a[176:179], a[72:75], v[244:247]
M v[248:251], a[176:179], a[80:83], v[248:251]
M v[248:251], a[180:183], a[84:87], v[248:251]
buffer_load_dwordx4 v3, s[8:11], s23 offen offset:1024 lds
M v[252:255], a[180:183], a[92:95], v[252:255]
M v[252:255], a[176:179], a[88:91], v[252:255]
M a[0:3], a[184:187], a[32:35], a[0:3]
M a[0:3], a[188:191], a[36:39], a[0:3]
ds_read_b128 a[168:171], v10 offset:34816
ds_read_b128 a[172:175], v11 offset:34816
M a[4:7], a[188:191], a[44:47], a[4:7]
M a[4:7], a[184:187], a[40:43], a[4:7]
M a[8:11], a[184:187], a[48:51], a[8:11]
buffer_load_dwordx4 v4, s[8:11], s23 offen offset:2048 lds
M a[8:11], a[188:191], a[52:55], a[8:11]
M a[12:15], a[188:191], a[60:63], a[12:15]
M a[12:15], a[184:187], a[56:59], a[12:15]
M a[16:19], a[184:187], a[64:67], a[16:19]
M a[16:19], a[188:191], a[68:71], a[16:19]
buffer_load_dwordx4 v5, s[8:11], s23 offen offset:3072 lds
M a[20:23], a[188:191], a[76:79], a[20:23]
M a[20:23], a[184:187], a[72:75], a[20:23]
M a[24:27], a[184:187], a[80:83], a[24:27]
M a[24:27], a[188:191], a[84:87], a[24:27]
M a[28:31], a[188:191], a[92:95], a[28:31]
M a[28:31], a[184:187], a[88:91], a[28:31]
s_waitcnt lgkmcnt(2)
M v[32:35], a[160:163], a[96:99], v[32:35]
s_add_u32 m0, s29, 98304
s_nop 0
buffer_load_dwordx4 v6, s[12:15], s24 offen offset:0 lds
M v[32:35], a[164:167], a[100:103], v[32:35]
ds_read_b128 a[176:179], v10 offset:36864
ds_read_b128 a[180:183], v11 offset:36864
M v[36:39], a[164:167], a[108:111], v[36:39]
M v[36:39], a[160:163], a[104:107], v[36:39]
ds_read_b64_tr_b16 a[32:33], v12 offset:0
ds_read_b64_tr_b16 a[34:35], v12 offset:2048
M v[40:43], a[160:163], a[112:115], v[40:43]
M v[40:43], a[164:167], a[116:119], v[40:43]
M v[44:47], a[164:167], a[124:127], v[44:47]
M v[44:47], a[160:163], a[120:123], v[44:47]
ds_read_b64_tr_b16 a[40:41], v13 offset:0
ds_read_b64_tr_b16 a[42:43], v13 offset:2048
M v[48:51], a[160:163], a[128:131], v[48:51]
s_add_u32 s94, s93, 4096
buffer_store_dwordx4 a[224:227], v1, s[16:19], s94 offen offset:0 sc1
M v[48:51], a[164:167], a[132:135], v[48:51]
buffer_load_dwordx4 v7, s[12:15], s24 offen offset:1024 lds
M v[52:55], a[164:167], a[140:143], v[52:55]
M v[52:55], a[160:163], a[136:139], v[52:55]
ds_read_b64_tr_b16 a[48:49], v14 offset:0
ds_read_b64_tr_b16 a[50:51], v14 offset:2048
M v[56:59], a[160:163], a[144:147], v[56:59]
M v[56:59], a[164:167], a[148:151], v[56:59]
M v[60:63], a[164:167], a[156:159], v[60:63]
M v[60:63], a[160:163], a[152:155], v[60:63]
s_waitcnt lgkmcnt(8)
ds_read_b64_tr_b16 a[56:57], v15 offset:0
ds_read_b64_tr_b16 a[58:59], v15 offset:2048
M v[64:67], a[168:171], a[96:99], v[64:67]
buffer_load_dwordx4 v8, s[12:15], s24 offen offset:2048 lds
M v[64:67], a[172:175], a[100:103], v[64:67]
ds_read_b128 a[184:187], v10 offset:38912
ds_read_b128 a[188:191], v11 offset:38912
M v[68:71], a[172:175], a[108:111], v[68:71]
M v[68:71], a[168:171], a[104:107], v[68:71]
ds_read_b64_tr_b16 a[64:65], v16 offset:0
ds_read_b64_tr_b16 a[66:67], v16 offset:2048
M v[72:75], a[168:171], a[112:115], v[72:75]
M v[72:75], a[172:175], a[116:119], v[72:75]
M v[76:79], a[172:175], a[124:127], v[76:79]
M v[76:79], a[168:171], a[120:123], v[76:79]
ds_read_b64_tr_b16 a[72:73], v17 offset:0
ds_read_b64_tr_b16 a[74:75], v17 offset:2048
M v[80:83], a[168:171], a[128:131], v[80:83]
buffer_load_dwordx4 v9, s[12:15], s24 offen offset:3072 lds
M v[80:83], a[172:175], a[132:135], v[80:83]
M v[84:87], a[172:175], a[140:143], v[84:87]
M v[84:87], a[168:171], a[136:139], v[84:87]
ds_read_b64_tr_b16 a[80:81], v18 offset:0
ds_read_b64_tr_b16 a[82:83], v18 offset:2048
M v[88:91], a[168:171], a[144:147], v[88:91]
M v[88:91], a[172:175], a[148:151], v[88:91]
M v[92:95], a[172:175], a[156:159], v[92:95]
s_add_u32 s24, s24, 262144
M v[92:95], a[168:171], a[152:155], v[92:95]
s_waitcnt lgkmcnt(15)
ds_read_b64_tr_b16 a[88:89], v19 offset:0
ds_read_b64_tr_b16 a[90:91], v19 offset:2048
M v[96:99], a[176:179], a[96:99], v[96:99]
M v[96:99], a[180:183], a[100:103], v[96:99]
M v[100:103], a[180:183], a[108:111], v[100:103]
M v[100:103], a[176:179], a[104:107], v[100:103]
M v[104:107], a[176:179], a[112:115], v[104:107]
s_add_u32 s94, s93, 4096
buffer_store_dwordx4 a[228:231], v1, s[16:19], s94 offen offset:1024 sc1
M v[104:107], a[180:183], a[116:119], v[104:107]
M v[108:111], a[180:183], a[124:127], v[108:111]
M v[108:111], a[176:179], a[120:123], v[108:111]
s_waitcnt vmcnt(11) lgkmcnt(0)
s_barrier
ds_read_b128 a[160:163], v10 offset:49152
ds_read_b128 a[164:167], v11 offset:49152
M v[112:115], a[176:179], a[128:131], v[112:115]
s_add_u32 m0, s29, 16384
s_add_u32 s3, s23, s31
buffer_load_dwordx4 v2, s[8:11], s3 offen offset:0 lds
M v[112:115], a[180:183], a[132:135], v[112:115]
M v[116:119], a[180:183], a[140:143], v[116:119]
M v[116:119], a[176:179], a[136:139], v[116:119]
ds_read_b64_tr_b16 a[36:37], v12 offset:16384
ds_read_b64_tr_b16 a[38:39], v12 offset:18432
M v[120:123], a[176:179], a[144:147], v[120:123]
M v[120:123], a[180:183], a[148:151], v[120:123]
buffer_load_dwordx4 v3, s[8:11], s3 offen offset:1024 lds
M v[124:127], a[180:183], a[156:159], v[124:127]
M v[124:127], a[176:179], a[152:155], v[124:127]
M v[128:131], a[184:187], a[96:99], v[128:131]
M v[128:131], a[188:191], a[100:103], v[128:131]
ds_read_b128 a[168:171], v10 offset:51200
ds_read_b128 a[172:175], v11 offset:51200
ds_read_b64_tr_b16 a[44:45], v13 offset:16384
ds_read_b64_tr_b16 a[46:47], v13 offset:18432
M v[132:135], a[188:191], a[108:111], v[132:135]
M v[132:135], a[184:187], a[104:107], v[132:135]
M v[136:139], a[184:187], a[112:115], v[136:139]
buffer_load_dwordx4 v4, s[8:11], s3 offen offset:2048 lds
M v[136:139], a[188:191], a[116:119], v[136:139]
M v[140:143], a[188:191], a[124:127], v[140:143]
M v[140:143], a[184:187], a[120:123], v[140:143]
ds_read_b64_tr_b16 a[52:53], v14 offset:16384
ds_read_b64_tr_b16 a[54:55], v14 offset:18432
M v[144:147], a[184:187], a[128:131], v[144:147]
M v[144:147], a[188:191], a[132:135], v[144:147]
buffer_load_dwordx4 v5, s[8:11], s3 offen offset:3072 lds
M v[148:151], a[188:191], a[140:143], v[148:151]
M v[148:151], a[184:187], a[136:139], v[148:151]
M v[152:155], a[184:187], a[144:147], v[152:155]
M v[152:155], a[188:191], a[148:151], v[152:155]
ds_read_b64_tr_b16 a[60:61], v15 offset:16384
ds_read_b64_tr_b16 a[62:63], v15 offset:18432
M v[156:159], a[188:191], a[156:159], v[156:159]
M v[156:159], a[184:187], a[152:155], v[156:159]
s_waitcnt lgkmcnt(10)
M v[160:163], a[160:163], a[96:99], v[160:163]
s_add_u32 s94, s93, 4096
buffer_store_dwordx4 a[232:235], v1, s[16:19], s94 offen offset:2048 sc1
M v[160:163], a[164:167], a[100:103], v[160:163]
ds_read_b128 a[176:179], v10 offset:53248
ds_read_b128 a[180:183], v11 offset:53248
M v[164:167], a[164:167], a[108:111], v[164:167]
s_add_u32 s23, s23, 128
s_cmp_eq_u32 s23, s25
s_cselect_b32 s23, s26, s23
M v[164:167], a[160:163], a[104:107], v[164:167]
ds_read_b64_tr_b16 a[68:69], v16 offset:16384
ds_read_b64_tr_b16 a[70:71], v16 offset:18432
M v[168:171], a[160:163], a[112:115], v[168:171]
M v[168:171], a[164:167], a[116:119], v[168:171]
M v[172:175], a[164:167], a[124:127], v[172:175]
M v[172:175], a[160:163], a[120:123], v[172:175]
M v[176:179], a[160:163], a[128:131], v[176:179]
s_add_u32 m0, s29, 114688
s_nop 0
buffer_load_dwordx4 v6, s[12:15], s24 offen offset:0 lds
M v[176:179], a[164:167], a[132:135], v[176:179]
ds_read_b64_tr_b16 a[76:77], v17 offset:16384
ds_read_b64_tr_b16 a[78:79], v17 offset:18432
M v[180:183], a[164:167], a[140:143], v[180:183]
M v[180:183], a[160:163], a[136:139], v[180:183]
M v[184:187], a[160:163], a[144:147], v[184:187]
M v[184:187], a[164:167], a[148:151], v[184:187]
buffer_load_dwordx4 v7, s[12:15], s24 offen offset:1024 lds
M v[188:191], a[164:167], a[156:159], v[188:191]
M v[188:191], a[160:163], a[152:155], v[188:191]
s_waitcnt lgkmcnt(12)
ds_read_b64_tr_b16 a[84:85], v18 offset:16384
ds_read_b64_tr_b16 a[86:87], v18 offset:18432
M v[192:195], a[168:171], a[96:99], v[192:195]
M v[192:195], a[172:175], a[100:103], v[192:195]
ds_read_b128 a[184:187], v10 offset:55296
ds_read_b128 a[188:191], v11 offset:55296
M v[196:199], a[172:175], a[108:111], v[196:199]
M v[196:199], a[168:171], a[104:107], v[196:199]
M v[200:203], a[168:171], a[112:115], v[200:203]
buffer_load_dwordx4 v8, s[12:15], s24 offen offset:2048 lds
M v[200:203], a[172:175], a[116:119], v[200:203]
ds_read_b64_tr_b16 a[92:93], v19 offset:16384
ds_read_b64_tr_b16 a[94:95], v19 offset:18432
M v[204:207], a[172:175], a[124:127], v[204:207]
M v[204:207], a[168:171], a[120:123], v[204:207]
M v[208:211], a[168:171], a[128:131], v[208:211]
M v[208:211], a[172:175], a[132:135], v[208:211]
buffer_load_dwordx4 v9, s[12:15], s24 offen offset:3072 lds
M v[212:215], a[172:175], a[140:143], v[212:215]
M v[212:215], a[168:171], a[136:139], v[212:215]
M v[216:219], a[168:171], a[144:147], v[216:219]
s_add_u32 s94, s93, 4096
buffer_store_dwordx4 a[236:239], v1, s[16:19], s94 offen offset:3072 sc1
M v[216:219], a[172:175], a[148:151], v[216:219]
M v[220:223], a[172:175], a[156:159], v[220:223]
M v[220:223], a[168:171], a[152:155], v[220:223]
s_waitcnt lgkmcnt(10)
M v[224:227], a[176:179], a[96:99], v[224:227]
s_add_u32 s24, s24, 262144
s_cmp_eq_u32 s24, s27
s_cselect_b32 s24, s28, s24
s_sub_u32 s6, s6, 1
s_cmp_eq_u32 s6, 0
s_cselect_b64 s[12:13], s[64:65], s[12:13]
M v[224:227], a[180:183], a[100:103], v[224:227]
M v[228:231], a[180:183], a[108:111], v[228:231]
M v[228:231], a[176:179], a[104:107], v[228:231]
M v[232:235], a[176:179], a[112:115], v[232:235]
M v[232:235], a[180:183], a[116:119], v[232:235]
M v[236:239], a[180:183], a[124:127], v[236:239]
M v[236:239], a[176:179], a[120:123], v[236:239]
s_waitcnt vmcnt(11) lgkmcnt(0)
s_barrier
ds_read_b128 a[160:163], v10 offset:0
ds_read_b128 a[164:167], v11 offset:0
M v[240:243], a[176:179], a[128:131], v[240:243]
s_add_u32 m0, s29, 32768
s_nop 0
buffer_load_dwordx4 v2, s[8:11], s23 offen offset:0 lds
M v[240:243], a[180:183], a[132:135], v[240:243]
M v[244:247], a[180:183], a[140:143], v[244:247]
M v[244:247], a[176:179], a[136:139], v[244:247]
M v[248:251], a[176:179], a[144:147], v[248:251]
M v[248:251], a[180:183], a[148:151], v[248:251]
buffer_load_dwordx4 v3, s[8:11], s23 offen offset:1024 lds
M v[252:255], a[180:183], a[156:159], v[252:255]
M v[252:255], a[176:179], a[152:155], v[252:255]
M a[0:3], a[184:187], a[96:99], a[0:3]
M a[0:3], a[188:191], a[100:103], a[0:3]
ds_read_b128 a[168:171], v10 offset:2048
ds_read_b128 a[172:175], v11 offset:2048
M a[4:7], a[188:191], a[108:111], a[4:7]
M a[4:7], a[184:187], a[104:107], a[4:7]
M a[8:11], a[184:187], a[112:115], a[8:11]
buffer_load_dwordx4 v4, s[8:11], s23 offen offset:2048 lds
M a[8:11], a[188:191], a[116:119], a[8:11]
M a[12:15], a[188:191], a[124:127], a[12:15]
M a[12:15], a[184:187], a[120:123], a[12:15]
M a[16:19], a[184:187], a[128:131], a[16:19]
M a[16:19], a[188:191], a[132:135], a[16:19]
buffer_load_dwordx4 v5, s[8:11], s23 offen offset:3072 lds
M a[20:23], a[188:191], a[140:143], a[20:23]
M a[20:23], a[184:187], a[136:139], a[20:23]
M a[24:27], a[184:187], a[144:147], a[24:27]
M a[24:27], a[188:191], a[148:151], a[24:27]
M a[28:31], a[188:191], a[156:159], a[28:31]
M a[28:31], a[184:187], a[152:155], a[28:31]
s_waitcnt lgkmcnt(2)
M v[32:35], a[160:163], a[32:35], v[32:35]
s_add_u32 m0, s29, 65536
s_nop 0
buffer_load_dwordx4 v6, s[12:15], s24 offen offset:0 lds
M v[32:35], a[164:167], a[36:39], v[32:35]
ds_read_b128 a[176:179], v10 offset:4096
ds_read_b128 a[180:183], v11 offset:4096
M v[36:39], a[164:167], a[44:47], v[36:39]
M v[36:39], a[160:163], a[40:43], v[36:39]
ds_read_b64_tr_b16 a[96:97], v12 offset:32768
ds_read_b64_tr_b16 a[98:99], v12 offset:34816
M v[40:43], a[160:163], a[48:51], v[40:43]
M v[40:43], a[164:167], a[52:55], v[40:43]
M v[44:47], a[164:167], a[60:63], v[44:47]
M v[44:47], a[160:163], a[56:59], v[44:47]
ds_read_b64_tr_b16 a[104:105], v13 offset:32768
ds_read_b64_tr_b16 a[106:107], v13 offset:34816
M v[48:51], a[160:163], a[64:67], v[48:51]
s_add_u32 s94, s93, 8192
buffer_store_dwordx4 a[240:243], v1, s[16:19], s94 offen offset:0 sc1
M v[48:51], a[164:167], a[68:71], v[48:51]
buffer_load_dwordx4 v7, s[12:15], s24 offen offset:1024 lds
M v[52:55], a[164:167], a[76:79], v[52:55]
M v[52:55], a[160:163], a[72:75], v[52:55]
ds_read_b64_tr_b16 a[112:113], v14 offset:32768
ds_read_b64_tr_b16 a[114:115], v14 offset:34816
M v[56:59], a[160:163], a[80:83], v[56:59]
M v[56:59], a[164:167], a[84:87], v[56:59]
M v[60:63], a[164:167], a[92:95], v[60:63]
M v[60:63], a[160:163], a[88:91], v[60:63]
s_waitcnt lgkmcnt(8)
ds_read_b64_tr_b16 a[120:121], v15 offset:32768
ds_read_b64_tr_b16 a[122:123], v15 offset:34816
M v[64:67], a[168:171], a[32:35], v[64:67]
buffer_load_dwordx4 v8, s[12:15], s24 offen offset:2048 lds
M v[64:67], a[172:175], a[36:39], v[64:67]
ds_read_b128 a[184:187], v10 offset:6144
ds_read_b128 a[188:191], v11 offset:6144
M v[68:71], a[172:175], a[44:47], v[68:71]
M v[68:71], a[168:171], a[40:43], v[68:71]
ds_read_b64_tr_b16 a[128:129], v16 offset:32768
ds_read_b64_tr_b16 a[130:131], v16 offset:34816
M v[72:75], a[168:171], a[48:51], v[72:75]
M v[72:75], a[172:175], a[52:55], v[72:75]
M v[76:79], a[172:175], a[60:63], v[76:79]
M v[76:79], a[168:171], a[56:59], v[76:79]
ds_read_b64_tr_b16 a[136:137], v17 offset:32768
ds_read_b64_tr_b16 a[138:139], v17 offset:34816
M v[80:83], a[168:171], a[64:67], v[80:83]
buffer_load_dwordx4 v9, s[12:15], s24 offen offset:3072 lds
M v[80:83], a[172:175], a[68:71], v[80:83]
M v[84:87], a[172:175], a[76:79], v[84:87]
M v[84:87], a[168:171], a[72:75], v[84:87]
ds_read_b64_tr_b16 a[144:145], v18 offset:32768
ds_read_b64_tr_b16 a[146:147], v18 offset:34816
M v[88:91], a[168:171], a[80:83], v[88:91]
M v[88:91], a[172:175], a[84:87], v[88:91]
M v[92:95], a[172:175], a[92:95], v[92:95]
s_add_u32 s24, s24, 262144
M v[92:95], a[168:171], a[88:91], v[92:95]
s_waitcnt lgkmcnt(15)
ds_read_b64_tr_b16 a[152:153], v19 offset:32768
ds_read_b64_tr_b16 a[154:155], v19 offset:34816
M v[96:99], a[176:179], a[32:35], v[96:99]
M v[96:99], a[180:183], a[36:39], v[96:99]
M v[100:103], a[180:183], a[44:47], v[100:103]
M v[100:103], a[176:179], a[40:43], v[100:103]
M v[104:107], a[176:179], a[48:51], v[104:107]
s_add_u32 s94, s93, 8192
buffer_store_dwordx4 a[244:247], v1, s[16:19], s94 offen offset:1024 sc1
M v[104:107], a[180:183], a[52:55], v[104:107]
M v[108:111], a[180:183], a[60:63], v[108:111]
M v[108:111], a[176:179], a[56:59], v[108:111]
s_waitcnt vmcnt(11) lgkmcnt(0)
s_barrier
ds_read_b128 a[160:163], v10 offset:16384
ds_read_b128 a[164:167], v11 offset:16384
M v[112:115], a[176:179], a[64:67], v[112:115]
s_add_u32 m0, s29, 49152
s_add_u32 s3, s23, s31
buffer_load_dwordx4 v2, s[8:11], s3 offen offset:0 lds
M v[112:115], a[180:183], a[68:71], v[112:115]
M v[116:119], a[180:183], a[76:79], v[116:119]
M v[116:119], a[176:179], a[72:75], v[116:119]
ds_read_b64_tr_b16 a[100:101], v12 offset:49152
ds_read_b64_tr_b16 a[102:103], v12 offset:51200
M v[120:123], a[176:179], a[80:83], v[120:123]
M v[120:123], a[180:183], a[84:87], v[120:123]
buffer_load_dwordx4 v3, s[8:11], s3 offen offset:1024 lds
M v[124:127], a[180:183], a[92:95], v[124:127]
M v[124:127], a[176:179], a[88:91], v[124:127]
M v[128:131], a[184:187], a[32:35], v[128:131]
M v[128:131], a[188:191], a[36:39], v[128:131]
ds_read_b128 a[168:171], v10 offset:18432
ds_read_b128 a[172:175], v11 offset:18432
ds_read_b64_tr_b16 a[108:109], v13 offset:49152
ds_read_b64_tr_b16 a[110:111], v13 offset:51200
M v[132:135], a[188:191], a[44:47], v[132:135]
M v[132:135], a[184:187], a[40:43], v[132:135]
M v[136:139], a[184:187], a[48:51], v[136:139]
buffer_load_dwordx4 v4, s[8:11], s3 offen offset:2048 lds
M v[136:139], a[188:191], a[52:55], v[136:139]
M v[140:143], a[188:191], a[60:63], v[140:143]
M v[140:143], a[184:187], a[56:59], v[140:143]
ds_read_b64_tr_b16 a[116:117], v14 offset:49152
ds_read_b64_tr_b16 a[118:119], v14 offset:51200
M v[144:147], a[184:187], a[64:67], v[144:147]
M v[144:147], a[188:191], a[68:71], v[144:147]
buffer_load_dwordx4 v5, s[8:11], s3 offen offset:3072 lds
M v[148:151], a[188:191], a[76:79], v[148:151]
M v[148:151], a[184:187], a[72:75], v[148:151]
M v[152:155], a[184:187], a[80:83], v[152:155]
M v[152:155], a[188:191], a[84:87], v[152:155]
ds_read_b64_tr_b16 a[124:125], v15 offset:49152
ds_read_b64_tr_b16 a[126:127], v15 offset:51200
M v[156:159], a[188:191], a[92:95], v[156:159]
M v[156:159], a[184:187], a[88:91], v[156:159]
s_waitcnt lgkmcnt(10)
M v[160:163], a[160:163], a[32:35], v[160:163]
s_add_u32 s94, s93, 8192
buffer_store_dwordx4 a[248:251], v1, s[16:19], s94 offen offset:2048 sc1
M v[160:163], a[164:167], a[36:39], v[160:163]
ds_read_b128 a[176:179], v10 offset:20480
ds_read_b128 a[180:183], v11 offset:20480
M v[164:167], a[164:167], a[44:47], v[164:167]
s_add_u32 s23, s23, 128
s_cmp_eq_u32 s23, s25
s_cselect_b32 s23, s26, s23
M v[164:167], a[160:163], a[40:43], v[164:167]
ds_read_b64_tr_b16 a[132:133], v16 offset:49152
ds_read_b64_tr_b16 a[134:135], v16 offset:51200
M v[168:171], a[160:163], a[48:51], v[168:171]
M v[168:171], a[164:167], a[52:55], v[168:171]
M v[172:175], a[164:167], a[60:63], v[172:175]
M v[172:175], a[160:163], a[56:59], v[172:175]
M v[176:179], a[160:163], a[64:67], v[176:179]
s_add_u32 m0, s29, 81920
s_nop 0
buffer_load_dwordx4 v6, s[12:15], s24 offen offset:0 lds
M v[176:179], a[164:167], a[68:71], v[176:179]
ds_read_b64_tr_b16 a[140:141], v17 offset:49152
ds_read_b64_tr_b16 a[142:143], v17 offset:51200
M v[180:183], a[164:167], a[76:79], v[180:183]
M v[180:183], a[160:163], a[72:75], v[180:183]
M v[184:187], a[160:163], a[80:83], v[184:187]
M v[184:187], a[164:167], a[84:87], v[184:187]
buffer_load_dwordx4 v7, s[12:15], s24 offen offset:1024 lds
M v[188:191], a[164:167], a[92:95], v[188:191]
M v[188:191], a[160:163], a[88:91], v[188:191]
s_waitcnt lgkmcnt(12)
ds_read_b64_tr_b16 a[148:149], v18 offset:49152
ds_read_b64_tr_b16 a[150:151], v18 offset:51200
M v[192:195], a[168:171], a[32:35], v[192:195]
M v[192:195], a[172:175], a[36:39], v[192:195]
ds_read_b128 a[184:187], v10 offset:22528
ds_read_b128 a[188:191], v11 offset:22528
M v[196:199], a[172:175], a[44:47], v[196:199]
M v[196:199], a[168:171], a[40:43], v[196:199]
M v[200:203], a[168:171], a[48:51], v[200:203]
buffer_load_dwordx4 v8, s[12:15], s24 offen offset:2048 lds
M v[200:203], a[172:175], a[52:55], v[200:203]
ds_read_b64_tr_b16 a[156:157], v19 offset:49152
ds_read_b64_tr_b16 a[158:159], v19 offset:51200
M v[204:207], a[172:175], a[60:63], v[204:207]
M v[204:207], a[168:171], a[56:59], v[204:207]
M v[208:211], a[168:171], a[64:67], v[208:211]
M v[208:211], a[172:175], a[68:71], v[208:211]
buffer_load_dwordx4 v9, s[12:15], s24 offen offset:3072 lds
M v[212:215], a[172:175], a[76:79], v[212:215]
M v[212:215], a[168:171], a[72:75], v[212:215]
M v[216:219], a[168:171], a[80:83], v[216:219]
s_add_u32 s94, s93, 8192
buffer_store_dwordx4 a[252:255], v1, s[16:19], s94 offen offset:3072 sc1
M v[216:219], a[172:175], a[84:87], v[216:219]
M v[220:223], a[172:175], a[92:95], v[220:223]
M v[220:223], a[168:171], a[88:91], v[220:223]
s_waitcnt lgkmcnt(10)
M v[224:227], a[176:179], a[32:35], v[224:227]
s_add_u32 s24, s24, 262144
s_cmp_eq_u32 s24, s27
s_cselect_b32 s24, s28, s24
s_sub_u32 s6, s6, 1
s_cmp_eq_u32 s6, 0
s_cselect_b64 s[12:13], s[64:65], s[12:13]
M v[224:227], a[180:183], a[36:39], v[224:227]
M v[228:231], a[180:183], a[44:47], v[228:231]
M v[228:231], a[176:179], a[40:43], v[228:231]
M v[232:235], a[176:179], a[48:51], v[232:235]
M v[232:235], a[180:183], a[52:55], v[232:235]
M v[236:239], a[180:183], a[60:63], v[236:239]
M v[236:239], a[176:179], a[56:59], v[236:239]
s_waitcnt vmcnt(11) lgkmcnt(0)
s_barrier
ds_read_b128 a[160:163], v10 offset:32768
ds_read_b128 a[164:167], v11 offset:32768
M v[240:243], a[176:179], a[64:67], v[240:243]
s_add_u32 m0, s29, 0
s_nop 0
buffer_load_dwordx4 v2, s[8:11], s23 offen offset:0 lds
M v[240:243], a[180:183], a[68:71], v[240:243]
M v[244:247], a[180:183], a[76:79], v[244:247]
M v[244:247], a[176:179], a[72:75], v[244:247]
M v[248:251], a[176:179], a[80:83], v[248:251]
M v[248:251], a[180:183], a[84:87], v[248:251]
buffer_load_dwordx4 v3, s[8:11], s23 offen offset:1024 lds
M v[252:255], a[180:183], a[92:95], v[252:255]
M v[252:255], a[176:179], a[88:91], v[252:255]
M a[0:3], a[184:187], a[32:35], a[0:3]
M a[0:3], a[188:191], a[36:39], a[0:3]
ds_read_b128 a[168:171], v10 offset:34816
ds_read_b128 a[172:175], v11 offset:34816
M a[4:7], a[188:191], a[44:47], a[4:7]
M a[4:7], a[184:187], a[40:43], a[4:7]
M a[8:11], a[184:187], a[48:51], a[8:11]
buffer_load_dwordx4 v4, s[8:11], s23 offen offset:2048 lds
M a[8:11], a[188:191], a[52:55], a[8:11]
M a[12:15], a[188:191], a[60:63], a[12:15]
M a[12:15], a[184:187], a[56:59], a[12:15]
M a[16:19], a[184:187], a[64:67], a[16:19]
M a[16:19], a[188:191], a[68:71], a[16:19]
buffer_load_dwordx4 v5, s[8:11], s23 offen offset:3072 lds
M a[20:23], a[188:191], a[76:79], a[20:23]
M a[20:23], a[184:187], a[72:75], a[20:23]
M a[24:27], a[184:187], a[80:83], a[24:27]
M a[24:27], a[188:191], a[84:87], a[24:27]
M a[28:31], a[188:191], a[92:95], a[28:31]
M a[28:31], a[184:187], a[88:91], a[28:31]
s_waitcnt lgkmcnt(2)
M v[32:35], a[160:163], a[96:99], v[32:35]
s_add_u32 m0, s29, 98304
s_nop 0
buffer_load_dwordx4 v6, s[12:15], s24 offen offset:0 lds
M v[32:35], a[164:167], a[100:103], v[32:35]
ds_read_b128 a[176:179], v10 offset:36864
ds_read_b128 a[180:183], v11 offset:36864
M v[36:39], a[164:167], a[108:111], v[36:39]
M v[36:39], a[160:163], a[104:107], v[36:39]
ds_read_b64_tr_b16 a[32:33], v12 offset:0
ds_read_b64_tr_b16 a[34:35], v12 offset:2048
M v[40:43], a[160:163], a[112:115], v[40:43]
M v[40:43], a[164:167], a[116:119], v[40:43]
M v[44:47], a[164:167], a[124:127], v[44:47]
M v[44:47], a[160:163], a[120:123], v[44:47]
ds_read_b64_tr_b16 a[40:41], v13 offset:0
ds_read_b64_tr_b16 a[42:43], v13 offset:2048
M v[48:51], a[160:163], a[128:131], v[48:51]
buffer_load_dwordx4 v7, s[12:15], s24 offen offset:1024 lds
M v[48:51], a[164:167], a[132:135], v[48:51]
M v[52:55], a[164:167], a[140:143], v[52:55]
M v[52:55], a[160:163], a[136:139], v[52:55]
ds_read_b64_tr_b16 a[48:49], v14 offset:0
ds_read_b64_tr_b16 a[50:51], v14 offset:2048
M v[56:59], a[160:163], a[144:147], v[56:59]
M v[56:59], a[164:167], a[148:151], v[56:59]
M v[60:63], a[164:167], a[156:159], v[60:63]
buffer_load_dwordx4 v8, s[12:15], s24 offen offset:2048 lds
M v[60:63], a[160:163], a[152:155], v[60:63]
s_waitcnt lgkmcnt(8)
ds_read_b64_tr_b16 a[56:57], v15 offset:0
ds_read_b64_tr_b16 a[58:59], v15 offset:2048
M v[64:67], a[168:171], a[96:99], v[64:67]
M v[64:67], a[172:175], a[100:103], v[64:67]
ds_read_b128 a[184:187], v10 offset:38912
ds_read_b128 a[188:191], v11 offset:38912
M v[68:71], a[172:175], a[108:111], v[68:71]
M v[68:71], a[168:171], a[104:107], v[68:71]
ds_read_b64_tr_b16 a[64:65], v16 offset:0
ds_read_b64_tr_b16 a[66:67], v16 offset:2048
M v[72:75], a[168:171], a[112:115], v[72:75]
M v[72:75], a[172:175], a[116:119], v[72:75]
M v[76:79], a[172:175], a[124:127], v[76:79]
M v[76:79], a[168:171], a[120:123], v[76:79]
ds_read_b64_tr_b16 a[72:73], v17 offset:0
ds_read_b64_tr_b16 a[74:75], v17 offset:2048
M v[80:83], a[168:171], a[128:131], v[80:83]
buffer_load_dwordx4 v9, s[12:15], s24 offen offset:3072 lds
M v[80:83], a[172:175], a[132:135], v[80:83]
M v[84:87], a[172:175], a[140:143], v[84:87]
M v[84:87], a[168:171], a[136:139], v[84:87]
ds_read_b64_tr_b16 a[80:81], v18 offset:0
ds_read_b64_tr_b16 a[82:83], v18 offset:2048
M v[88:91], a[168:171], a[144:147], v[88:91]
M v[88:91], a[172:175], a[148:151], v[88:91]
M v[92:95], a[172:175], a[156:159], v[92:95]
s_add_u32 s24, s24, 262144
M v[92:95], a[168:171], a[152:155], v[92:95]
s_waitcnt lgkmcnt(15)
ds_read_b64_tr_b16 a[88:89], v19 offset:0
ds_read_b64_tr_b16 a[90:91], v19 offset:2048
M v[96:99], a[176:179], a[96:99], v[96:99]
M v[96:99], a[180:183], a[100:103], v[96:99]
M v[100:103], a[180:183], a[108:111], v[100:103]
M v[100:103], a[176:179], a[104:107], v[100:103]
M v[104:107], a[176:179], a[112:115], v[104:107]
M v[104:107], a[180:183], a[116:119], v[104:107]
M v[108:111], a[180:183], a[124:127], v[108:111]
M v[108:111], a[176:179], a[120:123], v[108:111]
s_waitcnt vmcnt(9) lgkmcnt(0)
s_barrier
ds_read_b128 a[160:163], v10 offset:49152
ds_read_b128 a[164:167], v11 offset:49152
M v[112:115], a[176:179], a[128:131], v[112:115]
s_add_u32 m0, s29, 16384
s_add_u32 s3, s23, s31
buffer_load_dwordx4 v2, s[8:11], s3 offen offset:0 lds
M v[112:115], a[180:183], a[132:135], v[112:115]
M v[116:119], a[180:183], a[140:143], v[116:119]
M v[116:119], a[176:179], a[136:139], v[116:119]
ds_read_b64_tr_b16 a[36:37], v12 offset:16384
ds_read_b64_tr_b16 a[38:39], v12 offset:18432
M v[120:123], a[176:179], a[144:147], v[120:123]
M v[120:123], a[180:183], a[148:151], v[120:123]
buffer_load_dwordx4 v3, s[8:11], s3 offen offset:1024 lds
M v[124:127], a[180:183], a[156:159], v[124:127]
M v[124:127], a[176:179], a[152:155], v[124:127]
M v[128:131], a[184:187], a[96:99], v[128:131]
M v[128:131], a[188:191], a[100:103], v[128:131]
ds_read_b128 a[168:171], v10 offset:51200
ds_read_b128 a[172:175], v11 offset:51200
ds_read_b64_tr_b16 a[44:45], v13 offset:16384
ds_read_b64_tr_b16 a[46:47], v13 offset:18432
M v[132:135], a[188:191], a[108:111], v[132:135]
M v[132:135], a[184:187], a[104:107], v[132:135]
M v[136:139], a[184:187], a[112:115], v[136:139]
buffer_load_dwordx4 v4, s[8:11], s3 offen offset:2048 lds
M v[136:139], a[188:191], a[116:119], v[136:139]
M v[140:143], a[188:191], a[124:127], v[140:143]
M v[140:143], a[184:187], a[120:123], v[140:143]
ds_read_b64_tr_b16 a[52:53], v14 offset:16384
ds_read_b64_tr_b16 a[54:55], v14 offset:18432
M v[144:147], a[184:187], a[128:131], v[144:147]
M v[144:147], a[188:191], a[132:135], v[144:147]
M v[148:151], a[188:191], a[140:143], v[148:151]
buffer_load_dwordx4 v5, s[8:11], s3 offen offset:3072 lds
M v[148:151], a[184:187], a[136:139], v[148:151]
M v[152:155], a[184:187], a[144:147], v[152:155]
M v[152:155], a[188:191], a[148:151], v[152:155]
ds_read_b64_tr_b16 a[60:61], v15 offset:16384
ds_read_b64_tr_b16 a[62:63], v15 offset:18432
M v[156:159], a[188:191], a[156:159], v[156:159]
M v[156:159], a[184:187], a[152:155], v[156:159]
s_waitcnt lgkmcnt(10)
M v[160:163], a[160:163], a[96:99], v[160:163]
s_add_u32 s23, s23, 128
s_cmp_eq_u32 s23, s25
s_cselect_b32 s23, s26, s23
M v[160:163], a[164:167], a[100:103], v[160:163]
ds_read_b128 a[176:179], v10 offset:53248
ds_read_b128 a[180:183], v11 offset:53248
M v[164:167], a[164:167], a[108:111], v[164:167]
M v[164:167], a[160:163], a[104:107], v[164:167]
ds_read_b64_tr_b16 a[68:69], v16 offset:16384
ds_read_b64_tr_b16 a[70:71], v16 offset:18432
M v[168:171], a[160:163], a[112:115], v[168:171]
M v[168:171], a[164:167], a[116:119], v[168:171]
M v[172:175], a[164:167], a[124:127], v[172:175]
M v[172:175], a[160:163], a[120:123], v[172:175]
s_add_u32 m0, s29, 114688
s_nop 0
buffer_load_dwordx4 v6, s[12:15], s24 offen offset:0 lds
M v[176:179], a[160:163], a[128:131], v[176:179]
M v[176:179], a[164:167], a[132:135], v[176:179]
ds_read_b64_tr_b16 a[76:77], v17 offset:16384
ds_read_b64_tr_b16 a[78:79], v17 offset:18432
M v[180:183], a[164:167], a[140:143], v[180:183]
M v[180:183], a[160:163], a[136:139], v[180:183]
M v[184:187], a[160:163], a[144:147], v[184:187]
M v[184:187], a[164:167], a[148:151], v[184:187]
buffer_load_dwordx4 v7, s[12:15], s24 offen offset:1024 lds
M v[188:191], a[164:167], a[156:159], v[188:191]
M v[188:191], a[160:163], a[152:155], v[188:191]
s_waitcnt lgkmcnt(12)
ds_read_b64_tr_b16 a[84:85], v18 offset:16384
ds_read_b64_tr_b16 a[86:87], v18 offset:18432
M v[192:195], a[168:171], a[96:99], v[192:195]
M v[192:195], a[172:175], a[100:103], v[192:195]
ds_read_b128 a[184:187], v10 offset:55296
ds_read_b128 a[188:191], v11 offset:55296
M v[196:199], a[172:175], a[108:111], v[196:199]
M v[196:199], a[168:171], a[104:107], v[196:199]
buffer_load_dwordx4 v8, s[12:15], s24 offen offset:2048 lds
M v[200:203], a[168:171], a[112:115], v[200:203]
M v[200:203], a[172:175], a[116:119], v[200:203]
ds_read_b64_tr_b16 a[92:93], v19 offset:16384
ds_read_b64_tr_b16 a[94:95], v19 offset:18432
M v[204:207], a[172:175], a[124:127], v[204:207]
M v[204:207], a[168:171], a[120:123], v[204:207]
M v[208:211], a[168:171], a[128:131], v[208:211]
M v[208:211], a[172:175], a[132:135], v[208:211]
buffer_load_dwordx4 v9, s[12:15], s24 offen offset:3072 lds
M v[212:215], a[172:175], a[140:143], v[212:215]
s_getpc_b64 s[56:57]
Lpcc1:
s_add_u32 s56, s56, Lk1_b-Lpcc1
s_addc_u32 s57, s57, 0
s_lshr_b32 s58, s2, 3
s_lshl2_add_u32 s58, s58, s101
s_mul_i32 s58, s58, (((Lc2-Lk1_b)/128+127)&~127)
v_lshlrev_b32 v22, 7, v0
v_min_u32 v22, (((Lc2-Lk1_b)/128+127)&~127)-128, v22
v_add_u32 v22, s58, v22
v_min_u32 v22, Lc2-Lk1_b-4, v22
global_load_dword a255, v22, s[56:57]
M v[212:215], a[168:171], a[136:139], v[212:215]
M v[216:219], a[168:171], a[144:147], v[216:219]
M v[216:219], a[172:175], a[148:151], v[216:219]
M v[220:223], a[172:175], a[156:159], v[220:223]
M v[220:223], a[168:171], a[152:155], v[220:223]
s_waitcnt lgkmcnt(10)
M v[224:227], a[176:179], a[96:99], v[224:227]
s_add_u32 s24, s24, 262144
s_cmp_eq_u32 s24, s27
s_cselect_b32 s24, s28, s24
s_sub_u32 s6, s6, 1
s_cmp_eq_u32 s6, 0
s_cselect_b64 s[12:13], s[64:65], s[12:13]
M v[224:227], a[180:183], a[100:103], v[224:227]
M v[228:231], a[180:183], a[108:111], v[228:231]
M v[228:231], a[176:179], a[104:107], v[228:231]
M v[232:235], a[176:179], a[112:115], v[232:235]
M v[232:235], a[180:183], a[116:119], v[232:235]
M v[236:239], a[180:183], a[124:127], v[236:239]
M v[236:239], a[176:179], a[120:123], v[236:239]
s_waitcnt vmcnt(9) lgkmcnt(0)
s_barrier
ds_read_b128 a[160:163], v10 offset:0
ds_read_b128 a[164:167], v11 offset:0
M v[240:243], a[176:179], a[128:131], v[240:243]
s_add_u32 m0, s29, 32768
s_nop 0
buffer_load_dwordx4 v2, s[8:11], s23 offen offset:0 lds
M v[240:243], a[180:183], a[132:135], v[240:243]
M v[244:247], a[180:183], a[140:143], v[244:247]
M v[244:247], a[176:179], a[136:139], v[244:247]
M v[248:251], a[176:179], a[144:147], v[248:251]
M v[248:251], a[180:183], a[148:151], v[248:251]
M v[252:255], a[180:183], a[156:159], v[252:255]
M v[252:255], a[176:179], a[152:155], v[252:255]
M a[0:3], a[184:187], a[96:99], a[0:3]
M a[0:3], a[188:191], a[100:103], a[0:3]
ds_read_b128 a[168:171], v10 offset:2048
ds_read_b128 a[172:175], v11 offset:2048
M a[4:7], a[188:191], a[108:111], a[4:7]
M a[4:7], a[184:187], a[104:107], a[4:7]
M a[8:11], a[184:187], a[112:115], a[8:11]
buffer_load_dwordx4 v3, s[8:11], s23 offen offset:1024 lds
M a[8:11], a[188:191], a[116:119], a[8:11]
M a[12:15], a[188:191], a[124:127], a[12:15]
M a[12:15], a[184:187], a[120:123], a[12:15]
M a[16:19], a[184:187], a[128:131], a[16:19]
M a[16:19], a[188:191], a[132:135], a[16:19]
M a[20:23], a[188:191], a[140:143], a[20:23]
M a[20:23], a[184:187], a[136:139], a[20:23]
M a[24:27], a[184:187], a[144:147], a[24:27]
M a[24:27], a[188:191], a[148:151], a[24:27]
M a[28:31], a[188:191], a[156:159], a[28:31]
M a[28:31], a[184:187], a[152:155], a[28:31]
s_waitcnt lgkmcnt(2)
M v[32:35], a[160:163], a[32:35], v[32:35]
buffer_load_dwordx4 v4, s[8:11], s23 offen offset:2048 lds
M v[32:35], a[164:167], a[36:39], v[32:35]
ds_read_b128 a[176:179], v10 offset:4096
ds_read_b128 a[180:183], v11 offset:4096
M v[36:39], a[164:167], a[44:47], v[36:39]
M v[36:39], a[160:163], a[40:43], v[36:39]
ds_read_b64_tr_b16 a[96:97], v12 offset:32768
ds_read_b64_tr_b16 a[98:99], v12 offset:34816
M v[40:43], a[160:163], a[48:51], v[40:43]
M v[40:43], a[164:167], a[52:55], v[40:43]
M v[44:47], a[164:167], a[60:63], v[44:47]
M v[44:47], a[160:163], a[56:59], v[44:47]
ds_read_b64_tr_b16 a[104:105], v13 offset:32768
ds_read_b64_tr_b16 a[106:107], v13 offset:34816
M v[48:51], a[160:163], a[64:67], v[48:51]
M v[48:51], a[164:167], a[68:71], v[48:51]
M v[52:55], a[164:167], a[76:79], v[52:55]
M v[52:55], a[160:163], a[72:75], v[52:55]
ds_read_b64_tr_b16 a[112:113], v14 offset:32768
ds_read_b64_tr_b16 a[114:115], v14 offset:34816
M v[56:59], a[160:163], a[80:83], v[56:59]
M v[56:59], a[164:167], a[84:87], v[56:59]
M v[60:63], a[164:167], a[92:95], v[60:63]
M v[60:63], a[160:163], a[88:91], v[60:63]
s_waitcnt lgkmcnt(8)
ds_read_b64_tr_b16 a[120:121], v15 offset:32768
ds_read_b64_tr_b16 a[122:123], v15 offset:34816
M v[64:67], a[168:171], a[32:35], v[64:67]
M v[64:67], a[172:175], a[36:39], v[64:67]
ds_read_b128 a[184:187], v10 offset:6144
ds_read_b128 a[188:191], v11 offset:6144
M v[68:71], a[172:175], a[44:47], v[68:71]
M v[68:71], a[168:171], a[40:43], v[68:71]
ds_read_b64_tr_b16 a[128:129], v16 offset:32768
ds_read_b64_tr_b16 a[130:131], v16 offset:34816
M v[72:75], a[168:171], a[48:51], v[72:75]
buffer_load_dwordx4 v5, s[8:11], s23 offen offset:3072 lds
M v[72:75], a[172:175], a[52:55], v[72:75]
M v[76:79], a[172:175], a[60:63], v[76:79]
M v[76:79], a[168:171], a[56:59], v[76:79]
ds_read_b64_tr_b16 a[136:137], v17 offset:32768
ds_read_b64_tr_b16 a[138:139], v17 offset:34816
M v[80:83], a[168:171], a[64:67], v[80:83]
M v[80:83], a[172:175], a[68:71], v[80:83]
M v[84:87], a[172:175], a[76:79], v[84:87]
M v[84:87], a[168:171], a[72:75], v[84:87]
ds_read_b64_tr_b16 a[144:145], v18 offset:32768
ds_read_b64_tr_b16 a[146:147], v18 offset:34816
M v[88:91], a[168:171], a[80:83], v[88:91]
M v[88:91], a[172:175], a[84:87], v[88:91]
M v[92:95], a[172:175], a[92:95], v[92:95]
M v[92:95], a[168:171], a[88:91], v[92:95]
s_waitcnt lgkmcnt(15)
ds_read_b64_tr_b16 a[152:153], v19 offset:32768
ds_read_b64_tr_b16 a[154:155], v19 offset:34816
M v[96:99], a[176:179], a[32:35], v[96:99]
M v[96:99], a[180:183], a[36:39], v[96:99]
M v[100:103], a[180:183], a[44:47], v[100:103]
M v[100:103], a[176:179], a[40:43], v[100:103]
M v[104:107], a[176:179], a[48:51], v[104:107]
M v[104:107], a[180:183], a[52:55], v[104:107]
M v[108:111], a[180:183], a[60:63], v[108:111]
M v[108:111], a[176:179], a[56:59], v[108:111]
s_waitcnt vmcnt(5) lgkmcnt(0)
s_barrier
ds_read_b128 a[160:163], v10 offset:16384
ds_read_b128 a[164:167], v11 offset:16384
M v[112:115], a[176:179], a[64:67], v[112:115]
s_add_u32 m0, s29, 49152
s_add_u32 s3, s23, s31
buffer_load_dwordx4 v2, s[8:11], s3 offen offset:0 lds
M v[112:115], a[180:183], a[68:71], v[112:115]
M v[116:119], a[180:183], a[76:79], v[116:119]
buffer_load_dwordx4 v3, s[8:11], s3 offen offset:1024 lds
M v[116:119], a[176:179], a[72:75], v[116:119]
ds_read_b64_tr_b16 a[100:101], v12 offset:49152
ds_read_b64_tr_b16 a[102:103], v12 offset:51200
M v[120:123], a[176:179], a[80:83], v[120:123]
buffer_load_dwordx4 v4, s[8:11], s3 offen offset:2048 lds
M v[120:123], a[180:183], a[84:87], v[120:123]
M v[124:127], a[180:183], a[92:95], v[124:127]
buffer_load_dwordx4 v5, s[8:11], s3 offen offset:3072 lds
M v[124:127], a[176:179], a[88:91], v[124:127]
M v[128:131], a[184:187], a[32:35], v[128:131]
M v[128:131], a[188:191], a[36:39], v[128:131]
ds_read_b128 a[168:171], v10 offset:18432
ds_read_b128 a[172:175], v11 offset:18432
ds_read_b64_tr_b16 a[108:109], v13 offset:49152
ds_read_b64_tr_b16 a[110:111], v13 offset:51200
M v[132:135], a[188:191], a[44:47], v[132:135]
M v[132:135], a[184:187], a[40:43], v[132:135]
M v[136:139], a[184:187], a[48:51], v[136:139]
s_and_b32 s3, s2, 1
s_lshl_b32 s3, s3, 3
s_bfe_u32 s4, s2, 0x30003
M v[136:139], a[188:191], a[52:55], v[136:139]
s_add_u32 s26, s3, s4
s_bfe_u32 s3, s2, 0x20001
s_lshl_b32 s3, s3, 2
M v[140:143], a[188:191], a[60:63], v[140:143]
s_lshr_b32 s4, s2, 6
s_xor_b32 s4, s4, 3
s_add_u32 s27, s3, s4
M v[140:143], a[184:187], a[56:59], v[140:143]
ds_read_b64_tr_b16 a[116:117], v14 offset:49152
ds_read_b64_tr_b16 a[118:119], v14 offset:51200
s_lshl_b32 s23, s26, 18
s_sub_u32 s24, s23, 32768
s_max_i32 s24, s24, 0
M v[144:147], a[184:187], a[64:67], v[144:147]
s_lshl_b32 s25, s27, 7
s_mov_b64 s[8:9], s[44:45]
s_mov_b32 s10, 4194304
M v[144:147], a[188:191], a[68:71], v[144:147]
s_mov_b64 s[12:13], s[46:47]
s_mov_b32 s14, 6291456
s_mov_b64 s[36:37], s[90:91]
M v[148:151], a[188:191], a[76:79], v[148:151]
s_mov_b32 s38, 256
s_mov_b32 s39, 0x00020000
s_lshl_b32 s28, s20, 9
M v[148:151], a[184:187], a[72:75], v[148:151]
s_mul_i32 s30, s20, 6144
s_lshl_b32 s3, s20, 5
v_lshrrev_b32 v24, 3, v0
M v[152:155], a[184:187], a[80:83], v[152:155]
v_and_b32 v25, 7, v0
v_add_u32 v28, s3, v24
v_add_u32 v26, 0, v28
M v[152:155], a[188:191], a[84:87], v[152:155]
ds_read_b64_tr_b16 a[124:125], v15 offset:49152
ds_read_b64_tr_b16 a[126:127], v15 offset:51200
v_bfe_u32 v27, v26, 1, 3
v_xor_b32 v27, v27, v25
v_lshlrev_b32 v26, 11, v26
M v[156:159], a[188:191], a[92:95], v[156:159]
v_lshl_add_u32 v26, v27, 4, v26
v_subrev_u32 v2, 0, v26
v_add_u32 v26, 8, v28
M v[156:159], a[184:187], a[88:91], v[156:159]
s_waitcnt lgkmcnt(10)
v_bfe_u32 v27, v26, 1, 3
v_xor_b32 v27, v27, v25
v_lshlrev_b32 v26, 11, v26
M v[160:163], a[160:163], a[32:35], v[160:163]
v_lshl_add_u32 v26, v27, 4, v26
v_subrev_u32 v3, 1024, v26
v_add_u32 v26, 16, v28
M v[160:163], a[164:167], a[36:39], v[160:163]
ds_read_b128 a[176:179], v10 offset:20480
ds_read_b128 a[180:183], v11 offset:20480
v_bfe_u32 v27, v26, 1, 3
v_xor_b32 v27, v27, v25
v_lshlrev_b32 v26, 11, v26
M v[164:167], a[164:167], a[44:47], v[164:167]
v_lshl_add_u32 v26, v27, 4, v26
v_subrev_u32 v4, 2048, v26
v_add_u32 v26, 24, v28
M v[164:167], a[160:163], a[40:43], v[164:167]
ds_read_b64_tr_b16 a[132:133], v16 offset:49152
ds_read_b64_tr_b16 a[134:135], v16 offset:51200
v_bfe_u32 v27, v26, 1, 3
v_xor_b32 v27, v27, v25
v_lshlrev_b32 v26, 11, v26
M v[168:171], a[160:163], a[48:51], v[168:171]
v_lshl_add_u32 v26, v27, 4, v26
v_subrev_u32 v5, 3072, v26
s_lshl_b32 s3, s20, 2
M v[168:171], a[164:167], a[52:55], v[168:171]
v_lshrrev_b32 v26, 5, v0
v_add_u32 v26, s3, v26
v_bfe_u32 v29, v0, 2, 3
M v[172:175], a[164:167], a[60:63], v[172:175]
v_bfe_u32 v27, v26, 1, 3
v_xor_b32 v27, v27, v29
v_lshlrev_b32 v27, 4, v27
M v[172:175], a[160:163], a[56:59], v[172:175]
v_and_b32 v30, 3, v0
v_lshl_add_u32 v27, v30, 2, v27
v_lshl_add_u32 v20, v26, 11, v27
M v[176:179], a[160:163], a[64:67], v[176:179]
v_add_u32 v26, 2, v26
v_bfe_u32 v27, v26, 1, 3
v_xor_b32 v27, v27, v29
M v[176:179], a[164:167], a[68:71], v[176:179]
ds_read_b64_tr_b16 a[140:141], v17 offset:49152
ds_read_b64_tr_b16 a[142:143], v17 offset:51200
v_lshlrev_b32 v27, 4, v27
v_and_b32 v30, 3, v0
v_lshl_add_u32 v27, v30, 2, v27
M v[180:183], a[164:167], a[76:79], v[180:183]
v_lshl_add_u32 v23, v26, 11, v27
v_subrev_u32 v23, 256, v23
s_mul_i32 s3, s20, 48
M v[180:183], a[160:163], a[72:75], v[180:183]
v_add_u32 v28, s3, v24
v_add_u32 v26, 0, v28
v_mul_u32_u24 v27, 0xaaab, v26
M v[184:187], a[160:163], a[80:83], v[184:187]
v_lshrrev_b32 v27, 17, v27
v_lshrrev_b32 v29, 1, v27
v_and_b32 v29, 4, v29
M v[184:187], a[164:167], a[84:87], v[184:187]
v_and_or_b32 v27, v27, 2, v29
v_xor_b32 v27, v27, v25
v_lshlrev_b32 v26, 11, v26
M v[188:191], a[164:167], a[92:95], v[188:191]
v_lshl_add_u32 v26, v27, 4, v26
v_subrev_u32 v6, 0, v26
v_add_u32 v26, 8, v28
M v[188:191], a[160:163], a[88:91], v[188:191]
s_waitcnt lgkmcnt(12)
ds_read_b64_tr_b16 a[148:149], v18 offset:49152
ds_read_b64_tr_b16 a[150:151], v18 offset:51200
v_mul_u32_u24 v27, 0xaaab, v26
v_lshrrev_b32 v27, 17, v27
v_lshrrev_b32 v29, 1, v27
M v[192:195], a[168:171], a[32:35], v[192:195]
v_and_b32 v29, 4, v29
v_and_or_b32 v27, v27, 2, v29
v_xor_b32 v27, v27, v25
M v[192:195], a[172:175], a[36:39], v[192:195]
ds_read_b128 a[184:187], v10 offset:22528
ds_read_b128 a[188:191], v11 offset:22528
v_lshlrev_b32 v26, 11, v26
v_lshl_add_u32 v26, v27, 4, v26
v_subrev_u32 v7, 1024, v26
M v[196:199], a[172:175], a[44:47], v[196:199]
v_add_u32 v26, 16, v28
v_mul_u32_u24 v27, 0xaaab, v26
v_lshrrev_b32 v27, 17, v27
M v[196:199], a[168:171], a[40:43], v[196:199]
v_lshrrev_b32 v29, 1, v27
v_and_b32 v29, 4, v29
v_and_or_b32 v27, v27, 2, v29
M v[200:203], a[168:171], a[48:51], v[200:203]
v_xor_b32 v27, v27, v25
v_lshlrev_b32 v26, 11, v26
v_lshl_add_u32 v26, v27, 4, v26
M v[200:203], a[172:175], a[52:55], v[200:203]
ds_read_b64_tr_b16 a[156:157], v19 offset:49152
ds_read_b64_tr_b16 a[158:159], v19 offset:51200
v_subrev_u32 v8, 2048, v26
v_add_u32 v26, 24, v28
v_mul_u32_u24 v27, 0xaaab, v26
M v[204:207], a[172:175], a[60:63], v[204:207]
v_lshrrev_b32 v27, 17, v27
v_lshrrev_b32 v29, 1, v27
v_and_b32 v29, 4, v29
M v[204:207], a[168:171], a[56:59], v[204:207]
v_and_or_b32 v27, v27, 2, v29
v_xor_b32 v27, v27, v25
v_lshlrev_b32 v26, 11, v26
M v[208:211], a[168:171], a[64:67], v[208:211]
v_lshl_add_u32 v26, v27, 4, v26
v_subrev_u32 v9, 3072, v26
v_add_u32 v26, 32, v28
M v[208:211], a[172:175], a[68:71], v[208:211]
v_mul_u32_u24 v27, 0xaaab, v26
v_lshrrev_b32 v27, 17, v27
v_lshrrev_b32 v29, 1, v27
M v[212:215], a[172:175], a[76:79], v[212:215]
v_and_b32 v29, 4, v29
v_and_or_b32 v27, v27, 2, v29
v_xor_b32 v27, v27, v25
M v[212:215], a[168:171], a[72:75], v[212:215]
v_lshlrev_b32 v26, 11, v26
v_lshl_add_u32 v26, v27, 4, v26
v_subrev_u32 v21, 0, v26
M v[216:219], a[168:171], a[80:83], v[216:219]
v_add_u32 v26, 40, v28
v_mul_u32_u24 v27, 0xaaab, v26
v_lshrrev_b32 v27, 17, v27
M v[216:219], a[172:175], a[84:87], v[216:219]
v_lshrrev_b32 v29, 1, v27
v_and_b32 v29, 4, v29
v_and_or_b32 v27, v27, 2, v29
M v[220:223], a[172:175], a[92:95], v[220:223]
v_xor_b32 v27, v27, v25
v_lshlrev_b32 v26, 11, v26
v_lshl_add_u32 v26, v27, 4, v26
M v[220:223], a[168:171], a[88:91], v[220:223]
s_waitcnt lgkmcnt(10)
v_subrev_u32 v22, 1024, v26
s_lshr_b32 s3, s53, 7
s_add_u32 s3, s3, s22
M v[224:227], a[176:179], a[32:35], v[224:227]
s_lshl_b32 s3, s3, 5
s_lshr_b32 s19, s52, 6
s_add_u32 s3, s3, s19
M v[224:227], a[180:183], a[36:39], v[224:227]
s_lshl_b32 s19, s21, 1
s_add_u32 s3, s3, s19
s_lshl_b32 s92, s3, 15
M v[228:231], a[180:183], a[44:47], v[228:231]
s_add_u32 s92, s92, 16384
s_add_u32 s93, s92, 32768
s_add_u32 s16, s50, 16777216
M v[228:231], a[176:179], a[40:43], v[228:231]
s_addc_u32 s17, s51, 0
s_mov_b32 s18, 33554432
s_mov_b32 s19, 0x00020000
M v[232:235], a[176:179], a[48:51], v[232:235]
M v[232:235], a[180:183], a[52:55], v[232:235]
M v[236:239], a[180:183], a[60:63], v[236:239]
M v[236:239], a[176:179], a[56:59], v[236:239]
s_waitcnt vmcnt(4) lgkmcnt(0)
s_barrier
ds_read_b128 a[160:163], v10 offset:32768
ds_read_b128 a[164:167], v11 offset:32768
M v[240:243], a[176:179], a[64:67], v[240:243]
s_add_u32 m0, s28, 131072
s_nop 0
buffer_load_dword v20, s[8:11], s24 offen lds
M v[240:243], a[180:183], a[68:71], v[240:243]
M v[244:247], a[180:183], a[76:79], v[244:247]
M v[244:247], a[176:179], a[72:75], v[244:247]
M v[248:251], a[176:179], a[80:83], v[248:251]
buffer_load_dword v23, s[8:11], s24 offen offset:256 lds
s_add_u32 s24, s24, 128
M v[248:251], a[180:183], a[84:87], v[248:251]
M v[252:255], a[180:183], a[92:95], v[252:255]
M v[252:255], a[176:179], a[88:91], v[252:255]
M a[0:3], a[184:187], a[32:35], a[0:3]
M a[0:3], a[188:191], a[36:39], a[0:3]
ds_read_b128 a[168:171], v10 offset:34816
ds_read_b128 a[172:175], v11 offset:34816
M a[4:7], a[188:191], a[44:47], a[4:7]
s_add_u32 m0, s29, 133120
s_nop 0
buffer_load_dwordx4 v2, s[8:11], s23 offen offset:0 lds
M a[4:7], a[184:187], a[40:43], a[4:7]
M a[8:11], a[184:187], a[48:51], a[8:11]
M a[8:11], a[188:191], a[52:55], a[8:11]
M a[12:15], a[188:191], a[60:63], a[12:15]
buffer_load_dwordx4 v3, s[8:11], s23 offen offset:1024 lds
M a[12:15], a[184:187], a[56:59], a[12:15]
M a[16:19], a[184:187], a[64:67], a[16:19]
M a[16:19], a[188:191], a[68:71], a[16:19]
M a[20:23], a[188:191], a[76:79], a[20:23]
buffer_load_dwordx4 v4, s[8:11], s23 offen offset:2048 lds
M a[20:23], a[184:187], a[72:75], a[20:23]
M a[24:27], a[184:187], a[80:83], a[24:27]
M a[24:27], a[188:191], a[84:87], a[24:27]
M a[28:31], a[188:191], a[92:95], a[28:31]
M a[28:31], a[184:187], a[88:91], a[28:31]
s_waitcnt lgkmcnt(2)
M v[32:35], a[160:163], a[96:99], v[32:35]
buffer_load_dwordx4 v5, s[8:11], s23 offen offset:3072 lds
s_add_u32 s23, s23, 128
M v[32:35], a[164:167], a[100:103], v[32:35]
ds_read_b128 a[176:179], v10 offset:36864
ds_read_b128 a[180:183], v11 offset:36864
M v[36:39], a[164:167], a[108:111], v[36:39]
M v[36:39], a[160:163], a[104:107], v[36:39]
M v[40:43], a[160:163], a[112:115], v[40:43]
M v[40:43], a[164:167], a[116:119], v[40:43]
s_add_u32 m0, s30, 65536
s_nop 0
buffer_load_dwordx4 v6, s[12:15], s25 offen offset:0 lds
M v[44:47], a[164:167], a[124:127], v[44:47]
M v[44:47], a[160:163], a[120:123], v[44:47]
M v[48:51], a[160:163], a[128:131], v[48:51]
M v[48:51], a[164:167], a[132:135], v[48:51]
M v[52:55], a[164:167], a[140:143], v[52:55]
buffer_load_dwordx4 v7, s[12:15], s25 offen offset:1024 lds
M v[52:55], a[160:163], a[136:139], v[52:55]
M v[56:59], a[160:163], a[144:147], v[56:59]
M v[56:59], a[164:167], a[148:151], v[56:59]
M v[60:63], a[164:167], a[156:159], v[60:63]
M v[60:63], a[160:163], a[152:155], v[60:63]
s_waitcnt lgkmcnt(2)
M v[64:67], a[168:171], a[96:99], v[64:67]
buffer_load_dwordx4 v8, s[12:15], s25 offen offset:2048 lds
M v[64:67], a[172:175], a[100:103], v[64:67]
ds_read_b128 a[184:187], v10 offset:38912
ds_read_b128 a[188:191], v11 offset:38912
M v[68:71], a[172:175], a[108:111], v[68:71]
M v[68:71], a[168:171], a[104:107], v[68:71]
M v[72:75], a[168:171], a[112:115], v[72:75]
M v[72:75], a[172:175], a[116:119], v[72:75]
buffer_load_dwordx4 v9, s[12:15], s25 offen offset:3072 lds
M v[76:79], a[172:175], a[124:127], v[76:79]
M v[76:79], a[168:171], a[120:123], v[76:79]
M v[80:83], a[168:171], a[128:131], v[80:83]
M v[80:83], a[172:175], a[132:135], v[80:83]
M v[84:87], a[172:175], a[140:143], v[84:87]
s_add_u32 m0, s30, 69632
s_nop 0
buffer_load_dwordx4 v21, s[12:15], s25 offen offset:0 lds
M v[84:87], a[168:171], a[136:139], v[84:87]
M v[88:91], a[168:171], a[144:147], v[88:91]
M v[88:91], a[172:175], a[148:151], v[88:91]
M v[92:95], a[172:175], a[156:159], v[92:95]
M v[92:95], a[168:171], a[152:155], v[92:95]
s_waitcnt lgkmcnt(2)
M v[96:99], a[176:179], a[96:99], v[96:99]
buffer_load_dwordx4 v22, s[12:15], s25 offen offset:1024 lds
s_add_u32 s25, s25, 393216
M v[96:99], a[180:183], a[100:103], v[96:99]
M v[100:103], a[180:183], a[108:111], v[100:103]
M v[100:103], a[176:179], a[104:107], v[100:103]
v_cvt_pk_bf16_f32 v32, v32, v33
v_cvt_pk_bf16_f32 v33, v34, v35
M v[104:107], a[176:179], a[112:115], v[104:107]
v_cvt_pk_bf16_f32 v34, v64, v65
v_cvt_pk_bf16_f32 v35, v66, v67
M v[104:107], a[180:183], a[116:119], v[104:107]
v_cvt_pk_bf16_f32 v64, v48, v49
M v[108:111], a[180:183], a[124:127], v[108:111]
v_cvt_pk_bf16_f32 v65, v50, v51
v_cvt_pk_bf16_f32 v66, v80, v81
M v[108:111], a[176:179], a[120:123], v[108:111]
s_waitcnt vmcnt(12) lgkmcnt(0)
s_barrier
ds_read_b128 a[160:163], v10 offset:49152
ds_read_b128 a[164:167], v11 offset:49152
v_cvt_pk_bf16_f32 v67, v82, v83
M v[112:115], a[176:179], a[128:131], v[112:115]
s_add_u32 m0, s28, 0
s_nop 0
buffer_load_dword v20, s[8:11], s24 offen lds
v_cvt_pk_bf16_f32 v48, v40, v41
v_cvt_pk_bf16_f32 v49, v42, v43
M v[112:115], a[180:183], a[132:135], v[112:115]
v_cvt_pk_bf16_f32 v50, v72, v73
v_cvt_pk_bf16_f32 v51, v74, v75
M v[116:119], a[180:183], a[140:143], v[116:119]
v_cvt_pk_bf16_f32 v80, v56, v57
M v[116:119], a[176:179], a[136:139], v[116:119]
buffer_load_dword v23, s[8:11], s24 offen offset:256 lds
s_add_u32 s24, s24, 128
v_cvt_pk_bf16_f32 v81, v58, v59
v_cvt_pk_bf16_f32 v82, v88, v89
M v[120:123], a[176:179], a[144:147], v[120:123]
v_cvt_pk_bf16_f32 v83, v90, v91
M v[120:123], a[180:183], a[148:151], v[120:123]
v_cvt_pk_bf16_f32 v40, v36, v37
v_cvt_pk_bf16_f32 v41, v38, v39
M v[124:127], a[180:183], a[156:159], v[124:127]
v_cvt_pk_bf16_f32 v42, v68, v69
v_cvt_pk_bf16_f32 v43, v70, v71
M v[124:127], a[176:179], a[152:155], v[124:127]
v_cvt_pk_bf16_f32 v72, v52, v53
M v[128:131], a[184:187], a[96:99], v[128:131]
s_add_u32 m0, s29, 2048
s_nop 0
buffer_load_dwordx4 v2, s[8:11], s23 offen offset:0 lds
v_cvt_pk_bf16_f32 v73, v54, v55
v_cvt_pk_bf16_f32 v74, v84, v85
M v[128:131], a[188:191], a[100:103], v[128:131]
ds_read_b128 a[168:171], v10 offset:51200
ds_read_b128 a[172:175], v11 offset:51200
v_cvt_pk_bf16_f32 v75, v86, v87
M v[132:135], a[188:191], a[108:111], v[132:135]
v_cvt_pk_bf16_f32 v56, v44, v45
v_cvt_pk_bf16_f32 v57, v46, v47
M v[132:135], a[184:187], a[104:107], v[132:135]
v_cvt_pk_bf16_f32 v58, v76, v77
v_cvt_pk_bf16_f32 v59, v78, v79
M v[136:139], a[184:187], a[112:115], v[136:139]
v_cvt_pk_bf16_f32 v88, v60, v61
M v[136:139], a[188:191], a[116:119], v[136:139]
buffer_load_dwordx4 v3, s[8:11], s23 offen offset:1024 lds
v_cvt_pk_bf16_f32 v89, v62, v63
v_cvt_pk_bf16_f32 v90, v92, v93
M v[140:143], a[188:191], a[124:127], v[140:143]
v_cvt_pk_bf16_f32 v91, v94, v95
M v[140:143], a[184:187], a[120:123], v[140:143]
M v[144:147], a[184:187], a[128:131], v[144:147]
buffer_load_dwordx4 v4, s[8:11], s23 offen offset:2048 lds
M v[144:147], a[188:191], a[132:135], v[144:147]
M v[148:151], a[188:191], a[140:143], v[148:151]
s_add_u32 s94, s92, 0
buffer_store_dwordx4 v[32:35], v1, s[16:19], s94 offen offset:0 sc1
M v[148:151], a[184:187], a[136:139], v[148:151]
M v[152:155], a[184:187], a[144:147], v[152:155]
M v[152:155], a[188:191], a[148:151], v[152:155]
buffer_load_dwordx4 v5, s[8:11], s23 offen offset:3072 lds
s_add_u32 s23, s23, 128
M v[156:159], a[188:191], a[156:159], v[156:159]
s_add_u32 s94, s92, 0
buffer_store_dwordx4 v[40:43], v1, s[16:19], s94 offen offset:1024 sc1
M v[156:159], a[184:187], a[152:155], v[156:159]
s_waitcnt lgkmcnt(2)
M v[160:163], a[160:163], a[96:99], v[160:163]
M v[160:163], a[164:167], a[100:103], v[160:163]
ds_read_b128 a[176:179], v10 offset:53248
ds_read_b128 a[180:183], v11 offset:53248
M v[164:167], a[164:167], a[108:111], v[164:167]
s_add_u32 s94, s92, 0
buffer_store_dwordx4 v[48:51], v1, s[16:19], s94 offen offset:2048 sc1
M v[164:167], a[160:163], a[104:107], v[164:167]
v_cvt_pk_bf16_f32 v96, v96, v97
v_cvt_pk_bf16_f32 v97, v98, v99
M v[168:171], a[160:163], a[112:115], v[168:171]
v_cvt_pk_bf16_f32 v98, v128, v129
v_cvt_pk_bf16_f32 v99, v130, v131
M v[168:171], a[164:167], a[116:119], v[168:171]
s_add_u32 m0, s30, 98304
s_nop 0
buffer_load_dwordx4 v6, s[12:15], s25 offen offset:0 lds
v_cvt_pk_bf16_f32 v128, v112, v113
M v[172:175], a[164:167], a[124:127], v[172:175]
s_add_u32 s94, s92, 0
buffer_store_dwordx4 v[56:59], v1, s[16:19], s94 offen offset:3072 sc1
v_cvt_pk_bf16_f32 v129, v114, v115
v_cvt_pk_bf16_f32 v130, v144, v145
M v[172:175], a[160:163], a[120:123], v[172:175]
v_cvt_pk_bf16_f32 v131, v146, v147
M v[176:179], a[160:163], a[128:131], v[176:179]
v_cvt_pk_bf16_f32 v112, v104, v105
v_cvt_pk_bf16_f32 v113, v106, v107
M v[176:179], a[164:167], a[132:135], v[176:179]
buffer_load_dwordx4 v7, s[12:15], s25 offen offset:1024 lds
v_cvt_pk_bf16_f32 v114, v136, v137
v_cvt_pk_bf16_f32 v115, v138, v139
M v[180:183], a[164:167], a[140:143], v[180:183]
s_add_u32 s94, s92, 4096
buffer_store_dwordx4 v[64:67], v1, s[16:19], s94 offen offset:0 sc1
v_cvt_pk_bf16_f32 v144, v120, v121
M v[180:183], a[160:163], a[136:139], v[180:183]
v_cvt_pk_bf16_f32 v145, v122, v123
v_cvt_pk_bf16_f32 v146, v152, v153
M v[184:187], a[160:163], a[144:147], v[184:187]
v_cvt_pk_bf16_f32 v147, v154, v155
M v[184:187], a[164:167], a[148:151], v[184:187]
v_cvt_pk_bf16_f32 v104, v100, v101
v_cvt_pk_bf16_f32 v105, v102, v103
M v[188:191], a[164:167], a[156:159], v[188:191]
s_add_u32 s94, s92, 4096
buffer_store_dwordx4 v[72:75], v1, s[16:19], s94 offen offset:1024 sc1
v_cvt_pk_bf16_f32 v106, v132, v133
v_cvt_pk_bf16_f32 v107, v134, v135
M v[188:191], a[160:163], a[152:155], v[188:191]
s_waitcnt lgkmcnt(2)
v_cvt_pk_bf16_f32 v136, v116, v117
M v[192:195], a[168:171], a[96:99], v[192:195]
buffer_load_dwordx4 v8, s[12:15], s25 offen offset:2048 lds
v_cvt_pk_bf16_f32 v137, v118, v119
v_cvt_pk_bf16_f32 v138, v148, v149
M v[192:195], a[172:175], a[100:103], v[192:195]
ds_read_b128 a[184:187], v10 offset:55296
ds_read_b128 a[188:191], v11 offset:55296
v_cvt_pk_bf16_f32 v139, v150, v151
M v[196:199], a[172:175], a[108:111], v[196:199]
s_add_u32 s94, s92, 4096
buffer_store_dwordx4 v[80:83], v1, s[16:19], s94 offen offset:2048 sc1
v_cvt_pk_bf16_f32 v120, v108, v109
v_cvt_pk_bf16_f32 v121, v110, v111
M v[196:199], a[168:171], a[104:107], v[196:199]
v_cvt_pk_bf16_f32 v122, v140, v141
v_cvt_pk_bf16_f32 v123, v142, v143
M v[200:203], a[168:171], a[112:115], v[200:203]
v_cvt_pk_bf16_f32 v152, v124, v125
M v[200:203], a[172:175], a[116:119], v[200:203]
v_cvt_pk_bf16_f32 v153, v126, v127
v_cvt_pk_bf16_f32 v154, v156, v157
M v[204:207], a[172:175], a[124:127], v[204:207]
s_add_u32 s94, s92, 4096
buffer_store_dwordx4 v[88:91], v1, s[16:19], s94 offen offset:3072 sc1
v_cvt_pk_bf16_f32 v155, v158, v159
M v[204:207], a[168:171], a[120:123], v[204:207]
buffer_load_dwordx4 v9, s[12:15], s25 offen offset:3072 lds
M v[208:211], a[168:171], a[128:131], v[208:211]
M v[208:211], a[172:175], a[132:135], v[208:211]
M v[212:215], a[172:175], a[140:143], v[212:215]
s_add_u32 m0, s30, 102400
s_nop 0
buffer_load_dwordx4 v21, s[12:15], s25 offen offset:0 lds
M v[212:215], a[168:171], a[136:139], v[212:215]
M v[216:219], a[168:171], a[144:147], v[216:219]
s_add_u32 s94, s92, 8192
buffer_store_dwordx4 v[96:99], v1, s[16:19], s94 offen offset:0 sc1
M v[216:219], a[172:175], a[148:151], v[216:219]
M v[220:223], a[172:175], a[156:159], v[220:223]
M v[220:223], a[168:171], a[152:155], v[220:223]
s_waitcnt lgkmcnt(2)
M v[224:227], a[176:179], a[96:99], v[224:227]
buffer_load_dwordx4 v22, s[12:15], s25 offen offset:1024 lds
s_add_u32 s25, s25, 393216
M v[224:227], a[180:183], a[100:103], v[224:227]
M v[228:231], a[180:183], a[108:111], v[228:231]
s_add_u32 s94, s92, 8192
buffer_store_dwordx4 v[104:107], v1, s[16:19], s94 offen offset:1024 sc1
M v[228:231], a[176:179], a[104:107], v[228:231]
v_cvt_pk_bf16_f32 v160, v160, v161
v_cvt_pk_bf16_f32 v161, v162, v163
M v[232:235], a[176:179], a[112:115], v[232:235]
v_cvt_pk_bf16_f32 v162, v192, v193
v_cvt_pk_bf16_f32 v163, v194, v195
M v[232:235], a[180:183], a[116:119], v[232:235]
v_cvt_pk_bf16_f32 v192, v176, v177
M v[236:239], a[180:183], a[124:127], v[236:239]
v_cvt_pk_bf16_f32 v193, v178, v179
v_cvt_pk_bf16_f32 v194, v208, v209
M v[236:239], a[176:179], a[120:123], v[236:239]
s_waitcnt vmcnt(63) lgkmcnt(0)
s_barrier
v_cvt_pk_bf16_f32 v195, v210, v211
M v[240:243], a[176:179], a[128:131], v[240:243]
s_add_u32 s94, s92, 8192
buffer_store_dwordx4 v[112:115], v1, s[16:19], s94 offen offset:2048 sc1
v_cvt_pk_bf16_f32 v176, v168, v169
v_cvt_pk_bf16_f32 v177, v170, v171
M v[240:243], a[180:183], a[132:135], v[240:243]
s_add_u32 m0, s28, 18432
s_nop 0
buffer_load_dword v20, s[8:11], s24 offen lds
v_cvt_pk_bf16_f32 v178, v200, v201
v_cvt_pk_bf16_f32 v179, v202, v203
M v[244:247], a[180:183], a[140:143], v[244:247]
v_cvt_pk_bf16_f32 v208, v184, v185
M v[244:247], a[176:179], a[136:139], v[244:247]
v_cvt_pk_bf16_f32 v209, v186, v187
v_cvt_pk_bf16_f32 v210, v216, v217
M v[248:251], a[176:179], a[144:147], v[248:251]
buffer_load_dword v23, s[8:11], s24 offen offset:256 lds
s_add_u32 s24, s24, 128
v_cvt_pk_bf16_f32 v211, v218, v219
M v[248:251], a[180:183], a[148:151], v[248:251]
v_cvt_pk_bf16_f32 v168, v164, v165
v_cvt_pk_bf16_f32 v169, v166, v167
M v[252:255], a[180:183], a[156:159], v[252:255]
s_add_u32 s94, s92, 8192
buffer_store_dwordx4 v[120:123], v1, s[16:19], s94 offen offset:3072 sc1
v_cvt_pk_bf16_f32 v170, v196, v197
v_cvt_pk_bf16_f32 v171, v198, v199
M v[252:255], a[176:179], a[152:155], v[252:255]
v_cvt_pk_bf16_f32 v200, v180, v181
M a[0:3], a[184:187], a[96:99], a[0:3]
v_cvt_pk_bf16_f32 v201, v182, v183
v_cvt_pk_bf16_f32 v202, v212, v213
M a[0:3], a[188:191], a[100:103], a[0:3]
v_cvt_pk_bf16_f32 v203, v214, v215
M a[4:7], a[188:191], a[108:111], a[4:7]
s_add_u32 m0, s29, 20480
s_nop 0
buffer_load_dwordx4 v2, s[8:11], s23 offen offset:0 lds
v_cvt_pk_bf16_f32 v184, v172, v173
v_cvt_pk_bf16_f32 v185, v174, v175
M a[4:7], a[184:187], a[104:107], a[4:7]
v_cvt_pk_bf16_f32 v186, v204, v205
v_cvt_pk_bf16_f32 v187, v206, v207
M a[8:11], a[184:187], a[112:115], a[8:11]
s_add_u32 s94, s92, 12288
buffer_store_dwordx4 v[128:131], v1, s[16:19], s94 offen offset:0 sc1
v_cvt_pk_bf16_f32 v216, v188, v189
M a[8:11], a[188:191], a[116:119], a[8:11]
v_cvt_pk_bf16_f32 v217, v190, v191
v_cvt_pk_bf16_f32 v218, v220, v221
M a[12:15], a[188:191], a[124:127], a[12:15]
buffer_load_dwordx4 v3, s[8:11], s23 offen offset:1024 lds
v_cvt_pk_bf16_f32 v219, v222, v223
M a[12:15], a[184:187], a[120:123], a[12:15]
M a[16:19], a[184:187], a[128:131], a[16:19]
M a[16:19], a[188:191], a[132:135], a[16:19]
M a[20:23], a[188:191], a[140:143], a[20:23]
s_add_u32 s94, s92, 12288
buffer_store_dwordx4 v[136:139], v1, s[16:19], s94 offen offset:1024 sc1
M a[20:23], a[184:187], a[136:139], a[20:23]
buffer_load_dwordx4 v4, s[8:11], s23 offen offset:2048 lds
M a[24:27], a[184:187], a[144:147], a[24:27]
M a[24:27], a[188:191], a[148:151], a[24:27]
M a[28:31], a[188:191], a[156:159], a[28:31]
M a[28:31], a[184:187], a[152:155], a[28:31]
v_accvgpr_read_b32 v24, a0
v_accvgpr_read_b32 v25, a1
v_accvgpr_read_b32 v26, a2
v_accvgpr_read_b32 v27, a3
v_cvt_pk_bf16_f32 v224, v224, v225
v_cvt_pk_bf16_f32 v225, v226, v227
v_cvt_pk_bf16_f32 v226, v24, v25
v_cvt_pk_bf16_f32 v227, v26, v27
v_accvgpr_read_b32 v24, a16
v_accvgpr_read_b32 v25, a17
v_accvgpr_read_b32 v26, a18
v_accvgpr_read_b32 v27, a19
v_cvt_pk_bf16_f32 v36, v240, v241
v_cvt_pk_bf16_f32 v37, v242, v243
v_cvt_pk_bf16_f32 v38, v24, v25
v_cvt_pk_bf16_f32 v39, v26, v27
v_accvgpr_read_b32 v24, a24
v_accvgpr_read_b32 v25, a25
v_accvgpr_read_b32 v26, a26
v_accvgpr_read_b32 v27, a27
v_cvt_pk_bf16_f32 v52, v248, v249
v_cvt_pk_bf16_f32 v53, v250, v251
v_cvt_pk_bf16_f32 v54, v24, v25
v_cvt_pk_bf16_f32 v55, v26, v27
v_accvgpr_read_b32 v24, a8
v_accvgpr_read_b32 v25, a9
v_accvgpr_read_b32 v26, a10
v_accvgpr_read_b32 v27, a11
v_cvt_pk_bf16_f32 v240, v232, v233
v_cvt_pk_bf16_f32 v241, v234, v235
v_cvt_pk_bf16_f32 v242, v24, v25
v_cvt_pk_bf16_f32 v243, v26, v27
v_accvgpr_read_b32 v28, a4
v_accvgpr_read_b32 v29, a5
v_accvgpr_read_b32 v30, a6
v_accvgpr_read_b32 v31, a7
v_cvt_pk_bf16_f32 v232, v228, v229
v_cvt_pk_bf16_f32 v233, v230, v231
v_cvt_pk_bf16_f32 v234, v28, v29
v_cvt_pk_bf16_f32 v235, v30, v31
v_accvgpr_read_b32 v28, a12
v_accvgpr_read_b32 v29, a13
v_accvgpr_read_b32 v30, a14
v_accvgpr_read_b32 v31, a15
v_cvt_pk_bf16_f32 v248, v236, v237
v_cvt_pk_bf16_f32 v249, v238, v239
v_cvt_pk_bf16_f32 v250, v28, v29
v_cvt_pk_bf16_f32 v251, v30, v31
v_accvgpr_read_b32 v28, a20
v_accvgpr_read_b32 v29, a21
v_accvgpr_read_b32 v30, a22
v_accvgpr_read_b32 v31, a23
v_cvt_pk_bf16_f32 v44, v244, v245
v_cvt_pk_bf16_f32 v45, v246, v247
v_cvt_pk_bf16_f32 v46, v28, v29
v_cvt_pk_bf16_f32 v47, v30, v31
v_accvgpr_read_b32 v28, a28
v_accvgpr_read_b32 v29, a29
v_accvgpr_read_b32 v30, a30
v_accvgpr_read_b32 v31, a31
v_cvt_pk_bf16_f32 v60, v252, v253
v_cvt_pk_bf16_f32 v61, v254, v255
v_cvt_pk_bf16_f32 v62, v28, v29
v_cvt_pk_bf16_f32 v63, v30, v31
Lk1_b:
v_and_b32 v24, 15, v0
v_lshlrev_b32 v24, 7, v24
v_bfe_u32 v25, v0, 1, 3
v_lshrrev_b32 v26, 4, v0
v_xor_b32 v25, v25, v26
v_lshl_add_u32 v10, v25, 4, v24
v_xor_b32 v11, 64, v10
v_add_u32 v12, 131072, v10
v_add_u32 v13, 131072, v11
v_bfe_u32 v24, v0, 2, 2
v_lshl_add_u32 v29, v26, 3, v24
v_mul_u32_u24 v25, 384, v29
v_and_b32 v27, 1, v0
v_lshl_add_u32 v25, v27, 3, v25
v_add_u32 v25, 36864, v25
v_lshrrev_b32 v24, 1, v29
v_and_b32 v24, 4, v24
v_and_or_b32 v24, v29, 2, v24
v_bfe_u32 v26, v0, 1, 1
s_mul_i32 s4, s20, 3
s_add_u32 s3, s4, 0
s_and_b32 s5, s3, 3
s_lshl_b32 s5, s5, 1
s_lshr_b32 s3, s3, 2
s_lshl_b32 s3, s3, 7
v_add_u32 v27, s5, v26
v_xor_b32 v27, v27, v24
v_lshl_add_u32 v27, v27, 4, v25
v_add_u32 v14, s3, v27
v_add_u32 v17, 61440, v14
s_add_u32 s3, s4, 1
s_and_b32 s5, s3, 3
s_lshl_b32 s5, s5, 1
s_lshr_b32 s3, s3, 2
s_lshl_b32 s3, s3, 7
v_add_u32 v27, s5, v26
v_xor_b32 v27, v27, v24
v_lshl_add_u32 v27, v27, 4, v25
v_add_u32 v15, s3, v27
v_add_u32 v18, 61440, v15
s_add_u32 s3, s4, 2
s_and_b32 s5, s3, 3
s_lshl_b32 s5, s5, 1
s_lshr_b32 s3, s3, 2
s_lshl_b32 s3, s3, 7
v_add_u32 v27, s5, v26
v_xor_b32 v27, v27, v24
v_lshl_add_u32 v27, v27, 4, v25
v_add_u32 v16, s3, v27
v_add_u32 v19, 61440, v16
s_waitcnt vmcnt(9)
s_barrier
ds_read_b64_tr_b16 a[176:177], v14 offset:28672
ds_read_b64_tr_b16 a[178:179], v14 offset:30208
ds_read_b64_tr_b16 a[184:185], v15 offset:28672
ds_read_b64_tr_b16 a[186:187], v15 offset:30208
ds_read_b64_tr_b16 a[192:193], v16 offset:28672
ds_read_b64_tr_b16 a[194:195], v16 offset:30208
ds_read_b64_tr_b16 a[180:181], v14 offset:40960
ds_read_b64_tr_b16 a[182:183], v14 offset:42496
ds_read_b64_tr_b16 a[188:189], v15 offset:40960
ds_read_b64_tr_b16 a[190:191], v15 offset:42496
ds_read_b64_tr_b16 a[196:197], v16 offset:40960
ds_read_b64_tr_b16 a[198:199], v16 offset:42496
ds_read_b128 a[224:227], v12 offset:0
ds_read_b128 a[228:231], v13 offset:0
ds_read_b128 a[232:235], v12 offset:2048
ds_read_b128 a[236:239], v13 offset:2048
ds_read_b128 a[240:243], v12 offset:4096
ds_read_b128 a[244:247], v13 offset:4096
s_waitcnt lgkmcnt(0)
s_barrier
M a[68:71], a[176:179], a[224:227], 0
ds_read_b128 a[248:251], v12 offset:6144
ds_read_b128 a[252:255], v13 offset:6144
M a[68:71], a[180:183], a[228:231], a[68:71]
buffer_load_dwordx4 v5, s[8:11], s23 offen offset:3072 lds
s_add_u32 s23, s23, 128
M a[72:75], a[188:191], a[228:231], 0
ds_read_b64_tr_b16 a[200:201], v17 offset:0
ds_read_b64_tr_b16 a[202:203], v17 offset:1536
M a[72:75], a[184:187], a[224:227], a[72:75]
M a[76:79], a[192:195], a[224:227], 0
s_add_u32 m0, s30, 36864
s_nop 0
buffer_load_dwordx4 v6, s[12:15], s25 offen offset:0 lds
M a[76:79], a[196:199], a[228:231], a[76:79]
M a[80:83], a[180:183], a[236:239], 0
ds_read_b128 a[224:227], v12 offset:8192
ds_read_b128 a[228:231], v13 offset:8192
M a[80:83], a[176:179], a[232:235], a[80:83]
buffer_load_dwordx4 v7, s[12:15], s25 offen offset:1024 lds
M a[84:87], a[184:187], a[232:235], 0
ds_read_b64_tr_b16 a[208:209], v18 offset:0
ds_read_b64_tr_b16 a[210:211], v18 offset:1536
M a[84:87], a[188:191], a[236:239], a[84:87]
M a[88:91], a[196:199], a[236:239], 0
buffer_load_dwordx4 v8, s[12:15], s25 offen offset:2048 lds
M a[88:91], a[192:195], a[232:235], a[88:91]
M a[92:95], a[176:179], a[240:243], 0
ds_read_b128 a[232:235], v12 offset:10240
ds_read_b128 a[236:239], v13 offset:10240
M a[92:95], a[180:183], a[244:247], a[92:95]
buffer_load_dwordx4 v9, s[12:15], s25 offen offset:3072 lds
M a[96:99], a[188:191], a[244:247], 0
ds_read_b64_tr_b16 a[216:217], v19 offset:0
ds_read_b64_tr_b16 a[218:219], v19 offset:1536
M a[96:99], a[184:187], a[240:243], a[96:99]
M a[100:103], a[192:195], a[240:243], 0
s_add_u32 m0, s30, 40960
s_nop 0
buffer_load_dwordx4 v21, s[12:15], s25 offen offset:0 lds
M a[100:103], a[196:199], a[244:247], a[100:103]
s_waitcnt lgkmcnt(10)
M a[104:107], a[180:183], a[252:255], 0
ds_read_b128 a[240:243], v12 offset:12288
ds_read_b128 a[244:247], v13 offset:12288
M a[104:107], a[176:179], a[248:251], a[104:107]
buffer_load_dwordx4 v22, s[12:15], s25 offen offset:1024 lds
s_add_u32 s25, s25, 393216
M a[108:111], a[184:187], a[248:251], 0
ds_read_b64_tr_b16 a[204:205], v17 offset:12288
ds_read_b64_tr_b16 a[206:207], v17 offset:13824
M a[108:111], a[188:191], a[252:255], a[108:111]
M a[112:115], a[196:199], a[252:255], 0
s_add_u32 m0, s30, 65536
s_nop 0
buffer_load_dwordx4 v6, s[12:15], s25 offen offset:0 lds
M a[112:115], a[192:195], a[248:251], a[112:115]
s_waitcnt lgkmcnt(10)
M a[116:119], a[176:179], a[224:227], 0
ds_read_b128 a[248:251], v12 offset:14336
ds_read_b128 a[252:255], v13 offset:14336
M a[116:119], a[180:183], a[228:231], a[116:119]
buffer_load_dwordx4 v7, s[12:15], s25 offen offset:1024 lds
M a[120:123], a[188:191], a[228:231], 0
ds_read_b64_tr_b16 a[212:213], v18 offset:12288
ds_read_b64_tr_b16 a[214:215], v18 offset:13824
M a[120:123], a[184:187], a[224:227], a[120:123]
M a[124:127], a[192:195], a[224:227], 0
buffer_load_dwordx4 v8, s[12:15], s25 offen offset:2048 lds
M a[124:127], a[196:199], a[228:231], a[124:127]
s_waitcnt lgkmcnt(10)
M a[128:131], a[180:183], a[236:239], 0
ds_read_b128 a[224:227], v12 offset:16384
ds_read_b128 a[228:231], v13 offset:16384
M a[128:131], a[176:179], a[232:235], a[128:131]
buffer_load_dwordx4 v9, s[12:15], s25 offen offset:3072 lds
M a[132:135], a[184:187], a[232:235], 0
ds_read_b64_tr_b16 a[220:221], v19 offset:12288
ds_read_b64_tr_b16 a[222:223], v19 offset:13824
M a[132:135], a[188:191], a[236:239], a[132:135]
M a[136:139], a[196:199], a[236:239], 0
s_add_u32 m0, s30, 69632
s_nop 0
buffer_load_dwordx4 v21, s[12:15], s25 offen offset:0 lds
M a[136:139], a[192:195], a[232:235], a[136:139]
s_waitcnt lgkmcnt(10)
M a[140:143], a[176:179], a[240:243], 0
buffer_load_dwordx4 v22, s[12:15], s25 offen offset:1024 lds
s_add_u32 s25, s25, 393216
M a[140:143], a[180:183], a[244:247], a[140:143]
M a[144:147], a[188:191], a[244:247], 0
M a[144:147], a[184:187], a[240:243], a[144:147]
M a[148:151], a[192:195], a[240:243], 0
s_waitcnt vmcnt(6) lgkmcnt(0)
s_barrier
ds_read_b128 a[232:235], v10 offset:0
ds_read_b128 a[236:239], v11 offset:0
M a[148:151], a[196:199], a[244:247], a[148:151]
s_add_u32 m0, s28, 131072
s_nop 0
buffer_load_dword v20, s[8:11], s24 offen lds
M a[152:155], a[180:183], a[252:255], 0
ds_read_b128 a[240:243], v10 offset:2048
ds_read_b128 a[244:247], v11 offset:2048
M a[152:155], a[176:179], a[248:251], a[152:155]
M a[156:159], a[184:187], a[248:251], 0
buffer_load_dword v23, s[8:11], s24 offen offset:256 lds
s_add_u32 s24, s24, 128
M a[156:159], a[188:191], a[252:255], a[156:159]
M a[160:163], a[196:199], a[252:255], 0
M a[160:163], a[192:195], a[248:251], a[160:163]
s_add_u32 m0, s29, 133120
s_nop 0
buffer_load_dwordx4 v2, s[8:11], s23 offen offset:0 lds
M a[164:167], a[176:179], a[224:227], 0
ds_read_b128 a[248:251], v10 offset:4096
ds_read_b128 a[252:255], v11 offset:4096
M a[164:167], a[180:183], a[228:231], a[164:167]
M a[168:171], a[188:191], a[228:231], 0
M a[168:171], a[184:187], a[224:227], a[168:171]
buffer_load_dwordx4 v3, s[8:11], s23 offen offset:1024 lds
M a[172:175], a[192:195], a[224:227], 0
M a[172:175], a[196:199], a[228:231], a[172:175]
s_waitcnt lgkmcnt(4)
M a[68:71], a[200:203], a[232:235], a[68:71]
ds_read_b128 a[224:227], v10 offset:6144
ds_read_b128 a[228:231], v11 offset:6144
M a[68:71], a[204:207], a[236:239], a[68:71]
buffer_load_dwordx4 v4, s[8:11], s23 offen offset:2048 lds
M a[72:75], a[212:215], a[236:239], a[72:75]
ds_read_b64_tr_b16 a[176:177], v14 offset:0
ds_read_b64_tr_b16 a[178:179], v14 offset:1536
M a[72:75], a[208:211], a[232:235], a[72:75]
M a[76:79], a[216:219], a[232:235], a[76:79]
buffer_load_dwordx4 v5, s[8:11], s23 offen offset:3072 lds
s_add_u32 s23, s23, 128
M a[76:79], a[220:223], a[236:239], a[76:79]
s_waitcnt lgkmcnt(6)
M a[80:83], a[204:207], a[244:247], a[80:83]
ds_read_b128 a[232:235], v10 offset:8192
ds_read_b128 a[236:239], v11 offset:8192
M a[80:83], a[200:203], a[240:243], a[80:83]
s_add_u32 m0, s30, 98304
s_nop 0
buffer_load_dwordx4 v6, s[12:15], s25 offen offset:0 lds
M a[84:87], a[208:211], a[240:243], a[84:87]
ds_read_b64_tr_b16 a[184:185], v15 offset:0
ds_read_b64_tr_b16 a[186:187], v15 offset:1536
M a[84:87], a[212:215], a[244:247], a[84:87]
M a[88:91], a[220:223], a[244:247], a[88:91]
buffer_load_dwordx4 v7, s[12:15], s25 offen offset:1024 lds
M a[88:91], a[216:219], a[240:243], a[88:91]
s_waitcnt lgkmcnt(8)
M a[92:95], a[200:203], a[248:251], a[92:95]
ds_read_b128 a[240:243], v10 offset:10240
ds_read_b128 a[244:247], v11 offset:10240
M a[92:95], a[204:207], a[252:255], a[92:95]
M a[96:99], a[212:215], a[252:255], a[96:99]
ds_read_b64_tr_b16 a[192:193], v16 offset:0
ds_read_b64_tr_b16 a[194:195], v16 offset:1536
M a[96:99], a[208:211], a[248:251], a[96:99]
buffer_load_dwordx4 v8, s[12:15], s25 offen offset:2048 lds
M a[100:103], a[216:219], a[248:251], a[100:103]
M a[100:103], a[220:223], a[252:255], a[100:103]
buffer_load_dwordx4 v9, s[12:15], s25 offen offset:3072 lds
s_waitcnt lgkmcnt(10)
M a[104:107], a[204:207], a[228:231], a[104:107]
ds_read_b128 a[248:251], v10 offset:12288
ds_read_b128 a[252:255], v11 offset:12288
M a[104:107], a[200:203], a[224:227], a[104:107]
M a[108:111], a[208:211], a[224:227], a[108:111]
ds_read_b64_tr_b16 a[180:181], v14 offset:12288
ds_read_b64_tr_b16 a[182:183], v14 offset:13824
M a[108:111], a[212:215], a[228:231], a[108:111]
s_add_u32 m0, s30, 102400
s_nop 0
buffer_load_dwordx4 v21, s[12:15], s25 offen offset:0 lds
M a[112:115], a[220:223], a[228:231], a[112:115]
M a[112:115], a[216:219], a[224:227], a[112:115]
buffer_load_dwordx4 v22, s[12:15], s25 offen offset:1024 lds
s_add_u32 s25, s25, 393216
s_waitcnt lgkmcnt(10)
M a[116:119], a[200:203], a[232:235], a[116:119]
ds_read_b128 a[224:227], v10 offset:14336
ds_read_b128 a[228:231], v11 offset:14336
M a[116:119], a[204:207], a[236:239], a[116:119]
M a[120:123], a[212:215], a[236:239], a[120:123]
ds_read_b64_tr_b16 a[188:189], v15 offset:12288
ds_read_b64_tr_b16 a[190:191], v15 offset:13824
M a[120:123], a[208:211], a[232:235], a[120:123]
M a[124:127], a[216:219], a[232:235], a[124:127]
s_add_u32 s94, s92, 12288
buffer_store_dwordx4 v[144:147], v1, s[16:19], s94 offen offset:2048 sc1
M a[124:127], a[220:223], a[236:239], a[124:127]
s_waitcnt lgkmcnt(10)
M a[128:131], a[204:207], a[244:247], a[128:131]
ds_read_b128 a[232:235], v10 offset:16384
ds_read_b128 a[236:239], v11 offset:16384
M a[128:131], a[200:203], a[240:243], a[128:131]
s_add_u32 s94, s92, 12288
buffer_store_dwordx4 v[152:155], v1, s[16:19], s94 offen offset:3072 sc1
M a[132:135], a[208:211], a[240:243], a[132:135]
ds_read_b64_tr_b16 a[196:197], v16 offset:12288
ds_read_b64_tr_b16 a[198:199], v16 offset:13824
M a[132:135], a[212:215], a[244:247], a[132:135]
M a[136:139], a[220:223], a[244:247], a[136:139]
s_add_u32 s94, s93, 0
buffer_store_dwordx4 v[160:163], v1, s[16:19], s94 offen offset:0 sc1
M a[136:139], a[216:219], a[240:243], a[136:139]
s_waitcnt lgkmcnt(10)
M a[140:143], a[200:203], a[248:251], a[140:143]
s_add_u32 s94, s93, 0
buffer_store_dwordx4 v[168:171], v1, s[16:19], s94 offen offset:1024 sc1
M a[140:143], a[204:207], a[252:255], a[140:143]
M a[144:147], a[212:215], a[252:255], a[144:147]
M a[144:147], a[208:211], a[248:251], a[144:147]
M a[148:151], a[216:219], a[248:251], a[148:151]
s_waitcnt vmcnt(16) lgkmcnt(0)
s_barrier
ds_read_b128 a[240:243], v10 offset:18432
ds_read_b128 a[244:247], v11 offset:18432
M a[148:151], a[220:223], a[252:255], a[148:151]
s_add_u32 m0, s28, 0
s_nop 0
buffer_load_dword v20, s[8:11], s24 offen lds
M a[152:155], a[204:207], a[228:231], a[152:155]
ds_read_b128 a[248:251], v10 offset:20480
ds_read_b128 a[252:255], v11 offset:20480
M a[152:155], a[200:203], a[224:227], a[152:155]
M a[156:159], a[208:211], a[224:227], a[156:159]
buffer_load_dword v23, s[8:11], s24 offen offset:256 lds
s_add_u32 s24, s24, 128
M a[156:159], a[212:215], a[228:231], a[156:159]
M a[160:163], a[220:223], a[228:231], a[160:163]
M a[160:163], a[216:219], a[224:227], a[160:163]
s_add_u32 m0, s29, 2048
s_nop 0
buffer_load_dwordx4 v2, s[8:11], s23 offen offset:0 lds
M a[164:167], a[200:203], a[232:235], a[164:167]
ds_read_b128 a[224:227], v10 offset:22528
ds_read_b128 a[228:231], v11 offset:22528
M a[164:167], a[204:207], a[236:239], a[164:167]
M a[168:171], a[212:215], a[236:239], a[168:171]
M a[168:171], a[208:211], a[232:235], a[168:171]
buffer_load_dwordx4 v3, s[8:11], s23 offen offset:1024 lds
M a[172:175], a[216:219], a[232:235], a[172:175]
M a[172:175], a[220:223], a[236:239], a[172:175]
s_waitcnt lgkmcnt(4)
M a[68:71], a[176:179], a[240:243], a[68:71]
ds_read_b128 a[232:235], v10 offset:24576
ds_read_b128 a[236:239], v11 offset:24576
M a[68:71], a[180:183], a[244:247], a[68:71]
buffer_load_dwordx4 v4, s[8:11], s23 offen offset:2048 lds
M a[72:75], a[188:191], a[244:247], a[72:75]
ds_read_b64_tr_b16 a[200:201], v14 offset:28672
ds_read_b64_tr_b16 a[202:203], v14 offset:30208
M a[72:75], a[184:187], a[240:243], a[72:75]
M a[76:79], a[192:195], a[240:243], a[76:79]
buffer_load_dwordx4 v5, s[8:11], s23 offen offset:3072 lds
s_add_u32 s23, s23, 128
M a[76:79], a[196:199], a[244:247], a[76:79]
s_waitcnt lgkmcnt(6)
M a[80:83], a[180:183], a[252:255], a[80:83]
ds_read_b128 a[240:243], v10 offset:26624
ds_read_b128 a[244:247], v11 offset:26624
M a[80:83], a[176:179], a[248:251], a[80:83]
s_add_u32 m0, s30, 36864
s_nop 0
buffer_load_dwordx4 v6, s[12:15], s25 offen offset:0 lds
M a[84:87], a[184:187], a[248:251], a[84:87]
ds_read_b64_tr_b16 a[208:209], v15 offset:28672
ds_read_b64_tr_b16 a[210:211], v15 offset:30208
M a[84:87], a[188:191], a[252:255], a[84:87]
M a[88:91], a[196:199], a[252:255], a[88:91]
buffer_load_dwordx4 v7, s[12:15], s25 offen offset:1024 lds
M a[88:91], a[192:195], a[248:251], a[88:91]
s_waitcnt lgkmcnt(8)
M a[92:95], a[176:179], a[224:227], a[92:95]
ds_read_b128 a[248:251], v10 offset:28672
ds_read_b128 a[252:255], v11 offset:28672
M a[92:95], a[180:183], a[228:231], a[92:95]
M a[96:99], a[188:191], a[228:231], a[96:99]
ds_read_b64_tr_b16 a[216:217], v16 offset:28672
ds_read_b64_tr_b16 a[218:219], v16 offset:30208
M a[96:99], a[184:187], a[224:227], a[96:99]
buffer_load_dwordx4 v8, s[12:15], s25 offen offset:2048 lds
M a[100:103], a[192:195], a[224:227], a[100:103]
M a[100:103], a[196:199], a[228:231], a[100:103]
buffer_load_dwordx4 v9, s[12:15], s25 offen offset:3072 lds
s_waitcnt lgkmcnt(10)
M a[104:107], a[180:183], a[236:239], a[104:107]
ds_read_b128 a[224:227], v10 offset:30720
ds_read_b128 a[228:231], v11 offset:30720
M a[104:107], a[176:179], a[232:235], a[104:107]
M a[108:111], a[184:187], a[232:235], a[108:111]
ds_read_b64_tr_b16 a[204:205], v14 offset:40960
ds_read_b64_tr_b16 a[206:207], v14 offset:42496
M a[108:111], a[188:191], a[236:239], a[108:111]
s_add_u32 m0, s30, 40960
s_nop 0
buffer_load_dwordx4 v21, s[12:15], s25 offen offset:0 lds
M a[112:115], a[196:199], a[236:239], a[112:115]
M a[112:115], a[192:195], a[232:235], a[112:115]
buffer_load_dwordx4 v22, s[12:15], s25 offen offset:1024 lds
s_add_u32 s25, s25, 393216
s_waitcnt lgkmcnt(10)
M a[116:119], a[176:179], a[240:243], a[116:119]
ds_read_b128 a[232:235], v10 offset:32768
ds_read_b128 a[236:239], v11 offset:32768
M a[116:119], a[180:183], a[244:247], a[116:119]
M a[120:123], a[188:191], a[244:247], a[120:123]
ds_read_b64_tr_b16 a[212:213], v15 offset:40960
ds_read_b64_tr_b16 a[214:215], v15 offset:42496
M a[120:123], a[184:187], a[240:243], a[120:123]
M a[124:127], a[192:195], a[240:243], a[124:127]
s_add_u32 s94, s93, 0
buffer_store_dwordx4 v[176:179], v1, s[16:19], s94 offen offset:2048 sc1
M a[124:127], a[196:199], a[244:247], a[124:127]
s_waitcnt lgkmcnt(10)
M a[128:131], a[180:183], a[252:255], a[128:131]
ds_read_b128 a[240:243], v10 offset:34816
ds_read_b128 a[244:247], v11 offset:34816
M a[128:131], a[176:179], a[248:251], a[128:131]
s_add_u32 s94, s93, 0
buffer_store_dwordx4 v[184:187], v1, s[16:19], s94 offen offset:3072 sc1
M a[132:135], a[184:187], a[248:251], a[132:135]
ds_read_b64_tr_b16 a[220:221], v16 offset:40960
ds_read_b64_tr_b16 a[222:223], v16 offset:42496
M a[132:135], a[188:191], a[252:255], a[132:135]
M a[136:139], a[196:199], a[252:255], a[136:139]
s_add_u32 s94, s93, 4096
buffer_store_dwordx4 v[192:195], v1, s[16:19], s94 offen offset:0 sc1
M a[136:139], a[192:195], a[248:251], a[136:139]
s_waitcnt lgkmcnt(10)
M a[140:143], a[176:179], a[224:227], a[140:143]
s_add_u32 s94, s93, 4096
buffer_store_dwordx4 v[200:203], v1, s[16:19], s94 offen offset:1024 sc1
M a[140:143], a[180:183], a[228:231], a[140:143]
M a[144:147], a[188:191], a[228:231], a[144:147]
M a[144:147], a[184:187], a[224:227], a[144:147]
M a[148:151], a[192:195], a[224:227], a[148:151]
s_waitcnt vmcnt(20) lgkmcnt(0)
s_barrier
ds_read_b128 a[248:251], v12 offset:0
ds_read_b128 a[252:255], v13 offset:0
M a[148:151], a[196:199], a[228:231], a[148:151]
s_add_u32 m0, s28, 18432
s_nop 0
buffer_load_dword v20, s[8:11], s24 offen lds
M a[152:155], a[180:183], a[236:239], a[152:155]
ds_read_b128 a[224:227], v12 offset:2048
ds_read_b128 a[228:231], v13 offset:2048
M a[152:155], a[176:179], a[232:235], a[152:155]
M a[156:159], a[184:187], a[232:235], a[156:159]
buffer_load_dword v23, s[8:11], s24 offen offset:256 lds
s_add_u32 s24, s24, 128
M a[156:159], a[188:191], a[236:239], a[156:159]
M a[160:163], a[196:199], a[236:239], a[160:163]
M a[160:163], a[192:195], a[232:235], a[160:163]
s_add_u32 m0, s29, 20480
s_nop 0
buffer_load_dwordx4 v2, s[8:11], s23 offen offset:0 lds
M a[164:167], a[176:179], a[240:243], a[164:167]
ds_read_b128 a[232:235], v12 offset:4096
ds_read_b128 a[236:239], v13 offset:4096
M a[164:167], a[180:183], a[244:247], a[164:167]
M a[168:171], a[188:191], a[244:247], a[168:171]
M a[168:171], a[184:187], a[240:243], a[168:171]
buffer_load_dwordx4 v3, s[8:11], s23 offen offset:1024 lds
M a[172:175], a[192:195], a[240:243], a[172:175]
M a[172:175], a[196:199], a[244:247], a[172:175]
s_waitcnt lgkmcnt(4)
M a[68:71], a[200:203], a[248:251], a[68:71]
ds_read_b128 a[240:243], v12 offset:6144
ds_read_b128 a[244:247], v13 offset:6144
M a[68:71], a[204:207], a[252:255], a[68:71]
buffer_load_dwordx4 v4, s[8:11], s23 offen offset:2048 lds
M a[72:75], a[212:215], a[252:255], a[72:75]
ds_read_b64_tr_b16 a[176:177], v17 offset:0
ds_read_b64_tr_b16 a[178:179], v17 offset:1536
M a[72:75], a[208:211], a[248:251], a[72:75]
M a[76:79], a[216:219], a[248:251], a[76:79]
buffer_load_dwordx4 v5, s[8:11], s23 offen offset:3072 lds
s_add_u32 s23, s23, 128
M a[76:79], a[220:223], a[252:255], a[76:79]
s_waitcnt lgkmcnt(6)
M a[80:83], a[204:207], a[228:231], a[80:83]
ds_read_b128 a[248:251], v12 offset:8192
ds_read_b128 a[252:255], v13 offset:8192
M a[80:83], a[200:203], a[224:227], a[80:83]
s_add_u32 m0, s30, 65536
s_nop 0
buffer_load_dwordx4 v6, s[12:15], s25 offen offset:0 lds
M a[84:87], a[208:211], a[224:227], a[84:87]
ds_read_b64_tr_b16 a[184:185], v18 offset:0
ds_read_b64_tr_b16 a[186:187], v18 offset:1536
M a[84:87], a[212:215], a[228:231], a[84:87]
M a[88:91], a[220:223], a[228:231], a[88:91]
buffer_load_dwordx4 v7, s[12:15], s25 offen offset:1024 lds
M a[88:91], a[216:219], a[224:227], a[88:91]
s_waitcnt lgkmcnt(8)
M a[92:95], a[200:203], a[232:235], a[92:95]
ds_read_b128 a[224:227], v12 offset:10240
ds_read_b128 a[228:231], v13 offset:10240
M a[92:95], a[204:207], a[236:239], a[92:95]
M a[96:99], a[212:215], a[236:239], a[96:99]
ds_read_b64_tr_b16 a[192:193], v19 offset:0
ds_read_b64_tr_b16 a[194:195], v19 offset:1536
M a[96:99], a[208:211], a[232:235], a[96:99]
buffer_load_dwordx4 v8, s[12:15], s25 offen offset:2048 lds
M a[100:103], a[216:219], a[232:235], a[100:103]
M a[100:103], a[220:223], a[236:239], a[100:103]
buffer_load_dwordx4 v9, s[12:15], s25 offen offset:3072 lds
s_waitcnt lgkmcnt(10)
M a[104:107], a[204:207], a[244:247], a[104:107]
ds_read_b128 a[232:235], v12 offset:12288
ds_read_b128 a[236:239], v13 offset:12288
M a[104:107], a[200:203], a[240:243], a[104:107]
M a[108:111], a[208:211], a[240:243], a[108:111]
ds_read_b64_tr_b16 a[180:181], v17 offset:12288
ds_read_b64_tr_b16 a[182:183], v17 offset:13824
M a[108:111], a[212:215], a[244:247], a[108:111]
s_add_u32 m0, s30, 69632
s_nop 0
buffer_load_dwordx4 v21, s[12:15], s25 offen offset:0 lds
M a[112:115], a[220:223], a[244:247], a[112:115]
M a[112:115], a[216:219], a[240:243], a[112:115]
buffer_load_dwordx4 v22, s[12:15], s25 offen offset:1024 lds
s_add_u32 s25, s25, 393216
s_waitcnt lgkmcnt(10)
M a[116:119], a[200:203], a[248:251], a[116:119]
ds_read_b128 a[240:243], v12 offset:14336
ds_read_b128 a[244:247], v13 offset:14336
M a[116:119], a[204:207], a[252:255], a[116:119]
M a[120:123], a[212:215], a[252:255], a[120:123]
ds_read_b64_tr_b16 a[188:189], v18 offset:12288
ds_read_b64_tr_b16 a[190:191], v18 offset:13824
M a[120:123], a[208:211], a[248:251], a[120:123]
M a[124:127], a[216:219], a[248:251], a[124:127]
s_add_u32 s94, s93, 4096
buffer_store_dwordx4 v[208:211], v1, s[16:19], s94 offen offset:2048 sc1
M a[124:127], a[220:223], a[252:255], a[124:127]
s_waitcnt lgkmcnt(10)
M a[128:131], a[204:207], a[228:231], a[128:131]
ds_read_b128 a[248:251], v12 offset:16384
ds_read_b128 a[252:255], v13 offset:16384
M a[128:131], a[200:203], a[224:227], a[128:131]
s_add_u32 s94, s93, 4096
buffer_store_dwordx4 v[216:219], v1, s[16:19], s94 offen offset:3072 sc1
M a[132:135], a[208:211], a[224:227], a[132:135]
ds_read_b64_tr_b16 a[196:197], v19 offset:12288
ds_read_b64_tr_b16 a[198:199], v19 offset:13824
M a[132:135], a[212:215], a[228:231], a[132:135]
M a[136:139], a[220:223], a[228:231], a[136:139]
s_add_u32 s94, s93, 8192
buffer_store_dwordx4 v[224:227], v1, s[16:19], s94 offen offset:0 sc1
M a[136:139], a[216:219], a[224:227], a[136:139]
s_waitcnt lgkmcnt(10)
M a[140:143], a[200:203], a[232:235], a[140:143]
s_add_u32 s94, s93, 8192
buffer_store_dwordx4 v[232:235], v1, s[16:19], s94 offen offset:1024 sc1
M a[140:143], a[204:207], a[236:239], a[140:143]
M a[144:147], a[212:215], a[236:239], a[144:147]
M a[144:147], a[208:211], a[232:235], a[144:147]
M a[148:151], a[216:219], a[232:235], a[148:151]
s_waitcnt vmcnt(20) lgkmcnt(0)
s_barrier
ds_read_b128 a[224:227], v10 offset:0
ds_read_b128 a[228:231], v11 offset:0
M a[148:151], a[220:223], a[236:239], a[148:151]
s_add_u32 m0, s28, 131072
s_nop 0
buffer_load_dword v20, s[8:11], s24 offen lds
M a[152:155], a[204:207], a[244:247], a[152:155]
ds_read_b128 a[232:235], v10 offset:2048
ds_read_b128 a[236:239], v11 offset:2048
M a[152:155], a[200:203], a[240:243], a[152:155]
M a[156:159], a[208:211], a[240:243], a[156:159]
buffer_load_dword v23, s[8:11], s24 offen offset:256 lds
s_add_u32 s24, s24, 128
M a[156:159], a[212:215], a[244:247], a[156:159]
M a[160:163], a[220:223], a[244:247], a[160:163]
M a[160:163], a[216:219], a[240:243], a[160:163]
s_add_u32 m0, s29, 133120
s_nop 0
buffer_load_dwordx4 v2, s[8:11], s23 offen offset:0 lds
M a[164:167], a[200:203], a[248:251], a[164:167]
ds_read_b128 a[240:243], v10 offset:4096
ds_read_b128 a[244:247], v11 offset:4096
M a[164:167], a[204:207], a[252:255], a[164:167]
M a[168:171], a[212:215], a[252:255], a[168:171]
M a[168:171], a[208:211], a[248:251], a[168:171]
buffer_load_dwordx4 v3, s[8:11], s23 offen offset:1024 lds
M a[172:175], a[216:219], a[248:251], a[172:175]
M a[172:175], a[220:223], a[252:255], a[172:175]
s_waitcnt lgkmcnt(4)
M a[68:71], a[176:179], a[224:227], a[68:71]
ds_read_b128 a[248:251], v10 offset:6144
ds_read_b128 a[252:255], v11 offset:6144
M a[68:71], a[180:183], a[228:231], a[68:71]
buffer_load_dwordx4 v4, s[8:11], s23 offen offset:2048 lds
M a[72:75], a[188:191], a[228:231], a[72:75]
ds_read_b64_tr_b16 a[200:201], v14 offset:0
ds_read_b64_tr_b16 a[202:203], v14 offset:1536
M a[72:75], a[184:187], a[224:227], a[72:75]
M a[76:79], a[192:195], a[224:227], a[76:79]
buffer_load_dwordx4 v5, s[8:11], s23 offen offset:3072 lds
s_add_u32 s23, s23, 128
M a[76:79], a[196:199], a[228:231], a[76:79]
s_waitcnt lgkmcnt(6)
M a[80:83], a[180:183], a[236:239], a[80:83]
ds_read_b128 a[224:227], v10 offset:8192
ds_read_b128 a[228:231], v11 offset:8192
M a[80:83], a[176:179], a[232:235], a[80:83]
s_add_u32 m0, s30, 98304
s_nop 0
buffer_load_dwordx4 v6, s[12:15], s25 offen offset:0 lds
M a[84:87], a[184:187], a[232:235], a[84:87]
ds_read_b64_tr_b16 a[208:209], v15 offset:0
ds_read_b64_tr_b16 a[210:211], v15 offset:1536
M a[84:87], a[188:191], a[236:239], a[84:87]
M a[88:91], a[196:199], a[236:239], a[88:91]
buffer_load_dwordx4 v7, s[12:15], s25 offen offset:1024 lds
M a[88:91], a[192:195], a[232:235], a[88:91]
s_waitcnt lgkmcnt(8)
M a[92:95], a[176:179], a[240:243], a[92:95]
ds_read_b128 a[232:235], v10 offset:10240
ds_read_b128 a[236:239], v11 offset:10240
M a[92:95], a[180:183], a[244:247], a[92:95]
M a[96:99], a[188:191], a[244:247], a[96:99]
ds_read_b64_tr_b16 a[216:217], v16 offset:0
ds_read_b64_tr_b16 a[218:219], v16 offset:1536
M a[96:99], a[184:187], a[240:243], a[96:99]
buffer_load_dwordx4 v8, s[12:15], s25 offen offset:2048 lds
M a[100:103], a[192:195], a[240:243], a[100:103]
M a[100:103], a[196:199], a[244:247], a[100:103]
buffer_load_dwordx4 v9, s[12:15], s25 offen offset:3072 lds
s_waitcnt lgkmcnt(10)
M a[104:107], a[180:183], a[252:255], a[104:107]
ds_read_b128 a[240:243], v10 offset:12288
ds_read_b128 a[244:247], v11 offset:12288
M a[104:107], a[176:179], a[248:251], a[104:107]
M a[108:111], a[184:187], a[248:251], a[108:111]
ds_read_b64_tr_b16 a[204:205], v14 offset:12288
ds_read_b64_tr_b16 a[206:207], v14 offset:13824
M a[108:111], a[188:191], a[252:255], a[108:111]
s_add_u32 m0, s30, 102400
s_nop 0
buffer_load_dwordx4 v21, s[12:15], s25 offen offset:0 lds
M a[112:115], a[196:199], a[252:255], a[112:115]
M a[112:115], a[192:195], a[248:251], a[112:115]
buffer_load_dwordx4 v22, s[12:15], s25 offen offset:1024 lds
s_add_u32 s25, s25, 393216
s_waitcnt lgkmcnt(10)
M a[116:119], a[176:179], a[224:227], a[116:119]
ds_read_b128 a[248:251], v10 offset:14336
ds_read_b128 a[252:255], v11 offset:14336
M a[116:119], a[180:183], a[228:231], a[116:119]
M a[120:123], a[188:191], a[228:231], a[120:123]
ds_read_b64_tr_b16 a[212:213], v15 offset:12288
ds_read_b64_tr_b16 a[214:215], v15 offset:13824
M a[120:123], a[184:187], a[224:227], a[120:123]
M a[124:127], a[192:195], a[224:227], a[124:127]
s_add_u32 s94, s93, 8192
buffer_store_dwordx4 v[240:243], v1, s[16:19], s94 offen offset:2048 sc1
M a[124:127], a[196:199], a[228:231], a[124:127]
s_waitcnt lgkmcnt(10)
M a[128:131], a[180:183], a[236:239], a[128:131]
ds_read_b128 a[224:227], v10 offset:16384
ds_read_b128 a[228:231], v11 offset:16384
M a[128:131], a[176:179], a[232:235], a[128:131]
s_add_u32 s94, s93, 8192
buffer_store_dwordx4 v[248:251], v1, s[16:19], s94 offen offset:3072 sc1
M a[132:135], a[184:187], a[232:235], a[132:135]
ds_read_b64_tr_b16 a[220:221], v16 offset:12288
ds_read_b64_tr_b16 a[222:223], v16 offset:13824
M a[132:135], a[188:191], a[236:239], a[132:135]
M a[136:139], a[196:199], a[236:239], a[136:139]
s_add_u32 s94, s93, 12288
buffer_store_dwordx4 v[36:39], v1, s[16:19], s94 offen offset:0 sc1
M a[136:139], a[192:195], a[232:235], a[136:139]
s_waitcnt lgkmcnt(10)
M a[140:143], a[176:179], a[240:243], a[140:143]
s_add_u32 s94, s93, 12288
buffer_store_dwordx4 v[44:47], v1, s[16:19], s94 offen offset:1024 sc1
M a[140:143], a[180:183], a[244:247], a[140:143]
M a[144:147], a[188:191], a[244:247], a[144:147]
M a[144:147], a[184:187], a[240:243], a[144:147]
M a[148:151], a[192:195], a[240:243], a[148:151]
s_waitcnt vmcnt(20) lgkmcnt(0)
s_barrier
ds_read_b128 a[232:235], v10 offset:18432
ds_read_b128 a[236:239], v11 offset:18432
M a[148:151], a[196:199], a[244:247], a[148:151]
s_add_u32 m0, s28, 0
s_nop 0
buffer_load_dword v20, s[8:11], s24 offen lds
M a[152:155], a[180:183], a[252:255], a[152:155]
ds_read_b128 a[240:243], v10 offset:20480
ds_read_b128 a[244:247], v11 offset:20480
M a[152:155], a[176:179], a[248:251], a[152:155]
M a[156:159], a[184:187], a[248:251], a[156:159]
buffer_load_dword v23, s[8:11], s24 offen offset:256 lds
s_add_u32 s24, s24, 128
M a[156:159], a[188:191], a[252:255], a[156:159]
M a[160:163], a[196:199], a[252:255], a[160:163]
M a[160:163], a[192:195], a[248:251], a[160:163]
s_add_u32 m0, s29, 2048
s_nop 0
buffer_load_dwordx4 v2, s[8:11], s23 offen offset:0 lds
M a[164:167], a[176:179], a[224:227], a[164:167]
ds_read_b128 a[248:251], v10 offset:22528
ds_read_b128 a[252:255], v11 offset:22528
M a[164:167], a[180:183], a[228:231], a[164:167]
M a[168:171], a[188:191], a[228:231], a[168:171]
M a[168:171], a[184:187], a[224:227], a[168:171]
buffer_load_dwordx4 v3, s[8:11], s23 offen offset:1024 lds
M a[172:175], a[192:195], a[224:227], a[172:175]
M a[172:175], a[196:199], a[228:231], a[172:175]
s_waitcnt lgkmcnt(4)
M a[68:71], a[200:203], a[232:235], a[68:71]
ds_read_b128 a[224:227], v10 offset:24576
ds_read_b128 a[228:231], v11 offset:24576
M a[68:71], a[204:207], a[236:239], a[68:71]
buffer_load_dwordx4 v4, s[8:11], s23 offen offset:2048 lds
M a[72:75], a[212:215], a[236:239], a[72:75]
ds_read_b64_tr_b16 a[176:177], v14 offset:28672
ds_read_b64_tr_b16 a[178:179], v14 offset:30208
M a[72:75], a[208:211], a[232:235], a[72:75]
M a[76:79], a[216:219], a[232:235], a[76:79]
buffer_load_dwordx4 v5, s[8:11], s23 offen offset:3072 lds
s_add_u32 s23, s23, 128
M a[76:79], a[220:223], a[236:239], a[76:79]
s_waitcnt lgkmcnt(6)
M a[80:83], a[204:207], a[244:247], a[80:83]
ds_read_b128 a[232:235], v10 offset:26624
ds_read_b128 a[236:239], v11 offset:26624
M a[80:83], a[200:203], a[240:243], a[80:83]
M a[84:87], a[208:211], a[240:243], a[84:87]
ds_read_b64_tr_b16 a[184:185], v15 offset:28672
ds_read_b64_tr_b16 a[186:187], v15 offset:30208
M a[84:87], a[212:215], a[244:247], a[84:87]
s_add_u32 m0, s30, 36864
s_nop 0
buffer_load_dwordx4 v6, s[12:15], s25 offen offset:0 lds
M a[88:91], a[220:223], a[244:247], a[88:91]
M a[88:91], a[216:219], a[240:243], a[88:91]
s_waitcnt lgkmcnt(8)
M a[92:95], a[200:203], a[248:251], a[92:95]
ds_read_b128 a[240:243], v10 offset:28672
ds_read_b128 a[244:247], v11 offset:28672
M a[92:95], a[204:207], a[252:255], a[92:95]
buffer_load_dwordx4 v7, s[12:15], s25 offen offset:1024 lds
M a[96:99], a[212:215], a[252:255], a[96:99]
ds_read_b64_tr_b16 a[192:193], v16 offset:28672
ds_read_b64_tr_b16 a[194:195], v16 offset:30208
M a[96:99], a[208:211], a[248:251], a[96:99]
M a[100:103], a[216:219], a[248:251], a[100:103]
buffer_load_dwordx4 v8, s[12:15], s25 offen offset:2048 lds
M a[100:103], a[220:223], a[252:255], a[100:103]
s_waitcnt lgkmcnt(10)
M a[104:107], a[204:207], a[228:231], a[104:107]
ds_read_b128 a[248:251], v10 offset:30720
ds_read_b128 a[252:255], v11 offset:30720
M a[104:107], a[200:203], a[224:227], a[104:107]
M a[108:111], a[208:211], a[224:227], a[108:111]
ds_read_b64_tr_b16 a[180:181], v14 offset:40960
ds_read_b64_tr_b16 a[182:183], v14 offset:42496
M a[108:111], a[212:215], a[228:231], a[108:111]
buffer_load_dwordx4 v9, s[12:15], s25 offen offset:3072 lds
M a[112:115], a[220:223], a[228:231], a[112:115]
M a[112:115], a[216:219], a[224:227], a[112:115]
s_waitcnt lgkmcnt(10)
M a[116:119], a[200:203], a[232:235], a[116:119]
ds_read_b128 a[224:227], v10 offset:32768
ds_read_b128 a[228:231], v11 offset:32768
M a[116:119], a[204:207], a[236:239], a[116:119]
s_add_u32 m0, s30, 40960
s_nop 0
buffer_load_dwordx4 v21, s[12:15], s25 offen offset:0 lds
M a[120:123], a[212:215], a[236:239], a[120:123]
ds_read_b64_tr_b16 a[188:189], v15 offset:40960
ds_read_b64_tr_b16 a[190:191], v15 offset:42496
M a[120:123], a[208:211], a[232:235], a[120:123]
M a[124:127], a[216:219], a[232:235], a[124:127]
buffer_load_dwordx4 v22, s[12:15], s25 offen offset:1024 lds
s_add_u32 s25, s25, 393216
M a[124:127], a[220:223], a[236:239], a[124:127]
s_waitcnt lgkmcnt(10)
M a[128:131], a[204:207], a[244:247], a[128:131]
ds_read_b128 a[232:235], v10 offset:34816
ds_read_b128 a[236:239], v11 offset:34816
M a[128:131], a[200:203], a[240:243], a[128:131]
M a[132:135], a[208:211], a[240:243], a[132:135]
ds_read_b64_tr_b16 a[196:197], v16 offset:40960
ds_read_b64_tr_b16 a[198:199], v16 offset:42496
M a[132:135], a[212:215], a[244:247], a[132:135]
s_add_u32 s94, s93, 12288
buffer_store_dwordx4 v[52:55], v1, s[16:19], s94 offen offset:2048 sc1
M a[136:139], a[220:223], a[244:247], a[136:139]
M a[136:139], a[216:219], a[240:243], a[136:139]
s_waitcnt lgkmcnt(10)
M a[140:143], a[200:203], a[248:251], a[140:143]
s_add_u32 s94, s93, 12288
buffer_store_dwordx4 v[60:63], v1, s[16:19], s94 offen offset:3072 sc1
M a[140:143], a[204:207], a[252:255], a[140:143]
M a[144:147], a[212:215], a[252:255], a[144:147]
M a[144:147], a[208:211], a[248:251], a[144:147]
M a[148:151], a[216:219], a[248:251], a[148:151]
s_waitcnt vmcnt(18) lgkmcnt(0)
s_barrier
ds_read_b128 a[240:243], v12 offset:0
ds_read_b128 a[244:247], v13 offset:0
M a[148:151], a[220:223], a[252:255], a[148:151]
s_add_u32 m0, s28, 18432
s_nop 0
buffer_load_dword v20, s[8:11], s24 offen lds
M a[152:155], a[204:207], a[228:231], a[152:155]
ds_read_b128 a[248:251], v12 offset:2048
ds_read_b128 a[252:255], v13 offset:2048
M a[152:155], a[200:203], a[224:227], a[152:155]
M a[156:159], a[208:211], a[224:227], a[156:159]
buffer_load_dword v23, s[8:11], s24 offen offset:256 lds
s_add_u32 s24, s24, 128
M a[156:159], a[212:215], a[228:231], a[156:159]
M a[160:163], a[220:223], a[228:231], a[160:163]
M a[160:163], a[216:219], a[224:227], a[160:163]
s_add_u32 m0, s29, 20480
s_nop 0
buffer_load_dwordx4 v2, s[8:11], s23 offen offset:0 lds
M a[164:167], a[200:203], a[232:235], a[164:167]
ds_read_b128 a[224:227], v12 offset:4096
ds_read_b128 a[228:231], v13 offset:4096
M a[164:167], a[204:207], a[236:239], a[164:167]
M a[168:171], a[212:215], a[236:239], a[168:171]
M a[168:171], a[208:211], a[232:235], a[168:171]
buffer_load_dwordx4 v3, s[8:11], s23 offen offset:1024 lds
M a[172:175], a[216:219], a[232:235], a[172:175]
M a[172:175], a[220:223], a[236:239], a[172:175]
s_waitcnt lgkmcnt(4)
M a[68:71], a[176:179], a[240:243], a[68:71]
ds_read_b128 a[232:235], v12 offset:6144
ds_read_b128 a[236:239], v13 offset:6144
M a[68:71], a[180:183], a[244:247], a[68:71]
buffer_load_dwordx4 v4, s[8:11], s23 offen offset:2048 lds
M a[72:75], a[188:191], a[244:247], a[72:75]
ds_read_b64_tr_b16 a[200:201], v17 offset:0
ds_read_b64_tr_b16 a[202:203], v17 offset:1536
M a[72:75], a[184:187], a[240:243], a[72:75]
M a[76:79], a[192:195], a[240:243], a[76:79]
M a[76:79], a[196:199], a[244:247], a[76:79]
buffer_load_dwordx4 v5, s[8:11], s23 offen offset:3072 lds
s_add_u32 s23, s23, 128
s_waitcnt lgkmcnt(6)
M a[80:83], a[180:183], a[252:255], a[80:83]
ds_read_b128 a[240:243], v12 offset:8192
ds_read_b128 a[244:247], v13 offset:8192
M a[80:83], a[176:179], a[248:251], a[80:83]
M a[84:87], a[184:187], a[248:251], a[84:87]
ds_read_b64_tr_b16 a[208:209], v18 offset:0
ds_read_b64_tr_b16 a[210:211], v18 offset:1536
M a[84:87], a[188:191], a[252:255], a[84:87]
M a[88:91], a[196:199], a[252:255], a[88:91]
s_add_u32 m0, s30, 65536
s_nop 0
buffer_load_dwordx4 v6, s[12:15], s25 offen offset:0 lds
M a[88:91], a[192:195], a[248:251], a[88:91]
s_waitcnt lgkmcnt(8)
M a[92:95], a[176:179], a[224:227], a[92:95]
ds_read_b128 a[248:251], v12 offset:10240
ds_read_b128 a[252:255], v13 offset:10240
M a[92:95], a[180:183], a[228:231], a[92:95]
M a[96:99], a[188:191], a[228:231], a[96:99]
ds_read_b64_tr_b16 a[216:217], v19 offset:0
ds_read_b64_tr_b16 a[218:219], v19 offset:1536
M a[96:99], a[184:187], a[224:227], a[96:99]
M a[100:103], a[192:195], a[224:227], a[100:103]
buffer_load_dwordx4 v7, s[12:15], s25 offen offset:1024 lds
M a[100:103], a[196:199], a[228:231], a[100:103]
s_waitcnt lgkmcnt(10)
M a[104:107], a[180:183], a[236:239], a[104:107]
ds_read_b128 a[224:227], v12 offset:12288
ds_read_b128 a[228:231], v13 offset:12288
M a[104:107], a[176:179], a[232:235], a[104:107]
M a[108:111], a[184:187], a[232:235], a[108:111]
ds_read_b64_tr_b16 a[204:205], v17 offset:12288
ds_read_b64_tr_b16 a[206:207], v17 offset:13824
M a[108:111], a[188:191], a[236:239], a[108:111]
buffer_load_dwordx4 v8, s[12:15], s25 offen offset:2048 lds
M a[112:115], a[196:199], a[236:239], a[112:115]
M a[112:115], a[192:195], a[232:235], a[112:115]
s_waitcnt lgkmcnt(10)
M a[116:119], a[176:179], a[240:243], a[116:119]
ds_read_b128 a[232:235], v12 offset:14336
ds_read_b128 a[236:239], v13 offset:14336
M a[116:119], a[180:183], a[244:247], a[116:119]
buffer_load_dwordx4 v9, s[12:15], s25 offen offset:3072 lds
M a[120:123], a[188:191], a[244:247], a[120:123]
ds_read_b64_tr_b16 a[212:213], v18 offset:12288
ds_read_b64_tr_b16 a[214:215], v18 offset:13824
M a[120:123], a[184:187], a[240:243], a[120:123]
M a[124:127], a[192:195], a[240:243], a[124:127]
M a[124:127], a[196:199], a[244:247], a[124:127]
s_waitcnt lgkmcnt(10)
M a[128:131], a[180:183], a[252:255], a[128:131]
ds_read_b128 a[240:243], v12 offset:16384
ds_read_b128 a[244:247], v13 offset:16384
M a[128:131], a[176:179], a[248:251], a[128:131]
s_add_u32 m0, s30, 69632
s_nop 0
buffer_load_dwordx4 v21, s[12:15], s25 offen offset:0 lds
M a[132:135], a[184:187], a[248:251], a[132:135]
ds_read_b64_tr_b16 a[220:221], v19 offset:12288
ds_read_b64_tr_b16 a[222:223], v19 offset:13824
M a[132:135], a[188:191], a[252:255], a[132:135]
M a[136:139], a[196:199], a[252:255], a[136:139]
M a[136:139], a[192:195], a[248:251], a[136:139]
buffer_load_dwordx4 v22, s[12:15], s25 offen offset:1024 lds
s_add_u32 s25, s25, 393216
s_waitcnt lgkmcnt(10)
M a[140:143], a[176:179], a[224:227], a[140:143]
M a[140:143], a[180:183], a[228:231], a[140:143]
M a[144:147], a[188:191], a[228:231], a[144:147]
M a[144:147], a[184:187], a[224:227], a[144:147]
M a[148:151], a[192:195], a[224:227], a[148:151]
s_waitcnt vmcnt(12) lgkmcnt(0)
s_barrier
ds_read_b128 a[248:251], v10 offset:0
ds_read_b128 a[252:255], v11 offset:0
s_cmp_lg_u32 s101, 0
s_cbranch_scc1 Lk1_arr
v_mov_b32 v127, 1
s_and_b32 s41, s2, 128
s_mov_b64 exec, 1
buffer_atomic_add v127, off, s[36:39], s41 sc1
s_mov_b64 exec, -1
Lk1_arr:
M a[148:151], a[196:199], a[228:231], a[148:151]
s_add_u32 m0, s28, 131072
s_nop 0
buffer_load_dword v20, s[8:11], s24 offen lds
M a[152:155], a[180:183], a[236:239], a[152:155]
ds_read_b128 a[224:227], v10 offset:2048
ds_read_b128 a[228:231], v11 offset:2048
M a[152:155], a[176:179], a[232:235], a[152:155]
M a[156:159], a[184:187], a[232:235], a[156:159]
buffer_load_dword v23, s[8:11], s24 offen offset:256 lds
s_add_u32 s24, s24, 128
M a[156:159], a[188:191], a[236:239], a[156:159]
M a[160:163], a[196:199], a[236:239], a[160:163]
M a[160:163], a[192:195], a[232:235], a[160:163]
s_add_u32 m0, s29, 133120
s_nop 0
buffer_load_dwordx4 v2, s[8:11], s23 offen offset:0 lds
M a[164:167], a[176:179], a[240:243], a[164:167]
ds_read_b128 a[232:235], v10 offset:4096
ds_read_b128 a[236:239], v11 offset:4096
M a[164:167], a[180:183], a[244:247], a[164:167]
M a[168:171], a[188:191], a[244:247], a[168:171]
M a[168:171], a[184:187], a[240:243], a[168:171]
buffer_load_dwordx4 v3, s[8:11], s23 offen offset:1024 lds
M a[172:175], a[192:195], a[240:243], a[172:175]
M a[172:175], a[196:199], a[244:247], a[172:175]
s_waitcnt lgkmcnt(4)
M a[68:71], a[200:203], a[248:251], a[68:71]
ds_read_b128 a[240:243], v10 offset:6144
ds_read_b128 a[244:247], v11 offset:6144
M a[68:71], a[204:207], a[252:255], a[68:71]
buffer_load_dwordx4 v4, s[8:11], s23 offen offset:2048 lds
M a[72:75], a[212:215], a[252:255], a[72:75]
ds_read_b64_tr_b16 a[176:177], v14 offset:0
ds_read_b64_tr_b16 a[178:179], v14 offset:1536
M a[72:75], a[208:211], a[248:251], a[72:75]
M a[76:79], a[216:219], a[248:251], a[76:79]
M a[76:79], a[220:223], a[252:255], a[76:79]
buffer_load_dwordx4 v5, s[8:11], s23 offen offset:3072 lds
s_add_u32 s23, s23, 128
s_waitcnt lgkmcnt(6)
M a[80:83], a[204:207], a[228:231], a[80:83]
ds_read_b128 a[248:251], v10 offset:8192
ds_read_b128 a[252:255], v11 offset:8192
M a[80:83], a[200:203], a[224:227], a[80:83]
M a[84:87], a[208:211], a[224:227], a[84:87]
ds_read_b64_tr_b16 a[184:185], v15 offset:0
ds_read_b64_tr_b16 a[186:187], v15 offset:1536
M a[84:87], a[212:215], a[228:231], a[84:87]
M a[88:91], a[220:223], a[228:231], a[88:91]
s_add_u32 m0, s30, 98304
s_nop 0
buffer_load_dwordx4 v6, s[12:15], s25 offen offset:0 lds
M a[88:91], a[216:219], a[224:227], a[88:91]
s_waitcnt lgkmcnt(8)
M a[92:95], a[200:203], a[232:235], a[92:95]
ds_read_b128 a[224:227], v10 offset:10240
ds_read_b128 a[228:231], v11 offset:10240
M a[92:95], a[204:207], a[236:239], a[92:95]
M a[96:99], a[212:215], a[236:239], a[96:99]
ds_read_b64_tr_b16 a[192:193], v16 offset:0
ds_read_b64_tr_b16 a[194:195], v16 offset:1536
M a[96:99], a[208:211], a[232:235], a[96:99]
M a[100:103], a[216:219], a[232:235], a[100:103]
buffer_load_dwordx4 v7, s[12:15], s25 offen offset:1024 lds
M a[100:103], a[220:223], a[236:239], a[100:103]
s_waitcnt lgkmcnt(10)
M a[104:107], a[204:207], a[244:247], a[104:107]
ds_read_b128 a[232:235], v10 offset:12288
ds_read_b128 a[236:239], v11 offset:12288
M a[104:107], a[200:203], a[240:243], a[104:107]
M a[108:111], a[208:211], a[240:243], a[108:111]
ds_read_b64_tr_b16 a[180:181], v14 offset:12288
ds_read_b64_tr_b16 a[182:183], v14 offset:13824
M a[108:111], a[212:215], a[244:247], a[108:111]
buffer_load_dwordx4 v8, s[12:15], s25 offen offset:2048 lds
M a[112:115], a[220:223], a[244:247], a[112:115]
M a[112:115], a[216:219], a[240:243], a[112:115]
s_waitcnt lgkmcnt(10)
M a[116:119], a[200:203], a[248:251], a[116:119]
ds_read_b128 a[240:243], v10 offset:14336
ds_read_b128 a[244:247], v11 offset:14336
M a[116:119], a[204:207], a[252:255], a[116:119]
buffer_load_dwordx4 v9, s[12:15], s25 offen offset:3072 lds
M a[120:123], a[212:215], a[252:255], a[120:123]
ds_read_b64_tr_b16 a[188:189], v15 offset:12288
ds_read_b64_tr_b16 a[190:191], v15 offset:13824
M a[120:123], a[208:211], a[248:251], a[120:123]
M a[124:127], a[216:219], a[248:251], a[124:127]
M a[124:127], a[220:223], a[252:255], a[124:127]
s_waitcnt lgkmcnt(10)
M a[128:131], a[204:207], a[228:231], a[128:131]
ds_read_b128 a[248:251], v10 offset:16384
ds_read_b128 a[252:255], v11 offset:16384
M a[128:131], a[200:203], a[224:227], a[128:131]
s_add_u32 m0, s30, 102400
s_nop 0
buffer_load_dwordx4 v21, s[12:15], s25 offen offset:0 lds
M a[132:135], a[208:211], a[224:227], a[132:135]
ds_read_b64_tr_b16 a[196:197], v16 offset:12288
ds_read_b64_tr_b16 a[198:199], v16 offset:13824
M a[132:135], a[212:215], a[228:231], a[132:135]
M a[136:139], a[220:223], a[228:231], a[136:139]
M a[136:139], a[216:219], a[224:227], a[136:139]
buffer_load_dwordx4 v22, s[12:15], s25 offen offset:1024 lds
s_add_u32 s25, s25, 393216
s_waitcnt lgkmcnt(10)
M a[140:143], a[200:203], a[232:235], a[140:143]
M a[140:143], a[204:207], a[236:239], a[140:143]
M a[144:147], a[212:215], a[236:239], a[144:147]
M a[144:147], a[208:211], a[232:235], a[144:147]
M a[148:151], a[216:219], a[232:235], a[148:151]
s_waitcnt vmcnt(12) lgkmcnt(0)
s_barrier
ds_read_b128 a[224:227], v10 offset:18432
ds_read_b128 a[228:231], v11 offset:18432
M a[148:151], a[220:223], a[236:239], a[148:151]
s_add_u32 m0, s28, 0
s_nop 0
buffer_load_dword v20, s[8:11], s24 offen lds
M a[152:155], a[204:207], a[244:247], a[152:155]
ds_read_b128 a[232:235], v10 offset:20480
ds_read_b128 a[236:239], v11 offset:20480
M a[152:155], a[200:203], a[240:243], a[152:155]
M a[156:159], a[208:211], a[240:243], a[156:159]
buffer_load_dword v23, s[8:11], s24 offen offset:256 lds
s_add_u32 s24, s24, 128
M a[156:159], a[212:215], a[244:247], a[156:159]
M a[160:163], a[220:223], a[244:247], a[160:163]
M a[160:163], a[216:219], a[240:243], a[160:163]
s_add_u32 m0, s29, 2048
s_nop 0
buffer_load_dwordx4 v2, s[8:11], s23 offen offset:0 lds
M a[164:167], a[200:203], a[248:251], a[164:167]
ds_read_b128 a[240:243], v10 offset:22528
ds_read_b128 a[244:247], v11 offset:22528
M a[164:167], a[204:207], a[252:255], a[164:167]
M a[168:171], a[212:215], a[252:255], a[168:171]
M a[168:171], a[208:211], a[248:251], a[168:171]
buffer_load_dwordx4 v3, s[8:11], s23 offen offset:1024 lds
M a[172:175], a[216:219], a[248:251], a[172:175]
M a[172:175], a[220:223], a[252:255], a[172:175]
s_waitcnt lgkmcnt(4)
M a[68:71], a[176:179], a[224:227], a[68:71]
ds_read_b128 a[248:251], v10 offset:24576
ds_read_b128 a[252:255], v11 offset:24576
v_mov_b32 v160, 0
v_mov_b32 v161, 0
M a[68:71], a[180:183], a[228:231], a[68:71]
buffer_load_dwordx4 v4, s[8:11], s23 offen offset:2048 lds
M a[72:75], a[188:191], a[228:231], a[72:75]
ds_read_b64_tr_b16 a[200:201], v14 offset:28672
ds_read_b64_tr_b16 a[202:203], v14 offset:30208
v_mov_b32 v162, 0
v_mov_b32 v163, 0
M a[72:75], a[184:187], a[224:227], a[72:75]
M a[76:79], a[192:195], a[224:227], a[76:79]
v_mov_b32 v164, 0
v_mov_b32 v165, 0
M a[76:79], a[196:199], a[228:231], a[76:79]
buffer_load_dwordx4 v5, s[8:11], s23 offen offset:3072 lds
s_add_u32 s23, s23, 128
s_waitcnt lgkmcnt(6)
M a[80:83], a[180:183], a[236:239], a[80:83]
ds_read_b128 a[224:227], v10 offset:26624
ds_read_b128 a[228:231], v11 offset:26624
v_mov_b32 v166, 0
v_mov_b32 v167, 0
M a[80:83], a[176:179], a[232:235], a[80:83]
M a[84:87], a[184:187], a[232:235], a[84:87]
ds_read_b64_tr_b16 a[208:209], v15 offset:28672
ds_read_b64_tr_b16 a[210:211], v15 offset:30208
M a[84:87], a[188:191], a[236:239], a[84:87]
v_mov_b32 v168, 0
v_mov_b32 v169, 0
M a[88:91], a[196:199], a[236:239], a[88:91]
s_add_u32 m0, s30, 36864
s_nop 0
buffer_load_dwordx4 v6, s[12:15], s25 offen offset:0 lds
M a[88:91], a[192:195], a[232:235], a[88:91]
s_waitcnt lgkmcnt(8)
v_mov_b32 v170, 0
v_mov_b32 v171, 0
M a[92:95], a[176:179], a[240:243], a[92:95]
ds_read_b128 a[232:235], v10 offset:28672
ds_read_b128 a[236:239], v11 offset:28672
M a[92:95], a[180:183], a[244:247], a[92:95]
v_mov_b32 v172, 0
v_mov_b32 v173, 0
M a[96:99], a[188:191], a[244:247], a[96:99]
ds_read_b64_tr_b16 a[216:217], v16 offset:28672
ds_read_b64_tr_b16 a[218:219], v16 offset:30208
M a[96:99], a[184:187], a[240:243], a[96:99]
buffer_load_dwordx4 v7, s[12:15], s25 offen offset:1024 lds
v_mov_b32 v174, 0
v_mov_b32 v175, 0
M a[100:103], a[192:195], a[240:243], a[100:103]
M a[100:103], a[196:199], a[244:247], a[100:103]
s_waitcnt lgkmcnt(10)
M a[104:107], a[180:183], a[252:255], a[104:107]
ds_read_b128 a[240:243], v10 offset:30720
ds_read_b128 a[244:247], v11 offset:30720
v_mov_b32 v176, 0
v_mov_b32 v177, 0
M a[104:107], a[176:179], a[248:251], a[104:107]
buffer_load_dwordx4 v8, s[12:15], s25 offen offset:2048 lds
M a[108:111], a[184:187], a[248:251], a[108:111]
ds_read_b64_tr_b16 a[204:205], v14 offset:40960
ds_read_b64_tr_b16 a[206:207], v14 offset:42496
v_mov_b32 v178, 0
v_mov_b32 v179, 0
M a[108:111], a[188:191], a[252:255], a[108:111]
M a[112:115], a[196:199], a[252:255], a[112:115]
v_mov_b32 v180, 0
v_mov_b32 v181, 0
M a[112:115], a[192:195], a[248:251], a[112:115]
buffer_load_dwordx4 v9, s[12:15], s25 offen offset:3072 lds
s_waitcnt lgkmcnt(10)
M a[116:119], a[176:179], a[224:227], a[116:119]
ds_read_b128 a[248:251], v10 offset:32768
ds_read_b128 a[252:255], v11 offset:32768
v_mov_b32 v182, 0
v_mov_b32 v183, 0
M a[116:119], a[180:183], a[228:231], a[116:119]
M a[120:123], a[188:191], a[228:231], a[120:123]
ds_read_b64_tr_b16 a[212:213], v15 offset:40960
ds_read_b64_tr_b16 a[214:215], v15 offset:42496
M a[120:123], a[184:187], a[224:227], a[120:123]
v_mov_b32 v184, 0
v_mov_b32 v185, 0
M a[124:127], a[192:195], a[224:227], a[124:127]
s_add_u32 m0, s30, 40960
s_nop 0
buffer_load_dwordx4 v21, s[12:15], s25 offen offset:0 lds
M a[124:127], a[196:199], a[228:231], a[124:127]
s_waitcnt lgkmcnt(10)
v_mov_b32 v186, 0
v_mov_b32 v187, 0
M a[128:131], a[180:183], a[236:239], a[128:131]
ds_read_b128 a[224:227], v10 offset:34816
ds_read_b128 a[228:231], v11 offset:34816
M a[128:131], a[176:179], a[232:235], a[128:131]
v_mov_b32 v188, 0
v_mov_b32 v189, 0
M a[132:135], a[184:187], a[232:235], a[132:135]
ds_read_b64_tr_b16 a[220:221], v16 offset:40960
ds_read_b64_tr_b16 a[222:223], v16 offset:42496
M a[132:135], a[188:191], a[236:239], a[132:135]
buffer_load_dwordx4 v22, s[12:15], s25 offen offset:1024 lds
s_add_u32 s25, s25, 393216
v_mov_b32 v190, 0
v_mov_b32 v191, 0
M a[136:139], a[196:199], a[236:239], a[136:139]
M a[136:139], a[192:195], a[232:235], a[136:139]
s_waitcnt lgkmcnt(10)
M a[140:143], a[176:179], a[240:243], a[140:143]
s_getpc_b64 s[56:57]
Lpcd:
s_add_u32 s56, s56, Lc2-Lpcd
s_addc_u32 s57, s57, 0
s_lshr_b32 s58, s2, 3
s_lshl2_add_u32 s58, s58, s101
s_mul_i32 s58, s58, (((Lk2_chk-Lc2)/128+127)&~127)
v_lshlrev_b32 v116, 7, v0
v_min_u32 v116, (((Lk2_chk-Lc2)/128+127)&~127)-128, v116
v_add_u32 v116, s58, v116
v_min_u32 v116, Lk2_chk-Lc2-4, v116
global_load_dword v117, v116, s[56:57]
v_mov_b32 v192, 0
v_mov_b32 v193, 0
M a[140:143], a[180:183], a[244:247], a[140:143]
M a[144:147], a[188:191], a[244:247], a[144:147]
v_mov_b32 v194, 0
v_mov_b32 v195, 0
M a[144:147], a[184:187], a[240:243], a[144:147]
M a[148:151], a[192:195], a[240:243], a[148:151]
s_waitcnt vmcnt(13) lgkmcnt(0)
s_barrier
ds_read_b128 a[232:235], v12 offset:0
ds_read_b128 a[236:239], v13 offset:0
v_mov_b32 v196, 0
v_mov_b32 v197, 0
M a[148:151], a[196:199], a[244:247], a[148:151]
s_add_u32 m0, s28, 18432
s_nop 0
buffer_load_dword v20, s[8:11], s24 offen lds
M a[152:155], a[180:183], a[252:255], a[152:155]
ds_read_b128 a[240:243], v12 offset:2048
ds_read_b128 a[244:247], v13 offset:2048
v_mov_b32 v198, 0
v_mov_b32 v199, 0
M a[152:155], a[176:179], a[248:251], a[152:155]
M a[156:159], a[184:187], a[248:251], a[156:159]
buffer_load_dword v23, s[8:11], s24 offen offset:256 lds
s_add_u32 s24, s24, 128
M a[156:159], a[188:191], a[252:255], a[156:159]
v_mov_b32 v200, 0
v_mov_b32 v201, 0
M a[160:163], a[196:199], a[252:255], a[160:163]
M a[160:163], a[192:195], a[248:251], a[160:163]
s_add_u32 m0, s29, 20480
s_nop 0
buffer_load_dwordx4 v2, s[8:11], s23 offen offset:0 lds
v_mov_b32 v202, 0
v_mov_b32 v203, 0
M a[164:167], a[176:179], a[224:227], a[164:167]
ds_read_b128 a[248:251], v12 offset:4096
ds_read_b128 a[252:255], v13 offset:4096
M a[164:167], a[180:183], a[228:231], a[164:167]
v_mov_b32 v204, 0
v_mov_b32 v205, 0
M a[168:171], a[188:191], a[228:231], a[168:171]
M a[168:171], a[184:187], a[224:227], a[168:171]
buffer_load_dwordx4 v3, s[8:11], s23 offen offset:1024 lds
v_mov_b32 v206, 0
v_mov_b32 v207, 0
M a[172:175], a[192:195], a[224:227], a[172:175]
M a[172:175], a[196:199], a[228:231], a[172:175]
s_waitcnt lgkmcnt(4)
M a[68:71], a[200:203], a[232:235], a[68:71]
ds_read_b128 a[224:227], v12 offset:6144
ds_read_b128 a[228:231], v13 offset:6144
v_and_b32 v128, 15, v0
v_mul_u32_u24 v128, 400, v128
M a[68:71], a[204:207], a[236:239], a[68:71]
buffer_load_dwordx4 v4, s[8:11], s23 offen offset:2048 lds
M a[72:75], a[212:215], a[236:239], a[72:75]
ds_read_b64_tr_b16 a[176:177], v17 offset:0
ds_read_b64_tr_b16 a[178:179], v17 offset:1536
v_lshrrev_b32 v129, 4, v0
v_lshl_add_u32 v128, v129, 3, v128
M a[72:75], a[208:211], a[232:235], a[72:75]
M a[76:79], a[216:219], a[232:235], a[76:79]
s_mul_i32 s3, s20, 96
s_add_u32 s3, s3, 98304
M a[76:79], a[220:223], a[236:239], a[76:79]
buffer_load_dwordx4 v5, s[8:11], s23 offen offset:3072 lds
s_add_u32 s23, s23, 128
s_waitcnt lgkmcnt(6)
M a[80:83], a[204:207], a[244:247], a[80:83]
ds_read_b128 a[232:235], v12 offset:8192
ds_read_b128 a[236:239], v13 offset:8192
v_add_u32 v124, s3, v128
v_and_b32 v128, 15, v0
M a[80:83], a[200:203], a[240:243], a[80:83]
M a[84:87], a[208:211], a[240:243], a[84:87]
ds_read_b64_tr_b16 a[184:185], v18 offset:0
ds_read_b64_tr_b16 a[186:187], v18 offset:1536
v_lshrrev_b32 v129, 4, v0
s_add_u32 s3, s21, 16
M a[84:87], a[212:215], a[244:247], a[84:87]
M a[88:91], a[220:223], a[244:247], a[88:91]
s_add_u32 m0, s30, 65536
s_nop 0
buffer_load_dwordx4 v6, s[12:15], s25 offen offset:0 lds
v_lshl_add_u32 v130, v128, 1, s3
s_lshl_b32 s4, s22, 6
M a[88:91], a[216:219], a[240:243], a[88:91]
s_waitcnt lgkmcnt(8)
M a[92:95], a[200:203], a[248:251], a[92:95]
ds_read_b128 a[240:243], v12 offset:10240
ds_read_b128 a[244:247], v13 offset:10240
s_add_u32 s4, s4, 98304
v_mul_u32_u24 v120, 400, v130
M a[92:95], a[204:207], a[252:255], a[92:95]
M a[96:99], a[212:215], a[252:255], a[96:99]
ds_read_b64_tr_b16 a[192:193], v19 offset:0
ds_read_b64_tr_b16 a[194:195], v19 offset:1536
M a[96:99], a[208:211], a[248:251], a[96:99]
v_lshl_add_u32 v120, v129, 4, v120
v_add_u32 v120, s4, v120
M a[100:103], a[216:219], a[248:251], a[100:103]
buffer_load_dwordx4 v7, s[12:15], s25 offen offset:1024 lds
M a[100:103], a[220:223], a[252:255], a[100:103]
s_waitcnt lgkmcnt(10)
v_subrev_u32 v130, 32, v130
v_max_i32 v130, 0, v130
M a[104:107], a[204:207], a[228:231], a[104:107]
ds_read_b128 a[248:251], v12 offset:12288
ds_read_b128 a[252:255], v13 offset:12288
M a[104:107], a[200:203], a[224:227], a[104:107]
v_mul_u32_u24 v121, 400, v130
v_lshl_add_u32 v121, v129, 4, v121
M a[108:111], a[208:211], a[224:227], a[108:111]
ds_read_b64_tr_b16 a[180:181], v17 offset:12288
ds_read_b64_tr_b16 a[182:183], v17 offset:13824
M a[108:111], a[212:215], a[228:231], a[108:111]
buffer_load_dwordx4 v8, s[12:15], s25 offen offset:2048 lds
v_add_u32 v121, s4, v121
v_bfe_u32 v131, v0, 2, 2
M a[112:115], a[220:223], a[228:231], a[112:115]
M a[112:115], a[216:219], a[224:227], a[112:115]
s_waitcnt lgkmcnt(10)
v_lshl_add_u32 v131, v129, 2, v131
v_lshl_add_u32 v131, v131, 1, s3
M a[116:119], a[200:203], a[232:235], a[116:119]
ds_read_b128 a[224:227], v12 offset:14336
ds_read_b128 a[228:231], v13 offset:14336
M a[116:119], a[204:207], a[236:239], a[116:119]
buffer_load_dwordx4 v9, s[12:15], s25 offen offset:3072 lds
v_and_b32 v132, 3, v0
v_lshlrev_b32 v132, 3, v132
M a[120:123], a[212:215], a[236:239], a[120:123]
ds_read_b64_tr_b16 a[188:189], v18 offset:12288
ds_read_b64_tr_b16 a[190:191], v18 offset:13824
M a[120:123], a[208:211], a[232:235], a[120:123]
M a[124:127], a[216:219], a[232:235], a[124:127]
v_add_u32 v132, s4, v132
s_movk_i32 s5, 400
M a[124:127], a[220:223], a[236:239], a[124:127]
s_waitcnt lgkmcnt(10)
M a[128:131], a[204:207], a[244:247], a[128:131]
ds_read_b128 a[232:235], v12 offset:16384
ds_read_b128 a[236:239], v13 offset:16384
v_mad_u32_u24 v122, v131, s5, v132
v_subrev_u32 v131, 32, v131
M a[128:131], a[200:203], a[240:243], a[128:131]
s_add_u32 m0, s30, 69632
s_nop 0
buffer_load_dwordx4 v21, s[12:15], s25 offen offset:0 lds
M a[132:135], a[208:211], a[240:243], a[132:135]
ds_read_b64_tr_b16 a[196:197], v19 offset:12288
ds_read_b64_tr_b16 a[198:199], v19 offset:13824
v_max_i32 v131, 0, v131
v_mad_u32_u24 v123, v131, s5, v132
M a[132:135], a[212:215], a[244:247], a[132:135]
M a[136:139], a[220:223], a[244:247], a[136:139]
v_lshlrev_b32 v129, 2, v129
v_sub_u32 v128, v128, v129
M a[136:139], a[216:219], a[240:243], a[136:139]
buffer_load_dwordx4 v22, s[12:15], s25 offen offset:1024 lds
s_add_u32 s25, s25, 393216
s_waitcnt lgkmcnt(10)
M a[140:143], a[200:203], a[248:251], a[140:143]
v_mov_b32 v129, 0xf149f2ca
s_cmp_eq_u32 s26, 0
s_cselect_b32 s3, 0xf149f2ca, 0
M a[140:143], a[204:207], a[252:255], a[140:143]
M a[144:147], a[212:215], a[252:255], a[144:147]
v_cmp_lt_i32 vcc, -9, v128
s_nop 1
v_cndmask_b32 v144, 0, v129, vcc
M a[144:147], a[208:211], a[248:251], a[144:147]
M a[148:151], a[216:219], a[248:251], a[148:151]
s_waitcnt vmcnt(13) lgkmcnt(0)
s_barrier
ds_read_b128 a[240:243], v10 offset:0
ds_read_b128 a[244:247], v11 offset:0
M a[148:151], a[220:223], a[252:255], a[148:151]
s_add_u32 m0, s28, 131072
s_nop 0
buffer_load_dword v20, s[8:11], s24 offen lds
v_subrev_u32 v130, 0, v128
v_cmp_lt_u32 vcc, 7, v130
s_nop 1
v_cndmask_b32 v148, 0, v129, vcc
M a[152:155], a[204:207], a[228:231], a[152:155]
ds_read_b128 a[248:251], v10 offset:2048
ds_read_b128 a[252:255], v11 offset:2048
M a[152:155], a[200:203], a[224:227], a[152:155]
v_min_f32 v152, s3, v144
v_mov_b32 v156, 0x3f803f80
M a[156:159], a[208:211], a[224:227], a[156:159]
buffer_load_dword v23, s[8:11], s24 offen offset:256 lds
s_add_u32 s24, s24, 128
M a[156:159], a[212:215], a[228:231], a[156:159]
v_cmp_lt_i32 vcc, -8, v128
s_nop 1
v_cndmask_b32 v145, 0, v129, vcc
M a[160:163], a[220:223], a[228:231], a[160:163]
M a[160:163], a[216:219], a[224:227], a[160:163]
s_add_u32 m0, s29, 133120
s_nop 0
buffer_load_dwordx4 v2, s[8:11], s23 offen offset:0 lds
v_subrev_u32 v130, 1, v128
v_cmp_lt_u32 vcc, 7, v130
s_nop 1
v_cndmask_b32 v149, 0, v129, vcc
M a[164:167], a[200:203], a[232:235], a[164:167]
ds_read_b128 a[224:227], v10 offset:4096
ds_read_b128 a[228:231], v11 offset:4096
M a[164:167], a[204:207], a[236:239], a[164:167]
v_min_f32 v153, s3, v145
v_mov_b32 v157, 0x3f803f80
M a[168:171], a[212:215], a[236:239], a[168:171]
M a[168:171], a[208:211], a[232:235], a[168:171]
buffer_load_dwordx4 v3, s[8:11], s23 offen offset:1024 lds
v_cmp_lt_i32 vcc, -7, v128
s_nop 1
v_cndmask_b32 v146, 0, v129, vcc
M a[172:175], a[216:219], a[232:235], a[172:175]
M a[172:175], a[220:223], a[236:239], a[172:175]
s_waitcnt lgkmcnt(4)
M a[68:71], a[176:179], a[240:243], a[68:71]
ds_read_b128 a[232:235], v10 offset:6144
ds_read_b128 a[236:239], v11 offset:6144
v_subrev_u32 v130, 2, v128
v_cmp_lt_u32 vcc, 7, v130
s_nop 1
v_cndmask_b32 v150, 0, v129, vcc
M a[68:71], a[180:183], a[244:247], a[68:71]
buffer_load_dwordx4 v4, s[8:11], s23 offen offset:2048 lds
v_min_f32 v154, s3, v146
v_mov_b32 v158, 0x3f803f80
M a[72:75], a[188:191], a[244:247], a[72:75]
ds_read_b64_tr_b16 a[200:201], v14 offset:0
ds_read_b64_tr_b16 a[202:203], v14 offset:1536
M a[72:75], a[184:187], a[240:243], a[72:75]
v_cmp_lt_i32 vcc, -6, v128
s_nop 1
v_cndmask_b32 v147, 0, v129, vcc
M a[76:79], a[192:195], a[240:243], a[76:79]
v_subrev_u32 v130, 3, v128
v_cmp_lt_u32 vcc, 7, v130
s_nop 1
v_cndmask_b32 v151, 0, v129, vcc
M a[76:79], a[196:199], a[244:247], a[76:79]
buffer_load_dwordx4 v5, s[8:11], s23 offen offset:3072 lds
s_add_u32 s23, s23, 128
s_waitcnt lgkmcnt(6)
M a[80:83], a[180:183], a[252:255], a[80:83]
ds_read_b128 a[240:243], v10 offset:8192
ds_read_b128 a[244:247], v11 offset:8192
v_min_f32 v155, s3, v147
v_mov_b32 v159, 0x3f803f80
M a[80:83], a[176:179], a[248:251], a[80:83]
s_add_u32 s16, s50, 83886080
s_addc_u32 s17, s51, 0
M a[84:87], a[184:187], a[248:251], a[84:87]
ds_read_b64_tr_b16 a[208:209], v15 offset:0
ds_read_b64_tr_b16 a[210:211], v15 offset:1536
M a[84:87], a[188:191], a[252:255], a[84:87]
s_mov_b32 s18, 4194304
s_mov_b32 s19, 0x00020000
M a[88:91], a[196:199], a[252:255], a[88:91]
s_add_u32 m0, s30, 98304
s_nop 0
buffer_load_dwordx4 v6, s[12:15], s25 offen offset:0 lds
s_lshl_b32 s3, s26, 18
s_lshl_b32 s4, s27, 14
M a[88:91], a[192:195], a[248:251], a[88:91]
s_waitcnt lgkmcnt(8)
M a[92:95], a[176:179], a[224:227], a[92:95]
ds_read_b128 a[248:251], v10 offset:10240
ds_read_b128 a[252:255], v11 offset:10240
s_add_u32 s3, s3, s4
s_lshl_b32 s4, s21, 13
M a[92:95], a[180:183], a[228:231], a[92:95]
s_add_u32 s3, s3, s4
s_lshl_b32 s4, s22, 10
M a[96:99], a[188:191], a[228:231], a[96:99]
ds_read_b64_tr_b16 a[216:217], v16 offset:0
ds_read_b64_tr_b16 a[218:219], v16 offset:1536
M a[96:99], a[184:187], a[224:227], a[96:99]
s_add_u32 s6, s3, s4
s_mov_b32 s7, 0x3e8293ee
M a[100:103], a[192:195], a[224:227], a[100:103]
buffer_load_dwordx4 v7, s[12:15], s25 offen offset:1024 lds
s_lshl_b32 s65, s26, 8
s_lshl_b32 s3, s27, 4
M a[100:103], a[196:199], a[228:231], a[100:103]
s_waitcnt lgkmcnt(10)
M a[104:107], a[180:183], a[236:239], a[104:107]
ds_read_b128 a[224:227], v10 offset:12288
ds_read_b128 a[228:231], v11 offset:12288
s_add_u32 s65, s65, s3
s_lshl_b32 s3, s101, 2
M a[104:107], a[176:179], a[232:235], a[104:107]
s_add_u32 s65, s65, s3
s_add_u32 s65, s65, 16789504
M a[108:111], a[184:187], a[232:235], a[108:111]
ds_read_b64_tr_b16 a[204:205], v14 offset:12288
ds_read_b64_tr_b16 a[206:207], v14 offset:13824
M a[108:111], a[188:191], a[236:239], a[108:111]
buffer_load_dwordx4 v8, s[12:15], s25 offen offset:2048 lds
s_mov_b32 s40, 0
v_mov_b32 v119, 0
M a[112:115], a[196:199], a[236:239], a[112:115]
s_mov_b64 s[4:5], s[50:51]
s_and_b32 s20, s2, 7
M a[112:115], a[192:195], a[232:235], a[112:115]
s_waitcnt lgkmcnt(10)
M a[116:119], a[176:179], a[240:243], a[116:119]
ds_read_b128 a[232:235], v10 offset:14336
ds_read_b128 a[236:239], v11 offset:14336
s_lshr_b32 s33, s2, 6
s_lshl_b32 s33, s33, 3
M a[116:119], a[180:183], a[244:247], a[116:119]
buffer_load_dwordx4 v9, s[12:15], s25 offen offset:3072 lds
s_add_u32 s20, s20, s33
s_bfe_u32 s21, s2, 0x30003
M a[120:123], a[188:191], a[244:247], a[120:123]
ds_read_b64_tr_b16 a[212:213], v15 offset:12288
ds_read_b64_tr_b16 a[214:215], v15 offset:13824
M a[120:123], a[184:187], a[240:243], a[120:123]
s_sub_u32 s35, 15, s21
s_cmp_lt_u32 s101, 2
s_cselect_b32 s35, s21, s35
M a[124:127], a[192:195], a[240:243], a[124:127]
s_lshl_b32 s33, s20, 7
s_lshl_b32 s34, s35, 3
M a[124:127], a[196:199], a[244:247], a[124:127]
s_waitcnt lgkmcnt(10)
M a[128:131], a[180:183], a[252:255], a[128:131]
ds_read_b128 a[240:243], v10 offset:16384
ds_read_b128 a[244:247], v11 offset:16384
s_add_u32 s33, s33, s34
s_and_b32 s34, s101, 1
M a[128:131], a[176:179], a[248:251], a[128:131]
s_add_u32 m0, s30, 102400
s_nop 0
buffer_load_dwordx4 v21, s[12:15], s25 offen offset:0 lds
s_lshl_b32 s34, s34, 2
s_add_u32 s33, s33, s34
M a[132:135], a[184:187], a[248:251], a[132:135]
ds_read_b64_tr_b16 a[220:221], v16 offset:12288
ds_read_b64_tr_b16 a[222:223], v16 offset:13824
M a[132:135], a[188:191], a[252:255], a[132:135]
s_lshl_b32 s64, s33, 12
s_mov_b32 s44, s4
M a[136:139], a[196:199], a[252:255], a[136:139]
s_mov_b32 s45, s5
s_mov_b32 s46, 16777216
M a[136:139], a[192:195], a[248:251], a[136:139]
buffer_load_dwordx4 v22, s[12:15], s25 offen offset:1024 lds
s_add_u32 s25, s25, 393216
s_waitcnt lgkmcnt(10)
M a[140:143], a[176:179], a[224:227], a[140:143]
s_mov_b32 s47, 0x00020000
M a[140:143], a[180:183], a[228:231], a[140:143]
M a[144:147], a[188:191], a[228:231], a[144:147]
M a[144:147], a[184:187], a[224:227], a[144:147]
M a[148:151], a[192:195], a[224:227], a[148:151]
s_waitcnt vmcnt(12) lgkmcnt(0)
s_barrier
ds_read_b128 a[248:251], v10 offset:18432
ds_read_b128 a[252:255], v11 offset:18432
M a[148:151], a[196:199], a[228:231], a[148:151]
s_add_u32 m0, s28, 0
s_nop 0
buffer_load_dword v20, s[8:11], s24 offen lds
M a[152:155], a[180:183], a[236:239], a[152:155]
ds_read_b128 a[224:227], v10 offset:20480
ds_read_b128 a[228:231], v11 offset:20480
M a[152:155], a[176:179], a[232:235], a[152:155]
M a[156:159], a[184:187], a[232:235], a[156:159]
buffer_load_dword v23, s[8:11], s24 offen offset:256 lds
s_add_u32 s24, s24, 128
M a[156:159], a[188:191], a[236:239], a[156:159]
M a[160:163], a[196:199], a[236:239], a[160:163]
M a[160:163], a[192:195], a[232:235], a[160:163]
s_add_u32 m0, s29, 2048
s_nop 0
buffer_load_dwordx4 v2, s[8:11], s23 offen offset:0 lds
M a[164:167], a[176:179], a[240:243], a[164:167]
ds_read_b128 a[232:235], v10 offset:22528
ds_read_b128 a[236:239], v11 offset:22528
M a[164:167], a[180:183], a[244:247], a[164:167]
M a[168:171], a[188:191], a[244:247], a[168:171]
M a[168:171], a[184:187], a[240:243], a[168:171]
buffer_load_dwordx4 v3, s[8:11], s23 offen offset:1024 lds
M a[172:175], a[192:195], a[240:243], a[172:175]
M a[172:175], a[196:199], a[244:247], a[172:175]
s_waitcnt lgkmcnt(4)
M a[68:71], a[200:203], a[248:251], a[68:71]
ds_read_b128 a[240:243], v10 offset:24576
ds_read_b128 a[244:247], v11 offset:24576
M a[68:71], a[204:207], a[252:255], a[68:71]
buffer_load_dwordx4 v4, s[8:11], s23 offen offset:2048 lds
M a[72:75], a[212:215], a[252:255], a[72:75]
ds_read_b64_tr_b16 a[176:177], v14 offset:28672
ds_read_b64_tr_b16 a[178:179], v14 offset:30208
M a[72:75], a[208:211], a[248:251], a[72:75]
M a[76:79], a[216:219], a[248:251], a[76:79]
M a[76:79], a[220:223], a[252:255], a[76:79]
buffer_load_dwordx4 v5, s[8:11], s23 offen offset:3072 lds
s_add_u32 s23, s23, 128
s_waitcnt lgkmcnt(6)
M a[80:83], a[204:207], a[228:231], a[80:83]
ds_read_b128 a[248:251], v10 offset:26624
ds_read_b128 a[252:255], v11 offset:26624
M a[80:83], a[200:203], a[224:227], a[80:83]
M a[84:87], a[208:211], a[224:227], a[84:87]
ds_read_b64_tr_b16 a[184:185], v15 offset:28672
ds_read_b64_tr_b16 a[186:187], v15 offset:30208
M a[84:87], a[212:215], a[228:231], a[84:87]
M a[88:91], a[220:223], a[228:231], a[88:91]
s_add_u32 m0, s30, 36864
s_nop 0
buffer_load_dwordx4 v6, s[12:15], s25 offen offset:0 lds
M a[88:91], a[216:219], a[224:227], a[88:91]
s_waitcnt lgkmcnt(8)
M a[92:95], a[200:203], a[232:235], a[92:95]
ds_read_b128 a[224:227], v10 offset:28672
ds_read_b128 a[228:231], v11 offset:28672
M a[92:95], a[204:207], a[236:239], a[92:95]
M a[96:99], a[212:215], a[236:239], a[96:99]
ds_read_b64_tr_b16 a[192:193], v16 offset:28672
ds_read_b64_tr_b16 a[194:195], v16 offset:30208
M a[96:99], a[208:211], a[232:235], a[96:99]
M a[100:103], a[216:219], a[232:235], a[100:103]
buffer_load_dwordx4 v7, s[12:15], s25 offen offset:1024 lds
M a[100:103], a[220:223], a[236:239], a[100:103]
s_waitcnt lgkmcnt(10)
M a[104:107], a[204:207], a[244:247], a[104:107]
ds_read_b128 a[232:235], v10 offset:30720
ds_read_b128 a[236:239], v11 offset:30720
M a[104:107], a[200:203], a[240:243], a[104:107]
M a[108:111], a[208:211], a[240:243], a[108:111]
ds_read_b64_tr_b16 a[180:181], v14 offset:40960
ds_read_b64_tr_b16 a[182:183], v14 offset:42496
M a[108:111], a[212:215], a[244:247], a[108:111]
buffer_load_dwordx4 v8, s[12:15], s25 offen offset:2048 lds
M a[112:115], a[220:223], a[244:247], a[112:115]
M a[112:115], a[216:219], a[240:243], a[112:115]
s_waitcnt lgkmcnt(10)
M a[116:119], a[200:203], a[248:251], a[116:119]
ds_read_b128 a[240:243], v10 offset:32768
ds_read_b128 a[244:247], v11 offset:32768
M a[116:119], a[204:207], a[252:255], a[116:119]
buffer_load_dwordx4 v9, s[12:15], s25 offen offset:3072 lds
M a[120:123], a[212:215], a[252:255], a[120:123]
ds_read_b64_tr_b16 a[188:189], v15 offset:40960
ds_read_b64_tr_b16 a[190:191], v15 offset:42496
M a[120:123], a[208:211], a[248:251], a[120:123]
M a[124:127], a[216:219], a[248:251], a[124:127]
M a[124:127], a[220:223], a[252:255], a[124:127]
s_waitcnt lgkmcnt(10)
M a[128:131], a[204:207], a[228:231], a[128:131]
ds_read_b128 a[248:251], v10 offset:34816
ds_read_b128 a[252:255], v11 offset:34816
M a[128:131], a[200:203], a[224:227], a[128:131]
s_add_u32 m0, s30, 40960
s_nop 0
buffer_load_dwordx4 v21, s[12:15], s25 offen offset:0 lds
M a[132:135], a[208:211], a[224:227], a[132:135]
ds_read_b64_tr_b16 a[196:197], v16 offset:40960
ds_read_b64_tr_b16 a[198:199], v16 offset:42496
M a[132:135], a[212:215], a[228:231], a[132:135]
M a[136:139], a[220:223], a[228:231], a[136:139]
M a[136:139], a[216:219], a[224:227], a[136:139]
buffer_load_dwordx4 v22, s[12:15], s25 offen offset:1024 lds
s_add_u32 s25, s25, 393216
s_waitcnt lgkmcnt(10)
M a[140:143], a[200:203], a[232:235], a[140:143]
M a[140:143], a[204:207], a[236:239], a[140:143]
M a[144:147], a[212:215], a[236:239], a[144:147]
M a[144:147], a[208:211], a[232:235], a[144:147]
M a[148:151], a[216:219], a[232:235], a[148:151]
s_waitcnt vmcnt(12) lgkmcnt(0)
s_barrier
ds_read_b128 a[224:227], v12 offset:0
ds_read_b128 a[228:231], v13 offset:0
M a[148:151], a[220:223], a[236:239], a[148:151]
s_add_u32 m0, s28, 18432
s_nop 0
buffer_load_dword v20, s[8:11], s24 offen lds
M a[152:155], a[204:207], a[244:247], a[152:155]
ds_read_b128 a[232:235], v12 offset:2048
ds_read_b128 a[236:239], v13 offset:2048
M a[152:155], a[200:203], a[240:243], a[152:155]
M a[156:159], a[208:211], a[240:243], a[156:159]
buffer_load_dword v23, s[8:11], s24 offen offset:256 lds
s_add_u32 s24, s24, 128
M a[156:159], a[212:215], a[244:247], a[156:159]
M a[160:163], a[220:223], a[244:247], a[160:163]
M a[160:163], a[216:219], a[240:243], a[160:163]
s_add_u32 m0, s29, 20480
s_nop 0
buffer_load_dwordx4 v2, s[8:11], s23 offen offset:0 lds
M a[164:167], a[200:203], a[248:251], a[164:167]
ds_read_b128 a[240:243], v12 offset:4096
ds_read_b128 a[244:247], v13 offset:4096
M a[164:167], a[204:207], a[252:255], a[164:167]
M a[168:171], a[212:215], a[252:255], a[168:171]
M a[168:171], a[208:211], a[248:251], a[168:171]
buffer_load_dwordx4 v3, s[8:11], s23 offen offset:1024 lds
M a[172:175], a[216:219], a[248:251], a[172:175]
M a[172:175], a[220:223], a[252:255], a[172:175]
s_waitcnt lgkmcnt(4)
M a[68:71], a[176:179], a[224:227], a[68:71]
ds_read_b128 a[248:251], v12 offset:6144
ds_read_b128 a[252:255], v13 offset:6144
M a[68:71], a[180:183], a[228:231], a[68:71]
buffer_load_dwordx4 v4, s[8:11], s23 offen offset:2048 lds
M a[72:75], a[188:191], a[228:231], a[72:75]
ds_read_b64_tr_b16 a[200:201], v17 offset:0
ds_read_b64_tr_b16 a[202:203], v17 offset:1536
M a[72:75], a[184:187], a[224:227], a[72:75]
M a[76:79], a[192:195], a[224:227], a[76:79]
M a[76:79], a[196:199], a[228:231], a[76:79]
buffer_load_dwordx4 v5, s[8:11], s23 offen offset:3072 lds
s_add_u32 s23, s23, 128
s_waitcnt lgkmcnt(6)
M a[80:83], a[180:183], a[236:239], a[80:83]
ds_read_b128 a[224:227], v12 offset:8192
ds_read_b128 a[228:231], v13 offset:8192
M a[80:83], a[176:179], a[232:235], a[80:83]
M a[84:87], a[184:187], a[232:235], a[84:87]
ds_read_b64_tr_b16 a[208:209], v18 offset:0
ds_read_b64_tr_b16 a[210:211], v18 offset:1536
M a[84:87], a[188:191], a[236:239], a[84:87]
M a[88:91], a[196:199], a[236:239], a[88:91]
s_add_u32 m0, s30, 65536
s_nop 0
buffer_load_dwordx4 v6, s[12:15], s25 offen offset:0 lds
M a[88:91], a[192:195], a[232:235], a[88:91]
s_waitcnt lgkmcnt(8)
M a[92:95], a[176:179], a[240:243], a[92:95]
ds_read_b128 a[232:235], v12 offset:10240
ds_read_b128 a[236:239], v13 offset:10240
M a[92:95], a[180:183], a[244:247], a[92:95]
M a[96:99], a[188:191], a[244:247], a[96:99]
ds_read_b64_tr_b16 a[216:217], v19 offset:0
ds_read_b64_tr_b16 a[218:219], v19 offset:1536
M a[96:99], a[184:187], a[240:243], a[96:99]
buffer_load_dwordx4 v7, s[12:15], s25 offen offset:1024 lds
M a[100:103], a[192:195], a[240:243], a[100:103]
M a[100:103], a[196:199], a[244:247], a[100:103]
s_waitcnt lgkmcnt(10)
M a[104:107], a[180:183], a[252:255], a[104:107]
ds_read_b128 a[240:243], v12 offset:12288
ds_read_b128 a[244:247], v13 offset:12288
M a[104:107], a[176:179], a[248:251], a[104:107]
buffer_load_dwordx4 v8, s[12:15], s25 offen offset:2048 lds
M a[108:111], a[184:187], a[248:251], a[108:111]
ds_read_b64_tr_b16 a[204:205], v17 offset:12288
ds_read_b64_tr_b16 a[206:207], v17 offset:13824
M a[108:111], a[188:191], a[252:255], a[108:111]
M a[112:115], a[196:199], a[252:255], a[112:115]
M a[112:115], a[192:195], a[248:251], a[112:115]
buffer_load_dwordx4 v9, s[12:15], s25 offen offset:3072 lds
s_waitcnt lgkmcnt(10)
M a[116:119], a[176:179], a[224:227], a[116:119]
ds_read_b128 a[248:251], v12 offset:14336
ds_read_b128 a[252:255], v13 offset:14336
M a[116:119], a[180:183], a[228:231], a[116:119]
M a[120:123], a[188:191], a[228:231], a[120:123]
ds_read_b64_tr_b16 a[212:213], v18 offset:12288
ds_read_b64_tr_b16 a[214:215], v18 offset:13824
M a[120:123], a[184:187], a[224:227], a[120:123]
M a[124:127], a[192:195], a[224:227], a[124:127]
s_add_u32 m0, s30, 69632
s_nop 0
buffer_load_dwordx4 v21, s[12:15], s25 offen offset:0 lds
M a[124:127], a[196:199], a[228:231], a[124:127]
s_waitcnt lgkmcnt(10)
M a[128:131], a[180:183], a[236:239], a[128:131]
ds_read_b128 a[224:227], v12 offset:16384
ds_read_b128 a[228:231], v13 offset:16384
M a[128:131], a[176:179], a[232:235], a[128:131]
M a[132:135], a[184:187], a[232:235], a[132:135]
ds_read_b64_tr_b16 a[220:221], v19 offset:12288
ds_read_b64_tr_b16 a[222:223], v19 offset:13824
M a[132:135], a[188:191], a[236:239], a[132:135]
buffer_load_dwordx4 v22, s[12:15], s25 offen offset:1024 lds
s_add_u32 s25, s25, 393216
M a[136:139], a[196:199], a[236:239], a[136:139]
M a[136:139], a[192:195], a[232:235], a[136:139]
s_waitcnt lgkmcnt(10)
M a[140:143], a[176:179], a[240:243], a[140:143]
buffer_load_dword v125, v119, s[36:39], 0 offen sc1
M a[140:143], a[180:183], a[244:247], a[140:143]
M a[144:147], a[188:191], a[244:247], a[144:147]
M a[144:147], a[184:187], a[240:243], a[144:147]
M a[148:151], a[192:195], a[240:243], a[148:151]
s_waitcnt vmcnt(13) lgkmcnt(0)
s_barrier
ds_read_b128 a[232:235], v10 offset:0
ds_read_b128 a[236:239], v11 offset:0
s_waitcnt vmcnt(0)
v_cmp_gt_u32 vcc, 0x80, v125
s_nop 0
s_cbranch_vccnz Lk1_spinq
Lk1_gotq:
M a[148:151], a[196:199], a[244:247], a[148:151]
s_add_u32 m0, s28, 131072
s_nop 0
buffer_load_dword v20, s[8:11], s24 offen lds
M a[152:155], a[180:183], a[252:255], a[152:155]
ds_read_b128 a[240:243], v10 offset:2048
ds_read_b128 a[244:247], v11 offset:2048
M a[152:155], a[176:179], a[248:251], a[152:155]
M a[156:159], a[184:187], a[248:251], a[156:159]
buffer_load_dword v23, s[8:11], s24 offen offset:256 lds
s_add_u32 s24, s24, 128
M a[156:159], a[188:191], a[252:255], a[156:159]
M a[160:163], a[196:199], a[252:255], a[160:163]
M a[160:163], a[192:195], a[248:251], a[160:163]
s_add_u32 m0, s29, 133120
s_nop 0
buffer_load_dwordx4 v2, s[8:11], s23 offen offset:0 lds
M a[164:167], a[176:179], a[224:227], a[164:167]
ds_read_b128 a[248:251], v10 offset:4096
ds_read_b128 a[252:255], v11 offset:4096
M a[164:167], a[180:183], a[228:231], a[164:167]
M a[168:171], a[188:191], a[228:231], a[168:171]
M a[168:171], a[184:187], a[224:227], a[168:171]
buffer_load_dwordx4 v3, s[8:11], s23 offen offset:1024 lds
M a[172:175], a[192:195], a[224:227], a[172:175]
M a[172:175], a[196:199], a[228:231], a[172:175]
s_waitcnt lgkmcnt(4)
M a[68:71], a[200:203], a[232:235], a[68:71]
ds_read_b128 a[224:227], v10 offset:6144
ds_read_b128 a[228:231], v11 offset:6144
v_mov_b32 v208, 0
v_mov_b32 v209, 0
M a[68:71], a[204:207], a[236:239], a[68:71]
buffer_load_dwordx4 v4, s[8:11], s23 offen offset:2048 lds
M a[72:75], a[212:215], a[236:239], a[72:75]
ds_read_b64_tr_b16 a[176:177], v14 offset:0
ds_read_b64_tr_b16 a[178:179], v14 offset:1536
v_mov_b32 v210, 0
v_mov_b32 v211, 0
M a[72:75], a[208:211], a[232:235], a[72:75]
M a[76:79], a[216:219], a[232:235], a[76:79]
buffer_load_dwordx4 v5, s[8:11], s23 offen offset:3072 lds
s_add_u32 s23, s23, 128
v_mov_b32 v212, 0
v_mov_b32 v213, 0
M a[76:79], a[220:223], a[236:239], a[76:79]
s_waitcnt lgkmcnt(6)
M a[80:83], a[204:207], a[244:247], a[80:83]
ds_read_b128 a[232:235], v10 offset:8192
ds_read_b128 a[236:239], v11 offset:8192
v_mov_b32 v214, 0
v_mov_b32 v215, 0
M a[80:83], a[200:203], a[240:243], a[80:83]
M a[84:87], a[208:211], a[240:243], a[84:87]
ds_read_b64_tr_b16 a[184:185], v15 offset:0
ds_read_b64_tr_b16 a[186:187], v15 offset:1536
M a[84:87], a[212:215], a[244:247], a[84:87]
buffer_load_dwordx4 a[0:3], v1, s[44:47], s64 offen offset:0 sc1
v_mov_b32 v216, 0
v_mov_b32 v217, 0
M a[88:91], a[220:223], a[244:247], a[88:91]
M a[88:91], a[216:219], a[240:243], a[88:91]
s_waitcnt lgkmcnt(8)
v_mov_b32 v218, 0
v_mov_b32 v219, 0
M a[92:95], a[200:203], a[248:251], a[92:95]
ds_read_b128 a[240:243], v10 offset:10240
ds_read_b128 a[244:247], v11 offset:10240
M a[92:95], a[204:207], a[252:255], a[92:95]
buffer_load_dwordx4 a[4:7], v1, s[44:47], s64 offen offset:1024 sc1
v_mov_b32 v220, 0
v_mov_b32 v221, 0
M a[96:99], a[212:215], a[252:255], a[96:99]
ds_read_b64_tr_b16 a[192:193], v16 offset:0
ds_read_b64_tr_b16 a[194:195], v16 offset:1536
M a[96:99], a[208:211], a[248:251], a[96:99]
v_mov_b32 v222, 0
v_mov_b32 v223, 0
M a[100:103], a[216:219], a[248:251], a[100:103]
buffer_load_dwordx4 a[8:11], v1, s[44:47], s64 offen offset:2048 sc1
M a[100:103], a[220:223], a[252:255], a[100:103]
s_waitcnt lgkmcnt(10)
M a[104:107], a[204:207], a[228:231], a[104:107]
ds_read_b128 a[248:251], v10 offset:12288
ds_read_b128 a[252:255], v11 offset:12288
v_mov_b32 v224, 0
v_mov_b32 v225, 0
M a[104:107], a[200:203], a[224:227], a[104:107]
M a[108:111], a[208:211], a[224:227], a[108:111]
ds_read_b64_tr_b16 a[180:181], v14 offset:12288
ds_read_b64_tr_b16 a[182:183], v14 offset:13824
v_mov_b32 v226, 0
v_mov_b32 v227, 0
M a[108:111], a[212:215], a[228:231], a[108:111]
buffer_load_dwordx4 a[12:15], v1, s[44:47], s64 offen offset:3072 sc1
s_add_u32 s64, s64, 4096
M a[112:115], a[220:223], a[228:231], a[112:115]
v_mov_b32 v228, 0
v_mov_b32 v229, 0
M a[112:115], a[216:219], a[224:227], a[112:115]
s_waitcnt lgkmcnt(10)
M a[116:119], a[200:203], a[232:235], a[116:119]
ds_read_b128 a[224:227], v10 offset:14336
ds_read_b128 a[228:231], v11 offset:14336
v_mov_b32 v230, 0
v_mov_b32 v231, 0
M a[116:119], a[204:207], a[236:239], a[116:119]
buffer_load_dwordx4 a[16:19], v1, s[44:47], s64 offen offset:0 sc1
M a[120:123], a[212:215], a[236:239], a[120:123]
ds_read_b64_tr_b16 a[188:189], v15 offset:12288
ds_read_b64_tr_b16 a[190:191], v15 offset:13824
M a[120:123], a[208:211], a[232:235], a[120:123]
v_mov_b32 v232, 0
v_mov_b32 v233, 0
M a[124:127], a[216:219], a[232:235], a[124:127]
buffer_load_dwordx4 a[20:23], v1, s[44:47], s64 offen offset:1024 sc1
M a[124:127], a[220:223], a[236:239], a[124:127]
s_waitcnt lgkmcnt(10)
v_mov_b32 v234, 0
v_mov_b32 v235, 0
M a[128:131], a[204:207], a[244:247], a[128:131]
ds_read_b128 a[232:235], v10 offset:16384
ds_read_b128 a[236:239], v11 offset:16384
M a[128:131], a[200:203], a[240:243], a[128:131]
v_mov_b32 v236, 0
v_mov_b32 v237, 0
M a[132:135], a[208:211], a[240:243], a[132:135]
ds_read_b64_tr_b16 a[196:197], v16 offset:12288
ds_read_b64_tr_b16 a[198:199], v16 offset:13824
M a[132:135], a[212:215], a[244:247], a[132:135]
buffer_load_dwordx4 a[24:27], v1, s[44:47], s64 offen offset:2048 sc1
v_mov_b32 v238, 0
v_mov_b32 v239, 0
M a[136:139], a[220:223], a[244:247], a[136:139]
M a[136:139], a[216:219], a[240:243], a[136:139]
s_waitcnt lgkmcnt(10)
M a[140:143], a[200:203], a[248:251], a[140:143]
buffer_load_dwordx4 a[28:31], v1, s[44:47], s64 offen offset:3072 sc1
s_add_u32 s64, s64, 4096
v_mov_b32 v240, 0
v_mov_b32 v241, 0
M a[140:143], a[204:207], a[252:255], a[140:143]
M a[144:147], a[212:215], a[252:255], a[144:147]
v_mov_b32 v242, 0
v_mov_b32 v243, 0
M a[144:147], a[208:211], a[248:251], a[144:147]
M a[148:151], a[216:219], a[248:251], a[148:151]
s_waitcnt vmcnt(15) lgkmcnt(0)
s_barrier
ds_read_b128 a[240:243], v10 offset:18432
ds_read_b128 a[244:247], v11 offset:18432
v_mov_b32 v244, 0
v_mov_b32 v245, 0
M a[148:151], a[220:223], a[252:255], a[148:151]
buffer_load_dwordx4 a[32:35], v1, s[44:47], s64 offen offset:0 sc1
M a[152:155], a[204:207], a[228:231], a[152:155]
ds_read_b128 a[248:251], v10 offset:20480
ds_read_b128 a[252:255], v11 offset:20480
v_mov_b32 v246, 0
v_mov_b32 v247, 0
M a[152:155], a[200:203], a[224:227], a[152:155]
M a[156:159], a[208:211], a[224:227], a[156:159]
buffer_load_dwordx4 a[36:39], v1, s[44:47], s64 offen offset:1024 sc1
M a[156:159], a[212:215], a[228:231], a[156:159]
v_mov_b32 v248, 0
v_mov_b32 v249, 0
M a[160:163], a[220:223], a[228:231], a[160:163]
M a[160:163], a[216:219], a[224:227], a[160:163]
buffer_load_dwordx4 a[40:43], v1, s[44:47], s64 offen offset:2048 sc1
v_mov_b32 v250, 0
v_mov_b32 v251, 0
M a[164:167], a[200:203], a[232:235], a[164:167]
ds_read_b128 a[224:227], v10 offset:22528
ds_read_b128 a[228:231], v11 offset:22528
M a[164:167], a[204:207], a[236:239], a[164:167]
v_mov_b32 v252, 0
v_mov_b32 v253, 0
M a[168:171], a[212:215], a[236:239], a[168:171]
M a[168:171], a[208:211], a[232:235], a[168:171]
buffer_load_dwordx4 a[44:47], v1, s[44:47], s64 offen offset:3072 sc1
s_add_u32 s64, s64, 4096
v_mov_b32 v254, 0
v_mov_b32 v255, 0
M a[172:175], a[216:219], a[232:235], a[172:175]
M a[172:175], a[220:223], a[236:239], a[172:175]
s_waitcnt lgkmcnt(4)
M a[68:71], a[176:179], a[240:243], a[68:71]
ds_read_b128 a[232:235], v10 offset:24576
ds_read_b128 a[236:239], v11 offset:24576
s_mov_b32 s22, s101
s_and_b32 s23, s22, 1
M a[68:71], a[180:183], a[244:247], a[68:71]
buffer_load_dwordx4 a[48:51], v1, s[44:47], s64 offen offset:0 sc1
s_lshr_b32 s24, s22, 1
s_lshl_b32 s33, s24, 14
M a[72:75], a[188:191], a[244:247], a[72:75]
ds_read_b64_tr_b16 a[200:201], v14 offset:28672
ds_read_b64_tr_b16 a[202:203], v14 offset:30208
M a[72:75], a[184:187], a[240:243], a[72:75]
s_lshl_b32 s34, s23, 13
s_add_u32 s29, s33, s34
M a[76:79], a[192:195], a[240:243], a[76:79]
M a[76:79], a[196:199], a[244:247], a[76:79]
s_waitcnt lgkmcnt(6)
s_lshl_b32 s28, s20, 20
s_add_u32 s28, s28, s34
M a[80:83], a[180:183], a[252:255], a[80:83]
ds_read_b128 a[240:243], v10 offset:26624
ds_read_b128 a[244:247], v11 offset:26624
M a[80:83], a[176:179], a[248:251], a[80:83]
s_mov_b32 s25, s28
s_lshl_b32 s33, s21, 16
M a[84:87], a[184:187], a[248:251], a[84:87]
ds_read_b64_tr_b16 a[208:209], v15 offset:28672
ds_read_b64_tr_b16 a[210:211], v15 offset:30208
M a[84:87], a[188:191], a[252:255], a[84:87]
buffer_load_dwordx4 a[52:55], v1, s[44:47], s64 offen offset:1024 sc1
s_add_u32 s34, s28, s33
s_add_u32 s34, s34, 65536
M a[88:91], a[196:199], a[252:255], a[88:91]
M a[88:91], a[192:195], a[248:251], a[88:91]
s_waitcnt lgkmcnt(8)
s_add_u32 s32, s28, 491520
s_sub_u32 s33, s32, s33
M a[92:95], a[176:179], a[224:227], a[92:95]
ds_read_b128 a[248:251], v10 offset:28672
ds_read_b128 a[252:255], v11 offset:28672
M a[92:95], a[180:183], a[228:231], a[92:95]
s_add_u32 s33, s33, 491520
s_cmp_eq_u32 s24, 0
s_cselect_b32 s27, s34, s32
s_cselect_b32 s28, s32, s33
M a[96:99], a[188:191], a[228:231], a[96:99]
ds_read_b64_tr_b16 a[216:217], v16 offset:28672
ds_read_b64_tr_b16 a[218:219], v16 offset:30208
M a[96:99], a[184:187], a[224:227], a[96:99]
s_mov_b32 s56, s27
s_mov_b32 s57, s28
M a[100:103], a[192:195], a[224:227], a[100:103]
buffer_load_dwordx4 a[56:59], v1, s[44:47], s64 offen offset:2048 sc1
M a[100:103], a[196:199], a[228:231], a[100:103]
s_waitcnt lgkmcnt(10)
s_min_u32 s34, s34, s32
s_cmp_eq_u32 s34, s32
s_cselect_b32 s33, s33, s34
M a[104:107], a[180:183], a[236:239], a[104:107]
ds_read_b128 a[224:227], v10 offset:30720
ds_read_b128 a[228:231], v11 offset:30720
M a[104:107], a[176:179], a[232:235], a[104:107]
s_or_b32 s34, s34, 0x40000000
s_or_b32 s32, s25, 0x40000000
M a[108:111], a[184:187], a[232:235], a[108:111]
ds_read_b64_tr_b16 a[204:205], v14 offset:40960
ds_read_b64_tr_b16 a[206:207], v14 offset:42496
s_cmp_eq_u32 s24, 1
s_cselect_b32 s25, s32, s25
s_cselect_b32 s27, s34, s27
s_cselect_b32 s28, s33, s28
s_cselect_b32 s56, s56, -1
M a[108:111], a[188:191], a[236:239], a[108:111]
M a[112:115], a[196:199], a[236:239], a[112:115]
s_add_u32 s58, s56, 16384
s_add_u32 s59, s57, 16384
M a[112:115], a[192:195], a[232:235], a[112:115]
s_waitcnt lgkmcnt(10)
M a[116:119], a[176:179], a[240:243], a[116:119]
ds_read_b128 a[232:235], v10 offset:32768
ds_read_b128 a[236:239], v11 offset:32768
s_add_u32 s26, s25, 16384
s_add_u32 s62, s27, 16384
M a[116:119], a[180:183], a[244:247], a[116:119]
buffer_load_dwordx4 a[60:63], v1, s[44:47], s64 offen offset:3072 sc1
M a[120:123], a[188:191], a[244:247], a[120:123]
ds_read_b64_tr_b16 a[212:213], v15 offset:40960
ds_read_b64_tr_b16 a[214:215], v15 offset:42496
s_add_u32 s63, s28, 16384
s_lshl_b32 s31, s21, 7
M a[120:123], a[184:187], a[240:243], a[120:123]
M a[124:127], a[192:195], a[240:243], a[124:127]
s_cmp_eq_u32 s24, 0
s_cselect_b32 s31, s31, 960
M a[124:127], a[196:199], a[244:247], a[124:127]
s_waitcnt lgkmcnt(10)
M a[128:131], a[180:183], a[252:255], a[128:131]
ds_read_b128 a[240:243], v10 offset:34816
ds_read_b128 a[244:247], v11 offset:34816
s_mov_b32 s60, 0
s_add_u32 s12, s4, 16777216
s_addc_u32 s13, s5, 0
M a[128:131], a[176:179], a[248:251], a[128:131]
M a[132:135], a[184:187], a[248:251], a[132:135]
ds_read_b64_tr_b16 a[220:221], v16 offset:40960
ds_read_b64_tr_b16 a[222:223], v16 offset:42496
s_mov_b32 s14, 33554432
s_mov_b32 s15, 0x00020000
M a[132:135], a[188:191], a[252:255], a[132:135]
buffer_load_dword v126, v119, s[36:39], 0 offen offset:128 sc1
M a[136:139], a[196:199], a[252:255], a[136:139]
s_mov_b32 s8, s4
s_mov_b32 s9, s5
M a[136:139], a[192:195], a[248:251], a[136:139]
s_waitcnt lgkmcnt(10)
M a[140:143], a[176:179], a[224:227], a[140:143]
s_mov_b32 s10, 16777216
s_mov_b32 s11, 0x00020000
M a[140:143], a[180:183], a[228:231], a[140:143]
M a[144:147], a[188:191], a[228:231], a[144:147]
M a[144:147], a[184:187], a[224:227], a[144:147]
M a[148:151], a[192:195], a[224:227], a[148:151]
s_waitcnt vmcnt(17) lgkmcnt(0)
s_barrier
ds_read_b128 a[248:251], v12 offset:0
ds_read_b128 a[252:255], v13 offset:0
s_waitcnt vmcnt(0)
v_cmp_gt_u32 vcc, 0x80, v126
s_nop 0
s_cbranch_vccnz Lk1_spin
Lk1_got:
M a[148:151], a[196:199], a[228:231], a[148:151]
s_add_u32 m0, s29, 65536
s_add_u32 s32, s25, 4096
buffer_load_dwordx4 v1, s[12:15], s25 offen offset:0 sc1 lds
M a[152:155], a[180:183], a[236:239], a[152:155]
ds_read_b128 a[224:227], v12 offset:2048
ds_read_b128 a[228:231], v13 offset:2048
M a[152:155], a[176:179], a[232:235], a[152:155]
buffer_load_dwordx4 v1, s[12:15], s25 offen offset:1024 sc1 lds
M a[156:159], a[184:187], a[232:235], a[156:159]
M a[156:159], a[188:191], a[236:239], a[156:159]
buffer_load_dwordx4 v1, s[12:15], s25 offen offset:2048 sc1 lds
M a[160:163], a[196:199], a[236:239], a[160:163]
buffer_load_dwordx4 v1, s[12:15], s25 offen offset:3072 sc1 lds
M a[160:163], a[192:195], a[232:235], a[160:163]
M a[164:167], a[176:179], a[240:243], a[164:167]
ds_read_b128 a[232:235], v12 offset:4096
ds_read_b128 a[236:239], v13 offset:4096
M a[164:167], a[180:183], a[244:247], a[164:167]
s_add_u32 m0, s29, 69632
s_nop 0
buffer_load_dwordx4 v1, s[12:15], s32 offen offset:0 sc1 lds
M a[168:171], a[188:191], a[244:247], a[168:171]
buffer_load_dwordx4 v1, s[12:15], s32 offen offset:1024 sc1 lds
M a[168:171], a[184:187], a[240:243], a[168:171]
M a[172:175], a[192:195], a[240:243], a[172:175]
buffer_load_dwordx4 v1, s[12:15], s32 offen offset:2048 sc1 lds
M a[172:175], a[196:199], a[244:247], a[172:175]
s_waitcnt lgkmcnt(4)
M a[68:71], a[200:203], a[248:251], a[68:71]
ds_read_b128 a[240:243], v12 offset:6144
ds_read_b128 a[244:247], v13 offset:6144
M a[68:71], a[204:207], a[252:255], a[68:71]
buffer_load_dwordx4 v1, s[12:15], s32 offen offset:3072 sc1 lds
M a[72:75], a[212:215], a[252:255], a[72:75]
M a[72:75], a[208:211], a[248:251], a[72:75]
M a[76:79], a[216:219], a[248:251], a[76:79]
M a[76:79], a[220:223], a[252:255], a[76:79]
s_waitcnt lgkmcnt(4)
M a[80:83], a[204:207], a[228:231], a[80:83]
ds_read_b128 a[248:251], v12 offset:8192
ds_read_b128 a[252:255], v13 offset:8192
M a[80:83], a[200:203], a[224:227], a[80:83]
M a[84:87], a[208:211], a[224:227], a[84:87]
M a[84:87], a[212:215], a[228:231], a[84:87]
M a[88:91], a[220:223], a[228:231], a[88:91]
M a[88:91], a[216:219], a[224:227], a[88:91]
s_waitcnt lgkmcnt(4)
M a[92:95], a[200:203], a[232:235], a[92:95]
ds_read_b128 a[224:227], v12 offset:10240
ds_read_b128 a[228:231], v13 offset:10240
v_accvgpr_read_b32 v24, a68
v_accvgpr_read_b32 v25, a69
v_accvgpr_read_b32 v26, a70
M a[92:95], a[204:207], a[236:239], a[92:95]
v_accvgpr_read_b32 v27, a71
v_cvt_pk_bf16_f32 v24, v24, v25
v_cvt_pk_bf16_f32 v25, v26, v27
ds_write_b64 v124, v[24:25] offset:0
M a[96:99], a[212:215], a[236:239], a[96:99]
v_accvgpr_read_b32 v28, a72
v_accvgpr_read_b32 v29, a73
v_accvgpr_read_b32 v30, a74
M a[96:99], a[208:211], a[232:235], a[96:99]
v_accvgpr_read_b32 v31, a75
v_cvt_pk_bf16_f32 v28, v28, v29
v_cvt_pk_bf16_f32 v29, v30, v31
ds_write_b64 v124, v[28:29] offset:32
M a[100:103], a[216:219], a[232:235], a[100:103]
v_accvgpr_read_b32 v24, a76
v_accvgpr_read_b32 v25, a77
v_accvgpr_read_b32 v26, a78
M a[100:103], a[220:223], a[236:239], a[100:103]
s_waitcnt lgkmcnt(6)
v_accvgpr_read_b32 v27, a79
v_cvt_pk_bf16_f32 v24, v24, v25
v_cvt_pk_bf16_f32 v25, v26, v27
ds_write_b64 v124, v[24:25] offset:64
M a[104:107], a[204:207], a[244:247], a[104:107]
ds_read_b128 a[232:235], v12 offset:12288
ds_read_b128 a[236:239], v13 offset:12288
v_accvgpr_read_b32 v24, a80
v_accvgpr_read_b32 v25, a81
v_accvgpr_read_b32 v26, a82
M a[104:107], a[200:203], a[240:243], a[104:107]
v_accvgpr_read_b32 v27, a83
v_cvt_pk_bf16_f32 v24, v24, v25
v_cvt_pk_bf16_f32 v25, v26, v27
ds_write_b64 v124, v[24:25] offset:6400
M a[108:111], a[208:211], a[240:243], a[108:111]
v_accvgpr_read_b32 v28, a84
v_accvgpr_read_b32 v29, a85
v_accvgpr_read_b32 v30, a86
M a[108:111], a[212:215], a[244:247], a[108:111]
v_accvgpr_read_b32 v31, a87
v_cvt_pk_bf16_f32 v28, v28, v29
v_cvt_pk_bf16_f32 v29, v30, v31
ds_write_b64 v124, v[28:29] offset:6432
M a[112:115], a[220:223], a[244:247], a[112:115]
v_accvgpr_read_b32 v24, a88
v_accvgpr_read_b32 v25, a89
v_accvgpr_read_b32 v26, a90
M a[112:115], a[216:219], a[240:243], a[112:115]
s_waitcnt lgkmcnt(9)
v_accvgpr_read_b32 v27, a91
v_cvt_pk_bf16_f32 v24, v24, v25
v_cvt_pk_bf16_f32 v25, v26, v27
ds_write_b64 v124, v[24:25] offset:6464
M a[116:119], a[200:203], a[248:251], a[116:119]
ds_read_b128 a[240:243], v12 offset:14336
ds_read_b128 a[244:247], v13 offset:14336
v_accvgpr_read_b32 v24, a92
v_accvgpr_read_b32 v25, a93
v_accvgpr_read_b32 v26, a94
M a[116:119], a[204:207], a[252:255], a[116:119]
v_accvgpr_read_b32 v27, a95
v_cvt_pk_bf16_f32 v24, v24, v25
v_cvt_pk_bf16_f32 v25, v26, v27
ds_write_b64 v124, v[24:25] offset:12800
M a[120:123], a[212:215], a[252:255], a[120:123]
v_accvgpr_read_b32 v28, a96
v_accvgpr_read_b32 v29, a97
v_accvgpr_read_b32 v30, a98
M a[120:123], a[208:211], a[248:251], a[120:123]
v_accvgpr_read_b32 v31, a99
v_cvt_pk_bf16_f32 v28, v28, v29
v_cvt_pk_bf16_f32 v29, v30, v31
ds_write_b64 v124, v[28:29] offset:12832
M a[124:127], a[216:219], a[248:251], a[124:127]
v_accvgpr_read_b32 v24, a100
v_accvgpr_read_b32 v25, a101
v_accvgpr_read_b32 v26, a102
M a[124:127], a[220:223], a[252:255], a[124:127]
s_add_u32 s25, s25, 32768
s_cmp_eq_u32 s25, s27
s_cselect_b32 s25, s28, s25
s_cselect_b32 s27, s56, s27
s_cselect_b32 s28, s57, s28
s_cselect_b32 s56, -1, s56
s_waitcnt lgkmcnt(12)
v_accvgpr_read_b32 v27, a103
v_cvt_pk_bf16_f32 v24, v24, v25
v_cvt_pk_bf16_f32 v25, v26, v27
ds_write_b64 v124, v[24:25] offset:12864
M a[128:131], a[204:207], a[228:231], a[128:131]
ds_read_b128 a[248:251], v12 offset:16384
ds_read_b128 a[252:255], v13 offset:16384
v_accvgpr_read_b32 v24, a104
v_accvgpr_read_b32 v25, a105
v_accvgpr_read_b32 v26, a106
M a[128:131], a[200:203], a[224:227], a[128:131]
v_accvgpr_read_b32 v27, a107
v_cvt_pk_bf16_f32 v24, v24, v25
v_cvt_pk_bf16_f32 v25, v26, v27
ds_write_b64 v124, v[24:25] offset:19200
M a[132:135], a[208:211], a[224:227], a[132:135]
v_accvgpr_read_b32 v28, a108
v_accvgpr_read_b32 v29, a109
v_accvgpr_read_b32 v30, a110
M a[132:135], a[212:215], a[228:231], a[132:135]
v_accvgpr_read_b32 v31, a111
v_cvt_pk_bf16_f32 v28, v28, v29
v_cvt_pk_bf16_f32 v29, v30, v31
ds_write_b64 v124, v[28:29] offset:19232
M a[136:139], a[220:223], a[228:231], a[136:139]
v_accvgpr_read_b32 v24, a112
v_accvgpr_read_b32 v25, a113
v_accvgpr_read_b32 v26, a114
M a[136:139], a[216:219], a[224:227], a[136:139]
s_waitcnt lgkmcnt(12)
v_accvgpr_read_b32 v27, a115
v_cvt_pk_bf16_f32 v24, v24, v25
v_cvt_pk_bf16_f32 v25, v26, v27
ds_write_b64 v124, v[24:25] offset:19264
M a[140:143], a[200:203], a[232:235], a[140:143]
v_accvgpr_read_b32 v24, a116
v_accvgpr_read_b32 v25, a117
v_accvgpr_read_b32 v26, a118
M a[140:143], a[204:207], a[236:239], a[140:143]
v_accvgpr_read_b32 v27, a119
v_cvt_pk_bf16_f32 v24, v24, v25
v_cvt_pk_bf16_f32 v25, v26, v27
ds_write_b64 v124, v[24:25] offset:25600
M a[144:147], a[212:215], a[236:239], a[144:147]
v_accvgpr_read_b32 v28, a120
v_accvgpr_read_b32 v29, a121
v_accvgpr_read_b32 v30, a122
M a[144:147], a[208:211], a[232:235], a[144:147]
v_accvgpr_read_b32 v31, a123
v_cvt_pk_bf16_f32 v28, v28, v29
v_cvt_pk_bf16_f32 v29, v30, v31
ds_write_b64 v124, v[28:29] offset:25632
M a[148:151], a[216:219], a[232:235], a[148:151]
s_waitcnt lgkmcnt(0)
s_barrier
v_accvgpr_read_b32 v24, a124
v_accvgpr_read_b32 v25, a125
v_accvgpr_read_b32 v26, a126
M a[148:151], a[220:223], a[236:239], a[148:151]
v_accvgpr_read_b32 v27, a127
v_cvt_pk_bf16_f32 v24, v24, v25
v_cvt_pk_bf16_f32 v25, v26, v27
ds_write_b64 v124, v[24:25] offset:25664
v_accvgpr_read_b32 v24, a128
v_accvgpr_read_b32 v25, a129
v_accvgpr_read_b32 v26, a130
M a[152:155], a[204:207], a[244:247], a[152:155]
v_accvgpr_read_b32 v27, a131
v_cvt_pk_bf16_f32 v24, v24, v25
v_cvt_pk_bf16_f32 v25, v26, v27
M a[152:155], a[200:203], a[240:243], a[152:155]
ds_write_b64 v124, v[24:25] offset:32000
v_accvgpr_read_b32 v28, a132
v_accvgpr_read_b32 v29, a133
M a[156:159], a[208:211], a[240:243], a[156:159]
v_accvgpr_read_b32 v30, a134
v_accvgpr_read_b32 v31, a135
v_cvt_pk_bf16_f32 v28, v28, v29
M a[156:159], a[212:215], a[244:247], a[156:159]
v_cvt_pk_bf16_f32 v29, v30, v31
ds_write_b64 v124, v[28:29] offset:32032
v_accvgpr_read_b32 v24, a136
M a[160:163], a[220:223], a[244:247], a[160:163]
v_accvgpr_read_b32 v25, a137
v_accvgpr_read_b32 v26, a138
v_accvgpr_read_b32 v27, a139
M a[160:163], a[216:219], a[240:243], a[160:163]
v_cvt_pk_bf16_f32 v24, v24, v25
v_cvt_pk_bf16_f32 v25, v26, v27
ds_write_b64 v124, v[24:25] offset:32064
M a[164:167], a[200:203], a[248:251], a[164:167]
v_accvgpr_read_b32 v24, a140
v_accvgpr_read_b32 v25, a141
v_accvgpr_read_b32 v26, a142
M a[164:167], a[204:207], a[252:255], a[164:167]
v_accvgpr_read_b32 v27, a143
v_cvt_pk_bf16_f32 v24, v24, v25
v_cvt_pk_bf16_f32 v25, v26, v27
ds_write_b64 v124, v[24:25] offset:38400
M a[168:171], a[212:215], a[252:255], a[168:171]
v_accvgpr_read_b32 v28, a144
v_accvgpr_read_b32 v29, a145
v_accvgpr_read_b32 v30, a146
M a[168:171], a[208:211], a[248:251], a[168:171]
v_accvgpr_read_b32 v31, a147
v_cvt_pk_bf16_f32 v28, v28, v29
v_cvt_pk_bf16_f32 v29, v30, v31
ds_write_b64 v124, v[28:29] offset:38432
M a[172:175], a[216:219], a[248:251], a[172:175]
v_accvgpr_read_b32 v24, a148
v_accvgpr_read_b32 v25, a149
v_accvgpr_read_b32 v26, a150
M a[172:175], a[220:223], a[252:255], a[172:175]
v_accvgpr_read_b32 v27, a151
v_cvt_pk_bf16_f32 v24, v24, v25
v_cvt_pk_bf16_f32 v25, v26, v27
ds_write_b64 v124, v[24:25] offset:38464
s_mov_b64 s[44:45], s[42:43]
v_accvgpr_read_b32 v24, a152
v_accvgpr_read_b32 v25, a153
v_accvgpr_read_b32 v26, a154
v_accvgpr_read_b32 v27, a155
v_cvt_pk_bf16_f32 v24, v24, v25
v_cvt_pk_bf16_f32 v25, v26, v27
ds_write_b64 v124, v[24:25] offset:44800
v_accvgpr_read_b32 v28, a156
v_accvgpr_read_b32 v29, a157
v_accvgpr_read_b32 v30, a158
v_accvgpr_read_b32 v31, a159
v_cvt_pk_bf16_f32 v28, v28, v29
v_cvt_pk_bf16_f32 v29, v30, v31
ds_write_b64 v124, v[28:29] offset:44832
v_accvgpr_read_b32 v24, a160
v_accvgpr_read_b32 v25, a161
v_accvgpr_read_b32 v26, a162
v_accvgpr_read_b32 v27, a163
v_cvt_pk_bf16_f32 v24, v24, v25
v_cvt_pk_bf16_f32 v25, v26, v27
ds_write_b64 v124, v[24:25] offset:44864
v_accvgpr_read_b32 v24, a164
v_accvgpr_read_b32 v25, a165
v_accvgpr_read_b32 v26, a166
v_accvgpr_read_b32 v27, a167
v_cvt_pk_bf16_f32 v24, v24, v25
v_cvt_pk_bf16_f32 v25, v26, v27
ds_write_b64 v124, v[24:25] offset:51200
v_accvgpr_read_b32 v28, a168
v_accvgpr_read_b32 v29, a169
v_accvgpr_read_b32 v30, a170
v_accvgpr_read_b32 v31, a171
v_cvt_pk_bf16_f32 v28, v28, v29
v_cvt_pk_bf16_f32 v29, v30, v31
ds_write_b64 v124, v[28:29] offset:51232
v_accvgpr_read_b32 v24, a172
v_accvgpr_read_b32 v25, a173
v_accvgpr_read_b32 v26, a174
v_accvgpr_read_b32 v27, a175
v_cvt_pk_bf16_f32 v24, v24, v25
v_cvt_pk_bf16_f32 v25, v26, v27
ds_write_b64 v124, v[24:25] offset:51264
s_waitcnt lgkmcnt(0)
s_barrier
ds_read_b128 v[48:51], v121 offset:128
ds_read_b128 v[32:35], v120 offset:0
ds_read_b128 v[52:55], v120 offset:128
ds_read_b128 v[36:39], v120 offset:12800
ds_read_b128 v[56:59], v120 offset:12928
ds_read_b128 v[40:43], v120 offset:25600
ds_read_b128 v[60:63], v120 offset:25728
ds_read_b128 v[44:47], v120 offset:38400
ds_read_b128 v[64:67], v120 offset:38528
ds_read_b64_tr_b16 v[68:69], v123 offset:256
ds_read_b64_tr_b16 v[70:71], v122 offset:256
ds_read_b64_tr_b16 v[72:73], v122 offset:13056
ds_read_b64_tr_b16 v[74:75], v122 offset:25856
ds_read_b64_tr_b16 v[76:77], v122 offset:38656
ds_read_b64_tr_b16 v[78:79], v123 offset:288
ds_read_b64_tr_b16 v[80:81], v122 offset:288
ds_read_b64_tr_b16 v[82:83], v122 offset:13088
ds_read_b64_tr_b16 v[84:85], v122 offset:25888
ds_read_b64_tr_b16 v[86:87], v122 offset:38688
v_accvgpr_write_b32 a64, 0
v_accvgpr_write_b32 a65, 0
v_accvgpr_write_b32 a66, 0
v_accvgpr_write_b32 a67, 0
v_accvgpr_write_b32 a68, 0
v_accvgpr_write_b32 a69, 0
v_accvgpr_write_b32 a70, 0
v_accvgpr_write_b32 a71, 0
v_accvgpr_write_b32 a72, 0
v_accvgpr_write_b32 a73, 0
v_accvgpr_write_b32 a74, 0
v_accvgpr_write_b32 a75, 0
s_add_u32 m0, s29, 0
s_add_u32 s32, s25, 4096
buffer_load_dwordx4 v1, s[12:15], s25 offen offset:0 sc1 lds
v_accvgpr_write_b32 a76, 0
v_accvgpr_write_b32 a77, 0
v_accvgpr_write_b32 a78, 0
v_accvgpr_write_b32 a79, 0
v_accvgpr_write_b32 a80, 0
v_accvgpr_write_b32 a81, 0
v_accvgpr_write_b32 a82, 0
v_accvgpr_write_b32 a83, 0
v_accvgpr_write_b32 a84, 0
v_accvgpr_write_b32 a85, 0
v_accvgpr_write_b32 a86, 0
buffer_load_dwordx4 v1, s[12:15], s25 offen offset:1024 sc1 lds
v_accvgpr_write_b32 a87, 0
v_accvgpr_write_b32 a88, 0
v_accvgpr_write_b32 a89, 0
v_accvgpr_write_b32 a90, 0
v_accvgpr_write_b32 a91, 0
v_accvgpr_write_b32 a92, 0
v_accvgpr_write_b32 a93, 0
v_accvgpr_write_b32 a94, 0
v_accvgpr_write_b32 a95, 0
v_accvgpr_write_b32 a96, 0
buffer_load_dwordx4 v1, s[12:15], s25 offen offset:2048 sc1 lds
v_accvgpr_write_b32 a97, 0
v_accvgpr_write_b32 a98, 0
v_accvgpr_write_b32 a99, 0
v_accvgpr_write_b32 a100, 0
v_accvgpr_write_b32 a101, 0
v_accvgpr_write_b32 a102, 0
v_accvgpr_write_b32 a103, 0
v_accvgpr_write_b32 a104, 0
v_accvgpr_write_b32 a105, 0
v_accvgpr_write_b32 a106, 0
v_accvgpr_write_b32 a107, 0
buffer_load_dwordx4 v1, s[12:15], s25 offen offset:3072 sc1 lds
v_accvgpr_write_b32 a108, 0
v_accvgpr_write_b32 a109, 0
v_accvgpr_write_b32 a110, 0
v_accvgpr_write_b32 a111, 0
s_waitcnt lgkmcnt(15)
M v[88:91], v[48:51], v[32:35], v[152:155]
M v[92:95], v[52:55], v[32:35], v[148:151]
M v[96:99], v[52:55], v[36:39], v[144:147]
s_waitcnt lgkmcnt(14)
M v[100:103], v[56:59], v[36:39], v[148:151]
s_waitcnt lgkmcnt(13)
M v[104:107], v[56:59], v[40:43], v[144:147]
s_waitcnt lgkmcnt(12)
M v[108:111], v[60:63], v[40:43], v[148:151]
s_add_u32 m0, s29, 4096
s_nop 0
buffer_load_dwordx4 v1, s[12:15], s32 offen offset:0 sc1 lds
s_waitcnt lgkmcnt(11)
M v[112:115], v[60:63], v[44:47], v[144:147]
s_waitcnt lgkmcnt(10)
M v[116:119], v[64:67], v[44:47], v[148:151]
v_max3_f32 v136, v88, v89, v90
v_max3_f32 v136, v136, v91, v92
v_max3_f32 v136, v136, v93, v94
v_max_f32 v136, v136, v95
v_max3_f32 v137, v96, v97, v98
v_max3_f32 v137, v137, v99, v100
v_max3_f32 v137, v137, v101, v102
v_max_f32 v137, v137, v103
v_max3_f32 v138, v104, v105, v106
buffer_load_dwordx4 v1, s[12:15], s32 offen offset:1024 sc1 lds
v_max3_f32 v138, v138, v107, v108
v_max3_f32 v138, v138, v109, v110
v_max_f32 v138, v138, v111
v_max3_f32 v139, v112, v113, v114
v_max3_f32 v139, v139, v115, v116
v_max3_f32 v139, v139, v117, v118
v_max_f32 v139, v139, v119
v_mov_b32 v140, v136
v_mov_b32 v141, v137
v_mov_b32 v142, v138
buffer_load_dwordx4 v1, s[12:15], s32 offen offset:2048 sc1 lds
v_mov_b32 v143, v139
v_permlane16_swap_b32 v136, v140
v_permlane16_swap_b32 v137, v141
v_permlane16_swap_b32 v138, v142
v_permlane16_swap_b32 v139, v143
v_max_f32 v136, v136, v140
v_max_f32 v137, v137, v141
v_max_f32 v138, v138, v142
v_max_f32 v139, v139, v143
v_mov_b32 v140, v136
v_mov_b32 v141, v137
buffer_load_dwordx4 v1, s[12:15], s32 offen offset:3072 sc1 lds
v_mov_b32 v142, v138
v_mov_b32 v143, v139
v_permlane32_swap_b32 v136, v140
v_permlane32_swap_b32 v137, v141
v_permlane32_swap_b32 v138, v142
v_permlane32_swap_b32 v139, v143
v_max_f32 v136, v136, v140
v_max_f32 v137, v137, v141
v_max_f32 v138, v138, v142
v_max_f32 v139, v139, v143
s_add_u32 s25, s25, 32768
s_cmp_eq_u32 s25, s27
s_cselect_b32 s25, s28, s25
s_cselect_b32 s27, s56, s27
s_cselect_b32 s28, s57, s28
s_cselect_b32 s56, -1, s56
v_mul_f32 v136, s7, v136
v_mul_f32 v137, s7, v137
v_mul_f32 v138, s7, v138
v_mul_f32 v139, s7, v139
v_fma_f32 v88, v88, s7, -v136
v_fma_f32 v89, v89, s7, -v136
v_fma_f32 v90, v90, s7, -v136
v_fma_f32 v91, v91, s7, -v136
v_fma_f32 v92, v92, s7, -v136
v_fma_f32 v93, v93, s7, -v136
v_fma_f32 v94, v94, s7, -v136
s_add_u32 m0, s29, 32768
s_add_u32 s32, s26, 4096
buffer_load_dwordx4 v1, s[12:15], s26 offen offset:0 sc1 lds
v_fma_f32 v95, v95, s7, -v136
v_exp_f32 v88, v88
v_exp_f32 v89, v89
v_exp_f32 v90, v90
v_exp_f32 v91, v91
v_exp_f32 v92, v92
v_exp_f32 v93, v93
v_exp_f32 v94, v94
v_exp_f32 v95, v95
v_fma_f32 v96, v96, s7, -v137
v_fma_f32 v97, v97, s7, -v137
buffer_load_dwordx4 v1, s[12:15], s26 offen offset:1024 sc1 lds
v_fma_f32 v98, v98, s7, -v137
v_fma_f32 v99, v99, s7, -v137
v_fma_f32 v100, v100, s7, -v137
v_fma_f32 v101, v101, s7, -v137
v_fma_f32 v102, v102, s7, -v137
v_fma_f32 v103, v103, s7, -v137
v_exp_f32 v96, v96
v_exp_f32 v97, v97
v_exp_f32 v98, v98
v_exp_f32 v99, v99
buffer_load_dwordx4 v1, s[12:15], s26 offen offset:2048 sc1 lds
v_exp_f32 v100, v100
v_exp_f32 v101, v101
v_exp_f32 v102, v102
v_exp_f32 v103, v103
v_fma_f32 v104, v104, s7, -v138
v_fma_f32 v105, v105, s7, -v138
v_fma_f32 v106, v106, s7, -v138
v_fma_f32 v107, v107, s7, -v138
v_fma_f32 v108, v108, s7, -v138
v_fma_f32 v109, v109, s7, -v138
v_fma_f32 v110, v110, s7, -v138
buffer_load_dwordx4 v1, s[12:15], s26 offen offset:3072 sc1 lds
v_fma_f32 v111, v111, s7, -v138
v_exp_f32 v104, v104
v_exp_f32 v105, v105
v_exp_f32 v106, v106
v_exp_f32 v107, v107
v_exp_f32 v108, v108
v_exp_f32 v109, v109
v_exp_f32 v110, v110
v_exp_f32 v111, v111
v_fma_f32 v112, v112, s7, -v139
s_add_u32 m0, s29, 36864
s_nop 0
buffer_load_dwordx4 v1, s[12:15], s32 offen offset:0 sc1 lds
v_fma_f32 v113, v113, s7, -v139
v_fma_f32 v114, v114, s7, -v139
v_fma_f32 v115, v115, s7, -v139
v_fma_f32 v116, v116, s7, -v139
v_fma_f32 v117, v117, s7, -v139
v_fma_f32 v118, v118, s7, -v139
v_fma_f32 v119, v119, s7, -v139
v_exp_f32 v112, v112
v_exp_f32 v113, v113
v_exp_f32 v114, v114
v_exp_f32 v115, v115
buffer_load_dwordx4 v1, s[12:15], s32 offen offset:1024 sc1 lds
v_exp_f32 v116, v116
v_exp_f32 v117, v117
v_exp_f32 v118, v118
v_exp_f32 v119, v119
v_cvt_pk_bf16_f32 v88, v88, v89
v_cvt_pk_bf16_f32 v89, v90, v91
v_cvt_pk_bf16_f32 v90, v92, v93
v_cvt_pk_bf16_f32 v91, v94, v95
v_cvt_pk_bf16_f32 v96, v96, v97
v_cvt_pk_bf16_f32 v97, v98, v99
buffer_load_dwordx4 v1, s[12:15], s32 offen offset:2048 sc1 lds
v_cvt_pk_bf16_f32 v98, v100, v101
v_cvt_pk_bf16_f32 v99, v102, v103
v_cvt_pk_bf16_f32 v104, v104, v105
v_cvt_pk_bf16_f32 v105, v106, v107
v_cvt_pk_bf16_f32 v106, v108, v109
v_cvt_pk_bf16_f32 v107, v110, v111
v_cvt_pk_bf16_f32 v112, v112, v113
v_cvt_pk_bf16_f32 v113, v114, v115
v_cvt_pk_bf16_f32 v114, v116, v117
v_cvt_pk_bf16_f32 v115, v118, v119
M v[120:123], v[156:159], v[88:91], 0
buffer_load_dwordx4 v1, s[12:15], s32 offen offset:3072 sc1 lds
s_waitcnt lgkmcnt(8)
M v[32:35], v[68:71], v[88:91], 0
s_waitcnt lgkmcnt(3)
M v[36:39], v[78:81], v[88:91], 0
M v[124:127], v[156:159], v[96:99], 0
M v[40:43], v[70:73], v[96:99], 0
s_waitcnt lgkmcnt(2)
M v[44:47], v[80:83], v[96:99], 0
M v[128:131], v[156:159], v[104:107], 0
M v[48:51], v[72:75], v[104:107], 0
s_waitcnt lgkmcnt(1)
M v[52:55], v[82:85], v[104:107], 0
M v[132:135], v[156:159], v[112:115], 0
M v[56:59], v[74:77], v[112:115], 0
s_add_u32 s26, s26, 32768
s_cmp_eq_u32 s26, s62
s_cselect_b32 s26, s63, s26
s_cselect_b32 s62, s58, s62
s_cselect_b32 s63, s59, s63
s_cselect_b32 s58, -1, s58
s_waitcnt lgkmcnt(0)
M v[60:63], v[84:87], v[112:115], 0
v_rcp_f32 v120, v120
v_rcp_f32 v124, v124
v_rcp_f32 v128, v128
v_rcp_f32 v132, v132
v_pk_mul_f32 v[32:33], v[32:33], v[120:121] op_sel_hi:[1,0]
v_pk_mul_f32 v[34:35], v[34:35], v[120:121] op_sel_hi:[1,0]
v_pk_mul_f32 v[36:37], v[36:37], v[120:121] op_sel_hi:[1,0]
v_pk_mul_f32 v[38:39], v[38:39], v[120:121] op_sel_hi:[1,0]
v_cvt_pk_bf16_f32 v32, v32, v33
v_cvt_pk_bf16_f32 v33, v34, v35
v_cvt_pk_bf16_f32 v34, v36, v37
v_cvt_pk_bf16_f32 v35, v38, v39
s_add_u32 s3, s6, 0
buffer_store_dwordx4 v[32:35], v1, s[16:19], s3 offen sc1
v_pk_mul_f32 v[40:41], v[40:41], v[124:125] op_sel_hi:[1,0]
v_pk_mul_f32 v[42:43], v[42:43], v[124:125] op_sel_hi:[1,0]
v_pk_mul_f32 v[44:45], v[44:45], v[124:125] op_sel_hi:[1,0]
v_pk_mul_f32 v[46:47], v[46:47], v[124:125] op_sel_hi:[1,0]
v_cvt_pk_bf16_f32 v40, v40, v41
v_cvt_pk_bf16_f32 v41, v42, v43
v_cvt_pk_bf16_f32 v42, v44, v45
v_cvt_pk_bf16_f32 v43, v46, v47
s_add_u32 s3, s6, 2048
buffer_store_dwordx4 v[40:43], v1, s[16:19], s3 offen sc1
v_pk_mul_f32 v[48:49], v[48:49], v[128:129] op_sel_hi:[1,0]
v_pk_mul_f32 v[50:51], v[50:51], v[128:129] op_sel_hi:[1,0]
v_pk_mul_f32 v[52:53], v[52:53], v[128:129] op_sel_hi:[1,0]
v_pk_mul_f32 v[54:55], v[54:55], v[128:129] op_sel_hi:[1,0]
v_cvt_pk_bf16_f32 v48, v48, v49
v_cvt_pk_bf16_f32 v49, v50, v51
v_cvt_pk_bf16_f32 v50, v52, v53
v_cvt_pk_bf16_f32 v51, v54, v55
s_add_u32 s3, s6, 4096
buffer_store_dwordx4 v[48:51], v1, s[16:19], s3 offen sc1
v_pk_mul_f32 v[56:57], v[56:57], v[132:133] op_sel_hi:[1,0]
v_pk_mul_f32 v[58:59], v[58:59], v[132:133] op_sel_hi:[1,0]
v_pk_mul_f32 v[60:61], v[60:61], v[132:133] op_sel_hi:[1,0]
v_pk_mul_f32 v[62:63], v[62:63], v[132:133] op_sel_hi:[1,0]
v_cvt_pk_bf16_f32 v56, v56, v57
v_cvt_pk_bf16_f32 v57, v58, v59
v_cvt_pk_bf16_f32 v58, v60, v61
v_cvt_pk_bf16_f32 v59, v62, v63
s_add_u32 s3, s6, 6144
buffer_store_dwordx4 v[56:59], v1, s[16:19], s3 offen sc1
Lc2:
s_add_u32 s16, s4, 67108864
s_addc_u32 s17, s5, 0
s_mov_b32 s18, 16777216
s_mov_b32 s19, 0x00020000
s_add_u32 s52, s4, 100663296
s_addc_u32 s53, s5, 0
s_mov_b32 s54, 16793600
s_mov_b32 s55, 0x00020000
s_mov_b32 s46, 8388608
s_mov_b32 s47, 0x00020000
s_mov_b32 s50, 2097152
s_mov_b32 s51, 0x00020000
s_lshl_b32 s33, s24, 14
v_add_u32 v2, 0, v1
v_add_u32 v3, 0x10000, v2
v_mov_b32 v5, v2
v_mov_b32 v6, v3
v_and_b32 v8, 15, v0
v_bfe_u32 v9, v0, 4, 2
v_lshlrev_b32 v9, 2, v9
v_sub_u32 v8, v8, v9
v_mov_b32 v4, 0xf149f2ca
v_cmp_gt_i32 vcc, 0, v8
s_nop 1
v_cndmask_b32 v16, 0, v4, vcc
v_cmp_gt_i32 vcc, 1, v8
s_nop 1
v_cndmask_b32 v17, 0, v4, vcc
v_cmp_gt_i32 vcc, 2, v8
s_nop 1
v_cndmask_b32 v18, 0, v4, vcc
v_cmp_gt_i32 vcc, 3, v8
s_nop 1
v_cndmask_b32 v19, 0, v4, vcc
v_mov_b32 v8, 0x3f803f80
v_accvgpr_write_b32 a112, v8
v_accvgpr_write_b32 a113, v8
v_accvgpr_write_b32 a114, v8
v_accvgpr_write_b32 a115, v8
s_lshl_b32 s33, s23, 6
s_add_i32 s33, s33, s31
s_cmp_gt_i32 s33, 0
s_cselect_b32 s34, 0, 0xf149f2ca
s_cmp_lt_i32 s33, 0
s_cselect_b32 s33, 0xf149f2ca, 0
v_mov_b32 v20, s34
v_mov_b32 v21, s34
v_mov_b32 v22, s34
v_mov_b32 v23, s34
v_mov_b32 v28, s33
v_mov_b32 v29, s33
v_mov_b32 v30, s33
v_mov_b32 v31, s33
v_med3_f32 v24, v16, v20, v28
v_med3_f32 v25, v17, v20, v28
v_med3_f32 v26, v18, v20, v28
v_med3_f32 v27, v19, v20, v28
v_mov_b32 v12, 0
v_mov_b32 v13, 1
s_waitcnt vmcnt(20)
s_barrier
ds_read_b128 a[116:119], v3 offset:0
ds_read_b128 a[120:123], v3 offset:1024
ds_read_b128 a[124:127], v3 offset:2048
ds_read_b128 a[128:131], v3 offset:3072
ds_read_b128 a[132:135], v3 offset:4096
ds_read_b128 a[136:139], v3 offset:5120
ds_read_b128 a[140:143], v3 offset:6144
ds_read_b128 a[144:147], v3 offset:7168
s_waitcnt lgkmcnt(4)
M v[32:35], a[116:119], a[0:3], v[24:27]
M v[32:35], a[120:123], a[4:7], v[32:35]
ds_read_b128 a[148:151], v3 offset:8192
ds_read_b128 a[152:155], v3 offset:9216
M v[32:35], a[124:127], a[8:11], v[32:35]
M v[32:35], a[128:131], a[12:15], v[32:35]
M v[36:39], a[128:131], a[28:31], v[28:31]
M v[36:39], a[124:127], a[24:27], v[36:39]
M v[36:39], a[120:123], a[20:23], v[36:39]
M v[36:39], a[116:119], a[16:19], v[36:39]
M v[40:43], a[116:119], a[32:35], v[28:31]
M v[40:43], a[120:123], a[36:39], v[40:43]
ds_read_b128 a[156:159], v3 offset:10240
ds_read_b128 a[160:163], v3 offset:11264
M v[40:43], a[124:127], a[40:43], v[40:43]
M v[40:43], a[128:131], a[44:47], v[40:43]
M v[44:47], a[128:131], a[60:63], v[28:31]
M v[44:47], a[124:127], a[56:59], v[44:47]
M v[44:47], a[120:123], a[52:55], v[44:47]
M v[44:47], a[116:119], a[48:51], v[44:47]
s_waitcnt lgkmcnt(4)
M v[48:51], a[132:135], a[0:3], v[20:23]
M v[48:51], a[136:139], a[4:7], v[48:51]
ds_read_b128 a[164:167], v3 offset:12288
ds_read_b128 a[168:171], v3 offset:13312
M v[48:51], a[140:143], a[8:11], v[48:51]
M v[48:51], a[144:147], a[12:15], v[48:51]
M v[52:55], a[144:147], a[28:31], v[24:27]
M v[52:55], a[140:143], a[24:27], v[52:55]
M v[52:55], a[136:139], a[20:23], v[52:55]
M v[52:55], a[132:135], a[16:19], v[52:55]
M v[56:59], a[132:135], a[32:35], v[28:31]
M v[56:59], a[136:139], a[36:39], v[56:59]
ds_read_b128 a[172:175], v3 offset:14336
ds_read_b128 a[176:179], v3 offset:15360
M v[56:59], a[140:143], a[40:43], v[56:59]
M v[56:59], a[144:147], a[44:47], v[56:59]
M v[60:63], a[144:147], a[60:63], v[28:31]
M v[60:63], a[140:143], a[56:59], v[60:63]
M v[60:63], a[136:139], a[52:55], v[60:63]
M v[60:63], a[132:135], a[48:51], v[60:63]
s_waitcnt lgkmcnt(4)
M v[64:67], a[148:151], a[0:3], v[20:23]
M v[64:67], a[152:155], a[4:7], v[64:67]
M v[64:67], a[156:159], a[8:11], v[64:67]
M v[64:67], a[160:163], a[12:15], v[64:67]
M v[68:71], a[160:163], a[28:31], v[20:23]
M v[68:71], a[156:159], a[24:27], v[68:71]
M v[68:71], a[152:155], a[20:23], v[68:71]
M v[68:71], a[148:151], a[16:19], v[68:71]
M v[72:75], a[148:151], a[32:35], v[24:27]
M v[72:75], a[152:155], a[36:39], v[72:75]
M v[72:75], a[156:159], a[40:43], v[72:75]
M v[72:75], a[160:163], a[44:47], v[72:75]
M v[76:79], a[160:163], a[60:63], v[28:31]
M v[76:79], a[156:159], a[56:59], v[76:79]
s_waitcnt vmcnt(4) lgkmcnt(0)
s_barrier
ds_read_b128 a[116:119], v2 offset:0
ds_read_b128 a[120:123], v2 offset:1024
M v[76:79], a[152:155], a[52:55], v[76:79]
M v[76:79], a[148:151], a[48:51], v[76:79]
M v[80:83], a[164:167], a[0:3], v[20:23]
M v[80:83], a[168:171], a[4:7], v[80:83]
ds_read_b128 a[124:127], v2 offset:2048
ds_read_b128 a[128:131], v2 offset:3072
M v[80:83], a[172:175], a[8:11], v[80:83]
M v[80:83], a[176:179], a[12:15], v[80:83]
M v[84:87], a[176:179], a[28:31], v[20:23]
M v[84:87], a[172:175], a[24:27], v[84:87]
ds_read_b128 a[132:135], v2 offset:4096
ds_read_b128 a[136:139], v2 offset:5120
M v[84:87], a[168:171], a[20:23], v[84:87]
M v[84:87], a[164:167], a[16:19], v[84:87]
M v[88:91], a[164:167], a[32:35], v[20:23]
M v[88:91], a[168:171], a[36:39], v[88:91]
ds_read_b128 a[140:143], v2 offset:6144
ds_read_b128 a[144:147], v2 offset:7168
M v[88:91], a[172:175], a[40:43], v[88:91]
M v[88:91], a[176:179], a[44:47], v[88:91]
M v[92:95], a[176:179], a[60:63], v[24:27]
M v[92:95], a[172:175], a[56:59], v[92:95]
M v[92:95], a[168:171], a[52:55], v[92:95]
M v[92:95], a[164:167], a[48:51], v[92:95]
s_waitcnt vmcnt(0)
s_mov_b64 exec, 1
buffer_store_dword v13, v12, s[52:55], s65 offen sc1
s_mov_b64 exec, -1
v_exp_f32 v32, v32
v_exp_f32 v33, v33
v_exp_f32 v34, v34
v_exp_f32 v35, v35
v_exp_f32 v48, v48
v_exp_f32 v49, v49
v_exp_f32 v50, v50
v_exp_f32 v51, v51
v_cvt_pk_bf16_f32 v32, v32, v33
v_cvt_pk_bf16_f32 v33, v34, v35
v_exp_f32 v36, v36
v_exp_f32 v37, v37
v_exp_f32 v38, v38
v_exp_f32 v39, v39
v_cvt_pk_bf16_f32 v34, v48, v49
v_cvt_pk_bf16_f32 v35, v50, v51
v_exp_f32 v52, v52
v_exp_f32 v53, v53
v_exp_f32 v54, v54
v_exp_f32 v55, v55
v_cvt_pk_bf16_f32 v36, v36, v37
v_cvt_pk_bf16_f32 v37, v38, v39
v_exp_f32 v40, v40
v_exp_f32 v41, v41
v_exp_f32 v42, v42
v_exp_f32 v43, v43
v_cvt_pk_bf16_f32 v38, v52, v53
v_cvt_pk_bf16_f32 v39, v54, v55
v_exp_f32 v56, v56
v_exp_f32 v57, v57
v_exp_f32 v58, v58
v_exp_f32 v59, v59
v_cvt_pk_bf16_f32 v40, v40, v41
v_cvt_pk_bf16_f32 v41, v42, v43
v_exp_f32 v44, v44
v_exp_f32 v45, v45
v_exp_f32 v46, v46
v_exp_f32 v47, v47
v_cvt_pk_bf16_f32 v42, v56, v57
v_cvt_pk_bf16_f32 v43, v58, v59
v_exp_f32 v60, v60
v_exp_f32 v61, v61
v_exp_f32 v62, v62
v_exp_f32 v63, v63
v_cvt_pk_bf16_f32 v44, v44, v45
v_cvt_pk_bf16_f32 v45, v46, v47
v_cvt_pk_bf16_f32 v46, v60, v61
v_cvt_pk_bf16_f32 v47, v62, v63
s_cmp_eq_u32 s24, 1
s_cbranch_scc1 Lk2_g1
s_mov_b32 s30, s21
s_cmp_eq_u32 s21, 0
s_cbranch_scc1 Lk2_m2
Lk2_l1:
s_add_u32 m0, s29, 65536
s_waitcnt lgkmcnt(4)
M v[96:99], a[116:119], a[0:3], 0
v_exp_f32 v64, v64
M v[96:99], a[120:123], a[4:7], v[96:99]
ds_read_b128 a[148:151], v2 offset:8192
ds_read_b128 a[152:155], v2 offset:9216
M v[96:99], a[124:127], a[8:11], v[96:99]
v_exp_f32 v65, v65
M v[96:99], a[128:131], a[12:15], v[96:99]
buffer_load_dwordx4 v1, s[12:15], s25 offen offset:0 sc1 lds
s_add_u32 s32, s25, 4096
M v[100:103], a[128:131], a[28:31], 0
v_exp_f32 v66, v66
M v[100:103], a[124:127], a[24:27], v[100:103]
v_cvt_pk_bf16_f32 v64, v64, v65
M v[100:103], a[120:123], a[20:23], v[100:103]
v_exp_f32 v67, v67
M v[100:103], a[116:119], a[16:19], v[100:103]
buffer_load_dwordx4 v1, s[12:15], s25 offen offset:1024 sc1 lds
M v[104:107], a[116:119], a[32:35], 0
v_exp_f32 v80, v80
M v[104:107], a[120:123], a[36:39], v[104:107]
ds_read_b128 a[156:159], v2 offset:10240
ds_read_b128 a[160:163], v2 offset:11264
M v[104:107], a[124:127], a[40:43], v[104:107]
v_exp_f32 v81, v81
M v[104:107], a[128:131], a[44:47], v[104:107]
buffer_load_dwordx4 v1, s[12:15], s25 offen offset:2048 sc1 lds
M v[108:111], a[128:131], a[60:63], 0
v_exp_f32 v82, v82
M v[108:111], a[124:127], a[56:59], v[108:111]
v_cvt_pk_bf16_f32 v65, v66, v67
v_cvt_pk_bf16_f32 v66, v80, v81
M v[108:111], a[120:123], a[52:55], v[108:111]
v_exp_f32 v83, v83
M v[108:111], a[116:119], a[48:51], v[108:111]
buffer_load_dwordx4 v1, s[12:15], s25 offen offset:3072 sc1 lds
s_add_u32 m0, s29, 69632
s_waitcnt lgkmcnt(4)
M v[112:115], a[132:135], a[0:3], 0
v_exp_f32 v68, v68
M v[112:115], a[136:139], a[4:7], v[112:115]
ds_read_b128 a[164:167], v2 offset:12288
ds_read_b128 a[168:171], v2 offset:13312
M v[112:115], a[140:143], a[8:11], v[112:115]
v_exp_f32 v69, v69
M v[112:115], a[144:147], a[12:15], v[112:115]
buffer_load_dwordx4 v1, s[12:15], s32 offen offset:0 sc1 lds
M v[116:119], a[144:147], a[28:31], 0
v_exp_f32 v70, v70
M v[116:119], a[140:143], a[24:27], v[116:119]
v_cvt_pk_bf16_f32 v67, v82, v83
v_cvt_pk_bf16_f32 v68, v68, v69
M v[116:119], a[136:139], a[20:23], v[116:119]
v_exp_f32 v71, v71
M v[116:119], a[132:135], a[16:19], v[116:119]
buffer_load_dwordx4 v1, s[12:15], s32 offen offset:1024 sc1 lds
M v[120:123], a[132:135], a[32:35], 0
v_exp_f32 v84, v84
M v[120:123], a[136:139], a[36:39], v[120:123]
ds_read_b128 a[172:175], v2 offset:14336
ds_read_b128 a[176:179], v2 offset:15360
M v[120:123], a[140:143], a[40:43], v[120:123]
v_exp_f32 v85, v85
M v[120:123], a[144:147], a[44:47], v[120:123]
buffer_load_dwordx4 v1, s[12:15], s32 offen offset:2048 sc1 lds
M v[124:127], a[144:147], a[60:63], 0
v_exp_f32 v86, v86
M v[124:127], a[140:143], a[56:59], v[124:127]
v_cvt_pk_bf16_f32 v69, v70, v71
v_cvt_pk_bf16_f32 v70, v84, v85
M v[124:127], a[136:139], a[52:55], v[124:127]
v_exp_f32 v87, v87
M v[124:127], a[132:135], a[48:51], v[124:127]
buffer_load_dwordx4 v1, s[12:15], s32 offen offset:3072 sc1 lds
s_add_u32 m0, s29, 98304
s_waitcnt lgkmcnt(4)
M v[128:131], a[148:151], a[0:3], 0
v_exp_f32 v72, v72
M v[128:131], a[152:155], a[4:7], v[128:131]
ds_read_b128 a[116:119], v5 offset:32768
ds_read_b128 a[120:123], v5 offset:40960
M v[128:131], a[156:159], a[8:11], v[128:131]
v_exp_f32 v73, v73
M v[128:131], a[160:163], a[12:15], v[128:131]
buffer_load_dwordx4 v1, s[12:15], s26 offen offset:0 sc1 lds
s_add_u32 s43, s26, 4096
M v[132:135], a[160:163], a[28:31], 0
v_exp_f32 v74, v74
M v[132:135], a[156:159], a[24:27], v[132:135]
v_cvt_pk_bf16_f32 v71, v86, v87
v_cvt_pk_bf16_f32 v72, v72, v73
M v[132:135], a[152:155], a[20:23], v[132:135]
v_exp_f32 v75, v75
M v[132:135], a[148:151], a[16:19], v[132:135]
buffer_load_dwordx4 v1, s[12:15], s26 offen offset:1024 sc1 lds
M v[136:139], a[148:151], a[32:35], 0
v_exp_f32 v88, v88
M v[136:139], a[152:155], a[36:39], v[136:139]
ds_read_b128 a[124:127], v5 offset:33792
ds_read_b128 a[128:131], v5 offset:41984
M v[136:139], a[156:159], a[40:43], v[136:139]
v_exp_f32 v89, v89
M v[136:139], a[160:163], a[44:47], v[136:139]
buffer_load_dwordx4 v1, s[12:15], s26 offen offset:2048 sc1 lds
M v[140:143], a[160:163], a[60:63], 0
v_exp_f32 v90, v90
M v[140:143], a[156:159], a[56:59], v[140:143]
v_cvt_pk_bf16_f32 v73, v74, v75
v_cvt_pk_bf16_f32 v74, v88, v89
M v[140:143], a[152:155], a[52:55], v[140:143]
v_exp_f32 v91, v91
M v[140:143], a[148:151], a[48:51], v[140:143]
buffer_load_dwordx4 v1, s[12:15], s26 offen offset:3072 sc1 lds
s_add_u32 m0, s29, 102400
s_waitcnt lgkmcnt(4)
M v[144:147], a[164:167], a[0:3], 0
v_exp_f32 v76, v76
M v[144:147], a[168:171], a[4:7], v[144:147]
ds_read_b128 a[132:135], v5 offset:34816
ds_read_b128 a[136:139], v5 offset:43008
M v[144:147], a[172:175], a[8:11], v[144:147]
v_exp_f32 v77, v77
M v[144:147], a[176:179], a[12:15], v[144:147]
buffer_load_dwordx4 v1, s[12:15], s43 offen offset:0 sc1 lds
M v[148:151], a[176:179], a[28:31], 0
v_exp_f32 v78, v78
M v[148:151], a[172:175], a[24:27], v[148:151]
v_cvt_pk_bf16_f32 v75, v90, v91
v_cvt_pk_bf16_f32 v76, v76, v77
M v[148:151], a[168:171], a[20:23], v[148:151]
v_exp_f32 v79, v79
M v[148:151], a[164:167], a[16:19], v[148:151]
buffer_load_dwordx4 v1, s[12:15], s43 offen offset:1024 sc1 lds
M v[152:155], a[164:167], a[32:35], 0
v_exp_f32 v92, v92
M v[152:155], a[168:171], a[36:39], v[152:155]
ds_read_b128 a[140:143], v5 offset:35840
ds_read_b128 a[144:147], v5 offset:44032
M v[152:155], a[172:175], a[40:43], v[152:155]
v_exp_f32 v93, v93
M v[152:155], a[176:179], a[44:47], v[152:155]
buffer_load_dwordx4 v1, s[12:15], s43 offen offset:2048 sc1 lds
M v[156:159], a[176:179], a[60:63], 0
v_exp_f32 v94, v94
M v[156:159], a[172:175], a[56:59], v[156:159]
v_cvt_pk_bf16_f32 v77, v78, v79
v_cvt_pk_bf16_f32 v78, v92, v93
M v[156:159], a[168:171], a[52:55], v[156:159]
v_exp_f32 v95, v95
M v[156:159], a[164:167], a[48:51], v[156:159]
buffer_load_dwordx4 v1, s[12:15], s43 offen offset:3072 sc1 lds
v_cvt_pk_bf16_f32 v79, v94, v95
s_waitcnt lgkmcnt(6)
M v[160:163], a[116:119], v[32:35], v[160:163]
v_exp_f32 v96, v96
M v[160:163], a[120:123], v[64:67], v[160:163]
ds_read_b128 a[148:151], v5 offset:36864
ds_read_b128 a[152:155], v5 offset:45056
M v[164:167], a[120:123], v[68:71], v[164:167]
v_exp_f32 v97, v97
M v[164:167], a[116:119], v[36:39], v[164:167]
v_cvt_pk_bf16_f32 v96, v96, v97
M v[168:171], a[116:119], v[40:43], v[168:171]
v_exp_f32 v98, v98
M v[168:171], a[120:123], v[72:75], v[168:171]
s_add_u32 s25, s25, 32768
s_cmp_eq_u32 s25, s27
M v[172:175], a[120:123], v[76:79], v[172:175]
v_exp_f32 v99, v99
M v[172:175], a[116:119], v[44:47], v[172:175]
v_cvt_pk_bf16_f32 v97, v98, v99
s_waitcnt lgkmcnt(6)
M a[96:99], a[112:115], v[32:35], a[96:99]
s_cselect_b32 s25, s28, s25
s_cselect_b32 s27, -1, s27
M a[96:99], a[112:115], v[64:67], a[96:99]
s_add_u32 s26, s26, 32768
s_cmp_eq_u32 s26, s62
M v[176:179], a[124:127], v[32:35], v[176:179]
v_exp_f32 v112, v112
M v[176:179], a[128:131], v[64:67], v[176:179]
ds_read_b128 a[156:159], v5 offset:37888
ds_read_b128 a[160:163], v5 offset:46080
M v[180:183], a[128:131], v[68:71], v[180:183]
v_exp_f32 v113, v113
M v[180:183], a[124:127], v[36:39], v[180:183]
v_cvt_pk_bf16_f32 v98, v112, v113
M v[184:187], a[124:127], v[40:43], v[184:187]
v_exp_f32 v114, v114
M v[184:187], a[128:131], v[72:75], v[184:187]
s_cselect_b32 s26, s63, s26
s_cselect_b32 s62, -1, s62
M v[188:191], a[128:131], v[76:79], v[188:191]
v_exp_f32 v115, v115
M v[188:191], a[124:127], v[44:47], v[188:191]
v_cvt_pk_bf16_f32 v99, v114, v115
s_waitcnt lgkmcnt(6)
M a[100:103], a[112:115], v[36:39], a[100:103]
M a[100:103], a[112:115], v[68:71], a[100:103]
M v[192:195], a[132:135], v[32:35], v[192:195]
v_exp_f32 v100, v100
M v[192:195], a[136:139], v[64:67], v[192:195]
ds_read_b128 a[164:167], v5 offset:38912
ds_read_b128 a[168:171], v5 offset:47104
M v[196:199], a[136:139], v[68:71], v[196:199]
v_exp_f32 v101, v101
M v[196:199], a[132:135], v[36:39], v[196:199]
v_cvt_pk_bf16_f32 v100, v100, v101
M v[200:203], a[132:135], v[40:43], v[200:203]
v_exp_f32 v102, v102
M v[200:203], a[136:139], v[72:75], v[200:203]
M v[204:207], a[136:139], v[76:79], v[204:207]
v_exp_f32 v103, v103
M v[204:207], a[132:135], v[44:47], v[204:207]
v_cvt_pk_bf16_f32 v101, v102, v103
s_waitcnt lgkmcnt(6)
M a[104:107], a[112:115], v[40:43], a[104:107]
M a[104:107], a[112:115], v[72:75], a[104:107]
M v[208:211], a[140:143], v[32:35], v[208:211]
v_exp_f32 v116, v116
M v[208:211], a[144:147], v[64:67], v[208:211]
ds_read_b128 a[172:175], v5 offset:39936
ds_read_b128 a[176:179], v5 offset:48128
M v[212:215], a[144:147], v[68:71], v[212:215]
v_exp_f32 v117, v117
M v[212:215], a[140:143], v[36:39], v[212:215]
v_cvt_pk_bf16_f32 v102, v116, v117
M v[216:219], a[140:143], v[40:43], v[216:219]
v_exp_f32 v118, v118
M v[216:219], a[144:147], v[72:75], v[216:219]
M v[220:223], a[144:147], v[76:79], v[220:223]
v_exp_f32 v119, v119
M v[220:223], a[140:143], v[44:47], v[220:223]
v_cvt_pk_bf16_f32 v103, v118, v119
s_waitcnt lgkmcnt(6)
M a[108:111], a[112:115], v[44:47], a[108:111]
M a[108:111], a[112:115], v[76:79], a[108:111]
M v[224:227], a[148:151], v[32:35], v[224:227]
v_exp_f32 v104, v104
M v[224:227], a[152:155], v[64:67], v[224:227]
M v[228:231], a[152:155], v[68:71], v[228:231]
v_exp_f32 v105, v105
M v[228:231], a[148:151], v[36:39], v[228:231]
v_cvt_pk_bf16_f32 v104, v104, v105
M v[232:235], a[148:151], v[40:43], v[232:235]
v_exp_f32 v106, v106
M v[232:235], a[152:155], v[72:75], v[232:235]
M v[236:239], a[152:155], v[76:79], v[236:239]
v_exp_f32 v107, v107
M v[236:239], a[148:151], v[44:47], v[236:239]
v_cvt_pk_bf16_f32 v105, v106, v107
s_waitcnt lgkmcnt(4)
M v[240:243], a[156:159], v[32:35], v[240:243]
v_exp_f32 v120, v120
M v[240:243], a[160:163], v[64:67], v[240:243]
M v[244:247], a[160:163], v[68:71], v[244:247]
v_exp_f32 v121, v121
M v[244:247], a[156:159], v[36:39], v[244:247]
v_cvt_pk_bf16_f32 v106, v120, v121
M v[248:251], a[156:159], v[40:43], v[248:251]
v_exp_f32 v122, v122
M v[248:251], a[160:163], v[72:75], v[248:251]
s_waitcnt vmcnt(0) lgkmcnt(0)
s_barrier
ds_read_b128 a[116:119], v3 offset:0
ds_read_b128 a[120:123], v3 offset:1024
M v[252:255], a[160:163], v[76:79], v[252:255]
v_exp_f32 v123, v123
M v[252:255], a[156:159], v[44:47], v[252:255]
v_cvt_pk_bf16_f32 v107, v122, v123
M a[64:67], a[164:167], v[32:35], a[64:67]
v_exp_f32 v108, v108
M a[64:67], a[168:171], v[64:67], a[64:67]
ds_read_b128 a[124:127], v3 offset:2048
ds_read_b128 a[128:131], v3 offset:3072
M a[68:71], a[168:171], v[68:71], a[68:71]
v_exp_f32 v109, v109
M a[68:71], a[164:167], v[36:39], a[68:71]
v_cvt_pk_bf16_f32 v108, v108, v109
M a[72:75], a[164:167], v[40:43], a[72:75]
v_exp_f32 v110, v110
M a[72:75], a[168:171], v[72:75], a[72:75]
ds_read_b128 a[132:135], v3 offset:4096
ds_read_b128 a[136:139], v3 offset:5120
M a[76:79], a[168:171], v[76:79], a[76:79]
v_exp_f32 v111, v111
M a[76:79], a[164:167], v[44:47], a[76:79]
v_cvt_pk_bf16_f32 v109, v110, v111
M a[80:83], a[172:175], v[32:35], a[80:83]
v_exp_f32 v124, v124
M a[80:83], a[176:179], v[64:67], a[80:83]
ds_read_b128 a[140:143], v3 offset:6144
ds_read_b128 a[144:147], v3 offset:7168
M a[84:87], a[176:179], v[68:71], a[84:87]
v_exp_f32 v125, v125
M a[84:87], a[172:175], v[36:39], a[84:87]
v_cvt_pk_bf16_f32 v110, v124, v125
M a[88:91], a[172:175], v[40:43], a[88:91]
v_exp_f32 v126, v126
M a[88:91], a[176:179], v[72:75], a[88:91]
M a[92:95], a[176:179], v[76:79], a[92:95]
v_exp_f32 v127, v127
M a[92:95], a[172:175], v[44:47], a[92:95]
v_cvt_pk_bf16_f32 v111, v126, v127
s_sub_u32 s30, s30, 1
s_cmp_eq_u32 s30, 0
s_cbranch_scc1 Lk2_m1
s_add_u32 m0, s29, 0
s_waitcnt lgkmcnt(4)
M v[32:35], a[116:119], a[0:3], 0
v_exp_f32 v128, v128
M v[32:35], a[120:123], a[4:7], v[32:35]
ds_read_b128 a[148:151], v3 offset:8192
ds_read_b128 a[152:155], v3 offset:9216
M v[32:35], a[124:127], a[8:11], v[32:35]
v_exp_f32 v129, v129
M v[32:35], a[128:131], a[12:15], v[32:35]
buffer_load_dwordx4 v1, s[12:15], s25 offen offset:0 sc1 lds
s_add_u32 s32, s25, 4096
M v[36:39], a[128:131], a[28:31], 0
v_exp_f32 v130, v130
M v[36:39], a[124:127], a[24:27], v[36:39]
v_cvt_pk_bf16_f32 v128, v128, v129
M v[36:39], a[120:123], a[20:23], v[36:39]
v_exp_f32 v131, v131
M v[36:39], a[116:119], a[16:19], v[36:39]
buffer_load_dwordx4 v1, s[12:15], s25 offen offset:1024 sc1 lds
M v[40:43], a[116:119], a[32:35], 0
v_exp_f32 v144, v144
M v[40:43], a[120:123], a[36:39], v[40:43]
ds_read_b128 a[156:159], v3 offset:10240
ds_read_b128 a[160:163], v3 offset:11264
M v[40:43], a[124:127], a[40:43], v[40:43]
v_exp_f32 v145, v145
M v[40:43], a[128:131], a[44:47], v[40:43]
buffer_load_dwordx4 v1, s[12:15], s25 offen offset:2048 sc1 lds
M v[44:47], a[128:131], a[60:63], 0
v_exp_f32 v146, v146
M v[44:47], a[124:127], a[56:59], v[44:47]
v_cvt_pk_bf16_f32 v129, v130, v131
v_cvt_pk_bf16_f32 v130, v144, v145
M v[44:47], a[120:123], a[52:55], v[44:47]
v_exp_f32 v147, v147
M v[44:47], a[116:119], a[48:51], v[44:47]
buffer_load_dwordx4 v1, s[12:15], s25 offen offset:3072 sc1 lds
s_add_u32 m0, s29, 4096
s_waitcnt lgkmcnt(4)
M v[48:51], a[132:135], a[0:3], 0
v_exp_f32 v132, v132
M v[48:51], a[136:139], a[4:7], v[48:51]
ds_read_b128 a[164:167], v3 offset:12288
ds_read_b128 a[168:171], v3 offset:13312
M v[48:51], a[140:143], a[8:11], v[48:51]
v_exp_f32 v133, v133
M v[48:51], a[144:147], a[12:15], v[48:51]
buffer_load_dwordx4 v1, s[12:15], s32 offen offset:0 sc1 lds
M v[52:55], a[144:147], a[28:31], 0
v_exp_f32 v134, v134
M v[52:55], a[140:143], a[24:27], v[52:55]
v_cvt_pk_bf16_f32 v131, v146, v147
v_cvt_pk_bf16_f32 v132, v132, v133
M v[52:55], a[136:139], a[20:23], v[52:55]
v_exp_f32 v135, v135
M v[52:55], a[132:135], a[16:19], v[52:55]
buffer_load_dwordx4 v1, s[12:15], s32 offen offset:1024 sc1 lds
M v[56:59], a[132:135], a[32:35], 0
v_exp_f32 v148, v148
M v[56:59], a[136:139], a[36:39], v[56:59]
ds_read_b128 a[172:175], v3 offset:14336
ds_read_b128 a[176:179], v3 offset:15360
M v[56:59], a[140:143], a[40:43], v[56:59]
v_exp_f32 v149, v149
M v[56:59], a[144:147], a[44:47], v[56:59]
buffer_load_dwordx4 v1, s[12:15], s32 offen offset:2048 sc1 lds
M v[60:63], a[144:147], a[60:63], 0
v_exp_f32 v150, v150
M v[60:63], a[140:143], a[56:59], v[60:63]
v_cvt_pk_bf16_f32 v133, v134, v135
v_cvt_pk_bf16_f32 v134, v148, v149
M v[60:63], a[136:139], a[52:55], v[60:63]
v_exp_f32 v151, v151
M v[60:63], a[132:135], a[48:51], v[60:63]
buffer_load_dwordx4 v1, s[12:15], s32 offen offset:3072 sc1 lds
s_add_u32 m0, s29, 32768
s_waitcnt lgkmcnt(4)
M v[64:67], a[148:151], a[0:3], 0
v_exp_f32 v136, v136
M v[64:67], a[152:155], a[4:7], v[64:67]
ds_read_b128 a[116:119], v6 offset:32768
ds_read_b128 a[120:123], v6 offset:40960
M v[64:67], a[156:159], a[8:11], v[64:67]
v_exp_f32 v137, v137
M v[64:67], a[160:163], a[12:15], v[64:67]
buffer_load_dwordx4 v1, s[12:15], s26 offen offset:0 sc1 lds
s_add_u32 s43, s26, 4096
M v[68:71], a[160:163], a[28:31], 0
v_exp_f32 v138, v138
M v[68:71], a[156:159], a[24:27], v[68:71]
v_cvt_pk_bf16_f32 v135, v150, v151
v_cvt_pk_bf16_f32 v136, v136, v137
M v[68:71], a[152:155], a[20:23], v[68:71]
v_exp_f32 v139, v139
M v[68:71], a[148:151], a[16:19], v[68:71]
buffer_load_dwordx4 v1, s[12:15], s26 offen offset:1024 sc1 lds
M v[72:75], a[148:151], a[32:35], 0
v_exp_f32 v152, v152
M v[72:75], a[152:155], a[36:39], v[72:75]
ds_read_b128 a[124:127], v6 offset:33792
ds_read_b128 a[128:131], v6 offset:41984
M v[72:75], a[156:159], a[40:43], v[72:75]
v_exp_f32 v153, v153
M v[72:75], a[160:163], a[44:47], v[72:75]
buffer_load_dwordx4 v1, s[12:15], s26 offen offset:2048 sc1 lds
M v[76:79], a[160:163], a[60:63], 0
v_exp_f32 v154, v154
M v[76:79], a[156:159], a[56:59], v[76:79]
v_cvt_pk_bf16_f32 v137, v138, v139
v_cvt_pk_bf16_f32 v138, v152, v153
M v[76:79], a[152:155], a[52:55], v[76:79]
v_exp_f32 v155, v155
M v[76:79], a[148:151], a[48:51], v[76:79]
buffer_load_dwordx4 v1, s[12:15], s26 offen offset:3072 sc1 lds
s_add_u32 m0, s29, 36864
s_waitcnt lgkmcnt(4)
M v[80:83], a[164:167], a[0:3], 0
v_exp_f32 v140, v140
M v[80:83], a[168:171], a[4:7], v[80:83]
ds_read_b128 a[132:135], v6 offset:34816
ds_read_b128 a[136:139], v6 offset:43008
M v[80:83], a[172:175], a[8:11], v[80:83]
v_exp_f32 v141, v141
M v[80:83], a[176:179], a[12:15], v[80:83]
buffer_load_dwordx4 v1, s[12:15], s43 offen offset:0 sc1 lds
M v[84:87], a[176:179], a[28:31], 0
v_exp_f32 v142, v142
M v[84:87], a[172:175], a[24:27], v[84:87]
v_cvt_pk_bf16_f32 v139, v154, v155
v_cvt_pk_bf16_f32 v140, v140, v141
M v[84:87], a[168:171], a[20:23], v[84:87]
v_exp_f32 v143, v143
M v[84:87], a[164:167], a[16:19], v[84:87]
buffer_load_dwordx4 v1, s[12:15], s43 offen offset:1024 sc1 lds
M v[88:91], a[164:167], a[32:35], 0
v_exp_f32 v156, v156
M v[88:91], a[168:171], a[36:39], v[88:91]
ds_read_b128 a[140:143], v6 offset:35840
ds_read_b128 a[144:147], v6 offset:44032
M v[88:91], a[172:175], a[40:43], v[88:91]
v_exp_f32 v157, v157
M v[88:91], a[176:179], a[44:47], v[88:91]
buffer_load_dwordx4 v1, s[12:15], s43 offen offset:2048 sc1 lds
M v[92:95], a[176:179], a[60:63], 0
v_exp_f32 v158, v158
M v[92:95], a[172:175], a[56:59], v[92:95]
v_cvt_pk_bf16_f32 v141, v142, v143
v_cvt_pk_bf16_f32 v142, v156, v157
M v[92:95], a[168:171], a[52:55], v[92:95]
v_exp_f32 v159, v159
M v[92:95], a[164:167], a[48:51], v[92:95]
buffer_load_dwordx4 v1, s[12:15], s43 offen offset:3072 sc1 lds
v_cvt_pk_bf16_f32 v143, v158, v159
s_waitcnt lgkmcnt(6)
M v[160:163], a[116:119], v[96:99], v[160:163]
v_exp_f32 v32, v32
M v[160:163], a[120:123], v[128:131], v[160:163]
ds_read_b128 a[148:151], v6 offset:36864
ds_read_b128 a[152:155], v6 offset:45056
M v[164:167], a[120:123], v[132:135], v[164:167]
v_exp_f32 v33, v33
M v[164:167], a[116:119], v[100:103], v[164:167]
v_cvt_pk_bf16_f32 v32, v32, v33
M v[168:171], a[116:119], v[104:107], v[168:171]
v_exp_f32 v34, v34
M v[168:171], a[120:123], v[136:139], v[168:171]
s_add_u32 s25, s25, 32768
s_cmp_eq_u32 s25, s27
M v[172:175], a[120:123], v[140:143], v[172:175]
v_exp_f32 v35, v35
M v[172:175], a[116:119], v[108:111], v[172:175]
v_cvt_pk_bf16_f32 v33, v34, v35
s_waitcnt lgkmcnt(6)
M a[96:99], a[112:115], v[96:99], a[96:99]
s_cselect_b32 s25, s28, s25
s_cselect_b32 s27, -1, s27
M a[96:99], a[112:115], v[128:131], a[96:99]
s_add_u32 s26, s26, 32768
s_cmp_eq_u32 s26, s62
M v[176:179], a[124:127], v[96:99], v[176:179]
v_exp_f32 v48, v48
M v[176:179], a[128:131], v[128:131], v[176:179]
ds_read_b128 a[156:159], v6 offset:37888
ds_read_b128 a[160:163], v6 offset:46080
M v[180:183], a[128:131], v[132:135], v[180:183]
v_exp_f32 v49, v49
M v[180:183], a[124:127], v[100:103], v[180:183]
v_cvt_pk_bf16_f32 v34, v48, v49
M v[184:187], a[124:127], v[104:107], v[184:187]
v_exp_f32 v50, v50
M v[184:187], a[128:131], v[136:139], v[184:187]
s_cselect_b32 s26, s63, s26
s_cselect_b32 s62, -1, s62
M v[188:191], a[128:131], v[140:143], v[188:191]
v_exp_f32 v51, v51
M v[188:191], a[124:127], v[108:111], v[188:191]
v_cvt_pk_bf16_f32 v35, v50, v51
s_waitcnt lgkmcnt(6)
M a[100:103], a[112:115], v[100:103], a[100:103]
M a[100:103], a[112:115], v[132:135], a[100:103]
M v[192:195], a[132:135], v[96:99], v[192:195]
v_exp_f32 v36, v36
M v[192:195], a[136:139], v[128:131], v[192:195]
ds_read_b128 a[164:167], v6 offset:38912
ds_read_b128 a[168:171], v6 offset:47104
M v[196:199], a[136:139], v[132:135], v[196:199]
v_exp_f32 v37, v37
M v[196:199], a[132:135], v[100:103], v[196:199]
v_cvt_pk_bf16_f32 v36, v36, v37
M v[200:203], a[132:135], v[104:107], v[200:203]
v_exp_f32 v38, v38
M v[200:203], a[136:139], v[136:139], v[200:203]
M v[204:207], a[136:139], v[140:143], v[204:207]
v_exp_f32 v39, v39
M v[204:207], a[132:135], v[108:111], v[204:207]
v_cvt_pk_bf16_f32 v37, v38, v39
s_waitcnt lgkmcnt(6)
M a[104:107], a[112:115], v[104:107], a[104:107]
M a[104:107], a[112:115], v[136:139], a[104:107]
M v[208:211], a[140:143], v[96:99], v[208:211]
v_exp_f32 v52, v52
M v[208:211], a[144:147], v[128:131], v[208:211]
ds_read_b128 a[172:175], v6 offset:39936
ds_read_b128 a[176:179], v6 offset:48128
M v[212:215], a[144:147], v[132:135], v[212:215]
v_exp_f32 v53, v53
M v[212:215], a[140:143], v[100:103], v[212:215]
v_cvt_pk_bf16_f32 v38, v52, v53
M v[216:219], a[140:143], v[104:107], v[216:219]
v_exp_f32 v54, v54
M v[216:219], a[144:147], v[136:139], v[216:219]
M v[220:223], a[144:147], v[140:143], v[220:223]
v_exp_f32 v55, v55
M v[220:223], a[140:143], v[108:111], v[220:223]
v_cvt_pk_bf16_f32 v39, v54, v55
s_waitcnt lgkmcnt(6)
M a[108:111], a[112:115], v[108:111], a[108:111]
M a[108:111], a[112:115], v[140:143], a[108:111]
M v[224:227], a[148:151], v[96:99], v[224:227]
v_exp_f32 v40, v40
M v[224:227], a[152:155], v[128:131], v[224:227]
M v[228:231], a[152:155], v[132:135], v[228:231]
v_exp_f32 v41, v41
M v[228:231], a[148:151], v[100:103], v[228:231]
v_cvt_pk_bf16_f32 v40, v40, v41
M v[232:235], a[148:151], v[104:107], v[232:235]
v_exp_f32 v42, v42
M v[232:235], a[152:155], v[136:139], v[232:235]
M v[236:239], a[152:155], v[140:143], v[236:239]
v_exp_f32 v43, v43
M v[236:239], a[148:151], v[108:111], v[236:239]
v_cvt_pk_bf16_f32 v41, v42, v43
s_waitcnt lgkmcnt(4)
M v[240:243], a[156:159], v[96:99], v[240:243]
v_exp_f32 v56, v56
M v[240:243], a[160:163], v[128:131], v[240:243]
M v[244:247], a[160:163], v[132:135], v[244:247]
v_exp_f32 v57, v57
M v[244:247], a[156:159], v[100:103], v[244:247]
v_cvt_pk_bf16_f32 v42, v56, v57
M v[248:251], a[156:159], v[104:107], v[248:251]
v_exp_f32 v58, v58
M v[248:251], a[160:163], v[136:139], v[248:251]
s_waitcnt vmcnt(0) lgkmcnt(0)
s_barrier
ds_read_b128 a[116:119], v2 offset:0
ds_read_b128 a[120:123], v2 offset:1024
M v[252:255], a[160:163], v[140:143], v[252:255]
v_exp_f32 v59, v59
M v[252:255], a[156:159], v[108:111], v[252:255]
v_cvt_pk_bf16_f32 v43, v58, v59
M a[64:67], a[164:167], v[96:99], a[64:67]
v_exp_f32 v44, v44
M a[64:67], a[168:171], v[128:131], a[64:67]
ds_read_b128 a[124:127], v2 offset:2048
ds_read_b128 a[128:131], v2 offset:3072
M a[68:71], a[168:171], v[132:135], a[68:71]
v_exp_f32 v45, v45
M a[68:71], a[164:167], v[100:103], a[68:71]
v_cvt_pk_bf16_f32 v44, v44, v45
M a[72:75], a[164:167], v[104:107], a[72:75]
v_exp_f32 v46, v46
M a[72:75], a[168:171], v[136:139], a[72:75]
ds_read_b128 a[132:135], v2 offset:4096
ds_read_b128 a[136:139], v2 offset:5120
M a[76:79], a[168:171], v[140:143], a[76:79]
v_exp_f32 v47, v47
M a[76:79], a[164:167], v[108:111], a[76:79]
v_cvt_pk_bf16_f32 v45, v46, v47
M a[80:83], a[172:175], v[96:99], a[80:83]
v_exp_f32 v60, v60
M a[80:83], a[176:179], v[128:131], a[80:83]
ds_read_b128 a[140:143], v2 offset:6144
ds_read_b128 a[144:147], v2 offset:7168
M a[84:87], a[176:179], v[132:135], a[84:87]
v_exp_f32 v61, v61
M a[84:87], a[172:175], v[100:103], a[84:87]
v_cvt_pk_bf16_f32 v46, v60, v61
M a[88:91], a[172:175], v[104:107], a[88:91]
v_exp_f32 v62, v62
M a[88:91], a[176:179], v[136:139], a[88:91]
M a[92:95], a[176:179], v[140:143], a[92:95]
v_exp_f32 v63, v63
M a[92:95], a[172:175], v[108:111], a[92:95]
v_cvt_pk_bf16_f32 v47, v62, v63
s_branch Lk2_l1
Lk2_m1:
s_cmp_eq_u32 s23, 1
s_cbranch_scc1 Lk2_m1b
s_add_u32 m0, s29, 0
s_waitcnt lgkmcnt(4)
M v[32:35], a[116:119], a[0:3], v[16:19]
v_exp_f32 v128, v128
M v[32:35], a[120:123], a[4:7], v[32:35]
ds_read_b128 a[148:151], v3 offset:8192
ds_read_b128 a[152:155], v3 offset:9216
M v[32:35], a[124:127], a[8:11], v[32:35]
v_exp_f32 v129, v129
M v[32:35], a[128:131], a[12:15], v[32:35]
buffer_load_dwordx4 v1, s[12:15], s25 offen offset:0 sc1 lds
s_add_u32 s32, s25, 4096
M v[36:39], a[128:131], a[28:31], 0
v_exp_f32 v130, v130
M v[36:39], a[124:127], a[24:27], v[36:39]
v_cvt_pk_bf16_f32 v128, v128, v129
M v[36:39], a[120:123], a[20:23], v[36:39]
v_exp_f32 v131, v131
M v[36:39], a[116:119], a[16:19], v[36:39]
buffer_load_dwordx4 v1, s[12:15], s25 offen offset:1024 sc1 lds
M v[40:43], a[116:119], a[32:35], 0
v_exp_f32 v144, v144
M v[40:43], a[120:123], a[36:39], v[40:43]
ds_read_b128 a[156:159], v3 offset:10240
ds_read_b128 a[160:163], v3 offset:11264
M v[40:43], a[124:127], a[40:43], v[40:43]
v_exp_f32 v145, v145
M v[40:43], a[128:131], a[44:47], v[40:43]
buffer_load_dwordx4 v1, s[12:15], s25 offen offset:2048 sc1 lds
M v[44:47], a[128:131], a[60:63], 0
v_exp_f32 v146, v146
M v[44:47], a[124:127], a[56:59], v[44:47]
v_cvt_pk_bf16_f32 v129, v130, v131
v_cvt_pk_bf16_f32 v130, v144, v145
M v[44:47], a[120:123], a[52:55], v[44:47]
v_exp_f32 v147, v147
M v[44:47], a[116:119], a[48:51], v[44:47]
buffer_load_dwordx4 v1, s[12:15], s25 offen offset:3072 sc1 lds
s_add_u32 m0, s29, 4096
s_waitcnt lgkmcnt(4)
v_exp_f32 v132, v132
ds_read_b128 a[164:167], v3 offset:12288
ds_read_b128 a[168:171], v3 offset:13312
v_exp_f32 v133, v133
buffer_load_dwordx4 v1, s[12:15], s32 offen offset:0 sc1 lds
M v[52:55], a[144:147], a[28:31], v[16:19]
v_exp_f32 v134, v134
M v[52:55], a[140:143], a[24:27], v[52:55]
v_cvt_pk_bf16_f32 v131, v146, v147
v_cvt_pk_bf16_f32 v132, v132, v133
M v[52:55], a[136:139], a[20:23], v[52:55]
v_exp_f32 v135, v135
M v[52:55], a[132:135], a[16:19], v[52:55]
buffer_load_dwordx4 v1, s[12:15], s32 offen offset:1024 sc1 lds
M v[56:59], a[132:135], a[32:35], 0
v_exp_f32 v148, v148
M v[56:59], a[136:139], a[36:39], v[56:59]
ds_read_b128 a[172:175], v3 offset:14336
ds_read_b128 a[176:179], v3 offset:15360
M v[56:59], a[140:143], a[40:43], v[56:59]
v_exp_f32 v149, v149
M v[56:59], a[144:147], a[44:47], v[56:59]
buffer_load_dwordx4 v1, s[12:15], s32 offen offset:2048 sc1 lds
M v[60:63], a[144:147], a[60:63], 0
v_exp_f32 v150, v150
M v[60:63], a[140:143], a[56:59], v[60:63]
v_cvt_pk_bf16_f32 v133, v134, v135
v_cvt_pk_bf16_f32 v134, v148, v149
M v[60:63], a[136:139], a[52:55], v[60:63]
v_exp_f32 v151, v151
M v[60:63], a[132:135], a[48:51], v[60:63]
buffer_load_dwordx4 v1, s[12:15], s32 offen offset:3072 sc1 lds
s_add_u32 m0, s29, 32768
s_waitcnt lgkmcnt(4)
v_exp_f32 v136, v136
ds_read_b128 a[116:119], v6 offset:32768
ds_read_b128 a[120:123], v6 offset:40960
v_exp_f32 v137, v137
buffer_load_dwordx4 v1, s[12:15], s26 offen offset:0 sc1 lds
s_add_u32 s43, s26, 4096
v_exp_f32 v138, v138
v_cvt_pk_bf16_f32 v135, v150, v151
v_cvt_pk_bf16_f32 v136, v136, v137
v_exp_f32 v139, v139
buffer_load_dwordx4 v1, s[12:15], s26 offen offset:1024 sc1 lds
M v[72:75], a[148:151], a[32:35], v[16:19]
v_exp_f32 v152, v152
M v[72:75], a[152:155], a[36:39], v[72:75]
ds_read_b128 a[124:127], v6 offset:33792
ds_read_b128 a[128:131], v6 offset:41984
M v[72:75], a[156:159], a[40:43], v[72:75]
v_exp_f32 v153, v153
M v[72:75], a[160:163], a[44:47], v[72:75]
buffer_load_dwordx4 v1, s[12:15], s26 offen offset:2048 sc1 lds
M v[76:79], a[160:163], a[60:63], 0
v_exp_f32 v154, v154
M v[76:79], a[156:159], a[56:59], v[76:79]
v_cvt_pk_bf16_f32 v137, v138, v139
v_cvt_pk_bf16_f32 v138, v152, v153
M v[76:79], a[152:155], a[52:55], v[76:79]
v_exp_f32 v155, v155
M v[76:79], a[148:151], a[48:51], v[76:79]
buffer_load_dwordx4 v1, s[12:15], s26 offen offset:3072 sc1 lds
s_add_u32 m0, s29, 36864
s_waitcnt lgkmcnt(4)
v_exp_f32 v140, v140
ds_read_b128 a[132:135], v6 offset:34816
ds_read_b128 a[136:139], v6 offset:43008
v_exp_f32 v141, v141
buffer_load_dwordx4 v1, s[12:15], s43 offen offset:0 sc1 lds
v_exp_f32 v142, v142
v_cvt_pk_bf16_f32 v139, v154, v155
v_cvt_pk_bf16_f32 v140, v140, v141
v_exp_f32 v143, v143
buffer_load_dwordx4 v1, s[12:15], s43 offen offset:1024 sc1 lds
v_exp_f32 v156, v156
ds_read_b128 a[140:143], v6 offset:35840
ds_read_b128 a[144:147], v6 offset:44032
v_exp_f32 v157, v157
buffer_load_dwordx4 v1, s[12:15], s43 offen offset:2048 sc1 lds
M v[92:95], a[176:179], a[60:63], v[16:19]
v_exp_f32 v158, v158
M v[92:95], a[172:175], a[56:59], v[92:95]
v_cvt_pk_bf16_f32 v141, v142, v143
v_cvt_pk_bf16_f32 v142, v156, v157
M v[92:95], a[168:171], a[52:55], v[92:95]
v_exp_f32 v159, v159
M v[92:95], a[164:167], a[48:51], v[92:95]
buffer_load_dwordx4 v1, s[12:15], s43 offen offset:3072 sc1 lds
v_cvt_pk_bf16_f32 v143, v158, v159
s_waitcnt lgkmcnt(6)
M v[160:163], a[116:119], v[96:99], v[160:163]
v_exp_f32 v32, v32
M v[160:163], a[120:123], v[128:131], v[160:163]
ds_read_b128 a[148:151], v6 offset:36864
ds_read_b128 a[152:155], v6 offset:45056
M v[164:167], a[120:123], v[132:135], v[164:167]
v_exp_f32 v33, v33
M v[164:167], a[116:119], v[100:103], v[164:167]
v_cvt_pk_bf16_f32 v32, v32, v33
M v[168:171], a[116:119], v[104:107], v[168:171]
v_exp_f32 v34, v34
M v[168:171], a[120:123], v[136:139], v[168:171]
s_add_u32 s25, s25, 32768
s_cmp_eq_u32 s25, s27
M v[172:175], a[120:123], v[140:143], v[172:175]
v_exp_f32 v35, v35
M v[172:175], a[116:119], v[108:111], v[172:175]
v_cvt_pk_bf16_f32 v33, v34, v35
s_waitcnt lgkmcnt(6)
M a[96:99], a[112:115], v[96:99], a[96:99]
s_cselect_b32 s25, s28, s25
s_cselect_b32 s27, -1, s27
M a[96:99], a[112:115], v[128:131], a[96:99]
s_add_u32 s26, s26, 32768
s_cmp_eq_u32 s26, s62
M v[176:179], a[124:127], v[96:99], v[176:179]
M v[176:179], a[128:131], v[128:131], v[176:179]
ds_read_b128 a[156:159], v6 offset:37888
ds_read_b128 a[160:163], v6 offset:46080
M v[180:183], a[128:131], v[132:135], v[180:183]
M v[180:183], a[124:127], v[100:103], v[180:183]
v_mov_b32 v34, 0
M v[184:187], a[124:127], v[104:107], v[184:187]
M v[184:187], a[128:131], v[136:139], v[184:187]
s_cselect_b32 s26, s63, s26
s_cselect_b32 s62, -1, s62
M v[188:191], a[128:131], v[140:143], v[188:191]
M v[188:191], a[124:127], v[108:111], v[188:191]
v_mov_b32 v35, 0
s_waitcnt lgkmcnt(6)
M a[100:103], a[112:115], v[100:103], a[100:103]
M a[100:103], a[112:115], v[132:135], a[100:103]
M v[192:195], a[132:135], v[96:99], v[192:195]
v_exp_f32 v36, v36
M v[192:195], a[136:139], v[128:131], v[192:195]
ds_read_b128 a[164:167], v6 offset:38912
ds_read_b128 a[168:171], v6 offset:47104
M v[196:199], a[136:139], v[132:135], v[196:199]
v_exp_f32 v37, v37
M v[196:199], a[132:135], v[100:103], v[196:199]
v_cvt_pk_bf16_f32 v36, v36, v37
M v[200:203], a[132:135], v[104:107], v[200:203]
v_exp_f32 v38, v38
M v[200:203], a[136:139], v[136:139], v[200:203]
M v[204:207], a[136:139], v[140:143], v[204:207]
v_exp_f32 v39, v39
M v[204:207], a[132:135], v[108:111], v[204:207]
v_cvt_pk_bf16_f32 v37, v38, v39
s_waitcnt lgkmcnt(6)
M a[104:107], a[112:115], v[104:107], a[104:107]
M a[104:107], a[112:115], v[136:139], a[104:107]
M v[208:211], a[140:143], v[96:99], v[208:211]
v_exp_f32 v52, v52
M v[208:211], a[144:147], v[128:131], v[208:211]
ds_read_b128 a[172:175], v6 offset:39936
ds_read_b128 a[176:179], v6 offset:48128
M v[212:215], a[144:147], v[132:135], v[212:215]
v_exp_f32 v53, v53
M v[212:215], a[140:143], v[100:103], v[212:215]
v_cvt_pk_bf16_f32 v38, v52, v53
M v[216:219], a[140:143], v[104:107], v[216:219]
v_exp_f32 v54, v54
M v[216:219], a[144:147], v[136:139], v[216:219]
M v[220:223], a[144:147], v[140:143], v[220:223]
v_exp_f32 v55, v55
M v[220:223], a[140:143], v[108:111], v[220:223]
v_cvt_pk_bf16_f32 v39, v54, v55
s_waitcnt lgkmcnt(6)
M a[108:111], a[112:115], v[108:111], a[108:111]
M a[108:111], a[112:115], v[140:143], a[108:111]
M v[224:227], a[148:151], v[96:99], v[224:227]
v_exp_f32 v40, v40
M v[224:227], a[152:155], v[128:131], v[224:227]
M v[228:231], a[152:155], v[132:135], v[228:231]
v_exp_f32 v41, v41
M v[228:231], a[148:151], v[100:103], v[228:231]
v_cvt_pk_bf16_f32 v40, v40, v41
M v[232:235], a[148:151], v[104:107], v[232:235]
v_exp_f32 v42, v42
M v[232:235], a[152:155], v[136:139], v[232:235]
M v[236:239], a[152:155], v[140:143], v[236:239]
v_exp_f32 v43, v43
M v[236:239], a[148:151], v[108:111], v[236:239]
v_cvt_pk_bf16_f32 v41, v42, v43
s_waitcnt lgkmcnt(4)
M v[240:243], a[156:159], v[96:99], v[240:243]
v_exp_f32 v56, v56
M v[240:243], a[160:163], v[128:131], v[240:243]
M v[244:247], a[160:163], v[132:135], v[244:247]
v_exp_f32 v57, v57
M v[244:247], a[156:159], v[100:103], v[244:247]
v_cvt_pk_bf16_f32 v42, v56, v57
M v[248:251], a[156:159], v[104:107], v[248:251]
v_exp_f32 v58, v58
M v[248:251], a[160:163], v[136:139], v[248:251]
s_waitcnt vmcnt(0) lgkmcnt(0)
s_barrier
ds_read_b128 a[116:119], v2 offset:0
ds_read_b128 a[120:123], v2 offset:1024
M v[252:255], a[160:163], v[140:143], v[252:255]
v_exp_f32 v59, v59
M v[252:255], a[156:159], v[108:111], v[252:255]
v_cvt_pk_bf16_f32 v43, v58, v59
M a[64:67], a[164:167], v[96:99], a[64:67]
v_exp_f32 v44, v44
M a[64:67], a[168:171], v[128:131], a[64:67]
ds_read_b128 a[124:127], v2 offset:2048
ds_read_b128 a[128:131], v2 offset:3072
M a[68:71], a[168:171], v[132:135], a[68:71]
v_exp_f32 v45, v45
M a[68:71], a[164:167], v[100:103], a[68:71]
v_cvt_pk_bf16_f32 v44, v44, v45
M a[72:75], a[164:167], v[104:107], a[72:75]
v_exp_f32 v46, v46
M a[72:75], a[168:171], v[136:139], a[72:75]
ds_read_b128 a[132:135], v2 offset:4096
ds_read_b128 a[136:139], v2 offset:5120
M a[76:79], a[168:171], v[140:143], a[76:79]
v_exp_f32 v47, v47
M a[76:79], a[164:167], v[108:111], a[76:79]
v_cvt_pk_bf16_f32 v45, v46, v47
M a[80:83], a[172:175], v[96:99], a[80:83]
v_exp_f32 v60, v60
M a[80:83], a[176:179], v[128:131], a[80:83]
ds_read_b128 a[140:143], v2 offset:6144
ds_read_b128 a[144:147], v2 offset:7168
M a[84:87], a[176:179], v[132:135], a[84:87]
v_exp_f32 v61, v61
M a[84:87], a[172:175], v[100:103], a[84:87]
v_cvt_pk_bf16_f32 v46, v60, v61
M a[88:91], a[172:175], v[104:107], a[88:91]
v_exp_f32 v62, v62
M a[88:91], a[176:179], v[136:139], a[88:91]
M a[92:95], a[176:179], v[140:143], a[92:95]
v_exp_f32 v63, v63
M a[92:95], a[172:175], v[108:111], a[92:95]
v_cvt_pk_bf16_f32 v47, v62, v63
Lk2_m2a:
s_sub_u32 s35, 15, s21
s_lshl_b32 s33, s20, 7
s_lshl_b32 s34, s35, 3
s_add_u32 s33, s33, s34
s_lshl_b32 s34, s23, 2
s_add_u32 s33, s33, s34
s_lshl_b32 s33, s33, 12
buffer_load_dwordx4 a[180:183], v1, s[8:11], s33 offen offset:0 sc1
buffer_load_dwordx4 a[184:187], v1, s[8:11], s33 offen offset:1024 sc1
buffer_load_dwordx4 a[188:191], v1, s[8:11], s33 offen offset:2048 sc1
buffer_load_dwordx4 a[192:195], v1, s[8:11], s33 offen offset:3072 sc1
s_add_u32 s33, s33, 4096
buffer_load_dwordx4 a[196:199], v1, s[8:11], s33 offen offset:0 sc1
buffer_load_dwordx4 a[200:203], v1, s[8:11], s33 offen offset:1024 sc1
buffer_load_dwordx4 a[204:207], v1, s[8:11], s33 offen offset:2048 sc1
buffer_load_dwordx4 a[208:211], v1, s[8:11], s33 offen offset:3072 sc1
s_add_u32 s33, s33, 4096
buffer_load_dwordx4 a[212:215], v1, s[8:11], s33 offen offset:0 sc1
buffer_load_dwordx4 a[216:219], v1, s[8:11], s33 offen offset:1024 sc1
buffer_load_dwordx4 a[220:223], v1, s[8:11], s33 offen offset:2048 sc1
buffer_load_dwordx4 a[224:227], v1, s[8:11], s33 offen offset:3072 sc1
s_add_u32 s33, s33, 4096
buffer_load_dwordx4 a[228:231], v1, s[8:11], s33 offen offset:0 sc1
buffer_load_dwordx4 a[232:235], v1, s[8:11], s33 offen offset:1024 sc1
buffer_load_dwordx4 a[236:239], v1, s[8:11], s33 offen offset:2048 sc1
buffer_load_dwordx4 a[240:243], v1, s[8:11], s33 offen offset:3072 sc1
s_add_u32 m0, s29, 65536
s_nop 0
buffer_load_dwordx4 v1, s[12:15], s25 offen offset:0 sc1 lds
s_add_u32 s32, s25, 4096
buffer_load_dwordx4 v1, s[12:15], s25 offen offset:1024 sc1 lds
buffer_load_dwordx4 v1, s[12:15], s25 offen offset:2048 sc1 lds
buffer_load_dwordx4 v1, s[12:15], s25 offen offset:3072 sc1 lds
s_add_u32 m0, s29, 69632
s_nop 0
buffer_load_dwordx4 v1, s[12:15], s32 offen offset:0 sc1 lds
buffer_load_dwordx4 v1, s[12:15], s32 offen offset:1024 sc1 lds
buffer_load_dwordx4 v1, s[12:15], s32 offen offset:2048 sc1 lds
buffer_load_dwordx4 v1, s[12:15], s32 offen offset:3072 sc1 lds
s_add_u32 m0, s29, 98304
v_exp_f32 v72, v72
s_waitcnt lgkmcnt(7)
ds_read_b128 a[116:119], v5 offset:32768
s_waitcnt lgkmcnt(7)
ds_read_b128 a[120:123], v5 offset:40960
v_exp_f32 v73, v73
buffer_load_dwordx4 v1, s[12:15], s26 offen offset:0 sc1 lds
s_add_u32 s43, s26, 4096
v_exp_f32 v74, v74
v_cvt_pk_bf16_f32 v72, v72, v73
v_exp_f32 v75, v75
buffer_load_dwordx4 v1, s[12:15], s26 offen offset:1024 sc1 lds
s_waitcnt lgkmcnt(7)
ds_read_b128 a[124:127], v5 offset:33792
s_waitcnt lgkmcnt(7)
ds_read_b128 a[128:131], v5 offset:41984
buffer_load_dwordx4 v1, s[12:15], s26 offen offset:2048 sc1 lds
v_cvt_pk_bf16_f32 v73, v74, v75
v_mov_b32 v74, 0
buffer_load_dwordx4 v1, s[12:15], s26 offen offset:3072 sc1 lds
s_add_u32 m0, s29, 102400
v_exp_f32 v76, v76
s_waitcnt lgkmcnt(7)
ds_read_b128 a[132:135], v5 offset:34816
s_waitcnt lgkmcnt(7)
ds_read_b128 a[136:139], v5 offset:43008
v_exp_f32 v77, v77
buffer_load_dwordx4 v1, s[12:15], s43 offen offset:0 sc1 lds
v_exp_f32 v78, v78
v_mov_b32 v75, 0
v_cvt_pk_bf16_f32 v76, v76, v77
v_exp_f32 v79, v79
buffer_load_dwordx4 v1, s[12:15], s43 offen offset:1024 sc1 lds
v_exp_f32 v92, v92
s_waitcnt lgkmcnt(7)
ds_read_b128 a[140:143], v5 offset:35840
s_waitcnt lgkmcnt(7)
ds_read_b128 a[144:147], v5 offset:44032
v_exp_f32 v93, v93
buffer_load_dwordx4 v1, s[12:15], s43 offen offset:2048 sc1 lds
v_exp_f32 v94, v94
v_cvt_pk_bf16_f32 v77, v78, v79
v_cvt_pk_bf16_f32 v78, v92, v93
v_exp_f32 v95, v95
buffer_load_dwordx4 v1, s[12:15], s43 offen offset:3072 sc1 lds
v_cvt_pk_bf16_f32 v79, v94, v95
s_waitcnt lgkmcnt(6)
M v[160:163], a[116:119], v[32:35], v[160:163]
ds_read_b128 a[148:151], v5 offset:36864
ds_read_b128 a[152:155], v5 offset:45056
M v[164:167], a[116:119], v[36:39], v[164:167]
M v[168:171], a[116:119], v[40:43], v[168:171]
M v[168:171], a[120:123], v[72:75], v[168:171]
s_add_u32 s25, s25, 32768
s_cmp_eq_u32 s25, s27
M v[172:175], a[120:123], v[76:79], v[172:175]
M v[172:175], a[116:119], v[44:47], v[172:175]
s_waitcnt lgkmcnt(6)
M a[96:99], a[112:115], v[32:35], a[96:99]
s_cselect_b32 s25, s28, s25
s_cselect_b32 s27, -1, s27
s_add_u32 s26, s26, 32768
s_cmp_eq_u32 s26, s62
M v[176:179], a[124:127], v[32:35], v[176:179]
ds_read_b128 a[156:159], v5 offset:37888
ds_read_b128 a[160:163], v5 offset:46080
M v[180:183], a[124:127], v[36:39], v[180:183]
M v[184:187], a[124:127], v[40:43], v[184:187]
M v[184:187], a[128:131], v[72:75], v[184:187]
s_cselect_b32 s26, s63, s26
s_cselect_b32 s62, -1, s62
M v[188:191], a[128:131], v[76:79], v[188:191]
M v[188:191], a[124:127], v[44:47], v[188:191]
s_waitcnt lgkmcnt(6)
M a[100:103], a[112:115], v[36:39], a[100:103]
M v[192:195], a[132:135], v[32:35], v[192:195]
ds_read_b128 a[164:167], v5 offset:38912
ds_read_b128 a[168:171], v5 offset:47104
M v[196:199], a[132:135], v[36:39], v[196:199]
M v[200:203], a[132:135], v[40:43], v[200:203]
M v[200:203], a[136:139], v[72:75], v[200:203]
M v[204:207], a[136:139], v[76:79], v[204:207]
M v[204:207], a[132:135], v[44:47], v[204:207]
s_waitcnt lgkmcnt(6)
M a[104:107], a[112:115], v[40:43], a[104:107]
M a[104:107], a[112:115], v[72:75], a[104:107]
M v[208:211], a[140:143], v[32:35], v[208:211]
ds_read_b128 a[172:175], v5 offset:39936
ds_read_b128 a[176:179], v5 offset:48128
M v[212:215], a[140:143], v[36:39], v[212:215]
M v[216:219], a[140:143], v[40:43], v[216:219]
M v[216:219], a[144:147], v[72:75], v[216:219]
M v[220:223], a[144:147], v[76:79], v[220:223]
M v[220:223], a[140:143], v[44:47], v[220:223]
s_waitcnt lgkmcnt(6)
M a[108:111], a[112:115], v[44:47], a[108:111]
M a[108:111], a[112:115], v[76:79], a[108:111]
M v[224:227], a[148:151], v[32:35], v[224:227]
M v[228:231], a[148:151], v[36:39], v[228:231]
M v[232:235], a[148:151], v[40:43], v[232:235]
M v[232:235], a[152:155], v[72:75], v[232:235]
M v[236:239], a[152:155], v[76:79], v[236:239]
M v[236:239], a[148:151], v[44:47], v[236:239]
s_waitcnt lgkmcnt(4)
M v[240:243], a[156:159], v[32:35], v[240:243]
M v[244:247], a[156:159], v[36:39], v[244:247]
M v[248:251], a[156:159], v[40:43], v[248:251]
M v[248:251], a[160:163], v[72:75], v[248:251]
s_waitcnt vmcnt(0) lgkmcnt(0)
s_barrier
ds_read_b128 a[116:119], v3 offset:0
ds_read_b128 a[120:123], v3 offset:1024
M v[252:255], a[160:163], v[76:79], v[252:255]
M v[252:255], a[156:159], v[44:47], v[252:255]
M a[64:67], a[164:167], v[32:35], a[64:67]
ds_read_b128 a[124:127], v3 offset:2048
ds_read_b128 a[128:131], v3 offset:3072
M a[68:71], a[164:167], v[36:39], a[68:71]
M a[72:75], a[164:167], v[40:43], a[72:75]
M a[72:75], a[168:171], v[72:75], a[72:75]
ds_read_b128 a[132:135], v3 offset:4096
ds_read_b128 a[136:139], v3 offset:5120
M a[76:79], a[168:171], v[76:79], a[76:79]
M a[76:79], a[164:167], v[44:47], a[76:79]
M a[80:83], a[172:175], v[32:35], a[80:83]
ds_read_b128 a[140:143], v3 offset:6144
ds_read_b128 a[144:147], v3 offset:7168
M a[84:87], a[172:175], v[36:39], a[84:87]
M a[88:91], a[172:175], v[40:43], a[88:91]
M a[88:91], a[176:179], v[72:75], a[88:91]
M a[92:95], a[176:179], v[76:79], a[92:95]
M a[92:95], a[172:175], v[44:47], a[92:95]
s_waitcnt vmcnt(16)
s_add_u32 m0, s29, 0
s_waitcnt lgkmcnt(4)
M v[32:35], a[116:119], a[180:183], 0
M v[32:35], a[120:123], a[184:187], v[32:35]
ds_read_b128 a[148:151], v3 offset:8192
ds_read_b128 a[152:155], v3 offset:9216
M v[32:35], a[124:127], a[188:191], v[32:35]
M v[32:35], a[128:131], a[192:195], v[32:35]
buffer_load_dwordx4 v1, s[12:15], s25 offen offset:0 sc1 lds
s_add_u32 s32, s25, 4096
M v[36:39], a[128:131], a[208:211], 0
M v[36:39], a[124:127], a[204:207], v[36:39]
M v[36:39], a[120:123], a[200:203], v[36:39]
M v[36:39], a[116:119], a[196:199], v[36:39]
buffer_load_dwordx4 v1, s[12:15], s25 offen offset:1024 sc1 lds
M v[40:43], a[116:119], a[212:215], 0
M v[40:43], a[120:123], a[216:219], v[40:43]
ds_read_b128 a[156:159], v3 offset:10240
ds_read_b128 a[160:163], v3 offset:11264
M v[40:43], a[124:127], a[220:223], v[40:43]
M v[40:43], a[128:131], a[224:227], v[40:43]
buffer_load_dwordx4 v1, s[12:15], s25 offen offset:2048 sc1 lds
M v[44:47], a[128:131], a[240:243], 0
M v[44:47], a[124:127], a[236:239], v[44:47]
M v[44:47], a[120:123], a[232:235], v[44:47]
M v[44:47], a[116:119], a[228:231], v[44:47]
buffer_load_dwordx4 v1, s[12:15], s25 offen offset:3072 sc1 lds
s_add_u32 m0, s29, 4096
s_waitcnt lgkmcnt(4)
M v[48:51], a[132:135], a[180:183], 0
M v[48:51], a[136:139], a[184:187], v[48:51]
ds_read_b128 a[164:167], v3 offset:12288
ds_read_b128 a[168:171], v3 offset:13312
M v[48:51], a[140:143], a[188:191], v[48:51]
M v[48:51], a[144:147], a[192:195], v[48:51]
buffer_load_dwordx4 v1, s[12:15], s32 offen offset:0 sc1 lds
M v[52:55], a[144:147], a[208:211], 0
M v[52:55], a[140:143], a[204:207], v[52:55]
M v[52:55], a[136:139], a[200:203], v[52:55]
M v[52:55], a[132:135], a[196:199], v[52:55]
buffer_load_dwordx4 v1, s[12:15], s32 offen offset:1024 sc1 lds
M v[56:59], a[132:135], a[212:215], 0
M v[56:59], a[136:139], a[216:219], v[56:59]
ds_read_b128 a[172:175], v3 offset:14336
ds_read_b128 a[176:179], v3 offset:15360
M v[56:59], a[140:143], a[220:223], v[56:59]
M v[56:59], a[144:147], a[224:227], v[56:59]
buffer_load_dwordx4 v1, s[12:15], s32 offen offset:2048 sc1 lds
M v[60:63], a[144:147], a[240:243], 0
M v[60:63], a[140:143], a[236:239], v[60:63]
M v[60:63], a[136:139], a[232:235], v[60:63]
M v[60:63], a[132:135], a[228:231], v[60:63]
buffer_load_dwordx4 v1, s[12:15], s32 offen offset:3072 sc1 lds
s_add_u32 m0, s29, 32768
s_waitcnt lgkmcnt(4)
M v[64:67], a[148:151], a[180:183], 0
M v[64:67], a[152:155], a[184:187], v[64:67]
M v[64:67], a[156:159], a[188:191], v[64:67]
M v[64:67], a[160:163], a[192:195], v[64:67]
buffer_load_dwordx4 v1, s[12:15], s26 offen offset:0 sc1 lds
s_add_u32 s43, s26, 4096
M v[68:71], a[160:163], a[208:211], 0
M v[68:71], a[156:159], a[204:207], v[68:71]
M v[68:71], a[152:155], a[200:203], v[68:71]
M v[68:71], a[148:151], a[196:199], v[68:71]
buffer_load_dwordx4 v1, s[12:15], s26 offen offset:1024 sc1 lds
M v[72:75], a[148:151], a[212:215], 0
M v[72:75], a[152:155], a[216:219], v[72:75]
M v[72:75], a[156:159], a[220:223], v[72:75]
M v[72:75], a[160:163], a[224:227], v[72:75]
buffer_load_dwordx4 v1, s[12:15], s26 offen offset:2048 sc1 lds
M v[76:79], a[160:163], a[240:243], 0
M v[76:79], a[156:159], a[236:239], v[76:79]
M v[76:79], a[152:155], a[232:235], v[76:79]
M v[76:79], a[148:151], a[228:231], v[76:79]
buffer_load_dwordx4 v1, s[12:15], s26 offen offset:3072 sc1 lds
s_add_u32 m0, s29, 36864
s_waitcnt lgkmcnt(0)
M v[80:83], a[164:167], a[180:183], 0
M v[80:83], a[168:171], a[184:187], v[80:83]
M v[80:83], a[172:175], a[188:191], v[80:83]
M v[80:83], a[176:179], a[192:195], v[80:83]
buffer_load_dwordx4 v1, s[12:15], s43 offen offset:0 sc1 lds
M v[84:87], a[176:179], a[208:211], 0
M v[84:87], a[172:175], a[204:207], v[84:87]
M v[84:87], a[168:171], a[200:203], v[84:87]
M v[84:87], a[164:167], a[196:199], v[84:87]
buffer_load_dwordx4 v1, s[12:15], s43 offen offset:1024 sc1 lds
M v[88:91], a[164:167], a[212:215], 0
M v[88:91], a[168:171], a[216:219], v[88:91]
M v[88:91], a[172:175], a[220:223], v[88:91]
M v[88:91], a[176:179], a[224:227], v[88:91]
buffer_load_dwordx4 v1, s[12:15], s43 offen offset:2048 sc1 lds
M v[92:95], a[176:179], a[240:243], 0
M v[92:95], a[172:175], a[236:239], v[92:95]
M v[92:95], a[168:171], a[232:235], v[92:95]
M v[92:95], a[164:167], a[228:231], v[92:95]
buffer_load_dwordx4 v1, s[12:15], s43 offen offset:3072 sc1 lds
v_exp_f32 v32, v32
v_exp_f32 v33, v33
s_nop 0
v_cvt_pk_bf16_f32 v32, v32, v33
v_exp_f32 v34, v34
s_add_u32 s25, s25, 32768
s_cmp_eq_u32 s25, s27
v_exp_f32 v35, v35
s_nop 0
v_cvt_pk_bf16_f32 v33, v34, v35
s_cselect_b32 s25, s28, s25
s_cselect_b32 s27, -1, s27
s_add_u32 s26, s26, 32768
s_cmp_eq_u32 s26, s62
v_exp_f32 v48, v48
v_exp_f32 v49, v49
s_nop 0
v_cvt_pk_bf16_f32 v34, v48, v49
v_exp_f32 v50, v50
s_cselect_b32 s26, s63, s26
s_cselect_b32 s62, -1, s62
v_exp_f32 v51, v51
s_nop 0
v_cvt_pk_bf16_f32 v35, v50, v51
v_exp_f32 v36, v36
v_exp_f32 v37, v37
s_nop 0
v_cvt_pk_bf16_f32 v36, v36, v37
v_exp_f32 v38, v38
v_exp_f32 v39, v39
s_nop 0
v_cvt_pk_bf16_f32 v37, v38, v39
v_exp_f32 v52, v52
v_exp_f32 v53, v53
s_nop 0
v_cvt_pk_bf16_f32 v38, v52, v53
v_exp_f32 v54, v54
v_exp_f32 v55, v55
s_nop 0
v_cvt_pk_bf16_f32 v39, v54, v55
v_exp_f32 v40, v40
v_exp_f32 v41, v41
s_nop 0
v_cvt_pk_bf16_f32 v40, v40, v41
v_exp_f32 v42, v42
v_exp_f32 v43, v43
s_nop 0
v_cvt_pk_bf16_f32 v41, v42, v43
v_exp_f32 v56, v56
v_exp_f32 v57, v57
s_nop 0
v_cvt_pk_bf16_f32 v42, v56, v57
v_exp_f32 v58, v58
s_waitcnt vmcnt(0) lgkmcnt(0)
s_barrier
ds_read_b128 a[116:119], v2 offset:0
ds_read_b128 a[120:123], v2 offset:1024
v_exp_f32 v59, v59
s_nop 0
v_cvt_pk_bf16_f32 v43, v58, v59
v_exp_f32 v44, v44
ds_read_b128 a[124:127], v2 offset:2048
ds_read_b128 a[128:131], v2 offset:3072
v_exp_f32 v45, v45
s_nop 0
v_cvt_pk_bf16_f32 v44, v44, v45
v_exp_f32 v46, v46
ds_read_b128 a[132:135], v2 offset:4096
ds_read_b128 a[136:139], v2 offset:5120
v_exp_f32 v47, v47
s_nop 0
v_cvt_pk_bf16_f32 v45, v46, v47
v_exp_f32 v60, v60
ds_read_b128 a[140:143], v2 offset:6144
ds_read_b128 a[144:147], v2 offset:7168
v_exp_f32 v61, v61
s_nop 0
v_cvt_pk_bf16_f32 v46, v60, v61
v_exp_f32 v62, v62
v_exp_f32 v63, v63
s_nop 0
v_cvt_pk_bf16_f32 v47, v62, v63
s_branch Lk2_ea
Lk2_m2:
s_cmp_eq_u32 s23, 0
s_cbranch_scc1 Lk2_m2a
s_branch Lk2_m2b
Lk2_m1b:
s_add_u32 m0, s29, 0
s_waitcnt lgkmcnt(4)
M v[32:35], a[116:119], a[0:3], 0
v_exp_f32 v128, v128
M v[32:35], a[120:123], a[4:7], v[32:35]
ds_read_b128 a[148:151], v3 offset:8192
ds_read_b128 a[152:155], v3 offset:9216
M v[32:35], a[124:127], a[8:11], v[32:35]
v_exp_f32 v129, v129
M v[32:35], a[128:131], a[12:15], v[32:35]
buffer_load_dwordx4 v1, s[12:15], s25 offen offset:0 sc1 lds
s_add_u32 s32, s25, 4096
M v[36:39], a[128:131], a[28:31], 0
v_exp_f32 v130, v130
M v[36:39], a[124:127], a[24:27], v[36:39]
v_cvt_pk_bf16_f32 v128, v128, v129
M v[36:39], a[120:123], a[20:23], v[36:39]
v_exp_f32 v131, v131
M v[36:39], a[116:119], a[16:19], v[36:39]
buffer_load_dwordx4 v1, s[12:15], s25 offen offset:1024 sc1 lds
M v[40:43], a[116:119], a[32:35], 0
v_exp_f32 v144, v144
M v[40:43], a[120:123], a[36:39], v[40:43]
ds_read_b128 a[156:159], v3 offset:10240
ds_read_b128 a[160:163], v3 offset:11264
M v[40:43], a[124:127], a[40:43], v[40:43]
v_exp_f32 v145, v145
M v[40:43], a[128:131], a[44:47], v[40:43]
buffer_load_dwordx4 v1, s[12:15], s25 offen offset:2048 sc1 lds
M v[44:47], a[128:131], a[60:63], 0
v_exp_f32 v146, v146
M v[44:47], a[124:127], a[56:59], v[44:47]
v_cvt_pk_bf16_f32 v129, v130, v131
v_cvt_pk_bf16_f32 v130, v144, v145
M v[44:47], a[120:123], a[52:55], v[44:47]
v_exp_f32 v147, v147
M v[44:47], a[116:119], a[48:51], v[44:47]
buffer_load_dwordx4 v1, s[12:15], s25 offen offset:3072 sc1 lds
s_add_u32 m0, s29, 4096
s_waitcnt lgkmcnt(4)
M v[48:51], a[132:135], a[0:3], 0
v_exp_f32 v132, v132
M v[48:51], a[136:139], a[4:7], v[48:51]
ds_read_b128 a[164:167], v3 offset:12288
ds_read_b128 a[168:171], v3 offset:13312
M v[48:51], a[140:143], a[8:11], v[48:51]
v_exp_f32 v133, v133
M v[48:51], a[144:147], a[12:15], v[48:51]
buffer_load_dwordx4 v1, s[12:15], s32 offen offset:0 sc1 lds
M v[52:55], a[144:147], a[28:31], 0
v_exp_f32 v134, v134
M v[52:55], a[140:143], a[24:27], v[52:55]
v_cvt_pk_bf16_f32 v131, v146, v147
v_cvt_pk_bf16_f32 v132, v132, v133
M v[52:55], a[136:139], a[20:23], v[52:55]
v_exp_f32 v135, v135
M v[52:55], a[132:135], a[16:19], v[52:55]
buffer_load_dwordx4 v1, s[12:15], s32 offen offset:1024 sc1 lds
M v[56:59], a[132:135], a[32:35], 0
v_exp_f32 v148, v148
M v[56:59], a[136:139], a[36:39], v[56:59]
ds_read_b128 a[172:175], v3 offset:14336
ds_read_b128 a[176:179], v3 offset:15360
M v[56:59], a[140:143], a[40:43], v[56:59]
v_exp_f32 v149, v149
M v[56:59], a[144:147], a[44:47], v[56:59]
buffer_load_dwordx4 v1, s[12:15], s32 offen offset:2048 sc1 lds
M v[60:63], a[144:147], a[60:63], 0
v_exp_f32 v150, v150
M v[60:63], a[140:143], a[56:59], v[60:63]
v_cvt_pk_bf16_f32 v133, v134, v135
v_cvt_pk_bf16_f32 v134, v148, v149
M v[60:63], a[136:139], a[52:55], v[60:63]
v_exp_f32 v151, v151
M v[60:63], a[132:135], a[48:51], v[60:63]
buffer_load_dwordx4 v1, s[12:15], s32 offen offset:3072 sc1 lds
s_add_u32 m0, s29, 32768
s_waitcnt lgkmcnt(4)
M v[64:67], a[148:151], a[0:3], 0
v_exp_f32 v136, v136
M v[64:67], a[152:155], a[4:7], v[64:67]
ds_read_b128 a[116:119], v6 offset:32768
ds_read_b128 a[120:123], v6 offset:40960
M v[64:67], a[156:159], a[8:11], v[64:67]
v_exp_f32 v137, v137
M v[64:67], a[160:163], a[12:15], v[64:67]
buffer_load_dwordx4 v1, s[12:15], s26 offen offset:0 sc1 lds
s_add_u32 s43, s26, 4096
M v[68:71], a[160:163], a[28:31], 0
v_exp_f32 v138, v138
M v[68:71], a[156:159], a[24:27], v[68:71]
v_cvt_pk_bf16_f32 v135, v150, v151
v_cvt_pk_bf16_f32 v136, v136, v137
M v[68:71], a[152:155], a[20:23], v[68:71]
v_exp_f32 v139, v139
M v[68:71], a[148:151], a[16:19], v[68:71]
buffer_load_dwordx4 v1, s[12:15], s26 offen offset:1024 sc1 lds
M v[72:75], a[148:151], a[32:35], 0
v_exp_f32 v152, v152
M v[72:75], a[152:155], a[36:39], v[72:75]
ds_read_b128 a[124:127], v6 offset:33792
ds_read_b128 a[128:131], v6 offset:41984
M v[72:75], a[156:159], a[40:43], v[72:75]
v_exp_f32 v153, v153
M v[72:75], a[160:163], a[44:47], v[72:75]
buffer_load_dwordx4 v1, s[12:15], s26 offen offset:2048 sc1 lds
M v[76:79], a[160:163], a[60:63], 0
v_exp_f32 v154, v154
M v[76:79], a[156:159], a[56:59], v[76:79]
v_cvt_pk_bf16_f32 v137, v138, v139
v_cvt_pk_bf16_f32 v138, v152, v153
M v[76:79], a[152:155], a[52:55], v[76:79]
v_exp_f32 v155, v155
M v[76:79], a[148:151], a[48:51], v[76:79]
buffer_load_dwordx4 v1, s[12:15], s26 offen offset:3072 sc1 lds
s_add_u32 m0, s29, 36864
s_waitcnt lgkmcnt(4)
M v[80:83], a[164:167], a[0:3], 0
v_exp_f32 v140, v140
M v[80:83], a[168:171], a[4:7], v[80:83]
ds_read_b128 a[132:135], v6 offset:34816
ds_read_b128 a[136:139], v6 offset:43008
M v[80:83], a[172:175], a[8:11], v[80:83]
v_exp_f32 v141, v141
M v[80:83], a[176:179], a[12:15], v[80:83]
buffer_load_dwordx4 v1, s[12:15], s43 offen offset:0 sc1 lds
M v[84:87], a[176:179], a[28:31], 0
v_exp_f32 v142, v142
M v[84:87], a[172:175], a[24:27], v[84:87]
v_cvt_pk_bf16_f32 v139, v154, v155
v_cvt_pk_bf16_f32 v140, v140, v141
M v[84:87], a[168:171], a[20:23], v[84:87]
v_exp_f32 v143, v143
M v[84:87], a[164:167], a[16:19], v[84:87]
buffer_load_dwordx4 v1, s[12:15], s43 offen offset:1024 sc1 lds
M v[88:91], a[164:167], a[32:35], 0
v_exp_f32 v156, v156
M v[88:91], a[168:171], a[36:39], v[88:91]
ds_read_b128 a[140:143], v6 offset:35840
ds_read_b128 a[144:147], v6 offset:44032
M v[88:91], a[172:175], a[40:43], v[88:91]
v_exp_f32 v157, v157
M v[88:91], a[176:179], a[44:47], v[88:91]
buffer_load_dwordx4 v1, s[12:15], s43 offen offset:2048 sc1 lds
M v[92:95], a[176:179], a[60:63], 0
v_exp_f32 v158, v158
M v[92:95], a[172:175], a[56:59], v[92:95]
v_cvt_pk_bf16_f32 v141, v142, v143
v_cvt_pk_bf16_f32 v142, v156, v157
M v[92:95], a[168:171], a[52:55], v[92:95]
v_exp_f32 v159, v159
M v[92:95], a[164:167], a[48:51], v[92:95]
buffer_load_dwordx4 v1, s[12:15], s43 offen offset:3072 sc1 lds
v_cvt_pk_bf16_f32 v143, v158, v159
s_waitcnt lgkmcnt(6)
M v[160:163], a[116:119], v[96:99], v[160:163]
v_exp_f32 v32, v32
M v[160:163], a[120:123], v[128:131], v[160:163]
ds_read_b128 a[148:151], v6 offset:36864
ds_read_b128 a[152:155], v6 offset:45056
M v[164:167], a[120:123], v[132:135], v[164:167]
v_exp_f32 v33, v33
M v[164:167], a[116:119], v[100:103], v[164:167]
v_cvt_pk_bf16_f32 v32, v32, v33
M v[168:171], a[116:119], v[104:107], v[168:171]
v_exp_f32 v34, v34
M v[168:171], a[120:123], v[136:139], v[168:171]
s_add_u32 s25, s25, 32768
s_cmp_eq_u32 s25, s27
M v[172:175], a[120:123], v[140:143], v[172:175]
v_exp_f32 v35, v35
M v[172:175], a[116:119], v[108:111], v[172:175]
v_cvt_pk_bf16_f32 v33, v34, v35
s_waitcnt lgkmcnt(6)
M a[96:99], a[112:115], v[96:99], a[96:99]
s_cselect_b32 s25, s28, s25
s_cselect_b32 s27, -1, s27
M a[96:99], a[112:115], v[128:131], a[96:99]
s_add_u32 s26, s26, 32768
s_cmp_eq_u32 s26, s62
M v[176:179], a[124:127], v[96:99], v[176:179]
v_exp_f32 v48, v48
M v[176:179], a[128:131], v[128:131], v[176:179]
ds_read_b128 a[156:159], v6 offset:37888
ds_read_b128 a[160:163], v6 offset:46080
M v[180:183], a[128:131], v[132:135], v[180:183]
v_exp_f32 v49, v49
M v[180:183], a[124:127], v[100:103], v[180:183]
v_cvt_pk_bf16_f32 v34, v48, v49
M v[184:187], a[124:127], v[104:107], v[184:187]
v_exp_f32 v50, v50
M v[184:187], a[128:131], v[136:139], v[184:187]
s_cselect_b32 s26, s63, s26
s_cselect_b32 s62, -1, s62
M v[188:191], a[128:131], v[140:143], v[188:191]
v_exp_f32 v51, v51
M v[188:191], a[124:127], v[108:111], v[188:191]
v_cvt_pk_bf16_f32 v35, v50, v51
s_waitcnt lgkmcnt(6)
M a[100:103], a[112:115], v[100:103], a[100:103]
M a[100:103], a[112:115], v[132:135], a[100:103]
M v[192:195], a[132:135], v[96:99], v[192:195]
v_exp_f32 v36, v36
M v[192:195], a[136:139], v[128:131], v[192:195]
ds_read_b128 a[164:167], v6 offset:38912
ds_read_b128 a[168:171], v6 offset:47104
M v[196:199], a[136:139], v[132:135], v[196:199]
v_exp_f32 v37, v37
M v[196:199], a[132:135], v[100:103], v[196:199]
v_cvt_pk_bf16_f32 v36, v36, v37
M v[200:203], a[132:135], v[104:107], v[200:203]
v_exp_f32 v38, v38
M v[200:203], a[136:139], v[136:139], v[200:203]
M v[204:207], a[136:139], v[140:143], v[204:207]
v_exp_f32 v39, v39
M v[204:207], a[132:135], v[108:111], v[204:207]
v_cvt_pk_bf16_f32 v37, v38, v39
s_waitcnt lgkmcnt(6)
M a[104:107], a[112:115], v[104:107], a[104:107]
M a[104:107], a[112:115], v[136:139], a[104:107]
M v[208:211], a[140:143], v[96:99], v[208:211]
v_exp_f32 v52, v52
M v[208:211], a[144:147], v[128:131], v[208:211]
ds_read_b128 a[172:175], v6 offset:39936
ds_read_b128 a[176:179], v6 offset:48128
M v[212:215], a[144:147], v[132:135], v[212:215]
v_exp_f32 v53, v53
M v[212:215], a[140:143], v[100:103], v[212:215]
v_cvt_pk_bf16_f32 v38, v52, v53
M v[216:219], a[140:143], v[104:107], v[216:219]
v_exp_f32 v54, v54
M v[216:219], a[144:147], v[136:139], v[216:219]
M v[220:223], a[144:147], v[140:143], v[220:223]
v_exp_f32 v55, v55
M v[220:223], a[140:143], v[108:111], v[220:223]
v_cvt_pk_bf16_f32 v39, v54, v55
s_waitcnt lgkmcnt(6)
M a[108:111], a[112:115], v[108:111], a[108:111]
M a[108:111], a[112:115], v[140:143], a[108:111]
M v[224:227], a[148:151], v[96:99], v[224:227]
v_exp_f32 v40, v40
M v[224:227], a[152:155], v[128:131], v[224:227]
M v[228:231], a[152:155], v[132:135], v[228:231]
v_exp_f32 v41, v41
M v[228:231], a[148:151], v[100:103], v[228:231]
v_cvt_pk_bf16_f32 v40, v40, v41
M v[232:235], a[148:151], v[104:107], v[232:235]
v_exp_f32 v42, v42
M v[232:235], a[152:155], v[136:139], v[232:235]
M v[236:239], a[152:155], v[140:143], v[236:239]
v_exp_f32 v43, v43
M v[236:239], a[148:151], v[108:111], v[236:239]
v_cvt_pk_bf16_f32 v41, v42, v43
s_waitcnt lgkmcnt(4)
M v[240:243], a[156:159], v[96:99], v[240:243]
v_exp_f32 v56, v56
M v[240:243], a[160:163], v[128:131], v[240:243]
M v[244:247], a[160:163], v[132:135], v[244:247]
v_exp_f32 v57, v57
M v[244:247], a[156:159], v[100:103], v[244:247]
v_cvt_pk_bf16_f32 v42, v56, v57
M v[248:251], a[156:159], v[104:107], v[248:251]
v_exp_f32 v58, v58
M v[248:251], a[160:163], v[136:139], v[248:251]
s_waitcnt vmcnt(0) lgkmcnt(0)
s_barrier
ds_read_b128 a[116:119], v2 offset:0
ds_read_b128 a[120:123], v2 offset:1024
M v[252:255], a[160:163], v[140:143], v[252:255]
v_exp_f32 v59, v59
M v[252:255], a[156:159], v[108:111], v[252:255]
v_cvt_pk_bf16_f32 v43, v58, v59
M a[64:67], a[164:167], v[96:99], a[64:67]
v_exp_f32 v44, v44
M a[64:67], a[168:171], v[128:131], a[64:67]
ds_read_b128 a[124:127], v2 offset:2048
ds_read_b128 a[128:131], v2 offset:3072
M a[68:71], a[168:171], v[132:135], a[68:71]
v_exp_f32 v45, v45
M a[68:71], a[164:167], v[100:103], a[68:71]
v_cvt_pk_bf16_f32 v44, v44, v45
M a[72:75], a[164:167], v[104:107], a[72:75]
v_exp_f32 v46, v46
M a[72:75], a[168:171], v[136:139], a[72:75]
ds_read_b128 a[132:135], v2 offset:4096
ds_read_b128 a[136:139], v2 offset:5120
M a[76:79], a[168:171], v[140:143], a[76:79]
v_exp_f32 v47, v47
M a[76:79], a[164:167], v[108:111], a[76:79]
v_cvt_pk_bf16_f32 v45, v46, v47
M a[80:83], a[172:175], v[96:99], a[80:83]
v_exp_f32 v60, v60
M a[80:83], a[176:179], v[128:131], a[80:83]
ds_read_b128 a[140:143], v2 offset:6144
ds_read_b128 a[144:147], v2 offset:7168
M a[84:87], a[176:179], v[132:135], a[84:87]
v_exp_f32 v61, v61
M a[84:87], a[172:175], v[100:103], a[84:87]
v_cvt_pk_bf16_f32 v46, v60, v61
M a[88:91], a[172:175], v[104:107], a[88:91]
v_exp_f32 v62, v62
M a[88:91], a[176:179], v[136:139], a[88:91]
M a[92:95], a[176:179], v[140:143], a[92:95]
v_exp_f32 v63, v63
M a[92:95], a[172:175], v[108:111], a[92:95]
v_cvt_pk_bf16_f32 v47, v62, v63
Lk2_m2b:
s_sub_u32 s35, 15, s21
s_lshl_b32 s33, s20, 7
s_lshl_b32 s34, s35, 3
s_add_u32 s33, s33, s34
s_lshl_b32 s34, s23, 2
s_add_u32 s33, s33, s34
s_lshl_b32 s33, s33, 12
buffer_load_dwordx4 a[180:183], v1, s[8:11], s33 offen offset:0 sc1
buffer_load_dwordx4 a[184:187], v1, s[8:11], s33 offen offset:1024 sc1
buffer_load_dwordx4 a[188:191], v1, s[8:11], s33 offen offset:2048 sc1
buffer_load_dwordx4 a[192:195], v1, s[8:11], s33 offen offset:3072 sc1
s_add_u32 s33, s33, 4096
buffer_load_dwordx4 a[196:199], v1, s[8:11], s33 offen offset:0 sc1
buffer_load_dwordx4 a[200:203], v1, s[8:11], s33 offen offset:1024 sc1
buffer_load_dwordx4 a[204:207], v1, s[8:11], s33 offen offset:2048 sc1
buffer_load_dwordx4 a[208:211], v1, s[8:11], s33 offen offset:3072 sc1
s_add_u32 s33, s33, 4096
buffer_load_dwordx4 a[212:215], v1, s[8:11], s33 offen offset:0 sc1
buffer_load_dwordx4 a[216:219], v1, s[8:11], s33 offen offset:1024 sc1
buffer_load_dwordx4 a[220:223], v1, s[8:11], s33 offen offset:2048 sc1
buffer_load_dwordx4 a[224:227], v1, s[8:11], s33 offen offset:3072 sc1
s_add_u32 s33, s33, 4096
buffer_load_dwordx4 a[228:231], v1, s[8:11], s33 offen offset:0 sc1
buffer_load_dwordx4 a[232:235], v1, s[8:11], s33 offen offset:1024 sc1
buffer_load_dwordx4 a[236:239], v1, s[8:11], s33 offen offset:2048 sc1
buffer_load_dwordx4 a[240:243], v1, s[8:11], s33 offen offset:3072 sc1
s_add_u32 m0, s29, 65536
s_waitcnt lgkmcnt(4)
M v[96:99], a[116:119], a[0:3], v[16:19]
v_exp_f32 v64, v64
M v[96:99], a[120:123], a[4:7], v[96:99]
ds_read_b128 a[148:151], v2 offset:8192
ds_read_b128 a[152:155], v2 offset:9216
M v[96:99], a[124:127], a[8:11], v[96:99]
v_exp_f32 v65, v65
M v[96:99], a[128:131], a[12:15], v[96:99]
buffer_load_dwordx4 v1, s[12:15], s25 offen offset:0 sc1 lds
s_add_u32 s32, s25, 4096
M v[100:103], a[128:131], a[28:31], 0
v_exp_f32 v66, v66
M v[100:103], a[124:127], a[24:27], v[100:103]
v_cvt_pk_bf16_f32 v64, v64, v65
M v[100:103], a[120:123], a[20:23], v[100:103]
v_exp_f32 v67, v67
M v[100:103], a[116:119], a[16:19], v[100:103]
buffer_load_dwordx4 v1, s[12:15], s25 offen offset:1024 sc1 lds
M v[104:107], a[116:119], a[32:35], 0
v_exp_f32 v80, v80
M v[104:107], a[120:123], a[36:39], v[104:107]
ds_read_b128 a[156:159], v2 offset:10240
ds_read_b128 a[160:163], v2 offset:11264
M v[104:107], a[124:127], a[40:43], v[104:107]
v_exp_f32 v81, v81
M v[104:107], a[128:131], a[44:47], v[104:107]
buffer_load_dwordx4 v1, s[12:15], s25 offen offset:2048 sc1 lds
M v[108:111], a[128:131], a[60:63], 0
v_exp_f32 v82, v82
M v[108:111], a[124:127], a[56:59], v[108:111]
v_cvt_pk_bf16_f32 v65, v66, v67
v_cvt_pk_bf16_f32 v66, v80, v81
M v[108:111], a[120:123], a[52:55], v[108:111]
v_exp_f32 v83, v83
M v[108:111], a[116:119], a[48:51], v[108:111]
buffer_load_dwordx4 v1, s[12:15], s25 offen offset:3072 sc1 lds
s_add_u32 m0, s29, 69632
s_waitcnt lgkmcnt(4)
v_exp_f32 v68, v68
ds_read_b128 a[164:167], v2 offset:12288
ds_read_b128 a[168:171], v2 offset:13312
v_exp_f32 v69, v69
buffer_load_dwordx4 v1, s[12:15], s32 offen offset:0 sc1 lds
M v[116:119], a[144:147], a[28:31], v[16:19]
v_exp_f32 v70, v70
M v[116:119], a[140:143], a[24:27], v[116:119]
v_cvt_pk_bf16_f32 v67, v82, v83
v_cvt_pk_bf16_f32 v68, v68, v69
M v[116:119], a[136:139], a[20:23], v[116:119]
v_exp_f32 v71, v71
M v[116:119], a[132:135], a[16:19], v[116:119]
buffer_load_dwordx4 v1, s[12:15], s32 offen offset:1024 sc1 lds
M v[120:123], a[132:135], a[32:35], 0
v_exp_f32 v84, v84
M v[120:123], a[136:139], a[36:39], v[120:123]
ds_read_b128 a[172:175], v2 offset:14336
ds_read_b128 a[176:179], v2 offset:15360
M v[120:123], a[140:143], a[40:43], v[120:123]
v_exp_f32 v85, v85
M v[120:123], a[144:147], a[44:47], v[120:123]
buffer_load_dwordx4 v1, s[12:15], s32 offen offset:2048 sc1 lds
M v[124:127], a[144:147], a[60:63], 0
v_exp_f32 v86, v86
M v[124:127], a[140:143], a[56:59], v[124:127]
v_cvt_pk_bf16_f32 v69, v70, v71
v_cvt_pk_bf16_f32 v70, v84, v85
M v[124:127], a[136:139], a[52:55], v[124:127]
v_exp_f32 v87, v87
M v[124:127], a[132:135], a[48:51], v[124:127]
buffer_load_dwordx4 v1, s[12:15], s32 offen offset:3072 sc1 lds
s_add_u32 m0, s29, 98304
s_waitcnt lgkmcnt(4)
v_exp_f32 v72, v72
ds_read_b128 a[116:119], v5 offset:32768
ds_read_b128 a[120:123], v5 offset:40960
v_exp_f32 v73, v73
buffer_load_dwordx4 v1, s[12:15], s26 offen offset:0 sc1 lds
s_add_u32 s43, s26, 4096
v_exp_f32 v74, v74
v_cvt_pk_bf16_f32 v71, v86, v87
v_cvt_pk_bf16_f32 v72, v72, v73
v_exp_f32 v75, v75
buffer_load_dwordx4 v1, s[12:15], s26 offen offset:1024 sc1 lds
M v[136:139], a[148:151], a[32:35], v[16:19]
v_exp_f32 v88, v88
M v[136:139], a[152:155], a[36:39], v[136:139]
ds_read_b128 a[124:127], v5 offset:33792
ds_read_b128 a[128:131], v5 offset:41984
M v[136:139], a[156:159], a[40:43], v[136:139]
v_exp_f32 v89, v89
M v[136:139], a[160:163], a[44:47], v[136:139]
buffer_load_dwordx4 v1, s[12:15], s26 offen offset:2048 sc1 lds
M v[140:143], a[160:163], a[60:63], 0
v_exp_f32 v90, v90
M v[140:143], a[156:159], a[56:59], v[140:143]
v_cvt_pk_bf16_f32 v73, v74, v75
v_cvt_pk_bf16_f32 v74, v88, v89
M v[140:143], a[152:155], a[52:55], v[140:143]
v_exp_f32 v91, v91
M v[140:143], a[148:151], a[48:51], v[140:143]
buffer_load_dwordx4 v1, s[12:15], s26 offen offset:3072 sc1 lds
s_add_u32 m0, s29, 102400
s_waitcnt lgkmcnt(4)
v_exp_f32 v76, v76
ds_read_b128 a[132:135], v5 offset:34816
ds_read_b128 a[136:139], v5 offset:43008
v_exp_f32 v77, v77
buffer_load_dwordx4 v1, s[12:15], s43 offen offset:0 sc1 lds
v_exp_f32 v78, v78
v_cvt_pk_bf16_f32 v75, v90, v91
v_cvt_pk_bf16_f32 v76, v76, v77
v_exp_f32 v79, v79
buffer_load_dwordx4 v1, s[12:15], s43 offen offset:1024 sc1 lds
v_exp_f32 v92, v92
ds_read_b128 a[140:143], v5 offset:35840
ds_read_b128 a[144:147], v5 offset:44032
v_exp_f32 v93, v93
buffer_load_dwordx4 v1, s[12:15], s43 offen offset:2048 sc1 lds
M v[156:159], a[176:179], a[60:63], v[16:19]
v_exp_f32 v94, v94
M v[156:159], a[172:175], a[56:59], v[156:159]
v_cvt_pk_bf16_f32 v77, v78, v79
v_cvt_pk_bf16_f32 v78, v92, v93
M v[156:159], a[168:171], a[52:55], v[156:159]
v_exp_f32 v95, v95
M v[156:159], a[164:167], a[48:51], v[156:159]
buffer_load_dwordx4 v1, s[12:15], s43 offen offset:3072 sc1 lds
v_cvt_pk_bf16_f32 v79, v94, v95
s_waitcnt lgkmcnt(6)
M v[160:163], a[116:119], v[32:35], v[160:163]
v_exp_f32 v96, v96
M v[160:163], a[120:123], v[64:67], v[160:163]
ds_read_b128 a[148:151], v5 offset:36864
ds_read_b128 a[152:155], v5 offset:45056
M v[164:167], a[120:123], v[68:71], v[164:167]
v_exp_f32 v97, v97
M v[164:167], a[116:119], v[36:39], v[164:167]
v_cvt_pk_bf16_f32 v96, v96, v97
M v[168:171], a[116:119], v[40:43], v[168:171]
v_exp_f32 v98, v98
M v[168:171], a[120:123], v[72:75], v[168:171]
s_add_u32 s25, s25, 32768
s_cmp_eq_u32 s25, s27
M v[172:175], a[120:123], v[76:79], v[172:175]
v_exp_f32 v99, v99
M v[172:175], a[116:119], v[44:47], v[172:175]
v_cvt_pk_bf16_f32 v97, v98, v99
s_waitcnt lgkmcnt(6)
M a[96:99], a[112:115], v[32:35], a[96:99]
s_cselect_b32 s25, s28, s25
s_cselect_b32 s27, -1, s27
M a[96:99], a[112:115], v[64:67], a[96:99]
s_add_u32 s26, s26, 32768
s_cmp_eq_u32 s26, s62
M v[176:179], a[124:127], v[32:35], v[176:179]
M v[176:179], a[128:131], v[64:67], v[176:179]
ds_read_b128 a[156:159], v5 offset:37888
ds_read_b128 a[160:163], v5 offset:46080
M v[180:183], a[128:131], v[68:71], v[180:183]
M v[180:183], a[124:127], v[36:39], v[180:183]
v_mov_b32 v98, 0
M v[184:187], a[124:127], v[40:43], v[184:187]
M v[184:187], a[128:131], v[72:75], v[184:187]
s_cselect_b32 s26, s63, s26
s_cselect_b32 s62, -1, s62
M v[188:191], a[128:131], v[76:79], v[188:191]
M v[188:191], a[124:127], v[44:47], v[188:191]
v_mov_b32 v99, 0
s_waitcnt lgkmcnt(6)
M a[100:103], a[112:115], v[36:39], a[100:103]
M a[100:103], a[112:115], v[68:71], a[100:103]
M v[192:195], a[132:135], v[32:35], v[192:195]
v_exp_f32 v100, v100
M v[192:195], a[136:139], v[64:67], v[192:195]
ds_read_b128 a[164:167], v5 offset:38912
ds_read_b128 a[168:171], v5 offset:47104
M v[196:199], a[136:139], v[68:71], v[196:199]
v_exp_f32 v101, v101
M v[196:199], a[132:135], v[36:39], v[196:199]
v_cvt_pk_bf16_f32 v100, v100, v101
M v[200:203], a[132:135], v[40:43], v[200:203]
v_exp_f32 v102, v102
M v[200:203], a[136:139], v[72:75], v[200:203]
M v[204:207], a[136:139], v[76:79], v[204:207]
v_exp_f32 v103, v103
M v[204:207], a[132:135], v[44:47], v[204:207]
v_cvt_pk_bf16_f32 v101, v102, v103
s_waitcnt lgkmcnt(6)
M a[104:107], a[112:115], v[40:43], a[104:107]
M a[104:107], a[112:115], v[72:75], a[104:107]
M v[208:211], a[140:143], v[32:35], v[208:211]
v_exp_f32 v116, v116
M v[208:211], a[144:147], v[64:67], v[208:211]
ds_read_b128 a[172:175], v5 offset:39936
ds_read_b128 a[176:179], v5 offset:48128
M v[212:215], a[144:147], v[68:71], v[212:215]
v_exp_f32 v117, v117
M v[212:215], a[140:143], v[36:39], v[212:215]
v_cvt_pk_bf16_f32 v102, v116, v117
M v[216:219], a[140:143], v[40:43], v[216:219]
v_exp_f32 v118, v118
M v[216:219], a[144:147], v[72:75], v[216:219]
M v[220:223], a[144:147], v[76:79], v[220:223]
v_exp_f32 v119, v119
M v[220:223], a[140:143], v[44:47], v[220:223]
v_cvt_pk_bf16_f32 v103, v118, v119
s_waitcnt lgkmcnt(6)
M a[108:111], a[112:115], v[44:47], a[108:111]
M a[108:111], a[112:115], v[76:79], a[108:111]
M v[224:227], a[148:151], v[32:35], v[224:227]
v_exp_f32 v104, v104
M v[224:227], a[152:155], v[64:67], v[224:227]
M v[228:231], a[152:155], v[68:71], v[228:231]
v_exp_f32 v105, v105
M v[228:231], a[148:151], v[36:39], v[228:231]
v_cvt_pk_bf16_f32 v104, v104, v105
M v[232:235], a[148:151], v[40:43], v[232:235]
v_exp_f32 v106, v106
M v[232:235], a[152:155], v[72:75], v[232:235]
M v[236:239], a[152:155], v[76:79], v[236:239]
v_exp_f32 v107, v107
M v[236:239], a[148:151], v[44:47], v[236:239]
v_cvt_pk_bf16_f32 v105, v106, v107
s_waitcnt lgkmcnt(4)
M v[240:243], a[156:159], v[32:35], v[240:243]
v_exp_f32 v120, v120
M v[240:243], a[160:163], v[64:67], v[240:243]
M v[244:247], a[160:163], v[68:71], v[244:247]
v_exp_f32 v121, v121
M v[244:247], a[156:159], v[36:39], v[244:247]
v_cvt_pk_bf16_f32 v106, v120, v121
M v[248:251], a[156:159], v[40:43], v[248:251]
v_exp_f32 v122, v122
M v[248:251], a[160:163], v[72:75], v[248:251]
s_waitcnt vmcnt(0) lgkmcnt(0)
s_barrier
ds_read_b128 a[116:119], v3 offset:0
ds_read_b128 a[120:123], v3 offset:1024
M v[252:255], a[160:163], v[76:79], v[252:255]
v_exp_f32 v123, v123
M v[252:255], a[156:159], v[44:47], v[252:255]
v_cvt_pk_bf16_f32 v107, v122, v123
M a[64:67], a[164:167], v[32:35], a[64:67]
v_exp_f32 v108, v108
M a[64:67], a[168:171], v[64:67], a[64:67]
ds_read_b128 a[124:127], v3 offset:2048
ds_read_b128 a[128:131], v3 offset:3072
M a[68:71], a[168:171], v[68:71], a[68:71]
v_exp_f32 v109, v109
M a[68:71], a[164:167], v[36:39], a[68:71]
v_cvt_pk_bf16_f32 v108, v108, v109
M a[72:75], a[164:167], v[40:43], a[72:75]
v_exp_f32 v110, v110
M a[72:75], a[168:171], v[72:75], a[72:75]
ds_read_b128 a[132:135], v3 offset:4096
ds_read_b128 a[136:139], v3 offset:5120
M a[76:79], a[168:171], v[76:79], a[76:79]
v_exp_f32 v111, v111
M a[76:79], a[164:167], v[44:47], a[76:79]
v_cvt_pk_bf16_f32 v109, v110, v111
M a[80:83], a[172:175], v[32:35], a[80:83]
v_exp_f32 v124, v124
M a[80:83], a[176:179], v[64:67], a[80:83]
ds_read_b128 a[140:143], v3 offset:6144
ds_read_b128 a[144:147], v3 offset:7168
M a[84:87], a[176:179], v[68:71], a[84:87]
v_exp_f32 v125, v125
M a[84:87], a[172:175], v[36:39], a[84:87]
v_cvt_pk_bf16_f32 v110, v124, v125
M a[88:91], a[172:175], v[40:43], a[88:91]
v_exp_f32 v126, v126
M a[88:91], a[176:179], v[72:75], a[88:91]
M a[92:95], a[176:179], v[76:79], a[92:95]
v_exp_f32 v127, v127
M a[92:95], a[172:175], v[44:47], a[92:95]
v_cvt_pk_bf16_f32 v111, v126, v127
s_waitcnt vmcnt(16)
s_add_u32 m0, s29, 0
s_waitcnt lgkmcnt(4)
M v[32:35], a[116:119], a[180:183], 0
M v[32:35], a[120:123], a[184:187], v[32:35]
ds_read_b128 a[148:151], v3 offset:8192
ds_read_b128 a[152:155], v3 offset:9216
M v[32:35], a[124:127], a[188:191], v[32:35]
M v[32:35], a[128:131], a[192:195], v[32:35]
buffer_load_dwordx4 v1, s[12:15], s25 offen offset:0 sc1 lds
s_add_u32 s32, s25, 4096
M v[36:39], a[128:131], a[208:211], 0
M v[36:39], a[124:127], a[204:207], v[36:39]
M v[36:39], a[120:123], a[200:203], v[36:39]
M v[36:39], a[116:119], a[196:199], v[36:39]
buffer_load_dwordx4 v1, s[12:15], s25 offen offset:1024 sc1 lds
M v[40:43], a[116:119], a[212:215], 0
M v[40:43], a[120:123], a[216:219], v[40:43]
ds_read_b128 a[156:159], v3 offset:10240
ds_read_b128 a[160:163], v3 offset:11264
M v[40:43], a[124:127], a[220:223], v[40:43]
M v[40:43], a[128:131], a[224:227], v[40:43]
buffer_load_dwordx4 v1, s[12:15], s25 offen offset:2048 sc1 lds
M v[44:47], a[128:131], a[240:243], 0
M v[44:47], a[124:127], a[236:239], v[44:47]
M v[44:47], a[120:123], a[232:235], v[44:47]
M v[44:47], a[116:119], a[228:231], v[44:47]
buffer_load_dwordx4 v1, s[12:15], s25 offen offset:3072 sc1 lds
s_add_u32 m0, s29, 4096
s_waitcnt lgkmcnt(4)
M v[48:51], a[132:135], a[180:183], 0
M v[48:51], a[136:139], a[184:187], v[48:51]
ds_read_b128 a[164:167], v3 offset:12288
ds_read_b128 a[168:171], v3 offset:13312
M v[48:51], a[140:143], a[188:191], v[48:51]
M v[48:51], a[144:147], a[192:195], v[48:51]
buffer_load_dwordx4 v1, s[12:15], s32 offen offset:0 sc1 lds
M v[52:55], a[144:147], a[208:211], 0
M v[52:55], a[140:143], a[204:207], v[52:55]
M v[52:55], a[136:139], a[200:203], v[52:55]
M v[52:55], a[132:135], a[196:199], v[52:55]
buffer_load_dwordx4 v1, s[12:15], s32 offen offset:1024 sc1 lds
M v[56:59], a[132:135], a[212:215], 0
M v[56:59], a[136:139], a[216:219], v[56:59]
ds_read_b128 a[172:175], v3 offset:14336
ds_read_b128 a[176:179], v3 offset:15360
M v[56:59], a[140:143], a[220:223], v[56:59]
M v[56:59], a[144:147], a[224:227], v[56:59]
buffer_load_dwordx4 v1, s[12:15], s32 offen offset:2048 sc1 lds
M v[60:63], a[144:147], a[240:243], 0
M v[60:63], a[140:143], a[236:239], v[60:63]
M v[60:63], a[136:139], a[232:235], v[60:63]
M v[60:63], a[132:135], a[228:231], v[60:63]
buffer_load_dwordx4 v1, s[12:15], s32 offen offset:3072 sc1 lds
s_add_u32 m0, s29, 32768
s_waitcnt lgkmcnt(4)
M v[64:67], a[148:151], a[180:183], 0
v_exp_f32 v136, v136
M v[64:67], a[152:155], a[184:187], v[64:67]
ds_read_b128 a[116:119], v6 offset:32768
ds_read_b128 a[120:123], v6 offset:40960
M v[64:67], a[156:159], a[188:191], v[64:67]
v_exp_f32 v137, v137
M v[64:67], a[160:163], a[192:195], v[64:67]
buffer_load_dwordx4 v1, s[12:15], s26 offen offset:0 sc1 lds
s_add_u32 s43, s26, 4096
M v[68:71], a[160:163], a[208:211], 0
v_exp_f32 v138, v138
M v[68:71], a[156:159], a[204:207], v[68:71]
v_cvt_pk_bf16_f32 v136, v136, v137
M v[68:71], a[152:155], a[200:203], v[68:71]
v_exp_f32 v139, v139
M v[68:71], a[148:151], a[196:199], v[68:71]
buffer_load_dwordx4 v1, s[12:15], s26 offen offset:1024 sc1 lds
M v[72:75], a[148:151], a[212:215], 0
M v[72:75], a[152:155], a[216:219], v[72:75]
ds_read_b128 a[124:127], v6 offset:33792
ds_read_b128 a[128:131], v6 offset:41984
M v[72:75], a[156:159], a[220:223], v[72:75]
M v[72:75], a[160:163], a[224:227], v[72:75]
buffer_load_dwordx4 v1, s[12:15], s26 offen offset:2048 sc1 lds
M v[76:79], a[160:163], a[240:243], 0
M v[76:79], a[156:159], a[236:239], v[76:79]
v_cvt_pk_bf16_f32 v137, v138, v139
v_mov_b32 v138, 0
M v[76:79], a[152:155], a[232:235], v[76:79]
M v[76:79], a[148:151], a[228:231], v[76:79]
buffer_load_dwordx4 v1, s[12:15], s26 offen offset:3072 sc1 lds
s_add_u32 m0, s29, 36864
s_waitcnt lgkmcnt(4)
M v[80:83], a[164:167], a[180:183], 0
v_exp_f32 v140, v140
M v[80:83], a[168:171], a[184:187], v[80:83]
ds_read_b128 a[132:135], v6 offset:34816
ds_read_b128 a[136:139], v6 offset:43008
M v[80:83], a[172:175], a[188:191], v[80:83]
v_exp_f32 v141, v141
M v[80:83], a[176:179], a[192:195], v[80:83]
buffer_load_dwordx4 v1, s[12:15], s43 offen offset:0 sc1 lds
M v[84:87], a[176:179], a[208:211], 0
v_exp_f32 v142, v142
M v[84:87], a[172:175], a[204:207], v[84:87]
v_mov_b32 v139, 0
v_cvt_pk_bf16_f32 v140, v140, v141
M v[84:87], a[168:171], a[200:203], v[84:87]
v_exp_f32 v143, v143
M v[84:87], a[164:167], a[196:199], v[84:87]
buffer_load_dwordx4 v1, s[12:15], s43 offen offset:1024 sc1 lds
M v[88:91], a[164:167], a[212:215], 0
v_exp_f32 v156, v156
M v[88:91], a[168:171], a[216:219], v[88:91]
ds_read_b128 a[140:143], v6 offset:35840
ds_read_b128 a[144:147], v6 offset:44032
M v[88:91], a[172:175], a[220:223], v[88:91]
v_exp_f32 v157, v157
M v[88:91], a[176:179], a[224:227], v[88:91]
buffer_load_dwordx4 v1, s[12:15], s43 offen offset:2048 sc1 lds
M v[92:95], a[176:179], a[240:243], 0
v_exp_f32 v158, v158
M v[92:95], a[172:175], a[236:239], v[92:95]
v_cvt_pk_bf16_f32 v141, v142, v143
v_cvt_pk_bf16_f32 v142, v156, v157
M v[92:95], a[168:171], a[232:235], v[92:95]
v_exp_f32 v159, v159
M v[92:95], a[164:167], a[228:231], v[92:95]
buffer_load_dwordx4 v1, s[12:15], s43 offen offset:3072 sc1 lds
v_cvt_pk_bf16_f32 v143, v158, v159
s_waitcnt lgkmcnt(6)
M v[160:163], a[116:119], v[96:99], v[160:163]
v_exp_f32 v32, v32
ds_read_b128 a[148:151], v6 offset:36864
ds_read_b128 a[152:155], v6 offset:45056
v_exp_f32 v33, v33
M v[164:167], a[116:119], v[100:103], v[164:167]
v_cvt_pk_bf16_f32 v32, v32, v33
M v[168:171], a[116:119], v[104:107], v[168:171]
v_exp_f32 v34, v34
M v[168:171], a[120:123], v[136:139], v[168:171]
s_add_u32 s25, s25, 32768
s_cmp_eq_u32 s25, s27
M v[172:175], a[120:123], v[140:143], v[172:175]
v_exp_f32 v35, v35
M v[172:175], a[116:119], v[108:111], v[172:175]
v_cvt_pk_bf16_f32 v33, v34, v35
s_waitcnt lgkmcnt(6)
M a[96:99], a[112:115], v[96:99], a[96:99]
s_cselect_b32 s25, s28, s25
s_cselect_b32 s27, -1, s27
s_add_u32 s26, s26, 32768
s_cmp_eq_u32 s26, s62
M v[176:179], a[124:127], v[96:99], v[176:179]
v_exp_f32 v48, v48
ds_read_b128 a[156:159], v6 offset:37888
ds_read_b128 a[160:163], v6 offset:46080
v_exp_f32 v49, v49
M v[180:183], a[124:127], v[100:103], v[180:183]
v_cvt_pk_bf16_f32 v34, v48, v49
M v[184:187], a[124:127], v[104:107], v[184:187]
v_exp_f32 v50, v50
M v[184:187], a[128:131], v[136:139], v[184:187]
s_cselect_b32 s26, s63, s26
s_cselect_b32 s62, -1, s62
M v[188:191], a[128:131], v[140:143], v[188:191]
v_exp_f32 v51, v51
M v[188:191], a[124:127], v[108:111], v[188:191]
v_cvt_pk_bf16_f32 v35, v50, v51
s_waitcnt lgkmcnt(6)
M a[100:103], a[112:115], v[100:103], a[100:103]
M v[192:195], a[132:135], v[96:99], v[192:195]
v_exp_f32 v36, v36
ds_read_b128 a[164:167], v6 offset:38912
ds_read_b128 a[168:171], v6 offset:47104
v_exp_f32 v37, v37
M v[196:199], a[132:135], v[100:103], v[196:199]
v_cvt_pk_bf16_f32 v36, v36, v37
M v[200:203], a[132:135], v[104:107], v[200:203]
v_exp_f32 v38, v38
M v[200:203], a[136:139], v[136:139], v[200:203]
M v[204:207], a[136:139], v[140:143], v[204:207]
v_exp_f32 v39, v39
M v[204:207], a[132:135], v[108:111], v[204:207]
v_cvt_pk_bf16_f32 v37, v38, v39
s_waitcnt lgkmcnt(6)
M a[104:107], a[112:115], v[104:107], a[104:107]
M a[104:107], a[112:115], v[136:139], a[104:107]
M v[208:211], a[140:143], v[96:99], v[208:211]
v_exp_f32 v52, v52
ds_read_b128 a[172:175], v6 offset:39936
ds_read_b128 a[176:179], v6 offset:48128
v_exp_f32 v53, v53
M v[212:215], a[140:143], v[100:103], v[212:215]
v_cvt_pk_bf16_f32 v38, v52, v53
M v[216:219], a[140:143], v[104:107], v[216:219]
v_exp_f32 v54, v54
M v[216:219], a[144:147], v[136:139], v[216:219]
M v[220:223], a[144:147], v[140:143], v[220:223]
v_exp_f32 v55, v55
M v[220:223], a[140:143], v[108:111], v[220:223]
v_cvt_pk_bf16_f32 v39, v54, v55
s_waitcnt lgkmcnt(6)
M a[108:111], a[112:115], v[108:111], a[108:111]
M a[108:111], a[112:115], v[140:143], a[108:111]
M v[224:227], a[148:151], v[96:99], v[224:227]
v_exp_f32 v40, v40
v_exp_f32 v41, v41
M v[228:231], a[148:151], v[100:103], v[228:231]
v_cvt_pk_bf16_f32 v40, v40, v41
M v[232:235], a[148:151], v[104:107], v[232:235]
v_exp_f32 v42, v42
M v[232:235], a[152:155], v[136:139], v[232:235]
M v[236:239], a[152:155], v[140:143], v[236:239]
v_exp_f32 v43, v43
M v[236:239], a[148:151], v[108:111], v[236:239]
v_cvt_pk_bf16_f32 v41, v42, v43
s_waitcnt lgkmcnt(4)
M v[240:243], a[156:159], v[96:99], v[240:243]
v_exp_f32 v56, v56
v_exp_f32 v57, v57
M v[244:247], a[156:159], v[100:103], v[244:247]
v_cvt_pk_bf16_f32 v42, v56, v57
M v[248:251], a[156:159], v[104:107], v[248:251]
v_exp_f32 v58, v58
M v[248:251], a[160:163], v[136:139], v[248:251]
s_waitcnt vmcnt(0) lgkmcnt(0)
s_barrier
ds_read_b128 a[116:119], v2 offset:0
ds_read_b128 a[120:123], v2 offset:1024
M v[252:255], a[160:163], v[140:143], v[252:255]
v_exp_f32 v59, v59
M v[252:255], a[156:159], v[108:111], v[252:255]
v_cvt_pk_bf16_f32 v43, v58, v59
M a[64:67], a[164:167], v[96:99], a[64:67]
v_exp_f32 v44, v44
ds_read_b128 a[124:127], v2 offset:2048
ds_read_b128 a[128:131], v2 offset:3072
v_exp_f32 v45, v45
M a[68:71], a[164:167], v[100:103], a[68:71]
v_cvt_pk_bf16_f32 v44, v44, v45
M a[72:75], a[164:167], v[104:107], a[72:75]
v_exp_f32 v46, v46
M a[72:75], a[168:171], v[136:139], a[72:75]
ds_read_b128 a[132:135], v2 offset:4096
ds_read_b128 a[136:139], v2 offset:5120
M a[76:79], a[168:171], v[140:143], a[76:79]
v_exp_f32 v47, v47
M a[76:79], a[164:167], v[108:111], a[76:79]
v_cvt_pk_bf16_f32 v45, v46, v47
M a[80:83], a[172:175], v[96:99], a[80:83]
v_exp_f32 v60, v60
ds_read_b128 a[140:143], v2 offset:6144
ds_read_b128 a[144:147], v2 offset:7168
v_exp_f32 v61, v61
M a[84:87], a[172:175], v[100:103], a[84:87]
v_cvt_pk_bf16_f32 v46, v60, v61
M a[88:91], a[172:175], v[104:107], a[88:91]
v_exp_f32 v62, v62
M a[88:91], a[176:179], v[136:139], a[88:91]
M a[92:95], a[176:179], v[140:143], a[92:95]
v_exp_f32 v63, v63
M a[92:95], a[172:175], v[108:111], a[92:95]
v_cvt_pk_bf16_f32 v47, v62, v63
Lk2_ea:
v_accvgpr_read_b32 v20, a96
v_accvgpr_read_b32 v21, a100
v_accvgpr_read_b32 v22, a104
v_accvgpr_read_b32 v23, a108
v_rcp_f32 v8, v20
v_rcp_f32 v9, v21
v_rcp_f32 v10, v22
v_rcp_f32 v11, v23
v_subrev_u32 v20, 0x21800000, v20
v_subrev_u32 v21, 0x21800000, v21
v_subrev_u32 v22, 0x21800000, v22
v_subrev_u32 v23, 0x21800000, v23
v_max_u32 v12, v20, v21
v_max3_u32 v12, v12, v22, v23
s_mov_b32 s64, 0x207
s_lshl_b32 s33, s21, 20
s_lshl_b32 s34, s20, 15
s_add_u32 s33, s33, s34
s_lshl_b32 s34, s23, 13
s_add_u32 s36, s33, s34
s_add_u32 s37, s36, 4096
s_add_u32 s38, s36, 16384
s_add_u32 s39, s36, 20480
v_pk_mul_f32 v[160:161], v[160:161], v[8:9] op_sel:[0,0] op_sel_hi:[1,0]
v_pk_mul_f32 v[162:163], v[162:163], v[8:9] op_sel:[0,0] op_sel_hi:[1,0]
v_pk_mul_f32 v[176:177], v[176:177], v[8:9] op_sel:[0,0] op_sel_hi:[1,0]
v_pk_mul_f32 v[178:179], v[178:179], v[8:9] op_sel:[0,0] op_sel_hi:[1,0]
v_cvt_pk_bf16_f32 v160, v160, v161
v_cvt_pk_bf16_f32 v161, v162, v163
v_cvt_pk_bf16_f32 v162, v176, v177
v_cvt_pk_bf16_f32 v163, v178, v179
s_nop 1
M v[24:27], a[112:115], v[160:163], 0
buffer_store_dwordx4 v[160:163], v1, s[16:19], s36 offen offset:0 sc1
v_pk_mul_f32 v[164:165], v[164:165], v[8:9] op_sel:[0,1] op_sel_hi:[1,1]
v_pk_mul_f32 v[166:167], v[166:167], v[8:9] op_sel:[0,1] op_sel_hi:[1,1]
v_pk_mul_f32 v[180:181], v[180:181], v[8:9] op_sel:[0,1] op_sel_hi:[1,1]
v_pk_mul_f32 v[182:183], v[182:183], v[8:9] op_sel:[0,1] op_sel_hi:[1,1]
v_cvt_pk_bf16_f32 v164, v164, v165
v_cvt_pk_bf16_f32 v165, v166, v167
v_cvt_pk_bf16_f32 v166, v180, v181
v_cvt_pk_bf16_f32 v167, v182, v183
s_nop 1
M v[24:27], a[112:115], v[164:167], v[24:27]
buffer_store_dwordx4 v[164:167], v1, s[16:19], s36 offen offset:2048 sc1
v_pk_mul_f32 v[168:169], v[168:169], v[10:11] op_sel:[0,0] op_sel_hi:[1,0]
v_pk_mul_f32 v[170:171], v[170:171], v[10:11] op_sel:[0,0] op_sel_hi:[1,0]
v_pk_mul_f32 v[184:185], v[184:185], v[10:11] op_sel:[0,0] op_sel_hi:[1,0]
v_pk_mul_f32 v[186:187], v[186:187], v[10:11] op_sel:[0,0] op_sel_hi:[1,0]
v_cvt_pk_bf16_f32 v168, v168, v169
v_cvt_pk_bf16_f32 v169, v170, v171
v_cvt_pk_bf16_f32 v170, v184, v185
v_cvt_pk_bf16_f32 v171, v186, v187
s_nop 1
M v[24:27], a[112:115], v[168:171], v[24:27]
buffer_store_dwordx4 v[168:171], v1, s[16:19], s37 offen offset:0 sc1
v_pk_mul_f32 v[172:173], v[172:173], v[10:11] op_sel:[0,1] op_sel_hi:[1,1]
v_pk_mul_f32 v[174:175], v[174:175], v[10:11] op_sel:[0,1] op_sel_hi:[1,1]
v_pk_mul_f32 v[188:189], v[188:189], v[10:11] op_sel:[0,1] op_sel_hi:[1,1]
v_pk_mul_f32 v[190:191], v[190:191], v[10:11] op_sel:[0,1] op_sel_hi:[1,1]
v_cvt_pk_bf16_f32 v172, v172, v173
v_cvt_pk_bf16_f32 v173, v174, v175
v_cvt_pk_bf16_f32 v174, v188, v189
v_cvt_pk_bf16_f32 v175, v190, v191
s_nop 1
M v[24:27], a[112:115], v[172:175], v[24:27]
buffer_store_dwordx4 v[172:175], v1, s[16:19], s37 offen offset:2048 sc1
v_pk_mul_f32 v[192:193], v[192:193], v[8:9] op_sel:[0,0] op_sel_hi:[1,0]
v_pk_mul_f32 v[194:195], v[194:195], v[8:9] op_sel:[0,0] op_sel_hi:[1,0]
v_pk_mul_f32 v[208:209], v[208:209], v[8:9] op_sel:[0,0] op_sel_hi:[1,0]
v_pk_mul_f32 v[210:211], v[210:211], v[8:9] op_sel:[0,0] op_sel_hi:[1,0]
v_cvt_pk_bf16_f32 v192, v192, v193
v_cvt_pk_bf16_f32 v193, v194, v195
v_cvt_pk_bf16_f32 v194, v208, v209
v_cvt_pk_bf16_f32 v195, v210, v211
s_nop 1
M v[24:27], a[112:115], v[192:195], v[24:27]
buffer_store_dwordx4 v[192:195], v1, s[16:19], s36 offen offset:1024 sc1
v_pk_mul_f32 v[196:197], v[196:197], v[8:9] op_sel:[0,1] op_sel_hi:[1,1]
v_pk_mul_f32 v[198:199], v[198:199], v[8:9] op_sel:[0,1] op_sel_hi:[1,1]
v_pk_mul_f32 v[212:213], v[212:213], v[8:9] op_sel:[0,1] op_sel_hi:[1,1]
v_pk_mul_f32 v[214:215], v[214:215], v[8:9] op_sel:[0,1] op_sel_hi:[1,1]
v_cvt_pk_bf16_f32 v196, v196, v197
v_cvt_pk_bf16_f32 v197, v198, v199
v_cvt_pk_bf16_f32 v198, v212, v213
v_cvt_pk_bf16_f32 v199, v214, v215
s_nop 1
M v[24:27], a[112:115], v[196:199], v[24:27]
buffer_store_dwordx4 v[196:199], v1, s[16:19], s36 offen offset:3072 sc1
v_pk_mul_f32 v[200:201], v[200:201], v[10:11] op_sel:[0,0] op_sel_hi:[1,0]
v_pk_mul_f32 v[202:203], v[202:203], v[10:11] op_sel:[0,0] op_sel_hi:[1,0]
v_pk_mul_f32 v[216:217], v[216:217], v[10:11] op_sel:[0,0] op_sel_hi:[1,0]
v_pk_mul_f32 v[218:219], v[218:219], v[10:11] op_sel:[0,0] op_sel_hi:[1,0]
v_cvt_pk_bf16_f32 v200, v200, v201
v_cvt_pk_bf16_f32 v201, v202, v203
v_cvt_pk_bf16_f32 v202, v216, v217
v_cvt_pk_bf16_f32 v203, v218, v219
s_nop 1
M v[24:27], a[112:115], v[200:203], v[24:27]
buffer_store_dwordx4 v[200:203], v1, s[16:19], s37 offen offset:1024 sc1
v_pk_mul_f32 v[204:205], v[204:205], v[10:11] op_sel:[0,1] op_sel_hi:[1,1]
v_pk_mul_f32 v[206:207], v[206:207], v[10:11] op_sel:[0,1] op_sel_hi:[1,1]
v_pk_mul_f32 v[220:221], v[220:221], v[10:11] op_sel:[0,1] op_sel_hi:[1,1]
v_pk_mul_f32 v[222:223], v[222:223], v[10:11] op_sel:[0,1] op_sel_hi:[1,1]
v_cvt_pk_bf16_f32 v204, v204, v205
v_cvt_pk_bf16_f32 v205, v206, v207
v_cvt_pk_bf16_f32 v206, v220, v221
v_cvt_pk_bf16_f32 v207, v222, v223
s_nop 1
M v[24:27], a[112:115], v[204:207], v[24:27]
buffer_store_dwordx4 v[204:207], v1, s[16:19], s37 offen offset:3072 sc1
v_pk_mul_f32 v[224:225], v[224:225], v[8:9] op_sel:[0,0] op_sel_hi:[1,0]
v_pk_mul_f32 v[226:227], v[226:227], v[8:9] op_sel:[0,0] op_sel_hi:[1,0]
v_pk_mul_f32 v[240:241], v[240:241], v[8:9] op_sel:[0,0] op_sel_hi:[1,0]
v_pk_mul_f32 v[242:243], v[242:243], v[8:9] op_sel:[0,0] op_sel_hi:[1,0]
v_cvt_pk_bf16_f32 v224, v224, v225
v_cvt_pk_bf16_f32 v225, v226, v227
v_cvt_pk_bf16_f32 v226, v240, v241
v_cvt_pk_bf16_f32 v227, v242, v243
s_nop 1
M v[24:27], a[112:115], v[224:227], v[24:27]
buffer_store_dwordx4 v[224:227], v1, s[16:19], s38 offen offset:0 sc1
v_pk_mul_f32 v[228:229], v[228:229], v[8:9] op_sel:[0,1] op_sel_hi:[1,1]
v_pk_mul_f32 v[230:231], v[230:231], v[8:9] op_sel:[0,1] op_sel_hi:[1,1]
v_pk_mul_f32 v[244:245], v[244:245], v[8:9] op_sel:[0,1] op_sel_hi:[1,1]
v_pk_mul_f32 v[246:247], v[246:247], v[8:9] op_sel:[0,1] op_sel_hi:[1,1]
v_cvt_pk_bf16_f32 v228, v228, v229
v_cvt_pk_bf16_f32 v229, v230, v231
v_cvt_pk_bf16_f32 v230, v244, v245
v_cvt_pk_bf16_f32 v231, v246, v247
s_nop 1
M v[24:27], a[112:115], v[228:231], v[24:27]
buffer_store_dwordx4 v[228:231], v1, s[16:19], s38 offen offset:2048 sc1
v_pk_mul_f32 v[232:233], v[232:233], v[10:11] op_sel:[0,0] op_sel_hi:[1,0]
v_pk_mul_f32 v[234:235], v[234:235], v[10:11] op_sel:[0,0] op_sel_hi:[1,0]
v_pk_mul_f32 v[248:249], v[248:249], v[10:11] op_sel:[0,0] op_sel_hi:[1,0]
v_pk_mul_f32 v[250:251], v[250:251], v[10:11] op_sel:[0,0] op_sel_hi:[1,0]
v_cvt_pk_bf16_f32 v232, v232, v233
v_cvt_pk_bf16_f32 v233, v234, v235
v_cvt_pk_bf16_f32 v234, v248, v249
v_cvt_pk_bf16_f32 v235, v250, v251
s_nop 1
M v[24:27], a[112:115], v[232:235], v[24:27]
buffer_store_dwordx4 v[232:235], v1, s[16:19], s39 offen offset:0 sc1
v_pk_mul_f32 v[236:237], v[236:237], v[10:11] op_sel:[0,1] op_sel_hi:[1,1]
v_pk_mul_f32 v[238:239], v[238:239], v[10:11] op_sel:[0,1] op_sel_hi:[1,1]
v_pk_mul_f32 v[252:253], v[252:253], v[10:11] op_sel:[0,1] op_sel_hi:[1,1]
v_pk_mul_f32 v[254:255], v[254:255], v[10:11] op_sel:[0,1] op_sel_hi:[1,1]
v_cvt_pk_bf16_f32 v236, v236, v237
v_cvt_pk_bf16_f32 v237, v238, v239
v_cvt_pk_bf16_f32 v238, v252, v253
v_cvt_pk_bf16_f32 v239, v254, v255
v_accvgpr_read_b32 v176, a64
v_accvgpr_read_b32 v177, a65
v_accvgpr_read_b32 v178, a66
v_accvgpr_read_b32 v179, a67
v_accvgpr_read_b32 v180, a80
v_accvgpr_read_b32 v181, a81
v_accvgpr_read_b32 v182, a82
v_accvgpr_read_b32 v183, a83
M v[24:27], a[112:115], v[236:239], v[24:27]
buffer_store_dwordx4 v[236:239], v1, s[16:19], s39 offen offset:2048 sc1
v_pk_mul_f32 v[176:177], v[176:177], v[8:9] op_sel:[0,0] op_sel_hi:[1,0]
v_pk_mul_f32 v[178:179], v[178:179], v[8:9] op_sel:[0,0] op_sel_hi:[1,0]
v_pk_mul_f32 v[180:181], v[180:181], v[8:9] op_sel:[0,0] op_sel_hi:[1,0]
v_pk_mul_f32 v[182:183], v[182:183], v[8:9] op_sel:[0,0] op_sel_hi:[1,0]
v_cvt_pk_bf16_f32 v176, v176, v177
v_cvt_pk_bf16_f32 v177, v178, v179
v_cvt_pk_bf16_f32 v178, v180, v181
v_cvt_pk_bf16_f32 v179, v182, v183
v_accvgpr_read_b32 v184, a68
v_accvgpr_read_b32 v185, a69
v_accvgpr_read_b32 v186, a70
v_accvgpr_read_b32 v187, a71
v_accvgpr_read_b32 v188, a84
v_accvgpr_read_b32 v189, a85
v_accvgpr_read_b32 v190, a86
v_accvgpr_read_b32 v191, a87
M v[24:27], a[112:115], v[176:179], v[24:27]
buffer_store_dwordx4 v[176:179], v1, s[16:19], s38 offen offset:1024 sc1
v_pk_mul_f32 v[184:185], v[184:185], v[8:9] op_sel:[0,1] op_sel_hi:[1,1]
v_pk_mul_f32 v[186:187], v[186:187], v[8:9] op_sel:[0,1] op_sel_hi:[1,1]
v_pk_mul_f32 v[188:189], v[188:189], v[8:9] op_sel:[0,1] op_sel_hi:[1,1]
v_pk_mul_f32 v[190:191], v[190:191], v[8:9] op_sel:[0,1] op_sel_hi:[1,1]
v_cvt_pk_bf16_f32 v184, v184, v185
v_cvt_pk_bf16_f32 v185, v186, v187
v_cvt_pk_bf16_f32 v186, v188, v189
v_cvt_pk_bf16_f32 v187, v190, v191
v_accvgpr_read_b32 v208, a72
v_accvgpr_read_b32 v209, a73
v_accvgpr_read_b32 v210, a74
v_accvgpr_read_b32 v211, a75
v_accvgpr_read_b32 v212, a88
v_accvgpr_read_b32 v213, a89
v_accvgpr_read_b32 v214, a90
v_accvgpr_read_b32 v215, a91
M v[24:27], a[112:115], v[184:187], v[24:27]
buffer_store_dwordx4 v[184:187], v1, s[16:19], s38 offen offset:3072 sc1
v_pk_mul_f32 v[208:209], v[208:209], v[10:11] op_sel:[0,0] op_sel_hi:[1,0]
v_pk_mul_f32 v[210:211], v[210:211], v[10:11] op_sel:[0,0] op_sel_hi:[1,0]
v_pk_mul_f32 v[212:213], v[212:213], v[10:11] op_sel:[0,0] op_sel_hi:[1,0]
v_pk_mul_f32 v[214:215], v[214:215], v[10:11] op_sel:[0,0] op_sel_hi:[1,0]
v_cvt_pk_bf16_f32 v208, v208, v209
v_cvt_pk_bf16_f32 v209, v210, v211
v_cvt_pk_bf16_f32 v210, v212, v213
v_cvt_pk_bf16_f32 v211, v214, v215
v_accvgpr_read_b32 v216, a76
v_accvgpr_read_b32 v217, a77
v_accvgpr_read_b32 v218, a78
v_accvgpr_read_b32 v219, a79
v_accvgpr_read_b32 v220, a92
v_accvgpr_read_b32 v221, a93
v_accvgpr_read_b32 v222, a94
v_accvgpr_read_b32 v223, a95
M v[24:27], a[112:115], v[208:211], v[24:27]
buffer_store_dwordx4 v[208:211], v1, s[16:19], s39 offen offset:1024 sc1
v_pk_mul_f32 v[216:217], v[216:217], v[10:11] op_sel:[0,1] op_sel_hi:[1,1]
v_pk_mul_f32 v[218:219], v[218:219], v[10:11] op_sel:[0,1] op_sel_hi:[1,1]
v_pk_mul_f32 v[220:221], v[220:221], v[10:11] op_sel:[0,1] op_sel_hi:[1,1]
v_pk_mul_f32 v[222:223], v[222:223], v[10:11] op_sel:[0,1] op_sel_hi:[1,1]
v_cvt_pk_bf16_f32 v216, v216, v217
v_cvt_pk_bf16_f32 v217, v218, v219
v_cvt_pk_bf16_f32 v218, v220, v221
v_cvt_pk_bf16_f32 v219, v222, v223
s_nop 1
M v[24:27], a[112:115], v[216:219], v[24:27]
buffer_store_dwordx4 v[216:219], v1, s[16:19], s39 offen offset:3072 sc1
v_cmp_lt_u32 vcc, 0x3c000000, v12
s_nop 5
v_cmp_class_f32 s[40:41], v24, s64
s_nop 0
s_or_b64 vcc, vcc, s[40:41]
s_cmp_lg_u64 vcc, 0
s_cselect_b32 s33, 1, 0
s_or_b32 s60, s60, s33
s_sub_u32 s30, 7, s21
s_cmp_lg_u32 s30, 0
s_cbranch_scc1 Lk2_b0
s_and_b32 s3, s2, 3
s_lshl_b32 s3, s3, 2
s_bfe_u32 s27, s2, 0x20003
s_add_u32 s27, s3, s27
s_lshl_b32 s43, s27, 8
s_add_u32 s43, s43, 16789504
v_lshlrev_b32 v15, 2, v0
buffer_load_dword v7, v15, s[52:55], s43 offen sc1
s_waitcnt lgkmcnt(7)
ds_read_b128 a[116:119], v5 offset:36864
s_waitcnt lgkmcnt(7)
ds_read_b128 a[120:123], v5 offset:45056
s_waitcnt lgkmcnt(7)
ds_read_b128 a[124:127], v5 offset:37888
s_waitcnt lgkmcnt(7)
ds_read_b128 a[128:131], v5 offset:46080
s_waitcnt lgkmcnt(7)
ds_read_b128 a[132:135], v5 offset:38912
s_waitcnt lgkmcnt(7)
ds_read_b128 a[136:139], v5 offset:47104
s_waitcnt lgkmcnt(7)
ds_read_b128 a[140:143], v5 offset:39936
s_waitcnt lgkmcnt(7)
ds_read_b128 a[144:147], v5 offset:48128
s_lshl_b32 s33, s23, 14
s_add_u32 s34, s33, 98304
s_add_u32 s33, s33, 131072
v_add_u32 v2, s34, v1
v_add_u32 v3, s33, v1
v_exp_f32 v64, v64
v_exp_f32 v65, v65
v_exp_f32 v66, v66
v_exp_f32 v67, v67
v_exp_f32 v80, v80
v_exp_f32 v81, v81
v_exp_f32 v82, v82
v_exp_f32 v83, v83
v_cvt_pk_bf16_f32 v64, v64, v65
v_cvt_pk_bf16_f32 v65, v66, v67
v_exp_f32 v68, v68
v_exp_f32 v69, v69
v_exp_f32 v70, v70
v_exp_f32 v71, v71
v_cvt_pk_bf16_f32 v66, v80, v81
v_cvt_pk_bf16_f32 v67, v82, v83
v_exp_f32 v84, v84
v_exp_f32 v85, v85
v_exp_f32 v86, v86
v_exp_f32 v87, v87
v_cvt_pk_bf16_f32 v68, v68, v69
v_cvt_pk_bf16_f32 v69, v70, v71
v_exp_f32 v72, v72
v_exp_f32 v73, v73
v_exp_f32 v74, v74
v_exp_f32 v75, v75
v_cvt_pk_bf16_f32 v70, v84, v85
v_cvt_pk_bf16_f32 v71, v86, v87
v_exp_f32 v88, v88
v_exp_f32 v89, v89
v_exp_f32 v90, v90
v_exp_f32 v91, v91
v_cvt_pk_bf16_f32 v72, v72, v73
v_cvt_pk_bf16_f32 v73, v74, v75
v_exp_f32 v76, v76
v_exp_f32 v77, v77
v_exp_f32 v78, v78
v_exp_f32 v79, v79
v_cvt_pk_bf16_f32 v74, v88, v89
v_cvt_pk_bf16_f32 v75, v90, v91
v_exp_f32 v92, v92
v_exp_f32 v93, v93
v_exp_f32 v94, v94
v_exp_f32 v95, v95
v_cvt_pk_bf16_f32 v76, v76, v77
v_cvt_pk_bf16_f32 v77, v78, v79
v_cvt_pk_bf16_f32 v78, v92, v93
v_cvt_pk_bf16_f32 v79, v94, v95
s_waitcnt lgkmcnt(6)
M v[224:227], a[116:119], v[32:35], 0
M v[224:227], a[120:123], v[64:67], v[224:227]
ds_read_b128 a[148:151], v5 offset:32768
ds_read_b128 a[152:155], v5 offset:40960
s_mov_b32 s61, 0
M v[228:231], a[120:123], v[68:71], 0
M v[228:231], a[116:119], v[36:39], v[228:231]
s_bfe_u32 s3, s2, 0x10002
M v[232:235], a[116:119], v[40:43], 0
M v[232:235], a[120:123], v[72:75], v[232:235]
s_lshl_b32 s3, s3, 3
M v[236:239], a[120:123], v[76:79], 0
M v[236:239], a[116:119], v[44:47], v[236:239]
s_waitcnt lgkmcnt(6)
s_lshr_b32 s28, s2, 5
M a[96:99], a[112:115], v[32:35], 0
M a[96:99], a[112:115], v[64:67], a[96:99]
M v[240:243], a[124:127], v[32:35], 0
M v[240:243], a[128:131], v[64:67], v[240:243]
ds_read_b128 a[156:159], v5 offset:33792
ds_read_b128 a[160:163], v5 offset:41984
s_add_u32 s28, s3, s28
M v[244:247], a[128:131], v[68:71], 0
s_lshl_b32 s25, s27, 18
M v[244:247], a[124:127], v[36:39], v[244:247]
M v[248:251], a[124:127], v[40:43], 0
s_lshl_b32 s3, s101, 12
M v[248:251], a[128:131], v[72:75], v[248:251]
M v[252:255], a[128:131], v[76:79], 0
s_add_u32 s25, s25, s3
M v[252:255], a[124:127], v[44:47], v[252:255]
s_waitcnt lgkmcnt(6)
M a[100:103], a[112:115], v[36:39], 0
M a[100:103], a[112:115], v[68:71], a[100:103]
M a[64:67], a[132:135], v[32:35], 0
s_lshl_b32 s26, s28, 7
M a[64:67], a[136:139], v[64:67], a[64:67]
ds_read_b128 a[164:167], v5 offset:34816
ds_read_b128 a[168:171], v5 offset:43008
M a[68:71], a[136:139], v[68:71], 0
s_lshl_b32 s42, s101, 11
M a[68:71], a[132:135], v[36:39], a[68:71]
M a[72:75], a[132:135], v[40:43], 0
s_add_u32 s44, s4, 83886080
s_addc_u32 s45, s5, 0
M a[72:75], a[136:139], v[72:75], a[72:75]
s_mov_b32 s46, 4194304
M a[76:79], a[136:139], v[76:79], 0
M a[76:79], a[132:135], v[44:47], a[76:79]
s_waitcnt lgkmcnt(6)
s_mov_b32 s47, 0x00020000
M a[104:107], a[112:115], v[40:43], 0
M a[104:107], a[112:115], v[72:75], a[104:107]
M a[80:83], a[140:143], v[32:35], 0
M a[80:83], a[144:147], v[64:67], a[80:83]
ds_read_b128 a[172:175], v5 offset:35840
ds_read_b128 a[176:179], v5 offset:44032
s_mov_b32 s50, 2097152
M a[84:87], a[144:147], v[68:71], 0
M a[84:87], a[140:143], v[36:39], a[84:87]
s_mov_b32 s51, 0x00020000
M a[88:91], a[140:143], v[40:43], 0
M a[88:91], a[144:147], v[72:75], a[88:91]
s_lshl_b32 s3, s101, 4
M a[92:95], a[144:147], v[76:79], 0
M a[92:95], a[140:143], v[44:47], a[92:95]
s_waitcnt lgkmcnt(6)
v_lshrrev_b32 v96, 3, v0
M a[108:111], a[112:115], v[44:47], 0
M a[108:111], a[112:115], v[76:79], a[108:111]
M v[160:163], a[148:151], v[32:35], 0
v_and_b32 v97, 6, v96
M v[160:163], a[152:155], v[64:67], v[160:163]
M v[164:167], a[152:155], v[68:71], 0
ds_write_b128 v2, v[224:227] offset:0
v_and_b32 v98, 7, v0
M v[164:167], a[148:151], v[36:39], v[164:167]
M v[168:171], a[148:151], v[40:43], 0
ds_write_b128 v2, v[228:231] offset:1024
v_xor_b32 v97, v97, v98
M v[168:171], a[152:155], v[72:75], v[168:171]
M v[172:175], a[152:155], v[76:79], 0
ds_write_b128 v2, v[232:235] offset:2048
v_add_u32 v96, s3, v96
M v[172:175], a[148:151], v[44:47], v[172:175]
s_waitcnt lgkmcnt(7)
M v[176:179], a[156:159], v[32:35], 0
ds_write_b128 v2, v[236:239] offset:3072
v_lshlrev_b32 v96, 11, v96
M v[176:179], a[160:163], v[64:67], v[176:179]
M v[180:183], a[160:163], v[68:71], 0
ds_write_b128 v2, v[240:243] offset:4096
v_lshl_add_u32 v99, v97, 4, v96
M v[180:183], a[156:159], v[36:39], v[180:183]
v_add_u32 v100, 15360, v99
M v[184:187], a[156:159], v[40:43], 0
ds_write_b128 v2, v[244:247] offset:5120
M v[184:187], a[160:163], v[72:75], v[184:187]
s_waitcnt vmcnt(0) lgkmcnt(0)
s_barrier
M v[188:191], a[160:163], v[76:79], 0
ds_write_b128 v2, v[248:251] offset:6144
v_cmp_ne_u32 vcc, 1, v7
s_nop 0
s_cbranch_vccnz Lk3_spinb0
Lk3_gotb0:
M v[188:191], a[156:159], v[44:47], v[188:191]
s_add_u32 m0, s42, 16384
s_nop 0
buffer_load_dwordx4 v99, s[48:51], s26 offen offset:0 lds
M v[192:195], a[164:167], v[32:35], 0
ds_write_b128 v2, v[252:255] offset:7168
buffer_load_dwordx4 v100, s[48:51], s26 offen offset:1024 lds
M v[192:195], a[168:171], v[64:67], v[192:195]
M v[196:199], a[168:171], v[68:71], 0
ds_write_b128 v2, a[64:67] offset:8192
buffer_load_dwordx4 a[192:195], v1, s[44:47], s25 offen offset:0 sc1
M v[196:199], a[164:167], v[36:39], v[196:199]
buffer_load_dwordx4 a[196:199], v1, s[44:47], s25 offen offset:1024 sc1
M v[200:203], a[164:167], v[40:43], 0
ds_write_b128 v2, a[68:71] offset:9216
buffer_load_dwordx4 a[200:203], v1, s[44:47], s25 offen offset:2048 sc1
M v[200:203], a[168:171], v[72:75], v[200:203]
buffer_load_dwordx4 a[204:207], v1, s[44:47], s25 offen offset:3072 sc1
M v[204:207], a[168:171], v[76:79], 0
ds_write_b128 v2, a[72:75] offset:10240
M v[204:207], a[164:167], v[44:47], v[204:207]
s_add_u32 s25, s25, 16384
s_add_u32 s26, s26, 131072
M v[208:211], a[172:175], v[32:35], 0
ds_write_b128 v2, a[76:79] offset:11264
s_add_u32 m0, s42, 32768
s_nop 0
buffer_load_dwordx4 v99, s[48:51], s26 offen offset:0 lds
M v[208:211], a[176:179], v[64:67], v[208:211]
buffer_load_dwordx4 v100, s[48:51], s26 offen offset:1024 lds
M v[212:215], a[176:179], v[68:71], 0
ds_write_b128 v2, a[80:83] offset:12288
buffer_load_dwordx4 a[224:227], v1, s[44:47], s25 offen offset:0 sc1
M v[212:215], a[172:175], v[36:39], v[212:215]
M v[216:219], a[172:175], v[40:43], 0
ds_write_b128 v2, a[84:87] offset:13312
buffer_load_dwordx4 a[228:231], v1, s[44:47], s25 offen offset:1024 sc1
M v[216:219], a[176:179], v[72:75], v[216:219]
buffer_load_dwordx4 a[232:235], v1, s[44:47], s25 offen offset:2048 sc1
M v[220:223], a[176:179], v[76:79], 0
ds_write_b128 v2, a[88:91] offset:14336
buffer_load_dwordx4 a[236:239], v1, s[44:47], s25 offen offset:3072 sc1
M v[220:223], a[172:175], v[44:47], v[220:223]
s_add_u32 s25, s25, 16384
s_add_u32 s26, s26, 131072
ds_write_b128 v2, a[92:95] offset:15360
s_waitcnt lgkmcnt(0)
s_branch Lk2_merge
Lk2_b0:
s_add_u32 m0, s29, 65536
s_waitcnt lgkmcnt(4)
M v[96:99], a[116:119], a[180:183], 0
v_exp_f32 v64, v64
M v[96:99], a[120:123], a[184:187], v[96:99]
ds_read_b128 a[148:151], v2 offset:8192
ds_read_b128 a[152:155], v2 offset:9216
M v[96:99], a[124:127], a[188:191], v[96:99]
v_exp_f32 v65, v65
M v[96:99], a[128:131], a[192:195], v[96:99]
buffer_load_dwordx4 v1, s[12:15], s25 offen offset:0 sc1 lds
s_add_u32 s32, s25, 4096
M v[100:103], a[128:131], a[208:211], 0
v_exp_f32 v66, v66
M v[100:103], a[124:127], a[204:207], v[100:103]
v_cvt_pk_bf16_f32 v64, v64, v65
M v[100:103], a[120:123], a[200:203], v[100:103]
v_exp_f32 v67, v67
M v[100:103], a[116:119], a[196:199], v[100:103]
buffer_load_dwordx4 v1, s[12:15], s25 offen offset:1024 sc1 lds
M v[104:107], a[116:119], a[212:215], 0
v_exp_f32 v80, v80
M v[104:107], a[120:123], a[216:219], v[104:107]
ds_read_b128 a[156:159], v2 offset:10240
ds_read_b128 a[160:163], v2 offset:11264
M v[104:107], a[124:127], a[220:223], v[104:107]
v_exp_f32 v81, v81
M v[104:107], a[128:131], a[224:227], v[104:107]
buffer_load_dwordx4 v1, s[12:15], s25 offen offset:2048 sc1 lds
M v[108:111], a[128:131], a[240:243], 0
v_exp_f32 v82, v82
M v[108:111], a[124:127], a[236:239], v[108:111]
v_cvt_pk_bf16_f32 v65, v66, v67
v_cvt_pk_bf16_f32 v66, v80, v81
M v[108:111], a[120:123], a[232:235], v[108:111]
v_exp_f32 v83, v83
M v[108:111], a[116:119], a[228:231], v[108:111]
buffer_load_dwordx4 v1, s[12:15], s25 offen offset:3072 sc1 lds
s_add_u32 m0, s29, 69632
s_waitcnt lgkmcnt(4)
M v[112:115], a[132:135], a[180:183], 0
v_exp_f32 v68, v68
M v[112:115], a[136:139], a[184:187], v[112:115]
ds_read_b128 a[164:167], v2 offset:12288
ds_read_b128 a[168:171], v2 offset:13312
M v[112:115], a[140:143], a[188:191], v[112:115]
v_exp_f32 v69, v69
M v[112:115], a[144:147], a[192:195], v[112:115]
buffer_load_dwordx4 v1, s[12:15], s32 offen offset:0 sc1 lds
M v[116:119], a[144:147], a[208:211], 0
v_exp_f32 v70, v70
M v[116:119], a[140:143], a[204:207], v[116:119]
v_cvt_pk_bf16_f32 v67, v82, v83
v_cvt_pk_bf16_f32 v68, v68, v69
M v[116:119], a[136:139], a[200:203], v[116:119]
v_exp_f32 v71, v71
M v[116:119], a[132:135], a[196:199], v[116:119]
buffer_load_dwordx4 v1, s[12:15], s32 offen offset:1024 sc1 lds
M v[120:123], a[132:135], a[212:215], 0
v_exp_f32 v84, v84
M v[120:123], a[136:139], a[216:219], v[120:123]
ds_read_b128 a[172:175], v2 offset:14336
ds_read_b128 a[176:179], v2 offset:15360
M v[120:123], a[140:143], a[220:223], v[120:123]
v_exp_f32 v85, v85
M v[120:123], a[144:147], a[224:227], v[120:123]
buffer_load_dwordx4 v1, s[12:15], s32 offen offset:2048 sc1 lds
M v[124:127], a[144:147], a[240:243], 0
v_exp_f32 v86, v86
M v[124:127], a[140:143], a[236:239], v[124:127]
v_cvt_pk_bf16_f32 v69, v70, v71
v_cvt_pk_bf16_f32 v70, v84, v85
M v[124:127], a[136:139], a[232:235], v[124:127]
v_exp_f32 v87, v87
M v[124:127], a[132:135], a[228:231], v[124:127]
buffer_load_dwordx4 v1, s[12:15], s32 offen offset:3072 sc1 lds
s_add_u32 m0, s29, 98304
s_waitcnt lgkmcnt(4)
M v[128:131], a[148:151], a[180:183], 0
v_exp_f32 v72, v72
M v[128:131], a[152:155], a[184:187], v[128:131]
ds_read_b128 a[116:119], v5 offset:32768
ds_read_b128 a[120:123], v5 offset:40960
M v[128:131], a[156:159], a[188:191], v[128:131]
v_exp_f32 v73, v73
M v[128:131], a[160:163], a[192:195], v[128:131]
buffer_load_dwordx4 v1, s[12:15], s26 offen offset:0 sc1 lds
s_add_u32 s43, s26, 4096
M v[132:135], a[160:163], a[208:211], 0
v_exp_f32 v74, v74
M v[132:135], a[156:159], a[204:207], v[132:135]
v_cvt_pk_bf16_f32 v71, v86, v87
v_cvt_pk_bf16_f32 v72, v72, v73
M v[132:135], a[152:155], a[200:203], v[132:135]
v_exp_f32 v75, v75
M v[132:135], a[148:151], a[196:199], v[132:135]
buffer_load_dwordx4 v1, s[12:15], s26 offen offset:1024 sc1 lds
M v[136:139], a[148:151], a[212:215], 0
v_exp_f32 v88, v88
M v[136:139], a[152:155], a[216:219], v[136:139]
ds_read_b128 a[124:127], v5 offset:33792
ds_read_b128 a[128:131], v5 offset:41984
M v[136:139], a[156:159], a[220:223], v[136:139]
v_exp_f32 v89, v89
M v[136:139], a[160:163], a[224:227], v[136:139]
buffer_load_dwordx4 v1, s[12:15], s26 offen offset:2048 sc1 lds
M v[140:143], a[160:163], a[240:243], 0
v_exp_f32 v90, v90
M v[140:143], a[156:159], a[236:239], v[140:143]
v_cvt_pk_bf16_f32 v73, v74, v75
v_cvt_pk_bf16_f32 v74, v88, v89
M v[140:143], a[152:155], a[232:235], v[140:143]
v_exp_f32 v91, v91
M v[140:143], a[148:151], a[228:231], v[140:143]
buffer_load_dwordx4 v1, s[12:15], s26 offen offset:3072 sc1 lds
s_add_u32 m0, s29, 102400
s_waitcnt lgkmcnt(4)
M v[144:147], a[164:167], a[180:183], 0
v_exp_f32 v76, v76
M v[144:147], a[168:171], a[184:187], v[144:147]
ds_read_b128 a[132:135], v5 offset:34816
ds_read_b128 a[136:139], v5 offset:43008
M v[144:147], a[172:175], a[188:191], v[144:147]
v_exp_f32 v77, v77
M v[144:147], a[176:179], a[192:195], v[144:147]
buffer_load_dwordx4 v1, s[12:15], s43 offen offset:0 sc1 lds
M v[148:151], a[176:179], a[208:211], 0
v_exp_f32 v78, v78
M v[148:151], a[172:175], a[204:207], v[148:151]
v_cvt_pk_bf16_f32 v75, v90, v91
v_cvt_pk_bf16_f32 v76, v76, v77
M v[148:151], a[168:171], a[200:203], v[148:151]
v_exp_f32 v79, v79
M v[148:151], a[164:167], a[196:199], v[148:151]
buffer_load_dwordx4 v1, s[12:15], s43 offen offset:1024 sc1 lds
M v[152:155], a[164:167], a[212:215], 0
v_exp_f32 v92, v92
M v[152:155], a[168:171], a[216:219], v[152:155]
ds_read_b128 a[140:143], v5 offset:35840
ds_read_b128 a[144:147], v5 offset:44032
M v[152:155], a[172:175], a[220:223], v[152:155]
v_exp_f32 v93, v93
M v[152:155], a[176:179], a[224:227], v[152:155]
buffer_load_dwordx4 v1, s[12:15], s43 offen offset:2048 sc1 lds
M v[156:159], a[176:179], a[240:243], 0
v_exp_f32 v94, v94
M v[156:159], a[172:175], a[236:239], v[156:159]
v_cvt_pk_bf16_f32 v77, v78, v79
v_cvt_pk_bf16_f32 v78, v92, v93
M v[156:159], a[168:171], a[232:235], v[156:159]
v_exp_f32 v95, v95
M v[156:159], a[164:167], a[228:231], v[156:159]
buffer_load_dwordx4 v1, s[12:15], s43 offen offset:3072 sc1 lds
v_cvt_pk_bf16_f32 v79, v94, v95
s_waitcnt lgkmcnt(6)
M v[160:163], a[116:119], v[32:35], 0
v_exp_f32 v96, v96
M v[160:163], a[120:123], v[64:67], v[160:163]
ds_read_b128 a[148:151], v5 offset:36864
ds_read_b128 a[152:155], v5 offset:45056
M v[164:167], a[120:123], v[68:71], 0
v_exp_f32 v97, v97
M v[164:167], a[116:119], v[36:39], v[164:167]
v_cvt_pk_bf16_f32 v96, v96, v97
M v[168:171], a[116:119], v[40:43], 0
v_exp_f32 v98, v98
M v[168:171], a[120:123], v[72:75], v[168:171]
s_add_u32 s25, s25, 32768
s_cmp_eq_u32 s25, s27
M v[172:175], a[120:123], v[76:79], 0
v_exp_f32 v99, v99
M v[172:175], a[116:119], v[44:47], v[172:175]
v_cvt_pk_bf16_f32 v97, v98, v99
s_waitcnt lgkmcnt(6)
M a[96:99], a[112:115], v[32:35], 0
s_cselect_b32 s25, s28, s25
s_cselect_b32 s27, -1, s27
M a[96:99], a[112:115], v[64:67], a[96:99]
s_add_u32 s26, s26, 32768
s_cmp_eq_u32 s26, s62
M v[176:179], a[124:127], v[32:35], 0
v_exp_f32 v112, v112
M v[176:179], a[128:131], v[64:67], v[176:179]
ds_read_b128 a[156:159], v5 offset:37888
ds_read_b128 a[160:163], v5 offset:46080
M v[180:183], a[128:131], v[68:71], 0
v_exp_f32 v113, v113
M v[180:183], a[124:127], v[36:39], v[180:183]
v_cvt_pk_bf16_f32 v98, v112, v113
M v[184:187], a[124:127], v[40:43], 0
v_exp_f32 v114, v114
M v[184:187], a[128:131], v[72:75], v[184:187]
s_cselect_b32 s26, s63, s26
s_cselect_b32 s62, -1, s62
M v[188:191], a[128:131], v[76:79], 0
v_exp_f32 v115, v115
M v[188:191], a[124:127], v[44:47], v[188:191]
v_cvt_pk_bf16_f32 v99, v114, v115
s_waitcnt lgkmcnt(6)
M a[100:103], a[112:115], v[36:39], 0
M a[100:103], a[112:115], v[68:71], a[100:103]
M v[192:195], a[132:135], v[32:35], 0
v_exp_f32 v100, v100
M v[192:195], a[136:139], v[64:67], v[192:195]
ds_read_b128 a[164:167], v5 offset:38912
ds_read_b128 a[168:171], v5 offset:47104
M v[196:199], a[136:139], v[68:71], 0
v_exp_f32 v101, v101
M v[196:199], a[132:135], v[36:39], v[196:199]
v_cvt_pk_bf16_f32 v100, v100, v101
M v[200:203], a[132:135], v[40:43], 0
v_exp_f32 v102, v102
M v[200:203], a[136:139], v[72:75], v[200:203]
M v[204:207], a[136:139], v[76:79], 0
v_exp_f32 v103, v103
M v[204:207], a[132:135], v[44:47], v[204:207]
v_cvt_pk_bf16_f32 v101, v102, v103
s_waitcnt lgkmcnt(6)
M a[104:107], a[112:115], v[40:43], 0
M a[104:107], a[112:115], v[72:75], a[104:107]
M v[208:211], a[140:143], v[32:35], 0
v_exp_f32 v116, v116
M v[208:211], a[144:147], v[64:67], v[208:211]
ds_read_b128 a[172:175], v5 offset:39936
ds_read_b128 a[176:179], v5 offset:48128
M v[212:215], a[144:147], v[68:71], 0
v_exp_f32 v117, v117
M v[212:215], a[140:143], v[36:39], v[212:215]
v_cvt_pk_bf16_f32 v102, v116, v117
M v[216:219], a[140:143], v[40:43], 0
v_exp_f32 v118, v118
M v[216:219], a[144:147], v[72:75], v[216:219]
M v[220:223], a[144:147], v[76:79], 0
v_exp_f32 v119, v119
M v[220:223], a[140:143], v[44:47], v[220:223]
v_cvt_pk_bf16_f32 v103, v118, v119
s_waitcnt lgkmcnt(6)
M a[108:111], a[112:115], v[44:47], 0
M a[108:111], a[112:115], v[76:79], a[108:111]
M v[224:227], a[148:151], v[32:35], 0
v_exp_f32 v104, v104
M v[224:227], a[152:155], v[64:67], v[224:227]
M v[228:231], a[152:155], v[68:71], 0
v_exp_f32 v105, v105
M v[228:231], a[148:151], v[36:39], v[228:231]
v_cvt_pk_bf16_f32 v104, v104, v105
M v[232:235], a[148:151], v[40:43], 0
v_exp_f32 v106, v106
M v[232:235], a[152:155], v[72:75], v[232:235]
M v[236:239], a[152:155], v[76:79], 0
v_exp_f32 v107, v107
M v[236:239], a[148:151], v[44:47], v[236:239]
v_cvt_pk_bf16_f32 v105, v106, v107
s_waitcnt lgkmcnt(4)
M v[240:243], a[156:159], v[32:35], 0
v_exp_f32 v120, v120
M v[240:243], a[160:163], v[64:67], v[240:243]
M v[244:247], a[160:163], v[68:71], 0
v_exp_f32 v121, v121
M v[244:247], a[156:159], v[36:39], v[244:247]
v_cvt_pk_bf16_f32 v106, v120, v121
M v[248:251], a[156:159], v[40:43], 0
v_exp_f32 v122, v122
M v[248:251], a[160:163], v[72:75], v[248:251]
s_waitcnt vmcnt(0) lgkmcnt(0)
s_barrier
ds_read_b128 a[116:119], v3 offset:0
ds_read_b128 a[120:123], v3 offset:1024
M v[252:255], a[160:163], v[76:79], 0
v_exp_f32 v123, v123
M v[252:255], a[156:159], v[44:47], v[252:255]
v_cvt_pk_bf16_f32 v107, v122, v123
M a[64:67], a[164:167], v[32:35], 0
v_exp_f32 v108, v108
M a[64:67], a[168:171], v[64:67], a[64:67]
ds_read_b128 a[124:127], v3 offset:2048
ds_read_b128 a[128:131], v3 offset:3072
M a[68:71], a[168:171], v[68:71], 0
v_exp_f32 v109, v109
M a[68:71], a[164:167], v[36:39], a[68:71]
v_cvt_pk_bf16_f32 v108, v108, v109
M a[72:75], a[164:167], v[40:43], 0
v_exp_f32 v110, v110
M a[72:75], a[168:171], v[72:75], a[72:75]
ds_read_b128 a[132:135], v3 offset:4096
ds_read_b128 a[136:139], v3 offset:5120
M a[76:79], a[168:171], v[76:79], 0
v_exp_f32 v111, v111
M a[76:79], a[164:167], v[44:47], a[76:79]
v_cvt_pk_bf16_f32 v109, v110, v111
M a[80:83], a[172:175], v[32:35], 0
v_exp_f32 v124, v124
M a[80:83], a[176:179], v[64:67], a[80:83]
ds_read_b128 a[140:143], v3 offset:6144
ds_read_b128 a[144:147], v3 offset:7168
M a[84:87], a[176:179], v[68:71], 0
v_exp_f32 v125, v125
M a[84:87], a[172:175], v[36:39], a[84:87]
v_cvt_pk_bf16_f32 v110, v124, v125
M a[88:91], a[172:175], v[40:43], 0
v_exp_f32 v126, v126
M a[88:91], a[176:179], v[72:75], a[88:91]
M a[92:95], a[176:179], v[76:79], 0
v_exp_f32 v127, v127
M a[92:95], a[172:175], v[44:47], a[92:95]
v_cvt_pk_bf16_f32 v111, v126, v127
s_branch Lk2_l2b
Lk2_l2:
s_add_u32 m0, s29, 65536
s_waitcnt lgkmcnt(4)
M v[96:99], a[116:119], a[180:183], 0
v_exp_f32 v64, v64
M v[96:99], a[120:123], a[184:187], v[96:99]
ds_read_b128 a[148:151], v2 offset:8192
ds_read_b128 a[152:155], v2 offset:9216
M v[96:99], a[124:127], a[188:191], v[96:99]
v_exp_f32 v65, v65
M v[96:99], a[128:131], a[192:195], v[96:99]
buffer_load_dwordx4 v1, s[12:15], s25 offen offset:0 sc1 lds
s_add_u32 s32, s25, 4096
M v[100:103], a[128:131], a[208:211], 0
v_exp_f32 v66, v66
M v[100:103], a[124:127], a[204:207], v[100:103]
v_cvt_pk_bf16_f32 v64, v64, v65
M v[100:103], a[120:123], a[200:203], v[100:103]
v_exp_f32 v67, v67
M v[100:103], a[116:119], a[196:199], v[100:103]
buffer_load_dwordx4 v1, s[12:15], s25 offen offset:1024 sc1 lds
M v[104:107], a[116:119], a[212:215], 0
v_exp_f32 v80, v80
M v[104:107], a[120:123], a[216:219], v[104:107]
ds_read_b128 a[156:159], v2 offset:10240
ds_read_b128 a[160:163], v2 offset:11264
M v[104:107], a[124:127], a[220:223], v[104:107]
v_exp_f32 v81, v81
M v[104:107], a[128:131], a[224:227], v[104:107]
buffer_load_dwordx4 v1, s[12:15], s25 offen offset:2048 sc1 lds
M v[108:111], a[128:131], a[240:243], 0
v_exp_f32 v82, v82
M v[108:111], a[124:127], a[236:239], v[108:111]
v_cvt_pk_bf16_f32 v65, v66, v67
v_cvt_pk_bf16_f32 v66, v80, v81
M v[108:111], a[120:123], a[232:235], v[108:111]
v_exp_f32 v83, v83
M v[108:111], a[116:119], a[228:231], v[108:111]
buffer_load_dwordx4 v1, s[12:15], s25 offen offset:3072 sc1 lds
s_add_u32 m0, s29, 69632
s_waitcnt lgkmcnt(4)
M v[112:115], a[132:135], a[180:183], 0
v_exp_f32 v68, v68
M v[112:115], a[136:139], a[184:187], v[112:115]
ds_read_b128 a[164:167], v2 offset:12288
ds_read_b128 a[168:171], v2 offset:13312
M v[112:115], a[140:143], a[188:191], v[112:115]
v_exp_f32 v69, v69
M v[112:115], a[144:147], a[192:195], v[112:115]
buffer_load_dwordx4 v1, s[12:15], s32 offen offset:0 sc1 lds
M v[116:119], a[144:147], a[208:211], 0
v_exp_f32 v70, v70
M v[116:119], a[140:143], a[204:207], v[116:119]
v_cvt_pk_bf16_f32 v67, v82, v83
v_cvt_pk_bf16_f32 v68, v68, v69
M v[116:119], a[136:139], a[200:203], v[116:119]
v_exp_f32 v71, v71
M v[116:119], a[132:135], a[196:199], v[116:119]
buffer_load_dwordx4 v1, s[12:15], s32 offen offset:1024 sc1 lds
M v[120:123], a[132:135], a[212:215], 0
v_exp_f32 v84, v84
M v[120:123], a[136:139], a[216:219], v[120:123]
ds_read_b128 a[172:175], v2 offset:14336
ds_read_b128 a[176:179], v2 offset:15360
M v[120:123], a[140:143], a[220:223], v[120:123]
v_exp_f32 v85, v85
M v[120:123], a[144:147], a[224:227], v[120:123]
buffer_load_dwordx4 v1, s[12:15], s32 offen offset:2048 sc1 lds
M v[124:127], a[144:147], a[240:243], 0
v_exp_f32 v86, v86
M v[124:127], a[140:143], a[236:239], v[124:127]
v_cvt_pk_bf16_f32 v69, v70, v71
v_cvt_pk_bf16_f32 v70, v84, v85
M v[124:127], a[136:139], a[232:235], v[124:127]
v_exp_f32 v87, v87
M v[124:127], a[132:135], a[228:231], v[124:127]
buffer_load_dwordx4 v1, s[12:15], s32 offen offset:3072 sc1 lds
s_add_u32 m0, s29, 98304
s_waitcnt lgkmcnt(4)
M v[128:131], a[148:151], a[180:183], 0
v_exp_f32 v72, v72
M v[128:131], a[152:155], a[184:187], v[128:131]
ds_read_b128 a[116:119], v5 offset:32768
ds_read_b128 a[120:123], v5 offset:40960
M v[128:131], a[156:159], a[188:191], v[128:131]
v_exp_f32 v73, v73
M v[128:131], a[160:163], a[192:195], v[128:131]
buffer_load_dwordx4 v1, s[12:15], s26 offen offset:0 sc1 lds
s_add_u32 s43, s26, 4096
M v[132:135], a[160:163], a[208:211], 0
v_exp_f32 v74, v74
M v[132:135], a[156:159], a[204:207], v[132:135]
v_cvt_pk_bf16_f32 v71, v86, v87
v_cvt_pk_bf16_f32 v72, v72, v73
M v[132:135], a[152:155], a[200:203], v[132:135]
v_exp_f32 v75, v75
M v[132:135], a[148:151], a[196:199], v[132:135]
buffer_load_dwordx4 v1, s[12:15], s26 offen offset:1024 sc1 lds
M v[136:139], a[148:151], a[212:215], 0
v_exp_f32 v88, v88
M v[136:139], a[152:155], a[216:219], v[136:139]
ds_read_b128 a[124:127], v5 offset:33792
ds_read_b128 a[128:131], v5 offset:41984
M v[136:139], a[156:159], a[220:223], v[136:139]
v_exp_f32 v89, v89
M v[136:139], a[160:163], a[224:227], v[136:139]
buffer_load_dwordx4 v1, s[12:15], s26 offen offset:2048 sc1 lds
M v[140:143], a[160:163], a[240:243], 0
v_exp_f32 v90, v90
M v[140:143], a[156:159], a[236:239], v[140:143]
v_cvt_pk_bf16_f32 v73, v74, v75
v_cvt_pk_bf16_f32 v74, v88, v89
M v[140:143], a[152:155], a[232:235], v[140:143]
v_exp_f32 v91, v91
M v[140:143], a[148:151], a[228:231], v[140:143]
buffer_load_dwordx4 v1, s[12:15], s26 offen offset:3072 sc1 lds
s_add_u32 m0, s29, 102400
s_waitcnt lgkmcnt(4)
M v[144:147], a[164:167], a[180:183], 0
v_exp_f32 v76, v76
M v[144:147], a[168:171], a[184:187], v[144:147]
ds_read_b128 a[132:135], v5 offset:34816
ds_read_b128 a[136:139], v5 offset:43008
M v[144:147], a[172:175], a[188:191], v[144:147]
v_exp_f32 v77, v77
M v[144:147], a[176:179], a[192:195], v[144:147]
buffer_load_dwordx4 v1, s[12:15], s43 offen offset:0 sc1 lds
M v[148:151], a[176:179], a[208:211], 0
v_exp_f32 v78, v78
M v[148:151], a[172:175], a[204:207], v[148:151]
v_cvt_pk_bf16_f32 v75, v90, v91
v_cvt_pk_bf16_f32 v76, v76, v77
M v[148:151], a[168:171], a[200:203], v[148:151]
v_exp_f32 v79, v79
M v[148:151], a[164:167], a[196:199], v[148:151]
buffer_load_dwordx4 v1, s[12:15], s43 offen offset:1024 sc1 lds
M v[152:155], a[164:167], a[212:215], 0
v_exp_f32 v92, v92
M v[152:155], a[168:171], a[216:219], v[152:155]
ds_read_b128 a[140:143], v5 offset:35840
ds_read_b128 a[144:147], v5 offset:44032
M v[152:155], a[172:175], a[220:223], v[152:155]
v_exp_f32 v93, v93
M v[152:155], a[176:179], a[224:227], v[152:155]
buffer_load_dwordx4 v1, s[12:15], s43 offen offset:2048 sc1 lds
M v[156:159], a[176:179], a[240:243], 0
v_exp_f32 v94, v94
M v[156:159], a[172:175], a[236:239], v[156:159]
v_cvt_pk_bf16_f32 v77, v78, v79
v_cvt_pk_bf16_f32 v78, v92, v93
M v[156:159], a[168:171], a[232:235], v[156:159]
v_exp_f32 v95, v95
M v[156:159], a[164:167], a[228:231], v[156:159]
buffer_load_dwordx4 v1, s[12:15], s43 offen offset:3072 sc1 lds
v_cvt_pk_bf16_f32 v79, v94, v95
s_waitcnt lgkmcnt(6)
M v[160:163], a[116:119], v[32:35], v[160:163]
v_exp_f32 v96, v96
M v[160:163], a[120:123], v[64:67], v[160:163]
ds_read_b128 a[148:151], v5 offset:36864
ds_read_b128 a[152:155], v5 offset:45056
M v[164:167], a[120:123], v[68:71], v[164:167]
v_exp_f32 v97, v97
M v[164:167], a[116:119], v[36:39], v[164:167]
v_cvt_pk_bf16_f32 v96, v96, v97
M v[168:171], a[116:119], v[40:43], v[168:171]
v_exp_f32 v98, v98
M v[168:171], a[120:123], v[72:75], v[168:171]
s_add_u32 s25, s25, 32768
s_cmp_eq_u32 s25, s27
M v[172:175], a[120:123], v[76:79], v[172:175]
v_exp_f32 v99, v99
M v[172:175], a[116:119], v[44:47], v[172:175]
v_cvt_pk_bf16_f32 v97, v98, v99
s_waitcnt lgkmcnt(6)
M a[96:99], a[112:115], v[32:35], a[96:99]
s_cselect_b32 s25, s28, s25
s_cselect_b32 s27, -1, s27
M a[96:99], a[112:115], v[64:67], a[96:99]
s_add_u32 s26, s26, 32768
s_cmp_eq_u32 s26, s62
M v[176:179], a[124:127], v[32:35], v[176:179]
v_exp_f32 v112, v112
M v[176:179], a[128:131], v[64:67], v[176:179]
ds_read_b128 a[156:159], v5 offset:37888
ds_read_b128 a[160:163], v5 offset:46080
M v[180:183], a[128:131], v[68:71], v[180:183]
v_exp_f32 v113, v113
M v[180:183], a[124:127], v[36:39], v[180:183]
v_cvt_pk_bf16_f32 v98, v112, v113
M v[184:187], a[124:127], v[40:43], v[184:187]
v_exp_f32 v114, v114
M v[184:187], a[128:131], v[72:75], v[184:187]
s_cselect_b32 s26, s63, s26
s_cselect_b32 s62, -1, s62
M v[188:191], a[128:131], v[76:79], v[188:191]
v_exp_f32 v115, v115
M v[188:191], a[124:127], v[44:47], v[188:191]
v_cvt_pk_bf16_f32 v99, v114, v115
s_waitcnt lgkmcnt(6)
M a[100:103], a[112:115], v[36:39], a[100:103]
M a[100:103], a[112:115], v[68:71], a[100:103]
M v[192:195], a[132:135], v[32:35], v[192:195]
v_exp_f32 v100, v100
M v[192:195], a[136:139], v[64:67], v[192:195]
ds_read_b128 a[164:167], v5 offset:38912
ds_read_b128 a[168:171], v5 offset:47104
M v[196:199], a[136:139], v[68:71], v[196:199]
v_exp_f32 v101, v101
M v[196:199], a[132:135], v[36:39], v[196:199]
v_cvt_pk_bf16_f32 v100, v100, v101
M v[200:203], a[132:135], v[40:43], v[200:203]
v_exp_f32 v102, v102
M v[200:203], a[136:139], v[72:75], v[200:203]
M v[204:207], a[136:139], v[76:79], v[204:207]
v_exp_f32 v103, v103
M v[204:207], a[132:135], v[44:47], v[204:207]
v_cvt_pk_bf16_f32 v101, v102, v103
s_waitcnt lgkmcnt(6)
M a[104:107], a[112:115], v[40:43], a[104:107]
M a[104:107], a[112:115], v[72:75], a[104:107]
M v[208:211], a[140:143], v[32:35], v[208:211]
v_exp_f32 v116, v116
M v[208:211], a[144:147], v[64:67], v[208:211]
ds_read_b128 a[172:175], v5 offset:39936
ds_read_b128 a[176:179], v5 offset:48128
M v[212:215], a[144:147], v[68:71], v[212:215]
v_exp_f32 v117, v117
M v[212:215], a[140:143], v[36:39], v[212:215]
v_cvt_pk_bf16_f32 v102, v116, v117
M v[216:219], a[140:143], v[40:43], v[216:219]
v_exp_f32 v118, v118
M v[216:219], a[144:147], v[72:75], v[216:219]
M v[220:223], a[144:147], v[76:79], v[220:223]
v_exp_f32 v119, v119
M v[220:223], a[140:143], v[44:47], v[220:223]
v_cvt_pk_bf16_f32 v103, v118, v119
s_waitcnt lgkmcnt(6)
M a[108:111], a[112:115], v[44:47], a[108:111]
M a[108:111], a[112:115], v[76:79], a[108:111]
M v[224:227], a[148:151], v[32:35], v[224:227]
v_exp_f32 v104, v104
M v[224:227], a[152:155], v[64:67], v[224:227]
M v[228:231], a[152:155], v[68:71], v[228:231]
v_exp_f32 v105, v105
M v[228:231], a[148:151], v[36:39], v[228:231]
v_cvt_pk_bf16_f32 v104, v104, v105
M v[232:235], a[148:151], v[40:43], v[232:235]
v_exp_f32 v106, v106
M v[232:235], a[152:155], v[72:75], v[232:235]
M v[236:239], a[152:155], v[76:79], v[236:239]
v_exp_f32 v107, v107
M v[236:239], a[148:151], v[44:47], v[236:239]
v_cvt_pk_bf16_f32 v105, v106, v107
s_waitcnt lgkmcnt(4)
M v[240:243], a[156:159], v[32:35], v[240:243]
v_exp_f32 v120, v120
M v[240:243], a[160:163], v[64:67], v[240:243]
M v[244:247], a[160:163], v[68:71], v[244:247]
v_exp_f32 v121, v121
M v[244:247], a[156:159], v[36:39], v[244:247]
v_cvt_pk_bf16_f32 v106, v120, v121
M v[248:251], a[156:159], v[40:43], v[248:251]
v_exp_f32 v122, v122
M v[248:251], a[160:163], v[72:75], v[248:251]
s_waitcnt vmcnt(0) lgkmcnt(0)
s_barrier
ds_read_b128 a[116:119], v3 offset:0
ds_read_b128 a[120:123], v3 offset:1024
M v[252:255], a[160:163], v[76:79], v[252:255]
v_exp_f32 v123, v123
M v[252:255], a[156:159], v[44:47], v[252:255]
v_cvt_pk_bf16_f32 v107, v122, v123
M a[64:67], a[164:167], v[32:35], a[64:67]
v_exp_f32 v108, v108
M a[64:67], a[168:171], v[64:67], a[64:67]
ds_read_b128 a[124:127], v3 offset:2048
ds_read_b128 a[128:131], v3 offset:3072
M a[68:71], a[168:171], v[68:71], a[68:71]
v_exp_f32 v109, v109
M a[68:71], a[164:167], v[36:39], a[68:71]
v_cvt_pk_bf16_f32 v108, v108, v109
M a[72:75], a[164:167], v[40:43], a[72:75]
v_exp_f32 v110, v110
M a[72:75], a[168:171], v[72:75], a[72:75]
ds_read_b128 a[132:135], v3 offset:4096
ds_read_b128 a[136:139], v3 offset:5120
M a[76:79], a[168:171], v[76:79], a[76:79]
v_exp_f32 v111, v111
M a[76:79], a[164:167], v[44:47], a[76:79]
v_cvt_pk_bf16_f32 v109, v110, v111
M a[80:83], a[172:175], v[32:35], a[80:83]
v_exp_f32 v124, v124
M a[80:83], a[176:179], v[64:67], a[80:83]
ds_read_b128 a[140:143], v3 offset:6144
ds_read_b128 a[144:147], v3 offset:7168
M a[84:87], a[176:179], v[68:71], a[84:87]
v_exp_f32 v125, v125
M a[84:87], a[172:175], v[36:39], a[84:87]
v_cvt_pk_bf16_f32 v110, v124, v125
M a[88:91], a[172:175], v[40:43], a[88:91]
v_exp_f32 v126, v126
M a[88:91], a[176:179], v[72:75], a[88:91]
M a[92:95], a[176:179], v[76:79], a[92:95]
v_exp_f32 v127, v127
M a[92:95], a[172:175], v[44:47], a[92:95]
v_cvt_pk_bf16_f32 v111, v126, v127
Lk2_l2b:
s_add_u32 m0, s29, 0
s_waitcnt lgkmcnt(4)
M v[32:35], a[116:119], a[180:183], 0
v_exp_f32 v128, v128
M v[32:35], a[120:123], a[184:187], v[32:35]
ds_read_b128 a[148:151], v3 offset:8192
ds_read_b128 a[152:155], v3 offset:9216
M v[32:35], a[124:127], a[188:191], v[32:35]
v_exp_f32 v129, v129
M v[32:35], a[128:131], a[192:195], v[32:35]
buffer_load_dwordx4 v1, s[12:15], s25 offen offset:0 sc1 lds
s_add_u32 s32, s25, 4096
M v[36:39], a[128:131], a[208:211], 0
v_exp_f32 v130, v130
M v[36:39], a[124:127], a[204:207], v[36:39]
v_cvt_pk_bf16_f32 v128, v128, v129
M v[36:39], a[120:123], a[200:203], v[36:39]
v_exp_f32 v131, v131
M v[36:39], a[116:119], a[196:199], v[36:39]
buffer_load_dwordx4 v1, s[12:15], s25 offen offset:1024 sc1 lds
M v[40:43], a[116:119], a[212:215], 0
v_exp_f32 v144, v144
M v[40:43], a[120:123], a[216:219], v[40:43]
ds_read_b128 a[156:159], v3 offset:10240
ds_read_b128 a[160:163], v3 offset:11264
M v[40:43], a[124:127], a[220:223], v[40:43]
v_exp_f32 v145, v145
M v[40:43], a[128:131], a[224:227], v[40:43]
buffer_load_dwordx4 v1, s[12:15], s25 offen offset:2048 sc1 lds
M v[44:47], a[128:131], a[240:243], 0
v_exp_f32 v146, v146
M v[44:47], a[124:127], a[236:239], v[44:47]
v_cvt_pk_bf16_f32 v129, v130, v131
v_cvt_pk_bf16_f32 v130, v144, v145
M v[44:47], a[120:123], a[232:235], v[44:47]
v_exp_f32 v147, v147
M v[44:47], a[116:119], a[228:231], v[44:47]
buffer_load_dwordx4 v1, s[12:15], s25 offen offset:3072 sc1 lds
s_add_u32 m0, s29, 4096
s_waitcnt lgkmcnt(4)
M v[48:51], a[132:135], a[180:183], 0
v_exp_f32 v132, v132
M v[48:51], a[136:139], a[184:187], v[48:51]
ds_read_b128 a[164:167], v3 offset:12288
ds_read_b128 a[168:171], v3 offset:13312
M v[48:51], a[140:143], a[188:191], v[48:51]
v_exp_f32 v133, v133
M v[48:51], a[144:147], a[192:195], v[48:51]
buffer_load_dwordx4 v1, s[12:15], s32 offen offset:0 sc1 lds
M v[52:55], a[144:147], a[208:211], 0
v_exp_f32 v134, v134
M v[52:55], a[140:143], a[204:207], v[52:55]
v_cvt_pk_bf16_f32 v131, v146, v147
v_cvt_pk_bf16_f32 v132, v132, v133
M v[52:55], a[136:139], a[200:203], v[52:55]
v_exp_f32 v135, v135
M v[52:55], a[132:135], a[196:199], v[52:55]
buffer_load_dwordx4 v1, s[12:15], s32 offen offset:1024 sc1 lds
M v[56:59], a[132:135], a[212:215], 0
v_exp_f32 v148, v148
M v[56:59], a[136:139], a[216:219], v[56:59]
ds_read_b128 a[172:175], v3 offset:14336
ds_read_b128 a[176:179], v3 offset:15360
M v[56:59], a[140:143], a[220:223], v[56:59]
v_exp_f32 v149, v149
M v[56:59], a[144:147], a[224:227], v[56:59]
buffer_load_dwordx4 v1, s[12:15], s32 offen offset:2048 sc1 lds
M v[60:63], a[144:147], a[240:243], 0
v_exp_f32 v150, v150
M v[60:63], a[140:143], a[236:239], v[60:63]
v_cvt_pk_bf16_f32 v133, v134, v135
v_cvt_pk_bf16_f32 v134, v148, v149
M v[60:63], a[136:139], a[232:235], v[60:63]
v_exp_f32 v151, v151
M v[60:63], a[132:135], a[228:231], v[60:63]
buffer_load_dwordx4 v1, s[12:15], s32 offen offset:3072 sc1 lds
s_add_u32 m0, s29, 32768
s_waitcnt lgkmcnt(4)
M v[64:67], a[148:151], a[180:183], 0
v_exp_f32 v136, v136
M v[64:67], a[152:155], a[184:187], v[64:67]
ds_read_b128 a[116:119], v6 offset:32768
ds_read_b128 a[120:123], v6 offset:40960
M v[64:67], a[156:159], a[188:191], v[64:67]
v_exp_f32 v137, v137
M v[64:67], a[160:163], a[192:195], v[64:67]
buffer_load_dwordx4 v1, s[12:15], s26 offen offset:0 sc1 lds
s_add_u32 s43, s26, 4096
M v[68:71], a[160:163], a[208:211], 0
v_exp_f32 v138, v138
M v[68:71], a[156:159], a[204:207], v[68:71]
v_cvt_pk_bf16_f32 v135, v150, v151
v_cvt_pk_bf16_f32 v136, v136, v137
M v[68:71], a[152:155], a[200:203], v[68:71]
v_exp_f32 v139, v139
M v[68:71], a[148:151], a[196:199], v[68:71]
buffer_load_dwordx4 v1, s[12:15], s26 offen offset:1024 sc1 lds
M v[72:75], a[148:151], a[212:215], 0
v_exp_f32 v152, v152
M v[72:75], a[152:155], a[216:219], v[72:75]
ds_read_b128 a[124:127], v6 offset:33792
ds_read_b128 a[128:131], v6 offset:41984
M v[72:75], a[156:159], a[220:223], v[72:75]
v_exp_f32 v153, v153
M v[72:75], a[160:163], a[224:227], v[72:75]
buffer_load_dwordx4 v1, s[12:15], s26 offen offset:2048 sc1 lds
M v[76:79], a[160:163], a[240:243], 0
v_exp_f32 v154, v154
M v[76:79], a[156:159], a[236:239], v[76:79]
v_cvt_pk_bf16_f32 v137, v138, v139
v_cvt_pk_bf16_f32 v138, v152, v153
M v[76:79], a[152:155], a[232:235], v[76:79]
v_exp_f32 v155, v155
M v[76:79], a[148:151], a[228:231], v[76:79]
buffer_load_dwordx4 v1, s[12:15], s26 offen offset:3072 sc1 lds
s_add_u32 m0, s29, 36864
s_waitcnt lgkmcnt(4)
M v[80:83], a[164:167], a[180:183], 0
v_exp_f32 v140, v140
M v[80:83], a[168:171], a[184:187], v[80:83]
ds_read_b128 a[132:135], v6 offset:34816
ds_read_b128 a[136:139], v6 offset:43008
M v[80:83], a[172:175], a[188:191], v[80:83]
v_exp_f32 v141, v141
M v[80:83], a[176:179], a[192:195], v[80:83]
buffer_load_dwordx4 v1, s[12:15], s43 offen offset:0 sc1 lds
M v[84:87], a[176:179], a[208:211], 0
v_exp_f32 v142, v142
M v[84:87], a[172:175], a[204:207], v[84:87]
v_cvt_pk_bf16_f32 v139, v154, v155
v_cvt_pk_bf16_f32 v140, v140, v141
M v[84:87], a[168:171], a[200:203], v[84:87]
v_exp_f32 v143, v143
M v[84:87], a[164:167], a[196:199], v[84:87]
buffer_load_dwordx4 v1, s[12:15], s43 offen offset:1024 sc1 lds
M v[88:91], a[164:167], a[212:215], 0
v_exp_f32 v156, v156
M v[88:91], a[168:171], a[216:219], v[88:91]
ds_read_b128 a[140:143], v6 offset:35840
ds_read_b128 a[144:147], v6 offset:44032
M v[88:91], a[172:175], a[220:223], v[88:91]
v_exp_f32 v157, v157
M v[88:91], a[176:179], a[224:227], v[88:91]
buffer_load_dwordx4 v1, s[12:15], s43 offen offset:2048 sc1 lds
M v[92:95], a[176:179], a[240:243], 0
v_exp_f32 v158, v158
M v[92:95], a[172:175], a[236:239], v[92:95]
v_cvt_pk_bf16_f32 v141, v142, v143
v_cvt_pk_bf16_f32 v142, v156, v157
M v[92:95], a[168:171], a[232:235], v[92:95]
v_exp_f32 v159, v159
M v[92:95], a[164:167], a[228:231], v[92:95]
buffer_load_dwordx4 v1, s[12:15], s43 offen offset:3072 sc1 lds
v_cvt_pk_bf16_f32 v143, v158, v159
s_waitcnt lgkmcnt(6)
M v[160:163], a[116:119], v[96:99], v[160:163]
v_exp_f32 v32, v32
M v[160:163], a[120:123], v[128:131], v[160:163]
ds_read_b128 a[148:151], v6 offset:36864
ds_read_b128 a[152:155], v6 offset:45056
M v[164:167], a[120:123], v[132:135], v[164:167]
v_exp_f32 v33, v33
M v[164:167], a[116:119], v[100:103], v[164:167]
v_cvt_pk_bf16_f32 v32, v32, v33
M v[168:171], a[116:119], v[104:107], v[168:171]
v_exp_f32 v34, v34
M v[168:171], a[120:123], v[136:139], v[168:171]
s_add_u32 s25, s25, 32768
s_cmp_eq_u32 s25, s27
M v[172:175], a[120:123], v[140:143], v[172:175]
v_exp_f32 v35, v35
M v[172:175], a[116:119], v[108:111], v[172:175]
v_cvt_pk_bf16_f32 v33, v34, v35
s_waitcnt lgkmcnt(6)
M a[96:99], a[112:115], v[96:99], a[96:99]
s_cselect_b32 s25, s28, s25
s_cselect_b32 s27, -1, s27
M a[96:99], a[112:115], v[128:131], a[96:99]
s_add_u32 s26, s26, 32768
s_cmp_eq_u32 s26, s62
M v[176:179], a[124:127], v[96:99], v[176:179]
v_exp_f32 v48, v48
M v[176:179], a[128:131], v[128:131], v[176:179]
ds_read_b128 a[156:159], v6 offset:37888
ds_read_b128 a[160:163], v6 offset:46080
M v[180:183], a[128:131], v[132:135], v[180:183]
v_exp_f32 v49, v49
M v[180:183], a[124:127], v[100:103], v[180:183]
v_cvt_pk_bf16_f32 v34, v48, v49
M v[184:187], a[124:127], v[104:107], v[184:187]
v_exp_f32 v50, v50
M v[184:187], a[128:131], v[136:139], v[184:187]
s_cselect_b32 s26, s63, s26
s_cselect_b32 s62, -1, s62
M v[188:191], a[128:131], v[140:143], v[188:191]
v_exp_f32 v51, v51
M v[188:191], a[124:127], v[108:111], v[188:191]
v_cvt_pk_bf16_f32 v35, v50, v51
s_waitcnt lgkmcnt(6)
M a[100:103], a[112:115], v[100:103], a[100:103]
M a[100:103], a[112:115], v[132:135], a[100:103]
M v[192:195], a[132:135], v[96:99], v[192:195]
v_exp_f32 v36, v36
M v[192:195], a[136:139], v[128:131], v[192:195]
ds_read_b128 a[164:167], v6 offset:38912
ds_read_b128 a[168:171], v6 offset:47104
M v[196:199], a[136:139], v[132:135], v[196:199]
v_exp_f32 v37, v37
M v[196:199], a[132:135], v[100:103], v[196:199]
v_cvt_pk_bf16_f32 v36, v36, v37
M v[200:203], a[132:135], v[104:107], v[200:203]
v_exp_f32 v38, v38
M v[200:203], a[136:139], v[136:139], v[200:203]
M v[204:207], a[136:139], v[140:143], v[204:207]
v_exp_f32 v39, v39
M v[204:207], a[132:135], v[108:111], v[204:207]
v_cvt_pk_bf16_f32 v37, v38, v39
s_waitcnt lgkmcnt(6)
M a[104:107], a[112:115], v[104:107], a[104:107]
M a[104:107], a[112:115], v[136:139], a[104:107]
M v[208:211], a[140:143], v[96:99], v[208:211]
v_exp_f32 v52, v52
M v[208:211], a[144:147], v[128:131], v[208:211]
ds_read_b128 a[172:175], v6 offset:39936
ds_read_b128 a[176:179], v6 offset:48128
M v[212:215], a[144:147], v[132:135], v[212:215]
v_exp_f32 v53, v53
M v[212:215], a[140:143], v[100:103], v[212:215]
v_cvt_pk_bf16_f32 v38, v52, v53
M v[216:219], a[140:143], v[104:107], v[216:219]
v_exp_f32 v54, v54
M v[216:219], a[144:147], v[136:139], v[216:219]
M v[220:223], a[144:147], v[140:143], v[220:223]
v_exp_f32 v55, v55
M v[220:223], a[140:143], v[108:111], v[220:223]
v_cvt_pk_bf16_f32 v39, v54, v55
s_waitcnt lgkmcnt(6)
M a[108:111], a[112:115], v[108:111], a[108:111]
M a[108:111], a[112:115], v[140:143], a[108:111]
M v[224:227], a[148:151], v[96:99], v[224:227]
v_exp_f32 v40, v40
M v[224:227], a[152:155], v[128:131], v[224:227]
M v[228:231], a[152:155], v[132:135], v[228:231]
v_exp_f32 v41, v41
M v[228:231], a[148:151], v[100:103], v[228:231]
v_cvt_pk_bf16_f32 v40, v40, v41
M v[232:235], a[148:151], v[104:107], v[232:235]
v_exp_f32 v42, v42
M v[232:235], a[152:155], v[136:139], v[232:235]
M v[236:239], a[152:155], v[140:143], v[236:239]
v_exp_f32 v43, v43
M v[236:239], a[148:151], v[108:111], v[236:239]
v_cvt_pk_bf16_f32 v41, v42, v43
s_waitcnt lgkmcnt(4)
M v[240:243], a[156:159], v[96:99], v[240:243]
v_exp_f32 v56, v56
M v[240:243], a[160:163], v[128:131], v[240:243]
M v[244:247], a[160:163], v[132:135], v[244:247]
v_exp_f32 v57, v57
M v[244:247], a[156:159], v[100:103], v[244:247]
v_cvt_pk_bf16_f32 v42, v56, v57
M v[248:251], a[156:159], v[104:107], v[248:251]
v_exp_f32 v58, v58
M v[248:251], a[160:163], v[136:139], v[248:251]
s_waitcnt vmcnt(0) lgkmcnt(0)
s_barrier
ds_read_b128 a[116:119], v2 offset:0
ds_read_b128 a[120:123], v2 offset:1024
M v[252:255], a[160:163], v[140:143], v[252:255]
v_exp_f32 v59, v59
M v[252:255], a[156:159], v[108:111], v[252:255]
v_cvt_pk_bf16_f32 v43, v58, v59
M a[64:67], a[164:167], v[96:99], a[64:67]
v_exp_f32 v44, v44
M a[64:67], a[168:171], v[128:131], a[64:67]
ds_read_b128 a[124:127], v2 offset:2048
ds_read_b128 a[128:131], v2 offset:3072
M a[68:71], a[168:171], v[132:135], a[68:71]
v_exp_f32 v45, v45
M a[68:71], a[164:167], v[100:103], a[68:71]
v_cvt_pk_bf16_f32 v44, v44, v45
M a[72:75], a[164:167], v[104:107], a[72:75]
v_exp_f32 v46, v46
M a[72:75], a[168:171], v[136:139], a[72:75]
ds_read_b128 a[132:135], v2 offset:4096
ds_read_b128 a[136:139], v2 offset:5120
M a[76:79], a[168:171], v[140:143], a[76:79]
v_exp_f32 v47, v47
M a[76:79], a[164:167], v[108:111], a[76:79]
v_cvt_pk_bf16_f32 v45, v46, v47
M a[80:83], a[172:175], v[96:99], a[80:83]
v_exp_f32 v60, v60
M a[80:83], a[176:179], v[128:131], a[80:83]
ds_read_b128 a[140:143], v2 offset:6144
ds_read_b128 a[144:147], v2 offset:7168
M a[84:87], a[176:179], v[132:135], a[84:87]
v_exp_f32 v61, v61
M a[84:87], a[172:175], v[100:103], a[84:87]
v_cvt_pk_bf16_f32 v46, v60, v61
M a[88:91], a[172:175], v[104:107], a[88:91]
v_exp_f32 v62, v62
M a[88:91], a[176:179], v[136:139], a[88:91]
M a[92:95], a[176:179], v[140:143], a[92:95]
v_exp_f32 v63, v63
M a[92:95], a[172:175], v[108:111], a[92:95]
v_cvt_pk_bf16_f32 v47, v62, v63
s_sub_u32 s30, s30, 1
s_cmp_lg_u32 s30, 0
s_cbranch_scc1 Lk2_l2
Lf0:
s_and_b32 s3, s2, 3
s_lshl_b32 s3, s3, 2
s_bfe_u32 s27, s2, 0x20003
s_add_u32 s27, s3, s27
s_lshl_b32 s43, s27, 8
s_add_u32 s43, s43, 16789504
v_lshlrev_b32 v15, 2, v0
buffer_load_dword v7, v15, s[52:55], s43 offen sc1
s_waitcnt lgkmcnt(7)
ds_read_b128 a[116:119], v5 offset:36864
s_waitcnt lgkmcnt(7)
ds_read_b128 a[120:123], v5 offset:45056
s_waitcnt lgkmcnt(7)
ds_read_b128 a[124:127], v5 offset:37888
s_waitcnt lgkmcnt(7)
ds_read_b128 a[128:131], v5 offset:46080
s_waitcnt lgkmcnt(7)
ds_read_b128 a[132:135], v5 offset:38912
s_waitcnt lgkmcnt(7)
ds_read_b128 a[136:139], v5 offset:47104
s_waitcnt lgkmcnt(7)
ds_read_b128 a[140:143], v5 offset:39936
s_waitcnt lgkmcnt(7)
ds_read_b128 a[144:147], v5 offset:48128
s_lshl_b32 s33, s23, 14
s_add_u32 s34, s33, 98304
s_add_u32 s33, s33, 131072
v_add_u32 v2, s34, v1
v_add_u32 v3, s33, v1
v_exp_f32 v64, v64
v_exp_f32 v65, v65
v_exp_f32 v66, v66
v_exp_f32 v67, v67
v_exp_f32 v80, v80
v_exp_f32 v81, v81
v_exp_f32 v82, v82
v_exp_f32 v83, v83
v_cvt_pk_bf16_f32 v64, v64, v65
v_cvt_pk_bf16_f32 v65, v66, v67
v_exp_f32 v68, v68
v_exp_f32 v69, v69
v_exp_f32 v70, v70
v_exp_f32 v71, v71
v_cvt_pk_bf16_f32 v66, v80, v81
v_cvt_pk_bf16_f32 v67, v82, v83
v_exp_f32 v84, v84
v_exp_f32 v85, v85
v_exp_f32 v86, v86
v_exp_f32 v87, v87
v_cvt_pk_bf16_f32 v68, v68, v69
v_cvt_pk_bf16_f32 v69, v70, v71
v_exp_f32 v72, v72
v_exp_f32 v73, v73
v_exp_f32 v74, v74
v_exp_f32 v75, v75
v_cvt_pk_bf16_f32 v70, v84, v85
v_cvt_pk_bf16_f32 v71, v86, v87
v_exp_f32 v88, v88
v_exp_f32 v89, v89
v_exp_f32 v90, v90
v_exp_f32 v91, v91
v_cvt_pk_bf16_f32 v72, v72, v73
v_cvt_pk_bf16_f32 v73, v74, v75
v_exp_f32 v76, v76
v_exp_f32 v77, v77
v_exp_f32 v78, v78
v_exp_f32 v79, v79
v_cvt_pk_bf16_f32 v74, v88, v89
v_cvt_pk_bf16_f32 v75, v90, v91
v_exp_f32 v92, v92
v_exp_f32 v93, v93
v_exp_f32 v94, v94
v_exp_f32 v95, v95
v_cvt_pk_bf16_f32 v76, v76, v77
v_cvt_pk_bf16_f32 v77, v78, v79
v_cvt_pk_bf16_f32 v78, v92, v93
v_cvt_pk_bf16_f32 v79, v94, v95
s_waitcnt lgkmcnt(6)
M v[224:227], a[116:119], v[32:35], v[224:227]
M v[224:227], a[120:123], v[64:67], v[224:227]
ds_read_b128 a[148:151], v5 offset:32768
ds_read_b128 a[152:155], v5 offset:40960
s_mov_b32 s61, 0
M v[228:231], a[120:123], v[68:71], v[228:231]
M v[228:231], a[116:119], v[36:39], v[228:231]
s_bfe_u32 s3, s2, 0x10002
M v[232:235], a[116:119], v[40:43], v[232:235]
M v[232:235], a[120:123], v[72:75], v[232:235]
s_lshl_b32 s3, s3, 3
M v[236:239], a[120:123], v[76:79], v[236:239]
M v[236:239], a[116:119], v[44:47], v[236:239]
s_waitcnt lgkmcnt(6)
s_lshr_b32 s28, s2, 5
M a[96:99], a[112:115], v[32:35], a[96:99]
M a[96:99], a[112:115], v[64:67], a[96:99]
M v[240:243], a[124:127], v[32:35], v[240:243]
M v[240:243], a[128:131], v[64:67], v[240:243]
ds_read_b128 a[156:159], v5 offset:33792
ds_read_b128 a[160:163], v5 offset:41984
s_add_u32 s28, s3, s28
M v[244:247], a[128:131], v[68:71], v[244:247]
s_lshl_b32 s25, s27, 18
M v[244:247], a[124:127], v[36:39], v[244:247]
M v[248:251], a[124:127], v[40:43], v[248:251]
s_lshl_b32 s3, s101, 12
M v[248:251], a[128:131], v[72:75], v[248:251]
M v[252:255], a[128:131], v[76:79], v[252:255]
s_add_u32 s25, s25, s3
M v[252:255], a[124:127], v[44:47], v[252:255]
s_waitcnt lgkmcnt(6)
M a[100:103], a[112:115], v[36:39], a[100:103]
M a[100:103], a[112:115], v[68:71], a[100:103]
M a[64:67], a[132:135], v[32:35], a[64:67]
s_lshl_b32 s26, s28, 7
M a[64:67], a[136:139], v[64:67], a[64:67]
ds_read_b128 a[164:167], v5 offset:34816
ds_read_b128 a[168:171], v5 offset:43008
M a[68:71], a[136:139], v[68:71], a[68:71]
s_lshl_b32 s42, s101, 11
M a[68:71], a[132:135], v[36:39], a[68:71]
M a[72:75], a[132:135], v[40:43], a[72:75]
s_add_u32 s44, s4, 83886080
s_addc_u32 s45, s5, 0
M a[72:75], a[136:139], v[72:75], a[72:75]
s_mov_b32 s46, 4194304
M a[76:79], a[136:139], v[76:79], a[76:79]
M a[76:79], a[132:135], v[44:47], a[76:79]
s_waitcnt lgkmcnt(6)
s_mov_b32 s47, 0x00020000
M a[104:107], a[112:115], v[40:43], a[104:107]
M a[104:107], a[112:115], v[72:75], a[104:107]
M a[80:83], a[140:143], v[32:35], a[80:83]
M a[80:83], a[144:147], v[64:67], a[80:83]
ds_read_b128 a[172:175], v5 offset:35840
ds_read_b128 a[176:179], v5 offset:44032
s_mov_b32 s50, 2097152
M a[84:87], a[144:147], v[68:71], a[84:87]
M a[84:87], a[140:143], v[36:39], a[84:87]
s_mov_b32 s51, 0x00020000
M a[88:91], a[140:143], v[40:43], a[88:91]
M a[88:91], a[144:147], v[72:75], a[88:91]
s_lshl_b32 s3, s101, 4
M a[92:95], a[144:147], v[76:79], a[92:95]
M a[92:95], a[140:143], v[44:47], a[92:95]
s_waitcnt lgkmcnt(6)
v_lshrrev_b32 v96, 3, v0
M a[108:111], a[112:115], v[44:47], a[108:111]
M a[108:111], a[112:115], v[76:79], a[108:111]
M v[160:163], a[148:151], v[32:35], v[160:163]
v_and_b32 v97, 6, v96
M v[160:163], a[152:155], v[64:67], v[160:163]
M v[164:167], a[152:155], v[68:71], v[164:167]
ds_write_b128 v2, v[224:227] offset:0
v_and_b32 v98, 7, v0
M v[164:167], a[148:151], v[36:39], v[164:167]
M v[168:171], a[148:151], v[40:43], v[168:171]
ds_write_b128 v2, v[228:231] offset:1024
v_xor_b32 v97, v97, v98
M v[168:171], a[152:155], v[72:75], v[168:171]
M v[172:175], a[152:155], v[76:79], v[172:175]
ds_write_b128 v2, v[232:235] offset:2048
v_add_u32 v96, s3, v96
M v[172:175], a[148:151], v[44:47], v[172:175]
s_waitcnt lgkmcnt(7)
M v[176:179], a[156:159], v[32:35], v[176:179]
ds_write_b128 v2, v[236:239] offset:3072
v_lshlrev_b32 v96, 11, v96
M v[176:179], a[160:163], v[64:67], v[176:179]
M v[180:183], a[160:163], v[68:71], v[180:183]
ds_write_b128 v2, v[240:243] offset:4096
v_lshl_add_u32 v99, v97, 4, v96
M v[180:183], a[156:159], v[36:39], v[180:183]
v_add_u32 v100, 15360, v99
M v[184:187], a[156:159], v[40:43], v[184:187]
ds_write_b128 v2, v[244:247] offset:5120
M v[184:187], a[160:163], v[72:75], v[184:187]
s_waitcnt vmcnt(0) lgkmcnt(0)
s_barrier
M v[188:191], a[160:163], v[76:79], v[188:191]
ds_write_b128 v2, v[248:251] offset:6144
v_cmp_ne_u32 vcc, 1, v7
s_nop 0
s_cbranch_vccnz Lk3_spinb1
Lk3_gotb1:
M v[188:191], a[156:159], v[44:47], v[188:191]
s_add_u32 m0, s42, 16384
s_nop 0
buffer_load_dwordx4 v99, s[48:51], s26 offen offset:0 lds
M v[192:195], a[164:167], v[32:35], v[192:195]
ds_write_b128 v2, v[252:255] offset:7168
buffer_load_dwordx4 v100, s[48:51], s26 offen offset:1024 lds
M v[192:195], a[168:171], v[64:67], v[192:195]
M v[196:199], a[168:171], v[68:71], v[196:199]
ds_write_b128 v2, a[64:67] offset:8192
buffer_load_dwordx4 a[192:195], v1, s[44:47], s25 offen offset:0 sc1
M v[196:199], a[164:167], v[36:39], v[196:199]
buffer_load_dwordx4 a[196:199], v1, s[44:47], s25 offen offset:1024 sc1
M v[200:203], a[164:167], v[40:43], v[200:203]
ds_write_b128 v2, a[68:71] offset:9216
buffer_load_dwordx4 a[200:203], v1, s[44:47], s25 offen offset:2048 sc1
M v[200:203], a[168:171], v[72:75], v[200:203]
buffer_load_dwordx4 a[204:207], v1, s[44:47], s25 offen offset:3072 sc1
M v[204:207], a[168:171], v[76:79], v[204:207]
ds_write_b128 v2, a[72:75] offset:10240
M v[204:207], a[164:167], v[44:47], v[204:207]
s_add_u32 s25, s25, 16384
s_add_u32 s26, s26, 131072
M v[208:211], a[172:175], v[32:35], v[208:211]
ds_write_b128 v2, a[76:79] offset:11264
s_add_u32 m0, s42, 32768
s_nop 0
buffer_load_dwordx4 v99, s[48:51], s26 offen offset:0 lds
M v[208:211], a[176:179], v[64:67], v[208:211]
buffer_load_dwordx4 v100, s[48:51], s26 offen offset:1024 lds
M v[212:215], a[176:179], v[68:71], v[212:215]
ds_write_b128 v2, a[80:83] offset:12288
buffer_load_dwordx4 a[224:227], v1, s[44:47], s25 offen offset:0 sc1
M v[212:215], a[172:175], v[36:39], v[212:215]
M v[216:219], a[172:175], v[40:43], v[216:219]
ds_write_b128 v2, a[84:87] offset:13312
buffer_load_dwordx4 a[228:231], v1, s[44:47], s25 offen offset:1024 sc1
M v[216:219], a[176:179], v[72:75], v[216:219]
buffer_load_dwordx4 a[232:235], v1, s[44:47], s25 offen offset:2048 sc1
M v[220:223], a[176:179], v[76:79], v[220:223]
ds_write_b128 v2, a[88:91] offset:14336
buffer_load_dwordx4 a[236:239], v1, s[44:47], s25 offen offset:3072 sc1
M v[220:223], a[172:175], v[44:47], v[220:223]
s_add_u32 s25, s25, 16384
s_add_u32 s26, s26, 131072
ds_write_b128 v2, a[92:95] offset:15360
s_waitcnt lgkmcnt(0)
Lk2_merge:
s_lshl_b32 s33, s22, 10
s_add_u32 s33, s33, 28672
s_xor_b32 s34, s33, 2048
v_add_u32 v14, s33, v1
v_add_u32 v15, s34, v1
v_accvgpr_read_b32 v20, a96
v_accvgpr_read_b32 v21, a100
v_accvgpr_read_b32 v22, a104
v_accvgpr_read_b32 v23, a108
ds_write_b128 v14, v[20:23]
s_waitcnt lgkmcnt(0)
s_barrier
ds_read_b128 v[28:31], v15
ds_read_b128 v[32:35], v3 offset:0
ds_read_b128 v[36:39], v3 offset:1024
ds_read_b128 v[40:43], v3 offset:2048
ds_read_b128 v[44:47], v3 offset:3072
ds_read_b128 v[48:51], v3 offset:4096
ds_read_b128 v[52:55], v3 offset:5120
ds_read_b128 v[56:59], v3 offset:6144
ds_read_b128 v[60:63], v3 offset:7168
ds_read_b128 v[64:67], v3 offset:8192
ds_read_b128 v[68:71], v3 offset:9216
ds_read_b128 v[72:75], v3 offset:10240
ds_read_b128 v[76:79], v3 offset:11264
ds_read_b128 v[80:83], v3 offset:12288
ds_read_b128 v[84:87], v3 offset:13312
ds_read_b128 v[88:91], v3 offset:14336
ds_read_b128 v[92:95], v3 offset:15360
s_waitcnt lgkmcnt(15)
v_add_f32 v20, v20, v28
v_add_f32 v21, v21, v29
v_add_f32 v22, v22, v30
v_add_f32 v23, v23, v31
s_sub_u32 s35, 15, s21
v_rcp_f32 v8, v20
v_rcp_f32 v9, v21
v_rcp_f32 v10, v22
v_rcp_f32 v11, v23
v_subrev_u32 v20, 0x21800000, v20
v_subrev_u32 v21, 0x21800000, v21
v_subrev_u32 v22, 0x21800000, v22
v_subrev_u32 v23, 0x21800000, v23
v_max_u32 v12, v20, v21
v_max3_u32 v12, v12, v22, v23
s_mov_b32 s64, 0x207
s_lshl_b32 s33, s35, 20
s_lshl_b32 s34, s20, 15
s_add_u32 s33, s33, s34
s_lshl_b32 s34, s23, 13
s_add_u32 s36, s33, s34
s_add_u32 s37, s36, 4096
s_add_u32 s38, s36, 16384
s_add_u32 s39, s36, 20480
v_pk_add_f32 v[160:161], v[160:161], v[32:33]
v_pk_add_f32 v[162:163], v[162:163], v[34:35]
s_waitcnt lgkmcnt(11)
v_pk_add_f32 v[176:177], v[176:177], v[48:49]
v_pk_add_f32 v[178:179], v[178:179], v[50:51]
v_pk_mul_f32 v[160:161], v[160:161], v[8:9] op_sel:[0,0] op_sel_hi:[1,0]
v_pk_mul_f32 v[162:163], v[162:163], v[8:9] op_sel:[0,0] op_sel_hi:[1,0]
v_pk_mul_f32 v[176:177], v[176:177], v[8:9] op_sel:[0,0] op_sel_hi:[1,0]
v_pk_mul_f32 v[178:179], v[178:179], v[8:9] op_sel:[0,0] op_sel_hi:[1,0]
v_cvt_pk_bf16_f32 v160, v160, v161
v_cvt_pk_bf16_f32 v161, v162, v163
v_cvt_pk_bf16_f32 v162, v176, v177
v_cvt_pk_bf16_f32 v163, v178, v179
v_pk_add_f32 v[164:165], v[164:165], v[36:37]
v_pk_add_f32 v[166:167], v[166:167], v[38:39]
s_waitcnt lgkmcnt(10)
v_pk_add_f32 v[180:181], v[180:181], v[52:53]
v_pk_add_f32 v[182:183], v[182:183], v[54:55]
M v[24:27], a[112:115], v[160:163], 0
buffer_store_dwordx4 v[160:163], v1, s[16:19], s36 offen offset:0 sc1
v_pk_mul_f32 v[164:165], v[164:165], v[8:9] op_sel:[0,1] op_sel_hi:[1,1]
v_pk_mul_f32 v[166:167], v[166:167], v[8:9] op_sel:[0,1] op_sel_hi:[1,1]
v_pk_mul_f32 v[180:181], v[180:181], v[8:9] op_sel:[0,1] op_sel_hi:[1,1]
v_pk_mul_f32 v[182:183], v[182:183], v[8:9] op_sel:[0,1] op_sel_hi:[1,1]
v_cvt_pk_bf16_f32 v164, v164, v165
v_cvt_pk_bf16_f32 v165, v166, v167
v_cvt_pk_bf16_f32 v166, v180, v181
v_cvt_pk_bf16_f32 v167, v182, v183
v_pk_add_f32 v[168:169], v[168:169], v[40:41]
v_pk_add_f32 v[170:171], v[170:171], v[42:43]
s_waitcnt lgkmcnt(9)
v_pk_add_f32 v[184:185], v[184:185], v[56:57]
v_pk_add_f32 v[186:187], v[186:187], v[58:59]
M v[24:27], a[112:115], v[164:167], v[24:27]
buffer_store_dwordx4 v[164:167], v1, s[16:19], s36 offen offset:2048 sc1
v_pk_mul_f32 v[168:169], v[168:169], v[10:11] op_sel:[0,0] op_sel_hi:[1,0]
v_pk_mul_f32 v[170:171], v[170:171], v[10:11] op_sel:[0,0] op_sel_hi:[1,0]
v_pk_mul_f32 v[184:185], v[184:185], v[10:11] op_sel:[0,0] op_sel_hi:[1,0]
v_pk_mul_f32 v[186:187], v[186:187], v[10:11] op_sel:[0,0] op_sel_hi:[1,0]
v_cvt_pk_bf16_f32 v168, v168, v169
v_cvt_pk_bf16_f32 v169, v170, v171
v_cvt_pk_bf16_f32 v170, v184, v185
v_cvt_pk_bf16_f32 v171, v186, v187
v_pk_add_f32 v[172:173], v[172:173], v[44:45]
v_pk_add_f32 v[174:175], v[174:175], v[46:47]
s_waitcnt lgkmcnt(8)
v_pk_add_f32 v[188:189], v[188:189], v[60:61]
v_pk_add_f32 v[190:191], v[190:191], v[62:63]
M v[24:27], a[112:115], v[168:171], v[24:27]
buffer_store_dwordx4 v[168:171], v1, s[16:19], s37 offen offset:0 sc1
v_pk_mul_f32 v[172:173], v[172:173], v[10:11] op_sel:[0,1] op_sel_hi:[1,1]
v_pk_mul_f32 v[174:175], v[174:175], v[10:11] op_sel:[0,1] op_sel_hi:[1,1]
v_pk_mul_f32 v[188:189], v[188:189], v[10:11] op_sel:[0,1] op_sel_hi:[1,1]
v_pk_mul_f32 v[190:191], v[190:191], v[10:11] op_sel:[0,1] op_sel_hi:[1,1]
v_cvt_pk_bf16_f32 v172, v172, v173
v_cvt_pk_bf16_f32 v173, v174, v175
v_cvt_pk_bf16_f32 v174, v188, v189
v_cvt_pk_bf16_f32 v175, v190, v191
s_waitcnt lgkmcnt(7)
v_pk_add_f32 v[192:193], v[192:193], v[64:65]
v_pk_add_f32 v[194:195], v[194:195], v[66:67]
s_waitcnt lgkmcnt(3)
v_pk_add_f32 v[208:209], v[208:209], v[80:81]
v_pk_add_f32 v[210:211], v[210:211], v[82:83]
M v[24:27], a[112:115], v[172:175], v[24:27]
buffer_store_dwordx4 v[172:175], v1, s[16:19], s37 offen offset:2048 sc1
v_pk_mul_f32 v[192:193], v[192:193], v[8:9] op_sel:[0,0] op_sel_hi:[1,0]
v_pk_mul_f32 v[194:195], v[194:195], v[8:9] op_sel:[0,0] op_sel_hi:[1,0]
v_pk_mul_f32 v[208:209], v[208:209], v[8:9] op_sel:[0,0] op_sel_hi:[1,0]
v_pk_mul_f32 v[210:211], v[210:211], v[8:9] op_sel:[0,0] op_sel_hi:[1,0]
v_cvt_pk_bf16_f32 v192, v192, v193
v_cvt_pk_bf16_f32 v193, v194, v195
v_cvt_pk_bf16_f32 v194, v208, v209
v_cvt_pk_bf16_f32 v195, v210, v211
v_pk_add_f32 v[196:197], v[196:197], v[68:69]
v_pk_add_f32 v[198:199], v[198:199], v[70:71]
s_waitcnt lgkmcnt(2)
v_pk_add_f32 v[212:213], v[212:213], v[84:85]
v_pk_add_f32 v[214:215], v[214:215], v[86:87]
M v[24:27], a[112:115], v[192:195], v[24:27]
buffer_store_dwordx4 v[192:195], v1, s[16:19], s36 offen offset:1024 sc1
v_pk_mul_f32 v[196:197], v[196:197], v[8:9] op_sel:[0,1] op_sel_hi:[1,1]
v_pk_mul_f32 v[198:199], v[198:199], v[8:9] op_sel:[0,1] op_sel_hi:[1,1]
v_pk_mul_f32 v[212:213], v[212:213], v[8:9] op_sel:[0,1] op_sel_hi:[1,1]
v_pk_mul_f32 v[214:215], v[214:215], v[8:9] op_sel:[0,1] op_sel_hi:[1,1]
v_cvt_pk_bf16_f32 v196, v196, v197
v_cvt_pk_bf16_f32 v197, v198, v199
v_cvt_pk_bf16_f32 v198, v212, v213
v_cvt_pk_bf16_f32 v199, v214, v215
v_pk_add_f32 v[200:201], v[200:201], v[72:73]
v_pk_add_f32 v[202:203], v[202:203], v[74:75]
s_waitcnt lgkmcnt(1)
v_pk_add_f32 v[216:217], v[216:217], v[88:89]
v_pk_add_f32 v[218:219], v[218:219], v[90:91]
M v[24:27], a[112:115], v[196:199], v[24:27]
buffer_store_dwordx4 v[196:199], v1, s[16:19], s36 offen offset:3072 sc1
v_pk_mul_f32 v[200:201], v[200:201], v[10:11] op_sel:[0,0] op_sel_hi:[1,0]
v_pk_mul_f32 v[202:203], v[202:203], v[10:11] op_sel:[0,0] op_sel_hi:[1,0]
v_pk_mul_f32 v[216:217], v[216:217], v[10:11] op_sel:[0,0] op_sel_hi:[1,0]
v_pk_mul_f32 v[218:219], v[218:219], v[10:11] op_sel:[0,0] op_sel_hi:[1,0]
v_cvt_pk_bf16_f32 v200, v200, v201
v_cvt_pk_bf16_f32 v201, v202, v203
v_cvt_pk_bf16_f32 v202, v216, v217
v_cvt_pk_bf16_f32 v203, v218, v219
v_pk_add_f32 v[204:205], v[204:205], v[76:77]
v_pk_add_f32 v[206:207], v[206:207], v[78:79]
s_waitcnt lgkmcnt(0)
v_pk_add_f32 v[220:221], v[220:221], v[92:93]
v_pk_add_f32 v[222:223], v[222:223], v[94:95]
M v[24:27], a[112:115], v[200:203], v[24:27]
buffer_store_dwordx4 v[200:203], v1, s[16:19], s37 offen offset:1024 sc1
v_pk_mul_f32 v[204:205], v[204:205], v[10:11] op_sel:[0,1] op_sel_hi:[1,1]
v_pk_mul_f32 v[206:207], v[206:207], v[10:11] op_sel:[0,1] op_sel_hi:[1,1]
v_pk_mul_f32 v[220:221], v[220:221], v[10:11] op_sel:[0,1] op_sel_hi:[1,1]
v_pk_mul_f32 v[222:223], v[222:223], v[10:11] op_sel:[0,1] op_sel_hi:[1,1]
v_cvt_pk_bf16_f32 v204, v204, v205
v_cvt_pk_bf16_f32 v205, v206, v207
v_cvt_pk_bf16_f32 v206, v220, v221
v_cvt_pk_bf16_f32 v207, v222, v223
s_nop 1
M v[24:27], a[112:115], v[204:207], v[24:27]
buffer_store_dwordx4 v[204:207], v1, s[16:19], s37 offen offset:3072 sc1
v_cmp_lt_u32 vcc, 0x3c000000, v12
s_nop 5
v_cmp_class_f32 s[40:41], v24, s64
s_nop 0
s_or_b64 vcc, vcc, s[40:41]
s_cmp_lg_u64 vcc, 0
s_cselect_b32 s33, 2, 0
s_or_b32 s60, s60, s33
s_branch Lk2_chk
Lk2_wm:
s_lshl_b32 s33, s2, 1
s_add_u32 s33, s33, s23
s_lshl_b32 s34, s33, 12
s_lshl_b32 s33, s33, 14
v_lshlrev_b32 v8, 3, v1
v_lshlrev_b32 v9, 2, v1
buffer_load_dword a244, v8, s[44:47], s33 offen
s_add_u32 s33, s33, 8192
buffer_load_dword a245, v8, s[44:47], s33 offen
buffer_load_dword a246, v9, s[48:51], s34 offen
s_branch Lk2_l3b
Lk2_gt:
s_sub_u32 s39, s101, 2
s_getpc_b64 s[36:37]
Lpcg0:
s_add_u32 s36, s36, Lg1m-Lpcg0
s_addc_u32 s37, s37, 0
s_lshr_b32 s38, s2, 3
s_lshl2_add_u32 s38, s38, s101
s_mul_i32 s38, s38, (((Lk2_chk-Lg1m)/128+127)&~127)
v_lshlrev_b32 v8, 7, v0
v_min_u32 v8, (((Lk2_chk-Lg1m)/128+127)&~127)-128, v8
v_add_u32 v8, s38, v8
v_min_u32 v8, Lk2_chk-Lg1m-4, v8
global_load_dword a249, v8, s[36:37]
s_getpc_b64 s[36:37]
Lpch0:
s_add_u32 s36, s36, Lf0-Lpch0
s_addc_u32 s37, s37, -1
s_lshr_b32 s38, s2, 3
s_lshl2_add_u32 s38, s38, s101
s_mul_i32 s38, s38, (((Lk2_wm-Lf0)/128+127)&~127)
v_lshlrev_b32 v8, 7, v0
v_min_u32 v8, (((Lk2_wm-Lf0)/128+127)&~127)-128, v8
v_add_u32 v8, s38, v8
v_min_u32 v8, Lk2_wm-Lf0-4, v8
global_load_dword a251, v8, s[36:37]
s_getpc_b64 s[36:37]
Lpcg1:
s_add_u32 s36, s36, Lg1m-Lpcg1
s_addc_u32 s37, s37, 0
s_lshr_b32 s38, s2, 3
s_lshl2_add_u32 s38, s38, s39
s_mul_i32 s38, s38, (((Lk2_chk-Lg1m)/128+127)&~127)
v_lshlrev_b32 v8, 7, v0
v_min_u32 v8, (((Lk2_chk-Lg1m)/128+127)&~127)-128, v8
v_add_u32 v8, s38, v8
v_min_u32 v8, Lk2_chk-Lg1m-4, v8
global_load_dword a250, v8, s[36:37]
s_getpc_b64 s[36:37]
Lpch1:
s_add_u32 s36, s36, Lf0-Lpch1
s_addc_u32 s37, s37, -1
s_lshr_b32 s38, s2, 3
s_lshl2_add_u32 s38, s38, s39
s_mul_i32 s38, s38, (((Lk2_wm-Lf0)/128+127)&~127)
v_lshlrev_b32 v8, 7, v0
v_min_u32 v8, (((Lk2_wm-Lf0)/128+127)&~127)-128, v8
v_add_u32 v8, s38, v8
v_min_u32 v8, Lk2_wm-Lf0-4, v8
global_load_dword a252, v8, s[36:37]
s_branch Lk2_l3b
Lk2_g1:
s_mov_b32 s30, 7
s_bfe_u32 s65, s2, 0x20003
s_add_u32 s65, s65, 2
s_lshl_b32 s42, s21, 1
s_min_u32 s42, s42, 13
s_add_u32 s42, s42, 2
s_sub_u32 s33, s42, 1
s_cmp_le_u32 s33, 1
s_cselect_b32 s33, 0x4000, 0
v_add_u32 v3, s33, v3
s_sub_u32 s42, s42, 1
Lk2_l3:
s_cmp_eq_u32 s30, s65
s_cbranch_scc1 Lk2_wm
s_cmp_eq_u32 s30, 1
s_cbranch_scc1 Lk2_gt
Lk2_l3b:
s_add_u32 m0, s29, 65536
s_waitcnt lgkmcnt(4)
M v[96:99], a[116:119], a[0:3], 0
v_exp_f32 v64, v64
M v[96:99], a[120:123], a[4:7], v[96:99]
ds_read_b128 a[148:151], v2 offset:8192
ds_read_b128 a[152:155], v2 offset:9216
M v[96:99], a[124:127], a[8:11], v[96:99]
v_exp_f32 v65, v65
M v[96:99], a[128:131], a[12:15], v[96:99]
buffer_load_dwordx4 v1, s[12:15], s25 offen offset:0 sc1 lds
s_add_u32 s32, s25, 4096
M v[100:103], a[128:131], a[28:31], 0
v_exp_f32 v66, v66
M v[100:103], a[124:127], a[24:27], v[100:103]
v_cvt_pk_bf16_f32 v64, v64, v65
M v[100:103], a[120:123], a[20:23], v[100:103]
v_exp_f32 v67, v67
M v[100:103], a[116:119], a[16:19], v[100:103]
buffer_load_dwordx4 v1, s[12:15], s25 offen offset:1024 sc1 lds
M v[104:107], a[116:119], a[32:35], 0
v_exp_f32 v80, v80
M v[104:107], a[120:123], a[36:39], v[104:107]
ds_read_b128 a[156:159], v2 offset:10240
ds_read_b128 a[160:163], v2 offset:11264
M v[104:107], a[124:127], a[40:43], v[104:107]
v_exp_f32 v81, v81
M v[104:107], a[128:131], a[44:47], v[104:107]
buffer_load_dwordx4 v1, s[12:15], s25 offen offset:2048 sc1 lds
M v[108:111], a[128:131], a[60:63], 0
v_exp_f32 v82, v82
M v[108:111], a[124:127], a[56:59], v[108:111]
v_cvt_pk_bf16_f32 v65, v66, v67
v_cvt_pk_bf16_f32 v66, v80, v81
M v[108:111], a[120:123], a[52:55], v[108:111]
v_exp_f32 v83, v83
M v[108:111], a[116:119], a[48:51], v[108:111]
buffer_load_dwordx4 v1, s[12:15], s25 offen offset:3072 sc1 lds
s_add_u32 m0, s29, 69632
s_waitcnt lgkmcnt(4)
M v[112:115], a[132:135], a[0:3], 0
v_exp_f32 v68, v68
M v[112:115], a[136:139], a[4:7], v[112:115]
ds_read_b128 a[164:167], v2 offset:12288
ds_read_b128 a[168:171], v2 offset:13312
M v[112:115], a[140:143], a[8:11], v[112:115]
v_exp_f32 v69, v69
M v[112:115], a[144:147], a[12:15], v[112:115]
buffer_load_dwordx4 v1, s[12:15], s32 offen offset:0 sc1 lds
M v[116:119], a[144:147], a[28:31], 0
v_exp_f32 v70, v70
M v[116:119], a[140:143], a[24:27], v[116:119]
v_cvt_pk_bf16_f32 v67, v82, v83
v_cvt_pk_bf16_f32 v68, v68, v69
M v[116:119], a[136:139], a[20:23], v[116:119]
v_exp_f32 v71, v71
M v[116:119], a[132:135], a[16:19], v[116:119]
buffer_load_dwordx4 v1, s[12:15], s32 offen offset:1024 sc1 lds
M v[120:123], a[132:135], a[32:35], 0
v_exp_f32 v84, v84
M v[120:123], a[136:139], a[36:39], v[120:123]
ds_read_b128 a[172:175], v2 offset:14336
ds_read_b128 a[176:179], v2 offset:15360
M v[120:123], a[140:143], a[40:43], v[120:123]
v_exp_f32 v85, v85
M v[120:123], a[144:147], a[44:47], v[120:123]
buffer_load_dwordx4 v1, s[12:15], s32 offen offset:2048 sc1 lds
M v[124:127], a[144:147], a[60:63], 0
v_exp_f32 v86, v86
M v[124:127], a[140:143], a[56:59], v[124:127]
v_cvt_pk_bf16_f32 v69, v70, v71
v_cvt_pk_bf16_f32 v70, v84, v85
M v[124:127], a[136:139], a[52:55], v[124:127]
v_exp_f32 v87, v87
M v[124:127], a[132:135], a[48:51], v[124:127]
buffer_load_dwordx4 v1, s[12:15], s32 offen offset:3072 sc1 lds
s_add_u32 m0, s29, 98304
s_waitcnt lgkmcnt(4)
M v[128:131], a[148:151], a[0:3], 0
v_exp_f32 v72, v72
M v[128:131], a[152:155], a[4:7], v[128:131]
ds_read_b128 a[116:119], v5 offset:32768
ds_read_b128 a[120:123], v5 offset:40960
M v[128:131], a[156:159], a[8:11], v[128:131]
v_exp_f32 v73, v73
M v[128:131], a[160:163], a[12:15], v[128:131]
buffer_load_dwordx4 v1, s[12:15], s26 offen offset:0 sc1 lds
s_add_u32 s43, s26, 4096
M v[132:135], a[160:163], a[28:31], 0
v_exp_f32 v74, v74
M v[132:135], a[156:159], a[24:27], v[132:135]
v_cvt_pk_bf16_f32 v71, v86, v87
v_cvt_pk_bf16_f32 v72, v72, v73
M v[132:135], a[152:155], a[20:23], v[132:135]
v_exp_f32 v75, v75
M v[132:135], a[148:151], a[16:19], v[132:135]
buffer_load_dwordx4 v1, s[12:15], s26 offen offset:1024 sc1 lds
M v[136:139], a[148:151], a[32:35], 0
v_exp_f32 v88, v88
M v[136:139], a[152:155], a[36:39], v[136:139]
ds_read_b128 a[124:127], v5 offset:33792
ds_read_b128 a[128:131], v5 offset:41984
M v[136:139], a[156:159], a[40:43], v[136:139]
v_exp_f32 v89, v89
M v[136:139], a[160:163], a[44:47], v[136:139]
buffer_load_dwordx4 v1, s[12:15], s26 offen offset:2048 sc1 lds
M v[140:143], a[160:163], a[60:63], 0
v_exp_f32 v90, v90
M v[140:143], a[156:159], a[56:59], v[140:143]
v_cvt_pk_bf16_f32 v73, v74, v75
v_cvt_pk_bf16_f32 v74, v88, v89
M v[140:143], a[152:155], a[52:55], v[140:143]
v_exp_f32 v91, v91
M v[140:143], a[148:151], a[48:51], v[140:143]
buffer_load_dwordx4 v1, s[12:15], s26 offen offset:3072 sc1 lds
s_add_u32 m0, s29, 102400
s_waitcnt lgkmcnt(4)
M v[144:147], a[164:167], a[0:3], 0
v_exp_f32 v76, v76
M v[144:147], a[168:171], a[4:7], v[144:147]
ds_read_b128 a[132:135], v5 offset:34816
ds_read_b128 a[136:139], v5 offset:43008
M v[144:147], a[172:175], a[8:11], v[144:147]
v_exp_f32 v77, v77
M v[144:147], a[176:179], a[12:15], v[144:147]
buffer_load_dwordx4 v1, s[12:15], s43 offen offset:0 sc1 lds
M v[148:151], a[176:179], a[28:31], 0
v_exp_f32 v78, v78
M v[148:151], a[172:175], a[24:27], v[148:151]
v_cvt_pk_bf16_f32 v75, v90, v91
v_cvt_pk_bf16_f32 v76, v76, v77
M v[148:151], a[168:171], a[20:23], v[148:151]
v_exp_f32 v79, v79
M v[148:151], a[164:167], a[16:19], v[148:151]
buffer_load_dwordx4 v1, s[12:15], s43 offen offset:1024 sc1 lds
M v[152:155], a[164:167], a[32:35], 0
v_exp_f32 v92, v92
M v[152:155], a[168:171], a[36:39], v[152:155]
ds_read_b128 a[140:143], v5 offset:35840
ds_read_b128 a[144:147], v5 offset:44032
M v[152:155], a[172:175], a[40:43], v[152:155]
v_exp_f32 v93, v93
M v[152:155], a[176:179], a[44:47], v[152:155]
buffer_load_dwordx4 v1, s[12:15], s43 offen offset:2048 sc1 lds
M v[156:159], a[176:179], a[60:63], 0
v_exp_f32 v94, v94
M v[156:159], a[172:175], a[56:59], v[156:159]
v_cvt_pk_bf16_f32 v77, v78, v79
v_cvt_pk_bf16_f32 v78, v92, v93
M v[156:159], a[168:171], a[52:55], v[156:159]
v_exp_f32 v95, v95
M v[156:159], a[164:167], a[48:51], v[156:159]
buffer_load_dwordx4 v1, s[12:15], s43 offen offset:3072 sc1 lds
v_cvt_pk_bf16_f32 v79, v94, v95
s_waitcnt lgkmcnt(6)
M v[160:163], a[116:119], v[32:35], v[160:163]
v_exp_f32 v96, v96
M v[160:163], a[120:123], v[64:67], v[160:163]
ds_read_b128 a[148:151], v5 offset:36864
ds_read_b128 a[152:155], v5 offset:45056
M v[164:167], a[120:123], v[68:71], v[164:167]
v_exp_f32 v97, v97
M v[164:167], a[116:119], v[36:39], v[164:167]
v_cvt_pk_bf16_f32 v96, v96, v97
M v[168:171], a[116:119], v[40:43], v[168:171]
v_exp_f32 v98, v98
M v[168:171], a[120:123], v[72:75], v[168:171]
s_add_u32 s25, s25, 32768
s_cmp_eq_u32 s25, s27
M v[172:175], a[120:123], v[76:79], v[172:175]
v_exp_f32 v99, v99
M v[172:175], a[116:119], v[44:47], v[172:175]
v_cvt_pk_bf16_f32 v97, v98, v99
s_waitcnt lgkmcnt(6)
M a[96:99], a[112:115], v[32:35], a[96:99]
s_cselect_b32 s25, s28, s25
s_cselect_b32 s27, s56, s27
M a[96:99], a[112:115], v[64:67], a[96:99]
s_cselect_b32 s28, s57, s28
s_cselect_b32 s56, -1, s56
M v[176:179], a[124:127], v[32:35], v[176:179]
v_exp_f32 v112, v112
M v[176:179], a[128:131], v[64:67], v[176:179]
ds_read_b128 a[156:159], v5 offset:37888
ds_read_b128 a[160:163], v5 offset:46080
M v[180:183], a[128:131], v[68:71], v[180:183]
v_exp_f32 v113, v113
M v[180:183], a[124:127], v[36:39], v[180:183]
v_cvt_pk_bf16_f32 v98, v112, v113
M v[184:187], a[124:127], v[40:43], v[184:187]
v_exp_f32 v114, v114
M v[184:187], a[128:131], v[72:75], v[184:187]
s_add_u32 s26, s26, 32768
s_cmp_eq_u32 s26, s62
M v[188:191], a[128:131], v[76:79], v[188:191]
v_exp_f32 v115, v115
M v[188:191], a[124:127], v[44:47], v[188:191]
v_cvt_pk_bf16_f32 v99, v114, v115
s_waitcnt lgkmcnt(6)
M a[100:103], a[112:115], v[36:39], a[100:103]
s_cselect_b32 s26, s63, s26
s_cselect_b32 s62, s58, s62
M a[100:103], a[112:115], v[68:71], a[100:103]
s_cselect_b32 s63, s59, s63
s_cselect_b32 s58, -1, s58
M v[192:195], a[132:135], v[32:35], v[192:195]
v_exp_f32 v100, v100
M v[192:195], a[136:139], v[64:67], v[192:195]
ds_read_b128 a[164:167], v5 offset:38912
ds_read_b128 a[168:171], v5 offset:47104
M v[196:199], a[136:139], v[68:71], v[196:199]
v_exp_f32 v101, v101
M v[196:199], a[132:135], v[36:39], v[196:199]
v_cvt_pk_bf16_f32 v100, v100, v101
M v[200:203], a[132:135], v[40:43], v[200:203]
v_exp_f32 v102, v102
M v[200:203], a[136:139], v[72:75], v[200:203]
s_sub_u32 s33, s42, 1
s_cmp_le_u32 s33, 1
s_cselect_b32 s33, 0x4000, 0
v_add_u32 v2, s33, v2
M v[204:207], a[136:139], v[76:79], v[204:207]
v_exp_f32 v103, v103
M v[204:207], a[132:135], v[44:47], v[204:207]
v_cvt_pk_bf16_f32 v101, v102, v103
s_waitcnt lgkmcnt(6)
M a[104:107], a[112:115], v[40:43], a[104:107]
M a[104:107], a[112:115], v[72:75], a[104:107]
M v[208:211], a[140:143], v[32:35], v[208:211]
v_exp_f32 v116, v116
M v[208:211], a[144:147], v[64:67], v[208:211]
ds_read_b128 a[172:175], v5 offset:39936
ds_read_b128 a[176:179], v5 offset:48128
M v[212:215], a[144:147], v[68:71], v[212:215]
v_exp_f32 v117, v117
M v[212:215], a[140:143], v[36:39], v[212:215]
v_cvt_pk_bf16_f32 v102, v116, v117
M v[216:219], a[140:143], v[40:43], v[216:219]
v_exp_f32 v118, v118
M v[216:219], a[144:147], v[72:75], v[216:219]
M v[220:223], a[144:147], v[76:79], v[220:223]
v_exp_f32 v119, v119
M v[220:223], a[140:143], v[44:47], v[220:223]
v_cvt_pk_bf16_f32 v103, v118, v119
s_waitcnt lgkmcnt(6)
M a[108:111], a[112:115], v[44:47], a[108:111]
M a[108:111], a[112:115], v[76:79], a[108:111]
M v[224:227], a[148:151], v[32:35], v[224:227]
v_exp_f32 v104, v104
M v[224:227], a[152:155], v[64:67], v[224:227]
s_cmp_le_u32 s42, 1
s_cselect_b32 s33, 0x4000, 0
v_add_u32 v5, s33, v5
s_sub_u32 s42, s42, 1
M v[228:231], a[152:155], v[68:71], v[228:231]
v_exp_f32 v105, v105
M v[228:231], a[148:151], v[36:39], v[228:231]
v_cvt_pk_bf16_f32 v104, v104, v105
M v[232:235], a[148:151], v[40:43], v[232:235]
v_exp_f32 v106, v106
M v[232:235], a[152:155], v[72:75], v[232:235]
M v[236:239], a[152:155], v[76:79], v[236:239]
v_exp_f32 v107, v107
M v[236:239], a[148:151], v[44:47], v[236:239]
v_cvt_pk_bf16_f32 v105, v106, v107
s_waitcnt lgkmcnt(4)
M v[240:243], a[156:159], v[32:35], v[240:243]
v_exp_f32 v120, v120
M v[240:243], a[160:163], v[64:67], v[240:243]
M v[244:247], a[160:163], v[68:71], v[244:247]
v_exp_f32 v121, v121
M v[244:247], a[156:159], v[36:39], v[244:247]
v_cvt_pk_bf16_f32 v106, v120, v121
M v[248:251], a[156:159], v[40:43], v[248:251]
v_exp_f32 v122, v122
M v[248:251], a[160:163], v[72:75], v[248:251]
s_waitcnt vmcnt(0) lgkmcnt(0)
s_barrier
ds_read_b128 a[116:119], v3 offset:0
ds_read_b128 a[120:123], v3 offset:1024
M v[252:255], a[160:163], v[76:79], v[252:255]
v_exp_f32 v123, v123
M v[252:255], a[156:159], v[44:47], v[252:255]
v_cvt_pk_bf16_f32 v107, v122, v123
M a[64:67], a[164:167], v[32:35], a[64:67]
v_exp_f32 v108, v108
M a[64:67], a[168:171], v[64:67], a[64:67]
ds_read_b128 a[124:127], v3 offset:2048
ds_read_b128 a[128:131], v3 offset:3072
M a[68:71], a[168:171], v[68:71], a[68:71]
v_exp_f32 v109, v109
M a[68:71], a[164:167], v[36:39], a[68:71]
v_cvt_pk_bf16_f32 v108, v108, v109
M a[72:75], a[164:167], v[40:43], a[72:75]
v_exp_f32 v110, v110
M a[72:75], a[168:171], v[72:75], a[72:75]
ds_read_b128 a[132:135], v3 offset:4096
ds_read_b128 a[136:139], v3 offset:5120
M a[76:79], a[168:171], v[76:79], a[76:79]
v_exp_f32 v111, v111
M a[76:79], a[164:167], v[44:47], a[76:79]
v_cvt_pk_bf16_f32 v109, v110, v111
M a[80:83], a[172:175], v[32:35], a[80:83]
v_exp_f32 v124, v124
M a[80:83], a[176:179], v[64:67], a[80:83]
ds_read_b128 a[140:143], v3 offset:6144
ds_read_b128 a[144:147], v3 offset:7168
M a[84:87], a[176:179], v[68:71], a[84:87]
v_exp_f32 v125, v125
M a[84:87], a[172:175], v[36:39], a[84:87]
v_cvt_pk_bf16_f32 v110, v124, v125
M a[88:91], a[172:175], v[40:43], a[88:91]
v_exp_f32 v126, v126
M a[88:91], a[176:179], v[72:75], a[88:91]
M a[92:95], a[176:179], v[76:79], a[92:95]
v_exp_f32 v127, v127
M a[92:95], a[172:175], v[44:47], a[92:95]
v_cvt_pk_bf16_f32 v111, v126, v127
s_add_u32 m0, s29, 0
s_waitcnt lgkmcnt(4)
M v[32:35], a[116:119], a[0:3], 0
v_exp_f32 v128, v128
M v[32:35], a[120:123], a[4:7], v[32:35]
ds_read_b128 a[148:151], v3 offset:8192
ds_read_b128 a[152:155], v3 offset:9216
M v[32:35], a[124:127], a[8:11], v[32:35]
v_exp_f32 v129, v129
M v[32:35], a[128:131], a[12:15], v[32:35]
buffer_load_dwordx4 v1, s[12:15], s25 offen offset:0 sc1 lds
s_add_u32 s32, s25, 4096
M v[36:39], a[128:131], a[28:31], 0
v_exp_f32 v130, v130
M v[36:39], a[124:127], a[24:27], v[36:39]
v_cvt_pk_bf16_f32 v128, v128, v129
M v[36:39], a[120:123], a[20:23], v[36:39]
v_exp_f32 v131, v131
M v[36:39], a[116:119], a[16:19], v[36:39]
buffer_load_dwordx4 v1, s[12:15], s25 offen offset:1024 sc1 lds
M v[40:43], a[116:119], a[32:35], 0
v_exp_f32 v144, v144
M v[40:43], a[120:123], a[36:39], v[40:43]
ds_read_b128 a[156:159], v3 offset:10240
ds_read_b128 a[160:163], v3 offset:11264
M v[40:43], a[124:127], a[40:43], v[40:43]
v_exp_f32 v145, v145
M v[40:43], a[128:131], a[44:47], v[40:43]
buffer_load_dwordx4 v1, s[12:15], s25 offen offset:2048 sc1 lds
M v[44:47], a[128:131], a[60:63], 0
v_exp_f32 v146, v146
M v[44:47], a[124:127], a[56:59], v[44:47]
v_cvt_pk_bf16_f32 v129, v130, v131
v_cvt_pk_bf16_f32 v130, v144, v145
M v[44:47], a[120:123], a[52:55], v[44:47]
v_exp_f32 v147, v147
M v[44:47], a[116:119], a[48:51], v[44:47]
buffer_load_dwordx4 v1, s[12:15], s25 offen offset:3072 sc1 lds
s_add_u32 m0, s29, 4096
s_waitcnt lgkmcnt(4)
M v[48:51], a[132:135], a[0:3], 0
v_exp_f32 v132, v132
M v[48:51], a[136:139], a[4:7], v[48:51]
ds_read_b128 a[164:167], v3 offset:12288
ds_read_b128 a[168:171], v3 offset:13312
M v[48:51], a[140:143], a[8:11], v[48:51]
v_exp_f32 v133, v133
M v[48:51], a[144:147], a[12:15], v[48:51]
buffer_load_dwordx4 v1, s[12:15], s32 offen offset:0 sc1 lds
M v[52:55], a[144:147], a[28:31], 0
v_exp_f32 v134, v134
M v[52:55], a[140:143], a[24:27], v[52:55]
v_cvt_pk_bf16_f32 v131, v146, v147
v_cvt_pk_bf16_f32 v132, v132, v133
M v[52:55], a[136:139], a[20:23], v[52:55]
v_exp_f32 v135, v135
M v[52:55], a[132:135], a[16:19], v[52:55]
buffer_load_dwordx4 v1, s[12:15], s32 offen offset:1024 sc1 lds
M v[56:59], a[132:135], a[32:35], 0
v_exp_f32 v148, v148
M v[56:59], a[136:139], a[36:39], v[56:59]
ds_read_b128 a[172:175], v3 offset:14336
ds_read_b128 a[176:179], v3 offset:15360
M v[56:59], a[140:143], a[40:43], v[56:59]
v_exp_f32 v149, v149
M v[56:59], a[144:147], a[44:47], v[56:59]
buffer_load_dwordx4 v1, s[12:15], s32 offen offset:2048 sc1 lds
M v[60:63], a[144:147], a[60:63], 0
v_exp_f32 v150, v150
M v[60:63], a[140:143], a[56:59], v[60:63]
v_cvt_pk_bf16_f32 v133, v134, v135
v_cvt_pk_bf16_f32 v134, v148, v149
M v[60:63], a[136:139], a[52:55], v[60:63]
v_exp_f32 v151, v151
M v[60:63], a[132:135], a[48:51], v[60:63]
buffer_load_dwordx4 v1, s[12:15], s32 offen offset:3072 sc1 lds
s_add_u32 m0, s29, 32768
s_waitcnt lgkmcnt(4)
M v[64:67], a[148:151], a[0:3], 0
v_exp_f32 v136, v136
M v[64:67], a[152:155], a[4:7], v[64:67]
ds_read_b128 a[116:119], v6 offset:32768
ds_read_b128 a[120:123], v6 offset:40960
M v[64:67], a[156:159], a[8:11], v[64:67]
v_exp_f32 v137, v137
M v[64:67], a[160:163], a[12:15], v[64:67]
buffer_load_dwordx4 v1, s[12:15], s26 offen offset:0 sc1 lds
s_add_u32 s43, s26, 4096
M v[68:71], a[160:163], a[28:31], 0
v_exp_f32 v138, v138
M v[68:71], a[156:159], a[24:27], v[68:71]
v_cvt_pk_bf16_f32 v135, v150, v151
v_cvt_pk_bf16_f32 v136, v136, v137
M v[68:71], a[152:155], a[20:23], v[68:71]
v_exp_f32 v139, v139
M v[68:71], a[148:151], a[16:19], v[68:71]
buffer_load_dwordx4 v1, s[12:15], s26 offen offset:1024 sc1 lds
M v[72:75], a[148:151], a[32:35], 0
v_exp_f32 v152, v152
M v[72:75], a[152:155], a[36:39], v[72:75]
ds_read_b128 a[124:127], v6 offset:33792
ds_read_b128 a[128:131], v6 offset:41984
M v[72:75], a[156:159], a[40:43], v[72:75]
v_exp_f32 v153, v153
M v[72:75], a[160:163], a[44:47], v[72:75]
buffer_load_dwordx4 v1, s[12:15], s26 offen offset:2048 sc1 lds
M v[76:79], a[160:163], a[60:63], 0
v_exp_f32 v154, v154
M v[76:79], a[156:159], a[56:59], v[76:79]
v_cvt_pk_bf16_f32 v137, v138, v139
v_cvt_pk_bf16_f32 v138, v152, v153
M v[76:79], a[152:155], a[52:55], v[76:79]
v_exp_f32 v155, v155
M v[76:79], a[148:151], a[48:51], v[76:79]
buffer_load_dwordx4 v1, s[12:15], s26 offen offset:3072 sc1 lds
s_add_u32 m0, s29, 36864
s_waitcnt lgkmcnt(4)
M v[80:83], a[164:167], a[0:3], 0
v_exp_f32 v140, v140
M v[80:83], a[168:171], a[4:7], v[80:83]
ds_read_b128 a[132:135], v6 offset:34816
ds_read_b128 a[136:139], v6 offset:43008
M v[80:83], a[172:175], a[8:11], v[80:83]
v_exp_f32 v141, v141
M v[80:83], a[176:179], a[12:15], v[80:83]
buffer_load_dwordx4 v1, s[12:15], s43 offen offset:0 sc1 lds
M v[84:87], a[176:179], a[28:31], 0
v_exp_f32 v142, v142
M v[84:87], a[172:175], a[24:27], v[84:87]
v_cvt_pk_bf16_f32 v139, v154, v155
v_cvt_pk_bf16_f32 v140, v140, v141
M v[84:87], a[168:171], a[20:23], v[84:87]
v_exp_f32 v143, v143
M v[84:87], a[164:167], a[16:19], v[84:87]
buffer_load_dwordx4 v1, s[12:15], s43 offen offset:1024 sc1 lds
M v[88:91], a[164:167], a[32:35], 0
v_exp_f32 v156, v156
M v[88:91], a[168:171], a[36:39], v[88:91]
ds_read_b128 a[140:143], v6 offset:35840
ds_read_b128 a[144:147], v6 offset:44032
M v[88:91], a[172:175], a[40:43], v[88:91]
v_exp_f32 v157, v157
M v[88:91], a[176:179], a[44:47], v[88:91]
buffer_load_dwordx4 v1, s[12:15], s43 offen offset:2048 sc1 lds
M v[92:95], a[176:179], a[60:63], 0
v_exp_f32 v158, v158
M v[92:95], a[172:175], a[56:59], v[92:95]
v_cvt_pk_bf16_f32 v141, v142, v143
v_cvt_pk_bf16_f32 v142, v156, v157
M v[92:95], a[168:171], a[52:55], v[92:95]
v_exp_f32 v159, v159
M v[92:95], a[164:167], a[48:51], v[92:95]
buffer_load_dwordx4 v1, s[12:15], s43 offen offset:3072 sc1 lds
v_cvt_pk_bf16_f32 v143, v158, v159
s_waitcnt lgkmcnt(6)
M v[160:163], a[116:119], v[96:99], v[160:163]
v_exp_f32 v32, v32
M v[160:163], a[120:123], v[128:131], v[160:163]
ds_read_b128 a[148:151], v6 offset:36864
ds_read_b128 a[152:155], v6 offset:45056
M v[164:167], a[120:123], v[132:135], v[164:167]
v_exp_f32 v33, v33
M v[164:167], a[116:119], v[100:103], v[164:167]
v_cvt_pk_bf16_f32 v32, v32, v33
M v[168:171], a[116:119], v[104:107], v[168:171]
v_exp_f32 v34, v34
M v[168:171], a[120:123], v[136:139], v[168:171]
s_add_u32 s25, s25, 32768
s_cmp_eq_u32 s25, s27
M v[172:175], a[120:123], v[140:143], v[172:175]
v_exp_f32 v35, v35
M v[172:175], a[116:119], v[108:111], v[172:175]
v_cvt_pk_bf16_f32 v33, v34, v35
s_waitcnt lgkmcnt(6)
M a[96:99], a[112:115], v[96:99], a[96:99]
s_cselect_b32 s25, s28, s25
s_cselect_b32 s27, s56, s27
M a[96:99], a[112:115], v[128:131], a[96:99]
s_cselect_b32 s28, s57, s28
s_cselect_b32 s56, -1, s56
M v[176:179], a[124:127], v[96:99], v[176:179]
v_exp_f32 v48, v48
M v[176:179], a[128:131], v[128:131], v[176:179]
ds_read_b128 a[156:159], v6 offset:37888
ds_read_b128 a[160:163], v6 offset:46080
M v[180:183], a[128:131], v[132:135], v[180:183]
v_exp_f32 v49, v49
M v[180:183], a[124:127], v[100:103], v[180:183]
v_cvt_pk_bf16_f32 v34, v48, v49
M v[184:187], a[124:127], v[104:107], v[184:187]
v_exp_f32 v50, v50
M v[184:187], a[128:131], v[136:139], v[184:187]
s_add_u32 s26, s26, 32768
s_cmp_eq_u32 s26, s62
M v[188:191], a[128:131], v[140:143], v[188:191]
v_exp_f32 v51, v51
M v[188:191], a[124:127], v[108:111], v[188:191]
v_cvt_pk_bf16_f32 v35, v50, v51
s_waitcnt lgkmcnt(6)
M a[100:103], a[112:115], v[100:103], a[100:103]
s_cselect_b32 s26, s63, s26
s_cselect_b32 s62, s58, s62
M a[100:103], a[112:115], v[132:135], a[100:103]
s_cselect_b32 s63, s59, s63
s_cselect_b32 s58, -1, s58
M v[192:195], a[132:135], v[96:99], v[192:195]
v_exp_f32 v36, v36
M v[192:195], a[136:139], v[128:131], v[192:195]
ds_read_b128 a[164:167], v6 offset:38912
ds_read_b128 a[168:171], v6 offset:47104
M v[196:199], a[136:139], v[132:135], v[196:199]
v_exp_f32 v37, v37
M v[196:199], a[132:135], v[100:103], v[196:199]
v_cvt_pk_bf16_f32 v36, v36, v37
M v[200:203], a[132:135], v[104:107], v[200:203]
v_exp_f32 v38, v38
M v[200:203], a[136:139], v[136:139], v[200:203]
s_sub_u32 s33, s42, 1
s_cmp_le_u32 s33, 1
s_cselect_b32 s33, 0x4000, 0
v_add_u32 v3, s33, v3
M v[204:207], a[136:139], v[140:143], v[204:207]
v_exp_f32 v39, v39
M v[204:207], a[132:135], v[108:111], v[204:207]
v_cvt_pk_bf16_f32 v37, v38, v39
s_waitcnt lgkmcnt(6)
M a[104:107], a[112:115], v[104:107], a[104:107]
M a[104:107], a[112:115], v[136:139], a[104:107]
M v[208:211], a[140:143], v[96:99], v[208:211]
v_exp_f32 v52, v52
M v[208:211], a[144:147], v[128:131], v[208:211]
ds_read_b128 a[172:175], v6 offset:39936
ds_read_b128 a[176:179], v6 offset:48128
M v[212:215], a[144:147], v[132:135], v[212:215]
v_exp_f32 v53, v53
M v[212:215], a[140:143], v[100:103], v[212:215]
v_cvt_pk_bf16_f32 v38, v52, v53
M v[216:219], a[140:143], v[104:107], v[216:219]
v_exp_f32 v54, v54
M v[216:219], a[144:147], v[136:139], v[216:219]
M v[220:223], a[144:147], v[140:143], v[220:223]
v_exp_f32 v55, v55
M v[220:223], a[140:143], v[108:111], v[220:223]
v_cvt_pk_bf16_f32 v39, v54, v55
s_waitcnt lgkmcnt(6)
M a[108:111], a[112:115], v[108:111], a[108:111]
M a[108:111], a[112:115], v[140:143], a[108:111]
M v[224:227], a[148:151], v[96:99], v[224:227]
v_exp_f32 v40, v40
M v[224:227], a[152:155], v[128:131], v[224:227]
s_cmp_le_u32 s42, 1
s_cselect_b32 s33, 0x4000, 0
v_add_u32 v6, s33, v6
s_sub_u32 s42, s42, 1
M v[228:231], a[152:155], v[132:135], v[228:231]
v_exp_f32 v41, v41
M v[228:231], a[148:151], v[100:103], v[228:231]
v_cvt_pk_bf16_f32 v40, v40, v41
M v[232:235], a[148:151], v[104:107], v[232:235]
v_exp_f32 v42, v42
M v[232:235], a[152:155], v[136:139], v[232:235]
M v[236:239], a[152:155], v[140:143], v[236:239]
v_exp_f32 v43, v43
M v[236:239], a[148:151], v[108:111], v[236:239]
v_cvt_pk_bf16_f32 v41, v42, v43
s_waitcnt lgkmcnt(4)
M v[240:243], a[156:159], v[96:99], v[240:243]
v_exp_f32 v56, v56
M v[240:243], a[160:163], v[128:131], v[240:243]
M v[244:247], a[160:163], v[132:135], v[244:247]
v_exp_f32 v57, v57
M v[244:247], a[156:159], v[100:103], v[244:247]
v_cvt_pk_bf16_f32 v42, v56, v57
M v[248:251], a[156:159], v[104:107], v[248:251]
v_exp_f32 v58, v58
M v[248:251], a[160:163], v[136:139], v[248:251]
s_waitcnt vmcnt(0) lgkmcnt(0)
s_barrier
ds_read_b128 a[116:119], v2 offset:0
ds_read_b128 a[120:123], v2 offset:1024
M v[252:255], a[160:163], v[140:143], v[252:255]
v_exp_f32 v59, v59
M v[252:255], a[156:159], v[108:111], v[252:255]
v_cvt_pk_bf16_f32 v43, v58, v59
M a[64:67], a[164:167], v[96:99], a[64:67]
v_exp_f32 v44, v44
M a[64:67], a[168:171], v[128:131], a[64:67]
ds_read_b128 a[124:127], v2 offset:2048
ds_read_b128 a[128:131], v2 offset:3072
M a[68:71], a[168:171], v[132:135], a[68:71]
v_exp_f32 v45, v45
M a[68:71], a[164:167], v[100:103], a[68:71]
v_cvt_pk_bf16_f32 v44, v44, v45
M a[72:75], a[164:167], v[104:107], a[72:75]
v_exp_f32 v46, v46
M a[72:75], a[168:171], v[136:139], a[72:75]
ds_read_b128 a[132:135], v2 offset:4096
ds_read_b128 a[136:139], v2 offset:5120
M a[76:79], a[168:171], v[140:143], a[76:79]
v_exp_f32 v47, v47
M a[76:79], a[164:167], v[108:111], a[76:79]
v_cvt_pk_bf16_f32 v45, v46, v47
M a[80:83], a[172:175], v[96:99], a[80:83]
v_exp_f32 v60, v60
M a[80:83], a[176:179], v[128:131], a[80:83]
ds_read_b128 a[140:143], v2 offset:6144
ds_read_b128 a[144:147], v2 offset:7168
M a[84:87], a[176:179], v[132:135], a[84:87]
v_exp_f32 v61, v61
M a[84:87], a[172:175], v[100:103], a[84:87]
v_cvt_pk_bf16_f32 v46, v60, v61
M a[88:91], a[172:175], v[104:107], a[88:91]
v_exp_f32 v62, v62
M a[88:91], a[176:179], v[136:139], a[88:91]
M a[92:95], a[176:179], v[140:143], a[92:95]
v_exp_f32 v63, v63
M a[92:95], a[172:175], v[108:111], a[92:95]
v_cvt_pk_bf16_f32 v47, v62, v63
s_sub_u32 s30, s30, 1
s_cmp_lg_u32 s30, 0
s_cbranch_scc1 Lk2_l3
Lg1m:
s_cmp_eq_u32 s23, 1
s_cbranch_scc1 Lk2_g1b
s_sub_u32 s39, s101, 2
s_getpc_b64 s[36:37]
Lpce00:
s_add_u32 s36, s36, Lk2_done-Lpce00
s_addc_u32 s37, s37, 0
s_lshr_b32 s38, s2, 3
s_lshl2_add_u32 s38, s38, s101
s_mul_i32 s38, s38, (((Lo2-Lk2_done)/128+127)&~127)
v_lshlrev_b32 v8, 7, v0
v_min_u32 v8, (((Lo2-Lk2_done)/128+127)&~127)-128, v8
v_add_u32 v8, s38, v8
v_min_u32 v8, Lo2-Lk2_done-4, v8
global_load_dword a247, v8, s[36:37]
s_getpc_b64 s[36:37]
Lpce01:
s_add_u32 s36, s36, Lk2_done-Lpce01
s_addc_u32 s37, s37, 0
s_lshr_b32 s38, s2, 3
s_lshl2_add_u32 s38, s38, s39
s_mul_i32 s38, s38, (((Lo2-Lk2_done)/128+127)&~127)
v_lshlrev_b32 v8, 7, v0
v_min_u32 v8, (((Lo2-Lk2_done)/128+127)&~127)-128, v8
v_add_u32 v8, s38, v8
v_min_u32 v8, Lo2-Lk2_done-4, v8
global_load_dword a248, v8, s[36:37]
s_add_u32 m0, s29, 65536
s_waitcnt lgkmcnt(4)
M v[96:99], a[116:119], a[0:3], v[16:19]
v_exp_f32 v64, v64
M v[96:99], a[120:123], a[4:7], v[96:99]
ds_read_b128 a[148:151], v2 offset:8192
ds_read_b128 a[152:155], v2 offset:9216
M v[96:99], a[124:127], a[8:11], v[96:99]
v_exp_f32 v65, v65
M v[96:99], a[128:131], a[12:15], v[96:99]
buffer_load_dwordx4 v1, s[12:15], s25 offen offset:0 sc1 lds
s_add_u32 s32, s25, 4096
M v[100:103], a[128:131], a[28:31], 0
v_exp_f32 v66, v66
M v[100:103], a[124:127], a[24:27], v[100:103]
v_cvt_pk_bf16_f32 v64, v64, v65
M v[100:103], a[120:123], a[20:23], v[100:103]
v_exp_f32 v67, v67
M v[100:103], a[116:119], a[16:19], v[100:103]
buffer_load_dwordx4 v1, s[12:15], s25 offen offset:1024 sc1 lds
M v[104:107], a[116:119], a[32:35], 0
v_exp_f32 v80, v80
M v[104:107], a[120:123], a[36:39], v[104:107]
ds_read_b128 a[156:159], v2 offset:10240
ds_read_b128 a[160:163], v2 offset:11264
M v[104:107], a[124:127], a[40:43], v[104:107]
v_exp_f32 v81, v81
M v[104:107], a[128:131], a[44:47], v[104:107]
buffer_load_dwordx4 v1, s[12:15], s25 offen offset:2048 sc1 lds
M v[108:111], a[128:131], a[60:63], 0
v_exp_f32 v82, v82
M v[108:111], a[124:127], a[56:59], v[108:111]
v_cvt_pk_bf16_f32 v65, v66, v67
v_cvt_pk_bf16_f32 v66, v80, v81
M v[108:111], a[120:123], a[52:55], v[108:111]
v_exp_f32 v83, v83
M v[108:111], a[116:119], a[48:51], v[108:111]
buffer_load_dwordx4 v1, s[12:15], s25 offen offset:3072 sc1 lds
s_add_u32 m0, s29, 69632
s_waitcnt lgkmcnt(4)
v_exp_f32 v68, v68
ds_read_b128 a[164:167], v2 offset:12288
ds_read_b128 a[168:171], v2 offset:13312
v_exp_f32 v69, v69
buffer_load_dwordx4 v1, s[12:15], s32 offen offset:0 sc1 lds
M v[116:119], a[144:147], a[28:31], v[16:19]
v_exp_f32 v70, v70
M v[116:119], a[140:143], a[24:27], v[116:119]
v_cvt_pk_bf16_f32 v67, v82, v83
v_cvt_pk_bf16_f32 v68, v68, v69
M v[116:119], a[136:139], a[20:23], v[116:119]
v_exp_f32 v71, v71
M v[116:119], a[132:135], a[16:19], v[116:119]
buffer_load_dwordx4 v1, s[12:15], s32 offen offset:1024 sc1 lds
M v[120:123], a[132:135], a[32:35], 0
v_exp_f32 v84, v84
M v[120:123], a[136:139], a[36:39], v[120:123]
ds_read_b128 a[172:175], v2 offset:14336
ds_read_b128 a[176:179], v2 offset:15360
M v[120:123], a[140:143], a[40:43], v[120:123]
v_exp_f32 v85, v85
M v[120:123], a[144:147], a[44:47], v[120:123]
buffer_load_dwordx4 v1, s[12:15], s32 offen offset:2048 sc1 lds
M v[124:127], a[144:147], a[60:63], 0
v_exp_f32 v86, v86
M v[124:127], a[140:143], a[56:59], v[124:127]
v_cvt_pk_bf16_f32 v69, v70, v71
v_cvt_pk_bf16_f32 v70, v84, v85
M v[124:127], a[136:139], a[52:55], v[124:127]
v_exp_f32 v87, v87
M v[124:127], a[132:135], a[48:51], v[124:127]
buffer_load_dwordx4 v1, s[12:15], s32 offen offset:3072 sc1 lds
s_add_u32 m0, s29, 98304
s_waitcnt lgkmcnt(4)
v_exp_f32 v72, v72
ds_read_b128 a[116:119], v5 offset:32768
ds_read_b128 a[120:123], v5 offset:40960
v_exp_f32 v73, v73
buffer_load_dwordx4 v1, s[12:15], s26 offen offset:0 sc1 lds
s_add_u32 s43, s26, 4096
v_exp_f32 v74, v74
v_cvt_pk_bf16_f32 v71, v86, v87
v_cvt_pk_bf16_f32 v72, v72, v73
v_exp_f32 v75, v75
buffer_load_dwordx4 v1, s[12:15], s26 offen offset:1024 sc1 lds
M v[136:139], a[148:151], a[32:35], v[16:19]
v_exp_f32 v88, v88
M v[136:139], a[152:155], a[36:39], v[136:139]
ds_read_b128 a[124:127], v5 offset:33792
ds_read_b128 a[128:131], v5 offset:41984
M v[136:139], a[156:159], a[40:43], v[136:139]
v_exp_f32 v89, v89
M v[136:139], a[160:163], a[44:47], v[136:139]
buffer_load_dwordx4 v1, s[12:15], s26 offen offset:2048 sc1 lds
M v[140:143], a[160:163], a[60:63], 0
v_exp_f32 v90, v90
M v[140:143], a[156:159], a[56:59], v[140:143]
v_cvt_pk_bf16_f32 v73, v74, v75
v_cvt_pk_bf16_f32 v74, v88, v89
M v[140:143], a[152:155], a[52:55], v[140:143]
v_exp_f32 v91, v91
M v[140:143], a[148:151], a[48:51], v[140:143]
buffer_load_dwordx4 v1, s[12:15], s26 offen offset:3072 sc1 lds
s_add_u32 m0, s29, 102400
s_waitcnt lgkmcnt(4)
v_exp_f32 v76, v76
ds_read_b128 a[132:135], v5 offset:34816
ds_read_b128 a[136:139], v5 offset:43008
v_exp_f32 v77, v77
buffer_load_dwordx4 v1, s[12:15], s43 offen offset:0 sc1 lds
v_exp_f32 v78, v78
v_cvt_pk_bf16_f32 v75, v90, v91
v_cvt_pk_bf16_f32 v76, v76, v77
v_exp_f32 v79, v79
buffer_load_dwordx4 v1, s[12:15], s43 offen offset:1024 sc1 lds
v_exp_f32 v92, v92
ds_read_b128 a[140:143], v5 offset:35840
ds_read_b128 a[144:147], v5 offset:44032
v_exp_f32 v93, v93
buffer_load_dwordx4 v1, s[12:15], s43 offen offset:2048 sc1 lds
M v[156:159], a[176:179], a[60:63], v[16:19]
v_exp_f32 v94, v94
M v[156:159], a[172:175], a[56:59], v[156:159]
v_cvt_pk_bf16_f32 v77, v78, v79
v_cvt_pk_bf16_f32 v78, v92, v93
M v[156:159], a[168:171], a[52:55], v[156:159]
v_exp_f32 v95, v95
M v[156:159], a[164:167], a[48:51], v[156:159]
buffer_load_dwordx4 v1, s[12:15], s43 offen offset:3072 sc1 lds
v_cvt_pk_bf16_f32 v79, v94, v95
s_waitcnt lgkmcnt(6)
M v[160:163], a[116:119], v[32:35], v[160:163]
v_exp_f32 v96, v96
M v[160:163], a[120:123], v[64:67], v[160:163]
ds_read_b128 a[148:151], v5 offset:36864
ds_read_b128 a[152:155], v5 offset:45056
M v[164:167], a[120:123], v[68:71], v[164:167]
v_exp_f32 v97, v97
M v[164:167], a[116:119], v[36:39], v[164:167]
v_cvt_pk_bf16_f32 v96, v96, v97
M v[168:171], a[116:119], v[40:43], v[168:171]
v_exp_f32 v98, v98
M v[168:171], a[120:123], v[72:75], v[168:171]
s_add_u32 s25, s25, 32768
s_cmp_eq_u32 s25, s27
M v[172:175], a[120:123], v[76:79], v[172:175]
v_exp_f32 v99, v99
M v[172:175], a[116:119], v[44:47], v[172:175]
v_cvt_pk_bf16_f32 v97, v98, v99
s_waitcnt lgkmcnt(6)
M a[96:99], a[112:115], v[32:35], a[96:99]
s_cselect_b32 s25, s28, s25
s_cselect_b32 s27, s56, s27
M a[96:99], a[112:115], v[64:67], a[96:99]
s_cselect_b32 s28, s57, s28
s_cselect_b32 s56, -1, s56
M v[176:179], a[124:127], v[32:35], v[176:179]
M v[176:179], a[128:131], v[64:67], v[176:179]
ds_read_b128 a[156:159], v5 offset:37888
ds_read_b128 a[160:163], v5 offset:46080
M v[180:183], a[128:131], v[68:71], v[180:183]
M v[180:183], a[124:127], v[36:39], v[180:183]
v_mov_b32 v98, 0
M v[184:187], a[124:127], v[40:43], v[184:187]
M v[184:187], a[128:131], v[72:75], v[184:187]
s_add_u32 s26, s26, 32768
s_cmp_eq_u32 s26, s62
M v[188:191], a[128:131], v[76:79], v[188:191]
M v[188:191], a[124:127], v[44:47], v[188:191]
v_mov_b32 v99, 0
s_waitcnt lgkmcnt(6)
M a[100:103], a[112:115], v[36:39], a[100:103]
s_cselect_b32 s26, s63, s26
s_cselect_b32 s62, s58, s62
M a[100:103], a[112:115], v[68:71], a[100:103]
s_cselect_b32 s63, s59, s63
s_cselect_b32 s58, -1, s58
M v[192:195], a[132:135], v[32:35], v[192:195]
v_exp_f32 v100, v100
M v[192:195], a[136:139], v[64:67], v[192:195]
ds_read_b128 a[164:167], v5 offset:38912
ds_read_b128 a[168:171], v5 offset:47104
M v[196:199], a[136:139], v[68:71], v[196:199]
v_exp_f32 v101, v101
M v[196:199], a[132:135], v[36:39], v[196:199]
v_cvt_pk_bf16_f32 v100, v100, v101
M v[200:203], a[132:135], v[40:43], v[200:203]
v_exp_f32 v102, v102
M v[200:203], a[136:139], v[72:75], v[200:203]
s_sub_u32 s33, s42, 1
s_cmp_le_u32 s33, 1
s_cselect_b32 s33, 0x4000, 0
v_add_u32 v2, s33, v2
M v[204:207], a[136:139], v[76:79], v[204:207]
v_exp_f32 v103, v103
M v[204:207], a[132:135], v[44:47], v[204:207]
v_cvt_pk_bf16_f32 v101, v102, v103
s_waitcnt lgkmcnt(6)
M a[104:107], a[112:115], v[40:43], a[104:107]
M a[104:107], a[112:115], v[72:75], a[104:107]
M v[208:211], a[140:143], v[32:35], v[208:211]
v_exp_f32 v116, v116
M v[208:211], a[144:147], v[64:67], v[208:211]
ds_read_b128 a[172:175], v5 offset:39936
ds_read_b128 a[176:179], v5 offset:48128
M v[212:215], a[144:147], v[68:71], v[212:215]
v_exp_f32 v117, v117
M v[212:215], a[140:143], v[36:39], v[212:215]
v_cvt_pk_bf16_f32 v102, v116, v117
M v[216:219], a[140:143], v[40:43], v[216:219]
v_exp_f32 v118, v118
M v[216:219], a[144:147], v[72:75], v[216:219]
M v[220:223], a[144:147], v[76:79], v[220:223]
v_exp_f32 v119, v119
M v[220:223], a[140:143], v[44:47], v[220:223]
v_cvt_pk_bf16_f32 v103, v118, v119
s_waitcnt lgkmcnt(6)
M a[108:111], a[112:115], v[44:47], a[108:111]
M a[108:111], a[112:115], v[76:79], a[108:111]
M v[224:227], a[148:151], v[32:35], v[224:227]
v_exp_f32 v104, v104
M v[224:227], a[152:155], v[64:67], v[224:227]
s_cmp_le_u32 s42, 1
s_cselect_b32 s33, 0x4000, 0
v_add_u32 v5, s33, v5
s_sub_u32 s42, s42, 1
M v[228:231], a[152:155], v[68:71], v[228:231]
v_exp_f32 v105, v105
M v[228:231], a[148:151], v[36:39], v[228:231]
v_cvt_pk_bf16_f32 v104, v104, v105
M v[232:235], a[148:151], v[40:43], v[232:235]
v_exp_f32 v106, v106
M v[232:235], a[152:155], v[72:75], v[232:235]
M v[236:239], a[152:155], v[76:79], v[236:239]
v_exp_f32 v107, v107
M v[236:239], a[148:151], v[44:47], v[236:239]
v_cvt_pk_bf16_f32 v105, v106, v107
s_waitcnt lgkmcnt(4)
M v[240:243], a[156:159], v[32:35], v[240:243]
v_exp_f32 v120, v120
M v[240:243], a[160:163], v[64:67], v[240:243]
M v[244:247], a[160:163], v[68:71], v[244:247]
v_exp_f32 v121, v121
M v[244:247], a[156:159], v[36:39], v[244:247]
v_cvt_pk_bf16_f32 v106, v120, v121
M v[248:251], a[156:159], v[40:43], v[248:251]
v_exp_f32 v122, v122
M v[248:251], a[160:163], v[72:75], v[248:251]
s_waitcnt vmcnt(0) lgkmcnt(0)
s_barrier
ds_read_b128 a[116:119], v3 offset:0
ds_read_b128 a[120:123], v3 offset:1024
M v[252:255], a[160:163], v[76:79], v[252:255]
v_exp_f32 v123, v123
M v[252:255], a[156:159], v[44:47], v[252:255]
v_cvt_pk_bf16_f32 v107, v122, v123
M a[64:67], a[164:167], v[32:35], a[64:67]
v_exp_f32 v108, v108
M a[64:67], a[168:171], v[64:67], a[64:67]
ds_read_b128 a[124:127], v3 offset:2048
ds_read_b128 a[128:131], v3 offset:3072
M a[68:71], a[168:171], v[68:71], a[68:71]
v_exp_f32 v109, v109
M a[68:71], a[164:167], v[36:39], a[68:71]
v_cvt_pk_bf16_f32 v108, v108, v109
M a[72:75], a[164:167], v[40:43], a[72:75]
v_exp_f32 v110, v110
M a[72:75], a[168:171], v[72:75], a[72:75]
ds_read_b128 a[132:135], v3 offset:4096
ds_read_b128 a[136:139], v3 offset:5120
M a[76:79], a[168:171], v[76:79], a[76:79]
v_exp_f32 v111, v111
M a[76:79], a[164:167], v[44:47], a[76:79]
v_cvt_pk_bf16_f32 v109, v110, v111
M a[80:83], a[172:175], v[32:35], a[80:83]
v_exp_f32 v124, v124
M a[80:83], a[176:179], v[64:67], a[80:83]
ds_read_b128 a[140:143], v3 offset:6144
ds_read_b128 a[144:147], v3 offset:7168
M a[84:87], a[176:179], v[68:71], a[84:87]
v_exp_f32 v125, v125
M a[84:87], a[172:175], v[36:39], a[84:87]
v_cvt_pk_bf16_f32 v110, v124, v125
M a[88:91], a[172:175], v[40:43], a[88:91]
v_exp_f32 v126, v126
M a[88:91], a[176:179], v[72:75], a[88:91]
M a[92:95], a[176:179], v[76:79], a[92:95]
v_exp_f32 v127, v127
M a[92:95], a[172:175], v[44:47], a[92:95]
v_cvt_pk_bf16_f32 v111, v126, v127
s_add_u32 m0, s29, 0
s_nop 0
buffer_load_dwordx4 v1, s[12:15], s25 offen offset:0 sc1 lds
s_add_u32 s32, s25, 4096
buffer_load_dwordx4 v1, s[12:15], s25 offen offset:1024 sc1 lds
buffer_load_dwordx4 v1, s[12:15], s25 offen offset:2048 sc1 lds
buffer_load_dwordx4 v1, s[12:15], s25 offen offset:3072 sc1 lds
s_add_u32 m0, s29, 4096
s_nop 0
buffer_load_dwordx4 v1, s[12:15], s32 offen offset:0 sc1 lds
buffer_load_dwordx4 v1, s[12:15], s32 offen offset:1024 sc1 lds
buffer_load_dwordx4 v1, s[12:15], s32 offen offset:2048 sc1 lds
buffer_load_dwordx4 v1, s[12:15], s32 offen offset:3072 sc1 lds
s_add_u32 m0, s29, 32768
v_exp_f32 v136, v136
s_waitcnt lgkmcnt(7)
ds_read_b128 a[116:119], v6 offset:32768
s_waitcnt lgkmcnt(7)
ds_read_b128 a[120:123], v6 offset:40960
v_exp_f32 v137, v137
buffer_load_dwordx4 v1, s[12:15], s26 offen offset:0 sc1 lds
s_add_u32 s43, s26, 4096
v_exp_f32 v138, v138
v_cvt_pk_bf16_f32 v136, v136, v137
v_exp_f32 v139, v139
buffer_load_dwordx4 v1, s[12:15], s26 offen offset:1024 sc1 lds
s_waitcnt lgkmcnt(7)
ds_read_b128 a[124:127], v6 offset:33792
s_waitcnt lgkmcnt(7)
ds_read_b128 a[128:131], v6 offset:41984
buffer_load_dwordx4 v1, s[12:15], s26 offen offset:2048 sc1 lds
v_cvt_pk_bf16_f32 v137, v138, v139
v_mov_b32 v138, 0
buffer_load_dwordx4 v1, s[12:15], s26 offen offset:3072 sc1 lds
s_add_u32 m0, s29, 36864
v_exp_f32 v140, v140
s_waitcnt lgkmcnt(7)
ds_read_b128 a[132:135], v6 offset:34816
s_waitcnt lgkmcnt(7)
ds_read_b128 a[136:139], v6 offset:43008
v_exp_f32 v141, v141
buffer_load_dwordx4 v1, s[12:15], s43 offen offset:0 sc1 lds
v_exp_f32 v142, v142
v_mov_b32 v139, 0
v_cvt_pk_bf16_f32 v140, v140, v141
v_exp_f32 v143, v143
buffer_load_dwordx4 v1, s[12:15], s43 offen offset:1024 sc1 lds
v_exp_f32 v156, v156
s_waitcnt lgkmcnt(7)
ds_read_b128 a[140:143], v6 offset:35840
s_waitcnt lgkmcnt(7)
ds_read_b128 a[144:147], v6 offset:44032
v_exp_f32 v157, v157
buffer_load_dwordx4 v1, s[12:15], s43 offen offset:2048 sc1 lds
v_exp_f32 v158, v158
v_cvt_pk_bf16_f32 v141, v142, v143
v_cvt_pk_bf16_f32 v142, v156, v157
v_exp_f32 v159, v159
buffer_load_dwordx4 v1, s[12:15], s43 offen offset:3072 sc1 lds
v_cvt_pk_bf16_f32 v143, v158, v159
s_waitcnt lgkmcnt(6)
M v[160:163], a[116:119], v[96:99], v[160:163]
ds_read_b128 a[148:151], v6 offset:36864
ds_read_b128 a[152:155], v6 offset:45056
M v[164:167], a[116:119], v[100:103], v[164:167]
M v[168:171], a[116:119], v[104:107], v[168:171]
M v[168:171], a[120:123], v[136:139], v[168:171]
s_add_u32 s25, s25, 32768
s_cmp_eq_u32 s25, s27
M v[172:175], a[120:123], v[140:143], v[172:175]
M v[172:175], a[116:119], v[108:111], v[172:175]
s_waitcnt lgkmcnt(6)
M a[96:99], a[112:115], v[96:99], a[96:99]
s_cselect_b32 s25, s28, s25
s_cselect_b32 s27, s56, s27
s_cselect_b32 s28, s57, s28
s_cselect_b32 s56, -1, s56
M v[176:179], a[124:127], v[96:99], v[176:179]
ds_read_b128 a[156:159], v6 offset:37888
ds_read_b128 a[160:163], v6 offset:46080
M v[180:183], a[124:127], v[100:103], v[180:183]
M v[184:187], a[124:127], v[104:107], v[184:187]
M v[184:187], a[128:131], v[136:139], v[184:187]
s_add_u32 s26, s26, 32768
s_cmp_eq_u32 s26, s62
M v[188:191], a[128:131], v[140:143], v[188:191]
M v[188:191], a[124:127], v[108:111], v[188:191]
s_waitcnt lgkmcnt(6)
M a[100:103], a[112:115], v[100:103], a[100:103]
s_cselect_b32 s26, s63, s26
s_cselect_b32 s62, s58, s62
s_cselect_b32 s63, s59, s63
s_cselect_b32 s58, -1, s58
M v[192:195], a[132:135], v[96:99], v[192:195]
ds_read_b128 a[164:167], v6 offset:38912
ds_read_b128 a[168:171], v6 offset:47104
M v[196:199], a[132:135], v[100:103], v[196:199]
M v[200:203], a[132:135], v[104:107], v[200:203]
M v[200:203], a[136:139], v[136:139], v[200:203]
s_sub_u32 s33, s42, 1
s_cmp_le_u32 s33, 1
s_cselect_b32 s33, 0x4000, 0
v_add_u32 v3, s33, v3
M v[204:207], a[136:139], v[140:143], v[204:207]
M v[204:207], a[132:135], v[108:111], v[204:207]
s_waitcnt lgkmcnt(6)
M a[104:107], a[112:115], v[104:107], a[104:107]
M a[104:107], a[112:115], v[136:139], a[104:107]
M v[208:211], a[140:143], v[96:99], v[208:211]
ds_read_b128 a[172:175], v6 offset:39936
ds_read_b128 a[176:179], v6 offset:48128
M v[212:215], a[140:143], v[100:103], v[212:215]
M v[216:219], a[140:143], v[104:107], v[216:219]
M v[216:219], a[144:147], v[136:139], v[216:219]
M v[220:223], a[144:147], v[140:143], v[220:223]
M v[220:223], a[140:143], v[108:111], v[220:223]
s_waitcnt lgkmcnt(6)
M a[108:111], a[112:115], v[108:111], a[108:111]
M a[108:111], a[112:115], v[140:143], a[108:111]
M v[224:227], a[148:151], v[96:99], v[224:227]
s_cmp_le_u32 s42, 1
s_cselect_b32 s33, 0x4000, 0
v_add_u32 v6, s33, v6
s_sub_u32 s42, s42, 1
M v[228:231], a[148:151], v[100:103], v[228:231]
M v[232:235], a[148:151], v[104:107], v[232:235]
M v[232:235], a[152:155], v[136:139], v[232:235]
M v[236:239], a[152:155], v[140:143], v[236:239]
M v[236:239], a[148:151], v[108:111], v[236:239]
s_waitcnt lgkmcnt(4)
M v[240:243], a[156:159], v[96:99], v[240:243]
M v[244:247], a[156:159], v[100:103], v[244:247]
M v[248:251], a[156:159], v[104:107], v[248:251]
M v[248:251], a[160:163], v[136:139], v[248:251]
s_waitcnt vmcnt(0) lgkmcnt(0)
s_barrier
ds_read_b128 a[116:119], v2 offset:0
ds_read_b128 a[120:123], v2 offset:1024
M v[252:255], a[160:163], v[140:143], v[252:255]
M v[252:255], a[156:159], v[108:111], v[252:255]
M a[64:67], a[164:167], v[96:99], a[64:67]
ds_read_b128 a[124:127], v2 offset:2048
ds_read_b128 a[128:131], v2 offset:3072
M a[68:71], a[164:167], v[100:103], a[68:71]
M a[72:75], a[164:167], v[104:107], a[72:75]
M a[72:75], a[168:171], v[136:139], a[72:75]
ds_read_b128 a[132:135], v2 offset:4096
ds_read_b128 a[136:139], v2 offset:5120
M a[76:79], a[168:171], v[140:143], a[76:79]
M a[76:79], a[164:167], v[108:111], a[76:79]
M a[80:83], a[172:175], v[96:99], a[80:83]
ds_read_b128 a[140:143], v2 offset:6144
ds_read_b128 a[144:147], v2 offset:7168
M a[84:87], a[172:175], v[100:103], a[84:87]
M a[88:91], a[172:175], v[104:107], a[88:91]
M a[88:91], a[176:179], v[136:139], a[88:91]
M a[92:95], a[176:179], v[140:143], a[92:95]
M a[92:95], a[172:175], v[108:111], a[92:95]
s_and_b32 s3, s2, 3
s_lshl_b32 s3, s3, 2
s_bfe_u32 s27, s2, 0x20003
s_add_u32 s27, s3, s27
s_lshl_b32 s43, s27, 8
s_add_u32 s43, s43, 16789504
v_lshlrev_b32 v15, 2, v0
buffer_load_dword v7, v15, s[52:55], s43 offen sc1
s_lshl_b32 s33, s23, 14
s_add_u32 s34, s33, 131072
s_add_u32 s33, s33, 98304
v_add_u32 v2, s34, v1
v_add_u32 v3, s33, v1
s_mov_b32 s61, 0
s_bfe_u32 s3, s2, 0x10002
s_lshl_b32 s3, s3, 3
s_lshr_b32 s28, s2, 5
s_add_u32 s28, s3, s28
s_lshl_b32 s25, s27, 18
s_lshl_b32 s3, s101, 12
s_add_u32 s25, s25, s3
s_lshl_b32 s26, s28, 7
s_lshl_b32 s42, s101, 11
s_add_u32 s44, s4, 83886080
s_addc_u32 s45, s5, 0
s_mov_b32 s46, 4194304
s_mov_b32 s47, 0x00020000
s_mov_b32 s50, 2097152
s_mov_b32 s51, 0x00020000
s_lshl_b32 s3, s101, 4
v_lshrrev_b32 v96, 3, v0
v_and_b32 v97, 6, v96
ds_write_b128 v2, v[160:163] offset:0
v_and_b32 v98, 7, v0
ds_write_b128 v2, v[164:167] offset:1024
v_xor_b32 v97, v97, v98
ds_write_b128 v2, v[168:171] offset:2048
v_add_u32 v96, s3, v96
ds_write_b128 v2, v[172:175] offset:3072
v_lshlrev_b32 v96, 11, v96
ds_write_b128 v2, v[176:179] offset:4096
v_lshl_add_u32 v99, v97, 4, v96
v_add_u32 v100, 15360, v99
ds_write_b128 v2, v[180:183] offset:5120
s_waitcnt vmcnt(0) lgkmcnt(0)
s_barrier
ds_write_b128 v2, v[184:187] offset:6144
v_cmp_ne_u32 vcc, 1, v7
s_nop 0
s_cbranch_vccnz Lk3_spinb3
Lk3_gotb3:
s_add_u32 m0, s42, 16384
s_nop 0
buffer_load_dwordx4 v99, s[48:51], s26 offen offset:0 lds
ds_write_b128 v2, v[188:191] offset:7168
buffer_load_dwordx4 v100, s[48:51], s26 offen offset:1024 lds
ds_write_b128 v2, v[192:195] offset:8192
buffer_load_dwordx4 a[192:195], v1, s[44:47], s25 offen offset:0 sc1
buffer_load_dwordx4 a[196:199], v1, s[44:47], s25 offen offset:1024 sc1
ds_write_b128 v2, v[196:199] offset:9216
buffer_load_dwordx4 a[200:203], v1, s[44:47], s25 offen offset:2048 sc1
buffer_load_dwordx4 a[204:207], v1, s[44:47], s25 offen offset:3072 sc1
ds_write_b128 v2, v[200:203] offset:10240
s_add_u32 s25, s25, 16384
s_add_u32 s26, s26, 131072
ds_write_b128 v2, v[204:207] offset:11264
s_add_u32 m0, s42, 32768
s_nop 0
buffer_load_dwordx4 v99, s[48:51], s26 offen offset:0 lds
buffer_load_dwordx4 v100, s[48:51], s26 offen offset:1024 lds
ds_write_b128 v2, v[208:211] offset:12288
buffer_load_dwordx4 a[224:227], v1, s[44:47], s25 offen offset:0 sc1
ds_write_b128 v2, v[212:215] offset:13312
buffer_load_dwordx4 a[228:231], v1, s[44:47], s25 offen offset:1024 sc1
buffer_load_dwordx4 a[232:235], v1, s[44:47], s25 offen offset:2048 sc1
ds_write_b128 v2, v[216:219] offset:14336
buffer_load_dwordx4 a[236:239], v1, s[44:47], s25 offen offset:3072 sc1
s_add_u32 s25, s25, 16384
s_add_u32 s26, s26, 131072
ds_write_b128 v2, v[220:223] offset:15360
s_waitcnt lgkmcnt(0)
s_branch Lk2_mg1
Lk2_g1b:
s_sub_u32 s39, s101, 2
s_getpc_b64 s[36:37]
Lpce10:
s_add_u32 s36, s36, Lk2_done-Lpce10
s_addc_u32 s37, s37, 0
s_lshr_b32 s38, s2, 3
s_lshl2_add_u32 s38, s38, s101
s_mul_i32 s38, s38, (((Lo2-Lk2_done)/128+127)&~127)
v_lshlrev_b32 v8, 7, v0
v_min_u32 v8, (((Lo2-Lk2_done)/128+127)&~127)-128, v8
v_add_u32 v8, s38, v8
v_min_u32 v8, Lo2-Lk2_done-4, v8
global_load_dword a247, v8, s[36:37]
s_getpc_b64 s[36:37]
Lpce11:
s_add_u32 s36, s36, Lk2_done-Lpce11
s_addc_u32 s37, s37, 0
s_lshr_b32 s38, s2, 3
s_lshl2_add_u32 s38, s38, s39
s_mul_i32 s38, s38, (((Lo2-Lk2_done)/128+127)&~127)
v_lshlrev_b32 v8, 7, v0
v_min_u32 v8, (((Lo2-Lk2_done)/128+127)&~127)-128, v8
v_add_u32 v8, s38, v8
v_min_u32 v8, Lo2-Lk2_done-4, v8
global_load_dword a248, v8, s[36:37]
s_add_u32 m0, s29, 65536
s_waitcnt lgkmcnt(4)
M v[96:99], a[116:119], a[0:3], 0
v_exp_f32 v64, v64
M v[96:99], a[120:123], a[4:7], v[96:99]
ds_read_b128 a[148:151], v2 offset:8192
ds_read_b128 a[152:155], v2 offset:9216
M v[96:99], a[124:127], a[8:11], v[96:99]
v_exp_f32 v65, v65
M v[96:99], a[128:131], a[12:15], v[96:99]
buffer_load_dwordx4 v1, s[12:15], s25 offen offset:0 sc1 lds
s_add_u32 s32, s25, 4096
M v[100:103], a[128:131], a[28:31], 0
v_exp_f32 v66, v66
M v[100:103], a[124:127], a[24:27], v[100:103]
v_cvt_pk_bf16_f32 v64, v64, v65
M v[100:103], a[120:123], a[20:23], v[100:103]
v_exp_f32 v67, v67
M v[100:103], a[116:119], a[16:19], v[100:103]
buffer_load_dwordx4 v1, s[12:15], s25 offen offset:1024 sc1 lds
M v[104:107], a[116:119], a[32:35], 0
v_exp_f32 v80, v80
M v[104:107], a[120:123], a[36:39], v[104:107]
ds_read_b128 a[156:159], v2 offset:10240
ds_read_b128 a[160:163], v2 offset:11264
M v[104:107], a[124:127], a[40:43], v[104:107]
v_exp_f32 v81, v81
M v[104:107], a[128:131], a[44:47], v[104:107]
buffer_load_dwordx4 v1, s[12:15], s25 offen offset:2048 sc1 lds
M v[108:111], a[128:131], a[60:63], 0
v_exp_f32 v82, v82
M v[108:111], a[124:127], a[56:59], v[108:111]
v_cvt_pk_bf16_f32 v65, v66, v67
v_cvt_pk_bf16_f32 v66, v80, v81
M v[108:111], a[120:123], a[52:55], v[108:111]
v_exp_f32 v83, v83
M v[108:111], a[116:119], a[48:51], v[108:111]
buffer_load_dwordx4 v1, s[12:15], s25 offen offset:3072 sc1 lds
s_add_u32 m0, s29, 69632
s_waitcnt lgkmcnt(4)
M v[112:115], a[132:135], a[0:3], 0
v_exp_f32 v68, v68
M v[112:115], a[136:139], a[4:7], v[112:115]
ds_read_b128 a[164:167], v2 offset:12288
ds_read_b128 a[168:171], v2 offset:13312
M v[112:115], a[140:143], a[8:11], v[112:115]
v_exp_f32 v69, v69
M v[112:115], a[144:147], a[12:15], v[112:115]
buffer_load_dwordx4 v1, s[12:15], s32 offen offset:0 sc1 lds
M v[116:119], a[144:147], a[28:31], 0
v_exp_f32 v70, v70
M v[116:119], a[140:143], a[24:27], v[116:119]
v_cvt_pk_bf16_f32 v67, v82, v83
v_cvt_pk_bf16_f32 v68, v68, v69
M v[116:119], a[136:139], a[20:23], v[116:119]
v_exp_f32 v71, v71
M v[116:119], a[132:135], a[16:19], v[116:119]
buffer_load_dwordx4 v1, s[12:15], s32 offen offset:1024 sc1 lds
M v[120:123], a[132:135], a[32:35], 0
v_exp_f32 v84, v84
M v[120:123], a[136:139], a[36:39], v[120:123]
ds_read_b128 a[172:175], v2 offset:14336
ds_read_b128 a[176:179], v2 offset:15360
M v[120:123], a[140:143], a[40:43], v[120:123]
v_exp_f32 v85, v85
M v[120:123], a[144:147], a[44:47], v[120:123]
buffer_load_dwordx4 v1, s[12:15], s32 offen offset:2048 sc1 lds
M v[124:127], a[144:147], a[60:63], 0
v_exp_f32 v86, v86
M v[124:127], a[140:143], a[56:59], v[124:127]
v_cvt_pk_bf16_f32 v69, v70, v71
v_cvt_pk_bf16_f32 v70, v84, v85
M v[124:127], a[136:139], a[52:55], v[124:127]
v_exp_f32 v87, v87
M v[124:127], a[132:135], a[48:51], v[124:127]
buffer_load_dwordx4 v1, s[12:15], s32 offen offset:3072 sc1 lds
s_add_u32 m0, s29, 98304
s_waitcnt lgkmcnt(4)
M v[128:131], a[148:151], a[0:3], 0
v_exp_f32 v72, v72
M v[128:131], a[152:155], a[4:7], v[128:131]
ds_read_b128 a[116:119], v5 offset:32768
ds_read_b128 a[120:123], v5 offset:40960
M v[128:131], a[156:159], a[8:11], v[128:131]
v_exp_f32 v73, v73
M v[128:131], a[160:163], a[12:15], v[128:131]
buffer_load_dwordx4 v1, s[12:15], s26 offen offset:0 sc1 lds
s_add_u32 s43, s26, 4096
M v[132:135], a[160:163], a[28:31], 0
v_exp_f32 v74, v74
M v[132:135], a[156:159], a[24:27], v[132:135]
v_cvt_pk_bf16_f32 v71, v86, v87
v_cvt_pk_bf16_f32 v72, v72, v73
M v[132:135], a[152:155], a[20:23], v[132:135]
v_exp_f32 v75, v75
M v[132:135], a[148:151], a[16:19], v[132:135]
buffer_load_dwordx4 v1, s[12:15], s26 offen offset:1024 sc1 lds
M v[136:139], a[148:151], a[32:35], 0
v_exp_f32 v88, v88
M v[136:139], a[152:155], a[36:39], v[136:139]
ds_read_b128 a[124:127], v5 offset:33792
ds_read_b128 a[128:131], v5 offset:41984
M v[136:139], a[156:159], a[40:43], v[136:139]
v_exp_f32 v89, v89
M v[136:139], a[160:163], a[44:47], v[136:139]
buffer_load_dwordx4 v1, s[12:15], s26 offen offset:2048 sc1 lds
M v[140:143], a[160:163], a[60:63], 0
v_exp_f32 v90, v90
M v[140:143], a[156:159], a[56:59], v[140:143]
v_cvt_pk_bf16_f32 v73, v74, v75
v_cvt_pk_bf16_f32 v74, v88, v89
M v[140:143], a[152:155], a[52:55], v[140:143]
v_exp_f32 v91, v91
M v[140:143], a[148:151], a[48:51], v[140:143]
buffer_load_dwordx4 v1, s[12:15], s26 offen offset:3072 sc1 lds
s_add_u32 m0, s29, 102400
s_waitcnt lgkmcnt(4)
M v[144:147], a[164:167], a[0:3], 0
v_exp_f32 v76, v76
M v[144:147], a[168:171], a[4:7], v[144:147]
ds_read_b128 a[132:135], v5 offset:34816
ds_read_b128 a[136:139], v5 offset:43008
M v[144:147], a[172:175], a[8:11], v[144:147]
v_exp_f32 v77, v77
M v[144:147], a[176:179], a[12:15], v[144:147]
buffer_load_dwordx4 v1, s[12:15], s43 offen offset:0 sc1 lds
M v[148:151], a[176:179], a[28:31], 0
v_exp_f32 v78, v78
M v[148:151], a[172:175], a[24:27], v[148:151]
v_cvt_pk_bf16_f32 v75, v90, v91
v_cvt_pk_bf16_f32 v76, v76, v77
M v[148:151], a[168:171], a[20:23], v[148:151]
v_exp_f32 v79, v79
M v[148:151], a[164:167], a[16:19], v[148:151]
buffer_load_dwordx4 v1, s[12:15], s43 offen offset:1024 sc1 lds
M v[152:155], a[164:167], a[32:35], 0
v_exp_f32 v92, v92
M v[152:155], a[168:171], a[36:39], v[152:155]
ds_read_b128 a[140:143], v5 offset:35840
ds_read_b128 a[144:147], v5 offset:44032
M v[152:155], a[172:175], a[40:43], v[152:155]
v_exp_f32 v93, v93
M v[152:155], a[176:179], a[44:47], v[152:155]
buffer_load_dwordx4 v1, s[12:15], s43 offen offset:2048 sc1 lds
M v[156:159], a[176:179], a[60:63], 0
v_exp_f32 v94, v94
M v[156:159], a[172:175], a[56:59], v[156:159]
v_cvt_pk_bf16_f32 v77, v78, v79
v_cvt_pk_bf16_f32 v78, v92, v93
M v[156:159], a[168:171], a[52:55], v[156:159]
v_exp_f32 v95, v95
M v[156:159], a[164:167], a[48:51], v[156:159]
buffer_load_dwordx4 v1, s[12:15], s43 offen offset:3072 sc1 lds
v_cvt_pk_bf16_f32 v79, v94, v95
s_waitcnt lgkmcnt(6)
M v[160:163], a[116:119], v[32:35], v[160:163]
v_exp_f32 v96, v96
M v[160:163], a[120:123], v[64:67], v[160:163]
ds_read_b128 a[148:151], v5 offset:36864
ds_read_b128 a[152:155], v5 offset:45056
M v[164:167], a[120:123], v[68:71], v[164:167]
v_exp_f32 v97, v97
M v[164:167], a[116:119], v[36:39], v[164:167]
v_cvt_pk_bf16_f32 v96, v96, v97
M v[168:171], a[116:119], v[40:43], v[168:171]
v_exp_f32 v98, v98
M v[168:171], a[120:123], v[72:75], v[168:171]
s_add_u32 s25, s25, 32768
s_cmp_eq_u32 s25, s27
M v[172:175], a[120:123], v[76:79], v[172:175]
v_exp_f32 v99, v99
M v[172:175], a[116:119], v[44:47], v[172:175]
v_cvt_pk_bf16_f32 v97, v98, v99
s_waitcnt lgkmcnt(6)
M a[96:99], a[112:115], v[32:35], a[96:99]
s_cselect_b32 s25, s28, s25
s_cselect_b32 s27, s56, s27
M a[96:99], a[112:115], v[64:67], a[96:99]
s_cselect_b32 s28, s57, s28
s_cselect_b32 s56, -1, s56
M v[176:179], a[124:127], v[32:35], v[176:179]
v_exp_f32 v112, v112
M v[176:179], a[128:131], v[64:67], v[176:179]
ds_read_b128 a[156:159], v5 offset:37888
ds_read_b128 a[160:163], v5 offset:46080
M v[180:183], a[128:131], v[68:71], v[180:183]
v_exp_f32 v113, v113
M v[180:183], a[124:127], v[36:39], v[180:183]
v_cvt_pk_bf16_f32 v98, v112, v113
M v[184:187], a[124:127], v[40:43], v[184:187]
v_exp_f32 v114, v114
M v[184:187], a[128:131], v[72:75], v[184:187]
s_add_u32 s26, s26, 32768
s_cmp_eq_u32 s26, s62
M v[188:191], a[128:131], v[76:79], v[188:191]
v_exp_f32 v115, v115
M v[188:191], a[124:127], v[44:47], v[188:191]
v_cvt_pk_bf16_f32 v99, v114, v115
s_waitcnt lgkmcnt(6)
M a[100:103], a[112:115], v[36:39], a[100:103]
s_cselect_b32 s26, s63, s26
s_cselect_b32 s62, s58, s62
M a[100:103], a[112:115], v[68:71], a[100:103]
s_cselect_b32 s63, s59, s63
s_cselect_b32 s58, -1, s58
M v[192:195], a[132:135], v[32:35], v[192:195]
v_exp_f32 v100, v100
M v[192:195], a[136:139], v[64:67], v[192:195]
ds_read_b128 a[164:167], v5 offset:38912
ds_read_b128 a[168:171], v5 offset:47104
M v[196:199], a[136:139], v[68:71], v[196:199]
v_exp_f32 v101, v101
M v[196:199], a[132:135], v[36:39], v[196:199]
v_cvt_pk_bf16_f32 v100, v100, v101
M v[200:203], a[132:135], v[40:43], v[200:203]
v_exp_f32 v102, v102
M v[200:203], a[136:139], v[72:75], v[200:203]
s_sub_u32 s33, s42, 1
s_cmp_le_u32 s33, 1
s_cselect_b32 s33, 0x4000, 0
v_add_u32 v2, s33, v2
M v[204:207], a[136:139], v[76:79], v[204:207]
v_exp_f32 v103, v103
M v[204:207], a[132:135], v[44:47], v[204:207]
v_cvt_pk_bf16_f32 v101, v102, v103
s_waitcnt lgkmcnt(6)
M a[104:107], a[112:115], v[40:43], a[104:107]
M a[104:107], a[112:115], v[72:75], a[104:107]
M v[208:211], a[140:143], v[32:35], v[208:211]
v_exp_f32 v116, v116
M v[208:211], a[144:147], v[64:67], v[208:211]
ds_read_b128 a[172:175], v5 offset:39936
ds_read_b128 a[176:179], v5 offset:48128
M v[212:215], a[144:147], v[68:71], v[212:215]
v_exp_f32 v117, v117
M v[212:215], a[140:143], v[36:39], v[212:215]
v_cvt_pk_bf16_f32 v102, v116, v117
M v[216:219], a[140:143], v[40:43], v[216:219]
v_exp_f32 v118, v118
M v[216:219], a[144:147], v[72:75], v[216:219]
M v[220:223], a[144:147], v[76:79], v[220:223]
v_exp_f32 v119, v119
M v[220:223], a[140:143], v[44:47], v[220:223]
v_cvt_pk_bf16_f32 v103, v118, v119
s_waitcnt lgkmcnt(6)
M a[108:111], a[112:115], v[44:47], a[108:111]
M a[108:111], a[112:115], v[76:79], a[108:111]
M v[224:227], a[148:151], v[32:35], v[224:227]
v_exp_f32 v104, v104
M v[224:227], a[152:155], v[64:67], v[224:227]
s_cmp_le_u32 s42, 1
s_cselect_b32 s33, 0x4000, 0
v_add_u32 v5, s33, v5
s_sub_u32 s42, s42, 1
M v[228:231], a[152:155], v[68:71], v[228:231]
v_exp_f32 v105, v105
M v[228:231], a[148:151], v[36:39], v[228:231]
v_cvt_pk_bf16_f32 v104, v104, v105
M v[232:235], a[148:151], v[40:43], v[232:235]
v_exp_f32 v106, v106
M v[232:235], a[152:155], v[72:75], v[232:235]
M v[236:239], a[152:155], v[76:79], v[236:239]
v_exp_f32 v107, v107
M v[236:239], a[148:151], v[44:47], v[236:239]
v_cvt_pk_bf16_f32 v105, v106, v107
s_waitcnt lgkmcnt(4)
M v[240:243], a[156:159], v[32:35], v[240:243]
v_exp_f32 v120, v120
M v[240:243], a[160:163], v[64:67], v[240:243]
M v[244:247], a[160:163], v[68:71], v[244:247]
v_exp_f32 v121, v121
M v[244:247], a[156:159], v[36:39], v[244:247]
v_cvt_pk_bf16_f32 v106, v120, v121
M v[248:251], a[156:159], v[40:43], v[248:251]
v_exp_f32 v122, v122
M v[248:251], a[160:163], v[72:75], v[248:251]
s_waitcnt vmcnt(0) lgkmcnt(0)
s_barrier
ds_read_b128 a[116:119], v3 offset:0
ds_read_b128 a[120:123], v3 offset:1024
M v[252:255], a[160:163], v[76:79], v[252:255]
v_exp_f32 v123, v123
M v[252:255], a[156:159], v[44:47], v[252:255]
v_cvt_pk_bf16_f32 v107, v122, v123
M a[64:67], a[164:167], v[32:35], a[64:67]
v_exp_f32 v108, v108
M a[64:67], a[168:171], v[64:67], a[64:67]
ds_read_b128 a[124:127], v3 offset:2048
ds_read_b128 a[128:131], v3 offset:3072
M a[68:71], a[168:171], v[68:71], a[68:71]
v_exp_f32 v109, v109
M a[68:71], a[164:167], v[36:39], a[68:71]
v_cvt_pk_bf16_f32 v108, v108, v109
M a[72:75], a[164:167], v[40:43], a[72:75]
v_exp_f32 v110, v110
M a[72:75], a[168:171], v[72:75], a[72:75]
ds_read_b128 a[132:135], v3 offset:4096
ds_read_b128 a[136:139], v3 offset:5120
M a[76:79], a[168:171], v[76:79], a[76:79]
v_exp_f32 v111, v111
M a[76:79], a[164:167], v[44:47], a[76:79]
v_cvt_pk_bf16_f32 v109, v110, v111
M a[80:83], a[172:175], v[32:35], a[80:83]
v_exp_f32 v124, v124
M a[80:83], a[176:179], v[64:67], a[80:83]
ds_read_b128 a[140:143], v3 offset:6144
ds_read_b128 a[144:147], v3 offset:7168
M a[84:87], a[176:179], v[68:71], a[84:87]
v_exp_f32 v125, v125
M a[84:87], a[172:175], v[36:39], a[84:87]
v_cvt_pk_bf16_f32 v110, v124, v125
M a[88:91], a[172:175], v[40:43], a[88:91]
v_exp_f32 v126, v126
M a[88:91], a[176:179], v[72:75], a[88:91]
M a[92:95], a[176:179], v[76:79], a[92:95]
v_exp_f32 v127, v127
M a[92:95], a[172:175], v[44:47], a[92:95]
v_cvt_pk_bf16_f32 v111, v126, v127
s_add_u32 m0, s29, 0
s_waitcnt lgkmcnt(4)
M v[32:35], a[116:119], a[0:3], v[16:19]
v_exp_f32 v128, v128
M v[32:35], a[120:123], a[4:7], v[32:35]
ds_read_b128 a[148:151], v3 offset:8192
ds_read_b128 a[152:155], v3 offset:9216
M v[32:35], a[124:127], a[8:11], v[32:35]
v_exp_f32 v129, v129
M v[32:35], a[128:131], a[12:15], v[32:35]
buffer_load_dwordx4 v1, s[12:15], s25 offen offset:0 sc1 lds
s_add_u32 s32, s25, 4096
M v[36:39], a[128:131], a[28:31], 0
v_exp_f32 v130, v130
M v[36:39], a[124:127], a[24:27], v[36:39]
v_cvt_pk_bf16_f32 v128, v128, v129
M v[36:39], a[120:123], a[20:23], v[36:39]
v_exp_f32 v131, v131
M v[36:39], a[116:119], a[16:19], v[36:39]
buffer_load_dwordx4 v1, s[12:15], s25 offen offset:1024 sc1 lds
M v[40:43], a[116:119], a[32:35], 0
v_exp_f32 v144, v144
M v[40:43], a[120:123], a[36:39], v[40:43]
ds_read_b128 a[156:159], v3 offset:10240
ds_read_b128 a[160:163], v3 offset:11264
M v[40:43], a[124:127], a[40:43], v[40:43]
v_exp_f32 v145, v145
M v[40:43], a[128:131], a[44:47], v[40:43]
buffer_load_dwordx4 v1, s[12:15], s25 offen offset:2048 sc1 lds
M v[44:47], a[128:131], a[60:63], 0
v_exp_f32 v146, v146
M v[44:47], a[124:127], a[56:59], v[44:47]
v_cvt_pk_bf16_f32 v129, v130, v131
v_cvt_pk_bf16_f32 v130, v144, v145
M v[44:47], a[120:123], a[52:55], v[44:47]
v_exp_f32 v147, v147
M v[44:47], a[116:119], a[48:51], v[44:47]
buffer_load_dwordx4 v1, s[12:15], s25 offen offset:3072 sc1 lds
s_add_u32 m0, s29, 4096
s_waitcnt lgkmcnt(4)
v_exp_f32 v132, v132
ds_read_b128 a[164:167], v3 offset:12288
ds_read_b128 a[168:171], v3 offset:13312
v_exp_f32 v133, v133
buffer_load_dwordx4 v1, s[12:15], s32 offen offset:0 sc1 lds
M v[52:55], a[144:147], a[28:31], v[16:19]
v_exp_f32 v134, v134
M v[52:55], a[140:143], a[24:27], v[52:55]
v_cvt_pk_bf16_f32 v131, v146, v147
v_cvt_pk_bf16_f32 v132, v132, v133
M v[52:55], a[136:139], a[20:23], v[52:55]
v_exp_f32 v135, v135
M v[52:55], a[132:135], a[16:19], v[52:55]
buffer_load_dwordx4 v1, s[12:15], s32 offen offset:1024 sc1 lds
M v[56:59], a[132:135], a[32:35], 0
v_exp_f32 v148, v148
M v[56:59], a[136:139], a[36:39], v[56:59]
ds_read_b128 a[172:175], v3 offset:14336
ds_read_b128 a[176:179], v3 offset:15360
M v[56:59], a[140:143], a[40:43], v[56:59]
v_exp_f32 v149, v149
M v[56:59], a[144:147], a[44:47], v[56:59]
buffer_load_dwordx4 v1, s[12:15], s32 offen offset:2048 sc1 lds
M v[60:63], a[144:147], a[60:63], 0
v_exp_f32 v150, v150
M v[60:63], a[140:143], a[56:59], v[60:63]
v_cvt_pk_bf16_f32 v133, v134, v135
v_cvt_pk_bf16_f32 v134, v148, v149
M v[60:63], a[136:139], a[52:55], v[60:63]
v_exp_f32 v151, v151
M v[60:63], a[132:135], a[48:51], v[60:63]
buffer_load_dwordx4 v1, s[12:15], s32 offen offset:3072 sc1 lds
s_add_u32 m0, s29, 32768
s_waitcnt lgkmcnt(4)
v_exp_f32 v136, v136
ds_read_b128 a[116:119], v6 offset:32768
ds_read_b128 a[120:123], v6 offset:40960
v_exp_f32 v137, v137
buffer_load_dwordx4 v1, s[12:15], s26 offen offset:0 sc1 lds
s_add_u32 s43, s26, 4096
v_exp_f32 v138, v138
v_cvt_pk_bf16_f32 v135, v150, v151
v_cvt_pk_bf16_f32 v136, v136, v137
v_exp_f32 v139, v139
buffer_load_dwordx4 v1, s[12:15], s26 offen offset:1024 sc1 lds
M v[72:75], a[148:151], a[32:35], v[16:19]
v_exp_f32 v152, v152
M v[72:75], a[152:155], a[36:39], v[72:75]
ds_read_b128 a[124:127], v6 offset:33792
ds_read_b128 a[128:131], v6 offset:41984
M v[72:75], a[156:159], a[40:43], v[72:75]
v_exp_f32 v153, v153
M v[72:75], a[160:163], a[44:47], v[72:75]
buffer_load_dwordx4 v1, s[12:15], s26 offen offset:2048 sc1 lds
M v[76:79], a[160:163], a[60:63], 0
v_exp_f32 v154, v154
M v[76:79], a[156:159], a[56:59], v[76:79]
v_cvt_pk_bf16_f32 v137, v138, v139
v_cvt_pk_bf16_f32 v138, v152, v153
M v[76:79], a[152:155], a[52:55], v[76:79]
v_exp_f32 v155, v155
M v[76:79], a[148:151], a[48:51], v[76:79]
buffer_load_dwordx4 v1, s[12:15], s26 offen offset:3072 sc1 lds
s_add_u32 m0, s29, 36864
s_waitcnt lgkmcnt(4)
v_exp_f32 v140, v140
ds_read_b128 a[132:135], v6 offset:34816
ds_read_b128 a[136:139], v6 offset:43008
v_exp_f32 v141, v141
buffer_load_dwordx4 v1, s[12:15], s43 offen offset:0 sc1 lds
v_exp_f32 v142, v142
v_cvt_pk_bf16_f32 v139, v154, v155
v_cvt_pk_bf16_f32 v140, v140, v141
v_exp_f32 v143, v143
buffer_load_dwordx4 v1, s[12:15], s43 offen offset:1024 sc1 lds
v_exp_f32 v156, v156
ds_read_b128 a[140:143], v6 offset:35840
ds_read_b128 a[144:147], v6 offset:44032
v_exp_f32 v157, v157
buffer_load_dwordx4 v1, s[12:15], s43 offen offset:2048 sc1 lds
M v[92:95], a[176:179], a[60:63], v[16:19]
v_exp_f32 v158, v158
M v[92:95], a[172:175], a[56:59], v[92:95]
v_cvt_pk_bf16_f32 v141, v142, v143
v_cvt_pk_bf16_f32 v142, v156, v157
M v[92:95], a[168:171], a[52:55], v[92:95]
v_exp_f32 v159, v159
M v[92:95], a[164:167], a[48:51], v[92:95]
buffer_load_dwordx4 v1, s[12:15], s43 offen offset:3072 sc1 lds
v_cvt_pk_bf16_f32 v143, v158, v159
s_waitcnt lgkmcnt(6)
M v[160:163], a[116:119], v[96:99], v[160:163]
v_exp_f32 v32, v32
M v[160:163], a[120:123], v[128:131], v[160:163]
ds_read_b128 a[148:151], v6 offset:36864
ds_read_b128 a[152:155], v6 offset:45056
M v[164:167], a[120:123], v[132:135], v[164:167]
v_exp_f32 v33, v33
M v[164:167], a[116:119], v[100:103], v[164:167]
v_cvt_pk_bf16_f32 v32, v32, v33
M v[168:171], a[116:119], v[104:107], v[168:171]
v_exp_f32 v34, v34
M v[168:171], a[120:123], v[136:139], v[168:171]
s_add_u32 s25, s25, 32768
s_cmp_eq_u32 s25, s27
M v[172:175], a[120:123], v[140:143], v[172:175]
v_exp_f32 v35, v35
M v[172:175], a[116:119], v[108:111], v[172:175]
v_cvt_pk_bf16_f32 v33, v34, v35
s_waitcnt lgkmcnt(6)
M a[96:99], a[112:115], v[96:99], a[96:99]
s_cselect_b32 s25, s28, s25
s_cselect_b32 s27, s56, s27
M a[96:99], a[112:115], v[128:131], a[96:99]
s_cselect_b32 s28, s57, s28
s_cselect_b32 s56, -1, s56
M v[176:179], a[124:127], v[96:99], v[176:179]
M v[176:179], a[128:131], v[128:131], v[176:179]
ds_read_b128 a[156:159], v6 offset:37888
ds_read_b128 a[160:163], v6 offset:46080
M v[180:183], a[128:131], v[132:135], v[180:183]
M v[180:183], a[124:127], v[100:103], v[180:183]
v_mov_b32 v34, 0
M v[184:187], a[124:127], v[104:107], v[184:187]
M v[184:187], a[128:131], v[136:139], v[184:187]
s_add_u32 s26, s26, 32768
s_cmp_eq_u32 s26, s62
M v[188:191], a[128:131], v[140:143], v[188:191]
M v[188:191], a[124:127], v[108:111], v[188:191]
v_mov_b32 v35, 0
s_waitcnt lgkmcnt(6)
M a[100:103], a[112:115], v[100:103], a[100:103]
s_cselect_b32 s26, s63, s26
s_cselect_b32 s62, s58, s62
M a[100:103], a[112:115], v[132:135], a[100:103]
s_cselect_b32 s63, s59, s63
s_cselect_b32 s58, -1, s58
M v[192:195], a[132:135], v[96:99], v[192:195]
v_exp_f32 v36, v36
M v[192:195], a[136:139], v[128:131], v[192:195]
ds_read_b128 a[164:167], v6 offset:38912
ds_read_b128 a[168:171], v6 offset:47104
M v[196:199], a[136:139], v[132:135], v[196:199]
v_exp_f32 v37, v37
M v[196:199], a[132:135], v[100:103], v[196:199]
v_cvt_pk_bf16_f32 v36, v36, v37
M v[200:203], a[132:135], v[104:107], v[200:203]
v_exp_f32 v38, v38
M v[200:203], a[136:139], v[136:139], v[200:203]
s_sub_u32 s33, s42, 1
s_cmp_le_u32 s33, 1
s_cselect_b32 s33, 0x4000, 0
v_add_u32 v3, s33, v3
M v[204:207], a[136:139], v[140:143], v[204:207]
v_exp_f32 v39, v39
M v[204:207], a[132:135], v[108:111], v[204:207]
v_cvt_pk_bf16_f32 v37, v38, v39
s_waitcnt lgkmcnt(6)
M a[104:107], a[112:115], v[104:107], a[104:107]
M a[104:107], a[112:115], v[136:139], a[104:107]
M v[208:211], a[140:143], v[96:99], v[208:211]
v_exp_f32 v52, v52
M v[208:211], a[144:147], v[128:131], v[208:211]
ds_read_b128 a[172:175], v6 offset:39936
ds_read_b128 a[176:179], v6 offset:48128
M v[212:215], a[144:147], v[132:135], v[212:215]
v_exp_f32 v53, v53
M v[212:215], a[140:143], v[100:103], v[212:215]
v_cvt_pk_bf16_f32 v38, v52, v53
M v[216:219], a[140:143], v[104:107], v[216:219]
v_exp_f32 v54, v54
M v[216:219], a[144:147], v[136:139], v[216:219]
M v[220:223], a[144:147], v[140:143], v[220:223]
v_exp_f32 v55, v55
M v[220:223], a[140:143], v[108:111], v[220:223]
v_cvt_pk_bf16_f32 v39, v54, v55
s_waitcnt lgkmcnt(6)
M a[108:111], a[112:115], v[108:111], a[108:111]
M a[108:111], a[112:115], v[140:143], a[108:111]
M v[224:227], a[148:151], v[96:99], v[224:227]
v_exp_f32 v40, v40
M v[224:227], a[152:155], v[128:131], v[224:227]
s_cmp_le_u32 s42, 1
s_cselect_b32 s33, 0x4000, 0
v_add_u32 v6, s33, v6
s_sub_u32 s42, s42, 1
M v[228:231], a[152:155], v[132:135], v[228:231]
v_exp_f32 v41, v41
M v[228:231], a[148:151], v[100:103], v[228:231]
v_cvt_pk_bf16_f32 v40, v40, v41
M v[232:235], a[148:151], v[104:107], v[232:235]
v_exp_f32 v42, v42
M v[232:235], a[152:155], v[136:139], v[232:235]
M v[236:239], a[152:155], v[140:143], v[236:239]
v_exp_f32 v43, v43
M v[236:239], a[148:151], v[108:111], v[236:239]
v_cvt_pk_bf16_f32 v41, v42, v43
s_waitcnt lgkmcnt(4)
M v[240:243], a[156:159], v[96:99], v[240:243]
v_exp_f32 v56, v56
M v[240:243], a[160:163], v[128:131], v[240:243]
M v[244:247], a[160:163], v[132:135], v[244:247]
v_exp_f32 v57, v57
M v[244:247], a[156:159], v[100:103], v[244:247]
v_cvt_pk_bf16_f32 v42, v56, v57
M v[248:251], a[156:159], v[104:107], v[248:251]
v_exp_f32 v58, v58
M v[248:251], a[160:163], v[136:139], v[248:251]
s_waitcnt vmcnt(0) lgkmcnt(0)
s_barrier
ds_read_b128 a[116:119], v2 offset:0
ds_read_b128 a[120:123], v2 offset:1024
M v[252:255], a[160:163], v[140:143], v[252:255]
v_exp_f32 v59, v59
M v[252:255], a[156:159], v[108:111], v[252:255]
v_cvt_pk_bf16_f32 v43, v58, v59
M a[64:67], a[164:167], v[96:99], a[64:67]
v_exp_f32 v44, v44
M a[64:67], a[168:171], v[128:131], a[64:67]
ds_read_b128 a[124:127], v2 offset:2048
ds_read_b128 a[128:131], v2 offset:3072
M a[68:71], a[168:171], v[132:135], a[68:71]
v_exp_f32 v45, v45
M a[68:71], a[164:167], v[100:103], a[68:71]
v_cvt_pk_bf16_f32 v44, v44, v45
M a[72:75], a[164:167], v[104:107], a[72:75]
v_exp_f32 v46, v46
M a[72:75], a[168:171], v[136:139], a[72:75]
ds_read_b128 a[132:135], v2 offset:4096
ds_read_b128 a[136:139], v2 offset:5120
M a[76:79], a[168:171], v[140:143], a[76:79]
v_exp_f32 v47, v47
M a[76:79], a[164:167], v[108:111], a[76:79]
v_cvt_pk_bf16_f32 v45, v46, v47
M a[80:83], a[172:175], v[96:99], a[80:83]
v_exp_f32 v60, v60
M a[80:83], a[176:179], v[128:131], a[80:83]
ds_read_b128 a[140:143], v2 offset:6144
ds_read_b128 a[144:147], v2 offset:7168
M a[84:87], a[176:179], v[132:135], a[84:87]
v_exp_f32 v61, v61
M a[84:87], a[172:175], v[100:103], a[84:87]
v_cvt_pk_bf16_f32 v46, v60, v61
M a[88:91], a[172:175], v[104:107], a[88:91]
v_exp_f32 v62, v62
M a[88:91], a[176:179], v[136:139], a[88:91]
M a[92:95], a[176:179], v[140:143], a[92:95]
v_exp_f32 v63, v63
M a[92:95], a[172:175], v[108:111], a[92:95]
v_cvt_pk_bf16_f32 v47, v62, v63
s_and_b32 s3, s2, 3
s_lshl_b32 s3, s3, 2
s_bfe_u32 s27, s2, 0x20003
s_add_u32 s27, s3, s27
s_lshl_b32 s43, s27, 8
s_add_u32 s43, s43, 16789504
v_lshlrev_b32 v15, 2, v0
buffer_load_dword v7, v15, s[52:55], s43 offen sc1
s_waitcnt lgkmcnt(7)
ds_read_b128 a[116:119], v5 offset:32768
s_waitcnt lgkmcnt(7)
ds_read_b128 a[120:123], v5 offset:40960
s_waitcnt lgkmcnt(7)
ds_read_b128 a[124:127], v5 offset:33792
s_waitcnt lgkmcnt(7)
ds_read_b128 a[128:131], v5 offset:41984
s_waitcnt lgkmcnt(7)
ds_read_b128 a[132:135], v5 offset:34816
s_waitcnt lgkmcnt(7)
ds_read_b128 a[136:139], v5 offset:43008
s_waitcnt lgkmcnt(7)
ds_read_b128 a[140:143], v5 offset:35840
s_waitcnt lgkmcnt(7)
ds_read_b128 a[144:147], v5 offset:44032
s_lshl_b32 s33, s23, 14
s_add_u32 s34, s33, 131072
s_add_u32 s33, s33, 98304
v_add_u32 v2, s34, v1
v_add_u32 v3, s33, v1
v_exp_f32 v72, v72
v_exp_f32 v73, v73
v_exp_f32 v74, v74
v_exp_f32 v75, v75
v_cvt_pk_bf16_f32 v72, v72, v73
v_cvt_pk_bf16_f32 v73, v74, v75
v_exp_f32 v76, v76
v_exp_f32 v77, v77
v_exp_f32 v78, v78
v_exp_f32 v79, v79
v_mov_b32 v74, 0
v_mov_b32 v75, 0
v_exp_f32 v92, v92
v_exp_f32 v93, v93
v_exp_f32 v94, v94
v_exp_f32 v95, v95
v_cvt_pk_bf16_f32 v76, v76, v77
v_cvt_pk_bf16_f32 v77, v78, v79
v_cvt_pk_bf16_f32 v78, v92, v93
v_cvt_pk_bf16_f32 v79, v94, v95
s_waitcnt lgkmcnt(6)
M v[160:163], a[116:119], v[32:35], v[160:163]
ds_read_b128 a[148:151], v5 offset:36864
ds_read_b128 a[152:155], v5 offset:45056
s_mov_b32 s61, 0
M v[164:167], a[116:119], v[36:39], v[164:167]
s_bfe_u32 s3, s2, 0x10002
M v[168:171], a[116:119], v[40:43], v[168:171]
M v[168:171], a[120:123], v[72:75], v[168:171]
s_lshl_b32 s3, s3, 3
M v[172:175], a[120:123], v[76:79], v[172:175]
M v[172:175], a[116:119], v[44:47], v[172:175]
s_waitcnt lgkmcnt(6)
s_lshr_b32 s28, s2, 5
M a[96:99], a[112:115], v[32:35], a[96:99]
M v[176:179], a[124:127], v[32:35], v[176:179]
ds_read_b128 a[156:159], v5 offset:37888
ds_read_b128 a[160:163], v5 offset:46080
s_add_u32 s28, s3, s28
s_lshl_b32 s25, s27, 18
M v[180:183], a[124:127], v[36:39], v[180:183]
M v[184:187], a[124:127], v[40:43], v[184:187]
s_lshl_b32 s3, s101, 12
M v[184:187], a[128:131], v[72:75], v[184:187]
M v[188:191], a[128:131], v[76:79], v[188:191]
s_add_u32 s25, s25, s3
M v[188:191], a[124:127], v[44:47], v[188:191]
s_waitcnt lgkmcnt(6)
M a[100:103], a[112:115], v[36:39], a[100:103]
M v[192:195], a[132:135], v[32:35], v[192:195]
s_lshl_b32 s26, s28, 7
ds_read_b128 a[164:167], v5 offset:38912
ds_read_b128 a[168:171], v5 offset:47104
s_lshl_b32 s42, s101, 11
M v[196:199], a[132:135], v[36:39], v[196:199]
M v[200:203], a[132:135], v[40:43], v[200:203]
s_add_u32 s44, s4, 83886080
s_addc_u32 s45, s5, 0
M v[200:203], a[136:139], v[72:75], v[200:203]
s_mov_b32 s46, 4194304
M v[204:207], a[136:139], v[76:79], v[204:207]
M v[204:207], a[132:135], v[44:47], v[204:207]
s_waitcnt lgkmcnt(6)
s_mov_b32 s47, 0x00020000
M a[104:107], a[112:115], v[40:43], a[104:107]
M a[104:107], a[112:115], v[72:75], a[104:107]
M v[208:211], a[140:143], v[32:35], v[208:211]
ds_read_b128 a[172:175], v5 offset:39936
ds_read_b128 a[176:179], v5 offset:48128
s_mov_b32 s50, 2097152
M v[212:215], a[140:143], v[36:39], v[212:215]
s_mov_b32 s51, 0x00020000
M v[216:219], a[140:143], v[40:43], v[216:219]
M v[216:219], a[144:147], v[72:75], v[216:219]
s_lshl_b32 s3, s101, 4
M v[220:223], a[144:147], v[76:79], v[220:223]
M v[220:223], a[140:143], v[44:47], v[220:223]
s_waitcnt lgkmcnt(6)
v_lshrrev_b32 v96, 3, v0
M a[108:111], a[112:115], v[44:47], a[108:111]
M a[108:111], a[112:115], v[76:79], a[108:111]
M v[224:227], a[148:151], v[32:35], v[224:227]
v_and_b32 v97, 6, v96
ds_write_b128 v2, v[160:163] offset:0
v_and_b32 v98, 7, v0
M v[228:231], a[148:151], v[36:39], v[228:231]
M v[232:235], a[148:151], v[40:43], v[232:235]
ds_write_b128 v2, v[164:167] offset:1024
v_xor_b32 v97, v97, v98
M v[232:235], a[152:155], v[72:75], v[232:235]
M v[236:239], a[152:155], v[76:79], v[236:239]
ds_write_b128 v2, v[168:171] offset:2048
v_add_u32 v96, s3, v96
M v[236:239], a[148:151], v[44:47], v[236:239]
s_waitcnt lgkmcnt(7)
M v[240:243], a[156:159], v[32:35], v[240:243]
ds_write_b128 v2, v[172:175] offset:3072
v_lshlrev_b32 v96, 11, v96
ds_write_b128 v2, v[176:179] offset:4096
v_lshl_add_u32 v99, v97, 4, v96
M v[244:247], a[156:159], v[36:39], v[244:247]
v_add_u32 v100, 15360, v99
M v[248:251], a[156:159], v[40:43], v[248:251]
ds_write_b128 v2, v[180:183] offset:5120
M v[248:251], a[160:163], v[72:75], v[248:251]
s_waitcnt vmcnt(0) lgkmcnt(0)
s_barrier
M v[252:255], a[160:163], v[76:79], v[252:255]
ds_write_b128 v2, v[184:187] offset:6144
v_cmp_ne_u32 vcc, 1, v7
s_nop 0
s_cbranch_vccnz Lk3_spinb2
Lk3_gotb2:
M v[252:255], a[156:159], v[44:47], v[252:255]
s_add_u32 m0, s42, 16384
s_nop 0
buffer_load_dwordx4 v99, s[48:51], s26 offen offset:0 lds
M a[64:67], a[164:167], v[32:35], a[64:67]
ds_write_b128 v2, v[188:191] offset:7168
buffer_load_dwordx4 v100, s[48:51], s26 offen offset:1024 lds
ds_write_b128 v2, v[192:195] offset:8192
buffer_load_dwordx4 a[192:195], v1, s[44:47], s25 offen offset:0 sc1
M a[68:71], a[164:167], v[36:39], a[68:71]
buffer_load_dwordx4 a[196:199], v1, s[44:47], s25 offen offset:1024 sc1
M a[72:75], a[164:167], v[40:43], a[72:75]
ds_write_b128 v2, v[196:199] offset:9216
buffer_load_dwordx4 a[200:203], v1, s[44:47], s25 offen offset:2048 sc1
M a[72:75], a[168:171], v[72:75], a[72:75]
buffer_load_dwordx4 a[204:207], v1, s[44:47], s25 offen offset:3072 sc1
M a[76:79], a[168:171], v[76:79], a[76:79]
ds_write_b128 v2, v[200:203] offset:10240
M a[76:79], a[164:167], v[44:47], a[76:79]
s_add_u32 s25, s25, 16384
s_add_u32 s26, s26, 131072
M a[80:83], a[172:175], v[32:35], a[80:83]
ds_write_b128 v2, v[204:207] offset:11264
s_add_u32 m0, s42, 32768
s_nop 0
buffer_load_dwordx4 v99, s[48:51], s26 offen offset:0 lds
buffer_load_dwordx4 v100, s[48:51], s26 offen offset:1024 lds
ds_write_b128 v2, v[208:211] offset:12288
buffer_load_dwordx4 a[224:227], v1, s[44:47], s25 offen offset:0 sc1
M a[84:87], a[172:175], v[36:39], a[84:87]
M a[88:91], a[172:175], v[40:43], a[88:91]
ds_write_b128 v2, v[212:215] offset:13312
buffer_load_dwordx4 a[228:231], v1, s[44:47], s25 offen offset:1024 sc1
M a[88:91], a[176:179], v[72:75], a[88:91]
buffer_load_dwordx4 a[232:235], v1, s[44:47], s25 offen offset:2048 sc1
M a[92:95], a[176:179], v[76:79], a[92:95]
ds_write_b128 v2, v[216:219] offset:14336
buffer_load_dwordx4 a[236:239], v1, s[44:47], s25 offen offset:3072 sc1
M a[92:95], a[172:175], v[44:47], a[92:95]
s_add_u32 s25, s25, 16384
s_add_u32 s26, s26, 131072
ds_write_b128 v2, v[220:223] offset:15360
s_waitcnt lgkmcnt(0)
Lk2_mg1:
s_lshl_b32 s33, s22, 10
s_add_u32 s33, s33, 28672
s_xor_b32 s34, s33, 2048
v_add_u32 v14, s33, v1
v_add_u32 v15, s34, v1
v_accvgpr_read_b32 v20, a96
v_accvgpr_read_b32 v21, a100
v_accvgpr_read_b32 v22, a104
v_accvgpr_read_b32 v23, a108
ds_write_b128 v14, v[20:23]
s_waitcnt lgkmcnt(0)
s_barrier
ds_read_b128 v[28:31], v15
ds_read_b128 v[32:35], v3 offset:0
ds_read_b128 v[36:39], v3 offset:1024
ds_read_b128 v[40:43], v3 offset:2048
ds_read_b128 v[44:47], v3 offset:3072
ds_read_b128 v[48:51], v3 offset:4096
ds_read_b128 v[52:55], v3 offset:5120
ds_read_b128 v[56:59], v3 offset:6144
ds_read_b128 v[60:63], v3 offset:7168
ds_read_b128 v[64:67], v3 offset:8192
ds_read_b128 v[68:71], v3 offset:9216
ds_read_b128 v[72:75], v3 offset:10240
ds_read_b128 v[76:79], v3 offset:11264
ds_read_b128 v[80:83], v3 offset:12288
ds_read_b128 v[84:87], v3 offset:13312
ds_read_b128 v[88:91], v3 offset:14336
ds_read_b128 v[92:95], v3 offset:15360
s_waitcnt lgkmcnt(15)
v_add_f32 v20, v20, v28
v_add_f32 v21, v21, v29
v_add_f32 v22, v22, v30
v_add_f32 v23, v23, v31
s_sub_u32 s35, 15, s21
v_rcp_f32 v8, v20
v_rcp_f32 v9, v21
v_rcp_f32 v10, v22
v_rcp_f32 v11, v23
v_subrev_u32 v20, 0x21800000, v20
v_subrev_u32 v21, 0x21800000, v21
v_subrev_u32 v22, 0x21800000, v22
v_subrev_u32 v23, 0x21800000, v23
v_max_u32 v12, v20, v21
v_max3_u32 v12, v12, v22, v23
s_mov_b32 s64, 0x207
s_lshl_b32 s33, s35, 20
s_lshl_b32 s34, s20, 15
s_add_u32 s33, s33, s34
s_lshl_b32 s34, s23, 13
s_add_u32 s36, s33, s34
s_add_u32 s37, s36, 4096
s_add_u32 s38, s36, 16384
s_add_u32 s39, s36, 20480
v_pk_add_f32 v[224:225], v[224:225], v[32:33]
v_pk_add_f32 v[226:227], v[226:227], v[34:35]
s_waitcnt lgkmcnt(11)
v_pk_add_f32 v[240:241], v[240:241], v[48:49]
v_pk_add_f32 v[242:243], v[242:243], v[50:51]
v_pk_mul_f32 v[224:225], v[224:225], v[8:9] op_sel:[0,0] op_sel_hi:[1,0]
v_pk_mul_f32 v[226:227], v[226:227], v[8:9] op_sel:[0,0] op_sel_hi:[1,0]
v_pk_mul_f32 v[240:241], v[240:241], v[8:9] op_sel:[0,0] op_sel_hi:[1,0]
v_pk_mul_f32 v[242:243], v[242:243], v[8:9] op_sel:[0,0] op_sel_hi:[1,0]
v_cvt_pk_bf16_f32 v224, v224, v225
v_cvt_pk_bf16_f32 v225, v226, v227
v_cvt_pk_bf16_f32 v226, v240, v241
v_cvt_pk_bf16_f32 v227, v242, v243
v_pk_add_f32 v[228:229], v[228:229], v[36:37]
v_pk_add_f32 v[230:231], v[230:231], v[38:39]
s_waitcnt lgkmcnt(10)
v_pk_add_f32 v[244:245], v[244:245], v[52:53]
v_pk_add_f32 v[246:247], v[246:247], v[54:55]
M v[24:27], a[112:115], v[224:227], 0
buffer_store_dwordx4 v[224:227], v1, s[16:19], s38 offen offset:0 sc1
v_pk_mul_f32 v[228:229], v[228:229], v[8:9] op_sel:[0,1] op_sel_hi:[1,1]
v_pk_mul_f32 v[230:231], v[230:231], v[8:9] op_sel:[0,1] op_sel_hi:[1,1]
v_pk_mul_f32 v[244:245], v[244:245], v[8:9] op_sel:[0,1] op_sel_hi:[1,1]
v_pk_mul_f32 v[246:247], v[246:247], v[8:9] op_sel:[0,1] op_sel_hi:[1,1]
v_cvt_pk_bf16_f32 v228, v228, v229
v_cvt_pk_bf16_f32 v229, v230, v231
v_cvt_pk_bf16_f32 v230, v244, v245
v_cvt_pk_bf16_f32 v231, v246, v247
v_pk_add_f32 v[232:233], v[232:233], v[40:41]
v_pk_add_f32 v[234:235], v[234:235], v[42:43]
s_waitcnt lgkmcnt(9)
v_pk_add_f32 v[248:249], v[248:249], v[56:57]
v_pk_add_f32 v[250:251], v[250:251], v[58:59]
M v[24:27], a[112:115], v[228:231], v[24:27]
buffer_store_dwordx4 v[228:231], v1, s[16:19], s38 offen offset:2048 sc1
v_pk_mul_f32 v[232:233], v[232:233], v[10:11] op_sel:[0,0] op_sel_hi:[1,0]
v_pk_mul_f32 v[234:235], v[234:235], v[10:11] op_sel:[0,0] op_sel_hi:[1,0]
v_pk_mul_f32 v[248:249], v[248:249], v[10:11] op_sel:[0,0] op_sel_hi:[1,0]
v_pk_mul_f32 v[250:251], v[250:251], v[10:11] op_sel:[0,0] op_sel_hi:[1,0]
v_cvt_pk_bf16_f32 v232, v232, v233
v_cvt_pk_bf16_f32 v233, v234, v235
v_cvt_pk_bf16_f32 v234, v248, v249
v_cvt_pk_bf16_f32 v235, v250, v251
v_pk_add_f32 v[236:237], v[236:237], v[44:45]
v_pk_add_f32 v[238:239], v[238:239], v[46:47]
s_waitcnt lgkmcnt(8)
v_pk_add_f32 v[252:253], v[252:253], v[60:61]
v_pk_add_f32 v[254:255], v[254:255], v[62:63]
M v[24:27], a[112:115], v[232:235], v[24:27]
buffer_store_dwordx4 v[232:235], v1, s[16:19], s39 offen offset:0 sc1
v_pk_mul_f32 v[236:237], v[236:237], v[10:11] op_sel:[0,1] op_sel_hi:[1,1]
v_pk_mul_f32 v[238:239], v[238:239], v[10:11] op_sel:[0,1] op_sel_hi:[1,1]
v_pk_mul_f32 v[252:253], v[252:253], v[10:11] op_sel:[0,1] op_sel_hi:[1,1]
v_pk_mul_f32 v[254:255], v[254:255], v[10:11] op_sel:[0,1] op_sel_hi:[1,1]
v_cvt_pk_bf16_f32 v236, v236, v237
v_cvt_pk_bf16_f32 v237, v238, v239
v_cvt_pk_bf16_f32 v238, v252, v253
v_cvt_pk_bf16_f32 v239, v254, v255
v_accvgpr_read_b32 v32, a64
v_accvgpr_read_b32 v33, a65
v_accvgpr_read_b32 v34, a66
v_accvgpr_read_b32 v35, a67
s_waitcnt lgkmcnt(7)
v_pk_add_f32 v[32:33], v[32:33], v[64:65]
v_pk_add_f32 v[34:35], v[34:35], v[66:67]
v_accvgpr_read_b32 v48, a80
v_accvgpr_read_b32 v49, a81
v_accvgpr_read_b32 v50, a82
v_accvgpr_read_b32 v51, a83
s_waitcnt lgkmcnt(3)
v_pk_add_f32 v[48:49], v[48:49], v[80:81]
v_pk_add_f32 v[50:51], v[50:51], v[82:83]
M v[24:27], a[112:115], v[236:239], v[24:27]
buffer_store_dwordx4 v[236:239], v1, s[16:19], s39 offen offset:2048 sc1
v_pk_mul_f32 v[32:33], v[32:33], v[8:9] op_sel:[0,0] op_sel_hi:[1,0]
v_pk_mul_f32 v[34:35], v[34:35], v[8:9] op_sel:[0,0] op_sel_hi:[1,0]
v_pk_mul_f32 v[48:49], v[48:49], v[8:9] op_sel:[0,0] op_sel_hi:[1,0]
v_pk_mul_f32 v[50:51], v[50:51], v[8:9] op_sel:[0,0] op_sel_hi:[1,0]
v_cvt_pk_bf16_f32 v32, v32, v33
v_cvt_pk_bf16_f32 v33, v34, v35
v_cvt_pk_bf16_f32 v34, v48, v49
v_cvt_pk_bf16_f32 v35, v50, v51
v_accvgpr_read_b32 v240, a68
v_accvgpr_read_b32 v241, a69
v_accvgpr_read_b32 v242, a70
v_accvgpr_read_b32 v243, a71
v_pk_add_f32 v[240:241], v[240:241], v[68:69]
v_pk_add_f32 v[242:243], v[242:243], v[70:71]
v_accvgpr_read_b32 v36, a84
v_accvgpr_read_b32 v37, a85
v_accvgpr_read_b32 v38, a86
v_accvgpr_read_b32 v39, a87
s_waitcnt lgkmcnt(2)
v_pk_add_f32 v[36:37], v[36:37], v[84:85]
v_pk_add_f32 v[38:39], v[38:39], v[86:87]
M v[24:27], a[112:115], v[32:35], v[24:27]
buffer_store_dwordx4 v[32:35], v1, s[16:19], s38 offen offset:1024 sc1
v_pk_mul_f32 v[240:241], v[240:241], v[8:9] op_sel:[0,1] op_sel_hi:[1,1]
v_pk_mul_f32 v[242:243], v[242:243], v[8:9] op_sel:[0,1] op_sel_hi:[1,1]
v_pk_mul_f32 v[36:37], v[36:37], v[8:9] op_sel:[0,1] op_sel_hi:[1,1]
v_pk_mul_f32 v[38:39], v[38:39], v[8:9] op_sel:[0,1] op_sel_hi:[1,1]
v_cvt_pk_bf16_f32 v240, v240, v241
v_cvt_pk_bf16_f32 v241, v242, v243
v_cvt_pk_bf16_f32 v242, v36, v37
v_cvt_pk_bf16_f32 v243, v38, v39
v_accvgpr_read_b32 v52, a72
v_accvgpr_read_b32 v53, a73
v_accvgpr_read_b32 v54, a74
v_accvgpr_read_b32 v55, a75
v_pk_add_f32 v[52:53], v[52:53], v[72:73]
v_pk_add_f32 v[54:55], v[54:55], v[74:75]
v_accvgpr_read_b32 v244, a88
v_accvgpr_read_b32 v245, a89
v_accvgpr_read_b32 v246, a90
v_accvgpr_read_b32 v247, a91
s_waitcnt lgkmcnt(1)
v_pk_add_f32 v[244:245], v[244:245], v[88:89]
v_pk_add_f32 v[246:247], v[246:247], v[90:91]
M v[24:27], a[112:115], v[240:243], v[24:27]
buffer_store_dwordx4 v[240:243], v1, s[16:19], s38 offen offset:3072 sc1
v_pk_mul_f32 v[52:53], v[52:53], v[10:11] op_sel:[0,0] op_sel_hi:[1,0]
v_pk_mul_f32 v[54:55], v[54:55], v[10:11] op_sel:[0,0] op_sel_hi:[1,0]
v_pk_mul_f32 v[244:245], v[244:245], v[10:11] op_sel:[0,0] op_sel_hi:[1,0]
v_pk_mul_f32 v[246:247], v[246:247], v[10:11] op_sel:[0,0] op_sel_hi:[1,0]
v_cvt_pk_bf16_f32 v52, v52, v53
v_cvt_pk_bf16_f32 v53, v54, v55
v_cvt_pk_bf16_f32 v54, v244, v245
v_cvt_pk_bf16_f32 v55, v246, v247
v_accvgpr_read_b32 v40, a76
v_accvgpr_read_b32 v41, a77
v_accvgpr_read_b32 v42, a78
v_accvgpr_read_b32 v43, a79
v_pk_add_f32 v[40:41], v[40:41], v[76:77]
v_pk_add_f32 v[42:43], v[42:43], v[78:79]
v_accvgpr_read_b32 v56, a92
v_accvgpr_read_b32 v57, a93
v_accvgpr_read_b32 v58, a94
v_accvgpr_read_b32 v59, a95
s_waitcnt lgkmcnt(0)
v_pk_add_f32 v[56:57], v[56:57], v[92:93]
v_pk_add_f32 v[58:59], v[58:59], v[94:95]
M v[24:27], a[112:115], v[52:55], v[24:27]
buffer_store_dwordx4 v[52:55], v1, s[16:19], s39 offen offset:1024 sc1
v_pk_mul_f32 v[40:41], v[40:41], v[10:11] op_sel:[0,1] op_sel_hi:[1,1]
v_pk_mul_f32 v[42:43], v[42:43], v[10:11] op_sel:[0,1] op_sel_hi:[1,1]
v_pk_mul_f32 v[56:57], v[56:57], v[10:11] op_sel:[0,1] op_sel_hi:[1,1]
v_pk_mul_f32 v[58:59], v[58:59], v[10:11] op_sel:[0,1] op_sel_hi:[1,1]
v_cvt_pk_bf16_f32 v40, v40, v41
v_cvt_pk_bf16_f32 v41, v42, v43
v_cvt_pk_bf16_f32 v42, v56, v57
v_cvt_pk_bf16_f32 v43, v58, v59
s_nop 1
M v[24:27], a[112:115], v[40:43], v[24:27]
buffer_store_dwordx4 v[40:43], v1, s[16:19], s39 offen offset:3072 sc1
v_cmp_lt_u32 vcc, 0x3c000000, v12
s_nop 5
v_cmp_class_f32 s[40:41], v24, s64
s_nop 0
s_or_b64 vcc, vcc, s[40:41]
s_cmp_lg_u64 vcc, 0
s_cselect_b32 s33, 2, 0
s_or_b32 s60, s60, s33
Lk2_chk:
s_cmp_eq_u32 s60, 0
s_cbranch_scc1 Lk2_done
s_sub_u32 s56, 15, s21
s_lshl_b32 s33, s24, 1
s_lshl_b32 s61, 3, s33
s_and_b32 s34, s60, 2
s_bitcmp1_b32 s60, 0
s_cselect_b32 s56, s21, s56
s_cselect_b32 s61, 15, s61
s_cselect_b32 s60, s34, 0
s_waitcnt vmcnt(0)
s_lshl_b32 s33, s20, 7
s_lshl_b32 s34, s56, 3
s_add_u32 s33, s33, s34
s_lshl_b32 s34, s23, 2
s_add_u32 s33, s33, s34
s_lshl_b32 s33, s33, 12
buffer_load_dwordx4 a[0:3], v1, s[8:11], s33 offen offset:0 sc1
buffer_load_dwordx4 a[4:7], v1, s[8:11], s33 offen offset:1024 sc1
buffer_load_dwordx4 a[8:11], v1, s[8:11], s33 offen offset:2048 sc1
buffer_load_dwordx4 a[12:15], v1, s[8:11], s33 offen offset:3072 sc1
s_add_u32 s33, s33, 4096
buffer_load_dwordx4 a[16:19], v1, s[8:11], s33 offen offset:0 sc1
buffer_load_dwordx4 a[20:23], v1, s[8:11], s33 offen offset:1024 sc1
buffer_load_dwordx4 a[24:27], v1, s[8:11], s33 offen offset:2048 sc1
buffer_load_dwordx4 a[28:31], v1, s[8:11], s33 offen offset:3072 sc1
s_add_u32 s33, s33, 4096
buffer_load_dwordx4 a[32:35], v1, s[8:11], s33 offen offset:0 sc1
buffer_load_dwordx4 a[36:39], v1, s[8:11], s33 offen offset:1024 sc1
buffer_load_dwordx4 a[40:43], v1, s[8:11], s33 offen offset:2048 sc1
buffer_load_dwordx4 a[44:47], v1, s[8:11], s33 offen offset:3072 sc1
s_add_u32 s33, s33, 4096
buffer_load_dwordx4 a[48:51], v1, s[8:11], s33 offen offset:0 sc1
buffer_load_dwordx4 a[52:55], v1, s[8:11], s33 offen offset:1024 sc1
buffer_load_dwordx4 a[56:59], v1, s[8:11], s33 offen offset:2048 sc1
buffer_load_dwordx4 a[60:63], v1, s[8:11], s33 offen offset:3072 sc1
v_accvgpr_write_b32 a64, 0
v_accvgpr_write_b32 a65, 0
v_accvgpr_write_b32 a66, 0
v_accvgpr_write_b32 a67, 0
v_accvgpr_write_b32 a68, 0
v_accvgpr_write_b32 a69, 0
v_accvgpr_write_b32 a70, 0
v_accvgpr_write_b32 a71, 0
v_accvgpr_write_b32 a72, 0
v_accvgpr_write_b32 a73, 0
v_accvgpr_write_b32 a74, 0
v_accvgpr_write_b32 a75, 0
v_accvgpr_write_b32 a76, 0
v_accvgpr_write_b32 a77, 0
v_accvgpr_write_b32 a78, 0
v_accvgpr_write_b32 a79, 0
v_accvgpr_write_b32 a80, 0
v_accvgpr_write_b32 a81, 0
v_accvgpr_write_b32 a82, 0
v_accvgpr_write_b32 a83, 0
v_accvgpr_write_b32 a84, 0
v_accvgpr_write_b32 a85, 0
v_accvgpr_write_b32 a86, 0
v_accvgpr_write_b32 a87, 0
v_accvgpr_write_b32 a88, 0
v_accvgpr_write_b32 a89, 0
v_accvgpr_write_b32 a90, 0
v_accvgpr_write_b32 a91, 0
v_accvgpr_write_b32 a92, 0
v_accvgpr_write_b32 a93, 0
v_accvgpr_write_b32 a94, 0
v_accvgpr_write_b32 a95, 0
v_accvgpr_write_b32 a96, 0
v_accvgpr_write_b32 a97, 0
v_accvgpr_write_b32 a98, 0
v_accvgpr_write_b32 a99, 0
v_accvgpr_write_b32 a100, 0
v_accvgpr_write_b32 a101, 0
v_accvgpr_write_b32 a102, 0
v_accvgpr_write_b32 a103, 0
v_accvgpr_write_b32 a104, 0
v_accvgpr_write_b32 a105, 0
v_accvgpr_write_b32 a106, 0
v_accvgpr_write_b32 a107, 0
v_accvgpr_write_b32 a108, 0
v_accvgpr_write_b32 a109, 0
v_accvgpr_write_b32 a110, 0
v_accvgpr_write_b32 a111, 0
v_mov_b32 v160, 0
v_mov_b32 v161, 0
v_mov_b32 v162, 0
v_mov_b32 v163, 0
v_mov_b32 v164, 0
v_mov_b32 v165, 0
v_mov_b32 v166, 0
v_mov_b32 v167, 0
v_mov_b32 v168, 0
v_mov_b32 v169, 0
v_mov_b32 v170, 0
v_mov_b32 v171, 0
v_mov_b32 v172, 0
v_mov_b32 v173, 0
v_mov_b32 v174, 0
v_mov_b32 v175, 0
v_mov_b32 v176, 0
v_mov_b32 v177, 0
v_mov_b32 v178, 0
v_mov_b32 v179, 0
v_mov_b32 v180, 0
v_mov_b32 v181, 0
v_mov_b32 v182, 0
v_mov_b32 v183, 0
v_mov_b32 v184, 0
v_mov_b32 v185, 0
v_mov_b32 v186, 0
v_mov_b32 v187, 0
v_mov_b32 v188, 0
v_mov_b32 v189, 0
v_mov_b32 v190, 0
v_mov_b32 v191, 0
v_mov_b32 v192, 0
v_mov_b32 v193, 0
v_mov_b32 v194, 0
v_mov_b32 v195, 0
v_mov_b32 v196, 0
v_mov_b32 v197, 0
v_mov_b32 v198, 0
v_mov_b32 v199, 0
v_mov_b32 v200, 0
v_mov_b32 v201, 0
v_mov_b32 v202, 0
v_mov_b32 v203, 0
v_mov_b32 v204, 0
v_mov_b32 v205, 0
v_mov_b32 v206, 0
v_mov_b32 v207, 0
v_mov_b32 v208, 0
v_mov_b32 v209, 0
v_mov_b32 v210, 0
v_mov_b32 v211, 0
v_mov_b32 v212, 0
v_mov_b32 v213, 0
v_mov_b32 v214, 0
v_mov_b32 v215, 0
v_mov_b32 v216, 0
v_mov_b32 v217, 0
v_mov_b32 v218, 0
v_mov_b32 v219, 0
v_mov_b32 v220, 0
v_mov_b32 v221, 0
v_mov_b32 v222, 0
v_mov_b32 v223, 0
v_mov_b32 v224, 0
v_mov_b32 v225, 0
v_mov_b32 v226, 0
v_mov_b32 v227, 0
v_mov_b32 v228, 0
v_mov_b32 v229, 0
v_mov_b32 v230, 0
v_mov_b32 v231, 0
v_mov_b32 v232, 0
v_mov_b32 v233, 0
v_mov_b32 v234, 0
v_mov_b32 v235, 0
v_mov_b32 v236, 0
v_mov_b32 v237, 0
v_mov_b32 v238, 0
v_mov_b32 v239, 0
v_mov_b32 v240, 0
v_mov_b32 v241, 0
v_mov_b32 v242, 0
v_mov_b32 v243, 0
v_mov_b32 v244, 0
v_mov_b32 v245, 0
v_mov_b32 v246, 0
v_mov_b32 v247, 0
v_mov_b32 v248, 0
v_mov_b32 v249, 0
v_mov_b32 v250, 0
v_mov_b32 v251, 0
v_mov_b32 v252, 0
v_mov_b32 v253, 0
v_mov_b32 v254, 0
v_mov_b32 v255, 0
v_mov_b32 v8, v4
v_mov_b32 v9, v4
v_mov_b32 v10, v4
v_mov_b32 v11, v4
s_lshl_b32 s57, s20, 20
s_lshl_b32 s58, s56, 7
s_lshl_b32 s59, s56, 1
s_add_u32 s59, s59, 2
Lslow_1:
s_add_u32 s35, s57, 0
buffer_load_dwordx4 v[96:99], v1, s[12:15], s35 offen offset:0 sc1
buffer_load_dwordx4 v[100:103], v1, s[12:15], s35 offen offset:1024 sc1
buffer_load_dwordx4 v[104:107], v1, s[12:15], s35 offen offset:2048 sc1
buffer_load_dwordx4 v[108:111], v1, s[12:15], s35 offen offset:3072 sc1
s_add_u32 s35, s57, 4096
buffer_load_dwordx4 v[112:115], v1, s[12:15], s35 offen offset:0 sc1
buffer_load_dwordx4 v[116:119], v1, s[12:15], s35 offen offset:1024 sc1
buffer_load_dwordx4 v[120:123], v1, s[12:15], s35 offen offset:2048 sc1
buffer_load_dwordx4 v[124:127], v1, s[12:15], s35 offen offset:3072 sc1
s_add_u32 s35, s57, 8192
buffer_load_dwordx4 v[128:131], v1, s[12:15], s35 offen offset:0 sc1
buffer_load_dwordx4 v[132:135], v1, s[12:15], s35 offen offset:1024 sc1
buffer_load_dwordx4 v[136:139], v1, s[12:15], s35 offen offset:2048 sc1
buffer_load_dwordx4 v[140:143], v1, s[12:15], s35 offen offset:3072 sc1
s_add_u32 s35, s57, 12288
buffer_load_dwordx4 v[144:147], v1, s[12:15], s35 offen offset:0 sc1
buffer_load_dwordx4 v[148:151], v1, s[12:15], s35 offen offset:1024 sc1
buffer_load_dwordx4 v[152:155], v1, s[12:15], s35 offen offset:2048 sc1
buffer_load_dwordx4 v[156:159], v1, s[12:15], s35 offen offset:3072 sc1
s_lshl_b32 s33, s23, 6
s_add_i32 s33, s33, s58
s_cmp_gt_i32 s33, 0
s_cselect_b32 s34, 0, 0xf149f2ca
s_cmp_lt_i32 s33, 0
s_cselect_b32 s33, 0xf149f2ca, 0
v_mov_b32 v20, s34
v_mov_b32 v21, s34
v_mov_b32 v22, s34
v_mov_b32 v23, s34
v_mov_b32 v28, s33
v_mov_b32 v29, s33
v_mov_b32 v30, s33
v_mov_b32 v31, s33
v_med3_f32 v24, v16, v20, v28
v_med3_f32 v25, v17, v20, v28
v_med3_f32 v26, v18, v20, v28
v_med3_f32 v27, v19, v20, v28
s_waitcnt vmcnt(0)
s_nop 0
M v[32:35], v[96:99], a[0:3], v[24:27]
M v[32:35], v[100:103], a[4:7], v[32:35]
M v[32:35], v[104:107], a[8:11], v[32:35]
M v[32:35], v[108:111], a[12:15], v[32:35]
M v[36:39], v[96:99], a[16:19], v[28:31]
M v[36:39], v[100:103], a[20:23], v[36:39]
M v[36:39], v[104:107], a[24:27], v[36:39]
M v[36:39], v[108:111], a[28:31], v[36:39]
M v[40:43], v[96:99], a[32:35], v[28:31]
M v[40:43], v[100:103], a[36:39], v[40:43]
M v[40:43], v[104:107], a[40:43], v[40:43]
M v[40:43], v[108:111], a[44:47], v[40:43]
M v[44:47], v[96:99], a[48:51], v[28:31]
M v[44:47], v[100:103], a[52:55], v[44:47]
M v[44:47], v[104:107], a[56:59], v[44:47]
M v[44:47], v[108:111], a[60:63], v[44:47]
M v[48:51], v[112:115], a[0:3], v[20:23]
M v[48:51], v[116:119], a[4:7], v[48:51]
M v[48:51], v[120:123], a[8:11], v[48:51]
M v[48:51], v[124:127], a[12:15], v[48:51]
M v[52:55], v[112:115], a[16:19], v[24:27]
M v[52:55], v[116:119], a[20:23], v[52:55]
M v[52:55], v[120:123], a[24:27], v[52:55]
M v[52:55], v[124:127], a[28:31], v[52:55]
M v[56:59], v[112:115], a[32:35], v[28:31]
M v[56:59], v[116:119], a[36:39], v[56:59]
M v[56:59], v[120:123], a[40:43], v[56:59]
M v[56:59], v[124:127], a[44:47], v[56:59]
M v[60:63], v[112:115], a[48:51], v[28:31]
M v[60:63], v[116:119], a[52:55], v[60:63]
M v[60:63], v[120:123], a[56:59], v[60:63]
M v[60:63], v[124:127], a[60:63], v[60:63]
M v[64:67], v[128:131], a[0:3], v[20:23]
M v[64:67], v[132:135], a[4:7], v[64:67]
M v[64:67], v[136:139], a[8:11], v[64:67]
M v[64:67], v[140:143], a[12:15], v[64:67]
M v[68:71], v[128:131], a[16:19], v[20:23]
M v[68:71], v[132:135], a[20:23], v[68:71]
M v[68:71], v[136:139], a[24:27], v[68:71]
M v[68:71], v[140:143], a[28:31], v[68:71]
M v[72:75], v[128:131], a[32:35], v[24:27]
M v[72:75], v[132:135], a[36:39], v[72:75]
M v[72:75], v[136:139], a[40:43], v[72:75]
M v[72:75], v[140:143], a[44:47], v[72:75]
M v[76:79], v[128:131], a[48:51], v[28:31]
M v[76:79], v[132:135], a[52:55], v[76:79]
M v[76:79], v[136:139], a[56:59], v[76:79]
M v[76:79], v[140:143], a[60:63], v[76:79]
M v[80:83], v[144:147], a[0:3], v[20:23]
M v[80:83], v[148:151], a[4:7], v[80:83]
M v[80:83], v[152:155], a[8:11], v[80:83]
M v[80:83], v[156:159], a[12:15], v[80:83]
M v[84:87], v[144:147], a[16:19], v[20:23]
M v[84:87], v[148:151], a[20:23], v[84:87]
M v[84:87], v[152:155], a[24:27], v[84:87]
M v[84:87], v[156:159], a[28:31], v[84:87]
M v[88:91], v[144:147], a[32:35], v[20:23]
M v[88:91], v[148:151], a[36:39], v[88:91]
M v[88:91], v[152:155], a[40:43], v[88:91]
M v[88:91], v[156:159], a[44:47], v[88:91]
M v[92:95], v[144:147], a[48:51], v[24:27]
M v[92:95], v[148:151], a[52:55], v[92:95]
M v[92:95], v[152:155], a[56:59], v[92:95]
M v[92:95], v[156:159], a[60:63], v[92:95]
s_nop 7
s_add_u32 s35, s57, 16384
buffer_load_dwordx4 v[96:99], v1, s[12:15], s35 offen offset:0 sc1
buffer_load_dwordx4 v[100:103], v1, s[12:15], s35 offen offset:1024 sc1
buffer_load_dwordx4 v[104:107], v1, s[12:15], s35 offen offset:2048 sc1
buffer_load_dwordx4 v[108:111], v1, s[12:15], s35 offen offset:3072 sc1
s_add_u32 s35, s57, 20480
buffer_load_dwordx4 v[112:115], v1, s[12:15], s35 offen offset:0 sc1
buffer_load_dwordx4 v[116:119], v1, s[12:15], s35 offen offset:1024 sc1
buffer_load_dwordx4 v[120:123], v1, s[12:15], s35 offen offset:2048 sc1
buffer_load_dwordx4 v[124:127], v1, s[12:15], s35 offen offset:3072 sc1
s_add_u32 s35, s57, 24576
buffer_load_dwordx4 v[128:131], v1, s[12:15], s35 offen offset:0 sc1
buffer_load_dwordx4 v[132:135], v1, s[12:15], s35 offen offset:1024 sc1
buffer_load_dwordx4 v[136:139], v1, s[12:15], s35 offen offset:2048 sc1
buffer_load_dwordx4 v[140:143], v1, s[12:15], s35 offen offset:3072 sc1
s_add_u32 s35, s57, 28672
buffer_load_dwordx4 v[144:147], v1, s[12:15], s35 offen offset:0 sc1
buffer_load_dwordx4 v[148:151], v1, s[12:15], s35 offen offset:1024 sc1
buffer_load_dwordx4 v[152:155], v1, s[12:15], s35 offen offset:2048 sc1
buffer_load_dwordx4 v[156:159], v1, s[12:15], s35 offen offset:3072 sc1
v_max3_f32 v13, v32, v33, v8
v_max3_f32 v13, v13, v34, v35
v_max3_f32 v13, v13, v48, v49
v_max3_f32 v13, v13, v50, v51
v_max3_f32 v13, v13, v64, v65
v_max3_f32 v13, v13, v66, v67
v_max3_f32 v13, v13, v80, v81
v_max3_f32 v13, v13, v82, v83
v_mov_b32 v14, v13
s_nop 1
v_permlane16_swap_b32 v13, v14
v_max_f32 v13, v13, v14
v_mov_b32 v14, v13
s_nop 1
v_permlane32_swap_b32 v13, v14
v_max_f32 v13, v13, v14
v_sub_f32 v12, v8, v13
v_exp_f32 v12, v12
v_mov_b32 v8, v13
v_sub_f32 v32, v32, v13
v_sub_f32 v33, v33, v13
v_sub_f32 v34, v34, v13
v_sub_f32 v35, v35, v13
v_sub_f32 v48, v48, v13
v_sub_f32 v49, v49, v13
v_sub_f32 v50, v50, v13
v_sub_f32 v51, v51, v13
v_sub_f32 v64, v64, v13
v_sub_f32 v65, v65, v13
v_sub_f32 v66, v66, v13
v_sub_f32 v67, v67, v13
v_sub_f32 v80, v80, v13
v_sub_f32 v81, v81, v13
v_sub_f32 v82, v82, v13
v_sub_f32 v83, v83, v13
v_mul_f32 v160, v160, v12
v_mul_f32 v161, v161, v12
v_mul_f32 v162, v162, v12
v_mul_f32 v163, v163, v12
v_mul_f32 v176, v176, v12
v_mul_f32 v177, v177, v12
v_mul_f32 v178, v178, v12
v_mul_f32 v179, v179, v12
v_mul_f32 v192, v192, v12
v_mul_f32 v193, v193, v12
v_mul_f32 v194, v194, v12
v_mul_f32 v195, v195, v12
v_mul_f32 v208, v208, v12
v_mul_f32 v209, v209, v12
v_mul_f32 v210, v210, v12
v_mul_f32 v211, v211, v12
v_mul_f32 v224, v224, v12
v_mul_f32 v225, v225, v12
v_mul_f32 v226, v226, v12
v_mul_f32 v227, v227, v12
v_mul_f32 v240, v240, v12
v_mul_f32 v241, v241, v12
v_mul_f32 v242, v242, v12
v_mul_f32 v243, v243, v12
v_accvgpr_read_b32 v14, a64
v_mul_f32 v14, v14, v12
v_accvgpr_write_b32 a64, v14
v_accvgpr_read_b32 v14, a65
v_mul_f32 v14, v14, v12
v_accvgpr_write_b32 a65, v14
v_accvgpr_read_b32 v14, a66
v_mul_f32 v14, v14, v12
v_accvgpr_write_b32 a66, v14
v_accvgpr_read_b32 v14, a67
v_mul_f32 v14, v14, v12
v_accvgpr_write_b32 a67, v14
v_accvgpr_read_b32 v14, a80
v_mul_f32 v14, v14, v12
v_accvgpr_write_b32 a80, v14
v_accvgpr_read_b32 v14, a81
v_mul_f32 v14, v14, v12
v_accvgpr_write_b32 a81, v14
v_accvgpr_read_b32 v14, a82
v_mul_f32 v14, v14, v12
v_accvgpr_write_b32 a82, v14
v_accvgpr_read_b32 v14, a83
v_mul_f32 v14, v14, v12
v_accvgpr_write_b32 a83, v14
v_accvgpr_read_b32 v14, a96
v_mul_f32 v14, v14, v12
v_accvgpr_write_b32 a96, v14
v_accvgpr_read_b32 v14, a97
v_mul_f32 v14, v14, v12
v_accvgpr_write_b32 a97, v14
v_accvgpr_read_b32 v14, a98
v_mul_f32 v14, v14, v12
v_accvgpr_write_b32 a98, v14
v_accvgpr_read_b32 v14, a99
v_mul_f32 v14, v14, v12
v_accvgpr_write_b32 a99, v14
v_max3_f32 v13, v36, v37, v9
v_max3_f32 v13, v13, v38, v39
v_max3_f32 v13, v13, v52, v53
v_max3_f32 v13, v13, v54, v55
v_max3_f32 v13, v13, v68, v69
v_max3_f32 v13, v13, v70, v71
v_max3_f32 v13, v13, v84, v85
v_max3_f32 v13, v13, v86, v87
v_mov_b32 v14, v13
s_nop 1
v_permlane16_swap_b32 v13, v14
v_max_f32 v13, v13, v14
v_mov_b32 v14, v13
s_nop 1
v_permlane32_swap_b32 v13, v14
v_max_f32 v13, v13, v14
v_sub_f32 v12, v9, v13
v_exp_f32 v12, v12
v_mov_b32 v9, v13
v_sub_f32 v36, v36, v13
v_sub_f32 v37, v37, v13
v_sub_f32 v38, v38, v13
v_sub_f32 v39, v39, v13
v_sub_f32 v52, v52, v13
v_sub_f32 v53, v53, v13
v_sub_f32 v54, v54, v13
v_sub_f32 v55, v55, v13
v_sub_f32 v68, v68, v13
v_sub_f32 v69, v69, v13
v_sub_f32 v70, v70, v13
v_sub_f32 v71, v71, v13
v_sub_f32 v84, v84, v13
v_sub_f32 v85, v85, v13
v_sub_f32 v86, v86, v13
v_sub_f32 v87, v87, v13
v_mul_f32 v164, v164, v12
v_mul_f32 v165, v165, v12
v_mul_f32 v166, v166, v12
v_mul_f32 v167, v167, v12
v_mul_f32 v180, v180, v12
v_mul_f32 v181, v181, v12
v_mul_f32 v182, v182, v12
v_mul_f32 v183, v183, v12
v_mul_f32 v196, v196, v12
v_mul_f32 v197, v197, v12
v_mul_f32 v198, v198, v12
v_mul_f32 v199, v199, v12
v_mul_f32 v212, v212, v12
v_mul_f32 v213, v213, v12
v_mul_f32 v214, v214, v12
v_mul_f32 v215, v215, v12
v_mul_f32 v228, v228, v12
v_mul_f32 v229, v229, v12
v_mul_f32 v230, v230, v12
v_mul_f32 v231, v231, v12
v_mul_f32 v244, v244, v12
v_mul_f32 v245, v245, v12
v_mul_f32 v246, v246, v12
v_mul_f32 v247, v247, v12
v_accvgpr_read_b32 v14, a68
v_mul_f32 v14, v14, v12
v_accvgpr_write_b32 a68, v14
v_accvgpr_read_b32 v14, a69
v_mul_f32 v14, v14, v12
v_accvgpr_write_b32 a69, v14
v_accvgpr_read_b32 v14, a70
v_mul_f32 v14, v14, v12
v_accvgpr_write_b32 a70, v14
v_accvgpr_read_b32 v14, a71
v_mul_f32 v14, v14, v12
v_accvgpr_write_b32 a71, v14
v_accvgpr_read_b32 v14, a84
v_mul_f32 v14, v14, v12
v_accvgpr_write_b32 a84, v14
v_accvgpr_read_b32 v14, a85
v_mul_f32 v14, v14, v12
v_accvgpr_write_b32 a85, v14
v_accvgpr_read_b32 v14, a86
v_mul_f32 v14, v14, v12
v_accvgpr_write_b32 a86, v14
v_accvgpr_read_b32 v14, a87
v_mul_f32 v14, v14, v12
v_accvgpr_write_b32 a87, v14
v_accvgpr_read_b32 v14, a100
v_mul_f32 v14, v14, v12
v_accvgpr_write_b32 a100, v14
v_accvgpr_read_b32 v14, a101
v_mul_f32 v14, v14, v12
v_accvgpr_write_b32 a101, v14
v_accvgpr_read_b32 v14, a102
v_mul_f32 v14, v14, v12
v_accvgpr_write_b32 a102, v14
v_accvgpr_read_b32 v14, a103
v_mul_f32 v14, v14, v12
v_accvgpr_write_b32 a103, v14
v_max3_f32 v13, v40, v41, v10
v_max3_f32 v13, v13, v42, v43
v_max3_f32 v13, v13, v56, v57
v_max3_f32 v13, v13, v58, v59
v_max3_f32 v13, v13, v72, v73
v_max3_f32 v13, v13, v74, v75
v_max3_f32 v13, v13, v88, v89
v_max3_f32 v13, v13, v90, v91
v_mov_b32 v14, v13
s_nop 1
v_permlane16_swap_b32 v13, v14
v_max_f32 v13, v13, v14
v_mov_b32 v14, v13
s_nop 1
v_permlane32_swap_b32 v13, v14
v_max_f32 v13, v13, v14
v_sub_f32 v12, v10, v13
v_exp_f32 v12, v12
v_mov_b32 v10, v13
v_sub_f32 v40, v40, v13
v_sub_f32 v41, v41, v13
v_sub_f32 v42, v42, v13
v_sub_f32 v43, v43, v13
v_sub_f32 v56, v56, v13
v_sub_f32 v57, v57, v13
v_sub_f32 v58, v58, v13
v_sub_f32 v59, v59, v13
v_sub_f32 v72, v72, v13
v_sub_f32 v73, v73, v13
v_sub_f32 v74, v74, v13
v_sub_f32 v75, v75, v13
v_sub_f32 v88, v88, v13
v_sub_f32 v89, v89, v13
v_sub_f32 v90, v90, v13
v_sub_f32 v91, v91, v13
v_mul_f32 v168, v168, v12
v_mul_f32 v169, v169, v12
v_mul_f32 v170, v170, v12
v_mul_f32 v171, v171, v12
v_mul_f32 v184, v184, v12
v_mul_f32 v185, v185, v12
v_mul_f32 v186, v186, v12
v_mul_f32 v187, v187, v12
v_mul_f32 v200, v200, v12
v_mul_f32 v201, v201, v12
v_mul_f32 v202, v202, v12
v_mul_f32 v203, v203, v12
v_mul_f32 v216, v216, v12
v_mul_f32 v217, v217, v12
v_mul_f32 v218, v218, v12
v_mul_f32 v219, v219, v12
v_mul_f32 v232, v232, v12
v_mul_f32 v233, v233, v12
v_mul_f32 v234, v234, v12
v_mul_f32 v235, v235, v12
v_mul_f32 v248, v248, v12
v_mul_f32 v249, v249, v12
v_mul_f32 v250, v250, v12
v_mul_f32 v251, v251, v12
v_accvgpr_read_b32 v14, a72
v_mul_f32 v14, v14, v12
v_accvgpr_write_b32 a72, v14
v_accvgpr_read_b32 v14, a73
v_mul_f32 v14, v14, v12
v_accvgpr_write_b32 a73, v14
v_accvgpr_read_b32 v14, a74
v_mul_f32 v14, v14, v12
v_accvgpr_write_b32 a74, v14
v_accvgpr_read_b32 v14, a75
v_mul_f32 v14, v14, v12
v_accvgpr_write_b32 a75, v14
v_accvgpr_read_b32 v14, a88
v_mul_f32 v14, v14, v12
v_accvgpr_write_b32 a88, v14
v_accvgpr_read_b32 v14, a89
v_mul_f32 v14, v14, v12
v_accvgpr_write_b32 a89, v14
v_accvgpr_read_b32 v14, a90
v_mul_f32 v14, v14, v12
v_accvgpr_write_b32 a90, v14
v_accvgpr_read_b32 v14, a91
v_mul_f32 v14, v14, v12
v_accvgpr_write_b32 a91, v14
v_accvgpr_read_b32 v14, a104
v_mul_f32 v14, v14, v12
v_accvgpr_write_b32 a104, v14
v_accvgpr_read_b32 v14, a105
v_mul_f32 v14, v14, v12
v_accvgpr_write_b32 a105, v14
v_accvgpr_read_b32 v14, a106
v_mul_f32 v14, v14, v12
v_accvgpr_write_b32 a106, v14
v_accvgpr_read_b32 v14, a107
v_mul_f32 v14, v14, v12
v_accvgpr_write_b32 a107, v14
v_max3_f32 v13, v44, v45, v11
v_max3_f32 v13, v13, v46, v47
v_max3_f32 v13, v13, v60, v61
v_max3_f32 v13, v13, v62, v63
v_max3_f32 v13, v13, v76, v77
v_max3_f32 v13, v13, v78, v79
v_max3_f32 v13, v13, v92, v93
v_max3_f32 v13, v13, v94, v95
v_mov_b32 v14, v13
s_nop 1
v_permlane16_swap_b32 v13, v14
v_max_f32 v13, v13, v14
v_mov_b32 v14, v13
s_nop 1
v_permlane32_swap_b32 v13, v14
v_max_f32 v13, v13, v14
v_sub_f32 v12, v11, v13
v_exp_f32 v12, v12
v_mov_b32 v11, v13
v_sub_f32 v44, v44, v13
v_sub_f32 v45, v45, v13
v_sub_f32 v46, v46, v13
v_sub_f32 v47, v47, v13
v_sub_f32 v60, v60, v13
v_sub_f32 v61, v61, v13
v_sub_f32 v62, v62, v13
v_sub_f32 v63, v63, v13
v_sub_f32 v76, v76, v13
v_sub_f32 v77, v77, v13
v_sub_f32 v78, v78, v13
v_sub_f32 v79, v79, v13
v_sub_f32 v92, v92, v13
v_sub_f32 v93, v93, v13
v_sub_f32 v94, v94, v13
v_sub_f32 v95, v95, v13
v_mul_f32 v172, v172, v12
v_mul_f32 v173, v173, v12
v_mul_f32 v174, v174, v12
v_mul_f32 v175, v175, v12
v_mul_f32 v188, v188, v12
v_mul_f32 v189, v189, v12
v_mul_f32 v190, v190, v12
v_mul_f32 v191, v191, v12
v_mul_f32 v204, v204, v12
v_mul_f32 v205, v205, v12
v_mul_f32 v206, v206, v12
v_mul_f32 v207, v207, v12
v_mul_f32 v220, v220, v12
v_mul_f32 v221, v221, v12
v_mul_f32 v222, v222, v12
v_mul_f32 v223, v223, v12
v_mul_f32 v236, v236, v12
v_mul_f32 v237, v237, v12
v_mul_f32 v238, v238, v12
v_mul_f32 v239, v239, v12
v_mul_f32 v252, v252, v12
v_mul_f32 v253, v253, v12
v_mul_f32 v254, v254, v12
v_mul_f32 v255, v255, v12
v_accvgpr_read_b32 v14, a76
v_mul_f32 v14, v14, v12
v_accvgpr_write_b32 a76, v14
v_accvgpr_read_b32 v14, a77
v_mul_f32 v14, v14, v12
v_accvgpr_write_b32 a77, v14
v_accvgpr_read_b32 v14, a78
v_mul_f32 v14, v14, v12
v_accvgpr_write_b32 a78, v14
v_accvgpr_read_b32 v14, a79
v_mul_f32 v14, v14, v12
v_accvgpr_write_b32 a79, v14
v_accvgpr_read_b32 v14, a92
v_mul_f32 v14, v14, v12
v_accvgpr_write_b32 a92, v14
v_accvgpr_read_b32 v14, a93
v_mul_f32 v14, v14, v12
v_accvgpr_write_b32 a93, v14
v_accvgpr_read_b32 v14, a94
v_mul_f32 v14, v14, v12
v_accvgpr_write_b32 a94, v14
v_accvgpr_read_b32 v14, a95
v_mul_f32 v14, v14, v12
v_accvgpr_write_b32 a95, v14
v_accvgpr_read_b32 v14, a108
v_mul_f32 v14, v14, v12
v_accvgpr_write_b32 a108, v14
v_accvgpr_read_b32 v14, a109
v_mul_f32 v14, v14, v12
v_accvgpr_write_b32 a109, v14
v_accvgpr_read_b32 v14, a110
v_mul_f32 v14, v14, v12
v_accvgpr_write_b32 a110, v14
v_accvgpr_read_b32 v14, a111
v_mul_f32 v14, v14, v12
v_accvgpr_write_b32 a111, v14
v_exp_f32 v32, v32
v_exp_f32 v33, v33
v_exp_f32 v34, v34
v_exp_f32 v35, v35
v_exp_f32 v48, v48
v_exp_f32 v49, v49
v_exp_f32 v50, v50
v_exp_f32 v51, v51
v_cvt_pk_bf16_f32 v32, v32, v33
v_cvt_pk_bf16_f32 v33, v34, v35
v_exp_f32 v36, v36
v_exp_f32 v37, v37
v_exp_f32 v38, v38
v_exp_f32 v39, v39
v_cvt_pk_bf16_f32 v34, v48, v49
v_cvt_pk_bf16_f32 v35, v50, v51
v_exp_f32 v52, v52
v_exp_f32 v53, v53
v_exp_f32 v54, v54
v_exp_f32 v55, v55
v_cvt_pk_bf16_f32 v36, v36, v37
v_cvt_pk_bf16_f32 v37, v38, v39
v_exp_f32 v40, v40
v_exp_f32 v41, v41
v_exp_f32 v42, v42
v_exp_f32 v43, v43
v_cvt_pk_bf16_f32 v38, v52, v53
v_cvt_pk_bf16_f32 v39, v54, v55
v_exp_f32 v56, v56
v_exp_f32 v57, v57
v_exp_f32 v58, v58
v_exp_f32 v59, v59
v_cvt_pk_bf16_f32 v40, v40, v41
v_cvt_pk_bf16_f32 v41, v42, v43
v_exp_f32 v44, v44
v_exp_f32 v45, v45
v_exp_f32 v46, v46
v_exp_f32 v47, v47
v_cvt_pk_bf16_f32 v42, v56, v57
v_cvt_pk_bf16_f32 v43, v58, v59
v_exp_f32 v60, v60
v_exp_f32 v61, v61
v_exp_f32 v62, v62
v_exp_f32 v63, v63
v_cvt_pk_bf16_f32 v44, v44, v45
v_cvt_pk_bf16_f32 v45, v46, v47
v_cvt_pk_bf16_f32 v46, v60, v61
v_cvt_pk_bf16_f32 v47, v62, v63
v_exp_f32 v64, v64
v_exp_f32 v65, v65
v_exp_f32 v66, v66
v_exp_f32 v67, v67
v_exp_f32 v80, v80
v_exp_f32 v81, v81
v_exp_f32 v82, v82
v_exp_f32 v83, v83
v_cvt_pk_bf16_f32 v64, v64, v65
v_cvt_pk_bf16_f32 v65, v66, v67
v_exp_f32 v68, v68
v_exp_f32 v69, v69
v_exp_f32 v70, v70
v_exp_f32 v71, v71
v_cvt_pk_bf16_f32 v66, v80, v81
v_cvt_pk_bf16_f32 v67, v82, v83
v_exp_f32 v84, v84
v_exp_f32 v85, v85
v_exp_f32 v86, v86
v_exp_f32 v87, v87
v_cvt_pk_bf16_f32 v68, v68, v69
v_cvt_pk_bf16_f32 v69, v70, v71
v_exp_f32 v72, v72
v_exp_f32 v73, v73
v_exp_f32 v74, v74
v_exp_f32 v75, v75
v_cvt_pk_bf16_f32 v70, v84, v85
v_cvt_pk_bf16_f32 v71, v86, v87
v_exp_f32 v88, v88
v_exp_f32 v89, v89
v_exp_f32 v90, v90
v_exp_f32 v91, v91
v_cvt_pk_bf16_f32 v72, v72, v73
v_cvt_pk_bf16_f32 v73, v74, v75
v_exp_f32 v76, v76
v_exp_f32 v77, v77
v_exp_f32 v78, v78
v_exp_f32 v79, v79
v_cvt_pk_bf16_f32 v74, v88, v89
v_cvt_pk_bf16_f32 v75, v90, v91
v_exp_f32 v92, v92
v_exp_f32 v93, v93
v_exp_f32 v94, v94
v_exp_f32 v95, v95
v_cvt_pk_bf16_f32 v76, v76, v77
v_cvt_pk_bf16_f32 v77, v78, v79
v_cvt_pk_bf16_f32 v78, v92, v93
v_cvt_pk_bf16_f32 v79, v94, v95
s_waitcnt vmcnt(0)
M a[96:99], a[112:115], v[32:35], a[96:99]
M a[100:103], a[112:115], v[36:39], a[100:103]
M a[104:107], a[112:115], v[40:43], a[104:107]
M a[108:111], a[112:115], v[44:47], a[108:111]
M v[160:163], v[96:99], v[32:35], v[160:163]
M v[164:167], v[96:99], v[36:39], v[164:167]
M v[168:171], v[96:99], v[40:43], v[168:171]
M v[172:175], v[96:99], v[44:47], v[172:175]
M v[176:179], v[100:103], v[32:35], v[176:179]
M v[180:183], v[100:103], v[36:39], v[180:183]
M v[184:187], v[100:103], v[40:43], v[184:187]
M v[188:191], v[100:103], v[44:47], v[188:191]
M v[192:195], v[104:107], v[32:35], v[192:195]
M v[196:199], v[104:107], v[36:39], v[196:199]
M v[200:203], v[104:107], v[40:43], v[200:203]
M v[204:207], v[104:107], v[44:47], v[204:207]
M v[208:211], v[108:111], v[32:35], v[208:211]
M v[212:215], v[108:111], v[36:39], v[212:215]
M v[216:219], v[108:111], v[40:43], v[216:219]
M v[220:223], v[108:111], v[44:47], v[220:223]
M v[224:227], v[112:115], v[32:35], v[224:227]
M v[228:231], v[112:115], v[36:39], v[228:231]
M v[232:235], v[112:115], v[40:43], v[232:235]
M v[236:239], v[112:115], v[44:47], v[236:239]
M v[240:243], v[116:119], v[32:35], v[240:243]
M v[244:247], v[116:119], v[36:39], v[244:247]
M v[248:251], v[116:119], v[40:43], v[248:251]
M v[252:255], v[116:119], v[44:47], v[252:255]
M a[64:67], v[120:123], v[32:35], a[64:67]
M a[68:71], v[120:123], v[36:39], a[68:71]
M a[72:75], v[120:123], v[40:43], a[72:75]
M a[76:79], v[120:123], v[44:47], a[76:79]
M a[80:83], v[124:127], v[32:35], a[80:83]
M a[84:87], v[124:127], v[36:39], a[84:87]
M a[88:91], v[124:127], v[40:43], a[88:91]
M a[92:95], v[124:127], v[44:47], a[92:95]
M a[96:99], a[112:115], v[64:67], a[96:99]
M a[100:103], a[112:115], v[68:71], a[100:103]
M a[104:107], a[112:115], v[72:75], a[104:107]
M a[108:111], a[112:115], v[76:79], a[108:111]
M v[160:163], v[128:131], v[64:67], v[160:163]
M v[164:167], v[128:131], v[68:71], v[164:167]
M v[168:171], v[128:131], v[72:75], v[168:171]
M v[172:175], v[128:131], v[76:79], v[172:175]
M v[176:179], v[132:135], v[64:67], v[176:179]
M v[180:183], v[132:135], v[68:71], v[180:183]
M v[184:187], v[132:135], v[72:75], v[184:187]
M v[188:191], v[132:135], v[76:79], v[188:191]
M v[192:195], v[136:139], v[64:67], v[192:195]
M v[196:199], v[136:139], v[68:71], v[196:199]
M v[200:203], v[136:139], v[72:75], v[200:203]
M v[204:207], v[136:139], v[76:79], v[204:207]
M v[208:211], v[140:143], v[64:67], v[208:211]
M v[212:215], v[140:143], v[68:71], v[212:215]
M v[216:219], v[140:143], v[72:75], v[216:219]
M v[220:223], v[140:143], v[76:79], v[220:223]
M v[224:227], v[144:147], v[64:67], v[224:227]
M v[228:231], v[144:147], v[68:71], v[228:231]
M v[232:235], v[144:147], v[72:75], v[232:235]
M v[236:239], v[144:147], v[76:79], v[236:239]
M v[240:243], v[148:151], v[64:67], v[240:243]
M v[244:247], v[148:151], v[68:71], v[244:247]
M v[248:251], v[148:151], v[72:75], v[248:251]
M v[252:255], v[148:151], v[76:79], v[252:255]
M a[64:67], v[152:155], v[64:67], a[64:67]
M a[68:71], v[152:155], v[68:71], a[68:71]
M a[72:75], v[152:155], v[72:75], a[72:75]
M a[76:79], v[152:155], v[76:79], a[76:79]
M a[80:83], v[156:159], v[64:67], a[80:83]
M a[84:87], v[156:159], v[68:71], a[84:87]
M a[88:91], v[156:159], v[72:75], a[88:91]
M a[92:95], v[156:159], v[76:79], a[92:95]
s_nop 7
s_add_u32 s57, s57, 32768
s_sub_u32 s58, s58, 64
s_sub_u32 s59, s59, 1
s_cmp_lg_u32 s59, 0
s_cbranch_scc1 Lslow_1
v_accvgpr_read_b32 v20, a96
v_accvgpr_read_b32 v21, a100
v_accvgpr_read_b32 v22, a104
v_accvgpr_read_b32 v23, a108
v_rcp_f32 v8, v20
v_rcp_f32 v9, v21
v_rcp_f32 v10, v22
v_rcp_f32 v11, v23
s_lshl_b32 s33, s56, 20
s_lshl_b32 s34, s20, 15
s_add_u32 s33, s33, s34
s_lshl_b32 s34, s23, 13
s_add_u32 s36, s33, s34
s_add_u32 s37, s36, 4096
s_add_u32 s38, s36, 16384
s_add_u32 s39, s36, 20480
v_pk_mul_f32 v[160:161], v[160:161], v[8:9] op_sel:[0,0] op_sel_hi:[1,0]
v_pk_mul_f32 v[162:163], v[162:163], v[8:9] op_sel:[0,0] op_sel_hi:[1,0]
v_pk_mul_f32 v[176:177], v[176:177], v[8:9] op_sel:[0,0] op_sel_hi:[1,0]
v_pk_mul_f32 v[178:179], v[178:179], v[8:9] op_sel:[0,0] op_sel_hi:[1,0]
v_cvt_pk_bf16_f32 v160, v160, v161
v_cvt_pk_bf16_f32 v161, v162, v163
v_cvt_pk_bf16_f32 v162, v176, v177
v_cvt_pk_bf16_f32 v163, v178, v179
v_pk_mul_f32 v[164:165], v[164:165], v[8:9] op_sel:[0,1] op_sel_hi:[1,1]
v_pk_mul_f32 v[166:167], v[166:167], v[8:9] op_sel:[0,1] op_sel_hi:[1,1]
v_pk_mul_f32 v[180:181], v[180:181], v[8:9] op_sel:[0,1] op_sel_hi:[1,1]
v_pk_mul_f32 v[182:183], v[182:183], v[8:9] op_sel:[0,1] op_sel_hi:[1,1]
v_cvt_pk_bf16_f32 v164, v164, v165
v_cvt_pk_bf16_f32 v165, v166, v167
v_cvt_pk_bf16_f32 v166, v180, v181
v_cvt_pk_bf16_f32 v167, v182, v183
v_pk_mul_f32 v[168:169], v[168:169], v[10:11] op_sel:[0,0] op_sel_hi:[1,0]
v_pk_mul_f32 v[170:171], v[170:171], v[10:11] op_sel:[0,0] op_sel_hi:[1,0]
v_pk_mul_f32 v[184:185], v[184:185], v[10:11] op_sel:[0,0] op_sel_hi:[1,0]
v_pk_mul_f32 v[186:187], v[186:187], v[10:11] op_sel:[0,0] op_sel_hi:[1,0]
v_cvt_pk_bf16_f32 v168, v168, v169
v_cvt_pk_bf16_f32 v169, v170, v171
v_cvt_pk_bf16_f32 v170, v184, v185
v_cvt_pk_bf16_f32 v171, v186, v187
v_pk_mul_f32 v[172:173], v[172:173], v[10:11] op_sel:[0,1] op_sel_hi:[1,1]
v_pk_mul_f32 v[174:175], v[174:175], v[10:11] op_sel:[0,1] op_sel_hi:[1,1]
v_pk_mul_f32 v[188:189], v[188:189], v[10:11] op_sel:[0,1] op_sel_hi:[1,1]
v_pk_mul_f32 v[190:191], v[190:191], v[10:11] op_sel:[0,1] op_sel_hi:[1,1]
v_cvt_pk_bf16_f32 v172, v172, v173
v_cvt_pk_bf16_f32 v173, v174, v175
v_cvt_pk_bf16_f32 v174, v188, v189
v_cvt_pk_bf16_f32 v175, v190, v191
v_pk_mul_f32 v[192:193], v[192:193], v[8:9] op_sel:[0,0] op_sel_hi:[1,0]
v_pk_mul_f32 v[194:195], v[194:195], v[8:9] op_sel:[0,0] op_sel_hi:[1,0]
v_pk_mul_f32 v[208:209], v[208:209], v[8:9] op_sel:[0,0] op_sel_hi:[1,0]
v_pk_mul_f32 v[210:211], v[210:211], v[8:9] op_sel:[0,0] op_sel_hi:[1,0]
v_cvt_pk_bf16_f32 v192, v192, v193
v_cvt_pk_bf16_f32 v193, v194, v195
v_cvt_pk_bf16_f32 v194, v208, v209
v_cvt_pk_bf16_f32 v195, v210, v211
v_pk_mul_f32 v[196:197], v[196:197], v[8:9] op_sel:[0,1] op_sel_hi:[1,1]
v_pk_mul_f32 v[198:199], v[198:199], v[8:9] op_sel:[0,1] op_sel_hi:[1,1]
v_pk_mul_f32 v[212:213], v[212:213], v[8:9] op_sel:[0,1] op_sel_hi:[1,1]
v_pk_mul_f32 v[214:215], v[214:215], v[8:9] op_sel:[0,1] op_sel_hi:[1,1]
v_cvt_pk_bf16_f32 v196, v196, v197
v_cvt_pk_bf16_f32 v197, v198, v199
v_cvt_pk_bf16_f32 v198, v212, v213
v_cvt_pk_bf16_f32 v199, v214, v215
v_pk_mul_f32 v[200:201], v[200:201], v[10:11] op_sel:[0,0] op_sel_hi:[1,0]
v_pk_mul_f32 v[202:203], v[202:203], v[10:11] op_sel:[0,0] op_sel_hi:[1,0]
v_pk_mul_f32 v[216:217], v[216:217], v[10:11] op_sel:[0,0] op_sel_hi:[1,0]
v_pk_mul_f32 v[218:219], v[218:219], v[10:11] op_sel:[0,0] op_sel_hi:[1,0]
v_cvt_pk_bf16_f32 v200, v200, v201
v_cvt_pk_bf16_f32 v201, v202, v203
v_cvt_pk_bf16_f32 v202, v216, v217
v_cvt_pk_bf16_f32 v203, v218, v219
v_pk_mul_f32 v[204:205], v[204:205], v[10:11] op_sel:[0,1] op_sel_hi:[1,1]
v_pk_mul_f32 v[206:207], v[206:207], v[10:11] op_sel:[0,1] op_sel_hi:[1,1]
v_pk_mul_f32 v[220:221], v[220:221], v[10:11] op_sel:[0,1] op_sel_hi:[1,1]
v_pk_mul_f32 v[222:223], v[222:223], v[10:11] op_sel:[0,1] op_sel_hi:[1,1]
v_cvt_pk_bf16_f32 v204, v204, v205
v_cvt_pk_bf16_f32 v205, v206, v207
v_cvt_pk_bf16_f32 v206, v220, v221
v_cvt_pk_bf16_f32 v207, v222, v223
v_pk_mul_f32 v[224:225], v[224:225], v[8:9] op_sel:[0,0] op_sel_hi:[1,0]
v_pk_mul_f32 v[226:227], v[226:227], v[8:9] op_sel:[0,0] op_sel_hi:[1,0]
v_pk_mul_f32 v[240:241], v[240:241], v[8:9] op_sel:[0,0] op_sel_hi:[1,0]
v_pk_mul_f32 v[242:243], v[242:243], v[8:9] op_sel:[0,0] op_sel_hi:[1,0]
v_cvt_pk_bf16_f32 v224, v224, v225
v_cvt_pk_bf16_f32 v225, v226, v227
v_cvt_pk_bf16_f32 v226, v240, v241
v_cvt_pk_bf16_f32 v227, v242, v243
v_pk_mul_f32 v[228:229], v[228:229], v[8:9] op_sel:[0,1] op_sel_hi:[1,1]
v_pk_mul_f32 v[230:231], v[230:231], v[8:9] op_sel:[0,1] op_sel_hi:[1,1]
v_pk_mul_f32 v[244:245], v[244:245], v[8:9] op_sel:[0,1] op_sel_hi:[1,1]
v_pk_mul_f32 v[246:247], v[246:247], v[8:9] op_sel:[0,1] op_sel_hi:[1,1]
v_cvt_pk_bf16_f32 v228, v228, v229
v_cvt_pk_bf16_f32 v229, v230, v231
v_cvt_pk_bf16_f32 v230, v244, v245
v_cvt_pk_bf16_f32 v231, v246, v247
v_pk_mul_f32 v[232:233], v[232:233], v[10:11] op_sel:[0,0] op_sel_hi:[1,0]
v_pk_mul_f32 v[234:235], v[234:235], v[10:11] op_sel:[0,0] op_sel_hi:[1,0]
v_pk_mul_f32 v[248:249], v[248:249], v[10:11] op_sel:[0,0] op_sel_hi:[1,0]
v_pk_mul_f32 v[250:251], v[250:251], v[10:11] op_sel:[0,0] op_sel_hi:[1,0]
v_cvt_pk_bf16_f32 v232, v232, v233
v_cvt_pk_bf16_f32 v233, v234, v235
v_cvt_pk_bf16_f32 v234, v248, v249
v_cvt_pk_bf16_f32 v235, v250, v251
v_pk_mul_f32 v[236:237], v[236:237], v[10:11] op_sel:[0,1] op_sel_hi:[1,1]
v_pk_mul_f32 v[238:239], v[238:239], v[10:11] op_sel:[0,1] op_sel_hi:[1,1]
v_pk_mul_f32 v[252:253], v[252:253], v[10:11] op_sel:[0,1] op_sel_hi:[1,1]
v_pk_mul_f32 v[254:255], v[254:255], v[10:11] op_sel:[0,1] op_sel_hi:[1,1]
v_cvt_pk_bf16_f32 v236, v236, v237
v_cvt_pk_bf16_f32 v237, v238, v239
v_cvt_pk_bf16_f32 v238, v252, v253
v_cvt_pk_bf16_f32 v239, v254, v255
v_accvgpr_read_b32 v176, a64
v_accvgpr_read_b32 v177, a65
v_accvgpr_read_b32 v178, a66
v_accvgpr_read_b32 v179, a67
v_accvgpr_read_b32 v180, a80
v_accvgpr_read_b32 v181, a81
v_accvgpr_read_b32 v182, a82
v_accvgpr_read_b32 v183, a83
v_pk_mul_f32 v[176:177], v[176:177], v[8:9] op_sel:[0,0] op_sel_hi:[1,0]
v_pk_mul_f32 v[178:179], v[178:179], v[8:9] op_sel:[0,0] op_sel_hi:[1,0]
v_pk_mul_f32 v[180:181], v[180:181], v[8:9] op_sel:[0,0] op_sel_hi:[1,0]
v_pk_mul_f32 v[182:183], v[182:183], v[8:9] op_sel:[0,0] op_sel_hi:[1,0]
v_cvt_pk_bf16_f32 v176, v176, v177
v_cvt_pk_bf16_f32 v177, v178, v179
v_cvt_pk_bf16_f32 v178, v180, v181
v_cvt_pk_bf16_f32 v179, v182, v183
v_accvgpr_read_b32 v184, a68
v_accvgpr_read_b32 v185, a69
v_accvgpr_read_b32 v186, a70
v_accvgpr_read_b32 v187, a71
v_accvgpr_read_b32 v188, a84
v_accvgpr_read_b32 v189, a85
v_accvgpr_read_b32 v190, a86
v_accvgpr_read_b32 v191, a87
v_pk_mul_f32 v[184:185], v[184:185], v[8:9] op_sel:[0,1] op_sel_hi:[1,1]
v_pk_mul_f32 v[186:187], v[186:187], v[8:9] op_sel:[0,1] op_sel_hi:[1,1]
v_pk_mul_f32 v[188:189], v[188:189], v[8:9] op_sel:[0,1] op_sel_hi:[1,1]
v_pk_mul_f32 v[190:191], v[190:191], v[8:9] op_sel:[0,1] op_sel_hi:[1,1]
v_cvt_pk_bf16_f32 v184, v184, v185
v_cvt_pk_bf16_f32 v185, v186, v187
v_cvt_pk_bf16_f32 v186, v188, v189
v_cvt_pk_bf16_f32 v187, v190, v191
v_accvgpr_read_b32 v208, a72
v_accvgpr_read_b32 v209, a73
v_accvgpr_read_b32 v210, a74
v_accvgpr_read_b32 v211, a75
v_accvgpr_read_b32 v212, a88
v_accvgpr_read_b32 v213, a89
v_accvgpr_read_b32 v214, a90
v_accvgpr_read_b32 v215, a91
v_pk_mul_f32 v[208:209], v[208:209], v[10:11] op_sel:[0,0] op_sel_hi:[1,0]
v_pk_mul_f32 v[210:211], v[210:211], v[10:11] op_sel:[0,0] op_sel_hi:[1,0]
v_pk_mul_f32 v[212:213], v[212:213], v[10:11] op_sel:[0,0] op_sel_hi:[1,0]
v_pk_mul_f32 v[214:215], v[214:215], v[10:11] op_sel:[0,0] op_sel_hi:[1,0]
v_cvt_pk_bf16_f32 v208, v208, v209
v_cvt_pk_bf16_f32 v209, v210, v211
v_cvt_pk_bf16_f32 v210, v212, v213
v_cvt_pk_bf16_f32 v211, v214, v215
v_accvgpr_read_b32 v216, a76
v_accvgpr_read_b32 v217, a77
v_accvgpr_read_b32 v218, a78
v_accvgpr_read_b32 v219, a79
v_accvgpr_read_b32 v220, a92
v_accvgpr_read_b32 v221, a93
v_accvgpr_read_b32 v222, a94
v_accvgpr_read_b32 v223, a95
v_pk_mul_f32 v[216:217], v[216:217], v[10:11] op_sel:[0,1] op_sel_hi:[1,1]
v_pk_mul_f32 v[218:219], v[218:219], v[10:11] op_sel:[0,1] op_sel_hi:[1,1]
v_pk_mul_f32 v[220:221], v[220:221], v[10:11] op_sel:[0,1] op_sel_hi:[1,1]
v_pk_mul_f32 v[222:223], v[222:223], v[10:11] op_sel:[0,1] op_sel_hi:[1,1]
v_cvt_pk_bf16_f32 v216, v216, v217
v_cvt_pk_bf16_f32 v217, v218, v219
v_cvt_pk_bf16_f32 v218, v220, v221
v_cvt_pk_bf16_f32 v219, v222, v223
s_bitcmp1_b32 s61, 0
s_cbranch_scc0 Lss_2
buffer_store_dwordx4 v[160:163], v1, s[16:19], s36 offen offset:0 sc1
buffer_store_dwordx4 v[164:167], v1, s[16:19], s36 offen offset:2048 sc1
buffer_store_dwordx4 v[168:171], v1, s[16:19], s37 offen offset:0 sc1
buffer_store_dwordx4 v[172:175], v1, s[16:19], s37 offen offset:2048 sc1
Lss_2:
s_bitcmp1_b32 s61, 1
s_cbranch_scc0 Lss_3
buffer_store_dwordx4 v[192:195], v1, s[16:19], s36 offen offset:1024 sc1
buffer_store_dwordx4 v[196:199], v1, s[16:19], s36 offen offset:3072 sc1
buffer_store_dwordx4 v[200:203], v1, s[16:19], s37 offen offset:1024 sc1
buffer_store_dwordx4 v[204:207], v1, s[16:19], s37 offen offset:3072 sc1
Lss_3:
s_bitcmp1_b32 s61, 2
s_cbranch_scc0 Lss_4
buffer_store_dwordx4 v[224:227], v1, s[16:19], s38 offen offset:0 sc1
buffer_store_dwordx4 v[228:231], v1, s[16:19], s38 offen offset:2048 sc1
buffer_store_dwordx4 v[232:235], v1, s[16:19], s39 offen offset:0 sc1
buffer_store_dwordx4 v[236:239], v1, s[16:19], s39 offen offset:2048 sc1
Lss_4:
s_bitcmp1_b32 s61, 3
s_cbranch_scc0 Lss_5
buffer_store_dwordx4 v[176:179], v1, s[16:19], s38 offen offset:1024 sc1
buffer_store_dwordx4 v[184:187], v1, s[16:19], s38 offen offset:3072 sc1
buffer_store_dwordx4 v[208:211], v1, s[16:19], s39 offen offset:1024 sc1
buffer_store_dwordx4 v[216:219], v1, s[16:19], s39 offen offset:3072 sc1
Lss_5:
s_branch Lk2_chk
Lk2_done:
s_lshl_b32 s33, s20, 4
s_add_u32 s33, s33, 16781312
s_sub_u32 s34, 15, s21
s_lshl_b32 s34, s34, 9
s_add_u32 s92, s33, s34
s_lshl_b32 s34, s22, 2
s_add_u32 s92, s92, s34
s_lshl_b32 s34, s21, 9
s_add_u32 s93, s33, s34
s_lshl_b32 s34, s23, 3
s_add_u32 s93, s93, s34
s_cmp_eq_u32 s24, 0
s_cselect_b32 s93, s93, s92
s_cselect_b32 s94, 4, 0
s_add_u32 s94, s94, s93
s_load_dwordx2 s[10:11], s[0:1], 40
s_load_dwordx2 s[14:15], s[0:1], 72
s_lshl_b32 s21, s27, 7
s_lshl_b32 s22, s28, 6
s_lshl_b32 s3, s101, 4
v_lshrrev_b32 v232, 3, v0
v_and_b32 v233, 6, v232
v_and_b32 v234, 7, v0
v_xor_b32 v233, v233, v234
v_add_u32 v232, s3, v232
v_lshlrev_b32 v232, 11, v232
v_lshl_add_u32 v6, v233, 4, v232
v_add_u32 v7, 15360, v6
s_add_u32 m0, s42, 49152
s_nop 0
buffer_load_dwordx4 v6, s[48:51], s26 offen offset:0 lds
buffer_load_dwordx4 v7, s[48:51], s26 offen offset:1024 lds
buffer_load_dwordx4 a[96:99], v1, s[44:47], s25 offen offset:0 sc1
buffer_load_dwordx4 a[100:103], v1, s[44:47], s25 offen offset:1024 sc1
buffer_load_dwordx4 a[104:107], v1, s[44:47], s25 offen offset:2048 sc1
buffer_load_dwordx4 a[108:111], v1, s[44:47], s25 offen offset:3072 sc1
s_add_u32 s25, s25, 16384
s_add_u32 s26, s26, 131072
s_add_u32 m0, s42, 65536
s_nop 0
buffer_load_dwordx4 v6, s[48:51], s26 offen offset:0 lds
buffer_load_dwordx4 v7, s[48:51], s26 offen offset:1024 lds
buffer_load_dwordx4 a[128:131], v1, s[44:47], s25 offen offset:0 sc1
buffer_load_dwordx4 a[132:135], v1, s[44:47], s25 offen offset:1024 sc1
buffer_load_dwordx4 a[136:139], v1, s[44:47], s25 offen offset:2048 sc1
buffer_load_dwordx4 a[140:143], v1, s[44:47], s25 offen offset:3072 sc1
s_add_u32 s25, s25, 16384
s_add_u32 s26, s26, 131072
v_lshrrev_b32 v232, 2, v0
v_and_b32 v234, 1, v0
v_bfe_u32 v237, v0, 1, 1
v_lshlrev_b32 v233, 7, v232
v_lshl_add_u32 v233, v234, 3, v233
v_and_b32 v236, 6, v232
v_add_u32 v235, 0, v237
v_xor_b32 v235, v235, v236
v_lshl_add_u32 v24, v235, 4, v233
v_add_u32 v28, 0x10000, v24
v_add_u32 v235, 2, v237
v_xor_b32 v235, v235, v236
v_lshl_add_u32 v25, v235, 4, v233
v_add_u32 v29, 0x10000, v25
v_add_u32 v235, 4, v237
v_xor_b32 v235, v235, v236
v_lshl_add_u32 v26, v235, 4, v233
v_add_u32 v30, 0x10000, v26
v_add_u32 v235, 6, v237
v_xor_b32 v235, v235, v236
v_lshl_add_u32 v27, v235, 4, v233
v_add_u32 v31, 0x10000, v27
s_waitcnt vmcnt(26)
s_barrier
ds_read_b64_tr_b16 a[32:33], v24 offset:16384
ds_read_b64_tr_b16 a[34:35], v24 offset:18432
ds_read_b64_tr_b16 a[36:37], v24 offset:20480
ds_read_b64_tr_b16 a[38:39], v24 offset:22528
ds_read_b64_tr_b16 a[40:41], v25 offset:16384
ds_read_b64_tr_b16 a[42:43], v25 offset:18432
ds_read_b64_tr_b16 a[44:45], v25 offset:20480
ds_read_b64_tr_b16 a[46:47], v25 offset:22528
ds_read_b64_tr_b16 a[48:49], v26 offset:16384
ds_read_b64_tr_b16 a[50:51], v26 offset:18432
ds_read_b64_tr_b16 a[52:53], v26 offset:20480
ds_read_b64_tr_b16 a[54:55], v26 offset:22528
ds_read_b64_tr_b16 a[56:57], v27 offset:16384
ds_read_b64_tr_b16 a[58:59], v27 offset:18432
ds_read_b64_tr_b16 a[60:61], v27 offset:20480
ds_read_b64_tr_b16 a[62:63], v27 offset:22528
s_and_b32 s40, s2, 3
s_bfe_u32 s36, s2, 0x30003
s_lshl_b32 s29, s36, 8
s_bfe_u32 s3, s2, 0x10002
s_lshl_b32 s3, s3, 2
s_lshr_b32 s37, s2, 6
s_add_u32 s3, s3, s37
s_lshl_b32 s13, s3, 8
s_lshl_b32 s30, s3, 7
s_lshl_b32 s3, s40, 5
s_add_u32 s30, s30, s3
s_lshl_b32 s41, s101, 12
s_lshl_b32 s12, s36, 21
s_lshr_b32 s3, s101, 1
s_lshl_b32 s3, s3, 20
s_add_u32 s12, s12, s3
s_and_b32 s3, s101, 1
s_lshl_b32 s3, s3, 13
s_add_u32 s12, s12, s3
s_lshl_b32 s62, s36, 10
s_lshl_b32 s3, s40, 7
s_add_u32 s62, s62, s3
s_add_u32 s62, s62, 16781312
s_bfe_u32 s3, s2, 0x10002
s_lshl_b32 s3, s3, 3
s_sub_u32 s39, 16, s3
s_lshl_b32 s38, s40, 4
s_add_u32 s3, s3, s38
s_lshl_b32 s3, s3, 14
s_add_u32 s12, s12, s3
s_lshl_b32 s3, s3, 3
s_add_u32 s13, s13, s3
s_mov_b32 s64, 4294721536
s_mov_b32 s65, 16384
s_add_u32 s8, s4, 67108864
s_addc_u32 s9, s5, 0
s_lshl_b32 s56, s2, 16
s_lshl_b32 s38, s101, 14
s_add_u32 s56, s56, s38
s_lshl_b32 s58, s2, 4
s_lshl_b32 s38, s101, 2
s_add_u32 s58, s58, s38
s_add_u32 s58, s58, 16777216
s_and_b32 s59, s58, 0xffffffcf
s_mov_b32 s61, 0
s_lshl_b32 s3, s101, 4
v_lshrrev_b32 v240, 4, v0
v_and_b32 v242, 15, v0
v_add_u32 v241, 0, v240
v_lshlrev_b32 v241, 1, v241
v_xor_b32 v241, v241, v242
v_add_u32 v243, s3, v240
v_lshlrev_b32 v243, 11, v243
v_lshl_add_u32 v243, v241, 4, v243
v_add_u32 v2, 0, v243
v_add_u32 v241, 4, v240
v_lshlrev_b32 v241, 1, v241
v_xor_b32 v241, v241, v242
v_add_u32 v243, s3, v240
v_lshlrev_b32 v243, 11, v243
v_lshl_add_u32 v243, v241, 4, v243
v_add_u32 v3, 7168, v243
v_add_u32 v241, 0, v240
v_lshlrev_b32 v241, 1, v241
v_xor_b32 v241, v241, v242
v_add_u32 v243, s3, v240
v_lshlrev_b32 v243, 11, v243
v_lshl_add_u32 v243, v241, 4, v243
v_add_u32 v4, 14336, v243
v_add_u32 v241, 4, v240
v_lshlrev_b32 v241, 1, v241
v_xor_b32 v241, v241, v242
v_add_u32 v243, s3, v240
v_lshlrev_b32 v243, 11, v243
v_lshl_add_u32 v243, v241, 4, v243
v_add_u32 v5, 21504, v243
v_lshlrev_b32 v233, 8, v232
v_lshl_add_u32 v233, v234, 3, v233
v_and_b32 v236, 7, v232
v_lshlrev_b32 v236, 1, v236
s_lshl_b32 s38, s40, 2
v_xor_b32 v236, s38, v236
v_add_u32 v235, 0, v237
v_xor_b32 v235, v235, v236
v_lshl_add_u32 v8, v235, 4, v233
v_add_u32 v16, 0x10000, v8
v_add_u32 v235, 2, v237
v_xor_b32 v235, v235, v236
v_lshl_add_u32 v9, v235, 4, v233
v_add_u32 v17, 0x10000, v9
v_add_u32 v235, 4, v237
v_xor_b32 v235, v235, v236
v_lshl_add_u32 v10, v235, 4, v233
v_add_u32 v18, 0x10000, v10
v_add_u32 v235, 6, v237
v_xor_b32 v235, v235, v236
v_lshl_add_u32 v11, v235, 4, v233
v_add_u32 v19, 0x10000, v11
v_add_u32 v235, 8, v237
v_xor_b32 v235, v235, v236
v_lshl_add_u32 v12, v235, 4, v233
v_add_u32 v20, 0x10000, v12
v_add_u32 v235, 10, v237
v_xor_b32 v235, v235, v236
v_lshl_add_u32 v13, v235, 4, v233
v_add_u32 v21, 0x10000, v13
v_add_u32 v235, 12, v237
v_xor_b32 v235, v235, v236
v_lshl_add_u32 v14, v235, 4, v233
v_add_u32 v22, 0x10000, v14
v_add_u32 v235, 14, v237
v_xor_b32 v235, v235, v236
v_lshl_add_u32 v15, v235, 4, v233
v_add_u32 v23, 0x10000, v15
v_mov_b32 v253, 0
v_mov_b32 v254, 1
v_and_b32 v255, 31, v0
v_lshlrev_b32 v255, 2, v255
v_lshrrev_b32 v252, 5, v0
v_lshl_add_u32 v255, v252, 9, v255
s_waitcnt lgkmcnt(0)
s_mov_b32 s16, s14
s_mov_b32 s17, s15
s_mov_b32 s18, 8388608
s_mov_b32 s19, 0x00020000
s_waitcnt vmcnt(20) lgkmcnt(0)
s_barrier
s_waitcnt vmcnt(12)
s_mov_b64 exec, 1
buffer_store_dword v254, v253, s[52:55], s92 offen sc1
buffer_store_dword v254, v253, s[52:55], s93 offen sc1
buffer_store_dword v254, v253, s[52:55], s94 offen sc1
s_mov_b64 exec, -1
M a[0:3], a[32:35], a[192:195], 0
s_add_u32 m0, s42, 81920
s_nop 0
buffer_load_dwordx4 v6, s[48:51], s26 offen offset:0 lds
ds_read_b64_tr_b16 v[160:161], v24 offset:32768
ds_read_b64_tr_b16 v[162:163], v24 offset:34816
M a[0:3], a[36:39], a[196:199], a[0:3]
buffer_load_dwordx4 v7, s[48:51], s26 offen offset:1024 lds
M a[4:7], a[44:47], a[196:199], 0
ds_read_b64_tr_b16 v[164:165], v24 offset:36864
ds_read_b64_tr_b16 v[166:167], v24 offset:38912
M a[4:7], a[40:43], a[192:195], a[4:7]
buffer_load_dwordx4 a[160:163], v1, s[44:47], s25 offen offset:0 sc1
M a[8:11], a[48:51], a[192:195], 0
ds_read_b64_tr_b16 v[168:169], v25 offset:32768
ds_read_b64_tr_b16 v[170:171], v25 offset:34816
M a[8:11], a[52:55], a[196:199], a[8:11]
buffer_load_dwordx4 a[164:167], v1, s[44:47], s25 offen offset:1024 sc1
M a[12:15], a[60:63], a[196:199], 0
ds_read_b64_tr_b16 v[172:173], v25 offset:36864
ds_read_b64_tr_b16 v[174:175], v25 offset:38912
M a[12:15], a[56:59], a[192:195], a[12:15]
buffer_load_dwordx4 a[168:171], v1, s[44:47], s25 offen offset:2048 sc1
M a[16:19], a[32:35], a[200:203], 0
ds_read_b64_tr_b16 v[176:177], v26 offset:32768
ds_read_b64_tr_b16 v[178:179], v26 offset:34816
M a[16:19], a[36:39], a[204:207], a[16:19]
buffer_load_dwordx4 a[172:175], v1, s[44:47], s25 offen offset:3072 sc1
M a[20:23], a[44:47], a[204:207], 0
ds_read_b64_tr_b16 v[180:181], v26 offset:36864
ds_read_b64_tr_b16 v[182:183], v26 offset:38912
M a[20:23], a[40:43], a[200:203], a[20:23]
s_add_u32 s25, s25, 16384
s_add_u32 s26, s26, 131072
M a[24:27], a[48:51], a[200:203], 0
ds_read_b64_tr_b16 v[184:185], v27 offset:32768
ds_read_b64_tr_b16 v[186:187], v27 offset:34816
M a[24:27], a[52:55], a[204:207], a[24:27]
ds_read_b64_tr_b16 v[188:189], v27 offset:36864
ds_read_b64_tr_b16 v[190:191], v27 offset:38912
M a[28:31], a[60:63], a[204:207], 0
M a[28:31], a[56:59], a[200:203], a[28:31]
s_waitcnt vmcnt(15) lgkmcnt(0)
s_barrier
M a[0:3], v[160:163], a[224:227], a[0:3]
s_add_u32 m0, s42, 98304
s_nop 0
buffer_load_dwordx4 v6, s[48:51], s26 offen offset:0 lds
ds_read_b64_tr_b16 a[32:33], v24 offset:49152
ds_read_b64_tr_b16 a[34:35], v24 offset:51200
M a[0:3], v[164:167], a[228:231], a[0:3]
buffer_load_dwordx4 v7, s[48:51], s26 offen offset:1024 lds
M a[4:7], v[172:175], a[228:231], a[4:7]
ds_read_b64_tr_b16 a[36:37], v24 offset:53248
ds_read_b64_tr_b16 a[38:39], v24 offset:55296
M a[4:7], v[168:171], a[224:227], a[4:7]
buffer_load_dwordx4 a[192:195], v1, s[44:47], s25 offen offset:0 sc1
M a[8:11], v[176:179], a[224:227], a[8:11]
ds_read_b64_tr_b16 a[40:41], v25 offset:49152
ds_read_b64_tr_b16 a[42:43], v25 offset:51200
M a[8:11], v[180:183], a[228:231], a[8:11]
buffer_load_dwordx4 a[196:199], v1, s[44:47], s25 offen offset:1024 sc1
M a[12:15], v[188:191], a[228:231], a[12:15]
ds_read_b64_tr_b16 a[44:45], v25 offset:53248
ds_read_b64_tr_b16 a[46:47], v25 offset:55296
M a[12:15], v[184:187], a[224:227], a[12:15]
buffer_load_dwordx4 a[200:203], v1, s[44:47], s25 offen offset:2048 sc1
M a[16:19], v[160:163], a[232:235], a[16:19]
ds_read_b64_tr_b16 a[48:49], v26 offset:49152
ds_read_b64_tr_b16 a[50:51], v26 offset:51200
M a[16:19], v[164:167], a[236:239], a[16:19]
buffer_load_dwordx4 a[204:207], v1, s[44:47], s25 offen offset:3072 sc1
M a[20:23], v[172:175], a[236:239], a[20:23]
ds_read_b64_tr_b16 a[52:53], v26 offset:53248
ds_read_b64_tr_b16 a[54:55], v26 offset:55296
M a[20:23], v[168:171], a[232:235], a[20:23]
s_add_u32 s25, s25, 16384
s_add_u32 s26, s26, 131072
M a[24:27], v[176:179], a[232:235], a[24:27]
ds_read_b64_tr_b16 a[56:57], v27 offset:49152
ds_read_b64_tr_b16 a[58:59], v27 offset:51200
M a[24:27], v[180:183], a[236:239], a[24:27]
ds_read_b64_tr_b16 a[60:61], v27 offset:53248
ds_read_b64_tr_b16 a[62:63], v27 offset:55296
M a[28:31], v[188:191], a[236:239], a[28:31]
M a[28:31], v[184:187], a[232:235], a[28:31]
s_waitcnt vmcnt(15) lgkmcnt(0)
s_barrier
M a[0:3], a[32:35], a[96:99], a[0:3]
s_add_u32 m0, s42, 114688
s_nop 0
buffer_load_dwordx4 v6, s[48:51], s26 offen offset:0 lds
ds_read_b64_tr_b16 v[160:161], v28 offset:0
ds_read_b64_tr_b16 v[162:163], v28 offset:2048
M a[0:3], a[36:39], a[100:103], a[0:3]
buffer_load_dwordx4 v7, s[48:51], s26 offen offset:1024 lds
M a[4:7], a[44:47], a[100:103], a[4:7]
ds_read_b64_tr_b16 v[164:165], v28 offset:4096
ds_read_b64_tr_b16 v[166:167], v28 offset:6144
M a[4:7], a[40:43], a[96:99], a[4:7]
buffer_load_dwordx4 a[224:227], v1, s[44:47], s25 offen offset:0 sc1
M a[8:11], a[48:51], a[96:99], a[8:11]
ds_read_b64_tr_b16 v[168:169], v29 offset:0
ds_read_b64_tr_b16 v[170:171], v29 offset:2048
M a[8:11], a[52:55], a[100:103], a[8:11]
buffer_load_dwordx4 a[228:231], v1, s[44:47], s25 offen offset:1024 sc1
M a[12:15], a[60:63], a[100:103], a[12:15]
ds_read_b64_tr_b16 v[172:173], v29 offset:4096
ds_read_b64_tr_b16 v[174:175], v29 offset:6144
M a[12:15], a[56:59], a[96:99], a[12:15]
buffer_load_dwordx4 a[232:235], v1, s[44:47], s25 offen offset:2048 sc1
ds_read_b64_tr_b16 v[176:177], v30 offset:0
ds_read_b64_tr_b16 v[178:179], v30 offset:2048
M a[16:19], a[32:35], a[104:107], a[16:19]
buffer_load_dwordx4 a[236:239], v1, s[44:47], s25 offen offset:3072 sc1
M a[16:19], a[36:39], a[108:111], a[16:19]
ds_read_b64_tr_b16 v[180:181], v30 offset:4096
ds_read_b64_tr_b16 v[182:183], v30 offset:6144
M a[20:23], a[44:47], a[108:111], a[20:23]
s_add_u32 s25, s25, 16384
s_add_u32 s26, s26, 131072
M a[20:23], a[40:43], a[104:107], a[20:23]
ds_read_b64_tr_b16 v[184:185], v31 offset:0
ds_read_b64_tr_b16 v[186:187], v31 offset:2048
M a[24:27], a[48:51], a[104:107], a[24:27]
buffer_load_dword v252, v255, s[52:55], s62 offen sc1
M a[24:27], a[52:55], a[108:111], a[24:27]
ds_read_b64_tr_b16 v[188:189], v31 offset:4096
ds_read_b64_tr_b16 v[190:191], v31 offset:6144
M a[28:31], a[60:63], a[108:111], a[28:31]
M a[28:31], a[56:59], a[104:107], a[28:31]
s_waitcnt vmcnt(13) lgkmcnt(0)
s_barrier
s_waitcnt vmcnt(0)
v_cmp_ne_u32 vcc, 1, v252
s_nop 0
s_cbranch_vccnz Lk3_spinft
Lk3_gotft:
M a[0:3], v[160:163], a[128:131], a[0:3]
s_mov_b32 s32, s25
s_mov_b32 s33, s26
s_mov_b64 s[34:35], s[44:45]
s_mov_b64 s[36:37], s[48:49]
s_mov_b64 s[44:45], s[8:9]
s_mov_b32 s46, 16777216
s_mov_b64 s[48:49], s[10:11]
s_mov_b32 s50, 8388608
s_mov_b32 s25, s12
s_mov_b32 s26, s13
s_add_u32 m0, s41, 0
s_nop 0
buffer_load_dwordx4 v2, s[48:51], s26 offen offset:0 lds
ds_read_b64_tr_b16 a[32:33], v28 offset:16384
ds_read_b64_tr_b16 a[34:35], v28 offset:18432
M a[0:3], v[164:167], a[132:135], a[0:3]
buffer_load_dwordx4 v3, s[48:51], s26 offen offset:1024 lds
ds_read_b64_tr_b16 a[36:37], v28 offset:20480
ds_read_b64_tr_b16 a[38:39], v28 offset:22528
M a[4:7], v[172:175], a[132:135], a[4:7]
buffer_load_dwordx4 v4, s[48:51], s26 offen offset:2048 lds
M a[4:7], v[168:171], a[128:131], a[4:7]
ds_read_b64_tr_b16 a[40:41], v29 offset:16384
ds_read_b64_tr_b16 a[42:43], v29 offset:18432
buffer_load_dwordx4 v5, s[48:51], s26 offen offset:3072 lds
M a[8:11], v[176:179], a[128:131], a[8:11]
ds_read_b64_tr_b16 a[44:45], v29 offset:20480
ds_read_b64_tr_b16 a[46:47], v29 offset:22528
M a[8:11], v[180:183], a[132:135], a[8:11]
buffer_load_dwordx4 a[96:99], v1, s[44:47], s25 offen offset:0 sc1
ds_read_b64_tr_b16 a[48:49], v30 offset:16384
ds_read_b64_tr_b16 a[50:51], v30 offset:18432
M a[12:15], v[188:191], a[132:135], a[12:15]
buffer_load_dwordx4 a[100:103], v1, s[44:47], s25 offen offset:1024 sc1
M a[12:15], v[184:187], a[128:131], a[12:15]
ds_read_b64_tr_b16 a[52:53], v30 offset:20480
ds_read_b64_tr_b16 a[54:55], v30 offset:22528
buffer_load_dwordx4 a[104:107], v1, s[44:47], s25 offen offset:2048 sc1
M a[16:19], v[160:163], a[136:139], a[16:19]
ds_read_b64_tr_b16 a[56:57], v31 offset:16384
ds_read_b64_tr_b16 a[58:59], v31 offset:18432
buffer_load_dwordx4 a[108:111], v1, s[44:47], s25 offen offset:3072 sc1
M a[16:19], v[164:167], a[140:143], a[16:19]
ds_read_b64_tr_b16 a[60:61], v31 offset:20480
ds_read_b64_tr_b16 a[62:63], v31 offset:22528
M a[20:23], v[172:175], a[140:143], a[20:23]
s_add_u32 s63, s25, 4096
buffer_load_dwordx4 a[112:115], v1, s[44:47], s63 offen offset:0 sc1
buffer_load_dwordx4 a[116:119], v1, s[44:47], s63 offen offset:1024 sc1
M a[20:23], v[168:171], a[136:139], a[20:23]
buffer_load_dwordx4 a[120:123], v1, s[44:47], s63 offen offset:2048 sc1
M a[24:27], v[176:179], a[136:139], a[24:27]
buffer_load_dwordx4 a[124:127], v1, s[44:47], s63 offen offset:3072 sc1
s_sub_u32 s39, s39, 1
s_cmp_eq_u32 s39, 0
s_cselect_b32 s3, s64, s65
M a[24:27], v[180:183], a[140:143], a[24:27]
s_add_u32 s25, s25, s3
s_lshl_b32 s3, s3, 3
s_add_u32 s26, s26, s3
M a[28:31], v[188:191], a[140:143], a[28:31]
M a[28:31], v[184:187], a[136:139], a[28:31]
s_waitcnt vmcnt(19) lgkmcnt(0)
s_barrier
M a[0:3], a[32:35], a[160:163], a[0:3]
s_add_u32 m0, s41, 16384
s_nop 0
buffer_load_dwordx4 v2, s[48:51], s26 offen offset:0 lds
ds_read_b64_tr_b16 v[160:161], v28 offset:32768
ds_read_b64_tr_b16 v[162:163], v28 offset:34816
M a[0:3], a[36:39], a[164:167], a[0:3]
buffer_load_dwordx4 v3, s[48:51], s26 offen offset:1024 lds
ds_read_b64_tr_b16 v[164:165], v28 offset:36864
ds_read_b64_tr_b16 v[166:167], v28 offset:38912
M a[4:7], a[44:47], a[164:167], a[4:7]
buffer_load_dwordx4 v4, s[48:51], s26 offen offset:2048 lds
M a[4:7], a[40:43], a[160:163], a[4:7]
ds_read_b64_tr_b16 v[168:169], v29 offset:32768
ds_read_b64_tr_b16 v[170:171], v29 offset:34816
buffer_load_dwordx4 v5, s[48:51], s26 offen offset:3072 lds
M a[8:11], a[48:51], a[160:163], a[8:11]
ds_read_b64_tr_b16 v[172:173], v29 offset:36864
ds_read_b64_tr_b16 v[174:175], v29 offset:38912
M a[8:11], a[52:55], a[164:167], a[8:11]
buffer_load_dwordx4 a[128:131], v1, s[44:47], s25 offen offset:0 sc1
ds_read_b64_tr_b16 v[176:177], v30 offset:32768
ds_read_b64_tr_b16 v[178:179], v30 offset:34816
M a[12:15], a[60:63], a[164:167], a[12:15]
buffer_load_dwordx4 a[132:135], v1, s[44:47], s25 offen offset:1024 sc1
M a[12:15], a[56:59], a[160:163], a[12:15]
ds_read_b64_tr_b16 v[180:181], v30 offset:36864
ds_read_b64_tr_b16 v[182:183], v30 offset:38912
buffer_load_dwordx4 a[136:139], v1, s[44:47], s25 offen offset:2048 sc1
M a[16:19], a[32:35], a[168:171], a[16:19]
ds_read_b64_tr_b16 v[184:185], v31 offset:32768
ds_read_b64_tr_b16 v[186:187], v31 offset:34816
buffer_load_dwordx4 a[140:143], v1, s[44:47], s25 offen offset:3072 sc1
M a[16:19], a[36:39], a[172:175], a[16:19]
ds_read_b64_tr_b16 v[188:189], v31 offset:36864
ds_read_b64_tr_b16 v[190:191], v31 offset:38912
M a[20:23], a[44:47], a[172:175], a[20:23]
s_add_u32 s63, s25, 4096
buffer_load_dwordx4 a[144:147], v1, s[44:47], s63 offen offset:0 sc1
buffer_load_dwordx4 a[148:151], v1, s[44:47], s63 offen offset:1024 sc1
M a[20:23], a[40:43], a[168:171], a[20:23]
buffer_load_dwordx4 a[152:155], v1, s[44:47], s63 offen offset:2048 sc1
M a[24:27], a[48:51], a[168:171], a[24:27]
buffer_load_dwordx4 a[156:159], v1, s[44:47], s63 offen offset:3072 sc1
s_sub_u32 s39, s39, 1
s_cmp_eq_u32 s39, 0
s_cselect_b32 s3, s64, s65
M a[24:27], a[52:55], a[172:175], a[24:27]
s_add_u32 s25, s25, s3
s_lshl_b32 s3, s3, 3
s_add_u32 s26, s26, s3
M a[28:31], a[60:63], a[172:175], a[28:31]
M a[28:31], a[56:59], a[168:171], a[28:31]
s_waitcnt vmcnt(25) lgkmcnt(0)
s_barrier
M a[0:3], v[160:163], a[192:195], a[0:3]
s_add_u32 m0, s41, 32768
s_nop 0
buffer_load_dwordx4 v2, s[48:51], s26 offen offset:0 lds
ds_read_b64_tr_b16 a[32:33], v28 offset:49152
ds_read_b64_tr_b16 a[34:35], v28 offset:51200
M a[0:3], v[164:167], a[196:199], a[0:3]
buffer_load_dwordx4 v3, s[48:51], s26 offen offset:1024 lds
ds_read_b64_tr_b16 a[36:37], v28 offset:53248
ds_read_b64_tr_b16 a[38:39], v28 offset:55296
M a[4:7], v[172:175], a[196:199], a[4:7]
buffer_load_dwordx4 v4, s[48:51], s26 offen offset:2048 lds
M a[4:7], v[168:171], a[192:195], a[4:7]
ds_read_b64_tr_b16 a[40:41], v29 offset:49152
ds_read_b64_tr_b16 a[42:43], v29 offset:51200
buffer_load_dwordx4 v5, s[48:51], s26 offen offset:3072 lds
M a[8:11], v[176:179], a[192:195], a[8:11]
ds_read_b64_tr_b16 a[44:45], v29 offset:53248
ds_read_b64_tr_b16 a[46:47], v29 offset:55296
M a[8:11], v[180:183], a[196:199], a[8:11]
buffer_load_dwordx4 a[160:163], v1, s[44:47], s25 offen offset:0 sc1
ds_read_b64_tr_b16 a[48:49], v30 offset:49152
ds_read_b64_tr_b16 a[50:51], v30 offset:51200
M a[12:15], v[188:191], a[196:199], a[12:15]
buffer_load_dwordx4 a[164:167], v1, s[44:47], s25 offen offset:1024 sc1
M a[12:15], v[184:187], a[192:195], a[12:15]
ds_read_b64_tr_b16 a[52:53], v30 offset:53248
ds_read_b64_tr_b16 a[54:55], v30 offset:55296
buffer_load_dwordx4 a[168:171], v1, s[44:47], s25 offen offset:2048 sc1
M a[16:19], v[160:163], a[200:203], a[16:19]
ds_read_b64_tr_b16 a[56:57], v31 offset:49152
ds_read_b64_tr_b16 a[58:59], v31 offset:51200
buffer_load_dwordx4 a[172:175], v1, s[44:47], s25 offen offset:3072 sc1
M a[16:19], v[164:167], a[204:207], a[16:19]
ds_read_b64_tr_b16 a[60:61], v31 offset:53248
ds_read_b64_tr_b16 a[62:63], v31 offset:55296
M a[20:23], v[172:175], a[204:207], a[20:23]
s_add_u32 s63, s25, 4096
buffer_load_dwordx4 a[176:179], v1, s[44:47], s63 offen offset:0 sc1
buffer_load_dwordx4 a[180:183], v1, s[44:47], s63 offen offset:1024 sc1
M a[20:23], v[168:171], a[200:203], a[20:23]
buffer_load_dwordx4 a[184:187], v1, s[44:47], s63 offen offset:2048 sc1
M a[24:27], v[176:179], a[200:203], a[24:27]
buffer_load_dwordx4 a[188:191], v1, s[44:47], s63 offen offset:3072 sc1
s_sub_u32 s39, s39, 1
s_cmp_eq_u32 s39, 0
s_cselect_b32 s3, s64, s65
M a[24:27], v[180:183], a[204:207], a[24:27]
s_add_u32 s25, s25, s3
s_lshl_b32 s3, s3, 3
s_add_u32 s26, s26, s3
M a[28:31], v[188:191], a[204:207], a[28:31]
M a[28:31], v[184:187], a[200:203], a[28:31]
s_waitcnt vmcnt(24) lgkmcnt(0)
s_barrier
M a[0:3], a[32:35], a[224:227], a[0:3]
s_add_u32 m0, s41, 49152
s_nop 0
buffer_load_dwordx4 v2, s[48:51], s26 offen offset:0 lds
ds_read_b64_tr_b16 v[160:161], v8 offset:0
ds_read_b64_tr_b16 v[162:163], v8 offset:4096
buffer_load_dwordx4 v3, s[48:51], s26 offen offset:1024 lds
M a[0:3], a[36:39], a[228:231], a[0:3]
ds_read_b64_tr_b16 v[164:165], v8 offset:8192
ds_read_b64_tr_b16 v[166:167], v8 offset:12288
buffer_load_dwordx4 v4, s[48:51], s26 offen offset:2048 lds
M a[4:7], a[44:47], a[228:231], a[4:7]
ds_read_b64_tr_b16 v[168:169], v9 offset:0
ds_read_b64_tr_b16 v[170:171], v9 offset:4096
buffer_load_dwordx4 v5, s[48:51], s26 offen offset:3072 lds
M a[4:7], a[40:43], a[224:227], a[4:7]
ds_read_b64_tr_b16 v[172:173], v9 offset:8192
ds_read_b64_tr_b16 v[174:175], v9 offset:12288
buffer_load_dwordx4 a[192:195], v1, s[44:47], s25 offen offset:0 sc1
M a[8:11], a[48:51], a[224:227], a[8:11]
ds_read_b64_tr_b16 v[176:177], v10 offset:0
ds_read_b64_tr_b16 v[178:179], v10 offset:4096
buffer_load_dwordx4 a[196:199], v1, s[44:47], s25 offen offset:1024 sc1
M a[8:11], a[52:55], a[228:231], a[8:11]
ds_read_b64_tr_b16 v[180:181], v10 offset:8192
ds_read_b64_tr_b16 v[182:183], v10 offset:12288
buffer_load_dwordx4 a[200:203], v1, s[44:47], s25 offen offset:2048 sc1
M a[12:15], a[60:63], a[228:231], a[12:15]
ds_read_b64_tr_b16 v[184:185], v11 offset:0
ds_read_b64_tr_b16 v[186:187], v11 offset:4096
buffer_load_dwordx4 a[204:207], v1, s[44:47], s25 offen offset:3072 sc1
M a[12:15], a[56:59], a[224:227], a[12:15]
ds_read_b64_tr_b16 v[188:189], v11 offset:8192
ds_read_b64_tr_b16 v[190:191], v11 offset:12288
s_add_u32 s63, s25, 4096
buffer_load_dwordx4 a[208:211], v1, s[44:47], s63 offen offset:0 sc1
ds_read_b64_tr_b16 v[192:193], v12 offset:0
ds_read_b64_tr_b16 v[194:195], v12 offset:4096
M a[16:19], a[32:35], a[232:235], a[16:19]
buffer_load_dwordx4 a[212:215], v1, s[44:47], s63 offen offset:1024 sc1
ds_read_b64_tr_b16 v[196:197], v12 offset:8192
ds_read_b64_tr_b16 v[198:199], v12 offset:12288
M a[16:19], a[36:39], a[236:239], a[16:19]
buffer_load_dwordx4 a[216:219], v1, s[44:47], s63 offen offset:2048 sc1
ds_read_b64_tr_b16 v[200:201], v13 offset:0
ds_read_b64_tr_b16 v[202:203], v13 offset:4096
M a[20:23], a[44:47], a[236:239], a[20:23]
buffer_load_dwordx4 a[220:223], v1, s[44:47], s63 offen offset:3072 sc1
ds_read_b64_tr_b16 v[204:205], v13 offset:8192
ds_read_b64_tr_b16 v[206:207], v13 offset:12288
M a[20:23], a[40:43], a[232:235], a[20:23]
s_sub_u32 s39, s39, 1
s_cmp_eq_u32 s39, 0
s_cselect_b32 s3, s64, s65
ds_read_b64_tr_b16 v[208:209], v14 offset:0
ds_read_b64_tr_b16 v[210:211], v14 offset:4096
M a[24:27], a[48:51], a[232:235], a[24:27]
s_add_u32 s25, s25, s3
s_lshl_b32 s3, s3, 3
s_add_u32 s26, s26, s3
ds_read_b64_tr_b16 v[212:213], v14 offset:8192
ds_read_b64_tr_b16 v[214:215], v14 offset:12288
M a[24:27], a[52:55], a[236:239], a[24:27]
ds_read_b64_tr_b16 v[216:217], v15 offset:0
ds_read_b64_tr_b16 v[218:219], v15 offset:4096
ds_read_b64_tr_b16 v[220:221], v15 offset:8192
ds_read_b64_tr_b16 v[222:223], v15 offset:12288
M a[28:31], a[60:63], a[236:239], a[28:31]
M a[28:31], a[56:59], a[232:235], a[28:31]
s_waitcnt vmcnt(24) lgkmcnt(0)
s_barrier
M v[32:35], v[160:163], a[96:99], 0
s_add_u32 m0, s41, 65536
s_nop 0
buffer_load_dwordx4 v2, s[48:51], s26 offen offset:0 lds
M v[32:35], v[164:167], a[100:103], v[32:35]
M v[36:39], v[172:175], a[100:103], 0
ds_read_b64_tr_b16 a[32:33], v8 offset:16384
ds_read_b64_tr_b16 a[34:35], v8 offset:20480
M v[36:39], v[168:171], a[96:99], v[36:39]
M v[40:43], v[176:179], a[96:99], 0
buffer_load_dwordx4 v3, s[48:51], s26 offen offset:1024 lds
M v[40:43], v[180:183], a[100:103], v[40:43]
M v[44:47], v[188:191], a[100:103], 0
ds_read_b64_tr_b16 a[36:37], v8 offset:24576
ds_read_b64_tr_b16 a[38:39], v8 offset:28672
M v[44:47], v[184:187], a[96:99], v[44:47]
M v[48:51], v[192:195], a[96:99], 0
buffer_load_dwordx4 v4, s[48:51], s26 offen offset:2048 lds
M v[48:51], v[196:199], a[100:103], v[48:51]
M v[52:55], v[204:207], a[100:103], 0
ds_read_b64_tr_b16 a[40:41], v9 offset:16384
ds_read_b64_tr_b16 a[42:43], v9 offset:20480
M v[52:55], v[200:203], a[96:99], v[52:55]
M v[56:59], v[208:211], a[96:99], 0
buffer_load_dwordx4 v5, s[48:51], s26 offen offset:3072 lds
M v[56:59], v[212:215], a[100:103], v[56:59]
M v[60:63], v[220:223], a[100:103], 0
ds_read_b64_tr_b16 a[44:45], v9 offset:24576
ds_read_b64_tr_b16 a[46:47], v9 offset:28672
M v[60:63], v[216:219], a[96:99], v[60:63]
M v[64:67], v[160:163], a[104:107], 0
buffer_load_dwordx4 a[224:227], v1, s[44:47], s25 offen offset:0 sc1
M v[64:67], v[164:167], a[108:111], v[64:67]
M v[68:71], v[172:175], a[108:111], 0
ds_read_b64_tr_b16 a[48:49], v10 offset:16384
ds_read_b64_tr_b16 a[50:51], v10 offset:20480
M v[68:71], v[168:171], a[104:107], v[68:71]
M v[72:75], v[176:179], a[104:107], 0
buffer_load_dwordx4 a[228:231], v1, s[44:47], s25 offen offset:1024 sc1
M v[72:75], v[180:183], a[108:111], v[72:75]
M v[76:79], v[188:191], a[108:111], 0
ds_read_b64_tr_b16 a[52:53], v10 offset:24576
ds_read_b64_tr_b16 a[54:55], v10 offset:28672
M v[76:79], v[184:187], a[104:107], v[76:79]
M v[80:83], v[192:195], a[104:107], 0
buffer_load_dwordx4 a[232:235], v1, s[44:47], s25 offen offset:2048 sc1
M v[80:83], v[196:199], a[108:111], v[80:83]
M v[84:87], v[204:207], a[108:111], 0
ds_read_b64_tr_b16 a[56:57], v11 offset:16384
ds_read_b64_tr_b16 a[58:59], v11 offset:20480
M v[84:87], v[200:203], a[104:107], v[84:87]
M v[88:91], v[208:211], a[104:107], 0
buffer_load_dwordx4 a[236:239], v1, s[44:47], s25 offen offset:3072 sc1
M v[88:91], v[212:215], a[108:111], v[88:91]
M v[92:95], v[220:223], a[108:111], 0
M v[92:95], v[216:219], a[104:107], v[92:95]
ds_read_b64_tr_b16 a[60:61], v11 offset:24576
ds_read_b64_tr_b16 a[62:63], v11 offset:28672
M v[96:99], v[160:163], a[112:115], 0
M v[96:99], v[164:167], a[116:119], v[96:99]
s_add_u32 s63, s25, 4096
buffer_load_dwordx4 a[240:243], v1, s[44:47], s63 offen offset:0 sc1
M v[100:103], v[172:175], a[116:119], 0
M v[100:103], v[168:171], a[112:115], v[100:103]
ds_read_b64_tr_b16 a[64:65], v12 offset:16384
ds_read_b64_tr_b16 a[66:67], v12 offset:20480
M v[104:107], v[176:179], a[112:115], 0
M v[104:107], v[180:183], a[116:119], v[104:107]
buffer_load_dwordx4 a[244:247], v1, s[44:47], s63 offen offset:1024 sc1
M v[108:111], v[188:191], a[116:119], 0
M v[108:111], v[184:187], a[112:115], v[108:111]
ds_read_b64_tr_b16 a[68:69], v12 offset:24576
ds_read_b64_tr_b16 a[70:71], v12 offset:28672
M v[112:115], v[192:195], a[112:115], 0
M v[112:115], v[196:199], a[116:119], v[112:115]
buffer_load_dwordx4 a[248:251], v1, s[44:47], s63 offen offset:2048 sc1
M v[116:119], v[204:207], a[116:119], 0
M v[116:119], v[200:203], a[112:115], v[116:119]
ds_read_b64_tr_b16 a[72:73], v13 offset:16384
ds_read_b64_tr_b16 a[74:75], v13 offset:20480
M v[120:123], v[208:211], a[112:115], 0
M v[120:123], v[212:215], a[116:119], v[120:123]
buffer_load_dwordx4 a[252:255], v1, s[44:47], s63 offen offset:3072 sc1
M v[124:127], v[220:223], a[116:119], 0
M v[124:127], v[216:219], a[112:115], v[124:127]
ds_read_b64_tr_b16 a[76:77], v13 offset:24576
ds_read_b64_tr_b16 a[78:79], v13 offset:28672
M v[128:131], v[160:163], a[120:123], 0
M v[128:131], v[164:167], a[124:127], v[128:131]
s_sub_u32 s39, s39, 1
s_cmp_eq_u32 s39, 0
s_cselect_b32 s3, s64, s65
M v[132:135], v[172:175], a[124:127], 0
M v[132:135], v[168:171], a[120:123], v[132:135]
ds_read_b64_tr_b16 a[80:81], v14 offset:16384
ds_read_b64_tr_b16 a[82:83], v14 offset:20480
M v[136:139], v[176:179], a[120:123], 0
M v[136:139], v[180:183], a[124:127], v[136:139]
s_add_u32 s25, s25, s3
s_lshl_b32 s3, s3, 3
s_add_u32 s26, s26, s3
M v[140:143], v[188:191], a[124:127], 0
M v[140:143], v[184:187], a[120:123], v[140:143]
ds_read_b64_tr_b16 a[84:85], v14 offset:24576
ds_read_b64_tr_b16 a[86:87], v14 offset:28672
M v[144:147], v[192:195], a[120:123], 0
M v[144:147], v[196:199], a[124:127], v[144:147]
ds_read_b64_tr_b16 a[88:89], v15 offset:16384
ds_read_b64_tr_b16 a[90:91], v15 offset:20480
M v[148:151], v[204:207], a[124:127], 0
M v[148:151], v[200:203], a[120:123], v[148:151]
ds_read_b64_tr_b16 a[92:93], v15 offset:24576
ds_read_b64_tr_b16 a[94:95], v15 offset:28672
M v[152:155], v[208:211], a[120:123], 0
M v[152:155], v[212:215], a[124:127], v[152:155]
M v[156:159], v[220:223], a[124:127], 0
M v[156:159], v[216:219], a[120:123], v[156:159]
s_waitcnt vmcnt(24) lgkmcnt(0)
s_barrier
M v[32:35], a[32:35], a[128:131], v[32:35]
s_add_u32 m0, s41, 81920
s_nop 0
buffer_load_dwordx4 v2, s[48:51], s26 offen offset:0 lds
M v[32:35], a[36:39], a[132:135], v[32:35]
M v[36:39], a[44:47], a[132:135], v[36:39]
ds_read_b64_tr_b16 v[160:161], v8 offset:32768
ds_read_b64_tr_b16 v[162:163], v8 offset:36864
M v[36:39], a[40:43], a[128:131], v[36:39]
M v[40:43], a[48:51], a[128:131], v[40:43]
buffer_load_dwordx4 v3, s[48:51], s26 offen offset:1024 lds
M v[40:43], a[52:55], a[132:135], v[40:43]
M v[44:47], a[60:63], a[132:135], v[44:47]
ds_read_b64_tr_b16 v[164:165], v8 offset:40960
ds_read_b64_tr_b16 v[166:167], v8 offset:45056
M v[44:47], a[56:59], a[128:131], v[44:47]
M v[48:51], a[64:67], a[128:131], v[48:51]
buffer_load_dwordx4 v4, s[48:51], s26 offen offset:2048 lds
M v[48:51], a[68:71], a[132:135], v[48:51]
M v[52:55], a[76:79], a[132:135], v[52:55]
ds_read_b64_tr_b16 v[168:169], v9 offset:32768
ds_read_b64_tr_b16 v[170:171], v9 offset:36864
M v[52:55], a[72:75], a[128:131], v[52:55]
M v[56:59], a[80:83], a[128:131], v[56:59]
buffer_load_dwordx4 v5, s[48:51], s26 offen offset:3072 lds
M v[56:59], a[84:87], a[132:135], v[56:59]
M v[60:63], a[92:95], a[132:135], v[60:63]
ds_read_b64_tr_b16 v[172:173], v9 offset:40960
ds_read_b64_tr_b16 v[174:175], v9 offset:45056
M v[60:63], a[88:91], a[128:131], v[60:63]
M v[64:67], a[32:35], a[136:139], v[64:67]
buffer_load_dwordx4 a[96:99], v1, s[44:47], s25 offen offset:0 sc1
M v[64:67], a[36:39], a[140:143], v[64:67]
M v[68:71], a[44:47], a[140:143], v[68:71]
ds_read_b64_tr_b16 v[176:177], v10 offset:32768
ds_read_b64_tr_b16 v[178:179], v10 offset:36864
M v[68:71], a[40:43], a[136:139], v[68:71]
M v[72:75], a[48:51], a[136:139], v[72:75]
buffer_load_dwordx4 a[100:103], v1, s[44:47], s25 offen offset:1024 sc1
M v[72:75], a[52:55], a[140:143], v[72:75]
M v[76:79], a[60:63], a[140:143], v[76:79]
ds_read_b64_tr_b16 v[180:181], v10 offset:40960
ds_read_b64_tr_b16 v[182:183], v10 offset:45056
M v[76:79], a[56:59], a[136:139], v[76:79]
M v[80:83], a[64:67], a[136:139], v[80:83]
buffer_load_dwordx4 a[104:107], v1, s[44:47], s25 offen offset:2048 sc1
M v[80:83], a[68:71], a[140:143], v[80:83]
M v[84:87], a[76:79], a[140:143], v[84:87]
ds_read_b64_tr_b16 v[184:185], v11 offset:32768
ds_read_b64_tr_b16 v[186:187], v11 offset:36864
M v[84:87], a[72:75], a[136:139], v[84:87]
M v[88:91], a[80:83], a[136:139], v[88:91]
buffer_load_dwordx4 a[108:111], v1, s[44:47], s25 offen offset:3072 sc1
M v[88:91], a[84:87], a[140:143], v[88:91]
M v[92:95], a[92:95], a[140:143], v[92:95]
M v[92:95], a[88:91], a[136:139], v[92:95]
ds_read_b64_tr_b16 v[188:189], v11 offset:40960
ds_read_b64_tr_b16 v[190:191], v11 offset:45056
M v[96:99], a[32:35], a[144:147], v[96:99]
M v[96:99], a[36:39], a[148:151], v[96:99]
s_add_u32 s63, s25, 4096
buffer_load_dwordx4 a[112:115], v1, s[44:47], s63 offen offset:0 sc1
M v[100:103], a[44:47], a[148:151], v[100:103]
M v[100:103], a[40:43], a[144:147], v[100:103]
ds_read_b64_tr_b16 v[192:193], v12 offset:32768
ds_read_b64_tr_b16 v[194:195], v12 offset:36864
M v[104:107], a[48:51], a[144:147], v[104:107]
M v[104:107], a[52:55], a[148:151], v[104:107]
buffer_load_dwordx4 a[116:119], v1, s[44:47], s63 offen offset:1024 sc1
M v[108:111], a[60:63], a[148:151], v[108:111]
M v[108:111], a[56:59], a[144:147], v[108:111]
ds_read_b64_tr_b16 v[196:197], v12 offset:40960
ds_read_b64_tr_b16 v[198:199], v12 offset:45056
M v[112:115], a[64:67], a[144:147], v[112:115]
M v[112:115], a[68:71], a[148:151], v[112:115]
buffer_load_dwordx4 a[120:123], v1, s[44:47], s63 offen offset:2048 sc1
M v[116:119], a[76:79], a[148:151], v[116:119]
M v[116:119], a[72:75], a[144:147], v[116:119]
ds_read_b64_tr_b16 v[200:201], v13 offset:32768
ds_read_b64_tr_b16 v[202:203], v13 offset:36864
M v[120:123], a[80:83], a[144:147], v[120:123]
M v[120:123], a[84:87], a[148:151], v[120:123]
buffer_load_dwordx4 a[124:127], v1, s[44:47], s63 offen offset:3072 sc1
M v[124:127], a[92:95], a[148:151], v[124:127]
M v[124:127], a[88:91], a[144:147], v[124:127]
ds_read_b64_tr_b16 v[204:205], v13 offset:40960
ds_read_b64_tr_b16 v[206:207], v13 offset:45056
M v[128:131], a[32:35], a[152:155], v[128:131]
M v[128:131], a[36:39], a[156:159], v[128:131]
s_sub_u32 s39, s39, 1
s_cmp_eq_u32 s39, 0
s_cselect_b32 s3, s64, s65
M v[132:135], a[44:47], a[156:159], v[132:135]
M v[132:135], a[40:43], a[152:155], v[132:135]
ds_read_b64_tr_b16 v[208:209], v14 offset:32768
ds_read_b64_tr_b16 v[210:211], v14 offset:36864
M v[136:139], a[48:51], a[152:155], v[136:139]
M v[136:139], a[52:55], a[156:159], v[136:139]
s_add_u32 s25, s25, s3
s_lshl_b32 s3, s3, 3
s_add_u32 s26, s26, s3
M v[140:143], a[60:63], a[156:159], v[140:143]
M v[140:143], a[56:59], a[152:155], v[140:143]
ds_read_b64_tr_b16 v[212:213], v14 offset:40960
ds_read_b64_tr_b16 v[214:215], v14 offset:45056
M v[144:147], a[64:67], a[152:155], v[144:147]
M v[144:147], a[68:71], a[156:159], v[144:147]
ds_read_b64_tr_b16 v[216:217], v15 offset:32768
ds_read_b64_tr_b16 v[218:219], v15 offset:36864
M v[148:151], a[76:79], a[156:159], v[148:151]
M v[148:151], a[72:75], a[152:155], v[148:151]
ds_read_b64_tr_b16 v[220:221], v15 offset:40960
ds_read_b64_tr_b16 v[222:223], v15 offset:45056
M v[152:155], a[80:83], a[152:155], v[152:155]
M v[152:155], a[84:87], a[156:159], v[152:155]
M v[156:159], a[92:95], a[156:159], v[156:159]
M v[156:159], a[88:91], a[152:155], v[156:159]
s_waitcnt vmcnt(24) lgkmcnt(0)
s_barrier
M v[32:35], v[160:163], a[160:163], v[32:35]
s_add_u32 m0, s41, 98304
s_nop 0
buffer_load_dwordx4 v2, s[48:51], s26 offen offset:0 lds
M v[32:35], v[164:167], a[164:167], v[32:35]
M v[36:39], v[172:175], a[164:167], v[36:39]
ds_read_b64_tr_b16 a[32:33], v8 offset:49152
ds_read_b64_tr_b16 a[34:35], v8 offset:53248
M v[36:39], v[168:171], a[160:163], v[36:39]
M v[40:43], v[176:179], a[160:163], v[40:43]
buffer_load_dwordx4 v3, s[48:51], s26 offen offset:1024 lds
M v[40:43], v[180:183], a[164:167], v[40:43]
M v[44:47], v[188:191], a[164:167], v[44:47]
ds_read_b64_tr_b16 a[36:37], v8 offset:57344
ds_read_b64_tr_b16 a[38:39], v8 offset:61440
M v[44:47], v[184:187], a[160:163], v[44:47]
M v[48:51], v[192:195], a[160:163], v[48:51]
buffer_load_dwordx4 v4, s[48:51], s26 offen offset:2048 lds
M v[48:51], v[196:199], a[164:167], v[48:51]
M v[52:55], v[204:207], a[164:167], v[52:55]
ds_read_b64_tr_b16 a[40:41], v9 offset:49152
ds_read_b64_tr_b16 a[42:43], v9 offset:53248
M v[52:55], v[200:203], a[160:163], v[52:55]
M v[56:59], v[208:211], a[160:163], v[56:59]
buffer_load_dwordx4 v5, s[48:51], s26 offen offset:3072 lds
M v[56:59], v[212:215], a[164:167], v[56:59]
M v[60:63], v[220:223], a[164:167], v[60:63]
ds_read_b64_tr_b16 a[44:45], v9 offset:57344
ds_read_b64_tr_b16 a[46:47], v9 offset:61440
M v[60:63], v[216:219], a[160:163], v[60:63]
M v[64:67], v[160:163], a[168:171], v[64:67]
buffer_load_dwordx4 a[128:131], v1, s[44:47], s25 offen offset:0 sc1
M v[64:67], v[164:167], a[172:175], v[64:67]
M v[68:71], v[172:175], a[172:175], v[68:71]
ds_read_b64_tr_b16 a[48:49], v10 offset:49152
ds_read_b64_tr_b16 a[50:51], v10 offset:53248
M v[68:71], v[168:171], a[168:171], v[68:71]
M v[72:75], v[176:179], a[168:171], v[72:75]
buffer_load_dwordx4 a[132:135], v1, s[44:47], s25 offen offset:1024 sc1
M v[72:75], v[180:183], a[172:175], v[72:75]
M v[76:79], v[188:191], a[172:175], v[76:79]
ds_read_b64_tr_b16 a[52:53], v10 offset:57344
ds_read_b64_tr_b16 a[54:55], v10 offset:61440
M v[76:79], v[184:187], a[168:171], v[76:79]
M v[80:83], v[192:195], a[168:171], v[80:83]
buffer_load_dwordx4 a[136:139], v1, s[44:47], s25 offen offset:2048 sc1
M v[80:83], v[196:199], a[172:175], v[80:83]
M v[84:87], v[204:207], a[172:175], v[84:87]
ds_read_b64_tr_b16 a[56:57], v11 offset:49152
ds_read_b64_tr_b16 a[58:59], v11 offset:53248
M v[84:87], v[200:203], a[168:171], v[84:87]
M v[88:91], v[208:211], a[168:171], v[88:91]
buffer_load_dwordx4 a[140:143], v1, s[44:47], s25 offen offset:3072 sc1
M v[88:91], v[212:215], a[172:175], v[88:91]
M v[92:95], v[220:223], a[172:175], v[92:95]
M v[92:95], v[216:219], a[168:171], v[92:95]
ds_read_b64_tr_b16 a[60:61], v11 offset:57344
ds_read_b64_tr_b16 a[62:63], v11 offset:61440
M v[96:99], v[160:163], a[176:179], v[96:99]
M v[96:99], v[164:167], a[180:183], v[96:99]
s_add_u32 s63, s25, 4096
buffer_load_dwordx4 a[144:147], v1, s[44:47], s63 offen offset:0 sc1
M v[100:103], v[172:175], a[180:183], v[100:103]
M v[100:103], v[168:171], a[176:179], v[100:103]
ds_read_b64_tr_b16 a[64:65], v12 offset:49152
ds_read_b64_tr_b16 a[66:67], v12 offset:53248
M v[104:107], v[176:179], a[176:179], v[104:107]
M v[104:107], v[180:183], a[180:183], v[104:107]
buffer_load_dwordx4 a[148:151], v1, s[44:47], s63 offen offset:1024 sc1
M v[108:111], v[188:191], a[180:183], v[108:111]
M v[108:111], v[184:187], a[176:179], v[108:111]
ds_read_b64_tr_b16 a[68:69], v12 offset:57344
ds_read_b64_tr_b16 a[70:71], v12 offset:61440
M v[112:115], v[192:195], a[176:179], v[112:115]
s_getpc_b64 s[92:93]
Lpcf:
s_add_u32 s92, s92, Lo2-Lpcf
s_addc_u32 s93, s93, 0
s_lshr_b32 s94, s2, 3
s_lshl2_add_u32 s94, s94, s101
s_mul_i32 s94, s94, (((Lc3-Lo2)/128+127)&~127)
v_lshlrev_b32 v250, 7, v0
v_min_u32 v250, (((Lc3-Lo2)/128+127)&~127)-128, v250
v_add_u32 v250, s94, v250
v_min_u32 v250, Lc3-Lo2-4, v250
global_load_dword v251, v250, s[92:93]
M v[112:115], v[196:199], a[180:183], v[112:115]
buffer_load_dwordx4 a[152:155], v1, s[44:47], s63 offen offset:2048 sc1
M v[116:119], v[204:207], a[180:183], v[116:119]
M v[116:119], v[200:203], a[176:179], v[116:119]
ds_read_b64_tr_b16 a[72:73], v13 offset:49152
ds_read_b64_tr_b16 a[74:75], v13 offset:53248
M v[120:123], v[208:211], a[176:179], v[120:123]
M v[120:123], v[212:215], a[180:183], v[120:123]
buffer_load_dwordx4 a[156:159], v1, s[44:47], s63 offen offset:3072 sc1
M v[124:127], v[220:223], a[180:183], v[124:127]
M v[124:127], v[216:219], a[176:179], v[124:127]
ds_read_b64_tr_b16 a[76:77], v13 offset:57344
ds_read_b64_tr_b16 a[78:79], v13 offset:61440
M v[128:131], v[160:163], a[184:187], v[128:131]
M v[128:131], v[164:167], a[188:191], v[128:131]
s_sub_u32 s39, s39, 1
s_cmp_eq_u32 s39, 0
s_cselect_b32 s3, s64, s65
M v[132:135], v[172:175], a[188:191], v[132:135]
M v[132:135], v[168:171], a[184:187], v[132:135]
ds_read_b64_tr_b16 a[80:81], v14 offset:49152
ds_read_b64_tr_b16 a[82:83], v14 offset:53248
M v[136:139], v[176:179], a[184:187], v[136:139]
M v[136:139], v[180:183], a[188:191], v[136:139]
s_add_u32 s25, s25, s3
s_lshl_b32 s3, s3, 3
s_add_u32 s26, s26, s3
M v[140:143], v[188:191], a[188:191], v[140:143]
M v[140:143], v[184:187], a[184:187], v[140:143]
ds_read_b64_tr_b16 a[84:85], v14 offset:57344
ds_read_b64_tr_b16 a[86:87], v14 offset:61440
M v[144:147], v[192:195], a[184:187], v[144:147]
M v[144:147], v[196:199], a[188:191], v[144:147]
ds_read_b64_tr_b16 a[88:89], v15 offset:49152
ds_read_b64_tr_b16 a[90:91], v15 offset:53248
M v[148:151], v[204:207], a[188:191], v[148:151]
M v[148:151], v[200:203], a[184:187], v[148:151]
ds_read_b64_tr_b16 a[92:93], v15 offset:57344
ds_read_b64_tr_b16 a[94:95], v15 offset:61440
M v[152:155], v[208:211], a[184:187], v[152:155]
M v[152:155], v[212:215], a[188:191], v[152:155]
M v[156:159], v[220:223], a[188:191], v[156:159]
M v[156:159], v[216:219], a[184:187], v[156:159]
s_waitcnt vmcnt(25) lgkmcnt(0)
s_barrier
M v[32:35], a[32:35], a[192:195], v[32:35]
s_add_u32 m0, s41, 114688
s_nop 0
buffer_load_dwordx4 v2, s[48:51], s26 offen offset:0 lds
M v[32:35], a[36:39], a[196:199], v[32:35]
M v[36:39], a[44:47], a[196:199], v[36:39]
ds_read_b64_tr_b16 v[160:161], v16 offset:0
ds_read_b64_tr_b16 v[162:163], v16 offset:4096
M v[36:39], a[40:43], a[192:195], v[36:39]
M v[40:43], a[48:51], a[192:195], v[40:43]
buffer_load_dwordx4 v3, s[48:51], s26 offen offset:1024 lds
M v[40:43], a[52:55], a[196:199], v[40:43]
M v[44:47], a[60:63], a[196:199], v[44:47]
ds_read_b64_tr_b16 v[164:165], v16 offset:8192
ds_read_b64_tr_b16 v[166:167], v16 offset:12288
M v[44:47], a[56:59], a[192:195], v[44:47]
M v[48:51], a[64:67], a[192:195], v[48:51]
buffer_load_dwordx4 v4, s[48:51], s26 offen offset:2048 lds
M v[48:51], a[68:71], a[196:199], v[48:51]
M v[52:55], a[76:79], a[196:199], v[52:55]
ds_read_b64_tr_b16 v[168:169], v17 offset:0
ds_read_b64_tr_b16 v[170:171], v17 offset:4096
M v[52:55], a[72:75], a[192:195], v[52:55]
M v[56:59], a[80:83], a[192:195], v[56:59]
buffer_load_dwordx4 v5, s[48:51], s26 offen offset:3072 lds
M v[56:59], a[84:87], a[196:199], v[56:59]
M v[60:63], a[92:95], a[196:199], v[60:63]
ds_read_b64_tr_b16 v[172:173], v17 offset:8192
ds_read_b64_tr_b16 v[174:175], v17 offset:12288
M v[60:63], a[88:91], a[192:195], v[60:63]
M v[64:67], a[32:35], a[200:203], v[64:67]
buffer_load_dwordx4 a[160:163], v1, s[44:47], s25 offen offset:0 sc1
M v[64:67], a[36:39], a[204:207], v[64:67]
M v[68:71], a[44:47], a[204:207], v[68:71]
ds_read_b64_tr_b16 v[176:177], v18 offset:0
ds_read_b64_tr_b16 v[178:179], v18 offset:4096
M v[68:71], a[40:43], a[200:203], v[68:71]
M v[72:75], a[48:51], a[200:203], v[72:75]
buffer_load_dwordx4 a[164:167], v1, s[44:47], s25 offen offset:1024 sc1
M v[72:75], a[52:55], a[204:207], v[72:75]
M v[76:79], a[60:63], a[204:207], v[76:79]
ds_read_b64_tr_b16 v[180:181], v18 offset:8192
ds_read_b64_tr_b16 v[182:183], v18 offset:12288
M v[76:79], a[56:59], a[200:203], v[76:79]
M v[80:83], a[64:67], a[200:203], v[80:83]
buffer_load_dwordx4 a[168:171], v1, s[44:47], s25 offen offset:2048 sc1
M v[80:83], a[68:71], a[204:207], v[80:83]
M v[84:87], a[76:79], a[204:207], v[84:87]
ds_read_b64_tr_b16 v[184:185], v19 offset:0
ds_read_b64_tr_b16 v[186:187], v19 offset:4096
M v[84:87], a[72:75], a[200:203], v[84:87]
M v[88:91], a[80:83], a[200:203], v[88:91]
buffer_load_dwordx4 a[172:175], v1, s[44:47], s25 offen offset:3072 sc1
M v[88:91], a[84:87], a[204:207], v[88:91]
M v[92:95], a[92:95], a[204:207], v[92:95]
M v[92:95], a[88:91], a[200:203], v[92:95]
ds_read_b64_tr_b16 v[188:189], v19 offset:8192
ds_read_b64_tr_b16 v[190:191], v19 offset:12288
M v[96:99], a[32:35], a[208:211], v[96:99]
M v[96:99], a[36:39], a[212:215], v[96:99]
s_add_u32 s63, s25, 4096
buffer_load_dwordx4 a[176:179], v1, s[44:47], s63 offen offset:0 sc1
M v[100:103], a[44:47], a[212:215], v[100:103]
M v[100:103], a[40:43], a[208:211], v[100:103]
ds_read_b64_tr_b16 v[192:193], v20 offset:0
ds_read_b64_tr_b16 v[194:195], v20 offset:4096
M v[104:107], a[48:51], a[208:211], v[104:107]
M v[104:107], a[52:55], a[212:215], v[104:107]
buffer_load_dwordx4 a[180:183], v1, s[44:47], s63 offen offset:1024 sc1
M v[108:111], a[60:63], a[212:215], v[108:111]
M v[108:111], a[56:59], a[208:211], v[108:111]
ds_read_b64_tr_b16 v[196:197], v20 offset:8192
ds_read_b64_tr_b16 v[198:199], v20 offset:12288
M v[112:115], a[64:67], a[208:211], v[112:115]
M v[112:115], a[68:71], a[212:215], v[112:115]
buffer_load_dwordx4 a[184:187], v1, s[44:47], s63 offen offset:2048 sc1
M v[116:119], a[76:79], a[212:215], v[116:119]
M v[116:119], a[72:75], a[208:211], v[116:119]
ds_read_b64_tr_b16 v[200:201], v21 offset:0
ds_read_b64_tr_b16 v[202:203], v21 offset:4096
M v[120:123], a[80:83], a[208:211], v[120:123]
M v[120:123], a[84:87], a[212:215], v[120:123]
buffer_load_dwordx4 a[188:191], v1, s[44:47], s63 offen offset:3072 sc1
M v[124:127], a[92:95], a[212:215], v[124:127]
M v[124:127], a[88:91], a[208:211], v[124:127]
ds_read_b64_tr_b16 v[204:205], v21 offset:8192
ds_read_b64_tr_b16 v[206:207], v21 offset:12288
M v[128:131], a[32:35], a[216:219], v[128:131]
M v[128:131], a[36:39], a[220:223], v[128:131]
s_sub_u32 s39, s39, 1
s_cmp_eq_u32 s39, 0
s_cselect_b32 s3, s64, s65
M v[132:135], a[44:47], a[220:223], v[132:135]
M v[132:135], a[40:43], a[216:219], v[132:135]
ds_read_b64_tr_b16 v[208:209], v22 offset:0
ds_read_b64_tr_b16 v[210:211], v22 offset:4096
M v[136:139], a[48:51], a[216:219], v[136:139]
M v[136:139], a[52:55], a[220:223], v[136:139]
s_add_u32 s25, s25, s3
s_lshl_b32 s3, s3, 3
s_add_u32 s26, s26, s3
M v[140:143], a[60:63], a[220:223], v[140:143]
M v[140:143], a[56:59], a[216:219], v[140:143]
ds_read_b64_tr_b16 v[212:213], v22 offset:8192
ds_read_b64_tr_b16 v[214:215], v22 offset:12288
M v[144:147], a[64:67], a[216:219], v[144:147]
M v[144:147], a[68:71], a[220:223], v[144:147]
ds_read_b64_tr_b16 v[216:217], v23 offset:0
ds_read_b64_tr_b16 v[218:219], v23 offset:4096
M v[148:151], a[76:79], a[220:223], v[148:151]
M v[148:151], a[72:75], a[216:219], v[148:151]
ds_read_b64_tr_b16 v[220:221], v23 offset:8192
ds_read_b64_tr_b16 v[222:223], v23 offset:12288
M v[152:155], a[80:83], a[216:219], v[152:155]
M v[152:155], a[84:87], a[220:223], v[152:155]
M v[156:159], a[92:95], a[220:223], v[156:159]
M v[156:159], a[88:91], a[216:219], v[156:159]
s_waitcnt vmcnt(25) lgkmcnt(0)
s_barrier
M v[32:35], v[160:163], a[224:227], v[32:35]
s_add_u32 m0, s41, 0
s_nop 0
buffer_load_dwordx4 v2, s[48:51], s26 offen offset:0 lds
M v[32:35], v[164:167], a[228:231], v[32:35]
M v[36:39], v[172:175], a[228:231], v[36:39]
ds_read_b64_tr_b16 a[32:33], v16 offset:16384
ds_read_b64_tr_b16 a[34:35], v16 offset:20480
M v[36:39], v[168:171], a[224:227], v[36:39]
M v[40:43], v[176:179], a[224:227], v[40:43]
buffer_load_dwordx4 v3, s[48:51], s26 offen offset:1024 lds
M v[40:43], v[180:183], a[228:231], v[40:43]
M v[44:47], v[188:191], a[228:231], v[44:47]
ds_read_b64_tr_b16 a[36:37], v16 offset:24576
ds_read_b64_tr_b16 a[38:39], v16 offset:28672
M v[44:47], v[184:187], a[224:227], v[44:47]
M v[48:51], v[192:195], a[224:227], v[48:51]
buffer_load_dwordx4 v4, s[48:51], s26 offen offset:2048 lds
M v[48:51], v[196:199], a[228:231], v[48:51]
M v[52:55], v[204:207], a[228:231], v[52:55]
ds_read_b64_tr_b16 a[40:41], v17 offset:16384
ds_read_b64_tr_b16 a[42:43], v17 offset:20480
M v[52:55], v[200:203], a[224:227], v[52:55]
M v[56:59], v[208:211], a[224:227], v[56:59]
buffer_load_dwordx4 v5, s[48:51], s26 offen offset:3072 lds
M v[56:59], v[212:215], a[228:231], v[56:59]
M v[60:63], v[220:223], a[228:231], v[60:63]
ds_read_b64_tr_b16 a[44:45], v17 offset:24576
ds_read_b64_tr_b16 a[46:47], v17 offset:28672
M v[60:63], v[216:219], a[224:227], v[60:63]
M v[64:67], v[160:163], a[232:235], v[64:67]
buffer_load_dwordx4 a[192:195], v1, s[44:47], s25 offen offset:0 sc1
M v[64:67], v[164:167], a[236:239], v[64:67]
M v[68:71], v[172:175], a[236:239], v[68:71]
ds_read_b64_tr_b16 a[48:49], v18 offset:16384
ds_read_b64_tr_b16 a[50:51], v18 offset:20480
M v[68:71], v[168:171], a[232:235], v[68:71]
M v[72:75], v[176:179], a[232:235], v[72:75]
buffer_load_dwordx4 a[196:199], v1, s[44:47], s25 offen offset:1024 sc1
M v[72:75], v[180:183], a[236:239], v[72:75]
M v[76:79], v[188:191], a[236:239], v[76:79]
ds_read_b64_tr_b16 a[52:53], v18 offset:24576
ds_read_b64_tr_b16 a[54:55], v18 offset:28672
M v[76:79], v[184:187], a[232:235], v[76:79]
M v[80:83], v[192:195], a[232:235], v[80:83]
buffer_load_dwordx4 a[200:203], v1, s[44:47], s25 offen offset:2048 sc1
M v[80:83], v[196:199], a[236:239], v[80:83]
M v[84:87], v[204:207], a[236:239], v[84:87]
ds_read_b64_tr_b16 a[56:57], v19 offset:16384
ds_read_b64_tr_b16 a[58:59], v19 offset:20480
M v[84:87], v[200:203], a[232:235], v[84:87]
M v[88:91], v[208:211], a[232:235], v[88:91]
buffer_load_dwordx4 a[204:207], v1, s[44:47], s25 offen offset:3072 sc1
M v[88:91], v[212:215], a[236:239], v[88:91]
M v[92:95], v[220:223], a[236:239], v[92:95]
M v[92:95], v[216:219], a[232:235], v[92:95]
ds_read_b64_tr_b16 a[60:61], v19 offset:24576
ds_read_b64_tr_b16 a[62:63], v19 offset:28672
M v[96:99], v[160:163], a[240:243], v[96:99]
M v[96:99], v[164:167], a[244:247], v[96:99]
s_add_u32 s63, s25, 4096
buffer_load_dwordx4 a[208:211], v1, s[44:47], s63 offen offset:0 sc1
M v[100:103], v[172:175], a[244:247], v[100:103]
M v[100:103], v[168:171], a[240:243], v[100:103]
ds_read_b64_tr_b16 a[64:65], v20 offset:16384
ds_read_b64_tr_b16 a[66:67], v20 offset:20480
M v[104:107], v[176:179], a[240:243], v[104:107]
M v[104:107], v[180:183], a[244:247], v[104:107]
buffer_load_dwordx4 a[212:215], v1, s[44:47], s63 offen offset:1024 sc1
M v[108:111], v[188:191], a[244:247], v[108:111]
M v[108:111], v[184:187], a[240:243], v[108:111]
ds_read_b64_tr_b16 a[68:69], v20 offset:24576
ds_read_b64_tr_b16 a[70:71], v20 offset:28672
M v[112:115], v[192:195], a[240:243], v[112:115]
M v[112:115], v[196:199], a[244:247], v[112:115]
buffer_load_dwordx4 a[216:219], v1, s[44:47], s63 offen offset:2048 sc1
M v[116:119], v[204:207], a[244:247], v[116:119]
M v[116:119], v[200:203], a[240:243], v[116:119]
ds_read_b64_tr_b16 a[72:73], v21 offset:16384
ds_read_b64_tr_b16 a[74:75], v21 offset:20480
M v[120:123], v[208:211], a[240:243], v[120:123]
M v[120:123], v[212:215], a[244:247], v[120:123]
buffer_load_dwordx4 a[220:223], v1, s[44:47], s63 offen offset:3072 sc1
M v[124:127], v[220:223], a[244:247], v[124:127]
M v[124:127], v[216:219], a[240:243], v[124:127]
ds_read_b64_tr_b16 a[76:77], v21 offset:24576
ds_read_b64_tr_b16 a[78:79], v21 offset:28672
M v[128:131], v[160:163], a[248:251], v[128:131]
M v[128:131], v[164:167], a[252:255], v[128:131]
s_sub_u32 s39, s39, 1
s_cmp_eq_u32 s39, 0
s_cselect_b32 s3, s64, s65
M v[132:135], v[172:175], a[252:255], v[132:135]
M v[132:135], v[168:171], a[248:251], v[132:135]
ds_read_b64_tr_b16 a[80:81], v22 offset:16384
ds_read_b64_tr_b16 a[82:83], v22 offset:20480
M v[136:139], v[176:179], a[248:251], v[136:139]
M v[136:139], v[180:183], a[252:255], v[136:139]
s_add_u32 s25, s25, s3
s_lshl_b32 s3, s3, 3
s_add_u32 s26, s26, s3
M v[140:143], v[188:191], a[252:255], v[140:143]
M v[140:143], v[184:187], a[248:251], v[140:143]
ds_read_b64_tr_b16 a[84:85], v22 offset:24576
ds_read_b64_tr_b16 a[86:87], v22 offset:28672
M v[144:147], v[192:195], a[248:251], v[144:147]
M v[144:147], v[196:199], a[252:255], v[144:147]
ds_read_b64_tr_b16 a[88:89], v23 offset:16384
ds_read_b64_tr_b16 a[90:91], v23 offset:20480
M v[148:151], v[204:207], a[252:255], v[148:151]
M v[148:151], v[200:203], a[248:251], v[148:151]
ds_read_b64_tr_b16 a[92:93], v23 offset:24576
ds_read_b64_tr_b16 a[94:95], v23 offset:28672
M v[152:155], v[208:211], a[248:251], v[152:155]
M v[152:155], v[212:215], a[252:255], v[152:155]
M v[156:159], v[220:223], a[252:255], v[156:159]
M v[156:159], v[216:219], a[248:251], v[156:159]
s_waitcnt vmcnt(24) lgkmcnt(0)
s_barrier
M v[32:35], a[32:35], a[96:99], v[32:35]
s_add_u32 m0, s41, 16384
s_nop 0
buffer_load_dwordx4 v2, s[48:51], s26 offen offset:0 lds
M v[32:35], a[36:39], a[100:103], v[32:35]
M v[36:39], a[44:47], a[100:103], v[36:39]
ds_read_b64_tr_b16 v[160:161], v16 offset:32768
ds_read_b64_tr_b16 v[162:163], v16 offset:36864
M v[36:39], a[40:43], a[96:99], v[36:39]
M v[40:43], a[48:51], a[96:99], v[40:43]
buffer_load_dwordx4 v3, s[48:51], s26 offen offset:1024 lds
M v[40:43], a[52:55], a[100:103], v[40:43]
M v[44:47], a[60:63], a[100:103], v[44:47]
ds_read_b64_tr_b16 v[164:165], v16 offset:40960
ds_read_b64_tr_b16 v[166:167], v16 offset:45056
M v[44:47], a[56:59], a[96:99], v[44:47]
M v[48:51], a[64:67], a[96:99], v[48:51]
buffer_load_dwordx4 v4, s[48:51], s26 offen offset:2048 lds
M v[48:51], a[68:71], a[100:103], v[48:51]
M v[52:55], a[76:79], a[100:103], v[52:55]
ds_read_b64_tr_b16 v[168:169], v17 offset:32768
ds_read_b64_tr_b16 v[170:171], v17 offset:36864
M v[52:55], a[72:75], a[96:99], v[52:55]
M v[56:59], a[80:83], a[96:99], v[56:59]
buffer_load_dwordx4 v5, s[48:51], s26 offen offset:3072 lds
M v[56:59], a[84:87], a[100:103], v[56:59]
M v[60:63], a[92:95], a[100:103], v[60:63]
ds_read_b64_tr_b16 v[172:173], v17 offset:40960
ds_read_b64_tr_b16 v[174:175], v17 offset:45056
M v[60:63], a[88:91], a[96:99], v[60:63]
M v[64:67], a[32:35], a[104:107], v[64:67]
buffer_load_dwordx4 a[224:227], v1, s[44:47], s25 offen offset:0 sc1
M v[64:67], a[36:39], a[108:111], v[64:67]
M v[68:71], a[44:47], a[108:111], v[68:71]
ds_read_b64_tr_b16 v[176:177], v18 offset:32768
ds_read_b64_tr_b16 v[178:179], v18 offset:36864
M v[68:71], a[40:43], a[104:107], v[68:71]
M v[72:75], a[48:51], a[104:107], v[72:75]
buffer_load_dwordx4 a[228:231], v1, s[44:47], s25 offen offset:1024 sc1
M v[72:75], a[52:55], a[108:111], v[72:75]
M v[76:79], a[60:63], a[108:111], v[76:79]
ds_read_b64_tr_b16 v[180:181], v18 offset:40960
ds_read_b64_tr_b16 v[182:183], v18 offset:45056
M v[76:79], a[56:59], a[104:107], v[76:79]
M v[80:83], a[64:67], a[104:107], v[80:83]
buffer_load_dwordx4 a[232:235], v1, s[44:47], s25 offen offset:2048 sc1
M v[80:83], a[68:71], a[108:111], v[80:83]
M v[84:87], a[76:79], a[108:111], v[84:87]
ds_read_b64_tr_b16 v[184:185], v19 offset:32768
ds_read_b64_tr_b16 v[186:187], v19 offset:36864
M v[84:87], a[72:75], a[104:107], v[84:87]
M v[88:91], a[80:83], a[104:107], v[88:91]
buffer_load_dwordx4 a[236:239], v1, s[44:47], s25 offen offset:3072 sc1
M v[88:91], a[84:87], a[108:111], v[88:91]
M v[92:95], a[92:95], a[108:111], v[92:95]
M v[92:95], a[88:91], a[104:107], v[92:95]
ds_read_b64_tr_b16 v[188:189], v19 offset:40960
ds_read_b64_tr_b16 v[190:191], v19 offset:45056
M v[96:99], a[32:35], a[112:115], v[96:99]
M v[96:99], a[36:39], a[116:119], v[96:99]
s_add_u32 s63, s25, 4096
buffer_load_dwordx4 a[240:243], v1, s[44:47], s63 offen offset:0 sc1
M v[100:103], a[44:47], a[116:119], v[100:103]
M v[100:103], a[40:43], a[112:115], v[100:103]
ds_read_b64_tr_b16 v[192:193], v20 offset:32768
ds_read_b64_tr_b16 v[194:195], v20 offset:36864
M v[104:107], a[48:51], a[112:115], v[104:107]
M v[104:107], a[52:55], a[116:119], v[104:107]
buffer_load_dwordx4 a[244:247], v1, s[44:47], s63 offen offset:1024 sc1
M v[108:111], a[60:63], a[116:119], v[108:111]
M v[108:111], a[56:59], a[112:115], v[108:111]
ds_read_b64_tr_b16 v[196:197], v20 offset:40960
ds_read_b64_tr_b16 v[198:199], v20 offset:45056
M v[112:115], a[64:67], a[112:115], v[112:115]
M v[112:115], a[68:71], a[116:119], v[112:115]
buffer_load_dwordx4 a[248:251], v1, s[44:47], s63 offen offset:2048 sc1
M v[116:119], a[76:79], a[116:119], v[116:119]
M v[116:119], a[72:75], a[112:115], v[116:119]
ds_read_b64_tr_b16 v[200:201], v21 offset:32768
ds_read_b64_tr_b16 v[202:203], v21 offset:36864
M v[120:123], a[80:83], a[112:115], v[120:123]
M v[120:123], a[84:87], a[116:119], v[120:123]
buffer_load_dwordx4 a[252:255], v1, s[44:47], s63 offen offset:3072 sc1
M v[124:127], a[92:95], a[116:119], v[124:127]
M v[124:127], a[88:91], a[112:115], v[124:127]
ds_read_b64_tr_b16 v[204:205], v21 offset:40960
ds_read_b64_tr_b16 v[206:207], v21 offset:45056
M v[128:131], a[32:35], a[120:123], v[128:131]
M v[128:131], a[36:39], a[124:127], v[128:131]
s_sub_u32 s39, s39, 1
s_cmp_eq_u32 s39, 0
s_cselect_b32 s3, s64, s65
M v[132:135], a[44:47], a[124:127], v[132:135]
M v[132:135], a[40:43], a[120:123], v[132:135]
ds_read_b64_tr_b16 v[208:209], v22 offset:32768
ds_read_b64_tr_b16 v[210:211], v22 offset:36864
M v[136:139], a[48:51], a[120:123], v[136:139]
M v[136:139], a[52:55], a[124:127], v[136:139]
s_add_u32 s25, s25, s3
s_lshl_b32 s3, s3, 3
s_add_u32 s26, s26, s3
M v[140:143], a[60:63], a[124:127], v[140:143]
M v[140:143], a[56:59], a[120:123], v[140:143]
ds_read_b64_tr_b16 v[212:213], v22 offset:40960
ds_read_b64_tr_b16 v[214:215], v22 offset:45056
M v[144:147], a[64:67], a[120:123], v[144:147]
M v[144:147], a[68:71], a[124:127], v[144:147]
ds_read_b64_tr_b16 v[216:217], v23 offset:32768
ds_read_b64_tr_b16 v[218:219], v23 offset:36864
M v[148:151], a[76:79], a[124:127], v[148:151]
M v[148:151], a[72:75], a[120:123], v[148:151]
ds_read_b64_tr_b16 v[220:221], v23 offset:40960
ds_read_b64_tr_b16 v[222:223], v23 offset:45056
M v[152:155], a[80:83], a[120:123], v[152:155]
M v[152:155], a[84:87], a[124:127], v[152:155]
M v[156:159], a[92:95], a[124:127], v[156:159]
M v[156:159], a[88:91], a[120:123], v[156:159]
s_waitcnt vmcnt(24) lgkmcnt(0)
s_barrier
M v[32:35], v[160:163], a[128:131], v[32:35]
s_add_u32 m0, s41, 32768
s_nop 0
buffer_load_dwordx4 v2, s[48:51], s26 offen offset:0 lds
M v[32:35], v[164:167], a[132:135], v[32:35]
M v[36:39], v[172:175], a[132:135], v[36:39]
ds_read_b64_tr_b16 a[32:33], v16 offset:49152
ds_read_b64_tr_b16 a[34:35], v16 offset:53248
M v[36:39], v[168:171], a[128:131], v[36:39]
M v[40:43], v[176:179], a[128:131], v[40:43]
buffer_load_dwordx4 v3, s[48:51], s26 offen offset:1024 lds
M v[40:43], v[180:183], a[132:135], v[40:43]
M v[44:47], v[188:191], a[132:135], v[44:47]
ds_read_b64_tr_b16 a[36:37], v16 offset:57344
ds_read_b64_tr_b16 a[38:39], v16 offset:61440
M v[44:47], v[184:187], a[128:131], v[44:47]
M v[48:51], v[192:195], a[128:131], v[48:51]
buffer_load_dwordx4 v4, s[48:51], s26 offen offset:2048 lds
M v[48:51], v[196:199], a[132:135], v[48:51]
M v[52:55], v[204:207], a[132:135], v[52:55]
ds_read_b64_tr_b16 a[40:41], v17 offset:49152
ds_read_b64_tr_b16 a[42:43], v17 offset:53248
M v[52:55], v[200:203], a[128:131], v[52:55]
M v[56:59], v[208:211], a[128:131], v[56:59]
buffer_load_dwordx4 v5, s[48:51], s26 offen offset:3072 lds
M v[56:59], v[212:215], a[132:135], v[56:59]
M v[60:63], v[220:223], a[132:135], v[60:63]
ds_read_b64_tr_b16 a[44:45], v17 offset:57344
ds_read_b64_tr_b16 a[46:47], v17 offset:61440
M v[60:63], v[216:219], a[128:131], v[60:63]
M v[64:67], v[160:163], a[136:139], v[64:67]
buffer_load_dwordx4 a[96:99], v1, s[44:47], s25 offen offset:0 sc1
M v[64:67], v[164:167], a[140:143], v[64:67]
M v[68:71], v[172:175], a[140:143], v[68:71]
ds_read_b64_tr_b16 a[48:49], v18 offset:49152
ds_read_b64_tr_b16 a[50:51], v18 offset:53248
M v[68:71], v[168:171], a[136:139], v[68:71]
M v[72:75], v[176:179], a[136:139], v[72:75]
buffer_load_dwordx4 a[100:103], v1, s[44:47], s25 offen offset:1024 sc1
M v[72:75], v[180:183], a[140:143], v[72:75]
M v[76:79], v[188:191], a[140:143], v[76:79]
ds_read_b64_tr_b16 a[52:53], v18 offset:57344
ds_read_b64_tr_b16 a[54:55], v18 offset:61440
M v[76:79], v[184:187], a[136:139], v[76:79]
M v[80:83], v[192:195], a[136:139], v[80:83]
buffer_load_dwordx4 a[104:107], v1, s[44:47], s25 offen offset:2048 sc1
M v[80:83], v[196:199], a[140:143], v[80:83]
M v[84:87], v[204:207], a[140:143], v[84:87]
ds_read_b64_tr_b16 a[56:57], v19 offset:49152
ds_read_b64_tr_b16 a[58:59], v19 offset:53248
M v[84:87], v[200:203], a[136:139], v[84:87]
M v[88:91], v[208:211], a[136:139], v[88:91]
buffer_load_dwordx4 a[108:111], v1, s[44:47], s25 offen offset:3072 sc1
M v[88:91], v[212:215], a[140:143], v[88:91]
M v[92:95], v[220:223], a[140:143], v[92:95]
M v[92:95], v[216:219], a[136:139], v[92:95]
ds_read_b64_tr_b16 a[60:61], v19 offset:57344
ds_read_b64_tr_b16 a[62:63], v19 offset:61440
M v[96:99], v[160:163], a[144:147], v[96:99]
M v[96:99], v[164:167], a[148:151], v[96:99]
s_add_u32 s63, s25, 4096
buffer_load_dwordx4 a[112:115], v1, s[44:47], s63 offen offset:0 sc1
M v[100:103], v[172:175], a[148:151], v[100:103]
M v[100:103], v[168:171], a[144:147], v[100:103]
ds_read_b64_tr_b16 a[64:65], v20 offset:49152
ds_read_b64_tr_b16 a[66:67], v20 offset:53248
M v[104:107], v[176:179], a[144:147], v[104:107]
M v[104:107], v[180:183], a[148:151], v[104:107]
buffer_load_dwordx4 a[116:119], v1, s[44:47], s63 offen offset:1024 sc1
M v[108:111], v[188:191], a[148:151], v[108:111]
M v[108:111], v[184:187], a[144:147], v[108:111]
ds_read_b64_tr_b16 a[68:69], v20 offset:57344
ds_read_b64_tr_b16 a[70:71], v20 offset:61440
M v[112:115], v[192:195], a[144:147], v[112:115]
M v[112:115], v[196:199], a[148:151], v[112:115]
buffer_load_dwordx4 a[120:123], v1, s[44:47], s63 offen offset:2048 sc1
M v[116:119], v[204:207], a[148:151], v[116:119]
M v[116:119], v[200:203], a[144:147], v[116:119]
ds_read_b64_tr_b16 a[72:73], v21 offset:49152
ds_read_b64_tr_b16 a[74:75], v21 offset:53248
M v[120:123], v[208:211], a[144:147], v[120:123]
M v[120:123], v[212:215], a[148:151], v[120:123]
buffer_load_dwordx4 a[124:127], v1, s[44:47], s63 offen offset:3072 sc1
M v[124:127], v[220:223], a[148:151], v[124:127]
M v[124:127], v[216:219], a[144:147], v[124:127]
ds_read_b64_tr_b16 a[76:77], v21 offset:57344
ds_read_b64_tr_b16 a[78:79], v21 offset:61440
M v[128:131], v[160:163], a[152:155], v[128:131]
M v[128:131], v[164:167], a[156:159], v[128:131]
s_sub_u32 s39, s39, 1
s_cmp_eq_u32 s39, 0
s_cselect_b32 s3, s64, s65
M v[132:135], v[172:175], a[156:159], v[132:135]
M v[132:135], v[168:171], a[152:155], v[132:135]
ds_read_b64_tr_b16 a[80:81], v22 offset:49152
ds_read_b64_tr_b16 a[82:83], v22 offset:53248
M v[136:139], v[176:179], a[152:155], v[136:139]
M v[136:139], v[180:183], a[156:159], v[136:139]
s_add_u32 s25, s25, s3
s_lshl_b32 s3, s3, 3
s_add_u32 s26, s26, s3
M v[140:143], v[188:191], a[156:159], v[140:143]
M v[140:143], v[184:187], a[152:155], v[140:143]
ds_read_b64_tr_b16 a[84:85], v22 offset:57344
ds_read_b64_tr_b16 a[86:87], v22 offset:61440
M v[144:147], v[192:195], a[152:155], v[144:147]
M v[144:147], v[196:199], a[156:159], v[144:147]
ds_read_b64_tr_b16 a[88:89], v23 offset:49152
ds_read_b64_tr_b16 a[90:91], v23 offset:53248
M v[148:151], v[204:207], a[156:159], v[148:151]
M v[148:151], v[200:203], a[152:155], v[148:151]
ds_read_b64_tr_b16 a[92:93], v23 offset:57344
ds_read_b64_tr_b16 a[94:95], v23 offset:61440
M v[152:155], v[208:211], a[152:155], v[152:155]
M v[152:155], v[212:215], a[156:159], v[152:155]
M v[156:159], v[220:223], a[156:159], v[156:159]
M v[156:159], v[216:219], a[152:155], v[156:159]
Lo2:
s_waitcnt vmcnt(24) lgkmcnt(0)
s_barrier
M v[32:35], a[32:35], a[160:163], v[32:35]
s_add_u32 m0, s41, 49152
s_nop 0
buffer_load_dwordx4 v2, s[48:51], s26 offen offset:0 lds
M v[32:35], a[36:39], a[164:167], v[32:35]
M v[36:39], a[44:47], a[164:167], v[36:39]
ds_read_b64_tr_b16 v[160:161], v8 offset:0
ds_read_b64_tr_b16 v[162:163], v8 offset:4096
M v[36:39], a[40:43], a[160:163], v[36:39]
M v[40:43], a[48:51], a[160:163], v[40:43]
buffer_load_dwordx4 v3, s[48:51], s26 offen offset:1024 lds
M v[40:43], a[52:55], a[164:167], v[40:43]
M v[44:47], a[60:63], a[164:167], v[44:47]
ds_read_b64_tr_b16 v[164:165], v8 offset:8192
ds_read_b64_tr_b16 v[166:167], v8 offset:12288
M v[44:47], a[56:59], a[160:163], v[44:47]
M v[48:51], a[64:67], a[160:163], v[48:51]
buffer_load_dwordx4 v4, s[48:51], s26 offen offset:2048 lds
M v[48:51], a[68:71], a[164:167], v[48:51]
M v[52:55], a[76:79], a[164:167], v[52:55]
ds_read_b64_tr_b16 v[168:169], v9 offset:0
ds_read_b64_tr_b16 v[170:171], v9 offset:4096
M v[52:55], a[72:75], a[160:163], v[52:55]
M v[56:59], a[80:83], a[160:163], v[56:59]
buffer_load_dwordx4 v5, s[48:51], s26 offen offset:3072 lds
M v[56:59], a[84:87], a[164:167], v[56:59]
M v[60:63], a[92:95], a[164:167], v[60:63]
ds_read_b64_tr_b16 v[172:173], v9 offset:8192
ds_read_b64_tr_b16 v[174:175], v9 offset:12288
M v[60:63], a[88:91], a[160:163], v[60:63]
M v[64:67], a[32:35], a[168:171], v[64:67]
buffer_load_dwordx4 a[128:131], v1, s[44:47], s25 offen offset:0 sc1
M v[64:67], a[36:39], a[172:175], v[64:67]
M v[68:71], a[44:47], a[172:175], v[68:71]
ds_read_b64_tr_b16 v[176:177], v10 offset:0
ds_read_b64_tr_b16 v[178:179], v10 offset:4096
M v[68:71], a[40:43], a[168:171], v[68:71]
M v[72:75], a[48:51], a[168:171], v[72:75]
buffer_load_dwordx4 a[132:135], v1, s[44:47], s25 offen offset:1024 sc1
M v[72:75], a[52:55], a[172:175], v[72:75]
M v[76:79], a[60:63], a[172:175], v[76:79]
ds_read_b64_tr_b16 v[180:181], v10 offset:8192
ds_read_b64_tr_b16 v[182:183], v10 offset:12288
M v[76:79], a[56:59], a[168:171], v[76:79]
M v[80:83], a[64:67], a[168:171], v[80:83]
buffer_load_dwordx4 a[136:139], v1, s[44:47], s25 offen offset:2048 sc1
M v[80:83], a[68:71], a[172:175], v[80:83]
M v[84:87], a[76:79], a[172:175], v[84:87]
ds_read_b64_tr_b16 v[184:185], v11 offset:0
ds_read_b64_tr_b16 v[186:187], v11 offset:4096
M v[84:87], a[72:75], a[168:171], v[84:87]
M v[88:91], a[80:83], a[168:171], v[88:91]
buffer_load_dwordx4 a[140:143], v1, s[44:47], s25 offen offset:3072 sc1
M v[88:91], a[84:87], a[172:175], v[88:91]
M v[92:95], a[92:95], a[172:175], v[92:95]
M v[92:95], a[88:91], a[168:171], v[92:95]
ds_read_b64_tr_b16 v[188:189], v11 offset:8192
ds_read_b64_tr_b16 v[190:191], v11 offset:12288
M v[96:99], a[32:35], a[176:179], v[96:99]
M v[96:99], a[36:39], a[180:183], v[96:99]
s_add_u32 s63, s25, 4096
buffer_load_dwordx4 a[144:147], v1, s[44:47], s63 offen offset:0 sc1
M v[100:103], a[44:47], a[180:183], v[100:103]
M v[100:103], a[40:43], a[176:179], v[100:103]
ds_read_b64_tr_b16 v[192:193], v12 offset:0
ds_read_b64_tr_b16 v[194:195], v12 offset:4096
M v[104:107], a[48:51], a[176:179], v[104:107]
M v[104:107], a[52:55], a[180:183], v[104:107]
buffer_load_dwordx4 a[148:151], v1, s[44:47], s63 offen offset:1024 sc1
M v[108:111], a[60:63], a[180:183], v[108:111]
M v[108:111], a[56:59], a[176:179], v[108:111]
ds_read_b64_tr_b16 v[196:197], v12 offset:8192
ds_read_b64_tr_b16 v[198:199], v12 offset:12288
M v[112:115], a[64:67], a[176:179], v[112:115]
M v[112:115], a[68:71], a[180:183], v[112:115]
buffer_load_dwordx4 a[152:155], v1, s[44:47], s63 offen offset:2048 sc1
M v[116:119], a[76:79], a[180:183], v[116:119]
M v[116:119], a[72:75], a[176:179], v[116:119]
ds_read_b64_tr_b16 v[200:201], v13 offset:0
ds_read_b64_tr_b16 v[202:203], v13 offset:4096
M v[120:123], a[80:83], a[176:179], v[120:123]
M v[120:123], a[84:87], a[180:183], v[120:123]
buffer_load_dwordx4 a[156:159], v1, s[44:47], s63 offen offset:3072 sc1
M v[124:127], a[92:95], a[180:183], v[124:127]
M v[124:127], a[88:91], a[176:179], v[124:127]
ds_read_b64_tr_b16 v[204:205], v13 offset:8192
ds_read_b64_tr_b16 v[206:207], v13 offset:12288
M v[128:131], a[32:35], a[184:187], v[128:131]
M v[128:131], a[36:39], a[188:191], v[128:131]
s_sub_u32 s39, s39, 1
s_cmp_eq_u32 s39, 0
s_cselect_b32 s3, s64, s65
M v[132:135], a[44:47], a[188:191], v[132:135]
M v[132:135], a[40:43], a[184:187], v[132:135]
ds_read_b64_tr_b16 v[208:209], v14 offset:0
ds_read_b64_tr_b16 v[210:211], v14 offset:4096
M v[136:139], a[48:51], a[184:187], v[136:139]
M v[136:139], a[52:55], a[188:191], v[136:139]
s_add_u32 s25, s25, s3
s_lshl_b32 s3, s3, 3
s_add_u32 s26, s26, s3
M v[140:143], a[60:63], a[188:191], v[140:143]
M v[140:143], a[56:59], a[184:187], v[140:143]
ds_read_b64_tr_b16 v[212:213], v14 offset:8192
ds_read_b64_tr_b16 v[214:215], v14 offset:12288
M v[144:147], a[64:67], a[184:187], v[144:147]
M v[144:147], a[68:71], a[188:191], v[144:147]
ds_read_b64_tr_b16 v[216:217], v15 offset:0
ds_read_b64_tr_b16 v[218:219], v15 offset:4096
M v[148:151], a[76:79], a[188:191], v[148:151]
M v[148:151], a[72:75], a[184:187], v[148:151]
ds_read_b64_tr_b16 v[220:221], v15 offset:8192
ds_read_b64_tr_b16 v[222:223], v15 offset:12288
M v[152:155], a[80:83], a[184:187], v[152:155]
M v[152:155], a[84:87], a[188:191], v[152:155]
M v[156:159], a[92:95], a[188:191], v[156:159]
M v[156:159], a[88:91], a[184:187], v[156:159]
s_waitcnt vmcnt(24) lgkmcnt(0)
s_barrier
M v[32:35], v[160:163], a[192:195], v[32:35]
s_add_u32 m0, s41, 65536
s_nop 0
buffer_load_dwordx4 v2, s[48:51], s26 offen offset:0 lds
M v[32:35], v[164:167], a[196:199], v[32:35]
M v[36:39], v[172:175], a[196:199], v[36:39]
ds_read_b64_tr_b16 a[32:33], v8 offset:16384
ds_read_b64_tr_b16 a[34:35], v8 offset:20480
M v[36:39], v[168:171], a[192:195], v[36:39]
M v[40:43], v[176:179], a[192:195], v[40:43]
buffer_load_dwordx4 v3, s[48:51], s26 offen offset:1024 lds
M v[40:43], v[180:183], a[196:199], v[40:43]
M v[44:47], v[188:191], a[196:199], v[44:47]
ds_read_b64_tr_b16 a[36:37], v8 offset:24576
ds_read_b64_tr_b16 a[38:39], v8 offset:28672
M v[44:47], v[184:187], a[192:195], v[44:47]
M v[48:51], v[192:195], a[192:195], v[48:51]
buffer_load_dwordx4 v4, s[48:51], s26 offen offset:2048 lds
M v[48:51], v[196:199], a[196:199], v[48:51]
M v[52:55], v[204:207], a[196:199], v[52:55]
ds_read_b64_tr_b16 a[40:41], v9 offset:16384
ds_read_b64_tr_b16 a[42:43], v9 offset:20480
M v[52:55], v[200:203], a[192:195], v[52:55]
M v[56:59], v[208:211], a[192:195], v[56:59]
buffer_load_dwordx4 v5, s[48:51], s26 offen offset:3072 lds
M v[56:59], v[212:215], a[196:199], v[56:59]
M v[60:63], v[220:223], a[196:199], v[60:63]
ds_read_b64_tr_b16 a[44:45], v9 offset:24576
ds_read_b64_tr_b16 a[46:47], v9 offset:28672
M v[60:63], v[216:219], a[192:195], v[60:63]
M v[64:67], v[160:163], a[200:203], v[64:67]
buffer_load_dwordx4 a[160:163], v1, s[44:47], s25 offen offset:0 sc1
M v[64:67], v[164:167], a[204:207], v[64:67]
M v[68:71], v[172:175], a[204:207], v[68:71]
ds_read_b64_tr_b16 a[48:49], v10 offset:16384
ds_read_b64_tr_b16 a[50:51], v10 offset:20480
M v[68:71], v[168:171], a[200:203], v[68:71]
M v[72:75], v[176:179], a[200:203], v[72:75]
buffer_load_dwordx4 a[164:167], v1, s[44:47], s25 offen offset:1024 sc1
M v[72:75], v[180:183], a[204:207], v[72:75]
M v[76:79], v[188:191], a[204:207], v[76:79]
ds_read_b64_tr_b16 a[52:53], v10 offset:24576
ds_read_b64_tr_b16 a[54:55], v10 offset:28672
M v[76:79], v[184:187], a[200:203], v[76:79]
M v[80:83], v[192:195], a[200:203], v[80:83]
buffer_load_dwordx4 a[168:171], v1, s[44:47], s25 offen offset:2048 sc1
M v[80:83], v[196:199], a[204:207], v[80:83]
M v[84:87], v[204:207], a[204:207], v[84:87]
ds_read_b64_tr_b16 a[56:57], v11 offset:16384
ds_read_b64_tr_b16 a[58:59], v11 offset:20480
M v[84:87], v[200:203], a[200:203], v[84:87]
M v[88:91], v[208:211], a[200:203], v[88:91]
buffer_load_dwordx4 a[172:175], v1, s[44:47], s25 offen offset:3072 sc1
M v[88:91], v[212:215], a[204:207], v[88:91]
M v[92:95], v[220:223], a[204:207], v[92:95]
M v[92:95], v[216:219], a[200:203], v[92:95]
ds_read_b64_tr_b16 a[60:61], v11 offset:24576
ds_read_b64_tr_b16 a[62:63], v11 offset:28672
M v[96:99], v[160:163], a[208:211], v[96:99]
M v[96:99], v[164:167], a[212:215], v[96:99]
s_add_u32 s63, s25, 4096
buffer_load_dwordx4 a[176:179], v1, s[44:47], s63 offen offset:0 sc1
M v[100:103], v[172:175], a[212:215], v[100:103]
M v[100:103], v[168:171], a[208:211], v[100:103]
ds_read_b64_tr_b16 a[64:65], v12 offset:16384
ds_read_b64_tr_b16 a[66:67], v12 offset:20480
M v[104:107], v[176:179], a[208:211], v[104:107]
M v[104:107], v[180:183], a[212:215], v[104:107]
buffer_load_dwordx4 a[180:183], v1, s[44:47], s63 offen offset:1024 sc1
M v[108:111], v[188:191], a[212:215], v[108:111]
M v[108:111], v[184:187], a[208:211], v[108:111]
ds_read_b64_tr_b16 a[68:69], v12 offset:24576
ds_read_b64_tr_b16 a[70:71], v12 offset:28672
M v[112:115], v[192:195], a[208:211], v[112:115]
M v[112:115], v[196:199], a[212:215], v[112:115]
buffer_load_dwordx4 a[184:187], v1, s[44:47], s63 offen offset:2048 sc1
M v[116:119], v[204:207], a[212:215], v[116:119]
M v[116:119], v[200:203], a[208:211], v[116:119]
ds_read_b64_tr_b16 a[72:73], v13 offset:16384
ds_read_b64_tr_b16 a[74:75], v13 offset:20480
M v[120:123], v[208:211], a[208:211], v[120:123]
M v[120:123], v[212:215], a[212:215], v[120:123]
buffer_load_dwordx4 a[188:191], v1, s[44:47], s63 offen offset:3072 sc1
M v[124:127], v[220:223], a[212:215], v[124:127]
M v[124:127], v[216:219], a[208:211], v[124:127]
ds_read_b64_tr_b16 a[76:77], v13 offset:24576
ds_read_b64_tr_b16 a[78:79], v13 offset:28672
M v[128:131], v[160:163], a[216:219], v[128:131]
M v[128:131], v[164:167], a[220:223], v[128:131]
s_sub_u32 s39, s39, 1
s_cmp_eq_u32 s39, 0
s_cselect_b32 s3, s64, s65
M v[132:135], v[172:175], a[220:223], v[132:135]
M v[132:135], v[168:171], a[216:219], v[132:135]
ds_read_b64_tr_b16 a[80:81], v14 offset:16384
ds_read_b64_tr_b16 a[82:83], v14 offset:20480
M v[136:139], v[176:179], a[216:219], v[136:139]
M v[136:139], v[180:183], a[220:223], v[136:139]
s_add_u32 s25, s25, s3
s_lshl_b32 s3, s3, 3
s_add_u32 s26, s26, s3
M v[140:143], v[188:191], a[220:223], v[140:143]
M v[140:143], v[184:187], a[216:219], v[140:143]
ds_read_b64_tr_b16 a[84:85], v14 offset:24576
ds_read_b64_tr_b16 a[86:87], v14 offset:28672
M v[144:147], v[192:195], a[216:219], v[144:147]
M v[144:147], v[196:199], a[220:223], v[144:147]
ds_read_b64_tr_b16 a[88:89], v15 offset:16384
ds_read_b64_tr_b16 a[90:91], v15 offset:20480
M v[148:151], v[204:207], a[220:223], v[148:151]
M v[148:151], v[200:203], a[216:219], v[148:151]
ds_read_b64_tr_b16 a[92:93], v15 offset:24576
ds_read_b64_tr_b16 a[94:95], v15 offset:28672
M v[152:155], v[208:211], a[216:219], v[152:155]
M v[152:155], v[212:215], a[220:223], v[152:155]
M v[156:159], v[220:223], a[220:223], v[156:159]
M v[156:159], v[216:219], a[216:219], v[156:159]
s_waitcnt vmcnt(24) lgkmcnt(0)
s_barrier
M v[32:35], a[32:35], a[224:227], v[32:35]
s_add_u32 m0, s41, 81920
s_nop 0
buffer_load_dwordx4 v2, s[48:51], s26 offen offset:0 lds
M v[32:35], a[36:39], a[228:231], v[32:35]
M v[36:39], a[44:47], a[228:231], v[36:39]
ds_read_b64_tr_b16 v[160:161], v8 offset:32768
ds_read_b64_tr_b16 v[162:163], v8 offset:36864
M v[36:39], a[40:43], a[224:227], v[36:39]
M v[40:43], a[48:51], a[224:227], v[40:43]
buffer_load_dwordx4 v3, s[48:51], s26 offen offset:1024 lds
M v[40:43], a[52:55], a[228:231], v[40:43]
M v[44:47], a[60:63], a[228:231], v[44:47]
ds_read_b64_tr_b16 v[164:165], v8 offset:40960
ds_read_b64_tr_b16 v[166:167], v8 offset:45056
M v[44:47], a[56:59], a[224:227], v[44:47]
M v[48:51], a[64:67], a[224:227], v[48:51]
buffer_load_dwordx4 v4, s[48:51], s26 offen offset:2048 lds
M v[48:51], a[68:71], a[228:231], v[48:51]
M v[52:55], a[76:79], a[228:231], v[52:55]
ds_read_b64_tr_b16 v[168:169], v9 offset:32768
ds_read_b64_tr_b16 v[170:171], v9 offset:36864
M v[52:55], a[72:75], a[224:227], v[52:55]
M v[56:59], a[80:83], a[224:227], v[56:59]
buffer_load_dwordx4 v5, s[48:51], s26 offen offset:3072 lds
M v[56:59], a[84:87], a[228:231], v[56:59]
M v[60:63], a[92:95], a[228:231], v[60:63]
ds_read_b64_tr_b16 v[172:173], v9 offset:40960
ds_read_b64_tr_b16 v[174:175], v9 offset:45056
M v[60:63], a[88:91], a[224:227], v[60:63]
M v[64:67], a[32:35], a[232:235], v[64:67]
buffer_load_dwordx4 a[192:195], v1, s[44:47], s25 offen offset:0 sc1
M v[64:67], a[36:39], a[236:239], v[64:67]
M v[68:71], a[44:47], a[236:239], v[68:71]
ds_read_b64_tr_b16 v[176:177], v10 offset:32768
ds_read_b64_tr_b16 v[178:179], v10 offset:36864
M v[68:71], a[40:43], a[232:235], v[68:71]
M v[72:75], a[48:51], a[232:235], v[72:75]
buffer_load_dwordx4 a[196:199], v1, s[44:47], s25 offen offset:1024 sc1
M v[72:75], a[52:55], a[236:239], v[72:75]
M v[76:79], a[60:63], a[236:239], v[76:79]
ds_read_b64_tr_b16 v[180:181], v10 offset:40960
ds_read_b64_tr_b16 v[182:183], v10 offset:45056
M v[76:79], a[56:59], a[232:235], v[76:79]
M v[80:83], a[64:67], a[232:235], v[80:83]
buffer_load_dwordx4 a[200:203], v1, s[44:47], s25 offen offset:2048 sc1
M v[80:83], a[68:71], a[236:239], v[80:83]
M v[84:87], a[76:79], a[236:239], v[84:87]
ds_read_b64_tr_b16 v[184:185], v11 offset:32768
ds_read_b64_tr_b16 v[186:187], v11 offset:36864
M v[84:87], a[72:75], a[232:235], v[84:87]
M v[88:91], a[80:83], a[232:235], v[88:91]
buffer_load_dwordx4 a[204:207], v1, s[44:47], s25 offen offset:3072 sc1
M v[88:91], a[84:87], a[236:239], v[88:91]
M v[92:95], a[92:95], a[236:239], v[92:95]
M v[92:95], a[88:91], a[232:235], v[92:95]
ds_read_b64_tr_b16 v[188:189], v11 offset:40960
ds_read_b64_tr_b16 v[190:191], v11 offset:45056
M v[96:99], a[32:35], a[240:243], v[96:99]
M v[96:99], a[36:39], a[244:247], v[96:99]
s_add_u32 s63, s25, 4096
buffer_load_dwordx4 a[208:211], v1, s[44:47], s63 offen offset:0 sc1
M v[100:103], a[44:47], a[244:247], v[100:103]
M v[100:103], a[40:43], a[240:243], v[100:103]
ds_read_b64_tr_b16 v[192:193], v12 offset:32768
ds_read_b64_tr_b16 v[194:195], v12 offset:36864
M v[104:107], a[48:51], a[240:243], v[104:107]
M v[104:107], a[52:55], a[244:247], v[104:107]
buffer_load_dwordx4 a[212:215], v1, s[44:47], s63 offen offset:1024 sc1
M v[108:111], a[60:63], a[244:247], v[108:111]
M v[108:111], a[56:59], a[240:243], v[108:111]
ds_read_b64_tr_b16 v[196:197], v12 offset:40960
ds_read_b64_tr_b16 v[198:199], v12 offset:45056
M v[112:115], a[64:67], a[240:243], v[112:115]
M v[112:115], a[68:71], a[244:247], v[112:115]
buffer_load_dwordx4 a[216:219], v1, s[44:47], s63 offen offset:2048 sc1
M v[116:119], a[76:79], a[244:247], v[116:119]
M v[116:119], a[72:75], a[240:243], v[116:119]
ds_read_b64_tr_b16 v[200:201], v13 offset:32768
ds_read_b64_tr_b16 v[202:203], v13 offset:36864
M v[120:123], a[80:83], a[240:243], v[120:123]
M v[120:123], a[84:87], a[244:247], v[120:123]
buffer_load_dwordx4 a[220:223], v1, s[44:47], s63 offen offset:3072 sc1
M v[124:127], a[92:95], a[244:247], v[124:127]
M v[124:127], a[88:91], a[240:243], v[124:127]
ds_read_b64_tr_b16 v[204:205], v13 offset:40960
ds_read_b64_tr_b16 v[206:207], v13 offset:45056
M v[128:131], a[32:35], a[248:251], v[128:131]
M v[128:131], a[36:39], a[252:255], v[128:131]
s_sub_u32 s39, s39, 1
s_cmp_eq_u32 s39, 0
s_cselect_b32 s3, s64, s65
M v[132:135], a[44:47], a[252:255], v[132:135]
M v[132:135], a[40:43], a[248:251], v[132:135]
ds_read_b64_tr_b16 v[208:209], v14 offset:32768
ds_read_b64_tr_b16 v[210:211], v14 offset:36864
M v[136:139], a[48:51], a[248:251], v[136:139]
M v[136:139], a[52:55], a[252:255], v[136:139]
s_add_u32 s25, s25, s3
s_lshl_b32 s3, s3, 3
s_add_u32 s26, s26, s3
M v[140:143], a[60:63], a[252:255], v[140:143]
M v[140:143], a[56:59], a[248:251], v[140:143]
ds_read_b64_tr_b16 v[212:213], v14 offset:40960
ds_read_b64_tr_b16 v[214:215], v14 offset:45056
M v[144:147], a[64:67], a[248:251], v[144:147]
M v[144:147], a[68:71], a[252:255], v[144:147]
ds_read_b64_tr_b16 v[216:217], v15 offset:32768
ds_read_b64_tr_b16 v[218:219], v15 offset:36864
M v[148:151], a[76:79], a[252:255], v[148:151]
M v[148:151], a[72:75], a[248:251], v[148:151]
ds_read_b64_tr_b16 v[220:221], v15 offset:40960
ds_read_b64_tr_b16 v[222:223], v15 offset:45056
M v[152:155], a[80:83], a[248:251], v[152:155]
M v[152:155], a[84:87], a[252:255], v[152:155]
M v[156:159], a[92:95], a[252:255], v[156:159]
M v[156:159], a[88:91], a[248:251], v[156:159]
s_waitcnt vmcnt(24) lgkmcnt(0)
s_barrier
M v[32:35], v[160:163], a[96:99], v[32:35]
s_add_u32 m0, s41, 98304
s_nop 0
buffer_load_dwordx4 v2, s[48:51], s26 offen offset:0 lds
M v[32:35], v[164:167], a[100:103], v[32:35]
M v[36:39], v[172:175], a[100:103], v[36:39]
ds_read_b64_tr_b16 a[32:33], v8 offset:49152
ds_read_b64_tr_b16 a[34:35], v8 offset:53248
M v[36:39], v[168:171], a[96:99], v[36:39]
M v[40:43], v[176:179], a[96:99], v[40:43]
buffer_load_dwordx4 v3, s[48:51], s26 offen offset:1024 lds
M v[40:43], v[180:183], a[100:103], v[40:43]
M v[44:47], v[188:191], a[100:103], v[44:47]
ds_read_b64_tr_b16 a[36:37], v8 offset:57344
ds_read_b64_tr_b16 a[38:39], v8 offset:61440
M v[44:47], v[184:187], a[96:99], v[44:47]
M v[48:51], v[192:195], a[96:99], v[48:51]
buffer_load_dwordx4 v4, s[48:51], s26 offen offset:2048 lds
M v[48:51], v[196:199], a[100:103], v[48:51]
M v[52:55], v[204:207], a[100:103], v[52:55]
ds_read_b64_tr_b16 a[40:41], v9 offset:49152
ds_read_b64_tr_b16 a[42:43], v9 offset:53248
M v[52:55], v[200:203], a[96:99], v[52:55]
M v[56:59], v[208:211], a[96:99], v[56:59]
buffer_load_dwordx4 v5, s[48:51], s26 offen offset:3072 lds
M v[56:59], v[212:215], a[100:103], v[56:59]
M v[60:63], v[220:223], a[100:103], v[60:63]
ds_read_b64_tr_b16 a[44:45], v9 offset:57344
ds_read_b64_tr_b16 a[46:47], v9 offset:61440
M v[60:63], v[216:219], a[96:99], v[60:63]
M v[64:67], v[160:163], a[104:107], v[64:67]
buffer_load_dwordx4 a[224:227], v1, s[44:47], s25 offen offset:0 sc1
M v[64:67], v[164:167], a[108:111], v[64:67]
M v[68:71], v[172:175], a[108:111], v[68:71]
ds_read_b64_tr_b16 a[48:49], v10 offset:49152
ds_read_b64_tr_b16 a[50:51], v10 offset:53248
M v[68:71], v[168:171], a[104:107], v[68:71]
M v[72:75], v[176:179], a[104:107], v[72:75]
buffer_load_dwordx4 a[228:231], v1, s[44:47], s25 offen offset:1024 sc1
M v[72:75], v[180:183], a[108:111], v[72:75]
M v[76:79], v[188:191], a[108:111], v[76:79]
ds_read_b64_tr_b16 a[52:53], v10 offset:57344
ds_read_b64_tr_b16 a[54:55], v10 offset:61440
M v[76:79], v[184:187], a[104:107], v[76:79]
M v[80:83], v[192:195], a[104:107], v[80:83]
buffer_load_dwordx4 a[232:235], v1, s[44:47], s25 offen offset:2048 sc1
M v[80:83], v[196:199], a[108:111], v[80:83]
M v[84:87], v[204:207], a[108:111], v[84:87]
ds_read_b64_tr_b16 a[56:57], v11 offset:49152
ds_read_b64_tr_b16 a[58:59], v11 offset:53248
M v[84:87], v[200:203], a[104:107], v[84:87]
M v[88:91], v[208:211], a[104:107], v[88:91]
buffer_load_dwordx4 a[236:239], v1, s[44:47], s25 offen offset:3072 sc1
M v[88:91], v[212:215], a[108:111], v[88:91]
M v[92:95], v[220:223], a[108:111], v[92:95]
M v[92:95], v[216:219], a[104:107], v[92:95]
ds_read_b64_tr_b16 a[60:61], v11 offset:57344
ds_read_b64_tr_b16 a[62:63], v11 offset:61440
M v[96:99], v[160:163], a[112:115], v[96:99]
M v[96:99], v[164:167], a[116:119], v[96:99]
s_add_u32 s63, s25, 4096
buffer_load_dwordx4 a[240:243], v1, s[44:47], s63 offen offset:0 sc1
M v[100:103], v[172:175], a[116:119], v[100:103]
M v[100:103], v[168:171], a[112:115], v[100:103]
ds_read_b64_tr_b16 a[64:65], v12 offset:49152
ds_read_b64_tr_b16 a[66:67], v12 offset:53248
M v[104:107], v[176:179], a[112:115], v[104:107]
M v[104:107], v[180:183], a[116:119], v[104:107]
buffer_load_dwordx4 a[244:247], v1, s[44:47], s63 offen offset:1024 sc1
M v[108:111], v[188:191], a[116:119], v[108:111]
M v[108:111], v[184:187], a[112:115], v[108:111]
ds_read_b64_tr_b16 a[68:69], v12 offset:57344
ds_read_b64_tr_b16 a[70:71], v12 offset:61440
M v[112:115], v[192:195], a[112:115], v[112:115]
M v[112:115], v[196:199], a[116:119], v[112:115]
buffer_load_dwordx4 a[248:251], v1, s[44:47], s63 offen offset:2048 sc1
M v[116:119], v[204:207], a[116:119], v[116:119]
M v[116:119], v[200:203], a[112:115], v[116:119]
ds_read_b64_tr_b16 a[72:73], v13 offset:49152
ds_read_b64_tr_b16 a[74:75], v13 offset:53248
M v[120:123], v[208:211], a[112:115], v[120:123]
M v[120:123], v[212:215], a[116:119], v[120:123]
buffer_load_dwordx4 a[252:255], v1, s[44:47], s63 offen offset:3072 sc1
M v[124:127], v[220:223], a[116:119], v[124:127]
M v[124:127], v[216:219], a[112:115], v[124:127]
ds_read_b64_tr_b16 a[76:77], v13 offset:57344
ds_read_b64_tr_b16 a[78:79], v13 offset:61440
M v[128:131], v[160:163], a[120:123], v[128:131]
M v[128:131], v[164:167], a[124:127], v[128:131]
s_sub_u32 s39, s39, 1
s_cmp_eq_u32 s39, 0
s_cselect_b32 s3, s64, s65
M v[132:135], v[172:175], a[124:127], v[132:135]
M v[132:135], v[168:171], a[120:123], v[132:135]
ds_read_b64_tr_b16 a[80:81], v14 offset:49152
ds_read_b64_tr_b16 a[82:83], v14 offset:53248
M v[136:139], v[176:179], a[120:123], v[136:139]
M v[136:139], v[180:183], a[124:127], v[136:139]
s_add_u32 s25, s25, s3
s_lshl_b32 s3, s3, 3
s_add_u32 s26, s26, s3
M v[140:143], v[188:191], a[124:127], v[140:143]
M v[140:143], v[184:187], a[120:123], v[140:143]
ds_read_b64_tr_b16 a[84:85], v14 offset:57344
ds_read_b64_tr_b16 a[86:87], v14 offset:61440
M v[144:147], v[192:195], a[120:123], v[144:147]
M v[144:147], v[196:199], a[124:127], v[144:147]
ds_read_b64_tr_b16 a[88:89], v15 offset:49152
ds_read_b64_tr_b16 a[90:91], v15 offset:53248
M v[148:151], v[204:207], a[124:127], v[148:151]
M v[148:151], v[200:203], a[120:123], v[148:151]
ds_read_b64_tr_b16 a[92:93], v15 offset:57344
ds_read_b64_tr_b16 a[94:95], v15 offset:61440
M v[152:155], v[208:211], a[120:123], v[152:155]
M v[152:155], v[212:215], a[124:127], v[152:155]
M v[156:159], v[220:223], a[124:127], v[156:159]
M v[156:159], v[216:219], a[120:123], v[156:159]
s_waitcnt vmcnt(24) lgkmcnt(0)
s_barrier
M v[32:35], a[32:35], a[128:131], v[32:35]
s_add_u32 m0, s41, 114688
s_nop 0
buffer_load_dwordx4 v2, s[48:51], s26 offen offset:0 lds
M v[32:35], a[36:39], a[132:135], v[32:35]
M v[36:39], a[44:47], a[132:135], v[36:39]
ds_read_b64_tr_b16 v[160:161], v16 offset:0
ds_read_b64_tr_b16 v[162:163], v16 offset:4096
M v[36:39], a[40:43], a[128:131], v[36:39]
M v[40:43], a[48:51], a[128:131], v[40:43]
buffer_load_dwordx4 v3, s[48:51], s26 offen offset:1024 lds
M v[40:43], a[52:55], a[132:135], v[40:43]
M v[44:47], a[60:63], a[132:135], v[44:47]
ds_read_b64_tr_b16 v[164:165], v16 offset:8192
ds_read_b64_tr_b16 v[166:167], v16 offset:12288
M v[44:47], a[56:59], a[128:131], v[44:47]
M v[48:51], a[64:67], a[128:131], v[48:51]
buffer_load_dwordx4 v4, s[48:51], s26 offen offset:2048 lds
M v[48:51], a[68:71], a[132:135], v[48:51]
M v[52:55], a[76:79], a[132:135], v[52:55]
ds_read_b64_tr_b16 v[168:169], v17 offset:0
ds_read_b64_tr_b16 v[170:171], v17 offset:4096
M v[52:55], a[72:75], a[128:131], v[52:55]
M v[56:59], a[80:83], a[128:131], v[56:59]
buffer_load_dwordx4 v5, s[48:51], s26 offen offset:3072 lds
M v[56:59], a[84:87], a[132:135], v[56:59]
M v[60:63], a[92:95], a[132:135], v[60:63]
ds_read_b64_tr_b16 v[172:173], v17 offset:8192
ds_read_b64_tr_b16 v[174:175], v17 offset:12288
M v[60:63], a[88:91], a[128:131], v[60:63]
M v[64:67], a[32:35], a[136:139], v[64:67]
buffer_load_dwordx4 a[96:99], v1, s[44:47], s25 offen offset:0 sc1
M v[64:67], a[36:39], a[140:143], v[64:67]
M v[68:71], a[44:47], a[140:143], v[68:71]
ds_read_b64_tr_b16 v[176:177], v18 offset:0
ds_read_b64_tr_b16 v[178:179], v18 offset:4096
M v[68:71], a[40:43], a[136:139], v[68:71]
M v[72:75], a[48:51], a[136:139], v[72:75]
buffer_load_dwordx4 a[100:103], v1, s[44:47], s25 offen offset:1024 sc1
M v[72:75], a[52:55], a[140:143], v[72:75]
M v[76:79], a[60:63], a[140:143], v[76:79]
ds_read_b64_tr_b16 v[180:181], v18 offset:8192
ds_read_b64_tr_b16 v[182:183], v18 offset:12288
M v[76:79], a[56:59], a[136:139], v[76:79]
M v[80:83], a[64:67], a[136:139], v[80:83]
buffer_load_dwordx4 a[104:107], v1, s[44:47], s25 offen offset:2048 sc1
M v[80:83], a[68:71], a[140:143], v[80:83]
M v[84:87], a[76:79], a[140:143], v[84:87]
ds_read_b64_tr_b16 v[184:185], v19 offset:0
ds_read_b64_tr_b16 v[186:187], v19 offset:4096
M v[84:87], a[72:75], a[136:139], v[84:87]
M v[88:91], a[80:83], a[136:139], v[88:91]
buffer_load_dwordx4 a[108:111], v1, s[44:47], s25 offen offset:3072 sc1
M v[88:91], a[84:87], a[140:143], v[88:91]
M v[92:95], a[92:95], a[140:143], v[92:95]
M v[92:95], a[88:91], a[136:139], v[92:95]
ds_read_b64_tr_b16 v[188:189], v19 offset:8192
ds_read_b64_tr_b16 v[190:191], v19 offset:12288
M v[96:99], a[32:35], a[144:147], v[96:99]
M v[96:99], a[36:39], a[148:151], v[96:99]
s_add_u32 s63, s25, 4096
buffer_load_dwordx4 a[112:115], v1, s[44:47], s63 offen offset:0 sc1
M v[100:103], a[44:47], a[148:151], v[100:103]
M v[100:103], a[40:43], a[144:147], v[100:103]
ds_read_b64_tr_b16 v[192:193], v20 offset:0
ds_read_b64_tr_b16 v[194:195], v20 offset:4096
M v[104:107], a[48:51], a[144:147], v[104:107]
M v[104:107], a[52:55], a[148:151], v[104:107]
buffer_load_dwordx4 a[116:119], v1, s[44:47], s63 offen offset:1024 sc1
M v[108:111], a[60:63], a[148:151], v[108:111]
M v[108:111], a[56:59], a[144:147], v[108:111]
ds_read_b64_tr_b16 v[196:197], v20 offset:8192
ds_read_b64_tr_b16 v[198:199], v20 offset:12288
M v[112:115], a[64:67], a[144:147], v[112:115]
M v[112:115], a[68:71], a[148:151], v[112:115]
buffer_load_dwordx4 a[120:123], v1, s[44:47], s63 offen offset:2048 sc1
M v[116:119], a[76:79], a[148:151], v[116:119]
M v[116:119], a[72:75], a[144:147], v[116:119]
ds_read_b64_tr_b16 v[200:201], v21 offset:0
ds_read_b64_tr_b16 v[202:203], v21 offset:4096
M v[120:123], a[80:83], a[144:147], v[120:123]
M v[120:123], a[84:87], a[148:151], v[120:123]
buffer_load_dwordx4 a[124:127], v1, s[44:47], s63 offen offset:3072 sc1
M v[124:127], a[92:95], a[148:151], v[124:127]
M v[124:127], a[88:91], a[144:147], v[124:127]
ds_read_b64_tr_b16 v[204:205], v21 offset:8192
ds_read_b64_tr_b16 v[206:207], v21 offset:12288
M v[128:131], a[32:35], a[152:155], v[128:131]
M v[128:131], a[36:39], a[156:159], v[128:131]
s_sub_u32 s39, s39, 1
s_cmp_eq_u32 s39, 0
s_cselect_b32 s3, s64, s65
M v[132:135], a[44:47], a[156:159], v[132:135]
M v[132:135], a[40:43], a[152:155], v[132:135]
ds_read_b64_tr_b16 v[208:209], v22 offset:0
ds_read_b64_tr_b16 v[210:211], v22 offset:4096
M v[136:139], a[48:51], a[152:155], v[136:139]
M v[136:139], a[52:55], a[156:159], v[136:139]
s_add_u32 s25, s25, s3
s_lshl_b32 s3, s3, 3
s_add_u32 s26, s26, s3
M v[140:143], a[60:63], a[156:159], v[140:143]
M v[140:143], a[56:59], a[152:155], v[140:143]
ds_read_b64_tr_b16 v[212:213], v22 offset:8192
ds_read_b64_tr_b16 v[214:215], v22 offset:12288
M v[144:147], a[64:67], a[152:155], v[144:147]
M v[144:147], a[68:71], a[156:159], v[144:147]
ds_read_b64_tr_b16 v[216:217], v23 offset:0
ds_read_b64_tr_b16 v[218:219], v23 offset:4096
M v[148:151], a[76:79], a[156:159], v[148:151]
M v[148:151], a[72:75], a[152:155], v[148:151]
ds_read_b64_tr_b16 v[220:221], v23 offset:8192
ds_read_b64_tr_b16 v[222:223], v23 offset:12288
M v[152:155], a[80:83], a[152:155], v[152:155]
M v[152:155], a[84:87], a[156:159], v[152:155]
M v[156:159], a[92:95], a[156:159], v[156:159]
M v[156:159], a[88:91], a[152:155], v[156:159]
s_waitcnt vmcnt(24) lgkmcnt(0)
s_barrier
M v[32:35], v[160:163], a[160:163], v[32:35]
s_mov_b64 s[44:45], s[34:35]
s_mov_b32 s46, 4194304
s_mov_b64 s[48:49], s[36:37]
s_mov_b32 s50, 2097152
s_mov_b32 s25, s32
s_mov_b32 s26, s33
s_add_u32 m0, s42, 0
s_nop 0
buffer_load_dwordx4 v6, s[48:51], s26 offen offset:0 lds
M v[32:35], v[164:167], a[164:167], v[32:35]
M v[36:39], v[172:175], a[164:167], v[36:39]
ds_read_b64_tr_b16 a[32:33], v16 offset:16384
ds_read_b64_tr_b16 a[34:35], v16 offset:20480
M v[36:39], v[168:171], a[160:163], v[36:39]
M v[40:43], v[176:179], a[160:163], v[40:43]
M v[40:43], v[180:183], a[164:167], v[40:43]
buffer_load_dwordx4 v7, s[48:51], s26 offen offset:1024 lds
M v[44:47], v[188:191], a[164:167], v[44:47]
M v[44:47], v[184:187], a[160:163], v[44:47]
M v[48:51], v[192:195], a[160:163], v[48:51]
ds_read_b64_tr_b16 a[36:37], v16 offset:24576
ds_read_b64_tr_b16 a[38:39], v16 offset:28672
M v[48:51], v[196:199], a[164:167], v[48:51]
M v[52:55], v[204:207], a[164:167], v[52:55]
buffer_load_dwordx4 a[128:131], v1, s[44:47], s25 offen offset:0 sc1
M v[52:55], v[200:203], a[160:163], v[52:55]
M v[56:59], v[208:211], a[160:163], v[56:59]
M v[56:59], v[212:215], a[164:167], v[56:59]
ds_read_b64_tr_b16 a[40:41], v17 offset:16384
ds_read_b64_tr_b16 a[42:43], v17 offset:20480
M v[60:63], v[220:223], a[164:167], v[60:63]
M v[60:63], v[216:219], a[160:163], v[60:63]
M v[64:67], v[160:163], a[168:171], v[64:67]
buffer_load_dwordx4 a[132:135], v1, s[44:47], s25 offen offset:1024 sc1
M v[64:67], v[164:167], a[172:175], v[64:67]
M v[68:71], v[172:175], a[172:175], v[68:71]
ds_read_b64_tr_b16 a[44:45], v17 offset:24576
ds_read_b64_tr_b16 a[46:47], v17 offset:28672
M v[68:71], v[168:171], a[168:171], v[68:71]
M v[72:75], v[176:179], a[168:171], v[72:75]
M v[72:75], v[180:183], a[172:175], v[72:75]
buffer_load_dwordx4 a[136:139], v1, s[44:47], s25 offen offset:2048 sc1
M v[76:79], v[188:191], a[172:175], v[76:79]
M v[76:79], v[184:187], a[168:171], v[76:79]
M v[80:83], v[192:195], a[168:171], v[80:83]
ds_read_b64_tr_b16 a[48:49], v18 offset:16384
ds_read_b64_tr_b16 a[50:51], v18 offset:20480
M v[80:83], v[196:199], a[172:175], v[80:83]
M v[84:87], v[204:207], a[172:175], v[84:87]
buffer_load_dwordx4 a[140:143], v1, s[44:47], s25 offen offset:3072 sc1
M v[84:87], v[200:203], a[168:171], v[84:87]
M v[88:91], v[208:211], a[168:171], v[88:91]
M v[88:91], v[212:215], a[172:175], v[88:91]
ds_read_b64_tr_b16 a[52:53], v18 offset:24576
ds_read_b64_tr_b16 a[54:55], v18 offset:28672
M v[92:95], v[220:223], a[172:175], v[92:95]
M v[92:95], v[216:219], a[168:171], v[92:95]
M v[96:99], v[160:163], a[176:179], v[96:99]
s_add_u32 s25, s25, 16384
s_add_u32 s26, s26, 131072
M v[96:99], v[164:167], a[180:183], v[96:99]
M v[100:103], v[172:175], a[180:183], v[100:103]
M v[100:103], v[168:171], a[176:179], v[100:103]
ds_read_b64_tr_b16 a[56:57], v19 offset:16384
ds_read_b64_tr_b16 a[58:59], v19 offset:20480
M v[104:107], v[176:179], a[176:179], v[104:107]
M v[104:107], v[180:183], a[180:183], v[104:107]
ds_read_b64_tr_b16 a[60:61], v19 offset:24576
ds_read_b64_tr_b16 a[62:63], v19 offset:28672
M v[108:111], v[188:191], a[180:183], v[108:111]
M v[108:111], v[184:187], a[176:179], v[108:111]
M v[112:115], v[192:195], a[176:179], v[112:115]
ds_read_b64_tr_b16 a[64:65], v20 offset:16384
ds_read_b64_tr_b16 a[66:67], v20 offset:20480
M v[112:115], v[196:199], a[180:183], v[112:115]
M v[116:119], v[204:207], a[180:183], v[116:119]
M v[116:119], v[200:203], a[176:179], v[116:119]
ds_read_b64_tr_b16 a[68:69], v20 offset:24576
ds_read_b64_tr_b16 a[70:71], v20 offset:28672
M v[120:123], v[208:211], a[176:179], v[120:123]
M v[120:123], v[212:215], a[180:183], v[120:123]
ds_read_b64_tr_b16 a[72:73], v21 offset:16384
ds_read_b64_tr_b16 a[74:75], v21 offset:20480
M v[124:127], v[220:223], a[180:183], v[124:127]
M v[124:127], v[216:219], a[176:179], v[124:127]
M v[128:131], v[160:163], a[184:187], v[128:131]
ds_read_b64_tr_b16 a[76:77], v21 offset:24576
ds_read_b64_tr_b16 a[78:79], v21 offset:28672
M v[128:131], v[164:167], a[188:191], v[128:131]
M v[132:135], v[172:175], a[188:191], v[132:135]
M v[132:135], v[168:171], a[184:187], v[132:135]
ds_read_b64_tr_b16 a[80:81], v22 offset:16384
ds_read_b64_tr_b16 a[82:83], v22 offset:20480
M v[136:139], v[176:179], a[184:187], v[136:139]
M v[136:139], v[180:183], a[188:191], v[136:139]
ds_read_b64_tr_b16 a[84:85], v22 offset:24576
ds_read_b64_tr_b16 a[86:87], v22 offset:28672
M v[140:143], v[188:191], a[188:191], v[140:143]
M v[140:143], v[184:187], a[184:187], v[140:143]
M v[144:147], v[192:195], a[184:187], v[144:147]
ds_read_b64_tr_b16 a[88:89], v23 offset:16384
ds_read_b64_tr_b16 a[90:91], v23 offset:20480
M v[144:147], v[196:199], a[188:191], v[144:147]
M v[148:151], v[204:207], a[188:191], v[148:151]
M v[148:151], v[200:203], a[184:187], v[148:151]
ds_read_b64_tr_b16 a[92:93], v23 offset:24576
ds_read_b64_tr_b16 a[94:95], v23 offset:28672
M v[152:155], v[208:211], a[184:187], v[152:155]
M v[152:155], v[212:215], a[188:191], v[152:155]
M v[156:159], v[220:223], a[188:191], v[156:159]
M v[156:159], v[216:219], a[184:187], v[156:159]
s_waitcnt vmcnt(18) lgkmcnt(0)
s_barrier
M v[32:35], a[32:35], a[192:195], v[32:35]
s_add_u32 m0, s42, 16384
s_nop 0
buffer_load_dwordx4 v6, s[48:51], s26 offen offset:0 lds
M v[32:35], a[36:39], a[196:199], v[32:35]
M v[36:39], a[44:47], a[196:199], v[36:39]
ds_read_b64_tr_b16 v[160:161], v16 offset:32768
ds_read_b64_tr_b16 v[162:163], v16 offset:36864
M v[36:39], a[40:43], a[192:195], v[36:39]
M v[40:43], a[48:51], a[192:195], v[40:43]
M v[40:43], a[52:55], a[196:199], v[40:43]
buffer_load_dwordx4 v7, s[48:51], s26 offen offset:1024 lds
M v[44:47], a[60:63], a[196:199], v[44:47]
M v[44:47], a[56:59], a[192:195], v[44:47]
M v[48:51], a[64:67], a[192:195], v[48:51]
ds_read_b64_tr_b16 v[164:165], v16 offset:40960
ds_read_b64_tr_b16 v[166:167], v16 offset:45056
M v[48:51], a[68:71], a[196:199], v[48:51]
M v[52:55], a[76:79], a[196:199], v[52:55]
buffer_load_dwordx4 a[160:163], v1, s[44:47], s25 offen offset:0 sc1
M v[52:55], a[72:75], a[192:195], v[52:55]
M v[56:59], a[80:83], a[192:195], v[56:59]
M v[56:59], a[84:87], a[196:199], v[56:59]
ds_read_b64_tr_b16 v[168:169], v17 offset:32768
ds_read_b64_tr_b16 v[170:171], v17 offset:36864
M v[60:63], a[92:95], a[196:199], v[60:63]
M v[60:63], a[88:91], a[192:195], v[60:63]
M v[64:67], a[32:35], a[200:203], v[64:67]
buffer_load_dwordx4 a[164:167], v1, s[44:47], s25 offen offset:1024 sc1
M v[64:67], a[36:39], a[204:207], v[64:67]
M v[68:71], a[44:47], a[204:207], v[68:71]
ds_read_b64_tr_b16 v[172:173], v17 offset:40960
ds_read_b64_tr_b16 v[174:175], v17 offset:45056
M v[68:71], a[40:43], a[200:203], v[68:71]
M v[72:75], a[48:51], a[200:203], v[72:75]
M v[72:75], a[52:55], a[204:207], v[72:75]
buffer_load_dwordx4 a[168:171], v1, s[44:47], s25 offen offset:2048 sc1
M v[76:79], a[60:63], a[204:207], v[76:79]
M v[76:79], a[56:59], a[200:203], v[76:79]
M v[80:83], a[64:67], a[200:203], v[80:83]
ds_read_b64_tr_b16 v[176:177], v18 offset:32768
ds_read_b64_tr_b16 v[178:179], v18 offset:36864
M v[80:83], a[68:71], a[204:207], v[80:83]
M v[84:87], a[76:79], a[204:207], v[84:87]
buffer_load_dwordx4 a[172:175], v1, s[44:47], s25 offen offset:3072 sc1
M v[84:87], a[72:75], a[200:203], v[84:87]
M v[88:91], a[80:83], a[200:203], v[88:91]
M v[88:91], a[84:87], a[204:207], v[88:91]
ds_read_b64_tr_b16 v[180:181], v18 offset:40960
ds_read_b64_tr_b16 v[182:183], v18 offset:45056
M v[92:95], a[92:95], a[204:207], v[92:95]
M v[92:95], a[88:91], a[200:203], v[92:95]
M v[96:99], a[32:35], a[208:211], v[96:99]
s_add_u32 s25, s25, 16384
s_add_u32 s26, s26, 131072
M v[96:99], a[36:39], a[212:215], v[96:99]
M v[100:103], a[44:47], a[212:215], v[100:103]
M v[100:103], a[40:43], a[208:211], v[100:103]
ds_read_b64_tr_b16 v[184:185], v19 offset:32768
ds_read_b64_tr_b16 v[186:187], v19 offset:36864
M v[104:107], a[48:51], a[208:211], v[104:107]
M v[104:107], a[52:55], a[212:215], v[104:107]
ds_read_b64_tr_b16 v[188:189], v19 offset:40960
ds_read_b64_tr_b16 v[190:191], v19 offset:45056
M v[108:111], a[60:63], a[212:215], v[108:111]
M v[108:111], a[56:59], a[208:211], v[108:111]
M v[112:115], a[64:67], a[208:211], v[112:115]
ds_read_b64_tr_b16 v[192:193], v20 offset:32768
ds_read_b64_tr_b16 v[194:195], v20 offset:36864
M v[112:115], a[68:71], a[212:215], v[112:115]
M v[116:119], a[76:79], a[212:215], v[116:119]
M v[116:119], a[72:75], a[208:211], v[116:119]
ds_read_b64_tr_b16 v[196:197], v20 offset:40960
ds_read_b64_tr_b16 v[198:199], v20 offset:45056
M v[120:123], a[80:83], a[208:211], v[120:123]
M v[120:123], a[84:87], a[212:215], v[120:123]
ds_read_b64_tr_b16 v[200:201], v21 offset:32768
ds_read_b64_tr_b16 v[202:203], v21 offset:36864
M v[124:127], a[92:95], a[212:215], v[124:127]
M v[124:127], a[88:91], a[208:211], v[124:127]
M v[128:131], a[32:35], a[216:219], v[128:131]
ds_read_b64_tr_b16 v[204:205], v21 offset:40960
ds_read_b64_tr_b16 v[206:207], v21 offset:45056
M v[128:131], a[36:39], a[220:223], v[128:131]
M v[132:135], a[44:47], a[220:223], v[132:135]
M v[132:135], a[40:43], a[216:219], v[132:135]
ds_read_b64_tr_b16 v[208:209], v22 offset:32768
ds_read_b64_tr_b16 v[210:211], v22 offset:36864
M v[136:139], a[48:51], a[216:219], v[136:139]
M v[136:139], a[52:55], a[220:223], v[136:139]
ds_read_b64_tr_b16 v[212:213], v22 offset:40960
ds_read_b64_tr_b16 v[214:215], v22 offset:45056
M v[140:143], a[60:63], a[220:223], v[140:143]
M v[140:143], a[56:59], a[216:219], v[140:143]
M v[144:147], a[64:67], a[216:219], v[144:147]
ds_read_b64_tr_b16 v[216:217], v23 offset:32768
ds_read_b64_tr_b16 v[218:219], v23 offset:36864
M v[144:147], a[68:71], a[220:223], v[144:147]
M v[148:151], a[76:79], a[220:223], v[148:151]
M v[148:151], a[72:75], a[216:219], v[148:151]
ds_read_b64_tr_b16 v[220:221], v23 offset:40960
ds_read_b64_tr_b16 v[222:223], v23 offset:45056
M v[152:155], a[80:83], a[216:219], v[152:155]
M v[152:155], a[84:87], a[220:223], v[152:155]
M v[156:159], a[92:95], a[220:223], v[156:159]
M v[156:159], a[88:91], a[216:219], v[156:159]
s_waitcnt vmcnt(12) lgkmcnt(0)
s_barrier
M v[32:35], v[160:163], a[224:227], v[32:35]
s_add_u32 m0, s42, 32768
s_nop 0
buffer_load_dwordx4 v6, s[48:51], s26 offen offset:0 lds
M v[32:35], v[164:167], a[228:231], v[32:35]
M v[36:39], v[172:175], a[228:231], v[36:39]
ds_read_b64_tr_b16 a[32:33], v16 offset:49152
ds_read_b64_tr_b16 a[34:35], v16 offset:53248
M v[36:39], v[168:171], a[224:227], v[36:39]
M v[40:43], v[176:179], a[224:227], v[40:43]
M v[40:43], v[180:183], a[228:231], v[40:43]
buffer_load_dwordx4 v7, s[48:51], s26 offen offset:1024 lds
M v[44:47], v[188:191], a[228:231], v[44:47]
M v[44:47], v[184:187], a[224:227], v[44:47]
M v[48:51], v[192:195], a[224:227], v[48:51]
ds_read_b64_tr_b16 a[36:37], v16 offset:57344
ds_read_b64_tr_b16 a[38:39], v16 offset:61440
M v[48:51], v[196:199], a[228:231], v[48:51]
M v[52:55], v[204:207], a[228:231], v[52:55]
buffer_load_dwordx4 a[192:195], v1, s[44:47], s25 offen offset:0 sc1
M v[52:55], v[200:203], a[224:227], v[52:55]
M v[56:59], v[208:211], a[224:227], v[56:59]
M v[56:59], v[212:215], a[228:231], v[56:59]
ds_read_b64_tr_b16 a[40:41], v17 offset:49152
ds_read_b64_tr_b16 a[42:43], v17 offset:53248
M v[60:63], v[220:223], a[228:231], v[60:63]
M v[60:63], v[216:219], a[224:227], v[60:63]
M v[64:67], v[160:163], a[232:235], v[64:67]
buffer_load_dwordx4 a[196:199], v1, s[44:47], s25 offen offset:1024 sc1
M v[64:67], v[164:167], a[236:239], v[64:67]
M v[68:71], v[172:175], a[236:239], v[68:71]
ds_read_b64_tr_b16 a[44:45], v17 offset:57344
ds_read_b64_tr_b16 a[46:47], v17 offset:61440
M v[68:71], v[168:171], a[232:235], v[68:71]
M v[72:75], v[176:179], a[232:235], v[72:75]
M v[72:75], v[180:183], a[236:239], v[72:75]
buffer_load_dwordx4 a[200:203], v1, s[44:47], s25 offen offset:2048 sc1
M v[76:79], v[188:191], a[236:239], v[76:79]
M v[76:79], v[184:187], a[232:235], v[76:79]
M v[80:83], v[192:195], a[232:235], v[80:83]
ds_read_b64_tr_b16 a[48:49], v18 offset:49152
ds_read_b64_tr_b16 a[50:51], v18 offset:53248
M v[80:83], v[196:199], a[236:239], v[80:83]
M v[84:87], v[204:207], a[236:239], v[84:87]
buffer_load_dwordx4 a[204:207], v1, s[44:47], s25 offen offset:3072 sc1
M v[84:87], v[200:203], a[232:235], v[84:87]
M v[88:91], v[208:211], a[232:235], v[88:91]
M v[88:91], v[212:215], a[236:239], v[88:91]
ds_read_b64_tr_b16 a[52:53], v18 offset:57344
ds_read_b64_tr_b16 a[54:55], v18 offset:61440
M v[92:95], v[220:223], a[236:239], v[92:95]
M v[92:95], v[216:219], a[232:235], v[92:95]
M v[96:99], v[160:163], a[240:243], v[96:99]
s_add_u32 s25, s25, 16384
s_add_u32 s26, s26, 131072
M v[96:99], v[164:167], a[244:247], v[96:99]
M v[100:103], v[172:175], a[244:247], v[100:103]
M v[100:103], v[168:171], a[240:243], v[100:103]
ds_read_b64_tr_b16 a[56:57], v19 offset:49152
ds_read_b64_tr_b16 a[58:59], v19 offset:53248
M v[104:107], v[176:179], a[240:243], v[104:107]
M v[104:107], v[180:183], a[244:247], v[104:107]
ds_read_b64_tr_b16 a[60:61], v19 offset:57344
ds_read_b64_tr_b16 a[62:63], v19 offset:61440
M v[108:111], v[188:191], a[244:247], v[108:111]
M v[108:111], v[184:187], a[240:243], v[108:111]
M v[112:115], v[192:195], a[240:243], v[112:115]
ds_read_b64_tr_b16 a[64:65], v20 offset:49152
ds_read_b64_tr_b16 a[66:67], v20 offset:53248
M v[112:115], v[196:199], a[244:247], v[112:115]
M v[116:119], v[204:207], a[244:247], v[116:119]
M v[116:119], v[200:203], a[240:243], v[116:119]
ds_read_b64_tr_b16 a[68:69], v20 offset:57344
ds_read_b64_tr_b16 a[70:71], v20 offset:61440
M v[120:123], v[208:211], a[240:243], v[120:123]
M v[120:123], v[212:215], a[244:247], v[120:123]
ds_read_b64_tr_b16 a[72:73], v21 offset:49152
ds_read_b64_tr_b16 a[74:75], v21 offset:53248
M v[124:127], v[220:223], a[244:247], v[124:127]
M v[124:127], v[216:219], a[240:243], v[124:127]
M v[128:131], v[160:163], a[248:251], v[128:131]
ds_read_b64_tr_b16 a[76:77], v21 offset:57344
ds_read_b64_tr_b16 a[78:79], v21 offset:61440
M v[128:131], v[164:167], a[252:255], v[128:131]
M v[132:135], v[172:175], a[252:255], v[132:135]
M v[132:135], v[168:171], a[248:251], v[132:135]
ds_read_b64_tr_b16 a[80:81], v22 offset:49152
ds_read_b64_tr_b16 a[82:83], v22 offset:53248
M v[136:139], v[176:179], a[248:251], v[136:139]
M v[136:139], v[180:183], a[252:255], v[136:139]
ds_read_b64_tr_b16 a[84:85], v22 offset:57344
ds_read_b64_tr_b16 a[86:87], v22 offset:61440
M v[140:143], v[188:191], a[252:255], v[140:143]
M v[140:143], v[184:187], a[248:251], v[140:143]
M v[144:147], v[192:195], a[248:251], v[144:147]
ds_read_b64_tr_b16 a[88:89], v23 offset:49152
ds_read_b64_tr_b16 a[90:91], v23 offset:53248
M v[144:147], v[196:199], a[252:255], v[144:147]
M v[148:151], v[204:207], a[252:255], v[148:151]
M v[148:151], v[200:203], a[248:251], v[148:151]
ds_read_b64_tr_b16 a[92:93], v23 offset:57344
ds_read_b64_tr_b16 a[94:95], v23 offset:61440
M v[152:155], v[208:211], a[248:251], v[152:155]
M v[152:155], v[212:215], a[252:255], v[152:155]
M v[156:159], v[220:223], a[252:255], v[156:159]
M v[156:159], v[216:219], a[248:251], v[156:159]
s_waitcnt vmcnt(12) lgkmcnt(0)
s_barrier
M v[32:35], a[32:35], a[96:99], v[32:35]
s_add_u32 m0, s42, 49152
s_nop 0
buffer_load_dwordx4 v6, s[48:51], s26 offen offset:0 lds
M v[32:35], a[36:39], a[100:103], v[32:35]
M v[36:39], a[44:47], a[100:103], v[36:39]
M v[36:39], a[40:43], a[96:99], v[36:39]
M v[40:43], a[48:51], a[96:99], v[40:43]
ds_read_b64_tr_b16 v[160:161], v24 offset:0
ds_read_b64_tr_b16 v[162:163], v24 offset:2048
M v[40:43], a[52:55], a[100:103], v[40:43]
M v[44:47], a[60:63], a[100:103], v[44:47]
M v[44:47], a[56:59], a[96:99], v[44:47]
M v[48:51], a[64:67], a[96:99], v[48:51]
buffer_load_dwordx4 v7, s[48:51], s26 offen offset:1024 lds
M v[48:51], a[68:71], a[100:103], v[48:51]
M v[52:55], a[76:79], a[100:103], v[52:55]
M v[52:55], a[72:75], a[96:99], v[52:55]
M v[56:59], a[80:83], a[96:99], v[56:59]
ds_read_b64_tr_b16 v[164:165], v24 offset:4096
ds_read_b64_tr_b16 v[166:167], v24 offset:6144
M v[56:59], a[84:87], a[100:103], v[56:59]
M v[60:63], a[92:95], a[100:103], v[60:63]
M v[60:63], a[88:91], a[96:99], v[60:63]
M v[64:67], a[32:35], a[104:107], v[64:67]
buffer_load_dwordx4 a[224:227], v1, s[44:47], s25 offen offset:0 sc1
M v[64:67], a[36:39], a[108:111], v[64:67]
M v[68:71], a[44:47], a[108:111], v[68:71]
v_cvt_pk_bf16_f32 v40, v40, v41
v_cvt_pk_bf16_f32 v41, v42, v43
M v[68:71], a[40:43], a[104:107], v[68:71]
v_cvt_pk_bf16_f32 v42, v44, v45
v_cvt_pk_bf16_f32 v43, v46, v47
M v[72:75], a[48:51], a[104:107], v[72:75]
ds_read_b64_tr_b16 v[168:169], v25 offset:0
ds_read_b64_tr_b16 v[170:171], v25 offset:2048
M v[72:75], a[52:55], a[108:111], v[72:75]
s_add_u32 s60, s56, 4096
buffer_store_dwordx4 v[40:43], v1, s[52:55], s60 offen offset:0 sc1
M v[76:79], a[60:63], a[108:111], v[76:79]
M v[76:79], a[56:59], a[104:107], v[76:79]
v_cvt_pk_bf16_f32 v48, v48, v49
v_cvt_pk_bf16_f32 v49, v50, v51
M v[80:83], a[64:67], a[104:107], v[80:83]
buffer_load_dwordx4 a[228:231], v1, s[44:47], s25 offen offset:1024 sc1
v_cvt_pk_bf16_f32 v50, v52, v53
v_cvt_pk_bf16_f32 v51, v54, v55
M v[80:83], a[68:71], a[108:111], v[80:83]
M v[84:87], a[76:79], a[108:111], v[84:87]
s_add_u32 s60, s56, 8192
buffer_store_dwordx4 v[48:51], v1, s[52:55], s60 offen offset:0 sc1
M v[84:87], a[72:75], a[104:107], v[84:87]
M v[88:91], a[80:83], a[104:107], v[88:91]
ds_read_b64_tr_b16 v[172:173], v25 offset:4096
ds_read_b64_tr_b16 v[174:175], v25 offset:6144
v_cvt_pk_bf16_f32 v56, v56, v57
v_cvt_pk_bf16_f32 v57, v58, v59
M v[88:91], a[84:87], a[108:111], v[88:91]
v_cvt_pk_bf16_f32 v58, v60, v61
v_cvt_pk_bf16_f32 v59, v62, v63
M v[92:95], a[92:95], a[108:111], v[92:95]
M v[92:95], a[88:91], a[104:107], v[92:95]
s_add_u32 s60, s56, 12288
buffer_store_dwordx4 v[56:59], v1, s[52:55], s60 offen offset:0 sc1
M v[96:99], a[32:35], a[112:115], v[96:99]
M v[96:99], a[36:39], a[116:119], v[96:99]
buffer_load_dwordx4 a[232:235], v1, s[44:47], s25 offen offset:2048 sc1
M v[100:103], a[44:47], a[116:119], v[100:103]
v_cvt_pk_bf16_f32 v72, v72, v73
v_cvt_pk_bf16_f32 v73, v74, v75
M v[100:103], a[40:43], a[112:115], v[100:103]
v_cvt_pk_bf16_f32 v74, v76, v77
v_cvt_pk_bf16_f32 v75, v78, v79
M v[104:107], a[48:51], a[112:115], v[104:107]
M v[104:107], a[52:55], a[116:119], v[104:107]
ds_read_b64_tr_b16 v[176:177], v26 offset:0
ds_read_b64_tr_b16 v[178:179], v26 offset:2048
s_add_u32 s60, s56, 4096
buffer_store_dwordx4 v[72:75], v1, s[52:55], s60 offen offset:1024 sc1
M v[108:111], a[60:63], a[116:119], v[108:111]
M v[108:111], a[56:59], a[112:115], v[108:111]
v_cvt_pk_bf16_f32 v80, v80, v81
v_cvt_pk_bf16_f32 v81, v82, v83
M v[112:115], a[64:67], a[112:115], v[112:115]
v_cvt_pk_bf16_f32 v82, v84, v85
v_cvt_pk_bf16_f32 v83, v86, v87
M v[112:115], a[68:71], a[116:119], v[112:115]
buffer_load_dwordx4 a[236:239], v1, s[44:47], s25 offen offset:3072 sc1
M v[116:119], a[76:79], a[116:119], v[116:119]
s_add_u32 s60, s56, 8192
buffer_store_dwordx4 v[80:83], v1, s[52:55], s60 offen offset:1024 sc1
M v[116:119], a[72:75], a[112:115], v[116:119]
M v[120:123], a[80:83], a[112:115], v[120:123]
v_cvt_pk_bf16_f32 v88, v88, v89
v_cvt_pk_bf16_f32 v89, v90, v91
M v[120:123], a[84:87], a[116:119], v[120:123]
ds_read_b64_tr_b16 v[180:181], v26 offset:4096
ds_read_b64_tr_b16 v[182:183], v26 offset:6144
v_cvt_pk_bf16_f32 v90, v92, v93
v_cvt_pk_bf16_f32 v91, v94, v95
M v[124:127], a[92:95], a[116:119], v[124:127]
M v[124:127], a[88:91], a[112:115], v[124:127]
s_add_u32 s60, s56, 12288
buffer_store_dwordx4 v[88:91], v1, s[52:55], s60 offen offset:1024 sc1
M v[128:131], a[32:35], a[120:123], v[128:131]
M v[128:131], a[36:39], a[124:127], v[128:131]
s_add_u32 s25, s25, 16384
s_add_u32 s26, s26, 131072
M v[132:135], a[44:47], a[124:127], v[132:135]
v_cvt_pk_bf16_f32 v104, v104, v105
v_cvt_pk_bf16_f32 v105, v106, v107
M v[132:135], a[40:43], a[120:123], v[132:135]
v_cvt_pk_bf16_f32 v106, v108, v109
v_cvt_pk_bf16_f32 v107, v110, v111
M v[136:139], a[48:51], a[120:123], v[136:139]
M v[136:139], a[52:55], a[124:127], v[136:139]
ds_read_b64_tr_b16 v[184:185], v27 offset:0
ds_read_b64_tr_b16 v[186:187], v27 offset:2048
s_add_u32 s60, s56, 4096
buffer_store_dwordx4 v[104:107], v1, s[52:55], s60 offen offset:2048 sc1
M v[140:143], a[60:63], a[124:127], v[140:143]
M v[140:143], a[56:59], a[120:123], v[140:143]
v_cvt_pk_bf16_f32 v112, v112, v113
v_cvt_pk_bf16_f32 v113, v114, v115
M v[144:147], a[64:67], a[120:123], v[144:147]
v_cvt_pk_bf16_f32 v114, v116, v117
v_cvt_pk_bf16_f32 v115, v118, v119
M v[144:147], a[68:71], a[124:127], v[144:147]
ds_read_b64_tr_b16 v[188:189], v27 offset:4096
ds_read_b64_tr_b16 v[190:191], v27 offset:6144
M v[148:151], a[76:79], a[124:127], v[148:151]
s_add_u32 s60, s56, 8192
buffer_store_dwordx4 v[112:115], v1, s[52:55], s60 offen offset:2048 sc1
M v[148:151], a[72:75], a[120:123], v[148:151]
M v[152:155], a[80:83], a[120:123], v[152:155]
v_cvt_pk_bf16_f32 v120, v120, v121
v_cvt_pk_bf16_f32 v121, v122, v123
M v[152:155], a[84:87], a[124:127], v[152:155]
v_cvt_pk_bf16_f32 v122, v124, v125
v_cvt_pk_bf16_f32 v123, v126, v127
M v[156:159], a[92:95], a[124:127], v[156:159]
M v[156:159], a[88:91], a[120:123], v[156:159]
s_add_u32 s60, s56, 12288
buffer_store_dwordx4 v[120:123], v1, s[52:55], s60 offen offset:2048 sc1
s_waitcnt vmcnt(21) lgkmcnt(0)
s_barrier
M a[0:3], v[160:163], a[128:131], a[0:3]
s_add_u32 m0, s42, 65536
s_nop 0
buffer_load_dwordx4 v6, s[48:51], s26 offen offset:0 lds
ds_read_b64_tr_b16 a[32:33], v24 offset:16384
ds_read_b64_tr_b16 a[34:35], v24 offset:18432
M a[0:3], v[164:167], a[132:135], a[0:3]
buffer_load_dwordx4 v7, s[48:51], s26 offen offset:1024 lds
M a[4:7], v[172:175], a[132:135], a[4:7]
ds_read_b64_tr_b16 a[36:37], v24 offset:20480
ds_read_b64_tr_b16 a[38:39], v24 offset:22528
buffer_load_dwordx4 a[96:99], v1, s[44:47], s25 offen offset:0 sc1
M a[4:7], v[168:171], a[128:131], a[4:7]
ds_read_b64_tr_b16 a[40:41], v25 offset:16384
ds_read_b64_tr_b16 a[42:43], v25 offset:18432
M a[8:11], v[176:179], a[128:131], a[8:11]
buffer_load_dwordx4 a[100:103], v1, s[44:47], s25 offen offset:1024 sc1
M a[8:11], v[180:183], a[132:135], a[8:11]
ds_read_b64_tr_b16 a[44:45], v25 offset:20480
ds_read_b64_tr_b16 a[46:47], v25 offset:22528
buffer_load_dwordx4 a[104:107], v1, s[44:47], s25 offen offset:2048 sc1
M a[12:15], v[188:191], a[132:135], a[12:15]
ds_read_b64_tr_b16 a[48:49], v26 offset:16384
ds_read_b64_tr_b16 a[50:51], v26 offset:18432
M a[12:15], v[184:187], a[128:131], a[12:15]
buffer_load_dwordx4 a[108:111], v1, s[44:47], s25 offen offset:3072 sc1
M a[16:19], v[160:163], a[136:139], a[16:19]
ds_read_b64_tr_b16 a[52:53], v26 offset:20480
ds_read_b64_tr_b16 a[54:55], v26 offset:22528
s_add_u32 s25, s25, 16384
s_add_u32 s26, s26, 131072
M a[16:19], v[164:167], a[140:143], a[16:19]
ds_read_b64_tr_b16 a[56:57], v27 offset:16384
ds_read_b64_tr_b16 a[58:59], v27 offset:18432
M a[20:23], v[172:175], a[140:143], a[20:23]
v_cvt_pk_bf16_f32 v136, v136, v137
v_cvt_pk_bf16_f32 v137, v138, v139
v_cvt_pk_bf16_f32 v138, v140, v141
v_cvt_pk_bf16_f32 v139, v142, v143
s_add_u32 s60, s56, 4096
buffer_store_dwordx4 v[136:139], v1, s[52:55], s60 offen offset:3072 sc1
M a[20:23], v[168:171], a[136:139], a[20:23]
ds_read_b64_tr_b16 a[60:61], v27 offset:20480
ds_read_b64_tr_b16 a[62:63], v27 offset:22528
v_cvt_pk_bf16_f32 v144, v144, v145
v_cvt_pk_bf16_f32 v145, v146, v147
v_cvt_pk_bf16_f32 v146, v148, v149
v_cvt_pk_bf16_f32 v147, v150, v151
s_add_u32 s60, s56, 8192
buffer_store_dwordx4 v[144:147], v1, s[52:55], s60 offen offset:3072 sc1
M a[24:27], v[176:179], a[136:139], a[24:27]
v_cvt_pk_bf16_f32 v152, v152, v153
v_cvt_pk_bf16_f32 v153, v154, v155
v_cvt_pk_bf16_f32 v154, v156, v157
v_cvt_pk_bf16_f32 v155, v158, v159
s_add_u32 s60, s56, 12288
buffer_store_dwordx4 v[152:155], v1, s[52:55], s60 offen offset:3072 sc1
M a[24:27], v[180:183], a[140:143], a[24:27]
v_and_b32 v11, 3, v0
v_lshlrev_b32 v11, 4, v11
M a[28:31], v[188:191], a[140:143], a[28:31]
M a[28:31], v[184:187], a[136:139], a[28:31]
s_waitcnt vmcnt(24) lgkmcnt(0)
s_barrier
s_waitcnt vmcnt(0)
s_mov_b64 exec, 1
buffer_store_dword v254, v253, s[52:55], s58 offen sc1
s_mov_b64 exec, -1
M a[0:3], a[32:35], a[160:163], a[0:3]
s_add_u32 m0, s42, 81920
s_nop 0
buffer_load_dwordx4 v6, s[48:51], s26 offen offset:0 lds
ds_read_b64_tr_b16 v[160:161], v24 offset:32768
ds_read_b64_tr_b16 v[162:163], v24 offset:34816
M a[0:3], a[36:39], a[164:167], a[0:3]
buffer_load_dwordx4 v7, s[48:51], s26 offen offset:1024 lds
M a[4:7], a[44:47], a[164:167], a[4:7]
ds_read_b64_tr_b16 v[164:165], v24 offset:36864
ds_read_b64_tr_b16 v[166:167], v24 offset:38912
M a[4:7], a[40:43], a[160:163], a[4:7]
buffer_load_dwordx4 a[128:131], v1, s[44:47], s25 offen offset:0 sc1
M a[8:11], a[48:51], a[160:163], a[8:11]
ds_read_b64_tr_b16 v[168:169], v25 offset:32768
ds_read_b64_tr_b16 v[170:171], v25 offset:34816
M a[8:11], a[52:55], a[164:167], a[8:11]
buffer_load_dwordx4 a[132:135], v1, s[44:47], s25 offen offset:1024 sc1
M a[12:15], a[60:63], a[164:167], a[12:15]
ds_read_b64_tr_b16 v[172:173], v25 offset:36864
ds_read_b64_tr_b16 v[174:175], v25 offset:38912
M a[12:15], a[56:59], a[160:163], a[12:15]
buffer_load_dwordx4 a[136:139], v1, s[44:47], s25 offen offset:2048 sc1
M a[16:19], a[32:35], a[168:171], a[16:19]
ds_read_b64_tr_b16 v[176:177], v26 offset:32768
ds_read_b64_tr_b16 v[178:179], v26 offset:34816
M a[16:19], a[36:39], a[172:175], a[16:19]
buffer_load_dwordx4 a[140:143], v1, s[44:47], s25 offen offset:3072 sc1
M a[20:23], a[44:47], a[172:175], a[20:23]
ds_read_b64_tr_b16 v[180:181], v26 offset:36864
ds_read_b64_tr_b16 v[182:183], v26 offset:38912
M a[20:23], a[40:43], a[168:171], a[20:23]
s_add_u32 s25, s25, 16384
s_add_u32 s26, s26, 131072
M a[24:27], a[48:51], a[168:171], a[24:27]
ds_read_b64_tr_b16 v[184:185], v27 offset:32768
ds_read_b64_tr_b16 v[186:187], v27 offset:34816
M a[24:27], a[52:55], a[172:175], a[24:27]
ds_read_b64_tr_b16 v[188:189], v27 offset:36864
ds_read_b64_tr_b16 v[190:191], v27 offset:38912
M a[28:31], a[60:63], a[172:175], a[28:31]
M a[28:31], a[56:59], a[168:171], a[28:31]
s_waitcnt vmcnt(21) lgkmcnt(0)
s_barrier
M a[0:3], v[160:163], a[192:195], a[0:3]
s_add_u32 m0, s42, 98304
s_nop 0
buffer_load_dwordx4 v6, s[48:51], s26 offen offset:0 lds
ds_read_b64_tr_b16 a[32:33], v24 offset:49152
ds_read_b64_tr_b16 a[34:35], v24 offset:51200
M a[0:3], v[164:167], a[196:199], a[0:3]
buffer_load_dwordx4 v7, s[48:51], s26 offen offset:1024 lds
M a[4:7], v[172:175], a[196:199], a[4:7]
ds_read_b64_tr_b16 a[36:37], v24 offset:53248
ds_read_b64_tr_b16 a[38:39], v24 offset:55296
M a[4:7], v[168:171], a[192:195], a[4:7]
buffer_load_dwordx4 a[160:163], v1, s[44:47], s25 offen offset:0 sc1
M a[8:11], v[176:179], a[192:195], a[8:11]
ds_read_b64_tr_b16 a[40:41], v25 offset:49152
ds_read_b64_tr_b16 a[42:43], v25 offset:51200
M a[8:11], v[180:183], a[196:199], a[8:11]
buffer_load_dwordx4 a[164:167], v1, s[44:47], s25 offen offset:1024 sc1
M a[12:15], v[188:191], a[196:199], a[12:15]
ds_read_b64_tr_b16 a[44:45], v25 offset:53248
ds_read_b64_tr_b16 a[46:47], v25 offset:55296
M a[12:15], v[184:187], a[192:195], a[12:15]
buffer_load_dwordx4 a[168:171], v1, s[44:47], s25 offen offset:2048 sc1
M a[16:19], v[160:163], a[200:203], a[16:19]
ds_read_b64_tr_b16 a[48:49], v26 offset:49152
ds_read_b64_tr_b16 a[50:51], v26 offset:51200
M a[16:19], v[164:167], a[204:207], a[16:19]
buffer_load_dwordx4 a[172:175], v1, s[44:47], s25 offen offset:3072 sc1
M a[20:23], v[172:175], a[204:207], a[20:23]
ds_read_b64_tr_b16 a[52:53], v26 offset:53248
ds_read_b64_tr_b16 a[54:55], v26 offset:55296
M a[20:23], v[168:171], a[200:203], a[20:23]
s_add_u32 s25, s25, 16384
s_add_u32 s26, s26, 131072
M a[24:27], v[176:179], a[200:203], a[24:27]
ds_read_b64_tr_b16 a[56:57], v27 offset:49152
ds_read_b64_tr_b16 a[58:59], v27 offset:51200
M a[24:27], v[180:183], a[204:207], a[24:27]
ds_read_b64_tr_b16 a[60:61], v27 offset:53248
ds_read_b64_tr_b16 a[62:63], v27 offset:55296
M a[28:31], v[188:191], a[204:207], a[28:31]
M a[28:31], v[184:187], a[200:203], a[28:31]
s_waitcnt vmcnt(16) lgkmcnt(0)
s_barrier
M a[0:3], a[32:35], a[224:227], a[0:3]
s_add_u32 m0, s42, 114688
s_nop 0
buffer_load_dwordx4 v6, s[48:51], s26 offen offset:0 lds
ds_read_b64_tr_b16 v[160:161], v28 offset:0
ds_read_b64_tr_b16 v[162:163], v28 offset:2048
M a[0:3], a[36:39], a[228:231], a[0:3]
buffer_load_dwordx4 v7, s[48:51], s26 offen offset:1024 lds
M a[4:7], a[44:47], a[228:231], a[4:7]
ds_read_b64_tr_b16 v[164:165], v28 offset:4096
ds_read_b64_tr_b16 v[166:167], v28 offset:6144
M a[4:7], a[40:43], a[224:227], a[4:7]
buffer_load_dwordx4 a[192:195], v1, s[44:47], s25 offen offset:0 sc1
M a[8:11], a[48:51], a[224:227], a[8:11]
ds_read_b64_tr_b16 v[168:169], v29 offset:0
ds_read_b64_tr_b16 v[170:171], v29 offset:2048
M a[8:11], a[52:55], a[228:231], a[8:11]
buffer_load_dwordx4 a[196:199], v1, s[44:47], s25 offen offset:1024 sc1
M a[12:15], a[60:63], a[228:231], a[12:15]
ds_read_b64_tr_b16 v[172:173], v29 offset:4096
ds_read_b64_tr_b16 v[174:175], v29 offset:6144
M a[12:15], a[56:59], a[224:227], a[12:15]
buffer_load_dwordx4 a[200:203], v1, s[44:47], s25 offen offset:2048 sc1
M a[16:19], a[32:35], a[232:235], a[16:19]
ds_read_b64_tr_b16 v[176:177], v30 offset:0
ds_read_b64_tr_b16 v[178:179], v30 offset:2048
M a[16:19], a[36:39], a[236:239], a[16:19]
buffer_load_dwordx4 a[204:207], v1, s[44:47], s25 offen offset:3072 sc1
M a[20:23], a[44:47], a[236:239], a[20:23]
ds_read_b64_tr_b16 v[180:181], v30 offset:4096
ds_read_b64_tr_b16 v[182:183], v30 offset:6144
M a[20:23], a[40:43], a[232:235], a[20:23]
s_add_u32 s25, s25, 16384
s_add_u32 s26, s26, 131072
M a[24:27], a[48:51], a[232:235], a[24:27]
ds_read_b64_tr_b16 v[184:185], v31 offset:0
ds_read_b64_tr_b16 v[186:187], v31 offset:2048
M a[24:27], a[52:55], a[236:239], a[24:27]
ds_read_b64_tr_b16 v[188:189], v31 offset:4096
ds_read_b64_tr_b16 v[190:191], v31 offset:6144
M a[28:31], a[60:63], a[236:239], a[28:31]
M a[28:31], a[56:59], a[232:235], a[28:31]
s_waitcnt vmcnt(12) lgkmcnt(0)
s_barrier
M a[0:3], v[160:163], a[96:99], a[0:3]
s_add_u32 m0, s42, 0
s_nop 0
buffer_load_dwordx4 v6, s[48:51], s26 offen offset:0 lds
ds_read_b64_tr_b16 a[32:33], v28 offset:16384
ds_read_b64_tr_b16 a[34:35], v28 offset:18432
M a[0:3], v[164:167], a[100:103], a[0:3]
buffer_load_dwordx4 v7, s[48:51], s26 offen offset:1024 lds
M a[4:7], v[172:175], a[100:103], a[4:7]
ds_read_b64_tr_b16 a[36:37], v28 offset:20480
ds_read_b64_tr_b16 a[38:39], v28 offset:22528
M a[4:7], v[168:171], a[96:99], a[4:7]
buffer_load_dwordx4 a[224:227], v1, s[44:47], s25 offen offset:0 sc1
M a[8:11], v[176:179], a[96:99], a[8:11]
ds_read_b64_tr_b16 a[40:41], v29 offset:16384
ds_read_b64_tr_b16 a[42:43], v29 offset:18432
M a[8:11], v[180:183], a[100:103], a[8:11]
buffer_load_dwordx4 a[228:231], v1, s[44:47], s25 offen offset:1024 sc1
M a[12:15], v[188:191], a[100:103], a[12:15]
ds_read_b64_tr_b16 a[44:45], v29 offset:20480
ds_read_b64_tr_b16 a[46:47], v29 offset:22528
M a[12:15], v[184:187], a[96:99], a[12:15]
buffer_load_dwordx4 a[232:235], v1, s[44:47], s25 offen offset:2048 sc1
M a[16:19], v[160:163], a[104:107], a[16:19]
ds_read_b64_tr_b16 a[48:49], v30 offset:16384
ds_read_b64_tr_b16 a[50:51], v30 offset:18432
M a[16:19], v[164:167], a[108:111], a[16:19]
buffer_load_dwordx4 a[236:239], v1, s[44:47], s25 offen offset:3072 sc1
M a[20:23], v[172:175], a[108:111], a[20:23]
ds_read_b64_tr_b16 a[52:53], v30 offset:20480
ds_read_b64_tr_b16 a[54:55], v30 offset:22528
M a[20:23], v[168:171], a[104:107], a[20:23]
s_add_u32 s25, s25, 16384
s_add_u32 s26, s26, 131072
M a[24:27], v[176:179], a[104:107], a[24:27]
ds_read_b64_tr_b16 a[56:57], v31 offset:16384
ds_read_b64_tr_b16 a[58:59], v31 offset:18432
M a[24:27], v[180:183], a[108:111], a[24:27]
ds_read_b64_tr_b16 a[60:61], v31 offset:20480
ds_read_b64_tr_b16 a[62:63], v31 offset:22528
M a[28:31], v[188:191], a[108:111], a[28:31]
M a[28:31], v[184:187], a[104:107], a[28:31]
s_waitcnt vmcnt(12) lgkmcnt(0)
s_barrier
M a[0:3], a[32:35], a[128:131], a[0:3]
ds_read_b64_tr_b16 v[160:161], v28 offset:32768
ds_read_b64_tr_b16 v[162:163], v28 offset:34816
M a[0:3], a[36:39], a[132:135], a[0:3]
ds_read_b64_tr_b16 v[164:165], v28 offset:36864
ds_read_b64_tr_b16 v[166:167], v28 offset:38912
M a[4:7], a[44:47], a[132:135], a[4:7]
M a[4:7], a[40:43], a[128:131], a[4:7]
ds_read_b64_tr_b16 v[168:169], v29 offset:32768
ds_read_b64_tr_b16 v[170:171], v29 offset:34816
M a[8:11], a[48:51], a[128:131], a[8:11]
M a[8:11], a[52:55], a[132:135], a[8:11]
ds_read_b64_tr_b16 v[172:173], v29 offset:36864
ds_read_b64_tr_b16 v[174:175], v29 offset:38912
M a[12:15], a[60:63], a[132:135], a[12:15]
M a[12:15], a[56:59], a[128:131], a[12:15]
ds_read_b64_tr_b16 v[176:177], v30 offset:32768
ds_read_b64_tr_b16 v[178:179], v30 offset:34816
M a[16:19], a[32:35], a[136:139], a[16:19]
ds_read_b64_tr_b16 v[180:181], v30 offset:36864
ds_read_b64_tr_b16 v[182:183], v30 offset:38912
M a[16:19], a[36:39], a[140:143], a[16:19]
M a[20:23], a[44:47], a[140:143], a[20:23]
ds_read_b64_tr_b16 v[184:185], v31 offset:32768
ds_read_b64_tr_b16 v[186:187], v31 offset:34816
M a[20:23], a[40:43], a[136:139], a[20:23]
M a[24:27], a[48:51], a[136:139], a[24:27]
ds_read_b64_tr_b16 v[188:189], v31 offset:36864
ds_read_b64_tr_b16 v[190:191], v31 offset:38912
M a[24:27], a[52:55], a[140:143], a[24:27]
M a[28:31], a[60:63], a[140:143], a[28:31]
M a[28:31], a[56:59], a[136:139], a[28:31]
s_waitcnt vmcnt(6) lgkmcnt(0)
s_barrier
M a[0:3], v[160:163], a[160:163], a[0:3]
buffer_load_dword v8, v11, s[52:55], s59 offen sc1
M a[0:3], v[164:167], a[164:167], a[0:3]
ds_read_b64_tr_b16 a[32:33], v28 offset:49152
ds_read_b64_tr_b16 a[34:35], v28 offset:51200
M a[4:7], v[172:175], a[164:167], a[4:7]
M a[4:7], v[168:171], a[160:163], a[4:7]
ds_read_b64_tr_b16 a[36:37], v28 offset:53248
ds_read_b64_tr_b16 a[38:39], v28 offset:55296
M a[8:11], v[176:179], a[160:163], a[8:11]
ds_read_b64_tr_b16 a[40:41], v29 offset:49152
ds_read_b64_tr_b16 a[42:43], v29 offset:51200
M a[8:11], v[180:183], a[164:167], a[8:11]
M a[12:15], v[188:191], a[164:167], a[12:15]
ds_read_b64_tr_b16 a[44:45], v29 offset:53248
ds_read_b64_tr_b16 a[46:47], v29 offset:55296
M a[12:15], v[184:187], a[160:163], a[12:15]
ds_read_b64_tr_b16 a[48:49], v30 offset:49152
ds_read_b64_tr_b16 a[50:51], v30 offset:51200
M a[16:19], v[160:163], a[168:171], a[16:19]
M a[16:19], v[164:167], a[172:175], a[16:19]
ds_read_b64_tr_b16 a[52:53], v30 offset:53248
ds_read_b64_tr_b16 a[54:55], v30 offset:55296
M a[20:23], v[172:175], a[172:175], a[20:23]
ds_read_b64_tr_b16 a[56:57], v31 offset:49152
ds_read_b64_tr_b16 a[58:59], v31 offset:51200
M a[20:23], v[168:171], a[168:171], a[20:23]
M a[24:27], v[176:179], a[168:171], a[24:27]
ds_read_b64_tr_b16 a[60:61], v31 offset:53248
ds_read_b64_tr_b16 a[62:63], v31 offset:55296
M a[24:27], v[180:183], a[172:175], a[24:27]
M a[28:31], v[188:191], a[172:175], a[28:31]
M a[28:31], v[184:187], a[168:171], a[28:31]
s_waitcnt vmcnt(1) lgkmcnt(0)
s_barrier
s_waitcnt vmcnt(0)
v_cmp_ne_u32 vcc, 1, v8
s_nop 0
s_cbranch_vccnz Lk3_spinfl
Lk3_gotfl:
M a[0:3], a[32:35], a[192:195], a[0:3]
s_xor_b32 s60, s56, 65536
s_add_u32 s60, s60, 4096
buffer_load_dwordx4 v[192:195], v1, s[52:55], s60 offen offset:0 sc1
ds_read_b64_tr_b16 v[160:161], v24 offset:0
ds_read_b64_tr_b16 v[162:163], v24 offset:2048
M a[0:3], a[36:39], a[196:199], a[0:3]
buffer_load_dwordx4 v[196:199], v1, s[52:55], s60 offen offset:1024 sc1
M a[4:7], a[44:47], a[196:199], a[4:7]
ds_read_b64_tr_b16 v[164:165], v24 offset:4096
ds_read_b64_tr_b16 v[166:167], v24 offset:6144
buffer_load_dwordx4 v[200:203], v1, s[52:55], s60 offen offset:2048 sc1
M a[4:7], a[40:43], a[192:195], a[4:7]
ds_read_b64_tr_b16 v[168:169], v25 offset:0
ds_read_b64_tr_b16 v[170:171], v25 offset:2048
M a[8:11], a[48:51], a[192:195], a[8:11]
buffer_load_dwordx4 v[204:207], v1, s[52:55], s60 offen offset:3072 sc1
ds_read_b64_tr_b16 v[172:173], v25 offset:4096
ds_read_b64_tr_b16 v[174:175], v25 offset:6144
M a[8:11], a[52:55], a[196:199], a[8:11]
s_xor_b32 s60, s56, 131072
s_add_u32 s60, s60, 8192
buffer_load_dwordx4 v[208:211], v1, s[52:55], s60 offen offset:0 sc1
M a[12:15], a[60:63], a[196:199], a[12:15]
ds_read_b64_tr_b16 v[176:177], v26 offset:0
ds_read_b64_tr_b16 v[178:179], v26 offset:2048
M a[12:15], a[56:59], a[192:195], a[12:15]
buffer_load_dwordx4 v[212:215], v1, s[52:55], s60 offen offset:1024 sc1
ds_read_b64_tr_b16 v[180:181], v26 offset:4096
ds_read_b64_tr_b16 v[182:183], v26 offset:6144
M a[16:19], a[32:35], a[200:203], a[16:19]
buffer_load_dwordx4 v[216:219], v1, s[52:55], s60 offen offset:2048 sc1
M a[16:19], a[36:39], a[204:207], a[16:19]
ds_read_b64_tr_b16 v[184:185], v27 offset:0
ds_read_b64_tr_b16 v[186:187], v27 offset:2048
buffer_load_dwordx4 v[220:223], v1, s[52:55], s60 offen offset:3072 sc1
M a[20:23], a[44:47], a[204:207], a[20:23]
ds_read_b64_tr_b16 v[188:189], v27 offset:4096
ds_read_b64_tr_b16 v[190:191], v27 offset:6144
M a[20:23], a[40:43], a[200:203], a[20:23]
s_xor_b32 s60, s56, 196608
s_add_u32 s60, s60, 12288
buffer_load_dwordx4 v[224:227], v1, s[52:55], s60 offen offset:0 sc1
buffer_load_dwordx4 v[228:231], v1, s[52:55], s60 offen offset:1024 sc1
M a[24:27], a[48:51], a[200:203], a[24:27]
buffer_load_dwordx4 v[232:235], v1, s[52:55], s60 offen offset:2048 sc1
M a[24:27], a[52:55], a[204:207], a[24:27]
buffer_load_dwordx4 v[236:239], v1, s[52:55], s60 offen offset:3072 sc1
M a[28:31], a[60:63], a[204:207], a[28:31]
M a[28:31], a[56:59], a[200:203], a[28:31]
s_waitcnt lgkmcnt(0)
M a[0:3], v[160:163], a[224:227], a[0:3]
M a[0:3], v[164:167], a[228:231], a[0:3]
M a[4:7], v[172:175], a[228:231], a[4:7]
M a[4:7], v[168:171], a[224:227], a[4:7]
M a[8:11], v[176:179], a[224:227], a[8:11]
M a[8:11], v[180:183], a[228:231], a[8:11]
M a[12:15], v[188:191], a[228:231], a[12:15]
M a[12:15], v[184:187], a[224:227], a[12:15]
M a[16:19], v[160:163], a[232:235], a[16:19]
M a[16:19], v[164:167], a[236:239], a[16:19]
M a[20:23], v[172:175], a[236:239], a[20:23]
M a[20:23], v[168:171], a[232:235], a[20:23]
M a[24:27], v[176:179], a[232:235], a[24:27]
M a[24:27], v[180:183], a[236:239], a[24:27]
M a[28:31], v[188:191], a[236:239], a[28:31]
M a[28:31], v[184:187], a[232:235], a[28:31]
v_bfe_u32 v8, v0, 4, 1
v_lshrrev_b32 v9, 5, v0
v_lshl_or_b32 v8, v8, 1, v9
v_and_b32 v9, 15, v0
v_lshlrev_b32 v9, 13, v9
v_lshl_add_u32 v8, v8, 4, v9
s_and_b32 s3, s101, 1
s_lshl_b32 s3, s3, 6
s_lshr_b32 s6, s101, 1
s_add_u32 s3, s3, s6
s_add_u32 s3, s3, s21
s_lshl_b32 s3, s3, 12
s_lshl_b32 s6, s22, 1
s_add_u32 s3, s3, s6
s_add_u32 s3, s3, 2048
v_accvgpr_read_b32 v20, a0
v_accvgpr_read_b32 v21, a1
v_accvgpr_read_b32 v22, a2
v_accvgpr_read_b32 v23, a3
v_accvgpr_read_b32 v24, a4
v_accvgpr_read_b32 v25, a5
v_accvgpr_read_b32 v26, a6
v_accvgpr_read_b32 v27, a7
v_cvt_pk_bf16_f32 v12, v20, v21
v_cvt_pk_bf16_f32 v13, v22, v23
v_cvt_pk_bf16_f32 v14, v24, v25
v_cvt_pk_bf16_f32 v15, v26, v27
s_nop 0
v_permlane16_swap_b32 v12, v14
v_permlane16_swap_b32 v13, v15
buffer_store_dwordx4 v[12:15], v8, s[16:19], s3 offen offset:0
v_accvgpr_read_b32 v20, a8
v_accvgpr_read_b32 v21, a9
v_accvgpr_read_b32 v22, a10
v_accvgpr_read_b32 v23, a11
v_accvgpr_read_b32 v24, a12
v_accvgpr_read_b32 v25, a13
v_accvgpr_read_b32 v26, a14
v_accvgpr_read_b32 v27, a15
v_cvt_pk_bf16_f32 v16, v20, v21
v_cvt_pk_bf16_f32 v17, v22, v23
v_cvt_pk_bf16_f32 v18, v24, v25
v_cvt_pk_bf16_f32 v19, v26, v27
s_nop 0
v_permlane16_swap_b32 v16, v18
v_permlane16_swap_b32 v17, v19
buffer_store_dwordx4 v[16:19], v8, s[16:19], s3 offen offset:64
s_add_u32 s3, s3, 131072
v_accvgpr_read_b32 v20, a16
v_accvgpr_read_b32 v21, a17
v_accvgpr_read_b32 v22, a18
v_accvgpr_read_b32 v23, a19
v_accvgpr_read_b32 v24, a20
v_accvgpr_read_b32 v25, a21
v_accvgpr_read_b32 v26, a22
v_accvgpr_read_b32 v27, a23
v_cvt_pk_bf16_f32 v12, v20, v21
v_cvt_pk_bf16_f32 v13, v22, v23
v_cvt_pk_bf16_f32 v14, v24, v25
v_cvt_pk_bf16_f32 v15, v26, v27
s_nop 0
v_permlane16_swap_b32 v12, v14
v_permlane16_swap_b32 v13, v15
buffer_store_dwordx4 v[12:15], v8, s[16:19], s3 offen offset:0
v_accvgpr_read_b32 v20, a24
v_accvgpr_read_b32 v21, a25
v_accvgpr_read_b32 v22, a26
v_accvgpr_read_b32 v23, a27
v_accvgpr_read_b32 v24, a28
v_accvgpr_read_b32 v25, a29
v_accvgpr_read_b32 v26, a30
v_accvgpr_read_b32 v27, a31
v_cvt_pk_bf16_f32 v16, v20, v21
v_cvt_pk_bf16_f32 v17, v22, v23
v_cvt_pk_bf16_f32 v18, v24, v25
v_cvt_pk_bf16_f32 v19, v26, v27
s_nop 0
v_permlane16_swap_b32 v16, v18
v_permlane16_swap_b32 v17, v19
buffer_store_dwordx4 v[16:19], v8, s[16:19], s3 offen offset:64
v_bfe_u32 v8, v0, 4, 1
v_lshrrev_b32 v9, 5, v0
v_lshl_or_b32 v8, v8, 1, v9
v_and_b32 v9, 15, v0
v_lshlrev_b32 v9, 12, v9
v_lshl_add_u32 v8, v8, 4, v9
s_lshl_b32 s3, s101, 6
s_add_u32 s3, s3, s29
s_lshl_b32 s3, s3, 12
s_lshl_b32 s6, s30, 1
s_add_u32 s3, s3, s6
s_mov_b32 s6, 0x00003f80
s_mov_b32 s7, 0x3f800000
s_waitcnt vmcnt(4)
v_dot2_f32_bf16 v32, v192, s6, v32
v_dot2_f32_bf16 v33, v192, s7, v33
v_dot2_f32_bf16 v34, v193, s6, v34
v_dot2_f32_bf16 v35, v193, s7, v35
v_dot2_f32_bf16 v36, v194, s6, v36
v_dot2_f32_bf16 v37, v194, s7, v37
v_dot2_f32_bf16 v38, v195, s6, v38
v_dot2_f32_bf16 v39, v195, s7, v39
v_dot2_f32_bf16 v32, v208, s6, v32
v_dot2_f32_bf16 v33, v208, s7, v33
v_dot2_f32_bf16 v34, v209, s6, v34
v_dot2_f32_bf16 v35, v209, s7, v35
v_dot2_f32_bf16 v36, v210, s6, v36
v_dot2_f32_bf16 v37, v210, s7, v37
v_dot2_f32_bf16 v38, v211, s6, v38
v_dot2_f32_bf16 v39, v211, s7, v39
v_dot2_f32_bf16 v32, v224, s6, v32
v_dot2_f32_bf16 v33, v224, s7, v33
v_dot2_f32_bf16 v34, v225, s6, v34
v_dot2_f32_bf16 v35, v225, s7, v35
v_dot2_f32_bf16 v36, v226, s6, v36
v_dot2_f32_bf16 v37, v226, s7, v37
v_dot2_f32_bf16 v38, v227, s6, v38
v_dot2_f32_bf16 v39, v227, s7, v39
v_cvt_pk_bf16_f32 v12, v32, v33
v_cvt_pk_bf16_f32 v13, v34, v35
v_cvt_pk_bf16_f32 v14, v36, v37
v_cvt_pk_bf16_f32 v15, v38, v39
s_nop 0
v_permlane16_swap_b32 v12, v14
v_permlane16_swap_b32 v13, v15
buffer_store_dwordx4 v[12:15], v8, s[16:19], s3 offen offset:0
s_add_u32 s3, s3, 65536
v_dot2_f32_bf16 v64, v196, s6, v64
v_dot2_f32_bf16 v65, v196, s7, v65
v_dot2_f32_bf16 v66, v197, s6, v66
v_dot2_f32_bf16 v67, v197, s7, v67
v_dot2_f32_bf16 v68, v198, s6, v68
v_dot2_f32_bf16 v69, v198, s7, v69
v_dot2_f32_bf16 v70, v199, s6, v70
v_dot2_f32_bf16 v71, v199, s7, v71
v_dot2_f32_bf16 v64, v212, s6, v64
v_dot2_f32_bf16 v65, v212, s7, v65
v_dot2_f32_bf16 v66, v213, s6, v66
v_dot2_f32_bf16 v67, v213, s7, v67
v_dot2_f32_bf16 v68, v214, s6, v68
v_dot2_f32_bf16 v69, v214, s7, v69
v_dot2_f32_bf16 v70, v215, s6, v70
v_dot2_f32_bf16 v71, v215, s7, v71
v_dot2_f32_bf16 v64, v228, s6, v64
v_dot2_f32_bf16 v65, v228, s7, v65
v_dot2_f32_bf16 v66, v229, s6, v66
v_dot2_f32_bf16 v67, v229, s7, v67
v_dot2_f32_bf16 v68, v230, s6, v68
v_dot2_f32_bf16 v69, v230, s7, v69
v_dot2_f32_bf16 v70, v231, s6, v70
v_dot2_f32_bf16 v71, v231, s7, v71
v_cvt_pk_bf16_f32 v16, v64, v65
v_cvt_pk_bf16_f32 v17, v66, v67
v_cvt_pk_bf16_f32 v18, v68, v69
v_cvt_pk_bf16_f32 v19, v70, v71
s_nop 0
v_permlane16_swap_b32 v16, v18
v_permlane16_swap_b32 v17, v19
buffer_store_dwordx4 v[16:19], v8, s[16:19], s3 offen offset:0
s_add_u32 s3, s3, 65536
v_dot2_f32_bf16 v96, v200, s6, v96
v_dot2_f32_bf16 v97, v200, s7, v97
v_dot2_f32_bf16 v98, v201, s6, v98
v_dot2_f32_bf16 v99, v201, s7, v99
v_dot2_f32_bf16 v100, v202, s6, v100
v_dot2_f32_bf16 v101, v202, s7, v101
v_dot2_f32_bf16 v102, v203, s6, v102
v_dot2_f32_bf16 v103, v203, s7, v103
v_dot2_f32_bf16 v96, v216, s6, v96
v_dot2_f32_bf16 v97, v216, s7, v97
v_dot2_f32_bf16 v98, v217, s6, v98
v_dot2_f32_bf16 v99, v217, s7, v99
v_dot2_f32_bf16 v100, v218, s6, v100
v_dot2_f32_bf16 v101, v218, s7, v101
v_dot2_f32_bf16 v102, v219, s6, v102
v_dot2_f32_bf16 v103, v219, s7, v103
v_dot2_f32_bf16 v96, v232, s6, v96
v_dot2_f32_bf16 v97, v232, s7, v97
v_dot2_f32_bf16 v98, v233, s6, v98
v_dot2_f32_bf16 v99, v233, s7, v99
v_dot2_f32_bf16 v100, v234, s6, v100
v_dot2_f32_bf16 v101, v234, s7, v101
v_dot2_f32_bf16 v102, v235, s6, v102
v_dot2_f32_bf16 v103, v235, s7, v103
v_cvt_pk_bf16_f32 v12, v96, v97
v_cvt_pk_bf16_f32 v13, v98, v99
v_cvt_pk_bf16_f32 v14, v100, v101
v_cvt_pk_bf16_f32 v15, v102, v103
s_nop 0
v_permlane16_swap_b32 v12, v14
v_permlane16_swap_b32 v13, v15
buffer_store_dwordx4 v[12:15], v8, s[16:19], s3 offen offset:0
s_add_u32 s3, s3, 65536
v_dot2_f32_bf16 v128, v204, s6, v128
v_dot2_f32_bf16 v129, v204, s7, v129
v_dot2_f32_bf16 v130, v205, s6, v130
v_dot2_f32_bf16 v131, v205, s7, v131
v_dot2_f32_bf16 v132, v206, s6, v132
v_dot2_f32_bf16 v133, v206, s7, v133
v_dot2_f32_bf16 v134, v207, s6, v134
v_dot2_f32_bf16 v135, v207, s7, v135
v_dot2_f32_bf16 v128, v220, s6, v128
v_dot2_f32_bf16 v129, v220, s7, v129
v_dot2_f32_bf16 v130, v221, s6, v130
v_dot2_f32_bf16 v131, v221, s7, v131
v_dot2_f32_bf16 v132, v222, s6, v132
v_dot2_f32_bf16 v133, v222, s7, v133
v_dot2_f32_bf16 v134, v223, s6, v134
v_dot2_f32_bf16 v135, v223, s7, v135
v_dot2_f32_bf16 v128, v236, s6, v128
v_dot2_f32_bf16 v129, v236, s7, v129
v_dot2_f32_bf16 v130, v237, s6, v130
v_dot2_f32_bf16 v131, v237, s7, v131
v_dot2_f32_bf16 v132, v238, s6, v132
v_dot2_f32_bf16 v133, v238, s7, v133
v_dot2_f32_bf16 v134, v239, s6, v134
v_dot2_f32_bf16 v135, v239, s7, v135
v_cvt_pk_bf16_f32 v16, v128, v129
v_cvt_pk_bf16_f32 v17, v130, v131
v_cvt_pk_bf16_f32 v18, v132, v133
v_cvt_pk_bf16_f32 v19, v134, v135
s_nop 0
v_permlane16_swap_b32 v16, v18
v_permlane16_swap_b32 v17, v19
buffer_store_dwordx4 v[16:19], v8, s[16:19], s3 offen offset:0
s_endpgm
Lk3_spinb0:
Lk3_spinb0_:
s_add_u32 s61, s61, 1
s_cmp_gt_u32 s61, 1048576
s_cbranch_scc1 Lk3_gotb0
s_sleep 2
buffer_load_dword v7, v15, s[52:55], s43 offen sc1
s_waitcnt vmcnt(0)
v_cmp_ne_u32 vcc, 1, v7
s_nop 0
s_cbranch_vccnz Lk3_spinb0_
s_branch Lk3_gotb0
Lk3_spinb1:
Lk3_spinb1_:
s_add_u32 s61, s61, 1
s_cmp_gt_u32 s61, 1048576
s_cbranch_scc1 Lk3_gotb1
s_sleep 2
buffer_load_dword v7, v15, s[52:55], s43 offen sc1
s_waitcnt vmcnt(0)
v_cmp_ne_u32 vcc, 1, v7
s_nop 0
s_cbranch_vccnz Lk3_spinb1_
s_branch Lk3_gotb1
Lk3_spinb2:
Lk3_spinb2_:
s_add_u32 s61, s61, 1
s_cmp_gt_u32 s61, 1048576
s_cbranch_scc1 Lk3_gotb2
s_sleep 2
buffer_load_dword v7, v15, s[52:55], s43 offen sc1
s_waitcnt vmcnt(0)
v_cmp_ne_u32 vcc, 1, v7
s_nop 0
s_cbranch_vccnz Lk3_spinb2_
s_branch Lk3_gotb2
Lk3_spinb3:
Lk3_spinb3_:
s_add_u32 s61, s61, 1
s_cmp_gt_u32 s61, 1048576
s_cbranch_scc1 Lk3_gotb3
s_sleep 2
buffer_load_dword v7, v15, s[52:55], s43 offen sc1
s_waitcnt vmcnt(0)
v_cmp_ne_u32 vcc, 1, v7
s_nop 0
s_cbranch_vccnz Lk3_spinb3_
s_branch Lk3_gotb3
Lk3_spinft:
s_add_u32 s61, s61, 1
s_cmp_gt_u32 s61, 1048576
s_cbranch_scc1 Lk3_gotft
s_sleep 2
buffer_load_dword v252, v255, s[52:55], s62 offen sc1
s_waitcnt vmcnt(0)
v_cmp_ne_u32 vcc, 1, v252
s_nop 0
s_cbranch_vccnz Lk3_spinft
s_branch Lk3_gotft
Lk3_spinfl:
s_add_u32 s61, s61, 1
s_cmp_gt_u32 s61, 1048576
s_cbranch_scc1 Lk3_gotfl
s_sleep 2
buffer_load_dword v8, v11, s[52:55], s59 offen sc1
s_waitcnt vmcnt(0)
v_cmp_ne_u32 vcc, 1, v8
s_nop 0
s_cbranch_vccnz Lk3_spinfl
s_branch Lk3_gotfl
Lc3:
.section .rodata,"a"
.p2align 6
.amdhsa_kernel concat_heads__compressed_kv_cla__sliding_local_dilated__prompt_kernel
  .amdhsa_next_free_vgpr 512
  .amdhsa_next_free_sgpr 102
  .amdhsa_accum_offset 256
  .amdhsa_group_segment_fixed_size 0
  .amdhsa_kernarg_size 96
  .amdhsa_user_sgpr_count 2
  .amdhsa_user_sgpr_kernarg_segment_ptr 1
  .amdhsa_system_sgpr_workgroup_id_x 1
.end_amdhsa_kernel
```
